```python
import torch

def _softmax(x, axis=-1):
    return torch.softmax(x, dim=axis)

def _gelu(x):
    return torch.nn.functional.gelu(x, approximate='tanh')

def _silu(x):
    return torch.nn.functional.silu(x)

def _sigmoid(x):
    return torch.sigmoid(x)

def _layernorm(x, axis=-1, eps=1e-05):
    m = x.mean(dim=axis, keepdim=True)
    v = x.var(dim=axis, keepdim=True, unbiased=False)
    return (x - m) / torch.sqrt(v + eps)

def _scatter_add(tgt, idx, src, axis=0):
    return tgt.clone().index_add_(axis, idx, src)

def _segment_sum(src, seg, n):
    out = torch.zeros((n,) + src.shape[1:], dtype=src.dtype)
    return out.index_add_(0, seg, src)

def _pad(x, pw):
    flat = tuple((v for pair in reversed(pw) for v in pair))
    return torch.nn.functional.pad(x, flat)
kernel_name = 'concat_heads__ssm_conv_s4d__memory_aug_recurrent_mem_tr__prompt'

def setup_inputs():

    _w = lambda a: (lambda t: t.to(torch.bfloat16) if t.is_floating_point() else t)(torch.as_tensor(a))

    def _A_setup():
        Bsz, L, D, N = (1, 2048, 448, 256)
        return {'u': _w((lambda *s: torch.randn(*s, dtype=torch.bfloat16) * 0.05)(Bsz, L, D)), 'log_A_real': _w((lambda *s: torch.randn(*s, dtype=torch.bfloat16) * 6.4)(D, N) * 0.5), 'A_imag': _w((lambda *s: torch.randn(*s, dtype=torch.bfloat16) * 0.05)(D, N) * 3.14), 'C_real': _w((lambda *s: torch.randn(*s, dtype=torch.bfloat16) * 0.2)(D, N) / N ** 0.5), 'C_imag': _w((lambda *s: torch.randn(*s, dtype=torch.bfloat16) * 0.2)(D, N) / N ** 0.5), 'log_dt': _w((lambda *s: torch.randn(*s, dtype=torch.bfloat16) * 0.05)(D) * 0.5 - 4.0), 'D_skip': _w((lambda *s: torch.randn(*s, dtype=torch.bfloat16) * 0.05)(D))}
    _A_in = _A_setup()

    def _B_setup():
        B, S, Dm = (1, 2048, 448)
        H, Dh = (16, 256)
        M, seg = (8, 32)
        seg = min(seg, S)
        S = S // seg * seg
        return {'x': _w((lambda *s: torch.randn(*s, dtype=torch.bfloat16) * 0.05)(B, S, Dm)), 'mem0': _w((lambda *s: torch.randn(*s, dtype=torch.bfloat16) * 0.4)(B, M, Dm)), 'Wq': _w((lambda *s: torch.randn(*s, dtype=torch.bfloat16) * 6.4)(Dm, H, Dh) * Dm ** (-0.5)), 'Wk': _w((lambda *s: torch.randn(*s, dtype=torch.bfloat16) * 6.4)(Dm, H, Dh) * Dm ** (-0.5)), 'Wv': _w((lambda *s: torch.randn(*s, dtype=torch.bfloat16) * 0.4)(Dm, H, Dh) * Dm ** (-0.5)), 'Wo': _w((lambda *s: torch.randn(*s, dtype=torch.bfloat16) * 0.4)(H, Dh, Dm) * (H * Dh) ** (-0.5)), 'seg_len': seg}
    _B_in = _B_setup()
    return {'A_u': _A_in['u'], 'A_log_A_real': _A_in['log_A_real'], 'A_A_imag': _A_in['A_imag'], 'A_C_real': _A_in['C_real'], 'A_C_imag': _A_in['C_imag'], 'A_log_dt': _A_in['log_dt'], 'A_D_skip': _A_in['D_skip'], 'B_x': _B_in['x'], 'B_mem0': _B_in['mem0'], 'B_Wq': _B_in['Wq'], 'B_Wk': _B_in['Wk'], 'B_Wv': _B_in['Wv'], 'B_Wo': _B_in['Wo'], 'B_seg_len': _B_in['seg_len']}

def reference(A_u, A_log_A_real, A_A_imag, A_C_real, A_C_imag, A_log_dt, A_D_skip, B_x, B_mem0, B_Wq, B_Wk, B_Wv, B_Wo, B_seg_len):

    def _A_ref(u, log_A_real, A_imag, C_real, C_imag, log_dt, D_skip):
        L = u.shape[1]
        dt = torch.exp(log_dt)
        A = -torch.exp(log_A_real) + 1j * A_imag
        C = (C_real + 1j * C_imag) * dt[:, None]
        pos = (lambda x, dt: x.to(dt))(torch.arange(L), log_dt.dtype)
        P = torch.exp((A * dt[:, None])[:, :, None] * pos[None, None, :])
        K = 2.0 * torch.einsum('dn,dnl->dl', C, P).real
        L2 = 2 * L
        u_t = (lambda x, *d: x.permute(*d))(u, 0, 2, 1)
        Kf = (lambda x, *a, **k: torch.fft.rfft(x.float(), *a, **k))(K, L2)
        Uf = (lambda x, *a, **k: torch.fft.rfft(x.float(), *a, **k))(u_t, L2)
        y = (lambda x, *a, **k: torch.fft.irfft(x, *a, **k).to(torch.bfloat16))(Uf * Kf[None, :, :], L2)[:, :, :L]
        y = (lambda x, *d: x.permute(*d))(y, 0, 2, 1)
        return y + u * D_skip[None, None, :]

    def _B_ref(x, mem0, Wq, Wk, Wv, Wo, seg_len):
        B, S, Dm = x.shape
        H, Dh = (Wq.shape[1], Wq.shape[2])
        M = mem0.shape[1]
        scale = Dh ** (-0.5)
        n_seg = S // seg_len
        L = M + seg_len
        idx = torch.arange(L)
        mask = (idx[:, None] < M) | (idx[:, None] >= idx[None, :])
        mem = mem0
        outs = []
        for s in range(n_seg):
            xs = x[:, s * seg_len:(s + 1) * seg_len, :].clone()
            h = torch.concatenate([mem, xs], axis=1)
            q = torch.einsum('btd,dhe->bhte', h, Wq)
            k = torch.einsum('btd,dhe->bhte', h, Wk)
            v = torch.einsum('btd,dhe->bhte', h, Wv)
            scores = torch.einsum('bhqe,bhke->bhqk', q, k) * scale
            scores = torch.where(mask[None, None], scores, -1000000000.0)
            p = _softmax(scores, axis=-1)
            o = torch.einsum('bhqk,bhke->bhqe', p, v)
            o = torch.einsum('bhte,hed->btd', o, Wo)
            mem = o[:, :M, :].clone()
            outs.append(o[:, M:, :])
        return torch.concatenate(outs, axis=1)
    a = _A_ref(A_u, A_log_A_real, A_A_imag, A_C_real, A_C_imag, A_log_dt, A_D_skip)
    b = _B_ref(B_x, B_mem0, B_Wq, B_Wk, B_Wv, B_Wo, B_seg_len)
    return torch.concatenate([a, b], axis=-1)
```

```asm
; @launch kernel=prep_kernel grid=(256,1,1) block=(256,1,1) lds=163840
; @launch kernel=main_kernel grid=(256,1,1) block=(256,1,1) lds=163840
.amdgcn_target "amdgcn-amd-amdhsa--gfx950"
.text
.globl prep_kernel
.p2align 8
.type prep_kernel,@function
prep_kernel:
  s_cmp_ge_u32 s2, 256
  s_cbranch_scc1 pr_end
  s_load_dwordx2 s[6:7], s[0:1], 128
  s_getpc_b64 s[98:99]
pf_prep_kernel_1:
  s_sub_u32 s98, s98, pf_prep_kernel_1-prep_kernel
  s_subb_u32 s99, s99, 0
  v_lshlrev_b32 v200, 7, v0
  v_min_u32 v201, pr_end-prep_kernel-4, v200
  global_load_dword v202, v201, s[98:99]
  v_add_u32 v200, 32768, v200
  v_lshrrev_b32 v1, 6, v0
  s_nop 0
  v_readfirstlane_b32 s16, v1
  v_and_b32 v1, 63, v0
  v_lshlrev_b32 v2, 4, v1
  v_lshrrev_b32 v3, 4, v1
  v_and_b32 v4, 15, v1
  s_waitcnt lgkmcnt(0)
  s_mov_b32 s8, s6
  s_and_b32 s9, s7, 0xffff
  s_mov_b32 s10, 268435456
  s_mov_b32 s11, 0x20000
  s_cmp_ge_u32 s2, 224
  s_cbranch_scc1 pr_x
  s_load_dwordx4 s[40:43], s[0:1], 72
  s_load_dwordx4 s[44:47], s[0:1], 88
  s_mov_b32 s28, s16
  s_and_b32 s20, s2, 7
  s_lshr_b32 s21, s2, 3
  s_mul_i32 s22, s21, 37
  s_lshr_b32 s22, s22, 8
  s_mul_i32 s23, s22, 7
  s_sub_u32 s18, s21, s23
  s_lshl_b32 s20, s20, 2
  s_add_u32 s20, s20, s22
  s_lshr_b32 s19, s20, 4
  s_and_b32 s17, s20, 15
  s_waitcnt lgkmcnt(0)
  s_cmp_eq_u32 s19, 0
  s_cselect_b32 s52, s40, s44
  s_cselect_b32 s53, s41, s45
  s_cselect_b32 s54, s42, s46
  s_cselect_b32 s55, s43, s47
  s_cselect_b32 s24, 1035512379, 1.0
  s_mov_b32 s60, s52
  s_and_b32 s61, s53, 0xffff
  s_mov_b32 s62, 3670016
  s_mov_b32 s63, 0x20000
  s_mov_b32 s56, s54
  s_and_b32 s57, s55, 0xffff
  s_mov_b32 s58, 3670016
  s_mov_b32 s59, 0x20000
  s_mul_i32 s20, s18, 256
  v_mov_b32 v6, 255
  v_min_u32 v5, v0, v6
  v_add_u32 v5, s20, v5
  v_mov_b32 v6, 1791
  v_min_u32 v5, v5, v6
  v_lshrrev_b32 v6, 2, v5
  v_and_b32 v5, 3, v5
  v_lshlrev_b32 v5, 7, v5
  v_lshl_add_u32 v5, v6, 13, v5
  s_lshl_b32 s20, s17, 9
  buffer_load_dword v203, v5, s[60:63], s20 offen
  v_lshrrev_b32 v5, 5, v1
  v_and_b32 v6, 31, v1
  v_add_u32 v7, 0, v5
  v_and_b32 v8, 3, v7
  v_or_b32 v8, 0, v8
  v_xor_b32 v8, v6, v8
  v_lshlrev_b32 v8, 4, v8
  v_lshl_add_u32 v16, v7, 13, v8
  v_add_u32 v7, 2, v5
  v_and_b32 v8, 3, v7
  v_or_b32 v8, 0, v8
  v_xor_b32 v8, v6, v8
  v_lshlrev_b32 v8, 4, v8
  v_lshl_add_u32 v17, v7, 13, v8
  v_add_u32 v7, 4, v5
  v_and_b32 v8, 3, v7
  v_or_b32 v8, 0, v8
  v_xor_b32 v8, v6, v8
  v_lshlrev_b32 v8, 4, v8
  v_lshl_add_u32 v18, v7, 13, v8
  v_add_u32 v7, 6, v5
  v_and_b32 v8, 3, v7
  v_or_b32 v8, 0, v8
  v_xor_b32 v8, v6, v8
  v_lshlrev_b32 v8, 4, v8
  v_lshl_add_u32 v19, v7, 13, v8
  v_add_u32 v7, 8, v5
  v_and_b32 v8, 3, v7
  v_or_b32 v8, 4, v8
  v_xor_b32 v8, v6, v8
  v_lshlrev_b32 v8, 4, v8
  v_lshl_add_u32 v20, v7, 13, v8
  v_add_u32 v7, 10, v5
  v_and_b32 v8, 3, v7
  v_or_b32 v8, 4, v8
  v_xor_b32 v8, v6, v8
  v_lshlrev_b32 v8, 4, v8
  v_lshl_add_u32 v21, v7, 13, v8
  v_add_u32 v7, 12, v5
  v_and_b32 v8, 3, v7
  v_or_b32 v8, 4, v8
  v_xor_b32 v8, v6, v8
  v_lshlrev_b32 v8, 4, v8
  v_lshl_add_u32 v22, v7, 13, v8
  v_add_u32 v7, 14, v5
  v_and_b32 v8, 3, v7
  v_or_b32 v8, 4, v8
  v_xor_b32 v8, v6, v8
  v_lshlrev_b32 v8, 4, v8
  v_lshl_add_u32 v23, v7, 13, v8
  v_add_u32 v7, 16, v5
  v_and_b32 v8, 3, v7
  v_or_b32 v8, 8, v8
  v_xor_b32 v8, v6, v8
  v_lshlrev_b32 v8, 4, v8
  v_lshl_add_u32 v24, v7, 13, v8
  v_add_u32 v7, 18, v5
  v_and_b32 v8, 3, v7
  v_or_b32 v8, 8, v8
  v_xor_b32 v8, v6, v8
  v_lshlrev_b32 v8, 4, v8
  v_lshl_add_u32 v25, v7, 13, v8
  v_add_u32 v7, 20, v5
  v_and_b32 v8, 3, v7
  v_or_b32 v8, 8, v8
  v_xor_b32 v8, v6, v8
  v_lshlrev_b32 v8, 4, v8
  v_lshl_add_u32 v26, v7, 13, v8
  v_add_u32 v7, 22, v5
  v_and_b32 v8, 3, v7
  v_or_b32 v8, 8, v8
  v_xor_b32 v8, v6, v8
  v_lshlrev_b32 v8, 4, v8
  v_lshl_add_u32 v27, v7, 13, v8
  v_add_u32 v7, 24, v5
  v_and_b32 v8, 3, v7
  v_or_b32 v8, 12, v8
  v_xor_b32 v8, v6, v8
  v_lshlrev_b32 v8, 4, v8
  v_lshl_add_u32 v28, v7, 13, v8
  v_add_u32 v7, 26, v5
  v_and_b32 v8, 3, v7
  v_or_b32 v8, 12, v8
  v_xor_b32 v8, v6, v8
  v_lshlrev_b32 v8, 4, v8
  v_lshl_add_u32 v29, v7, 13, v8
  v_add_u32 v7, 28, v5
  v_and_b32 v8, 3, v7
  v_or_b32 v8, 12, v8
  v_xor_b32 v8, v6, v8
  v_lshlrev_b32 v8, 4, v8
  v_lshl_add_u32 v30, v7, 13, v8
  v_add_u32 v7, 30, v5
  v_and_b32 v8, 3, v7
  v_or_b32 v8, 12, v8
  v_xor_b32 v8, v6, v8
  v_lshlrev_b32 v8, 4, v8
  v_lshl_add_u32 v31, v7, 13, v8
  s_lshl_b32 s25, s16, 15
  s_add_u32 s25, s25, 32768
  s_lshl_b32 s26, s17, 9
  s_cmp_eq_u32 s19, 0
  s_cbranch_scc0 pw_pr_stB
  s_lshl_b32 s27, s18, 19
  s_add_u32 s27, s27, s26
  s_lshl_b32 s29, s16, 4
  v_add_u32 v7, 0, v5
  v_xor_b32 v8, v6, v7
  v_lshlrev_b32 v8, 4, v8
  v_add_u32 v7, s29, v7
  v_lshl_add_u32 v8, v7, 13, v8
  s_lshl_b32 s30, s16, 13
  s_add_u32 m0, s30, 0
  s_nop 0
  buffer_load_dwordx4 v8, s[56:59], s27 offen lds
  v_add_u32 v7, 2, v5
  v_xor_b32 v8, v6, v7
  v_lshlrev_b32 v8, 4, v8
  v_add_u32 v7, s29, v7
  v_lshl_add_u32 v8, v7, 13, v8
  s_lshl_b32 s30, s16, 13
  s_add_u32 m0, s30, 1024
  s_nop 0
  buffer_load_dwordx4 v8, s[56:59], s27 offen lds
  v_add_u32 v7, 4, v5
  v_xor_b32 v8, v6, v7
  v_lshlrev_b32 v8, 4, v8
  v_add_u32 v7, s29, v7
  v_lshl_add_u32 v8, v7, 13, v8
  s_lshl_b32 s30, s16, 13
  s_add_u32 m0, s30, 2048
  s_nop 0
  buffer_load_dwordx4 v8, s[56:59], s27 offen lds
  v_add_u32 v7, 6, v5
  v_xor_b32 v8, v6, v7
  v_lshlrev_b32 v8, 4, v8
  v_add_u32 v7, s29, v7
  v_lshl_add_u32 v8, v7, 13, v8
  s_lshl_b32 s30, s16, 13
  s_add_u32 m0, s30, 3072
  s_nop 0
  buffer_load_dwordx4 v8, s[56:59], s27 offen lds
  v_add_u32 v7, 8, v5
  v_xor_b32 v8, v6, v7
  v_lshlrev_b32 v8, 4, v8
  v_add_u32 v7, s29, v7
  v_lshl_add_u32 v8, v7, 13, v8
  s_lshl_b32 s30, s16, 13
  s_add_u32 m0, s30, 4096
  s_nop 0
  buffer_load_dwordx4 v8, s[56:59], s27 offen lds
  v_add_u32 v7, 10, v5
  v_xor_b32 v8, v6, v7
  v_lshlrev_b32 v8, 4, v8
  v_add_u32 v7, s29, v7
  v_lshl_add_u32 v8, v7, 13, v8
  s_lshl_b32 s30, s16, 13
  s_add_u32 m0, s30, 5120
  s_nop 0
  buffer_load_dwordx4 v8, s[56:59], s27 offen lds
  v_add_u32 v7, 12, v5
  v_xor_b32 v8, v6, v7
  v_lshlrev_b32 v8, 4, v8
  v_add_u32 v7, s29, v7
  v_lshl_add_u32 v8, v7, 13, v8
  s_lshl_b32 s30, s16, 13
  s_add_u32 m0, s30, 6144
  s_nop 0
  buffer_load_dwordx4 v8, s[56:59], s27 offen lds
  v_add_u32 v7, 14, v5
  v_xor_b32 v8, v6, v7
  v_lshlrev_b32 v8, 4, v8
  v_add_u32 v7, s29, v7
  v_lshl_add_u32 v8, v7, 13, v8
  s_lshl_b32 s30, s16, 13
  s_add_u32 m0, s30, 7168
  s_nop 0
  buffer_load_dwordx4 v8, s[56:59], s27 offen lds
  s_waitcnt vmcnt(0)
  s_barrier
  s_min_u32 s27, s28, 13
  s_lshl_b32 s27, s27, 18
  s_add_u32 s27, s27, s26
  s_add_u32 m0, s25, 0
  s_nop 0
  buffer_load_dwordx4 v16, s[60:63], s27 offen lds
  s_add_u32 m0, s25, 1024
  s_nop 0
  buffer_load_dwordx4 v17, s[60:63], s27 offen lds
  s_add_u32 m0, s25, 2048
  s_nop 0
  buffer_load_dwordx4 v18, s[60:63], s27 offen lds
  s_add_u32 m0, s25, 3072
  s_nop 0
  buffer_load_dwordx4 v19, s[60:63], s27 offen lds
  s_add_u32 m0, s25, 4096
  s_nop 0
  buffer_load_dwordx4 v20, s[60:63], s27 offen lds
  s_add_u32 m0, s25, 5120
  s_nop 0
  buffer_load_dwordx4 v21, s[60:63], s27 offen lds
  s_add_u32 m0, s25, 6144
  s_nop 0
  buffer_load_dwordx4 v22, s[60:63], s27 offen lds
  s_add_u32 m0, s25, 7168
  s_nop 0
  buffer_load_dwordx4 v23, s[60:63], s27 offen lds
  s_add_u32 m0, s25, 8192
  s_nop 0
  buffer_load_dwordx4 v24, s[60:63], s27 offen lds
  s_add_u32 m0, s25, 9216
  s_nop 0
  buffer_load_dwordx4 v25, s[60:63], s27 offen lds
  s_add_u32 m0, s25, 10240
  s_nop 0
  buffer_load_dwordx4 v26, s[60:63], s27 offen lds
  s_add_u32 m0, s25, 11264
  s_nop 0
  buffer_load_dwordx4 v27, s[60:63], s27 offen lds
  s_add_u32 m0, s25, 12288
  s_nop 0
  buffer_load_dwordx4 v28, s[60:63], s27 offen lds
  s_add_u32 m0, s25, 13312
  s_nop 0
  buffer_load_dwordx4 v29, s[60:63], s27 offen lds
  s_add_u32 m0, s25, 14336
  s_nop 0
  buffer_load_dwordx4 v30, s[60:63], s27 offen lds
  s_add_u32 m0, s25, 15360
  s_nop 0
  buffer_load_dwordx4 v31, s[60:63], s27 offen lds
  s_add_u32 s29, s28, 4
  s_min_u32 s27, s29, 13
  s_lshl_b32 s27, s27, 18
  s_add_u32 s27, s27, s26
  s_add_u32 m0, s25, 16384
  s_nop 0
  buffer_load_dwordx4 v16, s[60:63], s27 offen lds
  s_add_u32 m0, s25, 17408
  s_nop 0
  buffer_load_dwordx4 v17, s[60:63], s27 offen lds
  s_add_u32 m0, s25, 18432
  s_nop 0
  buffer_load_dwordx4 v18, s[60:63], s27 offen lds
  s_add_u32 m0, s25, 19456
  s_nop 0
  buffer_load_dwordx4 v19, s[60:63], s27 offen lds
  s_add_u32 m0, s25, 20480
  s_nop 0
  buffer_load_dwordx4 v20, s[60:63], s27 offen lds
  s_add_u32 m0, s25, 21504
  s_nop 0
  buffer_load_dwordx4 v21, s[60:63], s27 offen lds
  s_add_u32 m0, s25, 22528
  s_nop 0
  buffer_load_dwordx4 v22, s[60:63], s27 offen lds
  s_add_u32 m0, s25, 23552
  s_nop 0
  buffer_load_dwordx4 v23, s[60:63], s27 offen lds
  s_add_u32 m0, s25, 24576
  s_nop 0
  buffer_load_dwordx4 v24, s[60:63], s27 offen lds
  s_add_u32 m0, s25, 25600
  s_nop 0
  buffer_load_dwordx4 v25, s[60:63], s27 offen lds
  s_add_u32 m0, s25, 26624
  s_nop 0
  buffer_load_dwordx4 v26, s[60:63], s27 offen lds
  s_add_u32 m0, s25, 27648
  s_nop 0
  buffer_load_dwordx4 v27, s[60:63], s27 offen lds
  s_add_u32 m0, s25, 28672
  s_nop 0
  buffer_load_dwordx4 v28, s[60:63], s27 offen lds
  s_add_u32 m0, s25, 29696
  s_nop 0
  buffer_load_dwordx4 v29, s[60:63], s27 offen lds
  s_add_u32 m0, s25, 30720
  s_nop 0
  buffer_load_dwordx4 v30, s[60:63], s27 offen lds
  s_add_u32 m0, s25, 31744
  s_nop 0
  buffer_load_dwordx4 v31, s[60:63], s27 offen lds
  v_lshrrev_b32 v7, 2, v4
  v_lshlrev_b32 v7, 4, v7
  v_and_b32 v8, 2, v4
  v_lshl_add_u32 v7, v8, 1, v7
  v_and_b32 v8, 1, v4
  v_add_u32 v7, v7, v8
  v_add_u32 v7, 0, v7
  v_and_b32 v9, 15, v7
  v_or_b32 v10, 0, v3
  v_xor_b32 v10, v10, v9
  v_lshlrev_b32 v10, 4, v10
  v_lshl_add_u32 v10, v7, 9, v10
  ds_read_b128 v[128:131], v10 offset:0
  ds_read_b128 v[144:147], v10 offset:256
  v_or_b32 v10, 4, v3
  v_xor_b32 v10, v10, v9
  v_lshlrev_b32 v10, 4, v10
  v_lshl_add_u32 v10, v7, 9, v10
  ds_read_b128 v[132:135], v10 offset:0
  ds_read_b128 v[148:151], v10 offset:256
  v_or_b32 v10, 8, v3
  v_xor_b32 v10, v10, v9
  v_lshlrev_b32 v10, 4, v10
  v_lshl_add_u32 v10, v7, 9, v10
  ds_read_b128 v[136:139], v10 offset:0
  ds_read_b128 v[152:155], v10 offset:256
  v_or_b32 v10, 12, v3
  v_xor_b32 v10, v10, v9
  v_lshlrev_b32 v10, 4, v10
  v_lshl_add_u32 v10, v7, 9, v10
  ds_read_b128 v[140:143], v10 offset:0
  ds_read_b128 v[156:159], v10 offset:256
  s_waitcnt lgkmcnt(0)
  s_mul_i32 s30, s17, 401408
  s_mul_i32 s31, s18, 57344
  s_add_u32 s30, s30, s31
  s_add_u32 s30, s30, 0
  v_add_u32 v12, s30, v2
  v_lshrrev_b32 v7, 2, v4
  v_lshlrev_b32 v7, 4, v7
  v_and_b32 v8, 2, v4
  v_lshl_add_u32 v7, v8, 1, v7
  v_and_b32 v8, 1, v4
  v_add_u32 v7, v7, v8
  v_add_u32 v7, 2, v7
  v_and_b32 v9, 15, v7
  v_or_b32 v10, 0, v3
  v_xor_b32 v10, v10, v9
  v_lshlrev_b32 v10, 4, v10
  v_lshl_add_u32 v10, v7, 9, v10
  ds_read_b128 v[160:163], v10 offset:0
  ds_read_b128 v[176:179], v10 offset:256
  v_or_b32 v10, 4, v3
  v_xor_b32 v10, v10, v9
  v_lshlrev_b32 v10, 4, v10
  v_lshl_add_u32 v10, v7, 9, v10
  ds_read_b128 v[164:167], v10 offset:0
  ds_read_b128 v[180:183], v10 offset:256
  v_or_b32 v10, 8, v3
  v_xor_b32 v10, v10, v9
  v_lshlrev_b32 v10, 4, v10
  v_lshl_add_u32 v10, v7, 9, v10
  ds_read_b128 v[168:171], v10 offset:0
  ds_read_b128 v[184:187], v10 offset:256
  v_or_b32 v10, 12, v3
  v_xor_b32 v10, v10, v9
  v_lshlrev_b32 v10, 4, v10
  v_lshl_add_u32 v10, v7, 9, v10
  ds_read_b128 v[172:175], v10 offset:0
  ds_read_b128 v[188:191], v10 offset:256
  s_waitcnt lgkmcnt(0)
  s_mul_i32 s30, s17, 401408
  s_mul_i32 s31, s18, 57344
  s_add_u32 s30, s30, s31
  s_add_u32 s30, s30, 14336
  v_add_u32 v13, s30, v2
  v_lshrrev_b32 v7, 2, v4
  v_lshlrev_b32 v7, 4, v7
  v_and_b32 v8, 2, v4
  v_lshl_add_u32 v7, v8, 1, v7
  v_and_b32 v8, 1, v4
  v_add_u32 v7, v7, v8
  v_add_u32 v7, 8, v7
  v_and_b32 v9, 15, v7
  v_or_b32 v10, 0, v3
  v_xor_b32 v10, v10, v9
  v_lshlrev_b32 v10, 4, v10
  v_lshl_add_u32 v10, v7, 9, v10
  ds_read_b128 v[192:195], v10 offset:0
  ds_read_b128 v[208:211], v10 offset:256
  v_or_b32 v10, 4, v3
  v_xor_b32 v10, v10, v9
  v_lshlrev_b32 v10, 4, v10
  v_lshl_add_u32 v10, v7, 9, v10
  ds_read_b128 v[196:199], v10 offset:0
  ds_read_b128 v[212:215], v10 offset:256
  v_or_b32 v10, 8, v3
  v_xor_b32 v10, v10, v9
  v_lshlrev_b32 v10, 4, v10
  v_lshl_add_u32 v10, v7, 9, v10
  ds_read_b128 v[200:203], v10 offset:0
  ds_read_b128 v[216:219], v10 offset:256
  v_or_b32 v10, 12, v3
  v_xor_b32 v10, v10, v9
  v_lshlrev_b32 v10, 4, v10
  v_lshl_add_u32 v10, v7, 9, v10
  ds_read_b128 v[204:207], v10 offset:0
  ds_read_b128 v[220:223], v10 offset:256
  s_waitcnt lgkmcnt(0)
  s_mul_i32 s30, s17, 401408
  s_mul_i32 s31, s18, 57344
  s_add_u32 s30, s30, s31
  s_add_u32 s30, s30, 28672
  v_add_u32 v14, s30, v2
  v_lshrrev_b32 v7, 2, v4
  v_lshlrev_b32 v7, 4, v7
  v_and_b32 v8, 2, v4
  v_lshl_add_u32 v7, v8, 1, v7
  v_and_b32 v8, 1, v4
  v_add_u32 v7, v7, v8
  v_add_u32 v7, 10, v7
  v_and_b32 v9, 15, v7
  v_or_b32 v10, 0, v3
  v_xor_b32 v10, v10, v9
  v_lshlrev_b32 v10, 4, v10
  v_lshl_add_u32 v10, v7, 9, v10
  ds_read_b128 v[224:227], v10 offset:0
  ds_read_b128 v[240:243], v10 offset:256
  v_or_b32 v10, 4, v3
  v_xor_b32 v10, v10, v9
  v_lshlrev_b32 v10, 4, v10
  v_lshl_add_u32 v10, v7, 9, v10
  ds_read_b128 v[228:231], v10 offset:0
  ds_read_b128 v[244:247], v10 offset:256
  v_or_b32 v10, 8, v3
  v_xor_b32 v10, v10, v9
  v_lshlrev_b32 v10, 4, v10
  v_lshl_add_u32 v10, v7, 9, v10
  ds_read_b128 v[232:235], v10 offset:0
  ds_read_b128 v[248:251], v10 offset:256
  v_or_b32 v10, 12, v3
  v_xor_b32 v10, v10, v9
  v_lshlrev_b32 v10, 4, v10
  v_lshl_add_u32 v10, v7, 9, v10
  ds_read_b128 v[236:239], v10 offset:0
  ds_read_b128 v[252:255], v10 offset:256
  s_waitcnt lgkmcnt(0)
  s_mul_i32 s30, s17, 401408
  s_mul_i32 s31, s18, 57344
  s_add_u32 s30, s30, s31
  s_add_u32 s30, s30, 43008
  v_add_u32 v15, s30, v2
  s_branch pw_pr_main
pw_pr_stB:
  s_mul_i32 s27, s17, 229376
  s_lshl_b32 s30, s18, 7
  s_add_u32 s27, s27, s30
  v_lshrrev_b32 v7, 3, v1
  v_and_b32 v8, 7, v1
  s_lshl_b32 s29, s16, 6
  v_add_u32 v7, s29, v7
  v_mul_u32_u24 v7, 896, v7
  v_lshl_add_u32 v7, v8, 4, v7
  s_lshl_b32 s30, s16, 13
  s_add_u32 m0, s30, 0
  s_add_u32 s31, s27, 0
  buffer_load_dwordx4 v7, s[56:59], s31 offen lds
  s_lshl_b32 s30, s16, 13
  s_add_u32 m0, s30, 1024
  s_add_u32 s31, s27, 7168
  buffer_load_dwordx4 v7, s[56:59], s31 offen lds
  s_lshl_b32 s30, s16, 13
  s_add_u32 m0, s30, 2048
  s_add_u32 s31, s27, 14336
  buffer_load_dwordx4 v7, s[56:59], s31 offen lds
  s_lshl_b32 s30, s16, 13
  s_add_u32 m0, s30, 3072
  s_add_u32 s31, s27, 21504
  buffer_load_dwordx4 v7, s[56:59], s31 offen lds
  s_lshl_b32 s30, s16, 13
  s_add_u32 m0, s30, 4096
  s_add_u32 s31, s27, 28672
  buffer_load_dwordx4 v7, s[56:59], s31 offen lds
  s_lshl_b32 s30, s16, 13
  s_add_u32 m0, s30, 5120
  s_add_u32 s31, s27, 35840
  buffer_load_dwordx4 v7, s[56:59], s31 offen lds
  s_lshl_b32 s30, s16, 13
  s_add_u32 m0, s30, 6144
  s_add_u32 s31, s27, 43008
  buffer_load_dwordx4 v7, s[56:59], s31 offen lds
  s_lshl_b32 s30, s16, 13
  s_add_u32 m0, s30, 7168
  s_add_u32 s31, s27, 50176
  buffer_load_dwordx4 v7, s[56:59], s31 offen lds
  s_waitcnt vmcnt(0)
  s_barrier
  s_min_u32 s27, s28, 13
  s_lshl_b32 s27, s27, 18
  s_add_u32 s27, s27, s26
  s_add_u32 m0, s25, 0
  s_nop 0
  buffer_load_dwordx4 v16, s[60:63], s27 offen lds
  s_add_u32 m0, s25, 1024
  s_nop 0
  buffer_load_dwordx4 v17, s[60:63], s27 offen lds
  s_add_u32 m0, s25, 2048
  s_nop 0
  buffer_load_dwordx4 v18, s[60:63], s27 offen lds
  s_add_u32 m0, s25, 3072
  s_nop 0
  buffer_load_dwordx4 v19, s[60:63], s27 offen lds
  s_add_u32 m0, s25, 4096
  s_nop 0
  buffer_load_dwordx4 v20, s[60:63], s27 offen lds
  s_add_u32 m0, s25, 5120
  s_nop 0
  buffer_load_dwordx4 v21, s[60:63], s27 offen lds
  s_add_u32 m0, s25, 6144
  s_nop 0
  buffer_load_dwordx4 v22, s[60:63], s27 offen lds
  s_add_u32 m0, s25, 7168
  s_nop 0
  buffer_load_dwordx4 v23, s[60:63], s27 offen lds
  s_add_u32 m0, s25, 8192
  s_nop 0
  buffer_load_dwordx4 v24, s[60:63], s27 offen lds
  s_add_u32 m0, s25, 9216
  s_nop 0
  buffer_load_dwordx4 v25, s[60:63], s27 offen lds
  s_add_u32 m0, s25, 10240
  s_nop 0
  buffer_load_dwordx4 v26, s[60:63], s27 offen lds
  s_add_u32 m0, s25, 11264
  s_nop 0
  buffer_load_dwordx4 v27, s[60:63], s27 offen lds
  s_add_u32 m0, s25, 12288
  s_nop 0
  buffer_load_dwordx4 v28, s[60:63], s27 offen lds
  s_add_u32 m0, s25, 13312
  s_nop 0
  buffer_load_dwordx4 v29, s[60:63], s27 offen lds
  s_add_u32 m0, s25, 14336
  s_nop 0
  buffer_load_dwordx4 v30, s[60:63], s27 offen lds
  s_add_u32 m0, s25, 15360
  s_nop 0
  buffer_load_dwordx4 v31, s[60:63], s27 offen lds
  s_add_u32 s29, s28, 4
  s_min_u32 s27, s29, 13
  s_lshl_b32 s27, s27, 18
  s_add_u32 s27, s27, s26
  s_add_u32 m0, s25, 16384
  s_nop 0
  buffer_load_dwordx4 v16, s[60:63], s27 offen lds
  s_add_u32 m0, s25, 17408
  s_nop 0
  buffer_load_dwordx4 v17, s[60:63], s27 offen lds
  s_add_u32 m0, s25, 18432
  s_nop 0
  buffer_load_dwordx4 v18, s[60:63], s27 offen lds
  s_add_u32 m0, s25, 19456
  s_nop 0
  buffer_load_dwordx4 v19, s[60:63], s27 offen lds
  s_add_u32 m0, s25, 20480
  s_nop 0
  buffer_load_dwordx4 v20, s[60:63], s27 offen lds
  s_add_u32 m0, s25, 21504
  s_nop 0
  buffer_load_dwordx4 v21, s[60:63], s27 offen lds
  s_add_u32 m0, s25, 22528
  s_nop 0
  buffer_load_dwordx4 v22, s[60:63], s27 offen lds
  s_add_u32 m0, s25, 23552
  s_nop 0
  buffer_load_dwordx4 v23, s[60:63], s27 offen lds
  s_add_u32 m0, s25, 24576
  s_nop 0
  buffer_load_dwordx4 v24, s[60:63], s27 offen lds
  s_add_u32 m0, s25, 25600
  s_nop 0
  buffer_load_dwordx4 v25, s[60:63], s27 offen lds
  s_add_u32 m0, s25, 26624
  s_nop 0
  buffer_load_dwordx4 v26, s[60:63], s27 offen lds
  s_add_u32 m0, s25, 27648
  s_nop 0
  buffer_load_dwordx4 v27, s[60:63], s27 offen lds
  s_add_u32 m0, s25, 28672
  s_nop 0
  buffer_load_dwordx4 v28, s[60:63], s27 offen lds
  s_add_u32 m0, s25, 29696
  s_nop 0
  buffer_load_dwordx4 v29, s[60:63], s27 offen lds
  s_add_u32 m0, s25, 30720
  s_nop 0
  buffer_load_dwordx4 v30, s[60:63], s27 offen lds
  s_add_u32 m0, s25, 31744
  s_nop 0
  buffer_load_dwordx4 v31, s[60:63], s27 offen lds
  v_lshrrev_b32 v7, 2, v4
  v_lshl_add_u32 v7, v3, 3, v7
  v_lshlrev_b32 v7, 7, v7
  v_and_b32 v8, 3, v4
  v_lshl_add_u32 v7, v8, 3, v7
  ds_read_b64_tr_b16 v[128:129], v7 offset:0
  ds_read_b64_tr_b16 v[130:131], v7 offset:512
  ds_read_b64_tr_b16 v[132:133], v7 offset:4096
  ds_read_b64_tr_b16 v[134:135], v7 offset:4608
  ds_read_b64_tr_b16 v[136:137], v7 offset:8192
  ds_read_b64_tr_b16 v[138:139], v7 offset:8704
  ds_read_b64_tr_b16 v[140:141], v7 offset:12288
  ds_read_b64_tr_b16 v[142:143], v7 offset:12800
  s_waitcnt lgkmcnt(0)
  ds_read_b64_tr_b16 v[144:145], v7 offset:16384
  ds_read_b64_tr_b16 v[146:147], v7 offset:16896
  ds_read_b64_tr_b16 v[148:149], v7 offset:20480
  ds_read_b64_tr_b16 v[150:151], v7 offset:20992
  ds_read_b64_tr_b16 v[152:153], v7 offset:24576
  ds_read_b64_tr_b16 v[154:155], v7 offset:25088
  ds_read_b64_tr_b16 v[156:157], v7 offset:28672
  ds_read_b64_tr_b16 v[158:159], v7 offset:29184
  s_waitcnt lgkmcnt(0)
  s_lshl_b32 s30, s18, 6
  s_add_u32 s30, s30, 0
  v_add_u32 v8, s30, v4
  v_lshrrev_b32 v9, 3, v8
  v_mul_u32_u24 v10, 37, v9
  v_lshrrev_b32 v10, 8, v10
  v_mul_u32_u24 v11, 7, v10
  v_sub_u32 v9, v9, v11
  v_bfe_u32 v11, v8, 1, 1
  v_bfe_u32 v32, v8, 2, 1
  v_and_b32 v33, 1, v8
  v_lshl_add_u32 v32, v32, 1, v33
  v_lshrrev_b32 v33, 2, v9
  v_and_b32 v34, 3, v9
  v_mov_b32 v35, 0
  v_cmp_eq_u32 vcc, 3, v9
  s_nop 1
  v_cndmask_b32 v33, v33, v11, vcc
  v_cndmask_b32 v11, v11, v35, vcc
  v_lshl_add_u32 v10, v10, 1, v33
  v_lshl_add_u32 v32, v34, 2, v32
  v_lshl_add_u32 v32, v11, 4, v32
  s_mul_i32 s30, s17, 28
  v_add_u32 v32, s30, v32
  v_lshrrev_b32 v33, 4, v32
  v_and_b32 v32, 15, v32
  s_mov_b32 s30, 401408
  v_mul_lo_u32 v10, v10, s30
  v_mul_u32_u24 v33, 14336, v33
  v_add_u32 v10, v10, v33
  v_lshl_add_u32 v10, v3, 8, v10
  v_lshl_add_u32 v10, v32, 4, v10
  v_add_u32 v12, 6422528, v10
  ds_read_b64_tr_b16 v[160:161], v7 offset:32
  ds_read_b64_tr_b16 v[162:163], v7 offset:544
  ds_read_b64_tr_b16 v[164:165], v7 offset:4128
  ds_read_b64_tr_b16 v[166:167], v7 offset:4640
  ds_read_b64_tr_b16 v[168:169], v7 offset:8224
  ds_read_b64_tr_b16 v[170:171], v7 offset:8736
  ds_read_b64_tr_b16 v[172:173], v7 offset:12320
  ds_read_b64_tr_b16 v[174:175], v7 offset:12832
  s_waitcnt lgkmcnt(0)
  ds_read_b64_tr_b16 v[176:177], v7 offset:16416
  ds_read_b64_tr_b16 v[178:179], v7 offset:16928
  ds_read_b64_tr_b16 v[180:181], v7 offset:20512
  ds_read_b64_tr_b16 v[182:183], v7 offset:21024
  ds_read_b64_tr_b16 v[184:185], v7 offset:24608
  ds_read_b64_tr_b16 v[186:187], v7 offset:25120
  ds_read_b64_tr_b16 v[188:189], v7 offset:28704
  ds_read_b64_tr_b16 v[190:191], v7 offset:29216
  s_waitcnt lgkmcnt(0)
  s_lshl_b32 s30, s18, 6
  s_add_u32 s30, s30, 16
  v_add_u32 v8, s30, v4
  v_lshrrev_b32 v9, 3, v8
  v_mul_u32_u24 v10, 37, v9
  v_lshrrev_b32 v10, 8, v10
  v_mul_u32_u24 v11, 7, v10
  v_sub_u32 v9, v9, v11
  v_bfe_u32 v11, v8, 1, 1
  v_bfe_u32 v32, v8, 2, 1
  v_and_b32 v33, 1, v8
  v_lshl_add_u32 v32, v32, 1, v33
  v_lshrrev_b32 v33, 2, v9
  v_and_b32 v34, 3, v9
  v_mov_b32 v35, 0
  v_cmp_eq_u32 vcc, 3, v9
  s_nop 1
  v_cndmask_b32 v33, v33, v11, vcc
  v_cndmask_b32 v11, v11, v35, vcc
  v_lshl_add_u32 v10, v10, 1, v33
  v_lshl_add_u32 v32, v34, 2, v32
  v_lshl_add_u32 v32, v11, 4, v32
  s_mul_i32 s30, s17, 28
  v_add_u32 v32, s30, v32
  v_lshrrev_b32 v33, 4, v32
  v_and_b32 v32, 15, v32
  s_mov_b32 s30, 401408
  v_mul_lo_u32 v10, v10, s30
  v_mul_u32_u24 v33, 14336, v33
  v_add_u32 v10, v10, v33
  v_lshl_add_u32 v10, v3, 8, v10
  v_lshl_add_u32 v10, v32, 4, v10
  v_add_u32 v13, 6422528, v10
  ds_read_b64_tr_b16 v[192:193], v7 offset:64
  ds_read_b64_tr_b16 v[194:195], v7 offset:576
  ds_read_b64_tr_b16 v[196:197], v7 offset:4160
  ds_read_b64_tr_b16 v[198:199], v7 offset:4672
  ds_read_b64_tr_b16 v[200:201], v7 offset:8256
  ds_read_b64_tr_b16 v[202:203], v7 offset:8768
  ds_read_b64_tr_b16 v[204:205], v7 offset:12352
  ds_read_b64_tr_b16 v[206:207], v7 offset:12864
  s_waitcnt lgkmcnt(0)
  ds_read_b64_tr_b16 v[208:209], v7 offset:16448
  ds_read_b64_tr_b16 v[210:211], v7 offset:16960
  ds_read_b64_tr_b16 v[212:213], v7 offset:20544
  ds_read_b64_tr_b16 v[214:215], v7 offset:21056
  ds_read_b64_tr_b16 v[216:217], v7 offset:24640
  ds_read_b64_tr_b16 v[218:219], v7 offset:25152
  ds_read_b64_tr_b16 v[220:221], v7 offset:28736
  ds_read_b64_tr_b16 v[222:223], v7 offset:29248
  s_waitcnt lgkmcnt(0)
  s_lshl_b32 s30, s18, 6
  s_add_u32 s30, s30, 32
  v_add_u32 v8, s30, v4
  v_lshrrev_b32 v9, 3, v8
  v_mul_u32_u24 v10, 37, v9
  v_lshrrev_b32 v10, 8, v10
  v_mul_u32_u24 v11, 7, v10
  v_sub_u32 v9, v9, v11
  v_bfe_u32 v11, v8, 1, 1
  v_bfe_u32 v32, v8, 2, 1
  v_and_b32 v33, 1, v8
  v_lshl_add_u32 v32, v32, 1, v33
  v_lshrrev_b32 v33, 2, v9
  v_and_b32 v34, 3, v9
  v_mov_b32 v35, 0
  v_cmp_eq_u32 vcc, 3, v9
  s_nop 1
  v_cndmask_b32 v33, v33, v11, vcc
  v_cndmask_b32 v11, v11, v35, vcc
  v_lshl_add_u32 v10, v10, 1, v33
  v_lshl_add_u32 v32, v34, 2, v32
  v_lshl_add_u32 v32, v11, 4, v32
  s_mul_i32 s30, s17, 28
  v_add_u32 v32, s30, v32
  v_lshrrev_b32 v33, 4, v32
  v_and_b32 v32, 15, v32
  s_mov_b32 s30, 401408
  v_mul_lo_u32 v10, v10, s30
  v_mul_u32_u24 v33, 14336, v33
  v_add_u32 v10, v10, v33
  v_lshl_add_u32 v10, v3, 8, v10
  v_lshl_add_u32 v10, v32, 4, v10
  v_add_u32 v14, 6422528, v10
  ds_read_b64_tr_b16 v[224:225], v7 offset:96
  ds_read_b64_tr_b16 v[226:227], v7 offset:608
  ds_read_b64_tr_b16 v[228:229], v7 offset:4192
  ds_read_b64_tr_b16 v[230:231], v7 offset:4704
  ds_read_b64_tr_b16 v[232:233], v7 offset:8288
  ds_read_b64_tr_b16 v[234:235], v7 offset:8800
  ds_read_b64_tr_b16 v[236:237], v7 offset:12384
  ds_read_b64_tr_b16 v[238:239], v7 offset:12896
  s_waitcnt lgkmcnt(0)
  ds_read_b64_tr_b16 v[240:241], v7 offset:16480
  ds_read_b64_tr_b16 v[242:243], v7 offset:16992
  ds_read_b64_tr_b16 v[244:245], v7 offset:20576
  ds_read_b64_tr_b16 v[246:247], v7 offset:21088
  ds_read_b64_tr_b16 v[248:249], v7 offset:24672
  ds_read_b64_tr_b16 v[250:251], v7 offset:25184
  ds_read_b64_tr_b16 v[252:253], v7 offset:28768
  ds_read_b64_tr_b16 v[254:255], v7 offset:29280
  s_waitcnt lgkmcnt(0)
  s_lshl_b32 s30, s18, 6
  s_add_u32 s30, s30, 48
  v_add_u32 v8, s30, v4
  v_lshrrev_b32 v9, 3, v8
  v_mul_u32_u24 v10, 37, v9
  v_lshrrev_b32 v10, 8, v10
  v_mul_u32_u24 v11, 7, v10
  v_sub_u32 v9, v9, v11
  v_bfe_u32 v11, v8, 1, 1
  v_bfe_u32 v32, v8, 2, 1
  v_and_b32 v33, 1, v8
  v_lshl_add_u32 v32, v32, 1, v33
  v_lshrrev_b32 v33, 2, v9
  v_and_b32 v34, 3, v9
  v_mov_b32 v35, 0
  v_cmp_eq_u32 vcc, 3, v9
  s_nop 1
  v_cndmask_b32 v33, v33, v11, vcc
  v_cndmask_b32 v11, v11, v35, vcc
  v_lshl_add_u32 v10, v10, 1, v33
  v_lshl_add_u32 v32, v34, 2, v32
  v_lshl_add_u32 v32, v11, 4, v32
  s_mul_i32 s30, s17, 28
  v_add_u32 v32, s30, v32
  v_lshrrev_b32 v33, 4, v32
  v_and_b32 v32, 15, v32
  s_mov_b32 s30, 401408
  v_mul_lo_u32 v10, v10, s30
  v_mul_u32_u24 v33, 14336, v33
  v_add_u32 v10, v10, v33
  v_lshl_add_u32 v10, v3, 8, v10
  v_lshl_add_u32 v10, v32, 4, v10
  v_add_u32 v15, 6422528, v10
pw_pr_main:
  v_lshrrev_b32 v7, 2, v4
  v_lshlrev_b32 v7, 3, v7
  v_and_b32 v8, 3, v4
  v_add_u32 v7, v7, v8
  v_or_b32 v10, 0, v3
  v_xor_b32 v10, v10, v4
  v_lshlrev_b32 v10, 4, v10
  v_lshl_add_u32 v10, v7, 9, v10
  v_add_u32 v32, s25, v10
  v_or_b32 v10, 4, v3
  v_xor_b32 v10, v10, v4
  v_lshlrev_b32 v10, 4, v10
  v_lshl_add_u32 v10, v7, 9, v10
  v_add_u32 v33, s25, v10
  v_or_b32 v10, 8, v3
  v_xor_b32 v10, v10, v4
  v_lshlrev_b32 v10, 4, v10
  v_lshl_add_u32 v10, v7, 9, v10
  v_add_u32 v34, s25, v10
  v_or_b32 v10, 12, v3
  v_xor_b32 v10, v10, v4
  v_lshlrev_b32 v10, 4, v10
  v_lshl_add_u32 v10, v7, 9, v10
  v_add_u32 v35, s25, v10
  s_waitcnt vmcnt(16) lgkmcnt(0)
  ds_read_b128 v[36:39], v32 offset:0
  ds_read_b128 v[40:43], v33 offset:0
  ds_read_b128 v[44:47], v34 offset:0
  ds_read_b128 v[48:51], v35 offset:0
  ds_read_b128 v[52:55], v32 offset:256
  ds_read_b128 v[56:59], v33 offset:256
  ds_read_b128 v[60:63], v34 offset:256
  ds_read_b128 v[64:67], v35 offset:256
  s_waitcnt lgkmcnt(7)
  v_mfma_f32_16x16x32_bf16 v[96:99], v[36:39], v[128:131], 0
  v_mfma_f32_16x16x32_bf16 v[100:103], v[36:39], v[160:163], 0
  v_mfma_f32_16x16x32_bf16 v[104:107], v[36:39], v[192:195], 0
  v_mfma_f32_16x16x32_bf16 v[108:111], v[36:39], v[224:227], 0
  s_waitcnt lgkmcnt(6)
  v_mfma_f32_16x16x32_bf16 v[96:99], v[40:43], v[132:135], v[96:99]
  v_mfma_f32_16x16x32_bf16 v[100:103], v[40:43], v[164:167], v[100:103]
  v_mfma_f32_16x16x32_bf16 v[104:107], v[40:43], v[196:199], v[104:107]
  v_mfma_f32_16x16x32_bf16 v[108:111], v[40:43], v[228:231], v[108:111]
  s_waitcnt lgkmcnt(5)
  v_mfma_f32_16x16x32_bf16 v[96:99], v[44:47], v[136:139], v[96:99]
  v_mfma_f32_16x16x32_bf16 v[100:103], v[44:47], v[168:171], v[100:103]
  v_mfma_f32_16x16x32_bf16 v[104:107], v[44:47], v[200:203], v[104:107]
  v_mfma_f32_16x16x32_bf16 v[108:111], v[44:47], v[232:235], v[108:111]
  s_waitcnt lgkmcnt(4)
  v_mfma_f32_16x16x32_bf16 v[96:99], v[48:51], v[140:143], v[96:99]
  v_mfma_f32_16x16x32_bf16 v[100:103], v[48:51], v[172:175], v[100:103]
  v_mfma_f32_16x16x32_bf16 v[104:107], v[48:51], v[204:207], v[104:107]
  v_mfma_f32_16x16x32_bf16 v[108:111], v[48:51], v[236:239], v[108:111]
  s_waitcnt lgkmcnt(3)
  v_mfma_f32_16x16x32_bf16 v[96:99], v[52:55], v[144:147], v[96:99]
  v_mfma_f32_16x16x32_bf16 v[100:103], v[52:55], v[176:179], v[100:103]
  v_mfma_f32_16x16x32_bf16 v[104:107], v[52:55], v[208:211], v[104:107]
  v_mfma_f32_16x16x32_bf16 v[108:111], v[52:55], v[240:243], v[108:111]
  s_waitcnt lgkmcnt(2)
  v_mfma_f32_16x16x32_bf16 v[96:99], v[56:59], v[148:151], v[96:99]
  v_mfma_f32_16x16x32_bf16 v[100:103], v[56:59], v[180:183], v[100:103]
  v_mfma_f32_16x16x32_bf16 v[104:107], v[56:59], v[212:215], v[104:107]
  v_mfma_f32_16x16x32_bf16 v[108:111], v[56:59], v[244:247], v[108:111]
  s_waitcnt lgkmcnt(1)
  v_mfma_f32_16x16x32_bf16 v[96:99], v[60:63], v[152:155], v[96:99]
  v_mfma_f32_16x16x32_bf16 v[100:103], v[60:63], v[184:187], v[100:103]
  v_mfma_f32_16x16x32_bf16 v[104:107], v[60:63], v[216:219], v[104:107]
  v_mfma_f32_16x16x32_bf16 v[108:111], v[60:63], v[248:251], v[108:111]
  s_waitcnt lgkmcnt(0)
  v_mfma_f32_16x16x32_bf16 v[96:99], v[64:67], v[156:159], v[96:99]
  v_mfma_f32_16x16x32_bf16 v[100:103], v[64:67], v[188:191], v[100:103]
  v_mfma_f32_16x16x32_bf16 v[104:107], v[64:67], v[220:223], v[104:107]
  v_mfma_f32_16x16x32_bf16 v[108:111], v[64:67], v[252:255], v[108:111]
  ds_read_b128 v[36:39], v32 offset:2048
  ds_read_b128 v[40:43], v33 offset:2048
  ds_read_b128 v[44:47], v34 offset:2048
  ds_read_b128 v[48:51], v35 offset:2048
  ds_read_b128 v[52:55], v32 offset:2304
  ds_read_b128 v[56:59], v33 offset:2304
  ds_read_b128 v[60:63], v34 offset:2304
  ds_read_b128 v[64:67], v35 offset:2304
  s_waitcnt lgkmcnt(7)
  v_mfma_f32_16x16x32_bf16 v[112:115], v[36:39], v[128:131], 0
  v_mfma_f32_16x16x32_bf16 v[116:119], v[36:39], v[160:163], 0
  v_mfma_f32_16x16x32_bf16 v[120:123], v[36:39], v[192:195], 0
  v_mfma_f32_16x16x32_bf16 v[124:127], v[36:39], v[224:227], 0
  s_waitcnt lgkmcnt(6)
  v_mfma_f32_16x16x32_bf16 v[112:115], v[40:43], v[132:135], v[112:115]
  v_mfma_f32_16x16x32_bf16 v[116:119], v[40:43], v[164:167], v[116:119]
  v_mfma_f32_16x16x32_bf16 v[120:123], v[40:43], v[196:199], v[120:123]
  v_mfma_f32_16x16x32_bf16 v[124:127], v[40:43], v[228:231], v[124:127]
  s_waitcnt lgkmcnt(5)
  v_mfma_f32_16x16x32_bf16 v[112:115], v[44:47], v[136:139], v[112:115]
  v_mfma_f32_16x16x32_bf16 v[116:119], v[44:47], v[168:171], v[116:119]
  v_mfma_f32_16x16x32_bf16 v[120:123], v[44:47], v[200:203], v[120:123]
  v_mfma_f32_16x16x32_bf16 v[124:127], v[44:47], v[232:235], v[124:127]
  s_waitcnt lgkmcnt(4)
  v_mfma_f32_16x16x32_bf16 v[112:115], v[48:51], v[140:143], v[112:115]
  v_mfma_f32_16x16x32_bf16 v[116:119], v[48:51], v[172:175], v[116:119]
  v_mfma_f32_16x16x32_bf16 v[120:123], v[48:51], v[204:207], v[120:123]
  v_mfma_f32_16x16x32_bf16 v[124:127], v[48:51], v[236:239], v[124:127]
  s_waitcnt lgkmcnt(3)
  v_mfma_f32_16x16x32_bf16 v[112:115], v[52:55], v[144:147], v[112:115]
  v_mfma_f32_16x16x32_bf16 v[116:119], v[52:55], v[176:179], v[116:119]
  v_mfma_f32_16x16x32_bf16 v[120:123], v[52:55], v[208:211], v[120:123]
  v_mfma_f32_16x16x32_bf16 v[124:127], v[52:55], v[240:243], v[124:127]
  s_waitcnt lgkmcnt(2)
  v_mfma_f32_16x16x32_bf16 v[112:115], v[56:59], v[148:151], v[112:115]
  v_mfma_f32_16x16x32_bf16 v[116:119], v[56:59], v[180:183], v[116:119]
  v_mfma_f32_16x16x32_bf16 v[120:123], v[56:59], v[212:215], v[120:123]
  v_mfma_f32_16x16x32_bf16 v[124:127], v[56:59], v[244:247], v[124:127]
  s_waitcnt lgkmcnt(1)
  v_mfma_f32_16x16x32_bf16 v[112:115], v[60:63], v[152:155], v[112:115]
  v_mfma_f32_16x16x32_bf16 v[116:119], v[60:63], v[184:187], v[116:119]
  v_mfma_f32_16x16x32_bf16 v[120:123], v[60:63], v[216:219], v[120:123]
  v_mfma_f32_16x16x32_bf16 v[124:127], v[60:63], v[248:251], v[124:127]
  s_waitcnt lgkmcnt(0)
  s_add_u32 s29, s28, 8
  s_min_u32 s27, s29, 13
  s_lshl_b32 s27, s27, 18
  s_add_u32 s27, s27, s26
  s_add_u32 m0, s25, 0
  s_nop 0
  buffer_load_dwordx4 v16, s[60:63], s27 offen lds
  s_add_u32 m0, s25, 1024
  s_nop 0
  buffer_load_dwordx4 v17, s[60:63], s27 offen lds
  s_add_u32 m0, s25, 2048
  s_nop 0
  buffer_load_dwordx4 v18, s[60:63], s27 offen lds
  s_add_u32 m0, s25, 3072
  s_nop 0
  buffer_load_dwordx4 v19, s[60:63], s27 offen lds
  s_add_u32 m0, s25, 4096
  s_nop 0
  buffer_load_dwordx4 v20, s[60:63], s27 offen lds
  s_add_u32 m0, s25, 5120
  s_nop 0
  buffer_load_dwordx4 v21, s[60:63], s27 offen lds
  s_add_u32 m0, s25, 6144
  s_nop 0
  buffer_load_dwordx4 v22, s[60:63], s27 offen lds
  s_add_u32 m0, s25, 7168
  s_nop 0
  buffer_load_dwordx4 v23, s[60:63], s27 offen lds
  s_add_u32 m0, s25, 8192
  s_nop 0
  buffer_load_dwordx4 v24, s[60:63], s27 offen lds
  s_add_u32 m0, s25, 9216
  s_nop 0
  buffer_load_dwordx4 v25, s[60:63], s27 offen lds
  s_add_u32 m0, s25, 10240
  s_nop 0
  buffer_load_dwordx4 v26, s[60:63], s27 offen lds
  s_add_u32 m0, s25, 11264
  s_nop 0
  buffer_load_dwordx4 v27, s[60:63], s27 offen lds
  s_add_u32 m0, s25, 12288
  s_nop 0
  buffer_load_dwordx4 v28, s[60:63], s27 offen lds
  s_add_u32 m0, s25, 13312
  s_nop 0
  buffer_load_dwordx4 v29, s[60:63], s27 offen lds
  s_add_u32 m0, s25, 14336
  s_nop 0
  buffer_load_dwordx4 v30, s[60:63], s27 offen lds
  s_add_u32 m0, s25, 15360
  s_nop 0
  buffer_load_dwordx4 v31, s[60:63], s27 offen lds
  v_mfma_f32_16x16x32_bf16 v[112:115], v[64:67], v[156:159], v[112:115]
  v_mfma_f32_16x16x32_bf16 v[116:119], v[64:67], v[188:191], v[116:119]
  v_mfma_f32_16x16x32_bf16 v[120:123], v[64:67], v[220:223], v[120:123]
  v_mfma_f32_16x16x32_bf16 v[124:127], v[64:67], v[252:255], v[124:127]
  s_lshl_b32 s30, s28, 10
  v_mul_f32 v96, s24, v96
  v_mul_f32 v97, s24, v97
  v_mul_f32 v98, s24, v98
  v_mul_f32 v99, s24, v99
  v_cvt_pk_bf16_f32 v68, v96, v97
  v_cvt_pk_bf16_f32 v69, v98, v99
  v_mul_f32 v112, s24, v112
  v_mul_f32 v113, s24, v113
  v_mul_f32 v114, s24, v114
  v_mul_f32 v115, s24, v115
  v_cvt_pk_bf16_f32 v70, v112, v113
  v_cvt_pk_bf16_f32 v71, v114, v115
  buffer_store_dwordx4 v[68:71], v12, s[8:11], s30 offen
  v_mul_f32 v100, s24, v100
  v_mul_f32 v101, s24, v101
  v_mul_f32 v102, s24, v102
  v_mul_f32 v103, s24, v103
  v_cvt_pk_bf16_f32 v72, v100, v101
  v_cvt_pk_bf16_f32 v73, v102, v103
  v_mul_f32 v116, s24, v116
  v_mul_f32 v117, s24, v117
  v_mul_f32 v118, s24, v118
  v_mul_f32 v119, s24, v119
  v_cvt_pk_bf16_f32 v74, v116, v117
  v_cvt_pk_bf16_f32 v75, v118, v119
  buffer_store_dwordx4 v[72:75], v13, s[8:11], s30 offen
  v_mul_f32 v104, s24, v104
  v_mul_f32 v105, s24, v105
  v_mul_f32 v106, s24, v106
  v_mul_f32 v107, s24, v107
  v_cvt_pk_bf16_f32 v76, v104, v105
  v_cvt_pk_bf16_f32 v77, v106, v107
  v_mul_f32 v120, s24, v120
  v_mul_f32 v121, s24, v121
  v_mul_f32 v122, s24, v122
  v_mul_f32 v123, s24, v123
  v_cvt_pk_bf16_f32 v78, v120, v121
  v_cvt_pk_bf16_f32 v79, v122, v123
  buffer_store_dwordx4 v[76:79], v14, s[8:11], s30 offen
  v_mul_f32 v108, s24, v108
  v_mul_f32 v109, s24, v109
  v_mul_f32 v110, s24, v110
  v_mul_f32 v111, s24, v111
  v_cvt_pk_bf16_f32 v80, v108, v109
  v_cvt_pk_bf16_f32 v81, v110, v111
  v_mul_f32 v124, s24, v124
  v_mul_f32 v125, s24, v125
  v_mul_f32 v126, s24, v126
  v_mul_f32 v127, s24, v127
  v_cvt_pk_bf16_f32 v82, v124, v125
  v_cvt_pk_bf16_f32 v83, v126, v127
  buffer_store_dwordx4 v[80:83], v15, s[8:11], s30 offen
  s_add_u32 s28, s28, 4
  s_waitcnt vmcnt(20) lgkmcnt(0)
  ds_read_b128 v[36:39], v32 offset:16384
  ds_read_b128 v[40:43], v33 offset:16384
  ds_read_b128 v[44:47], v34 offset:16384
  ds_read_b128 v[48:51], v35 offset:16384
  ds_read_b128 v[52:55], v32 offset:16640
  ds_read_b128 v[56:59], v33 offset:16640
  ds_read_b128 v[60:63], v34 offset:16640
  ds_read_b128 v[64:67], v35 offset:16640
  s_waitcnt lgkmcnt(7)
  v_mfma_f32_16x16x32_bf16 v[96:99], v[36:39], v[128:131], 0
  v_mfma_f32_16x16x32_bf16 v[100:103], v[36:39], v[160:163], 0
  v_mfma_f32_16x16x32_bf16 v[104:107], v[36:39], v[192:195], 0
  v_mfma_f32_16x16x32_bf16 v[108:111], v[36:39], v[224:227], 0
  s_waitcnt lgkmcnt(6)
  v_mfma_f32_16x16x32_bf16 v[96:99], v[40:43], v[132:135], v[96:99]
  v_mfma_f32_16x16x32_bf16 v[100:103], v[40:43], v[164:167], v[100:103]
  v_mfma_f32_16x16x32_bf16 v[104:107], v[40:43], v[196:199], v[104:107]
  v_mfma_f32_16x16x32_bf16 v[108:111], v[40:43], v[228:231], v[108:111]
  s_waitcnt lgkmcnt(5)
  v_mfma_f32_16x16x32_bf16 v[96:99], v[44:47], v[136:139], v[96:99]
  v_mfma_f32_16x16x32_bf16 v[100:103], v[44:47], v[168:171], v[100:103]
  v_mfma_f32_16x16x32_bf16 v[104:107], v[44:47], v[200:203], v[104:107]
  v_mfma_f32_16x16x32_bf16 v[108:111], v[44:47], v[232:235], v[108:111]
  s_waitcnt lgkmcnt(4)
  v_mfma_f32_16x16x32_bf16 v[96:99], v[48:51], v[140:143], v[96:99]
  v_mfma_f32_16x16x32_bf16 v[100:103], v[48:51], v[172:175], v[100:103]
  v_mfma_f32_16x16x32_bf16 v[104:107], v[48:51], v[204:207], v[104:107]
  v_mfma_f32_16x16x32_bf16 v[108:111], v[48:51], v[236:239], v[108:111]
  s_waitcnt lgkmcnt(3)
  v_mfma_f32_16x16x32_bf16 v[96:99], v[52:55], v[144:147], v[96:99]
  v_mfma_f32_16x16x32_bf16 v[100:103], v[52:55], v[176:179], v[100:103]
  v_mfma_f32_16x16x32_bf16 v[104:107], v[52:55], v[208:211], v[104:107]
  v_mfma_f32_16x16x32_bf16 v[108:111], v[52:55], v[240:243], v[108:111]
  s_waitcnt lgkmcnt(2)
  v_mfma_f32_16x16x32_bf16 v[96:99], v[56:59], v[148:151], v[96:99]
  v_mfma_f32_16x16x32_bf16 v[100:103], v[56:59], v[180:183], v[100:103]
  v_mfma_f32_16x16x32_bf16 v[104:107], v[56:59], v[212:215], v[104:107]
  v_mfma_f32_16x16x32_bf16 v[108:111], v[56:59], v[244:247], v[108:111]
  s_waitcnt lgkmcnt(1)
  v_mfma_f32_16x16x32_bf16 v[96:99], v[60:63], v[152:155], v[96:99]
  v_mfma_f32_16x16x32_bf16 v[100:103], v[60:63], v[184:187], v[100:103]
  v_mfma_f32_16x16x32_bf16 v[104:107], v[60:63], v[216:219], v[104:107]
  v_mfma_f32_16x16x32_bf16 v[108:111], v[60:63], v[248:251], v[108:111]
  s_waitcnt lgkmcnt(0)
  v_mfma_f32_16x16x32_bf16 v[96:99], v[64:67], v[156:159], v[96:99]
  v_mfma_f32_16x16x32_bf16 v[100:103], v[64:67], v[188:191], v[100:103]
  v_mfma_f32_16x16x32_bf16 v[104:107], v[64:67], v[220:223], v[104:107]
  v_mfma_f32_16x16x32_bf16 v[108:111], v[64:67], v[252:255], v[108:111]
  ds_read_b128 v[36:39], v32 offset:18432
  ds_read_b128 v[40:43], v33 offset:18432
  ds_read_b128 v[44:47], v34 offset:18432
  ds_read_b128 v[48:51], v35 offset:18432
  ds_read_b128 v[52:55], v32 offset:18688
  ds_read_b128 v[56:59], v33 offset:18688
  ds_read_b128 v[60:63], v34 offset:18688
  ds_read_b128 v[64:67], v35 offset:18688
  s_waitcnt lgkmcnt(7)
  v_mfma_f32_16x16x32_bf16 v[112:115], v[36:39], v[128:131], 0
  v_mfma_f32_16x16x32_bf16 v[116:119], v[36:39], v[160:163], 0
  v_mfma_f32_16x16x32_bf16 v[120:123], v[36:39], v[192:195], 0
  v_mfma_f32_16x16x32_bf16 v[124:127], v[36:39], v[224:227], 0
  s_waitcnt lgkmcnt(6)
  v_mfma_f32_16x16x32_bf16 v[112:115], v[40:43], v[132:135], v[112:115]
  v_mfma_f32_16x16x32_bf16 v[116:119], v[40:43], v[164:167], v[116:119]
  v_mfma_f32_16x16x32_bf16 v[120:123], v[40:43], v[196:199], v[120:123]
  v_mfma_f32_16x16x32_bf16 v[124:127], v[40:43], v[228:231], v[124:127]
  s_waitcnt lgkmcnt(5)
  v_mfma_f32_16x16x32_bf16 v[112:115], v[44:47], v[136:139], v[112:115]
  v_mfma_f32_16x16x32_bf16 v[116:119], v[44:47], v[168:171], v[116:119]
  v_mfma_f32_16x16x32_bf16 v[120:123], v[44:47], v[200:203], v[120:123]
  v_mfma_f32_16x16x32_bf16 v[124:127], v[44:47], v[232:235], v[124:127]
  s_waitcnt lgkmcnt(4)
  v_mfma_f32_16x16x32_bf16 v[112:115], v[48:51], v[140:143], v[112:115]
  v_mfma_f32_16x16x32_bf16 v[116:119], v[48:51], v[172:175], v[116:119]
  v_mfma_f32_16x16x32_bf16 v[120:123], v[48:51], v[204:207], v[120:123]
  v_mfma_f32_16x16x32_bf16 v[124:127], v[48:51], v[236:239], v[124:127]
  s_waitcnt lgkmcnt(3)
  v_mfma_f32_16x16x32_bf16 v[112:115], v[52:55], v[144:147], v[112:115]
  v_mfma_f32_16x16x32_bf16 v[116:119], v[52:55], v[176:179], v[116:119]
  v_mfma_f32_16x16x32_bf16 v[120:123], v[52:55], v[208:211], v[120:123]
  v_mfma_f32_16x16x32_bf16 v[124:127], v[52:55], v[240:243], v[124:127]
  s_waitcnt lgkmcnt(2)
  v_mfma_f32_16x16x32_bf16 v[112:115], v[56:59], v[148:151], v[112:115]
  v_mfma_f32_16x16x32_bf16 v[116:119], v[56:59], v[180:183], v[116:119]
  v_mfma_f32_16x16x32_bf16 v[120:123], v[56:59], v[212:215], v[120:123]
  v_mfma_f32_16x16x32_bf16 v[124:127], v[56:59], v[244:247], v[124:127]
  s_waitcnt lgkmcnt(1)
  v_mfma_f32_16x16x32_bf16 v[112:115], v[60:63], v[152:155], v[112:115]
  v_mfma_f32_16x16x32_bf16 v[116:119], v[60:63], v[184:187], v[116:119]
  v_mfma_f32_16x16x32_bf16 v[120:123], v[60:63], v[216:219], v[120:123]
  v_mfma_f32_16x16x32_bf16 v[124:127], v[60:63], v[248:251], v[124:127]
  s_waitcnt lgkmcnt(0)
  s_add_u32 s29, s28, 8
  s_min_u32 s27, s29, 13
  s_lshl_b32 s27, s27, 18
  s_add_u32 s27, s27, s26
  s_add_u32 m0, s25, 16384
  s_nop 0
  buffer_load_dwordx4 v16, s[60:63], s27 offen lds
  s_add_u32 m0, s25, 17408
  s_nop 0
  buffer_load_dwordx4 v17, s[60:63], s27 offen lds
  s_add_u32 m0, s25, 18432
  s_nop 0
  buffer_load_dwordx4 v18, s[60:63], s27 offen lds
  s_add_u32 m0, s25, 19456
  s_nop 0
  buffer_load_dwordx4 v19, s[60:63], s27 offen lds
  s_add_u32 m0, s25, 20480
  s_nop 0
  buffer_load_dwordx4 v20, s[60:63], s27 offen lds
  s_add_u32 m0, s25, 21504
  s_nop 0
  buffer_load_dwordx4 v21, s[60:63], s27 offen lds
  s_add_u32 m0, s25, 22528
  s_nop 0
  buffer_load_dwordx4 v22, s[60:63], s27 offen lds
  s_add_u32 m0, s25, 23552
  s_nop 0
  buffer_load_dwordx4 v23, s[60:63], s27 offen lds
  s_add_u32 m0, s25, 24576
  s_nop 0
  buffer_load_dwordx4 v24, s[60:63], s27 offen lds
  s_add_u32 m0, s25, 25600
  s_nop 0
  buffer_load_dwordx4 v25, s[60:63], s27 offen lds
  s_add_u32 m0, s25, 26624
  s_nop 0
  buffer_load_dwordx4 v26, s[60:63], s27 offen lds
  s_add_u32 m0, s25, 27648
  s_nop 0
  buffer_load_dwordx4 v27, s[60:63], s27 offen lds
  s_add_u32 m0, s25, 28672
  s_nop 0
  buffer_load_dwordx4 v28, s[60:63], s27 offen lds
  s_add_u32 m0, s25, 29696
  s_nop 0
  buffer_load_dwordx4 v29, s[60:63], s27 offen lds
  s_add_u32 m0, s25, 30720
  s_nop 0
  buffer_load_dwordx4 v30, s[60:63], s27 offen lds
  s_add_u32 m0, s25, 31744
  s_nop 0
  buffer_load_dwordx4 v31, s[60:63], s27 offen lds
  v_mfma_f32_16x16x32_bf16 v[112:115], v[64:67], v[156:159], v[112:115]
  v_mfma_f32_16x16x32_bf16 v[116:119], v[64:67], v[188:191], v[116:119]
  v_mfma_f32_16x16x32_bf16 v[120:123], v[64:67], v[220:223], v[120:123]
  v_mfma_f32_16x16x32_bf16 v[124:127], v[64:67], v[252:255], v[124:127]
  s_lshl_b32 s30, s28, 10
  v_mul_f32 v96, s24, v96
  v_mul_f32 v97, s24, v97
  v_mul_f32 v98, s24, v98
  v_mul_f32 v99, s24, v99
  v_cvt_pk_bf16_f32 v68, v96, v97
  v_cvt_pk_bf16_f32 v69, v98, v99
  v_mul_f32 v112, s24, v112
  v_mul_f32 v113, s24, v113
  v_mul_f32 v114, s24, v114
  v_mul_f32 v115, s24, v115
  v_cvt_pk_bf16_f32 v70, v112, v113
  v_cvt_pk_bf16_f32 v71, v114, v115
  buffer_store_dwordx4 v[68:71], v12, s[8:11], s30 offen
  v_mul_f32 v100, s24, v100
  v_mul_f32 v101, s24, v101
  v_mul_f32 v102, s24, v102
  v_mul_f32 v103, s24, v103
  v_cvt_pk_bf16_f32 v72, v100, v101
  v_cvt_pk_bf16_f32 v73, v102, v103
  v_mul_f32 v116, s24, v116
  v_mul_f32 v117, s24, v117
  v_mul_f32 v118, s24, v118
  v_mul_f32 v119, s24, v119
  v_cvt_pk_bf16_f32 v74, v116, v117
  v_cvt_pk_bf16_f32 v75, v118, v119
  buffer_store_dwordx4 v[72:75], v13, s[8:11], s30 offen
  v_mul_f32 v104, s24, v104
  v_mul_f32 v105, s24, v105
  v_mul_f32 v106, s24, v106
  v_mul_f32 v107, s24, v107
  v_cvt_pk_bf16_f32 v76, v104, v105
  v_cvt_pk_bf16_f32 v77, v106, v107
  v_mul_f32 v120, s24, v120
  v_mul_f32 v121, s24, v121
  v_mul_f32 v122, s24, v122
  v_mul_f32 v123, s24, v123
  v_cvt_pk_bf16_f32 v78, v120, v121
  v_cvt_pk_bf16_f32 v79, v122, v123
  buffer_store_dwordx4 v[76:79], v14, s[8:11], s30 offen
  v_mul_f32 v108, s24, v108
  v_mul_f32 v109, s24, v109
  v_mul_f32 v110, s24, v110
  v_mul_f32 v111, s24, v111
  v_cvt_pk_bf16_f32 v80, v108, v109
  v_cvt_pk_bf16_f32 v81, v110, v111
  v_mul_f32 v124, s24, v124
  v_mul_f32 v125, s24, v125
  v_mul_f32 v126, s24, v126
  v_mul_f32 v127, s24, v127
  v_cvt_pk_bf16_f32 v82, v124, v125
  v_cvt_pk_bf16_f32 v83, v126, v127
  buffer_store_dwordx4 v[80:83], v15, s[8:11], s30 offen
  s_add_u32 s28, s28, 4
  s_waitcnt vmcnt(24) lgkmcnt(0)
  ds_read_b128 v[36:39], v32 offset:0
  ds_read_b128 v[40:43], v33 offset:0
  ds_read_b128 v[44:47], v34 offset:0
  ds_read_b128 v[48:51], v35 offset:0
  ds_read_b128 v[52:55], v32 offset:256
  ds_read_b128 v[56:59], v33 offset:256
  ds_read_b128 v[60:63], v34 offset:256
  ds_read_b128 v[64:67], v35 offset:256
  s_waitcnt lgkmcnt(7)
  v_mfma_f32_16x16x32_bf16 v[96:99], v[36:39], v[128:131], 0
  v_mfma_f32_16x16x32_bf16 v[100:103], v[36:39], v[160:163], 0
  v_mfma_f32_16x16x32_bf16 v[104:107], v[36:39], v[192:195], 0
  v_mfma_f32_16x16x32_bf16 v[108:111], v[36:39], v[224:227], 0
  s_waitcnt lgkmcnt(6)
  v_mfma_f32_16x16x32_bf16 v[96:99], v[40:43], v[132:135], v[96:99]
  v_mfma_f32_16x16x32_bf16 v[100:103], v[40:43], v[164:167], v[100:103]
  v_mfma_f32_16x16x32_bf16 v[104:107], v[40:43], v[196:199], v[104:107]
  v_mfma_f32_16x16x32_bf16 v[108:111], v[40:43], v[228:231], v[108:111]
  s_waitcnt lgkmcnt(5)
  v_mfma_f32_16x16x32_bf16 v[96:99], v[44:47], v[136:139], v[96:99]
  v_mfma_f32_16x16x32_bf16 v[100:103], v[44:47], v[168:171], v[100:103]
  v_mfma_f32_16x16x32_bf16 v[104:107], v[44:47], v[200:203], v[104:107]
  v_mfma_f32_16x16x32_bf16 v[108:111], v[44:47], v[232:235], v[108:111]
  s_waitcnt lgkmcnt(4)
  v_mfma_f32_16x16x32_bf16 v[96:99], v[48:51], v[140:143], v[96:99]
  v_mfma_f32_16x16x32_bf16 v[100:103], v[48:51], v[172:175], v[100:103]
  v_mfma_f32_16x16x32_bf16 v[104:107], v[48:51], v[204:207], v[104:107]
  v_mfma_f32_16x16x32_bf16 v[108:111], v[48:51], v[236:239], v[108:111]
  s_waitcnt lgkmcnt(3)
  v_mfma_f32_16x16x32_bf16 v[96:99], v[52:55], v[144:147], v[96:99]
  v_mfma_f32_16x16x32_bf16 v[100:103], v[52:55], v[176:179], v[100:103]
  v_mfma_f32_16x16x32_bf16 v[104:107], v[52:55], v[208:211], v[104:107]
  v_mfma_f32_16x16x32_bf16 v[108:111], v[52:55], v[240:243], v[108:111]
  s_waitcnt lgkmcnt(2)
  v_mfma_f32_16x16x32_bf16 v[96:99], v[56:59], v[148:151], v[96:99]
  v_mfma_f32_16x16x32_bf16 v[100:103], v[56:59], v[180:183], v[100:103]
  v_mfma_f32_16x16x32_bf16 v[104:107], v[56:59], v[212:215], v[104:107]
  v_mfma_f32_16x16x32_bf16 v[108:111], v[56:59], v[244:247], v[108:111]
  s_waitcnt lgkmcnt(1)
  v_mfma_f32_16x16x32_bf16 v[96:99], v[60:63], v[152:155], v[96:99]
  v_mfma_f32_16x16x32_bf16 v[100:103], v[60:63], v[184:187], v[100:103]
  v_mfma_f32_16x16x32_bf16 v[104:107], v[60:63], v[216:219], v[104:107]
  v_mfma_f32_16x16x32_bf16 v[108:111], v[60:63], v[248:251], v[108:111]
  s_waitcnt lgkmcnt(0)
  v_mfma_f32_16x16x32_bf16 v[96:99], v[64:67], v[156:159], v[96:99]
  v_mfma_f32_16x16x32_bf16 v[100:103], v[64:67], v[188:191], v[100:103]
  v_mfma_f32_16x16x32_bf16 v[104:107], v[64:67], v[220:223], v[104:107]
  v_mfma_f32_16x16x32_bf16 v[108:111], v[64:67], v[252:255], v[108:111]
  ds_read_b128 v[36:39], v32 offset:2048
  ds_read_b128 v[40:43], v33 offset:2048
  ds_read_b128 v[44:47], v34 offset:2048
  ds_read_b128 v[48:51], v35 offset:2048
  ds_read_b128 v[52:55], v32 offset:2304
  ds_read_b128 v[56:59], v33 offset:2304
  ds_read_b128 v[60:63], v34 offset:2304
  ds_read_b128 v[64:67], v35 offset:2304
  s_waitcnt lgkmcnt(7)
  v_mfma_f32_16x16x32_bf16 v[112:115], v[36:39], v[128:131], 0
  v_mfma_f32_16x16x32_bf16 v[116:119], v[36:39], v[160:163], 0
  v_mfma_f32_16x16x32_bf16 v[120:123], v[36:39], v[192:195], 0
  v_mfma_f32_16x16x32_bf16 v[124:127], v[36:39], v[224:227], 0
  s_waitcnt lgkmcnt(6)
  v_mfma_f32_16x16x32_bf16 v[112:115], v[40:43], v[132:135], v[112:115]
  v_mfma_f32_16x16x32_bf16 v[116:119], v[40:43], v[164:167], v[116:119]
  v_mfma_f32_16x16x32_bf16 v[120:123], v[40:43], v[196:199], v[120:123]
  v_mfma_f32_16x16x32_bf16 v[124:127], v[40:43], v[228:231], v[124:127]
  s_waitcnt lgkmcnt(5)
  v_mfma_f32_16x16x32_bf16 v[112:115], v[44:47], v[136:139], v[112:115]
  v_mfma_f32_16x16x32_bf16 v[116:119], v[44:47], v[168:171], v[116:119]
  v_mfma_f32_16x16x32_bf16 v[120:123], v[44:47], v[200:203], v[120:123]
  v_mfma_f32_16x16x32_bf16 v[124:127], v[44:47], v[232:235], v[124:127]
  s_waitcnt lgkmcnt(4)
  v_mfma_f32_16x16x32_bf16 v[112:115], v[48:51], v[140:143], v[112:115]
  v_mfma_f32_16x16x32_bf16 v[116:119], v[48:51], v[172:175], v[116:119]
  v_mfma_f32_16x16x32_bf16 v[120:123], v[48:51], v[204:207], v[120:123]
  v_mfma_f32_16x16x32_bf16 v[124:127], v[48:51], v[236:239], v[124:127]
  s_waitcnt lgkmcnt(3)
  v_mfma_f32_16x16x32_bf16 v[112:115], v[52:55], v[144:147], v[112:115]
  v_mfma_f32_16x16x32_bf16 v[116:119], v[52:55], v[176:179], v[116:119]
  v_mfma_f32_16x16x32_bf16 v[120:123], v[52:55], v[208:211], v[120:123]
  v_mfma_f32_16x16x32_bf16 v[124:127], v[52:55], v[240:243], v[124:127]
  s_waitcnt lgkmcnt(2)
  v_mfma_f32_16x16x32_bf16 v[112:115], v[56:59], v[148:151], v[112:115]
  v_mfma_f32_16x16x32_bf16 v[116:119], v[56:59], v[180:183], v[116:119]
  v_mfma_f32_16x16x32_bf16 v[120:123], v[56:59], v[212:215], v[120:123]
  v_mfma_f32_16x16x32_bf16 v[124:127], v[56:59], v[244:247], v[124:127]
  s_waitcnt lgkmcnt(1)
  v_mfma_f32_16x16x32_bf16 v[112:115], v[60:63], v[152:155], v[112:115]
  v_mfma_f32_16x16x32_bf16 v[116:119], v[60:63], v[184:187], v[116:119]
  v_mfma_f32_16x16x32_bf16 v[120:123], v[60:63], v[216:219], v[120:123]
  v_mfma_f32_16x16x32_bf16 v[124:127], v[60:63], v[248:251], v[124:127]
  s_waitcnt lgkmcnt(0)
  v_mfma_f32_16x16x32_bf16 v[112:115], v[64:67], v[156:159], v[112:115]
  v_mfma_f32_16x16x32_bf16 v[116:119], v[64:67], v[188:191], v[116:119]
  v_mfma_f32_16x16x32_bf16 v[120:123], v[64:67], v[220:223], v[120:123]
  v_mfma_f32_16x16x32_bf16 v[124:127], v[64:67], v[252:255], v[124:127]
  s_lshl_b32 s30, s28, 10
  v_mul_f32 v96, s24, v96
  v_mul_f32 v97, s24, v97
  v_mul_f32 v98, s24, v98
  v_mul_f32 v99, s24, v99
  v_cvt_pk_bf16_f32 v68, v96, v97
  v_cvt_pk_bf16_f32 v69, v98, v99
  v_mul_f32 v112, s24, v112
  v_mul_f32 v113, s24, v113
  v_mul_f32 v114, s24, v114
  v_mul_f32 v115, s24, v115
  v_cvt_pk_bf16_f32 v70, v112, v113
  v_cvt_pk_bf16_f32 v71, v114, v115
  buffer_store_dwordx4 v[68:71], v12, s[8:11], s30 offen
  v_mul_f32 v100, s24, v100
  v_mul_f32 v101, s24, v101
  v_mul_f32 v102, s24, v102
  v_mul_f32 v103, s24, v103
  v_cvt_pk_bf16_f32 v72, v100, v101
  v_cvt_pk_bf16_f32 v73, v102, v103
  v_mul_f32 v116, s24, v116
  v_mul_f32 v117, s24, v117
  v_mul_f32 v118, s24, v118
  v_mul_f32 v119, s24, v119
  v_cvt_pk_bf16_f32 v74, v116, v117
  v_cvt_pk_bf16_f32 v75, v118, v119
  buffer_store_dwordx4 v[72:75], v13, s[8:11], s30 offen
  v_mul_f32 v104, s24, v104
  v_mul_f32 v105, s24, v105
  v_mul_f32 v106, s24, v106
  v_mul_f32 v107, s24, v107
  v_cvt_pk_bf16_f32 v76, v104, v105
  v_cvt_pk_bf16_f32 v77, v106, v107
  v_mul_f32 v120, s24, v120
  v_mul_f32 v121, s24, v121
  v_mul_f32 v122, s24, v122
  v_mul_f32 v123, s24, v123
  v_cvt_pk_bf16_f32 v78, v120, v121
  v_cvt_pk_bf16_f32 v79, v122, v123
  buffer_store_dwordx4 v[76:79], v14, s[8:11], s30 offen
  v_mul_f32 v108, s24, v108
  v_mul_f32 v109, s24, v109
  v_mul_f32 v110, s24, v110
  v_mul_f32 v111, s24, v111
  v_cvt_pk_bf16_f32 v80, v108, v109
  v_cvt_pk_bf16_f32 v81, v110, v111
  v_mul_f32 v124, s24, v124
  v_mul_f32 v125, s24, v125
  v_mul_f32 v126, s24, v126
  v_mul_f32 v127, s24, v127
  v_cvt_pk_bf16_f32 v82, v124, v125
  v_cvt_pk_bf16_f32 v83, v126, v127
  buffer_store_dwordx4 v[80:83], v15, s[8:11], s30 offen
  s_add_u32 s28, s28, 4
  s_cmp_lt_u32 s28, 14
  s_cbranch_scc0 pw_wend
  s_waitcnt vmcnt(4) lgkmcnt(0)
  ds_read_b128 v[36:39], v32 offset:16384
  ds_read_b128 v[40:43], v33 offset:16384
  ds_read_b128 v[44:47], v34 offset:16384
  ds_read_b128 v[48:51], v35 offset:16384
  ds_read_b128 v[52:55], v32 offset:16640
  ds_read_b128 v[56:59], v33 offset:16640
  ds_read_b128 v[60:63], v34 offset:16640
  ds_read_b128 v[64:67], v35 offset:16640
  s_waitcnt lgkmcnt(7)
  v_mfma_f32_16x16x32_bf16 v[96:99], v[36:39], v[128:131], 0
  v_mfma_f32_16x16x32_bf16 v[100:103], v[36:39], v[160:163], 0
  v_mfma_f32_16x16x32_bf16 v[104:107], v[36:39], v[192:195], 0
  v_mfma_f32_16x16x32_bf16 v[108:111], v[36:39], v[224:227], 0
  s_waitcnt lgkmcnt(6)
  v_mfma_f32_16x16x32_bf16 v[96:99], v[40:43], v[132:135], v[96:99]
  v_mfma_f32_16x16x32_bf16 v[100:103], v[40:43], v[164:167], v[100:103]
  v_mfma_f32_16x16x32_bf16 v[104:107], v[40:43], v[196:199], v[104:107]
  v_mfma_f32_16x16x32_bf16 v[108:111], v[40:43], v[228:231], v[108:111]
  s_waitcnt lgkmcnt(5)
  v_mfma_f32_16x16x32_bf16 v[96:99], v[44:47], v[136:139], v[96:99]
  v_mfma_f32_16x16x32_bf16 v[100:103], v[44:47], v[168:171], v[100:103]
  v_mfma_f32_16x16x32_bf16 v[104:107], v[44:47], v[200:203], v[104:107]
  v_mfma_f32_16x16x32_bf16 v[108:111], v[44:47], v[232:235], v[108:111]
  s_waitcnt lgkmcnt(4)
  v_mfma_f32_16x16x32_bf16 v[96:99], v[48:51], v[140:143], v[96:99]
  v_mfma_f32_16x16x32_bf16 v[100:103], v[48:51], v[172:175], v[100:103]
  v_mfma_f32_16x16x32_bf16 v[104:107], v[48:51], v[204:207], v[104:107]
  v_mfma_f32_16x16x32_bf16 v[108:111], v[48:51], v[236:239], v[108:111]
  s_waitcnt lgkmcnt(3)
  v_mfma_f32_16x16x32_bf16 v[96:99], v[52:55], v[144:147], v[96:99]
  v_mfma_f32_16x16x32_bf16 v[100:103], v[52:55], v[176:179], v[100:103]
  v_mfma_f32_16x16x32_bf16 v[104:107], v[52:55], v[208:211], v[104:107]
  v_mfma_f32_16x16x32_bf16 v[108:111], v[52:55], v[240:243], v[108:111]
  s_waitcnt lgkmcnt(2)
  v_mfma_f32_16x16x32_bf16 v[96:99], v[56:59], v[148:151], v[96:99]
  v_mfma_f32_16x16x32_bf16 v[100:103], v[56:59], v[180:183], v[100:103]
  v_mfma_f32_16x16x32_bf16 v[104:107], v[56:59], v[212:215], v[104:107]
  v_mfma_f32_16x16x32_bf16 v[108:111], v[56:59], v[244:247], v[108:111]
  s_waitcnt lgkmcnt(1)
  v_mfma_f32_16x16x32_bf16 v[96:99], v[60:63], v[152:155], v[96:99]
  v_mfma_f32_16x16x32_bf16 v[100:103], v[60:63], v[184:187], v[100:103]
  v_mfma_f32_16x16x32_bf16 v[104:107], v[60:63], v[216:219], v[104:107]
  v_mfma_f32_16x16x32_bf16 v[108:111], v[60:63], v[248:251], v[108:111]
  s_waitcnt lgkmcnt(0)
  v_mfma_f32_16x16x32_bf16 v[96:99], v[64:67], v[156:159], v[96:99]
  v_mfma_f32_16x16x32_bf16 v[100:103], v[64:67], v[188:191], v[100:103]
  v_mfma_f32_16x16x32_bf16 v[104:107], v[64:67], v[220:223], v[104:107]
  v_mfma_f32_16x16x32_bf16 v[108:111], v[64:67], v[252:255], v[108:111]
  ds_read_b128 v[36:39], v32 offset:18432
  ds_read_b128 v[40:43], v33 offset:18432
  ds_read_b128 v[44:47], v34 offset:18432
  ds_read_b128 v[48:51], v35 offset:18432
  ds_read_b128 v[52:55], v32 offset:18688
  ds_read_b128 v[56:59], v33 offset:18688
  ds_read_b128 v[60:63], v34 offset:18688
  ds_read_b128 v[64:67], v35 offset:18688
  s_waitcnt lgkmcnt(7)
  v_mfma_f32_16x16x32_bf16 v[112:115], v[36:39], v[128:131], 0
  v_mfma_f32_16x16x32_bf16 v[116:119], v[36:39], v[160:163], 0
  v_mfma_f32_16x16x32_bf16 v[120:123], v[36:39], v[192:195], 0
  v_mfma_f32_16x16x32_bf16 v[124:127], v[36:39], v[224:227], 0
  s_waitcnt lgkmcnt(6)
  v_mfma_f32_16x16x32_bf16 v[112:115], v[40:43], v[132:135], v[112:115]
  v_mfma_f32_16x16x32_bf16 v[116:119], v[40:43], v[164:167], v[116:119]
  v_mfma_f32_16x16x32_bf16 v[120:123], v[40:43], v[196:199], v[120:123]
  v_mfma_f32_16x16x32_bf16 v[124:127], v[40:43], v[228:231], v[124:127]
  s_waitcnt lgkmcnt(5)
  v_mfma_f32_16x16x32_bf16 v[112:115], v[44:47], v[136:139], v[112:115]
  v_mfma_f32_16x16x32_bf16 v[116:119], v[44:47], v[168:171], v[116:119]
  v_mfma_f32_16x16x32_bf16 v[120:123], v[44:47], v[200:203], v[120:123]
  v_mfma_f32_16x16x32_bf16 v[124:127], v[44:47], v[232:235], v[124:127]
  s_waitcnt lgkmcnt(4)
  v_mfma_f32_16x16x32_bf16 v[112:115], v[48:51], v[140:143], v[112:115]
  v_mfma_f32_16x16x32_bf16 v[116:119], v[48:51], v[172:175], v[116:119]
  v_mfma_f32_16x16x32_bf16 v[120:123], v[48:51], v[204:207], v[120:123]
  v_mfma_f32_16x16x32_bf16 v[124:127], v[48:51], v[236:239], v[124:127]
  s_waitcnt lgkmcnt(3)
  v_mfma_f32_16x16x32_bf16 v[112:115], v[52:55], v[144:147], v[112:115]
  v_mfma_f32_16x16x32_bf16 v[116:119], v[52:55], v[176:179], v[116:119]
  v_mfma_f32_16x16x32_bf16 v[120:123], v[52:55], v[208:211], v[120:123]
  v_mfma_f32_16x16x32_bf16 v[124:127], v[52:55], v[240:243], v[124:127]
  s_waitcnt lgkmcnt(2)
  v_mfma_f32_16x16x32_bf16 v[112:115], v[56:59], v[148:151], v[112:115]
  v_mfma_f32_16x16x32_bf16 v[116:119], v[56:59], v[180:183], v[116:119]
  v_mfma_f32_16x16x32_bf16 v[120:123], v[56:59], v[212:215], v[120:123]
  v_mfma_f32_16x16x32_bf16 v[124:127], v[56:59], v[244:247], v[124:127]
  s_waitcnt lgkmcnt(1)
  v_mfma_f32_16x16x32_bf16 v[112:115], v[60:63], v[152:155], v[112:115]
  v_mfma_f32_16x16x32_bf16 v[116:119], v[60:63], v[184:187], v[116:119]
  v_mfma_f32_16x16x32_bf16 v[120:123], v[60:63], v[216:219], v[120:123]
  v_mfma_f32_16x16x32_bf16 v[124:127], v[60:63], v[248:251], v[124:127]
  s_waitcnt lgkmcnt(0)
  v_mfma_f32_16x16x32_bf16 v[112:115], v[64:67], v[156:159], v[112:115]
  v_mfma_f32_16x16x32_bf16 v[116:119], v[64:67], v[188:191], v[116:119]
  v_mfma_f32_16x16x32_bf16 v[120:123], v[64:67], v[220:223], v[120:123]
  v_mfma_f32_16x16x32_bf16 v[124:127], v[64:67], v[252:255], v[124:127]
  s_lshl_b32 s30, s28, 10
  v_mul_f32 v96, s24, v96
  v_mul_f32 v97, s24, v97
  v_mul_f32 v98, s24, v98
  v_mul_f32 v99, s24, v99
  v_cvt_pk_bf16_f32 v68, v96, v97
  v_cvt_pk_bf16_f32 v69, v98, v99
  v_mul_f32 v112, s24, v112
  v_mul_f32 v113, s24, v113
  v_mul_f32 v114, s24, v114
  v_mul_f32 v115, s24, v115
  v_cvt_pk_bf16_f32 v70, v112, v113
  v_cvt_pk_bf16_f32 v71, v114, v115
  buffer_store_dwordx4 v[68:71], v12, s[8:11], s30 offen
  v_mul_f32 v100, s24, v100
  v_mul_f32 v101, s24, v101
  v_mul_f32 v102, s24, v102
  v_mul_f32 v103, s24, v103
  v_cvt_pk_bf16_f32 v72, v100, v101
  v_cvt_pk_bf16_f32 v73, v102, v103
  v_mul_f32 v116, s24, v116
  v_mul_f32 v117, s24, v117
  v_mul_f32 v118, s24, v118
  v_mul_f32 v119, s24, v119
  v_cvt_pk_bf16_f32 v74, v116, v117
  v_cvt_pk_bf16_f32 v75, v118, v119
  buffer_store_dwordx4 v[72:75], v13, s[8:11], s30 offen
  v_mul_f32 v104, s24, v104
  v_mul_f32 v105, s24, v105
  v_mul_f32 v106, s24, v106
  v_mul_f32 v107, s24, v107
  v_cvt_pk_bf16_f32 v76, v104, v105
  v_cvt_pk_bf16_f32 v77, v106, v107
  v_mul_f32 v120, s24, v120
  v_mul_f32 v121, s24, v121
  v_mul_f32 v122, s24, v122
  v_mul_f32 v123, s24, v123
  v_cvt_pk_bf16_f32 v78, v120, v121
  v_cvt_pk_bf16_f32 v79, v122, v123
  buffer_store_dwordx4 v[76:79], v14, s[8:11], s30 offen
  v_mul_f32 v108, s24, v108
  v_mul_f32 v109, s24, v109
  v_mul_f32 v110, s24, v110
  v_mul_f32 v111, s24, v111
  v_cvt_pk_bf16_f32 v80, v108, v109
  v_cvt_pk_bf16_f32 v81, v110, v111
  v_mul_f32 v124, s24, v124
  v_mul_f32 v125, s24, v125
  v_mul_f32 v126, s24, v126
  v_mul_f32 v127, s24, v127
  v_cvt_pk_bf16_f32 v82, v124, v125
  v_cvt_pk_bf16_f32 v83, v126, v127
  buffer_store_dwordx4 v[80:83], v15, s[8:11], s30 offen
  s_add_u32 s28, s28, 4
pw_wend:
  s_branch pr_end
pr_x:
  s_sub_u32 s3, s2, 224
  s_load_dwordx4 s[48:51], s[0:1], 56
  s_waitcnt lgkmcnt(0)
  s_mov_b32 s60, s48
  s_and_b32 s61, s49, 0xffff
  s_mov_b32 s62, 1835008
  s_mov_b32 s63, 0x20000
  s_mov_b32 s56, s50
  s_and_b32 s57, s51, 0xffff
  s_mov_b32 s58, 7168
  s_mov_b32 s59, 0x20000
  s_lshl_b32 s20, s3, 8
  v_add_u32 v5, s20, v0
  s_mov_b32 s21, 0x924925
  s_mov_b32 s21, 599187
  s_mov_b32 s22, 153391872
  v_mov_b32 v6, v5
  v_lshlrev_b32 v9, 5, v6
  buffer_load_dwordx4 v[64:67], v9, s[60:63], 0 offen
  buffer_load_dwordx4 v[68:71], v9, s[60:63], 0 offen offset:16
  v_add_u32 v6, 8192, v5
  v_lshlrev_b32 v9, 5, v6
  buffer_load_dwordx4 v[72:75], v9, s[60:63], 0 offen
  buffer_load_dwordx4 v[76:79], v9, s[60:63], 0 offen offset:16
  v_add_u32 v6, 16384, v5
  v_lshlrev_b32 v9, 5, v6
  buffer_load_dwordx4 v[80:83], v9, s[60:63], 0 offen
  buffer_load_dwordx4 v[84:87], v9, s[60:63], 0 offen offset:16
  v_add_u32 v6, 24576, v5
  v_lshlrev_b32 v9, 5, v6
  buffer_load_dwordx4 v[88:91], v9, s[60:63], 0 offen
  buffer_load_dwordx4 v[92:95], v9, s[60:63], 0 offen offset:16
  v_add_u32 v6, 32768, v5
  v_lshlrev_b32 v9, 5, v6
  buffer_load_dwordx4 v[96:99], v9, s[60:63], 0 offen
  buffer_load_dwordx4 v[100:103], v9, s[60:63], 0 offen offset:16
  v_add_u32 v6, 40960, v5
  v_lshlrev_b32 v9, 5, v6
  buffer_load_dwordx4 v[104:107], v9, s[60:63], 0 offen
  buffer_load_dwordx4 v[108:111], v9, s[60:63], 0 offen offset:16
  v_add_u32 v6, 49152, v5
  v_lshlrev_b32 v9, 5, v6
  buffer_load_dwordx4 v[112:115], v9, s[60:63], 0 offen
  buffer_load_dwordx4 v[116:119], v9, s[60:63], 0 offen offset:16
  v_mov_b32 v6, v5
  v_lshlrev_b32 v9, 5, v6
  buffer_load_dwordx4 v[120:123], v9, s[56:59], 0 offen
  buffer_load_dwordx4 v[124:127], v9, s[56:59], 0 offen offset:16
  s_mov_b32 s23, 75235328
  v_add_u32 v6, 448, v5
  v_subrev_u32 v7, 1344, v6
  v_mov_b32 v48, -1
  v_mov_b32 v9, 0
  v_cmp_gt_u32 vcc, 0x100, v7
  s_nop 1
  v_cndmask_b32 v48, v48, v9, vcc
  v_mov_b32 v49, v48
  v_mov_b32 v50, v48
  v_mov_b32 v51, v48
  v_lshlrev_b32 v8, 4, v6
  v_mov_b32 v7, 105600
  v_cmp_lt_u32 vcc, v6, v7
  s_and_saveexec_b64 s[30:31], vcc
  s_cbranch_execz px_np0
  buffer_store_dwordx4 v[48:51], v8, s[8:11], s23 offen
px_np0:
  s_mov_b64 exec, -1
  s_nop 1
  v_add_u32 v6, 8640, v5
  v_subrev_u32 v7, 1344, v6
  v_mov_b32 v48, -1
  v_mov_b32 v9, 0
  v_cmp_gt_u32 vcc, 0x100, v7
  s_nop 1
  v_cndmask_b32 v48, v48, v9, vcc
  v_mov_b32 v49, v48
  v_mov_b32 v50, v48
  v_mov_b32 v51, v48
  v_lshlrev_b32 v8, 4, v6
  v_mov_b32 v7, 105600
  v_cmp_lt_u32 vcc, v6, v7
  s_and_saveexec_b64 s[30:31], vcc
  s_cbranch_execz px_np1
  buffer_store_dwordx4 v[48:51], v8, s[8:11], s23 offen
px_np1:
  s_mov_b64 exec, -1
  s_nop 1
  v_add_u32 v6, 16832, v5
  v_subrev_u32 v7, 1344, v6
  v_mov_b32 v48, -1
  v_mov_b32 v9, 0
  v_cmp_gt_u32 vcc, 0x100, v7
  s_nop 1
  v_cndmask_b32 v48, v48, v9, vcc
  v_mov_b32 v49, v48
  v_mov_b32 v50, v48
  v_mov_b32 v51, v48
  v_lshlrev_b32 v8, 4, v6
  v_mov_b32 v7, 105600
  v_cmp_lt_u32 vcc, v6, v7
  s_and_saveexec_b64 s[30:31], vcc
  s_cbranch_execz px_np2
  buffer_store_dwordx4 v[48:51], v8, s[8:11], s23 offen
px_np2:
  s_mov_b64 exec, -1
  s_nop 1
  v_add_u32 v6, 25024, v5
  v_subrev_u32 v7, 1344, v6
  v_mov_b32 v48, -1
  v_mov_b32 v9, 0
  v_cmp_gt_u32 vcc, 0x100, v7
  s_nop 1
  v_cndmask_b32 v48, v48, v9, vcc
  v_mov_b32 v49, v48
  v_mov_b32 v50, v48
  v_mov_b32 v51, v48
  v_lshlrev_b32 v8, 4, v6
  v_mov_b32 v7, 105600
  v_cmp_lt_u32 vcc, v6, v7
  s_and_saveexec_b64 s[30:31], vcc
  s_cbranch_execz px_np3
  buffer_store_dwordx4 v[48:51], v8, s[8:11], s23 offen
px_np3:
  s_mov_b64 exec, -1
  s_nop 1
  v_add_u32 v6, 33216, v5
  v_subrev_u32 v7, 1344, v6
  v_mov_b32 v48, -1
  v_mov_b32 v9, 0
  v_cmp_gt_u32 vcc, 0x100, v7
  s_nop 1
  v_cndmask_b32 v48, v48, v9, vcc
  v_mov_b32 v49, v48
  v_mov_b32 v50, v48
  v_mov_b32 v51, v48
  v_lshlrev_b32 v8, 4, v6
  v_mov_b32 v7, 105600
  v_cmp_lt_u32 vcc, v6, v7
  s_and_saveexec_b64 s[30:31], vcc
  s_cbranch_execz px_np4
  buffer_store_dwordx4 v[48:51], v8, s[8:11], s23 offen
px_np4:
  s_mov_b64 exec, -1
  s_nop 1
  v_add_u32 v6, 41408, v5
  v_subrev_u32 v7, 1344, v6
  v_mov_b32 v48, -1
  v_mov_b32 v9, 0
  v_cmp_gt_u32 vcc, 0x100, v7
  s_nop 1
  v_cndmask_b32 v48, v48, v9, vcc
  v_mov_b32 v49, v48
  v_mov_b32 v50, v48
  v_mov_b32 v51, v48
  v_lshlrev_b32 v8, 4, v6
  v_mov_b32 v7, 105600
  v_cmp_lt_u32 vcc, v6, v7
  s_and_saveexec_b64 s[30:31], vcc
  s_cbranch_execz px_np5
  buffer_store_dwordx4 v[48:51], v8, s[8:11], s23 offen
px_np5:
  s_mov_b64 exec, -1
  s_nop 1
  v_add_u32 v6, 49600, v5
  v_subrev_u32 v7, 1344, v6
  v_mov_b32 v48, -1
  v_mov_b32 v9, 0
  v_cmp_gt_u32 vcc, 0x100, v7
  s_nop 1
  v_cndmask_b32 v48, v48, v9, vcc
  v_mov_b32 v49, v48
  v_mov_b32 v50, v48
  v_mov_b32 v51, v48
  v_lshlrev_b32 v8, 4, v6
  v_mov_b32 v7, 105600
  v_cmp_lt_u32 vcc, v6, v7
  s_and_saveexec_b64 s[30:31], vcc
  s_cbranch_execz px_np6
  buffer_store_dwordx4 v[48:51], v8, s[8:11], s23 offen
px_np6:
  s_mov_b64 exec, -1
  s_nop 1
  v_add_u32 v6, 57792, v5
  v_subrev_u32 v7, 1344, v6
  v_mov_b32 v48, -1
  v_mov_b32 v9, 0
  v_cmp_gt_u32 vcc, 0x100, v7
  s_nop 1
  v_cndmask_b32 v48, v48, v9, vcc
  v_mov_b32 v49, v48
  v_mov_b32 v50, v48
  v_mov_b32 v51, v48
  v_lshlrev_b32 v8, 4, v6
  v_mov_b32 v7, 105600
  v_cmp_lt_u32 vcc, v6, v7
  s_and_saveexec_b64 s[30:31], vcc
  s_cbranch_execz px_np7
  buffer_store_dwordx4 v[48:51], v8, s[8:11], s23 offen
px_np7:
  s_mov_b64 exec, -1
  s_nop 1
  v_add_u32 v6, 65984, v5
  v_subrev_u32 v7, 1344, v6
  v_mov_b32 v48, -1
  v_mov_b32 v9, 0
  v_cmp_gt_u32 vcc, 0x100, v7
  s_nop 1
  v_cndmask_b32 v48, v48, v9, vcc
  v_mov_b32 v49, v48
  v_mov_b32 v50, v48
  v_mov_b32 v51, v48
  v_lshlrev_b32 v8, 4, v6
  v_mov_b32 v7, 105600
  v_cmp_lt_u32 vcc, v6, v7
  s_and_saveexec_b64 s[30:31], vcc
  s_cbranch_execz px_np8
  buffer_store_dwordx4 v[48:51], v8, s[8:11], s23 offen
px_np8:
  s_mov_b64 exec, -1
  s_nop 1
  v_add_u32 v6, 74176, v5
  v_subrev_u32 v7, 1344, v6
  v_mov_b32 v48, -1
  v_mov_b32 v9, 0
  v_cmp_gt_u32 vcc, 0x100, v7
  s_nop 1
  v_cndmask_b32 v48, v48, v9, vcc
  v_mov_b32 v49, v48
  v_mov_b32 v50, v48
  v_mov_b32 v51, v48
  v_lshlrev_b32 v8, 4, v6
  v_mov_b32 v7, 105600
  v_cmp_lt_u32 vcc, v6, v7
  s_and_saveexec_b64 s[30:31], vcc
  s_cbranch_execz px_np9
  buffer_store_dwordx4 v[48:51], v8, s[8:11], s23 offen
px_np9:
  s_mov_b64 exec, -1
  s_nop 1
  v_add_u32 v6, 82368, v5
  v_subrev_u32 v7, 1344, v6
  v_mov_b32 v48, -1
  v_mov_b32 v9, 0
  v_cmp_gt_u32 vcc, 0x100, v7
  s_nop 1
  v_cndmask_b32 v48, v48, v9, vcc
  v_mov_b32 v49, v48
  v_mov_b32 v50, v48
  v_mov_b32 v51, v48
  v_lshlrev_b32 v8, 4, v6
  v_mov_b32 v7, 105600
  v_cmp_lt_u32 vcc, v6, v7
  s_and_saveexec_b64 s[30:31], vcc
  s_cbranch_execz px_np10
  buffer_store_dwordx4 v[48:51], v8, s[8:11], s23 offen
px_np10:
  s_mov_b64 exec, -1
  s_nop 1
  v_add_u32 v6, 90560, v5
  v_subrev_u32 v7, 1344, v6
  v_mov_b32 v48, -1
  v_mov_b32 v9, 0
  v_cmp_gt_u32 vcc, 0x100, v7
  s_nop 1
  v_cndmask_b32 v48, v48, v9, vcc
  v_mov_b32 v49, v48
  v_mov_b32 v50, v48
  v_mov_b32 v51, v48
  v_lshlrev_b32 v8, 4, v6
  v_mov_b32 v7, 105600
  v_cmp_lt_u32 vcc, v6, v7
  s_and_saveexec_b64 s[30:31], vcc
  s_cbranch_execz px_np11
  buffer_store_dwordx4 v[48:51], v8, s[8:11], s23 offen
px_np11:
  s_mov_b64 exec, -1
  s_nop 1
  v_add_u32 v6, 98752, v5
  v_subrev_u32 v7, 1344, v6
  v_mov_b32 v48, -1
  v_mov_b32 v9, 0
  v_cmp_gt_u32 vcc, 0x100, v7
  s_nop 1
  v_cndmask_b32 v48, v48, v9, vcc
  v_mov_b32 v49, v48
  v_mov_b32 v50, v48
  v_mov_b32 v51, v48
  v_lshlrev_b32 v8, 4, v6
  v_mov_b32 v7, 105600
  v_cmp_lt_u32 vcc, v6, v7
  s_and_saveexec_b64 s[30:31], vcc
  s_cbranch_execz px_np12
  buffer_store_dwordx4 v[48:51], v8, s[8:11], s23 offen
px_np12:
  s_mov_b64 exec, -1
  s_nop 1
  s_mov_b32 s23, 88068096
  v_add_u32 v6, 448, v5
  v_mov_b32 v48, -1
  v_mov_b32 v9, 0
  v_mov_b32 v7, 28672
  v_cmp_ge_u32 vcc, v6, v7
  s_nop 1
  v_cndmask_b32 v48, v48, v9, vcc
  v_mov_b32 v49, v48
  v_mov_b32 v50, v48
  v_mov_b32 v51, v48
  v_lshlrev_b32 v8, 4, v6
  v_mov_b32 v7, 29936
  v_cmp_lt_u32 vcc, v6, v7
  s_and_saveexec_b64 s[30:31], vcc
  s_cbranch_execz px_nq0
  buffer_store_dwordx4 v[48:51], v8, s[8:11], s23 offen
px_nq0:
  s_mov_b64 exec, -1
  s_nop 1
  v_add_u32 v6, 8640, v5
  v_mov_b32 v48, -1
  v_mov_b32 v9, 0
  v_mov_b32 v7, 28672
  v_cmp_ge_u32 vcc, v6, v7
  s_nop 1
  v_cndmask_b32 v48, v48, v9, vcc
  v_mov_b32 v49, v48
  v_mov_b32 v50, v48
  v_mov_b32 v51, v48
  v_lshlrev_b32 v8, 4, v6
  v_mov_b32 v7, 29936
  v_cmp_lt_u32 vcc, v6, v7
  s_and_saveexec_b64 s[30:31], vcc
  s_cbranch_execz px_nq1
  buffer_store_dwordx4 v[48:51], v8, s[8:11], s23 offen
px_nq1:
  s_mov_b64 exec, -1
  s_nop 1
  v_add_u32 v6, 16832, v5
  v_mov_b32 v48, -1
  v_mov_b32 v9, 0
  v_mov_b32 v7, 28672
  v_cmp_ge_u32 vcc, v6, v7
  s_nop 1
  v_cndmask_b32 v48, v48, v9, vcc
  v_mov_b32 v49, v48
  v_mov_b32 v50, v48
  v_mov_b32 v51, v48
  v_lshlrev_b32 v8, 4, v6
  v_mov_b32 v7, 29936
  v_cmp_lt_u32 vcc, v6, v7
  s_and_saveexec_b64 s[30:31], vcc
  s_cbranch_execz px_nq2
  buffer_store_dwordx4 v[48:51], v8, s[8:11], s23 offen
px_nq2:
  s_mov_b64 exec, -1
  s_nop 1
  v_add_u32 v6, 25024, v5
  v_mov_b32 v48, -1
  v_mov_b32 v9, 0
  v_mov_b32 v7, 28672
  v_cmp_ge_u32 vcc, v6, v7
  s_nop 1
  v_cndmask_b32 v48, v48, v9, vcc
  v_mov_b32 v49, v48
  v_mov_b32 v50, v48
  v_mov_b32 v51, v48
  v_lshlrev_b32 v8, 4, v6
  v_mov_b32 v7, 29936
  v_cmp_lt_u32 vcc, v6, v7
  s_and_saveexec_b64 s[30:31], vcc
  s_cbranch_execz px_nq3
  buffer_store_dwordx4 v[48:51], v8, s[8:11], s23 offen
px_nq3:
  s_mov_b64 exec, -1
  s_nop 1
  v_mov_b32 v6, v5
  v_mul_hi_u32 v7, v6, s22
  v_mul_u32_u24 v8, 28, v7
  v_sub_u32 v8, v6, v8
  v_lshrrev_b32 v10, 4, v7
  v_and_b32 v11, 15, v7
  v_lshrrev_b32 v12, 2, v8
  v_and_b32 v13, 3, v8
  v_lshrrev_b32 v14, 1, v8
  v_mad_u32_u24 v14, v10, 14, v14
  v_lshlrev_b32 v14, 10, v14
  v_and_b32 v15, 1, v8
  v_lshl_add_u32 v14, v15, 9, v14
  v_lshl_add_u32 v14, v11, 4, v14
  v_mad_u32_u24 v15, v10, 7, v12
  v_lshlrev_b32 v15, 11, v15
  v_lshl_add_u32 v15, v13, 8, v15
  v_lshl_add_u32 v15, v11, 4, v15
  s_waitcnt vmcnt(0)
  v_mov_b32 v16, v64
  v_mov_b32 v20, v65
  v_mov_b32 v17, v66
  v_mov_b32 v21, v67
  v_mov_b32 v18, v68
  v_mov_b32 v22, v69
  v_mov_b32 v19, v70
  v_mov_b32 v23, v71
  s_mov_b32 s23, 71565312
  buffer_store_dwordx4 v[64:67], v14, s[8:11], s23 offen
  buffer_store_dwordx4 v[68:71], v14, s[8:11], s23 offen offset:256
  s_mov_b32 s23, 73400320
  buffer_store_dwordx4 v[16:19], v15, s[8:11], s23 offen
  buffer_store_dwordx4 v[20:23], v15, s[8:11], s23 offen offset:1024
  v_add_u32 v6, 8192, v5
  v_mul_hi_u32 v7, v6, s22
  v_mul_u32_u24 v8, 28, v7
  v_sub_u32 v8, v6, v8
  v_lshrrev_b32 v10, 4, v7
  v_and_b32 v11, 15, v7
  v_lshrrev_b32 v12, 2, v8
  v_and_b32 v13, 3, v8
  v_lshrrev_b32 v14, 1, v8
  v_mad_u32_u24 v14, v10, 14, v14
  v_lshlrev_b32 v14, 10, v14
  v_and_b32 v15, 1, v8
  v_lshl_add_u32 v14, v15, 9, v14
  v_lshl_add_u32 v14, v11, 4, v14
  v_mad_u32_u24 v15, v10, 7, v12
  v_lshlrev_b32 v15, 11, v15
  v_lshl_add_u32 v15, v13, 8, v15
  v_lshl_add_u32 v15, v11, 4, v15
  v_mov_b32 v24, v72
  v_mov_b32 v28, v73
  v_mov_b32 v25, v74
  v_mov_b32 v29, v75
  v_mov_b32 v26, v76
  v_mov_b32 v30, v77
  v_mov_b32 v27, v78
  v_mov_b32 v31, v79
  s_mov_b32 s23, 71565312
  buffer_store_dwordx4 v[72:75], v14, s[8:11], s23 offen
  buffer_store_dwordx4 v[76:79], v14, s[8:11], s23 offen offset:256
  s_mov_b32 s23, 73400320
  buffer_store_dwordx4 v[24:27], v15, s[8:11], s23 offen
  buffer_store_dwordx4 v[28:31], v15, s[8:11], s23 offen offset:1024
  v_add_u32 v6, 16384, v5
  v_mul_hi_u32 v7, v6, s22
  v_mul_u32_u24 v8, 28, v7
  v_sub_u32 v8, v6, v8
  v_lshrrev_b32 v10, 4, v7
  v_and_b32 v11, 15, v7
  v_lshrrev_b32 v12, 2, v8
  v_and_b32 v13, 3, v8
  v_lshrrev_b32 v14, 1, v8
  v_mad_u32_u24 v14, v10, 14, v14
  v_lshlrev_b32 v14, 10, v14
  v_and_b32 v15, 1, v8
  v_lshl_add_u32 v14, v15, 9, v14
  v_lshl_add_u32 v14, v11, 4, v14
  v_mad_u32_u24 v15, v10, 7, v12
  v_lshlrev_b32 v15, 11, v15
  v_lshl_add_u32 v15, v13, 8, v15
  v_lshl_add_u32 v15, v11, 4, v15
  v_mov_b32 v32, v80
  v_mov_b32 v36, v81
  v_mov_b32 v33, v82
  v_mov_b32 v37, v83
  v_mov_b32 v34, v84
  v_mov_b32 v38, v85
  v_mov_b32 v35, v86
  v_mov_b32 v39, v87
  s_mov_b32 s23, 71565312
  buffer_store_dwordx4 v[80:83], v14, s[8:11], s23 offen
  buffer_store_dwordx4 v[84:87], v14, s[8:11], s23 offen offset:256
  s_mov_b32 s23, 73400320
  buffer_store_dwordx4 v[32:35], v15, s[8:11], s23 offen
  buffer_store_dwordx4 v[36:39], v15, s[8:11], s23 offen offset:1024
  v_add_u32 v6, 24576, v5
  v_mul_hi_u32 v7, v6, s22
  v_mul_u32_u24 v8, 28, v7
  v_sub_u32 v8, v6, v8
  v_lshrrev_b32 v10, 4, v7
  v_and_b32 v11, 15, v7
  v_lshrrev_b32 v12, 2, v8
  v_and_b32 v13, 3, v8
  v_lshrrev_b32 v14, 1, v8
  v_mad_u32_u24 v14, v10, 14, v14
  v_lshlrev_b32 v14, 10, v14
  v_and_b32 v15, 1, v8
  v_lshl_add_u32 v14, v15, 9, v14
  v_lshl_add_u32 v14, v11, 4, v14
  v_mad_u32_u24 v15, v10, 7, v12
  v_lshlrev_b32 v15, 11, v15
  v_lshl_add_u32 v15, v13, 8, v15
  v_lshl_add_u32 v15, v11, 4, v15
  v_mov_b32 v40, v88
  v_mov_b32 v44, v89
  v_mov_b32 v41, v90
  v_mov_b32 v45, v91
  v_mov_b32 v42, v92
  v_mov_b32 v46, v93
  v_mov_b32 v43, v94
  v_mov_b32 v47, v95
  s_mov_b32 s23, 71565312
  buffer_store_dwordx4 v[88:91], v14, s[8:11], s23 offen
  buffer_store_dwordx4 v[92:95], v14, s[8:11], s23 offen offset:256
  s_mov_b32 s23, 73400320
  buffer_store_dwordx4 v[40:43], v15, s[8:11], s23 offen
  buffer_store_dwordx4 v[44:47], v15, s[8:11], s23 offen offset:1024
  v_add_u32 v6, 32768, v5
  v_mul_hi_u32 v7, v6, s22
  v_mul_u32_u24 v8, 28, v7
  v_sub_u32 v8, v6, v8
  v_lshrrev_b32 v10, 4, v7
  v_and_b32 v11, 15, v7
  v_lshrrev_b32 v12, 2, v8
  v_and_b32 v13, 3, v8
  v_lshrrev_b32 v14, 1, v8
  v_mad_u32_u24 v14, v10, 14, v14
  v_lshlrev_b32 v14, 10, v14
  v_and_b32 v15, 1, v8
  v_lshl_add_u32 v14, v15, 9, v14
  v_lshl_add_u32 v14, v11, 4, v14
  v_mad_u32_u24 v15, v10, 7, v12
  v_lshlrev_b32 v15, 11, v15
  v_lshl_add_u32 v15, v13, 8, v15
  v_lshl_add_u32 v15, v11, 4, v15
  v_mov_b32 v16, v96
  v_mov_b32 v20, v97
  v_mov_b32 v17, v98
  v_mov_b32 v21, v99
  v_mov_b32 v18, v100
  v_mov_b32 v22, v101
  v_mov_b32 v19, v102
  v_mov_b32 v23, v103
  s_mov_b32 s23, 71565312
  buffer_store_dwordx4 v[96:99], v14, s[8:11], s23 offen
  buffer_store_dwordx4 v[100:103], v14, s[8:11], s23 offen offset:256
  s_mov_b32 s23, 73400320
  buffer_store_dwordx4 v[16:19], v15, s[8:11], s23 offen
  buffer_store_dwordx4 v[20:23], v15, s[8:11], s23 offen offset:1024
  v_add_u32 v6, 40960, v5
  v_mul_hi_u32 v7, v6, s22
  v_mul_u32_u24 v8, 28, v7
  v_sub_u32 v8, v6, v8
  v_lshrrev_b32 v10, 4, v7
  v_and_b32 v11, 15, v7
  v_lshrrev_b32 v12, 2, v8
  v_and_b32 v13, 3, v8
  v_lshrrev_b32 v14, 1, v8
  v_mad_u32_u24 v14, v10, 14, v14
  v_lshlrev_b32 v14, 10, v14
  v_and_b32 v15, 1, v8
  v_lshl_add_u32 v14, v15, 9, v14
  v_lshl_add_u32 v14, v11, 4, v14
  v_mad_u32_u24 v15, v10, 7, v12
  v_lshlrev_b32 v15, 11, v15
  v_lshl_add_u32 v15, v13, 8, v15
  v_lshl_add_u32 v15, v11, 4, v15
  v_mov_b32 v24, v104
  v_mov_b32 v28, v105
  v_mov_b32 v25, v106
  v_mov_b32 v29, v107
  v_mov_b32 v26, v108
  v_mov_b32 v30, v109
  v_mov_b32 v27, v110
  v_mov_b32 v31, v111
  s_mov_b32 s23, 71565312
  buffer_store_dwordx4 v[104:107], v14, s[8:11], s23 offen
  buffer_store_dwordx4 v[108:111], v14, s[8:11], s23 offen offset:256
  s_mov_b32 s23, 73400320
  buffer_store_dwordx4 v[24:27], v15, s[8:11], s23 offen
  buffer_store_dwordx4 v[28:31], v15, s[8:11], s23 offen offset:1024
  v_add_u32 v6, 49152, v5
  v_mul_hi_u32 v7, v6, s22
  v_mul_u32_u24 v8, 28, v7
  v_sub_u32 v8, v6, v8
  v_lshrrev_b32 v10, 4, v7
  v_and_b32 v11, 15, v7
  v_lshrrev_b32 v12, 2, v8
  v_and_b32 v13, 3, v8
  v_lshrrev_b32 v14, 1, v8
  v_mad_u32_u24 v14, v10, 14, v14
  v_lshlrev_b32 v14, 10, v14
  v_and_b32 v15, 1, v8
  v_lshl_add_u32 v14, v15, 9, v14
  v_lshl_add_u32 v14, v11, 4, v14
  v_mad_u32_u24 v15, v10, 7, v12
  v_lshlrev_b32 v15, 11, v15
  v_lshl_add_u32 v15, v13, 8, v15
  v_lshl_add_u32 v15, v11, 4, v15
  v_mov_b32 v32, v112
  v_mov_b32 v36, v113
  v_mov_b32 v33, v114
  v_mov_b32 v37, v115
  v_mov_b32 v34, v116
  v_mov_b32 v38, v117
  v_mov_b32 v35, v118
  v_mov_b32 v39, v119
  s_mov_b32 s23, 71565312
  buffer_store_dwordx4 v[112:115], v14, s[8:11], s23 offen
  buffer_store_dwordx4 v[116:119], v14, s[8:11], s23 offen offset:256
  s_mov_b32 s23, 73400320
  buffer_store_dwordx4 v[32:35], v15, s[8:11], s23 offen
  buffer_store_dwordx4 v[36:39], v15, s[8:11], s23 offen offset:1024
  v_mov_b32 v6, v5
  v_mov_b32 v7, 224
  v_cmp_lt_u32 vcc, v5, v7
  s_and_saveexec_b64 s[30:31], vcc
  s_cbranch_execz px_nomem
  v_mul_hi_u32 v7, v6, s22
  v_mul_u32_u24 v8, 28, v7
  v_sub_u32 v8, v6, v8
  v_lshrrev_b32 v10, 4, v7
  v_and_b32 v11, 15, v7
  v_lshrrev_b32 v12, 2, v8
  v_and_b32 v13, 3, v8
  v_lshlrev_b32 v15, 10, v12
  v_lshl_add_u32 v15, v13, 8, v15
  v_lshl_add_u32 v15, v11, 4, v15
  v_mov_b32 v40, v120
  v_mov_b32 v44, v121
  v_mov_b32 v41, v122
  v_mov_b32 v45, v123
  v_mov_b32 v42, v124
  v_mov_b32 v46, v125
  v_mov_b32 v43, v126
  v_mov_b32 v47, v127
  s_mov_b32 s23, 75235328
  buffer_store_dwordx4 v[40:43], v15, s[8:11], s23 offen
  buffer_store_dwordx4 v[44:47], v15, s[8:11], s23 offen offset:128
  s_mov_b32 s23, 88068096
  buffer_store_dwordx4 v[40:43], v15, s[8:11], s23 offen
  buffer_store_dwordx4 v[44:47], v15, s[8:11], s23 offen offset:128
px_nomem:
  s_mov_b64 exec, -1
pr_end:
  s_endpgm

.globl main_kernel
.p2align 8
.type main_kernel,@function
main_kernel:
  s_cmp_ge_u32 s2, 256
  s_cbranch_scc1 ch_end
  s_load_dwordx2 s[4:5], s[0:1], 120
  s_load_dwordx2 s[6:7], s[0:1], 128
  s_getpc_b64 s[98:99]
pf_main_kernel_1:
  s_sub_u32 s98, s98, pf_main_kernel_1-main_kernel
  s_subb_u32 s99, s99, 0
  v_lshlrev_b32 v60, 7, v0
  v_min_u32 v61, ch_end-main_kernel-4, v60
  global_load_dword v62, v61, s[98:99]
  v_add_u32 v60, 32768, v60
  v_min_u32 v61, ch_end-main_kernel-4, v60
  global_load_dword v62, v61, s[98:99]
  v_add_u32 v60, 32768, v60
  v_min_u32 v61, ch_end-main_kernel-4, v60
  global_load_dword v62, v61, s[98:99]
  v_add_u32 v60, 32768, v60
  v_min_u32 v61, ch_end-main_kernel-4, v60
  global_load_dword v62, v61, s[98:99]
  v_add_u32 v60, 32768, v60
  s_getreg_b32 s3, hwreg(HW_REG_XCC_ID)
  s_and_b32 s3, s3, 15
  v_lshrrev_b32 v1, 6, v0
  s_nop 0
  v_readfirstlane_b32 s16, v1
  s_waitcnt lgkmcnt(0)
  s_mov_b32 s8, s6
  s_and_b32 s9, s7, 0xffff
  s_mov_b32 s10, 0x10000000
  s_mov_b32 s11, 0x20000
  s_mov_b32 s12, s4
  s_and_b32 s13, s5, 0xffff
  s_mov_b32 s14, 256
  s_mov_b32 s15, 0x20000
  s_cmp_lg_u32 s3, 0
  s_cbranch_scc1 ch_worker
  v_mov_b32 v4, 1
  s_mov_b32 s18, 0
ch_take:
  v_mov_b32 v5, 0
  v_mov_b32 v6, 160000
  s_barrier
  s_cmp_lg_u32 s16, 0
  s_cbranch_scc1 ch_el1
  s_mov_b64 exec, 1
  buffer_atomic_add v4, v5, s[12:15], 0 offen sc0
  s_waitcnt vmcnt(0)
  ds_write_b32 v6, v4
  s_waitcnt lgkmcnt(0)
  s_mov_b64 exec, -1
ch_el1:
  s_barrier
  ds_read_b32 v4, v6
  s_waitcnt lgkmcnt(0)
  v_readfirstlane_b32 s17, v4
  s_and_b32 s17, s17, 0xffff
  s_cmp_lt_u32 s17, 32
  s_cbranch_scc1 ch_role
  s_cmp_eq_u32 s18, 0
  s_cbranch_scc1 ch_worker
  s_branch ch_end
ch_role:
  v_and_b32 v1, 63, v0
  v_lshlrev_b32 v2, 4, v1
  v_lshrrev_b32 v116, 4, v1
  v_and_b32 v117, 15, v1
  v_mov_b32 v3, 0x4444
  v_mov_b32 v118, 0xeeee
  v_cmp_lt_u32 vcc, 7, v117
  s_nop 1
  v_cndmask_b32 v3, v3, v118, vcc
  s_mov_b32 s19, 0
  s_mov_b32 s20, 75235328
  s_lshr_b32 s22, s17, 4
  s_lshl_b32 s22, s22, 2
  s_add_u32 s22, s22, s16
  s_and_b32 s17, s17, 15
  s_cmp_eq_u32 s22, 0
  s_cbranch_scc1 ch_init0
  s_cmp_eq_u32 s22, 1
  s_cbranch_scc1 ch_init1
  s_cmp_eq_u32 s22, 2
  s_cbranch_scc1 ch_init2
  s_cmp_eq_u32 s22, 3
  s_cbranch_scc1 ch_init3
  s_cmp_eq_u32 s22, 4
  s_cbranch_scc1 ch_init4
  s_cmp_eq_u32 s22, 5
  s_cbranch_scc1 ch_init5
  s_cmp_eq_u32 s22, 6
  s_cbranch_scc1 ch_init6
  s_cmp_eq_u32 s22, 7
  s_cbranch_scc1 ch_init7
  s_branch ch_end
ch_init0:
  s_mul_i32 s31, s17, 401408
  s_add_u32 s31, s31, 0
  s_add_u32 s22, s31, 0
  buffer_load_dwordx4 a[0:3], v2, s[8:11], s22 offen offset:0
  buffer_load_dwordx4 a[4:7], v2, s[8:11], s22 offen offset:1024
  buffer_load_dwordx4 a[8:11], v2, s[8:11], s22 offen offset:2048
  buffer_load_dwordx4 a[12:15], v2, s[8:11], s22 offen offset:3072
  s_add_u32 s22, s31, 4096
  buffer_load_dwordx4 a[16:19], v2, s[8:11], s22 offen offset:0
  buffer_load_dwordx4 a[20:23], v2, s[8:11], s22 offen offset:1024
  buffer_load_dwordx4 a[24:27], v2, s[8:11], s22 offen offset:2048
  buffer_load_dwordx4 a[28:31], v2, s[8:11], s22 offen offset:3072
  s_add_u32 s22, s31, 8192
  buffer_load_dwordx4 a[32:35], v2, s[8:11], s22 offen offset:0
  buffer_load_dwordx4 a[36:39], v2, s[8:11], s22 offen offset:1024
  buffer_load_dwordx4 a[40:43], v2, s[8:11], s22 offen offset:2048
  buffer_load_dwordx4 a[44:47], v2, s[8:11], s22 offen offset:3072
  s_add_u32 s22, s31, 12288
  buffer_load_dwordx4 a[48:51], v2, s[8:11], s22 offen offset:0
  buffer_load_dwordx4 a[52:55], v2, s[8:11], s22 offen offset:1024
  buffer_load_dwordx4 a[56:59], v2, s[8:11], s22 offen offset:2048
  buffer_load_dwordx4 a[60:63], v2, s[8:11], s22 offen offset:3072
  s_add_u32 s22, s31, 16384
  buffer_load_dwordx4 a[64:67], v2, s[8:11], s22 offen offset:0
  buffer_load_dwordx4 a[68:71], v2, s[8:11], s22 offen offset:1024
  buffer_load_dwordx4 a[72:75], v2, s[8:11], s22 offen offset:2048
  buffer_load_dwordx4 a[76:79], v2, s[8:11], s22 offen offset:3072
  s_add_u32 s22, s31, 20480
  buffer_load_dwordx4 a[80:83], v2, s[8:11], s22 offen offset:0
  buffer_load_dwordx4 a[84:87], v2, s[8:11], s22 offen offset:1024
  buffer_load_dwordx4 a[88:91], v2, s[8:11], s22 offen offset:2048
  buffer_load_dwordx4 a[92:95], v2, s[8:11], s22 offen offset:3072
  s_add_u32 s22, s31, 24576
  buffer_load_dwordx4 a[96:99], v2, s[8:11], s22 offen offset:0
  buffer_load_dwordx4 a[100:103], v2, s[8:11], s22 offen offset:1024
  buffer_load_dwordx4 a[104:107], v2, s[8:11], s22 offen offset:2048
  buffer_load_dwordx4 a[108:111], v2, s[8:11], s22 offen offset:3072
  s_add_u32 s22, s31, 28672
  buffer_load_dwordx4 a[112:115], v2, s[8:11], s22 offen offset:0
  buffer_load_dwordx4 a[116:119], v2, s[8:11], s22 offen offset:1024
  buffer_load_dwordx4 a[120:123], v2, s[8:11], s22 offen offset:2048
  buffer_load_dwordx4 a[124:127], v2, s[8:11], s22 offen offset:3072
  s_waitcnt vmcnt(24)
  s_add_u32 s22, s31, 32768
  buffer_load_dwordx4 a[128:131], v2, s[8:11], s22 offen offset:0
  buffer_load_dwordx4 a[132:135], v2, s[8:11], s22 offen offset:1024
  buffer_load_dwordx4 a[136:139], v2, s[8:11], s22 offen offset:2048
  buffer_load_dwordx4 a[140:143], v2, s[8:11], s22 offen offset:3072
  s_add_u32 s22, s31, 36864
  buffer_load_dwordx4 a[144:147], v2, s[8:11], s22 offen offset:0
  buffer_load_dwordx4 a[148:151], v2, s[8:11], s22 offen offset:1024
  buffer_load_dwordx4 a[152:155], v2, s[8:11], s22 offen offset:2048
  buffer_load_dwordx4 a[156:159], v2, s[8:11], s22 offen offset:3072
  s_add_u32 s22, s31, 40960
  buffer_load_dwordx4 a[160:163], v2, s[8:11], s22 offen offset:0
  buffer_load_dwordx4 a[164:167], v2, s[8:11], s22 offen offset:1024
  buffer_load_dwordx4 a[168:171], v2, s[8:11], s22 offen offset:2048
  buffer_load_dwordx4 a[172:175], v2, s[8:11], s22 offen offset:3072
  s_add_u32 s22, s31, 45056
  buffer_load_dwordx4 a[176:179], v2, s[8:11], s22 offen offset:0
  buffer_load_dwordx4 a[180:183], v2, s[8:11], s22 offen offset:1024
  buffer_load_dwordx4 a[184:187], v2, s[8:11], s22 offen offset:2048
  buffer_load_dwordx4 a[188:191], v2, s[8:11], s22 offen offset:3072
  s_add_u32 s22, s31, 49152
  buffer_load_dwordx4 a[192:195], v2, s[8:11], s22 offen offset:0
  buffer_load_dwordx4 a[196:199], v2, s[8:11], s22 offen offset:1024
  buffer_load_dwordx4 a[200:203], v2, s[8:11], s22 offen offset:2048
  buffer_load_dwordx4 a[204:207], v2, s[8:11], s22 offen offset:3072
  s_add_u32 s22, s31, 53248
  buffer_load_dwordx4 a[208:211], v2, s[8:11], s22 offen offset:0
  buffer_load_dwordx4 a[212:215], v2, s[8:11], s22 offen offset:1024
  buffer_load_dwordx4 a[216:219], v2, s[8:11], s22 offen offset:2048
  buffer_load_dwordx4 a[220:223], v2, s[8:11], s22 offen offset:3072
  s_add_u32 s22, s31, 229376
  buffer_load_dwordx4 a[224:227], v2, s[8:11], s22 offen offset:0
  buffer_load_dwordx4 a[228:231], v2, s[8:11], s22 offen offset:1024
  buffer_load_dwordx4 a[232:235], v2, s[8:11], s22 offen offset:2048
  buffer_load_dwordx4 a[236:239], v2, s[8:11], s22 offen offset:3072
  s_add_u32 s22, s31, 233472
  buffer_load_dwordx4 a[240:243], v2, s[8:11], s22 offen offset:0
  buffer_load_dwordx4 a[244:247], v2, s[8:11], s22 offen offset:1024
  buffer_load_dwordx4 a[248:251], v2, s[8:11], s22 offen offset:2048
  buffer_load_dwordx4 a[252:255], v2, s[8:11], s22 offen offset:3072
  s_waitcnt vmcnt(24)
  s_add_u32 s22, s31, 237568
  buffer_load_dwordx4 v[120:123], v2, s[8:11], s22 offen offset:0
  buffer_load_dwordx4 v[124:127], v2, s[8:11], s22 offen offset:1024
  buffer_load_dwordx4 v[128:131], v2, s[8:11], s22 offen offset:2048
  buffer_load_dwordx4 v[132:135], v2, s[8:11], s22 offen offset:3072
  s_add_u32 s22, s31, 241664
  buffer_load_dwordx4 v[136:139], v2, s[8:11], s22 offen offset:0
  buffer_load_dwordx4 v[140:143], v2, s[8:11], s22 offen offset:1024
  buffer_load_dwordx4 v[144:147], v2, s[8:11], s22 offen offset:2048
  buffer_load_dwordx4 v[148:151], v2, s[8:11], s22 offen offset:3072
  s_add_u32 s22, s31, 245760
  buffer_load_dwordx4 v[152:155], v2, s[8:11], s22 offen offset:0
  buffer_load_dwordx4 v[156:159], v2, s[8:11], s22 offen offset:1024
  buffer_load_dwordx4 v[160:163], v2, s[8:11], s22 offen offset:2048
  buffer_load_dwordx4 v[164:167], v2, s[8:11], s22 offen offset:3072
  s_add_u32 s22, s31, 249856
  buffer_load_dwordx4 v[168:171], v2, s[8:11], s22 offen offset:0
  buffer_load_dwordx4 v[172:175], v2, s[8:11], s22 offen offset:1024
  buffer_load_dwordx4 v[176:179], v2, s[8:11], s22 offen offset:2048
  buffer_load_dwordx4 v[180:183], v2, s[8:11], s22 offen offset:3072
  s_add_u32 s22, s31, 253952
  buffer_load_dwordx4 v[184:187], v2, s[8:11], s22 offen offset:0
  buffer_load_dwordx4 v[188:191], v2, s[8:11], s22 offen offset:1024
  buffer_load_dwordx4 v[192:195], v2, s[8:11], s22 offen offset:2048
  buffer_load_dwordx4 v[196:199], v2, s[8:11], s22 offen offset:3072
  s_add_u32 s22, s31, 344064
  buffer_load_dwordx4 v[200:203], v2, s[8:11], s22 offen offset:0
  buffer_load_dwordx4 v[204:207], v2, s[8:11], s22 offen offset:1024
  buffer_load_dwordx4 v[208:211], v2, s[8:11], s22 offen offset:2048
  buffer_load_dwordx4 v[212:215], v2, s[8:11], s22 offen offset:3072
  s_add_u32 s22, s31, 348160
  buffer_load_dwordx4 v[216:219], v2, s[8:11], s22 offen offset:0
  buffer_load_dwordx4 v[220:223], v2, s[8:11], s22 offen offset:1024
  buffer_load_dwordx4 v[224:227], v2, s[8:11], s22 offen offset:2048
  buffer_load_dwordx4 v[228:231], v2, s[8:11], s22 offen offset:3072
  s_add_u32 s22, s31, 352256
  buffer_load_dwordx4 v[232:235], v2, s[8:11], s22 offen offset:0
  buffer_load_dwordx4 v[236:239], v2, s[8:11], s22 offen offset:1024
  buffer_load_dwordx4 v[240:243], v2, s[8:11], s22 offen offset:2048
  buffer_load_dwordx4 v[244:247], v2, s[8:11], s22 offen offset:3072
  s_waitcnt vmcnt(24)
  s_add_u32 s22, s31, 356352
  buffer_load_dwordx4 v[248:251], v2, s[8:11], s22 offen offset:0
  buffer_load_dwordx4 v[252:255], v2, s[8:11], s22 offen offset:1024
  s_mov_b32 s24, 71565312
  s_mov_b32 s25, 0
  s_add_u32 m0, s25, 0
  s_nop 0
  buffer_load_dwordx4 v2, s[8:11], s24 offen offset:0 lds
  buffer_load_dwordx4 v2, s[8:11], s24 offen offset:1024 lds
  buffer_load_dwordx4 v2, s[8:11], s24 offen offset:2048 lds
  buffer_load_dwordx4 v2, s[8:11], s24 offen offset:3072 lds
  s_add_u32 m0, s25, 4096
  s_add_u32 s22, s24, 4096
  buffer_load_dwordx4 v2, s[8:11], s22 offen offset:0 lds
  buffer_load_dwordx4 v2, s[8:11], s22 offen offset:1024 lds
  buffer_load_dwordx4 v2, s[8:11], s22 offen offset:2048 lds
  v_and_b32 v64, 7, v117
  v_and_b32 v65, 1, v116
  v_lshlrev_b32 v65, 2, v65
  v_sub_u32 v64, v64, v65
  v_lshrrev_b32 v65, 3, v117
  v_lshl_add_u32 v66, v65, 2, v64
  v_cmp_gt_u32 vcc, 4, v64
  v_mov_b32 v67, 99
  s_nop 0
  v_cndmask_b32 v66, v67, v66, vcc
  v_mov_b32 v68, 0x3f80
  v_mov_b32 v69, 0x3f800000
  v_mov_b32 v4, 0
  v_cmp_eq_u32 vcc, 0, v66
  s_nop 1
  v_cndmask_b32 v4, v4, v68, vcc
  v_cmp_eq_u32 vcc, 1, v66
  s_nop 1
  v_cndmask_b32 v4, v4, v69, vcc
  v_mov_b32 v5, 0
  v_cmp_eq_u32 vcc, 2, v66
  s_nop 1
  v_cndmask_b32 v5, v5, v68, vcc
  v_cmp_eq_u32 vcc, 3, v66
  s_nop 1
  v_cndmask_b32 v5, v5, v69, vcc
  v_mov_b32 v6, 0
  v_cmp_eq_u32 vcc, 4, v66
  s_nop 1
  v_cndmask_b32 v6, v6, v68, vcc
  v_cmp_eq_u32 vcc, 5, v66
  s_nop 1
  v_cndmask_b32 v6, v6, v69, vcc
  v_mov_b32 v7, 0
  v_cmp_eq_u32 vcc, 6, v66
  s_nop 1
  v_cndmask_b32 v7, v7, v68, vcc
  v_cmp_eq_u32 vcc, 7, v66
  s_nop 1
  v_cndmask_b32 v7, v7, v69, vcc
  v_lshrrev_b32 v64, 1, v116
  v_lshrrev_b32 v65, 3, v117
  v_cmp_eq_u32 s[26:27], v64, v65
  v_and_b32 v66, 1, v116
  v_add_u32 v64, 0, v64
  v_lshrrev_b32 v67, 1, v116
  v_lshlrev_b32 v67, 8, v67
  v_lshl_add_u32 v67, v66, 9, v67
  v_lshl_add_u32 v67, v117, 4, v67
  v_add_u32 v112, 57344, v67
  v_and_b32 v68, 7, v117
  v_lshlrev_b32 v67, 8, v64
  v_lshl_add_u32 v67, v68, 5, v67
  v_lshl_add_u32 v67, v66, 4, v67
  v_add_u32 v113, 65536, v67
  v_lshrrev_b32 v64, 5, v1
  v_and_b32 v65, 31, v1
  v_lshrrev_b32 v66, 3, v65
  v_and_b32 v67, 7, v65
  v_and_b32 v68, 3, v67
  v_lshl_add_u32 v68, v66, 2, v68
  v_lshrrev_b32 v69, 2, v67
  v_lshl_add_u32 v68, v69, 4, v68
  v_lshlrev_b32 v69, 11, v64
  v_lshl_add_u32 v69, v68, 4, v69
  v_add_u32 v114, 57344, v69
  v_add_u32 v70, 0, v64
  v_lshlrev_b32 v69, 9, v66
  v_lshl_add_u32 v69, v70, 5, v69
  v_lshl_add_u32 v69, v67, 2, v69
  v_add_u32 v115, 65536, v69
  v_and_b32 v71, 1, v1
  v_cmp_eq_u32 s[38:39], 0, v71
  v_cmp_gt_u32 vcc, 8, v65
  s_or_b64 s[28:29], s[38:39], vcc
  v_lshrrev_b32 v72, 1, v67
  v_lshlrev_b32 v72, 2, v72
  v_lshl_add_u32 v72, v70, 4, v72
  s_lshl_b32 s22, s17, 9
  s_add_u32 s22, s22, 9216
  v_lshl_add_u32 v73, v66, 7, v72
  v_add_u32 v73, s22, v73
  s_lshl_b32 s22, s17, 7
  s_add_u32 s22, s22, 7168
  v_add_u32 v74, s22, v72
  v_bfe_u32 v72, v65, 1, 1
  v_lshlrev_b32 v72, 7, v72
  v_lshl_add_u32 v72, v70, 4, v72
  v_bfe_u32 v73, v65, 2, 2
  v_lshl_add_u32 v72, v73, 2, v72
  v_lshrrev_b32 v73, 4, v65
  v_lshl_add_u32 v73, v73, 8, v72
  s_lshl_b32 s22, s17, 9
  s_add_u32 s22, s22, 9216
  v_add_u32 v73, s22, v73
  s_lshr_b32 s22, s17, 1
  s_lshl_b32 s22, s22, 8
  s_and_b32 s34, s17, 1
  s_lshl_b32 s34, s34, 3
  s_add_u32 s22, s22, s34
  s_add_u32 s22, s22, 7168
  v_add_u32 v74, s22, v72
  v_lshlrev_b32 v0, 2, v65
  s_and_b32 s22, s17, 31
  s_lshl_b32 s22, s22, 7
  s_add_u32 s22, s22, 21504
  v_add_u32 v0, s22, v0
  v_cndmask_b32 v1, v74, v73, s[38:39]
  s_lshl_b32 s36, s17, 2
  s_add_u32 s36, s36, 17408
  s_mov_b32 s37, 0x3e800000
  v_mov_b32 v64, 0
  v_mov_b32 v65, 0
  v_mov_b32 v66, 0
  v_mov_b32 v67, 0
  v_mov_b32 v68, 0
  v_mov_b32 v69, 0
  v_mov_b32 v70, 0
  v_mov_b32 v71, 0
  v_mov_b32 v72, 0
  v_mov_b32 v73, 0
  v_mov_b32 v74, 0
  v_mov_b32 v75, 0
  v_mov_b32 v76, 0
  v_mov_b32 v77, 0
  v_mov_b32 v78, 0
  v_mov_b32 v79, 0
  v_mov_b32 v80, 0
  v_mov_b32 v81, 0
  v_mov_b32 v82, 0
  v_mov_b32 v83, 0
  v_mov_b32 v84, 0
  v_mov_b32 v85, 0
  v_mov_b32 v86, 0
  v_mov_b32 v87, 0
  v_mov_b32 v88, 0
  v_mov_b32 v89, 0
  v_mov_b32 v90, 0
  v_mov_b32 v91, 0
  v_mov_b32 v92, 0
  v_mov_b32 v93, 0
  v_mov_b32 v94, 0
  v_mov_b32 v95, 0
  v_mov_b32 v96, 0
  v_mov_b32 v97, 0
  v_mov_b32 v98, 0
  v_mov_b32 v99, 0
  v_mov_b32 v100, 0
  v_mov_b32 v101, 0
  v_mov_b32 v102, 0
  v_mov_b32 v103, 0
  v_mov_b32 v104, 0
  v_mov_b32 v105, 0
  v_mov_b32 v106, 0
  v_mov_b32 v107, 0
  v_mov_b32 v108, 0
  v_mov_b32 v109, 0
  v_mov_b32 v110, 0
  v_mov_b32 v111, 0
  v_mov_b32 v116, v2
  v_lshrrev_b32 v117, 4, v2
  v_min_u32 v117, 55, v117
  v_lshlrev_b32 v117, 7, v117
  s_mul_i32 s35, s17, 1835008
  s_add_u32 s35, s35, 42262528
  s_mov_b32 s30, 0
  v_mov_b32 v36, 0
ch_md0:
  buffer_load_dword v37, v36, s[12:15], 0 offen sc1
  s_waitcnt vmcnt(0)
  v_readfirstlane_b32 s22, v37
  s_and_b32 s31, s22, 0xffff
  s_cmp_ge_u32 s31, 32
  s_cbranch_scc1 ch_go0
  s_sleep 2
  s_add_u32 s30, s30, 1
  s_cmp_lt_u32 s30, 3200000
  s_cbranch_scc1 ch_md0
  s_branch ch_end
ch_go0:
  s_mov_b32 s31, 0
  s_lshr_b32 s22, s22, 16
  s_cmp_lg_u32 s22, 0
  s_cbranch_scc1 cB_sc0_loop
  s_branch cA_sc0_loop
ch_init1:
  s_mul_i32 s31, s17, 401408
  s_add_u32 s31, s31, 0
  s_add_u32 s22, s31, 57344
  buffer_load_dwordx4 a[0:3], v2, s[8:11], s22 offen offset:0
  buffer_load_dwordx4 a[4:7], v2, s[8:11], s22 offen offset:1024
  buffer_load_dwordx4 a[8:11], v2, s[8:11], s22 offen offset:2048
  buffer_load_dwordx4 a[12:15], v2, s[8:11], s22 offen offset:3072
  s_add_u32 s22, s31, 61440
  buffer_load_dwordx4 a[16:19], v2, s[8:11], s22 offen offset:0
  buffer_load_dwordx4 a[20:23], v2, s[8:11], s22 offen offset:1024
  buffer_load_dwordx4 a[24:27], v2, s[8:11], s22 offen offset:2048
  buffer_load_dwordx4 a[28:31], v2, s[8:11], s22 offen offset:3072
  s_add_u32 s22, s31, 65536
  buffer_load_dwordx4 a[32:35], v2, s[8:11], s22 offen offset:0
  buffer_load_dwordx4 a[36:39], v2, s[8:11], s22 offen offset:1024
  buffer_load_dwordx4 a[40:43], v2, s[8:11], s22 offen offset:2048
  buffer_load_dwordx4 a[44:47], v2, s[8:11], s22 offen offset:3072
  s_add_u32 s22, s31, 69632
  buffer_load_dwordx4 a[48:51], v2, s[8:11], s22 offen offset:0
  buffer_load_dwordx4 a[52:55], v2, s[8:11], s22 offen offset:1024
  buffer_load_dwordx4 a[56:59], v2, s[8:11], s22 offen offset:2048
  buffer_load_dwordx4 a[60:63], v2, s[8:11], s22 offen offset:3072
  s_add_u32 s22, s31, 73728
  buffer_load_dwordx4 a[64:67], v2, s[8:11], s22 offen offset:0
  buffer_load_dwordx4 a[68:71], v2, s[8:11], s22 offen offset:1024
  buffer_load_dwordx4 a[72:75], v2, s[8:11], s22 offen offset:2048
  buffer_load_dwordx4 a[76:79], v2, s[8:11], s22 offen offset:3072
  s_add_u32 s22, s31, 77824
  buffer_load_dwordx4 a[80:83], v2, s[8:11], s22 offen offset:0
  buffer_load_dwordx4 a[84:87], v2, s[8:11], s22 offen offset:1024
  buffer_load_dwordx4 a[88:91], v2, s[8:11], s22 offen offset:2048
  buffer_load_dwordx4 a[92:95], v2, s[8:11], s22 offen offset:3072
  s_add_u32 s22, s31, 81920
  buffer_load_dwordx4 a[96:99], v2, s[8:11], s22 offen offset:0
  buffer_load_dwordx4 a[100:103], v2, s[8:11], s22 offen offset:1024
  buffer_load_dwordx4 a[104:107], v2, s[8:11], s22 offen offset:2048
  buffer_load_dwordx4 a[108:111], v2, s[8:11], s22 offen offset:3072
  s_add_u32 s22, s31, 86016
  buffer_load_dwordx4 a[112:115], v2, s[8:11], s22 offen offset:0
  buffer_load_dwordx4 a[116:119], v2, s[8:11], s22 offen offset:1024
  buffer_load_dwordx4 a[120:123], v2, s[8:11], s22 offen offset:2048
  buffer_load_dwordx4 a[124:127], v2, s[8:11], s22 offen offset:3072
  s_waitcnt vmcnt(24)
  s_add_u32 s22, s31, 90112
  buffer_load_dwordx4 a[128:131], v2, s[8:11], s22 offen offset:0
  buffer_load_dwordx4 a[132:135], v2, s[8:11], s22 offen offset:1024
  buffer_load_dwordx4 a[136:139], v2, s[8:11], s22 offen offset:2048
  buffer_load_dwordx4 a[140:143], v2, s[8:11], s22 offen offset:3072
  s_add_u32 s22, s31, 94208
  buffer_load_dwordx4 a[144:147], v2, s[8:11], s22 offen offset:0
  buffer_load_dwordx4 a[148:151], v2, s[8:11], s22 offen offset:1024
  buffer_load_dwordx4 a[152:155], v2, s[8:11], s22 offen offset:2048
  buffer_load_dwordx4 a[156:159], v2, s[8:11], s22 offen offset:3072
  s_add_u32 s22, s31, 98304
  buffer_load_dwordx4 a[160:163], v2, s[8:11], s22 offen offset:0
  buffer_load_dwordx4 a[164:167], v2, s[8:11], s22 offen offset:1024
  buffer_load_dwordx4 a[168:171], v2, s[8:11], s22 offen offset:2048
  buffer_load_dwordx4 a[172:175], v2, s[8:11], s22 offen offset:3072
  s_add_u32 s22, s31, 102400
  buffer_load_dwordx4 a[176:179], v2, s[8:11], s22 offen offset:0
  buffer_load_dwordx4 a[180:183], v2, s[8:11], s22 offen offset:1024
  buffer_load_dwordx4 a[184:187], v2, s[8:11], s22 offen offset:2048
  buffer_load_dwordx4 a[188:191], v2, s[8:11], s22 offen offset:3072
  s_add_u32 s22, s31, 106496
  buffer_load_dwordx4 a[192:195], v2, s[8:11], s22 offen offset:0
  buffer_load_dwordx4 a[196:199], v2, s[8:11], s22 offen offset:1024
  buffer_load_dwordx4 a[200:203], v2, s[8:11], s22 offen offset:2048
  buffer_load_dwordx4 a[204:207], v2, s[8:11], s22 offen offset:3072
  s_add_u32 s22, s31, 110592
  buffer_load_dwordx4 a[208:211], v2, s[8:11], s22 offen offset:0
  buffer_load_dwordx4 a[212:215], v2, s[8:11], s22 offen offset:1024
  buffer_load_dwordx4 a[216:219], v2, s[8:11], s22 offen offset:2048
  buffer_load_dwordx4 a[220:223], v2, s[8:11], s22 offen offset:3072
  s_add_u32 s22, s31, 258048
  buffer_load_dwordx4 a[224:227], v2, s[8:11], s22 offen offset:0
  buffer_load_dwordx4 a[228:231], v2, s[8:11], s22 offen offset:1024
  buffer_load_dwordx4 a[232:235], v2, s[8:11], s22 offen offset:2048
  buffer_load_dwordx4 a[236:239], v2, s[8:11], s22 offen offset:3072
  s_add_u32 s22, s31, 262144
  buffer_load_dwordx4 a[240:243], v2, s[8:11], s22 offen offset:0
  buffer_load_dwordx4 a[244:247], v2, s[8:11], s22 offen offset:1024
  buffer_load_dwordx4 a[248:251], v2, s[8:11], s22 offen offset:2048
  buffer_load_dwordx4 a[252:255], v2, s[8:11], s22 offen offset:3072
  s_waitcnt vmcnt(24)
  s_add_u32 s22, s31, 266240
  buffer_load_dwordx4 v[120:123], v2, s[8:11], s22 offen offset:0
  buffer_load_dwordx4 v[124:127], v2, s[8:11], s22 offen offset:1024
  buffer_load_dwordx4 v[128:131], v2, s[8:11], s22 offen offset:2048
  buffer_load_dwordx4 v[132:135], v2, s[8:11], s22 offen offset:3072
  s_add_u32 s22, s31, 270336
  buffer_load_dwordx4 v[136:139], v2, s[8:11], s22 offen offset:0
  buffer_load_dwordx4 v[140:143], v2, s[8:11], s22 offen offset:1024
  buffer_load_dwordx4 v[144:147], v2, s[8:11], s22 offen offset:2048
  buffer_load_dwordx4 v[148:151], v2, s[8:11], s22 offen offset:3072
  s_add_u32 s22, s31, 274432
  buffer_load_dwordx4 v[152:155], v2, s[8:11], s22 offen offset:0
  buffer_load_dwordx4 v[156:159], v2, s[8:11], s22 offen offset:1024
  buffer_load_dwordx4 v[160:163], v2, s[8:11], s22 offen offset:2048
  buffer_load_dwordx4 v[164:167], v2, s[8:11], s22 offen offset:3072
  s_add_u32 s22, s31, 278528
  buffer_load_dwordx4 v[168:171], v2, s[8:11], s22 offen offset:0
  buffer_load_dwordx4 v[172:175], v2, s[8:11], s22 offen offset:1024
  buffer_load_dwordx4 v[176:179], v2, s[8:11], s22 offen offset:2048
  buffer_load_dwordx4 v[180:183], v2, s[8:11], s22 offen offset:3072
  s_add_u32 s22, s31, 282624
  buffer_load_dwordx4 v[184:187], v2, s[8:11], s22 offen offset:0
  buffer_load_dwordx4 v[188:191], v2, s[8:11], s22 offen offset:1024
  buffer_load_dwordx4 v[192:195], v2, s[8:11], s22 offen offset:2048
  buffer_load_dwordx4 v[196:199], v2, s[8:11], s22 offen offset:3072
  s_add_u32 s22, s31, 356352
  buffer_load_dwordx4 v[200:203], v2, s[8:11], s22 offen offset:2048
  buffer_load_dwordx4 v[204:207], v2, s[8:11], s22 offen offset:3072
  s_add_u32 s22, s31, 360448
  buffer_load_dwordx4 v[208:211], v2, s[8:11], s22 offen offset:0
  buffer_load_dwordx4 v[212:215], v2, s[8:11], s22 offen offset:1024
  buffer_load_dwordx4 v[216:219], v2, s[8:11], s22 offen offset:2048
  buffer_load_dwordx4 v[220:223], v2, s[8:11], s22 offen offset:3072
  s_add_u32 s22, s31, 364544
  buffer_load_dwordx4 v[224:227], v2, s[8:11], s22 offen offset:0
  buffer_load_dwordx4 v[228:231], v2, s[8:11], s22 offen offset:1024
  buffer_load_dwordx4 v[232:235], v2, s[8:11], s22 offen offset:2048
  buffer_load_dwordx4 v[236:239], v2, s[8:11], s22 offen offset:3072
  s_add_u32 s22, s31, 368640
  buffer_load_dwordx4 v[240:243], v2, s[8:11], s22 offen offset:0
  buffer_load_dwordx4 v[244:247], v2, s[8:11], s22 offen offset:1024
  s_waitcnt vmcnt(24)
  buffer_load_dwordx4 v[248:251], v2, s[8:11], s22 offen offset:2048
  buffer_load_dwordx4 v[252:255], v2, s[8:11], s22 offen offset:3072
  s_mov_b32 s24, 71572480
  s_mov_b32 s25, 0
  s_add_u32 m0, s25, 7168
  s_nop 0
  buffer_load_dwordx4 v2, s[8:11], s24 offen offset:0 lds
  buffer_load_dwordx4 v2, s[8:11], s24 offen offset:1024 lds
  buffer_load_dwordx4 v2, s[8:11], s24 offen offset:2048 lds
  buffer_load_dwordx4 v2, s[8:11], s24 offen offset:3072 lds
  s_add_u32 m0, s25, 11264
  s_add_u32 s22, s24, 4096
  buffer_load_dwordx4 v2, s[8:11], s22 offen offset:0 lds
  buffer_load_dwordx4 v2, s[8:11], s22 offen offset:1024 lds
  buffer_load_dwordx4 v2, s[8:11], s22 offen offset:2048 lds
  v_and_b32 v64, 7, v117
  v_and_b32 v65, 1, v116
  v_lshlrev_b32 v65, 2, v65
  v_sub_u32 v64, v64, v65
  v_lshrrev_b32 v65, 3, v117
  v_lshl_add_u32 v66, v65, 2, v64
  v_cmp_gt_u32 vcc, 4, v64
  v_mov_b32 v67, 99
  s_nop 0
  v_cndmask_b32 v66, v67, v66, vcc
  v_mov_b32 v68, 0x3f80
  v_mov_b32 v69, 0x3f800000
  v_mov_b32 v4, 0
  v_cmp_eq_u32 vcc, 0, v66
  s_nop 1
  v_cndmask_b32 v4, v4, v68, vcc
  v_cmp_eq_u32 vcc, 1, v66
  s_nop 1
  v_cndmask_b32 v4, v4, v69, vcc
  v_mov_b32 v5, 0
  v_cmp_eq_u32 vcc, 2, v66
  s_nop 1
  v_cndmask_b32 v5, v5, v68, vcc
  v_cmp_eq_u32 vcc, 3, v66
  s_nop 1
  v_cndmask_b32 v5, v5, v69, vcc
  v_mov_b32 v6, 0
  v_cmp_eq_u32 vcc, 4, v66
  s_nop 1
  v_cndmask_b32 v6, v6, v68, vcc
  v_cmp_eq_u32 vcc, 5, v66
  s_nop 1
  v_cndmask_b32 v6, v6, v69, vcc
  v_mov_b32 v7, 0
  v_cmp_eq_u32 vcc, 6, v66
  s_nop 1
  v_cndmask_b32 v7, v7, v68, vcc
  v_cmp_eq_u32 vcc, 7, v66
  s_nop 1
  v_cndmask_b32 v7, v7, v69, vcc
  v_lshrrev_b32 v64, 1, v116
  v_lshrrev_b32 v65, 3, v117
  v_cmp_eq_u32 s[26:27], v64, v65
  v_and_b32 v66, 1, v116
  v_add_u32 v64, 2, v64
  v_lshrrev_b32 v67, 1, v116
  v_lshlrev_b32 v67, 8, v67
  v_lshl_add_u32 v67, v66, 9, v67
  v_lshl_add_u32 v67, v117, 4, v67
  v_add_u32 v112, 58368, v67
  v_and_b32 v68, 7, v117
  v_lshlrev_b32 v67, 8, v64
  v_lshl_add_u32 v67, v68, 5, v67
  v_lshl_add_u32 v67, v66, 4, v67
  v_add_u32 v113, 65536, v67
  v_lshrrev_b32 v64, 5, v1
  v_and_b32 v65, 31, v1
  v_lshrrev_b32 v66, 3, v65
  v_and_b32 v67, 7, v65
  v_and_b32 v68, 3, v67
  v_lshl_add_u32 v68, v66, 2, v68
  v_lshrrev_b32 v69, 2, v67
  v_lshl_add_u32 v68, v69, 4, v68
  v_lshlrev_b32 v69, 11, v64
  v_lshl_add_u32 v69, v68, 4, v69
  v_add_u32 v114, 57352, v69
  v_add_u32 v70, 2, v64
  v_lshlrev_b32 v69, 9, v66
  v_lshl_add_u32 v69, v70, 5, v69
  v_lshl_add_u32 v69, v67, 2, v69
  v_add_u32 v115, 65536, v69
  v_and_b32 v71, 1, v1
  v_cmp_eq_u32 s[38:39], 0, v71
  v_cmp_gt_u32 vcc, 8, v65
  s_or_b64 s[28:29], s[38:39], vcc
  v_lshrrev_b32 v72, 1, v67
  v_lshlrev_b32 v72, 2, v72
  v_lshl_add_u32 v72, v70, 4, v72
  s_lshl_b32 s22, s17, 9
  s_add_u32 s22, s22, 9216
  v_lshl_add_u32 v73, v66, 7, v72
  v_add_u32 v73, s22, v73
  s_lshl_b32 s22, s17, 7
  s_add_u32 s22, s22, 7168
  v_add_u32 v74, s22, v72
  v_bfe_u32 v72, v65, 1, 1
  v_lshlrev_b32 v72, 7, v72
  v_lshl_add_u32 v72, v70, 4, v72
  v_bfe_u32 v73, v65, 2, 2
  v_lshl_add_u32 v72, v73, 2, v72
  v_lshrrev_b32 v73, 4, v65
  v_lshl_add_u32 v73, v73, 8, v72
  s_lshl_b32 s22, s17, 9
  s_add_u32 s22, s22, 9216
  v_add_u32 v73, s22, v73
  s_lshr_b32 s22, s17, 1
  s_lshl_b32 s22, s22, 8
  s_and_b32 s34, s17, 1
  s_lshl_b32 s34, s34, 3
  s_add_u32 s22, s22, s34
  s_add_u32 s22, s22, 7168
  v_add_u32 v74, s22, v72
  v_lshlrev_b32 v0, 2, v65
  s_and_b32 s22, s17, 31
  s_lshl_b32 s22, s22, 7
  s_add_u32 s22, s22, 21504
  v_add_u32 v0, s22, v0
  v_cndmask_b32 v1, v74, v73, s[38:39]
  s_lshl_b32 s36, s17, 2
  s_add_u32 s36, s36, 17408
  s_mov_b32 s37, 0x3e800000
  v_mov_b32 v64, 0
  v_mov_b32 v65, 0
  v_mov_b32 v66, 0
  v_mov_b32 v67, 0
  v_mov_b32 v68, 0
  v_mov_b32 v69, 0
  v_mov_b32 v70, 0
  v_mov_b32 v71, 0
  v_mov_b32 v72, 0
  v_mov_b32 v73, 0
  v_mov_b32 v74, 0
  v_mov_b32 v75, 0
  v_mov_b32 v76, 0
  v_mov_b32 v77, 0
  v_mov_b32 v78, 0
  v_mov_b32 v79, 0
  v_mov_b32 v80, 0
  v_mov_b32 v81, 0
  v_mov_b32 v82, 0
  v_mov_b32 v83, 0
  v_mov_b32 v84, 0
  v_mov_b32 v85, 0
  v_mov_b32 v86, 0
  v_mov_b32 v87, 0
  v_mov_b32 v88, 0
  v_mov_b32 v89, 0
  v_mov_b32 v90, 0
  v_mov_b32 v91, 0
  v_mov_b32 v92, 0
  v_mov_b32 v93, 0
  v_mov_b32 v94, 0
  v_mov_b32 v95, 0
  v_mov_b32 v96, 0
  v_mov_b32 v97, 0
  v_mov_b32 v98, 0
  v_mov_b32 v99, 0
  v_mov_b32 v100, 0
  v_mov_b32 v101, 0
  v_mov_b32 v102, 0
  v_mov_b32 v103, 0
  v_mov_b32 v104, 0
  v_mov_b32 v105, 0
  v_mov_b32 v106, 0
  v_mov_b32 v107, 0
  v_mov_b32 v108, 0
  v_mov_b32 v109, 0
  v_mov_b32 v110, 0
  v_mov_b32 v111, 0
  v_mov_b32 v116, v2
  v_lshrrev_b32 v117, 4, v2
  v_min_u32 v117, 55, v117
  v_lshlrev_b32 v117, 7, v117
  v_lshrrev_b32 v0, 4, v2
  v_min_u32 v0, 12, v0
  s_mul_i32 s22, s17, 13
  v_add_u32 v0, s22, v0
  v_lshlrev_b32 v0, 7, v0
  v_add_u32 v0, 51200, v0
  s_mov_b32 s22, 75209728
  buffer_load_dword v119, v0, s[8:11], s22 offen sc1
  s_mov_b32 s22, 75184128
  buffer_load_dword v119, v0, s[8:11], s22 offen sc1
  s_mul_i32 s35, s17, 1835008
  s_add_u32 s35, s35, 42269696
  s_mov_b32 s30, 0
  v_mov_b32 v36, 0
ch_md1:
  buffer_load_dword v37, v36, s[12:15], 0 offen sc1
  s_waitcnt vmcnt(0)
  v_readfirstlane_b32 s22, v37
  s_and_b32 s31, s22, 0xffff
  s_cmp_ge_u32 s31, 32
  s_cbranch_scc1 ch_go1
  s_sleep 2
  s_add_u32 s30, s30, 1
  s_cmp_lt_u32 s30, 3200000
  s_cbranch_scc1 ch_md1
  s_branch ch_end
ch_go1:
  s_mov_b32 s31, 0
  s_lshr_b32 s22, s22, 16
  s_cmp_lg_u32 s22, 0
  s_cbranch_scc1 cB_sc1_loop
  s_branch cA_sc1_loop
ch_init2:
  s_mul_i32 s31, s17, 401408
  s_add_u32 s31, s31, 0
  s_add_u32 s22, s31, 114688
  buffer_load_dwordx4 a[0:3], v2, s[8:11], s22 offen offset:0
  buffer_load_dwordx4 a[4:7], v2, s[8:11], s22 offen offset:1024
  buffer_load_dwordx4 a[8:11], v2, s[8:11], s22 offen offset:2048
  buffer_load_dwordx4 a[12:15], v2, s[8:11], s22 offen offset:3072
  s_add_u32 s22, s31, 118784
  buffer_load_dwordx4 a[16:19], v2, s[8:11], s22 offen offset:0
  buffer_load_dwordx4 a[20:23], v2, s[8:11], s22 offen offset:1024
  buffer_load_dwordx4 a[24:27], v2, s[8:11], s22 offen offset:2048
  buffer_load_dwordx4 a[28:31], v2, s[8:11], s22 offen offset:3072
  s_add_u32 s22, s31, 122880
  buffer_load_dwordx4 a[32:35], v2, s[8:11], s22 offen offset:0
  buffer_load_dwordx4 a[36:39], v2, s[8:11], s22 offen offset:1024
  buffer_load_dwordx4 a[40:43], v2, s[8:11], s22 offen offset:2048
  buffer_load_dwordx4 a[44:47], v2, s[8:11], s22 offen offset:3072
  s_add_u32 s22, s31, 126976
  buffer_load_dwordx4 a[48:51], v2, s[8:11], s22 offen offset:0
  buffer_load_dwordx4 a[52:55], v2, s[8:11], s22 offen offset:1024
  buffer_load_dwordx4 a[56:59], v2, s[8:11], s22 offen offset:2048
  buffer_load_dwordx4 a[60:63], v2, s[8:11], s22 offen offset:3072
  s_add_u32 s22, s31, 131072
  buffer_load_dwordx4 a[64:67], v2, s[8:11], s22 offen offset:0
  buffer_load_dwordx4 a[68:71], v2, s[8:11], s22 offen offset:1024
  buffer_load_dwordx4 a[72:75], v2, s[8:11], s22 offen offset:2048
  buffer_load_dwordx4 a[76:79], v2, s[8:11], s22 offen offset:3072
  s_add_u32 s22, s31, 135168
  buffer_load_dwordx4 a[80:83], v2, s[8:11], s22 offen offset:0
  buffer_load_dwordx4 a[84:87], v2, s[8:11], s22 offen offset:1024
  buffer_load_dwordx4 a[88:91], v2, s[8:11], s22 offen offset:2048
  buffer_load_dwordx4 a[92:95], v2, s[8:11], s22 offen offset:3072
  s_add_u32 s22, s31, 139264
  buffer_load_dwordx4 a[96:99], v2, s[8:11], s22 offen offset:0
  buffer_load_dwordx4 a[100:103], v2, s[8:11], s22 offen offset:1024
  buffer_load_dwordx4 a[104:107], v2, s[8:11], s22 offen offset:2048
  buffer_load_dwordx4 a[108:111], v2, s[8:11], s22 offen offset:3072
  s_add_u32 s22, s31, 143360
  buffer_load_dwordx4 a[112:115], v2, s[8:11], s22 offen offset:0
  buffer_load_dwordx4 a[116:119], v2, s[8:11], s22 offen offset:1024
  buffer_load_dwordx4 a[120:123], v2, s[8:11], s22 offen offset:2048
  buffer_load_dwordx4 a[124:127], v2, s[8:11], s22 offen offset:3072
  s_waitcnt vmcnt(24)
  s_add_u32 s22, s31, 147456
  buffer_load_dwordx4 a[128:131], v2, s[8:11], s22 offen offset:0
  buffer_load_dwordx4 a[132:135], v2, s[8:11], s22 offen offset:1024
  buffer_load_dwordx4 a[136:139], v2, s[8:11], s22 offen offset:2048
  buffer_load_dwordx4 a[140:143], v2, s[8:11], s22 offen offset:3072
  s_add_u32 s22, s31, 151552
  buffer_load_dwordx4 a[144:147], v2, s[8:11], s22 offen offset:0
  buffer_load_dwordx4 a[148:151], v2, s[8:11], s22 offen offset:1024
  buffer_load_dwordx4 a[152:155], v2, s[8:11], s22 offen offset:2048
  buffer_load_dwordx4 a[156:159], v2, s[8:11], s22 offen offset:3072
  s_add_u32 s22, s31, 155648
  buffer_load_dwordx4 a[160:163], v2, s[8:11], s22 offen offset:0
  buffer_load_dwordx4 a[164:167], v2, s[8:11], s22 offen offset:1024
  buffer_load_dwordx4 a[168:171], v2, s[8:11], s22 offen offset:2048
  buffer_load_dwordx4 a[172:175], v2, s[8:11], s22 offen offset:3072
  s_add_u32 s22, s31, 159744
  buffer_load_dwordx4 a[176:179], v2, s[8:11], s22 offen offset:0
  buffer_load_dwordx4 a[180:183], v2, s[8:11], s22 offen offset:1024
  buffer_load_dwordx4 a[184:187], v2, s[8:11], s22 offen offset:2048
  buffer_load_dwordx4 a[188:191], v2, s[8:11], s22 offen offset:3072
  s_add_u32 s22, s31, 163840
  buffer_load_dwordx4 a[192:195], v2, s[8:11], s22 offen offset:0
  buffer_load_dwordx4 a[196:199], v2, s[8:11], s22 offen offset:1024
  buffer_load_dwordx4 a[200:203], v2, s[8:11], s22 offen offset:2048
  buffer_load_dwordx4 a[204:207], v2, s[8:11], s22 offen offset:3072
  s_add_u32 s22, s31, 167936
  buffer_load_dwordx4 a[208:211], v2, s[8:11], s22 offen offset:0
  buffer_load_dwordx4 a[212:215], v2, s[8:11], s22 offen offset:1024
  buffer_load_dwordx4 a[216:219], v2, s[8:11], s22 offen offset:2048
  buffer_load_dwordx4 a[220:223], v2, s[8:11], s22 offen offset:3072
  s_add_u32 s22, s31, 286720
  buffer_load_dwordx4 a[224:227], v2, s[8:11], s22 offen offset:0
  buffer_load_dwordx4 a[228:231], v2, s[8:11], s22 offen offset:1024
  buffer_load_dwordx4 a[232:235], v2, s[8:11], s22 offen offset:2048
  buffer_load_dwordx4 a[236:239], v2, s[8:11], s22 offen offset:3072
  s_add_u32 s22, s31, 290816
  buffer_load_dwordx4 a[240:243], v2, s[8:11], s22 offen offset:0
  buffer_load_dwordx4 a[244:247], v2, s[8:11], s22 offen offset:1024
  buffer_load_dwordx4 a[248:251], v2, s[8:11], s22 offen offset:2048
  buffer_load_dwordx4 a[252:255], v2, s[8:11], s22 offen offset:3072
  s_waitcnt vmcnt(24)
  s_add_u32 s22, s31, 294912
  buffer_load_dwordx4 v[120:123], v2, s[8:11], s22 offen offset:0
  buffer_load_dwordx4 v[124:127], v2, s[8:11], s22 offen offset:1024
  buffer_load_dwordx4 v[128:131], v2, s[8:11], s22 offen offset:2048
  buffer_load_dwordx4 v[132:135], v2, s[8:11], s22 offen offset:3072
  s_add_u32 s22, s31, 299008
  buffer_load_dwordx4 v[136:139], v2, s[8:11], s22 offen offset:0
  buffer_load_dwordx4 v[140:143], v2, s[8:11], s22 offen offset:1024
  buffer_load_dwordx4 v[144:147], v2, s[8:11], s22 offen offset:2048
  buffer_load_dwordx4 v[148:151], v2, s[8:11], s22 offen offset:3072
  s_add_u32 s22, s31, 303104
  buffer_load_dwordx4 v[152:155], v2, s[8:11], s22 offen offset:0
  buffer_load_dwordx4 v[156:159], v2, s[8:11], s22 offen offset:1024
  buffer_load_dwordx4 v[160:163], v2, s[8:11], s22 offen offset:2048
  buffer_load_dwordx4 v[164:167], v2, s[8:11], s22 offen offset:3072
  s_add_u32 s22, s31, 307200
  buffer_load_dwordx4 v[168:171], v2, s[8:11], s22 offen offset:0
  buffer_load_dwordx4 v[172:175], v2, s[8:11], s22 offen offset:1024
  buffer_load_dwordx4 v[176:179], v2, s[8:11], s22 offen offset:2048
  buffer_load_dwordx4 v[180:183], v2, s[8:11], s22 offen offset:3072
  s_add_u32 s22, s31, 311296
  buffer_load_dwordx4 v[184:187], v2, s[8:11], s22 offen offset:0
  buffer_load_dwordx4 v[188:191], v2, s[8:11], s22 offen offset:1024
  buffer_load_dwordx4 v[192:195], v2, s[8:11], s22 offen offset:2048
  buffer_load_dwordx4 v[196:199], v2, s[8:11], s22 offen offset:3072
  s_add_u32 s22, s31, 372736
  buffer_load_dwordx4 v[200:203], v2, s[8:11], s22 offen offset:0
  buffer_load_dwordx4 v[204:207], v2, s[8:11], s22 offen offset:1024
  buffer_load_dwordx4 v[208:211], v2, s[8:11], s22 offen offset:2048
  buffer_load_dwordx4 v[212:215], v2, s[8:11], s22 offen offset:3072
  s_add_u32 s22, s31, 376832
  buffer_load_dwordx4 v[216:219], v2, s[8:11], s22 offen offset:0
  buffer_load_dwordx4 v[220:223], v2, s[8:11], s22 offen offset:1024
  buffer_load_dwordx4 v[224:227], v2, s[8:11], s22 offen offset:2048
  buffer_load_dwordx4 v[228:231], v2, s[8:11], s22 offen offset:3072
  s_add_u32 s22, s31, 380928
  buffer_load_dwordx4 v[232:235], v2, s[8:11], s22 offen offset:0
  buffer_load_dwordx4 v[236:239], v2, s[8:11], s22 offen offset:1024
  buffer_load_dwordx4 v[240:243], v2, s[8:11], s22 offen offset:2048
  buffer_load_dwordx4 v[244:247], v2, s[8:11], s22 offen offset:3072
  s_waitcnt vmcnt(24)
  s_add_u32 s22, s31, 385024
  buffer_load_dwordx4 v[248:251], v2, s[8:11], s22 offen offset:0
  buffer_load_dwordx4 v[252:255], v2, s[8:11], s22 offen offset:1024
  s_mov_b32 s24, 71579648
  s_mov_b32 s25, 0
  s_add_u32 m0, s25, 14336
  s_nop 0
  buffer_load_dwordx4 v2, s[8:11], s24 offen offset:0 lds
  buffer_load_dwordx4 v2, s[8:11], s24 offen offset:1024 lds
  buffer_load_dwordx4 v2, s[8:11], s24 offen offset:2048 lds
  buffer_load_dwordx4 v2, s[8:11], s24 offen offset:3072 lds
  s_add_u32 m0, s25, 18432
  s_add_u32 s22, s24, 4096
  buffer_load_dwordx4 v2, s[8:11], s22 offen offset:0 lds
  buffer_load_dwordx4 v2, s[8:11], s22 offen offset:1024 lds
  buffer_load_dwordx4 v2, s[8:11], s22 offen offset:2048 lds
  v_and_b32 v64, 7, v117
  v_and_b32 v65, 1, v116
  v_lshlrev_b32 v65, 2, v65
  v_sub_u32 v64, v64, v65
  v_lshrrev_b32 v65, 3, v117
  v_lshl_add_u32 v66, v65, 2, v64
  v_cmp_gt_u32 vcc, 4, v64
  v_mov_b32 v67, 99
  s_nop 0
  v_cndmask_b32 v66, v67, v66, vcc
  v_mov_b32 v68, 0x3f80
  v_mov_b32 v69, 0x3f800000
  v_mov_b32 v4, 0
  v_cmp_eq_u32 vcc, 0, v66
  s_nop 1
  v_cndmask_b32 v4, v4, v68, vcc
  v_cmp_eq_u32 vcc, 1, v66
  s_nop 1
  v_cndmask_b32 v4, v4, v69, vcc
  v_mov_b32 v5, 0
  v_cmp_eq_u32 vcc, 2, v66
  s_nop 1
  v_cndmask_b32 v5, v5, v68, vcc
  v_cmp_eq_u32 vcc, 3, v66
  s_nop 1
  v_cndmask_b32 v5, v5, v69, vcc
  v_mov_b32 v6, 0
  v_cmp_eq_u32 vcc, 4, v66
  s_nop 1
  v_cndmask_b32 v6, v6, v68, vcc
  v_cmp_eq_u32 vcc, 5, v66
  s_nop 1
  v_cndmask_b32 v6, v6, v69, vcc
  v_mov_b32 v7, 0
  v_cmp_eq_u32 vcc, 6, v66
  s_nop 1
  v_cndmask_b32 v7, v7, v68, vcc
  v_cmp_eq_u32 vcc, 7, v66
  s_nop 1
  v_cndmask_b32 v7, v7, v69, vcc
  v_lshrrev_b32 v64, 1, v116
  v_lshrrev_b32 v65, 3, v117
  v_cmp_eq_u32 s[26:27], v64, v65
  v_and_b32 v66, 1, v116
  v_add_u32 v64, 4, v64
  v_lshrrev_b32 v67, 1, v116
  v_lshlrev_b32 v67, 8, v67
  v_lshl_add_u32 v67, v66, 9, v67
  v_lshl_add_u32 v67, v117, 4, v67
  v_add_u32 v112, 59392, v67
  v_and_b32 v68, 7, v117
  v_lshlrev_b32 v67, 8, v64
  v_lshl_add_u32 v67, v68, 5, v67
  v_lshl_add_u32 v67, v66, 4, v67
  v_add_u32 v113, 65536, v67
  v_lshrrev_b32 v64, 5, v1
  v_and_b32 v65, 31, v1
  v_lshrrev_b32 v66, 3, v65
  v_and_b32 v67, 7, v65
  v_and_b32 v68, 3, v67
  v_lshl_add_u32 v68, v66, 2, v68
  v_lshrrev_b32 v69, 2, v67
  v_lshl_add_u32 v68, v69, 4, v68
  v_lshlrev_b32 v69, 11, v64
  v_lshl_add_u32 v69, v68, 4, v69
  v_add_u32 v114, 57856, v69
  v_add_u32 v70, 4, v64
  v_lshlrev_b32 v69, 9, v66
  v_lshl_add_u32 v69, v70, 5, v69
  v_lshl_add_u32 v69, v67, 2, v69
  v_add_u32 v115, 65536, v69
  v_and_b32 v71, 1, v1
  v_cmp_eq_u32 s[38:39], 0, v71
  v_cmp_gt_u32 vcc, 8, v65
  s_or_b64 s[28:29], s[38:39], vcc
  v_lshrrev_b32 v72, 1, v67
  v_lshlrev_b32 v72, 2, v72
  v_lshl_add_u32 v72, v70, 4, v72
  s_lshl_b32 s22, s17, 9
  s_add_u32 s22, s22, 9216
  v_lshl_add_u32 v73, v66, 7, v72
  v_add_u32 v73, s22, v73
  s_lshl_b32 s22, s17, 7
  s_add_u32 s22, s22, 7168
  v_add_u32 v74, s22, v72
  v_bfe_u32 v72, v65, 1, 1
  v_lshlrev_b32 v72, 7, v72
  v_lshl_add_u32 v72, v70, 4, v72
  v_bfe_u32 v73, v65, 2, 2
  v_lshl_add_u32 v72, v73, 2, v72
  v_lshrrev_b32 v73, 4, v65
  v_lshl_add_u32 v73, v73, 8, v72
  s_lshl_b32 s22, s17, 9
  s_add_u32 s22, s22, 9216
  v_add_u32 v73, s22, v73
  s_lshr_b32 s22, s17, 1
  s_lshl_b32 s22, s22, 8
  s_and_b32 s34, s17, 1
  s_lshl_b32 s34, s34, 3
  s_add_u32 s22, s22, s34
  s_add_u32 s22, s22, 7168
  v_add_u32 v74, s22, v72
  v_lshlrev_b32 v0, 2, v65
  s_and_b32 s22, s17, 31
  s_lshl_b32 s22, s22, 7
  s_add_u32 s22, s22, 21504
  v_add_u32 v0, s22, v0
  v_cndmask_b32 v1, v74, v73, s[38:39]
  s_lshl_b32 s36, s17, 2
  s_add_u32 s36, s36, 17408
  s_mov_b32 s37, 0x3e800000
  v_mov_b32 v64, 0
  v_mov_b32 v65, 0
  v_mov_b32 v66, 0
  v_mov_b32 v67, 0
  v_mov_b32 v68, 0
  v_mov_b32 v69, 0
  v_mov_b32 v70, 0
  v_mov_b32 v71, 0
  v_mov_b32 v72, 0
  v_mov_b32 v73, 0
  v_mov_b32 v74, 0
  v_mov_b32 v75, 0
  v_mov_b32 v76, 0
  v_mov_b32 v77, 0
  v_mov_b32 v78, 0
  v_mov_b32 v79, 0
  v_mov_b32 v80, 0
  v_mov_b32 v81, 0
  v_mov_b32 v82, 0
  v_mov_b32 v83, 0
  v_mov_b32 v84, 0
  v_mov_b32 v85, 0
  v_mov_b32 v86, 0
  v_mov_b32 v87, 0
  v_mov_b32 v88, 0
  v_mov_b32 v89, 0
  v_mov_b32 v90, 0
  v_mov_b32 v91, 0
  v_mov_b32 v92, 0
  v_mov_b32 v93, 0
  v_mov_b32 v94, 0
  v_mov_b32 v95, 0
  v_mov_b32 v96, 0
  v_mov_b32 v97, 0
  v_mov_b32 v98, 0
  v_mov_b32 v99, 0
  v_mov_b32 v100, 0
  v_mov_b32 v101, 0
  v_mov_b32 v102, 0
  v_mov_b32 v103, 0
  v_mov_b32 v104, 0
  v_mov_b32 v105, 0
  v_mov_b32 v106, 0
  v_mov_b32 v107, 0
  v_mov_b32 v108, 0
  v_mov_b32 v109, 0
  v_mov_b32 v110, 0
  v_mov_b32 v111, 0
  v_mov_b32 v116, v2
  v_lshrrev_b32 v117, 4, v2
  v_min_u32 v117, 55, v117
  v_lshlrev_b32 v117, 7, v117
  v_lshrrev_b32 v0, 4, v2
  v_min_u32 v0, 13, v0
  s_mul_i32 s22, s17, 14
  v_add_u32 v0, s22, v0
  v_lshlrev_b32 v0, 7, v0
  v_add_u32 v0, 43008, v0
  s_mov_b32 s22, 71550976
  buffer_load_dword v119, v0, s[8:11], s22 offen sc1
  s_mov_b32 s22, 71522304
  buffer_load_dword v119, v0, s[8:11], s22 offen sc1
  s_mul_i32 s35, s17, 1835008
  s_add_u32 s35, s35, 42276864
  s_mov_b32 s30, 0
  v_mov_b32 v36, 0
ch_md2:
  buffer_load_dword v37, v36, s[12:15], 0 offen sc1
  s_waitcnt vmcnt(0)
  v_readfirstlane_b32 s22, v37
  s_and_b32 s31, s22, 0xffff
  s_cmp_ge_u32 s31, 32
  s_cbranch_scc1 ch_go2
  s_sleep 2
  s_add_u32 s30, s30, 1
  s_cmp_lt_u32 s30, 3200000
  s_cbranch_scc1 ch_md2
  s_branch ch_end
ch_go2:
  s_mov_b32 s31, 0
  s_lshr_b32 s22, s22, 16
  s_cmp_lg_u32 s22, 0
  s_cbranch_scc1 cB_sc2_loop
  s_branch cA_sc2_loop
ch_init3:
  s_mul_i32 s31, s17, 401408
  s_add_u32 s31, s31, 0
  s_add_u32 s22, s31, 172032
  buffer_load_dwordx4 a[0:3], v2, s[8:11], s22 offen offset:0
  buffer_load_dwordx4 a[4:7], v2, s[8:11], s22 offen offset:1024
  buffer_load_dwordx4 a[8:11], v2, s[8:11], s22 offen offset:2048
  buffer_load_dwordx4 a[12:15], v2, s[8:11], s22 offen offset:3072
  s_add_u32 s22, s31, 176128
  buffer_load_dwordx4 a[16:19], v2, s[8:11], s22 offen offset:0
  buffer_load_dwordx4 a[20:23], v2, s[8:11], s22 offen offset:1024
  buffer_load_dwordx4 a[24:27], v2, s[8:11], s22 offen offset:2048
  buffer_load_dwordx4 a[28:31], v2, s[8:11], s22 offen offset:3072
  s_add_u32 s22, s31, 180224
  buffer_load_dwordx4 a[32:35], v2, s[8:11], s22 offen offset:0
  buffer_load_dwordx4 a[36:39], v2, s[8:11], s22 offen offset:1024
  buffer_load_dwordx4 a[40:43], v2, s[8:11], s22 offen offset:2048
  buffer_load_dwordx4 a[44:47], v2, s[8:11], s22 offen offset:3072
  s_add_u32 s22, s31, 184320
  buffer_load_dwordx4 a[48:51], v2, s[8:11], s22 offen offset:0
  buffer_load_dwordx4 a[52:55], v2, s[8:11], s22 offen offset:1024
  buffer_load_dwordx4 a[56:59], v2, s[8:11], s22 offen offset:2048
  buffer_load_dwordx4 a[60:63], v2, s[8:11], s22 offen offset:3072
  s_add_u32 s22, s31, 188416
  buffer_load_dwordx4 a[64:67], v2, s[8:11], s22 offen offset:0
  buffer_load_dwordx4 a[68:71], v2, s[8:11], s22 offen offset:1024
  buffer_load_dwordx4 a[72:75], v2, s[8:11], s22 offen offset:2048
  buffer_load_dwordx4 a[76:79], v2, s[8:11], s22 offen offset:3072
  s_add_u32 s22, s31, 192512
  buffer_load_dwordx4 a[80:83], v2, s[8:11], s22 offen offset:0
  buffer_load_dwordx4 a[84:87], v2, s[8:11], s22 offen offset:1024
  buffer_load_dwordx4 a[88:91], v2, s[8:11], s22 offen offset:2048
  buffer_load_dwordx4 a[92:95], v2, s[8:11], s22 offen offset:3072
  s_add_u32 s22, s31, 196608
  buffer_load_dwordx4 a[96:99], v2, s[8:11], s22 offen offset:0
  buffer_load_dwordx4 a[100:103], v2, s[8:11], s22 offen offset:1024
  buffer_load_dwordx4 a[104:107], v2, s[8:11], s22 offen offset:2048
  buffer_load_dwordx4 a[108:111], v2, s[8:11], s22 offen offset:3072
  s_add_u32 s22, s31, 200704
  buffer_load_dwordx4 a[112:115], v2, s[8:11], s22 offen offset:0
  buffer_load_dwordx4 a[116:119], v2, s[8:11], s22 offen offset:1024
  buffer_load_dwordx4 a[120:123], v2, s[8:11], s22 offen offset:2048
  buffer_load_dwordx4 a[124:127], v2, s[8:11], s22 offen offset:3072
  s_waitcnt vmcnt(24)
  s_add_u32 s22, s31, 204800
  buffer_load_dwordx4 a[128:131], v2, s[8:11], s22 offen offset:0
  buffer_load_dwordx4 a[132:135], v2, s[8:11], s22 offen offset:1024
  buffer_load_dwordx4 a[136:139], v2, s[8:11], s22 offen offset:2048
  buffer_load_dwordx4 a[140:143], v2, s[8:11], s22 offen offset:3072
  s_add_u32 s22, s31, 208896
  buffer_load_dwordx4 a[144:147], v2, s[8:11], s22 offen offset:0
  buffer_load_dwordx4 a[148:151], v2, s[8:11], s22 offen offset:1024
  buffer_load_dwordx4 a[152:155], v2, s[8:11], s22 offen offset:2048
  buffer_load_dwordx4 a[156:159], v2, s[8:11], s22 offen offset:3072
  s_add_u32 s22, s31, 212992
  buffer_load_dwordx4 a[160:163], v2, s[8:11], s22 offen offset:0
  buffer_load_dwordx4 a[164:167], v2, s[8:11], s22 offen offset:1024
  buffer_load_dwordx4 a[168:171], v2, s[8:11], s22 offen offset:2048
  buffer_load_dwordx4 a[172:175], v2, s[8:11], s22 offen offset:3072
  s_add_u32 s22, s31, 217088
  buffer_load_dwordx4 a[176:179], v2, s[8:11], s22 offen offset:0
  buffer_load_dwordx4 a[180:183], v2, s[8:11], s22 offen offset:1024
  buffer_load_dwordx4 a[184:187], v2, s[8:11], s22 offen offset:2048
  buffer_load_dwordx4 a[188:191], v2, s[8:11], s22 offen offset:3072
  s_add_u32 s22, s31, 221184
  buffer_load_dwordx4 a[192:195], v2, s[8:11], s22 offen offset:0
  buffer_load_dwordx4 a[196:199], v2, s[8:11], s22 offen offset:1024
  buffer_load_dwordx4 a[200:203], v2, s[8:11], s22 offen offset:2048
  buffer_load_dwordx4 a[204:207], v2, s[8:11], s22 offen offset:3072
  s_add_u32 s22, s31, 225280
  buffer_load_dwordx4 a[208:211], v2, s[8:11], s22 offen offset:0
  buffer_load_dwordx4 a[212:215], v2, s[8:11], s22 offen offset:1024
  buffer_load_dwordx4 a[216:219], v2, s[8:11], s22 offen offset:2048
  buffer_load_dwordx4 a[220:223], v2, s[8:11], s22 offen offset:3072
  s_add_u32 s22, s31, 315392
  buffer_load_dwordx4 a[224:227], v2, s[8:11], s22 offen offset:0
  buffer_load_dwordx4 a[228:231], v2, s[8:11], s22 offen offset:1024
  buffer_load_dwordx4 a[232:235], v2, s[8:11], s22 offen offset:2048
  buffer_load_dwordx4 a[236:239], v2, s[8:11], s22 offen offset:3072
  s_add_u32 s22, s31, 319488
  buffer_load_dwordx4 a[240:243], v2, s[8:11], s22 offen offset:0
  buffer_load_dwordx4 a[244:247], v2, s[8:11], s22 offen offset:1024
  buffer_load_dwordx4 a[248:251], v2, s[8:11], s22 offen offset:2048
  buffer_load_dwordx4 a[252:255], v2, s[8:11], s22 offen offset:3072
  s_waitcnt vmcnt(24)
  s_add_u32 s22, s31, 323584
  buffer_load_dwordx4 v[120:123], v2, s[8:11], s22 offen offset:0
  buffer_load_dwordx4 v[124:127], v2, s[8:11], s22 offen offset:1024
  buffer_load_dwordx4 v[128:131], v2, s[8:11], s22 offen offset:2048
  buffer_load_dwordx4 v[132:135], v2, s[8:11], s22 offen offset:3072
  s_add_u32 s22, s31, 327680
  buffer_load_dwordx4 v[136:139], v2, s[8:11], s22 offen offset:0
  buffer_load_dwordx4 v[140:143], v2, s[8:11], s22 offen offset:1024
  buffer_load_dwordx4 v[144:147], v2, s[8:11], s22 offen offset:2048
  buffer_load_dwordx4 v[148:151], v2, s[8:11], s22 offen offset:3072
  s_add_u32 s22, s31, 331776
  buffer_load_dwordx4 v[152:155], v2, s[8:11], s22 offen offset:0
  buffer_load_dwordx4 v[156:159], v2, s[8:11], s22 offen offset:1024
  buffer_load_dwordx4 v[160:163], v2, s[8:11], s22 offen offset:2048
  buffer_load_dwordx4 v[164:167], v2, s[8:11], s22 offen offset:3072
  s_add_u32 s22, s31, 335872
  buffer_load_dwordx4 v[168:171], v2, s[8:11], s22 offen offset:0
  buffer_load_dwordx4 v[172:175], v2, s[8:11], s22 offen offset:1024
  buffer_load_dwordx4 v[176:179], v2, s[8:11], s22 offen offset:2048
  buffer_load_dwordx4 v[180:183], v2, s[8:11], s22 offen offset:3072
  s_add_u32 s22, s31, 339968
  buffer_load_dwordx4 v[184:187], v2, s[8:11], s22 offen offset:0
  buffer_load_dwordx4 v[188:191], v2, s[8:11], s22 offen offset:1024
  buffer_load_dwordx4 v[192:195], v2, s[8:11], s22 offen offset:2048
  buffer_load_dwordx4 v[196:199], v2, s[8:11], s22 offen offset:3072
  s_add_u32 s22, s31, 385024
  buffer_load_dwordx4 v[200:203], v2, s[8:11], s22 offen offset:2048
  buffer_load_dwordx4 v[204:207], v2, s[8:11], s22 offen offset:3072
  s_add_u32 s22, s31, 389120
  buffer_load_dwordx4 v[208:211], v2, s[8:11], s22 offen offset:0
  buffer_load_dwordx4 v[212:215], v2, s[8:11], s22 offen offset:1024
  buffer_load_dwordx4 v[216:219], v2, s[8:11], s22 offen offset:2048
  buffer_load_dwordx4 v[220:223], v2, s[8:11], s22 offen offset:3072
  s_add_u32 s22, s31, 393216
  buffer_load_dwordx4 v[224:227], v2, s[8:11], s22 offen offset:0
  buffer_load_dwordx4 v[228:231], v2, s[8:11], s22 offen offset:1024
  buffer_load_dwordx4 v[232:235], v2, s[8:11], s22 offen offset:2048
  buffer_load_dwordx4 v[236:239], v2, s[8:11], s22 offen offset:3072
  s_add_u32 s22, s31, 397312
  buffer_load_dwordx4 v[240:243], v2, s[8:11], s22 offen offset:0
  buffer_load_dwordx4 v[244:247], v2, s[8:11], s22 offen offset:1024
  s_waitcnt vmcnt(24)
  buffer_load_dwordx4 v[248:251], v2, s[8:11], s22 offen offset:2048
  buffer_load_dwordx4 v[252:255], v2, s[8:11], s22 offen offset:3072
  s_mov_b32 s24, 71586816
  s_mov_b32 s25, 0
  s_add_u32 m0, s25, 21504
  s_nop 0
  buffer_load_dwordx4 v2, s[8:11], s24 offen offset:0 lds
  buffer_load_dwordx4 v2, s[8:11], s24 offen offset:1024 lds
  buffer_load_dwordx4 v2, s[8:11], s24 offen offset:2048 lds
  buffer_load_dwordx4 v2, s[8:11], s24 offen offset:3072 lds
  s_add_u32 m0, s25, 25600
  s_add_u32 s22, s24, 4096
  buffer_load_dwordx4 v2, s[8:11], s22 offen offset:0 lds
  buffer_load_dwordx4 v2, s[8:11], s22 offen offset:1024 lds
  buffer_load_dwordx4 v2, s[8:11], s22 offen offset:2048 lds
  v_and_b32 v64, 7, v117
  v_and_b32 v65, 1, v116
  v_lshlrev_b32 v65, 2, v65
  v_sub_u32 v64, v64, v65
  v_lshrrev_b32 v65, 3, v117
  v_lshl_add_u32 v66, v65, 2, v64
  v_cmp_gt_u32 vcc, 4, v64
  v_mov_b32 v67, 99
  s_nop 0
  v_cndmask_b32 v66, v67, v66, vcc
  v_mov_b32 v68, 0x3f80
  v_mov_b32 v69, 0x3f800000
  v_mov_b32 v4, 0
  v_cmp_eq_u32 vcc, 0, v66
  s_nop 1
  v_cndmask_b32 v4, v4, v68, vcc
  v_cmp_eq_u32 vcc, 1, v66
  s_nop 1
  v_cndmask_b32 v4, v4, v69, vcc
  v_mov_b32 v5, 0
  v_cmp_eq_u32 vcc, 2, v66
  s_nop 1
  v_cndmask_b32 v5, v5, v68, vcc
  v_cmp_eq_u32 vcc, 3, v66
  s_nop 1
  v_cndmask_b32 v5, v5, v69, vcc
  v_mov_b32 v6, 0
  v_cmp_eq_u32 vcc, 4, v66
  s_nop 1
  v_cndmask_b32 v6, v6, v68, vcc
  v_cmp_eq_u32 vcc, 5, v66
  s_nop 1
  v_cndmask_b32 v6, v6, v69, vcc
  v_mov_b32 v7, 0
  v_cmp_eq_u32 vcc, 6, v66
  s_nop 1
  v_cndmask_b32 v7, v7, v68, vcc
  v_cmp_eq_u32 vcc, 7, v66
  s_nop 1
  v_cndmask_b32 v7, v7, v69, vcc
  v_lshrrev_b32 v64, 1, v116
  v_lshrrev_b32 v65, 3, v117
  v_cmp_eq_u32 s[26:27], v64, v65
  v_and_b32 v66, 1, v116
  v_add_u32 v64, 6, v64
  v_lshrrev_b32 v67, 1, v116
  v_lshlrev_b32 v67, 8, v67
  v_lshl_add_u32 v67, v66, 9, v67
  v_lshl_add_u32 v67, v117, 4, v67
  v_add_u32 v112, 60416, v67
  v_and_b32 v68, 7, v117
  v_lshlrev_b32 v67, 8, v64
  v_lshl_add_u32 v67, v68, 5, v67
  v_lshl_add_u32 v67, v66, 4, v67
  v_add_u32 v113, 65536, v67
  v_lshrrev_b32 v64, 5, v1
  v_and_b32 v65, 31, v1
  v_lshrrev_b32 v66, 3, v65
  v_and_b32 v67, 7, v65
  v_and_b32 v68, 3, v67
  v_lshl_add_u32 v68, v66, 2, v68
  v_lshrrev_b32 v69, 2, v67
  v_lshl_add_u32 v68, v69, 4, v68
  v_lshlrev_b32 v69, 11, v64
  v_lshl_add_u32 v69, v68, 4, v69
  v_add_u32 v114, 57864, v69
  v_add_u32 v70, 6, v64
  v_lshlrev_b32 v69, 9, v66
  v_lshl_add_u32 v69, v70, 5, v69
  v_lshl_add_u32 v69, v67, 2, v69
  v_add_u32 v115, 65536, v69
  v_and_b32 v71, 1, v1
  v_cmp_eq_u32 s[38:39], 0, v71
  v_cmp_gt_u32 vcc, 8, v65
  s_or_b64 s[28:29], s[38:39], vcc
  v_lshrrev_b32 v72, 1, v67
  v_lshlrev_b32 v72, 2, v72
  v_lshl_add_u32 v72, v70, 4, v72
  s_lshl_b32 s22, s17, 9
  s_add_u32 s22, s22, 9216
  v_lshl_add_u32 v73, v66, 7, v72
  v_add_u32 v73, s22, v73
  s_lshl_b32 s22, s17, 7
  s_add_u32 s22, s22, 7168
  v_add_u32 v74, s22, v72
  v_bfe_u32 v72, v65, 1, 1
  v_lshlrev_b32 v72, 7, v72
  v_lshl_add_u32 v72, v70, 4, v72
  v_bfe_u32 v73, v65, 2, 2
  v_lshl_add_u32 v72, v73, 2, v72
  v_lshrrev_b32 v73, 4, v65
  v_lshl_add_u32 v73, v73, 8, v72
  s_lshl_b32 s22, s17, 9
  s_add_u32 s22, s22, 9216
  v_add_u32 v73, s22, v73
  s_lshr_b32 s22, s17, 1
  s_lshl_b32 s22, s22, 8
  s_and_b32 s34, s17, 1
  s_lshl_b32 s34, s34, 3
  s_add_u32 s22, s22, s34
  s_add_u32 s22, s22, 7168
  v_add_u32 v74, s22, v72
  v_lshlrev_b32 v0, 2, v65
  s_and_b32 s22, s17, 31
  s_lshl_b32 s22, s22, 7
  s_add_u32 s22, s22, 21504
  v_add_u32 v0, s22, v0
  v_cndmask_b32 v1, v74, v73, s[38:39]
  s_lshl_b32 s36, s17, 2
  s_add_u32 s36, s36, 17408
  s_mov_b32 s37, 0x3e800000
  v_mov_b32 v64, 0
  v_mov_b32 v65, 0
  v_mov_b32 v66, 0
  v_mov_b32 v67, 0
  v_mov_b32 v68, 0
  v_mov_b32 v69, 0
  v_mov_b32 v70, 0
  v_mov_b32 v71, 0
  v_mov_b32 v72, 0
  v_mov_b32 v73, 0
  v_mov_b32 v74, 0
  v_mov_b32 v75, 0
  v_mov_b32 v76, 0
  v_mov_b32 v77, 0
  v_mov_b32 v78, 0
  v_mov_b32 v79, 0
  v_mov_b32 v80, 0
  v_mov_b32 v81, 0
  v_mov_b32 v82, 0
  v_mov_b32 v83, 0
  v_mov_b32 v84, 0
  v_mov_b32 v85, 0
  v_mov_b32 v86, 0
  v_mov_b32 v87, 0
  v_mov_b32 v88, 0
  v_mov_b32 v89, 0
  v_mov_b32 v90, 0
  v_mov_b32 v91, 0
  v_mov_b32 v92, 0
  v_mov_b32 v93, 0
  v_mov_b32 v94, 0
  v_mov_b32 v95, 0
  v_mov_b32 v96, 0
  v_mov_b32 v97, 0
  v_mov_b32 v98, 0
  v_mov_b32 v99, 0
  v_mov_b32 v100, 0
  v_mov_b32 v101, 0
  v_mov_b32 v102, 0
  v_mov_b32 v103, 0
  v_mov_b32 v104, 0
  v_mov_b32 v105, 0
  v_mov_b32 v106, 0
  v_mov_b32 v107, 0
  v_mov_b32 v108, 0
  v_mov_b32 v109, 0
  v_mov_b32 v110, 0
  v_mov_b32 v111, 0
  v_mov_b32 v116, v2
  v_lshrrev_b32 v117, 4, v2
  v_min_u32 v117, 55, v117
  v_lshlrev_b32 v117, 7, v117
  s_mul_i32 s35, s17, 1835008
  s_add_u32 s35, s35, 42284032
  s_mov_b32 s30, 0
  v_mov_b32 v36, 0
ch_md3:
  buffer_load_dword v37, v36, s[12:15], 0 offen sc1
  s_waitcnt vmcnt(0)
  v_readfirstlane_b32 s22, v37
  s_and_b32 s31, s22, 0xffff
  s_cmp_ge_u32 s31, 32
  s_cbranch_scc1 ch_go3
  s_sleep 2
  s_add_u32 s30, s30, 1
  s_cmp_lt_u32 s30, 3200000
  s_cbranch_scc1 ch_md3
  s_branch ch_end
ch_go3:
  s_mov_b32 s31, 0
  s_lshr_b32 s22, s22, 16
  s_cmp_lg_u32 s22, 0
  s_cbranch_scc1 cB_sc3_loop
  s_branch cA_sc3_loop
ch_init4:
  s_mul_i32 s31, s17, 401408
  s_add_u32 s31, s31, 6422528
  s_add_u32 s22, s31, 0
  buffer_load_dwordx4 a[0:3], v2, s[8:11], s22 offen offset:0
  buffer_load_dwordx4 a[4:7], v2, s[8:11], s22 offen offset:1024
  buffer_load_dwordx4 a[8:11], v2, s[8:11], s22 offen offset:2048
  buffer_load_dwordx4 a[12:15], v2, s[8:11], s22 offen offset:3072
  s_add_u32 s22, s31, 4096
  buffer_load_dwordx4 a[16:19], v2, s[8:11], s22 offen offset:0
  buffer_load_dwordx4 a[20:23], v2, s[8:11], s22 offen offset:1024
  buffer_load_dwordx4 a[24:27], v2, s[8:11], s22 offen offset:2048
  buffer_load_dwordx4 a[28:31], v2, s[8:11], s22 offen offset:3072
  s_add_u32 s22, s31, 8192
  buffer_load_dwordx4 a[32:35], v2, s[8:11], s22 offen offset:0
  buffer_load_dwordx4 a[36:39], v2, s[8:11], s22 offen offset:1024
  buffer_load_dwordx4 a[40:43], v2, s[8:11], s22 offen offset:2048
  buffer_load_dwordx4 a[44:47], v2, s[8:11], s22 offen offset:3072
  s_add_u32 s22, s31, 12288
  buffer_load_dwordx4 a[48:51], v2, s[8:11], s22 offen offset:0
  buffer_load_dwordx4 a[52:55], v2, s[8:11], s22 offen offset:1024
  buffer_load_dwordx4 a[56:59], v2, s[8:11], s22 offen offset:2048
  buffer_load_dwordx4 a[60:63], v2, s[8:11], s22 offen offset:3072
  s_add_u32 s22, s31, 16384
  buffer_load_dwordx4 a[64:67], v2, s[8:11], s22 offen offset:0
  buffer_load_dwordx4 a[68:71], v2, s[8:11], s22 offen offset:1024
  buffer_load_dwordx4 a[72:75], v2, s[8:11], s22 offen offset:2048
  buffer_load_dwordx4 a[76:79], v2, s[8:11], s22 offen offset:3072
  s_add_u32 s22, s31, 20480
  buffer_load_dwordx4 a[80:83], v2, s[8:11], s22 offen offset:0
  buffer_load_dwordx4 a[84:87], v2, s[8:11], s22 offen offset:1024
  buffer_load_dwordx4 a[88:91], v2, s[8:11], s22 offen offset:2048
  buffer_load_dwordx4 a[92:95], v2, s[8:11], s22 offen offset:3072
  s_add_u32 s22, s31, 24576
  buffer_load_dwordx4 a[96:99], v2, s[8:11], s22 offen offset:0
  buffer_load_dwordx4 a[100:103], v2, s[8:11], s22 offen offset:1024
  buffer_load_dwordx4 a[104:107], v2, s[8:11], s22 offen offset:2048
  buffer_load_dwordx4 a[108:111], v2, s[8:11], s22 offen offset:3072
  s_add_u32 s22, s31, 28672
  buffer_load_dwordx4 a[112:115], v2, s[8:11], s22 offen offset:0
  buffer_load_dwordx4 a[116:119], v2, s[8:11], s22 offen offset:1024
  buffer_load_dwordx4 a[120:123], v2, s[8:11], s22 offen offset:2048
  buffer_load_dwordx4 a[124:127], v2, s[8:11], s22 offen offset:3072
  s_waitcnt vmcnt(24)
  s_add_u32 s22, s31, 32768
  buffer_load_dwordx4 a[128:131], v2, s[8:11], s22 offen offset:0
  buffer_load_dwordx4 a[132:135], v2, s[8:11], s22 offen offset:1024
  buffer_load_dwordx4 a[136:139], v2, s[8:11], s22 offen offset:2048
  buffer_load_dwordx4 a[140:143], v2, s[8:11], s22 offen offset:3072
  s_add_u32 s22, s31, 36864
  buffer_load_dwordx4 a[144:147], v2, s[8:11], s22 offen offset:0
  buffer_load_dwordx4 a[148:151], v2, s[8:11], s22 offen offset:1024
  buffer_load_dwordx4 a[152:155], v2, s[8:11], s22 offen offset:2048
  buffer_load_dwordx4 a[156:159], v2, s[8:11], s22 offen offset:3072
  s_add_u32 s22, s31, 40960
  buffer_load_dwordx4 a[160:163], v2, s[8:11], s22 offen offset:0
  buffer_load_dwordx4 a[164:167], v2, s[8:11], s22 offen offset:1024
  buffer_load_dwordx4 a[168:171], v2, s[8:11], s22 offen offset:2048
  buffer_load_dwordx4 a[172:175], v2, s[8:11], s22 offen offset:3072
  s_add_u32 s22, s31, 45056
  buffer_load_dwordx4 a[176:179], v2, s[8:11], s22 offen offset:0
  buffer_load_dwordx4 a[180:183], v2, s[8:11], s22 offen offset:1024
  buffer_load_dwordx4 a[184:187], v2, s[8:11], s22 offen offset:2048
  buffer_load_dwordx4 a[188:191], v2, s[8:11], s22 offen offset:3072
  s_add_u32 s22, s31, 49152
  buffer_load_dwordx4 a[192:195], v2, s[8:11], s22 offen offset:0
  buffer_load_dwordx4 a[196:199], v2, s[8:11], s22 offen offset:1024
  buffer_load_dwordx4 a[200:203], v2, s[8:11], s22 offen offset:2048
  buffer_load_dwordx4 a[204:207], v2, s[8:11], s22 offen offset:3072
  s_add_u32 s22, s31, 53248
  buffer_load_dwordx4 a[208:211], v2, s[8:11], s22 offen offset:0
  buffer_load_dwordx4 a[212:215], v2, s[8:11], s22 offen offset:1024
  buffer_load_dwordx4 a[216:219], v2, s[8:11], s22 offen offset:2048
  buffer_load_dwordx4 a[220:223], v2, s[8:11], s22 offen offset:3072
  s_add_u32 s22, s31, 57344
  buffer_load_dwordx4 a[224:227], v2, s[8:11], s22 offen offset:0
  buffer_load_dwordx4 a[228:231], v2, s[8:11], s22 offen offset:1024
  buffer_load_dwordx4 a[232:235], v2, s[8:11], s22 offen offset:2048
  buffer_load_dwordx4 a[236:239], v2, s[8:11], s22 offen offset:3072
  s_add_u32 s22, s31, 61440
  buffer_load_dwordx4 a[240:243], v2, s[8:11], s22 offen offset:0
  buffer_load_dwordx4 a[244:247], v2, s[8:11], s22 offen offset:1024
  buffer_load_dwordx4 a[248:251], v2, s[8:11], s22 offen offset:2048
  buffer_load_dwordx4 a[252:255], v2, s[8:11], s22 offen offset:3072
  s_waitcnt vmcnt(24)
  s_add_u32 s22, s31, 65536
  buffer_load_dwordx4 v[176:179], v2, s[8:11], s22 offen offset:0
  buffer_load_dwordx4 v[180:183], v2, s[8:11], s22 offen offset:1024
  buffer_load_dwordx4 v[184:187], v2, s[8:11], s22 offen offset:2048
  buffer_load_dwordx4 v[188:191], v2, s[8:11], s22 offen offset:3072
  s_add_u32 s22, s31, 69632
  buffer_load_dwordx4 v[192:195], v2, s[8:11], s22 offen offset:0
  buffer_load_dwordx4 v[196:199], v2, s[8:11], s22 offen offset:1024
  buffer_load_dwordx4 v[200:203], v2, s[8:11], s22 offen offset:2048
  buffer_load_dwordx4 v[204:207], v2, s[8:11], s22 offen offset:3072
  s_add_u32 s22, s31, 73728
  buffer_load_dwordx4 v[208:211], v2, s[8:11], s22 offen offset:0
  buffer_load_dwordx4 v[212:215], v2, s[8:11], s22 offen offset:1024
  buffer_load_dwordx4 v[216:219], v2, s[8:11], s22 offen offset:2048
  buffer_load_dwordx4 v[220:223], v2, s[8:11], s22 offen offset:3072
  s_add_u32 s22, s31, 77824
  buffer_load_dwordx4 v[224:227], v2, s[8:11], s22 offen offset:0
  buffer_load_dwordx4 v[228:231], v2, s[8:11], s22 offen offset:1024
  buffer_load_dwordx4 v[232:235], v2, s[8:11], s22 offen offset:2048
  buffer_load_dwordx4 v[236:239], v2, s[8:11], s22 offen offset:3072
  s_add_u32 s22, s31, 81920
  buffer_load_dwordx4 v[240:243], v2, s[8:11], s22 offen offset:0
  buffer_load_dwordx4 v[244:247], v2, s[8:11], s22 offen offset:1024
  buffer_load_dwordx4 v[248:251], v2, s[8:11], s22 offen offset:2048
  buffer_load_dwordx4 v[252:255], v2, s[8:11], s22 offen offset:3072
  s_mov_b32 m0, 16384
  s_add_u32 s22, s31, 272384
  buffer_load_dwordx4 v2, s[8:11], s22 offen offset:0 lds
  buffer_load_dwordx4 v2, s[8:11], s22 offen offset:1024 lds
  buffer_load_dwordx4 v2, s[8:11], s22 offen offset:2048 lds
  buffer_load_dwordx4 v2, s[8:11], s22 offen offset:3072 lds
  s_mov_b32 m0, 20480
  s_add_u32 s22, s31, 276480
  buffer_load_dwordx4 v2, s[8:11], s22 offen offset:0 lds
  buffer_load_dwordx4 v2, s[8:11], s22 offen offset:1024 lds
  buffer_load_dwordx4 v2, s[8:11], s22 offen offset:2048 lds
  buffer_load_dwordx4 v2, s[8:11], s22 offen offset:3072 lds
  s_mov_b32 m0, 24576
  s_add_u32 s22, s31, 280576
  buffer_load_dwordx4 v2, s[8:11], s22 offen offset:0 lds
  buffer_load_dwordx4 v2, s[8:11], s22 offen offset:1024 lds
  buffer_load_dwordx4 v2, s[8:11], s22 offen offset:2048 lds
  buffer_load_dwordx4 v2, s[8:11], s22 offen offset:3072 lds
  s_mov_b32 m0, 28672
  s_add_u32 s22, s31, 284672
  buffer_load_dwordx4 v2, s[8:11], s22 offen offset:0 lds
  buffer_load_dwordx4 v2, s[8:11], s22 offen offset:1024 lds
  v_mov_b32 v72, v116
  v_mov_b32 v73, v117
  v_lshrrev_b32 v65, 1, v72
  v_and_b32 v66, 1, v72
  v_add_u32 v67, 0, v65
  v_lshl_add_u32 v67, v67, 4, v73
  v_mul_u32_u24 v68, 2341, v67
  v_lshrrev_b32 v68, 16, v68
  v_mul_u32_u24 v69, 28, v68
  v_sub_u32 v69, v67, v69
  v_lshrrev_b32 v70, 4, v69
  v_and_b32 v69, 15, v69
  v_and_b32 v71, 1, v69
  v_lshrrev_b32 v69, 1, v69
  v_lshl_add_u32 v69, v71, 3, v69
  v_lshlrev_b32 v71, 12, v70
  v_lshl_add_u32 v71, v68, 8, v71
  v_lshl_add_u32 v71, v69, 4, v71
  v_lshl_add_u32 v60, v66, 3, v71
  v_add_u32 v67, 2, v65
  v_lshl_add_u32 v67, v67, 4, v73
  v_mul_u32_u24 v68, 2341, v67
  v_lshrrev_b32 v68, 16, v68
  v_mul_u32_u24 v69, 28, v68
  v_sub_u32 v69, v67, v69
  v_lshrrev_b32 v70, 4, v69
  v_and_b32 v69, 15, v69
  v_and_b32 v71, 1, v69
  v_lshrrev_b32 v69, 1, v69
  v_lshl_add_u32 v69, v71, 3, v69
  v_lshlrev_b32 v71, 12, v70
  v_lshl_add_u32 v71, v68, 8, v71
  v_lshl_add_u32 v71, v69, 4, v71
  v_lshl_add_u32 v61, v66, 3, v71
  v_add_u32 v67, 4, v65
  v_lshl_add_u32 v67, v67, 4, v73
  v_mul_u32_u24 v68, 2341, v67
  v_lshrrev_b32 v68, 16, v68
  v_mul_u32_u24 v69, 28, v68
  v_sub_u32 v69, v67, v69
  v_lshrrev_b32 v70, 4, v69
  v_and_b32 v69, 15, v69
  v_and_b32 v71, 1, v69
  v_lshrrev_b32 v69, 1, v69
  v_lshl_add_u32 v69, v71, 3, v69
  v_lshlrev_b32 v71, 12, v70
  v_lshl_add_u32 v71, v68, 8, v71
  v_lshl_add_u32 v71, v69, 4, v71
  v_lshl_add_u32 v62, v66, 3, v71
  v_and_b32 v0, 31, v1
  v_lshlrev_b32 v0, 2, v0
  v_add_u32 v0, 21504, v0
  v_lshlrev_b32 v4, 2, v73
  s_and_b32 s22, s17, 15
  s_lshl_b32 s22, s22, 7
  s_add_u32 s22, s22, 17408
  v_add_u32 v4, s22, v4
  v_and_b32 v64, 7, v73
  v_lshlrev_b32 v5, 4, v64
  v_lshl_add_u32 v5, v72, 7, v5
  v_lshrrev_b32 v65, 3, v73
  v_lshl_add_u32 v5, v65, 9, v5
  s_lshl_b32 s22, s17, 3
  s_add_u32 s22, s22, 21504
  v_lshl_add_u32 v7, v2, 3, s22
  v_add_u32 v65, 0, v73
  v_min_u32 v65, 27, v65
  v_mad_u32_u24 v65, v72, 28, v65
  v_lshlrev_b32 v6, 4, v65
  s_lshr_b32 s22, s17, 1
  s_mul_i32 s22, s22, 7
  s_and_b32 s34, s17, 1
  s_lshl_b32 s35, s34, 2
  v_add_u32 v70, s35, v72
  v_mov_b32 v71, s34
  v_mov_b32 v69, 0
  v_cmp_eq_u32 vcc, 3, v72
  s_nop 1
  v_cndmask_b32 v70, v70, v72, vcc
  v_cndmask_b32 v69, v69, v71, vcc
  v_add_u32 v70, s22, v70
  v_lshrrev_b32 v68, 1, v70
  v_lshlrev_b32 v68, 8, v68
  v_lshl_add_u32 v68, v69, 7, v68
  v_and_b32 v69, 1, v70
  v_lshl_add_u32 v68, v69, 3, v68
  v_lshl_add_u32 v1, v64, 4, v68
  v_cmp_gt_u32 s[26:27], 8, v73
  v_lshrrev_b32 v65, 3, v73
  v_lshl_add_u32 v66, v64, 1, v65
  v_add_u32 v66, 0, v66
  v_min_u32 v66, 27, v66
  v_mad_u32_u24 v66, v72, 28, v66
  v_lshlrev_b32 v6, 4, v66
  v_lshrrev_b32 v67, 1, v64
  v_add_u32 v70, s35, v67
  v_mov_b32 v71, s34
  v_mov_b32 v69, 0
  v_cmp_eq_u32 vcc, 3, v67
  s_nop 1
  v_cndmask_b32 v70, v70, v67, vcc
  v_cndmask_b32 v69, v69, v71, vcc
  v_add_u32 v70, s22, v70
  v_lshrrev_b32 v68, 1, v70
  v_lshlrev_b32 v68, 8, v68
  v_lshl_add_u32 v68, v69, 7, v68
  v_and_b32 v69, 1, v70
  v_lshl_add_u32 v68, v69, 3, v68
  v_and_b32 v69, 1, v64
  v_lshl_add_u32 v68, v69, 2, v68
  v_and_b32 v69, 1, v72
  v_lshl_add_u32 v65, v69, 2, v65
  v_lshrrev_b32 v69, 1, v72
  v_lshl_add_u32 v65, v69, 1, v65
  v_lshl_add_u32 v1, v65, 4, v68
  v_cmp_gt_u32 s[26:27], 6, v64
  v_mov_b32 v156, 0
  v_mov_b32 v157, 0
  v_mov_b32 v158, 0
  v_mov_b32 v159, 0
  ds_write_b128 v2, v[156:159] offset:0
  ds_write_b128 v2, v[156:159] offset:1024
  ds_write_b128 v2, v[156:159] offset:2048
  ds_write_b128 v2, v[156:159] offset:3072
  s_mul_i32 s22, s17, 1835008
  s_add_u32 s25, s22, 42205184
  s_lshl_b32 s35, s17, 2
  s_add_u32 s35, s35, 88526848
  s_mov_b32 s30, 0
  v_mov_b32 v36, 0
ch_md4:
  buffer_load_dword v37, v36, s[12:15], 0 offen sc1
  s_waitcnt vmcnt(0)
  v_readfirstlane_b32 s22, v37
  s_and_b32 s31, s22, 0xffff
  s_cmp_ge_u32 s31, 32
  s_cbranch_scc1 ch_go4
  s_sleep 2
  s_add_u32 s30, s30, 1
  s_cmp_lt_u32 s30, 3200000
  s_cbranch_scc1 ch_md4
  s_branch ch_end
ch_go4:
  s_mov_b32 s31, 0
  v_mov_b32 v36, 0
  v_mov_b32 v37, 0
  v_mov_b32 v38, 0
  v_mov_b32 v39, 0
  v_mov_b32 v40, 0
  v_mov_b32 v41, 0
  v_mov_b32 v42, 0
  v_mov_b32 v43, 0
  v_mov_b32 v44, 0
  v_mov_b32 v45, 0
  v_mov_b32 v46, 0
  v_mov_b32 v47, 0
  v_mov_b32 v48, 0
  v_mov_b32 v49, 0
  v_mov_b32 v50, 0
  v_mov_b32 v51, 0
  v_mov_b32 v52, 0
  v_mov_b32 v53, 0
  v_mov_b32 v54, 0
  v_mov_b32 v55, 0
  v_mov_b32 v56, 0
  v_mov_b32 v57, 0
  v_mov_b32 v58, 0
  v_mov_b32 v59, 0
  s_lshr_b32 s22, s22, 16
  s_cmp_lg_u32 s22, 0
  s_cbranch_scc1 cB_va0_loop
  s_branch cA_va0_loop
ch_init5:
  s_mul_i32 s31, s17, 401408
  s_add_u32 s31, s31, 6422528
  s_add_u32 s22, s31, 86016
  buffer_load_dwordx4 a[0:3], v2, s[8:11], s22 offen offset:0
  buffer_load_dwordx4 a[4:7], v2, s[8:11], s22 offen offset:1024
  buffer_load_dwordx4 a[8:11], v2, s[8:11], s22 offen offset:2048
  buffer_load_dwordx4 a[12:15], v2, s[8:11], s22 offen offset:3072
  s_add_u32 s22, s31, 90112
  buffer_load_dwordx4 a[16:19], v2, s[8:11], s22 offen offset:0
  buffer_load_dwordx4 a[20:23], v2, s[8:11], s22 offen offset:1024
  buffer_load_dwordx4 a[24:27], v2, s[8:11], s22 offen offset:2048
  buffer_load_dwordx4 a[28:31], v2, s[8:11], s22 offen offset:3072
  s_add_u32 s22, s31, 94208
  buffer_load_dwordx4 a[32:35], v2, s[8:11], s22 offen offset:0
  buffer_load_dwordx4 a[36:39], v2, s[8:11], s22 offen offset:1024
  buffer_load_dwordx4 a[40:43], v2, s[8:11], s22 offen offset:2048
  buffer_load_dwordx4 a[44:47], v2, s[8:11], s22 offen offset:3072
  s_add_u32 s22, s31, 98304
  buffer_load_dwordx4 a[48:51], v2, s[8:11], s22 offen offset:0
  buffer_load_dwordx4 a[52:55], v2, s[8:11], s22 offen offset:1024
  buffer_load_dwordx4 a[56:59], v2, s[8:11], s22 offen offset:2048
  buffer_load_dwordx4 a[60:63], v2, s[8:11], s22 offen offset:3072
  s_add_u32 s22, s31, 102400
  buffer_load_dwordx4 a[64:67], v2, s[8:11], s22 offen offset:0
  buffer_load_dwordx4 a[68:71], v2, s[8:11], s22 offen offset:1024
  buffer_load_dwordx4 a[72:75], v2, s[8:11], s22 offen offset:2048
  buffer_load_dwordx4 a[76:79], v2, s[8:11], s22 offen offset:3072
  s_add_u32 s22, s31, 106496
  buffer_load_dwordx4 a[80:83], v2, s[8:11], s22 offen offset:0
  buffer_load_dwordx4 a[84:87], v2, s[8:11], s22 offen offset:1024
  buffer_load_dwordx4 a[88:91], v2, s[8:11], s22 offen offset:2048
  buffer_load_dwordx4 a[92:95], v2, s[8:11], s22 offen offset:3072
  s_add_u32 s22, s31, 110592
  buffer_load_dwordx4 a[96:99], v2, s[8:11], s22 offen offset:0
  buffer_load_dwordx4 a[100:103], v2, s[8:11], s22 offen offset:1024
  buffer_load_dwordx4 a[104:107], v2, s[8:11], s22 offen offset:2048
  buffer_load_dwordx4 a[108:111], v2, s[8:11], s22 offen offset:3072
  s_add_u32 s22, s31, 114688
  buffer_load_dwordx4 a[112:115], v2, s[8:11], s22 offen offset:0
  buffer_load_dwordx4 a[116:119], v2, s[8:11], s22 offen offset:1024
  buffer_load_dwordx4 a[120:123], v2, s[8:11], s22 offen offset:2048
  buffer_load_dwordx4 a[124:127], v2, s[8:11], s22 offen offset:3072
  s_waitcnt vmcnt(24)
  s_add_u32 s22, s31, 118784
  buffer_load_dwordx4 a[128:131], v2, s[8:11], s22 offen offset:0
  buffer_load_dwordx4 a[132:135], v2, s[8:11], s22 offen offset:1024
  buffer_load_dwordx4 a[136:139], v2, s[8:11], s22 offen offset:2048
  buffer_load_dwordx4 a[140:143], v2, s[8:11], s22 offen offset:3072
  s_add_u32 s22, s31, 122880
  buffer_load_dwordx4 a[144:147], v2, s[8:11], s22 offen offset:0
  buffer_load_dwordx4 a[148:151], v2, s[8:11], s22 offen offset:1024
  buffer_load_dwordx4 a[152:155], v2, s[8:11], s22 offen offset:2048
  buffer_load_dwordx4 a[156:159], v2, s[8:11], s22 offen offset:3072
  s_add_u32 s22, s31, 126976
  buffer_load_dwordx4 a[160:163], v2, s[8:11], s22 offen offset:0
  buffer_load_dwordx4 a[164:167], v2, s[8:11], s22 offen offset:1024
  buffer_load_dwordx4 a[168:171], v2, s[8:11], s22 offen offset:2048
  buffer_load_dwordx4 a[172:175], v2, s[8:11], s22 offen offset:3072
  s_add_u32 s22, s31, 131072
  buffer_load_dwordx4 a[176:179], v2, s[8:11], s22 offen offset:0
  buffer_load_dwordx4 a[180:183], v2, s[8:11], s22 offen offset:1024
  buffer_load_dwordx4 a[184:187], v2, s[8:11], s22 offen offset:2048
  buffer_load_dwordx4 a[188:191], v2, s[8:11], s22 offen offset:3072
  s_add_u32 s22, s31, 135168
  buffer_load_dwordx4 a[192:195], v2, s[8:11], s22 offen offset:0
  buffer_load_dwordx4 a[196:199], v2, s[8:11], s22 offen offset:1024
  buffer_load_dwordx4 a[200:203], v2, s[8:11], s22 offen offset:2048
  buffer_load_dwordx4 a[204:207], v2, s[8:11], s22 offen offset:3072
  s_add_u32 s22, s31, 139264
  buffer_load_dwordx4 a[208:211], v2, s[8:11], s22 offen offset:0
  buffer_load_dwordx4 a[212:215], v2, s[8:11], s22 offen offset:1024
  buffer_load_dwordx4 a[216:219], v2, s[8:11], s22 offen offset:2048
  buffer_load_dwordx4 a[220:223], v2, s[8:11], s22 offen offset:3072
  s_add_u32 s22, s31, 143360
  buffer_load_dwordx4 a[224:227], v2, s[8:11], s22 offen offset:0
  buffer_load_dwordx4 a[228:231], v2, s[8:11], s22 offen offset:1024
  buffer_load_dwordx4 a[232:235], v2, s[8:11], s22 offen offset:2048
  buffer_load_dwordx4 a[236:239], v2, s[8:11], s22 offen offset:3072
  s_add_u32 s22, s31, 147456
  buffer_load_dwordx4 a[240:243], v2, s[8:11], s22 offen offset:0
  buffer_load_dwordx4 a[244:247], v2, s[8:11], s22 offen offset:1024
  buffer_load_dwordx4 a[248:251], v2, s[8:11], s22 offen offset:2048
  buffer_load_dwordx4 a[252:255], v2, s[8:11], s22 offen offset:3072
  s_waitcnt vmcnt(24)
  s_add_u32 s22, s31, 151552
  buffer_load_dwordx4 v[176:179], v2, s[8:11], s22 offen offset:0
  buffer_load_dwordx4 v[180:183], v2, s[8:11], s22 offen offset:1024
  buffer_load_dwordx4 v[184:187], v2, s[8:11], s22 offen offset:2048
  buffer_load_dwordx4 v[188:191], v2, s[8:11], s22 offen offset:3072
  s_add_u32 s22, s31, 155648
  buffer_load_dwordx4 v[192:195], v2, s[8:11], s22 offen offset:0
  buffer_load_dwordx4 v[196:199], v2, s[8:11], s22 offen offset:1024
  buffer_load_dwordx4 v[200:203], v2, s[8:11], s22 offen offset:2048
  buffer_load_dwordx4 v[204:207], v2, s[8:11], s22 offen offset:3072
  s_add_u32 s22, s31, 159744
  buffer_load_dwordx4 v[208:211], v2, s[8:11], s22 offen offset:0
  buffer_load_dwordx4 v[212:215], v2, s[8:11], s22 offen offset:1024
  buffer_load_dwordx4 v[216:219], v2, s[8:11], s22 offen offset:2048
  buffer_load_dwordx4 v[220:223], v2, s[8:11], s22 offen offset:3072
  s_add_u32 s22, s31, 163840
  buffer_load_dwordx4 v[224:227], v2, s[8:11], s22 offen offset:0
  buffer_load_dwordx4 v[228:231], v2, s[8:11], s22 offen offset:1024
  buffer_load_dwordx4 v[232:235], v2, s[8:11], s22 offen offset:2048
  buffer_load_dwordx4 v[236:239], v2, s[8:11], s22 offen offset:3072
  s_add_u32 s22, s31, 167936
  buffer_load_dwordx4 v[240:243], v2, s[8:11], s22 offen offset:0
  buffer_load_dwordx4 v[244:247], v2, s[8:11], s22 offen offset:1024
  buffer_load_dwordx4 v[248:251], v2, s[8:11], s22 offen offset:2048
  buffer_load_dwordx4 v[252:255], v2, s[8:11], s22 offen offset:3072
  s_mov_b32 m0, 59392
  s_add_u32 s22, s31, 387072
  buffer_load_dwordx4 v2, s[8:11], s22 offen offset:0 lds
  buffer_load_dwordx4 v2, s[8:11], s22 offen offset:1024 lds
  buffer_load_dwordx4 v2, s[8:11], s22 offen offset:2048 lds
  buffer_load_dwordx4 v2, s[8:11], s22 offen offset:3072 lds
  s_mov_b32 m0, 63488
  s_add_u32 s22, s31, 391168
  buffer_load_dwordx4 v2, s[8:11], s22 offen offset:0 lds
  buffer_load_dwordx4 v2, s[8:11], s22 offen offset:1024 lds
  buffer_load_dwordx4 v2, s[8:11], s22 offen offset:2048 lds
  buffer_load_dwordx4 v2, s[8:11], s22 offen offset:3072 lds
  s_mov_b32 m0, 67584
  s_add_u32 s22, s31, 395264
  buffer_load_dwordx4 v2, s[8:11], s22 offen offset:0 lds
  buffer_load_dwordx4 v2, s[8:11], s22 offen offset:1024 lds
  buffer_load_dwordx4 v2, s[8:11], s22 offen offset:2048 lds
  buffer_load_dwordx4 v2, s[8:11], s22 offen offset:3072 lds
  s_mov_b32 m0, 71680
  s_add_u32 s22, s31, 399360
  buffer_load_dwordx4 v2, s[8:11], s22 offen offset:0 lds
  buffer_load_dwordx4 v2, s[8:11], s22 offen offset:1024 lds
  v_mov_b32 v72, v116
  v_mov_b32 v73, v117
  v_lshrrev_b32 v65, 1, v72
  v_and_b32 v66, 1, v72
  v_add_u32 v67, 6, v65
  v_lshl_add_u32 v67, v67, 4, v73
  v_mul_u32_u24 v68, 2341, v67
  v_lshrrev_b32 v68, 16, v68
  v_mul_u32_u24 v69, 28, v68
  v_sub_u32 v69, v67, v69
  v_lshrrev_b32 v70, 4, v69
  v_and_b32 v69, 15, v69
  v_and_b32 v71, 1, v69
  v_lshrrev_b32 v69, 1, v69
  v_lshl_add_u32 v69, v71, 3, v69
  v_lshlrev_b32 v71, 12, v70
  v_lshl_add_u32 v71, v68, 8, v71
  v_lshl_add_u32 v71, v69, 4, v71
  v_lshl_add_u32 v60, v66, 3, v71
  v_add_u32 v67, 8, v65
  v_lshl_add_u32 v67, v67, 4, v73
  v_mul_u32_u24 v68, 2341, v67
  v_lshrrev_b32 v68, 16, v68
  v_mul_u32_u24 v69, 28, v68
  v_sub_u32 v69, v67, v69
  v_lshrrev_b32 v70, 4, v69
  v_and_b32 v69, 15, v69
  v_and_b32 v71, 1, v69
  v_lshrrev_b32 v69, 1, v69
  v_lshl_add_u32 v69, v71, 3, v69
  v_lshlrev_b32 v71, 12, v70
  v_lshl_add_u32 v71, v68, 8, v71
  v_lshl_add_u32 v71, v69, 4, v71
  v_lshl_add_u32 v61, v66, 3, v71
  v_add_u32 v67, 10, v65
  v_lshl_add_u32 v67, v67, 4, v73
  v_mul_u32_u24 v68, 2341, v67
  v_lshrrev_b32 v68, 16, v68
  v_mul_u32_u24 v69, 28, v68
  v_sub_u32 v69, v67, v69
  v_lshrrev_b32 v70, 4, v69
  v_and_b32 v69, 15, v69
  v_and_b32 v71, 1, v69
  v_lshrrev_b32 v69, 1, v69
  v_lshl_add_u32 v69, v71, 3, v69
  v_lshlrev_b32 v71, 12, v70
  v_lshl_add_u32 v71, v68, 8, v71
  v_lshl_add_u32 v71, v69, 4, v71
  v_lshl_add_u32 v62, v66, 3, v71
  v_and_b32 v0, 31, v1
  v_lshlrev_b32 v0, 2, v0
  v_add_u32 v0, 21504, v0
  v_lshlrev_b32 v4, 2, v73
  s_and_b32 s22, s17, 15
  s_lshl_b32 s22, s22, 7
  s_add_u32 s22, s22, 17408
  v_add_u32 v4, s22, v4
  v_and_b32 v64, 7, v73
  v_lshlrev_b32 v5, 4, v64
  v_lshl_add_u32 v5, v72, 7, v5
  v_lshrrev_b32 v65, 3, v73
  v_lshl_add_u32 v5, v65, 9, v5
  s_lshl_b32 s22, s17, 3
  s_add_u32 s22, s22, 21508
  v_lshl_add_u32 v7, v2, 3, s22
  v_add_u32 v65, 16, v73
  v_min_u32 v65, 27, v65
  v_mad_u32_u24 v65, v72, 28, v65
  v_lshlrev_b32 v6, 4, v65
  s_lshr_b32 s22, s17, 1
  s_mul_i32 s22, s22, 7
  s_and_b32 s34, s17, 1
  s_lshl_b32 s35, s34, 2
  v_add_u32 v70, s35, v72
  v_mov_b32 v71, s34
  v_mov_b32 v69, 1
  v_cmp_eq_u32 vcc, 3, v72
  s_nop 1
  v_cndmask_b32 v70, v70, v72, vcc
  v_cndmask_b32 v69, v69, v71, vcc
  v_add_u32 v70, s22, v70
  v_lshrrev_b32 v68, 1, v70
  v_lshlrev_b32 v68, 8, v68
  v_lshl_add_u32 v68, v69, 7, v68
  v_and_b32 v69, 1, v70
  v_lshl_add_u32 v68, v69, 3, v68
  v_lshl_add_u32 v1, v64, 4, v68
  v_cmp_gt_u32 s[26:27], 8, v73
  v_cmp_gt_u32 vcc, 3, v72
  s_and_b64 s[26:27], s[26:27], vcc
  v_lshrrev_b32 v65, 3, v73
  v_lshl_add_u32 v66, v64, 1, v65
  v_add_u32 v66, 16, v66
  v_min_u32 v66, 27, v66
  v_mad_u32_u24 v66, v72, 28, v66
  v_lshlrev_b32 v6, 4, v66
  v_lshrrev_b32 v67, 1, v64
  v_add_u32 v70, s35, v67
  v_mov_b32 v71, s34
  v_mov_b32 v69, 1
  v_cmp_eq_u32 vcc, 3, v67
  s_nop 1
  v_cndmask_b32 v70, v70, v67, vcc
  v_cndmask_b32 v69, v69, v71, vcc
  v_add_u32 v70, s22, v70
  v_lshrrev_b32 v68, 1, v70
  v_lshlrev_b32 v68, 8, v68
  v_lshl_add_u32 v68, v69, 7, v68
  v_and_b32 v69, 1, v70
  v_lshl_add_u32 v68, v69, 3, v68
  v_and_b32 v69, 1, v64
  v_lshl_add_u32 v68, v69, 2, v68
  v_and_b32 v69, 1, v72
  v_lshl_add_u32 v65, v69, 2, v65
  v_lshrrev_b32 v69, 1, v72
  v_lshl_add_u32 v65, v69, 1, v65
  v_lshl_add_u32 v1, v65, 4, v68
  v_cmp_gt_u32 s[26:27], 6, v64
  v_mov_b32 v156, 0
  v_mov_b32 v157, 0
  v_mov_b32 v158, 0
  v_mov_b32 v159, 0
  ds_write_b128 v2, v[156:159] offset:4096
  ds_write_b128 v2, v[156:159] offset:5120
  ds_write_b128 v2, v[156:159] offset:6144
  ds_write_b128 v2, v[156:159] offset:7168
  s_mul_i32 s22, s17, 1835008
  s_add_u32 s25, s22, 42205184
  s_lshl_b32 s35, s17, 2
  s_add_u32 s35, s35, 88526848
  s_mov_b32 s30, 0
  v_mov_b32 v36, 0
ch_md5:
  buffer_load_dword v37, v36, s[12:15], 0 offen sc1
  s_waitcnt vmcnt(0)
  v_readfirstlane_b32 s22, v37
  s_and_b32 s31, s22, 0xffff
  s_cmp_ge_u32 s31, 32
  s_cbranch_scc1 ch_go5
  s_sleep 2
  s_add_u32 s30, s30, 1
  s_cmp_lt_u32 s30, 3200000
  s_cbranch_scc1 ch_md5
  s_branch ch_end
ch_go5:
  s_mov_b32 s31, 0
  v_mov_b32 v36, 0
  v_mov_b32 v37, 0
  v_mov_b32 v38, 0
  v_mov_b32 v39, 0
  v_mov_b32 v40, 0
  v_mov_b32 v41, 0
  v_mov_b32 v42, 0
  v_mov_b32 v43, 0
  v_mov_b32 v44, 0
  v_mov_b32 v45, 0
  v_mov_b32 v46, 0
  v_mov_b32 v47, 0
  v_mov_b32 v48, 0
  v_mov_b32 v49, 0
  v_mov_b32 v50, 0
  v_mov_b32 v51, 0
  v_mov_b32 v52, 0
  v_mov_b32 v53, 0
  v_mov_b32 v54, 0
  v_mov_b32 v55, 0
  v_mov_b32 v56, 0
  v_mov_b32 v57, 0
  v_mov_b32 v58, 0
  v_mov_b32 v59, 0
  s_lshr_b32 s22, s22, 16
  s_cmp_lg_u32 s22, 0
  s_cbranch_scc1 cB_va1_loop
  s_branch cA_va1_loop
ch_init6:
  s_mul_i32 s31, s17, 401408
  s_add_u32 s31, s31, 6422528
  s_add_u32 s22, s31, 172032
  buffer_load_dwordx4 a[0:3], v2, s[8:11], s22 offen offset:0
  buffer_load_dwordx4 a[4:7], v2, s[8:11], s22 offen offset:1024
  buffer_load_dwordx4 a[8:11], v2, s[8:11], s22 offen offset:2048
  buffer_load_dwordx4 a[12:15], v2, s[8:11], s22 offen offset:3072
  s_add_u32 s22, s31, 176128
  buffer_load_dwordx4 a[16:19], v2, s[8:11], s22 offen offset:0
  buffer_load_dwordx4 a[20:23], v2, s[8:11], s22 offen offset:1024
  buffer_load_dwordx4 a[24:27], v2, s[8:11], s22 offen offset:2048
  buffer_load_dwordx4 a[28:31], v2, s[8:11], s22 offen offset:3072
  s_add_u32 s22, s31, 180224
  buffer_load_dwordx4 a[32:35], v2, s[8:11], s22 offen offset:0
  buffer_load_dwordx4 a[36:39], v2, s[8:11], s22 offen offset:1024
  buffer_load_dwordx4 a[40:43], v2, s[8:11], s22 offen offset:2048
  buffer_load_dwordx4 a[44:47], v2, s[8:11], s22 offen offset:3072
  s_add_u32 s22, s31, 184320
  buffer_load_dwordx4 a[48:51], v2, s[8:11], s22 offen offset:0
  buffer_load_dwordx4 a[52:55], v2, s[8:11], s22 offen offset:1024
  buffer_load_dwordx4 a[56:59], v2, s[8:11], s22 offen offset:2048
  buffer_load_dwordx4 a[60:63], v2, s[8:11], s22 offen offset:3072
  s_add_u32 s22, s31, 188416
  buffer_load_dwordx4 a[64:67], v2, s[8:11], s22 offen offset:0
  buffer_load_dwordx4 a[68:71], v2, s[8:11], s22 offen offset:1024
  buffer_load_dwordx4 a[72:75], v2, s[8:11], s22 offen offset:2048
  buffer_load_dwordx4 a[76:79], v2, s[8:11], s22 offen offset:3072
  s_add_u32 s22, s31, 192512
  buffer_load_dwordx4 a[80:83], v2, s[8:11], s22 offen offset:0
  buffer_load_dwordx4 a[84:87], v2, s[8:11], s22 offen offset:1024
  buffer_load_dwordx4 a[88:91], v2, s[8:11], s22 offen offset:2048
  buffer_load_dwordx4 a[92:95], v2, s[8:11], s22 offen offset:3072
  s_add_u32 s22, s31, 196608
  buffer_load_dwordx4 a[96:99], v2, s[8:11], s22 offen offset:0
  buffer_load_dwordx4 a[100:103], v2, s[8:11], s22 offen offset:1024
  buffer_load_dwordx4 a[104:107], v2, s[8:11], s22 offen offset:2048
  buffer_load_dwordx4 a[108:111], v2, s[8:11], s22 offen offset:3072
  s_add_u32 s22, s31, 200704
  buffer_load_dwordx4 a[112:115], v2, s[8:11], s22 offen offset:0
  buffer_load_dwordx4 a[116:119], v2, s[8:11], s22 offen offset:1024
  buffer_load_dwordx4 a[120:123], v2, s[8:11], s22 offen offset:2048
  buffer_load_dwordx4 a[124:127], v2, s[8:11], s22 offen offset:3072
  s_waitcnt vmcnt(24)
  s_add_u32 s22, s31, 204800
  buffer_load_dwordx4 a[128:131], v2, s[8:11], s22 offen offset:0
  buffer_load_dwordx4 a[132:135], v2, s[8:11], s22 offen offset:1024
  buffer_load_dwordx4 a[136:139], v2, s[8:11], s22 offen offset:2048
  buffer_load_dwordx4 a[140:143], v2, s[8:11], s22 offen offset:3072
  s_add_u32 s22, s31, 208896
  buffer_load_dwordx4 a[144:147], v2, s[8:11], s22 offen offset:0
  buffer_load_dwordx4 a[148:151], v2, s[8:11], s22 offen offset:1024
  buffer_load_dwordx4 a[152:155], v2, s[8:11], s22 offen offset:2048
  buffer_load_dwordx4 a[156:159], v2, s[8:11], s22 offen offset:3072
  s_add_u32 s22, s31, 212992
  buffer_load_dwordx4 a[160:163], v2, s[8:11], s22 offen offset:0
  buffer_load_dwordx4 a[164:167], v2, s[8:11], s22 offen offset:1024
  buffer_load_dwordx4 a[168:171], v2, s[8:11], s22 offen offset:2048
  buffer_load_dwordx4 a[172:175], v2, s[8:11], s22 offen offset:3072
  s_add_u32 s22, s31, 217088
  buffer_load_dwordx4 a[176:179], v2, s[8:11], s22 offen offset:0
  buffer_load_dwordx4 a[180:183], v2, s[8:11], s22 offen offset:1024
  buffer_load_dwordx4 a[184:187], v2, s[8:11], s22 offen offset:2048
  buffer_load_dwordx4 a[188:191], v2, s[8:11], s22 offen offset:3072
  s_add_u32 s22, s31, 221184
  buffer_load_dwordx4 a[192:195], v2, s[8:11], s22 offen offset:0
  buffer_load_dwordx4 a[196:199], v2, s[8:11], s22 offen offset:1024
  buffer_load_dwordx4 a[200:203], v2, s[8:11], s22 offen offset:2048
  buffer_load_dwordx4 a[204:207], v2, s[8:11], s22 offen offset:3072
  s_add_u32 s22, s31, 225280
  buffer_load_dwordx4 a[208:211], v2, s[8:11], s22 offen offset:0
  buffer_load_dwordx4 a[212:215], v2, s[8:11], s22 offen offset:1024
  buffer_load_dwordx4 a[216:219], v2, s[8:11], s22 offen offset:2048
  buffer_load_dwordx4 a[220:223], v2, s[8:11], s22 offen offset:3072
  s_add_u32 s22, s31, 229376
  buffer_load_dwordx4 a[224:227], v2, s[8:11], s22 offen offset:0
  buffer_load_dwordx4 a[228:231], v2, s[8:11], s22 offen offset:1024
  buffer_load_dwordx4 a[232:235], v2, s[8:11], s22 offen offset:2048
  buffer_load_dwordx4 a[236:239], v2, s[8:11], s22 offen offset:3072
  s_add_u32 s22, s31, 233472
  buffer_load_dwordx4 a[240:243], v2, s[8:11], s22 offen offset:0
  buffer_load_dwordx4 a[244:247], v2, s[8:11], s22 offen offset:1024
  buffer_load_dwordx4 a[248:251], v2, s[8:11], s22 offen offset:2048
  buffer_load_dwordx4 a[252:255], v2, s[8:11], s22 offen offset:3072
  s_waitcnt vmcnt(24)
  s_add_u32 s22, s31, 237568
  buffer_load_dwordx4 v[120:123], v2, s[8:11], s22 offen offset:0
  buffer_load_dwordx4 v[124:127], v2, s[8:11], s22 offen offset:1024
  buffer_load_dwordx4 v[128:131], v2, s[8:11], s22 offen offset:2048
  buffer_load_dwordx4 v[132:135], v2, s[8:11], s22 offen offset:3072
  s_add_u32 s22, s31, 241664
  buffer_load_dwordx4 v[136:139], v2, s[8:11], s22 offen offset:0
  buffer_load_dwordx4 v[140:143], v2, s[8:11], s22 offen offset:1024
  buffer_load_dwordx4 v[144:147], v2, s[8:11], s22 offen offset:2048
  buffer_load_dwordx4 v[148:151], v2, s[8:11], s22 offen offset:3072
  s_add_u32 s22, s31, 245760
  buffer_load_dwordx4 v[152:155], v2, s[8:11], s22 offen offset:0
  buffer_load_dwordx4 v[156:159], v2, s[8:11], s22 offen offset:1024
  buffer_load_dwordx4 v[160:163], v2, s[8:11], s22 offen offset:2048
  buffer_load_dwordx4 v[164:167], v2, s[8:11], s22 offen offset:3072
  s_add_u32 s22, s31, 249856
  buffer_load_dwordx4 v[168:171], v2, s[8:11], s22 offen offset:0
  buffer_load_dwordx4 v[172:175], v2, s[8:11], s22 offen offset:1024
  buffer_load_dwordx4 v[176:179], v2, s[8:11], s22 offen offset:2048
  buffer_load_dwordx4 v[180:183], v2, s[8:11], s22 offen offset:3072
  s_add_u32 s22, s31, 253952
  buffer_load_dwordx4 v[184:187], v2, s[8:11], s22 offen offset:0
  buffer_load_dwordx4 v[188:191], v2, s[8:11], s22 offen offset:1024
  buffer_load_dwordx4 v[192:195], v2, s[8:11], s22 offen offset:2048
  buffer_load_dwordx4 v[196:199], v2, s[8:11], s22 offen offset:3072
  s_add_u32 s22, s31, 258048
  buffer_load_dwordx4 v[200:203], v2, s[8:11], s22 offen offset:0
  buffer_load_dwordx4 v[204:207], v2, s[8:11], s22 offen offset:1024
  buffer_load_dwordx4 v[208:211], v2, s[8:11], s22 offen offset:2048
  buffer_load_dwordx4 v[212:215], v2, s[8:11], s22 offen offset:3072
  s_add_u32 s22, s31, 262144
  buffer_load_dwordx4 v[216:219], v2, s[8:11], s22 offen offset:0
  buffer_load_dwordx4 v[220:223], v2, s[8:11], s22 offen offset:1024
  buffer_load_dwordx4 v[224:227], v2, s[8:11], s22 offen offset:2048
  buffer_load_dwordx4 v[228:231], v2, s[8:11], s22 offen offset:3072
  s_add_u32 s22, s31, 266240
  buffer_load_dwordx4 v[232:235], v2, s[8:11], s22 offen offset:0
  buffer_load_dwordx4 v[236:239], v2, s[8:11], s22 offen offset:1024
  buffer_load_dwordx4 v[240:243], v2, s[8:11], s22 offen offset:2048
  buffer_load_dwordx4 v[244:247], v2, s[8:11], s22 offen offset:3072
  s_waitcnt vmcnt(24)
  s_add_u32 s22, s31, 270336
  buffer_load_dwordx4 v[248:251], v2, s[8:11], s22 offen offset:0
  buffer_load_dwordx4 v[252:255], v2, s[8:11], s22 offen offset:1024
  v_mov_b32 v72, v116
  v_mov_b32 v73, v117
  v_lshrrev_b32 v65, 1, v72
  v_and_b32 v66, 1, v72
  v_add_u32 v67, 12, v65
  v_lshl_add_u32 v67, v67, 4, v73
  v_mul_u32_u24 v68, 2341, v67
  v_lshrrev_b32 v68, 16, v68
  v_mul_u32_u24 v69, 28, v68
  v_sub_u32 v69, v67, v69
  v_lshrrev_b32 v70, 4, v69
  v_and_b32 v69, 15, v69
  v_and_b32 v71, 1, v69
  v_lshrrev_b32 v69, 1, v69
  v_lshl_add_u32 v69, v71, 3, v69
  v_lshlrev_b32 v71, 12, v70
  v_lshl_add_u32 v71, v68, 8, v71
  v_lshl_add_u32 v71, v69, 4, v71
  v_lshl_add_u32 v112, v66, 3, v71
  v_add_u32 v67, 14, v65
  v_lshl_add_u32 v67, v67, 4, v73
  v_mul_u32_u24 v68, 2341, v67
  v_lshrrev_b32 v68, 16, v68
  v_mul_u32_u24 v69, 28, v68
  v_sub_u32 v69, v67, v69
  v_lshrrev_b32 v70, 4, v69
  v_and_b32 v69, 15, v69
  v_and_b32 v71, 1, v69
  v_lshrrev_b32 v69, 1, v69
  v_lshl_add_u32 v69, v71, 3, v69
  v_lshlrev_b32 v71, 12, v70
  v_lshl_add_u32 v71, v68, 8, v71
  v_lshl_add_u32 v71, v69, 4, v71
  v_lshl_add_u32 v113, v66, 3, v71
  v_add_u32 v67, 16, v65
  v_lshl_add_u32 v67, v67, 4, v73
  v_mul_u32_u24 v68, 2341, v67
  v_lshrrev_b32 v68, 16, v68
  v_mul_u32_u24 v69, 28, v68
  v_sub_u32 v69, v67, v69
  v_lshrrev_b32 v70, 4, v69
  v_and_b32 v69, 15, v69
  v_and_b32 v71, 1, v69
  v_lshrrev_b32 v69, 1, v69
  v_lshl_add_u32 v69, v71, 3, v69
  v_lshlrev_b32 v71, 12, v70
  v_lshl_add_u32 v71, v68, 8, v71
  v_lshl_add_u32 v71, v69, 4, v71
  v_lshl_add_u32 v114, v66, 3, v71
  v_add_u32 v67, 18, v65
  v_lshl_add_u32 v67, v67, 4, v73
  v_mul_u32_u24 v68, 2341, v67
  v_lshrrev_b32 v68, 16, v68
  v_mul_u32_u24 v69, 28, v68
  v_sub_u32 v69, v67, v69
  v_lshrrev_b32 v70, 4, v69
  v_and_b32 v69, 15, v69
  v_and_b32 v71, 1, v69
  v_lshrrev_b32 v69, 1, v69
  v_lshl_add_u32 v69, v71, 3, v69
  v_lshlrev_b32 v71, 12, v70
  v_lshl_add_u32 v71, v68, 8, v71
  v_lshl_add_u32 v71, v69, 4, v71
  v_lshl_add_u32 v115, v66, 3, v71
  s_mul_i32 s24, s17, 532480
  s_add_u32 s24, s24, 76926976
  s_mul_i32 s34, s17, 640
  s_add_u32 s34, s34, 88528128
  s_mul_i32 s36, s17, 448
  v_add_u32 v0, s36, v2
  v_add_u32 v0, 8192, v0
  s_add_u32 s36, s36, 88068096
  v_cmp_gt_u32 s[26:27], 28, v1
  v_and_b32 v119, 31, v1
  v_lshlrev_b32 v119, 2, v119
  s_add_u32 s22, s17, 16
  s_and_b32 s22, s22, 31
  s_lshl_b32 s22, s22, 7
  s_add_u32 s22, s22, 21504
  v_add_u32 v119, s22, v119
  v_min_u32 v118, 12, v1
  s_mul_i32 s22, s17, 13
  v_add_u32 v118, s22, v118
  v_lshlrev_b32 v118, 7, v118
  v_add_u32 v118, 51200, v118
  s_mov_b32 s39, 71565312
  v_add_u32 v1, 16384, v2
  v_mov_b32 v117, 1
  s_mul_i32 s38, s17, 1104
  s_add_u32 s38, s38, 25600
  s_mov_b32 s30, 0
  v_mov_b32 v36, 0
ch_md6:
  buffer_load_dword v37, v36, s[12:15], 0 offen sc1
  s_waitcnt vmcnt(0)
  v_readfirstlane_b32 s22, v37
  s_and_b32 s31, s22, 0xffff
  s_cmp_ge_u32 s31, 32
  s_cbranch_scc1 ch_go6
  s_sleep 2
  s_add_u32 s30, s30, 1
  s_cmp_lt_u32 s30, 3200000
  s_cbranch_scc1 ch_md6
  s_branch ch_end
ch_go6:
  s_mov_b32 s31, 0
  s_lshr_b32 s22, s22, 16
  s_cmp_lg_u32 s22, 0
  s_cbranch_scc1 cB_va2_loop
  s_branch cA_va2_loop
ch_init7:
  s_mul_i32 s31, s17, 401408
  s_add_u32 s31, s31, 6422528
  s_add_u32 s22, s31, 286720
  buffer_load_dwordx4 a[0:3], v2, s[8:11], s22 offen offset:0
  buffer_load_dwordx4 a[4:7], v2, s[8:11], s22 offen offset:1024
  buffer_load_dwordx4 a[8:11], v2, s[8:11], s22 offen offset:2048
  buffer_load_dwordx4 a[12:15], v2, s[8:11], s22 offen offset:3072
  s_add_u32 s22, s31, 290816
  buffer_load_dwordx4 a[16:19], v2, s[8:11], s22 offen offset:0
  buffer_load_dwordx4 a[20:23], v2, s[8:11], s22 offen offset:1024
  buffer_load_dwordx4 a[24:27], v2, s[8:11], s22 offen offset:2048
  buffer_load_dwordx4 a[28:31], v2, s[8:11], s22 offen offset:3072
  s_add_u32 s22, s31, 294912
  buffer_load_dwordx4 a[32:35], v2, s[8:11], s22 offen offset:0
  buffer_load_dwordx4 a[36:39], v2, s[8:11], s22 offen offset:1024
  buffer_load_dwordx4 a[40:43], v2, s[8:11], s22 offen offset:2048
  buffer_load_dwordx4 a[44:47], v2, s[8:11], s22 offen offset:3072
  s_add_u32 s22, s31, 299008
  buffer_load_dwordx4 a[48:51], v2, s[8:11], s22 offen offset:0
  buffer_load_dwordx4 a[52:55], v2, s[8:11], s22 offen offset:1024
  buffer_load_dwordx4 a[56:59], v2, s[8:11], s22 offen offset:2048
  buffer_load_dwordx4 a[60:63], v2, s[8:11], s22 offen offset:3072
  s_add_u32 s22, s31, 303104
  buffer_load_dwordx4 a[64:67], v2, s[8:11], s22 offen offset:0
  buffer_load_dwordx4 a[68:71], v2, s[8:11], s22 offen offset:1024
  buffer_load_dwordx4 a[72:75], v2, s[8:11], s22 offen offset:2048
  buffer_load_dwordx4 a[76:79], v2, s[8:11], s22 offen offset:3072
  s_add_u32 s22, s31, 307200
  buffer_load_dwordx4 a[80:83], v2, s[8:11], s22 offen offset:0
  buffer_load_dwordx4 a[84:87], v2, s[8:11], s22 offen offset:1024
  buffer_load_dwordx4 a[88:91], v2, s[8:11], s22 offen offset:2048
  buffer_load_dwordx4 a[92:95], v2, s[8:11], s22 offen offset:3072
  s_add_u32 s22, s31, 311296
  buffer_load_dwordx4 a[96:99], v2, s[8:11], s22 offen offset:0
  buffer_load_dwordx4 a[100:103], v2, s[8:11], s22 offen offset:1024
  buffer_load_dwordx4 a[104:107], v2, s[8:11], s22 offen offset:2048
  buffer_load_dwordx4 a[108:111], v2, s[8:11], s22 offen offset:3072
  s_add_u32 s22, s31, 315392
  buffer_load_dwordx4 a[112:115], v2, s[8:11], s22 offen offset:0
  buffer_load_dwordx4 a[116:119], v2, s[8:11], s22 offen offset:1024
  buffer_load_dwordx4 a[120:123], v2, s[8:11], s22 offen offset:2048
  buffer_load_dwordx4 a[124:127], v2, s[8:11], s22 offen offset:3072
  s_waitcnt vmcnt(24)
  s_add_u32 s22, s31, 319488
  buffer_load_dwordx4 a[128:131], v2, s[8:11], s22 offen offset:0
  buffer_load_dwordx4 a[132:135], v2, s[8:11], s22 offen offset:1024
  buffer_load_dwordx4 a[136:139], v2, s[8:11], s22 offen offset:2048
  buffer_load_dwordx4 a[140:143], v2, s[8:11], s22 offen offset:3072
  s_add_u32 s22, s31, 323584
  buffer_load_dwordx4 a[144:147], v2, s[8:11], s22 offen offset:0
  buffer_load_dwordx4 a[148:151], v2, s[8:11], s22 offen offset:1024
  buffer_load_dwordx4 a[152:155], v2, s[8:11], s22 offen offset:2048
  buffer_load_dwordx4 a[156:159], v2, s[8:11], s22 offen offset:3072
  s_add_u32 s22, s31, 327680
  buffer_load_dwordx4 a[160:163], v2, s[8:11], s22 offen offset:0
  buffer_load_dwordx4 a[164:167], v2, s[8:11], s22 offen offset:1024
  buffer_load_dwordx4 a[168:171], v2, s[8:11], s22 offen offset:2048
  buffer_load_dwordx4 a[172:175], v2, s[8:11], s22 offen offset:3072
  s_add_u32 s22, s31, 331776
  buffer_load_dwordx4 a[176:179], v2, s[8:11], s22 offen offset:0
  buffer_load_dwordx4 a[180:183], v2, s[8:11], s22 offen offset:1024
  buffer_load_dwordx4 a[184:187], v2, s[8:11], s22 offen offset:2048
  buffer_load_dwordx4 a[188:191], v2, s[8:11], s22 offen offset:3072
  s_add_u32 s22, s31, 335872
  buffer_load_dwordx4 a[192:195], v2, s[8:11], s22 offen offset:0
  buffer_load_dwordx4 a[196:199], v2, s[8:11], s22 offen offset:1024
  buffer_load_dwordx4 a[200:203], v2, s[8:11], s22 offen offset:2048
  buffer_load_dwordx4 a[204:207], v2, s[8:11], s22 offen offset:3072
  s_add_u32 s22, s31, 339968
  buffer_load_dwordx4 a[208:211], v2, s[8:11], s22 offen offset:0
  buffer_load_dwordx4 a[212:215], v2, s[8:11], s22 offen offset:1024
  buffer_load_dwordx4 a[216:219], v2, s[8:11], s22 offen offset:2048
  buffer_load_dwordx4 a[220:223], v2, s[8:11], s22 offen offset:3072
  s_add_u32 s22, s31, 344064
  buffer_load_dwordx4 a[224:227], v2, s[8:11], s22 offen offset:0
  buffer_load_dwordx4 a[228:231], v2, s[8:11], s22 offen offset:1024
  buffer_load_dwordx4 a[232:235], v2, s[8:11], s22 offen offset:2048
  buffer_load_dwordx4 a[236:239], v2, s[8:11], s22 offen offset:3072
  s_add_u32 s22, s31, 348160
  buffer_load_dwordx4 a[240:243], v2, s[8:11], s22 offen offset:0
  buffer_load_dwordx4 a[244:247], v2, s[8:11], s22 offen offset:1024
  buffer_load_dwordx4 a[248:251], v2, s[8:11], s22 offen offset:2048
  buffer_load_dwordx4 a[252:255], v2, s[8:11], s22 offen offset:3072
  s_waitcnt vmcnt(24)
  s_add_u32 s22, s31, 352256
  buffer_load_dwordx4 v[120:123], v2, s[8:11], s22 offen offset:0
  buffer_load_dwordx4 v[124:127], v2, s[8:11], s22 offen offset:1024
  buffer_load_dwordx4 v[128:131], v2, s[8:11], s22 offen offset:2048
  buffer_load_dwordx4 v[132:135], v2, s[8:11], s22 offen offset:3072
  s_add_u32 s22, s31, 356352
  buffer_load_dwordx4 v[136:139], v2, s[8:11], s22 offen offset:0
  buffer_load_dwordx4 v[140:143], v2, s[8:11], s22 offen offset:1024
  buffer_load_dwordx4 v[144:147], v2, s[8:11], s22 offen offset:2048
  buffer_load_dwordx4 v[148:151], v2, s[8:11], s22 offen offset:3072
  s_add_u32 s22, s31, 360448
  buffer_load_dwordx4 v[152:155], v2, s[8:11], s22 offen offset:0
  buffer_load_dwordx4 v[156:159], v2, s[8:11], s22 offen offset:1024
  buffer_load_dwordx4 v[160:163], v2, s[8:11], s22 offen offset:2048
  buffer_load_dwordx4 v[164:167], v2, s[8:11], s22 offen offset:3072
  s_add_u32 s22, s31, 364544
  buffer_load_dwordx4 v[168:171], v2, s[8:11], s22 offen offset:0
  buffer_load_dwordx4 v[172:175], v2, s[8:11], s22 offen offset:1024
  buffer_load_dwordx4 v[176:179], v2, s[8:11], s22 offen offset:2048
  buffer_load_dwordx4 v[180:183], v2, s[8:11], s22 offen offset:3072
  s_add_u32 s22, s31, 368640
  buffer_load_dwordx4 v[184:187], v2, s[8:11], s22 offen offset:0
  buffer_load_dwordx4 v[188:191], v2, s[8:11], s22 offen offset:1024
  buffer_load_dwordx4 v[192:195], v2, s[8:11], s22 offen offset:2048
  buffer_load_dwordx4 v[196:199], v2, s[8:11], s22 offen offset:3072
  s_add_u32 s22, s31, 372736
  buffer_load_dwordx4 v[200:203], v2, s[8:11], s22 offen offset:0
  buffer_load_dwordx4 v[204:207], v2, s[8:11], s22 offen offset:1024
  buffer_load_dwordx4 v[208:211], v2, s[8:11], s22 offen offset:2048
  buffer_load_dwordx4 v[212:215], v2, s[8:11], s22 offen offset:3072
  s_add_u32 s22, s31, 376832
  buffer_load_dwordx4 v[216:219], v2, s[8:11], s22 offen offset:0
  buffer_load_dwordx4 v[220:223], v2, s[8:11], s22 offen offset:1024
  buffer_load_dwordx4 v[224:227], v2, s[8:11], s22 offen offset:2048
  buffer_load_dwordx4 v[228:231], v2, s[8:11], s22 offen offset:3072
  s_add_u32 s22, s31, 380928
  buffer_load_dwordx4 v[232:235], v2, s[8:11], s22 offen offset:0
  buffer_load_dwordx4 v[236:239], v2, s[8:11], s22 offen offset:1024
  buffer_load_dwordx4 v[240:243], v2, s[8:11], s22 offen offset:2048
  buffer_load_dwordx4 v[244:247], v2, s[8:11], s22 offen offset:3072
  s_waitcnt vmcnt(24)
  s_add_u32 s22, s31, 385024
  buffer_load_dwordx4 v[248:251], v2, s[8:11], s22 offen offset:0
  buffer_load_dwordx4 v[252:255], v2, s[8:11], s22 offen offset:1024
  v_mov_b32 v72, v116
  v_mov_b32 v73, v117
  v_lshrrev_b32 v65, 1, v72
  v_and_b32 v66, 1, v72
  v_add_u32 v67, 20, v65
  v_lshl_add_u32 v67, v67, 4, v73
  v_mul_u32_u24 v68, 2341, v67
  v_lshrrev_b32 v68, 16, v68
  v_mul_u32_u24 v69, 28, v68
  v_sub_u32 v69, v67, v69
  v_lshrrev_b32 v70, 4, v69
  v_and_b32 v69, 15, v69
  v_and_b32 v71, 1, v69
  v_lshrrev_b32 v69, 1, v69
  v_lshl_add_u32 v69, v71, 3, v69
  v_lshlrev_b32 v71, 12, v70
  v_lshl_add_u32 v71, v68, 8, v71
  v_lshl_add_u32 v71, v69, 4, v71
  v_lshl_add_u32 v112, v66, 3, v71
  v_add_u32 v67, 22, v65
  v_lshl_add_u32 v67, v67, 4, v73
  v_mul_u32_u24 v68, 2341, v67
  v_lshrrev_b32 v68, 16, v68
  v_mul_u32_u24 v69, 28, v68
  v_sub_u32 v69, v67, v69
  v_lshrrev_b32 v70, 4, v69
  v_and_b32 v69, 15, v69
  v_and_b32 v71, 1, v69
  v_lshrrev_b32 v69, 1, v69
  v_lshl_add_u32 v69, v71, 3, v69
  v_lshlrev_b32 v71, 12, v70
  v_lshl_add_u32 v71, v68, 8, v71
  v_lshl_add_u32 v71, v69, 4, v71
  v_lshl_add_u32 v113, v66, 3, v71
  v_add_u32 v67, 24, v65
  v_lshl_add_u32 v67, v67, 4, v73
  v_mul_u32_u24 v68, 2341, v67
  v_lshrrev_b32 v68, 16, v68
  v_mul_u32_u24 v69, 28, v68
  v_sub_u32 v69, v67, v69
  v_lshrrev_b32 v70, 4, v69
  v_and_b32 v69, 15, v69
  v_and_b32 v71, 1, v69
  v_lshrrev_b32 v69, 1, v69
  v_lshl_add_u32 v69, v71, 3, v69
  v_lshlrev_b32 v71, 12, v70
  v_lshl_add_u32 v71, v68, 8, v71
  v_lshl_add_u32 v71, v69, 4, v71
  v_lshl_add_u32 v114, v66, 3, v71
  v_add_u32 v67, 26, v65
  v_lshl_add_u32 v67, v67, 4, v73
  v_mul_u32_u24 v68, 2341, v67
  v_lshrrev_b32 v68, 16, v68
  v_mul_u32_u24 v69, 28, v68
  v_sub_u32 v69, v67, v69
  v_lshrrev_b32 v70, 4, v69
  v_and_b32 v69, 15, v69
  v_and_b32 v71, 1, v69
  v_lshrrev_b32 v69, 1, v69
  v_lshl_add_u32 v69, v71, 3, v69
  v_lshlrev_b32 v71, 12, v70
  v_lshl_add_u32 v71, v68, 8, v71
  v_lshl_add_u32 v71, v69, 4, v71
  v_lshl_add_u32 v115, v66, 3, v71
  s_mul_i32 s24, s17, 532480
  s_add_u32 s24, s24, 76931072
  s_mul_i32 s34, s17, 640
  s_add_u32 s34, s34, 88528132
  s_mul_i32 s36, s17, 448
  v_add_u32 v0, s36, v2
  v_add_u32 v0, 8192, v0
  s_add_u32 s36, s36, 88068096
  v_cmp_gt_u32 s[26:27], 28, v1
  v_and_b32 v119, 31, v1
  v_lshlrev_b32 v119, 2, v119
  s_add_u32 s22, s17, 16
  s_and_b32 s22, s22, 31
  s_lshl_b32 s22, s22, 7
  s_add_u32 s22, s22, 21504
  v_add_u32 v119, s22, v119
  v_min_u32 v118, 13, v1
  s_mul_i32 s22, s17, 14
  v_add_u32 v118, s22, v118
  v_lshlrev_b32 v118, 7, v118
  v_add_u32 v118, 57344, v118
  s_mov_b32 s39, 71565312
  v_add_u32 v1, 59392, v2
  v_mov_b32 v117, 1
  s_mul_i32 s38, s17, 1104
  s_add_u32 s38, s38, 26624
  s_mov_b32 s30, 0
  v_mov_b32 v36, 0
ch_md7:
  buffer_load_dword v37, v36, s[12:15], 0 offen sc1
  s_waitcnt vmcnt(0)
  v_readfirstlane_b32 s22, v37
  s_and_b32 s31, s22, 0xffff
  s_cmp_ge_u32 s31, 32
  s_cbranch_scc1 ch_go7
  s_sleep 2
  s_add_u32 s30, s30, 1
  s_cmp_lt_u32 s30, 3200000
  s_cbranch_scc1 ch_md7
  s_branch ch_end
ch_go7:
  s_mov_b32 s31, 0
  s_lshr_b32 s22, s22, 16
  s_cmp_lg_u32 s22, 0
  s_cbranch_scc1 cB_va3_loop
  s_branch cA_va3_loop
cA_sc0_loop:
  s_add_u32 s23, s20, 4096
  s_add_u32 s21, s20, 25600
  v_mov_b32 v48, 0
  v_mov_b32 v49, 0
  v_mov_b32 v50, 0
  v_mov_b32 v51, 0
  v_mov_b32 v52, 0
  v_mov_b32 v53, 0
  v_mov_b32 v54, 0
  v_mov_b32 v55, 0
  v_mov_b32 v56, 0
  v_mov_b32 v57, 0
  v_mov_b32 v58, 0
  v_mov_b32 v59, 0
  v_mov_b32 v60, 0
  v_mov_b32 v61, 0
  v_mov_b32 v62, 0
  v_mov_b32 v63, 0
  v_mov_b32 v88, 0
  v_mov_b32 v89, 0
  v_mov_b32 v90, 0
  v_mov_b32 v91, 0
  v_mov_b32 v92, 0
  v_mov_b32 v93, 0
  v_mov_b32 v94, 0
  v_mov_b32 v95, 0
  v_mov_b32 v66, 0
  v_mov_b32 v67, 0
  s_mov_b32 s30, 0
  s_mov_b32 s62, 0
  buffer_load_dword v68, v0, s[8:11], s20 offen sc1
  s_nop 7
  buffer_load_dword v69, v0, s[8:11], s20 offen sc1
  s_nop 7
  buffer_load_dword v70, v0, s[8:11], s20 offen sc1
  s_nop 7
  buffer_load_dword v71, v0, s[8:11], s20 offen sc1
  s_nop 7
  buffer_load_dword v72, v0, s[8:11], s20 offen sc1
cA_sc0_fp_l:
  s_waitcnt vmcnt(4)
  v_cmp_eq_u32 vcc, -1, v68
  s_cbranch_vccz cA_sc0_fp_d
  buffer_load_dword v68, v0, s[8:11], s20 offen sc1
  s_waitcnt vmcnt(4)
  v_cmp_eq_u32 vcc, -1, v69
  s_cbranch_vccz cA_sc0_fp_d
  buffer_load_dword v69, v0, s[8:11], s20 offen sc1
  s_waitcnt vmcnt(4)
  v_cmp_eq_u32 vcc, -1, v70
  s_cbranch_vccz cA_sc0_fp_d
  buffer_load_dword v70, v0, s[8:11], s20 offen sc1
  s_waitcnt vmcnt(4)
  v_cmp_eq_u32 vcc, -1, v71
  s_cbranch_vccz cA_sc0_fp_d
  buffer_load_dword v71, v0, s[8:11], s20 offen sc1
  s_waitcnt vmcnt(4)
  v_cmp_eq_u32 vcc, -1, v72
  s_cbranch_vccz cA_sc0_fp_d
  buffer_load_dword v72, v0, s[8:11], s20 offen sc1
  s_add_u32 s30, s30, 1
  s_cmp_lt_u32 s30, 400000
  s_cbranch_scc1 cA_sc0_fp_l
  s_branch cA_abort
cA_sc0_fp_d:
  buffer_load_dwordx4 v[8:11], v2, s[8:11], s20 offen offset:0
  s_barrier
  s_branch cA_sc0_ld1
cA_sc0_ld:
  buffer_load_dwordx4 v[8:11], v2, s[8:11], s20 offen offset:0
cA_sc0_ld1:
  v_mov_b32 v36, 0
  v_mov_b32 v37, 0
  v_mov_b32 v38, 0
  v_mov_b32 v39, 0
  buffer_load_dwordx4 v[12:15], v2, s[8:11], s20 offen offset:1024
  v_mov_b32 v40, 0
  v_mov_b32 v41, 0
  v_mov_b32 v42, 0
  v_mov_b32 v43, 0
  buffer_load_dwordx4 v[16:19], v2, s[8:11], s20 offen offset:2048
  v_mov_b32 v44, 0
  v_mov_b32 v45, 0
  v_mov_b32 v46, 0
  v_mov_b32 v47, 0
  ds_read_b128 v[96:99], v116 offset:12288
  ds_read_b128 v[100:103], v116 offset:13312
  ds_read_b128 v[104:107], v116 offset:26624
  ds_read_b128 v[108:111], v116 offset:27648
  s_waitcnt vmcnt(2)
  v_smfmac_f32_16x16x64_bf16 v[36:39], v[8:11], a[0:7], v3
  v_smfmac_f32_16x16x64_bf16 v[40:43], v[8:11], a[56:63], v3
  buffer_load_dwordx4 v[20:23], v2, s[8:11], s20 offen offset:3072
  v_smfmac_f32_16x16x64_bf16 v[44:47], v[8:11], a[112:119], v3
  v_smfmac_f32_16x16x64_bf16 v[48:51], v[8:11], a[168:175], v3
  v_smfmac_f32_16x16x64_bf16 v[52:55], v[8:11], a[224:231], v3
  buffer_load_dwordx4 v[24:27], v2, s[8:11], s23 offen offset:0
  v_smfmac_f32_16x16x64_bf16 v[56:59], v[8:11], v[144:151], v3
  v_smfmac_f32_16x16x64_bf16 v[60:63], v[8:11], v[200:207], v3
  s_waitcnt vmcnt(3)
  v_smfmac_f32_16x16x64_bf16 v[36:39], v[12:15], a[8:15], v3
  v_smfmac_f32_16x16x64_bf16 v[40:43], v[12:15], a[64:71], v3
  buffer_load_dwordx4 v[28:31], v2, s[8:11], s23 offen offset:1024
  v_smfmac_f32_16x16x64_bf16 v[44:47], v[12:15], a[120:127], v3
  v_smfmac_f32_16x16x64_bf16 v[48:51], v[12:15], a[176:183], v3
  v_smfmac_f32_16x16x64_bf16 v[52:55], v[12:15], a[232:239], v3
  buffer_load_dwordx4 v[32:35], v2, s[8:11], s23 offen offset:2048
  v_smfmac_f32_16x16x64_bf16 v[56:59], v[12:15], v[152:159], v3
  v_smfmac_f32_16x16x64_bf16 v[60:63], v[12:15], v[208:215], v3
  s_waitcnt vmcnt(4)
  v_smfmac_f32_16x16x64_bf16 v[36:39], v[16:19], a[16:23], v3
  v_smfmac_f32_16x16x64_bf16 v[40:43], v[16:19], a[72:79], v3
  v_smfmac_f32_16x16x64_bf16 v[44:47], v[16:19], a[128:135], v3
  v_smfmac_f32_16x16x64_bf16 v[48:51], v[16:19], a[184:191], v3
  v_smfmac_f32_16x16x64_bf16 v[52:55], v[16:19], a[240:247], v3
  v_smfmac_f32_16x16x64_bf16 v[56:59], v[16:19], v[160:167], v3
  v_smfmac_f32_16x16x64_bf16 v[60:63], v[16:19], v[216:223], v3
  s_waitcnt vmcnt(3)
  v_smfmac_f32_16x16x64_bf16 v[36:39], v[20:23], a[24:31], v3
  v_smfmac_f32_16x16x64_bf16 v[40:43], v[20:23], a[80:87], v3
  v_smfmac_f32_16x16x64_bf16 v[44:47], v[20:23], a[136:143], v3
  v_smfmac_f32_16x16x64_bf16 v[48:51], v[20:23], a[192:199], v3
  v_smfmac_f32_16x16x64_bf16 v[52:55], v[20:23], a[248:255], v3
  v_smfmac_f32_16x16x64_bf16 v[56:59], v[20:23], v[168:175], v3
  v_smfmac_f32_16x16x64_bf16 v[60:63], v[20:23], v[224:231], v3
  s_waitcnt vmcnt(0)
cA_sc0_ph2:
  v_smfmac_f32_16x16x64_bf16 v[60:63], v[24:27], v[232:239], v3
  ds_read_b128 v[12:15], v116 offset:8192
  ds_read_b128 v[16:19], v116 offset:9216
  v_smfmac_f32_16x16x64_bf16 v[60:63], v[28:31], v[240:247], v3
  v_smfmac_f32_16x16x64_bf16 v[60:63], v[32:35], v[248:255], v3
  v_smfmac_f32_16x16x64_bf16 v[52:55], v[24:27], v[120:127], v3
  v_smfmac_f32_16x16x64_bf16 v[52:55], v[28:31], v[128:135], v3
  v_smfmac_f32_16x16x64_bf16 v[52:55], v[32:35], v[136:143], v3
  v_cvt_pk_bf16_f32 v64, v60, v61
  v_smfmac_f32_16x16x64_bf16 v[56:59], v[24:27], v[176:183], v3
  v_cvt_pk_bf16_f32 v65, v62, v63
  v_smfmac_f32_16x16x64_bf16 v[56:59], v[28:31], v[184:191], v3
  v_mfma_f32_16x16x32_bf16 v[68:71], v[64:67], v[4:7], 0
  v_smfmac_f32_16x16x64_bf16 v[56:59], v[32:35], v[192:199], v3
  v_cvt_pk_bf16_f32 v64, v52, v53
  v_smfmac_f32_16x16x64_bf16 v[36:39], v[24:27], a[32:39], v3
  v_cvt_pk_bf16_f32 v65, v54, v55
  v_smfmac_f32_16x16x64_bf16 v[36:39], v[28:31], a[40:47], v3
  v_cvt_pk_bf16_f32 v76, v68, v69
  v_smfmac_f32_16x16x64_bf16 v[36:39], v[32:35], a[48:55], v3
  v_cvt_pk_bf16_f32 v77, v70, v71
  v_cvt_pk_bf16_f32 v66, v56, v57
  v_smfmac_f32_16x16x64_bf16 v[40:43], v[24:27], a[88:95], v3
  v_cvt_pk_bf16_f32 v67, v58, v59
  v_smfmac_f32_16x16x64_bf16 v[40:43], v[28:31], a[96:103], v3
  v_mfma_f32_16x16x32_bf16 v[72:75], v[64:67], v[4:7], 0
  ds_read_b128 v[52:55], v116 offset:22528
  ds_read_b128 v[56:59], v116 offset:23552
  v_smfmac_f32_16x16x64_bf16 v[40:43], v[32:35], a[104:111], v3
  v_cvt_pk_bf16_f32 v64, v36, v37
  v_smfmac_f32_16x16x64_bf16 v[44:47], v[24:27], a[144:151], v3
  v_cvt_pk_bf16_f32 v65, v38, v39
  v_smfmac_f32_16x16x64_bf16 v[44:47], v[28:31], a[152:159], v3
  v_cvt_pk_bf16_f32 v80, v72, v73
  v_smfmac_f32_16x16x64_bf16 v[44:47], v[32:35], a[160:167], v3
  v_cvt_pk_bf16_f32 v81, v74, v75
  v_cvt_pk_bf16_f32 v66, v40, v41
  v_smfmac_f32_16x16x64_bf16 v[48:51], v[24:27], a[200:207], v3
  v_cvt_pk_bf16_f32 v67, v42, v43
  v_smfmac_f32_16x16x64_bf16 v[48:51], v[28:31], a[208:215], v3
  v_mfma_f32_16x16x32_bf16 v[68:71], v[64:67], v[4:7], 0
  ds_read_b128 v[36:39], v116 offset:0
  ds_read_b128 v[40:43], v116 offset:1024
  v_smfmac_f32_16x16x64_bf16 v[48:51], v[32:35], a[216:223], v3
  s_waitcnt lgkmcnt(4)
  v_cvt_pk_bf16_f32 v64, v44, v45
  v_mfma_f32_16x16x32_bf16 v[84:87], v[32:35], v[76:79], 0
  v_cvt_pk_bf16_f32 v65, v46, v47
  v_smfmac_f32_16x16x64_bf16 v[88:91], v[76:79], v[96:103], v3
  ds_read_b128 v[96:99], v116 offset:14336
  ds_read_b128 v[100:103], v116 offset:15360
  v_smfmac_f32_16x16x64_bf16 v[92:95], v[76:79], v[104:111], v3
  v_cvt_pk_bf16_f32 v66, v48, v49
  v_cvt_pk_bf16_f32 v67, v50, v51
  v_mfma_f32_16x16x32_bf16 v[84:87], v[24:27], v[80:83], v[84:87]
  v_cvt_pk_bf16_f32 v60, v68, v69
  v_mfma_f32_16x16x32_bf16 v[72:75], v[64:67], v[4:7], 0
  v_cvt_pk_bf16_f32 v61, v70, v71
  s_waitcnt lgkmcnt(4)
  v_smfmac_f32_16x16x64_bf16 v[88:91], v[80:83], v[12:19], v3
  v_smfmac_f32_16x16x64_bf16 v[92:95], v[80:83], v[52:59], v3
  s_waitcnt lgkmcnt(0)
  s_nop 0
  v_cvt_pk_bf16_f32 v62, v72, v73
  v_cvt_pk_bf16_f32 v63, v74, v75
  s_nop 1
  v_mfma_f32_16x16x32_bf16 v[84:87], v[8:11], v[60:63], v[84:87]
  v_smfmac_f32_16x16x64_bf16 v[88:91], v[60:63], v[36:43], v3
  v_smfmac_f32_16x16x64_bf16 v[92:95], v[60:63], v[96:103], v3
  s_mov_b64 exec, s[26:27]
  s_nop 0
  ds_write_b128 v113, v[84:87]
  s_mov_b64 exec, -1
  s_nop 0
  v_cmp_u_f32 vcc, v88, v89
  s_nop 1
  v_permlane32_swap_b32 v88, v92
  v_permlane32_swap_b32 v89, v93
  v_permlane32_swap_b32 v90, v94
  v_permlane32_swap_b32 v91, v95
  v_add_f32 v88, v88, v92
  v_add_f32 v89, v89, v93
  v_add_f32 v90, v90, v94
  v_add_f32 v91, v91, v95
  ds_write_b128 v112, v[88:91]
  s_cbranch_vccnz cA_sc0_retry
cA_sc0_cont:
  s_waitcnt lgkmcnt(0)
  s_barrier
  ds_read_b64 v[36:37], v114 offset:0
  ds_read_b64 v[38:39], v114 offset:1024
  ds_read2_b32 v[44:45], v115 offset0:0 offset1:64
  s_waitcnt lgkmcnt(0)
  v_add_f32 v44, v44, v45
  v_add_f32 v36, v36, v38
  v_add_f32 v37, v37, v39
  v_add_f32_dpp v44, v44, v44 row_ror:8 row_mask:0xf bank_mask:0xf
  v_mov_b32 v45, v44
  v_permlane32_swap_b32 v36, v37
  v_add_f32 v36, v36, v37
  v_permlane16_swap_b32 v44, v45
  v_add_f32 v44, v44, v45
  v_max_f32 v38, v36, v44
  s_nop 1
  v_max_f32_dpp v38, v38, v38 quad_perm:[1,0,3,2] row_mask:0xf bank_mask:0xf
  s_nop 1
  v_max_f32_dpp v38, v38, v38 quad_perm:[2,3,0,1] row_mask:0xf bank_mask:0xf
  s_nop 1
  v_max_f32_dpp v38, v38, v38 row_half_mirror row_mask:0xf bank_mask:0xf
  s_nop 1
  v_max_f32_dpp v38, v38, v38 row_mirror row_mask:0xf bank_mask:0xf
  v_mov_b32 v39, v38
  s_nop 1
  v_permlane16_swap_b32 v38, v39
  v_max_f32 v38, v38, v39
  v_sub_f32 v36, v36, v38
  v_sub_f32 v44, v44, v38
  v_exp_f32 v36, v36
  v_exp_f32 v44, v44
  s_nop 0
  v_fma_f32 v39, v44, s37, v36
  v_cndmask_b32 v40, v44, v36, s[38:39]
  v_cndmask_b32 v41, v36, v44, s[38:39]
  v_add_f32_dpp v39, v39, v39 quad_perm:[1,0,3,2] row_mask:0xf bank_mask:0xf
  s_nop 0
  v_mov_b32_dpp v46, v41 quad_perm:[1,0,3,2] row_mask:0xf bank_mask:0xf
  v_add_f32_dpp v39, v39, v39 quad_perm:[2,3,0,1] row_mask:0xf bank_mask:0xf
  v_cndmask_b32 v42, v46, v40, s[38:39]
  v_cndmask_b32 v43, v40, v46, s[38:39]
  v_add_f32_dpp v39, v39, v39 row_half_mirror row_mask:0xf bank_mask:0xf
  s_nop 1
  v_add_f32_dpp v39, v39, v39 row_mirror row_mask:0xf bank_mask:0xf
  v_mov_b32 v47, v39
  s_nop 1
  v_permlane16_swap_b32 v39, v47
  v_add_f32 v39, v39, v47
  v_rcp_f32 v39, v39
  s_nop 0
  v_mul_f32 v42, v42, v39
  v_mul_f32 v43, v43, v39
  v_cvt_pk_bf16_f32 v42, v42, v43
  v_min_u32 v42, -2, v42
  s_mov_b64 exec, s[28:29]
  buffer_store_dword v42, v1, s[8:11], s20 offen
  s_mov_b64 exec, -1
  s_barrier
  s_add_u32 s24, s24, 28672
  s_add_u32 s35, s35, 28672
  s_xor_b32 s25, s25, 28672
  s_add_u32 m0, s25, 0
  s_nop 0
  buffer_load_dwordx4 v2, s[8:11], s24 offen offset:0 lds
  buffer_load_dwordx4 v2, s[8:11], s24 offen offset:1024 lds
  buffer_load_dwordx4 v2, s[8:11], s24 offen offset:2048 lds
  buffer_load_dwordx4 v2, s[8:11], s24 offen offset:3072 lds
  s_add_u32 m0, s25, 4096
  s_add_u32 s22, s24, 4096
  buffer_load_dwordx4 v2, s[8:11], s22 offen offset:0 lds
  buffer_load_dwordx4 v2, s[8:11], s22 offen offset:1024 lds
  buffer_load_dwordx4 v2, s[8:11], s22 offen offset:2048 lds
  v_xor_b32 v116, 28672, v116
  s_add_u32 s19, s19, 1
  s_mov_b32 s20, s21
  s_cmp_lt_u32 s19, 63
  s_cbranch_scc1 cA_sc0_loop
  s_branch cA_done
cA_sc0_retry:
  s_cmp_lg_u32 s62, 0
  s_cbranch_scc1 cA_sc0_cont
  s_waitcnt vmcnt(0) lgkmcnt(0)
cA_sc0_rv:
  buffer_load_dwordx4 v[8:11], v2, s[8:11], s20 offen offset:0 sc1
  buffer_load_dwordx4 v[12:15], v2, s[8:11], s20 offen offset:1024 sc1
  buffer_load_dwordx4 v[16:19], v2, s[8:11], s20 offen offset:2048 sc1
  buffer_load_dwordx4 v[20:23], v2, s[8:11], s20 offen offset:3072 sc1
  buffer_load_dwordx4 v[24:27], v2, s[8:11], s23 offen offset:0 sc1
  buffer_load_dwordx4 v[28:31], v2, s[8:11], s23 offen offset:1024 sc1
  buffer_load_dwordx4 v[32:35], v2, s[8:11], s23 offen offset:2048 sc1
  s_waitcnt vmcnt(0)
  v_max3_u32 v118, v8, v9, v10
  v_max3_u32 v118, v118, v11, v12
  v_max3_u32 v118, v118, v13, v14
  v_max3_u32 v118, v118, v15, v16
  v_max3_u32 v118, v118, v17, v18
  v_max3_u32 v118, v118, v19, v20
  v_max3_u32 v118, v118, v21, v22
  v_max3_u32 v118, v118, v23, v24
  v_max3_u32 v118, v118, v25, v26
  v_max3_u32 v118, v118, v27, v28
  v_max3_u32 v118, v118, v29, v30
  v_max3_u32 v118, v118, v31, v32
  v_max3_u32 v118, v118, v33, v34
  v_max_u32 v118, v118, v35
  v_cmp_eq_u32 vcc, -1, v118
  s_cbranch_vccz cA_sc0_rk
  s_add_u32 s30, s30, 1
  s_cmp_lt_u32 s30, 400000
  s_cbranch_scc1 cA_sc0_rv
  s_branch cA_abort
cA_sc0_rk:
  s_mov_b32 s62, 1
  v_mov_b32 v36, 0
  v_mov_b32 v37, 0
  v_mov_b32 v38, 0
  v_mov_b32 v39, 0
  v_mov_b32 v40, 0
  v_mov_b32 v41, 0
  v_mov_b32 v42, 0
  v_mov_b32 v43, 0
  v_mov_b32 v44, 0
  v_mov_b32 v45, 0
  v_mov_b32 v46, 0
  v_mov_b32 v47, 0
  v_mov_b32 v48, 0
  v_mov_b32 v49, 0
  v_mov_b32 v50, 0
  v_mov_b32 v51, 0
  v_mov_b32 v52, 0
  v_mov_b32 v53, 0
  v_mov_b32 v54, 0
  v_mov_b32 v55, 0
  v_mov_b32 v56, 0
  v_mov_b32 v57, 0
  v_mov_b32 v58, 0
  v_mov_b32 v59, 0
  v_mov_b32 v60, 0
  v_mov_b32 v61, 0
  v_mov_b32 v62, 0
  v_mov_b32 v63, 0
  v_mov_b32 v88, 0
  v_mov_b32 v89, 0
  v_mov_b32 v90, 0
  v_mov_b32 v91, 0
  v_mov_b32 v92, 0
  v_mov_b32 v93, 0
  v_mov_b32 v94, 0
  v_mov_b32 v95, 0
  v_mov_b32 v66, 0
  v_mov_b32 v67, 0
  s_add_u32 s31, s31, 1
  ds_read_b128 v[96:99], v116 offset:12288
  ds_read_b128 v[100:103], v116 offset:13312
  ds_read_b128 v[104:107], v116 offset:26624
  ds_read_b128 v[108:111], v116 offset:27648
  v_smfmac_f32_16x16x64_bf16 v[36:39], v[8:11], a[0:7], v3
  v_smfmac_f32_16x16x64_bf16 v[40:43], v[8:11], a[56:63], v3
  v_smfmac_f32_16x16x64_bf16 v[44:47], v[8:11], a[112:119], v3
  v_smfmac_f32_16x16x64_bf16 v[48:51], v[8:11], a[168:175], v3
  v_smfmac_f32_16x16x64_bf16 v[52:55], v[8:11], a[224:231], v3
  v_smfmac_f32_16x16x64_bf16 v[56:59], v[8:11], v[144:151], v3
  v_smfmac_f32_16x16x64_bf16 v[60:63], v[8:11], v[200:207], v3
  v_smfmac_f32_16x16x64_bf16 v[36:39], v[12:15], a[8:15], v3
  v_smfmac_f32_16x16x64_bf16 v[40:43], v[12:15], a[64:71], v3
  v_smfmac_f32_16x16x64_bf16 v[44:47], v[12:15], a[120:127], v3
  v_smfmac_f32_16x16x64_bf16 v[48:51], v[12:15], a[176:183], v3
  v_smfmac_f32_16x16x64_bf16 v[52:55], v[12:15], a[232:239], v3
  v_smfmac_f32_16x16x64_bf16 v[56:59], v[12:15], v[152:159], v3
  v_smfmac_f32_16x16x64_bf16 v[60:63], v[12:15], v[208:215], v3
  v_smfmac_f32_16x16x64_bf16 v[36:39], v[16:19], a[16:23], v3
  v_smfmac_f32_16x16x64_bf16 v[40:43], v[16:19], a[72:79], v3
  v_smfmac_f32_16x16x64_bf16 v[44:47], v[16:19], a[128:135], v3
  v_smfmac_f32_16x16x64_bf16 v[48:51], v[16:19], a[184:191], v3
  v_smfmac_f32_16x16x64_bf16 v[52:55], v[16:19], a[240:247], v3
  v_smfmac_f32_16x16x64_bf16 v[56:59], v[16:19], v[160:167], v3
  v_smfmac_f32_16x16x64_bf16 v[60:63], v[16:19], v[216:223], v3
  v_smfmac_f32_16x16x64_bf16 v[36:39], v[20:23], a[24:31], v3
  v_smfmac_f32_16x16x64_bf16 v[40:43], v[20:23], a[80:87], v3
  v_smfmac_f32_16x16x64_bf16 v[44:47], v[20:23], a[136:143], v3
  v_smfmac_f32_16x16x64_bf16 v[48:51], v[20:23], a[192:199], v3
  v_smfmac_f32_16x16x64_bf16 v[52:55], v[20:23], a[248:255], v3
  v_smfmac_f32_16x16x64_bf16 v[56:59], v[20:23], v[168:175], v3
  v_smfmac_f32_16x16x64_bf16 v[60:63], v[20:23], v[224:231], v3
  s_branch cA_sc0_ph2
cA_sc1_loop:
  s_add_u32 s23, s20, 4096
  s_add_u32 s21, s20, 25600
  v_mov_b32 v48, 0
  v_mov_b32 v49, 0
  v_mov_b32 v50, 0
  v_mov_b32 v51, 0
  v_mov_b32 v52, 0
  v_mov_b32 v53, 0
  v_mov_b32 v54, 0
  v_mov_b32 v55, 0
  v_mov_b32 v56, 0
  v_mov_b32 v57, 0
  v_mov_b32 v58, 0
  v_mov_b32 v59, 0
  v_mov_b32 v60, 0
  v_mov_b32 v61, 0
  v_mov_b32 v62, 0
  v_mov_b32 v63, 0
  v_mov_b32 v88, 0
  v_mov_b32 v89, 0
  v_mov_b32 v90, 0
  v_mov_b32 v91, 0
  v_mov_b32 v92, 0
  v_mov_b32 v93, 0
  v_mov_b32 v94, 0
  v_mov_b32 v95, 0
  v_mov_b32 v64, 0
  v_mov_b32 v65, 0
  s_mov_b32 s30, 0
  s_mov_b32 s62, 0
  s_waitcnt vmcnt(0)
  s_barrier
cA_sc1_ld:
  buffer_load_dwordx4 v[8:11], v2, s[8:11], s20 offen offset:0
  v_mov_b32 v36, 0
  v_mov_b32 v37, 0
  v_mov_b32 v38, 0
  v_mov_b32 v39, 0
  buffer_load_dwordx4 v[12:15], v2, s[8:11], s20 offen offset:1024
  v_mov_b32 v40, 0
  v_mov_b32 v41, 0
  v_mov_b32 v42, 0
  v_mov_b32 v43, 0
  buffer_load_dwordx4 v[16:19], v2, s[8:11], s20 offen offset:2048
  v_mov_b32 v44, 0
  v_mov_b32 v45, 0
  v_mov_b32 v46, 0
  v_mov_b32 v47, 0
  ds_read_b128 v[96:99], v116 offset:12288
  ds_read_b128 v[100:103], v116 offset:13312
  ds_read_b128 v[104:107], v116 offset:26624
  ds_read_b128 v[108:111], v116 offset:27648
  s_waitcnt vmcnt(2)
  v_smfmac_f32_16x16x64_bf16 v[36:39], v[8:11], a[0:7], v3
  v_smfmac_f32_16x16x64_bf16 v[40:43], v[8:11], a[56:63], v3
  buffer_load_dwordx4 v[20:23], v2, s[8:11], s20 offen offset:3072
  v_smfmac_f32_16x16x64_bf16 v[44:47], v[8:11], a[112:119], v3
  v_smfmac_f32_16x16x64_bf16 v[48:51], v[8:11], a[168:175], v3
  v_smfmac_f32_16x16x64_bf16 v[52:55], v[8:11], a[224:231], v3
  buffer_load_dwordx4 v[24:27], v2, s[8:11], s23 offen offset:0
  v_smfmac_f32_16x16x64_bf16 v[56:59], v[8:11], v[144:151], v3
  v_smfmac_f32_16x16x64_bf16 v[60:63], v[8:11], v[200:207], v3
  s_waitcnt vmcnt(3)
  v_smfmac_f32_16x16x64_bf16 v[36:39], v[12:15], a[8:15], v3
  v_smfmac_f32_16x16x64_bf16 v[40:43], v[12:15], a[64:71], v3
  buffer_load_dwordx4 v[28:31], v2, s[8:11], s23 offen offset:1024
  v_smfmac_f32_16x16x64_bf16 v[44:47], v[12:15], a[120:127], v3
  v_smfmac_f32_16x16x64_bf16 v[48:51], v[12:15], a[176:183], v3
  v_smfmac_f32_16x16x64_bf16 v[52:55], v[12:15], a[232:239], v3
  buffer_load_dwordx4 v[32:35], v2, s[8:11], s23 offen offset:2048
  v_smfmac_f32_16x16x64_bf16 v[56:59], v[12:15], v[152:159], v3
  v_smfmac_f32_16x16x64_bf16 v[60:63], v[12:15], v[208:215], v3
  s_waitcnt vmcnt(4)
  v_smfmac_f32_16x16x64_bf16 v[36:39], v[16:19], a[16:23], v3
  v_smfmac_f32_16x16x64_bf16 v[40:43], v[16:19], a[72:79], v3
  v_smfmac_f32_16x16x64_bf16 v[44:47], v[16:19], a[128:135], v3
  v_smfmac_f32_16x16x64_bf16 v[48:51], v[16:19], a[184:191], v3
  v_smfmac_f32_16x16x64_bf16 v[52:55], v[16:19], a[240:247], v3
  v_smfmac_f32_16x16x64_bf16 v[56:59], v[16:19], v[160:167], v3
  v_smfmac_f32_16x16x64_bf16 v[60:63], v[16:19], v[216:223], v3
  s_waitcnt vmcnt(3)
  v_smfmac_f32_16x16x64_bf16 v[36:39], v[20:23], a[24:31], v3
  v_smfmac_f32_16x16x64_bf16 v[40:43], v[20:23], a[80:87], v3
  v_smfmac_f32_16x16x64_bf16 v[44:47], v[20:23], a[136:143], v3
  v_smfmac_f32_16x16x64_bf16 v[48:51], v[20:23], a[192:199], v3
  v_smfmac_f32_16x16x64_bf16 v[52:55], v[20:23], a[248:255], v3
  v_smfmac_f32_16x16x64_bf16 v[56:59], v[20:23], v[168:175], v3
  v_smfmac_f32_16x16x64_bf16 v[60:63], v[20:23], v[224:231], v3
  s_waitcnt vmcnt(0)
cA_sc1_ph2:
  v_smfmac_f32_16x16x64_bf16 v[60:63], v[24:27], v[232:239], v3
  ds_read_b128 v[16:19], v116 offset:8192
  ds_read_b128 v[20:23], v116 offset:9216
  v_smfmac_f32_16x16x64_bf16 v[60:63], v[28:31], v[240:247], v3
  buffer_load_dword v119, v0, s[8:11], s20 offen sc1
  v_smfmac_f32_16x16x64_bf16 v[60:63], v[32:35], v[248:255], v3
  v_smfmac_f32_16x16x64_bf16 v[52:55], v[24:27], v[120:127], v3
  v_smfmac_f32_16x16x64_bf16 v[52:55], v[28:31], v[128:135], v3
  v_smfmac_f32_16x16x64_bf16 v[52:55], v[32:35], v[136:143], v3
  v_cvt_pk_bf16_f32 v66, v60, v61
  v_smfmac_f32_16x16x64_bf16 v[56:59], v[24:27], v[176:183], v3
  v_cvt_pk_bf16_f32 v67, v62, v63
  v_smfmac_f32_16x16x64_bf16 v[56:59], v[28:31], v[184:191], v3
  v_mfma_f32_16x16x32_bf16 v[68:71], v[64:67], v[4:7], 0
  v_smfmac_f32_16x16x64_bf16 v[56:59], v[32:35], v[192:199], v3
  v_cvt_pk_bf16_f32 v64, v52, v53
  v_smfmac_f32_16x16x64_bf16 v[36:39], v[24:27], a[32:39], v3
  v_cvt_pk_bf16_f32 v65, v54, v55
  v_smfmac_f32_16x16x64_bf16 v[36:39], v[28:31], a[40:47], v3
  v_cvt_pk_bf16_f32 v76, v68, v69
  v_smfmac_f32_16x16x64_bf16 v[36:39], v[32:35], a[48:55], v3
  v_cvt_pk_bf16_f32 v77, v70, v71
  v_cvt_pk_bf16_f32 v66, v56, v57
  v_smfmac_f32_16x16x64_bf16 v[40:43], v[24:27], a[88:95], v3
  v_cvt_pk_bf16_f32 v67, v58, v59
  v_smfmac_f32_16x16x64_bf16 v[40:43], v[28:31], a[96:103], v3
  v_mfma_f32_16x16x32_bf16 v[72:75], v[64:67], v[4:7], 0
  ds_read_b128 v[52:55], v116 offset:22528
  ds_read_b128 v[56:59], v116 offset:23552
  v_smfmac_f32_16x16x64_bf16 v[40:43], v[32:35], a[104:111], v3
  v_cvt_pk_bf16_f32 v64, v36, v37
  v_smfmac_f32_16x16x64_bf16 v[44:47], v[24:27], a[144:151], v3
  v_cvt_pk_bf16_f32 v65, v38, v39
  v_smfmac_f32_16x16x64_bf16 v[44:47], v[28:31], a[152:159], v3
  v_cvt_pk_bf16_f32 v82, v72, v73
  v_smfmac_f32_16x16x64_bf16 v[44:47], v[32:35], a[160:167], v3
  v_cvt_pk_bf16_f32 v83, v74, v75
  v_cvt_pk_bf16_f32 v66, v40, v41
  v_smfmac_f32_16x16x64_bf16 v[48:51], v[24:27], a[200:207], v3
  v_cvt_pk_bf16_f32 v67, v42, v43
  v_smfmac_f32_16x16x64_bf16 v[48:51], v[28:31], a[208:215], v3
  v_mfma_f32_16x16x32_bf16 v[68:71], v[64:67], v[4:7], 0
  ds_read_b128 v[36:39], v116 offset:2048
  ds_read_b128 v[40:43], v116 offset:3072
  v_smfmac_f32_16x16x64_bf16 v[48:51], v[32:35], a[216:223], v3
  s_waitcnt lgkmcnt(4)
  v_cvt_pk_bf16_f32 v64, v44, v45
  v_mfma_f32_16x16x32_bf16 v[84:87], v[32:35], v[76:79], 0
  v_cvt_pk_bf16_f32 v65, v46, v47
  v_smfmac_f32_16x16x64_bf16 v[88:91], v[76:79], v[96:103], v3
  ds_read_b128 v[96:99], v116 offset:16384
  ds_read_b128 v[100:103], v116 offset:17408
  v_smfmac_f32_16x16x64_bf16 v[92:95], v[76:79], v[104:111], v3
  v_cvt_pk_bf16_f32 v66, v48, v49
  v_cvt_pk_bf16_f32 v67, v50, v51
  v_mfma_f32_16x16x32_bf16 v[84:87], v[24:27], v[80:83], v[84:87]
  v_cvt_pk_bf16_f32 v60, v68, v69
  v_mfma_f32_16x16x32_bf16 v[72:75], v[64:67], v[4:7], 0
  v_cvt_pk_bf16_f32 v61, v70, v71
  s_waitcnt lgkmcnt(4)
  v_smfmac_f32_16x16x64_bf16 v[88:91], v[80:83], v[16:23], v3
  v_smfmac_f32_16x16x64_bf16 v[92:95], v[80:83], v[52:59], v3
  s_waitcnt lgkmcnt(0)
  s_nop 0
  v_cvt_pk_bf16_f32 v62, v72, v73
  v_cvt_pk_bf16_f32 v63, v74, v75
  s_nop 1
  v_mfma_f32_16x16x32_bf16 v[84:87], v[12:15], v[60:63], v[84:87]
  v_smfmac_f32_16x16x64_bf16 v[88:91], v[60:63], v[36:43], v3
  v_smfmac_f32_16x16x64_bf16 v[92:95], v[60:63], v[96:103], v3
  s_mov_b64 exec, s[26:27]
  s_nop 0
  ds_write_b128 v113, v[84:87]
  s_mov_b64 exec, -1
  s_nop 0
  v_cmp_u_f32 vcc, v88, v89
  s_nop 1
  v_permlane32_swap_b32 v88, v92
  v_permlane32_swap_b32 v89, v93
  v_permlane32_swap_b32 v90, v94
  v_permlane32_swap_b32 v91, v95
  v_add_f32 v88, v88, v92
  v_add_f32 v89, v89, v93
  v_add_f32 v90, v90, v94
  v_add_f32 v91, v91, v95
  ds_write_b128 v112, v[88:91]
  s_cbranch_vccnz cA_sc1_retry
cA_sc1_cont:
  s_waitcnt lgkmcnt(0)
  s_barrier
  ds_read_b64 v[36:37], v114 offset:0
  ds_read_b64 v[38:39], v114 offset:1024
  ds_read2_b32 v[44:45], v115 offset0:0 offset1:64
  s_waitcnt lgkmcnt(0)
  v_add_f32 v44, v44, v45
  v_add_f32 v36, v36, v38
  v_add_f32 v37, v37, v39
  v_add_f32_dpp v44, v44, v44 row_ror:8 row_mask:0xf bank_mask:0xf
  v_mov_b32 v45, v44
  v_permlane32_swap_b32 v36, v37
  v_add_f32 v36, v36, v37
  v_permlane16_swap_b32 v44, v45
  v_add_f32 v44, v44, v45
  v_max_f32 v38, v36, v44
  s_nop 1
  v_max_f32_dpp v38, v38, v38 quad_perm:[1,0,3,2] row_mask:0xf bank_mask:0xf
  s_nop 1
  v_max_f32_dpp v38, v38, v38 quad_perm:[2,3,0,1] row_mask:0xf bank_mask:0xf
  s_nop 1
  v_max_f32_dpp v38, v38, v38 row_half_mirror row_mask:0xf bank_mask:0xf
  s_nop 1
  v_max_f32_dpp v38, v38, v38 row_mirror row_mask:0xf bank_mask:0xf
  v_mov_b32 v39, v38
  s_nop 1
  v_permlane16_swap_b32 v38, v39
  v_max_f32 v38, v38, v39
  v_sub_f32 v36, v36, v38
  v_sub_f32 v44, v44, v38
  v_exp_f32 v36, v36
  v_exp_f32 v44, v44
  s_nop 0
  v_fma_f32 v39, v44, s37, v36
  v_cndmask_b32 v40, v44, v36, s[38:39]
  v_cndmask_b32 v41, v36, v44, s[38:39]
  v_add_f32_dpp v39, v39, v39 quad_perm:[1,0,3,2] row_mask:0xf bank_mask:0xf
  s_nop 0
  v_mov_b32_dpp v46, v41 quad_perm:[1,0,3,2] row_mask:0xf bank_mask:0xf
  v_add_f32_dpp v39, v39, v39 quad_perm:[2,3,0,1] row_mask:0xf bank_mask:0xf
  v_cndmask_b32 v42, v46, v40, s[38:39]
  v_cndmask_b32 v43, v40, v46, s[38:39]
  v_add_f32_dpp v39, v39, v39 row_half_mirror row_mask:0xf bank_mask:0xf
  s_nop 1
  v_add_f32_dpp v39, v39, v39 row_mirror row_mask:0xf bank_mask:0xf
  v_mov_b32 v47, v39
  s_nop 1
  v_permlane16_swap_b32 v39, v47
  v_add_f32 v39, v39, v47
  v_rcp_f32 v39, v39
  s_nop 0
  v_mul_f32 v42, v42, v39
  v_mul_f32 v43, v43, v39
  v_cvt_pk_bf16_f32 v42, v42, v43
  v_min_u32 v42, -2, v42
  s_mov_b64 exec, s[28:29]
  buffer_store_dword v42, v1, s[8:11], s20 offen
  s_mov_b64 exec, -1
  s_barrier
  s_add_u32 s24, s24, 28672
  s_add_u32 s35, s35, 28672
  s_xor_b32 s25, s25, 28672
  s_add_u32 m0, s25, 7168
  s_nop 0
  buffer_load_dwordx4 v2, s[8:11], s24 offen offset:0 lds
  buffer_load_dwordx4 v2, s[8:11], s24 offen offset:1024 lds
  buffer_load_dwordx4 v2, s[8:11], s24 offen offset:2048 lds
  buffer_load_dwordx4 v2, s[8:11], s24 offen offset:3072 lds
  s_add_u32 m0, s25, 11264
  s_add_u32 s22, s24, 4096
  buffer_load_dwordx4 v2, s[8:11], s22 offen offset:0 lds
  buffer_load_dwordx4 v2, s[8:11], s22 offen offset:1024 lds
  buffer_load_dwordx4 v2, s[8:11], s22 offen offset:2048 lds
  v_xor_b32 v116, 28672, v116
  s_add_u32 s19, s19, 1
  s_mov_b32 s20, s21
  s_cmp_lt_u32 s19, 63
  s_cbranch_scc1 cA_sc1_loop
  s_branch cA_done
cA_sc1_retry:
  s_cmp_lg_u32 s62, 0
  s_cbranch_scc1 cA_sc1_cont
  s_waitcnt vmcnt(0) lgkmcnt(0)
cA_sc1_rv:
  buffer_load_dwordx4 v[8:11], v2, s[8:11], s20 offen offset:0 sc1
  buffer_load_dwordx4 v[12:15], v2, s[8:11], s20 offen offset:1024 sc1
  buffer_load_dwordx4 v[16:19], v2, s[8:11], s20 offen offset:2048 sc1
  buffer_load_dwordx4 v[20:23], v2, s[8:11], s20 offen offset:3072 sc1
  buffer_load_dwordx4 v[24:27], v2, s[8:11], s23 offen offset:0 sc1
  buffer_load_dwordx4 v[28:31], v2, s[8:11], s23 offen offset:1024 sc1
  buffer_load_dwordx4 v[32:35], v2, s[8:11], s23 offen offset:2048 sc1
  s_waitcnt vmcnt(0)
  v_max3_u32 v118, v8, v9, v10
  v_max3_u32 v118, v118, v11, v12
  v_max3_u32 v118, v118, v13, v14
  v_max3_u32 v118, v118, v15, v16
  v_max3_u32 v118, v118, v17, v18
  v_max3_u32 v118, v118, v19, v20
  v_max3_u32 v118, v118, v21, v22
  v_max3_u32 v118, v118, v23, v24
  v_max3_u32 v118, v118, v25, v26
  v_max3_u32 v118, v118, v27, v28
  v_max3_u32 v118, v118, v29, v30
  v_max3_u32 v118, v118, v31, v32
  v_max3_u32 v118, v118, v33, v34
  v_max_u32 v118, v118, v35
  v_cmp_eq_u32 vcc, -1, v118
  s_cbranch_vccz cA_sc1_rk
  s_add_u32 s30, s30, 1
  s_cmp_lt_u32 s30, 400000
  s_cbranch_scc1 cA_sc1_rv
  s_branch cA_abort
cA_sc1_rk:
  s_mov_b32 s62, 1
  v_mov_b32 v36, 0
  v_mov_b32 v37, 0
  v_mov_b32 v38, 0
  v_mov_b32 v39, 0
  v_mov_b32 v40, 0
  v_mov_b32 v41, 0
  v_mov_b32 v42, 0
  v_mov_b32 v43, 0
  v_mov_b32 v44, 0
  v_mov_b32 v45, 0
  v_mov_b32 v46, 0
  v_mov_b32 v47, 0
  v_mov_b32 v48, 0
  v_mov_b32 v49, 0
  v_mov_b32 v50, 0
  v_mov_b32 v51, 0
  v_mov_b32 v52, 0
  v_mov_b32 v53, 0
  v_mov_b32 v54, 0
  v_mov_b32 v55, 0
  v_mov_b32 v56, 0
  v_mov_b32 v57, 0
  v_mov_b32 v58, 0
  v_mov_b32 v59, 0
  v_mov_b32 v60, 0
  v_mov_b32 v61, 0
  v_mov_b32 v62, 0
  v_mov_b32 v63, 0
  v_mov_b32 v88, 0
  v_mov_b32 v89, 0
  v_mov_b32 v90, 0
  v_mov_b32 v91, 0
  v_mov_b32 v92, 0
  v_mov_b32 v93, 0
  v_mov_b32 v94, 0
  v_mov_b32 v95, 0
  v_mov_b32 v64, 0
  v_mov_b32 v65, 0
  s_add_u32 s31, s31, 1
  ds_read_b128 v[96:99], v116 offset:12288
  ds_read_b128 v[100:103], v116 offset:13312
  ds_read_b128 v[104:107], v116 offset:26624
  ds_read_b128 v[108:111], v116 offset:27648
  v_smfmac_f32_16x16x64_bf16 v[36:39], v[8:11], a[0:7], v3
  v_smfmac_f32_16x16x64_bf16 v[40:43], v[8:11], a[56:63], v3
  v_smfmac_f32_16x16x64_bf16 v[44:47], v[8:11], a[112:119], v3
  v_smfmac_f32_16x16x64_bf16 v[48:51], v[8:11], a[168:175], v3
  v_smfmac_f32_16x16x64_bf16 v[52:55], v[8:11], a[224:231], v3
  v_smfmac_f32_16x16x64_bf16 v[56:59], v[8:11], v[144:151], v3
  v_smfmac_f32_16x16x64_bf16 v[60:63], v[8:11], v[200:207], v3
  v_smfmac_f32_16x16x64_bf16 v[36:39], v[12:15], a[8:15], v3
  v_smfmac_f32_16x16x64_bf16 v[40:43], v[12:15], a[64:71], v3
  v_smfmac_f32_16x16x64_bf16 v[44:47], v[12:15], a[120:127], v3
  v_smfmac_f32_16x16x64_bf16 v[48:51], v[12:15], a[176:183], v3
  v_smfmac_f32_16x16x64_bf16 v[52:55], v[12:15], a[232:239], v3
  v_smfmac_f32_16x16x64_bf16 v[56:59], v[12:15], v[152:159], v3
  v_smfmac_f32_16x16x64_bf16 v[60:63], v[12:15], v[208:215], v3
  v_smfmac_f32_16x16x64_bf16 v[36:39], v[16:19], a[16:23], v3
  v_smfmac_f32_16x16x64_bf16 v[40:43], v[16:19], a[72:79], v3
  v_smfmac_f32_16x16x64_bf16 v[44:47], v[16:19], a[128:135], v3
  v_smfmac_f32_16x16x64_bf16 v[48:51], v[16:19], a[184:191], v3
  v_smfmac_f32_16x16x64_bf16 v[52:55], v[16:19], a[240:247], v3
  v_smfmac_f32_16x16x64_bf16 v[56:59], v[16:19], v[160:167], v3
  v_smfmac_f32_16x16x64_bf16 v[60:63], v[16:19], v[216:223], v3
  v_smfmac_f32_16x16x64_bf16 v[36:39], v[20:23], a[24:31], v3
  v_smfmac_f32_16x16x64_bf16 v[40:43], v[20:23], a[80:87], v3
  v_smfmac_f32_16x16x64_bf16 v[44:47], v[20:23], a[136:143], v3
  v_smfmac_f32_16x16x64_bf16 v[48:51], v[20:23], a[192:199], v3
  v_smfmac_f32_16x16x64_bf16 v[52:55], v[20:23], a[248:255], v3
  v_smfmac_f32_16x16x64_bf16 v[56:59], v[20:23], v[168:175], v3
  v_smfmac_f32_16x16x64_bf16 v[60:63], v[20:23], v[224:231], v3
  s_branch cA_sc1_ph2
cA_sc2_loop:
  s_add_u32 s23, s20, 4096
  s_add_u32 s21, s20, 25600
  v_mov_b32 v48, 0
  v_mov_b32 v49, 0
  v_mov_b32 v50, 0
  v_mov_b32 v51, 0
  v_mov_b32 v52, 0
  v_mov_b32 v53, 0
  v_mov_b32 v54, 0
  v_mov_b32 v55, 0
  v_mov_b32 v56, 0
  v_mov_b32 v57, 0
  v_mov_b32 v58, 0
  v_mov_b32 v59, 0
  v_mov_b32 v60, 0
  v_mov_b32 v61, 0
  v_mov_b32 v62, 0
  v_mov_b32 v63, 0
  v_mov_b32 v88, 0
  v_mov_b32 v89, 0
  v_mov_b32 v90, 0
  v_mov_b32 v91, 0
  v_mov_b32 v92, 0
  v_mov_b32 v93, 0
  v_mov_b32 v94, 0
  v_mov_b32 v95, 0
  v_mov_b32 v66, 0
  v_mov_b32 v67, 0
  s_mov_b32 s30, 0
  s_mov_b32 s62, 0
  s_waitcnt vmcnt(0)
  s_barrier
cA_sc2_ld:
  buffer_load_dwordx4 v[8:11], v2, s[8:11], s20 offen offset:0
  v_mov_b32 v36, 0
  v_mov_b32 v37, 0
  v_mov_b32 v38, 0
  v_mov_b32 v39, 0
  buffer_load_dwordx4 v[12:15], v2, s[8:11], s20 offen offset:1024
  v_mov_b32 v40, 0
  v_mov_b32 v41, 0
  v_mov_b32 v42, 0
  v_mov_b32 v43, 0
  buffer_load_dwordx4 v[16:19], v2, s[8:11], s20 offen offset:2048
  v_mov_b32 v44, 0
  v_mov_b32 v45, 0
  v_mov_b32 v46, 0
  v_mov_b32 v47, 0
  ds_read_b128 v[96:99], v116 offset:12288
  ds_read_b128 v[100:103], v116 offset:13312
  ds_read_b128 v[104:107], v116 offset:26624
  ds_read_b128 v[108:111], v116 offset:27648
  s_waitcnt vmcnt(2)
  v_smfmac_f32_16x16x64_bf16 v[36:39], v[8:11], a[0:7], v3
  v_smfmac_f32_16x16x64_bf16 v[40:43], v[8:11], a[56:63], v3
  buffer_load_dwordx4 v[20:23], v2, s[8:11], s20 offen offset:3072
  v_smfmac_f32_16x16x64_bf16 v[44:47], v[8:11], a[112:119], v3
  v_smfmac_f32_16x16x64_bf16 v[48:51], v[8:11], a[168:175], v3
  v_smfmac_f32_16x16x64_bf16 v[52:55], v[8:11], a[224:231], v3
  buffer_load_dwordx4 v[24:27], v2, s[8:11], s23 offen offset:0
  v_smfmac_f32_16x16x64_bf16 v[56:59], v[8:11], v[144:151], v3
  v_smfmac_f32_16x16x64_bf16 v[60:63], v[8:11], v[200:207], v3
  s_waitcnt vmcnt(3)
  v_smfmac_f32_16x16x64_bf16 v[36:39], v[12:15], a[8:15], v3
  v_smfmac_f32_16x16x64_bf16 v[40:43], v[12:15], a[64:71], v3
  buffer_load_dwordx4 v[28:31], v2, s[8:11], s23 offen offset:1024
  v_smfmac_f32_16x16x64_bf16 v[44:47], v[12:15], a[120:127], v3
  v_smfmac_f32_16x16x64_bf16 v[48:51], v[12:15], a[176:183], v3
  v_smfmac_f32_16x16x64_bf16 v[52:55], v[12:15], a[232:239], v3
  buffer_load_dwordx4 v[32:35], v2, s[8:11], s23 offen offset:2048
  v_smfmac_f32_16x16x64_bf16 v[56:59], v[12:15], v[152:159], v3
  v_smfmac_f32_16x16x64_bf16 v[60:63], v[12:15], v[208:215], v3
  s_waitcnt vmcnt(4)
  v_smfmac_f32_16x16x64_bf16 v[36:39], v[16:19], a[16:23], v3
  v_smfmac_f32_16x16x64_bf16 v[40:43], v[16:19], a[72:79], v3
  v_smfmac_f32_16x16x64_bf16 v[44:47], v[16:19], a[128:135], v3
  v_smfmac_f32_16x16x64_bf16 v[48:51], v[16:19], a[184:191], v3
  v_smfmac_f32_16x16x64_bf16 v[52:55], v[16:19], a[240:247], v3
  v_smfmac_f32_16x16x64_bf16 v[56:59], v[16:19], v[160:167], v3
  v_smfmac_f32_16x16x64_bf16 v[60:63], v[16:19], v[216:223], v3
  s_waitcnt vmcnt(3)
  v_smfmac_f32_16x16x64_bf16 v[36:39], v[20:23], a[24:31], v3
  v_smfmac_f32_16x16x64_bf16 v[40:43], v[20:23], a[80:87], v3
  v_smfmac_f32_16x16x64_bf16 v[44:47], v[20:23], a[136:143], v3
  v_smfmac_f32_16x16x64_bf16 v[48:51], v[20:23], a[192:199], v3
  v_smfmac_f32_16x16x64_bf16 v[52:55], v[20:23], a[248:255], v3
  v_smfmac_f32_16x16x64_bf16 v[56:59], v[20:23], v[168:175], v3
  v_smfmac_f32_16x16x64_bf16 v[60:63], v[20:23], v[224:231], v3
  s_waitcnt vmcnt(0)
cA_sc2_ph2:
  v_smfmac_f32_16x16x64_bf16 v[60:63], v[24:27], v[232:239], v3
  ds_read_b128 v[8:11], v116 offset:10240
  ds_read_b128 v[12:15], v116 offset:11264
  v_smfmac_f32_16x16x64_bf16 v[60:63], v[28:31], v[240:247], v3
  buffer_load_dword v119, v0, s[8:11], s24 offen sc1
  v_smfmac_f32_16x16x64_bf16 v[60:63], v[32:35], v[248:255], v3
  v_smfmac_f32_16x16x64_bf16 v[52:55], v[24:27], v[120:127], v3
  v_smfmac_f32_16x16x64_bf16 v[52:55], v[28:31], v[128:135], v3
  v_smfmac_f32_16x16x64_bf16 v[52:55], v[32:35], v[136:143], v3
  v_cvt_pk_bf16_f32 v64, v60, v61
  v_smfmac_f32_16x16x64_bf16 v[56:59], v[24:27], v[176:183], v3
  v_cvt_pk_bf16_f32 v65, v62, v63
  v_smfmac_f32_16x16x64_bf16 v[56:59], v[28:31], v[184:191], v3
  v_mfma_f32_16x16x32_bf16 v[68:71], v[64:67], v[4:7], 0
  v_smfmac_f32_16x16x64_bf16 v[56:59], v[32:35], v[192:199], v3
  v_cvt_pk_bf16_f32 v64, v52, v53
  v_smfmac_f32_16x16x64_bf16 v[36:39], v[24:27], a[32:39], v3
  v_cvt_pk_bf16_f32 v65, v54, v55
  v_smfmac_f32_16x16x64_bf16 v[36:39], v[28:31], a[40:47], v3
  v_cvt_pk_bf16_f32 v78, v68, v69
  v_smfmac_f32_16x16x64_bf16 v[36:39], v[32:35], a[48:55], v3
  v_cvt_pk_bf16_f32 v79, v70, v71
  v_cvt_pk_bf16_f32 v66, v56, v57
  v_smfmac_f32_16x16x64_bf16 v[40:43], v[24:27], a[88:95], v3
  v_cvt_pk_bf16_f32 v67, v58, v59
  v_smfmac_f32_16x16x64_bf16 v[40:43], v[28:31], a[96:103], v3
  v_mfma_f32_16x16x32_bf16 v[72:75], v[64:67], v[4:7], 0
  ds_read_b128 v[52:55], v116 offset:24576
  ds_read_b128 v[56:59], v116 offset:25600
  v_smfmac_f32_16x16x64_bf16 v[40:43], v[32:35], a[104:111], v3
  v_cvt_pk_bf16_f32 v64, v36, v37
  v_smfmac_f32_16x16x64_bf16 v[44:47], v[24:27], a[144:151], v3
  v_cvt_pk_bf16_f32 v65, v38, v39
  v_smfmac_f32_16x16x64_bf16 v[44:47], v[28:31], a[152:159], v3
  v_cvt_pk_bf16_f32 v80, v72, v73
  v_smfmac_f32_16x16x64_bf16 v[44:47], v[32:35], a[160:167], v3
  v_cvt_pk_bf16_f32 v81, v74, v75
  v_cvt_pk_bf16_f32 v66, v40, v41
  v_smfmac_f32_16x16x64_bf16 v[48:51], v[24:27], a[200:207], v3
  v_cvt_pk_bf16_f32 v67, v42, v43
  v_smfmac_f32_16x16x64_bf16 v[48:51], v[28:31], a[208:215], v3
  v_mfma_f32_16x16x32_bf16 v[68:71], v[64:67], v[4:7], 0
  ds_read_b128 v[36:39], v116 offset:4096
  ds_read_b128 v[40:43], v116 offset:5120
  v_smfmac_f32_16x16x64_bf16 v[48:51], v[32:35], a[216:223], v3
  s_waitcnt lgkmcnt(4)
  v_cvt_pk_bf16_f32 v64, v44, v45
  v_mfma_f32_16x16x32_bf16 v[84:87], v[32:35], v[76:79], 0
  v_cvt_pk_bf16_f32 v65, v46, v47
  v_smfmac_f32_16x16x64_bf16 v[88:91], v[76:79], v[96:103], v3
  ds_read_b128 v[96:99], v116 offset:18432
  ds_read_b128 v[100:103], v116 offset:19456
  v_smfmac_f32_16x16x64_bf16 v[92:95], v[76:79], v[104:111], v3
  v_cvt_pk_bf16_f32 v66, v48, v49
  v_cvt_pk_bf16_f32 v67, v50, v51
  v_mfma_f32_16x16x32_bf16 v[84:87], v[28:31], v[80:83], v[84:87]
  v_cvt_pk_bf16_f32 v60, v68, v69
  v_mfma_f32_16x16x32_bf16 v[72:75], v[64:67], v[4:7], 0
  v_cvt_pk_bf16_f32 v61, v70, v71
  s_waitcnt lgkmcnt(4)
  v_smfmac_f32_16x16x64_bf16 v[88:91], v[80:83], v[8:15], v3
  v_smfmac_f32_16x16x64_bf16 v[92:95], v[80:83], v[52:59], v3
  s_waitcnt lgkmcnt(0)
  s_nop 0
  v_cvt_pk_bf16_f32 v62, v72, v73
  v_cvt_pk_bf16_f32 v63, v74, v75
  s_nop 1
  v_mfma_f32_16x16x32_bf16 v[84:87], v[16:19], v[60:63], v[84:87]
  v_smfmac_f32_16x16x64_bf16 v[88:91], v[60:63], v[36:43], v3
  v_smfmac_f32_16x16x64_bf16 v[92:95], v[60:63], v[96:103], v3
  s_mov_b64 exec, s[26:27]
  s_nop 0
  ds_write_b128 v113, v[84:87]
  s_mov_b64 exec, -1
  s_nop 0
  v_cmp_u_f32 vcc, v88, v89
  s_nop 1
  v_permlane32_swap_b32 v88, v92
  v_permlane32_swap_b32 v89, v93
  v_permlane32_swap_b32 v90, v94
  v_permlane32_swap_b32 v91, v95
  v_add_f32 v88, v88, v92
  v_add_f32 v89, v89, v93
  v_add_f32 v90, v90, v94
  v_add_f32 v91, v91, v95
  ds_write_b128 v112, v[88:91]
  s_cbranch_vccnz cA_sc2_retry
cA_sc2_cont:
  s_waitcnt lgkmcnt(0)
  s_barrier
  ds_read_b64 v[36:37], v114 offset:0
  ds_read_b64 v[38:39], v114 offset:1024
  ds_read2_b32 v[44:45], v115 offset0:0 offset1:64
  v_lshl_add_u32 v56, v2, 3, s36
  s_waitcnt lgkmcnt(0)
  v_add_f32 v44, v44, v45
  v_add_f32 v36, v36, v38
  v_add_f32 v37, v37, v39
  v_add_f32_dpp v44, v44, v44 row_ror:8 row_mask:0xf bank_mask:0xf
  v_mov_b32 v45, v44
  v_permlane32_swap_b32 v36, v37
  v_add_f32 v36, v36, v37
  v_permlane16_swap_b32 v44, v45
  v_add_f32 v44, v44, v45
  v_max_f32 v38, v36, v44
  s_mov_b64 exec, 65535
  buffer_store_dword v2, v56, s[8:11], s20 offen
  s_mov_b64 exec, -1
  v_max_f32_dpp v38, v38, v38 quad_perm:[1,0,3,2] row_mask:0xf bank_mask:0xf
  s_nop 1
  v_max_f32_dpp v38, v38, v38 quad_perm:[2,3,0,1] row_mask:0xf bank_mask:0xf
  s_nop 1
  v_max_f32_dpp v38, v38, v38 row_half_mirror row_mask:0xf bank_mask:0xf
  s_nop 1
  v_max_f32_dpp v38, v38, v38 row_mirror row_mask:0xf bank_mask:0xf
  v_mov_b32 v39, v38
  s_nop 1
  v_permlane16_swap_b32 v38, v39
  v_max_f32 v38, v38, v39
  v_sub_f32 v36, v36, v38
  v_sub_f32 v44, v44, v38
  v_exp_f32 v36, v36
  v_exp_f32 v44, v44
  s_nop 0
  v_fma_f32 v39, v44, s37, v36
  v_cndmask_b32 v40, v44, v36, s[38:39]
  v_cndmask_b32 v41, v36, v44, s[38:39]
  v_add_f32_dpp v39, v39, v39 quad_perm:[1,0,3,2] row_mask:0xf bank_mask:0xf
  s_nop 0
  v_mov_b32_dpp v46, v41 quad_perm:[1,0,3,2] row_mask:0xf bank_mask:0xf
  v_add_f32_dpp v39, v39, v39 quad_perm:[2,3,0,1] row_mask:0xf bank_mask:0xf
  v_cndmask_b32 v42, v46, v40, s[38:39]
  v_cndmask_b32 v43, v40, v46, s[38:39]
  v_add_f32_dpp v39, v39, v39 row_half_mirror row_mask:0xf bank_mask:0xf
  s_nop 1
  v_add_f32_dpp v39, v39, v39 row_mirror row_mask:0xf bank_mask:0xf
  v_mov_b32 v47, v39
  s_nop 1
  v_permlane16_swap_b32 v39, v47
  v_add_f32 v39, v39, v47
  v_rcp_f32 v39, v39
  s_nop 0
  v_mul_f32 v42, v42, v39
  v_mul_f32 v43, v43, v39
  v_cvt_pk_bf16_f32 v42, v42, v43
  v_min_u32 v42, -2, v42
  s_mov_b64 exec, s[28:29]
  buffer_store_dword v42, v1, s[8:11], s20 offen
  s_mov_b64 exec, -1
  s_barrier
  s_add_u32 s24, s24, 28672
  s_add_u32 s35, s35, 28672
  s_xor_b32 s25, s25, 28672
  s_add_u32 m0, s25, 14336
  s_nop 0
  buffer_load_dwordx4 v2, s[8:11], s24 offen offset:0 lds
  buffer_load_dwordx4 v2, s[8:11], s24 offen offset:1024 lds
  buffer_load_dwordx4 v2, s[8:11], s24 offen offset:2048 lds
  buffer_load_dwordx4 v2, s[8:11], s24 offen offset:3072 lds
  s_add_u32 m0, s25, 18432
  s_add_u32 s22, s24, 4096
  buffer_load_dwordx4 v2, s[8:11], s22 offen offset:0 lds
  buffer_load_dwordx4 v2, s[8:11], s22 offen offset:1024 lds
  buffer_load_dwordx4 v2, s[8:11], s22 offen offset:2048 lds
  v_xor_b32 v116, 28672, v116
  s_add_u32 s19, s19, 1
  s_mov_b32 s20, s21
  s_cmp_lt_u32 s19, 63
  s_cbranch_scc1 cA_sc2_loop
  s_branch cA_done
cA_sc2_retry:
  s_cmp_lg_u32 s62, 0
  s_cbranch_scc1 cA_sc2_cont
  s_waitcnt vmcnt(0) lgkmcnt(0)
cA_sc2_rv:
  buffer_load_dwordx4 v[8:11], v2, s[8:11], s20 offen offset:0 sc1
  buffer_load_dwordx4 v[12:15], v2, s[8:11], s20 offen offset:1024 sc1
  buffer_load_dwordx4 v[16:19], v2, s[8:11], s20 offen offset:2048 sc1
  buffer_load_dwordx4 v[20:23], v2, s[8:11], s20 offen offset:3072 sc1
  buffer_load_dwordx4 v[24:27], v2, s[8:11], s23 offen offset:0 sc1
  buffer_load_dwordx4 v[28:31], v2, s[8:11], s23 offen offset:1024 sc1
  buffer_load_dwordx4 v[32:35], v2, s[8:11], s23 offen offset:2048 sc1
  s_waitcnt vmcnt(0)
  v_max3_u32 v118, v8, v9, v10
  v_max3_u32 v118, v118, v11, v12
  v_max3_u32 v118, v118, v13, v14
  v_max3_u32 v118, v118, v15, v16
  v_max3_u32 v118, v118, v17, v18
  v_max3_u32 v118, v118, v19, v20
  v_max3_u32 v118, v118, v21, v22
  v_max3_u32 v118, v118, v23, v24
  v_max3_u32 v118, v118, v25, v26
  v_max3_u32 v118, v118, v27, v28
  v_max3_u32 v118, v118, v29, v30
  v_max3_u32 v118, v118, v31, v32
  v_max3_u32 v118, v118, v33, v34
  v_max_u32 v118, v118, v35
  v_cmp_eq_u32 vcc, -1, v118
  s_cbranch_vccz cA_sc2_rk
  s_add_u32 s30, s30, 1
  s_cmp_lt_u32 s30, 400000
  s_cbranch_scc1 cA_sc2_rv
  s_branch cA_abort
cA_sc2_rk:
  s_mov_b32 s62, 1
  v_mov_b32 v36, 0
  v_mov_b32 v37, 0
  v_mov_b32 v38, 0
  v_mov_b32 v39, 0
  v_mov_b32 v40, 0
  v_mov_b32 v41, 0
  v_mov_b32 v42, 0
  v_mov_b32 v43, 0
  v_mov_b32 v44, 0
  v_mov_b32 v45, 0
  v_mov_b32 v46, 0
  v_mov_b32 v47, 0
  v_mov_b32 v48, 0
  v_mov_b32 v49, 0
  v_mov_b32 v50, 0
  v_mov_b32 v51, 0
  v_mov_b32 v52, 0
  v_mov_b32 v53, 0
  v_mov_b32 v54, 0
  v_mov_b32 v55, 0
  v_mov_b32 v56, 0
  v_mov_b32 v57, 0
  v_mov_b32 v58, 0
  v_mov_b32 v59, 0
  v_mov_b32 v60, 0
  v_mov_b32 v61, 0
  v_mov_b32 v62, 0
  v_mov_b32 v63, 0
  v_mov_b32 v88, 0
  v_mov_b32 v89, 0
  v_mov_b32 v90, 0
  v_mov_b32 v91, 0
  v_mov_b32 v92, 0
  v_mov_b32 v93, 0
  v_mov_b32 v94, 0
  v_mov_b32 v95, 0
  v_mov_b32 v66, 0
  v_mov_b32 v67, 0
  s_add_u32 s31, s31, 1
  ds_read_b128 v[96:99], v116 offset:12288
  ds_read_b128 v[100:103], v116 offset:13312
  ds_read_b128 v[104:107], v116 offset:26624
  ds_read_b128 v[108:111], v116 offset:27648
  v_smfmac_f32_16x16x64_bf16 v[36:39], v[8:11], a[0:7], v3
  v_smfmac_f32_16x16x64_bf16 v[40:43], v[8:11], a[56:63], v3
  v_smfmac_f32_16x16x64_bf16 v[44:47], v[8:11], a[112:119], v3
  v_smfmac_f32_16x16x64_bf16 v[48:51], v[8:11], a[168:175], v3
  v_smfmac_f32_16x16x64_bf16 v[52:55], v[8:11], a[224:231], v3
  v_smfmac_f32_16x16x64_bf16 v[56:59], v[8:11], v[144:151], v3
  v_smfmac_f32_16x16x64_bf16 v[60:63], v[8:11], v[200:207], v3
  v_smfmac_f32_16x16x64_bf16 v[36:39], v[12:15], a[8:15], v3
  v_smfmac_f32_16x16x64_bf16 v[40:43], v[12:15], a[64:71], v3
  v_smfmac_f32_16x16x64_bf16 v[44:47], v[12:15], a[120:127], v3
  v_smfmac_f32_16x16x64_bf16 v[48:51], v[12:15], a[176:183], v3
  v_smfmac_f32_16x16x64_bf16 v[52:55], v[12:15], a[232:239], v3
  v_smfmac_f32_16x16x64_bf16 v[56:59], v[12:15], v[152:159], v3
  v_smfmac_f32_16x16x64_bf16 v[60:63], v[12:15], v[208:215], v3
  v_smfmac_f32_16x16x64_bf16 v[36:39], v[16:19], a[16:23], v3
  v_smfmac_f32_16x16x64_bf16 v[40:43], v[16:19], a[72:79], v3
  v_smfmac_f32_16x16x64_bf16 v[44:47], v[16:19], a[128:135], v3
  v_smfmac_f32_16x16x64_bf16 v[48:51], v[16:19], a[184:191], v3
  v_smfmac_f32_16x16x64_bf16 v[52:55], v[16:19], a[240:247], v3
  v_smfmac_f32_16x16x64_bf16 v[56:59], v[16:19], v[160:167], v3
  v_smfmac_f32_16x16x64_bf16 v[60:63], v[16:19], v[216:223], v3
  v_smfmac_f32_16x16x64_bf16 v[36:39], v[20:23], a[24:31], v3
  v_smfmac_f32_16x16x64_bf16 v[40:43], v[20:23], a[80:87], v3
  v_smfmac_f32_16x16x64_bf16 v[44:47], v[20:23], a[136:143], v3
  v_smfmac_f32_16x16x64_bf16 v[48:51], v[20:23], a[192:199], v3
  v_smfmac_f32_16x16x64_bf16 v[52:55], v[20:23], a[248:255], v3
  v_smfmac_f32_16x16x64_bf16 v[56:59], v[20:23], v[168:175], v3
  v_smfmac_f32_16x16x64_bf16 v[60:63], v[20:23], v[224:231], v3
  s_branch cA_sc2_ph2
cA_sc3_loop:
  s_add_u32 s23, s20, 4096
  s_add_u32 s21, s20, 25600
  v_mov_b32 v48, 0
  v_mov_b32 v49, 0
  v_mov_b32 v50, 0
  v_mov_b32 v51, 0
  v_mov_b32 v52, 0
  v_mov_b32 v53, 0
  v_mov_b32 v54, 0
  v_mov_b32 v55, 0
  v_mov_b32 v56, 0
  v_mov_b32 v57, 0
  v_mov_b32 v58, 0
  v_mov_b32 v59, 0
  v_mov_b32 v60, 0
  v_mov_b32 v61, 0
  v_mov_b32 v62, 0
  v_mov_b32 v63, 0
  v_mov_b32 v88, 0
  v_mov_b32 v89, 0
  v_mov_b32 v90, 0
  v_mov_b32 v91, 0
  v_mov_b32 v92, 0
  v_mov_b32 v93, 0
  v_mov_b32 v94, 0
  v_mov_b32 v95, 0
  v_mov_b32 v64, 0
  v_mov_b32 v65, 0
  s_mov_b32 s30, 0
  s_mov_b32 s62, 0
  s_waitcnt vmcnt(0)
  s_barrier
cA_sc3_ld:
  buffer_load_dwordx4 v[8:11], v2, s[8:11], s20 offen offset:0
  v_mov_b32 v36, 0
  v_mov_b32 v37, 0
  v_mov_b32 v38, 0
  v_mov_b32 v39, 0
  buffer_load_dwordx4 v[12:15], v2, s[8:11], s20 offen offset:1024
  v_mov_b32 v40, 0
  v_mov_b32 v41, 0
  v_mov_b32 v42, 0
  v_mov_b32 v43, 0
  buffer_load_dwordx4 v[16:19], v2, s[8:11], s20 offen offset:2048
  v_mov_b32 v44, 0
  v_mov_b32 v45, 0
  v_mov_b32 v46, 0
  v_mov_b32 v47, 0
  ds_read_b128 v[96:99], v116 offset:12288
  ds_read_b128 v[100:103], v116 offset:13312
  ds_read_b128 v[104:107], v116 offset:26624
  ds_read_b128 v[108:111], v116 offset:27648
  s_waitcnt vmcnt(2)
  v_smfmac_f32_16x16x64_bf16 v[36:39], v[8:11], a[0:7], v3
  v_smfmac_f32_16x16x64_bf16 v[40:43], v[8:11], a[56:63], v3
  buffer_load_dwordx4 v[20:23], v2, s[8:11], s20 offen offset:3072
  v_smfmac_f32_16x16x64_bf16 v[44:47], v[8:11], a[112:119], v3
  v_smfmac_f32_16x16x64_bf16 v[48:51], v[8:11], a[168:175], v3
  v_smfmac_f32_16x16x64_bf16 v[52:55], v[8:11], a[224:231], v3
  buffer_load_dwordx4 v[24:27], v2, s[8:11], s23 offen offset:0
  v_smfmac_f32_16x16x64_bf16 v[56:59], v[8:11], v[144:151], v3
  v_smfmac_f32_16x16x64_bf16 v[60:63], v[8:11], v[200:207], v3
  s_waitcnt vmcnt(3)
  v_smfmac_f32_16x16x64_bf16 v[36:39], v[12:15], a[8:15], v3
  v_smfmac_f32_16x16x64_bf16 v[40:43], v[12:15], a[64:71], v3
  buffer_load_dwordx4 v[28:31], v2, s[8:11], s23 offen offset:1024
  v_smfmac_f32_16x16x64_bf16 v[44:47], v[12:15], a[120:127], v3
  v_smfmac_f32_16x16x64_bf16 v[48:51], v[12:15], a[176:183], v3
  v_smfmac_f32_16x16x64_bf16 v[52:55], v[12:15], a[232:239], v3
  buffer_load_dwordx4 v[32:35], v2, s[8:11], s23 offen offset:2048
  v_smfmac_f32_16x16x64_bf16 v[56:59], v[12:15], v[152:159], v3
  v_smfmac_f32_16x16x64_bf16 v[60:63], v[12:15], v[208:215], v3
  s_waitcnt vmcnt(4)
  v_smfmac_f32_16x16x64_bf16 v[36:39], v[16:19], a[16:23], v3
  v_smfmac_f32_16x16x64_bf16 v[40:43], v[16:19], a[72:79], v3
  v_smfmac_f32_16x16x64_bf16 v[44:47], v[16:19], a[128:135], v3
  v_smfmac_f32_16x16x64_bf16 v[48:51], v[16:19], a[184:191], v3
  v_smfmac_f32_16x16x64_bf16 v[52:55], v[16:19], a[240:247], v3
  v_smfmac_f32_16x16x64_bf16 v[56:59], v[16:19], v[160:167], v3
  v_smfmac_f32_16x16x64_bf16 v[60:63], v[16:19], v[216:223], v3
  s_waitcnt vmcnt(3)
  v_smfmac_f32_16x16x64_bf16 v[36:39], v[20:23], a[24:31], v3
  v_smfmac_f32_16x16x64_bf16 v[40:43], v[20:23], a[80:87], v3
  v_smfmac_f32_16x16x64_bf16 v[44:47], v[20:23], a[136:143], v3
  v_smfmac_f32_16x16x64_bf16 v[48:51], v[20:23], a[192:199], v3
  v_smfmac_f32_16x16x64_bf16 v[52:55], v[20:23], a[248:255], v3
  v_smfmac_f32_16x16x64_bf16 v[56:59], v[20:23], v[168:175], v3
  v_smfmac_f32_16x16x64_bf16 v[60:63], v[20:23], v[224:231], v3
  s_waitcnt vmcnt(0)
cA_sc3_ph2:
  v_smfmac_f32_16x16x64_bf16 v[60:63], v[24:27], v[232:239], v3
  ds_read_b128 v[8:11], v116 offset:10240
  ds_read_b128 v[12:15], v116 offset:11264
  v_smfmac_f32_16x16x64_bf16 v[60:63], v[28:31], v[240:247], v3
  v_smfmac_f32_16x16x64_bf16 v[60:63], v[32:35], v[248:255], v3
  v_smfmac_f32_16x16x64_bf16 v[52:55], v[24:27], v[120:127], v3
  v_smfmac_f32_16x16x64_bf16 v[52:55], v[28:31], v[128:135], v3
  v_smfmac_f32_16x16x64_bf16 v[52:55], v[32:35], v[136:143], v3
  v_cvt_pk_bf16_f32 v66, v60, v61
  v_smfmac_f32_16x16x64_bf16 v[56:59], v[24:27], v[176:183], v3
  v_cvt_pk_bf16_f32 v67, v62, v63
  v_smfmac_f32_16x16x64_bf16 v[56:59], v[28:31], v[184:191], v3
  v_mfma_f32_16x16x32_bf16 v[68:71], v[64:67], v[4:7], 0
  v_smfmac_f32_16x16x64_bf16 v[56:59], v[32:35], v[192:199], v3
  v_cvt_pk_bf16_f32 v64, v52, v53
  v_smfmac_f32_16x16x64_bf16 v[36:39], v[24:27], a[32:39], v3
  v_cvt_pk_bf16_f32 v65, v54, v55
  v_smfmac_f32_16x16x64_bf16 v[36:39], v[28:31], a[40:47], v3
  v_cvt_pk_bf16_f32 v78, v68, v69
  v_smfmac_f32_16x16x64_bf16 v[36:39], v[32:35], a[48:55], v3
  v_cvt_pk_bf16_f32 v79, v70, v71
  v_cvt_pk_bf16_f32 v66, v56, v57
  v_smfmac_f32_16x16x64_bf16 v[40:43], v[24:27], a[88:95], v3
  v_cvt_pk_bf16_f32 v67, v58, v59
  v_smfmac_f32_16x16x64_bf16 v[40:43], v[28:31], a[96:103], v3
  v_mfma_f32_16x16x32_bf16 v[72:75], v[64:67], v[4:7], 0
  ds_read_b128 v[52:55], v116 offset:24576
  ds_read_b128 v[56:59], v116 offset:25600
  v_smfmac_f32_16x16x64_bf16 v[40:43], v[32:35], a[104:111], v3
  v_cvt_pk_bf16_f32 v64, v36, v37
  v_smfmac_f32_16x16x64_bf16 v[44:47], v[24:27], a[144:151], v3
  v_cvt_pk_bf16_f32 v65, v38, v39
  v_smfmac_f32_16x16x64_bf16 v[44:47], v[28:31], a[152:159], v3
  v_cvt_pk_bf16_f32 v82, v72, v73
  v_smfmac_f32_16x16x64_bf16 v[44:47], v[32:35], a[160:167], v3
  v_cvt_pk_bf16_f32 v83, v74, v75
  v_cvt_pk_bf16_f32 v66, v40, v41
  v_smfmac_f32_16x16x64_bf16 v[48:51], v[24:27], a[200:207], v3
  v_cvt_pk_bf16_f32 v67, v42, v43
  v_smfmac_f32_16x16x64_bf16 v[48:51], v[28:31], a[208:215], v3
  v_mfma_f32_16x16x32_bf16 v[68:71], v[64:67], v[4:7], 0
  ds_read_b128 v[36:39], v116 offset:6144
  ds_read_b128 v[40:43], v116 offset:7168
  v_smfmac_f32_16x16x64_bf16 v[48:51], v[32:35], a[216:223], v3
  s_waitcnt lgkmcnt(4)
  v_cvt_pk_bf16_f32 v64, v44, v45
  v_mfma_f32_16x16x32_bf16 v[84:87], v[32:35], v[76:79], 0
  v_cvt_pk_bf16_f32 v65, v46, v47
  v_smfmac_f32_16x16x64_bf16 v[88:91], v[76:79], v[96:103], v3
  ds_read_b128 v[96:99], v116 offset:20480
  ds_read_b128 v[100:103], v116 offset:21504
  v_smfmac_f32_16x16x64_bf16 v[92:95], v[76:79], v[104:111], v3
  v_cvt_pk_bf16_f32 v66, v48, v49
  v_cvt_pk_bf16_f32 v67, v50, v51
  v_mfma_f32_16x16x32_bf16 v[84:87], v[28:31], v[80:83], v[84:87]
  v_cvt_pk_bf16_f32 v60, v68, v69
  v_mfma_f32_16x16x32_bf16 v[72:75], v[64:67], v[4:7], 0
  v_cvt_pk_bf16_f32 v61, v70, v71
  s_waitcnt lgkmcnt(4)
  v_smfmac_f32_16x16x64_bf16 v[88:91], v[80:83], v[8:15], v3
  v_smfmac_f32_16x16x64_bf16 v[92:95], v[80:83], v[52:59], v3
  s_waitcnt lgkmcnt(0)
  s_nop 0
  v_cvt_pk_bf16_f32 v62, v72, v73
  v_cvt_pk_bf16_f32 v63, v74, v75
  s_nop 1
  v_mfma_f32_16x16x32_bf16 v[84:87], v[20:23], v[60:63], v[84:87]
  v_smfmac_f32_16x16x64_bf16 v[88:91], v[60:63], v[36:43], v3
  v_smfmac_f32_16x16x64_bf16 v[92:95], v[60:63], v[96:103], v3
  s_mov_b64 exec, s[26:27]
  s_nop 0
  ds_write_b128 v113, v[84:87]
  s_mov_b64 exec, -1
  s_nop 0
  v_cmp_u_f32 vcc, v88, v89
  s_nop 1
  v_permlane32_swap_b32 v88, v92
  v_permlane32_swap_b32 v89, v93
  v_permlane32_swap_b32 v90, v94
  v_permlane32_swap_b32 v91, v95
  v_add_f32 v88, v88, v92
  v_add_f32 v89, v89, v93
  v_add_f32 v90, v90, v94
  v_add_f32 v91, v91, v95
  ds_write_b128 v112, v[88:91]
  s_cbranch_vccnz cA_sc3_retry
cA_sc3_cont:
  s_waitcnt lgkmcnt(0)
  s_barrier
  ds_read_b64 v[36:37], v114 offset:0
  ds_read_b64 v[38:39], v114 offset:1024
  ds_read2_b32 v[44:45], v115 offset0:0 offset1:64
  s_waitcnt lgkmcnt(0)
  v_add_f32 v44, v44, v45
  v_add_f32 v36, v36, v38
  v_add_f32 v37, v37, v39
  v_add_f32_dpp v44, v44, v44 row_ror:8 row_mask:0xf bank_mask:0xf
  v_mov_b32 v45, v44
  v_permlane32_swap_b32 v36, v37
  v_add_f32 v36, v36, v37
  v_permlane16_swap_b32 v44, v45
  v_add_f32 v44, v44, v45
  v_max_f32 v38, v36, v44
  s_nop 1
  v_max_f32_dpp v38, v38, v38 quad_perm:[1,0,3,2] row_mask:0xf bank_mask:0xf
  s_nop 1
  v_max_f32_dpp v38, v38, v38 quad_perm:[2,3,0,1] row_mask:0xf bank_mask:0xf
  s_nop 1
  v_max_f32_dpp v38, v38, v38 row_half_mirror row_mask:0xf bank_mask:0xf
  s_nop 1
  v_max_f32_dpp v38, v38, v38 row_mirror row_mask:0xf bank_mask:0xf
  v_mov_b32 v39, v38
  s_nop 1
  v_permlane16_swap_b32 v38, v39
  v_max_f32 v38, v38, v39
  v_sub_f32 v36, v36, v38
  v_sub_f32 v44, v44, v38
  v_exp_f32 v36, v36
  v_exp_f32 v44, v44
  s_nop 0
  v_fma_f32 v39, v44, s37, v36
  v_cndmask_b32 v40, v44, v36, s[38:39]
  v_cndmask_b32 v41, v36, v44, s[38:39]
  v_add_f32_dpp v39, v39, v39 quad_perm:[1,0,3,2] row_mask:0xf bank_mask:0xf
  s_nop 0
  v_mov_b32_dpp v46, v41 quad_perm:[1,0,3,2] row_mask:0xf bank_mask:0xf
  v_add_f32_dpp v39, v39, v39 quad_perm:[2,3,0,1] row_mask:0xf bank_mask:0xf
  v_cndmask_b32 v42, v46, v40, s[38:39]
  v_cndmask_b32 v43, v40, v46, s[38:39]
  v_add_f32_dpp v39, v39, v39 row_half_mirror row_mask:0xf bank_mask:0xf
  s_nop 1
  v_add_f32_dpp v39, v39, v39 row_mirror row_mask:0xf bank_mask:0xf
  v_mov_b32 v47, v39
  s_nop 1
  v_permlane16_swap_b32 v39, v47
  v_add_f32 v39, v39, v47
  v_rcp_f32 v39, v39
  s_nop 0
  v_mul_f32 v42, v42, v39
  v_mul_f32 v43, v43, v39
  v_cvt_pk_bf16_f32 v42, v42, v43
  v_min_u32 v42, -2, v42
  s_mov_b64 exec, s[28:29]
  buffer_store_dword v42, v1, s[8:11], s20 offen
  s_mov_b64 exec, -1
  s_barrier
  s_add_u32 s24, s24, 28672
  s_add_u32 s35, s35, 28672
  s_xor_b32 s25, s25, 28672
  s_add_u32 m0, s25, 21504
  s_nop 0
  buffer_load_dwordx4 v2, s[8:11], s24 offen offset:0 lds
  buffer_load_dwordx4 v2, s[8:11], s24 offen offset:1024 lds
  buffer_load_dwordx4 v2, s[8:11], s24 offen offset:2048 lds
  buffer_load_dwordx4 v2, s[8:11], s24 offen offset:3072 lds
  s_add_u32 m0, s25, 25600
  s_add_u32 s22, s24, 4096
  buffer_load_dwordx4 v2, s[8:11], s22 offen offset:0 lds
  buffer_load_dwordx4 v2, s[8:11], s22 offen offset:1024 lds
  buffer_load_dwordx4 v2, s[8:11], s22 offen offset:2048 lds
  v_xor_b32 v116, 28672, v116
  s_add_u32 s19, s19, 1
  s_mov_b32 s20, s21
  s_cmp_lt_u32 s19, 63
  s_cbranch_scc1 cA_sc3_loop
  s_branch cA_done
cA_sc3_retry:
  s_cmp_lg_u32 s62, 0
  s_cbranch_scc1 cA_sc3_cont
  s_waitcnt vmcnt(0) lgkmcnt(0)
cA_sc3_rv:
  buffer_load_dwordx4 v[8:11], v2, s[8:11], s20 offen offset:0 sc1
  buffer_load_dwordx4 v[12:15], v2, s[8:11], s20 offen offset:1024 sc1
  buffer_load_dwordx4 v[16:19], v2, s[8:11], s20 offen offset:2048 sc1
  buffer_load_dwordx4 v[20:23], v2, s[8:11], s20 offen offset:3072 sc1
  buffer_load_dwordx4 v[24:27], v2, s[8:11], s23 offen offset:0 sc1
  buffer_load_dwordx4 v[28:31], v2, s[8:11], s23 offen offset:1024 sc1
  buffer_load_dwordx4 v[32:35], v2, s[8:11], s23 offen offset:2048 sc1
  s_waitcnt vmcnt(0)
  v_max3_u32 v118, v8, v9, v10
  v_max3_u32 v118, v118, v11, v12
  v_max3_u32 v118, v118, v13, v14
  v_max3_u32 v118, v118, v15, v16
  v_max3_u32 v118, v118, v17, v18
  v_max3_u32 v118, v118, v19, v20
  v_max3_u32 v118, v118, v21, v22
  v_max3_u32 v118, v118, v23, v24
  v_max3_u32 v118, v118, v25, v26
  v_max3_u32 v118, v118, v27, v28
  v_max3_u32 v118, v118, v29, v30
  v_max3_u32 v118, v118, v31, v32
  v_max3_u32 v118, v118, v33, v34
  v_max_u32 v118, v118, v35
  v_cmp_eq_u32 vcc, -1, v118
  s_cbranch_vccz cA_sc3_rk
  s_add_u32 s30, s30, 1
  s_cmp_lt_u32 s30, 400000
  s_cbranch_scc1 cA_sc3_rv
  s_branch cA_abort
cA_sc3_rk:
  s_mov_b32 s62, 1
  v_mov_b32 v36, 0
  v_mov_b32 v37, 0
  v_mov_b32 v38, 0
  v_mov_b32 v39, 0
  v_mov_b32 v40, 0
  v_mov_b32 v41, 0
  v_mov_b32 v42, 0
  v_mov_b32 v43, 0
  v_mov_b32 v44, 0
  v_mov_b32 v45, 0
  v_mov_b32 v46, 0
  v_mov_b32 v47, 0
  v_mov_b32 v48, 0
  v_mov_b32 v49, 0
  v_mov_b32 v50, 0
  v_mov_b32 v51, 0
  v_mov_b32 v52, 0
  v_mov_b32 v53, 0
  v_mov_b32 v54, 0
  v_mov_b32 v55, 0
  v_mov_b32 v56, 0
  v_mov_b32 v57, 0
  v_mov_b32 v58, 0
  v_mov_b32 v59, 0
  v_mov_b32 v60, 0
  v_mov_b32 v61, 0
  v_mov_b32 v62, 0
  v_mov_b32 v63, 0
  v_mov_b32 v88, 0
  v_mov_b32 v89, 0
  v_mov_b32 v90, 0
  v_mov_b32 v91, 0
  v_mov_b32 v92, 0
  v_mov_b32 v93, 0
  v_mov_b32 v94, 0
  v_mov_b32 v95, 0
  v_mov_b32 v64, 0
  v_mov_b32 v65, 0
  s_add_u32 s31, s31, 1
  ds_read_b128 v[96:99], v116 offset:12288
  ds_read_b128 v[100:103], v116 offset:13312
  ds_read_b128 v[104:107], v116 offset:26624
  ds_read_b128 v[108:111], v116 offset:27648
  v_smfmac_f32_16x16x64_bf16 v[36:39], v[8:11], a[0:7], v3
  v_smfmac_f32_16x16x64_bf16 v[40:43], v[8:11], a[56:63], v3
  v_smfmac_f32_16x16x64_bf16 v[44:47], v[8:11], a[112:119], v3
  v_smfmac_f32_16x16x64_bf16 v[48:51], v[8:11], a[168:175], v3
  v_smfmac_f32_16x16x64_bf16 v[52:55], v[8:11], a[224:231], v3
  v_smfmac_f32_16x16x64_bf16 v[56:59], v[8:11], v[144:151], v3
  v_smfmac_f32_16x16x64_bf16 v[60:63], v[8:11], v[200:207], v3
  v_smfmac_f32_16x16x64_bf16 v[36:39], v[12:15], a[8:15], v3
  v_smfmac_f32_16x16x64_bf16 v[40:43], v[12:15], a[64:71], v3
  v_smfmac_f32_16x16x64_bf16 v[44:47], v[12:15], a[120:127], v3
  v_smfmac_f32_16x16x64_bf16 v[48:51], v[12:15], a[176:183], v3
  v_smfmac_f32_16x16x64_bf16 v[52:55], v[12:15], a[232:239], v3
  v_smfmac_f32_16x16x64_bf16 v[56:59], v[12:15], v[152:159], v3
  v_smfmac_f32_16x16x64_bf16 v[60:63], v[12:15], v[208:215], v3
  v_smfmac_f32_16x16x64_bf16 v[36:39], v[16:19], a[16:23], v3
  v_smfmac_f32_16x16x64_bf16 v[40:43], v[16:19], a[72:79], v3
  v_smfmac_f32_16x16x64_bf16 v[44:47], v[16:19], a[128:135], v3
  v_smfmac_f32_16x16x64_bf16 v[48:51], v[16:19], a[184:191], v3
  v_smfmac_f32_16x16x64_bf16 v[52:55], v[16:19], a[240:247], v3
  v_smfmac_f32_16x16x64_bf16 v[56:59], v[16:19], v[160:167], v3
  v_smfmac_f32_16x16x64_bf16 v[60:63], v[16:19], v[216:223], v3
  v_smfmac_f32_16x16x64_bf16 v[36:39], v[20:23], a[24:31], v3
  v_smfmac_f32_16x16x64_bf16 v[40:43], v[20:23], a[80:87], v3
  v_smfmac_f32_16x16x64_bf16 v[44:47], v[20:23], a[136:143], v3
  v_smfmac_f32_16x16x64_bf16 v[48:51], v[20:23], a[192:199], v3
  v_smfmac_f32_16x16x64_bf16 v[52:55], v[20:23], a[248:255], v3
  v_smfmac_f32_16x16x64_bf16 v[56:59], v[20:23], v[168:175], v3
  v_smfmac_f32_16x16x64_bf16 v[60:63], v[20:23], v[224:231], v3
  s_branch cA_sc3_ph2
cA_va0_loop:
  s_add_u32 s23, s20, 4096
  s_add_u32 s21, s20, 25600
  s_mov_b32 s30, 0
  s_and_b32 s22, s19, 7
  s_cmp_lg_u32 s22, 0
  s_cbranch_scc1 cA_va0_vok
  v_mov_b32 v164, 0
cA_va0_vow:
  buffer_load_dword v165, v164, s[8:11], s35 offen sc1
  s_waitcnt vmcnt(0)
  v_readfirstlane_b32 s22, v165
  s_cmp_eq_u32 s22, 56
  s_cbranch_scc1 cA_va0_vod
  s_sleep 2
  s_add_u32 s30, s30, 1
  s_cmp_lt_u32 s30, 400000
  s_cbranch_scc1 cA_va0_vow
  s_branch cA_abort
cA_va0_vod:
  s_add_u32 s35, s35, 64
cA_va0_vok:
  s_cmp_eq_u32 s19, 63
  s_cbranch_scc1 cA_done
  s_barrier
  s_add_u32 s22, s25, 0
  buffer_load_dwordx4 v[80:83], v6, s[8:11], s22 offen offset:0 sc1
  buffer_load_dwordx4 v[84:87], v6, s[8:11], s22 offen offset:1792 sc1
  s_add_u32 s22, s25, 3584
  buffer_load_dwordx4 v[88:91], v6, s[8:11], s22 offen offset:0 sc1
  buffer_load_dwordx4 v[92:95], v6, s[8:11], s22 offen offset:1792 sc1
  s_add_u32 s22, s25, 7168
  buffer_load_dwordx4 v[96:99], v6, s[8:11], s22 offen offset:0 sc1
  buffer_load_dwordx4 v[100:103], v6, s[8:11], s22 offen offset:1792 sc1
  s_add_u32 s22, s25, 10752
  buffer_load_dwordx4 v[104:107], v6, s[8:11], s22 offen offset:0 sc1
  buffer_load_dwordx4 v[108:111], v6, s[8:11], s22 offen offset:1792 sc1
  s_add_u32 s22, s25, 14336
  buffer_load_dwordx4 v[112:115], v6, s[8:11], s22 offen offset:0 sc1
  buffer_load_dwordx4 v[116:119], v6, s[8:11], s22 offen offset:1792 sc1
  s_add_u32 s22, s25, 17920
  buffer_load_dwordx4 v[120:123], v6, s[8:11], s22 offen offset:0 sc1
  buffer_load_dwordx4 v[124:127], v6, s[8:11], s22 offen offset:1792 sc1
  s_add_u32 s22, s25, 21504
  buffer_load_dwordx4 v[128:131], v6, s[8:11], s22 offen offset:0 sc1
  buffer_load_dwordx4 v[132:135], v6, s[8:11], s22 offen offset:1792 sc1
  s_add_u32 s22, s25, 25088
  buffer_load_dwordx4 v[136:139], v6, s[8:11], s22 offen offset:0 sc1
  buffer_load_dwordx4 v[140:143], v6, s[8:11], s22 offen offset:1792 sc1
  s_barrier
  ds_read_b128 v[8:11], v2 offset:8192
  ds_read_b128 v[12:15], v2 offset:9216
  ds_read_b128 v[16:19], v2 offset:10240
  ds_read_b128 v[20:23], v2 offset:11264
  ds_read_b128 v[24:27], v2 offset:12288
  ds_read_b128 v[28:31], v2 offset:13312
  ds_read_b128 v[32:35], v2 offset:14336
  s_waitcnt lgkmcnt(0)
  v_smfmac_f32_16x16x64_bf16 v[36:39], v[8:11], a[0:7], v3
  v_smfmac_f32_16x16x64_bf16 v[36:39], v[12:15], a[8:15], v3
  v_smfmac_f32_16x16x64_bf16 v[36:39], v[16:19], a[16:23], v3
  v_smfmac_f32_16x16x64_bf16 v[36:39], v[20:23], a[24:31], v3
  v_smfmac_f32_16x16x64_bf16 v[36:39], v[24:27], a[32:39], v3
  v_smfmac_f32_16x16x64_bf16 v[36:39], v[28:31], a[40:47], v3
  v_smfmac_f32_16x16x64_bf16 v[36:39], v[32:35], a[48:55], v3
  v_smfmac_f32_16x16x64_bf16 v[40:43], v[8:11], a[56:63], v3
  v_smfmac_f32_16x16x64_bf16 v[40:43], v[12:15], a[64:71], v3
  v_smfmac_f32_16x16x64_bf16 v[40:43], v[16:19], a[72:79], v3
  v_smfmac_f32_16x16x64_bf16 v[40:43], v[20:23], a[80:87], v3
  v_smfmac_f32_16x16x64_bf16 v[40:43], v[24:27], a[88:95], v3
  v_smfmac_f32_16x16x64_bf16 v[40:43], v[28:31], a[96:103], v3
  v_smfmac_f32_16x16x64_bf16 v[40:43], v[32:35], a[104:111], v3
  v_smfmac_f32_16x16x64_bf16 v[44:47], v[8:11], a[112:119], v3
  v_smfmac_f32_16x16x64_bf16 v[44:47], v[12:15], a[120:127], v3
  v_smfmac_f32_16x16x64_bf16 v[44:47], v[16:19], a[128:135], v3
  v_smfmac_f32_16x16x64_bf16 v[44:47], v[20:23], a[136:143], v3
  v_permlane32_swap_b32 v36, v40
  v_smfmac_f32_16x16x64_bf16 v[44:47], v[24:27], a[144:151], v3
  v_permlane32_swap_b32 v37, v41
  v_smfmac_f32_16x16x64_bf16 v[44:47], v[28:31], a[152:159], v3
  v_permlane32_swap_b32 v38, v42
  v_smfmac_f32_16x16x64_bf16 v[44:47], v[32:35], a[160:167], v3
  v_permlane32_swap_b32 v39, v43
  v_smfmac_f32_16x16x64_bf16 v[48:51], v[8:11], a[168:175], v3
  v_add_f32 v36, v36, v40
  v_smfmac_f32_16x16x64_bf16 v[48:51], v[12:15], a[176:183], v3
  v_add_f32 v37, v37, v41
  v_smfmac_f32_16x16x64_bf16 v[48:51], v[16:19], a[184:191], v3
  v_add_f32 v38, v38, v42
  v_smfmac_f32_16x16x64_bf16 v[48:51], v[20:23], a[192:199], v3
  v_add_f32 v39, v39, v43
  v_smfmac_f32_16x16x64_bf16 v[48:51], v[24:27], a[200:207], v3
  v_cvt_pk_bf16_f32 v40, v36, v37
  v_smfmac_f32_16x16x64_bf16 v[48:51], v[28:31], a[208:215], v3
  v_cvt_pk_bf16_f32 v41, v38, v39
  v_smfmac_f32_16x16x64_bf16 v[48:51], v[32:35], a[216:223], v3
  ds_write_b64 v60, v[40:41]
  v_smfmac_f32_16x16x64_bf16 v[52:55], v[8:11], a[224:231], v3
  v_smfmac_f32_16x16x64_bf16 v[52:55], v[12:15], a[232:239], v3
  v_smfmac_f32_16x16x64_bf16 v[52:55], v[16:19], a[240:247], v3
  v_smfmac_f32_16x16x64_bf16 v[52:55], v[20:23], a[248:255], v3
  v_permlane32_swap_b32 v44, v48
  v_smfmac_f32_16x16x64_bf16 v[52:55], v[24:27], v[176:183], v3
  v_permlane32_swap_b32 v45, v49
  v_smfmac_f32_16x16x64_bf16 v[52:55], v[28:31], v[184:191], v3
  v_permlane32_swap_b32 v46, v50
  v_smfmac_f32_16x16x64_bf16 v[52:55], v[32:35], v[192:199], v3
  v_permlane32_swap_b32 v47, v51
  v_smfmac_f32_16x16x64_bf16 v[56:59], v[8:11], v[200:207], v3
  v_add_f32 v44, v44, v48
  v_smfmac_f32_16x16x64_bf16 v[56:59], v[12:15], v[208:215], v3
  v_add_f32 v45, v45, v49
  v_smfmac_f32_16x16x64_bf16 v[56:59], v[16:19], v[216:223], v3
  v_add_f32 v46, v46, v50
  v_smfmac_f32_16x16x64_bf16 v[56:59], v[20:23], v[224:231], v3
  v_add_f32 v47, v47, v51
  v_smfmac_f32_16x16x64_bf16 v[56:59], v[24:27], v[232:239], v3
  v_cvt_pk_bf16_f32 v48, v44, v45
  v_smfmac_f32_16x16x64_bf16 v[56:59], v[28:31], v[240:247], v3
  v_cvt_pk_bf16_f32 v49, v46, v47
  v_smfmac_f32_16x16x64_bf16 v[56:59], v[32:35], v[248:255], v3
  ds_write_b64 v61, v[48:49]
  s_nop 6
  v_permlane32_swap_b32 v52, v56
  v_permlane32_swap_b32 v53, v57
  v_permlane32_swap_b32 v54, v58
  v_permlane32_swap_b32 v55, v59
  v_add_f32 v52, v52, v56
  v_add_f32 v53, v53, v57
  v_add_f32 v54, v54, v58
  v_add_f32 v55, v55, v59
  v_cvt_pk_bf16_f32 v56, v52, v53
  v_cvt_pk_bf16_f32 v57, v54, v55
  ds_write_b64 v62, v[56:57]
  s_cmp_eq_u32 s19, 63
  s_cbranch_scc1 cA_va0_last
  s_add_u32 s22, s20, 9216
  s_add_u32 s34, s20, 13312
  s_add_u32 s36, s20, 7168
  s_mov_b32 s37, 0
  buffer_load_dword v164, v4, s[8:11], s20 offen sc1
  s_nop 7
  buffer_load_dword v165, v4, s[8:11], s20 offen sc1
  s_nop 7
  buffer_load_dword v166, v4, s[8:11], s20 offen sc1
  s_nop 7
  buffer_load_dword v167, v4, s[8:11], s20 offen sc1
  s_nop 7
  buffer_load_dword v168, v4, s[8:11], s20 offen sc1
cA_va0_fw_l:
  s_waitcnt vmcnt(4)
  v_cmp_eq_u32 vcc, -1, v164
  s_cbranch_vccz cA_va0_fw_d
  buffer_load_dword v164, v4, s[8:11], s20 offen sc1
  s_waitcnt vmcnt(4)
  v_cmp_eq_u32 vcc, -1, v165
  s_cbranch_vccz cA_va0_fw_d
  buffer_load_dword v165, v4, s[8:11], s20 offen sc1
  s_waitcnt vmcnt(4)
  v_cmp_eq_u32 vcc, -1, v166
  s_cbranch_vccz cA_va0_fw_d
  buffer_load_dword v166, v4, s[8:11], s20 offen sc1
  s_waitcnt vmcnt(4)
  v_cmp_eq_u32 vcc, -1, v167
  s_cbranch_vccz cA_va0_fw_d
  buffer_load_dword v167, v4, s[8:11], s20 offen sc1
  s_waitcnt vmcnt(4)
  v_cmp_eq_u32 vcc, -1, v168
  s_cbranch_vccz cA_va0_fw_d
  buffer_load_dword v168, v4, s[8:11], s20 offen sc1
  s_add_u32 s30, s30, 1
  s_cmp_lt_u32 s30, 400000
  s_cbranch_scc1 cA_va0_fw_l
  s_branch cA_abort
cA_va0_fw_d:
  s_waitcnt lgkmcnt(0)
  buffer_load_dwordx4 v[8:11], v2, s[8:11], s22 offen offset:0
  v_mov_b32 v36, 0
  v_mov_b32 v37, 0
  v_mov_b32 v38, 0
  buffer_load_dwordx4 v[12:15], v2, s[8:11], s22 offen offset:1024
  v_mov_b32 v39, 0
  v_mov_b32 v40, 0
  v_mov_b32 v41, 0
  buffer_load_dwordx4 v[16:19], v2, s[8:11], s22 offen offset:2048
  v_mov_b32 v42, 0
  v_mov_b32 v43, 0
  v_mov_b32 v44, 0
  buffer_load_dwordx4 v[20:23], v2, s[8:11], s22 offen offset:3072
  v_mov_b32 v45, 0
  v_mov_b32 v46, 0
  v_mov_b32 v47, 0
  buffer_load_dwordx4 v[24:27], v2, s[8:11], s34 offen offset:0
  v_mov_b32 v48, 0
  v_mov_b32 v49, 0
  v_mov_b32 v50, 0
  buffer_load_dwordx4 v[28:31], v2, s[8:11], s34 offen offset:1024
  v_mov_b32 v51, 0
  v_mov_b32 v52, 0
  v_mov_b32 v53, 0
  buffer_load_dwordx4 v[32:35], v2, s[8:11], s34 offen offset:2048
  v_mov_b32 v54, 0
  v_mov_b32 v55, 0
  v_mov_b32 v56, 0
  buffer_load_dwordx4 v[144:147], v2, s[8:11], s34 offen offset:3072
  v_mov_b32 v57, 0
  v_mov_b32 v58, 0
  v_mov_b32 v59, 0
  buffer_load_dwordx4 v[148:151], v2, s[8:11], s36 offen offset:0
  buffer_load_dwordx4 v[152:155], v2, s[8:11], s36 offen offset:1024
  s_barrier
  ds_read_b128 v[64:67], v2 offset:0
  ds_read_b128 v[68:71], v2 offset:1024
  ds_read_b128 v[72:75], v2 offset:2048
  ds_read_b128 v[76:79], v2 offset:3072
  s_waitcnt vmcnt(9)
  v_smfmac_f32_16x16x64_bf16 v[156:159], v[8:11], v[80:87], v3
  s_waitcnt vmcnt(8)
  v_smfmac_f32_16x16x64_bf16 v[156:159], v[12:15], v[88:95], v3
  s_waitcnt vmcnt(7)
  v_smfmac_f32_16x16x64_bf16 v[156:159], v[16:19], v[96:103], v3
  s_waitcnt vmcnt(6)
  v_smfmac_f32_16x16x64_bf16 v[156:159], v[20:23], v[104:111], v3
  s_waitcnt vmcnt(5)
  v_smfmac_f32_16x16x64_bf16 v[156:159], v[24:27], v[112:119], v3
  s_mov_b32 exec_hi, 0
  buffer_store_dword v2, v7, s[8:11], s21 offen
  s_mov_b64 exec, -1
  s_waitcnt vmcnt(5)
  v_smfmac_f32_16x16x64_bf16 v[156:159], v[28:31], v[120:127], v3
  s_waitcnt vmcnt(4)
  v_smfmac_f32_16x16x64_bf16 v[156:159], v[32:35], v[128:135], v3
  s_waitcnt vmcnt(3)
  v_smfmac_f32_16x16x64_bf16 v[156:159], v[144:147], v[136:143], v3
  s_waitcnt vmcnt(2) lgkmcnt(0)
  v_smfmac_f32_16x16x64_bf16 v[156:159], v[148:151], v[64:71], v3
  s_waitcnt vmcnt(1)
  v_smfmac_f32_16x16x64_bf16 v[156:159], v[152:155], v[72:79], v3
cA_va0_ep:
  s_nop 7
  v_permlane32_swap_b32 v156, v158
  v_permlane32_swap_b32 v157, v159
  v_add_f32 v160, v156, v158
  v_add_f32 v161, v157, v159
  v_mov_b32 v156, 0
  v_mov_b32_dpp v162, v160 row_ror:8 row_mask:0xf bank_mask:0xf
  v_cmp_u_f32 vcc, v160, v161
  v_mov_b32_dpp v160, v161 row_ror:8 row_mask:0xf bank_mask:0xc
  v_mov_b32 v157, 0
  v_mov_b32_dpp v161, v162 quad_perm:[0,1,2,3] row_mask:0xf bank_mask:0x3
  v_mov_b32 v158, 0
  v_cvt_pk_bf16_f32 v160, v160, v161
  v_mov_b32 v159, 0
  v_min_u32 v160, -2, v160
  s_cbranch_vccnz cA_va0_rp
cA_va0_pc:
  buffer_store_dword v160, v1, s[8:11], s21 offen
  s_cmp_lg_u32 s19, 62
  s_cbranch_scc1 cA_va0_nl
  s_mov_b32 s22, 88519680
  buffer_store_dword v160, v1, s[8:11], s22 offen sc1
  s_mov_b64 exec, -1
  s_branch cA_done
cA_va0_nl:
  s_mov_b64 exec, -1
  s_add_u32 s25, s25, 28672
  s_add_u32 s19, s19, 1
  s_mov_b32 s20, s21
  s_branch cA_va0_loop
cA_va0_last:
  s_waitcnt lgkmcnt(0)
  s_barrier
  s_branch cA_done
cA_va0_rp:
  s_cmp_lg_u32 s37, 0
  s_cbranch_scc1 cA_va0_pc
cA_va0_rv:
  buffer_load_dwordx4 v[8:11], v2, s[8:11], s22 offen offset:0 sc1
  buffer_load_dwordx4 v[12:15], v2, s[8:11], s22 offen offset:1024 sc1
  buffer_load_dwordx4 v[16:19], v2, s[8:11], s22 offen offset:2048 sc1
  buffer_load_dwordx4 v[20:23], v2, s[8:11], s22 offen offset:3072 sc1
  buffer_load_dwordx4 v[24:27], v2, s[8:11], s34 offen offset:0 sc1
  buffer_load_dwordx4 v[28:31], v2, s[8:11], s34 offen offset:1024 sc1
  buffer_load_dwordx4 v[32:35], v2, s[8:11], s34 offen offset:2048 sc1
  buffer_load_dwordx4 v[144:147], v2, s[8:11], s34 offen offset:3072 sc1
  buffer_load_dwordx4 v[148:151], v2, s[8:11], s36 offen offset:0 sc1
  buffer_load_dwordx4 v[152:155], v2, s[8:11], s36 offen offset:1024 sc1
  s_waitcnt vmcnt(0)
  v_max3_u32 v63, v8, v9, v10
  v_max3_u32 v63, v63, v11, v12
  v_max3_u32 v63, v63, v13, v14
  v_max3_u32 v63, v63, v15, v16
  v_max3_u32 v63, v63, v17, v18
  v_max3_u32 v63, v63, v19, v20
  v_max3_u32 v63, v63, v21, v22
  v_max3_u32 v63, v63, v23, v24
  v_max3_u32 v63, v63, v25, v26
  v_max3_u32 v63, v63, v27, v28
  v_max3_u32 v63, v63, v29, v30
  v_max3_u32 v63, v63, v31, v32
  v_max3_u32 v63, v63, v33, v34
  v_max3_u32 v63, v63, v35, v144
  v_max3_u32 v63, v63, v145, v146
  v_max3_u32 v63, v63, v147, v148
  v_max3_u32 v63, v63, v149, v150
  v_max3_u32 v63, v63, v151, v152
  v_max3_u32 v63, v63, v153, v154
  v_max_u32 v63, v63, v155
  v_cmp_eq_u32 vcc, -1, v63
  s_cbranch_vccz cA_va0_rk
  s_add_u32 s30, s30, 1
  s_cmp_lt_u32 s30, 400000
  s_cbranch_scc1 cA_va0_rv
  s_branch cA_abort
cA_va0_rk:
  s_mov_b32 s37, 1
  s_add_u32 s31, s31, 0x10000
  v_smfmac_f32_16x16x64_bf16 v[156:159], v[8:11], v[80:87], v3
  v_smfmac_f32_16x16x64_bf16 v[156:159], v[12:15], v[88:95], v3
  v_smfmac_f32_16x16x64_bf16 v[156:159], v[16:19], v[96:103], v3
  v_smfmac_f32_16x16x64_bf16 v[156:159], v[20:23], v[104:111], v3
  v_smfmac_f32_16x16x64_bf16 v[156:159], v[24:27], v[112:119], v3
  v_smfmac_f32_16x16x64_bf16 v[156:159], v[28:31], v[120:127], v3
  v_smfmac_f32_16x16x64_bf16 v[156:159], v[32:35], v[128:135], v3
  v_smfmac_f32_16x16x64_bf16 v[156:159], v[144:147], v[136:143], v3
  v_smfmac_f32_16x16x64_bf16 v[156:159], v[148:151], v[64:71], v3
  v_smfmac_f32_16x16x64_bf16 v[156:159], v[152:155], v[72:79], v3
  s_nop 7
  s_branch cA_va0_ep
cA_va1_loop:
  s_add_u32 s23, s20, 4096
  s_add_u32 s21, s20, 25600
  s_mov_b32 s30, 0
  s_and_b32 s22, s19, 7
  s_cmp_lg_u32 s22, 0
  s_cbranch_scc1 cA_va1_vok
  v_mov_b32 v164, 0
cA_va1_vow:
  buffer_load_dword v165, v164, s[8:11], s35 offen sc1
  s_waitcnt vmcnt(0)
  v_readfirstlane_b32 s22, v165
  s_cmp_eq_u32 s22, 56
  s_cbranch_scc1 cA_va1_vod
  s_sleep 2
  s_add_u32 s30, s30, 1
  s_cmp_lt_u32 s30, 400000
  s_cbranch_scc1 cA_va1_vow
  s_branch cA_abort
cA_va1_vod:
  s_add_u32 s35, s35, 64
cA_va1_vok:
  s_cmp_eq_u32 s19, 63
  s_cbranch_scc1 cA_done
  s_barrier
  s_add_u32 s22, s25, 0
  buffer_load_dwordx4 v[80:83], v6, s[8:11], s22 offen offset:0 sc1
  buffer_load_dwordx4 v[84:87], v6, s[8:11], s22 offen offset:1792 sc1
  s_add_u32 s22, s25, 3584
  buffer_load_dwordx4 v[88:91], v6, s[8:11], s22 offen offset:0 sc1
  buffer_load_dwordx4 v[92:95], v6, s[8:11], s22 offen offset:1792 sc1
  s_add_u32 s22, s25, 7168
  buffer_load_dwordx4 v[96:99], v6, s[8:11], s22 offen offset:0 sc1
  buffer_load_dwordx4 v[100:103], v6, s[8:11], s22 offen offset:1792 sc1
  s_add_u32 s22, s25, 10752
  buffer_load_dwordx4 v[104:107], v6, s[8:11], s22 offen offset:0 sc1
  buffer_load_dwordx4 v[108:111], v6, s[8:11], s22 offen offset:1792 sc1
  s_add_u32 s22, s25, 14336
  buffer_load_dwordx4 v[112:115], v6, s[8:11], s22 offen offset:0 sc1
  buffer_load_dwordx4 v[116:119], v6, s[8:11], s22 offen offset:1792 sc1
  s_add_u32 s22, s25, 17920
  buffer_load_dwordx4 v[120:123], v6, s[8:11], s22 offen offset:0 sc1
  buffer_load_dwordx4 v[124:127], v6, s[8:11], s22 offen offset:1792 sc1
  s_add_u32 s22, s25, 21504
  buffer_load_dwordx4 v[128:131], v6, s[8:11], s22 offen offset:0 sc1
  buffer_load_dwordx4 v[132:135], v6, s[8:11], s22 offen offset:1792 sc1
  s_add_u32 s22, s25, 25088
  buffer_load_dwordx4 v[136:139], v6, s[8:11], s22 offen offset:0 sc1
  buffer_load_dwordx4 v[140:143], v6, s[8:11], s22 offen offset:1792 sc1
  s_barrier
  ds_read_b128 v[8:11], v2 offset:8192
  ds_read_b128 v[12:15], v2 offset:9216
  ds_read_b128 v[16:19], v2 offset:10240
  ds_read_b128 v[20:23], v2 offset:11264
  ds_read_b128 v[24:27], v2 offset:12288
  ds_read_b128 v[28:31], v2 offset:13312
  ds_read_b128 v[32:35], v2 offset:14336
  s_waitcnt lgkmcnt(0)
  v_smfmac_f32_16x16x64_bf16 v[36:39], v[8:11], a[0:7], v3
  v_smfmac_f32_16x16x64_bf16 v[36:39], v[12:15], a[8:15], v3
  v_smfmac_f32_16x16x64_bf16 v[36:39], v[16:19], a[16:23], v3
  v_smfmac_f32_16x16x64_bf16 v[36:39], v[20:23], a[24:31], v3
  v_smfmac_f32_16x16x64_bf16 v[36:39], v[24:27], a[32:39], v3
  v_smfmac_f32_16x16x64_bf16 v[36:39], v[28:31], a[40:47], v3
  v_smfmac_f32_16x16x64_bf16 v[36:39], v[32:35], a[48:55], v3
  v_smfmac_f32_16x16x64_bf16 v[40:43], v[8:11], a[56:63], v3
  v_smfmac_f32_16x16x64_bf16 v[40:43], v[12:15], a[64:71], v3
  v_smfmac_f32_16x16x64_bf16 v[40:43], v[16:19], a[72:79], v3
  v_smfmac_f32_16x16x64_bf16 v[40:43], v[20:23], a[80:87], v3
  v_smfmac_f32_16x16x64_bf16 v[40:43], v[24:27], a[88:95], v3
  v_smfmac_f32_16x16x64_bf16 v[40:43], v[28:31], a[96:103], v3
  v_smfmac_f32_16x16x64_bf16 v[40:43], v[32:35], a[104:111], v3
  v_smfmac_f32_16x16x64_bf16 v[44:47], v[8:11], a[112:119], v3
  v_smfmac_f32_16x16x64_bf16 v[44:47], v[12:15], a[120:127], v3
  v_smfmac_f32_16x16x64_bf16 v[44:47], v[16:19], a[128:135], v3
  v_smfmac_f32_16x16x64_bf16 v[44:47], v[20:23], a[136:143], v3
  v_permlane32_swap_b32 v36, v40
  v_smfmac_f32_16x16x64_bf16 v[44:47], v[24:27], a[144:151], v3
  v_permlane32_swap_b32 v37, v41
  v_smfmac_f32_16x16x64_bf16 v[44:47], v[28:31], a[152:159], v3
  v_permlane32_swap_b32 v38, v42
  v_smfmac_f32_16x16x64_bf16 v[44:47], v[32:35], a[160:167], v3
  v_permlane32_swap_b32 v39, v43
  v_smfmac_f32_16x16x64_bf16 v[48:51], v[8:11], a[168:175], v3
  v_add_f32 v36, v36, v40
  v_smfmac_f32_16x16x64_bf16 v[48:51], v[12:15], a[176:183], v3
  v_add_f32 v37, v37, v41
  v_smfmac_f32_16x16x64_bf16 v[48:51], v[16:19], a[184:191], v3
  v_add_f32 v38, v38, v42
  v_smfmac_f32_16x16x64_bf16 v[48:51], v[20:23], a[192:199], v3
  v_add_f32 v39, v39, v43
  v_smfmac_f32_16x16x64_bf16 v[48:51], v[24:27], a[200:207], v3
  v_cvt_pk_bf16_f32 v40, v36, v37
  v_smfmac_f32_16x16x64_bf16 v[48:51], v[28:31], a[208:215], v3
  v_cvt_pk_bf16_f32 v41, v38, v39
  v_smfmac_f32_16x16x64_bf16 v[48:51], v[32:35], a[216:223], v3
  ds_write_b64 v60, v[40:41]
  v_smfmac_f32_16x16x64_bf16 v[52:55], v[8:11], a[224:231], v3
  v_smfmac_f32_16x16x64_bf16 v[52:55], v[12:15], a[232:239], v3
  v_smfmac_f32_16x16x64_bf16 v[52:55], v[16:19], a[240:247], v3
  v_smfmac_f32_16x16x64_bf16 v[52:55], v[20:23], a[248:255], v3
  v_permlane32_swap_b32 v44, v48
  v_smfmac_f32_16x16x64_bf16 v[52:55], v[24:27], v[176:183], v3
  v_permlane32_swap_b32 v45, v49
  v_smfmac_f32_16x16x64_bf16 v[52:55], v[28:31], v[184:191], v3
  v_permlane32_swap_b32 v46, v50
  v_smfmac_f32_16x16x64_bf16 v[52:55], v[32:35], v[192:199], v3
  v_permlane32_swap_b32 v47, v51
  v_smfmac_f32_16x16x64_bf16 v[56:59], v[8:11], v[200:207], v3
  v_add_f32 v44, v44, v48
  v_smfmac_f32_16x16x64_bf16 v[56:59], v[12:15], v[208:215], v3
  v_add_f32 v45, v45, v49
  v_smfmac_f32_16x16x64_bf16 v[56:59], v[16:19], v[216:223], v3
  v_add_f32 v46, v46, v50
  v_smfmac_f32_16x16x64_bf16 v[56:59], v[20:23], v[224:231], v3
  v_add_f32 v47, v47, v51
  v_smfmac_f32_16x16x64_bf16 v[56:59], v[24:27], v[232:239], v3
  v_cvt_pk_bf16_f32 v48, v44, v45
  v_smfmac_f32_16x16x64_bf16 v[56:59], v[28:31], v[240:247], v3
  v_cvt_pk_bf16_f32 v49, v46, v47
  v_smfmac_f32_16x16x64_bf16 v[56:59], v[32:35], v[248:255], v3
  ds_write_b64 v61, v[48:49]
  s_nop 6
  v_permlane32_swap_b32 v52, v56
  v_permlane32_swap_b32 v53, v57
  v_permlane32_swap_b32 v54, v58
  v_permlane32_swap_b32 v55, v59
  v_add_f32 v52, v52, v56
  v_add_f32 v53, v53, v57
  v_add_f32 v54, v54, v58
  v_add_f32 v55, v55, v59
  v_cvt_pk_bf16_f32 v56, v52, v53
  v_cvt_pk_bf16_f32 v57, v54, v55
  ds_write_b64 v62, v[56:57]
  s_cmp_eq_u32 s19, 63
  s_cbranch_scc1 cA_va1_last
  s_add_u32 s22, s20, 9216
  s_add_u32 s34, s20, 13312
  s_add_u32 s36, s20, 7168
  s_mov_b32 s37, 0
  buffer_load_dword v164, v4, s[8:11], s20 offen sc1
  s_nop 7
  buffer_load_dword v165, v4, s[8:11], s20 offen sc1
  s_nop 7
  buffer_load_dword v166, v4, s[8:11], s20 offen sc1
  s_nop 7
  buffer_load_dword v167, v4, s[8:11], s20 offen sc1
  s_nop 7
  buffer_load_dword v168, v4, s[8:11], s20 offen sc1
cA_va1_fw_l:
  s_waitcnt vmcnt(4)
  v_cmp_eq_u32 vcc, -1, v164
  s_cbranch_vccz cA_va1_fw_d
  buffer_load_dword v164, v4, s[8:11], s20 offen sc1
  s_waitcnt vmcnt(4)
  v_cmp_eq_u32 vcc, -1, v165
  s_cbranch_vccz cA_va1_fw_d
  buffer_load_dword v165, v4, s[8:11], s20 offen sc1
  s_waitcnt vmcnt(4)
  v_cmp_eq_u32 vcc, -1, v166
  s_cbranch_vccz cA_va1_fw_d
  buffer_load_dword v166, v4, s[8:11], s20 offen sc1
  s_waitcnt vmcnt(4)
  v_cmp_eq_u32 vcc, -1, v167
  s_cbranch_vccz cA_va1_fw_d
  buffer_load_dword v167, v4, s[8:11], s20 offen sc1
  s_waitcnt vmcnt(4)
  v_cmp_eq_u32 vcc, -1, v168
  s_cbranch_vccz cA_va1_fw_d
  buffer_load_dword v168, v4, s[8:11], s20 offen sc1
  s_add_u32 s30, s30, 1
  s_cmp_lt_u32 s30, 400000
  s_cbranch_scc1 cA_va1_fw_l
  s_branch cA_abort
cA_va1_fw_d:
  s_waitcnt lgkmcnt(0)
  buffer_load_dwordx4 v[8:11], v2, s[8:11], s22 offen offset:0
  v_mov_b32 v36, 0
  v_mov_b32 v37, 0
  v_mov_b32 v38, 0
  buffer_load_dwordx4 v[12:15], v2, s[8:11], s22 offen offset:1024
  v_mov_b32 v39, 0
  v_mov_b32 v40, 0
  v_mov_b32 v41, 0
  buffer_load_dwordx4 v[16:19], v2, s[8:11], s22 offen offset:2048
  v_mov_b32 v42, 0
  v_mov_b32 v43, 0
  v_mov_b32 v44, 0
  buffer_load_dwordx4 v[20:23], v2, s[8:11], s22 offen offset:3072
  v_mov_b32 v45, 0
  v_mov_b32 v46, 0
  v_mov_b32 v47, 0
  buffer_load_dwordx4 v[24:27], v2, s[8:11], s34 offen offset:0
  v_mov_b32 v48, 0
  v_mov_b32 v49, 0
  v_mov_b32 v50, 0
  buffer_load_dwordx4 v[28:31], v2, s[8:11], s34 offen offset:1024
  v_mov_b32 v51, 0
  v_mov_b32 v52, 0
  v_mov_b32 v53, 0
  buffer_load_dwordx4 v[32:35], v2, s[8:11], s34 offen offset:2048
  v_mov_b32 v54, 0
  v_mov_b32 v55, 0
  v_mov_b32 v56, 0
  buffer_load_dwordx4 v[144:147], v2, s[8:11], s34 offen offset:3072
  v_mov_b32 v57, 0
  v_mov_b32 v58, 0
  v_mov_b32 v59, 0
  buffer_load_dwordx4 v[148:151], v2, s[8:11], s36 offen offset:0
  buffer_load_dwordx4 v[152:155], v2, s[8:11], s36 offen offset:1024
  s_barrier
  ds_read_b128 v[64:67], v2 offset:4096
  ds_read_b128 v[68:71], v2 offset:5120
  ds_read_b128 v[72:75], v2 offset:6144
  ds_read_b128 v[76:79], v2 offset:7168
  s_waitcnt vmcnt(9)
  v_smfmac_f32_16x16x64_bf16 v[156:159], v[8:11], v[80:87], v3
  s_waitcnt vmcnt(8)
  v_smfmac_f32_16x16x64_bf16 v[156:159], v[12:15], v[88:95], v3
  s_waitcnt vmcnt(7)
  v_smfmac_f32_16x16x64_bf16 v[156:159], v[16:19], v[96:103], v3
  s_waitcnt vmcnt(6)
  v_smfmac_f32_16x16x64_bf16 v[156:159], v[20:23], v[104:111], v3
  s_waitcnt vmcnt(5)
  v_smfmac_f32_16x16x64_bf16 v[156:159], v[24:27], v[112:119], v3
  s_mov_b32 exec_hi, 0
  buffer_store_dword v2, v7, s[8:11], s21 offen
  s_mov_b64 exec, -1
  s_waitcnt vmcnt(5)
  v_smfmac_f32_16x16x64_bf16 v[156:159], v[28:31], v[120:127], v3
  s_waitcnt vmcnt(4)
  v_smfmac_f32_16x16x64_bf16 v[156:159], v[32:35], v[128:135], v3
  s_waitcnt vmcnt(3)
  v_smfmac_f32_16x16x64_bf16 v[156:159], v[144:147], v[136:143], v3
  s_waitcnt vmcnt(2) lgkmcnt(0)
  v_smfmac_f32_16x16x64_bf16 v[156:159], v[148:151], v[64:71], v3
  s_waitcnt vmcnt(1)
  v_smfmac_f32_16x16x64_bf16 v[156:159], v[152:155], v[72:79], v3
cA_va1_ep:
  s_nop 7
  v_permlane32_swap_b32 v156, v158
  v_permlane32_swap_b32 v157, v159
  v_add_f32 v160, v156, v158
  v_add_f32 v161, v157, v159
  v_mov_b32 v156, 0
  v_mov_b32_dpp v162, v160 row_ror:8 row_mask:0xf bank_mask:0xf
  v_cmp_u_f32 vcc, v160, v161
  v_mov_b32_dpp v160, v161 row_ror:8 row_mask:0xf bank_mask:0xc
  v_mov_b32 v157, 0
  v_mov_b32_dpp v161, v162 quad_perm:[0,1,2,3] row_mask:0xf bank_mask:0x3
  v_mov_b32 v158, 0
  v_cvt_pk_bf16_f32 v160, v160, v161
  v_mov_b32 v159, 0
  v_min_u32 v160, -2, v160
  s_cbranch_vccnz cA_va1_rp
cA_va1_pc:
  s_mov_b64 exec, s[26:27]
  buffer_store_dword v160, v1, s[8:11], s21 offen
  s_cmp_lg_u32 s19, 62
  s_cbranch_scc1 cA_va1_nl
  s_mov_b32 s22, 88519680
  buffer_store_dword v160, v1, s[8:11], s22 offen sc1
  s_mov_b64 exec, -1
  s_branch cA_done
cA_va1_nl:
  s_mov_b64 exec, -1
  s_add_u32 s25, s25, 28672
  s_add_u32 s19, s19, 1
  s_mov_b32 s20, s21
  s_branch cA_va1_loop
cA_va1_last:
  s_waitcnt lgkmcnt(0)
  s_barrier
  s_branch cA_done
cA_va1_rp:
  s_cmp_lg_u32 s37, 0
  s_cbranch_scc1 cA_va1_pc
cA_va1_rv:
  buffer_load_dwordx4 v[8:11], v2, s[8:11], s22 offen offset:0 sc1
  buffer_load_dwordx4 v[12:15], v2, s[8:11], s22 offen offset:1024 sc1
  buffer_load_dwordx4 v[16:19], v2, s[8:11], s22 offen offset:2048 sc1
  buffer_load_dwordx4 v[20:23], v2, s[8:11], s22 offen offset:3072 sc1
  buffer_load_dwordx4 v[24:27], v2, s[8:11], s34 offen offset:0 sc1
  buffer_load_dwordx4 v[28:31], v2, s[8:11], s34 offen offset:1024 sc1
  buffer_load_dwordx4 v[32:35], v2, s[8:11], s34 offen offset:2048 sc1
  buffer_load_dwordx4 v[144:147], v2, s[8:11], s34 offen offset:3072 sc1
  buffer_load_dwordx4 v[148:151], v2, s[8:11], s36 offen offset:0 sc1
  buffer_load_dwordx4 v[152:155], v2, s[8:11], s36 offen offset:1024 sc1
  s_waitcnt vmcnt(0)
  v_max3_u32 v63, v8, v9, v10
  v_max3_u32 v63, v63, v11, v12
  v_max3_u32 v63, v63, v13, v14
  v_max3_u32 v63, v63, v15, v16
  v_max3_u32 v63, v63, v17, v18
  v_max3_u32 v63, v63, v19, v20
  v_max3_u32 v63, v63, v21, v22
  v_max3_u32 v63, v63, v23, v24
  v_max3_u32 v63, v63, v25, v26
  v_max3_u32 v63, v63, v27, v28
  v_max3_u32 v63, v63, v29, v30
  v_max3_u32 v63, v63, v31, v32
  v_max3_u32 v63, v63, v33, v34
  v_max3_u32 v63, v63, v35, v144
  v_max3_u32 v63, v63, v145, v146
  v_max3_u32 v63, v63, v147, v148
  v_max3_u32 v63, v63, v149, v150
  v_max3_u32 v63, v63, v151, v152
  v_max3_u32 v63, v63, v153, v154
  v_max_u32 v63, v63, v155
  v_cmp_eq_u32 vcc, -1, v63
  s_cbranch_vccz cA_va1_rk
  s_add_u32 s30, s30, 1
  s_cmp_lt_u32 s30, 400000
  s_cbranch_scc1 cA_va1_rv
  s_branch cA_abort
cA_va1_rk:
  s_mov_b32 s37, 1
  s_add_u32 s31, s31, 0x10000
  v_smfmac_f32_16x16x64_bf16 v[156:159], v[8:11], v[80:87], v3
  v_smfmac_f32_16x16x64_bf16 v[156:159], v[12:15], v[88:95], v3
  v_smfmac_f32_16x16x64_bf16 v[156:159], v[16:19], v[96:103], v3
  v_smfmac_f32_16x16x64_bf16 v[156:159], v[20:23], v[104:111], v3
  v_smfmac_f32_16x16x64_bf16 v[156:159], v[24:27], v[112:119], v3
  v_smfmac_f32_16x16x64_bf16 v[156:159], v[28:31], v[120:127], v3
  v_smfmac_f32_16x16x64_bf16 v[156:159], v[32:35], v[128:135], v3
  v_smfmac_f32_16x16x64_bf16 v[156:159], v[144:147], v[136:143], v3
  v_smfmac_f32_16x16x64_bf16 v[156:159], v[148:151], v[64:71], v3
  v_smfmac_f32_16x16x64_bf16 v[156:159], v[152:155], v[72:79], v3
  s_nop 7
  s_branch cA_va1_ep
cA_va2_loop:
  s_add_u32 s23, s20, 4096
  s_add_u32 s21, s20, 25600
  v_mov_b32 v36, 0
  v_mov_b32 v37, 0
  v_mov_b32 v38, 0
  v_mov_b32 v39, 0
  v_mov_b32 v40, 0
  v_mov_b32 v41, 0
  v_mov_b32 v42, 0
  v_mov_b32 v43, 0
  v_mov_b32 v44, 0
  v_mov_b32 v45, 0
  v_mov_b32 v46, 0
  v_mov_b32 v47, 0
  v_mov_b32 v48, 0
  v_mov_b32 v49, 0
  v_mov_b32 v50, 0
  v_mov_b32 v51, 0
  v_mov_b32 v52, 0
  v_mov_b32 v53, 0
  v_mov_b32 v54, 0
  v_mov_b32 v55, 0
  v_mov_b32 v56, 0
  v_mov_b32 v57, 0
  v_mov_b32 v58, 0
  v_mov_b32 v59, 0
  v_mov_b32 v60, 0
  v_mov_b32 v61, 0
  v_mov_b32 v62, 0
  v_mov_b32 v63, 0
  v_mov_b32 v64, 0
  v_mov_b32 v65, 0
  v_mov_b32 v66, 0
  v_mov_b32 v67, 0
  s_mov_b32 s30, 0
  buffer_load_dword v76, v119, s[8:11], s20 offen sc1
  buffer_load_dword v77, v119, s[8:11], s20 offen sc1
  buffer_load_dword v78, v119, s[8:11], s20 offen sc1
cA_va2_fp_l:
  s_waitcnt vmcnt(2)
  v_cmp_eq_u32 vcc, -1, v76
  s_cbranch_vccz cA_va2_fp_d
  buffer_load_dword v76, v119, s[8:11], s20 offen sc1
  s_waitcnt vmcnt(2)
  v_cmp_eq_u32 vcc, -1, v77
  s_cbranch_vccz cA_va2_fp_d
  buffer_load_dword v77, v119, s[8:11], s20 offen sc1
  s_waitcnt vmcnt(2)
  v_cmp_eq_u32 vcc, -1, v78
  s_cbranch_vccz cA_va2_fp_d
  buffer_load_dword v78, v119, s[8:11], s20 offen sc1
  s_add_u32 s30, s30, 1
  s_cmp_lt_u32 s30, 400000
  s_cbranch_scc1 cA_va2_fp_l
  s_branch cA_abort
cA_va2_fp_d:
  buffer_load_dwordx4 v[8:11], v2, s[8:11], s20 offen offset:0 sc1
  buffer_load_dwordx4 v[12:15], v2, s[8:11], s20 offen offset:1024 sc1
  buffer_load_dwordx4 v[16:19], v2, s[8:11], s20 offen offset:2048 sc1
  buffer_load_dwordx4 v[20:23], v2, s[8:11], s20 offen offset:3072 sc1
  s_barrier
cA_va2_ld:
  s_waitcnt vmcnt(0)
  v_max3_u32 v84, v8, v9, v10
  v_max3_u32 v84, v84, v11, v12
  v_max3_u32 v84, v84, v13, v14
  v_max3_u32 v84, v84, v15, v16
  v_max3_u32 v84, v84, v17, v18
  v_max3_u32 v84, v84, v19, v20
  v_max3_u32 v84, v84, v21, v22
  v_max_u32 v84, v84, v23
  v_cmp_eq_u32 vcc, -1, v84
  ds_write_b128 v2, v[8:11] offset:8192
  ds_write_b128 v2, v[12:15] offset:9216
  ds_write_b128 v2, v[16:19] offset:10240
  ds_write_b128 v2, v[20:23] offset:11264
  s_cbranch_vccnz cA_va2_retry
  s_waitcnt lgkmcnt(0)
  s_barrier
  ds_read_b128 v[24:27], v2 offset:12288
  ds_read_b128 v[28:31], v2 offset:13312
  ds_read_b128 v[32:35], v2 offset:14336
  ds_read_b128 v[92:95], v0
  s_waitcnt lgkmcnt(0)
  s_mov_b64 exec, s[26:27]
  buffer_store_dwordx4 v[92:95], v2, s[8:11], s36 offen sc1
  s_mov_b64 exec, -1
  s_add_u32 s36, s36, 7168
  s_cmp_eq_u32 s19, 63
  s_cbranch_scc1 cA_done
  ds_read_b128 v[76:79], v1 offset:0
  ds_read_b128 v[80:83], v1 offset:1024
  ds_read_b128 v[84:87], v1 offset:2048
  ds_read_b128 v[88:91], v1 offset:3072
  ds_read_b128 v[92:95], v1 offset:4096
  ds_read_b128 v[96:99], v1 offset:5120
  v_smfmac_f32_16x16x64_bf16 v[60:63], v[8:11], v[200:207], v3
  v_smfmac_f32_16x16x64_bf16 v[60:63], v[12:15], v[208:215], v3
  s_waitcnt lgkmcnt(4)
  v_smfmac_f32_16x16x64_bf16 v[64:67], v[8:11], v[76:83], v3
  ds_read_b128 v[76:79], v1 offset:6144
  ds_read_b128 v[80:83], v1 offset:7168
  v_smfmac_f32_16x16x64_bf16 v[60:63], v[16:19], v[216:223], v3
  v_smfmac_f32_16x16x64_bf16 v[60:63], v[20:23], v[224:231], v3
  s_waitcnt lgkmcnt(4)
  v_smfmac_f32_16x16x64_bf16 v[64:67], v[12:15], v[84:91], v3
  ds_read_b128 v[84:87], v1 offset:8192
  ds_read_b128 v[88:91], v1 offset:9216
  v_smfmac_f32_16x16x64_bf16 v[60:63], v[24:27], v[232:239], v3
  v_smfmac_f32_16x16x64_bf16 v[60:63], v[28:31], v[240:247], v3
  s_waitcnt lgkmcnt(4)
  v_smfmac_f32_16x16x64_bf16 v[64:67], v[16:19], v[92:99], v3
  ds_read_b128 v[92:95], v1 offset:10240
  ds_read_b128 v[96:99], v1 offset:11264
  v_smfmac_f32_16x16x64_bf16 v[60:63], v[32:35], v[248:255], v3
  v_smfmac_f32_16x16x64_bf16 v[36:39], v[8:11], a[0:7], v3
  s_waitcnt lgkmcnt(4)
  v_smfmac_f32_16x16x64_bf16 v[64:67], v[20:23], v[76:83], v3
  ds_read_b128 v[76:79], v1 offset:12288
  ds_read_b128 v[80:83], v1 offset:13312
  v_smfmac_f32_16x16x64_bf16 v[36:39], v[12:15], a[8:15], v3
  v_smfmac_f32_16x16x64_bf16 v[36:39], v[16:19], a[16:23], v3
  s_waitcnt lgkmcnt(4)
  v_smfmac_f32_16x16x64_bf16 v[64:67], v[24:27], v[84:91], v3
  v_smfmac_f32_16x16x64_bf16 v[36:39], v[20:23], a[24:31], v3
  v_smfmac_f32_16x16x64_bf16 v[36:39], v[24:27], a[32:39], v3
  s_waitcnt lgkmcnt(2)
  v_smfmac_f32_16x16x64_bf16 v[64:67], v[28:31], v[92:99], v3
  v_smfmac_f32_16x16x64_bf16 v[36:39], v[28:31], a[40:47], v3
  v_smfmac_f32_16x16x64_bf16 v[36:39], v[32:35], a[48:55], v3
  s_waitcnt lgkmcnt(0)
  v_smfmac_f32_16x16x64_bf16 v[64:67], v[32:35], v[76:83], v3
  v_smfmac_f32_16x16x64_bf16 v[40:43], v[8:11], a[56:63], v3
  v_smfmac_f32_16x16x64_bf16 v[40:43], v[12:15], a[64:71], v3
  v_smfmac_f32_16x16x64_bf16 v[40:43], v[16:19], a[72:79], v3
  v_smfmac_f32_16x16x64_bf16 v[40:43], v[20:23], a[80:87], v3
  v_permlane32_swap_b32 v60, v64
  v_smfmac_f32_16x16x64_bf16 v[40:43], v[24:27], a[88:95], v3
  v_permlane32_swap_b32 v61, v65
  v_smfmac_f32_16x16x64_bf16 v[40:43], v[28:31], a[96:103], v3
  v_permlane32_swap_b32 v62, v66
  v_smfmac_f32_16x16x64_bf16 v[40:43], v[32:35], a[104:111], v3
  v_permlane32_swap_b32 v63, v67
  v_smfmac_f32_16x16x64_bf16 v[44:47], v[8:11], a[112:119], v3
  v_smfmac_f32_16x16x64_bf16 v[44:47], v[12:15], a[120:127], v3
  v_smfmac_f32_16x16x64_bf16 v[44:47], v[16:19], a[128:135], v3
  v_smfmac_f32_16x16x64_bf16 v[44:47], v[20:23], a[136:143], v3
  v_add_f32 v60, v60, v64
  v_add_f32 v61, v61, v65
  v_smfmac_f32_16x16x64_bf16 v[44:47], v[24:27], a[144:151], v3
  v_add_f32 v62, v62, v66
  v_add_f32 v63, v63, v67
  v_smfmac_f32_16x16x64_bf16 v[44:47], v[28:31], a[152:159], v3
  v_cvt_pk_bf16_f32 v64, v60, v61
  v_cvt_pk_bf16_f32 v65, v62, v63
  v_smfmac_f32_16x16x64_bf16 v[44:47], v[32:35], a[160:167], v3
  ds_write_b64 v115, v[64:65]
  v_smfmac_f32_16x16x64_bf16 v[48:51], v[8:11], a[168:175], v3
  v_permlane32_swap_b32 v36, v40
  v_smfmac_f32_16x16x64_bf16 v[48:51], v[12:15], a[176:183], v3
  v_permlane32_swap_b32 v37, v41
  v_smfmac_f32_16x16x64_bf16 v[48:51], v[16:19], a[184:191], v3
  v_permlane32_swap_b32 v38, v42
  v_smfmac_f32_16x16x64_bf16 v[48:51], v[20:23], a[192:199], v3
  v_permlane32_swap_b32 v39, v43
  v_smfmac_f32_16x16x64_bf16 v[48:51], v[24:27], a[200:207], v3
  v_add_f32 v36, v36, v40
  v_smfmac_f32_16x16x64_bf16 v[48:51], v[28:31], a[208:215], v3
  v_add_f32 v37, v37, v41
  v_smfmac_f32_16x16x64_bf16 v[48:51], v[32:35], a[216:223], v3
  v_add_f32 v38, v38, v42
  v_smfmac_f32_16x16x64_bf16 v[52:55], v[8:11], a[224:231], v3
  v_smfmac_f32_16x16x64_bf16 v[52:55], v[12:15], a[232:239], v3
  v_smfmac_f32_16x16x64_bf16 v[52:55], v[16:19], a[240:247], v3
  v_smfmac_f32_16x16x64_bf16 v[52:55], v[20:23], a[248:255], v3
  v_add_f32 v39, v39, v43
  v_cvt_pk_bf16_f32 v40, v36, v37
  v_smfmac_f32_16x16x64_bf16 v[52:55], v[24:27], v[120:127], v3
  v_cvt_pk_bf16_f32 v41, v38, v39
  v_smfmac_f32_16x16x64_bf16 v[52:55], v[28:31], v[128:135], v3
  ds_write_b64 v112, v[40:41]
  v_smfmac_f32_16x16x64_bf16 v[52:55], v[32:35], v[136:143], v3
  v_permlane32_swap_b32 v44, v48
  v_smfmac_f32_16x16x64_bf16 v[56:59], v[8:11], v[144:151], v3
  v_permlane32_swap_b32 v45, v49
  v_smfmac_f32_16x16x64_bf16 v[56:59], v[12:15], v[152:159], v3
  v_permlane32_swap_b32 v46, v50
  v_smfmac_f32_16x16x64_bf16 v[56:59], v[16:19], v[160:167], v3
  v_permlane32_swap_b32 v47, v51
  v_smfmac_f32_16x16x64_bf16 v[56:59], v[20:23], v[168:175], v3
  v_add_f32 v44, v44, v48
  v_smfmac_f32_16x16x64_bf16 v[56:59], v[24:27], v[176:183], v3
  v_add_f32 v45, v45, v49
  v_smfmac_f32_16x16x64_bf16 v[56:59], v[28:31], v[184:191], v3
  v_add_f32 v46, v46, v50
  v_smfmac_f32_16x16x64_bf16 v[56:59], v[32:35], v[192:199], v3
  v_add_f32 v47, v47, v51
  v_cvt_pk_bf16_f32 v48, v44, v45
  v_cvt_pk_bf16_f32 v49, v46, v47
  ds_write_b64 v113, v[48:49]
  s_nop 3
  v_permlane32_swap_b32 v52, v56
  v_permlane32_swap_b32 v53, v57
  v_permlane32_swap_b32 v54, v58
  v_permlane32_swap_b32 v55, v59
  v_add_f32 v52, v52, v56
  v_add_f32 v53, v53, v57
  v_add_f32 v54, v54, v58
  v_add_f32 v55, v55, v59
  v_cvt_pk_bf16_f32 v56, v52, v53
  v_cvt_pk_bf16_f32 v57, v54, v55
  ds_write_b64 v114, v[56:57]
  s_waitcnt lgkmcnt(0)
  s_barrier
  s_cmp_eq_u32 s19, 62
  s_cbranch_scc1 cA_done
  s_waitcnt vmcnt(0) lgkmcnt(0)
  s_add_u32 s19, s19, 1
  s_mov_b32 s20, s21
  s_branch cA_va2_loop
cA_va2_retry:
  s_waitcnt lgkmcnt(0)
  buffer_load_dwordx4 v[8:11], v2, s[8:11], s20 offen offset:0 sc1
  buffer_load_dwordx4 v[12:15], v2, s[8:11], s20 offen offset:1024 sc1
  buffer_load_dwordx4 v[16:19], v2, s[8:11], s20 offen offset:2048 sc1
  buffer_load_dwordx4 v[20:23], v2, s[8:11], s20 offen offset:3072 sc1
  s_add_u32 s31, s31, 1
  s_add_u32 s30, s30, 1
  s_cmp_lt_u32 s30, 400000
  s_cbranch_scc1 cA_va2_ld
  s_branch cA_abort
cA_va2_last:
  s_waitcnt lgkmcnt(0)
  buffer_store_dwordx4 v[100:103], v2, s[8:11], s24 offen offset:0 sc1
  buffer_store_dwordx4 v[104:107], v2, s[8:11], s24 offen offset:1024 sc1
  buffer_store_dwordx4 v[108:111], v2, s[8:11], s24 offen offset:2048 sc1
  buffer_store_dwordx4 v[4:7], v2, s[8:11], s24 offen offset:3072 sc1
  s_add_u32 s24, s24, 8192
  s_waitcnt vmcnt(0)
  s_mov_b64 exec, 1
  buffer_store_dword v117, v2, s[8:11], s34 offen sc1
  s_mov_b64 exec, -1
  s_add_u32 s34, s34, 8
  s_mov_b64 exec, 1
  buffer_store_dword v117, v2, s[8:11], s34 offen sc1
  s_mov_b64 exec, -1
  s_add_u32 s34, s34, 8
  s_branch cA_done
cA_va3_loop:
  s_add_u32 s23, s20, 4096
  s_add_u32 s21, s20, 25600
  v_mov_b32 v36, 0
  v_mov_b32 v37, 0
  v_mov_b32 v38, 0
  v_mov_b32 v39, 0
  v_mov_b32 v40, 0
  v_mov_b32 v41, 0
  v_mov_b32 v42, 0
  v_mov_b32 v43, 0
  v_mov_b32 v44, 0
  v_mov_b32 v45, 0
  v_mov_b32 v46, 0
  v_mov_b32 v47, 0
  v_mov_b32 v48, 0
  v_mov_b32 v49, 0
  v_mov_b32 v50, 0
  v_mov_b32 v51, 0
  v_mov_b32 v52, 0
  v_mov_b32 v53, 0
  v_mov_b32 v54, 0
  v_mov_b32 v55, 0
  v_mov_b32 v56, 0
  v_mov_b32 v57, 0
  v_mov_b32 v58, 0
  v_mov_b32 v59, 0
  v_mov_b32 v60, 0
  v_mov_b32 v61, 0
  v_mov_b32 v62, 0
  v_mov_b32 v63, 0
  v_mov_b32 v64, 0
  v_mov_b32 v65, 0
  v_mov_b32 v66, 0
  v_mov_b32 v67, 0
  s_mov_b32 s30, 0
  buffer_load_dword v76, v119, s[8:11], s20 offen sc1
  buffer_load_dword v77, v119, s[8:11], s20 offen sc1
  buffer_load_dword v78, v119, s[8:11], s20 offen sc1
cA_va3_fp_l:
  s_waitcnt vmcnt(2)
  v_cmp_eq_u32 vcc, -1, v76
  s_cbranch_vccz cA_va3_fp_d
  buffer_load_dword v76, v119, s[8:11], s20 offen sc1
  s_waitcnt vmcnt(2)
  v_cmp_eq_u32 vcc, -1, v77
  s_cbranch_vccz cA_va3_fp_d
  buffer_load_dword v77, v119, s[8:11], s20 offen sc1
  s_waitcnt vmcnt(2)
  v_cmp_eq_u32 vcc, -1, v78
  s_cbranch_vccz cA_va3_fp_d
  buffer_load_dword v78, v119, s[8:11], s20 offen sc1
  s_add_u32 s30, s30, 1
  s_cmp_lt_u32 s30, 400000
  s_cbranch_scc1 cA_va3_fp_l
  s_branch cA_abort
cA_va3_fp_d:
  buffer_load_dwordx4 v[24:27], v2, s[8:11], s23 offen offset:0 sc1
  buffer_load_dwordx4 v[28:31], v2, s[8:11], s23 offen offset:1024 sc1
  buffer_load_dwordx4 v[32:35], v2, s[8:11], s23 offen offset:2048 sc1
  s_barrier
cA_va3_ld:
  s_waitcnt vmcnt(0)
  v_max3_u32 v84, v24, v25, v26
  v_max3_u32 v84, v84, v27, v28
  v_max3_u32 v84, v84, v29, v30
  v_max3_u32 v84, v84, v31, v32
  v_max3_u32 v84, v84, v33, v34
  v_max_u32 v84, v84, v35
  v_cmp_eq_u32 vcc, -1, v84
  ds_write_b128 v2, v[24:27] offset:12288
  ds_write_b128 v2, v[28:31] offset:13312
  ds_write_b128 v2, v[32:35] offset:14336
  s_cbranch_vccnz cA_va3_retry
  s_waitcnt lgkmcnt(0)
  s_barrier
  ds_read_b128 v[8:11], v2 offset:8192
  ds_read_b128 v[12:15], v2 offset:9216
  ds_read_b128 v[16:19], v2 offset:10240
  ds_read_b128 v[20:23], v2 offset:11264
  s_waitcnt lgkmcnt(0)
  s_cmp_eq_u32 s19, 63
  s_cbranch_scc1 cA_done
  ds_read_b128 v[76:79], v1 offset:0
  ds_read_b128 v[80:83], v1 offset:1024
  ds_read_b128 v[84:87], v1 offset:2048
  ds_read_b128 v[88:91], v1 offset:3072
  ds_read_b128 v[92:95], v1 offset:4096
  ds_read_b128 v[96:99], v1 offset:5120
  v_smfmac_f32_16x16x64_bf16 v[60:63], v[8:11], v[200:207], v3
  v_smfmac_f32_16x16x64_bf16 v[60:63], v[12:15], v[208:215], v3
  s_waitcnt lgkmcnt(4)
  v_smfmac_f32_16x16x64_bf16 v[64:67], v[8:11], v[76:83], v3
  ds_read_b128 v[76:79], v1 offset:6144
  ds_read_b128 v[80:83], v1 offset:7168
  v_smfmac_f32_16x16x64_bf16 v[60:63], v[16:19], v[216:223], v3
  v_smfmac_f32_16x16x64_bf16 v[60:63], v[20:23], v[224:231], v3
  s_waitcnt lgkmcnt(4)
  v_smfmac_f32_16x16x64_bf16 v[64:67], v[12:15], v[84:91], v3
  ds_read_b128 v[84:87], v1 offset:8192
  ds_read_b128 v[88:91], v1 offset:9216
  v_smfmac_f32_16x16x64_bf16 v[60:63], v[24:27], v[232:239], v3
  v_smfmac_f32_16x16x64_bf16 v[60:63], v[28:31], v[240:247], v3
  s_waitcnt lgkmcnt(4)
  v_smfmac_f32_16x16x64_bf16 v[64:67], v[16:19], v[92:99], v3
  ds_read_b128 v[92:95], v1 offset:10240
  ds_read_b128 v[96:99], v1 offset:11264
  v_smfmac_f32_16x16x64_bf16 v[60:63], v[32:35], v[248:255], v3
  v_smfmac_f32_16x16x64_bf16 v[36:39], v[8:11], a[0:7], v3
  s_waitcnt lgkmcnt(4)
  v_smfmac_f32_16x16x64_bf16 v[64:67], v[20:23], v[76:83], v3
  ds_read_b128 v[76:79], v1 offset:12288
  ds_read_b128 v[80:83], v1 offset:13312
  v_smfmac_f32_16x16x64_bf16 v[36:39], v[12:15], a[8:15], v3
  v_smfmac_f32_16x16x64_bf16 v[36:39], v[16:19], a[16:23], v3
  s_waitcnt lgkmcnt(4)
  v_smfmac_f32_16x16x64_bf16 v[64:67], v[24:27], v[84:91], v3
  v_smfmac_f32_16x16x64_bf16 v[36:39], v[20:23], a[24:31], v3
  v_smfmac_f32_16x16x64_bf16 v[36:39], v[24:27], a[32:39], v3
  s_waitcnt lgkmcnt(2)
  v_smfmac_f32_16x16x64_bf16 v[64:67], v[28:31], v[92:99], v3
  v_smfmac_f32_16x16x64_bf16 v[36:39], v[28:31], a[40:47], v3
  v_smfmac_f32_16x16x64_bf16 v[36:39], v[32:35], a[48:55], v3
  s_waitcnt lgkmcnt(0)
  v_smfmac_f32_16x16x64_bf16 v[64:67], v[32:35], v[76:83], v3
  v_smfmac_f32_16x16x64_bf16 v[40:43], v[8:11], a[56:63], v3
  v_smfmac_f32_16x16x64_bf16 v[40:43], v[12:15], a[64:71], v3
  v_smfmac_f32_16x16x64_bf16 v[40:43], v[16:19], a[72:79], v3
  v_smfmac_f32_16x16x64_bf16 v[40:43], v[20:23], a[80:87], v3
  v_permlane32_swap_b32 v60, v64
  v_smfmac_f32_16x16x64_bf16 v[40:43], v[24:27], a[88:95], v3
  v_permlane32_swap_b32 v61, v65
  v_smfmac_f32_16x16x64_bf16 v[40:43], v[28:31], a[96:103], v3
  v_permlane32_swap_b32 v62, v66
  v_smfmac_f32_16x16x64_bf16 v[40:43], v[32:35], a[104:111], v3
  v_permlane32_swap_b32 v63, v67
  v_smfmac_f32_16x16x64_bf16 v[44:47], v[8:11], a[112:119], v3
  v_smfmac_f32_16x16x64_bf16 v[44:47], v[12:15], a[120:127], v3
  v_smfmac_f32_16x16x64_bf16 v[44:47], v[16:19], a[128:135], v3
  v_smfmac_f32_16x16x64_bf16 v[44:47], v[20:23], a[136:143], v3
  v_add_f32 v60, v60, v64
  v_add_f32 v61, v61, v65
  v_smfmac_f32_16x16x64_bf16 v[44:47], v[24:27], a[144:151], v3
  v_add_f32 v62, v62, v66
  v_add_f32 v63, v63, v67
  v_smfmac_f32_16x16x64_bf16 v[44:47], v[28:31], a[152:159], v3
  v_cvt_pk_bf16_f32 v64, v60, v61
  v_cvt_pk_bf16_f32 v65, v62, v63
  v_smfmac_f32_16x16x64_bf16 v[44:47], v[32:35], a[160:167], v3
  ds_write_b64 v115, v[64:65]
  v_smfmac_f32_16x16x64_bf16 v[48:51], v[8:11], a[168:175], v3
  v_permlane32_swap_b32 v36, v40
  v_smfmac_f32_16x16x64_bf16 v[48:51], v[12:15], a[176:183], v3
  v_permlane32_swap_b32 v37, v41
  v_smfmac_f32_16x16x64_bf16 v[48:51], v[16:19], a[184:191], v3
  v_permlane32_swap_b32 v38, v42
  v_smfmac_f32_16x16x64_bf16 v[48:51], v[20:23], a[192:199], v3
  v_permlane32_swap_b32 v39, v43
  v_smfmac_f32_16x16x64_bf16 v[48:51], v[24:27], a[200:207], v3
  v_add_f32 v36, v36, v40
  v_smfmac_f32_16x16x64_bf16 v[48:51], v[28:31], a[208:215], v3
  v_add_f32 v37, v37, v41
  v_smfmac_f32_16x16x64_bf16 v[48:51], v[32:35], a[216:223], v3
  v_add_f32 v38, v38, v42
  v_smfmac_f32_16x16x64_bf16 v[52:55], v[8:11], a[224:231], v3
  v_smfmac_f32_16x16x64_bf16 v[52:55], v[12:15], a[232:239], v3
  v_smfmac_f32_16x16x64_bf16 v[52:55], v[16:19], a[240:247], v3
  v_smfmac_f32_16x16x64_bf16 v[52:55], v[20:23], a[248:255], v3
  v_add_f32 v39, v39, v43
  v_cvt_pk_bf16_f32 v40, v36, v37
  v_smfmac_f32_16x16x64_bf16 v[52:55], v[24:27], v[120:127], v3
  v_cvt_pk_bf16_f32 v41, v38, v39
  v_smfmac_f32_16x16x64_bf16 v[52:55], v[28:31], v[128:135], v3
  ds_write_b64 v112, v[40:41]
  v_smfmac_f32_16x16x64_bf16 v[52:55], v[32:35], v[136:143], v3
  v_permlane32_swap_b32 v44, v48
  v_smfmac_f32_16x16x64_bf16 v[56:59], v[8:11], v[144:151], v3
  v_permlane32_swap_b32 v45, v49
  v_smfmac_f32_16x16x64_bf16 v[56:59], v[12:15], v[152:159], v3
  v_permlane32_swap_b32 v46, v50
  v_smfmac_f32_16x16x64_bf16 v[56:59], v[16:19], v[160:167], v3
  v_permlane32_swap_b32 v47, v51
  v_smfmac_f32_16x16x64_bf16 v[56:59], v[20:23], v[168:175], v3
  v_add_f32 v44, v44, v48
  v_smfmac_f32_16x16x64_bf16 v[56:59], v[24:27], v[176:183], v3
  v_add_f32 v45, v45, v49
  v_smfmac_f32_16x16x64_bf16 v[56:59], v[28:31], v[184:191], v3
  v_add_f32 v46, v46, v50
  v_smfmac_f32_16x16x64_bf16 v[56:59], v[32:35], v[192:199], v3
  v_add_f32 v47, v47, v51
  v_cvt_pk_bf16_f32 v48, v44, v45
  v_cvt_pk_bf16_f32 v49, v46, v47
  ds_write_b64 v113, v[48:49]
  s_nop 3
  v_permlane32_swap_b32 v52, v56
  v_permlane32_swap_b32 v53, v57
  v_permlane32_swap_b32 v54, v58
  v_permlane32_swap_b32 v55, v59
  v_add_f32 v52, v52, v56
  v_add_f32 v53, v53, v57
  v_add_f32 v54, v54, v58
  v_add_f32 v55, v55, v59
  v_cvt_pk_bf16_f32 v56, v52, v53
  v_cvt_pk_bf16_f32 v57, v54, v55
  ds_write_b64 v114, v[56:57]
  s_waitcnt lgkmcnt(0)
  s_barrier
  s_cmp_eq_u32 s19, 62
  s_cbranch_scc1 cA_done
  s_waitcnt vmcnt(0) lgkmcnt(0)
  s_add_u32 s19, s19, 1
  s_mov_b32 s20, s21
  s_branch cA_va3_loop
cA_va3_retry:
  s_waitcnt lgkmcnt(0)
  buffer_load_dwordx4 v[24:27], v2, s[8:11], s23 offen offset:0 sc1
  buffer_load_dwordx4 v[28:31], v2, s[8:11], s23 offen offset:1024 sc1
  buffer_load_dwordx4 v[32:35], v2, s[8:11], s23 offen offset:2048 sc1
  s_add_u32 s31, s31, 1
  s_add_u32 s30, s30, 1
  s_cmp_lt_u32 s30, 400000
  s_cbranch_scc1 cA_va3_ld
  s_branch cA_abort
cA_va3_last:
  s_waitcnt lgkmcnt(0)
  buffer_store_dwordx4 v[100:103], v2, s[8:11], s24 offen offset:0 sc1
  buffer_store_dwordx4 v[104:107], v2, s[8:11], s24 offen offset:1024 sc1
  buffer_store_dwordx4 v[108:111], v2, s[8:11], s24 offen offset:2048 sc1
  buffer_store_dwordx4 v[4:7], v2, s[8:11], s24 offen offset:3072 sc1
  s_add_u32 s24, s24, 8192
  s_waitcnt vmcnt(0)
  s_mov_b64 exec, 1
  buffer_store_dword v117, v2, s[8:11], s34 offen sc1
  s_mov_b64 exec, -1
  s_add_u32 s34, s34, 8
  s_mov_b64 exec, 1
  buffer_store_dword v117, v2, s[8:11], s34 offen sc1
  s_mov_b64 exec, -1
  s_add_u32 s34, s34, 8
  s_branch cA_done
cA_abort:
  v_mov_b32 v4, 0xdead
  v_mov_b32 v5, 16
  buffer_store_dword v4, v5, s[12:15], 0 offen
  s_branch ch_end
cA_done:
  s_branch ch_end
cB_sc0_loop:
  s_add_u32 s23, s20, 4096
  s_add_u32 s21, s20, 25600
  v_mov_b32 v48, 0
  v_mov_b32 v49, 0
  v_mov_b32 v50, 0
  v_mov_b32 v51, 0
  v_mov_b32 v52, 0
  v_mov_b32 v53, 0
  v_mov_b32 v54, 0
  v_mov_b32 v55, 0
  v_mov_b32 v56, 0
  v_mov_b32 v57, 0
  v_mov_b32 v58, 0
  v_mov_b32 v59, 0
  v_mov_b32 v60, 0
  v_mov_b32 v61, 0
  v_mov_b32 v62, 0
  v_mov_b32 v63, 0
  v_mov_b32 v88, 0
  v_mov_b32 v89, 0
  v_mov_b32 v90, 0
  v_mov_b32 v91, 0
  v_mov_b32 v92, 0
  v_mov_b32 v93, 0
  v_mov_b32 v94, 0
  v_mov_b32 v95, 0
  v_mov_b32 v66, 0
  v_mov_b32 v67, 0
  s_mov_b32 s30, 0
  s_mov_b32 s62, 0
  buffer_load_dword v68, v0, s[8:11], s20 offen sc1
  s_nop 7
  buffer_load_dword v69, v0, s[8:11], s20 offen sc1
  s_nop 7
  buffer_load_dword v70, v0, s[8:11], s20 offen sc1
  s_nop 7
  buffer_load_dword v71, v0, s[8:11], s20 offen sc1
  s_nop 7
  buffer_load_dword v72, v0, s[8:11], s20 offen sc1
cB_sc0_fp_l:
  s_waitcnt vmcnt(4)
  v_cmp_eq_u32 vcc, -1, v68
  s_cbranch_vccz cB_sc0_fp_d
  buffer_load_dword v68, v0, s[8:11], s20 offen sc1
  s_waitcnt vmcnt(4)
  v_cmp_eq_u32 vcc, -1, v69
  s_cbranch_vccz cB_sc0_fp_d
  buffer_load_dword v69, v0, s[8:11], s20 offen sc1
  s_waitcnt vmcnt(4)
  v_cmp_eq_u32 vcc, -1, v70
  s_cbranch_vccz cB_sc0_fp_d
  buffer_load_dword v70, v0, s[8:11], s20 offen sc1
  s_waitcnt vmcnt(4)
  v_cmp_eq_u32 vcc, -1, v71
  s_cbranch_vccz cB_sc0_fp_d
  buffer_load_dword v71, v0, s[8:11], s20 offen sc1
  s_waitcnt vmcnt(4)
  v_cmp_eq_u32 vcc, -1, v72
  s_cbranch_vccz cB_sc0_fp_d
  buffer_load_dword v72, v0, s[8:11], s20 offen sc1
  s_add_u32 s30, s30, 1
  s_cmp_lt_u32 s30, 400000
  s_cbranch_scc1 cB_sc0_fp_l
  s_branch cB_abort
cB_sc0_fp_d:
  buffer_load_dwordx4 v[8:11], v2, s[8:11], s20 offen offset:0 sc1
  s_barrier
  s_branch cB_sc0_ld1
cB_sc0_ld:
  buffer_load_dwordx4 v[8:11], v2, s[8:11], s20 offen offset:0 sc1
cB_sc0_ld1:
  v_mov_b32 v36, 0
  v_mov_b32 v37, 0
  v_mov_b32 v38, 0
  v_mov_b32 v39, 0
  buffer_load_dwordx4 v[12:15], v2, s[8:11], s20 offen offset:1024 sc1
  v_mov_b32 v40, 0
  v_mov_b32 v41, 0
  v_mov_b32 v42, 0
  v_mov_b32 v43, 0
  buffer_load_dwordx4 v[16:19], v2, s[8:11], s20 offen offset:2048 sc1
  v_mov_b32 v44, 0
  v_mov_b32 v45, 0
  v_mov_b32 v46, 0
  v_mov_b32 v47, 0
  ds_read_b128 v[96:99], v116 offset:12288
  ds_read_b128 v[100:103], v116 offset:13312
  ds_read_b128 v[104:107], v116 offset:26624
  ds_read_b128 v[108:111], v116 offset:27648
  s_waitcnt vmcnt(2)
  v_smfmac_f32_16x16x64_bf16 v[36:39], v[8:11], a[0:7], v3
  v_smfmac_f32_16x16x64_bf16 v[40:43], v[8:11], a[56:63], v3
  buffer_load_dwordx4 v[20:23], v2, s[8:11], s20 offen offset:3072 sc1
  v_smfmac_f32_16x16x64_bf16 v[44:47], v[8:11], a[112:119], v3
  v_smfmac_f32_16x16x64_bf16 v[48:51], v[8:11], a[168:175], v3
  v_smfmac_f32_16x16x64_bf16 v[52:55], v[8:11], a[224:231], v3
  buffer_load_dwordx4 v[24:27], v2, s[8:11], s23 offen offset:0 sc1
  v_smfmac_f32_16x16x64_bf16 v[56:59], v[8:11], v[144:151], v3
  v_smfmac_f32_16x16x64_bf16 v[60:63], v[8:11], v[200:207], v3
  s_waitcnt vmcnt(3)
  v_smfmac_f32_16x16x64_bf16 v[36:39], v[12:15], a[8:15], v3
  v_smfmac_f32_16x16x64_bf16 v[40:43], v[12:15], a[64:71], v3
  buffer_load_dwordx4 v[28:31], v2, s[8:11], s23 offen offset:1024 sc1
  v_smfmac_f32_16x16x64_bf16 v[44:47], v[12:15], a[120:127], v3
  v_smfmac_f32_16x16x64_bf16 v[48:51], v[12:15], a[176:183], v3
  v_smfmac_f32_16x16x64_bf16 v[52:55], v[12:15], a[232:239], v3
  buffer_load_dwordx4 v[32:35], v2, s[8:11], s23 offen offset:2048 sc1
  v_smfmac_f32_16x16x64_bf16 v[56:59], v[12:15], v[152:159], v3
  v_smfmac_f32_16x16x64_bf16 v[60:63], v[12:15], v[208:215], v3
  s_waitcnt vmcnt(4)
  v_smfmac_f32_16x16x64_bf16 v[36:39], v[16:19], a[16:23], v3
  v_smfmac_f32_16x16x64_bf16 v[40:43], v[16:19], a[72:79], v3
  v_smfmac_f32_16x16x64_bf16 v[44:47], v[16:19], a[128:135], v3
  v_smfmac_f32_16x16x64_bf16 v[48:51], v[16:19], a[184:191], v3
  v_smfmac_f32_16x16x64_bf16 v[52:55], v[16:19], a[240:247], v3
  v_smfmac_f32_16x16x64_bf16 v[56:59], v[16:19], v[160:167], v3
  v_smfmac_f32_16x16x64_bf16 v[60:63], v[16:19], v[216:223], v3
  s_waitcnt vmcnt(3)
  v_smfmac_f32_16x16x64_bf16 v[36:39], v[20:23], a[24:31], v3
  v_smfmac_f32_16x16x64_bf16 v[40:43], v[20:23], a[80:87], v3
  v_smfmac_f32_16x16x64_bf16 v[44:47], v[20:23], a[136:143], v3
  v_smfmac_f32_16x16x64_bf16 v[48:51], v[20:23], a[192:199], v3
  v_smfmac_f32_16x16x64_bf16 v[52:55], v[20:23], a[248:255], v3
  v_smfmac_f32_16x16x64_bf16 v[56:59], v[20:23], v[168:175], v3
  v_smfmac_f32_16x16x64_bf16 v[60:63], v[20:23], v[224:231], v3
  s_waitcnt vmcnt(0)
cB_sc0_ph2:
  v_smfmac_f32_16x16x64_bf16 v[60:63], v[24:27], v[232:239], v3
  ds_read_b128 v[12:15], v116 offset:8192
  ds_read_b128 v[16:19], v116 offset:9216
  v_smfmac_f32_16x16x64_bf16 v[60:63], v[28:31], v[240:247], v3
  v_smfmac_f32_16x16x64_bf16 v[60:63], v[32:35], v[248:255], v3
  v_smfmac_f32_16x16x64_bf16 v[52:55], v[24:27], v[120:127], v3
  v_smfmac_f32_16x16x64_bf16 v[52:55], v[28:31], v[128:135], v3
  v_smfmac_f32_16x16x64_bf16 v[52:55], v[32:35], v[136:143], v3
  v_cvt_pk_bf16_f32 v64, v60, v61
  v_smfmac_f32_16x16x64_bf16 v[56:59], v[24:27], v[176:183], v3
  v_cvt_pk_bf16_f32 v65, v62, v63
  v_smfmac_f32_16x16x64_bf16 v[56:59], v[28:31], v[184:191], v3
  v_mfma_f32_16x16x32_bf16 v[68:71], v[64:67], v[4:7], 0
  v_smfmac_f32_16x16x64_bf16 v[56:59], v[32:35], v[192:199], v3
  v_cvt_pk_bf16_f32 v64, v52, v53
  v_smfmac_f32_16x16x64_bf16 v[36:39], v[24:27], a[32:39], v3
  v_cvt_pk_bf16_f32 v65, v54, v55
  v_smfmac_f32_16x16x64_bf16 v[36:39], v[28:31], a[40:47], v3
  v_cvt_pk_bf16_f32 v76, v68, v69
  v_smfmac_f32_16x16x64_bf16 v[36:39], v[32:35], a[48:55], v3
  v_cvt_pk_bf16_f32 v77, v70, v71
  v_cvt_pk_bf16_f32 v66, v56, v57
  v_smfmac_f32_16x16x64_bf16 v[40:43], v[24:27], a[88:95], v3
  v_cvt_pk_bf16_f32 v67, v58, v59
  v_smfmac_f32_16x16x64_bf16 v[40:43], v[28:31], a[96:103], v3
  v_mfma_f32_16x16x32_bf16 v[72:75], v[64:67], v[4:7], 0
  ds_read_b128 v[52:55], v116 offset:22528
  ds_read_b128 v[56:59], v116 offset:23552
  v_smfmac_f32_16x16x64_bf16 v[40:43], v[32:35], a[104:111], v3
  v_cvt_pk_bf16_f32 v64, v36, v37
  v_smfmac_f32_16x16x64_bf16 v[44:47], v[24:27], a[144:151], v3
  v_cvt_pk_bf16_f32 v65, v38, v39
  v_smfmac_f32_16x16x64_bf16 v[44:47], v[28:31], a[152:159], v3
  v_cvt_pk_bf16_f32 v80, v72, v73
  v_smfmac_f32_16x16x64_bf16 v[44:47], v[32:35], a[160:167], v3
  v_cvt_pk_bf16_f32 v81, v74, v75
  v_cvt_pk_bf16_f32 v66, v40, v41
  v_smfmac_f32_16x16x64_bf16 v[48:51], v[24:27], a[200:207], v3
  v_cvt_pk_bf16_f32 v67, v42, v43
  v_smfmac_f32_16x16x64_bf16 v[48:51], v[28:31], a[208:215], v3
  v_mfma_f32_16x16x32_bf16 v[68:71], v[64:67], v[4:7], 0
  ds_read_b128 v[36:39], v116 offset:0
  ds_read_b128 v[40:43], v116 offset:1024
  v_smfmac_f32_16x16x64_bf16 v[48:51], v[32:35], a[216:223], v3
  s_waitcnt lgkmcnt(4)
  v_cvt_pk_bf16_f32 v64, v44, v45
  v_mfma_f32_16x16x32_bf16 v[84:87], v[32:35], v[76:79], 0
  v_cvt_pk_bf16_f32 v65, v46, v47
  v_smfmac_f32_16x16x64_bf16 v[88:91], v[76:79], v[96:103], v3
  ds_read_b128 v[96:99], v116 offset:14336
  ds_read_b128 v[100:103], v116 offset:15360
  v_smfmac_f32_16x16x64_bf16 v[92:95], v[76:79], v[104:111], v3
  v_cvt_pk_bf16_f32 v66, v48, v49
  v_cvt_pk_bf16_f32 v67, v50, v51
  v_mfma_f32_16x16x32_bf16 v[84:87], v[24:27], v[80:83], v[84:87]
  v_cvt_pk_bf16_f32 v60, v68, v69
  v_mfma_f32_16x16x32_bf16 v[72:75], v[64:67], v[4:7], 0
  v_cvt_pk_bf16_f32 v61, v70, v71
  s_waitcnt lgkmcnt(4)
  v_smfmac_f32_16x16x64_bf16 v[88:91], v[80:83], v[12:19], v3
  v_smfmac_f32_16x16x64_bf16 v[92:95], v[80:83], v[52:59], v3
  s_waitcnt lgkmcnt(0)
  s_nop 0
  v_cvt_pk_bf16_f32 v62, v72, v73
  v_cvt_pk_bf16_f32 v63, v74, v75
  s_nop 1
  v_mfma_f32_16x16x32_bf16 v[84:87], v[8:11], v[60:63], v[84:87]
  v_smfmac_f32_16x16x64_bf16 v[88:91], v[60:63], v[36:43], v3
  v_smfmac_f32_16x16x64_bf16 v[92:95], v[60:63], v[96:103], v3
  s_mov_b64 exec, s[26:27]
  s_nop 0
  ds_write_b128 v113, v[84:87]
  s_mov_b64 exec, -1
  s_nop 0
  v_cmp_u_f32 vcc, v88, v89
  s_nop 1
  v_permlane32_swap_b32 v88, v92
  v_permlane32_swap_b32 v89, v93
  v_permlane32_swap_b32 v90, v94
  v_permlane32_swap_b32 v91, v95
  v_add_f32 v88, v88, v92
  v_add_f32 v89, v89, v93
  v_add_f32 v90, v90, v94
  v_add_f32 v91, v91, v95
  ds_write_b128 v112, v[88:91]
  s_cbranch_vccnz cB_sc0_retry
cB_sc0_cont:
  s_waitcnt lgkmcnt(0)
  s_barrier
  ds_read_b64 v[36:37], v114 offset:0
  ds_read_b64 v[38:39], v114 offset:1024
  ds_read2_b32 v[44:45], v115 offset0:0 offset1:64
  s_waitcnt lgkmcnt(0)
  v_add_f32 v44, v44, v45
  v_add_f32 v36, v36, v38
  v_add_f32 v37, v37, v39
  v_add_f32_dpp v44, v44, v44 row_ror:8 row_mask:0xf bank_mask:0xf
  v_mov_b32 v45, v44
  v_permlane32_swap_b32 v36, v37
  v_add_f32 v36, v36, v37
  v_permlane16_swap_b32 v44, v45
  v_add_f32 v44, v44, v45
  v_max_f32 v38, v36, v44
  s_nop 1
  v_max_f32_dpp v38, v38, v38 quad_perm:[1,0,3,2] row_mask:0xf bank_mask:0xf
  s_nop 1
  v_max_f32_dpp v38, v38, v38 quad_perm:[2,3,0,1] row_mask:0xf bank_mask:0xf
  s_nop 1
  v_max_f32_dpp v38, v38, v38 row_half_mirror row_mask:0xf bank_mask:0xf
  s_nop 1
  v_max_f32_dpp v38, v38, v38 row_mirror row_mask:0xf bank_mask:0xf
  v_mov_b32 v39, v38
  s_nop 1
  v_permlane16_swap_b32 v38, v39
  v_max_f32 v38, v38, v39
  v_sub_f32 v36, v36, v38
  v_sub_f32 v44, v44, v38
  v_exp_f32 v36, v36
  v_exp_f32 v44, v44
  s_nop 0
  v_fma_f32 v39, v44, s37, v36
  v_cndmask_b32 v40, v44, v36, s[38:39]
  v_cndmask_b32 v41, v36, v44, s[38:39]
  v_add_f32_dpp v39, v39, v39 quad_perm:[1,0,3,2] row_mask:0xf bank_mask:0xf
  s_nop 0
  v_mov_b32_dpp v46, v41 quad_perm:[1,0,3,2] row_mask:0xf bank_mask:0xf
  v_add_f32_dpp v39, v39, v39 quad_perm:[2,3,0,1] row_mask:0xf bank_mask:0xf
  v_cndmask_b32 v42, v46, v40, s[38:39]
  v_cndmask_b32 v43, v40, v46, s[38:39]
  v_add_f32_dpp v39, v39, v39 row_half_mirror row_mask:0xf bank_mask:0xf
  s_nop 1
  v_add_f32_dpp v39, v39, v39 row_mirror row_mask:0xf bank_mask:0xf
  v_mov_b32 v47, v39
  s_nop 1
  v_permlane16_swap_b32 v39, v47
  v_add_f32 v39, v39, v47
  v_rcp_f32 v39, v39
  s_nop 0
  v_mul_f32 v42, v42, v39
  v_mul_f32 v43, v43, v39
  v_cvt_pk_bf16_f32 v42, v42, v43
  v_min_u32 v42, -2, v42
  s_mov_b64 exec, s[28:29]
  buffer_store_dword v42, v1, s[8:11], s20 offen sc1
  s_mov_b64 exec, -1
  s_barrier
  s_add_u32 s24, s24, 28672
  s_add_u32 s35, s35, 28672
  s_xor_b32 s25, s25, 28672
  s_add_u32 m0, s25, 0
  s_nop 0
  buffer_load_dwordx4 v2, s[8:11], s24 offen offset:0 lds
  buffer_load_dwordx4 v2, s[8:11], s24 offen offset:1024 lds
  buffer_load_dwordx4 v2, s[8:11], s24 offen offset:2048 lds
  buffer_load_dwordx4 v2, s[8:11], s24 offen offset:3072 lds
  s_add_u32 m0, s25, 4096
  s_add_u32 s22, s24, 4096
  buffer_load_dwordx4 v2, s[8:11], s22 offen offset:0 lds
  buffer_load_dwordx4 v2, s[8:11], s22 offen offset:1024 lds
  buffer_load_dwordx4 v2, s[8:11], s22 offen offset:2048 lds
  v_xor_b32 v116, 28672, v116
  s_add_u32 s19, s19, 1
  s_mov_b32 s20, s21
  s_cmp_lt_u32 s19, 63
  s_cbranch_scc1 cB_sc0_loop
  s_branch cB_done
cB_sc0_retry:
  s_cmp_lg_u32 s62, 0
  s_cbranch_scc1 cB_sc0_cont
  s_waitcnt vmcnt(0) lgkmcnt(0)
cB_sc0_rv:
  buffer_load_dwordx4 v[8:11], v2, s[8:11], s20 offen offset:0 sc1
  buffer_load_dwordx4 v[12:15], v2, s[8:11], s20 offen offset:1024 sc1
  buffer_load_dwordx4 v[16:19], v2, s[8:11], s20 offen offset:2048 sc1
  buffer_load_dwordx4 v[20:23], v2, s[8:11], s20 offen offset:3072 sc1
  buffer_load_dwordx4 v[24:27], v2, s[8:11], s23 offen offset:0 sc1
  buffer_load_dwordx4 v[28:31], v2, s[8:11], s23 offen offset:1024 sc1
  buffer_load_dwordx4 v[32:35], v2, s[8:11], s23 offen offset:2048 sc1
  s_waitcnt vmcnt(0)
  v_max3_u32 v118, v8, v9, v10
  v_max3_u32 v118, v118, v11, v12
  v_max3_u32 v118, v118, v13, v14
  v_max3_u32 v118, v118, v15, v16
  v_max3_u32 v118, v118, v17, v18
  v_max3_u32 v118, v118, v19, v20
  v_max3_u32 v118, v118, v21, v22
  v_max3_u32 v118, v118, v23, v24
  v_max3_u32 v118, v118, v25, v26
  v_max3_u32 v118, v118, v27, v28
  v_max3_u32 v118, v118, v29, v30
  v_max3_u32 v118, v118, v31, v32
  v_max3_u32 v118, v118, v33, v34
  v_max_u32 v118, v118, v35
  v_cmp_eq_u32 vcc, -1, v118
  s_cbranch_vccz cB_sc0_rk
  s_add_u32 s30, s30, 1
  s_cmp_lt_u32 s30, 400000
  s_cbranch_scc1 cB_sc0_rv
  s_branch cB_abort
cB_sc0_rk:
  s_mov_b32 s62, 1
  v_mov_b32 v36, 0
  v_mov_b32 v37, 0
  v_mov_b32 v38, 0
  v_mov_b32 v39, 0
  v_mov_b32 v40, 0
  v_mov_b32 v41, 0
  v_mov_b32 v42, 0
  v_mov_b32 v43, 0
  v_mov_b32 v44, 0
  v_mov_b32 v45, 0
  v_mov_b32 v46, 0
  v_mov_b32 v47, 0
  v_mov_b32 v48, 0
  v_mov_b32 v49, 0
  v_mov_b32 v50, 0
  v_mov_b32 v51, 0
  v_mov_b32 v52, 0
  v_mov_b32 v53, 0
  v_mov_b32 v54, 0
  v_mov_b32 v55, 0
  v_mov_b32 v56, 0
  v_mov_b32 v57, 0
  v_mov_b32 v58, 0
  v_mov_b32 v59, 0
  v_mov_b32 v60, 0
  v_mov_b32 v61, 0
  v_mov_b32 v62, 0
  v_mov_b32 v63, 0
  v_mov_b32 v88, 0
  v_mov_b32 v89, 0
  v_mov_b32 v90, 0
  v_mov_b32 v91, 0
  v_mov_b32 v92, 0
  v_mov_b32 v93, 0
  v_mov_b32 v94, 0
  v_mov_b32 v95, 0
  v_mov_b32 v66, 0
  v_mov_b32 v67, 0
  s_add_u32 s31, s31, 1
  ds_read_b128 v[96:99], v116 offset:12288
  ds_read_b128 v[100:103], v116 offset:13312
  ds_read_b128 v[104:107], v116 offset:26624
  ds_read_b128 v[108:111], v116 offset:27648
  v_smfmac_f32_16x16x64_bf16 v[36:39], v[8:11], a[0:7], v3
  v_smfmac_f32_16x16x64_bf16 v[40:43], v[8:11], a[56:63], v3
  v_smfmac_f32_16x16x64_bf16 v[44:47], v[8:11], a[112:119], v3
  v_smfmac_f32_16x16x64_bf16 v[48:51], v[8:11], a[168:175], v3
  v_smfmac_f32_16x16x64_bf16 v[52:55], v[8:11], a[224:231], v3
  v_smfmac_f32_16x16x64_bf16 v[56:59], v[8:11], v[144:151], v3
  v_smfmac_f32_16x16x64_bf16 v[60:63], v[8:11], v[200:207], v3
  v_smfmac_f32_16x16x64_bf16 v[36:39], v[12:15], a[8:15], v3
  v_smfmac_f32_16x16x64_bf16 v[40:43], v[12:15], a[64:71], v3
  v_smfmac_f32_16x16x64_bf16 v[44:47], v[12:15], a[120:127], v3
  v_smfmac_f32_16x16x64_bf16 v[48:51], v[12:15], a[176:183], v3
  v_smfmac_f32_16x16x64_bf16 v[52:55], v[12:15], a[232:239], v3
  v_smfmac_f32_16x16x64_bf16 v[56:59], v[12:15], v[152:159], v3
  v_smfmac_f32_16x16x64_bf16 v[60:63], v[12:15], v[208:215], v3
  v_smfmac_f32_16x16x64_bf16 v[36:39], v[16:19], a[16:23], v3
  v_smfmac_f32_16x16x64_bf16 v[40:43], v[16:19], a[72:79], v3
  v_smfmac_f32_16x16x64_bf16 v[44:47], v[16:19], a[128:135], v3
  v_smfmac_f32_16x16x64_bf16 v[48:51], v[16:19], a[184:191], v3
  v_smfmac_f32_16x16x64_bf16 v[52:55], v[16:19], a[240:247], v3
  v_smfmac_f32_16x16x64_bf16 v[56:59], v[16:19], v[160:167], v3
  v_smfmac_f32_16x16x64_bf16 v[60:63], v[16:19], v[216:223], v3
  v_smfmac_f32_16x16x64_bf16 v[36:39], v[20:23], a[24:31], v3
  v_smfmac_f32_16x16x64_bf16 v[40:43], v[20:23], a[80:87], v3
  v_smfmac_f32_16x16x64_bf16 v[44:47], v[20:23], a[136:143], v3
  v_smfmac_f32_16x16x64_bf16 v[48:51], v[20:23], a[192:199], v3
  v_smfmac_f32_16x16x64_bf16 v[52:55], v[20:23], a[248:255], v3
  v_smfmac_f32_16x16x64_bf16 v[56:59], v[20:23], v[168:175], v3
  v_smfmac_f32_16x16x64_bf16 v[60:63], v[20:23], v[224:231], v3
  s_branch cB_sc0_ph2
cB_sc1_loop:
  s_add_u32 s23, s20, 4096
  s_add_u32 s21, s20, 25600
  v_mov_b32 v48, 0
  v_mov_b32 v49, 0
  v_mov_b32 v50, 0
  v_mov_b32 v51, 0
  v_mov_b32 v52, 0
  v_mov_b32 v53, 0
  v_mov_b32 v54, 0
  v_mov_b32 v55, 0
  v_mov_b32 v56, 0
  v_mov_b32 v57, 0
  v_mov_b32 v58, 0
  v_mov_b32 v59, 0
  v_mov_b32 v60, 0
  v_mov_b32 v61, 0
  v_mov_b32 v62, 0
  v_mov_b32 v63, 0
  v_mov_b32 v88, 0
  v_mov_b32 v89, 0
  v_mov_b32 v90, 0
  v_mov_b32 v91, 0
  v_mov_b32 v92, 0
  v_mov_b32 v93, 0
  v_mov_b32 v94, 0
  v_mov_b32 v95, 0
  v_mov_b32 v64, 0
  v_mov_b32 v65, 0
  s_mov_b32 s30, 0
  s_mov_b32 s62, 0
  s_waitcnt vmcnt(0)
  s_barrier
cB_sc1_ld:
  buffer_load_dwordx4 v[8:11], v2, s[8:11], s20 offen offset:0 sc1
  v_mov_b32 v36, 0
  v_mov_b32 v37, 0
  v_mov_b32 v38, 0
  v_mov_b32 v39, 0
  buffer_load_dwordx4 v[12:15], v2, s[8:11], s20 offen offset:1024 sc1
  v_mov_b32 v40, 0
  v_mov_b32 v41, 0
  v_mov_b32 v42, 0
  v_mov_b32 v43, 0
  buffer_load_dwordx4 v[16:19], v2, s[8:11], s20 offen offset:2048 sc1
  v_mov_b32 v44, 0
  v_mov_b32 v45, 0
  v_mov_b32 v46, 0
  v_mov_b32 v47, 0
  ds_read_b128 v[96:99], v116 offset:12288
  ds_read_b128 v[100:103], v116 offset:13312
  ds_read_b128 v[104:107], v116 offset:26624
  ds_read_b128 v[108:111], v116 offset:27648
  s_waitcnt vmcnt(2)
  v_smfmac_f32_16x16x64_bf16 v[36:39], v[8:11], a[0:7], v3
  v_smfmac_f32_16x16x64_bf16 v[40:43], v[8:11], a[56:63], v3
  buffer_load_dwordx4 v[20:23], v2, s[8:11], s20 offen offset:3072 sc1
  v_smfmac_f32_16x16x64_bf16 v[44:47], v[8:11], a[112:119], v3
  v_smfmac_f32_16x16x64_bf16 v[48:51], v[8:11], a[168:175], v3
  v_smfmac_f32_16x16x64_bf16 v[52:55], v[8:11], a[224:231], v3
  buffer_load_dwordx4 v[24:27], v2, s[8:11], s23 offen offset:0 sc1
  v_smfmac_f32_16x16x64_bf16 v[56:59], v[8:11], v[144:151], v3
  v_smfmac_f32_16x16x64_bf16 v[60:63], v[8:11], v[200:207], v3
  s_waitcnt vmcnt(3)
  v_smfmac_f32_16x16x64_bf16 v[36:39], v[12:15], a[8:15], v3
  v_smfmac_f32_16x16x64_bf16 v[40:43], v[12:15], a[64:71], v3
  buffer_load_dwordx4 v[28:31], v2, s[8:11], s23 offen offset:1024 sc1
  v_smfmac_f32_16x16x64_bf16 v[44:47], v[12:15], a[120:127], v3
  v_smfmac_f32_16x16x64_bf16 v[48:51], v[12:15], a[176:183], v3
  v_smfmac_f32_16x16x64_bf16 v[52:55], v[12:15], a[232:239], v3
  buffer_load_dwordx4 v[32:35], v2, s[8:11], s23 offen offset:2048 sc1
  v_smfmac_f32_16x16x64_bf16 v[56:59], v[12:15], v[152:159], v3
  v_smfmac_f32_16x16x64_bf16 v[60:63], v[12:15], v[208:215], v3
  s_waitcnt vmcnt(4)
  v_smfmac_f32_16x16x64_bf16 v[36:39], v[16:19], a[16:23], v3
  v_smfmac_f32_16x16x64_bf16 v[40:43], v[16:19], a[72:79], v3
  v_smfmac_f32_16x16x64_bf16 v[44:47], v[16:19], a[128:135], v3
  v_smfmac_f32_16x16x64_bf16 v[48:51], v[16:19], a[184:191], v3
  v_smfmac_f32_16x16x64_bf16 v[52:55], v[16:19], a[240:247], v3
  v_smfmac_f32_16x16x64_bf16 v[56:59], v[16:19], v[160:167], v3
  v_smfmac_f32_16x16x64_bf16 v[60:63], v[16:19], v[216:223], v3
  s_waitcnt vmcnt(3)
  v_smfmac_f32_16x16x64_bf16 v[36:39], v[20:23], a[24:31], v3
  v_smfmac_f32_16x16x64_bf16 v[40:43], v[20:23], a[80:87], v3
  v_smfmac_f32_16x16x64_bf16 v[44:47], v[20:23], a[136:143], v3
  v_smfmac_f32_16x16x64_bf16 v[48:51], v[20:23], a[192:199], v3
  v_smfmac_f32_16x16x64_bf16 v[52:55], v[20:23], a[248:255], v3
  v_smfmac_f32_16x16x64_bf16 v[56:59], v[20:23], v[168:175], v3
  v_smfmac_f32_16x16x64_bf16 v[60:63], v[20:23], v[224:231], v3
  s_waitcnt vmcnt(0)
cB_sc1_ph2:
  v_smfmac_f32_16x16x64_bf16 v[60:63], v[24:27], v[232:239], v3
  ds_read_b128 v[16:19], v116 offset:8192
  ds_read_b128 v[20:23], v116 offset:9216
  v_smfmac_f32_16x16x64_bf16 v[60:63], v[28:31], v[240:247], v3
  buffer_load_dword v119, v0, s[8:11], s20 offen sc1
  v_smfmac_f32_16x16x64_bf16 v[60:63], v[32:35], v[248:255], v3
  v_smfmac_f32_16x16x64_bf16 v[52:55], v[24:27], v[120:127], v3
  v_smfmac_f32_16x16x64_bf16 v[52:55], v[28:31], v[128:135], v3
  v_smfmac_f32_16x16x64_bf16 v[52:55], v[32:35], v[136:143], v3
  v_cvt_pk_bf16_f32 v66, v60, v61
  v_smfmac_f32_16x16x64_bf16 v[56:59], v[24:27], v[176:183], v3
  v_cvt_pk_bf16_f32 v67, v62, v63
  v_smfmac_f32_16x16x64_bf16 v[56:59], v[28:31], v[184:191], v3
  v_mfma_f32_16x16x32_bf16 v[68:71], v[64:67], v[4:7], 0
  v_smfmac_f32_16x16x64_bf16 v[56:59], v[32:35], v[192:199], v3
  v_cvt_pk_bf16_f32 v64, v52, v53
  v_smfmac_f32_16x16x64_bf16 v[36:39], v[24:27], a[32:39], v3
  v_cvt_pk_bf16_f32 v65, v54, v55
  v_smfmac_f32_16x16x64_bf16 v[36:39], v[28:31], a[40:47], v3
  v_cvt_pk_bf16_f32 v76, v68, v69
  v_smfmac_f32_16x16x64_bf16 v[36:39], v[32:35], a[48:55], v3
  v_cvt_pk_bf16_f32 v77, v70, v71
  v_cvt_pk_bf16_f32 v66, v56, v57
  v_smfmac_f32_16x16x64_bf16 v[40:43], v[24:27], a[88:95], v3
  v_cvt_pk_bf16_f32 v67, v58, v59
  v_smfmac_f32_16x16x64_bf16 v[40:43], v[28:31], a[96:103], v3
  v_mfma_f32_16x16x32_bf16 v[72:75], v[64:67], v[4:7], 0
  ds_read_b128 v[52:55], v116 offset:22528
  ds_read_b128 v[56:59], v116 offset:23552
  v_smfmac_f32_16x16x64_bf16 v[40:43], v[32:35], a[104:111], v3
  v_cvt_pk_bf16_f32 v64, v36, v37
  v_smfmac_f32_16x16x64_bf16 v[44:47], v[24:27], a[144:151], v3
  v_cvt_pk_bf16_f32 v65, v38, v39
  v_smfmac_f32_16x16x64_bf16 v[44:47], v[28:31], a[152:159], v3
  v_cvt_pk_bf16_f32 v82, v72, v73
  v_smfmac_f32_16x16x64_bf16 v[44:47], v[32:35], a[160:167], v3
  v_cvt_pk_bf16_f32 v83, v74, v75
  v_cvt_pk_bf16_f32 v66, v40, v41
  v_smfmac_f32_16x16x64_bf16 v[48:51], v[24:27], a[200:207], v3
  v_cvt_pk_bf16_f32 v67, v42, v43
  v_smfmac_f32_16x16x64_bf16 v[48:51], v[28:31], a[208:215], v3
  v_mfma_f32_16x16x32_bf16 v[68:71], v[64:67], v[4:7], 0
  ds_read_b128 v[36:39], v116 offset:2048
  ds_read_b128 v[40:43], v116 offset:3072
  v_smfmac_f32_16x16x64_bf16 v[48:51], v[32:35], a[216:223], v3
  s_waitcnt lgkmcnt(4)
  v_cvt_pk_bf16_f32 v64, v44, v45
  v_mfma_f32_16x16x32_bf16 v[84:87], v[32:35], v[76:79], 0
  v_cvt_pk_bf16_f32 v65, v46, v47
  v_smfmac_f32_16x16x64_bf16 v[88:91], v[76:79], v[96:103], v3
  ds_read_b128 v[96:99], v116 offset:16384
  ds_read_b128 v[100:103], v116 offset:17408
  v_smfmac_f32_16x16x64_bf16 v[92:95], v[76:79], v[104:111], v3
  v_cvt_pk_bf16_f32 v66, v48, v49
  v_cvt_pk_bf16_f32 v67, v50, v51
  v_mfma_f32_16x16x32_bf16 v[84:87], v[24:27], v[80:83], v[84:87]
  v_cvt_pk_bf16_f32 v60, v68, v69
  v_mfma_f32_16x16x32_bf16 v[72:75], v[64:67], v[4:7], 0
  v_cvt_pk_bf16_f32 v61, v70, v71
  s_waitcnt lgkmcnt(4)
  v_smfmac_f32_16x16x64_bf16 v[88:91], v[80:83], v[16:23], v3
  v_smfmac_f32_16x16x64_bf16 v[92:95], v[80:83], v[52:59], v3
  s_waitcnt lgkmcnt(0)
  s_nop 0
  v_cvt_pk_bf16_f32 v62, v72, v73
  v_cvt_pk_bf16_f32 v63, v74, v75
  s_nop 1
  v_mfma_f32_16x16x32_bf16 v[84:87], v[12:15], v[60:63], v[84:87]
  v_smfmac_f32_16x16x64_bf16 v[88:91], v[60:63], v[36:43], v3
  v_smfmac_f32_16x16x64_bf16 v[92:95], v[60:63], v[96:103], v3
  s_mov_b64 exec, s[26:27]
  s_nop 0
  ds_write_b128 v113, v[84:87]
  s_mov_b64 exec, -1
  s_nop 0
  v_cmp_u_f32 vcc, v88, v89
  s_nop 1
  v_permlane32_swap_b32 v88, v92
  v_permlane32_swap_b32 v89, v93
  v_permlane32_swap_b32 v90, v94
  v_permlane32_swap_b32 v91, v95
  v_add_f32 v88, v88, v92
  v_add_f32 v89, v89, v93
  v_add_f32 v90, v90, v94
  v_add_f32 v91, v91, v95
  ds_write_b128 v112, v[88:91]
  s_cbranch_vccnz cB_sc1_retry
cB_sc1_cont:
  s_waitcnt lgkmcnt(0)
  s_barrier
  ds_read_b64 v[36:37], v114 offset:0
  ds_read_b64 v[38:39], v114 offset:1024
  ds_read2_b32 v[44:45], v115 offset0:0 offset1:64
  s_waitcnt lgkmcnt(0)
  v_add_f32 v44, v44, v45
  v_add_f32 v36, v36, v38
  v_add_f32 v37, v37, v39
  v_add_f32_dpp v44, v44, v44 row_ror:8 row_mask:0xf bank_mask:0xf
  v_mov_b32 v45, v44
  v_permlane32_swap_b32 v36, v37
  v_add_f32 v36, v36, v37
  v_permlane16_swap_b32 v44, v45
  v_add_f32 v44, v44, v45
  v_max_f32 v38, v36, v44
  s_nop 1
  v_max_f32_dpp v38, v38, v38 quad_perm:[1,0,3,2] row_mask:0xf bank_mask:0xf
  s_nop 1
  v_max_f32_dpp v38, v38, v38 quad_perm:[2,3,0,1] row_mask:0xf bank_mask:0xf
  s_nop 1
  v_max_f32_dpp v38, v38, v38 row_half_mirror row_mask:0xf bank_mask:0xf
  s_nop 1
  v_max_f32_dpp v38, v38, v38 row_mirror row_mask:0xf bank_mask:0xf
  v_mov_b32 v39, v38
  s_nop 1
  v_permlane16_swap_b32 v38, v39
  v_max_f32 v38, v38, v39
  v_sub_f32 v36, v36, v38
  v_sub_f32 v44, v44, v38
  v_exp_f32 v36, v36
  v_exp_f32 v44, v44
  s_nop 0
  v_fma_f32 v39, v44, s37, v36
  v_cndmask_b32 v40, v44, v36, s[38:39]
  v_cndmask_b32 v41, v36, v44, s[38:39]
  v_add_f32_dpp v39, v39, v39 quad_perm:[1,0,3,2] row_mask:0xf bank_mask:0xf
  s_nop 0
  v_mov_b32_dpp v46, v41 quad_perm:[1,0,3,2] row_mask:0xf bank_mask:0xf
  v_add_f32_dpp v39, v39, v39 quad_perm:[2,3,0,1] row_mask:0xf bank_mask:0xf
  v_cndmask_b32 v42, v46, v40, s[38:39]
  v_cndmask_b32 v43, v40, v46, s[38:39]
  v_add_f32_dpp v39, v39, v39 row_half_mirror row_mask:0xf bank_mask:0xf
  s_nop 1
  v_add_f32_dpp v39, v39, v39 row_mirror row_mask:0xf bank_mask:0xf
  v_mov_b32 v47, v39
  s_nop 1
  v_permlane16_swap_b32 v39, v47
  v_add_f32 v39, v39, v47
  v_rcp_f32 v39, v39
  s_nop 0
  v_mul_f32 v42, v42, v39
  v_mul_f32 v43, v43, v39
  v_cvt_pk_bf16_f32 v42, v42, v43
  v_min_u32 v42, -2, v42
  s_mov_b64 exec, s[28:29]
  buffer_store_dword v42, v1, s[8:11], s20 offen sc1
  s_mov_b64 exec, -1
  s_barrier
  s_add_u32 s24, s24, 28672
  s_add_u32 s35, s35, 28672
  s_xor_b32 s25, s25, 28672
  s_add_u32 m0, s25, 7168
  s_nop 0
  buffer_load_dwordx4 v2, s[8:11], s24 offen offset:0 lds
  buffer_load_dwordx4 v2, s[8:11], s24 offen offset:1024 lds
  buffer_load_dwordx4 v2, s[8:11], s24 offen offset:2048 lds
  buffer_load_dwordx4 v2, s[8:11], s24 offen offset:3072 lds
  s_add_u32 m0, s25, 11264
  s_add_u32 s22, s24, 4096
  buffer_load_dwordx4 v2, s[8:11], s22 offen offset:0 lds
  buffer_load_dwordx4 v2, s[8:11], s22 offen offset:1024 lds
  buffer_load_dwordx4 v2, s[8:11], s22 offen offset:2048 lds
  v_xor_b32 v116, 28672, v116
  s_add_u32 s19, s19, 1
  s_mov_b32 s20, s21
  s_cmp_lt_u32 s19, 63
  s_cbranch_scc1 cB_sc1_loop
  s_branch cB_done
cB_sc1_retry:
  s_cmp_lg_u32 s62, 0
  s_cbranch_scc1 cB_sc1_cont
  s_waitcnt vmcnt(0) lgkmcnt(0)
cB_sc1_rv:
  buffer_load_dwordx4 v[8:11], v2, s[8:11], s20 offen offset:0 sc1
  buffer_load_dwordx4 v[12:15], v2, s[8:11], s20 offen offset:1024 sc1
  buffer_load_dwordx4 v[16:19], v2, s[8:11], s20 offen offset:2048 sc1
  buffer_load_dwordx4 v[20:23], v2, s[8:11], s20 offen offset:3072 sc1
  buffer_load_dwordx4 v[24:27], v2, s[8:11], s23 offen offset:0 sc1
  buffer_load_dwordx4 v[28:31], v2, s[8:11], s23 offen offset:1024 sc1
  buffer_load_dwordx4 v[32:35], v2, s[8:11], s23 offen offset:2048 sc1
  s_waitcnt vmcnt(0)
  v_max3_u32 v118, v8, v9, v10
  v_max3_u32 v118, v118, v11, v12
  v_max3_u32 v118, v118, v13, v14
  v_max3_u32 v118, v118, v15, v16
  v_max3_u32 v118, v118, v17, v18
  v_max3_u32 v118, v118, v19, v20
  v_max3_u32 v118, v118, v21, v22
  v_max3_u32 v118, v118, v23, v24
  v_max3_u32 v118, v118, v25, v26
  v_max3_u32 v118, v118, v27, v28
  v_max3_u32 v118, v118, v29, v30
  v_max3_u32 v118, v118, v31, v32
  v_max3_u32 v118, v118, v33, v34
  v_max_u32 v118, v118, v35
  v_cmp_eq_u32 vcc, -1, v118
  s_cbranch_vccz cB_sc1_rk
  s_add_u32 s30, s30, 1
  s_cmp_lt_u32 s30, 400000
  s_cbranch_scc1 cB_sc1_rv
  s_branch cB_abort
cB_sc1_rk:
  s_mov_b32 s62, 1
  v_mov_b32 v36, 0
  v_mov_b32 v37, 0
  v_mov_b32 v38, 0
  v_mov_b32 v39, 0
  v_mov_b32 v40, 0
  v_mov_b32 v41, 0
  v_mov_b32 v42, 0
  v_mov_b32 v43, 0
  v_mov_b32 v44, 0
  v_mov_b32 v45, 0
  v_mov_b32 v46, 0
  v_mov_b32 v47, 0
  v_mov_b32 v48, 0
  v_mov_b32 v49, 0
  v_mov_b32 v50, 0
  v_mov_b32 v51, 0
  v_mov_b32 v52, 0
  v_mov_b32 v53, 0
  v_mov_b32 v54, 0
  v_mov_b32 v55, 0
  v_mov_b32 v56, 0
  v_mov_b32 v57, 0
  v_mov_b32 v58, 0
  v_mov_b32 v59, 0
  v_mov_b32 v60, 0
  v_mov_b32 v61, 0
  v_mov_b32 v62, 0
  v_mov_b32 v63, 0
  v_mov_b32 v88, 0
  v_mov_b32 v89, 0
  v_mov_b32 v90, 0
  v_mov_b32 v91, 0
  v_mov_b32 v92, 0
  v_mov_b32 v93, 0
  v_mov_b32 v94, 0
  v_mov_b32 v95, 0
  v_mov_b32 v64, 0
  v_mov_b32 v65, 0
  s_add_u32 s31, s31, 1
  ds_read_b128 v[96:99], v116 offset:12288
  ds_read_b128 v[100:103], v116 offset:13312
  ds_read_b128 v[104:107], v116 offset:26624
  ds_read_b128 v[108:111], v116 offset:27648
  v_smfmac_f32_16x16x64_bf16 v[36:39], v[8:11], a[0:7], v3
  v_smfmac_f32_16x16x64_bf16 v[40:43], v[8:11], a[56:63], v3
  v_smfmac_f32_16x16x64_bf16 v[44:47], v[8:11], a[112:119], v3
  v_smfmac_f32_16x16x64_bf16 v[48:51], v[8:11], a[168:175], v3
  v_smfmac_f32_16x16x64_bf16 v[52:55], v[8:11], a[224:231], v3
  v_smfmac_f32_16x16x64_bf16 v[56:59], v[8:11], v[144:151], v3
  v_smfmac_f32_16x16x64_bf16 v[60:63], v[8:11], v[200:207], v3
  v_smfmac_f32_16x16x64_bf16 v[36:39], v[12:15], a[8:15], v3
  v_smfmac_f32_16x16x64_bf16 v[40:43], v[12:15], a[64:71], v3
  v_smfmac_f32_16x16x64_bf16 v[44:47], v[12:15], a[120:127], v3
  v_smfmac_f32_16x16x64_bf16 v[48:51], v[12:15], a[176:183], v3
  v_smfmac_f32_16x16x64_bf16 v[52:55], v[12:15], a[232:239], v3
  v_smfmac_f32_16x16x64_bf16 v[56:59], v[12:15], v[152:159], v3
  v_smfmac_f32_16x16x64_bf16 v[60:63], v[12:15], v[208:215], v3
  v_smfmac_f32_16x16x64_bf16 v[36:39], v[16:19], a[16:23], v3
  v_smfmac_f32_16x16x64_bf16 v[40:43], v[16:19], a[72:79], v3
  v_smfmac_f32_16x16x64_bf16 v[44:47], v[16:19], a[128:135], v3
  v_smfmac_f32_16x16x64_bf16 v[48:51], v[16:19], a[184:191], v3
  v_smfmac_f32_16x16x64_bf16 v[52:55], v[16:19], a[240:247], v3
  v_smfmac_f32_16x16x64_bf16 v[56:59], v[16:19], v[160:167], v3
  v_smfmac_f32_16x16x64_bf16 v[60:63], v[16:19], v[216:223], v3
  v_smfmac_f32_16x16x64_bf16 v[36:39], v[20:23], a[24:31], v3
  v_smfmac_f32_16x16x64_bf16 v[40:43], v[20:23], a[80:87], v3
  v_smfmac_f32_16x16x64_bf16 v[44:47], v[20:23], a[136:143], v3
  v_smfmac_f32_16x16x64_bf16 v[48:51], v[20:23], a[192:199], v3
  v_smfmac_f32_16x16x64_bf16 v[52:55], v[20:23], a[248:255], v3
  v_smfmac_f32_16x16x64_bf16 v[56:59], v[20:23], v[168:175], v3
  v_smfmac_f32_16x16x64_bf16 v[60:63], v[20:23], v[224:231], v3
  s_branch cB_sc1_ph2
cB_sc2_loop:
  s_add_u32 s23, s20, 4096
  s_add_u32 s21, s20, 25600
  v_mov_b32 v48, 0
  v_mov_b32 v49, 0
  v_mov_b32 v50, 0
  v_mov_b32 v51, 0
  v_mov_b32 v52, 0
  v_mov_b32 v53, 0
  v_mov_b32 v54, 0
  v_mov_b32 v55, 0
  v_mov_b32 v56, 0
  v_mov_b32 v57, 0
  v_mov_b32 v58, 0
  v_mov_b32 v59, 0
  v_mov_b32 v60, 0
  v_mov_b32 v61, 0
  v_mov_b32 v62, 0
  v_mov_b32 v63, 0
  v_mov_b32 v88, 0
  v_mov_b32 v89, 0
  v_mov_b32 v90, 0
  v_mov_b32 v91, 0
  v_mov_b32 v92, 0
  v_mov_b32 v93, 0
  v_mov_b32 v94, 0
  v_mov_b32 v95, 0
  v_mov_b32 v66, 0
  v_mov_b32 v67, 0
  s_mov_b32 s30, 0
  s_mov_b32 s62, 0
  s_waitcnt vmcnt(0)
  s_barrier
cB_sc2_ld:
  buffer_load_dwordx4 v[8:11], v2, s[8:11], s20 offen offset:0 sc1
  v_mov_b32 v36, 0
  v_mov_b32 v37, 0
  v_mov_b32 v38, 0
  v_mov_b32 v39, 0
  buffer_load_dwordx4 v[12:15], v2, s[8:11], s20 offen offset:1024 sc1
  v_mov_b32 v40, 0
  v_mov_b32 v41, 0
  v_mov_b32 v42, 0
  v_mov_b32 v43, 0
  buffer_load_dwordx4 v[16:19], v2, s[8:11], s20 offen offset:2048 sc1
  v_mov_b32 v44, 0
  v_mov_b32 v45, 0
  v_mov_b32 v46, 0
  v_mov_b32 v47, 0
  ds_read_b128 v[96:99], v116 offset:12288
  ds_read_b128 v[100:103], v116 offset:13312
  ds_read_b128 v[104:107], v116 offset:26624
  ds_read_b128 v[108:111], v116 offset:27648
  s_waitcnt vmcnt(2)
  v_smfmac_f32_16x16x64_bf16 v[36:39], v[8:11], a[0:7], v3
  v_smfmac_f32_16x16x64_bf16 v[40:43], v[8:11], a[56:63], v3
  buffer_load_dwordx4 v[20:23], v2, s[8:11], s20 offen offset:3072 sc1
  v_smfmac_f32_16x16x64_bf16 v[44:47], v[8:11], a[112:119], v3
  v_smfmac_f32_16x16x64_bf16 v[48:51], v[8:11], a[168:175], v3
  v_smfmac_f32_16x16x64_bf16 v[52:55], v[8:11], a[224:231], v3
  buffer_load_dwordx4 v[24:27], v2, s[8:11], s23 offen offset:0 sc1
  v_smfmac_f32_16x16x64_bf16 v[56:59], v[8:11], v[144:151], v3
  v_smfmac_f32_16x16x64_bf16 v[60:63], v[8:11], v[200:207], v3
  s_waitcnt vmcnt(3)
  v_smfmac_f32_16x16x64_bf16 v[36:39], v[12:15], a[8:15], v3
  v_smfmac_f32_16x16x64_bf16 v[40:43], v[12:15], a[64:71], v3
  buffer_load_dwordx4 v[28:31], v2, s[8:11], s23 offen offset:1024 sc1
  v_smfmac_f32_16x16x64_bf16 v[44:47], v[12:15], a[120:127], v3
  v_smfmac_f32_16x16x64_bf16 v[48:51], v[12:15], a[176:183], v3
  v_smfmac_f32_16x16x64_bf16 v[52:55], v[12:15], a[232:239], v3
  buffer_load_dwordx4 v[32:35], v2, s[8:11], s23 offen offset:2048 sc1
  v_smfmac_f32_16x16x64_bf16 v[56:59], v[12:15], v[152:159], v3
  v_smfmac_f32_16x16x64_bf16 v[60:63], v[12:15], v[208:215], v3
  s_waitcnt vmcnt(4)
  v_smfmac_f32_16x16x64_bf16 v[36:39], v[16:19], a[16:23], v3
  v_smfmac_f32_16x16x64_bf16 v[40:43], v[16:19], a[72:79], v3
  v_smfmac_f32_16x16x64_bf16 v[44:47], v[16:19], a[128:135], v3
  v_smfmac_f32_16x16x64_bf16 v[48:51], v[16:19], a[184:191], v3
  v_smfmac_f32_16x16x64_bf16 v[52:55], v[16:19], a[240:247], v3
  v_smfmac_f32_16x16x64_bf16 v[56:59], v[16:19], v[160:167], v3
  v_smfmac_f32_16x16x64_bf16 v[60:63], v[16:19], v[216:223], v3
  s_waitcnt vmcnt(3)
  v_smfmac_f32_16x16x64_bf16 v[36:39], v[20:23], a[24:31], v3
  v_smfmac_f32_16x16x64_bf16 v[40:43], v[20:23], a[80:87], v3
  v_smfmac_f32_16x16x64_bf16 v[44:47], v[20:23], a[136:143], v3
  v_smfmac_f32_16x16x64_bf16 v[48:51], v[20:23], a[192:199], v3
  v_smfmac_f32_16x16x64_bf16 v[52:55], v[20:23], a[248:255], v3
  v_smfmac_f32_16x16x64_bf16 v[56:59], v[20:23], v[168:175], v3
  v_smfmac_f32_16x16x64_bf16 v[60:63], v[20:23], v[224:231], v3
  s_waitcnt vmcnt(0)
cB_sc2_ph2:
  v_smfmac_f32_16x16x64_bf16 v[60:63], v[24:27], v[232:239], v3
  ds_read_b128 v[8:11], v116 offset:10240
  ds_read_b128 v[12:15], v116 offset:11264
  v_smfmac_f32_16x16x64_bf16 v[60:63], v[28:31], v[240:247], v3
  buffer_load_dword v119, v0, s[8:11], s24 offen sc1
  v_smfmac_f32_16x16x64_bf16 v[60:63], v[32:35], v[248:255], v3
  v_smfmac_f32_16x16x64_bf16 v[52:55], v[24:27], v[120:127], v3
  v_smfmac_f32_16x16x64_bf16 v[52:55], v[28:31], v[128:135], v3
  v_smfmac_f32_16x16x64_bf16 v[52:55], v[32:35], v[136:143], v3
  v_cvt_pk_bf16_f32 v64, v60, v61
  v_smfmac_f32_16x16x64_bf16 v[56:59], v[24:27], v[176:183], v3
  v_cvt_pk_bf16_f32 v65, v62, v63
  v_smfmac_f32_16x16x64_bf16 v[56:59], v[28:31], v[184:191], v3
  v_mfma_f32_16x16x32_bf16 v[68:71], v[64:67], v[4:7], 0
  v_smfmac_f32_16x16x64_bf16 v[56:59], v[32:35], v[192:199], v3
  v_cvt_pk_bf16_f32 v64, v52, v53
  v_smfmac_f32_16x16x64_bf16 v[36:39], v[24:27], a[32:39], v3
  v_cvt_pk_bf16_f32 v65, v54, v55
  v_smfmac_f32_16x16x64_bf16 v[36:39], v[28:31], a[40:47], v3
  v_cvt_pk_bf16_f32 v78, v68, v69
  v_smfmac_f32_16x16x64_bf16 v[36:39], v[32:35], a[48:55], v3
  v_cvt_pk_bf16_f32 v79, v70, v71
  v_cvt_pk_bf16_f32 v66, v56, v57
  v_smfmac_f32_16x16x64_bf16 v[40:43], v[24:27], a[88:95], v3
  v_cvt_pk_bf16_f32 v67, v58, v59
  v_smfmac_f32_16x16x64_bf16 v[40:43], v[28:31], a[96:103], v3
  v_mfma_f32_16x16x32_bf16 v[72:75], v[64:67], v[4:7], 0
  ds_read_b128 v[52:55], v116 offset:24576
  ds_read_b128 v[56:59], v116 offset:25600
  v_smfmac_f32_16x16x64_bf16 v[40:43], v[32:35], a[104:111], v3
  v_cvt_pk_bf16_f32 v64, v36, v37
  v_smfmac_f32_16x16x64_bf16 v[44:47], v[24:27], a[144:151], v3
  v_cvt_pk_bf16_f32 v65, v38, v39
  v_smfmac_f32_16x16x64_bf16 v[44:47], v[28:31], a[152:159], v3
  v_cvt_pk_bf16_f32 v80, v72, v73
  v_smfmac_f32_16x16x64_bf16 v[44:47], v[32:35], a[160:167], v3
  v_cvt_pk_bf16_f32 v81, v74, v75
  v_cvt_pk_bf16_f32 v66, v40, v41
  v_smfmac_f32_16x16x64_bf16 v[48:51], v[24:27], a[200:207], v3
  v_cvt_pk_bf16_f32 v67, v42, v43
  v_smfmac_f32_16x16x64_bf16 v[48:51], v[28:31], a[208:215], v3
  v_mfma_f32_16x16x32_bf16 v[68:71], v[64:67], v[4:7], 0
  ds_read_b128 v[36:39], v116 offset:4096
  ds_read_b128 v[40:43], v116 offset:5120
  v_smfmac_f32_16x16x64_bf16 v[48:51], v[32:35], a[216:223], v3
  s_waitcnt lgkmcnt(4)
  v_cvt_pk_bf16_f32 v64, v44, v45
  v_mfma_f32_16x16x32_bf16 v[84:87], v[32:35], v[76:79], 0
  v_cvt_pk_bf16_f32 v65, v46, v47
  v_smfmac_f32_16x16x64_bf16 v[88:91], v[76:79], v[96:103], v3
  ds_read_b128 v[96:99], v116 offset:18432
  ds_read_b128 v[100:103], v116 offset:19456
  v_smfmac_f32_16x16x64_bf16 v[92:95], v[76:79], v[104:111], v3
  v_cvt_pk_bf16_f32 v66, v48, v49
  v_cvt_pk_bf16_f32 v67, v50, v51
  v_mfma_f32_16x16x32_bf16 v[84:87], v[28:31], v[80:83], v[84:87]
  v_cvt_pk_bf16_f32 v60, v68, v69
  v_mfma_f32_16x16x32_bf16 v[72:75], v[64:67], v[4:7], 0
  v_cvt_pk_bf16_f32 v61, v70, v71
  s_waitcnt lgkmcnt(4)
  v_smfmac_f32_16x16x64_bf16 v[88:91], v[80:83], v[8:15], v3
  v_smfmac_f32_16x16x64_bf16 v[92:95], v[80:83], v[52:59], v3
  s_waitcnt lgkmcnt(0)
  s_nop 0
  v_cvt_pk_bf16_f32 v62, v72, v73
  v_cvt_pk_bf16_f32 v63, v74, v75
  s_nop 1
  v_mfma_f32_16x16x32_bf16 v[84:87], v[16:19], v[60:63], v[84:87]
  v_smfmac_f32_16x16x64_bf16 v[88:91], v[60:63], v[36:43], v3
  v_smfmac_f32_16x16x64_bf16 v[92:95], v[60:63], v[96:103], v3
  s_mov_b64 exec, s[26:27]
  s_nop 0
  ds_write_b128 v113, v[84:87]
  s_mov_b64 exec, -1
  s_nop 0
  v_cmp_u_f32 vcc, v88, v89
  s_nop 1
  v_permlane32_swap_b32 v88, v92
  v_permlane32_swap_b32 v89, v93
  v_permlane32_swap_b32 v90, v94
  v_permlane32_swap_b32 v91, v95
  v_add_f32 v88, v88, v92
  v_add_f32 v89, v89, v93
  v_add_f32 v90, v90, v94
  v_add_f32 v91, v91, v95
  ds_write_b128 v112, v[88:91]
  s_cbranch_vccnz cB_sc2_retry
cB_sc2_cont:
  s_waitcnt lgkmcnt(0)
  s_barrier
  ds_read_b64 v[36:37], v114 offset:0
  ds_read_b64 v[38:39], v114 offset:1024
  ds_read2_b32 v[44:45], v115 offset0:0 offset1:64
  v_lshl_add_u32 v56, v2, 3, s36
  s_waitcnt lgkmcnt(0)
  v_add_f32 v44, v44, v45
  v_add_f32 v36, v36, v38
  v_add_f32 v37, v37, v39
  v_add_f32_dpp v44, v44, v44 row_ror:8 row_mask:0xf bank_mask:0xf
  v_mov_b32 v45, v44
  v_permlane32_swap_b32 v36, v37
  v_add_f32 v36, v36, v37
  v_permlane16_swap_b32 v44, v45
  v_add_f32 v44, v44, v45
  v_max_f32 v38, v36, v44
  s_mov_b64 exec, 65535
  buffer_store_dword v2, v56, s[8:11], s20 offen sc1
  s_mov_b64 exec, -1
  v_max_f32_dpp v38, v38, v38 quad_perm:[1,0,3,2] row_mask:0xf bank_mask:0xf
  s_nop 1
  v_max_f32_dpp v38, v38, v38 quad_perm:[2,3,0,1] row_mask:0xf bank_mask:0xf
  s_nop 1
  v_max_f32_dpp v38, v38, v38 row_half_mirror row_mask:0xf bank_mask:0xf
  s_nop 1
  v_max_f32_dpp v38, v38, v38 row_mirror row_mask:0xf bank_mask:0xf
  v_mov_b32 v39, v38
  s_nop 1
  v_permlane16_swap_b32 v38, v39
  v_max_f32 v38, v38, v39
  v_sub_f32 v36, v36, v38
  v_sub_f32 v44, v44, v38
  v_exp_f32 v36, v36
  v_exp_f32 v44, v44
  s_nop 0
  v_fma_f32 v39, v44, s37, v36
  v_cndmask_b32 v40, v44, v36, s[38:39]
  v_cndmask_b32 v41, v36, v44, s[38:39]
  v_add_f32_dpp v39, v39, v39 quad_perm:[1,0,3,2] row_mask:0xf bank_mask:0xf
  s_nop 0
  v_mov_b32_dpp v46, v41 quad_perm:[1,0,3,2] row_mask:0xf bank_mask:0xf
  v_add_f32_dpp v39, v39, v39 quad_perm:[2,3,0,1] row_mask:0xf bank_mask:0xf
  v_cndmask_b32 v42, v46, v40, s[38:39]
  v_cndmask_b32 v43, v40, v46, s[38:39]
  v_add_f32_dpp v39, v39, v39 row_half_mirror row_mask:0xf bank_mask:0xf
  s_nop 1
  v_add_f32_dpp v39, v39, v39 row_mirror row_mask:0xf bank_mask:0xf
  v_mov_b32 v47, v39
  s_nop 1
  v_permlane16_swap_b32 v39, v47
  v_add_f32 v39, v39, v47
  v_rcp_f32 v39, v39
  s_nop 0
  v_mul_f32 v42, v42, v39
  v_mul_f32 v43, v43, v39
  v_cvt_pk_bf16_f32 v42, v42, v43
  v_min_u32 v42, -2, v42
  s_mov_b64 exec, s[28:29]
  buffer_store_dword v42, v1, s[8:11], s20 offen sc1
  s_mov_b64 exec, -1
  s_barrier
  s_add_u32 s24, s24, 28672
  s_add_u32 s35, s35, 28672
  s_xor_b32 s25, s25, 28672
  s_add_u32 m0, s25, 14336
  s_nop 0
  buffer_load_dwordx4 v2, s[8:11], s24 offen offset:0 lds
  buffer_load_dwordx4 v2, s[8:11], s24 offen offset:1024 lds
  buffer_load_dwordx4 v2, s[8:11], s24 offen offset:2048 lds
  buffer_load_dwordx4 v2, s[8:11], s24 offen offset:3072 lds
  s_add_u32 m0, s25, 18432
  s_add_u32 s22, s24, 4096
  buffer_load_dwordx4 v2, s[8:11], s22 offen offset:0 lds
  buffer_load_dwordx4 v2, s[8:11], s22 offen offset:1024 lds
  buffer_load_dwordx4 v2, s[8:11], s22 offen offset:2048 lds
  v_xor_b32 v116, 28672, v116
  s_add_u32 s19, s19, 1
  s_mov_b32 s20, s21
  s_cmp_lt_u32 s19, 63
  s_cbranch_scc1 cB_sc2_loop
  s_branch cB_done
cB_sc2_retry:
  s_cmp_lg_u32 s62, 0
  s_cbranch_scc1 cB_sc2_cont
  s_waitcnt vmcnt(0) lgkmcnt(0)
cB_sc2_rv:
  buffer_load_dwordx4 v[8:11], v2, s[8:11], s20 offen offset:0 sc1
  buffer_load_dwordx4 v[12:15], v2, s[8:11], s20 offen offset:1024 sc1
  buffer_load_dwordx4 v[16:19], v2, s[8:11], s20 offen offset:2048 sc1
  buffer_load_dwordx4 v[20:23], v2, s[8:11], s20 offen offset:3072 sc1
  buffer_load_dwordx4 v[24:27], v2, s[8:11], s23 offen offset:0 sc1
  buffer_load_dwordx4 v[28:31], v2, s[8:11], s23 offen offset:1024 sc1
  buffer_load_dwordx4 v[32:35], v2, s[8:11], s23 offen offset:2048 sc1
  s_waitcnt vmcnt(0)
  v_max3_u32 v118, v8, v9, v10
  v_max3_u32 v118, v118, v11, v12
  v_max3_u32 v118, v118, v13, v14
  v_max3_u32 v118, v118, v15, v16
  v_max3_u32 v118, v118, v17, v18
  v_max3_u32 v118, v118, v19, v20
  v_max3_u32 v118, v118, v21, v22
  v_max3_u32 v118, v118, v23, v24
  v_max3_u32 v118, v118, v25, v26
  v_max3_u32 v118, v118, v27, v28
  v_max3_u32 v118, v118, v29, v30
  v_max3_u32 v118, v118, v31, v32
  v_max3_u32 v118, v118, v33, v34
  v_max_u32 v118, v118, v35
  v_cmp_eq_u32 vcc, -1, v118
  s_cbranch_vccz cB_sc2_rk
  s_add_u32 s30, s30, 1
  s_cmp_lt_u32 s30, 400000
  s_cbranch_scc1 cB_sc2_rv
  s_branch cB_abort
cB_sc2_rk:
  s_mov_b32 s62, 1
  v_mov_b32 v36, 0
  v_mov_b32 v37, 0
  v_mov_b32 v38, 0
  v_mov_b32 v39, 0
  v_mov_b32 v40, 0
  v_mov_b32 v41, 0
  v_mov_b32 v42, 0
  v_mov_b32 v43, 0
  v_mov_b32 v44, 0
  v_mov_b32 v45, 0
  v_mov_b32 v46, 0
  v_mov_b32 v47, 0
  v_mov_b32 v48, 0
  v_mov_b32 v49, 0
  v_mov_b32 v50, 0
  v_mov_b32 v51, 0
  v_mov_b32 v52, 0
  v_mov_b32 v53, 0
  v_mov_b32 v54, 0
  v_mov_b32 v55, 0
  v_mov_b32 v56, 0
  v_mov_b32 v57, 0
  v_mov_b32 v58, 0
  v_mov_b32 v59, 0
  v_mov_b32 v60, 0
  v_mov_b32 v61, 0
  v_mov_b32 v62, 0
  v_mov_b32 v63, 0
  v_mov_b32 v88, 0
  v_mov_b32 v89, 0
  v_mov_b32 v90, 0
  v_mov_b32 v91, 0
  v_mov_b32 v92, 0
  v_mov_b32 v93, 0
  v_mov_b32 v94, 0
  v_mov_b32 v95, 0
  v_mov_b32 v66, 0
  v_mov_b32 v67, 0
  s_add_u32 s31, s31, 1
  ds_read_b128 v[96:99], v116 offset:12288
  ds_read_b128 v[100:103], v116 offset:13312
  ds_read_b128 v[104:107], v116 offset:26624
  ds_read_b128 v[108:111], v116 offset:27648
  v_smfmac_f32_16x16x64_bf16 v[36:39], v[8:11], a[0:7], v3
  v_smfmac_f32_16x16x64_bf16 v[40:43], v[8:11], a[56:63], v3
  v_smfmac_f32_16x16x64_bf16 v[44:47], v[8:11], a[112:119], v3
  v_smfmac_f32_16x16x64_bf16 v[48:51], v[8:11], a[168:175], v3
  v_smfmac_f32_16x16x64_bf16 v[52:55], v[8:11], a[224:231], v3
  v_smfmac_f32_16x16x64_bf16 v[56:59], v[8:11], v[144:151], v3
  v_smfmac_f32_16x16x64_bf16 v[60:63], v[8:11], v[200:207], v3
  v_smfmac_f32_16x16x64_bf16 v[36:39], v[12:15], a[8:15], v3
  v_smfmac_f32_16x16x64_bf16 v[40:43], v[12:15], a[64:71], v3
  v_smfmac_f32_16x16x64_bf16 v[44:47], v[12:15], a[120:127], v3
  v_smfmac_f32_16x16x64_bf16 v[48:51], v[12:15], a[176:183], v3
  v_smfmac_f32_16x16x64_bf16 v[52:55], v[12:15], a[232:239], v3
  v_smfmac_f32_16x16x64_bf16 v[56:59], v[12:15], v[152:159], v3
  v_smfmac_f32_16x16x64_bf16 v[60:63], v[12:15], v[208:215], v3
  v_smfmac_f32_16x16x64_bf16 v[36:39], v[16:19], a[16:23], v3
  v_smfmac_f32_16x16x64_bf16 v[40:43], v[16:19], a[72:79], v3
  v_smfmac_f32_16x16x64_bf16 v[44:47], v[16:19], a[128:135], v3
  v_smfmac_f32_16x16x64_bf16 v[48:51], v[16:19], a[184:191], v3
  v_smfmac_f32_16x16x64_bf16 v[52:55], v[16:19], a[240:247], v3
  v_smfmac_f32_16x16x64_bf16 v[56:59], v[16:19], v[160:167], v3
  v_smfmac_f32_16x16x64_bf16 v[60:63], v[16:19], v[216:223], v3
  v_smfmac_f32_16x16x64_bf16 v[36:39], v[20:23], a[24:31], v3
  v_smfmac_f32_16x16x64_bf16 v[40:43], v[20:23], a[80:87], v3
  v_smfmac_f32_16x16x64_bf16 v[44:47], v[20:23], a[136:143], v3
  v_smfmac_f32_16x16x64_bf16 v[48:51], v[20:23], a[192:199], v3
  v_smfmac_f32_16x16x64_bf16 v[52:55], v[20:23], a[248:255], v3
  v_smfmac_f32_16x16x64_bf16 v[56:59], v[20:23], v[168:175], v3
  v_smfmac_f32_16x16x64_bf16 v[60:63], v[20:23], v[224:231], v3
  s_branch cB_sc2_ph2
cB_sc3_loop:
  s_add_u32 s23, s20, 4096
  s_add_u32 s21, s20, 25600
  v_mov_b32 v48, 0
  v_mov_b32 v49, 0
  v_mov_b32 v50, 0
  v_mov_b32 v51, 0
  v_mov_b32 v52, 0
  v_mov_b32 v53, 0
  v_mov_b32 v54, 0
  v_mov_b32 v55, 0
  v_mov_b32 v56, 0
  v_mov_b32 v57, 0
  v_mov_b32 v58, 0
  v_mov_b32 v59, 0
  v_mov_b32 v60, 0
  v_mov_b32 v61, 0
  v_mov_b32 v62, 0
  v_mov_b32 v63, 0
  v_mov_b32 v88, 0
  v_mov_b32 v89, 0
  v_mov_b32 v90, 0
  v_mov_b32 v91, 0
  v_mov_b32 v92, 0
  v_mov_b32 v93, 0
  v_mov_b32 v94, 0
  v_mov_b32 v95, 0
  v_mov_b32 v64, 0
  v_mov_b32 v65, 0
  s_mov_b32 s30, 0
  s_mov_b32 s62, 0
  s_waitcnt vmcnt(0)
  s_barrier
cB_sc3_ld:
  buffer_load_dwordx4 v[8:11], v2, s[8:11], s20 offen offset:0 sc1
  v_mov_b32 v36, 0
  v_mov_b32 v37, 0
  v_mov_b32 v38, 0
  v_mov_b32 v39, 0
  buffer_load_dwordx4 v[12:15], v2, s[8:11], s20 offen offset:1024 sc1
  v_mov_b32 v40, 0
  v_mov_b32 v41, 0
  v_mov_b32 v42, 0
  v_mov_b32 v43, 0
  buffer_load_dwordx4 v[16:19], v2, s[8:11], s20 offen offset:2048 sc1
  v_mov_b32 v44, 0
  v_mov_b32 v45, 0
  v_mov_b32 v46, 0
  v_mov_b32 v47, 0
  ds_read_b128 v[96:99], v116 offset:12288
  ds_read_b128 v[100:103], v116 offset:13312
  ds_read_b128 v[104:107], v116 offset:26624
  ds_read_b128 v[108:111], v116 offset:27648
  s_waitcnt vmcnt(2)
  v_smfmac_f32_16x16x64_bf16 v[36:39], v[8:11], a[0:7], v3
  v_smfmac_f32_16x16x64_bf16 v[40:43], v[8:11], a[56:63], v3
  buffer_load_dwordx4 v[20:23], v2, s[8:11], s20 offen offset:3072 sc1
  v_smfmac_f32_16x16x64_bf16 v[44:47], v[8:11], a[112:119], v3
  v_smfmac_f32_16x16x64_bf16 v[48:51], v[8:11], a[168:175], v3
  v_smfmac_f32_16x16x64_bf16 v[52:55], v[8:11], a[224:231], v3
  buffer_load_dwordx4 v[24:27], v2, s[8:11], s23 offen offset:0 sc1
  v_smfmac_f32_16x16x64_bf16 v[56:59], v[8:11], v[144:151], v3
  v_smfmac_f32_16x16x64_bf16 v[60:63], v[8:11], v[200:207], v3
  s_waitcnt vmcnt(3)
  v_smfmac_f32_16x16x64_bf16 v[36:39], v[12:15], a[8:15], v3
  v_smfmac_f32_16x16x64_bf16 v[40:43], v[12:15], a[64:71], v3
  buffer_load_dwordx4 v[28:31], v2, s[8:11], s23 offen offset:1024 sc1
  v_smfmac_f32_16x16x64_bf16 v[44:47], v[12:15], a[120:127], v3
  v_smfmac_f32_16x16x64_bf16 v[48:51], v[12:15], a[176:183], v3
  v_smfmac_f32_16x16x64_bf16 v[52:55], v[12:15], a[232:239], v3
  buffer_load_dwordx4 v[32:35], v2, s[8:11], s23 offen offset:2048 sc1
  v_smfmac_f32_16x16x64_bf16 v[56:59], v[12:15], v[152:159], v3
  v_smfmac_f32_16x16x64_bf16 v[60:63], v[12:15], v[208:215], v3
  s_waitcnt vmcnt(4)
  v_smfmac_f32_16x16x64_bf16 v[36:39], v[16:19], a[16:23], v3
  v_smfmac_f32_16x16x64_bf16 v[40:43], v[16:19], a[72:79], v3
  v_smfmac_f32_16x16x64_bf16 v[44:47], v[16:19], a[128:135], v3
  v_smfmac_f32_16x16x64_bf16 v[48:51], v[16:19], a[184:191], v3
  v_smfmac_f32_16x16x64_bf16 v[52:55], v[16:19], a[240:247], v3
  v_smfmac_f32_16x16x64_bf16 v[56:59], v[16:19], v[160:167], v3
  v_smfmac_f32_16x16x64_bf16 v[60:63], v[16:19], v[216:223], v3
  s_waitcnt vmcnt(3)
  v_smfmac_f32_16x16x64_bf16 v[36:39], v[20:23], a[24:31], v3
  v_smfmac_f32_16x16x64_bf16 v[40:43], v[20:23], a[80:87], v3
  v_smfmac_f32_16x16x64_bf16 v[44:47], v[20:23], a[136:143], v3
  v_smfmac_f32_16x16x64_bf16 v[48:51], v[20:23], a[192:199], v3
  v_smfmac_f32_16x16x64_bf16 v[52:55], v[20:23], a[248:255], v3
  v_smfmac_f32_16x16x64_bf16 v[56:59], v[20:23], v[168:175], v3
  v_smfmac_f32_16x16x64_bf16 v[60:63], v[20:23], v[224:231], v3
  s_waitcnt vmcnt(0)
cB_sc3_ph2:
  v_smfmac_f32_16x16x64_bf16 v[60:63], v[24:27], v[232:239], v3
  ds_read_b128 v[8:11], v116 offset:10240
  ds_read_b128 v[12:15], v116 offset:11264
  v_smfmac_f32_16x16x64_bf16 v[60:63], v[28:31], v[240:247], v3
  v_smfmac_f32_16x16x64_bf16 v[60:63], v[32:35], v[248:255], v3
  v_smfmac_f32_16x16x64_bf16 v[52:55], v[24:27], v[120:127], v3
  v_smfmac_f32_16x16x64_bf16 v[52:55], v[28:31], v[128:135], v3
  v_smfmac_f32_16x16x64_bf16 v[52:55], v[32:35], v[136:143], v3
  v_cvt_pk_bf16_f32 v66, v60, v61
  v_smfmac_f32_16x16x64_bf16 v[56:59], v[24:27], v[176:183], v3
  v_cvt_pk_bf16_f32 v67, v62, v63
  v_smfmac_f32_16x16x64_bf16 v[56:59], v[28:31], v[184:191], v3
  v_mfma_f32_16x16x32_bf16 v[68:71], v[64:67], v[4:7], 0
  v_smfmac_f32_16x16x64_bf16 v[56:59], v[32:35], v[192:199], v3
  v_cvt_pk_bf16_f32 v64, v52, v53
  v_smfmac_f32_16x16x64_bf16 v[36:39], v[24:27], a[32:39], v3
  v_cvt_pk_bf16_f32 v65, v54, v55
  v_smfmac_f32_16x16x64_bf16 v[36:39], v[28:31], a[40:47], v3
  v_cvt_pk_bf16_f32 v78, v68, v69
  v_smfmac_f32_16x16x64_bf16 v[36:39], v[32:35], a[48:55], v3
  v_cvt_pk_bf16_f32 v79, v70, v71
  v_cvt_pk_bf16_f32 v66, v56, v57
  v_smfmac_f32_16x16x64_bf16 v[40:43], v[24:27], a[88:95], v3
  v_cvt_pk_bf16_f32 v67, v58, v59
  v_smfmac_f32_16x16x64_bf16 v[40:43], v[28:31], a[96:103], v3
  v_mfma_f32_16x16x32_bf16 v[72:75], v[64:67], v[4:7], 0
  ds_read_b128 v[52:55], v116 offset:24576
  ds_read_b128 v[56:59], v116 offset:25600
  v_smfmac_f32_16x16x64_bf16 v[40:43], v[32:35], a[104:111], v3
  v_cvt_pk_bf16_f32 v64, v36, v37
  v_smfmac_f32_16x16x64_bf16 v[44:47], v[24:27], a[144:151], v3
  v_cvt_pk_bf16_f32 v65, v38, v39
  v_smfmac_f32_16x16x64_bf16 v[44:47], v[28:31], a[152:159], v3
  v_cvt_pk_bf16_f32 v82, v72, v73
  v_smfmac_f32_16x16x64_bf16 v[44:47], v[32:35], a[160:167], v3
  v_cvt_pk_bf16_f32 v83, v74, v75
  v_cvt_pk_bf16_f32 v66, v40, v41
  v_smfmac_f32_16x16x64_bf16 v[48:51], v[24:27], a[200:207], v3
  v_cvt_pk_bf16_f32 v67, v42, v43
  v_smfmac_f32_16x16x64_bf16 v[48:51], v[28:31], a[208:215], v3
  v_mfma_f32_16x16x32_bf16 v[68:71], v[64:67], v[4:7], 0
  ds_read_b128 v[36:39], v116 offset:6144
  ds_read_b128 v[40:43], v116 offset:7168
  v_smfmac_f32_16x16x64_bf16 v[48:51], v[32:35], a[216:223], v3
  s_waitcnt lgkmcnt(4)
  v_cvt_pk_bf16_f32 v64, v44, v45
  v_mfma_f32_16x16x32_bf16 v[84:87], v[32:35], v[76:79], 0
  v_cvt_pk_bf16_f32 v65, v46, v47
  v_smfmac_f32_16x16x64_bf16 v[88:91], v[76:79], v[96:103], v3
  ds_read_b128 v[96:99], v116 offset:20480
  ds_read_b128 v[100:103], v116 offset:21504
  v_smfmac_f32_16x16x64_bf16 v[92:95], v[76:79], v[104:111], v3
  v_cvt_pk_bf16_f32 v66, v48, v49
  v_cvt_pk_bf16_f32 v67, v50, v51
  v_mfma_f32_16x16x32_bf16 v[84:87], v[28:31], v[80:83], v[84:87]
  v_cvt_pk_bf16_f32 v60, v68, v69
  v_mfma_f32_16x16x32_bf16 v[72:75], v[64:67], v[4:7], 0
  v_cvt_pk_bf16_f32 v61, v70, v71
  s_waitcnt lgkmcnt(4)
  v_smfmac_f32_16x16x64_bf16 v[88:91], v[80:83], v[8:15], v3
  v_smfmac_f32_16x16x64_bf16 v[92:95], v[80:83], v[52:59], v3
  s_waitcnt lgkmcnt(0)
  s_nop 0
  v_cvt_pk_bf16_f32 v62, v72, v73
  v_cvt_pk_bf16_f32 v63, v74, v75
  s_nop 1
  v_mfma_f32_16x16x32_bf16 v[84:87], v[20:23], v[60:63], v[84:87]
  v_smfmac_f32_16x16x64_bf16 v[88:91], v[60:63], v[36:43], v3
  v_smfmac_f32_16x16x64_bf16 v[92:95], v[60:63], v[96:103], v3
  s_mov_b64 exec, s[26:27]
  s_nop 0
  ds_write_b128 v113, v[84:87]
  s_mov_b64 exec, -1
  s_nop 0
  v_cmp_u_f32 vcc, v88, v89
  s_nop 1
  v_permlane32_swap_b32 v88, v92
  v_permlane32_swap_b32 v89, v93
  v_permlane32_swap_b32 v90, v94
  v_permlane32_swap_b32 v91, v95
  v_add_f32 v88, v88, v92
  v_add_f32 v89, v89, v93
  v_add_f32 v90, v90, v94
  v_add_f32 v91, v91, v95
  ds_write_b128 v112, v[88:91]
  s_cbranch_vccnz cB_sc3_retry
cB_sc3_cont:
  s_waitcnt lgkmcnt(0)
  s_barrier
  ds_read_b64 v[36:37], v114 offset:0
  ds_read_b64 v[38:39], v114 offset:1024
  ds_read2_b32 v[44:45], v115 offset0:0 offset1:64
  s_waitcnt lgkmcnt(0)
  v_add_f32 v44, v44, v45
  v_add_f32 v36, v36, v38
  v_add_f32 v37, v37, v39
  v_add_f32_dpp v44, v44, v44 row_ror:8 row_mask:0xf bank_mask:0xf
  v_mov_b32 v45, v44
  v_permlane32_swap_b32 v36, v37
  v_add_f32 v36, v36, v37
  v_permlane16_swap_b32 v44, v45
  v_add_f32 v44, v44, v45
  v_max_f32 v38, v36, v44
  s_nop 1
  v_max_f32_dpp v38, v38, v38 quad_perm:[1,0,3,2] row_mask:0xf bank_mask:0xf
  s_nop 1
  v_max_f32_dpp v38, v38, v38 quad_perm:[2,3,0,1] row_mask:0xf bank_mask:0xf
  s_nop 1
  v_max_f32_dpp v38, v38, v38 row_half_mirror row_mask:0xf bank_mask:0xf
  s_nop 1
  v_max_f32_dpp v38, v38, v38 row_mirror row_mask:0xf bank_mask:0xf
  v_mov_b32 v39, v38
  s_nop 1
  v_permlane16_swap_b32 v38, v39
  v_max_f32 v38, v38, v39
  v_sub_f32 v36, v36, v38
  v_sub_f32 v44, v44, v38
  v_exp_f32 v36, v36
  v_exp_f32 v44, v44
  s_nop 0
  v_fma_f32 v39, v44, s37, v36
  v_cndmask_b32 v40, v44, v36, s[38:39]
  v_cndmask_b32 v41, v36, v44, s[38:39]
  v_add_f32_dpp v39, v39, v39 quad_perm:[1,0,3,2] row_mask:0xf bank_mask:0xf
  s_nop 0
  v_mov_b32_dpp v46, v41 quad_perm:[1,0,3,2] row_mask:0xf bank_mask:0xf
  v_add_f32_dpp v39, v39, v39 quad_perm:[2,3,0,1] row_mask:0xf bank_mask:0xf
  v_cndmask_b32 v42, v46, v40, s[38:39]
  v_cndmask_b32 v43, v40, v46, s[38:39]
  v_add_f32_dpp v39, v39, v39 row_half_mirror row_mask:0xf bank_mask:0xf
  s_nop 1
  v_add_f32_dpp v39, v39, v39 row_mirror row_mask:0xf bank_mask:0xf
  v_mov_b32 v47, v39
  s_nop 1
  v_permlane16_swap_b32 v39, v47
  v_add_f32 v39, v39, v47
  v_rcp_f32 v39, v39
  s_nop 0
  v_mul_f32 v42, v42, v39
  v_mul_f32 v43, v43, v39
  v_cvt_pk_bf16_f32 v42, v42, v43
  v_min_u32 v42, -2, v42
  s_mov_b64 exec, s[28:29]
  buffer_store_dword v42, v1, s[8:11], s20 offen sc1
  s_mov_b64 exec, -1
  s_barrier
  s_add_u32 s24, s24, 28672
  s_add_u32 s35, s35, 28672
  s_xor_b32 s25, s25, 28672
  s_add_u32 m0, s25, 21504
  s_nop 0
  buffer_load_dwordx4 v2, s[8:11], s24 offen offset:0 lds
  buffer_load_dwordx4 v2, s[8:11], s24 offen offset:1024 lds
  buffer_load_dwordx4 v2, s[8:11], s24 offen offset:2048 lds
  buffer_load_dwordx4 v2, s[8:11], s24 offen offset:3072 lds
  s_add_u32 m0, s25, 25600
  s_add_u32 s22, s24, 4096
  buffer_load_dwordx4 v2, s[8:11], s22 offen offset:0 lds
  buffer_load_dwordx4 v2, s[8:11], s22 offen offset:1024 lds
  buffer_load_dwordx4 v2, s[8:11], s22 offen offset:2048 lds
  v_xor_b32 v116, 28672, v116
  s_add_u32 s19, s19, 1
  s_mov_b32 s20, s21
  s_cmp_lt_u32 s19, 63
  s_cbranch_scc1 cB_sc3_loop
  s_branch cB_done
cB_sc3_retry:
  s_cmp_lg_u32 s62, 0
  s_cbranch_scc1 cB_sc3_cont
  s_waitcnt vmcnt(0) lgkmcnt(0)
cB_sc3_rv:
  buffer_load_dwordx4 v[8:11], v2, s[8:11], s20 offen offset:0 sc1
  buffer_load_dwordx4 v[12:15], v2, s[8:11], s20 offen offset:1024 sc1
  buffer_load_dwordx4 v[16:19], v2, s[8:11], s20 offen offset:2048 sc1
  buffer_load_dwordx4 v[20:23], v2, s[8:11], s20 offen offset:3072 sc1
  buffer_load_dwordx4 v[24:27], v2, s[8:11], s23 offen offset:0 sc1
  buffer_load_dwordx4 v[28:31], v2, s[8:11], s23 offen offset:1024 sc1
  buffer_load_dwordx4 v[32:35], v2, s[8:11], s23 offen offset:2048 sc1
  s_waitcnt vmcnt(0)
  v_max3_u32 v118, v8, v9, v10
  v_max3_u32 v118, v118, v11, v12
  v_max3_u32 v118, v118, v13, v14
  v_max3_u32 v118, v118, v15, v16
  v_max3_u32 v118, v118, v17, v18
  v_max3_u32 v118, v118, v19, v20
  v_max3_u32 v118, v118, v21, v22
  v_max3_u32 v118, v118, v23, v24
  v_max3_u32 v118, v118, v25, v26
  v_max3_u32 v118, v118, v27, v28
  v_max3_u32 v118, v118, v29, v30
  v_max3_u32 v118, v118, v31, v32
  v_max3_u32 v118, v118, v33, v34
  v_max_u32 v118, v118, v35
  v_cmp_eq_u32 vcc, -1, v118
  s_cbranch_vccz cB_sc3_rk
  s_add_u32 s30, s30, 1
  s_cmp_lt_u32 s30, 400000
  s_cbranch_scc1 cB_sc3_rv
  s_branch cB_abort
cB_sc3_rk:
  s_mov_b32 s62, 1
  v_mov_b32 v36, 0
  v_mov_b32 v37, 0
  v_mov_b32 v38, 0
  v_mov_b32 v39, 0
  v_mov_b32 v40, 0
  v_mov_b32 v41, 0
  v_mov_b32 v42, 0
  v_mov_b32 v43, 0
  v_mov_b32 v44, 0
  v_mov_b32 v45, 0
  v_mov_b32 v46, 0
  v_mov_b32 v47, 0
  v_mov_b32 v48, 0
  v_mov_b32 v49, 0
  v_mov_b32 v50, 0
  v_mov_b32 v51, 0
  v_mov_b32 v52, 0
  v_mov_b32 v53, 0
  v_mov_b32 v54, 0
  v_mov_b32 v55, 0
  v_mov_b32 v56, 0
  v_mov_b32 v57, 0
  v_mov_b32 v58, 0
  v_mov_b32 v59, 0
  v_mov_b32 v60, 0
  v_mov_b32 v61, 0
  v_mov_b32 v62, 0
  v_mov_b32 v63, 0
  v_mov_b32 v88, 0
  v_mov_b32 v89, 0
  v_mov_b32 v90, 0
  v_mov_b32 v91, 0
  v_mov_b32 v92, 0
  v_mov_b32 v93, 0
  v_mov_b32 v94, 0
  v_mov_b32 v95, 0
  v_mov_b32 v64, 0
  v_mov_b32 v65, 0
  s_add_u32 s31, s31, 1
  ds_read_b128 v[96:99], v116 offset:12288
  ds_read_b128 v[100:103], v116 offset:13312
  ds_read_b128 v[104:107], v116 offset:26624
  ds_read_b128 v[108:111], v116 offset:27648
  v_smfmac_f32_16x16x64_bf16 v[36:39], v[8:11], a[0:7], v3
  v_smfmac_f32_16x16x64_bf16 v[40:43], v[8:11], a[56:63], v3
  v_smfmac_f32_16x16x64_bf16 v[44:47], v[8:11], a[112:119], v3
  v_smfmac_f32_16x16x64_bf16 v[48:51], v[8:11], a[168:175], v3
  v_smfmac_f32_16x16x64_bf16 v[52:55], v[8:11], a[224:231], v3
  v_smfmac_f32_16x16x64_bf16 v[56:59], v[8:11], v[144:151], v3
  v_smfmac_f32_16x16x64_bf16 v[60:63], v[8:11], v[200:207], v3
  v_smfmac_f32_16x16x64_bf16 v[36:39], v[12:15], a[8:15], v3
  v_smfmac_f32_16x16x64_bf16 v[40:43], v[12:15], a[64:71], v3
  v_smfmac_f32_16x16x64_bf16 v[44:47], v[12:15], a[120:127], v3
  v_smfmac_f32_16x16x64_bf16 v[48:51], v[12:15], a[176:183], v3
  v_smfmac_f32_16x16x64_bf16 v[52:55], v[12:15], a[232:239], v3
  v_smfmac_f32_16x16x64_bf16 v[56:59], v[12:15], v[152:159], v3
  v_smfmac_f32_16x16x64_bf16 v[60:63], v[12:15], v[208:215], v3
  v_smfmac_f32_16x16x64_bf16 v[36:39], v[16:19], a[16:23], v3
  v_smfmac_f32_16x16x64_bf16 v[40:43], v[16:19], a[72:79], v3
  v_smfmac_f32_16x16x64_bf16 v[44:47], v[16:19], a[128:135], v3
  v_smfmac_f32_16x16x64_bf16 v[48:51], v[16:19], a[184:191], v3
  v_smfmac_f32_16x16x64_bf16 v[52:55], v[16:19], a[240:247], v3
  v_smfmac_f32_16x16x64_bf16 v[56:59], v[16:19], v[160:167], v3
  v_smfmac_f32_16x16x64_bf16 v[60:63], v[16:19], v[216:223], v3
  v_smfmac_f32_16x16x64_bf16 v[36:39], v[20:23], a[24:31], v3
  v_smfmac_f32_16x16x64_bf16 v[40:43], v[20:23], a[80:87], v3
  v_smfmac_f32_16x16x64_bf16 v[44:47], v[20:23], a[136:143], v3
  v_smfmac_f32_16x16x64_bf16 v[48:51], v[20:23], a[192:199], v3
  v_smfmac_f32_16x16x64_bf16 v[52:55], v[20:23], a[248:255], v3
  v_smfmac_f32_16x16x64_bf16 v[56:59], v[20:23], v[168:175], v3
  v_smfmac_f32_16x16x64_bf16 v[60:63], v[20:23], v[224:231], v3
  s_branch cB_sc3_ph2
cB_va0_loop:
  s_add_u32 s23, s20, 4096
  s_add_u32 s21, s20, 25600
  s_mov_b32 s30, 0
  s_and_b32 s22, s19, 7
  s_cmp_lg_u32 s22, 0
  s_cbranch_scc1 cB_va0_vok
  v_mov_b32 v164, 0
cB_va0_vow:
  buffer_load_dword v165, v164, s[8:11], s35 offen sc1
  s_waitcnt vmcnt(0)
  v_readfirstlane_b32 s22, v165
  s_cmp_eq_u32 s22, 56
  s_cbranch_scc1 cB_va0_vod
  s_sleep 2
  s_add_u32 s30, s30, 1
  s_cmp_lt_u32 s30, 400000
  s_cbranch_scc1 cB_va0_vow
  s_branch cB_abort
cB_va0_vod:
  s_add_u32 s35, s35, 64
cB_va0_vok:
  s_cmp_eq_u32 s19, 63
  s_cbranch_scc1 cB_done
  s_barrier
  s_add_u32 s22, s25, 0
  buffer_load_dwordx4 v[80:83], v6, s[8:11], s22 offen offset:0 sc1
  buffer_load_dwordx4 v[84:87], v6, s[8:11], s22 offen offset:1792 sc1
  s_add_u32 s22, s25, 3584
  buffer_load_dwordx4 v[88:91], v6, s[8:11], s22 offen offset:0 sc1
  buffer_load_dwordx4 v[92:95], v6, s[8:11], s22 offen offset:1792 sc1
  s_add_u32 s22, s25, 7168
  buffer_load_dwordx4 v[96:99], v6, s[8:11], s22 offen offset:0 sc1
  buffer_load_dwordx4 v[100:103], v6, s[8:11], s22 offen offset:1792 sc1
  s_add_u32 s22, s25, 10752
  buffer_load_dwordx4 v[104:107], v6, s[8:11], s22 offen offset:0 sc1
  buffer_load_dwordx4 v[108:111], v6, s[8:11], s22 offen offset:1792 sc1
  s_add_u32 s22, s25, 14336
  buffer_load_dwordx4 v[112:115], v6, s[8:11], s22 offen offset:0 sc1
  buffer_load_dwordx4 v[116:119], v6, s[8:11], s22 offen offset:1792 sc1
  s_add_u32 s22, s25, 17920
  buffer_load_dwordx4 v[120:123], v6, s[8:11], s22 offen offset:0 sc1
  buffer_load_dwordx4 v[124:127], v6, s[8:11], s22 offen offset:1792 sc1
  s_add_u32 s22, s25, 21504
  buffer_load_dwordx4 v[128:131], v6, s[8:11], s22 offen offset:0 sc1
  buffer_load_dwordx4 v[132:135], v6, s[8:11], s22 offen offset:1792 sc1
  s_add_u32 s22, s25, 25088
  buffer_load_dwordx4 v[136:139], v6, s[8:11], s22 offen offset:0 sc1
  buffer_load_dwordx4 v[140:143], v6, s[8:11], s22 offen offset:1792 sc1
  s_barrier
  ds_read_b128 v[8:11], v2 offset:8192
  ds_read_b128 v[12:15], v2 offset:9216
  ds_read_b128 v[16:19], v2 offset:10240
  ds_read_b128 v[20:23], v2 offset:11264
  ds_read_b128 v[24:27], v2 offset:12288
  ds_read_b128 v[28:31], v2 offset:13312
  ds_read_b128 v[32:35], v2 offset:14336
  s_waitcnt lgkmcnt(0)
  v_smfmac_f32_16x16x64_bf16 v[36:39], v[8:11], a[0:7], v3
  v_smfmac_f32_16x16x64_bf16 v[36:39], v[12:15], a[8:15], v3
  v_smfmac_f32_16x16x64_bf16 v[36:39], v[16:19], a[16:23], v3
  v_smfmac_f32_16x16x64_bf16 v[36:39], v[20:23], a[24:31], v3
  v_smfmac_f32_16x16x64_bf16 v[36:39], v[24:27], a[32:39], v3
  v_smfmac_f32_16x16x64_bf16 v[36:39], v[28:31], a[40:47], v3
  v_smfmac_f32_16x16x64_bf16 v[36:39], v[32:35], a[48:55], v3
  v_smfmac_f32_16x16x64_bf16 v[40:43], v[8:11], a[56:63], v3
  v_smfmac_f32_16x16x64_bf16 v[40:43], v[12:15], a[64:71], v3
  v_smfmac_f32_16x16x64_bf16 v[40:43], v[16:19], a[72:79], v3
  v_smfmac_f32_16x16x64_bf16 v[40:43], v[20:23], a[80:87], v3
  v_smfmac_f32_16x16x64_bf16 v[40:43], v[24:27], a[88:95], v3
  v_smfmac_f32_16x16x64_bf16 v[40:43], v[28:31], a[96:103], v3
  v_smfmac_f32_16x16x64_bf16 v[40:43], v[32:35], a[104:111], v3
  v_smfmac_f32_16x16x64_bf16 v[44:47], v[8:11], a[112:119], v3
  v_smfmac_f32_16x16x64_bf16 v[44:47], v[12:15], a[120:127], v3
  v_smfmac_f32_16x16x64_bf16 v[44:47], v[16:19], a[128:135], v3
  v_smfmac_f32_16x16x64_bf16 v[44:47], v[20:23], a[136:143], v3
  v_permlane32_swap_b32 v36, v40
  v_smfmac_f32_16x16x64_bf16 v[44:47], v[24:27], a[144:151], v3
  v_permlane32_swap_b32 v37, v41
  v_smfmac_f32_16x16x64_bf16 v[44:47], v[28:31], a[152:159], v3
  v_permlane32_swap_b32 v38, v42
  v_smfmac_f32_16x16x64_bf16 v[44:47], v[32:35], a[160:167], v3
  v_permlane32_swap_b32 v39, v43
  v_smfmac_f32_16x16x64_bf16 v[48:51], v[8:11], a[168:175], v3
  v_add_f32 v36, v36, v40
  v_smfmac_f32_16x16x64_bf16 v[48:51], v[12:15], a[176:183], v3
  v_add_f32 v37, v37, v41
  v_smfmac_f32_16x16x64_bf16 v[48:51], v[16:19], a[184:191], v3
  v_add_f32 v38, v38, v42
  v_smfmac_f32_16x16x64_bf16 v[48:51], v[20:23], a[192:199], v3
  v_add_f32 v39, v39, v43
  v_smfmac_f32_16x16x64_bf16 v[48:51], v[24:27], a[200:207], v3
  v_cvt_pk_bf16_f32 v40, v36, v37
  v_smfmac_f32_16x16x64_bf16 v[48:51], v[28:31], a[208:215], v3
  v_cvt_pk_bf16_f32 v41, v38, v39
  v_smfmac_f32_16x16x64_bf16 v[48:51], v[32:35], a[216:223], v3
  ds_write_b64 v60, v[40:41]
  v_smfmac_f32_16x16x64_bf16 v[52:55], v[8:11], a[224:231], v3
  v_smfmac_f32_16x16x64_bf16 v[52:55], v[12:15], a[232:239], v3
  v_smfmac_f32_16x16x64_bf16 v[52:55], v[16:19], a[240:247], v3
  v_smfmac_f32_16x16x64_bf16 v[52:55], v[20:23], a[248:255], v3
  v_permlane32_swap_b32 v44, v48
  v_smfmac_f32_16x16x64_bf16 v[52:55], v[24:27], v[176:183], v3
  v_permlane32_swap_b32 v45, v49
  v_smfmac_f32_16x16x64_bf16 v[52:55], v[28:31], v[184:191], v3
  v_permlane32_swap_b32 v46, v50
  v_smfmac_f32_16x16x64_bf16 v[52:55], v[32:35], v[192:199], v3
  v_permlane32_swap_b32 v47, v51
  v_smfmac_f32_16x16x64_bf16 v[56:59], v[8:11], v[200:207], v3
  v_add_f32 v44, v44, v48
  v_smfmac_f32_16x16x64_bf16 v[56:59], v[12:15], v[208:215], v3
  v_add_f32 v45, v45, v49
  v_smfmac_f32_16x16x64_bf16 v[56:59], v[16:19], v[216:223], v3
  v_add_f32 v46, v46, v50
  v_smfmac_f32_16x16x64_bf16 v[56:59], v[20:23], v[224:231], v3
  v_add_f32 v47, v47, v51
  v_smfmac_f32_16x16x64_bf16 v[56:59], v[24:27], v[232:239], v3
  v_cvt_pk_bf16_f32 v48, v44, v45
  v_smfmac_f32_16x16x64_bf16 v[56:59], v[28:31], v[240:247], v3
  v_cvt_pk_bf16_f32 v49, v46, v47
  v_smfmac_f32_16x16x64_bf16 v[56:59], v[32:35], v[248:255], v3
  ds_write_b64 v61, v[48:49]
  s_nop 6
  v_permlane32_swap_b32 v52, v56
  v_permlane32_swap_b32 v53, v57
  v_permlane32_swap_b32 v54, v58
  v_permlane32_swap_b32 v55, v59
  v_add_f32 v52, v52, v56
  v_add_f32 v53, v53, v57
  v_add_f32 v54, v54, v58
  v_add_f32 v55, v55, v59
  v_cvt_pk_bf16_f32 v56, v52, v53
  v_cvt_pk_bf16_f32 v57, v54, v55
  ds_write_b64 v62, v[56:57]
  s_cmp_eq_u32 s19, 63
  s_cbranch_scc1 cB_va0_last
  s_add_u32 s22, s20, 9216
  s_add_u32 s34, s20, 13312
  s_add_u32 s36, s20, 7168
  s_mov_b32 s37, 0
  buffer_load_dword v164, v4, s[8:11], s20 offen sc1
  s_nop 7
  buffer_load_dword v165, v4, s[8:11], s20 offen sc1
  s_nop 7
  buffer_load_dword v166, v4, s[8:11], s20 offen sc1
  s_nop 7
  buffer_load_dword v167, v4, s[8:11], s20 offen sc1
  s_nop 7
  buffer_load_dword v168, v4, s[8:11], s20 offen sc1
cB_va0_fw_l:
  s_waitcnt vmcnt(4)
  v_cmp_eq_u32 vcc, -1, v164
  s_cbranch_vccz cB_va0_fw_d
  buffer_load_dword v164, v4, s[8:11], s20 offen sc1
  s_waitcnt vmcnt(4)
  v_cmp_eq_u32 vcc, -1, v165
  s_cbranch_vccz cB_va0_fw_d
  buffer_load_dword v165, v4, s[8:11], s20 offen sc1
  s_waitcnt vmcnt(4)
  v_cmp_eq_u32 vcc, -1, v166
  s_cbranch_vccz cB_va0_fw_d
  buffer_load_dword v166, v4, s[8:11], s20 offen sc1
  s_waitcnt vmcnt(4)
  v_cmp_eq_u32 vcc, -1, v167
  s_cbranch_vccz cB_va0_fw_d
  buffer_load_dword v167, v4, s[8:11], s20 offen sc1
  s_waitcnt vmcnt(4)
  v_cmp_eq_u32 vcc, -1, v168
  s_cbranch_vccz cB_va0_fw_d
  buffer_load_dword v168, v4, s[8:11], s20 offen sc1
  s_add_u32 s30, s30, 1
  s_cmp_lt_u32 s30, 400000
  s_cbranch_scc1 cB_va0_fw_l
  s_branch cB_abort
cB_va0_fw_d:
  s_waitcnt lgkmcnt(0)
  buffer_load_dwordx4 v[8:11], v2, s[8:11], s22 offen offset:0 sc1
  v_mov_b32 v36, 0
  v_mov_b32 v37, 0
  v_mov_b32 v38, 0
  buffer_load_dwordx4 v[12:15], v2, s[8:11], s22 offen offset:1024 sc1
  v_mov_b32 v39, 0
  v_mov_b32 v40, 0
  v_mov_b32 v41, 0
  buffer_load_dwordx4 v[16:19], v2, s[8:11], s22 offen offset:2048 sc1
  v_mov_b32 v42, 0
  v_mov_b32 v43, 0
  v_mov_b32 v44, 0
  buffer_load_dwordx4 v[20:23], v2, s[8:11], s22 offen offset:3072 sc1
  v_mov_b32 v45, 0
  v_mov_b32 v46, 0
  v_mov_b32 v47, 0
  buffer_load_dwordx4 v[24:27], v2, s[8:11], s34 offen offset:0 sc1
  v_mov_b32 v48, 0
  v_mov_b32 v49, 0
  v_mov_b32 v50, 0
  buffer_load_dwordx4 v[28:31], v2, s[8:11], s34 offen offset:1024 sc1
  v_mov_b32 v51, 0
  v_mov_b32 v52, 0
  v_mov_b32 v53, 0
  buffer_load_dwordx4 v[32:35], v2, s[8:11], s34 offen offset:2048 sc1
  v_mov_b32 v54, 0
  v_mov_b32 v55, 0
  v_mov_b32 v56, 0
  buffer_load_dwordx4 v[144:147], v2, s[8:11], s34 offen offset:3072 sc1
  v_mov_b32 v57, 0
  v_mov_b32 v58, 0
  v_mov_b32 v59, 0
  buffer_load_dwordx4 v[148:151], v2, s[8:11], s36 offen offset:0 sc1
  buffer_load_dwordx4 v[152:155], v2, s[8:11], s36 offen offset:1024 sc1
  s_barrier
  ds_read_b128 v[64:67], v2 offset:0
  ds_read_b128 v[68:71], v2 offset:1024
  ds_read_b128 v[72:75], v2 offset:2048
  ds_read_b128 v[76:79], v2 offset:3072
  s_waitcnt vmcnt(9)
  v_smfmac_f32_16x16x64_bf16 v[156:159], v[8:11], v[80:87], v3
  s_waitcnt vmcnt(8)
  v_smfmac_f32_16x16x64_bf16 v[156:159], v[12:15], v[88:95], v3
  s_waitcnt vmcnt(7)
  v_smfmac_f32_16x16x64_bf16 v[156:159], v[16:19], v[96:103], v3
  s_waitcnt vmcnt(6)
  v_smfmac_f32_16x16x64_bf16 v[156:159], v[20:23], v[104:111], v3
  s_waitcnt vmcnt(5)
  v_smfmac_f32_16x16x64_bf16 v[156:159], v[24:27], v[112:119], v3
  s_mov_b32 exec_hi, 0
  buffer_store_dword v2, v7, s[8:11], s21 offen sc1
  s_mov_b64 exec, -1
  s_waitcnt vmcnt(5)
  v_smfmac_f32_16x16x64_bf16 v[156:159], v[28:31], v[120:127], v3
  s_waitcnt vmcnt(4)
  v_smfmac_f32_16x16x64_bf16 v[156:159], v[32:35], v[128:135], v3
  s_waitcnt vmcnt(3)
  v_smfmac_f32_16x16x64_bf16 v[156:159], v[144:147], v[136:143], v3
  s_waitcnt vmcnt(2) lgkmcnt(0)
  v_smfmac_f32_16x16x64_bf16 v[156:159], v[148:151], v[64:71], v3
  s_waitcnt vmcnt(1)
  v_smfmac_f32_16x16x64_bf16 v[156:159], v[152:155], v[72:79], v3
cB_va0_ep:
  s_nop 7
  v_permlane32_swap_b32 v156, v158
  v_permlane32_swap_b32 v157, v159
  v_add_f32 v160, v156, v158
  v_add_f32 v161, v157, v159
  v_mov_b32 v156, 0
  v_mov_b32_dpp v162, v160 row_ror:8 row_mask:0xf bank_mask:0xf
  v_cmp_u_f32 vcc, v160, v161
  v_mov_b32_dpp v160, v161 row_ror:8 row_mask:0xf bank_mask:0xc
  v_mov_b32 v157, 0
  v_mov_b32_dpp v161, v162 quad_perm:[0,1,2,3] row_mask:0xf bank_mask:0x3
  v_mov_b32 v158, 0
  v_cvt_pk_bf16_f32 v160, v160, v161
  v_mov_b32 v159, 0
  v_min_u32 v160, -2, v160
  s_cbranch_vccnz cB_va0_rp
cB_va0_pc:
  buffer_store_dword v160, v1, s[8:11], s21 offen sc1
  s_cmp_lg_u32 s19, 62
  s_cbranch_scc1 cB_va0_nl
  s_mov_b32 s22, 88519680
  buffer_store_dword v160, v1, s[8:11], s22 offen sc1
  s_mov_b64 exec, -1
  s_branch cB_done
cB_va0_nl:
  s_mov_b64 exec, -1
  s_add_u32 s25, s25, 28672
  s_add_u32 s19, s19, 1
  s_mov_b32 s20, s21
  s_branch cB_va0_loop
cB_va0_last:
  s_waitcnt lgkmcnt(0)
  s_barrier
  s_branch cB_done
cB_va0_rp:
  s_cmp_lg_u32 s37, 0
  s_cbranch_scc1 cB_va0_pc
cB_va0_rv:
  buffer_load_dwordx4 v[8:11], v2, s[8:11], s22 offen offset:0 sc1
  buffer_load_dwordx4 v[12:15], v2, s[8:11], s22 offen offset:1024 sc1
  buffer_load_dwordx4 v[16:19], v2, s[8:11], s22 offen offset:2048 sc1
  buffer_load_dwordx4 v[20:23], v2, s[8:11], s22 offen offset:3072 sc1
  buffer_load_dwordx4 v[24:27], v2, s[8:11], s34 offen offset:0 sc1
  buffer_load_dwordx4 v[28:31], v2, s[8:11], s34 offen offset:1024 sc1
  buffer_load_dwordx4 v[32:35], v2, s[8:11], s34 offen offset:2048 sc1
  buffer_load_dwordx4 v[144:147], v2, s[8:11], s34 offen offset:3072 sc1
  buffer_load_dwordx4 v[148:151], v2, s[8:11], s36 offen offset:0 sc1
  buffer_load_dwordx4 v[152:155], v2, s[8:11], s36 offen offset:1024 sc1
  s_waitcnt vmcnt(0)
  v_max3_u32 v63, v8, v9, v10
  v_max3_u32 v63, v63, v11, v12
  v_max3_u32 v63, v63, v13, v14
  v_max3_u32 v63, v63, v15, v16
  v_max3_u32 v63, v63, v17, v18
  v_max3_u32 v63, v63, v19, v20
  v_max3_u32 v63, v63, v21, v22
  v_max3_u32 v63, v63, v23, v24
  v_max3_u32 v63, v63, v25, v26
  v_max3_u32 v63, v63, v27, v28
  v_max3_u32 v63, v63, v29, v30
  v_max3_u32 v63, v63, v31, v32
  v_max3_u32 v63, v63, v33, v34
  v_max3_u32 v63, v63, v35, v144
  v_max3_u32 v63, v63, v145, v146
  v_max3_u32 v63, v63, v147, v148
  v_max3_u32 v63, v63, v149, v150
  v_max3_u32 v63, v63, v151, v152
  v_max3_u32 v63, v63, v153, v154
  v_max_u32 v63, v63, v155
  v_cmp_eq_u32 vcc, -1, v63
  s_cbranch_vccz cB_va0_rk
  s_add_u32 s30, s30, 1
  s_cmp_lt_u32 s30, 400000
  s_cbranch_scc1 cB_va0_rv
  s_branch cB_abort
cB_va0_rk:
  s_mov_b32 s37, 1
  s_add_u32 s31, s31, 0x10000
  v_smfmac_f32_16x16x64_bf16 v[156:159], v[8:11], v[80:87], v3
  v_smfmac_f32_16x16x64_bf16 v[156:159], v[12:15], v[88:95], v3
  v_smfmac_f32_16x16x64_bf16 v[156:159], v[16:19], v[96:103], v3
  v_smfmac_f32_16x16x64_bf16 v[156:159], v[20:23], v[104:111], v3
  v_smfmac_f32_16x16x64_bf16 v[156:159], v[24:27], v[112:119], v3
  v_smfmac_f32_16x16x64_bf16 v[156:159], v[28:31], v[120:127], v3
  v_smfmac_f32_16x16x64_bf16 v[156:159], v[32:35], v[128:135], v3
  v_smfmac_f32_16x16x64_bf16 v[156:159], v[144:147], v[136:143], v3
  v_smfmac_f32_16x16x64_bf16 v[156:159], v[148:151], v[64:71], v3
  v_smfmac_f32_16x16x64_bf16 v[156:159], v[152:155], v[72:79], v3
  s_nop 7
  s_branch cB_va0_ep
cB_va1_loop:
  s_add_u32 s23, s20, 4096
  s_add_u32 s21, s20, 25600
  s_mov_b32 s30, 0
  s_and_b32 s22, s19, 7
  s_cmp_lg_u32 s22, 0
  s_cbranch_scc1 cB_va1_vok
  v_mov_b32 v164, 0
cB_va1_vow:
  buffer_load_dword v165, v164, s[8:11], s35 offen sc1
  s_waitcnt vmcnt(0)
  v_readfirstlane_b32 s22, v165
  s_cmp_eq_u32 s22, 56
  s_cbranch_scc1 cB_va1_vod
  s_sleep 2
  s_add_u32 s30, s30, 1
  s_cmp_lt_u32 s30, 400000
  s_cbranch_scc1 cB_va1_vow
  s_branch cB_abort
cB_va1_vod:
  s_add_u32 s35, s35, 64
cB_va1_vok:
  s_cmp_eq_u32 s19, 63
  s_cbranch_scc1 cB_done
  s_barrier
  s_add_u32 s22, s25, 0
  buffer_load_dwordx4 v[80:83], v6, s[8:11], s22 offen offset:0 sc1
  buffer_load_dwordx4 v[84:87], v6, s[8:11], s22 offen offset:1792 sc1
  s_add_u32 s22, s25, 3584
  buffer_load_dwordx4 v[88:91], v6, s[8:11], s22 offen offset:0 sc1
  buffer_load_dwordx4 v[92:95], v6, s[8:11], s22 offen offset:1792 sc1
  s_add_u32 s22, s25, 7168
  buffer_load_dwordx4 v[96:99], v6, s[8:11], s22 offen offset:0 sc1
  buffer_load_dwordx4 v[100:103], v6, s[8:11], s22 offen offset:1792 sc1
  s_add_u32 s22, s25, 10752
  buffer_load_dwordx4 v[104:107], v6, s[8:11], s22 offen offset:0 sc1
  buffer_load_dwordx4 v[108:111], v6, s[8:11], s22 offen offset:1792 sc1
  s_add_u32 s22, s25, 14336
  buffer_load_dwordx4 v[112:115], v6, s[8:11], s22 offen offset:0 sc1
  buffer_load_dwordx4 v[116:119], v6, s[8:11], s22 offen offset:1792 sc1
  s_add_u32 s22, s25, 17920
  buffer_load_dwordx4 v[120:123], v6, s[8:11], s22 offen offset:0 sc1
  buffer_load_dwordx4 v[124:127], v6, s[8:11], s22 offen offset:1792 sc1
  s_add_u32 s22, s25, 21504
  buffer_load_dwordx4 v[128:131], v6, s[8:11], s22 offen offset:0 sc1
  buffer_load_dwordx4 v[132:135], v6, s[8:11], s22 offen offset:1792 sc1
  s_add_u32 s22, s25, 25088
  buffer_load_dwordx4 v[136:139], v6, s[8:11], s22 offen offset:0 sc1
  buffer_load_dwordx4 v[140:143], v6, s[8:11], s22 offen offset:1792 sc1
  s_barrier
  ds_read_b128 v[8:11], v2 offset:8192
  ds_read_b128 v[12:15], v2 offset:9216
  ds_read_b128 v[16:19], v2 offset:10240
  ds_read_b128 v[20:23], v2 offset:11264
  ds_read_b128 v[24:27], v2 offset:12288
  ds_read_b128 v[28:31], v2 offset:13312
  ds_read_b128 v[32:35], v2 offset:14336
  s_waitcnt lgkmcnt(0)
  v_smfmac_f32_16x16x64_bf16 v[36:39], v[8:11], a[0:7], v3
  v_smfmac_f32_16x16x64_bf16 v[36:39], v[12:15], a[8:15], v3
  v_smfmac_f32_16x16x64_bf16 v[36:39], v[16:19], a[16:23], v3
  v_smfmac_f32_16x16x64_bf16 v[36:39], v[20:23], a[24:31], v3
  v_smfmac_f32_16x16x64_bf16 v[36:39], v[24:27], a[32:39], v3
  v_smfmac_f32_16x16x64_bf16 v[36:39], v[28:31], a[40:47], v3
  v_smfmac_f32_16x16x64_bf16 v[36:39], v[32:35], a[48:55], v3
  v_smfmac_f32_16x16x64_bf16 v[40:43], v[8:11], a[56:63], v3
  v_smfmac_f32_16x16x64_bf16 v[40:43], v[12:15], a[64:71], v3
  v_smfmac_f32_16x16x64_bf16 v[40:43], v[16:19], a[72:79], v3
  v_smfmac_f32_16x16x64_bf16 v[40:43], v[20:23], a[80:87], v3
  v_smfmac_f32_16x16x64_bf16 v[40:43], v[24:27], a[88:95], v3
  v_smfmac_f32_16x16x64_bf16 v[40:43], v[28:31], a[96:103], v3
  v_smfmac_f32_16x16x64_bf16 v[40:43], v[32:35], a[104:111], v3
  v_smfmac_f32_16x16x64_bf16 v[44:47], v[8:11], a[112:119], v3
  v_smfmac_f32_16x16x64_bf16 v[44:47], v[12:15], a[120:127], v3
  v_smfmac_f32_16x16x64_bf16 v[44:47], v[16:19], a[128:135], v3
  v_smfmac_f32_16x16x64_bf16 v[44:47], v[20:23], a[136:143], v3
  v_permlane32_swap_b32 v36, v40
  v_smfmac_f32_16x16x64_bf16 v[44:47], v[24:27], a[144:151], v3
  v_permlane32_swap_b32 v37, v41
  v_smfmac_f32_16x16x64_bf16 v[44:47], v[28:31], a[152:159], v3
  v_permlane32_swap_b32 v38, v42
  v_smfmac_f32_16x16x64_bf16 v[44:47], v[32:35], a[160:167], v3
  v_permlane32_swap_b32 v39, v43
  v_smfmac_f32_16x16x64_bf16 v[48:51], v[8:11], a[168:175], v3
  v_add_f32 v36, v36, v40
  v_smfmac_f32_16x16x64_bf16 v[48:51], v[12:15], a[176:183], v3
  v_add_f32 v37, v37, v41
  v_smfmac_f32_16x16x64_bf16 v[48:51], v[16:19], a[184:191], v3
  v_add_f32 v38, v38, v42
  v_smfmac_f32_16x16x64_bf16 v[48:51], v[20:23], a[192:199], v3
  v_add_f32 v39, v39, v43
  v_smfmac_f32_16x16x64_bf16 v[48:51], v[24:27], a[200:207], v3
  v_cvt_pk_bf16_f32 v40, v36, v37
  v_smfmac_f32_16x16x64_bf16 v[48:51], v[28:31], a[208:215], v3
  v_cvt_pk_bf16_f32 v41, v38, v39
  v_smfmac_f32_16x16x64_bf16 v[48:51], v[32:35], a[216:223], v3
  ds_write_b64 v60, v[40:41]
  v_smfmac_f32_16x16x64_bf16 v[52:55], v[8:11], a[224:231], v3
  v_smfmac_f32_16x16x64_bf16 v[52:55], v[12:15], a[232:239], v3
  v_smfmac_f32_16x16x64_bf16 v[52:55], v[16:19], a[240:247], v3
  v_smfmac_f32_16x16x64_bf16 v[52:55], v[20:23], a[248:255], v3
  v_permlane32_swap_b32 v44, v48
  v_smfmac_f32_16x16x64_bf16 v[52:55], v[24:27], v[176:183], v3
  v_permlane32_swap_b32 v45, v49
  v_smfmac_f32_16x16x64_bf16 v[52:55], v[28:31], v[184:191], v3
  v_permlane32_swap_b32 v46, v50
  v_smfmac_f32_16x16x64_bf16 v[52:55], v[32:35], v[192:199], v3
  v_permlane32_swap_b32 v47, v51
  v_smfmac_f32_16x16x64_bf16 v[56:59], v[8:11], v[200:207], v3
  v_add_f32 v44, v44, v48
  v_smfmac_f32_16x16x64_bf16 v[56:59], v[12:15], v[208:215], v3
  v_add_f32 v45, v45, v49
  v_smfmac_f32_16x16x64_bf16 v[56:59], v[16:19], v[216:223], v3
  v_add_f32 v46, v46, v50
  v_smfmac_f32_16x16x64_bf16 v[56:59], v[20:23], v[224:231], v3
  v_add_f32 v47, v47, v51
  v_smfmac_f32_16x16x64_bf16 v[56:59], v[24:27], v[232:239], v3
  v_cvt_pk_bf16_f32 v48, v44, v45
  v_smfmac_f32_16x16x64_bf16 v[56:59], v[28:31], v[240:247], v3
  v_cvt_pk_bf16_f32 v49, v46, v47
  v_smfmac_f32_16x16x64_bf16 v[56:59], v[32:35], v[248:255], v3
  ds_write_b64 v61, v[48:49]
  s_nop 6
  v_permlane32_swap_b32 v52, v56
  v_permlane32_swap_b32 v53, v57
  v_permlane32_swap_b32 v54, v58
  v_permlane32_swap_b32 v55, v59
  v_add_f32 v52, v52, v56
  v_add_f32 v53, v53, v57
  v_add_f32 v54, v54, v58
  v_add_f32 v55, v55, v59
  v_cvt_pk_bf16_f32 v56, v52, v53
  v_cvt_pk_bf16_f32 v57, v54, v55
  ds_write_b64 v62, v[56:57]
  s_cmp_eq_u32 s19, 63
  s_cbranch_scc1 cB_va1_last
  s_add_u32 s22, s20, 9216
  s_add_u32 s34, s20, 13312
  s_add_u32 s36, s20, 7168
  s_mov_b32 s37, 0
  buffer_load_dword v164, v4, s[8:11], s20 offen sc1
  s_nop 7
  buffer_load_dword v165, v4, s[8:11], s20 offen sc1
  s_nop 7
  buffer_load_dword v166, v4, s[8:11], s20 offen sc1
  s_nop 7
  buffer_load_dword v167, v4, s[8:11], s20 offen sc1
  s_nop 7
  buffer_load_dword v168, v4, s[8:11], s20 offen sc1
cB_va1_fw_l:
  s_waitcnt vmcnt(4)
  v_cmp_eq_u32 vcc, -1, v164
  s_cbranch_vccz cB_va1_fw_d
  buffer_load_dword v164, v4, s[8:11], s20 offen sc1
  s_waitcnt vmcnt(4)
  v_cmp_eq_u32 vcc, -1, v165
  s_cbranch_vccz cB_va1_fw_d
  buffer_load_dword v165, v4, s[8:11], s20 offen sc1
  s_waitcnt vmcnt(4)
  v_cmp_eq_u32 vcc, -1, v166
  s_cbranch_vccz cB_va1_fw_d
  buffer_load_dword v166, v4, s[8:11], s20 offen sc1
  s_waitcnt vmcnt(4)
  v_cmp_eq_u32 vcc, -1, v167
  s_cbranch_vccz cB_va1_fw_d
  buffer_load_dword v167, v4, s[8:11], s20 offen sc1
  s_waitcnt vmcnt(4)
  v_cmp_eq_u32 vcc, -1, v168
  s_cbranch_vccz cB_va1_fw_d
  buffer_load_dword v168, v4, s[8:11], s20 offen sc1
  s_add_u32 s30, s30, 1
  s_cmp_lt_u32 s30, 400000
  s_cbranch_scc1 cB_va1_fw_l
  s_branch cB_abort
cB_va1_fw_d:
  s_waitcnt lgkmcnt(0)
  buffer_load_dwordx4 v[8:11], v2, s[8:11], s22 offen offset:0 sc1
  v_mov_b32 v36, 0
  v_mov_b32 v37, 0
  v_mov_b32 v38, 0
  buffer_load_dwordx4 v[12:15], v2, s[8:11], s22 offen offset:1024 sc1
  v_mov_b32 v39, 0
  v_mov_b32 v40, 0
  v_mov_b32 v41, 0
  buffer_load_dwordx4 v[16:19], v2, s[8:11], s22 offen offset:2048 sc1
  v_mov_b32 v42, 0
  v_mov_b32 v43, 0
  v_mov_b32 v44, 0
  buffer_load_dwordx4 v[20:23], v2, s[8:11], s22 offen offset:3072 sc1
  v_mov_b32 v45, 0
  v_mov_b32 v46, 0
  v_mov_b32 v47, 0
  buffer_load_dwordx4 v[24:27], v2, s[8:11], s34 offen offset:0 sc1
  v_mov_b32 v48, 0
  v_mov_b32 v49, 0
  v_mov_b32 v50, 0
  buffer_load_dwordx4 v[28:31], v2, s[8:11], s34 offen offset:1024 sc1
  v_mov_b32 v51, 0
  v_mov_b32 v52, 0
  v_mov_b32 v53, 0
  buffer_load_dwordx4 v[32:35], v2, s[8:11], s34 offen offset:2048 sc1
  v_mov_b32 v54, 0
  v_mov_b32 v55, 0
  v_mov_b32 v56, 0
  buffer_load_dwordx4 v[144:147], v2, s[8:11], s34 offen offset:3072 sc1
  v_mov_b32 v57, 0
  v_mov_b32 v58, 0
  v_mov_b32 v59, 0
  buffer_load_dwordx4 v[148:151], v2, s[8:11], s36 offen offset:0 sc1
  buffer_load_dwordx4 v[152:155], v2, s[8:11], s36 offen offset:1024 sc1
  s_barrier
  ds_read_b128 v[64:67], v2 offset:4096
  ds_read_b128 v[68:71], v2 offset:5120
  ds_read_b128 v[72:75], v2 offset:6144
  ds_read_b128 v[76:79], v2 offset:7168
  s_waitcnt vmcnt(9)
  v_smfmac_f32_16x16x64_bf16 v[156:159], v[8:11], v[80:87], v3
  s_waitcnt vmcnt(8)
  v_smfmac_f32_16x16x64_bf16 v[156:159], v[12:15], v[88:95], v3
  s_waitcnt vmcnt(7)
  v_smfmac_f32_16x16x64_bf16 v[156:159], v[16:19], v[96:103], v3
  s_waitcnt vmcnt(6)
  v_smfmac_f32_16x16x64_bf16 v[156:159], v[20:23], v[104:111], v3
  s_waitcnt vmcnt(5)
  v_smfmac_f32_16x16x64_bf16 v[156:159], v[24:27], v[112:119], v3
  s_mov_b32 exec_hi, 0
  buffer_store_dword v2, v7, s[8:11], s21 offen sc1
  s_mov_b64 exec, -1
  s_waitcnt vmcnt(5)
  v_smfmac_f32_16x16x64_bf16 v[156:159], v[28:31], v[120:127], v3
  s_waitcnt vmcnt(4)
  v_smfmac_f32_16x16x64_bf16 v[156:159], v[32:35], v[128:135], v3
  s_waitcnt vmcnt(3)
  v_smfmac_f32_16x16x64_bf16 v[156:159], v[144:147], v[136:143], v3
  s_waitcnt vmcnt(2) lgkmcnt(0)
  v_smfmac_f32_16x16x64_bf16 v[156:159], v[148:151], v[64:71], v3
  s_waitcnt vmcnt(1)
  v_smfmac_f32_16x16x64_bf16 v[156:159], v[152:155], v[72:79], v3
cB_va1_ep:
  s_nop 7
  v_permlane32_swap_b32 v156, v158
  v_permlane32_swap_b32 v157, v159
  v_add_f32 v160, v156, v158
  v_add_f32 v161, v157, v159
  v_mov_b32 v156, 0
  v_mov_b32_dpp v162, v160 row_ror:8 row_mask:0xf bank_mask:0xf
  v_cmp_u_f32 vcc, v160, v161
  v_mov_b32_dpp v160, v161 row_ror:8 row_mask:0xf bank_mask:0xc
  v_mov_b32 v157, 0
  v_mov_b32_dpp v161, v162 quad_perm:[0,1,2,3] row_mask:0xf bank_mask:0x3
  v_mov_b32 v158, 0
  v_cvt_pk_bf16_f32 v160, v160, v161
  v_mov_b32 v159, 0
  v_min_u32 v160, -2, v160
  s_cbranch_vccnz cB_va1_rp
cB_va1_pc:
  s_mov_b64 exec, s[26:27]
  buffer_store_dword v160, v1, s[8:11], s21 offen sc1
  s_cmp_lg_u32 s19, 62
  s_cbranch_scc1 cB_va1_nl
  s_mov_b32 s22, 88519680
  buffer_store_dword v160, v1, s[8:11], s22 offen sc1
  s_mov_b64 exec, -1
  s_branch cB_done
cB_va1_nl:
  s_mov_b64 exec, -1
  s_add_u32 s25, s25, 28672
  s_add_u32 s19, s19, 1
  s_mov_b32 s20, s21
  s_branch cB_va1_loop
cB_va1_last:
  s_waitcnt lgkmcnt(0)
  s_barrier
  s_branch cB_done
cB_va1_rp:
  s_cmp_lg_u32 s37, 0
  s_cbranch_scc1 cB_va1_pc
cB_va1_rv:
  buffer_load_dwordx4 v[8:11], v2, s[8:11], s22 offen offset:0 sc1
  buffer_load_dwordx4 v[12:15], v2, s[8:11], s22 offen offset:1024 sc1
  buffer_load_dwordx4 v[16:19], v2, s[8:11], s22 offen offset:2048 sc1
  buffer_load_dwordx4 v[20:23], v2, s[8:11], s22 offen offset:3072 sc1
  buffer_load_dwordx4 v[24:27], v2, s[8:11], s34 offen offset:0 sc1
  buffer_load_dwordx4 v[28:31], v2, s[8:11], s34 offen offset:1024 sc1
  buffer_load_dwordx4 v[32:35], v2, s[8:11], s34 offen offset:2048 sc1
  buffer_load_dwordx4 v[144:147], v2, s[8:11], s34 offen offset:3072 sc1
  buffer_load_dwordx4 v[148:151], v2, s[8:11], s36 offen offset:0 sc1
  buffer_load_dwordx4 v[152:155], v2, s[8:11], s36 offen offset:1024 sc1
  s_waitcnt vmcnt(0)
  v_max3_u32 v63, v8, v9, v10
  v_max3_u32 v63, v63, v11, v12
  v_max3_u32 v63, v63, v13, v14
  v_max3_u32 v63, v63, v15, v16
  v_max3_u32 v63, v63, v17, v18
  v_max3_u32 v63, v63, v19, v20
  v_max3_u32 v63, v63, v21, v22
  v_max3_u32 v63, v63, v23, v24
  v_max3_u32 v63, v63, v25, v26
  v_max3_u32 v63, v63, v27, v28
  v_max3_u32 v63, v63, v29, v30
  v_max3_u32 v63, v63, v31, v32
  v_max3_u32 v63, v63, v33, v34
  v_max3_u32 v63, v63, v35, v144
  v_max3_u32 v63, v63, v145, v146
  v_max3_u32 v63, v63, v147, v148
  v_max3_u32 v63, v63, v149, v150
  v_max3_u32 v63, v63, v151, v152
  v_max3_u32 v63, v63, v153, v154
  v_max_u32 v63, v63, v155
  v_cmp_eq_u32 vcc, -1, v63
  s_cbranch_vccz cB_va1_rk
  s_add_u32 s30, s30, 1
  s_cmp_lt_u32 s30, 400000
  s_cbranch_scc1 cB_va1_rv
  s_branch cB_abort
cB_va1_rk:
  s_mov_b32 s37, 1
  s_add_u32 s31, s31, 0x10000
  v_smfmac_f32_16x16x64_bf16 v[156:159], v[8:11], v[80:87], v3
  v_smfmac_f32_16x16x64_bf16 v[156:159], v[12:15], v[88:95], v3
  v_smfmac_f32_16x16x64_bf16 v[156:159], v[16:19], v[96:103], v3
  v_smfmac_f32_16x16x64_bf16 v[156:159], v[20:23], v[104:111], v3
  v_smfmac_f32_16x16x64_bf16 v[156:159], v[24:27], v[112:119], v3
  v_smfmac_f32_16x16x64_bf16 v[156:159], v[28:31], v[120:127], v3
  v_smfmac_f32_16x16x64_bf16 v[156:159], v[32:35], v[128:135], v3
  v_smfmac_f32_16x16x64_bf16 v[156:159], v[144:147], v[136:143], v3
  v_smfmac_f32_16x16x64_bf16 v[156:159], v[148:151], v[64:71], v3
  v_smfmac_f32_16x16x64_bf16 v[156:159], v[152:155], v[72:79], v3
  s_nop 7
  s_branch cB_va1_ep
cB_va2_loop:
  s_add_u32 s23, s20, 4096
  s_add_u32 s21, s20, 25600
  v_mov_b32 v36, 0
  v_mov_b32 v37, 0
  v_mov_b32 v38, 0
  v_mov_b32 v39, 0
  v_mov_b32 v40, 0
  v_mov_b32 v41, 0
  v_mov_b32 v42, 0
  v_mov_b32 v43, 0
  v_mov_b32 v44, 0
  v_mov_b32 v45, 0
  v_mov_b32 v46, 0
  v_mov_b32 v47, 0
  v_mov_b32 v48, 0
  v_mov_b32 v49, 0
  v_mov_b32 v50, 0
  v_mov_b32 v51, 0
  v_mov_b32 v52, 0
  v_mov_b32 v53, 0
  v_mov_b32 v54, 0
  v_mov_b32 v55, 0
  v_mov_b32 v56, 0
  v_mov_b32 v57, 0
  v_mov_b32 v58, 0
  v_mov_b32 v59, 0
  v_mov_b32 v60, 0
  v_mov_b32 v61, 0
  v_mov_b32 v62, 0
  v_mov_b32 v63, 0
  v_mov_b32 v64, 0
  v_mov_b32 v65, 0
  v_mov_b32 v66, 0
  v_mov_b32 v67, 0
  s_mov_b32 s30, 0
  buffer_load_dword v76, v119, s[8:11], s20 offen sc1
  buffer_load_dword v77, v119, s[8:11], s20 offen sc1
  buffer_load_dword v78, v119, s[8:11], s20 offen sc1
cB_va2_fp_l:
  s_waitcnt vmcnt(2)
  v_cmp_eq_u32 vcc, -1, v76
  s_cbranch_vccz cB_va2_fp_d
  buffer_load_dword v76, v119, s[8:11], s20 offen sc1
  s_waitcnt vmcnt(2)
  v_cmp_eq_u32 vcc, -1, v77
  s_cbranch_vccz cB_va2_fp_d
  buffer_load_dword v77, v119, s[8:11], s20 offen sc1
  s_waitcnt vmcnt(2)
  v_cmp_eq_u32 vcc, -1, v78
  s_cbranch_vccz cB_va2_fp_d
  buffer_load_dword v78, v119, s[8:11], s20 offen sc1
  s_add_u32 s30, s30, 1
  s_cmp_lt_u32 s30, 400000
  s_cbranch_scc1 cB_va2_fp_l
  s_branch cB_abort
cB_va2_fp_d:
  buffer_load_dwordx4 v[8:11], v2, s[8:11], s20 offen offset:0 sc1
  buffer_load_dwordx4 v[12:15], v2, s[8:11], s20 offen offset:1024 sc1
  buffer_load_dwordx4 v[16:19], v2, s[8:11], s20 offen offset:2048 sc1
  buffer_load_dwordx4 v[20:23], v2, s[8:11], s20 offen offset:3072 sc1
  s_barrier
cB_va2_ld:
  s_waitcnt vmcnt(0)
  v_max3_u32 v84, v8, v9, v10
  v_max3_u32 v84, v84, v11, v12
  v_max3_u32 v84, v84, v13, v14
  v_max3_u32 v84, v84, v15, v16
  v_max3_u32 v84, v84, v17, v18
  v_max3_u32 v84, v84, v19, v20
  v_max3_u32 v84, v84, v21, v22
  v_max_u32 v84, v84, v23
  v_cmp_eq_u32 vcc, -1, v84
  ds_write_b128 v2, v[8:11] offset:8192
  ds_write_b128 v2, v[12:15] offset:9216
  ds_write_b128 v2, v[16:19] offset:10240
  ds_write_b128 v2, v[20:23] offset:11264
  s_cbranch_vccnz cB_va2_retry
  s_waitcnt lgkmcnt(0)
  s_barrier
  ds_read_b128 v[24:27], v2 offset:12288
  ds_read_b128 v[28:31], v2 offset:13312
  ds_read_b128 v[32:35], v2 offset:14336
  ds_read_b128 v[92:95], v0
  s_waitcnt lgkmcnt(0)
  s_mov_b64 exec, s[26:27]
  buffer_store_dwordx4 v[92:95], v2, s[8:11], s36 offen sc1
  s_mov_b64 exec, -1
  s_add_u32 s36, s36, 7168
  s_cmp_eq_u32 s19, 63
  s_cbranch_scc1 cB_done
  ds_read_b128 v[76:79], v1 offset:0
  ds_read_b128 v[80:83], v1 offset:1024
  ds_read_b128 v[84:87], v1 offset:2048
  ds_read_b128 v[88:91], v1 offset:3072
  ds_read_b128 v[92:95], v1 offset:4096
  ds_read_b128 v[96:99], v1 offset:5120
  v_smfmac_f32_16x16x64_bf16 v[60:63], v[8:11], v[200:207], v3
  v_smfmac_f32_16x16x64_bf16 v[60:63], v[12:15], v[208:215], v3
  s_waitcnt lgkmcnt(4)
  v_smfmac_f32_16x16x64_bf16 v[64:67], v[8:11], v[76:83], v3
  ds_read_b128 v[76:79], v1 offset:6144
  ds_read_b128 v[80:83], v1 offset:7168
  v_smfmac_f32_16x16x64_bf16 v[60:63], v[16:19], v[216:223], v3
  v_smfmac_f32_16x16x64_bf16 v[60:63], v[20:23], v[224:231], v3
  s_waitcnt lgkmcnt(4)
  v_smfmac_f32_16x16x64_bf16 v[64:67], v[12:15], v[84:91], v3
  ds_read_b128 v[84:87], v1 offset:8192
  ds_read_b128 v[88:91], v1 offset:9216
  v_smfmac_f32_16x16x64_bf16 v[60:63], v[24:27], v[232:239], v3
  v_smfmac_f32_16x16x64_bf16 v[60:63], v[28:31], v[240:247], v3
  s_waitcnt lgkmcnt(4)
  v_smfmac_f32_16x16x64_bf16 v[64:67], v[16:19], v[92:99], v3
  ds_read_b128 v[92:95], v1 offset:10240
  ds_read_b128 v[96:99], v1 offset:11264
  v_smfmac_f32_16x16x64_bf16 v[60:63], v[32:35], v[248:255], v3
  v_smfmac_f32_16x16x64_bf16 v[36:39], v[8:11], a[0:7], v3
  s_waitcnt lgkmcnt(4)
  v_smfmac_f32_16x16x64_bf16 v[64:67], v[20:23], v[76:83], v3
  ds_read_b128 v[76:79], v1 offset:12288
  ds_read_b128 v[80:83], v1 offset:13312
  v_smfmac_f32_16x16x64_bf16 v[36:39], v[12:15], a[8:15], v3
  v_smfmac_f32_16x16x64_bf16 v[36:39], v[16:19], a[16:23], v3
  s_waitcnt lgkmcnt(4)
  v_smfmac_f32_16x16x64_bf16 v[64:67], v[24:27], v[84:91], v3
  v_smfmac_f32_16x16x64_bf16 v[36:39], v[20:23], a[24:31], v3
  v_smfmac_f32_16x16x64_bf16 v[36:39], v[24:27], a[32:39], v3
  s_waitcnt lgkmcnt(2)
  v_smfmac_f32_16x16x64_bf16 v[64:67], v[28:31], v[92:99], v3
  v_smfmac_f32_16x16x64_bf16 v[36:39], v[28:31], a[40:47], v3
  v_smfmac_f32_16x16x64_bf16 v[36:39], v[32:35], a[48:55], v3
  s_waitcnt lgkmcnt(0)
  v_smfmac_f32_16x16x64_bf16 v[64:67], v[32:35], v[76:83], v3
  v_smfmac_f32_16x16x64_bf16 v[40:43], v[8:11], a[56:63], v3
  v_smfmac_f32_16x16x64_bf16 v[40:43], v[12:15], a[64:71], v3
  v_smfmac_f32_16x16x64_bf16 v[40:43], v[16:19], a[72:79], v3
  v_smfmac_f32_16x16x64_bf16 v[40:43], v[20:23], a[80:87], v3
  v_permlane32_swap_b32 v60, v64
  v_smfmac_f32_16x16x64_bf16 v[40:43], v[24:27], a[88:95], v3
  v_permlane32_swap_b32 v61, v65
  v_smfmac_f32_16x16x64_bf16 v[40:43], v[28:31], a[96:103], v3
  v_permlane32_swap_b32 v62, v66
  v_smfmac_f32_16x16x64_bf16 v[40:43], v[32:35], a[104:111], v3
  v_permlane32_swap_b32 v63, v67
  v_smfmac_f32_16x16x64_bf16 v[44:47], v[8:11], a[112:119], v3
  v_smfmac_f32_16x16x64_bf16 v[44:47], v[12:15], a[120:127], v3
  v_smfmac_f32_16x16x64_bf16 v[44:47], v[16:19], a[128:135], v3
  v_smfmac_f32_16x16x64_bf16 v[44:47], v[20:23], a[136:143], v3
  v_add_f32 v60, v60, v64
  v_add_f32 v61, v61, v65
  v_smfmac_f32_16x16x64_bf16 v[44:47], v[24:27], a[144:151], v3
  v_add_f32 v62, v62, v66
  v_add_f32 v63, v63, v67
  v_smfmac_f32_16x16x64_bf16 v[44:47], v[28:31], a[152:159], v3
  v_cvt_pk_bf16_f32 v64, v60, v61
  v_cvt_pk_bf16_f32 v65, v62, v63
  v_smfmac_f32_16x16x64_bf16 v[44:47], v[32:35], a[160:167], v3
  ds_write_b64 v115, v[64:65]
  v_smfmac_f32_16x16x64_bf16 v[48:51], v[8:11], a[168:175], v3
  v_permlane32_swap_b32 v36, v40
  v_smfmac_f32_16x16x64_bf16 v[48:51], v[12:15], a[176:183], v3
  v_permlane32_swap_b32 v37, v41
  v_smfmac_f32_16x16x64_bf16 v[48:51], v[16:19], a[184:191], v3
  v_permlane32_swap_b32 v38, v42
  v_smfmac_f32_16x16x64_bf16 v[48:51], v[20:23], a[192:199], v3
  v_permlane32_swap_b32 v39, v43
  v_smfmac_f32_16x16x64_bf16 v[48:51], v[24:27], a[200:207], v3
  v_add_f32 v36, v36, v40
  v_smfmac_f32_16x16x64_bf16 v[48:51], v[28:31], a[208:215], v3
  v_add_f32 v37, v37, v41
  v_smfmac_f32_16x16x64_bf16 v[48:51], v[32:35], a[216:223], v3
  v_add_f32 v38, v38, v42
  v_smfmac_f32_16x16x64_bf16 v[52:55], v[8:11], a[224:231], v3
  v_smfmac_f32_16x16x64_bf16 v[52:55], v[12:15], a[232:239], v3
  v_smfmac_f32_16x16x64_bf16 v[52:55], v[16:19], a[240:247], v3
  v_smfmac_f32_16x16x64_bf16 v[52:55], v[20:23], a[248:255], v3
  v_add_f32 v39, v39, v43
  v_cvt_pk_bf16_f32 v40, v36, v37
  v_smfmac_f32_16x16x64_bf16 v[52:55], v[24:27], v[120:127], v3
  v_cvt_pk_bf16_f32 v41, v38, v39
  v_smfmac_f32_16x16x64_bf16 v[52:55], v[28:31], v[128:135], v3
  ds_write_b64 v112, v[40:41]
  v_smfmac_f32_16x16x64_bf16 v[52:55], v[32:35], v[136:143], v3
  v_permlane32_swap_b32 v44, v48
  v_smfmac_f32_16x16x64_bf16 v[56:59], v[8:11], v[144:151], v3
  v_permlane32_swap_b32 v45, v49
  v_smfmac_f32_16x16x64_bf16 v[56:59], v[12:15], v[152:159], v3
  v_permlane32_swap_b32 v46, v50
  v_smfmac_f32_16x16x64_bf16 v[56:59], v[16:19], v[160:167], v3
  v_permlane32_swap_b32 v47, v51
  v_smfmac_f32_16x16x64_bf16 v[56:59], v[20:23], v[168:175], v3
  v_add_f32 v44, v44, v48
  v_smfmac_f32_16x16x64_bf16 v[56:59], v[24:27], v[176:183], v3
  v_add_f32 v45, v45, v49
  v_smfmac_f32_16x16x64_bf16 v[56:59], v[28:31], v[184:191], v3
  v_add_f32 v46, v46, v50
  v_smfmac_f32_16x16x64_bf16 v[56:59], v[32:35], v[192:199], v3
  v_add_f32 v47, v47, v51
  v_cvt_pk_bf16_f32 v48, v44, v45
  v_cvt_pk_bf16_f32 v49, v46, v47
  ds_write_b64 v113, v[48:49]
  s_nop 3
  v_permlane32_swap_b32 v52, v56
  v_permlane32_swap_b32 v53, v57
  v_permlane32_swap_b32 v54, v58
  v_permlane32_swap_b32 v55, v59
  v_add_f32 v52, v52, v56
  v_add_f32 v53, v53, v57
  v_add_f32 v54, v54, v58
  v_add_f32 v55, v55, v59
  v_cvt_pk_bf16_f32 v56, v52, v53
  v_cvt_pk_bf16_f32 v57, v54, v55
  ds_write_b64 v114, v[56:57]
  s_waitcnt lgkmcnt(0)
  s_barrier
  s_cmp_eq_u32 s19, 62
  s_cbranch_scc1 cB_done
  s_waitcnt vmcnt(0) lgkmcnt(0)
  s_add_u32 s19, s19, 1
  s_mov_b32 s20, s21
  s_branch cB_va2_loop
cB_va2_retry:
  s_waitcnt lgkmcnt(0)
  buffer_load_dwordx4 v[8:11], v2, s[8:11], s20 offen offset:0 sc1
  buffer_load_dwordx4 v[12:15], v2, s[8:11], s20 offen offset:1024 sc1
  buffer_load_dwordx4 v[16:19], v2, s[8:11], s20 offen offset:2048 sc1
  buffer_load_dwordx4 v[20:23], v2, s[8:11], s20 offen offset:3072 sc1
  s_add_u32 s31, s31, 1
  s_add_u32 s30, s30, 1
  s_cmp_lt_u32 s30, 400000
  s_cbranch_scc1 cB_va2_ld
  s_branch cB_abort
cB_va2_last:
  s_waitcnt lgkmcnt(0)
  buffer_store_dwordx4 v[100:103], v2, s[8:11], s24 offen offset:0 sc1
  buffer_store_dwordx4 v[104:107], v2, s[8:11], s24 offen offset:1024 sc1
  buffer_store_dwordx4 v[108:111], v2, s[8:11], s24 offen offset:2048 sc1
  buffer_store_dwordx4 v[4:7], v2, s[8:11], s24 offen offset:3072 sc1
  s_add_u32 s24, s24, 8192
  s_waitcnt vmcnt(0)
  s_mov_b64 exec, 1
  buffer_store_dword v117, v2, s[8:11], s34 offen sc1
  s_mov_b64 exec, -1
  s_add_u32 s34, s34, 8
  s_mov_b64 exec, 1
  buffer_store_dword v117, v2, s[8:11], s34 offen sc1
  s_mov_b64 exec, -1
  s_add_u32 s34, s34, 8
  s_branch cB_done
cB_va3_loop:
  s_add_u32 s23, s20, 4096
  s_add_u32 s21, s20, 25600
  v_mov_b32 v36, 0
  v_mov_b32 v37, 0
  v_mov_b32 v38, 0
  v_mov_b32 v39, 0
  v_mov_b32 v40, 0
  v_mov_b32 v41, 0
  v_mov_b32 v42, 0
  v_mov_b32 v43, 0
  v_mov_b32 v44, 0
  v_mov_b32 v45, 0
  v_mov_b32 v46, 0
  v_mov_b32 v47, 0
  v_mov_b32 v48, 0
  v_mov_b32 v49, 0
  v_mov_b32 v50, 0
  v_mov_b32 v51, 0
  v_mov_b32 v52, 0
  v_mov_b32 v53, 0
  v_mov_b32 v54, 0
  v_mov_b32 v55, 0
  v_mov_b32 v56, 0
  v_mov_b32 v57, 0
  v_mov_b32 v58, 0
  v_mov_b32 v59, 0
  v_mov_b32 v60, 0
  v_mov_b32 v61, 0
  v_mov_b32 v62, 0
  v_mov_b32 v63, 0
  v_mov_b32 v64, 0
  v_mov_b32 v65, 0
  v_mov_b32 v66, 0
  v_mov_b32 v67, 0
  s_mov_b32 s30, 0
  buffer_load_dword v76, v119, s[8:11], s20 offen sc1
  buffer_load_dword v77, v119, s[8:11], s20 offen sc1
  buffer_load_dword v78, v119, s[8:11], s20 offen sc1
cB_va3_fp_l:
  s_waitcnt vmcnt(2)
  v_cmp_eq_u32 vcc, -1, v76
  s_cbranch_vccz cB_va3_fp_d
  buffer_load_dword v76, v119, s[8:11], s20 offen sc1
  s_waitcnt vmcnt(2)
  v_cmp_eq_u32 vcc, -1, v77
  s_cbranch_vccz cB_va3_fp_d
  buffer_load_dword v77, v119, s[8:11], s20 offen sc1
  s_waitcnt vmcnt(2)
  v_cmp_eq_u32 vcc, -1, v78
  s_cbranch_vccz cB_va3_fp_d
  buffer_load_dword v78, v119, s[8:11], s20 offen sc1
  s_add_u32 s30, s30, 1
  s_cmp_lt_u32 s30, 400000
  s_cbranch_scc1 cB_va3_fp_l
  s_branch cB_abort
cB_va3_fp_d:
  buffer_load_dwordx4 v[24:27], v2, s[8:11], s23 offen offset:0 sc1
  buffer_load_dwordx4 v[28:31], v2, s[8:11], s23 offen offset:1024 sc1
  buffer_load_dwordx4 v[32:35], v2, s[8:11], s23 offen offset:2048 sc1
  s_barrier
cB_va3_ld:
  s_waitcnt vmcnt(0)
  v_max3_u32 v84, v24, v25, v26
  v_max3_u32 v84, v84, v27, v28
  v_max3_u32 v84, v84, v29, v30
  v_max3_u32 v84, v84, v31, v32
  v_max3_u32 v84, v84, v33, v34
  v_max_u32 v84, v84, v35
  v_cmp_eq_u32 vcc, -1, v84
  ds_write_b128 v2, v[24:27] offset:12288
  ds_write_b128 v2, v[28:31] offset:13312
  ds_write_b128 v2, v[32:35] offset:14336
  s_cbranch_vccnz cB_va3_retry
  s_waitcnt lgkmcnt(0)
  s_barrier
  ds_read_b128 v[8:11], v2 offset:8192
  ds_read_b128 v[12:15], v2 offset:9216
  ds_read_b128 v[16:19], v2 offset:10240
  ds_read_b128 v[20:23], v2 offset:11264
  s_waitcnt lgkmcnt(0)
  s_cmp_eq_u32 s19, 63
  s_cbranch_scc1 cB_done
  ds_read_b128 v[76:79], v1 offset:0
  ds_read_b128 v[80:83], v1 offset:1024
  ds_read_b128 v[84:87], v1 offset:2048
  ds_read_b128 v[88:91], v1 offset:3072
  ds_read_b128 v[92:95], v1 offset:4096
  ds_read_b128 v[96:99], v1 offset:5120
  v_smfmac_f32_16x16x64_bf16 v[60:63], v[8:11], v[200:207], v3
  v_smfmac_f32_16x16x64_bf16 v[60:63], v[12:15], v[208:215], v3
  s_waitcnt lgkmcnt(4)
  v_smfmac_f32_16x16x64_bf16 v[64:67], v[8:11], v[76:83], v3
  ds_read_b128 v[76:79], v1 offset:6144
  ds_read_b128 v[80:83], v1 offset:7168
  v_smfmac_f32_16x16x64_bf16 v[60:63], v[16:19], v[216:223], v3
  v_smfmac_f32_16x16x64_bf16 v[60:63], v[20:23], v[224:231], v3
  s_waitcnt lgkmcnt(4)
  v_smfmac_f32_16x16x64_bf16 v[64:67], v[12:15], v[84:91], v3
  ds_read_b128 v[84:87], v1 offset:8192
  ds_read_b128 v[88:91], v1 offset:9216
  v_smfmac_f32_16x16x64_bf16 v[60:63], v[24:27], v[232:239], v3
  v_smfmac_f32_16x16x64_bf16 v[60:63], v[28:31], v[240:247], v3
  s_waitcnt lgkmcnt(4)
  v_smfmac_f32_16x16x64_bf16 v[64:67], v[16:19], v[92:99], v3
  ds_read_b128 v[92:95], v1 offset:10240
  ds_read_b128 v[96:99], v1 offset:11264
  v_smfmac_f32_16x16x64_bf16 v[60:63], v[32:35], v[248:255], v3
  v_smfmac_f32_16x16x64_bf16 v[36:39], v[8:11], a[0:7], v3
  s_waitcnt lgkmcnt(4)
  v_smfmac_f32_16x16x64_bf16 v[64:67], v[20:23], v[76:83], v3
  ds_read_b128 v[76:79], v1 offset:12288
  ds_read_b128 v[80:83], v1 offset:13312
  v_smfmac_f32_16x16x64_bf16 v[36:39], v[12:15], a[8:15], v3
  v_smfmac_f32_16x16x64_bf16 v[36:39], v[16:19], a[16:23], v3
  s_waitcnt lgkmcnt(4)
  v_smfmac_f32_16x16x64_bf16 v[64:67], v[24:27], v[84:91], v3
  v_smfmac_f32_16x16x64_bf16 v[36:39], v[20:23], a[24:31], v3
  v_smfmac_f32_16x16x64_bf16 v[36:39], v[24:27], a[32:39], v3
  s_waitcnt lgkmcnt(2)
  v_smfmac_f32_16x16x64_bf16 v[64:67], v[28:31], v[92:99], v3
  v_smfmac_f32_16x16x64_bf16 v[36:39], v[28:31], a[40:47], v3
  v_smfmac_f32_16x16x64_bf16 v[36:39], v[32:35], a[48:55], v3
  s_waitcnt lgkmcnt(0)
  v_smfmac_f32_16x16x64_bf16 v[64:67], v[32:35], v[76:83], v3
  v_smfmac_f32_16x16x64_bf16 v[40:43], v[8:11], a[56:63], v3
  v_smfmac_f32_16x16x64_bf16 v[40:43], v[12:15], a[64:71], v3
  v_smfmac_f32_16x16x64_bf16 v[40:43], v[16:19], a[72:79], v3
  v_smfmac_f32_16x16x64_bf16 v[40:43], v[20:23], a[80:87], v3
  v_permlane32_swap_b32 v60, v64
  v_smfmac_f32_16x16x64_bf16 v[40:43], v[24:27], a[88:95], v3
  v_permlane32_swap_b32 v61, v65
  v_smfmac_f32_16x16x64_bf16 v[40:43], v[28:31], a[96:103], v3
  v_permlane32_swap_b32 v62, v66
  v_smfmac_f32_16x16x64_bf16 v[40:43], v[32:35], a[104:111], v3
  v_permlane32_swap_b32 v63, v67
  v_smfmac_f32_16x16x64_bf16 v[44:47], v[8:11], a[112:119], v3
  v_smfmac_f32_16x16x64_bf16 v[44:47], v[12:15], a[120:127], v3
  v_smfmac_f32_16x16x64_bf16 v[44:47], v[16:19], a[128:135], v3
  v_smfmac_f32_16x16x64_bf16 v[44:47], v[20:23], a[136:143], v3
  v_add_f32 v60, v60, v64
  v_add_f32 v61, v61, v65
  v_smfmac_f32_16x16x64_bf16 v[44:47], v[24:27], a[144:151], v3
  v_add_f32 v62, v62, v66
  v_add_f32 v63, v63, v67
  v_smfmac_f32_16x16x64_bf16 v[44:47], v[28:31], a[152:159], v3
  v_cvt_pk_bf16_f32 v64, v60, v61
  v_cvt_pk_bf16_f32 v65, v62, v63
  v_smfmac_f32_16x16x64_bf16 v[44:47], v[32:35], a[160:167], v3
  ds_write_b64 v115, v[64:65]
  v_smfmac_f32_16x16x64_bf16 v[48:51], v[8:11], a[168:175], v3
  v_permlane32_swap_b32 v36, v40
  v_smfmac_f32_16x16x64_bf16 v[48:51], v[12:15], a[176:183], v3
  v_permlane32_swap_b32 v37, v41
  v_smfmac_f32_16x16x64_bf16 v[48:51], v[16:19], a[184:191], v3
  v_permlane32_swap_b32 v38, v42
  v_smfmac_f32_16x16x64_bf16 v[48:51], v[20:23], a[192:199], v3
  v_permlane32_swap_b32 v39, v43
  v_smfmac_f32_16x16x64_bf16 v[48:51], v[24:27], a[200:207], v3
  v_add_f32 v36, v36, v40
  v_smfmac_f32_16x16x64_bf16 v[48:51], v[28:31], a[208:215], v3
  v_add_f32 v37, v37, v41
  v_smfmac_f32_16x16x64_bf16 v[48:51], v[32:35], a[216:223], v3
  v_add_f32 v38, v38, v42
  v_smfmac_f32_16x16x64_bf16 v[52:55], v[8:11], a[224:231], v3
  v_smfmac_f32_16x16x64_bf16 v[52:55], v[12:15], a[232:239], v3
  v_smfmac_f32_16x16x64_bf16 v[52:55], v[16:19], a[240:247], v3
  v_smfmac_f32_16x16x64_bf16 v[52:55], v[20:23], a[248:255], v3
  v_add_f32 v39, v39, v43
  v_cvt_pk_bf16_f32 v40, v36, v37
  v_smfmac_f32_16x16x64_bf16 v[52:55], v[24:27], v[120:127], v3
  v_cvt_pk_bf16_f32 v41, v38, v39
  v_smfmac_f32_16x16x64_bf16 v[52:55], v[28:31], v[128:135], v3
  ds_write_b64 v112, v[40:41]
  v_smfmac_f32_16x16x64_bf16 v[52:55], v[32:35], v[136:143], v3
  v_permlane32_swap_b32 v44, v48
  v_smfmac_f32_16x16x64_bf16 v[56:59], v[8:11], v[144:151], v3
  v_permlane32_swap_b32 v45, v49
  v_smfmac_f32_16x16x64_bf16 v[56:59], v[12:15], v[152:159], v3
  v_permlane32_swap_b32 v46, v50
  v_smfmac_f32_16x16x64_bf16 v[56:59], v[16:19], v[160:167], v3
  v_permlane32_swap_b32 v47, v51
  v_smfmac_f32_16x16x64_bf16 v[56:59], v[20:23], v[168:175], v3
  v_add_f32 v44, v44, v48
  v_smfmac_f32_16x16x64_bf16 v[56:59], v[24:27], v[176:183], v3
  v_add_f32 v45, v45, v49
  v_smfmac_f32_16x16x64_bf16 v[56:59], v[28:31], v[184:191], v3
  v_add_f32 v46, v46, v50
  v_smfmac_f32_16x16x64_bf16 v[56:59], v[32:35], v[192:199], v3
  v_add_f32 v47, v47, v51
  v_cvt_pk_bf16_f32 v48, v44, v45
  v_cvt_pk_bf16_f32 v49, v46, v47
  ds_write_b64 v113, v[48:49]
  s_nop 3
  v_permlane32_swap_b32 v52, v56
  v_permlane32_swap_b32 v53, v57
  v_permlane32_swap_b32 v54, v58
  v_permlane32_swap_b32 v55, v59
  v_add_f32 v52, v52, v56
  v_add_f32 v53, v53, v57
  v_add_f32 v54, v54, v58
  v_add_f32 v55, v55, v59
  v_cvt_pk_bf16_f32 v56, v52, v53
  v_cvt_pk_bf16_f32 v57, v54, v55
  ds_write_b64 v114, v[56:57]
  s_waitcnt lgkmcnt(0)
  s_barrier
  s_cmp_eq_u32 s19, 62
  s_cbranch_scc1 cB_done
  s_waitcnt vmcnt(0) lgkmcnt(0)
  s_add_u32 s19, s19, 1
  s_mov_b32 s20, s21
  s_branch cB_va3_loop
cB_va3_retry:
  s_waitcnt lgkmcnt(0)
  buffer_load_dwordx4 v[24:27], v2, s[8:11], s23 offen offset:0 sc1
  buffer_load_dwordx4 v[28:31], v2, s[8:11], s23 offen offset:1024 sc1
  buffer_load_dwordx4 v[32:35], v2, s[8:11], s23 offen offset:2048 sc1
  s_add_u32 s31, s31, 1
  s_add_u32 s30, s30, 1
  s_cmp_lt_u32 s30, 400000
  s_cbranch_scc1 cB_va3_ld
  s_branch cB_abort
cB_va3_last:
  s_waitcnt lgkmcnt(0)
  buffer_store_dwordx4 v[100:103], v2, s[8:11], s24 offen offset:0 sc1
  buffer_store_dwordx4 v[104:107], v2, s[8:11], s24 offen offset:1024 sc1
  buffer_store_dwordx4 v[108:111], v2, s[8:11], s24 offen offset:2048 sc1
  buffer_store_dwordx4 v[4:7], v2, s[8:11], s24 offen offset:3072 sc1
  s_add_u32 s24, s24, 8192
  s_waitcnt vmcnt(0)
  s_mov_b64 exec, 1
  buffer_store_dword v117, v2, s[8:11], s34 offen sc1
  s_mov_b64 exec, -1
  s_add_u32 s34, s34, 8
  s_mov_b64 exec, 1
  buffer_store_dword v117, v2, s[8:11], s34 offen sc1
  s_mov_b64 exec, -1
  s_add_u32 s34, s34, 8
  s_branch cB_done
cB_abort:
  v_mov_b32 v4, 0xdead
  v_mov_b32 v5, 16
  buffer_store_dword v4, v5, s[12:15], 0 offen
  s_branch ch_end
cB_done:
  s_branch ch_end
ch_worker:
  s_load_dwordx2 s[36:37], s[0:1], 112
  s_waitcnt lgkmcnt(0)
  s_mov_b32 s92, s36
  s_and_b32 s93, s37, 0xffff
  s_mov_b32 s94, 3670016
  s_mov_b32 s95, 0x20000
  s_mov_b32 s96, 0
  s_cmp_lg_u32 s16, 0
  s_cbranch_scc1 ask_2
  v_mov_b32 v250, 1
  v_mov_b32 v251, 88544640
  s_mov_b64 exec, 1
  buffer_atomic_add v250, v251, s[8:11], 0 offen sc0
  s_mov_b64 exec, -1
ask_2:
  s_branch wk_next
wk_loop:
  s_waitcnt vmcnt(0) lgkmcnt(0)
  s_cmp_eq_u32 s96, 1
  s_cbranch_scc1 wk_ask
  s_mov_b32 s96, 1
  s_mov_b32 s30, 0
  v_mov_b32 v36, 0
ch_chk:
  buffer_load_dword v37, v36, s[12:15], 0 offen sc1
  s_waitcnt vmcnt(0)
  v_readfirstlane_b32 s22, v37
  s_and_b32 s22, s22, 0xffff
  s_cmp_ge_u32 s22, 32
  s_cbranch_scc1 ch_go_end
  s_sleep 16
  s_add_u32 s30, s30, 1
  s_cmp_lt_u32 s30, 64
  s_cbranch_scc1 ch_chk
ch_go_end:
  v_mov_b32 v6, 160016
  v_mov_b32 v4, s22
  s_cmp_lg_u32 s16, 0
  s_cbranch_scc1 ch_dec
  ds_write_b32 v6, v4
  s_waitcnt lgkmcnt(0)
ch_dec:
  s_barrier
  ds_read_b32 v4, v6
  s_waitcnt lgkmcnt(0)
  v_readfirstlane_b32 s22, v4
  s_cmp_ge_u32 s22, 32
  s_cbranch_scc1 wk_ask
  v_mov_b32 v4, 0x10001
  s_mov_b32 s18, 0
  s_branch ch_take
wk_ask:
  v_readfirstlane_b32 s22, v250
  s_cmp_ge_u32 s22, 1104
  s_cbranch_scc1 wk_next
  s_cmp_lg_u32 s16, 0
  s_cbranch_scc1 ask_3
  v_mov_b32 v250, 1
  v_mov_b32 v251, 88544640
  s_mov_b64 exec, 1
  buffer_atomic_add v250, v251, s[8:11], 0 offen sc0
  s_mov_b64 exec, -1
ask_3:
wk_next:
  v_mov_b32 v6, 160000
  s_waitcnt vmcnt(0)
  s_barrier
  s_cmp_lg_u32 s16, 0
  s_cbranch_scc1 wk_n1
  s_mov_b64 exec, 1
  ds_write_b32 v6, v250
  s_mov_b64 exec, -1
  s_waitcnt lgkmcnt(0)
wk_n1:
  s_barrier
  ds_read_b32 v4, v6
  s_waitcnt lgkmcnt(0)
  v_readfirstlane_b32 s3, v4
wk_have:
  s_cmp_ge_u32 s3, 1104
  s_cbranch_scc1 wk_done
  v_mov_b32 v250, 0
  v_mov_b32 v251, 88544640
  v_and_b32 v1, 63, v0
  v_lshlrev_b32 v2, 4, v1
  v_lshrrev_b32 v3, 4, v1
  v_and_b32 v4, 15, v1
  s_cmp_ge_u32 s3, 592
  s_cbranch_scc1 wk_tok
  s_cmp_ge_u32 s3, 480
  s_cbranch_scc1 wk_s4d
  s_cmp_ge_u32 s3, 256
  s_cbranch_scc1 wk_full
  s_cmp_ge_u32 s3, 224
  s_cbranch_scc1 wk_srv
  s_cmp_ge_u32 s3, 112
  s_cselect_b32 s18, 1, 0
  s_cselect_b32 s20, 112, 0
  s_sub_u32 s20, s3, s20
  s_and_b32 s17, s20, 15
  s_add_u32 s17, s17, 16
  s_lshr_b32 s34, s20, 4
  s_lshl_b32 s34, s34, 1
  s_add_u32 s35, s34, 2
  s_branch wk_gemm
wk_full:
  s_sub_u32 s20, s3, 224
  s_and_b32 s17, s20, 15
  s_lshr_b32 s18, s20, 4
  s_cmp_lt_u32 s18, 8
  s_cselect_b32 s21, 16, 0
  s_add_u32 s17, s17, s21
  s_and_b32 s18, s18, 7
  s_mov_b32 s34, 0
  s_mov_b32 s35, 14
wk_gemm:
  s_lshl_b32 s20, s18, 4
  s_lshl_b32 s21, s16, 2
  s_add_u32 s20, s20, s21
  s_mul_i32 s21, s20, 14336
  s_add_u32 s21, s21, 71565312
  s_add_u32 s22, s21, 0
  buffer_load_dwordx4 a[0:3], v2, s[8:11], s22 offen offset:0
  buffer_load_dwordx4 a[4:7], v2, s[8:11], s22 offen offset:1024
  buffer_load_dwordx4 a[8:11], v2, s[8:11], s22 offen offset:2048
  buffer_load_dwordx4 a[12:15], v2, s[8:11], s22 offen offset:3072
  s_add_u32 s22, s21, 4096
  buffer_load_dwordx4 a[16:19], v2, s[8:11], s22 offen offset:0
  buffer_load_dwordx4 a[20:23], v2, s[8:11], s22 offen offset:1024
  buffer_load_dwordx4 a[24:27], v2, s[8:11], s22 offen offset:2048
  buffer_load_dwordx4 a[28:31], v2, s[8:11], s22 offen offset:3072
  s_add_u32 s22, s21, 8192
  buffer_load_dwordx4 a[32:35], v2, s[8:11], s22 offen offset:0
  buffer_load_dwordx4 a[36:39], v2, s[8:11], s22 offen offset:1024
  buffer_load_dwordx4 a[40:43], v2, s[8:11], s22 offen offset:2048
  buffer_load_dwordx4 a[44:47], v2, s[8:11], s22 offen offset:3072
  s_add_u32 s22, s21, 12288
  buffer_load_dwordx4 a[48:51], v2, s[8:11], s22 offen offset:0
  buffer_load_dwordx4 a[52:55], v2, s[8:11], s22 offen offset:1024
  buffer_load_dwordx4 a[56:59], v2, s[8:11], s22 offen offset:2048
  buffer_load_dwordx4 a[60:63], v2, s[8:11], s22 offen offset:3072
  s_add_u32 s22, s21, 16384
  buffer_load_dwordx4 a[64:67], v2, s[8:11], s22 offen offset:0
  buffer_load_dwordx4 a[68:71], v2, s[8:11], s22 offen offset:1024
  buffer_load_dwordx4 a[72:75], v2, s[8:11], s22 offen offset:2048
  buffer_load_dwordx4 a[76:79], v2, s[8:11], s22 offen offset:3072
  s_add_u32 s22, s21, 20480
  buffer_load_dwordx4 a[80:83], v2, s[8:11], s22 offen offset:0
  buffer_load_dwordx4 a[84:87], v2, s[8:11], s22 offen offset:1024
  buffer_load_dwordx4 a[88:91], v2, s[8:11], s22 offen offset:2048
  buffer_load_dwordx4 a[92:95], v2, s[8:11], s22 offen offset:3072
  s_add_u32 s22, s21, 24576
  buffer_load_dwordx4 a[96:99], v2, s[8:11], s22 offen offset:0
  buffer_load_dwordx4 a[100:103], v2, s[8:11], s22 offen offset:1024
  buffer_load_dwordx4 a[104:107], v2, s[8:11], s22 offen offset:2048
  buffer_load_dwordx4 a[108:111], v2, s[8:11], s22 offen offset:3072
  s_add_u32 s22, s21, 28672
  buffer_load_dwordx4 a[112:115], v2, s[8:11], s22 offen offset:0
  buffer_load_dwordx4 a[116:119], v2, s[8:11], s22 offen offset:1024
  buffer_load_dwordx4 a[120:123], v2, s[8:11], s22 offen offset:2048
  buffer_load_dwordx4 a[124:127], v2, s[8:11], s22 offen offset:3072
  s_add_u32 s22, s21, 32768
  buffer_load_dwordx4 a[128:131], v2, s[8:11], s22 offen offset:0
  buffer_load_dwordx4 a[132:135], v2, s[8:11], s22 offen offset:1024
  buffer_load_dwordx4 a[136:139], v2, s[8:11], s22 offen offset:2048
  buffer_load_dwordx4 a[140:143], v2, s[8:11], s22 offen offset:3072
  s_add_u32 s22, s21, 36864
  buffer_load_dwordx4 a[144:147], v2, s[8:11], s22 offen offset:0
  buffer_load_dwordx4 a[148:151], v2, s[8:11], s22 offen offset:1024
  buffer_load_dwordx4 a[152:155], v2, s[8:11], s22 offen offset:2048
  buffer_load_dwordx4 a[156:159], v2, s[8:11], s22 offen offset:3072
  s_add_u32 s22, s21, 40960
  buffer_load_dwordx4 a[160:163], v2, s[8:11], s22 offen offset:0
  buffer_load_dwordx4 a[164:167], v2, s[8:11], s22 offen offset:1024
  buffer_load_dwordx4 a[168:171], v2, s[8:11], s22 offen offset:2048
  buffer_load_dwordx4 a[172:175], v2, s[8:11], s22 offen offset:3072
  s_add_u32 s22, s21, 45056
  buffer_load_dwordx4 a[176:179], v2, s[8:11], s22 offen offset:0
  buffer_load_dwordx4 a[180:183], v2, s[8:11], s22 offen offset:1024
  buffer_load_dwordx4 a[184:187], v2, s[8:11], s22 offen offset:2048
  buffer_load_dwordx4 a[188:191], v2, s[8:11], s22 offen offset:3072
  s_add_u32 s22, s21, 49152
  buffer_load_dwordx4 a[192:195], v2, s[8:11], s22 offen offset:0
  buffer_load_dwordx4 a[196:199], v2, s[8:11], s22 offen offset:1024
  buffer_load_dwordx4 a[200:203], v2, s[8:11], s22 offen offset:2048
  buffer_load_dwordx4 a[204:207], v2, s[8:11], s22 offen offset:3072
  s_add_u32 s22, s21, 53248
  buffer_load_dwordx4 a[208:211], v2, s[8:11], s22 offen offset:0
  buffer_load_dwordx4 a[212:215], v2, s[8:11], s22 offen offset:1024
  buffer_load_dwordx4 a[216:219], v2, s[8:11], s22 offen offset:2048
  buffer_load_dwordx4 a[220:223], v2, s[8:11], s22 offen offset:3072
  s_waitcnt vmcnt(40)
  s_mul_i32 s23, s17, 401408
  s_and_b32 s22, s16, 1
  s_mul_i32 s22, s22, 7168
  s_add_u32 s23, s23, s22
  s_add_u32 s23, s23, 0
  s_lshr_b32 s22, s16, 1
  s_mul_i32 s22, s22, 14336
  s_add_u32 s23, s23, s22
  s_mul_i32 s27, s16, 7168
  s_lshr_b32 s28, s20, 1
  s_cmp_lt_u32 s17, 16
  s_cbranch_scc0 wg_vo
  s_add_u32 s23, s23, s22
  s_lshl_b32 s29, s28, 4
  s_add_u32 s29, s29, s17
  s_mul_i32 s29, s29, 28672
  s_add_u32 s29, s29, 12845056
  s_mov_b32 s31, 0
  s_lshr_b32 s24, s34, 1
  s_lshl_b32 s24, s24, 2
  s_and_b32 s25, s34, 1
  s_add_u32 s24, s24, s25
  s_mul_i32 s24, s24, 14336
  s_add_u32 s24, s24, s23
  s_add_u32 m0, s31, s27
  s_nop 0
  buffer_load_dwordx4 v2, s[8:11], s24 offen offset:0  lds
  buffer_load_dwordx4 v2, s[8:11], s24 offen offset:1024  lds
  buffer_load_dwordx4 v2, s[8:11], s24 offen offset:2048  lds
  buffer_load_dwordx4 v2, s[8:11], s24 offen offset:3072  lds
  s_add_u32 m0, m0, 4096
  s_add_u32 s24, s24, 4096
  buffer_load_dwordx4 v2, s[8:11], s24 offen offset:0  lds
  buffer_load_dwordx4 v2, s[8:11], s24 offen offset:1024  lds
  buffer_load_dwordx4 v2, s[8:11], s24 offen offset:2048  lds
  s_add_u32 s30, s34, 1
  s_mov_b32 s31, 28672
  s_lshr_b32 s24, s30, 1
  s_lshl_b32 s24, s24, 2
  s_and_b32 s25, s30, 1
  s_add_u32 s24, s24, s25
  s_mul_i32 s24, s24, 14336
  s_add_u32 s24, s24, s23
  s_add_u32 m0, s31, s27
  s_nop 0
  buffer_load_dwordx4 v2, s[8:11], s24 offen offset:0  lds
  buffer_load_dwordx4 v2, s[8:11], s24 offen offset:1024  lds
  buffer_load_dwordx4 v2, s[8:11], s24 offen offset:2048  lds
  buffer_load_dwordx4 v2, s[8:11], s24 offen offset:3072  lds
  s_add_u32 m0, m0, 4096
  s_add_u32 s24, s24, 4096
  buffer_load_dwordx4 v2, s[8:11], s24 offen offset:0  lds
  buffer_load_dwordx4 v2, s[8:11], s24 offen offset:1024  lds
  buffer_load_dwordx4 v2, s[8:11], s24 offen offset:2048  lds
  s_mov_b32 s19, s34
  s_mov_b32 s32, 0
  s_mov_b32 s33, 57344
  s_waitcnt vmcnt(7)
  s_branch wg_f_in
wg_f_loop:
  s_waitcnt vmcnt(11)
wg_f_in:
  s_barrier
  s_add_u32 s30, s19, 2
  s_min_u32 s30, s30, 13
  s_lshr_b32 s24, s30, 1
  s_lshl_b32 s24, s24, 2
  s_and_b32 s25, s30, 1
  s_add_u32 s24, s24, s25
  s_mul_i32 s24, s24, 14336
  s_add_u32 s24, s24, s23
  s_add_u32 m0, s33, s27
  s_nop 0
  buffer_load_dwordx4 v2, s[8:11], s24 offen offset:0  lds
  buffer_load_dwordx4 v2, s[8:11], s24 offen offset:1024  lds
  buffer_load_dwordx4 v2, s[8:11], s24 offen offset:2048  lds
  buffer_load_dwordx4 v2, s[8:11], s24 offen offset:3072  lds
  s_add_u32 m0, m0, 4096
  s_add_u32 s24, s24, 4096
  buffer_load_dwordx4 v2, s[8:11], s24 offen offset:0  lds
  buffer_load_dwordx4 v2, s[8:11], s24 offen offset:1024  lds
  buffer_load_dwordx4 v2, s[8:11], s24 offen offset:2048  lds
  v_add_u32 v5, s32, v2
  ds_read_b128 v[8:11], v5 offset:0
  ds_read_b128 v[12:15], v5 offset:14336
  ds_read_b128 v[16:19], v5 offset:1024
  ds_read_b128 v[20:23], v5 offset:15360
  ds_read_b128 v[24:27], v5 offset:2048
  ds_read_b128 v[28:31], v5 offset:16384
  ds_read_b128 v[32:35], v5 offset:3072
  s_waitcnt lgkmcnt(6)
  v_mfma_f32_16x16x32_bf16 v[40:43], v[8:11], a[0:3], 0
  v_mfma_f32_16x16x32_bf16 v[44:47], v[8:11], a[56:59], 0
  v_mfma_f32_16x16x32_bf16 v[48:51], v[8:11], a[112:115], 0
  v_mfma_f32_16x16x32_bf16 v[52:55], v[8:11], a[168:171], 0
  ds_read_b128 v[36:39], v5 offset:17408
  s_waitcnt lgkmcnt(6)
  v_mfma_f32_16x16x32_bf16 v[56:59], v[12:15], a[0:3], 0
  v_mfma_f32_16x16x32_bf16 v[60:63], v[12:15], a[56:59], 0
  v_mfma_f32_16x16x32_bf16 v[64:67], v[12:15], a[112:115], 0
  v_mfma_f32_16x16x32_bf16 v[68:71], v[12:15], a[168:171], 0
  ds_read_b128 v[8:11], v5 offset:4096
  s_waitcnt lgkmcnt(6)
  v_mfma_f32_16x16x32_bf16 v[40:43], v[16:19], a[4:7], v[40:43]
  v_mfma_f32_16x16x32_bf16 v[44:47], v[16:19], a[60:63], v[44:47]
  v_mfma_f32_16x16x32_bf16 v[48:51], v[16:19], a[116:119], v[48:51]
  v_mfma_f32_16x16x32_bf16 v[52:55], v[16:19], a[172:175], v[52:55]
  ds_read_b128 v[12:15], v5 offset:18432
  s_waitcnt lgkmcnt(6)
  v_mfma_f32_16x16x32_bf16 v[56:59], v[20:23], a[4:7], v[56:59]
  v_mfma_f32_16x16x32_bf16 v[60:63], v[20:23], a[60:63], v[60:63]
  v_mfma_f32_16x16x32_bf16 v[64:67], v[20:23], a[116:119], v[64:67]
  v_mfma_f32_16x16x32_bf16 v[68:71], v[20:23], a[172:175], v[68:71]
  ds_read_b128 v[16:19], v5 offset:5120
  s_waitcnt lgkmcnt(6)
  v_mfma_f32_16x16x32_bf16 v[40:43], v[24:27], a[8:11], v[40:43]
  v_mfma_f32_16x16x32_bf16 v[44:47], v[24:27], a[64:67], v[44:47]
  v_mfma_f32_16x16x32_bf16 v[48:51], v[24:27], a[120:123], v[48:51]
  v_mfma_f32_16x16x32_bf16 v[52:55], v[24:27], a[176:179], v[52:55]
  ds_read_b128 v[20:23], v5 offset:19456
  s_waitcnt lgkmcnt(6)
  v_mfma_f32_16x16x32_bf16 v[56:59], v[28:31], a[8:11], v[56:59]
  v_mfma_f32_16x16x32_bf16 v[60:63], v[28:31], a[64:67], v[60:63]
  v_mfma_f32_16x16x32_bf16 v[64:67], v[28:31], a[120:123], v[64:67]
  v_mfma_f32_16x16x32_bf16 v[68:71], v[28:31], a[176:179], v[68:71]
  ds_read_b128 v[24:27], v5 offset:6144
  s_waitcnt lgkmcnt(6)
  v_mfma_f32_16x16x32_bf16 v[40:43], v[32:35], a[12:15], v[40:43]
  v_mfma_f32_16x16x32_bf16 v[44:47], v[32:35], a[68:71], v[44:47]
  v_mfma_f32_16x16x32_bf16 v[48:51], v[32:35], a[124:127], v[48:51]
  v_mfma_f32_16x16x32_bf16 v[52:55], v[32:35], a[180:183], v[52:55]
  ds_read_b128 v[28:31], v5 offset:20480
  s_waitcnt lgkmcnt(6)
  v_mfma_f32_16x16x32_bf16 v[56:59], v[36:39], a[12:15], v[56:59]
  v_mfma_f32_16x16x32_bf16 v[60:63], v[36:39], a[68:71], v[60:63]
  v_mfma_f32_16x16x32_bf16 v[64:67], v[36:39], a[124:127], v[64:67]
  v_mfma_f32_16x16x32_bf16 v[68:71], v[36:39], a[180:183], v[68:71]
  ds_read_b128 v[32:35], v5 offset:7168
  s_waitcnt lgkmcnt(6)
  v_mfma_f32_16x16x32_bf16 v[40:43], v[8:11], a[16:19], v[40:43]
  v_mfma_f32_16x16x32_bf16 v[44:47], v[8:11], a[72:75], v[44:47]
  v_mfma_f32_16x16x32_bf16 v[48:51], v[8:11], a[128:131], v[48:51]
  v_mfma_f32_16x16x32_bf16 v[52:55], v[8:11], a[184:187], v[52:55]
  ds_read_b128 v[36:39], v5 offset:21504
  s_waitcnt lgkmcnt(6)
  v_mfma_f32_16x16x32_bf16 v[56:59], v[12:15], a[16:19], v[56:59]
  v_mfma_f32_16x16x32_bf16 v[60:63], v[12:15], a[72:75], v[60:63]
  v_mfma_f32_16x16x32_bf16 v[64:67], v[12:15], a[128:131], v[64:67]
  v_mfma_f32_16x16x32_bf16 v[68:71], v[12:15], a[184:187], v[68:71]
  ds_read_b128 v[8:11], v5 offset:8192
  s_waitcnt lgkmcnt(6)
  v_mfma_f32_16x16x32_bf16 v[40:43], v[16:19], a[20:23], v[40:43]
  v_mfma_f32_16x16x32_bf16 v[44:47], v[16:19], a[76:79], v[44:47]
  v_mfma_f32_16x16x32_bf16 v[48:51], v[16:19], a[132:135], v[48:51]
  v_mfma_f32_16x16x32_bf16 v[52:55], v[16:19], a[188:191], v[52:55]
  ds_read_b128 v[12:15], v5 offset:22528
  s_waitcnt lgkmcnt(6)
  v_mfma_f32_16x16x32_bf16 v[56:59], v[20:23], a[20:23], v[56:59]
  v_mfma_f32_16x16x32_bf16 v[60:63], v[20:23], a[76:79], v[60:63]
  v_mfma_f32_16x16x32_bf16 v[64:67], v[20:23], a[132:135], v[64:67]
  v_mfma_f32_16x16x32_bf16 v[68:71], v[20:23], a[188:191], v[68:71]
  ds_read_b128 v[16:19], v5 offset:9216
  s_waitcnt lgkmcnt(6)
  v_mfma_f32_16x16x32_bf16 v[40:43], v[24:27], a[24:27], v[40:43]
  v_mfma_f32_16x16x32_bf16 v[44:47], v[24:27], a[80:83], v[44:47]
  v_mfma_f32_16x16x32_bf16 v[48:51], v[24:27], a[136:139], v[48:51]
  v_mfma_f32_16x16x32_bf16 v[52:55], v[24:27], a[192:195], v[52:55]
  ds_read_b128 v[20:23], v5 offset:23552
  s_waitcnt lgkmcnt(6)
  v_mfma_f32_16x16x32_bf16 v[56:59], v[28:31], a[24:27], v[56:59]
  v_mfma_f32_16x16x32_bf16 v[60:63], v[28:31], a[80:83], v[60:63]
  v_mfma_f32_16x16x32_bf16 v[64:67], v[28:31], a[136:139], v[64:67]
  v_mfma_f32_16x16x32_bf16 v[68:71], v[28:31], a[192:195], v[68:71]
  ds_read_b128 v[24:27], v5 offset:10240
  s_waitcnt lgkmcnt(6)
  v_mfma_f32_16x16x32_bf16 v[40:43], v[32:35], a[28:31], v[40:43]
  v_mfma_f32_16x16x32_bf16 v[44:47], v[32:35], a[84:87], v[44:47]
  v_mfma_f32_16x16x32_bf16 v[48:51], v[32:35], a[140:143], v[48:51]
  v_mfma_f32_16x16x32_bf16 v[52:55], v[32:35], a[196:199], v[52:55]
  ds_read_b128 v[28:31], v5 offset:24576
  s_waitcnt lgkmcnt(6)
  v_mfma_f32_16x16x32_bf16 v[56:59], v[36:39], a[28:31], v[56:59]
  v_mfma_f32_16x16x32_bf16 v[60:63], v[36:39], a[84:87], v[60:63]
  v_mfma_f32_16x16x32_bf16 v[64:67], v[36:39], a[140:143], v[64:67]
  v_mfma_f32_16x16x32_bf16 v[68:71], v[36:39], a[196:199], v[68:71]
  ds_read_b128 v[32:35], v5 offset:11264
  s_waitcnt lgkmcnt(6)
  v_mfma_f32_16x16x32_bf16 v[40:43], v[8:11], a[32:35], v[40:43]
  v_mfma_f32_16x16x32_bf16 v[44:47], v[8:11], a[88:91], v[44:47]
  v_mfma_f32_16x16x32_bf16 v[48:51], v[8:11], a[144:147], v[48:51]
  v_mfma_f32_16x16x32_bf16 v[52:55], v[8:11], a[200:203], v[52:55]
  ds_read_b128 v[36:39], v5 offset:25600
  s_waitcnt lgkmcnt(6)
  v_mfma_f32_16x16x32_bf16 v[56:59], v[12:15], a[32:35], v[56:59]
  v_mfma_f32_16x16x32_bf16 v[60:63], v[12:15], a[88:91], v[60:63]
  v_mfma_f32_16x16x32_bf16 v[64:67], v[12:15], a[144:147], v[64:67]
  v_mfma_f32_16x16x32_bf16 v[68:71], v[12:15], a[200:203], v[68:71]
  ds_read_b128 v[8:11], v5 offset:12288
  s_waitcnt lgkmcnt(6)
  v_mfma_f32_16x16x32_bf16 v[40:43], v[16:19], a[36:39], v[40:43]
  v_mfma_f32_16x16x32_bf16 v[44:47], v[16:19], a[92:95], v[44:47]
  v_mfma_f32_16x16x32_bf16 v[48:51], v[16:19], a[148:151], v[48:51]
  v_mfma_f32_16x16x32_bf16 v[52:55], v[16:19], a[204:207], v[52:55]
  ds_read_b128 v[12:15], v5 offset:26624
  s_waitcnt lgkmcnt(6)
  v_mfma_f32_16x16x32_bf16 v[56:59], v[20:23], a[36:39], v[56:59]
  v_mfma_f32_16x16x32_bf16 v[60:63], v[20:23], a[92:95], v[60:63]
  v_mfma_f32_16x16x32_bf16 v[64:67], v[20:23], a[148:151], v[64:67]
  v_mfma_f32_16x16x32_bf16 v[68:71], v[20:23], a[204:207], v[68:71]
  ds_read_b128 v[16:19], v5 offset:13312
  s_waitcnt lgkmcnt(6)
  v_mfma_f32_16x16x32_bf16 v[40:43], v[24:27], a[40:43], v[40:43]
  v_mfma_f32_16x16x32_bf16 v[44:47], v[24:27], a[96:99], v[44:47]
  v_mfma_f32_16x16x32_bf16 v[48:51], v[24:27], a[152:155], v[48:51]
  v_mfma_f32_16x16x32_bf16 v[52:55], v[24:27], a[208:211], v[52:55]
  ds_read_b128 v[20:23], v5 offset:27648
  s_waitcnt lgkmcnt(6)
  v_mfma_f32_16x16x32_bf16 v[56:59], v[28:31], a[40:43], v[56:59]
  v_mfma_f32_16x16x32_bf16 v[60:63], v[28:31], a[96:99], v[60:63]
  v_mfma_f32_16x16x32_bf16 v[64:67], v[28:31], a[152:155], v[64:67]
  v_mfma_f32_16x16x32_bf16 v[68:71], v[28:31], a[208:211], v[68:71]
  s_waitcnt lgkmcnt(5)
  v_mfma_f32_16x16x32_bf16 v[40:43], v[32:35], a[44:47], v[40:43]
  v_mfma_f32_16x16x32_bf16 v[44:47], v[32:35], a[100:103], v[44:47]
  v_mfma_f32_16x16x32_bf16 v[48:51], v[32:35], a[156:159], v[48:51]
  v_mfma_f32_16x16x32_bf16 v[52:55], v[32:35], a[212:215], v[52:55]
  s_waitcnt lgkmcnt(4)
  v_mfma_f32_16x16x32_bf16 v[56:59], v[36:39], a[44:47], v[56:59]
  v_mfma_f32_16x16x32_bf16 v[60:63], v[36:39], a[100:103], v[60:63]
  v_mfma_f32_16x16x32_bf16 v[64:67], v[36:39], a[156:159], v[64:67]
  v_mfma_f32_16x16x32_bf16 v[68:71], v[36:39], a[212:215], v[68:71]
  s_waitcnt lgkmcnt(3)
  v_mfma_f32_16x16x32_bf16 v[40:43], v[8:11], a[48:51], v[40:43]
  v_mfma_f32_16x16x32_bf16 v[44:47], v[8:11], a[104:107], v[44:47]
  v_mfma_f32_16x16x32_bf16 v[48:51], v[8:11], a[160:163], v[48:51]
  v_mfma_f32_16x16x32_bf16 v[52:55], v[8:11], a[216:219], v[52:55]
  s_waitcnt lgkmcnt(2)
  v_mfma_f32_16x16x32_bf16 v[56:59], v[12:15], a[48:51], v[56:59]
  v_mfma_f32_16x16x32_bf16 v[60:63], v[12:15], a[104:107], v[60:63]
  v_mfma_f32_16x16x32_bf16 v[64:67], v[12:15], a[160:163], v[64:67]
  v_mfma_f32_16x16x32_bf16 v[68:71], v[12:15], a[216:219], v[68:71]
  s_waitcnt lgkmcnt(1)
  v_mfma_f32_16x16x32_bf16 v[40:43], v[16:19], a[52:55], v[40:43]
  v_mfma_f32_16x16x32_bf16 v[44:47], v[16:19], a[108:111], v[44:47]
  v_mfma_f32_16x16x32_bf16 v[48:51], v[16:19], a[164:167], v[48:51]
  v_mfma_f32_16x16x32_bf16 v[52:55], v[16:19], a[220:223], v[52:55]
  s_waitcnt lgkmcnt(0)
  v_mfma_f32_16x16x32_bf16 v[56:59], v[20:23], a[52:55], v[56:59]
  v_mfma_f32_16x16x32_bf16 v[60:63], v[20:23], a[108:111], v[60:63]
  v_mfma_f32_16x16x32_bf16 v[64:67], v[20:23], a[164:167], v[64:67]
  v_mfma_f32_16x16x32_bf16 v[68:71], v[20:23], a[220:223], v[68:71]
  s_lshl_b32 s24, s19, 10
  s_add_u32 s24, s24, s29
  v_cvt_pk_bf16_f32 v72, v40, v41
  v_cvt_pk_bf16_f32 v73, v42, v43
  v_cvt_pk_bf16_f32 v74, v56, v57
  v_cvt_pk_bf16_f32 v75, v58, v59
  s_add_u32 s25, s24, 0
  buffer_store_dwordx4 v[72:75], v2, s[8:11], s25 offen sc1
  v_cvt_pk_bf16_f32 v76, v44, v45
  v_cvt_pk_bf16_f32 v77, v46, v47
  v_cvt_pk_bf16_f32 v78, v60, v61
  v_cvt_pk_bf16_f32 v79, v62, v63
  s_add_u32 s25, s24, 14336
  buffer_store_dwordx4 v[76:79], v2, s[8:11], s25 offen sc1
  v_cvt_pk_bf16_f32 v80, v48, v49
  v_cvt_pk_bf16_f32 v81, v50, v51
  v_cvt_pk_bf16_f32 v82, v64, v65
  v_cvt_pk_bf16_f32 v83, v66, v67
  s_add_u32 s25, s24, 458752
  buffer_store_dwordx4 v[80:83], v2, s[8:11], s25 offen sc1
  v_cvt_pk_bf16_f32 v84, v52, v53
  v_cvt_pk_bf16_f32 v85, v54, v55
  v_cvt_pk_bf16_f32 v86, v68, v69
  v_cvt_pk_bf16_f32 v87, v70, v71
  s_add_u32 s25, s24, 473088
  buffer_store_dwordx4 v[84:87], v2, s[8:11], s25 offen sc1
  s_mov_b32 s33, s32
  s_add_u32 s32, s32, 28672
  s_cmp_eq_u32 s32, 86016
  s_cselect_b32 s32, 0, s32
  s_add_u32 s19, s19, 1
  s_cmp_lt_u32 s19, s35
  s_cbranch_scc1 wg_f_loop
  s_branch wg_done
wg_vo:
  s_sub_u32 s29, s17, 16
  s_lshl_b32 s29, s29, 6
  s_add_u32 s29, s29, s28
  s_mul_i32 s29, s29, 28672
  s_add_u32 s29, s29, 42205184
  v_mul_u32_u24 v6, 28, v3
  s_mov_b32 s31, 0
  s_lshl_b32 s24, s34, 1
  s_mul_i32 s24, s24, 14336
  s_add_u32 s24, s24, s23
  s_add_u32 m0, s31, s27
  s_nop 0
  buffer_load_dwordx4 v2, s[8:11], s24 offen offset:0  lds
  buffer_load_dwordx4 v2, s[8:11], s24 offen offset:1024  lds
  buffer_load_dwordx4 v2, s[8:11], s24 offen offset:2048  lds
  buffer_load_dwordx4 v2, s[8:11], s24 offen offset:3072  lds
  s_add_u32 m0, m0, 4096
  s_add_u32 s24, s24, 4096
  buffer_load_dwordx4 v2, s[8:11], s24 offen offset:0  lds
  buffer_load_dwordx4 v2, s[8:11], s24 offen offset:1024  lds
  buffer_load_dwordx4 v2, s[8:11], s24 offen offset:2048  lds
  s_add_u32 s30, s34, 1
  s_mov_b32 s31, 28672
  s_lshl_b32 s24, s30, 1
  s_mul_i32 s24, s24, 14336
  s_add_u32 s24, s24, s23
  s_add_u32 m0, s31, s27
  s_nop 0
  buffer_load_dwordx4 v2, s[8:11], s24 offen offset:0  lds
  buffer_load_dwordx4 v2, s[8:11], s24 offen offset:1024  lds
  buffer_load_dwordx4 v2, s[8:11], s24 offen offset:2048  lds
  buffer_load_dwordx4 v2, s[8:11], s24 offen offset:3072  lds
  s_add_u32 m0, m0, 4096
  s_add_u32 s24, s24, 4096
  buffer_load_dwordx4 v2, s[8:11], s24 offen offset:0  lds
  buffer_load_dwordx4 v2, s[8:11], s24 offen offset:1024  lds
  buffer_load_dwordx4 v2, s[8:11], s24 offen offset:2048  lds
  s_mov_b32 s19, s34
  s_mov_b32 s32, 0
  s_mov_b32 s33, 57344
  s_waitcnt vmcnt(7)
  s_branch wg_vo_in
wg_vo_loop:
  s_waitcnt vmcnt(11)
wg_vo_in:
  s_barrier
  s_add_u32 s30, s19, 2
  s_min_u32 s30, s30, 13
  s_lshl_b32 s24, s30, 1
  s_mul_i32 s24, s24, 14336
  s_add_u32 s24, s24, s23
  s_add_u32 m0, s33, s27
  s_nop 0
  buffer_load_dwordx4 v2, s[8:11], s24 offen offset:0  lds
  buffer_load_dwordx4 v2, s[8:11], s24 offen offset:1024  lds
  buffer_load_dwordx4 v2, s[8:11], s24 offen offset:2048  lds
  buffer_load_dwordx4 v2, s[8:11], s24 offen offset:3072  lds
  s_add_u32 m0, m0, 4096
  s_add_u32 s24, s24, 4096
  buffer_load_dwordx4 v2, s[8:11], s24 offen offset:0  lds
  buffer_load_dwordx4 v2, s[8:11], s24 offen offset:1024  lds
  buffer_load_dwordx4 v2, s[8:11], s24 offen offset:2048  lds
  v_add_u32 v5, s32, v2
  ds_read_b128 v[8:11], v5 offset:0
  ds_read_b128 v[12:15], v5 offset:14336
  ds_read_b128 v[16:19], v5 offset:1024
  ds_read_b128 v[20:23], v5 offset:15360
  ds_read_b128 v[24:27], v5 offset:2048
  ds_read_b128 v[28:31], v5 offset:16384
  ds_read_b128 v[32:35], v5 offset:3072
  s_waitcnt lgkmcnt(6)
  v_mfma_f32_16x16x32_bf16 v[40:43], a[0:3], v[8:11], 0
  v_mfma_f32_16x16x32_bf16 v[44:47], a[56:59], v[8:11], 0
  v_mfma_f32_16x16x32_bf16 v[48:51], a[112:115], v[8:11], 0
  v_mfma_f32_16x16x32_bf16 v[52:55], a[168:171], v[8:11], 0
  ds_read_b128 v[36:39], v5 offset:17408
  s_waitcnt lgkmcnt(6)
  v_mfma_f32_16x16x32_bf16 v[56:59], a[0:3], v[12:15], 0
  v_mfma_f32_16x16x32_bf16 v[60:63], a[56:59], v[12:15], 0
  v_mfma_f32_16x16x32_bf16 v[64:67], a[112:115], v[12:15], 0
  v_mfma_f32_16x16x32_bf16 v[68:71], a[168:171], v[12:15], 0
  ds_read_b128 v[8:11], v5 offset:4096
  s_waitcnt lgkmcnt(6)
  v_mfma_f32_16x16x32_bf16 v[40:43], a[4:7], v[16:19], v[40:43]
  v_mfma_f32_16x16x32_bf16 v[44:47], a[60:63], v[16:19], v[44:47]
  v_mfma_f32_16x16x32_bf16 v[48:51], a[116:119], v[16:19], v[48:51]
  v_mfma_f32_16x16x32_bf16 v[52:55], a[172:175], v[16:19], v[52:55]
  ds_read_b128 v[12:15], v5 offset:18432
  s_waitcnt lgkmcnt(6)
  v_mfma_f32_16x16x32_bf16 v[56:59], a[4:7], v[20:23], v[56:59]
  v_mfma_f32_16x16x32_bf16 v[60:63], a[60:63], v[20:23], v[60:63]
  v_mfma_f32_16x16x32_bf16 v[64:67], a[116:119], v[20:23], v[64:67]
  v_mfma_f32_16x16x32_bf16 v[68:71], a[172:175], v[20:23], v[68:71]
  ds_read_b128 v[16:19], v5 offset:5120
  s_waitcnt lgkmcnt(6)
  v_mfma_f32_16x16x32_bf16 v[40:43], a[8:11], v[24:27], v[40:43]
  v_mfma_f32_16x16x32_bf16 v[44:47], a[64:67], v[24:27], v[44:47]
  v_mfma_f32_16x16x32_bf16 v[48:51], a[120:123], v[24:27], v[48:51]
  v_mfma_f32_16x16x32_bf16 v[52:55], a[176:179], v[24:27], v[52:55]
  ds_read_b128 v[20:23], v5 offset:19456
  s_waitcnt lgkmcnt(6)
  v_mfma_f32_16x16x32_bf16 v[56:59], a[8:11], v[28:31], v[56:59]
  v_mfma_f32_16x16x32_bf16 v[60:63], a[64:67], v[28:31], v[60:63]
  v_mfma_f32_16x16x32_bf16 v[64:67], a[120:123], v[28:31], v[64:67]
  v_mfma_f32_16x16x32_bf16 v[68:71], a[176:179], v[28:31], v[68:71]
  ds_read_b128 v[24:27], v5 offset:6144
  s_waitcnt lgkmcnt(6)
  v_mfma_f32_16x16x32_bf16 v[40:43], a[12:15], v[32:35], v[40:43]
  v_mfma_f32_16x16x32_bf16 v[44:47], a[68:71], v[32:35], v[44:47]
  v_mfma_f32_16x16x32_bf16 v[48:51], a[124:127], v[32:35], v[48:51]
  v_mfma_f32_16x16x32_bf16 v[52:55], a[180:183], v[32:35], v[52:55]
  ds_read_b128 v[28:31], v5 offset:20480
  s_waitcnt lgkmcnt(6)
  v_mfma_f32_16x16x32_bf16 v[56:59], a[12:15], v[36:39], v[56:59]
  v_mfma_f32_16x16x32_bf16 v[60:63], a[68:71], v[36:39], v[60:63]
  v_mfma_f32_16x16x32_bf16 v[64:67], a[124:127], v[36:39], v[64:67]
  v_mfma_f32_16x16x32_bf16 v[68:71], a[180:183], v[36:39], v[68:71]
  ds_read_b128 v[32:35], v5 offset:7168
  s_waitcnt lgkmcnt(6)
  v_mfma_f32_16x16x32_bf16 v[40:43], a[16:19], v[8:11], v[40:43]
  v_mfma_f32_16x16x32_bf16 v[44:47], a[72:75], v[8:11], v[44:47]
  v_mfma_f32_16x16x32_bf16 v[48:51], a[128:131], v[8:11], v[48:51]
  v_mfma_f32_16x16x32_bf16 v[52:55], a[184:187], v[8:11], v[52:55]
  ds_read_b128 v[36:39], v5 offset:21504
  s_waitcnt lgkmcnt(6)
  v_mfma_f32_16x16x32_bf16 v[56:59], a[16:19], v[12:15], v[56:59]
  v_mfma_f32_16x16x32_bf16 v[60:63], a[72:75], v[12:15], v[60:63]
  v_mfma_f32_16x16x32_bf16 v[64:67], a[128:131], v[12:15], v[64:67]
  v_mfma_f32_16x16x32_bf16 v[68:71], a[184:187], v[12:15], v[68:71]
  ds_read_b128 v[8:11], v5 offset:8192
  s_waitcnt lgkmcnt(6)
  v_mfma_f32_16x16x32_bf16 v[40:43], a[20:23], v[16:19], v[40:43]
  v_mfma_f32_16x16x32_bf16 v[44:47], a[76:79], v[16:19], v[44:47]
  v_mfma_f32_16x16x32_bf16 v[48:51], a[132:135], v[16:19], v[48:51]
  v_mfma_f32_16x16x32_bf16 v[52:55], a[188:191], v[16:19], v[52:55]
  ds_read_b128 v[12:15], v5 offset:22528
  s_waitcnt lgkmcnt(6)
  v_mfma_f32_16x16x32_bf16 v[56:59], a[20:23], v[20:23], v[56:59]
  v_mfma_f32_16x16x32_bf16 v[60:63], a[76:79], v[20:23], v[60:63]
  v_mfma_f32_16x16x32_bf16 v[64:67], a[132:135], v[20:23], v[64:67]
  v_mfma_f32_16x16x32_bf16 v[68:71], a[188:191], v[20:23], v[68:71]
  ds_read_b128 v[16:19], v5 offset:9216
  s_waitcnt lgkmcnt(6)
  v_mfma_f32_16x16x32_bf16 v[40:43], a[24:27], v[24:27], v[40:43]
  v_mfma_f32_16x16x32_bf16 v[44:47], a[80:83], v[24:27], v[44:47]
  v_mfma_f32_16x16x32_bf16 v[48:51], a[136:139], v[24:27], v[48:51]
  v_mfma_f32_16x16x32_bf16 v[52:55], a[192:195], v[24:27], v[52:55]
  ds_read_b128 v[20:23], v5 offset:23552
  s_waitcnt lgkmcnt(6)
  v_mfma_f32_16x16x32_bf16 v[56:59], a[24:27], v[28:31], v[56:59]
  v_mfma_f32_16x16x32_bf16 v[60:63], a[80:83], v[28:31], v[60:63]
  v_mfma_f32_16x16x32_bf16 v[64:67], a[136:139], v[28:31], v[64:67]
  v_mfma_f32_16x16x32_bf16 v[68:71], a[192:195], v[28:31], v[68:71]
  ds_read_b128 v[24:27], v5 offset:10240
  s_waitcnt lgkmcnt(6)
  v_mfma_f32_16x16x32_bf16 v[40:43], a[28:31], v[32:35], v[40:43]
  v_mfma_f32_16x16x32_bf16 v[44:47], a[84:87], v[32:35], v[44:47]
  v_mfma_f32_16x16x32_bf16 v[48:51], a[140:143], v[32:35], v[48:51]
  v_mfma_f32_16x16x32_bf16 v[52:55], a[196:199], v[32:35], v[52:55]
  ds_read_b128 v[28:31], v5 offset:24576
  s_waitcnt lgkmcnt(6)
  v_mfma_f32_16x16x32_bf16 v[56:59], a[28:31], v[36:39], v[56:59]
  v_mfma_f32_16x16x32_bf16 v[60:63], a[84:87], v[36:39], v[60:63]
  v_mfma_f32_16x16x32_bf16 v[64:67], a[140:143], v[36:39], v[64:67]
  v_mfma_f32_16x16x32_bf16 v[68:71], a[196:199], v[36:39], v[68:71]
  ds_read_b128 v[32:35], v5 offset:11264
  s_waitcnt lgkmcnt(6)
  v_mfma_f32_16x16x32_bf16 v[40:43], a[32:35], v[8:11], v[40:43]
  v_mfma_f32_16x16x32_bf16 v[44:47], a[88:91], v[8:11], v[44:47]
  v_mfma_f32_16x16x32_bf16 v[48:51], a[144:147], v[8:11], v[48:51]
  v_mfma_f32_16x16x32_bf16 v[52:55], a[200:203], v[8:11], v[52:55]
  ds_read_b128 v[36:39], v5 offset:25600
  s_waitcnt lgkmcnt(6)
  v_mfma_f32_16x16x32_bf16 v[56:59], a[32:35], v[12:15], v[56:59]
  v_mfma_f32_16x16x32_bf16 v[60:63], a[88:91], v[12:15], v[60:63]
  v_mfma_f32_16x16x32_bf16 v[64:67], a[144:147], v[12:15], v[64:67]
  v_mfma_f32_16x16x32_bf16 v[68:71], a[200:203], v[12:15], v[68:71]
  ds_read_b128 v[8:11], v5 offset:12288
  s_waitcnt lgkmcnt(6)
  v_mfma_f32_16x16x32_bf16 v[40:43], a[36:39], v[16:19], v[40:43]
  v_mfma_f32_16x16x32_bf16 v[44:47], a[92:95], v[16:19], v[44:47]
  v_mfma_f32_16x16x32_bf16 v[48:51], a[148:151], v[16:19], v[48:51]
  v_mfma_f32_16x16x32_bf16 v[52:55], a[204:207], v[16:19], v[52:55]
  ds_read_b128 v[12:15], v5 offset:26624
  s_waitcnt lgkmcnt(6)
  v_mfma_f32_16x16x32_bf16 v[56:59], a[36:39], v[20:23], v[56:59]
  v_mfma_f32_16x16x32_bf16 v[60:63], a[92:95], v[20:23], v[60:63]
  v_mfma_f32_16x16x32_bf16 v[64:67], a[148:151], v[20:23], v[64:67]
  v_mfma_f32_16x16x32_bf16 v[68:71], a[204:207], v[20:23], v[68:71]
  ds_read_b128 v[16:19], v5 offset:13312
  s_waitcnt lgkmcnt(6)
  v_mfma_f32_16x16x32_bf16 v[40:43], a[40:43], v[24:27], v[40:43]
  v_mfma_f32_16x16x32_bf16 v[44:47], a[96:99], v[24:27], v[44:47]
  v_mfma_f32_16x16x32_bf16 v[48:51], a[152:155], v[24:27], v[48:51]
  v_mfma_f32_16x16x32_bf16 v[52:55], a[208:211], v[24:27], v[52:55]
  ds_read_b128 v[20:23], v5 offset:27648
  s_waitcnt lgkmcnt(6)
  v_mfma_f32_16x16x32_bf16 v[56:59], a[40:43], v[28:31], v[56:59]
  v_mfma_f32_16x16x32_bf16 v[60:63], a[96:99], v[28:31], v[60:63]
  v_mfma_f32_16x16x32_bf16 v[64:67], a[152:155], v[28:31], v[64:67]
  v_mfma_f32_16x16x32_bf16 v[68:71], a[208:211], v[28:31], v[68:71]
  s_waitcnt lgkmcnt(5)
  v_mfma_f32_16x16x32_bf16 v[40:43], a[44:47], v[32:35], v[40:43]
  v_mfma_f32_16x16x32_bf16 v[44:47], a[100:103], v[32:35], v[44:47]
  v_mfma_f32_16x16x32_bf16 v[48:51], a[156:159], v[32:35], v[48:51]
  v_mfma_f32_16x16x32_bf16 v[52:55], a[212:215], v[32:35], v[52:55]
  s_waitcnt lgkmcnt(4)
  v_mfma_f32_16x16x32_bf16 v[56:59], a[44:47], v[36:39], v[56:59]
  v_mfma_f32_16x16x32_bf16 v[60:63], a[100:103], v[36:39], v[60:63]
  v_mfma_f32_16x16x32_bf16 v[64:67], a[156:159], v[36:39], v[64:67]
  v_mfma_f32_16x16x32_bf16 v[68:71], a[212:215], v[36:39], v[68:71]
  s_waitcnt lgkmcnt(3)
  v_mfma_f32_16x16x32_bf16 v[40:43], a[48:51], v[8:11], v[40:43]
  v_mfma_f32_16x16x32_bf16 v[44:47], a[104:107], v[8:11], v[44:47]
  v_mfma_f32_16x16x32_bf16 v[48:51], a[160:163], v[8:11], v[48:51]
  v_mfma_f32_16x16x32_bf16 v[52:55], a[216:219], v[8:11], v[52:55]
  s_waitcnt lgkmcnt(2)
  v_mfma_f32_16x16x32_bf16 v[56:59], a[48:51], v[12:15], v[56:59]
  v_mfma_f32_16x16x32_bf16 v[60:63], a[104:107], v[12:15], v[60:63]
  v_mfma_f32_16x16x32_bf16 v[64:67], a[160:163], v[12:15], v[64:67]
  v_mfma_f32_16x16x32_bf16 v[68:71], a[216:219], v[12:15], v[68:71]
  s_waitcnt lgkmcnt(1)
  v_mfma_f32_16x16x32_bf16 v[40:43], a[52:55], v[16:19], v[40:43]
  v_mfma_f32_16x16x32_bf16 v[44:47], a[108:111], v[16:19], v[44:47]
  v_mfma_f32_16x16x32_bf16 v[48:51], a[164:167], v[16:19], v[48:51]
  v_mfma_f32_16x16x32_bf16 v[52:55], a[220:223], v[16:19], v[52:55]
  s_waitcnt lgkmcnt(0)
  v_mfma_f32_16x16x32_bf16 v[56:59], a[52:55], v[20:23], v[56:59]
  v_mfma_f32_16x16x32_bf16 v[60:63], a[108:111], v[20:23], v[60:63]
  v_mfma_f32_16x16x32_bf16 v[64:67], a[164:167], v[20:23], v[64:67]
  v_mfma_f32_16x16x32_bf16 v[68:71], a[220:223], v[20:23], v[68:71]
  s_add_u32 s25, s29, 28672
  s_lshl_b32 s24, s19, 5
  s_add_u32 s24, s24, 0
  v_add_u32 v88, s24, v4
  v_mul_u32_u24 v89, 2341, v88
  v_lshrrev_b32 v89, 16, v89
  v_mul_u32_u24 v89, 84, v89
  v_add3_u32 v88, v88, v89, v6
  v_lshlrev_b32 v90, 4, v88
  v_cvt_pk_bf16_f32 v72, v40, v41
  v_cvt_pk_bf16_f32 v73, v42, v43
  v_cvt_pk_bf16_f32 v74, v44, v45
  v_cvt_pk_bf16_f32 v75, v46, v47
  buffer_store_dwordx4 v[72:75], v90, s[8:11], s29 offen sc1
  v_cvt_pk_bf16_f32 v76, v48, v49
  v_cvt_pk_bf16_f32 v77, v50, v51
  v_cvt_pk_bf16_f32 v78, v52, v53
  v_cvt_pk_bf16_f32 v79, v54, v55
  buffer_store_dwordx4 v[76:79], v90, s[8:11], s25 offen sc1
  s_lshl_b32 s24, s19, 5
  s_add_u32 s24, s24, 16
  v_add_u32 v88, s24, v4
  v_mul_u32_u24 v89, 2341, v88
  v_lshrrev_b32 v89, 16, v89
  v_mul_u32_u24 v89, 84, v89
  v_add3_u32 v88, v88, v89, v6
  v_lshlrev_b32 v91, 4, v88
  v_cvt_pk_bf16_f32 v80, v56, v57
  v_cvt_pk_bf16_f32 v81, v58, v59
  v_cvt_pk_bf16_f32 v82, v60, v61
  v_cvt_pk_bf16_f32 v83, v62, v63
  buffer_store_dwordx4 v[80:83], v91, s[8:11], s29 offen sc1
  v_cvt_pk_bf16_f32 v84, v64, v65
  v_cvt_pk_bf16_f32 v85, v66, v67
  v_cvt_pk_bf16_f32 v86, v68, v69
  v_cvt_pk_bf16_f32 v87, v70, v71
  buffer_store_dwordx4 v[84:87], v91, s[8:11], s25 offen sc1
  s_mov_b32 s33, s32
  s_add_u32 s32, s32, 28672
  s_cmp_eq_u32 s32, 86016
  s_cselect_b32 s32, 0, s32
  s_add_u32 s19, s19, 1
  s_cmp_lt_u32 s19, s35
  s_cbranch_scc1 wg_vo_loop
  s_branch wg_done
wg_done:
  s_lshl_b32 s20, s18, 4
  s_and_b32 s21, s17, 15
  s_add_u32 s20, s20, s21
  s_lshl_b32 s20, s20, 2
  s_cmp_lt_u32 s17, 16
  s_cselect_b32 s21, 512, 0
  s_add_u32 s20, s20, s21
  s_add_u32 s20, s20, 88526848
  s_sub_u32 s21, s35, s34
  v_mov_b32 v5, s21
  v_mov_b32 v6, 0
  s_waitcnt vmcnt(0)
  s_mov_b64 exec, 1
  buffer_atomic_add v5, v6, s[8:11], s20 offen
  s_mov_b64 exec, -1
  s_branch wk_loop
wk_srv:
  s_and_b32 s18, s3, 15
  s_lshr_b32 s19, s3, 4
  s_and_b32 s19, s19, 1
  s_mul_i32 s20, s18, 401408
  s_mul_i32 s21, s16, 100352
  s_add_u32 s20, s20, s21
  s_add_u32 s20, s20, 6422528
  s_add_u32 s22, s20, 0
  buffer_load_dwordx4 a[0:3], v2, s[8:11], s22 offen offset:0
  buffer_load_dwordx4 a[4:7], v2, s[8:11], s22 offen offset:1024
  buffer_load_dwordx4 a[8:11], v2, s[8:11], s22 offen offset:2048
  buffer_load_dwordx4 a[12:15], v2, s[8:11], s22 offen offset:3072
  s_add_u32 s22, s20, 4096
  buffer_load_dwordx4 a[16:19], v2, s[8:11], s22 offen offset:0
  buffer_load_dwordx4 a[20:23], v2, s[8:11], s22 offen offset:1024
  buffer_load_dwordx4 a[24:27], v2, s[8:11], s22 offen offset:2048
  buffer_load_dwordx4 a[28:31], v2, s[8:11], s22 offen offset:3072
  s_add_u32 s22, s20, 8192
  buffer_load_dwordx4 a[32:35], v2, s[8:11], s22 offen offset:0
  buffer_load_dwordx4 a[36:39], v2, s[8:11], s22 offen offset:1024
  buffer_load_dwordx4 a[40:43], v2, s[8:11], s22 offen offset:2048
  buffer_load_dwordx4 a[44:47], v2, s[8:11], s22 offen offset:3072
  s_add_u32 s22, s20, 12288
  buffer_load_dwordx4 a[48:51], v2, s[8:11], s22 offen offset:0
  buffer_load_dwordx4 a[52:55], v2, s[8:11], s22 offen offset:1024
  buffer_load_dwordx4 a[56:59], v2, s[8:11], s22 offen offset:2048
  buffer_load_dwordx4 a[60:63], v2, s[8:11], s22 offen offset:3072
  s_add_u32 s22, s20, 16384
  buffer_load_dwordx4 a[64:67], v2, s[8:11], s22 offen offset:0
  buffer_load_dwordx4 a[68:71], v2, s[8:11], s22 offen offset:1024
  buffer_load_dwordx4 a[72:75], v2, s[8:11], s22 offen offset:2048
  buffer_load_dwordx4 a[76:79], v2, s[8:11], s22 offen offset:3072
  s_add_u32 s22, s20, 20480
  buffer_load_dwordx4 a[80:83], v2, s[8:11], s22 offen offset:0
  buffer_load_dwordx4 a[84:87], v2, s[8:11], s22 offen offset:1024
  buffer_load_dwordx4 a[88:91], v2, s[8:11], s22 offen offset:2048
  buffer_load_dwordx4 a[92:95], v2, s[8:11], s22 offen offset:3072
  s_add_u32 s22, s20, 24576
  buffer_load_dwordx4 a[96:99], v2, s[8:11], s22 offen offset:0
  buffer_load_dwordx4 a[100:103], v2, s[8:11], s22 offen offset:1024
  buffer_load_dwordx4 a[104:107], v2, s[8:11], s22 offen offset:2048
  buffer_load_dwordx4 a[108:111], v2, s[8:11], s22 offen offset:3072
  s_add_u32 s22, s20, 28672
  buffer_load_dwordx4 a[112:115], v2, s[8:11], s22 offen offset:0
  buffer_load_dwordx4 a[116:119], v2, s[8:11], s22 offen offset:1024
  buffer_load_dwordx4 a[120:123], v2, s[8:11], s22 offen offset:2048
  buffer_load_dwordx4 a[124:127], v2, s[8:11], s22 offen offset:3072
  s_waitcnt vmcnt(24)
  s_add_u32 s22, s20, 32768
  buffer_load_dwordx4 a[128:131], v2, s[8:11], s22 offen offset:0
  buffer_load_dwordx4 a[132:135], v2, s[8:11], s22 offen offset:1024
  buffer_load_dwordx4 a[136:139], v2, s[8:11], s22 offen offset:2048
  buffer_load_dwordx4 a[140:143], v2, s[8:11], s22 offen offset:3072
  s_add_u32 s22, s20, 36864
  buffer_load_dwordx4 a[144:147], v2, s[8:11], s22 offen offset:0
  buffer_load_dwordx4 a[148:151], v2, s[8:11], s22 offen offset:1024
  buffer_load_dwordx4 a[152:155], v2, s[8:11], s22 offen offset:2048
  buffer_load_dwordx4 a[156:159], v2, s[8:11], s22 offen offset:3072
  s_add_u32 s22, s20, 40960
  buffer_load_dwordx4 a[160:163], v2, s[8:11], s22 offen offset:0
  buffer_load_dwordx4 a[164:167], v2, s[8:11], s22 offen offset:1024
  buffer_load_dwordx4 a[168:171], v2, s[8:11], s22 offen offset:2048
  buffer_load_dwordx4 a[172:175], v2, s[8:11], s22 offen offset:3072
  s_add_u32 s22, s20, 45056
  buffer_load_dwordx4 a[176:179], v2, s[8:11], s22 offen offset:0
  buffer_load_dwordx4 a[180:183], v2, s[8:11], s22 offen offset:1024
  buffer_load_dwordx4 a[184:187], v2, s[8:11], s22 offen offset:2048
  buffer_load_dwordx4 a[188:191], v2, s[8:11], s22 offen offset:3072
  s_add_u32 s22, s20, 49152
  buffer_load_dwordx4 a[192:195], v2, s[8:11], s22 offen offset:0
  buffer_load_dwordx4 a[196:199], v2, s[8:11], s22 offen offset:1024
  buffer_load_dwordx4 a[200:203], v2, s[8:11], s22 offen offset:2048
  buffer_load_dwordx4 a[204:207], v2, s[8:11], s22 offen offset:3072
  s_add_u32 s22, s20, 53248
  buffer_load_dwordx4 a[208:211], v2, s[8:11], s22 offen offset:0
  buffer_load_dwordx4 a[212:215], v2, s[8:11], s22 offen offset:1024
  buffer_load_dwordx4 a[216:219], v2, s[8:11], s22 offen offset:2048
  buffer_load_dwordx4 a[220:223], v2, s[8:11], s22 offen offset:3072
  s_add_u32 s22, s20, 57344
  buffer_load_dwordx4 a[224:227], v2, s[8:11], s22 offen offset:0
  buffer_load_dwordx4 a[228:231], v2, s[8:11], s22 offen offset:1024
  buffer_load_dwordx4 a[232:235], v2, s[8:11], s22 offen offset:2048
  buffer_load_dwordx4 a[236:239], v2, s[8:11], s22 offen offset:3072
  s_add_u32 s22, s20, 61440
  buffer_load_dwordx4 a[240:243], v2, s[8:11], s22 offen offset:0
  buffer_load_dwordx4 a[244:247], v2, s[8:11], s22 offen offset:1024
  buffer_load_dwordx4 a[248:251], v2, s[8:11], s22 offen offset:2048
  buffer_load_dwordx4 a[252:255], v2, s[8:11], s22 offen offset:3072
  s_waitcnt vmcnt(24)
  s_add_u32 s22, s20, 65536
  buffer_load_dwordx4 v[120:123], v2, s[8:11], s22 offen offset:0
  buffer_load_dwordx4 v[124:127], v2, s[8:11], s22 offen offset:1024
  buffer_load_dwordx4 v[128:131], v2, s[8:11], s22 offen offset:2048
  buffer_load_dwordx4 v[132:135], v2, s[8:11], s22 offen offset:3072
  s_add_u32 s22, s20, 69632
  buffer_load_dwordx4 v[136:139], v2, s[8:11], s22 offen offset:0
  buffer_load_dwordx4 v[140:143], v2, s[8:11], s22 offen offset:1024
  buffer_load_dwordx4 v[144:147], v2, s[8:11], s22 offen offset:2048
  buffer_load_dwordx4 v[148:151], v2, s[8:11], s22 offen offset:3072
  s_add_u32 s22, s20, 73728
  buffer_load_dwordx4 v[152:155], v2, s[8:11], s22 offen offset:0
  buffer_load_dwordx4 v[156:159], v2, s[8:11], s22 offen offset:1024
  buffer_load_dwordx4 v[160:163], v2, s[8:11], s22 offen offset:2048
  buffer_load_dwordx4 v[164:167], v2, s[8:11], s22 offen offset:3072
  s_add_u32 s22, s20, 77824
  buffer_load_dwordx4 v[168:171], v2, s[8:11], s22 offen offset:0
  buffer_load_dwordx4 v[172:175], v2, s[8:11], s22 offen offset:1024
  buffer_load_dwordx4 v[176:179], v2, s[8:11], s22 offen offset:2048
  buffer_load_dwordx4 v[180:183], v2, s[8:11], s22 offen offset:3072
  s_add_u32 s22, s20, 81920
  buffer_load_dwordx4 v[184:187], v2, s[8:11], s22 offen offset:0
  buffer_load_dwordx4 v[188:191], v2, s[8:11], s22 offen offset:1024
  buffer_load_dwordx4 v[192:195], v2, s[8:11], s22 offen offset:2048
  buffer_load_dwordx4 v[196:199], v2, s[8:11], s22 offen offset:3072
  s_add_u32 s22, s20, 86016
  buffer_load_dwordx4 v[200:203], v2, s[8:11], s22 offen offset:0
  buffer_load_dwordx4 v[204:207], v2, s[8:11], s22 offen offset:1024
  buffer_load_dwordx4 v[208:211], v2, s[8:11], s22 offen offset:2048
  buffer_load_dwordx4 v[212:215], v2, s[8:11], s22 offen offset:3072
  s_add_u32 s22, s20, 90112
  buffer_load_dwordx4 v[216:219], v2, s[8:11], s22 offen offset:0
  buffer_load_dwordx4 v[220:223], v2, s[8:11], s22 offen offset:1024
  buffer_load_dwordx4 v[224:227], v2, s[8:11], s22 offen offset:2048
  buffer_load_dwordx4 v[228:231], v2, s[8:11], s22 offen offset:3072
  s_add_u32 s22, s20, 94208
  buffer_load_dwordx4 v[232:235], v2, s[8:11], s22 offen offset:0
  buffer_load_dwordx4 v[236:239], v2, s[8:11], s22 offen offset:1024
  buffer_load_dwordx4 v[240:243], v2, s[8:11], s22 offen offset:2048
  buffer_load_dwordx4 v[244:247], v2, s[8:11], s22 offen offset:3072
  s_waitcnt vmcnt(24)
  s_add_u32 s22, s20, 98304
  buffer_load_dwordx4 v[248:251], v2, s[8:11], s22 offen offset:0
  buffer_load_dwordx4 v[252:255], v2, s[8:11], s22 offen offset:1024
  v_mov_b32 v5, 0x4444
  v_mov_b32 v6, 0xeeee
  v_cmp_lt_u32 vcc, 7, v4
  s_nop 1
  v_cndmask_b32 v5, v5, v6, vcc
  s_lshl_b32 s23, s16, 11
  v_lshrrev_b32 v80, 1, v3
  v_and_b32 v81, 1, v3
  v_add_u32 v82, 0, v80
  v_lshl_add_u32 v82, v82, 4, v4
  v_mul_u32_u24 v83, 2341, v82
  v_lshrrev_b32 v83, 16, v83
  v_mul_u32_u24 v84, 28, v83
  v_sub_u32 v84, v82, v84
  v_lshrrev_b32 v85, 4, v84
  v_and_b32 v84, 15, v84
  v_lshlrev_b32 v86, 10, v85
  v_lshl_add_u32 v86, v83, 8, v86
  v_lshl_add_u32 v86, v84, 4, v86
  v_lshl_add_u32 v86, v81, 3, v86
  v_add_u32 v72, s23, v86
  v_add_u32 v82, 2, v80
  v_lshl_add_u32 v82, v82, 4, v4
  v_mul_u32_u24 v83, 2341, v82
  v_lshrrev_b32 v83, 16, v83
  v_mul_u32_u24 v84, 28, v83
  v_sub_u32 v84, v82, v84
  v_lshrrev_b32 v85, 4, v84
  v_and_b32 v84, 15, v84
  v_lshlrev_b32 v86, 10, v85
  v_lshl_add_u32 v86, v83, 8, v86
  v_lshl_add_u32 v86, v84, 4, v86
  v_lshl_add_u32 v86, v81, 3, v86
  v_add_u32 v73, s23, v86
  v_add_u32 v82, 4, v80
  v_lshl_add_u32 v82, v82, 4, v4
  v_mul_u32_u24 v83, 2341, v82
  v_lshrrev_b32 v83, 16, v83
  v_mul_u32_u24 v84, 28, v83
  v_sub_u32 v84, v82, v84
  v_lshrrev_b32 v85, 4, v84
  v_and_b32 v84, 15, v84
  v_lshlrev_b32 v86, 10, v85
  v_lshl_add_u32 v86, v83, 8, v86
  v_lshl_add_u32 v86, v84, 4, v86
  v_lshl_add_u32 v86, v81, 3, v86
  v_add_u32 v74, s23, v86
  v_mov_b32 v82, 6
  v_lshl_add_u32 v82, v82, 4, v4
  v_mul_u32_u24 v83, 2341, v82
  v_lshrrev_b32 v83, 16, v83
  v_mul_u32_u24 v84, 28, v83
  v_sub_u32 v84, v82, v84
  v_lshrrev_b32 v85, 4, v84
  v_and_b32 v84, 15, v84
  v_lshlrev_b32 v86, 10, v85
  v_lshl_add_u32 v86, v83, 8, v86
  v_lshl_add_u32 v86, v84, 4, v86
  v_lshl_add_u32 v86, v81, 3, v86
  v_add_u32 v75, s23, v86
  v_add_u32 v76, s23, v2
  s_mul_i32 s27, s18, 448
  v_mov_b32 v77, s27
  v_mov_b32 v78, 1
  s_mov_b32 s17, s19
  s_mul_i32 s24, s19, 7168
  s_add_u32 s24, s24, 88068096
  s_mul_i32 s25, s18, 65
  s_add_u32 s25, s25, s19
  s_lshl_b32 s25, s25, 13
  s_add_u32 s25, s25, s23
  s_add_u32 s25, s25, 76935168
  s_lshl_b32 s26, s18, 6
  s_add_u32 s26, s26, s19
  s_lshl_b32 s26, s26, 4
  s_lshl_b32 s27, s16, 2
  s_add_u32 s26, s26, s27
  s_add_u32 s26, s26, 88528128
ws_loop:
  v_mov_b32 v36, 0
  v_mov_b32 v37, 0
  v_mov_b32 v38, 0
  v_mov_b32 v39, 0
  v_mov_b32 v40, 0
  v_mov_b32 v41, 0
  v_mov_b32 v42, 0
  v_mov_b32 v43, 0
  v_mov_b32 v44, 0
  v_mov_b32 v45, 0
  v_mov_b32 v46, 0
  v_mov_b32 v47, 0
  v_mov_b32 v48, 0
  v_mov_b32 v49, 0
  v_mov_b32 v50, 0
  v_mov_b32 v51, 0
  v_mov_b32 v52, 0
  v_mov_b32 v53, 0
  v_mov_b32 v54, 0
  v_mov_b32 v55, 0
  v_mov_b32 v56, 0
  v_mov_b32 v57, 0
  v_mov_b32 v58, 0
  v_mov_b32 v59, 0
  v_mov_b32 v60, 0
  v_mov_b32 v61, 0
  v_mov_b32 v62, 0
  v_mov_b32 v63, 0
  s_mov_b32 s30, 0
  s_branch ws_fl
ws_pm:
  buffer_load_dword v79, v77, s[8:11], s24 offen sc1
  s_waitcnt vmcnt(0)
  v_cmp_eq_u32 vcc, -1, v79
  s_cbranch_vccnz ws_pr
ws_fl:
  s_add_u32 s22, s24, 4096
  buffer_load_dwordx4 v[8:11], v2, s[8:11], s24 offen offset:0 sc1
  buffer_load_dwordx4 v[12:15], v2, s[8:11], s24 offen offset:1024 sc1
  buffer_load_dwordx4 v[16:19], v2, s[8:11], s24 offen offset:2048 sc1
  buffer_load_dwordx4 v[20:23], v2, s[8:11], s24 offen offset:3072 sc1
  buffer_load_dwordx4 v[24:27], v2, s[8:11], s22 offen offset:0 sc1
  buffer_load_dwordx4 v[28:31], v2, s[8:11], s22 offen offset:1024 sc1
  buffer_load_dwordx4 v[32:35], v2, s[8:11], s22 offen offset:2048 sc1
  s_waitcnt vmcnt(0)
  v_max_u32 v79, v8, v9
  v_max3_u32 v79, v79, v10, v11
  v_max3_u32 v79, v79, v12, v13
  v_max3_u32 v79, v79, v14, v15
  v_max3_u32 v79, v79, v16, v17
  v_max3_u32 v79, v79, v18, v19
  v_max3_u32 v79, v79, v20, v21
  v_max3_u32 v79, v79, v22, v23
  v_max3_u32 v79, v79, v24, v25
  v_max3_u32 v79, v79, v26, v27
  v_max3_u32 v79, v79, v28, v29
  v_max3_u32 v79, v79, v30, v31
  v_max3_u32 v79, v79, v32, v33
  v_max3_u32 v79, v79, v34, v35
  v_cmp_eq_u32 vcc, -1, v79
  s_cbranch_vccz ws_pk
ws_pr:
  s_sleep 6
  s_add_u32 s30, s30, 1
  s_cmp_lt_u32 s30, 2000000
  s_cbranch_scc1 ws_pm
  s_branch cA_abort
ws_pk:
  v_smfmac_f32_16x16x64_bf16 v[36:39], v[8:11], a[0:7], v5
  v_smfmac_f32_16x16x64_bf16 v[36:39], v[12:15], a[8:15], v5
  v_smfmac_f32_16x16x64_bf16 v[36:39], v[16:19], a[16:23], v5
  v_smfmac_f32_16x16x64_bf16 v[36:39], v[20:23], a[24:31], v5
  v_smfmac_f32_16x16x64_bf16 v[36:39], v[24:27], a[32:39], v5
  v_smfmac_f32_16x16x64_bf16 v[36:39], v[28:31], a[40:47], v5
  v_smfmac_f32_16x16x64_bf16 v[36:39], v[32:35], a[48:55], v5
  v_smfmac_f32_16x16x64_bf16 v[40:43], v[8:11], a[56:63], v5
  v_smfmac_f32_16x16x64_bf16 v[40:43], v[12:15], a[64:71], v5
  v_smfmac_f32_16x16x64_bf16 v[40:43], v[16:19], a[72:79], v5
  v_smfmac_f32_16x16x64_bf16 v[40:43], v[20:23], a[80:87], v5
  v_smfmac_f32_16x16x64_bf16 v[40:43], v[24:27], a[88:95], v5
  v_smfmac_f32_16x16x64_bf16 v[40:43], v[28:31], a[96:103], v5
  v_smfmac_f32_16x16x64_bf16 v[40:43], v[32:35], a[104:111], v5
  v_smfmac_f32_16x16x64_bf16 v[44:47], v[8:11], a[112:119], v5
  v_smfmac_f32_16x16x64_bf16 v[44:47], v[12:15], a[120:127], v5
  v_smfmac_f32_16x16x64_bf16 v[44:47], v[16:19], a[128:135], v5
  v_smfmac_f32_16x16x64_bf16 v[44:47], v[20:23], a[136:143], v5
  v_smfmac_f32_16x16x64_bf16 v[44:47], v[24:27], a[144:151], v5
  v_smfmac_f32_16x16x64_bf16 v[44:47], v[28:31], a[152:159], v5
  v_smfmac_f32_16x16x64_bf16 v[44:47], v[32:35], a[160:167], v5
  v_smfmac_f32_16x16x64_bf16 v[48:51], v[8:11], a[168:175], v5
  v_smfmac_f32_16x16x64_bf16 v[48:51], v[12:15], a[176:183], v5
  v_smfmac_f32_16x16x64_bf16 v[48:51], v[16:19], a[184:191], v5
  v_smfmac_f32_16x16x64_bf16 v[48:51], v[20:23], a[192:199], v5
  v_smfmac_f32_16x16x64_bf16 v[48:51], v[24:27], a[200:207], v5
  v_smfmac_f32_16x16x64_bf16 v[48:51], v[28:31], a[208:215], v5
  v_smfmac_f32_16x16x64_bf16 v[48:51], v[32:35], a[216:223], v5
  v_smfmac_f32_16x16x64_bf16 v[52:55], v[8:11], a[224:231], v5
  v_smfmac_f32_16x16x64_bf16 v[52:55], v[12:15], a[232:239], v5
  v_smfmac_f32_16x16x64_bf16 v[52:55], v[16:19], a[240:247], v5
  v_smfmac_f32_16x16x64_bf16 v[52:55], v[20:23], a[248:255], v5
  v_smfmac_f32_16x16x64_bf16 v[52:55], v[24:27], v[120:127], v5
  v_smfmac_f32_16x16x64_bf16 v[52:55], v[28:31], v[128:135], v5
  v_smfmac_f32_16x16x64_bf16 v[52:55], v[32:35], v[136:143], v5
  v_smfmac_f32_16x16x64_bf16 v[56:59], v[8:11], v[144:151], v5
  v_smfmac_f32_16x16x64_bf16 v[56:59], v[12:15], v[152:159], v5
  v_smfmac_f32_16x16x64_bf16 v[56:59], v[16:19], v[160:167], v5
  v_smfmac_f32_16x16x64_bf16 v[56:59], v[20:23], v[168:175], v5
  v_smfmac_f32_16x16x64_bf16 v[56:59], v[24:27], v[176:183], v5
  v_smfmac_f32_16x16x64_bf16 v[56:59], v[28:31], v[184:191], v5
  v_smfmac_f32_16x16x64_bf16 v[56:59], v[32:35], v[192:199], v5
  v_smfmac_f32_16x16x64_bf16 v[60:63], v[8:11], v[200:207], v5
  v_smfmac_f32_16x16x64_bf16 v[60:63], v[12:15], v[208:215], v5
  v_smfmac_f32_16x16x64_bf16 v[60:63], v[16:19], v[216:223], v5
  v_smfmac_f32_16x16x64_bf16 v[60:63], v[20:23], v[224:231], v5
  v_smfmac_f32_16x16x64_bf16 v[60:63], v[24:27], v[232:239], v5
  v_smfmac_f32_16x16x64_bf16 v[60:63], v[28:31], v[240:247], v5
  v_smfmac_f32_16x16x64_bf16 v[60:63], v[32:35], v[248:255], v5
  v_permlane32_swap_b32 v36, v40
  v_permlane32_swap_b32 v37, v41
  v_permlane32_swap_b32 v38, v42
  v_permlane32_swap_b32 v39, v43
  v_add_f32 v36, v36, v40
  v_add_f32 v37, v37, v41
  v_add_f32 v38, v38, v42
  v_add_f32 v39, v39, v43
  v_cvt_pk_bf16_f32 v40, v36, v37
  v_cvt_pk_bf16_f32 v41, v38, v39
  ds_write_b64 v72, v[40:41]
  v_permlane32_swap_b32 v44, v48
  v_permlane32_swap_b32 v45, v49
  v_permlane32_swap_b32 v46, v50
  v_permlane32_swap_b32 v47, v51
  v_add_f32 v44, v44, v48
  v_add_f32 v45, v45, v49
  v_add_f32 v46, v46, v50
  v_add_f32 v47, v47, v51
  v_cvt_pk_bf16_f32 v48, v44, v45
  v_cvt_pk_bf16_f32 v49, v46, v47
  ds_write_b64 v73, v[48:49]
  v_permlane32_swap_b32 v52, v56
  v_permlane32_swap_b32 v53, v57
  v_permlane32_swap_b32 v54, v58
  v_permlane32_swap_b32 v55, v59
  v_add_f32 v52, v52, v56
  v_add_f32 v53, v53, v57
  v_add_f32 v54, v54, v58
  v_add_f32 v55, v55, v59
  v_cvt_pk_bf16_f32 v56, v52, v53
  v_cvt_pk_bf16_f32 v57, v54, v55
  ds_write_b64 v74, v[56:57]
  v_mov_b32 v64, v60
  v_mov_b32 v65, v61
  v_mov_b32 v66, v62
  v_mov_b32 v67, v63
  v_permlane32_swap_b32 v60, v64
  v_permlane32_swap_b32 v61, v65
  v_permlane32_swap_b32 v62, v66
  v_permlane32_swap_b32 v63, v67
  v_add_f32 v60, v60, v64
  v_add_f32 v61, v61, v65
  v_add_f32 v62, v62, v66
  v_add_f32 v63, v63, v67
  v_cvt_pk_bf16_f32 v64, v60, v61
  v_cvt_pk_bf16_f32 v65, v62, v63
  ds_write_b64 v75, v[64:65]
  s_waitcnt lgkmcnt(0)
  ds_read_b128 v[64:67], v76
  ds_read_b128 v[68:71], v76 offset:1024
  s_waitcnt lgkmcnt(0)
  buffer_store_dwordx4 v[64:67], v2, s[8:11], s25 offen sc1
  buffer_store_dwordx4 v[68:71], v2, s[8:11], s25 offen offset:1024 sc1
  s_waitcnt vmcnt(0)
  s_mov_b64 exec, 1
  buffer_store_dword v78, v2, s[8:11], s26 offen sc1
  s_mov_b64 exec, -1
  s_add_u32 s24, s24, 14336
  s_add_u32 s25, s25, 16384
  s_add_u32 s26, s26, 32
  s_add_u32 s17, s17, 2
  s_cmp_lt_u32 s17, 64
  s_cbranch_scc1 ws_loop
  v_mov_b32 v250, 0
  s_branch wk_loop
wk_s4d:
  s_sub_u32 s3, s3, 480
  s_load_dwordx8 s[40:47], s[0:1], 0
  s_load_dwordx4 s[48:51], s[0:1], 32
  s_load_dwordx2 s[52:53], s[0:1], 48
  s_load_dwordx2 s[54:55], s[0:1], 112
  v_lshrrev_b32 v1, 6, v0
  s_nop 0
  v_readfirstlane_b32 s16, v1
  v_and_b32 v1, 63, v0
  v_lshrrev_b32 v3, 4, v1
  v_and_b32 v4, 15, v1
  s_mul_i32 s17, s16, 24576
  s_waitcnt lgkmcnt(0)
  s_mov_b32 s60, s40
  s_and_b32 s61, s41, 0xffff
  s_mov_b32 s62, 1835008
  s_mov_b32 s63, 0x20000
  s_mov_b32 s64, s42
  s_and_b32 s65, s43, 0xffff
  s_mov_b32 s66, 229376
  s_mov_b32 s67, 0x20000
  s_mov_b32 s68, s44
  s_and_b32 s69, s45, 0xffff
  s_mov_b32 s70, 229376
  s_mov_b32 s71, 0x20000
  s_mov_b32 s72, s46
  s_and_b32 s73, s47, 0xffff
  s_mov_b32 s74, 229376
  s_mov_b32 s75, 0x20000
  s_mov_b32 s76, s48
  s_and_b32 s77, s49, 0xffff
  s_mov_b32 s78, 229376
  s_mov_b32 s79, 0x20000
  s_mov_b32 s80, s50
  s_and_b32 s81, s51, 0xffff
  s_mov_b32 s82, 896
  s_mov_b32 s83, 0x20000
  s_mov_b32 s84, s52
  s_and_b32 s85, s53, 0xffff
  s_mov_b32 s86, 896
  s_mov_b32 s87, 0x20000
  s_mov_b32 s88, s54
  s_and_b32 s89, s55, 0xffff
  s_mov_b32 s90, 3670016
  s_mov_b32 s91, 0x20000
  v_lshlrev_b32 v5, 5, v1
  v_sub_u32 v5, 2047, v5
  s_add_u32 s18, s17, 13056
  v_subrev_u32 v6, 0, v5
  v_max_i32 v7, 0, v6
  v_cvt_f32_u32 v7, v7
  v_cvt_pk_bf16_f32 v8, v7, v7
  v_and_b32 v7, 0xffff0000, v8
  v_lshrrev_b32 v8, 23, v7
  v_subrev_u32 v8, 134, v8
  v_max_i32 v8, 0, v8
  v_cvt_u32_f32 v7, v7
  v_lshrrev_b32 v7, v8, v7
  v_lshl_add_u32 v7, v8, 8, v7
  v_lshl_add_u32 v200, v7, 2, s18
  v_subrev_u32 v6, 1, v5
  v_max_i32 v7, 0, v6
  v_cvt_f32_u32 v7, v7
  v_cvt_pk_bf16_f32 v8, v7, v7
  v_and_b32 v7, 0xffff0000, v8
  v_lshrrev_b32 v8, 23, v7
  v_subrev_u32 v8, 134, v8
  v_max_i32 v8, 0, v8
  v_cvt_u32_f32 v7, v7
  v_lshrrev_b32 v7, v8, v7
  v_lshl_add_u32 v7, v8, 8, v7
  v_lshl_add_u32 v201, v7, 2, s18
  v_subrev_u32 v6, 2, v5
  v_max_i32 v7, 0, v6
  v_cvt_f32_u32 v7, v7
  v_cvt_pk_bf16_f32 v8, v7, v7
  v_and_b32 v7, 0xffff0000, v8
  v_lshrrev_b32 v8, 23, v7
  v_subrev_u32 v8, 134, v8
  v_max_i32 v8, 0, v8
  v_cvt_u32_f32 v7, v7
  v_lshrrev_b32 v7, v8, v7
  v_lshl_add_u32 v7, v8, 8, v7
  v_lshl_add_u32 v202, v7, 2, s18
  v_subrev_u32 v6, 3, v5
  v_max_i32 v7, 0, v6
  v_cvt_f32_u32 v7, v7
  v_cvt_pk_bf16_f32 v8, v7, v7
  v_and_b32 v7, 0xffff0000, v8
  v_lshrrev_b32 v8, 23, v7
  v_subrev_u32 v8, 134, v8
  v_max_i32 v8, 0, v8
  v_cvt_u32_f32 v7, v7
  v_lshrrev_b32 v7, v8, v7
  v_lshl_add_u32 v7, v8, 8, v7
  v_lshl_add_u32 v203, v7, 2, s18
  v_subrev_u32 v6, 4, v5
  v_max_i32 v7, 0, v6
  v_cvt_f32_u32 v7, v7
  v_cvt_pk_bf16_f32 v8, v7, v7
  v_and_b32 v7, 0xffff0000, v8
  v_lshrrev_b32 v8, 23, v7
  v_subrev_u32 v8, 134, v8
  v_max_i32 v8, 0, v8
  v_cvt_u32_f32 v7, v7
  v_lshrrev_b32 v7, v8, v7
  v_lshl_add_u32 v7, v8, 8, v7
  v_lshl_add_u32 v204, v7, 2, s18
  v_subrev_u32 v6, 5, v5
  v_max_i32 v7, 0, v6
  v_cvt_f32_u32 v7, v7
  v_cvt_pk_bf16_f32 v8, v7, v7
  v_and_b32 v7, 0xffff0000, v8
  v_lshrrev_b32 v8, 23, v7
  v_subrev_u32 v8, 134, v8
  v_max_i32 v8, 0, v8
  v_cvt_u32_f32 v7, v7
  v_lshrrev_b32 v7, v8, v7
  v_lshl_add_u32 v7, v8, 8, v7
  v_lshl_add_u32 v205, v7, 2, s18
  v_subrev_u32 v6, 6, v5
  v_max_i32 v7, 0, v6
  v_cvt_f32_u32 v7, v7
  v_cvt_pk_bf16_f32 v8, v7, v7
  v_and_b32 v7, 0xffff0000, v8
  v_lshrrev_b32 v8, 23, v7
  v_subrev_u32 v8, 134, v8
  v_max_i32 v8, 0, v8
  v_cvt_u32_f32 v7, v7
  v_lshrrev_b32 v7, v8, v7
  v_lshl_add_u32 v7, v8, 8, v7
  v_lshl_add_u32 v206, v7, 2, s18
  v_subrev_u32 v6, 7, v5
  v_max_i32 v7, 0, v6
  v_cvt_f32_u32 v7, v7
  v_cvt_pk_bf16_f32 v8, v7, v7
  v_and_b32 v7, 0xffff0000, v8
  v_lshrrev_b32 v8, 23, v7
  v_subrev_u32 v8, 134, v8
  v_max_i32 v8, 0, v8
  v_cvt_u32_f32 v7, v7
  v_lshrrev_b32 v7, v8, v7
  v_lshl_add_u32 v7, v8, 8, v7
  v_lshl_add_u32 v207, v7, 2, s18
  v_subrev_u32 v6, 8, v5
  v_max_i32 v7, 0, v6
  v_cvt_f32_u32 v7, v7
  v_cvt_pk_bf16_f32 v8, v7, v7
  v_and_b32 v7, 0xffff0000, v8
  v_lshrrev_b32 v8, 23, v7
  v_subrev_u32 v8, 134, v8
  v_max_i32 v8, 0, v8
  v_cvt_u32_f32 v7, v7
  v_lshrrev_b32 v7, v8, v7
  v_lshl_add_u32 v7, v8, 8, v7
  v_lshl_add_u32 v208, v7, 2, s18
  v_subrev_u32 v6, 9, v5
  v_max_i32 v7, 0, v6
  v_cvt_f32_u32 v7, v7
  v_cvt_pk_bf16_f32 v8, v7, v7
  v_and_b32 v7, 0xffff0000, v8
  v_lshrrev_b32 v8, 23, v7
  v_subrev_u32 v8, 134, v8
  v_max_i32 v8, 0, v8
  v_cvt_u32_f32 v7, v7
  v_lshrrev_b32 v7, v8, v7
  v_lshl_add_u32 v7, v8, 8, v7
  v_lshl_add_u32 v209, v7, 2, s18
  v_subrev_u32 v6, 10, v5
  v_max_i32 v7, 0, v6
  v_cvt_f32_u32 v7, v7
  v_cvt_pk_bf16_f32 v8, v7, v7
  v_and_b32 v7, 0xffff0000, v8
  v_lshrrev_b32 v8, 23, v7
  v_subrev_u32 v8, 134, v8
  v_max_i32 v8, 0, v8
  v_cvt_u32_f32 v7, v7
  v_lshrrev_b32 v7, v8, v7
  v_lshl_add_u32 v7, v8, 8, v7
  v_lshl_add_u32 v210, v7, 2, s18
  v_subrev_u32 v6, 11, v5
  v_max_i32 v7, 0, v6
  v_cvt_f32_u32 v7, v7
  v_cvt_pk_bf16_f32 v8, v7, v7
  v_and_b32 v7, 0xffff0000, v8
  v_lshrrev_b32 v8, 23, v7
  v_subrev_u32 v8, 134, v8
  v_max_i32 v8, 0, v8
  v_cvt_u32_f32 v7, v7
  v_lshrrev_b32 v7, v8, v7
  v_lshl_add_u32 v7, v8, 8, v7
  v_lshl_add_u32 v211, v7, 2, s18
  v_subrev_u32 v6, 12, v5
  v_max_i32 v7, 0, v6
  v_cvt_f32_u32 v7, v7
  v_cvt_pk_bf16_f32 v8, v7, v7
  v_and_b32 v7, 0xffff0000, v8
  v_lshrrev_b32 v8, 23, v7
  v_subrev_u32 v8, 134, v8
  v_max_i32 v8, 0, v8
  v_cvt_u32_f32 v7, v7
  v_lshrrev_b32 v7, v8, v7
  v_lshl_add_u32 v7, v8, 8, v7
  v_lshl_add_u32 v212, v7, 2, s18
  v_subrev_u32 v6, 13, v5
  v_max_i32 v7, 0, v6
  v_cvt_f32_u32 v7, v7
  v_cvt_pk_bf16_f32 v8, v7, v7
  v_and_b32 v7, 0xffff0000, v8
  v_lshrrev_b32 v8, 23, v7
  v_subrev_u32 v8, 134, v8
  v_max_i32 v8, 0, v8
  v_cvt_u32_f32 v7, v7
  v_lshrrev_b32 v7, v8, v7
  v_lshl_add_u32 v7, v8, 8, v7
  v_lshl_add_u32 v213, v7, 2, s18
  v_subrev_u32 v6, 14, v5
  v_max_i32 v7, 0, v6
  v_cvt_f32_u32 v7, v7
  v_cvt_pk_bf16_f32 v8, v7, v7
  v_and_b32 v7, 0xffff0000, v8
  v_lshrrev_b32 v8, 23, v7
  v_subrev_u32 v8, 134, v8
  v_max_i32 v8, 0, v8
  v_cvt_u32_f32 v7, v7
  v_lshrrev_b32 v7, v8, v7
  v_lshl_add_u32 v7, v8, 8, v7
  v_lshl_add_u32 v214, v7, 2, s18
  v_subrev_u32 v6, 15, v5
  v_max_i32 v7, 0, v6
  v_cvt_f32_u32 v7, v7
  v_cvt_pk_bf16_f32 v8, v7, v7
  v_and_b32 v7, 0xffff0000, v8
  v_lshrrev_b32 v8, 23, v7
  v_subrev_u32 v8, 134, v8
  v_max_i32 v8, 0, v8
  v_cvt_u32_f32 v7, v7
  v_lshrrev_b32 v7, v8, v7
  v_lshl_add_u32 v7, v8, 8, v7
  v_lshl_add_u32 v215, v7, 2, s18
  v_subrev_u32 v6, 16, v5
  v_max_i32 v7, 0, v6
  v_cvt_f32_u32 v7, v7
  v_cvt_pk_bf16_f32 v8, v7, v7
  v_and_b32 v7, 0xffff0000, v8
  v_lshrrev_b32 v8, 23, v7
  v_subrev_u32 v8, 134, v8
  v_max_i32 v8, 0, v8
  v_cvt_u32_f32 v7, v7
  v_lshrrev_b32 v7, v8, v7
  v_lshl_add_u32 v7, v8, 8, v7
  v_lshl_add_u32 v216, v7, 2, s18
  v_subrev_u32 v6, 17, v5
  v_max_i32 v7, 0, v6
  v_cvt_f32_u32 v7, v7
  v_cvt_pk_bf16_f32 v8, v7, v7
  v_and_b32 v7, 0xffff0000, v8
  v_lshrrev_b32 v8, 23, v7
  v_subrev_u32 v8, 134, v8
  v_max_i32 v8, 0, v8
  v_cvt_u32_f32 v7, v7
  v_lshrrev_b32 v7, v8, v7
  v_lshl_add_u32 v7, v8, 8, v7
  v_lshl_add_u32 v217, v7, 2, s18
  v_subrev_u32 v6, 18, v5
  v_max_i32 v7, 0, v6
  v_cvt_f32_u32 v7, v7
  v_cvt_pk_bf16_f32 v8, v7, v7
  v_and_b32 v7, 0xffff0000, v8
  v_lshrrev_b32 v8, 23, v7
  v_subrev_u32 v8, 134, v8
  v_max_i32 v8, 0, v8
  v_cvt_u32_f32 v7, v7
  v_lshrrev_b32 v7, v8, v7
  v_lshl_add_u32 v7, v8, 8, v7
  v_lshl_add_u32 v218, v7, 2, s18
  v_subrev_u32 v6, 19, v5
  v_max_i32 v7, 0, v6
  v_cvt_f32_u32 v7, v7
  v_cvt_pk_bf16_f32 v8, v7, v7
  v_and_b32 v7, 0xffff0000, v8
  v_lshrrev_b32 v8, 23, v7
  v_subrev_u32 v8, 134, v8
  v_max_i32 v8, 0, v8
  v_cvt_u32_f32 v7, v7
  v_lshrrev_b32 v7, v8, v7
  v_lshl_add_u32 v7, v8, 8, v7
  v_lshl_add_u32 v219, v7, 2, s18
  v_subrev_u32 v6, 20, v5
  v_max_i32 v7, 0, v6
  v_cvt_f32_u32 v7, v7
  v_cvt_pk_bf16_f32 v8, v7, v7
  v_and_b32 v7, 0xffff0000, v8
  v_lshrrev_b32 v8, 23, v7
  v_subrev_u32 v8, 134, v8
  v_max_i32 v8, 0, v8
  v_cvt_u32_f32 v7, v7
  v_lshrrev_b32 v7, v8, v7
  v_lshl_add_u32 v7, v8, 8, v7
  v_lshl_add_u32 v220, v7, 2, s18
  v_subrev_u32 v6, 21, v5
  v_max_i32 v7, 0, v6
  v_cvt_f32_u32 v7, v7
  v_cvt_pk_bf16_f32 v8, v7, v7
  v_and_b32 v7, 0xffff0000, v8
  v_lshrrev_b32 v8, 23, v7
  v_subrev_u32 v8, 134, v8
  v_max_i32 v8, 0, v8
  v_cvt_u32_f32 v7, v7
  v_lshrrev_b32 v7, v8, v7
  v_lshl_add_u32 v7, v8, 8, v7
  v_lshl_add_u32 v221, v7, 2, s18
  v_subrev_u32 v6, 22, v5
  v_max_i32 v7, 0, v6
  v_cvt_f32_u32 v7, v7
  v_cvt_pk_bf16_f32 v8, v7, v7
  v_and_b32 v7, 0xffff0000, v8
  v_lshrrev_b32 v8, 23, v7
  v_subrev_u32 v8, 134, v8
  v_max_i32 v8, 0, v8
  v_cvt_u32_f32 v7, v7
  v_lshrrev_b32 v7, v8, v7
  v_lshl_add_u32 v7, v8, 8, v7
  v_lshl_add_u32 v222, v7, 2, s18
  v_subrev_u32 v6, 23, v5
  v_max_i32 v7, 0, v6
  v_cvt_f32_u32 v7, v7
  v_cvt_pk_bf16_f32 v8, v7, v7
  v_and_b32 v7, 0xffff0000, v8
  v_lshrrev_b32 v8, 23, v7
  v_subrev_u32 v8, 134, v8
  v_max_i32 v8, 0, v8
  v_cvt_u32_f32 v7, v7
  v_lshrrev_b32 v7, v8, v7
  v_lshl_add_u32 v7, v8, 8, v7
  v_lshl_add_u32 v223, v7, 2, s18
  v_subrev_u32 v6, 24, v5
  v_max_i32 v7, 0, v6
  v_cvt_f32_u32 v7, v7
  v_cvt_pk_bf16_f32 v8, v7, v7
  v_and_b32 v7, 0xffff0000, v8
  v_lshrrev_b32 v8, 23, v7
  v_subrev_u32 v8, 134, v8
  v_max_i32 v8, 0, v8
  v_cvt_u32_f32 v7, v7
  v_lshrrev_b32 v7, v8, v7
  v_lshl_add_u32 v7, v8, 8, v7
  v_lshl_add_u32 v224, v7, 2, s18
  v_subrev_u32 v6, 25, v5
  v_max_i32 v7, 0, v6
  v_cvt_f32_u32 v7, v7
  v_cvt_pk_bf16_f32 v8, v7, v7
  v_and_b32 v7, 0xffff0000, v8
  v_lshrrev_b32 v8, 23, v7
  v_subrev_u32 v8, 134, v8
  v_max_i32 v8, 0, v8
  v_cvt_u32_f32 v7, v7
  v_lshrrev_b32 v7, v8, v7
  v_lshl_add_u32 v7, v8, 8, v7
  v_lshl_add_u32 v225, v7, 2, s18
  v_subrev_u32 v6, 26, v5
  v_max_i32 v7, 0, v6
  v_cvt_f32_u32 v7, v7
  v_cvt_pk_bf16_f32 v8, v7, v7
  v_and_b32 v7, 0xffff0000, v8
  v_lshrrev_b32 v8, 23, v7
  v_subrev_u32 v8, 134, v8
  v_max_i32 v8, 0, v8
  v_cvt_u32_f32 v7, v7
  v_lshrrev_b32 v7, v8, v7
  v_lshl_add_u32 v7, v8, 8, v7
  v_lshl_add_u32 v226, v7, 2, s18
  v_subrev_u32 v6, 27, v5
  v_max_i32 v7, 0, v6
  v_cvt_f32_u32 v7, v7
  v_cvt_pk_bf16_f32 v8, v7, v7
  v_and_b32 v7, 0xffff0000, v8
  v_lshrrev_b32 v8, 23, v7
  v_subrev_u32 v8, 134, v8
  v_max_i32 v8, 0, v8
  v_cvt_u32_f32 v7, v7
  v_lshrrev_b32 v7, v8, v7
  v_lshl_add_u32 v7, v8, 8, v7
  v_lshl_add_u32 v227, v7, 2, s18
  v_subrev_u32 v6, 28, v5
  v_max_i32 v7, 0, v6
  v_cvt_f32_u32 v7, v7
  v_cvt_pk_bf16_f32 v8, v7, v7
  v_and_b32 v7, 0xffff0000, v8
  v_lshrrev_b32 v8, 23, v7
  v_subrev_u32 v8, 134, v8
  v_max_i32 v8, 0, v8
  v_cvt_u32_f32 v7, v7
  v_lshrrev_b32 v7, v8, v7
  v_lshl_add_u32 v7, v8, 8, v7
  v_lshl_add_u32 v228, v7, 2, s18
  v_subrev_u32 v6, 29, v5
  v_max_i32 v7, 0, v6
  v_cvt_f32_u32 v7, v7
  v_cvt_pk_bf16_f32 v8, v7, v7
  v_and_b32 v7, 0xffff0000, v8
  v_lshrrev_b32 v8, 23, v7
  v_subrev_u32 v8, 134, v8
  v_max_i32 v8, 0, v8
  v_cvt_u32_f32 v7, v7
  v_lshrrev_b32 v7, v8, v7
  v_lshl_add_u32 v7, v8, 8, v7
  v_lshl_add_u32 v229, v7, 2, s18
  v_subrev_u32 v6, 30, v5
  v_max_i32 v7, 0, v6
  v_cvt_f32_u32 v7, v7
  v_cvt_pk_bf16_f32 v8, v7, v7
  v_and_b32 v7, 0xffff0000, v8
  v_lshrrev_b32 v8, 23, v7
  v_subrev_u32 v8, 134, v8
  v_max_i32 v8, 0, v8
  v_cvt_u32_f32 v7, v7
  v_lshrrev_b32 v7, v8, v7
  v_lshl_add_u32 v7, v8, 8, v7
  v_lshl_add_u32 v230, v7, 2, s18
  v_subrev_u32 v6, 31, v5
  v_max_i32 v7, 0, v6
  v_cvt_f32_u32 v7, v7
  v_cvt_pk_bf16_f32 v8, v7, v7
  v_and_b32 v7, 0xffff0000, v8
  v_lshrrev_b32 v8, 23, v7
  v_subrev_u32 v8, 134, v8
  v_max_i32 v8, 0, v8
  v_cvt_u32_f32 v7, v7
  v_lshrrev_b32 v7, v8, v7
  v_lshl_add_u32 v7, v8, 8, v7
  v_lshl_add_u32 v231, v7, 2, s18
  v_subrev_u32 v6, 32, v5
  v_max_i32 v7, 0, v6
  v_cvt_f32_u32 v7, v7
  v_cvt_pk_bf16_f32 v8, v7, v7
  v_and_b32 v7, 0xffff0000, v8
  v_lshrrev_b32 v8, 23, v7
  v_subrev_u32 v8, 134, v8
  v_max_i32 v8, 0, v8
  v_cvt_u32_f32 v7, v7
  v_lshrrev_b32 v7, v8, v7
  v_lshl_add_u32 v7, v8, 8, v7
  v_mov_b32 v8, 1280
  v_cmp_gt_i32 vcc, 0, v6
  s_nop 1
  v_cndmask_b32 v7, v7, v8, vcc
  v_lshl_add_u32 v232, v7, 2, s18
  v_mov_b32 v8, 0
  v_mov_b32 v9, 0
  v_lshlrev_b32 v5, 3, v1
  v_add_u32 v5, s17, v5
  ds_write_b64 v5, v[8:9]
  v_and_b32 v6, 15, v1
  v_lshlrev_b32 v6, 3, v6
  v_add_u32 v6, s17, v6
  ds_write_b64 v6, v[8:9] offset:8704
  ds_write_b64 v6, v[8:9] offset:12928
  v_mov_b32 v6, s17
  ds_write_b64 v6, v[8:9] offset:18176
  s_lshl_b32 s19, s3, 2
  s_add_u32 s20, s19, s16
  s_lshl_b32 s21, s3, 3
  v_mul_u32_u24 v5, 3584, v0
  s_add_u32 s22, s21, 0
  buffer_load_dwordx2 v[8:9], v5, s[60:63], s22 offen offset:0
  buffer_load_dwordx2 v[10:11], v5, s[60:63], s22 offen offset:896
  buffer_load_dwordx2 v[12:13], v5, s[60:63], s22 offen offset:1792
  buffer_load_dwordx2 v[14:15], v5, s[60:63], s22 offen offset:2688
  s_add_u32 s22, s21, 917504
  buffer_load_dwordx2 v[16:17], v5, s[60:63], s22 offen offset:0
  buffer_load_dwordx2 v[18:19], v5, s[60:63], s22 offen offset:896
  buffer_load_dwordx2 v[20:21], v5, s[60:63], s22 offen offset:1792
  buffer_load_dwordx2 v[22:23], v5, s[60:63], s22 offen offset:2688
  s_lshl_b32 s22, s20, 9
  v_lshlrev_b32 v6, 3, v1
  buffer_load_dwordx2 v[24:25], v6, s[64:67], s22 offen
  buffer_load_dwordx2 v[26:27], v6, s[68:71], s22 offen
  buffer_load_dwordx2 v[28:29], v6, s[72:75], s22 offen
  buffer_load_dwordx2 v[30:31], v6, s[76:79], s22 offen
  s_lshl_b32 s22, s20, 1
  v_mov_b32 v7, 0
  buffer_load_ushort v32, v7, s[80:83], s22 offen
  buffer_load_ushort v33, v7, s[84:87], s22 offen
  s_mov_b32 s24, 0x05040100
  s_mov_b32 s25, 0x07060302
  s_barrier
  s_waitcnt vmcnt(6)
  v_lshlrev_b32 v6, 3, v0
  v_perm_b32 v34, v10, v8, s24
  v_perm_b32 v35, v14, v12, s24
  v_add_u32 v36, 512, v6
  ds_write_b64 v36, v[34:35]
  v_perm_b32 v34, v10, v8, s25
  v_perm_b32 v35, v14, v12, s25
  v_add_u32 v36, 25088, v6
  ds_write_b64 v36, v[34:35]
  v_perm_b32 v34, v11, v9, s24
  v_perm_b32 v35, v15, v13, s24
  v_add_u32 v36, 49664, v6
  ds_write_b64 v36, v[34:35]
  v_perm_b32 v34, v11, v9, s25
  v_perm_b32 v35, v15, v13, s25
  v_add_u32 v36, 74240, v6
  ds_write_b64 v36, v[34:35]
  v_perm_b32 v34, v18, v16, s24
  v_perm_b32 v35, v22, v20, s24
  v_add_u32 v36, 2560, v6
  ds_write_b64 v36, v[34:35]
  v_perm_b32 v34, v18, v16, s25
  v_perm_b32 v35, v22, v20, s25
  v_add_u32 v36, 27136, v6
  ds_write_b64 v36, v[34:35]
  v_perm_b32 v34, v19, v17, s24
  v_perm_b32 v35, v23, v21, s24
  v_add_u32 v36, 51712, v6
  ds_write_b64 v36, v[34:35]
  v_perm_b32 v34, v19, v17, s25
  v_perm_b32 v35, v23, v21, s25
  v_add_u32 v36, 76288, v6
  ds_write_b64 v36, v[34:35]
  s_waitcnt vmcnt(0)
  s_mov_b32 s26, 1069066811
  s_mov_b32 s27, 1042479491
  v_lshlrev_b32 v32, 16, v32
  v_lshlrev_b32 v33, 16, v33
  v_mul_f32 v32, s26, v32
  v_exp_f32 v32, v32
  s_nop 0
  v_cvt_pk_bf16_f32 v34, v32, v32
  v_and_b32 v32, 0xffff0000, v34
  v_lshlrev_b32 v37, 6, v1
  v_add_u32 v37, s17, v37
  v_lshlrev_b32 v40, 16, v24
  v_lshlrev_b32 v41, 16, v26
  v_lshlrev_b32 v42, 16, v28
  v_lshlrev_b32 v43, 16, v30
  v_mul_f32 v40, s26, v40
  v_exp_f32 v40, v40
  s_nop 0
  v_cvt_pk_bf16_f32 v34, v40, v40
  v_and_b32 v40, 0xffff0000, v34
  v_mul_f32 v40, v40, v32
  v_mul_f32 v40, s26, v40
  v_sub_f32 v40, 0, v40
  v_mul_f32 v41, v41, v32
  v_mul_f32 v41, s27, v41
  v_mul_f32 v42, v42, v32
  v_mul_f32 v43, v43, v32
  v_add_f32 v42, v42, v42
  v_add_f32 v43, v43, v43
  ds_write_b128 v37, v[40:43] offset:18240
  v_and_b32 v40, 0xffff0000, v24
  v_and_b32 v41, 0xffff0000, v26
  v_and_b32 v42, 0xffff0000, v28
  v_and_b32 v43, 0xffff0000, v30
  v_mul_f32 v40, s26, v40
  v_exp_f32 v40, v40
  s_nop 0
  v_cvt_pk_bf16_f32 v34, v40, v40
  v_and_b32 v40, 0xffff0000, v34
  v_mul_f32 v40, v40, v32
  v_mul_f32 v40, s26, v40
  v_sub_f32 v40, 0, v40
  v_mul_f32 v41, v41, v32
  v_mul_f32 v41, s27, v41
  v_mul_f32 v42, v42, v32
  v_mul_f32 v43, v43, v32
  v_add_f32 v42, v42, v42
  v_add_f32 v43, v43, v43
  ds_write_b128 v37, v[40:43] offset:18256
  v_lshlrev_b32 v40, 16, v25
  v_lshlrev_b32 v41, 16, v27
  v_lshlrev_b32 v42, 16, v29
  v_lshlrev_b32 v43, 16, v31
  v_mul_f32 v40, s26, v40
  v_exp_f32 v40, v40
  s_nop 0
  v_cvt_pk_bf16_f32 v34, v40, v40
  v_and_b32 v40, 0xffff0000, v34
  v_mul_f32 v40, v40, v32
  v_mul_f32 v40, s26, v40
  v_sub_f32 v40, 0, v40
  v_mul_f32 v41, v41, v32
  v_mul_f32 v41, s27, v41
  v_mul_f32 v42, v42, v32
  v_mul_f32 v43, v43, v32
  v_add_f32 v42, v42, v42
  v_add_f32 v43, v43, v43
  ds_write_b128 v37, v[40:43] offset:18272
  v_and_b32 v40, 0xffff0000, v25
  v_and_b32 v41, 0xffff0000, v27
  v_and_b32 v42, 0xffff0000, v29
  v_and_b32 v43, 0xffff0000, v31
  v_mul_f32 v40, s26, v40
  v_exp_f32 v40, v40
  s_nop 0
  v_cvt_pk_bf16_f32 v34, v40, v40
  v_and_b32 v40, 0xffff0000, v34
  v_mul_f32 v40, v40, v32
  v_mul_f32 v40, s26, v40
  v_sub_f32 v40, 0, v40
  v_mul_f32 v41, v41, v32
  v_mul_f32 v41, s27, v41
  v_mul_f32 v42, v42, v32
  v_mul_f32 v43, v43, v32
  v_add_f32 v42, v42, v42
  v_add_f32 v43, v43, v43
  ds_write_b128 v37, v[40:43] offset:18288
  v_cvt_f32_u32 v44, v4
  v_lshlrev_b32 v45, 4, v4
  v_cvt_f32_u32 v45, v45
  v_lshlrev_b32 v46, 4, v3
  v_add_u32 v46, s17, v46
  v_mov_b32 v48, 0
  v_mov_b32 v49, 0
  v_mov_b32 v50, 0
  v_mov_b32 v51, 0
  v_mov_b32 v52, 0
  v_mov_b32 v53, 0
  v_mov_b32 v54, 0
  v_mov_b32 v55, 0
  v_mov_b32 v56, 0
  v_mov_b32 v57, 0
  v_mov_b32 v58, 0
  v_mov_b32 v59, 0
  v_mov_b32 v60, 0
  v_mov_b32 v61, 0
  v_mov_b32 v62, 0
  v_mov_b32 v63, 0
  v_mov_b32 v64, 0
  v_mov_b32 v65, 0
  v_mov_b32 v66, 0
  v_mov_b32 v67, 0
  s_mov_b32 s28, 0
  s_waitcnt lgkmcnt(0)
  ds_read_b128 v[68:71], v46 offset:18240
wk_kl:
  s_waitcnt lgkmcnt(0)
  v_mov_b32 v72, v68
  v_mov_b32 v73, v69
  v_mov_b32 v74, v70
  v_mov_b32 v75, v71
  v_add_u32 v46, 64, v46
  ds_read_b128 v[68:71], v46 offset:18240
  v_mul_f32 v80, v72, v45
  v_mul_f32 v81, v73, v45
  v_exp_f32 v80, v80
  v_fract_f32 v81, v81
  v_cos_f32 v76, v81
  v_sin_f32 v77, v81
  v_mul_f32 v76, v76, v80
  v_mul_f32 v77, v77, v80
  v_mul_f32 v80, v72, v44
  v_mul_f32 v81, v73, v44
  v_exp_f32 v80, v80
  v_fract_f32 v81, v81
  v_cos_f32 v78, v81
  v_sin_f32 v79, v81
  v_mul_f32 v78, v78, v80
  v_mul_f32 v79, v79, v80
  v_mul_f32 v82, v74, v76
  v_mul_f32 v83, v74, v77
  v_fma_f32 v82, -v75, v77, v82
  v_fma_f32 v83, -v75, v76, -v83
  v_mul_f32 v86, v76, v76
  v_mul_f32 v87, v76, v77
  v_fma_f32 v86, -v77, v77, v86
  v_add_f32 v87, v87, v87
  v_mfma_f32_16x16x4_f32 v[48:51], v82, v78, v[48:51]
  v_mul_f32 v88, v78, v78
  v_mul_f32 v89, v78, v79
  v_fma_f32 v88, -v79, v79, v88
  v_add_f32 v89, v89, v89
  v_mfma_f32_16x16x4_f32 v[48:51], v83, v79, v[48:51]
  v_mul_f32 v84, v74, v86
  v_mul_f32 v85, v74, v87
  v_fma_f32 v84, -v75, v87, v84
  v_fma_f32 v85, -v75, v86, -v85
  v_mul_f32 v76, v86, v86
  v_mul_f32 v77, v86, v87
  v_fma_f32 v76, -v87, v87, v76
  v_add_f32 v77, v77, v77
  v_mfma_f32_16x16x4_f32 v[52:55], v84, v88, v[52:55]
  v_mul_f32 v78, v88, v88
  v_mul_f32 v79, v88, v89
  v_fma_f32 v78, -v89, v89, v78
  v_add_f32 v79, v79, v79
  v_mfma_f32_16x16x4_f32 v[52:55], v85, v89, v[52:55]
  v_mul_f32 v82, v74, v76
  v_mul_f32 v83, v74, v77
  v_fma_f32 v82, -v75, v77, v82
  v_fma_f32 v83, -v75, v76, -v83
  v_mul_f32 v86, v76, v76
  v_mul_f32 v87, v76, v77
  v_fma_f32 v86, -v77, v77, v86
  v_add_f32 v87, v87, v87
  v_mfma_f32_16x16x4_f32 v[56:59], v82, v78, v[56:59]
  v_mul_f32 v88, v78, v78
  v_mul_f32 v89, v78, v79
  v_fma_f32 v88, -v79, v79, v88
  v_add_f32 v89, v89, v89
  v_mfma_f32_16x16x4_f32 v[56:59], v83, v79, v[56:59]
  v_mul_f32 v84, v74, v86
  v_mul_f32 v85, v74, v87
  v_fma_f32 v84, -v75, v87, v84
  v_fma_f32 v85, -v75, v86, -v85
  v_mul_f32 v76, v86, v86
  v_mul_f32 v77, v86, v87
  v_fma_f32 v76, -v87, v87, v76
  v_add_f32 v77, v77, v77
  v_mfma_f32_16x16x4_f32 v[60:63], v84, v88, v[60:63]
  v_mfma_f32_16x16x4_f32 v[60:63], v85, v89, v[60:63]
  v_mul_f32 v82, v74, v76
  v_fma_f32 v82, -v75, v77, v82
  s_nop 1
  v_mfma_f32_16x16x4_f32 v[64:67], v82, v88, v[64:67]
  s_add_u32 s28, s28, 1
  s_cmp_lt_u32 s28, 64
  s_cbranch_scc1 wk_kl
  s_nop 15
  s_nop 3
  v_lshlrev_b32 v46, 8, v3
  v_lshl_add_u32 v46, v4, 2, v46
  v_add_u32 v46, s17, v46
  ds_write_b32 v46, v48 offset:13056
  ds_write_b32 v46, v49 offset:13120
  ds_write_b32 v46, v50 offset:13184
  ds_write_b32 v46, v51 offset:13248
  s_waitcnt lgkmcnt(8)
  ds_write_b32 v46, v52 offset:14080
  ds_write_b32 v46, v53 offset:14144
  ds_write_b32 v46, v54 offset:14208
  ds_write_b32 v46, v55 offset:14272
  s_waitcnt lgkmcnt(8)
  ds_write_b32 v46, v56 offset:15104
  ds_write_b32 v46, v57 offset:15168
  ds_write_b32 v46, v58 offset:15232
  ds_write_b32 v46, v59 offset:15296
  s_waitcnt lgkmcnt(8)
  ds_write_b32 v46, v60 offset:16128
  ds_write_b32 v46, v61 offset:16192
  ds_write_b32 v46, v62 offset:16256
  ds_write_b32 v46, v63 offset:16320
  s_waitcnt lgkmcnt(8)
  ds_write_b32 v46, v64 offset:17152
  ds_write_b32 v46, v65 offset:17216
  ds_write_b32 v46, v66 offset:17280
  ds_write_b32 v46, v67 offset:17344
  s_waitcnt lgkmcnt(8)
  s_waitcnt lgkmcnt(0)
  ds_read_b32 v48, v200
  ds_read_b32 v49, v201
  ds_read_b32 v50, v202
  ds_read_b32 v51, v203
  ds_read_b32 v52, v204
  ds_read_b32 v53, v205
  ds_read_b32 v54, v206
  ds_read_b32 v55, v207
  s_waitcnt lgkmcnt(4)
  ds_read_b32 v56, v208
  ds_read_b32 v57, v209
  ds_read_b32 v58, v210
  ds_read_b32 v59, v211
  ds_read_b32 v60, v212
  ds_read_b32 v61, v213
  ds_read_b32 v62, v214
  ds_read_b32 v63, v215
  s_waitcnt lgkmcnt(4)
  ds_read_b32 v64, v216
  ds_read_b32 v65, v217
  ds_read_b32 v66, v218
  ds_read_b32 v67, v219
  ds_read_b32 v68, v220
  ds_read_b32 v69, v221
  ds_read_b32 v70, v222
  ds_read_b32 v71, v223
  s_waitcnt lgkmcnt(4)
  ds_read_b32 v72, v224
  ds_read_b32 v73, v225
  ds_read_b32 v74, v226
  ds_read_b32 v75, v227
  ds_read_b32 v76, v228
  ds_read_b32 v77, v229
  ds_read_b32 v78, v230
  ds_read_b32 v79, v231
  s_waitcnt lgkmcnt(4)
  ds_read_b32 v80, v232
  s_waitcnt lgkmcnt(0)
  v_lshlrev_b32 v46, 6, v1
  v_add_u32 v46, s17, v46
  v_cvt_pk_bf16_f32 v84, v48, v49
  v_cvt_pk_bf16_f32 v88, v49, v50
  v_cvt_pk_bf16_f32 v85, v50, v51
  v_cvt_pk_bf16_f32 v89, v51, v52
  v_cvt_pk_bf16_f32 v86, v52, v53
  v_cvt_pk_bf16_f32 v90, v53, v54
  v_cvt_pk_bf16_f32 v87, v54, v55
  v_cvt_pk_bf16_f32 v91, v55, v56
  ds_write_b128 v46, v[84:87] offset:4608
  ds_write_b128 v46, v[88:91] offset:8832
  s_waitcnt lgkmcnt(0)
  v_cvt_pk_bf16_f32 v84, v56, v57
  v_cvt_pk_bf16_f32 v88, v57, v58
  v_cvt_pk_bf16_f32 v85, v58, v59
  v_cvt_pk_bf16_f32 v89, v59, v60
  v_cvt_pk_bf16_f32 v86, v60, v61
  v_cvt_pk_bf16_f32 v90, v61, v62
  v_cvt_pk_bf16_f32 v87, v62, v63
  v_cvt_pk_bf16_f32 v91, v63, v64
  ds_write_b128 v46, v[84:87] offset:4624
  ds_write_b128 v46, v[88:91] offset:8848
  s_waitcnt lgkmcnt(0)
  v_cvt_pk_bf16_f32 v84, v64, v65
  v_cvt_pk_bf16_f32 v88, v65, v66
  v_cvt_pk_bf16_f32 v85, v66, v67
  v_cvt_pk_bf16_f32 v89, v67, v68
  v_cvt_pk_bf16_f32 v86, v68, v69
  v_cvt_pk_bf16_f32 v90, v69, v70
  v_cvt_pk_bf16_f32 v87, v70, v71
  v_cvt_pk_bf16_f32 v91, v71, v72
  ds_write_b128 v46, v[84:87] offset:4640
  ds_write_b128 v46, v[88:91] offset:8864
  s_waitcnt lgkmcnt(0)
  v_cvt_pk_bf16_f32 v84, v72, v73
  v_cvt_pk_bf16_f32 v88, v73, v74
  v_cvt_pk_bf16_f32 v85, v74, v75
  v_cvt_pk_bf16_f32 v89, v75, v76
  v_cvt_pk_bf16_f32 v86, v76, v77
  v_cvt_pk_bf16_f32 v90, v77, v78
  v_cvt_pk_bf16_f32 v87, v78, v79
  v_cvt_pk_bf16_f32 v91, v79, v80
  ds_write_b128 v46, v[84:87] offset:4656
  ds_write_b128 v46, v[88:91] offset:8880
  s_waitcnt lgkmcnt(0)
  s_barrier
  v_lshrrev_b32 v47, 1, v3
  v_sub_u32 v46, v4, v47
  v_add_u32 v46, 1, v46
  v_lshlrev_b32 v46, 5, v46
  v_and_b32 v48, 1, v3
  v_lshl_add_u32 v46, v48, 4, v46
  v_add_u32 v46, s17, v46
  ds_read_b128 a[0:3], v46 offset:32
  ds_read_b128 a[4:7], v46 offset:96
  ds_read_b128 a[8:11], v46 offset:160
  ds_read_b128 a[12:15], v46 offset:224
  ds_read_b128 a[16:19], v46 offset:288
  ds_read_b128 a[20:23], v46 offset:352
  ds_read_b128 a[24:27], v46 offset:416
  ds_read_b128 a[28:31], v46 offset:480
  s_waitcnt lgkmcnt(4)
  ds_read_b128 a[32:35], v46 offset:544
  ds_read_b128 a[36:39], v46 offset:608
  ds_read_b128 a[40:43], v46 offset:672
  ds_read_b128 a[44:47], v46 offset:736
  ds_read_b128 a[48:51], v46 offset:800
  ds_read_b128 a[52:55], v46 offset:864
  ds_read_b128 a[56:59], v46 offset:928
  ds_read_b128 a[60:63], v46 offset:992
  s_waitcnt lgkmcnt(4)
  ds_read_b128 a[64:67], v46 offset:1056
  ds_read_b128 a[68:71], v46 offset:1120
  ds_read_b128 a[72:75], v46 offset:1184
  ds_read_b128 a[76:79], v46 offset:1248
  ds_read_b128 a[80:83], v46 offset:1312
  ds_read_b128 a[84:87], v46 offset:1376
  ds_read_b128 a[88:91], v46 offset:1440
  ds_read_b128 a[92:95], v46 offset:1504
  s_waitcnt lgkmcnt(4)
  ds_read_b128 a[96:99], v46 offset:1568
  ds_read_b128 a[100:103], v46 offset:1632
  ds_read_b128 a[104:107], v46 offset:1696
  ds_read_b128 a[108:111], v46 offset:1760
  ds_read_b128 a[112:115], v46 offset:1824
  ds_read_b128 a[116:119], v46 offset:1888
  ds_read_b128 a[120:123], v46 offset:1952
  ds_read_b128 a[124:127], v46 offset:2016
  s_waitcnt lgkmcnt(4)
  ds_read_b128 a[128:131], v46 offset:2080
  ds_read_b128 a[132:135], v46 offset:2144
  ds_read_b128 a[136:139], v46 offset:2208
  ds_read_b128 a[140:143], v46 offset:2272
  ds_read_b128 a[144:147], v46 offset:2336
  ds_read_b128 a[148:151], v46 offset:2400
  ds_read_b128 a[152:155], v46 offset:2464
  ds_read_b128 a[156:159], v46 offset:2528
  s_waitcnt lgkmcnt(4)
  ds_read_b128 a[160:163], v46 offset:2592
  ds_read_b128 a[164:167], v46 offset:2656
  ds_read_b128 a[168:171], v46 offset:2720
  ds_read_b128 a[172:175], v46 offset:2784
  ds_read_b128 a[176:179], v46 offset:2848
  ds_read_b128 a[180:183], v46 offset:2912
  ds_read_b128 a[184:187], v46 offset:2976
  ds_read_b128 a[188:191], v46 offset:3040
  s_waitcnt lgkmcnt(4)
  ds_read_b128 a[192:195], v46 offset:3104
  ds_read_b128 a[196:199], v46 offset:3168
  ds_read_b128 a[200:203], v46 offset:3232
  ds_read_b128 a[204:207], v46 offset:3296
  ds_read_b128 a[208:211], v46 offset:3360
  ds_read_b128 a[212:215], v46 offset:3424
  ds_read_b128 a[216:219], v46 offset:3488
  ds_read_b128 a[220:223], v46 offset:3552
  s_waitcnt lgkmcnt(4)
  ds_read_b128 a[224:227], v46 offset:3616
  ds_read_b128 a[228:231], v46 offset:3680
  ds_read_b128 a[232:235], v46 offset:3744
  ds_read_b128 a[236:239], v46 offset:3808
  ds_read_b128 a[240:243], v46 offset:3872
  ds_read_b128 a[244:247], v46 offset:3936
  ds_read_b128 a[248:251], v46 offset:4000
  ds_read_b128 a[252:255], v46 offset:4064
  s_waitcnt lgkmcnt(4)
  v_lshlrev_b32 v49, 4, v47
  v_add_u32 v49, v49, v4
  v_sub_u32 v49, 2047, v49
  v_lshl_add_u32 v49, v48, 3, v49
  v_and_b32 v50, 1, v49
  v_lshrrev_b32 v49, 1, v49
  v_lshlrev_b32 v49, 2, v49
  v_mul_u32_u24 v50, 4224, v50
  v_add3_u32 v49, v49, v50, s17
  v_add_u32 v49, 4608, v49
  v_subrev_u32 v52, 896, v49
  v_subrev_u32 v53, 1856, v49
  v_subrev_u32 v54, 2816, v49
  v_subrev_u32 v55, 3776, v49
  v_subrev_u32 v56, 4736, v49
  s_waitcnt lgkmcnt(0)
  ds_read2_b32 v[92:93], v52 offset0:224 offset1:225
  ds_read2_b32 v[94:95], v52 offset0:226 offset1:227
  ds_read2_b32 v[96:97], v52 offset0:208 offset1:209
  ds_read2_b32 v[98:99], v52 offset0:210 offset1:211
  ds_read2_b32 v[100:101], v52 offset0:192 offset1:193
  ds_read2_b32 v[102:103], v52 offset0:194 offset1:195
  ds_read2_b32 v[104:105], v52 offset0:176 offset1:177
  ds_read2_b32 v[106:107], v52 offset0:178 offset1:179
  s_waitcnt lgkmcnt(6)
  v_mfma_f32_16x16x32_bf16 v[60:63], v[92:95], a[28:31], 0
  v_mfma_f32_16x16x32_bf16 v[64:67], v[92:95], a[60:63], 0
  v_mfma_f32_16x16x32_bf16 v[68:71], v[92:95], a[92:95], 0
  v_mfma_f32_16x16x32_bf16 v[72:75], v[92:95], a[124:127], 0
  v_mfma_f32_16x16x32_bf16 v[76:79], v[92:95], a[156:159], 0
  v_mfma_f32_16x16x32_bf16 v[80:83], v[92:95], a[188:191], 0
  v_mfma_f32_16x16x32_bf16 v[84:87], v[92:95], a[220:223], 0
  v_mfma_f32_16x16x32_bf16 v[88:91], v[92:95], a[252:255], 0
  ds_read2_b32 v[92:93], v52 offset0:160 offset1:161
  ds_read2_b32 v[94:95], v52 offset0:162 offset1:163
  s_waitcnt lgkmcnt(6)
  v_mfma_f32_16x16x32_bf16 v[60:63], v[96:99], a[24:27], v[60:63]
  v_mfma_f32_16x16x32_bf16 v[64:67], v[96:99], a[56:59], v[64:67]
  v_mfma_f32_16x16x32_bf16 v[68:71], v[96:99], a[88:91], v[68:71]
  v_mfma_f32_16x16x32_bf16 v[72:75], v[96:99], a[120:123], v[72:75]
  v_mfma_f32_16x16x32_bf16 v[76:79], v[96:99], a[152:155], v[76:79]
  v_mfma_f32_16x16x32_bf16 v[80:83], v[96:99], a[184:187], v[80:83]
  v_mfma_f32_16x16x32_bf16 v[84:87], v[96:99], a[216:219], v[84:87]
  v_mfma_f32_16x16x32_bf16 v[88:91], v[96:99], a[248:251], v[88:91]
  ds_read2_b32 v[96:97], v52 offset0:144 offset1:145
  ds_read2_b32 v[98:99], v52 offset0:146 offset1:147
  s_waitcnt lgkmcnt(6)
  v_mfma_f32_16x16x32_bf16 v[60:63], v[100:103], a[20:23], v[60:63]
  v_mfma_f32_16x16x32_bf16 v[64:67], v[100:103], a[52:55], v[64:67]
  v_mfma_f32_16x16x32_bf16 v[68:71], v[100:103], a[84:87], v[68:71]
  v_mfma_f32_16x16x32_bf16 v[72:75], v[100:103], a[116:119], v[72:75]
  v_mfma_f32_16x16x32_bf16 v[76:79], v[100:103], a[148:151], v[76:79]
  v_mfma_f32_16x16x32_bf16 v[80:83], v[100:103], a[180:183], v[80:83]
  v_mfma_f32_16x16x32_bf16 v[84:87], v[100:103], a[212:215], v[84:87]
  v_mfma_f32_16x16x32_bf16 v[88:91], v[100:103], a[244:247], v[88:91]
  ds_read2_b32 v[100:101], v52 offset0:128 offset1:129
  ds_read2_b32 v[102:103], v52 offset0:130 offset1:131
  s_waitcnt lgkmcnt(6)
  v_mfma_f32_16x16x32_bf16 v[60:63], v[104:107], a[16:19], v[60:63]
  v_mfma_f32_16x16x32_bf16 v[64:67], v[104:107], a[48:51], v[64:67]
  v_mfma_f32_16x16x32_bf16 v[68:71], v[104:107], a[80:83], v[68:71]
  v_mfma_f32_16x16x32_bf16 v[72:75], v[104:107], a[112:115], v[72:75]
  v_mfma_f32_16x16x32_bf16 v[76:79], v[104:107], a[144:147], v[76:79]
  v_mfma_f32_16x16x32_bf16 v[80:83], v[104:107], a[176:179], v[80:83]
  v_mfma_f32_16x16x32_bf16 v[84:87], v[104:107], a[208:211], v[84:87]
  v_mfma_f32_16x16x32_bf16 v[88:91], v[104:107], a[240:243], v[88:91]
  ds_read2_b32 v[104:105], v52 offset0:112 offset1:113
  ds_read2_b32 v[106:107], v52 offset0:114 offset1:115
  s_waitcnt lgkmcnt(6)
  v_mfma_f32_16x16x32_bf16 v[60:63], v[92:95], a[12:15], v[60:63]
  v_mfma_f32_16x16x32_bf16 v[64:67], v[92:95], a[44:47], v[64:67]
  v_mfma_f32_16x16x32_bf16 v[68:71], v[92:95], a[76:79], v[68:71]
  v_mfma_f32_16x16x32_bf16 v[72:75], v[92:95], a[108:111], v[72:75]
  v_mfma_f32_16x16x32_bf16 v[76:79], v[92:95], a[140:143], v[76:79]
  v_mfma_f32_16x16x32_bf16 v[80:83], v[92:95], a[172:175], v[80:83]
  v_mfma_f32_16x16x32_bf16 v[84:87], v[92:95], a[204:207], v[84:87]
  v_mfma_f32_16x16x32_bf16 v[88:91], v[92:95], a[236:239], v[88:91]
  ds_read2_b32 v[92:93], v52 offset0:96 offset1:97
  ds_read2_b32 v[94:95], v52 offset0:98 offset1:99
  s_waitcnt lgkmcnt(6)
  v_mfma_f32_16x16x32_bf16 v[60:63], v[96:99], a[8:11], v[60:63]
  v_mfma_f32_16x16x32_bf16 v[64:67], v[96:99], a[40:43], v[64:67]
  v_mfma_f32_16x16x32_bf16 v[68:71], v[96:99], a[72:75], v[68:71]
  v_mfma_f32_16x16x32_bf16 v[72:75], v[96:99], a[104:107], v[72:75]
  v_mfma_f32_16x16x32_bf16 v[76:79], v[96:99], a[136:139], v[76:79]
  v_mfma_f32_16x16x32_bf16 v[80:83], v[96:99], a[168:171], v[80:83]
  v_mfma_f32_16x16x32_bf16 v[84:87], v[96:99], a[200:203], v[84:87]
  v_mfma_f32_16x16x32_bf16 v[88:91], v[96:99], a[232:235], v[88:91]
  ds_read2_b32 v[96:97], v52 offset0:80 offset1:81
  ds_read2_b32 v[98:99], v52 offset0:82 offset1:83
  s_waitcnt lgkmcnt(6)
  v_mfma_f32_16x16x32_bf16 v[60:63], v[100:103], a[4:7], v[60:63]
  v_mfma_f32_16x16x32_bf16 v[64:67], v[100:103], a[36:39], v[64:67]
  v_mfma_f32_16x16x32_bf16 v[68:71], v[100:103], a[68:71], v[68:71]
  v_mfma_f32_16x16x32_bf16 v[72:75], v[100:103], a[100:103], v[72:75]
  v_mfma_f32_16x16x32_bf16 v[76:79], v[100:103], a[132:135], v[76:79]
  v_mfma_f32_16x16x32_bf16 v[80:83], v[100:103], a[164:167], v[80:83]
  v_mfma_f32_16x16x32_bf16 v[84:87], v[100:103], a[196:199], v[84:87]
  v_mfma_f32_16x16x32_bf16 v[88:91], v[100:103], a[228:231], v[88:91]
  ds_read2_b32 v[100:101], v52 offset0:64 offset1:65
  ds_read2_b32 v[102:103], v52 offset0:66 offset1:67
  s_waitcnt lgkmcnt(6)
  v_mfma_f32_16x16x32_bf16 v[60:63], v[104:107], a[0:3], v[60:63]
  v_mfma_f32_16x16x32_bf16 v[64:67], v[104:107], a[32:35], v[64:67]
  v_mfma_f32_16x16x32_bf16 v[68:71], v[104:107], a[64:67], v[68:71]
  v_mfma_f32_16x16x32_bf16 v[72:75], v[104:107], a[96:99], v[72:75]
  v_mfma_f32_16x16x32_bf16 v[76:79], v[104:107], a[128:131], v[76:79]
  v_mfma_f32_16x16x32_bf16 v[80:83], v[104:107], a[160:163], v[80:83]
  v_mfma_f32_16x16x32_bf16 v[84:87], v[104:107], a[192:195], v[84:87]
  v_mfma_f32_16x16x32_bf16 v[88:91], v[104:107], a[224:227], v[88:91]
  ds_read2_b32 v[104:105], v52 offset0:48 offset1:49
  ds_read2_b32 v[106:107], v52 offset0:50 offset1:51
  s_waitcnt lgkmcnt(6)
  v_mfma_f32_16x16x32_bf16 v[64:67], v[92:95], a[28:31], v[64:67]
  v_mfma_f32_16x16x32_bf16 v[68:71], v[92:95], a[60:63], v[68:71]
  v_mfma_f32_16x16x32_bf16 v[72:75], v[92:95], a[92:95], v[72:75]
  v_mfma_f32_16x16x32_bf16 v[76:79], v[92:95], a[124:127], v[76:79]
  v_mfma_f32_16x16x32_bf16 v[80:83], v[92:95], a[156:159], v[80:83]
  v_mfma_f32_16x16x32_bf16 v[84:87], v[92:95], a[188:191], v[84:87]
  v_mfma_f32_16x16x32_bf16 v[88:91], v[92:95], a[220:223], v[88:91]
  ds_read2_b32 v[92:93], v52 offset0:32 offset1:33
  ds_read2_b32 v[94:95], v52 offset0:34 offset1:35
  s_waitcnt lgkmcnt(6)
  v_mfma_f32_16x16x32_bf16 v[64:67], v[96:99], a[24:27], v[64:67]
  v_mfma_f32_16x16x32_bf16 v[68:71], v[96:99], a[56:59], v[68:71]
  v_mfma_f32_16x16x32_bf16 v[72:75], v[96:99], a[88:91], v[72:75]
  v_mfma_f32_16x16x32_bf16 v[76:79], v[96:99], a[120:123], v[76:79]
  v_mfma_f32_16x16x32_bf16 v[80:83], v[96:99], a[152:155], v[80:83]
  v_mfma_f32_16x16x32_bf16 v[84:87], v[96:99], a[184:187], v[84:87]
  v_mfma_f32_16x16x32_bf16 v[88:91], v[96:99], a[216:219], v[88:91]
  ds_read2_b32 v[96:97], v52 offset0:16 offset1:17
  ds_read2_b32 v[98:99], v52 offset0:18 offset1:19
  s_waitcnt lgkmcnt(6)
  v_mfma_f32_16x16x32_bf16 v[64:67], v[100:103], a[20:23], v[64:67]
  v_mfma_f32_16x16x32_bf16 v[68:71], v[100:103], a[52:55], v[68:71]
  v_mfma_f32_16x16x32_bf16 v[72:75], v[100:103], a[84:87], v[72:75]
  v_mfma_f32_16x16x32_bf16 v[76:79], v[100:103], a[116:119], v[76:79]
  v_mfma_f32_16x16x32_bf16 v[80:83], v[100:103], a[148:151], v[80:83]
  v_mfma_f32_16x16x32_bf16 v[84:87], v[100:103], a[180:183], v[84:87]
  v_mfma_f32_16x16x32_bf16 v[88:91], v[100:103], a[212:215], v[88:91]
  ds_read2_b32 v[100:101], v52 offset0:0 offset1:1
  ds_read2_b32 v[102:103], v52 offset0:2 offset1:3
  s_waitcnt lgkmcnt(6)
  v_mfma_f32_16x16x32_bf16 v[64:67], v[104:107], a[16:19], v[64:67]
  v_mfma_f32_16x16x32_bf16 v[68:71], v[104:107], a[48:51], v[68:71]
  v_mfma_f32_16x16x32_bf16 v[72:75], v[104:107], a[80:83], v[72:75]
  v_mfma_f32_16x16x32_bf16 v[76:79], v[104:107], a[112:115], v[76:79]
  v_mfma_f32_16x16x32_bf16 v[80:83], v[104:107], a[144:147], v[80:83]
  v_mfma_f32_16x16x32_bf16 v[84:87], v[104:107], a[176:179], v[84:87]
  v_mfma_f32_16x16x32_bf16 v[88:91], v[104:107], a[208:211], v[88:91]
  ds_read2_b32 v[104:105], v53 offset0:224 offset1:225
  ds_read2_b32 v[106:107], v53 offset0:226 offset1:227
  s_waitcnt lgkmcnt(6)
  v_mfma_f32_16x16x32_bf16 v[64:67], v[92:95], a[12:15], v[64:67]
  v_mfma_f32_16x16x32_bf16 v[68:71], v[92:95], a[44:47], v[68:71]
  v_mfma_f32_16x16x32_bf16 v[72:75], v[92:95], a[76:79], v[72:75]
  v_mfma_f32_16x16x32_bf16 v[76:79], v[92:95], a[108:111], v[76:79]
  v_mfma_f32_16x16x32_bf16 v[80:83], v[92:95], a[140:143], v[80:83]
  v_mfma_f32_16x16x32_bf16 v[84:87], v[92:95], a[172:175], v[84:87]
  v_mfma_f32_16x16x32_bf16 v[88:91], v[92:95], a[204:207], v[88:91]
  ds_read2_b32 v[92:93], v53 offset0:208 offset1:209
  ds_read2_b32 v[94:95], v53 offset0:210 offset1:211
  s_waitcnt lgkmcnt(6)
  v_mfma_f32_16x16x32_bf16 v[64:67], v[96:99], a[8:11], v[64:67]
  v_mfma_f32_16x16x32_bf16 v[68:71], v[96:99], a[40:43], v[68:71]
  v_mfma_f32_16x16x32_bf16 v[72:75], v[96:99], a[72:75], v[72:75]
  v_mfma_f32_16x16x32_bf16 v[76:79], v[96:99], a[104:107], v[76:79]
  v_mfma_f32_16x16x32_bf16 v[80:83], v[96:99], a[136:139], v[80:83]
  v_mfma_f32_16x16x32_bf16 v[84:87], v[96:99], a[168:171], v[84:87]
  v_mfma_f32_16x16x32_bf16 v[88:91], v[96:99], a[200:203], v[88:91]
  ds_read2_b32 v[96:97], v53 offset0:192 offset1:193
  ds_read2_b32 v[98:99], v53 offset0:194 offset1:195
  s_waitcnt lgkmcnt(6)
  v_mfma_f32_16x16x32_bf16 v[64:67], v[100:103], a[4:7], v[64:67]
  v_mfma_f32_16x16x32_bf16 v[68:71], v[100:103], a[36:39], v[68:71]
  v_mfma_f32_16x16x32_bf16 v[72:75], v[100:103], a[68:71], v[72:75]
  v_mfma_f32_16x16x32_bf16 v[76:79], v[100:103], a[100:103], v[76:79]
  v_mfma_f32_16x16x32_bf16 v[80:83], v[100:103], a[132:135], v[80:83]
  v_mfma_f32_16x16x32_bf16 v[84:87], v[100:103], a[164:167], v[84:87]
  v_mfma_f32_16x16x32_bf16 v[88:91], v[100:103], a[196:199], v[88:91]
  ds_read2_b32 v[100:101], v53 offset0:176 offset1:177
  ds_read2_b32 v[102:103], v53 offset0:178 offset1:179
  s_waitcnt lgkmcnt(6)
  v_mfma_f32_16x16x32_bf16 v[64:67], v[104:107], a[0:3], v[64:67]
  v_mfma_f32_16x16x32_bf16 v[68:71], v[104:107], a[32:35], v[68:71]
  v_mfma_f32_16x16x32_bf16 v[72:75], v[104:107], a[64:67], v[72:75]
  v_mfma_f32_16x16x32_bf16 v[76:79], v[104:107], a[96:99], v[76:79]
  v_mfma_f32_16x16x32_bf16 v[80:83], v[104:107], a[128:131], v[80:83]
  v_mfma_f32_16x16x32_bf16 v[84:87], v[104:107], a[160:163], v[84:87]
  v_mfma_f32_16x16x32_bf16 v[88:91], v[104:107], a[192:195], v[88:91]
  ds_read2_b32 v[104:105], v53 offset0:160 offset1:161
  ds_read2_b32 v[106:107], v53 offset0:162 offset1:163
  s_waitcnt lgkmcnt(6)
  v_mfma_f32_16x16x32_bf16 v[68:71], v[92:95], a[28:31], v[68:71]
  v_mfma_f32_16x16x32_bf16 v[72:75], v[92:95], a[60:63], v[72:75]
  v_mfma_f32_16x16x32_bf16 v[76:79], v[92:95], a[92:95], v[76:79]
  v_mfma_f32_16x16x32_bf16 v[80:83], v[92:95], a[124:127], v[80:83]
  v_mfma_f32_16x16x32_bf16 v[84:87], v[92:95], a[156:159], v[84:87]
  v_mfma_f32_16x16x32_bf16 v[88:91], v[92:95], a[188:191], v[88:91]
  ds_read2_b32 v[92:93], v53 offset0:144 offset1:145
  ds_read2_b32 v[94:95], v53 offset0:146 offset1:147
  s_waitcnt lgkmcnt(6)
  v_mfma_f32_16x16x32_bf16 v[68:71], v[96:99], a[24:27], v[68:71]
  v_mfma_f32_16x16x32_bf16 v[72:75], v[96:99], a[56:59], v[72:75]
  v_mfma_f32_16x16x32_bf16 v[76:79], v[96:99], a[88:91], v[76:79]
  v_mfma_f32_16x16x32_bf16 v[80:83], v[96:99], a[120:123], v[80:83]
  v_mfma_f32_16x16x32_bf16 v[84:87], v[96:99], a[152:155], v[84:87]
  v_mfma_f32_16x16x32_bf16 v[88:91], v[96:99], a[184:187], v[88:91]
  ds_read2_b32 v[96:97], v53 offset0:128 offset1:129
  ds_read2_b32 v[98:99], v53 offset0:130 offset1:131
  s_waitcnt lgkmcnt(6)
  v_mfma_f32_16x16x32_bf16 v[68:71], v[100:103], a[20:23], v[68:71]
  v_mfma_f32_16x16x32_bf16 v[72:75], v[100:103], a[52:55], v[72:75]
  v_mfma_f32_16x16x32_bf16 v[76:79], v[100:103], a[84:87], v[76:79]
  v_mfma_f32_16x16x32_bf16 v[80:83], v[100:103], a[116:119], v[80:83]
  v_mfma_f32_16x16x32_bf16 v[84:87], v[100:103], a[148:151], v[84:87]
  v_mfma_f32_16x16x32_bf16 v[88:91], v[100:103], a[180:183], v[88:91]
  ds_read2_b32 v[100:101], v53 offset0:112 offset1:113
  ds_read2_b32 v[102:103], v53 offset0:114 offset1:115
  s_waitcnt lgkmcnt(6)
  v_mfma_f32_16x16x32_bf16 v[68:71], v[104:107], a[16:19], v[68:71]
  v_mfma_f32_16x16x32_bf16 v[72:75], v[104:107], a[48:51], v[72:75]
  v_mfma_f32_16x16x32_bf16 v[76:79], v[104:107], a[80:83], v[76:79]
  v_mfma_f32_16x16x32_bf16 v[80:83], v[104:107], a[112:115], v[80:83]
  v_mfma_f32_16x16x32_bf16 v[84:87], v[104:107], a[144:147], v[84:87]
  v_mfma_f32_16x16x32_bf16 v[88:91], v[104:107], a[176:179], v[88:91]
  ds_read2_b32 v[104:105], v53 offset0:96 offset1:97
  ds_read2_b32 v[106:107], v53 offset0:98 offset1:99
  s_waitcnt lgkmcnt(6)
  v_mfma_f32_16x16x32_bf16 v[68:71], v[92:95], a[12:15], v[68:71]
  v_mfma_f32_16x16x32_bf16 v[72:75], v[92:95], a[44:47], v[72:75]
  v_mfma_f32_16x16x32_bf16 v[76:79], v[92:95], a[76:79], v[76:79]
  v_mfma_f32_16x16x32_bf16 v[80:83], v[92:95], a[108:111], v[80:83]
  v_mfma_f32_16x16x32_bf16 v[84:87], v[92:95], a[140:143], v[84:87]
  v_mfma_f32_16x16x32_bf16 v[88:91], v[92:95], a[172:175], v[88:91]
  ds_read2_b32 v[92:93], v53 offset0:80 offset1:81
  ds_read2_b32 v[94:95], v53 offset0:82 offset1:83
  s_waitcnt lgkmcnt(6)
  v_mfma_f32_16x16x32_bf16 v[68:71], v[96:99], a[8:11], v[68:71]
  v_mfma_f32_16x16x32_bf16 v[72:75], v[96:99], a[40:43], v[72:75]
  v_mfma_f32_16x16x32_bf16 v[76:79], v[96:99], a[72:75], v[76:79]
  v_mfma_f32_16x16x32_bf16 v[80:83], v[96:99], a[104:107], v[80:83]
  v_mfma_f32_16x16x32_bf16 v[84:87], v[96:99], a[136:139], v[84:87]
  v_mfma_f32_16x16x32_bf16 v[88:91], v[96:99], a[168:171], v[88:91]
  ds_read2_b32 v[96:97], v53 offset0:64 offset1:65
  ds_read2_b32 v[98:99], v53 offset0:66 offset1:67
  s_waitcnt lgkmcnt(6)
  v_mfma_f32_16x16x32_bf16 v[68:71], v[100:103], a[4:7], v[68:71]
  v_mfma_f32_16x16x32_bf16 v[72:75], v[100:103], a[36:39], v[72:75]
  v_mfma_f32_16x16x32_bf16 v[76:79], v[100:103], a[68:71], v[76:79]
  v_mfma_f32_16x16x32_bf16 v[80:83], v[100:103], a[100:103], v[80:83]
  v_mfma_f32_16x16x32_bf16 v[84:87], v[100:103], a[132:135], v[84:87]
  v_mfma_f32_16x16x32_bf16 v[88:91], v[100:103], a[164:167], v[88:91]
  ds_read2_b32 v[100:101], v53 offset0:48 offset1:49
  ds_read2_b32 v[102:103], v53 offset0:50 offset1:51
  s_waitcnt lgkmcnt(6)
  v_mfma_f32_16x16x32_bf16 v[68:71], v[104:107], a[0:3], v[68:71]
  v_mfma_f32_16x16x32_bf16 v[72:75], v[104:107], a[32:35], v[72:75]
  v_mfma_f32_16x16x32_bf16 v[76:79], v[104:107], a[64:67], v[76:79]
  v_mfma_f32_16x16x32_bf16 v[80:83], v[104:107], a[96:99], v[80:83]
  v_mfma_f32_16x16x32_bf16 v[84:87], v[104:107], a[128:131], v[84:87]
  v_mfma_f32_16x16x32_bf16 v[88:91], v[104:107], a[160:163], v[88:91]
  ds_read2_b32 v[104:105], v53 offset0:32 offset1:33
  ds_read2_b32 v[106:107], v53 offset0:34 offset1:35
  s_waitcnt lgkmcnt(6)
  v_mfma_f32_16x16x32_bf16 v[72:75], v[92:95], a[28:31], v[72:75]
  v_mfma_f32_16x16x32_bf16 v[76:79], v[92:95], a[60:63], v[76:79]
  v_mfma_f32_16x16x32_bf16 v[80:83], v[92:95], a[92:95], v[80:83]
  v_mfma_f32_16x16x32_bf16 v[84:87], v[92:95], a[124:127], v[84:87]
  v_mfma_f32_16x16x32_bf16 v[88:91], v[92:95], a[156:159], v[88:91]
  ds_read2_b32 v[92:93], v53 offset0:16 offset1:17
  ds_read2_b32 v[94:95], v53 offset0:18 offset1:19
  s_waitcnt lgkmcnt(6)
  v_mfma_f32_16x16x32_bf16 v[72:75], v[96:99], a[24:27], v[72:75]
  v_mfma_f32_16x16x32_bf16 v[76:79], v[96:99], a[56:59], v[76:79]
  v_mfma_f32_16x16x32_bf16 v[80:83], v[96:99], a[88:91], v[80:83]
  v_mfma_f32_16x16x32_bf16 v[84:87], v[96:99], a[120:123], v[84:87]
  v_mfma_f32_16x16x32_bf16 v[88:91], v[96:99], a[152:155], v[88:91]
  ds_read2_b32 v[96:97], v53 offset0:0 offset1:1
  ds_read2_b32 v[98:99], v53 offset0:2 offset1:3
  s_waitcnt lgkmcnt(6)
  v_mfma_f32_16x16x32_bf16 v[72:75], v[100:103], a[20:23], v[72:75]
  v_mfma_f32_16x16x32_bf16 v[76:79], v[100:103], a[52:55], v[76:79]
  v_mfma_f32_16x16x32_bf16 v[80:83], v[100:103], a[84:87], v[80:83]
  v_mfma_f32_16x16x32_bf16 v[84:87], v[100:103], a[116:119], v[84:87]
  v_mfma_f32_16x16x32_bf16 v[88:91], v[100:103], a[148:151], v[88:91]
  ds_read2_b32 v[100:101], v54 offset0:224 offset1:225
  ds_read2_b32 v[102:103], v54 offset0:226 offset1:227
  s_waitcnt lgkmcnt(6)
  v_mfma_f32_16x16x32_bf16 v[72:75], v[104:107], a[16:19], v[72:75]
  v_mfma_f32_16x16x32_bf16 v[76:79], v[104:107], a[48:51], v[76:79]
  v_mfma_f32_16x16x32_bf16 v[80:83], v[104:107], a[80:83], v[80:83]
  v_mfma_f32_16x16x32_bf16 v[84:87], v[104:107], a[112:115], v[84:87]
  v_mfma_f32_16x16x32_bf16 v[88:91], v[104:107], a[144:147], v[88:91]
  ds_read2_b32 v[104:105], v54 offset0:208 offset1:209
  ds_read2_b32 v[106:107], v54 offset0:210 offset1:211
  s_waitcnt lgkmcnt(6)
  v_mfma_f32_16x16x32_bf16 v[72:75], v[92:95], a[12:15], v[72:75]
  v_mfma_f32_16x16x32_bf16 v[76:79], v[92:95], a[44:47], v[76:79]
  v_mfma_f32_16x16x32_bf16 v[80:83], v[92:95], a[76:79], v[80:83]
  v_mfma_f32_16x16x32_bf16 v[84:87], v[92:95], a[108:111], v[84:87]
  v_mfma_f32_16x16x32_bf16 v[88:91], v[92:95], a[140:143], v[88:91]
  ds_read2_b32 v[92:93], v54 offset0:192 offset1:193
  ds_read2_b32 v[94:95], v54 offset0:194 offset1:195
  s_waitcnt lgkmcnt(6)
  v_mfma_f32_16x16x32_bf16 v[72:75], v[96:99], a[8:11], v[72:75]
  v_mfma_f32_16x16x32_bf16 v[76:79], v[96:99], a[40:43], v[76:79]
  v_mfma_f32_16x16x32_bf16 v[80:83], v[96:99], a[72:75], v[80:83]
  v_mfma_f32_16x16x32_bf16 v[84:87], v[96:99], a[104:107], v[84:87]
  v_mfma_f32_16x16x32_bf16 v[88:91], v[96:99], a[136:139], v[88:91]
  ds_read2_b32 v[96:97], v54 offset0:176 offset1:177
  ds_read2_b32 v[98:99], v54 offset0:178 offset1:179
  s_waitcnt lgkmcnt(6)
  v_mfma_f32_16x16x32_bf16 v[72:75], v[100:103], a[4:7], v[72:75]
  v_mfma_f32_16x16x32_bf16 v[76:79], v[100:103], a[36:39], v[76:79]
  v_mfma_f32_16x16x32_bf16 v[80:83], v[100:103], a[68:71], v[80:83]
  v_mfma_f32_16x16x32_bf16 v[84:87], v[100:103], a[100:103], v[84:87]
  v_mfma_f32_16x16x32_bf16 v[88:91], v[100:103], a[132:135], v[88:91]
  ds_read2_b32 v[100:101], v54 offset0:160 offset1:161
  ds_read2_b32 v[102:103], v54 offset0:162 offset1:163
  s_waitcnt lgkmcnt(6)
  v_mfma_f32_16x16x32_bf16 v[72:75], v[104:107], a[0:3], v[72:75]
  v_mfma_f32_16x16x32_bf16 v[76:79], v[104:107], a[32:35], v[76:79]
  v_mfma_f32_16x16x32_bf16 v[80:83], v[104:107], a[64:67], v[80:83]
  v_mfma_f32_16x16x32_bf16 v[84:87], v[104:107], a[96:99], v[84:87]
  v_mfma_f32_16x16x32_bf16 v[88:91], v[104:107], a[128:131], v[88:91]
  ds_read2_b32 v[104:105], v54 offset0:144 offset1:145
  ds_read2_b32 v[106:107], v54 offset0:146 offset1:147
  s_waitcnt lgkmcnt(6)
  v_mfma_f32_16x16x32_bf16 v[76:79], v[92:95], a[28:31], v[76:79]
  v_mfma_f32_16x16x32_bf16 v[80:83], v[92:95], a[60:63], v[80:83]
  v_mfma_f32_16x16x32_bf16 v[84:87], v[92:95], a[92:95], v[84:87]
  v_mfma_f32_16x16x32_bf16 v[88:91], v[92:95], a[124:127], v[88:91]
  ds_read2_b32 v[92:93], v54 offset0:128 offset1:129
  ds_read2_b32 v[94:95], v54 offset0:130 offset1:131
  s_waitcnt lgkmcnt(6)
  v_mfma_f32_16x16x32_bf16 v[76:79], v[96:99], a[24:27], v[76:79]
  v_mfma_f32_16x16x32_bf16 v[80:83], v[96:99], a[56:59], v[80:83]
  v_mfma_f32_16x16x32_bf16 v[84:87], v[96:99], a[88:91], v[84:87]
  v_mfma_f32_16x16x32_bf16 v[88:91], v[96:99], a[120:123], v[88:91]
  ds_read2_b32 v[96:97], v54 offset0:112 offset1:113
  ds_read2_b32 v[98:99], v54 offset0:114 offset1:115
  s_waitcnt lgkmcnt(6)
  v_mfma_f32_16x16x32_bf16 v[76:79], v[100:103], a[20:23], v[76:79]
  v_mfma_f32_16x16x32_bf16 v[80:83], v[100:103], a[52:55], v[80:83]
  v_mfma_f32_16x16x32_bf16 v[84:87], v[100:103], a[84:87], v[84:87]
  v_mfma_f32_16x16x32_bf16 v[88:91], v[100:103], a[116:119], v[88:91]
  ds_read2_b32 v[100:101], v54 offset0:96 offset1:97
  ds_read2_b32 v[102:103], v54 offset0:98 offset1:99
  s_waitcnt lgkmcnt(6)
  v_mfma_f32_16x16x32_bf16 v[76:79], v[104:107], a[16:19], v[76:79]
  v_mfma_f32_16x16x32_bf16 v[80:83], v[104:107], a[48:51], v[80:83]
  v_mfma_f32_16x16x32_bf16 v[84:87], v[104:107], a[80:83], v[84:87]
  v_mfma_f32_16x16x32_bf16 v[88:91], v[104:107], a[112:115], v[88:91]
  ds_read2_b32 v[104:105], v54 offset0:80 offset1:81
  ds_read2_b32 v[106:107], v54 offset0:82 offset1:83
  s_waitcnt lgkmcnt(6)
  v_mfma_f32_16x16x32_bf16 v[76:79], v[92:95], a[12:15], v[76:79]
  v_mfma_f32_16x16x32_bf16 v[80:83], v[92:95], a[44:47], v[80:83]
  v_mfma_f32_16x16x32_bf16 v[84:87], v[92:95], a[76:79], v[84:87]
  v_mfma_f32_16x16x32_bf16 v[88:91], v[92:95], a[108:111], v[88:91]
  ds_read2_b32 v[92:93], v54 offset0:64 offset1:65
  ds_read2_b32 v[94:95], v54 offset0:66 offset1:67
  s_waitcnt lgkmcnt(6)
  v_mfma_f32_16x16x32_bf16 v[76:79], v[96:99], a[8:11], v[76:79]
  v_mfma_f32_16x16x32_bf16 v[80:83], v[96:99], a[40:43], v[80:83]
  v_mfma_f32_16x16x32_bf16 v[84:87], v[96:99], a[72:75], v[84:87]
  v_mfma_f32_16x16x32_bf16 v[88:91], v[96:99], a[104:107], v[88:91]
  ds_read2_b32 v[96:97], v54 offset0:48 offset1:49
  ds_read2_b32 v[98:99], v54 offset0:50 offset1:51
  s_waitcnt lgkmcnt(6)
  v_mfma_f32_16x16x32_bf16 v[76:79], v[100:103], a[4:7], v[76:79]
  v_mfma_f32_16x16x32_bf16 v[80:83], v[100:103], a[36:39], v[80:83]
  v_mfma_f32_16x16x32_bf16 v[84:87], v[100:103], a[68:71], v[84:87]
  v_mfma_f32_16x16x32_bf16 v[88:91], v[100:103], a[100:103], v[88:91]
  ds_read2_b32 v[100:101], v54 offset0:32 offset1:33
  ds_read2_b32 v[102:103], v54 offset0:34 offset1:35
  s_waitcnt lgkmcnt(6)
  v_mfma_f32_16x16x32_bf16 v[76:79], v[104:107], a[0:3], v[76:79]
  v_mfma_f32_16x16x32_bf16 v[80:83], v[104:107], a[32:35], v[80:83]
  v_mfma_f32_16x16x32_bf16 v[84:87], v[104:107], a[64:67], v[84:87]
  v_mfma_f32_16x16x32_bf16 v[88:91], v[104:107], a[96:99], v[88:91]
  ds_read2_b32 v[104:105], v54 offset0:16 offset1:17
  ds_read2_b32 v[106:107], v54 offset0:18 offset1:19
  s_waitcnt lgkmcnt(6)
  v_mfma_f32_16x16x32_bf16 v[80:83], v[92:95], a[28:31], v[80:83]
  v_mfma_f32_16x16x32_bf16 v[84:87], v[92:95], a[60:63], v[84:87]
  v_mfma_f32_16x16x32_bf16 v[88:91], v[92:95], a[92:95], v[88:91]
  ds_read2_b32 v[92:93], v54 offset0:0 offset1:1
  ds_read2_b32 v[94:95], v54 offset0:2 offset1:3
  s_waitcnt lgkmcnt(6)
  v_mfma_f32_16x16x32_bf16 v[80:83], v[96:99], a[24:27], v[80:83]
  v_mfma_f32_16x16x32_bf16 v[84:87], v[96:99], a[56:59], v[84:87]
  v_mfma_f32_16x16x32_bf16 v[88:91], v[96:99], a[88:91], v[88:91]
  ds_read2_b32 v[96:97], v55 offset0:224 offset1:225
  ds_read2_b32 v[98:99], v55 offset0:226 offset1:227
  s_waitcnt lgkmcnt(6)
  v_mfma_f32_16x16x32_bf16 v[80:83], v[100:103], a[20:23], v[80:83]
  v_mfma_f32_16x16x32_bf16 v[84:87], v[100:103], a[52:55], v[84:87]
  v_mfma_f32_16x16x32_bf16 v[88:91], v[100:103], a[84:87], v[88:91]
  ds_read2_b32 v[100:101], v55 offset0:208 offset1:209
  ds_read2_b32 v[102:103], v55 offset0:210 offset1:211
  s_waitcnt lgkmcnt(6)
  v_mfma_f32_16x16x32_bf16 v[80:83], v[104:107], a[16:19], v[80:83]
  v_mfma_f32_16x16x32_bf16 v[84:87], v[104:107], a[48:51], v[84:87]
  v_mfma_f32_16x16x32_bf16 v[88:91], v[104:107], a[80:83], v[88:91]
  ds_read2_b32 v[104:105], v55 offset0:192 offset1:193
  ds_read2_b32 v[106:107], v55 offset0:194 offset1:195
  s_waitcnt lgkmcnt(6)
  v_mfma_f32_16x16x32_bf16 v[80:83], v[92:95], a[12:15], v[80:83]
  v_mfma_f32_16x16x32_bf16 v[84:87], v[92:95], a[44:47], v[84:87]
  v_mfma_f32_16x16x32_bf16 v[88:91], v[92:95], a[76:79], v[88:91]
  ds_read2_b32 v[92:93], v55 offset0:176 offset1:177
  ds_read2_b32 v[94:95], v55 offset0:178 offset1:179
  s_waitcnt lgkmcnt(6)
  v_mfma_f32_16x16x32_bf16 v[80:83], v[96:99], a[8:11], v[80:83]
  v_mfma_f32_16x16x32_bf16 v[84:87], v[96:99], a[40:43], v[84:87]
  v_mfma_f32_16x16x32_bf16 v[88:91], v[96:99], a[72:75], v[88:91]
  ds_read2_b32 v[96:97], v55 offset0:160 offset1:161
  ds_read2_b32 v[98:99], v55 offset0:162 offset1:163
  s_waitcnt lgkmcnt(6)
  v_mfma_f32_16x16x32_bf16 v[80:83], v[100:103], a[4:7], v[80:83]
  v_mfma_f32_16x16x32_bf16 v[84:87], v[100:103], a[36:39], v[84:87]
  v_mfma_f32_16x16x32_bf16 v[88:91], v[100:103], a[68:71], v[88:91]
  ds_read2_b32 v[100:101], v55 offset0:144 offset1:145
  ds_read2_b32 v[102:103], v55 offset0:146 offset1:147
  s_waitcnt lgkmcnt(6)
  v_mfma_f32_16x16x32_bf16 v[80:83], v[104:107], a[0:3], v[80:83]
  v_mfma_f32_16x16x32_bf16 v[84:87], v[104:107], a[32:35], v[84:87]
  v_mfma_f32_16x16x32_bf16 v[88:91], v[104:107], a[64:67], v[88:91]
  ds_read2_b32 v[104:105], v55 offset0:128 offset1:129
  ds_read2_b32 v[106:107], v55 offset0:130 offset1:131
  s_waitcnt lgkmcnt(6)
  v_mfma_f32_16x16x32_bf16 v[84:87], v[92:95], a[28:31], v[84:87]
  v_mfma_f32_16x16x32_bf16 v[88:91], v[92:95], a[60:63], v[88:91]
  ds_read2_b32 v[92:93], v55 offset0:112 offset1:113
  ds_read2_b32 v[94:95], v55 offset0:114 offset1:115
  s_waitcnt lgkmcnt(6)
  v_mfma_f32_16x16x32_bf16 v[84:87], v[96:99], a[24:27], v[84:87]
  v_mfma_f32_16x16x32_bf16 v[88:91], v[96:99], a[56:59], v[88:91]
  ds_read2_b32 v[96:97], v55 offset0:96 offset1:97
  ds_read2_b32 v[98:99], v55 offset0:98 offset1:99
  s_waitcnt lgkmcnt(6)
  v_mfma_f32_16x16x32_bf16 v[84:87], v[100:103], a[20:23], v[84:87]
  v_mfma_f32_16x16x32_bf16 v[88:91], v[100:103], a[52:55], v[88:91]
  ds_read2_b32 v[100:101], v55 offset0:80 offset1:81
  ds_read2_b32 v[102:103], v55 offset0:82 offset1:83
  s_waitcnt lgkmcnt(6)
  v_mfma_f32_16x16x32_bf16 v[84:87], v[104:107], a[16:19], v[84:87]
  v_mfma_f32_16x16x32_bf16 v[88:91], v[104:107], a[48:51], v[88:91]
  ds_read2_b32 v[104:105], v55 offset0:64 offset1:65
  ds_read2_b32 v[106:107], v55 offset0:66 offset1:67
  s_waitcnt lgkmcnt(6)
  v_mfma_f32_16x16x32_bf16 v[84:87], v[92:95], a[12:15], v[84:87]
  v_mfma_f32_16x16x32_bf16 v[88:91], v[92:95], a[44:47], v[88:91]
  ds_read2_b32 v[92:93], v55 offset0:48 offset1:49
  ds_read2_b32 v[94:95], v55 offset0:50 offset1:51
  s_waitcnt lgkmcnt(6)
  v_mfma_f32_16x16x32_bf16 v[84:87], v[96:99], a[8:11], v[84:87]
  v_mfma_f32_16x16x32_bf16 v[88:91], v[96:99], a[40:43], v[88:91]
  ds_read2_b32 v[96:97], v55 offset0:32 offset1:33
  ds_read2_b32 v[98:99], v55 offset0:34 offset1:35
  s_waitcnt lgkmcnt(6)
  v_mfma_f32_16x16x32_bf16 v[84:87], v[100:103], a[4:7], v[84:87]
  v_mfma_f32_16x16x32_bf16 v[88:91], v[100:103], a[36:39], v[88:91]
  ds_read2_b32 v[100:101], v55 offset0:16 offset1:17
  ds_read2_b32 v[102:103], v55 offset0:18 offset1:19
  s_waitcnt lgkmcnt(6)
  v_mfma_f32_16x16x32_bf16 v[84:87], v[104:107], a[0:3], v[84:87]
  v_mfma_f32_16x16x32_bf16 v[88:91], v[104:107], a[32:35], v[88:91]
  ds_read2_b32 v[104:105], v55 offset0:0 offset1:1
  ds_read2_b32 v[106:107], v55 offset0:2 offset1:3
  s_waitcnt lgkmcnt(6)
  v_mfma_f32_16x16x32_bf16 v[88:91], v[92:95], a[28:31], v[88:91]
  ds_read2_b32 v[92:93], v56 offset0:224 offset1:225
  ds_read2_b32 v[94:95], v56 offset0:226 offset1:227
  s_waitcnt lgkmcnt(6)
  v_mfma_f32_16x16x32_bf16 v[88:91], v[96:99], a[24:27], v[88:91]
  ds_read2_b32 v[96:97], v56 offset0:208 offset1:209
  ds_read2_b32 v[98:99], v56 offset0:210 offset1:211
  s_waitcnt lgkmcnt(6)
  v_mfma_f32_16x16x32_bf16 v[88:91], v[100:103], a[20:23], v[88:91]
  ds_read2_b32 v[100:101], v56 offset0:192 offset1:193
  ds_read2_b32 v[102:103], v56 offset0:194 offset1:195
  s_waitcnt lgkmcnt(6)
  v_mfma_f32_16x16x32_bf16 v[88:91], v[104:107], a[16:19], v[88:91]
  ds_read2_b32 v[104:105], v56 offset0:176 offset1:177
  ds_read2_b32 v[106:107], v56 offset0:178 offset1:179
  s_waitcnt lgkmcnt(6)
  v_mfma_f32_16x16x32_bf16 v[88:91], v[92:95], a[12:15], v[88:91]
  s_waitcnt lgkmcnt(4)
  v_mfma_f32_16x16x32_bf16 v[88:91], v[96:99], a[8:11], v[88:91]
  s_waitcnt lgkmcnt(2)
  v_mfma_f32_16x16x32_bf16 v[88:91], v[100:103], a[4:7], v[88:91]
  s_waitcnt lgkmcnt(0)
  v_mfma_f32_16x16x32_bf16 v[88:91], v[104:107], a[0:3], v[88:91]
  v_lshlrev_b32 v46, 5, v4
  v_lshl_add_u32 v46, v3, 3, v46
  v_add_u32 v46, s17, v46
  ds_read_b64 v[108:109], v46 offset:512
  ds_read_b64 v[110:111], v46 offset:1024
  ds_read_b64 v[112:113], v46 offset:1536
  ds_read_b64 v[114:115], v46 offset:2048
  ds_read_b64 v[116:117], v46 offset:2560
  ds_read_b64 v[118:119], v46 offset:3072
  ds_read_b64 v[120:121], v46 offset:3584
  ds_read_b64 v[122:123], v46 offset:4096
  s_waitcnt lgkmcnt(0)
  v_lshlrev_b32 v124, 16, v108
  v_and_b32 v125, 0xffff0000, v108
  v_lshlrev_b32 v126, 16, v109
  v_and_b32 v127, 0xffff0000, v109
  v_mul_f32 v124, v124, v33
  v_mul_f32 v125, v125, v33
  v_mul_f32 v126, v126, v33
  v_mul_f32 v127, v127, v33
  v_cvt_pk_bf16_f32 v128, v124, v125
  v_cvt_pk_bf16_f32 v129, v126, v127
  v_cvt_pk_bf16_f32 v130, v60, v61
  v_cvt_pk_bf16_f32 v131, v62, v63
  v_lshlrev_b32 v124, 16, v128
  v_and_b32 v125, 0xffff0000, v128
  v_lshlrev_b32 v132, 16, v130
  v_and_b32 v133, 0xffff0000, v130
  v_lshlrev_b32 v126, 16, v129
  v_and_b32 v127, 0xffff0000, v129
  v_lshlrev_b32 v134, 16, v131
  v_and_b32 v135, 0xffff0000, v131
  v_add_f32 v124, v124, v132
  v_add_f32 v125, v125, v133
  v_add_f32 v126, v126, v134
  v_add_f32 v127, v127, v135
  v_cvt_pk_bf16_f32 v108, v124, v125
  v_cvt_pk_bf16_f32 v109, v126, v127
  ds_write_b64 v46, v[108:109] offset:512
  v_lshlrev_b32 v124, 16, v110
  v_and_b32 v125, 0xffff0000, v110
  v_lshlrev_b32 v126, 16, v111
  v_and_b32 v127, 0xffff0000, v111
  v_mul_f32 v124, v124, v33
  v_mul_f32 v125, v125, v33
  v_mul_f32 v126, v126, v33
  v_mul_f32 v127, v127, v33
  v_cvt_pk_bf16_f32 v128, v124, v125
  v_cvt_pk_bf16_f32 v129, v126, v127
  v_cvt_pk_bf16_f32 v130, v64, v65
  v_cvt_pk_bf16_f32 v131, v66, v67
  v_lshlrev_b32 v124, 16, v128
  v_and_b32 v125, 0xffff0000, v128
  v_lshlrev_b32 v132, 16, v130
  v_and_b32 v133, 0xffff0000, v130
  v_lshlrev_b32 v126, 16, v129
  v_and_b32 v127, 0xffff0000, v129
  v_lshlrev_b32 v134, 16, v131
  v_and_b32 v135, 0xffff0000, v131
  v_add_f32 v124, v124, v132
  v_add_f32 v125, v125, v133
  v_add_f32 v126, v126, v134
  v_add_f32 v127, v127, v135
  v_cvt_pk_bf16_f32 v110, v124, v125
  v_cvt_pk_bf16_f32 v111, v126, v127
  ds_write_b64 v46, v[110:111] offset:1024
  v_lshlrev_b32 v124, 16, v112
  v_and_b32 v125, 0xffff0000, v112
  v_lshlrev_b32 v126, 16, v113
  v_and_b32 v127, 0xffff0000, v113
  v_mul_f32 v124, v124, v33
  v_mul_f32 v125, v125, v33
  v_mul_f32 v126, v126, v33
  v_mul_f32 v127, v127, v33
  v_cvt_pk_bf16_f32 v128, v124, v125
  v_cvt_pk_bf16_f32 v129, v126, v127
  v_cvt_pk_bf16_f32 v130, v68, v69
  v_cvt_pk_bf16_f32 v131, v70, v71
  v_lshlrev_b32 v124, 16, v128
  v_and_b32 v125, 0xffff0000, v128
  v_lshlrev_b32 v132, 16, v130
  v_and_b32 v133, 0xffff0000, v130
  v_lshlrev_b32 v126, 16, v129
  v_and_b32 v127, 0xffff0000, v129
  v_lshlrev_b32 v134, 16, v131
  v_and_b32 v135, 0xffff0000, v131
  v_add_f32 v124, v124, v132
  v_add_f32 v125, v125, v133
  v_add_f32 v126, v126, v134
  v_add_f32 v127, v127, v135
  v_cvt_pk_bf16_f32 v112, v124, v125
  v_cvt_pk_bf16_f32 v113, v126, v127
  ds_write_b64 v46, v[112:113] offset:1536
  v_lshlrev_b32 v124, 16, v114
  v_and_b32 v125, 0xffff0000, v114
  v_lshlrev_b32 v126, 16, v115
  v_and_b32 v127, 0xffff0000, v115
  v_mul_f32 v124, v124, v33
  v_mul_f32 v125, v125, v33
  v_mul_f32 v126, v126, v33
  v_mul_f32 v127, v127, v33
  v_cvt_pk_bf16_f32 v128, v124, v125
  v_cvt_pk_bf16_f32 v129, v126, v127
  v_cvt_pk_bf16_f32 v130, v72, v73
  v_cvt_pk_bf16_f32 v131, v74, v75
  v_lshlrev_b32 v124, 16, v128
  v_and_b32 v125, 0xffff0000, v128
  v_lshlrev_b32 v132, 16, v130
  v_and_b32 v133, 0xffff0000, v130
  v_lshlrev_b32 v126, 16, v129
  v_and_b32 v127, 0xffff0000, v129
  v_lshlrev_b32 v134, 16, v131
  v_and_b32 v135, 0xffff0000, v131
  v_add_f32 v124, v124, v132
  v_add_f32 v125, v125, v133
  v_add_f32 v126, v126, v134
  v_add_f32 v127, v127, v135
  v_cvt_pk_bf16_f32 v114, v124, v125
  v_cvt_pk_bf16_f32 v115, v126, v127
  ds_write_b64 v46, v[114:115] offset:2048
  v_lshlrev_b32 v124, 16, v116
  v_and_b32 v125, 0xffff0000, v116
  v_lshlrev_b32 v126, 16, v117
  v_and_b32 v127, 0xffff0000, v117
  v_mul_f32 v124, v124, v33
  v_mul_f32 v125, v125, v33
  v_mul_f32 v126, v126, v33
  v_mul_f32 v127, v127, v33
  v_cvt_pk_bf16_f32 v128, v124, v125
  v_cvt_pk_bf16_f32 v129, v126, v127
  v_cvt_pk_bf16_f32 v130, v76, v77
  v_cvt_pk_bf16_f32 v131, v78, v79
  v_lshlrev_b32 v124, 16, v128
  v_and_b32 v125, 0xffff0000, v128
  v_lshlrev_b32 v132, 16, v130
  v_and_b32 v133, 0xffff0000, v130
  v_lshlrev_b32 v126, 16, v129
  v_and_b32 v127, 0xffff0000, v129
  v_lshlrev_b32 v134, 16, v131
  v_and_b32 v135, 0xffff0000, v131
  v_add_f32 v124, v124, v132
  v_add_f32 v125, v125, v133
  v_add_f32 v126, v126, v134
  v_add_f32 v127, v127, v135
  v_cvt_pk_bf16_f32 v116, v124, v125
  v_cvt_pk_bf16_f32 v117, v126, v127
  ds_write_b64 v46, v[116:117] offset:2560
  v_lshlrev_b32 v124, 16, v118
  v_and_b32 v125, 0xffff0000, v118
  v_lshlrev_b32 v126, 16, v119
  v_and_b32 v127, 0xffff0000, v119
  v_mul_f32 v124, v124, v33
  v_mul_f32 v125, v125, v33
  v_mul_f32 v126, v126, v33
  v_mul_f32 v127, v127, v33
  v_cvt_pk_bf16_f32 v128, v124, v125
  v_cvt_pk_bf16_f32 v129, v126, v127
  v_cvt_pk_bf16_f32 v130, v80, v81
  v_cvt_pk_bf16_f32 v131, v82, v83
  v_lshlrev_b32 v124, 16, v128
  v_and_b32 v125, 0xffff0000, v128
  v_lshlrev_b32 v132, 16, v130
  v_and_b32 v133, 0xffff0000, v130
  v_lshlrev_b32 v126, 16, v129
  v_and_b32 v127, 0xffff0000, v129
  v_lshlrev_b32 v134, 16, v131
  v_and_b32 v135, 0xffff0000, v131
  v_add_f32 v124, v124, v132
  v_add_f32 v125, v125, v133
  v_add_f32 v126, v126, v134
  v_add_f32 v127, v127, v135
  v_cvt_pk_bf16_f32 v118, v124, v125
  v_cvt_pk_bf16_f32 v119, v126, v127
  ds_write_b64 v46, v[118:119] offset:3072
  v_lshlrev_b32 v124, 16, v120
  v_and_b32 v125, 0xffff0000, v120
  v_lshlrev_b32 v126, 16, v121
  v_and_b32 v127, 0xffff0000, v121
  v_mul_f32 v124, v124, v33
  v_mul_f32 v125, v125, v33
  v_mul_f32 v126, v126, v33
  v_mul_f32 v127, v127, v33
  v_cvt_pk_bf16_f32 v128, v124, v125
  v_cvt_pk_bf16_f32 v129, v126, v127
  v_cvt_pk_bf16_f32 v130, v84, v85
  v_cvt_pk_bf16_f32 v131, v86, v87
  v_lshlrev_b32 v124, 16, v128
  v_and_b32 v125, 0xffff0000, v128
  v_lshlrev_b32 v132, 16, v130
  v_and_b32 v133, 0xffff0000, v130
  v_lshlrev_b32 v126, 16, v129
  v_and_b32 v127, 0xffff0000, v129
  v_lshlrev_b32 v134, 16, v131
  v_and_b32 v135, 0xffff0000, v131
  v_add_f32 v124, v124, v132
  v_add_f32 v125, v125, v133
  v_add_f32 v126, v126, v134
  v_add_f32 v127, v127, v135
  v_cvt_pk_bf16_f32 v120, v124, v125
  v_cvt_pk_bf16_f32 v121, v126, v127
  ds_write_b64 v46, v[120:121] offset:3584
  v_lshlrev_b32 v124, 16, v122
  v_and_b32 v125, 0xffff0000, v122
  v_lshlrev_b32 v126, 16, v123
  v_and_b32 v127, 0xffff0000, v123
  v_mul_f32 v124, v124, v33
  v_mul_f32 v125, v125, v33
  v_mul_f32 v126, v126, v33
  v_mul_f32 v127, v127, v33
  v_cvt_pk_bf16_f32 v128, v124, v125
  v_cvt_pk_bf16_f32 v129, v126, v127
  v_cvt_pk_bf16_f32 v130, v88, v89
  v_cvt_pk_bf16_f32 v131, v90, v91
  v_lshlrev_b32 v124, 16, v128
  v_and_b32 v125, 0xffff0000, v128
  v_lshlrev_b32 v132, 16, v130
  v_and_b32 v133, 0xffff0000, v130
  v_lshlrev_b32 v126, 16, v129
  v_and_b32 v127, 0xffff0000, v129
  v_lshlrev_b32 v134, 16, v131
  v_and_b32 v135, 0xffff0000, v131
  v_add_f32 v124, v124, v132
  v_add_f32 v125, v125, v133
  v_add_f32 v126, v126, v134
  v_add_f32 v127, v127, v135
  v_cvt_pk_bf16_f32 v122, v124, v125
  v_cvt_pk_bf16_f32 v123, v126, v127
  ds_write_b64 v46, v[122:123] offset:4096
  s_waitcnt lgkmcnt(0)
  s_barrier
  v_lshlrev_b32 v6, 3, v0
  v_mul_u32_u24 v5, 7168, v0
  v_add_u32 v36, 512, v6
  ds_read_b64 v[8:9], v36
  v_add_u32 v36, 25088, v6
  ds_read_b64 v[10:11], v36
  v_add_u32 v36, 49664, v6
  ds_read_b64 v[12:13], v36
  v_add_u32 v36, 74240, v6
  ds_read_b64 v[14:15], v36
  s_waitcnt lgkmcnt(0)
  s_add_u32 s22, s21, 0
  s_add_u32 s23, s22, 3584
  v_perm_b32 v16, v10, v8, s24
  v_perm_b32 v17, v14, v12, s24
  buffer_store_dwordx2 v[16:17], v5, s[88:91], s22 offen offset:0
  v_perm_b32 v18, v10, v8, s25
  v_perm_b32 v19, v14, v12, s25
  buffer_store_dwordx2 v[18:19], v5, s[88:91], s22 offen offset:1792
  v_perm_b32 v20, v11, v9, s24
  v_perm_b32 v21, v15, v13, s24
  buffer_store_dwordx2 v[20:21], v5, s[88:91], s23 offen offset:0
  v_perm_b32 v22, v11, v9, s25
  v_perm_b32 v23, v15, v13, s25
  buffer_store_dwordx2 v[22:23], v5, s[88:91], s23 offen offset:1792
  v_add_u32 v36, 2560, v6
  ds_read_b64 v[8:9], v36
  v_add_u32 v36, 27136, v6
  ds_read_b64 v[10:11], v36
  v_add_u32 v36, 51712, v6
  ds_read_b64 v[12:13], v36
  v_add_u32 v36, 76288, v6
  ds_read_b64 v[14:15], v36
  s_waitcnt lgkmcnt(0)
  s_add_u32 s22, s21, 1835008
  s_add_u32 s23, s22, 3584
  v_perm_b32 v24, v10, v8, s24
  v_perm_b32 v25, v14, v12, s24
  buffer_store_dwordx2 v[24:25], v5, s[88:91], s22 offen offset:0
  v_perm_b32 v26, v10, v8, s25
  v_perm_b32 v27, v14, v12, s25
  buffer_store_dwordx2 v[26:27], v5, s[88:91], s22 offen offset:1792
  v_perm_b32 v28, v11, v9, s24
  v_perm_b32 v29, v15, v13, s24
  buffer_store_dwordx2 v[28:29], v5, s[88:91], s23 offen offset:0
  v_perm_b32 v30, v11, v9, s25
  v_perm_b32 v31, v15, v13, s25
  buffer_store_dwordx2 v[30:31], v5, s[88:91], s23 offen offset:1792
  s_branch wk_loop
wk_tok:
  s_sub_u32 s3, s3, 592
  s_cmp_ge_u32 s3, 512
  s_cbranch_scc1 wk_done
  s_lshr_b32 s17, s3, 3
  s_and_b32 s18, s3, 3
  s_bitcmp1_b32 s3, 2
  s_cbranch_scc1 wk_toko
  s_lshl_b32 s20, s18, 2
  s_add_u32 s20, s20, s16
  s_lshl_b32 s21, s17, 4
  s_add_u32 s21, s21, s20
  s_mul_i32 s21, s21, 28672
  s_add_u32 s21, s21, 12845056
  s_mul_i32 s23, s17, 28672
  s_add_u32 s23, s23, 73400320
  s_mul_i32 s24, s17, 7168
  s_add_u32 s24, s24, 88068096
  s_lshr_b32 s25, s17, 3
  s_lshl_b32 s25, s25, 4
  s_add_u32 s25, s25, s20
  s_lshl_b32 s25, s25, 2
  s_add_u32 s25, s25, 88527360
  v_mov_b32 v60, 0
  s_mov_b32 s30, 0
wp_wf:
  buffer_load_dword v61, v60, s[8:11], s25 offen sc1
  s_waitcnt vmcnt(0)
  v_cmp_ne_u32 vcc, 56, v61
  s_cbranch_vccz wp_wf_ok
  s_sleep 4
  s_cmp_ge_u32 s17, 56
  s_cbranch_scc1 wp_wf_bo
  s_sleep 127
wp_wf_bo:
  s_add_u32 s30, s30, 1
  s_cmp_lt_u32 s30, 2000000
  s_cbranch_scc1 wp_wf
  s_branch wp_abort
wp_wf_ok:
  s_add_u32 s22, s21, 0
  buffer_load_dwordx4 a[0:3], v2, s[8:11], s22 offen offset:0 sc1
  buffer_load_dwordx4 a[4:7], v2, s[8:11], s22 offen offset:1024 sc1
  buffer_load_dwordx4 a[8:11], v2, s[8:11], s22 offen offset:2048 sc1
  buffer_load_dwordx4 a[12:15], v2, s[8:11], s22 offen offset:3072 sc1
  s_add_u32 s22, s21, 4096
  buffer_load_dwordx4 a[16:19], v2, s[8:11], s22 offen offset:0 sc1
  buffer_load_dwordx4 a[20:23], v2, s[8:11], s22 offen offset:1024 sc1
  buffer_load_dwordx4 a[24:27], v2, s[8:11], s22 offen offset:2048 sc1
  buffer_load_dwordx4 a[28:31], v2, s[8:11], s22 offen offset:3072 sc1
  s_add_u32 s22, s21, 8192
  buffer_load_dwordx4 a[32:35], v2, s[8:11], s22 offen offset:0 sc1
  buffer_load_dwordx4 a[36:39], v2, s[8:11], s22 offen offset:1024 sc1
  buffer_load_dwordx4 a[40:43], v2, s[8:11], s22 offen offset:2048 sc1
  buffer_load_dwordx4 a[44:47], v2, s[8:11], s22 offen offset:3072 sc1
  s_add_u32 s22, s21, 12288
  buffer_load_dwordx4 a[48:51], v2, s[8:11], s22 offen offset:0 sc1
  buffer_load_dwordx4 a[52:55], v2, s[8:11], s22 offen offset:1024 sc1
  buffer_load_dwordx4 a[56:59], v2, s[8:11], s22 offen offset:2048 sc1
  buffer_load_dwordx4 a[60:63], v2, s[8:11], s22 offen offset:3072 sc1
  s_add_u32 s22, s21, 16384
  buffer_load_dwordx4 a[64:67], v2, s[8:11], s22 offen offset:0 sc1
  buffer_load_dwordx4 a[68:71], v2, s[8:11], s22 offen offset:1024 sc1
  buffer_load_dwordx4 a[72:75], v2, s[8:11], s22 offen offset:2048 sc1
  buffer_load_dwordx4 a[76:79], v2, s[8:11], s22 offen offset:3072 sc1
  s_add_u32 s22, s21, 20480
  buffer_load_dwordx4 a[80:83], v2, s[8:11], s22 offen offset:0 sc1
  buffer_load_dwordx4 a[84:87], v2, s[8:11], s22 offen offset:1024 sc1
  buffer_load_dwordx4 a[88:91], v2, s[8:11], s22 offen offset:2048 sc1
  buffer_load_dwordx4 a[92:95], v2, s[8:11], s22 offen offset:3072 sc1
  s_add_u32 s22, s21, 24576
  buffer_load_dwordx4 a[96:99], v2, s[8:11], s22 offen offset:0 sc1
  buffer_load_dwordx4 a[100:103], v2, s[8:11], s22 offen offset:1024 sc1
  buffer_load_dwordx4 a[104:107], v2, s[8:11], s22 offen offset:2048 sc1
  buffer_load_dwordx4 a[108:111], v2, s[8:11], s22 offen offset:3072 sc1
  s_add_u32 s22, s23, 0
  buffer_load_dwordx4 a[112:115], v2, s[8:11], s22 offen offset:0
  buffer_load_dwordx4 a[116:119], v2, s[8:11], s22 offen offset:1024
  buffer_load_dwordx4 a[120:123], v2, s[8:11], s22 offen offset:2048
  buffer_load_dwordx4 a[124:127], v2, s[8:11], s22 offen offset:3072
  s_add_u32 s22, s23, 4096
  buffer_load_dwordx4 a[128:131], v2, s[8:11], s22 offen offset:0
  buffer_load_dwordx4 a[132:135], v2, s[8:11], s22 offen offset:1024
  buffer_load_dwordx4 a[136:139], v2, s[8:11], s22 offen offset:2048
  buffer_load_dwordx4 a[140:143], v2, s[8:11], s22 offen offset:3072
  s_add_u32 s22, s23, 8192
  buffer_load_dwordx4 a[144:147], v2, s[8:11], s22 offen offset:0
  buffer_load_dwordx4 a[148:151], v2, s[8:11], s22 offen offset:1024
  buffer_load_dwordx4 a[152:155], v2, s[8:11], s22 offen offset:2048
  buffer_load_dwordx4 a[156:159], v2, s[8:11], s22 offen offset:3072
  s_add_u32 s22, s23, 12288
  buffer_load_dwordx4 a[160:163], v2, s[8:11], s22 offen offset:0
  buffer_load_dwordx4 a[164:167], v2, s[8:11], s22 offen offset:1024
  buffer_load_dwordx4 a[168:171], v2, s[8:11], s22 offen offset:2048
  buffer_load_dwordx4 a[172:175], v2, s[8:11], s22 offen offset:3072
  s_add_u32 s22, s23, 16384
  buffer_load_dwordx4 a[176:179], v2, s[8:11], s22 offen offset:0
  buffer_load_dwordx4 a[180:183], v2, s[8:11], s22 offen offset:1024
  buffer_load_dwordx4 a[184:187], v2, s[8:11], s22 offen offset:2048
  buffer_load_dwordx4 a[188:191], v2, s[8:11], s22 offen offset:3072
  s_add_u32 s22, s23, 20480
  buffer_load_dwordx4 a[192:195], v2, s[8:11], s22 offen offset:0
  buffer_load_dwordx4 a[196:199], v2, s[8:11], s22 offen offset:1024
  buffer_load_dwordx4 a[200:203], v2, s[8:11], s22 offen offset:2048
  buffer_load_dwordx4 a[204:207], v2, s[8:11], s22 offen offset:3072
  s_add_u32 s22, s23, 24576
  buffer_load_dwordx4 a[208:211], v2, s[8:11], s22 offen offset:0
  buffer_load_dwordx4 a[212:215], v2, s[8:11], s22 offen offset:1024
  buffer_load_dwordx4 a[216:219], v2, s[8:11], s22 offen offset:2048
  buffer_load_dwordx4 a[220:223], v2, s[8:11], s22 offen offset:3072
  v_lshl_add_u32 v5, v3, 2, 0
  v_cmp_le_u32 s[40:41], v5, v4
  v_lshl_add_u32 v5, v3, 2, 1
  v_cmp_le_u32 s[42:43], v5, v4
  v_lshl_add_u32 v5, v3, 2, 2
  v_cmp_le_u32 s[44:45], v5, v4
  v_lshl_add_u32 v5, v3, 2, 3
  v_cmp_le_u32 s[46:47], v5, v4
  v_cmp_gt_u32 s[48:49], 2, v3
  v_mov_b32 v6, 0xff800000
  s_waitcnt vmcnt(0)
  v_mfma_f32_16x16x32_bf16 v[8:11], a[112:115], a[0:3], 0
  v_mfma_f32_16x16x32_bf16 v[12:15], a[112:115], a[56:59], 0
  v_mfma_f32_16x16x32_bf16 v[16:19], a[168:171], a[56:59], 0
  v_mfma_f32_16x16x32_bf16 v[8:11], a[116:119], a[4:7], v[8:11]
  v_mfma_f32_16x16x32_bf16 v[12:15], a[116:119], a[60:63], v[12:15]
  v_mfma_f32_16x16x32_bf16 v[16:19], a[172:175], a[60:63], v[16:19]
  v_mfma_f32_16x16x32_bf16 v[8:11], a[120:123], a[8:11], v[8:11]
  v_mfma_f32_16x16x32_bf16 v[12:15], a[120:123], a[64:67], v[12:15]
  v_mfma_f32_16x16x32_bf16 v[16:19], a[176:179], a[64:67], v[16:19]
  v_mfma_f32_16x16x32_bf16 v[8:11], a[124:127], a[12:15], v[8:11]
  v_mfma_f32_16x16x32_bf16 v[12:15], a[124:127], a[68:71], v[12:15]
  v_mfma_f32_16x16x32_bf16 v[16:19], a[180:183], a[68:71], v[16:19]
  v_mfma_f32_16x16x32_bf16 v[8:11], a[128:131], a[16:19], v[8:11]
  v_mfma_f32_16x16x32_bf16 v[12:15], a[128:131], a[72:75], v[12:15]
  v_mfma_f32_16x16x32_bf16 v[16:19], a[184:187], a[72:75], v[16:19]
  v_mfma_f32_16x16x32_bf16 v[8:11], a[132:135], a[20:23], v[8:11]
  v_mfma_f32_16x16x32_bf16 v[12:15], a[132:135], a[76:79], v[12:15]
  v_mfma_f32_16x16x32_bf16 v[16:19], a[188:191], a[76:79], v[16:19]
  v_mfma_f32_16x16x32_bf16 v[8:11], a[136:139], a[24:27], v[8:11]
  v_mfma_f32_16x16x32_bf16 v[12:15], a[136:139], a[80:83], v[12:15]
  v_mfma_f32_16x16x32_bf16 v[16:19], a[192:195], a[80:83], v[16:19]
  v_mfma_f32_16x16x32_bf16 v[8:11], a[140:143], a[28:31], v[8:11]
  v_mfma_f32_16x16x32_bf16 v[12:15], a[140:143], a[84:87], v[12:15]
  v_mfma_f32_16x16x32_bf16 v[16:19], a[196:199], a[84:87], v[16:19]
  v_mfma_f32_16x16x32_bf16 v[8:11], a[144:147], a[32:35], v[8:11]
  v_mfma_f32_16x16x32_bf16 v[12:15], a[144:147], a[88:91], v[12:15]
  v_mfma_f32_16x16x32_bf16 v[16:19], a[200:203], a[88:91], v[16:19]
  v_mfma_f32_16x16x32_bf16 v[8:11], a[148:151], a[36:39], v[8:11]
  v_mfma_f32_16x16x32_bf16 v[12:15], a[148:151], a[92:95], v[12:15]
  v_mfma_f32_16x16x32_bf16 v[16:19], a[204:207], a[92:95], v[16:19]
  v_mfma_f32_16x16x32_bf16 v[8:11], a[152:155], a[40:43], v[8:11]
  v_mfma_f32_16x16x32_bf16 v[12:15], a[152:155], a[96:99], v[12:15]
  v_mfma_f32_16x16x32_bf16 v[16:19], a[208:211], a[96:99], v[16:19]
  v_mfma_f32_16x16x32_bf16 v[8:11], a[156:159], a[44:47], v[8:11]
  v_mfma_f32_16x16x32_bf16 v[12:15], a[156:159], a[100:103], v[12:15]
  v_mfma_f32_16x16x32_bf16 v[16:19], a[212:215], a[100:103], v[16:19]
  v_mfma_f32_16x16x32_bf16 v[8:11], a[160:163], a[48:51], v[8:11]
  v_mfma_f32_16x16x32_bf16 v[12:15], a[160:163], a[104:107], v[12:15]
  v_mfma_f32_16x16x32_bf16 v[16:19], a[216:219], a[104:107], v[16:19]
  v_mfma_f32_16x16x32_bf16 v[8:11], a[164:167], a[52:55], v[8:11]
  v_mfma_f32_16x16x32_bf16 v[12:15], a[164:167], a[108:111], v[12:15]
  v_mfma_f32_16x16x32_bf16 v[16:19], a[220:223], a[108:111], v[16:19]
  s_mul_i32 s22, s20, 448
  v_mov_b32 v62, s22
  s_mov_b32 s30, 0
wp_pm:
  s_cmp_ge_u32 s17, 64
  s_cbranch_scc1 wp_pf
  buffer_load_dword v61, v62, s[8:11], s24 offen sc1
  s_waitcnt vmcnt(0)
  v_cmp_eq_u32 vcc, -1, v61
  s_cbranch_vccnz wp_pr
wp_pf:
  s_add_u32 s22, s24, 4096
  buffer_load_dwordx4 v[64:67], v2, s[8:11], s24 offen offset:0 sc1
  buffer_load_dwordx4 v[68:71], v2, s[8:11], s24 offen offset:1024 sc1
  buffer_load_dwordx4 v[72:75], v2, s[8:11], s24 offen offset:2048 sc1
  buffer_load_dwordx4 v[76:79], v2, s[8:11], s24 offen offset:3072 sc1
  buffer_load_dwordx4 v[80:83], v2, s[8:11], s22 offen offset:0 sc1
  buffer_load_dwordx4 v[84:87], v2, s[8:11], s22 offen offset:1024 sc1
  buffer_load_dwordx4 v[88:91], v2, s[8:11], s22 offen offset:2048 sc1
  s_waitcnt vmcnt(0)
  v_max_u32 v61, v64, v65
  v_max3_u32 v61, v61, v66, v67
  v_max3_u32 v61, v61, v68, v69
  v_max3_u32 v61, v61, v70, v71
  v_max3_u32 v61, v61, v72, v73
  v_max3_u32 v61, v61, v74, v75
  v_max3_u32 v61, v61, v76, v77
  v_max3_u32 v61, v61, v78, v79
  v_max3_u32 v61, v61, v80, v81
  v_max3_u32 v61, v61, v82, v83
  v_max3_u32 v61, v61, v84, v85
  v_max3_u32 v61, v61, v86, v87
  v_max3_u32 v61, v61, v88, v89
  v_max3_u32 v61, v61, v90, v91
  v_cmp_eq_u32 vcc, -1, v61
  s_cbranch_vccz wp_pk
wp_pr:
  s_sleep 4
  s_cmp_ge_u32 s17, 56
  s_cbranch_scc1 wp_pm_bo
  s_sleep 127
wp_pm_bo:
  s_add_u32 s30, s30, 1
  s_cmp_lt_u32 s30, 2000000
  s_cbranch_scc1 wp_pm
  s_branch wp_abort
wp_pk:
  buffer_load_dword v250, v251, s[8:11], 0 offen sc1
  v_mfma_f32_16x16x32_bf16 v[20:23], v[64:67], a[0:3], 0
  v_mfma_f32_16x16x32_bf16 v[24:27], v[64:67], a[4:7], 0
  v_mfma_f32_16x16x32_bf16 v[28:31], v[64:67], a[56:59], 0
  v_mfma_f32_16x16x32_bf16 v[32:35], v[64:67], a[60:63], 0
  v_mfma_f32_16x16x32_bf16 v[20:23], v[68:71], a[8:11], v[20:23]
  v_mfma_f32_16x16x32_bf16 v[24:27], v[68:71], a[12:15], v[24:27]
  v_mfma_f32_16x16x32_bf16 v[28:31], v[68:71], a[64:67], v[28:31]
  v_mfma_f32_16x16x32_bf16 v[32:35], v[68:71], a[68:71], v[32:35]
  v_mfma_f32_16x16x32_bf16 v[20:23], v[72:75], a[16:19], v[20:23]
  v_mfma_f32_16x16x32_bf16 v[24:27], v[72:75], a[20:23], v[24:27]
  v_mfma_f32_16x16x32_bf16 v[28:31], v[72:75], a[72:75], v[28:31]
  v_mfma_f32_16x16x32_bf16 v[32:35], v[72:75], a[76:79], v[32:35]
  v_mfma_f32_16x16x32_bf16 v[20:23], v[76:79], a[24:27], v[20:23]
  v_mfma_f32_16x16x32_bf16 v[24:27], v[76:79], a[28:31], v[24:27]
  v_mfma_f32_16x16x32_bf16 v[28:31], v[76:79], a[80:83], v[28:31]
  v_mfma_f32_16x16x32_bf16 v[32:35], v[76:79], a[84:87], v[32:35]
  v_mfma_f32_16x16x32_bf16 v[20:23], v[80:83], a[32:35], v[20:23]
  v_mfma_f32_16x16x32_bf16 v[24:27], v[80:83], a[36:39], v[24:27]
  v_mfma_f32_16x16x32_bf16 v[28:31], v[80:83], a[88:91], v[28:31]
  v_mfma_f32_16x16x32_bf16 v[32:35], v[80:83], a[92:95], v[32:35]
  v_mfma_f32_16x16x32_bf16 v[20:23], v[84:87], a[40:43], v[20:23]
  v_mfma_f32_16x16x32_bf16 v[24:27], v[84:87], a[44:47], v[24:27]
  v_mfma_f32_16x16x32_bf16 v[28:31], v[84:87], a[96:99], v[28:31]
  v_mfma_f32_16x16x32_bf16 v[32:35], v[84:87], a[100:103], v[32:35]
  v_mfma_f32_16x16x32_bf16 v[20:23], v[88:91], a[48:51], v[20:23]
  v_mfma_f32_16x16x32_bf16 v[24:27], v[88:91], a[52:55], v[24:27]
  v_mfma_f32_16x16x32_bf16 v[28:31], v[88:91], a[104:107], v[28:31]
  v_mfma_f32_16x16x32_bf16 v[32:35], v[88:91], a[108:111], v[32:35]
  s_lshl_b32 s25, s17, 1
  s_mul_i32 s25, s25, 20480
  s_add_u32 s25, s25, 85446656
  s_lshl_b32 s26, s20, 10
  s_add_u32 s26, s26, s25
  s_lshl_b32 s27, s18, 10
  s_add_u32 s27, s27, s25
  s_lshr_b32 s28, s16, 1
  s_lshl_b32 s28, s28, 3
  s_add_u32 s27, s27, s28
  s_add_u32 s27, s27, 16384
  s_and_b32 s28, s16, 1
  s_cmp_eq_u32 s28, 0
  s_cselect_b32 s50, -1, 0
  s_cselect_b32 s51, 0, -1
  v_cndmask_b32 v8, v6, v8, s[40:41]
  v_cndmask_b32 v9, v6, v9, s[42:43]
  v_cndmask_b32 v10, v6, v10, s[44:45]
  v_cndmask_b32 v11, v6, v11, s[46:47]
  v_cndmask_b32 v20, v24, v20, s[48:49]
  v_cndmask_b32 v21, v25, v21, s[48:49]
  v_cndmask_b32 v22, v26, v22, s[48:49]
  v_cndmask_b32 v23, v27, v23, s[48:49]
  v_mov_b32 v24, v20
  v_mov_b32 v25, v21
  v_mov_b32 v26, v22
  v_mov_b32 v27, v23
  v_permlane32_swap_b32 v20, v24
  v_permlane32_swap_b32 v21, v25
  v_permlane32_swap_b32 v22, v26
  v_permlane32_swap_b32 v23, v27
  v_add_f32 v20, v20, v24
  v_add_f32 v21, v21, v25
  v_add_f32 v22, v22, v26
  v_add_f32 v23, v23, v27
  v_max3_f32 v40, v8, v9, v10
  v_max3_f32 v40, v40, v11, v20
  v_max3_f32 v40, v40, v21, v22
  v_max_f32 v40, v40, v23
  v_mov_b32 v41, v40
  s_nop 1
  v_permlane16_swap_b32 v40, v41
  v_max_f32 v40, v40, v41
  v_mov_b32 v41, v40
  s_nop 1
  v_permlane32_swap_b32 v40, v41
  v_max_f32 v40, v40, v41
  v_sub_f32 v8, v8, v40
  v_sub_f32 v9, v9, v40
  v_sub_f32 v10, v10, v40
  v_sub_f32 v11, v11, v40
  v_sub_f32 v20, v20, v40
  v_sub_f32 v21, v21, v40
  v_sub_f32 v22, v22, v40
  v_sub_f32 v23, v23, v40
  v_exp_f32 v8, v8
  v_exp_f32 v9, v9
  v_exp_f32 v10, v10
  v_exp_f32 v11, v11
  v_exp_f32 v20, v20
  v_exp_f32 v21, v21
  v_exp_f32 v22, v22
  v_exp_f32 v23, v23
  v_add_f32 v42, v20, v21
  v_add_f32 v43, v22, v23
  v_add_f32 v42, v42, v43
  v_mul_f32 v42, 0.5, v42
  v_add_f32 v42, v42, v8
  v_add_f32 v42, v42, v9
  v_add_f32 v42, v42, v10
  v_add_f32 v42, v42, v11
  v_mov_b32 v41, v42
  s_nop 1
  v_permlane16_swap_b32 v42, v41
  v_add_f32 v42, v42, v41
  v_mov_b32 v41, v42
  s_nop 1
  v_permlane32_swap_b32 v42, v41
  v_add_f32 v42, v42, v41
  v_rcp_f32 v42, v42
  s_nop 0
  v_mul_f32 v8, v8, v42
  v_mul_f32 v9, v9, v42
  v_mul_f32 v10, v10, v42
  v_mul_f32 v11, v11, v42
  v_mul_f32 v20, v20, v42
  v_mul_f32 v21, v21, v42
  v_mul_f32 v22, v22, v42
  v_mul_f32 v23, v23, v42
  v_cvt_pk_bf16_f32 v44, v8, v9
  v_cvt_pk_bf16_f32 v45, v10, v11
  v_mov_b32 v46, 0
  v_mov_b32 v47, 0
  v_cvt_pk_bf16_f32 v48, v20, v21
  v_cvt_pk_bf16_f32 v49, v22, v23
  buffer_store_dwordx4 v[44:47], v2, s[8:11], s26 offen sc1
  s_mov_b64 exec, s[50:51]
  buffer_store_dwordx2 v[48:49], v2, s[8:11], s27 offen sc1
  s_mov_b64 exec, -1
  s_add_u32 s26, s26, 20480
  s_add_u32 s27, s27, 20480
  v_cndmask_b32 v16, v6, v16, s[40:41]
  v_cndmask_b32 v17, v6, v17, s[42:43]
  v_cndmask_b32 v18, v6, v18, s[44:45]
  v_cndmask_b32 v19, v6, v19, s[46:47]
  v_cndmask_b32 v28, v32, v28, s[48:49]
  v_cndmask_b32 v29, v33, v29, s[48:49]
  v_cndmask_b32 v30, v34, v30, s[48:49]
  v_cndmask_b32 v31, v35, v31, s[48:49]
  v_mov_b32 v32, v28
  v_mov_b32 v33, v29
  v_mov_b32 v34, v30
  v_mov_b32 v35, v31
  v_permlane32_swap_b32 v28, v32
  v_permlane32_swap_b32 v29, v33
  v_permlane32_swap_b32 v30, v34
  v_permlane32_swap_b32 v31, v35
  v_add_f32 v28, v28, v32
  v_add_f32 v29, v29, v33
  v_add_f32 v30, v30, v34
  v_add_f32 v31, v31, v35
  v_max3_f32 v40, v12, v13, v14
  v_max3_f32 v40, v40, v15, v16
  v_max3_f32 v40, v40, v17, v18
  v_max3_f32 v40, v40, v19, v28
  v_max3_f32 v40, v40, v29, v30
  v_max_f32 v40, v40, v31
  v_mov_b32 v41, v40
  s_nop 1
  v_permlane16_swap_b32 v40, v41
  v_max_f32 v40, v40, v41
  v_mov_b32 v41, v40
  s_nop 1
  v_permlane32_swap_b32 v40, v41
  v_max_f32 v40, v40, v41
  v_sub_f32 v12, v12, v40
  v_sub_f32 v13, v13, v40
  v_sub_f32 v14, v14, v40
  v_sub_f32 v15, v15, v40
  v_sub_f32 v16, v16, v40
  v_sub_f32 v17, v17, v40
  v_sub_f32 v18, v18, v40
  v_sub_f32 v19, v19, v40
  v_sub_f32 v28, v28, v40
  v_sub_f32 v29, v29, v40
  v_sub_f32 v30, v30, v40
  v_sub_f32 v31, v31, v40
  v_exp_f32 v12, v12
  v_exp_f32 v13, v13
  v_exp_f32 v14, v14
  v_exp_f32 v15, v15
  v_exp_f32 v16, v16
  v_exp_f32 v17, v17
  v_exp_f32 v18, v18
  v_exp_f32 v19, v19
  v_exp_f32 v28, v28
  v_exp_f32 v29, v29
  v_exp_f32 v30, v30
  v_exp_f32 v31, v31
  v_add_f32 v42, v28, v29
  v_add_f32 v43, v30, v31
  v_add_f32 v42, v42, v43
  v_mul_f32 v42, 0.5, v42
  v_add_f32 v42, v42, v12
  v_add_f32 v42, v42, v13
  v_add_f32 v42, v42, v14
  v_add_f32 v42, v42, v15
  v_add_f32 v42, v42, v16
  v_add_f32 v42, v42, v17
  v_add_f32 v42, v42, v18
  v_add_f32 v42, v42, v19
  v_mov_b32 v41, v42
  s_nop 1
  v_permlane16_swap_b32 v42, v41
  v_add_f32 v42, v42, v41
  v_mov_b32 v41, v42
  s_nop 1
  v_permlane32_swap_b32 v42, v41
  v_add_f32 v42, v42, v41
  v_rcp_f32 v42, v42
  s_nop 0
  v_mul_f32 v12, v12, v42
  v_mul_f32 v13, v13, v42
  v_mul_f32 v14, v14, v42
  v_mul_f32 v15, v15, v42
  v_mul_f32 v16, v16, v42
  v_mul_f32 v17, v17, v42
  v_mul_f32 v18, v18, v42
  v_mul_f32 v19, v19, v42
  v_mul_f32 v28, v28, v42
  v_mul_f32 v29, v29, v42
  v_mul_f32 v30, v30, v42
  v_mul_f32 v31, v31, v42
  v_cvt_pk_bf16_f32 v52, v12, v13
  v_cvt_pk_bf16_f32 v53, v14, v15
  v_cvt_pk_bf16_f32 v54, v16, v17
  v_cvt_pk_bf16_f32 v55, v18, v19
  v_cvt_pk_bf16_f32 v56, v28, v29
  v_cvt_pk_bf16_f32 v57, v30, v31
  buffer_store_dwordx4 v[52:55], v2, s[8:11], s26 offen sc1
  s_mov_b64 exec, s[50:51]
  buffer_store_dwordx2 v[56:57], v2, s[8:11], s27 offen sc1
  s_mov_b64 exec, -1
  s_lshl_b32 s25, s17, 2
  s_add_u32 s25, s25, 88527872
  v_mov_b32 v5, 1
  v_mov_b32 v6, 0
  s_waitcnt vmcnt(0)
  s_mov_b64 exec, 1
  buffer_atomic_add v5, v6, s[8:11], s25 offen
  s_mov_b64 exec, -1
  s_branch wk_loop
wk_toko:
  s_lshl_b32 s20, s18, 2
  s_add_u32 s20, s20, s16
  s_mul_i32 s24, s20, 65
  s_add_u32 s24, s24, s17
  s_lshl_b32 s24, s24, 13
  s_add_u32 s24, s24, 76935168
  s_lshl_b32 s21, s20, 6
  s_add_u32 s21, s21, s17
  s_mul_i32 s21, s21, 28672
  s_add_u32 s21, s21, 42205184
  s_lshl_b32 s25, s17, 1
  s_mul_i32 s25, s25, 20480
  s_add_u32 s25, s25, 85446656
  v_mul_u32_u24 v7, 28, v3
  v_add_u32 v5, v7, v4
  v_lshlrev_b32 v5, 4, v5
  v_add_u32 v6, 16, v4
  v_min_u32 v6, 27, v6
  v_add_u32 v6, v7, v6
  v_lshlrev_b32 v6, 4, v6
  v_lshrrev_b32 v8, 1, v3
  v_lshl_add_u32 v8, v8, 4, v4
  v_lshlrev_b32 v8, 4, v8
  v_and_b32 v9, 1, v3
  v_lshl_add_u32 v7, v9, 3, v8
  s_lshr_b32 s26, s17, 3
  s_lshl_b32 s26, s26, 4
  s_add_u32 s26, s26, s20
  s_lshl_b32 s26, s26, 2
  s_add_u32 s26, s26, 88526848
  v_mov_b32 v60, 0
  s_mov_b32 s30, 0
wo_wv:
  buffer_load_dword v61, v60, s[8:11], s26 offen sc1
  s_waitcnt vmcnt(0)
  v_cmp_ne_u32 vcc, 56, v61
  s_cbranch_vccz wo_wv_ok
  s_sleep 4
  s_cmp_ge_u32 s17, 56
  s_cbranch_scc1 wo_wv_bo
  s_sleep 127
wo_wv_bo:
  s_add_u32 s30, s30, 1
  s_cmp_lt_u32 s30, 2000000
  s_cbranch_scc1 wo_wv
  s_branch wo_abort
wo_wv_ok:
  s_add_u32 s22, s21, 0
  buffer_load_dwordx4 a[0:3], v5, s[8:11], s22 offen offset:0 sc1
  buffer_load_dwordx4 a[4:7], v6, s[8:11], s22 offen offset:0 sc1
  buffer_load_dwordx4 a[8:11], v5, s[8:11], s22 offen offset:1792 sc1
  buffer_load_dwordx4 a[12:15], v6, s[8:11], s22 offen offset:1792 sc1
  s_add_u32 s22, s21, 3584
  buffer_load_dwordx4 a[16:19], v5, s[8:11], s22 offen offset:0 sc1
  buffer_load_dwordx4 a[20:23], v6, s[8:11], s22 offen offset:0 sc1
  buffer_load_dwordx4 a[24:27], v5, s[8:11], s22 offen offset:1792 sc1
  buffer_load_dwordx4 a[28:31], v6, s[8:11], s22 offen offset:1792 sc1
  s_add_u32 s22, s21, 7168
  buffer_load_dwordx4 a[32:35], v5, s[8:11], s22 offen offset:0 sc1
  buffer_load_dwordx4 a[36:39], v6, s[8:11], s22 offen offset:0 sc1
  buffer_load_dwordx4 a[40:43], v5, s[8:11], s22 offen offset:1792 sc1
  buffer_load_dwordx4 a[44:47], v6, s[8:11], s22 offen offset:1792 sc1
  s_add_u32 s22, s21, 10752
  buffer_load_dwordx4 a[48:51], v5, s[8:11], s22 offen offset:0 sc1
  buffer_load_dwordx4 a[52:55], v6, s[8:11], s22 offen offset:0 sc1
  buffer_load_dwordx4 a[56:59], v5, s[8:11], s22 offen offset:1792 sc1
  buffer_load_dwordx4 a[60:63], v6, s[8:11], s22 offen offset:1792 sc1
  s_add_u32 s22, s21, 14336
  buffer_load_dwordx4 a[64:67], v5, s[8:11], s22 offen offset:0 sc1
  buffer_load_dwordx4 a[68:71], v6, s[8:11], s22 offen offset:0 sc1
  buffer_load_dwordx4 a[72:75], v5, s[8:11], s22 offen offset:1792 sc1
  buffer_load_dwordx4 a[76:79], v6, s[8:11], s22 offen offset:1792 sc1
  s_add_u32 s22, s21, 17920
  buffer_load_dwordx4 a[80:83], v5, s[8:11], s22 offen offset:0 sc1
  buffer_load_dwordx4 a[84:87], v6, s[8:11], s22 offen offset:0 sc1
  buffer_load_dwordx4 a[88:91], v5, s[8:11], s22 offen offset:1792 sc1
  buffer_load_dwordx4 a[92:95], v6, s[8:11], s22 offen offset:1792 sc1
  s_add_u32 s22, s21, 21504
  buffer_load_dwordx4 a[96:99], v5, s[8:11], s22 offen offset:0 sc1
  buffer_load_dwordx4 a[100:103], v6, s[8:11], s22 offen offset:0 sc1
  buffer_load_dwordx4 a[104:107], v5, s[8:11], s22 offen offset:1792 sc1
  buffer_load_dwordx4 a[108:111], v6, s[8:11], s22 offen offset:1792 sc1
  s_add_u32 s22, s21, 25088
  buffer_load_dwordx4 a[112:115], v5, s[8:11], s22 offen offset:0 sc1
  buffer_load_dwordx4 a[116:119], v6, s[8:11], s22 offen offset:0 sc1
  buffer_load_dwordx4 a[120:123], v5, s[8:11], s22 offen offset:1792 sc1
  buffer_load_dwordx4 a[124:127], v6, s[8:11], s22 offen offset:1792 sc1
  s_lshl_b32 s26, s20, 6
  s_add_u32 s26, s26, s17
  s_lshl_b32 s26, s26, 4
  s_add_u32 s26, s26, 88528128
  v_lshlrev_b32 v60, 2, v3
  s_mov_b32 s30, 0
wo_wt:
  buffer_load_dword v61, v60, s[8:11], s26 offen sc1
  s_waitcnt vmcnt(0)
  v_cmp_ne_u32 vcc, 1, v61
  s_cbranch_vccz wo_wt_ok
  s_sleep 4
  s_cmp_ge_u32 s17, 56
  s_cbranch_scc1 wo_wt_bo
  s_sleep 127
wo_wt_bo:
  s_add_u32 s30, s30, 1
  s_cmp_lt_u32 s30, 2000000
  s_cbranch_scc1 wo_wt
  s_branch wo_abort
wo_wt_ok:
  s_add_u32 s22, s24, 0
  buffer_load_dwordx2 v[28:29], v7, s[8:11], s22 offen offset:0 sc1
  buffer_load_dwordx2 v[30:31], v7, s[8:11], s22 offen offset:512 sc1
  buffer_load_dwordx2 v[32:33], v7, s[8:11], s22 offen offset:1024 sc1
  buffer_load_dwordx2 v[34:35], v7, s[8:11], s22 offen offset:1536 sc1
  buffer_load_dwordx2 v[36:37], v7, s[8:11], s22 offen offset:2048 sc1
  buffer_load_dwordx2 v[38:39], v7, s[8:11], s22 offen offset:2560 sc1
  buffer_load_dwordx2 v[40:41], v7, s[8:11], s22 offen offset:3072 sc1
  buffer_load_dwordx2 v[42:43], v7, s[8:11], s22 offen offset:3584 sc1
  s_add_u32 s22, s24, 4096
  buffer_load_dwordx2 v[44:45], v7, s[8:11], s22 offen offset:0 sc1
  buffer_load_dwordx2 v[46:47], v7, s[8:11], s22 offen offset:512 sc1
  buffer_load_dwordx2 v[48:49], v7, s[8:11], s22 offen offset:1024 sc1
  buffer_load_dwordx2 v[50:51], v7, s[8:11], s22 offen offset:1536 sc1
  buffer_load_dwordx2 v[52:53], v7, s[8:11], s22 offen offset:2048 sc1
  buffer_load_dwordx2 v[54:55], v7, s[8:11], s22 offen offset:2560 sc1
  buffer_load_dwordx2 v[56:57], v7, s[8:11], s22 offen offset:3072 sc1
  buffer_load_dwordx2 v[58:59], v7, s[8:11], s22 offen offset:3584 sc1
  s_lshl_b32 s26, s17, 2
  s_add_u32 s26, s26, 88527872
  v_mov_b32 v60, 0
  s_mov_b32 s30, 0
wo_wp:
  buffer_load_dword v61, v60, s[8:11], s26 offen sc1
  s_waitcnt vmcnt(0)
  v_cmp_ne_u32 vcc, 16, v61
  s_cbranch_vccz wo_wp_ok
  s_sleep 2
  s_cmp_ge_u32 s17, 56
  s_cbranch_scc1 wo_wp_bo
  s_sleep 127
wo_wp_bo:
  s_add_u32 s30, s30, 1
  s_cmp_lt_u32 s30, 2000000
  s_cbranch_scc1 wo_wp
  s_branch wo_abort
wo_wp_ok:
  buffer_load_dword v250, v251, s[8:11], 0 offen sc1
  s_add_u32 s26, s25, 0
  s_add_u32 s27, s25, 20480
  buffer_load_dwordx4 a[128:131], v2, s[8:11], s26 offen offset:0 sc1
  buffer_load_dwordx4 a[132:135], v2, s[8:11], s27 offen offset:0 sc1
  buffer_load_dwordx4 a[136:139], v2, s[8:11], s26 offen offset:1024 sc1
  buffer_load_dwordx4 a[140:143], v2, s[8:11], s27 offen offset:1024 sc1
  buffer_load_dwordx4 a[144:147], v2, s[8:11], s26 offen offset:2048 sc1
  buffer_load_dwordx4 a[148:151], v2, s[8:11], s27 offen offset:2048 sc1
  buffer_load_dwordx4 a[152:155], v2, s[8:11], s26 offen offset:3072 sc1
  buffer_load_dwordx4 a[156:159], v2, s[8:11], s27 offen offset:3072 sc1
  s_add_u32 s26, s25, 4096
  s_add_u32 s27, s25, 24576
  buffer_load_dwordx4 a[160:163], v2, s[8:11], s26 offen offset:0 sc1
  buffer_load_dwordx4 a[164:167], v2, s[8:11], s27 offen offset:0 sc1
  buffer_load_dwordx4 a[168:171], v2, s[8:11], s26 offen offset:1024 sc1
  buffer_load_dwordx4 a[172:175], v2, s[8:11], s27 offen offset:1024 sc1
  buffer_load_dwordx4 a[176:179], v2, s[8:11], s26 offen offset:2048 sc1
  buffer_load_dwordx4 a[180:183], v2, s[8:11], s27 offen offset:2048 sc1
  buffer_load_dwordx4 a[184:187], v2, s[8:11], s26 offen offset:3072 sc1
  buffer_load_dwordx4 a[188:191], v2, s[8:11], s27 offen offset:3072 sc1
  s_add_u32 s26, s25, 8192
  s_add_u32 s27, s25, 28672
  buffer_load_dwordx4 a[192:195], v2, s[8:11], s26 offen offset:0 sc1
  buffer_load_dwordx4 a[196:199], v2, s[8:11], s27 offen offset:0 sc1
  buffer_load_dwordx4 a[200:203], v2, s[8:11], s26 offen offset:1024 sc1
  buffer_load_dwordx4 a[204:207], v2, s[8:11], s27 offen offset:1024 sc1
  buffer_load_dwordx4 a[208:211], v2, s[8:11], s26 offen offset:2048 sc1
  buffer_load_dwordx4 a[212:215], v2, s[8:11], s27 offen offset:2048 sc1
  buffer_load_dwordx4 a[216:219], v2, s[8:11], s26 offen offset:3072 sc1
  buffer_load_dwordx4 a[220:223], v2, s[8:11], s27 offen offset:3072 sc1
  s_add_u32 s26, s25, 12288
  s_add_u32 s27, s25, 32768
  buffer_load_dwordx4 a[224:227], v2, s[8:11], s26 offen offset:0 sc1
  buffer_load_dwordx4 a[228:231], v2, s[8:11], s27 offen offset:0 sc1
  buffer_load_dwordx4 a[232:235], v2, s[8:11], s26 offen offset:1024 sc1
  buffer_load_dwordx4 a[236:239], v2, s[8:11], s27 offen offset:1024 sc1
  buffer_load_dwordx4 a[240:243], v2, s[8:11], s26 offen offset:2048 sc1
  buffer_load_dwordx4 a[244:247], v2, s[8:11], s27 offen offset:2048 sc1
  buffer_load_dwordx4 a[248:251], v2, s[8:11], s26 offen offset:3072 sc1
  buffer_load_dwordx4 a[252:255], v2, s[8:11], s27 offen offset:3072 sc1
  s_add_u32 s26, s25, 16384
  s_add_u32 s27, s25, 36864
  buffer_load_dwordx4 v[64:67], v2, s[8:11], s26 offen offset:0 sc1
  buffer_load_dwordx4 v[68:71], v2, s[8:11], s27 offen offset:0 sc1
  buffer_load_dwordx4 v[72:75], v2, s[8:11], s26 offen offset:1024 sc1
  buffer_load_dwordx4 v[76:79], v2, s[8:11], s27 offen offset:1024 sc1
  buffer_load_dwordx4 v[80:83], v2, s[8:11], s26 offen offset:2048 sc1
  buffer_load_dwordx4 v[84:87], v2, s[8:11], s27 offen offset:2048 sc1
  buffer_load_dwordx4 v[88:91], v2, s[8:11], s26 offen offset:3072 sc1
  buffer_load_dwordx4 v[92:95], v2, s[8:11], s27 offen offset:3072 sc1
  s_waitcnt vmcnt(38)
  v_mfma_f32_16x16x32_bf16 v[12:15], a[0:3], a[128:131], 0
  v_mfma_f32_16x16x32_bf16 v[16:19], a[0:3], a[132:135], 0
  v_mfma_f32_16x16x32_bf16 v[20:23], a[4:7], a[128:131], 0
  v_mfma_f32_16x16x32_bf16 v[24:27], a[4:7], a[132:135], 0
  s_waitcnt vmcnt(36)
  v_mfma_f32_16x16x32_bf16 v[12:15], a[8:11], a[136:139], v[12:15]
  v_mfma_f32_16x16x32_bf16 v[16:19], a[8:11], a[140:143], v[16:19]
  v_mfma_f32_16x16x32_bf16 v[20:23], a[12:15], a[136:139], v[20:23]
  v_mfma_f32_16x16x32_bf16 v[24:27], a[12:15], a[140:143], v[24:27]
  s_waitcnt vmcnt(34)
  v_mfma_f32_16x16x32_bf16 v[12:15], a[16:19], a[144:147], v[12:15]
  v_mfma_f32_16x16x32_bf16 v[16:19], a[16:19], a[148:151], v[16:19]
  v_mfma_f32_16x16x32_bf16 v[20:23], a[20:23], a[144:147], v[20:23]
  v_mfma_f32_16x16x32_bf16 v[24:27], a[20:23], a[148:151], v[24:27]
  s_waitcnt vmcnt(32)
  v_mfma_f32_16x16x32_bf16 v[12:15], a[24:27], a[152:155], v[12:15]
  v_mfma_f32_16x16x32_bf16 v[16:19], a[24:27], a[156:159], v[16:19]
  v_mfma_f32_16x16x32_bf16 v[20:23], a[28:31], a[152:155], v[20:23]
  v_mfma_f32_16x16x32_bf16 v[24:27], a[28:31], a[156:159], v[24:27]
  s_waitcnt vmcnt(30)
  v_mfma_f32_16x16x32_bf16 v[12:15], a[32:35], a[160:163], v[12:15]
  v_mfma_f32_16x16x32_bf16 v[16:19], a[32:35], a[164:167], v[16:19]
  v_mfma_f32_16x16x32_bf16 v[20:23], a[36:39], a[160:163], v[20:23]
  v_mfma_f32_16x16x32_bf16 v[24:27], a[36:39], a[164:167], v[24:27]
  s_waitcnt vmcnt(28)
  v_mfma_f32_16x16x32_bf16 v[12:15], a[40:43], a[168:171], v[12:15]
  v_mfma_f32_16x16x32_bf16 v[16:19], a[40:43], a[172:175], v[16:19]
  v_mfma_f32_16x16x32_bf16 v[20:23], a[44:47], a[168:171], v[20:23]
  v_mfma_f32_16x16x32_bf16 v[24:27], a[44:47], a[172:175], v[24:27]
  s_waitcnt vmcnt(26)
  v_mfma_f32_16x16x32_bf16 v[12:15], a[48:51], a[176:179], v[12:15]
  v_mfma_f32_16x16x32_bf16 v[16:19], a[48:51], a[180:183], v[16:19]
  v_mfma_f32_16x16x32_bf16 v[20:23], a[52:55], a[176:179], v[20:23]
  v_mfma_f32_16x16x32_bf16 v[24:27], a[52:55], a[180:183], v[24:27]
  s_waitcnt vmcnt(24)
  v_mfma_f32_16x16x32_bf16 v[12:15], a[56:59], a[184:187], v[12:15]
  v_mfma_f32_16x16x32_bf16 v[16:19], a[56:59], a[188:191], v[16:19]
  v_mfma_f32_16x16x32_bf16 v[20:23], a[60:63], a[184:187], v[20:23]
  v_mfma_f32_16x16x32_bf16 v[24:27], a[60:63], a[188:191], v[24:27]
  s_waitcnt vmcnt(22)
  v_mfma_f32_16x16x32_bf16 v[12:15], a[64:67], a[192:195], v[12:15]
  v_mfma_f32_16x16x32_bf16 v[16:19], a[64:67], a[196:199], v[16:19]
  v_mfma_f32_16x16x32_bf16 v[20:23], a[68:71], a[192:195], v[20:23]
  v_mfma_f32_16x16x32_bf16 v[24:27], a[68:71], a[196:199], v[24:27]
  s_waitcnt vmcnt(20)
  v_mfma_f32_16x16x32_bf16 v[12:15], a[72:75], a[200:203], v[12:15]
  v_mfma_f32_16x16x32_bf16 v[16:19], a[72:75], a[204:207], v[16:19]
  v_mfma_f32_16x16x32_bf16 v[20:23], a[76:79], a[200:203], v[20:23]
  v_mfma_f32_16x16x32_bf16 v[24:27], a[76:79], a[204:207], v[24:27]
  s_waitcnt vmcnt(18)
  v_mfma_f32_16x16x32_bf16 v[12:15], a[80:83], a[208:211], v[12:15]
  v_mfma_f32_16x16x32_bf16 v[16:19], a[80:83], a[212:215], v[16:19]
  v_mfma_f32_16x16x32_bf16 v[20:23], a[84:87], a[208:211], v[20:23]
  v_mfma_f32_16x16x32_bf16 v[24:27], a[84:87], a[212:215], v[24:27]
  s_waitcnt vmcnt(16)
  v_mfma_f32_16x16x32_bf16 v[12:15], a[88:91], a[216:219], v[12:15]
  v_mfma_f32_16x16x32_bf16 v[16:19], a[88:91], a[220:223], v[16:19]
  v_mfma_f32_16x16x32_bf16 v[20:23], a[92:95], a[216:219], v[20:23]
  v_mfma_f32_16x16x32_bf16 v[24:27], a[92:95], a[220:223], v[24:27]
  s_waitcnt vmcnt(14)
  v_mfma_f32_16x16x32_bf16 v[12:15], a[96:99], a[224:227], v[12:15]
  v_mfma_f32_16x16x32_bf16 v[16:19], a[96:99], a[228:231], v[16:19]
  v_mfma_f32_16x16x32_bf16 v[20:23], a[100:103], a[224:227], v[20:23]
  v_mfma_f32_16x16x32_bf16 v[24:27], a[100:103], a[228:231], v[24:27]
  s_waitcnt vmcnt(12)
  v_mfma_f32_16x16x32_bf16 v[12:15], a[104:107], a[232:235], v[12:15]
  v_mfma_f32_16x16x32_bf16 v[16:19], a[104:107], a[236:239], v[16:19]
  v_mfma_f32_16x16x32_bf16 v[20:23], a[108:111], a[232:235], v[20:23]
  v_mfma_f32_16x16x32_bf16 v[24:27], a[108:111], a[236:239], v[24:27]
  s_waitcnt vmcnt(10)
  v_mfma_f32_16x16x32_bf16 v[12:15], a[112:115], a[240:243], v[12:15]
  v_mfma_f32_16x16x32_bf16 v[16:19], a[112:115], a[244:247], v[16:19]
  v_mfma_f32_16x16x32_bf16 v[20:23], a[116:119], a[240:243], v[20:23]
  v_mfma_f32_16x16x32_bf16 v[24:27], a[116:119], a[244:247], v[24:27]
  s_waitcnt vmcnt(8)
  v_mfma_f32_16x16x32_bf16 v[12:15], a[120:123], a[248:251], v[12:15]
  v_mfma_f32_16x16x32_bf16 v[16:19], a[120:123], a[252:255], v[16:19]
  v_mfma_f32_16x16x32_bf16 v[20:23], a[124:127], a[248:251], v[20:23]
  v_mfma_f32_16x16x32_bf16 v[24:27], a[124:127], a[252:255], v[24:27]
  s_waitcnt vmcnt(0)
  v_mfma_f32_16x16x32_bf16 v[12:15], v[28:31], v[64:67], v[12:15]
  v_mfma_f32_16x16x32_bf16 v[16:19], v[28:31], v[68:71], v[16:19]
  v_mfma_f32_16x16x32_bf16 v[20:23], v[32:35], v[64:67], v[20:23]
  v_mfma_f32_16x16x32_bf16 v[24:27], v[32:35], v[68:71], v[24:27]
  v_mfma_f32_16x16x32_bf16 v[12:15], v[36:39], v[72:75], v[12:15]
  v_mfma_f32_16x16x32_bf16 v[16:19], v[36:39], v[76:79], v[16:19]
  v_mfma_f32_16x16x32_bf16 v[20:23], v[40:43], v[72:75], v[20:23]
  v_mfma_f32_16x16x32_bf16 v[24:27], v[40:43], v[76:79], v[24:27]
  v_mfma_f32_16x16x32_bf16 v[12:15], v[44:47], v[80:83], v[12:15]
  v_mfma_f32_16x16x32_bf16 v[16:19], v[44:47], v[84:87], v[16:19]
  v_mfma_f32_16x16x32_bf16 v[20:23], v[48:51], v[80:83], v[20:23]
  v_mfma_f32_16x16x32_bf16 v[24:27], v[48:51], v[84:87], v[24:27]
  v_mfma_f32_16x16x32_bf16 v[12:15], v[52:55], v[88:91], v[12:15]
  v_mfma_f32_16x16x32_bf16 v[16:19], v[52:55], v[92:95], v[16:19]
  v_mfma_f32_16x16x32_bf16 v[20:23], v[56:59], v[88:91], v[20:23]
  v_mfma_f32_16x16x32_bf16 v[24:27], v[56:59], v[92:95], v[24:27]
  s_lshr_b32 s22, s20, 1
  s_mul_i32 s22, s22, 7
  s_and_b32 s23, s20, 1
  s_lshl_b32 s26, s23, 2
  v_add_u32 v8, s26, v3
  v_cmp_eq_u32 vcc, 3, v3
  s_nop 1
  v_cndmask_b32 v8, v8, v3, vcc
  v_add_u32 v8, s22, v8
  v_lshlrev_b32 v8, 4, v8
  v_mul_u32_u24 v9, 1792, v4
  v_add_u32 v8, v8, v9
  v_add_u32 v9, s26, v8
  s_mul_i32 s26, s17, 57344
  s_add_u32 s26, s26, 896
  s_add_u32 s27, s26, 28672
  s_mov_b32 s50, -1
  s_mov_b32 s51, 0xffff
  s_mov_b32 s52, 0
  s_mov_b32 s53, 0xffff0000
  v_cvt_pk_bf16_f32 v96, v12, v13
  v_cvt_pk_bf16_f32 v97, v20, v21
  v_cvt_pk_bf16_f32 v98, v14, v15
  v_cvt_pk_bf16_f32 v99, v22, v23
  s_mov_b64 exec, s[50:51]
  buffer_store_dwordx4 v[96:99], v8, s[92:95], s26 offen
  s_mov_b64 exec, s[52:53]
  buffer_store_dword v96, v9, s[92:95], s26 offen
  buffer_store_dword v98, v9, s[92:95], s26 offen offset:8
  s_mov_b64 exec, -1
  v_cvt_pk_bf16_f32 v100, v16, v17
  v_cvt_pk_bf16_f32 v101, v24, v25
  v_cvt_pk_bf16_f32 v102, v18, v19
  v_cvt_pk_bf16_f32 v103, v26, v27
  s_mov_b64 exec, s[50:51]
  buffer_store_dwordx4 v[100:103], v8, s[92:95], s27 offen
  s_mov_b64 exec, s[52:53]
  buffer_store_dword v100, v9, s[92:95], s27 offen
  buffer_store_dword v102, v9, s[92:95], s27 offen offset:8
  s_mov_b64 exec, -1
  s_branch wk_loop
wp_abort:
wo_abort:
  s_branch cA_abort
wk_done:
ch_end:
  s_endpgm

.section .rodata,"a"
.p2align 6
.amdhsa_kernel prep_kernel
  .amdhsa_next_free_vgpr 272
  .amdhsa_next_free_sgpr 102
  .amdhsa_accum_offset 256
  .amdhsa_group_segment_fixed_size 0
  .amdhsa_kernarg_size 136
  .amdhsa_user_sgpr_count 2
  .amdhsa_user_sgpr_kernarg_segment_ptr 1
  .amdhsa_system_sgpr_workgroup_id_x 1
.end_amdhsa_kernel
.p2align 6
.amdhsa_kernel main_kernel
  .amdhsa_next_free_vgpr 512
  .amdhsa_next_free_sgpr 102
  .amdhsa_accum_offset 256
  .amdhsa_group_segment_fixed_size 0
  .amdhsa_kernarg_size 136
  .amdhsa_user_sgpr_count 2
  .amdhsa_user_sgpr_kernarg_segment_ptr 1
  .amdhsa_system_sgpr_workgroup_id_x 1
.end_amdhsa_kernel
```

```asm
; @launch kernel=main_kernel grid=(256,1,1) block=(256,1,1) lds=163840
.amdgcn_target "amdgcn-amd-amdhsa--gfx950"
.text
.globl main_kernel
.p2align 8
.type main_kernel,@function
main_kernel:
  s_cmp_ge_u32 s2, 256
  s_cbranch_scc1 ch_end
  s_load_dwordx4 s[4:7], s[0:1], 120
  s_load_dwordx2 s[92:93], s[0:1], 112
  s_load_dwordx8 s[36:43], s[0:1], 56
  s_load_dwordx4 s[44:47], s[0:1], 88
  s_memrealtime s[88:89]
  s_getpc_b64 s[98:99]
pf_main_kernel_1:
  s_sub_u32 s98, s98, pf_main_kernel_1-main_kernel
  s_subb_u32 s99, s99, 0
  s_lshr_b32 s20, s2, 3
  v_lshl_add_u32 v60, v0, 5, s20
  v_lshlrev_b32 v60, 7, v60
  v_min_u32 v60, ch_end-main_kernel-4, v60
  v_cmp_gt_u32 vcc, 32, v0
  s_and_saveexec_b64 s[22:23], vcc
  s_cbranch_execz pf_main_kernel_1_n
  global_load_dword v62, v60, s[98:99]
pf_main_kernel_1_n:
  s_mov_b64 exec, -1
  s_getreg_b32 s67, hwreg(HW_REG_XCC_ID)
  s_and_b32 s67, s67, 7
  v_lshrrev_b32 v1, 6, v0
  s_nop 0
  v_readfirstlane_b32 s16, v1
  s_mov_b32 s66, 0
  s_mov_b32 s68, 0
  s_mov_b32 s69, 0
  s_mov_b32 s96, 0
  s_mov_b32 s97, 0
  s_mov_b32 s101, 0x5eed0000
  s_sub_u32 s20, s67, 0
  s_lshr_b32 s21, s2, 3
  s_and_b32 s20, s20, 7
  s_lshl_b32 s3, s20, 5
  s_add_u32 s3, s3, s21
  s_waitcnt lgkmcnt(0)
  s_mov_b32 s8, s6
  s_and_b32 s9, s7, 0xffff
  s_mov_b32 s10, 0x10000000
  s_mov_b32 s11, 0x20000
  s_mov_b32 s12, s4
  s_and_b32 s13, s5, 0xffff
  s_mov_b32 s14, 256
  s_mov_b32 s15, 0x20000
  s_or_b32 s88, s88, 1
  s_and_b32 s93, s93, 0xffff
  s_mov_b32 s94, 3670016
  s_mov_b32 s95, 0x20000
m_start:
  s_cmp_ge_u32 s3, 32
  s_cbranch_scc1 m_bjob
  v_and_b32 v1, 63, v0
  v_lshlrev_b32 v2, 4, v1
  v_lshrrev_b32 v116, 4, v1
  v_and_b32 v117, 15, v1
  v_mov_b32 v3, 0x4444
  v_mov_b32 v118, 0xeeee
  v_cmp_lt_u32 vcc, 7, v117
  s_nop 1
  v_cndmask_b32 v3, v3, v118, vcc
  s_and_b32 s17, s3, 15
  s_cmp_ge_u32 s3, 16
  s_cbranch_scc1 m_val
  s_mov_b32 s60, s42
  s_and_b32 s61, s43, 0xffff
  s_mov_b32 s62, 3670016
  s_mov_b32 s63, 0x20000
  v_lshrrev_b32 v24, 5, v1
  v_and_b32 v25, 31, v1
  s_lshl_b32 s26, s17, 9
  s_lshl_b32 s25, s16, 12
  v_xor_b32 v26, v25, v24
  v_lshlrev_b32 v26, 4, v26
  v_lshl_add_u32 v26, v24, 13, v26
  v_xor_b32 v100, 0, v26
  v_xor_b32 v101, 0, v26
  v_add_u32 v101, 15360, v101
  v_xor_b32 v102, 32, v26
  v_add_u32 v102, 30720, v102
  v_xor_b32 v103, 32, v26
  v_add_u32 v103, 46080, v103
  s_lshl_b32 s23, s16, 19
  s_add_u32 s23, s23, s26
  s_add_u32 m0, s25, 16384
  s_nop 0
  buffer_load_dwordx4 v100, s[60:63], s23 offen offset:0 lds
  buffer_load_dwordx4 v101, s[60:63], s23 offen offset:1024 lds
  buffer_load_dwordx4 v102, s[60:63], s23 offen offset:2048 lds
  buffer_load_dwordx4 v103, s[60:63], s23 offen offset:3072 lds
  s_add_u32 m0, s25, 32768
  s_add_u32 s23, s23, 65536
  buffer_load_dwordx4 v100, s[60:63], s23 offen offset:0 lds
  buffer_load_dwordx4 v101, s[60:63], s23 offen offset:1024 lds
  buffer_load_dwordx4 v102, s[60:63], s23 offen offset:2048 lds
  buffer_load_dwordx4 v103, s[60:63], s23 offen offset:3072 lds
  v_xor_b32 v100, 64, v100
  v_xor_b32 v101, 64, v101
  v_xor_b32 v102, 64, v102
  v_xor_b32 v103, 64, v103
  s_add_u32 m0, s25, 49152
  s_add_u32 s23, s23, 65536
  buffer_load_dwordx4 v100, s[60:63], s23 offen offset:0 lds
  buffer_load_dwordx4 v101, s[60:63], s23 offen offset:1024 lds
  buffer_load_dwordx4 v102, s[60:63], s23 offen offset:2048 lds
  buffer_load_dwordx4 v103, s[60:63], s23 offen offset:3072 lds
  s_add_u32 m0, s25, 65536
  s_add_u32 s23, s23, 65536
  buffer_load_dwordx4 v100, s[60:63], s23 offen offset:0 lds
  buffer_load_dwordx4 v101, s[60:63], s23 offen offset:1024 lds
  buffer_load_dwordx4 v102, s[60:63], s23 offen offset:2048 lds
  buffer_load_dwordx4 v103, s[60:63], s23 offen offset:3072 lds
  v_xor_b32 v100, 192, v100
  v_xor_b32 v101, 192, v101
  v_xor_b32 v102, 192, v102
  v_xor_b32 v103, 192, v103
  s_add_u32 m0, s25, 81920
  s_add_u32 s23, s23, 65536
  buffer_load_dwordx4 v100, s[60:63], s23 offen offset:0 lds
  buffer_load_dwordx4 v101, s[60:63], s23 offen offset:1024 lds
  buffer_load_dwordx4 v102, s[60:63], s23 offen offset:2048 lds
  buffer_load_dwordx4 v103, s[60:63], s23 offen offset:3072 lds
  s_add_u32 m0, s25, 98304
  s_add_u32 s23, s23, 65536
  buffer_load_dwordx4 v100, s[60:63], s23 offen offset:0 lds
  buffer_load_dwordx4 v101, s[60:63], s23 offen offset:1024 lds
  buffer_load_dwordx4 v102, s[60:63], s23 offen offset:2048 lds
  buffer_load_dwordx4 v103, s[60:63], s23 offen offset:3072 lds
  v_xor_b32 v100, 64, v100
  v_xor_b32 v101, 64, v101
  v_xor_b32 v102, 64, v102
  v_xor_b32 v103, 64, v103
  s_add_u32 m0, s25, 114688
  s_add_u32 s23, s23, 65536
  buffer_load_dwordx4 v100, s[60:63], s23 offen offset:0 lds
  buffer_load_dwordx4 v101, s[60:63], s23 offen offset:1024 lds
  buffer_load_dwordx4 v102, s[60:63], s23 offen offset:2048 lds
  buffer_load_dwordx4 v103, s[60:63], s23 offen offset:3072 lds
  s_add_u32 m0, s25, 131072
  s_add_u32 s23, s23, 65536
  buffer_load_dwordx4 v100, s[60:63], s23 offen offset:0 lds
  buffer_load_dwordx4 v101, s[60:63], s23 offen offset:1024 lds
  buffer_load_dwordx4 v102, s[60:63], s23 offen offset:2048 lds
  buffer_load_dwordx4 v103, s[60:63], s23 offen offset:3072 lds
  s_mov_b32 s56, s40
  s_and_b32 s57, s41, 0xffff
  s_mov_b32 s58, 3670016
  s_mov_b32 s59, 0x20000
  s_lshl_b32 s21, s16, 16
  s_add_u32 s27, s26, s21
  s_lshr_b32 s20, s16, 1
  s_lshl_b32 s20, s20, 6
  v_xor_b32 v26, s20, v26
  v_xor_b32 v4, 0, v26
  v_xor_b32 v5, 32, v26
  v_add_u32 v5, 15360, v5
  v_xor_b32 v6, 128, v26
  v_add_u32 v6, 30720, v6
  v_xor_b32 v7, 160, v26
  v_add_u32 v7, 46080, v7
  s_add_u32 s22, s27, 0
  s_add_u32 m0, s25, 0
  s_nop 0
  buffer_load_dwordx4 v4, s[56:59], s22 offen offset:0 lds
  buffer_load_dwordx4 v5, s[56:59], s22 offen offset:1024 lds
  buffer_load_dwordx4 v6, s[56:59], s22 offen offset:2048 lds
  buffer_load_dwordx4 v7, s[56:59], s22 offen offset:3072 lds
  s_cmp_lg_u32 s66, 0
  s_cbranch_scc1 sc_ci
  s_cmp_lg_u32 s16, 0
  s_cbranch_scc1 w0_2
  s_lshr_b32 s70, s3, 5
  s_and_b32 s71, s70, 4
  s_mul_i32 s71, s71, 12
  s_lshl_b32 s70, s70, 2
  s_add_u32 s70, s70, s71
  s_lshl_b32 s71, 1, s3
  v_mov_b32 v248, s71
  v_mov_b32 v249, 32
  s_mov_b64 exec, 1
  buffer_atomic_or v248, v249, s[12:15], s70 offen sc0
  buffer_load_dwordx2 v[250:251], v249, s[12:15], 0 offen offset:96 sc1
  s_mov_b64 exec, -1
w0_2:
sc_ci:
  v_and_b32 v26, 15, v25
  v_xor_b32 v27, v26, v24
  v_lshlrev_b32 v27, 4, v27
  v_bfe_u32 v28, v25, 2, 1
  v_lshlrev_b32 v28, 4, v28
  v_lshrrev_b32 v29, 3, v25
  v_lshl_add_u32 v28, v29, 2, v28
  v_and_b32 v29, 3, v25
  v_add_u32 v28, v28, v29
  v_lshl_add_u32 v28, v28, 9, v27
  v_lshrrev_b32 v29, 2, v26
  v_lshlrev_b32 v29, 15, v29
  v_bfe_u32 v30, v26, 1, 1
  v_lshl_add_u32 v29, v30, 11, v29
  v_lshrrev_b32 v30, 4, v25
  v_lshl_add_u32 v29, v30, 10, v29
  v_and_b32 v31, 1, v26
  v_lshl_add_u32 v29, v31, 9, v29
  v_add_u32 v29, v29, v27
  v_add_u32 v29, s25, v29
  v_xor_b32 v8, 0, v28
  v_xor_b32 v104, 0, v29
  v_xor_b32 v9, 32, v28
  v_xor_b32 v105, 32, v29
  v_xor_b32 v10, 64, v28
  v_xor_b32 v106, 64, v29
  v_xor_b32 v11, 96, v28
  v_xor_b32 v107, 96, v29
  v_xor_b32 v12, 128, v28
  v_xor_b32 v108, 128, v29
  v_xor_b32 v13, 160, v28
  v_xor_b32 v109, 160, v29
  v_xor_b32 v14, 192, v28
  v_xor_b32 v110, 192, v29
  v_xor_b32 v15, 224, v28
  v_xor_b32 v111, 224, v29
  s_mov_b32 s52, 1035512379
  s_waitcnt vmcnt(4)
  ds_read_b128 v[120:123], v104 offset:16384
  ds_read_b128 v[124:127], v105 offset:16384
  ds_read_b128 v[128:131], v106 offset:16384
  ds_read_b128 v[132:135], v107 offset:16384
  ds_read_b128 v[136:139], v108 offset:16384
  ds_read_b128 v[140:143], v109 offset:16384
  ds_read_b128 v[144:147], v110 offset:16384
  ds_read_b128 v[148:151], v111 offset:16384
  s_waitcnt lgkmcnt(4)
  ds_read_b128 v[152:155], v104 offset:16640
  ds_read_b128 v[156:159], v105 offset:16640
  ds_read_b128 v[160:163], v106 offset:16640
  ds_read_b128 v[164:167], v107 offset:16640
  ds_read_b128 v[168:171], v108 offset:16640
  ds_read_b128 v[172:175], v109 offset:16640
  ds_read_b128 v[176:179], v110 offset:16640
  ds_read_b128 v[180:183], v111 offset:16640
  s_waitcnt lgkmcnt(4)
  ds_read_b128 v[184:187], v104 offset:32768
  ds_read_b128 v[188:191], v105 offset:32768
  ds_read_b128 v[192:195], v106 offset:32768
  ds_read_b128 v[196:199], v107 offset:32768
  ds_read_b128 v[200:203], v108 offset:32768
  ds_read_b128 v[204:207], v109 offset:32768
  ds_read_b128 v[208:211], v110 offset:32768
  ds_read_b128 v[212:215], v111 offset:32768
  s_waitcnt lgkmcnt(4)
  ds_read_b128 v[216:219], v104 offset:33024
  ds_read_b128 v[220:223], v105 offset:33024
  ds_read_b128 v[224:227], v106 offset:33024
  ds_read_b128 v[228:231], v107 offset:33024
  ds_read_b128 v[232:235], v108 offset:33024
  ds_read_b128 v[236:239], v109 offset:33024
  ds_read_b128 v[240:243], v110 offset:33024
  ds_read_b128 v[244:247], v111 offset:33024
  s_waitcnt lgkmcnt(4)
  s_waitcnt lgkmcnt(0)
  s_add_u32 s22, s27, 262144
  s_add_u32 m0, s25, 16384
  s_nop 0
  buffer_load_dwordx4 v4, s[56:59], s22 offen offset:0 lds
  buffer_load_dwordx4 v5, s[56:59], s22 offen offset:1024 lds
  buffer_load_dwordx4 v6, s[56:59], s22 offen offset:2048 lds
  buffer_load_dwordx4 v7, s[56:59], s22 offen offset:3072 lds
  s_add_u32 s22, s27, 524288
  s_add_u32 m0, s25, 32768
  s_nop 0
  buffer_load_dwordx4 v4, s[56:59], s22 offen offset:0 lds
  buffer_load_dwordx4 v5, s[56:59], s22 offen offset:1024 lds
  buffer_load_dwordx4 v6, s[56:59], s22 offen offset:2048 lds
  buffer_load_dwordx4 v7, s[56:59], s22 offen offset:3072 lds
  s_add_u32 s22, s27, 786432
  s_add_u32 m0, s25, 49152
  s_nop 0
  buffer_load_dwordx4 v4, s[56:59], s22 offen offset:0 lds
  buffer_load_dwordx4 v5, s[56:59], s22 offen offset:1024 lds
  buffer_load_dwordx4 v6, s[56:59], s22 offen offset:2048 lds
  buffer_load_dwordx4 v7, s[56:59], s22 offen offset:3072 lds
  s_cmp_lg_u32 s66, 0
  s_cbranch_scc1 sc_cf
  s_cmp_lg_u32 s16, 0
  s_cbranch_scc1 w0_3
  s_waitcnt vmcnt(12)
  v_readfirstlane_b32 s70, v250
  s_cmp_lg_u32 s70, 0
  s_cbranch_scc1 sc_nz
  v_mov_b32 v249, 128
  v_mov_b32 v250, s88
  v_mov_b32 v251, s89
  v_mov_b32 v252, 0
  v_mov_b32 v253, 0
  s_mov_b64 exec, 1
  buffer_atomic_cmpswap_x2 v[250:253], v249, s[12:15], 0 offen sc0
  s_mov_b64 exec, -1
  s_waitcnt vmcnt(0)
  v_readfirstlane_b32 s70, v250
  s_cmp_lg_u32 s70, 0
  s_cbranch_scc1 sc_nz
  v_mov_b32 v250, s88
  v_mov_b32 v251, s89
sc_nz:
w0_3:
  v_mov_b32 v249, 160000
  s_add_u32 s101, s101, 1
  s_barrier
  s_mov_b64 exec, 1
  s_cmp_lg_u32 s16, 0
  s_cbranch_scc1 w0_4
  ds_write_b32 v249, v248 offset:0
  ds_write_b32 v249, v250 offset:4
  ds_write_b32 v249, v251 offset:8
  s_waitcnt lgkmcnt(0)
  v_mov_b32 v248, s101
  ds_write_b32 v249, v248 offset:16
  s_waitcnt lgkmcnt(0)
w0_4:
  s_mov_b64 exec, -1
  s_barrier
  ds_read_b32 v248, v249 offset:0
  ds_read_b32 v250, v249 offset:4
  ds_read_b32 v251, v249 offset:8
  ds_read_b32 v249, v249 offset:16
  s_waitcnt lgkmcnt(0)
  v_readfirstlane_b32 s70, v248
  v_readfirstlane_b32 s88, v250
  v_readfirstlane_b32 s89, v251
  v_cmp_ne_u32 vcc, s101, v249
  s_cbranch_vccnz ch_end
  s_mov_b32 s66, 1
  s_bitcmp1_b32 s70, s3
  s_cbranch_scc1 m_reclaim
sc_cf:
  s_cmp_lg_u32 s16, 0
  s_cbranch_scc1 w0_5
  s_cmp_eq_u32 s67, 0
  s_cselect_b32 s20, 1, 0x10001
  v_mov_b32 v248, s20
  v_mov_b32 v249, 0
  s_mov_b64 exec, 1
  buffer_atomic_add v248, v249, s[12:15], 0 offen
  s_mov_b64 exec, -1
w0_5:
  s_lshl_b32 s28, s17, 7
  s_add_u32 s28, s28, 88621120
  v_min_u32 v113, 32, v2
  s_mov_b32 s29, 88590336
  v_add_u32 v112, 1024, v2
  v_min_u32 v112, 1776, v112
  s_waitcnt vmcnt(8)
  s_barrier
  ds_read_b128 v[16:19], v8 offset:0
  ds_read_b128 v[20:23], v9 offset:0
  ds_read_b128 v[24:27], v10 offset:0
  ds_read_b128 v[28:31], v11 offset:0
  s_waitcnt lgkmcnt(3)
  v_mfma_f32_32x32x16_bf16 v[32:47], v[16:19], v[120:123], 0
  s_add_u32 s22, s27, 1048576
  s_add_u32 m0, s25, 65536
  s_nop 0
  buffer_load_dwordx4 v4, s[56:59], s22 offen offset:0 lds
  v_mfma_f32_32x32x16_bf16 v[48:63], v[16:19], v[184:187], 0
  ds_read_b128 v[16:19], v12 offset:0
  s_waitcnt lgkmcnt(3)
  v_mfma_f32_32x32x16_bf16 v[32:47], v[20:23], v[124:127], v[32:47]
  buffer_load_dwordx4 v5, s[56:59], s22 offen offset:1024 lds
  v_mfma_f32_32x32x16_bf16 v[48:63], v[20:23], v[188:191], v[48:63]
  ds_read_b128 v[20:23], v13 offset:0
  s_waitcnt lgkmcnt(3)
  v_mfma_f32_32x32x16_bf16 v[32:47], v[24:27], v[128:131], v[32:47]
  buffer_load_dwordx4 v6, s[56:59], s22 offen offset:2048 lds
  v_mfma_f32_32x32x16_bf16 v[48:63], v[24:27], v[192:195], v[48:63]
  ds_read_b128 v[24:27], v14 offset:0
  s_waitcnt lgkmcnt(3)
  v_mfma_f32_32x32x16_bf16 v[32:47], v[28:31], v[132:135], v[32:47]
  buffer_load_dwordx4 v7, s[56:59], s22 offen offset:3072 lds
  v_mfma_f32_32x32x16_bf16 v[48:63], v[28:31], v[196:199], v[48:63]
  ds_read_b128 v[28:31], v15 offset:0
  s_waitcnt lgkmcnt(3)
  v_mfma_f32_32x32x16_bf16 v[32:47], v[16:19], v[136:139], v[32:47]
  s_add_u32 s22, s27, 1310720
  s_add_u32 m0, s25, 81920
  s_nop 0
  buffer_load_dwordx4 v4, s[56:59], s22 offen offset:0 lds
  v_mfma_f32_32x32x16_bf16 v[48:63], v[16:19], v[200:203], v[48:63]
  ds_read_b128 v[16:19], v8 offset:256
  s_waitcnt lgkmcnt(3)
  v_mfma_f32_32x32x16_bf16 v[32:47], v[20:23], v[140:143], v[32:47]
  buffer_load_dwordx4 v5, s[56:59], s22 offen offset:1024 lds
  v_mfma_f32_32x32x16_bf16 v[48:63], v[20:23], v[204:207], v[48:63]
  ds_read_b128 v[20:23], v9 offset:256
  s_waitcnt lgkmcnt(3)
  v_mfma_f32_32x32x16_bf16 v[32:47], v[24:27], v[144:147], v[32:47]
  buffer_load_dwordx4 v6, s[56:59], s22 offen offset:2048 lds
  v_mfma_f32_32x32x16_bf16 v[48:63], v[24:27], v[208:211], v[48:63]
  ds_read_b128 v[24:27], v10 offset:256
  s_waitcnt lgkmcnt(3)
  v_mfma_f32_32x32x16_bf16 v[32:47], v[28:31], v[148:151], v[32:47]
  buffer_load_dwordx4 v7, s[56:59], s22 offen offset:3072 lds
  v_mfma_f32_32x32x16_bf16 v[48:63], v[28:31], v[212:215], v[48:63]
  ds_read_b128 v[28:31], v11 offset:256
  s_waitcnt lgkmcnt(3)
  v_mfma_f32_32x32x16_bf16 v[32:47], v[16:19], v[152:155], v[32:47]
  s_add_u32 s22, s27, 1572864
  s_add_u32 m0, s25, 98304
  s_nop 0
  buffer_load_dwordx4 v4, s[56:59], s22 offen offset:0 lds
  v_mfma_f32_32x32x16_bf16 v[48:63], v[16:19], v[216:219], v[48:63]
  ds_read_b128 v[16:19], v12 offset:256
  s_waitcnt lgkmcnt(3)
  v_mfma_f32_32x32x16_bf16 v[32:47], v[20:23], v[156:159], v[32:47]
  buffer_load_dwordx4 v5, s[56:59], s22 offen offset:1024 lds
  v_mfma_f32_32x32x16_bf16 v[48:63], v[20:23], v[220:223], v[48:63]
  ds_read_b128 v[20:23], v13 offset:256
  s_waitcnt lgkmcnt(3)
  v_mfma_f32_32x32x16_bf16 v[32:47], v[24:27], v[160:163], v[32:47]
  buffer_load_dwordx4 v6, s[56:59], s22 offen offset:2048 lds
  v_mfma_f32_32x32x16_bf16 v[48:63], v[24:27], v[224:227], v[48:63]
  ds_read_b128 v[24:27], v14 offset:256
  s_waitcnt lgkmcnt(3)
  v_mfma_f32_32x32x16_bf16 v[32:47], v[28:31], v[164:167], v[32:47]
  buffer_load_dwordx4 v7, s[56:59], s22 offen offset:3072 lds
  v_mfma_f32_32x32x16_bf16 v[48:63], v[28:31], v[228:231], v[48:63]
  ds_read_b128 v[28:31], v15 offset:256
  s_waitcnt lgkmcnt(3)
  v_mfma_f32_32x32x16_bf16 v[32:47], v[16:19], v[168:171], v[32:47]
  s_add_u32 s22, s27, 1835008
  s_add_u32 m0, s25, 114688
  s_nop 0
  buffer_load_dwordx4 v4, s[56:59], s22 offen offset:0 lds
  v_mfma_f32_32x32x16_bf16 v[48:63], v[16:19], v[232:235], v[48:63]
  ds_read_b128 v[16:19], v8 offset:16384
  s_waitcnt lgkmcnt(3)
  v_mfma_f32_32x32x16_bf16 v[32:47], v[20:23], v[172:175], v[32:47]
  buffer_load_dwordx4 v5, s[56:59], s22 offen offset:1024 lds
  v_mfma_f32_32x32x16_bf16 v[48:63], v[20:23], v[236:239], v[48:63]
  ds_read_b128 v[20:23], v9 offset:16384
  s_waitcnt lgkmcnt(3)
  v_mfma_f32_32x32x16_bf16 v[32:47], v[24:27], v[176:179], v[32:47]
  buffer_load_dwordx4 v6, s[56:59], s22 offen offset:2048 lds
  v_mfma_f32_32x32x16_bf16 v[48:63], v[24:27], v[240:243], v[48:63]
  ds_read_b128 v[24:27], v10 offset:16384
  s_waitcnt lgkmcnt(3)
  v_mfma_f32_32x32x16_bf16 v[32:47], v[28:31], v[180:183], v[32:47]
  buffer_load_dwordx4 v7, s[56:59], s22 offen offset:3072 lds
  v_mfma_f32_32x32x16_bf16 v[48:63], v[28:31], v[244:247], v[48:63]
  s_waitcnt vmcnt(16)
  s_barrier
  ds_read_b128 v[28:31], v11 offset:16384
  s_waitcnt lgkmcnt(3)
  v_mfma_f32_32x32x16_bf16 v[64:79], v[16:19], v[120:123], 0
  s_add_u32 s22, s27, 2097152
  s_add_u32 m0, s25, 131072
  s_nop 0
  buffer_load_dwordx4 v4, s[56:59], s22 offen offset:0 lds
  v_mfma_f32_32x32x16_bf16 v[80:95], v[16:19], v[184:187], 0
  ds_read_b128 v[16:19], v12 offset:16384
  s_waitcnt lgkmcnt(3)
  v_mfma_f32_32x32x16_bf16 v[64:79], v[20:23], v[124:127], v[64:79]
  buffer_load_dwordx4 v5, s[56:59], s22 offen offset:1024 lds
  v_mul_f32 v32, s52, v32
  v_mul_f32 v33, s52, v33
  v_cvt_pk_bf16_f32 v32, v32, v33
  v_mfma_f32_32x32x16_bf16 v[80:95], v[20:23], v[188:191], v[80:95]
  v_mul_f32 v34, s52, v34
  v_mul_f32 v35, s52, v35
  ds_read_b128 v[20:23], v13 offset:16384
  s_waitcnt lgkmcnt(3)
  v_mfma_f32_32x32x16_bf16 v[64:79], v[24:27], v[128:131], v[64:79]
  buffer_load_dwordx4 v6, s[56:59], s22 offen offset:2048 lds
  v_cvt_pk_bf16_f32 v33, v34, v35
  v_mul_f32 v36, s52, v36
  v_mul_f32 v37, s52, v37
  v_mfma_f32_32x32x16_bf16 v[80:95], v[24:27], v[192:195], v[80:95]
  v_cvt_pk_bf16_f32 v34, v36, v37
  v_mul_f32 v38, s52, v38
  ds_read_b128 v[24:27], v14 offset:16384
  s_waitcnt lgkmcnt(3)
  v_mfma_f32_32x32x16_bf16 v[64:79], v[28:31], v[132:135], v[64:79]
  buffer_load_dwordx4 v7, s[56:59], s22 offen offset:3072 lds
  v_mul_f32 v39, s52, v39
  v_cvt_pk_bf16_f32 v35, v38, v39
  v_mul_f32 v40, s52, v40
  v_mfma_f32_32x32x16_bf16 v[80:95], v[28:31], v[196:199], v[80:95]
  v_mul_f32 v41, s52, v41
  v_cvt_pk_bf16_f32 v40, v40, v41
  ds_read_b128 v[28:31], v15 offset:16384
  s_waitcnt lgkmcnt(3)
  v_mfma_f32_32x32x16_bf16 v[64:79], v[16:19], v[136:139], v[64:79]
  s_add_u32 s22, s27, 2359296
  s_add_u32 m0, s25, 0
  s_nop 0
  buffer_load_dwordx4 v4, s[56:59], s22 offen offset:0 lds
  v_mul_f32 v42, s52, v42
  v_mul_f32 v43, s52, v43
  v_cvt_pk_bf16_f32 v41, v42, v43
  v_mfma_f32_32x32x16_bf16 v[80:95], v[16:19], v[200:203], v[80:95]
  v_mul_f32 v44, s52, v44
  v_mul_f32 v45, s52, v45
  ds_read_b128 v[16:19], v8 offset:16640
  s_waitcnt lgkmcnt(3)
  v_mfma_f32_32x32x16_bf16 v[64:79], v[20:23], v[140:143], v[64:79]
  buffer_load_dwordx4 v5, s[56:59], s22 offen offset:1024 lds
  v_cvt_pk_bf16_f32 v42, v44, v45
  v_mul_f32 v46, s52, v46
  v_mul_f32 v47, s52, v47
  v_mfma_f32_32x32x16_bf16 v[80:95], v[20:23], v[204:207], v[80:95]
  v_cvt_pk_bf16_f32 v43, v46, v47
  v_permlane16_swap_b32 v32, v40
  ds_read_b128 v[20:23], v9 offset:16640
  s_waitcnt lgkmcnt(3)
  v_mfma_f32_32x32x16_bf16 v[64:79], v[24:27], v[144:147], v[64:79]
  buffer_load_dwordx4 v6, s[56:59], s22 offen offset:2048 lds
  v_permlane16_swap_b32 v33, v41
  v_permlane16_swap_b32 v34, v42
  v_permlane16_swap_b32 v35, v43
  v_mfma_f32_32x32x16_bf16 v[80:95], v[24:27], v[208:211], v[80:95]
  v_accvgpr_write_b32 a0, v32
  v_accvgpr_write_b32 a1, v33
  ds_read_b128 v[24:27], v10 offset:16640
  s_waitcnt lgkmcnt(3)
  v_mfma_f32_32x32x16_bf16 v[64:79], v[28:31], v[148:151], v[64:79]
  buffer_load_dwordx4 v7, s[56:59], s22 offen offset:3072 lds
  v_accvgpr_write_b32 a2, v34
  v_accvgpr_write_b32 a3, v35
  v_accvgpr_write_b32 a56, v40
  v_mfma_f32_32x32x16_bf16 v[80:95], v[28:31], v[212:215], v[80:95]
  v_accvgpr_write_b32 a57, v41
  v_accvgpr_write_b32 a58, v42
  ds_read_b128 v[28:31], v11 offset:16640
  s_waitcnt lgkmcnt(3)
  v_mfma_f32_32x32x16_bf16 v[64:79], v[16:19], v[152:155], v[64:79]
  v_accvgpr_write_b32 a59, v43
  v_mul_f32 v48, s52, v48
  v_mul_f32 v49, s52, v49
  v_mfma_f32_32x32x16_bf16 v[80:95], v[16:19], v[216:219], v[80:95]
  v_cvt_pk_bf16_f32 v48, v48, v49
  v_mul_f32 v50, s52, v50
  ds_read_b128 v[16:19], v12 offset:16640
  s_waitcnt lgkmcnt(3)
  v_mfma_f32_32x32x16_bf16 v[64:79], v[20:23], v[156:159], v[64:79]
  v_mul_f32 v51, s52, v51
  v_cvt_pk_bf16_f32 v49, v50, v51
  v_mul_f32 v52, s52, v52
  v_mfma_f32_32x32x16_bf16 v[80:95], v[20:23], v[220:223], v[80:95]
  v_mul_f32 v53, s52, v53
  v_cvt_pk_bf16_f32 v50, v52, v53
  ds_read_b128 v[20:23], v13 offset:16640
  s_waitcnt lgkmcnt(3)
  v_mfma_f32_32x32x16_bf16 v[64:79], v[24:27], v[160:163], v[64:79]
  v_mul_f32 v54, s52, v54
  v_mul_f32 v55, s52, v55
  v_cvt_pk_bf16_f32 v51, v54, v55
  v_mfma_f32_32x32x16_bf16 v[80:95], v[24:27], v[224:227], v[80:95]
  v_mul_f32 v56, s52, v56
  v_mul_f32 v57, s52, v57
  ds_read_b128 v[24:27], v14 offset:16640
  s_waitcnt lgkmcnt(3)
  v_mfma_f32_32x32x16_bf16 v[64:79], v[28:31], v[164:167], v[64:79]
  v_cvt_pk_bf16_f32 v56, v56, v57
  v_mul_f32 v58, s52, v58
  v_mul_f32 v59, s52, v59
  v_mfma_f32_32x32x16_bf16 v[80:95], v[28:31], v[228:231], v[80:95]
  v_cvt_pk_bf16_f32 v57, v58, v59
  v_mul_f32 v60, s52, v60
  ds_read_b128 v[28:31], v15 offset:16640
  s_waitcnt lgkmcnt(3)
  v_mfma_f32_32x32x16_bf16 v[64:79], v[16:19], v[168:171], v[64:79]
  v_mul_f32 v61, s52, v61
  v_cvt_pk_bf16_f32 v58, v60, v61
  v_mul_f32 v62, s52, v62
  v_mfma_f32_32x32x16_bf16 v[80:95], v[16:19], v[232:235], v[80:95]
  v_mul_f32 v63, s52, v63
  v_cvt_pk_bf16_f32 v59, v62, v63
  ds_read_b128 v[16:19], v8 offset:32768
  s_waitcnt lgkmcnt(3)
  v_mfma_f32_32x32x16_bf16 v[64:79], v[20:23], v[172:175], v[64:79]
  v_permlane16_swap_b32 v48, v56
  v_permlane16_swap_b32 v49, v57
  v_permlane16_swap_b32 v50, v58
  v_mfma_f32_32x32x16_bf16 v[80:95], v[20:23], v[236:239], v[80:95]
  v_permlane16_swap_b32 v51, v59
  v_accvgpr_write_b32 a112, v48
  ds_read_b128 v[20:23], v9 offset:32768
  s_waitcnt lgkmcnt(3)
  v_mfma_f32_32x32x16_bf16 v[64:79], v[24:27], v[176:179], v[64:79]
  v_accvgpr_write_b32 a113, v49
  v_accvgpr_write_b32 a114, v50
  v_accvgpr_write_b32 a115, v51
  v_mfma_f32_32x32x16_bf16 v[80:95], v[24:27], v[240:243], v[80:95]
  v_accvgpr_write_b32 a168, v56
  v_accvgpr_write_b32 a169, v57
  ds_read_b128 v[24:27], v10 offset:32768
  s_waitcnt lgkmcnt(3)
  v_mfma_f32_32x32x16_bf16 v[64:79], v[28:31], v[180:183], v[64:79]
  v_accvgpr_write_b32 a170, v58
  v_accvgpr_write_b32 a171, v59
  v_mfma_f32_32x32x16_bf16 v[80:95], v[28:31], v[244:247], v[80:95]
  ds_read_b128 v[28:31], v11 offset:32768
  s_waitcnt lgkmcnt(3)
  v_mfma_f32_32x32x16_bf16 v[32:47], v[16:19], v[120:123], 0
  v_mfma_f32_32x32x16_bf16 v[48:63], v[16:19], v[184:187], 0
  ds_read_b128 v[16:19], v12 offset:32768
  s_waitcnt lgkmcnt(3)
  v_mfma_f32_32x32x16_bf16 v[32:47], v[20:23], v[124:127], v[32:47]
  v_mul_f32 v64, s52, v64
  v_mul_f32 v65, s52, v65
  v_cvt_pk_bf16_f32 v64, v64, v65
  v_mfma_f32_32x32x16_bf16 v[48:63], v[20:23], v[188:191], v[48:63]
  v_mul_f32 v66, s52, v66
  v_mul_f32 v67, s52, v67
  ds_read_b128 v[20:23], v13 offset:32768
  s_waitcnt lgkmcnt(3)
  v_mfma_f32_32x32x16_bf16 v[32:47], v[24:27], v[128:131], v[32:47]
  v_cvt_pk_bf16_f32 v65, v66, v67
  v_mul_f32 v68, s52, v68
  v_mul_f32 v69, s52, v69
  v_mfma_f32_32x32x16_bf16 v[48:63], v[24:27], v[192:195], v[48:63]
  v_cvt_pk_bf16_f32 v66, v68, v69
  v_mul_f32 v70, s52, v70
  ds_read_b128 v[24:27], v14 offset:32768
  s_waitcnt lgkmcnt(3)
  v_mfma_f32_32x32x16_bf16 v[32:47], v[28:31], v[132:135], v[32:47]
  v_mul_f32 v71, s52, v71
  v_cvt_pk_bf16_f32 v67, v70, v71
  v_mul_f32 v72, s52, v72
  v_mfma_f32_32x32x16_bf16 v[48:63], v[28:31], v[196:199], v[48:63]
  v_mul_f32 v73, s52, v73
  v_cvt_pk_bf16_f32 v72, v72, v73
  ds_read_b128 v[28:31], v15 offset:32768
  s_waitcnt lgkmcnt(3)
  v_mfma_f32_32x32x16_bf16 v[32:47], v[16:19], v[136:139], v[32:47]
  v_mul_f32 v74, s52, v74
  v_mul_f32 v75, s52, v75
  v_cvt_pk_bf16_f32 v73, v74, v75
  v_mfma_f32_32x32x16_bf16 v[48:63], v[16:19], v[200:203], v[48:63]
  v_mul_f32 v76, s52, v76
  v_mul_f32 v77, s52, v77
  ds_read_b128 v[16:19], v8 offset:33024
  s_waitcnt lgkmcnt(3)
  v_mfma_f32_32x32x16_bf16 v[32:47], v[20:23], v[140:143], v[32:47]
  v_cvt_pk_bf16_f32 v74, v76, v77
  v_mul_f32 v78, s52, v78
  v_mul_f32 v79, s52, v79
  v_mfma_f32_32x32x16_bf16 v[48:63], v[20:23], v[204:207], v[48:63]
  v_cvt_pk_bf16_f32 v75, v78, v79
  v_permlane16_swap_b32 v64, v72
  ds_read_b128 v[20:23], v9 offset:33024
  s_waitcnt lgkmcnt(3)
  v_mfma_f32_32x32x16_bf16 v[32:47], v[24:27], v[144:147], v[32:47]
  v_permlane16_swap_b32 v65, v73
  v_permlane16_swap_b32 v66, v74
  v_permlane16_swap_b32 v67, v75
  v_mfma_f32_32x32x16_bf16 v[48:63], v[24:27], v[208:211], v[48:63]
  v_accvgpr_write_b32 a4, v64
  v_accvgpr_write_b32 a5, v65
  ds_read_b128 v[24:27], v10 offset:33024
  s_waitcnt lgkmcnt(3)
  v_mfma_f32_32x32x16_bf16 v[32:47], v[28:31], v[148:151], v[32:47]
  v_accvgpr_write_b32 a6, v66
  v_accvgpr_write_b32 a7, v67
  v_accvgpr_write_b32 a60, v72
  v_mfma_f32_32x32x16_bf16 v[48:63], v[28:31], v[212:215], v[48:63]
  v_accvgpr_write_b32 a61, v73
  v_accvgpr_write_b32 a62, v74
  ds_read_b128 v[28:31], v11 offset:33024
  s_waitcnt lgkmcnt(3)
  v_mfma_f32_32x32x16_bf16 v[32:47], v[16:19], v[152:155], v[32:47]
  v_accvgpr_write_b32 a63, v75
  v_mul_f32 v80, s52, v80
  v_mul_f32 v81, s52, v81
  v_mfma_f32_32x32x16_bf16 v[48:63], v[16:19], v[216:219], v[48:63]
  v_cvt_pk_bf16_f32 v80, v80, v81
  v_mul_f32 v82, s52, v82
  ds_read_b128 v[16:19], v12 offset:33024
  s_waitcnt lgkmcnt(3)
  v_mfma_f32_32x32x16_bf16 v[32:47], v[20:23], v[156:159], v[32:47]
  v_mul_f32 v83, s52, v83
  v_cvt_pk_bf16_f32 v81, v82, v83
  v_mul_f32 v84, s52, v84
  v_mfma_f32_32x32x16_bf16 v[48:63], v[20:23], v[220:223], v[48:63]
  v_mul_f32 v85, s52, v85
  v_cvt_pk_bf16_f32 v82, v84, v85
  ds_read_b128 v[20:23], v13 offset:33024
  s_waitcnt lgkmcnt(3)
  v_mfma_f32_32x32x16_bf16 v[32:47], v[24:27], v[160:163], v[32:47]
  v_mul_f32 v86, s52, v86
  v_mul_f32 v87, s52, v87
  v_cvt_pk_bf16_f32 v83, v86, v87
  v_mfma_f32_32x32x16_bf16 v[48:63], v[24:27], v[224:227], v[48:63]
  v_mul_f32 v88, s52, v88
  v_mul_f32 v89, s52, v89
  ds_read_b128 v[24:27], v14 offset:33024
  s_waitcnt lgkmcnt(3)
  v_mfma_f32_32x32x16_bf16 v[32:47], v[28:31], v[164:167], v[32:47]
  v_cvt_pk_bf16_f32 v88, v88, v89
  v_mul_f32 v90, s52, v90
  v_mul_f32 v91, s52, v91
  v_mfma_f32_32x32x16_bf16 v[48:63], v[28:31], v[228:231], v[48:63]
  v_cvt_pk_bf16_f32 v89, v90, v91
  v_mul_f32 v92, s52, v92
  ds_read_b128 v[28:31], v15 offset:33024
  s_waitcnt lgkmcnt(3)
  v_mfma_f32_32x32x16_bf16 v[32:47], v[16:19], v[168:171], v[32:47]
  v_mul_f32 v93, s52, v93
  v_cvt_pk_bf16_f32 v90, v92, v93
  v_mul_f32 v94, s52, v94
  v_mfma_f32_32x32x16_bf16 v[48:63], v[16:19], v[232:235], v[48:63]
  v_mul_f32 v95, s52, v95
  v_cvt_pk_bf16_f32 v91, v94, v95
  ds_read_b128 v[16:19], v8 offset:49152
  s_waitcnt lgkmcnt(3)
  v_mfma_f32_32x32x16_bf16 v[32:47], v[20:23], v[172:175], v[32:47]
  v_permlane16_swap_b32 v80, v88
  v_permlane16_swap_b32 v81, v89
  v_permlane16_swap_b32 v82, v90
  v_mfma_f32_32x32x16_bf16 v[48:63], v[20:23], v[236:239], v[48:63]
  v_permlane16_swap_b32 v83, v91
  v_accvgpr_write_b32 a116, v80
  ds_read_b128 v[20:23], v9 offset:49152
  s_waitcnt lgkmcnt(3)
  v_mfma_f32_32x32x16_bf16 v[32:47], v[24:27], v[176:179], v[32:47]
  v_accvgpr_write_b32 a117, v81
  v_accvgpr_write_b32 a118, v82
  v_accvgpr_write_b32 a119, v83
  v_mfma_f32_32x32x16_bf16 v[48:63], v[24:27], v[240:243], v[48:63]
  v_accvgpr_write_b32 a172, v88
  v_accvgpr_write_b32 a173, v89
  ds_read_b128 v[24:27], v10 offset:49152
  s_waitcnt lgkmcnt(3)
  v_mfma_f32_32x32x16_bf16 v[32:47], v[28:31], v[180:183], v[32:47]
  v_accvgpr_write_b32 a174, v90
  v_accvgpr_write_b32 a175, v91
  v_mfma_f32_32x32x16_bf16 v[48:63], v[28:31], v[244:247], v[48:63]
  s_waitcnt vmcnt(16)
  s_barrier
  ds_read_b128 v[28:31], v11 offset:49152
  s_waitcnt lgkmcnt(3)
  v_mfma_f32_32x32x16_bf16 v[64:79], v[16:19], v[120:123], 0
  s_add_u32 s22, s27, 2621440
  s_add_u32 m0, s25, 16384
  s_nop 0
  buffer_load_dwordx4 v4, s[56:59], s22 offen offset:0 lds
  v_mfma_f32_32x32x16_bf16 v[80:95], v[16:19], v[184:187], 0
  ds_read_b128 v[16:19], v12 offset:49152
  s_waitcnt lgkmcnt(3)
  v_mfma_f32_32x32x16_bf16 v[64:79], v[20:23], v[124:127], v[64:79]
  buffer_load_dwordx4 v5, s[56:59], s22 offen offset:1024 lds
  v_mul_f32 v32, s52, v32
  v_mul_f32 v33, s52, v33
  v_cvt_pk_bf16_f32 v32, v32, v33
  v_mfma_f32_32x32x16_bf16 v[80:95], v[20:23], v[188:191], v[80:95]
  v_mul_f32 v34, s52, v34
  v_mul_f32 v35, s52, v35
  ds_read_b128 v[20:23], v13 offset:49152
  s_waitcnt lgkmcnt(3)
  v_mfma_f32_32x32x16_bf16 v[64:79], v[24:27], v[128:131], v[64:79]
  buffer_load_dwordx4 v6, s[56:59], s22 offen offset:2048 lds
  v_cvt_pk_bf16_f32 v33, v34, v35
  v_mul_f32 v36, s52, v36
  v_mul_f32 v37, s52, v37
  v_mfma_f32_32x32x16_bf16 v[80:95], v[24:27], v[192:195], v[80:95]
  v_cvt_pk_bf16_f32 v34, v36, v37
  v_mul_f32 v38, s52, v38
  ds_read_b128 v[24:27], v14 offset:49152
  s_waitcnt lgkmcnt(3)
  v_mfma_f32_32x32x16_bf16 v[64:79], v[28:31], v[132:135], v[64:79]
  buffer_load_dwordx4 v7, s[56:59], s22 offen offset:3072 lds
  v_mul_f32 v39, s52, v39
  v_cvt_pk_bf16_f32 v35, v38, v39
  v_mul_f32 v40, s52, v40
  v_mfma_f32_32x32x16_bf16 v[80:95], v[28:31], v[196:199], v[80:95]
  v_mul_f32 v41, s52, v41
  v_cvt_pk_bf16_f32 v40, v40, v41
  ds_read_b128 v[28:31], v15 offset:49152
  s_waitcnt lgkmcnt(3)
  v_mfma_f32_32x32x16_bf16 v[64:79], v[16:19], v[136:139], v[64:79]
  s_add_u32 s22, s27, 2883584
  s_add_u32 m0, s25, 32768
  s_nop 0
  buffer_load_dwordx4 v4, s[56:59], s22 offen offset:0 lds
  v_mul_f32 v42, s52, v42
  v_mul_f32 v43, s52, v43
  v_cvt_pk_bf16_f32 v41, v42, v43
  v_mfma_f32_32x32x16_bf16 v[80:95], v[16:19], v[200:203], v[80:95]
  v_mul_f32 v44, s52, v44
  v_mul_f32 v45, s52, v45
  ds_read_b128 v[16:19], v8 offset:49408
  s_waitcnt lgkmcnt(3)
  v_mfma_f32_32x32x16_bf16 v[64:79], v[20:23], v[140:143], v[64:79]
  buffer_load_dwordx4 v5, s[56:59], s22 offen offset:1024 lds
  v_cvt_pk_bf16_f32 v42, v44, v45
  v_mul_f32 v46, s52, v46
  v_mul_f32 v47, s52, v47
  v_mfma_f32_32x32x16_bf16 v[80:95], v[20:23], v[204:207], v[80:95]
  v_cvt_pk_bf16_f32 v43, v46, v47
  v_permlane16_swap_b32 v32, v40
  ds_read_b128 v[20:23], v9 offset:49408
  s_waitcnt lgkmcnt(3)
  v_mfma_f32_32x32x16_bf16 v[64:79], v[24:27], v[144:147], v[64:79]
  buffer_load_dwordx4 v6, s[56:59], s22 offen offset:2048 lds
  v_permlane16_swap_b32 v33, v41
  v_permlane16_swap_b32 v34, v42
  v_permlane16_swap_b32 v35, v43
  v_mfma_f32_32x32x16_bf16 v[80:95], v[24:27], v[208:211], v[80:95]
  v_accvgpr_write_b32 a8, v32
  v_accvgpr_write_b32 a9, v33
  ds_read_b128 v[24:27], v10 offset:49408
  s_waitcnt lgkmcnt(3)
  v_mfma_f32_32x32x16_bf16 v[64:79], v[28:31], v[148:151], v[64:79]
  buffer_load_dwordx4 v7, s[56:59], s22 offen offset:3072 lds
  v_accvgpr_write_b32 a10, v34
  v_accvgpr_write_b32 a11, v35
  v_accvgpr_write_b32 a64, v40
  v_mfma_f32_32x32x16_bf16 v[80:95], v[28:31], v[212:215], v[80:95]
  v_accvgpr_write_b32 a65, v41
  v_accvgpr_write_b32 a66, v42
  ds_read_b128 v[28:31], v11 offset:49408
  s_waitcnt lgkmcnt(3)
  v_mfma_f32_32x32x16_bf16 v[64:79], v[16:19], v[152:155], v[64:79]
  v_accvgpr_write_b32 a67, v43
  v_mul_f32 v48, s52, v48
  v_mul_f32 v49, s52, v49
  v_mfma_f32_32x32x16_bf16 v[80:95], v[16:19], v[216:219], v[80:95]
  v_cvt_pk_bf16_f32 v48, v48, v49
  v_mul_f32 v50, s52, v50
  ds_read_b128 v[16:19], v12 offset:49408
  s_waitcnt lgkmcnt(3)
  v_mfma_f32_32x32x16_bf16 v[64:79], v[20:23], v[156:159], v[64:79]
  v_mul_f32 v51, s52, v51
  v_cvt_pk_bf16_f32 v49, v50, v51
  v_mul_f32 v52, s52, v52
  v_mfma_f32_32x32x16_bf16 v[80:95], v[20:23], v[220:223], v[80:95]
  v_mul_f32 v53, s52, v53
  v_cvt_pk_bf16_f32 v50, v52, v53
  ds_read_b128 v[20:23], v13 offset:49408
  s_waitcnt lgkmcnt(3)
  v_mfma_f32_32x32x16_bf16 v[64:79], v[24:27], v[160:163], v[64:79]
  v_mul_f32 v54, s52, v54
  v_mul_f32 v55, s52, v55
  v_cvt_pk_bf16_f32 v51, v54, v55
  v_mfma_f32_32x32x16_bf16 v[80:95], v[24:27], v[224:227], v[80:95]
  v_mul_f32 v56, s52, v56
  v_mul_f32 v57, s52, v57
  ds_read_b128 v[24:27], v14 offset:49408
  s_waitcnt lgkmcnt(3)
  v_mfma_f32_32x32x16_bf16 v[64:79], v[28:31], v[164:167], v[64:79]
  v_cvt_pk_bf16_f32 v56, v56, v57
  v_mul_f32 v58, s52, v58
  v_mul_f32 v59, s52, v59
  v_mfma_f32_32x32x16_bf16 v[80:95], v[28:31], v[228:231], v[80:95]
  v_cvt_pk_bf16_f32 v57, v58, v59
  v_mul_f32 v60, s52, v60
  ds_read_b128 v[28:31], v15 offset:49408
  s_waitcnt lgkmcnt(3)
  v_mfma_f32_32x32x16_bf16 v[64:79], v[16:19], v[168:171], v[64:79]
  v_mul_f32 v61, s52, v61
  v_cvt_pk_bf16_f32 v58, v60, v61
  v_mul_f32 v62, s52, v62
  v_mfma_f32_32x32x16_bf16 v[80:95], v[16:19], v[232:235], v[80:95]
  v_mul_f32 v63, s52, v63
  v_cvt_pk_bf16_f32 v59, v62, v63
  v_xor_b32 v8, 65536, v8
  ds_read_b128 v[16:19], v8 offset:0
  s_waitcnt lgkmcnt(3)
  v_mfma_f32_32x32x16_bf16 v[64:79], v[20:23], v[172:175], v[64:79]
  v_permlane16_swap_b32 v48, v56
  v_permlane16_swap_b32 v49, v57
  v_permlane16_swap_b32 v50, v58
  v_mfma_f32_32x32x16_bf16 v[80:95], v[20:23], v[236:239], v[80:95]
  v_permlane16_swap_b32 v51, v59
  v_accvgpr_write_b32 a120, v48
  v_xor_b32 v9, 65536, v9
  ds_read_b128 v[20:23], v9 offset:0
  s_waitcnt lgkmcnt(3)
  v_mfma_f32_32x32x16_bf16 v[64:79], v[24:27], v[176:179], v[64:79]
  v_accvgpr_write_b32 a121, v49
  v_accvgpr_write_b32 a122, v50
  v_accvgpr_write_b32 a123, v51
  v_mfma_f32_32x32x16_bf16 v[80:95], v[24:27], v[240:243], v[80:95]
  v_accvgpr_write_b32 a176, v56
  v_accvgpr_write_b32 a177, v57
  v_xor_b32 v10, 65536, v10
  ds_read_b128 v[24:27], v10 offset:0
  s_waitcnt lgkmcnt(3)
  v_mfma_f32_32x32x16_bf16 v[64:79], v[28:31], v[180:183], v[64:79]
  v_accvgpr_write_b32 a178, v58
  v_accvgpr_write_b32 a179, v59
  v_mfma_f32_32x32x16_bf16 v[80:95], v[28:31], v[244:247], v[80:95]
  v_xor_b32 v11, 65536, v11
  ds_read_b128 v[28:31], v11 offset:0
  s_waitcnt lgkmcnt(3)
  v_mfma_f32_32x32x16_bf16 v[32:47], v[16:19], v[120:123], 0
  v_mfma_f32_32x32x16_bf16 v[48:63], v[16:19], v[184:187], 0
  v_xor_b32 v12, 65536, v12
  ds_read_b128 v[16:19], v12 offset:0
  s_waitcnt lgkmcnt(3)
  v_mfma_f32_32x32x16_bf16 v[32:47], v[20:23], v[124:127], v[32:47]
  v_mul_f32 v64, s52, v64
  v_mul_f32 v65, s52, v65
  v_cvt_pk_bf16_f32 v64, v64, v65
  v_mfma_f32_32x32x16_bf16 v[48:63], v[20:23], v[188:191], v[48:63]
  v_mul_f32 v66, s52, v66
  v_mul_f32 v67, s52, v67
  v_xor_b32 v13, 65536, v13
  ds_read_b128 v[20:23], v13 offset:0
  s_waitcnt lgkmcnt(3)
  v_mfma_f32_32x32x16_bf16 v[32:47], v[24:27], v[128:131], v[32:47]
  v_cvt_pk_bf16_f32 v65, v66, v67
  v_mul_f32 v68, s52, v68
  v_mul_f32 v69, s52, v69
  v_mfma_f32_32x32x16_bf16 v[48:63], v[24:27], v[192:195], v[48:63]
  v_cvt_pk_bf16_f32 v66, v68, v69
  v_mul_f32 v70, s52, v70
  v_xor_b32 v14, 65536, v14
  ds_read_b128 v[24:27], v14 offset:0
  s_waitcnt lgkmcnt(3)
  v_mfma_f32_32x32x16_bf16 v[32:47], v[28:31], v[132:135], v[32:47]
  v_mul_f32 v71, s52, v71
  v_cvt_pk_bf16_f32 v67, v70, v71
  v_mul_f32 v72, s52, v72
  v_mfma_f32_32x32x16_bf16 v[48:63], v[28:31], v[196:199], v[48:63]
  v_mul_f32 v73, s52, v73
  v_cvt_pk_bf16_f32 v72, v72, v73
  v_xor_b32 v15, 65536, v15
  ds_read_b128 v[28:31], v15 offset:0
  s_waitcnt lgkmcnt(3)
  v_mfma_f32_32x32x16_bf16 v[32:47], v[16:19], v[136:139], v[32:47]
  v_mul_f32 v74, s52, v74
  v_mul_f32 v75, s52, v75
  v_cvt_pk_bf16_f32 v73, v74, v75
  v_mfma_f32_32x32x16_bf16 v[48:63], v[16:19], v[200:203], v[48:63]
  v_mul_f32 v76, s52, v76
  v_mul_f32 v77, s52, v77
  ds_read_b128 v[16:19], v8 offset:256
  s_waitcnt lgkmcnt(3)
  v_mfma_f32_32x32x16_bf16 v[32:47], v[20:23], v[140:143], v[32:47]
  v_cvt_pk_bf16_f32 v74, v76, v77
  v_mul_f32 v78, s52, v78
  v_mul_f32 v79, s52, v79
  v_mfma_f32_32x32x16_bf16 v[48:63], v[20:23], v[204:207], v[48:63]
  v_cvt_pk_bf16_f32 v75, v78, v79
  v_permlane16_swap_b32 v64, v72
  ds_read_b128 v[20:23], v9 offset:256
  s_waitcnt lgkmcnt(3)
  v_mfma_f32_32x32x16_bf16 v[32:47], v[24:27], v[144:147], v[32:47]
  v_permlane16_swap_b32 v65, v73
  v_permlane16_swap_b32 v66, v74
  v_permlane16_swap_b32 v67, v75
  v_mfma_f32_32x32x16_bf16 v[48:63], v[24:27], v[208:211], v[48:63]
  v_accvgpr_write_b32 a12, v64
  v_accvgpr_write_b32 a13, v65
  ds_read_b128 v[24:27], v10 offset:256
  s_waitcnt lgkmcnt(3)
  v_mfma_f32_32x32x16_bf16 v[32:47], v[28:31], v[148:151], v[32:47]
  v_accvgpr_write_b32 a14, v66
  v_accvgpr_write_b32 a15, v67
  v_accvgpr_write_b32 a68, v72
  v_mfma_f32_32x32x16_bf16 v[48:63], v[28:31], v[212:215], v[48:63]
  v_accvgpr_write_b32 a69, v73
  v_accvgpr_write_b32 a70, v74
  ds_read_b128 v[28:31], v11 offset:256
  s_waitcnt lgkmcnt(3)
  v_mfma_f32_32x32x16_bf16 v[32:47], v[16:19], v[152:155], v[32:47]
  v_accvgpr_write_b32 a71, v75
  v_mul_f32 v80, s52, v80
  v_mul_f32 v81, s52, v81
  v_mfma_f32_32x32x16_bf16 v[48:63], v[16:19], v[216:219], v[48:63]
  v_cvt_pk_bf16_f32 v80, v80, v81
  v_mul_f32 v82, s52, v82
  ds_read_b128 v[16:19], v12 offset:256
  s_waitcnt lgkmcnt(3)
  v_mfma_f32_32x32x16_bf16 v[32:47], v[20:23], v[156:159], v[32:47]
  v_mul_f32 v83, s52, v83
  v_cvt_pk_bf16_f32 v81, v82, v83
  v_mul_f32 v84, s52, v84
  v_mfma_f32_32x32x16_bf16 v[48:63], v[20:23], v[220:223], v[48:63]
  v_mul_f32 v85, s52, v85
  v_cvt_pk_bf16_f32 v82, v84, v85
  ds_read_b128 v[20:23], v13 offset:256
  s_waitcnt lgkmcnt(3)
  v_mfma_f32_32x32x16_bf16 v[32:47], v[24:27], v[160:163], v[32:47]
  v_mul_f32 v86, s52, v86
  v_mul_f32 v87, s52, v87
  v_cvt_pk_bf16_f32 v83, v86, v87
  v_mfma_f32_32x32x16_bf16 v[48:63], v[24:27], v[224:227], v[48:63]
  v_mul_f32 v88, s52, v88
  v_mul_f32 v89, s52, v89
  ds_read_b128 v[24:27], v14 offset:256
  s_waitcnt lgkmcnt(3)
  v_mfma_f32_32x32x16_bf16 v[32:47], v[28:31], v[164:167], v[32:47]
  v_cvt_pk_bf16_f32 v88, v88, v89
  v_mul_f32 v90, s52, v90
  v_mul_f32 v91, s52, v91
  v_mfma_f32_32x32x16_bf16 v[48:63], v[28:31], v[228:231], v[48:63]
  v_cvt_pk_bf16_f32 v89, v90, v91
  v_mul_f32 v92, s52, v92
  ds_read_b128 v[28:31], v15 offset:256
  s_waitcnt lgkmcnt(3)
  v_mfma_f32_32x32x16_bf16 v[32:47], v[16:19], v[168:171], v[32:47]
  v_mul_f32 v93, s52, v93
  v_cvt_pk_bf16_f32 v90, v92, v93
  v_mul_f32 v94, s52, v94
  v_mfma_f32_32x32x16_bf16 v[48:63], v[16:19], v[232:235], v[48:63]
  v_mul_f32 v95, s52, v95
  v_cvt_pk_bf16_f32 v91, v94, v95
  ds_read_b128 v[16:19], v8 offset:16384
  s_waitcnt lgkmcnt(3)
  v_mfma_f32_32x32x16_bf16 v[32:47], v[20:23], v[172:175], v[32:47]
  v_permlane16_swap_b32 v80, v88
  v_permlane16_swap_b32 v81, v89
  v_permlane16_swap_b32 v82, v90
  v_mfma_f32_32x32x16_bf16 v[48:63], v[20:23], v[236:239], v[48:63]
  v_permlane16_swap_b32 v83, v91
  v_accvgpr_write_b32 a124, v80
  ds_read_b128 v[20:23], v9 offset:16384
  s_waitcnt lgkmcnt(3)
  v_mfma_f32_32x32x16_bf16 v[32:47], v[24:27], v[176:179], v[32:47]
  v_accvgpr_write_b32 a125, v81
  v_accvgpr_write_b32 a126, v82
  v_accvgpr_write_b32 a127, v83
  v_mfma_f32_32x32x16_bf16 v[48:63], v[24:27], v[240:243], v[48:63]
  v_accvgpr_write_b32 a180, v88
  v_accvgpr_write_b32 a181, v89
  ds_read_b128 v[24:27], v10 offset:16384
  s_waitcnt lgkmcnt(3)
  v_mfma_f32_32x32x16_bf16 v[32:47], v[28:31], v[180:183], v[32:47]
  v_accvgpr_write_b32 a182, v90
  v_accvgpr_write_b32 a183, v91
  v_mfma_f32_32x32x16_bf16 v[48:63], v[28:31], v[244:247], v[48:63]
  s_waitcnt vmcnt(16)
  s_barrier
  ds_read_b128 v[28:31], v11 offset:16384
  s_waitcnt lgkmcnt(3)
  v_mfma_f32_32x32x16_bf16 v[64:79], v[16:19], v[120:123], 0
  s_add_u32 s22, s27, 3145728
  s_add_u32 m0, s25, 49152
  s_nop 0
  buffer_load_dwordx4 v4, s[56:59], s22 offen offset:0 lds
  v_mfma_f32_32x32x16_bf16 v[80:95], v[16:19], v[184:187], 0
  ds_read_b128 v[16:19], v12 offset:16384
  s_waitcnt lgkmcnt(3)
  v_mfma_f32_32x32x16_bf16 v[64:79], v[20:23], v[124:127], v[64:79]
  buffer_load_dwordx4 v5, s[56:59], s22 offen offset:1024 lds
  v_mul_f32 v32, s52, v32
  v_mul_f32 v33, s52, v33
  v_cvt_pk_bf16_f32 v32, v32, v33
  v_mfma_f32_32x32x16_bf16 v[80:95], v[20:23], v[188:191], v[80:95]
  v_mul_f32 v34, s52, v34
  v_mul_f32 v35, s52, v35
  ds_read_b128 v[20:23], v13 offset:16384
  s_waitcnt lgkmcnt(3)
  v_mfma_f32_32x32x16_bf16 v[64:79], v[24:27], v[128:131], v[64:79]
  buffer_load_dwordx4 v6, s[56:59], s22 offen offset:2048 lds
  v_cvt_pk_bf16_f32 v33, v34, v35
  v_mul_f32 v36, s52, v36
  v_mul_f32 v37, s52, v37
  v_mfma_f32_32x32x16_bf16 v[80:95], v[24:27], v[192:195], v[80:95]
  v_cvt_pk_bf16_f32 v34, v36, v37
  v_mul_f32 v38, s52, v38
  ds_read_b128 v[24:27], v14 offset:16384
  s_waitcnt lgkmcnt(3)
  v_mfma_f32_32x32x16_bf16 v[64:79], v[28:31], v[132:135], v[64:79]
  buffer_load_dwordx4 v7, s[56:59], s22 offen offset:3072 lds
  v_mul_f32 v39, s52, v39
  v_cvt_pk_bf16_f32 v35, v38, v39
  v_mul_f32 v40, s52, v40
  v_mfma_f32_32x32x16_bf16 v[80:95], v[28:31], v[196:199], v[80:95]
  v_mul_f32 v41, s52, v41
  v_cvt_pk_bf16_f32 v40, v40, v41
  ds_read_b128 v[28:31], v15 offset:16384
  s_waitcnt lgkmcnt(3)
  v_mfma_f32_32x32x16_bf16 v[64:79], v[16:19], v[136:139], v[64:79]
  s_add_u32 s22, s27, 3407872
  s_add_u32 m0, s25, 65536
  s_nop 0
  buffer_load_dwordx4 v4, s[56:59], s22 offen offset:0 lds
  v_mul_f32 v42, s52, v42
  v_mul_f32 v43, s52, v43
  v_cvt_pk_bf16_f32 v41, v42, v43
  v_mfma_f32_32x32x16_bf16 v[80:95], v[16:19], v[200:203], v[80:95]
  v_mul_f32 v44, s52, v44
  v_mul_f32 v45, s52, v45
  ds_read_b128 v[16:19], v8 offset:16640
  s_waitcnt lgkmcnt(3)
  v_mfma_f32_32x32x16_bf16 v[64:79], v[20:23], v[140:143], v[64:79]
  buffer_load_dwordx4 v5, s[56:59], s22 offen offset:1024 lds
  v_cvt_pk_bf16_f32 v42, v44, v45
  v_mul_f32 v46, s52, v46
  v_mul_f32 v47, s52, v47
  v_mfma_f32_32x32x16_bf16 v[80:95], v[20:23], v[204:207], v[80:95]
  v_cvt_pk_bf16_f32 v43, v46, v47
  v_permlane16_swap_b32 v32, v40
  ds_read_b128 v[20:23], v9 offset:16640
  s_waitcnt lgkmcnt(3)
  v_mfma_f32_32x32x16_bf16 v[64:79], v[24:27], v[144:147], v[64:79]
  buffer_load_dwordx4 v6, s[56:59], s22 offen offset:2048 lds
  v_permlane16_swap_b32 v33, v41
  v_permlane16_swap_b32 v34, v42
  v_permlane16_swap_b32 v35, v43
  v_mfma_f32_32x32x16_bf16 v[80:95], v[24:27], v[208:211], v[80:95]
  v_accvgpr_write_b32 a16, v32
  v_accvgpr_write_b32 a17, v33
  ds_read_b128 v[24:27], v10 offset:16640
  s_waitcnt lgkmcnt(3)
  v_mfma_f32_32x32x16_bf16 v[64:79], v[28:31], v[148:151], v[64:79]
  buffer_load_dwordx4 v7, s[56:59], s22 offen offset:3072 lds
  v_accvgpr_write_b32 a18, v34
  v_accvgpr_write_b32 a19, v35
  v_accvgpr_write_b32 a72, v40
  v_mfma_f32_32x32x16_bf16 v[80:95], v[28:31], v[212:215], v[80:95]
  v_accvgpr_write_b32 a73, v41
  v_accvgpr_write_b32 a74, v42
  ds_read_b128 v[28:31], v11 offset:16640
  s_waitcnt lgkmcnt(3)
  v_mfma_f32_32x32x16_bf16 v[64:79], v[16:19], v[152:155], v[64:79]
  v_accvgpr_write_b32 a75, v43
  v_mul_f32 v48, s52, v48
  v_mul_f32 v49, s52, v49
  v_mfma_f32_32x32x16_bf16 v[80:95], v[16:19], v[216:219], v[80:95]
  v_cvt_pk_bf16_f32 v48, v48, v49
  v_mul_f32 v50, s52, v50
  ds_read_b128 v[16:19], v12 offset:16640
  s_waitcnt lgkmcnt(3)
  v_mfma_f32_32x32x16_bf16 v[64:79], v[20:23], v[156:159], v[64:79]
  v_mul_f32 v51, s52, v51
  v_cvt_pk_bf16_f32 v49, v50, v51
  v_mul_f32 v52, s52, v52
  v_mfma_f32_32x32x16_bf16 v[80:95], v[20:23], v[220:223], v[80:95]
  v_mul_f32 v53, s52, v53
  v_cvt_pk_bf16_f32 v50, v52, v53
  ds_read_b128 v[20:23], v13 offset:16640
  s_waitcnt lgkmcnt(3)
  v_mfma_f32_32x32x16_bf16 v[64:79], v[24:27], v[160:163], v[64:79]
  v_mul_f32 v54, s52, v54
  v_mul_f32 v55, s52, v55
  v_cvt_pk_bf16_f32 v51, v54, v55
  v_mfma_f32_32x32x16_bf16 v[80:95], v[24:27], v[224:227], v[80:95]
  v_mul_f32 v56, s52, v56
  v_mul_f32 v57, s52, v57
  ds_read_b128 v[24:27], v14 offset:16640
  s_waitcnt lgkmcnt(3)
  v_mfma_f32_32x32x16_bf16 v[64:79], v[28:31], v[164:167], v[64:79]
  v_cvt_pk_bf16_f32 v56, v56, v57
  v_mul_f32 v58, s52, v58
  v_mul_f32 v59, s52, v59
  v_mfma_f32_32x32x16_bf16 v[80:95], v[28:31], v[228:231], v[80:95]
  v_cvt_pk_bf16_f32 v57, v58, v59
  v_mul_f32 v60, s52, v60
  ds_read_b128 v[28:31], v15 offset:16640
  s_waitcnt lgkmcnt(3)
  v_mfma_f32_32x32x16_bf16 v[64:79], v[16:19], v[168:171], v[64:79]
  v_mul_f32 v61, s52, v61
  v_cvt_pk_bf16_f32 v58, v60, v61
  v_mul_f32 v62, s52, v62
  v_mfma_f32_32x32x16_bf16 v[80:95], v[16:19], v[232:235], v[80:95]
  v_mul_f32 v63, s52, v63
  v_cvt_pk_bf16_f32 v59, v62, v63
  ds_read_b128 v[16:19], v8 offset:32768
  s_waitcnt lgkmcnt(3)
  v_mfma_f32_32x32x16_bf16 v[64:79], v[20:23], v[172:175], v[64:79]
  v_permlane16_swap_b32 v48, v56
  v_permlane16_swap_b32 v49, v57
  v_permlane16_swap_b32 v50, v58
  v_mfma_f32_32x32x16_bf16 v[80:95], v[20:23], v[236:239], v[80:95]
  v_permlane16_swap_b32 v51, v59
  v_accvgpr_write_b32 a128, v48
  ds_read_b128 v[20:23], v9 offset:32768
  s_waitcnt lgkmcnt(3)
  v_mfma_f32_32x32x16_bf16 v[64:79], v[24:27], v[176:179], v[64:79]
  v_accvgpr_write_b32 a129, v49
  v_accvgpr_write_b32 a130, v50
  v_accvgpr_write_b32 a131, v51
  v_mfma_f32_32x32x16_bf16 v[80:95], v[24:27], v[240:243], v[80:95]
  v_accvgpr_write_b32 a184, v56
  v_accvgpr_write_b32 a185, v57
  ds_read_b128 v[24:27], v10 offset:32768
  s_waitcnt lgkmcnt(3)
  v_mfma_f32_32x32x16_bf16 v[64:79], v[28:31], v[180:183], v[64:79]
  v_accvgpr_write_b32 a186, v58
  v_accvgpr_write_b32 a187, v59
  v_mfma_f32_32x32x16_bf16 v[80:95], v[28:31], v[244:247], v[80:95]
  ds_read_b128 v[28:31], v11 offset:32768
  s_waitcnt lgkmcnt(3)
  v_mfma_f32_32x32x16_bf16 v[32:47], v[16:19], v[120:123], 0
  v_mfma_f32_32x32x16_bf16 v[48:63], v[16:19], v[184:187], 0
  ds_read_b128 v[16:19], v12 offset:32768
  s_waitcnt lgkmcnt(3)
  v_mfma_f32_32x32x16_bf16 v[32:47], v[20:23], v[124:127], v[32:47]
  v_mul_f32 v64, s52, v64
  v_mul_f32 v65, s52, v65
  v_cvt_pk_bf16_f32 v64, v64, v65
  v_mfma_f32_32x32x16_bf16 v[48:63], v[20:23], v[188:191], v[48:63]
  v_mul_f32 v66, s52, v66
  v_mul_f32 v67, s52, v67
  ds_read_b128 v[20:23], v13 offset:32768
  s_waitcnt lgkmcnt(3)
  v_mfma_f32_32x32x16_bf16 v[32:47], v[24:27], v[128:131], v[32:47]
  v_cvt_pk_bf16_f32 v65, v66, v67
  v_mul_f32 v68, s52, v68
  v_mul_f32 v69, s52, v69
  v_mfma_f32_32x32x16_bf16 v[48:63], v[24:27], v[192:195], v[48:63]
  v_cvt_pk_bf16_f32 v66, v68, v69
  v_mul_f32 v70, s52, v70
  ds_read_b128 v[24:27], v14 offset:32768
  s_waitcnt lgkmcnt(3)
  v_mfma_f32_32x32x16_bf16 v[32:47], v[28:31], v[132:135], v[32:47]
  v_mul_f32 v71, s52, v71
  v_cvt_pk_bf16_f32 v67, v70, v71
  v_mul_f32 v72, s52, v72
  v_mfma_f32_32x32x16_bf16 v[48:63], v[28:31], v[196:199], v[48:63]
  v_mul_f32 v73, s52, v73
  v_cvt_pk_bf16_f32 v72, v72, v73
  ds_read_b128 v[28:31], v15 offset:32768
  s_waitcnt lgkmcnt(3)
  v_mfma_f32_32x32x16_bf16 v[32:47], v[16:19], v[136:139], v[32:47]
  v_mul_f32 v74, s52, v74
  v_mul_f32 v75, s52, v75
  v_cvt_pk_bf16_f32 v73, v74, v75
  v_mfma_f32_32x32x16_bf16 v[48:63], v[16:19], v[200:203], v[48:63]
  v_mul_f32 v76, s52, v76
  v_mul_f32 v77, s52, v77
  ds_read_b128 v[16:19], v8 offset:33024
  s_waitcnt lgkmcnt(3)
  v_mfma_f32_32x32x16_bf16 v[32:47], v[20:23], v[140:143], v[32:47]
  v_cvt_pk_bf16_f32 v74, v76, v77
  v_mul_f32 v78, s52, v78
  v_mul_f32 v79, s52, v79
  v_mfma_f32_32x32x16_bf16 v[48:63], v[20:23], v[204:207], v[48:63]
  v_cvt_pk_bf16_f32 v75, v78, v79
  v_permlane16_swap_b32 v64, v72
  ds_read_b128 v[20:23], v9 offset:33024
  s_waitcnt lgkmcnt(3)
  v_mfma_f32_32x32x16_bf16 v[32:47], v[24:27], v[144:147], v[32:47]
  v_permlane16_swap_b32 v65, v73
  v_permlane16_swap_b32 v66, v74
  v_permlane16_swap_b32 v67, v75
  v_mfma_f32_32x32x16_bf16 v[48:63], v[24:27], v[208:211], v[48:63]
  v_accvgpr_write_b32 a20, v64
  v_accvgpr_write_b32 a21, v65
  ds_read_b128 v[24:27], v10 offset:33024
  s_waitcnt lgkmcnt(3)
  v_mfma_f32_32x32x16_bf16 v[32:47], v[28:31], v[148:151], v[32:47]
  v_accvgpr_write_b32 a22, v66
  v_accvgpr_write_b32 a23, v67
  v_accvgpr_write_b32 a76, v72
  v_mfma_f32_32x32x16_bf16 v[48:63], v[28:31], v[212:215], v[48:63]
  v_accvgpr_write_b32 a77, v73
  v_accvgpr_write_b32 a78, v74
  ds_read_b128 v[28:31], v11 offset:33024
  s_waitcnt lgkmcnt(3)
  v_mfma_f32_32x32x16_bf16 v[32:47], v[16:19], v[152:155], v[32:47]
  v_accvgpr_write_b32 a79, v75
  v_mul_f32 v80, s52, v80
  v_mul_f32 v81, s52, v81
  v_mfma_f32_32x32x16_bf16 v[48:63], v[16:19], v[216:219], v[48:63]
  v_cvt_pk_bf16_f32 v80, v80, v81
  v_mul_f32 v82, s52, v82
  ds_read_b128 v[16:19], v12 offset:33024
  s_waitcnt lgkmcnt(3)
  v_mfma_f32_32x32x16_bf16 v[32:47], v[20:23], v[156:159], v[32:47]
  v_mul_f32 v83, s52, v83
  v_cvt_pk_bf16_f32 v81, v82, v83
  v_mul_f32 v84, s52, v84
  v_mfma_f32_32x32x16_bf16 v[48:63], v[20:23], v[220:223], v[48:63]
  v_mul_f32 v85, s52, v85
  v_cvt_pk_bf16_f32 v82, v84, v85
  ds_read_b128 v[20:23], v13 offset:33024
  s_waitcnt lgkmcnt(3)
  v_mfma_f32_32x32x16_bf16 v[32:47], v[24:27], v[160:163], v[32:47]
  v_mul_f32 v86, s52, v86
  v_mul_f32 v87, s52, v87
  v_cvt_pk_bf16_f32 v83, v86, v87
  v_mfma_f32_32x32x16_bf16 v[48:63], v[24:27], v[224:227], v[48:63]
  v_mul_f32 v88, s52, v88
  v_mul_f32 v89, s52, v89
  ds_read_b128 v[24:27], v14 offset:33024
  s_waitcnt lgkmcnt(3)
  v_mfma_f32_32x32x16_bf16 v[32:47], v[28:31], v[164:167], v[32:47]
  v_cvt_pk_bf16_f32 v88, v88, v89
  v_mul_f32 v90, s52, v90
  v_mul_f32 v91, s52, v91
  v_mfma_f32_32x32x16_bf16 v[48:63], v[28:31], v[228:231], v[48:63]
  v_cvt_pk_bf16_f32 v89, v90, v91
  v_mul_f32 v92, s52, v92
  ds_read_b128 v[28:31], v15 offset:33024
  s_waitcnt lgkmcnt(3)
  v_mfma_f32_32x32x16_bf16 v[32:47], v[16:19], v[168:171], v[32:47]
  v_mul_f32 v93, s52, v93
  v_cvt_pk_bf16_f32 v90, v92, v93
  v_mul_f32 v94, s52, v94
  v_mfma_f32_32x32x16_bf16 v[48:63], v[16:19], v[232:235], v[48:63]
  v_mul_f32 v95, s52, v95
  v_cvt_pk_bf16_f32 v91, v94, v95
  ds_read_b128 v[16:19], v8 offset:49152
  s_waitcnt lgkmcnt(3)
  v_mfma_f32_32x32x16_bf16 v[32:47], v[20:23], v[172:175], v[32:47]
  v_permlane16_swap_b32 v80, v88
  v_permlane16_swap_b32 v81, v89
  v_permlane16_swap_b32 v82, v90
  v_mfma_f32_32x32x16_bf16 v[48:63], v[20:23], v[236:239], v[48:63]
  v_permlane16_swap_b32 v83, v91
  v_accvgpr_write_b32 a132, v80
  ds_read_b128 v[20:23], v9 offset:49152
  s_waitcnt lgkmcnt(3)
  v_mfma_f32_32x32x16_bf16 v[32:47], v[24:27], v[176:179], v[32:47]
  v_accvgpr_write_b32 a133, v81
  v_accvgpr_write_b32 a134, v82
  v_accvgpr_write_b32 a135, v83
  v_mfma_f32_32x32x16_bf16 v[48:63], v[24:27], v[240:243], v[48:63]
  v_accvgpr_write_b32 a188, v88
  v_accvgpr_write_b32 a189, v89
  ds_read_b128 v[24:27], v10 offset:49152
  s_waitcnt lgkmcnt(3)
  v_mfma_f32_32x32x16_bf16 v[32:47], v[28:31], v[180:183], v[32:47]
  v_accvgpr_write_b32 a190, v90
  v_accvgpr_write_b32 a191, v91
  v_mfma_f32_32x32x16_bf16 v[48:63], v[28:31], v[244:247], v[48:63]
  s_waitcnt vmcnt(16)
  s_barrier
  ds_read_b128 v[28:31], v11 offset:49152
  s_waitcnt lgkmcnt(3)
  v_mfma_f32_32x32x16_bf16 v[64:79], v[16:19], v[120:123], 0
  v_mfma_f32_32x32x16_bf16 v[80:95], v[16:19], v[184:187], 0
  ds_read_b128 v[16:19], v12 offset:49152
  s_waitcnt lgkmcnt(3)
  v_mfma_f32_32x32x16_bf16 v[64:79], v[20:23], v[124:127], v[64:79]
  v_mul_f32 v32, s52, v32
  v_mul_f32 v33, s52, v33
  v_cvt_pk_bf16_f32 v32, v32, v33
  v_mfma_f32_32x32x16_bf16 v[80:95], v[20:23], v[188:191], v[80:95]
  v_mul_f32 v34, s52, v34
  v_mul_f32 v35, s52, v35
  ds_read_b128 v[20:23], v13 offset:49152
  s_waitcnt lgkmcnt(3)
  v_mfma_f32_32x32x16_bf16 v[64:79], v[24:27], v[128:131], v[64:79]
  v_cvt_pk_bf16_f32 v33, v34, v35
  v_mul_f32 v36, s52, v36
  v_mul_f32 v37, s52, v37
  v_mfma_f32_32x32x16_bf16 v[80:95], v[24:27], v[192:195], v[80:95]
  v_cvt_pk_bf16_f32 v34, v36, v37
  v_mul_f32 v38, s52, v38
  ds_read_b128 v[24:27], v14 offset:49152
  s_waitcnt lgkmcnt(3)
  v_mfma_f32_32x32x16_bf16 v[64:79], v[28:31], v[132:135], v[64:79]
  v_mul_f32 v39, s52, v39
  v_cvt_pk_bf16_f32 v35, v38, v39
  v_mul_f32 v40, s52, v40
  v_mfma_f32_32x32x16_bf16 v[80:95], v[28:31], v[196:199], v[80:95]
  v_mul_f32 v41, s52, v41
  v_cvt_pk_bf16_f32 v40, v40, v41
  ds_read_b128 v[28:31], v15 offset:49152
  s_waitcnt lgkmcnt(3)
  v_mfma_f32_32x32x16_bf16 v[64:79], v[16:19], v[136:139], v[64:79]
  v_mul_f32 v42, s52, v42
  v_mul_f32 v43, s52, v43
  v_cvt_pk_bf16_f32 v41, v42, v43
  v_mfma_f32_32x32x16_bf16 v[80:95], v[16:19], v[200:203], v[80:95]
  v_mul_f32 v44, s52, v44
  v_mul_f32 v45, s52, v45
  ds_read_b128 v[16:19], v8 offset:49408
  s_waitcnt lgkmcnt(3)
  v_mfma_f32_32x32x16_bf16 v[64:79], v[20:23], v[140:143], v[64:79]
  v_cvt_pk_bf16_f32 v42, v44, v45
  v_mul_f32 v46, s52, v46
  v_mul_f32 v47, s52, v47
  v_mfma_f32_32x32x16_bf16 v[80:95], v[20:23], v[204:207], v[80:95]
  v_cvt_pk_bf16_f32 v43, v46, v47
  v_permlane16_swap_b32 v32, v40
  ds_read_b128 v[20:23], v9 offset:49408
  s_waitcnt lgkmcnt(3)
  v_mfma_f32_32x32x16_bf16 v[64:79], v[24:27], v[144:147], v[64:79]
  v_permlane16_swap_b32 v33, v41
  v_permlane16_swap_b32 v34, v42
  v_permlane16_swap_b32 v35, v43
  v_mfma_f32_32x32x16_bf16 v[80:95], v[24:27], v[208:211], v[80:95]
  v_accvgpr_write_b32 a24, v32
  v_accvgpr_write_b32 a25, v33
  ds_read_b128 v[24:27], v10 offset:49408
  s_waitcnt lgkmcnt(3)
  v_mfma_f32_32x32x16_bf16 v[64:79], v[28:31], v[148:151], v[64:79]
  v_accvgpr_write_b32 a26, v34
  v_accvgpr_write_b32 a27, v35
  v_accvgpr_write_b32 a80, v40
  v_mfma_f32_32x32x16_bf16 v[80:95], v[28:31], v[212:215], v[80:95]
  v_accvgpr_write_b32 a81, v41
  v_accvgpr_write_b32 a82, v42
  ds_read_b128 v[28:31], v11 offset:49408
  s_waitcnt lgkmcnt(3)
  v_mfma_f32_32x32x16_bf16 v[64:79], v[16:19], v[152:155], v[64:79]
  v_accvgpr_write_b32 a83, v43
  v_mul_f32 v48, s52, v48
  v_mul_f32 v49, s52, v49
  v_mfma_f32_32x32x16_bf16 v[80:95], v[16:19], v[216:219], v[80:95]
  v_cvt_pk_bf16_f32 v48, v48, v49
  v_mul_f32 v50, s52, v50
  ds_read_b128 v[16:19], v12 offset:49408
  s_waitcnt lgkmcnt(3)
  v_mfma_f32_32x32x16_bf16 v[64:79], v[20:23], v[156:159], v[64:79]
  v_mul_f32 v51, s52, v51
  v_cvt_pk_bf16_f32 v49, v50, v51
  v_mul_f32 v52, s52, v52
  v_mfma_f32_32x32x16_bf16 v[80:95], v[20:23], v[220:223], v[80:95]
  v_mul_f32 v53, s52, v53
  v_cvt_pk_bf16_f32 v50, v52, v53
  ds_read_b128 v[20:23], v13 offset:49408
  s_waitcnt lgkmcnt(3)
  v_mfma_f32_32x32x16_bf16 v[64:79], v[24:27], v[160:163], v[64:79]
  v_mul_f32 v54, s52, v54
  v_mul_f32 v55, s52, v55
  v_cvt_pk_bf16_f32 v51, v54, v55
  v_mfma_f32_32x32x16_bf16 v[80:95], v[24:27], v[224:227], v[80:95]
  v_mul_f32 v56, s52, v56
  v_mul_f32 v57, s52, v57
  ds_read_b128 v[24:27], v14 offset:49408
  s_waitcnt lgkmcnt(3)
  v_mfma_f32_32x32x16_bf16 v[64:79], v[28:31], v[164:167], v[64:79]
  v_cvt_pk_bf16_f32 v56, v56, v57
  v_mul_f32 v58, s52, v58
  v_mul_f32 v59, s52, v59
  v_mfma_f32_32x32x16_bf16 v[80:95], v[28:31], v[228:231], v[80:95]
  v_cvt_pk_bf16_f32 v57, v58, v59
  v_mul_f32 v60, s52, v60
  ds_read_b128 v[28:31], v15 offset:49408
  s_waitcnt lgkmcnt(3)
  v_mfma_f32_32x32x16_bf16 v[64:79], v[16:19], v[168:171], v[64:79]
  v_mul_f32 v61, s52, v61
  v_cvt_pk_bf16_f32 v58, v60, v61
  v_mul_f32 v62, s52, v62
  v_mfma_f32_32x32x16_bf16 v[80:95], v[16:19], v[232:235], v[80:95]
  v_mul_f32 v63, s52, v63
  v_cvt_pk_bf16_f32 v59, v62, v63
  v_xor_b32 v8, 196608, v8
  ds_read_b128 v[16:19], v8 offset:0
  s_waitcnt lgkmcnt(3)
  v_mfma_f32_32x32x16_bf16 v[64:79], v[20:23], v[172:175], v[64:79]
  v_permlane16_swap_b32 v48, v56
  v_permlane16_swap_b32 v49, v57
  v_permlane16_swap_b32 v50, v58
  v_mfma_f32_32x32x16_bf16 v[80:95], v[20:23], v[236:239], v[80:95]
  v_permlane16_swap_b32 v51, v59
  v_accvgpr_write_b32 a136, v48
  v_xor_b32 v9, 196608, v9
  ds_read_b128 v[20:23], v9 offset:0
  s_waitcnt lgkmcnt(3)
  v_mfma_f32_32x32x16_bf16 v[64:79], v[24:27], v[176:179], v[64:79]
  v_accvgpr_write_b32 a137, v49
  v_accvgpr_write_b32 a138, v50
  v_accvgpr_write_b32 a139, v51
  v_mfma_f32_32x32x16_bf16 v[80:95], v[24:27], v[240:243], v[80:95]
  v_accvgpr_write_b32 a192, v56
  v_accvgpr_write_b32 a193, v57
  v_xor_b32 v10, 196608, v10
  ds_read_b128 v[24:27], v10 offset:0
  s_waitcnt lgkmcnt(3)
  v_mfma_f32_32x32x16_bf16 v[64:79], v[28:31], v[180:183], v[64:79]
  v_accvgpr_write_b32 a194, v58
  v_accvgpr_write_b32 a195, v59
  v_mfma_f32_32x32x16_bf16 v[80:95], v[28:31], v[244:247], v[80:95]
  v_xor_b32 v11, 196608, v11
  ds_read_b128 v[28:31], v11 offset:0
  s_waitcnt lgkmcnt(3)
  v_mfma_f32_32x32x16_bf16 v[32:47], v[16:19], v[120:123], 0
  v_mfma_f32_32x32x16_bf16 v[48:63], v[16:19], v[184:187], 0
  v_xor_b32 v12, 196608, v12
  ds_read_b128 v[16:19], v12 offset:0
  s_waitcnt lgkmcnt(3)
  v_mfma_f32_32x32x16_bf16 v[32:47], v[20:23], v[124:127], v[32:47]
  v_mul_f32 v64, s52, v64
  v_mul_f32 v65, s52, v65
  v_cvt_pk_bf16_f32 v64, v64, v65
  v_mfma_f32_32x32x16_bf16 v[48:63], v[20:23], v[188:191], v[48:63]
  v_mul_f32 v66, s52, v66
  v_mul_f32 v67, s52, v67
  v_xor_b32 v13, 196608, v13
  ds_read_b128 v[20:23], v13 offset:0
  s_waitcnt lgkmcnt(3)
  v_mfma_f32_32x32x16_bf16 v[32:47], v[24:27], v[128:131], v[32:47]
  v_cvt_pk_bf16_f32 v65, v66, v67
  v_mul_f32 v68, s52, v68
  v_mul_f32 v69, s52, v69
  v_mfma_f32_32x32x16_bf16 v[48:63], v[24:27], v[192:195], v[48:63]
  v_cvt_pk_bf16_f32 v66, v68, v69
  v_mul_f32 v70, s52, v70
  v_xor_b32 v14, 196608, v14
  ds_read_b128 v[24:27], v14 offset:0
  s_waitcnt lgkmcnt(3)
  v_mfma_f32_32x32x16_bf16 v[32:47], v[28:31], v[132:135], v[32:47]
  v_mul_f32 v71, s52, v71
  v_cvt_pk_bf16_f32 v67, v70, v71
  v_mul_f32 v72, s52, v72
  v_mfma_f32_32x32x16_bf16 v[48:63], v[28:31], v[196:199], v[48:63]
  v_mul_f32 v73, s52, v73
  v_cvt_pk_bf16_f32 v72, v72, v73
  v_xor_b32 v15, 196608, v15
  ds_read_b128 v[28:31], v15 offset:0
  s_waitcnt lgkmcnt(3)
  v_mfma_f32_32x32x16_bf16 v[32:47], v[16:19], v[136:139], v[32:47]
  v_mul_f32 v74, s52, v74
  v_mul_f32 v75, s52, v75
  v_cvt_pk_bf16_f32 v73, v74, v75
  v_mfma_f32_32x32x16_bf16 v[48:63], v[16:19], v[200:203], v[48:63]
  v_mul_f32 v76, s52, v76
  v_mul_f32 v77, s52, v77
  ds_read_b128 v[16:19], v8 offset:256
  s_waitcnt lgkmcnt(3)
  v_mfma_f32_32x32x16_bf16 v[32:47], v[20:23], v[140:143], v[32:47]
  v_cvt_pk_bf16_f32 v74, v76, v77
  v_mul_f32 v78, s52, v78
  v_mul_f32 v79, s52, v79
  v_mfma_f32_32x32x16_bf16 v[48:63], v[20:23], v[204:207], v[48:63]
  v_cvt_pk_bf16_f32 v75, v78, v79
  v_permlane16_swap_b32 v64, v72
  ds_read_b128 v[20:23], v9 offset:256
  s_waitcnt lgkmcnt(3)
  v_mfma_f32_32x32x16_bf16 v[32:47], v[24:27], v[144:147], v[32:47]
  v_permlane16_swap_b32 v65, v73
  v_permlane16_swap_b32 v66, v74
  v_permlane16_swap_b32 v67, v75
  v_mfma_f32_32x32x16_bf16 v[48:63], v[24:27], v[208:211], v[48:63]
  v_accvgpr_write_b32 a28, v64
  v_accvgpr_write_b32 a29, v65
  ds_read_b128 v[24:27], v10 offset:256
  s_waitcnt lgkmcnt(3)
  v_mfma_f32_32x32x16_bf16 v[32:47], v[28:31], v[148:151], v[32:47]
  v_accvgpr_write_b32 a30, v66
  v_accvgpr_write_b32 a31, v67
  v_accvgpr_write_b32 a84, v72
  v_mfma_f32_32x32x16_bf16 v[48:63], v[28:31], v[212:215], v[48:63]
  v_accvgpr_write_b32 a85, v73
  v_accvgpr_write_b32 a86, v74
  ds_read_b128 v[28:31], v11 offset:256
  s_waitcnt lgkmcnt(3)
  v_mfma_f32_32x32x16_bf16 v[32:47], v[16:19], v[152:155], v[32:47]
  v_accvgpr_write_b32 a87, v75
  v_mul_f32 v80, s52, v80
  v_mul_f32 v81, s52, v81
  v_mfma_f32_32x32x16_bf16 v[48:63], v[16:19], v[216:219], v[48:63]
  v_cvt_pk_bf16_f32 v80, v80, v81
  v_mul_f32 v82, s52, v82
  ds_read_b128 v[16:19], v12 offset:256
  s_waitcnt lgkmcnt(3)
  v_mfma_f32_32x32x16_bf16 v[32:47], v[20:23], v[156:159], v[32:47]
  v_mul_f32 v83, s52, v83
  v_cvt_pk_bf16_f32 v81, v82, v83
  v_mul_f32 v84, s52, v84
  v_mfma_f32_32x32x16_bf16 v[48:63], v[20:23], v[220:223], v[48:63]
  v_mul_f32 v85, s52, v85
  v_cvt_pk_bf16_f32 v82, v84, v85
  ds_read_b128 v[20:23], v13 offset:256
  s_waitcnt lgkmcnt(3)
  v_mfma_f32_32x32x16_bf16 v[32:47], v[24:27], v[160:163], v[32:47]
  v_mul_f32 v86, s52, v86
  v_mul_f32 v87, s52, v87
  v_cvt_pk_bf16_f32 v83, v86, v87
  v_mfma_f32_32x32x16_bf16 v[48:63], v[24:27], v[224:227], v[48:63]
  v_mul_f32 v88, s52, v88
  v_mul_f32 v89, s52, v89
  ds_read_b128 v[24:27], v14 offset:256
  s_waitcnt lgkmcnt(3)
  v_mfma_f32_32x32x16_bf16 v[32:47], v[28:31], v[164:167], v[32:47]
  v_cvt_pk_bf16_f32 v88, v88, v89
  v_mul_f32 v90, s52, v90
  v_mul_f32 v91, s52, v91
  v_mfma_f32_32x32x16_bf16 v[48:63], v[28:31], v[228:231], v[48:63]
  v_cvt_pk_bf16_f32 v89, v90, v91
  v_mul_f32 v92, s52, v92
  ds_read_b128 v[28:31], v15 offset:256
  s_waitcnt lgkmcnt(3)
  v_mfma_f32_32x32x16_bf16 v[32:47], v[16:19], v[168:171], v[32:47]
  v_mul_f32 v93, s52, v93
  v_cvt_pk_bf16_f32 v90, v92, v93
  v_mul_f32 v94, s52, v94
  v_mfma_f32_32x32x16_bf16 v[48:63], v[16:19], v[232:235], v[48:63]
  v_mul_f32 v95, s52, v95
  v_cvt_pk_bf16_f32 v91, v94, v95
  v_xor_b32 v8, 131072, v8
  ds_read_b128 v[16:19], v8 offset:0
  s_waitcnt lgkmcnt(3)
  v_mfma_f32_32x32x16_bf16 v[32:47], v[20:23], v[172:175], v[32:47]
  v_permlane16_swap_b32 v80, v88
  v_permlane16_swap_b32 v81, v89
  v_permlane16_swap_b32 v82, v90
  v_mfma_f32_32x32x16_bf16 v[48:63], v[20:23], v[236:239], v[48:63]
  v_permlane16_swap_b32 v83, v91
  v_accvgpr_write_b32 a140, v80
  v_xor_b32 v9, 131072, v9
  ds_read_b128 v[20:23], v9 offset:0
  s_waitcnt lgkmcnt(3)
  v_mfma_f32_32x32x16_bf16 v[32:47], v[24:27], v[176:179], v[32:47]
  v_accvgpr_write_b32 a141, v81
  v_accvgpr_write_b32 a142, v82
  v_accvgpr_write_b32 a143, v83
  v_mfma_f32_32x32x16_bf16 v[48:63], v[24:27], v[240:243], v[48:63]
  v_accvgpr_write_b32 a196, v88
  v_accvgpr_write_b32 a197, v89
  v_xor_b32 v10, 131072, v10
  ds_read_b128 v[24:27], v10 offset:0
  s_waitcnt lgkmcnt(3)
  v_mfma_f32_32x32x16_bf16 v[32:47], v[28:31], v[180:183], v[32:47]
  v_accvgpr_write_b32 a198, v90
  v_accvgpr_write_b32 a199, v91
  v_mfma_f32_32x32x16_bf16 v[48:63], v[28:31], v[244:247], v[48:63]
  s_waitcnt vmcnt(8)
  s_barrier
  v_xor_b32 v11, 131072, v11
  ds_read_b128 v[28:31], v11 offset:0
  s_waitcnt lgkmcnt(3)
  v_mfma_f32_32x32x16_bf16 v[64:79], v[16:19], v[120:123], 0
  v_mfma_f32_32x32x16_bf16 v[80:95], v[16:19], v[184:187], 0
  v_xor_b32 v12, 131072, v12
  ds_read_b128 v[16:19], v12 offset:0
  s_waitcnt lgkmcnt(3)
  v_mfma_f32_32x32x16_bf16 v[64:79], v[20:23], v[124:127], v[64:79]
  v_mul_f32 v32, s52, v32
  v_mul_f32 v33, s52, v33
  v_cvt_pk_bf16_f32 v32, v32, v33
  v_mfma_f32_32x32x16_bf16 v[80:95], v[20:23], v[188:191], v[80:95]
  v_mul_f32 v34, s52, v34
  v_mul_f32 v35, s52, v35
  v_xor_b32 v13, 131072, v13
  ds_read_b128 v[20:23], v13 offset:0
  s_waitcnt lgkmcnt(3)
  v_mfma_f32_32x32x16_bf16 v[64:79], v[24:27], v[128:131], v[64:79]
  v_cvt_pk_bf16_f32 v33, v34, v35
  v_mul_f32 v36, s52, v36
  v_mul_f32 v37, s52, v37
  v_mfma_f32_32x32x16_bf16 v[80:95], v[24:27], v[192:195], v[80:95]
  v_cvt_pk_bf16_f32 v34, v36, v37
  v_mul_f32 v38, s52, v38
  v_xor_b32 v14, 131072, v14
  ds_read_b128 v[24:27], v14 offset:0
  s_waitcnt lgkmcnt(3)
  v_mfma_f32_32x32x16_bf16 v[64:79], v[28:31], v[132:135], v[64:79]
  v_mul_f32 v39, s52, v39
  v_cvt_pk_bf16_f32 v35, v38, v39
  v_mul_f32 v40, s52, v40
  v_mfma_f32_32x32x16_bf16 v[80:95], v[28:31], v[196:199], v[80:95]
  v_mul_f32 v41, s52, v41
  v_cvt_pk_bf16_f32 v40, v40, v41
  v_xor_b32 v15, 131072, v15
  ds_read_b128 v[28:31], v15 offset:0
  s_waitcnt lgkmcnt(3)
  v_mfma_f32_32x32x16_bf16 v[64:79], v[16:19], v[136:139], v[64:79]
  v_mul_f32 v42, s52, v42
  v_mul_f32 v43, s52, v43
  v_cvt_pk_bf16_f32 v41, v42, v43
  v_mfma_f32_32x32x16_bf16 v[80:95], v[16:19], v[200:203], v[80:95]
  v_mul_f32 v44, s52, v44
  v_mul_f32 v45, s52, v45
  ds_read_b128 v[16:19], v8 offset:256
  s_waitcnt lgkmcnt(3)
  v_mfma_f32_32x32x16_bf16 v[64:79], v[20:23], v[140:143], v[64:79]
  v_cvt_pk_bf16_f32 v42, v44, v45
  v_mul_f32 v46, s52, v46
  v_mul_f32 v47, s52, v47
  v_mfma_f32_32x32x16_bf16 v[80:95], v[20:23], v[204:207], v[80:95]
  v_cvt_pk_bf16_f32 v43, v46, v47
  v_permlane16_swap_b32 v32, v40
  ds_read_b128 v[20:23], v9 offset:256
  s_waitcnt lgkmcnt(3)
  v_mfma_f32_32x32x16_bf16 v[64:79], v[24:27], v[144:147], v[64:79]
  v_permlane16_swap_b32 v33, v41
  v_permlane16_swap_b32 v34, v42
  v_permlane16_swap_b32 v35, v43
  v_mfma_f32_32x32x16_bf16 v[80:95], v[24:27], v[208:211], v[80:95]
  v_accvgpr_write_b32 a32, v32
  v_accvgpr_write_b32 a33, v33
  ds_read_b128 v[24:27], v10 offset:256
  s_waitcnt lgkmcnt(3)
  v_mfma_f32_32x32x16_bf16 v[64:79], v[28:31], v[148:151], v[64:79]
  v_accvgpr_write_b32 a34, v34
  v_accvgpr_write_b32 a35, v35
  v_accvgpr_write_b32 a88, v40
  v_mfma_f32_32x32x16_bf16 v[80:95], v[28:31], v[212:215], v[80:95]
  v_accvgpr_write_b32 a89, v41
  v_accvgpr_write_b32 a90, v42
  ds_read_b128 v[28:31], v11 offset:256
  s_waitcnt lgkmcnt(3)
  v_mfma_f32_32x32x16_bf16 v[64:79], v[16:19], v[152:155], v[64:79]
  v_accvgpr_write_b32 a91, v43
  v_mul_f32 v48, s52, v48
  v_mul_f32 v49, s52, v49
  v_mfma_f32_32x32x16_bf16 v[80:95], v[16:19], v[216:219], v[80:95]
  v_cvt_pk_bf16_f32 v48, v48, v49
  v_mul_f32 v50, s52, v50
  ds_read_b128 v[16:19], v12 offset:256
  s_waitcnt lgkmcnt(3)
  v_mfma_f32_32x32x16_bf16 v[64:79], v[20:23], v[156:159], v[64:79]
  v_mul_f32 v51, s52, v51
  v_cvt_pk_bf16_f32 v49, v50, v51
  v_mul_f32 v52, s52, v52
  v_mfma_f32_32x32x16_bf16 v[80:95], v[20:23], v[220:223], v[80:95]
  v_mul_f32 v53, s52, v53
  v_cvt_pk_bf16_f32 v50, v52, v53
  ds_read_b128 v[20:23], v13 offset:256
  s_waitcnt lgkmcnt(3)
  v_mfma_f32_32x32x16_bf16 v[64:79], v[24:27], v[160:163], v[64:79]
  v_mul_f32 v54, s52, v54
  v_mul_f32 v55, s52, v55
  v_cvt_pk_bf16_f32 v51, v54, v55
  v_mfma_f32_32x32x16_bf16 v[80:95], v[24:27], v[224:227], v[80:95]
  v_mul_f32 v56, s52, v56
  v_mul_f32 v57, s52, v57
  ds_read_b128 v[24:27], v14 offset:256
  s_waitcnt lgkmcnt(3)
  v_mfma_f32_32x32x16_bf16 v[64:79], v[28:31], v[164:167], v[64:79]
  v_cvt_pk_bf16_f32 v56, v56, v57
  v_mul_f32 v58, s52, v58
  v_mul_f32 v59, s52, v59
  v_mfma_f32_32x32x16_bf16 v[80:95], v[28:31], v[228:231], v[80:95]
  v_cvt_pk_bf16_f32 v57, v58, v59
  v_mul_f32 v60, s52, v60
  ds_read_b128 v[28:31], v15 offset:256
  s_waitcnt lgkmcnt(3)
  v_mfma_f32_32x32x16_bf16 v[64:79], v[16:19], v[168:171], v[64:79]
  v_mul_f32 v61, s52, v61
  v_cvt_pk_bf16_f32 v58, v60, v61
  v_mul_f32 v62, s52, v62
  v_mfma_f32_32x32x16_bf16 v[80:95], v[16:19], v[232:235], v[80:95]
  v_mul_f32 v63, s52, v63
  v_cvt_pk_bf16_f32 v59, v62, v63
  ds_read_b128 v[16:19], v8 offset:16384
  s_waitcnt lgkmcnt(3)
  v_mfma_f32_32x32x16_bf16 v[64:79], v[20:23], v[172:175], v[64:79]
  v_permlane16_swap_b32 v48, v56
  v_permlane16_swap_b32 v49, v57
  v_permlane16_swap_b32 v50, v58
  v_mfma_f32_32x32x16_bf16 v[80:95], v[20:23], v[236:239], v[80:95]
  v_permlane16_swap_b32 v51, v59
  v_accvgpr_write_b32 a144, v48
  ds_read_b128 v[20:23], v9 offset:16384
  s_waitcnt lgkmcnt(3)
  v_mfma_f32_32x32x16_bf16 v[64:79], v[24:27], v[176:179], v[64:79]
  v_accvgpr_write_b32 a145, v49
  v_accvgpr_write_b32 a146, v50
  v_accvgpr_write_b32 a147, v51
  v_mfma_f32_32x32x16_bf16 v[80:95], v[24:27], v[240:243], v[80:95]
  v_accvgpr_write_b32 a200, v56
  v_accvgpr_write_b32 a201, v57
  ds_read_b128 v[24:27], v10 offset:16384
  s_waitcnt lgkmcnt(3)
  v_mfma_f32_32x32x16_bf16 v[64:79], v[28:31], v[180:183], v[64:79]
  v_accvgpr_write_b32 a202, v58
  v_accvgpr_write_b32 a203, v59
  v_mfma_f32_32x32x16_bf16 v[80:95], v[28:31], v[244:247], v[80:95]
  ds_read_b128 v[28:31], v11 offset:16384
  s_waitcnt lgkmcnt(3)
  v_mfma_f32_32x32x16_bf16 v[32:47], v[16:19], v[120:123], 0
  v_mfma_f32_32x32x16_bf16 v[48:63], v[16:19], v[184:187], 0
  ds_read_b128 v[16:19], v12 offset:16384
  s_waitcnt lgkmcnt(3)
  v_mfma_f32_32x32x16_bf16 v[32:47], v[20:23], v[124:127], v[32:47]
  v_mul_f32 v64, s52, v64
  v_mul_f32 v65, s52, v65
  v_cvt_pk_bf16_f32 v64, v64, v65
  v_mfma_f32_32x32x16_bf16 v[48:63], v[20:23], v[188:191], v[48:63]
  v_mul_f32 v66, s52, v66
  v_mul_f32 v67, s52, v67
  ds_read_b128 v[20:23], v13 offset:16384
  s_waitcnt lgkmcnt(3)
  v_mfma_f32_32x32x16_bf16 v[32:47], v[24:27], v[128:131], v[32:47]
  v_cvt_pk_bf16_f32 v65, v66, v67
  v_mul_f32 v68, s52, v68
  v_mul_f32 v69, s52, v69
  v_mfma_f32_32x32x16_bf16 v[48:63], v[24:27], v[192:195], v[48:63]
  v_cvt_pk_bf16_f32 v66, v68, v69
  v_mul_f32 v70, s52, v70
  ds_read_b128 v[24:27], v14 offset:16384
  s_waitcnt lgkmcnt(3)
  v_mfma_f32_32x32x16_bf16 v[32:47], v[28:31], v[132:135], v[32:47]
  v_mul_f32 v71, s52, v71
  v_cvt_pk_bf16_f32 v67, v70, v71
  v_mul_f32 v72, s52, v72
  v_mfma_f32_32x32x16_bf16 v[48:63], v[28:31], v[196:199], v[48:63]
  v_mul_f32 v73, s52, v73
  v_cvt_pk_bf16_f32 v72, v72, v73
  ds_read_b128 v[28:31], v15 offset:16384
  s_waitcnt lgkmcnt(3)
  v_mfma_f32_32x32x16_bf16 v[32:47], v[16:19], v[136:139], v[32:47]
  v_mul_f32 v74, s52, v74
  v_mul_f32 v75, s52, v75
  v_cvt_pk_bf16_f32 v73, v74, v75
  v_mfma_f32_32x32x16_bf16 v[48:63], v[16:19], v[200:203], v[48:63]
  v_mul_f32 v76, s52, v76
  v_mul_f32 v77, s52, v77
  ds_read_b128 v[16:19], v8 offset:16640
  s_waitcnt lgkmcnt(3)
  v_mfma_f32_32x32x16_bf16 v[32:47], v[20:23], v[140:143], v[32:47]
  v_cvt_pk_bf16_f32 v74, v76, v77
  v_mul_f32 v78, s52, v78
  v_mul_f32 v79, s52, v79
  v_mfma_f32_32x32x16_bf16 v[48:63], v[20:23], v[204:207], v[48:63]
  v_cvt_pk_bf16_f32 v75, v78, v79
  v_permlane16_swap_b32 v64, v72
  ds_read_b128 v[20:23], v9 offset:16640
  s_waitcnt lgkmcnt(3)
  v_mfma_f32_32x32x16_bf16 v[32:47], v[24:27], v[144:147], v[32:47]
  v_permlane16_swap_b32 v65, v73
  v_permlane16_swap_b32 v66, v74
  v_permlane16_swap_b32 v67, v75
  v_mfma_f32_32x32x16_bf16 v[48:63], v[24:27], v[208:211], v[48:63]
  v_accvgpr_write_b32 a36, v64
  v_accvgpr_write_b32 a37, v65
  ds_read_b128 v[24:27], v10 offset:16640
  s_waitcnt lgkmcnt(3)
  v_mfma_f32_32x32x16_bf16 v[32:47], v[28:31], v[148:151], v[32:47]
  v_accvgpr_write_b32 a38, v66
  v_accvgpr_write_b32 a39, v67
  v_accvgpr_write_b32 a92, v72
  v_mfma_f32_32x32x16_bf16 v[48:63], v[28:31], v[212:215], v[48:63]
  v_accvgpr_write_b32 a93, v73
  v_accvgpr_write_b32 a94, v74
  ds_read_b128 v[28:31], v11 offset:16640
  s_waitcnt lgkmcnt(3)
  v_mfma_f32_32x32x16_bf16 v[32:47], v[16:19], v[152:155], v[32:47]
  v_accvgpr_write_b32 a95, v75
  v_mul_f32 v80, s52, v80
  v_mul_f32 v81, s52, v81
  v_mfma_f32_32x32x16_bf16 v[48:63], v[16:19], v[216:219], v[48:63]
  v_cvt_pk_bf16_f32 v80, v80, v81
  v_mul_f32 v82, s52, v82
  ds_read_b128 v[16:19], v12 offset:16640
  s_waitcnt lgkmcnt(3)
  v_mfma_f32_32x32x16_bf16 v[32:47], v[20:23], v[156:159], v[32:47]
  v_mul_f32 v83, s52, v83
  v_cvt_pk_bf16_f32 v81, v82, v83
  v_mul_f32 v84, s52, v84
  v_mfma_f32_32x32x16_bf16 v[48:63], v[20:23], v[220:223], v[48:63]
  v_mul_f32 v85, s52, v85
  v_cvt_pk_bf16_f32 v82, v84, v85
  ds_read_b128 v[20:23], v13 offset:16640
  s_waitcnt lgkmcnt(3)
  v_mfma_f32_32x32x16_bf16 v[32:47], v[24:27], v[160:163], v[32:47]
  v_mul_f32 v86, s52, v86
  v_mul_f32 v87, s52, v87
  v_cvt_pk_bf16_f32 v83, v86, v87
  v_mfma_f32_32x32x16_bf16 v[48:63], v[24:27], v[224:227], v[48:63]
  v_mul_f32 v88, s52, v88
  v_mul_f32 v89, s52, v89
  ds_read_b128 v[24:27], v14 offset:16640
  s_waitcnt lgkmcnt(3)
  v_mfma_f32_32x32x16_bf16 v[32:47], v[28:31], v[164:167], v[32:47]
  v_cvt_pk_bf16_f32 v88, v88, v89
  v_mul_f32 v90, s52, v90
  v_mul_f32 v91, s52, v91
  v_mfma_f32_32x32x16_bf16 v[48:63], v[28:31], v[228:231], v[48:63]
  v_cvt_pk_bf16_f32 v89, v90, v91
  v_mul_f32 v92, s52, v92
  ds_read_b128 v[28:31], v15 offset:16640
  s_waitcnt lgkmcnt(3)
  v_mfma_f32_32x32x16_bf16 v[32:47], v[16:19], v[168:171], v[32:47]
  v_mul_f32 v93, s52, v93
  v_cvt_pk_bf16_f32 v90, v92, v93
  v_mul_f32 v94, s52, v94
  v_mfma_f32_32x32x16_bf16 v[48:63], v[16:19], v[232:235], v[48:63]
  v_mul_f32 v95, s52, v95
  v_cvt_pk_bf16_f32 v91, v94, v95
  ds_read_b128 v[16:19], v8 offset:32768
  s_waitcnt lgkmcnt(3)
  v_mfma_f32_32x32x16_bf16 v[32:47], v[20:23], v[172:175], v[32:47]
  v_permlane16_swap_b32 v80, v88
  v_permlane16_swap_b32 v81, v89
  v_permlane16_swap_b32 v82, v90
  v_mfma_f32_32x32x16_bf16 v[48:63], v[20:23], v[236:239], v[48:63]
  v_permlane16_swap_b32 v83, v91
  v_accvgpr_write_b32 a148, v80
  ds_read_b128 v[20:23], v9 offset:32768
  s_waitcnt lgkmcnt(3)
  v_mfma_f32_32x32x16_bf16 v[32:47], v[24:27], v[176:179], v[32:47]
  v_accvgpr_write_b32 a149, v81
  v_accvgpr_write_b32 a150, v82
  v_accvgpr_write_b32 a151, v83
  v_mfma_f32_32x32x16_bf16 v[48:63], v[24:27], v[240:243], v[48:63]
  v_accvgpr_write_b32 a204, v88
  v_accvgpr_write_b32 a205, v89
  ds_read_b128 v[24:27], v10 offset:32768
  s_waitcnt lgkmcnt(3)
  v_mfma_f32_32x32x16_bf16 v[32:47], v[28:31], v[180:183], v[32:47]
  v_accvgpr_write_b32 a206, v90
  v_accvgpr_write_b32 a207, v91
  v_mfma_f32_32x32x16_bf16 v[48:63], v[28:31], v[244:247], v[48:63]
  s_waitcnt vmcnt(0)
  s_barrier
  ds_read_b128 v[28:31], v11 offset:32768
  s_waitcnt lgkmcnt(3)
  v_mfma_f32_32x32x16_bf16 v[64:79], v[16:19], v[120:123], 0
  v_mfma_f32_32x32x16_bf16 v[80:95], v[16:19], v[184:187], 0
  ds_read_b128 v[16:19], v12 offset:32768
  s_waitcnt lgkmcnt(3)
  v_mfma_f32_32x32x16_bf16 v[64:79], v[20:23], v[124:127], v[64:79]
  v_mul_f32 v32, s52, v32
  v_mul_f32 v33, s52, v33
  v_cvt_pk_bf16_f32 v32, v32, v33
  v_mfma_f32_32x32x16_bf16 v[80:95], v[20:23], v[188:191], v[80:95]
  v_mul_f32 v34, s52, v34
  v_mul_f32 v35, s52, v35
  ds_read_b128 v[20:23], v13 offset:32768
  s_waitcnt lgkmcnt(3)
  v_mfma_f32_32x32x16_bf16 v[64:79], v[24:27], v[128:131], v[64:79]
  v_cvt_pk_bf16_f32 v33, v34, v35
  v_mul_f32 v36, s52, v36
  v_mul_f32 v37, s52, v37
  v_mfma_f32_32x32x16_bf16 v[80:95], v[24:27], v[192:195], v[80:95]
  v_cvt_pk_bf16_f32 v34, v36, v37
  v_mul_f32 v38, s52, v38
  ds_read_b128 v[24:27], v14 offset:32768
  s_waitcnt lgkmcnt(3)
  v_mfma_f32_32x32x16_bf16 v[64:79], v[28:31], v[132:135], v[64:79]
  v_mul_f32 v39, s52, v39
  v_cvt_pk_bf16_f32 v35, v38, v39
  v_mul_f32 v40, s52, v40
  v_mfma_f32_32x32x16_bf16 v[80:95], v[28:31], v[196:199], v[80:95]
  v_mul_f32 v41, s52, v41
  v_cvt_pk_bf16_f32 v40, v40, v41
  ds_read_b128 v[28:31], v15 offset:32768
  s_waitcnt lgkmcnt(3)
  v_mfma_f32_32x32x16_bf16 v[64:79], v[16:19], v[136:139], v[64:79]
  v_mul_f32 v42, s52, v42
  v_mul_f32 v43, s52, v43
  v_cvt_pk_bf16_f32 v41, v42, v43
  v_mfma_f32_32x32x16_bf16 v[80:95], v[16:19], v[200:203], v[80:95]
  v_mul_f32 v44, s52, v44
  v_mul_f32 v45, s52, v45
  ds_read_b128 v[16:19], v8 offset:33024
  s_waitcnt lgkmcnt(3)
  v_mfma_f32_32x32x16_bf16 v[64:79], v[20:23], v[140:143], v[64:79]
  v_cvt_pk_bf16_f32 v42, v44, v45
  v_mul_f32 v46, s52, v46
  v_mul_f32 v47, s52, v47
  v_mfma_f32_32x32x16_bf16 v[80:95], v[20:23], v[204:207], v[80:95]
  v_cvt_pk_bf16_f32 v43, v46, v47
  v_permlane16_swap_b32 v32, v40
  ds_read_b128 v[20:23], v9 offset:33024
  s_waitcnt lgkmcnt(3)
  v_mfma_f32_32x32x16_bf16 v[64:79], v[24:27], v[144:147], v[64:79]
  v_permlane16_swap_b32 v33, v41
  v_permlane16_swap_b32 v34, v42
  v_permlane16_swap_b32 v35, v43
  v_mfma_f32_32x32x16_bf16 v[80:95], v[24:27], v[208:211], v[80:95]
  v_accvgpr_write_b32 a40, v32
  v_accvgpr_write_b32 a41, v33
  ds_read_b128 v[24:27], v10 offset:33024
  s_waitcnt lgkmcnt(3)
  v_mfma_f32_32x32x16_bf16 v[64:79], v[28:31], v[148:151], v[64:79]
  v_accvgpr_write_b32 a42, v34
  v_accvgpr_write_b32 a43, v35
  v_accvgpr_write_b32 a96, v40
  v_mfma_f32_32x32x16_bf16 v[80:95], v[28:31], v[212:215], v[80:95]
  v_accvgpr_write_b32 a97, v41
  v_accvgpr_write_b32 a98, v42
  ds_read_b128 v[28:31], v11 offset:33024
  s_waitcnt lgkmcnt(3)
  v_mfma_f32_32x32x16_bf16 v[64:79], v[16:19], v[152:155], v[64:79]
  v_accvgpr_write_b32 a99, v43
  v_mul_f32 v48, s52, v48
  v_mul_f32 v49, s52, v49
  v_mfma_f32_32x32x16_bf16 v[80:95], v[16:19], v[216:219], v[80:95]
  v_cvt_pk_bf16_f32 v48, v48, v49
  v_mul_f32 v50, s52, v50
  ds_read_b128 v[16:19], v12 offset:33024
  s_waitcnt lgkmcnt(3)
  v_mfma_f32_32x32x16_bf16 v[64:79], v[20:23], v[156:159], v[64:79]
  v_mul_f32 v51, s52, v51
  v_cvt_pk_bf16_f32 v49, v50, v51
  v_mul_f32 v52, s52, v52
  v_mfma_f32_32x32x16_bf16 v[80:95], v[20:23], v[220:223], v[80:95]
  v_mul_f32 v53, s52, v53
  v_cvt_pk_bf16_f32 v50, v52, v53
  ds_read_b128 v[20:23], v13 offset:33024
  s_waitcnt lgkmcnt(3)
  v_mfma_f32_32x32x16_bf16 v[64:79], v[24:27], v[160:163], v[64:79]
  v_mul_f32 v54, s52, v54
  v_mul_f32 v55, s52, v55
  v_cvt_pk_bf16_f32 v51, v54, v55
  v_mfma_f32_32x32x16_bf16 v[80:95], v[24:27], v[224:227], v[80:95]
  v_mul_f32 v56, s52, v56
  v_mul_f32 v57, s52, v57
  ds_read_b128 v[24:27], v14 offset:33024
  s_waitcnt lgkmcnt(3)
  v_mfma_f32_32x32x16_bf16 v[64:79], v[28:31], v[164:167], v[64:79]
  v_cvt_pk_bf16_f32 v56, v56, v57
  v_mul_f32 v58, s52, v58
  v_mul_f32 v59, s52, v59
  v_mfma_f32_32x32x16_bf16 v[80:95], v[28:31], v[228:231], v[80:95]
  v_cvt_pk_bf16_f32 v57, v58, v59
  v_mul_f32 v60, s52, v60
  ds_read_b128 v[28:31], v15 offset:33024
  s_waitcnt lgkmcnt(3)
  v_mfma_f32_32x32x16_bf16 v[64:79], v[16:19], v[168:171], v[64:79]
  v_mul_f32 v61, s52, v61
  v_cvt_pk_bf16_f32 v58, v60, v61
  v_mul_f32 v62, s52, v62
  v_mfma_f32_32x32x16_bf16 v[80:95], v[16:19], v[232:235], v[80:95]
  v_mul_f32 v63, s52, v63
  v_cvt_pk_bf16_f32 v59, v62, v63
  ds_read_b128 v[16:19], v8 offset:49152
  s_waitcnt lgkmcnt(3)
  v_mfma_f32_32x32x16_bf16 v[64:79], v[20:23], v[172:175], v[64:79]
  v_permlane16_swap_b32 v48, v56
  v_permlane16_swap_b32 v49, v57
  v_permlane16_swap_b32 v50, v58
  v_mfma_f32_32x32x16_bf16 v[80:95], v[20:23], v[236:239], v[80:95]
  v_permlane16_swap_b32 v51, v59
  v_accvgpr_write_b32 a152, v48
  ds_read_b128 v[20:23], v9 offset:49152
  s_waitcnt lgkmcnt(3)
  v_mfma_f32_32x32x16_bf16 v[64:79], v[24:27], v[176:179], v[64:79]
  v_accvgpr_write_b32 a153, v49
  v_accvgpr_write_b32 a154, v50
  v_accvgpr_write_b32 a155, v51
  v_mfma_f32_32x32x16_bf16 v[80:95], v[24:27], v[240:243], v[80:95]
  v_accvgpr_write_b32 a208, v56
  v_accvgpr_write_b32 a209, v57
  ds_read_b128 v[24:27], v10 offset:49152
  s_waitcnt lgkmcnt(3)
  v_mfma_f32_32x32x16_bf16 v[64:79], v[28:31], v[180:183], v[64:79]
  v_accvgpr_write_b32 a210, v58
  v_accvgpr_write_b32 a211, v59
  v_mfma_f32_32x32x16_bf16 v[80:95], v[28:31], v[244:247], v[80:95]
  ds_read_b128 v[28:31], v11 offset:49152
  s_waitcnt lgkmcnt(3)
  v_mfma_f32_32x32x16_bf16 v[32:47], v[16:19], v[120:123], 0
  v_mfma_f32_32x32x16_bf16 v[48:63], v[16:19], v[184:187], 0
  ds_read_b128 v[16:19], v12 offset:49152
  s_waitcnt lgkmcnt(3)
  v_mfma_f32_32x32x16_bf16 v[32:47], v[20:23], v[124:127], v[32:47]
  v_mul_f32 v64, s52, v64
  v_mul_f32 v65, s52, v65
  v_cvt_pk_bf16_f32 v64, v64, v65
  v_mfma_f32_32x32x16_bf16 v[48:63], v[20:23], v[188:191], v[48:63]
  v_mul_f32 v66, s52, v66
  v_mul_f32 v67, s52, v67
  ds_read_b128 v[20:23], v13 offset:49152
  s_waitcnt lgkmcnt(3)
  v_mfma_f32_32x32x16_bf16 v[32:47], v[24:27], v[128:131], v[32:47]
  v_cvt_pk_bf16_f32 v65, v66, v67
  v_mul_f32 v68, s52, v68
  v_mul_f32 v69, s52, v69
  v_mfma_f32_32x32x16_bf16 v[48:63], v[24:27], v[192:195], v[48:63]
  v_cvt_pk_bf16_f32 v66, v68, v69
  v_mul_f32 v70, s52, v70
  ds_read_b128 v[24:27], v14 offset:49152
  s_waitcnt lgkmcnt(3)
  v_mfma_f32_32x32x16_bf16 v[32:47], v[28:31], v[132:135], v[32:47]
  v_mul_f32 v71, s52, v71
  v_cvt_pk_bf16_f32 v67, v70, v71
  v_mul_f32 v72, s52, v72
  v_mfma_f32_32x32x16_bf16 v[48:63], v[28:31], v[196:199], v[48:63]
  v_mul_f32 v73, s52, v73
  v_cvt_pk_bf16_f32 v72, v72, v73
  ds_read_b128 v[28:31], v15 offset:49152
  s_waitcnt lgkmcnt(3)
  v_mfma_f32_32x32x16_bf16 v[32:47], v[16:19], v[136:139], v[32:47]
  v_mul_f32 v74, s52, v74
  v_mul_f32 v75, s52, v75
  v_cvt_pk_bf16_f32 v73, v74, v75
  v_mfma_f32_32x32x16_bf16 v[48:63], v[16:19], v[200:203], v[48:63]
  v_mul_f32 v76, s52, v76
  v_mul_f32 v77, s52, v77
  ds_read_b128 v[16:19], v8 offset:49408
  s_waitcnt lgkmcnt(3)
  v_mfma_f32_32x32x16_bf16 v[32:47], v[20:23], v[140:143], v[32:47]
  v_cvt_pk_bf16_f32 v74, v76, v77
  v_mul_f32 v78, s52, v78
  v_mul_f32 v79, s52, v79
  v_mfma_f32_32x32x16_bf16 v[48:63], v[20:23], v[204:207], v[48:63]
  v_cvt_pk_bf16_f32 v75, v78, v79
  v_permlane16_swap_b32 v64, v72
  ds_read_b128 v[20:23], v9 offset:49408
  s_waitcnt lgkmcnt(3)
  v_mfma_f32_32x32x16_bf16 v[32:47], v[24:27], v[144:147], v[32:47]
  v_permlane16_swap_b32 v65, v73
  v_permlane16_swap_b32 v66, v74
  v_permlane16_swap_b32 v67, v75
  v_mfma_f32_32x32x16_bf16 v[48:63], v[24:27], v[208:211], v[48:63]
  v_accvgpr_write_b32 a44, v64
  v_accvgpr_write_b32 a45, v65
  ds_read_b128 v[24:27], v10 offset:49408
  s_waitcnt lgkmcnt(3)
  v_mfma_f32_32x32x16_bf16 v[32:47], v[28:31], v[148:151], v[32:47]
  v_accvgpr_write_b32 a46, v66
  v_accvgpr_write_b32 a47, v67
  v_accvgpr_write_b32 a100, v72
  v_mfma_f32_32x32x16_bf16 v[48:63], v[28:31], v[212:215], v[48:63]
  v_accvgpr_write_b32 a101, v73
  v_accvgpr_write_b32 a102, v74
  ds_read_b128 v[28:31], v11 offset:49408
  s_waitcnt lgkmcnt(3)
  v_mfma_f32_32x32x16_bf16 v[32:47], v[16:19], v[152:155], v[32:47]
  v_accvgpr_write_b32 a103, v75
  v_mul_f32 v80, s52, v80
  v_mul_f32 v81, s52, v81
  v_mfma_f32_32x32x16_bf16 v[48:63], v[16:19], v[216:219], v[48:63]
  v_cvt_pk_bf16_f32 v80, v80, v81
  v_mul_f32 v82, s52, v82
  ds_read_b128 v[16:19], v12 offset:49408
  s_waitcnt lgkmcnt(3)
  v_mfma_f32_32x32x16_bf16 v[32:47], v[20:23], v[156:159], v[32:47]
  v_mul_f32 v83, s52, v83
  v_cvt_pk_bf16_f32 v81, v82, v83
  v_mul_f32 v84, s52, v84
  v_mfma_f32_32x32x16_bf16 v[48:63], v[20:23], v[220:223], v[48:63]
  v_mul_f32 v85, s52, v85
  v_cvt_pk_bf16_f32 v82, v84, v85
  ds_read_b128 v[20:23], v13 offset:49408
  s_waitcnt lgkmcnt(3)
  v_mfma_f32_32x32x16_bf16 v[32:47], v[24:27], v[160:163], v[32:47]
  v_mul_f32 v86, s52, v86
  v_mul_f32 v87, s52, v87
  v_cvt_pk_bf16_f32 v83, v86, v87
  v_mfma_f32_32x32x16_bf16 v[48:63], v[24:27], v[224:227], v[48:63]
  v_mul_f32 v88, s52, v88
  v_mul_f32 v89, s52, v89
  ds_read_b128 v[24:27], v14 offset:49408
  s_waitcnt lgkmcnt(3)
  v_mfma_f32_32x32x16_bf16 v[32:47], v[28:31], v[164:167], v[32:47]
  v_cvt_pk_bf16_f32 v88, v88, v89
  v_mul_f32 v90, s52, v90
  v_mul_f32 v91, s52, v91
  v_mfma_f32_32x32x16_bf16 v[48:63], v[28:31], v[228:231], v[48:63]
  v_cvt_pk_bf16_f32 v89, v90, v91
  v_mul_f32 v92, s52, v92
  ds_read_b128 v[28:31], v15 offset:49408
  s_waitcnt lgkmcnt(3)
  v_mfma_f32_32x32x16_bf16 v[32:47], v[16:19], v[168:171], v[32:47]
  v_mul_f32 v93, s52, v93
  v_cvt_pk_bf16_f32 v90, v92, v93
  v_mul_f32 v94, s52, v94
  v_mfma_f32_32x32x16_bf16 v[48:63], v[16:19], v[232:235], v[48:63]
  v_mul_f32 v95, s52, v95
  v_cvt_pk_bf16_f32 v91, v94, v95
  v_xor_b32 v8, 65536, v8
  ds_read_b128 v[16:19], v8 offset:0
  s_waitcnt lgkmcnt(3)
  v_mfma_f32_32x32x16_bf16 v[32:47], v[20:23], v[172:175], v[32:47]
  v_permlane16_swap_b32 v80, v88
  v_permlane16_swap_b32 v81, v89
  v_permlane16_swap_b32 v82, v90
  v_mfma_f32_32x32x16_bf16 v[48:63], v[20:23], v[236:239], v[48:63]
  v_permlane16_swap_b32 v83, v91
  v_accvgpr_write_b32 a156, v80
  v_xor_b32 v9, 65536, v9
  ds_read_b128 v[20:23], v9 offset:0
  s_waitcnt lgkmcnt(3)
  v_mfma_f32_32x32x16_bf16 v[32:47], v[24:27], v[176:179], v[32:47]
  v_accvgpr_write_b32 a157, v81
  v_accvgpr_write_b32 a158, v82
  v_accvgpr_write_b32 a159, v83
  v_mfma_f32_32x32x16_bf16 v[48:63], v[24:27], v[240:243], v[48:63]
  v_accvgpr_write_b32 a212, v88
  v_accvgpr_write_b32 a213, v89
  v_xor_b32 v10, 65536, v10
  ds_read_b128 v[24:27], v10 offset:0
  s_waitcnt lgkmcnt(3)
  v_mfma_f32_32x32x16_bf16 v[32:47], v[28:31], v[180:183], v[32:47]
  v_accvgpr_write_b32 a214, v90
  v_accvgpr_write_b32 a215, v91
  v_mfma_f32_32x32x16_bf16 v[48:63], v[28:31], v[244:247], v[48:63]
  v_xor_b32 v11, 65536, v11
  ds_read_b128 v[28:31], v11 offset:0
  s_waitcnt lgkmcnt(3)
  v_mfma_f32_32x32x16_bf16 v[64:79], v[16:19], v[120:123], 0
  buffer_load_dwordx4 v[100:103], v113, s[8:11], s28 offen sc1
  v_mfma_f32_32x32x16_bf16 v[80:95], v[16:19], v[184:187], 0
  v_xor_b32 v12, 65536, v12
  ds_read_b128 v[16:19], v12 offset:0
  s_waitcnt lgkmcnt(3)
  v_mfma_f32_32x32x16_bf16 v[64:79], v[20:23], v[124:127], v[64:79]
  buffer_load_dwordx4 v[104:107], v2, s[8:11], s29 offen sc1
  v_mul_f32 v32, s52, v32
  v_mul_f32 v33, s52, v33
  v_cvt_pk_bf16_f32 v32, v32, v33
  v_mfma_f32_32x32x16_bf16 v[80:95], v[20:23], v[188:191], v[80:95]
  v_mul_f32 v34, s52, v34
  v_mul_f32 v35, s52, v35
  v_xor_b32 v13, 65536, v13
  ds_read_b128 v[20:23], v13 offset:0
  s_waitcnt lgkmcnt(3)
  v_mfma_f32_32x32x16_bf16 v[64:79], v[24:27], v[128:131], v[64:79]
  buffer_load_dwordx4 v[108:111], v112, s[8:11], s29 offen sc1
  v_cvt_pk_bf16_f32 v33, v34, v35
  v_mul_f32 v36, s52, v36
  v_mul_f32 v37, s52, v37
  v_mfma_f32_32x32x16_bf16 v[80:95], v[24:27], v[192:195], v[80:95]
  v_cvt_pk_bf16_f32 v34, v36, v37
  v_mul_f32 v38, s52, v38
  v_xor_b32 v14, 65536, v14
  ds_read_b128 v[24:27], v14 offset:0
  s_waitcnt lgkmcnt(3)
  v_mfma_f32_32x32x16_bf16 v[64:79], v[28:31], v[132:135], v[64:79]
  v_mul_f32 v39, s52, v39
  v_cvt_pk_bf16_f32 v35, v38, v39
  v_mul_f32 v40, s52, v40
  v_mfma_f32_32x32x16_bf16 v[80:95], v[28:31], v[196:199], v[80:95]
  v_mul_f32 v41, s52, v41
  v_cvt_pk_bf16_f32 v40, v40, v41
  v_xor_b32 v15, 65536, v15
  ds_read_b128 v[28:31], v15 offset:0
  s_waitcnt lgkmcnt(3)
  v_mfma_f32_32x32x16_bf16 v[64:79], v[16:19], v[136:139], v[64:79]
  v_mul_f32 v42, s52, v42
  v_mul_f32 v43, s52, v43
  v_cvt_pk_bf16_f32 v41, v42, v43
  v_mfma_f32_32x32x16_bf16 v[80:95], v[16:19], v[200:203], v[80:95]
  v_mul_f32 v44, s52, v44
  v_mul_f32 v45, s52, v45
  ds_read_b128 v[16:19], v8 offset:256
  s_waitcnt lgkmcnt(3)
  v_mfma_f32_32x32x16_bf16 v[64:79], v[20:23], v[140:143], v[64:79]
  v_cvt_pk_bf16_f32 v42, v44, v45
  v_mul_f32 v46, s52, v46
  v_mul_f32 v47, s52, v47
  v_mfma_f32_32x32x16_bf16 v[80:95], v[20:23], v[204:207], v[80:95]
  v_cvt_pk_bf16_f32 v43, v46, v47
  v_permlane16_swap_b32 v32, v40
  ds_read_b128 v[20:23], v9 offset:256
  s_waitcnt lgkmcnt(3)
  v_mfma_f32_32x32x16_bf16 v[64:79], v[24:27], v[144:147], v[64:79]
  v_permlane16_swap_b32 v33, v41
  v_permlane16_swap_b32 v34, v42
  v_permlane16_swap_b32 v35, v43
  v_mfma_f32_32x32x16_bf16 v[80:95], v[24:27], v[208:211], v[80:95]
  v_accvgpr_write_b32 a48, v32
  v_accvgpr_write_b32 a49, v33
  ds_read_b128 v[24:27], v10 offset:256
  s_waitcnt lgkmcnt(3)
  v_mfma_f32_32x32x16_bf16 v[64:79], v[28:31], v[148:151], v[64:79]
  v_accvgpr_write_b32 a50, v34
  v_accvgpr_write_b32 a51, v35
  v_accvgpr_write_b32 a104, v40
  v_mfma_f32_32x32x16_bf16 v[80:95], v[28:31], v[212:215], v[80:95]
  v_accvgpr_write_b32 a105, v41
  v_accvgpr_write_b32 a106, v42
  ds_read_b128 v[28:31], v11 offset:256
  s_waitcnt lgkmcnt(3)
  v_mfma_f32_32x32x16_bf16 v[64:79], v[16:19], v[152:155], v[64:79]
  v_accvgpr_write_b32 a107, v43
  v_mul_f32 v48, s52, v48
  v_mul_f32 v49, s52, v49
  v_mfma_f32_32x32x16_bf16 v[80:95], v[16:19], v[216:219], v[80:95]
  v_cvt_pk_bf16_f32 v48, v48, v49
  v_mul_f32 v50, s52, v50
  ds_read_b128 v[16:19], v12 offset:256
  s_waitcnt lgkmcnt(3)
  v_mfma_f32_32x32x16_bf16 v[64:79], v[20:23], v[156:159], v[64:79]
  v_mul_f32 v51, s52, v51
  v_cvt_pk_bf16_f32 v49, v50, v51
  v_mul_f32 v52, s52, v52
  v_mfma_f32_32x32x16_bf16 v[80:95], v[20:23], v[220:223], v[80:95]
  v_mul_f32 v53, s52, v53
  v_cvt_pk_bf16_f32 v50, v52, v53
  ds_read_b128 v[20:23], v13 offset:256
  s_waitcnt lgkmcnt(3)
  v_mfma_f32_32x32x16_bf16 v[64:79], v[24:27], v[160:163], v[64:79]
  v_mul_f32 v54, s52, v54
  v_mul_f32 v55, s52, v55
  v_cvt_pk_bf16_f32 v51, v54, v55
  v_mfma_f32_32x32x16_bf16 v[80:95], v[24:27], v[224:227], v[80:95]
  v_mul_f32 v56, s52, v56
  v_mul_f32 v57, s52, v57
  ds_read_b128 v[24:27], v14 offset:256
  s_waitcnt lgkmcnt(3)
  v_mfma_f32_32x32x16_bf16 v[64:79], v[28:31], v[164:167], v[64:79]
  v_cvt_pk_bf16_f32 v56, v56, v57
  v_mul_f32 v58, s52, v58
  v_mul_f32 v59, s52, v59
  v_mfma_f32_32x32x16_bf16 v[80:95], v[28:31], v[228:231], v[80:95]
  v_cvt_pk_bf16_f32 v57, v58, v59
  v_mul_f32 v60, s52, v60
  ds_read_b128 v[28:31], v15 offset:256
  s_waitcnt lgkmcnt(3)
  v_mfma_f32_32x32x16_bf16 v[64:79], v[16:19], v[168:171], v[64:79]
  v_mul_f32 v61, s52, v61
  v_cvt_pk_bf16_f32 v58, v60, v61
  v_mul_f32 v62, s52, v62
  v_mfma_f32_32x32x16_bf16 v[80:95], v[16:19], v[232:235], v[80:95]
  v_mul_f32 v63, s52, v63
  v_cvt_pk_bf16_f32 v59, v62, v63
  s_waitcnt lgkmcnt(2)
  v_mfma_f32_32x32x16_bf16 v[64:79], v[20:23], v[172:175], v[64:79]
  v_permlane16_swap_b32 v48, v56
  v_permlane16_swap_b32 v49, v57
  v_permlane16_swap_b32 v50, v58
  v_mfma_f32_32x32x16_bf16 v[80:95], v[20:23], v[236:239], v[80:95]
  v_permlane16_swap_b32 v51, v59
  v_accvgpr_write_b32 a160, v48
  s_waitcnt lgkmcnt(1)
  v_mfma_f32_32x32x16_bf16 v[64:79], v[24:27], v[176:179], v[64:79]
  v_accvgpr_write_b32 a161, v49
  v_accvgpr_write_b32 a162, v50
  v_accvgpr_write_b32 a163, v51
  v_mfma_f32_32x32x16_bf16 v[80:95], v[24:27], v[240:243], v[80:95]
  v_accvgpr_write_b32 a216, v56
  v_accvgpr_write_b32 a217, v57
  s_waitcnt lgkmcnt(0)
  v_mfma_f32_32x32x16_bf16 v[64:79], v[28:31], v[180:183], v[64:79]
  v_accvgpr_write_b32 a218, v58
  v_accvgpr_write_b32 a219, v59
  v_mfma_f32_32x32x16_bf16 v[80:95], v[28:31], v[244:247], v[80:95]
  s_nop 4
  v_mul_f32 v64, s52, v64
  v_mul_f32 v65, s52, v65
  v_cvt_pk_bf16_f32 v64, v64, v65
  v_mul_f32 v66, s52, v66
  v_mul_f32 v67, s52, v67
  v_cvt_pk_bf16_f32 v65, v66, v67
  v_mul_f32 v68, s52, v68
  v_mul_f32 v69, s52, v69
  v_cvt_pk_bf16_f32 v66, v68, v69
  v_mul_f32 v70, s52, v70
  v_mul_f32 v71, s52, v71
  v_cvt_pk_bf16_f32 v67, v70, v71
  v_mul_f32 v72, s52, v72
  v_mul_f32 v73, s52, v73
  v_cvt_pk_bf16_f32 v72, v72, v73
  v_mul_f32 v74, s52, v74
  v_mul_f32 v75, s52, v75
  v_cvt_pk_bf16_f32 v73, v74, v75
  v_mul_f32 v76, s52, v76
  v_mul_f32 v77, s52, v77
  v_cvt_pk_bf16_f32 v74, v76, v77
  v_mul_f32 v78, s52, v78
  v_mul_f32 v79, s52, v79
  v_cvt_pk_bf16_f32 v75, v78, v79
  v_permlane16_swap_b32 v64, v72
  v_permlane16_swap_b32 v65, v73
  v_permlane16_swap_b32 v66, v74
  v_permlane16_swap_b32 v67, v75
  v_accvgpr_write_b32 a52, v64
  v_accvgpr_write_b32 a53, v65
  v_accvgpr_write_b32 a54, v66
  v_accvgpr_write_b32 a55, v67
  v_accvgpr_write_b32 a108, v72
  v_accvgpr_write_b32 a109, v73
  v_accvgpr_write_b32 a110, v74
  v_accvgpr_write_b32 a111, v75
  v_mul_f32 v80, s52, v80
  v_mul_f32 v81, s52, v81
  v_cvt_pk_bf16_f32 v80, v80, v81
  v_mul_f32 v82, s52, v82
  v_mul_f32 v83, s52, v83
  v_cvt_pk_bf16_f32 v81, v82, v83
  v_mul_f32 v84, s52, v84
  v_mul_f32 v85, s52, v85
  v_cvt_pk_bf16_f32 v82, v84, v85
  v_mul_f32 v86, s52, v86
  v_mul_f32 v87, s52, v87
  v_cvt_pk_bf16_f32 v83, v86, v87
  v_mul_f32 v88, s52, v88
  v_mul_f32 v89, s52, v89
  v_cvt_pk_bf16_f32 v88, v88, v89
  v_mul_f32 v90, s52, v90
  v_mul_f32 v91, s52, v91
  v_cvt_pk_bf16_f32 v89, v90, v91
  v_mul_f32 v92, s52, v92
  v_mul_f32 v93, s52, v93
  v_cvt_pk_bf16_f32 v90, v92, v93
  v_mul_f32 v94, s52, v94
  v_mul_f32 v95, s52, v95
  v_cvt_pk_bf16_f32 v91, v94, v95
  v_permlane16_swap_b32 v80, v88
  v_permlane16_swap_b32 v81, v89
  v_permlane16_swap_b32 v82, v90
  v_permlane16_swap_b32 v83, v91
  v_accvgpr_write_b32 a164, v80
  v_accvgpr_write_b32 a165, v81
  v_accvgpr_write_b32 a166, v82
  v_accvgpr_write_b32 a167, v83
  v_accvgpr_write_b32 a220, v88
  v_accvgpr_write_b32 a221, v89
  v_accvgpr_write_b32 a222, v90
  v_accvgpr_write_b32 a223, v91
  s_mov_b32 s30, 0
  s_branch sc_aw_w
sc_aw:
  buffer_load_dwordx4 v[100:103], v113, s[8:11], s28 offen sc1
  buffer_load_dwordx4 v[104:107], v2, s[8:11], s29 offen sc1
  buffer_load_dwordx4 v[108:111], v112, s[8:11], s29 offen sc1
sc_aw_w:
  s_waitcnt vmcnt(0)
  v_cmp_ne_u64 vcc, s[88:89], v[100:101]
  s_cbranch_vccnz sc_aw_no
  v_cmp_ne_u64 vcc, s[88:89], v[102:103]
  s_cbranch_vccnz sc_aw_no
  v_cmp_ne_u64 vcc, s[88:89], v[104:105]
  s_cbranch_vccnz sc_aw_no
  v_cmp_ne_u64 vcc, s[88:89], v[106:107]
  s_cbranch_vccnz sc_aw_no
  v_cmp_ne_u64 vcc, s[88:89], v[108:109]
  s_cbranch_vccnz sc_aw_no
  v_cmp_ne_u64 vcc, s[88:89], v[110:111]
  s_cbranch_vccnz sc_aw_no
  s_branch sc_aw_ok
sc_aw_no:
  s_sleep 1
  s_add_u32 s30, s30, 1
  s_cmp_lt_u32 s30, 50000
  s_cbranch_scc1 sc_aw
  s_branch cA_abort
sc_aw_ok:
  s_barrier
  s_branch m_role
m_val:
  s_cmp_lg_u32 s16, 0
  s_cbranch_scc1 w0_6
  v_mov_b32 v233, 128
  v_mov_b32 v234, s88
  v_mov_b32 v235, s89
  v_mov_b32 v236, 0
  v_mov_b32 v237, 0
  s_mov_b64 exec, 1
  buffer_atomic_cmpswap_x2 v[234:237], v233, s[12:15], 0 offen sc0
  s_mov_b64 exec, -1
w0_6:
  s_cmp_lg_u32 s66, 0
  s_cbranch_scc1 va_ci
  s_cmp_lg_u32 s16, 0
  s_cbranch_scc1 w0_7
  s_lshr_b32 s70, s3, 5
  s_and_b32 s71, s70, 4
  s_mul_i32 s71, s71, 12
  s_lshl_b32 s70, s70, 2
  s_add_u32 s70, s70, s71
  s_lshl_b32 s71, 1, s3
  v_mov_b32 v242, s71
  v_mov_b32 v243, 32
  s_mov_b64 exec, 1
  buffer_atomic_or v242, v243, s[12:15], s70 offen sc0
  buffer_load_dwordx2 v[244:245], v243, s[12:15], 0 offen offset:96 sc1
  s_mov_b64 exec, -1
w0_7:
va_ci:
  s_mov_b32 s56, s40
  s_and_b32 s57, s41, 0xffff
  s_mov_b32 s58, 3670016
  s_mov_b32 s59, 0x20000
  v_lshrrev_b32 v24, 5, v1
  v_and_b32 v25, 31, v1
  v_lshlrev_b32 v25, 4, v25
  v_lshl_add_u32 v24, v24, 13, v25
  s_mov_b32 s60, s42
  s_and_b32 s61, s43, 0xffff
  s_mov_b32 s62, 3670016
  s_mov_b32 s63, 0x20000
  s_lshl_b32 s22, s17, 9
  s_lshl_b32 s23, s16, 19
  s_add_u32 s23, s22, s23
  s_add_u32 s21, s23, 262144
  buffer_load_dwordx4 v[28:31], v24, s[60:63], s21 offen
  s_add_u32 s21, s23, 278528
  buffer_load_dwordx4 v[28:31], v24, s[60:63], s21 offen
  s_add_u32 s21, s23, 294912
  buffer_load_dwordx4 v[28:31], v24, s[60:63], s21 offen
  s_add_u32 s21, s23, 311296
  buffer_load_dwordx4 v[28:31], v24, s[60:63], s21 offen
  s_add_u32 s21, s23, 327680
  buffer_load_dwordx4 v[28:31], v24, s[60:63], s21 offen
  s_add_u32 s21, s23, 344064
  buffer_load_dwordx4 v[28:31], v24, s[60:63], s21 offen
  s_add_u32 s21, s23, 360448
  buffer_load_dwordx4 v[28:31], v24, s[60:63], s21 offen
  s_add_u32 s21, s23, 376832
  buffer_load_dwordx4 v[28:31], v24, s[60:63], s21 offen
  s_add_u32 s21, s23, 393216
  buffer_load_dwordx4 v[28:31], v24, s[60:63], s21 offen
  s_add_u32 s21, s23, 409600
  buffer_load_dwordx4 v[28:31], v24, s[60:63], s21 offen
  s_add_u32 s21, s23, 425984
  buffer_load_dwordx4 v[28:31], v24, s[60:63], s21 offen
  s_add_u32 s21, s23, 442368
  buffer_load_dwordx4 v[28:31], v24, s[60:63], s21 offen
  s_add_u32 s21, s23, 458752
  buffer_load_dwordx4 v[28:31], v24, s[60:63], s21 offen
  s_add_u32 s21, s23, 475136
  buffer_load_dwordx4 v[28:31], v24, s[60:63], s21 offen
  s_add_u32 s21, s23, 491520
  buffer_load_dwordx4 v[28:31], v24, s[60:63], s21 offen
  s_add_u32 s21, s23, 507904
  buffer_load_dwordx4 v[28:31], v24, s[60:63], s21 offen
  s_lshl_b32 s23, s16, 14
  s_add_u32 s22, s22, s23
  s_mov_b32 s30, 0
va_pf:
  buffer_load_dwordx4 v[28:31], v24, s[56:59], s22 offen
  s_waitcnt vmcnt(40)
  s_add_u32 s22, s22, 65536
  s_add_u32 s30, s30, 1
  s_cmp_lt_u32 s30, 28
  s_cbranch_scc1 va_pf
  s_cmp_lg_u32 s66, 0
  s_cbranch_scc1 va_cf
  s_cmp_lg_u32 s16, 0
  s_cbranch_scc1 w0_8
  s_waitcnt vmcnt(40)
  v_readfirstlane_b32 s70, v244
  s_cmp_lg_u32 s70, 0
  s_cbranch_scc1 va_nz
  v_mov_b32 v243, 128
  v_mov_b32 v244, s88
  v_mov_b32 v245, s89
  v_mov_b32 v246, 0
  v_mov_b32 v247, 0
  s_mov_b64 exec, 1
  buffer_atomic_cmpswap_x2 v[244:247], v243, s[12:15], 0 offen sc0
  s_mov_b64 exec, -1
  s_waitcnt vmcnt(0)
  v_readfirstlane_b32 s70, v244
  s_cmp_lg_u32 s70, 0
  s_cbranch_scc1 va_nz
  v_mov_b32 v244, s88
  v_mov_b32 v245, s89
va_nz:
w0_8:
  v_mov_b32 v243, 160000
  s_add_u32 s101, s101, 1
  s_barrier
  s_mov_b64 exec, 1
  s_cmp_lg_u32 s16, 0
  s_cbranch_scc1 w0_9
  ds_write_b32 v243, v242 offset:0
  ds_write_b32 v243, v244 offset:4
  ds_write_b32 v243, v245 offset:8
  s_waitcnt lgkmcnt(0)
  v_mov_b32 v242, s101
  ds_write_b32 v243, v242 offset:16
  s_waitcnt lgkmcnt(0)
w0_9:
  s_mov_b64 exec, -1
  s_barrier
  ds_read_b32 v242, v243 offset:0
  ds_read_b32 v244, v243 offset:4
  ds_read_b32 v245, v243 offset:8
  ds_read_b32 v243, v243 offset:16
  s_waitcnt lgkmcnt(0)
  v_readfirstlane_b32 s70, v242
  v_readfirstlane_b32 s88, v244
  v_readfirstlane_b32 s89, v245
  v_cmp_ne_u32 vcc, s101, v243
  s_cbranch_vccnz ch_end
  s_mov_b32 s66, 1
  s_bitcmp1_b32 s70, s3
  s_cbranch_scc1 m_reclaim
va_cf:
  s_cmp_lg_u32 s16, 0
  s_cbranch_scc1 w0_10
  s_cmp_eq_u32 s67, 0
  s_cselect_b32 s20, 1, 0x10001
  v_mov_b32 v242, s20
  v_mov_b32 v243, 0
  s_mov_b64 exec, 1
  buffer_atomic_add v242, v243, s[12:15], 0 offen
  s_mov_b64 exec, -1
w0_10:
m_role:
  s_mov_b32 s17, s3
  v_and_b32 v1, 63, v0
  v_lshlrev_b32 v2, 4, v1
  v_lshrrev_b32 v116, 4, v1
  v_and_b32 v117, 15, v1
  v_mov_b32 v3, 0x4444
  v_mov_b32 v118, 0xeeee
  v_cmp_lt_u32 vcc, 7, v117
  s_nop 1
  v_cndmask_b32 v3, v3, v118, vcc
  s_mov_b32 s19, 0
  s_mov_b32 s20, 75235328
  s_lshr_b32 s22, s17, 4
  s_lshl_b32 s22, s22, 2
  s_add_u32 s22, s22, s16
  s_and_b32 s17, s17, 15
  s_cmp_eq_u32 s22, 0
  s_cbranch_scc1 ch_init0
  s_cmp_eq_u32 s22, 1
  s_cbranch_scc1 ch_init1
  s_cmp_eq_u32 s22, 2
  s_cbranch_scc1 ch_init2
  s_cmp_eq_u32 s22, 3
  s_cbranch_scc1 ch_init3
  s_cmp_eq_u32 s22, 4
  s_cbranch_scc1 ch_init4
  s_cmp_eq_u32 s22, 5
  s_cbranch_scc1 ch_init5
  s_cmp_eq_u32 s22, 6
  s_cbranch_scc1 ch_init6
  s_cmp_eq_u32 s22, 7
  s_cbranch_scc1 ch_init7
  s_branch ch_end
ch_init0:
  s_mul_i32 s31, s17, 401408
  s_add_u32 s31, s31, 0
  s_add_u32 s22, s31, 229376
  buffer_load_dwordx4 a[224:227], v2, s[8:11], s22 offen offset:0 sc1
  buffer_load_dwordx4 a[228:231], v2, s[8:11], s22 offen offset:1024 sc1
  buffer_load_dwordx4 a[232:235], v2, s[8:11], s22 offen offset:2048 sc1
  buffer_load_dwordx4 a[236:239], v2, s[8:11], s22 offen offset:3072 sc1
  s_add_u32 s22, s31, 233472
  buffer_load_dwordx4 a[240:243], v2, s[8:11], s22 offen offset:0 sc1
  buffer_load_dwordx4 a[244:247], v2, s[8:11], s22 offen offset:1024 sc1
  buffer_load_dwordx4 a[248:251], v2, s[8:11], s22 offen offset:2048 sc1
  buffer_load_dwordx4 a[252:255], v2, s[8:11], s22 offen offset:3072 sc1
  s_add_u32 s22, s31, 237568
  buffer_load_dwordx4 v[120:123], v2, s[8:11], s22 offen offset:0 sc1
  buffer_load_dwordx4 v[124:127], v2, s[8:11], s22 offen offset:1024 sc1
  buffer_load_dwordx4 v[128:131], v2, s[8:11], s22 offen offset:2048 sc1
  buffer_load_dwordx4 v[132:135], v2, s[8:11], s22 offen offset:3072 sc1
  s_add_u32 s22, s31, 241664
  buffer_load_dwordx4 v[136:139], v2, s[8:11], s22 offen offset:0 sc1
  buffer_load_dwordx4 v[140:143], v2, s[8:11], s22 offen offset:1024 sc1
  buffer_load_dwordx4 v[144:147], v2, s[8:11], s22 offen offset:2048 sc1
  buffer_load_dwordx4 v[148:151], v2, s[8:11], s22 offen offset:3072 sc1
  s_add_u32 s22, s31, 245760
  buffer_load_dwordx4 v[152:155], v2, s[8:11], s22 offen offset:0 sc1
  buffer_load_dwordx4 v[156:159], v2, s[8:11], s22 offen offset:1024 sc1
  buffer_load_dwordx4 v[160:163], v2, s[8:11], s22 offen offset:2048 sc1
  buffer_load_dwordx4 v[164:167], v2, s[8:11], s22 offen offset:3072 sc1
  s_add_u32 s22, s31, 249856
  buffer_load_dwordx4 v[168:171], v2, s[8:11], s22 offen offset:0 sc1
  buffer_load_dwordx4 v[172:175], v2, s[8:11], s22 offen offset:1024 sc1
  buffer_load_dwordx4 v[176:179], v2, s[8:11], s22 offen offset:2048 sc1
  buffer_load_dwordx4 v[180:183], v2, s[8:11], s22 offen offset:3072 sc1
  s_add_u32 s22, s31, 253952
  buffer_load_dwordx4 v[184:187], v2, s[8:11], s22 offen offset:0 sc1
  buffer_load_dwordx4 v[188:191], v2, s[8:11], s22 offen offset:1024 sc1
  buffer_load_dwordx4 v[192:195], v2, s[8:11], s22 offen offset:2048 sc1
  buffer_load_dwordx4 v[196:199], v2, s[8:11], s22 offen offset:3072 sc1
  s_add_u32 s22, s31, 344064
  buffer_load_dwordx4 v[200:203], v2, s[8:11], s22 offen offset:0 sc1
  buffer_load_dwordx4 v[204:207], v2, s[8:11], s22 offen offset:1024 sc1
  buffer_load_dwordx4 v[208:211], v2, s[8:11], s22 offen offset:2048 sc1
  buffer_load_dwordx4 v[212:215], v2, s[8:11], s22 offen offset:3072 sc1
  s_waitcnt vmcnt(24)
  s_add_u32 s22, s31, 348160
  buffer_load_dwordx4 v[216:219], v2, s[8:11], s22 offen offset:0 sc1
  buffer_load_dwordx4 v[220:223], v2, s[8:11], s22 offen offset:1024 sc1
  buffer_load_dwordx4 v[224:227], v2, s[8:11], s22 offen offset:2048 sc1
  buffer_load_dwordx4 v[228:231], v2, s[8:11], s22 offen offset:3072 sc1
  s_add_u32 s22, s31, 352256
  buffer_load_dwordx4 v[232:235], v2, s[8:11], s22 offen offset:0 sc1
  buffer_load_dwordx4 v[236:239], v2, s[8:11], s22 offen offset:1024 sc1
  buffer_load_dwordx4 v[240:243], v2, s[8:11], s22 offen offset:2048 sc1
  buffer_load_dwordx4 v[244:247], v2, s[8:11], s22 offen offset:3072 sc1
  s_add_u32 s22, s31, 356352
  buffer_load_dwordx4 v[248:251], v2, s[8:11], s22 offen offset:0 sc1
  buffer_load_dwordx4 v[252:255], v2, s[8:11], s22 offen offset:1024 sc1
  s_mov_b32 s24, 71565312
  s_mov_b32 s25, 0
  s_add_u32 m0, s25, 0
  s_nop 0
  buffer_load_dwordx4 v2, s[8:11], s24 offen offset:0 sc1 lds
  buffer_load_dwordx4 v2, s[8:11], s24 offen offset:1024 sc1 lds
  buffer_load_dwordx4 v2, s[8:11], s24 offen offset:2048 sc1 lds
  buffer_load_dwordx4 v2, s[8:11], s24 offen offset:3072 sc1 lds
  s_add_u32 m0, s25, 4096
  s_add_u32 s22, s24, 4096
  buffer_load_dwordx4 v2, s[8:11], s22 offen offset:0 sc1 lds
  buffer_load_dwordx4 v2, s[8:11], s22 offen offset:1024 sc1 lds
  buffer_load_dwordx4 v2, s[8:11], s22 offen offset:2048 sc1 lds
  v_and_b32 v64, 7, v117
  v_and_b32 v65, 1, v116
  v_lshlrev_b32 v65, 2, v65
  v_sub_u32 v64, v64, v65
  v_lshrrev_b32 v65, 3, v117
  v_lshl_add_u32 v66, v65, 2, v64
  v_cmp_gt_u32 vcc, 4, v64
  v_mov_b32 v67, 99
  s_nop 0
  v_cndmask_b32 v66, v67, v66, vcc
  v_mov_b32 v68, 0x3f80
  v_mov_b32 v69, 0x3f800000
  v_mov_b32 v4, 0
  v_cmp_eq_u32 vcc, 0, v66
  s_nop 1
  v_cndmask_b32 v4, v4, v68, vcc
  v_cmp_eq_u32 vcc, 1, v66
  s_nop 1
  v_cndmask_b32 v4, v4, v69, vcc
  v_mov_b32 v5, 0
  v_cmp_eq_u32 vcc, 2, v66
  s_nop 1
  v_cndmask_b32 v5, v5, v68, vcc
  v_cmp_eq_u32 vcc, 3, v66
  s_nop 1
  v_cndmask_b32 v5, v5, v69, vcc
  v_mov_b32 v6, 0
  v_cmp_eq_u32 vcc, 4, v66
  s_nop 1
  v_cndmask_b32 v6, v6, v68, vcc
  v_cmp_eq_u32 vcc, 5, v66
  s_nop 1
  v_cndmask_b32 v6, v6, v69, vcc
  v_mov_b32 v7, 0
  v_cmp_eq_u32 vcc, 6, v66
  s_nop 1
  v_cndmask_b32 v7, v7, v68, vcc
  v_cmp_eq_u32 vcc, 7, v66
  s_nop 1
  v_cndmask_b32 v7, v7, v69, vcc
  v_lshrrev_b32 v64, 1, v116
  v_lshrrev_b32 v65, 3, v117
  v_cmp_eq_u32 s[26:27], v64, v65
  v_and_b32 v66, 1, v116
  v_add_u32 v64, 0, v64
  v_lshrrev_b32 v67, 1, v116
  v_lshlrev_b32 v67, 8, v67
  v_lshl_add_u32 v67, v66, 9, v67
  v_lshl_add_u32 v67, v117, 4, v67
  v_add_u32 v112, 57344, v67
  v_and_b32 v68, 7, v117
  v_lshlrev_b32 v67, 8, v64
  v_lshl_add_u32 v67, v68, 5, v67
  v_lshl_add_u32 v67, v66, 4, v67
  v_add_u32 v113, 65536, v67
  v_lshrrev_b32 v64, 5, v1
  v_and_b32 v65, 31, v1
  v_lshrrev_b32 v66, 3, v65
  v_and_b32 v67, 7, v65
  v_and_b32 v68, 3, v67
  v_lshl_add_u32 v68, v66, 2, v68
  v_lshrrev_b32 v69, 2, v67
  v_lshl_add_u32 v68, v69, 4, v68
  v_lshlrev_b32 v69, 11, v64
  v_lshl_add_u32 v69, v68, 4, v69
  v_add_u32 v114, 57344, v69
  v_add_u32 v70, 0, v64
  v_lshlrev_b32 v69, 9, v66
  v_lshl_add_u32 v69, v70, 5, v69
  v_lshl_add_u32 v69, v67, 2, v69
  v_add_u32 v115, 65536, v69
  v_and_b32 v71, 1, v1
  v_cmp_eq_u32 s[38:39], 0, v71
  v_cmp_gt_u32 vcc, 8, v65
  s_or_b64 s[28:29], s[38:39], vcc
  v_lshrrev_b32 v72, 1, v67
  v_lshlrev_b32 v72, 2, v72
  v_lshl_add_u32 v72, v70, 4, v72
  s_lshl_b32 s22, s17, 9
  s_add_u32 s22, s22, 9216
  v_lshl_add_u32 v73, v66, 7, v72
  v_add_u32 v73, s22, v73
  s_lshl_b32 s22, s17, 7
  s_add_u32 s22, s22, 7168
  v_add_u32 v74, s22, v72
  v_bfe_u32 v72, v65, 1, 1
  v_lshlrev_b32 v72, 7, v72
  v_lshl_add_u32 v72, v70, 4, v72
  v_bfe_u32 v73, v65, 2, 2
  v_lshl_add_u32 v72, v73, 2, v72
  v_lshrrev_b32 v73, 4, v65
  v_lshl_add_u32 v73, v73, 8, v72
  s_lshl_b32 s22, s17, 9
  s_add_u32 s22, s22, 9216
  v_add_u32 v73, s22, v73
  s_lshr_b32 s22, s17, 1
  s_lshl_b32 s22, s22, 8
  s_and_b32 s34, s17, 1
  s_lshl_b32 s34, s34, 3
  s_add_u32 s22, s22, s34
  s_add_u32 s22, s22, 7168
  v_add_u32 v74, s22, v72
  v_lshlrev_b32 v0, 2, v65
  s_and_b32 s22, s17, 31
  s_lshl_b32 s22, s22, 7
  s_add_u32 s22, s22, 21504
  v_add_u32 v0, s22, v0
  v_cndmask_b32 v1, v74, v73, s[38:39]
  s_lshl_b32 s36, s17, 2
  s_add_u32 s36, s36, 17408
  s_mov_b32 s37, 0x3e800000
  v_mov_b32 v64, 0
  v_mov_b32 v65, 0
  v_mov_b32 v66, 0
  v_mov_b32 v67, 0
  v_mov_b32 v68, 0
  v_mov_b32 v69, 0
  v_mov_b32 v70, 0
  v_mov_b32 v71, 0
  v_mov_b32 v72, 0
  v_mov_b32 v73, 0
  v_mov_b32 v74, 0
  v_mov_b32 v75, 0
  v_mov_b32 v76, 0
  v_mov_b32 v77, 0
  v_mov_b32 v78, 0
  v_mov_b32 v79, 0
  v_mov_b32 v80, 0
  v_mov_b32 v81, 0
  v_mov_b32 v82, 0
  v_mov_b32 v83, 0
  v_mov_b32 v84, 0
  v_mov_b32 v85, 0
  v_mov_b32 v86, 0
  v_mov_b32 v87, 0
  v_mov_b32 v88, 0
  v_mov_b32 v89, 0
  v_mov_b32 v90, 0
  v_mov_b32 v91, 0
  v_mov_b32 v92, 0
  v_mov_b32 v93, 0
  v_mov_b32 v94, 0
  v_mov_b32 v95, 0
  v_mov_b32 v96, 0
  v_mov_b32 v97, 0
  v_mov_b32 v98, 0
  v_mov_b32 v99, 0
  v_mov_b32 v100, 0
  v_mov_b32 v101, 0
  v_mov_b32 v102, 0
  v_mov_b32 v103, 0
  v_mov_b32 v104, 0
  v_mov_b32 v105, 0
  v_mov_b32 v106, 0
  v_mov_b32 v107, 0
  v_mov_b32 v108, 0
  v_mov_b32 v109, 0
  v_mov_b32 v110, 0
  v_mov_b32 v111, 0
  v_mov_b32 v116, v2
  v_lshrrev_b32 v117, 4, v2
  v_min_u32 v117, 55, v117
  v_lshlrev_b32 v117, 7, v117
  s_mul_i32 s35, s17, 1835008
  s_add_u32 s35, s35, 42262528
  s_mov_b32 s30, 0
  v_mov_b32 v36, 0
ch_md0:
  buffer_load_dword v37, v36, s[12:15], 0 offen sc1
  s_waitcnt vmcnt(0)
  v_readfirstlane_b32 s22, v37
  s_and_b32 s31, s22, 0xffff
  s_cmp_ge_u32 s31, 32
  s_cbranch_scc1 ch_go0
  s_sleep 2
  s_add_u32 s30, s30, 1
  s_cmp_lt_u32 s30, 50000
  s_cbranch_scc1 ch_md0
  s_branch ch_end
ch_go0:
  s_mov_b32 s31, 0
  s_lshr_b32 s22, s22, 16
  s_cmp_lg_u32 s22, 0
  s_cbranch_scc1 cB_sc0_loop
  s_branch cA_sc0_loop
ch_init1:
  s_mul_i32 s31, s17, 401408
  s_add_u32 s31, s31, 0
  s_add_u32 s22, s31, 258048
  buffer_load_dwordx4 a[224:227], v2, s[8:11], s22 offen offset:0 sc1
  buffer_load_dwordx4 a[228:231], v2, s[8:11], s22 offen offset:1024 sc1
  buffer_load_dwordx4 a[232:235], v2, s[8:11], s22 offen offset:2048 sc1
  buffer_load_dwordx4 a[236:239], v2, s[8:11], s22 offen offset:3072 sc1
  s_add_u32 s22, s31, 262144
  buffer_load_dwordx4 a[240:243], v2, s[8:11], s22 offen offset:0 sc1
  buffer_load_dwordx4 a[244:247], v2, s[8:11], s22 offen offset:1024 sc1
  buffer_load_dwordx4 a[248:251], v2, s[8:11], s22 offen offset:2048 sc1
  buffer_load_dwordx4 a[252:255], v2, s[8:11], s22 offen offset:3072 sc1
  s_add_u32 s22, s31, 266240
  buffer_load_dwordx4 v[120:123], v2, s[8:11], s22 offen offset:0 sc1
  buffer_load_dwordx4 v[124:127], v2, s[8:11], s22 offen offset:1024 sc1
  buffer_load_dwordx4 v[128:131], v2, s[8:11], s22 offen offset:2048 sc1
  buffer_load_dwordx4 v[132:135], v2, s[8:11], s22 offen offset:3072 sc1
  s_add_u32 s22, s31, 270336
  buffer_load_dwordx4 v[136:139], v2, s[8:11], s22 offen offset:0 sc1
  buffer_load_dwordx4 v[140:143], v2, s[8:11], s22 offen offset:1024 sc1
  buffer_load_dwordx4 v[144:147], v2, s[8:11], s22 offen offset:2048 sc1
  buffer_load_dwordx4 v[148:151], v2, s[8:11], s22 offen offset:3072 sc1
  s_add_u32 s22, s31, 274432
  buffer_load_dwordx4 v[152:155], v2, s[8:11], s22 offen offset:0 sc1
  buffer_load_dwordx4 v[156:159], v2, s[8:11], s22 offen offset:1024 sc1
  buffer_load_dwordx4 v[160:163], v2, s[8:11], s22 offen offset:2048 sc1
  buffer_load_dwordx4 v[164:167], v2, s[8:11], s22 offen offset:3072 sc1
  s_add_u32 s22, s31, 278528
  buffer_load_dwordx4 v[168:171], v2, s[8:11], s22 offen offset:0 sc1
  buffer_load_dwordx4 v[172:175], v2, s[8:11], s22 offen offset:1024 sc1
  buffer_load_dwordx4 v[176:179], v2, s[8:11], s22 offen offset:2048 sc1
  buffer_load_dwordx4 v[180:183], v2, s[8:11], s22 offen offset:3072 sc1
  s_add_u32 s22, s31, 282624
  buffer_load_dwordx4 v[184:187], v2, s[8:11], s22 offen offset:0 sc1
  buffer_load_dwordx4 v[188:191], v2, s[8:11], s22 offen offset:1024 sc1
  buffer_load_dwordx4 v[192:195], v2, s[8:11], s22 offen offset:2048 sc1
  buffer_load_dwordx4 v[196:199], v2, s[8:11], s22 offen offset:3072 sc1
  s_add_u32 s22, s31, 356352
  buffer_load_dwordx4 v[200:203], v2, s[8:11], s22 offen offset:2048 sc1
  buffer_load_dwordx4 v[204:207], v2, s[8:11], s22 offen offset:3072 sc1
  s_add_u32 s22, s31, 360448
  buffer_load_dwordx4 v[208:211], v2, s[8:11], s22 offen offset:0 sc1
  buffer_load_dwordx4 v[212:215], v2, s[8:11], s22 offen offset:1024 sc1
  s_waitcnt vmcnt(24)
  buffer_load_dwordx4 v[216:219], v2, s[8:11], s22 offen offset:2048 sc1
  buffer_load_dwordx4 v[220:223], v2, s[8:11], s22 offen offset:3072 sc1
  s_add_u32 s22, s31, 364544
  buffer_load_dwordx4 v[224:227], v2, s[8:11], s22 offen offset:0 sc1
  buffer_load_dwordx4 v[228:231], v2, s[8:11], s22 offen offset:1024 sc1
  buffer_load_dwordx4 v[232:235], v2, s[8:11], s22 offen offset:2048 sc1
  buffer_load_dwordx4 v[236:239], v2, s[8:11], s22 offen offset:3072 sc1
  s_add_u32 s22, s31, 368640
  buffer_load_dwordx4 v[240:243], v2, s[8:11], s22 offen offset:0 sc1
  buffer_load_dwordx4 v[244:247], v2, s[8:11], s22 offen offset:1024 sc1
  buffer_load_dwordx4 v[248:251], v2, s[8:11], s22 offen offset:2048 sc1
  buffer_load_dwordx4 v[252:255], v2, s[8:11], s22 offen offset:3072 sc1
  s_mov_b32 s24, 71572480
  s_mov_b32 s25, 0
  s_add_u32 m0, s25, 7168
  s_nop 0
  buffer_load_dwordx4 v2, s[8:11], s24 offen offset:0 sc1 lds
  buffer_load_dwordx4 v2, s[8:11], s24 offen offset:1024 sc1 lds
  buffer_load_dwordx4 v2, s[8:11], s24 offen offset:2048 sc1 lds
  buffer_load_dwordx4 v2, s[8:11], s24 offen offset:3072 sc1 lds
  s_add_u32 m0, s25, 11264
  s_add_u32 s22, s24, 4096
  buffer_load_dwordx4 v2, s[8:11], s22 offen offset:0 sc1 lds
  buffer_load_dwordx4 v2, s[8:11], s22 offen offset:1024 sc1 lds
  buffer_load_dwordx4 v2, s[8:11], s22 offen offset:2048 sc1 lds
  v_and_b32 v64, 7, v117
  v_and_b32 v65, 1, v116
  v_lshlrev_b32 v65, 2, v65
  v_sub_u32 v64, v64, v65
  v_lshrrev_b32 v65, 3, v117
  v_lshl_add_u32 v66, v65, 2, v64
  v_cmp_gt_u32 vcc, 4, v64
  v_mov_b32 v67, 99
  s_nop 0
  v_cndmask_b32 v66, v67, v66, vcc
  v_mov_b32 v68, 0x3f80
  v_mov_b32 v69, 0x3f800000
  v_mov_b32 v4, 0
  v_cmp_eq_u32 vcc, 0, v66
  s_nop 1
  v_cndmask_b32 v4, v4, v68, vcc
  v_cmp_eq_u32 vcc, 1, v66
  s_nop 1
  v_cndmask_b32 v4, v4, v69, vcc
  v_mov_b32 v5, 0
  v_cmp_eq_u32 vcc, 2, v66
  s_nop 1
  v_cndmask_b32 v5, v5, v68, vcc
  v_cmp_eq_u32 vcc, 3, v66
  s_nop 1
  v_cndmask_b32 v5, v5, v69, vcc
  v_mov_b32 v6, 0
  v_cmp_eq_u32 vcc, 4, v66
  s_nop 1
  v_cndmask_b32 v6, v6, v68, vcc
  v_cmp_eq_u32 vcc, 5, v66
  s_nop 1
  v_cndmask_b32 v6, v6, v69, vcc
  v_mov_b32 v7, 0
  v_cmp_eq_u32 vcc, 6, v66
  s_nop 1
  v_cndmask_b32 v7, v7, v68, vcc
  v_cmp_eq_u32 vcc, 7, v66
  s_nop 1
  v_cndmask_b32 v7, v7, v69, vcc
  v_lshrrev_b32 v64, 1, v116
  v_lshrrev_b32 v65, 3, v117
  v_cmp_eq_u32 s[26:27], v64, v65
  v_and_b32 v66, 1, v116
  v_add_u32 v64, 2, v64
  v_lshrrev_b32 v67, 1, v116
  v_lshlrev_b32 v67, 8, v67
  v_lshl_add_u32 v67, v66, 9, v67
  v_lshl_add_u32 v67, v117, 4, v67
  v_add_u32 v112, 58368, v67
  v_and_b32 v68, 7, v117
  v_lshlrev_b32 v67, 8, v64
  v_lshl_add_u32 v67, v68, 5, v67
  v_lshl_add_u32 v67, v66, 4, v67
  v_add_u32 v113, 65536, v67
  v_lshrrev_b32 v64, 5, v1
  v_and_b32 v65, 31, v1
  v_lshrrev_b32 v66, 3, v65
  v_and_b32 v67, 7, v65
  v_and_b32 v68, 3, v67
  v_lshl_add_u32 v68, v66, 2, v68
  v_lshrrev_b32 v69, 2, v67
  v_lshl_add_u32 v68, v69, 4, v68
  v_lshlrev_b32 v69, 11, v64
  v_lshl_add_u32 v69, v68, 4, v69
  v_add_u32 v114, 57352, v69
  v_add_u32 v70, 2, v64
  v_lshlrev_b32 v69, 9, v66
  v_lshl_add_u32 v69, v70, 5, v69
  v_lshl_add_u32 v69, v67, 2, v69
  v_add_u32 v115, 65536, v69
  v_and_b32 v71, 1, v1
  v_cmp_eq_u32 s[38:39], 0, v71
  v_cmp_gt_u32 vcc, 8, v65
  s_or_b64 s[28:29], s[38:39], vcc
  v_lshrrev_b32 v72, 1, v67
  v_lshlrev_b32 v72, 2, v72
  v_lshl_add_u32 v72, v70, 4, v72
  s_lshl_b32 s22, s17, 9
  s_add_u32 s22, s22, 9216
  v_lshl_add_u32 v73, v66, 7, v72
  v_add_u32 v73, s22, v73
  s_lshl_b32 s22, s17, 7
  s_add_u32 s22, s22, 7168
  v_add_u32 v74, s22, v72
  v_bfe_u32 v72, v65, 1, 1
  v_lshlrev_b32 v72, 7, v72
  v_lshl_add_u32 v72, v70, 4, v72
  v_bfe_u32 v73, v65, 2, 2
  v_lshl_add_u32 v72, v73, 2, v72
  v_lshrrev_b32 v73, 4, v65
  v_lshl_add_u32 v73, v73, 8, v72
  s_lshl_b32 s22, s17, 9
  s_add_u32 s22, s22, 9216
  v_add_u32 v73, s22, v73
  s_lshr_b32 s22, s17, 1
  s_lshl_b32 s22, s22, 8
  s_and_b32 s34, s17, 1
  s_lshl_b32 s34, s34, 3
  s_add_u32 s22, s22, s34
  s_add_u32 s22, s22, 7168
  v_add_u32 v74, s22, v72
  v_lshlrev_b32 v0, 2, v65
  s_and_b32 s22, s17, 31
  s_lshl_b32 s22, s22, 7
  s_add_u32 s22, s22, 21504
  v_add_u32 v0, s22, v0
  v_cndmask_b32 v1, v74, v73, s[38:39]
  s_lshl_b32 s36, s17, 2
  s_add_u32 s36, s36, 17408
  s_mov_b32 s37, 0x3e800000
  v_mov_b32 v64, 0
  v_mov_b32 v65, 0
  v_mov_b32 v66, 0
  v_mov_b32 v67, 0
  v_mov_b32 v68, 0
  v_mov_b32 v69, 0
  v_mov_b32 v70, 0
  v_mov_b32 v71, 0
  v_mov_b32 v72, 0
  v_mov_b32 v73, 0
  v_mov_b32 v74, 0
  v_mov_b32 v75, 0
  v_mov_b32 v76, 0
  v_mov_b32 v77, 0
  v_mov_b32 v78, 0
  v_mov_b32 v79, 0
  v_mov_b32 v80, 0
  v_mov_b32 v81, 0
  v_mov_b32 v82, 0
  v_mov_b32 v83, 0
  v_mov_b32 v84, 0
  v_mov_b32 v85, 0
  v_mov_b32 v86, 0
  v_mov_b32 v87, 0
  v_mov_b32 v88, 0
  v_mov_b32 v89, 0
  v_mov_b32 v90, 0
  v_mov_b32 v91, 0
  v_mov_b32 v92, 0
  v_mov_b32 v93, 0
  v_mov_b32 v94, 0
  v_mov_b32 v95, 0
  v_mov_b32 v96, 0
  v_mov_b32 v97, 0
  v_mov_b32 v98, 0
  v_mov_b32 v99, 0
  v_mov_b32 v100, 0
  v_mov_b32 v101, 0
  v_mov_b32 v102, 0
  v_mov_b32 v103, 0
  v_mov_b32 v104, 0
  v_mov_b32 v105, 0
  v_mov_b32 v106, 0
  v_mov_b32 v107, 0
  v_mov_b32 v108, 0
  v_mov_b32 v109, 0
  v_mov_b32 v110, 0
  v_mov_b32 v111, 0
  v_mov_b32 v116, v2
  v_lshrrev_b32 v117, 4, v2
  v_min_u32 v117, 55, v117
  v_lshlrev_b32 v117, 7, v117
  v_lshrrev_b32 v0, 4, v2
  v_min_u32 v0, 12, v0
  s_mul_i32 s22, s17, 13
  v_add_u32 v0, s22, v0
  v_lshlrev_b32 v0, 7, v0
  v_add_u32 v0, 51200, v0
  s_mov_b32 s22, 75209728
  buffer_load_dword v119, v0, s[8:11], s22 offen sc1
  s_mov_b32 s22, 75184128
  buffer_load_dword v119, v0, s[8:11], s22 offen sc1
  s_mul_i32 s35, s17, 1835008
  s_add_u32 s35, s35, 42269696
  s_mov_b32 s30, 0
  v_mov_b32 v36, 0
ch_md1:
  buffer_load_dword v37, v36, s[12:15], 0 offen sc1
  s_waitcnt vmcnt(0)
  v_readfirstlane_b32 s22, v37
  s_and_b32 s31, s22, 0xffff
  s_cmp_ge_u32 s31, 32
  s_cbranch_scc1 ch_go1
  s_sleep 2
  s_add_u32 s30, s30, 1
  s_cmp_lt_u32 s30, 50000
  s_cbranch_scc1 ch_md1
  s_branch ch_end
ch_go1:
  s_mov_b32 s31, 0
  s_lshr_b32 s22, s22, 16
  s_cmp_lg_u32 s22, 0
  s_cbranch_scc1 cB_sc1_loop
  s_branch cA_sc1_loop
ch_init2:
  s_mul_i32 s31, s17, 401408
  s_add_u32 s31, s31, 0
  s_add_u32 s22, s31, 286720
  buffer_load_dwordx4 a[224:227], v2, s[8:11], s22 offen offset:0 sc1
  buffer_load_dwordx4 a[228:231], v2, s[8:11], s22 offen offset:1024 sc1
  buffer_load_dwordx4 a[232:235], v2, s[8:11], s22 offen offset:2048 sc1
  buffer_load_dwordx4 a[236:239], v2, s[8:11], s22 offen offset:3072 sc1
  s_add_u32 s22, s31, 290816
  buffer_load_dwordx4 a[240:243], v2, s[8:11], s22 offen offset:0 sc1
  buffer_load_dwordx4 a[244:247], v2, s[8:11], s22 offen offset:1024 sc1
  buffer_load_dwordx4 a[248:251], v2, s[8:11], s22 offen offset:2048 sc1
  buffer_load_dwordx4 a[252:255], v2, s[8:11], s22 offen offset:3072 sc1
  s_add_u32 s22, s31, 294912
  buffer_load_dwordx4 v[120:123], v2, s[8:11], s22 offen offset:0 sc1
  buffer_load_dwordx4 v[124:127], v2, s[8:11], s22 offen offset:1024 sc1
  buffer_load_dwordx4 v[128:131], v2, s[8:11], s22 offen offset:2048 sc1
  buffer_load_dwordx4 v[132:135], v2, s[8:11], s22 offen offset:3072 sc1
  s_add_u32 s22, s31, 299008
  buffer_load_dwordx4 v[136:139], v2, s[8:11], s22 offen offset:0 sc1
  buffer_load_dwordx4 v[140:143], v2, s[8:11], s22 offen offset:1024 sc1
  buffer_load_dwordx4 v[144:147], v2, s[8:11], s22 offen offset:2048 sc1
  buffer_load_dwordx4 v[148:151], v2, s[8:11], s22 offen offset:3072 sc1
  s_add_u32 s22, s31, 303104
  buffer_load_dwordx4 v[152:155], v2, s[8:11], s22 offen offset:0 sc1
  buffer_load_dwordx4 v[156:159], v2, s[8:11], s22 offen offset:1024 sc1
  buffer_load_dwordx4 v[160:163], v2, s[8:11], s22 offen offset:2048 sc1
  buffer_load_dwordx4 v[164:167], v2, s[8:11], s22 offen offset:3072 sc1
  s_add_u32 s22, s31, 307200
  buffer_load_dwordx4 v[168:171], v2, s[8:11], s22 offen offset:0 sc1
  buffer_load_dwordx4 v[172:175], v2, s[8:11], s22 offen offset:1024 sc1
  buffer_load_dwordx4 v[176:179], v2, s[8:11], s22 offen offset:2048 sc1
  buffer_load_dwordx4 v[180:183], v2, s[8:11], s22 offen offset:3072 sc1
  s_add_u32 s22, s31, 311296
  buffer_load_dwordx4 v[184:187], v2, s[8:11], s22 offen offset:0 sc1
  buffer_load_dwordx4 v[188:191], v2, s[8:11], s22 offen offset:1024 sc1
  buffer_load_dwordx4 v[192:195], v2, s[8:11], s22 offen offset:2048 sc1
  buffer_load_dwordx4 v[196:199], v2, s[8:11], s22 offen offset:3072 sc1
  s_add_u32 s22, s31, 372736
  buffer_load_dwordx4 v[200:203], v2, s[8:11], s22 offen offset:0 sc1
  buffer_load_dwordx4 v[204:207], v2, s[8:11], s22 offen offset:1024 sc1
  buffer_load_dwordx4 v[208:211], v2, s[8:11], s22 offen offset:2048 sc1
  buffer_load_dwordx4 v[212:215], v2, s[8:11], s22 offen offset:3072 sc1
  s_waitcnt vmcnt(24)
  s_add_u32 s22, s31, 376832
  buffer_load_dwordx4 v[216:219], v2, s[8:11], s22 offen offset:0 sc1
  buffer_load_dwordx4 v[220:223], v2, s[8:11], s22 offen offset:1024 sc1
  buffer_load_dwordx4 v[224:227], v2, s[8:11], s22 offen offset:2048 sc1
  buffer_load_dwordx4 v[228:231], v2, s[8:11], s22 offen offset:3072 sc1
  s_add_u32 s22, s31, 380928
  buffer_load_dwordx4 v[232:235], v2, s[8:11], s22 offen offset:0 sc1
  buffer_load_dwordx4 v[236:239], v2, s[8:11], s22 offen offset:1024 sc1
  buffer_load_dwordx4 v[240:243], v2, s[8:11], s22 offen offset:2048 sc1
  buffer_load_dwordx4 v[244:247], v2, s[8:11], s22 offen offset:3072 sc1
  s_add_u32 s22, s31, 385024
  buffer_load_dwordx4 v[248:251], v2, s[8:11], s22 offen offset:0 sc1
  buffer_load_dwordx4 v[252:255], v2, s[8:11], s22 offen offset:1024 sc1
  s_mov_b32 s24, 71579648
  s_mov_b32 s25, 0
  s_add_u32 m0, s25, 14336
  s_nop 0
  buffer_load_dwordx4 v2, s[8:11], s24 offen offset:0 sc1 lds
  buffer_load_dwordx4 v2, s[8:11], s24 offen offset:1024 sc1 lds
  buffer_load_dwordx4 v2, s[8:11], s24 offen offset:2048 sc1 lds
  buffer_load_dwordx4 v2, s[8:11], s24 offen offset:3072 sc1 lds
  s_add_u32 m0, s25, 18432
  s_add_u32 s22, s24, 4096
  buffer_load_dwordx4 v2, s[8:11], s22 offen offset:0 sc1 lds
  buffer_load_dwordx4 v2, s[8:11], s22 offen offset:1024 sc1 lds
  buffer_load_dwordx4 v2, s[8:11], s22 offen offset:2048 sc1 lds
  v_and_b32 v64, 7, v117
  v_and_b32 v65, 1, v116
  v_lshlrev_b32 v65, 2, v65
  v_sub_u32 v64, v64, v65
  v_lshrrev_b32 v65, 3, v117
  v_lshl_add_u32 v66, v65, 2, v64
  v_cmp_gt_u32 vcc, 4, v64
  v_mov_b32 v67, 99
  s_nop 0
  v_cndmask_b32 v66, v67, v66, vcc
  v_mov_b32 v68, 0x3f80
  v_mov_b32 v69, 0x3f800000
  v_mov_b32 v4, 0
  v_cmp_eq_u32 vcc, 0, v66
  s_nop 1
  v_cndmask_b32 v4, v4, v68, vcc
  v_cmp_eq_u32 vcc, 1, v66
  s_nop 1
  v_cndmask_b32 v4, v4, v69, vcc
  v_mov_b32 v5, 0
  v_cmp_eq_u32 vcc, 2, v66
  s_nop 1
  v_cndmask_b32 v5, v5, v68, vcc
  v_cmp_eq_u32 vcc, 3, v66
  s_nop 1
  v_cndmask_b32 v5, v5, v69, vcc
  v_mov_b32 v6, 0
  v_cmp_eq_u32 vcc, 4, v66
  s_nop 1
  v_cndmask_b32 v6, v6, v68, vcc
  v_cmp_eq_u32 vcc, 5, v66
  s_nop 1
  v_cndmask_b32 v6, v6, v69, vcc
  v_mov_b32 v7, 0
  v_cmp_eq_u32 vcc, 6, v66
  s_nop 1
  v_cndmask_b32 v7, v7, v68, vcc
  v_cmp_eq_u32 vcc, 7, v66
  s_nop 1
  v_cndmask_b32 v7, v7, v69, vcc
  v_lshrrev_b32 v64, 1, v116
  v_lshrrev_b32 v65, 3, v117
  v_cmp_eq_u32 s[26:27], v64, v65
  v_and_b32 v66, 1, v116
  v_add_u32 v64, 4, v64
  v_lshrrev_b32 v67, 1, v116
  v_lshlrev_b32 v67, 8, v67
  v_lshl_add_u32 v67, v66, 9, v67
  v_lshl_add_u32 v67, v117, 4, v67
  v_add_u32 v112, 59392, v67
  v_and_b32 v68, 7, v117
  v_lshlrev_b32 v67, 8, v64
  v_lshl_add_u32 v67, v68, 5, v67
  v_lshl_add_u32 v67, v66, 4, v67
  v_add_u32 v113, 65536, v67
  v_lshrrev_b32 v64, 5, v1
  v_and_b32 v65, 31, v1
  v_lshrrev_b32 v66, 3, v65
  v_and_b32 v67, 7, v65
  v_and_b32 v68, 3, v67
  v_lshl_add_u32 v68, v66, 2, v68
  v_lshrrev_b32 v69, 2, v67
  v_lshl_add_u32 v68, v69, 4, v68
  v_lshlrev_b32 v69, 11, v64
  v_lshl_add_u32 v69, v68, 4, v69
  v_add_u32 v114, 57856, v69
  v_add_u32 v70, 4, v64
  v_lshlrev_b32 v69, 9, v66
  v_lshl_add_u32 v69, v70, 5, v69
  v_lshl_add_u32 v69, v67, 2, v69
  v_add_u32 v115, 65536, v69
  v_and_b32 v71, 1, v1
  v_cmp_eq_u32 s[38:39], 0, v71
  v_cmp_gt_u32 vcc, 8, v65
  s_or_b64 s[28:29], s[38:39], vcc
  v_lshrrev_b32 v72, 1, v67
  v_lshlrev_b32 v72, 2, v72
  v_lshl_add_u32 v72, v70, 4, v72
  s_lshl_b32 s22, s17, 9
  s_add_u32 s22, s22, 9216
  v_lshl_add_u32 v73, v66, 7, v72
  v_add_u32 v73, s22, v73
  s_lshl_b32 s22, s17, 7
  s_add_u32 s22, s22, 7168
  v_add_u32 v74, s22, v72
  v_bfe_u32 v72, v65, 1, 1
  v_lshlrev_b32 v72, 7, v72
  v_lshl_add_u32 v72, v70, 4, v72
  v_bfe_u32 v73, v65, 2, 2
  v_lshl_add_u32 v72, v73, 2, v72
  v_lshrrev_b32 v73, 4, v65
  v_lshl_add_u32 v73, v73, 8, v72
  s_lshl_b32 s22, s17, 9
  s_add_u32 s22, s22, 9216
  v_add_u32 v73, s22, v73
  s_lshr_b32 s22, s17, 1
  s_lshl_b32 s22, s22, 8
  s_and_b32 s34, s17, 1
  s_lshl_b32 s34, s34, 3
  s_add_u32 s22, s22, s34
  s_add_u32 s22, s22, 7168
  v_add_u32 v74, s22, v72
  v_lshlrev_b32 v0, 2, v65
  s_and_b32 s22, s17, 31
  s_lshl_b32 s22, s22, 7
  s_add_u32 s22, s22, 21504
  v_add_u32 v0, s22, v0
  v_cndmask_b32 v1, v74, v73, s[38:39]
  s_lshl_b32 s36, s17, 2
  s_add_u32 s36, s36, 17408
  s_mov_b32 s37, 0x3e800000
  v_mov_b32 v64, 0
  v_mov_b32 v65, 0
  v_mov_b32 v66, 0
  v_mov_b32 v67, 0
  v_mov_b32 v68, 0
  v_mov_b32 v69, 0
  v_mov_b32 v70, 0
  v_mov_b32 v71, 0
  v_mov_b32 v72, 0
  v_mov_b32 v73, 0
  v_mov_b32 v74, 0
  v_mov_b32 v75, 0
  v_mov_b32 v76, 0
  v_mov_b32 v77, 0
  v_mov_b32 v78, 0
  v_mov_b32 v79, 0
  v_mov_b32 v80, 0
  v_mov_b32 v81, 0
  v_mov_b32 v82, 0
  v_mov_b32 v83, 0
  v_mov_b32 v84, 0
  v_mov_b32 v85, 0
  v_mov_b32 v86, 0
  v_mov_b32 v87, 0
  v_mov_b32 v88, 0
  v_mov_b32 v89, 0
  v_mov_b32 v90, 0
  v_mov_b32 v91, 0
  v_mov_b32 v92, 0
  v_mov_b32 v93, 0
  v_mov_b32 v94, 0
  v_mov_b32 v95, 0
  v_mov_b32 v96, 0
  v_mov_b32 v97, 0
  v_mov_b32 v98, 0
  v_mov_b32 v99, 0
  v_mov_b32 v100, 0
  v_mov_b32 v101, 0
  v_mov_b32 v102, 0
  v_mov_b32 v103, 0
  v_mov_b32 v104, 0
  v_mov_b32 v105, 0
  v_mov_b32 v106, 0
  v_mov_b32 v107, 0
  v_mov_b32 v108, 0
  v_mov_b32 v109, 0
  v_mov_b32 v110, 0
  v_mov_b32 v111, 0
  v_mov_b32 v116, v2
  v_lshrrev_b32 v117, 4, v2
  v_min_u32 v117, 55, v117
  v_lshlrev_b32 v117, 7, v117
  v_lshrrev_b32 v0, 4, v2
  v_min_u32 v0, 13, v0
  s_mul_i32 s22, s17, 14
  v_add_u32 v0, s22, v0
  v_lshlrev_b32 v0, 7, v0
  v_add_u32 v0, 43008, v0
  s_mov_b32 s22, 71550976
  buffer_load_dword v119, v0, s[8:11], s22 offen sc1
  s_mov_b32 s22, 71522304
  buffer_load_dword v119, v0, s[8:11], s22 offen sc1
  s_mul_i32 s35, s17, 1835008
  s_add_u32 s35, s35, 42276864
  s_mov_b32 s30, 0
  v_mov_b32 v36, 0
ch_md2:
  buffer_load_dword v37, v36, s[12:15], 0 offen sc1
  s_waitcnt vmcnt(0)
  v_readfirstlane_b32 s22, v37
  s_and_b32 s31, s22, 0xffff
  s_cmp_ge_u32 s31, 32
  s_cbranch_scc1 ch_go2
  s_sleep 2
  s_add_u32 s30, s30, 1
  s_cmp_lt_u32 s30, 50000
  s_cbranch_scc1 ch_md2
  s_branch ch_end
ch_go2:
  s_mov_b32 s31, 0
  s_lshr_b32 s22, s22, 16
  s_cmp_lg_u32 s22, 0
  s_cbranch_scc1 cB_sc2_loop
  s_branch cA_sc2_loop
ch_init3:
  s_mul_i32 s31, s17, 401408
  s_add_u32 s31, s31, 0
  s_add_u32 s22, s31, 315392
  buffer_load_dwordx4 a[224:227], v2, s[8:11], s22 offen offset:0 sc1
  buffer_load_dwordx4 a[228:231], v2, s[8:11], s22 offen offset:1024 sc1
  buffer_load_dwordx4 a[232:235], v2, s[8:11], s22 offen offset:2048 sc1
  buffer_load_dwordx4 a[236:239], v2, s[8:11], s22 offen offset:3072 sc1
  s_add_u32 s22, s31, 319488
  buffer_load_dwordx4 a[240:243], v2, s[8:11], s22 offen offset:0 sc1
  buffer_load_dwordx4 a[244:247], v2, s[8:11], s22 offen offset:1024 sc1
  buffer_load_dwordx4 a[248:251], v2, s[8:11], s22 offen offset:2048 sc1
  buffer_load_dwordx4 a[252:255], v2, s[8:11], s22 offen offset:3072 sc1
  s_add_u32 s22, s31, 323584
  buffer_load_dwordx4 v[120:123], v2, s[8:11], s22 offen offset:0 sc1
  buffer_load_dwordx4 v[124:127], v2, s[8:11], s22 offen offset:1024 sc1
  buffer_load_dwordx4 v[128:131], v2, s[8:11], s22 offen offset:2048 sc1
  buffer_load_dwordx4 v[132:135], v2, s[8:11], s22 offen offset:3072 sc1
  s_add_u32 s22, s31, 327680
  buffer_load_dwordx4 v[136:139], v2, s[8:11], s22 offen offset:0 sc1
  buffer_load_dwordx4 v[140:143], v2, s[8:11], s22 offen offset:1024 sc1
  buffer_load_dwordx4 v[144:147], v2, s[8:11], s22 offen offset:2048 sc1
  buffer_load_dwordx4 v[148:151], v2, s[8:11], s22 offen offset:3072 sc1
  s_add_u32 s22, s31, 331776
  buffer_load_dwordx4 v[152:155], v2, s[8:11], s22 offen offset:0 sc1
  buffer_load_dwordx4 v[156:159], v2, s[8:11], s22 offen offset:1024 sc1
  buffer_load_dwordx4 v[160:163], v2, s[8:11], s22 offen offset:2048 sc1
  buffer_load_dwordx4 v[164:167], v2, s[8:11], s22 offen offset:3072 sc1
  s_add_u32 s22, s31, 335872
  buffer_load_dwordx4 v[168:171], v2, s[8:11], s22 offen offset:0 sc1
  buffer_load_dwordx4 v[172:175], v2, s[8:11], s22 offen offset:1024 sc1
  buffer_load_dwordx4 v[176:179], v2, s[8:11], s22 offen offset:2048 sc1
  buffer_load_dwordx4 v[180:183], v2, s[8:11], s22 offen offset:3072 sc1
  s_add_u32 s22, s31, 339968
  buffer_load_dwordx4 v[184:187], v2, s[8:11], s22 offen offset:0 sc1
  buffer_load_dwordx4 v[188:191], v2, s[8:11], s22 offen offset:1024 sc1
  buffer_load_dwordx4 v[192:195], v2, s[8:11], s22 offen offset:2048 sc1
  buffer_load_dwordx4 v[196:199], v2, s[8:11], s22 offen offset:3072 sc1
  s_add_u32 s22, s31, 385024
  buffer_load_dwordx4 v[200:203], v2, s[8:11], s22 offen offset:2048 sc1
  buffer_load_dwordx4 v[204:207], v2, s[8:11], s22 offen offset:3072 sc1
  s_add_u32 s22, s31, 389120
  buffer_load_dwordx4 v[208:211], v2, s[8:11], s22 offen offset:0 sc1
  buffer_load_dwordx4 v[212:215], v2, s[8:11], s22 offen offset:1024 sc1
  s_waitcnt vmcnt(24)
  buffer_load_dwordx4 v[216:219], v2, s[8:11], s22 offen offset:2048 sc1
  buffer_load_dwordx4 v[220:223], v2, s[8:11], s22 offen offset:3072 sc1
  s_add_u32 s22, s31, 393216
  buffer_load_dwordx4 v[224:227], v2, s[8:11], s22 offen offset:0 sc1
  buffer_load_dwordx4 v[228:231], v2, s[8:11], s22 offen offset:1024 sc1
  buffer_load_dwordx4 v[232:235], v2, s[8:11], s22 offen offset:2048 sc1
  buffer_load_dwordx4 v[236:239], v2, s[8:11], s22 offen offset:3072 sc1
  s_add_u32 s22, s31, 397312
  buffer_load_dwordx4 v[240:243], v2, s[8:11], s22 offen offset:0 sc1
  buffer_load_dwordx4 v[244:247], v2, s[8:11], s22 offen offset:1024 sc1
  buffer_load_dwordx4 v[248:251], v2, s[8:11], s22 offen offset:2048 sc1
  buffer_load_dwordx4 v[252:255], v2, s[8:11], s22 offen offset:3072 sc1
  s_mov_b32 s24, 71586816
  s_mov_b32 s25, 0
  s_add_u32 m0, s25, 21504
  s_nop 0
  buffer_load_dwordx4 v2, s[8:11], s24 offen offset:0 sc1 lds
  buffer_load_dwordx4 v2, s[8:11], s24 offen offset:1024 sc1 lds
  buffer_load_dwordx4 v2, s[8:11], s24 offen offset:2048 sc1 lds
  buffer_load_dwordx4 v2, s[8:11], s24 offen offset:3072 sc1 lds
  s_add_u32 m0, s25, 25600
  s_add_u32 s22, s24, 4096
  buffer_load_dwordx4 v2, s[8:11], s22 offen offset:0 sc1 lds
  buffer_load_dwordx4 v2, s[8:11], s22 offen offset:1024 sc1 lds
  buffer_load_dwordx4 v2, s[8:11], s22 offen offset:2048 sc1 lds
  v_and_b32 v64, 7, v117
  v_and_b32 v65, 1, v116
  v_lshlrev_b32 v65, 2, v65
  v_sub_u32 v64, v64, v65
  v_lshrrev_b32 v65, 3, v117
  v_lshl_add_u32 v66, v65, 2, v64
  v_cmp_gt_u32 vcc, 4, v64
  v_mov_b32 v67, 99
  s_nop 0
  v_cndmask_b32 v66, v67, v66, vcc
  v_mov_b32 v68, 0x3f80
  v_mov_b32 v69, 0x3f800000
  v_mov_b32 v4, 0
  v_cmp_eq_u32 vcc, 0, v66
  s_nop 1
  v_cndmask_b32 v4, v4, v68, vcc
  v_cmp_eq_u32 vcc, 1, v66
  s_nop 1
  v_cndmask_b32 v4, v4, v69, vcc
  v_mov_b32 v5, 0
  v_cmp_eq_u32 vcc, 2, v66
  s_nop 1
  v_cndmask_b32 v5, v5, v68, vcc
  v_cmp_eq_u32 vcc, 3, v66
  s_nop 1
  v_cndmask_b32 v5, v5, v69, vcc
  v_mov_b32 v6, 0
  v_cmp_eq_u32 vcc, 4, v66
  s_nop 1
  v_cndmask_b32 v6, v6, v68, vcc
  v_cmp_eq_u32 vcc, 5, v66
  s_nop 1
  v_cndmask_b32 v6, v6, v69, vcc
  v_mov_b32 v7, 0
  v_cmp_eq_u32 vcc, 6, v66
  s_nop 1
  v_cndmask_b32 v7, v7, v68, vcc
  v_cmp_eq_u32 vcc, 7, v66
  s_nop 1
  v_cndmask_b32 v7, v7, v69, vcc
  v_lshrrev_b32 v64, 1, v116
  v_lshrrev_b32 v65, 3, v117
  v_cmp_eq_u32 s[26:27], v64, v65
  v_and_b32 v66, 1, v116
  v_add_u32 v64, 6, v64
  v_lshrrev_b32 v67, 1, v116
  v_lshlrev_b32 v67, 8, v67
  v_lshl_add_u32 v67, v66, 9, v67
  v_lshl_add_u32 v67, v117, 4, v67
  v_add_u32 v112, 60416, v67
  v_and_b32 v68, 7, v117
  v_lshlrev_b32 v67, 8, v64
  v_lshl_add_u32 v67, v68, 5, v67
  v_lshl_add_u32 v67, v66, 4, v67
  v_add_u32 v113, 65536, v67
  v_lshrrev_b32 v64, 5, v1
  v_and_b32 v65, 31, v1
  v_lshrrev_b32 v66, 3, v65
  v_and_b32 v67, 7, v65
  v_and_b32 v68, 3, v67
  v_lshl_add_u32 v68, v66, 2, v68
  v_lshrrev_b32 v69, 2, v67
  v_lshl_add_u32 v68, v69, 4, v68
  v_lshlrev_b32 v69, 11, v64
  v_lshl_add_u32 v69, v68, 4, v69
  v_add_u32 v114, 57864, v69
  v_add_u32 v70, 6, v64
  v_lshlrev_b32 v69, 9, v66
  v_lshl_add_u32 v69, v70, 5, v69
  v_lshl_add_u32 v69, v67, 2, v69
  v_add_u32 v115, 65536, v69
  v_and_b32 v71, 1, v1
  v_cmp_eq_u32 s[38:39], 0, v71
  v_cmp_gt_u32 vcc, 8, v65
  s_or_b64 s[28:29], s[38:39], vcc
  v_lshrrev_b32 v72, 1, v67
  v_lshlrev_b32 v72, 2, v72
  v_lshl_add_u32 v72, v70, 4, v72
  s_lshl_b32 s22, s17, 9
  s_add_u32 s22, s22, 9216
  v_lshl_add_u32 v73, v66, 7, v72
  v_add_u32 v73, s22, v73
  s_lshl_b32 s22, s17, 7
  s_add_u32 s22, s22, 7168
  v_add_u32 v74, s22, v72
  v_bfe_u32 v72, v65, 1, 1
  v_lshlrev_b32 v72, 7, v72
  v_lshl_add_u32 v72, v70, 4, v72
  v_bfe_u32 v73, v65, 2, 2
  v_lshl_add_u32 v72, v73, 2, v72
  v_lshrrev_b32 v73, 4, v65
  v_lshl_add_u32 v73, v73, 8, v72
  s_lshl_b32 s22, s17, 9
  s_add_u32 s22, s22, 9216
  v_add_u32 v73, s22, v73
  s_lshr_b32 s22, s17, 1
  s_lshl_b32 s22, s22, 8
  s_and_b32 s34, s17, 1
  s_lshl_b32 s34, s34, 3
  s_add_u32 s22, s22, s34
  s_add_u32 s22, s22, 7168
  v_add_u32 v74, s22, v72
  v_lshlrev_b32 v0, 2, v65
  s_and_b32 s22, s17, 31
  s_lshl_b32 s22, s22, 7
  s_add_u32 s22, s22, 21504
  v_add_u32 v0, s22, v0
  v_cndmask_b32 v1, v74, v73, s[38:39]
  s_lshl_b32 s36, s17, 2
  s_add_u32 s36, s36, 17408
  s_mov_b32 s37, 0x3e800000
  v_mov_b32 v64, 0
  v_mov_b32 v65, 0
  v_mov_b32 v66, 0
  v_mov_b32 v67, 0
  v_mov_b32 v68, 0
  v_mov_b32 v69, 0
  v_mov_b32 v70, 0
  v_mov_b32 v71, 0
  v_mov_b32 v72, 0
  v_mov_b32 v73, 0
  v_mov_b32 v74, 0
  v_mov_b32 v75, 0
  v_mov_b32 v76, 0
  v_mov_b32 v77, 0
  v_mov_b32 v78, 0
  v_mov_b32 v79, 0
  v_mov_b32 v80, 0
  v_mov_b32 v81, 0
  v_mov_b32 v82, 0
  v_mov_b32 v83, 0
  v_mov_b32 v84, 0
  v_mov_b32 v85, 0
  v_mov_b32 v86, 0
  v_mov_b32 v87, 0
  v_mov_b32 v88, 0
  v_mov_b32 v89, 0
  v_mov_b32 v90, 0
  v_mov_b32 v91, 0
  v_mov_b32 v92, 0
  v_mov_b32 v93, 0
  v_mov_b32 v94, 0
  v_mov_b32 v95, 0
  v_mov_b32 v96, 0
  v_mov_b32 v97, 0
  v_mov_b32 v98, 0
  v_mov_b32 v99, 0
  v_mov_b32 v100, 0
  v_mov_b32 v101, 0
  v_mov_b32 v102, 0
  v_mov_b32 v103, 0
  v_mov_b32 v104, 0
  v_mov_b32 v105, 0
  v_mov_b32 v106, 0
  v_mov_b32 v107, 0
  v_mov_b32 v108, 0
  v_mov_b32 v109, 0
  v_mov_b32 v110, 0
  v_mov_b32 v111, 0
  v_mov_b32 v116, v2
  v_lshrrev_b32 v117, 4, v2
  v_min_u32 v117, 55, v117
  v_lshlrev_b32 v117, 7, v117
  s_mul_i32 s35, s17, 1835008
  s_add_u32 s35, s35, 42284032
  s_mov_b32 s30, 0
  v_mov_b32 v36, 0
ch_md3:
  buffer_load_dword v37, v36, s[12:15], 0 offen sc1
  s_waitcnt vmcnt(0)
  v_readfirstlane_b32 s22, v37
  s_and_b32 s31, s22, 0xffff
  s_cmp_ge_u32 s31, 32
  s_cbranch_scc1 ch_go3
  s_sleep 2
  s_add_u32 s30, s30, 1
  s_cmp_lt_u32 s30, 50000
  s_cbranch_scc1 ch_md3
  s_branch ch_end
ch_go3:
  s_mov_b32 s31, 0
  s_lshr_b32 s22, s22, 16
  s_cmp_lg_u32 s22, 0
  s_cbranch_scc1 cB_sc3_loop
  s_branch cA_sc3_loop
ch_init4:
  s_mul_i32 s31, s17, 401408
  s_add_u32 s31, s31, 6422528
  s_mul_i32 s22, s17, 28
  s_add_u32 s23, s22, 27
  s_lshr_b32 s22, s22, 6
  s_lshr_b32 s23, s23, 6
  s_sub_u32 s23, s23, s22
  s_lshl_b32 s23, s23, 8
  v_and_b32 v36, s23, v2
  v_med3_u32 v37, v117, 0, 3
  v_lshl_add_u32 v36, v37, 4, v36
  s_lshl_b32 s22, s22, 8
  s_add_u32 s22, s22, 88588288
  s_mov_b32 s30, 0
va_bw_11:
  buffer_load_dwordx4 v[40:43], v36, s[8:11], s22 offen sc1
  s_waitcnt vmcnt(0)
  v_cmp_ne_u64 vcc, s[88:89], v[40:41]
  s_cbranch_vccnz va_bw_11_no
  v_cmp_ne_u64 vcc, s[88:89], v[42:43]
  s_cbranch_vccnz va_bw_11_no
  s_branch va_bw_11_ok
va_bw_11_no:
  s_sleep 2
  s_add_u32 s30, s30, 1
  s_cmp_lt_u32 s30, 50000
  s_cbranch_scc1 va_bw_11
  s_branch cA_abort
va_bw_11_ok:
  s_add_u32 s22, s31, 0
  buffer_load_dwordx4 a[0:3], v2, s[8:11], s22 offen offset:0 sc1
  buffer_load_dwordx4 a[4:7], v2, s[8:11], s22 offen offset:1024 sc1
  buffer_load_dwordx4 a[8:11], v2, s[8:11], s22 offen offset:2048 sc1
  buffer_load_dwordx4 a[12:15], v2, s[8:11], s22 offen offset:3072 sc1
  s_add_u32 s22, s31, 4096
  buffer_load_dwordx4 a[16:19], v2, s[8:11], s22 offen offset:0 sc1
  buffer_load_dwordx4 a[20:23], v2, s[8:11], s22 offen offset:1024 sc1
  buffer_load_dwordx4 a[24:27], v2, s[8:11], s22 offen offset:2048 sc1
  buffer_load_dwordx4 a[28:31], v2, s[8:11], s22 offen offset:3072 sc1
  s_add_u32 s22, s31, 8192
  buffer_load_dwordx4 a[32:35], v2, s[8:11], s22 offen offset:0 sc1
  buffer_load_dwordx4 a[36:39], v2, s[8:11], s22 offen offset:1024 sc1
  buffer_load_dwordx4 a[40:43], v2, s[8:11], s22 offen offset:2048 sc1
  buffer_load_dwordx4 a[44:47], v2, s[8:11], s22 offen offset:3072 sc1
  s_add_u32 s22, s31, 12288
  buffer_load_dwordx4 a[48:51], v2, s[8:11], s22 offen offset:0 sc1
  buffer_load_dwordx4 a[52:55], v2, s[8:11], s22 offen offset:1024 sc1
  buffer_load_dwordx4 a[56:59], v2, s[8:11], s22 offen offset:2048 sc1
  buffer_load_dwordx4 a[60:63], v2, s[8:11], s22 offen offset:3072 sc1
  s_add_u32 s22, s31, 16384
  buffer_load_dwordx4 a[64:67], v2, s[8:11], s22 offen offset:0 sc1
  buffer_load_dwordx4 a[68:71], v2, s[8:11], s22 offen offset:1024 sc1
  buffer_load_dwordx4 a[72:75], v2, s[8:11], s22 offen offset:2048 sc1
  buffer_load_dwordx4 a[76:79], v2, s[8:11], s22 offen offset:3072 sc1
  s_add_u32 s22, s31, 20480
  buffer_load_dwordx4 a[80:83], v2, s[8:11], s22 offen offset:0 sc1
  buffer_load_dwordx4 a[84:87], v2, s[8:11], s22 offen offset:1024 sc1
  buffer_load_dwordx4 a[88:91], v2, s[8:11], s22 offen offset:2048 sc1
  buffer_load_dwordx4 a[92:95], v2, s[8:11], s22 offen offset:3072 sc1
  s_add_u32 s22, s31, 24576
  buffer_load_dwordx4 a[96:99], v2, s[8:11], s22 offen offset:0 sc1
  buffer_load_dwordx4 a[100:103], v2, s[8:11], s22 offen offset:1024 sc1
  buffer_load_dwordx4 a[104:107], v2, s[8:11], s22 offen offset:2048 sc1
  buffer_load_dwordx4 a[108:111], v2, s[8:11], s22 offen offset:3072 sc1
  s_add_u32 s22, s31, 28672
  buffer_load_dwordx4 a[112:115], v2, s[8:11], s22 offen offset:0 sc1
  buffer_load_dwordx4 a[116:119], v2, s[8:11], s22 offen offset:1024 sc1
  buffer_load_dwordx4 a[120:123], v2, s[8:11], s22 offen offset:2048 sc1
  buffer_load_dwordx4 a[124:127], v2, s[8:11], s22 offen offset:3072 sc1
  s_waitcnt vmcnt(24)
  s_add_u32 s22, s31, 32768
  buffer_load_dwordx4 a[128:131], v2, s[8:11], s22 offen offset:0 sc1
  buffer_load_dwordx4 a[132:135], v2, s[8:11], s22 offen offset:1024 sc1
  buffer_load_dwordx4 a[136:139], v2, s[8:11], s22 offen offset:2048 sc1
  buffer_load_dwordx4 a[140:143], v2, s[8:11], s22 offen offset:3072 sc1
  s_add_u32 s22, s31, 36864
  buffer_load_dwordx4 a[144:147], v2, s[8:11], s22 offen offset:0 sc1
  buffer_load_dwordx4 a[148:151], v2, s[8:11], s22 offen offset:1024 sc1
  buffer_load_dwordx4 a[152:155], v2, s[8:11], s22 offen offset:2048 sc1
  buffer_load_dwordx4 a[156:159], v2, s[8:11], s22 offen offset:3072 sc1
  s_add_u32 s22, s31, 40960
  buffer_load_dwordx4 a[160:163], v2, s[8:11], s22 offen offset:0 sc1
  buffer_load_dwordx4 a[164:167], v2, s[8:11], s22 offen offset:1024 sc1
  buffer_load_dwordx4 a[168:171], v2, s[8:11], s22 offen offset:2048 sc1
  buffer_load_dwordx4 a[172:175], v2, s[8:11], s22 offen offset:3072 sc1
  s_add_u32 s22, s31, 45056
  buffer_load_dwordx4 a[176:179], v2, s[8:11], s22 offen offset:0 sc1
  buffer_load_dwordx4 a[180:183], v2, s[8:11], s22 offen offset:1024 sc1
  buffer_load_dwordx4 a[184:187], v2, s[8:11], s22 offen offset:2048 sc1
  buffer_load_dwordx4 a[188:191], v2, s[8:11], s22 offen offset:3072 sc1
  s_add_u32 s22, s31, 49152
  buffer_load_dwordx4 a[192:195], v2, s[8:11], s22 offen offset:0 sc1
  buffer_load_dwordx4 a[196:199], v2, s[8:11], s22 offen offset:1024 sc1
  buffer_load_dwordx4 a[200:203], v2, s[8:11], s22 offen offset:2048 sc1
  buffer_load_dwordx4 a[204:207], v2, s[8:11], s22 offen offset:3072 sc1
  s_add_u32 s22, s31, 53248
  buffer_load_dwordx4 a[208:211], v2, s[8:11], s22 offen offset:0 sc1
  buffer_load_dwordx4 a[212:215], v2, s[8:11], s22 offen offset:1024 sc1
  buffer_load_dwordx4 a[216:219], v2, s[8:11], s22 offen offset:2048 sc1
  buffer_load_dwordx4 a[220:223], v2, s[8:11], s22 offen offset:3072 sc1
  s_add_u32 s22, s31, 57344
  buffer_load_dwordx4 a[224:227], v2, s[8:11], s22 offen offset:0 sc1
  buffer_load_dwordx4 a[228:231], v2, s[8:11], s22 offen offset:1024 sc1
  buffer_load_dwordx4 a[232:235], v2, s[8:11], s22 offen offset:2048 sc1
  buffer_load_dwordx4 a[236:239], v2, s[8:11], s22 offen offset:3072 sc1
  s_add_u32 s22, s31, 61440
  buffer_load_dwordx4 a[240:243], v2, s[8:11], s22 offen offset:0 sc1
  buffer_load_dwordx4 a[244:247], v2, s[8:11], s22 offen offset:1024 sc1
  buffer_load_dwordx4 a[248:251], v2, s[8:11], s22 offen offset:2048 sc1
  buffer_load_dwordx4 a[252:255], v2, s[8:11], s22 offen offset:3072 sc1
  s_waitcnt vmcnt(24)
  s_add_u32 s22, s31, 65536
  buffer_load_dwordx4 v[176:179], v2, s[8:11], s22 offen offset:0 sc1
  buffer_load_dwordx4 v[180:183], v2, s[8:11], s22 offen offset:1024 sc1
  buffer_load_dwordx4 v[184:187], v2, s[8:11], s22 offen offset:2048 sc1
  buffer_load_dwordx4 v[188:191], v2, s[8:11], s22 offen offset:3072 sc1
  s_add_u32 s22, s31, 69632
  buffer_load_dwordx4 v[192:195], v2, s[8:11], s22 offen offset:0 sc1
  buffer_load_dwordx4 v[196:199], v2, s[8:11], s22 offen offset:1024 sc1
  buffer_load_dwordx4 v[200:203], v2, s[8:11], s22 offen offset:2048 sc1
  buffer_load_dwordx4 v[204:207], v2, s[8:11], s22 offen offset:3072 sc1
  s_add_u32 s22, s31, 73728
  buffer_load_dwordx4 v[208:211], v2, s[8:11], s22 offen offset:0 sc1
  buffer_load_dwordx4 v[212:215], v2, s[8:11], s22 offen offset:1024 sc1
  buffer_load_dwordx4 v[216:219], v2, s[8:11], s22 offen offset:2048 sc1
  buffer_load_dwordx4 v[220:223], v2, s[8:11], s22 offen offset:3072 sc1
  s_add_u32 s22, s31, 77824
  buffer_load_dwordx4 v[224:227], v2, s[8:11], s22 offen offset:0 sc1
  buffer_load_dwordx4 v[228:231], v2, s[8:11], s22 offen offset:1024 sc1
  buffer_load_dwordx4 v[232:235], v2, s[8:11], s22 offen offset:2048 sc1
  buffer_load_dwordx4 v[236:239], v2, s[8:11], s22 offen offset:3072 sc1
  s_add_u32 s22, s31, 81920
  buffer_load_dwordx4 v[240:243], v2, s[8:11], s22 offen offset:0 sc1
  buffer_load_dwordx4 v[244:247], v2, s[8:11], s22 offen offset:1024 sc1
  buffer_load_dwordx4 v[248:251], v2, s[8:11], s22 offen offset:2048 sc1
  buffer_load_dwordx4 v[252:255], v2, s[8:11], s22 offen offset:3072 sc1
  s_mul_i32 s22, s17, 28
  s_add_u32 s23, s22, 27
  s_lshr_b32 s22, s22, 6
  s_lshr_b32 s23, s23, 6
  s_sub_u32 s23, s23, s22
  s_lshl_b32 s23, s23, 8
  v_and_b32 v36, s23, v2
  v_med3_u32 v37, v117, 10, 11
  v_lshl_add_u32 v36, v37, 4, v36
  s_lshl_b32 s22, s22, 8
  s_add_u32 s22, s22, 88588288
  s_mov_b32 s30, 0
va_bw_12:
  buffer_load_dwordx4 v[40:43], v36, s[8:11], s22 offen sc1
  s_waitcnt vmcnt(0)
  v_cmp_ne_u64 vcc, s[88:89], v[40:41]
  s_cbranch_vccnz va_bw_12_no
  v_cmp_ne_u64 vcc, s[88:89], v[42:43]
  s_cbranch_vccnz va_bw_12_no
  s_branch va_bw_12_ok
va_bw_12_no:
  s_sleep 2
  s_add_u32 s30, s30, 1
  s_cmp_lt_u32 s30, 50000
  s_cbranch_scc1 va_bw_12
  s_branch cA_abort
va_bw_12_ok:
  s_mov_b32 m0, 16384
  s_add_u32 s22, s31, 272384
  buffer_load_dwordx4 v2, s[8:11], s22 offen offset:0 sc1 lds
  buffer_load_dwordx4 v2, s[8:11], s22 offen offset:1024 sc1 lds
  buffer_load_dwordx4 v2, s[8:11], s22 offen offset:2048 sc1 lds
  buffer_load_dwordx4 v2, s[8:11], s22 offen offset:3072 sc1 lds
  s_mov_b32 m0, 20480
  s_add_u32 s22, s31, 276480
  buffer_load_dwordx4 v2, s[8:11], s22 offen offset:0 sc1 lds
  buffer_load_dwordx4 v2, s[8:11], s22 offen offset:1024 sc1 lds
  buffer_load_dwordx4 v2, s[8:11], s22 offen offset:2048 sc1 lds
  buffer_load_dwordx4 v2, s[8:11], s22 offen offset:3072 sc1 lds
  s_mov_b32 m0, 24576
  s_add_u32 s22, s31, 280576
  buffer_load_dwordx4 v2, s[8:11], s22 offen offset:0 sc1 lds
  buffer_load_dwordx4 v2, s[8:11], s22 offen offset:1024 sc1 lds
  buffer_load_dwordx4 v2, s[8:11], s22 offen offset:2048 sc1 lds
  buffer_load_dwordx4 v2, s[8:11], s22 offen offset:3072 sc1 lds
  s_mov_b32 m0, 28672
  s_add_u32 s22, s31, 284672
  buffer_load_dwordx4 v2, s[8:11], s22 offen offset:0 sc1 lds
  buffer_load_dwordx4 v2, s[8:11], s22 offen offset:1024 sc1 lds
  v_mov_b32 v72, v116
  v_mov_b32 v73, v117
  v_lshrrev_b32 v65, 1, v72
  v_and_b32 v66, 1, v72
  v_add_u32 v67, 0, v65
  v_lshl_add_u32 v67, v67, 4, v73
  v_mul_u32_u24 v68, 2341, v67
  v_lshrrev_b32 v68, 16, v68
  v_mul_u32_u24 v69, 28, v68
  v_sub_u32 v69, v67, v69
  v_lshrrev_b32 v70, 4, v69
  v_and_b32 v69, 15, v69
  v_and_b32 v71, 1, v69
  v_lshrrev_b32 v69, 1, v69
  v_lshl_add_u32 v69, v71, 3, v69
  v_lshlrev_b32 v71, 12, v70
  v_lshl_add_u32 v71, v68, 8, v71
  v_lshl_add_u32 v71, v69, 4, v71
  v_lshl_add_u32 v60, v66, 3, v71
  v_add_u32 v67, 2, v65
  v_lshl_add_u32 v67, v67, 4, v73
  v_mul_u32_u24 v68, 2341, v67
  v_lshrrev_b32 v68, 16, v68
  v_mul_u32_u24 v69, 28, v68
  v_sub_u32 v69, v67, v69
  v_lshrrev_b32 v70, 4, v69
  v_and_b32 v69, 15, v69
  v_and_b32 v71, 1, v69
  v_lshrrev_b32 v69, 1, v69
  v_lshl_add_u32 v69, v71, 3, v69
  v_lshlrev_b32 v71, 12, v70
  v_lshl_add_u32 v71, v68, 8, v71
  v_lshl_add_u32 v71, v69, 4, v71
  v_lshl_add_u32 v61, v66, 3, v71
  v_add_u32 v67, 4, v65
  v_lshl_add_u32 v67, v67, 4, v73
  v_mul_u32_u24 v68, 2341, v67
  v_lshrrev_b32 v68, 16, v68
  v_mul_u32_u24 v69, 28, v68
  v_sub_u32 v69, v67, v69
  v_lshrrev_b32 v70, 4, v69
  v_and_b32 v69, 15, v69
  v_and_b32 v71, 1, v69
  v_lshrrev_b32 v69, 1, v69
  v_lshl_add_u32 v69, v71, 3, v69
  v_lshlrev_b32 v71, 12, v70
  v_lshl_add_u32 v71, v68, 8, v71
  v_lshl_add_u32 v71, v69, 4, v71
  v_lshl_add_u32 v62, v66, 3, v71
  v_and_b32 v0, 31, v1
  v_lshlrev_b32 v0, 2, v0
  v_add_u32 v0, 21504, v0
  v_lshlrev_b32 v4, 2, v73
  s_and_b32 s22, s17, 15
  s_lshl_b32 s22, s22, 7
  s_add_u32 s22, s22, 17408
  v_add_u32 v4, s22, v4
  v_and_b32 v64, 7, v73
  v_lshlrev_b32 v5, 4, v64
  v_lshl_add_u32 v5, v72, 7, v5
  v_lshrrev_b32 v65, 3, v73
  v_lshl_add_u32 v5, v65, 9, v5
  s_lshl_b32 s22, s17, 3
  s_add_u32 s22, s22, 21504
  v_lshl_add_u32 v7, v2, 3, s22
  v_add_u32 v65, 0, v73
  v_min_u32 v65, 27, v65
  v_mad_u32_u24 v65, v72, 28, v65
  v_lshlrev_b32 v6, 4, v65
  s_lshr_b32 s22, s17, 1
  s_mul_i32 s22, s22, 7
  s_and_b32 s34, s17, 1
  s_lshl_b32 s35, s34, 2
  v_add_u32 v70, s35, v72
  v_mov_b32 v71, s34
  v_mov_b32 v69, 0
  v_cmp_eq_u32 vcc, 3, v72
  s_nop 1
  v_cndmask_b32 v70, v70, v72, vcc
  v_cndmask_b32 v69, v69, v71, vcc
  v_add_u32 v70, s22, v70
  v_lshrrev_b32 v68, 1, v70
  v_lshlrev_b32 v68, 8, v68
  v_lshl_add_u32 v68, v69, 7, v68
  v_and_b32 v69, 1, v70
  v_lshl_add_u32 v68, v69, 3, v68
  v_lshl_add_u32 v1, v64, 4, v68
  v_cmp_gt_u32 s[26:27], 8, v73
  v_lshrrev_b32 v65, 3, v73
  v_lshl_add_u32 v66, v64, 1, v65
  v_add_u32 v66, 0, v66
  v_min_u32 v66, 27, v66
  v_mad_u32_u24 v66, v72, 28, v66
  v_lshlrev_b32 v6, 4, v66
  s_mul_i32 s22, s17, 28
  s_add_u32 s22, s22, 0
  v_lshl_add_u32 v70, v64, 1, s22
  v_lshrrev_b32 v68, 4, v70
  v_lshlrev_b32 v68, 8, v68
  v_bfe_u32 v69, v70, 1, 1
  v_lshl_add_u32 v68, v69, 7, v68
  v_bfe_u32 v69, v70, 2, 2
  v_lshl_add_u32 v68, v69, 2, v68
  v_and_b32 v69, 1, v72
  v_lshl_add_u32 v65, v69, 2, v65
  v_lshrrev_b32 v69, 1, v72
  v_lshl_add_u32 v65, v69, 1, v65
  v_lshl_add_u32 v1, v65, 4, v68
  v_cmp_gt_u32 s[26:27], 6, v64
  v_mov_b32 v156, 0
  v_mov_b32 v157, 0
  v_mov_b32 v158, 0
  v_mov_b32 v159, 0
  ds_write_b128 v2, v[156:159] offset:0
  ds_write_b128 v2, v[156:159] offset:1024
  ds_write_b128 v2, v[156:159] offset:2048
  ds_write_b128 v2, v[156:159] offset:3072
  s_mul_i32 s22, s17, 1835008
  s_add_u32 s25, s22, 42205184
  s_lshl_b32 s35, s17, 7
  s_add_u32 s35, s35, 88526848
  s_mov_b32 s38, 0
  v_mov_b32 v175, 0
  s_lshl_b32 s22, 0, 11
  s_add_u32 s22, s22, 88590336
  v_add_u32 v36, 1024, v2
  v_min_u32 v36, 1776, v36
  s_mov_b32 s30, 0
va_iw4:
  buffer_load_dwordx4 v[40:43], v2, s[8:11], s22 offen sc1
  buffer_load_dwordx4 v[44:47], v36, s[8:11], s22 offen sc1
  s_waitcnt vmcnt(0)
  v_cmp_ne_u64 vcc, s[88:89], v[40:41]
  s_cbranch_vccnz va_iw4_no
  v_cmp_ne_u64 vcc, s[88:89], v[42:43]
  s_cbranch_vccnz va_iw4_no
  v_cmp_ne_u64 vcc, s[88:89], v[44:45]
  s_cbranch_vccnz va_iw4_no
  v_cmp_ne_u64 vcc, s[88:89], v[46:47]
  s_cbranch_vccnz va_iw4_no
  s_branch va_iw4_ok
va_iw4_no:
  s_sleep 2
  s_add_u32 s30, s30, 1
  s_cmp_lt_u32 s30, 50000
  s_cbranch_scc1 va_iw4
  s_branch cA_abort
va_iw4_ok:
  s_mov_b32 s30, 0
  v_mov_b32 v36, 0
ch_md4:
  buffer_load_dword v37, v36, s[12:15], 0 offen sc1
  s_waitcnt vmcnt(0)
  v_readfirstlane_b32 s22, v37
  s_and_b32 s31, s22, 0xffff
  s_cmp_ge_u32 s31, 32
  s_cbranch_scc1 ch_go4
  s_sleep 2
  s_add_u32 s30, s30, 1
  s_cmp_lt_u32 s30, 50000
  s_cbranch_scc1 ch_md4
  s_branch ch_end
ch_go4:
  s_mov_b32 s31, 0
  v_mov_b32 v36, 0
  v_mov_b32 v37, 0
  v_mov_b32 v38, 0
  v_mov_b32 v39, 0
  v_mov_b32 v40, 0
  v_mov_b32 v41, 0
  v_mov_b32 v42, 0
  v_mov_b32 v43, 0
  v_mov_b32 v44, 0
  v_mov_b32 v45, 0
  v_mov_b32 v46, 0
  v_mov_b32 v47, 0
  v_mov_b32 v48, 0
  v_mov_b32 v49, 0
  v_mov_b32 v50, 0
  v_mov_b32 v51, 0
  v_mov_b32 v52, 0
  v_mov_b32 v53, 0
  v_mov_b32 v54, 0
  v_mov_b32 v55, 0
  v_mov_b32 v56, 0
  v_mov_b32 v57, 0
  v_mov_b32 v58, 0
  v_mov_b32 v59, 0
  s_lshr_b32 s22, s22, 16
  s_cmp_lg_u32 s22, 0
  s_cbranch_scc1 cB_va0_loop
  s_branch cA_va0_loop
ch_init5:
  s_mul_i32 s31, s17, 401408
  s_add_u32 s31, s31, 6422528
  s_mul_i32 s22, s17, 28
  s_add_u32 s23, s22, 27
  s_lshr_b32 s22, s22, 6
  s_lshr_b32 s23, s23, 6
  s_sub_u32 s23, s23, s22
  s_lshl_b32 s23, s23, 8
  v_and_b32 v36, s23, v2
  v_med3_u32 v37, v117, 3, 6
  v_lshl_add_u32 v36, v37, 4, v36
  s_lshl_b32 s22, s22, 8
  s_add_u32 s22, s22, 88588288
  s_mov_b32 s30, 0
va_bw_13:
  buffer_load_dwordx4 v[40:43], v36, s[8:11], s22 offen sc1
  s_waitcnt vmcnt(0)
  v_cmp_ne_u64 vcc, s[88:89], v[40:41]
  s_cbranch_vccnz va_bw_13_no
  v_cmp_ne_u64 vcc, s[88:89], v[42:43]
  s_cbranch_vccnz va_bw_13_no
  s_branch va_bw_13_ok
va_bw_13_no:
  s_sleep 2
  s_add_u32 s30, s30, 1
  s_cmp_lt_u32 s30, 50000
  s_cbranch_scc1 va_bw_13
  s_branch cA_abort
va_bw_13_ok:
  s_add_u32 s22, s31, 86016
  buffer_load_dwordx4 a[0:3], v2, s[8:11], s22 offen offset:0 sc1
  buffer_load_dwordx4 a[4:7], v2, s[8:11], s22 offen offset:1024 sc1
  buffer_load_dwordx4 a[8:11], v2, s[8:11], s22 offen offset:2048 sc1
  buffer_load_dwordx4 a[12:15], v2, s[8:11], s22 offen offset:3072 sc1
  s_add_u32 s22, s31, 90112
  buffer_load_dwordx4 a[16:19], v2, s[8:11], s22 offen offset:0 sc1
  buffer_load_dwordx4 a[20:23], v2, s[8:11], s22 offen offset:1024 sc1
  buffer_load_dwordx4 a[24:27], v2, s[8:11], s22 offen offset:2048 sc1
  buffer_load_dwordx4 a[28:31], v2, s[8:11], s22 offen offset:3072 sc1
  s_add_u32 s22, s31, 94208
  buffer_load_dwordx4 a[32:35], v2, s[8:11], s22 offen offset:0 sc1
  buffer_load_dwordx4 a[36:39], v2, s[8:11], s22 offen offset:1024 sc1
  buffer_load_dwordx4 a[40:43], v2, s[8:11], s22 offen offset:2048 sc1
  buffer_load_dwordx4 a[44:47], v2, s[8:11], s22 offen offset:3072 sc1
  s_add_u32 s22, s31, 98304
  buffer_load_dwordx4 a[48:51], v2, s[8:11], s22 offen offset:0 sc1
  buffer_load_dwordx4 a[52:55], v2, s[8:11], s22 offen offset:1024 sc1
  buffer_load_dwordx4 a[56:59], v2, s[8:11], s22 offen offset:2048 sc1
  buffer_load_dwordx4 a[60:63], v2, s[8:11], s22 offen offset:3072 sc1
  s_add_u32 s22, s31, 102400
  buffer_load_dwordx4 a[64:67], v2, s[8:11], s22 offen offset:0 sc1
  buffer_load_dwordx4 a[68:71], v2, s[8:11], s22 offen offset:1024 sc1
  buffer_load_dwordx4 a[72:75], v2, s[8:11], s22 offen offset:2048 sc1
  buffer_load_dwordx4 a[76:79], v2, s[8:11], s22 offen offset:3072 sc1
  s_add_u32 s22, s31, 106496
  buffer_load_dwordx4 a[80:83], v2, s[8:11], s22 offen offset:0 sc1
  buffer_load_dwordx4 a[84:87], v2, s[8:11], s22 offen offset:1024 sc1
  buffer_load_dwordx4 a[88:91], v2, s[8:11], s22 offen offset:2048 sc1
  buffer_load_dwordx4 a[92:95], v2, s[8:11], s22 offen offset:3072 sc1
  s_add_u32 s22, s31, 110592
  buffer_load_dwordx4 a[96:99], v2, s[8:11], s22 offen offset:0 sc1
  buffer_load_dwordx4 a[100:103], v2, s[8:11], s22 offen offset:1024 sc1
  buffer_load_dwordx4 a[104:107], v2, s[8:11], s22 offen offset:2048 sc1
  buffer_load_dwordx4 a[108:111], v2, s[8:11], s22 offen offset:3072 sc1
  s_add_u32 s22, s31, 114688
  buffer_load_dwordx4 a[112:115], v2, s[8:11], s22 offen offset:0 sc1
  buffer_load_dwordx4 a[116:119], v2, s[8:11], s22 offen offset:1024 sc1
  buffer_load_dwordx4 a[120:123], v2, s[8:11], s22 offen offset:2048 sc1
  buffer_load_dwordx4 a[124:127], v2, s[8:11], s22 offen offset:3072 sc1
  s_waitcnt vmcnt(24)
  s_add_u32 s22, s31, 118784
  buffer_load_dwordx4 a[128:131], v2, s[8:11], s22 offen offset:0 sc1
  buffer_load_dwordx4 a[132:135], v2, s[8:11], s22 offen offset:1024 sc1
  buffer_load_dwordx4 a[136:139], v2, s[8:11], s22 offen offset:2048 sc1
  buffer_load_dwordx4 a[140:143], v2, s[8:11], s22 offen offset:3072 sc1
  s_add_u32 s22, s31, 122880
  buffer_load_dwordx4 a[144:147], v2, s[8:11], s22 offen offset:0 sc1
  buffer_load_dwordx4 a[148:151], v2, s[8:11], s22 offen offset:1024 sc1
  buffer_load_dwordx4 a[152:155], v2, s[8:11], s22 offen offset:2048 sc1
  buffer_load_dwordx4 a[156:159], v2, s[8:11], s22 offen offset:3072 sc1
  s_add_u32 s22, s31, 126976
  buffer_load_dwordx4 a[160:163], v2, s[8:11], s22 offen offset:0 sc1
  buffer_load_dwordx4 a[164:167], v2, s[8:11], s22 offen offset:1024 sc1
  buffer_load_dwordx4 a[168:171], v2, s[8:11], s22 offen offset:2048 sc1
  buffer_load_dwordx4 a[172:175], v2, s[8:11], s22 offen offset:3072 sc1
  s_add_u32 s22, s31, 131072
  buffer_load_dwordx4 a[176:179], v2, s[8:11], s22 offen offset:0 sc1
  buffer_load_dwordx4 a[180:183], v2, s[8:11], s22 offen offset:1024 sc1
  buffer_load_dwordx4 a[184:187], v2, s[8:11], s22 offen offset:2048 sc1
  buffer_load_dwordx4 a[188:191], v2, s[8:11], s22 offen offset:3072 sc1
  s_add_u32 s22, s31, 135168
  buffer_load_dwordx4 a[192:195], v2, s[8:11], s22 offen offset:0 sc1
  buffer_load_dwordx4 a[196:199], v2, s[8:11], s22 offen offset:1024 sc1
  buffer_load_dwordx4 a[200:203], v2, s[8:11], s22 offen offset:2048 sc1
  buffer_load_dwordx4 a[204:207], v2, s[8:11], s22 offen offset:3072 sc1
  s_add_u32 s22, s31, 139264
  buffer_load_dwordx4 a[208:211], v2, s[8:11], s22 offen offset:0 sc1
  buffer_load_dwordx4 a[212:215], v2, s[8:11], s22 offen offset:1024 sc1
  buffer_load_dwordx4 a[216:219], v2, s[8:11], s22 offen offset:2048 sc1
  buffer_load_dwordx4 a[220:223], v2, s[8:11], s22 offen offset:3072 sc1
  s_add_u32 s22, s31, 143360
  buffer_load_dwordx4 a[224:227], v2, s[8:11], s22 offen offset:0 sc1
  buffer_load_dwordx4 a[228:231], v2, s[8:11], s22 offen offset:1024 sc1
  buffer_load_dwordx4 a[232:235], v2, s[8:11], s22 offen offset:2048 sc1
  buffer_load_dwordx4 a[236:239], v2, s[8:11], s22 offen offset:3072 sc1
  s_add_u32 s22, s31, 147456
  buffer_load_dwordx4 a[240:243], v2, s[8:11], s22 offen offset:0 sc1
  buffer_load_dwordx4 a[244:247], v2, s[8:11], s22 offen offset:1024 sc1
  buffer_load_dwordx4 a[248:251], v2, s[8:11], s22 offen offset:2048 sc1
  buffer_load_dwordx4 a[252:255], v2, s[8:11], s22 offen offset:3072 sc1
  s_waitcnt vmcnt(24)
  s_add_u32 s22, s31, 151552
  buffer_load_dwordx4 v[176:179], v2, s[8:11], s22 offen offset:0 sc1
  buffer_load_dwordx4 v[180:183], v2, s[8:11], s22 offen offset:1024 sc1
  buffer_load_dwordx4 v[184:187], v2, s[8:11], s22 offen offset:2048 sc1
  buffer_load_dwordx4 v[188:191], v2, s[8:11], s22 offen offset:3072 sc1
  s_add_u32 s22, s31, 155648
  buffer_load_dwordx4 v[192:195], v2, s[8:11], s22 offen offset:0 sc1
  buffer_load_dwordx4 v[196:199], v2, s[8:11], s22 offen offset:1024 sc1
  buffer_load_dwordx4 v[200:203], v2, s[8:11], s22 offen offset:2048 sc1
  buffer_load_dwordx4 v[204:207], v2, s[8:11], s22 offen offset:3072 sc1
  s_add_u32 s22, s31, 159744
  buffer_load_dwordx4 v[208:211], v2, s[8:11], s22 offen offset:0 sc1
  buffer_load_dwordx4 v[212:215], v2, s[8:11], s22 offen offset:1024 sc1
  buffer_load_dwordx4 v[216:219], v2, s[8:11], s22 offen offset:2048 sc1
  buffer_load_dwordx4 v[220:223], v2, s[8:11], s22 offen offset:3072 sc1
  s_add_u32 s22, s31, 163840
  buffer_load_dwordx4 v[224:227], v2, s[8:11], s22 offen offset:0 sc1
  buffer_load_dwordx4 v[228:231], v2, s[8:11], s22 offen offset:1024 sc1
  buffer_load_dwordx4 v[232:235], v2, s[8:11], s22 offen offset:2048 sc1
  buffer_load_dwordx4 v[236:239], v2, s[8:11], s22 offen offset:3072 sc1
  s_add_u32 s22, s31, 167936
  buffer_load_dwordx4 v[240:243], v2, s[8:11], s22 offen offset:0 sc1
  buffer_load_dwordx4 v[244:247], v2, s[8:11], s22 offen offset:1024 sc1
  buffer_load_dwordx4 v[248:251], v2, s[8:11], s22 offen offset:2048 sc1
  buffer_load_dwordx4 v[252:255], v2, s[8:11], s22 offen offset:3072 sc1
  s_mul_i32 s22, s17, 28
  s_add_u32 s23, s22, 27
  s_lshr_b32 s22, s22, 6
  s_lshr_b32 s23, s23, 6
  s_sub_u32 s23, s23, s22
  s_lshl_b32 s23, s23, 8
  v_and_b32 v36, s23, v2
  v_med3_u32 v37, v117, 15, 15
  v_lshl_add_u32 v36, v37, 4, v36
  s_lshl_b32 s22, s22, 8
  s_add_u32 s22, s22, 88588288
  s_mov_b32 s30, 0
va_bw_14:
  buffer_load_dwordx4 v[40:43], v36, s[8:11], s22 offen sc1
  s_waitcnt vmcnt(0)
  v_cmp_ne_u64 vcc, s[88:89], v[40:41]
  s_cbranch_vccnz va_bw_14_no
  v_cmp_ne_u64 vcc, s[88:89], v[42:43]
  s_cbranch_vccnz va_bw_14_no
  s_branch va_bw_14_ok
va_bw_14_no:
  s_sleep 2
  s_add_u32 s30, s30, 1
  s_cmp_lt_u32 s30, 50000
  s_cbranch_scc1 va_bw_14
  s_branch cA_abort
va_bw_14_ok:
  s_mov_b32 m0, 59392
  s_add_u32 s22, s31, 387072
  buffer_load_dwordx4 v2, s[8:11], s22 offen offset:0 sc1 lds
  buffer_load_dwordx4 v2, s[8:11], s22 offen offset:1024 sc1 lds
  buffer_load_dwordx4 v2, s[8:11], s22 offen offset:2048 sc1 lds
  buffer_load_dwordx4 v2, s[8:11], s22 offen offset:3072 sc1 lds
  s_mov_b32 m0, 63488
  s_add_u32 s22, s31, 391168
  buffer_load_dwordx4 v2, s[8:11], s22 offen offset:0 sc1 lds
  buffer_load_dwordx4 v2, s[8:11], s22 offen offset:1024 sc1 lds
  buffer_load_dwordx4 v2, s[8:11], s22 offen offset:2048 sc1 lds
  buffer_load_dwordx4 v2, s[8:11], s22 offen offset:3072 sc1 lds
  s_mov_b32 m0, 67584
  s_add_u32 s22, s31, 395264
  buffer_load_dwordx4 v2, s[8:11], s22 offen offset:0 sc1 lds
  buffer_load_dwordx4 v2, s[8:11], s22 offen offset:1024 sc1 lds
  buffer_load_dwordx4 v2, s[8:11], s22 offen offset:2048 sc1 lds
  buffer_load_dwordx4 v2, s[8:11], s22 offen offset:3072 sc1 lds
  s_mov_b32 m0, 71680
  s_add_u32 s22, s31, 399360
  buffer_load_dwordx4 v2, s[8:11], s22 offen offset:0 sc1 lds
  buffer_load_dwordx4 v2, s[8:11], s22 offen offset:1024 sc1 lds
  v_mov_b32 v72, v116
  v_mov_b32 v73, v117
  v_lshrrev_b32 v65, 1, v72
  v_and_b32 v66, 1, v72
  v_add_u32 v67, 6, v65
  v_lshl_add_u32 v67, v67, 4, v73
  v_mul_u32_u24 v68, 2341, v67
  v_lshrrev_b32 v68, 16, v68
  v_mul_u32_u24 v69, 28, v68
  v_sub_u32 v69, v67, v69
  v_lshrrev_b32 v70, 4, v69
  v_and_b32 v69, 15, v69
  v_and_b32 v71, 1, v69
  v_lshrrev_b32 v69, 1, v69
  v_lshl_add_u32 v69, v71, 3, v69
  v_lshlrev_b32 v71, 12, v70
  v_lshl_add_u32 v71, v68, 8, v71
  v_lshl_add_u32 v71, v69, 4, v71
  v_lshl_add_u32 v60, v66, 3, v71
  v_add_u32 v67, 8, v65
  v_lshl_add_u32 v67, v67, 4, v73
  v_mul_u32_u24 v68, 2341, v67
  v_lshrrev_b32 v68, 16, v68
  v_mul_u32_u24 v69, 28, v68
  v_sub_u32 v69, v67, v69
  v_lshrrev_b32 v70, 4, v69
  v_and_b32 v69, 15, v69
  v_and_b32 v71, 1, v69
  v_lshrrev_b32 v69, 1, v69
  v_lshl_add_u32 v69, v71, 3, v69
  v_lshlrev_b32 v71, 12, v70
  v_lshl_add_u32 v71, v68, 8, v71
  v_lshl_add_u32 v71, v69, 4, v71
  v_lshl_add_u32 v61, v66, 3, v71
  v_add_u32 v67, 10, v65
  v_lshl_add_u32 v67, v67, 4, v73
  v_mul_u32_u24 v68, 2341, v67
  v_lshrrev_b32 v68, 16, v68
  v_mul_u32_u24 v69, 28, v68
  v_sub_u32 v69, v67, v69
  v_lshrrev_b32 v70, 4, v69
  v_and_b32 v69, 15, v69
  v_and_b32 v71, 1, v69
  v_lshrrev_b32 v69, 1, v69
  v_lshl_add_u32 v69, v71, 3, v69
  v_lshlrev_b32 v71, 12, v70
  v_lshl_add_u32 v71, v68, 8, v71
  v_lshl_add_u32 v71, v69, 4, v71
  v_lshl_add_u32 v62, v66, 3, v71
  v_and_b32 v0, 31, v1
  v_lshlrev_b32 v0, 2, v0
  v_add_u32 v0, 21504, v0
  v_lshlrev_b32 v4, 2, v73
  s_and_b32 s22, s17, 15
  s_lshl_b32 s22, s22, 7
  s_add_u32 s22, s22, 17408
  v_add_u32 v4, s22, v4
  v_and_b32 v64, 7, v73
  v_lshlrev_b32 v5, 4, v64
  v_lshl_add_u32 v5, v72, 7, v5
  v_lshrrev_b32 v65, 3, v73
  v_lshl_add_u32 v5, v65, 9, v5
  s_lshl_b32 s22, s17, 3
  s_add_u32 s22, s22, 21508
  v_lshl_add_u32 v7, v2, 3, s22
  v_add_u32 v65, 16, v73
  v_min_u32 v65, 27, v65
  v_mad_u32_u24 v65, v72, 28, v65
  v_lshlrev_b32 v6, 4, v65
  s_lshr_b32 s22, s17, 1
  s_mul_i32 s22, s22, 7
  s_and_b32 s34, s17, 1
  s_lshl_b32 s35, s34, 2
  v_add_u32 v70, s35, v72
  v_mov_b32 v71, s34
  v_mov_b32 v69, 1
  v_cmp_eq_u32 vcc, 3, v72
  s_nop 1
  v_cndmask_b32 v70, v70, v72, vcc
  v_cndmask_b32 v69, v69, v71, vcc
  v_add_u32 v70, s22, v70
  v_lshrrev_b32 v68, 1, v70
  v_lshlrev_b32 v68, 8, v68
  v_lshl_add_u32 v68, v69, 7, v68
  v_and_b32 v69, 1, v70
  v_lshl_add_u32 v68, v69, 3, v68
  v_lshl_add_u32 v1, v64, 4, v68
  v_cmp_gt_u32 s[26:27], 8, v73
  v_cmp_gt_u32 vcc, 3, v72
  s_and_b64 s[26:27], s[26:27], vcc
  v_lshrrev_b32 v65, 3, v73
  v_lshl_add_u32 v66, v64, 1, v65
  v_add_u32 v66, 16, v66
  v_min_u32 v66, 27, v66
  v_mad_u32_u24 v66, v72, 28, v66
  v_lshlrev_b32 v6, 4, v66
  s_mul_i32 s22, s17, 28
  s_add_u32 s22, s22, 16
  v_lshl_add_u32 v70, v64, 1, s22
  v_lshrrev_b32 v68, 4, v70
  v_lshlrev_b32 v68, 8, v68
  v_bfe_u32 v69, v70, 1, 1
  v_lshl_add_u32 v68, v69, 7, v68
  v_bfe_u32 v69, v70, 2, 2
  v_lshl_add_u32 v68, v69, 2, v68
  v_and_b32 v69, 1, v72
  v_lshl_add_u32 v65, v69, 2, v65
  v_lshrrev_b32 v69, 1, v72
  v_lshl_add_u32 v65, v69, 1, v65
  v_lshl_add_u32 v1, v65, 4, v68
  v_cmp_gt_u32 s[26:27], 6, v64
  v_mov_b32 v156, 0
  v_mov_b32 v157, 0
  v_mov_b32 v158, 0
  v_mov_b32 v159, 0
  ds_write_b128 v2, v[156:159] offset:4096
  ds_write_b128 v2, v[156:159] offset:5120
  ds_write_b128 v2, v[156:159] offset:6144
  ds_write_b128 v2, v[156:159] offset:7168
  s_mul_i32 s22, s17, 1835008
  s_add_u32 s25, s22, 42205184
  s_lshl_b32 s35, s17, 7
  s_add_u32 s35, s35, 88526848
  s_mov_b32 s38, 0
  v_mov_b32 v175, 0
  s_lshl_b32 s22, 0, 11
  s_add_u32 s22, s22, 88590336
  v_add_u32 v36, 1024, v2
  v_min_u32 v36, 1776, v36
  s_mov_b32 s30, 0
va_iw5:
  buffer_load_dwordx4 v[40:43], v2, s[8:11], s22 offen sc1
  buffer_load_dwordx4 v[44:47], v36, s[8:11], s22 offen sc1
  s_waitcnt vmcnt(0)
  v_cmp_ne_u64 vcc, s[88:89], v[40:41]
  s_cbranch_vccnz va_iw5_no
  v_cmp_ne_u64 vcc, s[88:89], v[42:43]
  s_cbranch_vccnz va_iw5_no
  v_cmp_ne_u64 vcc, s[88:89], v[44:45]
  s_cbranch_vccnz va_iw5_no
  v_cmp_ne_u64 vcc, s[88:89], v[46:47]
  s_cbranch_vccnz va_iw5_no
  s_branch va_iw5_ok
va_iw5_no:
  s_sleep 2
  s_add_u32 s30, s30, 1
  s_cmp_lt_u32 s30, 50000
  s_cbranch_scc1 va_iw5
  s_branch cA_abort
va_iw5_ok:
  s_mov_b32 s30, 0
  v_mov_b32 v36, 0
ch_md5:
  buffer_load_dword v37, v36, s[12:15], 0 offen sc1
  s_waitcnt vmcnt(0)
  v_readfirstlane_b32 s22, v37
  s_and_b32 s31, s22, 0xffff
  s_cmp_ge_u32 s31, 32
  s_cbranch_scc1 ch_go5
  s_sleep 2
  s_add_u32 s30, s30, 1
  s_cmp_lt_u32 s30, 50000
  s_cbranch_scc1 ch_md5
  s_branch ch_end
ch_go5:
  s_mov_b32 s31, 0
  v_mov_b32 v36, 0
  v_mov_b32 v37, 0
  v_mov_b32 v38, 0
  v_mov_b32 v39, 0
  v_mov_b32 v40, 0
  v_mov_b32 v41, 0
  v_mov_b32 v42, 0
  v_mov_b32 v43, 0
  v_mov_b32 v44, 0
  v_mov_b32 v45, 0
  v_mov_b32 v46, 0
  v_mov_b32 v47, 0
  v_mov_b32 v48, 0
  v_mov_b32 v49, 0
  v_mov_b32 v50, 0
  v_mov_b32 v51, 0
  v_mov_b32 v52, 0
  v_mov_b32 v53, 0
  v_mov_b32 v54, 0
  v_mov_b32 v55, 0
  v_mov_b32 v56, 0
  v_mov_b32 v57, 0
  v_mov_b32 v58, 0
  v_mov_b32 v59, 0
  s_lshr_b32 s22, s22, 16
  s_cmp_lg_u32 s22, 0
  s_cbranch_scc1 cB_va1_loop
  s_branch cA_va1_loop
ch_init6:
  s_mul_i32 s31, s17, 401408
  s_add_u32 s31, s31, 6422528
  s_mul_i32 s22, s17, 28
  s_add_u32 s23, s22, 27
  s_lshr_b32 s22, s22, 6
  s_lshr_b32 s23, s23, 6
  s_sub_u32 s23, s23, s22
  s_lshl_b32 s23, s23, 8
  v_and_b32 v36, s23, v2
  v_med3_u32 v37, v117, 6, 10
  v_lshl_add_u32 v36, v37, 4, v36
  s_lshl_b32 s22, s22, 8
  s_add_u32 s22, s22, 88588288
  s_mov_b32 s30, 0
va_bw_15:
  buffer_load_dwordx4 v[40:43], v36, s[8:11], s22 offen sc1
  s_waitcnt vmcnt(0)
  v_cmp_ne_u64 vcc, s[88:89], v[40:41]
  s_cbranch_vccnz va_bw_15_no
  v_cmp_ne_u64 vcc, s[88:89], v[42:43]
  s_cbranch_vccnz va_bw_15_no
  s_branch va_bw_15_ok
va_bw_15_no:
  s_sleep 2
  s_add_u32 s30, s30, 1
  s_cmp_lt_u32 s30, 50000
  s_cbranch_scc1 va_bw_15
  s_branch cA_abort
va_bw_15_ok:
  s_add_u32 s22, s31, 172032
  buffer_load_dwordx4 a[0:3], v2, s[8:11], s22 offen offset:0 sc1
  buffer_load_dwordx4 a[4:7], v2, s[8:11], s22 offen offset:1024 sc1
  buffer_load_dwordx4 a[8:11], v2, s[8:11], s22 offen offset:2048 sc1
  buffer_load_dwordx4 a[12:15], v2, s[8:11], s22 offen offset:3072 sc1
  s_add_u32 s22, s31, 176128
  buffer_load_dwordx4 a[16:19], v2, s[8:11], s22 offen offset:0 sc1
  buffer_load_dwordx4 a[20:23], v2, s[8:11], s22 offen offset:1024 sc1
  buffer_load_dwordx4 a[24:27], v2, s[8:11], s22 offen offset:2048 sc1
  buffer_load_dwordx4 a[28:31], v2, s[8:11], s22 offen offset:3072 sc1
  s_add_u32 s22, s31, 180224
  buffer_load_dwordx4 a[32:35], v2, s[8:11], s22 offen offset:0 sc1
  buffer_load_dwordx4 a[36:39], v2, s[8:11], s22 offen offset:1024 sc1
  buffer_load_dwordx4 a[40:43], v2, s[8:11], s22 offen offset:2048 sc1
  buffer_load_dwordx4 a[44:47], v2, s[8:11], s22 offen offset:3072 sc1
  s_add_u32 s22, s31, 184320
  buffer_load_dwordx4 a[48:51], v2, s[8:11], s22 offen offset:0 sc1
  buffer_load_dwordx4 a[52:55], v2, s[8:11], s22 offen offset:1024 sc1
  buffer_load_dwordx4 a[56:59], v2, s[8:11], s22 offen offset:2048 sc1
  buffer_load_dwordx4 a[60:63], v2, s[8:11], s22 offen offset:3072 sc1
  s_add_u32 s22, s31, 188416
  buffer_load_dwordx4 a[64:67], v2, s[8:11], s22 offen offset:0 sc1
  buffer_load_dwordx4 a[68:71], v2, s[8:11], s22 offen offset:1024 sc1
  buffer_load_dwordx4 a[72:75], v2, s[8:11], s22 offen offset:2048 sc1
  buffer_load_dwordx4 a[76:79], v2, s[8:11], s22 offen offset:3072 sc1
  s_add_u32 s22, s31, 192512
  buffer_load_dwordx4 a[80:83], v2, s[8:11], s22 offen offset:0 sc1
  buffer_load_dwordx4 a[84:87], v2, s[8:11], s22 offen offset:1024 sc1
  buffer_load_dwordx4 a[88:91], v2, s[8:11], s22 offen offset:2048 sc1
  buffer_load_dwordx4 a[92:95], v2, s[8:11], s22 offen offset:3072 sc1
  s_add_u32 s22, s31, 196608
  buffer_load_dwordx4 a[96:99], v2, s[8:11], s22 offen offset:0 sc1
  buffer_load_dwordx4 a[100:103], v2, s[8:11], s22 offen offset:1024 sc1
  buffer_load_dwordx4 a[104:107], v2, s[8:11], s22 offen offset:2048 sc1
  buffer_load_dwordx4 a[108:111], v2, s[8:11], s22 offen offset:3072 sc1
  s_add_u32 s22, s31, 200704
  buffer_load_dwordx4 a[112:115], v2, s[8:11], s22 offen offset:0 sc1
  buffer_load_dwordx4 a[116:119], v2, s[8:11], s22 offen offset:1024 sc1
  buffer_load_dwordx4 a[120:123], v2, s[8:11], s22 offen offset:2048 sc1
  buffer_load_dwordx4 a[124:127], v2, s[8:11], s22 offen offset:3072 sc1
  s_waitcnt vmcnt(24)
  s_add_u32 s22, s31, 204800
  buffer_load_dwordx4 a[128:131], v2, s[8:11], s22 offen offset:0 sc1
  buffer_load_dwordx4 a[132:135], v2, s[8:11], s22 offen offset:1024 sc1
  buffer_load_dwordx4 a[136:139], v2, s[8:11], s22 offen offset:2048 sc1
  buffer_load_dwordx4 a[140:143], v2, s[8:11], s22 offen offset:3072 sc1
  s_add_u32 s22, s31, 208896
  buffer_load_dwordx4 a[144:147], v2, s[8:11], s22 offen offset:0 sc1
  buffer_load_dwordx4 a[148:151], v2, s[8:11], s22 offen offset:1024 sc1
  buffer_load_dwordx4 a[152:155], v2, s[8:11], s22 offen offset:2048 sc1
  buffer_load_dwordx4 a[156:159], v2, s[8:11], s22 offen offset:3072 sc1
  s_add_u32 s22, s31, 212992
  buffer_load_dwordx4 a[160:163], v2, s[8:11], s22 offen offset:0 sc1
  buffer_load_dwordx4 a[164:167], v2, s[8:11], s22 offen offset:1024 sc1
  buffer_load_dwordx4 a[168:171], v2, s[8:11], s22 offen offset:2048 sc1
  buffer_load_dwordx4 a[172:175], v2, s[8:11], s22 offen offset:3072 sc1
  s_add_u32 s22, s31, 217088
  buffer_load_dwordx4 a[176:179], v2, s[8:11], s22 offen offset:0 sc1
  buffer_load_dwordx4 a[180:183], v2, s[8:11], s22 offen offset:1024 sc1
  buffer_load_dwordx4 a[184:187], v2, s[8:11], s22 offen offset:2048 sc1
  buffer_load_dwordx4 a[188:191], v2, s[8:11], s22 offen offset:3072 sc1
  s_add_u32 s22, s31, 221184
  buffer_load_dwordx4 a[192:195], v2, s[8:11], s22 offen offset:0 sc1
  buffer_load_dwordx4 a[196:199], v2, s[8:11], s22 offen offset:1024 sc1
  buffer_load_dwordx4 a[200:203], v2, s[8:11], s22 offen offset:2048 sc1
  buffer_load_dwordx4 a[204:207], v2, s[8:11], s22 offen offset:3072 sc1
  s_add_u32 s22, s31, 225280
  buffer_load_dwordx4 a[208:211], v2, s[8:11], s22 offen offset:0 sc1
  buffer_load_dwordx4 a[212:215], v2, s[8:11], s22 offen offset:1024 sc1
  buffer_load_dwordx4 a[216:219], v2, s[8:11], s22 offen offset:2048 sc1
  buffer_load_dwordx4 a[220:223], v2, s[8:11], s22 offen offset:3072 sc1
  s_add_u32 s22, s31, 229376
  buffer_load_dwordx4 a[224:227], v2, s[8:11], s22 offen offset:0 sc1
  buffer_load_dwordx4 a[228:231], v2, s[8:11], s22 offen offset:1024 sc1
  buffer_load_dwordx4 a[232:235], v2, s[8:11], s22 offen offset:2048 sc1
  buffer_load_dwordx4 a[236:239], v2, s[8:11], s22 offen offset:3072 sc1
  s_add_u32 s22, s31, 233472
  buffer_load_dwordx4 a[240:243], v2, s[8:11], s22 offen offset:0 sc1
  buffer_load_dwordx4 a[244:247], v2, s[8:11], s22 offen offset:1024 sc1
  buffer_load_dwordx4 a[248:251], v2, s[8:11], s22 offen offset:2048 sc1
  buffer_load_dwordx4 a[252:255], v2, s[8:11], s22 offen offset:3072 sc1
  s_waitcnt vmcnt(24)
  s_add_u32 s22, s31, 237568
  buffer_load_dwordx4 v[120:123], v2, s[8:11], s22 offen offset:0 sc1
  buffer_load_dwordx4 v[124:127], v2, s[8:11], s22 offen offset:1024 sc1
  buffer_load_dwordx4 v[128:131], v2, s[8:11], s22 offen offset:2048 sc1
  buffer_load_dwordx4 v[132:135], v2, s[8:11], s22 offen offset:3072 sc1
  s_add_u32 s22, s31, 241664
  buffer_load_dwordx4 v[136:139], v2, s[8:11], s22 offen offset:0 sc1
  buffer_load_dwordx4 v[140:143], v2, s[8:11], s22 offen offset:1024 sc1
  buffer_load_dwordx4 v[144:147], v2, s[8:11], s22 offen offset:2048 sc1
  buffer_load_dwordx4 v[148:151], v2, s[8:11], s22 offen offset:3072 sc1
  s_add_u32 s22, s31, 245760
  buffer_load_dwordx4 v[152:155], v2, s[8:11], s22 offen offset:0 sc1
  buffer_load_dwordx4 v[156:159], v2, s[8:11], s22 offen offset:1024 sc1
  buffer_load_dwordx4 v[160:163], v2, s[8:11], s22 offen offset:2048 sc1
  buffer_load_dwordx4 v[164:167], v2, s[8:11], s22 offen offset:3072 sc1
  s_add_u32 s22, s31, 249856
  buffer_load_dwordx4 v[168:171], v2, s[8:11], s22 offen offset:0 sc1
  buffer_load_dwordx4 v[172:175], v2, s[8:11], s22 offen offset:1024 sc1
  buffer_load_dwordx4 v[176:179], v2, s[8:11], s22 offen offset:2048 sc1
  buffer_load_dwordx4 v[180:183], v2, s[8:11], s22 offen offset:3072 sc1
  s_add_u32 s22, s31, 253952
  buffer_load_dwordx4 v[184:187], v2, s[8:11], s22 offen offset:0 sc1
  buffer_load_dwordx4 v[188:191], v2, s[8:11], s22 offen offset:1024 sc1
  buffer_load_dwordx4 v[192:195], v2, s[8:11], s22 offen offset:2048 sc1
  buffer_load_dwordx4 v[196:199], v2, s[8:11], s22 offen offset:3072 sc1
  s_add_u32 s22, s31, 258048
  buffer_load_dwordx4 v[200:203], v2, s[8:11], s22 offen offset:0 sc1
  buffer_load_dwordx4 v[204:207], v2, s[8:11], s22 offen offset:1024 sc1
  buffer_load_dwordx4 v[208:211], v2, s[8:11], s22 offen offset:2048 sc1
  buffer_load_dwordx4 v[212:215], v2, s[8:11], s22 offen offset:3072 sc1
  s_add_u32 s22, s31, 262144
  buffer_load_dwordx4 v[216:219], v2, s[8:11], s22 offen offset:0 sc1
  buffer_load_dwordx4 v[220:223], v2, s[8:11], s22 offen offset:1024 sc1
  buffer_load_dwordx4 v[224:227], v2, s[8:11], s22 offen offset:2048 sc1
  buffer_load_dwordx4 v[228:231], v2, s[8:11], s22 offen offset:3072 sc1
  s_add_u32 s22, s31, 266240
  buffer_load_dwordx4 v[232:235], v2, s[8:11], s22 offen offset:0 sc1
  buffer_load_dwordx4 v[236:239], v2, s[8:11], s22 offen offset:1024 sc1
  buffer_load_dwordx4 v[240:243], v2, s[8:11], s22 offen offset:2048 sc1
  buffer_load_dwordx4 v[244:247], v2, s[8:11], s22 offen offset:3072 sc1
  s_waitcnt vmcnt(24)
  s_add_u32 s22, s31, 270336
  buffer_load_dwordx4 v[248:251], v2, s[8:11], s22 offen offset:0 sc1
  buffer_load_dwordx4 v[252:255], v2, s[8:11], s22 offen offset:1024 sc1
  v_mov_b32 v72, v116
  v_mov_b32 v73, v117
  v_lshrrev_b32 v65, 1, v72
  v_and_b32 v66, 1, v72
  v_add_u32 v67, 12, v65
  v_lshl_add_u32 v67, v67, 4, v73
  v_mul_u32_u24 v68, 2341, v67
  v_lshrrev_b32 v68, 16, v68
  v_mul_u32_u24 v69, 28, v68
  v_sub_u32 v69, v67, v69
  v_lshrrev_b32 v70, 4, v69
  v_and_b32 v69, 15, v69
  v_and_b32 v71, 1, v69
  v_lshrrev_b32 v69, 1, v69
  v_lshl_add_u32 v69, v71, 3, v69
  v_lshlrev_b32 v71, 12, v70
  v_lshl_add_u32 v71, v68, 8, v71
  v_lshl_add_u32 v71, v69, 4, v71
  v_lshl_add_u32 v112, v66, 3, v71
  v_add_u32 v67, 14, v65
  v_lshl_add_u32 v67, v67, 4, v73
  v_mul_u32_u24 v68, 2341, v67
  v_lshrrev_b32 v68, 16, v68
  v_mul_u32_u24 v69, 28, v68
  v_sub_u32 v69, v67, v69
  v_lshrrev_b32 v70, 4, v69
  v_and_b32 v69, 15, v69
  v_and_b32 v71, 1, v69
  v_lshrrev_b32 v69, 1, v69
  v_lshl_add_u32 v69, v71, 3, v69
  v_lshlrev_b32 v71, 12, v70
  v_lshl_add_u32 v71, v68, 8, v71
  v_lshl_add_u32 v71, v69, 4, v71
  v_lshl_add_u32 v113, v66, 3, v71
  v_add_u32 v67, 16, v65
  v_lshl_add_u32 v67, v67, 4, v73
  v_mul_u32_u24 v68, 2341, v67
  v_lshrrev_b32 v68, 16, v68
  v_mul_u32_u24 v69, 28, v68
  v_sub_u32 v69, v67, v69
  v_lshrrev_b32 v70, 4, v69
  v_and_b32 v69, 15, v69
  v_and_b32 v71, 1, v69
  v_lshrrev_b32 v69, 1, v69
  v_lshl_add_u32 v69, v71, 3, v69
  v_lshlrev_b32 v71, 12, v70
  v_lshl_add_u32 v71, v68, 8, v71
  v_lshl_add_u32 v71, v69, 4, v71
  v_lshl_add_u32 v114, v66, 3, v71
  v_add_u32 v67, 18, v65
  v_lshl_add_u32 v67, v67, 4, v73
  v_mul_u32_u24 v68, 2341, v67
  v_lshrrev_b32 v68, 16, v68
  v_mul_u32_u24 v69, 28, v68
  v_sub_u32 v69, v67, v69
  v_lshrrev_b32 v70, 4, v69
  v_and_b32 v69, 15, v69
  v_and_b32 v71, 1, v69
  v_lshrrev_b32 v69, 1, v69
  v_lshl_add_u32 v69, v71, 3, v69
  v_lshlrev_b32 v71, 12, v70
  v_lshl_add_u32 v71, v68, 8, v71
  v_lshl_add_u32 v71, v69, 4, v71
  v_lshl_add_u32 v115, v66, 3, v71
  s_mul_i32 s24, s17, 532480
  s_add_u32 s24, s24, 76926976
  s_mul_i32 s34, s17, 640
  s_add_u32 s34, s34, 88569856
  s_mul_i32 s36, s17, 448
  v_add_u32 v0, s36, v2
  v_add_u32 v0, 8192, v0
  s_add_u32 s36, s36, 88068096
  v_cmp_gt_u32 s[26:27], 28, v1
  v_and_b32 v119, 31, v1
  v_lshlrev_b32 v119, 2, v119
  s_add_u32 s22, s17, 16
  s_and_b32 s22, s22, 31
  s_lshl_b32 s22, s22, 7
  s_add_u32 s22, s22, 21504
  v_add_u32 v119, s22, v119
  v_min_u32 v118, 12, v1
  s_mul_i32 s22, s17, 13
  v_add_u32 v118, s22, v118
  v_lshlrev_b32 v118, 7, v118
  v_add_u32 v118, 51200, v118
  s_mov_b32 s39, 71565312
  v_add_u32 v1, 16384, v2
  v_mov_b32 v117, 1
  s_mul_i32 s38, s17, 1104
  s_add_u32 s38, s38, 25600
  s_lshl_b32 s22, 0, 11
  s_add_u32 s22, s22, 88590336
  v_add_u32 v36, 1024, v2
  v_min_u32 v36, 1776, v36
  s_mov_b32 s30, 0
va_iw6:
  buffer_load_dwordx4 v[40:43], v2, s[8:11], s22 offen sc1
  buffer_load_dwordx4 v[44:47], v36, s[8:11], s22 offen sc1
  s_waitcnt vmcnt(0)
  v_cmp_ne_u64 vcc, s[88:89], v[40:41]
  s_cbranch_vccnz va_iw6_no
  v_cmp_ne_u64 vcc, s[88:89], v[42:43]
  s_cbranch_vccnz va_iw6_no
  v_cmp_ne_u64 vcc, s[88:89], v[44:45]
  s_cbranch_vccnz va_iw6_no
  v_cmp_ne_u64 vcc, s[88:89], v[46:47]
  s_cbranch_vccnz va_iw6_no
  s_branch va_iw6_ok
va_iw6_no:
  s_sleep 2
  s_add_u32 s30, s30, 1
  s_cmp_lt_u32 s30, 50000
  s_cbranch_scc1 va_iw6
  s_branch cA_abort
va_iw6_ok:
  s_mov_b32 s30, 0
  v_mov_b32 v36, 0
ch_md6:
  buffer_load_dword v37, v36, s[12:15], 0 offen sc1
  s_waitcnt vmcnt(0)
  v_readfirstlane_b32 s22, v37
  s_and_b32 s31, s22, 0xffff
  s_cmp_ge_u32 s31, 32
  s_cbranch_scc1 ch_go6
  s_sleep 2
  s_add_u32 s30, s30, 1
  s_cmp_lt_u32 s30, 50000
  s_cbranch_scc1 ch_md6
  s_branch ch_end
ch_go6:
  s_mov_b32 s31, 0
  s_lshr_b32 s22, s22, 16
  s_cmp_lg_u32 s22, 0
  s_cbranch_scc1 cB_va2_loop
  s_branch cA_va2_loop
ch_init7:
  s_mul_i32 s31, s17, 401408
  s_add_u32 s31, s31, 6422528
  s_mul_i32 s22, s17, 28
  s_add_u32 s23, s22, 27
  s_lshr_b32 s22, s22, 6
  s_lshr_b32 s23, s23, 6
  s_sub_u32 s23, s23, s22
  s_lshl_b32 s23, s23, 8
  v_and_b32 v36, s23, v2
  v_med3_u32 v37, v117, 11, 15
  v_lshl_add_u32 v36, v37, 4, v36
  s_lshl_b32 s22, s22, 8
  s_add_u32 s22, s22, 88588288
  s_mov_b32 s30, 0
va_bw_16:
  buffer_load_dwordx4 v[40:43], v36, s[8:11], s22 offen sc1
  s_waitcnt vmcnt(0)
  v_cmp_ne_u64 vcc, s[88:89], v[40:41]
  s_cbranch_vccnz va_bw_16_no
  v_cmp_ne_u64 vcc, s[88:89], v[42:43]
  s_cbranch_vccnz va_bw_16_no
  s_branch va_bw_16_ok
va_bw_16_no:
  s_sleep 2
  s_add_u32 s30, s30, 1
  s_cmp_lt_u32 s30, 50000
  s_cbranch_scc1 va_bw_16
  s_branch cA_abort
va_bw_16_ok:
  s_add_u32 s22, s31, 286720
  buffer_load_dwordx4 a[0:3], v2, s[8:11], s22 offen offset:0 sc1
  buffer_load_dwordx4 a[4:7], v2, s[8:11], s22 offen offset:1024 sc1
  buffer_load_dwordx4 a[8:11], v2, s[8:11], s22 offen offset:2048 sc1
  buffer_load_dwordx4 a[12:15], v2, s[8:11], s22 offen offset:3072 sc1
  s_add_u32 s22, s31, 290816
  buffer_load_dwordx4 a[16:19], v2, s[8:11], s22 offen offset:0 sc1
  buffer_load_dwordx4 a[20:23], v2, s[8:11], s22 offen offset:1024 sc1
  buffer_load_dwordx4 a[24:27], v2, s[8:11], s22 offen offset:2048 sc1
  buffer_load_dwordx4 a[28:31], v2, s[8:11], s22 offen offset:3072 sc1
  s_add_u32 s22, s31, 294912
  buffer_load_dwordx4 a[32:35], v2, s[8:11], s22 offen offset:0 sc1
  buffer_load_dwordx4 a[36:39], v2, s[8:11], s22 offen offset:1024 sc1
  buffer_load_dwordx4 a[40:43], v2, s[8:11], s22 offen offset:2048 sc1
  buffer_load_dwordx4 a[44:47], v2, s[8:11], s22 offen offset:3072 sc1
  s_add_u32 s22, s31, 299008
  buffer_load_dwordx4 a[48:51], v2, s[8:11], s22 offen offset:0 sc1
  buffer_load_dwordx4 a[52:55], v2, s[8:11], s22 offen offset:1024 sc1
  buffer_load_dwordx4 a[56:59], v2, s[8:11], s22 offen offset:2048 sc1
  buffer_load_dwordx4 a[60:63], v2, s[8:11], s22 offen offset:3072 sc1
  s_add_u32 s22, s31, 303104
  buffer_load_dwordx4 a[64:67], v2, s[8:11], s22 offen offset:0 sc1
  buffer_load_dwordx4 a[68:71], v2, s[8:11], s22 offen offset:1024 sc1
  buffer_load_dwordx4 a[72:75], v2, s[8:11], s22 offen offset:2048 sc1
  buffer_load_dwordx4 a[76:79], v2, s[8:11], s22 offen offset:3072 sc1
  s_add_u32 s22, s31, 307200
  buffer_load_dwordx4 a[80:83], v2, s[8:11], s22 offen offset:0 sc1
  buffer_load_dwordx4 a[84:87], v2, s[8:11], s22 offen offset:1024 sc1
  buffer_load_dwordx4 a[88:91], v2, s[8:11], s22 offen offset:2048 sc1
  buffer_load_dwordx4 a[92:95], v2, s[8:11], s22 offen offset:3072 sc1
  s_add_u32 s22, s31, 311296
  buffer_load_dwordx4 a[96:99], v2, s[8:11], s22 offen offset:0 sc1
  buffer_load_dwordx4 a[100:103], v2, s[8:11], s22 offen offset:1024 sc1
  buffer_load_dwordx4 a[104:107], v2, s[8:11], s22 offen offset:2048 sc1
  buffer_load_dwordx4 a[108:111], v2, s[8:11], s22 offen offset:3072 sc1
  s_add_u32 s22, s31, 315392
  buffer_load_dwordx4 a[112:115], v2, s[8:11], s22 offen offset:0 sc1
  buffer_load_dwordx4 a[116:119], v2, s[8:11], s22 offen offset:1024 sc1
  buffer_load_dwordx4 a[120:123], v2, s[8:11], s22 offen offset:2048 sc1
  buffer_load_dwordx4 a[124:127], v2, s[8:11], s22 offen offset:3072 sc1
  s_waitcnt vmcnt(24)
  s_add_u32 s22, s31, 319488
  buffer_load_dwordx4 a[128:131], v2, s[8:11], s22 offen offset:0 sc1
  buffer_load_dwordx4 a[132:135], v2, s[8:11], s22 offen offset:1024 sc1
  buffer_load_dwordx4 a[136:139], v2, s[8:11], s22 offen offset:2048 sc1
  buffer_load_dwordx4 a[140:143], v2, s[8:11], s22 offen offset:3072 sc1
  s_add_u32 s22, s31, 323584
  buffer_load_dwordx4 a[144:147], v2, s[8:11], s22 offen offset:0 sc1
  buffer_load_dwordx4 a[148:151], v2, s[8:11], s22 offen offset:1024 sc1
  buffer_load_dwordx4 a[152:155], v2, s[8:11], s22 offen offset:2048 sc1
  buffer_load_dwordx4 a[156:159], v2, s[8:11], s22 offen offset:3072 sc1
  s_add_u32 s22, s31, 327680
  buffer_load_dwordx4 a[160:163], v2, s[8:11], s22 offen offset:0 sc1
  buffer_load_dwordx4 a[164:167], v2, s[8:11], s22 offen offset:1024 sc1
  buffer_load_dwordx4 a[168:171], v2, s[8:11], s22 offen offset:2048 sc1
  buffer_load_dwordx4 a[172:175], v2, s[8:11], s22 offen offset:3072 sc1
  s_add_u32 s22, s31, 331776
  buffer_load_dwordx4 a[176:179], v2, s[8:11], s22 offen offset:0 sc1
  buffer_load_dwordx4 a[180:183], v2, s[8:11], s22 offen offset:1024 sc1
  buffer_load_dwordx4 a[184:187], v2, s[8:11], s22 offen offset:2048 sc1
  buffer_load_dwordx4 a[188:191], v2, s[8:11], s22 offen offset:3072 sc1
  s_add_u32 s22, s31, 335872
  buffer_load_dwordx4 a[192:195], v2, s[8:11], s22 offen offset:0 sc1
  buffer_load_dwordx4 a[196:199], v2, s[8:11], s22 offen offset:1024 sc1
  buffer_load_dwordx4 a[200:203], v2, s[8:11], s22 offen offset:2048 sc1
  buffer_load_dwordx4 a[204:207], v2, s[8:11], s22 offen offset:3072 sc1
  s_add_u32 s22, s31, 339968
  buffer_load_dwordx4 a[208:211], v2, s[8:11], s22 offen offset:0 sc1
  buffer_load_dwordx4 a[212:215], v2, s[8:11], s22 offen offset:1024 sc1
  buffer_load_dwordx4 a[216:219], v2, s[8:11], s22 offen offset:2048 sc1
  buffer_load_dwordx4 a[220:223], v2, s[8:11], s22 offen offset:3072 sc1
  s_add_u32 s22, s31, 344064
  buffer_load_dwordx4 a[224:227], v2, s[8:11], s22 offen offset:0 sc1
  buffer_load_dwordx4 a[228:231], v2, s[8:11], s22 offen offset:1024 sc1
  buffer_load_dwordx4 a[232:235], v2, s[8:11], s22 offen offset:2048 sc1
  buffer_load_dwordx4 a[236:239], v2, s[8:11], s22 offen offset:3072 sc1
  s_add_u32 s22, s31, 348160
  buffer_load_dwordx4 a[240:243], v2, s[8:11], s22 offen offset:0 sc1
  buffer_load_dwordx4 a[244:247], v2, s[8:11], s22 offen offset:1024 sc1
  buffer_load_dwordx4 a[248:251], v2, s[8:11], s22 offen offset:2048 sc1
  buffer_load_dwordx4 a[252:255], v2, s[8:11], s22 offen offset:3072 sc1
  s_waitcnt vmcnt(24)
  s_add_u32 s22, s31, 352256
  buffer_load_dwordx4 v[120:123], v2, s[8:11], s22 offen offset:0 sc1
  buffer_load_dwordx4 v[124:127], v2, s[8:11], s22 offen offset:1024 sc1
  buffer_load_dwordx4 v[128:131], v2, s[8:11], s22 offen offset:2048 sc1
  buffer_load_dwordx4 v[132:135], v2, s[8:11], s22 offen offset:3072 sc1
  s_add_u32 s22, s31, 356352
  buffer_load_dwordx4 v[136:139], v2, s[8:11], s22 offen offset:0 sc1
  buffer_load_dwordx4 v[140:143], v2, s[8:11], s22 offen offset:1024 sc1
  buffer_load_dwordx4 v[144:147], v2, s[8:11], s22 offen offset:2048 sc1
  buffer_load_dwordx4 v[148:151], v2, s[8:11], s22 offen offset:3072 sc1
  s_add_u32 s22, s31, 360448
  buffer_load_dwordx4 v[152:155], v2, s[8:11], s22 offen offset:0 sc1
  buffer_load_dwordx4 v[156:159], v2, s[8:11], s22 offen offset:1024 sc1
  buffer_load_dwordx4 v[160:163], v2, s[8:11], s22 offen offset:2048 sc1
  buffer_load_dwordx4 v[164:167], v2, s[8:11], s22 offen offset:3072 sc1
  s_add_u32 s22, s31, 364544
  buffer_load_dwordx4 v[168:171], v2, s[8:11], s22 offen offset:0 sc1
  buffer_load_dwordx4 v[172:175], v2, s[8:11], s22 offen offset:1024 sc1
  buffer_load_dwordx4 v[176:179], v2, s[8:11], s22 offen offset:2048 sc1
  buffer_load_dwordx4 v[180:183], v2, s[8:11], s22 offen offset:3072 sc1
  s_add_u32 s22, s31, 368640
  buffer_load_dwordx4 v[184:187], v2, s[8:11], s22 offen offset:0 sc1
  buffer_load_dwordx4 v[188:191], v2, s[8:11], s22 offen offset:1024 sc1
  buffer_load_dwordx4 v[192:195], v2, s[8:11], s22 offen offset:2048 sc1
  buffer_load_dwordx4 v[196:199], v2, s[8:11], s22 offen offset:3072 sc1
  s_add_u32 s22, s31, 372736
  buffer_load_dwordx4 v[200:203], v2, s[8:11], s22 offen offset:0 sc1
  buffer_load_dwordx4 v[204:207], v2, s[8:11], s22 offen offset:1024 sc1
  buffer_load_dwordx4 v[208:211], v2, s[8:11], s22 offen offset:2048 sc1
  buffer_load_dwordx4 v[212:215], v2, s[8:11], s22 offen offset:3072 sc1
  s_add_u32 s22, s31, 376832
  buffer_load_dwordx4 v[216:219], v2, s[8:11], s22 offen offset:0 sc1
  buffer_load_dwordx4 v[220:223], v2, s[8:11], s22 offen offset:1024 sc1
  buffer_load_dwordx4 v[224:227], v2, s[8:11], s22 offen offset:2048 sc1
  buffer_load_dwordx4 v[228:231], v2, s[8:11], s22 offen offset:3072 sc1
  s_add_u32 s22, s31, 380928
  buffer_load_dwordx4 v[232:235], v2, s[8:11], s22 offen offset:0 sc1
  buffer_load_dwordx4 v[236:239], v2, s[8:11], s22 offen offset:1024 sc1
  buffer_load_dwordx4 v[240:243], v2, s[8:11], s22 offen offset:2048 sc1
  buffer_load_dwordx4 v[244:247], v2, s[8:11], s22 offen offset:3072 sc1
  s_waitcnt vmcnt(24)
  s_add_u32 s22, s31, 385024
  buffer_load_dwordx4 v[248:251], v2, s[8:11], s22 offen offset:0 sc1
  buffer_load_dwordx4 v[252:255], v2, s[8:11], s22 offen offset:1024 sc1
  v_mov_b32 v72, v116
  v_mov_b32 v73, v117
  v_lshrrev_b32 v65, 1, v72
  v_and_b32 v66, 1, v72
  v_add_u32 v67, 20, v65
  v_lshl_add_u32 v67, v67, 4, v73
  v_mul_u32_u24 v68, 2341, v67
  v_lshrrev_b32 v68, 16, v68
  v_mul_u32_u24 v69, 28, v68
  v_sub_u32 v69, v67, v69
  v_lshrrev_b32 v70, 4, v69
  v_and_b32 v69, 15, v69
  v_and_b32 v71, 1, v69
  v_lshrrev_b32 v69, 1, v69
  v_lshl_add_u32 v69, v71, 3, v69
  v_lshlrev_b32 v71, 12, v70
  v_lshl_add_u32 v71, v68, 8, v71
  v_lshl_add_u32 v71, v69, 4, v71
  v_lshl_add_u32 v112, v66, 3, v71
  v_add_u32 v67, 22, v65
  v_lshl_add_u32 v67, v67, 4, v73
  v_mul_u32_u24 v68, 2341, v67
  v_lshrrev_b32 v68, 16, v68
  v_mul_u32_u24 v69, 28, v68
  v_sub_u32 v69, v67, v69
  v_lshrrev_b32 v70, 4, v69
  v_and_b32 v69, 15, v69
  v_and_b32 v71, 1, v69
  v_lshrrev_b32 v69, 1, v69
  v_lshl_add_u32 v69, v71, 3, v69
  v_lshlrev_b32 v71, 12, v70
  v_lshl_add_u32 v71, v68, 8, v71
  v_lshl_add_u32 v71, v69, 4, v71
  v_lshl_add_u32 v113, v66, 3, v71
  v_add_u32 v67, 24, v65
  v_lshl_add_u32 v67, v67, 4, v73
  v_mul_u32_u24 v68, 2341, v67
  v_lshrrev_b32 v68, 16, v68
  v_mul_u32_u24 v69, 28, v68
  v_sub_u32 v69, v67, v69
  v_lshrrev_b32 v70, 4, v69
  v_and_b32 v69, 15, v69
  v_and_b32 v71, 1, v69
  v_lshrrev_b32 v69, 1, v69
  v_lshl_add_u32 v69, v71, 3, v69
  v_lshlrev_b32 v71, 12, v70
  v_lshl_add_u32 v71, v68, 8, v71
  v_lshl_add_u32 v71, v69, 4, v71
  v_lshl_add_u32 v114, v66, 3, v71
  v_add_u32 v67, 26, v65
  v_lshl_add_u32 v67, v67, 4, v73
  v_mul_u32_u24 v68, 2341, v67
  v_lshrrev_b32 v68, 16, v68
  v_mul_u32_u24 v69, 28, v68
  v_sub_u32 v69, v67, v69
  v_lshrrev_b32 v70, 4, v69
  v_and_b32 v69, 15, v69
  v_and_b32 v71, 1, v69
  v_lshrrev_b32 v69, 1, v69
  v_lshl_add_u32 v69, v71, 3, v69
  v_lshlrev_b32 v71, 12, v70
  v_lshl_add_u32 v71, v68, 8, v71
  v_lshl_add_u32 v71, v69, 4, v71
  v_lshl_add_u32 v115, v66, 3, v71
  s_mul_i32 s24, s17, 532480
  s_add_u32 s24, s24, 76931072
  s_mul_i32 s34, s17, 640
  s_add_u32 s34, s34, 88569860
  s_mul_i32 s36, s17, 448
  v_add_u32 v0, s36, v2
  v_add_u32 v0, 8192, v0
  s_add_u32 s36, s36, 88068096
  v_cmp_gt_u32 s[26:27], 28, v1
  v_and_b32 v119, 31, v1
  v_lshlrev_b32 v119, 2, v119
  s_add_u32 s22, s17, 16
  s_and_b32 s22, s22, 31
  s_lshl_b32 s22, s22, 7
  s_add_u32 s22, s22, 21504
  v_add_u32 v119, s22, v119
  v_min_u32 v118, 13, v1
  s_mul_i32 s22, s17, 14
  v_add_u32 v118, s22, v118
  v_lshlrev_b32 v118, 7, v118
  v_add_u32 v118, 57344, v118
  s_mov_b32 s39, 71565312
  v_add_u32 v1, 59392, v2
  v_mov_b32 v117, 1
  s_mul_i32 s38, s17, 1104
  s_add_u32 s38, s38, 26624
  s_lshl_b32 s22, 0, 11
  s_add_u32 s22, s22, 88590336
  v_add_u32 v36, 1024, v2
  v_min_u32 v36, 1776, v36
  s_mov_b32 s30, 0
va_iw7:
  buffer_load_dwordx4 v[40:43], v2, s[8:11], s22 offen sc1
  buffer_load_dwordx4 v[44:47], v36, s[8:11], s22 offen sc1
  s_waitcnt vmcnt(0)
  v_cmp_ne_u64 vcc, s[88:89], v[40:41]
  s_cbranch_vccnz va_iw7_no
  v_cmp_ne_u64 vcc, s[88:89], v[42:43]
  s_cbranch_vccnz va_iw7_no
  v_cmp_ne_u64 vcc, s[88:89], v[44:45]
  s_cbranch_vccnz va_iw7_no
  v_cmp_ne_u64 vcc, s[88:89], v[46:47]
  s_cbranch_vccnz va_iw7_no
  s_branch va_iw7_ok
va_iw7_no:
  s_sleep 2
  s_add_u32 s30, s30, 1
  s_cmp_lt_u32 s30, 50000
  s_cbranch_scc1 va_iw7
  s_branch cA_abort
va_iw7_ok:
  s_mov_b32 s30, 0
  v_mov_b32 v36, 0
ch_md7:
  buffer_load_dword v37, v36, s[12:15], 0 offen sc1
  s_waitcnt vmcnt(0)
  v_readfirstlane_b32 s22, v37
  s_and_b32 s31, s22, 0xffff
  s_cmp_ge_u32 s31, 32
  s_cbranch_scc1 ch_go7
  s_sleep 2
  s_add_u32 s30, s30, 1
  s_cmp_lt_u32 s30, 50000
  s_cbranch_scc1 ch_md7
  s_branch ch_end
ch_go7:
  s_mov_b32 s31, 0
  s_lshr_b32 s22, s22, 16
  s_cmp_lg_u32 s22, 0
  s_cbranch_scc1 cB_va3_loop
  s_branch cA_va3_loop
cA_sc0_loop:
  s_add_u32 s23, s20, 4096
  s_add_u32 s21, s20, 25600
  v_mov_b32 v48, 0
  v_mov_b32 v49, 0
  v_mov_b32 v50, 0
  v_mov_b32 v51, 0
  v_mov_b32 v52, 0
  v_mov_b32 v53, 0
  v_mov_b32 v54, 0
  v_mov_b32 v55, 0
  v_mov_b32 v56, 0
  v_mov_b32 v57, 0
  v_mov_b32 v58, 0
  v_mov_b32 v59, 0
  v_mov_b32 v60, 0
  v_mov_b32 v61, 0
  v_mov_b32 v62, 0
  v_mov_b32 v63, 0
  v_mov_b32 v88, 0
  v_mov_b32 v89, 0
  v_mov_b32 v90, 0
  v_mov_b32 v91, 0
  v_mov_b32 v92, 0
  v_mov_b32 v93, 0
  v_mov_b32 v94, 0
  v_mov_b32 v95, 0
  v_mov_b32 v66, 0
  v_mov_b32 v67, 0
  s_mov_b32 s30, 0
  s_mov_b32 s62, 0
  buffer_load_dword v68, v0, s[8:11], s20 offen sc1
  s_nop 7
  buffer_load_dword v69, v0, s[8:11], s20 offen sc1
  s_nop 7
  buffer_load_dword v70, v0, s[8:11], s20 offen sc1
  s_nop 7
  buffer_load_dword v71, v0, s[8:11], s20 offen sc1
  s_nop 7
  buffer_load_dword v72, v0, s[8:11], s20 offen sc1
cA_sc0_fp_l:
  s_waitcnt vmcnt(4)
  v_cmp_eq_u32 vcc, -1, v68
  s_cbranch_vccz cA_sc0_fp_d
  buffer_load_dword v68, v0, s[8:11], s20 offen sc1
  s_waitcnt vmcnt(4)
  v_cmp_eq_u32 vcc, -1, v69
  s_cbranch_vccz cA_sc0_fp_d
  buffer_load_dword v69, v0, s[8:11], s20 offen sc1
  s_waitcnt vmcnt(4)
  v_cmp_eq_u32 vcc, -1, v70
  s_cbranch_vccz cA_sc0_fp_d
  buffer_load_dword v70, v0, s[8:11], s20 offen sc1
  s_waitcnt vmcnt(4)
  v_cmp_eq_u32 vcc, -1, v71
  s_cbranch_vccz cA_sc0_fp_d
  buffer_load_dword v71, v0, s[8:11], s20 offen sc1
  s_waitcnt vmcnt(4)
  v_cmp_eq_u32 vcc, -1, v72
  s_cbranch_vccz cA_sc0_fp_d
  buffer_load_dword v72, v0, s[8:11], s20 offen sc1
  s_add_u32 s30, s30, 1
  s_cmp_lt_u32 s30, 400000
  s_cbranch_scc1 cA_sc0_fp_l
  s_branch cA_abort
cA_sc0_fp_d:
  buffer_load_dwordx4 v[8:11], v2, s[8:11], s20 offen offset:0
  s_barrier
  s_branch cA_sc0_ld1
cA_sc0_ld:
  buffer_load_dwordx4 v[8:11], v2, s[8:11], s20 offen offset:0
cA_sc0_ld1:
  v_mov_b32 v36, 0
  v_mov_b32 v37, 0
  v_mov_b32 v38, 0
  v_mov_b32 v39, 0
  buffer_load_dwordx4 v[12:15], v2, s[8:11], s20 offen offset:1024
  v_mov_b32 v40, 0
  v_mov_b32 v41, 0
  v_mov_b32 v42, 0
  v_mov_b32 v43, 0
  buffer_load_dwordx4 v[16:19], v2, s[8:11], s20 offen offset:2048
  v_mov_b32 v44, 0
  v_mov_b32 v45, 0
  v_mov_b32 v46, 0
  v_mov_b32 v47, 0
  ds_read_b128 v[96:99], v116 offset:12288
  ds_read_b128 v[100:103], v116 offset:13312
  ds_read_b128 v[104:107], v116 offset:26624
  ds_read_b128 v[108:111], v116 offset:27648
  s_waitcnt vmcnt(2)
  v_smfmac_f32_16x16x64_bf16 v[36:39], v[8:11], a[0:7], v3
  v_smfmac_f32_16x16x64_bf16 v[40:43], v[8:11], a[56:63], v3
  buffer_load_dwordx4 v[20:23], v2, s[8:11], s20 offen offset:3072
  v_smfmac_f32_16x16x64_bf16 v[44:47], v[8:11], a[112:119], v3
  v_smfmac_f32_16x16x64_bf16 v[48:51], v[8:11], a[168:175], v3
  v_smfmac_f32_16x16x64_bf16 v[52:55], v[8:11], a[224:231], v3
  buffer_load_dwordx4 v[24:27], v2, s[8:11], s23 offen offset:0
  v_smfmac_f32_16x16x64_bf16 v[56:59], v[8:11], v[144:151], v3
  v_smfmac_f32_16x16x64_bf16 v[60:63], v[8:11], v[200:207], v3
  s_waitcnt vmcnt(3)
  v_smfmac_f32_16x16x64_bf16 v[36:39], v[12:15], a[8:15], v3
  v_smfmac_f32_16x16x64_bf16 v[40:43], v[12:15], a[64:71], v3
  buffer_load_dwordx4 v[28:31], v2, s[8:11], s23 offen offset:1024
  v_smfmac_f32_16x16x64_bf16 v[44:47], v[12:15], a[120:127], v3
  v_smfmac_f32_16x16x64_bf16 v[48:51], v[12:15], a[176:183], v3
  v_smfmac_f32_16x16x64_bf16 v[52:55], v[12:15], a[232:239], v3
  buffer_load_dwordx4 v[32:35], v2, s[8:11], s23 offen offset:2048
  v_smfmac_f32_16x16x64_bf16 v[56:59], v[12:15], v[152:159], v3
  v_smfmac_f32_16x16x64_bf16 v[60:63], v[12:15], v[208:215], v3
  s_waitcnt vmcnt(4)
  v_smfmac_f32_16x16x64_bf16 v[36:39], v[16:19], a[16:23], v3
  v_smfmac_f32_16x16x64_bf16 v[40:43], v[16:19], a[72:79], v3
  v_smfmac_f32_16x16x64_bf16 v[44:47], v[16:19], a[128:135], v3
  v_smfmac_f32_16x16x64_bf16 v[48:51], v[16:19], a[184:191], v3
  v_smfmac_f32_16x16x64_bf16 v[52:55], v[16:19], a[240:247], v3
  v_smfmac_f32_16x16x64_bf16 v[56:59], v[16:19], v[160:167], v3
  v_smfmac_f32_16x16x64_bf16 v[60:63], v[16:19], v[216:223], v3
  s_waitcnt vmcnt(3)
  v_smfmac_f32_16x16x64_bf16 v[36:39], v[20:23], a[24:31], v3
  v_smfmac_f32_16x16x64_bf16 v[40:43], v[20:23], a[80:87], v3
  v_smfmac_f32_16x16x64_bf16 v[44:47], v[20:23], a[136:143], v3
  v_smfmac_f32_16x16x64_bf16 v[48:51], v[20:23], a[192:199], v3
  v_smfmac_f32_16x16x64_bf16 v[52:55], v[20:23], a[248:255], v3
  v_smfmac_f32_16x16x64_bf16 v[56:59], v[20:23], v[168:175], v3
  v_smfmac_f32_16x16x64_bf16 v[60:63], v[20:23], v[224:231], v3
  s_waitcnt vmcnt(0)
cA_sc0_ph2:
  v_smfmac_f32_16x16x64_bf16 v[60:63], v[24:27], v[232:239], v3
  ds_read_b128 v[12:15], v116 offset:8192
  ds_read_b128 v[16:19], v116 offset:9216
  v_smfmac_f32_16x16x64_bf16 v[60:63], v[28:31], v[240:247], v3
  v_smfmac_f32_16x16x64_bf16 v[60:63], v[32:35], v[248:255], v3
  v_smfmac_f32_16x16x64_bf16 v[52:55], v[24:27], v[120:127], v3
  v_smfmac_f32_16x16x64_bf16 v[52:55], v[28:31], v[128:135], v3
  v_smfmac_f32_16x16x64_bf16 v[52:55], v[32:35], v[136:143], v3
  v_cvt_pk_bf16_f32 v64, v60, v61
  v_smfmac_f32_16x16x64_bf16 v[56:59], v[24:27], v[176:183], v3
  v_cvt_pk_bf16_f32 v65, v62, v63
  v_smfmac_f32_16x16x64_bf16 v[56:59], v[28:31], v[184:191], v3
  v_mfma_f32_16x16x32_bf16 v[68:71], v[64:67], v[4:7], 0
  v_smfmac_f32_16x16x64_bf16 v[56:59], v[32:35], v[192:199], v3
  v_cvt_pk_bf16_f32 v64, v52, v53
  v_smfmac_f32_16x16x64_bf16 v[36:39], v[24:27], a[32:39], v3
  v_cvt_pk_bf16_f32 v65, v54, v55
  v_smfmac_f32_16x16x64_bf16 v[36:39], v[28:31], a[40:47], v3
  v_cvt_pk_bf16_f32 v76, v68, v69
  v_smfmac_f32_16x16x64_bf16 v[36:39], v[32:35], a[48:55], v3
  v_cvt_pk_bf16_f32 v77, v70, v71
  v_cvt_pk_bf16_f32 v66, v56, v57
  v_smfmac_f32_16x16x64_bf16 v[40:43], v[24:27], a[88:95], v3
  v_cvt_pk_bf16_f32 v67, v58, v59
  v_smfmac_f32_16x16x64_bf16 v[40:43], v[28:31], a[96:103], v3
  v_mfma_f32_16x16x32_bf16 v[72:75], v[64:67], v[4:7], 0
  ds_read_b128 v[52:55], v116 offset:22528
  ds_read_b128 v[56:59], v116 offset:23552
  v_smfmac_f32_16x16x64_bf16 v[40:43], v[32:35], a[104:111], v3
  v_cvt_pk_bf16_f32 v64, v36, v37
  v_smfmac_f32_16x16x64_bf16 v[44:47], v[24:27], a[144:151], v3
  v_cvt_pk_bf16_f32 v65, v38, v39
  v_smfmac_f32_16x16x64_bf16 v[44:47], v[28:31], a[152:159], v3
  v_cvt_pk_bf16_f32 v80, v72, v73
  v_smfmac_f32_16x16x64_bf16 v[44:47], v[32:35], a[160:167], v3
  v_cvt_pk_bf16_f32 v81, v74, v75
  v_cvt_pk_bf16_f32 v66, v40, v41
  v_smfmac_f32_16x16x64_bf16 v[48:51], v[24:27], a[200:207], v3
  v_cvt_pk_bf16_f32 v67, v42, v43
  v_smfmac_f32_16x16x64_bf16 v[48:51], v[28:31], a[208:215], v3
  v_mfma_f32_16x16x32_bf16 v[68:71], v[64:67], v[4:7], 0
  ds_read_b128 v[36:39], v116 offset:0
  ds_read_b128 v[40:43], v116 offset:1024
  v_smfmac_f32_16x16x64_bf16 v[48:51], v[32:35], a[216:223], v3
  s_waitcnt lgkmcnt(4)
  v_cvt_pk_bf16_f32 v64, v44, v45
  v_mfma_f32_16x16x32_bf16 v[84:87], v[32:35], v[76:79], 0
  v_cvt_pk_bf16_f32 v65, v46, v47
  v_smfmac_f32_16x16x64_bf16 v[88:91], v[76:79], v[96:103], v3
  ds_read_b128 v[96:99], v116 offset:14336
  ds_read_b128 v[100:103], v116 offset:15360
  v_smfmac_f32_16x16x64_bf16 v[92:95], v[76:79], v[104:111], v3
  v_cvt_pk_bf16_f32 v66, v48, v49
  v_cvt_pk_bf16_f32 v67, v50, v51
  v_mfma_f32_16x16x32_bf16 v[84:87], v[24:27], v[80:83], v[84:87]
  v_cvt_pk_bf16_f32 v60, v68, v69
  v_mfma_f32_16x16x32_bf16 v[72:75], v[64:67], v[4:7], 0
  v_cvt_pk_bf16_f32 v61, v70, v71
  s_waitcnt lgkmcnt(4)
  v_smfmac_f32_16x16x64_bf16 v[88:91], v[80:83], v[12:19], v3
  v_smfmac_f32_16x16x64_bf16 v[92:95], v[80:83], v[52:59], v3
  s_waitcnt lgkmcnt(0)
  s_nop 0
  v_cvt_pk_bf16_f32 v62, v72, v73
  v_cvt_pk_bf16_f32 v63, v74, v75
  s_nop 1
  v_mfma_f32_16x16x32_bf16 v[84:87], v[8:11], v[60:63], v[84:87]
  v_smfmac_f32_16x16x64_bf16 v[88:91], v[60:63], v[36:43], v3
  v_smfmac_f32_16x16x64_bf16 v[92:95], v[60:63], v[96:103], v3
  s_mov_b64 exec, s[26:27]
  s_nop 0
  ds_write_b128 v113, v[84:87]
  s_mov_b64 exec, -1
  s_nop 0
  v_cmp_u_f32 vcc, v88, v89
  s_nop 1
  v_permlane32_swap_b32 v88, v92
  v_permlane32_swap_b32 v89, v93
  v_permlane32_swap_b32 v90, v94
  v_permlane32_swap_b32 v91, v95
  v_add_f32 v88, v88, v92
  v_add_f32 v89, v89, v93
  v_add_f32 v90, v90, v94
  v_add_f32 v91, v91, v95
  ds_write_b128 v112, v[88:91]
  s_cbranch_vccnz cA_sc0_retry
cA_sc0_cont:
  s_waitcnt lgkmcnt(0)
  s_barrier
  ds_read_b64 v[36:37], v114 offset:0
  ds_read_b64 v[38:39], v114 offset:1024
  ds_read2_b32 v[44:45], v115 offset0:0 offset1:64
  s_waitcnt lgkmcnt(0)
  v_add_f32 v44, v44, v45
  v_add_f32 v36, v36, v38
  v_add_f32 v37, v37, v39
  v_add_f32_dpp v44, v44, v44 row_ror:8 row_mask:0xf bank_mask:0xf
  v_mov_b32 v45, v44
  v_permlane32_swap_b32 v36, v37
  v_add_f32 v36, v36, v37
  v_permlane16_swap_b32 v44, v45
  v_add_f32 v44, v44, v45
  v_max_f32 v38, v36, v44
  s_nop 1
  v_max_f32_dpp v38, v38, v38 quad_perm:[1,0,3,2] row_mask:0xf bank_mask:0xf
  s_nop 1
  v_max_f32_dpp v38, v38, v38 quad_perm:[2,3,0,1] row_mask:0xf bank_mask:0xf
  s_nop 1
  v_max_f32_dpp v38, v38, v38 row_half_mirror row_mask:0xf bank_mask:0xf
  s_nop 1
  v_max_f32_dpp v38, v38, v38 row_mirror row_mask:0xf bank_mask:0xf
  v_mov_b32 v39, v38
  s_nop 1
  v_permlane16_swap_b32 v38, v39
  v_max_f32 v38, v38, v39
  v_sub_f32 v36, v36, v38
  v_sub_f32 v44, v44, v38
  v_exp_f32 v36, v36
  v_exp_f32 v44, v44
  s_nop 0
  v_fma_f32 v39, v44, s37, v36
  v_cndmask_b32 v40, v44, v36, s[38:39]
  v_cndmask_b32 v41, v36, v44, s[38:39]
  v_add_f32_dpp v39, v39, v39 quad_perm:[1,0,3,2] row_mask:0xf bank_mask:0xf
  s_nop 0
  v_mov_b32_dpp v46, v41 quad_perm:[1,0,3,2] row_mask:0xf bank_mask:0xf
  v_add_f32_dpp v39, v39, v39 quad_perm:[2,3,0,1] row_mask:0xf bank_mask:0xf
  v_cndmask_b32 v42, v46, v40, s[38:39]
  v_cndmask_b32 v43, v40, v46, s[38:39]
  v_add_f32_dpp v39, v39, v39 row_half_mirror row_mask:0xf bank_mask:0xf
  s_nop 1
  v_add_f32_dpp v39, v39, v39 row_mirror row_mask:0xf bank_mask:0xf
  v_mov_b32 v47, v39
  s_nop 1
  v_permlane16_swap_b32 v39, v47
  v_add_f32 v39, v39, v47
  v_rcp_f32 v39, v39
  s_nop 0
  v_mul_f32 v42, v42, v39
  v_mul_f32 v43, v43, v39
  v_cvt_pk_bf16_f32 v42, v42, v43
  v_min_u32 v42, -2, v42
  s_mov_b64 exec, s[28:29]
  buffer_store_dword v42, v1, s[8:11], s20 offen
  s_mov_b64 exec, -1
  s_barrier
  s_add_u32 s24, s24, 28672
  s_add_u32 s35, s35, 28672
  s_xor_b32 s25, s25, 28672
  s_add_u32 m0, s25, 0
  s_nop 0
  buffer_load_dwordx4 v2, s[8:11], s24 offen offset:0 sc1 lds
  buffer_load_dwordx4 v2, s[8:11], s24 offen offset:1024 sc1 lds
  buffer_load_dwordx4 v2, s[8:11], s24 offen offset:2048 sc1 lds
  buffer_load_dwordx4 v2, s[8:11], s24 offen offset:3072 sc1 lds
  s_add_u32 m0, s25, 4096
  s_add_u32 s22, s24, 4096
  buffer_load_dwordx4 v2, s[8:11], s22 offen offset:0 sc1 lds
  buffer_load_dwordx4 v2, s[8:11], s22 offen offset:1024 sc1 lds
  buffer_load_dwordx4 v2, s[8:11], s22 offen offset:2048 sc1 lds
  v_xor_b32 v116, 28672, v116
  s_add_u32 s19, s19, 1
  s_mov_b32 s20, s21
  s_cmp_lt_u32 s19, 63
  s_cbranch_scc1 cA_sc0_loop
  s_branch cA_done
cA_sc0_retry:
  s_cmp_lg_u32 s62, 0
  s_cbranch_scc1 cA_sc0_cont
  s_waitcnt vmcnt(0) lgkmcnt(0)
cA_sc0_rv:
  buffer_load_dwordx4 v[8:11], v2, s[8:11], s20 offen offset:0 sc1
  buffer_load_dwordx4 v[12:15], v2, s[8:11], s20 offen offset:1024 sc1
  buffer_load_dwordx4 v[16:19], v2, s[8:11], s20 offen offset:2048 sc1
  buffer_load_dwordx4 v[20:23], v2, s[8:11], s20 offen offset:3072 sc1
  buffer_load_dwordx4 v[24:27], v2, s[8:11], s23 offen offset:0 sc1
  buffer_load_dwordx4 v[28:31], v2, s[8:11], s23 offen offset:1024 sc1
  buffer_load_dwordx4 v[32:35], v2, s[8:11], s23 offen offset:2048 sc1
  s_waitcnt vmcnt(0)
  v_max3_u32 v118, v8, v9, v10
  v_max3_u32 v118, v118, v11, v12
  v_max3_u32 v118, v118, v13, v14
  v_max3_u32 v118, v118, v15, v16
  v_max3_u32 v118, v118, v17, v18
  v_max3_u32 v118, v118, v19, v20
  v_max3_u32 v118, v118, v21, v22
  v_max3_u32 v118, v118, v23, v24
  v_max3_u32 v118, v118, v25, v26
  v_max3_u32 v118, v118, v27, v28
  v_max3_u32 v118, v118, v29, v30
  v_max3_u32 v118, v118, v31, v32
  v_max3_u32 v118, v118, v33, v34
  v_max_u32 v118, v118, v35
  v_cmp_eq_u32 vcc, -1, v118
  s_cbranch_vccz cA_sc0_rk
  s_add_u32 s30, s30, 1
  s_cmp_lt_u32 s30, 400000
  s_cbranch_scc1 cA_sc0_rv
  s_branch cA_abort
cA_sc0_rk:
  s_mov_b32 s62, 1
  v_mov_b32 v36, 0
  v_mov_b32 v37, 0
  v_mov_b32 v38, 0
  v_mov_b32 v39, 0
  v_mov_b32 v40, 0
  v_mov_b32 v41, 0
  v_mov_b32 v42, 0
  v_mov_b32 v43, 0
  v_mov_b32 v44, 0
  v_mov_b32 v45, 0
  v_mov_b32 v46, 0
  v_mov_b32 v47, 0
  v_mov_b32 v48, 0
  v_mov_b32 v49, 0
  v_mov_b32 v50, 0
  v_mov_b32 v51, 0
  v_mov_b32 v52, 0
  v_mov_b32 v53, 0
  v_mov_b32 v54, 0
  v_mov_b32 v55, 0
  v_mov_b32 v56, 0
  v_mov_b32 v57, 0
  v_mov_b32 v58, 0
  v_mov_b32 v59, 0
  v_mov_b32 v60, 0
  v_mov_b32 v61, 0
  v_mov_b32 v62, 0
  v_mov_b32 v63, 0
  v_mov_b32 v88, 0
  v_mov_b32 v89, 0
  v_mov_b32 v90, 0
  v_mov_b32 v91, 0
  v_mov_b32 v92, 0
  v_mov_b32 v93, 0
  v_mov_b32 v94, 0
  v_mov_b32 v95, 0
  v_mov_b32 v66, 0
  v_mov_b32 v67, 0
  s_add_u32 s31, s31, 1
  ds_read_b128 v[96:99], v116 offset:12288
  ds_read_b128 v[100:103], v116 offset:13312
  ds_read_b128 v[104:107], v116 offset:26624
  ds_read_b128 v[108:111], v116 offset:27648
  v_smfmac_f32_16x16x64_bf16 v[36:39], v[8:11], a[0:7], v3
  v_smfmac_f32_16x16x64_bf16 v[40:43], v[8:11], a[56:63], v3
  v_smfmac_f32_16x16x64_bf16 v[44:47], v[8:11], a[112:119], v3
  v_smfmac_f32_16x16x64_bf16 v[48:51], v[8:11], a[168:175], v3
  v_smfmac_f32_16x16x64_bf16 v[52:55], v[8:11], a[224:231], v3
  v_smfmac_f32_16x16x64_bf16 v[56:59], v[8:11], v[144:151], v3
  v_smfmac_f32_16x16x64_bf16 v[60:63], v[8:11], v[200:207], v3
  v_smfmac_f32_16x16x64_bf16 v[36:39], v[12:15], a[8:15], v3
  v_smfmac_f32_16x16x64_bf16 v[40:43], v[12:15], a[64:71], v3
  v_smfmac_f32_16x16x64_bf16 v[44:47], v[12:15], a[120:127], v3
  v_smfmac_f32_16x16x64_bf16 v[48:51], v[12:15], a[176:183], v3
  v_smfmac_f32_16x16x64_bf16 v[52:55], v[12:15], a[232:239], v3
  v_smfmac_f32_16x16x64_bf16 v[56:59], v[12:15], v[152:159], v3
  v_smfmac_f32_16x16x64_bf16 v[60:63], v[12:15], v[208:215], v3
  v_smfmac_f32_16x16x64_bf16 v[36:39], v[16:19], a[16:23], v3
  v_smfmac_f32_16x16x64_bf16 v[40:43], v[16:19], a[72:79], v3
  v_smfmac_f32_16x16x64_bf16 v[44:47], v[16:19], a[128:135], v3
  v_smfmac_f32_16x16x64_bf16 v[48:51], v[16:19], a[184:191], v3
  v_smfmac_f32_16x16x64_bf16 v[52:55], v[16:19], a[240:247], v3
  v_smfmac_f32_16x16x64_bf16 v[56:59], v[16:19], v[160:167], v3
  v_smfmac_f32_16x16x64_bf16 v[60:63], v[16:19], v[216:223], v3
  v_smfmac_f32_16x16x64_bf16 v[36:39], v[20:23], a[24:31], v3
  v_smfmac_f32_16x16x64_bf16 v[40:43], v[20:23], a[80:87], v3
  v_smfmac_f32_16x16x64_bf16 v[44:47], v[20:23], a[136:143], v3
  v_smfmac_f32_16x16x64_bf16 v[48:51], v[20:23], a[192:199], v3
  v_smfmac_f32_16x16x64_bf16 v[52:55], v[20:23], a[248:255], v3
  v_smfmac_f32_16x16x64_bf16 v[56:59], v[20:23], v[168:175], v3
  v_smfmac_f32_16x16x64_bf16 v[60:63], v[20:23], v[224:231], v3
  s_branch cA_sc0_ph2
cA_sc1_loop:
  s_add_u32 s23, s20, 4096
  s_add_u32 s21, s20, 25600
  v_mov_b32 v48, 0
  v_mov_b32 v49, 0
  v_mov_b32 v50, 0
  v_mov_b32 v51, 0
  v_mov_b32 v52, 0
  v_mov_b32 v53, 0
  v_mov_b32 v54, 0
  v_mov_b32 v55, 0
  v_mov_b32 v56, 0
  v_mov_b32 v57, 0
  v_mov_b32 v58, 0
  v_mov_b32 v59, 0
  v_mov_b32 v60, 0
  v_mov_b32 v61, 0
  v_mov_b32 v62, 0
  v_mov_b32 v63, 0
  v_mov_b32 v88, 0
  v_mov_b32 v89, 0
  v_mov_b32 v90, 0
  v_mov_b32 v91, 0
  v_mov_b32 v92, 0
  v_mov_b32 v93, 0
  v_mov_b32 v94, 0
  v_mov_b32 v95, 0
  v_mov_b32 v64, 0
  v_mov_b32 v65, 0
  s_mov_b32 s30, 0
  s_mov_b32 s62, 0
  s_waitcnt vmcnt(0)
  s_barrier
cA_sc1_ld:
  buffer_load_dwordx4 v[8:11], v2, s[8:11], s20 offen offset:0
  v_mov_b32 v36, 0
  v_mov_b32 v37, 0
  v_mov_b32 v38, 0
  v_mov_b32 v39, 0
  buffer_load_dwordx4 v[12:15], v2, s[8:11], s20 offen offset:1024
  v_mov_b32 v40, 0
  v_mov_b32 v41, 0
  v_mov_b32 v42, 0
  v_mov_b32 v43, 0
  buffer_load_dwordx4 v[16:19], v2, s[8:11], s20 offen offset:2048
  v_mov_b32 v44, 0
  v_mov_b32 v45, 0
  v_mov_b32 v46, 0
  v_mov_b32 v47, 0
  ds_read_b128 v[96:99], v116 offset:12288
  ds_read_b128 v[100:103], v116 offset:13312
  ds_read_b128 v[104:107], v116 offset:26624
  ds_read_b128 v[108:111], v116 offset:27648
  s_waitcnt vmcnt(2)
  v_smfmac_f32_16x16x64_bf16 v[36:39], v[8:11], a[0:7], v3
  v_smfmac_f32_16x16x64_bf16 v[40:43], v[8:11], a[56:63], v3
  buffer_load_dwordx4 v[20:23], v2, s[8:11], s20 offen offset:3072
  v_smfmac_f32_16x16x64_bf16 v[44:47], v[8:11], a[112:119], v3
  v_smfmac_f32_16x16x64_bf16 v[48:51], v[8:11], a[168:175], v3
  v_smfmac_f32_16x16x64_bf16 v[52:55], v[8:11], a[224:231], v3
  buffer_load_dwordx4 v[24:27], v2, s[8:11], s23 offen offset:0
  v_smfmac_f32_16x16x64_bf16 v[56:59], v[8:11], v[144:151], v3
  v_smfmac_f32_16x16x64_bf16 v[60:63], v[8:11], v[200:207], v3
  s_waitcnt vmcnt(3)
  v_smfmac_f32_16x16x64_bf16 v[36:39], v[12:15], a[8:15], v3
  v_smfmac_f32_16x16x64_bf16 v[40:43], v[12:15], a[64:71], v3
  buffer_load_dwordx4 v[28:31], v2, s[8:11], s23 offen offset:1024
  v_smfmac_f32_16x16x64_bf16 v[44:47], v[12:15], a[120:127], v3
  v_smfmac_f32_16x16x64_bf16 v[48:51], v[12:15], a[176:183], v3
  v_smfmac_f32_16x16x64_bf16 v[52:55], v[12:15], a[232:239], v3
  buffer_load_dwordx4 v[32:35], v2, s[8:11], s23 offen offset:2048
  v_smfmac_f32_16x16x64_bf16 v[56:59], v[12:15], v[152:159], v3
  v_smfmac_f32_16x16x64_bf16 v[60:63], v[12:15], v[208:215], v3
  s_waitcnt vmcnt(4)
  v_smfmac_f32_16x16x64_bf16 v[36:39], v[16:19], a[16:23], v3
  v_smfmac_f32_16x16x64_bf16 v[40:43], v[16:19], a[72:79], v3
  v_smfmac_f32_16x16x64_bf16 v[44:47], v[16:19], a[128:135], v3
  v_smfmac_f32_16x16x64_bf16 v[48:51], v[16:19], a[184:191], v3
  v_smfmac_f32_16x16x64_bf16 v[52:55], v[16:19], a[240:247], v3
  v_smfmac_f32_16x16x64_bf16 v[56:59], v[16:19], v[160:167], v3
  v_smfmac_f32_16x16x64_bf16 v[60:63], v[16:19], v[216:223], v3
  s_waitcnt vmcnt(3)
  v_smfmac_f32_16x16x64_bf16 v[36:39], v[20:23], a[24:31], v3
  v_smfmac_f32_16x16x64_bf16 v[40:43], v[20:23], a[80:87], v3
  v_smfmac_f32_16x16x64_bf16 v[44:47], v[20:23], a[136:143], v3
  v_smfmac_f32_16x16x64_bf16 v[48:51], v[20:23], a[192:199], v3
  v_smfmac_f32_16x16x64_bf16 v[52:55], v[20:23], a[248:255], v3
  v_smfmac_f32_16x16x64_bf16 v[56:59], v[20:23], v[168:175], v3
  v_smfmac_f32_16x16x64_bf16 v[60:63], v[20:23], v[224:231], v3
  s_waitcnt vmcnt(0)
cA_sc1_ph2:
  v_smfmac_f32_16x16x64_bf16 v[60:63], v[24:27], v[232:239], v3
  ds_read_b128 v[16:19], v116 offset:8192
  ds_read_b128 v[20:23], v116 offset:9216
  v_smfmac_f32_16x16x64_bf16 v[60:63], v[28:31], v[240:247], v3
  buffer_load_dword v119, v0, s[8:11], s20 offen sc1
  v_smfmac_f32_16x16x64_bf16 v[60:63], v[32:35], v[248:255], v3
  v_smfmac_f32_16x16x64_bf16 v[52:55], v[24:27], v[120:127], v3
  v_smfmac_f32_16x16x64_bf16 v[52:55], v[28:31], v[128:135], v3
  v_smfmac_f32_16x16x64_bf16 v[52:55], v[32:35], v[136:143], v3
  v_cvt_pk_bf16_f32 v66, v60, v61
  v_smfmac_f32_16x16x64_bf16 v[56:59], v[24:27], v[176:183], v3
  v_cvt_pk_bf16_f32 v67, v62, v63
  v_smfmac_f32_16x16x64_bf16 v[56:59], v[28:31], v[184:191], v3
  v_mfma_f32_16x16x32_bf16 v[68:71], v[64:67], v[4:7], 0
  v_smfmac_f32_16x16x64_bf16 v[56:59], v[32:35], v[192:199], v3
  v_cvt_pk_bf16_f32 v64, v52, v53
  v_smfmac_f32_16x16x64_bf16 v[36:39], v[24:27], a[32:39], v3
  v_cvt_pk_bf16_f32 v65, v54, v55
  v_smfmac_f32_16x16x64_bf16 v[36:39], v[28:31], a[40:47], v3
  v_cvt_pk_bf16_f32 v76, v68, v69
  v_smfmac_f32_16x16x64_bf16 v[36:39], v[32:35], a[48:55], v3
  v_cvt_pk_bf16_f32 v77, v70, v71
  v_cvt_pk_bf16_f32 v66, v56, v57
  v_smfmac_f32_16x16x64_bf16 v[40:43], v[24:27], a[88:95], v3
  v_cvt_pk_bf16_f32 v67, v58, v59
  v_smfmac_f32_16x16x64_bf16 v[40:43], v[28:31], a[96:103], v3
  v_mfma_f32_16x16x32_bf16 v[72:75], v[64:67], v[4:7], 0
  ds_read_b128 v[52:55], v116 offset:22528
  ds_read_b128 v[56:59], v116 offset:23552
  v_smfmac_f32_16x16x64_bf16 v[40:43], v[32:35], a[104:111], v3
  v_cvt_pk_bf16_f32 v64, v36, v37
  v_smfmac_f32_16x16x64_bf16 v[44:47], v[24:27], a[144:151], v3
  v_cvt_pk_bf16_f32 v65, v38, v39
  v_smfmac_f32_16x16x64_bf16 v[44:47], v[28:31], a[152:159], v3
  v_cvt_pk_bf16_f32 v82, v72, v73
  v_smfmac_f32_16x16x64_bf16 v[44:47], v[32:35], a[160:167], v3
  v_cvt_pk_bf16_f32 v83, v74, v75
  v_cvt_pk_bf16_f32 v66, v40, v41
  v_smfmac_f32_16x16x64_bf16 v[48:51], v[24:27], a[200:207], v3
  v_cvt_pk_bf16_f32 v67, v42, v43
  v_smfmac_f32_16x16x64_bf16 v[48:51], v[28:31], a[208:215], v3
  v_mfma_f32_16x16x32_bf16 v[68:71], v[64:67], v[4:7], 0
  ds_read_b128 v[36:39], v116 offset:2048
  ds_read_b128 v[40:43], v116 offset:3072
  v_smfmac_f32_16x16x64_bf16 v[48:51], v[32:35], a[216:223], v3
  s_waitcnt lgkmcnt(4)
  v_cvt_pk_bf16_f32 v64, v44, v45
  v_mfma_f32_16x16x32_bf16 v[84:87], v[32:35], v[76:79], 0
  v_cvt_pk_bf16_f32 v65, v46, v47
  v_smfmac_f32_16x16x64_bf16 v[88:91], v[76:79], v[96:103], v3
  ds_read_b128 v[96:99], v116 offset:16384
  ds_read_b128 v[100:103], v116 offset:17408
  v_smfmac_f32_16x16x64_bf16 v[92:95], v[76:79], v[104:111], v3
  v_cvt_pk_bf16_f32 v66, v48, v49
  v_cvt_pk_bf16_f32 v67, v50, v51
  v_mfma_f32_16x16x32_bf16 v[84:87], v[24:27], v[80:83], v[84:87]
  v_cvt_pk_bf16_f32 v60, v68, v69
  v_mfma_f32_16x16x32_bf16 v[72:75], v[64:67], v[4:7], 0
  v_cvt_pk_bf16_f32 v61, v70, v71
  s_waitcnt lgkmcnt(4)
  v_smfmac_f32_16x16x64_bf16 v[88:91], v[80:83], v[16:23], v3
  v_smfmac_f32_16x16x64_bf16 v[92:95], v[80:83], v[52:59], v3
  s_waitcnt lgkmcnt(0)
  s_nop 0
  v_cvt_pk_bf16_f32 v62, v72, v73
  v_cvt_pk_bf16_f32 v63, v74, v75
  s_nop 1
  v_mfma_f32_16x16x32_bf16 v[84:87], v[12:15], v[60:63], v[84:87]
  v_smfmac_f32_16x16x64_bf16 v[88:91], v[60:63], v[36:43], v3
  v_smfmac_f32_16x16x64_bf16 v[92:95], v[60:63], v[96:103], v3
  s_mov_b64 exec, s[26:27]
  s_nop 0
  ds_write_b128 v113, v[84:87]
  s_mov_b64 exec, -1
  s_nop 0
  v_cmp_u_f32 vcc, v88, v89
  s_nop 1
  v_permlane32_swap_b32 v88, v92
  v_permlane32_swap_b32 v89, v93
  v_permlane32_swap_b32 v90, v94
  v_permlane32_swap_b32 v91, v95
  v_add_f32 v88, v88, v92
  v_add_f32 v89, v89, v93
  v_add_f32 v90, v90, v94
  v_add_f32 v91, v91, v95
  ds_write_b128 v112, v[88:91]
  s_cbranch_vccnz cA_sc1_retry
cA_sc1_cont:
  s_waitcnt lgkmcnt(0)
  s_barrier
  ds_read_b64 v[36:37], v114 offset:0
  ds_read_b64 v[38:39], v114 offset:1024
  ds_read2_b32 v[44:45], v115 offset0:0 offset1:64
  s_waitcnt lgkmcnt(0)
  v_add_f32 v44, v44, v45
  v_add_f32 v36, v36, v38
  v_add_f32 v37, v37, v39
  v_add_f32_dpp v44, v44, v44 row_ror:8 row_mask:0xf bank_mask:0xf
  v_mov_b32 v45, v44
  v_permlane32_swap_b32 v36, v37
  v_add_f32 v36, v36, v37
  v_permlane16_swap_b32 v44, v45
  v_add_f32 v44, v44, v45
  v_max_f32 v38, v36, v44
  s_nop 1
  v_max_f32_dpp v38, v38, v38 quad_perm:[1,0,3,2] row_mask:0xf bank_mask:0xf
  s_nop 1
  v_max_f32_dpp v38, v38, v38 quad_perm:[2,3,0,1] row_mask:0xf bank_mask:0xf
  s_nop 1
  v_max_f32_dpp v38, v38, v38 row_half_mirror row_mask:0xf bank_mask:0xf
  s_nop 1
  v_max_f32_dpp v38, v38, v38 row_mirror row_mask:0xf bank_mask:0xf
  v_mov_b32 v39, v38
  s_nop 1
  v_permlane16_swap_b32 v38, v39
  v_max_f32 v38, v38, v39
  v_sub_f32 v36, v36, v38
  v_sub_f32 v44, v44, v38
  v_exp_f32 v36, v36
  v_exp_f32 v44, v44
  s_nop 0
  v_fma_f32 v39, v44, s37, v36
  v_cndmask_b32 v40, v44, v36, s[38:39]
  v_cndmask_b32 v41, v36, v44, s[38:39]
  v_add_f32_dpp v39, v39, v39 quad_perm:[1,0,3,2] row_mask:0xf bank_mask:0xf
  s_nop 0
  v_mov_b32_dpp v46, v41 quad_perm:[1,0,3,2] row_mask:0xf bank_mask:0xf
  v_add_f32_dpp v39, v39, v39 quad_perm:[2,3,0,1] row_mask:0xf bank_mask:0xf
  v_cndmask_b32 v42, v46, v40, s[38:39]
  v_cndmask_b32 v43, v40, v46, s[38:39]
  v_add_f32_dpp v39, v39, v39 row_half_mirror row_mask:0xf bank_mask:0xf
  s_nop 1
  v_add_f32_dpp v39, v39, v39 row_mirror row_mask:0xf bank_mask:0xf
  v_mov_b32 v47, v39
  s_nop 1
  v_permlane16_swap_b32 v39, v47
  v_add_f32 v39, v39, v47
  v_rcp_f32 v39, v39
  s_nop 0
  v_mul_f32 v42, v42, v39
  v_mul_f32 v43, v43, v39
  v_cvt_pk_bf16_f32 v42, v42, v43
  v_min_u32 v42, -2, v42
  s_mov_b64 exec, s[28:29]
  buffer_store_dword v42, v1, s[8:11], s20 offen
  s_mov_b64 exec, -1
  s_barrier
  s_add_u32 s24, s24, 28672
  s_add_u32 s35, s35, 28672
  s_xor_b32 s25, s25, 28672
  s_add_u32 m0, s25, 7168
  s_nop 0
  buffer_load_dwordx4 v2, s[8:11], s24 offen offset:0 sc1 lds
  buffer_load_dwordx4 v2, s[8:11], s24 offen offset:1024 sc1 lds
  buffer_load_dwordx4 v2, s[8:11], s24 offen offset:2048 sc1 lds
  buffer_load_dwordx4 v2, s[8:11], s24 offen offset:3072 sc1 lds
  s_add_u32 m0, s25, 11264
  s_add_u32 s22, s24, 4096
  buffer_load_dwordx4 v2, s[8:11], s22 offen offset:0 sc1 lds
  buffer_load_dwordx4 v2, s[8:11], s22 offen offset:1024 sc1 lds
  buffer_load_dwordx4 v2, s[8:11], s22 offen offset:2048 sc1 lds
  v_xor_b32 v116, 28672, v116
  s_add_u32 s19, s19, 1
  s_mov_b32 s20, s21
  s_cmp_lt_u32 s19, 63
  s_cbranch_scc1 cA_sc1_loop
  s_branch cA_done
cA_sc1_retry:
  s_cmp_lg_u32 s62, 0
  s_cbranch_scc1 cA_sc1_cont
  s_waitcnt vmcnt(0) lgkmcnt(0)
cA_sc1_rv:
  buffer_load_dwordx4 v[8:11], v2, s[8:11], s20 offen offset:0 sc1
  buffer_load_dwordx4 v[12:15], v2, s[8:11], s20 offen offset:1024 sc1
  buffer_load_dwordx4 v[16:19], v2, s[8:11], s20 offen offset:2048 sc1
  buffer_load_dwordx4 v[20:23], v2, s[8:11], s20 offen offset:3072 sc1
  buffer_load_dwordx4 v[24:27], v2, s[8:11], s23 offen offset:0 sc1
  buffer_load_dwordx4 v[28:31], v2, s[8:11], s23 offen offset:1024 sc1
  buffer_load_dwordx4 v[32:35], v2, s[8:11], s23 offen offset:2048 sc1
  s_waitcnt vmcnt(0)
  v_max3_u32 v118, v8, v9, v10
  v_max3_u32 v118, v118, v11, v12
  v_max3_u32 v118, v118, v13, v14
  v_max3_u32 v118, v118, v15, v16
  v_max3_u32 v118, v118, v17, v18
  v_max3_u32 v118, v118, v19, v20
  v_max3_u32 v118, v118, v21, v22
  v_max3_u32 v118, v118, v23, v24
  v_max3_u32 v118, v118, v25, v26
  v_max3_u32 v118, v118, v27, v28
  v_max3_u32 v118, v118, v29, v30
  v_max3_u32 v118, v118, v31, v32
  v_max3_u32 v118, v118, v33, v34
  v_max_u32 v118, v118, v35
  v_cmp_eq_u32 vcc, -1, v118
  s_cbranch_vccz cA_sc1_rk
  s_add_u32 s30, s30, 1
  s_cmp_lt_u32 s30, 400000
  s_cbranch_scc1 cA_sc1_rv
  s_branch cA_abort
cA_sc1_rk:
  s_mov_b32 s62, 1
  v_mov_b32 v36, 0
  v_mov_b32 v37, 0
  v_mov_b32 v38, 0
  v_mov_b32 v39, 0
  v_mov_b32 v40, 0
  v_mov_b32 v41, 0
  v_mov_b32 v42, 0
  v_mov_b32 v43, 0
  v_mov_b32 v44, 0
  v_mov_b32 v45, 0
  v_mov_b32 v46, 0
  v_mov_b32 v47, 0
  v_mov_b32 v48, 0
  v_mov_b32 v49, 0
  v_mov_b32 v50, 0
  v_mov_b32 v51, 0
  v_mov_b32 v52, 0
  v_mov_b32 v53, 0
  v_mov_b32 v54, 0
  v_mov_b32 v55, 0
  v_mov_b32 v56, 0
  v_mov_b32 v57, 0
  v_mov_b32 v58, 0
  v_mov_b32 v59, 0
  v_mov_b32 v60, 0
  v_mov_b32 v61, 0
  v_mov_b32 v62, 0
  v_mov_b32 v63, 0
  v_mov_b32 v88, 0
  v_mov_b32 v89, 0
  v_mov_b32 v90, 0
  v_mov_b32 v91, 0
  v_mov_b32 v92, 0
  v_mov_b32 v93, 0
  v_mov_b32 v94, 0
  v_mov_b32 v95, 0
  v_mov_b32 v64, 0
  v_mov_b32 v65, 0
  s_add_u32 s31, s31, 1
  ds_read_b128 v[96:99], v116 offset:12288
  ds_read_b128 v[100:103], v116 offset:13312
  ds_read_b128 v[104:107], v116 offset:26624
  ds_read_b128 v[108:111], v116 offset:27648
  v_smfmac_f32_16x16x64_bf16 v[36:39], v[8:11], a[0:7], v3
  v_smfmac_f32_16x16x64_bf16 v[40:43], v[8:11], a[56:63], v3
  v_smfmac_f32_16x16x64_bf16 v[44:47], v[8:11], a[112:119], v3
  v_smfmac_f32_16x16x64_bf16 v[48:51], v[8:11], a[168:175], v3
  v_smfmac_f32_16x16x64_bf16 v[52:55], v[8:11], a[224:231], v3
  v_smfmac_f32_16x16x64_bf16 v[56:59], v[8:11], v[144:151], v3
  v_smfmac_f32_16x16x64_bf16 v[60:63], v[8:11], v[200:207], v3
  v_smfmac_f32_16x16x64_bf16 v[36:39], v[12:15], a[8:15], v3
  v_smfmac_f32_16x16x64_bf16 v[40:43], v[12:15], a[64:71], v3
  v_smfmac_f32_16x16x64_bf16 v[44:47], v[12:15], a[120:127], v3
  v_smfmac_f32_16x16x64_bf16 v[48:51], v[12:15], a[176:183], v3
  v_smfmac_f32_16x16x64_bf16 v[52:55], v[12:15], a[232:239], v3
  v_smfmac_f32_16x16x64_bf16 v[56:59], v[12:15], v[152:159], v3
  v_smfmac_f32_16x16x64_bf16 v[60:63], v[12:15], v[208:215], v3
  v_smfmac_f32_16x16x64_bf16 v[36:39], v[16:19], a[16:23], v3
  v_smfmac_f32_16x16x64_bf16 v[40:43], v[16:19], a[72:79], v3
  v_smfmac_f32_16x16x64_bf16 v[44:47], v[16:19], a[128:135], v3
  v_smfmac_f32_16x16x64_bf16 v[48:51], v[16:19], a[184:191], v3
  v_smfmac_f32_16x16x64_bf16 v[52:55], v[16:19], a[240:247], v3
  v_smfmac_f32_16x16x64_bf16 v[56:59], v[16:19], v[160:167], v3
  v_smfmac_f32_16x16x64_bf16 v[60:63], v[16:19], v[216:223], v3
  v_smfmac_f32_16x16x64_bf16 v[36:39], v[20:23], a[24:31], v3
  v_smfmac_f32_16x16x64_bf16 v[40:43], v[20:23], a[80:87], v3
  v_smfmac_f32_16x16x64_bf16 v[44:47], v[20:23], a[136:143], v3
  v_smfmac_f32_16x16x64_bf16 v[48:51], v[20:23], a[192:199], v3
  v_smfmac_f32_16x16x64_bf16 v[52:55], v[20:23], a[248:255], v3
  v_smfmac_f32_16x16x64_bf16 v[56:59], v[20:23], v[168:175], v3
  v_smfmac_f32_16x16x64_bf16 v[60:63], v[20:23], v[224:231], v3
  s_branch cA_sc1_ph2
cA_sc2_loop:
  s_add_u32 s23, s20, 4096
  s_add_u32 s21, s20, 25600
  v_mov_b32 v48, 0
  v_mov_b32 v49, 0
  v_mov_b32 v50, 0
  v_mov_b32 v51, 0
  v_mov_b32 v52, 0
  v_mov_b32 v53, 0
  v_mov_b32 v54, 0
  v_mov_b32 v55, 0
  v_mov_b32 v56, 0
  v_mov_b32 v57, 0
  v_mov_b32 v58, 0
  v_mov_b32 v59, 0
  v_mov_b32 v60, 0
  v_mov_b32 v61, 0
  v_mov_b32 v62, 0
  v_mov_b32 v63, 0
  v_mov_b32 v88, 0
  v_mov_b32 v89, 0
  v_mov_b32 v90, 0
  v_mov_b32 v91, 0
  v_mov_b32 v92, 0
  v_mov_b32 v93, 0
  v_mov_b32 v94, 0
  v_mov_b32 v95, 0
  v_mov_b32 v66, 0
  v_mov_b32 v67, 0
  s_mov_b32 s30, 0
  s_mov_b32 s62, 0
  s_waitcnt vmcnt(0)
  s_barrier
cA_sc2_ld:
  buffer_load_dwordx4 v[8:11], v2, s[8:11], s20 offen offset:0
  v_mov_b32 v36, 0
  v_mov_b32 v37, 0
  v_mov_b32 v38, 0
  v_mov_b32 v39, 0
  buffer_load_dwordx4 v[12:15], v2, s[8:11], s20 offen offset:1024
  v_mov_b32 v40, 0
  v_mov_b32 v41, 0
  v_mov_b32 v42, 0
  v_mov_b32 v43, 0
  buffer_load_dwordx4 v[16:19], v2, s[8:11], s20 offen offset:2048
  v_mov_b32 v44, 0
  v_mov_b32 v45, 0
  v_mov_b32 v46, 0
  v_mov_b32 v47, 0
  ds_read_b128 v[96:99], v116 offset:12288
  ds_read_b128 v[100:103], v116 offset:13312
  ds_read_b128 v[104:107], v116 offset:26624
  ds_read_b128 v[108:111], v116 offset:27648
  s_waitcnt vmcnt(2)
  v_smfmac_f32_16x16x64_bf16 v[36:39], v[8:11], a[0:7], v3
  v_smfmac_f32_16x16x64_bf16 v[40:43], v[8:11], a[56:63], v3
  buffer_load_dwordx4 v[20:23], v2, s[8:11], s20 offen offset:3072
  v_smfmac_f32_16x16x64_bf16 v[44:47], v[8:11], a[112:119], v3
  v_smfmac_f32_16x16x64_bf16 v[48:51], v[8:11], a[168:175], v3
  v_smfmac_f32_16x16x64_bf16 v[52:55], v[8:11], a[224:231], v3
  buffer_load_dwordx4 v[24:27], v2, s[8:11], s23 offen offset:0
  v_smfmac_f32_16x16x64_bf16 v[56:59], v[8:11], v[144:151], v3
  v_smfmac_f32_16x16x64_bf16 v[60:63], v[8:11], v[200:207], v3
  s_waitcnt vmcnt(3)
  v_smfmac_f32_16x16x64_bf16 v[36:39], v[12:15], a[8:15], v3
  v_smfmac_f32_16x16x64_bf16 v[40:43], v[12:15], a[64:71], v3
  buffer_load_dwordx4 v[28:31], v2, s[8:11], s23 offen offset:1024
  v_smfmac_f32_16x16x64_bf16 v[44:47], v[12:15], a[120:127], v3
  v_smfmac_f32_16x16x64_bf16 v[48:51], v[12:15], a[176:183], v3
  v_smfmac_f32_16x16x64_bf16 v[52:55], v[12:15], a[232:239], v3
  buffer_load_dwordx4 v[32:35], v2, s[8:11], s23 offen offset:2048
  v_smfmac_f32_16x16x64_bf16 v[56:59], v[12:15], v[152:159], v3
  v_smfmac_f32_16x16x64_bf16 v[60:63], v[12:15], v[208:215], v3
  s_waitcnt vmcnt(4)
  v_smfmac_f32_16x16x64_bf16 v[36:39], v[16:19], a[16:23], v3
  v_smfmac_f32_16x16x64_bf16 v[40:43], v[16:19], a[72:79], v3
  v_smfmac_f32_16x16x64_bf16 v[44:47], v[16:19], a[128:135], v3
  v_smfmac_f32_16x16x64_bf16 v[48:51], v[16:19], a[184:191], v3
  v_smfmac_f32_16x16x64_bf16 v[52:55], v[16:19], a[240:247], v3
  v_smfmac_f32_16x16x64_bf16 v[56:59], v[16:19], v[160:167], v3
  v_smfmac_f32_16x16x64_bf16 v[60:63], v[16:19], v[216:223], v3
  s_waitcnt vmcnt(3)
  v_smfmac_f32_16x16x64_bf16 v[36:39], v[20:23], a[24:31], v3
  v_smfmac_f32_16x16x64_bf16 v[40:43], v[20:23], a[80:87], v3
  v_smfmac_f32_16x16x64_bf16 v[44:47], v[20:23], a[136:143], v3
  v_smfmac_f32_16x16x64_bf16 v[48:51], v[20:23], a[192:199], v3
  v_smfmac_f32_16x16x64_bf16 v[52:55], v[20:23], a[248:255], v3
  v_smfmac_f32_16x16x64_bf16 v[56:59], v[20:23], v[168:175], v3
  v_smfmac_f32_16x16x64_bf16 v[60:63], v[20:23], v[224:231], v3
  s_waitcnt vmcnt(0)
cA_sc2_ph2:
  v_smfmac_f32_16x16x64_bf16 v[60:63], v[24:27], v[232:239], v3
  ds_read_b128 v[8:11], v116 offset:10240
  ds_read_b128 v[12:15], v116 offset:11264
  v_smfmac_f32_16x16x64_bf16 v[60:63], v[28:31], v[240:247], v3
  buffer_load_dword v119, v0, s[8:11], s24 offen sc1
  v_smfmac_f32_16x16x64_bf16 v[60:63], v[32:35], v[248:255], v3
  v_smfmac_f32_16x16x64_bf16 v[52:55], v[24:27], v[120:127], v3
  v_smfmac_f32_16x16x64_bf16 v[52:55], v[28:31], v[128:135], v3
  v_smfmac_f32_16x16x64_bf16 v[52:55], v[32:35], v[136:143], v3
  v_cvt_pk_bf16_f32 v64, v60, v61
  v_smfmac_f32_16x16x64_bf16 v[56:59], v[24:27], v[176:183], v3
  v_cvt_pk_bf16_f32 v65, v62, v63
  v_smfmac_f32_16x16x64_bf16 v[56:59], v[28:31], v[184:191], v3
  v_mfma_f32_16x16x32_bf16 v[68:71], v[64:67], v[4:7], 0
  v_smfmac_f32_16x16x64_bf16 v[56:59], v[32:35], v[192:199], v3
  v_cvt_pk_bf16_f32 v64, v52, v53
  v_smfmac_f32_16x16x64_bf16 v[36:39], v[24:27], a[32:39], v3
  v_cvt_pk_bf16_f32 v65, v54, v55
  v_smfmac_f32_16x16x64_bf16 v[36:39], v[28:31], a[40:47], v3
  v_cvt_pk_bf16_f32 v78, v68, v69
  v_smfmac_f32_16x16x64_bf16 v[36:39], v[32:35], a[48:55], v3
  v_cvt_pk_bf16_f32 v79, v70, v71
  v_cvt_pk_bf16_f32 v66, v56, v57
  v_smfmac_f32_16x16x64_bf16 v[40:43], v[24:27], a[88:95], v3
  v_cvt_pk_bf16_f32 v67, v58, v59
  v_smfmac_f32_16x16x64_bf16 v[40:43], v[28:31], a[96:103], v3
  v_mfma_f32_16x16x32_bf16 v[72:75], v[64:67], v[4:7], 0
  ds_read_b128 v[52:55], v116 offset:24576
  ds_read_b128 v[56:59], v116 offset:25600
  v_smfmac_f32_16x16x64_bf16 v[40:43], v[32:35], a[104:111], v3
  v_cvt_pk_bf16_f32 v64, v36, v37
  v_smfmac_f32_16x16x64_bf16 v[44:47], v[24:27], a[144:151], v3
  v_cvt_pk_bf16_f32 v65, v38, v39
  v_smfmac_f32_16x16x64_bf16 v[44:47], v[28:31], a[152:159], v3
  v_cvt_pk_bf16_f32 v80, v72, v73
  v_smfmac_f32_16x16x64_bf16 v[44:47], v[32:35], a[160:167], v3
  v_cvt_pk_bf16_f32 v81, v74, v75
  v_cvt_pk_bf16_f32 v66, v40, v41
  v_smfmac_f32_16x16x64_bf16 v[48:51], v[24:27], a[200:207], v3
  v_cvt_pk_bf16_f32 v67, v42, v43
  v_smfmac_f32_16x16x64_bf16 v[48:51], v[28:31], a[208:215], v3
  v_mfma_f32_16x16x32_bf16 v[68:71], v[64:67], v[4:7], 0
  ds_read_b128 v[36:39], v116 offset:4096
  ds_read_b128 v[40:43], v116 offset:5120
  v_smfmac_f32_16x16x64_bf16 v[48:51], v[32:35], a[216:223], v3
  s_waitcnt lgkmcnt(4)
  v_cvt_pk_bf16_f32 v64, v44, v45
  v_mfma_f32_16x16x32_bf16 v[84:87], v[32:35], v[76:79], 0
  v_cvt_pk_bf16_f32 v65, v46, v47
  v_smfmac_f32_16x16x64_bf16 v[88:91], v[76:79], v[96:103], v3
  ds_read_b128 v[96:99], v116 offset:18432
  ds_read_b128 v[100:103], v116 offset:19456
  v_smfmac_f32_16x16x64_bf16 v[92:95], v[76:79], v[104:111], v3
  v_cvt_pk_bf16_f32 v66, v48, v49
  v_cvt_pk_bf16_f32 v67, v50, v51
  v_mfma_f32_16x16x32_bf16 v[84:87], v[28:31], v[80:83], v[84:87]
  v_cvt_pk_bf16_f32 v60, v68, v69
  v_mfma_f32_16x16x32_bf16 v[72:75], v[64:67], v[4:7], 0
  v_cvt_pk_bf16_f32 v61, v70, v71
  s_waitcnt lgkmcnt(4)
  v_smfmac_f32_16x16x64_bf16 v[88:91], v[80:83], v[8:15], v3
  v_smfmac_f32_16x16x64_bf16 v[92:95], v[80:83], v[52:59], v3
  s_waitcnt lgkmcnt(0)
  s_nop 0
  v_cvt_pk_bf16_f32 v62, v72, v73
  v_cvt_pk_bf16_f32 v63, v74, v75
  s_nop 1
  v_mfma_f32_16x16x32_bf16 v[84:87], v[16:19], v[60:63], v[84:87]
  v_smfmac_f32_16x16x64_bf16 v[88:91], v[60:63], v[36:43], v3
  v_smfmac_f32_16x16x64_bf16 v[92:95], v[60:63], v[96:103], v3
  s_mov_b64 exec, s[26:27]
  s_nop 0
  ds_write_b128 v113, v[84:87]
  s_mov_b64 exec, -1
  s_nop 0
  v_cmp_u_f32 vcc, v88, v89
  s_nop 1
  v_permlane32_swap_b32 v88, v92
  v_permlane32_swap_b32 v89, v93
  v_permlane32_swap_b32 v90, v94
  v_permlane32_swap_b32 v91, v95
  v_add_f32 v88, v88, v92
  v_add_f32 v89, v89, v93
  v_add_f32 v90, v90, v94
  v_add_f32 v91, v91, v95
  ds_write_b128 v112, v[88:91]
  s_cbranch_vccnz cA_sc2_retry
cA_sc2_cont:
  s_waitcnt lgkmcnt(0)
  s_barrier
  ds_read_b64 v[36:37], v114 offset:0
  ds_read_b64 v[38:39], v114 offset:1024
  ds_read2_b32 v[44:45], v115 offset0:0 offset1:64
  v_lshl_add_u32 v56, v2, 3, s36
  s_waitcnt lgkmcnt(0)
  v_add_f32 v44, v44, v45
  v_add_f32 v36, v36, v38
  v_add_f32 v37, v37, v39
  v_add_f32_dpp v44, v44, v44 row_ror:8 row_mask:0xf bank_mask:0xf
  v_mov_b32 v45, v44
  v_permlane32_swap_b32 v36, v37
  v_add_f32 v36, v36, v37
  v_permlane16_swap_b32 v44, v45
  v_add_f32 v44, v44, v45
  v_max_f32 v38, v36, v44
  s_mov_b64 exec, 65535
  buffer_store_dword v2, v56, s[8:11], s20 offen
  s_mov_b64 exec, -1
  v_max_f32_dpp v38, v38, v38 quad_perm:[1,0,3,2] row_mask:0xf bank_mask:0xf
  s_nop 1
  v_max_f32_dpp v38, v38, v38 quad_perm:[2,3,0,1] row_mask:0xf bank_mask:0xf
  s_nop 1
  v_max_f32_dpp v38, v38, v38 row_half_mirror row_mask:0xf bank_mask:0xf
  s_nop 1
  v_max_f32_dpp v38, v38, v38 row_mirror row_mask:0xf bank_mask:0xf
  v_mov_b32 v39, v38
  s_nop 1
  v_permlane16_swap_b32 v38, v39
  v_max_f32 v38, v38, v39
  v_sub_f32 v36, v36, v38
  v_sub_f32 v44, v44, v38
  v_exp_f32 v36, v36
  v_exp_f32 v44, v44
  s_nop 0
  v_fma_f32 v39, v44, s37, v36
  v_cndmask_b32 v40, v44, v36, s[38:39]
  v_cndmask_b32 v41, v36, v44, s[38:39]
  v_add_f32_dpp v39, v39, v39 quad_perm:[1,0,3,2] row_mask:0xf bank_mask:0xf
  s_nop 0
  v_mov_b32_dpp v46, v41 quad_perm:[1,0,3,2] row_mask:0xf bank_mask:0xf
  v_add_f32_dpp v39, v39, v39 quad_perm:[2,3,0,1] row_mask:0xf bank_mask:0xf
  v_cndmask_b32 v42, v46, v40, s[38:39]
  v_cndmask_b32 v43, v40, v46, s[38:39]
  v_add_f32_dpp v39, v39, v39 row_half_mirror row_mask:0xf bank_mask:0xf
  s_nop 1
  v_add_f32_dpp v39, v39, v39 row_mirror row_mask:0xf bank_mask:0xf
  v_mov_b32 v47, v39
  s_nop 1
  v_permlane16_swap_b32 v39, v47
  v_add_f32 v39, v39, v47
  v_rcp_f32 v39, v39
  s_nop 0
  v_mul_f32 v42, v42, v39
  v_mul_f32 v43, v43, v39
  v_cvt_pk_bf16_f32 v42, v42, v43
  v_min_u32 v42, -2, v42
  s_mov_b64 exec, s[28:29]
  buffer_store_dword v42, v1, s[8:11], s20 offen
  s_mov_b64 exec, -1
  s_barrier
  s_add_u32 s24, s24, 28672
  s_add_u32 s35, s35, 28672
  s_xor_b32 s25, s25, 28672
  s_add_u32 m0, s25, 14336
  s_nop 0
  buffer_load_dwordx4 v2, s[8:11], s24 offen offset:0 sc1 lds
  buffer_load_dwordx4 v2, s[8:11], s24 offen offset:1024 sc1 lds
  buffer_load_dwordx4 v2, s[8:11], s24 offen offset:2048 sc1 lds
  buffer_load_dwordx4 v2, s[8:11], s24 offen offset:3072 sc1 lds
  s_add_u32 m0, s25, 18432
  s_add_u32 s22, s24, 4096
  buffer_load_dwordx4 v2, s[8:11], s22 offen offset:0 sc1 lds
  buffer_load_dwordx4 v2, s[8:11], s22 offen offset:1024 sc1 lds
  buffer_load_dwordx4 v2, s[8:11], s22 offen offset:2048 sc1 lds
  v_xor_b32 v116, 28672, v116
  s_add_u32 s19, s19, 1
  s_mov_b32 s20, s21
  s_cmp_lt_u32 s19, 63
  s_cbranch_scc1 cA_sc2_loop
  s_branch cA_done
cA_sc2_retry:
  s_cmp_lg_u32 s62, 0
  s_cbranch_scc1 cA_sc2_cont
  s_waitcnt vmcnt(0) lgkmcnt(0)
cA_sc2_rv:
  buffer_load_dwordx4 v[8:11], v2, s[8:11], s20 offen offset:0 sc1
  buffer_load_dwordx4 v[12:15], v2, s[8:11], s20 offen offset:1024 sc1
  buffer_load_dwordx4 v[16:19], v2, s[8:11], s20 offen offset:2048 sc1
  buffer_load_dwordx4 v[20:23], v2, s[8:11], s20 offen offset:3072 sc1
  buffer_load_dwordx4 v[24:27], v2, s[8:11], s23 offen offset:0 sc1
  buffer_load_dwordx4 v[28:31], v2, s[8:11], s23 offen offset:1024 sc1
  buffer_load_dwordx4 v[32:35], v2, s[8:11], s23 offen offset:2048 sc1
  s_waitcnt vmcnt(0)
  v_max3_u32 v118, v8, v9, v10
  v_max3_u32 v118, v118, v11, v12
  v_max3_u32 v118, v118, v13, v14
  v_max3_u32 v118, v118, v15, v16
  v_max3_u32 v118, v118, v17, v18
  v_max3_u32 v118, v118, v19, v20
  v_max3_u32 v118, v118, v21, v22
  v_max3_u32 v118, v118, v23, v24
  v_max3_u32 v118, v118, v25, v26
  v_max3_u32 v118, v118, v27, v28
  v_max3_u32 v118, v118, v29, v30
  v_max3_u32 v118, v118, v31, v32
  v_max3_u32 v118, v118, v33, v34
  v_max_u32 v118, v118, v35
  v_cmp_eq_u32 vcc, -1, v118
  s_cbranch_vccz cA_sc2_rk
  s_add_u32 s30, s30, 1
  s_cmp_lt_u32 s30, 400000
  s_cbranch_scc1 cA_sc2_rv
  s_branch cA_abort
cA_sc2_rk:
  s_mov_b32 s62, 1
  v_mov_b32 v36, 0
  v_mov_b32 v37, 0
  v_mov_b32 v38, 0
  v_mov_b32 v39, 0
  v_mov_b32 v40, 0
  v_mov_b32 v41, 0
  v_mov_b32 v42, 0
  v_mov_b32 v43, 0
  v_mov_b32 v44, 0
  v_mov_b32 v45, 0
  v_mov_b32 v46, 0
  v_mov_b32 v47, 0
  v_mov_b32 v48, 0
  v_mov_b32 v49, 0
  v_mov_b32 v50, 0
  v_mov_b32 v51, 0
  v_mov_b32 v52, 0
  v_mov_b32 v53, 0
  v_mov_b32 v54, 0
  v_mov_b32 v55, 0
  v_mov_b32 v56, 0
  v_mov_b32 v57, 0
  v_mov_b32 v58, 0
  v_mov_b32 v59, 0
  v_mov_b32 v60, 0
  v_mov_b32 v61, 0
  v_mov_b32 v62, 0
  v_mov_b32 v63, 0
  v_mov_b32 v88, 0
  v_mov_b32 v89, 0
  v_mov_b32 v90, 0
  v_mov_b32 v91, 0
  v_mov_b32 v92, 0
  v_mov_b32 v93, 0
  v_mov_b32 v94, 0
  v_mov_b32 v95, 0
  v_mov_b32 v66, 0
  v_mov_b32 v67, 0
  s_add_u32 s31, s31, 1
  ds_read_b128 v[96:99], v116 offset:12288
  ds_read_b128 v[100:103], v116 offset:13312
  ds_read_b128 v[104:107], v116 offset:26624
  ds_read_b128 v[108:111], v116 offset:27648
  v_smfmac_f32_16x16x64_bf16 v[36:39], v[8:11], a[0:7], v3
  v_smfmac_f32_16x16x64_bf16 v[40:43], v[8:11], a[56:63], v3
  v_smfmac_f32_16x16x64_bf16 v[44:47], v[8:11], a[112:119], v3
  v_smfmac_f32_16x16x64_bf16 v[48:51], v[8:11], a[168:175], v3
  v_smfmac_f32_16x16x64_bf16 v[52:55], v[8:11], a[224:231], v3
  v_smfmac_f32_16x16x64_bf16 v[56:59], v[8:11], v[144:151], v3
  v_smfmac_f32_16x16x64_bf16 v[60:63], v[8:11], v[200:207], v3
  v_smfmac_f32_16x16x64_bf16 v[36:39], v[12:15], a[8:15], v3
  v_smfmac_f32_16x16x64_bf16 v[40:43], v[12:15], a[64:71], v3
  v_smfmac_f32_16x16x64_bf16 v[44:47], v[12:15], a[120:127], v3
  v_smfmac_f32_16x16x64_bf16 v[48:51], v[12:15], a[176:183], v3
  v_smfmac_f32_16x16x64_bf16 v[52:55], v[12:15], a[232:239], v3
  v_smfmac_f32_16x16x64_bf16 v[56:59], v[12:15], v[152:159], v3
  v_smfmac_f32_16x16x64_bf16 v[60:63], v[12:15], v[208:215], v3
  v_smfmac_f32_16x16x64_bf16 v[36:39], v[16:19], a[16:23], v3
  v_smfmac_f32_16x16x64_bf16 v[40:43], v[16:19], a[72:79], v3
  v_smfmac_f32_16x16x64_bf16 v[44:47], v[16:19], a[128:135], v3
  v_smfmac_f32_16x16x64_bf16 v[48:51], v[16:19], a[184:191], v3
  v_smfmac_f32_16x16x64_bf16 v[52:55], v[16:19], a[240:247], v3
  v_smfmac_f32_16x16x64_bf16 v[56:59], v[16:19], v[160:167], v3
  v_smfmac_f32_16x16x64_bf16 v[60:63], v[16:19], v[216:223], v3
  v_smfmac_f32_16x16x64_bf16 v[36:39], v[20:23], a[24:31], v3
  v_smfmac_f32_16x16x64_bf16 v[40:43], v[20:23], a[80:87], v3
  v_smfmac_f32_16x16x64_bf16 v[44:47], v[20:23], a[136:143], v3
  v_smfmac_f32_16x16x64_bf16 v[48:51], v[20:23], a[192:199], v3
  v_smfmac_f32_16x16x64_bf16 v[52:55], v[20:23], a[248:255], v3
  v_smfmac_f32_16x16x64_bf16 v[56:59], v[20:23], v[168:175], v3
  v_smfmac_f32_16x16x64_bf16 v[60:63], v[20:23], v[224:231], v3
  s_branch cA_sc2_ph2
cA_sc3_loop:
  s_add_u32 s23, s20, 4096
  s_add_u32 s21, s20, 25600
  v_mov_b32 v48, 0
  v_mov_b32 v49, 0
  v_mov_b32 v50, 0
  v_mov_b32 v51, 0
  v_mov_b32 v52, 0
  v_mov_b32 v53, 0
  v_mov_b32 v54, 0
  v_mov_b32 v55, 0
  v_mov_b32 v56, 0
  v_mov_b32 v57, 0
  v_mov_b32 v58, 0
  v_mov_b32 v59, 0
  v_mov_b32 v60, 0
  v_mov_b32 v61, 0
  v_mov_b32 v62, 0
  v_mov_b32 v63, 0
  v_mov_b32 v88, 0
  v_mov_b32 v89, 0
  v_mov_b32 v90, 0
  v_mov_b32 v91, 0
  v_mov_b32 v92, 0
  v_mov_b32 v93, 0
  v_mov_b32 v94, 0
  v_mov_b32 v95, 0
  v_mov_b32 v64, 0
  v_mov_b32 v65, 0
  s_mov_b32 s30, 0
  s_mov_b32 s62, 0
  s_waitcnt vmcnt(0)
  s_barrier
cA_sc3_ld:
  buffer_load_dwordx4 v[8:11], v2, s[8:11], s20 offen offset:0
  v_mov_b32 v36, 0
  v_mov_b32 v37, 0
  v_mov_b32 v38, 0
  v_mov_b32 v39, 0
  buffer_load_dwordx4 v[12:15], v2, s[8:11], s20 offen offset:1024
  v_mov_b32 v40, 0
  v_mov_b32 v41, 0
  v_mov_b32 v42, 0
  v_mov_b32 v43, 0
  buffer_load_dwordx4 v[16:19], v2, s[8:11], s20 offen offset:2048
  v_mov_b32 v44, 0
  v_mov_b32 v45, 0
  v_mov_b32 v46, 0
  v_mov_b32 v47, 0
  ds_read_b128 v[96:99], v116 offset:12288
  ds_read_b128 v[100:103], v116 offset:13312
  ds_read_b128 v[104:107], v116 offset:26624
  ds_read_b128 v[108:111], v116 offset:27648
  s_waitcnt vmcnt(2)
  v_smfmac_f32_16x16x64_bf16 v[36:39], v[8:11], a[0:7], v3
  v_smfmac_f32_16x16x64_bf16 v[40:43], v[8:11], a[56:63], v3
  buffer_load_dwordx4 v[20:23], v2, s[8:11], s20 offen offset:3072
  v_smfmac_f32_16x16x64_bf16 v[44:47], v[8:11], a[112:119], v3
  v_smfmac_f32_16x16x64_bf16 v[48:51], v[8:11], a[168:175], v3
  v_smfmac_f32_16x16x64_bf16 v[52:55], v[8:11], a[224:231], v3
  buffer_load_dwordx4 v[24:27], v2, s[8:11], s23 offen offset:0
  v_smfmac_f32_16x16x64_bf16 v[56:59], v[8:11], v[144:151], v3
  v_smfmac_f32_16x16x64_bf16 v[60:63], v[8:11], v[200:207], v3
  s_waitcnt vmcnt(3)
  v_smfmac_f32_16x16x64_bf16 v[36:39], v[12:15], a[8:15], v3
  v_smfmac_f32_16x16x64_bf16 v[40:43], v[12:15], a[64:71], v3
  buffer_load_dwordx4 v[28:31], v2, s[8:11], s23 offen offset:1024
  v_smfmac_f32_16x16x64_bf16 v[44:47], v[12:15], a[120:127], v3
  v_smfmac_f32_16x16x64_bf16 v[48:51], v[12:15], a[176:183], v3
  v_smfmac_f32_16x16x64_bf16 v[52:55], v[12:15], a[232:239], v3
  buffer_load_dwordx4 v[32:35], v2, s[8:11], s23 offen offset:2048
  v_smfmac_f32_16x16x64_bf16 v[56:59], v[12:15], v[152:159], v3
  v_smfmac_f32_16x16x64_bf16 v[60:63], v[12:15], v[208:215], v3
  s_waitcnt vmcnt(4)
  v_smfmac_f32_16x16x64_bf16 v[36:39], v[16:19], a[16:23], v3
  v_smfmac_f32_16x16x64_bf16 v[40:43], v[16:19], a[72:79], v3
  v_smfmac_f32_16x16x64_bf16 v[44:47], v[16:19], a[128:135], v3
  v_smfmac_f32_16x16x64_bf16 v[48:51], v[16:19], a[184:191], v3
  v_smfmac_f32_16x16x64_bf16 v[52:55], v[16:19], a[240:247], v3
  v_smfmac_f32_16x16x64_bf16 v[56:59], v[16:19], v[160:167], v3
  v_smfmac_f32_16x16x64_bf16 v[60:63], v[16:19], v[216:223], v3
  s_waitcnt vmcnt(3)
  v_smfmac_f32_16x16x64_bf16 v[36:39], v[20:23], a[24:31], v3
  v_smfmac_f32_16x16x64_bf16 v[40:43], v[20:23], a[80:87], v3
  v_smfmac_f32_16x16x64_bf16 v[44:47], v[20:23], a[136:143], v3
  v_smfmac_f32_16x16x64_bf16 v[48:51], v[20:23], a[192:199], v3
  v_smfmac_f32_16x16x64_bf16 v[52:55], v[20:23], a[248:255], v3
  v_smfmac_f32_16x16x64_bf16 v[56:59], v[20:23], v[168:175], v3
  v_smfmac_f32_16x16x64_bf16 v[60:63], v[20:23], v[224:231], v3
  s_waitcnt vmcnt(0)
cA_sc3_ph2:
  v_smfmac_f32_16x16x64_bf16 v[60:63], v[24:27], v[232:239], v3
  ds_read_b128 v[8:11], v116 offset:10240
  ds_read_b128 v[12:15], v116 offset:11264
  v_smfmac_f32_16x16x64_bf16 v[60:63], v[28:31], v[240:247], v3
  v_smfmac_f32_16x16x64_bf16 v[60:63], v[32:35], v[248:255], v3
  v_smfmac_f32_16x16x64_bf16 v[52:55], v[24:27], v[120:127], v3
  v_smfmac_f32_16x16x64_bf16 v[52:55], v[28:31], v[128:135], v3
  v_smfmac_f32_16x16x64_bf16 v[52:55], v[32:35], v[136:143], v3
  v_cvt_pk_bf16_f32 v66, v60, v61
  v_smfmac_f32_16x16x64_bf16 v[56:59], v[24:27], v[176:183], v3
  v_cvt_pk_bf16_f32 v67, v62, v63
  v_smfmac_f32_16x16x64_bf16 v[56:59], v[28:31], v[184:191], v3
  v_mfma_f32_16x16x32_bf16 v[68:71], v[64:67], v[4:7], 0
  v_smfmac_f32_16x16x64_bf16 v[56:59], v[32:35], v[192:199], v3
  v_cvt_pk_bf16_f32 v64, v52, v53
  v_smfmac_f32_16x16x64_bf16 v[36:39], v[24:27], a[32:39], v3
  v_cvt_pk_bf16_f32 v65, v54, v55
  v_smfmac_f32_16x16x64_bf16 v[36:39], v[28:31], a[40:47], v3
  v_cvt_pk_bf16_f32 v78, v68, v69
  v_smfmac_f32_16x16x64_bf16 v[36:39], v[32:35], a[48:55], v3
  v_cvt_pk_bf16_f32 v79, v70, v71
  v_cvt_pk_bf16_f32 v66, v56, v57
  v_smfmac_f32_16x16x64_bf16 v[40:43], v[24:27], a[88:95], v3
  v_cvt_pk_bf16_f32 v67, v58, v59
  v_smfmac_f32_16x16x64_bf16 v[40:43], v[28:31], a[96:103], v3
  v_mfma_f32_16x16x32_bf16 v[72:75], v[64:67], v[4:7], 0
  ds_read_b128 v[52:55], v116 offset:24576
  ds_read_b128 v[56:59], v116 offset:25600
  v_smfmac_f32_16x16x64_bf16 v[40:43], v[32:35], a[104:111], v3
  v_cvt_pk_bf16_f32 v64, v36, v37
  v_smfmac_f32_16x16x64_bf16 v[44:47], v[24:27], a[144:151], v3
  v_cvt_pk_bf16_f32 v65, v38, v39
  v_smfmac_f32_16x16x64_bf16 v[44:47], v[28:31], a[152:159], v3
  v_cvt_pk_bf16_f32 v82, v72, v73
  v_smfmac_f32_16x16x64_bf16 v[44:47], v[32:35], a[160:167], v3
  v_cvt_pk_bf16_f32 v83, v74, v75
  v_cvt_pk_bf16_f32 v66, v40, v41
  v_smfmac_f32_16x16x64_bf16 v[48:51], v[24:27], a[200:207], v3
  v_cvt_pk_bf16_f32 v67, v42, v43
  v_smfmac_f32_16x16x64_bf16 v[48:51], v[28:31], a[208:215], v3
  v_mfma_f32_16x16x32_bf16 v[68:71], v[64:67], v[4:7], 0
  ds_read_b128 v[36:39], v116 offset:6144
  ds_read_b128 v[40:43], v116 offset:7168
  v_smfmac_f32_16x16x64_bf16 v[48:51], v[32:35], a[216:223], v3
  s_waitcnt lgkmcnt(4)
  v_cvt_pk_bf16_f32 v64, v44, v45
  v_mfma_f32_16x16x32_bf16 v[84:87], v[32:35], v[76:79], 0
  v_cvt_pk_bf16_f32 v65, v46, v47
  v_smfmac_f32_16x16x64_bf16 v[88:91], v[76:79], v[96:103], v3
  ds_read_b128 v[96:99], v116 offset:20480
  ds_read_b128 v[100:103], v116 offset:21504
  v_smfmac_f32_16x16x64_bf16 v[92:95], v[76:79], v[104:111], v3
  v_cvt_pk_bf16_f32 v66, v48, v49
  v_cvt_pk_bf16_f32 v67, v50, v51
  v_mfma_f32_16x16x32_bf16 v[84:87], v[28:31], v[80:83], v[84:87]
  v_cvt_pk_bf16_f32 v60, v68, v69
  v_mfma_f32_16x16x32_bf16 v[72:75], v[64:67], v[4:7], 0
  v_cvt_pk_bf16_f32 v61, v70, v71
  s_waitcnt lgkmcnt(4)
  v_smfmac_f32_16x16x64_bf16 v[88:91], v[80:83], v[8:15], v3
  v_smfmac_f32_16x16x64_bf16 v[92:95], v[80:83], v[52:59], v3
  s_waitcnt lgkmcnt(0)
  s_nop 0
  v_cvt_pk_bf16_f32 v62, v72, v73
  v_cvt_pk_bf16_f32 v63, v74, v75
  s_nop 1
  v_mfma_f32_16x16x32_bf16 v[84:87], v[20:23], v[60:63], v[84:87]
  v_smfmac_f32_16x16x64_bf16 v[88:91], v[60:63], v[36:43], v3
  v_smfmac_f32_16x16x64_bf16 v[92:95], v[60:63], v[96:103], v3
  s_mov_b64 exec, s[26:27]
  s_nop 0
  ds_write_b128 v113, v[84:87]
  s_mov_b64 exec, -1
  s_nop 0
  v_cmp_u_f32 vcc, v88, v89
  s_nop 1
  v_permlane32_swap_b32 v88, v92
  v_permlane32_swap_b32 v89, v93
  v_permlane32_swap_b32 v90, v94
  v_permlane32_swap_b32 v91, v95
  v_add_f32 v88, v88, v92
  v_add_f32 v89, v89, v93
  v_add_f32 v90, v90, v94
  v_add_f32 v91, v91, v95
  ds_write_b128 v112, v[88:91]
  s_cbranch_vccnz cA_sc3_retry
cA_sc3_cont:
  s_waitcnt lgkmcnt(0)
  s_barrier
  ds_read_b64 v[36:37], v114 offset:0
  ds_read_b64 v[38:39], v114 offset:1024
  ds_read2_b32 v[44:45], v115 offset0:0 offset1:64
  s_waitcnt lgkmcnt(0)
  v_add_f32 v44, v44, v45
  v_add_f32 v36, v36, v38
  v_add_f32 v37, v37, v39
  v_add_f32_dpp v44, v44, v44 row_ror:8 row_mask:0xf bank_mask:0xf
  v_mov_b32 v45, v44
  v_permlane32_swap_b32 v36, v37
  v_add_f32 v36, v36, v37
  v_permlane16_swap_b32 v44, v45
  v_add_f32 v44, v44, v45
  v_max_f32 v38, v36, v44
  s_nop 1
  v_max_f32_dpp v38, v38, v38 quad_perm:[1,0,3,2] row_mask:0xf bank_mask:0xf
  s_nop 1
  v_max_f32_dpp v38, v38, v38 quad_perm:[2,3,0,1] row_mask:0xf bank_mask:0xf
  s_nop 1
  v_max_f32_dpp v38, v38, v38 row_half_mirror row_mask:0xf bank_mask:0xf
  s_nop 1
  v_max_f32_dpp v38, v38, v38 row_mirror row_mask:0xf bank_mask:0xf
  v_mov_b32 v39, v38
  s_nop 1
  v_permlane16_swap_b32 v38, v39
  v_max_f32 v38, v38, v39
  v_sub_f32 v36, v36, v38
  v_sub_f32 v44, v44, v38
  v_exp_f32 v36, v36
  v_exp_f32 v44, v44
  s_nop 0
  v_fma_f32 v39, v44, s37, v36
  v_cndmask_b32 v40, v44, v36, s[38:39]
  v_cndmask_b32 v41, v36, v44, s[38:39]
  v_add_f32_dpp v39, v39, v39 quad_perm:[1,0,3,2] row_mask:0xf bank_mask:0xf
  s_nop 0
  v_mov_b32_dpp v46, v41 quad_perm:[1,0,3,2] row_mask:0xf bank_mask:0xf
  v_add_f32_dpp v39, v39, v39 quad_perm:[2,3,0,1] row_mask:0xf bank_mask:0xf
  v_cndmask_b32 v42, v46, v40, s[38:39]
  v_cndmask_b32 v43, v40, v46, s[38:39]
  v_add_f32_dpp v39, v39, v39 row_half_mirror row_mask:0xf bank_mask:0xf
  s_nop 1
  v_add_f32_dpp v39, v39, v39 row_mirror row_mask:0xf bank_mask:0xf
  v_mov_b32 v47, v39
  s_nop 1
  v_permlane16_swap_b32 v39, v47
  v_add_f32 v39, v39, v47
  v_rcp_f32 v39, v39
  s_nop 0
  v_mul_f32 v42, v42, v39
  v_mul_f32 v43, v43, v39
  v_cvt_pk_bf16_f32 v42, v42, v43
  v_min_u32 v42, -2, v42
  s_mov_b64 exec, s[28:29]
  buffer_store_dword v42, v1, s[8:11], s20 offen
  s_mov_b64 exec, -1
  s_barrier
  s_add_u32 s24, s24, 28672
  s_add_u32 s35, s35, 28672
  s_xor_b32 s25, s25, 28672
  s_add_u32 m0, s25, 21504
  s_nop 0
  buffer_load_dwordx4 v2, s[8:11], s24 offen offset:0 sc1 lds
  buffer_load_dwordx4 v2, s[8:11], s24 offen offset:1024 sc1 lds
  buffer_load_dwordx4 v2, s[8:11], s24 offen offset:2048 sc1 lds
  buffer_load_dwordx4 v2, s[8:11], s24 offen offset:3072 sc1 lds
  s_add_u32 m0, s25, 25600
  s_add_u32 s22, s24, 4096
  buffer_load_dwordx4 v2, s[8:11], s22 offen offset:0 sc1 lds
  buffer_load_dwordx4 v2, s[8:11], s22 offen offset:1024 sc1 lds
  buffer_load_dwordx4 v2, s[8:11], s22 offen offset:2048 sc1 lds
  v_xor_b32 v116, 28672, v116
  s_add_u32 s19, s19, 1
  s_mov_b32 s20, s21
  s_cmp_lt_u32 s19, 63
  s_cbranch_scc1 cA_sc3_loop
  s_branch cA_done
cA_sc3_retry:
  s_cmp_lg_u32 s62, 0
  s_cbranch_scc1 cA_sc3_cont
  s_waitcnt vmcnt(0) lgkmcnt(0)
cA_sc3_rv:
  buffer_load_dwordx4 v[8:11], v2, s[8:11], s20 offen offset:0 sc1
  buffer_load_dwordx4 v[12:15], v2, s[8:11], s20 offen offset:1024 sc1
  buffer_load_dwordx4 v[16:19], v2, s[8:11], s20 offen offset:2048 sc1
  buffer_load_dwordx4 v[20:23], v2, s[8:11], s20 offen offset:3072 sc1
  buffer_load_dwordx4 v[24:27], v2, s[8:11], s23 offen offset:0 sc1
  buffer_load_dwordx4 v[28:31], v2, s[8:11], s23 offen offset:1024 sc1
  buffer_load_dwordx4 v[32:35], v2, s[8:11], s23 offen offset:2048 sc1
  s_waitcnt vmcnt(0)
  v_max3_u32 v118, v8, v9, v10
  v_max3_u32 v118, v118, v11, v12
  v_max3_u32 v118, v118, v13, v14
  v_max3_u32 v118, v118, v15, v16
  v_max3_u32 v118, v118, v17, v18
  v_max3_u32 v118, v118, v19, v20
  v_max3_u32 v118, v118, v21, v22
  v_max3_u32 v118, v118, v23, v24
  v_max3_u32 v118, v118, v25, v26
  v_max3_u32 v118, v118, v27, v28
  v_max3_u32 v118, v118, v29, v30
  v_max3_u32 v118, v118, v31, v32
  v_max3_u32 v118, v118, v33, v34
  v_max_u32 v118, v118, v35
  v_cmp_eq_u32 vcc, -1, v118
  s_cbranch_vccz cA_sc3_rk
  s_add_u32 s30, s30, 1
  s_cmp_lt_u32 s30, 400000
  s_cbranch_scc1 cA_sc3_rv
  s_branch cA_abort
cA_sc3_rk:
  s_mov_b32 s62, 1
  v_mov_b32 v36, 0
  v_mov_b32 v37, 0
  v_mov_b32 v38, 0
  v_mov_b32 v39, 0
  v_mov_b32 v40, 0
  v_mov_b32 v41, 0
  v_mov_b32 v42, 0
  v_mov_b32 v43, 0
  v_mov_b32 v44, 0
  v_mov_b32 v45, 0
  v_mov_b32 v46, 0
  v_mov_b32 v47, 0
  v_mov_b32 v48, 0
  v_mov_b32 v49, 0
  v_mov_b32 v50, 0
  v_mov_b32 v51, 0
  v_mov_b32 v52, 0
  v_mov_b32 v53, 0
  v_mov_b32 v54, 0
  v_mov_b32 v55, 0
  v_mov_b32 v56, 0
  v_mov_b32 v57, 0
  v_mov_b32 v58, 0
  v_mov_b32 v59, 0
  v_mov_b32 v60, 0
  v_mov_b32 v61, 0
  v_mov_b32 v62, 0
  v_mov_b32 v63, 0
  v_mov_b32 v88, 0
  v_mov_b32 v89, 0
  v_mov_b32 v90, 0
  v_mov_b32 v91, 0
  v_mov_b32 v92, 0
  v_mov_b32 v93, 0
  v_mov_b32 v94, 0
  v_mov_b32 v95, 0
  v_mov_b32 v64, 0
  v_mov_b32 v65, 0
  s_add_u32 s31, s31, 1
  ds_read_b128 v[96:99], v116 offset:12288
  ds_read_b128 v[100:103], v116 offset:13312
  ds_read_b128 v[104:107], v116 offset:26624
  ds_read_b128 v[108:111], v116 offset:27648
  v_smfmac_f32_16x16x64_bf16 v[36:39], v[8:11], a[0:7], v3
  v_smfmac_f32_16x16x64_bf16 v[40:43], v[8:11], a[56:63], v3
  v_smfmac_f32_16x16x64_bf16 v[44:47], v[8:11], a[112:119], v3
  v_smfmac_f32_16x16x64_bf16 v[48:51], v[8:11], a[168:175], v3
  v_smfmac_f32_16x16x64_bf16 v[52:55], v[8:11], a[224:231], v3
  v_smfmac_f32_16x16x64_bf16 v[56:59], v[8:11], v[144:151], v3
  v_smfmac_f32_16x16x64_bf16 v[60:63], v[8:11], v[200:207], v3
  v_smfmac_f32_16x16x64_bf16 v[36:39], v[12:15], a[8:15], v3
  v_smfmac_f32_16x16x64_bf16 v[40:43], v[12:15], a[64:71], v3
  v_smfmac_f32_16x16x64_bf16 v[44:47], v[12:15], a[120:127], v3
  v_smfmac_f32_16x16x64_bf16 v[48:51], v[12:15], a[176:183], v3
  v_smfmac_f32_16x16x64_bf16 v[52:55], v[12:15], a[232:239], v3
  v_smfmac_f32_16x16x64_bf16 v[56:59], v[12:15], v[152:159], v3
  v_smfmac_f32_16x16x64_bf16 v[60:63], v[12:15], v[208:215], v3
  v_smfmac_f32_16x16x64_bf16 v[36:39], v[16:19], a[16:23], v3
  v_smfmac_f32_16x16x64_bf16 v[40:43], v[16:19], a[72:79], v3
  v_smfmac_f32_16x16x64_bf16 v[44:47], v[16:19], a[128:135], v3
  v_smfmac_f32_16x16x64_bf16 v[48:51], v[16:19], a[184:191], v3
  v_smfmac_f32_16x16x64_bf16 v[52:55], v[16:19], a[240:247], v3
  v_smfmac_f32_16x16x64_bf16 v[56:59], v[16:19], v[160:167], v3
  v_smfmac_f32_16x16x64_bf16 v[60:63], v[16:19], v[216:223], v3
  v_smfmac_f32_16x16x64_bf16 v[36:39], v[20:23], a[24:31], v3
  v_smfmac_f32_16x16x64_bf16 v[40:43], v[20:23], a[80:87], v3
  v_smfmac_f32_16x16x64_bf16 v[44:47], v[20:23], a[136:143], v3
  v_smfmac_f32_16x16x64_bf16 v[48:51], v[20:23], a[192:199], v3
  v_smfmac_f32_16x16x64_bf16 v[52:55], v[20:23], a[248:255], v3
  v_smfmac_f32_16x16x64_bf16 v[56:59], v[20:23], v[168:175], v3
  v_smfmac_f32_16x16x64_bf16 v[60:63], v[20:23], v[224:231], v3
  s_branch cA_sc3_ph2
cA_va0_loop:
  s_add_u32 s23, s20, 4096
  s_add_u32 s21, s20, 25600
  s_mov_b32 s30, 0
  s_cmp_lg_u32 s19, s38
  s_cbranch_scc1 cA_va0_vok
  s_branch cA_va0_voc
cA_va0_vow:
  buffer_load_dword v175, off, s[8:11], s35 sc1
  s_waitcnt vmcnt(0)
cA_va0_voc:
  v_readfirstlane_b32 s22, v175
  s_cmp_eq_u32 s22, 56
  s_cbranch_scc1 cA_va0_vod
  s_sleep 1
  s_add_u32 s30, s30, 1
  s_cmp_lt_u32 s30, 400000
  s_cbranch_scc1 cA_va0_vow
  s_branch cA_abort
cA_va0_vod:
  s_add_u32 s35, s35, 2048
  s_add_u32 s38, s19, 8
  s_and_b32 s38, s38, -8
  s_cmp_eq_u32 s19, 0
  s_cselect_b32 s38, 4, s38
cA_va0_vok:
  s_cmp_eq_u32 s19, 63
  s_cbranch_scc1 cA_done
  s_barrier
  s_add_u32 s22, s25, 0
  buffer_load_dwordx4 v[80:83], v6, s[8:11], s22 offen offset:0 sc1
  buffer_load_dwordx4 v[84:87], v6, s[8:11], s22 offen offset:1792 sc1
  s_add_u32 s22, s25, 3584
  buffer_load_dwordx4 v[88:91], v6, s[8:11], s22 offen offset:0 sc1
  buffer_load_dwordx4 v[92:95], v6, s[8:11], s22 offen offset:1792 sc1
  s_add_u32 s22, s25, 7168
  buffer_load_dwordx4 v[96:99], v6, s[8:11], s22 offen offset:0 sc1
  buffer_load_dwordx4 v[100:103], v6, s[8:11], s22 offen offset:1792 sc1
  s_add_u32 s22, s25, 10752
  buffer_load_dwordx4 v[104:107], v6, s[8:11], s22 offen offset:0 sc1
  buffer_load_dwordx4 v[108:111], v6, s[8:11], s22 offen offset:1792 sc1
  s_add_u32 s22, s25, 14336
  buffer_load_dwordx4 v[112:115], v6, s[8:11], s22 offen offset:0 sc1
  buffer_load_dwordx4 v[116:119], v6, s[8:11], s22 offen offset:1792 sc1
  s_add_u32 s22, s25, 17920
  buffer_load_dwordx4 v[120:123], v6, s[8:11], s22 offen offset:0 sc1
  buffer_load_dwordx4 v[124:127], v6, s[8:11], s22 offen offset:1792 sc1
  s_add_u32 s22, s25, 21504
  buffer_load_dwordx4 v[128:131], v6, s[8:11], s22 offen offset:0 sc1
  buffer_load_dwordx4 v[132:135], v6, s[8:11], s22 offen offset:1792 sc1
  s_add_u32 s22, s25, 25088
  buffer_load_dwordx4 v[136:139], v6, s[8:11], s22 offen offset:0 sc1
  buffer_load_dwordx4 v[140:143], v6, s[8:11], s22 offen offset:1792 sc1
  buffer_load_dword v175, off, s[8:11], s35 sc1
  s_barrier
  ds_read_b128 v[8:11], v2 offset:8192
  ds_read_b128 v[12:15], v2 offset:9216
  ds_read_b128 v[16:19], v2 offset:10240
  ds_read_b128 v[20:23], v2 offset:11264
  ds_read_b128 v[24:27], v2 offset:12288
  ds_read_b128 v[28:31], v2 offset:13312
  ds_read_b128 v[32:35], v2 offset:14336
  s_waitcnt lgkmcnt(0)
  v_smfmac_f32_16x16x64_bf16 v[36:39], v[8:11], a[0:7], v3
  v_smfmac_f32_16x16x64_bf16 v[36:39], v[12:15], a[8:15], v3
  v_smfmac_f32_16x16x64_bf16 v[36:39], v[16:19], a[16:23], v3
  v_smfmac_f32_16x16x64_bf16 v[36:39], v[20:23], a[24:31], v3
  v_smfmac_f32_16x16x64_bf16 v[36:39], v[24:27], a[32:39], v3
  v_smfmac_f32_16x16x64_bf16 v[36:39], v[28:31], a[40:47], v3
  v_smfmac_f32_16x16x64_bf16 v[36:39], v[32:35], a[48:55], v3
  v_smfmac_f32_16x16x64_bf16 v[40:43], v[8:11], a[56:63], v3
  v_smfmac_f32_16x16x64_bf16 v[40:43], v[12:15], a[64:71], v3
  v_smfmac_f32_16x16x64_bf16 v[40:43], v[16:19], a[72:79], v3
  v_smfmac_f32_16x16x64_bf16 v[40:43], v[20:23], a[80:87], v3
  v_smfmac_f32_16x16x64_bf16 v[40:43], v[24:27], a[88:95], v3
  v_smfmac_f32_16x16x64_bf16 v[40:43], v[28:31], a[96:103], v3
  v_smfmac_f32_16x16x64_bf16 v[40:43], v[32:35], a[104:111], v3
  v_smfmac_f32_16x16x64_bf16 v[44:47], v[8:11], a[112:119], v3
  v_smfmac_f32_16x16x64_bf16 v[44:47], v[12:15], a[120:127], v3
  v_smfmac_f32_16x16x64_bf16 v[44:47], v[16:19], a[128:135], v3
  v_smfmac_f32_16x16x64_bf16 v[44:47], v[20:23], a[136:143], v3
  v_permlane32_swap_b32 v36, v40
  v_smfmac_f32_16x16x64_bf16 v[44:47], v[24:27], a[144:151], v3
  v_permlane32_swap_b32 v37, v41
  v_smfmac_f32_16x16x64_bf16 v[44:47], v[28:31], a[152:159], v3
  v_permlane32_swap_b32 v38, v42
  v_smfmac_f32_16x16x64_bf16 v[44:47], v[32:35], a[160:167], v3
  v_permlane32_swap_b32 v39, v43
  v_smfmac_f32_16x16x64_bf16 v[48:51], v[8:11], a[168:175], v3
  v_add_f32 v36, v36, v40
  v_smfmac_f32_16x16x64_bf16 v[48:51], v[12:15], a[176:183], v3
  v_add_f32 v37, v37, v41
  v_smfmac_f32_16x16x64_bf16 v[48:51], v[16:19], a[184:191], v3
  v_add_f32 v38, v38, v42
  v_smfmac_f32_16x16x64_bf16 v[48:51], v[20:23], a[192:199], v3
  v_add_f32 v39, v39, v43
  v_smfmac_f32_16x16x64_bf16 v[48:51], v[24:27], a[200:207], v3
  v_cvt_pk_bf16_f32 v40, v36, v37
  v_smfmac_f32_16x16x64_bf16 v[48:51], v[28:31], a[208:215], v3
  v_cvt_pk_bf16_f32 v41, v38, v39
  v_smfmac_f32_16x16x64_bf16 v[48:51], v[32:35], a[216:223], v3
  ds_write_b64 v60, v[40:41]
  v_smfmac_f32_16x16x64_bf16 v[52:55], v[8:11], a[224:231], v3
  v_smfmac_f32_16x16x64_bf16 v[52:55], v[12:15], a[232:239], v3
  v_smfmac_f32_16x16x64_bf16 v[52:55], v[16:19], a[240:247], v3
  v_smfmac_f32_16x16x64_bf16 v[52:55], v[20:23], a[248:255], v3
  v_permlane32_swap_b32 v44, v48
  v_smfmac_f32_16x16x64_bf16 v[52:55], v[24:27], v[176:183], v3
  v_permlane32_swap_b32 v45, v49
  v_smfmac_f32_16x16x64_bf16 v[52:55], v[28:31], v[184:191], v3
  v_permlane32_swap_b32 v46, v50
  v_smfmac_f32_16x16x64_bf16 v[52:55], v[32:35], v[192:199], v3
  v_permlane32_swap_b32 v47, v51
  v_smfmac_f32_16x16x64_bf16 v[56:59], v[8:11], v[200:207], v3
  v_add_f32 v44, v44, v48
  v_smfmac_f32_16x16x64_bf16 v[56:59], v[12:15], v[208:215], v3
  v_add_f32 v45, v45, v49
  v_smfmac_f32_16x16x64_bf16 v[56:59], v[16:19], v[216:223], v3
  v_add_f32 v46, v46, v50
  v_smfmac_f32_16x16x64_bf16 v[56:59], v[20:23], v[224:231], v3
  v_add_f32 v47, v47, v51
  v_smfmac_f32_16x16x64_bf16 v[56:59], v[24:27], v[232:239], v3
  v_cvt_pk_bf16_f32 v48, v44, v45
  v_smfmac_f32_16x16x64_bf16 v[56:59], v[28:31], v[240:247], v3
  v_cvt_pk_bf16_f32 v49, v46, v47
  v_smfmac_f32_16x16x64_bf16 v[56:59], v[32:35], v[248:255], v3
  ds_write_b64 v61, v[48:49]
  s_nop 6
  v_permlane32_swap_b32 v52, v56
  v_permlane32_swap_b32 v53, v57
  v_permlane32_swap_b32 v54, v58
  v_permlane32_swap_b32 v55, v59
  v_add_f32 v52, v52, v56
  v_add_f32 v53, v53, v57
  v_add_f32 v54, v54, v58
  v_add_f32 v55, v55, v59
  v_cvt_pk_bf16_f32 v56, v52, v53
  v_cvt_pk_bf16_f32 v57, v54, v55
  ds_write_b64 v62, v[56:57]
  s_cmp_eq_u32 s19, 63
  s_cbranch_scc1 cA_va0_last
  s_add_u32 s22, s20, 9216
  s_add_u32 s34, s20, 13312
  s_add_u32 s36, s20, 7168
  s_mov_b32 s37, 0
  buffer_load_dword v164, v4, s[8:11], s20 offen sc1
  s_nop 7
  buffer_load_dword v165, v4, s[8:11], s20 offen sc1
  s_nop 7
  buffer_load_dword v166, v4, s[8:11], s20 offen sc1
  s_nop 7
  buffer_load_dword v167, v4, s[8:11], s20 offen sc1
  s_nop 7
  buffer_load_dword v168, v4, s[8:11], s20 offen sc1
cA_va0_fw_l:
  s_waitcnt vmcnt(4)
  v_cmp_eq_u32 vcc, -1, v164
  s_cbranch_vccz cA_va0_fw_d
  buffer_load_dword v164, v4, s[8:11], s20 offen sc1
  s_waitcnt vmcnt(4)
  v_cmp_eq_u32 vcc, -1, v165
  s_cbranch_vccz cA_va0_fw_d
  buffer_load_dword v165, v4, s[8:11], s20 offen sc1
  s_waitcnt vmcnt(4)
  v_cmp_eq_u32 vcc, -1, v166
  s_cbranch_vccz cA_va0_fw_d
  buffer_load_dword v166, v4, s[8:11], s20 offen sc1
  s_waitcnt vmcnt(4)
  v_cmp_eq_u32 vcc, -1, v167
  s_cbranch_vccz cA_va0_fw_d
  buffer_load_dword v167, v4, s[8:11], s20 offen sc1
  s_waitcnt vmcnt(4)
  v_cmp_eq_u32 vcc, -1, v168
  s_cbranch_vccz cA_va0_fw_d
  buffer_load_dword v168, v4, s[8:11], s20 offen sc1
  s_add_u32 s30, s30, 1
  s_cmp_lt_u32 s30, 400000
  s_cbranch_scc1 cA_va0_fw_l
  s_branch cA_abort
cA_va0_fw_d:
  s_waitcnt lgkmcnt(0)
  buffer_load_dwordx4 v[8:11], v2, s[8:11], s22 offen offset:0
  v_mov_b32 v36, 0
  v_mov_b32 v37, 0
  v_mov_b32 v38, 0
  buffer_load_dwordx4 v[12:15], v2, s[8:11], s22 offen offset:1024
  v_mov_b32 v39, 0
  v_mov_b32 v40, 0
  v_mov_b32 v41, 0
  buffer_load_dwordx4 v[16:19], v2, s[8:11], s22 offen offset:2048
  v_mov_b32 v42, 0
  v_mov_b32 v43, 0
  v_mov_b32 v44, 0
  buffer_load_dwordx4 v[20:23], v2, s[8:11], s22 offen offset:3072
  v_mov_b32 v45, 0
  v_mov_b32 v46, 0
  v_mov_b32 v47, 0
  buffer_load_dwordx4 v[24:27], v2, s[8:11], s34 offen offset:0
  v_mov_b32 v48, 0
  v_mov_b32 v49, 0
  v_mov_b32 v50, 0
  buffer_load_dwordx4 v[28:31], v2, s[8:11], s34 offen offset:1024
  v_mov_b32 v51, 0
  v_mov_b32 v52, 0
  v_mov_b32 v53, 0
  buffer_load_dwordx4 v[32:35], v2, s[8:11], s34 offen offset:2048
  v_mov_b32 v54, 0
  v_mov_b32 v55, 0
  v_mov_b32 v56, 0
  buffer_load_dwordx4 v[144:147], v2, s[8:11], s34 offen offset:3072
  v_mov_b32 v57, 0
  v_mov_b32 v58, 0
  v_mov_b32 v59, 0
  buffer_load_dwordx4 v[148:151], v2, s[8:11], s36 offen offset:0
  buffer_load_dwordx4 v[152:155], v2, s[8:11], s36 offen offset:1024
  s_barrier
  ds_read_b128 v[64:67], v2 offset:0
  ds_read_b128 v[68:71], v2 offset:1024
  ds_read_b128 v[72:75], v2 offset:2048
  ds_read_b128 v[76:79], v2 offset:3072
  s_waitcnt vmcnt(9)
  v_smfmac_f32_16x16x64_bf16 v[156:159], v[8:11], v[80:87], v3
  s_waitcnt vmcnt(8)
  v_smfmac_f32_16x16x64_bf16 v[156:159], v[12:15], v[88:95], v3
  s_waitcnt vmcnt(7)
  v_smfmac_f32_16x16x64_bf16 v[156:159], v[16:19], v[96:103], v3
  s_waitcnt vmcnt(6)
  v_smfmac_f32_16x16x64_bf16 v[156:159], v[20:23], v[104:111], v3
  s_waitcnt vmcnt(5)
  v_smfmac_f32_16x16x64_bf16 v[156:159], v[24:27], v[112:119], v3
  s_mov_b32 exec_hi, 0
  buffer_store_dword v2, v7, s[8:11], s21 offen
  s_mov_b64 exec, -1
  s_waitcnt vmcnt(5)
  v_smfmac_f32_16x16x64_bf16 v[156:159], v[28:31], v[120:127], v3
  s_waitcnt vmcnt(4)
  v_smfmac_f32_16x16x64_bf16 v[156:159], v[32:35], v[128:135], v3
  s_waitcnt vmcnt(3)
  v_smfmac_f32_16x16x64_bf16 v[156:159], v[144:147], v[136:143], v3
  s_waitcnt vmcnt(2) lgkmcnt(0)
  v_smfmac_f32_16x16x64_bf16 v[156:159], v[148:151], v[64:71], v3
  s_waitcnt vmcnt(1)
  v_smfmac_f32_16x16x64_bf16 v[156:159], v[152:155], v[72:79], v3
cA_va0_ep:
  s_nop 7
  v_permlane32_swap_b32 v156, v158
  v_permlane32_swap_b32 v157, v159
  v_add_f32 v160, v156, v158
  v_add_f32 v161, v157, v159
  v_mov_b32 v156, 0
  v_mov_b32_dpp v162, v160 row_ror:8 row_mask:0xf bank_mask:0xf
  v_cmp_u_f32 vcc, v160, v161
  v_mov_b32_dpp v160, v161 row_ror:8 row_mask:0xf bank_mask:0xc
  v_mov_b32 v157, 0
  v_mov_b32_dpp v161, v162 quad_perm:[0,1,2,3] row_mask:0xf bank_mask:0x3
  v_mov_b32 v158, 0
  v_cvt_pk_bf16_f32 v160, v160, v161
  v_mov_b32 v159, 0
  v_min_u32 v160, -2, v160
  s_cbranch_vccnz cA_va0_rp
cA_va0_pc:
  buffer_store_dword v160, v1, s[8:11], s21 offen
  s_cmp_lg_u32 s19, 62
  s_cbranch_scc1 cA_va0_nl
  s_mov_b32 s22, 88519680
  buffer_store_dword v160, v1, s[8:11], s22 offen sc1
  s_mov_b64 exec, -1
  s_branch cA_done
cA_va0_nl:
  s_mov_b64 exec, -1
  s_add_u32 s25, s25, 28672
  s_add_u32 s19, s19, 1
  s_mov_b32 s20, s21
  s_branch cA_va0_loop
cA_va0_last:
  s_waitcnt lgkmcnt(0)
  s_barrier
  s_branch cA_done
cA_va0_rp:
  s_cmp_lg_u32 s37, 0
  s_cbranch_scc1 cA_va0_pc
cA_va0_rv:
  buffer_load_dwordx4 v[8:11], v2, s[8:11], s22 offen offset:0 sc1
  buffer_load_dwordx4 v[12:15], v2, s[8:11], s22 offen offset:1024 sc1
  buffer_load_dwordx4 v[16:19], v2, s[8:11], s22 offen offset:2048 sc1
  buffer_load_dwordx4 v[20:23], v2, s[8:11], s22 offen offset:3072 sc1
  buffer_load_dwordx4 v[24:27], v2, s[8:11], s34 offen offset:0 sc1
  buffer_load_dwordx4 v[28:31], v2, s[8:11], s34 offen offset:1024 sc1
  buffer_load_dwordx4 v[32:35], v2, s[8:11], s34 offen offset:2048 sc1
  buffer_load_dwordx4 v[144:147], v2, s[8:11], s34 offen offset:3072 sc1
  buffer_load_dwordx4 v[148:151], v2, s[8:11], s36 offen offset:0 sc1
  buffer_load_dwordx4 v[152:155], v2, s[8:11], s36 offen offset:1024 sc1
  s_waitcnt vmcnt(0)
  v_max3_u32 v63, v8, v9, v10
  v_max3_u32 v63, v63, v11, v12
  v_max3_u32 v63, v63, v13, v14
  v_max3_u32 v63, v63, v15, v16
  v_max3_u32 v63, v63, v17, v18
  v_max3_u32 v63, v63, v19, v20
  v_max3_u32 v63, v63, v21, v22
  v_max3_u32 v63, v63, v23, v24
  v_max3_u32 v63, v63, v25, v26
  v_max3_u32 v63, v63, v27, v28
  v_max3_u32 v63, v63, v29, v30
  v_max3_u32 v63, v63, v31, v32
  v_max3_u32 v63, v63, v33, v34
  v_max3_u32 v63, v63, v35, v144
  v_max3_u32 v63, v63, v145, v146
  v_max3_u32 v63, v63, v147, v148
  v_max3_u32 v63, v63, v149, v150
  v_max3_u32 v63, v63, v151, v152
  v_max3_u32 v63, v63, v153, v154
  v_max_u32 v63, v63, v155
  v_cmp_eq_u32 vcc, -1, v63
  s_cbranch_vccz cA_va0_rk
  s_add_u32 s30, s30, 1
  s_cmp_lt_u32 s30, 400000
  s_cbranch_scc1 cA_va0_rv
  s_branch cA_abort
cA_va0_rk:
  s_mov_b32 s37, 1
  s_add_u32 s31, s31, 0x10000
  v_smfmac_f32_16x16x64_bf16 v[156:159], v[8:11], v[80:87], v3
  v_smfmac_f32_16x16x64_bf16 v[156:159], v[12:15], v[88:95], v3
  v_smfmac_f32_16x16x64_bf16 v[156:159], v[16:19], v[96:103], v3
  v_smfmac_f32_16x16x64_bf16 v[156:159], v[20:23], v[104:111], v3
  v_smfmac_f32_16x16x64_bf16 v[156:159], v[24:27], v[112:119], v3
  v_smfmac_f32_16x16x64_bf16 v[156:159], v[28:31], v[120:127], v3
  v_smfmac_f32_16x16x64_bf16 v[156:159], v[32:35], v[128:135], v3
  v_smfmac_f32_16x16x64_bf16 v[156:159], v[144:147], v[136:143], v3
  v_smfmac_f32_16x16x64_bf16 v[156:159], v[148:151], v[64:71], v3
  v_smfmac_f32_16x16x64_bf16 v[156:159], v[152:155], v[72:79], v3
  s_nop 7
  s_branch cA_va0_ep
cA_va1_loop:
  s_add_u32 s23, s20, 4096
  s_add_u32 s21, s20, 25600
  s_mov_b32 s30, 0
  s_cmp_lg_u32 s19, s38
  s_cbranch_scc1 cA_va1_vok
  s_branch cA_va1_voc
cA_va1_vow:
  buffer_load_dword v175, off, s[8:11], s35 sc1
  s_waitcnt vmcnt(0)
cA_va1_voc:
  v_readfirstlane_b32 s22, v175
  s_cmp_eq_u32 s22, 56
  s_cbranch_scc1 cA_va1_vod
  s_sleep 1
  s_add_u32 s30, s30, 1
  s_cmp_lt_u32 s30, 400000
  s_cbranch_scc1 cA_va1_vow
  s_branch cA_abort
cA_va1_vod:
  s_add_u32 s35, s35, 2048
  s_add_u32 s38, s19, 8
  s_and_b32 s38, s38, -8
  s_cmp_eq_u32 s19, 0
  s_cselect_b32 s38, 4, s38
cA_va1_vok:
  s_cmp_eq_u32 s19, 63
  s_cbranch_scc1 cA_done
  s_barrier
  s_add_u32 s22, s25, 0
  buffer_load_dwordx4 v[80:83], v6, s[8:11], s22 offen offset:0 sc1
  buffer_load_dwordx4 v[84:87], v6, s[8:11], s22 offen offset:1792 sc1
  s_add_u32 s22, s25, 3584
  buffer_load_dwordx4 v[88:91], v6, s[8:11], s22 offen offset:0 sc1
  buffer_load_dwordx4 v[92:95], v6, s[8:11], s22 offen offset:1792 sc1
  s_add_u32 s22, s25, 7168
  buffer_load_dwordx4 v[96:99], v6, s[8:11], s22 offen offset:0 sc1
  buffer_load_dwordx4 v[100:103], v6, s[8:11], s22 offen offset:1792 sc1
  s_add_u32 s22, s25, 10752
  buffer_load_dwordx4 v[104:107], v6, s[8:11], s22 offen offset:0 sc1
  buffer_load_dwordx4 v[108:111], v6, s[8:11], s22 offen offset:1792 sc1
  s_add_u32 s22, s25, 14336
  buffer_load_dwordx4 v[112:115], v6, s[8:11], s22 offen offset:0 sc1
  buffer_load_dwordx4 v[116:119], v6, s[8:11], s22 offen offset:1792 sc1
  s_add_u32 s22, s25, 17920
  buffer_load_dwordx4 v[120:123], v6, s[8:11], s22 offen offset:0 sc1
  buffer_load_dwordx4 v[124:127], v6, s[8:11], s22 offen offset:1792 sc1
  s_add_u32 s22, s25, 21504
  buffer_load_dwordx4 v[128:131], v6, s[8:11], s22 offen offset:0 sc1
  buffer_load_dwordx4 v[132:135], v6, s[8:11], s22 offen offset:1792 sc1
  s_add_u32 s22, s25, 25088
  buffer_load_dwordx4 v[136:139], v6, s[8:11], s22 offen offset:0 sc1
  buffer_load_dwordx4 v[140:143], v6, s[8:11], s22 offen offset:1792 sc1
  buffer_load_dword v175, off, s[8:11], s35 sc1
  s_barrier
  ds_read_b128 v[8:11], v2 offset:8192
  ds_read_b128 v[12:15], v2 offset:9216
  ds_read_b128 v[16:19], v2 offset:10240
  ds_read_b128 v[20:23], v2 offset:11264
  ds_read_b128 v[24:27], v2 offset:12288
  ds_read_b128 v[28:31], v2 offset:13312
  ds_read_b128 v[32:35], v2 offset:14336
  s_waitcnt lgkmcnt(0)
  v_smfmac_f32_16x16x64_bf16 v[36:39], v[8:11], a[0:7], v3
  v_smfmac_f32_16x16x64_bf16 v[36:39], v[12:15], a[8:15], v3
  v_smfmac_f32_16x16x64_bf16 v[36:39], v[16:19], a[16:23], v3
  v_smfmac_f32_16x16x64_bf16 v[36:39], v[20:23], a[24:31], v3
  v_smfmac_f32_16x16x64_bf16 v[36:39], v[24:27], a[32:39], v3
  v_smfmac_f32_16x16x64_bf16 v[36:39], v[28:31], a[40:47], v3
  v_smfmac_f32_16x16x64_bf16 v[36:39], v[32:35], a[48:55], v3
  v_smfmac_f32_16x16x64_bf16 v[40:43], v[8:11], a[56:63], v3
  v_smfmac_f32_16x16x64_bf16 v[40:43], v[12:15], a[64:71], v3
  v_smfmac_f32_16x16x64_bf16 v[40:43], v[16:19], a[72:79], v3
  v_smfmac_f32_16x16x64_bf16 v[40:43], v[20:23], a[80:87], v3
  v_smfmac_f32_16x16x64_bf16 v[40:43], v[24:27], a[88:95], v3
  v_smfmac_f32_16x16x64_bf16 v[40:43], v[28:31], a[96:103], v3
  v_smfmac_f32_16x16x64_bf16 v[40:43], v[32:35], a[104:111], v3
  v_smfmac_f32_16x16x64_bf16 v[44:47], v[8:11], a[112:119], v3
  v_smfmac_f32_16x16x64_bf16 v[44:47], v[12:15], a[120:127], v3
  v_smfmac_f32_16x16x64_bf16 v[44:47], v[16:19], a[128:135], v3
  v_smfmac_f32_16x16x64_bf16 v[44:47], v[20:23], a[136:143], v3
  v_permlane32_swap_b32 v36, v40
  v_smfmac_f32_16x16x64_bf16 v[44:47], v[24:27], a[144:151], v3
  v_permlane32_swap_b32 v37, v41
  v_smfmac_f32_16x16x64_bf16 v[44:47], v[28:31], a[152:159], v3
  v_permlane32_swap_b32 v38, v42
  v_smfmac_f32_16x16x64_bf16 v[44:47], v[32:35], a[160:167], v3
  v_permlane32_swap_b32 v39, v43
  v_smfmac_f32_16x16x64_bf16 v[48:51], v[8:11], a[168:175], v3
  v_add_f32 v36, v36, v40
  v_smfmac_f32_16x16x64_bf16 v[48:51], v[12:15], a[176:183], v3
  v_add_f32 v37, v37, v41
  v_smfmac_f32_16x16x64_bf16 v[48:51], v[16:19], a[184:191], v3
  v_add_f32 v38, v38, v42
  v_smfmac_f32_16x16x64_bf16 v[48:51], v[20:23], a[192:199], v3
  v_add_f32 v39, v39, v43
  v_smfmac_f32_16x16x64_bf16 v[48:51], v[24:27], a[200:207], v3
  v_cvt_pk_bf16_f32 v40, v36, v37
  v_smfmac_f32_16x16x64_bf16 v[48:51], v[28:31], a[208:215], v3
  v_cvt_pk_bf16_f32 v41, v38, v39
  v_smfmac_f32_16x16x64_bf16 v[48:51], v[32:35], a[216:223], v3
  ds_write_b64 v60, v[40:41]
  v_smfmac_f32_16x16x64_bf16 v[52:55], v[8:11], a[224:231], v3
  v_smfmac_f32_16x16x64_bf16 v[52:55], v[12:15], a[232:239], v3
  v_smfmac_f32_16x16x64_bf16 v[52:55], v[16:19], a[240:247], v3
  v_smfmac_f32_16x16x64_bf16 v[52:55], v[20:23], a[248:255], v3
  v_permlane32_swap_b32 v44, v48
  v_smfmac_f32_16x16x64_bf16 v[52:55], v[24:27], v[176:183], v3
  v_permlane32_swap_b32 v45, v49
  v_smfmac_f32_16x16x64_bf16 v[52:55], v[28:31], v[184:191], v3
  v_permlane32_swap_b32 v46, v50
  v_smfmac_f32_16x16x64_bf16 v[52:55], v[32:35], v[192:199], v3
  v_permlane32_swap_b32 v47, v51
  v_smfmac_f32_16x16x64_bf16 v[56:59], v[8:11], v[200:207], v3
  v_add_f32 v44, v44, v48
  v_smfmac_f32_16x16x64_bf16 v[56:59], v[12:15], v[208:215], v3
  v_add_f32 v45, v45, v49
  v_smfmac_f32_16x16x64_bf16 v[56:59], v[16:19], v[216:223], v3
  v_add_f32 v46, v46, v50
  v_smfmac_f32_16x16x64_bf16 v[56:59], v[20:23], v[224:231], v3
  v_add_f32 v47, v47, v51
  v_smfmac_f32_16x16x64_bf16 v[56:59], v[24:27], v[232:239], v3
  v_cvt_pk_bf16_f32 v48, v44, v45
  v_smfmac_f32_16x16x64_bf16 v[56:59], v[28:31], v[240:247], v3
  v_cvt_pk_bf16_f32 v49, v46, v47
  v_smfmac_f32_16x16x64_bf16 v[56:59], v[32:35], v[248:255], v3
  ds_write_b64 v61, v[48:49]
  s_nop 6
  v_permlane32_swap_b32 v52, v56
  v_permlane32_swap_b32 v53, v57
  v_permlane32_swap_b32 v54, v58
  v_permlane32_swap_b32 v55, v59
  v_add_f32 v52, v52, v56
  v_add_f32 v53, v53, v57
  v_add_f32 v54, v54, v58
  v_add_f32 v55, v55, v59
  v_cvt_pk_bf16_f32 v56, v52, v53
  v_cvt_pk_bf16_f32 v57, v54, v55
  ds_write_b64 v62, v[56:57]
  s_cmp_eq_u32 s19, 63
  s_cbranch_scc1 cA_va1_last
  s_add_u32 s22, s20, 9216
  s_add_u32 s34, s20, 13312
  s_add_u32 s36, s20, 7168
  s_mov_b32 s37, 0
  buffer_load_dword v164, v4, s[8:11], s20 offen sc1
  s_nop 7
  buffer_load_dword v165, v4, s[8:11], s20 offen sc1
  s_nop 7
  buffer_load_dword v166, v4, s[8:11], s20 offen sc1
  s_nop 7
  buffer_load_dword v167, v4, s[8:11], s20 offen sc1
  s_nop 7
  buffer_load_dword v168, v4, s[8:11], s20 offen sc1
cA_va1_fw_l:
  s_waitcnt vmcnt(4)
  v_cmp_eq_u32 vcc, -1, v164
  s_cbranch_vccz cA_va1_fw_d
  buffer_load_dword v164, v4, s[8:11], s20 offen sc1
  s_waitcnt vmcnt(4)
  v_cmp_eq_u32 vcc, -1, v165
  s_cbranch_vccz cA_va1_fw_d
  buffer_load_dword v165, v4, s[8:11], s20 offen sc1
  s_waitcnt vmcnt(4)
  v_cmp_eq_u32 vcc, -1, v166
  s_cbranch_vccz cA_va1_fw_d
  buffer_load_dword v166, v4, s[8:11], s20 offen sc1
  s_waitcnt vmcnt(4)
  v_cmp_eq_u32 vcc, -1, v167
  s_cbranch_vccz cA_va1_fw_d
  buffer_load_dword v167, v4, s[8:11], s20 offen sc1
  s_waitcnt vmcnt(4)
  v_cmp_eq_u32 vcc, -1, v168
  s_cbranch_vccz cA_va1_fw_d
  buffer_load_dword v168, v4, s[8:11], s20 offen sc1
  s_add_u32 s30, s30, 1
  s_cmp_lt_u32 s30, 400000
  s_cbranch_scc1 cA_va1_fw_l
  s_branch cA_abort
cA_va1_fw_d:
  s_waitcnt lgkmcnt(0)
  buffer_load_dwordx4 v[8:11], v2, s[8:11], s22 offen offset:0
  v_mov_b32 v36, 0
  v_mov_b32 v37, 0
  v_mov_b32 v38, 0
  buffer_load_dwordx4 v[12:15], v2, s[8:11], s22 offen offset:1024
  v_mov_b32 v39, 0
  v_mov_b32 v40, 0
  v_mov_b32 v41, 0
  buffer_load_dwordx4 v[16:19], v2, s[8:11], s22 offen offset:2048
  v_mov_b32 v42, 0
  v_mov_b32 v43, 0
  v_mov_b32 v44, 0
  buffer_load_dwordx4 v[20:23], v2, s[8:11], s22 offen offset:3072
  v_mov_b32 v45, 0
  v_mov_b32 v46, 0
  v_mov_b32 v47, 0
  buffer_load_dwordx4 v[24:27], v2, s[8:11], s34 offen offset:0
  v_mov_b32 v48, 0
  v_mov_b32 v49, 0
  v_mov_b32 v50, 0
  buffer_load_dwordx4 v[28:31], v2, s[8:11], s34 offen offset:1024
  v_mov_b32 v51, 0
  v_mov_b32 v52, 0
  v_mov_b32 v53, 0
  buffer_load_dwordx4 v[32:35], v2, s[8:11], s34 offen offset:2048
  v_mov_b32 v54, 0
  v_mov_b32 v55, 0
  v_mov_b32 v56, 0
  buffer_load_dwordx4 v[144:147], v2, s[8:11], s34 offen offset:3072
  v_mov_b32 v57, 0
  v_mov_b32 v58, 0
  v_mov_b32 v59, 0
  buffer_load_dwordx4 v[148:151], v2, s[8:11], s36 offen offset:0
  buffer_load_dwordx4 v[152:155], v2, s[8:11], s36 offen offset:1024
  s_barrier
  ds_read_b128 v[64:67], v2 offset:4096
  ds_read_b128 v[68:71], v2 offset:5120
  ds_read_b128 v[72:75], v2 offset:6144
  ds_read_b128 v[76:79], v2 offset:7168
  s_waitcnt vmcnt(9)
  v_smfmac_f32_16x16x64_bf16 v[156:159], v[8:11], v[80:87], v3
  s_waitcnt vmcnt(8)
  v_smfmac_f32_16x16x64_bf16 v[156:159], v[12:15], v[88:95], v3
  s_waitcnt vmcnt(7)
  v_smfmac_f32_16x16x64_bf16 v[156:159], v[16:19], v[96:103], v3
  s_waitcnt vmcnt(6)
  v_smfmac_f32_16x16x64_bf16 v[156:159], v[20:23], v[104:111], v3
  s_waitcnt vmcnt(5)
  v_smfmac_f32_16x16x64_bf16 v[156:159], v[24:27], v[112:119], v3
  s_mov_b32 exec_hi, 0
  buffer_store_dword v2, v7, s[8:11], s21 offen
  s_mov_b64 exec, -1
  s_waitcnt vmcnt(5)
  v_smfmac_f32_16x16x64_bf16 v[156:159], v[28:31], v[120:127], v3
  s_waitcnt vmcnt(4)
  v_smfmac_f32_16x16x64_bf16 v[156:159], v[32:35], v[128:135], v3
  s_waitcnt vmcnt(3)
  v_smfmac_f32_16x16x64_bf16 v[156:159], v[144:147], v[136:143], v3
  s_waitcnt vmcnt(2) lgkmcnt(0)
  v_smfmac_f32_16x16x64_bf16 v[156:159], v[148:151], v[64:71], v3
  s_waitcnt vmcnt(1)
  v_smfmac_f32_16x16x64_bf16 v[156:159], v[152:155], v[72:79], v3
cA_va1_ep:
  s_nop 7
  v_permlane32_swap_b32 v156, v158
  v_permlane32_swap_b32 v157, v159
  v_add_f32 v160, v156, v158
  v_add_f32 v161, v157, v159
  v_mov_b32 v156, 0
  v_mov_b32_dpp v162, v160 row_ror:8 row_mask:0xf bank_mask:0xf
  v_cmp_u_f32 vcc, v160, v161
  v_mov_b32_dpp v160, v161 row_ror:8 row_mask:0xf bank_mask:0xc
  v_mov_b32 v157, 0
  v_mov_b32_dpp v161, v162 quad_perm:[0,1,2,3] row_mask:0xf bank_mask:0x3
  v_mov_b32 v158, 0
  v_cvt_pk_bf16_f32 v160, v160, v161
  v_mov_b32 v159, 0
  v_min_u32 v160, -2, v160
  s_cbranch_vccnz cA_va1_rp
cA_va1_pc:
  s_mov_b64 exec, s[26:27]
  buffer_store_dword v160, v1, s[8:11], s21 offen
  s_cmp_lg_u32 s19, 62
  s_cbranch_scc1 cA_va1_nl
  s_mov_b32 s22, 88519680
  buffer_store_dword v160, v1, s[8:11], s22 offen sc1
  s_mov_b64 exec, -1
  s_branch cA_done
cA_va1_nl:
  s_mov_b64 exec, -1
  s_add_u32 s25, s25, 28672
  s_add_u32 s19, s19, 1
  s_mov_b32 s20, s21
  s_branch cA_va1_loop
cA_va1_last:
  s_waitcnt lgkmcnt(0)
  s_barrier
  s_branch cA_done
cA_va1_rp:
  s_cmp_lg_u32 s37, 0
  s_cbranch_scc1 cA_va1_pc
cA_va1_rv:
  buffer_load_dwordx4 v[8:11], v2, s[8:11], s22 offen offset:0 sc1
  buffer_load_dwordx4 v[12:15], v2, s[8:11], s22 offen offset:1024 sc1
  buffer_load_dwordx4 v[16:19], v2, s[8:11], s22 offen offset:2048 sc1
  buffer_load_dwordx4 v[20:23], v2, s[8:11], s22 offen offset:3072 sc1
  buffer_load_dwordx4 v[24:27], v2, s[8:11], s34 offen offset:0 sc1
  buffer_load_dwordx4 v[28:31], v2, s[8:11], s34 offen offset:1024 sc1
  buffer_load_dwordx4 v[32:35], v2, s[8:11], s34 offen offset:2048 sc1
  buffer_load_dwordx4 v[144:147], v2, s[8:11], s34 offen offset:3072 sc1
  buffer_load_dwordx4 v[148:151], v2, s[8:11], s36 offen offset:0 sc1
  buffer_load_dwordx4 v[152:155], v2, s[8:11], s36 offen offset:1024 sc1
  s_waitcnt vmcnt(0)
  v_max3_u32 v63, v8, v9, v10
  v_max3_u32 v63, v63, v11, v12
  v_max3_u32 v63, v63, v13, v14
  v_max3_u32 v63, v63, v15, v16
  v_max3_u32 v63, v63, v17, v18
  v_max3_u32 v63, v63, v19, v20
  v_max3_u32 v63, v63, v21, v22
  v_max3_u32 v63, v63, v23, v24
  v_max3_u32 v63, v63, v25, v26
  v_max3_u32 v63, v63, v27, v28
  v_max3_u32 v63, v63, v29, v30
  v_max3_u32 v63, v63, v31, v32
  v_max3_u32 v63, v63, v33, v34
  v_max3_u32 v63, v63, v35, v144
  v_max3_u32 v63, v63, v145, v146
  v_max3_u32 v63, v63, v147, v148
  v_max3_u32 v63, v63, v149, v150
  v_max3_u32 v63, v63, v151, v152
  v_max3_u32 v63, v63, v153, v154
  v_max_u32 v63, v63, v155
  v_cmp_eq_u32 vcc, -1, v63
  s_cbranch_vccz cA_va1_rk
  s_add_u32 s30, s30, 1
  s_cmp_lt_u32 s30, 400000
  s_cbranch_scc1 cA_va1_rv
  s_branch cA_abort
cA_va1_rk:
  s_mov_b32 s37, 1
  s_add_u32 s31, s31, 0x10000
  v_smfmac_f32_16x16x64_bf16 v[156:159], v[8:11], v[80:87], v3
  v_smfmac_f32_16x16x64_bf16 v[156:159], v[12:15], v[88:95], v3
  v_smfmac_f32_16x16x64_bf16 v[156:159], v[16:19], v[96:103], v3
  v_smfmac_f32_16x16x64_bf16 v[156:159], v[20:23], v[104:111], v3
  v_smfmac_f32_16x16x64_bf16 v[156:159], v[24:27], v[112:119], v3
  v_smfmac_f32_16x16x64_bf16 v[156:159], v[28:31], v[120:127], v3
  v_smfmac_f32_16x16x64_bf16 v[156:159], v[32:35], v[128:135], v3
  v_smfmac_f32_16x16x64_bf16 v[156:159], v[144:147], v[136:143], v3
  v_smfmac_f32_16x16x64_bf16 v[156:159], v[148:151], v[64:71], v3
  v_smfmac_f32_16x16x64_bf16 v[156:159], v[152:155], v[72:79], v3
  s_nop 7
  s_branch cA_va1_ep
cA_va2_loop:
  s_add_u32 s23, s20, 4096
  s_add_u32 s21, s20, 25600
  v_mov_b32 v36, 0
  v_mov_b32 v37, 0
  v_mov_b32 v38, 0
  v_mov_b32 v39, 0
  v_mov_b32 v40, 0
  v_mov_b32 v41, 0
  v_mov_b32 v42, 0
  v_mov_b32 v43, 0
  v_mov_b32 v44, 0
  v_mov_b32 v45, 0
  v_mov_b32 v46, 0
  v_mov_b32 v47, 0
  v_mov_b32 v48, 0
  v_mov_b32 v49, 0
  v_mov_b32 v50, 0
  v_mov_b32 v51, 0
  v_mov_b32 v52, 0
  v_mov_b32 v53, 0
  v_mov_b32 v54, 0
  v_mov_b32 v55, 0
  v_mov_b32 v56, 0
  v_mov_b32 v57, 0
  v_mov_b32 v58, 0
  v_mov_b32 v59, 0
  v_mov_b32 v60, 0
  v_mov_b32 v61, 0
  v_mov_b32 v62, 0
  v_mov_b32 v63, 0
  v_mov_b32 v64, 0
  v_mov_b32 v65, 0
  v_mov_b32 v66, 0
  v_mov_b32 v67, 0
  s_mov_b32 s30, 0
  buffer_load_dword v76, v119, s[8:11], s20 offen sc1
  buffer_load_dword v77, v119, s[8:11], s20 offen sc1
  buffer_load_dword v78, v119, s[8:11], s20 offen sc1
cA_va2_fp_l:
  s_waitcnt vmcnt(2)
  v_cmp_eq_u32 vcc, -1, v76
  s_cbranch_vccz cA_va2_fp_d
  buffer_load_dword v76, v119, s[8:11], s20 offen sc1
  s_waitcnt vmcnt(2)
  v_cmp_eq_u32 vcc, -1, v77
  s_cbranch_vccz cA_va2_fp_d
  buffer_load_dword v77, v119, s[8:11], s20 offen sc1
  s_waitcnt vmcnt(2)
  v_cmp_eq_u32 vcc, -1, v78
  s_cbranch_vccz cA_va2_fp_d
  buffer_load_dword v78, v119, s[8:11], s20 offen sc1
  s_add_u32 s30, s30, 1
  s_cmp_lt_u32 s30, 400000
  s_cbranch_scc1 cA_va2_fp_l
  s_branch cA_abort
cA_va2_fp_d:
  buffer_load_dwordx4 v[8:11], v2, s[8:11], s20 offen offset:0 sc1
  buffer_load_dwordx4 v[12:15], v2, s[8:11], s20 offen offset:1024 sc1
  buffer_load_dwordx4 v[16:19], v2, s[8:11], s20 offen offset:2048 sc1
  buffer_load_dwordx4 v[20:23], v2, s[8:11], s20 offen offset:3072 sc1
  s_barrier
cA_va2_ld:
  s_waitcnt vmcnt(0)
  v_max3_u32 v84, v8, v9, v10
  v_max3_u32 v84, v84, v11, v12
  v_max3_u32 v84, v84, v13, v14
  v_max3_u32 v84, v84, v15, v16
  v_max3_u32 v84, v84, v17, v18
  v_max3_u32 v84, v84, v19, v20
  v_max3_u32 v84, v84, v21, v22
  v_max_u32 v84, v84, v23
  v_cmp_eq_u32 vcc, -1, v84
  ds_write_b128 v2, v[8:11] offset:8192
  ds_write_b128 v2, v[12:15] offset:9216
  ds_write_b128 v2, v[16:19] offset:10240
  ds_write_b128 v2, v[20:23] offset:11264
  s_cbranch_vccnz cA_va2_retry
  s_waitcnt lgkmcnt(0)
  s_barrier
  ds_read_b128 v[24:27], v2 offset:12288
  ds_read_b128 v[28:31], v2 offset:13312
  ds_read_b128 v[32:35], v2 offset:14336
  ds_read_b128 v[92:95], v0
  s_waitcnt lgkmcnt(0)
  s_mov_b64 exec, s[26:27]
  buffer_store_dwordx4 v[92:95], v2, s[8:11], s36 offen sc1
  s_mov_b64 exec, -1
  s_add_u32 s36, s36, 7168
  s_cmp_eq_u32 s19, 63
  s_cbranch_scc1 cA_done
  ds_read_b128 v[76:79], v1 offset:0
  ds_read_b128 v[80:83], v1 offset:1024
  ds_read_b128 v[84:87], v1 offset:2048
  ds_read_b128 v[88:91], v1 offset:3072
  ds_read_b128 v[92:95], v1 offset:4096
  ds_read_b128 v[96:99], v1 offset:5120
  v_smfmac_f32_16x16x64_bf16 v[60:63], v[8:11], v[200:207], v3
  v_smfmac_f32_16x16x64_bf16 v[60:63], v[12:15], v[208:215], v3
  s_waitcnt lgkmcnt(4)
  v_smfmac_f32_16x16x64_bf16 v[64:67], v[8:11], v[76:83], v3
  ds_read_b128 v[76:79], v1 offset:6144
  ds_read_b128 v[80:83], v1 offset:7168
  v_smfmac_f32_16x16x64_bf16 v[60:63], v[16:19], v[216:223], v3
  v_smfmac_f32_16x16x64_bf16 v[60:63], v[20:23], v[224:231], v3
  s_waitcnt lgkmcnt(4)
  v_smfmac_f32_16x16x64_bf16 v[64:67], v[12:15], v[84:91], v3
  ds_read_b128 v[84:87], v1 offset:8192
  ds_read_b128 v[88:91], v1 offset:9216
  v_smfmac_f32_16x16x64_bf16 v[60:63], v[24:27], v[232:239], v3
  v_smfmac_f32_16x16x64_bf16 v[60:63], v[28:31], v[240:247], v3
  s_waitcnt lgkmcnt(4)
  v_smfmac_f32_16x16x64_bf16 v[64:67], v[16:19], v[92:99], v3
  ds_read_b128 v[92:95], v1 offset:10240
  ds_read_b128 v[96:99], v1 offset:11264
  v_smfmac_f32_16x16x64_bf16 v[60:63], v[32:35], v[248:255], v3
  v_smfmac_f32_16x16x64_bf16 v[36:39], v[8:11], a[0:7], v3
  s_waitcnt lgkmcnt(4)
  v_smfmac_f32_16x16x64_bf16 v[64:67], v[20:23], v[76:83], v3
  ds_read_b128 v[76:79], v1 offset:12288
  ds_read_b128 v[80:83], v1 offset:13312
  v_smfmac_f32_16x16x64_bf16 v[36:39], v[12:15], a[8:15], v3
  v_smfmac_f32_16x16x64_bf16 v[36:39], v[16:19], a[16:23], v3
  s_waitcnt lgkmcnt(4)
  v_smfmac_f32_16x16x64_bf16 v[64:67], v[24:27], v[84:91], v3
  v_smfmac_f32_16x16x64_bf16 v[36:39], v[20:23], a[24:31], v3
  v_smfmac_f32_16x16x64_bf16 v[36:39], v[24:27], a[32:39], v3
  s_waitcnt lgkmcnt(2)
  v_smfmac_f32_16x16x64_bf16 v[64:67], v[28:31], v[92:99], v3
  v_smfmac_f32_16x16x64_bf16 v[36:39], v[28:31], a[40:47], v3
  v_smfmac_f32_16x16x64_bf16 v[36:39], v[32:35], a[48:55], v3
  s_waitcnt lgkmcnt(0)
  v_smfmac_f32_16x16x64_bf16 v[64:67], v[32:35], v[76:83], v3
  v_smfmac_f32_16x16x64_bf16 v[40:43], v[8:11], a[56:63], v3
  v_smfmac_f32_16x16x64_bf16 v[40:43], v[12:15], a[64:71], v3
  v_smfmac_f32_16x16x64_bf16 v[40:43], v[16:19], a[72:79], v3
  v_smfmac_f32_16x16x64_bf16 v[40:43], v[20:23], a[80:87], v3
  v_permlane32_swap_b32 v60, v64
  v_smfmac_f32_16x16x64_bf16 v[40:43], v[24:27], a[88:95], v3
  v_permlane32_swap_b32 v61, v65
  v_smfmac_f32_16x16x64_bf16 v[40:43], v[28:31], a[96:103], v3
  v_permlane32_swap_b32 v62, v66
  v_smfmac_f32_16x16x64_bf16 v[40:43], v[32:35], a[104:111], v3
  v_permlane32_swap_b32 v63, v67
  v_smfmac_f32_16x16x64_bf16 v[44:47], v[8:11], a[112:119], v3
  v_smfmac_f32_16x16x64_bf16 v[44:47], v[12:15], a[120:127], v3
  v_smfmac_f32_16x16x64_bf16 v[44:47], v[16:19], a[128:135], v3
  v_smfmac_f32_16x16x64_bf16 v[44:47], v[20:23], a[136:143], v3
  v_add_f32 v60, v60, v64
  v_add_f32 v61, v61, v65
  v_smfmac_f32_16x16x64_bf16 v[44:47], v[24:27], a[144:151], v3
  v_add_f32 v62, v62, v66
  v_add_f32 v63, v63, v67
  v_smfmac_f32_16x16x64_bf16 v[44:47], v[28:31], a[152:159], v3
  v_cvt_pk_bf16_f32 v64, v60, v61
  v_cvt_pk_bf16_f32 v65, v62, v63
  v_smfmac_f32_16x16x64_bf16 v[44:47], v[32:35], a[160:167], v3
  ds_write_b64 v115, v[64:65]
  v_smfmac_f32_16x16x64_bf16 v[48:51], v[8:11], a[168:175], v3
  v_permlane32_swap_b32 v36, v40
  v_smfmac_f32_16x16x64_bf16 v[48:51], v[12:15], a[176:183], v3
  v_permlane32_swap_b32 v37, v41
  v_smfmac_f32_16x16x64_bf16 v[48:51], v[16:19], a[184:191], v3
  v_permlane32_swap_b32 v38, v42
  v_smfmac_f32_16x16x64_bf16 v[48:51], v[20:23], a[192:199], v3
  v_permlane32_swap_b32 v39, v43
  v_smfmac_f32_16x16x64_bf16 v[48:51], v[24:27], a[200:207], v3
  v_add_f32 v36, v36, v40
  v_smfmac_f32_16x16x64_bf16 v[48:51], v[28:31], a[208:215], v3
  v_add_f32 v37, v37, v41
  v_smfmac_f32_16x16x64_bf16 v[48:51], v[32:35], a[216:223], v3
  v_add_f32 v38, v38, v42
  v_smfmac_f32_16x16x64_bf16 v[52:55], v[8:11], a[224:231], v3
  v_smfmac_f32_16x16x64_bf16 v[52:55], v[12:15], a[232:239], v3
  v_smfmac_f32_16x16x64_bf16 v[52:55], v[16:19], a[240:247], v3
  v_smfmac_f32_16x16x64_bf16 v[52:55], v[20:23], a[248:255], v3
  v_add_f32 v39, v39, v43
  v_cvt_pk_bf16_f32 v40, v36, v37
  v_smfmac_f32_16x16x64_bf16 v[52:55], v[24:27], v[120:127], v3
  v_cvt_pk_bf16_f32 v41, v38, v39
  v_smfmac_f32_16x16x64_bf16 v[52:55], v[28:31], v[128:135], v3
  ds_write_b64 v112, v[40:41]
  v_smfmac_f32_16x16x64_bf16 v[52:55], v[32:35], v[136:143], v3
  v_permlane32_swap_b32 v44, v48
  v_smfmac_f32_16x16x64_bf16 v[56:59], v[8:11], v[144:151], v3
  v_permlane32_swap_b32 v45, v49
  v_smfmac_f32_16x16x64_bf16 v[56:59], v[12:15], v[152:159], v3
  v_permlane32_swap_b32 v46, v50
  v_smfmac_f32_16x16x64_bf16 v[56:59], v[16:19], v[160:167], v3
  v_permlane32_swap_b32 v47, v51
  v_smfmac_f32_16x16x64_bf16 v[56:59], v[20:23], v[168:175], v3
  v_add_f32 v44, v44, v48
  v_smfmac_f32_16x16x64_bf16 v[56:59], v[24:27], v[176:183], v3
  v_add_f32 v45, v45, v49
  v_smfmac_f32_16x16x64_bf16 v[56:59], v[28:31], v[184:191], v3
  v_add_f32 v46, v46, v50
  v_smfmac_f32_16x16x64_bf16 v[56:59], v[32:35], v[192:199], v3
  v_add_f32 v47, v47, v51
  v_cvt_pk_bf16_f32 v48, v44, v45
  v_cvt_pk_bf16_f32 v49, v46, v47
  ds_write_b64 v113, v[48:49]
  s_nop 3
  v_permlane32_swap_b32 v52, v56
  v_permlane32_swap_b32 v53, v57
  v_permlane32_swap_b32 v54, v58
  v_permlane32_swap_b32 v55, v59
  v_add_f32 v52, v52, v56
  v_add_f32 v53, v53, v57
  v_add_f32 v54, v54, v58
  v_add_f32 v55, v55, v59
  v_cvt_pk_bf16_f32 v56, v52, v53
  v_cvt_pk_bf16_f32 v57, v54, v55
  ds_write_b64 v114, v[56:57]
  s_waitcnt lgkmcnt(0)
  s_barrier
  s_cmp_eq_u32 s19, 62
  s_cbranch_scc1 cA_done
  s_waitcnt vmcnt(0) lgkmcnt(0)
  s_add_u32 s19, s19, 1
  s_mov_b32 s20, s21
  s_branch cA_va2_loop
cA_va2_retry:
  s_waitcnt lgkmcnt(0)
  buffer_load_dwordx4 v[8:11], v2, s[8:11], s20 offen offset:0 sc1
  buffer_load_dwordx4 v[12:15], v2, s[8:11], s20 offen offset:1024 sc1
  buffer_load_dwordx4 v[16:19], v2, s[8:11], s20 offen offset:2048 sc1
  buffer_load_dwordx4 v[20:23], v2, s[8:11], s20 offen offset:3072 sc1
  s_add_u32 s31, s31, 1
  s_add_u32 s30, s30, 1
  s_cmp_lt_u32 s30, 400000
  s_cbranch_scc1 cA_va2_ld
  s_branch cA_abort
cA_va2_last:
  s_waitcnt lgkmcnt(0)
  buffer_store_dwordx4 v[100:103], v2, s[8:11], s24 offen offset:0 sc1
  buffer_store_dwordx4 v[104:107], v2, s[8:11], s24 offen offset:1024 sc1
  buffer_store_dwordx4 v[108:111], v2, s[8:11], s24 offen offset:2048 sc1
  buffer_store_dwordx4 v[4:7], v2, s[8:11], s24 offen offset:3072 sc1
  s_add_u32 s24, s24, 8192
  s_waitcnt vmcnt(0)
  s_mov_b64 exec, 1
  buffer_store_dword v117, v2, s[8:11], s34 offen sc1
  s_mov_b64 exec, -1
  s_add_u32 s34, s34, 8
  s_mov_b64 exec, 1
  buffer_store_dword v117, v2, s[8:11], s34 offen sc1
  s_mov_b64 exec, -1
  s_add_u32 s34, s34, 8
  s_branch cA_done
cA_va3_loop:
  s_add_u32 s23, s20, 4096
  s_add_u32 s21, s20, 25600
  v_mov_b32 v36, 0
  v_mov_b32 v37, 0
  v_mov_b32 v38, 0
  v_mov_b32 v39, 0
  v_mov_b32 v40, 0
  v_mov_b32 v41, 0
  v_mov_b32 v42, 0
  v_mov_b32 v43, 0
  v_mov_b32 v44, 0
  v_mov_b32 v45, 0
  v_mov_b32 v46, 0
  v_mov_b32 v47, 0
  v_mov_b32 v48, 0
  v_mov_b32 v49, 0
  v_mov_b32 v50, 0
  v_mov_b32 v51, 0
  v_mov_b32 v52, 0
  v_mov_b32 v53, 0
  v_mov_b32 v54, 0
  v_mov_b32 v55, 0
  v_mov_b32 v56, 0
  v_mov_b32 v57, 0
  v_mov_b32 v58, 0
  v_mov_b32 v59, 0
  v_mov_b32 v60, 0
  v_mov_b32 v61, 0
  v_mov_b32 v62, 0
  v_mov_b32 v63, 0
  v_mov_b32 v64, 0
  v_mov_b32 v65, 0
  v_mov_b32 v66, 0
  v_mov_b32 v67, 0
  s_mov_b32 s30, 0
  buffer_load_dword v76, v119, s[8:11], s20 offen sc1
  buffer_load_dword v77, v119, s[8:11], s20 offen sc1
  buffer_load_dword v78, v119, s[8:11], s20 offen sc1
cA_va3_fp_l:
  s_waitcnt vmcnt(2)
  v_cmp_eq_u32 vcc, -1, v76
  s_cbranch_vccz cA_va3_fp_d
  buffer_load_dword v76, v119, s[8:11], s20 offen sc1
  s_waitcnt vmcnt(2)
  v_cmp_eq_u32 vcc, -1, v77
  s_cbranch_vccz cA_va3_fp_d
  buffer_load_dword v77, v119, s[8:11], s20 offen sc1
  s_waitcnt vmcnt(2)
  v_cmp_eq_u32 vcc, -1, v78
  s_cbranch_vccz cA_va3_fp_d
  buffer_load_dword v78, v119, s[8:11], s20 offen sc1
  s_add_u32 s30, s30, 1
  s_cmp_lt_u32 s30, 400000
  s_cbranch_scc1 cA_va3_fp_l
  s_branch cA_abort
cA_va3_fp_d:
  buffer_load_dwordx4 v[24:27], v2, s[8:11], s23 offen offset:0 sc1
  buffer_load_dwordx4 v[28:31], v2, s[8:11], s23 offen offset:1024 sc1
  buffer_load_dwordx4 v[32:35], v2, s[8:11], s23 offen offset:2048 sc1
  s_barrier
cA_va3_ld:
  s_waitcnt vmcnt(0)
  v_max3_u32 v84, v24, v25, v26
  v_max3_u32 v84, v84, v27, v28
  v_max3_u32 v84, v84, v29, v30
  v_max3_u32 v84, v84, v31, v32
  v_max3_u32 v84, v84, v33, v34
  v_max_u32 v84, v84, v35
  v_cmp_eq_u32 vcc, -1, v84
  ds_write_b128 v2, v[24:27] offset:12288
  ds_write_b128 v2, v[28:31] offset:13312
  ds_write_b128 v2, v[32:35] offset:14336
  s_cbranch_vccnz cA_va3_retry
  s_waitcnt lgkmcnt(0)
  s_barrier
  ds_read_b128 v[8:11], v2 offset:8192
  ds_read_b128 v[12:15], v2 offset:9216
  ds_read_b128 v[16:19], v2 offset:10240
  ds_read_b128 v[20:23], v2 offset:11264
  s_waitcnt lgkmcnt(0)
  s_cmp_eq_u32 s19, 63
  s_cbranch_scc1 cA_done
  ds_read_b128 v[76:79], v1 offset:0
  ds_read_b128 v[80:83], v1 offset:1024
  ds_read_b128 v[84:87], v1 offset:2048
  ds_read_b128 v[88:91], v1 offset:3072
  ds_read_b128 v[92:95], v1 offset:4096
  ds_read_b128 v[96:99], v1 offset:5120
  v_smfmac_f32_16x16x64_bf16 v[60:63], v[8:11], v[200:207], v3
  v_smfmac_f32_16x16x64_bf16 v[60:63], v[12:15], v[208:215], v3
  s_waitcnt lgkmcnt(4)
  v_smfmac_f32_16x16x64_bf16 v[64:67], v[8:11], v[76:83], v3
  ds_read_b128 v[76:79], v1 offset:6144
  ds_read_b128 v[80:83], v1 offset:7168
  v_smfmac_f32_16x16x64_bf16 v[60:63], v[16:19], v[216:223], v3
  v_smfmac_f32_16x16x64_bf16 v[60:63], v[20:23], v[224:231], v3
  s_waitcnt lgkmcnt(4)
  v_smfmac_f32_16x16x64_bf16 v[64:67], v[12:15], v[84:91], v3
  ds_read_b128 v[84:87], v1 offset:8192
  ds_read_b128 v[88:91], v1 offset:9216
  v_smfmac_f32_16x16x64_bf16 v[60:63], v[24:27], v[232:239], v3
  v_smfmac_f32_16x16x64_bf16 v[60:63], v[28:31], v[240:247], v3
  s_waitcnt lgkmcnt(4)
  v_smfmac_f32_16x16x64_bf16 v[64:67], v[16:19], v[92:99], v3
  ds_read_b128 v[92:95], v1 offset:10240
  ds_read_b128 v[96:99], v1 offset:11264
  v_smfmac_f32_16x16x64_bf16 v[60:63], v[32:35], v[248:255], v3
  v_smfmac_f32_16x16x64_bf16 v[36:39], v[8:11], a[0:7], v3
  s_waitcnt lgkmcnt(4)
  v_smfmac_f32_16x16x64_bf16 v[64:67], v[20:23], v[76:83], v3
  ds_read_b128 v[76:79], v1 offset:12288
  ds_read_b128 v[80:83], v1 offset:13312
  v_smfmac_f32_16x16x64_bf16 v[36:39], v[12:15], a[8:15], v3
  v_smfmac_f32_16x16x64_bf16 v[36:39], v[16:19], a[16:23], v3
  s_waitcnt lgkmcnt(4)
  v_smfmac_f32_16x16x64_bf16 v[64:67], v[24:27], v[84:91], v3
  v_smfmac_f32_16x16x64_bf16 v[36:39], v[20:23], a[24:31], v3
  v_smfmac_f32_16x16x64_bf16 v[36:39], v[24:27], a[32:39], v3
  s_waitcnt lgkmcnt(2)
  v_smfmac_f32_16x16x64_bf16 v[64:67], v[28:31], v[92:99], v3
  v_smfmac_f32_16x16x64_bf16 v[36:39], v[28:31], a[40:47], v3
  v_smfmac_f32_16x16x64_bf16 v[36:39], v[32:35], a[48:55], v3
  s_waitcnt lgkmcnt(0)
  v_smfmac_f32_16x16x64_bf16 v[64:67], v[32:35], v[76:83], v3
  v_smfmac_f32_16x16x64_bf16 v[40:43], v[8:11], a[56:63], v3
  v_smfmac_f32_16x16x64_bf16 v[40:43], v[12:15], a[64:71], v3
  v_smfmac_f32_16x16x64_bf16 v[40:43], v[16:19], a[72:79], v3
  v_smfmac_f32_16x16x64_bf16 v[40:43], v[20:23], a[80:87], v3
  v_permlane32_swap_b32 v60, v64
  v_smfmac_f32_16x16x64_bf16 v[40:43], v[24:27], a[88:95], v3
  v_permlane32_swap_b32 v61, v65
  v_smfmac_f32_16x16x64_bf16 v[40:43], v[28:31], a[96:103], v3
  v_permlane32_swap_b32 v62, v66
  v_smfmac_f32_16x16x64_bf16 v[40:43], v[32:35], a[104:111], v3
  v_permlane32_swap_b32 v63, v67
  v_smfmac_f32_16x16x64_bf16 v[44:47], v[8:11], a[112:119], v3
  v_smfmac_f32_16x16x64_bf16 v[44:47], v[12:15], a[120:127], v3
  v_smfmac_f32_16x16x64_bf16 v[44:47], v[16:19], a[128:135], v3
  v_smfmac_f32_16x16x64_bf16 v[44:47], v[20:23], a[136:143], v3
  v_add_f32 v60, v60, v64
  v_add_f32 v61, v61, v65
  v_smfmac_f32_16x16x64_bf16 v[44:47], v[24:27], a[144:151], v3
  v_add_f32 v62, v62, v66
  v_add_f32 v63, v63, v67
  v_smfmac_f32_16x16x64_bf16 v[44:47], v[28:31], a[152:159], v3
  v_cvt_pk_bf16_f32 v64, v60, v61
  v_cvt_pk_bf16_f32 v65, v62, v63
  v_smfmac_f32_16x16x64_bf16 v[44:47], v[32:35], a[160:167], v3
  ds_write_b64 v115, v[64:65]
  v_smfmac_f32_16x16x64_bf16 v[48:51], v[8:11], a[168:175], v3
  v_permlane32_swap_b32 v36, v40
  v_smfmac_f32_16x16x64_bf16 v[48:51], v[12:15], a[176:183], v3
  v_permlane32_swap_b32 v37, v41
  v_smfmac_f32_16x16x64_bf16 v[48:51], v[16:19], a[184:191], v3
  v_permlane32_swap_b32 v38, v42
  v_smfmac_f32_16x16x64_bf16 v[48:51], v[20:23], a[192:199], v3
  v_permlane32_swap_b32 v39, v43
  v_smfmac_f32_16x16x64_bf16 v[48:51], v[24:27], a[200:207], v3
  v_add_f32 v36, v36, v40
  v_smfmac_f32_16x16x64_bf16 v[48:51], v[28:31], a[208:215], v3
  v_add_f32 v37, v37, v41
  v_smfmac_f32_16x16x64_bf16 v[48:51], v[32:35], a[216:223], v3
  v_add_f32 v38, v38, v42
  v_smfmac_f32_16x16x64_bf16 v[52:55], v[8:11], a[224:231], v3
  v_smfmac_f32_16x16x64_bf16 v[52:55], v[12:15], a[232:239], v3
  v_smfmac_f32_16x16x64_bf16 v[52:55], v[16:19], a[240:247], v3
  v_smfmac_f32_16x16x64_bf16 v[52:55], v[20:23], a[248:255], v3
  v_add_f32 v39, v39, v43
  v_cvt_pk_bf16_f32 v40, v36, v37
  v_smfmac_f32_16x16x64_bf16 v[52:55], v[24:27], v[120:127], v3
  v_cvt_pk_bf16_f32 v41, v38, v39
  v_smfmac_f32_16x16x64_bf16 v[52:55], v[28:31], v[128:135], v3
  ds_write_b64 v112, v[40:41]
  v_smfmac_f32_16x16x64_bf16 v[52:55], v[32:35], v[136:143], v3
  v_permlane32_swap_b32 v44, v48
  v_smfmac_f32_16x16x64_bf16 v[56:59], v[8:11], v[144:151], v3
  v_permlane32_swap_b32 v45, v49
  v_smfmac_f32_16x16x64_bf16 v[56:59], v[12:15], v[152:159], v3
  v_permlane32_swap_b32 v46, v50
  v_smfmac_f32_16x16x64_bf16 v[56:59], v[16:19], v[160:167], v3
  v_permlane32_swap_b32 v47, v51
  v_smfmac_f32_16x16x64_bf16 v[56:59], v[20:23], v[168:175], v3
  v_add_f32 v44, v44, v48
  v_smfmac_f32_16x16x64_bf16 v[56:59], v[24:27], v[176:183], v3
  v_add_f32 v45, v45, v49
  v_smfmac_f32_16x16x64_bf16 v[56:59], v[28:31], v[184:191], v3
  v_add_f32 v46, v46, v50
  v_smfmac_f32_16x16x64_bf16 v[56:59], v[32:35], v[192:199], v3
  v_add_f32 v47, v47, v51
  v_cvt_pk_bf16_f32 v48, v44, v45
  v_cvt_pk_bf16_f32 v49, v46, v47
  ds_write_b64 v113, v[48:49]
  s_nop 3
  v_permlane32_swap_b32 v52, v56
  v_permlane32_swap_b32 v53, v57
  v_permlane32_swap_b32 v54, v58
  v_permlane32_swap_b32 v55, v59
  v_add_f32 v52, v52, v56
  v_add_f32 v53, v53, v57
  v_add_f32 v54, v54, v58
  v_add_f32 v55, v55, v59
  v_cvt_pk_bf16_f32 v56, v52, v53
  v_cvt_pk_bf16_f32 v57, v54, v55
  ds_write_b64 v114, v[56:57]
  s_waitcnt lgkmcnt(0)
  s_barrier
  s_cmp_eq_u32 s19, 62
  s_cbranch_scc1 cA_done
  s_waitcnt vmcnt(0) lgkmcnt(0)
  s_add_u32 s19, s19, 1
  s_mov_b32 s20, s21
  s_branch cA_va3_loop
cA_va3_retry:
  s_waitcnt lgkmcnt(0)
  buffer_load_dwordx4 v[24:27], v2, s[8:11], s23 offen offset:0 sc1
  buffer_load_dwordx4 v[28:31], v2, s[8:11], s23 offen offset:1024 sc1
  buffer_load_dwordx4 v[32:35], v2, s[8:11], s23 offen offset:2048 sc1
  s_add_u32 s31, s31, 1
  s_add_u32 s30, s30, 1
  s_cmp_lt_u32 s30, 400000
  s_cbranch_scc1 cA_va3_ld
  s_branch cA_abort
cA_va3_last:
  s_waitcnt lgkmcnt(0)
  buffer_store_dwordx4 v[100:103], v2, s[8:11], s24 offen offset:0 sc1
  buffer_store_dwordx4 v[104:107], v2, s[8:11], s24 offen offset:1024 sc1
  buffer_store_dwordx4 v[108:111], v2, s[8:11], s24 offen offset:2048 sc1
  buffer_store_dwordx4 v[4:7], v2, s[8:11], s24 offen offset:3072 sc1
  s_add_u32 s24, s24, 8192
  s_waitcnt vmcnt(0)
  s_mov_b64 exec, 1
  buffer_store_dword v117, v2, s[8:11], s34 offen sc1
  s_mov_b64 exec, -1
  s_add_u32 s34, s34, 8
  s_mov_b64 exec, 1
  buffer_store_dword v117, v2, s[8:11], s34 offen sc1
  s_mov_b64 exec, -1
  s_add_u32 s34, s34, 8
  s_branch cA_done
cA_abort:
  v_mov_b32 v4, 0xdead
  v_mov_b32 v5, 16
  buffer_store_dword v4, v5, s[12:15], 0 offen
  s_branch ch_end
cA_done:
  s_branch ch_end
cB_sc0_loop:
  s_add_u32 s23, s20, 4096
  s_add_u32 s21, s20, 25600
  v_mov_b32 v48, 0
  v_mov_b32 v49, 0
  v_mov_b32 v50, 0
  v_mov_b32 v51, 0
  v_mov_b32 v52, 0
  v_mov_b32 v53, 0
  v_mov_b32 v54, 0
  v_mov_b32 v55, 0
  v_mov_b32 v56, 0
  v_mov_b32 v57, 0
  v_mov_b32 v58, 0
  v_mov_b32 v59, 0
  v_mov_b32 v60, 0
  v_mov_b32 v61, 0
  v_mov_b32 v62, 0
  v_mov_b32 v63, 0
  v_mov_b32 v88, 0
  v_mov_b32 v89, 0
  v_mov_b32 v90, 0
  v_mov_b32 v91, 0
  v_mov_b32 v92, 0
  v_mov_b32 v93, 0
  v_mov_b32 v94, 0
  v_mov_b32 v95, 0
  v_mov_b32 v66, 0
  v_mov_b32 v67, 0
  s_mov_b32 s30, 0
  s_mov_b32 s62, 0
  buffer_load_dword v68, v0, s[8:11], s20 offen sc1
  s_nop 7
  buffer_load_dword v69, v0, s[8:11], s20 offen sc1
  s_nop 7
  buffer_load_dword v70, v0, s[8:11], s20 offen sc1
  s_nop 7
  buffer_load_dword v71, v0, s[8:11], s20 offen sc1
  s_nop 7
  buffer_load_dword v72, v0, s[8:11], s20 offen sc1
cB_sc0_fp_l:
  s_waitcnt vmcnt(4)
  v_cmp_eq_u32 vcc, -1, v68
  s_cbranch_vccz cB_sc0_fp_d
  buffer_load_dword v68, v0, s[8:11], s20 offen sc1
  s_waitcnt vmcnt(4)
  v_cmp_eq_u32 vcc, -1, v69
  s_cbranch_vccz cB_sc0_fp_d
  buffer_load_dword v69, v0, s[8:11], s20 offen sc1
  s_waitcnt vmcnt(4)
  v_cmp_eq_u32 vcc, -1, v70
  s_cbranch_vccz cB_sc0_fp_d
  buffer_load_dword v70, v0, s[8:11], s20 offen sc1
  s_waitcnt vmcnt(4)
  v_cmp_eq_u32 vcc, -1, v71
  s_cbranch_vccz cB_sc0_fp_d
  buffer_load_dword v71, v0, s[8:11], s20 offen sc1
  s_waitcnt vmcnt(4)
  v_cmp_eq_u32 vcc, -1, v72
  s_cbranch_vccz cB_sc0_fp_d
  buffer_load_dword v72, v0, s[8:11], s20 offen sc1
  s_add_u32 s30, s30, 1
  s_cmp_lt_u32 s30, 400000
  s_cbranch_scc1 cB_sc0_fp_l
  s_branch cB_abort
cB_sc0_fp_d:
  buffer_load_dwordx4 v[8:11], v2, s[8:11], s20 offen offset:0 sc1
  s_barrier
  s_branch cB_sc0_ld1
cB_sc0_ld:
  buffer_load_dwordx4 v[8:11], v2, s[8:11], s20 offen offset:0 sc1
cB_sc0_ld1:
  v_mov_b32 v36, 0
  v_mov_b32 v37, 0
  v_mov_b32 v38, 0
  v_mov_b32 v39, 0
  buffer_load_dwordx4 v[12:15], v2, s[8:11], s20 offen offset:1024 sc1
  v_mov_b32 v40, 0
  v_mov_b32 v41, 0
  v_mov_b32 v42, 0
  v_mov_b32 v43, 0
  buffer_load_dwordx4 v[16:19], v2, s[8:11], s20 offen offset:2048 sc1
  v_mov_b32 v44, 0
  v_mov_b32 v45, 0
  v_mov_b32 v46, 0
  v_mov_b32 v47, 0
  ds_read_b128 v[96:99], v116 offset:12288
  ds_read_b128 v[100:103], v116 offset:13312
  ds_read_b128 v[104:107], v116 offset:26624
  ds_read_b128 v[108:111], v116 offset:27648
  s_waitcnt vmcnt(2)
  v_smfmac_f32_16x16x64_bf16 v[36:39], v[8:11], a[0:7], v3
  v_smfmac_f32_16x16x64_bf16 v[40:43], v[8:11], a[56:63], v3
  buffer_load_dwordx4 v[20:23], v2, s[8:11], s20 offen offset:3072 sc1
  v_smfmac_f32_16x16x64_bf16 v[44:47], v[8:11], a[112:119], v3
  v_smfmac_f32_16x16x64_bf16 v[48:51], v[8:11], a[168:175], v3
  v_smfmac_f32_16x16x64_bf16 v[52:55], v[8:11], a[224:231], v3
  buffer_load_dwordx4 v[24:27], v2, s[8:11], s23 offen offset:0 sc1
  v_smfmac_f32_16x16x64_bf16 v[56:59], v[8:11], v[144:151], v3
  v_smfmac_f32_16x16x64_bf16 v[60:63], v[8:11], v[200:207], v3
  s_waitcnt vmcnt(3)
  v_smfmac_f32_16x16x64_bf16 v[36:39], v[12:15], a[8:15], v3
  v_smfmac_f32_16x16x64_bf16 v[40:43], v[12:15], a[64:71], v3
  buffer_load_dwordx4 v[28:31], v2, s[8:11], s23 offen offset:1024 sc1
  v_smfmac_f32_16x16x64_bf16 v[44:47], v[12:15], a[120:127], v3
  v_smfmac_f32_16x16x64_bf16 v[48:51], v[12:15], a[176:183], v3
  v_smfmac_f32_16x16x64_bf16 v[52:55], v[12:15], a[232:239], v3
  buffer_load_dwordx4 v[32:35], v2, s[8:11], s23 offen offset:2048 sc1
  v_smfmac_f32_16x16x64_bf16 v[56:59], v[12:15], v[152:159], v3
  v_smfmac_f32_16x16x64_bf16 v[60:63], v[12:15], v[208:215], v3
  s_waitcnt vmcnt(4)
  v_smfmac_f32_16x16x64_bf16 v[36:39], v[16:19], a[16:23], v3
  v_smfmac_f32_16x16x64_bf16 v[40:43], v[16:19], a[72:79], v3
  v_smfmac_f32_16x16x64_bf16 v[44:47], v[16:19], a[128:135], v3
  v_smfmac_f32_16x16x64_bf16 v[48:51], v[16:19], a[184:191], v3
  v_smfmac_f32_16x16x64_bf16 v[52:55], v[16:19], a[240:247], v3
  v_smfmac_f32_16x16x64_bf16 v[56:59], v[16:19], v[160:167], v3
  v_smfmac_f32_16x16x64_bf16 v[60:63], v[16:19], v[216:223], v3
  s_waitcnt vmcnt(3)
  v_smfmac_f32_16x16x64_bf16 v[36:39], v[20:23], a[24:31], v3
  v_smfmac_f32_16x16x64_bf16 v[40:43], v[20:23], a[80:87], v3
  v_smfmac_f32_16x16x64_bf16 v[44:47], v[20:23], a[136:143], v3
  v_smfmac_f32_16x16x64_bf16 v[48:51], v[20:23], a[192:199], v3
  v_smfmac_f32_16x16x64_bf16 v[52:55], v[20:23], a[248:255], v3
  v_smfmac_f32_16x16x64_bf16 v[56:59], v[20:23], v[168:175], v3
  v_smfmac_f32_16x16x64_bf16 v[60:63], v[20:23], v[224:231], v3
  s_waitcnt vmcnt(0)
cB_sc0_ph2:
  v_smfmac_f32_16x16x64_bf16 v[60:63], v[24:27], v[232:239], v3
  ds_read_b128 v[12:15], v116 offset:8192
  ds_read_b128 v[16:19], v116 offset:9216
  v_smfmac_f32_16x16x64_bf16 v[60:63], v[28:31], v[240:247], v3
  v_smfmac_f32_16x16x64_bf16 v[60:63], v[32:35], v[248:255], v3
  v_smfmac_f32_16x16x64_bf16 v[52:55], v[24:27], v[120:127], v3
  v_smfmac_f32_16x16x64_bf16 v[52:55], v[28:31], v[128:135], v3
  v_smfmac_f32_16x16x64_bf16 v[52:55], v[32:35], v[136:143], v3
  v_cvt_pk_bf16_f32 v64, v60, v61
  v_smfmac_f32_16x16x64_bf16 v[56:59], v[24:27], v[176:183], v3
  v_cvt_pk_bf16_f32 v65, v62, v63
  v_smfmac_f32_16x16x64_bf16 v[56:59], v[28:31], v[184:191], v3
  v_mfma_f32_16x16x32_bf16 v[68:71], v[64:67], v[4:7], 0
  v_smfmac_f32_16x16x64_bf16 v[56:59], v[32:35], v[192:199], v3
  v_cvt_pk_bf16_f32 v64, v52, v53
  v_smfmac_f32_16x16x64_bf16 v[36:39], v[24:27], a[32:39], v3
  v_cvt_pk_bf16_f32 v65, v54, v55
  v_smfmac_f32_16x16x64_bf16 v[36:39], v[28:31], a[40:47], v3
  v_cvt_pk_bf16_f32 v76, v68, v69
  v_smfmac_f32_16x16x64_bf16 v[36:39], v[32:35], a[48:55], v3
  v_cvt_pk_bf16_f32 v77, v70, v71
  v_cvt_pk_bf16_f32 v66, v56, v57
  v_smfmac_f32_16x16x64_bf16 v[40:43], v[24:27], a[88:95], v3
  v_cvt_pk_bf16_f32 v67, v58, v59
  v_smfmac_f32_16x16x64_bf16 v[40:43], v[28:31], a[96:103], v3
  v_mfma_f32_16x16x32_bf16 v[72:75], v[64:67], v[4:7], 0
  ds_read_b128 v[52:55], v116 offset:22528
  ds_read_b128 v[56:59], v116 offset:23552
  v_smfmac_f32_16x16x64_bf16 v[40:43], v[32:35], a[104:111], v3
  v_cvt_pk_bf16_f32 v64, v36, v37
  v_smfmac_f32_16x16x64_bf16 v[44:47], v[24:27], a[144:151], v3
  v_cvt_pk_bf16_f32 v65, v38, v39
  v_smfmac_f32_16x16x64_bf16 v[44:47], v[28:31], a[152:159], v3
  v_cvt_pk_bf16_f32 v80, v72, v73
  v_smfmac_f32_16x16x64_bf16 v[44:47], v[32:35], a[160:167], v3
  v_cvt_pk_bf16_f32 v81, v74, v75
  v_cvt_pk_bf16_f32 v66, v40, v41
  v_smfmac_f32_16x16x64_bf16 v[48:51], v[24:27], a[200:207], v3
  v_cvt_pk_bf16_f32 v67, v42, v43
  v_smfmac_f32_16x16x64_bf16 v[48:51], v[28:31], a[208:215], v3
  v_mfma_f32_16x16x32_bf16 v[68:71], v[64:67], v[4:7], 0
  ds_read_b128 v[36:39], v116 offset:0
  ds_read_b128 v[40:43], v116 offset:1024
  v_smfmac_f32_16x16x64_bf16 v[48:51], v[32:35], a[216:223], v3
  s_waitcnt lgkmcnt(4)
  v_cvt_pk_bf16_f32 v64, v44, v45
  v_mfma_f32_16x16x32_bf16 v[84:87], v[32:35], v[76:79], 0
  v_cvt_pk_bf16_f32 v65, v46, v47
  v_smfmac_f32_16x16x64_bf16 v[88:91], v[76:79], v[96:103], v3
  ds_read_b128 v[96:99], v116 offset:14336
  ds_read_b128 v[100:103], v116 offset:15360
  v_smfmac_f32_16x16x64_bf16 v[92:95], v[76:79], v[104:111], v3
  v_cvt_pk_bf16_f32 v66, v48, v49
  v_cvt_pk_bf16_f32 v67, v50, v51
  v_mfma_f32_16x16x32_bf16 v[84:87], v[24:27], v[80:83], v[84:87]
  v_cvt_pk_bf16_f32 v60, v68, v69
  v_mfma_f32_16x16x32_bf16 v[72:75], v[64:67], v[4:7], 0
  v_cvt_pk_bf16_f32 v61, v70, v71
  s_waitcnt lgkmcnt(4)
  v_smfmac_f32_16x16x64_bf16 v[88:91], v[80:83], v[12:19], v3
  v_smfmac_f32_16x16x64_bf16 v[92:95], v[80:83], v[52:59], v3
  s_waitcnt lgkmcnt(0)
  s_nop 0
  v_cvt_pk_bf16_f32 v62, v72, v73
  v_cvt_pk_bf16_f32 v63, v74, v75
  s_nop 1
  v_mfma_f32_16x16x32_bf16 v[84:87], v[8:11], v[60:63], v[84:87]
  v_smfmac_f32_16x16x64_bf16 v[88:91], v[60:63], v[36:43], v3
  v_smfmac_f32_16x16x64_bf16 v[92:95], v[60:63], v[96:103], v3
  s_mov_b64 exec, s[26:27]
  s_nop 0
  ds_write_b128 v113, v[84:87]
  s_mov_b64 exec, -1
  s_nop 0
  v_cmp_u_f32 vcc, v88, v89
  s_nop 1
  v_permlane32_swap_b32 v88, v92
  v_permlane32_swap_b32 v89, v93
  v_permlane32_swap_b32 v90, v94
  v_permlane32_swap_b32 v91, v95
  v_add_f32 v88, v88, v92
  v_add_f32 v89, v89, v93
  v_add_f32 v90, v90, v94
  v_add_f32 v91, v91, v95
  ds_write_b128 v112, v[88:91]
  s_cbranch_vccnz cB_sc0_retry
cB_sc0_cont:
  s_waitcnt lgkmcnt(0)
  s_barrier
  ds_read_b64 v[36:37], v114 offset:0
  ds_read_b64 v[38:39], v114 offset:1024
  ds_read2_b32 v[44:45], v115 offset0:0 offset1:64
  s_waitcnt lgkmcnt(0)
  v_add_f32 v44, v44, v45
  v_add_f32 v36, v36, v38
  v_add_f32 v37, v37, v39
  v_add_f32_dpp v44, v44, v44 row_ror:8 row_mask:0xf bank_mask:0xf
  v_mov_b32 v45, v44
  v_permlane32_swap_b32 v36, v37
  v_add_f32 v36, v36, v37
  v_permlane16_swap_b32 v44, v45
  v_add_f32 v44, v44, v45
  v_max_f32 v38, v36, v44
  s_nop 1
  v_max_f32_dpp v38, v38, v38 quad_perm:[1,0,3,2] row_mask:0xf bank_mask:0xf
  s_nop 1
  v_max_f32_dpp v38, v38, v38 quad_perm:[2,3,0,1] row_mask:0xf bank_mask:0xf
  s_nop 1
  v_max_f32_dpp v38, v38, v38 row_half_mirror row_mask:0xf bank_mask:0xf
  s_nop 1
  v_max_f32_dpp v38, v38, v38 row_mirror row_mask:0xf bank_mask:0xf
  v_mov_b32 v39, v38
  s_nop 1
  v_permlane16_swap_b32 v38, v39
  v_max_f32 v38, v38, v39
  v_sub_f32 v36, v36, v38
  v_sub_f32 v44, v44, v38
  v_exp_f32 v36, v36
  v_exp_f32 v44, v44
  s_nop 0
  v_fma_f32 v39, v44, s37, v36
  v_cndmask_b32 v40, v44, v36, s[38:39]
  v_cndmask_b32 v41, v36, v44, s[38:39]
  v_add_f32_dpp v39, v39, v39 quad_perm:[1,0,3,2] row_mask:0xf bank_mask:0xf
  s_nop 0
  v_mov_b32_dpp v46, v41 quad_perm:[1,0,3,2] row_mask:0xf bank_mask:0xf
  v_add_f32_dpp v39, v39, v39 quad_perm:[2,3,0,1] row_mask:0xf bank_mask:0xf
  v_cndmask_b32 v42, v46, v40, s[38:39]
  v_cndmask_b32 v43, v40, v46, s[38:39]
  v_add_f32_dpp v39, v39, v39 row_half_mirror row_mask:0xf bank_mask:0xf
  s_nop 1
  v_add_f32_dpp v39, v39, v39 row_mirror row_mask:0xf bank_mask:0xf
  v_mov_b32 v47, v39
  s_nop 1
  v_permlane16_swap_b32 v39, v47
  v_add_f32 v39, v39, v47
  v_rcp_f32 v39, v39
  s_nop 0
  v_mul_f32 v42, v42, v39
  v_mul_f32 v43, v43, v39
  v_cvt_pk_bf16_f32 v42, v42, v43
  v_min_u32 v42, -2, v42
  s_mov_b64 exec, s[28:29]
  buffer_store_dword v42, v1, s[8:11], s20 offen sc1
  s_mov_b64 exec, -1
  s_barrier
  s_add_u32 s24, s24, 28672
  s_add_u32 s35, s35, 28672
  s_xor_b32 s25, s25, 28672
  s_add_u32 m0, s25, 0
  s_nop 0
  buffer_load_dwordx4 v2, s[8:11], s24 offen offset:0 sc1 lds
  buffer_load_dwordx4 v2, s[8:11], s24 offen offset:1024 sc1 lds
  buffer_load_dwordx4 v2, s[8:11], s24 offen offset:2048 sc1 lds
  buffer_load_dwordx4 v2, s[8:11], s24 offen offset:3072 sc1 lds
  s_add_u32 m0, s25, 4096
  s_add_u32 s22, s24, 4096
  buffer_load_dwordx4 v2, s[8:11], s22 offen offset:0 sc1 lds
  buffer_load_dwordx4 v2, s[8:11], s22 offen offset:1024 sc1 lds
  buffer_load_dwordx4 v2, s[8:11], s22 offen offset:2048 sc1 lds
  v_xor_b32 v116, 28672, v116
  s_add_u32 s19, s19, 1
  s_mov_b32 s20, s21
  s_cmp_lt_u32 s19, 63
  s_cbranch_scc1 cB_sc0_loop
  s_branch cB_done
cB_sc0_retry:
  s_cmp_lg_u32 s62, 0
  s_cbranch_scc1 cB_sc0_cont
  s_waitcnt vmcnt(0) lgkmcnt(0)
cB_sc0_rv:
  buffer_load_dwordx4 v[8:11], v2, s[8:11], s20 offen offset:0 sc1
  buffer_load_dwordx4 v[12:15], v2, s[8:11], s20 offen offset:1024 sc1
  buffer_load_dwordx4 v[16:19], v2, s[8:11], s20 offen offset:2048 sc1
  buffer_load_dwordx4 v[20:23], v2, s[8:11], s20 offen offset:3072 sc1
  buffer_load_dwordx4 v[24:27], v2, s[8:11], s23 offen offset:0 sc1
  buffer_load_dwordx4 v[28:31], v2, s[8:11], s23 offen offset:1024 sc1
  buffer_load_dwordx4 v[32:35], v2, s[8:11], s23 offen offset:2048 sc1
  s_waitcnt vmcnt(0)
  v_max3_u32 v118, v8, v9, v10
  v_max3_u32 v118, v118, v11, v12
  v_max3_u32 v118, v118, v13, v14
  v_max3_u32 v118, v118, v15, v16
  v_max3_u32 v118, v118, v17, v18
  v_max3_u32 v118, v118, v19, v20
  v_max3_u32 v118, v118, v21, v22
  v_max3_u32 v118, v118, v23, v24
  v_max3_u32 v118, v118, v25, v26
  v_max3_u32 v118, v118, v27, v28
  v_max3_u32 v118, v118, v29, v30
  v_max3_u32 v118, v118, v31, v32
  v_max3_u32 v118, v118, v33, v34
  v_max_u32 v118, v118, v35
  v_cmp_eq_u32 vcc, -1, v118
  s_cbranch_vccz cB_sc0_rk
  s_add_u32 s30, s30, 1
  s_cmp_lt_u32 s30, 400000
  s_cbranch_scc1 cB_sc0_rv
  s_branch cB_abort
cB_sc0_rk:
  s_mov_b32 s62, 1
  v_mov_b32 v36, 0
  v_mov_b32 v37, 0
  v_mov_b32 v38, 0
  v_mov_b32 v39, 0
  v_mov_b32 v40, 0
  v_mov_b32 v41, 0
  v_mov_b32 v42, 0
  v_mov_b32 v43, 0
  v_mov_b32 v44, 0
  v_mov_b32 v45, 0
  v_mov_b32 v46, 0
  v_mov_b32 v47, 0
  v_mov_b32 v48, 0
  v_mov_b32 v49, 0
  v_mov_b32 v50, 0
  v_mov_b32 v51, 0
  v_mov_b32 v52, 0
  v_mov_b32 v53, 0
  v_mov_b32 v54, 0
  v_mov_b32 v55, 0
  v_mov_b32 v56, 0
  v_mov_b32 v57, 0
  v_mov_b32 v58, 0
  v_mov_b32 v59, 0
  v_mov_b32 v60, 0
  v_mov_b32 v61, 0
  v_mov_b32 v62, 0
  v_mov_b32 v63, 0
  v_mov_b32 v88, 0
  v_mov_b32 v89, 0
  v_mov_b32 v90, 0
  v_mov_b32 v91, 0
  v_mov_b32 v92, 0
  v_mov_b32 v93, 0
  v_mov_b32 v94, 0
  v_mov_b32 v95, 0
  v_mov_b32 v66, 0
  v_mov_b32 v67, 0
  s_add_u32 s31, s31, 1
  ds_read_b128 v[96:99], v116 offset:12288
  ds_read_b128 v[100:103], v116 offset:13312
  ds_read_b128 v[104:107], v116 offset:26624
  ds_read_b128 v[108:111], v116 offset:27648
  v_smfmac_f32_16x16x64_bf16 v[36:39], v[8:11], a[0:7], v3
  v_smfmac_f32_16x16x64_bf16 v[40:43], v[8:11], a[56:63], v3
  v_smfmac_f32_16x16x64_bf16 v[44:47], v[8:11], a[112:119], v3
  v_smfmac_f32_16x16x64_bf16 v[48:51], v[8:11], a[168:175], v3
  v_smfmac_f32_16x16x64_bf16 v[52:55], v[8:11], a[224:231], v3
  v_smfmac_f32_16x16x64_bf16 v[56:59], v[8:11], v[144:151], v3
  v_smfmac_f32_16x16x64_bf16 v[60:63], v[8:11], v[200:207], v3
  v_smfmac_f32_16x16x64_bf16 v[36:39], v[12:15], a[8:15], v3
  v_smfmac_f32_16x16x64_bf16 v[40:43], v[12:15], a[64:71], v3
  v_smfmac_f32_16x16x64_bf16 v[44:47], v[12:15], a[120:127], v3
  v_smfmac_f32_16x16x64_bf16 v[48:51], v[12:15], a[176:183], v3
  v_smfmac_f32_16x16x64_bf16 v[52:55], v[12:15], a[232:239], v3
  v_smfmac_f32_16x16x64_bf16 v[56:59], v[12:15], v[152:159], v3
  v_smfmac_f32_16x16x64_bf16 v[60:63], v[12:15], v[208:215], v3
  v_smfmac_f32_16x16x64_bf16 v[36:39], v[16:19], a[16:23], v3
  v_smfmac_f32_16x16x64_bf16 v[40:43], v[16:19], a[72:79], v3
  v_smfmac_f32_16x16x64_bf16 v[44:47], v[16:19], a[128:135], v3
  v_smfmac_f32_16x16x64_bf16 v[48:51], v[16:19], a[184:191], v3
  v_smfmac_f32_16x16x64_bf16 v[52:55], v[16:19], a[240:247], v3
  v_smfmac_f32_16x16x64_bf16 v[56:59], v[16:19], v[160:167], v3
  v_smfmac_f32_16x16x64_bf16 v[60:63], v[16:19], v[216:223], v3
  v_smfmac_f32_16x16x64_bf16 v[36:39], v[20:23], a[24:31], v3
  v_smfmac_f32_16x16x64_bf16 v[40:43], v[20:23], a[80:87], v3
  v_smfmac_f32_16x16x64_bf16 v[44:47], v[20:23], a[136:143], v3
  v_smfmac_f32_16x16x64_bf16 v[48:51], v[20:23], a[192:199], v3
  v_smfmac_f32_16x16x64_bf16 v[52:55], v[20:23], a[248:255], v3
  v_smfmac_f32_16x16x64_bf16 v[56:59], v[20:23], v[168:175], v3
  v_smfmac_f32_16x16x64_bf16 v[60:63], v[20:23], v[224:231], v3
  s_branch cB_sc0_ph2
cB_sc1_loop:
  s_add_u32 s23, s20, 4096
  s_add_u32 s21, s20, 25600
  v_mov_b32 v48, 0
  v_mov_b32 v49, 0
  v_mov_b32 v50, 0
  v_mov_b32 v51, 0
  v_mov_b32 v52, 0
  v_mov_b32 v53, 0
  v_mov_b32 v54, 0
  v_mov_b32 v55, 0
  v_mov_b32 v56, 0
  v_mov_b32 v57, 0
  v_mov_b32 v58, 0
  v_mov_b32 v59, 0
  v_mov_b32 v60, 0
  v_mov_b32 v61, 0
  v_mov_b32 v62, 0
  v_mov_b32 v63, 0
  v_mov_b32 v88, 0
  v_mov_b32 v89, 0
  v_mov_b32 v90, 0
  v_mov_b32 v91, 0
  v_mov_b32 v92, 0
  v_mov_b32 v93, 0
  v_mov_b32 v94, 0
  v_mov_b32 v95, 0
  v_mov_b32 v64, 0
  v_mov_b32 v65, 0
  s_mov_b32 s30, 0
  s_mov_b32 s62, 0
  s_waitcnt vmcnt(0)
  s_barrier
cB_sc1_ld:
  buffer_load_dwordx4 v[8:11], v2, s[8:11], s20 offen offset:0 sc1
  v_mov_b32 v36, 0
  v_mov_b32 v37, 0
  v_mov_b32 v38, 0
  v_mov_b32 v39, 0
  buffer_load_dwordx4 v[12:15], v2, s[8:11], s20 offen offset:1024 sc1
  v_mov_b32 v40, 0
  v_mov_b32 v41, 0
  v_mov_b32 v42, 0
  v_mov_b32 v43, 0
  buffer_load_dwordx4 v[16:19], v2, s[8:11], s20 offen offset:2048 sc1
  v_mov_b32 v44, 0
  v_mov_b32 v45, 0
  v_mov_b32 v46, 0
  v_mov_b32 v47, 0
  ds_read_b128 v[96:99], v116 offset:12288
  ds_read_b128 v[100:103], v116 offset:13312
  ds_read_b128 v[104:107], v116 offset:26624
  ds_read_b128 v[108:111], v116 offset:27648
  s_waitcnt vmcnt(2)
  v_smfmac_f32_16x16x64_bf16 v[36:39], v[8:11], a[0:7], v3
  v_smfmac_f32_16x16x64_bf16 v[40:43], v[8:11], a[56:63], v3
  buffer_load_dwordx4 v[20:23], v2, s[8:11], s20 offen offset:3072 sc1
  v_smfmac_f32_16x16x64_bf16 v[44:47], v[8:11], a[112:119], v3
  v_smfmac_f32_16x16x64_bf16 v[48:51], v[8:11], a[168:175], v3
  v_smfmac_f32_16x16x64_bf16 v[52:55], v[8:11], a[224:231], v3
  buffer_load_dwordx4 v[24:27], v2, s[8:11], s23 offen offset:0 sc1
  v_smfmac_f32_16x16x64_bf16 v[56:59], v[8:11], v[144:151], v3
  v_smfmac_f32_16x16x64_bf16 v[60:63], v[8:11], v[200:207], v3
  s_waitcnt vmcnt(3)
  v_smfmac_f32_16x16x64_bf16 v[36:39], v[12:15], a[8:15], v3
  v_smfmac_f32_16x16x64_bf16 v[40:43], v[12:15], a[64:71], v3
  buffer_load_dwordx4 v[28:31], v2, s[8:11], s23 offen offset:1024 sc1
  v_smfmac_f32_16x16x64_bf16 v[44:47], v[12:15], a[120:127], v3
  v_smfmac_f32_16x16x64_bf16 v[48:51], v[12:15], a[176:183], v3
  v_smfmac_f32_16x16x64_bf16 v[52:55], v[12:15], a[232:239], v3
  buffer_load_dwordx4 v[32:35], v2, s[8:11], s23 offen offset:2048 sc1
  v_smfmac_f32_16x16x64_bf16 v[56:59], v[12:15], v[152:159], v3
  v_smfmac_f32_16x16x64_bf16 v[60:63], v[12:15], v[208:215], v3
  s_waitcnt vmcnt(4)
  v_smfmac_f32_16x16x64_bf16 v[36:39], v[16:19], a[16:23], v3
  v_smfmac_f32_16x16x64_bf16 v[40:43], v[16:19], a[72:79], v3
  v_smfmac_f32_16x16x64_bf16 v[44:47], v[16:19], a[128:135], v3
  v_smfmac_f32_16x16x64_bf16 v[48:51], v[16:19], a[184:191], v3
  v_smfmac_f32_16x16x64_bf16 v[52:55], v[16:19], a[240:247], v3
  v_smfmac_f32_16x16x64_bf16 v[56:59], v[16:19], v[160:167], v3
  v_smfmac_f32_16x16x64_bf16 v[60:63], v[16:19], v[216:223], v3
  s_waitcnt vmcnt(3)
  v_smfmac_f32_16x16x64_bf16 v[36:39], v[20:23], a[24:31], v3
  v_smfmac_f32_16x16x64_bf16 v[40:43], v[20:23], a[80:87], v3
  v_smfmac_f32_16x16x64_bf16 v[44:47], v[20:23], a[136:143], v3
  v_smfmac_f32_16x16x64_bf16 v[48:51], v[20:23], a[192:199], v3
  v_smfmac_f32_16x16x64_bf16 v[52:55], v[20:23], a[248:255], v3
  v_smfmac_f32_16x16x64_bf16 v[56:59], v[20:23], v[168:175], v3
  v_smfmac_f32_16x16x64_bf16 v[60:63], v[20:23], v[224:231], v3
  s_waitcnt vmcnt(0)
cB_sc1_ph2:
  v_smfmac_f32_16x16x64_bf16 v[60:63], v[24:27], v[232:239], v3
  ds_read_b128 v[16:19], v116 offset:8192
  ds_read_b128 v[20:23], v116 offset:9216
  v_smfmac_f32_16x16x64_bf16 v[60:63], v[28:31], v[240:247], v3
  buffer_load_dword v119, v0, s[8:11], s20 offen sc1
  v_smfmac_f32_16x16x64_bf16 v[60:63], v[32:35], v[248:255], v3
  v_smfmac_f32_16x16x64_bf16 v[52:55], v[24:27], v[120:127], v3
  v_smfmac_f32_16x16x64_bf16 v[52:55], v[28:31], v[128:135], v3
  v_smfmac_f32_16x16x64_bf16 v[52:55], v[32:35], v[136:143], v3
  v_cvt_pk_bf16_f32 v66, v60, v61
  v_smfmac_f32_16x16x64_bf16 v[56:59], v[24:27], v[176:183], v3
  v_cvt_pk_bf16_f32 v67, v62, v63
  v_smfmac_f32_16x16x64_bf16 v[56:59], v[28:31], v[184:191], v3
  v_mfma_f32_16x16x32_bf16 v[68:71], v[64:67], v[4:7], 0
  v_smfmac_f32_16x16x64_bf16 v[56:59], v[32:35], v[192:199], v3
  v_cvt_pk_bf16_f32 v64, v52, v53
  v_smfmac_f32_16x16x64_bf16 v[36:39], v[24:27], a[32:39], v3
  v_cvt_pk_bf16_f32 v65, v54, v55
  v_smfmac_f32_16x16x64_bf16 v[36:39], v[28:31], a[40:47], v3
  v_cvt_pk_bf16_f32 v76, v68, v69
  v_smfmac_f32_16x16x64_bf16 v[36:39], v[32:35], a[48:55], v3
  v_cvt_pk_bf16_f32 v77, v70, v71
  v_cvt_pk_bf16_f32 v66, v56, v57
  v_smfmac_f32_16x16x64_bf16 v[40:43], v[24:27], a[88:95], v3
  v_cvt_pk_bf16_f32 v67, v58, v59
  v_smfmac_f32_16x16x64_bf16 v[40:43], v[28:31], a[96:103], v3
  v_mfma_f32_16x16x32_bf16 v[72:75], v[64:67], v[4:7], 0
  ds_read_b128 v[52:55], v116 offset:22528
  ds_read_b128 v[56:59], v116 offset:23552
  v_smfmac_f32_16x16x64_bf16 v[40:43], v[32:35], a[104:111], v3
  v_cvt_pk_bf16_f32 v64, v36, v37
  v_smfmac_f32_16x16x64_bf16 v[44:47], v[24:27], a[144:151], v3
  v_cvt_pk_bf16_f32 v65, v38, v39
  v_smfmac_f32_16x16x64_bf16 v[44:47], v[28:31], a[152:159], v3
  v_cvt_pk_bf16_f32 v82, v72, v73
  v_smfmac_f32_16x16x64_bf16 v[44:47], v[32:35], a[160:167], v3
  v_cvt_pk_bf16_f32 v83, v74, v75
  v_cvt_pk_bf16_f32 v66, v40, v41
  v_smfmac_f32_16x16x64_bf16 v[48:51], v[24:27], a[200:207], v3
  v_cvt_pk_bf16_f32 v67, v42, v43
  v_smfmac_f32_16x16x64_bf16 v[48:51], v[28:31], a[208:215], v3
  v_mfma_f32_16x16x32_bf16 v[68:71], v[64:67], v[4:7], 0
  ds_read_b128 v[36:39], v116 offset:2048
  ds_read_b128 v[40:43], v116 offset:3072
  v_smfmac_f32_16x16x64_bf16 v[48:51], v[32:35], a[216:223], v3
  s_waitcnt lgkmcnt(4)
  v_cvt_pk_bf16_f32 v64, v44, v45
  v_mfma_f32_16x16x32_bf16 v[84:87], v[32:35], v[76:79], 0
  v_cvt_pk_bf16_f32 v65, v46, v47
  v_smfmac_f32_16x16x64_bf16 v[88:91], v[76:79], v[96:103], v3
  ds_read_b128 v[96:99], v116 offset:16384
  ds_read_b128 v[100:103], v116 offset:17408
  v_smfmac_f32_16x16x64_bf16 v[92:95], v[76:79], v[104:111], v3
  v_cvt_pk_bf16_f32 v66, v48, v49
  v_cvt_pk_bf16_f32 v67, v50, v51
  v_mfma_f32_16x16x32_bf16 v[84:87], v[24:27], v[80:83], v[84:87]
  v_cvt_pk_bf16_f32 v60, v68, v69
  v_mfma_f32_16x16x32_bf16 v[72:75], v[64:67], v[4:7], 0
  v_cvt_pk_bf16_f32 v61, v70, v71
  s_waitcnt lgkmcnt(4)
  v_smfmac_f32_16x16x64_bf16 v[88:91], v[80:83], v[16:23], v3
  v_smfmac_f32_16x16x64_bf16 v[92:95], v[80:83], v[52:59], v3
  s_waitcnt lgkmcnt(0)
  s_nop 0
  v_cvt_pk_bf16_f32 v62, v72, v73
  v_cvt_pk_bf16_f32 v63, v74, v75
  s_nop 1
  v_mfma_f32_16x16x32_bf16 v[84:87], v[12:15], v[60:63], v[84:87]
  v_smfmac_f32_16x16x64_bf16 v[88:91], v[60:63], v[36:43], v3
  v_smfmac_f32_16x16x64_bf16 v[92:95], v[60:63], v[96:103], v3
  s_mov_b64 exec, s[26:27]
  s_nop 0
  ds_write_b128 v113, v[84:87]
  s_mov_b64 exec, -1
  s_nop 0
  v_cmp_u_f32 vcc, v88, v89
  s_nop 1
  v_permlane32_swap_b32 v88, v92
  v_permlane32_swap_b32 v89, v93
  v_permlane32_swap_b32 v90, v94
  v_permlane32_swap_b32 v91, v95
  v_add_f32 v88, v88, v92
  v_add_f32 v89, v89, v93
  v_add_f32 v90, v90, v94
  v_add_f32 v91, v91, v95
  ds_write_b128 v112, v[88:91]
  s_cbranch_vccnz cB_sc1_retry
cB_sc1_cont:
  s_waitcnt lgkmcnt(0)
  s_barrier
  ds_read_b64 v[36:37], v114 offset:0
  ds_read_b64 v[38:39], v114 offset:1024
  ds_read2_b32 v[44:45], v115 offset0:0 offset1:64
  s_waitcnt lgkmcnt(0)
  v_add_f32 v44, v44, v45
  v_add_f32 v36, v36, v38
  v_add_f32 v37, v37, v39
  v_add_f32_dpp v44, v44, v44 row_ror:8 row_mask:0xf bank_mask:0xf
  v_mov_b32 v45, v44
  v_permlane32_swap_b32 v36, v37
  v_add_f32 v36, v36, v37
  v_permlane16_swap_b32 v44, v45
  v_add_f32 v44, v44, v45
  v_max_f32 v38, v36, v44
  s_nop 1
  v_max_f32_dpp v38, v38, v38 quad_perm:[1,0,3,2] row_mask:0xf bank_mask:0xf
  s_nop 1
  v_max_f32_dpp v38, v38, v38 quad_perm:[2,3,0,1] row_mask:0xf bank_mask:0xf
  s_nop 1
  v_max_f32_dpp v38, v38, v38 row_half_mirror row_mask:0xf bank_mask:0xf
  s_nop 1
  v_max_f32_dpp v38, v38, v38 row_mirror row_mask:0xf bank_mask:0xf
  v_mov_b32 v39, v38
  s_nop 1
  v_permlane16_swap_b32 v38, v39
  v_max_f32 v38, v38, v39
  v_sub_f32 v36, v36, v38
  v_sub_f32 v44, v44, v38
  v_exp_f32 v36, v36
  v_exp_f32 v44, v44
  s_nop 0
  v_fma_f32 v39, v44, s37, v36
  v_cndmask_b32 v40, v44, v36, s[38:39]
  v_cndmask_b32 v41, v36, v44, s[38:39]
  v_add_f32_dpp v39, v39, v39 quad_perm:[1,0,3,2] row_mask:0xf bank_mask:0xf
  s_nop 0
  v_mov_b32_dpp v46, v41 quad_perm:[1,0,3,2] row_mask:0xf bank_mask:0xf
  v_add_f32_dpp v39, v39, v39 quad_perm:[2,3,0,1] row_mask:0xf bank_mask:0xf
  v_cndmask_b32 v42, v46, v40, s[38:39]
  v_cndmask_b32 v43, v40, v46, s[38:39]
  v_add_f32_dpp v39, v39, v39 row_half_mirror row_mask:0xf bank_mask:0xf
  s_nop 1
  v_add_f32_dpp v39, v39, v39 row_mirror row_mask:0xf bank_mask:0xf
  v_mov_b32 v47, v39
  s_nop 1
  v_permlane16_swap_b32 v39, v47
  v_add_f32 v39, v39, v47
  v_rcp_f32 v39, v39
  s_nop 0
  v_mul_f32 v42, v42, v39
  v_mul_f32 v43, v43, v39
  v_cvt_pk_bf16_f32 v42, v42, v43
  v_min_u32 v42, -2, v42
  s_mov_b64 exec, s[28:29]
  buffer_store_dword v42, v1, s[8:11], s20 offen sc1
  s_mov_b64 exec, -1
  s_barrier
  s_add_u32 s24, s24, 28672
  s_add_u32 s35, s35, 28672
  s_xor_b32 s25, s25, 28672
  s_add_u32 m0, s25, 7168
  s_nop 0
  buffer_load_dwordx4 v2, s[8:11], s24 offen offset:0 sc1 lds
  buffer_load_dwordx4 v2, s[8:11], s24 offen offset:1024 sc1 lds
  buffer_load_dwordx4 v2, s[8:11], s24 offen offset:2048 sc1 lds
  buffer_load_dwordx4 v2, s[8:11], s24 offen offset:3072 sc1 lds
  s_add_u32 m0, s25, 11264
  s_add_u32 s22, s24, 4096
  buffer_load_dwordx4 v2, s[8:11], s22 offen offset:0 sc1 lds
  buffer_load_dwordx4 v2, s[8:11], s22 offen offset:1024 sc1 lds
  buffer_load_dwordx4 v2, s[8:11], s22 offen offset:2048 sc1 lds
  v_xor_b32 v116, 28672, v116
  s_add_u32 s19, s19, 1
  s_mov_b32 s20, s21
  s_cmp_lt_u32 s19, 63
  s_cbranch_scc1 cB_sc1_loop
  s_branch cB_done
cB_sc1_retry:
  s_cmp_lg_u32 s62, 0
  s_cbranch_scc1 cB_sc1_cont
  s_waitcnt vmcnt(0) lgkmcnt(0)
cB_sc1_rv:
  buffer_load_dwordx4 v[8:11], v2, s[8:11], s20 offen offset:0 sc1
  buffer_load_dwordx4 v[12:15], v2, s[8:11], s20 offen offset:1024 sc1
  buffer_load_dwordx4 v[16:19], v2, s[8:11], s20 offen offset:2048 sc1
  buffer_load_dwordx4 v[20:23], v2, s[8:11], s20 offen offset:3072 sc1
  buffer_load_dwordx4 v[24:27], v2, s[8:11], s23 offen offset:0 sc1
  buffer_load_dwordx4 v[28:31], v2, s[8:11], s23 offen offset:1024 sc1
  buffer_load_dwordx4 v[32:35], v2, s[8:11], s23 offen offset:2048 sc1
  s_waitcnt vmcnt(0)
  v_max3_u32 v118, v8, v9, v10
  v_max3_u32 v118, v118, v11, v12
  v_max3_u32 v118, v118, v13, v14
  v_max3_u32 v118, v118, v15, v16
  v_max3_u32 v118, v118, v17, v18
  v_max3_u32 v118, v118, v19, v20
  v_max3_u32 v118, v118, v21, v22
  v_max3_u32 v118, v118, v23, v24
  v_max3_u32 v118, v118, v25, v26
  v_max3_u32 v118, v118, v27, v28
  v_max3_u32 v118, v118, v29, v30
  v_max3_u32 v118, v118, v31, v32
  v_max3_u32 v118, v118, v33, v34
  v_max_u32 v118, v118, v35
  v_cmp_eq_u32 vcc, -1, v118
  s_cbranch_vccz cB_sc1_rk
  s_add_u32 s30, s30, 1
  s_cmp_lt_u32 s30, 400000
  s_cbranch_scc1 cB_sc1_rv
  s_branch cB_abort
cB_sc1_rk:
  s_mov_b32 s62, 1
  v_mov_b32 v36, 0
  v_mov_b32 v37, 0
  v_mov_b32 v38, 0
  v_mov_b32 v39, 0
  v_mov_b32 v40, 0
  v_mov_b32 v41, 0
  v_mov_b32 v42, 0
  v_mov_b32 v43, 0
  v_mov_b32 v44, 0
  v_mov_b32 v45, 0
  v_mov_b32 v46, 0
  v_mov_b32 v47, 0
  v_mov_b32 v48, 0
  v_mov_b32 v49, 0
  v_mov_b32 v50, 0
  v_mov_b32 v51, 0
  v_mov_b32 v52, 0
  v_mov_b32 v53, 0
  v_mov_b32 v54, 0
  v_mov_b32 v55, 0
  v_mov_b32 v56, 0
  v_mov_b32 v57, 0
  v_mov_b32 v58, 0
  v_mov_b32 v59, 0
  v_mov_b32 v60, 0
  v_mov_b32 v61, 0
  v_mov_b32 v62, 0
  v_mov_b32 v63, 0
  v_mov_b32 v88, 0
  v_mov_b32 v89, 0
  v_mov_b32 v90, 0
  v_mov_b32 v91, 0
  v_mov_b32 v92, 0
  v_mov_b32 v93, 0
  v_mov_b32 v94, 0
  v_mov_b32 v95, 0
  v_mov_b32 v64, 0
  v_mov_b32 v65, 0
  s_add_u32 s31, s31, 1
  ds_read_b128 v[96:99], v116 offset:12288
  ds_read_b128 v[100:103], v116 offset:13312
  ds_read_b128 v[104:107], v116 offset:26624
  ds_read_b128 v[108:111], v116 offset:27648
  v_smfmac_f32_16x16x64_bf16 v[36:39], v[8:11], a[0:7], v3
  v_smfmac_f32_16x16x64_bf16 v[40:43], v[8:11], a[56:63], v3
  v_smfmac_f32_16x16x64_bf16 v[44:47], v[8:11], a[112:119], v3
  v_smfmac_f32_16x16x64_bf16 v[48:51], v[8:11], a[168:175], v3
  v_smfmac_f32_16x16x64_bf16 v[52:55], v[8:11], a[224:231], v3
  v_smfmac_f32_16x16x64_bf16 v[56:59], v[8:11], v[144:151], v3
  v_smfmac_f32_16x16x64_bf16 v[60:63], v[8:11], v[200:207], v3
  v_smfmac_f32_16x16x64_bf16 v[36:39], v[12:15], a[8:15], v3
  v_smfmac_f32_16x16x64_bf16 v[40:43], v[12:15], a[64:71], v3
  v_smfmac_f32_16x16x64_bf16 v[44:47], v[12:15], a[120:127], v3
  v_smfmac_f32_16x16x64_bf16 v[48:51], v[12:15], a[176:183], v3
  v_smfmac_f32_16x16x64_bf16 v[52:55], v[12:15], a[232:239], v3
  v_smfmac_f32_16x16x64_bf16 v[56:59], v[12:15], v[152:159], v3
  v_smfmac_f32_16x16x64_bf16 v[60:63], v[12:15], v[208:215], v3
  v_smfmac_f32_16x16x64_bf16 v[36:39], v[16:19], a[16:23], v3
  v_smfmac_f32_16x16x64_bf16 v[40:43], v[16:19], a[72:79], v3
  v_smfmac_f32_16x16x64_bf16 v[44:47], v[16:19], a[128:135], v3
  v_smfmac_f32_16x16x64_bf16 v[48:51], v[16:19], a[184:191], v3
  v_smfmac_f32_16x16x64_bf16 v[52:55], v[16:19], a[240:247], v3
  v_smfmac_f32_16x16x64_bf16 v[56:59], v[16:19], v[160:167], v3
  v_smfmac_f32_16x16x64_bf16 v[60:63], v[16:19], v[216:223], v3
  v_smfmac_f32_16x16x64_bf16 v[36:39], v[20:23], a[24:31], v3
  v_smfmac_f32_16x16x64_bf16 v[40:43], v[20:23], a[80:87], v3
  v_smfmac_f32_16x16x64_bf16 v[44:47], v[20:23], a[136:143], v3
  v_smfmac_f32_16x16x64_bf16 v[48:51], v[20:23], a[192:199], v3
  v_smfmac_f32_16x16x64_bf16 v[52:55], v[20:23], a[248:255], v3
  v_smfmac_f32_16x16x64_bf16 v[56:59], v[20:23], v[168:175], v3
  v_smfmac_f32_16x16x64_bf16 v[60:63], v[20:23], v[224:231], v3
  s_branch cB_sc1_ph2
cB_sc2_loop:
  s_add_u32 s23, s20, 4096
  s_add_u32 s21, s20, 25600
  v_mov_b32 v48, 0
  v_mov_b32 v49, 0
  v_mov_b32 v50, 0
  v_mov_b32 v51, 0
  v_mov_b32 v52, 0
  v_mov_b32 v53, 0
  v_mov_b32 v54, 0
  v_mov_b32 v55, 0
  v_mov_b32 v56, 0
  v_mov_b32 v57, 0
  v_mov_b32 v58, 0
  v_mov_b32 v59, 0
  v_mov_b32 v60, 0
  v_mov_b32 v61, 0
  v_mov_b32 v62, 0
  v_mov_b32 v63, 0
  v_mov_b32 v88, 0
  v_mov_b32 v89, 0
  v_mov_b32 v90, 0
  v_mov_b32 v91, 0
  v_mov_b32 v92, 0
  v_mov_b32 v93, 0
  v_mov_b32 v94, 0
  v_mov_b32 v95, 0
  v_mov_b32 v66, 0
  v_mov_b32 v67, 0
  s_mov_b32 s30, 0
  s_mov_b32 s62, 0
  s_waitcnt vmcnt(0)
  s_barrier
cB_sc2_ld:
  buffer_load_dwordx4 v[8:11], v2, s[8:11], s20 offen offset:0 sc1
  v_mov_b32 v36, 0
  v_mov_b32 v37, 0
  v_mov_b32 v38, 0
  v_mov_b32 v39, 0
  buffer_load_dwordx4 v[12:15], v2, s[8:11], s20 offen offset:1024 sc1
  v_mov_b32 v40, 0
  v_mov_b32 v41, 0
  v_mov_b32 v42, 0
  v_mov_b32 v43, 0
  buffer_load_dwordx4 v[16:19], v2, s[8:11], s20 offen offset:2048 sc1
  v_mov_b32 v44, 0
  v_mov_b32 v45, 0
  v_mov_b32 v46, 0
  v_mov_b32 v47, 0
  ds_read_b128 v[96:99], v116 offset:12288
  ds_read_b128 v[100:103], v116 offset:13312
  ds_read_b128 v[104:107], v116 offset:26624
  ds_read_b128 v[108:111], v116 offset:27648
  s_waitcnt vmcnt(2)
  v_smfmac_f32_16x16x64_bf16 v[36:39], v[8:11], a[0:7], v3
  v_smfmac_f32_16x16x64_bf16 v[40:43], v[8:11], a[56:63], v3
  buffer_load_dwordx4 v[20:23], v2, s[8:11], s20 offen offset:3072 sc1
  v_smfmac_f32_16x16x64_bf16 v[44:47], v[8:11], a[112:119], v3
  v_smfmac_f32_16x16x64_bf16 v[48:51], v[8:11], a[168:175], v3
  v_smfmac_f32_16x16x64_bf16 v[52:55], v[8:11], a[224:231], v3
  buffer_load_dwordx4 v[24:27], v2, s[8:11], s23 offen offset:0 sc1
  v_smfmac_f32_16x16x64_bf16 v[56:59], v[8:11], v[144:151], v3
  v_smfmac_f32_16x16x64_bf16 v[60:63], v[8:11], v[200:207], v3
  s_waitcnt vmcnt(3)
  v_smfmac_f32_16x16x64_bf16 v[36:39], v[12:15], a[8:15], v3
  v_smfmac_f32_16x16x64_bf16 v[40:43], v[12:15], a[64:71], v3
  buffer_load_dwordx4 v[28:31], v2, s[8:11], s23 offen offset:1024 sc1
  v_smfmac_f32_16x16x64_bf16 v[44:47], v[12:15], a[120:127], v3
  v_smfmac_f32_16x16x64_bf16 v[48:51], v[12:15], a[176:183], v3
  v_smfmac_f32_16x16x64_bf16 v[52:55], v[12:15], a[232:239], v3
  buffer_load_dwordx4 v[32:35], v2, s[8:11], s23 offen offset:2048 sc1
  v_smfmac_f32_16x16x64_bf16 v[56:59], v[12:15], v[152:159], v3
  v_smfmac_f32_16x16x64_bf16 v[60:63], v[12:15], v[208:215], v3
  s_waitcnt vmcnt(4)
  v_smfmac_f32_16x16x64_bf16 v[36:39], v[16:19], a[16:23], v3
  v_smfmac_f32_16x16x64_bf16 v[40:43], v[16:19], a[72:79], v3
  v_smfmac_f32_16x16x64_bf16 v[44:47], v[16:19], a[128:135], v3
  v_smfmac_f32_16x16x64_bf16 v[48:51], v[16:19], a[184:191], v3
  v_smfmac_f32_16x16x64_bf16 v[52:55], v[16:19], a[240:247], v3
  v_smfmac_f32_16x16x64_bf16 v[56:59], v[16:19], v[160:167], v3
  v_smfmac_f32_16x16x64_bf16 v[60:63], v[16:19], v[216:223], v3
  s_waitcnt vmcnt(3)
  v_smfmac_f32_16x16x64_bf16 v[36:39], v[20:23], a[24:31], v3
  v_smfmac_f32_16x16x64_bf16 v[40:43], v[20:23], a[80:87], v3
  v_smfmac_f32_16x16x64_bf16 v[44:47], v[20:23], a[136:143], v3
  v_smfmac_f32_16x16x64_bf16 v[48:51], v[20:23], a[192:199], v3
  v_smfmac_f32_16x16x64_bf16 v[52:55], v[20:23], a[248:255], v3
  v_smfmac_f32_16x16x64_bf16 v[56:59], v[20:23], v[168:175], v3
  v_smfmac_f32_16x16x64_bf16 v[60:63], v[20:23], v[224:231], v3
  s_waitcnt vmcnt(0)
cB_sc2_ph2:
  v_smfmac_f32_16x16x64_bf16 v[60:63], v[24:27], v[232:239], v3
  ds_read_b128 v[8:11], v116 offset:10240
  ds_read_b128 v[12:15], v116 offset:11264
  v_smfmac_f32_16x16x64_bf16 v[60:63], v[28:31], v[240:247], v3
  buffer_load_dword v119, v0, s[8:11], s24 offen sc1
  v_smfmac_f32_16x16x64_bf16 v[60:63], v[32:35], v[248:255], v3
  v_smfmac_f32_16x16x64_bf16 v[52:55], v[24:27], v[120:127], v3
  v_smfmac_f32_16x16x64_bf16 v[52:55], v[28:31], v[128:135], v3
  v_smfmac_f32_16x16x64_bf16 v[52:55], v[32:35], v[136:143], v3
  v_cvt_pk_bf16_f32 v64, v60, v61
  v_smfmac_f32_16x16x64_bf16 v[56:59], v[24:27], v[176:183], v3
  v_cvt_pk_bf16_f32 v65, v62, v63
  v_smfmac_f32_16x16x64_bf16 v[56:59], v[28:31], v[184:191], v3
  v_mfma_f32_16x16x32_bf16 v[68:71], v[64:67], v[4:7], 0
  v_smfmac_f32_16x16x64_bf16 v[56:59], v[32:35], v[192:199], v3
  v_cvt_pk_bf16_f32 v64, v52, v53
  v_smfmac_f32_16x16x64_bf16 v[36:39], v[24:27], a[32:39], v3
  v_cvt_pk_bf16_f32 v65, v54, v55
  v_smfmac_f32_16x16x64_bf16 v[36:39], v[28:31], a[40:47], v3
  v_cvt_pk_bf16_f32 v78, v68, v69
  v_smfmac_f32_16x16x64_bf16 v[36:39], v[32:35], a[48:55], v3
  v_cvt_pk_bf16_f32 v79, v70, v71
  v_cvt_pk_bf16_f32 v66, v56, v57
  v_smfmac_f32_16x16x64_bf16 v[40:43], v[24:27], a[88:95], v3
  v_cvt_pk_bf16_f32 v67, v58, v59
  v_smfmac_f32_16x16x64_bf16 v[40:43], v[28:31], a[96:103], v3
  v_mfma_f32_16x16x32_bf16 v[72:75], v[64:67], v[4:7], 0
  ds_read_b128 v[52:55], v116 offset:24576
  ds_read_b128 v[56:59], v116 offset:25600
  v_smfmac_f32_16x16x64_bf16 v[40:43], v[32:35], a[104:111], v3
  v_cvt_pk_bf16_f32 v64, v36, v37
  v_smfmac_f32_16x16x64_bf16 v[44:47], v[24:27], a[144:151], v3
  v_cvt_pk_bf16_f32 v65, v38, v39
  v_smfmac_f32_16x16x64_bf16 v[44:47], v[28:31], a[152:159], v3
  v_cvt_pk_bf16_f32 v80, v72, v73
  v_smfmac_f32_16x16x64_bf16 v[44:47], v[32:35], a[160:167], v3
  v_cvt_pk_bf16_f32 v81, v74, v75
  v_cvt_pk_bf16_f32 v66, v40, v41
  v_smfmac_f32_16x16x64_bf16 v[48:51], v[24:27], a[200:207], v3
  v_cvt_pk_bf16_f32 v67, v42, v43
  v_smfmac_f32_16x16x64_bf16 v[48:51], v[28:31], a[208:215], v3
  v_mfma_f32_16x16x32_bf16 v[68:71], v[64:67], v[4:7], 0
  ds_read_b128 v[36:39], v116 offset:4096
  ds_read_b128 v[40:43], v116 offset:5120
  v_smfmac_f32_16x16x64_bf16 v[48:51], v[32:35], a[216:223], v3
  s_waitcnt lgkmcnt(4)
  v_cvt_pk_bf16_f32 v64, v44, v45
  v_mfma_f32_16x16x32_bf16 v[84:87], v[32:35], v[76:79], 0
  v_cvt_pk_bf16_f32 v65, v46, v47
  v_smfmac_f32_16x16x64_bf16 v[88:91], v[76:79], v[96:103], v3
  ds_read_b128 v[96:99], v116 offset:18432
  ds_read_b128 v[100:103], v116 offset:19456
  v_smfmac_f32_16x16x64_bf16 v[92:95], v[76:79], v[104:111], v3
  v_cvt_pk_bf16_f32 v66, v48, v49
  v_cvt_pk_bf16_f32 v67, v50, v51
  v_mfma_f32_16x16x32_bf16 v[84:87], v[28:31], v[80:83], v[84:87]
  v_cvt_pk_bf16_f32 v60, v68, v69
  v_mfma_f32_16x16x32_bf16 v[72:75], v[64:67], v[4:7], 0
  v_cvt_pk_bf16_f32 v61, v70, v71
  s_waitcnt lgkmcnt(4)
  v_smfmac_f32_16x16x64_bf16 v[88:91], v[80:83], v[8:15], v3
  v_smfmac_f32_16x16x64_bf16 v[92:95], v[80:83], v[52:59], v3
  s_waitcnt lgkmcnt(0)
  s_nop 0
  v_cvt_pk_bf16_f32 v62, v72, v73
  v_cvt_pk_bf16_f32 v63, v74, v75
  s_nop 1
  v_mfma_f32_16x16x32_bf16 v[84:87], v[16:19], v[60:63], v[84:87]
  v_smfmac_f32_16x16x64_bf16 v[88:91], v[60:63], v[36:43], v3
  v_smfmac_f32_16x16x64_bf16 v[92:95], v[60:63], v[96:103], v3
  s_mov_b64 exec, s[26:27]
  s_nop 0
  ds_write_b128 v113, v[84:87]
  s_mov_b64 exec, -1
  s_nop 0
  v_cmp_u_f32 vcc, v88, v89
  s_nop 1
  v_permlane32_swap_b32 v88, v92
  v_permlane32_swap_b32 v89, v93
  v_permlane32_swap_b32 v90, v94
  v_permlane32_swap_b32 v91, v95
  v_add_f32 v88, v88, v92
  v_add_f32 v89, v89, v93
  v_add_f32 v90, v90, v94
  v_add_f32 v91, v91, v95
  ds_write_b128 v112, v[88:91]
  s_cbranch_vccnz cB_sc2_retry
cB_sc2_cont:
  s_waitcnt lgkmcnt(0)
  s_barrier
  ds_read_b64 v[36:37], v114 offset:0
  ds_read_b64 v[38:39], v114 offset:1024
  ds_read2_b32 v[44:45], v115 offset0:0 offset1:64
  v_lshl_add_u32 v56, v2, 3, s36
  s_waitcnt lgkmcnt(0)
  v_add_f32 v44, v44, v45
  v_add_f32 v36, v36, v38
  v_add_f32 v37, v37, v39
  v_add_f32_dpp v44, v44, v44 row_ror:8 row_mask:0xf bank_mask:0xf
  v_mov_b32 v45, v44
  v_permlane32_swap_b32 v36, v37
  v_add_f32 v36, v36, v37
  v_permlane16_swap_b32 v44, v45
  v_add_f32 v44, v44, v45
  v_max_f32 v38, v36, v44
  s_mov_b64 exec, 65535
  buffer_store_dword v2, v56, s[8:11], s20 offen sc1
  s_mov_b64 exec, -1
  v_max_f32_dpp v38, v38, v38 quad_perm:[1,0,3,2] row_mask:0xf bank_mask:0xf
  s_nop 1
  v_max_f32_dpp v38, v38, v38 quad_perm:[2,3,0,1] row_mask:0xf bank_mask:0xf
  s_nop 1
  v_max_f32_dpp v38, v38, v38 row_half_mirror row_mask:0xf bank_mask:0xf
  s_nop 1
  v_max_f32_dpp v38, v38, v38 row_mirror row_mask:0xf bank_mask:0xf
  v_mov_b32 v39, v38
  s_nop 1
  v_permlane16_swap_b32 v38, v39
  v_max_f32 v38, v38, v39
  v_sub_f32 v36, v36, v38
  v_sub_f32 v44, v44, v38
  v_exp_f32 v36, v36
  v_exp_f32 v44, v44
  s_nop 0
  v_fma_f32 v39, v44, s37, v36
  v_cndmask_b32 v40, v44, v36, s[38:39]
  v_cndmask_b32 v41, v36, v44, s[38:39]
  v_add_f32_dpp v39, v39, v39 quad_perm:[1,0,3,2] row_mask:0xf bank_mask:0xf
  s_nop 0
  v_mov_b32_dpp v46, v41 quad_perm:[1,0,3,2] row_mask:0xf bank_mask:0xf
  v_add_f32_dpp v39, v39, v39 quad_perm:[2,3,0,1] row_mask:0xf bank_mask:0xf
  v_cndmask_b32 v42, v46, v40, s[38:39]
  v_cndmask_b32 v43, v40, v46, s[38:39]
  v_add_f32_dpp v39, v39, v39 row_half_mirror row_mask:0xf bank_mask:0xf
  s_nop 1
  v_add_f32_dpp v39, v39, v39 row_mirror row_mask:0xf bank_mask:0xf
  v_mov_b32 v47, v39
  s_nop 1
  v_permlane16_swap_b32 v39, v47
  v_add_f32 v39, v39, v47
  v_rcp_f32 v39, v39
  s_nop 0
  v_mul_f32 v42, v42, v39
  v_mul_f32 v43, v43, v39
  v_cvt_pk_bf16_f32 v42, v42, v43
  v_min_u32 v42, -2, v42
  s_mov_b64 exec, s[28:29]
  buffer_store_dword v42, v1, s[8:11], s20 offen sc1
  s_mov_b64 exec, -1
  s_barrier
  s_add_u32 s24, s24, 28672
  s_add_u32 s35, s35, 28672
  s_xor_b32 s25, s25, 28672
  s_add_u32 m0, s25, 14336
  s_nop 0
  buffer_load_dwordx4 v2, s[8:11], s24 offen offset:0 sc1 lds
  buffer_load_dwordx4 v2, s[8:11], s24 offen offset:1024 sc1 lds
  buffer_load_dwordx4 v2, s[8:11], s24 offen offset:2048 sc1 lds
  buffer_load_dwordx4 v2, s[8:11], s24 offen offset:3072 sc1 lds
  s_add_u32 m0, s25, 18432
  s_add_u32 s22, s24, 4096
  buffer_load_dwordx4 v2, s[8:11], s22 offen offset:0 sc1 lds
  buffer_load_dwordx4 v2, s[8:11], s22 offen offset:1024 sc1 lds
  buffer_load_dwordx4 v2, s[8:11], s22 offen offset:2048 sc1 lds
  v_xor_b32 v116, 28672, v116
  s_add_u32 s19, s19, 1
  s_mov_b32 s20, s21
  s_cmp_lt_u32 s19, 63
  s_cbranch_scc1 cB_sc2_loop
  s_branch cB_done
cB_sc2_retry:
  s_cmp_lg_u32 s62, 0
  s_cbranch_scc1 cB_sc2_cont
  s_waitcnt vmcnt(0) lgkmcnt(0)
cB_sc2_rv:
  buffer_load_dwordx4 v[8:11], v2, s[8:11], s20 offen offset:0 sc1
  buffer_load_dwordx4 v[12:15], v2, s[8:11], s20 offen offset:1024 sc1
  buffer_load_dwordx4 v[16:19], v2, s[8:11], s20 offen offset:2048 sc1
  buffer_load_dwordx4 v[20:23], v2, s[8:11], s20 offen offset:3072 sc1
  buffer_load_dwordx4 v[24:27], v2, s[8:11], s23 offen offset:0 sc1
  buffer_load_dwordx4 v[28:31], v2, s[8:11], s23 offen offset:1024 sc1
  buffer_load_dwordx4 v[32:35], v2, s[8:11], s23 offen offset:2048 sc1
  s_waitcnt vmcnt(0)
  v_max3_u32 v118, v8, v9, v10
  v_max3_u32 v118, v118, v11, v12
  v_max3_u32 v118, v118, v13, v14
  v_max3_u32 v118, v118, v15, v16
  v_max3_u32 v118, v118, v17, v18
  v_max3_u32 v118, v118, v19, v20
  v_max3_u32 v118, v118, v21, v22
  v_max3_u32 v118, v118, v23, v24
  v_max3_u32 v118, v118, v25, v26
  v_max3_u32 v118, v118, v27, v28
  v_max3_u32 v118, v118, v29, v30
  v_max3_u32 v118, v118, v31, v32
  v_max3_u32 v118, v118, v33, v34
  v_max_u32 v118, v118, v35
  v_cmp_eq_u32 vcc, -1, v118
  s_cbranch_vccz cB_sc2_rk
  s_add_u32 s30, s30, 1
  s_cmp_lt_u32 s30, 400000
  s_cbranch_scc1 cB_sc2_rv
  s_branch cB_abort
cB_sc2_rk:
  s_mov_b32 s62, 1
  v_mov_b32 v36, 0
  v_mov_b32 v37, 0
  v_mov_b32 v38, 0
  v_mov_b32 v39, 0
  v_mov_b32 v40, 0
  v_mov_b32 v41, 0
  v_mov_b32 v42, 0
  v_mov_b32 v43, 0
  v_mov_b32 v44, 0
  v_mov_b32 v45, 0
  v_mov_b32 v46, 0
  v_mov_b32 v47, 0
  v_mov_b32 v48, 0
  v_mov_b32 v49, 0
  v_mov_b32 v50, 0
  v_mov_b32 v51, 0
  v_mov_b32 v52, 0
  v_mov_b32 v53, 0
  v_mov_b32 v54, 0
  v_mov_b32 v55, 0
  v_mov_b32 v56, 0
  v_mov_b32 v57, 0
  v_mov_b32 v58, 0
  v_mov_b32 v59, 0
  v_mov_b32 v60, 0
  v_mov_b32 v61, 0
  v_mov_b32 v62, 0
  v_mov_b32 v63, 0
  v_mov_b32 v88, 0
  v_mov_b32 v89, 0
  v_mov_b32 v90, 0
  v_mov_b32 v91, 0
  v_mov_b32 v92, 0
  v_mov_b32 v93, 0
  v_mov_b32 v94, 0
  v_mov_b32 v95, 0
  v_mov_b32 v66, 0
  v_mov_b32 v67, 0
  s_add_u32 s31, s31, 1
  ds_read_b128 v[96:99], v116 offset:12288
  ds_read_b128 v[100:103], v116 offset:13312
  ds_read_b128 v[104:107], v116 offset:26624
  ds_read_b128 v[108:111], v116 offset:27648
  v_smfmac_f32_16x16x64_bf16 v[36:39], v[8:11], a[0:7], v3
  v_smfmac_f32_16x16x64_bf16 v[40:43], v[8:11], a[56:63], v3
  v_smfmac_f32_16x16x64_bf16 v[44:47], v[8:11], a[112:119], v3
  v_smfmac_f32_16x16x64_bf16 v[48:51], v[8:11], a[168:175], v3
  v_smfmac_f32_16x16x64_bf16 v[52:55], v[8:11], a[224:231], v3
  v_smfmac_f32_16x16x64_bf16 v[56:59], v[8:11], v[144:151], v3
  v_smfmac_f32_16x16x64_bf16 v[60:63], v[8:11], v[200:207], v3
  v_smfmac_f32_16x16x64_bf16 v[36:39], v[12:15], a[8:15], v3
  v_smfmac_f32_16x16x64_bf16 v[40:43], v[12:15], a[64:71], v3
  v_smfmac_f32_16x16x64_bf16 v[44:47], v[12:15], a[120:127], v3
  v_smfmac_f32_16x16x64_bf16 v[48:51], v[12:15], a[176:183], v3
  v_smfmac_f32_16x16x64_bf16 v[52:55], v[12:15], a[232:239], v3
  v_smfmac_f32_16x16x64_bf16 v[56:59], v[12:15], v[152:159], v3
  v_smfmac_f32_16x16x64_bf16 v[60:63], v[12:15], v[208:215], v3
  v_smfmac_f32_16x16x64_bf16 v[36:39], v[16:19], a[16:23], v3
  v_smfmac_f32_16x16x64_bf16 v[40:43], v[16:19], a[72:79], v3
  v_smfmac_f32_16x16x64_bf16 v[44:47], v[16:19], a[128:135], v3
  v_smfmac_f32_16x16x64_bf16 v[48:51], v[16:19], a[184:191], v3
  v_smfmac_f32_16x16x64_bf16 v[52:55], v[16:19], a[240:247], v3
  v_smfmac_f32_16x16x64_bf16 v[56:59], v[16:19], v[160:167], v3
  v_smfmac_f32_16x16x64_bf16 v[60:63], v[16:19], v[216:223], v3
  v_smfmac_f32_16x16x64_bf16 v[36:39], v[20:23], a[24:31], v3
  v_smfmac_f32_16x16x64_bf16 v[40:43], v[20:23], a[80:87], v3
  v_smfmac_f32_16x16x64_bf16 v[44:47], v[20:23], a[136:143], v3
  v_smfmac_f32_16x16x64_bf16 v[48:51], v[20:23], a[192:199], v3
  v_smfmac_f32_16x16x64_bf16 v[52:55], v[20:23], a[248:255], v3
  v_smfmac_f32_16x16x64_bf16 v[56:59], v[20:23], v[168:175], v3
  v_smfmac_f32_16x16x64_bf16 v[60:63], v[20:23], v[224:231], v3
  s_branch cB_sc2_ph2
cB_sc3_loop:
  s_add_u32 s23, s20, 4096
  s_add_u32 s21, s20, 25600
  v_mov_b32 v48, 0
  v_mov_b32 v49, 0
  v_mov_b32 v50, 0
  v_mov_b32 v51, 0
  v_mov_b32 v52, 0
  v_mov_b32 v53, 0
  v_mov_b32 v54, 0
  v_mov_b32 v55, 0
  v_mov_b32 v56, 0
  v_mov_b32 v57, 0
  v_mov_b32 v58, 0
  v_mov_b32 v59, 0
  v_mov_b32 v60, 0
  v_mov_b32 v61, 0
  v_mov_b32 v62, 0
  v_mov_b32 v63, 0
  v_mov_b32 v88, 0
  v_mov_b32 v89, 0
  v_mov_b32 v90, 0
  v_mov_b32 v91, 0
  v_mov_b32 v92, 0
  v_mov_b32 v93, 0
  v_mov_b32 v94, 0
  v_mov_b32 v95, 0
  v_mov_b32 v64, 0
  v_mov_b32 v65, 0
  s_mov_b32 s30, 0
  s_mov_b32 s62, 0
  s_waitcnt vmcnt(0)
  s_barrier
cB_sc3_ld:
  buffer_load_dwordx4 v[8:11], v2, s[8:11], s20 offen offset:0 sc1
  v_mov_b32 v36, 0
  v_mov_b32 v37, 0
  v_mov_b32 v38, 0
  v_mov_b32 v39, 0
  buffer_load_dwordx4 v[12:15], v2, s[8:11], s20 offen offset:1024 sc1
  v_mov_b32 v40, 0
  v_mov_b32 v41, 0
  v_mov_b32 v42, 0
  v_mov_b32 v43, 0
  buffer_load_dwordx4 v[16:19], v2, s[8:11], s20 offen offset:2048 sc1
  v_mov_b32 v44, 0
  v_mov_b32 v45, 0
  v_mov_b32 v46, 0
  v_mov_b32 v47, 0
  ds_read_b128 v[96:99], v116 offset:12288
  ds_read_b128 v[100:103], v116 offset:13312
  ds_read_b128 v[104:107], v116 offset:26624
  ds_read_b128 v[108:111], v116 offset:27648
  s_waitcnt vmcnt(2)
  v_smfmac_f32_16x16x64_bf16 v[36:39], v[8:11], a[0:7], v3
  v_smfmac_f32_16x16x64_bf16 v[40:43], v[8:11], a[56:63], v3
  buffer_load_dwordx4 v[20:23], v2, s[8:11], s20 offen offset:3072 sc1
  v_smfmac_f32_16x16x64_bf16 v[44:47], v[8:11], a[112:119], v3
  v_smfmac_f32_16x16x64_bf16 v[48:51], v[8:11], a[168:175], v3
  v_smfmac_f32_16x16x64_bf16 v[52:55], v[8:11], a[224:231], v3
  buffer_load_dwordx4 v[24:27], v2, s[8:11], s23 offen offset:0 sc1
  v_smfmac_f32_16x16x64_bf16 v[56:59], v[8:11], v[144:151], v3
  v_smfmac_f32_16x16x64_bf16 v[60:63], v[8:11], v[200:207], v3
  s_waitcnt vmcnt(3)
  v_smfmac_f32_16x16x64_bf16 v[36:39], v[12:15], a[8:15], v3
  v_smfmac_f32_16x16x64_bf16 v[40:43], v[12:15], a[64:71], v3
  buffer_load_dwordx4 v[28:31], v2, s[8:11], s23 offen offset:1024 sc1
  v_smfmac_f32_16x16x64_bf16 v[44:47], v[12:15], a[120:127], v3
  v_smfmac_f32_16x16x64_bf16 v[48:51], v[12:15], a[176:183], v3
  v_smfmac_f32_16x16x64_bf16 v[52:55], v[12:15], a[232:239], v3
  buffer_load_dwordx4 v[32:35], v2, s[8:11], s23 offen offset:2048 sc1
  v_smfmac_f32_16x16x64_bf16 v[56:59], v[12:15], v[152:159], v3
  v_smfmac_f32_16x16x64_bf16 v[60:63], v[12:15], v[208:215], v3
  s_waitcnt vmcnt(4)
  v_smfmac_f32_16x16x64_bf16 v[36:39], v[16:19], a[16:23], v3
  v_smfmac_f32_16x16x64_bf16 v[40:43], v[16:19], a[72:79], v3
  v_smfmac_f32_16x16x64_bf16 v[44:47], v[16:19], a[128:135], v3
  v_smfmac_f32_16x16x64_bf16 v[48:51], v[16:19], a[184:191], v3
  v_smfmac_f32_16x16x64_bf16 v[52:55], v[16:19], a[240:247], v3
  v_smfmac_f32_16x16x64_bf16 v[56:59], v[16:19], v[160:167], v3
  v_smfmac_f32_16x16x64_bf16 v[60:63], v[16:19], v[216:223], v3
  s_waitcnt vmcnt(3)
  v_smfmac_f32_16x16x64_bf16 v[36:39], v[20:23], a[24:31], v3
  v_smfmac_f32_16x16x64_bf16 v[40:43], v[20:23], a[80:87], v3
  v_smfmac_f32_16x16x64_bf16 v[44:47], v[20:23], a[136:143], v3
  v_smfmac_f32_16x16x64_bf16 v[48:51], v[20:23], a[192:199], v3
  v_smfmac_f32_16x16x64_bf16 v[52:55], v[20:23], a[248:255], v3
  v_smfmac_f32_16x16x64_bf16 v[56:59], v[20:23], v[168:175], v3
  v_smfmac_f32_16x16x64_bf16 v[60:63], v[20:23], v[224:231], v3
  s_waitcnt vmcnt(0)
cB_sc3_ph2:
  v_smfmac_f32_16x16x64_bf16 v[60:63], v[24:27], v[232:239], v3
  ds_read_b128 v[8:11], v116 offset:10240
  ds_read_b128 v[12:15], v116 offset:11264
  v_smfmac_f32_16x16x64_bf16 v[60:63], v[28:31], v[240:247], v3
  v_smfmac_f32_16x16x64_bf16 v[60:63], v[32:35], v[248:255], v3
  v_smfmac_f32_16x16x64_bf16 v[52:55], v[24:27], v[120:127], v3
  v_smfmac_f32_16x16x64_bf16 v[52:55], v[28:31], v[128:135], v3
  v_smfmac_f32_16x16x64_bf16 v[52:55], v[32:35], v[136:143], v3
  v_cvt_pk_bf16_f32 v66, v60, v61
  v_smfmac_f32_16x16x64_bf16 v[56:59], v[24:27], v[176:183], v3
  v_cvt_pk_bf16_f32 v67, v62, v63
  v_smfmac_f32_16x16x64_bf16 v[56:59], v[28:31], v[184:191], v3
  v_mfma_f32_16x16x32_bf16 v[68:71], v[64:67], v[4:7], 0
  v_smfmac_f32_16x16x64_bf16 v[56:59], v[32:35], v[192:199], v3
  v_cvt_pk_bf16_f32 v64, v52, v53
  v_smfmac_f32_16x16x64_bf16 v[36:39], v[24:27], a[32:39], v3
  v_cvt_pk_bf16_f32 v65, v54, v55
  v_smfmac_f32_16x16x64_bf16 v[36:39], v[28:31], a[40:47], v3
  v_cvt_pk_bf16_f32 v78, v68, v69
  v_smfmac_f32_16x16x64_bf16 v[36:39], v[32:35], a[48:55], v3
  v_cvt_pk_bf16_f32 v79, v70, v71
  v_cvt_pk_bf16_f32 v66, v56, v57
  v_smfmac_f32_16x16x64_bf16 v[40:43], v[24:27], a[88:95], v3
  v_cvt_pk_bf16_f32 v67, v58, v59
  v_smfmac_f32_16x16x64_bf16 v[40:43], v[28:31], a[96:103], v3
  v_mfma_f32_16x16x32_bf16 v[72:75], v[64:67], v[4:7], 0
  ds_read_b128 v[52:55], v116 offset:24576
  ds_read_b128 v[56:59], v116 offset:25600
  v_smfmac_f32_16x16x64_bf16 v[40:43], v[32:35], a[104:111], v3
  v_cvt_pk_bf16_f32 v64, v36, v37
  v_smfmac_f32_16x16x64_bf16 v[44:47], v[24:27], a[144:151], v3
  v_cvt_pk_bf16_f32 v65, v38, v39
  v_smfmac_f32_16x16x64_bf16 v[44:47], v[28:31], a[152:159], v3
  v_cvt_pk_bf16_f32 v82, v72, v73
  v_smfmac_f32_16x16x64_bf16 v[44:47], v[32:35], a[160:167], v3
  v_cvt_pk_bf16_f32 v83, v74, v75
  v_cvt_pk_bf16_f32 v66, v40, v41
  v_smfmac_f32_16x16x64_bf16 v[48:51], v[24:27], a[200:207], v3
  v_cvt_pk_bf16_f32 v67, v42, v43
  v_smfmac_f32_16x16x64_bf16 v[48:51], v[28:31], a[208:215], v3
  v_mfma_f32_16x16x32_bf16 v[68:71], v[64:67], v[4:7], 0
  ds_read_b128 v[36:39], v116 offset:6144
  ds_read_b128 v[40:43], v116 offset:7168
  v_smfmac_f32_16x16x64_bf16 v[48:51], v[32:35], a[216:223], v3
  s_waitcnt lgkmcnt(4)
  v_cvt_pk_bf16_f32 v64, v44, v45
  v_mfma_f32_16x16x32_bf16 v[84:87], v[32:35], v[76:79], 0
  v_cvt_pk_bf16_f32 v65, v46, v47
  v_smfmac_f32_16x16x64_bf16 v[88:91], v[76:79], v[96:103], v3
  ds_read_b128 v[96:99], v116 offset:20480
  ds_read_b128 v[100:103], v116 offset:21504
  v_smfmac_f32_16x16x64_bf16 v[92:95], v[76:79], v[104:111], v3
  v_cvt_pk_bf16_f32 v66, v48, v49
  v_cvt_pk_bf16_f32 v67, v50, v51
  v_mfma_f32_16x16x32_bf16 v[84:87], v[28:31], v[80:83], v[84:87]
  v_cvt_pk_bf16_f32 v60, v68, v69
  v_mfma_f32_16x16x32_bf16 v[72:75], v[64:67], v[4:7], 0
  v_cvt_pk_bf16_f32 v61, v70, v71
  s_waitcnt lgkmcnt(4)
  v_smfmac_f32_16x16x64_bf16 v[88:91], v[80:83], v[8:15], v3
  v_smfmac_f32_16x16x64_bf16 v[92:95], v[80:83], v[52:59], v3
  s_waitcnt lgkmcnt(0)
  s_nop 0
  v_cvt_pk_bf16_f32 v62, v72, v73
  v_cvt_pk_bf16_f32 v63, v74, v75
  s_nop 1
  v_mfma_f32_16x16x32_bf16 v[84:87], v[20:23], v[60:63], v[84:87]
  v_smfmac_f32_16x16x64_bf16 v[88:91], v[60:63], v[36:43], v3
  v_smfmac_f32_16x16x64_bf16 v[92:95], v[60:63], v[96:103], v3
  s_mov_b64 exec, s[26:27]
  s_nop 0
  ds_write_b128 v113, v[84:87]
  s_mov_b64 exec, -1
  s_nop 0
  v_cmp_u_f32 vcc, v88, v89
  s_nop 1
  v_permlane32_swap_b32 v88, v92
  v_permlane32_swap_b32 v89, v93
  v_permlane32_swap_b32 v90, v94
  v_permlane32_swap_b32 v91, v95
  v_add_f32 v88, v88, v92
  v_add_f32 v89, v89, v93
  v_add_f32 v90, v90, v94
  v_add_f32 v91, v91, v95
  ds_write_b128 v112, v[88:91]
  s_cbranch_vccnz cB_sc3_retry
cB_sc3_cont:
  s_waitcnt lgkmcnt(0)
  s_barrier
  ds_read_b64 v[36:37], v114 offset:0
  ds_read_b64 v[38:39], v114 offset:1024
  ds_read2_b32 v[44:45], v115 offset0:0 offset1:64
  s_waitcnt lgkmcnt(0)
  v_add_f32 v44, v44, v45
  v_add_f32 v36, v36, v38
  v_add_f32 v37, v37, v39
  v_add_f32_dpp v44, v44, v44 row_ror:8 row_mask:0xf bank_mask:0xf
  v_mov_b32 v45, v44
  v_permlane32_swap_b32 v36, v37
  v_add_f32 v36, v36, v37
  v_permlane16_swap_b32 v44, v45
  v_add_f32 v44, v44, v45
  v_max_f32 v38, v36, v44
  s_nop 1
  v_max_f32_dpp v38, v38, v38 quad_perm:[1,0,3,2] row_mask:0xf bank_mask:0xf
  s_nop 1
  v_max_f32_dpp v38, v38, v38 quad_perm:[2,3,0,1] row_mask:0xf bank_mask:0xf
  s_nop 1
  v_max_f32_dpp v38, v38, v38 row_half_mirror row_mask:0xf bank_mask:0xf
  s_nop 1
  v_max_f32_dpp v38, v38, v38 row_mirror row_mask:0xf bank_mask:0xf
  v_mov_b32 v39, v38
  s_nop 1
  v_permlane16_swap_b32 v38, v39
  v_max_f32 v38, v38, v39
  v_sub_f32 v36, v36, v38
  v_sub_f32 v44, v44, v38
  v_exp_f32 v36, v36
  v_exp_f32 v44, v44
  s_nop 0
  v_fma_f32 v39, v44, s37, v36
  v_cndmask_b32 v40, v44, v36, s[38:39]
  v_cndmask_b32 v41, v36, v44, s[38:39]
  v_add_f32_dpp v39, v39, v39 quad_perm:[1,0,3,2] row_mask:0xf bank_mask:0xf
  s_nop 0
  v_mov_b32_dpp v46, v41 quad_perm:[1,0,3,2] row_mask:0xf bank_mask:0xf
  v_add_f32_dpp v39, v39, v39 quad_perm:[2,3,0,1] row_mask:0xf bank_mask:0xf
  v_cndmask_b32 v42, v46, v40, s[38:39]
  v_cndmask_b32 v43, v40, v46, s[38:39]
  v_add_f32_dpp v39, v39, v39 row_half_mirror row_mask:0xf bank_mask:0xf
  s_nop 1
  v_add_f32_dpp v39, v39, v39 row_mirror row_mask:0xf bank_mask:0xf
  v_mov_b32 v47, v39
  s_nop 1
  v_permlane16_swap_b32 v39, v47
  v_add_f32 v39, v39, v47
  v_rcp_f32 v39, v39
  s_nop 0
  v_mul_f32 v42, v42, v39
  v_mul_f32 v43, v43, v39
  v_cvt_pk_bf16_f32 v42, v42, v43
  v_min_u32 v42, -2, v42
  s_mov_b64 exec, s[28:29]
  buffer_store_dword v42, v1, s[8:11], s20 offen sc1
  s_mov_b64 exec, -1
  s_barrier
  s_add_u32 s24, s24, 28672
  s_add_u32 s35, s35, 28672
  s_xor_b32 s25, s25, 28672
  s_add_u32 m0, s25, 21504
  s_nop 0
  buffer_load_dwordx4 v2, s[8:11], s24 offen offset:0 sc1 lds
  buffer_load_dwordx4 v2, s[8:11], s24 offen offset:1024 sc1 lds
  buffer_load_dwordx4 v2, s[8:11], s24 offen offset:2048 sc1 lds
  buffer_load_dwordx4 v2, s[8:11], s24 offen offset:3072 sc1 lds
  s_add_u32 m0, s25, 25600
  s_add_u32 s22, s24, 4096
  buffer_load_dwordx4 v2, s[8:11], s22 offen offset:0 sc1 lds
  buffer_load_dwordx4 v2, s[8:11], s22 offen offset:1024 sc1 lds
  buffer_load_dwordx4 v2, s[8:11], s22 offen offset:2048 sc1 lds
  v_xor_b32 v116, 28672, v116
  s_add_u32 s19, s19, 1
  s_mov_b32 s20, s21
  s_cmp_lt_u32 s19, 63
  s_cbranch_scc1 cB_sc3_loop
  s_branch cB_done
cB_sc3_retry:
  s_cmp_lg_u32 s62, 0
  s_cbranch_scc1 cB_sc3_cont
  s_waitcnt vmcnt(0) lgkmcnt(0)
cB_sc3_rv:
  buffer_load_dwordx4 v[8:11], v2, s[8:11], s20 offen offset:0 sc1
  buffer_load_dwordx4 v[12:15], v2, s[8:11], s20 offen offset:1024 sc1
  buffer_load_dwordx4 v[16:19], v2, s[8:11], s20 offen offset:2048 sc1
  buffer_load_dwordx4 v[20:23], v2, s[8:11], s20 offen offset:3072 sc1
  buffer_load_dwordx4 v[24:27], v2, s[8:11], s23 offen offset:0 sc1
  buffer_load_dwordx4 v[28:31], v2, s[8:11], s23 offen offset:1024 sc1
  buffer_load_dwordx4 v[32:35], v2, s[8:11], s23 offen offset:2048 sc1
  s_waitcnt vmcnt(0)
  v_max3_u32 v118, v8, v9, v10
  v_max3_u32 v118, v118, v11, v12
  v_max3_u32 v118, v118, v13, v14
  v_max3_u32 v118, v118, v15, v16
  v_max3_u32 v118, v118, v17, v18
  v_max3_u32 v118, v118, v19, v20
  v_max3_u32 v118, v118, v21, v22
  v_max3_u32 v118, v118, v23, v24
  v_max3_u32 v118, v118, v25, v26
  v_max3_u32 v118, v118, v27, v28
  v_max3_u32 v118, v118, v29, v30
  v_max3_u32 v118, v118, v31, v32
  v_max3_u32 v118, v118, v33, v34
  v_max_u32 v118, v118, v35
  v_cmp_eq_u32 vcc, -1, v118
  s_cbranch_vccz cB_sc3_rk
  s_add_u32 s30, s30, 1
  s_cmp_lt_u32 s30, 400000
  s_cbranch_scc1 cB_sc3_rv
  s_branch cB_abort
cB_sc3_rk:
  s_mov_b32 s62, 1
  v_mov_b32 v36, 0
  v_mov_b32 v37, 0
  v_mov_b32 v38, 0
  v_mov_b32 v39, 0
  v_mov_b32 v40, 0
  v_mov_b32 v41, 0
  v_mov_b32 v42, 0
  v_mov_b32 v43, 0
  v_mov_b32 v44, 0
  v_mov_b32 v45, 0
  v_mov_b32 v46, 0
  v_mov_b32 v47, 0
  v_mov_b32 v48, 0
  v_mov_b32 v49, 0
  v_mov_b32 v50, 0
  v_mov_b32 v51, 0
  v_mov_b32 v52, 0
  v_mov_b32 v53, 0
  v_mov_b32 v54, 0
  v_mov_b32 v55, 0
  v_mov_b32 v56, 0
  v_mov_b32 v57, 0
  v_mov_b32 v58, 0
  v_mov_b32 v59, 0
  v_mov_b32 v60, 0
  v_mov_b32 v61, 0
  v_mov_b32 v62, 0
  v_mov_b32 v63, 0
  v_mov_b32 v88, 0
  v_mov_b32 v89, 0
  v_mov_b32 v90, 0
  v_mov_b32 v91, 0
  v_mov_b32 v92, 0
  v_mov_b32 v93, 0
  v_mov_b32 v94, 0
  v_mov_b32 v95, 0
  v_mov_b32 v64, 0
  v_mov_b32 v65, 0
  s_add_u32 s31, s31, 1
  ds_read_b128 v[96:99], v116 offset:12288
  ds_read_b128 v[100:103], v116 offset:13312
  ds_read_b128 v[104:107], v116 offset:26624
  ds_read_b128 v[108:111], v116 offset:27648
  v_smfmac_f32_16x16x64_bf16 v[36:39], v[8:11], a[0:7], v3
  v_smfmac_f32_16x16x64_bf16 v[40:43], v[8:11], a[56:63], v3
  v_smfmac_f32_16x16x64_bf16 v[44:47], v[8:11], a[112:119], v3
  v_smfmac_f32_16x16x64_bf16 v[48:51], v[8:11], a[168:175], v3
  v_smfmac_f32_16x16x64_bf16 v[52:55], v[8:11], a[224:231], v3
  v_smfmac_f32_16x16x64_bf16 v[56:59], v[8:11], v[144:151], v3
  v_smfmac_f32_16x16x64_bf16 v[60:63], v[8:11], v[200:207], v3
  v_smfmac_f32_16x16x64_bf16 v[36:39], v[12:15], a[8:15], v3
  v_smfmac_f32_16x16x64_bf16 v[40:43], v[12:15], a[64:71], v3
  v_smfmac_f32_16x16x64_bf16 v[44:47], v[12:15], a[120:127], v3
  v_smfmac_f32_16x16x64_bf16 v[48:51], v[12:15], a[176:183], v3
  v_smfmac_f32_16x16x64_bf16 v[52:55], v[12:15], a[232:239], v3
  v_smfmac_f32_16x16x64_bf16 v[56:59], v[12:15], v[152:159], v3
  v_smfmac_f32_16x16x64_bf16 v[60:63], v[12:15], v[208:215], v3
  v_smfmac_f32_16x16x64_bf16 v[36:39], v[16:19], a[16:23], v3
  v_smfmac_f32_16x16x64_bf16 v[40:43], v[16:19], a[72:79], v3
  v_smfmac_f32_16x16x64_bf16 v[44:47], v[16:19], a[128:135], v3
  v_smfmac_f32_16x16x64_bf16 v[48:51], v[16:19], a[184:191], v3
  v_smfmac_f32_16x16x64_bf16 v[52:55], v[16:19], a[240:247], v3
  v_smfmac_f32_16x16x64_bf16 v[56:59], v[16:19], v[160:167], v3
  v_smfmac_f32_16x16x64_bf16 v[60:63], v[16:19], v[216:223], v3
  v_smfmac_f32_16x16x64_bf16 v[36:39], v[20:23], a[24:31], v3
  v_smfmac_f32_16x16x64_bf16 v[40:43], v[20:23], a[80:87], v3
  v_smfmac_f32_16x16x64_bf16 v[44:47], v[20:23], a[136:143], v3
  v_smfmac_f32_16x16x64_bf16 v[48:51], v[20:23], a[192:199], v3
  v_smfmac_f32_16x16x64_bf16 v[52:55], v[20:23], a[248:255], v3
  v_smfmac_f32_16x16x64_bf16 v[56:59], v[20:23], v[168:175], v3
  v_smfmac_f32_16x16x64_bf16 v[60:63], v[20:23], v[224:231], v3
  s_branch cB_sc3_ph2
cB_va0_loop:
  s_add_u32 s23, s20, 4096
  s_add_u32 s21, s20, 25600
  s_mov_b32 s30, 0
  s_cmp_lg_u32 s19, s38
  s_cbranch_scc1 cB_va0_vok
  s_branch cB_va0_voc
cB_va0_vow:
  buffer_load_dword v175, off, s[8:11], s35 sc1
  s_waitcnt vmcnt(0)
cB_va0_voc:
  v_readfirstlane_b32 s22, v175
  s_cmp_eq_u32 s22, 56
  s_cbranch_scc1 cB_va0_vod
  s_sleep 1
  s_add_u32 s30, s30, 1
  s_cmp_lt_u32 s30, 400000
  s_cbranch_scc1 cB_va0_vow
  s_branch cB_abort
cB_va0_vod:
  s_add_u32 s35, s35, 2048
  s_add_u32 s38, s19, 8
  s_and_b32 s38, s38, -8
  s_cmp_eq_u32 s19, 0
  s_cselect_b32 s38, 4, s38
cB_va0_vok:
  s_cmp_eq_u32 s19, 63
  s_cbranch_scc1 cB_done
  s_barrier
  s_add_u32 s22, s25, 0
  buffer_load_dwordx4 v[80:83], v6, s[8:11], s22 offen offset:0 sc1
  buffer_load_dwordx4 v[84:87], v6, s[8:11], s22 offen offset:1792 sc1
  s_add_u32 s22, s25, 3584
  buffer_load_dwordx4 v[88:91], v6, s[8:11], s22 offen offset:0 sc1
  buffer_load_dwordx4 v[92:95], v6, s[8:11], s22 offen offset:1792 sc1
  s_add_u32 s22, s25, 7168
  buffer_load_dwordx4 v[96:99], v6, s[8:11], s22 offen offset:0 sc1
  buffer_load_dwordx4 v[100:103], v6, s[8:11], s22 offen offset:1792 sc1
  s_add_u32 s22, s25, 10752
  buffer_load_dwordx4 v[104:107], v6, s[8:11], s22 offen offset:0 sc1
  buffer_load_dwordx4 v[108:111], v6, s[8:11], s22 offen offset:1792 sc1
  s_add_u32 s22, s25, 14336
  buffer_load_dwordx4 v[112:115], v6, s[8:11], s22 offen offset:0 sc1
  buffer_load_dwordx4 v[116:119], v6, s[8:11], s22 offen offset:1792 sc1
  s_add_u32 s22, s25, 17920
  buffer_load_dwordx4 v[120:123], v6, s[8:11], s22 offen offset:0 sc1
  buffer_load_dwordx4 v[124:127], v6, s[8:11], s22 offen offset:1792 sc1
  s_add_u32 s22, s25, 21504
  buffer_load_dwordx4 v[128:131], v6, s[8:11], s22 offen offset:0 sc1
  buffer_load_dwordx4 v[132:135], v6, s[8:11], s22 offen offset:1792 sc1
  s_add_u32 s22, s25, 25088
  buffer_load_dwordx4 v[136:139], v6, s[8:11], s22 offen offset:0 sc1
  buffer_load_dwordx4 v[140:143], v6, s[8:11], s22 offen offset:1792 sc1
  buffer_load_dword v175, off, s[8:11], s35 sc1
  s_barrier
  ds_read_b128 v[8:11], v2 offset:8192
  ds_read_b128 v[12:15], v2 offset:9216
  ds_read_b128 v[16:19], v2 offset:10240
  ds_read_b128 v[20:23], v2 offset:11264
  ds_read_b128 v[24:27], v2 offset:12288
  ds_read_b128 v[28:31], v2 offset:13312
  ds_read_b128 v[32:35], v2 offset:14336
  s_waitcnt lgkmcnt(0)
  v_smfmac_f32_16x16x64_bf16 v[36:39], v[8:11], a[0:7], v3
  v_smfmac_f32_16x16x64_bf16 v[36:39], v[12:15], a[8:15], v3
  v_smfmac_f32_16x16x64_bf16 v[36:39], v[16:19], a[16:23], v3
  v_smfmac_f32_16x16x64_bf16 v[36:39], v[20:23], a[24:31], v3
  v_smfmac_f32_16x16x64_bf16 v[36:39], v[24:27], a[32:39], v3
  v_smfmac_f32_16x16x64_bf16 v[36:39], v[28:31], a[40:47], v3
  v_smfmac_f32_16x16x64_bf16 v[36:39], v[32:35], a[48:55], v3
  v_smfmac_f32_16x16x64_bf16 v[40:43], v[8:11], a[56:63], v3
  v_smfmac_f32_16x16x64_bf16 v[40:43], v[12:15], a[64:71], v3
  v_smfmac_f32_16x16x64_bf16 v[40:43], v[16:19], a[72:79], v3
  v_smfmac_f32_16x16x64_bf16 v[40:43], v[20:23], a[80:87], v3
  v_smfmac_f32_16x16x64_bf16 v[40:43], v[24:27], a[88:95], v3
  v_smfmac_f32_16x16x64_bf16 v[40:43], v[28:31], a[96:103], v3
  v_smfmac_f32_16x16x64_bf16 v[40:43], v[32:35], a[104:111], v3
  v_smfmac_f32_16x16x64_bf16 v[44:47], v[8:11], a[112:119], v3
  v_smfmac_f32_16x16x64_bf16 v[44:47], v[12:15], a[120:127], v3
  v_smfmac_f32_16x16x64_bf16 v[44:47], v[16:19], a[128:135], v3
  v_smfmac_f32_16x16x64_bf16 v[44:47], v[20:23], a[136:143], v3
  v_permlane32_swap_b32 v36, v40
  v_smfmac_f32_16x16x64_bf16 v[44:47], v[24:27], a[144:151], v3
  v_permlane32_swap_b32 v37, v41
  v_smfmac_f32_16x16x64_bf16 v[44:47], v[28:31], a[152:159], v3
  v_permlane32_swap_b32 v38, v42
  v_smfmac_f32_16x16x64_bf16 v[44:47], v[32:35], a[160:167], v3
  v_permlane32_swap_b32 v39, v43
  v_smfmac_f32_16x16x64_bf16 v[48:51], v[8:11], a[168:175], v3
  v_add_f32 v36, v36, v40
  v_smfmac_f32_16x16x64_bf16 v[48:51], v[12:15], a[176:183], v3
  v_add_f32 v37, v37, v41
  v_smfmac_f32_16x16x64_bf16 v[48:51], v[16:19], a[184:191], v3
  v_add_f32 v38, v38, v42
  v_smfmac_f32_16x16x64_bf16 v[48:51], v[20:23], a[192:199], v3
  v_add_f32 v39, v39, v43
  v_smfmac_f32_16x16x64_bf16 v[48:51], v[24:27], a[200:207], v3
  v_cvt_pk_bf16_f32 v40, v36, v37
  v_smfmac_f32_16x16x64_bf16 v[48:51], v[28:31], a[208:215], v3
  v_cvt_pk_bf16_f32 v41, v38, v39
  v_smfmac_f32_16x16x64_bf16 v[48:51], v[32:35], a[216:223], v3
  ds_write_b64 v60, v[40:41]
  v_smfmac_f32_16x16x64_bf16 v[52:55], v[8:11], a[224:231], v3
  v_smfmac_f32_16x16x64_bf16 v[52:55], v[12:15], a[232:239], v3
  v_smfmac_f32_16x16x64_bf16 v[52:55], v[16:19], a[240:247], v3
  v_smfmac_f32_16x16x64_bf16 v[52:55], v[20:23], a[248:255], v3
  v_permlane32_swap_b32 v44, v48
  v_smfmac_f32_16x16x64_bf16 v[52:55], v[24:27], v[176:183], v3
  v_permlane32_swap_b32 v45, v49
  v_smfmac_f32_16x16x64_bf16 v[52:55], v[28:31], v[184:191], v3
  v_permlane32_swap_b32 v46, v50
  v_smfmac_f32_16x16x64_bf16 v[52:55], v[32:35], v[192:199], v3
  v_permlane32_swap_b32 v47, v51
  v_smfmac_f32_16x16x64_bf16 v[56:59], v[8:11], v[200:207], v3
  v_add_f32 v44, v44, v48
  v_smfmac_f32_16x16x64_bf16 v[56:59], v[12:15], v[208:215], v3
  v_add_f32 v45, v45, v49
  v_smfmac_f32_16x16x64_bf16 v[56:59], v[16:19], v[216:223], v3
  v_add_f32 v46, v46, v50
  v_smfmac_f32_16x16x64_bf16 v[56:59], v[20:23], v[224:231], v3
  v_add_f32 v47, v47, v51
  v_smfmac_f32_16x16x64_bf16 v[56:59], v[24:27], v[232:239], v3
  v_cvt_pk_bf16_f32 v48, v44, v45
  v_smfmac_f32_16x16x64_bf16 v[56:59], v[28:31], v[240:247], v3
  v_cvt_pk_bf16_f32 v49, v46, v47
  v_smfmac_f32_16x16x64_bf16 v[56:59], v[32:35], v[248:255], v3
  ds_write_b64 v61, v[48:49]
  s_nop 6
  v_permlane32_swap_b32 v52, v56
  v_permlane32_swap_b32 v53, v57
  v_permlane32_swap_b32 v54, v58
  v_permlane32_swap_b32 v55, v59
  v_add_f32 v52, v52, v56
  v_add_f32 v53, v53, v57
  v_add_f32 v54, v54, v58
  v_add_f32 v55, v55, v59
  v_cvt_pk_bf16_f32 v56, v52, v53
  v_cvt_pk_bf16_f32 v57, v54, v55
  ds_write_b64 v62, v[56:57]
  s_cmp_eq_u32 s19, 63
  s_cbranch_scc1 cB_va0_last
  s_add_u32 s22, s20, 9216
  s_add_u32 s34, s20, 13312
  s_add_u32 s36, s20, 7168
  s_mov_b32 s37, 0
  buffer_load_dword v164, v4, s[8:11], s20 offen sc1
  s_nop 7
  buffer_load_dword v165, v4, s[8:11], s20 offen sc1
  s_nop 7
  buffer_load_dword v166, v4, s[8:11], s20 offen sc1
  s_nop 7
  buffer_load_dword v167, v4, s[8:11], s20 offen sc1
  s_nop 7
  buffer_load_dword v168, v4, s[8:11], s20 offen sc1
cB_va0_fw_l:
  s_waitcnt vmcnt(4)
  v_cmp_eq_u32 vcc, -1, v164
  s_cbranch_vccz cB_va0_fw_d
  buffer_load_dword v164, v4, s[8:11], s20 offen sc1
  s_waitcnt vmcnt(4)
  v_cmp_eq_u32 vcc, -1, v165
  s_cbranch_vccz cB_va0_fw_d
  buffer_load_dword v165, v4, s[8:11], s20 offen sc1
  s_waitcnt vmcnt(4)
  v_cmp_eq_u32 vcc, -1, v166
  s_cbranch_vccz cB_va0_fw_d
  buffer_load_dword v166, v4, s[8:11], s20 offen sc1
  s_waitcnt vmcnt(4)
  v_cmp_eq_u32 vcc, -1, v167
  s_cbranch_vccz cB_va0_fw_d
  buffer_load_dword v167, v4, s[8:11], s20 offen sc1
  s_waitcnt vmcnt(4)
  v_cmp_eq_u32 vcc, -1, v168
  s_cbranch_vccz cB_va0_fw_d
  buffer_load_dword v168, v4, s[8:11], s20 offen sc1
  s_add_u32 s30, s30, 1
  s_cmp_lt_u32 s30, 400000
  s_cbranch_scc1 cB_va0_fw_l
  s_branch cB_abort
cB_va0_fw_d:
  s_waitcnt lgkmcnt(0)
  buffer_load_dwordx4 v[8:11], v2, s[8:11], s22 offen offset:0 sc1
  v_mov_b32 v36, 0
  v_mov_b32 v37, 0
  v_mov_b32 v38, 0
  buffer_load_dwordx4 v[12:15], v2, s[8:11], s22 offen offset:1024 sc1
  v_mov_b32 v39, 0
  v_mov_b32 v40, 0
  v_mov_b32 v41, 0
  buffer_load_dwordx4 v[16:19], v2, s[8:11], s22 offen offset:2048 sc1
  v_mov_b32 v42, 0
  v_mov_b32 v43, 0
  v_mov_b32 v44, 0
  buffer_load_dwordx4 v[20:23], v2, s[8:11], s22 offen offset:3072 sc1
  v_mov_b32 v45, 0
  v_mov_b32 v46, 0
  v_mov_b32 v47, 0
  buffer_load_dwordx4 v[24:27], v2, s[8:11], s34 offen offset:0 sc1
  v_mov_b32 v48, 0
  v_mov_b32 v49, 0
  v_mov_b32 v50, 0
  buffer_load_dwordx4 v[28:31], v2, s[8:11], s34 offen offset:1024 sc1
  v_mov_b32 v51, 0
  v_mov_b32 v52, 0
  v_mov_b32 v53, 0
  buffer_load_dwordx4 v[32:35], v2, s[8:11], s34 offen offset:2048 sc1
  v_mov_b32 v54, 0
  v_mov_b32 v55, 0
  v_mov_b32 v56, 0
  buffer_load_dwordx4 v[144:147], v2, s[8:11], s34 offen offset:3072 sc1
  v_mov_b32 v57, 0
  v_mov_b32 v58, 0
  v_mov_b32 v59, 0
  buffer_load_dwordx4 v[148:151], v2, s[8:11], s36 offen offset:0 sc1
  buffer_load_dwordx4 v[152:155], v2, s[8:11], s36 offen offset:1024 sc1
  s_barrier
  ds_read_b128 v[64:67], v2 offset:0
  ds_read_b128 v[68:71], v2 offset:1024
  ds_read_b128 v[72:75], v2 offset:2048
  ds_read_b128 v[76:79], v2 offset:3072
  s_waitcnt vmcnt(9)
  v_smfmac_f32_16x16x64_bf16 v[156:159], v[8:11], v[80:87], v3
  s_waitcnt vmcnt(8)
  v_smfmac_f32_16x16x64_bf16 v[156:159], v[12:15], v[88:95], v3
  s_waitcnt vmcnt(7)
  v_smfmac_f32_16x16x64_bf16 v[156:159], v[16:19], v[96:103], v3
  s_waitcnt vmcnt(6)
  v_smfmac_f32_16x16x64_bf16 v[156:159], v[20:23], v[104:111], v3
  s_waitcnt vmcnt(5)
  v_smfmac_f32_16x16x64_bf16 v[156:159], v[24:27], v[112:119], v3
  s_mov_b32 exec_hi, 0
  buffer_store_dword v2, v7, s[8:11], s21 offen sc1
  s_mov_b64 exec, -1
  s_waitcnt vmcnt(5)
  v_smfmac_f32_16x16x64_bf16 v[156:159], v[28:31], v[120:127], v3
  s_waitcnt vmcnt(4)
  v_smfmac_f32_16x16x64_bf16 v[156:159], v[32:35], v[128:135], v3
  s_waitcnt vmcnt(3)
  v_smfmac_f32_16x16x64_bf16 v[156:159], v[144:147], v[136:143], v3
  s_waitcnt vmcnt(2) lgkmcnt(0)
  v_smfmac_f32_16x16x64_bf16 v[156:159], v[148:151], v[64:71], v3
  s_waitcnt vmcnt(1)
  v_smfmac_f32_16x16x64_bf16 v[156:159], v[152:155], v[72:79], v3
cB_va0_ep:
  s_nop 7
  v_permlane32_swap_b32 v156, v158
  v_permlane32_swap_b32 v157, v159
  v_add_f32 v160, v156, v158
  v_add_f32 v161, v157, v159
  v_mov_b32 v156, 0
  v_mov_b32_dpp v162, v160 row_ror:8 row_mask:0xf bank_mask:0xf
  v_cmp_u_f32 vcc, v160, v161
  v_mov_b32_dpp v160, v161 row_ror:8 row_mask:0xf bank_mask:0xc
  v_mov_b32 v157, 0
  v_mov_b32_dpp v161, v162 quad_perm:[0,1,2,3] row_mask:0xf bank_mask:0x3
  v_mov_b32 v158, 0
  v_cvt_pk_bf16_f32 v160, v160, v161
  v_mov_b32 v159, 0
  v_min_u32 v160, -2, v160
  s_cbranch_vccnz cB_va0_rp
cB_va0_pc:
  buffer_store_dword v160, v1, s[8:11], s21 offen sc1
  s_cmp_lg_u32 s19, 62
  s_cbranch_scc1 cB_va0_nl
  s_mov_b32 s22, 88519680
  buffer_store_dword v160, v1, s[8:11], s22 offen sc1
  s_mov_b64 exec, -1
  s_branch cB_done
cB_va0_nl:
  s_mov_b64 exec, -1
  s_add_u32 s25, s25, 28672
  s_add_u32 s19, s19, 1
  s_mov_b32 s20, s21
  s_branch cB_va0_loop
cB_va0_last:
  s_waitcnt lgkmcnt(0)
  s_barrier
  s_branch cB_done
cB_va0_rp:
  s_cmp_lg_u32 s37, 0
  s_cbranch_scc1 cB_va0_pc
cB_va0_rv:
  buffer_load_dwordx4 v[8:11], v2, s[8:11], s22 offen offset:0 sc1
  buffer_load_dwordx4 v[12:15], v2, s[8:11], s22 offen offset:1024 sc1
  buffer_load_dwordx4 v[16:19], v2, s[8:11], s22 offen offset:2048 sc1
  buffer_load_dwordx4 v[20:23], v2, s[8:11], s22 offen offset:3072 sc1
  buffer_load_dwordx4 v[24:27], v2, s[8:11], s34 offen offset:0 sc1
  buffer_load_dwordx4 v[28:31], v2, s[8:11], s34 offen offset:1024 sc1
  buffer_load_dwordx4 v[32:35], v2, s[8:11], s34 offen offset:2048 sc1
  buffer_load_dwordx4 v[144:147], v2, s[8:11], s34 offen offset:3072 sc1
  buffer_load_dwordx4 v[148:151], v2, s[8:11], s36 offen offset:0 sc1
  buffer_load_dwordx4 v[152:155], v2, s[8:11], s36 offen offset:1024 sc1
  s_waitcnt vmcnt(0)
  v_max3_u32 v63, v8, v9, v10
  v_max3_u32 v63, v63, v11, v12
  v_max3_u32 v63, v63, v13, v14
  v_max3_u32 v63, v63, v15, v16
  v_max3_u32 v63, v63, v17, v18
  v_max3_u32 v63, v63, v19, v20
  v_max3_u32 v63, v63, v21, v22
  v_max3_u32 v63, v63, v23, v24
  v_max3_u32 v63, v63, v25, v26
  v_max3_u32 v63, v63, v27, v28
  v_max3_u32 v63, v63, v29, v30
  v_max3_u32 v63, v63, v31, v32
  v_max3_u32 v63, v63, v33, v34
  v_max3_u32 v63, v63, v35, v144
  v_max3_u32 v63, v63, v145, v146
  v_max3_u32 v63, v63, v147, v148
  v_max3_u32 v63, v63, v149, v150
  v_max3_u32 v63, v63, v151, v152
  v_max3_u32 v63, v63, v153, v154
  v_max_u32 v63, v63, v155
  v_cmp_eq_u32 vcc, -1, v63
  s_cbranch_vccz cB_va0_rk
  s_add_u32 s30, s30, 1
  s_cmp_lt_u32 s30, 400000
  s_cbranch_scc1 cB_va0_rv
  s_branch cB_abort
cB_va0_rk:
  s_mov_b32 s37, 1
  s_add_u32 s31, s31, 0x10000
  v_smfmac_f32_16x16x64_bf16 v[156:159], v[8:11], v[80:87], v3
  v_smfmac_f32_16x16x64_bf16 v[156:159], v[12:15], v[88:95], v3
  v_smfmac_f32_16x16x64_bf16 v[156:159], v[16:19], v[96:103], v3
  v_smfmac_f32_16x16x64_bf16 v[156:159], v[20:23], v[104:111], v3
  v_smfmac_f32_16x16x64_bf16 v[156:159], v[24:27], v[112:119], v3
  v_smfmac_f32_16x16x64_bf16 v[156:159], v[28:31], v[120:127], v3
  v_smfmac_f32_16x16x64_bf16 v[156:159], v[32:35], v[128:135], v3
  v_smfmac_f32_16x16x64_bf16 v[156:159], v[144:147], v[136:143], v3
  v_smfmac_f32_16x16x64_bf16 v[156:159], v[148:151], v[64:71], v3
  v_smfmac_f32_16x16x64_bf16 v[156:159], v[152:155], v[72:79], v3
  s_nop 7
  s_branch cB_va0_ep
cB_va1_loop:
  s_add_u32 s23, s20, 4096
  s_add_u32 s21, s20, 25600
  s_mov_b32 s30, 0
  s_cmp_lg_u32 s19, s38
  s_cbranch_scc1 cB_va1_vok
  s_branch cB_va1_voc
cB_va1_vow:
  buffer_load_dword v175, off, s[8:11], s35 sc1
  s_waitcnt vmcnt(0)
cB_va1_voc:
  v_readfirstlane_b32 s22, v175
  s_cmp_eq_u32 s22, 56
  s_cbranch_scc1 cB_va1_vod
  s_sleep 1
  s_add_u32 s30, s30, 1
  s_cmp_lt_u32 s30, 400000
  s_cbranch_scc1 cB_va1_vow
  s_branch cB_abort
cB_va1_vod:
  s_add_u32 s35, s35, 2048
  s_add_u32 s38, s19, 8
  s_and_b32 s38, s38, -8
  s_cmp_eq_u32 s19, 0
  s_cselect_b32 s38, 4, s38
cB_va1_vok:
  s_cmp_eq_u32 s19, 63
  s_cbranch_scc1 cB_done
  s_barrier
  s_add_u32 s22, s25, 0
  buffer_load_dwordx4 v[80:83], v6, s[8:11], s22 offen offset:0 sc1
  buffer_load_dwordx4 v[84:87], v6, s[8:11], s22 offen offset:1792 sc1
  s_add_u32 s22, s25, 3584
  buffer_load_dwordx4 v[88:91], v6, s[8:11], s22 offen offset:0 sc1
  buffer_load_dwordx4 v[92:95], v6, s[8:11], s22 offen offset:1792 sc1
  s_add_u32 s22, s25, 7168
  buffer_load_dwordx4 v[96:99], v6, s[8:11], s22 offen offset:0 sc1
  buffer_load_dwordx4 v[100:103], v6, s[8:11], s22 offen offset:1792 sc1
  s_add_u32 s22, s25, 10752
  buffer_load_dwordx4 v[104:107], v6, s[8:11], s22 offen offset:0 sc1
  buffer_load_dwordx4 v[108:111], v6, s[8:11], s22 offen offset:1792 sc1
  s_add_u32 s22, s25, 14336
  buffer_load_dwordx4 v[112:115], v6, s[8:11], s22 offen offset:0 sc1
  buffer_load_dwordx4 v[116:119], v6, s[8:11], s22 offen offset:1792 sc1
  s_add_u32 s22, s25, 17920
  buffer_load_dwordx4 v[120:123], v6, s[8:11], s22 offen offset:0 sc1
  buffer_load_dwordx4 v[124:127], v6, s[8:11], s22 offen offset:1792 sc1
  s_add_u32 s22, s25, 21504
  buffer_load_dwordx4 v[128:131], v6, s[8:11], s22 offen offset:0 sc1
  buffer_load_dwordx4 v[132:135], v6, s[8:11], s22 offen offset:1792 sc1
  s_add_u32 s22, s25, 25088
  buffer_load_dwordx4 v[136:139], v6, s[8:11], s22 offen offset:0 sc1
  buffer_load_dwordx4 v[140:143], v6, s[8:11], s22 offen offset:1792 sc1
  buffer_load_dword v175, off, s[8:11], s35 sc1
  s_barrier
  ds_read_b128 v[8:11], v2 offset:8192
  ds_read_b128 v[12:15], v2 offset:9216
  ds_read_b128 v[16:19], v2 offset:10240
  ds_read_b128 v[20:23], v2 offset:11264
  ds_read_b128 v[24:27], v2 offset:12288
  ds_read_b128 v[28:31], v2 offset:13312
  ds_read_b128 v[32:35], v2 offset:14336
  s_waitcnt lgkmcnt(0)
  v_smfmac_f32_16x16x64_bf16 v[36:39], v[8:11], a[0:7], v3
  v_smfmac_f32_16x16x64_bf16 v[36:39], v[12:15], a[8:15], v3
  v_smfmac_f32_16x16x64_bf16 v[36:39], v[16:19], a[16:23], v3
  v_smfmac_f32_16x16x64_bf16 v[36:39], v[20:23], a[24:31], v3
  v_smfmac_f32_16x16x64_bf16 v[36:39], v[24:27], a[32:39], v3
  v_smfmac_f32_16x16x64_bf16 v[36:39], v[28:31], a[40:47], v3
  v_smfmac_f32_16x16x64_bf16 v[36:39], v[32:35], a[48:55], v3
  v_smfmac_f32_16x16x64_bf16 v[40:43], v[8:11], a[56:63], v3
  v_smfmac_f32_16x16x64_bf16 v[40:43], v[12:15], a[64:71], v3
  v_smfmac_f32_16x16x64_bf16 v[40:43], v[16:19], a[72:79], v3
  v_smfmac_f32_16x16x64_bf16 v[40:43], v[20:23], a[80:87], v3
  v_smfmac_f32_16x16x64_bf16 v[40:43], v[24:27], a[88:95], v3
  v_smfmac_f32_16x16x64_bf16 v[40:43], v[28:31], a[96:103], v3
  v_smfmac_f32_16x16x64_bf16 v[40:43], v[32:35], a[104:111], v3
  v_smfmac_f32_16x16x64_bf16 v[44:47], v[8:11], a[112:119], v3
  v_smfmac_f32_16x16x64_bf16 v[44:47], v[12:15], a[120:127], v3
  v_smfmac_f32_16x16x64_bf16 v[44:47], v[16:19], a[128:135], v3
  v_smfmac_f32_16x16x64_bf16 v[44:47], v[20:23], a[136:143], v3
  v_permlane32_swap_b32 v36, v40
  v_smfmac_f32_16x16x64_bf16 v[44:47], v[24:27], a[144:151], v3
  v_permlane32_swap_b32 v37, v41
  v_smfmac_f32_16x16x64_bf16 v[44:47], v[28:31], a[152:159], v3
  v_permlane32_swap_b32 v38, v42
  v_smfmac_f32_16x16x64_bf16 v[44:47], v[32:35], a[160:167], v3
  v_permlane32_swap_b32 v39, v43
  v_smfmac_f32_16x16x64_bf16 v[48:51], v[8:11], a[168:175], v3
  v_add_f32 v36, v36, v40
  v_smfmac_f32_16x16x64_bf16 v[48:51], v[12:15], a[176:183], v3
  v_add_f32 v37, v37, v41
  v_smfmac_f32_16x16x64_bf16 v[48:51], v[16:19], a[184:191], v3
  v_add_f32 v38, v38, v42
  v_smfmac_f32_16x16x64_bf16 v[48:51], v[20:23], a[192:199], v3
  v_add_f32 v39, v39, v43
  v_smfmac_f32_16x16x64_bf16 v[48:51], v[24:27], a[200:207], v3
  v_cvt_pk_bf16_f32 v40, v36, v37
  v_smfmac_f32_16x16x64_bf16 v[48:51], v[28:31], a[208:215], v3
  v_cvt_pk_bf16_f32 v41, v38, v39
  v_smfmac_f32_16x16x64_bf16 v[48:51], v[32:35], a[216:223], v3
  ds_write_b64 v60, v[40:41]
  v_smfmac_f32_16x16x64_bf16 v[52:55], v[8:11], a[224:231], v3
  v_smfmac_f32_16x16x64_bf16 v[52:55], v[12:15], a[232:239], v3
  v_smfmac_f32_16x16x64_bf16 v[52:55], v[16:19], a[240:247], v3
  v_smfmac_f32_16x16x64_bf16 v[52:55], v[20:23], a[248:255], v3
  v_permlane32_swap_b32 v44, v48
  v_smfmac_f32_16x16x64_bf16 v[52:55], v[24:27], v[176:183], v3
  v_permlane32_swap_b32 v45, v49
  v_smfmac_f32_16x16x64_bf16 v[52:55], v[28:31], v[184:191], v3
  v_permlane32_swap_b32 v46, v50
  v_smfmac_f32_16x16x64_bf16 v[52:55], v[32:35], v[192:199], v3
  v_permlane32_swap_b32 v47, v51
  v_smfmac_f32_16x16x64_bf16 v[56:59], v[8:11], v[200:207], v3
  v_add_f32 v44, v44, v48
  v_smfmac_f32_16x16x64_bf16 v[56:59], v[12:15], v[208:215], v3
  v_add_f32 v45, v45, v49
  v_smfmac_f32_16x16x64_bf16 v[56:59], v[16:19], v[216:223], v3
  v_add_f32 v46, v46, v50
  v_smfmac_f32_16x16x64_bf16 v[56:59], v[20:23], v[224:231], v3
  v_add_f32 v47, v47, v51
  v_smfmac_f32_16x16x64_bf16 v[56:59], v[24:27], v[232:239], v3
  v_cvt_pk_bf16_f32 v48, v44, v45
  v_smfmac_f32_16x16x64_bf16 v[56:59], v[28:31], v[240:247], v3
  v_cvt_pk_bf16_f32 v49, v46, v47
  v_smfmac_f32_16x16x64_bf16 v[56:59], v[32:35], v[248:255], v3
  ds_write_b64 v61, v[48:49]
  s_nop 6
  v_permlane32_swap_b32 v52, v56
  v_permlane32_swap_b32 v53, v57
  v_permlane32_swap_b32 v54, v58
  v_permlane32_swap_b32 v55, v59
  v_add_f32 v52, v52, v56
  v_add_f32 v53, v53, v57
  v_add_f32 v54, v54, v58
  v_add_f32 v55, v55, v59
  v_cvt_pk_bf16_f32 v56, v52, v53
  v_cvt_pk_bf16_f32 v57, v54, v55
  ds_write_b64 v62, v[56:57]
  s_cmp_eq_u32 s19, 63
  s_cbranch_scc1 cB_va1_last
  s_add_u32 s22, s20, 9216
  s_add_u32 s34, s20, 13312
  s_add_u32 s36, s20, 7168
  s_mov_b32 s37, 0
  buffer_load_dword v164, v4, s[8:11], s20 offen sc1
  s_nop 7
  buffer_load_dword v165, v4, s[8:11], s20 offen sc1
  s_nop 7
  buffer_load_dword v166, v4, s[8:11], s20 offen sc1
  s_nop 7
  buffer_load_dword v167, v4, s[8:11], s20 offen sc1
  s_nop 7
  buffer_load_dword v168, v4, s[8:11], s20 offen sc1
cB_va1_fw_l:
  s_waitcnt vmcnt(4)
  v_cmp_eq_u32 vcc, -1, v164
  s_cbranch_vccz cB_va1_fw_d
  buffer_load_dword v164, v4, s[8:11], s20 offen sc1
  s_waitcnt vmcnt(4)
  v_cmp_eq_u32 vcc, -1, v165
  s_cbranch_vccz cB_va1_fw_d
  buffer_load_dword v165, v4, s[8:11], s20 offen sc1
  s_waitcnt vmcnt(4)
  v_cmp_eq_u32 vcc, -1, v166
  s_cbranch_vccz cB_va1_fw_d
  buffer_load_dword v166, v4, s[8:11], s20 offen sc1
  s_waitcnt vmcnt(4)
  v_cmp_eq_u32 vcc, -1, v167
  s_cbranch_vccz cB_va1_fw_d
  buffer_load_dword v167, v4, s[8:11], s20 offen sc1
  s_waitcnt vmcnt(4)
  v_cmp_eq_u32 vcc, -1, v168
  s_cbranch_vccz cB_va1_fw_d
  buffer_load_dword v168, v4, s[8:11], s20 offen sc1
  s_add_u32 s30, s30, 1
  s_cmp_lt_u32 s30, 400000
  s_cbranch_scc1 cB_va1_fw_l
  s_branch cB_abort
cB_va1_fw_d:
  s_waitcnt lgkmcnt(0)
  buffer_load_dwordx4 v[8:11], v2, s[8:11], s22 offen offset:0 sc1
  v_mov_b32 v36, 0
  v_mov_b32 v37, 0
  v_mov_b32 v38, 0
  buffer_load_dwordx4 v[12:15], v2, s[8:11], s22 offen offset:1024 sc1
  v_mov_b32 v39, 0
  v_mov_b32 v40, 0
  v_mov_b32 v41, 0
  buffer_load_dwordx4 v[16:19], v2, s[8:11], s22 offen offset:2048 sc1
  v_mov_b32 v42, 0
  v_mov_b32 v43, 0
  v_mov_b32 v44, 0
  buffer_load_dwordx4 v[20:23], v2, s[8:11], s22 offen offset:3072 sc1
  v_mov_b32 v45, 0
  v_mov_b32 v46, 0
  v_mov_b32 v47, 0
  buffer_load_dwordx4 v[24:27], v2, s[8:11], s34 offen offset:0 sc1
  v_mov_b32 v48, 0
  v_mov_b32 v49, 0
  v_mov_b32 v50, 0
  buffer_load_dwordx4 v[28:31], v2, s[8:11], s34 offen offset:1024 sc1
  v_mov_b32 v51, 0
  v_mov_b32 v52, 0
  v_mov_b32 v53, 0
  buffer_load_dwordx4 v[32:35], v2, s[8:11], s34 offen offset:2048 sc1
  v_mov_b32 v54, 0
  v_mov_b32 v55, 0
  v_mov_b32 v56, 0
  buffer_load_dwordx4 v[144:147], v2, s[8:11], s34 offen offset:3072 sc1
  v_mov_b32 v57, 0
  v_mov_b32 v58, 0
  v_mov_b32 v59, 0
  buffer_load_dwordx4 v[148:151], v2, s[8:11], s36 offen offset:0 sc1
  buffer_load_dwordx4 v[152:155], v2, s[8:11], s36 offen offset:1024 sc1
  s_barrier
  ds_read_b128 v[64:67], v2 offset:4096
  ds_read_b128 v[68:71], v2 offset:5120
  ds_read_b128 v[72:75], v2 offset:6144
  ds_read_b128 v[76:79], v2 offset:7168
  s_waitcnt vmcnt(9)
  v_smfmac_f32_16x16x64_bf16 v[156:159], v[8:11], v[80:87], v3
  s_waitcnt vmcnt(8)
  v_smfmac_f32_16x16x64_bf16 v[156:159], v[12:15], v[88:95], v3
  s_waitcnt vmcnt(7)
  v_smfmac_f32_16x16x64_bf16 v[156:159], v[16:19], v[96:103], v3
  s_waitcnt vmcnt(6)
  v_smfmac_f32_16x16x64_bf16 v[156:159], v[20:23], v[104:111], v3
  s_waitcnt vmcnt(5)
  v_smfmac_f32_16x16x64_bf16 v[156:159], v[24:27], v[112:119], v3
  s_mov_b32 exec_hi, 0
  buffer_store_dword v2, v7, s[8:11], s21 offen sc1
  s_mov_b64 exec, -1
  s_waitcnt vmcnt(5)
  v_smfmac_f32_16x16x64_bf16 v[156:159], v[28:31], v[120:127], v3
  s_waitcnt vmcnt(4)
  v_smfmac_f32_16x16x64_bf16 v[156:159], v[32:35], v[128:135], v3
  s_waitcnt vmcnt(3)
  v_smfmac_f32_16x16x64_bf16 v[156:159], v[144:147], v[136:143], v3
  s_waitcnt vmcnt(2) lgkmcnt(0)
  v_smfmac_f32_16x16x64_bf16 v[156:159], v[148:151], v[64:71], v3
  s_waitcnt vmcnt(1)
  v_smfmac_f32_16x16x64_bf16 v[156:159], v[152:155], v[72:79], v3
cB_va1_ep:
  s_nop 7
  v_permlane32_swap_b32 v156, v158
  v_permlane32_swap_b32 v157, v159
  v_add_f32 v160, v156, v158
  v_add_f32 v161, v157, v159
  v_mov_b32 v156, 0
  v_mov_b32_dpp v162, v160 row_ror:8 row_mask:0xf bank_mask:0xf
  v_cmp_u_f32 vcc, v160, v161
  v_mov_b32_dpp v160, v161 row_ror:8 row_mask:0xf bank_mask:0xc
  v_mov_b32 v157, 0
  v_mov_b32_dpp v161, v162 quad_perm:[0,1,2,3] row_mask:0xf bank_mask:0x3
  v_mov_b32 v158, 0
  v_cvt_pk_bf16_f32 v160, v160, v161
  v_mov_b32 v159, 0
  v_min_u32 v160, -2, v160
  s_cbranch_vccnz cB_va1_rp
cB_va1_pc:
  s_mov_b64 exec, s[26:27]
  buffer_store_dword v160, v1, s[8:11], s21 offen sc1
  s_cmp_lg_u32 s19, 62
  s_cbranch_scc1 cB_va1_nl
  s_mov_b32 s22, 88519680
  buffer_store_dword v160, v1, s[8:11], s22 offen sc1
  s_mov_b64 exec, -1
  s_branch cB_done
cB_va1_nl:
  s_mov_b64 exec, -1
  s_add_u32 s25, s25, 28672
  s_add_u32 s19, s19, 1
  s_mov_b32 s20, s21
  s_branch cB_va1_loop
cB_va1_last:
  s_waitcnt lgkmcnt(0)
  s_barrier
  s_branch cB_done
cB_va1_rp:
  s_cmp_lg_u32 s37, 0
  s_cbranch_scc1 cB_va1_pc
cB_va1_rv:
  buffer_load_dwordx4 v[8:11], v2, s[8:11], s22 offen offset:0 sc1
  buffer_load_dwordx4 v[12:15], v2, s[8:11], s22 offen offset:1024 sc1
  buffer_load_dwordx4 v[16:19], v2, s[8:11], s22 offen offset:2048 sc1
  buffer_load_dwordx4 v[20:23], v2, s[8:11], s22 offen offset:3072 sc1
  buffer_load_dwordx4 v[24:27], v2, s[8:11], s34 offen offset:0 sc1
  buffer_load_dwordx4 v[28:31], v2, s[8:11], s34 offen offset:1024 sc1
  buffer_load_dwordx4 v[32:35], v2, s[8:11], s34 offen offset:2048 sc1
  buffer_load_dwordx4 v[144:147], v2, s[8:11], s34 offen offset:3072 sc1
  buffer_load_dwordx4 v[148:151], v2, s[8:11], s36 offen offset:0 sc1
  buffer_load_dwordx4 v[152:155], v2, s[8:11], s36 offen offset:1024 sc1
  s_waitcnt vmcnt(0)
  v_max3_u32 v63, v8, v9, v10
  v_max3_u32 v63, v63, v11, v12
  v_max3_u32 v63, v63, v13, v14
  v_max3_u32 v63, v63, v15, v16
  v_max3_u32 v63, v63, v17, v18
  v_max3_u32 v63, v63, v19, v20
  v_max3_u32 v63, v63, v21, v22
  v_max3_u32 v63, v63, v23, v24
  v_max3_u32 v63, v63, v25, v26
  v_max3_u32 v63, v63, v27, v28
  v_max3_u32 v63, v63, v29, v30
  v_max3_u32 v63, v63, v31, v32
  v_max3_u32 v63, v63, v33, v34
  v_max3_u32 v63, v63, v35, v144
  v_max3_u32 v63, v63, v145, v146
  v_max3_u32 v63, v63, v147, v148
  v_max3_u32 v63, v63, v149, v150
  v_max3_u32 v63, v63, v151, v152
  v_max3_u32 v63, v63, v153, v154
  v_max_u32 v63, v63, v155
  v_cmp_eq_u32 vcc, -1, v63
  s_cbranch_vccz cB_va1_rk
  s_add_u32 s30, s30, 1
  s_cmp_lt_u32 s30, 400000
  s_cbranch_scc1 cB_va1_rv
  s_branch cB_abort
cB_va1_rk:
  s_mov_b32 s37, 1
  s_add_u32 s31, s31, 0x10000
  v_smfmac_f32_16x16x64_bf16 v[156:159], v[8:11], v[80:87], v3
  v_smfmac_f32_16x16x64_bf16 v[156:159], v[12:15], v[88:95], v3
  v_smfmac_f32_16x16x64_bf16 v[156:159], v[16:19], v[96:103], v3
  v_smfmac_f32_16x16x64_bf16 v[156:159], v[20:23], v[104:111], v3
  v_smfmac_f32_16x16x64_bf16 v[156:159], v[24:27], v[112:119], v3
  v_smfmac_f32_16x16x64_bf16 v[156:159], v[28:31], v[120:127], v3
  v_smfmac_f32_16x16x64_bf16 v[156:159], v[32:35], v[128:135], v3
  v_smfmac_f32_16x16x64_bf16 v[156:159], v[144:147], v[136:143], v3
  v_smfmac_f32_16x16x64_bf16 v[156:159], v[148:151], v[64:71], v3
  v_smfmac_f32_16x16x64_bf16 v[156:159], v[152:155], v[72:79], v3
  s_nop 7
  s_branch cB_va1_ep
cB_va2_loop:
  s_add_u32 s23, s20, 4096
  s_add_u32 s21, s20, 25600
  v_mov_b32 v36, 0
  v_mov_b32 v37, 0
  v_mov_b32 v38, 0
  v_mov_b32 v39, 0
  v_mov_b32 v40, 0
  v_mov_b32 v41, 0
  v_mov_b32 v42, 0
  v_mov_b32 v43, 0
  v_mov_b32 v44, 0
  v_mov_b32 v45, 0
  v_mov_b32 v46, 0
  v_mov_b32 v47, 0
  v_mov_b32 v48, 0
  v_mov_b32 v49, 0
  v_mov_b32 v50, 0
  v_mov_b32 v51, 0
  v_mov_b32 v52, 0
  v_mov_b32 v53, 0
  v_mov_b32 v54, 0
  v_mov_b32 v55, 0
  v_mov_b32 v56, 0
  v_mov_b32 v57, 0
  v_mov_b32 v58, 0
  v_mov_b32 v59, 0
  v_mov_b32 v60, 0
  v_mov_b32 v61, 0
  v_mov_b32 v62, 0
  v_mov_b32 v63, 0
  v_mov_b32 v64, 0
  v_mov_b32 v65, 0
  v_mov_b32 v66, 0
  v_mov_b32 v67, 0
  s_mov_b32 s30, 0
  buffer_load_dword v76, v119, s[8:11], s20 offen sc1
  buffer_load_dword v77, v119, s[8:11], s20 offen sc1
  buffer_load_dword v78, v119, s[8:11], s20 offen sc1
cB_va2_fp_l:
  s_waitcnt vmcnt(2)
  v_cmp_eq_u32 vcc, -1, v76
  s_cbranch_vccz cB_va2_fp_d
  buffer_load_dword v76, v119, s[8:11], s20 offen sc1
  s_waitcnt vmcnt(2)
  v_cmp_eq_u32 vcc, -1, v77
  s_cbranch_vccz cB_va2_fp_d
  buffer_load_dword v77, v119, s[8:11], s20 offen sc1
  s_waitcnt vmcnt(2)
  v_cmp_eq_u32 vcc, -1, v78
  s_cbranch_vccz cB_va2_fp_d
  buffer_load_dword v78, v119, s[8:11], s20 offen sc1
  s_add_u32 s30, s30, 1
  s_cmp_lt_u32 s30, 400000
  s_cbranch_scc1 cB_va2_fp_l
  s_branch cB_abort
cB_va2_fp_d:
  buffer_load_dwordx4 v[8:11], v2, s[8:11], s20 offen offset:0 sc1
  buffer_load_dwordx4 v[12:15], v2, s[8:11], s20 offen offset:1024 sc1
  buffer_load_dwordx4 v[16:19], v2, s[8:11], s20 offen offset:2048 sc1
  buffer_load_dwordx4 v[20:23], v2, s[8:11], s20 offen offset:3072 sc1
  s_barrier
cB_va2_ld:
  s_waitcnt vmcnt(0)
  v_max3_u32 v84, v8, v9, v10
  v_max3_u32 v84, v84, v11, v12
  v_max3_u32 v84, v84, v13, v14
  v_max3_u32 v84, v84, v15, v16
  v_max3_u32 v84, v84, v17, v18
  v_max3_u32 v84, v84, v19, v20
  v_max3_u32 v84, v84, v21, v22
  v_max_u32 v84, v84, v23
  v_cmp_eq_u32 vcc, -1, v84
  ds_write_b128 v2, v[8:11] offset:8192
  ds_write_b128 v2, v[12:15] offset:9216
  ds_write_b128 v2, v[16:19] offset:10240
  ds_write_b128 v2, v[20:23] offset:11264
  s_cbranch_vccnz cB_va2_retry
  s_waitcnt lgkmcnt(0)
  s_barrier
  ds_read_b128 v[24:27], v2 offset:12288
  ds_read_b128 v[28:31], v2 offset:13312
  ds_read_b128 v[32:35], v2 offset:14336
  ds_read_b128 v[92:95], v0
  s_waitcnt lgkmcnt(0)
  s_mov_b64 exec, s[26:27]
  buffer_store_dwordx4 v[92:95], v2, s[8:11], s36 offen sc1
  s_mov_b64 exec, -1
  s_add_u32 s36, s36, 7168
  s_cmp_eq_u32 s19, 63
  s_cbranch_scc1 cB_done
  ds_read_b128 v[76:79], v1 offset:0
  ds_read_b128 v[80:83], v1 offset:1024
  ds_read_b128 v[84:87], v1 offset:2048
  ds_read_b128 v[88:91], v1 offset:3072
  ds_read_b128 v[92:95], v1 offset:4096
  ds_read_b128 v[96:99], v1 offset:5120
  v_smfmac_f32_16x16x64_bf16 v[60:63], v[8:11], v[200:207], v3
  v_smfmac_f32_16x16x64_bf16 v[60:63], v[12:15], v[208:215], v3
  s_waitcnt lgkmcnt(4)
  v_smfmac_f32_16x16x64_bf16 v[64:67], v[8:11], v[76:83], v3
  ds_read_b128 v[76:79], v1 offset:6144
  ds_read_b128 v[80:83], v1 offset:7168
  v_smfmac_f32_16x16x64_bf16 v[60:63], v[16:19], v[216:223], v3
  v_smfmac_f32_16x16x64_bf16 v[60:63], v[20:23], v[224:231], v3
  s_waitcnt lgkmcnt(4)
  v_smfmac_f32_16x16x64_bf16 v[64:67], v[12:15], v[84:91], v3
  ds_read_b128 v[84:87], v1 offset:8192
  ds_read_b128 v[88:91], v1 offset:9216
  v_smfmac_f32_16x16x64_bf16 v[60:63], v[24:27], v[232:239], v3
  v_smfmac_f32_16x16x64_bf16 v[60:63], v[28:31], v[240:247], v3
  s_waitcnt lgkmcnt(4)
  v_smfmac_f32_16x16x64_bf16 v[64:67], v[16:19], v[92:99], v3
  ds_read_b128 v[92:95], v1 offset:10240
  ds_read_b128 v[96:99], v1 offset:11264
  v_smfmac_f32_16x16x64_bf16 v[60:63], v[32:35], v[248:255], v3
  v_smfmac_f32_16x16x64_bf16 v[36:39], v[8:11], a[0:7], v3
  s_waitcnt lgkmcnt(4)
  v_smfmac_f32_16x16x64_bf16 v[64:67], v[20:23], v[76:83], v3
  ds_read_b128 v[76:79], v1 offset:12288
  ds_read_b128 v[80:83], v1 offset:13312
  v_smfmac_f32_16x16x64_bf16 v[36:39], v[12:15], a[8:15], v3
  v_smfmac_f32_16x16x64_bf16 v[36:39], v[16:19], a[16:23], v3
  s_waitcnt lgkmcnt(4)
  v_smfmac_f32_16x16x64_bf16 v[64:67], v[24:27], v[84:91], v3
  v_smfmac_f32_16x16x64_bf16 v[36:39], v[20:23], a[24:31], v3
  v_smfmac_f32_16x16x64_bf16 v[36:39], v[24:27], a[32:39], v3
  s_waitcnt lgkmcnt(2)
  v_smfmac_f32_16x16x64_bf16 v[64:67], v[28:31], v[92:99], v3
  v_smfmac_f32_16x16x64_bf16 v[36:39], v[28:31], a[40:47], v3
  v_smfmac_f32_16x16x64_bf16 v[36:39], v[32:35], a[48:55], v3
  s_waitcnt lgkmcnt(0)
  v_smfmac_f32_16x16x64_bf16 v[64:67], v[32:35], v[76:83], v3
  v_smfmac_f32_16x16x64_bf16 v[40:43], v[8:11], a[56:63], v3
  v_smfmac_f32_16x16x64_bf16 v[40:43], v[12:15], a[64:71], v3
  v_smfmac_f32_16x16x64_bf16 v[40:43], v[16:19], a[72:79], v3
  v_smfmac_f32_16x16x64_bf16 v[40:43], v[20:23], a[80:87], v3
  v_permlane32_swap_b32 v60, v64
  v_smfmac_f32_16x16x64_bf16 v[40:43], v[24:27], a[88:95], v3
  v_permlane32_swap_b32 v61, v65
  v_smfmac_f32_16x16x64_bf16 v[40:43], v[28:31], a[96:103], v3
  v_permlane32_swap_b32 v62, v66
  v_smfmac_f32_16x16x64_bf16 v[40:43], v[32:35], a[104:111], v3
  v_permlane32_swap_b32 v63, v67
  v_smfmac_f32_16x16x64_bf16 v[44:47], v[8:11], a[112:119], v3
  v_smfmac_f32_16x16x64_bf16 v[44:47], v[12:15], a[120:127], v3
  v_smfmac_f32_16x16x64_bf16 v[44:47], v[16:19], a[128:135], v3
  v_smfmac_f32_16x16x64_bf16 v[44:47], v[20:23], a[136:143], v3
  v_add_f32 v60, v60, v64
  v_add_f32 v61, v61, v65
  v_smfmac_f32_16x16x64_bf16 v[44:47], v[24:27], a[144:151], v3
  v_add_f32 v62, v62, v66
  v_add_f32 v63, v63, v67
  v_smfmac_f32_16x16x64_bf16 v[44:47], v[28:31], a[152:159], v3
  v_cvt_pk_bf16_f32 v64, v60, v61
  v_cvt_pk_bf16_f32 v65, v62, v63
  v_smfmac_f32_16x16x64_bf16 v[44:47], v[32:35], a[160:167], v3
  ds_write_b64 v115, v[64:65]
  v_smfmac_f32_16x16x64_bf16 v[48:51], v[8:11], a[168:175], v3
  v_permlane32_swap_b32 v36, v40
  v_smfmac_f32_16x16x64_bf16 v[48:51], v[12:15], a[176:183], v3
  v_permlane32_swap_b32 v37, v41
  v_smfmac_f32_16x16x64_bf16 v[48:51], v[16:19], a[184:191], v3
  v_permlane32_swap_b32 v38, v42
  v_smfmac_f32_16x16x64_bf16 v[48:51], v[20:23], a[192:199], v3
  v_permlane32_swap_b32 v39, v43
  v_smfmac_f32_16x16x64_bf16 v[48:51], v[24:27], a[200:207], v3
  v_add_f32 v36, v36, v40
  v_smfmac_f32_16x16x64_bf16 v[48:51], v[28:31], a[208:215], v3
  v_add_f32 v37, v37, v41
  v_smfmac_f32_16x16x64_bf16 v[48:51], v[32:35], a[216:223], v3
  v_add_f32 v38, v38, v42
  v_smfmac_f32_16x16x64_bf16 v[52:55], v[8:11], a[224:231], v3
  v_smfmac_f32_16x16x64_bf16 v[52:55], v[12:15], a[232:239], v3
  v_smfmac_f32_16x16x64_bf16 v[52:55], v[16:19], a[240:247], v3
  v_smfmac_f32_16x16x64_bf16 v[52:55], v[20:23], a[248:255], v3
  v_add_f32 v39, v39, v43
  v_cvt_pk_bf16_f32 v40, v36, v37
  v_smfmac_f32_16x16x64_bf16 v[52:55], v[24:27], v[120:127], v3
  v_cvt_pk_bf16_f32 v41, v38, v39
  v_smfmac_f32_16x16x64_bf16 v[52:55], v[28:31], v[128:135], v3
  ds_write_b64 v112, v[40:41]
  v_smfmac_f32_16x16x64_bf16 v[52:55], v[32:35], v[136:143], v3
  v_permlane32_swap_b32 v44, v48
  v_smfmac_f32_16x16x64_bf16 v[56:59], v[8:11], v[144:151], v3
  v_permlane32_swap_b32 v45, v49
  v_smfmac_f32_16x16x64_bf16 v[56:59], v[12:15], v[152:159], v3
  v_permlane32_swap_b32 v46, v50
  v_smfmac_f32_16x16x64_bf16 v[56:59], v[16:19], v[160:167], v3
  v_permlane32_swap_b32 v47, v51
  v_smfmac_f32_16x16x64_bf16 v[56:59], v[20:23], v[168:175], v3
  v_add_f32 v44, v44, v48
  v_smfmac_f32_16x16x64_bf16 v[56:59], v[24:27], v[176:183], v3
  v_add_f32 v45, v45, v49
  v_smfmac_f32_16x16x64_bf16 v[56:59], v[28:31], v[184:191], v3
  v_add_f32 v46, v46, v50
  v_smfmac_f32_16x16x64_bf16 v[56:59], v[32:35], v[192:199], v3
  v_add_f32 v47, v47, v51
  v_cvt_pk_bf16_f32 v48, v44, v45
  v_cvt_pk_bf16_f32 v49, v46, v47
  ds_write_b64 v113, v[48:49]
  s_nop 3
  v_permlane32_swap_b32 v52, v56
  v_permlane32_swap_b32 v53, v57
  v_permlane32_swap_b32 v54, v58
  v_permlane32_swap_b32 v55, v59
  v_add_f32 v52, v52, v56
  v_add_f32 v53, v53, v57
  v_add_f32 v54, v54, v58
  v_add_f32 v55, v55, v59
  v_cvt_pk_bf16_f32 v56, v52, v53
  v_cvt_pk_bf16_f32 v57, v54, v55
  ds_write_b64 v114, v[56:57]
  s_waitcnt lgkmcnt(0)
  s_barrier
  s_cmp_eq_u32 s19, 62
  s_cbranch_scc1 cB_done
  s_waitcnt vmcnt(0) lgkmcnt(0)
  s_add_u32 s19, s19, 1
  s_mov_b32 s20, s21
  s_branch cB_va2_loop
cB_va2_retry:
  s_waitcnt lgkmcnt(0)
  buffer_load_dwordx4 v[8:11], v2, s[8:11], s20 offen offset:0 sc1
  buffer_load_dwordx4 v[12:15], v2, s[8:11], s20 offen offset:1024 sc1
  buffer_load_dwordx4 v[16:19], v2, s[8:11], s20 offen offset:2048 sc1
  buffer_load_dwordx4 v[20:23], v2, s[8:11], s20 offen offset:3072 sc1
  s_add_u32 s31, s31, 1
  s_add_u32 s30, s30, 1
  s_cmp_lt_u32 s30, 400000
  s_cbranch_scc1 cB_va2_ld
  s_branch cB_abort
cB_va2_last:
  s_waitcnt lgkmcnt(0)
  buffer_store_dwordx4 v[100:103], v2, s[8:11], s24 offen offset:0 sc1
  buffer_store_dwordx4 v[104:107], v2, s[8:11], s24 offen offset:1024 sc1
  buffer_store_dwordx4 v[108:111], v2, s[8:11], s24 offen offset:2048 sc1
  buffer_store_dwordx4 v[4:7], v2, s[8:11], s24 offen offset:3072 sc1
  s_add_u32 s24, s24, 8192
  s_waitcnt vmcnt(0)
  s_mov_b64 exec, 1
  buffer_store_dword v117, v2, s[8:11], s34 offen sc1
  s_mov_b64 exec, -1
  s_add_u32 s34, s34, 8
  s_mov_b64 exec, 1
  buffer_store_dword v117, v2, s[8:11], s34 offen sc1
  s_mov_b64 exec, -1
  s_add_u32 s34, s34, 8
  s_branch cB_done
cB_va3_loop:
  s_add_u32 s23, s20, 4096
  s_add_u32 s21, s20, 25600
  v_mov_b32 v36, 0
  v_mov_b32 v37, 0
  v_mov_b32 v38, 0
  v_mov_b32 v39, 0
  v_mov_b32 v40, 0
  v_mov_b32 v41, 0
  v_mov_b32 v42, 0
  v_mov_b32 v43, 0
  v_mov_b32 v44, 0
  v_mov_b32 v45, 0
  v_mov_b32 v46, 0
  v_mov_b32 v47, 0
  v_mov_b32 v48, 0
  v_mov_b32 v49, 0
  v_mov_b32 v50, 0
  v_mov_b32 v51, 0
  v_mov_b32 v52, 0
  v_mov_b32 v53, 0
  v_mov_b32 v54, 0
  v_mov_b32 v55, 0
  v_mov_b32 v56, 0
  v_mov_b32 v57, 0
  v_mov_b32 v58, 0
  v_mov_b32 v59, 0
  v_mov_b32 v60, 0
  v_mov_b32 v61, 0
  v_mov_b32 v62, 0
  v_mov_b32 v63, 0
  v_mov_b32 v64, 0
  v_mov_b32 v65, 0
  v_mov_b32 v66, 0
  v_mov_b32 v67, 0
  s_mov_b32 s30, 0
  buffer_load_dword v76, v119, s[8:11], s20 offen sc1
  buffer_load_dword v77, v119, s[8:11], s20 offen sc1
  buffer_load_dword v78, v119, s[8:11], s20 offen sc1
cB_va3_fp_l:
  s_waitcnt vmcnt(2)
  v_cmp_eq_u32 vcc, -1, v76
  s_cbranch_vccz cB_va3_fp_d
  buffer_load_dword v76, v119, s[8:11], s20 offen sc1
  s_waitcnt vmcnt(2)
  v_cmp_eq_u32 vcc, -1, v77
  s_cbranch_vccz cB_va3_fp_d
  buffer_load_dword v77, v119, s[8:11], s20 offen sc1
  s_waitcnt vmcnt(2)
  v_cmp_eq_u32 vcc, -1, v78
  s_cbranch_vccz cB_va3_fp_d
  buffer_load_dword v78, v119, s[8:11], s20 offen sc1
  s_add_u32 s30, s30, 1
  s_cmp_lt_u32 s30, 400000
  s_cbranch_scc1 cB_va3_fp_l
  s_branch cB_abort
cB_va3_fp_d:
  buffer_load_dwordx4 v[24:27], v2, s[8:11], s23 offen offset:0 sc1
  buffer_load_dwordx4 v[28:31], v2, s[8:11], s23 offen offset:1024 sc1
  buffer_load_dwordx4 v[32:35], v2, s[8:11], s23 offen offset:2048 sc1
  s_barrier
cB_va3_ld:
  s_waitcnt vmcnt(0)
  v_max3_u32 v84, v24, v25, v26
  v_max3_u32 v84, v84, v27, v28
  v_max3_u32 v84, v84, v29, v30
  v_max3_u32 v84, v84, v31, v32
  v_max3_u32 v84, v84, v33, v34
  v_max_u32 v84, v84, v35
  v_cmp_eq_u32 vcc, -1, v84
  ds_write_b128 v2, v[24:27] offset:12288
  ds_write_b128 v2, v[28:31] offset:13312
  ds_write_b128 v2, v[32:35] offset:14336
  s_cbranch_vccnz cB_va3_retry
  s_waitcnt lgkmcnt(0)
  s_barrier
  ds_read_b128 v[8:11], v2 offset:8192
  ds_read_b128 v[12:15], v2 offset:9216
  ds_read_b128 v[16:19], v2 offset:10240
  ds_read_b128 v[20:23], v2 offset:11264
  s_waitcnt lgkmcnt(0)
  s_cmp_eq_u32 s19, 63
  s_cbranch_scc1 cB_done
  ds_read_b128 v[76:79], v1 offset:0
  ds_read_b128 v[80:83], v1 offset:1024
  ds_read_b128 v[84:87], v1 offset:2048
  ds_read_b128 v[88:91], v1 offset:3072
  ds_read_b128 v[92:95], v1 offset:4096
  ds_read_b128 v[96:99], v1 offset:5120
  v_smfmac_f32_16x16x64_bf16 v[60:63], v[8:11], v[200:207], v3
  v_smfmac_f32_16x16x64_bf16 v[60:63], v[12:15], v[208:215], v3
  s_waitcnt lgkmcnt(4)
  v_smfmac_f32_16x16x64_bf16 v[64:67], v[8:11], v[76:83], v3
  ds_read_b128 v[76:79], v1 offset:6144
  ds_read_b128 v[80:83], v1 offset:7168
  v_smfmac_f32_16x16x64_bf16 v[60:63], v[16:19], v[216:223], v3
  v_smfmac_f32_16x16x64_bf16 v[60:63], v[20:23], v[224:231], v3
  s_waitcnt lgkmcnt(4)
  v_smfmac_f32_16x16x64_bf16 v[64:67], v[12:15], v[84:91], v3
  ds_read_b128 v[84:87], v1 offset:8192
  ds_read_b128 v[88:91], v1 offset:9216
  v_smfmac_f32_16x16x64_bf16 v[60:63], v[24:27], v[232:239], v3
  v_smfmac_f32_16x16x64_bf16 v[60:63], v[28:31], v[240:247], v3
  s_waitcnt lgkmcnt(4)
  v_smfmac_f32_16x16x64_bf16 v[64:67], v[16:19], v[92:99], v3
  ds_read_b128 v[92:95], v1 offset:10240
  ds_read_b128 v[96:99], v1 offset:11264
  v_smfmac_f32_16x16x64_bf16 v[60:63], v[32:35], v[248:255], v3
  v_smfmac_f32_16x16x64_bf16 v[36:39], v[8:11], a[0:7], v3
  s_waitcnt lgkmcnt(4)
  v_smfmac_f32_16x16x64_bf16 v[64:67], v[20:23], v[76:83], v3
  ds_read_b128 v[76:79], v1 offset:12288
  ds_read_b128 v[80:83], v1 offset:13312
  v_smfmac_f32_16x16x64_bf16 v[36:39], v[12:15], a[8:15], v3
  v_smfmac_f32_16x16x64_bf16 v[36:39], v[16:19], a[16:23], v3
  s_waitcnt lgkmcnt(4)
  v_smfmac_f32_16x16x64_bf16 v[64:67], v[24:27], v[84:91], v3
  v_smfmac_f32_16x16x64_bf16 v[36:39], v[20:23], a[24:31], v3
  v_smfmac_f32_16x16x64_bf16 v[36:39], v[24:27], a[32:39], v3
  s_waitcnt lgkmcnt(2)
  v_smfmac_f32_16x16x64_bf16 v[64:67], v[28:31], v[92:99], v3
  v_smfmac_f32_16x16x64_bf16 v[36:39], v[28:31], a[40:47], v3
  v_smfmac_f32_16x16x64_bf16 v[36:39], v[32:35], a[48:55], v3
  s_waitcnt lgkmcnt(0)
  v_smfmac_f32_16x16x64_bf16 v[64:67], v[32:35], v[76:83], v3
  v_smfmac_f32_16x16x64_bf16 v[40:43], v[8:11], a[56:63], v3
  v_smfmac_f32_16x16x64_bf16 v[40:43], v[12:15], a[64:71], v3
  v_smfmac_f32_16x16x64_bf16 v[40:43], v[16:19], a[72:79], v3
  v_smfmac_f32_16x16x64_bf16 v[40:43], v[20:23], a[80:87], v3
  v_permlane32_swap_b32 v60, v64
  v_smfmac_f32_16x16x64_bf16 v[40:43], v[24:27], a[88:95], v3
  v_permlane32_swap_b32 v61, v65
  v_smfmac_f32_16x16x64_bf16 v[40:43], v[28:31], a[96:103], v3
  v_permlane32_swap_b32 v62, v66
  v_smfmac_f32_16x16x64_bf16 v[40:43], v[32:35], a[104:111], v3
  v_permlane32_swap_b32 v63, v67
  v_smfmac_f32_16x16x64_bf16 v[44:47], v[8:11], a[112:119], v3
  v_smfmac_f32_16x16x64_bf16 v[44:47], v[12:15], a[120:127], v3
  v_smfmac_f32_16x16x64_bf16 v[44:47], v[16:19], a[128:135], v3
  v_smfmac_f32_16x16x64_bf16 v[44:47], v[20:23], a[136:143], v3
  v_add_f32 v60, v60, v64
  v_add_f32 v61, v61, v65
  v_smfmac_f32_16x16x64_bf16 v[44:47], v[24:27], a[144:151], v3
  v_add_f32 v62, v62, v66
  v_add_f32 v63, v63, v67
  v_smfmac_f32_16x16x64_bf16 v[44:47], v[28:31], a[152:159], v3
  v_cvt_pk_bf16_f32 v64, v60, v61
  v_cvt_pk_bf16_f32 v65, v62, v63
  v_smfmac_f32_16x16x64_bf16 v[44:47], v[32:35], a[160:167], v3
  ds_write_b64 v115, v[64:65]
  v_smfmac_f32_16x16x64_bf16 v[48:51], v[8:11], a[168:175], v3
  v_permlane32_swap_b32 v36, v40
  v_smfmac_f32_16x16x64_bf16 v[48:51], v[12:15], a[176:183], v3
  v_permlane32_swap_b32 v37, v41
  v_smfmac_f32_16x16x64_bf16 v[48:51], v[16:19], a[184:191], v3
  v_permlane32_swap_b32 v38, v42
  v_smfmac_f32_16x16x64_bf16 v[48:51], v[20:23], a[192:199], v3
  v_permlane32_swap_b32 v39, v43
  v_smfmac_f32_16x16x64_bf16 v[48:51], v[24:27], a[200:207], v3
  v_add_f32 v36, v36, v40
  v_smfmac_f32_16x16x64_bf16 v[48:51], v[28:31], a[208:215], v3
  v_add_f32 v37, v37, v41
  v_smfmac_f32_16x16x64_bf16 v[48:51], v[32:35], a[216:223], v3
  v_add_f32 v38, v38, v42
  v_smfmac_f32_16x16x64_bf16 v[52:55], v[8:11], a[224:231], v3
  v_smfmac_f32_16x16x64_bf16 v[52:55], v[12:15], a[232:239], v3
  v_smfmac_f32_16x16x64_bf16 v[52:55], v[16:19], a[240:247], v3
  v_smfmac_f32_16x16x64_bf16 v[52:55], v[20:23], a[248:255], v3
  v_add_f32 v39, v39, v43
  v_cvt_pk_bf16_f32 v40, v36, v37
  v_smfmac_f32_16x16x64_bf16 v[52:55], v[24:27], v[120:127], v3
  v_cvt_pk_bf16_f32 v41, v38, v39
  v_smfmac_f32_16x16x64_bf16 v[52:55], v[28:31], v[128:135], v3
  ds_write_b64 v112, v[40:41]
  v_smfmac_f32_16x16x64_bf16 v[52:55], v[32:35], v[136:143], v3
  v_permlane32_swap_b32 v44, v48
  v_smfmac_f32_16x16x64_bf16 v[56:59], v[8:11], v[144:151], v3
  v_permlane32_swap_b32 v45, v49
  v_smfmac_f32_16x16x64_bf16 v[56:59], v[12:15], v[152:159], v3
  v_permlane32_swap_b32 v46, v50
  v_smfmac_f32_16x16x64_bf16 v[56:59], v[16:19], v[160:167], v3
  v_permlane32_swap_b32 v47, v51
  v_smfmac_f32_16x16x64_bf16 v[56:59], v[20:23], v[168:175], v3
  v_add_f32 v44, v44, v48
  v_smfmac_f32_16x16x64_bf16 v[56:59], v[24:27], v[176:183], v3
  v_add_f32 v45, v45, v49
  v_smfmac_f32_16x16x64_bf16 v[56:59], v[28:31], v[184:191], v3
  v_add_f32 v46, v46, v50
  v_smfmac_f32_16x16x64_bf16 v[56:59], v[32:35], v[192:199], v3
  v_add_f32 v47, v47, v51
  v_cvt_pk_bf16_f32 v48, v44, v45
  v_cvt_pk_bf16_f32 v49, v46, v47
  ds_write_b64 v113, v[48:49]
  s_nop 3
  v_permlane32_swap_b32 v52, v56
  v_permlane32_swap_b32 v53, v57
  v_permlane32_swap_b32 v54, v58
  v_permlane32_swap_b32 v55, v59
  v_add_f32 v52, v52, v56
  v_add_f32 v53, v53, v57
  v_add_f32 v54, v54, v58
  v_add_f32 v55, v55, v59
  v_cvt_pk_bf16_f32 v56, v52, v53
  v_cvt_pk_bf16_f32 v57, v54, v55
  ds_write_b64 v114, v[56:57]
  s_waitcnt lgkmcnt(0)
  s_barrier
  s_cmp_eq_u32 s19, 62
  s_cbranch_scc1 cB_done
  s_waitcnt vmcnt(0) lgkmcnt(0)
  s_add_u32 s19, s19, 1
  s_mov_b32 s20, s21
  s_branch cB_va3_loop
cB_va3_retry:
  s_waitcnt lgkmcnt(0)
  buffer_load_dwordx4 v[24:27], v2, s[8:11], s23 offen offset:0 sc1
  buffer_load_dwordx4 v[28:31], v2, s[8:11], s23 offen offset:1024 sc1
  buffer_load_dwordx4 v[32:35], v2, s[8:11], s23 offen offset:2048 sc1
  s_add_u32 s31, s31, 1
  s_add_u32 s30, s30, 1
  s_cmp_lt_u32 s30, 400000
  s_cbranch_scc1 cB_va3_ld
  s_branch cB_abort
cB_va3_last:
  s_waitcnt lgkmcnt(0)
  buffer_store_dwordx4 v[100:103], v2, s[8:11], s24 offen offset:0 sc1
  buffer_store_dwordx4 v[104:107], v2, s[8:11], s24 offen offset:1024 sc1
  buffer_store_dwordx4 v[108:111], v2, s[8:11], s24 offen offset:2048 sc1
  buffer_store_dwordx4 v[4:7], v2, s[8:11], s24 offen offset:3072 sc1
  s_add_u32 s24, s24, 8192
  s_waitcnt vmcnt(0)
  s_mov_b64 exec, 1
  buffer_store_dword v117, v2, s[8:11], s34 offen sc1
  s_mov_b64 exec, -1
  s_add_u32 s34, s34, 8
  s_mov_b64 exec, 1
  buffer_store_dword v117, v2, s[8:11], s34 offen sc1
  s_mov_b64 exec, -1
  s_add_u32 s34, s34, 8
  s_branch cB_done
cB_abort:
  v_mov_b32 v4, 0xdead
  v_mov_b32 v5, 16
  buffer_store_dword v4, v5, s[12:15], 0 offen
  s_branch ch_end
cB_done:
  s_branch ch_end
m_reclaim:
  s_waitcnt vmcnt(0)
  s_lshr_b32 s20, s3, 5
  s_cmp_lg_u32 s16, 0
  s_cbranch_scc1 w0_17
  s_mov_b32 s21, 0
  s_mov_b64 exec, 1
rc_l:
  s_cmp_lg_u32 s70, -1
  s_cbranch_scc1 rc_t
  s_add_u32 s20, s20, 1
  s_cmp_lt_u32 s20, 8
  s_cselect_b32 s20, s20, 0
  s_mov_b32 s70, 0
  s_mov_b32 s3, -1
  s_add_u32 s21, s21, 1
  s_cmp_ge_u32 s21, 9
  s_cbranch_scc1 rc_d
rc_t:
  s_ff0_i32_b32 s22, s70
  s_lshl_b32 s23, 1, s22
  s_and_b32 s71, s20, 4
  s_mul_i32 s71, s71, 12
  s_lshl_b32 s3, s20, 2
  s_add_u32 s3, s3, s71
  v_mov_b32 v242, s23
  v_mov_b32 v243, 32
  buffer_atomic_or v242, v243, s[12:15], s3 offen sc0
  s_waitcnt vmcnt(0)
  v_readfirstlane_b32 s70, v242
  s_lshl_b32 s3, s20, 5
  s_add_u32 s3, s3, s22
  s_bitcmp1_b32 s70, s22
  s_cbranch_scc1 rc_l
rc_d:
  s_mov_b64 exec, -1
  v_mov_b32 v242, s3
w0_17:
  v_mov_b32 v250, 160000
  s_add_u32 s101, s101, 1
  s_barrier
  s_mov_b64 exec, 1
  s_cmp_lg_u32 s16, 0
  s_cbranch_scc1 w0_18
  ds_write_b32 v250, v242 offset:0
  s_waitcnt lgkmcnt(0)
  v_mov_b32 v242, s101
  ds_write_b32 v250, v242 offset:16
  s_waitcnt lgkmcnt(0)
w0_18:
  s_mov_b64 exec, -1
  s_barrier
  ds_read_b32 v242, v250 offset:0
  ds_read_b32 v250, v250 offset:16
  s_waitcnt lgkmcnt(0)
  v_readfirstlane_b32 s3, v242
  v_cmp_ne_u32 vcc, s101, v250
  s_cbranch_vccnz ch_end
  s_cmp_lg_u32 s3, -1
  s_cbranch_scc1 m_start
  v_mov_b32 v250, 0
  s_branch wk_ask
m_bjob:
  v_and_b32 v1, 63, v0
  v_lshlrev_b32 v2, 4, v1
  v_lshrrev_b32 v3, 4, v1
  v_and_b32 v4, 15, v1
  s_sub_u32 s18, s3, 32
  s_mul_i32 s17, s18, 4682
  s_lshr_b32 s17, s17, 16
  s_mul_i32 s20, s17, 14
  s_sub_u32 s19, s18, s20
  s_cmp_ge_u32 s19, 7
  s_cselect_b32 s31, 7, 0
  s_sub_u32 s19, s19, s31
  s_mov_b32 s60, s44
  s_and_b32 s61, s45, 0xffff
  s_mov_b32 s62, 3670016
  s_mov_b32 s63, 0x20000
  s_mov_b32 s56, s46
  s_and_b32 s57, s47, 0xffff
  s_mov_b32 s58, 3670016
  s_mov_b32 s59, 0x20000
  s_lshl_b32 s30, s16, 13
  s_mul_i32 s27, s17, 229376
  s_lshl_b32 s29, s19, 7
  s_add_u32 s27, s27, s29
  v_lshrrev_b32 v7, 3, v1
  v_and_b32 v8, 7, v1
  s_lshl_b32 s29, s16, 6
  v_add_u32 v7, s29, v7
  v_mul_u32_u24 v7, 896, v7
  v_lshl_add_u32 v7, v8, 4, v7
  s_add_u32 m0, s30, 0
  s_add_u32 s22, s27, 0
  buffer_load_dwordx4 v7, s[56:59], s22 offen offset:0 lds
  s_add_u32 s22, s27, 6144
  buffer_load_dwordx4 v7, s[56:59], s22 offen offset:1024 lds
  s_add_u32 s22, s27, 12288
  buffer_load_dwordx4 v7, s[56:59], s22 offen offset:2048 lds
  s_add_u32 s22, s27, 18432
  buffer_load_dwordx4 v7, s[56:59], s22 offen offset:3072 lds
  s_add_u32 m0, s30, 4096
  s_add_u32 s22, s27, 28672
  buffer_load_dwordx4 v7, s[56:59], s22 offen offset:0 lds
  s_add_u32 s22, s27, 34816
  buffer_load_dwordx4 v7, s[56:59], s22 offen offset:1024 lds
  s_add_u32 s22, s27, 40960
  buffer_load_dwordx4 v7, s[56:59], s22 offen offset:2048 lds
  s_add_u32 s22, s27, 47104
  buffer_load_dwordx4 v7, s[56:59], s22 offen offset:3072 lds
  v_lshrrev_b32 v5, 5, v1
  v_and_b32 v6, 31, v1
  s_lshl_b32 s25, s16, 15
  s_add_u32 s25, s25, 32768
  s_lshl_b32 s26, s17, 9
  s_add_u32 s28, s19, s16
  s_cmp_ge_u32 s28, 7
  s_cselect_b32 s20, 7, 0
  s_sub_u32 s28, s28, s20
  s_add_u32 s28, s28, s31
  s_add_u32 s29, s19, s16
  s_add_u32 s29, s29, 4
  s_cmp_ge_u32 s29, 7
  s_cselect_b32 s20, 7, 0
  s_sub_u32 s29, s29, s20
  s_add_u32 s29, s29, s31
  s_lshl_b32 s32, s28, 18
  s_add_u32 s32, s32, s26
  s_lshl_b32 s33, s29, 18
  s_add_u32 s33, s33, s26
  v_xor_b32 v8, v6, v5
  v_lshlrev_b32 v8, 4, v8
  v_lshl_add_u32 v8, v5, 13, v8
  v_xor_b32 v12, 0, v8
  v_xor_b32 v13, 32, v8
  v_add_u32 v13, 15360, v13
  v_xor_b32 v14, 0, v8
  v_add_u32 v14, 30720, v14
  v_xor_b32 v15, 32, v8
  v_add_u32 v15, 46080, v15
  s_add_u32 s20, s16, 0
  s_and_b32 s20, s20, 3
  s_mul_i32 s21, s20, 65600
  s_lshl_b32 s20, s20, 12
  s_add_u32 s48, s20, s25
  s_mov_b32 m0, s48
  v_xor_b32 v16, s21, v12
  buffer_load_dwordx4 v16, s[60:63], s32 offen offset:0 lds
  v_xor_b32 v17, s21, v13
  buffer_load_dwordx4 v17, s[60:63], s32 offen offset:1024 lds
  v_xor_b32 v18, s21, v14
  buffer_load_dwordx4 v18, s[60:63], s32 offen offset:2048 lds
  v_xor_b32 v19, s21, v15
  buffer_load_dwordx4 v19, s[60:63], s32 offen offset:3072 lds
  s_add_u32 s20, s16, 1
  s_and_b32 s20, s20, 3
  s_mul_i32 s21, s20, 65600
  s_lshl_b32 s20, s20, 12
  s_add_u32 s49, s20, s25
  s_mov_b32 m0, s49
  v_xor_b32 v20, s21, v12
  buffer_load_dwordx4 v20, s[60:63], s32 offen offset:0 lds
  v_xor_b32 v21, s21, v13
  buffer_load_dwordx4 v21, s[60:63], s32 offen offset:1024 lds
  v_xor_b32 v22, s21, v14
  buffer_load_dwordx4 v22, s[60:63], s32 offen offset:2048 lds
  v_xor_b32 v23, s21, v15
  buffer_load_dwordx4 v23, s[60:63], s32 offen offset:3072 lds
  s_add_u32 s20, s16, 2
  s_and_b32 s20, s20, 3
  s_mul_i32 s21, s20, 65600
  s_lshl_b32 s20, s20, 12
  s_add_u32 s50, s20, s25
  s_mov_b32 m0, s50
  v_xor_b32 v24, s21, v12
  buffer_load_dwordx4 v24, s[60:63], s32 offen offset:0 lds
  v_xor_b32 v25, s21, v13
  buffer_load_dwordx4 v25, s[60:63], s32 offen offset:1024 lds
  v_xor_b32 v26, s21, v14
  buffer_load_dwordx4 v26, s[60:63], s32 offen offset:2048 lds
  v_xor_b32 v27, s21, v15
  buffer_load_dwordx4 v27, s[60:63], s32 offen offset:3072 lds
  s_add_u32 s20, s16, 3
  s_and_b32 s20, s20, 3
  s_mul_i32 s21, s20, 65600
  s_lshl_b32 s20, s20, 12
  s_add_u32 s51, s20, s25
  s_mov_b32 m0, s51
  v_xor_b32 v28, s21, v12
  buffer_load_dwordx4 v28, s[60:63], s32 offen offset:0 lds
  v_xor_b32 v29, s21, v13
  buffer_load_dwordx4 v29, s[60:63], s32 offen offset:1024 lds
  v_xor_b32 v30, s21, v14
  buffer_load_dwordx4 v30, s[60:63], s32 offen offset:2048 lds
  v_xor_b32 v31, s21, v15
  buffer_load_dwordx4 v31, s[60:63], s32 offen offset:3072 lds
  s_cmp_eq_u32 s16, 3
  s_cbranch_scc1 bj_np1
  s_add_u32 m0, s48, 16384
  s_nop 0
  buffer_load_dwordx4 v16, s[60:63], s33 offen offset:0 lds
  buffer_load_dwordx4 v17, s[60:63], s33 offen offset:1024 lds
  buffer_load_dwordx4 v18, s[60:63], s33 offen offset:2048 lds
  buffer_load_dwordx4 v19, s[60:63], s33 offen offset:3072 lds
  s_add_u32 m0, s49, 16384
  s_nop 0
  buffer_load_dwordx4 v20, s[60:63], s33 offen offset:0 lds
  buffer_load_dwordx4 v21, s[60:63], s33 offen offset:1024 lds
  buffer_load_dwordx4 v22, s[60:63], s33 offen offset:2048 lds
  buffer_load_dwordx4 v23, s[60:63], s33 offen offset:3072 lds
  s_add_u32 m0, s50, 16384
  s_nop 0
  buffer_load_dwordx4 v24, s[60:63], s33 offen offset:0 lds
  buffer_load_dwordx4 v25, s[60:63], s33 offen offset:1024 lds
  buffer_load_dwordx4 v26, s[60:63], s33 offen offset:2048 lds
  buffer_load_dwordx4 v27, s[60:63], s33 offen offset:3072 lds
  s_add_u32 m0, s51, 16384
  s_nop 0
  buffer_load_dwordx4 v28, s[60:63], s33 offen offset:0 lds
  buffer_load_dwordx4 v29, s[60:63], s33 offen offset:1024 lds
  buffer_load_dwordx4 v30, s[60:63], s33 offen offset:2048 lds
  buffer_load_dwordx4 v31, s[60:63], s33 offen offset:3072 lds
bj_np1:
  s_mov_b32 s52, s36
  s_and_b32 s53, s37, 0xffff
  s_mov_b32 s54, 1835008
  s_mov_b32 s55, 0x20000
  s_lshl_b32 s20, s18, 8
  v_add_u32 v95, s20, v0
  s_mov_b32 s21, 9586981
  v_mul_hi_u32 v6, v95, s21
  v_mul_u32_u24 v7, 448, v6
  v_sub_u32 v7, v95, v7
  v_lshrrev_b32 v8, 4, v7
  v_and_b32 v7, 15, v7
  v_lshl_add_u32 v9, v6, 4, v7
  v_mul_u32_u24 v9, 896, v9
  v_lshl_add_u32 v9, v8, 5, v9
  buffer_load_dwordx4 v[84:87], v9, s[52:55], 0 offen
  buffer_load_dwordx4 v[88:91], v9, s[52:55], 0 offen offset:16
  v_mul_u32_u24 v6, 14336, v6
  v_lshl_add_u32 v6, v7, 4, v6
  v_lshl_add_u32 v92, v8, 9, v6
  v_lshrrev_b32 v7, 2, v8
  v_lshl_add_u32 v6, v7, 11, v6
  v_and_b32 v7, 3, v8
  v_lshl_add_u32 v93, v7, 8, v6
  s_mov_b32 s72, s38
  s_and_b32 s73, s39, 0xffff
  s_mov_b32 s74, 7168
  s_mov_b32 s75, 0x20000
  v_min_u32 v6, 223, v0
  v_lshrrev_b32 v7, 3, v6
  v_and_b32 v6, 7, v6
  v_mul_u32_u24 v9, 896, v6
  v_lshl_add_u32 v9, v7, 5, v9
  buffer_load_dwordx4 v[36:39], v9, s[72:75], 0 offen
  buffer_load_dwordx4 v[40:43], v9, s[72:75], 0 offen offset:16
  v_lshlrev_b32 v7, 8, v7
  v_lshl_add_u32 v94, v6, 4, v7
  s_cmp_lt_u32 s16, 2
  s_cselect_b32 s20, s40, s42
  s_cselect_b32 s21, s41, s43
  s_mov_b32 s72, s20
  s_and_b32 s73, s21, 0xffff
  s_mov_b32 s74, 3670016
  s_mov_b32 s75, 0x20000
  s_add_u32 s20, s19, s31
  s_lshl_b32 s21, s20, 5
  s_lshl_b32 s22, s16, 4
  s_add_u32 s21, s21, s22
  s_mul_i32 s20, s20, 14
  s_add_u32 s20, s20, 250
  s_cmp_lt_u32 s16, 2
  s_cselect_b32 s20, s21, s20
  s_lshl_b32 s20, s20, 13
  s_add_u32 s20, s20, s26
  v_lshlrev_b32 v6, 13, v4
  v_lshl_add_u32 v6, v3, 7, v6
  buffer_load_dword v51, v6, s[72:75], s20 offen
  s_cmp_lg_u32 s66, 0
  s_cbranch_scc1 bj_ci
  s_cmp_lg_u32 s16, 0
  s_cbranch_scc1 w0_19
  s_lshr_b32 s70, s3, 5
  s_and_b32 s71, s70, 4
  s_mul_i32 s71, s71, 12
  s_lshl_b32 s70, s70, 2
  s_add_u32 s70, s70, s71
  s_lshl_b32 s71, 1, s3
  v_mov_b32 v44, s71
  v_mov_b32 v45, 32
  s_mov_b64 exec, 1
  buffer_atomic_or v44, v45, s[12:15], s70 offen sc0
  buffer_load_dwordx2 v[46:47], v45, s[12:15], 0 offen offset:96 sc1
  s_mov_b64 exec, -1
w0_19:
bj_ci:
  s_lshl_b32 s30, s19, 6
  s_add_u32 s30, s30, 0
  v_add_u32 v8, s30, v4
  v_mul_u32_u24 v10, 2341, v8
  v_lshrrev_b32 v10, 16, v10
  v_mul_u32_u24 v11, 28, v10
  v_sub_u32 v32, v8, v11
  s_mul_i32 s30, s17, 28
  v_add_u32 v32, s30, v32
  v_lshrrev_b32 v33, 4, v32
  v_and_b32 v32, 15, v32
  s_mov_b32 s30, 401408
  v_mul_lo_u32 v10, v10, s30
  v_mul_u32_u24 v33, 14336, v33
  v_add_u32 v10, v10, v33
  v_lshl_add_u32 v10, v3, 8, v10
  v_lshl_add_u32 v10, v32, 4, v10
  v_add_u32 v12, 6422528, v10
  s_lshl_b32 s30, s19, 6
  s_add_u32 s30, s30, 16
  v_add_u32 v8, s30, v4
  v_mul_u32_u24 v10, 2341, v8
  v_lshrrev_b32 v10, 16, v10
  v_mul_u32_u24 v11, 28, v10
  v_sub_u32 v32, v8, v11
  s_mul_i32 s30, s17, 28
  v_add_u32 v32, s30, v32
  v_lshrrev_b32 v33, 4, v32
  v_and_b32 v32, 15, v32
  s_mov_b32 s30, 401408
  v_mul_lo_u32 v10, v10, s30
  v_mul_u32_u24 v33, 14336, v33
  v_add_u32 v10, v10, v33
  v_lshl_add_u32 v10, v3, 8, v10
  v_lshl_add_u32 v10, v32, 4, v10
  v_add_u32 v13, 6422528, v10
  s_lshl_b32 s30, s19, 6
  s_add_u32 s30, s30, 32
  v_add_u32 v8, s30, v4
  v_mul_u32_u24 v10, 2341, v8
  v_lshrrev_b32 v10, 16, v10
  v_mul_u32_u24 v11, 28, v10
  v_sub_u32 v32, v8, v11
  s_mul_i32 s30, s17, 28
  v_add_u32 v32, s30, v32
  v_lshrrev_b32 v33, 4, v32
  v_and_b32 v32, 15, v32
  s_mov_b32 s30, 401408
  v_mul_lo_u32 v10, v10, s30
  v_mul_u32_u24 v33, 14336, v33
  v_add_u32 v10, v10, v33
  v_lshl_add_u32 v10, v3, 8, v10
  v_lshl_add_u32 v10, v32, 4, v10
  v_add_u32 v14, 6422528, v10
  s_lshl_b32 s30, s19, 6
  s_add_u32 s30, s30, 48
  v_add_u32 v8, s30, v4
  v_mul_u32_u24 v10, 2341, v8
  v_lshrrev_b32 v10, 16, v10
  v_mul_u32_u24 v11, 28, v10
  v_sub_u32 v32, v8, v11
  s_mul_i32 s30, s17, 28
  v_add_u32 v32, s30, v32
  v_lshrrev_b32 v33, 4, v32
  v_and_b32 v32, 15, v32
  s_mov_b32 s30, 401408
  v_mul_lo_u32 v10, v10, s30
  v_mul_u32_u24 v33, 14336, v33
  v_add_u32 v10, v10, v33
  v_lshl_add_u32 v10, v3, 8, v10
  v_lshl_add_u32 v10, v32, 4, v10
  v_add_u32 v15, 6422528, v10
  v_lshrrev_b32 v7, 2, v4
  v_lshlrev_b32 v7, 3, v7
  v_and_b32 v8, 3, v4
  v_add_u32 v7, v7, v8
  v_xor_b32 v10, v3, v4
  v_lshlrev_b32 v10, 4, v10
  v_lshl_add_u32 v10, v7, 9, v10
  v_add_u32 v10, s25, v10
  v_xor_b32 v32, 0, v10
  v_xor_b32 v33, 64, v10
  v_xor_b32 v34, 128, v10
  v_xor_b32 v35, 192, v10
  v_lshrrev_b32 v7, 2, v4
  v_lshl_add_u32 v7, v3, 3, v7
  v_lshlrev_b32 v7, 7, v7
  v_and_b32 v8, 3, v4
  v_lshl_add_u32 v7, v8, 3, v7
  s_waitcnt vmcnt(37)
  s_cmp_lg_u32 s16, 3
  s_cbranch_scc1 w3_20
  s_waitcnt vmcnt(21)
w3_20:
  s_barrier
  ds_read_b64_tr_b16 v[128:129], v7 offset:0
  ds_read_b64_tr_b16 v[130:131], v7 offset:512
  ds_read_b64_tr_b16 v[132:133], v7 offset:4096
  ds_read_b64_tr_b16 v[134:135], v7 offset:4608
  ds_read_b64_tr_b16 v[136:137], v7 offset:8192
  ds_read_b64_tr_b16 v[138:139], v7 offset:8704
  ds_read_b64_tr_b16 v[140:141], v7 offset:12288
  ds_read_b64_tr_b16 v[142:143], v7 offset:12800
  s_waitcnt lgkmcnt(6)
  ds_read_b64_tr_b16 v[144:145], v7 offset:16384
  ds_read_b64_tr_b16 v[146:147], v7 offset:16896
  ds_read_b64_tr_b16 v[148:149], v7 offset:20480
  ds_read_b64_tr_b16 v[150:151], v7 offset:20992
  ds_read_b64_tr_b16 v[152:153], v7 offset:24576
  ds_read_b64_tr_b16 v[154:155], v7 offset:25088
  ds_read_b64_tr_b16 v[156:157], v7 offset:28672
  ds_read_b64_tr_b16 v[158:159], v7 offset:29184
  s_waitcnt lgkmcnt(6)
  ds_read_b64_tr_b16 v[160:161], v7 offset:32
  ds_read_b64_tr_b16 v[162:163], v7 offset:544
  ds_read_b64_tr_b16 v[164:165], v7 offset:4128
  ds_read_b64_tr_b16 v[166:167], v7 offset:4640
  ds_read_b64_tr_b16 v[168:169], v7 offset:8224
  ds_read_b64_tr_b16 v[170:171], v7 offset:8736
  ds_read_b64_tr_b16 v[172:173], v7 offset:12320
  ds_read_b64_tr_b16 v[174:175], v7 offset:12832
  s_waitcnt lgkmcnt(6)
  ds_read_b64_tr_b16 v[176:177], v7 offset:16416
  ds_read_b64_tr_b16 v[178:179], v7 offset:16928
  ds_read_b64_tr_b16 v[180:181], v7 offset:20512
  ds_read_b64_tr_b16 v[182:183], v7 offset:21024
  ds_read_b64_tr_b16 v[184:185], v7 offset:24608
  ds_read_b64_tr_b16 v[186:187], v7 offset:25120
  ds_read_b64_tr_b16 v[188:189], v7 offset:28704
  ds_read_b64_tr_b16 v[190:191], v7 offset:29216
  s_waitcnt lgkmcnt(6)
  ds_read_b64_tr_b16 v[192:193], v7 offset:64
  ds_read_b64_tr_b16 v[194:195], v7 offset:576
  ds_read_b64_tr_b16 v[196:197], v7 offset:4160
  ds_read_b64_tr_b16 v[198:199], v7 offset:4672
  ds_read_b64_tr_b16 v[200:201], v7 offset:8256
  ds_read_b64_tr_b16 v[202:203], v7 offset:8768
  ds_read_b64_tr_b16 v[204:205], v7 offset:12352
  ds_read_b64_tr_b16 v[206:207], v7 offset:12864
  s_waitcnt lgkmcnt(6)
  ds_read_b64_tr_b16 v[208:209], v7 offset:16448
  ds_read_b64_tr_b16 v[210:211], v7 offset:16960
  ds_read_b64_tr_b16 v[212:213], v7 offset:20544
  ds_read_b64_tr_b16 v[214:215], v7 offset:21056
  ds_read_b64_tr_b16 v[216:217], v7 offset:24640
  ds_read_b64_tr_b16 v[218:219], v7 offset:25152
  ds_read_b64_tr_b16 v[220:221], v7 offset:28736
  ds_read_b64_tr_b16 v[222:223], v7 offset:29248
  s_waitcnt lgkmcnt(6)
  ds_read_b64_tr_b16 v[224:225], v7 offset:96
  ds_read_b64_tr_b16 v[226:227], v7 offset:608
  ds_read_b64_tr_b16 v[228:229], v7 offset:4192
  ds_read_b64_tr_b16 v[230:231], v7 offset:4704
  ds_read_b64_tr_b16 v[232:233], v7 offset:8288
  ds_read_b64_tr_b16 v[234:235], v7 offset:8800
  ds_read_b64_tr_b16 v[236:237], v7 offset:12384
  ds_read_b64_tr_b16 v[238:239], v7 offset:12896
  s_waitcnt lgkmcnt(6)
  ds_read_b64_tr_b16 v[240:241], v7 offset:16480
  ds_read_b64_tr_b16 v[242:243], v7 offset:16992
  ds_read_b64_tr_b16 v[244:245], v7 offset:20576
  ds_read_b64_tr_b16 v[246:247], v7 offset:21088
  ds_read_b64_tr_b16 v[248:249], v7 offset:24672
  ds_read_b64_tr_b16 v[250:251], v7 offset:25184
  ds_read_b64_tr_b16 v[252:253], v7 offset:28768
  ds_read_b64_tr_b16 v[254:255], v7 offset:29280
  s_waitcnt lgkmcnt(6)
  s_waitcnt vmcnt(21) lgkmcnt(0)
  s_cmp_lg_u32 s16, 3
  s_cbranch_scc1 w3_21
  s_waitcnt vmcnt(5)
w3_21:
  ds_read_b128 v[52:55], v32 offset:0
  ds_read_b128 v[56:59], v33 offset:0
  ds_read_b128 v[60:63], v34 offset:0
  ds_read_b128 v[64:67], v35 offset:0
  s_waitcnt lgkmcnt(3)
  v_mfma_f32_16x16x32_bf16 v[96:99], v[52:55], v[128:131], 0
  v_mfma_f32_16x16x32_bf16 v[100:103], v[52:55], v[160:163], 0
  v_mfma_f32_16x16x32_bf16 v[104:107], v[52:55], v[192:195], 0
  v_mfma_f32_16x16x32_bf16 v[108:111], v[52:55], v[224:227], 0
  ds_read_b128 v[52:55], v32 offset:256
  s_waitcnt lgkmcnt(3)
  v_mfma_f32_16x16x32_bf16 v[96:99], v[56:59], v[132:135], v[96:99]
  v_mfma_f32_16x16x32_bf16 v[100:103], v[56:59], v[164:167], v[100:103]
  v_mfma_f32_16x16x32_bf16 v[104:107], v[56:59], v[196:199], v[104:107]
  v_mfma_f32_16x16x32_bf16 v[108:111], v[56:59], v[228:231], v[108:111]
  ds_read_b128 v[56:59], v33 offset:256
  s_waitcnt lgkmcnt(3)
  v_mfma_f32_16x16x32_bf16 v[96:99], v[60:63], v[136:139], v[96:99]
  v_mfma_f32_16x16x32_bf16 v[100:103], v[60:63], v[168:171], v[100:103]
  v_mfma_f32_16x16x32_bf16 v[104:107], v[60:63], v[200:203], v[104:107]
  v_mfma_f32_16x16x32_bf16 v[108:111], v[60:63], v[232:235], v[108:111]
  ds_read_b128 v[60:63], v34 offset:256
  s_waitcnt lgkmcnt(3)
  v_mfma_f32_16x16x32_bf16 v[96:99], v[64:67], v[140:143], v[96:99]
  v_mfma_f32_16x16x32_bf16 v[100:103], v[64:67], v[172:175], v[100:103]
  v_mfma_f32_16x16x32_bf16 v[104:107], v[64:67], v[204:207], v[104:107]
  v_mfma_f32_16x16x32_bf16 v[108:111], v[64:67], v[236:239], v[108:111]
  ds_read_b128 v[64:67], v35 offset:256
  s_waitcnt lgkmcnt(3)
  v_mfma_f32_16x16x32_bf16 v[96:99], v[52:55], v[144:147], v[96:99]
  v_mfma_f32_16x16x32_bf16 v[100:103], v[52:55], v[176:179], v[100:103]
  v_mfma_f32_16x16x32_bf16 v[104:107], v[52:55], v[208:211], v[104:107]
  v_mfma_f32_16x16x32_bf16 v[108:111], v[52:55], v[240:243], v[108:111]
  ds_read_b128 v[52:55], v32 offset:2048
  s_waitcnt lgkmcnt(3)
  v_mfma_f32_16x16x32_bf16 v[96:99], v[56:59], v[148:151], v[96:99]
  v_mfma_f32_16x16x32_bf16 v[100:103], v[56:59], v[180:183], v[100:103]
  v_mfma_f32_16x16x32_bf16 v[104:107], v[56:59], v[212:215], v[104:107]
  v_mfma_f32_16x16x32_bf16 v[108:111], v[56:59], v[244:247], v[108:111]
  ds_read_b128 v[56:59], v33 offset:2048
  s_waitcnt lgkmcnt(3)
  v_mfma_f32_16x16x32_bf16 v[96:99], v[60:63], v[152:155], v[96:99]
  v_mfma_f32_16x16x32_bf16 v[100:103], v[60:63], v[184:187], v[100:103]
  v_mfma_f32_16x16x32_bf16 v[104:107], v[60:63], v[216:219], v[104:107]
  v_mfma_f32_16x16x32_bf16 v[108:111], v[60:63], v[248:251], v[108:111]
  ds_read_b128 v[60:63], v34 offset:2048
  s_waitcnt lgkmcnt(3)
  v_mfma_f32_16x16x32_bf16 v[96:99], v[64:67], v[156:159], v[96:99]
  v_mfma_f32_16x16x32_bf16 v[100:103], v[64:67], v[188:191], v[100:103]
  v_mfma_f32_16x16x32_bf16 v[104:107], v[64:67], v[220:223], v[104:107]
  v_mfma_f32_16x16x32_bf16 v[108:111], v[64:67], v[252:255], v[108:111]
  ds_read_b128 v[64:67], v35 offset:2048
  s_waitcnt lgkmcnt(3)
  v_mfma_f32_16x16x32_bf16 v[112:115], v[52:55], v[128:131], 0
  v_mfma_f32_16x16x32_bf16 v[116:119], v[52:55], v[160:163], 0
  v_mfma_f32_16x16x32_bf16 v[120:123], v[52:55], v[192:195], 0
  v_mfma_f32_16x16x32_bf16 v[124:127], v[52:55], v[224:227], 0
  ds_read_b128 v[52:55], v32 offset:2304
  s_waitcnt lgkmcnt(3)
  v_mfma_f32_16x16x32_bf16 v[112:115], v[56:59], v[132:135], v[112:115]
  v_mfma_f32_16x16x32_bf16 v[116:119], v[56:59], v[164:167], v[116:119]
  v_mfma_f32_16x16x32_bf16 v[120:123], v[56:59], v[196:199], v[120:123]
  v_mfma_f32_16x16x32_bf16 v[124:127], v[56:59], v[228:231], v[124:127]
  ds_read_b128 v[56:59], v33 offset:2304
  s_waitcnt lgkmcnt(3)
  v_mfma_f32_16x16x32_bf16 v[112:115], v[60:63], v[136:139], v[112:115]
  v_mfma_f32_16x16x32_bf16 v[116:119], v[60:63], v[168:171], v[116:119]
  v_mfma_f32_16x16x32_bf16 v[120:123], v[60:63], v[200:203], v[120:123]
  v_mfma_f32_16x16x32_bf16 v[124:127], v[60:63], v[232:235], v[124:127]
  ds_read_b128 v[60:63], v34 offset:2304
  s_waitcnt lgkmcnt(3)
  v_mfma_f32_16x16x32_bf16 v[112:115], v[64:67], v[140:143], v[112:115]
  v_mfma_f32_16x16x32_bf16 v[116:119], v[64:67], v[172:175], v[116:119]
  v_mfma_f32_16x16x32_bf16 v[120:123], v[64:67], v[204:207], v[120:123]
  v_mfma_f32_16x16x32_bf16 v[124:127], v[64:67], v[236:239], v[124:127]
  ds_read_b128 v[64:67], v35 offset:2304
  s_waitcnt lgkmcnt(3)
  v_mfma_f32_16x16x32_bf16 v[112:115], v[52:55], v[144:147], v[112:115]
  v_mfma_f32_16x16x32_bf16 v[116:119], v[52:55], v[176:179], v[116:119]
  v_mfma_f32_16x16x32_bf16 v[120:123], v[52:55], v[208:211], v[120:123]
  v_mfma_f32_16x16x32_bf16 v[124:127], v[52:55], v[240:243], v[124:127]
  s_waitcnt lgkmcnt(2)
  v_mfma_f32_16x16x32_bf16 v[112:115], v[56:59], v[148:151], v[112:115]
  v_mfma_f32_16x16x32_bf16 v[116:119], v[56:59], v[180:183], v[116:119]
  v_mfma_f32_16x16x32_bf16 v[120:123], v[56:59], v[212:215], v[120:123]
  v_mfma_f32_16x16x32_bf16 v[124:127], v[56:59], v[244:247], v[124:127]
  s_waitcnt lgkmcnt(1)
  v_mfma_f32_16x16x32_bf16 v[112:115], v[60:63], v[152:155], v[112:115]
  v_mfma_f32_16x16x32_bf16 v[116:119], v[60:63], v[184:187], v[116:119]
  v_mfma_f32_16x16x32_bf16 v[120:123], v[60:63], v[216:219], v[120:123]
  v_mfma_f32_16x16x32_bf16 v[124:127], v[60:63], v[248:251], v[124:127]
  s_waitcnt lgkmcnt(0)
  v_mfma_f32_16x16x32_bf16 v[112:115], v[64:67], v[156:159], v[112:115]
  v_mfma_f32_16x16x32_bf16 v[116:119], v[64:67], v[188:191], v[116:119]
  v_mfma_f32_16x16x32_bf16 v[120:123], v[64:67], v[220:223], v[120:123]
  v_mfma_f32_16x16x32_bf16 v[124:127], v[64:67], v[252:255], v[124:127]
  s_cmp_lg_u32 s66, 0
  s_cbranch_scc1 bj_cf
  s_cmp_lg_u32 s16, 0
  s_cbranch_scc1 w0_22
  s_waitcnt vmcnt(0)
  v_readfirstlane_b32 s70, v46
  s_cmp_lg_u32 s70, 0
  s_cbranch_scc1 bj_nz
  v_mov_b32 v45, 128
  v_mov_b32 v46, s88
  v_mov_b32 v47, s89
  v_mov_b32 v48, 0
  v_mov_b32 v49, 0
  s_mov_b64 exec, 1
  buffer_atomic_cmpswap_x2 v[46:49], v45, s[12:15], 0 offen sc0
  s_mov_b64 exec, -1
  s_waitcnt vmcnt(0)
  v_readfirstlane_b32 s70, v46
  s_cmp_lg_u32 s70, 0
  s_cbranch_scc1 bj_nz
  v_mov_b32 v46, s88
  v_mov_b32 v47, s89
bj_nz:
w0_22:
  v_mov_b32 v45, 160000
  s_add_u32 s101, s101, 1
  s_barrier
  s_mov_b64 exec, 1
  s_cmp_lg_u32 s16, 0
  s_cbranch_scc1 w0_23
  ds_write_b32 v45, v44 offset:0
  ds_write_b32 v45, v46 offset:4
  ds_write_b32 v45, v47 offset:8
  s_waitcnt lgkmcnt(0)
  v_mov_b32 v44, s101
  ds_write_b32 v45, v44 offset:16
  s_waitcnt lgkmcnt(0)
w0_23:
  s_mov_b64 exec, -1
  s_barrier
  ds_read_b32 v44, v45 offset:0
  ds_read_b32 v46, v45 offset:4
  ds_read_b32 v47, v45 offset:8
  ds_read_b32 v45, v45 offset:16
  s_waitcnt lgkmcnt(0)
  v_readfirstlane_b32 s70, v44
  v_readfirstlane_b32 s88, v46
  v_readfirstlane_b32 s89, v47
  v_cmp_ne_u32 vcc, s101, v45
  s_cbranch_vccnz ch_end
  s_mov_b32 s66, 1
  s_bitcmp1_b32 s70, s3
  s_cbranch_scc1 m_reclaim
bj_cf:
  s_lshl_b32 s30, s28, 10
  v_cvt_pk_bf16_f32 v68, v96, v97
  v_cvt_pk_bf16_f32 v69, v98, v99
  v_cvt_pk_bf16_f32 v70, v112, v113
  v_cvt_pk_bf16_f32 v71, v114, v115
  buffer_store_dwordx4 v[68:71], v12, s[8:11], s30 offen sc1
  v_cvt_pk_bf16_f32 v72, v100, v101
  v_cvt_pk_bf16_f32 v73, v102, v103
  v_cvt_pk_bf16_f32 v74, v116, v117
  v_cvt_pk_bf16_f32 v75, v118, v119
  buffer_store_dwordx4 v[72:75], v13, s[8:11], s30 offen sc1
  v_cvt_pk_bf16_f32 v76, v104, v105
  v_cvt_pk_bf16_f32 v77, v106, v107
  v_cvt_pk_bf16_f32 v78, v120, v121
  v_cvt_pk_bf16_f32 v79, v122, v123
  buffer_store_dwordx4 v[76:79], v14, s[8:11], s30 offen sc1
  v_cvt_pk_bf16_f32 v80, v108, v109
  v_cvt_pk_bf16_f32 v81, v110, v111
  v_cvt_pk_bf16_f32 v82, v124, v125
  v_cvt_pk_bf16_f32 v83, v126, v127
  buffer_store_dwordx4 v[80:83], v15, s[8:11], s30 offen sc1
  s_cmp_eq_u32 s16, 3
  s_cbranch_scc1 bj_w3
  s_waitcnt vmcnt(9)
  ds_read_b128 v[52:55], v32 offset:16384
  ds_read_b128 v[56:59], v33 offset:16384
  ds_read_b128 v[60:63], v34 offset:16384
  ds_read_b128 v[64:67], v35 offset:16384
  s_waitcnt lgkmcnt(3)
  v_mfma_f32_16x16x32_bf16 v[96:99], v[52:55], v[128:131], 0
  v_mfma_f32_16x16x32_bf16 v[100:103], v[52:55], v[160:163], 0
  v_mfma_f32_16x16x32_bf16 v[104:107], v[52:55], v[192:195], 0
  v_mfma_f32_16x16x32_bf16 v[108:111], v[52:55], v[224:227], 0
  ds_read_b128 v[52:55], v32 offset:16640
  s_waitcnt lgkmcnt(3)
  v_mfma_f32_16x16x32_bf16 v[96:99], v[56:59], v[132:135], v[96:99]
  v_mfma_f32_16x16x32_bf16 v[100:103], v[56:59], v[164:167], v[100:103]
  v_mfma_f32_16x16x32_bf16 v[104:107], v[56:59], v[196:199], v[104:107]
  v_mfma_f32_16x16x32_bf16 v[108:111], v[56:59], v[228:231], v[108:111]
  ds_read_b128 v[56:59], v33 offset:16640
  s_waitcnt lgkmcnt(3)
  v_mfma_f32_16x16x32_bf16 v[96:99], v[60:63], v[136:139], v[96:99]
  v_mfma_f32_16x16x32_bf16 v[100:103], v[60:63], v[168:171], v[100:103]
  v_mfma_f32_16x16x32_bf16 v[104:107], v[60:63], v[200:203], v[104:107]
  v_mfma_f32_16x16x32_bf16 v[108:111], v[60:63], v[232:235], v[108:111]
  ds_read_b128 v[60:63], v34 offset:16640
  s_waitcnt lgkmcnt(3)
  v_mfma_f32_16x16x32_bf16 v[96:99], v[64:67], v[140:143], v[96:99]
  v_mfma_f32_16x16x32_bf16 v[100:103], v[64:67], v[172:175], v[100:103]
  v_mfma_f32_16x16x32_bf16 v[104:107], v[64:67], v[204:207], v[104:107]
  v_mfma_f32_16x16x32_bf16 v[108:111], v[64:67], v[236:239], v[108:111]
  ds_read_b128 v[64:67], v35 offset:16640
  s_waitcnt lgkmcnt(3)
  v_mfma_f32_16x16x32_bf16 v[96:99], v[52:55], v[144:147], v[96:99]
  v_mfma_f32_16x16x32_bf16 v[100:103], v[52:55], v[176:179], v[100:103]
  v_mfma_f32_16x16x32_bf16 v[104:107], v[52:55], v[208:211], v[104:107]
  v_mfma_f32_16x16x32_bf16 v[108:111], v[52:55], v[240:243], v[108:111]
  ds_read_b128 v[52:55], v32 offset:18432
  s_waitcnt lgkmcnt(3)
  v_mfma_f32_16x16x32_bf16 v[96:99], v[56:59], v[148:151], v[96:99]
  v_mfma_f32_16x16x32_bf16 v[100:103], v[56:59], v[180:183], v[100:103]
  v_mfma_f32_16x16x32_bf16 v[104:107], v[56:59], v[212:215], v[104:107]
  v_mfma_f32_16x16x32_bf16 v[108:111], v[56:59], v[244:247], v[108:111]
  ds_read_b128 v[56:59], v33 offset:18432
  s_waitcnt lgkmcnt(3)
  v_mfma_f32_16x16x32_bf16 v[96:99], v[60:63], v[152:155], v[96:99]
  v_mfma_f32_16x16x32_bf16 v[100:103], v[60:63], v[184:187], v[100:103]
  v_mfma_f32_16x16x32_bf16 v[104:107], v[60:63], v[216:219], v[104:107]
  v_mfma_f32_16x16x32_bf16 v[108:111], v[60:63], v[248:251], v[108:111]
  ds_read_b128 v[60:63], v34 offset:18432
  s_waitcnt lgkmcnt(3)
  v_mfma_f32_16x16x32_bf16 v[96:99], v[64:67], v[156:159], v[96:99]
  v_mfma_f32_16x16x32_bf16 v[100:103], v[64:67], v[188:191], v[100:103]
  v_mfma_f32_16x16x32_bf16 v[104:107], v[64:67], v[220:223], v[104:107]
  v_mfma_f32_16x16x32_bf16 v[108:111], v[64:67], v[252:255], v[108:111]
  ds_read_b128 v[64:67], v35 offset:18432
  s_waitcnt lgkmcnt(3)
  v_mfma_f32_16x16x32_bf16 v[112:115], v[52:55], v[128:131], 0
  v_mfma_f32_16x16x32_bf16 v[116:119], v[52:55], v[160:163], 0
  v_mfma_f32_16x16x32_bf16 v[120:123], v[52:55], v[192:195], 0
  v_mfma_f32_16x16x32_bf16 v[124:127], v[52:55], v[224:227], 0
  ds_read_b128 v[52:55], v32 offset:18688
  s_waitcnt lgkmcnt(3)
  v_mfma_f32_16x16x32_bf16 v[112:115], v[56:59], v[132:135], v[112:115]
  v_mfma_f32_16x16x32_bf16 v[116:119], v[56:59], v[164:167], v[116:119]
  v_mfma_f32_16x16x32_bf16 v[120:123], v[56:59], v[196:199], v[120:123]
  v_mfma_f32_16x16x32_bf16 v[124:127], v[56:59], v[228:231], v[124:127]
  ds_read_b128 v[56:59], v33 offset:18688
  s_waitcnt lgkmcnt(3)
  v_mfma_f32_16x16x32_bf16 v[112:115], v[60:63], v[136:139], v[112:115]
  v_mfma_f32_16x16x32_bf16 v[116:119], v[60:63], v[168:171], v[116:119]
  v_mfma_f32_16x16x32_bf16 v[120:123], v[60:63], v[200:203], v[120:123]
  v_mfma_f32_16x16x32_bf16 v[124:127], v[60:63], v[232:235], v[124:127]
  ds_read_b128 v[60:63], v34 offset:18688
  s_waitcnt lgkmcnt(3)
  v_mfma_f32_16x16x32_bf16 v[112:115], v[64:67], v[140:143], v[112:115]
  v_mfma_f32_16x16x32_bf16 v[116:119], v[64:67], v[172:175], v[116:119]
  v_mfma_f32_16x16x32_bf16 v[120:123], v[64:67], v[204:207], v[120:123]
  v_mfma_f32_16x16x32_bf16 v[124:127], v[64:67], v[236:239], v[124:127]
  ds_read_b128 v[64:67], v35 offset:18688
  s_waitcnt lgkmcnt(3)
  v_mfma_f32_16x16x32_bf16 v[112:115], v[52:55], v[144:147], v[112:115]
  v_mfma_f32_16x16x32_bf16 v[116:119], v[52:55], v[176:179], v[116:119]
  v_mfma_f32_16x16x32_bf16 v[120:123], v[52:55], v[208:211], v[120:123]
  v_mfma_f32_16x16x32_bf16 v[124:127], v[52:55], v[240:243], v[124:127]
  s_waitcnt lgkmcnt(2)
  v_mfma_f32_16x16x32_bf16 v[112:115], v[56:59], v[148:151], v[112:115]
  v_mfma_f32_16x16x32_bf16 v[116:119], v[56:59], v[180:183], v[116:119]
  v_mfma_f32_16x16x32_bf16 v[120:123], v[56:59], v[212:215], v[120:123]
  v_mfma_f32_16x16x32_bf16 v[124:127], v[56:59], v[244:247], v[124:127]
  s_waitcnt lgkmcnt(1)
  v_mfma_f32_16x16x32_bf16 v[112:115], v[60:63], v[152:155], v[112:115]
  v_mfma_f32_16x16x32_bf16 v[116:119], v[60:63], v[184:187], v[116:119]
  v_mfma_f32_16x16x32_bf16 v[120:123], v[60:63], v[216:219], v[120:123]
  v_mfma_f32_16x16x32_bf16 v[124:127], v[60:63], v[248:251], v[124:127]
  s_waitcnt lgkmcnt(0)
  v_mfma_f32_16x16x32_bf16 v[112:115], v[64:67], v[156:159], v[112:115]
  v_mfma_f32_16x16x32_bf16 v[116:119], v[64:67], v[188:191], v[116:119]
  v_mfma_f32_16x16x32_bf16 v[120:123], v[64:67], v[220:223], v[120:123]
  v_mfma_f32_16x16x32_bf16 v[124:127], v[64:67], v[252:255], v[124:127]
  s_lshl_b32 s30, s29, 10
  v_cvt_pk_bf16_f32 v68, v96, v97
  v_cvt_pk_bf16_f32 v69, v98, v99
  v_cvt_pk_bf16_f32 v70, v112, v113
  v_cvt_pk_bf16_f32 v71, v114, v115
  buffer_store_dwordx4 v[68:71], v12, s[8:11], s30 offen sc1
  v_cvt_pk_bf16_f32 v72, v100, v101
  v_cvt_pk_bf16_f32 v73, v102, v103
  v_cvt_pk_bf16_f32 v74, v116, v117
  v_cvt_pk_bf16_f32 v75, v118, v119
  buffer_store_dwordx4 v[72:75], v13, s[8:11], s30 offen sc1
  v_cvt_pk_bf16_f32 v76, v104, v105
  v_cvt_pk_bf16_f32 v77, v106, v107
  v_cvt_pk_bf16_f32 v78, v120, v121
  v_cvt_pk_bf16_f32 v79, v122, v123
  buffer_store_dwordx4 v[76:79], v14, s[8:11], s30 offen sc1
  v_cvt_pk_bf16_f32 v80, v108, v109
  v_cvt_pk_bf16_f32 v81, v110, v111
  v_cvt_pk_bf16_f32 v82, v124, v125
  v_cvt_pk_bf16_f32 v83, v126, v127
  buffer_store_dwordx4 v[80:83], v15, s[8:11], s30 offen sc1
bj_w3:
  s_lshl_b32 s77, s19, 8
  s_lshl_b32 s21, s17, 4
  s_add_u32 s77, s77, s21
  s_cmp_lg_u32 s31, 0
  s_cselect_b32 s21, 8, 0
  s_add_u32 s77, s77, s21
  s_add_u32 s77, s77, 88588288
  s_add_u32 s78, s77, 2048
  s_cmp_lt_u32 s19, 3
  s_cbranch_scc1 bj_a1
  s_waitcnt vmcnt(4)
  v_mov_b32 v96, v84
  v_mov_b32 v100, v85
  v_min_u32 v104, -2, v36
  v_min_u32 v108, -2, v37
  v_mov_b32 v97, v86
  v_mov_b32 v101, v87
  v_min_u32 v105, -2, v38
  v_min_u32 v109, -2, v39
  v_mov_b32 v98, v88
  v_mov_b32 v102, v89
  v_min_u32 v106, -2, v40
  v_min_u32 v110, -2, v41
  v_mov_b32 v99, v90
  v_mov_b32 v103, v91
  v_min_u32 v107, -2, v42
  v_min_u32 v111, -2, v43
  s_mov_b32 s20, 71565312
  s_mov_b32 s21, 73400320
  buffer_store_dwordx4 v[84:87], v92, s[8:11], s20 offen sc1
  buffer_store_dwordx4 v[88:91], v92, s[8:11], s20 offen offset:256 sc1
  buffer_store_dwordx4 v[96:99], v93, s[8:11], s21 offen sc1
  buffer_store_dwordx4 v[100:103], v93, s[8:11], s21 offen offset:1024 sc1
  s_cmp_lg_u32 s18, 0
  s_cbranch_scc1 bi_nm
  s_mov_b32 s20, 75235328
  s_mov_b32 s21, 88068096
  buffer_store_dwordx4 v[104:107], v94, s[8:11], s20 offen sc1
  buffer_store_dwordx4 v[108:111], v94, s[8:11], s20 offen offset:128 sc1
  buffer_store_dwordx4 v[104:107], v94, s[8:11], s21 offen sc1
  buffer_store_dwordx4 v[108:111], v94, s[8:11], s21 offen offset:128 sc1
bi_nm:
  s_waitcnt vmcnt(4)
  s_mov_b32 s23, 75235328
  v_add_u32 v6, 448, v95
  v_subrev_u32 v7, 1344, v6
  v_mov_b32 v52, -1
  v_mov_b32 v9, 0
  v_cmp_gt_u32 vcc, 256, v7
  s_nop 1
  v_cndmask_b32 v52, v52, v9, vcc
  v_mov_b32 v53, v52
  v_mov_b32 v54, v52
  v_mov_b32 v55, v52
  v_lshlrev_b32 v8, 4, v6
  v_mov_b32 v9, 0x10000000
  v_cmp_lt_u32 vcc, 105599, v6
  s_nop 1
  v_cndmask_b32 v8, v8, v9, vcc
  buffer_store_dwordx4 v[52:55], v8, s[8:11], s23 offen sc1
  v_add_u32 v6, 57792, v95
  v_subrev_u32 v7, 1344, v6
  v_mov_b32 v56, -1
  v_mov_b32 v9, 0
  v_cmp_gt_u32 vcc, 256, v7
  s_nop 1
  v_cndmask_b32 v56, v56, v9, vcc
  v_mov_b32 v57, v56
  v_mov_b32 v58, v56
  v_mov_b32 v59, v56
  v_lshlrev_b32 v8, 4, v6
  v_mov_b32 v9, 0x10000000
  v_cmp_lt_u32 vcc, 105599, v6
  s_nop 1
  v_cndmask_b32 v8, v8, v9, vcc
  buffer_store_dwordx4 v[56:59], v8, s[8:11], s23 offen sc1
  s_mov_b32 s23, 88068096
  v_add_u32 v6, 448, v95
  v_subrev_u32 v7, 28672, v6
  v_mov_b32 v60, -1
  v_mov_b32 v9, 0
  v_cmp_gt_u32 vcc, 1048576, v7
  s_nop 1
  v_cndmask_b32 v60, v60, v9, vcc
  v_mov_b32 v61, v60
  v_mov_b32 v62, v60
  v_mov_b32 v63, v60
  v_lshlrev_b32 v8, 4, v6
  v_mov_b32 v9, 0x10000000
  v_cmp_lt_u32 vcc, 32391, v6
  s_nop 1
  v_cndmask_b32 v8, v8, v9, vcc
  buffer_store_dwordx4 v[60:63], v8, s[8:11], s23 offen sc1
  s_barrier
  s_cmp_lg_u32 s16, 0
  s_cbranch_scc1 pub_24
  v_mul_u32_u24 v26, 2048, v1
  v_mov_b32 v24, s88
  v_mov_b32 v25, s89
  s_mov_b64 exec, 1
  buffer_store_dwordx2 v[24:25], v26, s[8:11], s77 offen sc1
  s_mov_b64 exec, -1
pub_24:
  s_waitcnt vmcnt(0)
  s_barrier
  s_cmp_lg_u32 s16, 0
  s_cbranch_scc1 pub_25
  v_mul_u32_u24 v26, 2048, v1
  v_mov_b32 v24, s88
  v_mov_b32 v25, s89
  s_mov_b64 exec, 511
  buffer_store_dwordx2 v[24:25], v26, s[8:11], s78 offen sc1
  s_mov_b64 exec, -1
pub_25:
  s_branch bj_end
bj_a1:
  s_add_u32 s19, s19, 4
  s_waitcnt vmcnt(4)
  v_mov_b32 v96, v84
  v_mov_b32 v100, v85
  v_min_u32 v104, -2, v36
  v_min_u32 v108, -2, v37
  v_mov_b32 v97, v86
  v_mov_b32 v101, v87
  v_min_u32 v105, -2, v38
  v_min_u32 v109, -2, v39
  v_mov_b32 v98, v88
  v_mov_b32 v102, v89
  v_min_u32 v106, -2, v40
  v_min_u32 v110, -2, v41
  v_mov_b32 v99, v90
  v_mov_b32 v103, v91
  v_min_u32 v107, -2, v42
  v_min_u32 v111, -2, v43
  s_mov_b32 s20, 71565312
  s_mov_b32 s21, 73400320
  buffer_store_dwordx4 v[84:87], v92, s[8:11], s20 offen sc1
  buffer_store_dwordx4 v[88:91], v92, s[8:11], s20 offen offset:256 sc1
  buffer_store_dwordx4 v[96:99], v93, s[8:11], s21 offen sc1
  buffer_store_dwordx4 v[100:103], v93, s[8:11], s21 offen offset:1024 sc1
  s_cmp_lg_u32 s18, 0
  s_cbranch_scc1 bk_nm
  s_mov_b32 s20, 75235328
  s_mov_b32 s21, 88068096
  buffer_store_dwordx4 v[104:107], v94, s[8:11], s20 offen sc1
  buffer_store_dwordx4 v[108:111], v94, s[8:11], s20 offen offset:128 sc1
  buffer_store_dwordx4 v[104:107], v94, s[8:11], s21 offen sc1
  buffer_store_dwordx4 v[108:111], v94, s[8:11], s21 offen offset:128 sc1
bk_nm:
  s_mov_b32 s23, 75235328
  v_add_u32 v6, 448, v95
  v_subrev_u32 v7, 1344, v6
  v_mov_b32 v52, -1
  v_mov_b32 v9, 0
  v_cmp_gt_u32 vcc, 256, v7
  s_nop 1
  v_cndmask_b32 v52, v52, v9, vcc
  v_mov_b32 v53, v52
  v_mov_b32 v54, v52
  v_mov_b32 v55, v52
  v_lshlrev_b32 v8, 4, v6
  v_mov_b32 v9, 0x10000000
  v_cmp_lt_u32 vcc, 105599, v6
  s_nop 1
  v_cndmask_b32 v8, v8, v9, vcc
  buffer_store_dwordx4 v[52:55], v8, s[8:11], s23 offen sc1
  v_add_u32 v6, 57792, v95
  v_subrev_u32 v7, 1344, v6
  v_mov_b32 v56, -1
  v_mov_b32 v9, 0
  v_cmp_gt_u32 vcc, 256, v7
  s_nop 1
  v_cndmask_b32 v56, v56, v9, vcc
  v_mov_b32 v57, v56
  v_mov_b32 v58, v56
  v_mov_b32 v59, v56
  v_lshlrev_b32 v8, 4, v6
  v_mov_b32 v9, 0x10000000
  v_cmp_lt_u32 vcc, 105599, v6
  s_nop 1
  v_cndmask_b32 v8, v8, v9, vcc
  buffer_store_dwordx4 v[56:59], v8, s[8:11], s23 offen sc1
  s_mov_b32 s23, 88068096
  v_add_u32 v6, 448, v95
  v_subrev_u32 v7, 28672, v6
  v_mov_b32 v60, -1
  v_mov_b32 v9, 0
  v_cmp_gt_u32 vcc, 1048576, v7
  s_nop 1
  v_cndmask_b32 v60, v60, v9, vcc
  v_mov_b32 v61, v60
  v_mov_b32 v62, v60
  v_mov_b32 v63, v60
  v_lshlrev_b32 v8, 4, v6
  v_mov_b32 v9, 0x10000000
  v_cmp_lt_u32 vcc, 32391, v6
  s_nop 1
  v_cndmask_b32 v8, v8, v9, vcc
  buffer_store_dwordx4 v[60:63], v8, s[8:11], s23 offen sc1
  s_barrier
  s_mov_b32 s60, s40
  s_and_b32 s61, s41, 0xffff
  s_mov_b32 s62, 3670016
  s_mov_b32 s63, 0x20000
  s_mov_b32 s56, s42
  s_and_b32 s57, s43, 0xffff
  s_mov_b32 s58, 3670016
  s_mov_b32 s59, 0x20000
  s_lshl_b32 s30, s16, 13
  s_lshl_b32 s27, s19, 19
  s_lshl_b32 s29, s16, 17
  s_add_u32 s27, s27, s29
  s_lshl_b32 s29, s17, 9
  s_add_u32 s27, s27, s29
  v_lshrrev_b32 v5, 5, v1
  v_and_b32 v6, 31, v1
  v_xor_b32 v6, v6, v5
  v_lshlrev_b32 v6, 4, v6
  v_lshl_add_u32 v6, v5, 13, v6
  s_add_u32 m0, s30, 0
  s_add_u32 s22, s27, 0
  v_xor_b32 v7, 0, v6
  buffer_load_dwordx4 v7, s[56:59], s22 offen offset:0 lds
  s_add_u32 s22, s27, 15360
  v_xor_b32 v7, 32, v6
  buffer_load_dwordx4 v7, s[56:59], s22 offen offset:1024 lds
  s_add_u32 s22, s27, 30720
  v_xor_b32 v7, 64, v6
  buffer_load_dwordx4 v7, s[56:59], s22 offen offset:2048 lds
  s_add_u32 s22, s27, 46080
  v_xor_b32 v7, 96, v6
  buffer_load_dwordx4 v7, s[56:59], s22 offen offset:3072 lds
  s_add_u32 m0, s30, 4096
  s_add_u32 s22, s27, 65536
  v_xor_b32 v7, 128, v6
  buffer_load_dwordx4 v7, s[56:59], s22 offen offset:0 lds
  s_add_u32 s22, s27, 80896
  v_xor_b32 v7, 160, v6
  buffer_load_dwordx4 v7, s[56:59], s22 offen offset:1024 lds
  s_add_u32 s22, s27, 96256
  v_xor_b32 v7, 192, v6
  buffer_load_dwordx4 v7, s[56:59], s22 offen offset:2048 lds
  s_add_u32 s22, s27, 111616
  v_xor_b32 v7, 224, v6
  buffer_load_dwordx4 v7, s[56:59], s22 offen offset:3072 lds
  s_waitcnt vmcnt(8)
  s_barrier
  s_cmp_lg_u32 s16, 0
  s_cbranch_scc1 pub_26
  v_mul_u32_u24 v46, 2048, v1
  v_mov_b32 v44, s88
  v_mov_b32 v45, s89
  s_mov_b64 exec, 1
  buffer_store_dwordx2 v[44:45], v46, s[8:11], s77 offen sc1
  s_mov_b64 exec, -1
pub_26:
  s_cmp_lg_u32 s16, 0
  s_cbranch_scc1 w0_27
  v_mul_u32_u24 v50, 2048, v1
  v_mov_b32 v48, s88
  v_mov_b32 v49, s89
  s_mov_b64 exec, 511
  buffer_store_dwordx2 v[48:49], v50, s[8:11], s78 offen sc1
  s_mov_b64 exec, -1
w0_27:
  v_lshrrev_b32 v5, 5, v1
  v_and_b32 v6, 31, v1
  s_lshl_b32 s25, s16, 15
  s_add_u32 s25, s25, 32768
  s_lshl_b32 s26, s17, 9
  s_add_u32 s28, s19, s16
  s_cmp_ge_u32 s28, 7
  s_cselect_b32 s20, 7, 0
  s_sub_u32 s28, s28, s20
  s_add_u32 s28, s28, s31
  s_add_u32 s29, s19, s16
  s_add_u32 s29, s29, 4
  s_cmp_ge_u32 s29, 7
  s_cselect_b32 s20, 7, 0
  s_sub_u32 s29, s29, s20
  s_add_u32 s29, s29, s31
  s_lshl_b32 s32, s28, 18
  s_add_u32 s32, s32, s26
  s_lshl_b32 s33, s29, 18
  s_add_u32 s33, s33, s26
  v_xor_b32 v8, v6, v5
  v_lshlrev_b32 v8, 4, v8
  v_lshl_add_u32 v8, v5, 13, v8
  v_xor_b32 v12, 0, v8
  v_xor_b32 v13, 32, v8
  v_add_u32 v13, 15360, v13
  v_xor_b32 v14, 0, v8
  v_add_u32 v14, 30720, v14
  v_xor_b32 v15, 32, v8
  v_add_u32 v15, 46080, v15
  s_add_u32 s20, s16, 0
  s_and_b32 s20, s20, 3
  s_mul_i32 s21, s20, 65600
  s_lshl_b32 s20, s20, 12
  s_add_u32 s48, s20, s25
  s_mov_b32 m0, s48
  v_xor_b32 v16, s21, v12
  buffer_load_dwordx4 v16, s[60:63], s32 offen offset:0 lds
  v_xor_b32 v17, s21, v13
  buffer_load_dwordx4 v17, s[60:63], s32 offen offset:1024 lds
  v_xor_b32 v18, s21, v14
  buffer_load_dwordx4 v18, s[60:63], s32 offen offset:2048 lds
  v_xor_b32 v19, s21, v15
  buffer_load_dwordx4 v19, s[60:63], s32 offen offset:3072 lds
  s_add_u32 s20, s16, 1
  s_and_b32 s20, s20, 3
  s_mul_i32 s21, s20, 65600
  s_lshl_b32 s20, s20, 12
  s_add_u32 s49, s20, s25
  s_mov_b32 m0, s49
  v_xor_b32 v20, s21, v12
  buffer_load_dwordx4 v20, s[60:63], s32 offen offset:0 lds
  v_xor_b32 v21, s21, v13
  buffer_load_dwordx4 v21, s[60:63], s32 offen offset:1024 lds
  v_xor_b32 v22, s21, v14
  buffer_load_dwordx4 v22, s[60:63], s32 offen offset:2048 lds
  v_xor_b32 v23, s21, v15
  buffer_load_dwordx4 v23, s[60:63], s32 offen offset:3072 lds
  s_add_u32 s20, s16, 2
  s_and_b32 s20, s20, 3
  s_mul_i32 s21, s20, 65600
  s_lshl_b32 s20, s20, 12
  s_add_u32 s50, s20, s25
  s_mov_b32 m0, s50
  v_xor_b32 v24, s21, v12
  buffer_load_dwordx4 v24, s[60:63], s32 offen offset:0 lds
  v_xor_b32 v25, s21, v13
  buffer_load_dwordx4 v25, s[60:63], s32 offen offset:1024 lds
  v_xor_b32 v26, s21, v14
  buffer_load_dwordx4 v26, s[60:63], s32 offen offset:2048 lds
  v_xor_b32 v27, s21, v15
  buffer_load_dwordx4 v27, s[60:63], s32 offen offset:3072 lds
  s_add_u32 s20, s16, 3
  s_and_b32 s20, s20, 3
  s_mul_i32 s21, s20, 65600
  s_lshl_b32 s20, s20, 12
  s_add_u32 s51, s20, s25
  s_mov_b32 m0, s51
  v_xor_b32 v28, s21, v12
  buffer_load_dwordx4 v28, s[60:63], s32 offen offset:0 lds
  v_xor_b32 v29, s21, v13
  buffer_load_dwordx4 v29, s[60:63], s32 offen offset:1024 lds
  v_xor_b32 v30, s21, v14
  buffer_load_dwordx4 v30, s[60:63], s32 offen offset:2048 lds
  v_xor_b32 v31, s21, v15
  buffer_load_dwordx4 v31, s[60:63], s32 offen offset:3072 lds
  s_cmp_eq_u32 s16, 3
  s_cbranch_scc1 ak_np1
  s_add_u32 m0, s48, 16384
  s_nop 0
  buffer_load_dwordx4 v16, s[60:63], s33 offen offset:0 lds
  buffer_load_dwordx4 v17, s[60:63], s33 offen offset:1024 lds
  buffer_load_dwordx4 v18, s[60:63], s33 offen offset:2048 lds
  buffer_load_dwordx4 v19, s[60:63], s33 offen offset:3072 lds
  s_add_u32 m0, s49, 16384
  s_nop 0
  buffer_load_dwordx4 v20, s[60:63], s33 offen offset:0 lds
  buffer_load_dwordx4 v21, s[60:63], s33 offen offset:1024 lds
  buffer_load_dwordx4 v22, s[60:63], s33 offen offset:2048 lds
  buffer_load_dwordx4 v23, s[60:63], s33 offen offset:3072 lds
  s_add_u32 m0, s50, 16384
  s_nop 0
  buffer_load_dwordx4 v24, s[60:63], s33 offen offset:0 lds
  buffer_load_dwordx4 v25, s[60:63], s33 offen offset:1024 lds
  buffer_load_dwordx4 v26, s[60:63], s33 offen offset:2048 lds
  buffer_load_dwordx4 v27, s[60:63], s33 offen offset:3072 lds
  s_add_u32 m0, s51, 16384
  s_nop 0
  buffer_load_dwordx4 v28, s[60:63], s33 offen offset:0 lds
  buffer_load_dwordx4 v29, s[60:63], s33 offen offset:1024 lds
  buffer_load_dwordx4 v30, s[60:63], s33 offen offset:2048 lds
  buffer_load_dwordx4 v31, s[60:63], s33 offen offset:3072 lds
ak_np1:
  s_mov_b32 s79, 1
  s_branch aj_run
bj_end:
  s_mov_b32 s3, s68
  s_cmp_lg_u32 s69, 0
  s_cbranch_scc1 wk_have
  v_mov_b32 v250, 0
  s_branch wk_ask
wk_loop:
  s_waitcnt vmcnt(0) lgkmcnt(0)
  s_cmp_eq_u32 s96, 1
  s_cbranch_scc1 wk_ask
  s_mov_b32 s96, 1
  s_cmp_lg_u32 s16, 0
  s_cbranch_scc1 w0_28
  s_mov_b32 s30, 0
  v_mov_b32 v243, 32
sf_l:
  buffer_load_dword v242, v243, s[12:15], 0 offen sc1
  s_waitcnt vmcnt(0)
  v_readfirstlane_b32 s70, v242
  s_cmp_eq_u32 s70, -1
  s_cbranch_scc1 sf_d
  s_sleep 16
  s_add_u32 s30, s30, 1
  s_cmp_lt_u32 s30, 64
  s_cbranch_scc1 sf_l
  s_mov_b32 s20, 0
  s_mov_b32 s21, 0
  s_mov_b64 exec, 1
sf_c_l:
  s_cmp_lg_u32 s70, -1
  s_cbranch_scc1 sf_c_t
  s_add_u32 s20, s20, 1
  s_cmp_lt_u32 s20, 8
  s_cselect_b32 s20, s20, 0
  s_mov_b32 s70, 0
  s_mov_b32 s3, -1
  s_add_u32 s21, s21, 1
  s_cmp_ge_u32 s21, 1
  s_cbranch_scc1 sf_c_d
sf_c_t:
  s_ff0_i32_b32 s22, s70
  s_lshl_b32 s23, 1, s22
  s_and_b32 s71, s20, 4
  s_mul_i32 s71, s71, 12
  s_lshl_b32 s3, s20, 2
  s_add_u32 s3, s3, s71
  v_mov_b32 v242, s23
  v_mov_b32 v243, 32
  buffer_atomic_or v242, v243, s[12:15], s3 offen sc0
  s_waitcnt vmcnt(0)
  v_readfirstlane_b32 s70, v242
  s_lshl_b32 s3, s20, 5
  s_add_u32 s3, s3, s22
  s_bitcmp1_b32 s70, s22
  s_cbranch_scc1 sf_c_l
sf_c_d:
  s_mov_b64 exec, -1
  v_mov_b32 v242, s3
sf_d:
w0_28:
  v_mov_b32 v243, 160000
  s_add_u32 s101, s101, 1
  s_barrier
  s_mov_b64 exec, 1
  s_cmp_lg_u32 s16, 0
  s_cbranch_scc1 w0_29
  ds_write_b32 v243, v242 offset:0
  s_waitcnt lgkmcnt(0)
  v_mov_b32 v242, s101
  ds_write_b32 v243, v242 offset:16
  s_waitcnt lgkmcnt(0)
w0_29:
  s_mov_b64 exec, -1
  s_barrier
  ds_read_b32 v242, v243 offset:0
  ds_read_b32 v243, v243 offset:16
  s_waitcnt lgkmcnt(0)
  v_readfirstlane_b32 s3, v242
  v_cmp_ne_u32 vcc, s101, v243
  s_cbranch_vccnz ch_end
  s_cmp_eq_u32 s3, -1
  s_cbranch_scc1 wk_ask
  s_load_dwordx8 s[36:43], s[0:1], 56
  s_load_dwordx4 s[44:47], s[0:1], 88
  s_getreg_b32 s67, hwreg(HW_REG_XCC_ID)
  s_and_b32 s67, s67, 7
  s_mov_b32 s66, 1
  s_waitcnt lgkmcnt(0)
  s_branch m_start
wk_ask:
  v_readfirstlane_b32 s22, v250
  s_cmp_ge_u32 s22, 1376
  s_cbranch_scc1 wk_next
  s_cmp_lg_u32 s16, 0
  s_cbranch_scc1 w0_30
  v_mov_b32 v250, 1
  v_mov_b32 v251, 192
  s_mov_b64 exec, 1
  buffer_atomic_add v250, v251, s[12:15], 0 offen sc0
  s_mov_b64 exec, -1
w0_30:
wk_next:
  s_waitcnt vmcnt(0)
  v_mov_b32 v6, 160000
  s_add_u32 s101, s101, 1
  s_barrier
  s_mov_b64 exec, 1
  s_cmp_lg_u32 s16, 0
  s_cbranch_scc1 w0_31
  ds_write_b32 v6, v250 offset:0
  s_waitcnt lgkmcnt(0)
  v_mov_b32 v250, s101
  ds_write_b32 v6, v250 offset:16
  s_waitcnt lgkmcnt(0)
w0_31:
  s_mov_b64 exec, -1
  s_barrier
  ds_read_b32 v250, v6 offset:0
  ds_read_b32 v6, v6 offset:16
  s_waitcnt lgkmcnt(0)
  v_readfirstlane_b32 s3, v250
  v_cmp_ne_u32 vcc, s101, v6
  s_cbranch_vccnz ch_end
wk_have:
  s_cmp_ge_u32 s3, 1376
  s_cbranch_scc1 ch_end
  v_mov_b32 v250, 0
  v_mov_b32 v251, 192
  v_and_b32 v1, 63, v0
  v_lshlrev_b32 v2, 4, v1
  v_lshrrev_b32 v3, 4, v1
  v_and_b32 v4, 15, v1
  s_cmp_lg_u32 s97, 0
  s_cbranch_scc1 wk_go
  s_mov_b32 s68, s3
  s_mov_b32 s69, 1
  s_cmp_lg_u32 s16, 0
  s_cbranch_scc1 w0_32
  s_add_u32 s20, s67, 1
  s_lshl_b32 s22, s20, 11
  s_add_u32 s22, s22, 88590336
  v_add_u32 v24, 1024, v2
  v_min_u32 v24, 1776, v24
  s_mov_b32 s30, 0
wk_af:
  buffer_load_dwordx4 v[28:31], v2, s[8:11], s22 offen sc1
  buffer_load_dwordx4 v[32:35], v24, s[8:11], s22 offen sc1
  s_waitcnt vmcnt(0)
  v_cmp_ne_u64 vcc, s[88:89], v[28:29]
  s_cbranch_vccnz wk_af_no
  v_cmp_ne_u64 vcc, s[88:89], v[30:31]
  s_cbranch_vccnz wk_af_no
  v_cmp_ne_u64 vcc, s[88:89], v[32:33]
  s_cbranch_vccnz wk_af_no
  v_cmp_ne_u64 vcc, s[88:89], v[34:35]
  s_cbranch_vccnz wk_af_no
  s_branch wk_af_ok
wk_af_no:
  s_sleep 4
  s_add_u32 s30, s30, 1
  s_and_b32 s20, s30, 63
  s_cbranch_scc1 wk_ns
  s_mov_b32 s20, 1
  s_mov_b32 s70, 0
  s_mov_b32 s21, 0
  s_mov_b64 exec, 1
wk_st_l:
  s_cmp_lg_u32 s70, -1
  s_cbranch_scc1 wk_st_t
  s_add_u32 s20, s20, 1
  s_cmp_lt_u32 s20, 8
  s_cselect_b32 s20, s20, 1
  s_mov_b32 s70, 0
  s_mov_b32 s3, -1
  s_add_u32 s21, s21, 1
  s_cmp_ge_u32 s21, 7
  s_cbranch_scc1 wk_st_d
wk_st_t:
  s_ff0_i32_b32 s22, s70
  s_lshl_b32 s23, 1, s22
  s_and_b32 s71, s20, 4
  s_mul_i32 s71, s71, 12
  s_lshl_b32 s3, s20, 2
  s_add_u32 s3, s3, s71
  v_mov_b32 v242, s23
  v_mov_b32 v243, 32
  buffer_atomic_or v242, v243, s[12:15], s3 offen sc0
  s_waitcnt vmcnt(0)
  v_readfirstlane_b32 s70, v242
  s_lshl_b32 s3, s20, 5
  s_add_u32 s3, s3, s22
  s_bitcmp1_b32 s70, s22
  s_cbranch_scc1 wk_st_l
wk_st_d:
  s_mov_b64 exec, -1
  v_mov_b32 v242, s3
  s_cmp_lg_u32 s3, -1
  s_cbranch_scc1 wk_pd
  s_add_u32 s20, s67, 1
  s_lshl_b32 s22, s20, 11
  s_add_u32 s22, s22, 88590336
wk_ns:
  s_cmp_lt_u32 s30, 50000
  s_cbranch_scc1 wk_af
  s_branch cA_abort
wk_af_ok:
  v_mov_b32 v242, -1
wk_pd:
w0_32:
  v_mov_b32 v243, 160000
  s_add_u32 s101, s101, 1
  s_barrier
  s_mov_b64 exec, 1
  s_cmp_lg_u32 s16, 0
  s_cbranch_scc1 w0_33
  ds_write_b32 v243, v242 offset:0
  s_waitcnt lgkmcnt(0)
  v_mov_b32 v242, s101
  ds_write_b32 v243, v242 offset:16
  s_waitcnt lgkmcnt(0)
w0_33:
  s_mov_b64 exec, -1
  s_barrier
  ds_read_b32 v242, v243 offset:0
  ds_read_b32 v243, v243 offset:16
  s_waitcnt lgkmcnt(0)
  v_readfirstlane_b32 s3, v242
  v_cmp_ne_u32 vcc, s101, v243
  s_cbranch_vccnz ch_end
  s_cmp_lg_u32 s3, -1
  s_cbranch_scc1 m_bjob
  s_mov_b32 s3, s68
  s_mov_b32 s97, 1
wk_go:
  s_cmp_ge_u32 s3, 864
  s_cbranch_scc1 wk_tok
  s_cmp_ge_u32 s3, 736
  s_cbranch_scc1 wk_f
  s_cmp_ge_u32 s3, 624
  s_cbranch_scc1 wk_s4d
  s_cmp_ge_u32 s3, 560
  s_cbranch_scc1 wk_vf
  s_cmp_ge_u32 s3, 496
  s_cbranch_scc1 wk_vh
  s_cmp_ge_u32 s3, 368
  s_cbranch_scc1 wk_a
  s_cmp_ge_u32 s3, 336
  s_cbranch_scc1 wk_srv
  s_cmp_ge_u32 s3, 224
  s_cbranch_scc1 wk_v7
  s_sub_u32 s20, s3, 0
  s_cmp_ge_u32 s20, 112
  s_cselect_b32 s18, 1, 0
  s_cselect_b32 s21, 112, 0
  s_sub_u32 s20, s20, s21
  s_and_b32 s17, s20, 15
  s_add_u32 s17, s17, 16
  s_lshr_b32 s34, s20, 4
  s_lshl_b32 s34, s34, 1
  s_add_u32 s35, s34, 2
  s_lshl_b32 s20, s18, 3
  s_lshl_b32 s21, s16, 1
  s_add_u32 s20, s20, s21
  s_mul_i32 s21, s20, 14336
  s_add_u32 s21, s21, 71565312
  s_add_u32 s22, s21, 0
  buffer_load_dwordx4 a[0:3], v2, s[8:11], s22 offen offset:0 sc1
  buffer_load_dwordx4 a[4:7], v2, s[8:11], s22 offen offset:1024 sc1
  buffer_load_dwordx4 a[8:11], v2, s[8:11], s22 offen offset:2048 sc1
  buffer_load_dwordx4 a[12:15], v2, s[8:11], s22 offen offset:3072 sc1
  s_add_u32 s22, s21, 4096
  buffer_load_dwordx4 a[16:19], v2, s[8:11], s22 offen offset:0 sc1
  buffer_load_dwordx4 a[20:23], v2, s[8:11], s22 offen offset:1024 sc1
  buffer_load_dwordx4 a[24:27], v2, s[8:11], s22 offen offset:2048 sc1
  buffer_load_dwordx4 a[28:31], v2, s[8:11], s22 offen offset:3072 sc1
  s_add_u32 s22, s21, 8192
  buffer_load_dwordx4 a[32:35], v2, s[8:11], s22 offen offset:0 sc1
  buffer_load_dwordx4 a[36:39], v2, s[8:11], s22 offen offset:1024 sc1
  buffer_load_dwordx4 a[40:43], v2, s[8:11], s22 offen offset:2048 sc1
  buffer_load_dwordx4 a[44:47], v2, s[8:11], s22 offen offset:3072 sc1
  s_add_u32 s22, s21, 12288
  buffer_load_dwordx4 a[48:51], v2, s[8:11], s22 offen offset:0 sc1
  buffer_load_dwordx4 a[52:55], v2, s[8:11], s22 offen offset:1024 sc1
  buffer_load_dwordx4 a[56:59], v2, s[8:11], s22 offen offset:2048 sc1
  buffer_load_dwordx4 a[60:63], v2, s[8:11], s22 offen offset:3072 sc1
  s_add_u32 s22, s21, 16384
  buffer_load_dwordx4 a[64:67], v2, s[8:11], s22 offen offset:0 sc1
  buffer_load_dwordx4 a[68:71], v2, s[8:11], s22 offen offset:1024 sc1
  buffer_load_dwordx4 a[72:75], v2, s[8:11], s22 offen offset:2048 sc1
  buffer_load_dwordx4 a[76:79], v2, s[8:11], s22 offen offset:3072 sc1
  s_add_u32 s22, s21, 20480
  buffer_load_dwordx4 a[80:83], v2, s[8:11], s22 offen offset:0 sc1
  buffer_load_dwordx4 a[84:87], v2, s[8:11], s22 offen offset:1024 sc1
  buffer_load_dwordx4 a[88:91], v2, s[8:11], s22 offen offset:2048 sc1
  buffer_load_dwordx4 a[92:95], v2, s[8:11], s22 offen offset:3072 sc1
  s_add_u32 s22, s21, 24576
  buffer_load_dwordx4 a[96:99], v2, s[8:11], s22 offen offset:0 sc1
  buffer_load_dwordx4 a[100:103], v2, s[8:11], s22 offen offset:1024 sc1
  buffer_load_dwordx4 a[104:107], v2, s[8:11], s22 offen offset:2048 sc1
  buffer_load_dwordx4 a[108:111], v2, s[8:11], s22 offen offset:3072 sc1
  s_waitcnt vmcnt(40)
  s_mul_i32 s23, s17, 401408
  s_and_b32 s22, s16, 1
  s_mul_i32 s22, s22, 7168
  s_add_u32 s23, s23, s22
  s_add_u32 s23, s23, 0
  s_lshr_b32 s22, s16, 1
  s_mul_i32 s22, s22, 14336
  s_add_u32 s23, s23, s22
  s_mul_i32 s27, s16, 7168
  s_lshr_b32 s28, s20, 1
wf_vo:
  s_sub_u32 s29, s17, 16
  s_lshl_b32 s29, s29, 6
  s_add_u32 s29, s29, s28
  s_mul_i32 s29, s29, 28672
  s_add_u32 s29, s29, 42205184
  v_mul_u32_u24 v6, 28, v3
  s_mov_b32 s31, 0
  s_lshl_b32 s24, s34, 1
  s_mul_i32 s24, s24, 14336
  s_add_u32 s24, s24, s23
  s_cmp_lt_u32 s34, s35
  s_cselect_b32 s24, s24, 0x10000000
  s_add_u32 m0, s31, s27
  s_nop 0
  buffer_load_dwordx4 v2, s[8:11], s24 offen offset:0 sc1 lds
  buffer_load_dwordx4 v2, s[8:11], s24 offen offset:1024 sc1 lds
  buffer_load_dwordx4 v2, s[8:11], s24 offen offset:2048 sc1 lds
  buffer_load_dwordx4 v2, s[8:11], s24 offen offset:3072 sc1 lds
  s_add_u32 m0, m0, 4096
  s_add_u32 s24, s24, 4096
  buffer_load_dwordx4 v2, s[8:11], s24 offen offset:0 sc1 lds
  buffer_load_dwordx4 v2, s[8:11], s24 offen offset:1024 sc1 lds
  buffer_load_dwordx4 v2, s[8:11], s24 offen offset:2048 sc1 lds
  s_add_u32 s30, s34, 1
  s_mov_b32 s31, 28672
  s_lshl_b32 s24, s30, 1
  s_mul_i32 s24, s24, 14336
  s_add_u32 s24, s24, s23
  s_cmp_lt_u32 s30, s35
  s_cselect_b32 s24, s24, 0x10000000
  s_add_u32 m0, s31, s27
  s_nop 0
  buffer_load_dwordx4 v2, s[8:11], s24 offen offset:0 sc1 lds
  buffer_load_dwordx4 v2, s[8:11], s24 offen offset:1024 sc1 lds
  buffer_load_dwordx4 v2, s[8:11], s24 offen offset:2048 sc1 lds
  buffer_load_dwordx4 v2, s[8:11], s24 offen offset:3072 sc1 lds
  s_add_u32 m0, m0, 4096
  s_add_u32 s24, s24, 4096
  buffer_load_dwordx4 v2, s[8:11], s24 offen offset:0 sc1 lds
  buffer_load_dwordx4 v2, s[8:11], s24 offen offset:1024 sc1 lds
  buffer_load_dwordx4 v2, s[8:11], s24 offen offset:2048 sc1 lds
  s_mov_b32 s19, s34
  s_mov_b32 s32, 0
  s_mov_b32 s33, 57344
  s_waitcnt vmcnt(7)
  s_branch wf_vo_in
wf_vo_loop:
  s_waitcnt vmcnt(9)
wf_vo_in:
  s_barrier
  s_add_u32 s30, s19, 2
  s_lshl_b32 s24, s30, 1
  s_mul_i32 s24, s24, 14336
  s_add_u32 s24, s24, s23
  s_cmp_lt_u32 s30, s35
  s_cselect_b32 s24, s24, 0x10000000
  s_add_u32 m0, s33, s27
  s_nop 0
  buffer_load_dwordx4 v2, s[8:11], s24 offen offset:0 sc1 lds
  buffer_load_dwordx4 v2, s[8:11], s24 offen offset:1024 sc1 lds
  buffer_load_dwordx4 v2, s[8:11], s24 offen offset:2048 sc1 lds
  buffer_load_dwordx4 v2, s[8:11], s24 offen offset:3072 sc1 lds
  s_add_u32 m0, m0, 4096
  s_add_u32 s24, s24, 4096
  buffer_load_dwordx4 v2, s[8:11], s24 offen offset:0 sc1 lds
  buffer_load_dwordx4 v2, s[8:11], s24 offen offset:1024 sc1 lds
  buffer_load_dwordx4 v2, s[8:11], s24 offen offset:2048 sc1 lds
  v_add_u32 v5, s32, v2
  ds_read_b128 v[8:11], v5 offset:0
  ds_read_b128 v[12:15], v5 offset:14336
  ds_read_b128 v[16:19], v5 offset:1024
  ds_read_b128 v[20:23], v5 offset:15360
  ds_read_b128 v[24:27], v5 offset:2048
  ds_read_b128 v[28:31], v5 offset:16384
  ds_read_b128 v[32:35], v5 offset:3072
  s_waitcnt lgkmcnt(6)
  v_mfma_f32_16x16x32_bf16 v[40:43], a[0:3], v[8:11], 0
  v_mfma_f32_16x16x32_bf16 v[44:47], a[56:59], v[8:11], 0
  ds_read_b128 v[36:39], v5 offset:17408
  s_waitcnt lgkmcnt(6)
  v_mfma_f32_16x16x32_bf16 v[56:59], a[0:3], v[12:15], 0
  v_mfma_f32_16x16x32_bf16 v[60:63], a[56:59], v[12:15], 0
  ds_read_b128 v[8:11], v5 offset:4096
  s_waitcnt lgkmcnt(6)
  v_mfma_f32_16x16x32_bf16 v[40:43], a[4:7], v[16:19], v[40:43]
  v_mfma_f32_16x16x32_bf16 v[44:47], a[60:63], v[16:19], v[44:47]
  ds_read_b128 v[12:15], v5 offset:18432
  s_waitcnt lgkmcnt(6)
  v_mfma_f32_16x16x32_bf16 v[56:59], a[4:7], v[20:23], v[56:59]
  v_mfma_f32_16x16x32_bf16 v[60:63], a[60:63], v[20:23], v[60:63]
  ds_read_b128 v[16:19], v5 offset:5120
  s_waitcnt lgkmcnt(6)
  v_mfma_f32_16x16x32_bf16 v[40:43], a[8:11], v[24:27], v[40:43]
  v_mfma_f32_16x16x32_bf16 v[44:47], a[64:67], v[24:27], v[44:47]
  ds_read_b128 v[20:23], v5 offset:19456
  s_waitcnt lgkmcnt(6)
  v_mfma_f32_16x16x32_bf16 v[56:59], a[8:11], v[28:31], v[56:59]
  v_mfma_f32_16x16x32_bf16 v[60:63], a[64:67], v[28:31], v[60:63]
  ds_read_b128 v[24:27], v5 offset:6144
  s_waitcnt lgkmcnt(6)
  v_mfma_f32_16x16x32_bf16 v[40:43], a[12:15], v[32:35], v[40:43]
  v_mfma_f32_16x16x32_bf16 v[44:47], a[68:71], v[32:35], v[44:47]
  ds_read_b128 v[28:31], v5 offset:20480
  s_waitcnt lgkmcnt(6)
  v_mfma_f32_16x16x32_bf16 v[56:59], a[12:15], v[36:39], v[56:59]
  v_mfma_f32_16x16x32_bf16 v[60:63], a[68:71], v[36:39], v[60:63]
  ds_read_b128 v[32:35], v5 offset:7168
  s_waitcnt lgkmcnt(6)
  v_mfma_f32_16x16x32_bf16 v[40:43], a[16:19], v[8:11], v[40:43]
  v_mfma_f32_16x16x32_bf16 v[44:47], a[72:75], v[8:11], v[44:47]
  ds_read_b128 v[36:39], v5 offset:21504
  s_waitcnt lgkmcnt(6)
  v_mfma_f32_16x16x32_bf16 v[56:59], a[16:19], v[12:15], v[56:59]
  v_mfma_f32_16x16x32_bf16 v[60:63], a[72:75], v[12:15], v[60:63]
  ds_read_b128 v[8:11], v5 offset:8192
  s_waitcnt lgkmcnt(6)
  v_mfma_f32_16x16x32_bf16 v[40:43], a[20:23], v[16:19], v[40:43]
  v_mfma_f32_16x16x32_bf16 v[44:47], a[76:79], v[16:19], v[44:47]
  ds_read_b128 v[12:15], v5 offset:22528
  s_waitcnt lgkmcnt(6)
  v_mfma_f32_16x16x32_bf16 v[56:59], a[20:23], v[20:23], v[56:59]
  v_mfma_f32_16x16x32_bf16 v[60:63], a[76:79], v[20:23], v[60:63]
  ds_read_b128 v[16:19], v5 offset:9216
  s_waitcnt lgkmcnt(6)
  v_mfma_f32_16x16x32_bf16 v[40:43], a[24:27], v[24:27], v[40:43]
  v_mfma_f32_16x16x32_bf16 v[44:47], a[80:83], v[24:27], v[44:47]
  ds_read_b128 v[20:23], v5 offset:23552
  s_waitcnt lgkmcnt(6)
  v_mfma_f32_16x16x32_bf16 v[56:59], a[24:27], v[28:31], v[56:59]
  v_mfma_f32_16x16x32_bf16 v[60:63], a[80:83], v[28:31], v[60:63]
  ds_read_b128 v[24:27], v5 offset:10240
  s_waitcnt lgkmcnt(6)
  v_mfma_f32_16x16x32_bf16 v[40:43], a[28:31], v[32:35], v[40:43]
  v_mfma_f32_16x16x32_bf16 v[44:47], a[84:87], v[32:35], v[44:47]
  ds_read_b128 v[28:31], v5 offset:24576
  s_waitcnt lgkmcnt(6)
  v_mfma_f32_16x16x32_bf16 v[56:59], a[28:31], v[36:39], v[56:59]
  v_mfma_f32_16x16x32_bf16 v[60:63], a[84:87], v[36:39], v[60:63]
  ds_read_b128 v[32:35], v5 offset:11264
  s_waitcnt lgkmcnt(6)
  v_mfma_f32_16x16x32_bf16 v[40:43], a[32:35], v[8:11], v[40:43]
  v_mfma_f32_16x16x32_bf16 v[44:47], a[88:91], v[8:11], v[44:47]
  ds_read_b128 v[36:39], v5 offset:25600
  s_waitcnt lgkmcnt(6)
  v_mfma_f32_16x16x32_bf16 v[56:59], a[32:35], v[12:15], v[56:59]
  v_mfma_f32_16x16x32_bf16 v[60:63], a[88:91], v[12:15], v[60:63]
  ds_read_b128 v[8:11], v5 offset:12288
  s_waitcnt lgkmcnt(6)
  v_mfma_f32_16x16x32_bf16 v[40:43], a[36:39], v[16:19], v[40:43]
  v_mfma_f32_16x16x32_bf16 v[44:47], a[92:95], v[16:19], v[44:47]
  ds_read_b128 v[12:15], v5 offset:26624
  s_waitcnt lgkmcnt(6)
  v_mfma_f32_16x16x32_bf16 v[56:59], a[36:39], v[20:23], v[56:59]
  v_mfma_f32_16x16x32_bf16 v[60:63], a[92:95], v[20:23], v[60:63]
  ds_read_b128 v[16:19], v5 offset:13312
  s_waitcnt lgkmcnt(6)
  v_mfma_f32_16x16x32_bf16 v[40:43], a[40:43], v[24:27], v[40:43]
  v_mfma_f32_16x16x32_bf16 v[44:47], a[96:99], v[24:27], v[44:47]
  ds_read_b128 v[20:23], v5 offset:27648
  s_waitcnt lgkmcnt(6)
  v_mfma_f32_16x16x32_bf16 v[56:59], a[40:43], v[28:31], v[56:59]
  v_mfma_f32_16x16x32_bf16 v[60:63], a[96:99], v[28:31], v[60:63]
  s_waitcnt lgkmcnt(5)
  v_mfma_f32_16x16x32_bf16 v[40:43], a[44:47], v[32:35], v[40:43]
  v_mfma_f32_16x16x32_bf16 v[44:47], a[100:103], v[32:35], v[44:47]
  s_waitcnt lgkmcnt(4)
  v_mfma_f32_16x16x32_bf16 v[56:59], a[44:47], v[36:39], v[56:59]
  v_mfma_f32_16x16x32_bf16 v[60:63], a[100:103], v[36:39], v[60:63]
  s_waitcnt lgkmcnt(3)
  v_mfma_f32_16x16x32_bf16 v[40:43], a[48:51], v[8:11], v[40:43]
  v_mfma_f32_16x16x32_bf16 v[44:47], a[104:107], v[8:11], v[44:47]
  s_waitcnt lgkmcnt(2)
  v_mfma_f32_16x16x32_bf16 v[56:59], a[48:51], v[12:15], v[56:59]
  v_mfma_f32_16x16x32_bf16 v[60:63], a[104:107], v[12:15], v[60:63]
  s_waitcnt lgkmcnt(1)
  v_mfma_f32_16x16x32_bf16 v[40:43], a[52:55], v[16:19], v[40:43]
  v_mfma_f32_16x16x32_bf16 v[44:47], a[108:111], v[16:19], v[44:47]
  s_waitcnt lgkmcnt(0)
  v_mfma_f32_16x16x32_bf16 v[56:59], a[52:55], v[20:23], v[56:59]
  v_mfma_f32_16x16x32_bf16 v[60:63], a[108:111], v[20:23], v[60:63]
  s_add_u32 s25, s29, 28672
  s_lshl_b32 s24, s19, 5
  s_add_u32 s24, s24, 0
  v_add_u32 v88, s24, v4
  v_mul_u32_u24 v89, 2341, v88
  v_lshrrev_b32 v89, 16, v89
  v_mul_u32_u24 v89, 84, v89
  v_add3_u32 v88, v88, v89, v6
  v_lshlrev_b32 v90, 4, v88
  v_cvt_pk_bf16_f32 v72, v40, v41
  v_cvt_pk_bf16_f32 v73, v42, v43
  v_cvt_pk_bf16_f32 v74, v44, v45
  v_cvt_pk_bf16_f32 v75, v46, v47
  buffer_store_dwordx4 v[72:75], v90, s[8:11], s29 offen sc1
  s_lshl_b32 s24, s19, 5
  s_add_u32 s24, s24, 16
  v_add_u32 v88, s24, v4
  v_mul_u32_u24 v89, 2341, v88
  v_lshrrev_b32 v89, 16, v89
  v_mul_u32_u24 v89, 84, v89
  v_add3_u32 v88, v88, v89, v6
  v_lshlrev_b32 v91, 4, v88
  v_cvt_pk_bf16_f32 v80, v56, v57
  v_cvt_pk_bf16_f32 v81, v58, v59
  v_cvt_pk_bf16_f32 v82, v60, v61
  v_cvt_pk_bf16_f32 v83, v62, v63
  buffer_store_dwordx4 v[80:83], v91, s[8:11], s29 offen sc1
  s_mov_b32 s33, s32
  s_add_u32 s32, s32, 28672
  s_cmp_eq_u32 s32, 86016
  s_cselect_b32 s32, 0, s32
  s_add_u32 s19, s19, 1
  s_cmp_lt_u32 s19, s35
  s_cbranch_scc1 wf_vo_loop
  s_branch wf_done
wf_done:
  s_lshr_b32 s20, s18, 1
  s_lshl_b32 s20, s20, 4
  s_and_b32 s21, s17, 15
  s_add_u32 s20, s20, s21
  s_lshl_b32 s20, s20, 7
  s_cmp_lt_u32 s17, 16
  s_cselect_b32 s21, 16384, 0
  s_add_u32 s20, s20, s21
  s_add_u32 s20, s20, 88528896
  s_sub_u32 s21, s35, s34
  s_lshr_b32 s21, s21, 1
  v_mov_b32 v5, s21
  v_mov_b32 v6, 0
  s_waitcnt vmcnt(0)
  s_mov_b64 exec, 1
  s_cmp_lg_u32 s18, 0
  s_cbranch_scc1 wf_h1
  v_mov_b32 v7, 2
  s_sub_u32 s21, s20, 2048
  buffer_atomic_add v7, v6, s[8:11], s21 offen
wf_h1:
  buffer_atomic_add v5, v6, s[8:11], s20 offen
  s_mov_b64 exec, -1
  s_branch wk_loop
wk_v7:
  s_sub_u32 s20, s3, 224
  s_mov_b32 s18, 1
  s_and_b32 s17, s20, 15
  s_add_u32 s17, s17, 16
  s_lshr_b32 s34, s20, 4
  s_lshl_b32 s34, s34, 1
  s_add_u32 s35, s34, 2
  s_branch wk_gemm
wk_vh:
  s_sub_u32 s20, s3, 496
  s_and_b32 s17, s20, 15
  s_add_u32 s17, s17, 16
  s_lshr_b32 s18, s20, 5
  s_add_u32 s18, s18, 2
  s_bitcmp1_b32 s20, 4
  s_cselect_b32 s34, 7, 0
  s_add_u32 s35, s34, 7
  s_branch wk_gemm
wk_vf:
  s_sub_u32 s20, s3, 560
  s_and_b32 s17, s20, 15
  s_add_u32 s17, s17, 16
  s_lshr_b32 s18, s20, 4
  s_add_u32 s18, s18, 4
  s_mov_b32 s34, 0
  s_mov_b32 s35, 14
  s_branch wk_gemm
wk_f:
  s_sub_u32 s20, s3, 736
  s_and_b32 s17, s20, 15
  s_lshr_b32 s18, s20, 4
  s_mov_b32 s34, 0
  s_mov_b32 s35, 14
  s_lshl_b32 s22, s17, 7
  s_add_u32 s22, s22, 88621056
  v_min_u32 v24, 96, v2
  s_mov_b32 s30, 0
wk_aw:
  buffer_load_dwordx4 v[28:31], v24, s[8:11], s22 offen sc1
  s_waitcnt vmcnt(0)
  v_cmp_ne_u64 vcc, s[88:89], v[28:29]
  s_cbranch_vccnz wk_aw_no
  v_cmp_ne_u64 vcc, s[88:89], v[30:31]
  s_cbranch_vccnz wk_aw_no
  s_branch wk_aw_ok
wk_aw_no:
  s_sleep 6
  s_add_u32 s30, s30, 1
  s_cmp_lt_u32 s30, 50000
  s_cbranch_scc1 wk_aw
  s_branch cA_abort
wk_aw_ok:
wk_gemm:
  s_lshl_b32 s20, s18, 4
  s_lshl_b32 s21, s16, 2
  s_add_u32 s20, s20, s21
  s_mul_i32 s21, s20, 14336
  s_add_u32 s21, s21, 71565312
  s_add_u32 s22, s21, 0
  buffer_load_dwordx4 a[0:3], v2, s[8:11], s22 offen offset:0 sc1
  buffer_load_dwordx4 a[4:7], v2, s[8:11], s22 offen offset:1024 sc1
  buffer_load_dwordx4 a[8:11], v2, s[8:11], s22 offen offset:2048 sc1
  buffer_load_dwordx4 a[12:15], v2, s[8:11], s22 offen offset:3072 sc1
  s_add_u32 s22, s21, 4096
  buffer_load_dwordx4 a[16:19], v2, s[8:11], s22 offen offset:0 sc1
  buffer_load_dwordx4 a[20:23], v2, s[8:11], s22 offen offset:1024 sc1
  buffer_load_dwordx4 a[24:27], v2, s[8:11], s22 offen offset:2048 sc1
  buffer_load_dwordx4 a[28:31], v2, s[8:11], s22 offen offset:3072 sc1
  s_add_u32 s22, s21, 8192
  buffer_load_dwordx4 a[32:35], v2, s[8:11], s22 offen offset:0 sc1
  buffer_load_dwordx4 a[36:39], v2, s[8:11], s22 offen offset:1024 sc1
  buffer_load_dwordx4 a[40:43], v2, s[8:11], s22 offen offset:2048 sc1
  buffer_load_dwordx4 a[44:47], v2, s[8:11], s22 offen offset:3072 sc1
  s_add_u32 s22, s21, 12288
  buffer_load_dwordx4 a[48:51], v2, s[8:11], s22 offen offset:0 sc1
  buffer_load_dwordx4 a[52:55], v2, s[8:11], s22 offen offset:1024 sc1
  buffer_load_dwordx4 a[56:59], v2, s[8:11], s22 offen offset:2048 sc1
  buffer_load_dwordx4 a[60:63], v2, s[8:11], s22 offen offset:3072 sc1
  s_add_u32 s22, s21, 16384
  buffer_load_dwordx4 a[64:67], v2, s[8:11], s22 offen offset:0 sc1
  buffer_load_dwordx4 a[68:71], v2, s[8:11], s22 offen offset:1024 sc1
  buffer_load_dwordx4 a[72:75], v2, s[8:11], s22 offen offset:2048 sc1
  buffer_load_dwordx4 a[76:79], v2, s[8:11], s22 offen offset:3072 sc1
  s_add_u32 s22, s21, 20480
  buffer_load_dwordx4 a[80:83], v2, s[8:11], s22 offen offset:0 sc1
  buffer_load_dwordx4 a[84:87], v2, s[8:11], s22 offen offset:1024 sc1
  buffer_load_dwordx4 a[88:91], v2, s[8:11], s22 offen offset:2048 sc1
  buffer_load_dwordx4 a[92:95], v2, s[8:11], s22 offen offset:3072 sc1
  s_add_u32 s22, s21, 24576
  buffer_load_dwordx4 a[96:99], v2, s[8:11], s22 offen offset:0 sc1
  buffer_load_dwordx4 a[100:103], v2, s[8:11], s22 offen offset:1024 sc1
  buffer_load_dwordx4 a[104:107], v2, s[8:11], s22 offen offset:2048 sc1
  buffer_load_dwordx4 a[108:111], v2, s[8:11], s22 offen offset:3072 sc1
  s_add_u32 s22, s21, 28672
  buffer_load_dwordx4 a[112:115], v2, s[8:11], s22 offen offset:0 sc1
  buffer_load_dwordx4 a[116:119], v2, s[8:11], s22 offen offset:1024 sc1
  buffer_load_dwordx4 a[120:123], v2, s[8:11], s22 offen offset:2048 sc1
  buffer_load_dwordx4 a[124:127], v2, s[8:11], s22 offen offset:3072 sc1
  s_add_u32 s22, s21, 32768
  buffer_load_dwordx4 a[128:131], v2, s[8:11], s22 offen offset:0 sc1
  buffer_load_dwordx4 a[132:135], v2, s[8:11], s22 offen offset:1024 sc1
  buffer_load_dwordx4 a[136:139], v2, s[8:11], s22 offen offset:2048 sc1
  buffer_load_dwordx4 a[140:143], v2, s[8:11], s22 offen offset:3072 sc1
  s_add_u32 s22, s21, 36864
  buffer_load_dwordx4 a[144:147], v2, s[8:11], s22 offen offset:0 sc1
  buffer_load_dwordx4 a[148:151], v2, s[8:11], s22 offen offset:1024 sc1
  buffer_load_dwordx4 a[152:155], v2, s[8:11], s22 offen offset:2048 sc1
  buffer_load_dwordx4 a[156:159], v2, s[8:11], s22 offen offset:3072 sc1
  s_add_u32 s22, s21, 40960
  buffer_load_dwordx4 a[160:163], v2, s[8:11], s22 offen offset:0 sc1
  buffer_load_dwordx4 a[164:167], v2, s[8:11], s22 offen offset:1024 sc1
  buffer_load_dwordx4 a[168:171], v2, s[8:11], s22 offen offset:2048 sc1
  buffer_load_dwordx4 a[172:175], v2, s[8:11], s22 offen offset:3072 sc1
  s_add_u32 s22, s21, 45056
  buffer_load_dwordx4 a[176:179], v2, s[8:11], s22 offen offset:0 sc1
  buffer_load_dwordx4 a[180:183], v2, s[8:11], s22 offen offset:1024 sc1
  buffer_load_dwordx4 a[184:187], v2, s[8:11], s22 offen offset:2048 sc1
  buffer_load_dwordx4 a[188:191], v2, s[8:11], s22 offen offset:3072 sc1
  s_add_u32 s22, s21, 49152
  buffer_load_dwordx4 a[192:195], v2, s[8:11], s22 offen offset:0 sc1
  buffer_load_dwordx4 a[196:199], v2, s[8:11], s22 offen offset:1024 sc1
  buffer_load_dwordx4 a[200:203], v2, s[8:11], s22 offen offset:2048 sc1
  buffer_load_dwordx4 a[204:207], v2, s[8:11], s22 offen offset:3072 sc1
  s_add_u32 s22, s21, 53248
  buffer_load_dwordx4 a[208:211], v2, s[8:11], s22 offen offset:0 sc1
  buffer_load_dwordx4 a[212:215], v2, s[8:11], s22 offen offset:1024 sc1
  buffer_load_dwordx4 a[216:219], v2, s[8:11], s22 offen offset:2048 sc1
  buffer_load_dwordx4 a[220:223], v2, s[8:11], s22 offen offset:3072 sc1
  s_waitcnt vmcnt(40)
  s_mul_i32 s23, s17, 401408
  s_and_b32 s22, s16, 1
  s_mul_i32 s22, s22, 7168
  s_add_u32 s23, s23, s22
  s_add_u32 s23, s23, 0
  s_lshr_b32 s22, s16, 1
  s_mul_i32 s22, s22, 14336
  s_add_u32 s23, s23, s22
  s_mul_i32 s27, s16, 7168
  s_lshr_b32 s28, s20, 1
  s_cmp_lt_u32 s17, 16
  s_cbranch_scc0 wg_vo
  s_add_u32 s23, s23, s22
  s_lshl_b32 s29, s28, 4
  s_add_u32 s29, s29, s17
  s_mul_i32 s29, s29, 28672
  s_add_u32 s29, s29, 12845056
  s_mov_b32 s31, 0
  s_lshr_b32 s24, s34, 1
  s_lshl_b32 s24, s24, 2
  s_and_b32 s25, s34, 1
  s_add_u32 s24, s24, s25
  s_mul_i32 s24, s24, 14336
  s_add_u32 s24, s24, s23
  s_cmp_lt_u32 s34, s35
  s_cselect_b32 s24, s24, 0x10000000
  s_add_u32 m0, s31, s27
  s_nop 0
  buffer_load_dwordx4 v2, s[8:11], s24 offen offset:0 sc1 lds
  buffer_load_dwordx4 v2, s[8:11], s24 offen offset:1024 sc1 lds
  buffer_load_dwordx4 v2, s[8:11], s24 offen offset:2048 sc1 lds
  buffer_load_dwordx4 v2, s[8:11], s24 offen offset:3072 sc1 lds
  s_add_u32 m0, m0, 4096
  s_add_u32 s24, s24, 4096
  buffer_load_dwordx4 v2, s[8:11], s24 offen offset:0 sc1 lds
  buffer_load_dwordx4 v2, s[8:11], s24 offen offset:1024 sc1 lds
  buffer_load_dwordx4 v2, s[8:11], s24 offen offset:2048 sc1 lds
  s_add_u32 s30, s34, 1
  s_mov_b32 s31, 28672
  s_lshr_b32 s24, s30, 1
  s_lshl_b32 s24, s24, 2
  s_and_b32 s25, s30, 1
  s_add_u32 s24, s24, s25
  s_mul_i32 s24, s24, 14336
  s_add_u32 s24, s24, s23
  s_cmp_lt_u32 s30, s35
  s_cselect_b32 s24, s24, 0x10000000
  s_add_u32 m0, s31, s27
  s_nop 0
  buffer_load_dwordx4 v2, s[8:11], s24 offen offset:0 sc1 lds
  buffer_load_dwordx4 v2, s[8:11], s24 offen offset:1024 sc1 lds
  buffer_load_dwordx4 v2, s[8:11], s24 offen offset:2048 sc1 lds
  buffer_load_dwordx4 v2, s[8:11], s24 offen offset:3072 sc1 lds
  s_add_u32 m0, m0, 4096
  s_add_u32 s24, s24, 4096
  buffer_load_dwordx4 v2, s[8:11], s24 offen offset:0 sc1 lds
  buffer_load_dwordx4 v2, s[8:11], s24 offen offset:1024 sc1 lds
  buffer_load_dwordx4 v2, s[8:11], s24 offen offset:2048 sc1 lds
  s_mov_b32 s19, s34
  s_mov_b32 s32, 0
  s_mov_b32 s33, 57344
  s_waitcnt vmcnt(7)
  s_branch wg_f_in
wg_f_loop:
  s_waitcnt vmcnt(11)
wg_f_in:
  s_barrier
  s_add_u32 s30, s19, 2
  s_lshr_b32 s24, s30, 1
  s_lshl_b32 s24, s24, 2
  s_and_b32 s25, s30, 1
  s_add_u32 s24, s24, s25
  s_mul_i32 s24, s24, 14336
  s_add_u32 s24, s24, s23
  s_cmp_lt_u32 s30, s35
  s_cselect_b32 s24, s24, 0x10000000
  s_add_u32 m0, s33, s27
  s_nop 0
  buffer_load_dwordx4 v2, s[8:11], s24 offen offset:0 sc1 lds
  buffer_load_dwordx4 v2, s[8:11], s24 offen offset:1024 sc1 lds
  buffer_load_dwordx4 v2, s[8:11], s24 offen offset:2048 sc1 lds
  buffer_load_dwordx4 v2, s[8:11], s24 offen offset:3072 sc1 lds
  s_add_u32 m0, m0, 4096
  s_add_u32 s24, s24, 4096
  buffer_load_dwordx4 v2, s[8:11], s24 offen offset:0 sc1 lds
  buffer_load_dwordx4 v2, s[8:11], s24 offen offset:1024 sc1 lds
  buffer_load_dwordx4 v2, s[8:11], s24 offen offset:2048 sc1 lds
  v_add_u32 v5, s32, v2
  ds_read_b128 v[8:11], v5 offset:0
  ds_read_b128 v[12:15], v5 offset:14336
  ds_read_b128 v[16:19], v5 offset:1024
  ds_read_b128 v[20:23], v5 offset:15360
  ds_read_b128 v[24:27], v5 offset:2048
  ds_read_b128 v[28:31], v5 offset:16384
  ds_read_b128 v[32:35], v5 offset:3072
  s_waitcnt lgkmcnt(6)
  v_mfma_f32_16x16x32_bf16 v[40:43], v[8:11], a[0:3], 0
  v_mfma_f32_16x16x32_bf16 v[44:47], v[8:11], a[56:59], 0
  v_mfma_f32_16x16x32_bf16 v[48:51], v[8:11], a[112:115], 0
  v_mfma_f32_16x16x32_bf16 v[52:55], v[8:11], a[168:171], 0
  ds_read_b128 v[36:39], v5 offset:17408
  s_waitcnt lgkmcnt(6)
  v_mfma_f32_16x16x32_bf16 v[56:59], v[12:15], a[0:3], 0
  v_mfma_f32_16x16x32_bf16 v[60:63], v[12:15], a[56:59], 0
  v_mfma_f32_16x16x32_bf16 v[64:67], v[12:15], a[112:115], 0
  v_mfma_f32_16x16x32_bf16 v[68:71], v[12:15], a[168:171], 0
  ds_read_b128 v[8:11], v5 offset:4096
  s_waitcnt lgkmcnt(6)
  v_mfma_f32_16x16x32_bf16 v[40:43], v[16:19], a[4:7], v[40:43]
  v_mfma_f32_16x16x32_bf16 v[44:47], v[16:19], a[60:63], v[44:47]
  v_mfma_f32_16x16x32_bf16 v[48:51], v[16:19], a[116:119], v[48:51]
  v_mfma_f32_16x16x32_bf16 v[52:55], v[16:19], a[172:175], v[52:55]
  ds_read_b128 v[12:15], v5 offset:18432
  s_waitcnt lgkmcnt(6)
  v_mfma_f32_16x16x32_bf16 v[56:59], v[20:23], a[4:7], v[56:59]
  v_mfma_f32_16x16x32_bf16 v[60:63], v[20:23], a[60:63], v[60:63]
  v_mfma_f32_16x16x32_bf16 v[64:67], v[20:23], a[116:119], v[64:67]
  v_mfma_f32_16x16x32_bf16 v[68:71], v[20:23], a[172:175], v[68:71]
  ds_read_b128 v[16:19], v5 offset:5120
  s_waitcnt lgkmcnt(6)
  v_mfma_f32_16x16x32_bf16 v[40:43], v[24:27], a[8:11], v[40:43]
  v_mfma_f32_16x16x32_bf16 v[44:47], v[24:27], a[64:67], v[44:47]
  v_mfma_f32_16x16x32_bf16 v[48:51], v[24:27], a[120:123], v[48:51]
  v_mfma_f32_16x16x32_bf16 v[52:55], v[24:27], a[176:179], v[52:55]
  ds_read_b128 v[20:23], v5 offset:19456
  s_waitcnt lgkmcnt(6)
  v_mfma_f32_16x16x32_bf16 v[56:59], v[28:31], a[8:11], v[56:59]
  v_mfma_f32_16x16x32_bf16 v[60:63], v[28:31], a[64:67], v[60:63]
  v_mfma_f32_16x16x32_bf16 v[64:67], v[28:31], a[120:123], v[64:67]
  v_mfma_f32_16x16x32_bf16 v[68:71], v[28:31], a[176:179], v[68:71]
  ds_read_b128 v[24:27], v5 offset:6144
  s_waitcnt lgkmcnt(6)
  v_mfma_f32_16x16x32_bf16 v[40:43], v[32:35], a[12:15], v[40:43]
  v_mfma_f32_16x16x32_bf16 v[44:47], v[32:35], a[68:71], v[44:47]
  v_mfma_f32_16x16x32_bf16 v[48:51], v[32:35], a[124:127], v[48:51]
  v_mfma_f32_16x16x32_bf16 v[52:55], v[32:35], a[180:183], v[52:55]
  ds_read_b128 v[28:31], v5 offset:20480
  s_waitcnt lgkmcnt(6)
  v_mfma_f32_16x16x32_bf16 v[56:59], v[36:39], a[12:15], v[56:59]
  v_mfma_f32_16x16x32_bf16 v[60:63], v[36:39], a[68:71], v[60:63]
  v_mfma_f32_16x16x32_bf16 v[64:67], v[36:39], a[124:127], v[64:67]
  v_mfma_f32_16x16x32_bf16 v[68:71], v[36:39], a[180:183], v[68:71]
  ds_read_b128 v[32:35], v5 offset:7168
  s_waitcnt lgkmcnt(6)
  v_mfma_f32_16x16x32_bf16 v[40:43], v[8:11], a[16:19], v[40:43]
  v_mfma_f32_16x16x32_bf16 v[44:47], v[8:11], a[72:75], v[44:47]
  v_mfma_f32_16x16x32_bf16 v[48:51], v[8:11], a[128:131], v[48:51]
  v_mfma_f32_16x16x32_bf16 v[52:55], v[8:11], a[184:187], v[52:55]
  ds_read_b128 v[36:39], v5 offset:21504
  s_waitcnt lgkmcnt(6)
  v_mfma_f32_16x16x32_bf16 v[56:59], v[12:15], a[16:19], v[56:59]
  v_mfma_f32_16x16x32_bf16 v[60:63], v[12:15], a[72:75], v[60:63]
  v_mfma_f32_16x16x32_bf16 v[64:67], v[12:15], a[128:131], v[64:67]
  v_mfma_f32_16x16x32_bf16 v[68:71], v[12:15], a[184:187], v[68:71]
  ds_read_b128 v[8:11], v5 offset:8192
  s_waitcnt lgkmcnt(6)
  v_mfma_f32_16x16x32_bf16 v[40:43], v[16:19], a[20:23], v[40:43]
  v_mfma_f32_16x16x32_bf16 v[44:47], v[16:19], a[76:79], v[44:47]
  v_mfma_f32_16x16x32_bf16 v[48:51], v[16:19], a[132:135], v[48:51]
  v_mfma_f32_16x16x32_bf16 v[52:55], v[16:19], a[188:191], v[52:55]
  ds_read_b128 v[12:15], v5 offset:22528
  s_waitcnt lgkmcnt(6)
  v_mfma_f32_16x16x32_bf16 v[56:59], v[20:23], a[20:23], v[56:59]
  v_mfma_f32_16x16x32_bf16 v[60:63], v[20:23], a[76:79], v[60:63]
  v_mfma_f32_16x16x32_bf16 v[64:67], v[20:23], a[132:135], v[64:67]
  v_mfma_f32_16x16x32_bf16 v[68:71], v[20:23], a[188:191], v[68:71]
  ds_read_b128 v[16:19], v5 offset:9216
  s_waitcnt lgkmcnt(6)
  v_mfma_f32_16x16x32_bf16 v[40:43], v[24:27], a[24:27], v[40:43]
  v_mfma_f32_16x16x32_bf16 v[44:47], v[24:27], a[80:83], v[44:47]
  v_mfma_f32_16x16x32_bf16 v[48:51], v[24:27], a[136:139], v[48:51]
  v_mfma_f32_16x16x32_bf16 v[52:55], v[24:27], a[192:195], v[52:55]
  ds_read_b128 v[20:23], v5 offset:23552
  s_waitcnt lgkmcnt(6)
  v_mfma_f32_16x16x32_bf16 v[56:59], v[28:31], a[24:27], v[56:59]
  v_mfma_f32_16x16x32_bf16 v[60:63], v[28:31], a[80:83], v[60:63]
  v_mfma_f32_16x16x32_bf16 v[64:67], v[28:31], a[136:139], v[64:67]
  v_mfma_f32_16x16x32_bf16 v[68:71], v[28:31], a[192:195], v[68:71]
  ds_read_b128 v[24:27], v5 offset:10240
  s_waitcnt lgkmcnt(6)
  v_mfma_f32_16x16x32_bf16 v[40:43], v[32:35], a[28:31], v[40:43]
  v_mfma_f32_16x16x32_bf16 v[44:47], v[32:35], a[84:87], v[44:47]
  v_mfma_f32_16x16x32_bf16 v[48:51], v[32:35], a[140:143], v[48:51]
  v_mfma_f32_16x16x32_bf16 v[52:55], v[32:35], a[196:199], v[52:55]
  ds_read_b128 v[28:31], v5 offset:24576
  s_waitcnt lgkmcnt(6)
  v_mfma_f32_16x16x32_bf16 v[56:59], v[36:39], a[28:31], v[56:59]
  v_mfma_f32_16x16x32_bf16 v[60:63], v[36:39], a[84:87], v[60:63]
  v_mfma_f32_16x16x32_bf16 v[64:67], v[36:39], a[140:143], v[64:67]
  v_mfma_f32_16x16x32_bf16 v[68:71], v[36:39], a[196:199], v[68:71]
  ds_read_b128 v[32:35], v5 offset:11264
  s_waitcnt lgkmcnt(6)
  v_mfma_f32_16x16x32_bf16 v[40:43], v[8:11], a[32:35], v[40:43]
  v_mfma_f32_16x16x32_bf16 v[44:47], v[8:11], a[88:91], v[44:47]
  v_mfma_f32_16x16x32_bf16 v[48:51], v[8:11], a[144:147], v[48:51]
  v_mfma_f32_16x16x32_bf16 v[52:55], v[8:11], a[200:203], v[52:55]
  ds_read_b128 v[36:39], v5 offset:25600
  s_waitcnt lgkmcnt(6)
  v_mfma_f32_16x16x32_bf16 v[56:59], v[12:15], a[32:35], v[56:59]
  v_mfma_f32_16x16x32_bf16 v[60:63], v[12:15], a[88:91], v[60:63]
  v_mfma_f32_16x16x32_bf16 v[64:67], v[12:15], a[144:147], v[64:67]
  v_mfma_f32_16x16x32_bf16 v[68:71], v[12:15], a[200:203], v[68:71]
  ds_read_b128 v[8:11], v5 offset:12288
  s_waitcnt lgkmcnt(6)
  v_mfma_f32_16x16x32_bf16 v[40:43], v[16:19], a[36:39], v[40:43]
  v_mfma_f32_16x16x32_bf16 v[44:47], v[16:19], a[92:95], v[44:47]
  v_mfma_f32_16x16x32_bf16 v[48:51], v[16:19], a[148:151], v[48:51]
  v_mfma_f32_16x16x32_bf16 v[52:55], v[16:19], a[204:207], v[52:55]
  ds_read_b128 v[12:15], v5 offset:26624
  s_waitcnt lgkmcnt(6)
  v_mfma_f32_16x16x32_bf16 v[56:59], v[20:23], a[36:39], v[56:59]
  v_mfma_f32_16x16x32_bf16 v[60:63], v[20:23], a[92:95], v[60:63]
  v_mfma_f32_16x16x32_bf16 v[64:67], v[20:23], a[148:151], v[64:67]
  v_mfma_f32_16x16x32_bf16 v[68:71], v[20:23], a[204:207], v[68:71]
  ds_read_b128 v[16:19], v5 offset:13312
  s_waitcnt lgkmcnt(6)
  v_mfma_f32_16x16x32_bf16 v[40:43], v[24:27], a[40:43], v[40:43]
  v_mfma_f32_16x16x32_bf16 v[44:47], v[24:27], a[96:99], v[44:47]
  v_mfma_f32_16x16x32_bf16 v[48:51], v[24:27], a[152:155], v[48:51]
  v_mfma_f32_16x16x32_bf16 v[52:55], v[24:27], a[208:211], v[52:55]
  ds_read_b128 v[20:23], v5 offset:27648
  s_waitcnt lgkmcnt(6)
  v_mfma_f32_16x16x32_bf16 v[56:59], v[28:31], a[40:43], v[56:59]
  v_mfma_f32_16x16x32_bf16 v[60:63], v[28:31], a[96:99], v[60:63]
  v_mfma_f32_16x16x32_bf16 v[64:67], v[28:31], a[152:155], v[64:67]
  v_mfma_f32_16x16x32_bf16 v[68:71], v[28:31], a[208:211], v[68:71]
  s_waitcnt lgkmcnt(5)
  v_mfma_f32_16x16x32_bf16 v[40:43], v[32:35], a[44:47], v[40:43]
  v_mfma_f32_16x16x32_bf16 v[44:47], v[32:35], a[100:103], v[44:47]
  v_mfma_f32_16x16x32_bf16 v[48:51], v[32:35], a[156:159], v[48:51]
  v_mfma_f32_16x16x32_bf16 v[52:55], v[32:35], a[212:215], v[52:55]
  s_waitcnt lgkmcnt(4)
  v_mfma_f32_16x16x32_bf16 v[56:59], v[36:39], a[44:47], v[56:59]
  v_mfma_f32_16x16x32_bf16 v[60:63], v[36:39], a[100:103], v[60:63]
  v_mfma_f32_16x16x32_bf16 v[64:67], v[36:39], a[156:159], v[64:67]
  v_mfma_f32_16x16x32_bf16 v[68:71], v[36:39], a[212:215], v[68:71]
  s_waitcnt lgkmcnt(3)
  v_mfma_f32_16x16x32_bf16 v[40:43], v[8:11], a[48:51], v[40:43]
  v_mfma_f32_16x16x32_bf16 v[44:47], v[8:11], a[104:107], v[44:47]
  v_mfma_f32_16x16x32_bf16 v[48:51], v[8:11], a[160:163], v[48:51]
  v_mfma_f32_16x16x32_bf16 v[52:55], v[8:11], a[216:219], v[52:55]
  s_waitcnt lgkmcnt(2)
  v_mfma_f32_16x16x32_bf16 v[56:59], v[12:15], a[48:51], v[56:59]
  v_mfma_f32_16x16x32_bf16 v[60:63], v[12:15], a[104:107], v[60:63]
  v_mfma_f32_16x16x32_bf16 v[64:67], v[12:15], a[160:163], v[64:67]
  v_mfma_f32_16x16x32_bf16 v[68:71], v[12:15], a[216:219], v[68:71]
  s_waitcnt lgkmcnt(1)
  v_mfma_f32_16x16x32_bf16 v[40:43], v[16:19], a[52:55], v[40:43]
  v_mfma_f32_16x16x32_bf16 v[44:47], v[16:19], a[108:111], v[44:47]
  v_mfma_f32_16x16x32_bf16 v[48:51], v[16:19], a[164:167], v[48:51]
  v_mfma_f32_16x16x32_bf16 v[52:55], v[16:19], a[220:223], v[52:55]
  s_waitcnt lgkmcnt(0)
  v_mfma_f32_16x16x32_bf16 v[56:59], v[20:23], a[52:55], v[56:59]
  v_mfma_f32_16x16x32_bf16 v[60:63], v[20:23], a[108:111], v[60:63]
  v_mfma_f32_16x16x32_bf16 v[64:67], v[20:23], a[164:167], v[64:67]
  v_mfma_f32_16x16x32_bf16 v[68:71], v[20:23], a[220:223], v[68:71]
  s_lshl_b32 s24, s19, 10
  s_add_u32 s24, s24, s29
  v_cvt_pk_bf16_f32 v72, v40, v41
  v_cvt_pk_bf16_f32 v73, v42, v43
  v_cvt_pk_bf16_f32 v74, v56, v57
  v_cvt_pk_bf16_f32 v75, v58, v59
  s_add_u32 s25, s24, 0
  buffer_store_dwordx4 v[72:75], v2, s[8:11], s25 offen sc1
  v_cvt_pk_bf16_f32 v76, v44, v45
  v_cvt_pk_bf16_f32 v77, v46, v47
  v_cvt_pk_bf16_f32 v78, v60, v61
  v_cvt_pk_bf16_f32 v79, v62, v63
  s_add_u32 s25, s24, 14336
  buffer_store_dwordx4 v[76:79], v2, s[8:11], s25 offen sc1
  v_cvt_pk_bf16_f32 v80, v48, v49
  v_cvt_pk_bf16_f32 v81, v50, v51
  v_cvt_pk_bf16_f32 v82, v64, v65
  v_cvt_pk_bf16_f32 v83, v66, v67
  s_add_u32 s25, s24, 458752
  buffer_store_dwordx4 v[80:83], v2, s[8:11], s25 offen sc1
  v_cvt_pk_bf16_f32 v84, v52, v53
  v_cvt_pk_bf16_f32 v85, v54, v55
  v_cvt_pk_bf16_f32 v86, v68, v69
  v_cvt_pk_bf16_f32 v87, v70, v71
  s_add_u32 s25, s24, 473088
  buffer_store_dwordx4 v[84:87], v2, s[8:11], s25 offen sc1
  s_mov_b32 s33, s32
  s_add_u32 s32, s32, 28672
  s_cmp_eq_u32 s32, 86016
  s_cselect_b32 s32, 0, s32
  s_add_u32 s19, s19, 1
  s_cmp_lt_u32 s19, s35
  s_cbranch_scc1 wg_f_loop
  s_branch wg_done
wg_vo:
  s_sub_u32 s29, s17, 16
  s_lshl_b32 s29, s29, 6
  s_add_u32 s29, s29, s28
  s_mul_i32 s29, s29, 28672
  s_add_u32 s29, s29, 42205184
  v_mul_u32_u24 v6, 28, v3
  s_mov_b32 s31, 0
  s_lshl_b32 s24, s34, 1
  s_mul_i32 s24, s24, 14336
  s_add_u32 s24, s24, s23
  s_cmp_lt_u32 s34, s35
  s_cselect_b32 s24, s24, 0x10000000
  s_add_u32 m0, s31, s27
  s_nop 0
  buffer_load_dwordx4 v2, s[8:11], s24 offen offset:0 sc1 lds
  buffer_load_dwordx4 v2, s[8:11], s24 offen offset:1024 sc1 lds
  buffer_load_dwordx4 v2, s[8:11], s24 offen offset:2048 sc1 lds
  buffer_load_dwordx4 v2, s[8:11], s24 offen offset:3072 sc1 lds
  s_add_u32 m0, m0, 4096
  s_add_u32 s24, s24, 4096
  buffer_load_dwordx4 v2, s[8:11], s24 offen offset:0 sc1 lds
  buffer_load_dwordx4 v2, s[8:11], s24 offen offset:1024 sc1 lds
  buffer_load_dwordx4 v2, s[8:11], s24 offen offset:2048 sc1 lds
  s_add_u32 s30, s34, 1
  s_mov_b32 s31, 28672
  s_lshl_b32 s24, s30, 1
  s_mul_i32 s24, s24, 14336
  s_add_u32 s24, s24, s23
  s_cmp_lt_u32 s30, s35
  s_cselect_b32 s24, s24, 0x10000000
  s_add_u32 m0, s31, s27
  s_nop 0
  buffer_load_dwordx4 v2, s[8:11], s24 offen offset:0 sc1 lds
  buffer_load_dwordx4 v2, s[8:11], s24 offen offset:1024 sc1 lds
  buffer_load_dwordx4 v2, s[8:11], s24 offen offset:2048 sc1 lds
  buffer_load_dwordx4 v2, s[8:11], s24 offen offset:3072 sc1 lds
  s_add_u32 m0, m0, 4096
  s_add_u32 s24, s24, 4096
  buffer_load_dwordx4 v2, s[8:11], s24 offen offset:0 sc1 lds
  buffer_load_dwordx4 v2, s[8:11], s24 offen offset:1024 sc1 lds
  buffer_load_dwordx4 v2, s[8:11], s24 offen offset:2048 sc1 lds
  s_mov_b32 s19, s34
  s_mov_b32 s32, 0
  s_mov_b32 s33, 57344
  s_waitcnt vmcnt(7)
  s_branch wg_vo_in
wg_vo_loop:
  s_waitcnt vmcnt(11)
wg_vo_in:
  s_barrier
  s_add_u32 s30, s19, 2
  s_lshl_b32 s24, s30, 1
  s_mul_i32 s24, s24, 14336
  s_add_u32 s24, s24, s23
  s_cmp_lt_u32 s30, s35
  s_cselect_b32 s24, s24, 0x10000000
  s_add_u32 m0, s33, s27
  s_nop 0
  buffer_load_dwordx4 v2, s[8:11], s24 offen offset:0 sc1 lds
  buffer_load_dwordx4 v2, s[8:11], s24 offen offset:1024 sc1 lds
  buffer_load_dwordx4 v2, s[8:11], s24 offen offset:2048 sc1 lds
  buffer_load_dwordx4 v2, s[8:11], s24 offen offset:3072 sc1 lds
  s_add_u32 m0, m0, 4096
  s_add_u32 s24, s24, 4096
  buffer_load_dwordx4 v2, s[8:11], s24 offen offset:0 sc1 lds
  buffer_load_dwordx4 v2, s[8:11], s24 offen offset:1024 sc1 lds
  buffer_load_dwordx4 v2, s[8:11], s24 offen offset:2048 sc1 lds
  v_add_u32 v5, s32, v2
  ds_read_b128 v[8:11], v5 offset:0
  ds_read_b128 v[12:15], v5 offset:14336
  ds_read_b128 v[16:19], v5 offset:1024
  ds_read_b128 v[20:23], v5 offset:15360
  ds_read_b128 v[24:27], v5 offset:2048
  ds_read_b128 v[28:31], v5 offset:16384
  ds_read_b128 v[32:35], v5 offset:3072
  s_waitcnt lgkmcnt(6)
  v_mfma_f32_16x16x32_bf16 v[40:43], a[0:3], v[8:11], 0
  v_mfma_f32_16x16x32_bf16 v[44:47], a[56:59], v[8:11], 0
  v_mfma_f32_16x16x32_bf16 v[48:51], a[112:115], v[8:11], 0
  v_mfma_f32_16x16x32_bf16 v[52:55], a[168:171], v[8:11], 0
  ds_read_b128 v[36:39], v5 offset:17408
  s_waitcnt lgkmcnt(6)
  v_mfma_f32_16x16x32_bf16 v[56:59], a[0:3], v[12:15], 0
  v_mfma_f32_16x16x32_bf16 v[60:63], a[56:59], v[12:15], 0
  v_mfma_f32_16x16x32_bf16 v[64:67], a[112:115], v[12:15], 0
  v_mfma_f32_16x16x32_bf16 v[68:71], a[168:171], v[12:15], 0
  ds_read_b128 v[8:11], v5 offset:4096
  s_waitcnt lgkmcnt(6)
  v_mfma_f32_16x16x32_bf16 v[40:43], a[4:7], v[16:19], v[40:43]
  v_mfma_f32_16x16x32_bf16 v[44:47], a[60:63], v[16:19], v[44:47]
  v_mfma_f32_16x16x32_bf16 v[48:51], a[116:119], v[16:19], v[48:51]
  v_mfma_f32_16x16x32_bf16 v[52:55], a[172:175], v[16:19], v[52:55]
  ds_read_b128 v[12:15], v5 offset:18432
  s_waitcnt lgkmcnt(6)
  v_mfma_f32_16x16x32_bf16 v[56:59], a[4:7], v[20:23], v[56:59]
  v_mfma_f32_16x16x32_bf16 v[60:63], a[60:63], v[20:23], v[60:63]
  v_mfma_f32_16x16x32_bf16 v[64:67], a[116:119], v[20:23], v[64:67]
  v_mfma_f32_16x16x32_bf16 v[68:71], a[172:175], v[20:23], v[68:71]
  ds_read_b128 v[16:19], v5 offset:5120
  s_waitcnt lgkmcnt(6)
  v_mfma_f32_16x16x32_bf16 v[40:43], a[8:11], v[24:27], v[40:43]
  v_mfma_f32_16x16x32_bf16 v[44:47], a[64:67], v[24:27], v[44:47]
  v_mfma_f32_16x16x32_bf16 v[48:51], a[120:123], v[24:27], v[48:51]
  v_mfma_f32_16x16x32_bf16 v[52:55], a[176:179], v[24:27], v[52:55]
  ds_read_b128 v[20:23], v5 offset:19456
  s_waitcnt lgkmcnt(6)
  v_mfma_f32_16x16x32_bf16 v[56:59], a[8:11], v[28:31], v[56:59]
  v_mfma_f32_16x16x32_bf16 v[60:63], a[64:67], v[28:31], v[60:63]
  v_mfma_f32_16x16x32_bf16 v[64:67], a[120:123], v[28:31], v[64:67]
  v_mfma_f32_16x16x32_bf16 v[68:71], a[176:179], v[28:31], v[68:71]
  ds_read_b128 v[24:27], v5 offset:6144
  s_waitcnt lgkmcnt(6)
  v_mfma_f32_16x16x32_bf16 v[40:43], a[12:15], v[32:35], v[40:43]
  v_mfma_f32_16x16x32_bf16 v[44:47], a[68:71], v[32:35], v[44:47]
  v_mfma_f32_16x16x32_bf16 v[48:51], a[124:127], v[32:35], v[48:51]
  v_mfma_f32_16x16x32_bf16 v[52:55], a[180:183], v[32:35], v[52:55]
  ds_read_b128 v[28:31], v5 offset:20480
  s_waitcnt lgkmcnt(6)
  v_mfma_f32_16x16x32_bf16 v[56:59], a[12:15], v[36:39], v[56:59]
  v_mfma_f32_16x16x32_bf16 v[60:63], a[68:71], v[36:39], v[60:63]
  v_mfma_f32_16x16x32_bf16 v[64:67], a[124:127], v[36:39], v[64:67]
  v_mfma_f32_16x16x32_bf16 v[68:71], a[180:183], v[36:39], v[68:71]
  ds_read_b128 v[32:35], v5 offset:7168
  s_waitcnt lgkmcnt(6)
  v_mfma_f32_16x16x32_bf16 v[40:43], a[16:19], v[8:11], v[40:43]
  v_mfma_f32_16x16x32_bf16 v[44:47], a[72:75], v[8:11], v[44:47]
  v_mfma_f32_16x16x32_bf16 v[48:51], a[128:131], v[8:11], v[48:51]
  v_mfma_f32_16x16x32_bf16 v[52:55], a[184:187], v[8:11], v[52:55]
  ds_read_b128 v[36:39], v5 offset:21504
  s_waitcnt lgkmcnt(6)
  v_mfma_f32_16x16x32_bf16 v[56:59], a[16:19], v[12:15], v[56:59]
  v_mfma_f32_16x16x32_bf16 v[60:63], a[72:75], v[12:15], v[60:63]
  v_mfma_f32_16x16x32_bf16 v[64:67], a[128:131], v[12:15], v[64:67]
  v_mfma_f32_16x16x32_bf16 v[68:71], a[184:187], v[12:15], v[68:71]
  ds_read_b128 v[8:11], v5 offset:8192
  s_waitcnt lgkmcnt(6)
  v_mfma_f32_16x16x32_bf16 v[40:43], a[20:23], v[16:19], v[40:43]
  v_mfma_f32_16x16x32_bf16 v[44:47], a[76:79], v[16:19], v[44:47]
  v_mfma_f32_16x16x32_bf16 v[48:51], a[132:135], v[16:19], v[48:51]
  v_mfma_f32_16x16x32_bf16 v[52:55], a[188:191], v[16:19], v[52:55]
  ds_read_b128 v[12:15], v5 offset:22528
  s_waitcnt lgkmcnt(6)
  v_mfma_f32_16x16x32_bf16 v[56:59], a[20:23], v[20:23], v[56:59]
  v_mfma_f32_16x16x32_bf16 v[60:63], a[76:79], v[20:23], v[60:63]
  v_mfma_f32_16x16x32_bf16 v[64:67], a[132:135], v[20:23], v[64:67]
  v_mfma_f32_16x16x32_bf16 v[68:71], a[188:191], v[20:23], v[68:71]
  ds_read_b128 v[16:19], v5 offset:9216
  s_waitcnt lgkmcnt(6)
  v_mfma_f32_16x16x32_bf16 v[40:43], a[24:27], v[24:27], v[40:43]
  v_mfma_f32_16x16x32_bf16 v[44:47], a[80:83], v[24:27], v[44:47]
  v_mfma_f32_16x16x32_bf16 v[48:51], a[136:139], v[24:27], v[48:51]
  v_mfma_f32_16x16x32_bf16 v[52:55], a[192:195], v[24:27], v[52:55]
  ds_read_b128 v[20:23], v5 offset:23552
  s_waitcnt lgkmcnt(6)
  v_mfma_f32_16x16x32_bf16 v[56:59], a[24:27], v[28:31], v[56:59]
  v_mfma_f32_16x16x32_bf16 v[60:63], a[80:83], v[28:31], v[60:63]
  v_mfma_f32_16x16x32_bf16 v[64:67], a[136:139], v[28:31], v[64:67]
  v_mfma_f32_16x16x32_bf16 v[68:71], a[192:195], v[28:31], v[68:71]
  ds_read_b128 v[24:27], v5 offset:10240
  s_waitcnt lgkmcnt(6)
  v_mfma_f32_16x16x32_bf16 v[40:43], a[28:31], v[32:35], v[40:43]
  v_mfma_f32_16x16x32_bf16 v[44:47], a[84:87], v[32:35], v[44:47]
  v_mfma_f32_16x16x32_bf16 v[48:51], a[140:143], v[32:35], v[48:51]
  v_mfma_f32_16x16x32_bf16 v[52:55], a[196:199], v[32:35], v[52:55]
  ds_read_b128 v[28:31], v5 offset:24576
  s_waitcnt lgkmcnt(6)
  v_mfma_f32_16x16x32_bf16 v[56:59], a[28:31], v[36:39], v[56:59]
  v_mfma_f32_16x16x32_bf16 v[60:63], a[84:87], v[36:39], v[60:63]
  v_mfma_f32_16x16x32_bf16 v[64:67], a[140:143], v[36:39], v[64:67]
  v_mfma_f32_16x16x32_bf16 v[68:71], a[196:199], v[36:39], v[68:71]
  ds_read_b128 v[32:35], v5 offset:11264
  s_waitcnt lgkmcnt(6)
  v_mfma_f32_16x16x32_bf16 v[40:43], a[32:35], v[8:11], v[40:43]
  v_mfma_f32_16x16x32_bf16 v[44:47], a[88:91], v[8:11], v[44:47]
  v_mfma_f32_16x16x32_bf16 v[48:51], a[144:147], v[8:11], v[48:51]
  v_mfma_f32_16x16x32_bf16 v[52:55], a[200:203], v[8:11], v[52:55]
  ds_read_b128 v[36:39], v5 offset:25600
  s_waitcnt lgkmcnt(6)
  v_mfma_f32_16x16x32_bf16 v[56:59], a[32:35], v[12:15], v[56:59]
  v_mfma_f32_16x16x32_bf16 v[60:63], a[88:91], v[12:15], v[60:63]
  v_mfma_f32_16x16x32_bf16 v[64:67], a[144:147], v[12:15], v[64:67]
  v_mfma_f32_16x16x32_bf16 v[68:71], a[200:203], v[12:15], v[68:71]
  ds_read_b128 v[8:11], v5 offset:12288
  s_waitcnt lgkmcnt(6)
  v_mfma_f32_16x16x32_bf16 v[40:43], a[36:39], v[16:19], v[40:43]
  v_mfma_f32_16x16x32_bf16 v[44:47], a[92:95], v[16:19], v[44:47]
  v_mfma_f32_16x16x32_bf16 v[48:51], a[148:151], v[16:19], v[48:51]
  v_mfma_f32_16x16x32_bf16 v[52:55], a[204:207], v[16:19], v[52:55]
  ds_read_b128 v[12:15], v5 offset:26624
  s_waitcnt lgkmcnt(6)
  v_mfma_f32_16x16x32_bf16 v[56:59], a[36:39], v[20:23], v[56:59]
  v_mfma_f32_16x16x32_bf16 v[60:63], a[92:95], v[20:23], v[60:63]
  v_mfma_f32_16x16x32_bf16 v[64:67], a[148:151], v[20:23], v[64:67]
  v_mfma_f32_16x16x32_bf16 v[68:71], a[204:207], v[20:23], v[68:71]
  ds_read_b128 v[16:19], v5 offset:13312
  s_waitcnt lgkmcnt(6)
  v_mfma_f32_16x16x32_bf16 v[40:43], a[40:43], v[24:27], v[40:43]
  v_mfma_f32_16x16x32_bf16 v[44:47], a[96:99], v[24:27], v[44:47]
  v_mfma_f32_16x16x32_bf16 v[48:51], a[152:155], v[24:27], v[48:51]
  v_mfma_f32_16x16x32_bf16 v[52:55], a[208:211], v[24:27], v[52:55]
  ds_read_b128 v[20:23], v5 offset:27648
  s_waitcnt lgkmcnt(6)
  v_mfma_f32_16x16x32_bf16 v[56:59], a[40:43], v[28:31], v[56:59]
  v_mfma_f32_16x16x32_bf16 v[60:63], a[96:99], v[28:31], v[60:63]
  v_mfma_f32_16x16x32_bf16 v[64:67], a[152:155], v[28:31], v[64:67]
  v_mfma_f32_16x16x32_bf16 v[68:71], a[208:211], v[28:31], v[68:71]
  s_waitcnt lgkmcnt(5)
  v_mfma_f32_16x16x32_bf16 v[40:43], a[44:47], v[32:35], v[40:43]
  v_mfma_f32_16x16x32_bf16 v[44:47], a[100:103], v[32:35], v[44:47]
  v_mfma_f32_16x16x32_bf16 v[48:51], a[156:159], v[32:35], v[48:51]
  v_mfma_f32_16x16x32_bf16 v[52:55], a[212:215], v[32:35], v[52:55]
  s_waitcnt lgkmcnt(4)
  v_mfma_f32_16x16x32_bf16 v[56:59], a[44:47], v[36:39], v[56:59]
  v_mfma_f32_16x16x32_bf16 v[60:63], a[100:103], v[36:39], v[60:63]
  v_mfma_f32_16x16x32_bf16 v[64:67], a[156:159], v[36:39], v[64:67]
  v_mfma_f32_16x16x32_bf16 v[68:71], a[212:215], v[36:39], v[68:71]
  s_waitcnt lgkmcnt(3)
  v_mfma_f32_16x16x32_bf16 v[40:43], a[48:51], v[8:11], v[40:43]
  v_mfma_f32_16x16x32_bf16 v[44:47], a[104:107], v[8:11], v[44:47]
  v_mfma_f32_16x16x32_bf16 v[48:51], a[160:163], v[8:11], v[48:51]
  v_mfma_f32_16x16x32_bf16 v[52:55], a[216:219], v[8:11], v[52:55]
  s_waitcnt lgkmcnt(2)
  v_mfma_f32_16x16x32_bf16 v[56:59], a[48:51], v[12:15], v[56:59]
  v_mfma_f32_16x16x32_bf16 v[60:63], a[104:107], v[12:15], v[60:63]
  v_mfma_f32_16x16x32_bf16 v[64:67], a[160:163], v[12:15], v[64:67]
  v_mfma_f32_16x16x32_bf16 v[68:71], a[216:219], v[12:15], v[68:71]
  s_waitcnt lgkmcnt(1)
  v_mfma_f32_16x16x32_bf16 v[40:43], a[52:55], v[16:19], v[40:43]
  v_mfma_f32_16x16x32_bf16 v[44:47], a[108:111], v[16:19], v[44:47]
  v_mfma_f32_16x16x32_bf16 v[48:51], a[164:167], v[16:19], v[48:51]
  v_mfma_f32_16x16x32_bf16 v[52:55], a[220:223], v[16:19], v[52:55]
  s_waitcnt lgkmcnt(0)
  v_mfma_f32_16x16x32_bf16 v[56:59], a[52:55], v[20:23], v[56:59]
  v_mfma_f32_16x16x32_bf16 v[60:63], a[108:111], v[20:23], v[60:63]
  v_mfma_f32_16x16x32_bf16 v[64:67], a[164:167], v[20:23], v[64:67]
  v_mfma_f32_16x16x32_bf16 v[68:71], a[220:223], v[20:23], v[68:71]
  s_add_u32 s25, s29, 28672
  s_lshl_b32 s24, s19, 5
  s_add_u32 s24, s24, 0
  v_add_u32 v88, s24, v4
  v_mul_u32_u24 v89, 2341, v88
  v_lshrrev_b32 v89, 16, v89
  v_mul_u32_u24 v89, 84, v89
  v_add3_u32 v88, v88, v89, v6
  v_lshlrev_b32 v90, 4, v88
  v_cvt_pk_bf16_f32 v72, v40, v41
  v_cvt_pk_bf16_f32 v73, v42, v43
  v_cvt_pk_bf16_f32 v74, v44, v45
  v_cvt_pk_bf16_f32 v75, v46, v47
  buffer_store_dwordx4 v[72:75], v90, s[8:11], s29 offen sc1
  v_cvt_pk_bf16_f32 v76, v48, v49
  v_cvt_pk_bf16_f32 v77, v50, v51
  v_cvt_pk_bf16_f32 v78, v52, v53
  v_cvt_pk_bf16_f32 v79, v54, v55
  buffer_store_dwordx4 v[76:79], v90, s[8:11], s25 offen sc1
  s_lshl_b32 s24, s19, 5
  s_add_u32 s24, s24, 16
  v_add_u32 v88, s24, v4
  v_mul_u32_u24 v89, 2341, v88
  v_lshrrev_b32 v89, 16, v89
  v_mul_u32_u24 v89, 84, v89
  v_add3_u32 v88, v88, v89, v6
  v_lshlrev_b32 v91, 4, v88
  v_cvt_pk_bf16_f32 v80, v56, v57
  v_cvt_pk_bf16_f32 v81, v58, v59
  v_cvt_pk_bf16_f32 v82, v60, v61
  v_cvt_pk_bf16_f32 v83, v62, v63
  buffer_store_dwordx4 v[80:83], v91, s[8:11], s29 offen sc1
  v_cvt_pk_bf16_f32 v84, v64, v65
  v_cvt_pk_bf16_f32 v85, v66, v67
  v_cvt_pk_bf16_f32 v86, v68, v69
  v_cvt_pk_bf16_f32 v87, v70, v71
  buffer_store_dwordx4 v[84:87], v91, s[8:11], s25 offen sc1
  s_mov_b32 s33, s32
  s_add_u32 s32, s32, 28672
  s_cmp_eq_u32 s32, 86016
  s_cselect_b32 s32, 0, s32
  s_add_u32 s19, s19, 1
  s_cmp_lt_u32 s19, s35
  s_cbranch_scc1 wg_vo_loop
  s_branch wg_done
wg_done:
  s_lshl_b32 s20, s18, 4
  s_and_b32 s21, s17, 15
  s_add_u32 s20, s20, s21
  s_lshl_b32 s20, s20, 7
  s_cmp_lt_u32 s17, 16
  s_cselect_b32 s21, 16384, 0
  s_add_u32 s20, s20, s21
  s_add_u32 s20, s20, 88528896
  s_sub_u32 s21, s35, s34
  v_mov_b32 v5, s21
  v_mov_b32 v6, 0
  s_waitcnt vmcnt(0)
  s_mov_b64 exec, 1
  buffer_atomic_add v5, v6, s[8:11], s20 offen
  s_mov_b64 exec, -1
  s_branch wk_loop
wk_a:
  s_load_dwordx8 s[36:43], s[0:1], 56
  s_load_dwordx4 s[44:47], s[0:1], 88
  s_sub_u32 s3, s3, 368
  s_and_b32 s17, s3, 15
  s_lshr_b32 s19, s3, 5
  s_bitcmp1_b32 s3, 4
  s_cselect_b32 s31, 7, 0
  s_waitcnt lgkmcnt(0)
  s_mov_b32 s60, s40
  s_and_b32 s61, s41, 0xffff
  s_mov_b32 s62, 3670016
  s_mov_b32 s63, 0x20000
  s_mov_b32 s56, s42
  s_and_b32 s57, s43, 0xffff
  s_mov_b32 s58, 3670016
  s_mov_b32 s59, 0x20000
  s_lshl_b32 s30, s16, 13
  s_lshl_b32 s27, s19, 19
  s_lshl_b32 s29, s16, 17
  s_add_u32 s27, s27, s29
  s_lshl_b32 s29, s17, 9
  s_add_u32 s27, s27, s29
  v_lshrrev_b32 v5, 5, v1
  v_and_b32 v6, 31, v1
  v_xor_b32 v6, v6, v5
  v_lshlrev_b32 v6, 4, v6
  v_lshl_add_u32 v6, v5, 13, v6
  s_add_u32 m0, s30, 0
  s_add_u32 s22, s27, 0
  v_xor_b32 v7, 0, v6
  buffer_load_dwordx4 v7, s[56:59], s22 offen offset:0 lds
  s_add_u32 s22, s27, 15360
  v_xor_b32 v7, 32, v6
  buffer_load_dwordx4 v7, s[56:59], s22 offen offset:1024 lds
  s_add_u32 s22, s27, 30720
  v_xor_b32 v7, 64, v6
  buffer_load_dwordx4 v7, s[56:59], s22 offen offset:2048 lds
  s_add_u32 s22, s27, 46080
  v_xor_b32 v7, 96, v6
  buffer_load_dwordx4 v7, s[56:59], s22 offen offset:3072 lds
  s_add_u32 m0, s30, 4096
  s_add_u32 s22, s27, 65536
  v_xor_b32 v7, 128, v6
  buffer_load_dwordx4 v7, s[56:59], s22 offen offset:0 lds
  s_add_u32 s22, s27, 80896
  v_xor_b32 v7, 160, v6
  buffer_load_dwordx4 v7, s[56:59], s22 offen offset:1024 lds
  s_add_u32 s22, s27, 96256
  v_xor_b32 v7, 192, v6
  buffer_load_dwordx4 v7, s[56:59], s22 offen offset:2048 lds
  s_add_u32 s22, s27, 111616
  v_xor_b32 v7, 224, v6
  buffer_load_dwordx4 v7, s[56:59], s22 offen offset:3072 lds
  v_lshrrev_b32 v5, 5, v1
  v_and_b32 v6, 31, v1
  s_lshl_b32 s25, s16, 15
  s_add_u32 s25, s25, 32768
  s_lshl_b32 s26, s17, 9
  s_add_u32 s28, s19, s16
  s_cmp_ge_u32 s28, 7
  s_cselect_b32 s20, 7, 0
  s_sub_u32 s28, s28, s20
  s_add_u32 s28, s28, s31
  s_add_u32 s29, s19, s16
  s_add_u32 s29, s29, 4
  s_cmp_ge_u32 s29, 7
  s_cselect_b32 s20, 7, 0
  s_sub_u32 s29, s29, s20
  s_add_u32 s29, s29, s31
  s_lshl_b32 s32, s28, 18
  s_add_u32 s32, s32, s26
  s_lshl_b32 s33, s29, 18
  s_add_u32 s33, s33, s26
  v_xor_b32 v8, v6, v5
  v_lshlrev_b32 v8, 4, v8
  v_lshl_add_u32 v8, v5, 13, v8
  v_xor_b32 v12, 0, v8
  v_xor_b32 v13, 32, v8
  v_add_u32 v13, 15360, v13
  v_xor_b32 v14, 0, v8
  v_add_u32 v14, 30720, v14
  v_xor_b32 v15, 32, v8
  v_add_u32 v15, 46080, v15
  s_add_u32 s20, s16, 0
  s_and_b32 s20, s20, 3
  s_mul_i32 s21, s20, 65600
  s_lshl_b32 s20, s20, 12
  s_add_u32 s48, s20, s25
  s_mov_b32 m0, s48
  v_xor_b32 v16, s21, v12
  buffer_load_dwordx4 v16, s[60:63], s32 offen offset:0 lds
  v_xor_b32 v17, s21, v13
  buffer_load_dwordx4 v17, s[60:63], s32 offen offset:1024 lds
  v_xor_b32 v18, s21, v14
  buffer_load_dwordx4 v18, s[60:63], s32 offen offset:2048 lds
  v_xor_b32 v19, s21, v15
  buffer_load_dwordx4 v19, s[60:63], s32 offen offset:3072 lds
  s_add_u32 s20, s16, 1
  s_and_b32 s20, s20, 3
  s_mul_i32 s21, s20, 65600
  s_lshl_b32 s20, s20, 12
  s_add_u32 s49, s20, s25
  s_mov_b32 m0, s49
  v_xor_b32 v20, s21, v12
  buffer_load_dwordx4 v20, s[60:63], s32 offen offset:0 lds
  v_xor_b32 v21, s21, v13
  buffer_load_dwordx4 v21, s[60:63], s32 offen offset:1024 lds
  v_xor_b32 v22, s21, v14
  buffer_load_dwordx4 v22, s[60:63], s32 offen offset:2048 lds
  v_xor_b32 v23, s21, v15
  buffer_load_dwordx4 v23, s[60:63], s32 offen offset:3072 lds
  s_add_u32 s20, s16, 2
  s_and_b32 s20, s20, 3
  s_mul_i32 s21, s20, 65600
  s_lshl_b32 s20, s20, 12
  s_add_u32 s50, s20, s25
  s_mov_b32 m0, s50
  v_xor_b32 v24, s21, v12
  buffer_load_dwordx4 v24, s[60:63], s32 offen offset:0 lds
  v_xor_b32 v25, s21, v13
  buffer_load_dwordx4 v25, s[60:63], s32 offen offset:1024 lds
  v_xor_b32 v26, s21, v14
  buffer_load_dwordx4 v26, s[60:63], s32 offen offset:2048 lds
  v_xor_b32 v27, s21, v15
  buffer_load_dwordx4 v27, s[60:63], s32 offen offset:3072 lds
  s_add_u32 s20, s16, 3
  s_and_b32 s20, s20, 3
  s_mul_i32 s21, s20, 65600
  s_lshl_b32 s20, s20, 12
  s_add_u32 s51, s20, s25
  s_mov_b32 m0, s51
  v_xor_b32 v28, s21, v12
  buffer_load_dwordx4 v28, s[60:63], s32 offen offset:0 lds
  v_xor_b32 v29, s21, v13
  buffer_load_dwordx4 v29, s[60:63], s32 offen offset:1024 lds
  v_xor_b32 v30, s21, v14
  buffer_load_dwordx4 v30, s[60:63], s32 offen offset:2048 lds
  v_xor_b32 v31, s21, v15
  buffer_load_dwordx4 v31, s[60:63], s32 offen offset:3072 lds
  s_cmp_eq_u32 s16, 3
  s_cbranch_scc1 aj_np1
  s_add_u32 m0, s48, 16384
  s_nop 0
  buffer_load_dwordx4 v16, s[60:63], s33 offen offset:0 lds
  buffer_load_dwordx4 v17, s[60:63], s33 offen offset:1024 lds
  buffer_load_dwordx4 v18, s[60:63], s33 offen offset:2048 lds
  buffer_load_dwordx4 v19, s[60:63], s33 offen offset:3072 lds
  s_add_u32 m0, s49, 16384
  s_nop 0
  buffer_load_dwordx4 v20, s[60:63], s33 offen offset:0 lds
  buffer_load_dwordx4 v21, s[60:63], s33 offen offset:1024 lds
  buffer_load_dwordx4 v22, s[60:63], s33 offen offset:2048 lds
  buffer_load_dwordx4 v23, s[60:63], s33 offen offset:3072 lds
  s_add_u32 m0, s50, 16384
  s_nop 0
  buffer_load_dwordx4 v24, s[60:63], s33 offen offset:0 lds
  buffer_load_dwordx4 v25, s[60:63], s33 offen offset:1024 lds
  buffer_load_dwordx4 v26, s[60:63], s33 offen offset:2048 lds
  buffer_load_dwordx4 v27, s[60:63], s33 offen offset:3072 lds
  s_add_u32 m0, s51, 16384
  s_nop 0
  buffer_load_dwordx4 v28, s[60:63], s33 offen offset:0 lds
  buffer_load_dwordx4 v29, s[60:63], s33 offen offset:1024 lds
  buffer_load_dwordx4 v30, s[60:63], s33 offen offset:2048 lds
  buffer_load_dwordx4 v31, s[60:63], s33 offen offset:3072 lds
aj_np1:
  s_mov_b32 s79, 0
aj_run:
  s_mul_i32 s30, s17, 401408
  s_mul_i32 s20, s19, 57344
  s_add_u32 s30, s30, s20
  v_add_u32 v12, s30, v2
  v_add_u32 v13, 14336, v12
  v_add_u32 v14, 28672, v12
  v_add_u32 v15, 43008, v12
  v_lshrrev_b32 v7, 2, v4
  v_lshlrev_b32 v7, 3, v7
  v_and_b32 v8, 3, v4
  v_add_u32 v7, v7, v8
  v_xor_b32 v10, v3, v4
  v_lshlrev_b32 v10, 4, v10
  v_lshl_add_u32 v10, v7, 9, v10
  v_add_u32 v10, s25, v10
  v_xor_b32 v32, 0, v10
  v_xor_b32 v33, 64, v10
  v_xor_b32 v34, 128, v10
  v_xor_b32 v35, 192, v10
  v_and_b32 v8, 2, v4
  v_lshlrev_b32 v8, 1, v8
  v_and_b32 v9, 1, v4
  v_add_u32 v8, v8, v9
  v_lshrrev_b32 v7, 2, v4
  v_lshl_add_u32 v7, v7, 4, v8
  v_xor_b32 v8, v8, v3
  v_lshlrev_b32 v8, 4, v8
  v_lshl_add_u32 v7, v7, 9, v8
  s_mov_b32 s24, 1035512379
  s_waitcnt vmcnt(32)
  s_cmp_lg_u32 s16, 3
  s_cbranch_scc1 w3_34
  s_waitcnt vmcnt(16)
w3_34:
  s_barrier
  v_xor_b32 v8, 0, v7
  ds_read_b128 v[128:131], v8 offset:0
  v_xor_b32 v9, 64, v7
  ds_read_b128 v[132:135], v9 offset:0
  v_xor_b32 v10, 128, v7
  ds_read_b128 v[136:139], v10 offset:0
  v_xor_b32 v11, 192, v7
  ds_read_b128 v[140:143], v11 offset:0
  ds_read_b128 v[144:147], v8 offset:256
  ds_read_b128 v[148:151], v9 offset:256
  ds_read_b128 v[152:155], v10 offset:256
  ds_read_b128 v[156:159], v11 offset:256
  s_waitcnt lgkmcnt(4)
  v_xor_b32 v8, 32, v7
  ds_read_b128 v[160:163], v8 offset:1024
  v_xor_b32 v9, 96, v7
  ds_read_b128 v[164:167], v9 offset:1024
  v_xor_b32 v10, 160, v7
  ds_read_b128 v[168:171], v10 offset:1024
  v_xor_b32 v11, 224, v7
  ds_read_b128 v[172:175], v11 offset:1024
  ds_read_b128 v[176:179], v8 offset:1280
  ds_read_b128 v[180:183], v9 offset:1280
  ds_read_b128 v[184:187], v10 offset:1280
  ds_read_b128 v[188:191], v11 offset:1280
  s_waitcnt lgkmcnt(4)
  v_xor_b32 v8, 128, v7
  ds_read_b128 v[192:195], v8 offset:4096
  v_xor_b32 v9, 192, v7
  ds_read_b128 v[196:199], v9 offset:4096
  v_xor_b32 v10, 0, v7
  ds_read_b128 v[200:203], v10 offset:4096
  v_xor_b32 v11, 64, v7
  ds_read_b128 v[204:207], v11 offset:4096
  ds_read_b128 v[208:211], v8 offset:4352
  ds_read_b128 v[212:215], v9 offset:4352
  ds_read_b128 v[216:219], v10 offset:4352
  ds_read_b128 v[220:223], v11 offset:4352
  s_waitcnt lgkmcnt(4)
  v_xor_b32 v8, 160, v7
  ds_read_b128 v[224:227], v8 offset:5120
  v_xor_b32 v9, 224, v7
  ds_read_b128 v[228:231], v9 offset:5120
  v_xor_b32 v10, 32, v7
  ds_read_b128 v[232:235], v10 offset:5120
  v_xor_b32 v11, 96, v7
  ds_read_b128 v[236:239], v11 offset:5120
  ds_read_b128 v[240:243], v8 offset:5376
  ds_read_b128 v[244:247], v9 offset:5376
  ds_read_b128 v[248:251], v10 offset:5376
  ds_read_b128 v[252:255], v11 offset:5376
  s_waitcnt lgkmcnt(4)
  s_waitcnt vmcnt(16) lgkmcnt(0)
  s_cmp_lg_u32 s16, 3
  s_cbranch_scc1 w3_35
  s_waitcnt vmcnt(0)
w3_35:
  ds_read_b128 v[52:55], v32 offset:0
  ds_read_b128 v[56:59], v33 offset:0
  ds_read_b128 v[60:63], v34 offset:0
  ds_read_b128 v[64:67], v35 offset:0
  s_waitcnt lgkmcnt(3)
  v_mfma_f32_16x16x32_bf16 v[96:99], v[52:55], v[128:131], 0
  v_mfma_f32_16x16x32_bf16 v[100:103], v[52:55], v[160:163], 0
  v_mfma_f32_16x16x32_bf16 v[104:107], v[52:55], v[192:195], 0
  v_mfma_f32_16x16x32_bf16 v[108:111], v[52:55], v[224:227], 0
  ds_read_b128 v[52:55], v32 offset:256
  s_waitcnt lgkmcnt(3)
  v_mfma_f32_16x16x32_bf16 v[96:99], v[56:59], v[132:135], v[96:99]
  v_mfma_f32_16x16x32_bf16 v[100:103], v[56:59], v[164:167], v[100:103]
  v_mfma_f32_16x16x32_bf16 v[104:107], v[56:59], v[196:199], v[104:107]
  v_mfma_f32_16x16x32_bf16 v[108:111], v[56:59], v[228:231], v[108:111]
  ds_read_b128 v[56:59], v33 offset:256
  s_waitcnt lgkmcnt(3)
  v_mfma_f32_16x16x32_bf16 v[96:99], v[60:63], v[136:139], v[96:99]
  v_mfma_f32_16x16x32_bf16 v[100:103], v[60:63], v[168:171], v[100:103]
  v_mfma_f32_16x16x32_bf16 v[104:107], v[60:63], v[200:203], v[104:107]
  v_mfma_f32_16x16x32_bf16 v[108:111], v[60:63], v[232:235], v[108:111]
  ds_read_b128 v[60:63], v34 offset:256
  s_waitcnt lgkmcnt(3)
  v_mfma_f32_16x16x32_bf16 v[96:99], v[64:67], v[140:143], v[96:99]
  v_mfma_f32_16x16x32_bf16 v[100:103], v[64:67], v[172:175], v[100:103]
  v_mfma_f32_16x16x32_bf16 v[104:107], v[64:67], v[204:207], v[104:107]
  v_mfma_f32_16x16x32_bf16 v[108:111], v[64:67], v[236:239], v[108:111]
  ds_read_b128 v[64:67], v35 offset:256
  s_waitcnt lgkmcnt(3)
  v_mfma_f32_16x16x32_bf16 v[96:99], v[52:55], v[144:147], v[96:99]
  v_mfma_f32_16x16x32_bf16 v[100:103], v[52:55], v[176:179], v[100:103]
  v_mfma_f32_16x16x32_bf16 v[104:107], v[52:55], v[208:211], v[104:107]
  v_mfma_f32_16x16x32_bf16 v[108:111], v[52:55], v[240:243], v[108:111]
  ds_read_b128 v[52:55], v32 offset:2048
  s_waitcnt lgkmcnt(3)
  v_mfma_f32_16x16x32_bf16 v[96:99], v[56:59], v[148:151], v[96:99]
  v_mfma_f32_16x16x32_bf16 v[100:103], v[56:59], v[180:183], v[100:103]
  v_mfma_f32_16x16x32_bf16 v[104:107], v[56:59], v[212:215], v[104:107]
  v_mfma_f32_16x16x32_bf16 v[108:111], v[56:59], v[244:247], v[108:111]
  ds_read_b128 v[56:59], v33 offset:2048
  s_waitcnt lgkmcnt(3)
  v_mfma_f32_16x16x32_bf16 v[96:99], v[60:63], v[152:155], v[96:99]
  v_mfma_f32_16x16x32_bf16 v[100:103], v[60:63], v[184:187], v[100:103]
  v_mfma_f32_16x16x32_bf16 v[104:107], v[60:63], v[216:219], v[104:107]
  v_mfma_f32_16x16x32_bf16 v[108:111], v[60:63], v[248:251], v[108:111]
  ds_read_b128 v[60:63], v34 offset:2048
  s_waitcnt lgkmcnt(3)
  v_mfma_f32_16x16x32_bf16 v[96:99], v[64:67], v[156:159], v[96:99]
  v_mfma_f32_16x16x32_bf16 v[100:103], v[64:67], v[188:191], v[100:103]
  v_mfma_f32_16x16x32_bf16 v[104:107], v[64:67], v[220:223], v[104:107]
  v_mfma_f32_16x16x32_bf16 v[108:111], v[64:67], v[252:255], v[108:111]
  ds_read_b128 v[64:67], v35 offset:2048
  s_waitcnt lgkmcnt(3)
  v_mfma_f32_16x16x32_bf16 v[112:115], v[52:55], v[128:131], 0
  v_mfma_f32_16x16x32_bf16 v[116:119], v[52:55], v[160:163], 0
  v_mfma_f32_16x16x32_bf16 v[120:123], v[52:55], v[192:195], 0
  v_mfma_f32_16x16x32_bf16 v[124:127], v[52:55], v[224:227], 0
  ds_read_b128 v[52:55], v32 offset:2304
  s_waitcnt lgkmcnt(3)
  v_mfma_f32_16x16x32_bf16 v[112:115], v[56:59], v[132:135], v[112:115]
  v_mfma_f32_16x16x32_bf16 v[116:119], v[56:59], v[164:167], v[116:119]
  v_mfma_f32_16x16x32_bf16 v[120:123], v[56:59], v[196:199], v[120:123]
  v_mfma_f32_16x16x32_bf16 v[124:127], v[56:59], v[228:231], v[124:127]
  ds_read_b128 v[56:59], v33 offset:2304
  s_waitcnt lgkmcnt(3)
  v_mfma_f32_16x16x32_bf16 v[112:115], v[60:63], v[136:139], v[112:115]
  v_mfma_f32_16x16x32_bf16 v[116:119], v[60:63], v[168:171], v[116:119]
  v_mfma_f32_16x16x32_bf16 v[120:123], v[60:63], v[200:203], v[120:123]
  v_mfma_f32_16x16x32_bf16 v[124:127], v[60:63], v[232:235], v[124:127]
  ds_read_b128 v[60:63], v34 offset:2304
  s_waitcnt lgkmcnt(3)
  v_mfma_f32_16x16x32_bf16 v[112:115], v[64:67], v[140:143], v[112:115]
  v_mfma_f32_16x16x32_bf16 v[116:119], v[64:67], v[172:175], v[116:119]
  v_mfma_f32_16x16x32_bf16 v[120:123], v[64:67], v[204:207], v[120:123]
  v_mfma_f32_16x16x32_bf16 v[124:127], v[64:67], v[236:239], v[124:127]
  ds_read_b128 v[64:67], v35 offset:2304
  s_waitcnt lgkmcnt(3)
  v_mfma_f32_16x16x32_bf16 v[112:115], v[52:55], v[144:147], v[112:115]
  v_mfma_f32_16x16x32_bf16 v[116:119], v[52:55], v[176:179], v[116:119]
  v_mfma_f32_16x16x32_bf16 v[120:123], v[52:55], v[208:211], v[120:123]
  v_mfma_f32_16x16x32_bf16 v[124:127], v[52:55], v[240:243], v[124:127]
  s_waitcnt lgkmcnt(2)
  v_mfma_f32_16x16x32_bf16 v[112:115], v[56:59], v[148:151], v[112:115]
  v_mfma_f32_16x16x32_bf16 v[116:119], v[56:59], v[180:183], v[116:119]
  v_mfma_f32_16x16x32_bf16 v[120:123], v[56:59], v[212:215], v[120:123]
  v_mfma_f32_16x16x32_bf16 v[124:127], v[56:59], v[244:247], v[124:127]
  s_waitcnt lgkmcnt(1)
  v_mfma_f32_16x16x32_bf16 v[112:115], v[60:63], v[152:155], v[112:115]
  v_mfma_f32_16x16x32_bf16 v[116:119], v[60:63], v[184:187], v[116:119]
  v_mfma_f32_16x16x32_bf16 v[120:123], v[60:63], v[216:219], v[120:123]
  v_mfma_f32_16x16x32_bf16 v[124:127], v[60:63], v[248:251], v[124:127]
  s_waitcnt lgkmcnt(0)
  v_mfma_f32_16x16x32_bf16 v[112:115], v[64:67], v[156:159], v[112:115]
  v_mfma_f32_16x16x32_bf16 v[116:119], v[64:67], v[188:191], v[116:119]
  v_mfma_f32_16x16x32_bf16 v[120:123], v[64:67], v[220:223], v[120:123]
  v_mfma_f32_16x16x32_bf16 v[124:127], v[64:67], v[252:255], v[124:127]
  s_lshl_b32 s30, s28, 10
  v_mul_f32 v96, s24, v96
  v_mul_f32 v97, s24, v97
  v_mul_f32 v98, s24, v98
  v_mul_f32 v99, s24, v99
  v_cvt_pk_bf16_f32 v68, v96, v97
  v_cvt_pk_bf16_f32 v69, v98, v99
  v_mul_f32 v112, s24, v112
  v_mul_f32 v113, s24, v113
  v_mul_f32 v114, s24, v114
  v_mul_f32 v115, s24, v115
  v_cvt_pk_bf16_f32 v70, v112, v113
  v_cvt_pk_bf16_f32 v71, v114, v115
  buffer_store_dwordx4 v[68:71], v12, s[8:11], s30 offen sc1
  v_mul_f32 v100, s24, v100
  v_mul_f32 v101, s24, v101
  v_mul_f32 v102, s24, v102
  v_mul_f32 v103, s24, v103
  v_cvt_pk_bf16_f32 v72, v100, v101
  v_cvt_pk_bf16_f32 v73, v102, v103
  v_mul_f32 v116, s24, v116
  v_mul_f32 v117, s24, v117
  v_mul_f32 v118, s24, v118
  v_mul_f32 v119, s24, v119
  v_cvt_pk_bf16_f32 v74, v116, v117
  v_cvt_pk_bf16_f32 v75, v118, v119
  buffer_store_dwordx4 v[72:75], v13, s[8:11], s30 offen sc1
  v_mul_f32 v104, s24, v104
  v_mul_f32 v105, s24, v105
  v_mul_f32 v106, s24, v106
  v_mul_f32 v107, s24, v107
  v_cvt_pk_bf16_f32 v76, v104, v105
  v_cvt_pk_bf16_f32 v77, v106, v107
  v_mul_f32 v120, s24, v120
  v_mul_f32 v121, s24, v121
  v_mul_f32 v122, s24, v122
  v_mul_f32 v123, s24, v123
  v_cvt_pk_bf16_f32 v78, v120, v121
  v_cvt_pk_bf16_f32 v79, v122, v123
  buffer_store_dwordx4 v[76:79], v14, s[8:11], s30 offen sc1
  v_mul_f32 v108, s24, v108
  v_mul_f32 v109, s24, v109
  v_mul_f32 v110, s24, v110
  v_mul_f32 v111, s24, v111
  v_cvt_pk_bf16_f32 v80, v108, v109
  v_cvt_pk_bf16_f32 v81, v110, v111
  v_mul_f32 v124, s24, v124
  v_mul_f32 v125, s24, v125
  v_mul_f32 v126, s24, v126
  v_mul_f32 v127, s24, v127
  v_cvt_pk_bf16_f32 v82, v124, v125
  v_cvt_pk_bf16_f32 v83, v126, v127
  buffer_store_dwordx4 v[80:83], v15, s[8:11], s30 offen sc1
  s_cmp_eq_u32 s16, 3
  s_cbranch_scc1 aj_w3
  s_waitcnt vmcnt(4)
  ds_read_b128 v[52:55], v32 offset:16384
  ds_read_b128 v[56:59], v33 offset:16384
  ds_read_b128 v[60:63], v34 offset:16384
  ds_read_b128 v[64:67], v35 offset:16384
  s_waitcnt lgkmcnt(3)
  v_mfma_f32_16x16x32_bf16 v[96:99], v[52:55], v[128:131], 0
  v_mfma_f32_16x16x32_bf16 v[100:103], v[52:55], v[160:163], 0
  v_mfma_f32_16x16x32_bf16 v[104:107], v[52:55], v[192:195], 0
  v_mfma_f32_16x16x32_bf16 v[108:111], v[52:55], v[224:227], 0
  ds_read_b128 v[52:55], v32 offset:16640
  s_waitcnt lgkmcnt(3)
  v_mfma_f32_16x16x32_bf16 v[96:99], v[56:59], v[132:135], v[96:99]
  v_mfma_f32_16x16x32_bf16 v[100:103], v[56:59], v[164:167], v[100:103]
  v_mfma_f32_16x16x32_bf16 v[104:107], v[56:59], v[196:199], v[104:107]
  v_mfma_f32_16x16x32_bf16 v[108:111], v[56:59], v[228:231], v[108:111]
  ds_read_b128 v[56:59], v33 offset:16640
  s_waitcnt lgkmcnt(3)
  v_mfma_f32_16x16x32_bf16 v[96:99], v[60:63], v[136:139], v[96:99]
  v_mfma_f32_16x16x32_bf16 v[100:103], v[60:63], v[168:171], v[100:103]
  v_mfma_f32_16x16x32_bf16 v[104:107], v[60:63], v[200:203], v[104:107]
  v_mfma_f32_16x16x32_bf16 v[108:111], v[60:63], v[232:235], v[108:111]
  ds_read_b128 v[60:63], v34 offset:16640
  s_waitcnt lgkmcnt(3)
  v_mfma_f32_16x16x32_bf16 v[96:99], v[64:67], v[140:143], v[96:99]
  v_mfma_f32_16x16x32_bf16 v[100:103], v[64:67], v[172:175], v[100:103]
  v_mfma_f32_16x16x32_bf16 v[104:107], v[64:67], v[204:207], v[104:107]
  v_mfma_f32_16x16x32_bf16 v[108:111], v[64:67], v[236:239], v[108:111]
  ds_read_b128 v[64:67], v35 offset:16640
  s_waitcnt lgkmcnt(3)
  v_mfma_f32_16x16x32_bf16 v[96:99], v[52:55], v[144:147], v[96:99]
  v_mfma_f32_16x16x32_bf16 v[100:103], v[52:55], v[176:179], v[100:103]
  v_mfma_f32_16x16x32_bf16 v[104:107], v[52:55], v[208:211], v[104:107]
  v_mfma_f32_16x16x32_bf16 v[108:111], v[52:55], v[240:243], v[108:111]
  ds_read_b128 v[52:55], v32 offset:18432
  s_waitcnt lgkmcnt(3)
  v_mfma_f32_16x16x32_bf16 v[96:99], v[56:59], v[148:151], v[96:99]
  v_mfma_f32_16x16x32_bf16 v[100:103], v[56:59], v[180:183], v[100:103]
  v_mfma_f32_16x16x32_bf16 v[104:107], v[56:59], v[212:215], v[104:107]
  v_mfma_f32_16x16x32_bf16 v[108:111], v[56:59], v[244:247], v[108:111]
  ds_read_b128 v[56:59], v33 offset:18432
  s_waitcnt lgkmcnt(3)
  v_mfma_f32_16x16x32_bf16 v[96:99], v[60:63], v[152:155], v[96:99]
  v_mfma_f32_16x16x32_bf16 v[100:103], v[60:63], v[184:187], v[100:103]
  v_mfma_f32_16x16x32_bf16 v[104:107], v[60:63], v[216:219], v[104:107]
  v_mfma_f32_16x16x32_bf16 v[108:111], v[60:63], v[248:251], v[108:111]
  ds_read_b128 v[60:63], v34 offset:18432
  s_waitcnt lgkmcnt(3)
  v_mfma_f32_16x16x32_bf16 v[96:99], v[64:67], v[156:159], v[96:99]
  v_mfma_f32_16x16x32_bf16 v[100:103], v[64:67], v[188:191], v[100:103]
  v_mfma_f32_16x16x32_bf16 v[104:107], v[64:67], v[220:223], v[104:107]
  v_mfma_f32_16x16x32_bf16 v[108:111], v[64:67], v[252:255], v[108:111]
  ds_read_b128 v[64:67], v35 offset:18432
  s_waitcnt lgkmcnt(3)
  v_mfma_f32_16x16x32_bf16 v[112:115], v[52:55], v[128:131], 0
  v_mfma_f32_16x16x32_bf16 v[116:119], v[52:55], v[160:163], 0
  v_mfma_f32_16x16x32_bf16 v[120:123], v[52:55], v[192:195], 0
  v_mfma_f32_16x16x32_bf16 v[124:127], v[52:55], v[224:227], 0
  ds_read_b128 v[52:55], v32 offset:18688
  s_waitcnt lgkmcnt(3)
  v_mfma_f32_16x16x32_bf16 v[112:115], v[56:59], v[132:135], v[112:115]
  v_mfma_f32_16x16x32_bf16 v[116:119], v[56:59], v[164:167], v[116:119]
  v_mfma_f32_16x16x32_bf16 v[120:123], v[56:59], v[196:199], v[120:123]
  v_mfma_f32_16x16x32_bf16 v[124:127], v[56:59], v[228:231], v[124:127]
  ds_read_b128 v[56:59], v33 offset:18688
  s_waitcnt lgkmcnt(3)
  v_mfma_f32_16x16x32_bf16 v[112:115], v[60:63], v[136:139], v[112:115]
  v_mfma_f32_16x16x32_bf16 v[116:119], v[60:63], v[168:171], v[116:119]
  v_mfma_f32_16x16x32_bf16 v[120:123], v[60:63], v[200:203], v[120:123]
  v_mfma_f32_16x16x32_bf16 v[124:127], v[60:63], v[232:235], v[124:127]
  ds_read_b128 v[60:63], v34 offset:18688
  s_waitcnt lgkmcnt(3)
  v_mfma_f32_16x16x32_bf16 v[112:115], v[64:67], v[140:143], v[112:115]
  v_mfma_f32_16x16x32_bf16 v[116:119], v[64:67], v[172:175], v[116:119]
  v_mfma_f32_16x16x32_bf16 v[120:123], v[64:67], v[204:207], v[120:123]
  v_mfma_f32_16x16x32_bf16 v[124:127], v[64:67], v[236:239], v[124:127]
  ds_read_b128 v[64:67], v35 offset:18688
  s_waitcnt lgkmcnt(3)
  v_mfma_f32_16x16x32_bf16 v[112:115], v[52:55], v[144:147], v[112:115]
  v_mfma_f32_16x16x32_bf16 v[116:119], v[52:55], v[176:179], v[116:119]
  v_mfma_f32_16x16x32_bf16 v[120:123], v[52:55], v[208:211], v[120:123]
  v_mfma_f32_16x16x32_bf16 v[124:127], v[52:55], v[240:243], v[124:127]
  s_waitcnt lgkmcnt(2)
  v_mfma_f32_16x16x32_bf16 v[112:115], v[56:59], v[148:151], v[112:115]
  v_mfma_f32_16x16x32_bf16 v[116:119], v[56:59], v[180:183], v[116:119]
  v_mfma_f32_16x16x32_bf16 v[120:123], v[56:59], v[212:215], v[120:123]
  v_mfma_f32_16x16x32_bf16 v[124:127], v[56:59], v[244:247], v[124:127]
  s_waitcnt lgkmcnt(1)
  v_mfma_f32_16x16x32_bf16 v[112:115], v[60:63], v[152:155], v[112:115]
  v_mfma_f32_16x16x32_bf16 v[116:119], v[60:63], v[184:187], v[116:119]
  v_mfma_f32_16x16x32_bf16 v[120:123], v[60:63], v[216:219], v[120:123]
  v_mfma_f32_16x16x32_bf16 v[124:127], v[60:63], v[248:251], v[124:127]
  s_waitcnt lgkmcnt(0)
  v_mfma_f32_16x16x32_bf16 v[112:115], v[64:67], v[156:159], v[112:115]
  v_mfma_f32_16x16x32_bf16 v[116:119], v[64:67], v[188:191], v[116:119]
  v_mfma_f32_16x16x32_bf16 v[120:123], v[64:67], v[220:223], v[120:123]
  v_mfma_f32_16x16x32_bf16 v[124:127], v[64:67], v[252:255], v[124:127]
  s_lshl_b32 s30, s29, 10
  v_mul_f32 v96, s24, v96
  v_mul_f32 v97, s24, v97
  v_mul_f32 v98, s24, v98
  v_mul_f32 v99, s24, v99
  v_cvt_pk_bf16_f32 v68, v96, v97
  v_cvt_pk_bf16_f32 v69, v98, v99
  v_mul_f32 v112, s24, v112
  v_mul_f32 v113, s24, v113
  v_mul_f32 v114, s24, v114
  v_mul_f32 v115, s24, v115
  v_cvt_pk_bf16_f32 v70, v112, v113
  v_cvt_pk_bf16_f32 v71, v114, v115
  buffer_store_dwordx4 v[68:71], v12, s[8:11], s30 offen sc1
  v_mul_f32 v100, s24, v100
  v_mul_f32 v101, s24, v101
  v_mul_f32 v102, s24, v102
  v_mul_f32 v103, s24, v103
  v_cvt_pk_bf16_f32 v72, v100, v101
  v_cvt_pk_bf16_f32 v73, v102, v103
  v_mul_f32 v116, s24, v116
  v_mul_f32 v117, s24, v117
  v_mul_f32 v118, s24, v118
  v_mul_f32 v119, s24, v119
  v_cvt_pk_bf16_f32 v74, v116, v117
  v_cvt_pk_bf16_f32 v75, v118, v119
  buffer_store_dwordx4 v[72:75], v13, s[8:11], s30 offen sc1
  v_mul_f32 v104, s24, v104
  v_mul_f32 v105, s24, v105
  v_mul_f32 v106, s24, v106
  v_mul_f32 v107, s24, v107
  v_cvt_pk_bf16_f32 v76, v104, v105
  v_cvt_pk_bf16_f32 v77, v106, v107
  v_mul_f32 v120, s24, v120
  v_mul_f32 v121, s24, v121
  v_mul_f32 v122, s24, v122
  v_mul_f32 v123, s24, v123
  v_cvt_pk_bf16_f32 v78, v120, v121
  v_cvt_pk_bf16_f32 v79, v122, v123
  buffer_store_dwordx4 v[76:79], v14, s[8:11], s30 offen sc1
  v_mul_f32 v108, s24, v108
  v_mul_f32 v109, s24, v109
  v_mul_f32 v110, s24, v110
  v_mul_f32 v111, s24, v111
  v_cvt_pk_bf16_f32 v80, v108, v109
  v_cvt_pk_bf16_f32 v81, v110, v111
  v_mul_f32 v124, s24, v124
  v_mul_f32 v125, s24, v125
  v_mul_f32 v126, s24, v126
  v_mul_f32 v127, s24, v127
  v_cvt_pk_bf16_f32 v82, v124, v125
  v_cvt_pk_bf16_f32 v83, v126, v127
  buffer_store_dwordx4 v[80:83], v15, s[8:11], s30 offen sc1
aj_w3:
  s_lshl_b32 s28, s17, 7
  s_lshl_b32 s21, s19, 4
  s_add_u32 s28, s28, s21
  s_cmp_lg_u32 s31, 0
  s_cselect_b32 s21, 8, 0
  s_add_u32 s28, s28, s21
  s_add_u32 s28, s28, 88621056
  s_waitcnt vmcnt(0)
  s_barrier
  s_cmp_lg_u32 s16, 0
  s_cbranch_scc1 pub_36
  v_mul_u32_u24 v26, 2048, v1
  v_mov_b32 v24, s88
  v_mov_b32 v25, s89
  s_mov_b64 exec, 1
  buffer_store_dwordx2 v[24:25], v26, s[8:11], s28 offen sc1
  s_mov_b64 exec, -1
pub_36:
  s_cmp_lg_u32 s79, 0
  s_cbranch_scc1 bj_end
  v_mov_b32 v250, 0
  s_branch wk_loop
wk_srv:
  s_sub_u32 s3, s3, 336
  s_and_b32 s18, s3, 15
  s_lshr_b32 s19, s3, 4
  s_and_b32 s19, s19, 1
  s_mul_i32 s20, s18, 401408
  s_mul_i32 s21, s16, 100352
  s_add_u32 s20, s20, s21
  s_add_u32 s20, s20, 6422528
  s_add_u32 s22, s20, 0
  buffer_load_dwordx4 a[0:3], v2, s[8:11], s22 offen offset:0 sc1
  buffer_load_dwordx4 a[4:7], v2, s[8:11], s22 offen offset:1024 sc1
  buffer_load_dwordx4 a[8:11], v2, s[8:11], s22 offen offset:2048 sc1
  buffer_load_dwordx4 a[12:15], v2, s[8:11], s22 offen offset:3072 sc1
  s_add_u32 s22, s20, 4096
  buffer_load_dwordx4 a[16:19], v2, s[8:11], s22 offen offset:0 sc1
  buffer_load_dwordx4 a[20:23], v2, s[8:11], s22 offen offset:1024 sc1
  buffer_load_dwordx4 a[24:27], v2, s[8:11], s22 offen offset:2048 sc1
  buffer_load_dwordx4 a[28:31], v2, s[8:11], s22 offen offset:3072 sc1
  s_add_u32 s22, s20, 8192
  buffer_load_dwordx4 a[32:35], v2, s[8:11], s22 offen offset:0 sc1
  buffer_load_dwordx4 a[36:39], v2, s[8:11], s22 offen offset:1024 sc1
  buffer_load_dwordx4 a[40:43], v2, s[8:11], s22 offen offset:2048 sc1
  buffer_load_dwordx4 a[44:47], v2, s[8:11], s22 offen offset:3072 sc1
  s_add_u32 s22, s20, 12288
  buffer_load_dwordx4 a[48:51], v2, s[8:11], s22 offen offset:0 sc1
  buffer_load_dwordx4 a[52:55], v2, s[8:11], s22 offen offset:1024 sc1
  buffer_load_dwordx4 a[56:59], v2, s[8:11], s22 offen offset:2048 sc1
  buffer_load_dwordx4 a[60:63], v2, s[8:11], s22 offen offset:3072 sc1
  s_add_u32 s22, s20, 16384
  buffer_load_dwordx4 a[64:67], v2, s[8:11], s22 offen offset:0 sc1
  buffer_load_dwordx4 a[68:71], v2, s[8:11], s22 offen offset:1024 sc1
  buffer_load_dwordx4 a[72:75], v2, s[8:11], s22 offen offset:2048 sc1
  buffer_load_dwordx4 a[76:79], v2, s[8:11], s22 offen offset:3072 sc1
  s_add_u32 s22, s20, 20480
  buffer_load_dwordx4 a[80:83], v2, s[8:11], s22 offen offset:0 sc1
  buffer_load_dwordx4 a[84:87], v2, s[8:11], s22 offen offset:1024 sc1
  buffer_load_dwordx4 a[88:91], v2, s[8:11], s22 offen offset:2048 sc1
  buffer_load_dwordx4 a[92:95], v2, s[8:11], s22 offen offset:3072 sc1
  s_add_u32 s22, s20, 24576
  buffer_load_dwordx4 a[96:99], v2, s[8:11], s22 offen offset:0 sc1
  buffer_load_dwordx4 a[100:103], v2, s[8:11], s22 offen offset:1024 sc1
  buffer_load_dwordx4 a[104:107], v2, s[8:11], s22 offen offset:2048 sc1
  buffer_load_dwordx4 a[108:111], v2, s[8:11], s22 offen offset:3072 sc1
  s_add_u32 s22, s20, 28672
  buffer_load_dwordx4 a[112:115], v2, s[8:11], s22 offen offset:0 sc1
  buffer_load_dwordx4 a[116:119], v2, s[8:11], s22 offen offset:1024 sc1
  buffer_load_dwordx4 a[120:123], v2, s[8:11], s22 offen offset:2048 sc1
  buffer_load_dwordx4 a[124:127], v2, s[8:11], s22 offen offset:3072 sc1
  s_waitcnt vmcnt(24)
  s_add_u32 s22, s20, 32768
  buffer_load_dwordx4 a[128:131], v2, s[8:11], s22 offen offset:0 sc1
  buffer_load_dwordx4 a[132:135], v2, s[8:11], s22 offen offset:1024 sc1
  buffer_load_dwordx4 a[136:139], v2, s[8:11], s22 offen offset:2048 sc1
  buffer_load_dwordx4 a[140:143], v2, s[8:11], s22 offen offset:3072 sc1
  s_add_u32 s22, s20, 36864
  buffer_load_dwordx4 a[144:147], v2, s[8:11], s22 offen offset:0 sc1
  buffer_load_dwordx4 a[148:151], v2, s[8:11], s22 offen offset:1024 sc1
  buffer_load_dwordx4 a[152:155], v2, s[8:11], s22 offen offset:2048 sc1
  buffer_load_dwordx4 a[156:159], v2, s[8:11], s22 offen offset:3072 sc1
  s_add_u32 s22, s20, 40960
  buffer_load_dwordx4 a[160:163], v2, s[8:11], s22 offen offset:0 sc1
  buffer_load_dwordx4 a[164:167], v2, s[8:11], s22 offen offset:1024 sc1
  buffer_load_dwordx4 a[168:171], v2, s[8:11], s22 offen offset:2048 sc1
  buffer_load_dwordx4 a[172:175], v2, s[8:11], s22 offen offset:3072 sc1
  s_add_u32 s22, s20, 45056
  buffer_load_dwordx4 a[176:179], v2, s[8:11], s22 offen offset:0 sc1
  buffer_load_dwordx4 a[180:183], v2, s[8:11], s22 offen offset:1024 sc1
  buffer_load_dwordx4 a[184:187], v2, s[8:11], s22 offen offset:2048 sc1
  buffer_load_dwordx4 a[188:191], v2, s[8:11], s22 offen offset:3072 sc1
  s_add_u32 s22, s20, 49152
  buffer_load_dwordx4 a[192:195], v2, s[8:11], s22 offen offset:0 sc1
  buffer_load_dwordx4 a[196:199], v2, s[8:11], s22 offen offset:1024 sc1
  buffer_load_dwordx4 a[200:203], v2, s[8:11], s22 offen offset:2048 sc1
  buffer_load_dwordx4 a[204:207], v2, s[8:11], s22 offen offset:3072 sc1
  s_add_u32 s22, s20, 53248
  buffer_load_dwordx4 a[208:211], v2, s[8:11], s22 offen offset:0 sc1
  buffer_load_dwordx4 a[212:215], v2, s[8:11], s22 offen offset:1024 sc1
  buffer_load_dwordx4 a[216:219], v2, s[8:11], s22 offen offset:2048 sc1
  buffer_load_dwordx4 a[220:223], v2, s[8:11], s22 offen offset:3072 sc1
  s_add_u32 s22, s20, 57344
  buffer_load_dwordx4 a[224:227], v2, s[8:11], s22 offen offset:0 sc1
  buffer_load_dwordx4 a[228:231], v2, s[8:11], s22 offen offset:1024 sc1
  buffer_load_dwordx4 a[232:235], v2, s[8:11], s22 offen offset:2048 sc1
  buffer_load_dwordx4 a[236:239], v2, s[8:11], s22 offen offset:3072 sc1
  s_add_u32 s22, s20, 61440
  buffer_load_dwordx4 a[240:243], v2, s[8:11], s22 offen offset:0 sc1
  buffer_load_dwordx4 a[244:247], v2, s[8:11], s22 offen offset:1024 sc1
  buffer_load_dwordx4 a[248:251], v2, s[8:11], s22 offen offset:2048 sc1
  buffer_load_dwordx4 a[252:255], v2, s[8:11], s22 offen offset:3072 sc1
  s_waitcnt vmcnt(24)
  s_add_u32 s22, s20, 65536
  buffer_load_dwordx4 v[120:123], v2, s[8:11], s22 offen offset:0 sc1
  buffer_load_dwordx4 v[124:127], v2, s[8:11], s22 offen offset:1024 sc1
  buffer_load_dwordx4 v[128:131], v2, s[8:11], s22 offen offset:2048 sc1
  buffer_load_dwordx4 v[132:135], v2, s[8:11], s22 offen offset:3072 sc1
  s_add_u32 s22, s20, 69632
  buffer_load_dwordx4 v[136:139], v2, s[8:11], s22 offen offset:0 sc1
  buffer_load_dwordx4 v[140:143], v2, s[8:11], s22 offen offset:1024 sc1
  buffer_load_dwordx4 v[144:147], v2, s[8:11], s22 offen offset:2048 sc1
  buffer_load_dwordx4 v[148:151], v2, s[8:11], s22 offen offset:3072 sc1
  s_add_u32 s22, s20, 73728
  buffer_load_dwordx4 v[152:155], v2, s[8:11], s22 offen offset:0 sc1
  buffer_load_dwordx4 v[156:159], v2, s[8:11], s22 offen offset:1024 sc1
  buffer_load_dwordx4 v[160:163], v2, s[8:11], s22 offen offset:2048 sc1
  buffer_load_dwordx4 v[164:167], v2, s[8:11], s22 offen offset:3072 sc1
  s_add_u32 s22, s20, 77824
  buffer_load_dwordx4 v[168:171], v2, s[8:11], s22 offen offset:0 sc1
  buffer_load_dwordx4 v[172:175], v2, s[8:11], s22 offen offset:1024 sc1
  buffer_load_dwordx4 v[176:179], v2, s[8:11], s22 offen offset:2048 sc1
  buffer_load_dwordx4 v[180:183], v2, s[8:11], s22 offen offset:3072 sc1
  s_add_u32 s22, s20, 81920
  buffer_load_dwordx4 v[184:187], v2, s[8:11], s22 offen offset:0 sc1
  buffer_load_dwordx4 v[188:191], v2, s[8:11], s22 offen offset:1024 sc1
  buffer_load_dwordx4 v[192:195], v2, s[8:11], s22 offen offset:2048 sc1
  buffer_load_dwordx4 v[196:199], v2, s[8:11], s22 offen offset:3072 sc1
  s_add_u32 s22, s20, 86016
  buffer_load_dwordx4 v[200:203], v2, s[8:11], s22 offen offset:0 sc1
  buffer_load_dwordx4 v[204:207], v2, s[8:11], s22 offen offset:1024 sc1
  buffer_load_dwordx4 v[208:211], v2, s[8:11], s22 offen offset:2048 sc1
  buffer_load_dwordx4 v[212:215], v2, s[8:11], s22 offen offset:3072 sc1
  s_add_u32 s22, s20, 90112
  buffer_load_dwordx4 v[216:219], v2, s[8:11], s22 offen offset:0 sc1
  buffer_load_dwordx4 v[220:223], v2, s[8:11], s22 offen offset:1024 sc1
  buffer_load_dwordx4 v[224:227], v2, s[8:11], s22 offen offset:2048 sc1
  buffer_load_dwordx4 v[228:231], v2, s[8:11], s22 offen offset:3072 sc1
  s_add_u32 s22, s20, 94208
  buffer_load_dwordx4 v[232:235], v2, s[8:11], s22 offen offset:0 sc1
  buffer_load_dwordx4 v[236:239], v2, s[8:11], s22 offen offset:1024 sc1
  buffer_load_dwordx4 v[240:243], v2, s[8:11], s22 offen offset:2048 sc1
  buffer_load_dwordx4 v[244:247], v2, s[8:11], s22 offen offset:3072 sc1
  s_waitcnt vmcnt(24)
  s_add_u32 s22, s20, 98304
  buffer_load_dwordx4 v[248:251], v2, s[8:11], s22 offen offset:0 sc1
  buffer_load_dwordx4 v[252:255], v2, s[8:11], s22 offen offset:1024 sc1
  v_mov_b32 v5, 0x4444
  v_mov_b32 v6, 0xeeee
  v_cmp_lt_u32 vcc, 7, v4
  s_nop 1
  v_cndmask_b32 v5, v5, v6, vcc
  s_lshl_b32 s23, s16, 11
  v_lshrrev_b32 v80, 1, v3
  v_and_b32 v81, 1, v3
  v_add_u32 v82, 0, v80
  v_lshl_add_u32 v82, v82, 4, v4
  v_mul_u32_u24 v83, 2341, v82
  v_lshrrev_b32 v83, 16, v83
  v_mul_u32_u24 v84, 28, v83
  v_sub_u32 v84, v82, v84
  v_lshrrev_b32 v85, 4, v84
  v_and_b32 v84, 15, v84
  v_lshlrev_b32 v86, 10, v85
  v_lshl_add_u32 v86, v83, 8, v86
  v_lshl_add_u32 v86, v84, 4, v86
  v_lshl_add_u32 v86, v81, 3, v86
  v_add_u32 v72, s23, v86
  v_add_u32 v82, 2, v80
  v_lshl_add_u32 v82, v82, 4, v4
  v_mul_u32_u24 v83, 2341, v82
  v_lshrrev_b32 v83, 16, v83
  v_mul_u32_u24 v84, 28, v83
  v_sub_u32 v84, v82, v84
  v_lshrrev_b32 v85, 4, v84
  v_and_b32 v84, 15, v84
  v_lshlrev_b32 v86, 10, v85
  v_lshl_add_u32 v86, v83, 8, v86
  v_lshl_add_u32 v86, v84, 4, v86
  v_lshl_add_u32 v86, v81, 3, v86
  v_add_u32 v73, s23, v86
  v_add_u32 v82, 4, v80
  v_lshl_add_u32 v82, v82, 4, v4
  v_mul_u32_u24 v83, 2341, v82
  v_lshrrev_b32 v83, 16, v83
  v_mul_u32_u24 v84, 28, v83
  v_sub_u32 v84, v82, v84
  v_lshrrev_b32 v85, 4, v84
  v_and_b32 v84, 15, v84
  v_lshlrev_b32 v86, 10, v85
  v_lshl_add_u32 v86, v83, 8, v86
  v_lshl_add_u32 v86, v84, 4, v86
  v_lshl_add_u32 v86, v81, 3, v86
  v_add_u32 v74, s23, v86
  v_mov_b32 v82, 6
  v_lshl_add_u32 v82, v82, 4, v4
  v_mul_u32_u24 v83, 2341, v82
  v_lshrrev_b32 v83, 16, v83
  v_mul_u32_u24 v84, 28, v83
  v_sub_u32 v84, v82, v84
  v_lshrrev_b32 v85, 4, v84
  v_and_b32 v84, 15, v84
  v_lshlrev_b32 v86, 10, v85
  v_lshl_add_u32 v86, v83, 8, v86
  v_lshl_add_u32 v86, v84, 4, v86
  v_lshl_add_u32 v86, v81, 3, v86
  v_add_u32 v75, s23, v86
  v_add_u32 v76, s23, v2
  s_mul_i32 s27, s18, 448
  v_mov_b32 v77, s27
  v_mov_b32 v78, 1
  s_mov_b32 s17, s19
  s_mul_i32 s24, s19, 7168
  s_add_u32 s24, s24, 88068096
  s_mul_i32 s25, s18, 65
  s_add_u32 s25, s25, s19
  s_lshl_b32 s25, s25, 13
  s_add_u32 s25, s25, s23
  s_add_u32 s25, s25, 76935168
  s_lshl_b32 s26, s18, 6
  s_add_u32 s26, s26, s19
  s_lshl_b32 s26, s26, 4
  s_lshl_b32 s27, s16, 2
  s_add_u32 s26, s26, s27
  s_add_u32 s26, s26, 88569856
ws_loop:
  v_mov_b32 v36, 0
  v_mov_b32 v37, 0
  v_mov_b32 v38, 0
  v_mov_b32 v39, 0
  v_mov_b32 v40, 0
  v_mov_b32 v41, 0
  v_mov_b32 v42, 0
  v_mov_b32 v43, 0
  v_mov_b32 v44, 0
  v_mov_b32 v45, 0
  v_mov_b32 v46, 0
  v_mov_b32 v47, 0
  v_mov_b32 v48, 0
  v_mov_b32 v49, 0
  v_mov_b32 v50, 0
  v_mov_b32 v51, 0
  v_mov_b32 v52, 0
  v_mov_b32 v53, 0
  v_mov_b32 v54, 0
  v_mov_b32 v55, 0
  v_mov_b32 v56, 0
  v_mov_b32 v57, 0
  v_mov_b32 v58, 0
  v_mov_b32 v59, 0
  v_mov_b32 v60, 0
  v_mov_b32 v61, 0
  v_mov_b32 v62, 0
  v_mov_b32 v63, 0
  s_mov_b32 s30, 0
  s_branch ws_fl
ws_pm:
  buffer_load_dword v79, v77, s[8:11], s24 offen sc1
  s_waitcnt vmcnt(0)
  v_cmp_eq_u32 vcc, -1, v79
  s_cbranch_vccnz ws_pr
ws_fl:
  s_add_u32 s22, s24, 4096
  buffer_load_dwordx4 v[8:11], v2, s[8:11], s24 offen offset:0 sc1
  buffer_load_dwordx4 v[12:15], v2, s[8:11], s24 offen offset:1024 sc1
  buffer_load_dwordx4 v[16:19], v2, s[8:11], s24 offen offset:2048 sc1
  buffer_load_dwordx4 v[20:23], v2, s[8:11], s24 offen offset:3072 sc1
  buffer_load_dwordx4 v[24:27], v2, s[8:11], s22 offen offset:0 sc1
  buffer_load_dwordx4 v[28:31], v2, s[8:11], s22 offen offset:1024 sc1
  buffer_load_dwordx4 v[32:35], v2, s[8:11], s22 offen offset:2048 sc1
  s_waitcnt vmcnt(0)
  v_max_u32 v79, v8, v9
  v_max3_u32 v79, v79, v10, v11
  v_max3_u32 v79, v79, v12, v13
  v_max3_u32 v79, v79, v14, v15
  v_max3_u32 v79, v79, v16, v17
  v_max3_u32 v79, v79, v18, v19
  v_max3_u32 v79, v79, v20, v21
  v_max3_u32 v79, v79, v22, v23
  v_max3_u32 v79, v79, v24, v25
  v_max3_u32 v79, v79, v26, v27
  v_max3_u32 v79, v79, v28, v29
  v_max3_u32 v79, v79, v30, v31
  v_max3_u32 v79, v79, v32, v33
  v_max3_u32 v79, v79, v34, v35
  v_cmp_eq_u32 vcc, -1, v79
  s_cbranch_vccz ws_pk
ws_pr:
  s_sleep 6
  s_add_u32 s30, s30, 1
  s_cmp_lt_u32 s30, 30000
  s_cbranch_scc1 ws_pm
  s_branch cA_abort
ws_pk:
  v_smfmac_f32_16x16x64_bf16 v[36:39], v[8:11], a[0:7], v5
  v_smfmac_f32_16x16x64_bf16 v[36:39], v[12:15], a[8:15], v5
  v_smfmac_f32_16x16x64_bf16 v[36:39], v[16:19], a[16:23], v5
  v_smfmac_f32_16x16x64_bf16 v[36:39], v[20:23], a[24:31], v5
  v_smfmac_f32_16x16x64_bf16 v[36:39], v[24:27], a[32:39], v5
  v_smfmac_f32_16x16x64_bf16 v[36:39], v[28:31], a[40:47], v5
  v_smfmac_f32_16x16x64_bf16 v[36:39], v[32:35], a[48:55], v5
  v_smfmac_f32_16x16x64_bf16 v[40:43], v[8:11], a[56:63], v5
  v_smfmac_f32_16x16x64_bf16 v[40:43], v[12:15], a[64:71], v5
  v_smfmac_f32_16x16x64_bf16 v[40:43], v[16:19], a[72:79], v5
  v_smfmac_f32_16x16x64_bf16 v[40:43], v[20:23], a[80:87], v5
  v_smfmac_f32_16x16x64_bf16 v[40:43], v[24:27], a[88:95], v5
  v_smfmac_f32_16x16x64_bf16 v[40:43], v[28:31], a[96:103], v5
  v_smfmac_f32_16x16x64_bf16 v[40:43], v[32:35], a[104:111], v5
  v_smfmac_f32_16x16x64_bf16 v[44:47], v[8:11], a[112:119], v5
  v_smfmac_f32_16x16x64_bf16 v[44:47], v[12:15], a[120:127], v5
  v_smfmac_f32_16x16x64_bf16 v[44:47], v[16:19], a[128:135], v5
  v_smfmac_f32_16x16x64_bf16 v[44:47], v[20:23], a[136:143], v5
  v_smfmac_f32_16x16x64_bf16 v[44:47], v[24:27], a[144:151], v5
  v_smfmac_f32_16x16x64_bf16 v[44:47], v[28:31], a[152:159], v5
  v_smfmac_f32_16x16x64_bf16 v[44:47], v[32:35], a[160:167], v5
  v_smfmac_f32_16x16x64_bf16 v[48:51], v[8:11], a[168:175], v5
  v_smfmac_f32_16x16x64_bf16 v[48:51], v[12:15], a[176:183], v5
  v_smfmac_f32_16x16x64_bf16 v[48:51], v[16:19], a[184:191], v5
  v_smfmac_f32_16x16x64_bf16 v[48:51], v[20:23], a[192:199], v5
  v_smfmac_f32_16x16x64_bf16 v[48:51], v[24:27], a[200:207], v5
  v_smfmac_f32_16x16x64_bf16 v[48:51], v[28:31], a[208:215], v5
  v_smfmac_f32_16x16x64_bf16 v[48:51], v[32:35], a[216:223], v5
  v_smfmac_f32_16x16x64_bf16 v[52:55], v[8:11], a[224:231], v5
  v_smfmac_f32_16x16x64_bf16 v[52:55], v[12:15], a[232:239], v5
  v_smfmac_f32_16x16x64_bf16 v[52:55], v[16:19], a[240:247], v5
  v_smfmac_f32_16x16x64_bf16 v[52:55], v[20:23], a[248:255], v5
  v_smfmac_f32_16x16x64_bf16 v[52:55], v[24:27], v[120:127], v5
  v_smfmac_f32_16x16x64_bf16 v[52:55], v[28:31], v[128:135], v5
  v_smfmac_f32_16x16x64_bf16 v[52:55], v[32:35], v[136:143], v5
  v_smfmac_f32_16x16x64_bf16 v[56:59], v[8:11], v[144:151], v5
  v_smfmac_f32_16x16x64_bf16 v[56:59], v[12:15], v[152:159], v5
  v_smfmac_f32_16x16x64_bf16 v[56:59], v[16:19], v[160:167], v5
  v_smfmac_f32_16x16x64_bf16 v[56:59], v[20:23], v[168:175], v5
  v_smfmac_f32_16x16x64_bf16 v[56:59], v[24:27], v[176:183], v5
  v_smfmac_f32_16x16x64_bf16 v[56:59], v[28:31], v[184:191], v5
  v_smfmac_f32_16x16x64_bf16 v[56:59], v[32:35], v[192:199], v5
  v_smfmac_f32_16x16x64_bf16 v[60:63], v[8:11], v[200:207], v5
  v_smfmac_f32_16x16x64_bf16 v[60:63], v[12:15], v[208:215], v5
  v_smfmac_f32_16x16x64_bf16 v[60:63], v[16:19], v[216:223], v5
  v_smfmac_f32_16x16x64_bf16 v[60:63], v[20:23], v[224:231], v5
  v_smfmac_f32_16x16x64_bf16 v[60:63], v[24:27], v[232:239], v5
  v_smfmac_f32_16x16x64_bf16 v[60:63], v[28:31], v[240:247], v5
  v_smfmac_f32_16x16x64_bf16 v[60:63], v[32:35], v[248:255], v5
  v_permlane32_swap_b32 v36, v40
  v_permlane32_swap_b32 v37, v41
  v_permlane32_swap_b32 v38, v42
  v_permlane32_swap_b32 v39, v43
  v_add_f32 v36, v36, v40
  v_add_f32 v37, v37, v41
  v_add_f32 v38, v38, v42
  v_add_f32 v39, v39, v43
  v_cvt_pk_bf16_f32 v40, v36, v37
  v_cvt_pk_bf16_f32 v41, v38, v39
  ds_write_b64 v72, v[40:41]
  v_permlane32_swap_b32 v44, v48
  v_permlane32_swap_b32 v45, v49
  v_permlane32_swap_b32 v46, v50
  v_permlane32_swap_b32 v47, v51
  v_add_f32 v44, v44, v48
  v_add_f32 v45, v45, v49
  v_add_f32 v46, v46, v50
  v_add_f32 v47, v47, v51
  v_cvt_pk_bf16_f32 v48, v44, v45
  v_cvt_pk_bf16_f32 v49, v46, v47
  ds_write_b64 v73, v[48:49]
  v_permlane32_swap_b32 v52, v56
  v_permlane32_swap_b32 v53, v57
  v_permlane32_swap_b32 v54, v58
  v_permlane32_swap_b32 v55, v59
  v_add_f32 v52, v52, v56
  v_add_f32 v53, v53, v57
  v_add_f32 v54, v54, v58
  v_add_f32 v55, v55, v59
  v_cvt_pk_bf16_f32 v56, v52, v53
  v_cvt_pk_bf16_f32 v57, v54, v55
  ds_write_b64 v74, v[56:57]
  v_mov_b32 v64, v60
  v_mov_b32 v65, v61
  v_mov_b32 v66, v62
  v_mov_b32 v67, v63
  v_permlane32_swap_b32 v60, v64
  v_permlane32_swap_b32 v61, v65
  v_permlane32_swap_b32 v62, v66
  v_permlane32_swap_b32 v63, v67
  v_add_f32 v60, v60, v64
  v_add_f32 v61, v61, v65
  v_add_f32 v62, v62, v66
  v_add_f32 v63, v63, v67
  v_cvt_pk_bf16_f32 v64, v60, v61
  v_cvt_pk_bf16_f32 v65, v62, v63
  ds_write_b64 v75, v[64:65]
  s_waitcnt lgkmcnt(0)
  ds_read_b128 v[64:67], v76
  ds_read_b128 v[68:71], v76 offset:1024
  s_waitcnt lgkmcnt(0)
  buffer_store_dwordx4 v[64:67], v2, s[8:11], s25 offen sc1
  buffer_store_dwordx4 v[68:71], v2, s[8:11], s25 offen offset:1024 sc1
  s_waitcnt vmcnt(0)
  s_mov_b64 exec, 1
  buffer_store_dword v78, v2, s[8:11], s26 offen sc1
  s_mov_b64 exec, -1
  s_add_u32 s24, s24, 14336
  s_add_u32 s25, s25, 16384
  s_add_u32 s26, s26, 32
  s_add_u32 s17, s17, 2
  s_cmp_lt_u32 s17, 64
  s_cbranch_scc1 ws_loop
  v_mov_b32 v250, 0
  s_branch wk_loop
wk_s4d:
  s_sub_u32 s3, s3, 624
  s_load_dwordx8 s[40:47], s[0:1], 0
  s_load_dwordx4 s[48:51], s[0:1], 32
  s_load_dwordx2 s[52:53], s[0:1], 48
  s_load_dwordx2 s[54:55], s[0:1], 112
  v_lshrrev_b32 v1, 6, v0
  s_nop 0
  v_readfirstlane_b32 s16, v1
  v_and_b32 v1, 63, v0
  v_lshrrev_b32 v3, 4, v1
  v_and_b32 v4, 15, v1
  s_mul_i32 s17, s16, 24576
  s_waitcnt lgkmcnt(0)
  s_mov_b32 s60, s40
  s_and_b32 s61, s41, 0xffff
  s_mov_b32 s62, 1835008
  s_mov_b32 s63, 0x20000
  s_mov_b32 s64, s42
  s_and_b32 s65, s43, 0xffff
  s_mov_b32 s66, 229376
  s_mov_b32 s67, 0x20000
  s_mov_b32 s68, s44
  s_and_b32 s69, s45, 0xffff
  s_mov_b32 s70, 229376
  s_mov_b32 s71, 0x20000
  s_mov_b32 s72, s46
  s_and_b32 s73, s47, 0xffff
  s_mov_b32 s74, 229376
  s_mov_b32 s75, 0x20000
  s_mov_b32 s76, s48
  s_and_b32 s77, s49, 0xffff
  s_mov_b32 s78, 229376
  s_mov_b32 s79, 0x20000
  s_mov_b32 s80, s50
  s_and_b32 s81, s51, 0xffff
  s_mov_b32 s82, 896
  s_mov_b32 s83, 0x20000
  s_mov_b32 s84, s52
  s_and_b32 s85, s53, 0xffff
  s_mov_b32 s86, 896
  s_mov_b32 s87, 0x20000
  s_mov_b32 s92, s54
  s_and_b32 s93, s55, 0xffff
  s_mov_b32 s94, 3670016
  s_mov_b32 s95, 0x20000
  v_lshlrev_b32 v5, 5, v1
  v_sub_u32 v5, 2047, v5
  s_add_u32 s18, s17, 13056
  v_subrev_u32 v6, 0, v5
  v_max_i32 v7, 0, v6
  v_cvt_f32_u32 v7, v7
  v_cvt_pk_bf16_f32 v8, v7, v7
  v_and_b32 v7, 0xffff0000, v8
  v_lshrrev_b32 v8, 23, v7
  v_subrev_u32 v8, 134, v8
  v_max_i32 v8, 0, v8
  v_cvt_u32_f32 v7, v7
  v_lshrrev_b32 v7, v8, v7
  v_lshl_add_u32 v7, v8, 8, v7
  v_lshl_add_u32 v200, v7, 2, s18
  v_subrev_u32 v6, 1, v5
  v_max_i32 v7, 0, v6
  v_cvt_f32_u32 v7, v7
  v_cvt_pk_bf16_f32 v8, v7, v7
  v_and_b32 v7, 0xffff0000, v8
  v_lshrrev_b32 v8, 23, v7
  v_subrev_u32 v8, 134, v8
  v_max_i32 v8, 0, v8
  v_cvt_u32_f32 v7, v7
  v_lshrrev_b32 v7, v8, v7
  v_lshl_add_u32 v7, v8, 8, v7
  v_lshl_add_u32 v201, v7, 2, s18
  v_subrev_u32 v6, 2, v5
  v_max_i32 v7, 0, v6
  v_cvt_f32_u32 v7, v7
  v_cvt_pk_bf16_f32 v8, v7, v7
  v_and_b32 v7, 0xffff0000, v8
  v_lshrrev_b32 v8, 23, v7
  v_subrev_u32 v8, 134, v8
  v_max_i32 v8, 0, v8
  v_cvt_u32_f32 v7, v7
  v_lshrrev_b32 v7, v8, v7
  v_lshl_add_u32 v7, v8, 8, v7
  v_lshl_add_u32 v202, v7, 2, s18
  v_subrev_u32 v6, 3, v5
  v_max_i32 v7, 0, v6
  v_cvt_f32_u32 v7, v7
  v_cvt_pk_bf16_f32 v8, v7, v7
  v_and_b32 v7, 0xffff0000, v8
  v_lshrrev_b32 v8, 23, v7
  v_subrev_u32 v8, 134, v8
  v_max_i32 v8, 0, v8
  v_cvt_u32_f32 v7, v7
  v_lshrrev_b32 v7, v8, v7
  v_lshl_add_u32 v7, v8, 8, v7
  v_lshl_add_u32 v203, v7, 2, s18
  v_subrev_u32 v6, 4, v5
  v_max_i32 v7, 0, v6
  v_cvt_f32_u32 v7, v7
  v_cvt_pk_bf16_f32 v8, v7, v7
  v_and_b32 v7, 0xffff0000, v8
  v_lshrrev_b32 v8, 23, v7
  v_subrev_u32 v8, 134, v8
  v_max_i32 v8, 0, v8
  v_cvt_u32_f32 v7, v7
  v_lshrrev_b32 v7, v8, v7
  v_lshl_add_u32 v7, v8, 8, v7
  v_lshl_add_u32 v204, v7, 2, s18
  v_subrev_u32 v6, 5, v5
  v_max_i32 v7, 0, v6
  v_cvt_f32_u32 v7, v7
  v_cvt_pk_bf16_f32 v8, v7, v7
  v_and_b32 v7, 0xffff0000, v8
  v_lshrrev_b32 v8, 23, v7
  v_subrev_u32 v8, 134, v8
  v_max_i32 v8, 0, v8
  v_cvt_u32_f32 v7, v7
  v_lshrrev_b32 v7, v8, v7
  v_lshl_add_u32 v7, v8, 8, v7
  v_lshl_add_u32 v205, v7, 2, s18
  v_subrev_u32 v6, 6, v5
  v_max_i32 v7, 0, v6
  v_cvt_f32_u32 v7, v7
  v_cvt_pk_bf16_f32 v8, v7, v7
  v_and_b32 v7, 0xffff0000, v8
  v_lshrrev_b32 v8, 23, v7
  v_subrev_u32 v8, 134, v8
  v_max_i32 v8, 0, v8
  v_cvt_u32_f32 v7, v7
  v_lshrrev_b32 v7, v8, v7
  v_lshl_add_u32 v7, v8, 8, v7
  v_lshl_add_u32 v206, v7, 2, s18
  v_subrev_u32 v6, 7, v5
  v_max_i32 v7, 0, v6
  v_cvt_f32_u32 v7, v7
  v_cvt_pk_bf16_f32 v8, v7, v7
  v_and_b32 v7, 0xffff0000, v8
  v_lshrrev_b32 v8, 23, v7
  v_subrev_u32 v8, 134, v8
  v_max_i32 v8, 0, v8
  v_cvt_u32_f32 v7, v7
  v_lshrrev_b32 v7, v8, v7
  v_lshl_add_u32 v7, v8, 8, v7
  v_lshl_add_u32 v207, v7, 2, s18
  v_subrev_u32 v6, 8, v5
  v_max_i32 v7, 0, v6
  v_cvt_f32_u32 v7, v7
  v_cvt_pk_bf16_f32 v8, v7, v7
  v_and_b32 v7, 0xffff0000, v8
  v_lshrrev_b32 v8, 23, v7
  v_subrev_u32 v8, 134, v8
  v_max_i32 v8, 0, v8
  v_cvt_u32_f32 v7, v7
  v_lshrrev_b32 v7, v8, v7
  v_lshl_add_u32 v7, v8, 8, v7
  v_lshl_add_u32 v208, v7, 2, s18
  v_subrev_u32 v6, 9, v5
  v_max_i32 v7, 0, v6
  v_cvt_f32_u32 v7, v7
  v_cvt_pk_bf16_f32 v8, v7, v7
  v_and_b32 v7, 0xffff0000, v8
  v_lshrrev_b32 v8, 23, v7
  v_subrev_u32 v8, 134, v8
  v_max_i32 v8, 0, v8
  v_cvt_u32_f32 v7, v7
  v_lshrrev_b32 v7, v8, v7
  v_lshl_add_u32 v7, v8, 8, v7
  v_lshl_add_u32 v209, v7, 2, s18
  v_subrev_u32 v6, 10, v5
  v_max_i32 v7, 0, v6
  v_cvt_f32_u32 v7, v7
  v_cvt_pk_bf16_f32 v8, v7, v7
  v_and_b32 v7, 0xffff0000, v8
  v_lshrrev_b32 v8, 23, v7
  v_subrev_u32 v8, 134, v8
  v_max_i32 v8, 0, v8
  v_cvt_u32_f32 v7, v7
  v_lshrrev_b32 v7, v8, v7
  v_lshl_add_u32 v7, v8, 8, v7
  v_lshl_add_u32 v210, v7, 2, s18
  v_subrev_u32 v6, 11, v5
  v_max_i32 v7, 0, v6
  v_cvt_f32_u32 v7, v7
  v_cvt_pk_bf16_f32 v8, v7, v7
  v_and_b32 v7, 0xffff0000, v8
  v_lshrrev_b32 v8, 23, v7
  v_subrev_u32 v8, 134, v8
  v_max_i32 v8, 0, v8
  v_cvt_u32_f32 v7, v7
  v_lshrrev_b32 v7, v8, v7
  v_lshl_add_u32 v7, v8, 8, v7
  v_lshl_add_u32 v211, v7, 2, s18
  v_subrev_u32 v6, 12, v5
  v_max_i32 v7, 0, v6
  v_cvt_f32_u32 v7, v7
  v_cvt_pk_bf16_f32 v8, v7, v7
  v_and_b32 v7, 0xffff0000, v8
  v_lshrrev_b32 v8, 23, v7
  v_subrev_u32 v8, 134, v8
  v_max_i32 v8, 0, v8
  v_cvt_u32_f32 v7, v7
  v_lshrrev_b32 v7, v8, v7
  v_lshl_add_u32 v7, v8, 8, v7
  v_lshl_add_u32 v212, v7, 2, s18
  v_subrev_u32 v6, 13, v5
  v_max_i32 v7, 0, v6
  v_cvt_f32_u32 v7, v7
  v_cvt_pk_bf16_f32 v8, v7, v7
  v_and_b32 v7, 0xffff0000, v8
  v_lshrrev_b32 v8, 23, v7
  v_subrev_u32 v8, 134, v8
  v_max_i32 v8, 0, v8
  v_cvt_u32_f32 v7, v7
  v_lshrrev_b32 v7, v8, v7
  v_lshl_add_u32 v7, v8, 8, v7
  v_lshl_add_u32 v213, v7, 2, s18
  v_subrev_u32 v6, 14, v5
  v_max_i32 v7, 0, v6
  v_cvt_f32_u32 v7, v7
  v_cvt_pk_bf16_f32 v8, v7, v7
  v_and_b32 v7, 0xffff0000, v8
  v_lshrrev_b32 v8, 23, v7
  v_subrev_u32 v8, 134, v8
  v_max_i32 v8, 0, v8
  v_cvt_u32_f32 v7, v7
  v_lshrrev_b32 v7, v8, v7
  v_lshl_add_u32 v7, v8, 8, v7
  v_lshl_add_u32 v214, v7, 2, s18
  v_subrev_u32 v6, 15, v5
  v_max_i32 v7, 0, v6
  v_cvt_f32_u32 v7, v7
  v_cvt_pk_bf16_f32 v8, v7, v7
  v_and_b32 v7, 0xffff0000, v8
  v_lshrrev_b32 v8, 23, v7
  v_subrev_u32 v8, 134, v8
  v_max_i32 v8, 0, v8
  v_cvt_u32_f32 v7, v7
  v_lshrrev_b32 v7, v8, v7
  v_lshl_add_u32 v7, v8, 8, v7
  v_lshl_add_u32 v215, v7, 2, s18
  v_subrev_u32 v6, 16, v5
  v_max_i32 v7, 0, v6
  v_cvt_f32_u32 v7, v7
  v_cvt_pk_bf16_f32 v8, v7, v7
  v_and_b32 v7, 0xffff0000, v8
  v_lshrrev_b32 v8, 23, v7
  v_subrev_u32 v8, 134, v8
  v_max_i32 v8, 0, v8
  v_cvt_u32_f32 v7, v7
  v_lshrrev_b32 v7, v8, v7
  v_lshl_add_u32 v7, v8, 8, v7
  v_lshl_add_u32 v216, v7, 2, s18
  v_subrev_u32 v6, 17, v5
  v_max_i32 v7, 0, v6
  v_cvt_f32_u32 v7, v7
  v_cvt_pk_bf16_f32 v8, v7, v7
  v_and_b32 v7, 0xffff0000, v8
  v_lshrrev_b32 v8, 23, v7
  v_subrev_u32 v8, 134, v8
  v_max_i32 v8, 0, v8
  v_cvt_u32_f32 v7, v7
  v_lshrrev_b32 v7, v8, v7
  v_lshl_add_u32 v7, v8, 8, v7
  v_lshl_add_u32 v217, v7, 2, s18
  v_subrev_u32 v6, 18, v5
  v_max_i32 v7, 0, v6
  v_cvt_f32_u32 v7, v7
  v_cvt_pk_bf16_f32 v8, v7, v7
  v_and_b32 v7, 0xffff0000, v8
  v_lshrrev_b32 v8, 23, v7
  v_subrev_u32 v8, 134, v8
  v_max_i32 v8, 0, v8
  v_cvt_u32_f32 v7, v7
  v_lshrrev_b32 v7, v8, v7
  v_lshl_add_u32 v7, v8, 8, v7
  v_lshl_add_u32 v218, v7, 2, s18
  v_subrev_u32 v6, 19, v5
  v_max_i32 v7, 0, v6
  v_cvt_f32_u32 v7, v7
  v_cvt_pk_bf16_f32 v8, v7, v7
  v_and_b32 v7, 0xffff0000, v8
  v_lshrrev_b32 v8, 23, v7
  v_subrev_u32 v8, 134, v8
  v_max_i32 v8, 0, v8
  v_cvt_u32_f32 v7, v7
  v_lshrrev_b32 v7, v8, v7
  v_lshl_add_u32 v7, v8, 8, v7
  v_lshl_add_u32 v219, v7, 2, s18
  v_subrev_u32 v6, 20, v5
  v_max_i32 v7, 0, v6
  v_cvt_f32_u32 v7, v7
  v_cvt_pk_bf16_f32 v8, v7, v7
  v_and_b32 v7, 0xffff0000, v8
  v_lshrrev_b32 v8, 23, v7
  v_subrev_u32 v8, 134, v8
  v_max_i32 v8, 0, v8
  v_cvt_u32_f32 v7, v7
  v_lshrrev_b32 v7, v8, v7
  v_lshl_add_u32 v7, v8, 8, v7
  v_lshl_add_u32 v220, v7, 2, s18
  v_subrev_u32 v6, 21, v5
  v_max_i32 v7, 0, v6
  v_cvt_f32_u32 v7, v7
  v_cvt_pk_bf16_f32 v8, v7, v7
  v_and_b32 v7, 0xffff0000, v8
  v_lshrrev_b32 v8, 23, v7
  v_subrev_u32 v8, 134, v8
  v_max_i32 v8, 0, v8
  v_cvt_u32_f32 v7, v7
  v_lshrrev_b32 v7, v8, v7
  v_lshl_add_u32 v7, v8, 8, v7
  v_lshl_add_u32 v221, v7, 2, s18
  v_subrev_u32 v6, 22, v5
  v_max_i32 v7, 0, v6
  v_cvt_f32_u32 v7, v7
  v_cvt_pk_bf16_f32 v8, v7, v7
  v_and_b32 v7, 0xffff0000, v8
  v_lshrrev_b32 v8, 23, v7
  v_subrev_u32 v8, 134, v8
  v_max_i32 v8, 0, v8
  v_cvt_u32_f32 v7, v7
  v_lshrrev_b32 v7, v8, v7
  v_lshl_add_u32 v7, v8, 8, v7
  v_lshl_add_u32 v222, v7, 2, s18
  v_subrev_u32 v6, 23, v5
  v_max_i32 v7, 0, v6
  v_cvt_f32_u32 v7, v7
  v_cvt_pk_bf16_f32 v8, v7, v7
  v_and_b32 v7, 0xffff0000, v8
  v_lshrrev_b32 v8, 23, v7
  v_subrev_u32 v8, 134, v8
  v_max_i32 v8, 0, v8
  v_cvt_u32_f32 v7, v7
  v_lshrrev_b32 v7, v8, v7
  v_lshl_add_u32 v7, v8, 8, v7
  v_lshl_add_u32 v223, v7, 2, s18
  v_subrev_u32 v6, 24, v5
  v_max_i32 v7, 0, v6
  v_cvt_f32_u32 v7, v7
  v_cvt_pk_bf16_f32 v8, v7, v7
  v_and_b32 v7, 0xffff0000, v8
  v_lshrrev_b32 v8, 23, v7
  v_subrev_u32 v8, 134, v8
  v_max_i32 v8, 0, v8
  v_cvt_u32_f32 v7, v7
  v_lshrrev_b32 v7, v8, v7
  v_lshl_add_u32 v7, v8, 8, v7
  v_lshl_add_u32 v224, v7, 2, s18
  v_subrev_u32 v6, 25, v5
  v_max_i32 v7, 0, v6
  v_cvt_f32_u32 v7, v7
  v_cvt_pk_bf16_f32 v8, v7, v7
  v_and_b32 v7, 0xffff0000, v8
  v_lshrrev_b32 v8, 23, v7
  v_subrev_u32 v8, 134, v8
  v_max_i32 v8, 0, v8
  v_cvt_u32_f32 v7, v7
  v_lshrrev_b32 v7, v8, v7
  v_lshl_add_u32 v7, v8, 8, v7
  v_lshl_add_u32 v225, v7, 2, s18
  v_subrev_u32 v6, 26, v5
  v_max_i32 v7, 0, v6
  v_cvt_f32_u32 v7, v7
  v_cvt_pk_bf16_f32 v8, v7, v7
  v_and_b32 v7, 0xffff0000, v8
  v_lshrrev_b32 v8, 23, v7
  v_subrev_u32 v8, 134, v8
  v_max_i32 v8, 0, v8
  v_cvt_u32_f32 v7, v7
  v_lshrrev_b32 v7, v8, v7
  v_lshl_add_u32 v7, v8, 8, v7
  v_lshl_add_u32 v226, v7, 2, s18
  v_subrev_u32 v6, 27, v5
  v_max_i32 v7, 0, v6
  v_cvt_f32_u32 v7, v7
  v_cvt_pk_bf16_f32 v8, v7, v7
  v_and_b32 v7, 0xffff0000, v8
  v_lshrrev_b32 v8, 23, v7
  v_subrev_u32 v8, 134, v8
  v_max_i32 v8, 0, v8
  v_cvt_u32_f32 v7, v7
  v_lshrrev_b32 v7, v8, v7
  v_lshl_add_u32 v7, v8, 8, v7
  v_lshl_add_u32 v227, v7, 2, s18
  v_subrev_u32 v6, 28, v5
  v_max_i32 v7, 0, v6
  v_cvt_f32_u32 v7, v7
  v_cvt_pk_bf16_f32 v8, v7, v7
  v_and_b32 v7, 0xffff0000, v8
  v_lshrrev_b32 v8, 23, v7
  v_subrev_u32 v8, 134, v8
  v_max_i32 v8, 0, v8
  v_cvt_u32_f32 v7, v7
  v_lshrrev_b32 v7, v8, v7
  v_lshl_add_u32 v7, v8, 8, v7
  v_lshl_add_u32 v228, v7, 2, s18
  v_subrev_u32 v6, 29, v5
  v_max_i32 v7, 0, v6
  v_cvt_f32_u32 v7, v7
  v_cvt_pk_bf16_f32 v8, v7, v7
  v_and_b32 v7, 0xffff0000, v8
  v_lshrrev_b32 v8, 23, v7
  v_subrev_u32 v8, 134, v8
  v_max_i32 v8, 0, v8
  v_cvt_u32_f32 v7, v7
  v_lshrrev_b32 v7, v8, v7
  v_lshl_add_u32 v7, v8, 8, v7
  v_lshl_add_u32 v229, v7, 2, s18
  v_subrev_u32 v6, 30, v5
  v_max_i32 v7, 0, v6
  v_cvt_f32_u32 v7, v7
  v_cvt_pk_bf16_f32 v8, v7, v7
  v_and_b32 v7, 0xffff0000, v8
  v_lshrrev_b32 v8, 23, v7
  v_subrev_u32 v8, 134, v8
  v_max_i32 v8, 0, v8
  v_cvt_u32_f32 v7, v7
  v_lshrrev_b32 v7, v8, v7
  v_lshl_add_u32 v7, v8, 8, v7
  v_lshl_add_u32 v230, v7, 2, s18
  v_subrev_u32 v6, 31, v5
  v_max_i32 v7, 0, v6
  v_cvt_f32_u32 v7, v7
  v_cvt_pk_bf16_f32 v8, v7, v7
  v_and_b32 v7, 0xffff0000, v8
  v_lshrrev_b32 v8, 23, v7
  v_subrev_u32 v8, 134, v8
  v_max_i32 v8, 0, v8
  v_cvt_u32_f32 v7, v7
  v_lshrrev_b32 v7, v8, v7
  v_lshl_add_u32 v7, v8, 8, v7
  v_lshl_add_u32 v231, v7, 2, s18
  v_subrev_u32 v6, 32, v5
  v_max_i32 v7, 0, v6
  v_cvt_f32_u32 v7, v7
  v_cvt_pk_bf16_f32 v8, v7, v7
  v_and_b32 v7, 0xffff0000, v8
  v_lshrrev_b32 v8, 23, v7
  v_subrev_u32 v8, 134, v8
  v_max_i32 v8, 0, v8
  v_cvt_u32_f32 v7, v7
  v_lshrrev_b32 v7, v8, v7
  v_lshl_add_u32 v7, v8, 8, v7
  v_mov_b32 v8, 1280
  v_cmp_gt_i32 vcc, 0, v6
  s_nop 1
  v_cndmask_b32 v7, v7, v8, vcc
  v_lshl_add_u32 v232, v7, 2, s18
  v_mov_b32 v8, 0
  v_mov_b32 v9, 0
  v_lshlrev_b32 v5, 3, v1
  v_add_u32 v5, s17, v5
  ds_write_b64 v5, v[8:9]
  v_and_b32 v6, 15, v1
  v_lshlrev_b32 v6, 3, v6
  v_add_u32 v6, s17, v6
  ds_write_b64 v6, v[8:9] offset:8704
  ds_write_b64 v6, v[8:9] offset:12928
  v_mov_b32 v6, s17
  ds_write_b64 v6, v[8:9] offset:18176
  s_lshl_b32 s19, s3, 2
  s_add_u32 s20, s19, s16
  s_lshl_b32 s21, s3, 3
  v_mul_u32_u24 v5, 3584, v0
  s_add_u32 s22, s21, 0
  buffer_load_dwordx2 v[8:9], v5, s[60:63], s22 offen offset:0
  buffer_load_dwordx2 v[10:11], v5, s[60:63], s22 offen offset:896
  buffer_load_dwordx2 v[12:13], v5, s[60:63], s22 offen offset:1792
  buffer_load_dwordx2 v[14:15], v5, s[60:63], s22 offen offset:2688
  s_add_u32 s22, s21, 917504
  buffer_load_dwordx2 v[16:17], v5, s[60:63], s22 offen offset:0
  buffer_load_dwordx2 v[18:19], v5, s[60:63], s22 offen offset:896
  buffer_load_dwordx2 v[20:21], v5, s[60:63], s22 offen offset:1792
  buffer_load_dwordx2 v[22:23], v5, s[60:63], s22 offen offset:2688
  s_lshl_b32 s22, s20, 9
  v_lshlrev_b32 v6, 3, v1
  buffer_load_dwordx2 v[24:25], v6, s[64:67], s22 offen
  buffer_load_dwordx2 v[26:27], v6, s[68:71], s22 offen
  buffer_load_dwordx2 v[28:29], v6, s[72:75], s22 offen
  buffer_load_dwordx2 v[30:31], v6, s[76:79], s22 offen
  s_lshl_b32 s22, s20, 1
  v_mov_b32 v7, 0
  buffer_load_ushort v32, v7, s[80:83], s22 offen
  buffer_load_ushort v33, v7, s[84:87], s22 offen
  s_mov_b32 s24, 0x05040100
  s_mov_b32 s25, 0x07060302
  s_barrier
  s_waitcnt vmcnt(6)
  v_lshlrev_b32 v6, 3, v0
  v_perm_b32 v34, v10, v8, s24
  v_perm_b32 v35, v14, v12, s24
  v_add_u32 v36, 512, v6
  ds_write_b64 v36, v[34:35]
  v_perm_b32 v34, v10, v8, s25
  v_perm_b32 v35, v14, v12, s25
  v_add_u32 v36, 25088, v6
  ds_write_b64 v36, v[34:35]
  v_perm_b32 v34, v11, v9, s24
  v_perm_b32 v35, v15, v13, s24
  v_add_u32 v36, 49664, v6
  ds_write_b64 v36, v[34:35]
  v_perm_b32 v34, v11, v9, s25
  v_perm_b32 v35, v15, v13, s25
  v_add_u32 v36, 74240, v6
  ds_write_b64 v36, v[34:35]
  v_perm_b32 v34, v18, v16, s24
  v_perm_b32 v35, v22, v20, s24
  v_add_u32 v36, 2560, v6
  ds_write_b64 v36, v[34:35]
  v_perm_b32 v34, v18, v16, s25
  v_perm_b32 v35, v22, v20, s25
  v_add_u32 v36, 27136, v6
  ds_write_b64 v36, v[34:35]
  v_perm_b32 v34, v19, v17, s24
  v_perm_b32 v35, v23, v21, s24
  v_add_u32 v36, 51712, v6
  ds_write_b64 v36, v[34:35]
  v_perm_b32 v34, v19, v17, s25
  v_perm_b32 v35, v23, v21, s25
  v_add_u32 v36, 76288, v6
  ds_write_b64 v36, v[34:35]
  s_waitcnt vmcnt(0)
  s_mov_b32 s26, 1069066811
  s_mov_b32 s27, 1042479491
  v_lshlrev_b32 v32, 16, v32
  v_lshlrev_b32 v33, 16, v33
  v_mul_f32 v32, s26, v32
  v_exp_f32 v32, v32
  s_nop 0
  v_cvt_pk_bf16_f32 v34, v32, v32
  v_and_b32 v32, 0xffff0000, v34
  v_lshlrev_b32 v37, 6, v1
  v_add_u32 v37, s17, v37
  v_lshlrev_b32 v40, 16, v24
  v_lshlrev_b32 v41, 16, v26
  v_lshlrev_b32 v42, 16, v28
  v_lshlrev_b32 v43, 16, v30
  v_mul_f32 v40, s26, v40
  v_exp_f32 v40, v40
  s_nop 0
  v_cvt_pk_bf16_f32 v34, v40, v40
  v_and_b32 v40, 0xffff0000, v34
  v_mul_f32 v40, v40, v32
  v_mul_f32 v40, s26, v40
  v_sub_f32 v40, 0, v40
  v_mul_f32 v41, v41, v32
  v_mul_f32 v41, s27, v41
  v_mul_f32 v42, v42, v32
  v_mul_f32 v43, v43, v32
  v_add_f32 v42, v42, v42
  v_add_f32 v43, v43, v43
  ds_write_b128 v37, v[40:43] offset:18240
  v_and_b32 v40, 0xffff0000, v24
  v_and_b32 v41, 0xffff0000, v26
  v_and_b32 v42, 0xffff0000, v28
  v_and_b32 v43, 0xffff0000, v30
  v_mul_f32 v40, s26, v40
  v_exp_f32 v40, v40
  s_nop 0
  v_cvt_pk_bf16_f32 v34, v40, v40
  v_and_b32 v40, 0xffff0000, v34
  v_mul_f32 v40, v40, v32
  v_mul_f32 v40, s26, v40
  v_sub_f32 v40, 0, v40
  v_mul_f32 v41, v41, v32
  v_mul_f32 v41, s27, v41
  v_mul_f32 v42, v42, v32
  v_mul_f32 v43, v43, v32
  v_add_f32 v42, v42, v42
  v_add_f32 v43, v43, v43
  ds_write_b128 v37, v[40:43] offset:18256
  v_lshlrev_b32 v40, 16, v25
  v_lshlrev_b32 v41, 16, v27
  v_lshlrev_b32 v42, 16, v29
  v_lshlrev_b32 v43, 16, v31
  v_mul_f32 v40, s26, v40
  v_exp_f32 v40, v40
  s_nop 0
  v_cvt_pk_bf16_f32 v34, v40, v40
  v_and_b32 v40, 0xffff0000, v34
  v_mul_f32 v40, v40, v32
  v_mul_f32 v40, s26, v40
  v_sub_f32 v40, 0, v40
  v_mul_f32 v41, v41, v32
  v_mul_f32 v41, s27, v41
  v_mul_f32 v42, v42, v32
  v_mul_f32 v43, v43, v32
  v_add_f32 v42, v42, v42
  v_add_f32 v43, v43, v43
  ds_write_b128 v37, v[40:43] offset:18272
  v_and_b32 v40, 0xffff0000, v25
  v_and_b32 v41, 0xffff0000, v27
  v_and_b32 v42, 0xffff0000, v29
  v_and_b32 v43, 0xffff0000, v31
  v_mul_f32 v40, s26, v40
  v_exp_f32 v40, v40
  s_nop 0
  v_cvt_pk_bf16_f32 v34, v40, v40
  v_and_b32 v40, 0xffff0000, v34
  v_mul_f32 v40, v40, v32
  v_mul_f32 v40, s26, v40
  v_sub_f32 v40, 0, v40
  v_mul_f32 v41, v41, v32
  v_mul_f32 v41, s27, v41
  v_mul_f32 v42, v42, v32
  v_mul_f32 v43, v43, v32
  v_add_f32 v42, v42, v42
  v_add_f32 v43, v43, v43
  ds_write_b128 v37, v[40:43] offset:18288
  v_cvt_f32_u32 v44, v4
  v_lshlrev_b32 v45, 4, v4
  v_cvt_f32_u32 v45, v45
  v_lshlrev_b32 v46, 4, v3
  v_add_u32 v46, s17, v46
  v_mov_b32 v48, 0
  v_mov_b32 v49, 0
  v_mov_b32 v50, 0
  v_mov_b32 v51, 0
  v_mov_b32 v52, 0
  v_mov_b32 v53, 0
  v_mov_b32 v54, 0
  v_mov_b32 v55, 0
  v_mov_b32 v56, 0
  v_mov_b32 v57, 0
  v_mov_b32 v58, 0
  v_mov_b32 v59, 0
  v_mov_b32 v60, 0
  v_mov_b32 v61, 0
  v_mov_b32 v62, 0
  v_mov_b32 v63, 0
  v_mov_b32 v64, 0
  v_mov_b32 v65, 0
  v_mov_b32 v66, 0
  v_mov_b32 v67, 0
  s_mov_b32 s28, 0
  s_waitcnt lgkmcnt(0)
  ds_read_b128 v[68:71], v46 offset:18240
wk_kl:
  s_waitcnt lgkmcnt(0)
  v_mov_b32 v72, v68
  v_mov_b32 v73, v69
  v_mov_b32 v74, v70
  v_mov_b32 v75, v71
  v_add_u32 v46, 64, v46
  ds_read_b128 v[68:71], v46 offset:18240
  v_mul_f32 v80, v72, v45
  v_mul_f32 v81, v73, v45
  v_exp_f32 v80, v80
  v_fract_f32 v81, v81
  v_cos_f32 v76, v81
  v_sin_f32 v77, v81
  v_mul_f32 v76, v76, v80
  v_mul_f32 v77, v77, v80
  v_mul_f32 v80, v72, v44
  v_mul_f32 v81, v73, v44
  v_exp_f32 v80, v80
  v_fract_f32 v81, v81
  v_cos_f32 v78, v81
  v_sin_f32 v79, v81
  v_mul_f32 v78, v78, v80
  v_mul_f32 v79, v79, v80
  v_mul_f32 v82, v74, v76
  v_mul_f32 v83, v74, v77
  v_fma_f32 v82, -v75, v77, v82
  v_fma_f32 v83, -v75, v76, -v83
  v_mul_f32 v86, v76, v76
  v_mul_f32 v87, v76, v77
  v_fma_f32 v86, -v77, v77, v86
  v_add_f32 v87, v87, v87
  v_mfma_f32_16x16x4_f32 v[48:51], v82, v78, v[48:51]
  v_mul_f32 v88, v78, v78
  v_mul_f32 v89, v78, v79
  v_fma_f32 v88, -v79, v79, v88
  v_add_f32 v89, v89, v89
  v_mfma_f32_16x16x4_f32 v[48:51], v83, v79, v[48:51]
  v_mul_f32 v84, v74, v86
  v_mul_f32 v85, v74, v87
  v_fma_f32 v84, -v75, v87, v84
  v_fma_f32 v85, -v75, v86, -v85
  v_mul_f32 v76, v86, v86
  v_mul_f32 v77, v86, v87
  v_fma_f32 v76, -v87, v87, v76
  v_add_f32 v77, v77, v77
  v_mfma_f32_16x16x4_f32 v[52:55], v84, v88, v[52:55]
  v_mul_f32 v78, v88, v88
  v_mul_f32 v79, v88, v89
  v_fma_f32 v78, -v89, v89, v78
  v_add_f32 v79, v79, v79
  v_mfma_f32_16x16x4_f32 v[52:55], v85, v89, v[52:55]
  v_mul_f32 v82, v74, v76
  v_mul_f32 v83, v74, v77
  v_fma_f32 v82, -v75, v77, v82
  v_fma_f32 v83, -v75, v76, -v83
  v_mul_f32 v86, v76, v76
  v_mul_f32 v87, v76, v77
  v_fma_f32 v86, -v77, v77, v86
  v_add_f32 v87, v87, v87
  v_mfma_f32_16x16x4_f32 v[56:59], v82, v78, v[56:59]
  v_mul_f32 v88, v78, v78
  v_mul_f32 v89, v78, v79
  v_fma_f32 v88, -v79, v79, v88
  v_add_f32 v89, v89, v89
  v_mfma_f32_16x16x4_f32 v[56:59], v83, v79, v[56:59]
  v_mul_f32 v84, v74, v86
  v_mul_f32 v85, v74, v87
  v_fma_f32 v84, -v75, v87, v84
  v_fma_f32 v85, -v75, v86, -v85
  v_mul_f32 v76, v86, v86
  v_mul_f32 v77, v86, v87
  v_fma_f32 v76, -v87, v87, v76
  v_add_f32 v77, v77, v77
  v_mfma_f32_16x16x4_f32 v[60:63], v84, v88, v[60:63]
  v_mfma_f32_16x16x4_f32 v[60:63], v85, v89, v[60:63]
  v_mul_f32 v82, v74, v76
  v_fma_f32 v82, -v75, v77, v82
  s_nop 1
  v_mfma_f32_16x16x4_f32 v[64:67], v82, v88, v[64:67]
  s_add_u32 s28, s28, 1
  s_cmp_lt_u32 s28, 64
  s_cbranch_scc1 wk_kl
  s_nop 15
  s_nop 3
  v_lshlrev_b32 v46, 8, v3
  v_lshl_add_u32 v46, v4, 2, v46
  v_add_u32 v46, s17, v46
  ds_write_b32 v46, v48 offset:13056
  ds_write_b32 v46, v49 offset:13120
  ds_write_b32 v46, v50 offset:13184
  ds_write_b32 v46, v51 offset:13248
  s_waitcnt lgkmcnt(8)
  ds_write_b32 v46, v52 offset:14080
  ds_write_b32 v46, v53 offset:14144
  ds_write_b32 v46, v54 offset:14208
  ds_write_b32 v46, v55 offset:14272
  s_waitcnt lgkmcnt(8)
  ds_write_b32 v46, v56 offset:15104
  ds_write_b32 v46, v57 offset:15168
  ds_write_b32 v46, v58 offset:15232
  ds_write_b32 v46, v59 offset:15296
  s_waitcnt lgkmcnt(8)
  ds_write_b32 v46, v60 offset:16128
  ds_write_b32 v46, v61 offset:16192
  ds_write_b32 v46, v62 offset:16256
  ds_write_b32 v46, v63 offset:16320
  s_waitcnt lgkmcnt(8)
  ds_write_b32 v46, v64 offset:17152
  ds_write_b32 v46, v65 offset:17216
  ds_write_b32 v46, v66 offset:17280
  ds_write_b32 v46, v67 offset:17344
  s_waitcnt lgkmcnt(8)
  s_waitcnt lgkmcnt(0)
  ds_read_b32 v48, v200
  ds_read_b32 v49, v201
  ds_read_b32 v50, v202
  ds_read_b32 v51, v203
  ds_read_b32 v52, v204
  ds_read_b32 v53, v205
  ds_read_b32 v54, v206
  ds_read_b32 v55, v207
  s_waitcnt lgkmcnt(4)
  ds_read_b32 v56, v208
  ds_read_b32 v57, v209
  ds_read_b32 v58, v210
  ds_read_b32 v59, v211
  ds_read_b32 v60, v212
  ds_read_b32 v61, v213
  ds_read_b32 v62, v214
  ds_read_b32 v63, v215
  s_waitcnt lgkmcnt(4)
  ds_read_b32 v64, v216
  ds_read_b32 v65, v217
  ds_read_b32 v66, v218
  ds_read_b32 v67, v219
  ds_read_b32 v68, v220
  ds_read_b32 v69, v221
  ds_read_b32 v70, v222
  ds_read_b32 v71, v223
  s_waitcnt lgkmcnt(4)
  ds_read_b32 v72, v224
  ds_read_b32 v73, v225
  ds_read_b32 v74, v226
  ds_read_b32 v75, v227
  ds_read_b32 v76, v228
  ds_read_b32 v77, v229
  ds_read_b32 v78, v230
  ds_read_b32 v79, v231
  s_waitcnt lgkmcnt(4)
  ds_read_b32 v80, v232
  s_waitcnt lgkmcnt(0)
  v_lshlrev_b32 v46, 6, v1
  v_add_u32 v46, s17, v46
  v_cvt_pk_bf16_f32 v84, v48, v49
  v_cvt_pk_bf16_f32 v88, v49, v50
  v_cvt_pk_bf16_f32 v85, v50, v51
  v_cvt_pk_bf16_f32 v89, v51, v52
  v_cvt_pk_bf16_f32 v86, v52, v53
  v_cvt_pk_bf16_f32 v90, v53, v54
  v_cvt_pk_bf16_f32 v87, v54, v55
  v_cvt_pk_bf16_f32 v91, v55, v56
  ds_write_b128 v46, v[84:87] offset:4608
  ds_write_b128 v46, v[88:91] offset:8832
  s_waitcnt lgkmcnt(0)
  v_cvt_pk_bf16_f32 v84, v56, v57
  v_cvt_pk_bf16_f32 v88, v57, v58
  v_cvt_pk_bf16_f32 v85, v58, v59
  v_cvt_pk_bf16_f32 v89, v59, v60
  v_cvt_pk_bf16_f32 v86, v60, v61
  v_cvt_pk_bf16_f32 v90, v61, v62
  v_cvt_pk_bf16_f32 v87, v62, v63
  v_cvt_pk_bf16_f32 v91, v63, v64
  ds_write_b128 v46, v[84:87] offset:4624
  ds_write_b128 v46, v[88:91] offset:8848
  s_waitcnt lgkmcnt(0)
  v_cvt_pk_bf16_f32 v84, v64, v65
  v_cvt_pk_bf16_f32 v88, v65, v66
  v_cvt_pk_bf16_f32 v85, v66, v67
  v_cvt_pk_bf16_f32 v89, v67, v68
  v_cvt_pk_bf16_f32 v86, v68, v69
  v_cvt_pk_bf16_f32 v90, v69, v70
  v_cvt_pk_bf16_f32 v87, v70, v71
  v_cvt_pk_bf16_f32 v91, v71, v72
  ds_write_b128 v46, v[84:87] offset:4640
  ds_write_b128 v46, v[88:91] offset:8864
  s_waitcnt lgkmcnt(0)
  v_cvt_pk_bf16_f32 v84, v72, v73
  v_cvt_pk_bf16_f32 v88, v73, v74
  v_cvt_pk_bf16_f32 v85, v74, v75
  v_cvt_pk_bf16_f32 v89, v75, v76
  v_cvt_pk_bf16_f32 v86, v76, v77
  v_cvt_pk_bf16_f32 v90, v77, v78
  v_cvt_pk_bf16_f32 v87, v78, v79
  v_cvt_pk_bf16_f32 v91, v79, v80
  ds_write_b128 v46, v[84:87] offset:4656
  ds_write_b128 v46, v[88:91] offset:8880
  s_waitcnt lgkmcnt(0)
  s_barrier
  v_lshrrev_b32 v47, 1, v3
  v_sub_u32 v46, v4, v47
  v_add_u32 v46, 1, v46
  v_lshlrev_b32 v46, 5, v46
  v_and_b32 v48, 1, v3
  v_lshl_add_u32 v46, v48, 4, v46
  v_add_u32 v46, s17, v46
  ds_read_b128 a[0:3], v46 offset:32
  ds_read_b128 a[4:7], v46 offset:96
  ds_read_b128 a[8:11], v46 offset:160
  ds_read_b128 a[12:15], v46 offset:224
  ds_read_b128 a[16:19], v46 offset:288
  ds_read_b128 a[20:23], v46 offset:352
  ds_read_b128 a[24:27], v46 offset:416
  ds_read_b128 a[28:31], v46 offset:480
  s_waitcnt lgkmcnt(4)
  ds_read_b128 a[32:35], v46 offset:544
  ds_read_b128 a[36:39], v46 offset:608
  ds_read_b128 a[40:43], v46 offset:672
  ds_read_b128 a[44:47], v46 offset:736
  ds_read_b128 a[48:51], v46 offset:800
  ds_read_b128 a[52:55], v46 offset:864
  ds_read_b128 a[56:59], v46 offset:928
  ds_read_b128 a[60:63], v46 offset:992
  s_waitcnt lgkmcnt(4)
  ds_read_b128 a[64:67], v46 offset:1056
  ds_read_b128 a[68:71], v46 offset:1120
  ds_read_b128 a[72:75], v46 offset:1184
  ds_read_b128 a[76:79], v46 offset:1248
  ds_read_b128 a[80:83], v46 offset:1312
  ds_read_b128 a[84:87], v46 offset:1376
  ds_read_b128 a[88:91], v46 offset:1440
  ds_read_b128 a[92:95], v46 offset:1504
  s_waitcnt lgkmcnt(4)
  ds_read_b128 a[96:99], v46 offset:1568
  ds_read_b128 a[100:103], v46 offset:1632
  ds_read_b128 a[104:107], v46 offset:1696
  ds_read_b128 a[108:111], v46 offset:1760
  ds_read_b128 a[112:115], v46 offset:1824
  ds_read_b128 a[116:119], v46 offset:1888
  ds_read_b128 a[120:123], v46 offset:1952
  ds_read_b128 a[124:127], v46 offset:2016
  s_waitcnt lgkmcnt(4)
  ds_read_b128 a[128:131], v46 offset:2080
  ds_read_b128 a[132:135], v46 offset:2144
  ds_read_b128 a[136:139], v46 offset:2208
  ds_read_b128 a[140:143], v46 offset:2272
  ds_read_b128 a[144:147], v46 offset:2336
  ds_read_b128 a[148:151], v46 offset:2400
  ds_read_b128 a[152:155], v46 offset:2464
  ds_read_b128 a[156:159], v46 offset:2528
  s_waitcnt lgkmcnt(4)
  ds_read_b128 a[160:163], v46 offset:2592
  ds_read_b128 a[164:167], v46 offset:2656
  ds_read_b128 a[168:171], v46 offset:2720
  ds_read_b128 a[172:175], v46 offset:2784
  ds_read_b128 a[176:179], v46 offset:2848
  ds_read_b128 a[180:183], v46 offset:2912
  ds_read_b128 a[184:187], v46 offset:2976
  ds_read_b128 a[188:191], v46 offset:3040
  s_waitcnt lgkmcnt(4)
  ds_read_b128 a[192:195], v46 offset:3104
  ds_read_b128 a[196:199], v46 offset:3168
  ds_read_b128 a[200:203], v46 offset:3232
  ds_read_b128 a[204:207], v46 offset:3296
  ds_read_b128 a[208:211], v46 offset:3360
  ds_read_b128 a[212:215], v46 offset:3424
  ds_read_b128 a[216:219], v46 offset:3488
  ds_read_b128 a[220:223], v46 offset:3552
  s_waitcnt lgkmcnt(4)
  ds_read_b128 a[224:227], v46 offset:3616
  ds_read_b128 a[228:231], v46 offset:3680
  ds_read_b128 a[232:235], v46 offset:3744
  ds_read_b128 a[236:239], v46 offset:3808
  ds_read_b128 a[240:243], v46 offset:3872
  ds_read_b128 a[244:247], v46 offset:3936
  ds_read_b128 a[248:251], v46 offset:4000
  ds_read_b128 a[252:255], v46 offset:4064
  s_waitcnt lgkmcnt(4)
  v_lshlrev_b32 v49, 4, v47
  v_add_u32 v49, v49, v4
  v_sub_u32 v49, 2047, v49
  v_lshl_add_u32 v49, v48, 3, v49
  v_and_b32 v50, 1, v49
  v_lshrrev_b32 v49, 1, v49
  v_lshlrev_b32 v49, 2, v49
  v_mul_u32_u24 v50, 4224, v50
  v_add3_u32 v49, v49, v50, s17
  v_add_u32 v49, 4608, v49
  v_subrev_u32 v52, 896, v49
  v_subrev_u32 v53, 1856, v49
  v_subrev_u32 v54, 2816, v49
  v_subrev_u32 v55, 3776, v49
  v_subrev_u32 v56, 4736, v49
  s_waitcnt lgkmcnt(0)
  ds_read2_b32 v[92:93], v52 offset0:224 offset1:225
  ds_read2_b32 v[94:95], v52 offset0:226 offset1:227
  ds_read2_b32 v[96:97], v52 offset0:208 offset1:209
  ds_read2_b32 v[98:99], v52 offset0:210 offset1:211
  ds_read2_b32 v[100:101], v52 offset0:192 offset1:193
  ds_read2_b32 v[102:103], v52 offset0:194 offset1:195
  ds_read2_b32 v[104:105], v52 offset0:176 offset1:177
  ds_read2_b32 v[106:107], v52 offset0:178 offset1:179
  s_waitcnt lgkmcnt(6)
  v_mfma_f32_16x16x32_bf16 v[60:63], v[92:95], a[28:31], 0
  v_mfma_f32_16x16x32_bf16 v[64:67], v[92:95], a[60:63], 0
  v_mfma_f32_16x16x32_bf16 v[68:71], v[92:95], a[92:95], 0
  v_mfma_f32_16x16x32_bf16 v[72:75], v[92:95], a[124:127], 0
  v_mfma_f32_16x16x32_bf16 v[76:79], v[92:95], a[156:159], 0
  v_mfma_f32_16x16x32_bf16 v[80:83], v[92:95], a[188:191], 0
  v_mfma_f32_16x16x32_bf16 v[84:87], v[92:95], a[220:223], 0
  v_mfma_f32_16x16x32_bf16 v[88:91], v[92:95], a[252:255], 0
  ds_read2_b32 v[92:93], v52 offset0:160 offset1:161
  ds_read2_b32 v[94:95], v52 offset0:162 offset1:163
  s_waitcnt lgkmcnt(6)
  v_mfma_f32_16x16x32_bf16 v[60:63], v[96:99], a[24:27], v[60:63]
  v_mfma_f32_16x16x32_bf16 v[64:67], v[96:99], a[56:59], v[64:67]
  v_mfma_f32_16x16x32_bf16 v[68:71], v[96:99], a[88:91], v[68:71]
  v_mfma_f32_16x16x32_bf16 v[72:75], v[96:99], a[120:123], v[72:75]
  v_mfma_f32_16x16x32_bf16 v[76:79], v[96:99], a[152:155], v[76:79]
  v_mfma_f32_16x16x32_bf16 v[80:83], v[96:99], a[184:187], v[80:83]
  v_mfma_f32_16x16x32_bf16 v[84:87], v[96:99], a[216:219], v[84:87]
  v_mfma_f32_16x16x32_bf16 v[88:91], v[96:99], a[248:251], v[88:91]
  ds_read2_b32 v[96:97], v52 offset0:144 offset1:145
  ds_read2_b32 v[98:99], v52 offset0:146 offset1:147
  s_waitcnt lgkmcnt(6)
  v_mfma_f32_16x16x32_bf16 v[60:63], v[100:103], a[20:23], v[60:63]
  v_mfma_f32_16x16x32_bf16 v[64:67], v[100:103], a[52:55], v[64:67]
  v_mfma_f32_16x16x32_bf16 v[68:71], v[100:103], a[84:87], v[68:71]
  v_mfma_f32_16x16x32_bf16 v[72:75], v[100:103], a[116:119], v[72:75]
  v_mfma_f32_16x16x32_bf16 v[76:79], v[100:103], a[148:151], v[76:79]
  v_mfma_f32_16x16x32_bf16 v[80:83], v[100:103], a[180:183], v[80:83]
  v_mfma_f32_16x16x32_bf16 v[84:87], v[100:103], a[212:215], v[84:87]
  v_mfma_f32_16x16x32_bf16 v[88:91], v[100:103], a[244:247], v[88:91]
  ds_read2_b32 v[100:101], v52 offset0:128 offset1:129
  ds_read2_b32 v[102:103], v52 offset0:130 offset1:131
  s_waitcnt lgkmcnt(6)
  v_mfma_f32_16x16x32_bf16 v[60:63], v[104:107], a[16:19], v[60:63]
  v_mfma_f32_16x16x32_bf16 v[64:67], v[104:107], a[48:51], v[64:67]
  v_mfma_f32_16x16x32_bf16 v[68:71], v[104:107], a[80:83], v[68:71]
  v_mfma_f32_16x16x32_bf16 v[72:75], v[104:107], a[112:115], v[72:75]
  v_mfma_f32_16x16x32_bf16 v[76:79], v[104:107], a[144:147], v[76:79]
  v_mfma_f32_16x16x32_bf16 v[80:83], v[104:107], a[176:179], v[80:83]
  v_mfma_f32_16x16x32_bf16 v[84:87], v[104:107], a[208:211], v[84:87]
  v_mfma_f32_16x16x32_bf16 v[88:91], v[104:107], a[240:243], v[88:91]
  ds_read2_b32 v[104:105], v52 offset0:112 offset1:113
  ds_read2_b32 v[106:107], v52 offset0:114 offset1:115
  s_waitcnt lgkmcnt(6)
  v_mfma_f32_16x16x32_bf16 v[60:63], v[92:95], a[12:15], v[60:63]
  v_mfma_f32_16x16x32_bf16 v[64:67], v[92:95], a[44:47], v[64:67]
  v_mfma_f32_16x16x32_bf16 v[68:71], v[92:95], a[76:79], v[68:71]
  v_mfma_f32_16x16x32_bf16 v[72:75], v[92:95], a[108:111], v[72:75]
  v_mfma_f32_16x16x32_bf16 v[76:79], v[92:95], a[140:143], v[76:79]
  v_mfma_f32_16x16x32_bf16 v[80:83], v[92:95], a[172:175], v[80:83]
  v_mfma_f32_16x16x32_bf16 v[84:87], v[92:95], a[204:207], v[84:87]
  v_mfma_f32_16x16x32_bf16 v[88:91], v[92:95], a[236:239], v[88:91]
  ds_read2_b32 v[92:93], v52 offset0:96 offset1:97
  ds_read2_b32 v[94:95], v52 offset0:98 offset1:99
  s_waitcnt lgkmcnt(6)
  v_mfma_f32_16x16x32_bf16 v[60:63], v[96:99], a[8:11], v[60:63]
  v_mfma_f32_16x16x32_bf16 v[64:67], v[96:99], a[40:43], v[64:67]
  v_mfma_f32_16x16x32_bf16 v[68:71], v[96:99], a[72:75], v[68:71]
  v_mfma_f32_16x16x32_bf16 v[72:75], v[96:99], a[104:107], v[72:75]
  v_mfma_f32_16x16x32_bf16 v[76:79], v[96:99], a[136:139], v[76:79]
  v_mfma_f32_16x16x32_bf16 v[80:83], v[96:99], a[168:171], v[80:83]
  v_mfma_f32_16x16x32_bf16 v[84:87], v[96:99], a[200:203], v[84:87]
  v_mfma_f32_16x16x32_bf16 v[88:91], v[96:99], a[232:235], v[88:91]
  ds_read2_b32 v[96:97], v52 offset0:80 offset1:81
  ds_read2_b32 v[98:99], v52 offset0:82 offset1:83
  s_waitcnt lgkmcnt(6)
  v_mfma_f32_16x16x32_bf16 v[60:63], v[100:103], a[4:7], v[60:63]
  v_mfma_f32_16x16x32_bf16 v[64:67], v[100:103], a[36:39], v[64:67]
  v_mfma_f32_16x16x32_bf16 v[68:71], v[100:103], a[68:71], v[68:71]
  v_mfma_f32_16x16x32_bf16 v[72:75], v[100:103], a[100:103], v[72:75]
  v_mfma_f32_16x16x32_bf16 v[76:79], v[100:103], a[132:135], v[76:79]
  v_mfma_f32_16x16x32_bf16 v[80:83], v[100:103], a[164:167], v[80:83]
  v_mfma_f32_16x16x32_bf16 v[84:87], v[100:103], a[196:199], v[84:87]
  v_mfma_f32_16x16x32_bf16 v[88:91], v[100:103], a[228:231], v[88:91]
  ds_read2_b32 v[100:101], v52 offset0:64 offset1:65
  ds_read2_b32 v[102:103], v52 offset0:66 offset1:67
  s_waitcnt lgkmcnt(6)
  v_mfma_f32_16x16x32_bf16 v[60:63], v[104:107], a[0:3], v[60:63]
  v_mfma_f32_16x16x32_bf16 v[64:67], v[104:107], a[32:35], v[64:67]
  v_mfma_f32_16x16x32_bf16 v[68:71], v[104:107], a[64:67], v[68:71]
  v_mfma_f32_16x16x32_bf16 v[72:75], v[104:107], a[96:99], v[72:75]
  v_mfma_f32_16x16x32_bf16 v[76:79], v[104:107], a[128:131], v[76:79]
  v_mfma_f32_16x16x32_bf16 v[80:83], v[104:107], a[160:163], v[80:83]
  v_mfma_f32_16x16x32_bf16 v[84:87], v[104:107], a[192:195], v[84:87]
  v_mfma_f32_16x16x32_bf16 v[88:91], v[104:107], a[224:227], v[88:91]
  ds_read2_b32 v[104:105], v52 offset0:48 offset1:49
  ds_read2_b32 v[106:107], v52 offset0:50 offset1:51
  s_waitcnt lgkmcnt(6)
  v_mfma_f32_16x16x32_bf16 v[64:67], v[92:95], a[28:31], v[64:67]
  v_mfma_f32_16x16x32_bf16 v[68:71], v[92:95], a[60:63], v[68:71]
  v_mfma_f32_16x16x32_bf16 v[72:75], v[92:95], a[92:95], v[72:75]
  v_mfma_f32_16x16x32_bf16 v[76:79], v[92:95], a[124:127], v[76:79]
  v_mfma_f32_16x16x32_bf16 v[80:83], v[92:95], a[156:159], v[80:83]
  v_mfma_f32_16x16x32_bf16 v[84:87], v[92:95], a[188:191], v[84:87]
  v_mfma_f32_16x16x32_bf16 v[88:91], v[92:95], a[220:223], v[88:91]
  ds_read2_b32 v[92:93], v52 offset0:32 offset1:33
  ds_read2_b32 v[94:95], v52 offset0:34 offset1:35
  s_waitcnt lgkmcnt(6)
  v_mfma_f32_16x16x32_bf16 v[64:67], v[96:99], a[24:27], v[64:67]
  v_mfma_f32_16x16x32_bf16 v[68:71], v[96:99], a[56:59], v[68:71]
  v_mfma_f32_16x16x32_bf16 v[72:75], v[96:99], a[88:91], v[72:75]
  v_mfma_f32_16x16x32_bf16 v[76:79], v[96:99], a[120:123], v[76:79]
  v_mfma_f32_16x16x32_bf16 v[80:83], v[96:99], a[152:155], v[80:83]
  v_mfma_f32_16x16x32_bf16 v[84:87], v[96:99], a[184:187], v[84:87]
  v_mfma_f32_16x16x32_bf16 v[88:91], v[96:99], a[216:219], v[88:91]
  ds_read2_b32 v[96:97], v52 offset0:16 offset1:17
  ds_read2_b32 v[98:99], v52 offset0:18 offset1:19
  s_waitcnt lgkmcnt(6)
  v_mfma_f32_16x16x32_bf16 v[64:67], v[100:103], a[20:23], v[64:67]
  v_mfma_f32_16x16x32_bf16 v[68:71], v[100:103], a[52:55], v[68:71]
  v_mfma_f32_16x16x32_bf16 v[72:75], v[100:103], a[84:87], v[72:75]
  v_mfma_f32_16x16x32_bf16 v[76:79], v[100:103], a[116:119], v[76:79]
  v_mfma_f32_16x16x32_bf16 v[80:83], v[100:103], a[148:151], v[80:83]
  v_mfma_f32_16x16x32_bf16 v[84:87], v[100:103], a[180:183], v[84:87]
  v_mfma_f32_16x16x32_bf16 v[88:91], v[100:103], a[212:215], v[88:91]
  ds_read2_b32 v[100:101], v52 offset0:0 offset1:1
  ds_read2_b32 v[102:103], v52 offset0:2 offset1:3
  s_waitcnt lgkmcnt(6)
  v_mfma_f32_16x16x32_bf16 v[64:67], v[104:107], a[16:19], v[64:67]
  v_mfma_f32_16x16x32_bf16 v[68:71], v[104:107], a[48:51], v[68:71]
  v_mfma_f32_16x16x32_bf16 v[72:75], v[104:107], a[80:83], v[72:75]
  v_mfma_f32_16x16x32_bf16 v[76:79], v[104:107], a[112:115], v[76:79]
  v_mfma_f32_16x16x32_bf16 v[80:83], v[104:107], a[144:147], v[80:83]
  v_mfma_f32_16x16x32_bf16 v[84:87], v[104:107], a[176:179], v[84:87]
  v_mfma_f32_16x16x32_bf16 v[88:91], v[104:107], a[208:211], v[88:91]
  ds_read2_b32 v[104:105], v53 offset0:224 offset1:225
  ds_read2_b32 v[106:107], v53 offset0:226 offset1:227
  s_waitcnt lgkmcnt(6)
  v_mfma_f32_16x16x32_bf16 v[64:67], v[92:95], a[12:15], v[64:67]
  v_mfma_f32_16x16x32_bf16 v[68:71], v[92:95], a[44:47], v[68:71]
  v_mfma_f32_16x16x32_bf16 v[72:75], v[92:95], a[76:79], v[72:75]
  v_mfma_f32_16x16x32_bf16 v[76:79], v[92:95], a[108:111], v[76:79]
  v_mfma_f32_16x16x32_bf16 v[80:83], v[92:95], a[140:143], v[80:83]
  v_mfma_f32_16x16x32_bf16 v[84:87], v[92:95], a[172:175], v[84:87]
  v_mfma_f32_16x16x32_bf16 v[88:91], v[92:95], a[204:207], v[88:91]
  ds_read2_b32 v[92:93], v53 offset0:208 offset1:209
  ds_read2_b32 v[94:95], v53 offset0:210 offset1:211
  s_waitcnt lgkmcnt(6)
  v_mfma_f32_16x16x32_bf16 v[64:67], v[96:99], a[8:11], v[64:67]
  v_mfma_f32_16x16x32_bf16 v[68:71], v[96:99], a[40:43], v[68:71]
  v_mfma_f32_16x16x32_bf16 v[72:75], v[96:99], a[72:75], v[72:75]
  v_mfma_f32_16x16x32_bf16 v[76:79], v[96:99], a[104:107], v[76:79]
  v_mfma_f32_16x16x32_bf16 v[80:83], v[96:99], a[136:139], v[80:83]
  v_mfma_f32_16x16x32_bf16 v[84:87], v[96:99], a[168:171], v[84:87]
  v_mfma_f32_16x16x32_bf16 v[88:91], v[96:99], a[200:203], v[88:91]
  ds_read2_b32 v[96:97], v53 offset0:192 offset1:193
  ds_read2_b32 v[98:99], v53 offset0:194 offset1:195
  s_waitcnt lgkmcnt(6)
  v_mfma_f32_16x16x32_bf16 v[64:67], v[100:103], a[4:7], v[64:67]
  v_mfma_f32_16x16x32_bf16 v[68:71], v[100:103], a[36:39], v[68:71]
  v_mfma_f32_16x16x32_bf16 v[72:75], v[100:103], a[68:71], v[72:75]
  v_mfma_f32_16x16x32_bf16 v[76:79], v[100:103], a[100:103], v[76:79]
  v_mfma_f32_16x16x32_bf16 v[80:83], v[100:103], a[132:135], v[80:83]
  v_mfma_f32_16x16x32_bf16 v[84:87], v[100:103], a[164:167], v[84:87]
  v_mfma_f32_16x16x32_bf16 v[88:91], v[100:103], a[196:199], v[88:91]
  ds_read2_b32 v[100:101], v53 offset0:176 offset1:177
  ds_read2_b32 v[102:103], v53 offset0:178 offset1:179
  s_waitcnt lgkmcnt(6)
  v_mfma_f32_16x16x32_bf16 v[64:67], v[104:107], a[0:3], v[64:67]
  v_mfma_f32_16x16x32_bf16 v[68:71], v[104:107], a[32:35], v[68:71]
  v_mfma_f32_16x16x32_bf16 v[72:75], v[104:107], a[64:67], v[72:75]
  v_mfma_f32_16x16x32_bf16 v[76:79], v[104:107], a[96:99], v[76:79]
  v_mfma_f32_16x16x32_bf16 v[80:83], v[104:107], a[128:131], v[80:83]
  v_mfma_f32_16x16x32_bf16 v[84:87], v[104:107], a[160:163], v[84:87]
  v_mfma_f32_16x16x32_bf16 v[88:91], v[104:107], a[192:195], v[88:91]
  ds_read2_b32 v[104:105], v53 offset0:160 offset1:161
  ds_read2_b32 v[106:107], v53 offset0:162 offset1:163
  s_waitcnt lgkmcnt(6)
  v_mfma_f32_16x16x32_bf16 v[68:71], v[92:95], a[28:31], v[68:71]
  v_mfma_f32_16x16x32_bf16 v[72:75], v[92:95], a[60:63], v[72:75]
  v_mfma_f32_16x16x32_bf16 v[76:79], v[92:95], a[92:95], v[76:79]
  v_mfma_f32_16x16x32_bf16 v[80:83], v[92:95], a[124:127], v[80:83]
  v_mfma_f32_16x16x32_bf16 v[84:87], v[92:95], a[156:159], v[84:87]
  v_mfma_f32_16x16x32_bf16 v[88:91], v[92:95], a[188:191], v[88:91]
  ds_read2_b32 v[92:93], v53 offset0:144 offset1:145
  ds_read2_b32 v[94:95], v53 offset0:146 offset1:147
  s_waitcnt lgkmcnt(6)
  v_mfma_f32_16x16x32_bf16 v[68:71], v[96:99], a[24:27], v[68:71]
  v_mfma_f32_16x16x32_bf16 v[72:75], v[96:99], a[56:59], v[72:75]
  v_mfma_f32_16x16x32_bf16 v[76:79], v[96:99], a[88:91], v[76:79]
  v_mfma_f32_16x16x32_bf16 v[80:83], v[96:99], a[120:123], v[80:83]
  v_mfma_f32_16x16x32_bf16 v[84:87], v[96:99], a[152:155], v[84:87]
  v_mfma_f32_16x16x32_bf16 v[88:91], v[96:99], a[184:187], v[88:91]
  ds_read2_b32 v[96:97], v53 offset0:128 offset1:129
  ds_read2_b32 v[98:99], v53 offset0:130 offset1:131
  s_waitcnt lgkmcnt(6)
  v_mfma_f32_16x16x32_bf16 v[68:71], v[100:103], a[20:23], v[68:71]
  v_mfma_f32_16x16x32_bf16 v[72:75], v[100:103], a[52:55], v[72:75]
  v_mfma_f32_16x16x32_bf16 v[76:79], v[100:103], a[84:87], v[76:79]
  v_mfma_f32_16x16x32_bf16 v[80:83], v[100:103], a[116:119], v[80:83]
  v_mfma_f32_16x16x32_bf16 v[84:87], v[100:103], a[148:151], v[84:87]
  v_mfma_f32_16x16x32_bf16 v[88:91], v[100:103], a[180:183], v[88:91]
  ds_read2_b32 v[100:101], v53 offset0:112 offset1:113
  ds_read2_b32 v[102:103], v53 offset0:114 offset1:115
  s_waitcnt lgkmcnt(6)
  v_mfma_f32_16x16x32_bf16 v[68:71], v[104:107], a[16:19], v[68:71]
  v_mfma_f32_16x16x32_bf16 v[72:75], v[104:107], a[48:51], v[72:75]
  v_mfma_f32_16x16x32_bf16 v[76:79], v[104:107], a[80:83], v[76:79]
  v_mfma_f32_16x16x32_bf16 v[80:83], v[104:107], a[112:115], v[80:83]
  v_mfma_f32_16x16x32_bf16 v[84:87], v[104:107], a[144:147], v[84:87]
  v_mfma_f32_16x16x32_bf16 v[88:91], v[104:107], a[176:179], v[88:91]
  ds_read2_b32 v[104:105], v53 offset0:96 offset1:97
  ds_read2_b32 v[106:107], v53 offset0:98 offset1:99
  s_waitcnt lgkmcnt(6)
  v_mfma_f32_16x16x32_bf16 v[68:71], v[92:95], a[12:15], v[68:71]
  v_mfma_f32_16x16x32_bf16 v[72:75], v[92:95], a[44:47], v[72:75]
  v_mfma_f32_16x16x32_bf16 v[76:79], v[92:95], a[76:79], v[76:79]
  v_mfma_f32_16x16x32_bf16 v[80:83], v[92:95], a[108:111], v[80:83]
  v_mfma_f32_16x16x32_bf16 v[84:87], v[92:95], a[140:143], v[84:87]
  v_mfma_f32_16x16x32_bf16 v[88:91], v[92:95], a[172:175], v[88:91]
  ds_read2_b32 v[92:93], v53 offset0:80 offset1:81
  ds_read2_b32 v[94:95], v53 offset0:82 offset1:83
  s_waitcnt lgkmcnt(6)
  v_mfma_f32_16x16x32_bf16 v[68:71], v[96:99], a[8:11], v[68:71]
  v_mfma_f32_16x16x32_bf16 v[72:75], v[96:99], a[40:43], v[72:75]
  v_mfma_f32_16x16x32_bf16 v[76:79], v[96:99], a[72:75], v[76:79]
  v_mfma_f32_16x16x32_bf16 v[80:83], v[96:99], a[104:107], v[80:83]
  v_mfma_f32_16x16x32_bf16 v[84:87], v[96:99], a[136:139], v[84:87]
  v_mfma_f32_16x16x32_bf16 v[88:91], v[96:99], a[168:171], v[88:91]
  ds_read2_b32 v[96:97], v53 offset0:64 offset1:65
  ds_read2_b32 v[98:99], v53 offset0:66 offset1:67
  s_waitcnt lgkmcnt(6)
  v_mfma_f32_16x16x32_bf16 v[68:71], v[100:103], a[4:7], v[68:71]
  v_mfma_f32_16x16x32_bf16 v[72:75], v[100:103], a[36:39], v[72:75]
  v_mfma_f32_16x16x32_bf16 v[76:79], v[100:103], a[68:71], v[76:79]
  v_mfma_f32_16x16x32_bf16 v[80:83], v[100:103], a[100:103], v[80:83]
  v_mfma_f32_16x16x32_bf16 v[84:87], v[100:103], a[132:135], v[84:87]
  v_mfma_f32_16x16x32_bf16 v[88:91], v[100:103], a[164:167], v[88:91]
  ds_read2_b32 v[100:101], v53 offset0:48 offset1:49
  ds_read2_b32 v[102:103], v53 offset0:50 offset1:51
  s_waitcnt lgkmcnt(6)
  v_mfma_f32_16x16x32_bf16 v[68:71], v[104:107], a[0:3], v[68:71]
  v_mfma_f32_16x16x32_bf16 v[72:75], v[104:107], a[32:35], v[72:75]
  v_mfma_f32_16x16x32_bf16 v[76:79], v[104:107], a[64:67], v[76:79]
  v_mfma_f32_16x16x32_bf16 v[80:83], v[104:107], a[96:99], v[80:83]
  v_mfma_f32_16x16x32_bf16 v[84:87], v[104:107], a[128:131], v[84:87]
  v_mfma_f32_16x16x32_bf16 v[88:91], v[104:107], a[160:163], v[88:91]
  ds_read2_b32 v[104:105], v53 offset0:32 offset1:33
  ds_read2_b32 v[106:107], v53 offset0:34 offset1:35
  s_waitcnt lgkmcnt(6)
  v_mfma_f32_16x16x32_bf16 v[72:75], v[92:95], a[28:31], v[72:75]
  v_mfma_f32_16x16x32_bf16 v[76:79], v[92:95], a[60:63], v[76:79]
  v_mfma_f32_16x16x32_bf16 v[80:83], v[92:95], a[92:95], v[80:83]
  v_mfma_f32_16x16x32_bf16 v[84:87], v[92:95], a[124:127], v[84:87]
  v_mfma_f32_16x16x32_bf16 v[88:91], v[92:95], a[156:159], v[88:91]
  ds_read2_b32 v[92:93], v53 offset0:16 offset1:17
  ds_read2_b32 v[94:95], v53 offset0:18 offset1:19
  s_waitcnt lgkmcnt(6)
  v_mfma_f32_16x16x32_bf16 v[72:75], v[96:99], a[24:27], v[72:75]
  v_mfma_f32_16x16x32_bf16 v[76:79], v[96:99], a[56:59], v[76:79]
  v_mfma_f32_16x16x32_bf16 v[80:83], v[96:99], a[88:91], v[80:83]
  v_mfma_f32_16x16x32_bf16 v[84:87], v[96:99], a[120:123], v[84:87]
  v_mfma_f32_16x16x32_bf16 v[88:91], v[96:99], a[152:155], v[88:91]
  ds_read2_b32 v[96:97], v53 offset0:0 offset1:1
  ds_read2_b32 v[98:99], v53 offset0:2 offset1:3
  s_waitcnt lgkmcnt(6)
  v_mfma_f32_16x16x32_bf16 v[72:75], v[100:103], a[20:23], v[72:75]
  v_mfma_f32_16x16x32_bf16 v[76:79], v[100:103], a[52:55], v[76:79]
  v_mfma_f32_16x16x32_bf16 v[80:83], v[100:103], a[84:87], v[80:83]
  v_mfma_f32_16x16x32_bf16 v[84:87], v[100:103], a[116:119], v[84:87]
  v_mfma_f32_16x16x32_bf16 v[88:91], v[100:103], a[148:151], v[88:91]
  ds_read2_b32 v[100:101], v54 offset0:224 offset1:225
  ds_read2_b32 v[102:103], v54 offset0:226 offset1:227
  s_waitcnt lgkmcnt(6)
  v_mfma_f32_16x16x32_bf16 v[72:75], v[104:107], a[16:19], v[72:75]
  v_mfma_f32_16x16x32_bf16 v[76:79], v[104:107], a[48:51], v[76:79]
  v_mfma_f32_16x16x32_bf16 v[80:83], v[104:107], a[80:83], v[80:83]
  v_mfma_f32_16x16x32_bf16 v[84:87], v[104:107], a[112:115], v[84:87]
  v_mfma_f32_16x16x32_bf16 v[88:91], v[104:107], a[144:147], v[88:91]
  ds_read2_b32 v[104:105], v54 offset0:208 offset1:209
  ds_read2_b32 v[106:107], v54 offset0:210 offset1:211
  s_waitcnt lgkmcnt(6)
  v_mfma_f32_16x16x32_bf16 v[72:75], v[92:95], a[12:15], v[72:75]
  v_mfma_f32_16x16x32_bf16 v[76:79], v[92:95], a[44:47], v[76:79]
  v_mfma_f32_16x16x32_bf16 v[80:83], v[92:95], a[76:79], v[80:83]
  v_mfma_f32_16x16x32_bf16 v[84:87], v[92:95], a[108:111], v[84:87]
  v_mfma_f32_16x16x32_bf16 v[88:91], v[92:95], a[140:143], v[88:91]
  ds_read2_b32 v[92:93], v54 offset0:192 offset1:193
  ds_read2_b32 v[94:95], v54 offset0:194 offset1:195
  s_waitcnt lgkmcnt(6)
  v_mfma_f32_16x16x32_bf16 v[72:75], v[96:99], a[8:11], v[72:75]
  v_mfma_f32_16x16x32_bf16 v[76:79], v[96:99], a[40:43], v[76:79]
  v_mfma_f32_16x16x32_bf16 v[80:83], v[96:99], a[72:75], v[80:83]
  v_mfma_f32_16x16x32_bf16 v[84:87], v[96:99], a[104:107], v[84:87]
  v_mfma_f32_16x16x32_bf16 v[88:91], v[96:99], a[136:139], v[88:91]
  ds_read2_b32 v[96:97], v54 offset0:176 offset1:177
  ds_read2_b32 v[98:99], v54 offset0:178 offset1:179
  s_waitcnt lgkmcnt(6)
  v_mfma_f32_16x16x32_bf16 v[72:75], v[100:103], a[4:7], v[72:75]
  v_mfma_f32_16x16x32_bf16 v[76:79], v[100:103], a[36:39], v[76:79]
  v_mfma_f32_16x16x32_bf16 v[80:83], v[100:103], a[68:71], v[80:83]
  v_mfma_f32_16x16x32_bf16 v[84:87], v[100:103], a[100:103], v[84:87]
  v_mfma_f32_16x16x32_bf16 v[88:91], v[100:103], a[132:135], v[88:91]
  ds_read2_b32 v[100:101], v54 offset0:160 offset1:161
  ds_read2_b32 v[102:103], v54 offset0:162 offset1:163
  s_waitcnt lgkmcnt(6)
  v_mfma_f32_16x16x32_bf16 v[72:75], v[104:107], a[0:3], v[72:75]
  v_mfma_f32_16x16x32_bf16 v[76:79], v[104:107], a[32:35], v[76:79]
  v_mfma_f32_16x16x32_bf16 v[80:83], v[104:107], a[64:67], v[80:83]
  v_mfma_f32_16x16x32_bf16 v[84:87], v[104:107], a[96:99], v[84:87]
  v_mfma_f32_16x16x32_bf16 v[88:91], v[104:107], a[128:131], v[88:91]
  ds_read2_b32 v[104:105], v54 offset0:144 offset1:145
  ds_read2_b32 v[106:107], v54 offset0:146 offset1:147
  s_waitcnt lgkmcnt(6)
  v_mfma_f32_16x16x32_bf16 v[76:79], v[92:95], a[28:31], v[76:79]
  v_mfma_f32_16x16x32_bf16 v[80:83], v[92:95], a[60:63], v[80:83]
  v_mfma_f32_16x16x32_bf16 v[84:87], v[92:95], a[92:95], v[84:87]
  v_mfma_f32_16x16x32_bf16 v[88:91], v[92:95], a[124:127], v[88:91]
  ds_read2_b32 v[92:93], v54 offset0:128 offset1:129
  ds_read2_b32 v[94:95], v54 offset0:130 offset1:131
  s_waitcnt lgkmcnt(6)
  v_mfma_f32_16x16x32_bf16 v[76:79], v[96:99], a[24:27], v[76:79]
  v_mfma_f32_16x16x32_bf16 v[80:83], v[96:99], a[56:59], v[80:83]
  v_mfma_f32_16x16x32_bf16 v[84:87], v[96:99], a[88:91], v[84:87]
  v_mfma_f32_16x16x32_bf16 v[88:91], v[96:99], a[120:123], v[88:91]
  ds_read2_b32 v[96:97], v54 offset0:112 offset1:113
  ds_read2_b32 v[98:99], v54 offset0:114 offset1:115
  s_waitcnt lgkmcnt(6)
  v_mfma_f32_16x16x32_bf16 v[76:79], v[100:103], a[20:23], v[76:79]
  v_mfma_f32_16x16x32_bf16 v[80:83], v[100:103], a[52:55], v[80:83]
  v_mfma_f32_16x16x32_bf16 v[84:87], v[100:103], a[84:87], v[84:87]
  v_mfma_f32_16x16x32_bf16 v[88:91], v[100:103], a[116:119], v[88:91]
  ds_read2_b32 v[100:101], v54 offset0:96 offset1:97
  ds_read2_b32 v[102:103], v54 offset0:98 offset1:99
  s_waitcnt lgkmcnt(6)
  v_mfma_f32_16x16x32_bf16 v[76:79], v[104:107], a[16:19], v[76:79]
  v_mfma_f32_16x16x32_bf16 v[80:83], v[104:107], a[48:51], v[80:83]
  v_mfma_f32_16x16x32_bf16 v[84:87], v[104:107], a[80:83], v[84:87]
  v_mfma_f32_16x16x32_bf16 v[88:91], v[104:107], a[112:115], v[88:91]
  ds_read2_b32 v[104:105], v54 offset0:80 offset1:81
  ds_read2_b32 v[106:107], v54 offset0:82 offset1:83
  s_waitcnt lgkmcnt(6)
  v_mfma_f32_16x16x32_bf16 v[76:79], v[92:95], a[12:15], v[76:79]
  v_mfma_f32_16x16x32_bf16 v[80:83], v[92:95], a[44:47], v[80:83]
  v_mfma_f32_16x16x32_bf16 v[84:87], v[92:95], a[76:79], v[84:87]
  v_mfma_f32_16x16x32_bf16 v[88:91], v[92:95], a[108:111], v[88:91]
  ds_read2_b32 v[92:93], v54 offset0:64 offset1:65
  ds_read2_b32 v[94:95], v54 offset0:66 offset1:67
  s_waitcnt lgkmcnt(6)
  v_mfma_f32_16x16x32_bf16 v[76:79], v[96:99], a[8:11], v[76:79]
  v_mfma_f32_16x16x32_bf16 v[80:83], v[96:99], a[40:43], v[80:83]
  v_mfma_f32_16x16x32_bf16 v[84:87], v[96:99], a[72:75], v[84:87]
  v_mfma_f32_16x16x32_bf16 v[88:91], v[96:99], a[104:107], v[88:91]
  ds_read2_b32 v[96:97], v54 offset0:48 offset1:49
  ds_read2_b32 v[98:99], v54 offset0:50 offset1:51
  s_waitcnt lgkmcnt(6)
  v_mfma_f32_16x16x32_bf16 v[76:79], v[100:103], a[4:7], v[76:79]
  v_mfma_f32_16x16x32_bf16 v[80:83], v[100:103], a[36:39], v[80:83]
  v_mfma_f32_16x16x32_bf16 v[84:87], v[100:103], a[68:71], v[84:87]
  v_mfma_f32_16x16x32_bf16 v[88:91], v[100:103], a[100:103], v[88:91]
  ds_read2_b32 v[100:101], v54 offset0:32 offset1:33
  ds_read2_b32 v[102:103], v54 offset0:34 offset1:35
  s_waitcnt lgkmcnt(6)
  v_mfma_f32_16x16x32_bf16 v[76:79], v[104:107], a[0:3], v[76:79]
  v_mfma_f32_16x16x32_bf16 v[80:83], v[104:107], a[32:35], v[80:83]
  v_mfma_f32_16x16x32_bf16 v[84:87], v[104:107], a[64:67], v[84:87]
  v_mfma_f32_16x16x32_bf16 v[88:91], v[104:107], a[96:99], v[88:91]
  ds_read2_b32 v[104:105], v54 offset0:16 offset1:17
  ds_read2_b32 v[106:107], v54 offset0:18 offset1:19
  s_waitcnt lgkmcnt(6)
  v_mfma_f32_16x16x32_bf16 v[80:83], v[92:95], a[28:31], v[80:83]
  v_mfma_f32_16x16x32_bf16 v[84:87], v[92:95], a[60:63], v[84:87]
  v_mfma_f32_16x16x32_bf16 v[88:91], v[92:95], a[92:95], v[88:91]
  ds_read2_b32 v[92:93], v54 offset0:0 offset1:1
  ds_read2_b32 v[94:95], v54 offset0:2 offset1:3
  s_waitcnt lgkmcnt(6)
  v_mfma_f32_16x16x32_bf16 v[80:83], v[96:99], a[24:27], v[80:83]
  v_mfma_f32_16x16x32_bf16 v[84:87], v[96:99], a[56:59], v[84:87]
  v_mfma_f32_16x16x32_bf16 v[88:91], v[96:99], a[88:91], v[88:91]
  ds_read2_b32 v[96:97], v55 offset0:224 offset1:225
  ds_read2_b32 v[98:99], v55 offset0:226 offset1:227
  s_waitcnt lgkmcnt(6)
  v_mfma_f32_16x16x32_bf16 v[80:83], v[100:103], a[20:23], v[80:83]
  v_mfma_f32_16x16x32_bf16 v[84:87], v[100:103], a[52:55], v[84:87]
  v_mfma_f32_16x16x32_bf16 v[88:91], v[100:103], a[84:87], v[88:91]
  ds_read2_b32 v[100:101], v55 offset0:208 offset1:209
  ds_read2_b32 v[102:103], v55 offset0:210 offset1:211
  s_waitcnt lgkmcnt(6)
  v_mfma_f32_16x16x32_bf16 v[80:83], v[104:107], a[16:19], v[80:83]
  v_mfma_f32_16x16x32_bf16 v[84:87], v[104:107], a[48:51], v[84:87]
  v_mfma_f32_16x16x32_bf16 v[88:91], v[104:107], a[80:83], v[88:91]
  ds_read2_b32 v[104:105], v55 offset0:192 offset1:193
  ds_read2_b32 v[106:107], v55 offset0:194 offset1:195
  s_waitcnt lgkmcnt(6)
  v_mfma_f32_16x16x32_bf16 v[80:83], v[92:95], a[12:15], v[80:83]
  v_mfma_f32_16x16x32_bf16 v[84:87], v[92:95], a[44:47], v[84:87]
  v_mfma_f32_16x16x32_bf16 v[88:91], v[92:95], a[76:79], v[88:91]
  ds_read2_b32 v[92:93], v55 offset0:176 offset1:177
  ds_read2_b32 v[94:95], v55 offset0:178 offset1:179
  s_waitcnt lgkmcnt(6)
  v_mfma_f32_16x16x32_bf16 v[80:83], v[96:99], a[8:11], v[80:83]
  v_mfma_f32_16x16x32_bf16 v[84:87], v[96:99], a[40:43], v[84:87]
  v_mfma_f32_16x16x32_bf16 v[88:91], v[96:99], a[72:75], v[88:91]
  ds_read2_b32 v[96:97], v55 offset0:160 offset1:161
  ds_read2_b32 v[98:99], v55 offset0:162 offset1:163
  s_waitcnt lgkmcnt(6)
  v_mfma_f32_16x16x32_bf16 v[80:83], v[100:103], a[4:7], v[80:83]
  v_mfma_f32_16x16x32_bf16 v[84:87], v[100:103], a[36:39], v[84:87]
  v_mfma_f32_16x16x32_bf16 v[88:91], v[100:103], a[68:71], v[88:91]
  ds_read2_b32 v[100:101], v55 offset0:144 offset1:145
  ds_read2_b32 v[102:103], v55 offset0:146 offset1:147
  s_waitcnt lgkmcnt(6)
  v_mfma_f32_16x16x32_bf16 v[80:83], v[104:107], a[0:3], v[80:83]
  v_mfma_f32_16x16x32_bf16 v[84:87], v[104:107], a[32:35], v[84:87]
  v_mfma_f32_16x16x32_bf16 v[88:91], v[104:107], a[64:67], v[88:91]
  ds_read2_b32 v[104:105], v55 offset0:128 offset1:129
  ds_read2_b32 v[106:107], v55 offset0:130 offset1:131
  s_waitcnt lgkmcnt(6)
  v_mfma_f32_16x16x32_bf16 v[84:87], v[92:95], a[28:31], v[84:87]
  v_mfma_f32_16x16x32_bf16 v[88:91], v[92:95], a[60:63], v[88:91]
  ds_read2_b32 v[92:93], v55 offset0:112 offset1:113
  ds_read2_b32 v[94:95], v55 offset0:114 offset1:115
  s_waitcnt lgkmcnt(6)
  v_mfma_f32_16x16x32_bf16 v[84:87], v[96:99], a[24:27], v[84:87]
  v_mfma_f32_16x16x32_bf16 v[88:91], v[96:99], a[56:59], v[88:91]
  ds_read2_b32 v[96:97], v55 offset0:96 offset1:97
  ds_read2_b32 v[98:99], v55 offset0:98 offset1:99
  s_waitcnt lgkmcnt(6)
  v_mfma_f32_16x16x32_bf16 v[84:87], v[100:103], a[20:23], v[84:87]
  v_mfma_f32_16x16x32_bf16 v[88:91], v[100:103], a[52:55], v[88:91]
  ds_read2_b32 v[100:101], v55 offset0:80 offset1:81
  ds_read2_b32 v[102:103], v55 offset0:82 offset1:83
  s_waitcnt lgkmcnt(6)
  v_mfma_f32_16x16x32_bf16 v[84:87], v[104:107], a[16:19], v[84:87]
  v_mfma_f32_16x16x32_bf16 v[88:91], v[104:107], a[48:51], v[88:91]
  ds_read2_b32 v[104:105], v55 offset0:64 offset1:65
  ds_read2_b32 v[106:107], v55 offset0:66 offset1:67
  s_waitcnt lgkmcnt(6)
  v_mfma_f32_16x16x32_bf16 v[84:87], v[92:95], a[12:15], v[84:87]
  v_mfma_f32_16x16x32_bf16 v[88:91], v[92:95], a[44:47], v[88:91]
  ds_read2_b32 v[92:93], v55 offset0:48 offset1:49
  ds_read2_b32 v[94:95], v55 offset0:50 offset1:51
  s_waitcnt lgkmcnt(6)
  v_mfma_f32_16x16x32_bf16 v[84:87], v[96:99], a[8:11], v[84:87]
  v_mfma_f32_16x16x32_bf16 v[88:91], v[96:99], a[40:43], v[88:91]
  ds_read2_b32 v[96:97], v55 offset0:32 offset1:33
  ds_read2_b32 v[98:99], v55 offset0:34 offset1:35
  s_waitcnt lgkmcnt(6)
  v_mfma_f32_16x16x32_bf16 v[84:87], v[100:103], a[4:7], v[84:87]
  v_mfma_f32_16x16x32_bf16 v[88:91], v[100:103], a[36:39], v[88:91]
  ds_read2_b32 v[100:101], v55 offset0:16 offset1:17
  ds_read2_b32 v[102:103], v55 offset0:18 offset1:19
  s_waitcnt lgkmcnt(6)
  v_mfma_f32_16x16x32_bf16 v[84:87], v[104:107], a[0:3], v[84:87]
  v_mfma_f32_16x16x32_bf16 v[88:91], v[104:107], a[32:35], v[88:91]
  ds_read2_b32 v[104:105], v55 offset0:0 offset1:1
  ds_read2_b32 v[106:107], v55 offset0:2 offset1:3
  s_waitcnt lgkmcnt(6)
  v_mfma_f32_16x16x32_bf16 v[88:91], v[92:95], a[28:31], v[88:91]
  ds_read2_b32 v[92:93], v56 offset0:224 offset1:225
  ds_read2_b32 v[94:95], v56 offset0:226 offset1:227
  s_waitcnt lgkmcnt(6)
  v_mfma_f32_16x16x32_bf16 v[88:91], v[96:99], a[24:27], v[88:91]
  ds_read2_b32 v[96:97], v56 offset0:208 offset1:209
  ds_read2_b32 v[98:99], v56 offset0:210 offset1:211
  s_waitcnt lgkmcnt(6)
  v_mfma_f32_16x16x32_bf16 v[88:91], v[100:103], a[20:23], v[88:91]
  ds_read2_b32 v[100:101], v56 offset0:192 offset1:193
  ds_read2_b32 v[102:103], v56 offset0:194 offset1:195
  s_waitcnt lgkmcnt(6)
  v_mfma_f32_16x16x32_bf16 v[88:91], v[104:107], a[16:19], v[88:91]
  ds_read2_b32 v[104:105], v56 offset0:176 offset1:177
  ds_read2_b32 v[106:107], v56 offset0:178 offset1:179
  s_waitcnt lgkmcnt(6)
  v_mfma_f32_16x16x32_bf16 v[88:91], v[92:95], a[12:15], v[88:91]
  s_waitcnt lgkmcnt(4)
  v_mfma_f32_16x16x32_bf16 v[88:91], v[96:99], a[8:11], v[88:91]
  s_waitcnt lgkmcnt(2)
  v_mfma_f32_16x16x32_bf16 v[88:91], v[100:103], a[4:7], v[88:91]
  s_waitcnt lgkmcnt(0)
  v_mfma_f32_16x16x32_bf16 v[88:91], v[104:107], a[0:3], v[88:91]
  v_lshlrev_b32 v46, 5, v4
  v_lshl_add_u32 v46, v3, 3, v46
  v_add_u32 v46, s17, v46
  ds_read_b64 v[108:109], v46 offset:512
  ds_read_b64 v[110:111], v46 offset:1024
  ds_read_b64 v[112:113], v46 offset:1536
  ds_read_b64 v[114:115], v46 offset:2048
  ds_read_b64 v[116:117], v46 offset:2560
  ds_read_b64 v[118:119], v46 offset:3072
  ds_read_b64 v[120:121], v46 offset:3584
  ds_read_b64 v[122:123], v46 offset:4096
  s_waitcnt lgkmcnt(0)
  v_lshlrev_b32 v124, 16, v108
  v_and_b32 v125, 0xffff0000, v108
  v_lshlrev_b32 v126, 16, v109
  v_and_b32 v127, 0xffff0000, v109
  v_mul_f32 v124, v124, v33
  v_mul_f32 v125, v125, v33
  v_mul_f32 v126, v126, v33
  v_mul_f32 v127, v127, v33
  v_cvt_pk_bf16_f32 v128, v124, v125
  v_cvt_pk_bf16_f32 v129, v126, v127
  v_cvt_pk_bf16_f32 v130, v60, v61
  v_cvt_pk_bf16_f32 v131, v62, v63
  v_lshlrev_b32 v124, 16, v128
  v_and_b32 v125, 0xffff0000, v128
  v_lshlrev_b32 v132, 16, v130
  v_and_b32 v133, 0xffff0000, v130
  v_lshlrev_b32 v126, 16, v129
  v_and_b32 v127, 0xffff0000, v129
  v_lshlrev_b32 v134, 16, v131
  v_and_b32 v135, 0xffff0000, v131
  v_add_f32 v124, v124, v132
  v_add_f32 v125, v125, v133
  v_add_f32 v126, v126, v134
  v_add_f32 v127, v127, v135
  v_cvt_pk_bf16_f32 v108, v124, v125
  v_cvt_pk_bf16_f32 v109, v126, v127
  ds_write_b64 v46, v[108:109] offset:512
  v_lshlrev_b32 v124, 16, v110
  v_and_b32 v125, 0xffff0000, v110
  v_lshlrev_b32 v126, 16, v111
  v_and_b32 v127, 0xffff0000, v111
  v_mul_f32 v124, v124, v33
  v_mul_f32 v125, v125, v33
  v_mul_f32 v126, v126, v33
  v_mul_f32 v127, v127, v33
  v_cvt_pk_bf16_f32 v128, v124, v125
  v_cvt_pk_bf16_f32 v129, v126, v127
  v_cvt_pk_bf16_f32 v130, v64, v65
  v_cvt_pk_bf16_f32 v131, v66, v67
  v_lshlrev_b32 v124, 16, v128
  v_and_b32 v125, 0xffff0000, v128
  v_lshlrev_b32 v132, 16, v130
  v_and_b32 v133, 0xffff0000, v130
  v_lshlrev_b32 v126, 16, v129
  v_and_b32 v127, 0xffff0000, v129
  v_lshlrev_b32 v134, 16, v131
  v_and_b32 v135, 0xffff0000, v131
  v_add_f32 v124, v124, v132
  v_add_f32 v125, v125, v133
  v_add_f32 v126, v126, v134
  v_add_f32 v127, v127, v135
  v_cvt_pk_bf16_f32 v110, v124, v125
  v_cvt_pk_bf16_f32 v111, v126, v127
  ds_write_b64 v46, v[110:111] offset:1024
  v_lshlrev_b32 v124, 16, v112
  v_and_b32 v125, 0xffff0000, v112
  v_lshlrev_b32 v126, 16, v113
  v_and_b32 v127, 0xffff0000, v113
  v_mul_f32 v124, v124, v33
  v_mul_f32 v125, v125, v33
  v_mul_f32 v126, v126, v33
  v_mul_f32 v127, v127, v33
  v_cvt_pk_bf16_f32 v128, v124, v125
  v_cvt_pk_bf16_f32 v129, v126, v127
  v_cvt_pk_bf16_f32 v130, v68, v69
  v_cvt_pk_bf16_f32 v131, v70, v71
  v_lshlrev_b32 v124, 16, v128
  v_and_b32 v125, 0xffff0000, v128
  v_lshlrev_b32 v132, 16, v130
  v_and_b32 v133, 0xffff0000, v130
  v_lshlrev_b32 v126, 16, v129
  v_and_b32 v127, 0xffff0000, v129
  v_lshlrev_b32 v134, 16, v131
  v_and_b32 v135, 0xffff0000, v131
  v_add_f32 v124, v124, v132
  v_add_f32 v125, v125, v133
  v_add_f32 v126, v126, v134
  v_add_f32 v127, v127, v135
  v_cvt_pk_bf16_f32 v112, v124, v125
  v_cvt_pk_bf16_f32 v113, v126, v127
  ds_write_b64 v46, v[112:113] offset:1536
  v_lshlrev_b32 v124, 16, v114
  v_and_b32 v125, 0xffff0000, v114
  v_lshlrev_b32 v126, 16, v115
  v_and_b32 v127, 0xffff0000, v115
  v_mul_f32 v124, v124, v33
  v_mul_f32 v125, v125, v33
  v_mul_f32 v126, v126, v33
  v_mul_f32 v127, v127, v33
  v_cvt_pk_bf16_f32 v128, v124, v125
  v_cvt_pk_bf16_f32 v129, v126, v127
  v_cvt_pk_bf16_f32 v130, v72, v73
  v_cvt_pk_bf16_f32 v131, v74, v75
  v_lshlrev_b32 v124, 16, v128
  v_and_b32 v125, 0xffff0000, v128
  v_lshlrev_b32 v132, 16, v130
  v_and_b32 v133, 0xffff0000, v130
  v_lshlrev_b32 v126, 16, v129
  v_and_b32 v127, 0xffff0000, v129
  v_lshlrev_b32 v134, 16, v131
  v_and_b32 v135, 0xffff0000, v131
  v_add_f32 v124, v124, v132
  v_add_f32 v125, v125, v133
  v_add_f32 v126, v126, v134
  v_add_f32 v127, v127, v135
  v_cvt_pk_bf16_f32 v114, v124, v125
  v_cvt_pk_bf16_f32 v115, v126, v127
  ds_write_b64 v46, v[114:115] offset:2048
  v_lshlrev_b32 v124, 16, v116
  v_and_b32 v125, 0xffff0000, v116
  v_lshlrev_b32 v126, 16, v117
  v_and_b32 v127, 0xffff0000, v117
  v_mul_f32 v124, v124, v33
  v_mul_f32 v125, v125, v33
  v_mul_f32 v126, v126, v33
  v_mul_f32 v127, v127, v33
  v_cvt_pk_bf16_f32 v128, v124, v125
  v_cvt_pk_bf16_f32 v129, v126, v127
  v_cvt_pk_bf16_f32 v130, v76, v77
  v_cvt_pk_bf16_f32 v131, v78, v79
  v_lshlrev_b32 v124, 16, v128
  v_and_b32 v125, 0xffff0000, v128
  v_lshlrev_b32 v132, 16, v130
  v_and_b32 v133, 0xffff0000, v130
  v_lshlrev_b32 v126, 16, v129
  v_and_b32 v127, 0xffff0000, v129
  v_lshlrev_b32 v134, 16, v131
  v_and_b32 v135, 0xffff0000, v131
  v_add_f32 v124, v124, v132
  v_add_f32 v125, v125, v133
  v_add_f32 v126, v126, v134
  v_add_f32 v127, v127, v135
  v_cvt_pk_bf16_f32 v116, v124, v125
  v_cvt_pk_bf16_f32 v117, v126, v127
  ds_write_b64 v46, v[116:117] offset:2560
  v_lshlrev_b32 v124, 16, v118
  v_and_b32 v125, 0xffff0000, v118
  v_lshlrev_b32 v126, 16, v119
  v_and_b32 v127, 0xffff0000, v119
  v_mul_f32 v124, v124, v33
  v_mul_f32 v125, v125, v33
  v_mul_f32 v126, v126, v33
  v_mul_f32 v127, v127, v33
  v_cvt_pk_bf16_f32 v128, v124, v125
  v_cvt_pk_bf16_f32 v129, v126, v127
  v_cvt_pk_bf16_f32 v130, v80, v81
  v_cvt_pk_bf16_f32 v131, v82, v83
  v_lshlrev_b32 v124, 16, v128
  v_and_b32 v125, 0xffff0000, v128
  v_lshlrev_b32 v132, 16, v130
  v_and_b32 v133, 0xffff0000, v130
  v_lshlrev_b32 v126, 16, v129
  v_and_b32 v127, 0xffff0000, v129
  v_lshlrev_b32 v134, 16, v131
  v_and_b32 v135, 0xffff0000, v131
  v_add_f32 v124, v124, v132
  v_add_f32 v125, v125, v133
  v_add_f32 v126, v126, v134
  v_add_f32 v127, v127, v135
  v_cvt_pk_bf16_f32 v118, v124, v125
  v_cvt_pk_bf16_f32 v119, v126, v127
  ds_write_b64 v46, v[118:119] offset:3072
  v_lshlrev_b32 v124, 16, v120
  v_and_b32 v125, 0xffff0000, v120
  v_lshlrev_b32 v126, 16, v121
  v_and_b32 v127, 0xffff0000, v121
  v_mul_f32 v124, v124, v33
  v_mul_f32 v125, v125, v33
  v_mul_f32 v126, v126, v33
  v_mul_f32 v127, v127, v33
  v_cvt_pk_bf16_f32 v128, v124, v125
  v_cvt_pk_bf16_f32 v129, v126, v127
  v_cvt_pk_bf16_f32 v130, v84, v85
  v_cvt_pk_bf16_f32 v131, v86, v87
  v_lshlrev_b32 v124, 16, v128
  v_and_b32 v125, 0xffff0000, v128
  v_lshlrev_b32 v132, 16, v130
  v_and_b32 v133, 0xffff0000, v130
  v_lshlrev_b32 v126, 16, v129
  v_and_b32 v127, 0xffff0000, v129
  v_lshlrev_b32 v134, 16, v131
  v_and_b32 v135, 0xffff0000, v131
  v_add_f32 v124, v124, v132
  v_add_f32 v125, v125, v133
  v_add_f32 v126, v126, v134
  v_add_f32 v127, v127, v135
  v_cvt_pk_bf16_f32 v120, v124, v125
  v_cvt_pk_bf16_f32 v121, v126, v127
  ds_write_b64 v46, v[120:121] offset:3584
  v_lshlrev_b32 v124, 16, v122
  v_and_b32 v125, 0xffff0000, v122
  v_lshlrev_b32 v126, 16, v123
  v_and_b32 v127, 0xffff0000, v123
  v_mul_f32 v124, v124, v33
  v_mul_f32 v125, v125, v33
  v_mul_f32 v126, v126, v33
  v_mul_f32 v127, v127, v33
  v_cvt_pk_bf16_f32 v128, v124, v125
  v_cvt_pk_bf16_f32 v129, v126, v127
  v_cvt_pk_bf16_f32 v130, v88, v89
  v_cvt_pk_bf16_f32 v131, v90, v91
  v_lshlrev_b32 v124, 16, v128
  v_and_b32 v125, 0xffff0000, v128
  v_lshlrev_b32 v132, 16, v130
  v_and_b32 v133, 0xffff0000, v130
  v_lshlrev_b32 v126, 16, v129
  v_and_b32 v127, 0xffff0000, v129
  v_lshlrev_b32 v134, 16, v131
  v_and_b32 v135, 0xffff0000, v131
  v_add_f32 v124, v124, v132
  v_add_f32 v125, v125, v133
  v_add_f32 v126, v126, v134
  v_add_f32 v127, v127, v135
  v_cvt_pk_bf16_f32 v122, v124, v125
  v_cvt_pk_bf16_f32 v123, v126, v127
  ds_write_b64 v46, v[122:123] offset:4096
  s_waitcnt lgkmcnt(0)
  s_barrier
  v_lshlrev_b32 v6, 3, v0
  v_mul_u32_u24 v5, 7168, v0
  v_add_u32 v36, 512, v6
  ds_read_b64 v[8:9], v36
  v_add_u32 v36, 25088, v6
  ds_read_b64 v[10:11], v36
  v_add_u32 v36, 49664, v6
  ds_read_b64 v[12:13], v36
  v_add_u32 v36, 74240, v6
  ds_read_b64 v[14:15], v36
  s_waitcnt lgkmcnt(0)
  s_add_u32 s22, s21, 0
  s_add_u32 s23, s22, 3584
  v_perm_b32 v16, v10, v8, s24
  v_perm_b32 v17, v14, v12, s24
  buffer_store_dwordx2 v[16:17], v5, s[92:95], s22 offen offset:0
  v_perm_b32 v18, v10, v8, s25
  v_perm_b32 v19, v14, v12, s25
  buffer_store_dwordx2 v[18:19], v5, s[92:95], s22 offen offset:1792
  v_perm_b32 v20, v11, v9, s24
  v_perm_b32 v21, v15, v13, s24
  buffer_store_dwordx2 v[20:21], v5, s[92:95], s23 offen offset:0
  v_perm_b32 v22, v11, v9, s25
  v_perm_b32 v23, v15, v13, s25
  buffer_store_dwordx2 v[22:23], v5, s[92:95], s23 offen offset:1792
  v_add_u32 v36, 2560, v6
  ds_read_b64 v[8:9], v36
  v_add_u32 v36, 27136, v6
  ds_read_b64 v[10:11], v36
  v_add_u32 v36, 51712, v6
  ds_read_b64 v[12:13], v36
  v_add_u32 v36, 76288, v6
  ds_read_b64 v[14:15], v36
  s_waitcnt lgkmcnt(0)
  s_add_u32 s22, s21, 1835008
  s_add_u32 s23, s22, 3584
  v_perm_b32 v24, v10, v8, s24
  v_perm_b32 v25, v14, v12, s24
  buffer_store_dwordx2 v[24:25], v5, s[92:95], s22 offen offset:0
  v_perm_b32 v26, v10, v8, s25
  v_perm_b32 v27, v14, v12, s25
  buffer_store_dwordx2 v[26:27], v5, s[92:95], s22 offen offset:1792
  v_perm_b32 v28, v11, v9, s24
  v_perm_b32 v29, v15, v13, s24
  buffer_store_dwordx2 v[28:29], v5, s[92:95], s23 offen offset:0
  v_perm_b32 v30, v11, v9, s25
  v_perm_b32 v31, v15, v13, s25
  buffer_store_dwordx2 v[30:31], v5, s[92:95], s23 offen offset:1792
  s_branch wk_loop
wk_tok:
  s_sub_u32 s3, s3, 864
  s_lshr_b32 s17, s3, 3
  s_and_b32 s18, s3, 3
  s_bitcmp1_b32 s3, 2
  s_cbranch_scc1 wk_toko
  s_lshl_b32 s20, s18, 2
  s_add_u32 s20, s20, s16
  s_lshl_b32 s21, s17, 4
  s_add_u32 s21, s21, s20
  s_mul_i32 s21, s21, 28672
  s_add_u32 s21, s21, 12845056
  s_mul_i32 s23, s17, 28672
  s_add_u32 s23, s23, 73400320
  s_mul_i32 s24, s17, 7168
  s_add_u32 s24, s24, 88068096
  s_lshr_b32 s25, s17, 3
  s_lshl_b32 s25, s25, 4
  s_add_u32 s25, s25, s20
  s_lshl_b32 s25, s25, 7
  s_add_u32 s25, s25, 88545280
  v_mov_b32 v60, 0
  s_mov_b32 s30, 0
wp_wf:
  buffer_load_dword v61, v60, s[8:11], s25 offen sc1
  s_waitcnt vmcnt(0)
  v_cmp_ne_u32 vcc, 56, v61
  s_cbranch_vccz wp_wf_ok
  s_sleep 4
  s_cmp_ge_u32 s17, 56
  s_cbranch_scc1 wp_wf_bo
  s_sleep 127
wp_wf_bo:
  s_add_u32 s30, s30, 1
  s_cmp_lt_u32 s30, 30000
  s_cbranch_scc1 wp_wf
  s_branch wp_abort
wp_wf_ok:
  s_add_u32 s22, s21, 0
  buffer_load_dwordx4 a[0:3], v2, s[8:11], s22 offen offset:0 sc1
  buffer_load_dwordx4 a[4:7], v2, s[8:11], s22 offen offset:1024 sc1
  buffer_load_dwordx4 a[8:11], v2, s[8:11], s22 offen offset:2048 sc1
  buffer_load_dwordx4 a[12:15], v2, s[8:11], s22 offen offset:3072 sc1
  s_add_u32 s22, s21, 4096
  buffer_load_dwordx4 a[16:19], v2, s[8:11], s22 offen offset:0 sc1
  buffer_load_dwordx4 a[20:23], v2, s[8:11], s22 offen offset:1024 sc1
  buffer_load_dwordx4 a[24:27], v2, s[8:11], s22 offen offset:2048 sc1
  buffer_load_dwordx4 a[28:31], v2, s[8:11], s22 offen offset:3072 sc1
  s_add_u32 s22, s21, 8192
  buffer_load_dwordx4 a[32:35], v2, s[8:11], s22 offen offset:0 sc1
  buffer_load_dwordx4 a[36:39], v2, s[8:11], s22 offen offset:1024 sc1
  buffer_load_dwordx4 a[40:43], v2, s[8:11], s22 offen offset:2048 sc1
  buffer_load_dwordx4 a[44:47], v2, s[8:11], s22 offen offset:3072 sc1
  s_add_u32 s22, s21, 12288
  buffer_load_dwordx4 a[48:51], v2, s[8:11], s22 offen offset:0 sc1
  buffer_load_dwordx4 a[52:55], v2, s[8:11], s22 offen offset:1024 sc1
  buffer_load_dwordx4 a[56:59], v2, s[8:11], s22 offen offset:2048 sc1
  buffer_load_dwordx4 a[60:63], v2, s[8:11], s22 offen offset:3072 sc1
  s_add_u32 s22, s21, 16384
  buffer_load_dwordx4 a[64:67], v2, s[8:11], s22 offen offset:0 sc1
  buffer_load_dwordx4 a[68:71], v2, s[8:11], s22 offen offset:1024 sc1
  buffer_load_dwordx4 a[72:75], v2, s[8:11], s22 offen offset:2048 sc1
  buffer_load_dwordx4 a[76:79], v2, s[8:11], s22 offen offset:3072 sc1
  s_add_u32 s22, s21, 20480
  buffer_load_dwordx4 a[80:83], v2, s[8:11], s22 offen offset:0 sc1
  buffer_load_dwordx4 a[84:87], v2, s[8:11], s22 offen offset:1024 sc1
  buffer_load_dwordx4 a[88:91], v2, s[8:11], s22 offen offset:2048 sc1
  buffer_load_dwordx4 a[92:95], v2, s[8:11], s22 offen offset:3072 sc1
  s_add_u32 s22, s21, 24576
  buffer_load_dwordx4 a[96:99], v2, s[8:11], s22 offen offset:0 sc1
  buffer_load_dwordx4 a[100:103], v2, s[8:11], s22 offen offset:1024 sc1
  buffer_load_dwordx4 a[104:107], v2, s[8:11], s22 offen offset:2048 sc1
  buffer_load_dwordx4 a[108:111], v2, s[8:11], s22 offen offset:3072 sc1
  s_add_u32 s22, s23, 0
  buffer_load_dwordx4 a[112:115], v2, s[8:11], s22 offen offset:0 sc1
  buffer_load_dwordx4 a[116:119], v2, s[8:11], s22 offen offset:1024 sc1
  buffer_load_dwordx4 a[120:123], v2, s[8:11], s22 offen offset:2048 sc1
  buffer_load_dwordx4 a[124:127], v2, s[8:11], s22 offen offset:3072 sc1
  s_add_u32 s22, s23, 4096
  buffer_load_dwordx4 a[128:131], v2, s[8:11], s22 offen offset:0 sc1
  buffer_load_dwordx4 a[132:135], v2, s[8:11], s22 offen offset:1024 sc1
  buffer_load_dwordx4 a[136:139], v2, s[8:11], s22 offen offset:2048 sc1
  buffer_load_dwordx4 a[140:143], v2, s[8:11], s22 offen offset:3072 sc1
  s_add_u32 s22, s23, 8192
  buffer_load_dwordx4 a[144:147], v2, s[8:11], s22 offen offset:0 sc1
  buffer_load_dwordx4 a[148:151], v2, s[8:11], s22 offen offset:1024 sc1
  buffer_load_dwordx4 a[152:155], v2, s[8:11], s22 offen offset:2048 sc1
  buffer_load_dwordx4 a[156:159], v2, s[8:11], s22 offen offset:3072 sc1
  s_add_u32 s22, s23, 12288
  buffer_load_dwordx4 a[160:163], v2, s[8:11], s22 offen offset:0 sc1
  buffer_load_dwordx4 a[164:167], v2, s[8:11], s22 offen offset:1024 sc1
  buffer_load_dwordx4 a[168:171], v2, s[8:11], s22 offen offset:2048 sc1
  buffer_load_dwordx4 a[172:175], v2, s[8:11], s22 offen offset:3072 sc1
  s_add_u32 s22, s23, 16384
  buffer_load_dwordx4 a[176:179], v2, s[8:11], s22 offen offset:0 sc1
  buffer_load_dwordx4 a[180:183], v2, s[8:11], s22 offen offset:1024 sc1
  buffer_load_dwordx4 a[184:187], v2, s[8:11], s22 offen offset:2048 sc1
  buffer_load_dwordx4 a[188:191], v2, s[8:11], s22 offen offset:3072 sc1
  s_add_u32 s22, s23, 20480
  buffer_load_dwordx4 a[192:195], v2, s[8:11], s22 offen offset:0 sc1
  buffer_load_dwordx4 a[196:199], v2, s[8:11], s22 offen offset:1024 sc1
  buffer_load_dwordx4 a[200:203], v2, s[8:11], s22 offen offset:2048 sc1
  buffer_load_dwordx4 a[204:207], v2, s[8:11], s22 offen offset:3072 sc1
  s_add_u32 s22, s23, 24576
  buffer_load_dwordx4 a[208:211], v2, s[8:11], s22 offen offset:0 sc1
  buffer_load_dwordx4 a[212:215], v2, s[8:11], s22 offen offset:1024 sc1
  buffer_load_dwordx4 a[216:219], v2, s[8:11], s22 offen offset:2048 sc1
  buffer_load_dwordx4 a[220:223], v2, s[8:11], s22 offen offset:3072 sc1
  v_lshl_add_u32 v5, v3, 2, 0
  v_cmp_le_u32 s[40:41], v5, v4
  v_lshl_add_u32 v5, v3, 2, 1
  v_cmp_le_u32 s[42:43], v5, v4
  v_lshl_add_u32 v5, v3, 2, 2
  v_cmp_le_u32 s[44:45], v5, v4
  v_lshl_add_u32 v5, v3, 2, 3
  v_cmp_le_u32 s[46:47], v5, v4
  v_cmp_gt_u32 s[48:49], 2, v3
  v_mov_b32 v6, 0xff800000
  s_waitcnt vmcnt(0)
  v_mfma_f32_16x16x32_bf16 v[8:11], a[112:115], a[0:3], 0
  v_mfma_f32_16x16x32_bf16 v[12:15], a[112:115], a[56:59], 0
  v_mfma_f32_16x16x32_bf16 v[16:19], a[168:171], a[56:59], 0
  v_mfma_f32_16x16x32_bf16 v[8:11], a[116:119], a[4:7], v[8:11]
  v_mfma_f32_16x16x32_bf16 v[12:15], a[116:119], a[60:63], v[12:15]
  v_mfma_f32_16x16x32_bf16 v[16:19], a[172:175], a[60:63], v[16:19]
  v_mfma_f32_16x16x32_bf16 v[8:11], a[120:123], a[8:11], v[8:11]
  v_mfma_f32_16x16x32_bf16 v[12:15], a[120:123], a[64:67], v[12:15]
  v_mfma_f32_16x16x32_bf16 v[16:19], a[176:179], a[64:67], v[16:19]
  v_mfma_f32_16x16x32_bf16 v[8:11], a[124:127], a[12:15], v[8:11]
  v_mfma_f32_16x16x32_bf16 v[12:15], a[124:127], a[68:71], v[12:15]
  v_mfma_f32_16x16x32_bf16 v[16:19], a[180:183], a[68:71], v[16:19]
  v_mfma_f32_16x16x32_bf16 v[8:11], a[128:131], a[16:19], v[8:11]
  v_mfma_f32_16x16x32_bf16 v[12:15], a[128:131], a[72:75], v[12:15]
  v_mfma_f32_16x16x32_bf16 v[16:19], a[184:187], a[72:75], v[16:19]
  v_mfma_f32_16x16x32_bf16 v[8:11], a[132:135], a[20:23], v[8:11]
  v_mfma_f32_16x16x32_bf16 v[12:15], a[132:135], a[76:79], v[12:15]
  v_mfma_f32_16x16x32_bf16 v[16:19], a[188:191], a[76:79], v[16:19]
  v_mfma_f32_16x16x32_bf16 v[8:11], a[136:139], a[24:27], v[8:11]
  v_mfma_f32_16x16x32_bf16 v[12:15], a[136:139], a[80:83], v[12:15]
  v_mfma_f32_16x16x32_bf16 v[16:19], a[192:195], a[80:83], v[16:19]
  v_mfma_f32_16x16x32_bf16 v[8:11], a[140:143], a[28:31], v[8:11]
  v_mfma_f32_16x16x32_bf16 v[12:15], a[140:143], a[84:87], v[12:15]
  v_mfma_f32_16x16x32_bf16 v[16:19], a[196:199], a[84:87], v[16:19]
  v_mfma_f32_16x16x32_bf16 v[8:11], a[144:147], a[32:35], v[8:11]
  v_mfma_f32_16x16x32_bf16 v[12:15], a[144:147], a[88:91], v[12:15]
  v_mfma_f32_16x16x32_bf16 v[16:19], a[200:203], a[88:91], v[16:19]
  v_mfma_f32_16x16x32_bf16 v[8:11], a[148:151], a[36:39], v[8:11]
  v_mfma_f32_16x16x32_bf16 v[12:15], a[148:151], a[92:95], v[12:15]
  v_mfma_f32_16x16x32_bf16 v[16:19], a[204:207], a[92:95], v[16:19]
  v_mfma_f32_16x16x32_bf16 v[8:11], a[152:155], a[40:43], v[8:11]
  v_mfma_f32_16x16x32_bf16 v[12:15], a[152:155], a[96:99], v[12:15]
  v_mfma_f32_16x16x32_bf16 v[16:19], a[208:211], a[96:99], v[16:19]
  v_mfma_f32_16x16x32_bf16 v[8:11], a[156:159], a[44:47], v[8:11]
  v_mfma_f32_16x16x32_bf16 v[12:15], a[156:159], a[100:103], v[12:15]
  v_mfma_f32_16x16x32_bf16 v[16:19], a[212:215], a[100:103], v[16:19]
  v_mfma_f32_16x16x32_bf16 v[8:11], a[160:163], a[48:51], v[8:11]
  v_mfma_f32_16x16x32_bf16 v[12:15], a[160:163], a[104:107], v[12:15]
  v_mfma_f32_16x16x32_bf16 v[16:19], a[216:219], a[104:107], v[16:19]
  v_mfma_f32_16x16x32_bf16 v[8:11], a[164:167], a[52:55], v[8:11]
  v_mfma_f32_16x16x32_bf16 v[12:15], a[164:167], a[108:111], v[12:15]
  v_mfma_f32_16x16x32_bf16 v[16:19], a[220:223], a[108:111], v[16:19]
  s_mul_i32 s22, s20, 448
  v_mov_b32 v62, s22
  s_mov_b32 s30, 0
wp_pm:
  s_cmp_ge_u32 s17, 64
  s_cbranch_scc1 wp_pf
  buffer_load_dword v61, v62, s[8:11], s24 offen sc1
  s_waitcnt vmcnt(0)
  v_cmp_eq_u32 vcc, -1, v61
  s_cbranch_vccnz wp_pr
wp_pf:
  s_add_u32 s22, s24, 4096
  buffer_load_dwordx4 v[64:67], v2, s[8:11], s24 offen offset:0 sc1
  buffer_load_dwordx4 v[68:71], v2, s[8:11], s24 offen offset:1024 sc1
  buffer_load_dwordx4 v[72:75], v2, s[8:11], s24 offen offset:2048 sc1
  buffer_load_dwordx4 v[76:79], v2, s[8:11], s24 offen offset:3072 sc1
  buffer_load_dwordx4 v[80:83], v2, s[8:11], s22 offen offset:0 sc1
  buffer_load_dwordx4 v[84:87], v2, s[8:11], s22 offen offset:1024 sc1
  buffer_load_dwordx4 v[88:91], v2, s[8:11], s22 offen offset:2048 sc1
  s_waitcnt vmcnt(0)
  v_max_u32 v61, v64, v65
  v_max3_u32 v61, v61, v66, v67
  v_max3_u32 v61, v61, v68, v69
  v_max3_u32 v61, v61, v70, v71
  v_max3_u32 v61, v61, v72, v73
  v_max3_u32 v61, v61, v74, v75
  v_max3_u32 v61, v61, v76, v77
  v_max3_u32 v61, v61, v78, v79
  v_max3_u32 v61, v61, v80, v81
  v_max3_u32 v61, v61, v82, v83
  v_max3_u32 v61, v61, v84, v85
  v_max3_u32 v61, v61, v86, v87
  v_max3_u32 v61, v61, v88, v89
  v_max3_u32 v61, v61, v90, v91
  v_cmp_eq_u32 vcc, -1, v61
  s_cbranch_vccz wp_pk
wp_pr:
  s_sleep 4
  s_cmp_ge_u32 s17, 56
  s_cbranch_scc1 wp_pm_bo
  s_sleep 127
wp_pm_bo:
  s_add_u32 s30, s30, 1
  s_cmp_lt_u32 s30, 30000
  s_cbranch_scc1 wp_pm
  s_branch wp_abort
wp_pk:
  buffer_load_dword v250, v251, s[12:15], 0 offen sc1
  v_mfma_f32_16x16x32_bf16 v[20:23], v[64:67], a[0:3], 0
  v_mfma_f32_16x16x32_bf16 v[24:27], v[64:67], a[4:7], 0
  v_mfma_f32_16x16x32_bf16 v[28:31], v[64:67], a[56:59], 0
  v_mfma_f32_16x16x32_bf16 v[32:35], v[64:67], a[60:63], 0
  v_mfma_f32_16x16x32_bf16 v[20:23], v[68:71], a[8:11], v[20:23]
  v_mfma_f32_16x16x32_bf16 v[24:27], v[68:71], a[12:15], v[24:27]
  v_mfma_f32_16x16x32_bf16 v[28:31], v[68:71], a[64:67], v[28:31]
  v_mfma_f32_16x16x32_bf16 v[32:35], v[68:71], a[68:71], v[32:35]
  v_mfma_f32_16x16x32_bf16 v[20:23], v[72:75], a[16:19], v[20:23]
  v_mfma_f32_16x16x32_bf16 v[24:27], v[72:75], a[20:23], v[24:27]
  v_mfma_f32_16x16x32_bf16 v[28:31], v[72:75], a[72:75], v[28:31]
  v_mfma_f32_16x16x32_bf16 v[32:35], v[72:75], a[76:79], v[32:35]
  v_mfma_f32_16x16x32_bf16 v[20:23], v[76:79], a[24:27], v[20:23]
  v_mfma_f32_16x16x32_bf16 v[24:27], v[76:79], a[28:31], v[24:27]
  v_mfma_f32_16x16x32_bf16 v[28:31], v[76:79], a[80:83], v[28:31]
  v_mfma_f32_16x16x32_bf16 v[32:35], v[76:79], a[84:87], v[32:35]
  v_mfma_f32_16x16x32_bf16 v[20:23], v[80:83], a[32:35], v[20:23]
  v_mfma_f32_16x16x32_bf16 v[24:27], v[80:83], a[36:39], v[24:27]
  v_mfma_f32_16x16x32_bf16 v[28:31], v[80:83], a[88:91], v[28:31]
  v_mfma_f32_16x16x32_bf16 v[32:35], v[80:83], a[92:95], v[32:35]
  v_mfma_f32_16x16x32_bf16 v[20:23], v[84:87], a[40:43], v[20:23]
  v_mfma_f32_16x16x32_bf16 v[24:27], v[84:87], a[44:47], v[24:27]
  v_mfma_f32_16x16x32_bf16 v[28:31], v[84:87], a[96:99], v[28:31]
  v_mfma_f32_16x16x32_bf16 v[32:35], v[84:87], a[100:103], v[32:35]
  v_mfma_f32_16x16x32_bf16 v[20:23], v[88:91], a[48:51], v[20:23]
  v_mfma_f32_16x16x32_bf16 v[24:27], v[88:91], a[52:55], v[24:27]
  v_mfma_f32_16x16x32_bf16 v[28:31], v[88:91], a[104:107], v[28:31]
  v_mfma_f32_16x16x32_bf16 v[32:35], v[88:91], a[108:111], v[32:35]
  s_lshl_b32 s25, s17, 1
  s_mul_i32 s25, s25, 20480
  s_add_u32 s25, s25, 85446656
  s_lshl_b32 s26, s20, 10
  s_add_u32 s26, s26, s25
  s_lshl_b32 s27, s18, 10
  s_add_u32 s27, s27, s25
  s_lshr_b32 s28, s16, 1
  s_lshl_b32 s28, s28, 3
  s_add_u32 s27, s27, s28
  s_add_u32 s27, s27, 16384
  s_and_b32 s28, s16, 1
  s_cmp_eq_u32 s28, 0
  s_cselect_b32 s50, -1, 0
  s_cselect_b32 s51, 0, -1
  v_cndmask_b32 v8, v6, v8, s[40:41]
  v_cndmask_b32 v9, v6, v9, s[42:43]
  v_cndmask_b32 v10, v6, v10, s[44:45]
  v_cndmask_b32 v11, v6, v11, s[46:47]
  v_cndmask_b32 v20, v24, v20, s[48:49]
  v_cndmask_b32 v21, v25, v21, s[48:49]
  v_cndmask_b32 v22, v26, v22, s[48:49]
  v_cndmask_b32 v23, v27, v23, s[48:49]
  v_mov_b32 v24, v20
  v_mov_b32 v25, v21
  v_mov_b32 v26, v22
  v_mov_b32 v27, v23
  v_permlane32_swap_b32 v20, v24
  v_permlane32_swap_b32 v21, v25
  v_permlane32_swap_b32 v22, v26
  v_permlane32_swap_b32 v23, v27
  v_add_f32 v20, v20, v24
  v_add_f32 v21, v21, v25
  v_add_f32 v22, v22, v26
  v_add_f32 v23, v23, v27
  v_max3_f32 v40, v8, v9, v10
  v_max3_f32 v40, v40, v11, v20
  v_max3_f32 v40, v40, v21, v22
  v_max_f32 v40, v40, v23
  v_mov_b32 v41, v40
  s_nop 1
  v_permlane16_swap_b32 v40, v41
  v_max_f32 v40, v40, v41
  v_mov_b32 v41, v40
  s_nop 1
  v_permlane32_swap_b32 v40, v41
  v_max_f32 v40, v40, v41
  v_sub_f32 v8, v8, v40
  v_sub_f32 v9, v9, v40
  v_sub_f32 v10, v10, v40
  v_sub_f32 v11, v11, v40
  v_sub_f32 v20, v20, v40
  v_sub_f32 v21, v21, v40
  v_sub_f32 v22, v22, v40
  v_sub_f32 v23, v23, v40
  v_exp_f32 v8, v8
  v_exp_f32 v9, v9
  v_exp_f32 v10, v10
  v_exp_f32 v11, v11
  v_exp_f32 v20, v20
  v_exp_f32 v21, v21
  v_exp_f32 v22, v22
  v_exp_f32 v23, v23
  v_add_f32 v42, v20, v21
  v_add_f32 v43, v22, v23
  v_add_f32 v42, v42, v43
  v_mul_f32 v42, 0.5, v42
  v_add_f32 v42, v42, v8
  v_add_f32 v42, v42, v9
  v_add_f32 v42, v42, v10
  v_add_f32 v42, v42, v11
  v_mov_b32 v41, v42
  s_nop 1
  v_permlane16_swap_b32 v42, v41
  v_add_f32 v42, v42, v41
  v_mov_b32 v41, v42
  s_nop 1
  v_permlane32_swap_b32 v42, v41
  v_add_f32 v42, v42, v41
  v_rcp_f32 v42, v42
  s_nop 0
  v_mul_f32 v8, v8, v42
  v_mul_f32 v9, v9, v42
  v_mul_f32 v10, v10, v42
  v_mul_f32 v11, v11, v42
  v_mul_f32 v20, v20, v42
  v_mul_f32 v21, v21, v42
  v_mul_f32 v22, v22, v42
  v_mul_f32 v23, v23, v42
  v_cvt_pk_bf16_f32 v44, v8, v9
  v_cvt_pk_bf16_f32 v45, v10, v11
  v_mov_b32 v46, 0
  v_mov_b32 v47, 0
  v_cvt_pk_bf16_f32 v48, v20, v21
  v_cvt_pk_bf16_f32 v49, v22, v23
  buffer_store_dwordx4 v[44:47], v2, s[8:11], s26 offen sc1
  s_mov_b64 exec, s[50:51]
  buffer_store_dwordx2 v[48:49], v2, s[8:11], s27 offen sc1
  s_mov_b64 exec, -1
  s_add_u32 s26, s26, 20480
  s_add_u32 s27, s27, 20480
  v_cndmask_b32 v16, v6, v16, s[40:41]
  v_cndmask_b32 v17, v6, v17, s[42:43]
  v_cndmask_b32 v18, v6, v18, s[44:45]
  v_cndmask_b32 v19, v6, v19, s[46:47]
  v_cndmask_b32 v28, v32, v28, s[48:49]
  v_cndmask_b32 v29, v33, v29, s[48:49]
  v_cndmask_b32 v30, v34, v30, s[48:49]
  v_cndmask_b32 v31, v35, v31, s[48:49]
  v_mov_b32 v32, v28
  v_mov_b32 v33, v29
  v_mov_b32 v34, v30
  v_mov_b32 v35, v31
  v_permlane32_swap_b32 v28, v32
  v_permlane32_swap_b32 v29, v33
  v_permlane32_swap_b32 v30, v34
  v_permlane32_swap_b32 v31, v35
  v_add_f32 v28, v28, v32
  v_add_f32 v29, v29, v33
  v_add_f32 v30, v30, v34
  v_add_f32 v31, v31, v35
  v_max3_f32 v40, v12, v13, v14
  v_max3_f32 v40, v40, v15, v16
  v_max3_f32 v40, v40, v17, v18
  v_max3_f32 v40, v40, v19, v28
  v_max3_f32 v40, v40, v29, v30
  v_max_f32 v40, v40, v31
  v_mov_b32 v41, v40
  s_nop 1
  v_permlane16_swap_b32 v40, v41
  v_max_f32 v40, v40, v41
  v_mov_b32 v41, v40
  s_nop 1
  v_permlane32_swap_b32 v40, v41
  v_max_f32 v40, v40, v41
  v_sub_f32 v12, v12, v40
  v_sub_f32 v13, v13, v40
  v_sub_f32 v14, v14, v40
  v_sub_f32 v15, v15, v40
  v_sub_f32 v16, v16, v40
  v_sub_f32 v17, v17, v40
  v_sub_f32 v18, v18, v40
  v_sub_f32 v19, v19, v40
  v_sub_f32 v28, v28, v40
  v_sub_f32 v29, v29, v40
  v_sub_f32 v30, v30, v40
  v_sub_f32 v31, v31, v40
  v_exp_f32 v12, v12
  v_exp_f32 v13, v13
  v_exp_f32 v14, v14
  v_exp_f32 v15, v15
  v_exp_f32 v16, v16
  v_exp_f32 v17, v17
  v_exp_f32 v18, v18
  v_exp_f32 v19, v19
  v_exp_f32 v28, v28
  v_exp_f32 v29, v29
  v_exp_f32 v30, v30
  v_exp_f32 v31, v31
  v_add_f32 v42, v28, v29
  v_add_f32 v43, v30, v31
  v_add_f32 v42, v42, v43
  v_mul_f32 v42, 0.5, v42
  v_add_f32 v42, v42, v12
  v_add_f32 v42, v42, v13
  v_add_f32 v42, v42, v14
  v_add_f32 v42, v42, v15
  v_add_f32 v42, v42, v16
  v_add_f32 v42, v42, v17
  v_add_f32 v42, v42, v18
  v_add_f32 v42, v42, v19
  v_mov_b32 v41, v42
  s_nop 1
  v_permlane16_swap_b32 v42, v41
  v_add_f32 v42, v42, v41
  v_mov_b32 v41, v42
  s_nop 1
  v_permlane32_swap_b32 v42, v41
  v_add_f32 v42, v42, v41
  v_rcp_f32 v42, v42
  s_nop 0
  v_mul_f32 v12, v12, v42
  v_mul_f32 v13, v13, v42
  v_mul_f32 v14, v14, v42
  v_mul_f32 v15, v15, v42
  v_mul_f32 v16, v16, v42
  v_mul_f32 v17, v17, v42
  v_mul_f32 v18, v18, v42
  v_mul_f32 v19, v19, v42
  v_mul_f32 v28, v28, v42
  v_mul_f32 v29, v29, v42
  v_mul_f32 v30, v30, v42
  v_mul_f32 v31, v31, v42
  v_cvt_pk_bf16_f32 v52, v12, v13
  v_cvt_pk_bf16_f32 v53, v14, v15
  v_cvt_pk_bf16_f32 v54, v16, v17
  v_cvt_pk_bf16_f32 v55, v18, v19
  v_cvt_pk_bf16_f32 v56, v28, v29
  v_cvt_pk_bf16_f32 v57, v30, v31
  buffer_store_dwordx4 v[52:55], v2, s[8:11], s26 offen sc1
  s_mov_b64 exec, s[50:51]
  buffer_store_dwordx2 v[56:57], v2, s[8:11], s27 offen sc1
  s_mov_b64 exec, -1
  s_lshl_b32 s25, s17, 7
  s_add_u32 s25, s25, 88561664
  v_mov_b32 v5, 1
  v_mov_b32 v6, 0
  s_waitcnt vmcnt(0)
  s_mov_b64 exec, 1
  buffer_atomic_add v5, v6, s[8:11], s25 offen
  s_mov_b64 exec, -1
  s_branch wk_loop
wk_toko:
  s_lshl_b32 s20, s18, 2
  s_add_u32 s20, s20, s16
  s_mul_i32 s24, s20, 65
  s_add_u32 s24, s24, s17
  s_lshl_b32 s24, s24, 13
  s_add_u32 s24, s24, 76935168
  s_lshl_b32 s21, s20, 6
  s_add_u32 s21, s21, s17
  s_mul_i32 s21, s21, 28672
  s_add_u32 s21, s21, 42205184
  s_lshl_b32 s25, s17, 1
  s_mul_i32 s25, s25, 20480
  s_add_u32 s25, s25, 85446656
  v_mul_u32_u24 v7, 28, v3
  v_add_u32 v5, v7, v4
  v_lshlrev_b32 v5, 4, v5
  v_add_u32 v6, 16, v4
  v_min_u32 v6, 27, v6
  v_add_u32 v6, v7, v6
  v_lshlrev_b32 v6, 4, v6
  v_lshrrev_b32 v8, 1, v3
  v_lshl_add_u32 v8, v8, 4, v4
  v_lshlrev_b32 v8, 4, v8
  v_and_b32 v9, 1, v3
  v_lshl_add_u32 v7, v9, 3, v8
  s_lshr_b32 s26, s17, 3
  s_lshl_b32 s26, s26, 4
  s_add_u32 s26, s26, s20
  s_lshl_b32 s26, s26, 7
  s_add_u32 s26, s26, 88528896
  v_mov_b32 v60, 0
  s_mov_b32 s30, 0
wo_wv:
  buffer_load_dword v61, v60, s[8:11], s26 offen sc1
  s_waitcnt vmcnt(0)
  v_cmp_ne_u32 vcc, 56, v61
  s_cbranch_vccz wo_wv_ok
  s_sleep 4
  s_cmp_ge_u32 s17, 56
  s_cbranch_scc1 wo_wv_bo
  s_sleep 127
wo_wv_bo:
  s_add_u32 s30, s30, 1
  s_cmp_lt_u32 s30, 30000
  s_cbranch_scc1 wo_wv
  s_branch wo_abort
wo_wv_ok:
  s_add_u32 s22, s21, 0
  buffer_load_dwordx4 a[0:3], v5, s[8:11], s22 offen offset:0 sc1
  buffer_load_dwordx4 a[4:7], v6, s[8:11], s22 offen offset:0 sc1
  buffer_load_dwordx4 a[8:11], v5, s[8:11], s22 offen offset:1792 sc1
  buffer_load_dwordx4 a[12:15], v6, s[8:11], s22 offen offset:1792 sc1
  s_add_u32 s22, s21, 3584
  buffer_load_dwordx4 a[16:19], v5, s[8:11], s22 offen offset:0 sc1
  buffer_load_dwordx4 a[20:23], v6, s[8:11], s22 offen offset:0 sc1
  buffer_load_dwordx4 a[24:27], v5, s[8:11], s22 offen offset:1792 sc1
  buffer_load_dwordx4 a[28:31], v6, s[8:11], s22 offen offset:1792 sc1
  s_add_u32 s22, s21, 7168
  buffer_load_dwordx4 a[32:35], v5, s[8:11], s22 offen offset:0 sc1
  buffer_load_dwordx4 a[36:39], v6, s[8:11], s22 offen offset:0 sc1
  buffer_load_dwordx4 a[40:43], v5, s[8:11], s22 offen offset:1792 sc1
  buffer_load_dwordx4 a[44:47], v6, s[8:11], s22 offen offset:1792 sc1
  s_add_u32 s22, s21, 10752
  buffer_load_dwordx4 a[48:51], v5, s[8:11], s22 offen offset:0 sc1
  buffer_load_dwordx4 a[52:55], v6, s[8:11], s22 offen offset:0 sc1
  buffer_load_dwordx4 a[56:59], v5, s[8:11], s22 offen offset:1792 sc1
  buffer_load_dwordx4 a[60:63], v6, s[8:11], s22 offen offset:1792 sc1
  s_add_u32 s22, s21, 14336
  buffer_load_dwordx4 a[64:67], v5, s[8:11], s22 offen offset:0 sc1
  buffer_load_dwordx4 a[68:71], v6, s[8:11], s22 offen offset:0 sc1
  buffer_load_dwordx4 a[72:75], v5, s[8:11], s22 offen offset:1792 sc1
  buffer_load_dwordx4 a[76:79], v6, s[8:11], s22 offen offset:1792 sc1
  s_add_u32 s22, s21, 17920
  buffer_load_dwordx4 a[80:83], v5, s[8:11], s22 offen offset:0 sc1
  buffer_load_dwordx4 a[84:87], v6, s[8:11], s22 offen offset:0 sc1
  buffer_load_dwordx4 a[88:91], v5, s[8:11], s22 offen offset:1792 sc1
  buffer_load_dwordx4 a[92:95], v6, s[8:11], s22 offen offset:1792 sc1
  s_add_u32 s22, s21, 21504
  buffer_load_dwordx4 a[96:99], v5, s[8:11], s22 offen offset:0 sc1
  buffer_load_dwordx4 a[100:103], v6, s[8:11], s22 offen offset:0 sc1
  buffer_load_dwordx4 a[104:107], v5, s[8:11], s22 offen offset:1792 sc1
  buffer_load_dwordx4 a[108:111], v6, s[8:11], s22 offen offset:1792 sc1
  s_add_u32 s22, s21, 25088
  buffer_load_dwordx4 a[112:115], v5, s[8:11], s22 offen offset:0 sc1
  buffer_load_dwordx4 a[116:119], v6, s[8:11], s22 offen offset:0 sc1
  buffer_load_dwordx4 a[120:123], v5, s[8:11], s22 offen offset:1792 sc1
  buffer_load_dwordx4 a[124:127], v6, s[8:11], s22 offen offset:1792 sc1
  s_lshl_b32 s26, s20, 6
  s_add_u32 s26, s26, s17
  s_lshl_b32 s26, s26, 4
  s_add_u32 s26, s26, 88569856
  v_lshlrev_b32 v60, 2, v3
  s_mov_b32 s30, 0
wo_wt:
  buffer_load_dword v61, v60, s[8:11], s26 offen sc1
  s_waitcnt vmcnt(0)
  v_cmp_ne_u32 vcc, 1, v61
  s_cbranch_vccz wo_wt_ok
  s_sleep 4
  s_cmp_ge_u32 s17, 56
  s_cbranch_scc1 wo_wt_bo
  s_sleep 127
wo_wt_bo:
  s_add_u32 s30, s30, 1
  s_cmp_lt_u32 s30, 30000
  s_cbranch_scc1 wo_wt
  s_branch wo_abort
wo_wt_ok:
  s_add_u32 s22, s24, 0
  buffer_load_dwordx2 v[28:29], v7, s[8:11], s22 offen offset:0 sc1
  buffer_load_dwordx2 v[30:31], v7, s[8:11], s22 offen offset:512 sc1
  buffer_load_dwordx2 v[32:33], v7, s[8:11], s22 offen offset:1024 sc1
  buffer_load_dwordx2 v[34:35], v7, s[8:11], s22 offen offset:1536 sc1
  buffer_load_dwordx2 v[36:37], v7, s[8:11], s22 offen offset:2048 sc1
  buffer_load_dwordx2 v[38:39], v7, s[8:11], s22 offen offset:2560 sc1
  buffer_load_dwordx2 v[40:41], v7, s[8:11], s22 offen offset:3072 sc1
  buffer_load_dwordx2 v[42:43], v7, s[8:11], s22 offen offset:3584 sc1
  s_add_u32 s22, s24, 4096
  buffer_load_dwordx2 v[44:45], v7, s[8:11], s22 offen offset:0 sc1
  buffer_load_dwordx2 v[46:47], v7, s[8:11], s22 offen offset:512 sc1
  buffer_load_dwordx2 v[48:49], v7, s[8:11], s22 offen offset:1024 sc1
  buffer_load_dwordx2 v[50:51], v7, s[8:11], s22 offen offset:1536 sc1
  buffer_load_dwordx2 v[52:53], v7, s[8:11], s22 offen offset:2048 sc1
  buffer_load_dwordx2 v[54:55], v7, s[8:11], s22 offen offset:2560 sc1
  buffer_load_dwordx2 v[56:57], v7, s[8:11], s22 offen offset:3072 sc1
  buffer_load_dwordx2 v[58:59], v7, s[8:11], s22 offen offset:3584 sc1
  s_lshl_b32 s26, s17, 7
  s_add_u32 s26, s26, 88561664
  v_mov_b32 v60, 0
  s_mov_b32 s30, 0
wo_wp:
  buffer_load_dword v61, v60, s[8:11], s26 offen sc1
  s_waitcnt vmcnt(0)
  v_cmp_ne_u32 vcc, 16, v61
  s_cbranch_vccz wo_wp_ok
  s_sleep 2
  s_cmp_ge_u32 s17, 56
  s_cbranch_scc1 wo_wp_bo
  s_sleep 127
wo_wp_bo:
  s_add_u32 s30, s30, 1
  s_cmp_lt_u32 s30, 30000
  s_cbranch_scc1 wo_wp
  s_branch wo_abort
wo_wp_ok:
  buffer_load_dword v250, v251, s[12:15], 0 offen sc1
  s_add_u32 s26, s25, 0
  s_add_u32 s27, s25, 20480
  buffer_load_dwordx4 a[128:131], v2, s[8:11], s26 offen offset:0 sc1
  buffer_load_dwordx4 a[132:135], v2, s[8:11], s27 offen offset:0 sc1
  buffer_load_dwordx4 a[136:139], v2, s[8:11], s26 offen offset:1024 sc1
  buffer_load_dwordx4 a[140:143], v2, s[8:11], s27 offen offset:1024 sc1
  buffer_load_dwordx4 a[144:147], v2, s[8:11], s26 offen offset:2048 sc1
  buffer_load_dwordx4 a[148:151], v2, s[8:11], s27 offen offset:2048 sc1
  buffer_load_dwordx4 a[152:155], v2, s[8:11], s26 offen offset:3072 sc1
  buffer_load_dwordx4 a[156:159], v2, s[8:11], s27 offen offset:3072 sc1
  s_add_u32 s26, s25, 4096
  s_add_u32 s27, s25, 24576
  buffer_load_dwordx4 a[160:163], v2, s[8:11], s26 offen offset:0 sc1
  buffer_load_dwordx4 a[164:167], v2, s[8:11], s27 offen offset:0 sc1
  buffer_load_dwordx4 a[168:171], v2, s[8:11], s26 offen offset:1024 sc1
  buffer_load_dwordx4 a[172:175], v2, s[8:11], s27 offen offset:1024 sc1
  buffer_load_dwordx4 a[176:179], v2, s[8:11], s26 offen offset:2048 sc1
  buffer_load_dwordx4 a[180:183], v2, s[8:11], s27 offen offset:2048 sc1
  buffer_load_dwordx4 a[184:187], v2, s[8:11], s26 offen offset:3072 sc1
  buffer_load_dwordx4 a[188:191], v2, s[8:11], s27 offen offset:3072 sc1
  s_add_u32 s26, s25, 8192
  s_add_u32 s27, s25, 28672
  buffer_load_dwordx4 a[192:195], v2, s[8:11], s26 offen offset:0 sc1
  buffer_load_dwordx4 a[196:199], v2, s[8:11], s27 offen offset:0 sc1
  buffer_load_dwordx4 a[200:203], v2, s[8:11], s26 offen offset:1024 sc1
  buffer_load_dwordx4 a[204:207], v2, s[8:11], s27 offen offset:1024 sc1
  buffer_load_dwordx4 a[208:211], v2, s[8:11], s26 offen offset:2048 sc1
  buffer_load_dwordx4 a[212:215], v2, s[8:11], s27 offen offset:2048 sc1
  buffer_load_dwordx4 a[216:219], v2, s[8:11], s26 offen offset:3072 sc1
  buffer_load_dwordx4 a[220:223], v2, s[8:11], s27 offen offset:3072 sc1
  s_add_u32 s26, s25, 12288
  s_add_u32 s27, s25, 32768
  buffer_load_dwordx4 a[224:227], v2, s[8:11], s26 offen offset:0 sc1
  buffer_load_dwordx4 a[228:231], v2, s[8:11], s27 offen offset:0 sc1
  buffer_load_dwordx4 a[232:235], v2, s[8:11], s26 offen offset:1024 sc1
  buffer_load_dwordx4 a[236:239], v2, s[8:11], s27 offen offset:1024 sc1
  buffer_load_dwordx4 a[240:243], v2, s[8:11], s26 offen offset:2048 sc1
  buffer_load_dwordx4 a[244:247], v2, s[8:11], s27 offen offset:2048 sc1
  buffer_load_dwordx4 a[248:251], v2, s[8:11], s26 offen offset:3072 sc1
  buffer_load_dwordx4 a[252:255], v2, s[8:11], s27 offen offset:3072 sc1
  s_add_u32 s26, s25, 16384
  s_add_u32 s27, s25, 36864
  buffer_load_dwordx4 v[64:67], v2, s[8:11], s26 offen offset:0 sc1
  buffer_load_dwordx4 v[68:71], v2, s[8:11], s27 offen offset:0 sc1
  buffer_load_dwordx4 v[72:75], v2, s[8:11], s26 offen offset:1024 sc1
  buffer_load_dwordx4 v[76:79], v2, s[8:11], s27 offen offset:1024 sc1
  buffer_load_dwordx4 v[80:83], v2, s[8:11], s26 offen offset:2048 sc1
  buffer_load_dwordx4 v[84:87], v2, s[8:11], s27 offen offset:2048 sc1
  buffer_load_dwordx4 v[88:91], v2, s[8:11], s26 offen offset:3072 sc1
  buffer_load_dwordx4 v[92:95], v2, s[8:11], s27 offen offset:3072 sc1
  s_waitcnt vmcnt(38)
  v_mfma_f32_16x16x32_bf16 v[12:15], a[0:3], a[128:131], 0
  v_mfma_f32_16x16x32_bf16 v[16:19], a[0:3], a[132:135], 0
  v_mfma_f32_16x16x32_bf16 v[20:23], a[4:7], a[128:131], 0
  v_mfma_f32_16x16x32_bf16 v[24:27], a[4:7], a[132:135], 0
  s_waitcnt vmcnt(36)
  v_mfma_f32_16x16x32_bf16 v[12:15], a[8:11], a[136:139], v[12:15]
  v_mfma_f32_16x16x32_bf16 v[16:19], a[8:11], a[140:143], v[16:19]
  v_mfma_f32_16x16x32_bf16 v[20:23], a[12:15], a[136:139], v[20:23]
  v_mfma_f32_16x16x32_bf16 v[24:27], a[12:15], a[140:143], v[24:27]
  s_waitcnt vmcnt(34)
  v_mfma_f32_16x16x32_bf16 v[12:15], a[16:19], a[144:147], v[12:15]
  v_mfma_f32_16x16x32_bf16 v[16:19], a[16:19], a[148:151], v[16:19]
  v_mfma_f32_16x16x32_bf16 v[20:23], a[20:23], a[144:147], v[20:23]
  v_mfma_f32_16x16x32_bf16 v[24:27], a[20:23], a[148:151], v[24:27]
  s_waitcnt vmcnt(32)
  v_mfma_f32_16x16x32_bf16 v[12:15], a[24:27], a[152:155], v[12:15]
  v_mfma_f32_16x16x32_bf16 v[16:19], a[24:27], a[156:159], v[16:19]
  v_mfma_f32_16x16x32_bf16 v[20:23], a[28:31], a[152:155], v[20:23]
  v_mfma_f32_16x16x32_bf16 v[24:27], a[28:31], a[156:159], v[24:27]
  s_waitcnt vmcnt(30)
  v_mfma_f32_16x16x32_bf16 v[12:15], a[32:35], a[160:163], v[12:15]
  v_mfma_f32_16x16x32_bf16 v[16:19], a[32:35], a[164:167], v[16:19]
  v_mfma_f32_16x16x32_bf16 v[20:23], a[36:39], a[160:163], v[20:23]
  v_mfma_f32_16x16x32_bf16 v[24:27], a[36:39], a[164:167], v[24:27]
  s_waitcnt vmcnt(28)
  v_mfma_f32_16x16x32_bf16 v[12:15], a[40:43], a[168:171], v[12:15]
  v_mfma_f32_16x16x32_bf16 v[16:19], a[40:43], a[172:175], v[16:19]
  v_mfma_f32_16x16x32_bf16 v[20:23], a[44:47], a[168:171], v[20:23]
  v_mfma_f32_16x16x32_bf16 v[24:27], a[44:47], a[172:175], v[24:27]
  s_waitcnt vmcnt(26)
  v_mfma_f32_16x16x32_bf16 v[12:15], a[48:51], a[176:179], v[12:15]
  v_mfma_f32_16x16x32_bf16 v[16:19], a[48:51], a[180:183], v[16:19]
  v_mfma_f32_16x16x32_bf16 v[20:23], a[52:55], a[176:179], v[20:23]
  v_mfma_f32_16x16x32_bf16 v[24:27], a[52:55], a[180:183], v[24:27]
  s_waitcnt vmcnt(24)
  v_mfma_f32_16x16x32_bf16 v[12:15], a[56:59], a[184:187], v[12:15]
  v_mfma_f32_16x16x32_bf16 v[16:19], a[56:59], a[188:191], v[16:19]
  v_mfma_f32_16x16x32_bf16 v[20:23], a[60:63], a[184:187], v[20:23]
  v_mfma_f32_16x16x32_bf16 v[24:27], a[60:63], a[188:191], v[24:27]
  s_waitcnt vmcnt(22)
  v_mfma_f32_16x16x32_bf16 v[12:15], a[64:67], a[192:195], v[12:15]
  v_mfma_f32_16x16x32_bf16 v[16:19], a[64:67], a[196:199], v[16:19]
  v_mfma_f32_16x16x32_bf16 v[20:23], a[68:71], a[192:195], v[20:23]
  v_mfma_f32_16x16x32_bf16 v[24:27], a[68:71], a[196:199], v[24:27]
  s_waitcnt vmcnt(20)
  v_mfma_f32_16x16x32_bf16 v[12:15], a[72:75], a[200:203], v[12:15]
  v_mfma_f32_16x16x32_bf16 v[16:19], a[72:75], a[204:207], v[16:19]
  v_mfma_f32_16x16x32_bf16 v[20:23], a[76:79], a[200:203], v[20:23]
  v_mfma_f32_16x16x32_bf16 v[24:27], a[76:79], a[204:207], v[24:27]
  s_waitcnt vmcnt(18)
  v_mfma_f32_16x16x32_bf16 v[12:15], a[80:83], a[208:211], v[12:15]
  v_mfma_f32_16x16x32_bf16 v[16:19], a[80:83], a[212:215], v[16:19]
  v_mfma_f32_16x16x32_bf16 v[20:23], a[84:87], a[208:211], v[20:23]
  v_mfma_f32_16x16x32_bf16 v[24:27], a[84:87], a[212:215], v[24:27]
  s_waitcnt vmcnt(16)
  v_mfma_f32_16x16x32_bf16 v[12:15], a[88:91], a[216:219], v[12:15]
  v_mfma_f32_16x16x32_bf16 v[16:19], a[88:91], a[220:223], v[16:19]
  v_mfma_f32_16x16x32_bf16 v[20:23], a[92:95], a[216:219], v[20:23]
  v_mfma_f32_16x16x32_bf16 v[24:27], a[92:95], a[220:223], v[24:27]
  s_waitcnt vmcnt(14)
  v_mfma_f32_16x16x32_bf16 v[12:15], a[96:99], a[224:227], v[12:15]
  v_mfma_f32_16x16x32_bf16 v[16:19], a[96:99], a[228:231], v[16:19]
  v_mfma_f32_16x16x32_bf16 v[20:23], a[100:103], a[224:227], v[20:23]
  v_mfma_f32_16x16x32_bf16 v[24:27], a[100:103], a[228:231], v[24:27]
  s_waitcnt vmcnt(12)
  v_mfma_f32_16x16x32_bf16 v[12:15], a[104:107], a[232:235], v[12:15]
  v_mfma_f32_16x16x32_bf16 v[16:19], a[104:107], a[236:239], v[16:19]
  v_mfma_f32_16x16x32_bf16 v[20:23], a[108:111], a[232:235], v[20:23]
  v_mfma_f32_16x16x32_bf16 v[24:27], a[108:111], a[236:239], v[24:27]
  s_waitcnt vmcnt(10)
  v_mfma_f32_16x16x32_bf16 v[12:15], a[112:115], a[240:243], v[12:15]
  v_mfma_f32_16x16x32_bf16 v[16:19], a[112:115], a[244:247], v[16:19]
  v_mfma_f32_16x16x32_bf16 v[20:23], a[116:119], a[240:243], v[20:23]
  v_mfma_f32_16x16x32_bf16 v[24:27], a[116:119], a[244:247], v[24:27]
  s_waitcnt vmcnt(8)
  v_mfma_f32_16x16x32_bf16 v[12:15], a[120:123], a[248:251], v[12:15]
  v_mfma_f32_16x16x32_bf16 v[16:19], a[120:123], a[252:255], v[16:19]
  v_mfma_f32_16x16x32_bf16 v[20:23], a[124:127], a[248:251], v[20:23]
  v_mfma_f32_16x16x32_bf16 v[24:27], a[124:127], a[252:255], v[24:27]
  s_waitcnt vmcnt(0)
  v_mfma_f32_16x16x32_bf16 v[12:15], v[28:31], v[64:67], v[12:15]
  v_mfma_f32_16x16x32_bf16 v[16:19], v[28:31], v[68:71], v[16:19]
  v_mfma_f32_16x16x32_bf16 v[20:23], v[32:35], v[64:67], v[20:23]
  v_mfma_f32_16x16x32_bf16 v[24:27], v[32:35], v[68:71], v[24:27]
  v_mfma_f32_16x16x32_bf16 v[12:15], v[36:39], v[72:75], v[12:15]
  v_mfma_f32_16x16x32_bf16 v[16:19], v[36:39], v[76:79], v[16:19]
  v_mfma_f32_16x16x32_bf16 v[20:23], v[40:43], v[72:75], v[20:23]
  v_mfma_f32_16x16x32_bf16 v[24:27], v[40:43], v[76:79], v[24:27]
  v_mfma_f32_16x16x32_bf16 v[12:15], v[44:47], v[80:83], v[12:15]
  v_mfma_f32_16x16x32_bf16 v[16:19], v[44:47], v[84:87], v[16:19]
  v_mfma_f32_16x16x32_bf16 v[20:23], v[48:51], v[80:83], v[20:23]
  v_mfma_f32_16x16x32_bf16 v[24:27], v[48:51], v[84:87], v[24:27]
  v_mfma_f32_16x16x32_bf16 v[12:15], v[52:55], v[88:91], v[12:15]
  v_mfma_f32_16x16x32_bf16 v[16:19], v[52:55], v[92:95], v[16:19]
  v_mfma_f32_16x16x32_bf16 v[20:23], v[56:59], v[88:91], v[20:23]
  v_mfma_f32_16x16x32_bf16 v[24:27], v[56:59], v[92:95], v[24:27]
  v_mul_u32_u24 v8, 1792, v4
  v_lshl_add_u32 v8, v3, 3, v8
  s_mul_i32 s26, s17, 57344
  s_mul_i32 s22, s20, 56
  s_add_u32 s26, s26, s22
  s_add_u32 s26, s26, 896
  s_add_u32 s27, s26, 28672
  v_cvt_pk_bf16_f32 v96, v12, v13
  v_cvt_pk_bf16_f32 v97, v14, v15
  v_cvt_pk_bf16_f32 v98, v16, v17
  v_cvt_pk_bf16_f32 v99, v18, v19
  buffer_store_dwordx2 v[96:97], v8, s[92:95], s26 offen offset:0
  buffer_store_dwordx2 v[98:99], v8, s[92:95], s27 offen offset:0
  v_cvt_pk_bf16_f32 v100, v20, v21
  v_cvt_pk_bf16_f32 v101, v22, v23
  v_cvt_pk_bf16_f32 v102, v24, v25
  v_cvt_pk_bf16_f32 v103, v26, v27
  s_mov_b32 exec_hi, 0xffff
  buffer_store_dwordx2 v[100:101], v8, s[92:95], s26 offen offset:32
  buffer_store_dwordx2 v[102:103], v8, s[92:95], s27 offen offset:32
  s_mov_b64 exec, -1
  s_branch wk_loop
wp_abort:
wo_abort:
  s_branch cA_abort
ch_end:
  s_endpgm

.section .rodata,"a"
.p2align 6
.amdhsa_kernel main_kernel
  .amdhsa_next_free_vgpr 512
  .amdhsa_next_free_sgpr 102
  .amdhsa_accum_offset 256
  .amdhsa_group_segment_fixed_size 0
  .amdhsa_kernarg_size 136
  .amdhsa_user_sgpr_count 2
  .amdhsa_user_sgpr_kernarg_segment_ptr 1
  .amdhsa_system_sgpr_workgroup_id_x 1
.end_amdhsa_kernel
```

```asm
; @launch kernel=main_kernel grid=(256,1,1) block=(256,1,1) lds=163840
.amdgcn_target "amdgcn-amd-amdhsa--gfx950"
.text
.globl main_kernel
.p2align 8
.type main_kernel,@function
main_kernel:
  s_cmp_ge_u32 s2, 256
  s_cbranch_scc1 ch_end
  s_load_dwordx4 s[4:7], s[0:1], 120
  s_load_dwordx2 s[92:93], s[0:1], 112
  s_load_dwordx8 s[36:43], s[0:1], 56
  s_load_dwordx4 s[44:47], s[0:1], 88
  s_memrealtime s[88:89]
  s_getpc_b64 s[98:99]
pf_main_kernel_1:
  s_sub_u32 s98, s98, pf_main_kernel_1-main_kernel
  s_subb_u32 s99, s99, 0
  s_lshr_b32 s20, s2, 3
  v_lshl_add_u32 v60, v0, 5, s20
  v_lshlrev_b32 v60, 7, v60
  v_min_u32 v60, ch_end-main_kernel-4, v60
  v_cmp_gt_u32 vcc, 32, v0
  s_and_saveexec_b64 s[22:23], vcc
  s_cbranch_execz pf_main_kernel_1_n
  global_load_dword v62, v60, s[98:99]
pf_main_kernel_1_n:
  s_mov_b64 exec, -1
  s_getreg_b32 s67, hwreg(HW_REG_XCC_ID)
  s_and_b32 s67, s67, 7
  v_lshrrev_b32 v1, 6, v0
  s_nop 0
  v_readfirstlane_b32 s16, v1
  s_mov_b32 s66, 0
  s_mov_b32 s68, 0
  s_mov_b32 s69, 0
  s_mov_b32 s96, 0
  s_mov_b32 s97, 0
  s_mov_b32 s101, 0x5eed0000
  s_sub_u32 s20, s67, 0
  s_lshr_b32 s21, s2, 3
  s_and_b32 s20, s20, 7
  s_lshl_b32 s3, s20, 5
  s_add_u32 s3, s3, s21
  s_waitcnt lgkmcnt(0)
  s_mov_b32 s8, s6
  s_and_b32 s9, s7, 0xffff
  s_mov_b32 s10, 0x10000000
  s_mov_b32 s11, 0x20000
  s_mov_b32 s12, s4
  s_and_b32 s13, s5, 0xffff
  s_mov_b32 s14, 256
  s_mov_b32 s15, 0x20000
  s_or_b32 s88, s88, 1
  s_and_b32 s93, s93, 0xffff
  s_mov_b32 s94, 3670016
  s_mov_b32 s95, 0x20000
m_start:
  s_cmp_ge_u32 s3, 32
  s_cbranch_scc1 m_bjob
  v_and_b32 v1, 63, v0
  v_lshlrev_b32 v2, 4, v1
  v_lshrrev_b32 v116, 4, v1
  v_and_b32 v117, 15, v1
  v_mov_b32 v3, 0x4444
  v_mov_b32 v118, 0xeeee
  v_cmp_lt_u32 vcc, 7, v117
  s_nop 1
  v_cndmask_b32 v3, v3, v118, vcc
  s_and_b32 s17, s3, 15
  s_cmp_ge_u32 s3, 16
  s_cbranch_scc1 m_val
  s_mov_b32 s60, s42
  s_and_b32 s61, s43, 0xffff
  s_mov_b32 s62, 3670016
  s_mov_b32 s63, 0x20000
  v_lshrrev_b32 v24, 5, v1
  v_and_b32 v25, 31, v1
  s_lshl_b32 s26, s17, 9
  s_lshl_b32 s25, s16, 12
  v_xor_b32 v26, v25, v24
  v_lshlrev_b32 v26, 4, v26
  v_lshl_add_u32 v26, v24, 13, v26
  v_xor_b32 v100, 0, v26
  v_xor_b32 v101, 0, v26
  v_add_u32 v101, 15360, v101
  v_xor_b32 v102, 32, v26
  v_add_u32 v102, 30720, v102
  v_xor_b32 v103, 32, v26
  v_add_u32 v103, 46080, v103
  s_lshl_b32 s23, s16, 19
  s_add_u32 s23, s23, s26
  s_add_u32 m0, s25, 16384
  s_nop 0
  buffer_load_dwordx4 v100, s[60:63], s23 offen offset:0 lds
  buffer_load_dwordx4 v101, s[60:63], s23 offen offset:1024 lds
  buffer_load_dwordx4 v102, s[60:63], s23 offen offset:2048 lds
  buffer_load_dwordx4 v103, s[60:63], s23 offen offset:3072 lds
  s_add_u32 m0, s25, 32768
  s_add_u32 s23, s23, 65536
  buffer_load_dwordx4 v100, s[60:63], s23 offen offset:0 lds
  buffer_load_dwordx4 v101, s[60:63], s23 offen offset:1024 lds
  buffer_load_dwordx4 v102, s[60:63], s23 offen offset:2048 lds
  buffer_load_dwordx4 v103, s[60:63], s23 offen offset:3072 lds
  v_xor_b32 v100, 64, v100
  v_xor_b32 v101, 64, v101
  v_xor_b32 v102, 64, v102
  v_xor_b32 v103, 64, v103
  s_add_u32 m0, s25, 49152
  s_add_u32 s23, s23, 65536
  buffer_load_dwordx4 v100, s[60:63], s23 offen offset:0 lds
  buffer_load_dwordx4 v101, s[60:63], s23 offen offset:1024 lds
  buffer_load_dwordx4 v102, s[60:63], s23 offen offset:2048 lds
  buffer_load_dwordx4 v103, s[60:63], s23 offen offset:3072 lds
  s_add_u32 m0, s25, 65536
  s_add_u32 s23, s23, 65536
  buffer_load_dwordx4 v100, s[60:63], s23 offen offset:0 lds
  buffer_load_dwordx4 v101, s[60:63], s23 offen offset:1024 lds
  buffer_load_dwordx4 v102, s[60:63], s23 offen offset:2048 lds
  buffer_load_dwordx4 v103, s[60:63], s23 offen offset:3072 lds
  v_xor_b32 v100, 192, v100
  v_xor_b32 v101, 192, v101
  v_xor_b32 v102, 192, v102
  v_xor_b32 v103, 192, v103
  s_add_u32 m0, s25, 81920
  s_add_u32 s23, s23, 65536
  buffer_load_dwordx4 v100, s[60:63], s23 offen offset:0 lds
  buffer_load_dwordx4 v101, s[60:63], s23 offen offset:1024 lds
  buffer_load_dwordx4 v102, s[60:63], s23 offen offset:2048 lds
  buffer_load_dwordx4 v103, s[60:63], s23 offen offset:3072 lds
  s_add_u32 m0, s25, 98304
  s_add_u32 s23, s23, 65536
  buffer_load_dwordx4 v100, s[60:63], s23 offen offset:0 lds
  buffer_load_dwordx4 v101, s[60:63], s23 offen offset:1024 lds
  buffer_load_dwordx4 v102, s[60:63], s23 offen offset:2048 lds
  buffer_load_dwordx4 v103, s[60:63], s23 offen offset:3072 lds
  v_xor_b32 v100, 64, v100
  v_xor_b32 v101, 64, v101
  v_xor_b32 v102, 64, v102
  v_xor_b32 v103, 64, v103
  s_add_u32 m0, s25, 114688
  s_add_u32 s23, s23, 65536
  buffer_load_dwordx4 v100, s[60:63], s23 offen offset:0 lds
  buffer_load_dwordx4 v101, s[60:63], s23 offen offset:1024 lds
  buffer_load_dwordx4 v102, s[60:63], s23 offen offset:2048 lds
  buffer_load_dwordx4 v103, s[60:63], s23 offen offset:3072 lds
  s_add_u32 m0, s25, 131072
  s_add_u32 s23, s23, 65536
  buffer_load_dwordx4 v100, s[60:63], s23 offen offset:0 lds
  buffer_load_dwordx4 v101, s[60:63], s23 offen offset:1024 lds
  buffer_load_dwordx4 v102, s[60:63], s23 offen offset:2048 lds
  buffer_load_dwordx4 v103, s[60:63], s23 offen offset:3072 lds
  s_mov_b32 s56, s40
  s_and_b32 s57, s41, 0xffff
  s_mov_b32 s58, 3670016
  s_mov_b32 s59, 0x20000
  s_lshl_b32 s21, s16, 16
  s_add_u32 s27, s26, s21
  s_lshr_b32 s20, s16, 1
  s_lshl_b32 s20, s20, 6
  v_xor_b32 v26, s20, v26
  v_xor_b32 v4, 0, v26
  v_xor_b32 v5, 32, v26
  v_add_u32 v5, 15360, v5
  v_xor_b32 v6, 128, v26
  v_add_u32 v6, 30720, v6
  v_xor_b32 v7, 160, v26
  v_add_u32 v7, 46080, v7
  s_add_u32 s22, s27, 0
  s_add_u32 m0, s25, 0
  s_nop 0
  buffer_load_dwordx4 v4, s[56:59], s22 offen offset:0 lds
  buffer_load_dwordx4 v5, s[56:59], s22 offen offset:1024 lds
  buffer_load_dwordx4 v6, s[56:59], s22 offen offset:2048 lds
  buffer_load_dwordx4 v7, s[56:59], s22 offen offset:3072 lds
  s_cmp_lg_u32 s66, 0
  s_cbranch_scc1 sc_ci
  s_cmp_lg_u32 s16, 0
  s_cbranch_scc1 w0_2
  s_lshr_b32 s70, s3, 5
  s_and_b32 s71, s70, 4
  s_mul_i32 s71, s71, 12
  s_lshl_b32 s70, s70, 2
  s_add_u32 s70, s70, s71
  s_lshl_b32 s71, 1, s3
  v_mov_b32 v248, s71
  v_mov_b32 v249, 32
  s_mov_b64 exec, 1
  buffer_atomic_or v248, v249, s[12:15], s70 offen sc0
  buffer_load_dwordx2 v[250:251], v249, s[12:15], 0 offen offset:96 sc1
  s_mov_b64 exec, -1
w0_2:
sc_ci:
  v_and_b32 v26, 15, v25
  v_xor_b32 v27, v26, v24
  v_lshlrev_b32 v27, 4, v27
  v_bfe_u32 v28, v25, 2, 1
  v_lshlrev_b32 v28, 4, v28
  v_lshrrev_b32 v29, 3, v25
  v_lshl_add_u32 v28, v29, 2, v28
  v_and_b32 v29, 3, v25
  v_add_u32 v28, v28, v29
  v_lshl_add_u32 v28, v28, 9, v27
  v_lshrrev_b32 v29, 2, v26
  v_lshlrev_b32 v29, 15, v29
  v_bfe_u32 v30, v26, 1, 1
  v_lshl_add_u32 v29, v30, 11, v29
  v_lshrrev_b32 v30, 4, v25
  v_lshl_add_u32 v29, v30, 10, v29
  v_and_b32 v31, 1, v26
  v_lshl_add_u32 v29, v31, 9, v29
  v_add_u32 v29, v29, v27
  v_add_u32 v29, s25, v29
  v_xor_b32 v8, 0, v28
  v_xor_b32 v104, 0, v29
  v_xor_b32 v9, 32, v28
  v_xor_b32 v105, 32, v29
  v_xor_b32 v10, 64, v28
  v_xor_b32 v106, 64, v29
  v_xor_b32 v11, 96, v28
  v_xor_b32 v107, 96, v29
  v_xor_b32 v12, 128, v28
  v_xor_b32 v108, 128, v29
  v_xor_b32 v13, 160, v28
  v_xor_b32 v109, 160, v29
  v_xor_b32 v14, 192, v28
  v_xor_b32 v110, 192, v29
  v_xor_b32 v15, 224, v28
  v_xor_b32 v111, 224, v29
  s_mov_b32 s52, 1035512379
  s_waitcnt vmcnt(4)
  ds_read_b128 v[120:123], v104 offset:16384
  ds_read_b128 v[124:127], v105 offset:16384
  ds_read_b128 v[128:131], v106 offset:16384
  ds_read_b128 v[132:135], v107 offset:16384
  ds_read_b128 v[136:139], v108 offset:16384
  ds_read_b128 v[140:143], v109 offset:16384
  ds_read_b128 v[144:147], v110 offset:16384
  ds_read_b128 v[148:151], v111 offset:16384
  s_waitcnt lgkmcnt(4)
  ds_read_b128 v[152:155], v104 offset:16640
  ds_read_b128 v[156:159], v105 offset:16640
  ds_read_b128 v[160:163], v106 offset:16640
  ds_read_b128 v[164:167], v107 offset:16640
  ds_read_b128 v[168:171], v108 offset:16640
  ds_read_b128 v[172:175], v109 offset:16640
  ds_read_b128 v[176:179], v110 offset:16640
  ds_read_b128 v[180:183], v111 offset:16640
  s_waitcnt lgkmcnt(4)
  ds_read_b128 v[184:187], v104 offset:32768
  ds_read_b128 v[188:191], v105 offset:32768
  ds_read_b128 v[192:195], v106 offset:32768
  ds_read_b128 v[196:199], v107 offset:32768
  ds_read_b128 v[200:203], v108 offset:32768
  ds_read_b128 v[204:207], v109 offset:32768
  ds_read_b128 v[208:211], v110 offset:32768
  ds_read_b128 v[212:215], v111 offset:32768
  s_waitcnt lgkmcnt(4)
  ds_read_b128 v[216:219], v104 offset:33024
  ds_read_b128 v[220:223], v105 offset:33024
  ds_read_b128 v[224:227], v106 offset:33024
  ds_read_b128 v[228:231], v107 offset:33024
  ds_read_b128 v[232:235], v108 offset:33024
  ds_read_b128 v[236:239], v109 offset:33024
  ds_read_b128 v[240:243], v110 offset:33024
  ds_read_b128 v[244:247], v111 offset:33024
  s_waitcnt lgkmcnt(4)
  s_waitcnt lgkmcnt(0)
  s_add_u32 s22, s27, 262144
  s_add_u32 m0, s25, 16384
  s_nop 0
  buffer_load_dwordx4 v4, s[56:59], s22 offen offset:0 lds
  buffer_load_dwordx4 v5, s[56:59], s22 offen offset:1024 lds
  buffer_load_dwordx4 v6, s[56:59], s22 offen offset:2048 lds
  buffer_load_dwordx4 v7, s[56:59], s22 offen offset:3072 lds
  s_add_u32 s22, s27, 524288
  s_add_u32 m0, s25, 32768
  s_nop 0
  buffer_load_dwordx4 v4, s[56:59], s22 offen offset:0 lds
  buffer_load_dwordx4 v5, s[56:59], s22 offen offset:1024 lds
  buffer_load_dwordx4 v6, s[56:59], s22 offen offset:2048 lds
  buffer_load_dwordx4 v7, s[56:59], s22 offen offset:3072 lds
  s_add_u32 s22, s27, 786432
  s_add_u32 m0, s25, 49152
  s_nop 0
  buffer_load_dwordx4 v4, s[56:59], s22 offen offset:0 lds
  buffer_load_dwordx4 v5, s[56:59], s22 offen offset:1024 lds
  buffer_load_dwordx4 v6, s[56:59], s22 offen offset:2048 lds
  buffer_load_dwordx4 v7, s[56:59], s22 offen offset:3072 lds
  s_cmp_lg_u32 s66, 0
  s_cbranch_scc1 sc_cf
  s_cmp_lg_u32 s16, 0
  s_cbranch_scc1 w0_3
  s_waitcnt vmcnt(12)
  v_readfirstlane_b32 s70, v250
  s_cmp_lg_u32 s70, 0
  s_cbranch_scc1 sc_nz
  v_mov_b32 v249, 128
  v_mov_b32 v250, s88
  v_mov_b32 v251, s89
  v_mov_b32 v252, 0
  v_mov_b32 v253, 0
  s_mov_b64 exec, 1
  buffer_atomic_cmpswap_x2 v[250:253], v249, s[12:15], 0 offen sc0
  s_mov_b64 exec, -1
  s_waitcnt vmcnt(0)
  v_readfirstlane_b32 s70, v250
  s_cmp_lg_u32 s70, 0
  s_cbranch_scc1 sc_nz
  v_mov_b32 v250, s88
  v_mov_b32 v251, s89
sc_nz:
w0_3:
  v_mov_b32 v249, 160000
  s_add_u32 s101, s101, 1
  s_barrier
  s_mov_b64 exec, 1
  s_cmp_lg_u32 s16, 0
  s_cbranch_scc1 w0_4
  ds_write_b32 v249, v248 offset:0
  ds_write_b32 v249, v250 offset:4
  ds_write_b32 v249, v251 offset:8
  s_waitcnt lgkmcnt(0)
  v_mov_b32 v248, s101
  ds_write_b32 v249, v248 offset:16
  s_waitcnt lgkmcnt(0)
w0_4:
  s_mov_b64 exec, -1
  s_barrier
  ds_read_b32 v248, v249 offset:0
  ds_read_b32 v250, v249 offset:4
  ds_read_b32 v251, v249 offset:8
  ds_read_b32 v249, v249 offset:16
  s_waitcnt lgkmcnt(0)
  v_readfirstlane_b32 s70, v248
  v_readfirstlane_b32 s88, v250
  v_readfirstlane_b32 s89, v251
  v_cmp_ne_u32 vcc, s101, v249
  s_cbranch_vccnz ch_end
  s_mov_b32 s66, 1
  s_bitcmp1_b32 s70, s3
  s_cbranch_scc1 m_reclaim
sc_cf:
  s_cmp_lg_u32 s16, 0
  s_cbranch_scc1 w0_5
  s_cmp_eq_u32 s67, 0
  s_cselect_b32 s20, 1, 0x10001
  v_mov_b32 v248, s20
  v_mov_b32 v249, 0
  s_mov_b64 exec, 1
  buffer_atomic_add v248, v249, s[12:15], 0 offen
  s_mov_b64 exec, -1
w0_5:
  s_lshl_b32 s28, s17, 7
  s_add_u32 s28, s28, 88621120
  v_min_u32 v113, 32, v2
  s_mov_b32 s29, 88590336
  v_add_u32 v112, 1024, v2
  v_min_u32 v112, 1776, v112
  s_waitcnt vmcnt(8)
  s_barrier
  ds_read_b128 v[16:19], v8 offset:0
  ds_read_b128 v[20:23], v9 offset:0
  ds_read_b128 v[24:27], v10 offset:0
  ds_read_b128 v[28:31], v11 offset:0
  s_waitcnt lgkmcnt(3)
  v_mfma_f32_32x32x16_bf16 v[32:47], v[16:19], v[120:123], 0
  s_add_u32 s22, s27, 1048576
  s_add_u32 m0, s25, 65536
  s_nop 0
  buffer_load_dwordx4 v4, s[56:59], s22 offen offset:0 lds
  v_mfma_f32_32x32x16_bf16 v[48:63], v[16:19], v[184:187], 0
  ds_read_b128 v[16:19], v12 offset:0
  s_waitcnt lgkmcnt(3)
  v_mfma_f32_32x32x16_bf16 v[32:47], v[20:23], v[124:127], v[32:47]
  buffer_load_dwordx4 v5, s[56:59], s22 offen offset:1024 lds
  v_mfma_f32_32x32x16_bf16 v[48:63], v[20:23], v[188:191], v[48:63]
  ds_read_b128 v[20:23], v13 offset:0
  s_waitcnt lgkmcnt(3)
  v_mfma_f32_32x32x16_bf16 v[32:47], v[24:27], v[128:131], v[32:47]
  buffer_load_dwordx4 v6, s[56:59], s22 offen offset:2048 lds
  v_mfma_f32_32x32x16_bf16 v[48:63], v[24:27], v[192:195], v[48:63]
  ds_read_b128 v[24:27], v14 offset:0
  s_waitcnt lgkmcnt(3)
  v_mfma_f32_32x32x16_bf16 v[32:47], v[28:31], v[132:135], v[32:47]
  buffer_load_dwordx4 v7, s[56:59], s22 offen offset:3072 lds
  v_mfma_f32_32x32x16_bf16 v[48:63], v[28:31], v[196:199], v[48:63]
  ds_read_b128 v[28:31], v15 offset:0
  s_waitcnt lgkmcnt(3)
  v_mfma_f32_32x32x16_bf16 v[32:47], v[16:19], v[136:139], v[32:47]
  s_add_u32 s22, s27, 1310720
  s_add_u32 m0, s25, 81920
  s_nop 0
  buffer_load_dwordx4 v4, s[56:59], s22 offen offset:0 lds
  v_mfma_f32_32x32x16_bf16 v[48:63], v[16:19], v[200:203], v[48:63]
  ds_read_b128 v[16:19], v8 offset:256
  s_waitcnt lgkmcnt(3)
  v_mfma_f32_32x32x16_bf16 v[32:47], v[20:23], v[140:143], v[32:47]
  buffer_load_dwordx4 v5, s[56:59], s22 offen offset:1024 lds
  v_mfma_f32_32x32x16_bf16 v[48:63], v[20:23], v[204:207], v[48:63]
  ds_read_b128 v[20:23], v9 offset:256
  s_waitcnt lgkmcnt(3)
  v_mfma_f32_32x32x16_bf16 v[32:47], v[24:27], v[144:147], v[32:47]
  buffer_load_dwordx4 v6, s[56:59], s22 offen offset:2048 lds
  v_mfma_f32_32x32x16_bf16 v[48:63], v[24:27], v[208:211], v[48:63]
  ds_read_b128 v[24:27], v10 offset:256
  s_waitcnt lgkmcnt(3)
  v_mfma_f32_32x32x16_bf16 v[32:47], v[28:31], v[148:151], v[32:47]
  buffer_load_dwordx4 v7, s[56:59], s22 offen offset:3072 lds
  v_mfma_f32_32x32x16_bf16 v[48:63], v[28:31], v[212:215], v[48:63]
  ds_read_b128 v[28:31], v11 offset:256
  s_waitcnt lgkmcnt(3)
  v_mfma_f32_32x32x16_bf16 v[32:47], v[16:19], v[152:155], v[32:47]
  s_add_u32 s22, s27, 1572864
  s_add_u32 m0, s25, 98304
  s_nop 0
  buffer_load_dwordx4 v4, s[56:59], s22 offen offset:0 lds
  v_mfma_f32_32x32x16_bf16 v[48:63], v[16:19], v[216:219], v[48:63]
  ds_read_b128 v[16:19], v12 offset:256
  s_waitcnt lgkmcnt(3)
  v_mfma_f32_32x32x16_bf16 v[32:47], v[20:23], v[156:159], v[32:47]
  buffer_load_dwordx4 v5, s[56:59], s22 offen offset:1024 lds
  v_mfma_f32_32x32x16_bf16 v[48:63], v[20:23], v[220:223], v[48:63]
  ds_read_b128 v[20:23], v13 offset:256
  s_waitcnt lgkmcnt(3)
  v_mfma_f32_32x32x16_bf16 v[32:47], v[24:27], v[160:163], v[32:47]
  buffer_load_dwordx4 v6, s[56:59], s22 offen offset:2048 lds
  v_mfma_f32_32x32x16_bf16 v[48:63], v[24:27], v[224:227], v[48:63]
  ds_read_b128 v[24:27], v14 offset:256
  s_waitcnt lgkmcnt(3)
  v_mfma_f32_32x32x16_bf16 v[32:47], v[28:31], v[164:167], v[32:47]
  buffer_load_dwordx4 v7, s[56:59], s22 offen offset:3072 lds
  v_mfma_f32_32x32x16_bf16 v[48:63], v[28:31], v[228:231], v[48:63]
  ds_read_b128 v[28:31], v15 offset:256
  s_waitcnt lgkmcnt(3)
  v_mfma_f32_32x32x16_bf16 v[32:47], v[16:19], v[168:171], v[32:47]
  s_add_u32 s22, s27, 1835008
  s_add_u32 m0, s25, 114688
  s_nop 0
  buffer_load_dwordx4 v4, s[56:59], s22 offen offset:0 lds
  v_mfma_f32_32x32x16_bf16 v[48:63], v[16:19], v[232:235], v[48:63]
  ds_read_b128 v[16:19], v8 offset:16384
  s_waitcnt lgkmcnt(3)
  v_mfma_f32_32x32x16_bf16 v[32:47], v[20:23], v[172:175], v[32:47]
  buffer_load_dwordx4 v5, s[56:59], s22 offen offset:1024 lds
  v_mfma_f32_32x32x16_bf16 v[48:63], v[20:23], v[236:239], v[48:63]
  ds_read_b128 v[20:23], v9 offset:16384
  s_waitcnt lgkmcnt(3)
  v_mfma_f32_32x32x16_bf16 v[32:47], v[24:27], v[176:179], v[32:47]
  buffer_load_dwordx4 v6, s[56:59], s22 offen offset:2048 lds
  v_mfma_f32_32x32x16_bf16 v[48:63], v[24:27], v[240:243], v[48:63]
  ds_read_b128 v[24:27], v10 offset:16384
  s_waitcnt lgkmcnt(3)
  v_mfma_f32_32x32x16_bf16 v[32:47], v[28:31], v[180:183], v[32:47]
  buffer_load_dwordx4 v7, s[56:59], s22 offen offset:3072 lds
  v_mfma_f32_32x32x16_bf16 v[48:63], v[28:31], v[244:247], v[48:63]
  s_waitcnt vmcnt(16)
  s_barrier
  ds_read_b128 v[28:31], v11 offset:16384
  s_waitcnt lgkmcnt(3)
  v_mfma_f32_32x32x16_bf16 v[64:79], v[16:19], v[120:123], 0
  s_add_u32 s22, s27, 2097152
  s_add_u32 m0, s25, 131072
  s_nop 0
  buffer_load_dwordx4 v4, s[56:59], s22 offen offset:0 lds
  v_mfma_f32_32x32x16_bf16 v[80:95], v[16:19], v[184:187], 0
  ds_read_b128 v[16:19], v12 offset:16384
  s_waitcnt lgkmcnt(3)
  v_mfma_f32_32x32x16_bf16 v[64:79], v[20:23], v[124:127], v[64:79]
  buffer_load_dwordx4 v5, s[56:59], s22 offen offset:1024 lds
  v_mul_f32 v32, s52, v32
  v_mul_f32 v33, s52, v33
  v_cvt_pk_bf16_f32 v32, v32, v33
  v_mfma_f32_32x32x16_bf16 v[80:95], v[20:23], v[188:191], v[80:95]
  v_mul_f32 v34, s52, v34
  v_mul_f32 v35, s52, v35
  ds_read_b128 v[20:23], v13 offset:16384
  s_waitcnt lgkmcnt(3)
  v_mfma_f32_32x32x16_bf16 v[64:79], v[24:27], v[128:131], v[64:79]
  buffer_load_dwordx4 v6, s[56:59], s22 offen offset:2048 lds
  v_cvt_pk_bf16_f32 v33, v34, v35
  v_mul_f32 v36, s52, v36
  v_mul_f32 v37, s52, v37
  v_mfma_f32_32x32x16_bf16 v[80:95], v[24:27], v[192:195], v[80:95]
  v_cvt_pk_bf16_f32 v34, v36, v37
  v_mul_f32 v38, s52, v38
  ds_read_b128 v[24:27], v14 offset:16384
  s_waitcnt lgkmcnt(3)
  v_mfma_f32_32x32x16_bf16 v[64:79], v[28:31], v[132:135], v[64:79]
  buffer_load_dwordx4 v7, s[56:59], s22 offen offset:3072 lds
  v_mul_f32 v39, s52, v39
  v_cvt_pk_bf16_f32 v35, v38, v39
  v_mul_f32 v40, s52, v40
  v_mfma_f32_32x32x16_bf16 v[80:95], v[28:31], v[196:199], v[80:95]
  v_mul_f32 v41, s52, v41
  v_cvt_pk_bf16_f32 v40, v40, v41
  ds_read_b128 v[28:31], v15 offset:16384
  s_waitcnt lgkmcnt(3)
  v_mfma_f32_32x32x16_bf16 v[64:79], v[16:19], v[136:139], v[64:79]
  s_add_u32 s22, s27, 2359296
  s_add_u32 m0, s25, 0
  s_nop 0
  buffer_load_dwordx4 v4, s[56:59], s22 offen offset:0 lds
  v_mul_f32 v42, s52, v42
  v_mul_f32 v43, s52, v43
  v_cvt_pk_bf16_f32 v41, v42, v43
  v_mfma_f32_32x32x16_bf16 v[80:95], v[16:19], v[200:203], v[80:95]
  v_mul_f32 v44, s52, v44
  v_mul_f32 v45, s52, v45
  ds_read_b128 v[16:19], v8 offset:16640
  s_waitcnt lgkmcnt(3)
  v_mfma_f32_32x32x16_bf16 v[64:79], v[20:23], v[140:143], v[64:79]
  buffer_load_dwordx4 v5, s[56:59], s22 offen offset:1024 lds
  v_cvt_pk_bf16_f32 v42, v44, v45
  v_mul_f32 v46, s52, v46
  v_mul_f32 v47, s52, v47
  v_mfma_f32_32x32x16_bf16 v[80:95], v[20:23], v[204:207], v[80:95]
  v_cvt_pk_bf16_f32 v43, v46, v47
  v_permlane16_swap_b32 v32, v40
  ds_read_b128 v[20:23], v9 offset:16640
  s_waitcnt lgkmcnt(3)
  v_mfma_f32_32x32x16_bf16 v[64:79], v[24:27], v[144:147], v[64:79]
  buffer_load_dwordx4 v6, s[56:59], s22 offen offset:2048 lds
  v_permlane16_swap_b32 v33, v41
  v_permlane16_swap_b32 v34, v42
  v_permlane16_swap_b32 v35, v43
  v_mfma_f32_32x32x16_bf16 v[80:95], v[24:27], v[208:211], v[80:95]
  v_accvgpr_write_b32 a0, v32
  v_accvgpr_write_b32 a1, v33
  ds_read_b128 v[24:27], v10 offset:16640
  s_waitcnt lgkmcnt(3)
  v_mfma_f32_32x32x16_bf16 v[64:79], v[28:31], v[148:151], v[64:79]
  buffer_load_dwordx4 v7, s[56:59], s22 offen offset:3072 lds
  v_accvgpr_write_b32 a2, v34
  v_accvgpr_write_b32 a3, v35
  v_accvgpr_write_b32 a56, v40
  v_mfma_f32_32x32x16_bf16 v[80:95], v[28:31], v[212:215], v[80:95]
  v_accvgpr_write_b32 a57, v41
  v_accvgpr_write_b32 a58, v42
  ds_read_b128 v[28:31], v11 offset:16640
  s_waitcnt lgkmcnt(3)
  v_mfma_f32_32x32x16_bf16 v[64:79], v[16:19], v[152:155], v[64:79]
  v_accvgpr_write_b32 a59, v43
  v_mul_f32 v48, s52, v48
  v_mul_f32 v49, s52, v49
  v_mfma_f32_32x32x16_bf16 v[80:95], v[16:19], v[216:219], v[80:95]
  v_cvt_pk_bf16_f32 v48, v48, v49
  v_mul_f32 v50, s52, v50
  ds_read_b128 v[16:19], v12 offset:16640
  s_waitcnt lgkmcnt(3)
  v_mfma_f32_32x32x16_bf16 v[64:79], v[20:23], v[156:159], v[64:79]
  v_mul_f32 v51, s52, v51
  v_cvt_pk_bf16_f32 v49, v50, v51
  v_mul_f32 v52, s52, v52
  v_mfma_f32_32x32x16_bf16 v[80:95], v[20:23], v[220:223], v[80:95]
  v_mul_f32 v53, s52, v53
  v_cvt_pk_bf16_f32 v50, v52, v53
  ds_read_b128 v[20:23], v13 offset:16640
  s_waitcnt lgkmcnt(3)
  v_mfma_f32_32x32x16_bf16 v[64:79], v[24:27], v[160:163], v[64:79]
  v_mul_f32 v54, s52, v54
  v_mul_f32 v55, s52, v55
  v_cvt_pk_bf16_f32 v51, v54, v55
  v_mfma_f32_32x32x16_bf16 v[80:95], v[24:27], v[224:227], v[80:95]
  v_mul_f32 v56, s52, v56
  v_mul_f32 v57, s52, v57
  ds_read_b128 v[24:27], v14 offset:16640
  s_waitcnt lgkmcnt(3)
  v_mfma_f32_32x32x16_bf16 v[64:79], v[28:31], v[164:167], v[64:79]
  v_cvt_pk_bf16_f32 v56, v56, v57
  v_mul_f32 v58, s52, v58
  v_mul_f32 v59, s52, v59
  v_mfma_f32_32x32x16_bf16 v[80:95], v[28:31], v[228:231], v[80:95]
  v_cvt_pk_bf16_f32 v57, v58, v59
  v_mul_f32 v60, s52, v60
  ds_read_b128 v[28:31], v15 offset:16640
  s_waitcnt lgkmcnt(3)
  v_mfma_f32_32x32x16_bf16 v[64:79], v[16:19], v[168:171], v[64:79]
  v_mul_f32 v61, s52, v61
  v_cvt_pk_bf16_f32 v58, v60, v61
  v_mul_f32 v62, s52, v62
  v_mfma_f32_32x32x16_bf16 v[80:95], v[16:19], v[232:235], v[80:95]
  v_mul_f32 v63, s52, v63
  v_cvt_pk_bf16_f32 v59, v62, v63
  ds_read_b128 v[16:19], v8 offset:32768
  s_waitcnt lgkmcnt(3)
  v_mfma_f32_32x32x16_bf16 v[64:79], v[20:23], v[172:175], v[64:79]
  v_permlane16_swap_b32 v48, v56
  v_permlane16_swap_b32 v49, v57
  v_permlane16_swap_b32 v50, v58
  v_mfma_f32_32x32x16_bf16 v[80:95], v[20:23], v[236:239], v[80:95]
  v_permlane16_swap_b32 v51, v59
  v_accvgpr_write_b32 a112, v48
  ds_read_b128 v[20:23], v9 offset:32768
  s_waitcnt lgkmcnt(3)
  v_mfma_f32_32x32x16_bf16 v[64:79], v[24:27], v[176:179], v[64:79]
  v_accvgpr_write_b32 a113, v49
  v_accvgpr_write_b32 a114, v50
  v_accvgpr_write_b32 a115, v51
  v_mfma_f32_32x32x16_bf16 v[80:95], v[24:27], v[240:243], v[80:95]
  v_accvgpr_write_b32 a168, v56
  v_accvgpr_write_b32 a169, v57
  ds_read_b128 v[24:27], v10 offset:32768
  s_waitcnt lgkmcnt(3)
  v_mfma_f32_32x32x16_bf16 v[64:79], v[28:31], v[180:183], v[64:79]
  v_accvgpr_write_b32 a170, v58
  v_accvgpr_write_b32 a171, v59
  v_mfma_f32_32x32x16_bf16 v[80:95], v[28:31], v[244:247], v[80:95]
  ds_read_b128 v[28:31], v11 offset:32768
  s_waitcnt lgkmcnt(3)
  v_mfma_f32_32x32x16_bf16 v[32:47], v[16:19], v[120:123], 0
  v_mfma_f32_32x32x16_bf16 v[48:63], v[16:19], v[184:187], 0
  ds_read_b128 v[16:19], v12 offset:32768
  s_waitcnt lgkmcnt(3)
  v_mfma_f32_32x32x16_bf16 v[32:47], v[20:23], v[124:127], v[32:47]
  v_mul_f32 v64, s52, v64
  v_mul_f32 v65, s52, v65
  v_cvt_pk_bf16_f32 v64, v64, v65
  v_mfma_f32_32x32x16_bf16 v[48:63], v[20:23], v[188:191], v[48:63]
  v_mul_f32 v66, s52, v66
  v_mul_f32 v67, s52, v67
  ds_read_b128 v[20:23], v13 offset:32768
  s_waitcnt lgkmcnt(3)
  v_mfma_f32_32x32x16_bf16 v[32:47], v[24:27], v[128:131], v[32:47]
  v_cvt_pk_bf16_f32 v65, v66, v67
  v_mul_f32 v68, s52, v68
  v_mul_f32 v69, s52, v69
  v_mfma_f32_32x32x16_bf16 v[48:63], v[24:27], v[192:195], v[48:63]
  v_cvt_pk_bf16_f32 v66, v68, v69
  v_mul_f32 v70, s52, v70
  ds_read_b128 v[24:27], v14 offset:32768
  s_waitcnt lgkmcnt(3)
  v_mfma_f32_32x32x16_bf16 v[32:47], v[28:31], v[132:135], v[32:47]
  v_mul_f32 v71, s52, v71
  v_cvt_pk_bf16_f32 v67, v70, v71
  v_mul_f32 v72, s52, v72
  v_mfma_f32_32x32x16_bf16 v[48:63], v[28:31], v[196:199], v[48:63]
  v_mul_f32 v73, s52, v73
  v_cvt_pk_bf16_f32 v72, v72, v73
  ds_read_b128 v[28:31], v15 offset:32768
  s_waitcnt lgkmcnt(3)
  v_mfma_f32_32x32x16_bf16 v[32:47], v[16:19], v[136:139], v[32:47]
  v_mul_f32 v74, s52, v74
  v_mul_f32 v75, s52, v75
  v_cvt_pk_bf16_f32 v73, v74, v75
  v_mfma_f32_32x32x16_bf16 v[48:63], v[16:19], v[200:203], v[48:63]
  v_mul_f32 v76, s52, v76
  v_mul_f32 v77, s52, v77
  ds_read_b128 v[16:19], v8 offset:33024
  s_waitcnt lgkmcnt(3)
  v_mfma_f32_32x32x16_bf16 v[32:47], v[20:23], v[140:143], v[32:47]
  v_cvt_pk_bf16_f32 v74, v76, v77
  v_mul_f32 v78, s52, v78
  v_mul_f32 v79, s52, v79
  v_mfma_f32_32x32x16_bf16 v[48:63], v[20:23], v[204:207], v[48:63]
  v_cvt_pk_bf16_f32 v75, v78, v79
  v_permlane16_swap_b32 v64, v72
  ds_read_b128 v[20:23], v9 offset:33024
  s_waitcnt lgkmcnt(3)
  v_mfma_f32_32x32x16_bf16 v[32:47], v[24:27], v[144:147], v[32:47]
  v_permlane16_swap_b32 v65, v73
  v_permlane16_swap_b32 v66, v74
  v_permlane16_swap_b32 v67, v75
  v_mfma_f32_32x32x16_bf16 v[48:63], v[24:27], v[208:211], v[48:63]
  v_accvgpr_write_b32 a4, v64
  v_accvgpr_write_b32 a5, v65
  ds_read_b128 v[24:27], v10 offset:33024
  s_waitcnt lgkmcnt(3)
  v_mfma_f32_32x32x16_bf16 v[32:47], v[28:31], v[148:151], v[32:47]
  v_accvgpr_write_b32 a6, v66
  v_accvgpr_write_b32 a7, v67
  v_accvgpr_write_b32 a60, v72
  v_mfma_f32_32x32x16_bf16 v[48:63], v[28:31], v[212:215], v[48:63]
  v_accvgpr_write_b32 a61, v73
  v_accvgpr_write_b32 a62, v74
  ds_read_b128 v[28:31], v11 offset:33024
  s_waitcnt lgkmcnt(3)
  v_mfma_f32_32x32x16_bf16 v[32:47], v[16:19], v[152:155], v[32:47]
  v_accvgpr_write_b32 a63, v75
  v_mul_f32 v80, s52, v80
  v_mul_f32 v81, s52, v81
  v_mfma_f32_32x32x16_bf16 v[48:63], v[16:19], v[216:219], v[48:63]
  v_cvt_pk_bf16_f32 v80, v80, v81
  v_mul_f32 v82, s52, v82
  ds_read_b128 v[16:19], v12 offset:33024
  s_waitcnt lgkmcnt(3)
  v_mfma_f32_32x32x16_bf16 v[32:47], v[20:23], v[156:159], v[32:47]
  v_mul_f32 v83, s52, v83
  v_cvt_pk_bf16_f32 v81, v82, v83
  v_mul_f32 v84, s52, v84
  v_mfma_f32_32x32x16_bf16 v[48:63], v[20:23], v[220:223], v[48:63]
  v_mul_f32 v85, s52, v85
  v_cvt_pk_bf16_f32 v82, v84, v85
  ds_read_b128 v[20:23], v13 offset:33024
  s_waitcnt lgkmcnt(3)
  v_mfma_f32_32x32x16_bf16 v[32:47], v[24:27], v[160:163], v[32:47]
  v_mul_f32 v86, s52, v86
  v_mul_f32 v87, s52, v87
  v_cvt_pk_bf16_f32 v83, v86, v87
  v_mfma_f32_32x32x16_bf16 v[48:63], v[24:27], v[224:227], v[48:63]
  v_mul_f32 v88, s52, v88
  v_mul_f32 v89, s52, v89
  ds_read_b128 v[24:27], v14 offset:33024
  s_waitcnt lgkmcnt(3)
  v_mfma_f32_32x32x16_bf16 v[32:47], v[28:31], v[164:167], v[32:47]
  v_cvt_pk_bf16_f32 v88, v88, v89
  v_mul_f32 v90, s52, v90
  v_mul_f32 v91, s52, v91
  v_mfma_f32_32x32x16_bf16 v[48:63], v[28:31], v[228:231], v[48:63]
  v_cvt_pk_bf16_f32 v89, v90, v91
  v_mul_f32 v92, s52, v92
  ds_read_b128 v[28:31], v15 offset:33024
  s_waitcnt lgkmcnt(3)
  v_mfma_f32_32x32x16_bf16 v[32:47], v[16:19], v[168:171], v[32:47]
  v_mul_f32 v93, s52, v93
  v_cvt_pk_bf16_f32 v90, v92, v93
  v_mul_f32 v94, s52, v94
  v_mfma_f32_32x32x16_bf16 v[48:63], v[16:19], v[232:235], v[48:63]
  v_mul_f32 v95, s52, v95
  v_cvt_pk_bf16_f32 v91, v94, v95
  ds_read_b128 v[16:19], v8 offset:49152
  s_waitcnt lgkmcnt(3)
  v_mfma_f32_32x32x16_bf16 v[32:47], v[20:23], v[172:175], v[32:47]
  v_permlane16_swap_b32 v80, v88
  v_permlane16_swap_b32 v81, v89
  v_permlane16_swap_b32 v82, v90
  v_mfma_f32_32x32x16_bf16 v[48:63], v[20:23], v[236:239], v[48:63]
  v_permlane16_swap_b32 v83, v91
  v_accvgpr_write_b32 a116, v80
  ds_read_b128 v[20:23], v9 offset:49152
  s_waitcnt lgkmcnt(3)
  v_mfma_f32_32x32x16_bf16 v[32:47], v[24:27], v[176:179], v[32:47]
  v_accvgpr_write_b32 a117, v81
  v_accvgpr_write_b32 a118, v82
  v_accvgpr_write_b32 a119, v83
  v_mfma_f32_32x32x16_bf16 v[48:63], v[24:27], v[240:243], v[48:63]
  v_accvgpr_write_b32 a172, v88
  v_accvgpr_write_b32 a173, v89
  ds_read_b128 v[24:27], v10 offset:49152
  s_waitcnt lgkmcnt(3)
  v_mfma_f32_32x32x16_bf16 v[32:47], v[28:31], v[180:183], v[32:47]
  v_accvgpr_write_b32 a174, v90
  v_accvgpr_write_b32 a175, v91
  v_mfma_f32_32x32x16_bf16 v[48:63], v[28:31], v[244:247], v[48:63]
  s_waitcnt vmcnt(16)
  s_barrier
  ds_read_b128 v[28:31], v11 offset:49152
  s_waitcnt lgkmcnt(3)
  v_mfma_f32_32x32x16_bf16 v[64:79], v[16:19], v[120:123], 0
  s_add_u32 s22, s27, 2621440
  s_add_u32 m0, s25, 16384
  s_nop 0
  buffer_load_dwordx4 v4, s[56:59], s22 offen offset:0 lds
  v_mfma_f32_32x32x16_bf16 v[80:95], v[16:19], v[184:187], 0
  ds_read_b128 v[16:19], v12 offset:49152
  s_waitcnt lgkmcnt(3)
  v_mfma_f32_32x32x16_bf16 v[64:79], v[20:23], v[124:127], v[64:79]
  buffer_load_dwordx4 v5, s[56:59], s22 offen offset:1024 lds
  v_mul_f32 v32, s52, v32
  v_mul_f32 v33, s52, v33
  v_cvt_pk_bf16_f32 v32, v32, v33
  v_mfma_f32_32x32x16_bf16 v[80:95], v[20:23], v[188:191], v[80:95]
  v_mul_f32 v34, s52, v34
  v_mul_f32 v35, s52, v35
  ds_read_b128 v[20:23], v13 offset:49152
  s_waitcnt lgkmcnt(3)
  v_mfma_f32_32x32x16_bf16 v[64:79], v[24:27], v[128:131], v[64:79]
  buffer_load_dwordx4 v6, s[56:59], s22 offen offset:2048 lds
  v_cvt_pk_bf16_f32 v33, v34, v35
  v_mul_f32 v36, s52, v36
  v_mul_f32 v37, s52, v37
  v_mfma_f32_32x32x16_bf16 v[80:95], v[24:27], v[192:195], v[80:95]
  v_cvt_pk_bf16_f32 v34, v36, v37
  v_mul_f32 v38, s52, v38
  ds_read_b128 v[24:27], v14 offset:49152
  s_waitcnt lgkmcnt(3)
  v_mfma_f32_32x32x16_bf16 v[64:79], v[28:31], v[132:135], v[64:79]
  buffer_load_dwordx4 v7, s[56:59], s22 offen offset:3072 lds
  v_mul_f32 v39, s52, v39
  v_cvt_pk_bf16_f32 v35, v38, v39
  v_mul_f32 v40, s52, v40
  v_mfma_f32_32x32x16_bf16 v[80:95], v[28:31], v[196:199], v[80:95]
  v_mul_f32 v41, s52, v41
  v_cvt_pk_bf16_f32 v40, v40, v41
  ds_read_b128 v[28:31], v15 offset:49152
  s_waitcnt lgkmcnt(3)
  v_mfma_f32_32x32x16_bf16 v[64:79], v[16:19], v[136:139], v[64:79]
  s_add_u32 s22, s27, 2883584
  s_add_u32 m0, s25, 32768
  s_nop 0
  buffer_load_dwordx4 v4, s[56:59], s22 offen offset:0 lds
  v_mul_f32 v42, s52, v42
  v_mul_f32 v43, s52, v43
  v_cvt_pk_bf16_f32 v41, v42, v43
  v_mfma_f32_32x32x16_bf16 v[80:95], v[16:19], v[200:203], v[80:95]
  v_mul_f32 v44, s52, v44
  v_mul_f32 v45, s52, v45
  ds_read_b128 v[16:19], v8 offset:49408
  s_waitcnt lgkmcnt(3)
  v_mfma_f32_32x32x16_bf16 v[64:79], v[20:23], v[140:143], v[64:79]
  buffer_load_dwordx4 v5, s[56:59], s22 offen offset:1024 lds
  v_cvt_pk_bf16_f32 v42, v44, v45
  v_mul_f32 v46, s52, v46
  v_mul_f32 v47, s52, v47
  v_mfma_f32_32x32x16_bf16 v[80:95], v[20:23], v[204:207], v[80:95]
  v_cvt_pk_bf16_f32 v43, v46, v47
  v_permlane16_swap_b32 v32, v40
  ds_read_b128 v[20:23], v9 offset:49408
  s_waitcnt lgkmcnt(3)
  v_mfma_f32_32x32x16_bf16 v[64:79], v[24:27], v[144:147], v[64:79]
  buffer_load_dwordx4 v6, s[56:59], s22 offen offset:2048 lds
  v_permlane16_swap_b32 v33, v41
  v_permlane16_swap_b32 v34, v42
  v_permlane16_swap_b32 v35, v43
  v_mfma_f32_32x32x16_bf16 v[80:95], v[24:27], v[208:211], v[80:95]
  v_accvgpr_write_b32 a8, v32
  v_accvgpr_write_b32 a9, v33
  ds_read_b128 v[24:27], v10 offset:49408
  s_waitcnt lgkmcnt(3)
  v_mfma_f32_32x32x16_bf16 v[64:79], v[28:31], v[148:151], v[64:79]
  buffer_load_dwordx4 v7, s[56:59], s22 offen offset:3072 lds
  v_accvgpr_write_b32 a10, v34
  v_accvgpr_write_b32 a11, v35
  v_accvgpr_write_b32 a64, v40
  v_mfma_f32_32x32x16_bf16 v[80:95], v[28:31], v[212:215], v[80:95]
  v_accvgpr_write_b32 a65, v41
  v_accvgpr_write_b32 a66, v42
  ds_read_b128 v[28:31], v11 offset:49408
  s_waitcnt lgkmcnt(3)
  v_mfma_f32_32x32x16_bf16 v[64:79], v[16:19], v[152:155], v[64:79]
  v_accvgpr_write_b32 a67, v43
  v_mul_f32 v48, s52, v48
  v_mul_f32 v49, s52, v49
  v_mfma_f32_32x32x16_bf16 v[80:95], v[16:19], v[216:219], v[80:95]
  v_cvt_pk_bf16_f32 v48, v48, v49
  v_mul_f32 v50, s52, v50
  ds_read_b128 v[16:19], v12 offset:49408
  s_waitcnt lgkmcnt(3)
  v_mfma_f32_32x32x16_bf16 v[64:79], v[20:23], v[156:159], v[64:79]
  v_mul_f32 v51, s52, v51
  v_cvt_pk_bf16_f32 v49, v50, v51
  v_mul_f32 v52, s52, v52
  v_mfma_f32_32x32x16_bf16 v[80:95], v[20:23], v[220:223], v[80:95]
  v_mul_f32 v53, s52, v53
  v_cvt_pk_bf16_f32 v50, v52, v53
  ds_read_b128 v[20:23], v13 offset:49408
  s_waitcnt lgkmcnt(3)
  v_mfma_f32_32x32x16_bf16 v[64:79], v[24:27], v[160:163], v[64:79]
  v_mul_f32 v54, s52, v54
  v_mul_f32 v55, s52, v55
  v_cvt_pk_bf16_f32 v51, v54, v55
  v_mfma_f32_32x32x16_bf16 v[80:95], v[24:27], v[224:227], v[80:95]
  v_mul_f32 v56, s52, v56
  v_mul_f32 v57, s52, v57
  ds_read_b128 v[24:27], v14 offset:49408
  s_waitcnt lgkmcnt(3)
  v_mfma_f32_32x32x16_bf16 v[64:79], v[28:31], v[164:167], v[64:79]
  v_cvt_pk_bf16_f32 v56, v56, v57
  v_mul_f32 v58, s52, v58
  v_mul_f32 v59, s52, v59
  v_mfma_f32_32x32x16_bf16 v[80:95], v[28:31], v[228:231], v[80:95]
  v_cvt_pk_bf16_f32 v57, v58, v59
  v_mul_f32 v60, s52, v60
  ds_read_b128 v[28:31], v15 offset:49408
  s_waitcnt lgkmcnt(3)
  v_mfma_f32_32x32x16_bf16 v[64:79], v[16:19], v[168:171], v[64:79]
  v_mul_f32 v61, s52, v61
  v_cvt_pk_bf16_f32 v58, v60, v61
  v_mul_f32 v62, s52, v62
  v_mfma_f32_32x32x16_bf16 v[80:95], v[16:19], v[232:235], v[80:95]
  v_mul_f32 v63, s52, v63
  v_cvt_pk_bf16_f32 v59, v62, v63
  v_xor_b32 v8, 65536, v8
  ds_read_b128 v[16:19], v8 offset:0
  s_waitcnt lgkmcnt(3)
  v_mfma_f32_32x32x16_bf16 v[64:79], v[20:23], v[172:175], v[64:79]
  v_permlane16_swap_b32 v48, v56
  v_permlane16_swap_b32 v49, v57
  v_permlane16_swap_b32 v50, v58
  v_mfma_f32_32x32x16_bf16 v[80:95], v[20:23], v[236:239], v[80:95]
  v_permlane16_swap_b32 v51, v59
  v_accvgpr_write_b32 a120, v48
  v_xor_b32 v9, 65536, v9
  ds_read_b128 v[20:23], v9 offset:0
  s_waitcnt lgkmcnt(3)
  v_mfma_f32_32x32x16_bf16 v[64:79], v[24:27], v[176:179], v[64:79]
  v_accvgpr_write_b32 a121, v49
  v_accvgpr_write_b32 a122, v50
  v_accvgpr_write_b32 a123, v51
  v_mfma_f32_32x32x16_bf16 v[80:95], v[24:27], v[240:243], v[80:95]
  v_accvgpr_write_b32 a176, v56
  v_accvgpr_write_b32 a177, v57
  v_xor_b32 v10, 65536, v10
  ds_read_b128 v[24:27], v10 offset:0
  s_waitcnt lgkmcnt(3)
  v_mfma_f32_32x32x16_bf16 v[64:79], v[28:31], v[180:183], v[64:79]
  v_accvgpr_write_b32 a178, v58
  v_accvgpr_write_b32 a179, v59
  v_mfma_f32_32x32x16_bf16 v[80:95], v[28:31], v[244:247], v[80:95]
  v_xor_b32 v11, 65536, v11
  ds_read_b128 v[28:31], v11 offset:0
  s_waitcnt lgkmcnt(3)
  v_mfma_f32_32x32x16_bf16 v[32:47], v[16:19], v[120:123], 0
  v_mfma_f32_32x32x16_bf16 v[48:63], v[16:19], v[184:187], 0
  v_xor_b32 v12, 65536, v12
  ds_read_b128 v[16:19], v12 offset:0
  s_waitcnt lgkmcnt(3)
  v_mfma_f32_32x32x16_bf16 v[32:47], v[20:23], v[124:127], v[32:47]
  v_mul_f32 v64, s52, v64
  v_mul_f32 v65, s52, v65
  v_cvt_pk_bf16_f32 v64, v64, v65
  v_mfma_f32_32x32x16_bf16 v[48:63], v[20:23], v[188:191], v[48:63]
  v_mul_f32 v66, s52, v66
  v_mul_f32 v67, s52, v67
  v_xor_b32 v13, 65536, v13
  ds_read_b128 v[20:23], v13 offset:0
  s_waitcnt lgkmcnt(3)
  v_mfma_f32_32x32x16_bf16 v[32:47], v[24:27], v[128:131], v[32:47]
  v_cvt_pk_bf16_f32 v65, v66, v67
  v_mul_f32 v68, s52, v68
  v_mul_f32 v69, s52, v69
  v_mfma_f32_32x32x16_bf16 v[48:63], v[24:27], v[192:195], v[48:63]
  v_cvt_pk_bf16_f32 v66, v68, v69
  v_mul_f32 v70, s52, v70
  v_xor_b32 v14, 65536, v14
  ds_read_b128 v[24:27], v14 offset:0
  s_waitcnt lgkmcnt(3)
  v_mfma_f32_32x32x16_bf16 v[32:47], v[28:31], v[132:135], v[32:47]
  v_mul_f32 v71, s52, v71
  v_cvt_pk_bf16_f32 v67, v70, v71
  v_mul_f32 v72, s52, v72
  v_mfma_f32_32x32x16_bf16 v[48:63], v[28:31], v[196:199], v[48:63]
  v_mul_f32 v73, s52, v73
  v_cvt_pk_bf16_f32 v72, v72, v73
  v_xor_b32 v15, 65536, v15
  ds_read_b128 v[28:31], v15 offset:0
  s_waitcnt lgkmcnt(3)
  v_mfma_f32_32x32x16_bf16 v[32:47], v[16:19], v[136:139], v[32:47]
  v_mul_f32 v74, s52, v74
  v_mul_f32 v75, s52, v75
  v_cvt_pk_bf16_f32 v73, v74, v75
  v_mfma_f32_32x32x16_bf16 v[48:63], v[16:19], v[200:203], v[48:63]
  v_mul_f32 v76, s52, v76
  v_mul_f32 v77, s52, v77
  ds_read_b128 v[16:19], v8 offset:256
  s_waitcnt lgkmcnt(3)
  v_mfma_f32_32x32x16_bf16 v[32:47], v[20:23], v[140:143], v[32:47]
  v_cvt_pk_bf16_f32 v74, v76, v77
  v_mul_f32 v78, s52, v78
  v_mul_f32 v79, s52, v79
  v_mfma_f32_32x32x16_bf16 v[48:63], v[20:23], v[204:207], v[48:63]
  v_cvt_pk_bf16_f32 v75, v78, v79
  v_permlane16_swap_b32 v64, v72
  ds_read_b128 v[20:23], v9 offset:256
  s_waitcnt lgkmcnt(3)
  v_mfma_f32_32x32x16_bf16 v[32:47], v[24:27], v[144:147], v[32:47]
  v_permlane16_swap_b32 v65, v73
  v_permlane16_swap_b32 v66, v74
  v_permlane16_swap_b32 v67, v75
  v_mfma_f32_32x32x16_bf16 v[48:63], v[24:27], v[208:211], v[48:63]
  v_accvgpr_write_b32 a12, v64
  v_accvgpr_write_b32 a13, v65
  ds_read_b128 v[24:27], v10 offset:256
  s_waitcnt lgkmcnt(3)
  v_mfma_f32_32x32x16_bf16 v[32:47], v[28:31], v[148:151], v[32:47]
  v_accvgpr_write_b32 a14, v66
  v_accvgpr_write_b32 a15, v67
  v_accvgpr_write_b32 a68, v72
  v_mfma_f32_32x32x16_bf16 v[48:63], v[28:31], v[212:215], v[48:63]
  v_accvgpr_write_b32 a69, v73
  v_accvgpr_write_b32 a70, v74
  ds_read_b128 v[28:31], v11 offset:256
  s_waitcnt lgkmcnt(3)
  v_mfma_f32_32x32x16_bf16 v[32:47], v[16:19], v[152:155], v[32:47]
  v_accvgpr_write_b32 a71, v75
  v_mul_f32 v80, s52, v80
  v_mul_f32 v81, s52, v81
  v_mfma_f32_32x32x16_bf16 v[48:63], v[16:19], v[216:219], v[48:63]
  v_cvt_pk_bf16_f32 v80, v80, v81
  v_mul_f32 v82, s52, v82
  ds_read_b128 v[16:19], v12 offset:256
  s_waitcnt lgkmcnt(3)
  v_mfma_f32_32x32x16_bf16 v[32:47], v[20:23], v[156:159], v[32:47]
  v_mul_f32 v83, s52, v83
  v_cvt_pk_bf16_f32 v81, v82, v83
  v_mul_f32 v84, s52, v84
  v_mfma_f32_32x32x16_bf16 v[48:63], v[20:23], v[220:223], v[48:63]
  v_mul_f32 v85, s52, v85
  v_cvt_pk_bf16_f32 v82, v84, v85
  ds_read_b128 v[20:23], v13 offset:256
  s_waitcnt lgkmcnt(3)
  v_mfma_f32_32x32x16_bf16 v[32:47], v[24:27], v[160:163], v[32:47]
  v_mul_f32 v86, s52, v86
  v_mul_f32 v87, s52, v87
  v_cvt_pk_bf16_f32 v83, v86, v87
  v_mfma_f32_32x32x16_bf16 v[48:63], v[24:27], v[224:227], v[48:63]
  v_mul_f32 v88, s52, v88
  v_mul_f32 v89, s52, v89
  ds_read_b128 v[24:27], v14 offset:256
  s_waitcnt lgkmcnt(3)
  v_mfma_f32_32x32x16_bf16 v[32:47], v[28:31], v[164:167], v[32:47]
  v_cvt_pk_bf16_f32 v88, v88, v89
  v_mul_f32 v90, s52, v90
  v_mul_f32 v91, s52, v91
  v_mfma_f32_32x32x16_bf16 v[48:63], v[28:31], v[228:231], v[48:63]
  v_cvt_pk_bf16_f32 v89, v90, v91
  v_mul_f32 v92, s52, v92
  ds_read_b128 v[28:31], v15 offset:256
  s_waitcnt lgkmcnt(3)
  v_mfma_f32_32x32x16_bf16 v[32:47], v[16:19], v[168:171], v[32:47]
  v_mul_f32 v93, s52, v93
  v_cvt_pk_bf16_f32 v90, v92, v93
  v_mul_f32 v94, s52, v94
  v_mfma_f32_32x32x16_bf16 v[48:63], v[16:19], v[232:235], v[48:63]
  v_mul_f32 v95, s52, v95
  v_cvt_pk_bf16_f32 v91, v94, v95
  ds_read_b128 v[16:19], v8 offset:16384
  s_waitcnt lgkmcnt(3)
  v_mfma_f32_32x32x16_bf16 v[32:47], v[20:23], v[172:175], v[32:47]
  v_permlane16_swap_b32 v80, v88
  v_permlane16_swap_b32 v81, v89
  v_permlane16_swap_b32 v82, v90
  v_mfma_f32_32x32x16_bf16 v[48:63], v[20:23], v[236:239], v[48:63]
  v_permlane16_swap_b32 v83, v91
  v_accvgpr_write_b32 a124, v80
  ds_read_b128 v[20:23], v9 offset:16384
  s_waitcnt lgkmcnt(3)
  v_mfma_f32_32x32x16_bf16 v[32:47], v[24:27], v[176:179], v[32:47]
  v_accvgpr_write_b32 a125, v81
  v_accvgpr_write_b32 a126, v82
  v_accvgpr_write_b32 a127, v83
  v_mfma_f32_32x32x16_bf16 v[48:63], v[24:27], v[240:243], v[48:63]
  v_accvgpr_write_b32 a180, v88
  v_accvgpr_write_b32 a181, v89
  ds_read_b128 v[24:27], v10 offset:16384
  s_waitcnt lgkmcnt(3)
  v_mfma_f32_32x32x16_bf16 v[32:47], v[28:31], v[180:183], v[32:47]
  v_accvgpr_write_b32 a182, v90
  v_accvgpr_write_b32 a183, v91
  v_mfma_f32_32x32x16_bf16 v[48:63], v[28:31], v[244:247], v[48:63]
  s_waitcnt vmcnt(16)
  s_barrier
  ds_read_b128 v[28:31], v11 offset:16384
  s_waitcnt lgkmcnt(3)
  v_mfma_f32_32x32x16_bf16 v[64:79], v[16:19], v[120:123], 0
  s_add_u32 s22, s27, 3145728
  s_add_u32 m0, s25, 49152
  s_nop 0
  buffer_load_dwordx4 v4, s[56:59], s22 offen offset:0 lds
  v_mfma_f32_32x32x16_bf16 v[80:95], v[16:19], v[184:187], 0
  ds_read_b128 v[16:19], v12 offset:16384
  s_waitcnt lgkmcnt(3)
  v_mfma_f32_32x32x16_bf16 v[64:79], v[20:23], v[124:127], v[64:79]
  buffer_load_dwordx4 v5, s[56:59], s22 offen offset:1024 lds
  v_mul_f32 v32, s52, v32
  v_mul_f32 v33, s52, v33
  v_cvt_pk_bf16_f32 v32, v32, v33
  v_mfma_f32_32x32x16_bf16 v[80:95], v[20:23], v[188:191], v[80:95]
  v_mul_f32 v34, s52, v34
  v_mul_f32 v35, s52, v35
  ds_read_b128 v[20:23], v13 offset:16384
  s_waitcnt lgkmcnt(3)
  v_mfma_f32_32x32x16_bf16 v[64:79], v[24:27], v[128:131], v[64:79]
  buffer_load_dwordx4 v6, s[56:59], s22 offen offset:2048 lds
  v_cvt_pk_bf16_f32 v33, v34, v35
  v_mul_f32 v36, s52, v36
  v_mul_f32 v37, s52, v37
  v_mfma_f32_32x32x16_bf16 v[80:95], v[24:27], v[192:195], v[80:95]
  v_cvt_pk_bf16_f32 v34, v36, v37
  v_mul_f32 v38, s52, v38
  ds_read_b128 v[24:27], v14 offset:16384
  s_waitcnt lgkmcnt(3)
  v_mfma_f32_32x32x16_bf16 v[64:79], v[28:31], v[132:135], v[64:79]
  buffer_load_dwordx4 v7, s[56:59], s22 offen offset:3072 lds
  v_mul_f32 v39, s52, v39
  v_cvt_pk_bf16_f32 v35, v38, v39
  v_mul_f32 v40, s52, v40
  v_mfma_f32_32x32x16_bf16 v[80:95], v[28:31], v[196:199], v[80:95]
  v_mul_f32 v41, s52, v41
  v_cvt_pk_bf16_f32 v40, v40, v41
  ds_read_b128 v[28:31], v15 offset:16384
  s_waitcnt lgkmcnt(3)
  v_mfma_f32_32x32x16_bf16 v[64:79], v[16:19], v[136:139], v[64:79]
  s_add_u32 s22, s27, 3407872
  s_add_u32 m0, s25, 65536
  s_nop 0
  buffer_load_dwordx4 v4, s[56:59], s22 offen offset:0 lds
  v_mul_f32 v42, s52, v42
  v_mul_f32 v43, s52, v43
  v_cvt_pk_bf16_f32 v41, v42, v43
  v_mfma_f32_32x32x16_bf16 v[80:95], v[16:19], v[200:203], v[80:95]
  v_mul_f32 v44, s52, v44
  v_mul_f32 v45, s52, v45
  ds_read_b128 v[16:19], v8 offset:16640
  s_waitcnt lgkmcnt(3)
  v_mfma_f32_32x32x16_bf16 v[64:79], v[20:23], v[140:143], v[64:79]
  buffer_load_dwordx4 v5, s[56:59], s22 offen offset:1024 lds
  v_cvt_pk_bf16_f32 v42, v44, v45
  v_mul_f32 v46, s52, v46
  v_mul_f32 v47, s52, v47
  v_mfma_f32_32x32x16_bf16 v[80:95], v[20:23], v[204:207], v[80:95]
  v_cvt_pk_bf16_f32 v43, v46, v47
  v_permlane16_swap_b32 v32, v40
  ds_read_b128 v[20:23], v9 offset:16640
  s_waitcnt lgkmcnt(3)
  v_mfma_f32_32x32x16_bf16 v[64:79], v[24:27], v[144:147], v[64:79]
  buffer_load_dwordx4 v6, s[56:59], s22 offen offset:2048 lds
  v_permlane16_swap_b32 v33, v41
  v_permlane16_swap_b32 v34, v42
  v_permlane16_swap_b32 v35, v43
  v_mfma_f32_32x32x16_bf16 v[80:95], v[24:27], v[208:211], v[80:95]
  v_accvgpr_write_b32 a16, v32
  v_accvgpr_write_b32 a17, v33
  ds_read_b128 v[24:27], v10 offset:16640
  s_waitcnt lgkmcnt(3)
  v_mfma_f32_32x32x16_bf16 v[64:79], v[28:31], v[148:151], v[64:79]
  buffer_load_dwordx4 v7, s[56:59], s22 offen offset:3072 lds
  v_accvgpr_write_b32 a18, v34
  v_accvgpr_write_b32 a19, v35
  v_accvgpr_write_b32 a72, v40
  v_mfma_f32_32x32x16_bf16 v[80:95], v[28:31], v[212:215], v[80:95]
  v_accvgpr_write_b32 a73, v41
  v_accvgpr_write_b32 a74, v42
  ds_read_b128 v[28:31], v11 offset:16640
  s_waitcnt lgkmcnt(3)
  v_mfma_f32_32x32x16_bf16 v[64:79], v[16:19], v[152:155], v[64:79]
  v_accvgpr_write_b32 a75, v43
  v_mul_f32 v48, s52, v48
  v_mul_f32 v49, s52, v49
  v_mfma_f32_32x32x16_bf16 v[80:95], v[16:19], v[216:219], v[80:95]
  v_cvt_pk_bf16_f32 v48, v48, v49
  v_mul_f32 v50, s52, v50
  ds_read_b128 v[16:19], v12 offset:16640
  s_waitcnt lgkmcnt(3)
  v_mfma_f32_32x32x16_bf16 v[64:79], v[20:23], v[156:159], v[64:79]
  v_mul_f32 v51, s52, v51
  v_cvt_pk_bf16_f32 v49, v50, v51
  v_mul_f32 v52, s52, v52
  v_mfma_f32_32x32x16_bf16 v[80:95], v[20:23], v[220:223], v[80:95]
  v_mul_f32 v53, s52, v53
  v_cvt_pk_bf16_f32 v50, v52, v53
  ds_read_b128 v[20:23], v13 offset:16640
  s_waitcnt lgkmcnt(3)
  v_mfma_f32_32x32x16_bf16 v[64:79], v[24:27], v[160:163], v[64:79]
  v_mul_f32 v54, s52, v54
  v_mul_f32 v55, s52, v55
  v_cvt_pk_bf16_f32 v51, v54, v55
  v_mfma_f32_32x32x16_bf16 v[80:95], v[24:27], v[224:227], v[80:95]
  v_mul_f32 v56, s52, v56
  v_mul_f32 v57, s52, v57
  ds_read_b128 v[24:27], v14 offset:16640
  s_waitcnt lgkmcnt(3)
  v_mfma_f32_32x32x16_bf16 v[64:79], v[28:31], v[164:167], v[64:79]
  v_cvt_pk_bf16_f32 v56, v56, v57
  v_mul_f32 v58, s52, v58
  v_mul_f32 v59, s52, v59
  v_mfma_f32_32x32x16_bf16 v[80:95], v[28:31], v[228:231], v[80:95]
  v_cvt_pk_bf16_f32 v57, v58, v59
  v_mul_f32 v60, s52, v60
  ds_read_b128 v[28:31], v15 offset:16640
  s_waitcnt lgkmcnt(3)
  v_mfma_f32_32x32x16_bf16 v[64:79], v[16:19], v[168:171], v[64:79]
  v_mul_f32 v61, s52, v61
  v_cvt_pk_bf16_f32 v58, v60, v61
  v_mul_f32 v62, s52, v62
  v_mfma_f32_32x32x16_bf16 v[80:95], v[16:19], v[232:235], v[80:95]
  v_mul_f32 v63, s52, v63
  v_cvt_pk_bf16_f32 v59, v62, v63
  ds_read_b128 v[16:19], v8 offset:32768
  s_waitcnt lgkmcnt(3)
  v_mfma_f32_32x32x16_bf16 v[64:79], v[20:23], v[172:175], v[64:79]
  v_permlane16_swap_b32 v48, v56
  v_permlane16_swap_b32 v49, v57
  v_permlane16_swap_b32 v50, v58
  v_mfma_f32_32x32x16_bf16 v[80:95], v[20:23], v[236:239], v[80:95]
  v_permlane16_swap_b32 v51, v59
  v_accvgpr_write_b32 a128, v48
  ds_read_b128 v[20:23], v9 offset:32768
  s_waitcnt lgkmcnt(3)
  v_mfma_f32_32x32x16_bf16 v[64:79], v[24:27], v[176:179], v[64:79]
  v_accvgpr_write_b32 a129, v49
  v_accvgpr_write_b32 a130, v50
  v_accvgpr_write_b32 a131, v51
  v_mfma_f32_32x32x16_bf16 v[80:95], v[24:27], v[240:243], v[80:95]
  v_accvgpr_write_b32 a184, v56
  v_accvgpr_write_b32 a185, v57
  ds_read_b128 v[24:27], v10 offset:32768
  s_waitcnt lgkmcnt(3)
  v_mfma_f32_32x32x16_bf16 v[64:79], v[28:31], v[180:183], v[64:79]
  v_accvgpr_write_b32 a186, v58
  v_accvgpr_write_b32 a187, v59
  v_mfma_f32_32x32x16_bf16 v[80:95], v[28:31], v[244:247], v[80:95]
  ds_read_b128 v[28:31], v11 offset:32768
  s_waitcnt lgkmcnt(3)
  v_mfma_f32_32x32x16_bf16 v[32:47], v[16:19], v[120:123], 0
  v_mfma_f32_32x32x16_bf16 v[48:63], v[16:19], v[184:187], 0
  ds_read_b128 v[16:19], v12 offset:32768
  s_waitcnt lgkmcnt(3)
  v_mfma_f32_32x32x16_bf16 v[32:47], v[20:23], v[124:127], v[32:47]
  v_mul_f32 v64, s52, v64
  v_mul_f32 v65, s52, v65
  v_cvt_pk_bf16_f32 v64, v64, v65
  v_mfma_f32_32x32x16_bf16 v[48:63], v[20:23], v[188:191], v[48:63]
  v_mul_f32 v66, s52, v66
  v_mul_f32 v67, s52, v67
  ds_read_b128 v[20:23], v13 offset:32768
  s_waitcnt lgkmcnt(3)
  v_mfma_f32_32x32x16_bf16 v[32:47], v[24:27], v[128:131], v[32:47]
  v_cvt_pk_bf16_f32 v65, v66, v67
  v_mul_f32 v68, s52, v68
  v_mul_f32 v69, s52, v69
  v_mfma_f32_32x32x16_bf16 v[48:63], v[24:27], v[192:195], v[48:63]
  v_cvt_pk_bf16_f32 v66, v68, v69
  v_mul_f32 v70, s52, v70
  ds_read_b128 v[24:27], v14 offset:32768
  s_waitcnt lgkmcnt(3)
  v_mfma_f32_32x32x16_bf16 v[32:47], v[28:31], v[132:135], v[32:47]
  v_mul_f32 v71, s52, v71
  v_cvt_pk_bf16_f32 v67, v70, v71
  v_mul_f32 v72, s52, v72
  v_mfma_f32_32x32x16_bf16 v[48:63], v[28:31], v[196:199], v[48:63]
  v_mul_f32 v73, s52, v73
  v_cvt_pk_bf16_f32 v72, v72, v73
  ds_read_b128 v[28:31], v15 offset:32768
  s_waitcnt lgkmcnt(3)
  v_mfma_f32_32x32x16_bf16 v[32:47], v[16:19], v[136:139], v[32:47]
  v_mul_f32 v74, s52, v74
  v_mul_f32 v75, s52, v75
  v_cvt_pk_bf16_f32 v73, v74, v75
  v_mfma_f32_32x32x16_bf16 v[48:63], v[16:19], v[200:203], v[48:63]
  v_mul_f32 v76, s52, v76
  v_mul_f32 v77, s52, v77
  ds_read_b128 v[16:19], v8 offset:33024
  s_waitcnt lgkmcnt(3)
  v_mfma_f32_32x32x16_bf16 v[32:47], v[20:23], v[140:143], v[32:47]
  v_cvt_pk_bf16_f32 v74, v76, v77
  v_mul_f32 v78, s52, v78
  v_mul_f32 v79, s52, v79
  v_mfma_f32_32x32x16_bf16 v[48:63], v[20:23], v[204:207], v[48:63]
  v_cvt_pk_bf16_f32 v75, v78, v79
  v_permlane16_swap_b32 v64, v72
  ds_read_b128 v[20:23], v9 offset:33024
  s_waitcnt lgkmcnt(3)
  v_mfma_f32_32x32x16_bf16 v[32:47], v[24:27], v[144:147], v[32:47]
  v_permlane16_swap_b32 v65, v73
  v_permlane16_swap_b32 v66, v74
  v_permlane16_swap_b32 v67, v75
  v_mfma_f32_32x32x16_bf16 v[48:63], v[24:27], v[208:211], v[48:63]
  v_accvgpr_write_b32 a20, v64
  v_accvgpr_write_b32 a21, v65
  ds_read_b128 v[24:27], v10 offset:33024
  s_waitcnt lgkmcnt(3)
  v_mfma_f32_32x32x16_bf16 v[32:47], v[28:31], v[148:151], v[32:47]
  v_accvgpr_write_b32 a22, v66
  v_accvgpr_write_b32 a23, v67
  v_accvgpr_write_b32 a76, v72
  v_mfma_f32_32x32x16_bf16 v[48:63], v[28:31], v[212:215], v[48:63]
  v_accvgpr_write_b32 a77, v73
  v_accvgpr_write_b32 a78, v74
  ds_read_b128 v[28:31], v11 offset:33024
  s_waitcnt lgkmcnt(3)
  v_mfma_f32_32x32x16_bf16 v[32:47], v[16:19], v[152:155], v[32:47]
  v_accvgpr_write_b32 a79, v75
  v_mul_f32 v80, s52, v80
  v_mul_f32 v81, s52, v81
  v_mfma_f32_32x32x16_bf16 v[48:63], v[16:19], v[216:219], v[48:63]
  v_cvt_pk_bf16_f32 v80, v80, v81
  v_mul_f32 v82, s52, v82
  ds_read_b128 v[16:19], v12 offset:33024
  s_waitcnt lgkmcnt(3)
  v_mfma_f32_32x32x16_bf16 v[32:47], v[20:23], v[156:159], v[32:47]
  v_mul_f32 v83, s52, v83
  v_cvt_pk_bf16_f32 v81, v82, v83
  v_mul_f32 v84, s52, v84
  v_mfma_f32_32x32x16_bf16 v[48:63], v[20:23], v[220:223], v[48:63]
  v_mul_f32 v85, s52, v85
  v_cvt_pk_bf16_f32 v82, v84, v85
  ds_read_b128 v[20:23], v13 offset:33024
  s_waitcnt lgkmcnt(3)
  v_mfma_f32_32x32x16_bf16 v[32:47], v[24:27], v[160:163], v[32:47]
  v_mul_f32 v86, s52, v86
  v_mul_f32 v87, s52, v87
  v_cvt_pk_bf16_f32 v83, v86, v87
  v_mfma_f32_32x32x16_bf16 v[48:63], v[24:27], v[224:227], v[48:63]
  v_mul_f32 v88, s52, v88
  v_mul_f32 v89, s52, v89
  ds_read_b128 v[24:27], v14 offset:33024
  s_waitcnt lgkmcnt(3)
  v_mfma_f32_32x32x16_bf16 v[32:47], v[28:31], v[164:167], v[32:47]
  v_cvt_pk_bf16_f32 v88, v88, v89
  v_mul_f32 v90, s52, v90
  v_mul_f32 v91, s52, v91
  v_mfma_f32_32x32x16_bf16 v[48:63], v[28:31], v[228:231], v[48:63]
  v_cvt_pk_bf16_f32 v89, v90, v91
  v_mul_f32 v92, s52, v92
  ds_read_b128 v[28:31], v15 offset:33024
  s_waitcnt lgkmcnt(3)
  v_mfma_f32_32x32x16_bf16 v[32:47], v[16:19], v[168:171], v[32:47]
  v_mul_f32 v93, s52, v93
  v_cvt_pk_bf16_f32 v90, v92, v93
  v_mul_f32 v94, s52, v94
  v_mfma_f32_32x32x16_bf16 v[48:63], v[16:19], v[232:235], v[48:63]
  v_mul_f32 v95, s52, v95
  v_cvt_pk_bf16_f32 v91, v94, v95
  ds_read_b128 v[16:19], v8 offset:49152
  s_waitcnt lgkmcnt(3)
  v_mfma_f32_32x32x16_bf16 v[32:47], v[20:23], v[172:175], v[32:47]
  v_permlane16_swap_b32 v80, v88
  v_permlane16_swap_b32 v81, v89
  v_permlane16_swap_b32 v82, v90
  v_mfma_f32_32x32x16_bf16 v[48:63], v[20:23], v[236:239], v[48:63]
  v_permlane16_swap_b32 v83, v91
  v_accvgpr_write_b32 a132, v80
  ds_read_b128 v[20:23], v9 offset:49152
  s_waitcnt lgkmcnt(3)
  v_mfma_f32_32x32x16_bf16 v[32:47], v[24:27], v[176:179], v[32:47]
  v_accvgpr_write_b32 a133, v81
  v_accvgpr_write_b32 a134, v82
  v_accvgpr_write_b32 a135, v83
  v_mfma_f32_32x32x16_bf16 v[48:63], v[24:27], v[240:243], v[48:63]
  v_accvgpr_write_b32 a188, v88
  v_accvgpr_write_b32 a189, v89
  ds_read_b128 v[24:27], v10 offset:49152
  s_waitcnt lgkmcnt(3)
  v_mfma_f32_32x32x16_bf16 v[32:47], v[28:31], v[180:183], v[32:47]
  v_accvgpr_write_b32 a190, v90
  v_accvgpr_write_b32 a191, v91
  v_mfma_f32_32x32x16_bf16 v[48:63], v[28:31], v[244:247], v[48:63]
  s_waitcnt vmcnt(16)
  s_barrier
  ds_read_b128 v[28:31], v11 offset:49152
  s_waitcnt lgkmcnt(3)
  v_mfma_f32_32x32x16_bf16 v[64:79], v[16:19], v[120:123], 0
  v_mfma_f32_32x32x16_bf16 v[80:95], v[16:19], v[184:187], 0
  ds_read_b128 v[16:19], v12 offset:49152
  s_waitcnt lgkmcnt(3)
  v_mfma_f32_32x32x16_bf16 v[64:79], v[20:23], v[124:127], v[64:79]
  v_mul_f32 v32, s52, v32
  v_mul_f32 v33, s52, v33
  v_cvt_pk_bf16_f32 v32, v32, v33
  v_mfma_f32_32x32x16_bf16 v[80:95], v[20:23], v[188:191], v[80:95]
  v_mul_f32 v34, s52, v34
  v_mul_f32 v35, s52, v35
  ds_read_b128 v[20:23], v13 offset:49152
  s_waitcnt lgkmcnt(3)
  v_mfma_f32_32x32x16_bf16 v[64:79], v[24:27], v[128:131], v[64:79]
  v_cvt_pk_bf16_f32 v33, v34, v35
  v_mul_f32 v36, s52, v36
  v_mul_f32 v37, s52, v37
  v_mfma_f32_32x32x16_bf16 v[80:95], v[24:27], v[192:195], v[80:95]
  v_cvt_pk_bf16_f32 v34, v36, v37
  v_mul_f32 v38, s52, v38
  ds_read_b128 v[24:27], v14 offset:49152
  s_waitcnt lgkmcnt(3)
  v_mfma_f32_32x32x16_bf16 v[64:79], v[28:31], v[132:135], v[64:79]
  v_mul_f32 v39, s52, v39
  v_cvt_pk_bf16_f32 v35, v38, v39
  v_mul_f32 v40, s52, v40
  v_mfma_f32_32x32x16_bf16 v[80:95], v[28:31], v[196:199], v[80:95]
  v_mul_f32 v41, s52, v41
  v_cvt_pk_bf16_f32 v40, v40, v41
  ds_read_b128 v[28:31], v15 offset:49152
  s_waitcnt lgkmcnt(3)
  v_mfma_f32_32x32x16_bf16 v[64:79], v[16:19], v[136:139], v[64:79]
  v_mul_f32 v42, s52, v42
  v_mul_f32 v43, s52, v43
  v_cvt_pk_bf16_f32 v41, v42, v43
  v_mfma_f32_32x32x16_bf16 v[80:95], v[16:19], v[200:203], v[80:95]
  v_mul_f32 v44, s52, v44
  v_mul_f32 v45, s52, v45
  ds_read_b128 v[16:19], v8 offset:49408
  s_waitcnt lgkmcnt(3)
  v_mfma_f32_32x32x16_bf16 v[64:79], v[20:23], v[140:143], v[64:79]
  v_cvt_pk_bf16_f32 v42, v44, v45
  v_mul_f32 v46, s52, v46
  v_mul_f32 v47, s52, v47
  v_mfma_f32_32x32x16_bf16 v[80:95], v[20:23], v[204:207], v[80:95]
  v_cvt_pk_bf16_f32 v43, v46, v47
  v_permlane16_swap_b32 v32, v40
  ds_read_b128 v[20:23], v9 offset:49408
  s_waitcnt lgkmcnt(3)
  v_mfma_f32_32x32x16_bf16 v[64:79], v[24:27], v[144:147], v[64:79]
  v_permlane16_swap_b32 v33, v41
  v_permlane16_swap_b32 v34, v42
  v_permlane16_swap_b32 v35, v43
  v_mfma_f32_32x32x16_bf16 v[80:95], v[24:27], v[208:211], v[80:95]
  v_accvgpr_write_b32 a24, v32
  v_accvgpr_write_b32 a25, v33
  ds_read_b128 v[24:27], v10 offset:49408
  s_waitcnt lgkmcnt(3)
  v_mfma_f32_32x32x16_bf16 v[64:79], v[28:31], v[148:151], v[64:79]
  v_accvgpr_write_b32 a26, v34
  v_accvgpr_write_b32 a27, v35
  v_accvgpr_write_b32 a80, v40
  v_mfma_f32_32x32x16_bf16 v[80:95], v[28:31], v[212:215], v[80:95]
  v_accvgpr_write_b32 a81, v41
  v_accvgpr_write_b32 a82, v42
  ds_read_b128 v[28:31], v11 offset:49408
  s_waitcnt lgkmcnt(3)
  v_mfma_f32_32x32x16_bf16 v[64:79], v[16:19], v[152:155], v[64:79]
  v_accvgpr_write_b32 a83, v43
  v_mul_f32 v48, s52, v48
  v_mul_f32 v49, s52, v49
  v_mfma_f32_32x32x16_bf16 v[80:95], v[16:19], v[216:219], v[80:95]
  v_cvt_pk_bf16_f32 v48, v48, v49
  v_mul_f32 v50, s52, v50
  ds_read_b128 v[16:19], v12 offset:49408
  s_waitcnt lgkmcnt(3)
  v_mfma_f32_32x32x16_bf16 v[64:79], v[20:23], v[156:159], v[64:79]
  v_mul_f32 v51, s52, v51
  v_cvt_pk_bf16_f32 v49, v50, v51
  v_mul_f32 v52, s52, v52
  v_mfma_f32_32x32x16_bf16 v[80:95], v[20:23], v[220:223], v[80:95]
  v_mul_f32 v53, s52, v53
  v_cvt_pk_bf16_f32 v50, v52, v53
  ds_read_b128 v[20:23], v13 offset:49408
  s_waitcnt lgkmcnt(3)
  v_mfma_f32_32x32x16_bf16 v[64:79], v[24:27], v[160:163], v[64:79]
  v_mul_f32 v54, s52, v54
  v_mul_f32 v55, s52, v55
  v_cvt_pk_bf16_f32 v51, v54, v55
  v_mfma_f32_32x32x16_bf16 v[80:95], v[24:27], v[224:227], v[80:95]
  v_mul_f32 v56, s52, v56
  v_mul_f32 v57, s52, v57
  ds_read_b128 v[24:27], v14 offset:49408
  s_waitcnt lgkmcnt(3)
  v_mfma_f32_32x32x16_bf16 v[64:79], v[28:31], v[164:167], v[64:79]
  v_cvt_pk_bf16_f32 v56, v56, v57
  v_mul_f32 v58, s52, v58
  v_mul_f32 v59, s52, v59
  v_mfma_f32_32x32x16_bf16 v[80:95], v[28:31], v[228:231], v[80:95]
  v_cvt_pk_bf16_f32 v57, v58, v59
  v_mul_f32 v60, s52, v60
  ds_read_b128 v[28:31], v15 offset:49408
  s_waitcnt lgkmcnt(3)
  v_mfma_f32_32x32x16_bf16 v[64:79], v[16:19], v[168:171], v[64:79]
  v_mul_f32 v61, s52, v61
  v_cvt_pk_bf16_f32 v58, v60, v61
  v_mul_f32 v62, s52, v62
  v_mfma_f32_32x32x16_bf16 v[80:95], v[16:19], v[232:235], v[80:95]
  v_mul_f32 v63, s52, v63
  v_cvt_pk_bf16_f32 v59, v62, v63
  v_xor_b32 v8, 196608, v8
  ds_read_b128 v[16:19], v8 offset:0
  s_waitcnt lgkmcnt(3)
  v_mfma_f32_32x32x16_bf16 v[64:79], v[20:23], v[172:175], v[64:79]
  v_permlane16_swap_b32 v48, v56
  v_permlane16_swap_b32 v49, v57
  v_permlane16_swap_b32 v50, v58
  v_mfma_f32_32x32x16_bf16 v[80:95], v[20:23], v[236:239], v[80:95]
  v_permlane16_swap_b32 v51, v59
  v_accvgpr_write_b32 a136, v48
  v_xor_b32 v9, 196608, v9
  ds_read_b128 v[20:23], v9 offset:0
  s_waitcnt lgkmcnt(3)
  v_mfma_f32_32x32x16_bf16 v[64:79], v[24:27], v[176:179], v[64:79]
  v_accvgpr_write_b32 a137, v49
  v_accvgpr_write_b32 a138, v50
  v_accvgpr_write_b32 a139, v51
  v_mfma_f32_32x32x16_bf16 v[80:95], v[24:27], v[240:243], v[80:95]
  v_accvgpr_write_b32 a192, v56
  v_accvgpr_write_b32 a193, v57
  v_xor_b32 v10, 196608, v10
  ds_read_b128 v[24:27], v10 offset:0
  s_waitcnt lgkmcnt(3)
  v_mfma_f32_32x32x16_bf16 v[64:79], v[28:31], v[180:183], v[64:79]
  v_accvgpr_write_b32 a194, v58
  v_accvgpr_write_b32 a195, v59
  v_mfma_f32_32x32x16_bf16 v[80:95], v[28:31], v[244:247], v[80:95]
  v_xor_b32 v11, 196608, v11
  ds_read_b128 v[28:31], v11 offset:0
  s_waitcnt lgkmcnt(3)
  v_mfma_f32_32x32x16_bf16 v[32:47], v[16:19], v[120:123], 0
  v_mfma_f32_32x32x16_bf16 v[48:63], v[16:19], v[184:187], 0
  v_xor_b32 v12, 196608, v12
  ds_read_b128 v[16:19], v12 offset:0
  s_waitcnt lgkmcnt(3)
  v_mfma_f32_32x32x16_bf16 v[32:47], v[20:23], v[124:127], v[32:47]
  v_mul_f32 v64, s52, v64
  v_mul_f32 v65, s52, v65
  v_cvt_pk_bf16_f32 v64, v64, v65
  v_mfma_f32_32x32x16_bf16 v[48:63], v[20:23], v[188:191], v[48:63]
  v_mul_f32 v66, s52, v66
  v_mul_f32 v67, s52, v67
  v_xor_b32 v13, 196608, v13
  ds_read_b128 v[20:23], v13 offset:0
  s_waitcnt lgkmcnt(3)
  v_mfma_f32_32x32x16_bf16 v[32:47], v[24:27], v[128:131], v[32:47]
  v_cvt_pk_bf16_f32 v65, v66, v67
  v_mul_f32 v68, s52, v68
  v_mul_f32 v69, s52, v69
  v_mfma_f32_32x32x16_bf16 v[48:63], v[24:27], v[192:195], v[48:63]
  v_cvt_pk_bf16_f32 v66, v68, v69
  v_mul_f32 v70, s52, v70
  v_xor_b32 v14, 196608, v14
  ds_read_b128 v[24:27], v14 offset:0
  s_waitcnt lgkmcnt(3)
  v_mfma_f32_32x32x16_bf16 v[32:47], v[28:31], v[132:135], v[32:47]
  v_mul_f32 v71, s52, v71
  v_cvt_pk_bf16_f32 v67, v70, v71
  v_mul_f32 v72, s52, v72
  v_mfma_f32_32x32x16_bf16 v[48:63], v[28:31], v[196:199], v[48:63]
  v_mul_f32 v73, s52, v73
  v_cvt_pk_bf16_f32 v72, v72, v73
  v_xor_b32 v15, 196608, v15
  ds_read_b128 v[28:31], v15 offset:0
  s_waitcnt lgkmcnt(3)
  v_mfma_f32_32x32x16_bf16 v[32:47], v[16:19], v[136:139], v[32:47]
  v_mul_f32 v74, s52, v74
  v_mul_f32 v75, s52, v75
  v_cvt_pk_bf16_f32 v73, v74, v75
  v_mfma_f32_32x32x16_bf16 v[48:63], v[16:19], v[200:203], v[48:63]
  v_mul_f32 v76, s52, v76
  v_mul_f32 v77, s52, v77
  ds_read_b128 v[16:19], v8 offset:256
  s_waitcnt lgkmcnt(3)
  v_mfma_f32_32x32x16_bf16 v[32:47], v[20:23], v[140:143], v[32:47]
  v_cvt_pk_bf16_f32 v74, v76, v77
  v_mul_f32 v78, s52, v78
  v_mul_f32 v79, s52, v79
  v_mfma_f32_32x32x16_bf16 v[48:63], v[20:23], v[204:207], v[48:63]
  v_cvt_pk_bf16_f32 v75, v78, v79
  v_permlane16_swap_b32 v64, v72
  ds_read_b128 v[20:23], v9 offset:256
  s_waitcnt lgkmcnt(3)
  v_mfma_f32_32x32x16_bf16 v[32:47], v[24:27], v[144:147], v[32:47]
  v_permlane16_swap_b32 v65, v73
  v_permlane16_swap_b32 v66, v74
  v_permlane16_swap_b32 v67, v75
  v_mfma_f32_32x32x16_bf16 v[48:63], v[24:27], v[208:211], v[48:63]
  v_accvgpr_write_b32 a28, v64
  v_accvgpr_write_b32 a29, v65
  ds_read_b128 v[24:27], v10 offset:256
  s_waitcnt lgkmcnt(3)
  v_mfma_f32_32x32x16_bf16 v[32:47], v[28:31], v[148:151], v[32:47]
  v_accvgpr_write_b32 a30, v66
  v_accvgpr_write_b32 a31, v67
  v_accvgpr_write_b32 a84, v72
  v_mfma_f32_32x32x16_bf16 v[48:63], v[28:31], v[212:215], v[48:63]
  v_accvgpr_write_b32 a85, v73
  v_accvgpr_write_b32 a86, v74
  ds_read_b128 v[28:31], v11 offset:256
  s_waitcnt lgkmcnt(3)
  v_mfma_f32_32x32x16_bf16 v[32:47], v[16:19], v[152:155], v[32:47]
  v_accvgpr_write_b32 a87, v75
  v_mul_f32 v80, s52, v80
  v_mul_f32 v81, s52, v81
  v_mfma_f32_32x32x16_bf16 v[48:63], v[16:19], v[216:219], v[48:63]
  v_cvt_pk_bf16_f32 v80, v80, v81
  v_mul_f32 v82, s52, v82
  ds_read_b128 v[16:19], v12 offset:256
  s_waitcnt lgkmcnt(3)
  v_mfma_f32_32x32x16_bf16 v[32:47], v[20:23], v[156:159], v[32:47]
  v_mul_f32 v83, s52, v83
  v_cvt_pk_bf16_f32 v81, v82, v83
  v_mul_f32 v84, s52, v84
  v_mfma_f32_32x32x16_bf16 v[48:63], v[20:23], v[220:223], v[48:63]
  v_mul_f32 v85, s52, v85
  v_cvt_pk_bf16_f32 v82, v84, v85
  ds_read_b128 v[20:23], v13 offset:256
  s_waitcnt lgkmcnt(3)
  v_mfma_f32_32x32x16_bf16 v[32:47], v[24:27], v[160:163], v[32:47]
  v_mul_f32 v86, s52, v86
  v_mul_f32 v87, s52, v87
  v_cvt_pk_bf16_f32 v83, v86, v87
  v_mfma_f32_32x32x16_bf16 v[48:63], v[24:27], v[224:227], v[48:63]
  v_mul_f32 v88, s52, v88
  v_mul_f32 v89, s52, v89
  ds_read_b128 v[24:27], v14 offset:256
  s_waitcnt lgkmcnt(3)
  v_mfma_f32_32x32x16_bf16 v[32:47], v[28:31], v[164:167], v[32:47]
  v_cvt_pk_bf16_f32 v88, v88, v89
  v_mul_f32 v90, s52, v90
  v_mul_f32 v91, s52, v91
  v_mfma_f32_32x32x16_bf16 v[48:63], v[28:31], v[228:231], v[48:63]
  v_cvt_pk_bf16_f32 v89, v90, v91
  v_mul_f32 v92, s52, v92
  ds_read_b128 v[28:31], v15 offset:256
  s_waitcnt lgkmcnt(3)
  v_mfma_f32_32x32x16_bf16 v[32:47], v[16:19], v[168:171], v[32:47]
  v_mul_f32 v93, s52, v93
  v_cvt_pk_bf16_f32 v90, v92, v93
  v_mul_f32 v94, s52, v94
  v_mfma_f32_32x32x16_bf16 v[48:63], v[16:19], v[232:235], v[48:63]
  v_mul_f32 v95, s52, v95
  v_cvt_pk_bf16_f32 v91, v94, v95
  v_xor_b32 v8, 131072, v8
  ds_read_b128 v[16:19], v8 offset:0
  s_waitcnt lgkmcnt(3)
  v_mfma_f32_32x32x16_bf16 v[32:47], v[20:23], v[172:175], v[32:47]
  v_permlane16_swap_b32 v80, v88
  v_permlane16_swap_b32 v81, v89
  v_permlane16_swap_b32 v82, v90
  v_mfma_f32_32x32x16_bf16 v[48:63], v[20:23], v[236:239], v[48:63]
  v_permlane16_swap_b32 v83, v91
  v_accvgpr_write_b32 a140, v80
  v_xor_b32 v9, 131072, v9
  ds_read_b128 v[20:23], v9 offset:0
  s_waitcnt lgkmcnt(3)
  v_mfma_f32_32x32x16_bf16 v[32:47], v[24:27], v[176:179], v[32:47]
  v_accvgpr_write_b32 a141, v81
  v_accvgpr_write_b32 a142, v82
  v_accvgpr_write_b32 a143, v83
  v_mfma_f32_32x32x16_bf16 v[48:63], v[24:27], v[240:243], v[48:63]
  v_accvgpr_write_b32 a196, v88
  v_accvgpr_write_b32 a197, v89
  v_xor_b32 v10, 131072, v10
  ds_read_b128 v[24:27], v10 offset:0
  s_waitcnt lgkmcnt(3)
  v_mfma_f32_32x32x16_bf16 v[32:47], v[28:31], v[180:183], v[32:47]
  v_accvgpr_write_b32 a198, v90
  v_accvgpr_write_b32 a199, v91
  v_mfma_f32_32x32x16_bf16 v[48:63], v[28:31], v[244:247], v[48:63]
  s_waitcnt vmcnt(8)
  s_barrier
  v_xor_b32 v11, 131072, v11
  ds_read_b128 v[28:31], v11 offset:0
  s_waitcnt lgkmcnt(3)
  v_mfma_f32_32x32x16_bf16 v[64:79], v[16:19], v[120:123], 0
  v_mfma_f32_32x32x16_bf16 v[80:95], v[16:19], v[184:187], 0
  v_xor_b32 v12, 131072, v12
  ds_read_b128 v[16:19], v12 offset:0
  s_waitcnt lgkmcnt(3)
  v_mfma_f32_32x32x16_bf16 v[64:79], v[20:23], v[124:127], v[64:79]
  v_mul_f32 v32, s52, v32
  v_mul_f32 v33, s52, v33
  v_cvt_pk_bf16_f32 v32, v32, v33
  v_mfma_f32_32x32x16_bf16 v[80:95], v[20:23], v[188:191], v[80:95]
  v_mul_f32 v34, s52, v34
  v_mul_f32 v35, s52, v35
  v_xor_b32 v13, 131072, v13
  ds_read_b128 v[20:23], v13 offset:0
  s_waitcnt lgkmcnt(3)
  v_mfma_f32_32x32x16_bf16 v[64:79], v[24:27], v[128:131], v[64:79]
  v_cvt_pk_bf16_f32 v33, v34, v35
  v_mul_f32 v36, s52, v36
  v_mul_f32 v37, s52, v37
  v_mfma_f32_32x32x16_bf16 v[80:95], v[24:27], v[192:195], v[80:95]
  v_cvt_pk_bf16_f32 v34, v36, v37
  v_mul_f32 v38, s52, v38
  v_xor_b32 v14, 131072, v14
  ds_read_b128 v[24:27], v14 offset:0
  s_waitcnt lgkmcnt(3)
  v_mfma_f32_32x32x16_bf16 v[64:79], v[28:31], v[132:135], v[64:79]
  v_mul_f32 v39, s52, v39
  v_cvt_pk_bf16_f32 v35, v38, v39
  v_mul_f32 v40, s52, v40
  v_mfma_f32_32x32x16_bf16 v[80:95], v[28:31], v[196:199], v[80:95]
  v_mul_f32 v41, s52, v41
  v_cvt_pk_bf16_f32 v40, v40, v41
  v_xor_b32 v15, 131072, v15
  ds_read_b128 v[28:31], v15 offset:0
  s_waitcnt lgkmcnt(3)
  v_mfma_f32_32x32x16_bf16 v[64:79], v[16:19], v[136:139], v[64:79]
  v_mul_f32 v42, s52, v42
  v_mul_f32 v43, s52, v43
  v_cvt_pk_bf16_f32 v41, v42, v43
  v_mfma_f32_32x32x16_bf16 v[80:95], v[16:19], v[200:203], v[80:95]
  v_mul_f32 v44, s52, v44
  v_mul_f32 v45, s52, v45
  ds_read_b128 v[16:19], v8 offset:256
  s_waitcnt lgkmcnt(3)
  v_mfma_f32_32x32x16_bf16 v[64:79], v[20:23], v[140:143], v[64:79]
  v_cvt_pk_bf16_f32 v42, v44, v45
  v_mul_f32 v46, s52, v46
  v_mul_f32 v47, s52, v47
  v_mfma_f32_32x32x16_bf16 v[80:95], v[20:23], v[204:207], v[80:95]
  v_cvt_pk_bf16_f32 v43, v46, v47
  v_permlane16_swap_b32 v32, v40
  ds_read_b128 v[20:23], v9 offset:256
  s_waitcnt lgkmcnt(3)
  v_mfma_f32_32x32x16_bf16 v[64:79], v[24:27], v[144:147], v[64:79]
  v_permlane16_swap_b32 v33, v41
  v_permlane16_swap_b32 v34, v42
  v_permlane16_swap_b32 v35, v43
  v_mfma_f32_32x32x16_bf16 v[80:95], v[24:27], v[208:211], v[80:95]
  v_accvgpr_write_b32 a32, v32
  v_accvgpr_write_b32 a33, v33
  ds_read_b128 v[24:27], v10 offset:256
  s_waitcnt lgkmcnt(3)
  v_mfma_f32_32x32x16_bf16 v[64:79], v[28:31], v[148:151], v[64:79]
  v_accvgpr_write_b32 a34, v34
  v_accvgpr_write_b32 a35, v35
  v_accvgpr_write_b32 a88, v40
  v_mfma_f32_32x32x16_bf16 v[80:95], v[28:31], v[212:215], v[80:95]
  v_accvgpr_write_b32 a89, v41
  v_accvgpr_write_b32 a90, v42
  ds_read_b128 v[28:31], v11 offset:256
  s_waitcnt lgkmcnt(3)
  v_mfma_f32_32x32x16_bf16 v[64:79], v[16:19], v[152:155], v[64:79]
  v_accvgpr_write_b32 a91, v43
  v_mul_f32 v48, s52, v48
  v_mul_f32 v49, s52, v49
  v_mfma_f32_32x32x16_bf16 v[80:95], v[16:19], v[216:219], v[80:95]
  v_cvt_pk_bf16_f32 v48, v48, v49
  v_mul_f32 v50, s52, v50
  ds_read_b128 v[16:19], v12 offset:256
  s_waitcnt lgkmcnt(3)
  v_mfma_f32_32x32x16_bf16 v[64:79], v[20:23], v[156:159], v[64:79]
  v_mul_f32 v51, s52, v51
  v_cvt_pk_bf16_f32 v49, v50, v51
  v_mul_f32 v52, s52, v52
  v_mfma_f32_32x32x16_bf16 v[80:95], v[20:23], v[220:223], v[80:95]
  v_mul_f32 v53, s52, v53
  v_cvt_pk_bf16_f32 v50, v52, v53
  ds_read_b128 v[20:23], v13 offset:256
  s_waitcnt lgkmcnt(3)
  v_mfma_f32_32x32x16_bf16 v[64:79], v[24:27], v[160:163], v[64:79]
  v_mul_f32 v54, s52, v54
  v_mul_f32 v55, s52, v55
  v_cvt_pk_bf16_f32 v51, v54, v55
  v_mfma_f32_32x32x16_bf16 v[80:95], v[24:27], v[224:227], v[80:95]
  v_mul_f32 v56, s52, v56
  v_mul_f32 v57, s52, v57
  ds_read_b128 v[24:27], v14 offset:256
  s_waitcnt lgkmcnt(3)
  v_mfma_f32_32x32x16_bf16 v[64:79], v[28:31], v[164:167], v[64:79]
  v_cvt_pk_bf16_f32 v56, v56, v57
  v_mul_f32 v58, s52, v58
  v_mul_f32 v59, s52, v59
  v_mfma_f32_32x32x16_bf16 v[80:95], v[28:31], v[228:231], v[80:95]
  v_cvt_pk_bf16_f32 v57, v58, v59
  v_mul_f32 v60, s52, v60
  ds_read_b128 v[28:31], v15 offset:256
  s_waitcnt lgkmcnt(3)
  v_mfma_f32_32x32x16_bf16 v[64:79], v[16:19], v[168:171], v[64:79]
  v_mul_f32 v61, s52, v61
  v_cvt_pk_bf16_f32 v58, v60, v61
  v_mul_f32 v62, s52, v62
  v_mfma_f32_32x32x16_bf16 v[80:95], v[16:19], v[232:235], v[80:95]
  v_mul_f32 v63, s52, v63
  v_cvt_pk_bf16_f32 v59, v62, v63
  ds_read_b128 v[16:19], v8 offset:16384
  s_waitcnt lgkmcnt(3)
  v_mfma_f32_32x32x16_bf16 v[64:79], v[20:23], v[172:175], v[64:79]
  v_permlane16_swap_b32 v48, v56
  v_permlane16_swap_b32 v49, v57
  v_permlane16_swap_b32 v50, v58
  v_mfma_f32_32x32x16_bf16 v[80:95], v[20:23], v[236:239], v[80:95]
  v_permlane16_swap_b32 v51, v59
  v_accvgpr_write_b32 a144, v48
  ds_read_b128 v[20:23], v9 offset:16384
  s_waitcnt lgkmcnt(3)
  v_mfma_f32_32x32x16_bf16 v[64:79], v[24:27], v[176:179], v[64:79]
  v_accvgpr_write_b32 a145, v49
  v_accvgpr_write_b32 a146, v50
  v_accvgpr_write_b32 a147, v51
  v_mfma_f32_32x32x16_bf16 v[80:95], v[24:27], v[240:243], v[80:95]
  v_accvgpr_write_b32 a200, v56
  v_accvgpr_write_b32 a201, v57
  ds_read_b128 v[24:27], v10 offset:16384
  s_waitcnt lgkmcnt(3)
  v_mfma_f32_32x32x16_bf16 v[64:79], v[28:31], v[180:183], v[64:79]
  v_accvgpr_write_b32 a202, v58
  v_accvgpr_write_b32 a203, v59
  v_mfma_f32_32x32x16_bf16 v[80:95], v[28:31], v[244:247], v[80:95]
  ds_read_b128 v[28:31], v11 offset:16384
  s_waitcnt lgkmcnt(3)
  v_mfma_f32_32x32x16_bf16 v[32:47], v[16:19], v[120:123], 0
  v_mfma_f32_32x32x16_bf16 v[48:63], v[16:19], v[184:187], 0
  ds_read_b128 v[16:19], v12 offset:16384
  s_waitcnt lgkmcnt(3)
  v_mfma_f32_32x32x16_bf16 v[32:47], v[20:23], v[124:127], v[32:47]
  v_mul_f32 v64, s52, v64
  v_mul_f32 v65, s52, v65
  v_cvt_pk_bf16_f32 v64, v64, v65
  v_mfma_f32_32x32x16_bf16 v[48:63], v[20:23], v[188:191], v[48:63]
  v_mul_f32 v66, s52, v66
  v_mul_f32 v67, s52, v67
  ds_read_b128 v[20:23], v13 offset:16384
  s_waitcnt lgkmcnt(3)
  v_mfma_f32_32x32x16_bf16 v[32:47], v[24:27], v[128:131], v[32:47]
  v_cvt_pk_bf16_f32 v65, v66, v67
  v_mul_f32 v68, s52, v68
  v_mul_f32 v69, s52, v69
  v_mfma_f32_32x32x16_bf16 v[48:63], v[24:27], v[192:195], v[48:63]
  v_cvt_pk_bf16_f32 v66, v68, v69
  v_mul_f32 v70, s52, v70
  ds_read_b128 v[24:27], v14 offset:16384
  s_waitcnt lgkmcnt(3)
  v_mfma_f32_32x32x16_bf16 v[32:47], v[28:31], v[132:135], v[32:47]
  v_mul_f32 v71, s52, v71
  v_cvt_pk_bf16_f32 v67, v70, v71
  v_mul_f32 v72, s52, v72
  v_mfma_f32_32x32x16_bf16 v[48:63], v[28:31], v[196:199], v[48:63]
  v_mul_f32 v73, s52, v73
  v_cvt_pk_bf16_f32 v72, v72, v73
  ds_read_b128 v[28:31], v15 offset:16384
  s_waitcnt lgkmcnt(3)
  v_mfma_f32_32x32x16_bf16 v[32:47], v[16:19], v[136:139], v[32:47]
  v_mul_f32 v74, s52, v74
  v_mul_f32 v75, s52, v75
  v_cvt_pk_bf16_f32 v73, v74, v75
  v_mfma_f32_32x32x16_bf16 v[48:63], v[16:19], v[200:203], v[48:63]
  v_mul_f32 v76, s52, v76
  v_mul_f32 v77, s52, v77
  ds_read_b128 v[16:19], v8 offset:16640
  s_waitcnt lgkmcnt(3)
  v_mfma_f32_32x32x16_bf16 v[32:47], v[20:23], v[140:143], v[32:47]
  v_cvt_pk_bf16_f32 v74, v76, v77
  v_mul_f32 v78, s52, v78
  v_mul_f32 v79, s52, v79
  v_mfma_f32_32x32x16_bf16 v[48:63], v[20:23], v[204:207], v[48:63]
  v_cvt_pk_bf16_f32 v75, v78, v79
  v_permlane16_swap_b32 v64, v72
  ds_read_b128 v[20:23], v9 offset:16640
  s_waitcnt lgkmcnt(3)
  v_mfma_f32_32x32x16_bf16 v[32:47], v[24:27], v[144:147], v[32:47]
  v_permlane16_swap_b32 v65, v73
  v_permlane16_swap_b32 v66, v74
  v_permlane16_swap_b32 v67, v75
  v_mfma_f32_32x32x16_bf16 v[48:63], v[24:27], v[208:211], v[48:63]
  v_accvgpr_write_b32 a36, v64
  v_accvgpr_write_b32 a37, v65
  ds_read_b128 v[24:27], v10 offset:16640
  s_waitcnt lgkmcnt(3)
  v_mfma_f32_32x32x16_bf16 v[32:47], v[28:31], v[148:151], v[32:47]
  v_accvgpr_write_b32 a38, v66
  v_accvgpr_write_b32 a39, v67
  v_accvgpr_write_b32 a92, v72
  v_mfma_f32_32x32x16_bf16 v[48:63], v[28:31], v[212:215], v[48:63]
  v_accvgpr_write_b32 a93, v73
  v_accvgpr_write_b32 a94, v74
  ds_read_b128 v[28:31], v11 offset:16640
  s_waitcnt lgkmcnt(3)
  v_mfma_f32_32x32x16_bf16 v[32:47], v[16:19], v[152:155], v[32:47]
  v_accvgpr_write_b32 a95, v75
  v_mul_f32 v80, s52, v80
  v_mul_f32 v81, s52, v81
  v_mfma_f32_32x32x16_bf16 v[48:63], v[16:19], v[216:219], v[48:63]
  v_cvt_pk_bf16_f32 v80, v80, v81
  v_mul_f32 v82, s52, v82
  ds_read_b128 v[16:19], v12 offset:16640
  s_waitcnt lgkmcnt(3)
  v_mfma_f32_32x32x16_bf16 v[32:47], v[20:23], v[156:159], v[32:47]
  v_mul_f32 v83, s52, v83
  v_cvt_pk_bf16_f32 v81, v82, v83
  v_mul_f32 v84, s52, v84
  v_mfma_f32_32x32x16_bf16 v[48:63], v[20:23], v[220:223], v[48:63]
  v_mul_f32 v85, s52, v85
  v_cvt_pk_bf16_f32 v82, v84, v85
  ds_read_b128 v[20:23], v13 offset:16640
  s_waitcnt lgkmcnt(3)
  v_mfma_f32_32x32x16_bf16 v[32:47], v[24:27], v[160:163], v[32:47]
  v_mul_f32 v86, s52, v86
  v_mul_f32 v87, s52, v87
  v_cvt_pk_bf16_f32 v83, v86, v87
  v_mfma_f32_32x32x16_bf16 v[48:63], v[24:27], v[224:227], v[48:63]
  v_mul_f32 v88, s52, v88
  v_mul_f32 v89, s52, v89
  ds_read_b128 v[24:27], v14 offset:16640
  s_waitcnt lgkmcnt(3)
  v_mfma_f32_32x32x16_bf16 v[32:47], v[28:31], v[164:167], v[32:47]
  v_cvt_pk_bf16_f32 v88, v88, v89
  v_mul_f32 v90, s52, v90
  v_mul_f32 v91, s52, v91
  v_mfma_f32_32x32x16_bf16 v[48:63], v[28:31], v[228:231], v[48:63]
  v_cvt_pk_bf16_f32 v89, v90, v91
  v_mul_f32 v92, s52, v92
  ds_read_b128 v[28:31], v15 offset:16640
  s_waitcnt lgkmcnt(3)
  v_mfma_f32_32x32x16_bf16 v[32:47], v[16:19], v[168:171], v[32:47]
  v_mul_f32 v93, s52, v93
  v_cvt_pk_bf16_f32 v90, v92, v93
  v_mul_f32 v94, s52, v94
  v_mfma_f32_32x32x16_bf16 v[48:63], v[16:19], v[232:235], v[48:63]
  v_mul_f32 v95, s52, v95
  v_cvt_pk_bf16_f32 v91, v94, v95
  ds_read_b128 v[16:19], v8 offset:32768
  s_waitcnt lgkmcnt(3)
  v_mfma_f32_32x32x16_bf16 v[32:47], v[20:23], v[172:175], v[32:47]
  v_permlane16_swap_b32 v80, v88
  v_permlane16_swap_b32 v81, v89
  v_permlane16_swap_b32 v82, v90
  v_mfma_f32_32x32x16_bf16 v[48:63], v[20:23], v[236:239], v[48:63]
  v_permlane16_swap_b32 v83, v91
  v_accvgpr_write_b32 a148, v80
  ds_read_b128 v[20:23], v9 offset:32768
  s_waitcnt lgkmcnt(3)
  v_mfma_f32_32x32x16_bf16 v[32:47], v[24:27], v[176:179], v[32:47]
  v_accvgpr_write_b32 a149, v81
  v_accvgpr_write_b32 a150, v82
  v_accvgpr_write_b32 a151, v83
  v_mfma_f32_32x32x16_bf16 v[48:63], v[24:27], v[240:243], v[48:63]
  v_accvgpr_write_b32 a204, v88
  v_accvgpr_write_b32 a205, v89
  ds_read_b128 v[24:27], v10 offset:32768
  s_waitcnt lgkmcnt(3)
  v_mfma_f32_32x32x16_bf16 v[32:47], v[28:31], v[180:183], v[32:47]
  v_accvgpr_write_b32 a206, v90
  v_accvgpr_write_b32 a207, v91
  v_mfma_f32_32x32x16_bf16 v[48:63], v[28:31], v[244:247], v[48:63]
  s_waitcnt vmcnt(0)
  s_barrier
  ds_read_b128 v[28:31], v11 offset:32768
  s_waitcnt lgkmcnt(3)
  v_mfma_f32_32x32x16_bf16 v[64:79], v[16:19], v[120:123], 0
  v_mfma_f32_32x32x16_bf16 v[80:95], v[16:19], v[184:187], 0
  ds_read_b128 v[16:19], v12 offset:32768
  s_waitcnt lgkmcnt(3)
  v_mfma_f32_32x32x16_bf16 v[64:79], v[20:23], v[124:127], v[64:79]
  v_mul_f32 v32, s52, v32
  v_mul_f32 v33, s52, v33
  v_cvt_pk_bf16_f32 v32, v32, v33
  v_mfma_f32_32x32x16_bf16 v[80:95], v[20:23], v[188:191], v[80:95]
  v_mul_f32 v34, s52, v34
  v_mul_f32 v35, s52, v35
  ds_read_b128 v[20:23], v13 offset:32768
  s_waitcnt lgkmcnt(3)
  v_mfma_f32_32x32x16_bf16 v[64:79], v[24:27], v[128:131], v[64:79]
  v_cvt_pk_bf16_f32 v33, v34, v35
  v_mul_f32 v36, s52, v36
  v_mul_f32 v37, s52, v37
  v_mfma_f32_32x32x16_bf16 v[80:95], v[24:27], v[192:195], v[80:95]
  v_cvt_pk_bf16_f32 v34, v36, v37
  v_mul_f32 v38, s52, v38
  ds_read_b128 v[24:27], v14 offset:32768
  s_waitcnt lgkmcnt(3)
  v_mfma_f32_32x32x16_bf16 v[64:79], v[28:31], v[132:135], v[64:79]
  v_mul_f32 v39, s52, v39
  v_cvt_pk_bf16_f32 v35, v38, v39
  v_mul_f32 v40, s52, v40
  v_mfma_f32_32x32x16_bf16 v[80:95], v[28:31], v[196:199], v[80:95]
  v_mul_f32 v41, s52, v41
  v_cvt_pk_bf16_f32 v40, v40, v41
  ds_read_b128 v[28:31], v15 offset:32768
  s_waitcnt lgkmcnt(3)
  v_mfma_f32_32x32x16_bf16 v[64:79], v[16:19], v[136:139], v[64:79]
  v_mul_f32 v42, s52, v42
  v_mul_f32 v43, s52, v43
  v_cvt_pk_bf16_f32 v41, v42, v43
  v_mfma_f32_32x32x16_bf16 v[80:95], v[16:19], v[200:203], v[80:95]
  v_mul_f32 v44, s52, v44
  v_mul_f32 v45, s52, v45
  ds_read_b128 v[16:19], v8 offset:33024
  s_waitcnt lgkmcnt(3)
  v_mfma_f32_32x32x16_bf16 v[64:79], v[20:23], v[140:143], v[64:79]
  v_cvt_pk_bf16_f32 v42, v44, v45
  v_mul_f32 v46, s52, v46
  v_mul_f32 v47, s52, v47
  v_mfma_f32_32x32x16_bf16 v[80:95], v[20:23], v[204:207], v[80:95]
  v_cvt_pk_bf16_f32 v43, v46, v47
  v_permlane16_swap_b32 v32, v40
  ds_read_b128 v[20:23], v9 offset:33024
  s_waitcnt lgkmcnt(3)
  v_mfma_f32_32x32x16_bf16 v[64:79], v[24:27], v[144:147], v[64:79]
  v_permlane16_swap_b32 v33, v41
  v_permlane16_swap_b32 v34, v42
  v_permlane16_swap_b32 v35, v43
  v_mfma_f32_32x32x16_bf16 v[80:95], v[24:27], v[208:211], v[80:95]
  v_accvgpr_write_b32 a40, v32
  v_accvgpr_write_b32 a41, v33
  ds_read_b128 v[24:27], v10 offset:33024
  s_waitcnt lgkmcnt(3)
  v_mfma_f32_32x32x16_bf16 v[64:79], v[28:31], v[148:151], v[64:79]
  v_accvgpr_write_b32 a42, v34
  v_accvgpr_write_b32 a43, v35
  v_accvgpr_write_b32 a96, v40
  v_mfma_f32_32x32x16_bf16 v[80:95], v[28:31], v[212:215], v[80:95]
  v_accvgpr_write_b32 a97, v41
  v_accvgpr_write_b32 a98, v42
  ds_read_b128 v[28:31], v11 offset:33024
  s_waitcnt lgkmcnt(3)
  v_mfma_f32_32x32x16_bf16 v[64:79], v[16:19], v[152:155], v[64:79]
  v_accvgpr_write_b32 a99, v43
  v_mul_f32 v48, s52, v48
  v_mul_f32 v49, s52, v49
  v_mfma_f32_32x32x16_bf16 v[80:95], v[16:19], v[216:219], v[80:95]
  v_cvt_pk_bf16_f32 v48, v48, v49
  v_mul_f32 v50, s52, v50
  ds_read_b128 v[16:19], v12 offset:33024
  s_waitcnt lgkmcnt(3)
  v_mfma_f32_32x32x16_bf16 v[64:79], v[20:23], v[156:159], v[64:79]
  v_mul_f32 v51, s52, v51
  v_cvt_pk_bf16_f32 v49, v50, v51
  v_mul_f32 v52, s52, v52
  v_mfma_f32_32x32x16_bf16 v[80:95], v[20:23], v[220:223], v[80:95]
  v_mul_f32 v53, s52, v53
  v_cvt_pk_bf16_f32 v50, v52, v53
  ds_read_b128 v[20:23], v13 offset:33024
  s_waitcnt lgkmcnt(3)
  v_mfma_f32_32x32x16_bf16 v[64:79], v[24:27], v[160:163], v[64:79]
  v_mul_f32 v54, s52, v54
  v_mul_f32 v55, s52, v55
  v_cvt_pk_bf16_f32 v51, v54, v55
  v_mfma_f32_32x32x16_bf16 v[80:95], v[24:27], v[224:227], v[80:95]
  v_mul_f32 v56, s52, v56
  v_mul_f32 v57, s52, v57
  ds_read_b128 v[24:27], v14 offset:33024
  s_waitcnt lgkmcnt(3)
  v_mfma_f32_32x32x16_bf16 v[64:79], v[28:31], v[164:167], v[64:79]
  v_cvt_pk_bf16_f32 v56, v56, v57
  v_mul_f32 v58, s52, v58
  v_mul_f32 v59, s52, v59
  v_mfma_f32_32x32x16_bf16 v[80:95], v[28:31], v[228:231], v[80:95]
  v_cvt_pk_bf16_f32 v57, v58, v59
  v_mul_f32 v60, s52, v60
  ds_read_b128 v[28:31], v15 offset:33024
  s_waitcnt lgkmcnt(3)
  v_mfma_f32_32x32x16_bf16 v[64:79], v[16:19], v[168:171], v[64:79]
  v_mul_f32 v61, s52, v61
  v_cvt_pk_bf16_f32 v58, v60, v61
  v_mul_f32 v62, s52, v62
  v_mfma_f32_32x32x16_bf16 v[80:95], v[16:19], v[232:235], v[80:95]
  v_mul_f32 v63, s52, v63
  v_cvt_pk_bf16_f32 v59, v62, v63
  ds_read_b128 v[16:19], v8 offset:49152
  s_waitcnt lgkmcnt(3)
  v_mfma_f32_32x32x16_bf16 v[64:79], v[20:23], v[172:175], v[64:79]
  v_permlane16_swap_b32 v48, v56
  v_permlane16_swap_b32 v49, v57
  v_permlane16_swap_b32 v50, v58
  v_mfma_f32_32x32x16_bf16 v[80:95], v[20:23], v[236:239], v[80:95]
  v_permlane16_swap_b32 v51, v59
  v_accvgpr_write_b32 a152, v48
  ds_read_b128 v[20:23], v9 offset:49152
  s_waitcnt lgkmcnt(3)
  v_mfma_f32_32x32x16_bf16 v[64:79], v[24:27], v[176:179], v[64:79]
  v_accvgpr_write_b32 a153, v49
  v_accvgpr_write_b32 a154, v50
  v_accvgpr_write_b32 a155, v51
  v_mfma_f32_32x32x16_bf16 v[80:95], v[24:27], v[240:243], v[80:95]
  v_accvgpr_write_b32 a208, v56
  v_accvgpr_write_b32 a209, v57
  ds_read_b128 v[24:27], v10 offset:49152
  s_waitcnt lgkmcnt(3)
  v_mfma_f32_32x32x16_bf16 v[64:79], v[28:31], v[180:183], v[64:79]
  v_accvgpr_write_b32 a210, v58
  v_accvgpr_write_b32 a211, v59
  v_mfma_f32_32x32x16_bf16 v[80:95], v[28:31], v[244:247], v[80:95]
  ds_read_b128 v[28:31], v11 offset:49152
  s_waitcnt lgkmcnt(3)
  v_mfma_f32_32x32x16_bf16 v[32:47], v[16:19], v[120:123], 0
  v_mfma_f32_32x32x16_bf16 v[48:63], v[16:19], v[184:187], 0
  ds_read_b128 v[16:19], v12 offset:49152
  s_waitcnt lgkmcnt(3)
  v_mfma_f32_32x32x16_bf16 v[32:47], v[20:23], v[124:127], v[32:47]
  v_mul_f32 v64, s52, v64
  v_mul_f32 v65, s52, v65
  v_cvt_pk_bf16_f32 v64, v64, v65
  v_mfma_f32_32x32x16_bf16 v[48:63], v[20:23], v[188:191], v[48:63]
  v_mul_f32 v66, s52, v66
  v_mul_f32 v67, s52, v67
  ds_read_b128 v[20:23], v13 offset:49152
  s_waitcnt lgkmcnt(3)
  v_mfma_f32_32x32x16_bf16 v[32:47], v[24:27], v[128:131], v[32:47]
  v_cvt_pk_bf16_f32 v65, v66, v67
  v_mul_f32 v68, s52, v68
  v_mul_f32 v69, s52, v69
  v_mfma_f32_32x32x16_bf16 v[48:63], v[24:27], v[192:195], v[48:63]
  v_cvt_pk_bf16_f32 v66, v68, v69
  v_mul_f32 v70, s52, v70
  ds_read_b128 v[24:27], v14 offset:49152
  s_waitcnt lgkmcnt(3)
  v_mfma_f32_32x32x16_bf16 v[32:47], v[28:31], v[132:135], v[32:47]
  v_mul_f32 v71, s52, v71
  v_cvt_pk_bf16_f32 v67, v70, v71
  v_mul_f32 v72, s52, v72
  v_mfma_f32_32x32x16_bf16 v[48:63], v[28:31], v[196:199], v[48:63]
  v_mul_f32 v73, s52, v73
  v_cvt_pk_bf16_f32 v72, v72, v73
  ds_read_b128 v[28:31], v15 offset:49152
  s_waitcnt lgkmcnt(3)
  v_mfma_f32_32x32x16_bf16 v[32:47], v[16:19], v[136:139], v[32:47]
  v_mul_f32 v74, s52, v74
  v_mul_f32 v75, s52, v75
  v_cvt_pk_bf16_f32 v73, v74, v75
  v_mfma_f32_32x32x16_bf16 v[48:63], v[16:19], v[200:203], v[48:63]
  v_mul_f32 v76, s52, v76
  v_mul_f32 v77, s52, v77
  ds_read_b128 v[16:19], v8 offset:49408
  s_waitcnt lgkmcnt(3)
  v_mfma_f32_32x32x16_bf16 v[32:47], v[20:23], v[140:143], v[32:47]
  v_cvt_pk_bf16_f32 v74, v76, v77
  v_mul_f32 v78, s52, v78
  v_mul_f32 v79, s52, v79
  v_mfma_f32_32x32x16_bf16 v[48:63], v[20:23], v[204:207], v[48:63]
  v_cvt_pk_bf16_f32 v75, v78, v79
  v_permlane16_swap_b32 v64, v72
  ds_read_b128 v[20:23], v9 offset:49408
  s_waitcnt lgkmcnt(3)
  v_mfma_f32_32x32x16_bf16 v[32:47], v[24:27], v[144:147], v[32:47]
  v_permlane16_swap_b32 v65, v73
  v_permlane16_swap_b32 v66, v74
  v_permlane16_swap_b32 v67, v75
  v_mfma_f32_32x32x16_bf16 v[48:63], v[24:27], v[208:211], v[48:63]
  v_accvgpr_write_b32 a44, v64
  v_accvgpr_write_b32 a45, v65
  ds_read_b128 v[24:27], v10 offset:49408
  s_waitcnt lgkmcnt(3)
  v_mfma_f32_32x32x16_bf16 v[32:47], v[28:31], v[148:151], v[32:47]
  v_accvgpr_write_b32 a46, v66
  v_accvgpr_write_b32 a47, v67
  v_accvgpr_write_b32 a100, v72
  v_mfma_f32_32x32x16_bf16 v[48:63], v[28:31], v[212:215], v[48:63]
  v_accvgpr_write_b32 a101, v73
  v_accvgpr_write_b32 a102, v74
  ds_read_b128 v[28:31], v11 offset:49408
  s_waitcnt lgkmcnt(3)
  v_mfma_f32_32x32x16_bf16 v[32:47], v[16:19], v[152:155], v[32:47]
  v_accvgpr_write_b32 a103, v75
  v_mul_f32 v80, s52, v80
  v_mul_f32 v81, s52, v81
  v_mfma_f32_32x32x16_bf16 v[48:63], v[16:19], v[216:219], v[48:63]
  v_cvt_pk_bf16_f32 v80, v80, v81
  v_mul_f32 v82, s52, v82
  ds_read_b128 v[16:19], v12 offset:49408
  s_waitcnt lgkmcnt(3)
  v_mfma_f32_32x32x16_bf16 v[32:47], v[20:23], v[156:159], v[32:47]
  v_mul_f32 v83, s52, v83
  v_cvt_pk_bf16_f32 v81, v82, v83
  v_mul_f32 v84, s52, v84
  v_mfma_f32_32x32x16_bf16 v[48:63], v[20:23], v[220:223], v[48:63]
  v_mul_f32 v85, s52, v85
  v_cvt_pk_bf16_f32 v82, v84, v85
  ds_read_b128 v[20:23], v13 offset:49408
  s_waitcnt lgkmcnt(3)
  v_mfma_f32_32x32x16_bf16 v[32:47], v[24:27], v[160:163], v[32:47]
  v_mul_f32 v86, s52, v86
  v_mul_f32 v87, s52, v87
  v_cvt_pk_bf16_f32 v83, v86, v87
  v_mfma_f32_32x32x16_bf16 v[48:63], v[24:27], v[224:227], v[48:63]
  v_mul_f32 v88, s52, v88
  v_mul_f32 v89, s52, v89
  ds_read_b128 v[24:27], v14 offset:49408
  s_waitcnt lgkmcnt(3)
  v_mfma_f32_32x32x16_bf16 v[32:47], v[28:31], v[164:167], v[32:47]
  v_cvt_pk_bf16_f32 v88, v88, v89
  v_mul_f32 v90, s52, v90
  v_mul_f32 v91, s52, v91
  v_mfma_f32_32x32x16_bf16 v[48:63], v[28:31], v[228:231], v[48:63]
  v_cvt_pk_bf16_f32 v89, v90, v91
  v_mul_f32 v92, s52, v92
  ds_read_b128 v[28:31], v15 offset:49408
  s_waitcnt lgkmcnt(3)
  v_mfma_f32_32x32x16_bf16 v[32:47], v[16:19], v[168:171], v[32:47]
  v_mul_f32 v93, s52, v93
  v_cvt_pk_bf16_f32 v90, v92, v93
  v_mul_f32 v94, s52, v94
  v_mfma_f32_32x32x16_bf16 v[48:63], v[16:19], v[232:235], v[48:63]
  v_mul_f32 v95, s52, v95
  v_cvt_pk_bf16_f32 v91, v94, v95
  v_xor_b32 v8, 65536, v8
  ds_read_b128 v[16:19], v8 offset:0
  s_waitcnt lgkmcnt(3)
  v_mfma_f32_32x32x16_bf16 v[32:47], v[20:23], v[172:175], v[32:47]
  v_permlane16_swap_b32 v80, v88
  v_permlane16_swap_b32 v81, v89
  v_permlane16_swap_b32 v82, v90
  v_mfma_f32_32x32x16_bf16 v[48:63], v[20:23], v[236:239], v[48:63]
  v_permlane16_swap_b32 v83, v91
  v_accvgpr_write_b32 a156, v80
  v_xor_b32 v9, 65536, v9
  ds_read_b128 v[20:23], v9 offset:0
  s_waitcnt lgkmcnt(3)
  v_mfma_f32_32x32x16_bf16 v[32:47], v[24:27], v[176:179], v[32:47]
  v_accvgpr_write_b32 a157, v81
  v_accvgpr_write_b32 a158, v82
  v_accvgpr_write_b32 a159, v83
  v_mfma_f32_32x32x16_bf16 v[48:63], v[24:27], v[240:243], v[48:63]
  v_accvgpr_write_b32 a212, v88
  v_accvgpr_write_b32 a213, v89
  v_xor_b32 v10, 65536, v10
  ds_read_b128 v[24:27], v10 offset:0
  s_waitcnt lgkmcnt(3)
  v_mfma_f32_32x32x16_bf16 v[32:47], v[28:31], v[180:183], v[32:47]
  v_accvgpr_write_b32 a214, v90
  v_accvgpr_write_b32 a215, v91
  v_mfma_f32_32x32x16_bf16 v[48:63], v[28:31], v[244:247], v[48:63]
  v_xor_b32 v11, 65536, v11
  ds_read_b128 v[28:31], v11 offset:0
  s_waitcnt lgkmcnt(3)
  v_mfma_f32_32x32x16_bf16 v[64:79], v[16:19], v[120:123], 0
  buffer_load_dwordx4 v[100:103], v113, s[8:11], s28 offen sc1
  v_mfma_f32_32x32x16_bf16 v[80:95], v[16:19], v[184:187], 0
  v_xor_b32 v12, 65536, v12
  ds_read_b128 v[16:19], v12 offset:0
  s_waitcnt lgkmcnt(3)
  v_mfma_f32_32x32x16_bf16 v[64:79], v[20:23], v[124:127], v[64:79]
  buffer_load_dwordx4 v[104:107], v2, s[8:11], s29 offen sc1
  v_mul_f32 v32, s52, v32
  v_mul_f32 v33, s52, v33
  v_cvt_pk_bf16_f32 v32, v32, v33
  v_mfma_f32_32x32x16_bf16 v[80:95], v[20:23], v[188:191], v[80:95]
  v_mul_f32 v34, s52, v34
  v_mul_f32 v35, s52, v35
  v_xor_b32 v13, 65536, v13
  ds_read_b128 v[20:23], v13 offset:0
  s_waitcnt lgkmcnt(3)
  v_mfma_f32_32x32x16_bf16 v[64:79], v[24:27], v[128:131], v[64:79]
  buffer_load_dwordx4 v[108:111], v112, s[8:11], s29 offen sc1
  v_cvt_pk_bf16_f32 v33, v34, v35
  v_mul_f32 v36, s52, v36
  v_mul_f32 v37, s52, v37
  v_mfma_f32_32x32x16_bf16 v[80:95], v[24:27], v[192:195], v[80:95]
  v_cvt_pk_bf16_f32 v34, v36, v37
  v_mul_f32 v38, s52, v38
  v_xor_b32 v14, 65536, v14
  ds_read_b128 v[24:27], v14 offset:0
  s_waitcnt lgkmcnt(3)
  v_mfma_f32_32x32x16_bf16 v[64:79], v[28:31], v[132:135], v[64:79]
  v_mul_f32 v39, s52, v39
  v_cvt_pk_bf16_f32 v35, v38, v39
  v_mul_f32 v40, s52, v40
  v_mfma_f32_32x32x16_bf16 v[80:95], v[28:31], v[196:199], v[80:95]
  v_mul_f32 v41, s52, v41
  v_cvt_pk_bf16_f32 v40, v40, v41
  v_xor_b32 v15, 65536, v15
  ds_read_b128 v[28:31], v15 offset:0
  s_waitcnt lgkmcnt(3)
  v_mfma_f32_32x32x16_bf16 v[64:79], v[16:19], v[136:139], v[64:79]
  v_mul_f32 v42, s52, v42
  v_mul_f32 v43, s52, v43
  v_cvt_pk_bf16_f32 v41, v42, v43
  v_mfma_f32_32x32x16_bf16 v[80:95], v[16:19], v[200:203], v[80:95]
  v_mul_f32 v44, s52, v44
  v_mul_f32 v45, s52, v45
  ds_read_b128 v[16:19], v8 offset:256
  s_waitcnt lgkmcnt(3)
  v_mfma_f32_32x32x16_bf16 v[64:79], v[20:23], v[140:143], v[64:79]
  v_cvt_pk_bf16_f32 v42, v44, v45
  v_mul_f32 v46, s52, v46
  v_mul_f32 v47, s52, v47
  v_mfma_f32_32x32x16_bf16 v[80:95], v[20:23], v[204:207], v[80:95]
  v_cvt_pk_bf16_f32 v43, v46, v47
  v_permlane16_swap_b32 v32, v40
  ds_read_b128 v[20:23], v9 offset:256
  s_waitcnt lgkmcnt(3)
  v_mfma_f32_32x32x16_bf16 v[64:79], v[24:27], v[144:147], v[64:79]
  v_permlane16_swap_b32 v33, v41
  v_permlane16_swap_b32 v34, v42
  v_permlane16_swap_b32 v35, v43
  v_mfma_f32_32x32x16_bf16 v[80:95], v[24:27], v[208:211], v[80:95]
  v_accvgpr_write_b32 a48, v32
  v_accvgpr_write_b32 a49, v33
  ds_read_b128 v[24:27], v10 offset:256
  s_waitcnt lgkmcnt(3)
  v_mfma_f32_32x32x16_bf16 v[64:79], v[28:31], v[148:151], v[64:79]
  v_accvgpr_write_b32 a50, v34
  v_accvgpr_write_b32 a51, v35
  v_accvgpr_write_b32 a104, v40
  v_mfma_f32_32x32x16_bf16 v[80:95], v[28:31], v[212:215], v[80:95]
  v_accvgpr_write_b32 a105, v41
  v_accvgpr_write_b32 a106, v42
  ds_read_b128 v[28:31], v11 offset:256
  s_waitcnt lgkmcnt(3)
  v_mfma_f32_32x32x16_bf16 v[64:79], v[16:19], v[152:155], v[64:79]
  v_accvgpr_write_b32 a107, v43
  v_mul_f32 v48, s52, v48
  v_mul_f32 v49, s52, v49
  v_mfma_f32_32x32x16_bf16 v[80:95], v[16:19], v[216:219], v[80:95]
  v_cvt_pk_bf16_f32 v48, v48, v49
  v_mul_f32 v50, s52, v50
  ds_read_b128 v[16:19], v12 offset:256
  s_waitcnt lgkmcnt(3)
  v_mfma_f32_32x32x16_bf16 v[64:79], v[20:23], v[156:159], v[64:79]
  v_mul_f32 v51, s52, v51
  v_cvt_pk_bf16_f32 v49, v50, v51
  v_mul_f32 v52, s52, v52
  v_mfma_f32_32x32x16_bf16 v[80:95], v[20:23], v[220:223], v[80:95]
  v_mul_f32 v53, s52, v53
  v_cvt_pk_bf16_f32 v50, v52, v53
  ds_read_b128 v[20:23], v13 offset:256
  s_waitcnt lgkmcnt(3)
  v_mfma_f32_32x32x16_bf16 v[64:79], v[24:27], v[160:163], v[64:79]
  v_mul_f32 v54, s52, v54
  v_mul_f32 v55, s52, v55
  v_cvt_pk_bf16_f32 v51, v54, v55
  v_mfma_f32_32x32x16_bf16 v[80:95], v[24:27], v[224:227], v[80:95]
  v_mul_f32 v56, s52, v56
  v_mul_f32 v57, s52, v57
  ds_read_b128 v[24:27], v14 offset:256
  s_waitcnt lgkmcnt(3)
  v_mfma_f32_32x32x16_bf16 v[64:79], v[28:31], v[164:167], v[64:79]
  v_cvt_pk_bf16_f32 v56, v56, v57
  v_mul_f32 v58, s52, v58
  v_mul_f32 v59, s52, v59
  v_mfma_f32_32x32x16_bf16 v[80:95], v[28:31], v[228:231], v[80:95]
  v_cvt_pk_bf16_f32 v57, v58, v59
  v_mul_f32 v60, s52, v60
  ds_read_b128 v[28:31], v15 offset:256
  s_waitcnt lgkmcnt(3)
  v_mfma_f32_32x32x16_bf16 v[64:79], v[16:19], v[168:171], v[64:79]
  v_mul_f32 v61, s52, v61
  v_cvt_pk_bf16_f32 v58, v60, v61
  v_mul_f32 v62, s52, v62
  v_mfma_f32_32x32x16_bf16 v[80:95], v[16:19], v[232:235], v[80:95]
  v_mul_f32 v63, s52, v63
  v_cvt_pk_bf16_f32 v59, v62, v63
  s_waitcnt lgkmcnt(2)
  v_mfma_f32_32x32x16_bf16 v[64:79], v[20:23], v[172:175], v[64:79]
  v_permlane16_swap_b32 v48, v56
  v_permlane16_swap_b32 v49, v57
  v_permlane16_swap_b32 v50, v58
  v_mfma_f32_32x32x16_bf16 v[80:95], v[20:23], v[236:239], v[80:95]
  v_permlane16_swap_b32 v51, v59
  v_accvgpr_write_b32 a160, v48
  s_waitcnt lgkmcnt(1)
  v_mfma_f32_32x32x16_bf16 v[64:79], v[24:27], v[176:179], v[64:79]
  v_accvgpr_write_b32 a161, v49
  v_accvgpr_write_b32 a162, v50
  v_accvgpr_write_b32 a163, v51
  v_mfma_f32_32x32x16_bf16 v[80:95], v[24:27], v[240:243], v[80:95]
  v_accvgpr_write_b32 a216, v56
  v_accvgpr_write_b32 a217, v57
  s_waitcnt lgkmcnt(0)
  v_mfma_f32_32x32x16_bf16 v[64:79], v[28:31], v[180:183], v[64:79]
  v_accvgpr_write_b32 a218, v58
  v_accvgpr_write_b32 a219, v59
  v_mfma_f32_32x32x16_bf16 v[80:95], v[28:31], v[244:247], v[80:95]
  s_nop 4
  v_mul_f32 v64, s52, v64
  v_mul_f32 v65, s52, v65
  v_cvt_pk_bf16_f32 v64, v64, v65
  v_mul_f32 v66, s52, v66
  v_mul_f32 v67, s52, v67
  v_cvt_pk_bf16_f32 v65, v66, v67
  v_mul_f32 v68, s52, v68
  v_mul_f32 v69, s52, v69
  v_cvt_pk_bf16_f32 v66, v68, v69
  v_mul_f32 v70, s52, v70
  v_mul_f32 v71, s52, v71
  v_cvt_pk_bf16_f32 v67, v70, v71
  v_mul_f32 v72, s52, v72
  v_mul_f32 v73, s52, v73
  v_cvt_pk_bf16_f32 v72, v72, v73
  v_mul_f32 v74, s52, v74
  v_mul_f32 v75, s52, v75
  v_cvt_pk_bf16_f32 v73, v74, v75
  v_mul_f32 v76, s52, v76
  v_mul_f32 v77, s52, v77
  v_cvt_pk_bf16_f32 v74, v76, v77
  v_mul_f32 v78, s52, v78
  v_mul_f32 v79, s52, v79
  v_cvt_pk_bf16_f32 v75, v78, v79
  v_permlane16_swap_b32 v64, v72
  v_permlane16_swap_b32 v65, v73
  v_permlane16_swap_b32 v66, v74
  v_permlane16_swap_b32 v67, v75
  v_accvgpr_write_b32 a52, v64
  v_accvgpr_write_b32 a53, v65
  v_accvgpr_write_b32 a54, v66
  v_accvgpr_write_b32 a55, v67
  v_accvgpr_write_b32 a108, v72
  v_accvgpr_write_b32 a109, v73
  v_accvgpr_write_b32 a110, v74
  v_accvgpr_write_b32 a111, v75
  v_mul_f32 v80, s52, v80
  v_mul_f32 v81, s52, v81
  v_cvt_pk_bf16_f32 v80, v80, v81
  v_mul_f32 v82, s52, v82
  v_mul_f32 v83, s52, v83
  v_cvt_pk_bf16_f32 v81, v82, v83
  v_mul_f32 v84, s52, v84
  v_mul_f32 v85, s52, v85
  v_cvt_pk_bf16_f32 v82, v84, v85
  v_mul_f32 v86, s52, v86
  v_mul_f32 v87, s52, v87
  v_cvt_pk_bf16_f32 v83, v86, v87
  v_mul_f32 v88, s52, v88
  v_mul_f32 v89, s52, v89
  v_cvt_pk_bf16_f32 v88, v88, v89
  v_mul_f32 v90, s52, v90
  v_mul_f32 v91, s52, v91
  v_cvt_pk_bf16_f32 v89, v90, v91
  v_mul_f32 v92, s52, v92
  v_mul_f32 v93, s52, v93
  v_cvt_pk_bf16_f32 v90, v92, v93
  v_mul_f32 v94, s52, v94
  v_mul_f32 v95, s52, v95
  v_cvt_pk_bf16_f32 v91, v94, v95
  v_permlane16_swap_b32 v80, v88
  v_permlane16_swap_b32 v81, v89
  v_permlane16_swap_b32 v82, v90
  v_permlane16_swap_b32 v83, v91
  v_accvgpr_write_b32 a164, v80
  v_accvgpr_write_b32 a165, v81
  v_accvgpr_write_b32 a166, v82
  v_accvgpr_write_b32 a167, v83
  v_accvgpr_write_b32 a220, v88
  v_accvgpr_write_b32 a221, v89
  v_accvgpr_write_b32 a222, v90
  v_accvgpr_write_b32 a223, v91
  s_mov_b32 s30, 0
  s_branch sc_aw_w
sc_aw:
  buffer_load_dwordx4 v[100:103], v113, s[8:11], s28 offen sc1
  buffer_load_dwordx4 v[104:107], v2, s[8:11], s29 offen sc1
  buffer_load_dwordx4 v[108:111], v112, s[8:11], s29 offen sc1
sc_aw_w:
  s_waitcnt vmcnt(0)
  v_cmp_ne_u64 vcc, s[88:89], v[100:101]
  s_cbranch_vccnz sc_aw_no
  v_cmp_ne_u64 vcc, s[88:89], v[102:103]
  s_cbranch_vccnz sc_aw_no
  v_cmp_ne_u64 vcc, s[88:89], v[104:105]
  s_cbranch_vccnz sc_aw_no
  v_cmp_ne_u64 vcc, s[88:89], v[106:107]
  s_cbranch_vccnz sc_aw_no
  v_cmp_ne_u64 vcc, s[88:89], v[108:109]
  s_cbranch_vccnz sc_aw_no
  v_cmp_ne_u64 vcc, s[88:89], v[110:111]
  s_cbranch_vccnz sc_aw_no
  s_branch sc_aw_ok
sc_aw_no:
  s_sleep 1
  s_add_u32 s30, s30, 1
  s_cmp_lt_u32 s30, 50000
  s_cbranch_scc1 sc_aw
  s_branch cA_abort
sc_aw_ok:
  s_barrier
  s_branch m_role
m_val:
  s_cmp_lg_u32 s16, 0
  s_cbranch_scc1 w0_6
  v_mov_b32 v233, 128
  v_mov_b32 v234, s88
  v_mov_b32 v235, s89
  v_mov_b32 v236, 0
  v_mov_b32 v237, 0
  s_mov_b64 exec, 1
  buffer_atomic_cmpswap_x2 v[234:237], v233, s[12:15], 0 offen sc0
  s_mov_b64 exec, -1
w0_6:
  s_cmp_lg_u32 s66, 0
  s_cbranch_scc1 va_ci
  s_cmp_lg_u32 s16, 0
  s_cbranch_scc1 w0_7
  s_lshr_b32 s70, s3, 5
  s_and_b32 s71, s70, 4
  s_mul_i32 s71, s71, 12
  s_lshl_b32 s70, s70, 2
  s_add_u32 s70, s70, s71
  s_lshl_b32 s71, 1, s3
  v_mov_b32 v242, s71
  v_mov_b32 v243, 32
  s_mov_b64 exec, 1
  buffer_atomic_or v242, v243, s[12:15], s70 offen sc0
  buffer_load_dwordx2 v[244:245], v243, s[12:15], 0 offen offset:96 sc1
  s_mov_b64 exec, -1
w0_7:
va_ci:
  s_mov_b32 s56, s40
  s_and_b32 s57, s41, 0xffff
  s_mov_b32 s58, 3670016
  s_mov_b32 s59, 0x20000
  v_lshrrev_b32 v24, 5, v1
  v_and_b32 v25, 31, v1
  v_lshlrev_b32 v25, 4, v25
  v_lshl_add_u32 v24, v24, 13, v25
  s_mov_b32 s60, s42
  s_and_b32 s61, s43, 0xffff
  s_mov_b32 s62, 3670016
  s_mov_b32 s63, 0x20000
  s_lshl_b32 s22, s17, 9
  s_lshl_b32 s23, s16, 19
  s_add_u32 s23, s22, s23
  s_add_u32 s21, s23, 262144
  buffer_load_dwordx4 v[28:31], v24, s[60:63], s21 offen
  s_add_u32 s21, s23, 278528
  buffer_load_dwordx4 v[28:31], v24, s[60:63], s21 offen
  s_add_u32 s21, s23, 294912
  buffer_load_dwordx4 v[28:31], v24, s[60:63], s21 offen
  s_add_u32 s21, s23, 311296
  buffer_load_dwordx4 v[28:31], v24, s[60:63], s21 offen
  s_add_u32 s21, s23, 327680
  buffer_load_dwordx4 v[28:31], v24, s[60:63], s21 offen
  s_add_u32 s21, s23, 344064
  buffer_load_dwordx4 v[28:31], v24, s[60:63], s21 offen
  s_add_u32 s21, s23, 360448
  buffer_load_dwordx4 v[28:31], v24, s[60:63], s21 offen
  s_add_u32 s21, s23, 376832
  buffer_load_dwordx4 v[28:31], v24, s[60:63], s21 offen
  s_add_u32 s21, s23, 393216
  buffer_load_dwordx4 v[28:31], v24, s[60:63], s21 offen
  s_add_u32 s21, s23, 409600
  buffer_load_dwordx4 v[28:31], v24, s[60:63], s21 offen
  s_add_u32 s21, s23, 425984
  buffer_load_dwordx4 v[28:31], v24, s[60:63], s21 offen
  s_add_u32 s21, s23, 442368
  buffer_load_dwordx4 v[28:31], v24, s[60:63], s21 offen
  s_add_u32 s21, s23, 458752
  buffer_load_dwordx4 v[28:31], v24, s[60:63], s21 offen
  s_add_u32 s21, s23, 475136
  buffer_load_dwordx4 v[28:31], v24, s[60:63], s21 offen
  s_add_u32 s21, s23, 491520
  buffer_load_dwordx4 v[28:31], v24, s[60:63], s21 offen
  s_add_u32 s21, s23, 507904
  buffer_load_dwordx4 v[28:31], v24, s[60:63], s21 offen
  s_lshl_b32 s23, s16, 14
  s_add_u32 s22, s22, s23
  s_mov_b32 s30, 0
va_pf:
  buffer_load_dwordx4 v[28:31], v24, s[56:59], s22 offen
  s_waitcnt vmcnt(40)
  s_add_u32 s22, s22, 65536
  s_add_u32 s30, s30, 1
  s_cmp_lt_u32 s30, 28
  s_cbranch_scc1 va_pf
  s_cmp_lg_u32 s66, 0
  s_cbranch_scc1 va_cf
  s_cmp_lg_u32 s16, 0
  s_cbranch_scc1 w0_8
  s_waitcnt vmcnt(40)
  v_readfirstlane_b32 s70, v244
  s_cmp_lg_u32 s70, 0
  s_cbranch_scc1 va_nz
  v_mov_b32 v243, 128
  v_mov_b32 v244, s88
  v_mov_b32 v245, s89
  v_mov_b32 v246, 0
  v_mov_b32 v247, 0
  s_mov_b64 exec, 1
  buffer_atomic_cmpswap_x2 v[244:247], v243, s[12:15], 0 offen sc0
  s_mov_b64 exec, -1
  s_waitcnt vmcnt(0)
  v_readfirstlane_b32 s70, v244
  s_cmp_lg_u32 s70, 0
  s_cbranch_scc1 va_nz
  v_mov_b32 v244, s88
  v_mov_b32 v245, s89
va_nz:
w0_8:
  v_mov_b32 v243, 160000
  s_add_u32 s101, s101, 1
  s_barrier
  s_mov_b64 exec, 1
  s_cmp_lg_u32 s16, 0
  s_cbranch_scc1 w0_9
  ds_write_b32 v243, v242 offset:0
  ds_write_b32 v243, v244 offset:4
  ds_write_b32 v243, v245 offset:8
  s_waitcnt lgkmcnt(0)
  v_mov_b32 v242, s101
  ds_write_b32 v243, v242 offset:16
  s_waitcnt lgkmcnt(0)
w0_9:
  s_mov_b64 exec, -1
  s_barrier
  ds_read_b32 v242, v243 offset:0
  ds_read_b32 v244, v243 offset:4
  ds_read_b32 v245, v243 offset:8
  ds_read_b32 v243, v243 offset:16
  s_waitcnt lgkmcnt(0)
  v_readfirstlane_b32 s70, v242
  v_readfirstlane_b32 s88, v244
  v_readfirstlane_b32 s89, v245
  v_cmp_ne_u32 vcc, s101, v243
  s_cbranch_vccnz ch_end
  s_mov_b32 s66, 1
  s_bitcmp1_b32 s70, s3
  s_cbranch_scc1 m_reclaim
va_cf:
  s_cmp_lg_u32 s16, 0
  s_cbranch_scc1 w0_10
  s_cmp_eq_u32 s67, 0
  s_cselect_b32 s20, 1, 0x10001
  v_mov_b32 v242, s20
  v_mov_b32 v243, 0
  s_mov_b64 exec, 1
  buffer_atomic_add v242, v243, s[12:15], 0 offen
  s_mov_b64 exec, -1
w0_10:
m_role:
  s_mov_b32 s17, s3
  v_and_b32 v1, 63, v0
  v_lshlrev_b32 v2, 4, v1
  v_lshrrev_b32 v116, 4, v1
  v_and_b32 v117, 15, v1
  v_mov_b32 v3, 0x4444
  v_mov_b32 v118, 0xeeee
  v_cmp_lt_u32 vcc, 7, v117
  s_nop 1
  v_cndmask_b32 v3, v3, v118, vcc
  s_mov_b32 s19, 0
  s_mov_b32 s20, 75235328
  s_lshr_b32 s22, s17, 4
  s_lshl_b32 s22, s22, 2
  s_add_u32 s22, s22, s16
  s_and_b32 s17, s17, 15
  s_cmp_eq_u32 s22, 0
  s_cbranch_scc1 ch_init0
  s_cmp_eq_u32 s22, 1
  s_cbranch_scc1 ch_init1
  s_cmp_eq_u32 s22, 2
  s_cbranch_scc1 ch_init2
  s_cmp_eq_u32 s22, 3
  s_cbranch_scc1 ch_init3
  s_cmp_eq_u32 s22, 4
  s_cbranch_scc1 ch_init4
  s_cmp_eq_u32 s22, 5
  s_cbranch_scc1 ch_init5
  s_cmp_eq_u32 s22, 6
  s_cbranch_scc1 ch_init6
  s_cmp_eq_u32 s22, 7
  s_cbranch_scc1 ch_init7
  s_branch ch_end
ch_init0:
  s_mul_i32 s31, s17, 401408
  s_add_u32 s31, s31, 0
  s_add_u32 s22, s31, 229376
  buffer_load_dwordx4 a[224:227], v2, s[8:11], s22 offen offset:0 sc1
  buffer_load_dwordx4 a[228:231], v2, s[8:11], s22 offen offset:1024 sc1
  buffer_load_dwordx4 a[232:235], v2, s[8:11], s22 offen offset:2048 sc1
  buffer_load_dwordx4 a[236:239], v2, s[8:11], s22 offen offset:3072 sc1
  s_add_u32 s22, s31, 233472
  buffer_load_dwordx4 a[240:243], v2, s[8:11], s22 offen offset:0 sc1
  buffer_load_dwordx4 a[244:247], v2, s[8:11], s22 offen offset:1024 sc1
  buffer_load_dwordx4 a[248:251], v2, s[8:11], s22 offen offset:2048 sc1
  buffer_load_dwordx4 a[252:255], v2, s[8:11], s22 offen offset:3072 sc1
  s_add_u32 s22, s31, 237568
  buffer_load_dwordx4 v[120:123], v2, s[8:11], s22 offen offset:0 sc1
  buffer_load_dwordx4 v[124:127], v2, s[8:11], s22 offen offset:1024 sc1
  buffer_load_dwordx4 v[128:131], v2, s[8:11], s22 offen offset:2048 sc1
  buffer_load_dwordx4 v[132:135], v2, s[8:11], s22 offen offset:3072 sc1
  s_add_u32 s22, s31, 241664
  buffer_load_dwordx4 v[136:139], v2, s[8:11], s22 offen offset:0 sc1
  buffer_load_dwordx4 v[140:143], v2, s[8:11], s22 offen offset:1024 sc1
  buffer_load_dwordx4 v[144:147], v2, s[8:11], s22 offen offset:2048 sc1
  buffer_load_dwordx4 v[148:151], v2, s[8:11], s22 offen offset:3072 sc1
  s_add_u32 s22, s31, 245760
  buffer_load_dwordx4 v[152:155], v2, s[8:11], s22 offen offset:0 sc1
  buffer_load_dwordx4 v[156:159], v2, s[8:11], s22 offen offset:1024 sc1
  buffer_load_dwordx4 v[160:163], v2, s[8:11], s22 offen offset:2048 sc1
  buffer_load_dwordx4 v[164:167], v2, s[8:11], s22 offen offset:3072 sc1
  s_add_u32 s22, s31, 249856
  buffer_load_dwordx4 v[168:171], v2, s[8:11], s22 offen offset:0 sc1
  buffer_load_dwordx4 v[172:175], v2, s[8:11], s22 offen offset:1024 sc1
  buffer_load_dwordx4 v[176:179], v2, s[8:11], s22 offen offset:2048 sc1
  buffer_load_dwordx4 v[180:183], v2, s[8:11], s22 offen offset:3072 sc1
  s_add_u32 s22, s31, 253952
  buffer_load_dwordx4 v[184:187], v2, s[8:11], s22 offen offset:0 sc1
  buffer_load_dwordx4 v[188:191], v2, s[8:11], s22 offen offset:1024 sc1
  buffer_load_dwordx4 v[192:195], v2, s[8:11], s22 offen offset:2048 sc1
  buffer_load_dwordx4 v[196:199], v2, s[8:11], s22 offen offset:3072 sc1
  s_add_u32 s22, s31, 344064
  buffer_load_dwordx4 v[200:203], v2, s[8:11], s22 offen offset:0 sc1
  buffer_load_dwordx4 v[204:207], v2, s[8:11], s22 offen offset:1024 sc1
  buffer_load_dwordx4 v[208:211], v2, s[8:11], s22 offen offset:2048 sc1
  buffer_load_dwordx4 v[212:215], v2, s[8:11], s22 offen offset:3072 sc1
  s_waitcnt vmcnt(24)
  s_add_u32 s22, s31, 348160
  buffer_load_dwordx4 v[216:219], v2, s[8:11], s22 offen offset:0 sc1
  buffer_load_dwordx4 v[220:223], v2, s[8:11], s22 offen offset:1024 sc1
  buffer_load_dwordx4 v[224:227], v2, s[8:11], s22 offen offset:2048 sc1
  buffer_load_dwordx4 v[228:231], v2, s[8:11], s22 offen offset:3072 sc1
  s_add_u32 s22, s31, 352256
  buffer_load_dwordx4 v[232:235], v2, s[8:11], s22 offen offset:0 sc1
  buffer_load_dwordx4 v[236:239], v2, s[8:11], s22 offen offset:1024 sc1
  buffer_load_dwordx4 v[240:243], v2, s[8:11], s22 offen offset:2048 sc1
  buffer_load_dwordx4 v[244:247], v2, s[8:11], s22 offen offset:3072 sc1
  s_add_u32 s22, s31, 356352
  buffer_load_dwordx4 v[248:251], v2, s[8:11], s22 offen offset:0 sc1
  buffer_load_dwordx4 v[252:255], v2, s[8:11], s22 offen offset:1024 sc1
  s_mov_b32 s24, 71565312
  s_mov_b32 s25, 0
  s_add_u32 m0, s25, 0
  s_nop 0
  buffer_load_dwordx4 v2, s[8:11], s24 offen offset:0 sc1 lds
  buffer_load_dwordx4 v2, s[8:11], s24 offen offset:1024 sc1 lds
  buffer_load_dwordx4 v2, s[8:11], s24 offen offset:2048 sc1 lds
  buffer_load_dwordx4 v2, s[8:11], s24 offen offset:3072 sc1 lds
  s_add_u32 m0, s25, 4096
  s_add_u32 s22, s24, 4096
  buffer_load_dwordx4 v2, s[8:11], s22 offen offset:0 sc1 lds
  buffer_load_dwordx4 v2, s[8:11], s22 offen offset:1024 sc1 lds
  buffer_load_dwordx4 v2, s[8:11], s22 offen offset:2048 sc1 lds
  v_and_b32 v64, 7, v117
  v_and_b32 v65, 1, v116
  v_lshlrev_b32 v65, 2, v65
  v_sub_u32 v64, v64, v65
  v_lshrrev_b32 v65, 3, v117
  v_lshl_add_u32 v66, v65, 2, v64
  v_cmp_gt_u32 vcc, 4, v64
  v_mov_b32 v67, 99
  s_nop 0
  v_cndmask_b32 v66, v67, v66, vcc
  v_mov_b32 v68, 0x3f80
  v_mov_b32 v69, 0x3f800000
  v_mov_b32 v4, 0
  v_cmp_eq_u32 vcc, 0, v66
  s_nop 1
  v_cndmask_b32 v4, v4, v68, vcc
  v_cmp_eq_u32 vcc, 1, v66
  s_nop 1
  v_cndmask_b32 v4, v4, v69, vcc
  v_mov_b32 v5, 0
  v_cmp_eq_u32 vcc, 2, v66
  s_nop 1
  v_cndmask_b32 v5, v5, v68, vcc
  v_cmp_eq_u32 vcc, 3, v66
  s_nop 1
  v_cndmask_b32 v5, v5, v69, vcc
  v_mov_b32 v6, 0
  v_cmp_eq_u32 vcc, 4, v66
  s_nop 1
  v_cndmask_b32 v6, v6, v68, vcc
  v_cmp_eq_u32 vcc, 5, v66
  s_nop 1
  v_cndmask_b32 v6, v6, v69, vcc
  v_mov_b32 v7, 0
  v_cmp_eq_u32 vcc, 6, v66
  s_nop 1
  v_cndmask_b32 v7, v7, v68, vcc
  v_cmp_eq_u32 vcc, 7, v66
  s_nop 1
  v_cndmask_b32 v7, v7, v69, vcc
  v_lshrrev_b32 v64, 1, v116
  v_lshrrev_b32 v65, 3, v117
  v_cmp_eq_u32 s[26:27], v64, v65
  v_and_b32 v66, 1, v116
  v_add_u32 v64, 0, v64
  v_lshrrev_b32 v67, 1, v116
  v_lshlrev_b32 v67, 8, v67
  v_lshl_add_u32 v67, v66, 9, v67
  v_lshl_add_u32 v67, v117, 4, v67
  v_add_u32 v112, 57344, v67
  v_and_b32 v68, 7, v117
  v_lshlrev_b32 v67, 8, v64
  v_lshl_add_u32 v67, v68, 5, v67
  v_lshl_add_u32 v67, v66, 4, v67
  v_add_u32 v113, 65536, v67
  v_lshrrev_b32 v64, 5, v1
  v_and_b32 v65, 31, v1
  v_lshrrev_b32 v66, 3, v65
  v_and_b32 v67, 7, v65
  v_and_b32 v68, 3, v67
  v_lshl_add_u32 v68, v66, 2, v68
  v_lshrrev_b32 v69, 2, v67
  v_lshl_add_u32 v68, v69, 4, v68
  v_lshlrev_b32 v69, 11, v64
  v_lshl_add_u32 v69, v68, 4, v69
  v_add_u32 v114, 57344, v69
  v_add_u32 v70, 0, v64
  v_lshlrev_b32 v69, 9, v66
  v_lshl_add_u32 v69, v70, 5, v69
  v_lshl_add_u32 v69, v67, 2, v69
  v_add_u32 v115, 65536, v69
  v_and_b32 v71, 1, v1
  v_cmp_eq_u32 s[38:39], 0, v71
  v_cmp_gt_u32 vcc, 8, v65
  s_or_b64 s[28:29], s[38:39], vcc
  v_lshrrev_b32 v72, 1, v67
  v_lshlrev_b32 v72, 2, v72
  v_lshl_add_u32 v72, v70, 4, v72
  s_lshl_b32 s22, s17, 9
  s_add_u32 s22, s22, 9216
  v_lshl_add_u32 v73, v66, 7, v72
  v_add_u32 v73, s22, v73
  s_lshl_b32 s22, s17, 7
  s_add_u32 s22, s22, 7168
  v_add_u32 v74, s22, v72
  v_bfe_u32 v72, v65, 1, 1
  v_lshlrev_b32 v72, 7, v72
  v_lshl_add_u32 v72, v70, 4, v72
  v_bfe_u32 v73, v65, 2, 2
  v_lshl_add_u32 v72, v73, 2, v72
  v_lshrrev_b32 v73, 4, v65
  v_lshl_add_u32 v73, v73, 8, v72
  s_lshl_b32 s22, s17, 9
  s_add_u32 s22, s22, 9216
  v_add_u32 v73, s22, v73
  s_lshr_b32 s22, s17, 1
  s_lshl_b32 s22, s22, 8
  s_and_b32 s34, s17, 1
  s_lshl_b32 s34, s34, 3
  s_add_u32 s22, s22, s34
  s_add_u32 s22, s22, 7168
  v_add_u32 v74, s22, v72
  v_lshlrev_b32 v0, 2, v65
  s_and_b32 s22, s17, 31
  s_lshl_b32 s22, s22, 7
  s_add_u32 s22, s22, 21504
  v_add_u32 v0, s22, v0
  v_cndmask_b32 v1, v74, v73, s[38:39]
  s_lshl_b32 s36, s17, 2
  s_add_u32 s36, s36, 17408
  s_mov_b32 s37, 0x3e800000
  v_mov_b32 v64, 0
  v_mov_b32 v65, 0
  v_mov_b32 v66, 0
  v_mov_b32 v67, 0
  v_mov_b32 v68, 0
  v_mov_b32 v69, 0
  v_mov_b32 v70, 0
  v_mov_b32 v71, 0
  v_mov_b32 v72, 0
  v_mov_b32 v73, 0
  v_mov_b32 v74, 0
  v_mov_b32 v75, 0
  v_mov_b32 v76, 0
  v_mov_b32 v77, 0
  v_mov_b32 v78, 0
  v_mov_b32 v79, 0
  v_mov_b32 v80, 0
  v_mov_b32 v81, 0
  v_mov_b32 v82, 0
  v_mov_b32 v83, 0
  v_mov_b32 v84, 0
  v_mov_b32 v85, 0
  v_mov_b32 v86, 0
  v_mov_b32 v87, 0
  v_mov_b32 v88, 0
  v_mov_b32 v89, 0
  v_mov_b32 v90, 0
  v_mov_b32 v91, 0
  v_mov_b32 v92, 0
  v_mov_b32 v93, 0
  v_mov_b32 v94, 0
  v_mov_b32 v95, 0
  v_mov_b32 v96, 0
  v_mov_b32 v97, 0
  v_mov_b32 v98, 0
  v_mov_b32 v99, 0
  v_mov_b32 v100, 0
  v_mov_b32 v101, 0
  v_mov_b32 v102, 0
  v_mov_b32 v103, 0
  v_mov_b32 v104, 0
  v_mov_b32 v105, 0
  v_mov_b32 v106, 0
  v_mov_b32 v107, 0
  v_mov_b32 v108, 0
  v_mov_b32 v109, 0
  v_mov_b32 v110, 0
  v_mov_b32 v111, 0
  v_and_b32 v118, 1, v116
  v_cmp_eq_u32 vcc, 0, v118
  v_mov_b32 v118, 12288
  v_mov_b32 v119, 8192
  v_cndmask_b32 v118, v118, v119, vcc
  v_lshrrev_b32 v116, 1, v116
  v_lshl_add_u32 v118, v116, 9, v118
  v_lshl_add_u32 v117, v117, 4, v118
  s_mov_b32 s57, 28672
  s_mov_b32 s56, 0x42800000
  v_mov_b32 v116, v2
  s_mul_i32 s35, s17, 1835008
  s_add_u32 s35, s35, 42262528
  s_mov_b32 s30, 0
  v_mov_b32 v36, 0
ch_md0:
  buffer_load_dword v37, v36, s[12:15], 0 offen sc1
  s_waitcnt vmcnt(0)
  v_readfirstlane_b32 s22, v37
  s_and_b32 s31, s22, 0xffff
  s_cmp_ge_u32 s31, 32
  s_cbranch_scc1 ch_go0
  s_sleep 2
  s_add_u32 s30, s30, 1
  s_cmp_lt_u32 s30, 50000
  s_cbranch_scc1 ch_md0
  s_branch ch_end
ch_go0:
  s_mov_b32 s31, 0
  s_lshr_b32 s22, s22, 16
  s_cmp_lg_u32 s22, 0
  s_cbranch_scc1 cB_sc0_loop
  s_branch cA_sc0_loop
ch_init1:
  s_mul_i32 s31, s17, 401408
  s_add_u32 s31, s31, 0
  s_add_u32 s22, s31, 258048
  buffer_load_dwordx4 a[224:227], v2, s[8:11], s22 offen offset:0 sc1
  buffer_load_dwordx4 a[228:231], v2, s[8:11], s22 offen offset:1024 sc1
  buffer_load_dwordx4 a[232:235], v2, s[8:11], s22 offen offset:2048 sc1
  buffer_load_dwordx4 a[236:239], v2, s[8:11], s22 offen offset:3072 sc1
  s_add_u32 s22, s31, 262144
  buffer_load_dwordx4 a[240:243], v2, s[8:11], s22 offen offset:0 sc1
  buffer_load_dwordx4 a[244:247], v2, s[8:11], s22 offen offset:1024 sc1
  buffer_load_dwordx4 a[248:251], v2, s[8:11], s22 offen offset:2048 sc1
  buffer_load_dwordx4 a[252:255], v2, s[8:11], s22 offen offset:3072 sc1
  s_add_u32 s22, s31, 266240
  buffer_load_dwordx4 v[120:123], v2, s[8:11], s22 offen offset:0 sc1
  buffer_load_dwordx4 v[124:127], v2, s[8:11], s22 offen offset:1024 sc1
  buffer_load_dwordx4 v[128:131], v2, s[8:11], s22 offen offset:2048 sc1
  buffer_load_dwordx4 v[132:135], v2, s[8:11], s22 offen offset:3072 sc1
  s_add_u32 s22, s31, 270336
  buffer_load_dwordx4 v[136:139], v2, s[8:11], s22 offen offset:0 sc1
  buffer_load_dwordx4 v[140:143], v2, s[8:11], s22 offen offset:1024 sc1
  buffer_load_dwordx4 v[144:147], v2, s[8:11], s22 offen offset:2048 sc1
  buffer_load_dwordx4 v[148:151], v2, s[8:11], s22 offen offset:3072 sc1
  s_add_u32 s22, s31, 274432
  buffer_load_dwordx4 v[152:155], v2, s[8:11], s22 offen offset:0 sc1
  buffer_load_dwordx4 v[156:159], v2, s[8:11], s22 offen offset:1024 sc1
  buffer_load_dwordx4 v[160:163], v2, s[8:11], s22 offen offset:2048 sc1
  buffer_load_dwordx4 v[164:167], v2, s[8:11], s22 offen offset:3072 sc1
  s_add_u32 s22, s31, 278528
  buffer_load_dwordx4 v[168:171], v2, s[8:11], s22 offen offset:0 sc1
  buffer_load_dwordx4 v[172:175], v2, s[8:11], s22 offen offset:1024 sc1
  buffer_load_dwordx4 v[176:179], v2, s[8:11], s22 offen offset:2048 sc1
  buffer_load_dwordx4 v[180:183], v2, s[8:11], s22 offen offset:3072 sc1
  s_add_u32 s22, s31, 282624
  buffer_load_dwordx4 v[184:187], v2, s[8:11], s22 offen offset:0 sc1
  buffer_load_dwordx4 v[188:191], v2, s[8:11], s22 offen offset:1024 sc1
  buffer_load_dwordx4 v[192:195], v2, s[8:11], s22 offen offset:2048 sc1
  buffer_load_dwordx4 v[196:199], v2, s[8:11], s22 offen offset:3072 sc1
  s_add_u32 s22, s31, 356352
  buffer_load_dwordx4 v[200:203], v2, s[8:11], s22 offen offset:2048 sc1
  buffer_load_dwordx4 v[204:207], v2, s[8:11], s22 offen offset:3072 sc1
  s_add_u32 s22, s31, 360448
  buffer_load_dwordx4 v[208:211], v2, s[8:11], s22 offen offset:0 sc1
  buffer_load_dwordx4 v[212:215], v2, s[8:11], s22 offen offset:1024 sc1
  s_waitcnt vmcnt(24)
  buffer_load_dwordx4 v[216:219], v2, s[8:11], s22 offen offset:2048 sc1
  buffer_load_dwordx4 v[220:223], v2, s[8:11], s22 offen offset:3072 sc1
  s_add_u32 s22, s31, 364544
  buffer_load_dwordx4 v[224:227], v2, s[8:11], s22 offen offset:0 sc1
  buffer_load_dwordx4 v[228:231], v2, s[8:11], s22 offen offset:1024 sc1
  buffer_load_dwordx4 v[232:235], v2, s[8:11], s22 offen offset:2048 sc1
  buffer_load_dwordx4 v[236:239], v2, s[8:11], s22 offen offset:3072 sc1
  s_add_u32 s22, s31, 368640
  buffer_load_dwordx4 v[240:243], v2, s[8:11], s22 offen offset:0 sc1
  buffer_load_dwordx4 v[244:247], v2, s[8:11], s22 offen offset:1024 sc1
  buffer_load_dwordx4 v[248:251], v2, s[8:11], s22 offen offset:2048 sc1
  buffer_load_dwordx4 v[252:255], v2, s[8:11], s22 offen offset:3072 sc1
  s_mov_b32 s24, 71572480
  s_mov_b32 s25, 0
  s_add_u32 m0, s25, 7168
  s_nop 0
  buffer_load_dwordx4 v2, s[8:11], s24 offen offset:0 sc1 lds
  buffer_load_dwordx4 v2, s[8:11], s24 offen offset:1024 sc1 lds
  buffer_load_dwordx4 v2, s[8:11], s24 offen offset:2048 sc1 lds
  buffer_load_dwordx4 v2, s[8:11], s24 offen offset:3072 sc1 lds
  s_add_u32 m0, s25, 11264
  s_add_u32 s22, s24, 4096
  buffer_load_dwordx4 v2, s[8:11], s22 offen offset:0 sc1 lds
  buffer_load_dwordx4 v2, s[8:11], s22 offen offset:1024 sc1 lds
  buffer_load_dwordx4 v2, s[8:11], s22 offen offset:2048 sc1 lds
  v_and_b32 v64, 7, v117
  v_and_b32 v65, 1, v116
  v_lshlrev_b32 v65, 2, v65
  v_sub_u32 v64, v64, v65
  v_lshrrev_b32 v65, 3, v117
  v_lshl_add_u32 v66, v65, 2, v64
  v_cmp_gt_u32 vcc, 4, v64
  v_mov_b32 v67, 99
  s_nop 0
  v_cndmask_b32 v66, v67, v66, vcc
  v_mov_b32 v68, 0x3f80
  v_mov_b32 v69, 0x3f800000
  v_mov_b32 v4, 0
  v_cmp_eq_u32 vcc, 0, v66
  s_nop 1
  v_cndmask_b32 v4, v4, v68, vcc
  v_cmp_eq_u32 vcc, 1, v66
  s_nop 1
  v_cndmask_b32 v4, v4, v69, vcc
  v_mov_b32 v5, 0
  v_cmp_eq_u32 vcc, 2, v66
  s_nop 1
  v_cndmask_b32 v5, v5, v68, vcc
  v_cmp_eq_u32 vcc, 3, v66
  s_nop 1
  v_cndmask_b32 v5, v5, v69, vcc
  v_mov_b32 v6, 0
  v_cmp_eq_u32 vcc, 4, v66
  s_nop 1
  v_cndmask_b32 v6, v6, v68, vcc
  v_cmp_eq_u32 vcc, 5, v66
  s_nop 1
  v_cndmask_b32 v6, v6, v69, vcc
  v_mov_b32 v7, 0
  v_cmp_eq_u32 vcc, 6, v66
  s_nop 1
  v_cndmask_b32 v7, v7, v68, vcc
  v_cmp_eq_u32 vcc, 7, v66
  s_nop 1
  v_cndmask_b32 v7, v7, v69, vcc
  v_lshrrev_b32 v64, 1, v116
  v_lshrrev_b32 v65, 3, v117
  v_cmp_eq_u32 s[26:27], v64, v65
  v_and_b32 v66, 1, v116
  v_add_u32 v64, 2, v64
  v_lshrrev_b32 v67, 1, v116
  v_lshlrev_b32 v67, 8, v67
  v_lshl_add_u32 v67, v66, 9, v67
  v_lshl_add_u32 v67, v117, 4, v67
  v_add_u32 v112, 58368, v67
  v_and_b32 v68, 7, v117
  v_lshlrev_b32 v67, 8, v64
  v_lshl_add_u32 v67, v68, 5, v67
  v_lshl_add_u32 v67, v66, 4, v67
  v_add_u32 v113, 65536, v67
  v_lshrrev_b32 v64, 5, v1
  v_and_b32 v65, 31, v1
  v_lshrrev_b32 v66, 3, v65
  v_and_b32 v67, 7, v65
  v_and_b32 v68, 3, v67
  v_lshl_add_u32 v68, v66, 2, v68
  v_lshrrev_b32 v69, 2, v67
  v_lshl_add_u32 v68, v69, 4, v68
  v_lshlrev_b32 v69, 11, v64
  v_lshl_add_u32 v69, v68, 4, v69
  v_add_u32 v114, 57352, v69
  v_add_u32 v70, 2, v64
  v_lshlrev_b32 v69, 9, v66
  v_lshl_add_u32 v69, v70, 5, v69
  v_lshl_add_u32 v69, v67, 2, v69
  v_add_u32 v115, 65536, v69
  v_and_b32 v71, 1, v1
  v_cmp_eq_u32 s[38:39], 0, v71
  v_cmp_gt_u32 vcc, 8, v65
  s_or_b64 s[28:29], s[38:39], vcc
  v_lshrrev_b32 v72, 1, v67
  v_lshlrev_b32 v72, 2, v72
  v_lshl_add_u32 v72, v70, 4, v72
  s_lshl_b32 s22, s17, 9
  s_add_u32 s22, s22, 9216
  v_lshl_add_u32 v73, v66, 7, v72
  v_add_u32 v73, s22, v73
  s_lshl_b32 s22, s17, 7
  s_add_u32 s22, s22, 7168
  v_add_u32 v74, s22, v72
  v_bfe_u32 v72, v65, 1, 1
  v_lshlrev_b32 v72, 7, v72
  v_lshl_add_u32 v72, v70, 4, v72
  v_bfe_u32 v73, v65, 2, 2
  v_lshl_add_u32 v72, v73, 2, v72
  v_lshrrev_b32 v73, 4, v65
  v_lshl_add_u32 v73, v73, 8, v72
  s_lshl_b32 s22, s17, 9
  s_add_u32 s22, s22, 9216
  v_add_u32 v73, s22, v73
  s_lshr_b32 s22, s17, 1
  s_lshl_b32 s22, s22, 8
  s_and_b32 s34, s17, 1
  s_lshl_b32 s34, s34, 3
  s_add_u32 s22, s22, s34
  s_add_u32 s22, s22, 7168
  v_add_u32 v74, s22, v72
  v_lshlrev_b32 v0, 2, v65
  s_and_b32 s22, s17, 31
  s_lshl_b32 s22, s22, 7
  s_add_u32 s22, s22, 21504
  v_add_u32 v0, s22, v0
  v_cndmask_b32 v1, v74, v73, s[38:39]
  s_lshl_b32 s36, s17, 2
  s_add_u32 s36, s36, 17408
  s_mov_b32 s37, 0x3e800000
  v_mov_b32 v64, 0
  v_mov_b32 v65, 0
  v_mov_b32 v66, 0
  v_mov_b32 v67, 0
  v_mov_b32 v68, 0
  v_mov_b32 v69, 0
  v_mov_b32 v70, 0
  v_mov_b32 v71, 0
  v_mov_b32 v72, 0
  v_mov_b32 v73, 0
  v_mov_b32 v74, 0
  v_mov_b32 v75, 0
  v_mov_b32 v76, 0
  v_mov_b32 v77, 0
  v_mov_b32 v78, 0
  v_mov_b32 v79, 0
  v_mov_b32 v80, 0
  v_mov_b32 v81, 0
  v_mov_b32 v82, 0
  v_mov_b32 v83, 0
  v_mov_b32 v84, 0
  v_mov_b32 v85, 0
  v_mov_b32 v86, 0
  v_mov_b32 v87, 0
  v_mov_b32 v88, 0
  v_mov_b32 v89, 0
  v_mov_b32 v90, 0
  v_mov_b32 v91, 0
  v_mov_b32 v92, 0
  v_mov_b32 v93, 0
  v_mov_b32 v94, 0
  v_mov_b32 v95, 0
  v_mov_b32 v96, 0
  v_mov_b32 v97, 0
  v_mov_b32 v98, 0
  v_mov_b32 v99, 0
  v_mov_b32 v100, 0
  v_mov_b32 v101, 0
  v_mov_b32 v102, 0
  v_mov_b32 v103, 0
  v_mov_b32 v104, 0
  v_mov_b32 v105, 0
  v_mov_b32 v106, 0
  v_mov_b32 v107, 0
  v_mov_b32 v108, 0
  v_mov_b32 v109, 0
  v_mov_b32 v110, 0
  v_mov_b32 v111, 0
  v_and_b32 v118, 1, v116
  v_cmp_eq_u32 vcc, 0, v118
  v_mov_b32 v118, 12288
  v_mov_b32 v119, 8448
  v_cndmask_b32 v118, v118, v119, vcc
  v_lshrrev_b32 v116, 1, v116
  v_lshl_add_u32 v118, v116, 9, v118
  v_lshl_add_u32 v117, v117, 4, v118
  s_mov_b32 s57, 28672
  s_mov_b32 s56, 0x42800000
  v_mov_b32 v116, v2
  v_lshrrev_b32 v0, 4, v2
  v_min_u32 v0, 12, v0
  s_mul_i32 s22, s17, 13
  v_add_u32 v0, s22, v0
  v_lshlrev_b32 v0, 7, v0
  v_add_u32 v0, 51200, v0
  s_mov_b32 s22, 75209728
  buffer_load_dword v119, v0, s[8:11], s22 offen sc1
  s_mov_b32 s22, 75184128
  buffer_load_dword v119, v0, s[8:11], s22 offen sc1
  s_mul_i32 s35, s17, 1835008
  s_add_u32 s35, s35, 42269696
  s_mov_b32 s30, 0
  v_mov_b32 v36, 0
ch_md1:
  buffer_load_dword v37, v36, s[12:15], 0 offen sc1
  s_waitcnt vmcnt(0)
  v_readfirstlane_b32 s22, v37
  s_and_b32 s31, s22, 0xffff
  s_cmp_ge_u32 s31, 32
  s_cbranch_scc1 ch_go1
  s_sleep 2
  s_add_u32 s30, s30, 1
  s_cmp_lt_u32 s30, 50000
  s_cbranch_scc1 ch_md1
  s_branch ch_end
ch_go1:
  s_mov_b32 s31, 0
  s_lshr_b32 s22, s22, 16
  s_cmp_lg_u32 s22, 0
  s_cbranch_scc1 cB_sc1_loop
  s_branch cA_sc1_loop
ch_init2:
  s_mul_i32 s31, s17, 401408
  s_add_u32 s31, s31, 0
  s_add_u32 s22, s31, 286720
  buffer_load_dwordx4 a[224:227], v2, s[8:11], s22 offen offset:0 sc1
  buffer_load_dwordx4 a[228:231], v2, s[8:11], s22 offen offset:1024 sc1
  buffer_load_dwordx4 a[232:235], v2, s[8:11], s22 offen offset:2048 sc1
  buffer_load_dwordx4 a[236:239], v2, s[8:11], s22 offen offset:3072 sc1
  s_add_u32 s22, s31, 290816
  buffer_load_dwordx4 a[240:243], v2, s[8:11], s22 offen offset:0 sc1
  buffer_load_dwordx4 a[244:247], v2, s[8:11], s22 offen offset:1024 sc1
  buffer_load_dwordx4 a[248:251], v2, s[8:11], s22 offen offset:2048 sc1
  buffer_load_dwordx4 a[252:255], v2, s[8:11], s22 offen offset:3072 sc1
  s_add_u32 s22, s31, 294912
  buffer_load_dwordx4 v[120:123], v2, s[8:11], s22 offen offset:0 sc1
  buffer_load_dwordx4 v[124:127], v2, s[8:11], s22 offen offset:1024 sc1
  buffer_load_dwordx4 v[128:131], v2, s[8:11], s22 offen offset:2048 sc1
  buffer_load_dwordx4 v[132:135], v2, s[8:11], s22 offen offset:3072 sc1
  s_add_u32 s22, s31, 299008
  buffer_load_dwordx4 v[136:139], v2, s[8:11], s22 offen offset:0 sc1
  buffer_load_dwordx4 v[140:143], v2, s[8:11], s22 offen offset:1024 sc1
  buffer_load_dwordx4 v[144:147], v2, s[8:11], s22 offen offset:2048 sc1
  buffer_load_dwordx4 v[148:151], v2, s[8:11], s22 offen offset:3072 sc1
  s_add_u32 s22, s31, 303104
  buffer_load_dwordx4 v[152:155], v2, s[8:11], s22 offen offset:0 sc1
  buffer_load_dwordx4 v[156:159], v2, s[8:11], s22 offen offset:1024 sc1
  buffer_load_dwordx4 v[160:163], v2, s[8:11], s22 offen offset:2048 sc1
  buffer_load_dwordx4 v[164:167], v2, s[8:11], s22 offen offset:3072 sc1
  s_add_u32 s22, s31, 307200
  buffer_load_dwordx4 v[168:171], v2, s[8:11], s22 offen offset:0 sc1
  buffer_load_dwordx4 v[172:175], v2, s[8:11], s22 offen offset:1024 sc1
  buffer_load_dwordx4 v[176:179], v2, s[8:11], s22 offen offset:2048 sc1
  buffer_load_dwordx4 v[180:183], v2, s[8:11], s22 offen offset:3072 sc1
  s_add_u32 s22, s31, 311296
  buffer_load_dwordx4 v[184:187], v2, s[8:11], s22 offen offset:0 sc1
  buffer_load_dwordx4 v[188:191], v2, s[8:11], s22 offen offset:1024 sc1
  buffer_load_dwordx4 v[192:195], v2, s[8:11], s22 offen offset:2048 sc1
  buffer_load_dwordx4 v[196:199], v2, s[8:11], s22 offen offset:3072 sc1
  s_add_u32 s22, s31, 372736
  buffer_load_dwordx4 v[200:203], v2, s[8:11], s22 offen offset:0 sc1
  buffer_load_dwordx4 v[204:207], v2, s[8:11], s22 offen offset:1024 sc1
  buffer_load_dwordx4 v[208:211], v2, s[8:11], s22 offen offset:2048 sc1
  buffer_load_dwordx4 v[212:215], v2, s[8:11], s22 offen offset:3072 sc1
  s_waitcnt vmcnt(24)
  s_add_u32 s22, s31, 376832
  buffer_load_dwordx4 v[216:219], v2, s[8:11], s22 offen offset:0 sc1
  buffer_load_dwordx4 v[220:223], v2, s[8:11], s22 offen offset:1024 sc1
  buffer_load_dwordx4 v[224:227], v2, s[8:11], s22 offen offset:2048 sc1
  buffer_load_dwordx4 v[228:231], v2, s[8:11], s22 offen offset:3072 sc1
  s_add_u32 s22, s31, 380928
  buffer_load_dwordx4 v[232:235], v2, s[8:11], s22 offen offset:0 sc1
  buffer_load_dwordx4 v[236:239], v2, s[8:11], s22 offen offset:1024 sc1
  buffer_load_dwordx4 v[240:243], v2, s[8:11], s22 offen offset:2048 sc1
  buffer_load_dwordx4 v[244:247], v2, s[8:11], s22 offen offset:3072 sc1
  s_add_u32 s22, s31, 385024
  buffer_load_dwordx4 v[248:251], v2, s[8:11], s22 offen offset:0 sc1
  buffer_load_dwordx4 v[252:255], v2, s[8:11], s22 offen offset:1024 sc1
  s_mov_b32 s24, 71579648
  s_mov_b32 s25, 0
  s_add_u32 m0, s25, 14336
  s_nop 0
  buffer_load_dwordx4 v2, s[8:11], s24 offen offset:0 sc1 lds
  buffer_load_dwordx4 v2, s[8:11], s24 offen offset:1024 sc1 lds
  buffer_load_dwordx4 v2, s[8:11], s24 offen offset:2048 sc1 lds
  buffer_load_dwordx4 v2, s[8:11], s24 offen offset:3072 sc1 lds
  s_add_u32 m0, s25, 18432
  s_add_u32 s22, s24, 4096
  buffer_load_dwordx4 v2, s[8:11], s22 offen offset:0 sc1 lds
  buffer_load_dwordx4 v2, s[8:11], s22 offen offset:1024 sc1 lds
  buffer_load_dwordx4 v2, s[8:11], s22 offen offset:2048 sc1 lds
  v_and_b32 v64, 7, v117
  v_and_b32 v65, 1, v116
  v_lshlrev_b32 v65, 2, v65
  v_sub_u32 v64, v64, v65
  v_lshrrev_b32 v65, 3, v117
  v_lshl_add_u32 v66, v65, 2, v64
  v_cmp_gt_u32 vcc, 4, v64
  v_mov_b32 v67, 99
  s_nop 0
  v_cndmask_b32 v66, v67, v66, vcc
  v_mov_b32 v68, 0x3f80
  v_mov_b32 v69, 0x3f800000
  v_mov_b32 v4, 0
  v_cmp_eq_u32 vcc, 0, v66
  s_nop 1
  v_cndmask_b32 v4, v4, v68, vcc
  v_cmp_eq_u32 vcc, 1, v66
  s_nop 1
  v_cndmask_b32 v4, v4, v69, vcc
  v_mov_b32 v5, 0
  v_cmp_eq_u32 vcc, 2, v66
  s_nop 1
  v_cndmask_b32 v5, v5, v68, vcc
  v_cmp_eq_u32 vcc, 3, v66
  s_nop 1
  v_cndmask_b32 v5, v5, v69, vcc
  v_mov_b32 v6, 0
  v_cmp_eq_u32 vcc, 4, v66
  s_nop 1
  v_cndmask_b32 v6, v6, v68, vcc
  v_cmp_eq_u32 vcc, 5, v66
  s_nop 1
  v_cndmask_b32 v6, v6, v69, vcc
  v_mov_b32 v7, 0
  v_cmp_eq_u32 vcc, 6, v66
  s_nop 1
  v_cndmask_b32 v7, v7, v68, vcc
  v_cmp_eq_u32 vcc, 7, v66
  s_nop 1
  v_cndmask_b32 v7, v7, v69, vcc
  v_lshrrev_b32 v64, 1, v116
  v_lshrrev_b32 v65, 3, v117
  v_cmp_eq_u32 s[26:27], v64, v65
  v_and_b32 v66, 1, v116
  v_add_u32 v64, 4, v64
  v_lshrrev_b32 v67, 1, v116
  v_lshlrev_b32 v67, 8, v67
  v_lshl_add_u32 v67, v66, 9, v67
  v_lshl_add_u32 v67, v117, 4, v67
  v_add_u32 v112, 59392, v67
  v_and_b32 v68, 7, v117
  v_lshlrev_b32 v67, 8, v64
  v_lshl_add_u32 v67, v68, 5, v67
  v_lshl_add_u32 v67, v66, 4, v67
  v_add_u32 v113, 65536, v67
  v_lshrrev_b32 v64, 5, v1
  v_and_b32 v65, 31, v1
  v_lshrrev_b32 v66, 3, v65
  v_and_b32 v67, 7, v65
  v_and_b32 v68, 3, v67
  v_lshl_add_u32 v68, v66, 2, v68
  v_lshrrev_b32 v69, 2, v67
  v_lshl_add_u32 v68, v69, 4, v68
  v_lshlrev_b32 v69, 11, v64
  v_lshl_add_u32 v69, v68, 4, v69
  v_add_u32 v114, 57856, v69
  v_add_u32 v70, 4, v64
  v_lshlrev_b32 v69, 9, v66
  v_lshl_add_u32 v69, v70, 5, v69
  v_lshl_add_u32 v69, v67, 2, v69
  v_add_u32 v115, 65536, v69
  v_and_b32 v71, 1, v1
  v_cmp_eq_u32 s[38:39], 0, v71
  v_cmp_gt_u32 vcc, 8, v65
  s_or_b64 s[28:29], s[38:39], vcc
  v_lshrrev_b32 v72, 1, v67
  v_lshlrev_b32 v72, 2, v72
  v_lshl_add_u32 v72, v70, 4, v72
  s_lshl_b32 s22, s17, 9
  s_add_u32 s22, s22, 9216
  v_lshl_add_u32 v73, v66, 7, v72
  v_add_u32 v73, s22, v73
  s_lshl_b32 s22, s17, 7
  s_add_u32 s22, s22, 7168
  v_add_u32 v74, s22, v72
  v_bfe_u32 v72, v65, 1, 1
  v_lshlrev_b32 v72, 7, v72
  v_lshl_add_u32 v72, v70, 4, v72
  v_bfe_u32 v73, v65, 2, 2
  v_lshl_add_u32 v72, v73, 2, v72
  v_lshrrev_b32 v73, 4, v65
  v_lshl_add_u32 v73, v73, 8, v72
  s_lshl_b32 s22, s17, 9
  s_add_u32 s22, s22, 9216
  v_add_u32 v73, s22, v73
  s_lshr_b32 s22, s17, 1
  s_lshl_b32 s22, s22, 8
  s_and_b32 s34, s17, 1
  s_lshl_b32 s34, s34, 3
  s_add_u32 s22, s22, s34
  s_add_u32 s22, s22, 7168
  v_add_u32 v74, s22, v72
  v_lshlrev_b32 v0, 2, v65
  s_and_b32 s22, s17, 31
  s_lshl_b32 s22, s22, 7
  s_add_u32 s22, s22, 21504
  v_add_u32 v0, s22, v0
  v_cndmask_b32 v1, v74, v73, s[38:39]
  s_lshl_b32 s36, s17, 2
  s_add_u32 s36, s36, 17408
  s_mov_b32 s37, 0x3e800000
  v_mov_b32 v64, 0
  v_mov_b32 v65, 0
  v_mov_b32 v66, 0
  v_mov_b32 v67, 0
  v_mov_b32 v68, 0
  v_mov_b32 v69, 0
  v_mov_b32 v70, 0
  v_mov_b32 v71, 0
  v_mov_b32 v72, 0
  v_mov_b32 v73, 0
  v_mov_b32 v74, 0
  v_mov_b32 v75, 0
  v_mov_b32 v76, 0
  v_mov_b32 v77, 0
  v_mov_b32 v78, 0
  v_mov_b32 v79, 0
  v_mov_b32 v80, 0
  v_mov_b32 v81, 0
  v_mov_b32 v82, 0
  v_mov_b32 v83, 0
  v_mov_b32 v84, 0
  v_mov_b32 v85, 0
  v_mov_b32 v86, 0
  v_mov_b32 v87, 0
  v_mov_b32 v88, 0
  v_mov_b32 v89, 0
  v_mov_b32 v90, 0
  v_mov_b32 v91, 0
  v_mov_b32 v92, 0
  v_mov_b32 v93, 0
  v_mov_b32 v94, 0
  v_mov_b32 v95, 0
  v_mov_b32 v96, 0
  v_mov_b32 v97, 0
  v_mov_b32 v98, 0
  v_mov_b32 v99, 0
  v_mov_b32 v100, 0
  v_mov_b32 v101, 0
  v_mov_b32 v102, 0
  v_mov_b32 v103, 0
  v_mov_b32 v104, 0
  v_mov_b32 v105, 0
  v_mov_b32 v106, 0
  v_mov_b32 v107, 0
  v_mov_b32 v108, 0
  v_mov_b32 v109, 0
  v_mov_b32 v110, 0
  v_mov_b32 v111, 0
  v_and_b32 v118, 1, v116
  v_cmp_eq_u32 vcc, 0, v118
  v_mov_b32 v118, 12544
  v_mov_b32 v119, 10240
  v_cndmask_b32 v118, v118, v119, vcc
  v_lshrrev_b32 v116, 1, v116
  v_lshl_add_u32 v118, v116, 9, v118
  v_lshl_add_u32 v117, v117, 4, v118
  s_mov_b32 s57, 28672
  s_mov_b32 s56, 0x42800000
  v_mov_b32 v116, v2
  v_lshrrev_b32 v0, 4, v2
  v_min_u32 v0, 13, v0
  s_mul_i32 s22, s17, 14
  v_add_u32 v0, s22, v0
  v_lshlrev_b32 v0, 7, v0
  v_add_u32 v0, 43008, v0
  s_mov_b32 s22, 71550976
  buffer_load_dword v119, v0, s[8:11], s22 offen sc1
  s_mov_b32 s22, 71522304
  buffer_load_dword v119, v0, s[8:11], s22 offen sc1
  s_mul_i32 s35, s17, 1835008
  s_add_u32 s35, s35, 42276864
  s_mov_b32 s30, 0
  v_mov_b32 v36, 0
ch_md2:
  buffer_load_dword v37, v36, s[12:15], 0 offen sc1
  s_waitcnt vmcnt(0)
  v_readfirstlane_b32 s22, v37
  s_and_b32 s31, s22, 0xffff
  s_cmp_ge_u32 s31, 32
  s_cbranch_scc1 ch_go2
  s_sleep 2
  s_add_u32 s30, s30, 1
  s_cmp_lt_u32 s30, 50000
  s_cbranch_scc1 ch_md2
  s_branch ch_end
ch_go2:
  s_mov_b32 s31, 0
  s_lshr_b32 s22, s22, 16
  s_cmp_lg_u32 s22, 0
  s_cbranch_scc1 cB_sc2_loop
  s_branch cA_sc2_loop
ch_init3:
  s_mul_i32 s31, s17, 401408
  s_add_u32 s31, s31, 0
  s_add_u32 s22, s31, 315392
  buffer_load_dwordx4 a[224:227], v2, s[8:11], s22 offen offset:0 sc1
  buffer_load_dwordx4 a[228:231], v2, s[8:11], s22 offen offset:1024 sc1
  buffer_load_dwordx4 a[232:235], v2, s[8:11], s22 offen offset:2048 sc1
  buffer_load_dwordx4 a[236:239], v2, s[8:11], s22 offen offset:3072 sc1
  s_add_u32 s22, s31, 319488
  buffer_load_dwordx4 a[240:243], v2, s[8:11], s22 offen offset:0 sc1
  buffer_load_dwordx4 a[244:247], v2, s[8:11], s22 offen offset:1024 sc1
  buffer_load_dwordx4 a[248:251], v2, s[8:11], s22 offen offset:2048 sc1
  buffer_load_dwordx4 a[252:255], v2, s[8:11], s22 offen offset:3072 sc1
  s_add_u32 s22, s31, 323584
  buffer_load_dwordx4 v[120:123], v2, s[8:11], s22 offen offset:0 sc1
  buffer_load_dwordx4 v[124:127], v2, s[8:11], s22 offen offset:1024 sc1
  buffer_load_dwordx4 v[128:131], v2, s[8:11], s22 offen offset:2048 sc1
  buffer_load_dwordx4 v[132:135], v2, s[8:11], s22 offen offset:3072 sc1
  s_add_u32 s22, s31, 327680
  buffer_load_dwordx4 v[136:139], v2, s[8:11], s22 offen offset:0 sc1
  buffer_load_dwordx4 v[140:143], v2, s[8:11], s22 offen offset:1024 sc1
  buffer_load_dwordx4 v[144:147], v2, s[8:11], s22 offen offset:2048 sc1
  buffer_load_dwordx4 v[148:151], v2, s[8:11], s22 offen offset:3072 sc1
  s_add_u32 s22, s31, 331776
  buffer_load_dwordx4 v[152:155], v2, s[8:11], s22 offen offset:0 sc1
  buffer_load_dwordx4 v[156:159], v2, s[8:11], s22 offen offset:1024 sc1
  buffer_load_dwordx4 v[160:163], v2, s[8:11], s22 offen offset:2048 sc1
  buffer_load_dwordx4 v[164:167], v2, s[8:11], s22 offen offset:3072 sc1
  s_add_u32 s22, s31, 335872
  buffer_load_dwordx4 v[168:171], v2, s[8:11], s22 offen offset:0 sc1
  buffer_load_dwordx4 v[172:175], v2, s[8:11], s22 offen offset:1024 sc1
  buffer_load_dwordx4 v[176:179], v2, s[8:11], s22 offen offset:2048 sc1
  buffer_load_dwordx4 v[180:183], v2, s[8:11], s22 offen offset:3072 sc1
  s_add_u32 s22, s31, 339968
  buffer_load_dwordx4 v[184:187], v2, s[8:11], s22 offen offset:0 sc1
  buffer_load_dwordx4 v[188:191], v2, s[8:11], s22 offen offset:1024 sc1
  buffer_load_dwordx4 v[192:195], v2, s[8:11], s22 offen offset:2048 sc1
  buffer_load_dwordx4 v[196:199], v2, s[8:11], s22 offen offset:3072 sc1
  s_add_u32 s22, s31, 385024
  buffer_load_dwordx4 v[200:203], v2, s[8:11], s22 offen offset:2048 sc1
  buffer_load_dwordx4 v[204:207], v2, s[8:11], s22 offen offset:3072 sc1
  s_add_u32 s22, s31, 389120
  buffer_load_dwordx4 v[208:211], v2, s[8:11], s22 offen offset:0 sc1
  buffer_load_dwordx4 v[212:215], v2, s[8:11], s22 offen offset:1024 sc1
  s_waitcnt vmcnt(24)
  buffer_load_dwordx4 v[216:219], v2, s[8:11], s22 offen offset:2048 sc1
  buffer_load_dwordx4 v[220:223], v2, s[8:11], s22 offen offset:3072 sc1
  s_add_u32 s22, s31, 393216
  buffer_load_dwordx4 v[224:227], v2, s[8:11], s22 offen offset:0 sc1
  buffer_load_dwordx4 v[228:231], v2, s[8:11], s22 offen offset:1024 sc1
  buffer_load_dwordx4 v[232:235], v2, s[8:11], s22 offen offset:2048 sc1
  buffer_load_dwordx4 v[236:239], v2, s[8:11], s22 offen offset:3072 sc1
  s_add_u32 s22, s31, 397312
  buffer_load_dwordx4 v[240:243], v2, s[8:11], s22 offen offset:0 sc1
  buffer_load_dwordx4 v[244:247], v2, s[8:11], s22 offen offset:1024 sc1
  buffer_load_dwordx4 v[248:251], v2, s[8:11], s22 offen offset:2048 sc1
  buffer_load_dwordx4 v[252:255], v2, s[8:11], s22 offen offset:3072 sc1
  s_mov_b32 s24, 71586816
  s_mov_b32 s25, 0
  s_add_u32 m0, s25, 21504
  s_nop 0
  buffer_load_dwordx4 v2, s[8:11], s24 offen offset:0 sc1 lds
  buffer_load_dwordx4 v2, s[8:11], s24 offen offset:1024 sc1 lds
  buffer_load_dwordx4 v2, s[8:11], s24 offen offset:2048 sc1 lds
  buffer_load_dwordx4 v2, s[8:11], s24 offen offset:3072 sc1 lds
  s_add_u32 m0, s25, 25600
  s_add_u32 s22, s24, 4096
  buffer_load_dwordx4 v2, s[8:11], s22 offen offset:0 sc1 lds
  buffer_load_dwordx4 v2, s[8:11], s22 offen offset:1024 sc1 lds
  buffer_load_dwordx4 v2, s[8:11], s22 offen offset:2048 sc1 lds
  v_and_b32 v64, 7, v117
  v_and_b32 v65, 1, v116
  v_lshlrev_b32 v65, 2, v65
  v_sub_u32 v64, v64, v65
  v_lshrrev_b32 v65, 3, v117
  v_lshl_add_u32 v66, v65, 2, v64
  v_cmp_gt_u32 vcc, 4, v64
  v_mov_b32 v67, 99
  s_nop 0
  v_cndmask_b32 v66, v67, v66, vcc
  v_mov_b32 v68, 0x3f80
  v_mov_b32 v69, 0x3f800000
  v_mov_b32 v4, 0
  v_cmp_eq_u32 vcc, 0, v66
  s_nop 1
  v_cndmask_b32 v4, v4, v68, vcc
  v_cmp_eq_u32 vcc, 1, v66
  s_nop 1
  v_cndmask_b32 v4, v4, v69, vcc
  v_mov_b32 v5, 0
  v_cmp_eq_u32 vcc, 2, v66
  s_nop 1
  v_cndmask_b32 v5, v5, v68, vcc
  v_cmp_eq_u32 vcc, 3, v66
  s_nop 1
  v_cndmask_b32 v5, v5, v69, vcc
  v_mov_b32 v6, 0
  v_cmp_eq_u32 vcc, 4, v66
  s_nop 1
  v_cndmask_b32 v6, v6, v68, vcc
  v_cmp_eq_u32 vcc, 5, v66
  s_nop 1
  v_cndmask_b32 v6, v6, v69, vcc
  v_mov_b32 v7, 0
  v_cmp_eq_u32 vcc, 6, v66
  s_nop 1
  v_cndmask_b32 v7, v7, v68, vcc
  v_cmp_eq_u32 vcc, 7, v66
  s_nop 1
  v_cndmask_b32 v7, v7, v69, vcc
  v_lshrrev_b32 v64, 1, v116
  v_lshrrev_b32 v65, 3, v117
  v_cmp_eq_u32 s[26:27], v64, v65
  v_and_b32 v66, 1, v116
  v_add_u32 v64, 6, v64
  v_lshrrev_b32 v67, 1, v116
  v_lshlrev_b32 v67, 8, v67
  v_lshl_add_u32 v67, v66, 9, v67
  v_lshl_add_u32 v67, v117, 4, v67
  v_add_u32 v112, 60416, v67
  v_and_b32 v68, 7, v117
  v_lshlrev_b32 v67, 8, v64
  v_lshl_add_u32 v67, v68, 5, v67
  v_lshl_add_u32 v67, v66, 4, v67
  v_add_u32 v113, 65536, v67
  v_lshrrev_b32 v64, 5, v1
  v_and_b32 v65, 31, v1
  v_lshrrev_b32 v66, 3, v65
  v_and_b32 v67, 7, v65
  v_and_b32 v68, 3, v67
  v_lshl_add_u32 v68, v66, 2, v68
  v_lshrrev_b32 v69, 2, v67
  v_lshl_add_u32 v68, v69, 4, v68
  v_lshlrev_b32 v69, 11, v64
  v_lshl_add_u32 v69, v68, 4, v69
  v_add_u32 v114, 57864, v69
  v_add_u32 v70, 6, v64
  v_lshlrev_b32 v69, 9, v66
  v_lshl_add_u32 v69, v70, 5, v69
  v_lshl_add_u32 v69, v67, 2, v69
  v_add_u32 v115, 65536, v69
  v_and_b32 v71, 1, v1
  v_cmp_eq_u32 s[38:39], 0, v71
  v_cmp_gt_u32 vcc, 8, v65
  s_or_b64 s[28:29], s[38:39], vcc
  v_lshrrev_b32 v72, 1, v67
  v_lshlrev_b32 v72, 2, v72
  v_lshl_add_u32 v72, v70, 4, v72
  s_lshl_b32 s22, s17, 9
  s_add_u32 s22, s22, 9216
  v_lshl_add_u32 v73, v66, 7, v72
  v_add_u32 v73, s22, v73
  s_lshl_b32 s22, s17, 7
  s_add_u32 s22, s22, 7168
  v_add_u32 v74, s22, v72
  v_bfe_u32 v72, v65, 1, 1
  v_lshlrev_b32 v72, 7, v72
  v_lshl_add_u32 v72, v70, 4, v72
  v_bfe_u32 v73, v65, 2, 2
  v_lshl_add_u32 v72, v73, 2, v72
  v_lshrrev_b32 v73, 4, v65
  v_lshl_add_u32 v73, v73, 8, v72
  s_lshl_b32 s22, s17, 9
  s_add_u32 s22, s22, 9216
  v_add_u32 v73, s22, v73
  s_lshr_b32 s22, s17, 1
  s_lshl_b32 s22, s22, 8
  s_and_b32 s34, s17, 1
  s_lshl_b32 s34, s34, 3
  s_add_u32 s22, s22, s34
  s_add_u32 s22, s22, 7168
  v_add_u32 v74, s22, v72
  v_lshlrev_b32 v0, 2, v65
  s_and_b32 s22, s17, 31
  s_lshl_b32 s22, s22, 7
  s_add_u32 s22, s22, 21504
  v_add_u32 v0, s22, v0
  v_cndmask_b32 v1, v74, v73, s[38:39]
  s_lshl_b32 s36, s17, 2
  s_add_u32 s36, s36, 17408
  s_mov_b32 s37, 0x3e800000
  v_mov_b32 v64, 0
  v_mov_b32 v65, 0
  v_mov_b32 v66, 0
  v_mov_b32 v67, 0
  v_mov_b32 v68, 0
  v_mov_b32 v69, 0
  v_mov_b32 v70, 0
  v_mov_b32 v71, 0
  v_mov_b32 v72, 0
  v_mov_b32 v73, 0
  v_mov_b32 v74, 0
  v_mov_b32 v75, 0
  v_mov_b32 v76, 0
  v_mov_b32 v77, 0
  v_mov_b32 v78, 0
  v_mov_b32 v79, 0
  v_mov_b32 v80, 0
  v_mov_b32 v81, 0
  v_mov_b32 v82, 0
  v_mov_b32 v83, 0
  v_mov_b32 v84, 0
  v_mov_b32 v85, 0
  v_mov_b32 v86, 0
  v_mov_b32 v87, 0
  v_mov_b32 v88, 0
  v_mov_b32 v89, 0
  v_mov_b32 v90, 0
  v_mov_b32 v91, 0
  v_mov_b32 v92, 0
  v_mov_b32 v93, 0
  v_mov_b32 v94, 0
  v_mov_b32 v95, 0
  v_mov_b32 v96, 0
  v_mov_b32 v97, 0
  v_mov_b32 v98, 0
  v_mov_b32 v99, 0
  v_mov_b32 v100, 0
  v_mov_b32 v101, 0
  v_mov_b32 v102, 0
  v_mov_b32 v103, 0
  v_mov_b32 v104, 0
  v_mov_b32 v105, 0
  v_mov_b32 v106, 0
  v_mov_b32 v107, 0
  v_mov_b32 v108, 0
  v_mov_b32 v109, 0
  v_mov_b32 v110, 0
  v_mov_b32 v111, 0
  v_and_b32 v118, 1, v116
  v_cmp_eq_u32 vcc, 0, v118
  v_mov_b32 v118, 12544
  v_mov_b32 v119, 10496
  v_cndmask_b32 v118, v118, v119, vcc
  v_lshrrev_b32 v116, 1, v116
  v_lshl_add_u32 v118, v116, 9, v118
  v_lshl_add_u32 v117, v117, 4, v118
  s_mov_b32 s57, 28672
  s_mov_b32 s56, 0x42800000
  v_mov_b32 v116, v2
  s_mul_i32 s35, s17, 1835008
  s_add_u32 s35, s35, 42284032
  s_mov_b32 s30, 0
  v_mov_b32 v36, 0
ch_md3:
  buffer_load_dword v37, v36, s[12:15], 0 offen sc1
  s_waitcnt vmcnt(0)
  v_readfirstlane_b32 s22, v37
  s_and_b32 s31, s22, 0xffff
  s_cmp_ge_u32 s31, 32
  s_cbranch_scc1 ch_go3
  s_sleep 2
  s_add_u32 s30, s30, 1
  s_cmp_lt_u32 s30, 50000
  s_cbranch_scc1 ch_md3
  s_branch ch_end
ch_go3:
  s_mov_b32 s31, 0
  s_lshr_b32 s22, s22, 16
  s_cmp_lg_u32 s22, 0
  s_cbranch_scc1 cB_sc3_loop
  s_branch cA_sc3_loop
ch_init4:
  s_mul_i32 s31, s17, 401408
  s_add_u32 s31, s31, 6422528
  s_mul_i32 s22, s17, 28
  s_add_u32 s23, s22, 27
  s_lshr_b32 s22, s22, 6
  s_lshr_b32 s23, s23, 6
  s_sub_u32 s23, s23, s22
  s_lshl_b32 s23, s23, 8
  v_and_b32 v36, s23, v2
  v_med3_u32 v37, v117, 0, 3
  v_lshl_add_u32 v36, v37, 4, v36
  s_lshl_b32 s22, s22, 8
  s_add_u32 s22, s22, 88588288
  s_mov_b32 s30, 0
va_bw_11:
  buffer_load_dwordx4 v[40:43], v36, s[8:11], s22 offen sc1
  s_waitcnt vmcnt(0)
  v_cmp_ne_u64 vcc, s[88:89], v[40:41]
  s_cbranch_vccnz va_bw_11_no
  v_cmp_ne_u64 vcc, s[88:89], v[42:43]
  s_cbranch_vccnz va_bw_11_no
  s_branch va_bw_11_ok
va_bw_11_no:
  s_sleep 2
  s_add_u32 s30, s30, 1
  s_cmp_lt_u32 s30, 50000
  s_cbranch_scc1 va_bw_11
  s_branch cA_abort
va_bw_11_ok:
  s_add_u32 s22, s31, 0
  buffer_load_dwordx4 a[0:3], v2, s[8:11], s22 offen offset:0 sc1
  buffer_load_dwordx4 a[4:7], v2, s[8:11], s22 offen offset:1024 sc1
  buffer_load_dwordx4 a[8:11], v2, s[8:11], s22 offen offset:2048 sc1
  buffer_load_dwordx4 a[12:15], v2, s[8:11], s22 offen offset:3072 sc1
  s_add_u32 s22, s31, 4096
  buffer_load_dwordx4 a[16:19], v2, s[8:11], s22 offen offset:0 sc1
  buffer_load_dwordx4 a[20:23], v2, s[8:11], s22 offen offset:1024 sc1
  buffer_load_dwordx4 a[24:27], v2, s[8:11], s22 offen offset:2048 sc1
  buffer_load_dwordx4 a[28:31], v2, s[8:11], s22 offen offset:3072 sc1
  s_add_u32 s22, s31, 8192
  buffer_load_dwordx4 a[32:35], v2, s[8:11], s22 offen offset:0 sc1
  buffer_load_dwordx4 a[36:39], v2, s[8:11], s22 offen offset:1024 sc1
  buffer_load_dwordx4 a[40:43], v2, s[8:11], s22 offen offset:2048 sc1
  buffer_load_dwordx4 a[44:47], v2, s[8:11], s22 offen offset:3072 sc1
  s_add_u32 s22, s31, 12288
  buffer_load_dwordx4 a[48:51], v2, s[8:11], s22 offen offset:0 sc1
  buffer_load_dwordx4 a[52:55], v2, s[8:11], s22 offen offset:1024 sc1
  buffer_load_dwordx4 a[56:59], v2, s[8:11], s22 offen offset:2048 sc1
  buffer_load_dwordx4 a[60:63], v2, s[8:11], s22 offen offset:3072 sc1
  s_add_u32 s22, s31, 16384
  buffer_load_dwordx4 a[64:67], v2, s[8:11], s22 offen offset:0 sc1
  buffer_load_dwordx4 a[68:71], v2, s[8:11], s22 offen offset:1024 sc1
  buffer_load_dwordx4 a[72:75], v2, s[8:11], s22 offen offset:2048 sc1
  buffer_load_dwordx4 a[76:79], v2, s[8:11], s22 offen offset:3072 sc1
  s_add_u32 s22, s31, 20480
  buffer_load_dwordx4 a[80:83], v2, s[8:11], s22 offen offset:0 sc1
  buffer_load_dwordx4 a[84:87], v2, s[8:11], s22 offen offset:1024 sc1
  buffer_load_dwordx4 a[88:91], v2, s[8:11], s22 offen offset:2048 sc1
  buffer_load_dwordx4 a[92:95], v2, s[8:11], s22 offen offset:3072 sc1
  s_add_u32 s22, s31, 24576
  buffer_load_dwordx4 a[96:99], v2, s[8:11], s22 offen offset:0 sc1
  buffer_load_dwordx4 a[100:103], v2, s[8:11], s22 offen offset:1024 sc1
  buffer_load_dwordx4 a[104:107], v2, s[8:11], s22 offen offset:2048 sc1
  buffer_load_dwordx4 a[108:111], v2, s[8:11], s22 offen offset:3072 sc1
  s_add_u32 s22, s31, 28672
  buffer_load_dwordx4 a[112:115], v2, s[8:11], s22 offen offset:0 sc1
  buffer_load_dwordx4 a[116:119], v2, s[8:11], s22 offen offset:1024 sc1
  buffer_load_dwordx4 a[120:123], v2, s[8:11], s22 offen offset:2048 sc1
  buffer_load_dwordx4 a[124:127], v2, s[8:11], s22 offen offset:3072 sc1
  s_waitcnt vmcnt(24)
  s_add_u32 s22, s31, 32768
  buffer_load_dwordx4 a[128:131], v2, s[8:11], s22 offen offset:0 sc1
  buffer_load_dwordx4 a[132:135], v2, s[8:11], s22 offen offset:1024 sc1
  buffer_load_dwordx4 a[136:139], v2, s[8:11], s22 offen offset:2048 sc1
  buffer_load_dwordx4 a[140:143], v2, s[8:11], s22 offen offset:3072 sc1
  s_add_u32 s22, s31, 36864
  buffer_load_dwordx4 a[144:147], v2, s[8:11], s22 offen offset:0 sc1
  buffer_load_dwordx4 a[148:151], v2, s[8:11], s22 offen offset:1024 sc1
  buffer_load_dwordx4 a[152:155], v2, s[8:11], s22 offen offset:2048 sc1
  buffer_load_dwordx4 a[156:159], v2, s[8:11], s22 offen offset:3072 sc1
  s_add_u32 s22, s31, 40960
  buffer_load_dwordx4 a[160:163], v2, s[8:11], s22 offen offset:0 sc1
  buffer_load_dwordx4 a[164:167], v2, s[8:11], s22 offen offset:1024 sc1
  buffer_load_dwordx4 a[168:171], v2, s[8:11], s22 offen offset:2048 sc1
  buffer_load_dwordx4 a[172:175], v2, s[8:11], s22 offen offset:3072 sc1
  s_add_u32 s22, s31, 45056
  buffer_load_dwordx4 a[176:179], v2, s[8:11], s22 offen offset:0 sc1
  buffer_load_dwordx4 a[180:183], v2, s[8:11], s22 offen offset:1024 sc1
  buffer_load_dwordx4 a[184:187], v2, s[8:11], s22 offen offset:2048 sc1
  buffer_load_dwordx4 a[188:191], v2, s[8:11], s22 offen offset:3072 sc1
  s_add_u32 s22, s31, 49152
  buffer_load_dwordx4 a[192:195], v2, s[8:11], s22 offen offset:0 sc1
  buffer_load_dwordx4 a[196:199], v2, s[8:11], s22 offen offset:1024 sc1
  buffer_load_dwordx4 a[200:203], v2, s[8:11], s22 offen offset:2048 sc1
  buffer_load_dwordx4 a[204:207], v2, s[8:11], s22 offen offset:3072 sc1
  s_add_u32 s22, s31, 53248
  buffer_load_dwordx4 a[208:211], v2, s[8:11], s22 offen offset:0 sc1
  buffer_load_dwordx4 a[212:215], v2, s[8:11], s22 offen offset:1024 sc1
  buffer_load_dwordx4 a[216:219], v2, s[8:11], s22 offen offset:2048 sc1
  buffer_load_dwordx4 a[220:223], v2, s[8:11], s22 offen offset:3072 sc1
  s_add_u32 s22, s31, 57344
  buffer_load_dwordx4 a[224:227], v2, s[8:11], s22 offen offset:0 sc1
  buffer_load_dwordx4 a[228:231], v2, s[8:11], s22 offen offset:1024 sc1
  buffer_load_dwordx4 a[232:235], v2, s[8:11], s22 offen offset:2048 sc1
  buffer_load_dwordx4 a[236:239], v2, s[8:11], s22 offen offset:3072 sc1
  s_add_u32 s22, s31, 61440
  buffer_load_dwordx4 a[240:243], v2, s[8:11], s22 offen offset:0 sc1
  buffer_load_dwordx4 a[244:247], v2, s[8:11], s22 offen offset:1024 sc1
  buffer_load_dwordx4 a[248:251], v2, s[8:11], s22 offen offset:2048 sc1
  buffer_load_dwordx4 a[252:255], v2, s[8:11], s22 offen offset:3072 sc1
  s_waitcnt vmcnt(24)
  s_add_u32 s22, s31, 65536
  buffer_load_dwordx4 v[176:179], v2, s[8:11], s22 offen offset:0 sc1
  buffer_load_dwordx4 v[180:183], v2, s[8:11], s22 offen offset:1024 sc1
  buffer_load_dwordx4 v[184:187], v2, s[8:11], s22 offen offset:2048 sc1
  buffer_load_dwordx4 v[188:191], v2, s[8:11], s22 offen offset:3072 sc1
  s_add_u32 s22, s31, 69632
  buffer_load_dwordx4 v[192:195], v2, s[8:11], s22 offen offset:0 sc1
  buffer_load_dwordx4 v[196:199], v2, s[8:11], s22 offen offset:1024 sc1
  buffer_load_dwordx4 v[200:203], v2, s[8:11], s22 offen offset:2048 sc1
  buffer_load_dwordx4 v[204:207], v2, s[8:11], s22 offen offset:3072 sc1
  s_add_u32 s22, s31, 73728
  buffer_load_dwordx4 v[208:211], v2, s[8:11], s22 offen offset:0 sc1
  buffer_load_dwordx4 v[212:215], v2, s[8:11], s22 offen offset:1024 sc1
  buffer_load_dwordx4 v[216:219], v2, s[8:11], s22 offen offset:2048 sc1
  buffer_load_dwordx4 v[220:223], v2, s[8:11], s22 offen offset:3072 sc1
  s_add_u32 s22, s31, 77824
  buffer_load_dwordx4 v[224:227], v2, s[8:11], s22 offen offset:0 sc1
  buffer_load_dwordx4 v[228:231], v2, s[8:11], s22 offen offset:1024 sc1
  buffer_load_dwordx4 v[232:235], v2, s[8:11], s22 offen offset:2048 sc1
  buffer_load_dwordx4 v[236:239], v2, s[8:11], s22 offen offset:3072 sc1
  s_add_u32 s22, s31, 81920
  buffer_load_dwordx4 v[240:243], v2, s[8:11], s22 offen offset:0 sc1
  buffer_load_dwordx4 v[244:247], v2, s[8:11], s22 offen offset:1024 sc1
  buffer_load_dwordx4 v[248:251], v2, s[8:11], s22 offen offset:2048 sc1
  buffer_load_dwordx4 v[252:255], v2, s[8:11], s22 offen offset:3072 sc1
  s_mul_i32 s22, s17, 28
  s_add_u32 s23, s22, 27
  s_lshr_b32 s22, s22, 6
  s_lshr_b32 s23, s23, 6
  s_sub_u32 s23, s23, s22
  s_lshl_b32 s23, s23, 8
  v_and_b32 v36, s23, v2
  v_med3_u32 v37, v117, 10, 11
  v_lshl_add_u32 v36, v37, 4, v36
  s_lshl_b32 s22, s22, 8
  s_add_u32 s22, s22, 88588288
  s_mov_b32 s30, 0
va_bw_12:
  buffer_load_dwordx4 v[40:43], v36, s[8:11], s22 offen sc1
  s_waitcnt vmcnt(0)
  v_cmp_ne_u64 vcc, s[88:89], v[40:41]
  s_cbranch_vccnz va_bw_12_no
  v_cmp_ne_u64 vcc, s[88:89], v[42:43]
  s_cbranch_vccnz va_bw_12_no
  s_branch va_bw_12_ok
va_bw_12_no:
  s_sleep 2
  s_add_u32 s30, s30, 1
  s_cmp_lt_u32 s30, 50000
  s_cbranch_scc1 va_bw_12
  s_branch cA_abort
va_bw_12_ok:
  s_mov_b32 m0, 16384
  s_add_u32 s22, s31, 272384
  buffer_load_dwordx4 v2, s[8:11], s22 offen offset:0 sc1 lds
  buffer_load_dwordx4 v2, s[8:11], s22 offen offset:1024 sc1 lds
  buffer_load_dwordx4 v2, s[8:11], s22 offen offset:2048 sc1 lds
  buffer_load_dwordx4 v2, s[8:11], s22 offen offset:3072 sc1 lds
  s_mov_b32 m0, 20480
  s_add_u32 s22, s31, 276480
  buffer_load_dwordx4 v2, s[8:11], s22 offen offset:0 sc1 lds
  buffer_load_dwordx4 v2, s[8:11], s22 offen offset:1024 sc1 lds
  buffer_load_dwordx4 v2, s[8:11], s22 offen offset:2048 sc1 lds
  buffer_load_dwordx4 v2, s[8:11], s22 offen offset:3072 sc1 lds
  s_mov_b32 m0, 24576
  s_add_u32 s22, s31, 280576
  buffer_load_dwordx4 v2, s[8:11], s22 offen offset:0 sc1 lds
  buffer_load_dwordx4 v2, s[8:11], s22 offen offset:1024 sc1 lds
  buffer_load_dwordx4 v2, s[8:11], s22 offen offset:2048 sc1 lds
  buffer_load_dwordx4 v2, s[8:11], s22 offen offset:3072 sc1 lds
  s_mov_b32 m0, 28672
  s_add_u32 s22, s31, 284672
  buffer_load_dwordx4 v2, s[8:11], s22 offen offset:0 sc1 lds
  buffer_load_dwordx4 v2, s[8:11], s22 offen offset:1024 sc1 lds
  v_mov_b32 v72, v116
  v_mov_b32 v73, v117
  v_lshrrev_b32 v65, 1, v72
  v_and_b32 v66, 1, v72
  v_add_u32 v67, 0, v65
  v_lshl_add_u32 v67, v67, 4, v73
  v_mul_u32_u24 v68, 2341, v67
  v_lshrrev_b32 v68, 16, v68
  v_mul_u32_u24 v69, 28, v68
  v_sub_u32 v69, v67, v69
  v_lshrrev_b32 v70, 4, v69
  v_and_b32 v69, 15, v69
  v_and_b32 v71, 1, v69
  v_lshrrev_b32 v69, 1, v69
  v_lshl_add_u32 v69, v71, 3, v69
  v_lshlrev_b32 v71, 12, v70
  v_lshl_add_u32 v71, v68, 8, v71
  v_lshl_add_u32 v71, v69, 4, v71
  v_lshl_add_u32 v60, v66, 3, v71
  v_add_u32 v67, 2, v65
  v_lshl_add_u32 v67, v67, 4, v73
  v_mul_u32_u24 v68, 2341, v67
  v_lshrrev_b32 v68, 16, v68
  v_mul_u32_u24 v69, 28, v68
  v_sub_u32 v69, v67, v69
  v_lshrrev_b32 v70, 4, v69
  v_and_b32 v69, 15, v69
  v_and_b32 v71, 1, v69
  v_lshrrev_b32 v69, 1, v69
  v_lshl_add_u32 v69, v71, 3, v69
  v_lshlrev_b32 v71, 12, v70
  v_lshl_add_u32 v71, v68, 8, v71
  v_lshl_add_u32 v71, v69, 4, v71
  v_lshl_add_u32 v61, v66, 3, v71
  v_add_u32 v67, 4, v65
  v_lshl_add_u32 v67, v67, 4, v73
  v_mul_u32_u24 v68, 2341, v67
  v_lshrrev_b32 v68, 16, v68
  v_mul_u32_u24 v69, 28, v68
  v_sub_u32 v69, v67, v69
  v_lshrrev_b32 v70, 4, v69
  v_and_b32 v69, 15, v69
  v_and_b32 v71, 1, v69
  v_lshrrev_b32 v69, 1, v69
  v_lshl_add_u32 v69, v71, 3, v69
  v_lshlrev_b32 v71, 12, v70
  v_lshl_add_u32 v71, v68, 8, v71
  v_lshl_add_u32 v71, v69, 4, v71
  v_lshl_add_u32 v62, v66, 3, v71
  v_and_b32 v0, 31, v1
  v_lshlrev_b32 v0, 2, v0
  v_add_u32 v0, 21504, v0
  v_lshlrev_b32 v4, 2, v73
  s_and_b32 s22, s17, 15
  s_lshl_b32 s22, s22, 7
  s_add_u32 s22, s22, 17408
  v_add_u32 v4, s22, v4
  v_and_b32 v64, 7, v73
  v_lshlrev_b32 v5, 4, v64
  v_lshl_add_u32 v5, v72, 7, v5
  v_lshrrev_b32 v65, 3, v73
  v_lshl_add_u32 v5, v65, 9, v5
  s_lshl_b32 s22, s17, 3
  s_add_u32 s22, s22, 21504
  v_lshl_add_u32 v7, v2, 3, s22
  v_add_u32 v65, 0, v73
  v_min_u32 v65, 27, v65
  v_mad_u32_u24 v65, v72, 28, v65
  v_lshlrev_b32 v6, 4, v65
  s_lshr_b32 s22, s17, 1
  s_mul_i32 s22, s22, 7
  s_and_b32 s34, s17, 1
  s_lshl_b32 s35, s34, 2
  v_add_u32 v70, s35, v72
  v_mov_b32 v71, s34
  v_mov_b32 v69, 0
  v_cmp_eq_u32 vcc, 3, v72
  s_nop 1
  v_cndmask_b32 v70, v70, v72, vcc
  v_cndmask_b32 v69, v69, v71, vcc
  v_add_u32 v70, s22, v70
  v_lshrrev_b32 v68, 1, v70
  v_lshlrev_b32 v68, 8, v68
  v_lshl_add_u32 v68, v69, 7, v68
  v_and_b32 v69, 1, v70
  v_lshl_add_u32 v68, v69, 3, v68
  v_lshl_add_u32 v1, v64, 4, v68
  v_cmp_gt_u32 s[26:27], 8, v73
  v_lshrrev_b32 v65, 3, v73
  v_lshl_add_u32 v66, v64, 1, v65
  v_add_u32 v66, 0, v66
  v_min_u32 v66, 27, v66
  v_mad_u32_u24 v66, v72, 28, v66
  v_lshlrev_b32 v6, 4, v66
  s_mul_i32 s22, s17, 28
  s_add_u32 s22, s22, 0
  v_lshl_add_u32 v70, v64, 1, s22
  v_lshrrev_b32 v68, 4, v70
  v_lshlrev_b32 v68, 8, v68
  v_bfe_u32 v69, v70, 1, 1
  v_lshl_add_u32 v68, v69, 7, v68
  v_bfe_u32 v69, v70, 2, 2
  v_lshl_add_u32 v68, v69, 2, v68
  v_and_b32 v69, 1, v72
  v_lshl_add_u32 v65, v69, 2, v65
  v_lshrrev_b32 v69, 1, v72
  v_lshl_add_u32 v65, v69, 1, v65
  v_lshl_add_u32 v1, v65, 4, v68
  v_cmp_gt_u32 s[26:27], 6, v64
  v_mov_b32 v156, 0
  v_mov_b32 v157, 0
  v_mov_b32 v158, 0
  v_mov_b32 v159, 0
  ds_write_b128 v2, v[156:159] offset:0
  ds_write_b128 v2, v[156:159] offset:1024
  ds_write_b128 v2, v[156:159] offset:2048
  ds_write_b128 v2, v[156:159] offset:3072
  s_mul_i32 s22, s17, 1835008
  s_add_u32 s25, s22, 42205184
  s_lshl_b32 s35, s17, 7
  s_add_u32 s35, s35, 88526848
  s_mov_b32 s38, 0
  v_mov_b32 v175, 0
  s_lshl_b32 s22, 0, 11
  s_add_u32 s22, s22, 88590336
  v_add_u32 v36, 1024, v2
  v_min_u32 v36, 1776, v36
  s_mov_b32 s30, 0
va_iw4:
  buffer_load_dwordx4 v[40:43], v2, s[8:11], s22 offen sc1
  buffer_load_dwordx4 v[44:47], v36, s[8:11], s22 offen sc1
  s_waitcnt vmcnt(0)
  v_cmp_ne_u64 vcc, s[88:89], v[40:41]
  s_cbranch_vccnz va_iw4_no
  v_cmp_ne_u64 vcc, s[88:89], v[42:43]
  s_cbranch_vccnz va_iw4_no
  v_cmp_ne_u64 vcc, s[88:89], v[44:45]
  s_cbranch_vccnz va_iw4_no
  v_cmp_ne_u64 vcc, s[88:89], v[46:47]
  s_cbranch_vccnz va_iw4_no
  s_branch va_iw4_ok
va_iw4_no:
  s_sleep 2
  s_add_u32 s30, s30, 1
  s_cmp_lt_u32 s30, 50000
  s_cbranch_scc1 va_iw4
  s_branch cA_abort
va_iw4_ok:
  s_mov_b32 s30, 0
  v_mov_b32 v36, 0
ch_md4:
  buffer_load_dword v37, v36, s[12:15], 0 offen sc1
  s_waitcnt vmcnt(0)
  v_readfirstlane_b32 s22, v37
  s_and_b32 s31, s22, 0xffff
  s_cmp_ge_u32 s31, 32
  s_cbranch_scc1 ch_go4
  s_sleep 2
  s_add_u32 s30, s30, 1
  s_cmp_lt_u32 s30, 50000
  s_cbranch_scc1 ch_md4
  s_branch ch_end
ch_go4:
  s_mov_b32 s31, 0
  v_mov_b32 v36, 0
  v_mov_b32 v37, 0
  v_mov_b32 v38, 0
  v_mov_b32 v39, 0
  v_mov_b32 v40, 0
  v_mov_b32 v41, 0
  v_mov_b32 v42, 0
  v_mov_b32 v43, 0
  v_mov_b32 v44, 0
  v_mov_b32 v45, 0
  v_mov_b32 v46, 0
  v_mov_b32 v47, 0
  v_mov_b32 v48, 0
  v_mov_b32 v49, 0
  v_mov_b32 v50, 0
  v_mov_b32 v51, 0
  v_mov_b32 v52, 0
  v_mov_b32 v53, 0
  v_mov_b32 v54, 0
  v_mov_b32 v55, 0
  v_mov_b32 v56, 0
  v_mov_b32 v57, 0
  v_mov_b32 v58, 0
  v_mov_b32 v59, 0
  s_lshr_b32 s22, s22, 16
  s_cmp_lg_u32 s22, 0
  s_cbranch_scc1 cB_va0_loop
  s_branch cA_va0_loop
ch_init5:
  s_mul_i32 s31, s17, 401408
  s_add_u32 s31, s31, 6422528
  s_mul_i32 s22, s17, 28
  s_add_u32 s23, s22, 27
  s_lshr_b32 s22, s22, 6
  s_lshr_b32 s23, s23, 6
  s_sub_u32 s23, s23, s22
  s_lshl_b32 s23, s23, 8
  v_and_b32 v36, s23, v2
  v_med3_u32 v37, v117, 3, 6
  v_lshl_add_u32 v36, v37, 4, v36
  s_lshl_b32 s22, s22, 8
  s_add_u32 s22, s22, 88588288
  s_mov_b32 s30, 0
va_bw_13:
  buffer_load_dwordx4 v[40:43], v36, s[8:11], s22 offen sc1
  s_waitcnt vmcnt(0)
  v_cmp_ne_u64 vcc, s[88:89], v[40:41]
  s_cbranch_vccnz va_bw_13_no
  v_cmp_ne_u64 vcc, s[88:89], v[42:43]
  s_cbranch_vccnz va_bw_13_no
  s_branch va_bw_13_ok
va_bw_13_no:
  s_sleep 2
  s_add_u32 s30, s30, 1
  s_cmp_lt_u32 s30, 50000
  s_cbranch_scc1 va_bw_13
  s_branch cA_abort
va_bw_13_ok:
  s_add_u32 s22, s31, 86016
  buffer_load_dwordx4 a[0:3], v2, s[8:11], s22 offen offset:0 sc1
  buffer_load_dwordx4 a[4:7], v2, s[8:11], s22 offen offset:1024 sc1
  buffer_load_dwordx4 a[8:11], v2, s[8:11], s22 offen offset:2048 sc1
  buffer_load_dwordx4 a[12:15], v2, s[8:11], s22 offen offset:3072 sc1
  s_add_u32 s22, s31, 90112
  buffer_load_dwordx4 a[16:19], v2, s[8:11], s22 offen offset:0 sc1
  buffer_load_dwordx4 a[20:23], v2, s[8:11], s22 offen offset:1024 sc1
  buffer_load_dwordx4 a[24:27], v2, s[8:11], s22 offen offset:2048 sc1
  buffer_load_dwordx4 a[28:31], v2, s[8:11], s22 offen offset:3072 sc1
  s_add_u32 s22, s31, 94208
  buffer_load_dwordx4 a[32:35], v2, s[8:11], s22 offen offset:0 sc1
  buffer_load_dwordx4 a[36:39], v2, s[8:11], s22 offen offset:1024 sc1
  buffer_load_dwordx4 a[40:43], v2, s[8:11], s22 offen offset:2048 sc1
  buffer_load_dwordx4 a[44:47], v2, s[8:11], s22 offen offset:3072 sc1
  s_add_u32 s22, s31, 98304
  buffer_load_dwordx4 a[48:51], v2, s[8:11], s22 offen offset:0 sc1
  buffer_load_dwordx4 a[52:55], v2, s[8:11], s22 offen offset:1024 sc1
  buffer_load_dwordx4 a[56:59], v2, s[8:11], s22 offen offset:2048 sc1
  buffer_load_dwordx4 a[60:63], v2, s[8:11], s22 offen offset:3072 sc1
  s_add_u32 s22, s31, 102400
  buffer_load_dwordx4 a[64:67], v2, s[8:11], s22 offen offset:0 sc1
  buffer_load_dwordx4 a[68:71], v2, s[8:11], s22 offen offset:1024 sc1
  buffer_load_dwordx4 a[72:75], v2, s[8:11], s22 offen offset:2048 sc1
  buffer_load_dwordx4 a[76:79], v2, s[8:11], s22 offen offset:3072 sc1
  s_add_u32 s22, s31, 106496
  buffer_load_dwordx4 a[80:83], v2, s[8:11], s22 offen offset:0 sc1
  buffer_load_dwordx4 a[84:87], v2, s[8:11], s22 offen offset:1024 sc1
  buffer_load_dwordx4 a[88:91], v2, s[8:11], s22 offen offset:2048 sc1
  buffer_load_dwordx4 a[92:95], v2, s[8:11], s22 offen offset:3072 sc1
  s_add_u32 s22, s31, 110592
  buffer_load_dwordx4 a[96:99], v2, s[8:11], s22 offen offset:0 sc1
  buffer_load_dwordx4 a[100:103], v2, s[8:11], s22 offen offset:1024 sc1
  buffer_load_dwordx4 a[104:107], v2, s[8:11], s22 offen offset:2048 sc1
  buffer_load_dwordx4 a[108:111], v2, s[8:11], s22 offen offset:3072 sc1
  s_add_u32 s22, s31, 114688
  buffer_load_dwordx4 a[112:115], v2, s[8:11], s22 offen offset:0 sc1
  buffer_load_dwordx4 a[116:119], v2, s[8:11], s22 offen offset:1024 sc1
  buffer_load_dwordx4 a[120:123], v2, s[8:11], s22 offen offset:2048 sc1
  buffer_load_dwordx4 a[124:127], v2, s[8:11], s22 offen offset:3072 sc1
  s_waitcnt vmcnt(24)
  s_add_u32 s22, s31, 118784
  buffer_load_dwordx4 a[128:131], v2, s[8:11], s22 offen offset:0 sc1
  buffer_load_dwordx4 a[132:135], v2, s[8:11], s22 offen offset:1024 sc1
  buffer_load_dwordx4 a[136:139], v2, s[8:11], s22 offen offset:2048 sc1
  buffer_load_dwordx4 a[140:143], v2, s[8:11], s22 offen offset:3072 sc1
  s_add_u32 s22, s31, 122880
  buffer_load_dwordx4 a[144:147], v2, s[8:11], s22 offen offset:0 sc1
  buffer_load_dwordx4 a[148:151], v2, s[8:11], s22 offen offset:1024 sc1
  buffer_load_dwordx4 a[152:155], v2, s[8:11], s22 offen offset:2048 sc1
  buffer_load_dwordx4 a[156:159], v2, s[8:11], s22 offen offset:3072 sc1
  s_add_u32 s22, s31, 126976
  buffer_load_dwordx4 a[160:163], v2, s[8:11], s22 offen offset:0 sc1
  buffer_load_dwordx4 a[164:167], v2, s[8:11], s22 offen offset:1024 sc1
  buffer_load_dwordx4 a[168:171], v2, s[8:11], s22 offen offset:2048 sc1
  buffer_load_dwordx4 a[172:175], v2, s[8:11], s22 offen offset:3072 sc1
  s_add_u32 s22, s31, 131072
  buffer_load_dwordx4 a[176:179], v2, s[8:11], s22 offen offset:0 sc1
  buffer_load_dwordx4 a[180:183], v2, s[8:11], s22 offen offset:1024 sc1
  buffer_load_dwordx4 a[184:187], v2, s[8:11], s22 offen offset:2048 sc1
  buffer_load_dwordx4 a[188:191], v2, s[8:11], s22 offen offset:3072 sc1
  s_add_u32 s22, s31, 135168
  buffer_load_dwordx4 a[192:195], v2, s[8:11], s22 offen offset:0 sc1
  buffer_load_dwordx4 a[196:199], v2, s[8:11], s22 offen offset:1024 sc1
  buffer_load_dwordx4 a[200:203], v2, s[8:11], s22 offen offset:2048 sc1
  buffer_load_dwordx4 a[204:207], v2, s[8:11], s22 offen offset:3072 sc1
  s_add_u32 s22, s31, 139264
  buffer_load_dwordx4 a[208:211], v2, s[8:11], s22 offen offset:0 sc1
  buffer_load_dwordx4 a[212:215], v2, s[8:11], s22 offen offset:1024 sc1
  buffer_load_dwordx4 a[216:219], v2, s[8:11], s22 offen offset:2048 sc1
  buffer_load_dwordx4 a[220:223], v2, s[8:11], s22 offen offset:3072 sc1
  s_add_u32 s22, s31, 143360
  buffer_load_dwordx4 a[224:227], v2, s[8:11], s22 offen offset:0 sc1
  buffer_load_dwordx4 a[228:231], v2, s[8:11], s22 offen offset:1024 sc1
  buffer_load_dwordx4 a[232:235], v2, s[8:11], s22 offen offset:2048 sc1
  buffer_load_dwordx4 a[236:239], v2, s[8:11], s22 offen offset:3072 sc1
  s_add_u32 s22, s31, 147456
  buffer_load_dwordx4 a[240:243], v2, s[8:11], s22 offen offset:0 sc1
  buffer_load_dwordx4 a[244:247], v2, s[8:11], s22 offen offset:1024 sc1
  buffer_load_dwordx4 a[248:251], v2, s[8:11], s22 offen offset:2048 sc1
  buffer_load_dwordx4 a[252:255], v2, s[8:11], s22 offen offset:3072 sc1
  s_waitcnt vmcnt(24)
  s_add_u32 s22, s31, 151552
  buffer_load_dwordx4 v[176:179], v2, s[8:11], s22 offen offset:0 sc1
  buffer_load_dwordx4 v[180:183], v2, s[8:11], s22 offen offset:1024 sc1
  buffer_load_dwordx4 v[184:187], v2, s[8:11], s22 offen offset:2048 sc1
  buffer_load_dwordx4 v[188:191], v2, s[8:11], s22 offen offset:3072 sc1
  s_add_u32 s22, s31, 155648
  buffer_load_dwordx4 v[192:195], v2, s[8:11], s22 offen offset:0 sc1
  buffer_load_dwordx4 v[196:199], v2, s[8:11], s22 offen offset:1024 sc1
  buffer_load_dwordx4 v[200:203], v2, s[8:11], s22 offen offset:2048 sc1
  buffer_load_dwordx4 v[204:207], v2, s[8:11], s22 offen offset:3072 sc1
  s_add_u32 s22, s31, 159744
  buffer_load_dwordx4 v[208:211], v2, s[8:11], s22 offen offset:0 sc1
  buffer_load_dwordx4 v[212:215], v2, s[8:11], s22 offen offset:1024 sc1
  buffer_load_dwordx4 v[216:219], v2, s[8:11], s22 offen offset:2048 sc1
  buffer_load_dwordx4 v[220:223], v2, s[8:11], s22 offen offset:3072 sc1
  s_add_u32 s22, s31, 163840
  buffer_load_dwordx4 v[224:227], v2, s[8:11], s22 offen offset:0 sc1
  buffer_load_dwordx4 v[228:231], v2, s[8:11], s22 offen offset:1024 sc1
  buffer_load_dwordx4 v[232:235], v2, s[8:11], s22 offen offset:2048 sc1
  buffer_load_dwordx4 v[236:239], v2, s[8:11], s22 offen offset:3072 sc1
  s_add_u32 s22, s31, 167936
  buffer_load_dwordx4 v[240:243], v2, s[8:11], s22 offen offset:0 sc1
  buffer_load_dwordx4 v[244:247], v2, s[8:11], s22 offen offset:1024 sc1
  buffer_load_dwordx4 v[248:251], v2, s[8:11], s22 offen offset:2048 sc1
  buffer_load_dwordx4 v[252:255], v2, s[8:11], s22 offen offset:3072 sc1
  s_mul_i32 s22, s17, 28
  s_add_u32 s23, s22, 27
  s_lshr_b32 s22, s22, 6
  s_lshr_b32 s23, s23, 6
  s_sub_u32 s23, s23, s22
  s_lshl_b32 s23, s23, 8
  v_and_b32 v36, s23, v2
  v_med3_u32 v37, v117, 15, 15
  v_lshl_add_u32 v36, v37, 4, v36
  s_lshl_b32 s22, s22, 8
  s_add_u32 s22, s22, 88588288
  s_mov_b32 s30, 0
va_bw_14:
  buffer_load_dwordx4 v[40:43], v36, s[8:11], s22 offen sc1
  s_waitcnt vmcnt(0)
  v_cmp_ne_u64 vcc, s[88:89], v[40:41]
  s_cbranch_vccnz va_bw_14_no
  v_cmp_ne_u64 vcc, s[88:89], v[42:43]
  s_cbranch_vccnz va_bw_14_no
  s_branch va_bw_14_ok
va_bw_14_no:
  s_sleep 2
  s_add_u32 s30, s30, 1
  s_cmp_lt_u32 s30, 50000
  s_cbranch_scc1 va_bw_14
  s_branch cA_abort
va_bw_14_ok:
  s_mov_b32 m0, 59392
  s_add_u32 s22, s31, 387072
  buffer_load_dwordx4 v2, s[8:11], s22 offen offset:0 sc1 lds
  buffer_load_dwordx4 v2, s[8:11], s22 offen offset:1024 sc1 lds
  buffer_load_dwordx4 v2, s[8:11], s22 offen offset:2048 sc1 lds
  buffer_load_dwordx4 v2, s[8:11], s22 offen offset:3072 sc1 lds
  s_mov_b32 m0, 63488
  s_add_u32 s22, s31, 391168
  buffer_load_dwordx4 v2, s[8:11], s22 offen offset:0 sc1 lds
  buffer_load_dwordx4 v2, s[8:11], s22 offen offset:1024 sc1 lds
  buffer_load_dwordx4 v2, s[8:11], s22 offen offset:2048 sc1 lds
  buffer_load_dwordx4 v2, s[8:11], s22 offen offset:3072 sc1 lds
  s_mov_b32 m0, 67584
  s_add_u32 s22, s31, 395264
  buffer_load_dwordx4 v2, s[8:11], s22 offen offset:0 sc1 lds
  buffer_load_dwordx4 v2, s[8:11], s22 offen offset:1024 sc1 lds
  buffer_load_dwordx4 v2, s[8:11], s22 offen offset:2048 sc1 lds
  buffer_load_dwordx4 v2, s[8:11], s22 offen offset:3072 sc1 lds
  s_mov_b32 m0, 71680
  s_add_u32 s22, s31, 399360
  buffer_load_dwordx4 v2, s[8:11], s22 offen offset:0 sc1 lds
  buffer_load_dwordx4 v2, s[8:11], s22 offen offset:1024 sc1 lds
  v_mov_b32 v72, v116
  v_mov_b32 v73, v117
  v_lshrrev_b32 v65, 1, v72
  v_and_b32 v66, 1, v72
  v_add_u32 v67, 6, v65
  v_lshl_add_u32 v67, v67, 4, v73
  v_mul_u32_u24 v68, 2341, v67
  v_lshrrev_b32 v68, 16, v68
  v_mul_u32_u24 v69, 28, v68
  v_sub_u32 v69, v67, v69
  v_lshrrev_b32 v70, 4, v69
  v_and_b32 v69, 15, v69
  v_and_b32 v71, 1, v69
  v_lshrrev_b32 v69, 1, v69
  v_lshl_add_u32 v69, v71, 3, v69
  v_lshlrev_b32 v71, 12, v70
  v_lshl_add_u32 v71, v68, 8, v71
  v_lshl_add_u32 v71, v69, 4, v71
  v_lshl_add_u32 v60, v66, 3, v71
  v_add_u32 v67, 8, v65
  v_lshl_add_u32 v67, v67, 4, v73
  v_mul_u32_u24 v68, 2341, v67
  v_lshrrev_b32 v68, 16, v68
  v_mul_u32_u24 v69, 28, v68
  v_sub_u32 v69, v67, v69
  v_lshrrev_b32 v70, 4, v69
  v_and_b32 v69, 15, v69
  v_and_b32 v71, 1, v69
  v_lshrrev_b32 v69, 1, v69
  v_lshl_add_u32 v69, v71, 3, v69
  v_lshlrev_b32 v71, 12, v70
  v_lshl_add_u32 v71, v68, 8, v71
  v_lshl_add_u32 v71, v69, 4, v71
  v_lshl_add_u32 v61, v66, 3, v71
  v_add_u32 v67, 10, v65
  v_lshl_add_u32 v67, v67, 4, v73
  v_mul_u32_u24 v68, 2341, v67
  v_lshrrev_b32 v68, 16, v68
  v_mul_u32_u24 v69, 28, v68
  v_sub_u32 v69, v67, v69
  v_lshrrev_b32 v70, 4, v69
  v_and_b32 v69, 15, v69
  v_and_b32 v71, 1, v69
  v_lshrrev_b32 v69, 1, v69
  v_lshl_add_u32 v69, v71, 3, v69
  v_lshlrev_b32 v71, 12, v70
  v_lshl_add_u32 v71, v68, 8, v71
  v_lshl_add_u32 v71, v69, 4, v71
  v_lshl_add_u32 v62, v66, 3, v71
  v_and_b32 v0, 31, v1
  v_lshlrev_b32 v0, 2, v0
  v_add_u32 v0, 21504, v0
  v_lshlrev_b32 v4, 2, v73
  s_and_b32 s22, s17, 15
  s_lshl_b32 s22, s22, 7
  s_add_u32 s22, s22, 17408
  v_add_u32 v4, s22, v4
  v_and_b32 v64, 7, v73
  v_lshlrev_b32 v5, 4, v64
  v_lshl_add_u32 v5, v72, 7, v5
  v_lshrrev_b32 v65, 3, v73
  v_lshl_add_u32 v5, v65, 9, v5
  s_lshl_b32 s22, s17, 3
  s_add_u32 s22, s22, 21508
  v_lshl_add_u32 v7, v2, 3, s22
  v_add_u32 v65, 16, v73
  v_min_u32 v65, 27, v65
  v_mad_u32_u24 v65, v72, 28, v65
  v_lshlrev_b32 v6, 4, v65
  s_lshr_b32 s22, s17, 1
  s_mul_i32 s22, s22, 7
  s_and_b32 s34, s17, 1
  s_lshl_b32 s35, s34, 2
  v_add_u32 v70, s35, v72
  v_mov_b32 v71, s34
  v_mov_b32 v69, 1
  v_cmp_eq_u32 vcc, 3, v72
  s_nop 1
  v_cndmask_b32 v70, v70, v72, vcc
  v_cndmask_b32 v69, v69, v71, vcc
  v_add_u32 v70, s22, v70
  v_lshrrev_b32 v68, 1, v70
  v_lshlrev_b32 v68, 8, v68
  v_lshl_add_u32 v68, v69, 7, v68
  v_and_b32 v69, 1, v70
  v_lshl_add_u32 v68, v69, 3, v68
  v_lshl_add_u32 v1, v64, 4, v68
  v_cmp_gt_u32 s[26:27], 8, v73
  v_cmp_gt_u32 vcc, 3, v72
  s_and_b64 s[26:27], s[26:27], vcc
  v_lshrrev_b32 v65, 3, v73
  v_lshl_add_u32 v66, v64, 1, v65
  v_add_u32 v66, 16, v66
  v_min_u32 v66, 27, v66
  v_mad_u32_u24 v66, v72, 28, v66
  v_lshlrev_b32 v6, 4, v66
  s_mul_i32 s22, s17, 28
  s_add_u32 s22, s22, 16
  v_lshl_add_u32 v70, v64, 1, s22
  v_lshrrev_b32 v68, 4, v70
  v_lshlrev_b32 v68, 8, v68
  v_bfe_u32 v69, v70, 1, 1
  v_lshl_add_u32 v68, v69, 7, v68
  v_bfe_u32 v69, v70, 2, 2
  v_lshl_add_u32 v68, v69, 2, v68
  v_and_b32 v69, 1, v72
  v_lshl_add_u32 v65, v69, 2, v65
  v_lshrrev_b32 v69, 1, v72
  v_lshl_add_u32 v65, v69, 1, v65
  v_lshl_add_u32 v1, v65, 4, v68
  v_cmp_gt_u32 s[26:27], 6, v64
  v_mov_b32 v156, 0
  v_mov_b32 v157, 0
  v_mov_b32 v158, 0
  v_mov_b32 v159, 0
  ds_write_b128 v2, v[156:159] offset:4096
  ds_write_b128 v2, v[156:159] offset:5120
  ds_write_b128 v2, v[156:159] offset:6144
  ds_write_b128 v2, v[156:159] offset:7168
  s_mul_i32 s22, s17, 1835008
  s_add_u32 s25, s22, 42205184
  s_lshl_b32 s35, s17, 7
  s_add_u32 s35, s35, 88526848
  s_mov_b32 s38, 0
  v_mov_b32 v175, 0
  s_lshl_b32 s22, 0, 11
  s_add_u32 s22, s22, 88590336
  v_add_u32 v36, 1024, v2
  v_min_u32 v36, 1776, v36
  s_mov_b32 s30, 0
va_iw5:
  buffer_load_dwordx4 v[40:43], v2, s[8:11], s22 offen sc1
  buffer_load_dwordx4 v[44:47], v36, s[8:11], s22 offen sc1
  s_waitcnt vmcnt(0)
  v_cmp_ne_u64 vcc, s[88:89], v[40:41]
  s_cbranch_vccnz va_iw5_no
  v_cmp_ne_u64 vcc, s[88:89], v[42:43]
  s_cbranch_vccnz va_iw5_no
  v_cmp_ne_u64 vcc, s[88:89], v[44:45]
  s_cbranch_vccnz va_iw5_no
  v_cmp_ne_u64 vcc, s[88:89], v[46:47]
  s_cbranch_vccnz va_iw5_no
  s_branch va_iw5_ok
va_iw5_no:
  s_sleep 2
  s_add_u32 s30, s30, 1
  s_cmp_lt_u32 s30, 50000
  s_cbranch_scc1 va_iw5
  s_branch cA_abort
va_iw5_ok:
  s_mov_b32 s30, 0
  v_mov_b32 v36, 0
ch_md5:
  buffer_load_dword v37, v36, s[12:15], 0 offen sc1
  s_waitcnt vmcnt(0)
  v_readfirstlane_b32 s22, v37
  s_and_b32 s31, s22, 0xffff
  s_cmp_ge_u32 s31, 32
  s_cbranch_scc1 ch_go5
  s_sleep 2
  s_add_u32 s30, s30, 1
  s_cmp_lt_u32 s30, 50000
  s_cbranch_scc1 ch_md5
  s_branch ch_end
ch_go5:
  s_mov_b32 s31, 0
  v_mov_b32 v36, 0
  v_mov_b32 v37, 0
  v_mov_b32 v38, 0
  v_mov_b32 v39, 0
  v_mov_b32 v40, 0
  v_mov_b32 v41, 0
  v_mov_b32 v42, 0
  v_mov_b32 v43, 0
  v_mov_b32 v44, 0
  v_mov_b32 v45, 0
  v_mov_b32 v46, 0
  v_mov_b32 v47, 0
  v_mov_b32 v48, 0
  v_mov_b32 v49, 0
  v_mov_b32 v50, 0
  v_mov_b32 v51, 0
  v_mov_b32 v52, 0
  v_mov_b32 v53, 0
  v_mov_b32 v54, 0
  v_mov_b32 v55, 0
  v_mov_b32 v56, 0
  v_mov_b32 v57, 0
  v_mov_b32 v58, 0
  v_mov_b32 v59, 0
  s_lshr_b32 s22, s22, 16
  s_cmp_lg_u32 s22, 0
  s_cbranch_scc1 cB_va1_loop
  s_branch cA_va1_loop
ch_init6:
  s_mul_i32 s31, s17, 401408
  s_add_u32 s31, s31, 6422528
  s_mul_i32 s22, s17, 28
  s_add_u32 s23, s22, 27
  s_lshr_b32 s22, s22, 6
  s_lshr_b32 s23, s23, 6
  s_sub_u32 s23, s23, s22
  s_lshl_b32 s23, s23, 8
  v_and_b32 v36, s23, v2
  v_med3_u32 v37, v117, 6, 10
  v_lshl_add_u32 v36, v37, 4, v36
  s_lshl_b32 s22, s22, 8
  s_add_u32 s22, s22, 88588288
  s_mov_b32 s30, 0
va_bw_15:
  buffer_load_dwordx4 v[40:43], v36, s[8:11], s22 offen sc1
  s_waitcnt vmcnt(0)
  v_cmp_ne_u64 vcc, s[88:89], v[40:41]
  s_cbranch_vccnz va_bw_15_no
  v_cmp_ne_u64 vcc, s[88:89], v[42:43]
  s_cbranch_vccnz va_bw_15_no
  s_branch va_bw_15_ok
va_bw_15_no:
  s_sleep 2
  s_add_u32 s30, s30, 1
  s_cmp_lt_u32 s30, 50000
  s_cbranch_scc1 va_bw_15
  s_branch cA_abort
va_bw_15_ok:
  s_add_u32 s22, s31, 172032
  buffer_load_dwordx4 a[0:3], v2, s[8:11], s22 offen offset:0 sc1
  buffer_load_dwordx4 a[4:7], v2, s[8:11], s22 offen offset:1024 sc1
  buffer_load_dwordx4 a[8:11], v2, s[8:11], s22 offen offset:2048 sc1
  buffer_load_dwordx4 a[12:15], v2, s[8:11], s22 offen offset:3072 sc1
  s_add_u32 s22, s31, 176128
  buffer_load_dwordx4 a[16:19], v2, s[8:11], s22 offen offset:0 sc1
  buffer_load_dwordx4 a[20:23], v2, s[8:11], s22 offen offset:1024 sc1
  buffer_load_dwordx4 a[24:27], v2, s[8:11], s22 offen offset:2048 sc1
  buffer_load_dwordx4 a[28:31], v2, s[8:11], s22 offen offset:3072 sc1
  s_add_u32 s22, s31, 180224
  buffer_load_dwordx4 a[32:35], v2, s[8:11], s22 offen offset:0 sc1
  buffer_load_dwordx4 a[36:39], v2, s[8:11], s22 offen offset:1024 sc1
  buffer_load_dwordx4 a[40:43], v2, s[8:11], s22 offen offset:2048 sc1
  buffer_load_dwordx4 a[44:47], v2, s[8:11], s22 offen offset:3072 sc1
  s_add_u32 s22, s31, 184320
  buffer_load_dwordx4 a[48:51], v2, s[8:11], s22 offen offset:0 sc1
  buffer_load_dwordx4 a[52:55], v2, s[8:11], s22 offen offset:1024 sc1
  buffer_load_dwordx4 a[56:59], v2, s[8:11], s22 offen offset:2048 sc1
  buffer_load_dwordx4 a[60:63], v2, s[8:11], s22 offen offset:3072 sc1
  s_add_u32 s22, s31, 188416
  buffer_load_dwordx4 a[64:67], v2, s[8:11], s22 offen offset:0 sc1
  buffer_load_dwordx4 a[68:71], v2, s[8:11], s22 offen offset:1024 sc1
  buffer_load_dwordx4 a[72:75], v2, s[8:11], s22 offen offset:2048 sc1
  buffer_load_dwordx4 a[76:79], v2, s[8:11], s22 offen offset:3072 sc1
  s_add_u32 s22, s31, 192512
  buffer_load_dwordx4 a[80:83], v2, s[8:11], s22 offen offset:0 sc1
  buffer_load_dwordx4 a[84:87], v2, s[8:11], s22 offen offset:1024 sc1
  buffer_load_dwordx4 a[88:91], v2, s[8:11], s22 offen offset:2048 sc1
  buffer_load_dwordx4 a[92:95], v2, s[8:11], s22 offen offset:3072 sc1
  s_add_u32 s22, s31, 196608
  buffer_load_dwordx4 a[96:99], v2, s[8:11], s22 offen offset:0 sc1
  buffer_load_dwordx4 a[100:103], v2, s[8:11], s22 offen offset:1024 sc1
  buffer_load_dwordx4 a[104:107], v2, s[8:11], s22 offen offset:2048 sc1
  buffer_load_dwordx4 a[108:111], v2, s[8:11], s22 offen offset:3072 sc1
  s_add_u32 s22, s31, 200704
  buffer_load_dwordx4 a[112:115], v2, s[8:11], s22 offen offset:0 sc1
  buffer_load_dwordx4 a[116:119], v2, s[8:11], s22 offen offset:1024 sc1
  buffer_load_dwordx4 a[120:123], v2, s[8:11], s22 offen offset:2048 sc1
  buffer_load_dwordx4 a[124:127], v2, s[8:11], s22 offen offset:3072 sc1
  s_waitcnt vmcnt(24)
  s_add_u32 s22, s31, 204800
  buffer_load_dwordx4 a[128:131], v2, s[8:11], s22 offen offset:0 sc1
  buffer_load_dwordx4 a[132:135], v2, s[8:11], s22 offen offset:1024 sc1
  buffer_load_dwordx4 a[136:139], v2, s[8:11], s22 offen offset:2048 sc1
  buffer_load_dwordx4 a[140:143], v2, s[8:11], s22 offen offset:3072 sc1
  s_add_u32 s22, s31, 208896
  buffer_load_dwordx4 a[144:147], v2, s[8:11], s22 offen offset:0 sc1
  buffer_load_dwordx4 a[148:151], v2, s[8:11], s22 offen offset:1024 sc1
  buffer_load_dwordx4 a[152:155], v2, s[8:11], s22 offen offset:2048 sc1
  buffer_load_dwordx4 a[156:159], v2, s[8:11], s22 offen offset:3072 sc1
  s_add_u32 s22, s31, 212992
  buffer_load_dwordx4 a[160:163], v2, s[8:11], s22 offen offset:0 sc1
  buffer_load_dwordx4 a[164:167], v2, s[8:11], s22 offen offset:1024 sc1
  buffer_load_dwordx4 a[168:171], v2, s[8:11], s22 offen offset:2048 sc1
  buffer_load_dwordx4 a[172:175], v2, s[8:11], s22 offen offset:3072 sc1
  s_add_u32 s22, s31, 217088
  buffer_load_dwordx4 a[176:179], v2, s[8:11], s22 offen offset:0 sc1
  buffer_load_dwordx4 a[180:183], v2, s[8:11], s22 offen offset:1024 sc1
  buffer_load_dwordx4 a[184:187], v2, s[8:11], s22 offen offset:2048 sc1
  buffer_load_dwordx4 a[188:191], v2, s[8:11], s22 offen offset:3072 sc1
  s_add_u32 s22, s31, 221184
  buffer_load_dwordx4 a[192:195], v2, s[8:11], s22 offen offset:0 sc1
  buffer_load_dwordx4 a[196:199], v2, s[8:11], s22 offen offset:1024 sc1
  buffer_load_dwordx4 a[200:203], v2, s[8:11], s22 offen offset:2048 sc1
  buffer_load_dwordx4 a[204:207], v2, s[8:11], s22 offen offset:3072 sc1
  s_add_u32 s22, s31, 225280
  buffer_load_dwordx4 a[208:211], v2, s[8:11], s22 offen offset:0 sc1
  buffer_load_dwordx4 a[212:215], v2, s[8:11], s22 offen offset:1024 sc1
  buffer_load_dwordx4 a[216:219], v2, s[8:11], s22 offen offset:2048 sc1
  buffer_load_dwordx4 a[220:223], v2, s[8:11], s22 offen offset:3072 sc1
  s_add_u32 s22, s31, 229376
  buffer_load_dwordx4 a[224:227], v2, s[8:11], s22 offen offset:0 sc1
  buffer_load_dwordx4 a[228:231], v2, s[8:11], s22 offen offset:1024 sc1
  buffer_load_dwordx4 a[232:235], v2, s[8:11], s22 offen offset:2048 sc1
  buffer_load_dwordx4 a[236:239], v2, s[8:11], s22 offen offset:3072 sc1
  s_add_u32 s22, s31, 233472
  buffer_load_dwordx4 a[240:243], v2, s[8:11], s22 offen offset:0 sc1
  buffer_load_dwordx4 a[244:247], v2, s[8:11], s22 offen offset:1024 sc1
  buffer_load_dwordx4 a[248:251], v2, s[8:11], s22 offen offset:2048 sc1
  buffer_load_dwordx4 a[252:255], v2, s[8:11], s22 offen offset:3072 sc1
  s_waitcnt vmcnt(24)
  s_add_u32 s22, s31, 237568
  buffer_load_dwordx4 v[120:123], v2, s[8:11], s22 offen offset:0 sc1
  buffer_load_dwordx4 v[124:127], v2, s[8:11], s22 offen offset:1024 sc1
  buffer_load_dwordx4 v[128:131], v2, s[8:11], s22 offen offset:2048 sc1
  buffer_load_dwordx4 v[132:135], v2, s[8:11], s22 offen offset:3072 sc1
  s_add_u32 s22, s31, 241664
  buffer_load_dwordx4 v[136:139], v2, s[8:11], s22 offen offset:0 sc1
  buffer_load_dwordx4 v[140:143], v2, s[8:11], s22 offen offset:1024 sc1
  buffer_load_dwordx4 v[144:147], v2, s[8:11], s22 offen offset:2048 sc1
  buffer_load_dwordx4 v[148:151], v2, s[8:11], s22 offen offset:3072 sc1
  s_add_u32 s22, s31, 245760
  buffer_load_dwordx4 v[152:155], v2, s[8:11], s22 offen offset:0 sc1
  buffer_load_dwordx4 v[156:159], v2, s[8:11], s22 offen offset:1024 sc1
  buffer_load_dwordx4 v[160:163], v2, s[8:11], s22 offen offset:2048 sc1
  buffer_load_dwordx4 v[164:167], v2, s[8:11], s22 offen offset:3072 sc1
  s_add_u32 s22, s31, 249856
  buffer_load_dwordx4 v[168:171], v2, s[8:11], s22 offen offset:0 sc1
  buffer_load_dwordx4 v[172:175], v2, s[8:11], s22 offen offset:1024 sc1
  buffer_load_dwordx4 v[176:179], v2, s[8:11], s22 offen offset:2048 sc1
  buffer_load_dwordx4 v[180:183], v2, s[8:11], s22 offen offset:3072 sc1
  s_add_u32 s22, s31, 253952
  buffer_load_dwordx4 v[184:187], v2, s[8:11], s22 offen offset:0 sc1
  buffer_load_dwordx4 v[188:191], v2, s[8:11], s22 offen offset:1024 sc1
  buffer_load_dwordx4 v[192:195], v2, s[8:11], s22 offen offset:2048 sc1
  buffer_load_dwordx4 v[196:199], v2, s[8:11], s22 offen offset:3072 sc1
  s_add_u32 s22, s31, 258048
  buffer_load_dwordx4 v[200:203], v2, s[8:11], s22 offen offset:0 sc1
  buffer_load_dwordx4 v[204:207], v2, s[8:11], s22 offen offset:1024 sc1
  buffer_load_dwordx4 v[208:211], v2, s[8:11], s22 offen offset:2048 sc1
  buffer_load_dwordx4 v[212:215], v2, s[8:11], s22 offen offset:3072 sc1
  s_add_u32 s22, s31, 262144
  buffer_load_dwordx4 v[216:219], v2, s[8:11], s22 offen offset:0 sc1
  buffer_load_dwordx4 v[220:223], v2, s[8:11], s22 offen offset:1024 sc1
  buffer_load_dwordx4 v[224:227], v2, s[8:11], s22 offen offset:2048 sc1
  buffer_load_dwordx4 v[228:231], v2, s[8:11], s22 offen offset:3072 sc1
  s_add_u32 s22, s31, 266240
  buffer_load_dwordx4 v[232:235], v2, s[8:11], s22 offen offset:0 sc1
  buffer_load_dwordx4 v[236:239], v2, s[8:11], s22 offen offset:1024 sc1
  buffer_load_dwordx4 v[240:243], v2, s[8:11], s22 offen offset:2048 sc1
  buffer_load_dwordx4 v[244:247], v2, s[8:11], s22 offen offset:3072 sc1
  s_waitcnt vmcnt(24)
  s_add_u32 s22, s31, 270336
  buffer_load_dwordx4 v[248:251], v2, s[8:11], s22 offen offset:0 sc1
  buffer_load_dwordx4 v[252:255], v2, s[8:11], s22 offen offset:1024 sc1
  v_mov_b32 v72, v116
  v_mov_b32 v73, v117
  v_lshrrev_b32 v65, 1, v72
  v_and_b32 v66, 1, v72
  v_add_u32 v67, 12, v65
  v_lshl_add_u32 v67, v67, 4, v73
  v_mul_u32_u24 v68, 2341, v67
  v_lshrrev_b32 v68, 16, v68
  v_mul_u32_u24 v69, 28, v68
  v_sub_u32 v69, v67, v69
  v_lshrrev_b32 v70, 4, v69
  v_and_b32 v69, 15, v69
  v_and_b32 v71, 1, v69
  v_lshrrev_b32 v69, 1, v69
  v_lshl_add_u32 v69, v71, 3, v69
  v_lshlrev_b32 v71, 12, v70
  v_lshl_add_u32 v71, v68, 8, v71
  v_lshl_add_u32 v71, v69, 4, v71
  v_lshl_add_u32 v112, v66, 3, v71
  v_add_u32 v67, 14, v65
  v_lshl_add_u32 v67, v67, 4, v73
  v_mul_u32_u24 v68, 2341, v67
  v_lshrrev_b32 v68, 16, v68
  v_mul_u32_u24 v69, 28, v68
  v_sub_u32 v69, v67, v69
  v_lshrrev_b32 v70, 4, v69
  v_and_b32 v69, 15, v69
  v_and_b32 v71, 1, v69
  v_lshrrev_b32 v69, 1, v69
  v_lshl_add_u32 v69, v71, 3, v69
  v_lshlrev_b32 v71, 12, v70
  v_lshl_add_u32 v71, v68, 8, v71
  v_lshl_add_u32 v71, v69, 4, v71
  v_lshl_add_u32 v113, v66, 3, v71
  v_add_u32 v67, 16, v65
  v_lshl_add_u32 v67, v67, 4, v73
  v_mul_u32_u24 v68, 2341, v67
  v_lshrrev_b32 v68, 16, v68
  v_mul_u32_u24 v69, 28, v68
  v_sub_u32 v69, v67, v69
  v_lshrrev_b32 v70, 4, v69
  v_and_b32 v69, 15, v69
  v_and_b32 v71, 1, v69
  v_lshrrev_b32 v69, 1, v69
  v_lshl_add_u32 v69, v71, 3, v69
  v_lshlrev_b32 v71, 12, v70
  v_lshl_add_u32 v71, v68, 8, v71
  v_lshl_add_u32 v71, v69, 4, v71
  v_lshl_add_u32 v114, v66, 3, v71
  v_add_u32 v67, 18, v65
  v_lshl_add_u32 v67, v67, 4, v73
  v_mul_u32_u24 v68, 2341, v67
  v_lshrrev_b32 v68, 16, v68
  v_mul_u32_u24 v69, 28, v68
  v_sub_u32 v69, v67, v69
  v_lshrrev_b32 v70, 4, v69
  v_and_b32 v69, 15, v69
  v_and_b32 v71, 1, v69
  v_lshrrev_b32 v69, 1, v69
  v_lshl_add_u32 v69, v71, 3, v69
  v_lshlrev_b32 v71, 12, v70
  v_lshl_add_u32 v71, v68, 8, v71
  v_lshl_add_u32 v71, v69, 4, v71
  v_lshl_add_u32 v115, v66, 3, v71
  s_mul_i32 s24, s17, 532480
  s_add_u32 s24, s24, 76926976
  s_mul_i32 s34, s17, 640
  s_add_u32 s34, s34, 88569856
  s_mul_i32 s36, s17, 448
  v_add_u32 v0, s36, v2
  v_add_u32 v0, 8192, v0
  s_add_u32 s36, s36, 88068096
  v_cmp_gt_u32 s[26:27], 28, v1
  v_and_b32 v119, 31, v1
  v_lshlrev_b32 v119, 2, v119
  s_add_u32 s22, s17, 16
  s_and_b32 s22, s22, 31
  s_lshl_b32 s22, s22, 7
  s_add_u32 s22, s22, 21504
  v_add_u32 v119, s22, v119
  v_min_u32 v118, 12, v1
  s_mul_i32 s22, s17, 13
  v_add_u32 v118, s22, v118
  v_lshlrev_b32 v118, 7, v118
  v_add_u32 v118, 51200, v118
  s_mov_b32 s39, 71565312
  v_add_u32 v1, 16384, v2
  v_mov_b32 v117, 1
  s_mul_i32 s38, s17, 1104
  s_add_u32 s38, s38, 25600
  s_lshl_b32 s22, 0, 11
  s_add_u32 s22, s22, 88590336
  v_add_u32 v36, 1024, v2
  v_min_u32 v36, 1776, v36
  s_mov_b32 s30, 0
va_iw6:
  buffer_load_dwordx4 v[40:43], v2, s[8:11], s22 offen sc1
  buffer_load_dwordx4 v[44:47], v36, s[8:11], s22 offen sc1
  s_waitcnt vmcnt(0)
  v_cmp_ne_u64 vcc, s[88:89], v[40:41]
  s_cbranch_vccnz va_iw6_no
  v_cmp_ne_u64 vcc, s[88:89], v[42:43]
  s_cbranch_vccnz va_iw6_no
  v_cmp_ne_u64 vcc, s[88:89], v[44:45]
  s_cbranch_vccnz va_iw6_no
  v_cmp_ne_u64 vcc, s[88:89], v[46:47]
  s_cbranch_vccnz va_iw6_no
  s_branch va_iw6_ok
va_iw6_no:
  s_sleep 2
  s_add_u32 s30, s30, 1
  s_cmp_lt_u32 s30, 50000
  s_cbranch_scc1 va_iw6
  s_branch cA_abort
va_iw6_ok:
  s_mov_b32 s30, 0
  v_mov_b32 v36, 0
ch_md6:
  buffer_load_dword v37, v36, s[12:15], 0 offen sc1
  s_waitcnt vmcnt(0)
  v_readfirstlane_b32 s22, v37
  s_and_b32 s31, s22, 0xffff
  s_cmp_ge_u32 s31, 32
  s_cbranch_scc1 ch_go6
  s_sleep 2
  s_add_u32 s30, s30, 1
  s_cmp_lt_u32 s30, 50000
  s_cbranch_scc1 ch_md6
  s_branch ch_end
ch_go6:
  s_mov_b32 s31, 0
  s_lshr_b32 s22, s22, 16
  s_cmp_lg_u32 s22, 0
  s_cbranch_scc1 cB_va2_loop
  s_branch cA_va2_loop
ch_init7:
  s_mul_i32 s31, s17, 401408
  s_add_u32 s31, s31, 6422528
  s_mul_i32 s22, s17, 28
  s_add_u32 s23, s22, 27
  s_lshr_b32 s22, s22, 6
  s_lshr_b32 s23, s23, 6
  s_sub_u32 s23, s23, s22
  s_lshl_b32 s23, s23, 8
  v_and_b32 v36, s23, v2
  v_med3_u32 v37, v117, 11, 15
  v_lshl_add_u32 v36, v37, 4, v36
  s_lshl_b32 s22, s22, 8
  s_add_u32 s22, s22, 88588288
  s_mov_b32 s30, 0
va_bw_16:
  buffer_load_dwordx4 v[40:43], v36, s[8:11], s22 offen sc1
  s_waitcnt vmcnt(0)
  v_cmp_ne_u64 vcc, s[88:89], v[40:41]
  s_cbranch_vccnz va_bw_16_no
  v_cmp_ne_u64 vcc, s[88:89], v[42:43]
  s_cbranch_vccnz va_bw_16_no
  s_branch va_bw_16_ok
va_bw_16_no:
  s_sleep 2
  s_add_u32 s30, s30, 1
  s_cmp_lt_u32 s30, 50000
  s_cbranch_scc1 va_bw_16
  s_branch cA_abort
va_bw_16_ok:
  s_add_u32 s22, s31, 286720
  buffer_load_dwordx4 a[0:3], v2, s[8:11], s22 offen offset:0 sc1
  buffer_load_dwordx4 a[4:7], v2, s[8:11], s22 offen offset:1024 sc1
  buffer_load_dwordx4 a[8:11], v2, s[8:11], s22 offen offset:2048 sc1
  buffer_load_dwordx4 a[12:15], v2, s[8:11], s22 offen offset:3072 sc1
  s_add_u32 s22, s31, 290816
  buffer_load_dwordx4 a[16:19], v2, s[8:11], s22 offen offset:0 sc1
  buffer_load_dwordx4 a[20:23], v2, s[8:11], s22 offen offset:1024 sc1
  buffer_load_dwordx4 a[24:27], v2, s[8:11], s22 offen offset:2048 sc1
  buffer_load_dwordx4 a[28:31], v2, s[8:11], s22 offen offset:3072 sc1
  s_add_u32 s22, s31, 294912
  buffer_load_dwordx4 a[32:35], v2, s[8:11], s22 offen offset:0 sc1
  buffer_load_dwordx4 a[36:39], v2, s[8:11], s22 offen offset:1024 sc1
  buffer_load_dwordx4 a[40:43], v2, s[8:11], s22 offen offset:2048 sc1
  buffer_load_dwordx4 a[44:47], v2, s[8:11], s22 offen offset:3072 sc1
  s_add_u32 s22, s31, 299008
  buffer_load_dwordx4 a[48:51], v2, s[8:11], s22 offen offset:0 sc1
  buffer_load_dwordx4 a[52:55], v2, s[8:11], s22 offen offset:1024 sc1
  buffer_load_dwordx4 a[56:59], v2, s[8:11], s22 offen offset:2048 sc1
  buffer_load_dwordx4 a[60:63], v2, s[8:11], s22 offen offset:3072 sc1
  s_add_u32 s22, s31, 303104
  buffer_load_dwordx4 a[64:67], v2, s[8:11], s22 offen offset:0 sc1
  buffer_load_dwordx4 a[68:71], v2, s[8:11], s22 offen offset:1024 sc1
  buffer_load_dwordx4 a[72:75], v2, s[8:11], s22 offen offset:2048 sc1
  buffer_load_dwordx4 a[76:79], v2, s[8:11], s22 offen offset:3072 sc1
  s_add_u32 s22, s31, 307200
  buffer_load_dwordx4 a[80:83], v2, s[8:11], s22 offen offset:0 sc1
  buffer_load_dwordx4 a[84:87], v2, s[8:11], s22 offen offset:1024 sc1
  buffer_load_dwordx4 a[88:91], v2, s[8:11], s22 offen offset:2048 sc1
  buffer_load_dwordx4 a[92:95], v2, s[8:11], s22 offen offset:3072 sc1
  s_add_u32 s22, s31, 311296
  buffer_load_dwordx4 a[96:99], v2, s[8:11], s22 offen offset:0 sc1
  buffer_load_dwordx4 a[100:103], v2, s[8:11], s22 offen offset:1024 sc1
  buffer_load_dwordx4 a[104:107], v2, s[8:11], s22 offen offset:2048 sc1
  buffer_load_dwordx4 a[108:111], v2, s[8:11], s22 offen offset:3072 sc1
  s_add_u32 s22, s31, 315392
  buffer_load_dwordx4 a[112:115], v2, s[8:11], s22 offen offset:0 sc1
  buffer_load_dwordx4 a[116:119], v2, s[8:11], s22 offen offset:1024 sc1
  buffer_load_dwordx4 a[120:123], v2, s[8:11], s22 offen offset:2048 sc1
  buffer_load_dwordx4 a[124:127], v2, s[8:11], s22 offen offset:3072 sc1
  s_waitcnt vmcnt(24)
  s_add_u32 s22, s31, 319488
  buffer_load_dwordx4 a[128:131], v2, s[8:11], s22 offen offset:0 sc1
  buffer_load_dwordx4 a[132:135], v2, s[8:11], s22 offen offset:1024 sc1
  buffer_load_dwordx4 a[136:139], v2, s[8:11], s22 offen offset:2048 sc1
  buffer_load_dwordx4 a[140:143], v2, s[8:11], s22 offen offset:3072 sc1
  s_add_u32 s22, s31, 323584
  buffer_load_dwordx4 a[144:147], v2, s[8:11], s22 offen offset:0 sc1
  buffer_load_dwordx4 a[148:151], v2, s[8:11], s22 offen offset:1024 sc1
  buffer_load_dwordx4 a[152:155], v2, s[8:11], s22 offen offset:2048 sc1
  buffer_load_dwordx4 a[156:159], v2, s[8:11], s22 offen offset:3072 sc1
  s_add_u32 s22, s31, 327680
  buffer_load_dwordx4 a[160:163], v2, s[8:11], s22 offen offset:0 sc1
  buffer_load_dwordx4 a[164:167], v2, s[8:11], s22 offen offset:1024 sc1
  buffer_load_dwordx4 a[168:171], v2, s[8:11], s22 offen offset:2048 sc1
  buffer_load_dwordx4 a[172:175], v2, s[8:11], s22 offen offset:3072 sc1
  s_add_u32 s22, s31, 331776
  buffer_load_dwordx4 a[176:179], v2, s[8:11], s22 offen offset:0 sc1
  buffer_load_dwordx4 a[180:183], v2, s[8:11], s22 offen offset:1024 sc1
  buffer_load_dwordx4 a[184:187], v2, s[8:11], s22 offen offset:2048 sc1
  buffer_load_dwordx4 a[188:191], v2, s[8:11], s22 offen offset:3072 sc1
  s_add_u32 s22, s31, 335872
  buffer_load_dwordx4 a[192:195], v2, s[8:11], s22 offen offset:0 sc1
  buffer_load_dwordx4 a[196:199], v2, s[8:11], s22 offen offset:1024 sc1
  buffer_load_dwordx4 a[200:203], v2, s[8:11], s22 offen offset:2048 sc1
  buffer_load_dwordx4 a[204:207], v2, s[8:11], s22 offen offset:3072 sc1
  s_add_u32 s22, s31, 339968
  buffer_load_dwordx4 a[208:211], v2, s[8:11], s22 offen offset:0 sc1
  buffer_load_dwordx4 a[212:215], v2, s[8:11], s22 offen offset:1024 sc1
  buffer_load_dwordx4 a[216:219], v2, s[8:11], s22 offen offset:2048 sc1
  buffer_load_dwordx4 a[220:223], v2, s[8:11], s22 offen offset:3072 sc1
  s_add_u32 s22, s31, 344064
  buffer_load_dwordx4 a[224:227], v2, s[8:11], s22 offen offset:0 sc1
  buffer_load_dwordx4 a[228:231], v2, s[8:11], s22 offen offset:1024 sc1
  buffer_load_dwordx4 a[232:235], v2, s[8:11], s22 offen offset:2048 sc1
  buffer_load_dwordx4 a[236:239], v2, s[8:11], s22 offen offset:3072 sc1
  s_add_u32 s22, s31, 348160
  buffer_load_dwordx4 a[240:243], v2, s[8:11], s22 offen offset:0 sc1
  buffer_load_dwordx4 a[244:247], v2, s[8:11], s22 offen offset:1024 sc1
  buffer_load_dwordx4 a[248:251], v2, s[8:11], s22 offen offset:2048 sc1
  buffer_load_dwordx4 a[252:255], v2, s[8:11], s22 offen offset:3072 sc1
  s_waitcnt vmcnt(24)
  s_add_u32 s22, s31, 352256
  buffer_load_dwordx4 v[120:123], v2, s[8:11], s22 offen offset:0 sc1
  buffer_load_dwordx4 v[124:127], v2, s[8:11], s22 offen offset:1024 sc1
  buffer_load_dwordx4 v[128:131], v2, s[8:11], s22 offen offset:2048 sc1
  buffer_load_dwordx4 v[132:135], v2, s[8:11], s22 offen offset:3072 sc1
  s_add_u32 s22, s31, 356352
  buffer_load_dwordx4 v[136:139], v2, s[8:11], s22 offen offset:0 sc1
  buffer_load_dwordx4 v[140:143], v2, s[8:11], s22 offen offset:1024 sc1
  buffer_load_dwordx4 v[144:147], v2, s[8:11], s22 offen offset:2048 sc1
  buffer_load_dwordx4 v[148:151], v2, s[8:11], s22 offen offset:3072 sc1
  s_add_u32 s22, s31, 360448
  buffer_load_dwordx4 v[152:155], v2, s[8:11], s22 offen offset:0 sc1
  buffer_load_dwordx4 v[156:159], v2, s[8:11], s22 offen offset:1024 sc1
  buffer_load_dwordx4 v[160:163], v2, s[8:11], s22 offen offset:2048 sc1
  buffer_load_dwordx4 v[164:167], v2, s[8:11], s22 offen offset:3072 sc1
  s_add_u32 s22, s31, 364544
  buffer_load_dwordx4 v[168:171], v2, s[8:11], s22 offen offset:0 sc1
  buffer_load_dwordx4 v[172:175], v2, s[8:11], s22 offen offset:1024 sc1
  buffer_load_dwordx4 v[176:179], v2, s[8:11], s22 offen offset:2048 sc1
  buffer_load_dwordx4 v[180:183], v2, s[8:11], s22 offen offset:3072 sc1
  s_add_u32 s22, s31, 368640
  buffer_load_dwordx4 v[184:187], v2, s[8:11], s22 offen offset:0 sc1
  buffer_load_dwordx4 v[188:191], v2, s[8:11], s22 offen offset:1024 sc1
  buffer_load_dwordx4 v[192:195], v2, s[8:11], s22 offen offset:2048 sc1
  buffer_load_dwordx4 v[196:199], v2, s[8:11], s22 offen offset:3072 sc1
  s_add_u32 s22, s31, 372736
  buffer_load_dwordx4 v[200:203], v2, s[8:11], s22 offen offset:0 sc1
  buffer_load_dwordx4 v[204:207], v2, s[8:11], s22 offen offset:1024 sc1
  buffer_load_dwordx4 v[208:211], v2, s[8:11], s22 offen offset:2048 sc1
  buffer_load_dwordx4 v[212:215], v2, s[8:11], s22 offen offset:3072 sc1
  s_add_u32 s22, s31, 376832
  buffer_load_dwordx4 v[216:219], v2, s[8:11], s22 offen offset:0 sc1
  buffer_load_dwordx4 v[220:223], v2, s[8:11], s22 offen offset:1024 sc1
  buffer_load_dwordx4 v[224:227], v2, s[8:11], s22 offen offset:2048 sc1
  buffer_load_dwordx4 v[228:231], v2, s[8:11], s22 offen offset:3072 sc1
  s_add_u32 s22, s31, 380928
  buffer_load_dwordx4 v[232:235], v2, s[8:11], s22 offen offset:0 sc1
  buffer_load_dwordx4 v[236:239], v2, s[8:11], s22 offen offset:1024 sc1
  buffer_load_dwordx4 v[240:243], v2, s[8:11], s22 offen offset:2048 sc1
  buffer_load_dwordx4 v[244:247], v2, s[8:11], s22 offen offset:3072 sc1
  s_waitcnt vmcnt(24)
  s_add_u32 s22, s31, 385024
  buffer_load_dwordx4 v[248:251], v2, s[8:11], s22 offen offset:0 sc1
  buffer_load_dwordx4 v[252:255], v2, s[8:11], s22 offen offset:1024 sc1
  v_mov_b32 v72, v116
  v_mov_b32 v73, v117
  v_lshrrev_b32 v65, 1, v72
  v_and_b32 v66, 1, v72
  v_add_u32 v67, 20, v65
  v_lshl_add_u32 v67, v67, 4, v73
  v_mul_u32_u24 v68, 2341, v67
  v_lshrrev_b32 v68, 16, v68
  v_mul_u32_u24 v69, 28, v68
  v_sub_u32 v69, v67, v69
  v_lshrrev_b32 v70, 4, v69
  v_and_b32 v69, 15, v69
  v_and_b32 v71, 1, v69
  v_lshrrev_b32 v69, 1, v69
  v_lshl_add_u32 v69, v71, 3, v69
  v_lshlrev_b32 v71, 12, v70
  v_lshl_add_u32 v71, v68, 8, v71
  v_lshl_add_u32 v71, v69, 4, v71
  v_lshl_add_u32 v112, v66, 3, v71
  v_add_u32 v67, 22, v65
  v_lshl_add_u32 v67, v67, 4, v73
  v_mul_u32_u24 v68, 2341, v67
  v_lshrrev_b32 v68, 16, v68
  v_mul_u32_u24 v69, 28, v68
  v_sub_u32 v69, v67, v69
  v_lshrrev_b32 v70, 4, v69
  v_and_b32 v69, 15, v69
  v_and_b32 v71, 1, v69
  v_lshrrev_b32 v69, 1, v69
  v_lshl_add_u32 v69, v71, 3, v69
  v_lshlrev_b32 v71, 12, v70
  v_lshl_add_u32 v71, v68, 8, v71
  v_lshl_add_u32 v71, v69, 4, v71
  v_lshl_add_u32 v113, v66, 3, v71
  v_add_u32 v67, 24, v65
  v_lshl_add_u32 v67, v67, 4, v73
  v_mul_u32_u24 v68, 2341, v67
  v_lshrrev_b32 v68, 16, v68
  v_mul_u32_u24 v69, 28, v68
  v_sub_u32 v69, v67, v69
  v_lshrrev_b32 v70, 4, v69
  v_and_b32 v69, 15, v69
  v_and_b32 v71, 1, v69
  v_lshrrev_b32 v69, 1, v69
  v_lshl_add_u32 v69, v71, 3, v69
  v_lshlrev_b32 v71, 12, v70
  v_lshl_add_u32 v71, v68, 8, v71
  v_lshl_add_u32 v71, v69, 4, v71
  v_lshl_add_u32 v114, v66, 3, v71
  v_add_u32 v67, 26, v65
  v_lshl_add_u32 v67, v67, 4, v73
  v_mul_u32_u24 v68, 2341, v67
  v_lshrrev_b32 v68, 16, v68
  v_mul_u32_u24 v69, 28, v68
  v_sub_u32 v69, v67, v69
  v_lshrrev_b32 v70, 4, v69
  v_and_b32 v69, 15, v69
  v_and_b32 v71, 1, v69
  v_lshrrev_b32 v69, 1, v69
  v_lshl_add_u32 v69, v71, 3, v69
  v_lshlrev_b32 v71, 12, v70
  v_lshl_add_u32 v71, v68, 8, v71
  v_lshl_add_u32 v71, v69, 4, v71
  v_lshl_add_u32 v115, v66, 3, v71
  s_mul_i32 s24, s17, 532480
  s_add_u32 s24, s24, 76931072
  s_mul_i32 s34, s17, 640
  s_add_u32 s34, s34, 88569860
  s_mul_i32 s36, s17, 448
  v_add_u32 v0, s36, v2
  v_add_u32 v0, 8192, v0
  s_add_u32 s36, s36, 88068096
  v_cmp_gt_u32 s[26:27], 28, v1
  v_and_b32 v119, 31, v1
  v_lshlrev_b32 v119, 2, v119
  s_add_u32 s22, s17, 16
  s_and_b32 s22, s22, 31
  s_lshl_b32 s22, s22, 7
  s_add_u32 s22, s22, 21504
  v_add_u32 v119, s22, v119
  v_min_u32 v118, 13, v1
  s_mul_i32 s22, s17, 14
  v_add_u32 v118, s22, v118
  v_lshlrev_b32 v118, 7, v118
  v_add_u32 v118, 57344, v118
  s_mov_b32 s39, 71565312
  v_add_u32 v1, 59392, v2
  v_mov_b32 v117, 1
  s_mul_i32 s38, s17, 1104
  s_add_u32 s38, s38, 26624
  s_lshl_b32 s22, 0, 11
  s_add_u32 s22, s22, 88590336
  v_add_u32 v36, 1024, v2
  v_min_u32 v36, 1776, v36
  s_mov_b32 s30, 0
va_iw7:
  buffer_load_dwordx4 v[40:43], v2, s[8:11], s22 offen sc1
  buffer_load_dwordx4 v[44:47], v36, s[8:11], s22 offen sc1
  s_waitcnt vmcnt(0)
  v_cmp_ne_u64 vcc, s[88:89], v[40:41]
  s_cbranch_vccnz va_iw7_no
  v_cmp_ne_u64 vcc, s[88:89], v[42:43]
  s_cbranch_vccnz va_iw7_no
  v_cmp_ne_u64 vcc, s[88:89], v[44:45]
  s_cbranch_vccnz va_iw7_no
  v_cmp_ne_u64 vcc, s[88:89], v[46:47]
  s_cbranch_vccnz va_iw7_no
  s_branch va_iw7_ok
va_iw7_no:
  s_sleep 2
  s_add_u32 s30, s30, 1
  s_cmp_lt_u32 s30, 50000
  s_cbranch_scc1 va_iw7
  s_branch cA_abort
va_iw7_ok:
  s_mov_b32 s30, 0
  v_mov_b32 v36, 0
ch_md7:
  buffer_load_dword v37, v36, s[12:15], 0 offen sc1
  s_waitcnt vmcnt(0)
  v_readfirstlane_b32 s22, v37
  s_and_b32 s31, s22, 0xffff
  s_cmp_ge_u32 s31, 32
  s_cbranch_scc1 ch_go7
  s_sleep 2
  s_add_u32 s30, s30, 1
  s_cmp_lt_u32 s30, 50000
  s_cbranch_scc1 ch_md7
  s_branch ch_end
ch_go7:
  s_mov_b32 s31, 0
  s_lshr_b32 s22, s22, 16
  s_cmp_lg_u32 s22, 0
  s_cbranch_scc1 cB_va3_loop
  s_branch cA_va3_loop
cA_sc0_loop:
  s_add_u32 s23, s20, 4096
  s_add_u32 s21, s20, 25600
  v_mov_b32 v48, 0
  v_mov_b32 v49, 0
  v_mov_b32 v50, 0
  v_mov_b32 v51, 0
  v_mov_b32 v52, 0
  v_mov_b32 v53, 0
  v_mov_b32 v54, 0
  v_mov_b32 v55, 0
  v_mov_b32 v56, 0
  v_mov_b32 v57, 0
  v_mov_b32 v58, 0
  v_mov_b32 v59, 0
  v_mov_b32 v60, 0
  v_mov_b32 v61, 0
  v_mov_b32 v62, 0
  v_mov_b32 v63, 0
  v_mov_b32 v88, 0
  v_mov_b32 v89, 0
  v_mov_b32 v90, 0
  v_mov_b32 v91, 0
  v_mov_b32 v92, 0
  v_mov_b32 v93, 0
  v_mov_b32 v94, 0
  v_mov_b32 v95, 0
  v_mov_b32 v66, 0
  v_mov_b32 v67, 0
  s_mov_b32 s30, 0
  s_mov_b32 s62, 0
  buffer_load_dword v68, v0, s[8:11], s20 offen sc1
  s_nop 7
  buffer_load_dword v69, v0, s[8:11], s20 offen sc1
  s_nop 7
  buffer_load_dword v70, v0, s[8:11], s20 offen sc1
  s_nop 7
  buffer_load_dword v71, v0, s[8:11], s20 offen sc1
  s_nop 7
  buffer_load_dword v72, v0, s[8:11], s20 offen sc1
cA_sc0_fp_l:
  s_waitcnt vmcnt(4)
  v_cmp_eq_u32 vcc, -1, v68
  s_cbranch_vccz cA_sc0_fp_d
  buffer_load_dword v68, v0, s[8:11], s20 offen sc1
  s_waitcnt vmcnt(4)
  v_cmp_eq_u32 vcc, -1, v69
  s_cbranch_vccz cA_sc0_fp_d
  buffer_load_dword v69, v0, s[8:11], s20 offen sc1
  s_waitcnt vmcnt(4)
  v_cmp_eq_u32 vcc, -1, v70
  s_cbranch_vccz cA_sc0_fp_d
  buffer_load_dword v70, v0, s[8:11], s20 offen sc1
  s_waitcnt vmcnt(4)
  v_cmp_eq_u32 vcc, -1, v71
  s_cbranch_vccz cA_sc0_fp_d
  buffer_load_dword v71, v0, s[8:11], s20 offen sc1
  s_waitcnt vmcnt(4)
  v_cmp_eq_u32 vcc, -1, v72
  s_cbranch_vccz cA_sc0_fp_d
  buffer_load_dword v72, v0, s[8:11], s20 offen sc1
  s_add_u32 s30, s30, 1
  s_cmp_lt_u32 s30, 400000
  s_cbranch_scc1 cA_sc0_fp_l
  s_branch cA_abort
cA_sc0_fp_d:
  buffer_load_dwordx4 v[8:11], v2, s[8:11], s20 offen offset:0
  s_barrier
  s_branch cA_sc0_ld1
cA_sc0_ld:
  buffer_load_dwordx4 v[8:11], v2, s[8:11], s20 offen offset:0
cA_sc0_ld1:
  v_mov_b32 v36, 0
  v_mov_b32 v37, 0
  v_mov_b32 v38, 0
  v_mov_b32 v39, 0
  buffer_load_dwordx4 v[12:15], v2, s[8:11], s20 offen offset:1024
  v_mov_b32 v40, 0
  v_mov_b32 v41, 0
  v_mov_b32 v42, 0
  v_mov_b32 v43, 0
  buffer_load_dwordx4 v[16:19], v2, s[8:11], s20 offen offset:2048
  v_mov_b32 v44, 0
  v_mov_b32 v45, 0
  v_mov_b32 v46, 0
  v_mov_b32 v47, 0
  ds_read_b128 v[96:99], v117 offset:0
  ds_read_b128 v[100:103], v117 offset:1024
  ds_read_b128 v[104:107], v117 offset:14336
  ds_read_b128 v[108:111], v117 offset:15360
  s_waitcnt vmcnt(2)
  v_smfmac_f32_16x16x64_bf16 v[36:39], v[8:11], a[0:7], v3
  v_smfmac_f32_16x16x64_bf16 v[40:43], v[8:11], a[56:63], v3
  buffer_load_dwordx4 v[20:23], v2, s[8:11], s20 offen offset:3072
  v_smfmac_f32_16x16x64_bf16 v[44:47], v[8:11], a[112:119], v3
  v_smfmac_f32_16x16x64_bf16 v[48:51], v[8:11], a[168:175], v3
  v_smfmac_f32_16x16x64_bf16 v[52:55], v[8:11], a[224:231], v3
  buffer_load_dwordx4 v[24:27], v2, s[8:11], s23 offen offset:0
  v_smfmac_f32_16x16x64_bf16 v[56:59], v[8:11], v[144:151], v3
  v_smfmac_f32_16x16x64_bf16 v[60:63], v[8:11], v[200:207], v3
  s_waitcnt vmcnt(3)
  v_smfmac_f32_16x16x64_bf16 v[36:39], v[12:15], a[8:15], v3
  v_smfmac_f32_16x16x64_bf16 v[40:43], v[12:15], a[64:71], v3
  buffer_load_dwordx4 v[28:31], v2, s[8:11], s23 offen offset:1024
  v_smfmac_f32_16x16x64_bf16 v[44:47], v[12:15], a[120:127], v3
  v_smfmac_f32_16x16x64_bf16 v[48:51], v[12:15], a[176:183], v3
  v_smfmac_f32_16x16x64_bf16 v[52:55], v[12:15], a[232:239], v3
  buffer_load_dwordx4 v[32:35], v2, s[8:11], s23 offen offset:2048
  v_smfmac_f32_16x16x64_bf16 v[56:59], v[12:15], v[152:159], v3
  v_smfmac_f32_16x16x64_bf16 v[60:63], v[12:15], v[208:215], v3
  s_waitcnt vmcnt(4)
  v_smfmac_f32_16x16x64_bf16 v[36:39], v[16:19], a[16:23], v3
  v_smfmac_f32_16x16x64_bf16 v[40:43], v[16:19], a[72:79], v3
  v_smfmac_f32_16x16x64_bf16 v[44:47], v[16:19], a[128:135], v3
  v_smfmac_f32_16x16x64_bf16 v[48:51], v[16:19], a[184:191], v3
  v_smfmac_f32_16x16x64_bf16 v[52:55], v[16:19], a[240:247], v3
  v_smfmac_f32_16x16x64_bf16 v[56:59], v[16:19], v[160:167], v3
  v_smfmac_f32_16x16x64_bf16 v[60:63], v[16:19], v[216:223], v3
  s_waitcnt vmcnt(3)
  v_smfmac_f32_16x16x64_bf16 v[36:39], v[20:23], a[24:31], v3
  v_smfmac_f32_16x16x64_bf16 v[40:43], v[20:23], a[80:87], v3
  v_smfmac_f32_16x16x64_bf16 v[44:47], v[20:23], a[136:143], v3
  v_smfmac_f32_16x16x64_bf16 v[48:51], v[20:23], a[192:199], v3
  v_smfmac_f32_16x16x64_bf16 v[52:55], v[20:23], a[248:255], v3
  v_smfmac_f32_16x16x64_bf16 v[56:59], v[20:23], v[168:175], v3
  v_smfmac_f32_16x16x64_bf16 v[60:63], v[20:23], v[224:231], v3
  s_waitcnt vmcnt(0)
cA_sc0_ph2:
  v_smfmac_f32_16x16x64_bf16 v[60:63], v[24:27], v[232:239], v3
  ds_read_b128 v[12:15], v116 offset:0
  ds_read_b128 v[16:19], v116 offset:1024
  v_smfmac_f32_16x16x64_bf16 v[60:63], v[28:31], v[240:247], v3
  v_smfmac_f32_16x16x64_bf16 v[60:63], v[32:35], v[248:255], v3
  v_mov_b32 v80, v24
  v_smfmac_f32_16x16x64_bf16 v[52:55], v[24:27], v[120:127], v3
  v_mov_b32 v81, v25
  v_smfmac_f32_16x16x64_bf16 v[52:55], v[28:31], v[128:135], v3
  v_mov_b32 v82, v32
  v_smfmac_f32_16x16x64_bf16 v[52:55], v[32:35], v[136:143], v3
  v_cvt_pk_bf16_f32 v64, v60, v61
  v_smfmac_f32_16x16x64_bf16 v[56:59], v[24:27], v[176:183], v3
  v_cvt_pk_bf16_f32 v65, v62, v63
  v_smfmac_f32_16x16x64_bf16 v[56:59], v[28:31], v[184:191], v3
  v_mov_b32 v83, v33
  v_mfma_f32_16x16x32_bf16 v[68:71], v[64:67], v[4:7], 0
  v_smfmac_f32_16x16x64_bf16 v[56:59], v[32:35], v[192:199], v3
  v_cvt_pk_bf16_f32 v64, v52, v53
  v_smfmac_f32_16x16x64_bf16 v[36:39], v[24:27], a[32:39], v3
  v_cvt_pk_bf16_f32 v65, v54, v55
  v_smfmac_f32_16x16x64_bf16 v[36:39], v[28:31], a[40:47], v3
  v_cvt_pk_bf16_f32 v78, v68, v69
  v_smfmac_f32_16x16x64_bf16 v[36:39], v[32:35], a[48:55], v3
  v_cvt_pk_bf16_f32 v79, v70, v71
  v_cvt_pk_bf16_f32 v66, v56, v57
  v_smfmac_f32_16x16x64_bf16 v[40:43], v[24:27], a[88:95], v3
  v_cvt_pk_bf16_f32 v67, v58, v59
  v_smfmac_f32_16x16x64_bf16 v[40:43], v[28:31], a[96:103], v3
  v_mfma_f32_16x16x32_bf16 v[72:75], v[64:67], v[4:7], 0
  ds_read_b128 v[52:55], v116 offset:14336
  ds_read_b128 v[56:59], v116 offset:15360
  v_smfmac_f32_16x16x64_bf16 v[40:43], v[32:35], a[104:111], v3
  v_cvt_pk_bf16_f32 v64, v36, v37
  v_smfmac_f32_16x16x64_bf16 v[44:47], v[24:27], a[144:151], v3
  v_cvt_pk_bf16_f32 v65, v38, v39
  v_smfmac_f32_16x16x64_bf16 v[44:47], v[28:31], a[152:159], v3
  v_cvt_pk_bf16_f32 v76, v72, v73
  v_smfmac_f32_16x16x64_bf16 v[44:47], v[32:35], a[160:167], v3
  v_cvt_pk_bf16_f32 v77, v74, v75
  v_cvt_pk_bf16_f32 v66, v40, v41
  v_smfmac_f32_16x16x64_bf16 v[48:51], v[24:27], a[200:207], v3
  v_cvt_pk_bf16_f32 v67, v42, v43
  v_smfmac_f32_16x16x64_bf16 v[48:51], v[28:31], a[208:215], v3
  v_mfma_f32_16x16x32_bf16 v[68:71], v[64:67], v[4:7], 0
  v_smfmac_f32_16x16x64_bf16 v[48:51], v[32:35], a[216:223], v3
  v_cvt_pk_bf16_f32 v64, v44, v45
  v_mfma_f32_16x16x32_bf16 v[84:87], v[80:83], v[76:79], 0
  v_cvt_pk_bf16_f32 v65, v46, v47
  s_waitcnt lgkmcnt(0)
  v_smfmac_f32_16x16x64_bf16 v[88:91], v[76:79], v[96:103], v3
  v_cvt_pk_bf16_f32 v60, v68, v69
  v_cvt_pk_bf16_f32 v61, v70, v71
  v_cvt_pk_bf16_f32 v66, v48, v49
  v_cvt_pk_bf16_f32 v67, v50, v51
  s_nop 1
  v_mfma_f32_16x16x32_bf16 v[72:75], v[64:67], v[4:7], 0
  v_smfmac_f32_16x16x64_bf16 v[92:95], v[76:79], v[104:111], v3
  s_nop 4
  v_cvt_pk_bf16_f32 v62, v72, v73
  v_cvt_pk_bf16_f32 v63, v74, v75
  s_nop 1
  v_mfma_f32_16x16x32_bf16 v[84:87], v[8:11], v[60:63], v[84:87]
  v_smfmac_f32_16x16x64_bf16 v[88:91], v[60:63], v[12:19], v3
  v_smfmac_f32_16x16x64_bf16 v[92:95], v[60:63], v[52:59], v3
  s_mov_b64 exec, s[26:27]
  s_nop 0
  ds_write_b128 v113, v[84:87]
  s_mov_b64 exec, -1
  s_nop 0
  v_cmp_u_f32 vcc, v88, v89
  s_nop 1
  v_permlane32_swap_b32 v88, v92
  v_permlane32_swap_b32 v89, v93
  v_permlane32_swap_b32 v90, v94
  v_permlane32_swap_b32 v91, v95
  v_add_f32 v88, v88, v92
  v_add_f32 v89, v89, v93
  v_add_f32 v90, v90, v94
  v_add_f32 v91, v91, v95
  ds_write_b128 v112, v[88:91]
  s_cbranch_vccnz cA_sc0_retry
cA_sc0_cont:
  s_waitcnt lgkmcnt(0)
  s_barrier
  ds_read_b64 v[36:37], v114 offset:0
  ds_read_b64 v[38:39], v114 offset:1024
  ds_read2_b32 v[44:45], v115 offset0:0 offset1:64
  s_waitcnt lgkmcnt(0)
  v_add_f32 v44, v44, v45
  v_add_f32 v36, v36, v38
  v_add_f32 v37, v37, v39
  v_add_f32_dpp v44, v44, v44 row_ror:8 row_mask:0xf bank_mask:0xf
  v_mov_b32 v45, v44
  v_permlane32_swap_b32 v36, v37
  v_add_f32 v36, v36, v37
  v_permlane16_swap_b32 v44, v45
  v_add_f32 v44, v44, v45
  v_exp_f32 v48, v36
  v_exp_f32 v49, v44
  v_add_f32 v50, abs(v36), abs(v44)
  v_fma_f32 v39, v49, s37, v48
  v_cmp_ngt_f32 vcc, s56, v50
  v_cndmask_b32 v41, v48, v49, s[38:39]
  v_add_f32_dpp v39, v39, v39 quad_perm:[1,0,3,2] row_mask:0xf bank_mask:0xf
  v_cndmask_b32 v40, v49, v48, s[38:39]
  v_mov_b32_dpp v46, v41 quad_perm:[1,0,3,2] row_mask:0xf bank_mask:0xf
  v_add_f32_dpp v39, v39, v39 quad_perm:[2,3,0,1] row_mask:0xf bank_mask:0xf
  v_cndmask_b32 v42, v46, v40, s[38:39]
  v_cndmask_b32 v43, v40, v46, s[38:39]
  v_add_f32_dpp v39, v39, v39 row_half_mirror row_mask:0xf bank_mask:0xf
  s_cbranch_vccnz cA_sc0_slow
  s_nop 0
  v_add_f32_dpp v39, v39, v39 row_mirror row_mask:0xf bank_mask:0xf
  v_mov_b32 v47, v39
  s_nop 1
  v_permlane16_swap_b32 v39, v47
  v_add_f32 v39, v39, v47
  v_rcp_f32 v39, v39
  s_mov_b64 exec, s[28:29]
  v_mul_f32 v42, v42, v39
  v_mul_f32 v43, v43, v39
  v_cvt_pk_bf16_f32 v42, v42, v43
cA_sc0_pst:
  buffer_store_dword v42, v1, s[8:11], s20 offen
  s_mov_b64 exec, -1
  s_barrier
  s_add_u32 s24, s24, 28672
  s_add_u32 s35, s35, 28672
  s_xor_b32 s25, s25, 28672
  s_add_u32 m0, s25, 0
  s_nop 0
  buffer_load_dwordx4 v2, s[8:11], s24 offen offset:0 sc1 lds
  buffer_load_dwordx4 v2, s[8:11], s24 offen offset:1024 sc1 lds
  buffer_load_dwordx4 v2, s[8:11], s24 offen offset:2048 sc1 lds
  buffer_load_dwordx4 v2, s[8:11], s24 offen offset:3072 sc1 lds
  s_add_u32 m0, s25, 4096
  s_add_u32 s22, s24, 4096
  buffer_load_dwordx4 v2, s[8:11], s22 offen offset:0 sc1 lds
  buffer_load_dwordx4 v2, s[8:11], s22 offen offset:1024 sc1 lds
  buffer_load_dwordx4 v2, s[8:11], s22 offen offset:2048 sc1 lds
  v_xor_b32 v116, 28672, v116
  v_add_u32 v117, s57, v117
  s_sub_u32 s57, 0, s57
  s_add_u32 s19, s19, 1
  s_mov_b32 s20, s21
  s_cmp_lt_u32 s19, 63
  s_cbranch_scc1 cA_sc0_loop
  s_branch cA_done
cA_sc0_slow:
  v_max_f32 v50, v36, v44
  s_nop 1
  v_max_f32_dpp v50, v50, v50 quad_perm:[1,0,3,2] row_mask:0xf bank_mask:0xf
  s_nop 1
  v_max_f32_dpp v50, v50, v50 quad_perm:[2,3,0,1] row_mask:0xf bank_mask:0xf
  s_nop 1
  v_max_f32_dpp v50, v50, v50 row_half_mirror row_mask:0xf bank_mask:0xf
  s_nop 1
  v_max_f32_dpp v50, v50, v50 row_mirror row_mask:0xf bank_mask:0xf
  v_mov_b32 v47, v50
  s_nop 1
  v_permlane16_swap_b32 v50, v47
  v_max_f32 v50, v50, v47
  v_sub_f32 v48, v36, v50
  v_sub_f32 v49, v44, v50
  v_exp_f32 v48, v48
  v_exp_f32 v49, v49
  s_add_u32 s31, s31, 0x100
  v_fma_f32 v39, v49, s37, v48
  v_cndmask_b32 v41, v48, v49, s[38:39]
  s_nop 0
  v_add_f32_dpp v39, v39, v39 quad_perm:[1,0,3,2] row_mask:0xf bank_mask:0xf
  v_cndmask_b32 v40, v49, v48, s[38:39]
  v_mov_b32_dpp v46, v41 quad_perm:[1,0,3,2] row_mask:0xf bank_mask:0xf
  v_add_f32_dpp v39, v39, v39 quad_perm:[2,3,0,1] row_mask:0xf bank_mask:0xf
  v_cndmask_b32 v42, v46, v40, s[38:39]
  v_cndmask_b32 v43, v40, v46, s[38:39]
  v_add_f32_dpp v39, v39, v39 row_half_mirror row_mask:0xf bank_mask:0xf
  s_nop 1
  v_add_f32_dpp v39, v39, v39 row_mirror row_mask:0xf bank_mask:0xf
  v_mov_b32 v47, v39
  s_nop 1
  v_permlane16_swap_b32 v39, v47
  v_add_f32 v39, v39, v47
  v_rcp_f32 v39, v39
  s_mov_b64 exec, s[28:29]
  v_mul_f32 v42, v42, v39
  v_mul_f32 v43, v43, v39
  v_cvt_pk_bf16_f32 v42, v42, v43
  v_min_u32 v42, -2, v42
  s_branch cA_sc0_pst
cA_sc0_retry:
  s_cmp_lg_u32 s62, 0
  s_cbranch_scc1 cA_sc0_cont
  s_waitcnt vmcnt(0) lgkmcnt(0)
cA_sc0_rv:
  buffer_load_dwordx4 v[8:11], v2, s[8:11], s20 offen offset:0 sc1
  buffer_load_dwordx4 v[12:15], v2, s[8:11], s20 offen offset:1024 sc1
  buffer_load_dwordx4 v[16:19], v2, s[8:11], s20 offen offset:2048 sc1
  buffer_load_dwordx4 v[20:23], v2, s[8:11], s20 offen offset:3072 sc1
  buffer_load_dwordx4 v[24:27], v2, s[8:11], s23 offen offset:0 sc1
  buffer_load_dwordx4 v[28:31], v2, s[8:11], s23 offen offset:1024 sc1
  buffer_load_dwordx4 v[32:35], v2, s[8:11], s23 offen offset:2048 sc1
  s_waitcnt vmcnt(0)
  v_max3_u32 v118, v8, v9, v10
  v_max3_u32 v118, v118, v11, v12
  v_max3_u32 v118, v118, v13, v14
  v_max3_u32 v118, v118, v15, v16
  v_max3_u32 v118, v118, v17, v18
  v_max3_u32 v118, v118, v19, v20
  v_max3_u32 v118, v118, v21, v22
  v_max3_u32 v118, v118, v23, v24
  v_max3_u32 v118, v118, v25, v26
  v_max3_u32 v118, v118, v27, v28
  v_max3_u32 v118, v118, v29, v30
  v_max3_u32 v118, v118, v31, v32
  v_max3_u32 v118, v118, v33, v34
  v_max_u32 v118, v118, v35
  v_cmp_eq_u32 vcc, -1, v118
  s_cbranch_vccz cA_sc0_rk
  s_add_u32 s30, s30, 1
  s_cmp_lt_u32 s30, 400000
  s_cbranch_scc1 cA_sc0_rv
  s_branch cA_abort
cA_sc0_rk:
  s_mov_b32 s62, 1
  v_mov_b32 v36, 0
  v_mov_b32 v37, 0
  v_mov_b32 v38, 0
  v_mov_b32 v39, 0
  v_mov_b32 v40, 0
  v_mov_b32 v41, 0
  v_mov_b32 v42, 0
  v_mov_b32 v43, 0
  v_mov_b32 v44, 0
  v_mov_b32 v45, 0
  v_mov_b32 v46, 0
  v_mov_b32 v47, 0
  v_mov_b32 v48, 0
  v_mov_b32 v49, 0
  v_mov_b32 v50, 0
  v_mov_b32 v51, 0
  v_mov_b32 v52, 0
  v_mov_b32 v53, 0
  v_mov_b32 v54, 0
  v_mov_b32 v55, 0
  v_mov_b32 v56, 0
  v_mov_b32 v57, 0
  v_mov_b32 v58, 0
  v_mov_b32 v59, 0
  v_mov_b32 v60, 0
  v_mov_b32 v61, 0
  v_mov_b32 v62, 0
  v_mov_b32 v63, 0
  v_mov_b32 v88, 0
  v_mov_b32 v89, 0
  v_mov_b32 v90, 0
  v_mov_b32 v91, 0
  v_mov_b32 v92, 0
  v_mov_b32 v93, 0
  v_mov_b32 v94, 0
  v_mov_b32 v95, 0
  v_mov_b32 v66, 0
  v_mov_b32 v67, 0
  s_add_u32 s31, s31, 1
  ds_read_b128 v[96:99], v117 offset:0
  ds_read_b128 v[100:103], v117 offset:1024
  ds_read_b128 v[104:107], v117 offset:14336
  ds_read_b128 v[108:111], v117 offset:15360
  v_smfmac_f32_16x16x64_bf16 v[36:39], v[8:11], a[0:7], v3
  v_smfmac_f32_16x16x64_bf16 v[40:43], v[8:11], a[56:63], v3
  v_smfmac_f32_16x16x64_bf16 v[44:47], v[8:11], a[112:119], v3
  v_smfmac_f32_16x16x64_bf16 v[48:51], v[8:11], a[168:175], v3
  v_smfmac_f32_16x16x64_bf16 v[52:55], v[8:11], a[224:231], v3
  v_smfmac_f32_16x16x64_bf16 v[56:59], v[8:11], v[144:151], v3
  v_smfmac_f32_16x16x64_bf16 v[60:63], v[8:11], v[200:207], v3
  v_smfmac_f32_16x16x64_bf16 v[36:39], v[12:15], a[8:15], v3
  v_smfmac_f32_16x16x64_bf16 v[40:43], v[12:15], a[64:71], v3
  v_smfmac_f32_16x16x64_bf16 v[44:47], v[12:15], a[120:127], v3
  v_smfmac_f32_16x16x64_bf16 v[48:51], v[12:15], a[176:183], v3
  v_smfmac_f32_16x16x64_bf16 v[52:55], v[12:15], a[232:239], v3
  v_smfmac_f32_16x16x64_bf16 v[56:59], v[12:15], v[152:159], v3
  v_smfmac_f32_16x16x64_bf16 v[60:63], v[12:15], v[208:215], v3
  v_smfmac_f32_16x16x64_bf16 v[36:39], v[16:19], a[16:23], v3
  v_smfmac_f32_16x16x64_bf16 v[40:43], v[16:19], a[72:79], v3
  v_smfmac_f32_16x16x64_bf16 v[44:47], v[16:19], a[128:135], v3
  v_smfmac_f32_16x16x64_bf16 v[48:51], v[16:19], a[184:191], v3
  v_smfmac_f32_16x16x64_bf16 v[52:55], v[16:19], a[240:247], v3
  v_smfmac_f32_16x16x64_bf16 v[56:59], v[16:19], v[160:167], v3
  v_smfmac_f32_16x16x64_bf16 v[60:63], v[16:19], v[216:223], v3
  v_smfmac_f32_16x16x64_bf16 v[36:39], v[20:23], a[24:31], v3
  v_smfmac_f32_16x16x64_bf16 v[40:43], v[20:23], a[80:87], v3
  v_smfmac_f32_16x16x64_bf16 v[44:47], v[20:23], a[136:143], v3
  v_smfmac_f32_16x16x64_bf16 v[48:51], v[20:23], a[192:199], v3
  v_smfmac_f32_16x16x64_bf16 v[52:55], v[20:23], a[248:255], v3
  v_smfmac_f32_16x16x64_bf16 v[56:59], v[20:23], v[168:175], v3
  v_smfmac_f32_16x16x64_bf16 v[60:63], v[20:23], v[224:231], v3
  s_branch cA_sc0_ph2
cA_sc1_loop:
  s_add_u32 s23, s20, 4096
  s_add_u32 s21, s20, 25600
  v_mov_b32 v48, 0
  v_mov_b32 v49, 0
  v_mov_b32 v50, 0
  v_mov_b32 v51, 0
  v_mov_b32 v52, 0
  v_mov_b32 v53, 0
  v_mov_b32 v54, 0
  v_mov_b32 v55, 0
  v_mov_b32 v56, 0
  v_mov_b32 v57, 0
  v_mov_b32 v58, 0
  v_mov_b32 v59, 0
  v_mov_b32 v60, 0
  v_mov_b32 v61, 0
  v_mov_b32 v62, 0
  v_mov_b32 v63, 0
  v_mov_b32 v88, 0
  v_mov_b32 v89, 0
  v_mov_b32 v90, 0
  v_mov_b32 v91, 0
  v_mov_b32 v92, 0
  v_mov_b32 v93, 0
  v_mov_b32 v94, 0
  v_mov_b32 v95, 0
  v_mov_b32 v64, 0
  v_mov_b32 v65, 0
  s_mov_b32 s30, 0
  s_mov_b32 s62, 0
  s_waitcnt vmcnt(0)
  s_barrier
cA_sc1_ld:
  buffer_load_dwordx4 v[8:11], v2, s[8:11], s20 offen offset:0
  v_mov_b32 v36, 0
  v_mov_b32 v37, 0
  v_mov_b32 v38, 0
  v_mov_b32 v39, 0
  buffer_load_dwordx4 v[12:15], v2, s[8:11], s20 offen offset:1024
  v_mov_b32 v40, 0
  v_mov_b32 v41, 0
  v_mov_b32 v42, 0
  v_mov_b32 v43, 0
  buffer_load_dwordx4 v[16:19], v2, s[8:11], s20 offen offset:2048
  v_mov_b32 v44, 0
  v_mov_b32 v45, 0
  v_mov_b32 v46, 0
  v_mov_b32 v47, 0
  ds_read_b128 v[96:99], v117 offset:0
  ds_read_b128 v[100:103], v117 offset:1024
  ds_read_b128 v[104:107], v117 offset:14336
  ds_read_b128 v[108:111], v117 offset:15360
  s_waitcnt vmcnt(2)
  v_smfmac_f32_16x16x64_bf16 v[36:39], v[8:11], a[0:7], v3
  v_smfmac_f32_16x16x64_bf16 v[40:43], v[8:11], a[56:63], v3
  buffer_load_dwordx4 v[20:23], v2, s[8:11], s20 offen offset:3072
  v_smfmac_f32_16x16x64_bf16 v[44:47], v[8:11], a[112:119], v3
  v_smfmac_f32_16x16x64_bf16 v[48:51], v[8:11], a[168:175], v3
  v_smfmac_f32_16x16x64_bf16 v[52:55], v[8:11], a[224:231], v3
  buffer_load_dwordx4 v[24:27], v2, s[8:11], s23 offen offset:0
  v_smfmac_f32_16x16x64_bf16 v[56:59], v[8:11], v[144:151], v3
  v_smfmac_f32_16x16x64_bf16 v[60:63], v[8:11], v[200:207], v3
  s_waitcnt vmcnt(3)
  v_smfmac_f32_16x16x64_bf16 v[36:39], v[12:15], a[8:15], v3
  v_smfmac_f32_16x16x64_bf16 v[40:43], v[12:15], a[64:71], v3
  buffer_load_dwordx4 v[28:31], v2, s[8:11], s23 offen offset:1024
  v_smfmac_f32_16x16x64_bf16 v[44:47], v[12:15], a[120:127], v3
  v_smfmac_f32_16x16x64_bf16 v[48:51], v[12:15], a[176:183], v3
  v_smfmac_f32_16x16x64_bf16 v[52:55], v[12:15], a[232:239], v3
  buffer_load_dwordx4 v[32:35], v2, s[8:11], s23 offen offset:2048
  v_smfmac_f32_16x16x64_bf16 v[56:59], v[12:15], v[152:159], v3
  v_smfmac_f32_16x16x64_bf16 v[60:63], v[12:15], v[208:215], v3
  s_waitcnt vmcnt(4)
  v_smfmac_f32_16x16x64_bf16 v[36:39], v[16:19], a[16:23], v3
  v_smfmac_f32_16x16x64_bf16 v[40:43], v[16:19], a[72:79], v3
  v_smfmac_f32_16x16x64_bf16 v[44:47], v[16:19], a[128:135], v3
  v_smfmac_f32_16x16x64_bf16 v[48:51], v[16:19], a[184:191], v3
  v_smfmac_f32_16x16x64_bf16 v[52:55], v[16:19], a[240:247], v3
  v_smfmac_f32_16x16x64_bf16 v[56:59], v[16:19], v[160:167], v3
  v_smfmac_f32_16x16x64_bf16 v[60:63], v[16:19], v[216:223], v3
  s_waitcnt vmcnt(3)
  v_smfmac_f32_16x16x64_bf16 v[36:39], v[20:23], a[24:31], v3
  v_smfmac_f32_16x16x64_bf16 v[40:43], v[20:23], a[80:87], v3
  v_smfmac_f32_16x16x64_bf16 v[44:47], v[20:23], a[136:143], v3
  v_smfmac_f32_16x16x64_bf16 v[48:51], v[20:23], a[192:199], v3
  v_smfmac_f32_16x16x64_bf16 v[52:55], v[20:23], a[248:255], v3
  v_smfmac_f32_16x16x64_bf16 v[56:59], v[20:23], v[168:175], v3
  v_smfmac_f32_16x16x64_bf16 v[60:63], v[20:23], v[224:231], v3
  s_waitcnt vmcnt(0)
cA_sc1_ph2:
  v_smfmac_f32_16x16x64_bf16 v[60:63], v[24:27], v[232:239], v3
  ds_read_b128 v[16:19], v116 offset:2048
  ds_read_b128 v[20:23], v116 offset:3072
  v_smfmac_f32_16x16x64_bf16 v[60:63], v[28:31], v[240:247], v3
  buffer_load_dword v119, v0, s[8:11], s20 offen sc1
  v_smfmac_f32_16x16x64_bf16 v[60:63], v[32:35], v[248:255], v3
  v_mov_b32 v80, v26
  v_smfmac_f32_16x16x64_bf16 v[52:55], v[24:27], v[120:127], v3
  v_mov_b32 v81, v27
  v_smfmac_f32_16x16x64_bf16 v[52:55], v[28:31], v[128:135], v3
  v_mov_b32 v82, v32
  v_smfmac_f32_16x16x64_bf16 v[52:55], v[32:35], v[136:143], v3
  v_cvt_pk_bf16_f32 v66, v60, v61
  v_smfmac_f32_16x16x64_bf16 v[56:59], v[24:27], v[176:183], v3
  v_cvt_pk_bf16_f32 v67, v62, v63
  v_smfmac_f32_16x16x64_bf16 v[56:59], v[28:31], v[184:191], v3
  v_mov_b32 v83, v33
  v_mfma_f32_16x16x32_bf16 v[68:71], v[64:67], v[4:7], 0
  v_smfmac_f32_16x16x64_bf16 v[56:59], v[32:35], v[192:199], v3
  v_cvt_pk_bf16_f32 v64, v52, v53
  v_smfmac_f32_16x16x64_bf16 v[36:39], v[24:27], a[32:39], v3
  v_cvt_pk_bf16_f32 v65, v54, v55
  v_smfmac_f32_16x16x64_bf16 v[36:39], v[28:31], a[40:47], v3
  v_cvt_pk_bf16_f32 v78, v68, v69
  v_smfmac_f32_16x16x64_bf16 v[36:39], v[32:35], a[48:55], v3
  v_cvt_pk_bf16_f32 v79, v70, v71
  v_cvt_pk_bf16_f32 v66, v56, v57
  v_smfmac_f32_16x16x64_bf16 v[40:43], v[24:27], a[88:95], v3
  v_cvt_pk_bf16_f32 v67, v58, v59
  v_smfmac_f32_16x16x64_bf16 v[40:43], v[28:31], a[96:103], v3
  v_mfma_f32_16x16x32_bf16 v[72:75], v[64:67], v[4:7], 0
  ds_read_b128 v[52:55], v116 offset:16384
  ds_read_b128 v[56:59], v116 offset:17408
  v_smfmac_f32_16x16x64_bf16 v[40:43], v[32:35], a[104:111], v3
  v_cvt_pk_bf16_f32 v64, v36, v37
  v_smfmac_f32_16x16x64_bf16 v[44:47], v[24:27], a[144:151], v3
  v_cvt_pk_bf16_f32 v65, v38, v39
  v_smfmac_f32_16x16x64_bf16 v[44:47], v[28:31], a[152:159], v3
  v_cvt_pk_bf16_f32 v76, v72, v73
  v_smfmac_f32_16x16x64_bf16 v[44:47], v[32:35], a[160:167], v3
  v_cvt_pk_bf16_f32 v77, v74, v75
  v_cvt_pk_bf16_f32 v66, v40, v41
  v_smfmac_f32_16x16x64_bf16 v[48:51], v[24:27], a[200:207], v3
  v_cvt_pk_bf16_f32 v67, v42, v43
  v_smfmac_f32_16x16x64_bf16 v[48:51], v[28:31], a[208:215], v3
  v_mfma_f32_16x16x32_bf16 v[68:71], v[64:67], v[4:7], 0
  v_smfmac_f32_16x16x64_bf16 v[48:51], v[32:35], a[216:223], v3
  v_cvt_pk_bf16_f32 v64, v44, v45
  v_mfma_f32_16x16x32_bf16 v[84:87], v[80:83], v[76:79], 0
  v_cvt_pk_bf16_f32 v65, v46, v47
  s_waitcnt lgkmcnt(0)
  v_smfmac_f32_16x16x64_bf16 v[88:91], v[76:79], v[96:103], v3
  v_cvt_pk_bf16_f32 v60, v68, v69
  v_cvt_pk_bf16_f32 v61, v70, v71
  v_cvt_pk_bf16_f32 v66, v48, v49
  v_cvt_pk_bf16_f32 v67, v50, v51
  s_nop 1
  v_mfma_f32_16x16x32_bf16 v[72:75], v[64:67], v[4:7], 0
  v_smfmac_f32_16x16x64_bf16 v[92:95], v[76:79], v[104:111], v3
  s_nop 4
  v_cvt_pk_bf16_f32 v62, v72, v73
  v_cvt_pk_bf16_f32 v63, v74, v75
  s_nop 1
  v_mfma_f32_16x16x32_bf16 v[84:87], v[12:15], v[60:63], v[84:87]
  v_smfmac_f32_16x16x64_bf16 v[88:91], v[60:63], v[16:23], v3
  v_smfmac_f32_16x16x64_bf16 v[92:95], v[60:63], v[52:59], v3
  s_mov_b64 exec, s[26:27]
  s_nop 0
  ds_write_b128 v113, v[84:87]
  s_mov_b64 exec, -1
  s_nop 0
  v_cmp_u_f32 vcc, v88, v89
  s_nop 1
  v_permlane32_swap_b32 v88, v92
  v_permlane32_swap_b32 v89, v93
  v_permlane32_swap_b32 v90, v94
  v_permlane32_swap_b32 v91, v95
  v_add_f32 v88, v88, v92
  v_add_f32 v89, v89, v93
  v_add_f32 v90, v90, v94
  v_add_f32 v91, v91, v95
  ds_write_b128 v112, v[88:91]
  s_cbranch_vccnz cA_sc1_retry
cA_sc1_cont:
  s_waitcnt lgkmcnt(0)
  s_barrier
  ds_read_b64 v[36:37], v114 offset:0
  ds_read_b64 v[38:39], v114 offset:1024
  ds_read2_b32 v[44:45], v115 offset0:0 offset1:64
  s_waitcnt lgkmcnt(0)
  v_add_f32 v44, v44, v45
  v_add_f32 v36, v36, v38
  v_add_f32 v37, v37, v39
  v_add_f32_dpp v44, v44, v44 row_ror:8 row_mask:0xf bank_mask:0xf
  v_mov_b32 v45, v44
  v_permlane32_swap_b32 v36, v37
  v_add_f32 v36, v36, v37
  v_permlane16_swap_b32 v44, v45
  v_add_f32 v44, v44, v45
  v_exp_f32 v48, v36
  v_exp_f32 v49, v44
  v_add_f32 v50, abs(v36), abs(v44)
  v_fma_f32 v39, v49, s37, v48
  v_cmp_ngt_f32 vcc, s56, v50
  v_cndmask_b32 v41, v48, v49, s[38:39]
  v_add_f32_dpp v39, v39, v39 quad_perm:[1,0,3,2] row_mask:0xf bank_mask:0xf
  v_cndmask_b32 v40, v49, v48, s[38:39]
  v_mov_b32_dpp v46, v41 quad_perm:[1,0,3,2] row_mask:0xf bank_mask:0xf
  v_add_f32_dpp v39, v39, v39 quad_perm:[2,3,0,1] row_mask:0xf bank_mask:0xf
  v_cndmask_b32 v42, v46, v40, s[38:39]
  v_cndmask_b32 v43, v40, v46, s[38:39]
  v_add_f32_dpp v39, v39, v39 row_half_mirror row_mask:0xf bank_mask:0xf
  s_cbranch_vccnz cA_sc1_slow
  s_nop 0
  v_add_f32_dpp v39, v39, v39 row_mirror row_mask:0xf bank_mask:0xf
  v_mov_b32 v47, v39
  s_nop 1
  v_permlane16_swap_b32 v39, v47
  v_add_f32 v39, v39, v47
  v_rcp_f32 v39, v39
  s_mov_b64 exec, s[28:29]
  v_mul_f32 v42, v42, v39
  v_mul_f32 v43, v43, v39
  v_cvt_pk_bf16_f32 v42, v42, v43
cA_sc1_pst:
  buffer_store_dword v42, v1, s[8:11], s20 offen
  s_mov_b64 exec, -1
  s_barrier
  s_add_u32 s24, s24, 28672
  s_add_u32 s35, s35, 28672
  s_xor_b32 s25, s25, 28672
  s_add_u32 m0, s25, 7168
  s_nop 0
  buffer_load_dwordx4 v2, s[8:11], s24 offen offset:0 sc1 lds
  buffer_load_dwordx4 v2, s[8:11], s24 offen offset:1024 sc1 lds
  buffer_load_dwordx4 v2, s[8:11], s24 offen offset:2048 sc1 lds
  buffer_load_dwordx4 v2, s[8:11], s24 offen offset:3072 sc1 lds
  s_add_u32 m0, s25, 11264
  s_add_u32 s22, s24, 4096
  buffer_load_dwordx4 v2, s[8:11], s22 offen offset:0 sc1 lds
  buffer_load_dwordx4 v2, s[8:11], s22 offen offset:1024 sc1 lds
  buffer_load_dwordx4 v2, s[8:11], s22 offen offset:2048 sc1 lds
  v_xor_b32 v116, 28672, v116
  v_add_u32 v117, s57, v117
  s_sub_u32 s57, 0, s57
  s_add_u32 s19, s19, 1
  s_mov_b32 s20, s21
  s_cmp_lt_u32 s19, 63
  s_cbranch_scc1 cA_sc1_loop
  s_branch cA_done
cA_sc1_slow:
  v_max_f32 v50, v36, v44
  s_nop 1
  v_max_f32_dpp v50, v50, v50 quad_perm:[1,0,3,2] row_mask:0xf bank_mask:0xf
  s_nop 1
  v_max_f32_dpp v50, v50, v50 quad_perm:[2,3,0,1] row_mask:0xf bank_mask:0xf
  s_nop 1
  v_max_f32_dpp v50, v50, v50 row_half_mirror row_mask:0xf bank_mask:0xf
  s_nop 1
  v_max_f32_dpp v50, v50, v50 row_mirror row_mask:0xf bank_mask:0xf
  v_mov_b32 v47, v50
  s_nop 1
  v_permlane16_swap_b32 v50, v47
  v_max_f32 v50, v50, v47
  v_sub_f32 v48, v36, v50
  v_sub_f32 v49, v44, v50
  v_exp_f32 v48, v48
  v_exp_f32 v49, v49
  s_add_u32 s31, s31, 0x100
  v_fma_f32 v39, v49, s37, v48
  v_cndmask_b32 v41, v48, v49, s[38:39]
  s_nop 0
  v_add_f32_dpp v39, v39, v39 quad_perm:[1,0,3,2] row_mask:0xf bank_mask:0xf
  v_cndmask_b32 v40, v49, v48, s[38:39]
  v_mov_b32_dpp v46, v41 quad_perm:[1,0,3,2] row_mask:0xf bank_mask:0xf
  v_add_f32_dpp v39, v39, v39 quad_perm:[2,3,0,1] row_mask:0xf bank_mask:0xf
  v_cndmask_b32 v42, v46, v40, s[38:39]
  v_cndmask_b32 v43, v40, v46, s[38:39]
  v_add_f32_dpp v39, v39, v39 row_half_mirror row_mask:0xf bank_mask:0xf
  s_nop 1
  v_add_f32_dpp v39, v39, v39 row_mirror row_mask:0xf bank_mask:0xf
  v_mov_b32 v47, v39
  s_nop 1
  v_permlane16_swap_b32 v39, v47
  v_add_f32 v39, v39, v47
  v_rcp_f32 v39, v39
  s_mov_b64 exec, s[28:29]
  v_mul_f32 v42, v42, v39
  v_mul_f32 v43, v43, v39
  v_cvt_pk_bf16_f32 v42, v42, v43
  v_min_u32 v42, -2, v42
  s_branch cA_sc1_pst
cA_sc1_retry:
  s_cmp_lg_u32 s62, 0
  s_cbranch_scc1 cA_sc1_cont
  s_waitcnt vmcnt(0) lgkmcnt(0)
cA_sc1_rv:
  buffer_load_dwordx4 v[8:11], v2, s[8:11], s20 offen offset:0 sc1
  buffer_load_dwordx4 v[12:15], v2, s[8:11], s20 offen offset:1024 sc1
  buffer_load_dwordx4 v[16:19], v2, s[8:11], s20 offen offset:2048 sc1
  buffer_load_dwordx4 v[20:23], v2, s[8:11], s20 offen offset:3072 sc1
  buffer_load_dwordx4 v[24:27], v2, s[8:11], s23 offen offset:0 sc1
  buffer_load_dwordx4 v[28:31], v2, s[8:11], s23 offen offset:1024 sc1
  buffer_load_dwordx4 v[32:35], v2, s[8:11], s23 offen offset:2048 sc1
  s_waitcnt vmcnt(0)
  v_max3_u32 v118, v8, v9, v10
  v_max3_u32 v118, v118, v11, v12
  v_max3_u32 v118, v118, v13, v14
  v_max3_u32 v118, v118, v15, v16
  v_max3_u32 v118, v118, v17, v18
  v_max3_u32 v118, v118, v19, v20
  v_max3_u32 v118, v118, v21, v22
  v_max3_u32 v118, v118, v23, v24
  v_max3_u32 v118, v118, v25, v26
  v_max3_u32 v118, v118, v27, v28
  v_max3_u32 v118, v118, v29, v30
  v_max3_u32 v118, v118, v31, v32
  v_max3_u32 v118, v118, v33, v34
  v_max_u32 v118, v118, v35
  v_cmp_eq_u32 vcc, -1, v118
  s_cbranch_vccz cA_sc1_rk
  s_add_u32 s30, s30, 1
  s_cmp_lt_u32 s30, 400000
  s_cbranch_scc1 cA_sc1_rv
  s_branch cA_abort
cA_sc1_rk:
  s_mov_b32 s62, 1
  v_mov_b32 v36, 0
  v_mov_b32 v37, 0
  v_mov_b32 v38, 0
  v_mov_b32 v39, 0
  v_mov_b32 v40, 0
  v_mov_b32 v41, 0
  v_mov_b32 v42, 0
  v_mov_b32 v43, 0
  v_mov_b32 v44, 0
  v_mov_b32 v45, 0
  v_mov_b32 v46, 0
  v_mov_b32 v47, 0
  v_mov_b32 v48, 0
  v_mov_b32 v49, 0
  v_mov_b32 v50, 0
  v_mov_b32 v51, 0
  v_mov_b32 v52, 0
  v_mov_b32 v53, 0
  v_mov_b32 v54, 0
  v_mov_b32 v55, 0
  v_mov_b32 v56, 0
  v_mov_b32 v57, 0
  v_mov_b32 v58, 0
  v_mov_b32 v59, 0
  v_mov_b32 v60, 0
  v_mov_b32 v61, 0
  v_mov_b32 v62, 0
  v_mov_b32 v63, 0
  v_mov_b32 v88, 0
  v_mov_b32 v89, 0
  v_mov_b32 v90, 0
  v_mov_b32 v91, 0
  v_mov_b32 v92, 0
  v_mov_b32 v93, 0
  v_mov_b32 v94, 0
  v_mov_b32 v95, 0
  v_mov_b32 v64, 0
  v_mov_b32 v65, 0
  s_add_u32 s31, s31, 1
  ds_read_b128 v[96:99], v117 offset:0
  ds_read_b128 v[100:103], v117 offset:1024
  ds_read_b128 v[104:107], v117 offset:14336
  ds_read_b128 v[108:111], v117 offset:15360
  v_smfmac_f32_16x16x64_bf16 v[36:39], v[8:11], a[0:7], v3
  v_smfmac_f32_16x16x64_bf16 v[40:43], v[8:11], a[56:63], v3
  v_smfmac_f32_16x16x64_bf16 v[44:47], v[8:11], a[112:119], v3
  v_smfmac_f32_16x16x64_bf16 v[48:51], v[8:11], a[168:175], v3
  v_smfmac_f32_16x16x64_bf16 v[52:55], v[8:11], a[224:231], v3
  v_smfmac_f32_16x16x64_bf16 v[56:59], v[8:11], v[144:151], v3
  v_smfmac_f32_16x16x64_bf16 v[60:63], v[8:11], v[200:207], v3
  v_smfmac_f32_16x16x64_bf16 v[36:39], v[12:15], a[8:15], v3
  v_smfmac_f32_16x16x64_bf16 v[40:43], v[12:15], a[64:71], v3
  v_smfmac_f32_16x16x64_bf16 v[44:47], v[12:15], a[120:127], v3
  v_smfmac_f32_16x16x64_bf16 v[48:51], v[12:15], a[176:183], v3
  v_smfmac_f32_16x16x64_bf16 v[52:55], v[12:15], a[232:239], v3
  v_smfmac_f32_16x16x64_bf16 v[56:59], v[12:15], v[152:159], v3
  v_smfmac_f32_16x16x64_bf16 v[60:63], v[12:15], v[208:215], v3
  v_smfmac_f32_16x16x64_bf16 v[36:39], v[16:19], a[16:23], v3
  v_smfmac_f32_16x16x64_bf16 v[40:43], v[16:19], a[72:79], v3
  v_smfmac_f32_16x16x64_bf16 v[44:47], v[16:19], a[128:135], v3
  v_smfmac_f32_16x16x64_bf16 v[48:51], v[16:19], a[184:191], v3
  v_smfmac_f32_16x16x64_bf16 v[52:55], v[16:19], a[240:247], v3
  v_smfmac_f32_16x16x64_bf16 v[56:59], v[16:19], v[160:167], v3
  v_smfmac_f32_16x16x64_bf16 v[60:63], v[16:19], v[216:223], v3
  v_smfmac_f32_16x16x64_bf16 v[36:39], v[20:23], a[24:31], v3
  v_smfmac_f32_16x16x64_bf16 v[40:43], v[20:23], a[80:87], v3
  v_smfmac_f32_16x16x64_bf16 v[44:47], v[20:23], a[136:143], v3
  v_smfmac_f32_16x16x64_bf16 v[48:51], v[20:23], a[192:199], v3
  v_smfmac_f32_16x16x64_bf16 v[52:55], v[20:23], a[248:255], v3
  v_smfmac_f32_16x16x64_bf16 v[56:59], v[20:23], v[168:175], v3
  v_smfmac_f32_16x16x64_bf16 v[60:63], v[20:23], v[224:231], v3
  s_branch cA_sc1_ph2
cA_sc2_loop:
  s_add_u32 s23, s20, 4096
  s_add_u32 s21, s20, 25600
  v_mov_b32 v48, 0
  v_mov_b32 v49, 0
  v_mov_b32 v50, 0
  v_mov_b32 v51, 0
  v_mov_b32 v52, 0
  v_mov_b32 v53, 0
  v_mov_b32 v54, 0
  v_mov_b32 v55, 0
  v_mov_b32 v56, 0
  v_mov_b32 v57, 0
  v_mov_b32 v58, 0
  v_mov_b32 v59, 0
  v_mov_b32 v60, 0
  v_mov_b32 v61, 0
  v_mov_b32 v62, 0
  v_mov_b32 v63, 0
  v_mov_b32 v88, 0
  v_mov_b32 v89, 0
  v_mov_b32 v90, 0
  v_mov_b32 v91, 0
  v_mov_b32 v92, 0
  v_mov_b32 v93, 0
  v_mov_b32 v94, 0
  v_mov_b32 v95, 0
  v_mov_b32 v66, 0
  v_mov_b32 v67, 0
  s_mov_b32 s30, 0
  s_mov_b32 s62, 0
  s_waitcnt vmcnt(0)
  s_barrier
cA_sc2_ld:
  buffer_load_dwordx4 v[8:11], v2, s[8:11], s20 offen offset:0
  v_mov_b32 v36, 0
  v_mov_b32 v37, 0
  v_mov_b32 v38, 0
  v_mov_b32 v39, 0
  buffer_load_dwordx4 v[12:15], v2, s[8:11], s20 offen offset:1024
  v_mov_b32 v40, 0
  v_mov_b32 v41, 0
  v_mov_b32 v42, 0
  v_mov_b32 v43, 0
  buffer_load_dwordx4 v[16:19], v2, s[8:11], s20 offen offset:2048
  v_mov_b32 v44, 0
  v_mov_b32 v45, 0
  v_mov_b32 v46, 0
  v_mov_b32 v47, 0
  ds_read_b128 v[96:99], v117 offset:0
  ds_read_b128 v[100:103], v117 offset:1024
  ds_read_b128 v[104:107], v117 offset:14336
  ds_read_b128 v[108:111], v117 offset:15360
  s_waitcnt vmcnt(2)
  v_smfmac_f32_16x16x64_bf16 v[36:39], v[8:11], a[0:7], v3
  v_smfmac_f32_16x16x64_bf16 v[40:43], v[8:11], a[56:63], v3
  buffer_load_dwordx4 v[20:23], v2, s[8:11], s20 offen offset:3072
  v_smfmac_f32_16x16x64_bf16 v[44:47], v[8:11], a[112:119], v3
  v_smfmac_f32_16x16x64_bf16 v[48:51], v[8:11], a[168:175], v3
  v_smfmac_f32_16x16x64_bf16 v[52:55], v[8:11], a[224:231], v3
  buffer_load_dwordx4 v[24:27], v2, s[8:11], s23 offen offset:0
  v_smfmac_f32_16x16x64_bf16 v[56:59], v[8:11], v[144:151], v3
  v_smfmac_f32_16x16x64_bf16 v[60:63], v[8:11], v[200:207], v3
  s_waitcnt vmcnt(3)
  v_smfmac_f32_16x16x64_bf16 v[36:39], v[12:15], a[8:15], v3
  v_smfmac_f32_16x16x64_bf16 v[40:43], v[12:15], a[64:71], v3
  buffer_load_dwordx4 v[28:31], v2, s[8:11], s23 offen offset:1024
  v_smfmac_f32_16x16x64_bf16 v[44:47], v[12:15], a[120:127], v3
  v_smfmac_f32_16x16x64_bf16 v[48:51], v[12:15], a[176:183], v3
  v_smfmac_f32_16x16x64_bf16 v[52:55], v[12:15], a[232:239], v3
  buffer_load_dwordx4 v[32:35], v2, s[8:11], s23 offen offset:2048
  v_smfmac_f32_16x16x64_bf16 v[56:59], v[12:15], v[152:159], v3
  v_smfmac_f32_16x16x64_bf16 v[60:63], v[12:15], v[208:215], v3
  s_waitcnt vmcnt(4)
  v_smfmac_f32_16x16x64_bf16 v[36:39], v[16:19], a[16:23], v3
  v_smfmac_f32_16x16x64_bf16 v[40:43], v[16:19], a[72:79], v3
  v_smfmac_f32_16x16x64_bf16 v[44:47], v[16:19], a[128:135], v3
  v_smfmac_f32_16x16x64_bf16 v[48:51], v[16:19], a[184:191], v3
  v_smfmac_f32_16x16x64_bf16 v[52:55], v[16:19], a[240:247], v3
  v_smfmac_f32_16x16x64_bf16 v[56:59], v[16:19], v[160:167], v3
  v_smfmac_f32_16x16x64_bf16 v[60:63], v[16:19], v[216:223], v3
  s_waitcnt vmcnt(3)
  v_smfmac_f32_16x16x64_bf16 v[36:39], v[20:23], a[24:31], v3
  v_smfmac_f32_16x16x64_bf16 v[40:43], v[20:23], a[80:87], v3
  v_smfmac_f32_16x16x64_bf16 v[44:47], v[20:23], a[136:143], v3
  v_smfmac_f32_16x16x64_bf16 v[48:51], v[20:23], a[192:199], v3
  v_smfmac_f32_16x16x64_bf16 v[52:55], v[20:23], a[248:255], v3
  v_smfmac_f32_16x16x64_bf16 v[56:59], v[20:23], v[168:175], v3
  v_smfmac_f32_16x16x64_bf16 v[60:63], v[20:23], v[224:231], v3
  s_waitcnt vmcnt(0)
cA_sc2_ph2:
  v_smfmac_f32_16x16x64_bf16 v[60:63], v[24:27], v[232:239], v3
  ds_read_b128 v[8:11], v116 offset:4096
  ds_read_b128 v[12:15], v116 offset:5120
  v_smfmac_f32_16x16x64_bf16 v[60:63], v[28:31], v[240:247], v3
  buffer_load_dword v119, v0, s[8:11], s24 offen sc1
  v_smfmac_f32_16x16x64_bf16 v[60:63], v[32:35], v[248:255], v3
  v_mov_b32 v80, v28
  v_smfmac_f32_16x16x64_bf16 v[52:55], v[24:27], v[120:127], v3
  v_mov_b32 v81, v29
  v_smfmac_f32_16x16x64_bf16 v[52:55], v[28:31], v[128:135], v3
  v_mov_b32 v82, v34
  v_smfmac_f32_16x16x64_bf16 v[52:55], v[32:35], v[136:143], v3
  v_cvt_pk_bf16_f32 v64, v60, v61
  v_smfmac_f32_16x16x64_bf16 v[56:59], v[24:27], v[176:183], v3
  v_cvt_pk_bf16_f32 v65, v62, v63
  v_smfmac_f32_16x16x64_bf16 v[56:59], v[28:31], v[184:191], v3
  v_mov_b32 v83, v35
  v_mfma_f32_16x16x32_bf16 v[68:71], v[64:67], v[4:7], 0
  v_smfmac_f32_16x16x64_bf16 v[56:59], v[32:35], v[192:199], v3
  v_cvt_pk_bf16_f32 v64, v52, v53
  v_smfmac_f32_16x16x64_bf16 v[36:39], v[24:27], a[32:39], v3
  v_cvt_pk_bf16_f32 v65, v54, v55
  v_smfmac_f32_16x16x64_bf16 v[36:39], v[28:31], a[40:47], v3
  v_cvt_pk_bf16_f32 v78, v68, v69
  v_smfmac_f32_16x16x64_bf16 v[36:39], v[32:35], a[48:55], v3
  v_cvt_pk_bf16_f32 v79, v70, v71
  v_cvt_pk_bf16_f32 v66, v56, v57
  v_smfmac_f32_16x16x64_bf16 v[40:43], v[24:27], a[88:95], v3
  v_cvt_pk_bf16_f32 v67, v58, v59
  v_smfmac_f32_16x16x64_bf16 v[40:43], v[28:31], a[96:103], v3
  v_mfma_f32_16x16x32_bf16 v[72:75], v[64:67], v[4:7], 0
  ds_read_b128 v[52:55], v116 offset:18432
  ds_read_b128 v[56:59], v116 offset:19456
  v_smfmac_f32_16x16x64_bf16 v[40:43], v[32:35], a[104:111], v3
  v_cvt_pk_bf16_f32 v64, v36, v37
  v_smfmac_f32_16x16x64_bf16 v[44:47], v[24:27], a[144:151], v3
  v_cvt_pk_bf16_f32 v65, v38, v39
  v_smfmac_f32_16x16x64_bf16 v[44:47], v[28:31], a[152:159], v3
  v_cvt_pk_bf16_f32 v76, v72, v73
  v_smfmac_f32_16x16x64_bf16 v[44:47], v[32:35], a[160:167], v3
  v_cvt_pk_bf16_f32 v77, v74, v75
  v_cvt_pk_bf16_f32 v66, v40, v41
  v_smfmac_f32_16x16x64_bf16 v[48:51], v[24:27], a[200:207], v3
  v_cvt_pk_bf16_f32 v67, v42, v43
  v_smfmac_f32_16x16x64_bf16 v[48:51], v[28:31], a[208:215], v3
  v_mfma_f32_16x16x32_bf16 v[68:71], v[64:67], v[4:7], 0
  v_smfmac_f32_16x16x64_bf16 v[48:51], v[32:35], a[216:223], v3
  v_cvt_pk_bf16_f32 v64, v44, v45
  v_mfma_f32_16x16x32_bf16 v[84:87], v[80:83], v[76:79], 0
  v_cvt_pk_bf16_f32 v65, v46, v47
  s_waitcnt lgkmcnt(0)
  v_smfmac_f32_16x16x64_bf16 v[88:91], v[76:79], v[96:103], v3
  v_cvt_pk_bf16_f32 v60, v68, v69
  v_cvt_pk_bf16_f32 v61, v70, v71
  v_cvt_pk_bf16_f32 v66, v48, v49
  v_cvt_pk_bf16_f32 v67, v50, v51
  s_nop 1
  v_mfma_f32_16x16x32_bf16 v[72:75], v[64:67], v[4:7], 0
  v_smfmac_f32_16x16x64_bf16 v[92:95], v[76:79], v[104:111], v3
  s_nop 4
  v_cvt_pk_bf16_f32 v62, v72, v73
  v_cvt_pk_bf16_f32 v63, v74, v75
  s_nop 1
  v_mfma_f32_16x16x32_bf16 v[84:87], v[16:19], v[60:63], v[84:87]
  v_smfmac_f32_16x16x64_bf16 v[88:91], v[60:63], v[8:15], v3
  v_smfmac_f32_16x16x64_bf16 v[92:95], v[60:63], v[52:59], v3
  s_mov_b64 exec, s[26:27]
  s_nop 0
  ds_write_b128 v113, v[84:87]
  s_mov_b64 exec, -1
  s_nop 0
  v_cmp_u_f32 vcc, v88, v89
  s_nop 1
  v_permlane32_swap_b32 v88, v92
  v_permlane32_swap_b32 v89, v93
  v_permlane32_swap_b32 v90, v94
  v_permlane32_swap_b32 v91, v95
  v_add_f32 v88, v88, v92
  v_add_f32 v89, v89, v93
  v_add_f32 v90, v90, v94
  v_add_f32 v91, v91, v95
  ds_write_b128 v112, v[88:91]
  s_cbranch_vccnz cA_sc2_retry
cA_sc2_cont:
  s_waitcnt lgkmcnt(0)
  s_barrier
  ds_read_b64 v[36:37], v114 offset:0
  ds_read_b64 v[38:39], v114 offset:1024
  ds_read2_b32 v[44:45], v115 offset0:0 offset1:64
  v_lshl_add_u32 v56, v2, 3, s36
  s_waitcnt lgkmcnt(0)
  v_add_f32 v44, v44, v45
  v_add_f32 v36, v36, v38
  v_add_f32 v37, v37, v39
  v_add_f32_dpp v44, v44, v44 row_ror:8 row_mask:0xf bank_mask:0xf
  v_mov_b32 v45, v44
  s_mov_b64 exec, 65535
  buffer_store_dword v2, v56, s[8:11], s20 offen
  s_mov_b64 exec, -1
  v_permlane32_swap_b32 v36, v37
  v_add_f32 v36, v36, v37
  v_permlane16_swap_b32 v44, v45
  v_add_f32 v44, v44, v45
  v_exp_f32 v48, v36
  v_exp_f32 v49, v44
  v_add_f32 v50, abs(v36), abs(v44)
  v_fma_f32 v39, v49, s37, v48
  v_cmp_ngt_f32 vcc, s56, v50
  v_cndmask_b32 v41, v48, v49, s[38:39]
  v_add_f32_dpp v39, v39, v39 quad_perm:[1,0,3,2] row_mask:0xf bank_mask:0xf
  v_cndmask_b32 v40, v49, v48, s[38:39]
  v_mov_b32_dpp v46, v41 quad_perm:[1,0,3,2] row_mask:0xf bank_mask:0xf
  v_add_f32_dpp v39, v39, v39 quad_perm:[2,3,0,1] row_mask:0xf bank_mask:0xf
  v_cndmask_b32 v42, v46, v40, s[38:39]
  v_cndmask_b32 v43, v40, v46, s[38:39]
  v_add_f32_dpp v39, v39, v39 row_half_mirror row_mask:0xf bank_mask:0xf
  s_cbranch_vccnz cA_sc2_slow
  s_nop 0
  v_add_f32_dpp v39, v39, v39 row_mirror row_mask:0xf bank_mask:0xf
  v_mov_b32 v47, v39
  s_nop 1
  v_permlane16_swap_b32 v39, v47
  v_add_f32 v39, v39, v47
  v_rcp_f32 v39, v39
  s_mov_b64 exec, s[28:29]
  v_mul_f32 v42, v42, v39
  v_mul_f32 v43, v43, v39
  v_cvt_pk_bf16_f32 v42, v42, v43
cA_sc2_pst:
  buffer_store_dword v42, v1, s[8:11], s20 offen
  s_mov_b64 exec, -1
  s_barrier
  s_add_u32 s24, s24, 28672
  s_add_u32 s35, s35, 28672
  s_xor_b32 s25, s25, 28672
  s_add_u32 m0, s25, 14336
  s_nop 0
  buffer_load_dwordx4 v2, s[8:11], s24 offen offset:0 sc1 lds
  buffer_load_dwordx4 v2, s[8:11], s24 offen offset:1024 sc1 lds
  buffer_load_dwordx4 v2, s[8:11], s24 offen offset:2048 sc1 lds
  buffer_load_dwordx4 v2, s[8:11], s24 offen offset:3072 sc1 lds
  s_add_u32 m0, s25, 18432
  s_add_u32 s22, s24, 4096
  buffer_load_dwordx4 v2, s[8:11], s22 offen offset:0 sc1 lds
  buffer_load_dwordx4 v2, s[8:11], s22 offen offset:1024 sc1 lds
  buffer_load_dwordx4 v2, s[8:11], s22 offen offset:2048 sc1 lds
  v_xor_b32 v116, 28672, v116
  v_add_u32 v117, s57, v117
  s_sub_u32 s57, 0, s57
  s_add_u32 s19, s19, 1
  s_mov_b32 s20, s21
  s_cmp_lt_u32 s19, 63
  s_cbranch_scc1 cA_sc2_loop
  s_branch cA_done
cA_sc2_slow:
  v_max_f32 v50, v36, v44
  s_nop 1
  v_max_f32_dpp v50, v50, v50 quad_perm:[1,0,3,2] row_mask:0xf bank_mask:0xf
  s_nop 1
  v_max_f32_dpp v50, v50, v50 quad_perm:[2,3,0,1] row_mask:0xf bank_mask:0xf
  s_nop 1
  v_max_f32_dpp v50, v50, v50 row_half_mirror row_mask:0xf bank_mask:0xf
  s_nop 1
  v_max_f32_dpp v50, v50, v50 row_mirror row_mask:0xf bank_mask:0xf
  v_mov_b32 v47, v50
  s_nop 1
  v_permlane16_swap_b32 v50, v47
  v_max_f32 v50, v50, v47
  v_sub_f32 v48, v36, v50
  v_sub_f32 v49, v44, v50
  v_exp_f32 v48, v48
  v_exp_f32 v49, v49
  s_add_u32 s31, s31, 0x100
  v_fma_f32 v39, v49, s37, v48
  v_cndmask_b32 v41, v48, v49, s[38:39]
  s_nop 0
  v_add_f32_dpp v39, v39, v39 quad_perm:[1,0,3,2] row_mask:0xf bank_mask:0xf
  v_cndmask_b32 v40, v49, v48, s[38:39]
  v_mov_b32_dpp v46, v41 quad_perm:[1,0,3,2] row_mask:0xf bank_mask:0xf
  v_add_f32_dpp v39, v39, v39 quad_perm:[2,3,0,1] row_mask:0xf bank_mask:0xf
  v_cndmask_b32 v42, v46, v40, s[38:39]
  v_cndmask_b32 v43, v40, v46, s[38:39]
  v_add_f32_dpp v39, v39, v39 row_half_mirror row_mask:0xf bank_mask:0xf
  s_nop 1
  v_add_f32_dpp v39, v39, v39 row_mirror row_mask:0xf bank_mask:0xf
  v_mov_b32 v47, v39
  s_nop 1
  v_permlane16_swap_b32 v39, v47
  v_add_f32 v39, v39, v47
  v_rcp_f32 v39, v39
  s_mov_b64 exec, s[28:29]
  v_mul_f32 v42, v42, v39
  v_mul_f32 v43, v43, v39
  v_cvt_pk_bf16_f32 v42, v42, v43
  v_min_u32 v42, -2, v42
  s_branch cA_sc2_pst
cA_sc2_retry:
  s_cmp_lg_u32 s62, 0
  s_cbranch_scc1 cA_sc2_cont
  s_waitcnt vmcnt(0) lgkmcnt(0)
cA_sc2_rv:
  buffer_load_dwordx4 v[8:11], v2, s[8:11], s20 offen offset:0 sc1
  buffer_load_dwordx4 v[12:15], v2, s[8:11], s20 offen offset:1024 sc1
  buffer_load_dwordx4 v[16:19], v2, s[8:11], s20 offen offset:2048 sc1
  buffer_load_dwordx4 v[20:23], v2, s[8:11], s20 offen offset:3072 sc1
  buffer_load_dwordx4 v[24:27], v2, s[8:11], s23 offen offset:0 sc1
  buffer_load_dwordx4 v[28:31], v2, s[8:11], s23 offen offset:1024 sc1
  buffer_load_dwordx4 v[32:35], v2, s[8:11], s23 offen offset:2048 sc1
  s_waitcnt vmcnt(0)
  v_max3_u32 v118, v8, v9, v10
  v_max3_u32 v118, v118, v11, v12
  v_max3_u32 v118, v118, v13, v14
  v_max3_u32 v118, v118, v15, v16
  v_max3_u32 v118, v118, v17, v18
  v_max3_u32 v118, v118, v19, v20
  v_max3_u32 v118, v118, v21, v22
  v_max3_u32 v118, v118, v23, v24
  v_max3_u32 v118, v118, v25, v26
  v_max3_u32 v118, v118, v27, v28
  v_max3_u32 v118, v118, v29, v30
  v_max3_u32 v118, v118, v31, v32
  v_max3_u32 v118, v118, v33, v34
  v_max_u32 v118, v118, v35
  v_cmp_eq_u32 vcc, -1, v118
  s_cbranch_vccz cA_sc2_rk
  s_add_u32 s30, s30, 1
  s_cmp_lt_u32 s30, 400000
  s_cbranch_scc1 cA_sc2_rv
  s_branch cA_abort
cA_sc2_rk:
  s_mov_b32 s62, 1
  v_mov_b32 v36, 0
  v_mov_b32 v37, 0
  v_mov_b32 v38, 0
  v_mov_b32 v39, 0
  v_mov_b32 v40, 0
  v_mov_b32 v41, 0
  v_mov_b32 v42, 0
  v_mov_b32 v43, 0
  v_mov_b32 v44, 0
  v_mov_b32 v45, 0
  v_mov_b32 v46, 0
  v_mov_b32 v47, 0
  v_mov_b32 v48, 0
  v_mov_b32 v49, 0
  v_mov_b32 v50, 0
  v_mov_b32 v51, 0
  v_mov_b32 v52, 0
  v_mov_b32 v53, 0
  v_mov_b32 v54, 0
  v_mov_b32 v55, 0
  v_mov_b32 v56, 0
  v_mov_b32 v57, 0
  v_mov_b32 v58, 0
  v_mov_b32 v59, 0
  v_mov_b32 v60, 0
  v_mov_b32 v61, 0
  v_mov_b32 v62, 0
  v_mov_b32 v63, 0
  v_mov_b32 v88, 0
  v_mov_b32 v89, 0
  v_mov_b32 v90, 0
  v_mov_b32 v91, 0
  v_mov_b32 v92, 0
  v_mov_b32 v93, 0
  v_mov_b32 v94, 0
  v_mov_b32 v95, 0
  v_mov_b32 v66, 0
  v_mov_b32 v67, 0
  s_add_u32 s31, s31, 1
  ds_read_b128 v[96:99], v117 offset:0
  ds_read_b128 v[100:103], v117 offset:1024
  ds_read_b128 v[104:107], v117 offset:14336
  ds_read_b128 v[108:111], v117 offset:15360
  v_smfmac_f32_16x16x64_bf16 v[36:39], v[8:11], a[0:7], v3
  v_smfmac_f32_16x16x64_bf16 v[40:43], v[8:11], a[56:63], v3
  v_smfmac_f32_16x16x64_bf16 v[44:47], v[8:11], a[112:119], v3
  v_smfmac_f32_16x16x64_bf16 v[48:51], v[8:11], a[168:175], v3
  v_smfmac_f32_16x16x64_bf16 v[52:55], v[8:11], a[224:231], v3
  v_smfmac_f32_16x16x64_bf16 v[56:59], v[8:11], v[144:151], v3
  v_smfmac_f32_16x16x64_bf16 v[60:63], v[8:11], v[200:207], v3
  v_smfmac_f32_16x16x64_bf16 v[36:39], v[12:15], a[8:15], v3
  v_smfmac_f32_16x16x64_bf16 v[40:43], v[12:15], a[64:71], v3
  v_smfmac_f32_16x16x64_bf16 v[44:47], v[12:15], a[120:127], v3
  v_smfmac_f32_16x16x64_bf16 v[48:51], v[12:15], a[176:183], v3
  v_smfmac_f32_16x16x64_bf16 v[52:55], v[12:15], a[232:239], v3
  v_smfmac_f32_16x16x64_bf16 v[56:59], v[12:15], v[152:159], v3
  v_smfmac_f32_16x16x64_bf16 v[60:63], v[12:15], v[208:215], v3
  v_smfmac_f32_16x16x64_bf16 v[36:39], v[16:19], a[16:23], v3
  v_smfmac_f32_16x16x64_bf16 v[40:43], v[16:19], a[72:79], v3
  v_smfmac_f32_16x16x64_bf16 v[44:47], v[16:19], a[128:135], v3
  v_smfmac_f32_16x16x64_bf16 v[48:51], v[16:19], a[184:191], v3
  v_smfmac_f32_16x16x64_bf16 v[52:55], v[16:19], a[240:247], v3
  v_smfmac_f32_16x16x64_bf16 v[56:59], v[16:19], v[160:167], v3
  v_smfmac_f32_16x16x64_bf16 v[60:63], v[16:19], v[216:223], v3
  v_smfmac_f32_16x16x64_bf16 v[36:39], v[20:23], a[24:31], v3
  v_smfmac_f32_16x16x64_bf16 v[40:43], v[20:23], a[80:87], v3
  v_smfmac_f32_16x16x64_bf16 v[44:47], v[20:23], a[136:143], v3
  v_smfmac_f32_16x16x64_bf16 v[48:51], v[20:23], a[192:199], v3
  v_smfmac_f32_16x16x64_bf16 v[52:55], v[20:23], a[248:255], v3
  v_smfmac_f32_16x16x64_bf16 v[56:59], v[20:23], v[168:175], v3
  v_smfmac_f32_16x16x64_bf16 v[60:63], v[20:23], v[224:231], v3
  s_branch cA_sc2_ph2
cA_sc3_loop:
  s_add_u32 s23, s20, 4096
  s_add_u32 s21, s20, 25600
  v_mov_b32 v48, 0
  v_mov_b32 v49, 0
  v_mov_b32 v50, 0
  v_mov_b32 v51, 0
  v_mov_b32 v52, 0
  v_mov_b32 v53, 0
  v_mov_b32 v54, 0
  v_mov_b32 v55, 0
  v_mov_b32 v56, 0
  v_mov_b32 v57, 0
  v_mov_b32 v58, 0
  v_mov_b32 v59, 0
  v_mov_b32 v60, 0
  v_mov_b32 v61, 0
  v_mov_b32 v62, 0
  v_mov_b32 v63, 0
  v_mov_b32 v88, 0
  v_mov_b32 v89, 0
  v_mov_b32 v90, 0
  v_mov_b32 v91, 0
  v_mov_b32 v92, 0
  v_mov_b32 v93, 0
  v_mov_b32 v94, 0
  v_mov_b32 v95, 0
  v_mov_b32 v64, 0
  v_mov_b32 v65, 0
  s_mov_b32 s30, 0
  s_mov_b32 s62, 0
  s_waitcnt vmcnt(0)
  s_barrier
cA_sc3_ld:
  buffer_load_dwordx4 v[8:11], v2, s[8:11], s20 offen offset:0
  v_mov_b32 v36, 0
  v_mov_b32 v37, 0
  v_mov_b32 v38, 0
  v_mov_b32 v39, 0
  buffer_load_dwordx4 v[12:15], v2, s[8:11], s20 offen offset:1024
  v_mov_b32 v40, 0
  v_mov_b32 v41, 0
  v_mov_b32 v42, 0
  v_mov_b32 v43, 0
  buffer_load_dwordx4 v[16:19], v2, s[8:11], s20 offen offset:2048
  v_mov_b32 v44, 0
  v_mov_b32 v45, 0
  v_mov_b32 v46, 0
  v_mov_b32 v47, 0
  ds_read_b128 v[96:99], v117 offset:0
  ds_read_b128 v[100:103], v117 offset:1024
  ds_read_b128 v[104:107], v117 offset:14336
  ds_read_b128 v[108:111], v117 offset:15360
  s_waitcnt vmcnt(2)
  v_smfmac_f32_16x16x64_bf16 v[36:39], v[8:11], a[0:7], v3
  v_smfmac_f32_16x16x64_bf16 v[40:43], v[8:11], a[56:63], v3
  buffer_load_dwordx4 v[20:23], v2, s[8:11], s20 offen offset:3072
  v_smfmac_f32_16x16x64_bf16 v[44:47], v[8:11], a[112:119], v3
  v_smfmac_f32_16x16x64_bf16 v[48:51], v[8:11], a[168:175], v3
  v_smfmac_f32_16x16x64_bf16 v[52:55], v[8:11], a[224:231], v3
  buffer_load_dwordx4 v[24:27], v2, s[8:11], s23 offen offset:0
  v_smfmac_f32_16x16x64_bf16 v[56:59], v[8:11], v[144:151], v3
  v_smfmac_f32_16x16x64_bf16 v[60:63], v[8:11], v[200:207], v3
  s_waitcnt vmcnt(3)
  v_smfmac_f32_16x16x64_bf16 v[36:39], v[12:15], a[8:15], v3
  v_smfmac_f32_16x16x64_bf16 v[40:43], v[12:15], a[64:71], v3
  buffer_load_dwordx4 v[28:31], v2, s[8:11], s23 offen offset:1024
  v_smfmac_f32_16x16x64_bf16 v[44:47], v[12:15], a[120:127], v3
  v_smfmac_f32_16x16x64_bf16 v[48:51], v[12:15], a[176:183], v3
  v_smfmac_f32_16x16x64_bf16 v[52:55], v[12:15], a[232:239], v3
  buffer_load_dwordx4 v[32:35], v2, s[8:11], s23 offen offset:2048
  v_smfmac_f32_16x16x64_bf16 v[56:59], v[12:15], v[152:159], v3
  v_smfmac_f32_16x16x64_bf16 v[60:63], v[12:15], v[208:215], v3
  s_waitcnt vmcnt(4)
  v_smfmac_f32_16x16x64_bf16 v[36:39], v[16:19], a[16:23], v3
  v_smfmac_f32_16x16x64_bf16 v[40:43], v[16:19], a[72:79], v3
  v_smfmac_f32_16x16x64_bf16 v[44:47], v[16:19], a[128:135], v3
  v_smfmac_f32_16x16x64_bf16 v[48:51], v[16:19], a[184:191], v3
  v_smfmac_f32_16x16x64_bf16 v[52:55], v[16:19], a[240:247], v3
  v_smfmac_f32_16x16x64_bf16 v[56:59], v[16:19], v[160:167], v3
  v_smfmac_f32_16x16x64_bf16 v[60:63], v[16:19], v[216:223], v3
  s_waitcnt vmcnt(3)
  v_smfmac_f32_16x16x64_bf16 v[36:39], v[20:23], a[24:31], v3
  v_smfmac_f32_16x16x64_bf16 v[40:43], v[20:23], a[80:87], v3
  v_smfmac_f32_16x16x64_bf16 v[44:47], v[20:23], a[136:143], v3
  v_smfmac_f32_16x16x64_bf16 v[48:51], v[20:23], a[192:199], v3
  v_smfmac_f32_16x16x64_bf16 v[52:55], v[20:23], a[248:255], v3
  v_smfmac_f32_16x16x64_bf16 v[56:59], v[20:23], v[168:175], v3
  v_smfmac_f32_16x16x64_bf16 v[60:63], v[20:23], v[224:231], v3
  s_waitcnt vmcnt(0)
cA_sc3_ph2:
  v_smfmac_f32_16x16x64_bf16 v[60:63], v[24:27], v[232:239], v3
  ds_read_b128 v[8:11], v116 offset:6144
  ds_read_b128 v[12:15], v116 offset:7168
  v_smfmac_f32_16x16x64_bf16 v[60:63], v[28:31], v[240:247], v3
  v_smfmac_f32_16x16x64_bf16 v[60:63], v[32:35], v[248:255], v3
  v_mov_b32 v80, v30
  v_smfmac_f32_16x16x64_bf16 v[52:55], v[24:27], v[120:127], v3
  v_mov_b32 v81, v31
  v_smfmac_f32_16x16x64_bf16 v[52:55], v[28:31], v[128:135], v3
  v_mov_b32 v82, v34
  v_smfmac_f32_16x16x64_bf16 v[52:55], v[32:35], v[136:143], v3
  v_cvt_pk_bf16_f32 v66, v60, v61
  v_smfmac_f32_16x16x64_bf16 v[56:59], v[24:27], v[176:183], v3
  v_cvt_pk_bf16_f32 v67, v62, v63
  v_smfmac_f32_16x16x64_bf16 v[56:59], v[28:31], v[184:191], v3
  v_mov_b32 v83, v35
  v_mfma_f32_16x16x32_bf16 v[68:71], v[64:67], v[4:7], 0
  v_smfmac_f32_16x16x64_bf16 v[56:59], v[32:35], v[192:199], v3
  v_cvt_pk_bf16_f32 v64, v52, v53
  v_smfmac_f32_16x16x64_bf16 v[36:39], v[24:27], a[32:39], v3
  v_cvt_pk_bf16_f32 v65, v54, v55
  v_smfmac_f32_16x16x64_bf16 v[36:39], v[28:31], a[40:47], v3
  v_cvt_pk_bf16_f32 v78, v68, v69
  v_smfmac_f32_16x16x64_bf16 v[36:39], v[32:35], a[48:55], v3
  v_cvt_pk_bf16_f32 v79, v70, v71
  v_cvt_pk_bf16_f32 v66, v56, v57
  v_smfmac_f32_16x16x64_bf16 v[40:43], v[24:27], a[88:95], v3
  v_cvt_pk_bf16_f32 v67, v58, v59
  v_smfmac_f32_16x16x64_bf16 v[40:43], v[28:31], a[96:103], v3
  v_mfma_f32_16x16x32_bf16 v[72:75], v[64:67], v[4:7], 0
  ds_read_b128 v[52:55], v116 offset:20480
  ds_read_b128 v[56:59], v116 offset:21504
  v_smfmac_f32_16x16x64_bf16 v[40:43], v[32:35], a[104:111], v3
  v_cvt_pk_bf16_f32 v64, v36, v37
  v_smfmac_f32_16x16x64_bf16 v[44:47], v[24:27], a[144:151], v3
  v_cvt_pk_bf16_f32 v65, v38, v39
  v_smfmac_f32_16x16x64_bf16 v[44:47], v[28:31], a[152:159], v3
  v_cvt_pk_bf16_f32 v76, v72, v73
  v_smfmac_f32_16x16x64_bf16 v[44:47], v[32:35], a[160:167], v3
  v_cvt_pk_bf16_f32 v77, v74, v75
  v_cvt_pk_bf16_f32 v66, v40, v41
  v_smfmac_f32_16x16x64_bf16 v[48:51], v[24:27], a[200:207], v3
  v_cvt_pk_bf16_f32 v67, v42, v43
  v_smfmac_f32_16x16x64_bf16 v[48:51], v[28:31], a[208:215], v3
  v_mfma_f32_16x16x32_bf16 v[68:71], v[64:67], v[4:7], 0
  v_smfmac_f32_16x16x64_bf16 v[48:51], v[32:35], a[216:223], v3
  v_cvt_pk_bf16_f32 v64, v44, v45
  v_mfma_f32_16x16x32_bf16 v[84:87], v[80:83], v[76:79], 0
  v_cvt_pk_bf16_f32 v65, v46, v47
  s_waitcnt lgkmcnt(0)
  v_smfmac_f32_16x16x64_bf16 v[88:91], v[76:79], v[96:103], v3
  v_cvt_pk_bf16_f32 v60, v68, v69
  v_cvt_pk_bf16_f32 v61, v70, v71
  v_cvt_pk_bf16_f32 v66, v48, v49
  v_cvt_pk_bf16_f32 v67, v50, v51
  s_nop 1
  v_mfma_f32_16x16x32_bf16 v[72:75], v[64:67], v[4:7], 0
  v_smfmac_f32_16x16x64_bf16 v[92:95], v[76:79], v[104:111], v3
  s_nop 4
  v_cvt_pk_bf16_f32 v62, v72, v73
  v_cvt_pk_bf16_f32 v63, v74, v75
  s_nop 1
  v_mfma_f32_16x16x32_bf16 v[84:87], v[20:23], v[60:63], v[84:87]
  v_smfmac_f32_16x16x64_bf16 v[88:91], v[60:63], v[8:15], v3
  v_smfmac_f32_16x16x64_bf16 v[92:95], v[60:63], v[52:59], v3
  s_mov_b64 exec, s[26:27]
  s_nop 0
  ds_write_b128 v113, v[84:87]
  s_mov_b64 exec, -1
  s_nop 0
  v_cmp_u_f32 vcc, v88, v89
  s_nop 1
  v_permlane32_swap_b32 v88, v92
  v_permlane32_swap_b32 v89, v93
  v_permlane32_swap_b32 v90, v94
  v_permlane32_swap_b32 v91, v95
  v_add_f32 v88, v88, v92
  v_add_f32 v89, v89, v93
  v_add_f32 v90, v90, v94
  v_add_f32 v91, v91, v95
  ds_write_b128 v112, v[88:91]
  s_cbranch_vccnz cA_sc3_retry
cA_sc3_cont:
  s_waitcnt lgkmcnt(0)
  s_barrier
  ds_read_b64 v[36:37], v114 offset:0
  ds_read_b64 v[38:39], v114 offset:1024
  ds_read2_b32 v[44:45], v115 offset0:0 offset1:64
  s_waitcnt lgkmcnt(0)
  v_add_f32 v44, v44, v45
  v_add_f32 v36, v36, v38
  v_add_f32 v37, v37, v39
  v_add_f32_dpp v44, v44, v44 row_ror:8 row_mask:0xf bank_mask:0xf
  v_mov_b32 v45, v44
  v_permlane32_swap_b32 v36, v37
  v_add_f32 v36, v36, v37
  v_permlane16_swap_b32 v44, v45
  v_add_f32 v44, v44, v45
  v_exp_f32 v48, v36
  v_exp_f32 v49, v44
  v_add_f32 v50, abs(v36), abs(v44)
  v_fma_f32 v39, v49, s37, v48
  v_cmp_ngt_f32 vcc, s56, v50
  v_cndmask_b32 v41, v48, v49, s[38:39]
  v_add_f32_dpp v39, v39, v39 quad_perm:[1,0,3,2] row_mask:0xf bank_mask:0xf
  v_cndmask_b32 v40, v49, v48, s[38:39]
  v_mov_b32_dpp v46, v41 quad_perm:[1,0,3,2] row_mask:0xf bank_mask:0xf
  v_add_f32_dpp v39, v39, v39 quad_perm:[2,3,0,1] row_mask:0xf bank_mask:0xf
  v_cndmask_b32 v42, v46, v40, s[38:39]
  v_cndmask_b32 v43, v40, v46, s[38:39]
  v_add_f32_dpp v39, v39, v39 row_half_mirror row_mask:0xf bank_mask:0xf
  s_cbranch_vccnz cA_sc3_slow
  s_nop 0
  v_add_f32_dpp v39, v39, v39 row_mirror row_mask:0xf bank_mask:0xf
  v_mov_b32 v47, v39
  s_nop 1
  v_permlane16_swap_b32 v39, v47
  v_add_f32 v39, v39, v47
  v_rcp_f32 v39, v39
  s_mov_b64 exec, s[28:29]
  v_mul_f32 v42, v42, v39
  v_mul_f32 v43, v43, v39
  v_cvt_pk_bf16_f32 v42, v42, v43
cA_sc3_pst:
  buffer_store_dword v42, v1, s[8:11], s20 offen
  s_mov_b64 exec, -1
  s_barrier
  s_add_u32 s24, s24, 28672
  s_add_u32 s35, s35, 28672
  s_xor_b32 s25, s25, 28672
  s_add_u32 m0, s25, 21504
  s_nop 0
  buffer_load_dwordx4 v2, s[8:11], s24 offen offset:0 sc1 lds
  buffer_load_dwordx4 v2, s[8:11], s24 offen offset:1024 sc1 lds
  buffer_load_dwordx4 v2, s[8:11], s24 offen offset:2048 sc1 lds
  buffer_load_dwordx4 v2, s[8:11], s24 offen offset:3072 sc1 lds
  s_add_u32 m0, s25, 25600
  s_add_u32 s22, s24, 4096
  buffer_load_dwordx4 v2, s[8:11], s22 offen offset:0 sc1 lds
  buffer_load_dwordx4 v2, s[8:11], s22 offen offset:1024 sc1 lds
  buffer_load_dwordx4 v2, s[8:11], s22 offen offset:2048 sc1 lds
  v_xor_b32 v116, 28672, v116
  v_add_u32 v117, s57, v117
  s_sub_u32 s57, 0, s57
  s_add_u32 s19, s19, 1
  s_mov_b32 s20, s21
  s_cmp_lt_u32 s19, 63
  s_cbranch_scc1 cA_sc3_loop
  s_branch cA_done
cA_sc3_slow:
  v_max_f32 v50, v36, v44
  s_nop 1
  v_max_f32_dpp v50, v50, v50 quad_perm:[1,0,3,2] row_mask:0xf bank_mask:0xf
  s_nop 1
  v_max_f32_dpp v50, v50, v50 quad_perm:[2,3,0,1] row_mask:0xf bank_mask:0xf
  s_nop 1
  v_max_f32_dpp v50, v50, v50 row_half_mirror row_mask:0xf bank_mask:0xf
  s_nop 1
  v_max_f32_dpp v50, v50, v50 row_mirror row_mask:0xf bank_mask:0xf
  v_mov_b32 v47, v50
  s_nop 1
  v_permlane16_swap_b32 v50, v47
  v_max_f32 v50, v50, v47
  v_sub_f32 v48, v36, v50
  v_sub_f32 v49, v44, v50
  v_exp_f32 v48, v48
  v_exp_f32 v49, v49
  s_add_u32 s31, s31, 0x100
  v_fma_f32 v39, v49, s37, v48
  v_cndmask_b32 v41, v48, v49, s[38:39]
  s_nop 0
  v_add_f32_dpp v39, v39, v39 quad_perm:[1,0,3,2] row_mask:0xf bank_mask:0xf
  v_cndmask_b32 v40, v49, v48, s[38:39]
  v_mov_b32_dpp v46, v41 quad_perm:[1,0,3,2] row_mask:0xf bank_mask:0xf
  v_add_f32_dpp v39, v39, v39 quad_perm:[2,3,0,1] row_mask:0xf bank_mask:0xf
  v_cndmask_b32 v42, v46, v40, s[38:39]
  v_cndmask_b32 v43, v40, v46, s[38:39]
  v_add_f32_dpp v39, v39, v39 row_half_mirror row_mask:0xf bank_mask:0xf
  s_nop 1
  v_add_f32_dpp v39, v39, v39 row_mirror row_mask:0xf bank_mask:0xf
  v_mov_b32 v47, v39
  s_nop 1
  v_permlane16_swap_b32 v39, v47
  v_add_f32 v39, v39, v47
  v_rcp_f32 v39, v39
  s_mov_b64 exec, s[28:29]
  v_mul_f32 v42, v42, v39
  v_mul_f32 v43, v43, v39
  v_cvt_pk_bf16_f32 v42, v42, v43
  v_min_u32 v42, -2, v42
  s_branch cA_sc3_pst
cA_sc3_retry:
  s_cmp_lg_u32 s62, 0
  s_cbranch_scc1 cA_sc3_cont
  s_waitcnt vmcnt(0) lgkmcnt(0)
cA_sc3_rv:
  buffer_load_dwordx4 v[8:11], v2, s[8:11], s20 offen offset:0 sc1
  buffer_load_dwordx4 v[12:15], v2, s[8:11], s20 offen offset:1024 sc1
  buffer_load_dwordx4 v[16:19], v2, s[8:11], s20 offen offset:2048 sc1
  buffer_load_dwordx4 v[20:23], v2, s[8:11], s20 offen offset:3072 sc1
  buffer_load_dwordx4 v[24:27], v2, s[8:11], s23 offen offset:0 sc1
  buffer_load_dwordx4 v[28:31], v2, s[8:11], s23 offen offset:1024 sc1
  buffer_load_dwordx4 v[32:35], v2, s[8:11], s23 offen offset:2048 sc1
  s_waitcnt vmcnt(0)
  v_max3_u32 v118, v8, v9, v10
  v_max3_u32 v118, v118, v11, v12
  v_max3_u32 v118, v118, v13, v14
  v_max3_u32 v118, v118, v15, v16
  v_max3_u32 v118, v118, v17, v18
  v_max3_u32 v118, v118, v19, v20
  v_max3_u32 v118, v118, v21, v22
  v_max3_u32 v118, v118, v23, v24
  v_max3_u32 v118, v118, v25, v26
  v_max3_u32 v118, v118, v27, v28
  v_max3_u32 v118, v118, v29, v30
  v_max3_u32 v118, v118, v31, v32
  v_max3_u32 v118, v118, v33, v34
  v_max_u32 v118, v118, v35
  v_cmp_eq_u32 vcc, -1, v118
  s_cbranch_vccz cA_sc3_rk
  s_add_u32 s30, s30, 1
  s_cmp_lt_u32 s30, 400000
  s_cbranch_scc1 cA_sc3_rv
  s_branch cA_abort
cA_sc3_rk:
  s_mov_b32 s62, 1
  v_mov_b32 v36, 0
  v_mov_b32 v37, 0
  v_mov_b32 v38, 0
  v_mov_b32 v39, 0
  v_mov_b32 v40, 0
  v_mov_b32 v41, 0
  v_mov_b32 v42, 0
  v_mov_b32 v43, 0
  v_mov_b32 v44, 0
  v_mov_b32 v45, 0
  v_mov_b32 v46, 0
  v_mov_b32 v47, 0
  v_mov_b32 v48, 0
  v_mov_b32 v49, 0
  v_mov_b32 v50, 0
  v_mov_b32 v51, 0
  v_mov_b32 v52, 0
  v_mov_b32 v53, 0
  v_mov_b32 v54, 0
  v_mov_b32 v55, 0
  v_mov_b32 v56, 0
  v_mov_b32 v57, 0
  v_mov_b32 v58, 0
  v_mov_b32 v59, 0
  v_mov_b32 v60, 0
  v_mov_b32 v61, 0
  v_mov_b32 v62, 0
  v_mov_b32 v63, 0
  v_mov_b32 v88, 0
  v_mov_b32 v89, 0
  v_mov_b32 v90, 0
  v_mov_b32 v91, 0
  v_mov_b32 v92, 0
  v_mov_b32 v93, 0
  v_mov_b32 v94, 0
  v_mov_b32 v95, 0
  v_mov_b32 v64, 0
  v_mov_b32 v65, 0
  s_add_u32 s31, s31, 1
  ds_read_b128 v[96:99], v117 offset:0
  ds_read_b128 v[100:103], v117 offset:1024
  ds_read_b128 v[104:107], v117 offset:14336
  ds_read_b128 v[108:111], v117 offset:15360
  v_smfmac_f32_16x16x64_bf16 v[36:39], v[8:11], a[0:7], v3
  v_smfmac_f32_16x16x64_bf16 v[40:43], v[8:11], a[56:63], v3
  v_smfmac_f32_16x16x64_bf16 v[44:47], v[8:11], a[112:119], v3
  v_smfmac_f32_16x16x64_bf16 v[48:51], v[8:11], a[168:175], v3
  v_smfmac_f32_16x16x64_bf16 v[52:55], v[8:11], a[224:231], v3
  v_smfmac_f32_16x16x64_bf16 v[56:59], v[8:11], v[144:151], v3
  v_smfmac_f32_16x16x64_bf16 v[60:63], v[8:11], v[200:207], v3
  v_smfmac_f32_16x16x64_bf16 v[36:39], v[12:15], a[8:15], v3
  v_smfmac_f32_16x16x64_bf16 v[40:43], v[12:15], a[64:71], v3
  v_smfmac_f32_16x16x64_bf16 v[44:47], v[12:15], a[120:127], v3
  v_smfmac_f32_16x16x64_bf16 v[48:51], v[12:15], a[176:183], v3
  v_smfmac_f32_16x16x64_bf16 v[52:55], v[12:15], a[232:239], v3
  v_smfmac_f32_16x16x64_bf16 v[56:59], v[12:15], v[152:159], v3
  v_smfmac_f32_16x16x64_bf16 v[60:63], v[12:15], v[208:215], v3
  v_smfmac_f32_16x16x64_bf16 v[36:39], v[16:19], a[16:23], v3
  v_smfmac_f32_16x16x64_bf16 v[40:43], v[16:19], a[72:79], v3
  v_smfmac_f32_16x16x64_bf16 v[44:47], v[16:19], a[128:135], v3
  v_smfmac_f32_16x16x64_bf16 v[48:51], v[16:19], a[184:191], v3
  v_smfmac_f32_16x16x64_bf16 v[52:55], v[16:19], a[240:247], v3
  v_smfmac_f32_16x16x64_bf16 v[56:59], v[16:19], v[160:167], v3
  v_smfmac_f32_16x16x64_bf16 v[60:63], v[16:19], v[216:223], v3
  v_smfmac_f32_16x16x64_bf16 v[36:39], v[20:23], a[24:31], v3
  v_smfmac_f32_16x16x64_bf16 v[40:43], v[20:23], a[80:87], v3
  v_smfmac_f32_16x16x64_bf16 v[44:47], v[20:23], a[136:143], v3
  v_smfmac_f32_16x16x64_bf16 v[48:51], v[20:23], a[192:199], v3
  v_smfmac_f32_16x16x64_bf16 v[52:55], v[20:23], a[248:255], v3
  v_smfmac_f32_16x16x64_bf16 v[56:59], v[20:23], v[168:175], v3
  v_smfmac_f32_16x16x64_bf16 v[60:63], v[20:23], v[224:231], v3
  s_branch cA_sc3_ph2
cA_va0_loop:
  s_add_u32 s23, s20, 4096
  s_add_u32 s21, s20, 25600
  s_mov_b32 s30, 0
  s_cmp_lg_u32 s19, s38
  s_cbranch_scc1 cA_va0_vok
  s_branch cA_va0_voc
cA_va0_vow:
  buffer_load_dword v175, off, s[8:11], s35 sc1
  s_waitcnt vmcnt(0)
cA_va0_voc:
  v_readfirstlane_b32 s22, v175
  s_cmp_eq_u32 s22, 56
  s_cbranch_scc1 cA_va0_vod
  s_sleep 1
  s_add_u32 s30, s30, 1
  s_cmp_lt_u32 s30, 400000
  s_cbranch_scc1 cA_va0_vow
  s_branch cA_abort
cA_va0_vod:
  s_add_u32 s35, s35, 2048
  s_add_u32 s38, s19, 8
  s_and_b32 s38, s38, -8
  s_cmp_eq_u32 s19, 0
  s_cselect_b32 s38, 4, s38
cA_va0_vok:
  s_cmp_eq_u32 s19, 63
  s_cbranch_scc1 cA_done
  s_barrier
  s_add_u32 s22, s25, 0
  buffer_load_dwordx4 v[80:83], v6, s[8:11], s22 offen offset:0 sc1
  buffer_load_dwordx4 v[84:87], v6, s[8:11], s22 offen offset:1792 sc1
  s_add_u32 s22, s25, 3584
  buffer_load_dwordx4 v[88:91], v6, s[8:11], s22 offen offset:0 sc1
  buffer_load_dwordx4 v[92:95], v6, s[8:11], s22 offen offset:1792 sc1
  s_add_u32 s22, s25, 7168
  buffer_load_dwordx4 v[96:99], v6, s[8:11], s22 offen offset:0 sc1
  buffer_load_dwordx4 v[100:103], v6, s[8:11], s22 offen offset:1792 sc1
  s_add_u32 s22, s25, 10752
  buffer_load_dwordx4 v[104:107], v6, s[8:11], s22 offen offset:0 sc1
  buffer_load_dwordx4 v[108:111], v6, s[8:11], s22 offen offset:1792 sc1
  s_add_u32 s22, s25, 14336
  buffer_load_dwordx4 v[112:115], v6, s[8:11], s22 offen offset:0 sc1
  buffer_load_dwordx4 v[116:119], v6, s[8:11], s22 offen offset:1792 sc1
  s_add_u32 s22, s25, 17920
  buffer_load_dwordx4 v[120:123], v6, s[8:11], s22 offen offset:0 sc1
  buffer_load_dwordx4 v[124:127], v6, s[8:11], s22 offen offset:1792 sc1
  s_add_u32 s22, s25, 21504
  buffer_load_dwordx4 v[128:131], v6, s[8:11], s22 offen offset:0 sc1
  buffer_load_dwordx4 v[132:135], v6, s[8:11], s22 offen offset:1792 sc1
  s_add_u32 s22, s25, 25088
  buffer_load_dwordx4 v[136:139], v6, s[8:11], s22 offen offset:0 sc1
  buffer_load_dwordx4 v[140:143], v6, s[8:11], s22 offen offset:1792 sc1
  buffer_load_dword v175, off, s[8:11], s35 sc1
  s_barrier
  ds_read_b128 v[8:11], v2 offset:8192
  ds_read_b128 v[12:15], v2 offset:9216
  ds_read_b128 v[16:19], v2 offset:10240
  ds_read_b128 v[20:23], v2 offset:11264
  ds_read_b128 v[24:27], v2 offset:12288
  ds_read_b128 v[28:31], v2 offset:13312
  ds_read_b128 v[32:35], v2 offset:14336
  s_waitcnt lgkmcnt(0)
  v_smfmac_f32_16x16x64_bf16 v[36:39], v[8:11], a[0:7], v3
  v_smfmac_f32_16x16x64_bf16 v[36:39], v[12:15], a[8:15], v3
  v_smfmac_f32_16x16x64_bf16 v[36:39], v[16:19], a[16:23], v3
  v_smfmac_f32_16x16x64_bf16 v[36:39], v[20:23], a[24:31], v3
  v_smfmac_f32_16x16x64_bf16 v[36:39], v[24:27], a[32:39], v3
  v_smfmac_f32_16x16x64_bf16 v[36:39], v[28:31], a[40:47], v3
  v_smfmac_f32_16x16x64_bf16 v[36:39], v[32:35], a[48:55], v3
  v_smfmac_f32_16x16x64_bf16 v[40:43], v[8:11], a[56:63], v3
  v_smfmac_f32_16x16x64_bf16 v[40:43], v[12:15], a[64:71], v3
  v_smfmac_f32_16x16x64_bf16 v[40:43], v[16:19], a[72:79], v3
  v_smfmac_f32_16x16x64_bf16 v[40:43], v[20:23], a[80:87], v3
  v_smfmac_f32_16x16x64_bf16 v[40:43], v[24:27], a[88:95], v3
  v_smfmac_f32_16x16x64_bf16 v[40:43], v[28:31], a[96:103], v3
  v_smfmac_f32_16x16x64_bf16 v[40:43], v[32:35], a[104:111], v3
  v_smfmac_f32_16x16x64_bf16 v[44:47], v[8:11], a[112:119], v3
  v_smfmac_f32_16x16x64_bf16 v[44:47], v[12:15], a[120:127], v3
  v_smfmac_f32_16x16x64_bf16 v[44:47], v[16:19], a[128:135], v3
  v_smfmac_f32_16x16x64_bf16 v[44:47], v[20:23], a[136:143], v3
  v_permlane32_swap_b32 v36, v40
  v_smfmac_f32_16x16x64_bf16 v[44:47], v[24:27], a[144:151], v3
  v_permlane32_swap_b32 v37, v41
  v_smfmac_f32_16x16x64_bf16 v[44:47], v[28:31], a[152:159], v3
  v_permlane32_swap_b32 v38, v42
  v_smfmac_f32_16x16x64_bf16 v[44:47], v[32:35], a[160:167], v3
  v_permlane32_swap_b32 v39, v43
  v_smfmac_f32_16x16x64_bf16 v[48:51], v[8:11], a[168:175], v3
  v_add_f32 v36, v36, v40
  v_smfmac_f32_16x16x64_bf16 v[48:51], v[12:15], a[176:183], v3
  v_add_f32 v37, v37, v41
  v_smfmac_f32_16x16x64_bf16 v[48:51], v[16:19], a[184:191], v3
  v_add_f32 v38, v38, v42
  v_smfmac_f32_16x16x64_bf16 v[48:51], v[20:23], a[192:199], v3
  v_add_f32 v39, v39, v43
  v_smfmac_f32_16x16x64_bf16 v[48:51], v[24:27], a[200:207], v3
  v_cvt_pk_bf16_f32 v40, v36, v37
  v_smfmac_f32_16x16x64_bf16 v[48:51], v[28:31], a[208:215], v3
  v_cvt_pk_bf16_f32 v41, v38, v39
  v_smfmac_f32_16x16x64_bf16 v[48:51], v[32:35], a[216:223], v3
  ds_write_b64 v60, v[40:41]
  v_smfmac_f32_16x16x64_bf16 v[52:55], v[8:11], a[224:231], v3
  v_smfmac_f32_16x16x64_bf16 v[52:55], v[12:15], a[232:239], v3
  v_smfmac_f32_16x16x64_bf16 v[52:55], v[16:19], a[240:247], v3
  v_smfmac_f32_16x16x64_bf16 v[52:55], v[20:23], a[248:255], v3
  v_permlane32_swap_b32 v44, v48
  v_smfmac_f32_16x16x64_bf16 v[52:55], v[24:27], v[176:183], v3
  v_permlane32_swap_b32 v45, v49
  v_smfmac_f32_16x16x64_bf16 v[52:55], v[28:31], v[184:191], v3
  v_permlane32_swap_b32 v46, v50
  v_smfmac_f32_16x16x64_bf16 v[52:55], v[32:35], v[192:199], v3
  v_permlane32_swap_b32 v47, v51
  v_smfmac_f32_16x16x64_bf16 v[56:59], v[8:11], v[200:207], v3
  v_add_f32 v44, v44, v48
  v_smfmac_f32_16x16x64_bf16 v[56:59], v[12:15], v[208:215], v3
  v_add_f32 v45, v45, v49
  v_smfmac_f32_16x16x64_bf16 v[56:59], v[16:19], v[216:223], v3
  v_add_f32 v46, v46, v50
  v_smfmac_f32_16x16x64_bf16 v[56:59], v[20:23], v[224:231], v3
  v_add_f32 v47, v47, v51
  v_smfmac_f32_16x16x64_bf16 v[56:59], v[24:27], v[232:239], v3
  v_cvt_pk_bf16_f32 v48, v44, v45
  v_smfmac_f32_16x16x64_bf16 v[56:59], v[28:31], v[240:247], v3
  v_cvt_pk_bf16_f32 v49, v46, v47
  v_smfmac_f32_16x16x64_bf16 v[56:59], v[32:35], v[248:255], v3
  ds_write_b64 v61, v[48:49]
  s_nop 6
  v_permlane32_swap_b32 v52, v56
  v_permlane32_swap_b32 v53, v57
  v_permlane32_swap_b32 v54, v58
  v_permlane32_swap_b32 v55, v59
  v_add_f32 v52, v52, v56
  v_add_f32 v53, v53, v57
  v_add_f32 v54, v54, v58
  v_add_f32 v55, v55, v59
  v_cvt_pk_bf16_f32 v56, v52, v53
  v_cvt_pk_bf16_f32 v57, v54, v55
  ds_write_b64 v62, v[56:57]
  s_cmp_eq_u32 s19, 63
  s_cbranch_scc1 cA_va0_last
  s_add_u32 s22, s20, 9216
  s_add_u32 s34, s20, 13312
  s_add_u32 s36, s20, 7168
  s_mov_b32 s37, 0
  v_mov_b32 v156, 0
  v_mov_b32 v157, 0
  v_mov_b32 v158, 0
  v_mov_b32 v159, 0
  buffer_load_dword v164, v4, s[8:11], s20 offen sc1
  s_nop 7
  buffer_load_dword v165, v4, s[8:11], s20 offen sc1
  s_nop 7
  buffer_load_dword v166, v4, s[8:11], s20 offen sc1
  s_nop 7
  buffer_load_dword v167, v4, s[8:11], s20 offen sc1
  s_nop 7
  buffer_load_dword v168, v4, s[8:11], s20 offen sc1
cA_va0_fw_l:
  s_waitcnt vmcnt(4)
  v_cmp_eq_u32 vcc, -1, v164
  s_cbranch_vccz cA_va0_fw_d
  buffer_load_dword v164, v4, s[8:11], s20 offen sc1
  s_waitcnt vmcnt(4)
  v_cmp_eq_u32 vcc, -1, v165
  s_cbranch_vccz cA_va0_fw_d
  buffer_load_dword v165, v4, s[8:11], s20 offen sc1
  s_waitcnt vmcnt(4)
  v_cmp_eq_u32 vcc, -1, v166
  s_cbranch_vccz cA_va0_fw_d
  buffer_load_dword v166, v4, s[8:11], s20 offen sc1
  s_waitcnt vmcnt(4)
  v_cmp_eq_u32 vcc, -1, v167
  s_cbranch_vccz cA_va0_fw_d
  buffer_load_dword v167, v4, s[8:11], s20 offen sc1
  s_waitcnt vmcnt(4)
  v_cmp_eq_u32 vcc, -1, v168
  s_cbranch_vccz cA_va0_fw_d
  buffer_load_dword v168, v4, s[8:11], s20 offen sc1
  s_add_u32 s30, s30, 1
  s_cmp_lt_u32 s30, 400000
  s_cbranch_scc1 cA_va0_fw_l
  s_branch cA_abort
cA_va0_fw_d:
  s_waitcnt lgkmcnt(0)
  buffer_load_dwordx4 v[8:11], v2, s[8:11], s22 offen offset:0
  v_mov_b32 v36, 0
  v_mov_b32 v37, 0
  v_mov_b32 v38, 0
  buffer_load_dwordx4 v[12:15], v2, s[8:11], s22 offen offset:1024
  v_mov_b32 v39, 0
  v_mov_b32 v40, 0
  v_mov_b32 v41, 0
  buffer_load_dwordx4 v[16:19], v2, s[8:11], s22 offen offset:2048
  v_mov_b32 v42, 0
  v_mov_b32 v43, 0
  v_mov_b32 v44, 0
  buffer_load_dwordx4 v[20:23], v2, s[8:11], s22 offen offset:3072
  v_mov_b32 v45, 0
  v_mov_b32 v46, 0
  v_mov_b32 v47, 0
  buffer_load_dwordx4 v[24:27], v2, s[8:11], s34 offen offset:0
  v_mov_b32 v48, 0
  v_mov_b32 v49, 0
  v_mov_b32 v50, 0
  buffer_load_dwordx4 v[28:31], v2, s[8:11], s34 offen offset:1024
  v_mov_b32 v51, 0
  v_mov_b32 v52, 0
  v_mov_b32 v53, 0
  buffer_load_dwordx4 v[32:35], v2, s[8:11], s34 offen offset:2048
  v_mov_b32 v54, 0
  v_mov_b32 v55, 0
  v_mov_b32 v56, 0
  buffer_load_dwordx4 v[144:147], v2, s[8:11], s34 offen offset:3072
  v_mov_b32 v57, 0
  v_mov_b32 v58, 0
  v_mov_b32 v59, 0
  buffer_load_dwordx4 v[148:151], v2, s[8:11], s36 offen offset:0
  buffer_load_dwordx4 v[152:155], v2, s[8:11], s36 offen offset:1024
  s_barrier
  ds_read_b128 v[64:67], v2 offset:0
  ds_read_b128 v[68:71], v2 offset:1024
  ds_read_b128 v[72:75], v2 offset:2048
  ds_read_b128 v[76:79], v2 offset:3072
  s_waitcnt vmcnt(9)
  v_smfmac_f32_16x16x64_bf16 v[156:159], v[8:11], v[80:87], v3
  s_waitcnt vmcnt(8)
  v_smfmac_f32_16x16x64_bf16 v[156:159], v[12:15], v[88:95], v3
  s_waitcnt vmcnt(7)
  v_smfmac_f32_16x16x64_bf16 v[156:159], v[16:19], v[96:103], v3
  s_waitcnt vmcnt(6)
  v_smfmac_f32_16x16x64_bf16 v[156:159], v[20:23], v[104:111], v3
  s_waitcnt vmcnt(5)
  v_smfmac_f32_16x16x64_bf16 v[156:159], v[24:27], v[112:119], v3
  s_mov_b32 exec_hi, 0
  buffer_store_dword v2, v7, s[8:11], s21 offen
  s_mov_b64 exec, -1
  s_waitcnt vmcnt(5)
  v_smfmac_f32_16x16x64_bf16 v[156:159], v[28:31], v[120:127], v3
  s_waitcnt vmcnt(4)
  v_smfmac_f32_16x16x64_bf16 v[156:159], v[32:35], v[128:135], v3
  s_waitcnt vmcnt(3)
  v_smfmac_f32_16x16x64_bf16 v[156:159], v[144:147], v[136:143], v3
  s_waitcnt vmcnt(2) lgkmcnt(0)
  v_smfmac_f32_16x16x64_bf16 v[156:159], v[148:151], v[64:71], v3
  s_waitcnt vmcnt(1)
  v_smfmac_f32_16x16x64_bf16 v[156:159], v[152:155], v[72:79], v3
cA_va0_ep:
  s_nop 7
  v_permlane32_swap_b32 v156, v158
  v_permlane32_swap_b32 v157, v159
  v_add_f32 v160, v156, v158
  v_add_f32 v161, v157, v159
  v_cmp_u_f32 vcc, v160, v161
  v_mov_b32_dpp v162, v160 row_ror:8 row_mask:0xf bank_mask:0xf
  v_mov_b32_dpp v160, v161 row_ror:8 row_mask:0xf bank_mask:0xc
  s_cbranch_vccnz cA_va0_rp
  v_mov_b32_dpp v161, v162 quad_perm:[0,1,2,3] row_mask:0xf bank_mask:0x3
  v_cvt_pk_bf16_f32 v160, v160, v161
cA_va0_pc:
  buffer_store_dword v160, v1, s[8:11], s21 offen
  s_cmp_lg_u32 s19, 62
  s_cbranch_scc1 cA_va0_nl
  s_mov_b32 s22, 88519680
  buffer_store_dword v160, v1, s[8:11], s22 offen sc1
  s_mov_b64 exec, -1
  s_branch cA_done
cA_va0_nl:
  s_mov_b64 exec, -1
  s_add_u32 s25, s25, 28672
  s_add_u32 s19, s19, 1
  s_mov_b32 s20, s21
  s_branch cA_va0_loop
cA_va0_last:
  s_waitcnt lgkmcnt(0)
  s_barrier
  s_branch cA_done
cA_va0_rp:
  s_cmp_eq_u32 s37, 0
  s_cbranch_scc1 cA_va0_rv
  v_mov_b32_dpp v161, v162 quad_perm:[0,1,2,3] row_mask:0xf bank_mask:0x3
  v_cvt_pk_bf16_f32 v160, v160, v161
  v_min_u32 v160, -2, v160
  s_branch cA_va0_pc
cA_va0_rv:
  buffer_load_dwordx4 v[8:11], v2, s[8:11], s22 offen offset:0 sc1
  buffer_load_dwordx4 v[12:15], v2, s[8:11], s22 offen offset:1024 sc1
  buffer_load_dwordx4 v[16:19], v2, s[8:11], s22 offen offset:2048 sc1
  buffer_load_dwordx4 v[20:23], v2, s[8:11], s22 offen offset:3072 sc1
  buffer_load_dwordx4 v[24:27], v2, s[8:11], s34 offen offset:0 sc1
  buffer_load_dwordx4 v[28:31], v2, s[8:11], s34 offen offset:1024 sc1
  buffer_load_dwordx4 v[32:35], v2, s[8:11], s34 offen offset:2048 sc1
  buffer_load_dwordx4 v[144:147], v2, s[8:11], s34 offen offset:3072 sc1
  buffer_load_dwordx4 v[148:151], v2, s[8:11], s36 offen offset:0 sc1
  buffer_load_dwordx4 v[152:155], v2, s[8:11], s36 offen offset:1024 sc1
  s_waitcnt vmcnt(0)
  v_max3_u32 v63, v8, v9, v10
  v_max3_u32 v63, v63, v11, v12
  v_max3_u32 v63, v63, v13, v14
  v_max3_u32 v63, v63, v15, v16
  v_max3_u32 v63, v63, v17, v18
  v_max3_u32 v63, v63, v19, v20
  v_max3_u32 v63, v63, v21, v22
  v_max3_u32 v63, v63, v23, v24
  v_max3_u32 v63, v63, v25, v26
  v_max3_u32 v63, v63, v27, v28
  v_max3_u32 v63, v63, v29, v30
  v_max3_u32 v63, v63, v31, v32
  v_max3_u32 v63, v63, v33, v34
  v_max3_u32 v63, v63, v35, v144
  v_max3_u32 v63, v63, v145, v146
  v_max3_u32 v63, v63, v147, v148
  v_max3_u32 v63, v63, v149, v150
  v_max3_u32 v63, v63, v151, v152
  v_max3_u32 v63, v63, v153, v154
  v_max_u32 v63, v63, v155
  v_cmp_eq_u32 vcc, -1, v63
  s_cbranch_vccz cA_va0_rk
  s_add_u32 s30, s30, 1
  s_cmp_lt_u32 s30, 400000
  s_cbranch_scc1 cA_va0_rv
  s_branch cA_abort
cA_va0_rk:
  s_mov_b32 s37, 1
  s_add_u32 s31, s31, 0x10000
  v_mov_b32 v156, 0
  v_mov_b32 v157, 0
  v_mov_b32 v158, 0
  v_mov_b32 v159, 0
  s_nop 1
  v_smfmac_f32_16x16x64_bf16 v[156:159], v[8:11], v[80:87], v3
  v_smfmac_f32_16x16x64_bf16 v[156:159], v[12:15], v[88:95], v3
  v_smfmac_f32_16x16x64_bf16 v[156:159], v[16:19], v[96:103], v3
  v_smfmac_f32_16x16x64_bf16 v[156:159], v[20:23], v[104:111], v3
  v_smfmac_f32_16x16x64_bf16 v[156:159], v[24:27], v[112:119], v3
  v_smfmac_f32_16x16x64_bf16 v[156:159], v[28:31], v[120:127], v3
  v_smfmac_f32_16x16x64_bf16 v[156:159], v[32:35], v[128:135], v3
  v_smfmac_f32_16x16x64_bf16 v[156:159], v[144:147], v[136:143], v3
  v_smfmac_f32_16x16x64_bf16 v[156:159], v[148:151], v[64:71], v3
  v_smfmac_f32_16x16x64_bf16 v[156:159], v[152:155], v[72:79], v3
  s_nop 7
  s_branch cA_va0_ep
cA_va1_loop:
  s_add_u32 s23, s20, 4096
  s_add_u32 s21, s20, 25600
  s_mov_b32 s30, 0
  s_cmp_lg_u32 s19, s38
  s_cbranch_scc1 cA_va1_vok
  s_branch cA_va1_voc
cA_va1_vow:
  buffer_load_dword v175, off, s[8:11], s35 sc1
  s_waitcnt vmcnt(0)
cA_va1_voc:
  v_readfirstlane_b32 s22, v175
  s_cmp_eq_u32 s22, 56
  s_cbranch_scc1 cA_va1_vod
  s_sleep 1
  s_add_u32 s30, s30, 1
  s_cmp_lt_u32 s30, 400000
  s_cbranch_scc1 cA_va1_vow
  s_branch cA_abort
cA_va1_vod:
  s_add_u32 s35, s35, 2048
  s_add_u32 s38, s19, 8
  s_and_b32 s38, s38, -8
  s_cmp_eq_u32 s19, 0
  s_cselect_b32 s38, 4, s38
cA_va1_vok:
  s_cmp_eq_u32 s19, 63
  s_cbranch_scc1 cA_done
  s_barrier
  s_add_u32 s22, s25, 0
  buffer_load_dwordx4 v[80:83], v6, s[8:11], s22 offen offset:0 sc1
  buffer_load_dwordx4 v[84:87], v6, s[8:11], s22 offen offset:1792 sc1
  s_add_u32 s22, s25, 3584
  buffer_load_dwordx4 v[88:91], v6, s[8:11], s22 offen offset:0 sc1
  buffer_load_dwordx4 v[92:95], v6, s[8:11], s22 offen offset:1792 sc1
  s_add_u32 s22, s25, 7168
  buffer_load_dwordx4 v[96:99], v6, s[8:11], s22 offen offset:0 sc1
  buffer_load_dwordx4 v[100:103], v6, s[8:11], s22 offen offset:1792 sc1
  s_add_u32 s22, s25, 10752
  buffer_load_dwordx4 v[104:107], v6, s[8:11], s22 offen offset:0 sc1
  buffer_load_dwordx4 v[108:111], v6, s[8:11], s22 offen offset:1792 sc1
  s_add_u32 s22, s25, 14336
  buffer_load_dwordx4 v[112:115], v6, s[8:11], s22 offen offset:0 sc1
  buffer_load_dwordx4 v[116:119], v6, s[8:11], s22 offen offset:1792 sc1
  s_add_u32 s22, s25, 17920
  buffer_load_dwordx4 v[120:123], v6, s[8:11], s22 offen offset:0 sc1
  buffer_load_dwordx4 v[124:127], v6, s[8:11], s22 offen offset:1792 sc1
  s_add_u32 s22, s25, 21504
  buffer_load_dwordx4 v[128:131], v6, s[8:11], s22 offen offset:0 sc1
  buffer_load_dwordx4 v[132:135], v6, s[8:11], s22 offen offset:1792 sc1
  s_add_u32 s22, s25, 25088
  buffer_load_dwordx4 v[136:139], v6, s[8:11], s22 offen offset:0 sc1
  buffer_load_dwordx4 v[140:143], v6, s[8:11], s22 offen offset:1792 sc1
  buffer_load_dword v175, off, s[8:11], s35 sc1
  s_barrier
  ds_read_b128 v[8:11], v2 offset:8192
  ds_read_b128 v[12:15], v2 offset:9216
  ds_read_b128 v[16:19], v2 offset:10240
  ds_read_b128 v[20:23], v2 offset:11264
  ds_read_b128 v[24:27], v2 offset:12288
  ds_read_b128 v[28:31], v2 offset:13312
  ds_read_b128 v[32:35], v2 offset:14336
  s_waitcnt lgkmcnt(0)
  v_smfmac_f32_16x16x64_bf16 v[36:39], v[8:11], a[0:7], v3
  v_smfmac_f32_16x16x64_bf16 v[36:39], v[12:15], a[8:15], v3
  v_smfmac_f32_16x16x64_bf16 v[36:39], v[16:19], a[16:23], v3
  v_smfmac_f32_16x16x64_bf16 v[36:39], v[20:23], a[24:31], v3
  v_smfmac_f32_16x16x64_bf16 v[36:39], v[24:27], a[32:39], v3
  v_smfmac_f32_16x16x64_bf16 v[36:39], v[28:31], a[40:47], v3
  v_smfmac_f32_16x16x64_bf16 v[36:39], v[32:35], a[48:55], v3
  v_smfmac_f32_16x16x64_bf16 v[40:43], v[8:11], a[56:63], v3
  v_smfmac_f32_16x16x64_bf16 v[40:43], v[12:15], a[64:71], v3
  v_smfmac_f32_16x16x64_bf16 v[40:43], v[16:19], a[72:79], v3
  v_smfmac_f32_16x16x64_bf16 v[40:43], v[20:23], a[80:87], v3
  v_smfmac_f32_16x16x64_bf16 v[40:43], v[24:27], a[88:95], v3
  v_smfmac_f32_16x16x64_bf16 v[40:43], v[28:31], a[96:103], v3
  v_smfmac_f32_16x16x64_bf16 v[40:43], v[32:35], a[104:111], v3
  v_smfmac_f32_16x16x64_bf16 v[44:47], v[8:11], a[112:119], v3
  v_smfmac_f32_16x16x64_bf16 v[44:47], v[12:15], a[120:127], v3
  v_smfmac_f32_16x16x64_bf16 v[44:47], v[16:19], a[128:135], v3
  v_smfmac_f32_16x16x64_bf16 v[44:47], v[20:23], a[136:143], v3
  v_permlane32_swap_b32 v36, v40
  v_smfmac_f32_16x16x64_bf16 v[44:47], v[24:27], a[144:151], v3
  v_permlane32_swap_b32 v37, v41
  v_smfmac_f32_16x16x64_bf16 v[44:47], v[28:31], a[152:159], v3
  v_permlane32_swap_b32 v38, v42
  v_smfmac_f32_16x16x64_bf16 v[44:47], v[32:35], a[160:167], v3
  v_permlane32_swap_b32 v39, v43
  v_smfmac_f32_16x16x64_bf16 v[48:51], v[8:11], a[168:175], v3
  v_add_f32 v36, v36, v40
  v_smfmac_f32_16x16x64_bf16 v[48:51], v[12:15], a[176:183], v3
  v_add_f32 v37, v37, v41
  v_smfmac_f32_16x16x64_bf16 v[48:51], v[16:19], a[184:191], v3
  v_add_f32 v38, v38, v42
  v_smfmac_f32_16x16x64_bf16 v[48:51], v[20:23], a[192:199], v3
  v_add_f32 v39, v39, v43
  v_smfmac_f32_16x16x64_bf16 v[48:51], v[24:27], a[200:207], v3
  v_cvt_pk_bf16_f32 v40, v36, v37
  v_smfmac_f32_16x16x64_bf16 v[48:51], v[28:31], a[208:215], v3
  v_cvt_pk_bf16_f32 v41, v38, v39
  v_smfmac_f32_16x16x64_bf16 v[48:51], v[32:35], a[216:223], v3
  ds_write_b64 v60, v[40:41]
  v_smfmac_f32_16x16x64_bf16 v[52:55], v[8:11], a[224:231], v3
  v_smfmac_f32_16x16x64_bf16 v[52:55], v[12:15], a[232:239], v3
  v_smfmac_f32_16x16x64_bf16 v[52:55], v[16:19], a[240:247], v3
  v_smfmac_f32_16x16x64_bf16 v[52:55], v[20:23], a[248:255], v3
  v_permlane32_swap_b32 v44, v48
  v_smfmac_f32_16x16x64_bf16 v[52:55], v[24:27], v[176:183], v3
  v_permlane32_swap_b32 v45, v49
  v_smfmac_f32_16x16x64_bf16 v[52:55], v[28:31], v[184:191], v3
  v_permlane32_swap_b32 v46, v50
  v_smfmac_f32_16x16x64_bf16 v[52:55], v[32:35], v[192:199], v3
  v_permlane32_swap_b32 v47, v51
  v_smfmac_f32_16x16x64_bf16 v[56:59], v[8:11], v[200:207], v3
  v_add_f32 v44, v44, v48
  v_smfmac_f32_16x16x64_bf16 v[56:59], v[12:15], v[208:215], v3
  v_add_f32 v45, v45, v49
  v_smfmac_f32_16x16x64_bf16 v[56:59], v[16:19], v[216:223], v3
  v_add_f32 v46, v46, v50
  v_smfmac_f32_16x16x64_bf16 v[56:59], v[20:23], v[224:231], v3
  v_add_f32 v47, v47, v51
  v_smfmac_f32_16x16x64_bf16 v[56:59], v[24:27], v[232:239], v3
  v_cvt_pk_bf16_f32 v48, v44, v45
  v_smfmac_f32_16x16x64_bf16 v[56:59], v[28:31], v[240:247], v3
  v_cvt_pk_bf16_f32 v49, v46, v47
  v_smfmac_f32_16x16x64_bf16 v[56:59], v[32:35], v[248:255], v3
  ds_write_b64 v61, v[48:49]
  s_nop 6
  v_permlane32_swap_b32 v52, v56
  v_permlane32_swap_b32 v53, v57
  v_permlane32_swap_b32 v54, v58
  v_permlane32_swap_b32 v55, v59
  v_add_f32 v52, v52, v56
  v_add_f32 v53, v53, v57
  v_add_f32 v54, v54, v58
  v_add_f32 v55, v55, v59
  v_cvt_pk_bf16_f32 v56, v52, v53
  v_cvt_pk_bf16_f32 v57, v54, v55
  ds_write_b64 v62, v[56:57]
  s_cmp_eq_u32 s19, 63
  s_cbranch_scc1 cA_va1_last
  s_add_u32 s22, s20, 9216
  s_add_u32 s34, s20, 13312
  s_add_u32 s36, s20, 7168
  s_mov_b32 s37, 0
  v_mov_b32 v156, 0
  v_mov_b32 v157, 0
  v_mov_b32 v158, 0
  v_mov_b32 v159, 0
  buffer_load_dword v164, v4, s[8:11], s20 offen sc1
  s_nop 7
  buffer_load_dword v165, v4, s[8:11], s20 offen sc1
  s_nop 7
  buffer_load_dword v166, v4, s[8:11], s20 offen sc1
  s_nop 7
  buffer_load_dword v167, v4, s[8:11], s20 offen sc1
  s_nop 7
  buffer_load_dword v168, v4, s[8:11], s20 offen sc1
cA_va1_fw_l:
  s_waitcnt vmcnt(4)
  v_cmp_eq_u32 vcc, -1, v164
  s_cbranch_vccz cA_va1_fw_d
  buffer_load_dword v164, v4, s[8:11], s20 offen sc1
  s_waitcnt vmcnt(4)
  v_cmp_eq_u32 vcc, -1, v165
  s_cbranch_vccz cA_va1_fw_d
  buffer_load_dword v165, v4, s[8:11], s20 offen sc1
  s_waitcnt vmcnt(4)
  v_cmp_eq_u32 vcc, -1, v166
  s_cbranch_vccz cA_va1_fw_d
  buffer_load_dword v166, v4, s[8:11], s20 offen sc1
  s_waitcnt vmcnt(4)
  v_cmp_eq_u32 vcc, -1, v167
  s_cbranch_vccz cA_va1_fw_d
  buffer_load_dword v167, v4, s[8:11], s20 offen sc1
  s_waitcnt vmcnt(4)
  v_cmp_eq_u32 vcc, -1, v168
  s_cbranch_vccz cA_va1_fw_d
  buffer_load_dword v168, v4, s[8:11], s20 offen sc1
  s_add_u32 s30, s30, 1
  s_cmp_lt_u32 s30, 400000
  s_cbranch_scc1 cA_va1_fw_l
  s_branch cA_abort
cA_va1_fw_d:
  s_waitcnt lgkmcnt(0)
  buffer_load_dwordx4 v[8:11], v2, s[8:11], s22 offen offset:0
  v_mov_b32 v36, 0
  v_mov_b32 v37, 0
  v_mov_b32 v38, 0
  buffer_load_dwordx4 v[12:15], v2, s[8:11], s22 offen offset:1024
  v_mov_b32 v39, 0
  v_mov_b32 v40, 0
  v_mov_b32 v41, 0
  buffer_load_dwordx4 v[16:19], v2, s[8:11], s22 offen offset:2048
  v_mov_b32 v42, 0
  v_mov_b32 v43, 0
  v_mov_b32 v44, 0
  buffer_load_dwordx4 v[20:23], v2, s[8:11], s22 offen offset:3072
  v_mov_b32 v45, 0
  v_mov_b32 v46, 0
  v_mov_b32 v47, 0
  buffer_load_dwordx4 v[24:27], v2, s[8:11], s34 offen offset:0
  v_mov_b32 v48, 0
  v_mov_b32 v49, 0
  v_mov_b32 v50, 0
  buffer_load_dwordx4 v[28:31], v2, s[8:11], s34 offen offset:1024
  v_mov_b32 v51, 0
  v_mov_b32 v52, 0
  v_mov_b32 v53, 0
  buffer_load_dwordx4 v[32:35], v2, s[8:11], s34 offen offset:2048
  v_mov_b32 v54, 0
  v_mov_b32 v55, 0
  v_mov_b32 v56, 0
  buffer_load_dwordx4 v[144:147], v2, s[8:11], s34 offen offset:3072
  v_mov_b32 v57, 0
  v_mov_b32 v58, 0
  v_mov_b32 v59, 0
  buffer_load_dwordx4 v[148:151], v2, s[8:11], s36 offen offset:0
  buffer_load_dwordx4 v[152:155], v2, s[8:11], s36 offen offset:1024
  s_barrier
  ds_read_b128 v[64:67], v2 offset:4096
  ds_read_b128 v[68:71], v2 offset:5120
  ds_read_b128 v[72:75], v2 offset:6144
  ds_read_b128 v[76:79], v2 offset:7168
  s_waitcnt vmcnt(9)
  v_smfmac_f32_16x16x64_bf16 v[156:159], v[8:11], v[80:87], v3
  s_waitcnt vmcnt(8)
  v_smfmac_f32_16x16x64_bf16 v[156:159], v[12:15], v[88:95], v3
  s_waitcnt vmcnt(7)
  v_smfmac_f32_16x16x64_bf16 v[156:159], v[16:19], v[96:103], v3
  s_waitcnt vmcnt(6)
  v_smfmac_f32_16x16x64_bf16 v[156:159], v[20:23], v[104:111], v3
  s_waitcnt vmcnt(5)
  v_smfmac_f32_16x16x64_bf16 v[156:159], v[24:27], v[112:119], v3
  s_mov_b32 exec_hi, 0
  buffer_store_dword v2, v7, s[8:11], s21 offen
  s_mov_b64 exec, -1
  s_waitcnt vmcnt(5)
  v_smfmac_f32_16x16x64_bf16 v[156:159], v[28:31], v[120:127], v3
  s_waitcnt vmcnt(4)
  v_smfmac_f32_16x16x64_bf16 v[156:159], v[32:35], v[128:135], v3
  s_waitcnt vmcnt(3)
  v_smfmac_f32_16x16x64_bf16 v[156:159], v[144:147], v[136:143], v3
  s_waitcnt vmcnt(2) lgkmcnt(0)
  v_smfmac_f32_16x16x64_bf16 v[156:159], v[148:151], v[64:71], v3
  s_waitcnt vmcnt(1)
  v_smfmac_f32_16x16x64_bf16 v[156:159], v[152:155], v[72:79], v3
cA_va1_ep:
  s_nop 7
  v_permlane32_swap_b32 v156, v158
  v_permlane32_swap_b32 v157, v159
  v_add_f32 v160, v156, v158
  v_add_f32 v161, v157, v159
  v_cmp_u_f32 vcc, v160, v161
  v_mov_b32_dpp v162, v160 row_ror:8 row_mask:0xf bank_mask:0xf
  v_mov_b32_dpp v160, v161 row_ror:8 row_mask:0xf bank_mask:0xc
  s_cbranch_vccnz cA_va1_rp
  v_mov_b32_dpp v161, v162 quad_perm:[0,1,2,3] row_mask:0xf bank_mask:0x3
  v_cvt_pk_bf16_f32 v160, v160, v161
cA_va1_pc:
  s_mov_b64 exec, s[26:27]
  buffer_store_dword v160, v1, s[8:11], s21 offen
  s_cmp_lg_u32 s19, 62
  s_cbranch_scc1 cA_va1_nl
  s_mov_b32 s22, 88519680
  buffer_store_dword v160, v1, s[8:11], s22 offen sc1
  s_mov_b64 exec, -1
  s_branch cA_done
cA_va1_nl:
  s_mov_b64 exec, -1
  s_add_u32 s25, s25, 28672
  s_add_u32 s19, s19, 1
  s_mov_b32 s20, s21
  s_branch cA_va1_loop
cA_va1_last:
  s_waitcnt lgkmcnt(0)
  s_barrier
  s_branch cA_done
cA_va1_rp:
  s_cmp_eq_u32 s37, 0
  s_cbranch_scc1 cA_va1_rv
  v_mov_b32_dpp v161, v162 quad_perm:[0,1,2,3] row_mask:0xf bank_mask:0x3
  v_cvt_pk_bf16_f32 v160, v160, v161
  v_min_u32 v160, -2, v160
  s_branch cA_va1_pc
cA_va1_rv:
  buffer_load_dwordx4 v[8:11], v2, s[8:11], s22 offen offset:0 sc1
  buffer_load_dwordx4 v[12:15], v2, s[8:11], s22 offen offset:1024 sc1
  buffer_load_dwordx4 v[16:19], v2, s[8:11], s22 offen offset:2048 sc1
  buffer_load_dwordx4 v[20:23], v2, s[8:11], s22 offen offset:3072 sc1
  buffer_load_dwordx4 v[24:27], v2, s[8:11], s34 offen offset:0 sc1
  buffer_load_dwordx4 v[28:31], v2, s[8:11], s34 offen offset:1024 sc1
  buffer_load_dwordx4 v[32:35], v2, s[8:11], s34 offen offset:2048 sc1
  buffer_load_dwordx4 v[144:147], v2, s[8:11], s34 offen offset:3072 sc1
  buffer_load_dwordx4 v[148:151], v2, s[8:11], s36 offen offset:0 sc1
  buffer_load_dwordx4 v[152:155], v2, s[8:11], s36 offen offset:1024 sc1
  s_waitcnt vmcnt(0)
  v_max3_u32 v63, v8, v9, v10
  v_max3_u32 v63, v63, v11, v12
  v_max3_u32 v63, v63, v13, v14
  v_max3_u32 v63, v63, v15, v16
  v_max3_u32 v63, v63, v17, v18
  v_max3_u32 v63, v63, v19, v20
  v_max3_u32 v63, v63, v21, v22
  v_max3_u32 v63, v63, v23, v24
  v_max3_u32 v63, v63, v25, v26
  v_max3_u32 v63, v63, v27, v28
  v_max3_u32 v63, v63, v29, v30
  v_max3_u32 v63, v63, v31, v32
  v_max3_u32 v63, v63, v33, v34
  v_max3_u32 v63, v63, v35, v144
  v_max3_u32 v63, v63, v145, v146
  v_max3_u32 v63, v63, v147, v148
  v_max3_u32 v63, v63, v149, v150
  v_max3_u32 v63, v63, v151, v152
  v_max3_u32 v63, v63, v153, v154
  v_max_u32 v63, v63, v155
  v_cmp_eq_u32 vcc, -1, v63
  s_cbranch_vccz cA_va1_rk
  s_add_u32 s30, s30, 1
  s_cmp_lt_u32 s30, 400000
  s_cbranch_scc1 cA_va1_rv
  s_branch cA_abort
cA_va1_rk:
  s_mov_b32 s37, 1
  s_add_u32 s31, s31, 0x10000
  v_mov_b32 v156, 0
  v_mov_b32 v157, 0
  v_mov_b32 v158, 0
  v_mov_b32 v159, 0
  s_nop 1
  v_smfmac_f32_16x16x64_bf16 v[156:159], v[8:11], v[80:87], v3
  v_smfmac_f32_16x16x64_bf16 v[156:159], v[12:15], v[88:95], v3
  v_smfmac_f32_16x16x64_bf16 v[156:159], v[16:19], v[96:103], v3
  v_smfmac_f32_16x16x64_bf16 v[156:159], v[20:23], v[104:111], v3
  v_smfmac_f32_16x16x64_bf16 v[156:159], v[24:27], v[112:119], v3
  v_smfmac_f32_16x16x64_bf16 v[156:159], v[28:31], v[120:127], v3
  v_smfmac_f32_16x16x64_bf16 v[156:159], v[32:35], v[128:135], v3
  v_smfmac_f32_16x16x64_bf16 v[156:159], v[144:147], v[136:143], v3
  v_smfmac_f32_16x16x64_bf16 v[156:159], v[148:151], v[64:71], v3
  v_smfmac_f32_16x16x64_bf16 v[156:159], v[152:155], v[72:79], v3
  s_nop 7
  s_branch cA_va1_ep
cA_va2_loop:
  s_add_u32 s23, s20, 4096
  s_add_u32 s21, s20, 25600
  v_mov_b32 v36, 0
  v_mov_b32 v37, 0
  v_mov_b32 v38, 0
  v_mov_b32 v39, 0
  v_mov_b32 v40, 0
  v_mov_b32 v41, 0
  v_mov_b32 v42, 0
  v_mov_b32 v43, 0
  v_mov_b32 v44, 0
  v_mov_b32 v45, 0
  v_mov_b32 v46, 0
  v_mov_b32 v47, 0
  v_mov_b32 v48, 0
  v_mov_b32 v49, 0
  v_mov_b32 v50, 0
  v_mov_b32 v51, 0
  v_mov_b32 v52, 0
  v_mov_b32 v53, 0
  v_mov_b32 v54, 0
  v_mov_b32 v55, 0
  v_mov_b32 v56, 0
  v_mov_b32 v57, 0
  v_mov_b32 v58, 0
  v_mov_b32 v59, 0
  v_mov_b32 v60, 0
  v_mov_b32 v61, 0
  v_mov_b32 v62, 0
  v_mov_b32 v63, 0
  v_mov_b32 v64, 0
  v_mov_b32 v65, 0
  v_mov_b32 v66, 0
  v_mov_b32 v67, 0
  s_mov_b32 s30, 0
  buffer_load_dword v76, v119, s[8:11], s20 offen sc1
  buffer_load_dword v77, v119, s[8:11], s20 offen sc1
  buffer_load_dword v78, v119, s[8:11], s20 offen sc1
cA_va2_fp_l:
  s_waitcnt vmcnt(2)
  v_cmp_eq_u32 vcc, -1, v76
  s_cbranch_vccz cA_va2_fp_d
  buffer_load_dword v76, v119, s[8:11], s20 offen sc1
  s_waitcnt vmcnt(2)
  v_cmp_eq_u32 vcc, -1, v77
  s_cbranch_vccz cA_va2_fp_d
  buffer_load_dword v77, v119, s[8:11], s20 offen sc1
  s_waitcnt vmcnt(2)
  v_cmp_eq_u32 vcc, -1, v78
  s_cbranch_vccz cA_va2_fp_d
  buffer_load_dword v78, v119, s[8:11], s20 offen sc1
  s_add_u32 s30, s30, 1
  s_cmp_lt_u32 s30, 400000
  s_cbranch_scc1 cA_va2_fp_l
  s_branch cA_abort
cA_va2_fp_d:
  buffer_load_dwordx4 v[8:11], v2, s[8:11], s20 offen offset:0 sc1
  buffer_load_dwordx4 v[12:15], v2, s[8:11], s20 offen offset:1024 sc1
  buffer_load_dwordx4 v[16:19], v2, s[8:11], s20 offen offset:2048 sc1
  buffer_load_dwordx4 v[20:23], v2, s[8:11], s20 offen offset:3072 sc1
  s_barrier
cA_va2_ld:
  s_waitcnt vmcnt(0)
  v_max3_u32 v84, v8, v9, v10
  v_max3_u32 v84, v84, v11, v12
  v_max3_u32 v84, v84, v13, v14
  v_max3_u32 v84, v84, v15, v16
  v_max3_u32 v84, v84, v17, v18
  v_max3_u32 v84, v84, v19, v20
  v_max3_u32 v84, v84, v21, v22
  v_max_u32 v84, v84, v23
  v_cmp_eq_u32 vcc, -1, v84
  ds_write_b128 v2, v[8:11] offset:8192
  ds_write_b128 v2, v[12:15] offset:9216
  ds_write_b128 v2, v[16:19] offset:10240
  ds_write_b128 v2, v[20:23] offset:11264
  s_cbranch_vccnz cA_va2_retry
  s_waitcnt lgkmcnt(0)
  s_barrier
  ds_read_b128 v[24:27], v2 offset:12288
  ds_read_b128 v[28:31], v2 offset:13312
  ds_read_b128 v[32:35], v2 offset:14336
  ds_read_b128 v[92:95], v0
  s_waitcnt lgkmcnt(0)
  s_mov_b64 exec, s[26:27]
  buffer_store_dwordx4 v[92:95], v2, s[8:11], s36 offen sc1
  s_mov_b64 exec, -1
  s_add_u32 s36, s36, 7168
  s_cmp_eq_u32 s19, 63
  s_cbranch_scc1 cA_done
  ds_read_b128 v[76:79], v1 offset:0
  ds_read_b128 v[80:83], v1 offset:1024
  ds_read_b128 v[84:87], v1 offset:2048
  ds_read_b128 v[88:91], v1 offset:3072
  ds_read_b128 v[92:95], v1 offset:4096
  ds_read_b128 v[96:99], v1 offset:5120
  v_smfmac_f32_16x16x64_bf16 v[60:63], v[8:11], v[200:207], v3
  v_smfmac_f32_16x16x64_bf16 v[60:63], v[12:15], v[208:215], v3
  s_waitcnt lgkmcnt(4)
  v_smfmac_f32_16x16x64_bf16 v[64:67], v[8:11], v[76:83], v3
  ds_read_b128 v[76:79], v1 offset:6144
  ds_read_b128 v[80:83], v1 offset:7168
  v_smfmac_f32_16x16x64_bf16 v[60:63], v[16:19], v[216:223], v3
  v_smfmac_f32_16x16x64_bf16 v[60:63], v[20:23], v[224:231], v3
  s_waitcnt lgkmcnt(4)
  v_smfmac_f32_16x16x64_bf16 v[64:67], v[12:15], v[84:91], v3
  ds_read_b128 v[84:87], v1 offset:8192
  ds_read_b128 v[88:91], v1 offset:9216
  v_smfmac_f32_16x16x64_bf16 v[60:63], v[24:27], v[232:239], v3
  v_smfmac_f32_16x16x64_bf16 v[60:63], v[28:31], v[240:247], v3
  s_waitcnt lgkmcnt(4)
  v_smfmac_f32_16x16x64_bf16 v[64:67], v[16:19], v[92:99], v3
  ds_read_b128 v[92:95], v1 offset:10240
  ds_read_b128 v[96:99], v1 offset:11264
  v_smfmac_f32_16x16x64_bf16 v[60:63], v[32:35], v[248:255], v3
  v_smfmac_f32_16x16x64_bf16 v[36:39], v[8:11], a[0:7], v3
  s_waitcnt lgkmcnt(4)
  v_smfmac_f32_16x16x64_bf16 v[64:67], v[20:23], v[76:83], v3
  ds_read_b128 v[76:79], v1 offset:12288
  ds_read_b128 v[80:83], v1 offset:13312
  v_smfmac_f32_16x16x64_bf16 v[36:39], v[12:15], a[8:15], v3
  v_smfmac_f32_16x16x64_bf16 v[36:39], v[16:19], a[16:23], v3
  s_waitcnt lgkmcnt(4)
  v_smfmac_f32_16x16x64_bf16 v[64:67], v[24:27], v[84:91], v3
  v_smfmac_f32_16x16x64_bf16 v[36:39], v[20:23], a[24:31], v3
  v_smfmac_f32_16x16x64_bf16 v[36:39], v[24:27], a[32:39], v3
  s_waitcnt lgkmcnt(2)
  v_smfmac_f32_16x16x64_bf16 v[64:67], v[28:31], v[92:99], v3
  v_smfmac_f32_16x16x64_bf16 v[36:39], v[28:31], a[40:47], v3
  v_smfmac_f32_16x16x64_bf16 v[36:39], v[32:35], a[48:55], v3
  s_waitcnt lgkmcnt(0)
  v_smfmac_f32_16x16x64_bf16 v[64:67], v[32:35], v[76:83], v3
  v_smfmac_f32_16x16x64_bf16 v[40:43], v[8:11], a[56:63], v3
  v_smfmac_f32_16x16x64_bf16 v[40:43], v[12:15], a[64:71], v3
  v_smfmac_f32_16x16x64_bf16 v[40:43], v[16:19], a[72:79], v3
  v_smfmac_f32_16x16x64_bf16 v[40:43], v[20:23], a[80:87], v3
  v_permlane32_swap_b32 v60, v64
  v_smfmac_f32_16x16x64_bf16 v[40:43], v[24:27], a[88:95], v3
  v_permlane32_swap_b32 v61, v65
  v_smfmac_f32_16x16x64_bf16 v[40:43], v[28:31], a[96:103], v3
  v_permlane32_swap_b32 v62, v66
  v_smfmac_f32_16x16x64_bf16 v[40:43], v[32:35], a[104:111], v3
  v_permlane32_swap_b32 v63, v67
  v_smfmac_f32_16x16x64_bf16 v[44:47], v[8:11], a[112:119], v3
  v_smfmac_f32_16x16x64_bf16 v[44:47], v[12:15], a[120:127], v3
  v_smfmac_f32_16x16x64_bf16 v[44:47], v[16:19], a[128:135], v3
  v_smfmac_f32_16x16x64_bf16 v[44:47], v[20:23], a[136:143], v3
  v_add_f32 v60, v60, v64
  v_add_f32 v61, v61, v65
  v_smfmac_f32_16x16x64_bf16 v[44:47], v[24:27], a[144:151], v3
  v_add_f32 v62, v62, v66
  v_add_f32 v63, v63, v67
  v_smfmac_f32_16x16x64_bf16 v[44:47], v[28:31], a[152:159], v3
  v_cvt_pk_bf16_f32 v64, v60, v61
  v_cvt_pk_bf16_f32 v65, v62, v63
  v_smfmac_f32_16x16x64_bf16 v[44:47], v[32:35], a[160:167], v3
  ds_write_b64 v115, v[64:65]
  v_smfmac_f32_16x16x64_bf16 v[48:51], v[8:11], a[168:175], v3
  v_permlane32_swap_b32 v36, v40
  v_smfmac_f32_16x16x64_bf16 v[48:51], v[12:15], a[176:183], v3
  v_permlane32_swap_b32 v37, v41
  v_smfmac_f32_16x16x64_bf16 v[48:51], v[16:19], a[184:191], v3
  v_permlane32_swap_b32 v38, v42
  v_smfmac_f32_16x16x64_bf16 v[48:51], v[20:23], a[192:199], v3
  v_permlane32_swap_b32 v39, v43
  v_smfmac_f32_16x16x64_bf16 v[48:51], v[24:27], a[200:207], v3
  v_add_f32 v36, v36, v40
  v_smfmac_f32_16x16x64_bf16 v[48:51], v[28:31], a[208:215], v3
  v_add_f32 v37, v37, v41
  v_smfmac_f32_16x16x64_bf16 v[48:51], v[32:35], a[216:223], v3
  v_add_f32 v38, v38, v42
  v_smfmac_f32_16x16x64_bf16 v[52:55], v[8:11], a[224:231], v3
  v_smfmac_f32_16x16x64_bf16 v[52:55], v[12:15], a[232:239], v3
  v_smfmac_f32_16x16x64_bf16 v[52:55], v[16:19], a[240:247], v3
  v_smfmac_f32_16x16x64_bf16 v[52:55], v[20:23], a[248:255], v3
  v_add_f32 v39, v39, v43
  v_cvt_pk_bf16_f32 v40, v36, v37
  v_smfmac_f32_16x16x64_bf16 v[52:55], v[24:27], v[120:127], v3
  v_cvt_pk_bf16_f32 v41, v38, v39
  v_smfmac_f32_16x16x64_bf16 v[52:55], v[28:31], v[128:135], v3
  ds_write_b64 v112, v[40:41]
  v_smfmac_f32_16x16x64_bf16 v[52:55], v[32:35], v[136:143], v3
  v_permlane32_swap_b32 v44, v48
  v_smfmac_f32_16x16x64_bf16 v[56:59], v[8:11], v[144:151], v3
  v_permlane32_swap_b32 v45, v49
  v_smfmac_f32_16x16x64_bf16 v[56:59], v[12:15], v[152:159], v3
  v_permlane32_swap_b32 v46, v50
  v_smfmac_f32_16x16x64_bf16 v[56:59], v[16:19], v[160:167], v3
  v_permlane32_swap_b32 v47, v51
  v_smfmac_f32_16x16x64_bf16 v[56:59], v[20:23], v[168:175], v3
  v_add_f32 v44, v44, v48
  v_smfmac_f32_16x16x64_bf16 v[56:59], v[24:27], v[176:183], v3
  v_add_f32 v45, v45, v49
  v_smfmac_f32_16x16x64_bf16 v[56:59], v[28:31], v[184:191], v3
  v_add_f32 v46, v46, v50
  v_smfmac_f32_16x16x64_bf16 v[56:59], v[32:35], v[192:199], v3
  v_add_f32 v47, v47, v51
  v_cvt_pk_bf16_f32 v48, v44, v45
  v_cvt_pk_bf16_f32 v49, v46, v47
  ds_write_b64 v113, v[48:49]
  s_nop 3
  v_permlane32_swap_b32 v52, v56
  v_permlane32_swap_b32 v53, v57
  v_permlane32_swap_b32 v54, v58
  v_permlane32_swap_b32 v55, v59
  v_add_f32 v52, v52, v56
  v_add_f32 v53, v53, v57
  v_add_f32 v54, v54, v58
  v_add_f32 v55, v55, v59
  v_cvt_pk_bf16_f32 v56, v52, v53
  v_cvt_pk_bf16_f32 v57, v54, v55
  ds_write_b64 v114, v[56:57]
  s_waitcnt lgkmcnt(0)
  s_barrier
  s_cmp_eq_u32 s19, 62
  s_cbranch_scc1 cA_done
  s_waitcnt vmcnt(0) lgkmcnt(0)
  s_add_u32 s19, s19, 1
  s_mov_b32 s20, s21
  s_branch cA_va2_loop
cA_va2_retry:
  s_waitcnt lgkmcnt(0)
  buffer_load_dwordx4 v[8:11], v2, s[8:11], s20 offen offset:0 sc1
  buffer_load_dwordx4 v[12:15], v2, s[8:11], s20 offen offset:1024 sc1
  buffer_load_dwordx4 v[16:19], v2, s[8:11], s20 offen offset:2048 sc1
  buffer_load_dwordx4 v[20:23], v2, s[8:11], s20 offen offset:3072 sc1
  s_add_u32 s31, s31, 1
  s_add_u32 s30, s30, 1
  s_cmp_lt_u32 s30, 400000
  s_cbranch_scc1 cA_va2_ld
  s_branch cA_abort
cA_va2_last:
  s_waitcnt lgkmcnt(0)
  buffer_store_dwordx4 v[100:103], v2, s[8:11], s24 offen offset:0 sc1
  buffer_store_dwordx4 v[104:107], v2, s[8:11], s24 offen offset:1024 sc1
  buffer_store_dwordx4 v[108:111], v2, s[8:11], s24 offen offset:2048 sc1
  buffer_store_dwordx4 v[4:7], v2, s[8:11], s24 offen offset:3072 sc1
  s_add_u32 s24, s24, 8192
  s_waitcnt vmcnt(0)
  s_mov_b64 exec, 1
  buffer_store_dword v117, v2, s[8:11], s34 offen sc1
  s_mov_b64 exec, -1
  s_add_u32 s34, s34, 8
  s_mov_b64 exec, 1
  buffer_store_dword v117, v2, s[8:11], s34 offen sc1
  s_mov_b64 exec, -1
  s_add_u32 s34, s34, 8
  s_branch cA_done
cA_va3_loop:
  s_add_u32 s23, s20, 4096
  s_add_u32 s21, s20, 25600
  v_mov_b32 v36, 0
  v_mov_b32 v37, 0
  v_mov_b32 v38, 0
  v_mov_b32 v39, 0
  v_mov_b32 v40, 0
  v_mov_b32 v41, 0
  v_mov_b32 v42, 0
  v_mov_b32 v43, 0
  v_mov_b32 v44, 0
  v_mov_b32 v45, 0
  v_mov_b32 v46, 0
  v_mov_b32 v47, 0
  v_mov_b32 v48, 0
  v_mov_b32 v49, 0
  v_mov_b32 v50, 0
  v_mov_b32 v51, 0
  v_mov_b32 v52, 0
  v_mov_b32 v53, 0
  v_mov_b32 v54, 0
  v_mov_b32 v55, 0
  v_mov_b32 v56, 0
  v_mov_b32 v57, 0
  v_mov_b32 v58, 0
  v_mov_b32 v59, 0
  v_mov_b32 v60, 0
  v_mov_b32 v61, 0
  v_mov_b32 v62, 0
  v_mov_b32 v63, 0
  v_mov_b32 v64, 0
  v_mov_b32 v65, 0
  v_mov_b32 v66, 0
  v_mov_b32 v67, 0
  s_mov_b32 s30, 0
  buffer_load_dword v76, v119, s[8:11], s20 offen sc1
  buffer_load_dword v77, v119, s[8:11], s20 offen sc1
  buffer_load_dword v78, v119, s[8:11], s20 offen sc1
cA_va3_fp_l:
  s_waitcnt vmcnt(2)
  v_cmp_eq_u32 vcc, -1, v76
  s_cbranch_vccz cA_va3_fp_d
  buffer_load_dword v76, v119, s[8:11], s20 offen sc1
  s_waitcnt vmcnt(2)
  v_cmp_eq_u32 vcc, -1, v77
  s_cbranch_vccz cA_va3_fp_d
  buffer_load_dword v77, v119, s[8:11], s20 offen sc1
  s_waitcnt vmcnt(2)
  v_cmp_eq_u32 vcc, -1, v78
  s_cbranch_vccz cA_va3_fp_d
  buffer_load_dword v78, v119, s[8:11], s20 offen sc1
  s_add_u32 s30, s30, 1
  s_cmp_lt_u32 s30, 400000
  s_cbranch_scc1 cA_va3_fp_l
  s_branch cA_abort
cA_va3_fp_d:
  buffer_load_dwordx4 v[24:27], v2, s[8:11], s23 offen offset:0 sc1
  buffer_load_dwordx4 v[28:31], v2, s[8:11], s23 offen offset:1024 sc1
  buffer_load_dwordx4 v[32:35], v2, s[8:11], s23 offen offset:2048 sc1
  s_barrier
cA_va3_ld:
  s_waitcnt vmcnt(0)
  v_max3_u32 v84, v24, v25, v26
  v_max3_u32 v84, v84, v27, v28
  v_max3_u32 v84, v84, v29, v30
  v_max3_u32 v84, v84, v31, v32
  v_max3_u32 v84, v84, v33, v34
  v_max_u32 v84, v84, v35
  v_cmp_eq_u32 vcc, -1, v84
  ds_write_b128 v2, v[24:27] offset:12288
  ds_write_b128 v2, v[28:31] offset:13312
  ds_write_b128 v2, v[32:35] offset:14336
  s_cbranch_vccnz cA_va3_retry
  s_waitcnt lgkmcnt(0)
  s_barrier
  ds_read_b128 v[8:11], v2 offset:8192
  ds_read_b128 v[12:15], v2 offset:9216
  ds_read_b128 v[16:19], v2 offset:10240
  ds_read_b128 v[20:23], v2 offset:11264
  s_waitcnt lgkmcnt(0)
  s_cmp_eq_u32 s19, 63
  s_cbranch_scc1 cA_done
  ds_read_b128 v[76:79], v1 offset:0
  ds_read_b128 v[80:83], v1 offset:1024
  ds_read_b128 v[84:87], v1 offset:2048
  ds_read_b128 v[88:91], v1 offset:3072
  ds_read_b128 v[92:95], v1 offset:4096
  ds_read_b128 v[96:99], v1 offset:5120
  v_smfmac_f32_16x16x64_bf16 v[60:63], v[8:11], v[200:207], v3
  v_smfmac_f32_16x16x64_bf16 v[60:63], v[12:15], v[208:215], v3
  s_waitcnt lgkmcnt(4)
  v_smfmac_f32_16x16x64_bf16 v[64:67], v[8:11], v[76:83], v3
  ds_read_b128 v[76:79], v1 offset:6144
  ds_read_b128 v[80:83], v1 offset:7168
  v_smfmac_f32_16x16x64_bf16 v[60:63], v[16:19], v[216:223], v3
  v_smfmac_f32_16x16x64_bf16 v[60:63], v[20:23], v[224:231], v3
  s_waitcnt lgkmcnt(4)
  v_smfmac_f32_16x16x64_bf16 v[64:67], v[12:15], v[84:91], v3
  ds_read_b128 v[84:87], v1 offset:8192
  ds_read_b128 v[88:91], v1 offset:9216
  v_smfmac_f32_16x16x64_bf16 v[60:63], v[24:27], v[232:239], v3
  v_smfmac_f32_16x16x64_bf16 v[60:63], v[28:31], v[240:247], v3
  s_waitcnt lgkmcnt(4)
  v_smfmac_f32_16x16x64_bf16 v[64:67], v[16:19], v[92:99], v3
  ds_read_b128 v[92:95], v1 offset:10240
  ds_read_b128 v[96:99], v1 offset:11264
  v_smfmac_f32_16x16x64_bf16 v[60:63], v[32:35], v[248:255], v3
  v_smfmac_f32_16x16x64_bf16 v[36:39], v[8:11], a[0:7], v3
  s_waitcnt lgkmcnt(4)
  v_smfmac_f32_16x16x64_bf16 v[64:67], v[20:23], v[76:83], v3
  ds_read_b128 v[76:79], v1 offset:12288
  ds_read_b128 v[80:83], v1 offset:13312
  v_smfmac_f32_16x16x64_bf16 v[36:39], v[12:15], a[8:15], v3
  v_smfmac_f32_16x16x64_bf16 v[36:39], v[16:19], a[16:23], v3
  s_waitcnt lgkmcnt(4)
  v_smfmac_f32_16x16x64_bf16 v[64:67], v[24:27], v[84:91], v3
  v_smfmac_f32_16x16x64_bf16 v[36:39], v[20:23], a[24:31], v3
  v_smfmac_f32_16x16x64_bf16 v[36:39], v[24:27], a[32:39], v3
  s_waitcnt lgkmcnt(2)
  v_smfmac_f32_16x16x64_bf16 v[64:67], v[28:31], v[92:99], v3
  v_smfmac_f32_16x16x64_bf16 v[36:39], v[28:31], a[40:47], v3
  v_smfmac_f32_16x16x64_bf16 v[36:39], v[32:35], a[48:55], v3
  s_waitcnt lgkmcnt(0)
  v_smfmac_f32_16x16x64_bf16 v[64:67], v[32:35], v[76:83], v3
  v_smfmac_f32_16x16x64_bf16 v[40:43], v[8:11], a[56:63], v3
  v_smfmac_f32_16x16x64_bf16 v[40:43], v[12:15], a[64:71], v3
  v_smfmac_f32_16x16x64_bf16 v[40:43], v[16:19], a[72:79], v3
  v_smfmac_f32_16x16x64_bf16 v[40:43], v[20:23], a[80:87], v3
  v_permlane32_swap_b32 v60, v64
  v_smfmac_f32_16x16x64_bf16 v[40:43], v[24:27], a[88:95], v3
  v_permlane32_swap_b32 v61, v65
  v_smfmac_f32_16x16x64_bf16 v[40:43], v[28:31], a[96:103], v3
  v_permlane32_swap_b32 v62, v66
  v_smfmac_f32_16x16x64_bf16 v[40:43], v[32:35], a[104:111], v3
  v_permlane32_swap_b32 v63, v67
  v_smfmac_f32_16x16x64_bf16 v[44:47], v[8:11], a[112:119], v3
  v_smfmac_f32_16x16x64_bf16 v[44:47], v[12:15], a[120:127], v3
  v_smfmac_f32_16x16x64_bf16 v[44:47], v[16:19], a[128:135], v3
  v_smfmac_f32_16x16x64_bf16 v[44:47], v[20:23], a[136:143], v3
  v_add_f32 v60, v60, v64
  v_add_f32 v61, v61, v65
  v_smfmac_f32_16x16x64_bf16 v[44:47], v[24:27], a[144:151], v3
  v_add_f32 v62, v62, v66
  v_add_f32 v63, v63, v67
  v_smfmac_f32_16x16x64_bf16 v[44:47], v[28:31], a[152:159], v3
  v_cvt_pk_bf16_f32 v64, v60, v61
  v_cvt_pk_bf16_f32 v65, v62, v63
  v_smfmac_f32_16x16x64_bf16 v[44:47], v[32:35], a[160:167], v3
  ds_write_b64 v115, v[64:65]
  v_smfmac_f32_16x16x64_bf16 v[48:51], v[8:11], a[168:175], v3
  v_permlane32_swap_b32 v36, v40
  v_smfmac_f32_16x16x64_bf16 v[48:51], v[12:15], a[176:183], v3
  v_permlane32_swap_b32 v37, v41
  v_smfmac_f32_16x16x64_bf16 v[48:51], v[16:19], a[184:191], v3
  v_permlane32_swap_b32 v38, v42
  v_smfmac_f32_16x16x64_bf16 v[48:51], v[20:23], a[192:199], v3
  v_permlane32_swap_b32 v39, v43
  v_smfmac_f32_16x16x64_bf16 v[48:51], v[24:27], a[200:207], v3
  v_add_f32 v36, v36, v40
  v_smfmac_f32_16x16x64_bf16 v[48:51], v[28:31], a[208:215], v3
  v_add_f32 v37, v37, v41
  v_smfmac_f32_16x16x64_bf16 v[48:51], v[32:35], a[216:223], v3
  v_add_f32 v38, v38, v42
  v_smfmac_f32_16x16x64_bf16 v[52:55], v[8:11], a[224:231], v3
  v_smfmac_f32_16x16x64_bf16 v[52:55], v[12:15], a[232:239], v3
  v_smfmac_f32_16x16x64_bf16 v[52:55], v[16:19], a[240:247], v3
  v_smfmac_f32_16x16x64_bf16 v[52:55], v[20:23], a[248:255], v3
  v_add_f32 v39, v39, v43
  v_cvt_pk_bf16_f32 v40, v36, v37
  v_smfmac_f32_16x16x64_bf16 v[52:55], v[24:27], v[120:127], v3
  v_cvt_pk_bf16_f32 v41, v38, v39
  v_smfmac_f32_16x16x64_bf16 v[52:55], v[28:31], v[128:135], v3
  ds_write_b64 v112, v[40:41]
  v_smfmac_f32_16x16x64_bf16 v[52:55], v[32:35], v[136:143], v3
  v_permlane32_swap_b32 v44, v48
  v_smfmac_f32_16x16x64_bf16 v[56:59], v[8:11], v[144:151], v3
  v_permlane32_swap_b32 v45, v49
  v_smfmac_f32_16x16x64_bf16 v[56:59], v[12:15], v[152:159], v3
  v_permlane32_swap_b32 v46, v50
  v_smfmac_f32_16x16x64_bf16 v[56:59], v[16:19], v[160:167], v3
  v_permlane32_swap_b32 v47, v51
  v_smfmac_f32_16x16x64_bf16 v[56:59], v[20:23], v[168:175], v3
  v_add_f32 v44, v44, v48
  v_smfmac_f32_16x16x64_bf16 v[56:59], v[24:27], v[176:183], v3
  v_add_f32 v45, v45, v49
  v_smfmac_f32_16x16x64_bf16 v[56:59], v[28:31], v[184:191], v3
  v_add_f32 v46, v46, v50
  v_smfmac_f32_16x16x64_bf16 v[56:59], v[32:35], v[192:199], v3
  v_add_f32 v47, v47, v51
  v_cvt_pk_bf16_f32 v48, v44, v45
  v_cvt_pk_bf16_f32 v49, v46, v47
  ds_write_b64 v113, v[48:49]
  s_nop 3
  v_permlane32_swap_b32 v52, v56
  v_permlane32_swap_b32 v53, v57
  v_permlane32_swap_b32 v54, v58
  v_permlane32_swap_b32 v55, v59
  v_add_f32 v52, v52, v56
  v_add_f32 v53, v53, v57
  v_add_f32 v54, v54, v58
  v_add_f32 v55, v55, v59
  v_cvt_pk_bf16_f32 v56, v52, v53
  v_cvt_pk_bf16_f32 v57, v54, v55
  ds_write_b64 v114, v[56:57]
  s_waitcnt lgkmcnt(0)
  s_barrier
  s_cmp_eq_u32 s19, 62
  s_cbranch_scc1 cA_done
  s_waitcnt vmcnt(0) lgkmcnt(0)
  s_add_u32 s19, s19, 1
  s_mov_b32 s20, s21
  s_branch cA_va3_loop
cA_va3_retry:
  s_waitcnt lgkmcnt(0)
  buffer_load_dwordx4 v[24:27], v2, s[8:11], s23 offen offset:0 sc1
  buffer_load_dwordx4 v[28:31], v2, s[8:11], s23 offen offset:1024 sc1
  buffer_load_dwordx4 v[32:35], v2, s[8:11], s23 offen offset:2048 sc1
  s_add_u32 s31, s31, 1
  s_add_u32 s30, s30, 1
  s_cmp_lt_u32 s30, 400000
  s_cbranch_scc1 cA_va3_ld
  s_branch cA_abort
cA_va3_last:
  s_waitcnt lgkmcnt(0)
  buffer_store_dwordx4 v[100:103], v2, s[8:11], s24 offen offset:0 sc1
  buffer_store_dwordx4 v[104:107], v2, s[8:11], s24 offen offset:1024 sc1
  buffer_store_dwordx4 v[108:111], v2, s[8:11], s24 offen offset:2048 sc1
  buffer_store_dwordx4 v[4:7], v2, s[8:11], s24 offen offset:3072 sc1
  s_add_u32 s24, s24, 8192
  s_waitcnt vmcnt(0)
  s_mov_b64 exec, 1
  buffer_store_dword v117, v2, s[8:11], s34 offen sc1
  s_mov_b64 exec, -1
  s_add_u32 s34, s34, 8
  s_mov_b64 exec, 1
  buffer_store_dword v117, v2, s[8:11], s34 offen sc1
  s_mov_b64 exec, -1
  s_add_u32 s34, s34, 8
  s_branch cA_done
cA_abort:
  v_mov_b32 v4, 0xdead
  v_mov_b32 v5, 16
  buffer_store_dword v4, v5, s[12:15], 0 offen
  s_branch ch_end
cA_done:
  s_branch ch_end
cB_sc0_loop:
  s_add_u32 s23, s20, 4096
  s_add_u32 s21, s20, 25600
  v_mov_b32 v48, 0
  v_mov_b32 v49, 0
  v_mov_b32 v50, 0
  v_mov_b32 v51, 0
  v_mov_b32 v52, 0
  v_mov_b32 v53, 0
  v_mov_b32 v54, 0
  v_mov_b32 v55, 0
  v_mov_b32 v56, 0
  v_mov_b32 v57, 0
  v_mov_b32 v58, 0
  v_mov_b32 v59, 0
  v_mov_b32 v60, 0
  v_mov_b32 v61, 0
  v_mov_b32 v62, 0
  v_mov_b32 v63, 0
  v_mov_b32 v88, 0
  v_mov_b32 v89, 0
  v_mov_b32 v90, 0
  v_mov_b32 v91, 0
  v_mov_b32 v92, 0
  v_mov_b32 v93, 0
  v_mov_b32 v94, 0
  v_mov_b32 v95, 0
  v_mov_b32 v66, 0
  v_mov_b32 v67, 0
  s_mov_b32 s30, 0
  s_mov_b32 s62, 0
  buffer_load_dword v68, v0, s[8:11], s20 offen sc1
  s_nop 7
  buffer_load_dword v69, v0, s[8:11], s20 offen sc1
  s_nop 7
  buffer_load_dword v70, v0, s[8:11], s20 offen sc1
  s_nop 7
  buffer_load_dword v71, v0, s[8:11], s20 offen sc1
  s_nop 7
  buffer_load_dword v72, v0, s[8:11], s20 offen sc1
cB_sc0_fp_l:
  s_waitcnt vmcnt(4)
  v_cmp_eq_u32 vcc, -1, v68
  s_cbranch_vccz cB_sc0_fp_d
  buffer_load_dword v68, v0, s[8:11], s20 offen sc1
  s_waitcnt vmcnt(4)
  v_cmp_eq_u32 vcc, -1, v69
  s_cbranch_vccz cB_sc0_fp_d
  buffer_load_dword v69, v0, s[8:11], s20 offen sc1
  s_waitcnt vmcnt(4)
  v_cmp_eq_u32 vcc, -1, v70
  s_cbranch_vccz cB_sc0_fp_d
  buffer_load_dword v70, v0, s[8:11], s20 offen sc1
  s_waitcnt vmcnt(4)
  v_cmp_eq_u32 vcc, -1, v71
  s_cbranch_vccz cB_sc0_fp_d
  buffer_load_dword v71, v0, s[8:11], s20 offen sc1
  s_waitcnt vmcnt(4)
  v_cmp_eq_u32 vcc, -1, v72
  s_cbranch_vccz cB_sc0_fp_d
  buffer_load_dword v72, v0, s[8:11], s20 offen sc1
  s_add_u32 s30, s30, 1
  s_cmp_lt_u32 s30, 400000
  s_cbranch_scc1 cB_sc0_fp_l
  s_branch cB_abort
cB_sc0_fp_d:
  buffer_load_dwordx4 v[8:11], v2, s[8:11], s20 offen offset:0 sc1
  s_barrier
  s_branch cB_sc0_ld1
cB_sc0_ld:
  buffer_load_dwordx4 v[8:11], v2, s[8:11], s20 offen offset:0 sc1
cB_sc0_ld1:
  v_mov_b32 v36, 0
  v_mov_b32 v37, 0
  v_mov_b32 v38, 0
  v_mov_b32 v39, 0
  buffer_load_dwordx4 v[12:15], v2, s[8:11], s20 offen offset:1024 sc1
  v_mov_b32 v40, 0
  v_mov_b32 v41, 0
  v_mov_b32 v42, 0
  v_mov_b32 v43, 0
  buffer_load_dwordx4 v[16:19], v2, s[8:11], s20 offen offset:2048 sc1
  v_mov_b32 v44, 0
  v_mov_b32 v45, 0
  v_mov_b32 v46, 0
  v_mov_b32 v47, 0
  ds_read_b128 v[96:99], v117 offset:0
  ds_read_b128 v[100:103], v117 offset:1024
  ds_read_b128 v[104:107], v117 offset:14336
  ds_read_b128 v[108:111], v117 offset:15360
  s_waitcnt vmcnt(2)
  v_smfmac_f32_16x16x64_bf16 v[36:39], v[8:11], a[0:7], v3
  v_smfmac_f32_16x16x64_bf16 v[40:43], v[8:11], a[56:63], v3
  buffer_load_dwordx4 v[20:23], v2, s[8:11], s20 offen offset:3072 sc1
  v_smfmac_f32_16x16x64_bf16 v[44:47], v[8:11], a[112:119], v3
  v_smfmac_f32_16x16x64_bf16 v[48:51], v[8:11], a[168:175], v3
  v_smfmac_f32_16x16x64_bf16 v[52:55], v[8:11], a[224:231], v3
  buffer_load_dwordx4 v[24:27], v2, s[8:11], s23 offen offset:0 sc1
  v_smfmac_f32_16x16x64_bf16 v[56:59], v[8:11], v[144:151], v3
  v_smfmac_f32_16x16x64_bf16 v[60:63], v[8:11], v[200:207], v3
  s_waitcnt vmcnt(3)
  v_smfmac_f32_16x16x64_bf16 v[36:39], v[12:15], a[8:15], v3
  v_smfmac_f32_16x16x64_bf16 v[40:43], v[12:15], a[64:71], v3
  buffer_load_dwordx4 v[28:31], v2, s[8:11], s23 offen offset:1024 sc1
  v_smfmac_f32_16x16x64_bf16 v[44:47], v[12:15], a[120:127], v3
  v_smfmac_f32_16x16x64_bf16 v[48:51], v[12:15], a[176:183], v3
  v_smfmac_f32_16x16x64_bf16 v[52:55], v[12:15], a[232:239], v3
  buffer_load_dwordx4 v[32:35], v2, s[8:11], s23 offen offset:2048 sc1
  v_smfmac_f32_16x16x64_bf16 v[56:59], v[12:15], v[152:159], v3
  v_smfmac_f32_16x16x64_bf16 v[60:63], v[12:15], v[208:215], v3
  s_waitcnt vmcnt(4)
  v_smfmac_f32_16x16x64_bf16 v[36:39], v[16:19], a[16:23], v3
  v_smfmac_f32_16x16x64_bf16 v[40:43], v[16:19], a[72:79], v3
  v_smfmac_f32_16x16x64_bf16 v[44:47], v[16:19], a[128:135], v3
  v_smfmac_f32_16x16x64_bf16 v[48:51], v[16:19], a[184:191], v3
  v_smfmac_f32_16x16x64_bf16 v[52:55], v[16:19], a[240:247], v3
  v_smfmac_f32_16x16x64_bf16 v[56:59], v[16:19], v[160:167], v3
  v_smfmac_f32_16x16x64_bf16 v[60:63], v[16:19], v[216:223], v3
  s_waitcnt vmcnt(3)
  v_smfmac_f32_16x16x64_bf16 v[36:39], v[20:23], a[24:31], v3
  v_smfmac_f32_16x16x64_bf16 v[40:43], v[20:23], a[80:87], v3
  v_smfmac_f32_16x16x64_bf16 v[44:47], v[20:23], a[136:143], v3
  v_smfmac_f32_16x16x64_bf16 v[48:51], v[20:23], a[192:199], v3
  v_smfmac_f32_16x16x64_bf16 v[52:55], v[20:23], a[248:255], v3
  v_smfmac_f32_16x16x64_bf16 v[56:59], v[20:23], v[168:175], v3
  v_smfmac_f32_16x16x64_bf16 v[60:63], v[20:23], v[224:231], v3
  s_waitcnt vmcnt(0)
cB_sc0_ph2:
  v_smfmac_f32_16x16x64_bf16 v[60:63], v[24:27], v[232:239], v3
  ds_read_b128 v[12:15], v116 offset:0
  ds_read_b128 v[16:19], v116 offset:1024
  v_smfmac_f32_16x16x64_bf16 v[60:63], v[28:31], v[240:247], v3
  v_smfmac_f32_16x16x64_bf16 v[60:63], v[32:35], v[248:255], v3
  v_mov_b32 v80, v24
  v_smfmac_f32_16x16x64_bf16 v[52:55], v[24:27], v[120:127], v3
  v_mov_b32 v81, v25
  v_smfmac_f32_16x16x64_bf16 v[52:55], v[28:31], v[128:135], v3
  v_mov_b32 v82, v32
  v_smfmac_f32_16x16x64_bf16 v[52:55], v[32:35], v[136:143], v3
  v_cvt_pk_bf16_f32 v64, v60, v61
  v_smfmac_f32_16x16x64_bf16 v[56:59], v[24:27], v[176:183], v3
  v_cvt_pk_bf16_f32 v65, v62, v63
  v_smfmac_f32_16x16x64_bf16 v[56:59], v[28:31], v[184:191], v3
  v_mov_b32 v83, v33
  v_mfma_f32_16x16x32_bf16 v[68:71], v[64:67], v[4:7], 0
  v_smfmac_f32_16x16x64_bf16 v[56:59], v[32:35], v[192:199], v3
  v_cvt_pk_bf16_f32 v64, v52, v53
  v_smfmac_f32_16x16x64_bf16 v[36:39], v[24:27], a[32:39], v3
  v_cvt_pk_bf16_f32 v65, v54, v55
  v_smfmac_f32_16x16x64_bf16 v[36:39], v[28:31], a[40:47], v3
  v_cvt_pk_bf16_f32 v78, v68, v69
  v_smfmac_f32_16x16x64_bf16 v[36:39], v[32:35], a[48:55], v3
  v_cvt_pk_bf16_f32 v79, v70, v71
  v_cvt_pk_bf16_f32 v66, v56, v57
  v_smfmac_f32_16x16x64_bf16 v[40:43], v[24:27], a[88:95], v3
  v_cvt_pk_bf16_f32 v67, v58, v59
  v_smfmac_f32_16x16x64_bf16 v[40:43], v[28:31], a[96:103], v3
  v_mfma_f32_16x16x32_bf16 v[72:75], v[64:67], v[4:7], 0
  ds_read_b128 v[52:55], v116 offset:14336
  ds_read_b128 v[56:59], v116 offset:15360
  v_smfmac_f32_16x16x64_bf16 v[40:43], v[32:35], a[104:111], v3
  v_cvt_pk_bf16_f32 v64, v36, v37
  v_smfmac_f32_16x16x64_bf16 v[44:47], v[24:27], a[144:151], v3
  v_cvt_pk_bf16_f32 v65, v38, v39
  v_smfmac_f32_16x16x64_bf16 v[44:47], v[28:31], a[152:159], v3
  v_cvt_pk_bf16_f32 v76, v72, v73
  v_smfmac_f32_16x16x64_bf16 v[44:47], v[32:35], a[160:167], v3
  v_cvt_pk_bf16_f32 v77, v74, v75
  v_cvt_pk_bf16_f32 v66, v40, v41
  v_smfmac_f32_16x16x64_bf16 v[48:51], v[24:27], a[200:207], v3
  v_cvt_pk_bf16_f32 v67, v42, v43
  v_smfmac_f32_16x16x64_bf16 v[48:51], v[28:31], a[208:215], v3
  v_mfma_f32_16x16x32_bf16 v[68:71], v[64:67], v[4:7], 0
  v_smfmac_f32_16x16x64_bf16 v[48:51], v[32:35], a[216:223], v3
  v_cvt_pk_bf16_f32 v64, v44, v45
  v_mfma_f32_16x16x32_bf16 v[84:87], v[80:83], v[76:79], 0
  v_cvt_pk_bf16_f32 v65, v46, v47
  s_waitcnt lgkmcnt(0)
  v_smfmac_f32_16x16x64_bf16 v[88:91], v[76:79], v[96:103], v3
  v_cvt_pk_bf16_f32 v60, v68, v69
  v_cvt_pk_bf16_f32 v61, v70, v71
  v_cvt_pk_bf16_f32 v66, v48, v49
  v_cvt_pk_bf16_f32 v67, v50, v51
  s_nop 1
  v_mfma_f32_16x16x32_bf16 v[72:75], v[64:67], v[4:7], 0
  v_smfmac_f32_16x16x64_bf16 v[92:95], v[76:79], v[104:111], v3
  s_nop 4
  v_cvt_pk_bf16_f32 v62, v72, v73
  v_cvt_pk_bf16_f32 v63, v74, v75
  s_nop 1
  v_mfma_f32_16x16x32_bf16 v[84:87], v[8:11], v[60:63], v[84:87]
  v_smfmac_f32_16x16x64_bf16 v[88:91], v[60:63], v[12:19], v3
  v_smfmac_f32_16x16x64_bf16 v[92:95], v[60:63], v[52:59], v3
  s_mov_b64 exec, s[26:27]
  s_nop 0
  ds_write_b128 v113, v[84:87]
  s_mov_b64 exec, -1
  s_nop 0
  v_cmp_u_f32 vcc, v88, v89
  s_nop 1
  v_permlane32_swap_b32 v88, v92
  v_permlane32_swap_b32 v89, v93
  v_permlane32_swap_b32 v90, v94
  v_permlane32_swap_b32 v91, v95
  v_add_f32 v88, v88, v92
  v_add_f32 v89, v89, v93
  v_add_f32 v90, v90, v94
  v_add_f32 v91, v91, v95
  ds_write_b128 v112, v[88:91]
  s_cbranch_vccnz cB_sc0_retry
cB_sc0_cont:
  s_waitcnt lgkmcnt(0)
  s_barrier
  ds_read_b64 v[36:37], v114 offset:0
  ds_read_b64 v[38:39], v114 offset:1024
  ds_read2_b32 v[44:45], v115 offset0:0 offset1:64
  s_waitcnt lgkmcnt(0)
  v_add_f32 v44, v44, v45
  v_add_f32 v36, v36, v38
  v_add_f32 v37, v37, v39
  v_add_f32_dpp v44, v44, v44 row_ror:8 row_mask:0xf bank_mask:0xf
  v_mov_b32 v45, v44
  v_permlane32_swap_b32 v36, v37
  v_add_f32 v36, v36, v37
  v_permlane16_swap_b32 v44, v45
  v_add_f32 v44, v44, v45
  v_exp_f32 v48, v36
  v_exp_f32 v49, v44
  v_add_f32 v50, abs(v36), abs(v44)
  v_fma_f32 v39, v49, s37, v48
  v_cmp_ngt_f32 vcc, s56, v50
  v_cndmask_b32 v41, v48, v49, s[38:39]
  v_add_f32_dpp v39, v39, v39 quad_perm:[1,0,3,2] row_mask:0xf bank_mask:0xf
  v_cndmask_b32 v40, v49, v48, s[38:39]
  v_mov_b32_dpp v46, v41 quad_perm:[1,0,3,2] row_mask:0xf bank_mask:0xf
  v_add_f32_dpp v39, v39, v39 quad_perm:[2,3,0,1] row_mask:0xf bank_mask:0xf
  v_cndmask_b32 v42, v46, v40, s[38:39]
  v_cndmask_b32 v43, v40, v46, s[38:39]
  v_add_f32_dpp v39, v39, v39 row_half_mirror row_mask:0xf bank_mask:0xf
  s_cbranch_vccnz cB_sc0_slow
  s_nop 0
  v_add_f32_dpp v39, v39, v39 row_mirror row_mask:0xf bank_mask:0xf
  v_mov_b32 v47, v39
  s_nop 1
  v_permlane16_swap_b32 v39, v47
  v_add_f32 v39, v39, v47
  v_rcp_f32 v39, v39
  s_mov_b64 exec, s[28:29]
  v_mul_f32 v42, v42, v39
  v_mul_f32 v43, v43, v39
  v_cvt_pk_bf16_f32 v42, v42, v43
cB_sc0_pst:
  buffer_store_dword v42, v1, s[8:11], s20 offen sc1
  s_mov_b64 exec, -1
  s_barrier
  s_add_u32 s24, s24, 28672
  s_add_u32 s35, s35, 28672
  s_xor_b32 s25, s25, 28672
  s_add_u32 m0, s25, 0
  s_nop 0
  buffer_load_dwordx4 v2, s[8:11], s24 offen offset:0 sc1 lds
  buffer_load_dwordx4 v2, s[8:11], s24 offen offset:1024 sc1 lds
  buffer_load_dwordx4 v2, s[8:11], s24 offen offset:2048 sc1 lds
  buffer_load_dwordx4 v2, s[8:11], s24 offen offset:3072 sc1 lds
  s_add_u32 m0, s25, 4096
  s_add_u32 s22, s24, 4096
  buffer_load_dwordx4 v2, s[8:11], s22 offen offset:0 sc1 lds
  buffer_load_dwordx4 v2, s[8:11], s22 offen offset:1024 sc1 lds
  buffer_load_dwordx4 v2, s[8:11], s22 offen offset:2048 sc1 lds
  v_xor_b32 v116, 28672, v116
  v_add_u32 v117, s57, v117
  s_sub_u32 s57, 0, s57
  s_add_u32 s19, s19, 1
  s_mov_b32 s20, s21
  s_cmp_lt_u32 s19, 63
  s_cbranch_scc1 cB_sc0_loop
  s_branch cB_done
cB_sc0_slow:
  v_max_f32 v50, v36, v44
  s_nop 1
  v_max_f32_dpp v50, v50, v50 quad_perm:[1,0,3,2] row_mask:0xf bank_mask:0xf
  s_nop 1
  v_max_f32_dpp v50, v50, v50 quad_perm:[2,3,0,1] row_mask:0xf bank_mask:0xf
  s_nop 1
  v_max_f32_dpp v50, v50, v50 row_half_mirror row_mask:0xf bank_mask:0xf
  s_nop 1
  v_max_f32_dpp v50, v50, v50 row_mirror row_mask:0xf bank_mask:0xf
  v_mov_b32 v47, v50
  s_nop 1
  v_permlane16_swap_b32 v50, v47
  v_max_f32 v50, v50, v47
  v_sub_f32 v48, v36, v50
  v_sub_f32 v49, v44, v50
  v_exp_f32 v48, v48
  v_exp_f32 v49, v49
  s_add_u32 s31, s31, 0x100
  v_fma_f32 v39, v49, s37, v48
  v_cndmask_b32 v41, v48, v49, s[38:39]
  s_nop 0
  v_add_f32_dpp v39, v39, v39 quad_perm:[1,0,3,2] row_mask:0xf bank_mask:0xf
  v_cndmask_b32 v40, v49, v48, s[38:39]
  v_mov_b32_dpp v46, v41 quad_perm:[1,0,3,2] row_mask:0xf bank_mask:0xf
  v_add_f32_dpp v39, v39, v39 quad_perm:[2,3,0,1] row_mask:0xf bank_mask:0xf
  v_cndmask_b32 v42, v46, v40, s[38:39]
  v_cndmask_b32 v43, v40, v46, s[38:39]
  v_add_f32_dpp v39, v39, v39 row_half_mirror row_mask:0xf bank_mask:0xf
  s_nop 1
  v_add_f32_dpp v39, v39, v39 row_mirror row_mask:0xf bank_mask:0xf
  v_mov_b32 v47, v39
  s_nop 1
  v_permlane16_swap_b32 v39, v47
  v_add_f32 v39, v39, v47
  v_rcp_f32 v39, v39
  s_mov_b64 exec, s[28:29]
  v_mul_f32 v42, v42, v39
  v_mul_f32 v43, v43, v39
  v_cvt_pk_bf16_f32 v42, v42, v43
  v_min_u32 v42, -2, v42
  s_branch cB_sc0_pst
cB_sc0_retry:
  s_cmp_lg_u32 s62, 0
  s_cbranch_scc1 cB_sc0_cont
  s_waitcnt vmcnt(0) lgkmcnt(0)
cB_sc0_rv:
  buffer_load_dwordx4 v[8:11], v2, s[8:11], s20 offen offset:0 sc1
  buffer_load_dwordx4 v[12:15], v2, s[8:11], s20 offen offset:1024 sc1
  buffer_load_dwordx4 v[16:19], v2, s[8:11], s20 offen offset:2048 sc1
  buffer_load_dwordx4 v[20:23], v2, s[8:11], s20 offen offset:3072 sc1
  buffer_load_dwordx4 v[24:27], v2, s[8:11], s23 offen offset:0 sc1
  buffer_load_dwordx4 v[28:31], v2, s[8:11], s23 offen offset:1024 sc1
  buffer_load_dwordx4 v[32:35], v2, s[8:11], s23 offen offset:2048 sc1
  s_waitcnt vmcnt(0)
  v_max3_u32 v118, v8, v9, v10
  v_max3_u32 v118, v118, v11, v12
  v_max3_u32 v118, v118, v13, v14
  v_max3_u32 v118, v118, v15, v16
  v_max3_u32 v118, v118, v17, v18
  v_max3_u32 v118, v118, v19, v20
  v_max3_u32 v118, v118, v21, v22
  v_max3_u32 v118, v118, v23, v24
  v_max3_u32 v118, v118, v25, v26
  v_max3_u32 v118, v118, v27, v28
  v_max3_u32 v118, v118, v29, v30
  v_max3_u32 v118, v118, v31, v32
  v_max3_u32 v118, v118, v33, v34
  v_max_u32 v118, v118, v35
  v_cmp_eq_u32 vcc, -1, v118
  s_cbranch_vccz cB_sc0_rk
  s_add_u32 s30, s30, 1
  s_cmp_lt_u32 s30, 400000
  s_cbranch_scc1 cB_sc0_rv
  s_branch cB_abort
cB_sc0_rk:
  s_mov_b32 s62, 1
  v_mov_b32 v36, 0
  v_mov_b32 v37, 0
  v_mov_b32 v38, 0
  v_mov_b32 v39, 0
  v_mov_b32 v40, 0
  v_mov_b32 v41, 0
  v_mov_b32 v42, 0
  v_mov_b32 v43, 0
  v_mov_b32 v44, 0
  v_mov_b32 v45, 0
  v_mov_b32 v46, 0
  v_mov_b32 v47, 0
  v_mov_b32 v48, 0
  v_mov_b32 v49, 0
  v_mov_b32 v50, 0
  v_mov_b32 v51, 0
  v_mov_b32 v52, 0
  v_mov_b32 v53, 0
  v_mov_b32 v54, 0
  v_mov_b32 v55, 0
  v_mov_b32 v56, 0
  v_mov_b32 v57, 0
  v_mov_b32 v58, 0
  v_mov_b32 v59, 0
  v_mov_b32 v60, 0
  v_mov_b32 v61, 0
  v_mov_b32 v62, 0
  v_mov_b32 v63, 0
  v_mov_b32 v88, 0
  v_mov_b32 v89, 0
  v_mov_b32 v90, 0
  v_mov_b32 v91, 0
  v_mov_b32 v92, 0
  v_mov_b32 v93, 0
  v_mov_b32 v94, 0
  v_mov_b32 v95, 0
  v_mov_b32 v66, 0
  v_mov_b32 v67, 0
  s_add_u32 s31, s31, 1
  ds_read_b128 v[96:99], v117 offset:0
  ds_read_b128 v[100:103], v117 offset:1024
  ds_read_b128 v[104:107], v117 offset:14336
  ds_read_b128 v[108:111], v117 offset:15360
  v_smfmac_f32_16x16x64_bf16 v[36:39], v[8:11], a[0:7], v3
  v_smfmac_f32_16x16x64_bf16 v[40:43], v[8:11], a[56:63], v3
  v_smfmac_f32_16x16x64_bf16 v[44:47], v[8:11], a[112:119], v3
  v_smfmac_f32_16x16x64_bf16 v[48:51], v[8:11], a[168:175], v3
  v_smfmac_f32_16x16x64_bf16 v[52:55], v[8:11], a[224:231], v3
  v_smfmac_f32_16x16x64_bf16 v[56:59], v[8:11], v[144:151], v3
  v_smfmac_f32_16x16x64_bf16 v[60:63], v[8:11], v[200:207], v3
  v_smfmac_f32_16x16x64_bf16 v[36:39], v[12:15], a[8:15], v3
  v_smfmac_f32_16x16x64_bf16 v[40:43], v[12:15], a[64:71], v3
  v_smfmac_f32_16x16x64_bf16 v[44:47], v[12:15], a[120:127], v3
  v_smfmac_f32_16x16x64_bf16 v[48:51], v[12:15], a[176:183], v3
  v_smfmac_f32_16x16x64_bf16 v[52:55], v[12:15], a[232:239], v3
  v_smfmac_f32_16x16x64_bf16 v[56:59], v[12:15], v[152:159], v3
  v_smfmac_f32_16x16x64_bf16 v[60:63], v[12:15], v[208:215], v3
  v_smfmac_f32_16x16x64_bf16 v[36:39], v[16:19], a[16:23], v3
  v_smfmac_f32_16x16x64_bf16 v[40:43], v[16:19], a[72:79], v3
  v_smfmac_f32_16x16x64_bf16 v[44:47], v[16:19], a[128:135], v3
  v_smfmac_f32_16x16x64_bf16 v[48:51], v[16:19], a[184:191], v3
  v_smfmac_f32_16x16x64_bf16 v[52:55], v[16:19], a[240:247], v3
  v_smfmac_f32_16x16x64_bf16 v[56:59], v[16:19], v[160:167], v3
  v_smfmac_f32_16x16x64_bf16 v[60:63], v[16:19], v[216:223], v3
  v_smfmac_f32_16x16x64_bf16 v[36:39], v[20:23], a[24:31], v3
  v_smfmac_f32_16x16x64_bf16 v[40:43], v[20:23], a[80:87], v3
  v_smfmac_f32_16x16x64_bf16 v[44:47], v[20:23], a[136:143], v3
  v_smfmac_f32_16x16x64_bf16 v[48:51], v[20:23], a[192:199], v3
  v_smfmac_f32_16x16x64_bf16 v[52:55], v[20:23], a[248:255], v3
  v_smfmac_f32_16x16x64_bf16 v[56:59], v[20:23], v[168:175], v3
  v_smfmac_f32_16x16x64_bf16 v[60:63], v[20:23], v[224:231], v3
  s_branch cB_sc0_ph2
cB_sc1_loop:
  s_add_u32 s23, s20, 4096
  s_add_u32 s21, s20, 25600
  v_mov_b32 v48, 0
  v_mov_b32 v49, 0
  v_mov_b32 v50, 0
  v_mov_b32 v51, 0
  v_mov_b32 v52, 0
  v_mov_b32 v53, 0
  v_mov_b32 v54, 0
  v_mov_b32 v55, 0
  v_mov_b32 v56, 0
  v_mov_b32 v57, 0
  v_mov_b32 v58, 0
  v_mov_b32 v59, 0
  v_mov_b32 v60, 0
  v_mov_b32 v61, 0
  v_mov_b32 v62, 0
  v_mov_b32 v63, 0
  v_mov_b32 v88, 0
  v_mov_b32 v89, 0
  v_mov_b32 v90, 0
  v_mov_b32 v91, 0
  v_mov_b32 v92, 0
  v_mov_b32 v93, 0
  v_mov_b32 v94, 0
  v_mov_b32 v95, 0
  v_mov_b32 v64, 0
  v_mov_b32 v65, 0
  s_mov_b32 s30, 0
  s_mov_b32 s62, 0
  s_waitcnt vmcnt(0)
  s_barrier
cB_sc1_ld:
  buffer_load_dwordx4 v[8:11], v2, s[8:11], s20 offen offset:0 sc1
  v_mov_b32 v36, 0
  v_mov_b32 v37, 0
  v_mov_b32 v38, 0
  v_mov_b32 v39, 0
  buffer_load_dwordx4 v[12:15], v2, s[8:11], s20 offen offset:1024 sc1
  v_mov_b32 v40, 0
  v_mov_b32 v41, 0
  v_mov_b32 v42, 0
  v_mov_b32 v43, 0
  buffer_load_dwordx4 v[16:19], v2, s[8:11], s20 offen offset:2048 sc1
  v_mov_b32 v44, 0
  v_mov_b32 v45, 0
  v_mov_b32 v46, 0
  v_mov_b32 v47, 0
  ds_read_b128 v[96:99], v117 offset:0
  ds_read_b128 v[100:103], v117 offset:1024
  ds_read_b128 v[104:107], v117 offset:14336
  ds_read_b128 v[108:111], v117 offset:15360
  s_waitcnt vmcnt(2)
  v_smfmac_f32_16x16x64_bf16 v[36:39], v[8:11], a[0:7], v3
  v_smfmac_f32_16x16x64_bf16 v[40:43], v[8:11], a[56:63], v3
  buffer_load_dwordx4 v[20:23], v2, s[8:11], s20 offen offset:3072 sc1
  v_smfmac_f32_16x16x64_bf16 v[44:47], v[8:11], a[112:119], v3
  v_smfmac_f32_16x16x64_bf16 v[48:51], v[8:11], a[168:175], v3
  v_smfmac_f32_16x16x64_bf16 v[52:55], v[8:11], a[224:231], v3
  buffer_load_dwordx4 v[24:27], v2, s[8:11], s23 offen offset:0 sc1
  v_smfmac_f32_16x16x64_bf16 v[56:59], v[8:11], v[144:151], v3
  v_smfmac_f32_16x16x64_bf16 v[60:63], v[8:11], v[200:207], v3
  s_waitcnt vmcnt(3)
  v_smfmac_f32_16x16x64_bf16 v[36:39], v[12:15], a[8:15], v3
  v_smfmac_f32_16x16x64_bf16 v[40:43], v[12:15], a[64:71], v3
  buffer_load_dwordx4 v[28:31], v2, s[8:11], s23 offen offset:1024 sc1
  v_smfmac_f32_16x16x64_bf16 v[44:47], v[12:15], a[120:127], v3
  v_smfmac_f32_16x16x64_bf16 v[48:51], v[12:15], a[176:183], v3
  v_smfmac_f32_16x16x64_bf16 v[52:55], v[12:15], a[232:239], v3
  buffer_load_dwordx4 v[32:35], v2, s[8:11], s23 offen offset:2048 sc1
  v_smfmac_f32_16x16x64_bf16 v[56:59], v[12:15], v[152:159], v3
  v_smfmac_f32_16x16x64_bf16 v[60:63], v[12:15], v[208:215], v3
  s_waitcnt vmcnt(4)
  v_smfmac_f32_16x16x64_bf16 v[36:39], v[16:19], a[16:23], v3
  v_smfmac_f32_16x16x64_bf16 v[40:43], v[16:19], a[72:79], v3
  v_smfmac_f32_16x16x64_bf16 v[44:47], v[16:19], a[128:135], v3
  v_smfmac_f32_16x16x64_bf16 v[48:51], v[16:19], a[184:191], v3
  v_smfmac_f32_16x16x64_bf16 v[52:55], v[16:19], a[240:247], v3
  v_smfmac_f32_16x16x64_bf16 v[56:59], v[16:19], v[160:167], v3
  v_smfmac_f32_16x16x64_bf16 v[60:63], v[16:19], v[216:223], v3
  s_waitcnt vmcnt(3)
  v_smfmac_f32_16x16x64_bf16 v[36:39], v[20:23], a[24:31], v3
  v_smfmac_f32_16x16x64_bf16 v[40:43], v[20:23], a[80:87], v3
  v_smfmac_f32_16x16x64_bf16 v[44:47], v[20:23], a[136:143], v3
  v_smfmac_f32_16x16x64_bf16 v[48:51], v[20:23], a[192:199], v3
  v_smfmac_f32_16x16x64_bf16 v[52:55], v[20:23], a[248:255], v3
  v_smfmac_f32_16x16x64_bf16 v[56:59], v[20:23], v[168:175], v3
  v_smfmac_f32_16x16x64_bf16 v[60:63], v[20:23], v[224:231], v3
  s_waitcnt vmcnt(0)
cB_sc1_ph2:
  v_smfmac_f32_16x16x64_bf16 v[60:63], v[24:27], v[232:239], v3
  ds_read_b128 v[16:19], v116 offset:2048
  ds_read_b128 v[20:23], v116 offset:3072
  v_smfmac_f32_16x16x64_bf16 v[60:63], v[28:31], v[240:247], v3
  buffer_load_dword v119, v0, s[8:11], s20 offen sc1
  v_smfmac_f32_16x16x64_bf16 v[60:63], v[32:35], v[248:255], v3
  v_mov_b32 v80, v26
  v_smfmac_f32_16x16x64_bf16 v[52:55], v[24:27], v[120:127], v3
  v_mov_b32 v81, v27
  v_smfmac_f32_16x16x64_bf16 v[52:55], v[28:31], v[128:135], v3
  v_mov_b32 v82, v32
  v_smfmac_f32_16x16x64_bf16 v[52:55], v[32:35], v[136:143], v3
  v_cvt_pk_bf16_f32 v66, v60, v61
  v_smfmac_f32_16x16x64_bf16 v[56:59], v[24:27], v[176:183], v3
  v_cvt_pk_bf16_f32 v67, v62, v63
  v_smfmac_f32_16x16x64_bf16 v[56:59], v[28:31], v[184:191], v3
  v_mov_b32 v83, v33
  v_mfma_f32_16x16x32_bf16 v[68:71], v[64:67], v[4:7], 0
  v_smfmac_f32_16x16x64_bf16 v[56:59], v[32:35], v[192:199], v3
  v_cvt_pk_bf16_f32 v64, v52, v53
  v_smfmac_f32_16x16x64_bf16 v[36:39], v[24:27], a[32:39], v3
  v_cvt_pk_bf16_f32 v65, v54, v55
  v_smfmac_f32_16x16x64_bf16 v[36:39], v[28:31], a[40:47], v3
  v_cvt_pk_bf16_f32 v78, v68, v69
  v_smfmac_f32_16x16x64_bf16 v[36:39], v[32:35], a[48:55], v3
  v_cvt_pk_bf16_f32 v79, v70, v71
  v_cvt_pk_bf16_f32 v66, v56, v57
  v_smfmac_f32_16x16x64_bf16 v[40:43], v[24:27], a[88:95], v3
  v_cvt_pk_bf16_f32 v67, v58, v59
  v_smfmac_f32_16x16x64_bf16 v[40:43], v[28:31], a[96:103], v3
  v_mfma_f32_16x16x32_bf16 v[72:75], v[64:67], v[4:7], 0
  ds_read_b128 v[52:55], v116 offset:16384
  ds_read_b128 v[56:59], v116 offset:17408
  v_smfmac_f32_16x16x64_bf16 v[40:43], v[32:35], a[104:111], v3
  v_cvt_pk_bf16_f32 v64, v36, v37
  v_smfmac_f32_16x16x64_bf16 v[44:47], v[24:27], a[144:151], v3
  v_cvt_pk_bf16_f32 v65, v38, v39
  v_smfmac_f32_16x16x64_bf16 v[44:47], v[28:31], a[152:159], v3
  v_cvt_pk_bf16_f32 v76, v72, v73
  v_smfmac_f32_16x16x64_bf16 v[44:47], v[32:35], a[160:167], v3
  v_cvt_pk_bf16_f32 v77, v74, v75
  v_cvt_pk_bf16_f32 v66, v40, v41
  v_smfmac_f32_16x16x64_bf16 v[48:51], v[24:27], a[200:207], v3
  v_cvt_pk_bf16_f32 v67, v42, v43
  v_smfmac_f32_16x16x64_bf16 v[48:51], v[28:31], a[208:215], v3
  v_mfma_f32_16x16x32_bf16 v[68:71], v[64:67], v[4:7], 0
  v_smfmac_f32_16x16x64_bf16 v[48:51], v[32:35], a[216:223], v3
  v_cvt_pk_bf16_f32 v64, v44, v45
  v_mfma_f32_16x16x32_bf16 v[84:87], v[80:83], v[76:79], 0
  v_cvt_pk_bf16_f32 v65, v46, v47
  s_waitcnt lgkmcnt(0)
  v_smfmac_f32_16x16x64_bf16 v[88:91], v[76:79], v[96:103], v3
  v_cvt_pk_bf16_f32 v60, v68, v69
  v_cvt_pk_bf16_f32 v61, v70, v71
  v_cvt_pk_bf16_f32 v66, v48, v49
  v_cvt_pk_bf16_f32 v67, v50, v51
  s_nop 1
  v_mfma_f32_16x16x32_bf16 v[72:75], v[64:67], v[4:7], 0
  v_smfmac_f32_16x16x64_bf16 v[92:95], v[76:79], v[104:111], v3
  s_nop 4
  v_cvt_pk_bf16_f32 v62, v72, v73
  v_cvt_pk_bf16_f32 v63, v74, v75
  s_nop 1
  v_mfma_f32_16x16x32_bf16 v[84:87], v[12:15], v[60:63], v[84:87]
  v_smfmac_f32_16x16x64_bf16 v[88:91], v[60:63], v[16:23], v3
  v_smfmac_f32_16x16x64_bf16 v[92:95], v[60:63], v[52:59], v3
  s_mov_b64 exec, s[26:27]
  s_nop 0
  ds_write_b128 v113, v[84:87]
  s_mov_b64 exec, -1
  s_nop 0
  v_cmp_u_f32 vcc, v88, v89
  s_nop 1
  v_permlane32_swap_b32 v88, v92
  v_permlane32_swap_b32 v89, v93
  v_permlane32_swap_b32 v90, v94
  v_permlane32_swap_b32 v91, v95
  v_add_f32 v88, v88, v92
  v_add_f32 v89, v89, v93
  v_add_f32 v90, v90, v94
  v_add_f32 v91, v91, v95
  ds_write_b128 v112, v[88:91]
  s_cbranch_vccnz cB_sc1_retry
cB_sc1_cont:
  s_waitcnt lgkmcnt(0)
  s_barrier
  ds_read_b64 v[36:37], v114 offset:0
  ds_read_b64 v[38:39], v114 offset:1024
  ds_read2_b32 v[44:45], v115 offset0:0 offset1:64
  s_waitcnt lgkmcnt(0)
  v_add_f32 v44, v44, v45
  v_add_f32 v36, v36, v38
  v_add_f32 v37, v37, v39
  v_add_f32_dpp v44, v44, v44 row_ror:8 row_mask:0xf bank_mask:0xf
  v_mov_b32 v45, v44
  v_permlane32_swap_b32 v36, v37
  v_add_f32 v36, v36, v37
  v_permlane16_swap_b32 v44, v45
  v_add_f32 v44, v44, v45
  v_exp_f32 v48, v36
  v_exp_f32 v49, v44
  v_add_f32 v50, abs(v36), abs(v44)
  v_fma_f32 v39, v49, s37, v48
  v_cmp_ngt_f32 vcc, s56, v50
  v_cndmask_b32 v41, v48, v49, s[38:39]
  v_add_f32_dpp v39, v39, v39 quad_perm:[1,0,3,2] row_mask:0xf bank_mask:0xf
  v_cndmask_b32 v40, v49, v48, s[38:39]
  v_mov_b32_dpp v46, v41 quad_perm:[1,0,3,2] row_mask:0xf bank_mask:0xf
  v_add_f32_dpp v39, v39, v39 quad_perm:[2,3,0,1] row_mask:0xf bank_mask:0xf
  v_cndmask_b32 v42, v46, v40, s[38:39]
  v_cndmask_b32 v43, v40, v46, s[38:39]
  v_add_f32_dpp v39, v39, v39 row_half_mirror row_mask:0xf bank_mask:0xf
  s_cbranch_vccnz cB_sc1_slow
  s_nop 0
  v_add_f32_dpp v39, v39, v39 row_mirror row_mask:0xf bank_mask:0xf
  v_mov_b32 v47, v39
  s_nop 1
  v_permlane16_swap_b32 v39, v47
  v_add_f32 v39, v39, v47
  v_rcp_f32 v39, v39
  s_mov_b64 exec, s[28:29]
  v_mul_f32 v42, v42, v39
  v_mul_f32 v43, v43, v39
  v_cvt_pk_bf16_f32 v42, v42, v43
cB_sc1_pst:
  buffer_store_dword v42, v1, s[8:11], s20 offen sc1
  s_mov_b64 exec, -1
  s_barrier
  s_add_u32 s24, s24, 28672
  s_add_u32 s35, s35, 28672
  s_xor_b32 s25, s25, 28672
  s_add_u32 m0, s25, 7168
  s_nop 0
  buffer_load_dwordx4 v2, s[8:11], s24 offen offset:0 sc1 lds
  buffer_load_dwordx4 v2, s[8:11], s24 offen offset:1024 sc1 lds
  buffer_load_dwordx4 v2, s[8:11], s24 offen offset:2048 sc1 lds
  buffer_load_dwordx4 v2, s[8:11], s24 offen offset:3072 sc1 lds
  s_add_u32 m0, s25, 11264
  s_add_u32 s22, s24, 4096
  buffer_load_dwordx4 v2, s[8:11], s22 offen offset:0 sc1 lds
  buffer_load_dwordx4 v2, s[8:11], s22 offen offset:1024 sc1 lds
  buffer_load_dwordx4 v2, s[8:11], s22 offen offset:2048 sc1 lds
  v_xor_b32 v116, 28672, v116
  v_add_u32 v117, s57, v117
  s_sub_u32 s57, 0, s57
  s_add_u32 s19, s19, 1
  s_mov_b32 s20, s21
  s_cmp_lt_u32 s19, 63
  s_cbranch_scc1 cB_sc1_loop
  s_branch cB_done
cB_sc1_slow:
  v_max_f32 v50, v36, v44
  s_nop 1
  v_max_f32_dpp v50, v50, v50 quad_perm:[1,0,3,2] row_mask:0xf bank_mask:0xf
  s_nop 1
  v_max_f32_dpp v50, v50, v50 quad_perm:[2,3,0,1] row_mask:0xf bank_mask:0xf
  s_nop 1
  v_max_f32_dpp v50, v50, v50 row_half_mirror row_mask:0xf bank_mask:0xf
  s_nop 1
  v_max_f32_dpp v50, v50, v50 row_mirror row_mask:0xf bank_mask:0xf
  v_mov_b32 v47, v50
  s_nop 1
  v_permlane16_swap_b32 v50, v47
  v_max_f32 v50, v50, v47
  v_sub_f32 v48, v36, v50
  v_sub_f32 v49, v44, v50
  v_exp_f32 v48, v48
  v_exp_f32 v49, v49
  s_add_u32 s31, s31, 0x100
  v_fma_f32 v39, v49, s37, v48
  v_cndmask_b32 v41, v48, v49, s[38:39]
  s_nop 0
  v_add_f32_dpp v39, v39, v39 quad_perm:[1,0,3,2] row_mask:0xf bank_mask:0xf
  v_cndmask_b32 v40, v49, v48, s[38:39]
  v_mov_b32_dpp v46, v41 quad_perm:[1,0,3,2] row_mask:0xf bank_mask:0xf
  v_add_f32_dpp v39, v39, v39 quad_perm:[2,3,0,1] row_mask:0xf bank_mask:0xf
  v_cndmask_b32 v42, v46, v40, s[38:39]
  v_cndmask_b32 v43, v40, v46, s[38:39]
  v_add_f32_dpp v39, v39, v39 row_half_mirror row_mask:0xf bank_mask:0xf
  s_nop 1
  v_add_f32_dpp v39, v39, v39 row_mirror row_mask:0xf bank_mask:0xf
  v_mov_b32 v47, v39
  s_nop 1
  v_permlane16_swap_b32 v39, v47
  v_add_f32 v39, v39, v47
  v_rcp_f32 v39, v39
  s_mov_b64 exec, s[28:29]
  v_mul_f32 v42, v42, v39
  v_mul_f32 v43, v43, v39
  v_cvt_pk_bf16_f32 v42, v42, v43
  v_min_u32 v42, -2, v42
  s_branch cB_sc1_pst
cB_sc1_retry:
  s_cmp_lg_u32 s62, 0
  s_cbranch_scc1 cB_sc1_cont
  s_waitcnt vmcnt(0) lgkmcnt(0)
cB_sc1_rv:
  buffer_load_dwordx4 v[8:11], v2, s[8:11], s20 offen offset:0 sc1
  buffer_load_dwordx4 v[12:15], v2, s[8:11], s20 offen offset:1024 sc1
  buffer_load_dwordx4 v[16:19], v2, s[8:11], s20 offen offset:2048 sc1
  buffer_load_dwordx4 v[20:23], v2, s[8:11], s20 offen offset:3072 sc1
  buffer_load_dwordx4 v[24:27], v2, s[8:11], s23 offen offset:0 sc1
  buffer_load_dwordx4 v[28:31], v2, s[8:11], s23 offen offset:1024 sc1
  buffer_load_dwordx4 v[32:35], v2, s[8:11], s23 offen offset:2048 sc1
  s_waitcnt vmcnt(0)
  v_max3_u32 v118, v8, v9, v10
  v_max3_u32 v118, v118, v11, v12
  v_max3_u32 v118, v118, v13, v14
  v_max3_u32 v118, v118, v15, v16
  v_max3_u32 v118, v118, v17, v18
  v_max3_u32 v118, v118, v19, v20
  v_max3_u32 v118, v118, v21, v22
  v_max3_u32 v118, v118, v23, v24
  v_max3_u32 v118, v118, v25, v26
  v_max3_u32 v118, v118, v27, v28
  v_max3_u32 v118, v118, v29, v30
  v_max3_u32 v118, v118, v31, v32
  v_max3_u32 v118, v118, v33, v34
  v_max_u32 v118, v118, v35
  v_cmp_eq_u32 vcc, -1, v118
  s_cbranch_vccz cB_sc1_rk
  s_add_u32 s30, s30, 1
  s_cmp_lt_u32 s30, 400000
  s_cbranch_scc1 cB_sc1_rv
  s_branch cB_abort
cB_sc1_rk:
  s_mov_b32 s62, 1
  v_mov_b32 v36, 0
  v_mov_b32 v37, 0
  v_mov_b32 v38, 0
  v_mov_b32 v39, 0
  v_mov_b32 v40, 0
  v_mov_b32 v41, 0
  v_mov_b32 v42, 0
  v_mov_b32 v43, 0
  v_mov_b32 v44, 0
  v_mov_b32 v45, 0
  v_mov_b32 v46, 0
  v_mov_b32 v47, 0
  v_mov_b32 v48, 0
  v_mov_b32 v49, 0
  v_mov_b32 v50, 0
  v_mov_b32 v51, 0
  v_mov_b32 v52, 0
  v_mov_b32 v53, 0
  v_mov_b32 v54, 0
  v_mov_b32 v55, 0
  v_mov_b32 v56, 0
  v_mov_b32 v57, 0
  v_mov_b32 v58, 0
  v_mov_b32 v59, 0
  v_mov_b32 v60, 0
  v_mov_b32 v61, 0
  v_mov_b32 v62, 0
  v_mov_b32 v63, 0
  v_mov_b32 v88, 0
  v_mov_b32 v89, 0
  v_mov_b32 v90, 0
  v_mov_b32 v91, 0
  v_mov_b32 v92, 0
  v_mov_b32 v93, 0
  v_mov_b32 v94, 0
  v_mov_b32 v95, 0
  v_mov_b32 v64, 0
  v_mov_b32 v65, 0
  s_add_u32 s31, s31, 1
  ds_read_b128 v[96:99], v117 offset:0
  ds_read_b128 v[100:103], v117 offset:1024
  ds_read_b128 v[104:107], v117 offset:14336
  ds_read_b128 v[108:111], v117 offset:15360
  v_smfmac_f32_16x16x64_bf16 v[36:39], v[8:11], a[0:7], v3
  v_smfmac_f32_16x16x64_bf16 v[40:43], v[8:11], a[56:63], v3
  v_smfmac_f32_16x16x64_bf16 v[44:47], v[8:11], a[112:119], v3
  v_smfmac_f32_16x16x64_bf16 v[48:51], v[8:11], a[168:175], v3
  v_smfmac_f32_16x16x64_bf16 v[52:55], v[8:11], a[224:231], v3
  v_smfmac_f32_16x16x64_bf16 v[56:59], v[8:11], v[144:151], v3
  v_smfmac_f32_16x16x64_bf16 v[60:63], v[8:11], v[200:207], v3
  v_smfmac_f32_16x16x64_bf16 v[36:39], v[12:15], a[8:15], v3
  v_smfmac_f32_16x16x64_bf16 v[40:43], v[12:15], a[64:71], v3
  v_smfmac_f32_16x16x64_bf16 v[44:47], v[12:15], a[120:127], v3
  v_smfmac_f32_16x16x64_bf16 v[48:51], v[12:15], a[176:183], v3
  v_smfmac_f32_16x16x64_bf16 v[52:55], v[12:15], a[232:239], v3
  v_smfmac_f32_16x16x64_bf16 v[56:59], v[12:15], v[152:159], v3
  v_smfmac_f32_16x16x64_bf16 v[60:63], v[12:15], v[208:215], v3
  v_smfmac_f32_16x16x64_bf16 v[36:39], v[16:19], a[16:23], v3
  v_smfmac_f32_16x16x64_bf16 v[40:43], v[16:19], a[72:79], v3
  v_smfmac_f32_16x16x64_bf16 v[44:47], v[16:19], a[128:135], v3
  v_smfmac_f32_16x16x64_bf16 v[48:51], v[16:19], a[184:191], v3
  v_smfmac_f32_16x16x64_bf16 v[52:55], v[16:19], a[240:247], v3
  v_smfmac_f32_16x16x64_bf16 v[56:59], v[16:19], v[160:167], v3
  v_smfmac_f32_16x16x64_bf16 v[60:63], v[16:19], v[216:223], v3
  v_smfmac_f32_16x16x64_bf16 v[36:39], v[20:23], a[24:31], v3
  v_smfmac_f32_16x16x64_bf16 v[40:43], v[20:23], a[80:87], v3
  v_smfmac_f32_16x16x64_bf16 v[44:47], v[20:23], a[136:143], v3
  v_smfmac_f32_16x16x64_bf16 v[48:51], v[20:23], a[192:199], v3
  v_smfmac_f32_16x16x64_bf16 v[52:55], v[20:23], a[248:255], v3
  v_smfmac_f32_16x16x64_bf16 v[56:59], v[20:23], v[168:175], v3
  v_smfmac_f32_16x16x64_bf16 v[60:63], v[20:23], v[224:231], v3
  s_branch cB_sc1_ph2
cB_sc2_loop:
  s_add_u32 s23, s20, 4096
  s_add_u32 s21, s20, 25600
  v_mov_b32 v48, 0
  v_mov_b32 v49, 0
  v_mov_b32 v50, 0
  v_mov_b32 v51, 0
  v_mov_b32 v52, 0
  v_mov_b32 v53, 0
  v_mov_b32 v54, 0
  v_mov_b32 v55, 0
  v_mov_b32 v56, 0
  v_mov_b32 v57, 0
  v_mov_b32 v58, 0
  v_mov_b32 v59, 0
  v_mov_b32 v60, 0
  v_mov_b32 v61, 0
  v_mov_b32 v62, 0
  v_mov_b32 v63, 0
  v_mov_b32 v88, 0
  v_mov_b32 v89, 0
  v_mov_b32 v90, 0
  v_mov_b32 v91, 0
  v_mov_b32 v92, 0
  v_mov_b32 v93, 0
  v_mov_b32 v94, 0
  v_mov_b32 v95, 0
  v_mov_b32 v66, 0
  v_mov_b32 v67, 0
  s_mov_b32 s30, 0
  s_mov_b32 s62, 0
  s_waitcnt vmcnt(0)
  s_barrier
cB_sc2_ld:
  buffer_load_dwordx4 v[8:11], v2, s[8:11], s20 offen offset:0 sc1
  v_mov_b32 v36, 0
  v_mov_b32 v37, 0
  v_mov_b32 v38, 0
  v_mov_b32 v39, 0
  buffer_load_dwordx4 v[12:15], v2, s[8:11], s20 offen offset:1024 sc1
  v_mov_b32 v40, 0
  v_mov_b32 v41, 0
  v_mov_b32 v42, 0
  v_mov_b32 v43, 0
  buffer_load_dwordx4 v[16:19], v2, s[8:11], s20 offen offset:2048 sc1
  v_mov_b32 v44, 0
  v_mov_b32 v45, 0
  v_mov_b32 v46, 0
  v_mov_b32 v47, 0
  ds_read_b128 v[96:99], v117 offset:0
  ds_read_b128 v[100:103], v117 offset:1024
  ds_read_b128 v[104:107], v117 offset:14336
  ds_read_b128 v[108:111], v117 offset:15360
  s_waitcnt vmcnt(2)
  v_smfmac_f32_16x16x64_bf16 v[36:39], v[8:11], a[0:7], v3
  v_smfmac_f32_16x16x64_bf16 v[40:43], v[8:11], a[56:63], v3
  buffer_load_dwordx4 v[20:23], v2, s[8:11], s20 offen offset:3072 sc1
  v_smfmac_f32_16x16x64_bf16 v[44:47], v[8:11], a[112:119], v3
  v_smfmac_f32_16x16x64_bf16 v[48:51], v[8:11], a[168:175], v3
  v_smfmac_f32_16x16x64_bf16 v[52:55], v[8:11], a[224:231], v3
  buffer_load_dwordx4 v[24:27], v2, s[8:11], s23 offen offset:0 sc1
  v_smfmac_f32_16x16x64_bf16 v[56:59], v[8:11], v[144:151], v3
  v_smfmac_f32_16x16x64_bf16 v[60:63], v[8:11], v[200:207], v3
  s_waitcnt vmcnt(3)
  v_smfmac_f32_16x16x64_bf16 v[36:39], v[12:15], a[8:15], v3
  v_smfmac_f32_16x16x64_bf16 v[40:43], v[12:15], a[64:71], v3
  buffer_load_dwordx4 v[28:31], v2, s[8:11], s23 offen offset:1024 sc1
  v_smfmac_f32_16x16x64_bf16 v[44:47], v[12:15], a[120:127], v3
  v_smfmac_f32_16x16x64_bf16 v[48:51], v[12:15], a[176:183], v3
  v_smfmac_f32_16x16x64_bf16 v[52:55], v[12:15], a[232:239], v3
  buffer_load_dwordx4 v[32:35], v2, s[8:11], s23 offen offset:2048 sc1
  v_smfmac_f32_16x16x64_bf16 v[56:59], v[12:15], v[152:159], v3
  v_smfmac_f32_16x16x64_bf16 v[60:63], v[12:15], v[208:215], v3
  s_waitcnt vmcnt(4)
  v_smfmac_f32_16x16x64_bf16 v[36:39], v[16:19], a[16:23], v3
  v_smfmac_f32_16x16x64_bf16 v[40:43], v[16:19], a[72:79], v3
  v_smfmac_f32_16x16x64_bf16 v[44:47], v[16:19], a[128:135], v3
  v_smfmac_f32_16x16x64_bf16 v[48:51], v[16:19], a[184:191], v3
  v_smfmac_f32_16x16x64_bf16 v[52:55], v[16:19], a[240:247], v3
  v_smfmac_f32_16x16x64_bf16 v[56:59], v[16:19], v[160:167], v3
  v_smfmac_f32_16x16x64_bf16 v[60:63], v[16:19], v[216:223], v3
  s_waitcnt vmcnt(3)
  v_smfmac_f32_16x16x64_bf16 v[36:39], v[20:23], a[24:31], v3
  v_smfmac_f32_16x16x64_bf16 v[40:43], v[20:23], a[80:87], v3
  v_smfmac_f32_16x16x64_bf16 v[44:47], v[20:23], a[136:143], v3
  v_smfmac_f32_16x16x64_bf16 v[48:51], v[20:23], a[192:199], v3
  v_smfmac_f32_16x16x64_bf16 v[52:55], v[20:23], a[248:255], v3
  v_smfmac_f32_16x16x64_bf16 v[56:59], v[20:23], v[168:175], v3
  v_smfmac_f32_16x16x64_bf16 v[60:63], v[20:23], v[224:231], v3
  s_waitcnt vmcnt(0)
cB_sc2_ph2:
  v_smfmac_f32_16x16x64_bf16 v[60:63], v[24:27], v[232:239], v3
  ds_read_b128 v[8:11], v116 offset:4096
  ds_read_b128 v[12:15], v116 offset:5120
  v_smfmac_f32_16x16x64_bf16 v[60:63], v[28:31], v[240:247], v3
  buffer_load_dword v119, v0, s[8:11], s24 offen sc1
  v_smfmac_f32_16x16x64_bf16 v[60:63], v[32:35], v[248:255], v3
  v_mov_b32 v80, v28
  v_smfmac_f32_16x16x64_bf16 v[52:55], v[24:27], v[120:127], v3
  v_mov_b32 v81, v29
  v_smfmac_f32_16x16x64_bf16 v[52:55], v[28:31], v[128:135], v3
  v_mov_b32 v82, v34
  v_smfmac_f32_16x16x64_bf16 v[52:55], v[32:35], v[136:143], v3
  v_cvt_pk_bf16_f32 v64, v60, v61
  v_smfmac_f32_16x16x64_bf16 v[56:59], v[24:27], v[176:183], v3
  v_cvt_pk_bf16_f32 v65, v62, v63
  v_smfmac_f32_16x16x64_bf16 v[56:59], v[28:31], v[184:191], v3
  v_mov_b32 v83, v35
  v_mfma_f32_16x16x32_bf16 v[68:71], v[64:67], v[4:7], 0
  v_smfmac_f32_16x16x64_bf16 v[56:59], v[32:35], v[192:199], v3
  v_cvt_pk_bf16_f32 v64, v52, v53
  v_smfmac_f32_16x16x64_bf16 v[36:39], v[24:27], a[32:39], v3
  v_cvt_pk_bf16_f32 v65, v54, v55
  v_smfmac_f32_16x16x64_bf16 v[36:39], v[28:31], a[40:47], v3
  v_cvt_pk_bf16_f32 v78, v68, v69
  v_smfmac_f32_16x16x64_bf16 v[36:39], v[32:35], a[48:55], v3
  v_cvt_pk_bf16_f32 v79, v70, v71
  v_cvt_pk_bf16_f32 v66, v56, v57
  v_smfmac_f32_16x16x64_bf16 v[40:43], v[24:27], a[88:95], v3
  v_cvt_pk_bf16_f32 v67, v58, v59
  v_smfmac_f32_16x16x64_bf16 v[40:43], v[28:31], a[96:103], v3
  v_mfma_f32_16x16x32_bf16 v[72:75], v[64:67], v[4:7], 0
  ds_read_b128 v[52:55], v116 offset:18432
  ds_read_b128 v[56:59], v116 offset:19456
  v_smfmac_f32_16x16x64_bf16 v[40:43], v[32:35], a[104:111], v3
  v_cvt_pk_bf16_f32 v64, v36, v37
  v_smfmac_f32_16x16x64_bf16 v[44:47], v[24:27], a[144:151], v3
  v_cvt_pk_bf16_f32 v65, v38, v39
  v_smfmac_f32_16x16x64_bf16 v[44:47], v[28:31], a[152:159], v3
  v_cvt_pk_bf16_f32 v76, v72, v73
  v_smfmac_f32_16x16x64_bf16 v[44:47], v[32:35], a[160:167], v3
  v_cvt_pk_bf16_f32 v77, v74, v75
  v_cvt_pk_bf16_f32 v66, v40, v41
  v_smfmac_f32_16x16x64_bf16 v[48:51], v[24:27], a[200:207], v3
  v_cvt_pk_bf16_f32 v67, v42, v43
  v_smfmac_f32_16x16x64_bf16 v[48:51], v[28:31], a[208:215], v3
  v_mfma_f32_16x16x32_bf16 v[68:71], v[64:67], v[4:7], 0
  v_smfmac_f32_16x16x64_bf16 v[48:51], v[32:35], a[216:223], v3
  v_cvt_pk_bf16_f32 v64, v44, v45
  v_mfma_f32_16x16x32_bf16 v[84:87], v[80:83], v[76:79], 0
  v_cvt_pk_bf16_f32 v65, v46, v47
  s_waitcnt lgkmcnt(0)
  v_smfmac_f32_16x16x64_bf16 v[88:91], v[76:79], v[96:103], v3
  v_cvt_pk_bf16_f32 v60, v68, v69
  v_cvt_pk_bf16_f32 v61, v70, v71
  v_cvt_pk_bf16_f32 v66, v48, v49
  v_cvt_pk_bf16_f32 v67, v50, v51
  s_nop 1
  v_mfma_f32_16x16x32_bf16 v[72:75], v[64:67], v[4:7], 0
  v_smfmac_f32_16x16x64_bf16 v[92:95], v[76:79], v[104:111], v3
  s_nop 4
  v_cvt_pk_bf16_f32 v62, v72, v73
  v_cvt_pk_bf16_f32 v63, v74, v75
  s_nop 1
  v_mfma_f32_16x16x32_bf16 v[84:87], v[16:19], v[60:63], v[84:87]
  v_smfmac_f32_16x16x64_bf16 v[88:91], v[60:63], v[8:15], v3
  v_smfmac_f32_16x16x64_bf16 v[92:95], v[60:63], v[52:59], v3
  s_mov_b64 exec, s[26:27]
  s_nop 0
  ds_write_b128 v113, v[84:87]
  s_mov_b64 exec, -1
  s_nop 0
  v_cmp_u_f32 vcc, v88, v89
  s_nop 1
  v_permlane32_swap_b32 v88, v92
  v_permlane32_swap_b32 v89, v93
  v_permlane32_swap_b32 v90, v94
  v_permlane32_swap_b32 v91, v95
  v_add_f32 v88, v88, v92
  v_add_f32 v89, v89, v93
  v_add_f32 v90, v90, v94
  v_add_f32 v91, v91, v95
  ds_write_b128 v112, v[88:91]
  s_cbranch_vccnz cB_sc2_retry
cB_sc2_cont:
  s_waitcnt lgkmcnt(0)
  s_barrier
  ds_read_b64 v[36:37], v114 offset:0
  ds_read_b64 v[38:39], v114 offset:1024
  ds_read2_b32 v[44:45], v115 offset0:0 offset1:64
  v_lshl_add_u32 v56, v2, 3, s36
  s_waitcnt lgkmcnt(0)
  v_add_f32 v44, v44, v45
  v_add_f32 v36, v36, v38
  v_add_f32 v37, v37, v39
  v_add_f32_dpp v44, v44, v44 row_ror:8 row_mask:0xf bank_mask:0xf
  v_mov_b32 v45, v44
  s_mov_b64 exec, 65535
  buffer_store_dword v2, v56, s[8:11], s20 offen sc1
  s_mov_b64 exec, -1
  v_permlane32_swap_b32 v36, v37
  v_add_f32 v36, v36, v37
  v_permlane16_swap_b32 v44, v45
  v_add_f32 v44, v44, v45
  v_exp_f32 v48, v36
  v_exp_f32 v49, v44
  v_add_f32 v50, abs(v36), abs(v44)
  v_fma_f32 v39, v49, s37, v48
  v_cmp_ngt_f32 vcc, s56, v50
  v_cndmask_b32 v41, v48, v49, s[38:39]
  v_add_f32_dpp v39, v39, v39 quad_perm:[1,0,3,2] row_mask:0xf bank_mask:0xf
  v_cndmask_b32 v40, v49, v48, s[38:39]
  v_mov_b32_dpp v46, v41 quad_perm:[1,0,3,2] row_mask:0xf bank_mask:0xf
  v_add_f32_dpp v39, v39, v39 quad_perm:[2,3,0,1] row_mask:0xf bank_mask:0xf
  v_cndmask_b32 v42, v46, v40, s[38:39]
  v_cndmask_b32 v43, v40, v46, s[38:39]
  v_add_f32_dpp v39, v39, v39 row_half_mirror row_mask:0xf bank_mask:0xf
  s_cbranch_vccnz cB_sc2_slow
  s_nop 0
  v_add_f32_dpp v39, v39, v39 row_mirror row_mask:0xf bank_mask:0xf
  v_mov_b32 v47, v39
  s_nop 1
  v_permlane16_swap_b32 v39, v47
  v_add_f32 v39, v39, v47
  v_rcp_f32 v39, v39
  s_mov_b64 exec, s[28:29]
  v_mul_f32 v42, v42, v39
  v_mul_f32 v43, v43, v39
  v_cvt_pk_bf16_f32 v42, v42, v43
cB_sc2_pst:
  buffer_store_dword v42, v1, s[8:11], s20 offen sc1
  s_mov_b64 exec, -1
  s_barrier
  s_add_u32 s24, s24, 28672
  s_add_u32 s35, s35, 28672
  s_xor_b32 s25, s25, 28672
  s_add_u32 m0, s25, 14336
  s_nop 0
  buffer_load_dwordx4 v2, s[8:11], s24 offen offset:0 sc1 lds
  buffer_load_dwordx4 v2, s[8:11], s24 offen offset:1024 sc1 lds
  buffer_load_dwordx4 v2, s[8:11], s24 offen offset:2048 sc1 lds
  buffer_load_dwordx4 v2, s[8:11], s24 offen offset:3072 sc1 lds
  s_add_u32 m0, s25, 18432
  s_add_u32 s22, s24, 4096
  buffer_load_dwordx4 v2, s[8:11], s22 offen offset:0 sc1 lds
  buffer_load_dwordx4 v2, s[8:11], s22 offen offset:1024 sc1 lds
  buffer_load_dwordx4 v2, s[8:11], s22 offen offset:2048 sc1 lds
  v_xor_b32 v116, 28672, v116
  v_add_u32 v117, s57, v117
  s_sub_u32 s57, 0, s57
  s_add_u32 s19, s19, 1
  s_mov_b32 s20, s21
  s_cmp_lt_u32 s19, 63
  s_cbranch_scc1 cB_sc2_loop
  s_branch cB_done
cB_sc2_slow:
  v_max_f32 v50, v36, v44
  s_nop 1
  v_max_f32_dpp v50, v50, v50 quad_perm:[1,0,3,2] row_mask:0xf bank_mask:0xf
  s_nop 1
  v_max_f32_dpp v50, v50, v50 quad_perm:[2,3,0,1] row_mask:0xf bank_mask:0xf
  s_nop 1
  v_max_f32_dpp v50, v50, v50 row_half_mirror row_mask:0xf bank_mask:0xf
  s_nop 1
  v_max_f32_dpp v50, v50, v50 row_mirror row_mask:0xf bank_mask:0xf
  v_mov_b32 v47, v50
  s_nop 1
  v_permlane16_swap_b32 v50, v47
  v_max_f32 v50, v50, v47
  v_sub_f32 v48, v36, v50
  v_sub_f32 v49, v44, v50
  v_exp_f32 v48, v48
  v_exp_f32 v49, v49
  s_add_u32 s31, s31, 0x100
  v_fma_f32 v39, v49, s37, v48
  v_cndmask_b32 v41, v48, v49, s[38:39]
  s_nop 0
  v_add_f32_dpp v39, v39, v39 quad_perm:[1,0,3,2] row_mask:0xf bank_mask:0xf
  v_cndmask_b32 v40, v49, v48, s[38:39]
  v_mov_b32_dpp v46, v41 quad_perm:[1,0,3,2] row_mask:0xf bank_mask:0xf
  v_add_f32_dpp v39, v39, v39 quad_perm:[2,3,0,1] row_mask:0xf bank_mask:0xf
  v_cndmask_b32 v42, v46, v40, s[38:39]
  v_cndmask_b32 v43, v40, v46, s[38:39]
  v_add_f32_dpp v39, v39, v39 row_half_mirror row_mask:0xf bank_mask:0xf
  s_nop 1
  v_add_f32_dpp v39, v39, v39 row_mirror row_mask:0xf bank_mask:0xf
  v_mov_b32 v47, v39
  s_nop 1
  v_permlane16_swap_b32 v39, v47
  v_add_f32 v39, v39, v47
  v_rcp_f32 v39, v39
  s_mov_b64 exec, s[28:29]
  v_mul_f32 v42, v42, v39
  v_mul_f32 v43, v43, v39
  v_cvt_pk_bf16_f32 v42, v42, v43
  v_min_u32 v42, -2, v42
  s_branch cB_sc2_pst
cB_sc2_retry:
  s_cmp_lg_u32 s62, 0
  s_cbranch_scc1 cB_sc2_cont
  s_waitcnt vmcnt(0) lgkmcnt(0)
cB_sc2_rv:
  buffer_load_dwordx4 v[8:11], v2, s[8:11], s20 offen offset:0 sc1
  buffer_load_dwordx4 v[12:15], v2, s[8:11], s20 offen offset:1024 sc1
  buffer_load_dwordx4 v[16:19], v2, s[8:11], s20 offen offset:2048 sc1
  buffer_load_dwordx4 v[20:23], v2, s[8:11], s20 offen offset:3072 sc1
  buffer_load_dwordx4 v[24:27], v2, s[8:11], s23 offen offset:0 sc1
  buffer_load_dwordx4 v[28:31], v2, s[8:11], s23 offen offset:1024 sc1
  buffer_load_dwordx4 v[32:35], v2, s[8:11], s23 offen offset:2048 sc1
  s_waitcnt vmcnt(0)
  v_max3_u32 v118, v8, v9, v10
  v_max3_u32 v118, v118, v11, v12
  v_max3_u32 v118, v118, v13, v14
  v_max3_u32 v118, v118, v15, v16
  v_max3_u32 v118, v118, v17, v18
  v_max3_u32 v118, v118, v19, v20
  v_max3_u32 v118, v118, v21, v22
  v_max3_u32 v118, v118, v23, v24
  v_max3_u32 v118, v118, v25, v26
  v_max3_u32 v118, v118, v27, v28
  v_max3_u32 v118, v118, v29, v30
  v_max3_u32 v118, v118, v31, v32
  v_max3_u32 v118, v118, v33, v34
  v_max_u32 v118, v118, v35
  v_cmp_eq_u32 vcc, -1, v118
  s_cbranch_vccz cB_sc2_rk
  s_add_u32 s30, s30, 1
  s_cmp_lt_u32 s30, 400000
  s_cbranch_scc1 cB_sc2_rv
  s_branch cB_abort
cB_sc2_rk:
  s_mov_b32 s62, 1
  v_mov_b32 v36, 0
  v_mov_b32 v37, 0
  v_mov_b32 v38, 0
  v_mov_b32 v39, 0
  v_mov_b32 v40, 0
  v_mov_b32 v41, 0
  v_mov_b32 v42, 0
  v_mov_b32 v43, 0
  v_mov_b32 v44, 0
  v_mov_b32 v45, 0
  v_mov_b32 v46, 0
  v_mov_b32 v47, 0
  v_mov_b32 v48, 0
  v_mov_b32 v49, 0
  v_mov_b32 v50, 0
  v_mov_b32 v51, 0
  v_mov_b32 v52, 0
  v_mov_b32 v53, 0
  v_mov_b32 v54, 0
  v_mov_b32 v55, 0
  v_mov_b32 v56, 0
  v_mov_b32 v57, 0
  v_mov_b32 v58, 0
  v_mov_b32 v59, 0
  v_mov_b32 v60, 0
  v_mov_b32 v61, 0
  v_mov_b32 v62, 0
  v_mov_b32 v63, 0
  v_mov_b32 v88, 0
  v_mov_b32 v89, 0
  v_mov_b32 v90, 0
  v_mov_b32 v91, 0
  v_mov_b32 v92, 0
  v_mov_b32 v93, 0
  v_mov_b32 v94, 0
  v_mov_b32 v95, 0
  v_mov_b32 v66, 0
  v_mov_b32 v67, 0
  s_add_u32 s31, s31, 1
  ds_read_b128 v[96:99], v117 offset:0
  ds_read_b128 v[100:103], v117 offset:1024
  ds_read_b128 v[104:107], v117 offset:14336
  ds_read_b128 v[108:111], v117 offset:15360
  v_smfmac_f32_16x16x64_bf16 v[36:39], v[8:11], a[0:7], v3
  v_smfmac_f32_16x16x64_bf16 v[40:43], v[8:11], a[56:63], v3
  v_smfmac_f32_16x16x64_bf16 v[44:47], v[8:11], a[112:119], v3
  v_smfmac_f32_16x16x64_bf16 v[48:51], v[8:11], a[168:175], v3
  v_smfmac_f32_16x16x64_bf16 v[52:55], v[8:11], a[224:231], v3
  v_smfmac_f32_16x16x64_bf16 v[56:59], v[8:11], v[144:151], v3
  v_smfmac_f32_16x16x64_bf16 v[60:63], v[8:11], v[200:207], v3
  v_smfmac_f32_16x16x64_bf16 v[36:39], v[12:15], a[8:15], v3
  v_smfmac_f32_16x16x64_bf16 v[40:43], v[12:15], a[64:71], v3
  v_smfmac_f32_16x16x64_bf16 v[44:47], v[12:15], a[120:127], v3
  v_smfmac_f32_16x16x64_bf16 v[48:51], v[12:15], a[176:183], v3
  v_smfmac_f32_16x16x64_bf16 v[52:55], v[12:15], a[232:239], v3
  v_smfmac_f32_16x16x64_bf16 v[56:59], v[12:15], v[152:159], v3
  v_smfmac_f32_16x16x64_bf16 v[60:63], v[12:15], v[208:215], v3
  v_smfmac_f32_16x16x64_bf16 v[36:39], v[16:19], a[16:23], v3
  v_smfmac_f32_16x16x64_bf16 v[40:43], v[16:19], a[72:79], v3
  v_smfmac_f32_16x16x64_bf16 v[44:47], v[16:19], a[128:135], v3
  v_smfmac_f32_16x16x64_bf16 v[48:51], v[16:19], a[184:191], v3
  v_smfmac_f32_16x16x64_bf16 v[52:55], v[16:19], a[240:247], v3
  v_smfmac_f32_16x16x64_bf16 v[56:59], v[16:19], v[160:167], v3
  v_smfmac_f32_16x16x64_bf16 v[60:63], v[16:19], v[216:223], v3
  v_smfmac_f32_16x16x64_bf16 v[36:39], v[20:23], a[24:31], v3
  v_smfmac_f32_16x16x64_bf16 v[40:43], v[20:23], a[80:87], v3
  v_smfmac_f32_16x16x64_bf16 v[44:47], v[20:23], a[136:143], v3
  v_smfmac_f32_16x16x64_bf16 v[48:51], v[20:23], a[192:199], v3
  v_smfmac_f32_16x16x64_bf16 v[52:55], v[20:23], a[248:255], v3
  v_smfmac_f32_16x16x64_bf16 v[56:59], v[20:23], v[168:175], v3
  v_smfmac_f32_16x16x64_bf16 v[60:63], v[20:23], v[224:231], v3
  s_branch cB_sc2_ph2
cB_sc3_loop:
  s_add_u32 s23, s20, 4096
  s_add_u32 s21, s20, 25600
  v_mov_b32 v48, 0
  v_mov_b32 v49, 0
  v_mov_b32 v50, 0
  v_mov_b32 v51, 0
  v_mov_b32 v52, 0
  v_mov_b32 v53, 0
  v_mov_b32 v54, 0
  v_mov_b32 v55, 0
  v_mov_b32 v56, 0
  v_mov_b32 v57, 0
  v_mov_b32 v58, 0
  v_mov_b32 v59, 0
  v_mov_b32 v60, 0
  v_mov_b32 v61, 0
  v_mov_b32 v62, 0
  v_mov_b32 v63, 0
  v_mov_b32 v88, 0
  v_mov_b32 v89, 0
  v_mov_b32 v90, 0
  v_mov_b32 v91, 0
  v_mov_b32 v92, 0
  v_mov_b32 v93, 0
  v_mov_b32 v94, 0
  v_mov_b32 v95, 0
  v_mov_b32 v64, 0
  v_mov_b32 v65, 0
  s_mov_b32 s30, 0
  s_mov_b32 s62, 0
  s_waitcnt vmcnt(0)
  s_barrier
cB_sc3_ld:
  buffer_load_dwordx4 v[8:11], v2, s[8:11], s20 offen offset:0 sc1
  v_mov_b32 v36, 0
  v_mov_b32 v37, 0
  v_mov_b32 v38, 0
  v_mov_b32 v39, 0
  buffer_load_dwordx4 v[12:15], v2, s[8:11], s20 offen offset:1024 sc1
  v_mov_b32 v40, 0
  v_mov_b32 v41, 0
  v_mov_b32 v42, 0
  v_mov_b32 v43, 0
  buffer_load_dwordx4 v[16:19], v2, s[8:11], s20 offen offset:2048 sc1
  v_mov_b32 v44, 0
  v_mov_b32 v45, 0
  v_mov_b32 v46, 0
  v_mov_b32 v47, 0
  ds_read_b128 v[96:99], v117 offset:0
  ds_read_b128 v[100:103], v117 offset:1024
  ds_read_b128 v[104:107], v117 offset:14336
  ds_read_b128 v[108:111], v117 offset:15360
  s_waitcnt vmcnt(2)
  v_smfmac_f32_16x16x64_bf16 v[36:39], v[8:11], a[0:7], v3
  v_smfmac_f32_16x16x64_bf16 v[40:43], v[8:11], a[56:63], v3
  buffer_load_dwordx4 v[20:23], v2, s[8:11], s20 offen offset:3072 sc1
  v_smfmac_f32_16x16x64_bf16 v[44:47], v[8:11], a[112:119], v3
  v_smfmac_f32_16x16x64_bf16 v[48:51], v[8:11], a[168:175], v3
  v_smfmac_f32_16x16x64_bf16 v[52:55], v[8:11], a[224:231], v3
  buffer_load_dwordx4 v[24:27], v2, s[8:11], s23 offen offset:0 sc1
  v_smfmac_f32_16x16x64_bf16 v[56:59], v[8:11], v[144:151], v3
  v_smfmac_f32_16x16x64_bf16 v[60:63], v[8:11], v[200:207], v3
  s_waitcnt vmcnt(3)
  v_smfmac_f32_16x16x64_bf16 v[36:39], v[12:15], a[8:15], v3
  v_smfmac_f32_16x16x64_bf16 v[40:43], v[12:15], a[64:71], v3
  buffer_load_dwordx4 v[28:31], v2, s[8:11], s23 offen offset:1024 sc1
  v_smfmac_f32_16x16x64_bf16 v[44:47], v[12:15], a[120:127], v3
  v_smfmac_f32_16x16x64_bf16 v[48:51], v[12:15], a[176:183], v3
  v_smfmac_f32_16x16x64_bf16 v[52:55], v[12:15], a[232:239], v3
  buffer_load_dwordx4 v[32:35], v2, s[8:11], s23 offen offset:2048 sc1
  v_smfmac_f32_16x16x64_bf16 v[56:59], v[12:15], v[152:159], v3
  v_smfmac_f32_16x16x64_bf16 v[60:63], v[12:15], v[208:215], v3
  s_waitcnt vmcnt(4)
  v_smfmac_f32_16x16x64_bf16 v[36:39], v[16:19], a[16:23], v3
  v_smfmac_f32_16x16x64_bf16 v[40:43], v[16:19], a[72:79], v3
  v_smfmac_f32_16x16x64_bf16 v[44:47], v[16:19], a[128:135], v3
  v_smfmac_f32_16x16x64_bf16 v[48:51], v[16:19], a[184:191], v3
  v_smfmac_f32_16x16x64_bf16 v[52:55], v[16:19], a[240:247], v3
  v_smfmac_f32_16x16x64_bf16 v[56:59], v[16:19], v[160:167], v3
  v_smfmac_f32_16x16x64_bf16 v[60:63], v[16:19], v[216:223], v3
  s_waitcnt vmcnt(3)
  v_smfmac_f32_16x16x64_bf16 v[36:39], v[20:23], a[24:31], v3
  v_smfmac_f32_16x16x64_bf16 v[40:43], v[20:23], a[80:87], v3
  v_smfmac_f32_16x16x64_bf16 v[44:47], v[20:23], a[136:143], v3
  v_smfmac_f32_16x16x64_bf16 v[48:51], v[20:23], a[192:199], v3
  v_smfmac_f32_16x16x64_bf16 v[52:55], v[20:23], a[248:255], v3
  v_smfmac_f32_16x16x64_bf16 v[56:59], v[20:23], v[168:175], v3
  v_smfmac_f32_16x16x64_bf16 v[60:63], v[20:23], v[224:231], v3
  s_waitcnt vmcnt(0)
cB_sc3_ph2:
  v_smfmac_f32_16x16x64_bf16 v[60:63], v[24:27], v[232:239], v3
  ds_read_b128 v[8:11], v116 offset:6144
  ds_read_b128 v[12:15], v116 offset:7168
  v_smfmac_f32_16x16x64_bf16 v[60:63], v[28:31], v[240:247], v3
  v_smfmac_f32_16x16x64_bf16 v[60:63], v[32:35], v[248:255], v3
  v_mov_b32 v80, v30
  v_smfmac_f32_16x16x64_bf16 v[52:55], v[24:27], v[120:127], v3
  v_mov_b32 v81, v31
  v_smfmac_f32_16x16x64_bf16 v[52:55], v[28:31], v[128:135], v3
  v_mov_b32 v82, v34
  v_smfmac_f32_16x16x64_bf16 v[52:55], v[32:35], v[136:143], v3
  v_cvt_pk_bf16_f32 v66, v60, v61
  v_smfmac_f32_16x16x64_bf16 v[56:59], v[24:27], v[176:183], v3
  v_cvt_pk_bf16_f32 v67, v62, v63
  v_smfmac_f32_16x16x64_bf16 v[56:59], v[28:31], v[184:191], v3
  v_mov_b32 v83, v35
  v_mfma_f32_16x16x32_bf16 v[68:71], v[64:67], v[4:7], 0
  v_smfmac_f32_16x16x64_bf16 v[56:59], v[32:35], v[192:199], v3
  v_cvt_pk_bf16_f32 v64, v52, v53
  v_smfmac_f32_16x16x64_bf16 v[36:39], v[24:27], a[32:39], v3
  v_cvt_pk_bf16_f32 v65, v54, v55
  v_smfmac_f32_16x16x64_bf16 v[36:39], v[28:31], a[40:47], v3
  v_cvt_pk_bf16_f32 v78, v68, v69
  v_smfmac_f32_16x16x64_bf16 v[36:39], v[32:35], a[48:55], v3
  v_cvt_pk_bf16_f32 v79, v70, v71
  v_cvt_pk_bf16_f32 v66, v56, v57
  v_smfmac_f32_16x16x64_bf16 v[40:43], v[24:27], a[88:95], v3
  v_cvt_pk_bf16_f32 v67, v58, v59
  v_smfmac_f32_16x16x64_bf16 v[40:43], v[28:31], a[96:103], v3
  v_mfma_f32_16x16x32_bf16 v[72:75], v[64:67], v[4:7], 0
  ds_read_b128 v[52:55], v116 offset:20480
  ds_read_b128 v[56:59], v116 offset:21504
  v_smfmac_f32_16x16x64_bf16 v[40:43], v[32:35], a[104:111], v3
  v_cvt_pk_bf16_f32 v64, v36, v37
  v_smfmac_f32_16x16x64_bf16 v[44:47], v[24:27], a[144:151], v3
  v_cvt_pk_bf16_f32 v65, v38, v39
  v_smfmac_f32_16x16x64_bf16 v[44:47], v[28:31], a[152:159], v3
  v_cvt_pk_bf16_f32 v76, v72, v73
  v_smfmac_f32_16x16x64_bf16 v[44:47], v[32:35], a[160:167], v3
  v_cvt_pk_bf16_f32 v77, v74, v75
  v_cvt_pk_bf16_f32 v66, v40, v41
  v_smfmac_f32_16x16x64_bf16 v[48:51], v[24:27], a[200:207], v3
  v_cvt_pk_bf16_f32 v67, v42, v43
  v_smfmac_f32_16x16x64_bf16 v[48:51], v[28:31], a[208:215], v3
  v_mfma_f32_16x16x32_bf16 v[68:71], v[64:67], v[4:7], 0
  v_smfmac_f32_16x16x64_bf16 v[48:51], v[32:35], a[216:223], v3
  v_cvt_pk_bf16_f32 v64, v44, v45
  v_mfma_f32_16x16x32_bf16 v[84:87], v[80:83], v[76:79], 0
  v_cvt_pk_bf16_f32 v65, v46, v47
  s_waitcnt lgkmcnt(0)
  v_smfmac_f32_16x16x64_bf16 v[88:91], v[76:79], v[96:103], v3
  v_cvt_pk_bf16_f32 v60, v68, v69
  v_cvt_pk_bf16_f32 v61, v70, v71
  v_cvt_pk_bf16_f32 v66, v48, v49
  v_cvt_pk_bf16_f32 v67, v50, v51
  s_nop 1
  v_mfma_f32_16x16x32_bf16 v[72:75], v[64:67], v[4:7], 0
  v_smfmac_f32_16x16x64_bf16 v[92:95], v[76:79], v[104:111], v3
  s_nop 4
  v_cvt_pk_bf16_f32 v62, v72, v73
  v_cvt_pk_bf16_f32 v63, v74, v75
  s_nop 1
  v_mfma_f32_16x16x32_bf16 v[84:87], v[20:23], v[60:63], v[84:87]
  v_smfmac_f32_16x16x64_bf16 v[88:91], v[60:63], v[8:15], v3
  v_smfmac_f32_16x16x64_bf16 v[92:95], v[60:63], v[52:59], v3
  s_mov_b64 exec, s[26:27]
  s_nop 0
  ds_write_b128 v113, v[84:87]
  s_mov_b64 exec, -1
  s_nop 0
  v_cmp_u_f32 vcc, v88, v89
  s_nop 1
  v_permlane32_swap_b32 v88, v92
  v_permlane32_swap_b32 v89, v93
  v_permlane32_swap_b32 v90, v94
  v_permlane32_swap_b32 v91, v95
  v_add_f32 v88, v88, v92
  v_add_f32 v89, v89, v93
  v_add_f32 v90, v90, v94
  v_add_f32 v91, v91, v95
  ds_write_b128 v112, v[88:91]
  s_cbranch_vccnz cB_sc3_retry
cB_sc3_cont:
  s_waitcnt lgkmcnt(0)
  s_barrier
  ds_read_b64 v[36:37], v114 offset:0
  ds_read_b64 v[38:39], v114 offset:1024
  ds_read2_b32 v[44:45], v115 offset0:0 offset1:64
  s_waitcnt lgkmcnt(0)
  v_add_f32 v44, v44, v45
  v_add_f32 v36, v36, v38
  v_add_f32 v37, v37, v39
  v_add_f32_dpp v44, v44, v44 row_ror:8 row_mask:0xf bank_mask:0xf
  v_mov_b32 v45, v44
  v_permlane32_swap_b32 v36, v37
  v_add_f32 v36, v36, v37
  v_permlane16_swap_b32 v44, v45
  v_add_f32 v44, v44, v45
  v_exp_f32 v48, v36
  v_exp_f32 v49, v44
  v_add_f32 v50, abs(v36), abs(v44)
  v_fma_f32 v39, v49, s37, v48
  v_cmp_ngt_f32 vcc, s56, v50
  v_cndmask_b32 v41, v48, v49, s[38:39]
  v_add_f32_dpp v39, v39, v39 quad_perm:[1,0,3,2] row_mask:0xf bank_mask:0xf
  v_cndmask_b32 v40, v49, v48, s[38:39]
  v_mov_b32_dpp v46, v41 quad_perm:[1,0,3,2] row_mask:0xf bank_mask:0xf
  v_add_f32_dpp v39, v39, v39 quad_perm:[2,3,0,1] row_mask:0xf bank_mask:0xf
  v_cndmask_b32 v42, v46, v40, s[38:39]
  v_cndmask_b32 v43, v40, v46, s[38:39]
  v_add_f32_dpp v39, v39, v39 row_half_mirror row_mask:0xf bank_mask:0xf
  s_cbranch_vccnz cB_sc3_slow
  s_nop 0
  v_add_f32_dpp v39, v39, v39 row_mirror row_mask:0xf bank_mask:0xf
  v_mov_b32 v47, v39
  s_nop 1
  v_permlane16_swap_b32 v39, v47
  v_add_f32 v39, v39, v47
  v_rcp_f32 v39, v39
  s_mov_b64 exec, s[28:29]
  v_mul_f32 v42, v42, v39
  v_mul_f32 v43, v43, v39
  v_cvt_pk_bf16_f32 v42, v42, v43
cB_sc3_pst:
  buffer_store_dword v42, v1, s[8:11], s20 offen sc1
  s_mov_b64 exec, -1
  s_barrier
  s_add_u32 s24, s24, 28672
  s_add_u32 s35, s35, 28672
  s_xor_b32 s25, s25, 28672
  s_add_u32 m0, s25, 21504
  s_nop 0
  buffer_load_dwordx4 v2, s[8:11], s24 offen offset:0 sc1 lds
  buffer_load_dwordx4 v2, s[8:11], s24 offen offset:1024 sc1 lds
  buffer_load_dwordx4 v2, s[8:11], s24 offen offset:2048 sc1 lds
  buffer_load_dwordx4 v2, s[8:11], s24 offen offset:3072 sc1 lds
  s_add_u32 m0, s25, 25600
  s_add_u32 s22, s24, 4096
  buffer_load_dwordx4 v2, s[8:11], s22 offen offset:0 sc1 lds
  buffer_load_dwordx4 v2, s[8:11], s22 offen offset:1024 sc1 lds
  buffer_load_dwordx4 v2, s[8:11], s22 offen offset:2048 sc1 lds
  v_xor_b32 v116, 28672, v116
  v_add_u32 v117, s57, v117
  s_sub_u32 s57, 0, s57
  s_add_u32 s19, s19, 1
  s_mov_b32 s20, s21
  s_cmp_lt_u32 s19, 63
  s_cbranch_scc1 cB_sc3_loop
  s_branch cB_done
cB_sc3_slow:
  v_max_f32 v50, v36, v44
  s_nop 1
  v_max_f32_dpp v50, v50, v50 quad_perm:[1,0,3,2] row_mask:0xf bank_mask:0xf
  s_nop 1
  v_max_f32_dpp v50, v50, v50 quad_perm:[2,3,0,1] row_mask:0xf bank_mask:0xf
  s_nop 1
  v_max_f32_dpp v50, v50, v50 row_half_mirror row_mask:0xf bank_mask:0xf
  s_nop 1
  v_max_f32_dpp v50, v50, v50 row_mirror row_mask:0xf bank_mask:0xf
  v_mov_b32 v47, v50
  s_nop 1
  v_permlane16_swap_b32 v50, v47
  v_max_f32 v50, v50, v47
  v_sub_f32 v48, v36, v50
  v_sub_f32 v49, v44, v50
  v_exp_f32 v48, v48
  v_exp_f32 v49, v49
  s_add_u32 s31, s31, 0x100
  v_fma_f32 v39, v49, s37, v48
  v_cndmask_b32 v41, v48, v49, s[38:39]
  s_nop 0
  v_add_f32_dpp v39, v39, v39 quad_perm:[1,0,3,2] row_mask:0xf bank_mask:0xf
  v_cndmask_b32 v40, v49, v48, s[38:39]
  v_mov_b32_dpp v46, v41 quad_perm:[1,0,3,2] row_mask:0xf bank_mask:0xf
  v_add_f32_dpp v39, v39, v39 quad_perm:[2,3,0,1] row_mask:0xf bank_mask:0xf
  v_cndmask_b32 v42, v46, v40, s[38:39]
  v_cndmask_b32 v43, v40, v46, s[38:39]
  v_add_f32_dpp v39, v39, v39 row_half_mirror row_mask:0xf bank_mask:0xf
  s_nop 1
  v_add_f32_dpp v39, v39, v39 row_mirror row_mask:0xf bank_mask:0xf
  v_mov_b32 v47, v39
  s_nop 1
  v_permlane16_swap_b32 v39, v47
  v_add_f32 v39, v39, v47
  v_rcp_f32 v39, v39
  s_mov_b64 exec, s[28:29]
  v_mul_f32 v42, v42, v39
  v_mul_f32 v43, v43, v39
  v_cvt_pk_bf16_f32 v42, v42, v43
  v_min_u32 v42, -2, v42
  s_branch cB_sc3_pst
cB_sc3_retry:
  s_cmp_lg_u32 s62, 0
  s_cbranch_scc1 cB_sc3_cont
  s_waitcnt vmcnt(0) lgkmcnt(0)
cB_sc3_rv:
  buffer_load_dwordx4 v[8:11], v2, s[8:11], s20 offen offset:0 sc1
  buffer_load_dwordx4 v[12:15], v2, s[8:11], s20 offen offset:1024 sc1
  buffer_load_dwordx4 v[16:19], v2, s[8:11], s20 offen offset:2048 sc1
  buffer_load_dwordx4 v[20:23], v2, s[8:11], s20 offen offset:3072 sc1
  buffer_load_dwordx4 v[24:27], v2, s[8:11], s23 offen offset:0 sc1
  buffer_load_dwordx4 v[28:31], v2, s[8:11], s23 offen offset:1024 sc1
  buffer_load_dwordx4 v[32:35], v2, s[8:11], s23 offen offset:2048 sc1
  s_waitcnt vmcnt(0)
  v_max3_u32 v118, v8, v9, v10
  v_max3_u32 v118, v118, v11, v12
  v_max3_u32 v118, v118, v13, v14
  v_max3_u32 v118, v118, v15, v16
  v_max3_u32 v118, v118, v17, v18
  v_max3_u32 v118, v118, v19, v20
  v_max3_u32 v118, v118, v21, v22
  v_max3_u32 v118, v118, v23, v24
  v_max3_u32 v118, v118, v25, v26
  v_max3_u32 v118, v118, v27, v28
  v_max3_u32 v118, v118, v29, v30
  v_max3_u32 v118, v118, v31, v32
  v_max3_u32 v118, v118, v33, v34
  v_max_u32 v118, v118, v35
  v_cmp_eq_u32 vcc, -1, v118
  s_cbranch_vccz cB_sc3_rk
  s_add_u32 s30, s30, 1
  s_cmp_lt_u32 s30, 400000
  s_cbranch_scc1 cB_sc3_rv
  s_branch cB_abort
cB_sc3_rk:
  s_mov_b32 s62, 1
  v_mov_b32 v36, 0
  v_mov_b32 v37, 0
  v_mov_b32 v38, 0
  v_mov_b32 v39, 0
  v_mov_b32 v40, 0
  v_mov_b32 v41, 0
  v_mov_b32 v42, 0
  v_mov_b32 v43, 0
  v_mov_b32 v44, 0
  v_mov_b32 v45, 0
  v_mov_b32 v46, 0
  v_mov_b32 v47, 0
  v_mov_b32 v48, 0
  v_mov_b32 v49, 0
  v_mov_b32 v50, 0
  v_mov_b32 v51, 0
  v_mov_b32 v52, 0
  v_mov_b32 v53, 0
  v_mov_b32 v54, 0
  v_mov_b32 v55, 0
  v_mov_b32 v56, 0
  v_mov_b32 v57, 0
  v_mov_b32 v58, 0
  v_mov_b32 v59, 0
  v_mov_b32 v60, 0
  v_mov_b32 v61, 0
  v_mov_b32 v62, 0
  v_mov_b32 v63, 0
  v_mov_b32 v88, 0
  v_mov_b32 v89, 0
  v_mov_b32 v90, 0
  v_mov_b32 v91, 0
  v_mov_b32 v92, 0
  v_mov_b32 v93, 0
  v_mov_b32 v94, 0
  v_mov_b32 v95, 0
  v_mov_b32 v64, 0
  v_mov_b32 v65, 0
  s_add_u32 s31, s31, 1
  ds_read_b128 v[96:99], v117 offset:0
  ds_read_b128 v[100:103], v117 offset:1024
  ds_read_b128 v[104:107], v117 offset:14336
  ds_read_b128 v[108:111], v117 offset:15360
  v_smfmac_f32_16x16x64_bf16 v[36:39], v[8:11], a[0:7], v3
  v_smfmac_f32_16x16x64_bf16 v[40:43], v[8:11], a[56:63], v3
  v_smfmac_f32_16x16x64_bf16 v[44:47], v[8:11], a[112:119], v3
  v_smfmac_f32_16x16x64_bf16 v[48:51], v[8:11], a[168:175], v3
  v_smfmac_f32_16x16x64_bf16 v[52:55], v[8:11], a[224:231], v3
  v_smfmac_f32_16x16x64_bf16 v[56:59], v[8:11], v[144:151], v3
  v_smfmac_f32_16x16x64_bf16 v[60:63], v[8:11], v[200:207], v3
  v_smfmac_f32_16x16x64_bf16 v[36:39], v[12:15], a[8:15], v3
  v_smfmac_f32_16x16x64_bf16 v[40:43], v[12:15], a[64:71], v3
  v_smfmac_f32_16x16x64_bf16 v[44:47], v[12:15], a[120:127], v3
  v_smfmac_f32_16x16x64_bf16 v[48:51], v[12:15], a[176:183], v3
  v_smfmac_f32_16x16x64_bf16 v[52:55], v[12:15], a[232:239], v3
  v_smfmac_f32_16x16x64_bf16 v[56:59], v[12:15], v[152:159], v3
  v_smfmac_f32_16x16x64_bf16 v[60:63], v[12:15], v[208:215], v3
  v_smfmac_f32_16x16x64_bf16 v[36:39], v[16:19], a[16:23], v3
  v_smfmac_f32_16x16x64_bf16 v[40:43], v[16:19], a[72:79], v3
  v_smfmac_f32_16x16x64_bf16 v[44:47], v[16:19], a[128:135], v3
  v_smfmac_f32_16x16x64_bf16 v[48:51], v[16:19], a[184:191], v3
  v_smfmac_f32_16x16x64_bf16 v[52:55], v[16:19], a[240:247], v3
  v_smfmac_f32_16x16x64_bf16 v[56:59], v[16:19], v[160:167], v3
  v_smfmac_f32_16x16x64_bf16 v[60:63], v[16:19], v[216:223], v3
  v_smfmac_f32_16x16x64_bf16 v[36:39], v[20:23], a[24:31], v3
  v_smfmac_f32_16x16x64_bf16 v[40:43], v[20:23], a[80:87], v3
  v_smfmac_f32_16x16x64_bf16 v[44:47], v[20:23], a[136:143], v3
  v_smfmac_f32_16x16x64_bf16 v[48:51], v[20:23], a[192:199], v3
  v_smfmac_f32_16x16x64_bf16 v[52:55], v[20:23], a[248:255], v3
  v_smfmac_f32_16x16x64_bf16 v[56:59], v[20:23], v[168:175], v3
  v_smfmac_f32_16x16x64_bf16 v[60:63], v[20:23], v[224:231], v3
  s_branch cB_sc3_ph2
cB_va0_loop:
  s_add_u32 s23, s20, 4096
  s_add_u32 s21, s20, 25600
  s_mov_b32 s30, 0
  s_cmp_lg_u32 s19, s38
  s_cbranch_scc1 cB_va0_vok
  s_branch cB_va0_voc
cB_va0_vow:
  buffer_load_dword v175, off, s[8:11], s35 sc1
  s_waitcnt vmcnt(0)
cB_va0_voc:
  v_readfirstlane_b32 s22, v175
  s_cmp_eq_u32 s22, 56
  s_cbranch_scc1 cB_va0_vod
  s_sleep 1
  s_add_u32 s30, s30, 1
  s_cmp_lt_u32 s30, 400000
  s_cbranch_scc1 cB_va0_vow
  s_branch cB_abort
cB_va0_vod:
  s_add_u32 s35, s35, 2048
  s_add_u32 s38, s19, 8
  s_and_b32 s38, s38, -8
  s_cmp_eq_u32 s19, 0
  s_cselect_b32 s38, 4, s38
cB_va0_vok:
  s_cmp_eq_u32 s19, 63
  s_cbranch_scc1 cB_done
  s_barrier
  s_add_u32 s22, s25, 0
  buffer_load_dwordx4 v[80:83], v6, s[8:11], s22 offen offset:0 sc1
  buffer_load_dwordx4 v[84:87], v6, s[8:11], s22 offen offset:1792 sc1
  s_add_u32 s22, s25, 3584
  buffer_load_dwordx4 v[88:91], v6, s[8:11], s22 offen offset:0 sc1
  buffer_load_dwordx4 v[92:95], v6, s[8:11], s22 offen offset:1792 sc1
  s_add_u32 s22, s25, 7168
  buffer_load_dwordx4 v[96:99], v6, s[8:11], s22 offen offset:0 sc1
  buffer_load_dwordx4 v[100:103], v6, s[8:11], s22 offen offset:1792 sc1
  s_add_u32 s22, s25, 10752
  buffer_load_dwordx4 v[104:107], v6, s[8:11], s22 offen offset:0 sc1
  buffer_load_dwordx4 v[108:111], v6, s[8:11], s22 offen offset:1792 sc1
  s_add_u32 s22, s25, 14336
  buffer_load_dwordx4 v[112:115], v6, s[8:11], s22 offen offset:0 sc1
  buffer_load_dwordx4 v[116:119], v6, s[8:11], s22 offen offset:1792 sc1
  s_add_u32 s22, s25, 17920
  buffer_load_dwordx4 v[120:123], v6, s[8:11], s22 offen offset:0 sc1
  buffer_load_dwordx4 v[124:127], v6, s[8:11], s22 offen offset:1792 sc1
  s_add_u32 s22, s25, 21504
  buffer_load_dwordx4 v[128:131], v6, s[8:11], s22 offen offset:0 sc1
  buffer_load_dwordx4 v[132:135], v6, s[8:11], s22 offen offset:1792 sc1
  s_add_u32 s22, s25, 25088
  buffer_load_dwordx4 v[136:139], v6, s[8:11], s22 offen offset:0 sc1
  buffer_load_dwordx4 v[140:143], v6, s[8:11], s22 offen offset:1792 sc1
  buffer_load_dword v175, off, s[8:11], s35 sc1
  s_barrier
  ds_read_b128 v[8:11], v2 offset:8192
  ds_read_b128 v[12:15], v2 offset:9216
  ds_read_b128 v[16:19], v2 offset:10240
  ds_read_b128 v[20:23], v2 offset:11264
  ds_read_b128 v[24:27], v2 offset:12288
  ds_read_b128 v[28:31], v2 offset:13312
  ds_read_b128 v[32:35], v2 offset:14336
  s_waitcnt lgkmcnt(0)
  v_smfmac_f32_16x16x64_bf16 v[36:39], v[8:11], a[0:7], v3
  v_smfmac_f32_16x16x64_bf16 v[36:39], v[12:15], a[8:15], v3
  v_smfmac_f32_16x16x64_bf16 v[36:39], v[16:19], a[16:23], v3
  v_smfmac_f32_16x16x64_bf16 v[36:39], v[20:23], a[24:31], v3
  v_smfmac_f32_16x16x64_bf16 v[36:39], v[24:27], a[32:39], v3
  v_smfmac_f32_16x16x64_bf16 v[36:39], v[28:31], a[40:47], v3
  v_smfmac_f32_16x16x64_bf16 v[36:39], v[32:35], a[48:55], v3
  v_smfmac_f32_16x16x64_bf16 v[40:43], v[8:11], a[56:63], v3
  v_smfmac_f32_16x16x64_bf16 v[40:43], v[12:15], a[64:71], v3
  v_smfmac_f32_16x16x64_bf16 v[40:43], v[16:19], a[72:79], v3
  v_smfmac_f32_16x16x64_bf16 v[40:43], v[20:23], a[80:87], v3
  v_smfmac_f32_16x16x64_bf16 v[40:43], v[24:27], a[88:95], v3
  v_smfmac_f32_16x16x64_bf16 v[40:43], v[28:31], a[96:103], v3
  v_smfmac_f32_16x16x64_bf16 v[40:43], v[32:35], a[104:111], v3
  v_smfmac_f32_16x16x64_bf16 v[44:47], v[8:11], a[112:119], v3
  v_smfmac_f32_16x16x64_bf16 v[44:47], v[12:15], a[120:127], v3
  v_smfmac_f32_16x16x64_bf16 v[44:47], v[16:19], a[128:135], v3
  v_smfmac_f32_16x16x64_bf16 v[44:47], v[20:23], a[136:143], v3
  v_permlane32_swap_b32 v36, v40
  v_smfmac_f32_16x16x64_bf16 v[44:47], v[24:27], a[144:151], v3
  v_permlane32_swap_b32 v37, v41
  v_smfmac_f32_16x16x64_bf16 v[44:47], v[28:31], a[152:159], v3
  v_permlane32_swap_b32 v38, v42
  v_smfmac_f32_16x16x64_bf16 v[44:47], v[32:35], a[160:167], v3
  v_permlane32_swap_b32 v39, v43
  v_smfmac_f32_16x16x64_bf16 v[48:51], v[8:11], a[168:175], v3
  v_add_f32 v36, v36, v40
  v_smfmac_f32_16x16x64_bf16 v[48:51], v[12:15], a[176:183], v3
  v_add_f32 v37, v37, v41
  v_smfmac_f32_16x16x64_bf16 v[48:51], v[16:19], a[184:191], v3
  v_add_f32 v38, v38, v42
  v_smfmac_f32_16x16x64_bf16 v[48:51], v[20:23], a[192:199], v3
  v_add_f32 v39, v39, v43
  v_smfmac_f32_16x16x64_bf16 v[48:51], v[24:27], a[200:207], v3
  v_cvt_pk_bf16_f32 v40, v36, v37
  v_smfmac_f32_16x16x64_bf16 v[48:51], v[28:31], a[208:215], v3
  v_cvt_pk_bf16_f32 v41, v38, v39
  v_smfmac_f32_16x16x64_bf16 v[48:51], v[32:35], a[216:223], v3
  ds_write_b64 v60, v[40:41]
  v_smfmac_f32_16x16x64_bf16 v[52:55], v[8:11], a[224:231], v3
  v_smfmac_f32_16x16x64_bf16 v[52:55], v[12:15], a[232:239], v3
  v_smfmac_f32_16x16x64_bf16 v[52:55], v[16:19], a[240:247], v3
  v_smfmac_f32_16x16x64_bf16 v[52:55], v[20:23], a[248:255], v3
  v_permlane32_swap_b32 v44, v48
  v_smfmac_f32_16x16x64_bf16 v[52:55], v[24:27], v[176:183], v3
  v_permlane32_swap_b32 v45, v49
  v_smfmac_f32_16x16x64_bf16 v[52:55], v[28:31], v[184:191], v3
  v_permlane32_swap_b32 v46, v50
  v_smfmac_f32_16x16x64_bf16 v[52:55], v[32:35], v[192:199], v3
  v_permlane32_swap_b32 v47, v51
  v_smfmac_f32_16x16x64_bf16 v[56:59], v[8:11], v[200:207], v3
  v_add_f32 v44, v44, v48
  v_smfmac_f32_16x16x64_bf16 v[56:59], v[12:15], v[208:215], v3
  v_add_f32 v45, v45, v49
  v_smfmac_f32_16x16x64_bf16 v[56:59], v[16:19], v[216:223], v3
  v_add_f32 v46, v46, v50
  v_smfmac_f32_16x16x64_bf16 v[56:59], v[20:23], v[224:231], v3
  v_add_f32 v47, v47, v51
  v_smfmac_f32_16x16x64_bf16 v[56:59], v[24:27], v[232:239], v3
  v_cvt_pk_bf16_f32 v48, v44, v45
  v_smfmac_f32_16x16x64_bf16 v[56:59], v[28:31], v[240:247], v3
  v_cvt_pk_bf16_f32 v49, v46, v47
  v_smfmac_f32_16x16x64_bf16 v[56:59], v[32:35], v[248:255], v3
  ds_write_b64 v61, v[48:49]
  s_nop 6
  v_permlane32_swap_b32 v52, v56
  v_permlane32_swap_b32 v53, v57
  v_permlane32_swap_b32 v54, v58
  v_permlane32_swap_b32 v55, v59
  v_add_f32 v52, v52, v56
  v_add_f32 v53, v53, v57
  v_add_f32 v54, v54, v58
  v_add_f32 v55, v55, v59
  v_cvt_pk_bf16_f32 v56, v52, v53
  v_cvt_pk_bf16_f32 v57, v54, v55
  ds_write_b64 v62, v[56:57]
  s_cmp_eq_u32 s19, 63
  s_cbranch_scc1 cB_va0_last
  s_add_u32 s22, s20, 9216
  s_add_u32 s34, s20, 13312
  s_add_u32 s36, s20, 7168
  s_mov_b32 s37, 0
  v_mov_b32 v156, 0
  v_mov_b32 v157, 0
  v_mov_b32 v158, 0
  v_mov_b32 v159, 0
  buffer_load_dword v164, v4, s[8:11], s20 offen sc1
  s_nop 7
  buffer_load_dword v165, v4, s[8:11], s20 offen sc1
  s_nop 7
  buffer_load_dword v166, v4, s[8:11], s20 offen sc1
  s_nop 7
  buffer_load_dword v167, v4, s[8:11], s20 offen sc1
  s_nop 7
  buffer_load_dword v168, v4, s[8:11], s20 offen sc1
cB_va0_fw_l:
  s_waitcnt vmcnt(4)
  v_cmp_eq_u32 vcc, -1, v164
  s_cbranch_vccz cB_va0_fw_d
  buffer_load_dword v164, v4, s[8:11], s20 offen sc1
  s_waitcnt vmcnt(4)
  v_cmp_eq_u32 vcc, -1, v165
  s_cbranch_vccz cB_va0_fw_d
  buffer_load_dword v165, v4, s[8:11], s20 offen sc1
  s_waitcnt vmcnt(4)
  v_cmp_eq_u32 vcc, -1, v166
  s_cbranch_vccz cB_va0_fw_d
  buffer_load_dword v166, v4, s[8:11], s20 offen sc1
  s_waitcnt vmcnt(4)
  v_cmp_eq_u32 vcc, -1, v167
  s_cbranch_vccz cB_va0_fw_d
  buffer_load_dword v167, v4, s[8:11], s20 offen sc1
  s_waitcnt vmcnt(4)
  v_cmp_eq_u32 vcc, -1, v168
  s_cbranch_vccz cB_va0_fw_d
  buffer_load_dword v168, v4, s[8:11], s20 offen sc1
  s_add_u32 s30, s30, 1
  s_cmp_lt_u32 s30, 400000
  s_cbranch_scc1 cB_va0_fw_l
  s_branch cB_abort
cB_va0_fw_d:
  s_waitcnt lgkmcnt(0)
  buffer_load_dwordx4 v[8:11], v2, s[8:11], s22 offen offset:0 sc1
  v_mov_b32 v36, 0
  v_mov_b32 v37, 0
  v_mov_b32 v38, 0
  buffer_load_dwordx4 v[12:15], v2, s[8:11], s22 offen offset:1024 sc1
  v_mov_b32 v39, 0
  v_mov_b32 v40, 0
  v_mov_b32 v41, 0
  buffer_load_dwordx4 v[16:19], v2, s[8:11], s22 offen offset:2048 sc1
  v_mov_b32 v42, 0
  v_mov_b32 v43, 0
  v_mov_b32 v44, 0
  buffer_load_dwordx4 v[20:23], v2, s[8:11], s22 offen offset:3072 sc1
  v_mov_b32 v45, 0
  v_mov_b32 v46, 0
  v_mov_b32 v47, 0
  buffer_load_dwordx4 v[24:27], v2, s[8:11], s34 offen offset:0 sc1
  v_mov_b32 v48, 0
  v_mov_b32 v49, 0
  v_mov_b32 v50, 0
  buffer_load_dwordx4 v[28:31], v2, s[8:11], s34 offen offset:1024 sc1
  v_mov_b32 v51, 0
  v_mov_b32 v52, 0
  v_mov_b32 v53, 0
  buffer_load_dwordx4 v[32:35], v2, s[8:11], s34 offen offset:2048 sc1
  v_mov_b32 v54, 0
  v_mov_b32 v55, 0
  v_mov_b32 v56, 0
  buffer_load_dwordx4 v[144:147], v2, s[8:11], s34 offen offset:3072 sc1
  v_mov_b32 v57, 0
  v_mov_b32 v58, 0
  v_mov_b32 v59, 0
  buffer_load_dwordx4 v[148:151], v2, s[8:11], s36 offen offset:0 sc1
  buffer_load_dwordx4 v[152:155], v2, s[8:11], s36 offen offset:1024 sc1
  s_barrier
  ds_read_b128 v[64:67], v2 offset:0
  ds_read_b128 v[68:71], v2 offset:1024
  ds_read_b128 v[72:75], v2 offset:2048
  ds_read_b128 v[76:79], v2 offset:3072
  s_waitcnt vmcnt(9)
  v_smfmac_f32_16x16x64_bf16 v[156:159], v[8:11], v[80:87], v3
  s_waitcnt vmcnt(8)
  v_smfmac_f32_16x16x64_bf16 v[156:159], v[12:15], v[88:95], v3
  s_waitcnt vmcnt(7)
  v_smfmac_f32_16x16x64_bf16 v[156:159], v[16:19], v[96:103], v3
  s_waitcnt vmcnt(6)
  v_smfmac_f32_16x16x64_bf16 v[156:159], v[20:23], v[104:111], v3
  s_waitcnt vmcnt(5)
  v_smfmac_f32_16x16x64_bf16 v[156:159], v[24:27], v[112:119], v3
  s_mov_b32 exec_hi, 0
  buffer_store_dword v2, v7, s[8:11], s21 offen sc1
  s_mov_b64 exec, -1
  s_waitcnt vmcnt(5)
  v_smfmac_f32_16x16x64_bf16 v[156:159], v[28:31], v[120:127], v3
  s_waitcnt vmcnt(4)
  v_smfmac_f32_16x16x64_bf16 v[156:159], v[32:35], v[128:135], v3
  s_waitcnt vmcnt(3)
  v_smfmac_f32_16x16x64_bf16 v[156:159], v[144:147], v[136:143], v3
  s_waitcnt vmcnt(2) lgkmcnt(0)
  v_smfmac_f32_16x16x64_bf16 v[156:159], v[148:151], v[64:71], v3
  s_waitcnt vmcnt(1)
  v_smfmac_f32_16x16x64_bf16 v[156:159], v[152:155], v[72:79], v3
cB_va0_ep:
  s_nop 7
  v_permlane32_swap_b32 v156, v158
  v_permlane32_swap_b32 v157, v159
  v_add_f32 v160, v156, v158
  v_add_f32 v161, v157, v159
  v_cmp_u_f32 vcc, v160, v161
  v_mov_b32_dpp v162, v160 row_ror:8 row_mask:0xf bank_mask:0xf
  v_mov_b32_dpp v160, v161 row_ror:8 row_mask:0xf bank_mask:0xc
  s_cbranch_vccnz cB_va0_rp
  v_mov_b32_dpp v161, v162 quad_perm:[0,1,2,3] row_mask:0xf bank_mask:0x3
  v_cvt_pk_bf16_f32 v160, v160, v161
cB_va0_pc:
  buffer_store_dword v160, v1, s[8:11], s21 offen sc1
  s_cmp_lg_u32 s19, 62
  s_cbranch_scc1 cB_va0_nl
  s_mov_b32 s22, 88519680
  buffer_store_dword v160, v1, s[8:11], s22 offen sc1
  s_mov_b64 exec, -1
  s_branch cB_done
cB_va0_nl:
  s_mov_b64 exec, -1
  s_add_u32 s25, s25, 28672
  s_add_u32 s19, s19, 1
  s_mov_b32 s20, s21
  s_branch cB_va0_loop
cB_va0_last:
  s_waitcnt lgkmcnt(0)
  s_barrier
  s_branch cB_done
cB_va0_rp:
  s_cmp_eq_u32 s37, 0
  s_cbranch_scc1 cB_va0_rv
  v_mov_b32_dpp v161, v162 quad_perm:[0,1,2,3] row_mask:0xf bank_mask:0x3
  v_cvt_pk_bf16_f32 v160, v160, v161
  v_min_u32 v160, -2, v160
  s_branch cB_va0_pc
cB_va0_rv:
  buffer_load_dwordx4 v[8:11], v2, s[8:11], s22 offen offset:0 sc1
  buffer_load_dwordx4 v[12:15], v2, s[8:11], s22 offen offset:1024 sc1
  buffer_load_dwordx4 v[16:19], v2, s[8:11], s22 offen offset:2048 sc1
  buffer_load_dwordx4 v[20:23], v2, s[8:11], s22 offen offset:3072 sc1
  buffer_load_dwordx4 v[24:27], v2, s[8:11], s34 offen offset:0 sc1
  buffer_load_dwordx4 v[28:31], v2, s[8:11], s34 offen offset:1024 sc1
  buffer_load_dwordx4 v[32:35], v2, s[8:11], s34 offen offset:2048 sc1
  buffer_load_dwordx4 v[144:147], v2, s[8:11], s34 offen offset:3072 sc1
  buffer_load_dwordx4 v[148:151], v2, s[8:11], s36 offen offset:0 sc1
  buffer_load_dwordx4 v[152:155], v2, s[8:11], s36 offen offset:1024 sc1
  s_waitcnt vmcnt(0)
  v_max3_u32 v63, v8, v9, v10
  v_max3_u32 v63, v63, v11, v12
  v_max3_u32 v63, v63, v13, v14
  v_max3_u32 v63, v63, v15, v16
  v_max3_u32 v63, v63, v17, v18
  v_max3_u32 v63, v63, v19, v20
  v_max3_u32 v63, v63, v21, v22
  v_max3_u32 v63, v63, v23, v24
  v_max3_u32 v63, v63, v25, v26
  v_max3_u32 v63, v63, v27, v28
  v_max3_u32 v63, v63, v29, v30
  v_max3_u32 v63, v63, v31, v32
  v_max3_u32 v63, v63, v33, v34
  v_max3_u32 v63, v63, v35, v144
  v_max3_u32 v63, v63, v145, v146
  v_max3_u32 v63, v63, v147, v148
  v_max3_u32 v63, v63, v149, v150
  v_max3_u32 v63, v63, v151, v152
  v_max3_u32 v63, v63, v153, v154
  v_max_u32 v63, v63, v155
  v_cmp_eq_u32 vcc, -1, v63
  s_cbranch_vccz cB_va0_rk
  s_add_u32 s30, s30, 1
  s_cmp_lt_u32 s30, 400000
  s_cbranch_scc1 cB_va0_rv
  s_branch cB_abort
cB_va0_rk:
  s_mov_b32 s37, 1
  s_add_u32 s31, s31, 0x10000
  v_mov_b32 v156, 0
  v_mov_b32 v157, 0
  v_mov_b32 v158, 0
  v_mov_b32 v159, 0
  s_nop 1
  v_smfmac_f32_16x16x64_bf16 v[156:159], v[8:11], v[80:87], v3
  v_smfmac_f32_16x16x64_bf16 v[156:159], v[12:15], v[88:95], v3
  v_smfmac_f32_16x16x64_bf16 v[156:159], v[16:19], v[96:103], v3
  v_smfmac_f32_16x16x64_bf16 v[156:159], v[20:23], v[104:111], v3
  v_smfmac_f32_16x16x64_bf16 v[156:159], v[24:27], v[112:119], v3
  v_smfmac_f32_16x16x64_bf16 v[156:159], v[28:31], v[120:127], v3
  v_smfmac_f32_16x16x64_bf16 v[156:159], v[32:35], v[128:135], v3
  v_smfmac_f32_16x16x64_bf16 v[156:159], v[144:147], v[136:143], v3
  v_smfmac_f32_16x16x64_bf16 v[156:159], v[148:151], v[64:71], v3
  v_smfmac_f32_16x16x64_bf16 v[156:159], v[152:155], v[72:79], v3
  s_nop 7
  s_branch cB_va0_ep
cB_va1_loop:
  s_add_u32 s23, s20, 4096
  s_add_u32 s21, s20, 25600
  s_mov_b32 s30, 0
  s_cmp_lg_u32 s19, s38
  s_cbranch_scc1 cB_va1_vok
  s_branch cB_va1_voc
cB_va1_vow:
  buffer_load_dword v175, off, s[8:11], s35 sc1
  s_waitcnt vmcnt(0)
cB_va1_voc:
  v_readfirstlane_b32 s22, v175
  s_cmp_eq_u32 s22, 56
  s_cbranch_scc1 cB_va1_vod
  s_sleep 1
  s_add_u32 s30, s30, 1
  s_cmp_lt_u32 s30, 400000
  s_cbranch_scc1 cB_va1_vow
  s_branch cB_abort
cB_va1_vod:
  s_add_u32 s35, s35, 2048
  s_add_u32 s38, s19, 8
  s_and_b32 s38, s38, -8
  s_cmp_eq_u32 s19, 0
  s_cselect_b32 s38, 4, s38
cB_va1_vok:
  s_cmp_eq_u32 s19, 63
  s_cbranch_scc1 cB_done
  s_barrier
  s_add_u32 s22, s25, 0
  buffer_load_dwordx4 v[80:83], v6, s[8:11], s22 offen offset:0 sc1
  buffer_load_dwordx4 v[84:87], v6, s[8:11], s22 offen offset:1792 sc1
  s_add_u32 s22, s25, 3584
  buffer_load_dwordx4 v[88:91], v6, s[8:11], s22 offen offset:0 sc1
  buffer_load_dwordx4 v[92:95], v6, s[8:11], s22 offen offset:1792 sc1
  s_add_u32 s22, s25, 7168
  buffer_load_dwordx4 v[96:99], v6, s[8:11], s22 offen offset:0 sc1
  buffer_load_dwordx4 v[100:103], v6, s[8:11], s22 offen offset:1792 sc1
  s_add_u32 s22, s25, 10752
  buffer_load_dwordx4 v[104:107], v6, s[8:11], s22 offen offset:0 sc1
  buffer_load_dwordx4 v[108:111], v6, s[8:11], s22 offen offset:1792 sc1
  s_add_u32 s22, s25, 14336
  buffer_load_dwordx4 v[112:115], v6, s[8:11], s22 offen offset:0 sc1
  buffer_load_dwordx4 v[116:119], v6, s[8:11], s22 offen offset:1792 sc1
  s_add_u32 s22, s25, 17920
  buffer_load_dwordx4 v[120:123], v6, s[8:11], s22 offen offset:0 sc1
  buffer_load_dwordx4 v[124:127], v6, s[8:11], s22 offen offset:1792 sc1
  s_add_u32 s22, s25, 21504
  buffer_load_dwordx4 v[128:131], v6, s[8:11], s22 offen offset:0 sc1
  buffer_load_dwordx4 v[132:135], v6, s[8:11], s22 offen offset:1792 sc1
  s_add_u32 s22, s25, 25088
  buffer_load_dwordx4 v[136:139], v6, s[8:11], s22 offen offset:0 sc1
  buffer_load_dwordx4 v[140:143], v6, s[8:11], s22 offen offset:1792 sc1
  buffer_load_dword v175, off, s[8:11], s35 sc1
  s_barrier
  ds_read_b128 v[8:11], v2 offset:8192
  ds_read_b128 v[12:15], v2 offset:9216
  ds_read_b128 v[16:19], v2 offset:10240
  ds_read_b128 v[20:23], v2 offset:11264
  ds_read_b128 v[24:27], v2 offset:12288
  ds_read_b128 v[28:31], v2 offset:13312
  ds_read_b128 v[32:35], v2 offset:14336
  s_waitcnt lgkmcnt(0)
  v_smfmac_f32_16x16x64_bf16 v[36:39], v[8:11], a[0:7], v3
  v_smfmac_f32_16x16x64_bf16 v[36:39], v[12:15], a[8:15], v3
  v_smfmac_f32_16x16x64_bf16 v[36:39], v[16:19], a[16:23], v3
  v_smfmac_f32_16x16x64_bf16 v[36:39], v[20:23], a[24:31], v3
  v_smfmac_f32_16x16x64_bf16 v[36:39], v[24:27], a[32:39], v3
  v_smfmac_f32_16x16x64_bf16 v[36:39], v[28:31], a[40:47], v3
  v_smfmac_f32_16x16x64_bf16 v[36:39], v[32:35], a[48:55], v3
  v_smfmac_f32_16x16x64_bf16 v[40:43], v[8:11], a[56:63], v3
  v_smfmac_f32_16x16x64_bf16 v[40:43], v[12:15], a[64:71], v3
  v_smfmac_f32_16x16x64_bf16 v[40:43], v[16:19], a[72:79], v3
  v_smfmac_f32_16x16x64_bf16 v[40:43], v[20:23], a[80:87], v3
  v_smfmac_f32_16x16x64_bf16 v[40:43], v[24:27], a[88:95], v3
  v_smfmac_f32_16x16x64_bf16 v[40:43], v[28:31], a[96:103], v3
  v_smfmac_f32_16x16x64_bf16 v[40:43], v[32:35], a[104:111], v3
  v_smfmac_f32_16x16x64_bf16 v[44:47], v[8:11], a[112:119], v3
  v_smfmac_f32_16x16x64_bf16 v[44:47], v[12:15], a[120:127], v3
  v_smfmac_f32_16x16x64_bf16 v[44:47], v[16:19], a[128:135], v3
  v_smfmac_f32_16x16x64_bf16 v[44:47], v[20:23], a[136:143], v3
  v_permlane32_swap_b32 v36, v40
  v_smfmac_f32_16x16x64_bf16 v[44:47], v[24:27], a[144:151], v3
  v_permlane32_swap_b32 v37, v41
  v_smfmac_f32_16x16x64_bf16 v[44:47], v[28:31], a[152:159], v3
  v_permlane32_swap_b32 v38, v42
  v_smfmac_f32_16x16x64_bf16 v[44:47], v[32:35], a[160:167], v3
  v_permlane32_swap_b32 v39, v43
  v_smfmac_f32_16x16x64_bf16 v[48:51], v[8:11], a[168:175], v3
  v_add_f32 v36, v36, v40
  v_smfmac_f32_16x16x64_bf16 v[48:51], v[12:15], a[176:183], v3
  v_add_f32 v37, v37, v41
  v_smfmac_f32_16x16x64_bf16 v[48:51], v[16:19], a[184:191], v3
  v_add_f32 v38, v38, v42
  v_smfmac_f32_16x16x64_bf16 v[48:51], v[20:23], a[192:199], v3
  v_add_f32 v39, v39, v43
  v_smfmac_f32_16x16x64_bf16 v[48:51], v[24:27], a[200:207], v3
  v_cvt_pk_bf16_f32 v40, v36, v37
  v_smfmac_f32_16x16x64_bf16 v[48:51], v[28:31], a[208:215], v3
  v_cvt_pk_bf16_f32 v41, v38, v39
  v_smfmac_f32_16x16x64_bf16 v[48:51], v[32:35], a[216:223], v3
  ds_write_b64 v60, v[40:41]
  v_smfmac_f32_16x16x64_bf16 v[52:55], v[8:11], a[224:231], v3
  v_smfmac_f32_16x16x64_bf16 v[52:55], v[12:15], a[232:239], v3
  v_smfmac_f32_16x16x64_bf16 v[52:55], v[16:19], a[240:247], v3
  v_smfmac_f32_16x16x64_bf16 v[52:55], v[20:23], a[248:255], v3
  v_permlane32_swap_b32 v44, v48
  v_smfmac_f32_16x16x64_bf16 v[52:55], v[24:27], v[176:183], v3
  v_permlane32_swap_b32 v45, v49
  v_smfmac_f32_16x16x64_bf16 v[52:55], v[28:31], v[184:191], v3
  v_permlane32_swap_b32 v46, v50
  v_smfmac_f32_16x16x64_bf16 v[52:55], v[32:35], v[192:199], v3
  v_permlane32_swap_b32 v47, v51
  v_smfmac_f32_16x16x64_bf16 v[56:59], v[8:11], v[200:207], v3
  v_add_f32 v44, v44, v48
  v_smfmac_f32_16x16x64_bf16 v[56:59], v[12:15], v[208:215], v3
  v_add_f32 v45, v45, v49
  v_smfmac_f32_16x16x64_bf16 v[56:59], v[16:19], v[216:223], v3
  v_add_f32 v46, v46, v50
  v_smfmac_f32_16x16x64_bf16 v[56:59], v[20:23], v[224:231], v3
  v_add_f32 v47, v47, v51
  v_smfmac_f32_16x16x64_bf16 v[56:59], v[24:27], v[232:239], v3
  v_cvt_pk_bf16_f32 v48, v44, v45
  v_smfmac_f32_16x16x64_bf16 v[56:59], v[28:31], v[240:247], v3
  v_cvt_pk_bf16_f32 v49, v46, v47
  v_smfmac_f32_16x16x64_bf16 v[56:59], v[32:35], v[248:255], v3
  ds_write_b64 v61, v[48:49]
  s_nop 6
  v_permlane32_swap_b32 v52, v56
  v_permlane32_swap_b32 v53, v57
  v_permlane32_swap_b32 v54, v58
  v_permlane32_swap_b32 v55, v59
  v_add_f32 v52, v52, v56
  v_add_f32 v53, v53, v57
  v_add_f32 v54, v54, v58
  v_add_f32 v55, v55, v59
  v_cvt_pk_bf16_f32 v56, v52, v53
  v_cvt_pk_bf16_f32 v57, v54, v55
  ds_write_b64 v62, v[56:57]
  s_cmp_eq_u32 s19, 63
  s_cbranch_scc1 cB_va1_last
  s_add_u32 s22, s20, 9216
  s_add_u32 s34, s20, 13312
  s_add_u32 s36, s20, 7168
  s_mov_b32 s37, 0
  v_mov_b32 v156, 0
  v_mov_b32 v157, 0
  v_mov_b32 v158, 0
  v_mov_b32 v159, 0
  buffer_load_dword v164, v4, s[8:11], s20 offen sc1
  s_nop 7
  buffer_load_dword v165, v4, s[8:11], s20 offen sc1
  s_nop 7
  buffer_load_dword v166, v4, s[8:11], s20 offen sc1
  s_nop 7
  buffer_load_dword v167, v4, s[8:11], s20 offen sc1
  s_nop 7
  buffer_load_dword v168, v4, s[8:11], s20 offen sc1
cB_va1_fw_l:
  s_waitcnt vmcnt(4)
  v_cmp_eq_u32 vcc, -1, v164
  s_cbranch_vccz cB_va1_fw_d
  buffer_load_dword v164, v4, s[8:11], s20 offen sc1
  s_waitcnt vmcnt(4)
  v_cmp_eq_u32 vcc, -1, v165
  s_cbranch_vccz cB_va1_fw_d
  buffer_load_dword v165, v4, s[8:11], s20 offen sc1
  s_waitcnt vmcnt(4)
  v_cmp_eq_u32 vcc, -1, v166
  s_cbranch_vccz cB_va1_fw_d
  buffer_load_dword v166, v4, s[8:11], s20 offen sc1
  s_waitcnt vmcnt(4)
  v_cmp_eq_u32 vcc, -1, v167
  s_cbranch_vccz cB_va1_fw_d
  buffer_load_dword v167, v4, s[8:11], s20 offen sc1
  s_waitcnt vmcnt(4)
  v_cmp_eq_u32 vcc, -1, v168
  s_cbranch_vccz cB_va1_fw_d
  buffer_load_dword v168, v4, s[8:11], s20 offen sc1
  s_add_u32 s30, s30, 1
  s_cmp_lt_u32 s30, 400000
  s_cbranch_scc1 cB_va1_fw_l
  s_branch cB_abort
cB_va1_fw_d:
  s_waitcnt lgkmcnt(0)
  buffer_load_dwordx4 v[8:11], v2, s[8:11], s22 offen offset:0 sc1
  v_mov_b32 v36, 0
  v_mov_b32 v37, 0
  v_mov_b32 v38, 0
  buffer_load_dwordx4 v[12:15], v2, s[8:11], s22 offen offset:1024 sc1
  v_mov_b32 v39, 0
  v_mov_b32 v40, 0
  v_mov_b32 v41, 0
  buffer_load_dwordx4 v[16:19], v2, s[8:11], s22 offen offset:2048 sc1
  v_mov_b32 v42, 0
  v_mov_b32 v43, 0
  v_mov_b32 v44, 0
  buffer_load_dwordx4 v[20:23], v2, s[8:11], s22 offen offset:3072 sc1
  v_mov_b32 v45, 0
  v_mov_b32 v46, 0
  v_mov_b32 v47, 0
  buffer_load_dwordx4 v[24:27], v2, s[8:11], s34 offen offset:0 sc1
  v_mov_b32 v48, 0
  v_mov_b32 v49, 0
  v_mov_b32 v50, 0
  buffer_load_dwordx4 v[28:31], v2, s[8:11], s34 offen offset:1024 sc1
  v_mov_b32 v51, 0
  v_mov_b32 v52, 0
  v_mov_b32 v53, 0
  buffer_load_dwordx4 v[32:35], v2, s[8:11], s34 offen offset:2048 sc1
  v_mov_b32 v54, 0
  v_mov_b32 v55, 0
  v_mov_b32 v56, 0
  buffer_load_dwordx4 v[144:147], v2, s[8:11], s34 offen offset:3072 sc1
  v_mov_b32 v57, 0
  v_mov_b32 v58, 0
  v_mov_b32 v59, 0
  buffer_load_dwordx4 v[148:151], v2, s[8:11], s36 offen offset:0 sc1
  buffer_load_dwordx4 v[152:155], v2, s[8:11], s36 offen offset:1024 sc1
  s_barrier
  ds_read_b128 v[64:67], v2 offset:4096
  ds_read_b128 v[68:71], v2 offset:5120
  ds_read_b128 v[72:75], v2 offset:6144
  ds_read_b128 v[76:79], v2 offset:7168
  s_waitcnt vmcnt(9)
  v_smfmac_f32_16x16x64_bf16 v[156:159], v[8:11], v[80:87], v3
  s_waitcnt vmcnt(8)
  v_smfmac_f32_16x16x64_bf16 v[156:159], v[12:15], v[88:95], v3
  s_waitcnt vmcnt(7)
  v_smfmac_f32_16x16x64_bf16 v[156:159], v[16:19], v[96:103], v3
  s_waitcnt vmcnt(6)
  v_smfmac_f32_16x16x64_bf16 v[156:159], v[20:23], v[104:111], v3
  s_waitcnt vmcnt(5)
  v_smfmac_f32_16x16x64_bf16 v[156:159], v[24:27], v[112:119], v3
  s_mov_b32 exec_hi, 0
  buffer_store_dword v2, v7, s[8:11], s21 offen sc1
  s_mov_b64 exec, -1
  s_waitcnt vmcnt(5)
  v_smfmac_f32_16x16x64_bf16 v[156:159], v[28:31], v[120:127], v3
  s_waitcnt vmcnt(4)
  v_smfmac_f32_16x16x64_bf16 v[156:159], v[32:35], v[128:135], v3
  s_waitcnt vmcnt(3)
  v_smfmac_f32_16x16x64_bf16 v[156:159], v[144:147], v[136:143], v3
  s_waitcnt vmcnt(2) lgkmcnt(0)
  v_smfmac_f32_16x16x64_bf16 v[156:159], v[148:151], v[64:71], v3
  s_waitcnt vmcnt(1)
  v_smfmac_f32_16x16x64_bf16 v[156:159], v[152:155], v[72:79], v3
cB_va1_ep:
  s_nop 7
  v_permlane32_swap_b32 v156, v158
  v_permlane32_swap_b32 v157, v159
  v_add_f32 v160, v156, v158
  v_add_f32 v161, v157, v159
  v_cmp_u_f32 vcc, v160, v161
  v_mov_b32_dpp v162, v160 row_ror:8 row_mask:0xf bank_mask:0xf
  v_mov_b32_dpp v160, v161 row_ror:8 row_mask:0xf bank_mask:0xc
  s_cbranch_vccnz cB_va1_rp
  v_mov_b32_dpp v161, v162 quad_perm:[0,1,2,3] row_mask:0xf bank_mask:0x3
  v_cvt_pk_bf16_f32 v160, v160, v161
cB_va1_pc:
  s_mov_b64 exec, s[26:27]
  buffer_store_dword v160, v1, s[8:11], s21 offen sc1
  s_cmp_lg_u32 s19, 62
  s_cbranch_scc1 cB_va1_nl
  s_mov_b32 s22, 88519680
  buffer_store_dword v160, v1, s[8:11], s22 offen sc1
  s_mov_b64 exec, -1
  s_branch cB_done
cB_va1_nl:
  s_mov_b64 exec, -1
  s_add_u32 s25, s25, 28672
  s_add_u32 s19, s19, 1
  s_mov_b32 s20, s21
  s_branch cB_va1_loop
cB_va1_last:
  s_waitcnt lgkmcnt(0)
  s_barrier
  s_branch cB_done
cB_va1_rp:
  s_cmp_eq_u32 s37, 0
  s_cbranch_scc1 cB_va1_rv
  v_mov_b32_dpp v161, v162 quad_perm:[0,1,2,3] row_mask:0xf bank_mask:0x3
  v_cvt_pk_bf16_f32 v160, v160, v161
  v_min_u32 v160, -2, v160
  s_branch cB_va1_pc
cB_va1_rv:
  buffer_load_dwordx4 v[8:11], v2, s[8:11], s22 offen offset:0 sc1
  buffer_load_dwordx4 v[12:15], v2, s[8:11], s22 offen offset:1024 sc1
  buffer_load_dwordx4 v[16:19], v2, s[8:11], s22 offen offset:2048 sc1
  buffer_load_dwordx4 v[20:23], v2, s[8:11], s22 offen offset:3072 sc1
  buffer_load_dwordx4 v[24:27], v2, s[8:11], s34 offen offset:0 sc1
  buffer_load_dwordx4 v[28:31], v2, s[8:11], s34 offen offset:1024 sc1
  buffer_load_dwordx4 v[32:35], v2, s[8:11], s34 offen offset:2048 sc1
  buffer_load_dwordx4 v[144:147], v2, s[8:11], s34 offen offset:3072 sc1
  buffer_load_dwordx4 v[148:151], v2, s[8:11], s36 offen offset:0 sc1
  buffer_load_dwordx4 v[152:155], v2, s[8:11], s36 offen offset:1024 sc1
  s_waitcnt vmcnt(0)
  v_max3_u32 v63, v8, v9, v10
  v_max3_u32 v63, v63, v11, v12
  v_max3_u32 v63, v63, v13, v14
  v_max3_u32 v63, v63, v15, v16
  v_max3_u32 v63, v63, v17, v18
  v_max3_u32 v63, v63, v19, v20
  v_max3_u32 v63, v63, v21, v22
  v_max3_u32 v63, v63, v23, v24
  v_max3_u32 v63, v63, v25, v26
  v_max3_u32 v63, v63, v27, v28
  v_max3_u32 v63, v63, v29, v30
  v_max3_u32 v63, v63, v31, v32
  v_max3_u32 v63, v63, v33, v34
  v_max3_u32 v63, v63, v35, v144
  v_max3_u32 v63, v63, v145, v146
  v_max3_u32 v63, v63, v147, v148
  v_max3_u32 v63, v63, v149, v150
  v_max3_u32 v63, v63, v151, v152
  v_max3_u32 v63, v63, v153, v154
  v_max_u32 v63, v63, v155
  v_cmp_eq_u32 vcc, -1, v63
  s_cbranch_vccz cB_va1_rk
  s_add_u32 s30, s30, 1
  s_cmp_lt_u32 s30, 400000
  s_cbranch_scc1 cB_va1_rv
  s_branch cB_abort
cB_va1_rk:
  s_mov_b32 s37, 1
  s_add_u32 s31, s31, 0x10000
  v_mov_b32 v156, 0
  v_mov_b32 v157, 0
  v_mov_b32 v158, 0
  v_mov_b32 v159, 0
  s_nop 1
  v_smfmac_f32_16x16x64_bf16 v[156:159], v[8:11], v[80:87], v3
  v_smfmac_f32_16x16x64_bf16 v[156:159], v[12:15], v[88:95], v3
  v_smfmac_f32_16x16x64_bf16 v[156:159], v[16:19], v[96:103], v3
  v_smfmac_f32_16x16x64_bf16 v[156:159], v[20:23], v[104:111], v3
  v_smfmac_f32_16x16x64_bf16 v[156:159], v[24:27], v[112:119], v3
  v_smfmac_f32_16x16x64_bf16 v[156:159], v[28:31], v[120:127], v3
  v_smfmac_f32_16x16x64_bf16 v[156:159], v[32:35], v[128:135], v3
  v_smfmac_f32_16x16x64_bf16 v[156:159], v[144:147], v[136:143], v3
  v_smfmac_f32_16x16x64_bf16 v[156:159], v[148:151], v[64:71], v3
  v_smfmac_f32_16x16x64_bf16 v[156:159], v[152:155], v[72:79], v3
  s_nop 7
  s_branch cB_va1_ep
cB_va2_loop:
  s_add_u32 s23, s20, 4096
  s_add_u32 s21, s20, 25600
  v_mov_b32 v36, 0
  v_mov_b32 v37, 0
  v_mov_b32 v38, 0
  v_mov_b32 v39, 0
  v_mov_b32 v40, 0
  v_mov_b32 v41, 0
  v_mov_b32 v42, 0
  v_mov_b32 v43, 0
  v_mov_b32 v44, 0
  v_mov_b32 v45, 0
  v_mov_b32 v46, 0
  v_mov_b32 v47, 0
  v_mov_b32 v48, 0
  v_mov_b32 v49, 0
  v_mov_b32 v50, 0
  v_mov_b32 v51, 0
  v_mov_b32 v52, 0
  v_mov_b32 v53, 0
  v_mov_b32 v54, 0
  v_mov_b32 v55, 0
  v_mov_b32 v56, 0
  v_mov_b32 v57, 0
  v_mov_b32 v58, 0
  v_mov_b32 v59, 0
  v_mov_b32 v60, 0
  v_mov_b32 v61, 0
  v_mov_b32 v62, 0
  v_mov_b32 v63, 0
  v_mov_b32 v64, 0
  v_mov_b32 v65, 0
  v_mov_b32 v66, 0
  v_mov_b32 v67, 0
  s_mov_b32 s30, 0
  buffer_load_dword v76, v119, s[8:11], s20 offen sc1
  buffer_load_dword v77, v119, s[8:11], s20 offen sc1
  buffer_load_dword v78, v119, s[8:11], s20 offen sc1
cB_va2_fp_l:
  s_waitcnt vmcnt(2)
  v_cmp_eq_u32 vcc, -1, v76
  s_cbranch_vccz cB_va2_fp_d
  buffer_load_dword v76, v119, s[8:11], s20 offen sc1
  s_waitcnt vmcnt(2)
  v_cmp_eq_u32 vcc, -1, v77
  s_cbranch_vccz cB_va2_fp_d
  buffer_load_dword v77, v119, s[8:11], s20 offen sc1
  s_waitcnt vmcnt(2)
  v_cmp_eq_u32 vcc, -1, v78
  s_cbranch_vccz cB_va2_fp_d
  buffer_load_dword v78, v119, s[8:11], s20 offen sc1
  s_add_u32 s30, s30, 1
  s_cmp_lt_u32 s30, 400000
  s_cbranch_scc1 cB_va2_fp_l
  s_branch cB_abort
cB_va2_fp_d:
  buffer_load_dwordx4 v[8:11], v2, s[8:11], s20 offen offset:0 sc1
  buffer_load_dwordx4 v[12:15], v2, s[8:11], s20 offen offset:1024 sc1
  buffer_load_dwordx4 v[16:19], v2, s[8:11], s20 offen offset:2048 sc1
  buffer_load_dwordx4 v[20:23], v2, s[8:11], s20 offen offset:3072 sc1
  s_barrier
cB_va2_ld:
  s_waitcnt vmcnt(0)
  v_max3_u32 v84, v8, v9, v10
  v_max3_u32 v84, v84, v11, v12
  v_max3_u32 v84, v84, v13, v14
  v_max3_u32 v84, v84, v15, v16
  v_max3_u32 v84, v84, v17, v18
  v_max3_u32 v84, v84, v19, v20
  v_max3_u32 v84, v84, v21, v22
  v_max_u32 v84, v84, v23
  v_cmp_eq_u32 vcc, -1, v84
  ds_write_b128 v2, v[8:11] offset:8192
  ds_write_b128 v2, v[12:15] offset:9216
  ds_write_b128 v2, v[16:19] offset:10240
  ds_write_b128 v2, v[20:23] offset:11264
  s_cbranch_vccnz cB_va2_retry
  s_waitcnt lgkmcnt(0)
  s_barrier
  ds_read_b128 v[24:27], v2 offset:12288
  ds_read_b128 v[28:31], v2 offset:13312
  ds_read_b128 v[32:35], v2 offset:14336
  ds_read_b128 v[92:95], v0
  s_waitcnt lgkmcnt(0)
  s_mov_b64 exec, s[26:27]
  buffer_store_dwordx4 v[92:95], v2, s[8:11], s36 offen sc1
  s_mov_b64 exec, -1
  s_add_u32 s36, s36, 7168
  s_cmp_eq_u32 s19, 63
  s_cbranch_scc1 cB_done
  ds_read_b128 v[76:79], v1 offset:0
  ds_read_b128 v[80:83], v1 offset:1024
  ds_read_b128 v[84:87], v1 offset:2048
  ds_read_b128 v[88:91], v1 offset:3072
  ds_read_b128 v[92:95], v1 offset:4096
  ds_read_b128 v[96:99], v1 offset:5120
  v_smfmac_f32_16x16x64_bf16 v[60:63], v[8:11], v[200:207], v3
  v_smfmac_f32_16x16x64_bf16 v[60:63], v[12:15], v[208:215], v3
  s_waitcnt lgkmcnt(4)
  v_smfmac_f32_16x16x64_bf16 v[64:67], v[8:11], v[76:83], v3
  ds_read_b128 v[76:79], v1 offset:6144
  ds_read_b128 v[80:83], v1 offset:7168
  v_smfmac_f32_16x16x64_bf16 v[60:63], v[16:19], v[216:223], v3
  v_smfmac_f32_16x16x64_bf16 v[60:63], v[20:23], v[224:231], v3
  s_waitcnt lgkmcnt(4)
  v_smfmac_f32_16x16x64_bf16 v[64:67], v[12:15], v[84:91], v3
  ds_read_b128 v[84:87], v1 offset:8192
  ds_read_b128 v[88:91], v1 offset:9216
  v_smfmac_f32_16x16x64_bf16 v[60:63], v[24:27], v[232:239], v3
  v_smfmac_f32_16x16x64_bf16 v[60:63], v[28:31], v[240:247], v3
  s_waitcnt lgkmcnt(4)
  v_smfmac_f32_16x16x64_bf16 v[64:67], v[16:19], v[92:99], v3
  ds_read_b128 v[92:95], v1 offset:10240
  ds_read_b128 v[96:99], v1 offset:11264
  v_smfmac_f32_16x16x64_bf16 v[60:63], v[32:35], v[248:255], v3
  v_smfmac_f32_16x16x64_bf16 v[36:39], v[8:11], a[0:7], v3
  s_waitcnt lgkmcnt(4)
  v_smfmac_f32_16x16x64_bf16 v[64:67], v[20:23], v[76:83], v3
  ds_read_b128 v[76:79], v1 offset:12288
  ds_read_b128 v[80:83], v1 offset:13312
  v_smfmac_f32_16x16x64_bf16 v[36:39], v[12:15], a[8:15], v3
  v_smfmac_f32_16x16x64_bf16 v[36:39], v[16:19], a[16:23], v3
  s_waitcnt lgkmcnt(4)
  v_smfmac_f32_16x16x64_bf16 v[64:67], v[24:27], v[84:91], v3
  v_smfmac_f32_16x16x64_bf16 v[36:39], v[20:23], a[24:31], v3
  v_smfmac_f32_16x16x64_bf16 v[36:39], v[24:27], a[32:39], v3
  s_waitcnt lgkmcnt(2)
  v_smfmac_f32_16x16x64_bf16 v[64:67], v[28:31], v[92:99], v3
  v_smfmac_f32_16x16x64_bf16 v[36:39], v[28:31], a[40:47], v3
  v_smfmac_f32_16x16x64_bf16 v[36:39], v[32:35], a[48:55], v3
  s_waitcnt lgkmcnt(0)
  v_smfmac_f32_16x16x64_bf16 v[64:67], v[32:35], v[76:83], v3
  v_smfmac_f32_16x16x64_bf16 v[40:43], v[8:11], a[56:63], v3
  v_smfmac_f32_16x16x64_bf16 v[40:43], v[12:15], a[64:71], v3
  v_smfmac_f32_16x16x64_bf16 v[40:43], v[16:19], a[72:79], v3
  v_smfmac_f32_16x16x64_bf16 v[40:43], v[20:23], a[80:87], v3
  v_permlane32_swap_b32 v60, v64
  v_smfmac_f32_16x16x64_bf16 v[40:43], v[24:27], a[88:95], v3
  v_permlane32_swap_b32 v61, v65
  v_smfmac_f32_16x16x64_bf16 v[40:43], v[28:31], a[96:103], v3
  v_permlane32_swap_b32 v62, v66
  v_smfmac_f32_16x16x64_bf16 v[40:43], v[32:35], a[104:111], v3
  v_permlane32_swap_b32 v63, v67
  v_smfmac_f32_16x16x64_bf16 v[44:47], v[8:11], a[112:119], v3
  v_smfmac_f32_16x16x64_bf16 v[44:47], v[12:15], a[120:127], v3
  v_smfmac_f32_16x16x64_bf16 v[44:47], v[16:19], a[128:135], v3
  v_smfmac_f32_16x16x64_bf16 v[44:47], v[20:23], a[136:143], v3
  v_add_f32 v60, v60, v64
  v_add_f32 v61, v61, v65
  v_smfmac_f32_16x16x64_bf16 v[44:47], v[24:27], a[144:151], v3
  v_add_f32 v62, v62, v66
  v_add_f32 v63, v63, v67
  v_smfmac_f32_16x16x64_bf16 v[44:47], v[28:31], a[152:159], v3
  v_cvt_pk_bf16_f32 v64, v60, v61
  v_cvt_pk_bf16_f32 v65, v62, v63
  v_smfmac_f32_16x16x64_bf16 v[44:47], v[32:35], a[160:167], v3
  ds_write_b64 v115, v[64:65]
  v_smfmac_f32_16x16x64_bf16 v[48:51], v[8:11], a[168:175], v3
  v_permlane32_swap_b32 v36, v40
  v_smfmac_f32_16x16x64_bf16 v[48:51], v[12:15], a[176:183], v3
  v_permlane32_swap_b32 v37, v41
  v_smfmac_f32_16x16x64_bf16 v[48:51], v[16:19], a[184:191], v3
  v_permlane32_swap_b32 v38, v42
  v_smfmac_f32_16x16x64_bf16 v[48:51], v[20:23], a[192:199], v3
  v_permlane32_swap_b32 v39, v43
  v_smfmac_f32_16x16x64_bf16 v[48:51], v[24:27], a[200:207], v3
  v_add_f32 v36, v36, v40
  v_smfmac_f32_16x16x64_bf16 v[48:51], v[28:31], a[208:215], v3
  v_add_f32 v37, v37, v41
  v_smfmac_f32_16x16x64_bf16 v[48:51], v[32:35], a[216:223], v3
  v_add_f32 v38, v38, v42
  v_smfmac_f32_16x16x64_bf16 v[52:55], v[8:11], a[224:231], v3
  v_smfmac_f32_16x16x64_bf16 v[52:55], v[12:15], a[232:239], v3
  v_smfmac_f32_16x16x64_bf16 v[52:55], v[16:19], a[240:247], v3
  v_smfmac_f32_16x16x64_bf16 v[52:55], v[20:23], a[248:255], v3
  v_add_f32 v39, v39, v43
  v_cvt_pk_bf16_f32 v40, v36, v37
  v_smfmac_f32_16x16x64_bf16 v[52:55], v[24:27], v[120:127], v3
  v_cvt_pk_bf16_f32 v41, v38, v39
  v_smfmac_f32_16x16x64_bf16 v[52:55], v[28:31], v[128:135], v3
  ds_write_b64 v112, v[40:41]
  v_smfmac_f32_16x16x64_bf16 v[52:55], v[32:35], v[136:143], v3
  v_permlane32_swap_b32 v44, v48
  v_smfmac_f32_16x16x64_bf16 v[56:59], v[8:11], v[144:151], v3
  v_permlane32_swap_b32 v45, v49
  v_smfmac_f32_16x16x64_bf16 v[56:59], v[12:15], v[152:159], v3
  v_permlane32_swap_b32 v46, v50
  v_smfmac_f32_16x16x64_bf16 v[56:59], v[16:19], v[160:167], v3
  v_permlane32_swap_b32 v47, v51
  v_smfmac_f32_16x16x64_bf16 v[56:59], v[20:23], v[168:175], v3
  v_add_f32 v44, v44, v48
  v_smfmac_f32_16x16x64_bf16 v[56:59], v[24:27], v[176:183], v3
  v_add_f32 v45, v45, v49
  v_smfmac_f32_16x16x64_bf16 v[56:59], v[28:31], v[184:191], v3
  v_add_f32 v46, v46, v50
  v_smfmac_f32_16x16x64_bf16 v[56:59], v[32:35], v[192:199], v3
  v_add_f32 v47, v47, v51
  v_cvt_pk_bf16_f32 v48, v44, v45
  v_cvt_pk_bf16_f32 v49, v46, v47
  ds_write_b64 v113, v[48:49]
  s_nop 3
  v_permlane32_swap_b32 v52, v56
  v_permlane32_swap_b32 v53, v57
  v_permlane32_swap_b32 v54, v58
  v_permlane32_swap_b32 v55, v59
  v_add_f32 v52, v52, v56
  v_add_f32 v53, v53, v57
  v_add_f32 v54, v54, v58
  v_add_f32 v55, v55, v59
  v_cvt_pk_bf16_f32 v56, v52, v53
  v_cvt_pk_bf16_f32 v57, v54, v55
  ds_write_b64 v114, v[56:57]
  s_waitcnt lgkmcnt(0)
  s_barrier
  s_cmp_eq_u32 s19, 62
  s_cbranch_scc1 cB_done
  s_waitcnt vmcnt(0) lgkmcnt(0)
  s_add_u32 s19, s19, 1
  s_mov_b32 s20, s21
  s_branch cB_va2_loop
cB_va2_retry:
  s_waitcnt lgkmcnt(0)
  buffer_load_dwordx4 v[8:11], v2, s[8:11], s20 offen offset:0 sc1
  buffer_load_dwordx4 v[12:15], v2, s[8:11], s20 offen offset:1024 sc1
  buffer_load_dwordx4 v[16:19], v2, s[8:11], s20 offen offset:2048 sc1
  buffer_load_dwordx4 v[20:23], v2, s[8:11], s20 offen offset:3072 sc1
  s_add_u32 s31, s31, 1
  s_add_u32 s30, s30, 1
  s_cmp_lt_u32 s30, 400000
  s_cbranch_scc1 cB_va2_ld
  s_branch cB_abort
cB_va2_last:
  s_waitcnt lgkmcnt(0)
  buffer_store_dwordx4 v[100:103], v2, s[8:11], s24 offen offset:0 sc1
  buffer_store_dwordx4 v[104:107], v2, s[8:11], s24 offen offset:1024 sc1
  buffer_store_dwordx4 v[108:111], v2, s[8:11], s24 offen offset:2048 sc1
  buffer_store_dwordx4 v[4:7], v2, s[8:11], s24 offen offset:3072 sc1
  s_add_u32 s24, s24, 8192
  s_waitcnt vmcnt(0)
  s_mov_b64 exec, 1
  buffer_store_dword v117, v2, s[8:11], s34 offen sc1
  s_mov_b64 exec, -1
  s_add_u32 s34, s34, 8
  s_mov_b64 exec, 1
  buffer_store_dword v117, v2, s[8:11], s34 offen sc1
  s_mov_b64 exec, -1
  s_add_u32 s34, s34, 8
  s_branch cB_done
cB_va3_loop:
  s_add_u32 s23, s20, 4096
  s_add_u32 s21, s20, 25600
  v_mov_b32 v36, 0
  v_mov_b32 v37, 0
  v_mov_b32 v38, 0
  v_mov_b32 v39, 0
  v_mov_b32 v40, 0
  v_mov_b32 v41, 0
  v_mov_b32 v42, 0
  v_mov_b32 v43, 0
  v_mov_b32 v44, 0
  v_mov_b32 v45, 0
  v_mov_b32 v46, 0
  v_mov_b32 v47, 0
  v_mov_b32 v48, 0
  v_mov_b32 v49, 0
  v_mov_b32 v50, 0
  v_mov_b32 v51, 0
  v_mov_b32 v52, 0
  v_mov_b32 v53, 0
  v_mov_b32 v54, 0
  v_mov_b32 v55, 0
  v_mov_b32 v56, 0
  v_mov_b32 v57, 0
  v_mov_b32 v58, 0
  v_mov_b32 v59, 0
  v_mov_b32 v60, 0
  v_mov_b32 v61, 0
  v_mov_b32 v62, 0
  v_mov_b32 v63, 0
  v_mov_b32 v64, 0
  v_mov_b32 v65, 0
  v_mov_b32 v66, 0
  v_mov_b32 v67, 0
  s_mov_b32 s30, 0
  buffer_load_dword v76, v119, s[8:11], s20 offen sc1
  buffer_load_dword v77, v119, s[8:11], s20 offen sc1
  buffer_load_dword v78, v119, s[8:11], s20 offen sc1
cB_va3_fp_l:
  s_waitcnt vmcnt(2)
  v_cmp_eq_u32 vcc, -1, v76
  s_cbranch_vccz cB_va3_fp_d
  buffer_load_dword v76, v119, s[8:11], s20 offen sc1
  s_waitcnt vmcnt(2)
  v_cmp_eq_u32 vcc, -1, v77
  s_cbranch_vccz cB_va3_fp_d
  buffer_load_dword v77, v119, s[8:11], s20 offen sc1
  s_waitcnt vmcnt(2)
  v_cmp_eq_u32 vcc, -1, v78
  s_cbranch_vccz cB_va3_fp_d
  buffer_load_dword v78, v119, s[8:11], s20 offen sc1
  s_add_u32 s30, s30, 1
  s_cmp_lt_u32 s30, 400000
  s_cbranch_scc1 cB_va3_fp_l
  s_branch cB_abort
cB_va3_fp_d:
  buffer_load_dwordx4 v[24:27], v2, s[8:11], s23 offen offset:0 sc1
  buffer_load_dwordx4 v[28:31], v2, s[8:11], s23 offen offset:1024 sc1
  buffer_load_dwordx4 v[32:35], v2, s[8:11], s23 offen offset:2048 sc1
  s_barrier
cB_va3_ld:
  s_waitcnt vmcnt(0)
  v_max3_u32 v84, v24, v25, v26
  v_max3_u32 v84, v84, v27, v28
  v_max3_u32 v84, v84, v29, v30
  v_max3_u32 v84, v84, v31, v32
  v_max3_u32 v84, v84, v33, v34
  v_max_u32 v84, v84, v35
  v_cmp_eq_u32 vcc, -1, v84
  ds_write_b128 v2, v[24:27] offset:12288
  ds_write_b128 v2, v[28:31] offset:13312
  ds_write_b128 v2, v[32:35] offset:14336
  s_cbranch_vccnz cB_va3_retry
  s_waitcnt lgkmcnt(0)
  s_barrier
  ds_read_b128 v[8:11], v2 offset:8192
  ds_read_b128 v[12:15], v2 offset:9216
  ds_read_b128 v[16:19], v2 offset:10240
  ds_read_b128 v[20:23], v2 offset:11264
  s_waitcnt lgkmcnt(0)
  s_cmp_eq_u32 s19, 63
  s_cbranch_scc1 cB_done
  ds_read_b128 v[76:79], v1 offset:0
  ds_read_b128 v[80:83], v1 offset:1024
  ds_read_b128 v[84:87], v1 offset:2048
  ds_read_b128 v[88:91], v1 offset:3072
  ds_read_b128 v[92:95], v1 offset:4096
  ds_read_b128 v[96:99], v1 offset:5120
  v_smfmac_f32_16x16x64_bf16 v[60:63], v[8:11], v[200:207], v3
  v_smfmac_f32_16x16x64_bf16 v[60:63], v[12:15], v[208:215], v3
  s_waitcnt lgkmcnt(4)
  v_smfmac_f32_16x16x64_bf16 v[64:67], v[8:11], v[76:83], v3
  ds_read_b128 v[76:79], v1 offset:6144
  ds_read_b128 v[80:83], v1 offset:7168
  v_smfmac_f32_16x16x64_bf16 v[60:63], v[16:19], v[216:223], v3
  v_smfmac_f32_16x16x64_bf16 v[60:63], v[20:23], v[224:231], v3
  s_waitcnt lgkmcnt(4)
  v_smfmac_f32_16x16x64_bf16 v[64:67], v[12:15], v[84:91], v3
  ds_read_b128 v[84:87], v1 offset:8192
  ds_read_b128 v[88:91], v1 offset:9216
  v_smfmac_f32_16x16x64_bf16 v[60:63], v[24:27], v[232:239], v3
  v_smfmac_f32_16x16x64_bf16 v[60:63], v[28:31], v[240:247], v3
  s_waitcnt lgkmcnt(4)
  v_smfmac_f32_16x16x64_bf16 v[64:67], v[16:19], v[92:99], v3
  ds_read_b128 v[92:95], v1 offset:10240
  ds_read_b128 v[96:99], v1 offset:11264
  v_smfmac_f32_16x16x64_bf16 v[60:63], v[32:35], v[248:255], v3
  v_smfmac_f32_16x16x64_bf16 v[36:39], v[8:11], a[0:7], v3
  s_waitcnt lgkmcnt(4)
  v_smfmac_f32_16x16x64_bf16 v[64:67], v[20:23], v[76:83], v3
  ds_read_b128 v[76:79], v1 offset:12288
  ds_read_b128 v[80:83], v1 offset:13312
  v_smfmac_f32_16x16x64_bf16 v[36:39], v[12:15], a[8:15], v3
  v_smfmac_f32_16x16x64_bf16 v[36:39], v[16:19], a[16:23], v3
  s_waitcnt lgkmcnt(4)
  v_smfmac_f32_16x16x64_bf16 v[64:67], v[24:27], v[84:91], v3
  v_smfmac_f32_16x16x64_bf16 v[36:39], v[20:23], a[24:31], v3
  v_smfmac_f32_16x16x64_bf16 v[36:39], v[24:27], a[32:39], v3
  s_waitcnt lgkmcnt(2)
  v_smfmac_f32_16x16x64_bf16 v[64:67], v[28:31], v[92:99], v3
  v_smfmac_f32_16x16x64_bf16 v[36:39], v[28:31], a[40:47], v3
  v_smfmac_f32_16x16x64_bf16 v[36:39], v[32:35], a[48:55], v3
  s_waitcnt lgkmcnt(0)
  v_smfmac_f32_16x16x64_bf16 v[64:67], v[32:35], v[76:83], v3
  v_smfmac_f32_16x16x64_bf16 v[40:43], v[8:11], a[56:63], v3
  v_smfmac_f32_16x16x64_bf16 v[40:43], v[12:15], a[64:71], v3
  v_smfmac_f32_16x16x64_bf16 v[40:43], v[16:19], a[72:79], v3
  v_smfmac_f32_16x16x64_bf16 v[40:43], v[20:23], a[80:87], v3
  v_permlane32_swap_b32 v60, v64
  v_smfmac_f32_16x16x64_bf16 v[40:43], v[24:27], a[88:95], v3
  v_permlane32_swap_b32 v61, v65
  v_smfmac_f32_16x16x64_bf16 v[40:43], v[28:31], a[96:103], v3
  v_permlane32_swap_b32 v62, v66
  v_smfmac_f32_16x16x64_bf16 v[40:43], v[32:35], a[104:111], v3
  v_permlane32_swap_b32 v63, v67
  v_smfmac_f32_16x16x64_bf16 v[44:47], v[8:11], a[112:119], v3
  v_smfmac_f32_16x16x64_bf16 v[44:47], v[12:15], a[120:127], v3
  v_smfmac_f32_16x16x64_bf16 v[44:47], v[16:19], a[128:135], v3
  v_smfmac_f32_16x16x64_bf16 v[44:47], v[20:23], a[136:143], v3
  v_add_f32 v60, v60, v64
  v_add_f32 v61, v61, v65
  v_smfmac_f32_16x16x64_bf16 v[44:47], v[24:27], a[144:151], v3
  v_add_f32 v62, v62, v66
  v_add_f32 v63, v63, v67
  v_smfmac_f32_16x16x64_bf16 v[44:47], v[28:31], a[152:159], v3
  v_cvt_pk_bf16_f32 v64, v60, v61
  v_cvt_pk_bf16_f32 v65, v62, v63
  v_smfmac_f32_16x16x64_bf16 v[44:47], v[32:35], a[160:167], v3
  ds_write_b64 v115, v[64:65]
  v_smfmac_f32_16x16x64_bf16 v[48:51], v[8:11], a[168:175], v3
  v_permlane32_swap_b32 v36, v40
  v_smfmac_f32_16x16x64_bf16 v[48:51], v[12:15], a[176:183], v3
  v_permlane32_swap_b32 v37, v41
  v_smfmac_f32_16x16x64_bf16 v[48:51], v[16:19], a[184:191], v3
  v_permlane32_swap_b32 v38, v42
  v_smfmac_f32_16x16x64_bf16 v[48:51], v[20:23], a[192:199], v3
  v_permlane32_swap_b32 v39, v43
  v_smfmac_f32_16x16x64_bf16 v[48:51], v[24:27], a[200:207], v3
  v_add_f32 v36, v36, v40
  v_smfmac_f32_16x16x64_bf16 v[48:51], v[28:31], a[208:215], v3
  v_add_f32 v37, v37, v41
  v_smfmac_f32_16x16x64_bf16 v[48:51], v[32:35], a[216:223], v3
  v_add_f32 v38, v38, v42
  v_smfmac_f32_16x16x64_bf16 v[52:55], v[8:11], a[224:231], v3
  v_smfmac_f32_16x16x64_bf16 v[52:55], v[12:15], a[232:239], v3
  v_smfmac_f32_16x16x64_bf16 v[52:55], v[16:19], a[240:247], v3
  v_smfmac_f32_16x16x64_bf16 v[52:55], v[20:23], a[248:255], v3
  v_add_f32 v39, v39, v43
  v_cvt_pk_bf16_f32 v40, v36, v37
  v_smfmac_f32_16x16x64_bf16 v[52:55], v[24:27], v[120:127], v3
  v_cvt_pk_bf16_f32 v41, v38, v39
  v_smfmac_f32_16x16x64_bf16 v[52:55], v[28:31], v[128:135], v3
  ds_write_b64 v112, v[40:41]
  v_smfmac_f32_16x16x64_bf16 v[52:55], v[32:35], v[136:143], v3
  v_permlane32_swap_b32 v44, v48
  v_smfmac_f32_16x16x64_bf16 v[56:59], v[8:11], v[144:151], v3
  v_permlane32_swap_b32 v45, v49
  v_smfmac_f32_16x16x64_bf16 v[56:59], v[12:15], v[152:159], v3
  v_permlane32_swap_b32 v46, v50
  v_smfmac_f32_16x16x64_bf16 v[56:59], v[16:19], v[160:167], v3
  v_permlane32_swap_b32 v47, v51
  v_smfmac_f32_16x16x64_bf16 v[56:59], v[20:23], v[168:175], v3
  v_add_f32 v44, v44, v48
  v_smfmac_f32_16x16x64_bf16 v[56:59], v[24:27], v[176:183], v3
  v_add_f32 v45, v45, v49
  v_smfmac_f32_16x16x64_bf16 v[56:59], v[28:31], v[184:191], v3
  v_add_f32 v46, v46, v50
  v_smfmac_f32_16x16x64_bf16 v[56:59], v[32:35], v[192:199], v3
  v_add_f32 v47, v47, v51
  v_cvt_pk_bf16_f32 v48, v44, v45
  v_cvt_pk_bf16_f32 v49, v46, v47
  ds_write_b64 v113, v[48:49]
  s_nop 3
  v_permlane32_swap_b32 v52, v56
  v_permlane32_swap_b32 v53, v57
  v_permlane32_swap_b32 v54, v58
  v_permlane32_swap_b32 v55, v59
  v_add_f32 v52, v52, v56
  v_add_f32 v53, v53, v57
  v_add_f32 v54, v54, v58
  v_add_f32 v55, v55, v59
  v_cvt_pk_bf16_f32 v56, v52, v53
  v_cvt_pk_bf16_f32 v57, v54, v55
  ds_write_b64 v114, v[56:57]
  s_waitcnt lgkmcnt(0)
  s_barrier
  s_cmp_eq_u32 s19, 62
  s_cbranch_scc1 cB_done
  s_waitcnt vmcnt(0) lgkmcnt(0)
  s_add_u32 s19, s19, 1
  s_mov_b32 s20, s21
  s_branch cB_va3_loop
cB_va3_retry:
  s_waitcnt lgkmcnt(0)
  buffer_load_dwordx4 v[24:27], v2, s[8:11], s23 offen offset:0 sc1
  buffer_load_dwordx4 v[28:31], v2, s[8:11], s23 offen offset:1024 sc1
  buffer_load_dwordx4 v[32:35], v2, s[8:11], s23 offen offset:2048 sc1
  s_add_u32 s31, s31, 1
  s_add_u32 s30, s30, 1
  s_cmp_lt_u32 s30, 400000
  s_cbranch_scc1 cB_va3_ld
  s_branch cB_abort
cB_va3_last:
  s_waitcnt lgkmcnt(0)
  buffer_store_dwordx4 v[100:103], v2, s[8:11], s24 offen offset:0 sc1
  buffer_store_dwordx4 v[104:107], v2, s[8:11], s24 offen offset:1024 sc1
  buffer_store_dwordx4 v[108:111], v2, s[8:11], s24 offen offset:2048 sc1
  buffer_store_dwordx4 v[4:7], v2, s[8:11], s24 offen offset:3072 sc1
  s_add_u32 s24, s24, 8192
  s_waitcnt vmcnt(0)
  s_mov_b64 exec, 1
  buffer_store_dword v117, v2, s[8:11], s34 offen sc1
  s_mov_b64 exec, -1
  s_add_u32 s34, s34, 8
  s_mov_b64 exec, 1
  buffer_store_dword v117, v2, s[8:11], s34 offen sc1
  s_mov_b64 exec, -1
  s_add_u32 s34, s34, 8
  s_branch cB_done
cB_abort:
  v_mov_b32 v4, 0xdead
  v_mov_b32 v5, 16
  buffer_store_dword v4, v5, s[12:15], 0 offen
  s_branch ch_end
cB_done:
  s_branch ch_end
m_reclaim:
  s_waitcnt vmcnt(0)
  s_lshr_b32 s20, s3, 5
  s_cmp_lg_u32 s16, 0
  s_cbranch_scc1 w0_17
  s_mov_b32 s21, 0
  s_mov_b64 exec, 1
rc_l:
  s_cmp_lg_u32 s70, -1
  s_cbranch_scc1 rc_t
  s_add_u32 s20, s20, 1
  s_cmp_lt_u32 s20, 8
  s_cselect_b32 s20, s20, 0
  s_mov_b32 s70, 0
  s_mov_b32 s3, -1
  s_add_u32 s21, s21, 1
  s_cmp_ge_u32 s21, 9
  s_cbranch_scc1 rc_d
rc_t:
  s_ff0_i32_b32 s22, s70
  s_lshl_b32 s23, 1, s22
  s_and_b32 s71, s20, 4
  s_mul_i32 s71, s71, 12
  s_lshl_b32 s3, s20, 2
  s_add_u32 s3, s3, s71
  v_mov_b32 v242, s23
  v_mov_b32 v243, 32
  buffer_atomic_or v242, v243, s[12:15], s3 offen sc0
  s_waitcnt vmcnt(0)
  v_readfirstlane_b32 s70, v242
  s_lshl_b32 s3, s20, 5
  s_add_u32 s3, s3, s22
  s_bitcmp1_b32 s70, s22
  s_cbranch_scc1 rc_l
rc_d:
  s_mov_b64 exec, -1
  v_mov_b32 v242, s3
w0_17:
  v_mov_b32 v250, 160000
  s_add_u32 s101, s101, 1
  s_barrier
  s_mov_b64 exec, 1
  s_cmp_lg_u32 s16, 0
  s_cbranch_scc1 w0_18
  ds_write_b32 v250, v242 offset:0
  s_waitcnt lgkmcnt(0)
  v_mov_b32 v242, s101
  ds_write_b32 v250, v242 offset:16
  s_waitcnt lgkmcnt(0)
w0_18:
  s_mov_b64 exec, -1
  s_barrier
  ds_read_b32 v242, v250 offset:0
  ds_read_b32 v250, v250 offset:16
  s_waitcnt lgkmcnt(0)
  v_readfirstlane_b32 s3, v242
  v_cmp_ne_u32 vcc, s101, v250
  s_cbranch_vccnz ch_end
  s_cmp_lg_u32 s3, -1
  s_cbranch_scc1 m_start
  v_mov_b32 v250, 0
  s_branch wk_ask
m_bjob:
  v_and_b32 v1, 63, v0
  v_lshlrev_b32 v2, 4, v1
  v_lshrrev_b32 v3, 4, v1
  v_and_b32 v4, 15, v1
  s_sub_u32 s18, s3, 32
  s_mul_i32 s17, s18, 4682
  s_lshr_b32 s17, s17, 16
  s_mul_i32 s20, s17, 14
  s_sub_u32 s19, s18, s20
  s_cmp_ge_u32 s19, 7
  s_cselect_b32 s31, 7, 0
  s_sub_u32 s19, s19, s31
  s_mov_b32 s60, s44
  s_and_b32 s61, s45, 0xffff
  s_mov_b32 s62, 3670016
  s_mov_b32 s63, 0x20000
  s_mov_b32 s56, s46
  s_and_b32 s57, s47, 0xffff
  s_mov_b32 s58, 3670016
  s_mov_b32 s59, 0x20000
  s_lshl_b32 s30, s16, 13
  s_mul_i32 s27, s17, 229376
  s_lshl_b32 s29, s19, 7
  s_add_u32 s27, s27, s29
  v_lshrrev_b32 v7, 3, v1
  v_and_b32 v8, 7, v1
  s_lshl_b32 s29, s16, 6
  v_add_u32 v7, s29, v7
  v_mul_u32_u24 v7, 896, v7
  v_lshl_add_u32 v7, v8, 4, v7
  s_add_u32 m0, s30, 0
  s_add_u32 s22, s27, 0
  buffer_load_dwordx4 v7, s[56:59], s22 offen offset:0 lds
  s_add_u32 s22, s27, 6144
  buffer_load_dwordx4 v7, s[56:59], s22 offen offset:1024 lds
  s_add_u32 s22, s27, 12288
  buffer_load_dwordx4 v7, s[56:59], s22 offen offset:2048 lds
  s_add_u32 s22, s27, 18432
  buffer_load_dwordx4 v7, s[56:59], s22 offen offset:3072 lds
  s_add_u32 m0, s30, 4096
  s_add_u32 s22, s27, 28672
  buffer_load_dwordx4 v7, s[56:59], s22 offen offset:0 lds
  s_add_u32 s22, s27, 34816
  buffer_load_dwordx4 v7, s[56:59], s22 offen offset:1024 lds
  s_add_u32 s22, s27, 40960
  buffer_load_dwordx4 v7, s[56:59], s22 offen offset:2048 lds
  s_add_u32 s22, s27, 47104
  buffer_load_dwordx4 v7, s[56:59], s22 offen offset:3072 lds
  v_lshrrev_b32 v5, 5, v1
  v_and_b32 v6, 31, v1
  s_lshl_b32 s25, s16, 15
  s_add_u32 s25, s25, 32768
  s_lshl_b32 s26, s17, 9
  s_add_u32 s28, s19, s16
  s_cmp_ge_u32 s28, 7
  s_cselect_b32 s20, 7, 0
  s_sub_u32 s28, s28, s20
  s_add_u32 s28, s28, s31
  s_add_u32 s29, s19, s16
  s_add_u32 s29, s29, 4
  s_cmp_ge_u32 s29, 7
  s_cselect_b32 s20, 7, 0
  s_sub_u32 s29, s29, s20
  s_add_u32 s29, s29, s31
  s_lshl_b32 s32, s28, 18
  s_add_u32 s32, s32, s26
  s_lshl_b32 s33, s29, 18
  s_add_u32 s33, s33, s26
  v_xor_b32 v8, v6, v5
  v_lshlrev_b32 v8, 4, v8
  v_lshl_add_u32 v8, v5, 13, v8
  v_xor_b32 v12, 0, v8
  v_xor_b32 v13, 32, v8
  v_add_u32 v13, 15360, v13
  v_xor_b32 v14, 0, v8
  v_add_u32 v14, 30720, v14
  v_xor_b32 v15, 32, v8
  v_add_u32 v15, 46080, v15
  s_add_u32 s20, s16, 0
  s_and_b32 s20, s20, 3
  s_mul_i32 s21, s20, 65600
  s_lshl_b32 s20, s20, 12
  s_add_u32 s48, s20, s25
  s_mov_b32 m0, s48
  v_xor_b32 v16, s21, v12
  buffer_load_dwordx4 v16, s[60:63], s32 offen offset:0 lds
  v_xor_b32 v17, s21, v13
  buffer_load_dwordx4 v17, s[60:63], s32 offen offset:1024 lds
  v_xor_b32 v18, s21, v14
  buffer_load_dwordx4 v18, s[60:63], s32 offen offset:2048 lds
  v_xor_b32 v19, s21, v15
  buffer_load_dwordx4 v19, s[60:63], s32 offen offset:3072 lds
  s_add_u32 s20, s16, 1
  s_and_b32 s20, s20, 3
  s_mul_i32 s21, s20, 65600
  s_lshl_b32 s20, s20, 12
  s_add_u32 s49, s20, s25
  s_mov_b32 m0, s49
  v_xor_b32 v20, s21, v12
  buffer_load_dwordx4 v20, s[60:63], s32 offen offset:0 lds
  v_xor_b32 v21, s21, v13
  buffer_load_dwordx4 v21, s[60:63], s32 offen offset:1024 lds
  v_xor_b32 v22, s21, v14
  buffer_load_dwordx4 v22, s[60:63], s32 offen offset:2048 lds
  v_xor_b32 v23, s21, v15
  buffer_load_dwordx4 v23, s[60:63], s32 offen offset:3072 lds
  s_add_u32 s20, s16, 2
  s_and_b32 s20, s20, 3
  s_mul_i32 s21, s20, 65600
  s_lshl_b32 s20, s20, 12
  s_add_u32 s50, s20, s25
  s_mov_b32 m0, s50
  v_xor_b32 v24, s21, v12
  buffer_load_dwordx4 v24, s[60:63], s32 offen offset:0 lds
  v_xor_b32 v25, s21, v13
  buffer_load_dwordx4 v25, s[60:63], s32 offen offset:1024 lds
  v_xor_b32 v26, s21, v14
  buffer_load_dwordx4 v26, s[60:63], s32 offen offset:2048 lds
  v_xor_b32 v27, s21, v15
  buffer_load_dwordx4 v27, s[60:63], s32 offen offset:3072 lds
  s_add_u32 s20, s16, 3
  s_and_b32 s20, s20, 3
  s_mul_i32 s21, s20, 65600
  s_lshl_b32 s20, s20, 12
  s_add_u32 s51, s20, s25
  s_mov_b32 m0, s51
  v_xor_b32 v28, s21, v12
  buffer_load_dwordx4 v28, s[60:63], s32 offen offset:0 lds
  v_xor_b32 v29, s21, v13
  buffer_load_dwordx4 v29, s[60:63], s32 offen offset:1024 lds
  v_xor_b32 v30, s21, v14
  buffer_load_dwordx4 v30, s[60:63], s32 offen offset:2048 lds
  v_xor_b32 v31, s21, v15
  buffer_load_dwordx4 v31, s[60:63], s32 offen offset:3072 lds
  s_cmp_eq_u32 s16, 3
  s_cbranch_scc1 bj_np1
  s_add_u32 m0, s48, 16384
  s_nop 0
  buffer_load_dwordx4 v16, s[60:63], s33 offen offset:0 lds
  buffer_load_dwordx4 v17, s[60:63], s33 offen offset:1024 lds
  buffer_load_dwordx4 v18, s[60:63], s33 offen offset:2048 lds
  buffer_load_dwordx4 v19, s[60:63], s33 offen offset:3072 lds
  s_add_u32 m0, s49, 16384
  s_nop 0
  buffer_load_dwordx4 v20, s[60:63], s33 offen offset:0 lds
  buffer_load_dwordx4 v21, s[60:63], s33 offen offset:1024 lds
  buffer_load_dwordx4 v22, s[60:63], s33 offen offset:2048 lds
  buffer_load_dwordx4 v23, s[60:63], s33 offen offset:3072 lds
  s_add_u32 m0, s50, 16384
  s_nop 0
  buffer_load_dwordx4 v24, s[60:63], s33 offen offset:0 lds
  buffer_load_dwordx4 v25, s[60:63], s33 offen offset:1024 lds
  buffer_load_dwordx4 v26, s[60:63], s33 offen offset:2048 lds
  buffer_load_dwordx4 v27, s[60:63], s33 offen offset:3072 lds
  s_add_u32 m0, s51, 16384
  s_nop 0
  buffer_load_dwordx4 v28, s[60:63], s33 offen offset:0 lds
  buffer_load_dwordx4 v29, s[60:63], s33 offen offset:1024 lds
  buffer_load_dwordx4 v30, s[60:63], s33 offen offset:2048 lds
  buffer_load_dwordx4 v31, s[60:63], s33 offen offset:3072 lds
bj_np1:
  s_mov_b32 s52, s36
  s_and_b32 s53, s37, 0xffff
  s_mov_b32 s54, 1835008
  s_mov_b32 s55, 0x20000
  s_lshl_b32 s20, s18, 8
  v_add_u32 v95, s20, v0
  s_mov_b32 s21, 9586981
  v_mul_hi_u32 v6, v95, s21
  v_mul_u32_u24 v7, 448, v6
  v_sub_u32 v7, v95, v7
  v_lshrrev_b32 v8, 4, v7
  v_and_b32 v7, 15, v7
  v_lshl_add_u32 v9, v6, 4, v7
  v_mul_u32_u24 v9, 896, v9
  v_lshl_add_u32 v9, v8, 5, v9
  buffer_load_dwordx4 v[84:87], v9, s[52:55], 0 offen
  buffer_load_dwordx4 v[88:91], v9, s[52:55], 0 offen offset:16
  v_mul_u32_u24 v6, 14336, v6
  v_lshl_add_u32 v6, v7, 4, v6
  v_lshl_add_u32 v92, v8, 9, v6
  v_lshrrev_b32 v7, 2, v8
  v_lshl_add_u32 v6, v7, 11, v6
  v_and_b32 v7, 3, v8
  v_lshl_add_u32 v93, v7, 8, v6
  s_mov_b32 s72, s38
  s_and_b32 s73, s39, 0xffff
  s_mov_b32 s74, 7168
  s_mov_b32 s75, 0x20000
  v_min_u32 v6, 223, v0
  v_lshrrev_b32 v7, 3, v6
  v_and_b32 v6, 7, v6
  v_mul_u32_u24 v9, 896, v6
  v_lshl_add_u32 v9, v7, 5, v9
  buffer_load_dwordx4 v[36:39], v9, s[72:75], 0 offen
  buffer_load_dwordx4 v[40:43], v9, s[72:75], 0 offen offset:16
  v_lshlrev_b32 v7, 8, v7
  v_lshl_add_u32 v94, v6, 4, v7
  s_cmp_lt_u32 s16, 2
  s_cselect_b32 s20, s40, s42
  s_cselect_b32 s21, s41, s43
  s_mov_b32 s72, s20
  s_and_b32 s73, s21, 0xffff
  s_mov_b32 s74, 3670016
  s_mov_b32 s75, 0x20000
  s_add_u32 s20, s19, s31
  s_lshl_b32 s21, s20, 5
  s_lshl_b32 s22, s16, 4
  s_add_u32 s21, s21, s22
  s_mul_i32 s20, s20, 14
  s_add_u32 s20, s20, 250
  s_cmp_lt_u32 s16, 2
  s_cselect_b32 s20, s21, s20
  s_lshl_b32 s20, s20, 13
  s_add_u32 s20, s20, s26
  v_lshlrev_b32 v6, 13, v4
  v_lshl_add_u32 v6, v3, 7, v6
  buffer_load_dword v51, v6, s[72:75], s20 offen
  s_cmp_lg_u32 s66, 0
  s_cbranch_scc1 bj_ci
  s_cmp_lg_u32 s16, 0
  s_cbranch_scc1 w0_19
  s_lshr_b32 s70, s3, 5
  s_and_b32 s71, s70, 4
  s_mul_i32 s71, s71, 12
  s_lshl_b32 s70, s70, 2
  s_add_u32 s70, s70, s71
  s_lshl_b32 s71, 1, s3
  v_mov_b32 v44, s71
  v_mov_b32 v45, 32
  s_mov_b64 exec, 1
  buffer_atomic_or v44, v45, s[12:15], s70 offen sc0
  buffer_load_dwordx2 v[46:47], v45, s[12:15], 0 offen offset:96 sc1
  s_mov_b64 exec, -1
w0_19:
bj_ci:
  s_lshl_b32 s30, s19, 6
  s_add_u32 s30, s30, 0
  v_add_u32 v8, s30, v4
  v_mul_u32_u24 v10, 2341, v8
  v_lshrrev_b32 v10, 16, v10
  v_mul_u32_u24 v11, 28, v10
  v_sub_u32 v32, v8, v11
  s_mul_i32 s30, s17, 28
  v_add_u32 v32, s30, v32
  v_lshrrev_b32 v33, 4, v32
  v_and_b32 v32, 15, v32
  s_mov_b32 s30, 401408
  v_mul_lo_u32 v10, v10, s30
  v_mul_u32_u24 v33, 14336, v33
  v_add_u32 v10, v10, v33
  v_lshl_add_u32 v10, v3, 8, v10
  v_lshl_add_u32 v10, v32, 4, v10
  v_add_u32 v12, 6422528, v10
  s_lshl_b32 s30, s19, 6
  s_add_u32 s30, s30, 16
  v_add_u32 v8, s30, v4
  v_mul_u32_u24 v10, 2341, v8
  v_lshrrev_b32 v10, 16, v10
  v_mul_u32_u24 v11, 28, v10
  v_sub_u32 v32, v8, v11
  s_mul_i32 s30, s17, 28
  v_add_u32 v32, s30, v32
  v_lshrrev_b32 v33, 4, v32
  v_and_b32 v32, 15, v32
  s_mov_b32 s30, 401408
  v_mul_lo_u32 v10, v10, s30
  v_mul_u32_u24 v33, 14336, v33
  v_add_u32 v10, v10, v33
  v_lshl_add_u32 v10, v3, 8, v10
  v_lshl_add_u32 v10, v32, 4, v10
  v_add_u32 v13, 6422528, v10
  s_lshl_b32 s30, s19, 6
  s_add_u32 s30, s30, 32
  v_add_u32 v8, s30, v4
  v_mul_u32_u24 v10, 2341, v8
  v_lshrrev_b32 v10, 16, v10
  v_mul_u32_u24 v11, 28, v10
  v_sub_u32 v32, v8, v11
  s_mul_i32 s30, s17, 28
  v_add_u32 v32, s30, v32
  v_lshrrev_b32 v33, 4, v32
  v_and_b32 v32, 15, v32
  s_mov_b32 s30, 401408
  v_mul_lo_u32 v10, v10, s30
  v_mul_u32_u24 v33, 14336, v33
  v_add_u32 v10, v10, v33
  v_lshl_add_u32 v10, v3, 8, v10
  v_lshl_add_u32 v10, v32, 4, v10
  v_add_u32 v14, 6422528, v10
  s_lshl_b32 s30, s19, 6
  s_add_u32 s30, s30, 48
  v_add_u32 v8, s30, v4
  v_mul_u32_u24 v10, 2341, v8
  v_lshrrev_b32 v10, 16, v10
  v_mul_u32_u24 v11, 28, v10
  v_sub_u32 v32, v8, v11
  s_mul_i32 s30, s17, 28
  v_add_u32 v32, s30, v32
  v_lshrrev_b32 v33, 4, v32
  v_and_b32 v32, 15, v32
  s_mov_b32 s30, 401408
  v_mul_lo_u32 v10, v10, s30
  v_mul_u32_u24 v33, 14336, v33
  v_add_u32 v10, v10, v33
  v_lshl_add_u32 v10, v3, 8, v10
  v_lshl_add_u32 v10, v32, 4, v10
  v_add_u32 v15, 6422528, v10
  v_lshrrev_b32 v7, 2, v4
  v_lshlrev_b32 v7, 3, v7
  v_and_b32 v8, 3, v4
  v_add_u32 v7, v7, v8
  v_xor_b32 v10, v3, v4
  v_lshlrev_b32 v10, 4, v10
  v_lshl_add_u32 v10, v7, 9, v10
  v_add_u32 v10, s25, v10
  v_xor_b32 v32, 0, v10
  v_xor_b32 v33, 64, v10
  v_xor_b32 v34, 128, v10
  v_xor_b32 v35, 192, v10
  v_lshrrev_b32 v7, 2, v4
  v_lshl_add_u32 v7, v3, 3, v7
  v_lshlrev_b32 v7, 7, v7
  v_and_b32 v8, 3, v4
  v_lshl_add_u32 v7, v8, 3, v7
  s_waitcnt vmcnt(37)
  s_cmp_lg_u32 s16, 3
  s_cbranch_scc1 w3_20
  s_waitcnt vmcnt(21)
w3_20:
  s_barrier
  ds_read_b64_tr_b16 v[128:129], v7 offset:0
  ds_read_b64_tr_b16 v[130:131], v7 offset:512
  ds_read_b64_tr_b16 v[132:133], v7 offset:4096
  ds_read_b64_tr_b16 v[134:135], v7 offset:4608
  ds_read_b64_tr_b16 v[136:137], v7 offset:8192
  ds_read_b64_tr_b16 v[138:139], v7 offset:8704
  ds_read_b64_tr_b16 v[140:141], v7 offset:12288
  ds_read_b64_tr_b16 v[142:143], v7 offset:12800
  s_waitcnt lgkmcnt(6)
  ds_read_b64_tr_b16 v[144:145], v7 offset:16384
  ds_read_b64_tr_b16 v[146:147], v7 offset:16896
  ds_read_b64_tr_b16 v[148:149], v7 offset:20480
  ds_read_b64_tr_b16 v[150:151], v7 offset:20992
  ds_read_b64_tr_b16 v[152:153], v7 offset:24576
  ds_read_b64_tr_b16 v[154:155], v7 offset:25088
  ds_read_b64_tr_b16 v[156:157], v7 offset:28672
  ds_read_b64_tr_b16 v[158:159], v7 offset:29184
  s_waitcnt lgkmcnt(6)
  ds_read_b64_tr_b16 v[160:161], v7 offset:32
  ds_read_b64_tr_b16 v[162:163], v7 offset:544
  ds_read_b64_tr_b16 v[164:165], v7 offset:4128
  ds_read_b64_tr_b16 v[166:167], v7 offset:4640
  ds_read_b64_tr_b16 v[168:169], v7 offset:8224
  ds_read_b64_tr_b16 v[170:171], v7 offset:8736
  ds_read_b64_tr_b16 v[172:173], v7 offset:12320
  ds_read_b64_tr_b16 v[174:175], v7 offset:12832
  s_waitcnt lgkmcnt(6)
  ds_read_b64_tr_b16 v[176:177], v7 offset:16416
  ds_read_b64_tr_b16 v[178:179], v7 offset:16928
  ds_read_b64_tr_b16 v[180:181], v7 offset:20512
  ds_read_b64_tr_b16 v[182:183], v7 offset:21024
  ds_read_b64_tr_b16 v[184:185], v7 offset:24608
  ds_read_b64_tr_b16 v[186:187], v7 offset:25120
  ds_read_b64_tr_b16 v[188:189], v7 offset:28704
  ds_read_b64_tr_b16 v[190:191], v7 offset:29216
  s_waitcnt lgkmcnt(6)
  ds_read_b64_tr_b16 v[192:193], v7 offset:64
  ds_read_b64_tr_b16 v[194:195], v7 offset:576
  ds_read_b64_tr_b16 v[196:197], v7 offset:4160
  ds_read_b64_tr_b16 v[198:199], v7 offset:4672
  ds_read_b64_tr_b16 v[200:201], v7 offset:8256
  ds_read_b64_tr_b16 v[202:203], v7 offset:8768
  ds_read_b64_tr_b16 v[204:205], v7 offset:12352
  ds_read_b64_tr_b16 v[206:207], v7 offset:12864
  s_waitcnt lgkmcnt(6)
  ds_read_b64_tr_b16 v[208:209], v7 offset:16448
  ds_read_b64_tr_b16 v[210:211], v7 offset:16960
  ds_read_b64_tr_b16 v[212:213], v7 offset:20544
  ds_read_b64_tr_b16 v[214:215], v7 offset:21056
  ds_read_b64_tr_b16 v[216:217], v7 offset:24640
  ds_read_b64_tr_b16 v[218:219], v7 offset:25152
  ds_read_b64_tr_b16 v[220:221], v7 offset:28736
  ds_read_b64_tr_b16 v[222:223], v7 offset:29248
  s_waitcnt lgkmcnt(6)
  ds_read_b64_tr_b16 v[224:225], v7 offset:96
  ds_read_b64_tr_b16 v[226:227], v7 offset:608
  ds_read_b64_tr_b16 v[228:229], v7 offset:4192
  ds_read_b64_tr_b16 v[230:231], v7 offset:4704
  ds_read_b64_tr_b16 v[232:233], v7 offset:8288
  ds_read_b64_tr_b16 v[234:235], v7 offset:8800
  ds_read_b64_tr_b16 v[236:237], v7 offset:12384
  ds_read_b64_tr_b16 v[238:239], v7 offset:12896
  s_waitcnt lgkmcnt(6)
  ds_read_b64_tr_b16 v[240:241], v7 offset:16480
  ds_read_b64_tr_b16 v[242:243], v7 offset:16992
  ds_read_b64_tr_b16 v[244:245], v7 offset:20576
  ds_read_b64_tr_b16 v[246:247], v7 offset:21088
  ds_read_b64_tr_b16 v[248:249], v7 offset:24672
  ds_read_b64_tr_b16 v[250:251], v7 offset:25184
  ds_read_b64_tr_b16 v[252:253], v7 offset:28768
  ds_read_b64_tr_b16 v[254:255], v7 offset:29280
  s_waitcnt lgkmcnt(6)
  s_waitcnt vmcnt(21) lgkmcnt(0)
  s_cmp_lg_u32 s16, 3
  s_cbranch_scc1 w3_21
  s_waitcnt vmcnt(5)
w3_21:
  ds_read_b128 v[52:55], v32 offset:0
  ds_read_b128 v[56:59], v33 offset:0
  ds_read_b128 v[60:63], v34 offset:0
  ds_read_b128 v[64:67], v35 offset:0
  s_waitcnt lgkmcnt(3)
  v_mfma_f32_16x16x32_bf16 v[96:99], v[52:55], v[128:131], 0
  v_mfma_f32_16x16x32_bf16 v[100:103], v[52:55], v[160:163], 0
  v_mfma_f32_16x16x32_bf16 v[104:107], v[52:55], v[192:195], 0
  v_mfma_f32_16x16x32_bf16 v[108:111], v[52:55], v[224:227], 0
  ds_read_b128 v[52:55], v32 offset:256
  s_waitcnt lgkmcnt(3)
  v_mfma_f32_16x16x32_bf16 v[96:99], v[56:59], v[132:135], v[96:99]
  v_mfma_f32_16x16x32_bf16 v[100:103], v[56:59], v[164:167], v[100:103]
  v_mfma_f32_16x16x32_bf16 v[104:107], v[56:59], v[196:199], v[104:107]
  v_mfma_f32_16x16x32_bf16 v[108:111], v[56:59], v[228:231], v[108:111]
  ds_read_b128 v[56:59], v33 offset:256
  s_waitcnt lgkmcnt(3)
  v_mfma_f32_16x16x32_bf16 v[96:99], v[60:63], v[136:139], v[96:99]
  v_mfma_f32_16x16x32_bf16 v[100:103], v[60:63], v[168:171], v[100:103]
  v_mfma_f32_16x16x32_bf16 v[104:107], v[60:63], v[200:203], v[104:107]
  v_mfma_f32_16x16x32_bf16 v[108:111], v[60:63], v[232:235], v[108:111]
  ds_read_b128 v[60:63], v34 offset:256
  s_waitcnt lgkmcnt(3)
  v_mfma_f32_16x16x32_bf16 v[96:99], v[64:67], v[140:143], v[96:99]
  v_mfma_f32_16x16x32_bf16 v[100:103], v[64:67], v[172:175], v[100:103]
  v_mfma_f32_16x16x32_bf16 v[104:107], v[64:67], v[204:207], v[104:107]
  v_mfma_f32_16x16x32_bf16 v[108:111], v[64:67], v[236:239], v[108:111]
  ds_read_b128 v[64:67], v35 offset:256
  s_waitcnt lgkmcnt(3)
  v_mfma_f32_16x16x32_bf16 v[96:99], v[52:55], v[144:147], v[96:99]
  v_mfma_f32_16x16x32_bf16 v[100:103], v[52:55], v[176:179], v[100:103]
  v_mfma_f32_16x16x32_bf16 v[104:107], v[52:55], v[208:211], v[104:107]
  v_mfma_f32_16x16x32_bf16 v[108:111], v[52:55], v[240:243], v[108:111]
  ds_read_b128 v[52:55], v32 offset:2048
  s_waitcnt lgkmcnt(3)
  v_mfma_f32_16x16x32_bf16 v[96:99], v[56:59], v[148:151], v[96:99]
  v_mfma_f32_16x16x32_bf16 v[100:103], v[56:59], v[180:183], v[100:103]
  v_mfma_f32_16x16x32_bf16 v[104:107], v[56:59], v[212:215], v[104:107]
  v_mfma_f32_16x16x32_bf16 v[108:111], v[56:59], v[244:247], v[108:111]
  ds_read_b128 v[56:59], v33 offset:2048
  s_waitcnt lgkmcnt(3)
  v_mfma_f32_16x16x32_bf16 v[96:99], v[60:63], v[152:155], v[96:99]
  v_mfma_f32_16x16x32_bf16 v[100:103], v[60:63], v[184:187], v[100:103]
  v_mfma_f32_16x16x32_bf16 v[104:107], v[60:63], v[216:219], v[104:107]
  v_mfma_f32_16x16x32_bf16 v[108:111], v[60:63], v[248:251], v[108:111]
  ds_read_b128 v[60:63], v34 offset:2048
  s_waitcnt lgkmcnt(3)
  v_mfma_f32_16x16x32_bf16 v[96:99], v[64:67], v[156:159], v[96:99]
  v_mfma_f32_16x16x32_bf16 v[100:103], v[64:67], v[188:191], v[100:103]
  v_mfma_f32_16x16x32_bf16 v[104:107], v[64:67], v[220:223], v[104:107]
  v_mfma_f32_16x16x32_bf16 v[108:111], v[64:67], v[252:255], v[108:111]
  ds_read_b128 v[64:67], v35 offset:2048
  s_waitcnt lgkmcnt(3)
  v_mfma_f32_16x16x32_bf16 v[112:115], v[52:55], v[128:131], 0
  v_mfma_f32_16x16x32_bf16 v[116:119], v[52:55], v[160:163], 0
  v_mfma_f32_16x16x32_bf16 v[120:123], v[52:55], v[192:195], 0
  v_mfma_f32_16x16x32_bf16 v[124:127], v[52:55], v[224:227], 0
  ds_read_b128 v[52:55], v32 offset:2304
  s_waitcnt lgkmcnt(3)
  v_mfma_f32_16x16x32_bf16 v[112:115], v[56:59], v[132:135], v[112:115]
  v_mfma_f32_16x16x32_bf16 v[116:119], v[56:59], v[164:167], v[116:119]
  v_mfma_f32_16x16x32_bf16 v[120:123], v[56:59], v[196:199], v[120:123]
  v_mfma_f32_16x16x32_bf16 v[124:127], v[56:59], v[228:231], v[124:127]
  ds_read_b128 v[56:59], v33 offset:2304
  s_waitcnt lgkmcnt(3)
  v_mfma_f32_16x16x32_bf16 v[112:115], v[60:63], v[136:139], v[112:115]
  v_mfma_f32_16x16x32_bf16 v[116:119], v[60:63], v[168:171], v[116:119]
  v_mfma_f32_16x16x32_bf16 v[120:123], v[60:63], v[200:203], v[120:123]
  v_mfma_f32_16x16x32_bf16 v[124:127], v[60:63], v[232:235], v[124:127]
  ds_read_b128 v[60:63], v34 offset:2304
  s_waitcnt lgkmcnt(3)
  v_mfma_f32_16x16x32_bf16 v[112:115], v[64:67], v[140:143], v[112:115]
  v_mfma_f32_16x16x32_bf16 v[116:119], v[64:67], v[172:175], v[116:119]
  v_mfma_f32_16x16x32_bf16 v[120:123], v[64:67], v[204:207], v[120:123]
  v_mfma_f32_16x16x32_bf16 v[124:127], v[64:67], v[236:239], v[124:127]
  ds_read_b128 v[64:67], v35 offset:2304
  s_waitcnt lgkmcnt(3)
  v_mfma_f32_16x16x32_bf16 v[112:115], v[52:55], v[144:147], v[112:115]
  v_mfma_f32_16x16x32_bf16 v[116:119], v[52:55], v[176:179], v[116:119]
  v_mfma_f32_16x16x32_bf16 v[120:123], v[52:55], v[208:211], v[120:123]
  v_mfma_f32_16x16x32_bf16 v[124:127], v[52:55], v[240:243], v[124:127]
  s_waitcnt lgkmcnt(2)
  v_mfma_f32_16x16x32_bf16 v[112:115], v[56:59], v[148:151], v[112:115]
  v_mfma_f32_16x16x32_bf16 v[116:119], v[56:59], v[180:183], v[116:119]
  v_mfma_f32_16x16x32_bf16 v[120:123], v[56:59], v[212:215], v[120:123]
  v_mfma_f32_16x16x32_bf16 v[124:127], v[56:59], v[244:247], v[124:127]
  s_waitcnt lgkmcnt(1)
  v_mfma_f32_16x16x32_bf16 v[112:115], v[60:63], v[152:155], v[112:115]
  v_mfma_f32_16x16x32_bf16 v[116:119], v[60:63], v[184:187], v[116:119]
  v_mfma_f32_16x16x32_bf16 v[120:123], v[60:63], v[216:219], v[120:123]
  v_mfma_f32_16x16x32_bf16 v[124:127], v[60:63], v[248:251], v[124:127]
  s_waitcnt lgkmcnt(0)
  v_mfma_f32_16x16x32_bf16 v[112:115], v[64:67], v[156:159], v[112:115]
  v_mfma_f32_16x16x32_bf16 v[116:119], v[64:67], v[188:191], v[116:119]
  v_mfma_f32_16x16x32_bf16 v[120:123], v[64:67], v[220:223], v[120:123]
  v_mfma_f32_16x16x32_bf16 v[124:127], v[64:67], v[252:255], v[124:127]
  s_cmp_lg_u32 s66, 0
  s_cbranch_scc1 bj_cf
  s_cmp_lg_u32 s16, 0
  s_cbranch_scc1 w0_22
  s_waitcnt vmcnt(0)
  v_readfirstlane_b32 s70, v46
  s_cmp_lg_u32 s70, 0
  s_cbranch_scc1 bj_nz
  v_mov_b32 v45, 128
  v_mov_b32 v46, s88
  v_mov_b32 v47, s89
  v_mov_b32 v48, 0
  v_mov_b32 v49, 0
  s_mov_b64 exec, 1
  buffer_atomic_cmpswap_x2 v[46:49], v45, s[12:15], 0 offen sc0
  s_mov_b64 exec, -1
  s_waitcnt vmcnt(0)
  v_readfirstlane_b32 s70, v46
  s_cmp_lg_u32 s70, 0
  s_cbranch_scc1 bj_nz
  v_mov_b32 v46, s88
  v_mov_b32 v47, s89
bj_nz:
w0_22:
  v_mov_b32 v45, 160000
  s_add_u32 s101, s101, 1
  s_barrier
  s_mov_b64 exec, 1
  s_cmp_lg_u32 s16, 0
  s_cbranch_scc1 w0_23
  ds_write_b32 v45, v44 offset:0
  ds_write_b32 v45, v46 offset:4
  ds_write_b32 v45, v47 offset:8
  s_waitcnt lgkmcnt(0)
  v_mov_b32 v44, s101
  ds_write_b32 v45, v44 offset:16
  s_waitcnt lgkmcnt(0)
w0_23:
  s_mov_b64 exec, -1
  s_barrier
  ds_read_b32 v44, v45 offset:0
  ds_read_b32 v46, v45 offset:4
  ds_read_b32 v47, v45 offset:8
  ds_read_b32 v45, v45 offset:16
  s_waitcnt lgkmcnt(0)
  v_readfirstlane_b32 s70, v44
  v_readfirstlane_b32 s88, v46
  v_readfirstlane_b32 s89, v47
  v_cmp_ne_u32 vcc, s101, v45
  s_cbranch_vccnz ch_end
  s_mov_b32 s66, 1
  s_bitcmp1_b32 s70, s3
  s_cbranch_scc1 m_reclaim
bj_cf:
  s_lshl_b32 s30, s28, 10
  v_cvt_pk_bf16_f32 v68, v96, v97
  v_cvt_pk_bf16_f32 v69, v98, v99
  v_cvt_pk_bf16_f32 v70, v112, v113
  v_cvt_pk_bf16_f32 v71, v114, v115
  buffer_store_dwordx4 v[68:71], v12, s[8:11], s30 offen sc1
  v_cvt_pk_bf16_f32 v72, v100, v101
  v_cvt_pk_bf16_f32 v73, v102, v103
  v_cvt_pk_bf16_f32 v74, v116, v117
  v_cvt_pk_bf16_f32 v75, v118, v119
  buffer_store_dwordx4 v[72:75], v13, s[8:11], s30 offen sc1
  v_cvt_pk_bf16_f32 v76, v104, v105
  v_cvt_pk_bf16_f32 v77, v106, v107
  v_cvt_pk_bf16_f32 v78, v120, v121
  v_cvt_pk_bf16_f32 v79, v122, v123
  buffer_store_dwordx4 v[76:79], v14, s[8:11], s30 offen sc1
  v_cvt_pk_bf16_f32 v80, v108, v109
  v_cvt_pk_bf16_f32 v81, v110, v111
  v_cvt_pk_bf16_f32 v82, v124, v125
  v_cvt_pk_bf16_f32 v83, v126, v127
  buffer_store_dwordx4 v[80:83], v15, s[8:11], s30 offen sc1
  s_cmp_eq_u32 s16, 3
  s_cbranch_scc1 bj_w3
  s_waitcnt vmcnt(9)
  ds_read_b128 v[52:55], v32 offset:16384
  ds_read_b128 v[56:59], v33 offset:16384
  ds_read_b128 v[60:63], v34 offset:16384
  ds_read_b128 v[64:67], v35 offset:16384
  s_waitcnt lgkmcnt(3)
  v_mfma_f32_16x16x32_bf16 v[96:99], v[52:55], v[128:131], 0
  v_mfma_f32_16x16x32_bf16 v[100:103], v[52:55], v[160:163], 0
  v_mfma_f32_16x16x32_bf16 v[104:107], v[52:55], v[192:195], 0
  v_mfma_f32_16x16x32_bf16 v[108:111], v[52:55], v[224:227], 0
  ds_read_b128 v[52:55], v32 offset:16640
  s_waitcnt lgkmcnt(3)
  v_mfma_f32_16x16x32_bf16 v[96:99], v[56:59], v[132:135], v[96:99]
  v_mfma_f32_16x16x32_bf16 v[100:103], v[56:59], v[164:167], v[100:103]
  v_mfma_f32_16x16x32_bf16 v[104:107], v[56:59], v[196:199], v[104:107]
  v_mfma_f32_16x16x32_bf16 v[108:111], v[56:59], v[228:231], v[108:111]
  ds_read_b128 v[56:59], v33 offset:16640
  s_waitcnt lgkmcnt(3)
  v_mfma_f32_16x16x32_bf16 v[96:99], v[60:63], v[136:139], v[96:99]
  v_mfma_f32_16x16x32_bf16 v[100:103], v[60:63], v[168:171], v[100:103]
  v_mfma_f32_16x16x32_bf16 v[104:107], v[60:63], v[200:203], v[104:107]
  v_mfma_f32_16x16x32_bf16 v[108:111], v[60:63], v[232:235], v[108:111]
  ds_read_b128 v[60:63], v34 offset:16640
  s_waitcnt lgkmcnt(3)
  v_mfma_f32_16x16x32_bf16 v[96:99], v[64:67], v[140:143], v[96:99]
  v_mfma_f32_16x16x32_bf16 v[100:103], v[64:67], v[172:175], v[100:103]
  v_mfma_f32_16x16x32_bf16 v[104:107], v[64:67], v[204:207], v[104:107]
  v_mfma_f32_16x16x32_bf16 v[108:111], v[64:67], v[236:239], v[108:111]
  ds_read_b128 v[64:67], v35 offset:16640
  s_waitcnt lgkmcnt(3)
  v_mfma_f32_16x16x32_bf16 v[96:99], v[52:55], v[144:147], v[96:99]
  v_mfma_f32_16x16x32_bf16 v[100:103], v[52:55], v[176:179], v[100:103]
  v_mfma_f32_16x16x32_bf16 v[104:107], v[52:55], v[208:211], v[104:107]
  v_mfma_f32_16x16x32_bf16 v[108:111], v[52:55], v[240:243], v[108:111]
  ds_read_b128 v[52:55], v32 offset:18432
  s_waitcnt lgkmcnt(3)
  v_mfma_f32_16x16x32_bf16 v[96:99], v[56:59], v[148:151], v[96:99]
  v_mfma_f32_16x16x32_bf16 v[100:103], v[56:59], v[180:183], v[100:103]
  v_mfma_f32_16x16x32_bf16 v[104:107], v[56:59], v[212:215], v[104:107]
  v_mfma_f32_16x16x32_bf16 v[108:111], v[56:59], v[244:247], v[108:111]
  ds_read_b128 v[56:59], v33 offset:18432
  s_waitcnt lgkmcnt(3)
  v_mfma_f32_16x16x32_bf16 v[96:99], v[60:63], v[152:155], v[96:99]
  v_mfma_f32_16x16x32_bf16 v[100:103], v[60:63], v[184:187], v[100:103]
  v_mfma_f32_16x16x32_bf16 v[104:107], v[60:63], v[216:219], v[104:107]
  v_mfma_f32_16x16x32_bf16 v[108:111], v[60:63], v[248:251], v[108:111]
  ds_read_b128 v[60:63], v34 offset:18432
  s_waitcnt lgkmcnt(3)
  v_mfma_f32_16x16x32_bf16 v[96:99], v[64:67], v[156:159], v[96:99]
  v_mfma_f32_16x16x32_bf16 v[100:103], v[64:67], v[188:191], v[100:103]
  v_mfma_f32_16x16x32_bf16 v[104:107], v[64:67], v[220:223], v[104:107]
  v_mfma_f32_16x16x32_bf16 v[108:111], v[64:67], v[252:255], v[108:111]
  ds_read_b128 v[64:67], v35 offset:18432
  s_waitcnt lgkmcnt(3)
  v_mfma_f32_16x16x32_bf16 v[112:115], v[52:55], v[128:131], 0
  v_mfma_f32_16x16x32_bf16 v[116:119], v[52:55], v[160:163], 0
  v_mfma_f32_16x16x32_bf16 v[120:123], v[52:55], v[192:195], 0
  v_mfma_f32_16x16x32_bf16 v[124:127], v[52:55], v[224:227], 0
  ds_read_b128 v[52:55], v32 offset:18688
  s_waitcnt lgkmcnt(3)
  v_mfma_f32_16x16x32_bf16 v[112:115], v[56:59], v[132:135], v[112:115]
  v_mfma_f32_16x16x32_bf16 v[116:119], v[56:59], v[164:167], v[116:119]
  v_mfma_f32_16x16x32_bf16 v[120:123], v[56:59], v[196:199], v[120:123]
  v_mfma_f32_16x16x32_bf16 v[124:127], v[56:59], v[228:231], v[124:127]
  ds_read_b128 v[56:59], v33 offset:18688
  s_waitcnt lgkmcnt(3)
  v_mfma_f32_16x16x32_bf16 v[112:115], v[60:63], v[136:139], v[112:115]
  v_mfma_f32_16x16x32_bf16 v[116:119], v[60:63], v[168:171], v[116:119]
  v_mfma_f32_16x16x32_bf16 v[120:123], v[60:63], v[200:203], v[120:123]
  v_mfma_f32_16x16x32_bf16 v[124:127], v[60:63], v[232:235], v[124:127]
  ds_read_b128 v[60:63], v34 offset:18688
  s_waitcnt lgkmcnt(3)
  v_mfma_f32_16x16x32_bf16 v[112:115], v[64:67], v[140:143], v[112:115]
  v_mfma_f32_16x16x32_bf16 v[116:119], v[64:67], v[172:175], v[116:119]
  v_mfma_f32_16x16x32_bf16 v[120:123], v[64:67], v[204:207], v[120:123]
  v_mfma_f32_16x16x32_bf16 v[124:127], v[64:67], v[236:239], v[124:127]
  ds_read_b128 v[64:67], v35 offset:18688
  s_waitcnt lgkmcnt(3)
  v_mfma_f32_16x16x32_bf16 v[112:115], v[52:55], v[144:147], v[112:115]
  v_mfma_f32_16x16x32_bf16 v[116:119], v[52:55], v[176:179], v[116:119]
  v_mfma_f32_16x16x32_bf16 v[120:123], v[52:55], v[208:211], v[120:123]
  v_mfma_f32_16x16x32_bf16 v[124:127], v[52:55], v[240:243], v[124:127]
  s_waitcnt lgkmcnt(2)
  v_mfma_f32_16x16x32_bf16 v[112:115], v[56:59], v[148:151], v[112:115]
  v_mfma_f32_16x16x32_bf16 v[116:119], v[56:59], v[180:183], v[116:119]
  v_mfma_f32_16x16x32_bf16 v[120:123], v[56:59], v[212:215], v[120:123]
  v_mfma_f32_16x16x32_bf16 v[124:127], v[56:59], v[244:247], v[124:127]
  s_waitcnt lgkmcnt(1)
  v_mfma_f32_16x16x32_bf16 v[112:115], v[60:63], v[152:155], v[112:115]
  v_mfma_f32_16x16x32_bf16 v[116:119], v[60:63], v[184:187], v[116:119]
  v_mfma_f32_16x16x32_bf16 v[120:123], v[60:63], v[216:219], v[120:123]
  v_mfma_f32_16x16x32_bf16 v[124:127], v[60:63], v[248:251], v[124:127]
  s_waitcnt lgkmcnt(0)
  v_mfma_f32_16x16x32_bf16 v[112:115], v[64:67], v[156:159], v[112:115]
  v_mfma_f32_16x16x32_bf16 v[116:119], v[64:67], v[188:191], v[116:119]
  v_mfma_f32_16x16x32_bf16 v[120:123], v[64:67], v[220:223], v[120:123]
  v_mfma_f32_16x16x32_bf16 v[124:127], v[64:67], v[252:255], v[124:127]
  s_lshl_b32 s30, s29, 10
  v_cvt_pk_bf16_f32 v68, v96, v97
  v_cvt_pk_bf16_f32 v69, v98, v99
  v_cvt_pk_bf16_f32 v70, v112, v113
  v_cvt_pk_bf16_f32 v71, v114, v115
  buffer_store_dwordx4 v[68:71], v12, s[8:11], s30 offen sc1
  v_cvt_pk_bf16_f32 v72, v100, v101
  v_cvt_pk_bf16_f32 v73, v102, v103
  v_cvt_pk_bf16_f32 v74, v116, v117
  v_cvt_pk_bf16_f32 v75, v118, v119
  buffer_store_dwordx4 v[72:75], v13, s[8:11], s30 offen sc1
  v_cvt_pk_bf16_f32 v76, v104, v105
  v_cvt_pk_bf16_f32 v77, v106, v107
  v_cvt_pk_bf16_f32 v78, v120, v121
  v_cvt_pk_bf16_f32 v79, v122, v123
  buffer_store_dwordx4 v[76:79], v14, s[8:11], s30 offen sc1
  v_cvt_pk_bf16_f32 v80, v108, v109
  v_cvt_pk_bf16_f32 v81, v110, v111
  v_cvt_pk_bf16_f32 v82, v124, v125
  v_cvt_pk_bf16_f32 v83, v126, v127
  buffer_store_dwordx4 v[80:83], v15, s[8:11], s30 offen sc1
bj_w3:
  s_lshl_b32 s77, s19, 8
  s_lshl_b32 s21, s17, 4
  s_add_u32 s77, s77, s21
  s_cmp_lg_u32 s31, 0
  s_cselect_b32 s21, 8, 0
  s_add_u32 s77, s77, s21
  s_add_u32 s77, s77, 88588288
  s_add_u32 s78, s77, 2048
  s_cmp_lt_u32 s19, 3
  s_cbranch_scc1 bj_a1
  s_waitcnt vmcnt(4)
  v_mov_b32 v96, v84
  v_mov_b32 v100, v85
  v_min_u32 v104, -2, v36
  v_min_u32 v108, -2, v37
  v_mov_b32 v97, v86
  v_mov_b32 v101, v87
  v_min_u32 v105, -2, v38
  v_min_u32 v109, -2, v39
  v_mov_b32 v98, v88
  v_mov_b32 v102, v89
  v_min_u32 v106, -2, v40
  v_min_u32 v110, -2, v41
  v_mov_b32 v99, v90
  v_mov_b32 v103, v91
  v_min_u32 v107, -2, v42
  v_min_u32 v111, -2, v43
  s_mov_b32 s20, 71565312
  s_mov_b32 s21, 73400320
  buffer_store_dwordx4 v[84:87], v92, s[8:11], s20 offen sc1
  buffer_store_dwordx4 v[88:91], v92, s[8:11], s20 offen offset:256 sc1
  buffer_store_dwordx4 v[96:99], v93, s[8:11], s21 offen sc1
  buffer_store_dwordx4 v[100:103], v93, s[8:11], s21 offen offset:1024 sc1
  s_cmp_lg_u32 s18, 0
  s_cbranch_scc1 bi_nm
  s_mov_b32 s20, 75235328
  s_mov_b32 s21, 88068096
  buffer_store_dwordx4 v[104:107], v94, s[8:11], s20 offen sc1
  buffer_store_dwordx4 v[108:111], v94, s[8:11], s20 offen offset:128 sc1
  buffer_store_dwordx4 v[104:107], v94, s[8:11], s21 offen sc1
  buffer_store_dwordx4 v[108:111], v94, s[8:11], s21 offen offset:128 sc1
bi_nm:
  s_waitcnt vmcnt(4)
  s_mov_b32 s23, 75235328
  v_add_u32 v6, 448, v95
  v_subrev_u32 v7, 1344, v6
  v_mov_b32 v52, -1
  v_mov_b32 v9, 0
  v_cmp_gt_u32 vcc, 256, v7
  s_nop 1
  v_cndmask_b32 v52, v52, v9, vcc
  v_mov_b32 v53, v52
  v_mov_b32 v54, v52
  v_mov_b32 v55, v52
  v_lshlrev_b32 v8, 4, v6
  v_mov_b32 v9, 0x10000000
  v_cmp_lt_u32 vcc, 105599, v6
  s_nop 1
  v_cndmask_b32 v8, v8, v9, vcc
  buffer_store_dwordx4 v[52:55], v8, s[8:11], s23 offen sc1
  v_add_u32 v6, 57792, v95
  v_subrev_u32 v7, 1344, v6
  v_mov_b32 v56, -1
  v_mov_b32 v9, 0
  v_cmp_gt_u32 vcc, 256, v7
  s_nop 1
  v_cndmask_b32 v56, v56, v9, vcc
  v_mov_b32 v57, v56
  v_mov_b32 v58, v56
  v_mov_b32 v59, v56
  v_lshlrev_b32 v8, 4, v6
  v_mov_b32 v9, 0x10000000
  v_cmp_lt_u32 vcc, 105599, v6
  s_nop 1
  v_cndmask_b32 v8, v8, v9, vcc
  buffer_store_dwordx4 v[56:59], v8, s[8:11], s23 offen sc1
  s_mov_b32 s23, 88068096
  v_add_u32 v6, 448, v95
  v_subrev_u32 v7, 28672, v6
  v_mov_b32 v60, -1
  v_mov_b32 v9, 0
  v_cmp_gt_u32 vcc, 1048576, v7
  s_nop 1
  v_cndmask_b32 v60, v60, v9, vcc
  v_mov_b32 v61, v60
  v_mov_b32 v62, v60
  v_mov_b32 v63, v60
  v_lshlrev_b32 v8, 4, v6
  v_mov_b32 v9, 0x10000000
  v_cmp_lt_u32 vcc, 32511, v6
  s_nop 1
  v_cndmask_b32 v8, v8, v9, vcc
  buffer_store_dwordx4 v[60:63], v8, s[8:11], s23 offen sc1
  s_barrier
  s_cmp_lg_u32 s16, 0
  s_cbranch_scc1 pub_24
  v_mul_u32_u24 v26, 2048, v1
  v_mov_b32 v24, s88
  v_mov_b32 v25, s89
  s_mov_b64 exec, 1
  buffer_store_dwordx2 v[24:25], v26, s[8:11], s77 offen sc1
  s_mov_b64 exec, -1
pub_24:
  s_waitcnt vmcnt(0)
  s_barrier
  s_cmp_lg_u32 s16, 0
  s_cbranch_scc1 pub_25
  v_mul_u32_u24 v26, 2048, v1
  v_mov_b32 v24, s88
  v_mov_b32 v25, s89
  s_mov_b64 exec, 511
  buffer_store_dwordx2 v[24:25], v26, s[8:11], s78 offen sc1
  s_mov_b64 exec, -1
pub_25:
  s_branch bj_end
bj_a1:
  s_add_u32 s19, s19, 4
  s_waitcnt vmcnt(4)
  v_mov_b32 v96, v84
  v_mov_b32 v100, v85
  v_min_u32 v104, -2, v36
  v_min_u32 v108, -2, v37
  v_mov_b32 v97, v86
  v_mov_b32 v101, v87
  v_min_u32 v105, -2, v38
  v_min_u32 v109, -2, v39
  v_mov_b32 v98, v88
  v_mov_b32 v102, v89
  v_min_u32 v106, -2, v40
  v_min_u32 v110, -2, v41
  v_mov_b32 v99, v90
  v_mov_b32 v103, v91
  v_min_u32 v107, -2, v42
  v_min_u32 v111, -2, v43
  s_mov_b32 s20, 71565312
  s_mov_b32 s21, 73400320
  buffer_store_dwordx4 v[84:87], v92, s[8:11], s20 offen sc1
  buffer_store_dwordx4 v[88:91], v92, s[8:11], s20 offen offset:256 sc1
  buffer_store_dwordx4 v[96:99], v93, s[8:11], s21 offen sc1
  buffer_store_dwordx4 v[100:103], v93, s[8:11], s21 offen offset:1024 sc1
  s_cmp_lg_u32 s18, 0
  s_cbranch_scc1 bk_nm
  s_mov_b32 s20, 75235328
  s_mov_b32 s21, 88068096
  buffer_store_dwordx4 v[104:107], v94, s[8:11], s20 offen sc1
  buffer_store_dwordx4 v[108:111], v94, s[8:11], s20 offen offset:128 sc1
  buffer_store_dwordx4 v[104:107], v94, s[8:11], s21 offen sc1
  buffer_store_dwordx4 v[108:111], v94, s[8:11], s21 offen offset:128 sc1
bk_nm:
  s_mov_b32 s23, 75235328
  v_add_u32 v6, 448, v95
  v_subrev_u32 v7, 1344, v6
  v_mov_b32 v52, -1
  v_mov_b32 v9, 0
  v_cmp_gt_u32 vcc, 256, v7
  s_nop 1
  v_cndmask_b32 v52, v52, v9, vcc
  v_mov_b32 v53, v52
  v_mov_b32 v54, v52
  v_mov_b32 v55, v52
  v_lshlrev_b32 v8, 4, v6
  v_mov_b32 v9, 0x10000000
  v_cmp_lt_u32 vcc, 105599, v6
  s_nop 1
  v_cndmask_b32 v8, v8, v9, vcc
  buffer_store_dwordx4 v[52:55], v8, s[8:11], s23 offen sc1
  v_add_u32 v6, 57792, v95
  v_subrev_u32 v7, 1344, v6
  v_mov_b32 v56, -1
  v_mov_b32 v9, 0
  v_cmp_gt_u32 vcc, 256, v7
  s_nop 1
  v_cndmask_b32 v56, v56, v9, vcc
  v_mov_b32 v57, v56
  v_mov_b32 v58, v56
  v_mov_b32 v59, v56
  v_lshlrev_b32 v8, 4, v6
  v_mov_b32 v9, 0x10000000
  v_cmp_lt_u32 vcc, 105599, v6
  s_nop 1
  v_cndmask_b32 v8, v8, v9, vcc
  buffer_store_dwordx4 v[56:59], v8, s[8:11], s23 offen sc1
  s_mov_b32 s23, 88068096
  v_add_u32 v6, 448, v95
  v_subrev_u32 v7, 28672, v6
  v_mov_b32 v60, -1
  v_mov_b32 v9, 0
  v_cmp_gt_u32 vcc, 1048576, v7
  s_nop 1
  v_cndmask_b32 v60, v60, v9, vcc
  v_mov_b32 v61, v60
  v_mov_b32 v62, v60
  v_mov_b32 v63, v60
  v_lshlrev_b32 v8, 4, v6
  v_mov_b32 v9, 0x10000000
  v_cmp_lt_u32 vcc, 32511, v6
  s_nop 1
  v_cndmask_b32 v8, v8, v9, vcc
  buffer_store_dwordx4 v[60:63], v8, s[8:11], s23 offen sc1
  s_barrier
  s_mov_b32 s60, s40
  s_and_b32 s61, s41, 0xffff
  s_mov_b32 s62, 3670016
  s_mov_b32 s63, 0x20000
  s_mov_b32 s56, s42
  s_and_b32 s57, s43, 0xffff
  s_mov_b32 s58, 3670016
  s_mov_b32 s59, 0x20000
  s_lshl_b32 s30, s16, 13
  s_lshl_b32 s27, s19, 19
  s_lshl_b32 s29, s16, 17
  s_add_u32 s27, s27, s29
  s_lshl_b32 s29, s17, 9
  s_add_u32 s27, s27, s29
  v_lshrrev_b32 v5, 5, v1
  v_and_b32 v6, 31, v1
  v_xor_b32 v6, v6, v5
  v_lshlrev_b32 v6, 4, v6
  v_lshl_add_u32 v6, v5, 13, v6
  s_add_u32 m0, s30, 0
  s_add_u32 s22, s27, 0
  v_xor_b32 v7, 0, v6
  buffer_load_dwordx4 v7, s[56:59], s22 offen offset:0 lds
  s_add_u32 s22, s27, 15360
  v_xor_b32 v7, 32, v6
  buffer_load_dwordx4 v7, s[56:59], s22 offen offset:1024 lds
  s_add_u32 s22, s27, 30720
  v_xor_b32 v7, 64, v6
  buffer_load_dwordx4 v7, s[56:59], s22 offen offset:2048 lds
  s_add_u32 s22, s27, 46080
  v_xor_b32 v7, 96, v6
  buffer_load_dwordx4 v7, s[56:59], s22 offen offset:3072 lds
  s_add_u32 m0, s30, 4096
  s_add_u32 s22, s27, 65536
  v_xor_b32 v7, 128, v6
  buffer_load_dwordx4 v7, s[56:59], s22 offen offset:0 lds
  s_add_u32 s22, s27, 80896
  v_xor_b32 v7, 160, v6
  buffer_load_dwordx4 v7, s[56:59], s22 offen offset:1024 lds
  s_add_u32 s22, s27, 96256
  v_xor_b32 v7, 192, v6
  buffer_load_dwordx4 v7, s[56:59], s22 offen offset:2048 lds
  s_add_u32 s22, s27, 111616
  v_xor_b32 v7, 224, v6
  buffer_load_dwordx4 v7, s[56:59], s22 offen offset:3072 lds
  s_waitcnt vmcnt(8)
  s_barrier
  s_cmp_lg_u32 s16, 0
  s_cbranch_scc1 pub_26
  v_mul_u32_u24 v46, 2048, v1
  v_mov_b32 v44, s88
  v_mov_b32 v45, s89
  s_mov_b64 exec, 1
  buffer_store_dwordx2 v[44:45], v46, s[8:11], s77 offen sc1
  s_mov_b64 exec, -1
pub_26:
  s_cmp_lg_u32 s16, 0
  s_cbranch_scc1 w0_27
  v_mul_u32_u24 v50, 2048, v1
  v_mov_b32 v48, s88
  v_mov_b32 v49, s89
  s_mov_b64 exec, 511
  buffer_store_dwordx2 v[48:49], v50, s[8:11], s78 offen sc1
  s_mov_b64 exec, -1
w0_27:
  v_lshrrev_b32 v5, 5, v1
  v_and_b32 v6, 31, v1
  s_lshl_b32 s25, s16, 15
  s_add_u32 s25, s25, 32768
  s_lshl_b32 s26, s17, 9
  s_add_u32 s28, s19, s16
  s_cmp_ge_u32 s28, 7
  s_cselect_b32 s20, 7, 0
  s_sub_u32 s28, s28, s20
  s_add_u32 s28, s28, s31
  s_add_u32 s29, s19, s16
  s_add_u32 s29, s29, 4
  s_cmp_ge_u32 s29, 7
  s_cselect_b32 s20, 7, 0
  s_sub_u32 s29, s29, s20
  s_add_u32 s29, s29, s31
  s_lshl_b32 s32, s28, 18
  s_add_u32 s32, s32, s26
  s_lshl_b32 s33, s29, 18
  s_add_u32 s33, s33, s26
  v_xor_b32 v8, v6, v5
  v_lshlrev_b32 v8, 4, v8
  v_lshl_add_u32 v8, v5, 13, v8
  v_xor_b32 v12, 0, v8
  v_xor_b32 v13, 32, v8
  v_add_u32 v13, 15360, v13
  v_xor_b32 v14, 0, v8
  v_add_u32 v14, 30720, v14
  v_xor_b32 v15, 32, v8
  v_add_u32 v15, 46080, v15
  s_add_u32 s20, s16, 0
  s_and_b32 s20, s20, 3
  s_mul_i32 s21, s20, 65600
  s_lshl_b32 s20, s20, 12
  s_add_u32 s48, s20, s25
  s_mov_b32 m0, s48
  v_xor_b32 v16, s21, v12
  buffer_load_dwordx4 v16, s[60:63], s32 offen offset:0 lds
  v_xor_b32 v17, s21, v13
  buffer_load_dwordx4 v17, s[60:63], s32 offen offset:1024 lds
  v_xor_b32 v18, s21, v14
  buffer_load_dwordx4 v18, s[60:63], s32 offen offset:2048 lds
  v_xor_b32 v19, s21, v15
  buffer_load_dwordx4 v19, s[60:63], s32 offen offset:3072 lds
  s_add_u32 s20, s16, 1
  s_and_b32 s20, s20, 3
  s_mul_i32 s21, s20, 65600
  s_lshl_b32 s20, s20, 12
  s_add_u32 s49, s20, s25
  s_mov_b32 m0, s49
  v_xor_b32 v20, s21, v12
  buffer_load_dwordx4 v20, s[60:63], s32 offen offset:0 lds
  v_xor_b32 v21, s21, v13
  buffer_load_dwordx4 v21, s[60:63], s32 offen offset:1024 lds
  v_xor_b32 v22, s21, v14
  buffer_load_dwordx4 v22, s[60:63], s32 offen offset:2048 lds
  v_xor_b32 v23, s21, v15
  buffer_load_dwordx4 v23, s[60:63], s32 offen offset:3072 lds
  s_add_u32 s20, s16, 2
  s_and_b32 s20, s20, 3
  s_mul_i32 s21, s20, 65600
  s_lshl_b32 s20, s20, 12
  s_add_u32 s50, s20, s25
  s_mov_b32 m0, s50
  v_xor_b32 v24, s21, v12
  buffer_load_dwordx4 v24, s[60:63], s32 offen offset:0 lds
  v_xor_b32 v25, s21, v13
  buffer_load_dwordx4 v25, s[60:63], s32 offen offset:1024 lds
  v_xor_b32 v26, s21, v14
  buffer_load_dwordx4 v26, s[60:63], s32 offen offset:2048 lds
  v_xor_b32 v27, s21, v15
  buffer_load_dwordx4 v27, s[60:63], s32 offen offset:3072 lds
  s_add_u32 s20, s16, 3
  s_and_b32 s20, s20, 3
  s_mul_i32 s21, s20, 65600
  s_lshl_b32 s20, s20, 12
  s_add_u32 s51, s20, s25
  s_mov_b32 m0, s51
  v_xor_b32 v28, s21, v12
  buffer_load_dwordx4 v28, s[60:63], s32 offen offset:0 lds
  v_xor_b32 v29, s21, v13
  buffer_load_dwordx4 v29, s[60:63], s32 offen offset:1024 lds
  v_xor_b32 v30, s21, v14
  buffer_load_dwordx4 v30, s[60:63], s32 offen offset:2048 lds
  v_xor_b32 v31, s21, v15
  buffer_load_dwordx4 v31, s[60:63], s32 offen offset:3072 lds
  s_cmp_eq_u32 s16, 3
  s_cbranch_scc1 ak_np1
  s_add_u32 m0, s48, 16384
  s_nop 0
  buffer_load_dwordx4 v16, s[60:63], s33 offen offset:0 lds
  buffer_load_dwordx4 v17, s[60:63], s33 offen offset:1024 lds
  buffer_load_dwordx4 v18, s[60:63], s33 offen offset:2048 lds
  buffer_load_dwordx4 v19, s[60:63], s33 offen offset:3072 lds
  s_add_u32 m0, s49, 16384
  s_nop 0
  buffer_load_dwordx4 v20, s[60:63], s33 offen offset:0 lds
  buffer_load_dwordx4 v21, s[60:63], s33 offen offset:1024 lds
  buffer_load_dwordx4 v22, s[60:63], s33 offen offset:2048 lds
  buffer_load_dwordx4 v23, s[60:63], s33 offen offset:3072 lds
  s_add_u32 m0, s50, 16384
  s_nop 0
  buffer_load_dwordx4 v24, s[60:63], s33 offen offset:0 lds
  buffer_load_dwordx4 v25, s[60:63], s33 offen offset:1024 lds
  buffer_load_dwordx4 v26, s[60:63], s33 offen offset:2048 lds
  buffer_load_dwordx4 v27, s[60:63], s33 offen offset:3072 lds
  s_add_u32 m0, s51, 16384
  s_nop 0
  buffer_load_dwordx4 v28, s[60:63], s33 offen offset:0 lds
  buffer_load_dwordx4 v29, s[60:63], s33 offen offset:1024 lds
  buffer_load_dwordx4 v30, s[60:63], s33 offen offset:2048 lds
  buffer_load_dwordx4 v31, s[60:63], s33 offen offset:3072 lds
ak_np1:
  s_mov_b32 s79, 1
  s_branch aj_run
bj_end:
  s_mov_b32 s3, s68
  s_cmp_lg_u32 s69, 0
  s_cbranch_scc1 wk_have
  v_mov_b32 v250, 0
  s_branch wk_ask
wk_loop:
  s_waitcnt vmcnt(0) lgkmcnt(0)
  s_cmp_eq_u32 s96, 1
  s_cbranch_scc1 wk_ask
  s_mov_b32 s96, 1
  s_cmp_lg_u32 s16, 0
  s_cbranch_scc1 w0_28
  s_mov_b32 s30, 0
  v_mov_b32 v243, 32
sf_l:
  buffer_load_dword v242, v243, s[12:15], 0 offen sc1
  s_waitcnt vmcnt(0)
  v_readfirstlane_b32 s70, v242
  s_cmp_eq_u32 s70, -1
  s_cbranch_scc1 sf_d
  s_sleep 16
  s_add_u32 s30, s30, 1
  s_cmp_lt_u32 s30, 64
  s_cbranch_scc1 sf_l
  s_mov_b32 s20, 0
  s_mov_b32 s21, 0
  s_mov_b64 exec, 1
sf_c_l:
  s_cmp_lg_u32 s70, -1
  s_cbranch_scc1 sf_c_t
  s_add_u32 s20, s20, 1
  s_cmp_lt_u32 s20, 8
  s_cselect_b32 s20, s20, 0
  s_mov_b32 s70, 0
  s_mov_b32 s3, -1
  s_add_u32 s21, s21, 1
  s_cmp_ge_u32 s21, 1
  s_cbranch_scc1 sf_c_d
sf_c_t:
  s_ff0_i32_b32 s22, s70
  s_lshl_b32 s23, 1, s22
  s_and_b32 s71, s20, 4
  s_mul_i32 s71, s71, 12
  s_lshl_b32 s3, s20, 2
  s_add_u32 s3, s3, s71
  v_mov_b32 v242, s23
  v_mov_b32 v243, 32
  buffer_atomic_or v242, v243, s[12:15], s3 offen sc0
  s_waitcnt vmcnt(0)
  v_readfirstlane_b32 s70, v242
  s_lshl_b32 s3, s20, 5
  s_add_u32 s3, s3, s22
  s_bitcmp1_b32 s70, s22
  s_cbranch_scc1 sf_c_l
sf_c_d:
  s_mov_b64 exec, -1
  v_mov_b32 v242, s3
sf_d:
w0_28:
  v_mov_b32 v243, 160000
  s_add_u32 s101, s101, 1
  s_barrier
  s_mov_b64 exec, 1
  s_cmp_lg_u32 s16, 0
  s_cbranch_scc1 w0_29
  ds_write_b32 v243, v242 offset:0
  s_waitcnt lgkmcnt(0)
  v_mov_b32 v242, s101
  ds_write_b32 v243, v242 offset:16
  s_waitcnt lgkmcnt(0)
w0_29:
  s_mov_b64 exec, -1
  s_barrier
  ds_read_b32 v242, v243 offset:0
  ds_read_b32 v243, v243 offset:16
  s_waitcnt lgkmcnt(0)
  v_readfirstlane_b32 s3, v242
  v_cmp_ne_u32 vcc, s101, v243
  s_cbranch_vccnz ch_end
  s_cmp_eq_u32 s3, -1
  s_cbranch_scc1 wk_ask
  s_load_dwordx8 s[36:43], s[0:1], 56
  s_load_dwordx4 s[44:47], s[0:1], 88
  s_getreg_b32 s67, hwreg(HW_REG_XCC_ID)
  s_and_b32 s67, s67, 7
  s_mov_b32 s66, 1
  s_waitcnt lgkmcnt(0)
  s_branch m_start
wk_ask:
  v_readfirstlane_b32 s22, v250
  s_cmp_ge_u32 s22, 1376
  s_cbranch_scc1 wk_next
  s_cmp_lg_u32 s16, 0
  s_cbranch_scc1 w0_30
  v_mov_b32 v250, 1
  v_mov_b32 v251, 192
  s_mov_b64 exec, 1
  buffer_atomic_add v250, v251, s[12:15], 0 offen sc0
  s_mov_b64 exec, -1
w0_30:
wk_next:
  s_waitcnt vmcnt(0)
  v_mov_b32 v6, 160000
  s_add_u32 s101, s101, 1
  s_barrier
  s_mov_b64 exec, 1
  s_cmp_lg_u32 s16, 0
  s_cbranch_scc1 w0_31
  ds_write_b32 v6, v250 offset:0
  s_waitcnt lgkmcnt(0)
  v_mov_b32 v250, s101
  ds_write_b32 v6, v250 offset:16
  s_waitcnt lgkmcnt(0)
w0_31:
  s_mov_b64 exec, -1
  s_barrier
  ds_read_b32 v250, v6 offset:0
  ds_read_b32 v6, v6 offset:16
  s_waitcnt lgkmcnt(0)
  v_readfirstlane_b32 s3, v250
  v_cmp_ne_u32 vcc, s101, v6
  s_cbranch_vccnz ch_end
wk_have:
  s_cmp_ge_u32 s3, 1376
  s_cbranch_scc1 ch_end
  v_mov_b32 v250, 0
  v_mov_b32 v251, 192
  v_and_b32 v1, 63, v0
  v_lshlrev_b32 v2, 4, v1
  v_lshrrev_b32 v3, 4, v1
  v_and_b32 v4, 15, v1
  s_cmp_lg_u32 s97, 0
  s_cbranch_scc1 wk_go
  s_mov_b32 s68, s3
  s_mov_b32 s69, 1
  s_cmp_lg_u32 s16, 0
  s_cbranch_scc1 w0_32
  s_add_u32 s20, s67, 1
  s_lshl_b32 s22, s20, 11
  s_add_u32 s22, s22, 88590336
  v_add_u32 v24, 1024, v2
  v_min_u32 v24, 1776, v24
  s_mov_b32 s30, 0
wk_af:
  buffer_load_dwordx4 v[28:31], v2, s[8:11], s22 offen sc1
  buffer_load_dwordx4 v[32:35], v24, s[8:11], s22 offen sc1
  s_waitcnt vmcnt(0)
  v_cmp_ne_u64 vcc, s[88:89], v[28:29]
  s_cbranch_vccnz wk_af_no
  v_cmp_ne_u64 vcc, s[88:89], v[30:31]
  s_cbranch_vccnz wk_af_no
  v_cmp_ne_u64 vcc, s[88:89], v[32:33]
  s_cbranch_vccnz wk_af_no
  v_cmp_ne_u64 vcc, s[88:89], v[34:35]
  s_cbranch_vccnz wk_af_no
  s_branch wk_af_ok
wk_af_no:
  s_sleep 4
  s_add_u32 s30, s30, 1
  s_and_b32 s20, s30, 63
  s_cbranch_scc1 wk_ns
  s_mov_b32 s20, 1
  s_mov_b32 s70, 0
  s_mov_b32 s21, 0
  s_mov_b64 exec, 1
wk_st_l:
  s_cmp_lg_u32 s70, -1
  s_cbranch_scc1 wk_st_t
  s_add_u32 s20, s20, 1
  s_cmp_lt_u32 s20, 8
  s_cselect_b32 s20, s20, 1
  s_mov_b32 s70, 0
  s_mov_b32 s3, -1
  s_add_u32 s21, s21, 1
  s_cmp_ge_u32 s21, 7
  s_cbranch_scc1 wk_st_d
wk_st_t:
  s_ff0_i32_b32 s22, s70
  s_lshl_b32 s23, 1, s22
  s_and_b32 s71, s20, 4
  s_mul_i32 s71, s71, 12
  s_lshl_b32 s3, s20, 2
  s_add_u32 s3, s3, s71
  v_mov_b32 v242, s23
  v_mov_b32 v243, 32
  buffer_atomic_or v242, v243, s[12:15], s3 offen sc0
  s_waitcnt vmcnt(0)
  v_readfirstlane_b32 s70, v242
  s_lshl_b32 s3, s20, 5
  s_add_u32 s3, s3, s22
  s_bitcmp1_b32 s70, s22
  s_cbranch_scc1 wk_st_l
wk_st_d:
  s_mov_b64 exec, -1
  v_mov_b32 v242, s3
  s_cmp_lg_u32 s3, -1
  s_cbranch_scc1 wk_pd
  s_add_u32 s20, s67, 1
  s_lshl_b32 s22, s20, 11
  s_add_u32 s22, s22, 88590336
wk_ns:
  s_cmp_lt_u32 s30, 50000
  s_cbranch_scc1 wk_af
  s_branch cA_abort
wk_af_ok:
  v_mov_b32 v242, -1
wk_pd:
w0_32:
  v_mov_b32 v243, 160000
  s_add_u32 s101, s101, 1
  s_barrier
  s_mov_b64 exec, 1
  s_cmp_lg_u32 s16, 0
  s_cbranch_scc1 w0_33
  ds_write_b32 v243, v242 offset:0
  s_waitcnt lgkmcnt(0)
  v_mov_b32 v242, s101
  ds_write_b32 v243, v242 offset:16
  s_waitcnt lgkmcnt(0)
w0_33:
  s_mov_b64 exec, -1
  s_barrier
  ds_read_b32 v242, v243 offset:0
  ds_read_b32 v243, v243 offset:16
  s_waitcnt lgkmcnt(0)
  v_readfirstlane_b32 s3, v242
  v_cmp_ne_u32 vcc, s101, v243
  s_cbranch_vccnz ch_end
  s_cmp_lg_u32 s3, -1
  s_cbranch_scc1 m_bjob
  s_mov_b32 s3, s68
  s_mov_b32 s97, 1
wk_go:
  s_cmp_ge_u32 s3, 864
  s_cbranch_scc1 wk_tok
  s_cmp_ge_u32 s3, 752
  s_cbranch_scc1 wk_s4d
  s_cmp_ge_u32 s3, 624
  s_cbranch_scc1 wk_f
  s_cmp_ge_u32 s3, 560
  s_cbranch_scc1 wk_vf
  s_cmp_ge_u32 s3, 496
  s_cbranch_scc1 wk_vh
  s_cmp_ge_u32 s3, 368
  s_cbranch_scc1 wk_a
  s_cmp_ge_u32 s3, 336
  s_cbranch_scc1 wk_srv
  s_cmp_ge_u32 s3, 224
  s_cbranch_scc1 wk_v7
  s_sub_u32 s20, s3, 0
  s_cmp_ge_u32 s20, 112
  s_cselect_b32 s18, 1, 0
  s_cselect_b32 s21, 112, 0
  s_sub_u32 s20, s20, s21
  s_and_b32 s17, s20, 15
  s_add_u32 s17, s17, 16
  s_lshr_b32 s34, s20, 4
  s_lshl_b32 s34, s34, 1
  s_add_u32 s35, s34, 2
  s_lshl_b32 s20, s18, 3
  s_lshl_b32 s21, s16, 1
  s_add_u32 s20, s20, s21
  s_mul_i32 s21, s20, 14336
  s_add_u32 s21, s21, 71565312
  s_add_u32 s22, s21, 0
  buffer_load_dwordx4 a[0:3], v2, s[8:11], s22 offen offset:0 sc1
  buffer_load_dwordx4 a[4:7], v2, s[8:11], s22 offen offset:1024 sc1
  buffer_load_dwordx4 a[8:11], v2, s[8:11], s22 offen offset:2048 sc1
  buffer_load_dwordx4 a[12:15], v2, s[8:11], s22 offen offset:3072 sc1
  s_add_u32 s22, s21, 4096
  buffer_load_dwordx4 a[16:19], v2, s[8:11], s22 offen offset:0 sc1
  buffer_load_dwordx4 a[20:23], v2, s[8:11], s22 offen offset:1024 sc1
  buffer_load_dwordx4 a[24:27], v2, s[8:11], s22 offen offset:2048 sc1
  buffer_load_dwordx4 a[28:31], v2, s[8:11], s22 offen offset:3072 sc1
  s_add_u32 s22, s21, 8192
  buffer_load_dwordx4 a[32:35], v2, s[8:11], s22 offen offset:0 sc1
  buffer_load_dwordx4 a[36:39], v2, s[8:11], s22 offen offset:1024 sc1
  buffer_load_dwordx4 a[40:43], v2, s[8:11], s22 offen offset:2048 sc1
  buffer_load_dwordx4 a[44:47], v2, s[8:11], s22 offen offset:3072 sc1
  s_add_u32 s22, s21, 12288
  buffer_load_dwordx4 a[48:51], v2, s[8:11], s22 offen offset:0 sc1
  buffer_load_dwordx4 a[52:55], v2, s[8:11], s22 offen offset:1024 sc1
  buffer_load_dwordx4 a[56:59], v2, s[8:11], s22 offen offset:2048 sc1
  buffer_load_dwordx4 a[60:63], v2, s[8:11], s22 offen offset:3072 sc1
  s_add_u32 s22, s21, 16384
  buffer_load_dwordx4 a[64:67], v2, s[8:11], s22 offen offset:0 sc1
  buffer_load_dwordx4 a[68:71], v2, s[8:11], s22 offen offset:1024 sc1
  buffer_load_dwordx4 a[72:75], v2, s[8:11], s22 offen offset:2048 sc1
  buffer_load_dwordx4 a[76:79], v2, s[8:11], s22 offen offset:3072 sc1
  s_add_u32 s22, s21, 20480
  buffer_load_dwordx4 a[80:83], v2, s[8:11], s22 offen offset:0 sc1
  buffer_load_dwordx4 a[84:87], v2, s[8:11], s22 offen offset:1024 sc1
  buffer_load_dwordx4 a[88:91], v2, s[8:11], s22 offen offset:2048 sc1
  buffer_load_dwordx4 a[92:95], v2, s[8:11], s22 offen offset:3072 sc1
  s_add_u32 s22, s21, 24576
  buffer_load_dwordx4 a[96:99], v2, s[8:11], s22 offen offset:0 sc1
  buffer_load_dwordx4 a[100:103], v2, s[8:11], s22 offen offset:1024 sc1
  buffer_load_dwordx4 a[104:107], v2, s[8:11], s22 offen offset:2048 sc1
  buffer_load_dwordx4 a[108:111], v2, s[8:11], s22 offen offset:3072 sc1
  s_waitcnt vmcnt(40)
  s_mul_i32 s23, s17, 401408
  s_and_b32 s22, s16, 1
  s_mul_i32 s22, s22, 7168
  s_add_u32 s23, s23, s22
  s_add_u32 s23, s23, 0
  s_lshr_b32 s22, s16, 1
  s_mul_i32 s22, s22, 14336
  s_add_u32 s23, s23, s22
  s_mul_i32 s27, s16, 7168
  s_lshr_b32 s28, s20, 1
wf_vo:
  s_sub_u32 s29, s17, 16
  s_lshl_b32 s29, s29, 6
  s_add_u32 s29, s29, s28
  s_mul_i32 s29, s29, 28672
  s_add_u32 s29, s29, 42205184
  v_mul_u32_u24 v6, 28, v3
  s_mov_b32 s31, 0
  s_lshl_b32 s24, s34, 1
  s_mul_i32 s24, s24, 14336
  s_add_u32 s24, s24, s23
  s_cmp_lt_u32 s34, s35
  s_cselect_b32 s24, s24, 0x10000000
  s_add_u32 m0, s31, s27
  s_nop 0
  buffer_load_dwordx4 v2, s[8:11], s24 offen offset:0 sc1 lds
  buffer_load_dwordx4 v2, s[8:11], s24 offen offset:1024 sc1 lds
  buffer_load_dwordx4 v2, s[8:11], s24 offen offset:2048 sc1 lds
  buffer_load_dwordx4 v2, s[8:11], s24 offen offset:3072 sc1 lds
  s_add_u32 m0, m0, 4096
  s_add_u32 s24, s24, 4096
  buffer_load_dwordx4 v2, s[8:11], s24 offen offset:0 sc1 lds
  buffer_load_dwordx4 v2, s[8:11], s24 offen offset:1024 sc1 lds
  buffer_load_dwordx4 v2, s[8:11], s24 offen offset:2048 sc1 lds
  s_add_u32 s30, s34, 1
  s_mov_b32 s31, 28672
  s_lshl_b32 s24, s30, 1
  s_mul_i32 s24, s24, 14336
  s_add_u32 s24, s24, s23
  s_cmp_lt_u32 s30, s35
  s_cselect_b32 s24, s24, 0x10000000
  s_add_u32 m0, s31, s27
  s_nop 0
  buffer_load_dwordx4 v2, s[8:11], s24 offen offset:0 sc1 lds
  buffer_load_dwordx4 v2, s[8:11], s24 offen offset:1024 sc1 lds
  buffer_load_dwordx4 v2, s[8:11], s24 offen offset:2048 sc1 lds
  buffer_load_dwordx4 v2, s[8:11], s24 offen offset:3072 sc1 lds
  s_add_u32 m0, m0, 4096
  s_add_u32 s24, s24, 4096
  buffer_load_dwordx4 v2, s[8:11], s24 offen offset:0 sc1 lds
  buffer_load_dwordx4 v2, s[8:11], s24 offen offset:1024 sc1 lds
  buffer_load_dwordx4 v2, s[8:11], s24 offen offset:2048 sc1 lds
  s_mov_b32 s19, s34
  s_mov_b32 s32, 0
  s_mov_b32 s33, 57344
  s_waitcnt vmcnt(7)
  s_branch wf_vo_in
wf_vo_loop:
  s_waitcnt vmcnt(9)
wf_vo_in:
  s_barrier
  s_add_u32 s30, s19, 2
  s_lshl_b32 s24, s30, 1
  s_mul_i32 s24, s24, 14336
  s_add_u32 s24, s24, s23
  s_cmp_lt_u32 s30, s35
  s_cselect_b32 s24, s24, 0x10000000
  s_add_u32 m0, s33, s27
  s_nop 0
  buffer_load_dwordx4 v2, s[8:11], s24 offen offset:0 sc1 lds
  buffer_load_dwordx4 v2, s[8:11], s24 offen offset:1024 sc1 lds
  buffer_load_dwordx4 v2, s[8:11], s24 offen offset:2048 sc1 lds
  buffer_load_dwordx4 v2, s[8:11], s24 offen offset:3072 sc1 lds
  s_add_u32 m0, m0, 4096
  s_add_u32 s24, s24, 4096
  buffer_load_dwordx4 v2, s[8:11], s24 offen offset:0 sc1 lds
  buffer_load_dwordx4 v2, s[8:11], s24 offen offset:1024 sc1 lds
  buffer_load_dwordx4 v2, s[8:11], s24 offen offset:2048 sc1 lds
  v_add_u32 v5, s32, v2
  ds_read_b128 v[8:11], v5 offset:0
  ds_read_b128 v[12:15], v5 offset:14336
  ds_read_b128 v[16:19], v5 offset:1024
  ds_read_b128 v[20:23], v5 offset:15360
  ds_read_b128 v[24:27], v5 offset:2048
  ds_read_b128 v[28:31], v5 offset:16384
  ds_read_b128 v[32:35], v5 offset:3072
  s_waitcnt lgkmcnt(6)
  v_mfma_f32_16x16x32_bf16 v[40:43], a[0:3], v[8:11], 0
  v_mfma_f32_16x16x32_bf16 v[44:47], a[56:59], v[8:11], 0
  ds_read_b128 v[36:39], v5 offset:17408
  s_waitcnt lgkmcnt(6)
  v_mfma_f32_16x16x32_bf16 v[56:59], a[0:3], v[12:15], 0
  v_mfma_f32_16x16x32_bf16 v[60:63], a[56:59], v[12:15], 0
  ds_read_b128 v[8:11], v5 offset:4096
  s_waitcnt lgkmcnt(6)
  v_mfma_f32_16x16x32_bf16 v[40:43], a[4:7], v[16:19], v[40:43]
  v_mfma_f32_16x16x32_bf16 v[44:47], a[60:63], v[16:19], v[44:47]
  ds_read_b128 v[12:15], v5 offset:18432
  s_waitcnt lgkmcnt(6)
  v_mfma_f32_16x16x32_bf16 v[56:59], a[4:7], v[20:23], v[56:59]
  v_mfma_f32_16x16x32_bf16 v[60:63], a[60:63], v[20:23], v[60:63]
  ds_read_b128 v[16:19], v5 offset:5120
  s_waitcnt lgkmcnt(6)
  v_mfma_f32_16x16x32_bf16 v[40:43], a[8:11], v[24:27], v[40:43]
  v_mfma_f32_16x16x32_bf16 v[44:47], a[64:67], v[24:27], v[44:47]
  ds_read_b128 v[20:23], v5 offset:19456
  s_waitcnt lgkmcnt(6)
  v_mfma_f32_16x16x32_bf16 v[56:59], a[8:11], v[28:31], v[56:59]
  v_mfma_f32_16x16x32_bf16 v[60:63], a[64:67], v[28:31], v[60:63]
  ds_read_b128 v[24:27], v5 offset:6144
  s_waitcnt lgkmcnt(6)
  v_mfma_f32_16x16x32_bf16 v[40:43], a[12:15], v[32:35], v[40:43]
  v_mfma_f32_16x16x32_bf16 v[44:47], a[68:71], v[32:35], v[44:47]
  ds_read_b128 v[28:31], v5 offset:20480
  s_waitcnt lgkmcnt(6)
  v_mfma_f32_16x16x32_bf16 v[56:59], a[12:15], v[36:39], v[56:59]
  v_mfma_f32_16x16x32_bf16 v[60:63], a[68:71], v[36:39], v[60:63]
  ds_read_b128 v[32:35], v5 offset:7168
  s_waitcnt lgkmcnt(6)
  v_mfma_f32_16x16x32_bf16 v[40:43], a[16:19], v[8:11], v[40:43]
  v_mfma_f32_16x16x32_bf16 v[44:47], a[72:75], v[8:11], v[44:47]
  ds_read_b128 v[36:39], v5 offset:21504
  s_waitcnt lgkmcnt(6)
  v_mfma_f32_16x16x32_bf16 v[56:59], a[16:19], v[12:15], v[56:59]
  v_mfma_f32_16x16x32_bf16 v[60:63], a[72:75], v[12:15], v[60:63]
  ds_read_b128 v[8:11], v5 offset:8192
  s_waitcnt lgkmcnt(6)
  v_mfma_f32_16x16x32_bf16 v[40:43], a[20:23], v[16:19], v[40:43]
  v_mfma_f32_16x16x32_bf16 v[44:47], a[76:79], v[16:19], v[44:47]
  ds_read_b128 v[12:15], v5 offset:22528
  s_waitcnt lgkmcnt(6)
  v_mfma_f32_16x16x32_bf16 v[56:59], a[20:23], v[20:23], v[56:59]
  v_mfma_f32_16x16x32_bf16 v[60:63], a[76:79], v[20:23], v[60:63]
  ds_read_b128 v[16:19], v5 offset:9216
  s_waitcnt lgkmcnt(6)
  v_mfma_f32_16x16x32_bf16 v[40:43], a[24:27], v[24:27], v[40:43]
  v_mfma_f32_16x16x32_bf16 v[44:47], a[80:83], v[24:27], v[44:47]
  ds_read_b128 v[20:23], v5 offset:23552
  s_waitcnt lgkmcnt(6)
  v_mfma_f32_16x16x32_bf16 v[56:59], a[24:27], v[28:31], v[56:59]
  v_mfma_f32_16x16x32_bf16 v[60:63], a[80:83], v[28:31], v[60:63]
  ds_read_b128 v[24:27], v5 offset:10240
  s_waitcnt lgkmcnt(6)
  v_mfma_f32_16x16x32_bf16 v[40:43], a[28:31], v[32:35], v[40:43]
  v_mfma_f32_16x16x32_bf16 v[44:47], a[84:87], v[32:35], v[44:47]
  ds_read_b128 v[28:31], v5 offset:24576
  s_waitcnt lgkmcnt(6)
  v_mfma_f32_16x16x32_bf16 v[56:59], a[28:31], v[36:39], v[56:59]
  v_mfma_f32_16x16x32_bf16 v[60:63], a[84:87], v[36:39], v[60:63]
  ds_read_b128 v[32:35], v5 offset:11264
  s_waitcnt lgkmcnt(6)
  v_mfma_f32_16x16x32_bf16 v[40:43], a[32:35], v[8:11], v[40:43]
  v_mfma_f32_16x16x32_bf16 v[44:47], a[88:91], v[8:11], v[44:47]
  ds_read_b128 v[36:39], v5 offset:25600
  s_waitcnt lgkmcnt(6)
  v_mfma_f32_16x16x32_bf16 v[56:59], a[32:35], v[12:15], v[56:59]
  v_mfma_f32_16x16x32_bf16 v[60:63], a[88:91], v[12:15], v[60:63]
  ds_read_b128 v[8:11], v5 offset:12288
  s_waitcnt lgkmcnt(6)
  v_mfma_f32_16x16x32_bf16 v[40:43], a[36:39], v[16:19], v[40:43]
  v_mfma_f32_16x16x32_bf16 v[44:47], a[92:95], v[16:19], v[44:47]
  ds_read_b128 v[12:15], v5 offset:26624
  s_waitcnt lgkmcnt(6)
  v_mfma_f32_16x16x32_bf16 v[56:59], a[36:39], v[20:23], v[56:59]
  v_mfma_f32_16x16x32_bf16 v[60:63], a[92:95], v[20:23], v[60:63]
  ds_read_b128 v[16:19], v5 offset:13312
  s_waitcnt lgkmcnt(6)
  v_mfma_f32_16x16x32_bf16 v[40:43], a[40:43], v[24:27], v[40:43]
  v_mfma_f32_16x16x32_bf16 v[44:47], a[96:99], v[24:27], v[44:47]
  ds_read_b128 v[20:23], v5 offset:27648
  s_waitcnt lgkmcnt(6)
  v_mfma_f32_16x16x32_bf16 v[56:59], a[40:43], v[28:31], v[56:59]
  v_mfma_f32_16x16x32_bf16 v[60:63], a[96:99], v[28:31], v[60:63]
  s_waitcnt lgkmcnt(5)
  v_mfma_f32_16x16x32_bf16 v[40:43], a[44:47], v[32:35], v[40:43]
  v_mfma_f32_16x16x32_bf16 v[44:47], a[100:103], v[32:35], v[44:47]
  s_waitcnt lgkmcnt(4)
  v_mfma_f32_16x16x32_bf16 v[56:59], a[44:47], v[36:39], v[56:59]
  v_mfma_f32_16x16x32_bf16 v[60:63], a[100:103], v[36:39], v[60:63]
  s_waitcnt lgkmcnt(3)
  v_mfma_f32_16x16x32_bf16 v[40:43], a[48:51], v[8:11], v[40:43]
  v_mfma_f32_16x16x32_bf16 v[44:47], a[104:107], v[8:11], v[44:47]
  s_waitcnt lgkmcnt(2)
  v_mfma_f32_16x16x32_bf16 v[56:59], a[48:51], v[12:15], v[56:59]
  v_mfma_f32_16x16x32_bf16 v[60:63], a[104:107], v[12:15], v[60:63]
  s_waitcnt lgkmcnt(1)
  v_mfma_f32_16x16x32_bf16 v[40:43], a[52:55], v[16:19], v[40:43]
  v_mfma_f32_16x16x32_bf16 v[44:47], a[108:111], v[16:19], v[44:47]
  s_waitcnt lgkmcnt(0)
  v_mfma_f32_16x16x32_bf16 v[56:59], a[52:55], v[20:23], v[56:59]
  v_mfma_f32_16x16x32_bf16 v[60:63], a[108:111], v[20:23], v[60:63]
  s_add_u32 s25, s29, 28672
  s_lshl_b32 s24, s19, 5
  s_add_u32 s24, s24, 0
  v_add_u32 v88, s24, v4
  v_mul_u32_u24 v89, 2341, v88
  v_lshrrev_b32 v89, 16, v89
  v_mul_u32_u24 v89, 84, v89
  v_add3_u32 v88, v88, v89, v6
  v_lshlrev_b32 v90, 4, v88
  v_cvt_pk_bf16_f32 v72, v40, v41
  v_cvt_pk_bf16_f32 v73, v42, v43
  v_cvt_pk_bf16_f32 v74, v44, v45
  v_cvt_pk_bf16_f32 v75, v46, v47
  buffer_store_dwordx4 v[72:75], v90, s[8:11], s29 offen sc1
  s_lshl_b32 s24, s19, 5
  s_add_u32 s24, s24, 16
  v_add_u32 v88, s24, v4
  v_mul_u32_u24 v89, 2341, v88
  v_lshrrev_b32 v89, 16, v89
  v_mul_u32_u24 v89, 84, v89
  v_add3_u32 v88, v88, v89, v6
  v_lshlrev_b32 v91, 4, v88
  v_cvt_pk_bf16_f32 v80, v56, v57
  v_cvt_pk_bf16_f32 v81, v58, v59
  v_cvt_pk_bf16_f32 v82, v60, v61
  v_cvt_pk_bf16_f32 v83, v62, v63
  buffer_store_dwordx4 v[80:83], v91, s[8:11], s29 offen sc1
  s_mov_b32 s33, s32
  s_add_u32 s32, s32, 28672
  s_cmp_eq_u32 s32, 86016
  s_cselect_b32 s32, 0, s32
  s_add_u32 s19, s19, 1
  s_cmp_lt_u32 s19, s35
  s_cbranch_scc1 wf_vo_loop
  s_branch wf_done
wf_done:
  s_lshr_b32 s20, s18, 1
  s_lshl_b32 s20, s20, 4
  s_and_b32 s21, s17, 15
  s_add_u32 s20, s20, s21
  s_lshl_b32 s20, s20, 7
  s_cmp_lt_u32 s17, 16
  s_cselect_b32 s21, 16384, 0
  s_add_u32 s20, s20, s21
  s_add_u32 s20, s20, 88528896
  s_sub_u32 s21, s35, s34
  s_lshr_b32 s21, s21, 1
  v_mov_b32 v5, s21
  v_mov_b32 v6, 0
  s_waitcnt vmcnt(0)
  s_mov_b64 exec, 1
  s_cmp_lg_u32 s18, 0
  s_cbranch_scc1 wf_h1
  v_mov_b32 v7, 2
  s_sub_u32 s21, s20, 2048
  buffer_atomic_add v7, v6, s[8:11], s21 offen
wf_h1:
  buffer_atomic_add v5, v6, s[8:11], s20 offen
  s_mov_b64 exec, -1
  s_branch wk_loop
wk_v7:
  s_sub_u32 s20, s3, 224
  s_mov_b32 s18, 1
  s_and_b32 s17, s20, 15
  s_add_u32 s17, s17, 16
  s_lshr_b32 s34, s20, 4
  s_lshl_b32 s34, s34, 1
  s_add_u32 s35, s34, 2
  s_branch wk_gemm
wk_vh:
  s_sub_u32 s20, s3, 496
  s_and_b32 s17, s20, 15
  s_add_u32 s17, s17, 16
  s_lshr_b32 s18, s20, 5
  s_add_u32 s18, s18, 2
  s_bitcmp1_b32 s20, 4
  s_cselect_b32 s34, 7, 0
  s_add_u32 s35, s34, 7
  s_branch wk_gemm
wk_vf:
  s_sub_u32 s20, s3, 560
  s_and_b32 s17, s20, 15
  s_add_u32 s17, s17, 16
  s_lshr_b32 s18, s20, 4
  s_add_u32 s18, s18, 4
  s_mov_b32 s34, 0
  s_mov_b32 s35, 14
  s_branch wk_gemm
wk_f:
  s_sub_u32 s20, s3, 624
  s_and_b32 s17, s20, 15
  s_lshr_b32 s18, s20, 4
  s_mov_b32 s34, 0
  s_mov_b32 s35, 14
  s_lshl_b32 s22, s17, 7
  s_add_u32 s22, s22, 88621056
  v_min_u32 v24, 96, v2
  s_mov_b32 s30, 0
wk_aw:
  buffer_load_dwordx4 v[28:31], v24, s[8:11], s22 offen sc1
  s_waitcnt vmcnt(0)
  v_cmp_ne_u64 vcc, s[88:89], v[28:29]
  s_cbranch_vccnz wk_aw_no
  v_cmp_ne_u64 vcc, s[88:89], v[30:31]
  s_cbranch_vccnz wk_aw_no
  s_branch wk_aw_ok
wk_aw_no:
  s_sleep 6
  s_add_u32 s30, s30, 1
  s_cmp_lt_u32 s30, 50000
  s_cbranch_scc1 wk_aw
  s_branch cA_abort
wk_aw_ok:
wk_gemm:
  s_lshl_b32 s20, s18, 4
  s_lshl_b32 s21, s16, 2
  s_add_u32 s20, s20, s21
  s_mul_i32 s21, s20, 14336
  s_add_u32 s21, s21, 71565312
  s_add_u32 s22, s21, 0
  buffer_load_dwordx4 a[0:3], v2, s[8:11], s22 offen offset:0 sc1
  buffer_load_dwordx4 a[4:7], v2, s[8:11], s22 offen offset:1024 sc1
  buffer_load_dwordx4 a[8:11], v2, s[8:11], s22 offen offset:2048 sc1
  buffer_load_dwordx4 a[12:15], v2, s[8:11], s22 offen offset:3072 sc1
  s_add_u32 s22, s21, 4096
  buffer_load_dwordx4 a[16:19], v2, s[8:11], s22 offen offset:0 sc1
  buffer_load_dwordx4 a[20:23], v2, s[8:11], s22 offen offset:1024 sc1
  buffer_load_dwordx4 a[24:27], v2, s[8:11], s22 offen offset:2048 sc1
  buffer_load_dwordx4 a[28:31], v2, s[8:11], s22 offen offset:3072 sc1
  s_add_u32 s22, s21, 8192
  buffer_load_dwordx4 a[32:35], v2, s[8:11], s22 offen offset:0 sc1
  buffer_load_dwordx4 a[36:39], v2, s[8:11], s22 offen offset:1024 sc1
  buffer_load_dwordx4 a[40:43], v2, s[8:11], s22 offen offset:2048 sc1
  buffer_load_dwordx4 a[44:47], v2, s[8:11], s22 offen offset:3072 sc1
  s_add_u32 s22, s21, 12288
  buffer_load_dwordx4 a[48:51], v2, s[8:11], s22 offen offset:0 sc1
  buffer_load_dwordx4 a[52:55], v2, s[8:11], s22 offen offset:1024 sc1
  buffer_load_dwordx4 a[56:59], v2, s[8:11], s22 offen offset:2048 sc1
  buffer_load_dwordx4 a[60:63], v2, s[8:11], s22 offen offset:3072 sc1
  s_add_u32 s22, s21, 16384
  buffer_load_dwordx4 a[64:67], v2, s[8:11], s22 offen offset:0 sc1
  buffer_load_dwordx4 a[68:71], v2, s[8:11], s22 offen offset:1024 sc1
  buffer_load_dwordx4 a[72:75], v2, s[8:11], s22 offen offset:2048 sc1
  buffer_load_dwordx4 a[76:79], v2, s[8:11], s22 offen offset:3072 sc1
  s_add_u32 s22, s21, 20480
  buffer_load_dwordx4 a[80:83], v2, s[8:11], s22 offen offset:0 sc1
  buffer_load_dwordx4 a[84:87], v2, s[8:11], s22 offen offset:1024 sc1
  buffer_load_dwordx4 a[88:91], v2, s[8:11], s22 offen offset:2048 sc1
  buffer_load_dwordx4 a[92:95], v2, s[8:11], s22 offen offset:3072 sc1
  s_add_u32 s22, s21, 24576
  buffer_load_dwordx4 a[96:99], v2, s[8:11], s22 offen offset:0 sc1
  buffer_load_dwordx4 a[100:103], v2, s[8:11], s22 offen offset:1024 sc1
  buffer_load_dwordx4 a[104:107], v2, s[8:11], s22 offen offset:2048 sc1
  buffer_load_dwordx4 a[108:111], v2, s[8:11], s22 offen offset:3072 sc1
  s_add_u32 s22, s21, 28672
  buffer_load_dwordx4 a[112:115], v2, s[8:11], s22 offen offset:0 sc1
  buffer_load_dwordx4 a[116:119], v2, s[8:11], s22 offen offset:1024 sc1
  buffer_load_dwordx4 a[120:123], v2, s[8:11], s22 offen offset:2048 sc1
  buffer_load_dwordx4 a[124:127], v2, s[8:11], s22 offen offset:3072 sc1
  s_add_u32 s22, s21, 32768
  buffer_load_dwordx4 a[128:131], v2, s[8:11], s22 offen offset:0 sc1
  buffer_load_dwordx4 a[132:135], v2, s[8:11], s22 offen offset:1024 sc1
  buffer_load_dwordx4 a[136:139], v2, s[8:11], s22 offen offset:2048 sc1
  buffer_load_dwordx4 a[140:143], v2, s[8:11], s22 offen offset:3072 sc1
  s_add_u32 s22, s21, 36864
  buffer_load_dwordx4 a[144:147], v2, s[8:11], s22 offen offset:0 sc1
  buffer_load_dwordx4 a[148:151], v2, s[8:11], s22 offen offset:1024 sc1
  buffer_load_dwordx4 a[152:155], v2, s[8:11], s22 offen offset:2048 sc1
  buffer_load_dwordx4 a[156:159], v2, s[8:11], s22 offen offset:3072 sc1
  s_add_u32 s22, s21, 40960
  buffer_load_dwordx4 a[160:163], v2, s[8:11], s22 offen offset:0 sc1
  buffer_load_dwordx4 a[164:167], v2, s[8:11], s22 offen offset:1024 sc1
  buffer_load_dwordx4 a[168:171], v2, s[8:11], s22 offen offset:2048 sc1
  buffer_load_dwordx4 a[172:175], v2, s[8:11], s22 offen offset:3072 sc1
  s_add_u32 s22, s21, 45056
  buffer_load_dwordx4 a[176:179], v2, s[8:11], s22 offen offset:0 sc1
  buffer_load_dwordx4 a[180:183], v2, s[8:11], s22 offen offset:1024 sc1
  buffer_load_dwordx4 a[184:187], v2, s[8:11], s22 offen offset:2048 sc1
  buffer_load_dwordx4 a[188:191], v2, s[8:11], s22 offen offset:3072 sc1
  s_add_u32 s22, s21, 49152
  buffer_load_dwordx4 a[192:195], v2, s[8:11], s22 offen offset:0 sc1
  buffer_load_dwordx4 a[196:199], v2, s[8:11], s22 offen offset:1024 sc1
  buffer_load_dwordx4 a[200:203], v2, s[8:11], s22 offen offset:2048 sc1
  buffer_load_dwordx4 a[204:207], v2, s[8:11], s22 offen offset:3072 sc1
  s_add_u32 s22, s21, 53248
  buffer_load_dwordx4 a[208:211], v2, s[8:11], s22 offen offset:0 sc1
  buffer_load_dwordx4 a[212:215], v2, s[8:11], s22 offen offset:1024 sc1
  buffer_load_dwordx4 a[216:219], v2, s[8:11], s22 offen offset:2048 sc1
  buffer_load_dwordx4 a[220:223], v2, s[8:11], s22 offen offset:3072 sc1
  s_waitcnt vmcnt(40)
  s_mul_i32 s23, s17, 401408
  s_and_b32 s22, s16, 1
  s_mul_i32 s22, s22, 7168
  s_add_u32 s23, s23, s22
  s_add_u32 s23, s23, 0
  s_lshr_b32 s22, s16, 1
  s_mul_i32 s22, s22, 14336
  s_add_u32 s23, s23, s22
  s_mul_i32 s27, s16, 7168
  s_lshr_b32 s28, s20, 1
  s_cmp_lt_u32 s17, 16
  s_cbranch_scc0 wg_vo
  s_add_u32 s23, s23, s22
  s_lshl_b32 s29, s28, 4
  s_add_u32 s29, s29, s17
  s_mul_i32 s29, s29, 28672
  s_add_u32 s29, s29, 12845056
  s_mov_b32 s31, 0
  s_lshr_b32 s24, s34, 1
  s_lshl_b32 s24, s24, 2
  s_and_b32 s25, s34, 1
  s_add_u32 s24, s24, s25
  s_mul_i32 s24, s24, 14336
  s_add_u32 s24, s24, s23
  s_cmp_lt_u32 s34, s35
  s_cselect_b32 s24, s24, 0x10000000
  s_add_u32 m0, s31, s27
  s_nop 0
  buffer_load_dwordx4 v2, s[8:11], s24 offen offset:0 sc1 lds
  buffer_load_dwordx4 v2, s[8:11], s24 offen offset:1024 sc1 lds
  buffer_load_dwordx4 v2, s[8:11], s24 offen offset:2048 sc1 lds
  buffer_load_dwordx4 v2, s[8:11], s24 offen offset:3072 sc1 lds
  s_add_u32 m0, m0, 4096
  s_add_u32 s24, s24, 4096
  buffer_load_dwordx4 v2, s[8:11], s24 offen offset:0 sc1 lds
  buffer_load_dwordx4 v2, s[8:11], s24 offen offset:1024 sc1 lds
  buffer_load_dwordx4 v2, s[8:11], s24 offen offset:2048 sc1 lds
  s_add_u32 s30, s34, 1
  s_mov_b32 s31, 28672
  s_lshr_b32 s24, s30, 1
  s_lshl_b32 s24, s24, 2
  s_and_b32 s25, s30, 1
  s_add_u32 s24, s24, s25
  s_mul_i32 s24, s24, 14336
  s_add_u32 s24, s24, s23
  s_cmp_lt_u32 s30, s35
  s_cselect_b32 s24, s24, 0x10000000
  s_add_u32 m0, s31, s27
  s_nop 0
  buffer_load_dwordx4 v2, s[8:11], s24 offen offset:0 sc1 lds
  buffer_load_dwordx4 v2, s[8:11], s24 offen offset:1024 sc1 lds
  buffer_load_dwordx4 v2, s[8:11], s24 offen offset:2048 sc1 lds
  buffer_load_dwordx4 v2, s[8:11], s24 offen offset:3072 sc1 lds
  s_add_u32 m0, m0, 4096
  s_add_u32 s24, s24, 4096
  buffer_load_dwordx4 v2, s[8:11], s24 offen offset:0 sc1 lds
  buffer_load_dwordx4 v2, s[8:11], s24 offen offset:1024 sc1 lds
  buffer_load_dwordx4 v2, s[8:11], s24 offen offset:2048 sc1 lds
  s_mov_b32 s19, s34
  s_mov_b32 s32, 0
  s_mov_b32 s33, 57344
  s_waitcnt vmcnt(7)
  s_branch wg_f_in
wg_f_loop:
  s_waitcnt vmcnt(11)
wg_f_in:
  s_barrier
  s_add_u32 s30, s19, 2
  s_lshr_b32 s24, s30, 1
  s_lshl_b32 s24, s24, 2
  s_and_b32 s25, s30, 1
  s_add_u32 s24, s24, s25
  s_mul_i32 s24, s24, 14336
  s_add_u32 s24, s24, s23
  s_cmp_lt_u32 s30, s35
  s_cselect_b32 s24, s24, 0x10000000
  s_add_u32 m0, s33, s27
  s_nop 0
  buffer_load_dwordx4 v2, s[8:11], s24 offen offset:0 sc1 lds
  buffer_load_dwordx4 v2, s[8:11], s24 offen offset:1024 sc1 lds
  buffer_load_dwordx4 v2, s[8:11], s24 offen offset:2048 sc1 lds
  buffer_load_dwordx4 v2, s[8:11], s24 offen offset:3072 sc1 lds
  s_add_u32 m0, m0, 4096
  s_add_u32 s24, s24, 4096
  buffer_load_dwordx4 v2, s[8:11], s24 offen offset:0 sc1 lds
  buffer_load_dwordx4 v2, s[8:11], s24 offen offset:1024 sc1 lds
  buffer_load_dwordx4 v2, s[8:11], s24 offen offset:2048 sc1 lds
  v_add_u32 v5, s32, v2
  ds_read_b128 v[8:11], v5 offset:0
  ds_read_b128 v[12:15], v5 offset:14336
  ds_read_b128 v[16:19], v5 offset:1024
  ds_read_b128 v[20:23], v5 offset:15360
  ds_read_b128 v[24:27], v5 offset:2048
  ds_read_b128 v[28:31], v5 offset:16384
  ds_read_b128 v[32:35], v5 offset:3072
  s_waitcnt lgkmcnt(6)
  v_mfma_f32_16x16x32_bf16 v[40:43], v[8:11], a[0:3], 0
  v_mfma_f32_16x16x32_bf16 v[44:47], v[8:11], a[56:59], 0
  v_mfma_f32_16x16x32_bf16 v[48:51], v[8:11], a[112:115], 0
  v_mfma_f32_16x16x32_bf16 v[52:55], v[8:11], a[168:171], 0
  ds_read_b128 v[36:39], v5 offset:17408
  s_waitcnt lgkmcnt(6)
  v_mfma_f32_16x16x32_bf16 v[56:59], v[12:15], a[0:3], 0
  v_mfma_f32_16x16x32_bf16 v[60:63], v[12:15], a[56:59], 0
  v_mfma_f32_16x16x32_bf16 v[64:67], v[12:15], a[112:115], 0
  v_mfma_f32_16x16x32_bf16 v[68:71], v[12:15], a[168:171], 0
  ds_read_b128 v[8:11], v5 offset:4096
  s_waitcnt lgkmcnt(6)
  v_mfma_f32_16x16x32_bf16 v[40:43], v[16:19], a[4:7], v[40:43]
  v_mfma_f32_16x16x32_bf16 v[44:47], v[16:19], a[60:63], v[44:47]
  v_mfma_f32_16x16x32_bf16 v[48:51], v[16:19], a[116:119], v[48:51]
  v_mfma_f32_16x16x32_bf16 v[52:55], v[16:19], a[172:175], v[52:55]
  ds_read_b128 v[12:15], v5 offset:18432
  s_waitcnt lgkmcnt(6)
  v_mfma_f32_16x16x32_bf16 v[56:59], v[20:23], a[4:7], v[56:59]
  v_mfma_f32_16x16x32_bf16 v[60:63], v[20:23], a[60:63], v[60:63]
  v_mfma_f32_16x16x32_bf16 v[64:67], v[20:23], a[116:119], v[64:67]
  v_mfma_f32_16x16x32_bf16 v[68:71], v[20:23], a[172:175], v[68:71]
  ds_read_b128 v[16:19], v5 offset:5120
  s_waitcnt lgkmcnt(6)
  v_mfma_f32_16x16x32_bf16 v[40:43], v[24:27], a[8:11], v[40:43]
  v_mfma_f32_16x16x32_bf16 v[44:47], v[24:27], a[64:67], v[44:47]
  v_mfma_f32_16x16x32_bf16 v[48:51], v[24:27], a[120:123], v[48:51]
  v_mfma_f32_16x16x32_bf16 v[52:55], v[24:27], a[176:179], v[52:55]
  ds_read_b128 v[20:23], v5 offset:19456
  s_waitcnt lgkmcnt(6)
  v_mfma_f32_16x16x32_bf16 v[56:59], v[28:31], a[8:11], v[56:59]
  v_mfma_f32_16x16x32_bf16 v[60:63], v[28:31], a[64:67], v[60:63]
  v_mfma_f32_16x16x32_bf16 v[64:67], v[28:31], a[120:123], v[64:67]
  v_mfma_f32_16x16x32_bf16 v[68:71], v[28:31], a[176:179], v[68:71]
  ds_read_b128 v[24:27], v5 offset:6144
  s_waitcnt lgkmcnt(6)
  v_mfma_f32_16x16x32_bf16 v[40:43], v[32:35], a[12:15], v[40:43]
  v_mfma_f32_16x16x32_bf16 v[44:47], v[32:35], a[68:71], v[44:47]
  v_mfma_f32_16x16x32_bf16 v[48:51], v[32:35], a[124:127], v[48:51]
  v_mfma_f32_16x16x32_bf16 v[52:55], v[32:35], a[180:183], v[52:55]
  ds_read_b128 v[28:31], v5 offset:20480
  s_waitcnt lgkmcnt(6)
  v_mfma_f32_16x16x32_bf16 v[56:59], v[36:39], a[12:15], v[56:59]
  v_mfma_f32_16x16x32_bf16 v[60:63], v[36:39], a[68:71], v[60:63]
  v_mfma_f32_16x16x32_bf16 v[64:67], v[36:39], a[124:127], v[64:67]
  v_mfma_f32_16x16x32_bf16 v[68:71], v[36:39], a[180:183], v[68:71]
  ds_read_b128 v[32:35], v5 offset:7168
  s_waitcnt lgkmcnt(6)
  v_mfma_f32_16x16x32_bf16 v[40:43], v[8:11], a[16:19], v[40:43]
  v_mfma_f32_16x16x32_bf16 v[44:47], v[8:11], a[72:75], v[44:47]
  v_mfma_f32_16x16x32_bf16 v[48:51], v[8:11], a[128:131], v[48:51]
  v_mfma_f32_16x16x32_bf16 v[52:55], v[8:11], a[184:187], v[52:55]
  ds_read_b128 v[36:39], v5 offset:21504
  s_waitcnt lgkmcnt(6)
  v_mfma_f32_16x16x32_bf16 v[56:59], v[12:15], a[16:19], v[56:59]
  v_mfma_f32_16x16x32_bf16 v[60:63], v[12:15], a[72:75], v[60:63]
  v_mfma_f32_16x16x32_bf16 v[64:67], v[12:15], a[128:131], v[64:67]
  v_mfma_f32_16x16x32_bf16 v[68:71], v[12:15], a[184:187], v[68:71]
  ds_read_b128 v[8:11], v5 offset:8192
  s_waitcnt lgkmcnt(6)
  v_mfma_f32_16x16x32_bf16 v[40:43], v[16:19], a[20:23], v[40:43]
  v_mfma_f32_16x16x32_bf16 v[44:47], v[16:19], a[76:79], v[44:47]
  v_mfma_f32_16x16x32_bf16 v[48:51], v[16:19], a[132:135], v[48:51]
  v_mfma_f32_16x16x32_bf16 v[52:55], v[16:19], a[188:191], v[52:55]
  ds_read_b128 v[12:15], v5 offset:22528
  s_waitcnt lgkmcnt(6)
  v_mfma_f32_16x16x32_bf16 v[56:59], v[20:23], a[20:23], v[56:59]
  v_mfma_f32_16x16x32_bf16 v[60:63], v[20:23], a[76:79], v[60:63]
  v_mfma_f32_16x16x32_bf16 v[64:67], v[20:23], a[132:135], v[64:67]
  v_mfma_f32_16x16x32_bf16 v[68:71], v[20:23], a[188:191], v[68:71]
  ds_read_b128 v[16:19], v5 offset:9216
  s_waitcnt lgkmcnt(6)
  v_mfma_f32_16x16x32_bf16 v[40:43], v[24:27], a[24:27], v[40:43]
  v_mfma_f32_16x16x32_bf16 v[44:47], v[24:27], a[80:83], v[44:47]
  v_mfma_f32_16x16x32_bf16 v[48:51], v[24:27], a[136:139], v[48:51]
  v_mfma_f32_16x16x32_bf16 v[52:55], v[24:27], a[192:195], v[52:55]
  ds_read_b128 v[20:23], v5 offset:23552
  s_waitcnt lgkmcnt(6)
  v_mfma_f32_16x16x32_bf16 v[56:59], v[28:31], a[24:27], v[56:59]
  v_mfma_f32_16x16x32_bf16 v[60:63], v[28:31], a[80:83], v[60:63]
  v_mfma_f32_16x16x32_bf16 v[64:67], v[28:31], a[136:139], v[64:67]
  v_mfma_f32_16x16x32_bf16 v[68:71], v[28:31], a[192:195], v[68:71]
  ds_read_b128 v[24:27], v5 offset:10240
  s_waitcnt lgkmcnt(6)
  v_mfma_f32_16x16x32_bf16 v[40:43], v[32:35], a[28:31], v[40:43]
  v_mfma_f32_16x16x32_bf16 v[44:47], v[32:35], a[84:87], v[44:47]
  v_mfma_f32_16x16x32_bf16 v[48:51], v[32:35], a[140:143], v[48:51]
  v_mfma_f32_16x16x32_bf16 v[52:55], v[32:35], a[196:199], v[52:55]
  ds_read_b128 v[28:31], v5 offset:24576
  s_waitcnt lgkmcnt(6)
  v_mfma_f32_16x16x32_bf16 v[56:59], v[36:39], a[28:31], v[56:59]
  v_mfma_f32_16x16x32_bf16 v[60:63], v[36:39], a[84:87], v[60:63]
  v_mfma_f32_16x16x32_bf16 v[64:67], v[36:39], a[140:143], v[64:67]
  v_mfma_f32_16x16x32_bf16 v[68:71], v[36:39], a[196:199], v[68:71]
  ds_read_b128 v[32:35], v5 offset:11264
  s_waitcnt lgkmcnt(6)
  v_mfma_f32_16x16x32_bf16 v[40:43], v[8:11], a[32:35], v[40:43]
  v_mfma_f32_16x16x32_bf16 v[44:47], v[8:11], a[88:91], v[44:47]
  v_mfma_f32_16x16x32_bf16 v[48:51], v[8:11], a[144:147], v[48:51]
  v_mfma_f32_16x16x32_bf16 v[52:55], v[8:11], a[200:203], v[52:55]
  ds_read_b128 v[36:39], v5 offset:25600
  s_waitcnt lgkmcnt(6)
  v_mfma_f32_16x16x32_bf16 v[56:59], v[12:15], a[32:35], v[56:59]
  v_mfma_f32_16x16x32_bf16 v[60:63], v[12:15], a[88:91], v[60:63]
  v_mfma_f32_16x16x32_bf16 v[64:67], v[12:15], a[144:147], v[64:67]
  v_mfma_f32_16x16x32_bf16 v[68:71], v[12:15], a[200:203], v[68:71]
  ds_read_b128 v[8:11], v5 offset:12288
  s_waitcnt lgkmcnt(6)
  v_mfma_f32_16x16x32_bf16 v[40:43], v[16:19], a[36:39], v[40:43]
  v_mfma_f32_16x16x32_bf16 v[44:47], v[16:19], a[92:95], v[44:47]
  v_mfma_f32_16x16x32_bf16 v[48:51], v[16:19], a[148:151], v[48:51]
  v_mfma_f32_16x16x32_bf16 v[52:55], v[16:19], a[204:207], v[52:55]
  ds_read_b128 v[12:15], v5 offset:26624
  s_waitcnt lgkmcnt(6)
  v_mfma_f32_16x16x32_bf16 v[56:59], v[20:23], a[36:39], v[56:59]
  v_mfma_f32_16x16x32_bf16 v[60:63], v[20:23], a[92:95], v[60:63]
  v_mfma_f32_16x16x32_bf16 v[64:67], v[20:23], a[148:151], v[64:67]
  v_mfma_f32_16x16x32_bf16 v[68:71], v[20:23], a[204:207], v[68:71]
  ds_read_b128 v[16:19], v5 offset:13312
  s_waitcnt lgkmcnt(6)
  v_mfma_f32_16x16x32_bf16 v[40:43], v[24:27], a[40:43], v[40:43]
  v_mfma_f32_16x16x32_bf16 v[44:47], v[24:27], a[96:99], v[44:47]
  v_mfma_f32_16x16x32_bf16 v[48:51], v[24:27], a[152:155], v[48:51]
  v_mfma_f32_16x16x32_bf16 v[52:55], v[24:27], a[208:211], v[52:55]
  ds_read_b128 v[20:23], v5 offset:27648
  s_waitcnt lgkmcnt(6)
  v_mfma_f32_16x16x32_bf16 v[56:59], v[28:31], a[40:43], v[56:59]
  v_mfma_f32_16x16x32_bf16 v[60:63], v[28:31], a[96:99], v[60:63]
  v_mfma_f32_16x16x32_bf16 v[64:67], v[28:31], a[152:155], v[64:67]
  v_mfma_f32_16x16x32_bf16 v[68:71], v[28:31], a[208:211], v[68:71]
  s_waitcnt lgkmcnt(5)
  v_mfma_f32_16x16x32_bf16 v[40:43], v[32:35], a[44:47], v[40:43]
  v_mfma_f32_16x16x32_bf16 v[44:47], v[32:35], a[100:103], v[44:47]
  v_mfma_f32_16x16x32_bf16 v[48:51], v[32:35], a[156:159], v[48:51]
  v_mfma_f32_16x16x32_bf16 v[52:55], v[32:35], a[212:215], v[52:55]
  s_waitcnt lgkmcnt(4)
  v_mfma_f32_16x16x32_bf16 v[56:59], v[36:39], a[44:47], v[56:59]
  v_mfma_f32_16x16x32_bf16 v[60:63], v[36:39], a[100:103], v[60:63]
  v_mfma_f32_16x16x32_bf16 v[64:67], v[36:39], a[156:159], v[64:67]
  v_mfma_f32_16x16x32_bf16 v[68:71], v[36:39], a[212:215], v[68:71]
  s_waitcnt lgkmcnt(3)
  v_mfma_f32_16x16x32_bf16 v[40:43], v[8:11], a[48:51], v[40:43]
  v_mfma_f32_16x16x32_bf16 v[44:47], v[8:11], a[104:107], v[44:47]
  v_mfma_f32_16x16x32_bf16 v[48:51], v[8:11], a[160:163], v[48:51]
  v_mfma_f32_16x16x32_bf16 v[52:55], v[8:11], a[216:219], v[52:55]
  s_waitcnt lgkmcnt(2)
  v_mfma_f32_16x16x32_bf16 v[56:59], v[12:15], a[48:51], v[56:59]
  v_mfma_f32_16x16x32_bf16 v[60:63], v[12:15], a[104:107], v[60:63]
  v_mfma_f32_16x16x32_bf16 v[64:67], v[12:15], a[160:163], v[64:67]
  v_mfma_f32_16x16x32_bf16 v[68:71], v[12:15], a[216:219], v[68:71]
  s_waitcnt lgkmcnt(1)
  v_mfma_f32_16x16x32_bf16 v[40:43], v[16:19], a[52:55], v[40:43]
  v_mfma_f32_16x16x32_bf16 v[44:47], v[16:19], a[108:111], v[44:47]
  v_mfma_f32_16x16x32_bf16 v[48:51], v[16:19], a[164:167], v[48:51]
  v_mfma_f32_16x16x32_bf16 v[52:55], v[16:19], a[220:223], v[52:55]
  s_waitcnt lgkmcnt(0)
  v_mfma_f32_16x16x32_bf16 v[56:59], v[20:23], a[52:55], v[56:59]
  v_mfma_f32_16x16x32_bf16 v[60:63], v[20:23], a[108:111], v[60:63]
  v_mfma_f32_16x16x32_bf16 v[64:67], v[20:23], a[164:167], v[64:67]
  v_mfma_f32_16x16x32_bf16 v[68:71], v[20:23], a[220:223], v[68:71]
  s_lshl_b32 s24, s19, 10
  s_add_u32 s24, s24, s29
  v_cvt_pk_bf16_f32 v72, v40, v41
  v_cvt_pk_bf16_f32 v73, v42, v43
  v_cvt_pk_bf16_f32 v74, v56, v57
  v_cvt_pk_bf16_f32 v75, v58, v59
  s_add_u32 s25, s24, 0
  buffer_store_dwordx4 v[72:75], v2, s[8:11], s25 offen sc1
  v_cvt_pk_bf16_f32 v76, v44, v45
  v_cvt_pk_bf16_f32 v77, v46, v47
  v_cvt_pk_bf16_f32 v78, v60, v61
  v_cvt_pk_bf16_f32 v79, v62, v63
  s_add_u32 s25, s24, 14336
  buffer_store_dwordx4 v[76:79], v2, s[8:11], s25 offen sc1
  v_cvt_pk_bf16_f32 v80, v48, v49
  v_cvt_pk_bf16_f32 v81, v50, v51
  v_cvt_pk_bf16_f32 v82, v64, v65
  v_cvt_pk_bf16_f32 v83, v66, v67
  s_add_u32 s25, s24, 458752
  buffer_store_dwordx4 v[80:83], v2, s[8:11], s25 offen sc1
  v_cvt_pk_bf16_f32 v84, v52, v53
  v_cvt_pk_bf16_f32 v85, v54, v55
  v_cvt_pk_bf16_f32 v86, v68, v69
  v_cvt_pk_bf16_f32 v87, v70, v71
  s_add_u32 s25, s24, 473088
  buffer_store_dwordx4 v[84:87], v2, s[8:11], s25 offen sc1
  s_mov_b32 s33, s32
  s_add_u32 s32, s32, 28672
  s_cmp_eq_u32 s32, 86016
  s_cselect_b32 s32, 0, s32
  s_add_u32 s19, s19, 1
  s_cmp_lt_u32 s19, s35
  s_cbranch_scc1 wg_f_loop
  s_branch wg_done
wg_vo:
  s_sub_u32 s29, s17, 16
  s_lshl_b32 s29, s29, 6
  s_add_u32 s29, s29, s28
  s_mul_i32 s29, s29, 28672
  s_add_u32 s29, s29, 42205184
  v_mul_u32_u24 v6, 28, v3
  s_mov_b32 s31, 0
  s_lshl_b32 s24, s34, 1
  s_mul_i32 s24, s24, 14336
  s_add_u32 s24, s24, s23
  s_cmp_lt_u32 s34, s35
  s_cselect_b32 s24, s24, 0x10000000
  s_add_u32 m0, s31, s27
  s_nop 0
  buffer_load_dwordx4 v2, s[8:11], s24 offen offset:0 sc1 lds
  buffer_load_dwordx4 v2, s[8:11], s24 offen offset:1024 sc1 lds
  buffer_load_dwordx4 v2, s[8:11], s24 offen offset:2048 sc1 lds
  buffer_load_dwordx4 v2, s[8:11], s24 offen offset:3072 sc1 lds
  s_add_u32 m0, m0, 4096
  s_add_u32 s24, s24, 4096
  buffer_load_dwordx4 v2, s[8:11], s24 offen offset:0 sc1 lds
  buffer_load_dwordx4 v2, s[8:11], s24 offen offset:1024 sc1 lds
  buffer_load_dwordx4 v2, s[8:11], s24 offen offset:2048 sc1 lds
  s_add_u32 s30, s34, 1
  s_mov_b32 s31, 28672
  s_lshl_b32 s24, s30, 1
  s_mul_i32 s24, s24, 14336
  s_add_u32 s24, s24, s23
  s_cmp_lt_u32 s30, s35
  s_cselect_b32 s24, s24, 0x10000000
  s_add_u32 m0, s31, s27
  s_nop 0
  buffer_load_dwordx4 v2, s[8:11], s24 offen offset:0 sc1 lds
  buffer_load_dwordx4 v2, s[8:11], s24 offen offset:1024 sc1 lds
  buffer_load_dwordx4 v2, s[8:11], s24 offen offset:2048 sc1 lds
  buffer_load_dwordx4 v2, s[8:11], s24 offen offset:3072 sc1 lds
  s_add_u32 m0, m0, 4096
  s_add_u32 s24, s24, 4096
  buffer_load_dwordx4 v2, s[8:11], s24 offen offset:0 sc1 lds
  buffer_load_dwordx4 v2, s[8:11], s24 offen offset:1024 sc1 lds
  buffer_load_dwordx4 v2, s[8:11], s24 offen offset:2048 sc1 lds
  s_mov_b32 s19, s34
  s_mov_b32 s32, 0
  s_mov_b32 s33, 57344
  s_waitcnt vmcnt(7)
  s_branch wg_vo_in
wg_vo_loop:
  s_waitcnt vmcnt(11)
wg_vo_in:
  s_barrier
  s_add_u32 s30, s19, 2
  s_lshl_b32 s24, s30, 1
  s_mul_i32 s24, s24, 14336
  s_add_u32 s24, s24, s23
  s_cmp_lt_u32 s30, s35
  s_cselect_b32 s24, s24, 0x10000000
  s_add_u32 m0, s33, s27
  s_nop 0
  buffer_load_dwordx4 v2, s[8:11], s24 offen offset:0 sc1 lds
  buffer_load_dwordx4 v2, s[8:11], s24 offen offset:1024 sc1 lds
  buffer_load_dwordx4 v2, s[8:11], s24 offen offset:2048 sc1 lds
  buffer_load_dwordx4 v2, s[8:11], s24 offen offset:3072 sc1 lds
  s_add_u32 m0, m0, 4096
  s_add_u32 s24, s24, 4096
  buffer_load_dwordx4 v2, s[8:11], s24 offen offset:0 sc1 lds
  buffer_load_dwordx4 v2, s[8:11], s24 offen offset:1024 sc1 lds
  buffer_load_dwordx4 v2, s[8:11], s24 offen offset:2048 sc1 lds
  v_add_u32 v5, s32, v2
  ds_read_b128 v[8:11], v5 offset:0
  ds_read_b128 v[12:15], v5 offset:14336
  ds_read_b128 v[16:19], v5 offset:1024
  ds_read_b128 v[20:23], v5 offset:15360
  ds_read_b128 v[24:27], v5 offset:2048
  ds_read_b128 v[28:31], v5 offset:16384
  ds_read_b128 v[32:35], v5 offset:3072
  s_waitcnt lgkmcnt(6)
  v_mfma_f32_16x16x32_bf16 v[40:43], a[0:3], v[8:11], 0
  v_mfma_f32_16x16x32_bf16 v[44:47], a[56:59], v[8:11], 0
  v_mfma_f32_16x16x32_bf16 v[48:51], a[112:115], v[8:11], 0
  v_mfma_f32_16x16x32_bf16 v[52:55], a[168:171], v[8:11], 0
  ds_read_b128 v[36:39], v5 offset:17408
  s_waitcnt lgkmcnt(6)
  v_mfma_f32_16x16x32_bf16 v[56:59], a[0:3], v[12:15], 0
  v_mfma_f32_16x16x32_bf16 v[60:63], a[56:59], v[12:15], 0
  v_mfma_f32_16x16x32_bf16 v[64:67], a[112:115], v[12:15], 0
  v_mfma_f32_16x16x32_bf16 v[68:71], a[168:171], v[12:15], 0
  ds_read_b128 v[8:11], v5 offset:4096
  s_waitcnt lgkmcnt(6)
  v_mfma_f32_16x16x32_bf16 v[40:43], a[4:7], v[16:19], v[40:43]
  v_mfma_f32_16x16x32_bf16 v[44:47], a[60:63], v[16:19], v[44:47]
  v_mfma_f32_16x16x32_bf16 v[48:51], a[116:119], v[16:19], v[48:51]
  v_mfma_f32_16x16x32_bf16 v[52:55], a[172:175], v[16:19], v[52:55]
  ds_read_b128 v[12:15], v5 offset:18432
  s_waitcnt lgkmcnt(6)
  v_mfma_f32_16x16x32_bf16 v[56:59], a[4:7], v[20:23], v[56:59]
  v_mfma_f32_16x16x32_bf16 v[60:63], a[60:63], v[20:23], v[60:63]
  v_mfma_f32_16x16x32_bf16 v[64:67], a[116:119], v[20:23], v[64:67]
  v_mfma_f32_16x16x32_bf16 v[68:71], a[172:175], v[20:23], v[68:71]
  ds_read_b128 v[16:19], v5 offset:5120
  s_waitcnt lgkmcnt(6)
  v_mfma_f32_16x16x32_bf16 v[40:43], a[8:11], v[24:27], v[40:43]
  v_mfma_f32_16x16x32_bf16 v[44:47], a[64:67], v[24:27], v[44:47]
  v_mfma_f32_16x16x32_bf16 v[48:51], a[120:123], v[24:27], v[48:51]
  v_mfma_f32_16x16x32_bf16 v[52:55], a[176:179], v[24:27], v[52:55]
  ds_read_b128 v[20:23], v5 offset:19456
  s_waitcnt lgkmcnt(6)
  v_mfma_f32_16x16x32_bf16 v[56:59], a[8:11], v[28:31], v[56:59]
  v_mfma_f32_16x16x32_bf16 v[60:63], a[64:67], v[28:31], v[60:63]
  v_mfma_f32_16x16x32_bf16 v[64:67], a[120:123], v[28:31], v[64:67]
  v_mfma_f32_16x16x32_bf16 v[68:71], a[176:179], v[28:31], v[68:71]
  ds_read_b128 v[24:27], v5 offset:6144
  s_waitcnt lgkmcnt(6)
  v_mfma_f32_16x16x32_bf16 v[40:43], a[12:15], v[32:35], v[40:43]
  v_mfma_f32_16x16x32_bf16 v[44:47], a[68:71], v[32:35], v[44:47]
  v_mfma_f32_16x16x32_bf16 v[48:51], a[124:127], v[32:35], v[48:51]
  v_mfma_f32_16x16x32_bf16 v[52:55], a[180:183], v[32:35], v[52:55]
  ds_read_b128 v[28:31], v5 offset:20480
  s_waitcnt lgkmcnt(6)
  v_mfma_f32_16x16x32_bf16 v[56:59], a[12:15], v[36:39], v[56:59]
  v_mfma_f32_16x16x32_bf16 v[60:63], a[68:71], v[36:39], v[60:63]
  v_mfma_f32_16x16x32_bf16 v[64:67], a[124:127], v[36:39], v[64:67]
  v_mfma_f32_16x16x32_bf16 v[68:71], a[180:183], v[36:39], v[68:71]
  ds_read_b128 v[32:35], v5 offset:7168
  s_waitcnt lgkmcnt(6)
  v_mfma_f32_16x16x32_bf16 v[40:43], a[16:19], v[8:11], v[40:43]
  v_mfma_f32_16x16x32_bf16 v[44:47], a[72:75], v[8:11], v[44:47]
  v_mfma_f32_16x16x32_bf16 v[48:51], a[128:131], v[8:11], v[48:51]
  v_mfma_f32_16x16x32_bf16 v[52:55], a[184:187], v[8:11], v[52:55]
  ds_read_b128 v[36:39], v5 offset:21504
  s_waitcnt lgkmcnt(6)
  v_mfma_f32_16x16x32_bf16 v[56:59], a[16:19], v[12:15], v[56:59]
  v_mfma_f32_16x16x32_bf16 v[60:63], a[72:75], v[12:15], v[60:63]
  v_mfma_f32_16x16x32_bf16 v[64:67], a[128:131], v[12:15], v[64:67]
  v_mfma_f32_16x16x32_bf16 v[68:71], a[184:187], v[12:15], v[68:71]
  ds_read_b128 v[8:11], v5 offset:8192
  s_waitcnt lgkmcnt(6)
  v_mfma_f32_16x16x32_bf16 v[40:43], a[20:23], v[16:19], v[40:43]
  v_mfma_f32_16x16x32_bf16 v[44:47], a[76:79], v[16:19], v[44:47]
  v_mfma_f32_16x16x32_bf16 v[48:51], a[132:135], v[16:19], v[48:51]
  v_mfma_f32_16x16x32_bf16 v[52:55], a[188:191], v[16:19], v[52:55]
  ds_read_b128 v[12:15], v5 offset:22528
  s_waitcnt lgkmcnt(6)
  v_mfma_f32_16x16x32_bf16 v[56:59], a[20:23], v[20:23], v[56:59]
  v_mfma_f32_16x16x32_bf16 v[60:63], a[76:79], v[20:23], v[60:63]
  v_mfma_f32_16x16x32_bf16 v[64:67], a[132:135], v[20:23], v[64:67]
  v_mfma_f32_16x16x32_bf16 v[68:71], a[188:191], v[20:23], v[68:71]
  ds_read_b128 v[16:19], v5 offset:9216
  s_waitcnt lgkmcnt(6)
  v_mfma_f32_16x16x32_bf16 v[40:43], a[24:27], v[24:27], v[40:43]
  v_mfma_f32_16x16x32_bf16 v[44:47], a[80:83], v[24:27], v[44:47]
  v_mfma_f32_16x16x32_bf16 v[48:51], a[136:139], v[24:27], v[48:51]
  v_mfma_f32_16x16x32_bf16 v[52:55], a[192:195], v[24:27], v[52:55]
  ds_read_b128 v[20:23], v5 offset:23552
  s_waitcnt lgkmcnt(6)
  v_mfma_f32_16x16x32_bf16 v[56:59], a[24:27], v[28:31], v[56:59]
  v_mfma_f32_16x16x32_bf16 v[60:63], a[80:83], v[28:31], v[60:63]
  v_mfma_f32_16x16x32_bf16 v[64:67], a[136:139], v[28:31], v[64:67]
  v_mfma_f32_16x16x32_bf16 v[68:71], a[192:195], v[28:31], v[68:71]
  ds_read_b128 v[24:27], v5 offset:10240
  s_waitcnt lgkmcnt(6)
  v_mfma_f32_16x16x32_bf16 v[40:43], a[28:31], v[32:35], v[40:43]
  v_mfma_f32_16x16x32_bf16 v[44:47], a[84:87], v[32:35], v[44:47]
  v_mfma_f32_16x16x32_bf16 v[48:51], a[140:143], v[32:35], v[48:51]
  v_mfma_f32_16x16x32_bf16 v[52:55], a[196:199], v[32:35], v[52:55]
  ds_read_b128 v[28:31], v5 offset:24576
  s_waitcnt lgkmcnt(6)
  v_mfma_f32_16x16x32_bf16 v[56:59], a[28:31], v[36:39], v[56:59]
  v_mfma_f32_16x16x32_bf16 v[60:63], a[84:87], v[36:39], v[60:63]
  v_mfma_f32_16x16x32_bf16 v[64:67], a[140:143], v[36:39], v[64:67]
  v_mfma_f32_16x16x32_bf16 v[68:71], a[196:199], v[36:39], v[68:71]
  ds_read_b128 v[32:35], v5 offset:11264
  s_waitcnt lgkmcnt(6)
  v_mfma_f32_16x16x32_bf16 v[40:43], a[32:35], v[8:11], v[40:43]
  v_mfma_f32_16x16x32_bf16 v[44:47], a[88:91], v[8:11], v[44:47]
  v_mfma_f32_16x16x32_bf16 v[48:51], a[144:147], v[8:11], v[48:51]
  v_mfma_f32_16x16x32_bf16 v[52:55], a[200:203], v[8:11], v[52:55]
  ds_read_b128 v[36:39], v5 offset:25600
  s_waitcnt lgkmcnt(6)
  v_mfma_f32_16x16x32_bf16 v[56:59], a[32:35], v[12:15], v[56:59]
  v_mfma_f32_16x16x32_bf16 v[60:63], a[88:91], v[12:15], v[60:63]
  v_mfma_f32_16x16x32_bf16 v[64:67], a[144:147], v[12:15], v[64:67]
  v_mfma_f32_16x16x32_bf16 v[68:71], a[200:203], v[12:15], v[68:71]
  ds_read_b128 v[8:11], v5 offset:12288
  s_waitcnt lgkmcnt(6)
  v_mfma_f32_16x16x32_bf16 v[40:43], a[36:39], v[16:19], v[40:43]
  v_mfma_f32_16x16x32_bf16 v[44:47], a[92:95], v[16:19], v[44:47]
  v_mfma_f32_16x16x32_bf16 v[48:51], a[148:151], v[16:19], v[48:51]
  v_mfma_f32_16x16x32_bf16 v[52:55], a[204:207], v[16:19], v[52:55]
  ds_read_b128 v[12:15], v5 offset:26624
  s_waitcnt lgkmcnt(6)
  v_mfma_f32_16x16x32_bf16 v[56:59], a[36:39], v[20:23], v[56:59]
  v_mfma_f32_16x16x32_bf16 v[60:63], a[92:95], v[20:23], v[60:63]
  v_mfma_f32_16x16x32_bf16 v[64:67], a[148:151], v[20:23], v[64:67]
  v_mfma_f32_16x16x32_bf16 v[68:71], a[204:207], v[20:23], v[68:71]
  ds_read_b128 v[16:19], v5 offset:13312
  s_waitcnt lgkmcnt(6)
  v_mfma_f32_16x16x32_bf16 v[40:43], a[40:43], v[24:27], v[40:43]
  v_mfma_f32_16x16x32_bf16 v[44:47], a[96:99], v[24:27], v[44:47]
  v_mfma_f32_16x16x32_bf16 v[48:51], a[152:155], v[24:27], v[48:51]
  v_mfma_f32_16x16x32_bf16 v[52:55], a[208:211], v[24:27], v[52:55]
  ds_read_b128 v[20:23], v5 offset:27648
  s_waitcnt lgkmcnt(6)
  v_mfma_f32_16x16x32_bf16 v[56:59], a[40:43], v[28:31], v[56:59]
  v_mfma_f32_16x16x32_bf16 v[60:63], a[96:99], v[28:31], v[60:63]
  v_mfma_f32_16x16x32_bf16 v[64:67], a[152:155], v[28:31], v[64:67]
  v_mfma_f32_16x16x32_bf16 v[68:71], a[208:211], v[28:31], v[68:71]
  s_waitcnt lgkmcnt(5)
  v_mfma_f32_16x16x32_bf16 v[40:43], a[44:47], v[32:35], v[40:43]
  v_mfma_f32_16x16x32_bf16 v[44:47], a[100:103], v[32:35], v[44:47]
  v_mfma_f32_16x16x32_bf16 v[48:51], a[156:159], v[32:35], v[48:51]
  v_mfma_f32_16x16x32_bf16 v[52:55], a[212:215], v[32:35], v[52:55]
  s_waitcnt lgkmcnt(4)
  v_mfma_f32_16x16x32_bf16 v[56:59], a[44:47], v[36:39], v[56:59]
  v_mfma_f32_16x16x32_bf16 v[60:63], a[100:103], v[36:39], v[60:63]
  v_mfma_f32_16x16x32_bf16 v[64:67], a[156:159], v[36:39], v[64:67]
  v_mfma_f32_16x16x32_bf16 v[68:71], a[212:215], v[36:39], v[68:71]
  s_waitcnt lgkmcnt(3)
  v_mfma_f32_16x16x32_bf16 v[40:43], a[48:51], v[8:11], v[40:43]
  v_mfma_f32_16x16x32_bf16 v[44:47], a[104:107], v[8:11], v[44:47]
  v_mfma_f32_16x16x32_bf16 v[48:51], a[160:163], v[8:11], v[48:51]
  v_mfma_f32_16x16x32_bf16 v[52:55], a[216:219], v[8:11], v[52:55]
  s_waitcnt lgkmcnt(2)
  v_mfma_f32_16x16x32_bf16 v[56:59], a[48:51], v[12:15], v[56:59]
  v_mfma_f32_16x16x32_bf16 v[60:63], a[104:107], v[12:15], v[60:63]
  v_mfma_f32_16x16x32_bf16 v[64:67], a[160:163], v[12:15], v[64:67]
  v_mfma_f32_16x16x32_bf16 v[68:71], a[216:219], v[12:15], v[68:71]
  s_waitcnt lgkmcnt(1)
  v_mfma_f32_16x16x32_bf16 v[40:43], a[52:55], v[16:19], v[40:43]
  v_mfma_f32_16x16x32_bf16 v[44:47], a[108:111], v[16:19], v[44:47]
  v_mfma_f32_16x16x32_bf16 v[48:51], a[164:167], v[16:19], v[48:51]
  v_mfma_f32_16x16x32_bf16 v[52:55], a[220:223], v[16:19], v[52:55]
  s_waitcnt lgkmcnt(0)
  v_mfma_f32_16x16x32_bf16 v[56:59], a[52:55], v[20:23], v[56:59]
  v_mfma_f32_16x16x32_bf16 v[60:63], a[108:111], v[20:23], v[60:63]
  v_mfma_f32_16x16x32_bf16 v[64:67], a[164:167], v[20:23], v[64:67]
  v_mfma_f32_16x16x32_bf16 v[68:71], a[220:223], v[20:23], v[68:71]
  s_add_u32 s25, s29, 28672
  s_lshl_b32 s24, s19, 5
  s_add_u32 s24, s24, 0
  v_add_u32 v88, s24, v4
  v_mul_u32_u24 v89, 2341, v88
  v_lshrrev_b32 v89, 16, v89
  v_mul_u32_u24 v89, 84, v89
  v_add3_u32 v88, v88, v89, v6
  v_lshlrev_b32 v90, 4, v88
  v_cvt_pk_bf16_f32 v72, v40, v41
  v_cvt_pk_bf16_f32 v73, v42, v43
  v_cvt_pk_bf16_f32 v74, v44, v45
  v_cvt_pk_bf16_f32 v75, v46, v47
  buffer_store_dwordx4 v[72:75], v90, s[8:11], s29 offen sc1
  v_cvt_pk_bf16_f32 v76, v48, v49
  v_cvt_pk_bf16_f32 v77, v50, v51
  v_cvt_pk_bf16_f32 v78, v52, v53
  v_cvt_pk_bf16_f32 v79, v54, v55
  buffer_store_dwordx4 v[76:79], v90, s[8:11], s25 offen sc1
  s_lshl_b32 s24, s19, 5
  s_add_u32 s24, s24, 16
  v_add_u32 v88, s24, v4
  v_mul_u32_u24 v89, 2341, v88
  v_lshrrev_b32 v89, 16, v89
  v_mul_u32_u24 v89, 84, v89
  v_add3_u32 v88, v88, v89, v6
  v_lshlrev_b32 v91, 4, v88
  v_cvt_pk_bf16_f32 v80, v56, v57
  v_cvt_pk_bf16_f32 v81, v58, v59
  v_cvt_pk_bf16_f32 v82, v60, v61
  v_cvt_pk_bf16_f32 v83, v62, v63
  buffer_store_dwordx4 v[80:83], v91, s[8:11], s29 offen sc1
  v_cvt_pk_bf16_f32 v84, v64, v65
  v_cvt_pk_bf16_f32 v85, v66, v67
  v_cvt_pk_bf16_f32 v86, v68, v69
  v_cvt_pk_bf16_f32 v87, v70, v71
  buffer_store_dwordx4 v[84:87], v91, s[8:11], s25 offen sc1
  s_mov_b32 s33, s32
  s_add_u32 s32, s32, 28672
  s_cmp_eq_u32 s32, 86016
  s_cselect_b32 s32, 0, s32
  s_add_u32 s19, s19, 1
  s_cmp_lt_u32 s19, s35
  s_cbranch_scc1 wg_vo_loop
  s_branch wg_done
wg_done:
  s_lshl_b32 s20, s18, 4
  s_and_b32 s21, s17, 15
  s_add_u32 s20, s20, s21
  s_lshl_b32 s20, s20, 7
  s_cmp_lt_u32 s17, 16
  s_cselect_b32 s21, 16384, 0
  s_add_u32 s20, s20, s21
  s_add_u32 s20, s20, 88528896
  s_sub_u32 s21, s35, s34
  v_mov_b32 v5, s21
  v_mov_b32 v6, 0
  s_waitcnt vmcnt(0)
  s_mov_b64 exec, 1
  buffer_atomic_add v5, v6, s[8:11], s20 offen
  s_mov_b64 exec, -1
  s_branch wk_loop
wk_a:
  s_load_dwordx8 s[36:43], s[0:1], 56
  s_load_dwordx4 s[44:47], s[0:1], 88
  s_sub_u32 s3, s3, 368
  s_and_b32 s17, s3, 15
  s_lshr_b32 s19, s3, 5
  s_bitcmp1_b32 s3, 4
  s_cselect_b32 s31, 7, 0
  s_waitcnt lgkmcnt(0)
  s_mov_b32 s60, s40
  s_and_b32 s61, s41, 0xffff
  s_mov_b32 s62, 3670016
  s_mov_b32 s63, 0x20000
  s_mov_b32 s56, s42
  s_and_b32 s57, s43, 0xffff
  s_mov_b32 s58, 3670016
  s_mov_b32 s59, 0x20000
  s_lshl_b32 s30, s16, 13
  s_lshl_b32 s27, s19, 19
  s_lshl_b32 s29, s16, 17
  s_add_u32 s27, s27, s29
  s_lshl_b32 s29, s17, 9
  s_add_u32 s27, s27, s29
  v_lshrrev_b32 v5, 5, v1
  v_and_b32 v6, 31, v1
  v_xor_b32 v6, v6, v5
  v_lshlrev_b32 v6, 4, v6
  v_lshl_add_u32 v6, v5, 13, v6
  s_add_u32 m0, s30, 0
  s_add_u32 s22, s27, 0
  v_xor_b32 v7, 0, v6
  buffer_load_dwordx4 v7, s[56:59], s22 offen offset:0 lds
  s_add_u32 s22, s27, 15360
  v_xor_b32 v7, 32, v6
  buffer_load_dwordx4 v7, s[56:59], s22 offen offset:1024 lds
  s_add_u32 s22, s27, 30720
  v_xor_b32 v7, 64, v6
  buffer_load_dwordx4 v7, s[56:59], s22 offen offset:2048 lds
  s_add_u32 s22, s27, 46080
  v_xor_b32 v7, 96, v6
  buffer_load_dwordx4 v7, s[56:59], s22 offen offset:3072 lds
  s_add_u32 m0, s30, 4096
  s_add_u32 s22, s27, 65536
  v_xor_b32 v7, 128, v6
  buffer_load_dwordx4 v7, s[56:59], s22 offen offset:0 lds
  s_add_u32 s22, s27, 80896
  v_xor_b32 v7, 160, v6
  buffer_load_dwordx4 v7, s[56:59], s22 offen offset:1024 lds
  s_add_u32 s22, s27, 96256
  v_xor_b32 v7, 192, v6
  buffer_load_dwordx4 v7, s[56:59], s22 offen offset:2048 lds
  s_add_u32 s22, s27, 111616
  v_xor_b32 v7, 224, v6
  buffer_load_dwordx4 v7, s[56:59], s22 offen offset:3072 lds
  v_lshrrev_b32 v5, 5, v1
  v_and_b32 v6, 31, v1
  s_lshl_b32 s25, s16, 15
  s_add_u32 s25, s25, 32768
  s_lshl_b32 s26, s17, 9
  s_add_u32 s28, s19, s16
  s_cmp_ge_u32 s28, 7
  s_cselect_b32 s20, 7, 0
  s_sub_u32 s28, s28, s20
  s_add_u32 s28, s28, s31
  s_add_u32 s29, s19, s16
  s_add_u32 s29, s29, 4
  s_cmp_ge_u32 s29, 7
  s_cselect_b32 s20, 7, 0
  s_sub_u32 s29, s29, s20
  s_add_u32 s29, s29, s31
  s_lshl_b32 s32, s28, 18
  s_add_u32 s32, s32, s26
  s_lshl_b32 s33, s29, 18
  s_add_u32 s33, s33, s26
  v_xor_b32 v8, v6, v5
  v_lshlrev_b32 v8, 4, v8
  v_lshl_add_u32 v8, v5, 13, v8
  v_xor_b32 v12, 0, v8
  v_xor_b32 v13, 32, v8
  v_add_u32 v13, 15360, v13
  v_xor_b32 v14, 0, v8
  v_add_u32 v14, 30720, v14
  v_xor_b32 v15, 32, v8
  v_add_u32 v15, 46080, v15
  s_add_u32 s20, s16, 0
  s_and_b32 s20, s20, 3
  s_mul_i32 s21, s20, 65600
  s_lshl_b32 s20, s20, 12
  s_add_u32 s48, s20, s25
  s_mov_b32 m0, s48
  v_xor_b32 v16, s21, v12
  buffer_load_dwordx4 v16, s[60:63], s32 offen offset:0 lds
  v_xor_b32 v17, s21, v13
  buffer_load_dwordx4 v17, s[60:63], s32 offen offset:1024 lds
  v_xor_b32 v18, s21, v14
  buffer_load_dwordx4 v18, s[60:63], s32 offen offset:2048 lds
  v_xor_b32 v19, s21, v15
  buffer_load_dwordx4 v19, s[60:63], s32 offen offset:3072 lds
  s_add_u32 s20, s16, 1
  s_and_b32 s20, s20, 3
  s_mul_i32 s21, s20, 65600
  s_lshl_b32 s20, s20, 12
  s_add_u32 s49, s20, s25
  s_mov_b32 m0, s49
  v_xor_b32 v20, s21, v12
  buffer_load_dwordx4 v20, s[60:63], s32 offen offset:0 lds
  v_xor_b32 v21, s21, v13
  buffer_load_dwordx4 v21, s[60:63], s32 offen offset:1024 lds
  v_xor_b32 v22, s21, v14
  buffer_load_dwordx4 v22, s[60:63], s32 offen offset:2048 lds
  v_xor_b32 v23, s21, v15
  buffer_load_dwordx4 v23, s[60:63], s32 offen offset:3072 lds
  s_add_u32 s20, s16, 2
  s_and_b32 s20, s20, 3
  s_mul_i32 s21, s20, 65600
  s_lshl_b32 s20, s20, 12
  s_add_u32 s50, s20, s25
  s_mov_b32 m0, s50
  v_xor_b32 v24, s21, v12
  buffer_load_dwordx4 v24, s[60:63], s32 offen offset:0 lds
  v_xor_b32 v25, s21, v13
  buffer_load_dwordx4 v25, s[60:63], s32 offen offset:1024 lds
  v_xor_b32 v26, s21, v14
  buffer_load_dwordx4 v26, s[60:63], s32 offen offset:2048 lds
  v_xor_b32 v27, s21, v15
  buffer_load_dwordx4 v27, s[60:63], s32 offen offset:3072 lds
  s_add_u32 s20, s16, 3
  s_and_b32 s20, s20, 3
  s_mul_i32 s21, s20, 65600
  s_lshl_b32 s20, s20, 12
  s_add_u32 s51, s20, s25
  s_mov_b32 m0, s51
  v_xor_b32 v28, s21, v12
  buffer_load_dwordx4 v28, s[60:63], s32 offen offset:0 lds
  v_xor_b32 v29, s21, v13
  buffer_load_dwordx4 v29, s[60:63], s32 offen offset:1024 lds
  v_xor_b32 v30, s21, v14
  buffer_load_dwordx4 v30, s[60:63], s32 offen offset:2048 lds
  v_xor_b32 v31, s21, v15
  buffer_load_dwordx4 v31, s[60:63], s32 offen offset:3072 lds
  s_cmp_eq_u32 s16, 3
  s_cbranch_scc1 aj_np1
  s_add_u32 m0, s48, 16384
  s_nop 0
  buffer_load_dwordx4 v16, s[60:63], s33 offen offset:0 lds
  buffer_load_dwordx4 v17, s[60:63], s33 offen offset:1024 lds
  buffer_load_dwordx4 v18, s[60:63], s33 offen offset:2048 lds
  buffer_load_dwordx4 v19, s[60:63], s33 offen offset:3072 lds
  s_add_u32 m0, s49, 16384
  s_nop 0
  buffer_load_dwordx4 v20, s[60:63], s33 offen offset:0 lds
  buffer_load_dwordx4 v21, s[60:63], s33 offen offset:1024 lds
  buffer_load_dwordx4 v22, s[60:63], s33 offen offset:2048 lds
  buffer_load_dwordx4 v23, s[60:63], s33 offen offset:3072 lds
  s_add_u32 m0, s50, 16384
  s_nop 0
  buffer_load_dwordx4 v24, s[60:63], s33 offen offset:0 lds
  buffer_load_dwordx4 v25, s[60:63], s33 offen offset:1024 lds
  buffer_load_dwordx4 v26, s[60:63], s33 offen offset:2048 lds
  buffer_load_dwordx4 v27, s[60:63], s33 offen offset:3072 lds
  s_add_u32 m0, s51, 16384
  s_nop 0
  buffer_load_dwordx4 v28, s[60:63], s33 offen offset:0 lds
  buffer_load_dwordx4 v29, s[60:63], s33 offen offset:1024 lds
  buffer_load_dwordx4 v30, s[60:63], s33 offen offset:2048 lds
  buffer_load_dwordx4 v31, s[60:63], s33 offen offset:3072 lds
aj_np1:
  s_mov_b32 s79, 0
aj_run:
  s_mul_i32 s30, s17, 401408
  s_mul_i32 s20, s19, 57344
  s_add_u32 s30, s30, s20
  v_add_u32 v12, s30, v2
  v_add_u32 v13, 14336, v12
  v_add_u32 v14, 28672, v12
  v_add_u32 v15, 43008, v12
  v_lshrrev_b32 v7, 2, v4
  v_lshlrev_b32 v7, 3, v7
  v_and_b32 v8, 3, v4
  v_add_u32 v7, v7, v8
  v_xor_b32 v10, v3, v4
  v_lshlrev_b32 v10, 4, v10
  v_lshl_add_u32 v10, v7, 9, v10
  v_add_u32 v10, s25, v10
  v_xor_b32 v32, 0, v10
  v_xor_b32 v33, 64, v10
  v_xor_b32 v34, 128, v10
  v_xor_b32 v35, 192, v10
  v_and_b32 v8, 2, v4
  v_lshlrev_b32 v8, 1, v8
  v_and_b32 v9, 1, v4
  v_add_u32 v8, v8, v9
  v_lshrrev_b32 v7, 2, v4
  v_lshl_add_u32 v7, v7, 4, v8
  v_xor_b32 v8, v8, v3
  v_lshlrev_b32 v8, 4, v8
  v_lshl_add_u32 v7, v7, 9, v8
  s_mov_b32 s24, 1035512379
  s_waitcnt vmcnt(32)
  s_cmp_lg_u32 s16, 3
  s_cbranch_scc1 w3_34
  s_waitcnt vmcnt(16)
w3_34:
  s_barrier
  v_xor_b32 v8, 0, v7
  ds_read_b128 v[128:131], v8 offset:0
  v_xor_b32 v9, 64, v7
  ds_read_b128 v[132:135], v9 offset:0
  v_xor_b32 v10, 128, v7
  ds_read_b128 v[136:139], v10 offset:0
  v_xor_b32 v11, 192, v7
  ds_read_b128 v[140:143], v11 offset:0
  ds_read_b128 v[144:147], v8 offset:256
  ds_read_b128 v[148:151], v9 offset:256
  ds_read_b128 v[152:155], v10 offset:256
  ds_read_b128 v[156:159], v11 offset:256
  s_waitcnt lgkmcnt(4)
  v_xor_b32 v8, 32, v7
  ds_read_b128 v[160:163], v8 offset:1024
  v_xor_b32 v9, 96, v7
  ds_read_b128 v[164:167], v9 offset:1024
  v_xor_b32 v10, 160, v7
  ds_read_b128 v[168:171], v10 offset:1024
  v_xor_b32 v11, 224, v7
  ds_read_b128 v[172:175], v11 offset:1024
  ds_read_b128 v[176:179], v8 offset:1280
  ds_read_b128 v[180:183], v9 offset:1280
  ds_read_b128 v[184:187], v10 offset:1280
  ds_read_b128 v[188:191], v11 offset:1280
  s_waitcnt lgkmcnt(4)
  v_xor_b32 v8, 128, v7
  ds_read_b128 v[192:195], v8 offset:4096
  v_xor_b32 v9, 192, v7
  ds_read_b128 v[196:199], v9 offset:4096
  v_xor_b32 v10, 0, v7
  ds_read_b128 v[200:203], v10 offset:4096
  v_xor_b32 v11, 64, v7
  ds_read_b128 v[204:207], v11 offset:4096
  ds_read_b128 v[208:211], v8 offset:4352
  ds_read_b128 v[212:215], v9 offset:4352
  ds_read_b128 v[216:219], v10 offset:4352
  ds_read_b128 v[220:223], v11 offset:4352
  s_waitcnt lgkmcnt(4)
  v_xor_b32 v8, 160, v7
  ds_read_b128 v[224:227], v8 offset:5120
  v_xor_b32 v9, 224, v7
  ds_read_b128 v[228:231], v9 offset:5120
  v_xor_b32 v10, 32, v7
  ds_read_b128 v[232:235], v10 offset:5120
  v_xor_b32 v11, 96, v7
  ds_read_b128 v[236:239], v11 offset:5120
  ds_read_b128 v[240:243], v8 offset:5376
  ds_read_b128 v[244:247], v9 offset:5376
  ds_read_b128 v[248:251], v10 offset:5376
  ds_read_b128 v[252:255], v11 offset:5376
  s_waitcnt lgkmcnt(4)
  s_waitcnt vmcnt(16) lgkmcnt(0)
  s_cmp_lg_u32 s16, 3
  s_cbranch_scc1 w3_35
  s_waitcnt vmcnt(0)
w3_35:
  ds_read_b128 v[52:55], v32 offset:0
  ds_read_b128 v[56:59], v33 offset:0
  ds_read_b128 v[60:63], v34 offset:0
  ds_read_b128 v[64:67], v35 offset:0
  s_waitcnt lgkmcnt(3)
  v_mfma_f32_16x16x32_bf16 v[96:99], v[52:55], v[128:131], 0
  v_mfma_f32_16x16x32_bf16 v[100:103], v[52:55], v[160:163], 0
  v_mfma_f32_16x16x32_bf16 v[104:107], v[52:55], v[192:195], 0
  v_mfma_f32_16x16x32_bf16 v[108:111], v[52:55], v[224:227], 0
  ds_read_b128 v[52:55], v32 offset:256
  s_waitcnt lgkmcnt(3)
  v_mfma_f32_16x16x32_bf16 v[96:99], v[56:59], v[132:135], v[96:99]
  v_mfma_f32_16x16x32_bf16 v[100:103], v[56:59], v[164:167], v[100:103]
  v_mfma_f32_16x16x32_bf16 v[104:107], v[56:59], v[196:199], v[104:107]
  v_mfma_f32_16x16x32_bf16 v[108:111], v[56:59], v[228:231], v[108:111]
  ds_read_b128 v[56:59], v33 offset:256
  s_waitcnt lgkmcnt(3)
  v_mfma_f32_16x16x32_bf16 v[96:99], v[60:63], v[136:139], v[96:99]
  v_mfma_f32_16x16x32_bf16 v[100:103], v[60:63], v[168:171], v[100:103]
  v_mfma_f32_16x16x32_bf16 v[104:107], v[60:63], v[200:203], v[104:107]
  v_mfma_f32_16x16x32_bf16 v[108:111], v[60:63], v[232:235], v[108:111]
  ds_read_b128 v[60:63], v34 offset:256
  s_waitcnt lgkmcnt(3)
  v_mfma_f32_16x16x32_bf16 v[96:99], v[64:67], v[140:143], v[96:99]
  v_mfma_f32_16x16x32_bf16 v[100:103], v[64:67], v[172:175], v[100:103]
  v_mfma_f32_16x16x32_bf16 v[104:107], v[64:67], v[204:207], v[104:107]
  v_mfma_f32_16x16x32_bf16 v[108:111], v[64:67], v[236:239], v[108:111]
  ds_read_b128 v[64:67], v35 offset:256
  s_waitcnt lgkmcnt(3)
  v_mfma_f32_16x16x32_bf16 v[96:99], v[52:55], v[144:147], v[96:99]
  v_mfma_f32_16x16x32_bf16 v[100:103], v[52:55], v[176:179], v[100:103]
  v_mfma_f32_16x16x32_bf16 v[104:107], v[52:55], v[208:211], v[104:107]
  v_mfma_f32_16x16x32_bf16 v[108:111], v[52:55], v[240:243], v[108:111]
  ds_read_b128 v[52:55], v32 offset:2048
  s_waitcnt lgkmcnt(3)
  v_mfma_f32_16x16x32_bf16 v[96:99], v[56:59], v[148:151], v[96:99]
  v_mfma_f32_16x16x32_bf16 v[100:103], v[56:59], v[180:183], v[100:103]
  v_mfma_f32_16x16x32_bf16 v[104:107], v[56:59], v[212:215], v[104:107]
  v_mfma_f32_16x16x32_bf16 v[108:111], v[56:59], v[244:247], v[108:111]
  ds_read_b128 v[56:59], v33 offset:2048
  s_waitcnt lgkmcnt(3)
  v_mfma_f32_16x16x32_bf16 v[96:99], v[60:63], v[152:155], v[96:99]
  v_mfma_f32_16x16x32_bf16 v[100:103], v[60:63], v[184:187], v[100:103]
  v_mfma_f32_16x16x32_bf16 v[104:107], v[60:63], v[216:219], v[104:107]
  v_mfma_f32_16x16x32_bf16 v[108:111], v[60:63], v[248:251], v[108:111]
  ds_read_b128 v[60:63], v34 offset:2048
  s_waitcnt lgkmcnt(3)
  v_mfma_f32_16x16x32_bf16 v[96:99], v[64:67], v[156:159], v[96:99]
  v_mfma_f32_16x16x32_bf16 v[100:103], v[64:67], v[188:191], v[100:103]
  v_mfma_f32_16x16x32_bf16 v[104:107], v[64:67], v[220:223], v[104:107]
  v_mfma_f32_16x16x32_bf16 v[108:111], v[64:67], v[252:255], v[108:111]
  ds_read_b128 v[64:67], v35 offset:2048
  s_waitcnt lgkmcnt(3)
  v_mfma_f32_16x16x32_bf16 v[112:115], v[52:55], v[128:131], 0
  v_mfma_f32_16x16x32_bf16 v[116:119], v[52:55], v[160:163], 0
  v_mfma_f32_16x16x32_bf16 v[120:123], v[52:55], v[192:195], 0
  v_mfma_f32_16x16x32_bf16 v[124:127], v[52:55], v[224:227], 0
  ds_read_b128 v[52:55], v32 offset:2304
  s_waitcnt lgkmcnt(3)
  v_mfma_f32_16x16x32_bf16 v[112:115], v[56:59], v[132:135], v[112:115]
  v_mfma_f32_16x16x32_bf16 v[116:119], v[56:59], v[164:167], v[116:119]
  v_mfma_f32_16x16x32_bf16 v[120:123], v[56:59], v[196:199], v[120:123]
  v_mfma_f32_16x16x32_bf16 v[124:127], v[56:59], v[228:231], v[124:127]
  ds_read_b128 v[56:59], v33 offset:2304
  s_waitcnt lgkmcnt(3)
  v_mfma_f32_16x16x32_bf16 v[112:115], v[60:63], v[136:139], v[112:115]
  v_mfma_f32_16x16x32_bf16 v[116:119], v[60:63], v[168:171], v[116:119]
  v_mfma_f32_16x16x32_bf16 v[120:123], v[60:63], v[200:203], v[120:123]
  v_mfma_f32_16x16x32_bf16 v[124:127], v[60:63], v[232:235], v[124:127]
  ds_read_b128 v[60:63], v34 offset:2304
  s_waitcnt lgkmcnt(3)
  v_mfma_f32_16x16x32_bf16 v[112:115], v[64:67], v[140:143], v[112:115]
  v_mfma_f32_16x16x32_bf16 v[116:119], v[64:67], v[172:175], v[116:119]
  v_mfma_f32_16x16x32_bf16 v[120:123], v[64:67], v[204:207], v[120:123]
  v_mfma_f32_16x16x32_bf16 v[124:127], v[64:67], v[236:239], v[124:127]
  ds_read_b128 v[64:67], v35 offset:2304
  s_waitcnt lgkmcnt(3)
  v_mfma_f32_16x16x32_bf16 v[112:115], v[52:55], v[144:147], v[112:115]
  v_mfma_f32_16x16x32_bf16 v[116:119], v[52:55], v[176:179], v[116:119]
  v_mfma_f32_16x16x32_bf16 v[120:123], v[52:55], v[208:211], v[120:123]
  v_mfma_f32_16x16x32_bf16 v[124:127], v[52:55], v[240:243], v[124:127]
  s_waitcnt lgkmcnt(2)
  v_mfma_f32_16x16x32_bf16 v[112:115], v[56:59], v[148:151], v[112:115]
  v_mfma_f32_16x16x32_bf16 v[116:119], v[56:59], v[180:183], v[116:119]
  v_mfma_f32_16x16x32_bf16 v[120:123], v[56:59], v[212:215], v[120:123]
  v_mfma_f32_16x16x32_bf16 v[124:127], v[56:59], v[244:247], v[124:127]
  s_waitcnt lgkmcnt(1)
  v_mfma_f32_16x16x32_bf16 v[112:115], v[60:63], v[152:155], v[112:115]
  v_mfma_f32_16x16x32_bf16 v[116:119], v[60:63], v[184:187], v[116:119]
  v_mfma_f32_16x16x32_bf16 v[120:123], v[60:63], v[216:219], v[120:123]
  v_mfma_f32_16x16x32_bf16 v[124:127], v[60:63], v[248:251], v[124:127]
  s_waitcnt lgkmcnt(0)
  v_mfma_f32_16x16x32_bf16 v[112:115], v[64:67], v[156:159], v[112:115]
  v_mfma_f32_16x16x32_bf16 v[116:119], v[64:67], v[188:191], v[116:119]
  v_mfma_f32_16x16x32_bf16 v[120:123], v[64:67], v[220:223], v[120:123]
  v_mfma_f32_16x16x32_bf16 v[124:127], v[64:67], v[252:255], v[124:127]
  s_lshl_b32 s30, s28, 10
  v_mul_f32 v96, s24, v96
  v_mul_f32 v97, s24, v97
  v_mul_f32 v98, s24, v98
  v_mul_f32 v99, s24, v99
  v_cvt_pk_bf16_f32 v68, v96, v97
  v_cvt_pk_bf16_f32 v69, v98, v99
  v_mul_f32 v112, s24, v112
  v_mul_f32 v113, s24, v113
  v_mul_f32 v114, s24, v114
  v_mul_f32 v115, s24, v115
  v_cvt_pk_bf16_f32 v70, v112, v113
  v_cvt_pk_bf16_f32 v71, v114, v115
  buffer_store_dwordx4 v[68:71], v12, s[8:11], s30 offen sc1
  v_mul_f32 v100, s24, v100
  v_mul_f32 v101, s24, v101
  v_mul_f32 v102, s24, v102
  v_mul_f32 v103, s24, v103
  v_cvt_pk_bf16_f32 v72, v100, v101
  v_cvt_pk_bf16_f32 v73, v102, v103
  v_mul_f32 v116, s24, v116
  v_mul_f32 v117, s24, v117
  v_mul_f32 v118, s24, v118
  v_mul_f32 v119, s24, v119
  v_cvt_pk_bf16_f32 v74, v116, v117
  v_cvt_pk_bf16_f32 v75, v118, v119
  buffer_store_dwordx4 v[72:75], v13, s[8:11], s30 offen sc1
  v_mul_f32 v104, s24, v104
  v_mul_f32 v105, s24, v105
  v_mul_f32 v106, s24, v106
  v_mul_f32 v107, s24, v107
  v_cvt_pk_bf16_f32 v76, v104, v105
  v_cvt_pk_bf16_f32 v77, v106, v107
  v_mul_f32 v120, s24, v120
  v_mul_f32 v121, s24, v121
  v_mul_f32 v122, s24, v122
  v_mul_f32 v123, s24, v123
  v_cvt_pk_bf16_f32 v78, v120, v121
  v_cvt_pk_bf16_f32 v79, v122, v123
  buffer_store_dwordx4 v[76:79], v14, s[8:11], s30 offen sc1
  v_mul_f32 v108, s24, v108
  v_mul_f32 v109, s24, v109
  v_mul_f32 v110, s24, v110
  v_mul_f32 v111, s24, v111
  v_cvt_pk_bf16_f32 v80, v108, v109
  v_cvt_pk_bf16_f32 v81, v110, v111
  v_mul_f32 v124, s24, v124
  v_mul_f32 v125, s24, v125
  v_mul_f32 v126, s24, v126
  v_mul_f32 v127, s24, v127
  v_cvt_pk_bf16_f32 v82, v124, v125
  v_cvt_pk_bf16_f32 v83, v126, v127
  buffer_store_dwordx4 v[80:83], v15, s[8:11], s30 offen sc1
  s_cmp_eq_u32 s16, 3
  s_cbranch_scc1 aj_w3
  s_waitcnt vmcnt(4)
  ds_read_b128 v[52:55], v32 offset:16384
  ds_read_b128 v[56:59], v33 offset:16384
  ds_read_b128 v[60:63], v34 offset:16384
  ds_read_b128 v[64:67], v35 offset:16384
  s_waitcnt lgkmcnt(3)
  v_mfma_f32_16x16x32_bf16 v[96:99], v[52:55], v[128:131], 0
  v_mfma_f32_16x16x32_bf16 v[100:103], v[52:55], v[160:163], 0
  v_mfma_f32_16x16x32_bf16 v[104:107], v[52:55], v[192:195], 0
  v_mfma_f32_16x16x32_bf16 v[108:111], v[52:55], v[224:227], 0
  ds_read_b128 v[52:55], v32 offset:16640
  s_waitcnt lgkmcnt(3)
  v_mfma_f32_16x16x32_bf16 v[96:99], v[56:59], v[132:135], v[96:99]
  v_mfma_f32_16x16x32_bf16 v[100:103], v[56:59], v[164:167], v[100:103]
  v_mfma_f32_16x16x32_bf16 v[104:107], v[56:59], v[196:199], v[104:107]
  v_mfma_f32_16x16x32_bf16 v[108:111], v[56:59], v[228:231], v[108:111]
  ds_read_b128 v[56:59], v33 offset:16640
  s_waitcnt lgkmcnt(3)
  v_mfma_f32_16x16x32_bf16 v[96:99], v[60:63], v[136:139], v[96:99]
  v_mfma_f32_16x16x32_bf16 v[100:103], v[60:63], v[168:171], v[100:103]
  v_mfma_f32_16x16x32_bf16 v[104:107], v[60:63], v[200:203], v[104:107]
  v_mfma_f32_16x16x32_bf16 v[108:111], v[60:63], v[232:235], v[108:111]
  ds_read_b128 v[60:63], v34 offset:16640
  s_waitcnt lgkmcnt(3)
  v_mfma_f32_16x16x32_bf16 v[96:99], v[64:67], v[140:143], v[96:99]
  v_mfma_f32_16x16x32_bf16 v[100:103], v[64:67], v[172:175], v[100:103]
  v_mfma_f32_16x16x32_bf16 v[104:107], v[64:67], v[204:207], v[104:107]
  v_mfma_f32_16x16x32_bf16 v[108:111], v[64:67], v[236:239], v[108:111]
  ds_read_b128 v[64:67], v35 offset:16640
  s_waitcnt lgkmcnt(3)
  v_mfma_f32_16x16x32_bf16 v[96:99], v[52:55], v[144:147], v[96:99]
  v_mfma_f32_16x16x32_bf16 v[100:103], v[52:55], v[176:179], v[100:103]
  v_mfma_f32_16x16x32_bf16 v[104:107], v[52:55], v[208:211], v[104:107]
  v_mfma_f32_16x16x32_bf16 v[108:111], v[52:55], v[240:243], v[108:111]
  ds_read_b128 v[52:55], v32 offset:18432
  s_waitcnt lgkmcnt(3)
  v_mfma_f32_16x16x32_bf16 v[96:99], v[56:59], v[148:151], v[96:99]
  v_mfma_f32_16x16x32_bf16 v[100:103], v[56:59], v[180:183], v[100:103]
  v_mfma_f32_16x16x32_bf16 v[104:107], v[56:59], v[212:215], v[104:107]
  v_mfma_f32_16x16x32_bf16 v[108:111], v[56:59], v[244:247], v[108:111]
  ds_read_b128 v[56:59], v33 offset:18432
  s_waitcnt lgkmcnt(3)
  v_mfma_f32_16x16x32_bf16 v[96:99], v[60:63], v[152:155], v[96:99]
  v_mfma_f32_16x16x32_bf16 v[100:103], v[60:63], v[184:187], v[100:103]
  v_mfma_f32_16x16x32_bf16 v[104:107], v[60:63], v[216:219], v[104:107]
  v_mfma_f32_16x16x32_bf16 v[108:111], v[60:63], v[248:251], v[108:111]
  ds_read_b128 v[60:63], v34 offset:18432
  s_waitcnt lgkmcnt(3)
  v_mfma_f32_16x16x32_bf16 v[96:99], v[64:67], v[156:159], v[96:99]
  v_mfma_f32_16x16x32_bf16 v[100:103], v[64:67], v[188:191], v[100:103]
  v_mfma_f32_16x16x32_bf16 v[104:107], v[64:67], v[220:223], v[104:107]
  v_mfma_f32_16x16x32_bf16 v[108:111], v[64:67], v[252:255], v[108:111]
  ds_read_b128 v[64:67], v35 offset:18432
  s_waitcnt lgkmcnt(3)
  v_mfma_f32_16x16x32_bf16 v[112:115], v[52:55], v[128:131], 0
  v_mfma_f32_16x16x32_bf16 v[116:119], v[52:55], v[160:163], 0
  v_mfma_f32_16x16x32_bf16 v[120:123], v[52:55], v[192:195], 0
  v_mfma_f32_16x16x32_bf16 v[124:127], v[52:55], v[224:227], 0
  ds_read_b128 v[52:55], v32 offset:18688
  s_waitcnt lgkmcnt(3)
  v_mfma_f32_16x16x32_bf16 v[112:115], v[56:59], v[132:135], v[112:115]
  v_mfma_f32_16x16x32_bf16 v[116:119], v[56:59], v[164:167], v[116:119]
  v_mfma_f32_16x16x32_bf16 v[120:123], v[56:59], v[196:199], v[120:123]
  v_mfma_f32_16x16x32_bf16 v[124:127], v[56:59], v[228:231], v[124:127]
  ds_read_b128 v[56:59], v33 offset:18688
  s_waitcnt lgkmcnt(3)
  v_mfma_f32_16x16x32_bf16 v[112:115], v[60:63], v[136:139], v[112:115]
  v_mfma_f32_16x16x32_bf16 v[116:119], v[60:63], v[168:171], v[116:119]
  v_mfma_f32_16x16x32_bf16 v[120:123], v[60:63], v[200:203], v[120:123]
  v_mfma_f32_16x16x32_bf16 v[124:127], v[60:63], v[232:235], v[124:127]
  ds_read_b128 v[60:63], v34 offset:18688
  s_waitcnt lgkmcnt(3)
  v_mfma_f32_16x16x32_bf16 v[112:115], v[64:67], v[140:143], v[112:115]
  v_mfma_f32_16x16x32_bf16 v[116:119], v[64:67], v[172:175], v[116:119]
  v_mfma_f32_16x16x32_bf16 v[120:123], v[64:67], v[204:207], v[120:123]
  v_mfma_f32_16x16x32_bf16 v[124:127], v[64:67], v[236:239], v[124:127]
  ds_read_b128 v[64:67], v35 offset:18688
  s_waitcnt lgkmcnt(3)
  v_mfma_f32_16x16x32_bf16 v[112:115], v[52:55], v[144:147], v[112:115]
  v_mfma_f32_16x16x32_bf16 v[116:119], v[52:55], v[176:179], v[116:119]
  v_mfma_f32_16x16x32_bf16 v[120:123], v[52:55], v[208:211], v[120:123]
  v_mfma_f32_16x16x32_bf16 v[124:127], v[52:55], v[240:243], v[124:127]
  s_waitcnt lgkmcnt(2)
  v_mfma_f32_16x16x32_bf16 v[112:115], v[56:59], v[148:151], v[112:115]
  v_mfma_f32_16x16x32_bf16 v[116:119], v[56:59], v[180:183], v[116:119]
  v_mfma_f32_16x16x32_bf16 v[120:123], v[56:59], v[212:215], v[120:123]
  v_mfma_f32_16x16x32_bf16 v[124:127], v[56:59], v[244:247], v[124:127]
  s_waitcnt lgkmcnt(1)
  v_mfma_f32_16x16x32_bf16 v[112:115], v[60:63], v[152:155], v[112:115]
  v_mfma_f32_16x16x32_bf16 v[116:119], v[60:63], v[184:187], v[116:119]
  v_mfma_f32_16x16x32_bf16 v[120:123], v[60:63], v[216:219], v[120:123]
  v_mfma_f32_16x16x32_bf16 v[124:127], v[60:63], v[248:251], v[124:127]
  s_waitcnt lgkmcnt(0)
  v_mfma_f32_16x16x32_bf16 v[112:115], v[64:67], v[156:159], v[112:115]
  v_mfma_f32_16x16x32_bf16 v[116:119], v[64:67], v[188:191], v[116:119]
  v_mfma_f32_16x16x32_bf16 v[120:123], v[64:67], v[220:223], v[120:123]
  v_mfma_f32_16x16x32_bf16 v[124:127], v[64:67], v[252:255], v[124:127]
  s_lshl_b32 s30, s29, 10
  v_mul_f32 v96, s24, v96
  v_mul_f32 v97, s24, v97
  v_mul_f32 v98, s24, v98
  v_mul_f32 v99, s24, v99
  v_cvt_pk_bf16_f32 v68, v96, v97
  v_cvt_pk_bf16_f32 v69, v98, v99
  v_mul_f32 v112, s24, v112
  v_mul_f32 v113, s24, v113
  v_mul_f32 v114, s24, v114
  v_mul_f32 v115, s24, v115
  v_cvt_pk_bf16_f32 v70, v112, v113
  v_cvt_pk_bf16_f32 v71, v114, v115
  buffer_store_dwordx4 v[68:71], v12, s[8:11], s30 offen sc1
  v_mul_f32 v100, s24, v100
  v_mul_f32 v101, s24, v101
  v_mul_f32 v102, s24, v102
  v_mul_f32 v103, s24, v103
  v_cvt_pk_bf16_f32 v72, v100, v101
  v_cvt_pk_bf16_f32 v73, v102, v103
  v_mul_f32 v116, s24, v116
  v_mul_f32 v117, s24, v117
  v_mul_f32 v118, s24, v118
  v_mul_f32 v119, s24, v119
  v_cvt_pk_bf16_f32 v74, v116, v117
  v_cvt_pk_bf16_f32 v75, v118, v119
  buffer_store_dwordx4 v[72:75], v13, s[8:11], s30 offen sc1
  v_mul_f32 v104, s24, v104
  v_mul_f32 v105, s24, v105
  v_mul_f32 v106, s24, v106
  v_mul_f32 v107, s24, v107
  v_cvt_pk_bf16_f32 v76, v104, v105
  v_cvt_pk_bf16_f32 v77, v106, v107
  v_mul_f32 v120, s24, v120
  v_mul_f32 v121, s24, v121
  v_mul_f32 v122, s24, v122
  v_mul_f32 v123, s24, v123
  v_cvt_pk_bf16_f32 v78, v120, v121
  v_cvt_pk_bf16_f32 v79, v122, v123
  buffer_store_dwordx4 v[76:79], v14, s[8:11], s30 offen sc1
  v_mul_f32 v108, s24, v108
  v_mul_f32 v109, s24, v109
  v_mul_f32 v110, s24, v110
  v_mul_f32 v111, s24, v111
  v_cvt_pk_bf16_f32 v80, v108, v109
  v_cvt_pk_bf16_f32 v81, v110, v111
  v_mul_f32 v124, s24, v124
  v_mul_f32 v125, s24, v125
  v_mul_f32 v126, s24, v126
  v_mul_f32 v127, s24, v127
  v_cvt_pk_bf16_f32 v82, v124, v125
  v_cvt_pk_bf16_f32 v83, v126, v127
  buffer_store_dwordx4 v[80:83], v15, s[8:11], s30 offen sc1
aj_w3:
  s_lshl_b32 s28, s17, 7
  s_lshl_b32 s21, s19, 4
  s_add_u32 s28, s28, s21
  s_cmp_lg_u32 s31, 0
  s_cselect_b32 s21, 8, 0
  s_add_u32 s28, s28, s21
  s_add_u32 s28, s28, 88621056
  s_waitcnt vmcnt(0)
  s_barrier
  s_cmp_lg_u32 s16, 0
  s_cbranch_scc1 pub_36
  v_mul_u32_u24 v26, 2048, v1
  v_mov_b32 v24, s88
  v_mov_b32 v25, s89
  s_mov_b64 exec, 1
  buffer_store_dwordx2 v[24:25], v26, s[8:11], s28 offen sc1
  s_mov_b64 exec, -1
pub_36:
  s_cmp_lg_u32 s79, 0
  s_cbranch_scc1 bj_end
  v_mov_b32 v250, 0
  s_branch wk_loop
wk_srv:
  s_sub_u32 s3, s3, 336
  s_and_b32 s18, s3, 15
  s_lshr_b32 s19, s3, 4
  s_and_b32 s19, s19, 1
  s_mul_i32 s20, s18, 401408
  s_mul_i32 s21, s16, 100352
  s_add_u32 s20, s20, s21
  s_add_u32 s20, s20, 6422528
  s_add_u32 s22, s20, 0
  buffer_load_dwordx4 a[0:3], v2, s[8:11], s22 offen offset:0 sc1
  buffer_load_dwordx4 a[4:7], v2, s[8:11], s22 offen offset:1024 sc1
  buffer_load_dwordx4 a[8:11], v2, s[8:11], s22 offen offset:2048 sc1
  buffer_load_dwordx4 a[12:15], v2, s[8:11], s22 offen offset:3072 sc1
  s_add_u32 s22, s20, 4096
  buffer_load_dwordx4 a[16:19], v2, s[8:11], s22 offen offset:0 sc1
  buffer_load_dwordx4 a[20:23], v2, s[8:11], s22 offen offset:1024 sc1
  buffer_load_dwordx4 a[24:27], v2, s[8:11], s22 offen offset:2048 sc1
  buffer_load_dwordx4 a[28:31], v2, s[8:11], s22 offen offset:3072 sc1
  s_add_u32 s22, s20, 8192
  buffer_load_dwordx4 a[32:35], v2, s[8:11], s22 offen offset:0 sc1
  buffer_load_dwordx4 a[36:39], v2, s[8:11], s22 offen offset:1024 sc1
  buffer_load_dwordx4 a[40:43], v2, s[8:11], s22 offen offset:2048 sc1
  buffer_load_dwordx4 a[44:47], v2, s[8:11], s22 offen offset:3072 sc1
  s_add_u32 s22, s20, 12288
  buffer_load_dwordx4 a[48:51], v2, s[8:11], s22 offen offset:0 sc1
  buffer_load_dwordx4 a[52:55], v2, s[8:11], s22 offen offset:1024 sc1
  buffer_load_dwordx4 a[56:59], v2, s[8:11], s22 offen offset:2048 sc1
  buffer_load_dwordx4 a[60:63], v2, s[8:11], s22 offen offset:3072 sc1
  s_add_u32 s22, s20, 16384
  buffer_load_dwordx4 a[64:67], v2, s[8:11], s22 offen offset:0 sc1
  buffer_load_dwordx4 a[68:71], v2, s[8:11], s22 offen offset:1024 sc1
  buffer_load_dwordx4 a[72:75], v2, s[8:11], s22 offen offset:2048 sc1
  buffer_load_dwordx4 a[76:79], v2, s[8:11], s22 offen offset:3072 sc1
  s_add_u32 s22, s20, 20480
  buffer_load_dwordx4 a[80:83], v2, s[8:11], s22 offen offset:0 sc1
  buffer_load_dwordx4 a[84:87], v2, s[8:11], s22 offen offset:1024 sc1
  buffer_load_dwordx4 a[88:91], v2, s[8:11], s22 offen offset:2048 sc1
  buffer_load_dwordx4 a[92:95], v2, s[8:11], s22 offen offset:3072 sc1
  s_add_u32 s22, s20, 24576
  buffer_load_dwordx4 a[96:99], v2, s[8:11], s22 offen offset:0 sc1
  buffer_load_dwordx4 a[100:103], v2, s[8:11], s22 offen offset:1024 sc1
  buffer_load_dwordx4 a[104:107], v2, s[8:11], s22 offen offset:2048 sc1
  buffer_load_dwordx4 a[108:111], v2, s[8:11], s22 offen offset:3072 sc1
  s_add_u32 s22, s20, 28672
  buffer_load_dwordx4 a[112:115], v2, s[8:11], s22 offen offset:0 sc1
  buffer_load_dwordx4 a[116:119], v2, s[8:11], s22 offen offset:1024 sc1
  buffer_load_dwordx4 a[120:123], v2, s[8:11], s22 offen offset:2048 sc1
  buffer_load_dwordx4 a[124:127], v2, s[8:11], s22 offen offset:3072 sc1
  s_waitcnt vmcnt(24)
  s_add_u32 s22, s20, 32768
  buffer_load_dwordx4 a[128:131], v2, s[8:11], s22 offen offset:0 sc1
  buffer_load_dwordx4 a[132:135], v2, s[8:11], s22 offen offset:1024 sc1
  buffer_load_dwordx4 a[136:139], v2, s[8:11], s22 offen offset:2048 sc1
  buffer_load_dwordx4 a[140:143], v2, s[8:11], s22 offen offset:3072 sc1
  s_add_u32 s22, s20, 36864
  buffer_load_dwordx4 a[144:147], v2, s[8:11], s22 offen offset:0 sc1
  buffer_load_dwordx4 a[148:151], v2, s[8:11], s22 offen offset:1024 sc1
  buffer_load_dwordx4 a[152:155], v2, s[8:11], s22 offen offset:2048 sc1
  buffer_load_dwordx4 a[156:159], v2, s[8:11], s22 offen offset:3072 sc1
  s_add_u32 s22, s20, 40960
  buffer_load_dwordx4 a[160:163], v2, s[8:11], s22 offen offset:0 sc1
  buffer_load_dwordx4 a[164:167], v2, s[8:11], s22 offen offset:1024 sc1
  buffer_load_dwordx4 a[168:171], v2, s[8:11], s22 offen offset:2048 sc1
  buffer_load_dwordx4 a[172:175], v2, s[8:11], s22 offen offset:3072 sc1
  s_add_u32 s22, s20, 45056
  buffer_load_dwordx4 a[176:179], v2, s[8:11], s22 offen offset:0 sc1
  buffer_load_dwordx4 a[180:183], v2, s[8:11], s22 offen offset:1024 sc1
  buffer_load_dwordx4 a[184:187], v2, s[8:11], s22 offen offset:2048 sc1
  buffer_load_dwordx4 a[188:191], v2, s[8:11], s22 offen offset:3072 sc1
  s_add_u32 s22, s20, 49152
  buffer_load_dwordx4 a[192:195], v2, s[8:11], s22 offen offset:0 sc1
  buffer_load_dwordx4 a[196:199], v2, s[8:11], s22 offen offset:1024 sc1
  buffer_load_dwordx4 a[200:203], v2, s[8:11], s22 offen offset:2048 sc1
  buffer_load_dwordx4 a[204:207], v2, s[8:11], s22 offen offset:3072 sc1
  s_add_u32 s22, s20, 53248
  buffer_load_dwordx4 a[208:211], v2, s[8:11], s22 offen offset:0 sc1
  buffer_load_dwordx4 a[212:215], v2, s[8:11], s22 offen offset:1024 sc1
  buffer_load_dwordx4 a[216:219], v2, s[8:11], s22 offen offset:2048 sc1
  buffer_load_dwordx4 a[220:223], v2, s[8:11], s22 offen offset:3072 sc1
  s_add_u32 s22, s20, 57344
  buffer_load_dwordx4 a[224:227], v2, s[8:11], s22 offen offset:0 sc1
  buffer_load_dwordx4 a[228:231], v2, s[8:11], s22 offen offset:1024 sc1
  buffer_load_dwordx4 a[232:235], v2, s[8:11], s22 offen offset:2048 sc1
  buffer_load_dwordx4 a[236:239], v2, s[8:11], s22 offen offset:3072 sc1
  s_add_u32 s22, s20, 61440
  buffer_load_dwordx4 a[240:243], v2, s[8:11], s22 offen offset:0 sc1
  buffer_load_dwordx4 a[244:247], v2, s[8:11], s22 offen offset:1024 sc1
  buffer_load_dwordx4 a[248:251], v2, s[8:11], s22 offen offset:2048 sc1
  buffer_load_dwordx4 a[252:255], v2, s[8:11], s22 offen offset:3072 sc1
  s_waitcnt vmcnt(24)
  s_add_u32 s22, s20, 65536
  buffer_load_dwordx4 v[120:123], v2, s[8:11], s22 offen offset:0 sc1
  buffer_load_dwordx4 v[124:127], v2, s[8:11], s22 offen offset:1024 sc1
  buffer_load_dwordx4 v[128:131], v2, s[8:11], s22 offen offset:2048 sc1
  buffer_load_dwordx4 v[132:135], v2, s[8:11], s22 offen offset:3072 sc1
  s_add_u32 s22, s20, 69632
  buffer_load_dwordx4 v[136:139], v2, s[8:11], s22 offen offset:0 sc1
  buffer_load_dwordx4 v[140:143], v2, s[8:11], s22 offen offset:1024 sc1
  buffer_load_dwordx4 v[144:147], v2, s[8:11], s22 offen offset:2048 sc1
  buffer_load_dwordx4 v[148:151], v2, s[8:11], s22 offen offset:3072 sc1
  s_add_u32 s22, s20, 73728
  buffer_load_dwordx4 v[152:155], v2, s[8:11], s22 offen offset:0 sc1
  buffer_load_dwordx4 v[156:159], v2, s[8:11], s22 offen offset:1024 sc1
  buffer_load_dwordx4 v[160:163], v2, s[8:11], s22 offen offset:2048 sc1
  buffer_load_dwordx4 v[164:167], v2, s[8:11], s22 offen offset:3072 sc1
  s_add_u32 s22, s20, 77824
  buffer_load_dwordx4 v[168:171], v2, s[8:11], s22 offen offset:0 sc1
  buffer_load_dwordx4 v[172:175], v2, s[8:11], s22 offen offset:1024 sc1
  buffer_load_dwordx4 v[176:179], v2, s[8:11], s22 offen offset:2048 sc1
  buffer_load_dwordx4 v[180:183], v2, s[8:11], s22 offen offset:3072 sc1
  s_add_u32 s22, s20, 81920
  buffer_load_dwordx4 v[184:187], v2, s[8:11], s22 offen offset:0 sc1
  buffer_load_dwordx4 v[188:191], v2, s[8:11], s22 offen offset:1024 sc1
  buffer_load_dwordx4 v[192:195], v2, s[8:11], s22 offen offset:2048 sc1
  buffer_load_dwordx4 v[196:199], v2, s[8:11], s22 offen offset:3072 sc1
  s_add_u32 s22, s20, 86016
  buffer_load_dwordx4 v[200:203], v2, s[8:11], s22 offen offset:0 sc1
  buffer_load_dwordx4 v[204:207], v2, s[8:11], s22 offen offset:1024 sc1
  buffer_load_dwordx4 v[208:211], v2, s[8:11], s22 offen offset:2048 sc1
  buffer_load_dwordx4 v[212:215], v2, s[8:11], s22 offen offset:3072 sc1
  s_add_u32 s22, s20, 90112
  buffer_load_dwordx4 v[216:219], v2, s[8:11], s22 offen offset:0 sc1
  buffer_load_dwordx4 v[220:223], v2, s[8:11], s22 offen offset:1024 sc1
  buffer_load_dwordx4 v[224:227], v2, s[8:11], s22 offen offset:2048 sc1
  buffer_load_dwordx4 v[228:231], v2, s[8:11], s22 offen offset:3072 sc1
  s_add_u32 s22, s20, 94208
  buffer_load_dwordx4 v[232:235], v2, s[8:11], s22 offen offset:0 sc1
  buffer_load_dwordx4 v[236:239], v2, s[8:11], s22 offen offset:1024 sc1
  buffer_load_dwordx4 v[240:243], v2, s[8:11], s22 offen offset:2048 sc1
  buffer_load_dwordx4 v[244:247], v2, s[8:11], s22 offen offset:3072 sc1
  s_waitcnt vmcnt(24)
  s_add_u32 s22, s20, 98304
  buffer_load_dwordx4 v[248:251], v2, s[8:11], s22 offen offset:0 sc1
  buffer_load_dwordx4 v[252:255], v2, s[8:11], s22 offen offset:1024 sc1
  v_mov_b32 v5, 0x4444
  v_mov_b32 v6, 0xeeee
  v_cmp_lt_u32 vcc, 7, v4
  s_nop 1
  v_cndmask_b32 v5, v5, v6, vcc
  s_lshl_b32 s23, s16, 11
  v_lshrrev_b32 v80, 1, v3
  v_and_b32 v81, 1, v3
  v_add_u32 v82, 0, v80
  v_lshl_add_u32 v82, v82, 4, v4
  v_mul_u32_u24 v83, 2341, v82
  v_lshrrev_b32 v83, 16, v83
  v_mul_u32_u24 v84, 28, v83
  v_sub_u32 v84, v82, v84
  v_lshrrev_b32 v85, 4, v84
  v_and_b32 v84, 15, v84
  v_lshlrev_b32 v86, 10, v85
  v_lshl_add_u32 v86, v83, 8, v86
  v_lshl_add_u32 v86, v84, 4, v86
  v_lshl_add_u32 v86, v81, 3, v86
  v_add_u32 v72, s23, v86
  v_add_u32 v82, 2, v80
  v_lshl_add_u32 v82, v82, 4, v4
  v_mul_u32_u24 v83, 2341, v82
  v_lshrrev_b32 v83, 16, v83
  v_mul_u32_u24 v84, 28, v83
  v_sub_u32 v84, v82, v84
  v_lshrrev_b32 v85, 4, v84
  v_and_b32 v84, 15, v84
  v_lshlrev_b32 v86, 10, v85
  v_lshl_add_u32 v86, v83, 8, v86
  v_lshl_add_u32 v86, v84, 4, v86
  v_lshl_add_u32 v86, v81, 3, v86
  v_add_u32 v73, s23, v86
  v_add_u32 v82, 4, v80
  v_lshl_add_u32 v82, v82, 4, v4
  v_mul_u32_u24 v83, 2341, v82
  v_lshrrev_b32 v83, 16, v83
  v_mul_u32_u24 v84, 28, v83
  v_sub_u32 v84, v82, v84
  v_lshrrev_b32 v85, 4, v84
  v_and_b32 v84, 15, v84
  v_lshlrev_b32 v86, 10, v85
  v_lshl_add_u32 v86, v83, 8, v86
  v_lshl_add_u32 v86, v84, 4, v86
  v_lshl_add_u32 v86, v81, 3, v86
  v_add_u32 v74, s23, v86
  v_mov_b32 v82, 6
  v_lshl_add_u32 v82, v82, 4, v4
  v_mul_u32_u24 v83, 2341, v82
  v_lshrrev_b32 v83, 16, v83
  v_mul_u32_u24 v84, 28, v83
  v_sub_u32 v84, v82, v84
  v_lshrrev_b32 v85, 4, v84
  v_and_b32 v84, 15, v84
  v_lshlrev_b32 v86, 10, v85
  v_lshl_add_u32 v86, v83, 8, v86
  v_lshl_add_u32 v86, v84, 4, v86
  v_lshl_add_u32 v86, v81, 3, v86
  v_add_u32 v75, s23, v86
  v_add_u32 v76, s23, v2
  s_mul_i32 s27, s18, 448
  v_mov_b32 v77, s27
  v_mov_b32 v78, 1
  s_mov_b32 s17, s19
  s_mul_i32 s24, s19, 7168
  s_add_u32 s24, s24, 88068096
  s_mul_i32 s25, s18, 65
  s_add_u32 s25, s25, s19
  s_lshl_b32 s25, s25, 13
  s_add_u32 s25, s25, s23
  s_add_u32 s25, s25, 76935168
  s_lshl_b32 s26, s18, 6
  s_add_u32 s26, s26, s19
  s_lshl_b32 s26, s26, 4
  s_lshl_b32 s27, s16, 2
  s_add_u32 s26, s26, s27
  s_add_u32 s26, s26, 88569856
ws_loop:
  v_mov_b32 v36, 0
  v_mov_b32 v37, 0
  v_mov_b32 v38, 0
  v_mov_b32 v39, 0
  v_mov_b32 v40, 0
  v_mov_b32 v41, 0
  v_mov_b32 v42, 0
  v_mov_b32 v43, 0
  v_mov_b32 v44, 0
  v_mov_b32 v45, 0
  v_mov_b32 v46, 0
  v_mov_b32 v47, 0
  v_mov_b32 v48, 0
  v_mov_b32 v49, 0
  v_mov_b32 v50, 0
  v_mov_b32 v51, 0
  v_mov_b32 v52, 0
  v_mov_b32 v53, 0
  v_mov_b32 v54, 0
  v_mov_b32 v55, 0
  v_mov_b32 v56, 0
  v_mov_b32 v57, 0
  v_mov_b32 v58, 0
  v_mov_b32 v59, 0
  v_mov_b32 v60, 0
  v_mov_b32 v61, 0
  v_mov_b32 v62, 0
  v_mov_b32 v63, 0
  s_mov_b32 s30, 0
ws_pm:
  v_mov_b32 v79, 0
  s_mov_b64 exec, 1
  buffer_atomic_or v79, v77, s[8:11], s24 offen sc0
  s_mov_b64 exec, -1
  s_waitcnt vmcnt(0)
  v_cmp_eq_u32 vcc, -1, v79
  s_cbranch_vccnz ws_pr
ws_fl:
  s_add_u32 s22, s24, 4096
  buffer_load_dwordx4 v[8:11], v2, s[8:11], s24 offen offset:0 sc1
  buffer_load_dwordx4 v[12:15], v2, s[8:11], s24 offen offset:1024 sc1
  buffer_load_dwordx4 v[16:19], v2, s[8:11], s24 offen offset:2048 sc1
  buffer_load_dwordx4 v[20:23], v2, s[8:11], s24 offen offset:3072 sc1
  buffer_load_dwordx4 v[24:27], v2, s[8:11], s22 offen offset:0 sc1
  buffer_load_dwordx4 v[28:31], v2, s[8:11], s22 offen offset:1024 sc1
  buffer_load_dwordx4 v[32:35], v2, s[8:11], s22 offen offset:2048 sc1
  s_waitcnt vmcnt(0)
  v_max_u32 v79, v8, v9
  v_max3_u32 v79, v79, v10, v11
  v_max3_u32 v79, v79, v12, v13
  v_max3_u32 v79, v79, v14, v15
  v_max3_u32 v79, v79, v16, v17
  v_max3_u32 v79, v79, v18, v19
  v_max3_u32 v79, v79, v20, v21
  v_max3_u32 v79, v79, v22, v23
  v_max3_u32 v79, v79, v24, v25
  v_max3_u32 v79, v79, v26, v27
  v_max3_u32 v79, v79, v28, v29
  v_max3_u32 v79, v79, v30, v31
  v_max3_u32 v79, v79, v32, v33
  v_max3_u32 v79, v79, v34, v35
  v_cmp_eq_u32 vcc, -1, v79
  s_cbranch_vccz ws_pk
ws_pr:
  s_sleep 6
  s_add_u32 s30, s30, 1
  s_cmp_lt_u32 s30, 30000
  s_cbranch_scc1 ws_pm
  s_branch cA_abort
ws_pk:
  v_smfmac_f32_16x16x64_bf16 v[36:39], v[8:11], a[0:7], v5
  v_smfmac_f32_16x16x64_bf16 v[36:39], v[12:15], a[8:15], v5
  v_smfmac_f32_16x16x64_bf16 v[36:39], v[16:19], a[16:23], v5
  v_smfmac_f32_16x16x64_bf16 v[36:39], v[20:23], a[24:31], v5
  v_smfmac_f32_16x16x64_bf16 v[36:39], v[24:27], a[32:39], v5
  v_smfmac_f32_16x16x64_bf16 v[36:39], v[28:31], a[40:47], v5
  v_smfmac_f32_16x16x64_bf16 v[36:39], v[32:35], a[48:55], v5
  v_smfmac_f32_16x16x64_bf16 v[40:43], v[8:11], a[56:63], v5
  v_smfmac_f32_16x16x64_bf16 v[40:43], v[12:15], a[64:71], v5
  v_smfmac_f32_16x16x64_bf16 v[40:43], v[16:19], a[72:79], v5
  v_smfmac_f32_16x16x64_bf16 v[40:43], v[20:23], a[80:87], v5
  v_smfmac_f32_16x16x64_bf16 v[40:43], v[24:27], a[88:95], v5
  v_smfmac_f32_16x16x64_bf16 v[40:43], v[28:31], a[96:103], v5
  v_smfmac_f32_16x16x64_bf16 v[40:43], v[32:35], a[104:111], v5
  v_smfmac_f32_16x16x64_bf16 v[44:47], v[8:11], a[112:119], v5
  v_smfmac_f32_16x16x64_bf16 v[44:47], v[12:15], a[120:127], v5
  v_smfmac_f32_16x16x64_bf16 v[44:47], v[16:19], a[128:135], v5
  v_smfmac_f32_16x16x64_bf16 v[44:47], v[20:23], a[136:143], v5
  v_smfmac_f32_16x16x64_bf16 v[44:47], v[24:27], a[144:151], v5
  v_smfmac_f32_16x16x64_bf16 v[44:47], v[28:31], a[152:159], v5
  v_smfmac_f32_16x16x64_bf16 v[44:47], v[32:35], a[160:167], v5
  v_smfmac_f32_16x16x64_bf16 v[48:51], v[8:11], a[168:175], v5
  v_smfmac_f32_16x16x64_bf16 v[48:51], v[12:15], a[176:183], v5
  v_smfmac_f32_16x16x64_bf16 v[48:51], v[16:19], a[184:191], v5
  v_smfmac_f32_16x16x64_bf16 v[48:51], v[20:23], a[192:199], v5
  v_smfmac_f32_16x16x64_bf16 v[48:51], v[24:27], a[200:207], v5
  v_smfmac_f32_16x16x64_bf16 v[48:51], v[28:31], a[208:215], v5
  v_smfmac_f32_16x16x64_bf16 v[48:51], v[32:35], a[216:223], v5
  v_smfmac_f32_16x16x64_bf16 v[52:55], v[8:11], a[224:231], v5
  v_smfmac_f32_16x16x64_bf16 v[52:55], v[12:15], a[232:239], v5
  v_smfmac_f32_16x16x64_bf16 v[52:55], v[16:19], a[240:247], v5
  v_smfmac_f32_16x16x64_bf16 v[52:55], v[20:23], a[248:255], v5
  v_smfmac_f32_16x16x64_bf16 v[52:55], v[24:27], v[120:127], v5
  v_smfmac_f32_16x16x64_bf16 v[52:55], v[28:31], v[128:135], v5
  v_smfmac_f32_16x16x64_bf16 v[52:55], v[32:35], v[136:143], v5
  v_smfmac_f32_16x16x64_bf16 v[56:59], v[8:11], v[144:151], v5
  v_smfmac_f32_16x16x64_bf16 v[56:59], v[12:15], v[152:159], v5
  v_smfmac_f32_16x16x64_bf16 v[56:59], v[16:19], v[160:167], v5
  v_smfmac_f32_16x16x64_bf16 v[56:59], v[20:23], v[168:175], v5
  v_smfmac_f32_16x16x64_bf16 v[56:59], v[24:27], v[176:183], v5
  v_smfmac_f32_16x16x64_bf16 v[56:59], v[28:31], v[184:191], v5
  v_smfmac_f32_16x16x64_bf16 v[56:59], v[32:35], v[192:199], v5
  v_smfmac_f32_16x16x64_bf16 v[60:63], v[8:11], v[200:207], v5
  v_smfmac_f32_16x16x64_bf16 v[60:63], v[12:15], v[208:215], v5
  v_smfmac_f32_16x16x64_bf16 v[60:63], v[16:19], v[216:223], v5
  v_smfmac_f32_16x16x64_bf16 v[60:63], v[20:23], v[224:231], v5
  v_smfmac_f32_16x16x64_bf16 v[60:63], v[24:27], v[232:239], v5
  v_smfmac_f32_16x16x64_bf16 v[60:63], v[28:31], v[240:247], v5
  v_smfmac_f32_16x16x64_bf16 v[60:63], v[32:35], v[248:255], v5
  v_permlane32_swap_b32 v36, v40
  v_permlane32_swap_b32 v37, v41
  v_permlane32_swap_b32 v38, v42
  v_permlane32_swap_b32 v39, v43
  v_add_f32 v36, v36, v40
  v_add_f32 v37, v37, v41
  v_add_f32 v38, v38, v42
  v_add_f32 v39, v39, v43
  v_cvt_pk_bf16_f32 v40, v36, v37
  v_cvt_pk_bf16_f32 v41, v38, v39
  ds_write_b64 v72, v[40:41]
  v_permlane32_swap_b32 v44, v48
  v_permlane32_swap_b32 v45, v49
  v_permlane32_swap_b32 v46, v50
  v_permlane32_swap_b32 v47, v51
  v_add_f32 v44, v44, v48
  v_add_f32 v45, v45, v49
  v_add_f32 v46, v46, v50
  v_add_f32 v47, v47, v51
  v_cvt_pk_bf16_f32 v48, v44, v45
  v_cvt_pk_bf16_f32 v49, v46, v47
  ds_write_b64 v73, v[48:49]
  v_permlane32_swap_b32 v52, v56
  v_permlane32_swap_b32 v53, v57
  v_permlane32_swap_b32 v54, v58
  v_permlane32_swap_b32 v55, v59
  v_add_f32 v52, v52, v56
  v_add_f32 v53, v53, v57
  v_add_f32 v54, v54, v58
  v_add_f32 v55, v55, v59
  v_cvt_pk_bf16_f32 v56, v52, v53
  v_cvt_pk_bf16_f32 v57, v54, v55
  ds_write_b64 v74, v[56:57]
  v_mov_b32 v64, v60
  v_mov_b32 v65, v61
  v_mov_b32 v66, v62
  v_mov_b32 v67, v63
  v_permlane32_swap_b32 v60, v64
  v_permlane32_swap_b32 v61, v65
  v_permlane32_swap_b32 v62, v66
  v_permlane32_swap_b32 v63, v67
  v_add_f32 v60, v60, v64
  v_add_f32 v61, v61, v65
  v_add_f32 v62, v62, v66
  v_add_f32 v63, v63, v67
  v_cvt_pk_bf16_f32 v64, v60, v61
  v_cvt_pk_bf16_f32 v65, v62, v63
  ds_write_b64 v75, v[64:65]
  s_waitcnt lgkmcnt(0)
  ds_read_b128 v[64:67], v76
  ds_read_b128 v[68:71], v76 offset:1024
  s_waitcnt lgkmcnt(0)
  buffer_store_dwordx4 v[64:67], v2, s[8:11], s25 offen sc1
  buffer_store_dwordx4 v[68:71], v2, s[8:11], s25 offen offset:1024 sc1
  s_waitcnt vmcnt(0)
  s_mov_b64 exec, 1
  buffer_store_dword v78, v2, s[8:11], s26 offen sc1
  s_mov_b64 exec, -1
  s_add_u32 s24, s24, 14336
  s_add_u32 s25, s25, 16384
  s_add_u32 s26, s26, 32
  s_add_u32 s17, s17, 2
  s_cmp_lt_u32 s17, 64
  s_cbranch_scc1 ws_loop
  v_mov_b32 v250, 0
  s_branch wk_loop
wk_s4d:
  s_cmp_lg_u32 s16, 0
  s_cbranch_scc1 w0_37
  s_getreg_b32 s20, hwreg(HW_REG_XCC_ID)
  s_sub_u32 s20, s20, 1
  s_and_b32 s20, s20, 7
  s_mov_b64 exec, 1
s4_l:
  s_cmp_ge_u32 s20, 7
  s_cselect_b32 s20, 0, s20
  s_lshl_b32 s21, s20, 7
  s_add_u32 s21, s21, 88586240
  v_mov_b32 v242, 1
  buffer_atomic_add v242, off, s[8:11], s21 sc0
  s_waitcnt vmcnt(0)
  v_readfirstlane_b32 s21, v242
  s_lshl_b32 s22, s20, 4
  s_add_u32 s20, s20, 1
  s_cmp_ge_u32 s21, 16
  s_cbranch_scc1 s4_l
  v_add_u32 v242, s22, v242
  s_mov_b64 exec, -1
w0_37:
  v_mov_b32 v243, 160000
  s_add_u32 s101, s101, 1
  s_barrier
  s_mov_b64 exec, 1
  s_cmp_lg_u32 s16, 0
  s_cbranch_scc1 w0_38
  ds_write_b32 v243, v242 offset:0
  s_waitcnt lgkmcnt(0)
  v_mov_b32 v242, s101
  ds_write_b32 v243, v242 offset:16
  s_waitcnt lgkmcnt(0)
w0_38:
  s_mov_b64 exec, -1
  s_barrier
  ds_read_b32 v242, v243 offset:0
  ds_read_b32 v243, v243 offset:16
  s_waitcnt lgkmcnt(0)
  v_readfirstlane_b32 s3, v242
  v_cmp_ne_u32 vcc, s101, v243
  s_cbranch_vccnz ch_end
  s_load_dwordx8 s[40:47], s[0:1], 0
  s_load_dwordx4 s[48:51], s[0:1], 32
  s_load_dwordx2 s[52:53], s[0:1], 48
  s_load_dwordx2 s[54:55], s[0:1], 112
  v_lshrrev_b32 v1, 6, v0
  s_nop 0
  v_readfirstlane_b32 s16, v1
  v_and_b32 v1, 63, v0
  v_lshrrev_b32 v3, 4, v1
  v_and_b32 v4, 15, v1
  s_mul_i32 s17, s16, 24576
  s_waitcnt lgkmcnt(0)
  s_mov_b32 s60, s40
  s_and_b32 s61, s41, 0xffff
  s_mov_b32 s62, 1835008
  s_mov_b32 s63, 0x20000
  s_mov_b32 s64, s42
  s_and_b32 s65, s43, 0xffff
  s_mov_b32 s66, 229376
  s_mov_b32 s67, 0x20000
  s_mov_b32 s68, s44
  s_and_b32 s69, s45, 0xffff
  s_mov_b32 s70, 229376
  s_mov_b32 s71, 0x20000
  s_mov_b32 s72, s46
  s_and_b32 s73, s47, 0xffff
  s_mov_b32 s74, 229376
  s_mov_b32 s75, 0x20000
  s_mov_b32 s76, s48
  s_and_b32 s77, s49, 0xffff
  s_mov_b32 s78, 229376
  s_mov_b32 s79, 0x20000
  s_mov_b32 s80, s50
  s_and_b32 s81, s51, 0xffff
  s_mov_b32 s82, 896
  s_mov_b32 s83, 0x20000
  s_mov_b32 s84, s52
  s_and_b32 s85, s53, 0xffff
  s_mov_b32 s86, 896
  s_mov_b32 s87, 0x20000
  s_mov_b32 s92, s54
  s_and_b32 s93, s55, 0xffff
  s_mov_b32 s94, 3670016
  s_mov_b32 s95, 0x20000
  v_lshlrev_b32 v5, 5, v1
  v_sub_u32 v5, 2047, v5
  s_add_u32 s18, s17, 13056
  v_subrev_u32 v6, 0, v5
  v_max_i32 v7, 0, v6
  v_cvt_f32_u32 v7, v7
  v_cvt_pk_bf16_f32 v8, v7, v7
  v_and_b32 v7, 0xffff0000, v8
  v_lshrrev_b32 v8, 23, v7
  v_subrev_u32 v8, 134, v8
  v_max_i32 v8, 0, v8
  v_cvt_u32_f32 v7, v7
  v_lshrrev_b32 v7, v8, v7
  v_lshl_add_u32 v7, v8, 8, v7
  v_lshl_add_u32 v200, v7, 2, s18
  v_subrev_u32 v6, 1, v5
  v_max_i32 v7, 0, v6
  v_cvt_f32_u32 v7, v7
  v_cvt_pk_bf16_f32 v8, v7, v7
  v_and_b32 v7, 0xffff0000, v8
  v_lshrrev_b32 v8, 23, v7
  v_subrev_u32 v8, 134, v8
  v_max_i32 v8, 0, v8
  v_cvt_u32_f32 v7, v7
  v_lshrrev_b32 v7, v8, v7
  v_lshl_add_u32 v7, v8, 8, v7
  v_lshl_add_u32 v201, v7, 2, s18
  v_subrev_u32 v6, 2, v5
  v_max_i32 v7, 0, v6
  v_cvt_f32_u32 v7, v7
  v_cvt_pk_bf16_f32 v8, v7, v7
  v_and_b32 v7, 0xffff0000, v8
  v_lshrrev_b32 v8, 23, v7
  v_subrev_u32 v8, 134, v8
  v_max_i32 v8, 0, v8
  v_cvt_u32_f32 v7, v7
  v_lshrrev_b32 v7, v8, v7
  v_lshl_add_u32 v7, v8, 8, v7
  v_lshl_add_u32 v202, v7, 2, s18
  v_subrev_u32 v6, 3, v5
  v_max_i32 v7, 0, v6
  v_cvt_f32_u32 v7, v7
  v_cvt_pk_bf16_f32 v8, v7, v7
  v_and_b32 v7, 0xffff0000, v8
  v_lshrrev_b32 v8, 23, v7
  v_subrev_u32 v8, 134, v8
  v_max_i32 v8, 0, v8
  v_cvt_u32_f32 v7, v7
  v_lshrrev_b32 v7, v8, v7
  v_lshl_add_u32 v7, v8, 8, v7
  v_lshl_add_u32 v203, v7, 2, s18
  v_subrev_u32 v6, 4, v5
  v_max_i32 v7, 0, v6
  v_cvt_f32_u32 v7, v7
  v_cvt_pk_bf16_f32 v8, v7, v7
  v_and_b32 v7, 0xffff0000, v8
  v_lshrrev_b32 v8, 23, v7
  v_subrev_u32 v8, 134, v8
  v_max_i32 v8, 0, v8
  v_cvt_u32_f32 v7, v7
  v_lshrrev_b32 v7, v8, v7
  v_lshl_add_u32 v7, v8, 8, v7
  v_lshl_add_u32 v204, v7, 2, s18
  v_subrev_u32 v6, 5, v5
  v_max_i32 v7, 0, v6
  v_cvt_f32_u32 v7, v7
  v_cvt_pk_bf16_f32 v8, v7, v7
  v_and_b32 v7, 0xffff0000, v8
  v_lshrrev_b32 v8, 23, v7
  v_subrev_u32 v8, 134, v8
  v_max_i32 v8, 0, v8
  v_cvt_u32_f32 v7, v7
  v_lshrrev_b32 v7, v8, v7
  v_lshl_add_u32 v7, v8, 8, v7
  v_lshl_add_u32 v205, v7, 2, s18
  v_subrev_u32 v6, 6, v5
  v_max_i32 v7, 0, v6
  v_cvt_f32_u32 v7, v7
  v_cvt_pk_bf16_f32 v8, v7, v7
  v_and_b32 v7, 0xffff0000, v8
  v_lshrrev_b32 v8, 23, v7
  v_subrev_u32 v8, 134, v8
  v_max_i32 v8, 0, v8
  v_cvt_u32_f32 v7, v7
  v_lshrrev_b32 v7, v8, v7
  v_lshl_add_u32 v7, v8, 8, v7
  v_lshl_add_u32 v206, v7, 2, s18
  v_subrev_u32 v6, 7, v5
  v_max_i32 v7, 0, v6
  v_cvt_f32_u32 v7, v7
  v_cvt_pk_bf16_f32 v8, v7, v7
  v_and_b32 v7, 0xffff0000, v8
  v_lshrrev_b32 v8, 23, v7
  v_subrev_u32 v8, 134, v8
  v_max_i32 v8, 0, v8
  v_cvt_u32_f32 v7, v7
  v_lshrrev_b32 v7, v8, v7
  v_lshl_add_u32 v7, v8, 8, v7
  v_lshl_add_u32 v207, v7, 2, s18
  v_subrev_u32 v6, 8, v5
  v_max_i32 v7, 0, v6
  v_cvt_f32_u32 v7, v7
  v_cvt_pk_bf16_f32 v8, v7, v7
  v_and_b32 v7, 0xffff0000, v8
  v_lshrrev_b32 v8, 23, v7
  v_subrev_u32 v8, 134, v8
  v_max_i32 v8, 0, v8
  v_cvt_u32_f32 v7, v7
  v_lshrrev_b32 v7, v8, v7
  v_lshl_add_u32 v7, v8, 8, v7
  v_lshl_add_u32 v208, v7, 2, s18
  v_subrev_u32 v6, 9, v5
  v_max_i32 v7, 0, v6
  v_cvt_f32_u32 v7, v7
  v_cvt_pk_bf16_f32 v8, v7, v7
  v_and_b32 v7, 0xffff0000, v8
  v_lshrrev_b32 v8, 23, v7
  v_subrev_u32 v8, 134, v8
  v_max_i32 v8, 0, v8
  v_cvt_u32_f32 v7, v7
  v_lshrrev_b32 v7, v8, v7
  v_lshl_add_u32 v7, v8, 8, v7
  v_lshl_add_u32 v209, v7, 2, s18
  v_subrev_u32 v6, 10, v5
  v_max_i32 v7, 0, v6
  v_cvt_f32_u32 v7, v7
  v_cvt_pk_bf16_f32 v8, v7, v7
  v_and_b32 v7, 0xffff0000, v8
  v_lshrrev_b32 v8, 23, v7
  v_subrev_u32 v8, 134, v8
  v_max_i32 v8, 0, v8
  v_cvt_u32_f32 v7, v7
  v_lshrrev_b32 v7, v8, v7
  v_lshl_add_u32 v7, v8, 8, v7
  v_lshl_add_u32 v210, v7, 2, s18
  v_subrev_u32 v6, 11, v5
  v_max_i32 v7, 0, v6
  v_cvt_f32_u32 v7, v7
  v_cvt_pk_bf16_f32 v8, v7, v7
  v_and_b32 v7, 0xffff0000, v8
  v_lshrrev_b32 v8, 23, v7
  v_subrev_u32 v8, 134, v8
  v_max_i32 v8, 0, v8
  v_cvt_u32_f32 v7, v7
  v_lshrrev_b32 v7, v8, v7
  v_lshl_add_u32 v7, v8, 8, v7
  v_lshl_add_u32 v211, v7, 2, s18
  v_subrev_u32 v6, 12, v5
  v_max_i32 v7, 0, v6
  v_cvt_f32_u32 v7, v7
  v_cvt_pk_bf16_f32 v8, v7, v7
  v_and_b32 v7, 0xffff0000, v8
  v_lshrrev_b32 v8, 23, v7
  v_subrev_u32 v8, 134, v8
  v_max_i32 v8, 0, v8
  v_cvt_u32_f32 v7, v7
  v_lshrrev_b32 v7, v8, v7
  v_lshl_add_u32 v7, v8, 8, v7
  v_lshl_add_u32 v212, v7, 2, s18
  v_subrev_u32 v6, 13, v5
  v_max_i32 v7, 0, v6
  v_cvt_f32_u32 v7, v7
  v_cvt_pk_bf16_f32 v8, v7, v7
  v_and_b32 v7, 0xffff0000, v8
  v_lshrrev_b32 v8, 23, v7
  v_subrev_u32 v8, 134, v8
  v_max_i32 v8, 0, v8
  v_cvt_u32_f32 v7, v7
  v_lshrrev_b32 v7, v8, v7
  v_lshl_add_u32 v7, v8, 8, v7
  v_lshl_add_u32 v213, v7, 2, s18
  v_subrev_u32 v6, 14, v5
  v_max_i32 v7, 0, v6
  v_cvt_f32_u32 v7, v7
  v_cvt_pk_bf16_f32 v8, v7, v7
  v_and_b32 v7, 0xffff0000, v8
  v_lshrrev_b32 v8, 23, v7
  v_subrev_u32 v8, 134, v8
  v_max_i32 v8, 0, v8
  v_cvt_u32_f32 v7, v7
  v_lshrrev_b32 v7, v8, v7
  v_lshl_add_u32 v7, v8, 8, v7
  v_lshl_add_u32 v214, v7, 2, s18
  v_subrev_u32 v6, 15, v5
  v_max_i32 v7, 0, v6
  v_cvt_f32_u32 v7, v7
  v_cvt_pk_bf16_f32 v8, v7, v7
  v_and_b32 v7, 0xffff0000, v8
  v_lshrrev_b32 v8, 23, v7
  v_subrev_u32 v8, 134, v8
  v_max_i32 v8, 0, v8
  v_cvt_u32_f32 v7, v7
  v_lshrrev_b32 v7, v8, v7
  v_lshl_add_u32 v7, v8, 8, v7
  v_lshl_add_u32 v215, v7, 2, s18
  v_subrev_u32 v6, 16, v5
  v_max_i32 v7, 0, v6
  v_cvt_f32_u32 v7, v7
  v_cvt_pk_bf16_f32 v8, v7, v7
  v_and_b32 v7, 0xffff0000, v8
  v_lshrrev_b32 v8, 23, v7
  v_subrev_u32 v8, 134, v8
  v_max_i32 v8, 0, v8
  v_cvt_u32_f32 v7, v7
  v_lshrrev_b32 v7, v8, v7
  v_lshl_add_u32 v7, v8, 8, v7
  v_lshl_add_u32 v216, v7, 2, s18
  v_subrev_u32 v6, 17, v5
  v_max_i32 v7, 0, v6
  v_cvt_f32_u32 v7, v7
  v_cvt_pk_bf16_f32 v8, v7, v7
  v_and_b32 v7, 0xffff0000, v8
  v_lshrrev_b32 v8, 23, v7
  v_subrev_u32 v8, 134, v8
  v_max_i32 v8, 0, v8
  v_cvt_u32_f32 v7, v7
  v_lshrrev_b32 v7, v8, v7
  v_lshl_add_u32 v7, v8, 8, v7
  v_lshl_add_u32 v217, v7, 2, s18
  v_subrev_u32 v6, 18, v5
  v_max_i32 v7, 0, v6
  v_cvt_f32_u32 v7, v7
  v_cvt_pk_bf16_f32 v8, v7, v7
  v_and_b32 v7, 0xffff0000, v8
  v_lshrrev_b32 v8, 23, v7
  v_subrev_u32 v8, 134, v8
  v_max_i32 v8, 0, v8
  v_cvt_u32_f32 v7, v7
  v_lshrrev_b32 v7, v8, v7
  v_lshl_add_u32 v7, v8, 8, v7
  v_lshl_add_u32 v218, v7, 2, s18
  v_subrev_u32 v6, 19, v5
  v_max_i32 v7, 0, v6
  v_cvt_f32_u32 v7, v7
  v_cvt_pk_bf16_f32 v8, v7, v7
  v_and_b32 v7, 0xffff0000, v8
  v_lshrrev_b32 v8, 23, v7
  v_subrev_u32 v8, 134, v8
  v_max_i32 v8, 0, v8
  v_cvt_u32_f32 v7, v7
  v_lshrrev_b32 v7, v8, v7
  v_lshl_add_u32 v7, v8, 8, v7
  v_lshl_add_u32 v219, v7, 2, s18
  v_subrev_u32 v6, 20, v5
  v_max_i32 v7, 0, v6
  v_cvt_f32_u32 v7, v7
  v_cvt_pk_bf16_f32 v8, v7, v7
  v_and_b32 v7, 0xffff0000, v8
  v_lshrrev_b32 v8, 23, v7
  v_subrev_u32 v8, 134, v8
  v_max_i32 v8, 0, v8
  v_cvt_u32_f32 v7, v7
  v_lshrrev_b32 v7, v8, v7
  v_lshl_add_u32 v7, v8, 8, v7
  v_lshl_add_u32 v220, v7, 2, s18
  v_subrev_u32 v6, 21, v5
  v_max_i32 v7, 0, v6
  v_cvt_f32_u32 v7, v7
  v_cvt_pk_bf16_f32 v8, v7, v7
  v_and_b32 v7, 0xffff0000, v8
  v_lshrrev_b32 v8, 23, v7
  v_subrev_u32 v8, 134, v8
  v_max_i32 v8, 0, v8
  v_cvt_u32_f32 v7, v7
  v_lshrrev_b32 v7, v8, v7
  v_lshl_add_u32 v7, v8, 8, v7
  v_lshl_add_u32 v221, v7, 2, s18
  v_subrev_u32 v6, 22, v5
  v_max_i32 v7, 0, v6
  v_cvt_f32_u32 v7, v7
  v_cvt_pk_bf16_f32 v8, v7, v7
  v_and_b32 v7, 0xffff0000, v8
  v_lshrrev_b32 v8, 23, v7
  v_subrev_u32 v8, 134, v8
  v_max_i32 v8, 0, v8
  v_cvt_u32_f32 v7, v7
  v_lshrrev_b32 v7, v8, v7
  v_lshl_add_u32 v7, v8, 8, v7
  v_lshl_add_u32 v222, v7, 2, s18
  v_subrev_u32 v6, 23, v5
  v_max_i32 v7, 0, v6
  v_cvt_f32_u32 v7, v7
  v_cvt_pk_bf16_f32 v8, v7, v7
  v_and_b32 v7, 0xffff0000, v8
  v_lshrrev_b32 v8, 23, v7
  v_subrev_u32 v8, 134, v8
  v_max_i32 v8, 0, v8
  v_cvt_u32_f32 v7, v7
  v_lshrrev_b32 v7, v8, v7
  v_lshl_add_u32 v7, v8, 8, v7
  v_lshl_add_u32 v223, v7, 2, s18
  v_subrev_u32 v6, 24, v5
  v_max_i32 v7, 0, v6
  v_cvt_f32_u32 v7, v7
  v_cvt_pk_bf16_f32 v8, v7, v7
  v_and_b32 v7, 0xffff0000, v8
  v_lshrrev_b32 v8, 23, v7
  v_subrev_u32 v8, 134, v8
  v_max_i32 v8, 0, v8
  v_cvt_u32_f32 v7, v7
  v_lshrrev_b32 v7, v8, v7
  v_lshl_add_u32 v7, v8, 8, v7
  v_lshl_add_u32 v224, v7, 2, s18
  v_subrev_u32 v6, 25, v5
  v_max_i32 v7, 0, v6
  v_cvt_f32_u32 v7, v7
  v_cvt_pk_bf16_f32 v8, v7, v7
  v_and_b32 v7, 0xffff0000, v8
  v_lshrrev_b32 v8, 23, v7
  v_subrev_u32 v8, 134, v8
  v_max_i32 v8, 0, v8
  v_cvt_u32_f32 v7, v7
  v_lshrrev_b32 v7, v8, v7
  v_lshl_add_u32 v7, v8, 8, v7
  v_lshl_add_u32 v225, v7, 2, s18
  v_subrev_u32 v6, 26, v5
  v_max_i32 v7, 0, v6
  v_cvt_f32_u32 v7, v7
  v_cvt_pk_bf16_f32 v8, v7, v7
  v_and_b32 v7, 0xffff0000, v8
  v_lshrrev_b32 v8, 23, v7
  v_subrev_u32 v8, 134, v8
  v_max_i32 v8, 0, v8
  v_cvt_u32_f32 v7, v7
  v_lshrrev_b32 v7, v8, v7
  v_lshl_add_u32 v7, v8, 8, v7
  v_lshl_add_u32 v226, v7, 2, s18
  v_subrev_u32 v6, 27, v5
  v_max_i32 v7, 0, v6
  v_cvt_f32_u32 v7, v7
  v_cvt_pk_bf16_f32 v8, v7, v7
  v_and_b32 v7, 0xffff0000, v8
  v_lshrrev_b32 v8, 23, v7
  v_subrev_u32 v8, 134, v8
  v_max_i32 v8, 0, v8
  v_cvt_u32_f32 v7, v7
  v_lshrrev_b32 v7, v8, v7
  v_lshl_add_u32 v7, v8, 8, v7
  v_lshl_add_u32 v227, v7, 2, s18
  v_subrev_u32 v6, 28, v5
  v_max_i32 v7, 0, v6
  v_cvt_f32_u32 v7, v7
  v_cvt_pk_bf16_f32 v8, v7, v7
  v_and_b32 v7, 0xffff0000, v8
  v_lshrrev_b32 v8, 23, v7
  v_subrev_u32 v8, 134, v8
  v_max_i32 v8, 0, v8
  v_cvt_u32_f32 v7, v7
  v_lshrrev_b32 v7, v8, v7
  v_lshl_add_u32 v7, v8, 8, v7
  v_lshl_add_u32 v228, v7, 2, s18
  v_subrev_u32 v6, 29, v5
  v_max_i32 v7, 0, v6
  v_cvt_f32_u32 v7, v7
  v_cvt_pk_bf16_f32 v8, v7, v7
  v_and_b32 v7, 0xffff0000, v8
  v_lshrrev_b32 v8, 23, v7
  v_subrev_u32 v8, 134, v8
  v_max_i32 v8, 0, v8
  v_cvt_u32_f32 v7, v7
  v_lshrrev_b32 v7, v8, v7
  v_lshl_add_u32 v7, v8, 8, v7
  v_lshl_add_u32 v229, v7, 2, s18
  v_subrev_u32 v6, 30, v5
  v_max_i32 v7, 0, v6
  v_cvt_f32_u32 v7, v7
  v_cvt_pk_bf16_f32 v8, v7, v7
  v_and_b32 v7, 0xffff0000, v8
  v_lshrrev_b32 v8, 23, v7
  v_subrev_u32 v8, 134, v8
  v_max_i32 v8, 0, v8
  v_cvt_u32_f32 v7, v7
  v_lshrrev_b32 v7, v8, v7
  v_lshl_add_u32 v7, v8, 8, v7
  v_lshl_add_u32 v230, v7, 2, s18
  v_subrev_u32 v6, 31, v5
  v_max_i32 v7, 0, v6
  v_cvt_f32_u32 v7, v7
  v_cvt_pk_bf16_f32 v8, v7, v7
  v_and_b32 v7, 0xffff0000, v8
  v_lshrrev_b32 v8, 23, v7
  v_subrev_u32 v8, 134, v8
  v_max_i32 v8, 0, v8
  v_cvt_u32_f32 v7, v7
  v_lshrrev_b32 v7, v8, v7
  v_lshl_add_u32 v7, v8, 8, v7
  v_lshl_add_u32 v231, v7, 2, s18
  v_subrev_u32 v6, 32, v5
  v_max_i32 v7, 0, v6
  v_cvt_f32_u32 v7, v7
  v_cvt_pk_bf16_f32 v8, v7, v7
  v_and_b32 v7, 0xffff0000, v8
  v_lshrrev_b32 v8, 23, v7
  v_subrev_u32 v8, 134, v8
  v_max_i32 v8, 0, v8
  v_cvt_u32_f32 v7, v7
  v_lshrrev_b32 v7, v8, v7
  v_lshl_add_u32 v7, v8, 8, v7
  v_mov_b32 v8, 1280
  v_cmp_gt_i32 vcc, 0, v6
  s_nop 1
  v_cndmask_b32 v7, v7, v8, vcc
  v_lshl_add_u32 v232, v7, 2, s18
  v_mov_b32 v8, 0
  v_mov_b32 v9, 0
  v_lshlrev_b32 v5, 3, v1
  v_add_u32 v5, s17, v5
  ds_write_b64 v5, v[8:9]
  v_and_b32 v6, 15, v1
  v_lshlrev_b32 v6, 3, v6
  v_add_u32 v6, s17, v6
  ds_write_b64 v6, v[8:9] offset:8704
  ds_write_b64 v6, v[8:9] offset:12928
  v_mov_b32 v6, s17
  ds_write_b64 v6, v[8:9] offset:18176
  s_lshl_b32 s19, s3, 2
  s_add_u32 s20, s19, s16
  s_lshl_b32 s21, s3, 3
  v_mul_u32_u24 v5, 3584, v0
  v_mul_u32_u24 v141, 1792, v0
  s_lshl_b32 s22, s20, 9
  v_lshlrev_b32 v6, 3, v1
  buffer_load_dwordx2 v[24:25], v6, s[64:67], s22 offen
  buffer_load_dwordx2 v[26:27], v6, s[68:71], s22 offen
  buffer_load_dwordx2 v[28:29], v6, s[72:75], s22 offen
  buffer_load_dwordx2 v[30:31], v6, s[76:79], s22 offen
  s_lshl_b32 s22, s20, 1
  v_mov_b32 v7, 0
  buffer_load_ushort v32, v7, s[80:83], s22 offen
  buffer_load_ushort v33, v7, s[84:87], s22 offen
  s_mov_b32 s24, 0x05040100
  s_mov_b32 s25, 0x07060302
  s_barrier
  s_waitcnt vmcnt(0)
  s_mov_b32 s26, 1069066811
  s_mov_b32 s27, 1042479491
  v_lshlrev_b32 v32, 16, v32
  v_lshlrev_b32 v33, 16, v33
  v_mul_f32 v32, s26, v32
  v_exp_f32 v32, v32
  s_nop 0
  v_cvt_pk_bf16_f32 v34, v32, v32
  v_and_b32 v32, 0xffff0000, v34
  v_lshlrev_b32 v37, 6, v1
  v_add_u32 v37, s17, v37
  v_lshlrev_b32 v40, 16, v24
  v_lshlrev_b32 v41, 16, v26
  v_lshlrev_b32 v42, 16, v28
  v_lshlrev_b32 v43, 16, v30
  v_mul_f32 v40, s26, v40
  v_exp_f32 v40, v40
  s_nop 0
  v_cvt_pk_bf16_f32 v34, v40, v40
  v_and_b32 v40, 0xffff0000, v34
  v_mul_f32 v40, v40, v32
  v_mul_f32 v40, s26, v40
  v_sub_f32 v40, 0, v40
  v_mul_f32 v41, v41, v32
  v_mul_f32 v41, s27, v41
  v_mul_f32 v42, v42, v32
  v_mul_f32 v43, v43, v32
  v_add_f32 v42, v42, v42
  v_add_f32 v43, v43, v43
  ds_write_b128 v37, v[40:43] offset:18240
  v_and_b32 v40, 0xffff0000, v24
  v_and_b32 v41, 0xffff0000, v26
  v_and_b32 v42, 0xffff0000, v28
  v_and_b32 v43, 0xffff0000, v30
  v_mul_f32 v40, s26, v40
  v_exp_f32 v40, v40
  s_nop 0
  v_cvt_pk_bf16_f32 v34, v40, v40
  v_and_b32 v40, 0xffff0000, v34
  v_mul_f32 v40, v40, v32
  v_mul_f32 v40, s26, v40
  v_sub_f32 v40, 0, v40
  v_mul_f32 v41, v41, v32
  v_mul_f32 v41, s27, v41
  v_mul_f32 v42, v42, v32
  v_mul_f32 v43, v43, v32
  v_add_f32 v42, v42, v42
  v_add_f32 v43, v43, v43
  ds_write_b128 v37, v[40:43] offset:18256
  v_lshlrev_b32 v40, 16, v25
  v_lshlrev_b32 v41, 16, v27
  v_lshlrev_b32 v42, 16, v29
  v_lshlrev_b32 v43, 16, v31
  v_mul_f32 v40, s26, v40
  v_exp_f32 v40, v40
  s_nop 0
  v_cvt_pk_bf16_f32 v34, v40, v40
  v_and_b32 v40, 0xffff0000, v34
  v_mul_f32 v40, v40, v32
  v_mul_f32 v40, s26, v40
  v_sub_f32 v40, 0, v40
  v_mul_f32 v41, v41, v32
  v_mul_f32 v41, s27, v41
  v_mul_f32 v42, v42, v32
  v_mul_f32 v43, v43, v32
  v_add_f32 v42, v42, v42
  v_add_f32 v43, v43, v43
  ds_write_b128 v37, v[40:43] offset:18272
  v_and_b32 v40, 0xffff0000, v25
  v_and_b32 v41, 0xffff0000, v27
  v_and_b32 v42, 0xffff0000, v29
  v_and_b32 v43, 0xffff0000, v31
  v_mul_f32 v40, s26, v40
  v_exp_f32 v40, v40
  s_nop 0
  v_cvt_pk_bf16_f32 v34, v40, v40
  v_and_b32 v40, 0xffff0000, v34
  v_mul_f32 v40, v40, v32
  v_mul_f32 v40, s26, v40
  v_sub_f32 v40, 0, v40
  v_mul_f32 v41, v41, v32
  v_mul_f32 v41, s27, v41
  v_mul_f32 v42, v42, v32
  v_mul_f32 v43, v43, v32
  v_add_f32 v42, v42, v42
  v_add_f32 v43, v43, v43
  ds_write_b128 v37, v[40:43] offset:18288
  v_cvt_f32_u32 v44, v4
  v_lshlrev_b32 v45, 4, v4
  v_cvt_f32_u32 v45, v45
  v_lshlrev_b32 v46, 4, v3
  v_add_u32 v46, s17, v46
  v_mov_b32 v48, 0
  v_mov_b32 v49, 0
  v_mov_b32 v50, 0
  v_mov_b32 v51, 0
  v_mov_b32 v52, 0
  v_mov_b32 v53, 0
  v_mov_b32 v54, 0
  v_mov_b32 v55, 0
  v_mov_b32 v56, 0
  v_mov_b32 v57, 0
  v_mov_b32 v58, 0
  v_mov_b32 v59, 0
  v_mov_b32 v60, 0
  v_mov_b32 v61, 0
  v_mov_b32 v62, 0
  v_mov_b32 v63, 0
  v_mov_b32 v64, 0
  v_mov_b32 v65, 0
  v_mov_b32 v66, 0
  v_mov_b32 v67, 0
  s_waitcnt lgkmcnt(0)
  ds_read_b128 v[68:71], v46 offset:18240
  s_add_u32 s22, s21, 0
  buffer_load_dwordx2 v[8:9], v5, s[60:63], s22 offen offset:0
  s_mov_b32 s28, 0
  s_call_b64 s[30:31], wk_kl
  s_mov_b32 s28, 0
  s_call_b64 s[30:31], wk_kl
  s_add_u32 s22, s21, 0
  buffer_load_dwordx2 v[10:11], v5, s[60:63], s22 offen offset:896
  s_mov_b32 s28, 0
  s_call_b64 s[30:31], wk_kl
  s_mov_b32 s28, 0
  s_call_b64 s[30:31], wk_kl
  s_add_u32 s22, s21, 0
  buffer_load_dwordx2 v[12:13], v5, s[60:63], s22 offen offset:1792
  s_mov_b32 s28, 0
  s_call_b64 s[30:31], wk_kl
  s_mov_b32 s28, 0
  s_call_b64 s[30:31], wk_kl
  s_add_u32 s22, s21, 0
  buffer_load_dwordx2 v[14:15], v5, s[60:63], s22 offen offset:2688
  s_mov_b32 s28, 0
  s_call_b64 s[30:31], wk_kl
  s_mov_b32 s28, 0
  s_call_b64 s[30:31], wk_kl
  s_add_u32 s22, s21, 917504
  buffer_load_dwordx2 v[16:17], v5, s[60:63], s22 offen offset:0
  s_mov_b32 s28, 0
  s_call_b64 s[30:31], wk_kl
  s_mov_b32 s28, 0
  s_call_b64 s[30:31], wk_kl
  s_add_u32 s22, s21, 917504
  buffer_load_dwordx2 v[18:19], v5, s[60:63], s22 offen offset:896
  s_mov_b32 s28, 0
  s_call_b64 s[30:31], wk_kl
  s_mov_b32 s28, 0
  s_call_b64 s[30:31], wk_kl
  s_add_u32 s22, s21, 917504
  buffer_load_dwordx2 v[20:21], v5, s[60:63], s22 offen offset:1792
  s_mov_b32 s28, 0
  s_call_b64 s[30:31], wk_kl
  s_mov_b32 s28, 0
  s_call_b64 s[30:31], wk_kl
  s_add_u32 s22, s21, 917504
  buffer_load_dwordx2 v[22:23], v5, s[60:63], s22 offen offset:2688
  s_mov_b32 s28, 0
  s_call_b64 s[30:31], wk_kl
  s_mov_b32 s28, 0
  s_call_b64 s[30:31], wk_kl
  s_branch wk_kd
wk_kl:
  s_waitcnt lgkmcnt(0)
  v_mov_b32 v72, v68
  v_mov_b32 v73, v69
  v_mov_b32 v74, v70
  v_mov_b32 v75, v71
  v_add_u32 v46, 64, v46
  ds_read_b128 v[68:71], v46 offset:18240
  v_mul_f32 v80, v72, v45
  v_mul_f32 v81, v73, v45
  v_exp_f32 v80, v80
  v_fract_f32 v81, v81
  v_cos_f32 v76, v81
  v_sin_f32 v77, v81
  v_mul_f32 v76, v76, v80
  v_mul_f32 v77, v77, v80
  v_mul_f32 v80, v72, v44
  v_mul_f32 v81, v73, v44
  v_exp_f32 v80, v80
  v_fract_f32 v81, v81
  v_cos_f32 v78, v81
  v_sin_f32 v79, v81
  v_mul_f32 v78, v78, v80
  v_mul_f32 v79, v79, v80
  v_mul_f32 v82, v74, v76
  v_mul_f32 v83, v74, v77
  v_fma_f32 v82, -v75, v77, v82
  v_fma_f32 v83, -v75, v76, -v83
  v_mul_f32 v86, v76, v76
  v_mul_f32 v87, v76, v77
  v_fma_f32 v86, -v77, v77, v86
  v_add_f32 v87, v87, v87
  v_mfma_f32_16x16x4_f32 v[48:51], v82, v78, v[48:51]
  v_mul_f32 v88, v78, v78
  v_mul_f32 v89, v78, v79
  v_fma_f32 v88, -v79, v79, v88
  v_add_f32 v89, v89, v89
  v_mfma_f32_16x16x4_f32 v[48:51], v83, v79, v[48:51]
  v_mul_f32 v84, v74, v86
  v_mul_f32 v85, v74, v87
  v_fma_f32 v84, -v75, v87, v84
  v_fma_f32 v85, -v75, v86, -v85
  v_mul_f32 v76, v86, v86
  v_mul_f32 v77, v86, v87
  v_fma_f32 v76, -v87, v87, v76
  v_add_f32 v77, v77, v77
  v_mfma_f32_16x16x4_f32 v[52:55], v84, v88, v[52:55]
  v_mul_f32 v78, v88, v88
  v_mul_f32 v79, v88, v89
  v_fma_f32 v78, -v89, v89, v78
  v_add_f32 v79, v79, v79
  v_mfma_f32_16x16x4_f32 v[52:55], v85, v89, v[52:55]
  v_mul_f32 v82, v74, v76
  v_mul_f32 v83, v74, v77
  v_fma_f32 v82, -v75, v77, v82
  v_fma_f32 v83, -v75, v76, -v83
  v_mul_f32 v86, v76, v76
  v_mul_f32 v87, v76, v77
  v_fma_f32 v86, -v77, v77, v86
  v_add_f32 v87, v87, v87
  v_mfma_f32_16x16x4_f32 v[56:59], v82, v78, v[56:59]
  v_mul_f32 v88, v78, v78
  v_mul_f32 v89, v78, v79
  v_fma_f32 v88, -v79, v79, v88
  v_add_f32 v89, v89, v89
  v_mfma_f32_16x16x4_f32 v[56:59], v83, v79, v[56:59]
  v_mul_f32 v84, v74, v86
  v_mul_f32 v85, v74, v87
  v_fma_f32 v84, -v75, v87, v84
  v_fma_f32 v85, -v75, v86, -v85
  v_mul_f32 v76, v86, v86
  v_mul_f32 v77, v86, v87
  v_fma_f32 v76, -v87, v87, v76
  v_add_f32 v77, v77, v77
  v_mfma_f32_16x16x4_f32 v[60:63], v84, v88, v[60:63]
  v_mfma_f32_16x16x4_f32 v[60:63], v85, v89, v[60:63]
  v_mul_f32 v82, v74, v76
  v_fma_f32 v82, -v75, v77, v82
  s_nop 1
  v_mfma_f32_16x16x4_f32 v[64:67], v82, v88, v[64:67]
  s_add_u32 s28, s28, 1
  s_cmp_lt_u32 s28, 4
  s_cbranch_scc1 wk_kl
  s_setpc_b64 s[30:31]
wk_kd:
  s_nop 15
  s_nop 3
  s_waitcnt vmcnt(0)
  v_lshlrev_b32 v6, 3, v0
  v_perm_b32 v34, v10, v8, s24
  v_perm_b32 v35, v14, v12, s24
  v_add_u32 v36, 512, v6
  ds_write_b64 v36, v[34:35]
  v_perm_b32 v34, v10, v8, s25
  v_perm_b32 v35, v14, v12, s25
  v_add_u32 v36, 25088, v6
  ds_write_b64 v36, v[34:35]
  v_perm_b32 v34, v11, v9, s24
  v_perm_b32 v35, v15, v13, s24
  v_add_u32 v36, 49664, v6
  ds_write_b64 v36, v[34:35]
  v_perm_b32 v34, v11, v9, s25
  v_perm_b32 v35, v15, v13, s25
  v_add_u32 v36, 74240, v6
  ds_write_b64 v36, v[34:35]
  v_perm_b32 v34, v18, v16, s24
  v_perm_b32 v35, v22, v20, s24
  v_add_u32 v36, 2560, v6
  ds_write_b64 v36, v[34:35]
  v_perm_b32 v34, v18, v16, s25
  v_perm_b32 v35, v22, v20, s25
  v_add_u32 v36, 27136, v6
  ds_write_b64 v36, v[34:35]
  v_perm_b32 v34, v19, v17, s24
  v_perm_b32 v35, v23, v21, s24
  v_add_u32 v36, 51712, v6
  ds_write_b64 v36, v[34:35]
  v_perm_b32 v34, v19, v17, s25
  v_perm_b32 v35, v23, v21, s25
  v_add_u32 v36, 76288, v6
  ds_write_b64 v36, v[34:35]
  v_lshlrev_b32 v46, 8, v3
  v_lshl_add_u32 v46, v4, 2, v46
  v_add_u32 v46, s17, v46
  ds_write_b32 v46, v48 offset:13056
  ds_write_b32 v46, v49 offset:13120
  ds_write_b32 v46, v50 offset:13184
  ds_write_b32 v46, v51 offset:13248
  s_waitcnt lgkmcnt(8)
  ds_write_b32 v46, v52 offset:14080
  ds_write_b32 v46, v53 offset:14144
  ds_write_b32 v46, v54 offset:14208
  ds_write_b32 v46, v55 offset:14272
  s_waitcnt lgkmcnt(8)
  ds_write_b32 v46, v56 offset:15104
  ds_write_b32 v46, v57 offset:15168
  ds_write_b32 v46, v58 offset:15232
  ds_write_b32 v46, v59 offset:15296
  s_waitcnt lgkmcnt(8)
  ds_write_b32 v46, v60 offset:16128
  ds_write_b32 v46, v61 offset:16192
  ds_write_b32 v46, v62 offset:16256
  ds_write_b32 v46, v63 offset:16320
  s_waitcnt lgkmcnt(8)
  ds_write_b32 v46, v64 offset:17152
  ds_write_b32 v46, v65 offset:17216
  ds_write_b32 v46, v66 offset:17280
  ds_write_b32 v46, v67 offset:17344
  s_waitcnt lgkmcnt(8)
  s_waitcnt lgkmcnt(0)
  ds_read_b32 v48, v200
  ds_read_b32 v49, v201
  ds_read_b32 v50, v202
  ds_read_b32 v51, v203
  ds_read_b32 v52, v204
  ds_read_b32 v53, v205
  ds_read_b32 v54, v206
  ds_read_b32 v55, v207
  s_waitcnt lgkmcnt(4)
  ds_read_b32 v56, v208
  ds_read_b32 v57, v209
  ds_read_b32 v58, v210
  ds_read_b32 v59, v211
  ds_read_b32 v60, v212
  ds_read_b32 v61, v213
  ds_read_b32 v62, v214
  ds_read_b32 v63, v215
  s_waitcnt lgkmcnt(4)
  ds_read_b32 v64, v216
  ds_read_b32 v65, v217
  ds_read_b32 v66, v218
  ds_read_b32 v67, v219
  ds_read_b32 v68, v220
  ds_read_b32 v69, v221
  ds_read_b32 v70, v222
  ds_read_b32 v71, v223
  s_waitcnt lgkmcnt(4)
  ds_read_b32 v72, v224
  ds_read_b32 v73, v225
  ds_read_b32 v74, v226
  ds_read_b32 v75, v227
  ds_read_b32 v76, v228
  ds_read_b32 v77, v229
  ds_read_b32 v78, v230
  ds_read_b32 v79, v231
  s_waitcnt lgkmcnt(4)
  ds_read_b32 v80, v232
  s_waitcnt lgkmcnt(0)
  v_lshlrev_b32 v46, 6, v1
  v_add_u32 v46, s17, v46
  v_cvt_pk_bf16_f32 v84, v48, v49
  v_cvt_pk_bf16_f32 v88, v49, v50
  v_cvt_pk_bf16_f32 v85, v50, v51
  v_cvt_pk_bf16_f32 v89, v51, v52
  v_cvt_pk_bf16_f32 v86, v52, v53
  v_cvt_pk_bf16_f32 v90, v53, v54
  v_cvt_pk_bf16_f32 v87, v54, v55
  v_cvt_pk_bf16_f32 v91, v55, v56
  ds_write_b128 v46, v[84:87] offset:4608
  ds_write_b128 v46, v[88:91] offset:8832
  s_waitcnt lgkmcnt(0)
  v_cvt_pk_bf16_f32 v84, v56, v57
  v_cvt_pk_bf16_f32 v88, v57, v58
  v_cvt_pk_bf16_f32 v85, v58, v59
  v_cvt_pk_bf16_f32 v89, v59, v60
  v_cvt_pk_bf16_f32 v86, v60, v61
  v_cvt_pk_bf16_f32 v90, v61, v62
  v_cvt_pk_bf16_f32 v87, v62, v63
  v_cvt_pk_bf16_f32 v91, v63, v64
  ds_write_b128 v46, v[84:87] offset:4624
  ds_write_b128 v46, v[88:91] offset:8848
  s_waitcnt lgkmcnt(0)
  v_cvt_pk_bf16_f32 v84, v64, v65
  v_cvt_pk_bf16_f32 v88, v65, v66
  v_cvt_pk_bf16_f32 v85, v66, v67
  v_cvt_pk_bf16_f32 v89, v67, v68
  v_cvt_pk_bf16_f32 v86, v68, v69
  v_cvt_pk_bf16_f32 v90, v69, v70
  v_cvt_pk_bf16_f32 v87, v70, v71
  v_cvt_pk_bf16_f32 v91, v71, v72
  ds_write_b128 v46, v[84:87] offset:4640
  ds_write_b128 v46, v[88:91] offset:8864
  s_waitcnt lgkmcnt(0)
  v_cvt_pk_bf16_f32 v84, v72, v73
  v_cvt_pk_bf16_f32 v88, v73, v74
  v_cvt_pk_bf16_f32 v85, v74, v75
  v_cvt_pk_bf16_f32 v89, v75, v76
  v_cvt_pk_bf16_f32 v86, v76, v77
  v_cvt_pk_bf16_f32 v90, v77, v78
  v_cvt_pk_bf16_f32 v87, v78, v79
  v_cvt_pk_bf16_f32 v91, v79, v80
  ds_write_b128 v46, v[84:87] offset:4656
  ds_write_b128 v46, v[88:91] offset:8880
  s_waitcnt lgkmcnt(0)
  s_barrier
  v_lshrrev_b32 v47, 1, v3
  v_sub_u32 v46, v4, v47
  v_add_u32 v46, 1, v46
  v_lshlrev_b32 v46, 5, v46
  v_and_b32 v48, 1, v3
  v_lshl_add_u32 v46, v48, 4, v46
  v_add_u32 v46, s17, v46
  ds_read_b128 a[0:3], v46 offset:32
  ds_read_b128 a[4:7], v46 offset:96
  ds_read_b128 a[8:11], v46 offset:160
  ds_read_b128 a[12:15], v46 offset:224
  ds_read_b128 a[16:19], v46 offset:288
  ds_read_b128 a[20:23], v46 offset:352
  ds_read_b128 a[24:27], v46 offset:416
  ds_read_b128 a[28:31], v46 offset:480
  s_waitcnt lgkmcnt(4)
  ds_read_b128 a[32:35], v46 offset:544
  ds_read_b128 a[36:39], v46 offset:608
  ds_read_b128 a[40:43], v46 offset:672
  ds_read_b128 a[44:47], v46 offset:736
  ds_read_b128 a[48:51], v46 offset:800
  ds_read_b128 a[52:55], v46 offset:864
  ds_read_b128 a[56:59], v46 offset:928
  ds_read_b128 a[60:63], v46 offset:992
  s_waitcnt lgkmcnt(4)
  ds_read_b128 a[64:67], v46 offset:1056
  ds_read_b128 a[68:71], v46 offset:1120
  ds_read_b128 a[72:75], v46 offset:1184
  ds_read_b128 a[76:79], v46 offset:1248
  ds_read_b128 a[80:83], v46 offset:1312
  ds_read_b128 a[84:87], v46 offset:1376
  ds_read_b128 a[88:91], v46 offset:1440
  ds_read_b128 a[92:95], v46 offset:1504
  s_waitcnt lgkmcnt(4)
  ds_read_b128 a[96:99], v46 offset:1568
  ds_read_b128 a[100:103], v46 offset:1632
  ds_read_b128 a[104:107], v46 offset:1696
  ds_read_b128 a[108:111], v46 offset:1760
  ds_read_b128 a[112:115], v46 offset:1824
  ds_read_b128 a[116:119], v46 offset:1888
  ds_read_b128 a[120:123], v46 offset:1952
  ds_read_b128 a[124:127], v46 offset:2016
  s_waitcnt lgkmcnt(4)
  ds_read_b128 a[128:131], v46 offset:2080
  ds_read_b128 a[132:135], v46 offset:2144
  ds_read_b128 a[136:139], v46 offset:2208
  ds_read_b128 a[140:143], v46 offset:2272
  ds_read_b128 a[144:147], v46 offset:2336
  ds_read_b128 a[148:151], v46 offset:2400
  ds_read_b128 a[152:155], v46 offset:2464
  ds_read_b128 a[156:159], v46 offset:2528
  s_waitcnt lgkmcnt(4)
  ds_read_b128 a[160:163], v46 offset:2592
  ds_read_b128 a[164:167], v46 offset:2656
  ds_read_b128 a[168:171], v46 offset:2720
  ds_read_b128 a[172:175], v46 offset:2784
  ds_read_b128 a[176:179], v46 offset:2848
  ds_read_b128 a[180:183], v46 offset:2912
  ds_read_b128 a[184:187], v46 offset:2976
  ds_read_b128 a[188:191], v46 offset:3040
  s_waitcnt lgkmcnt(4)
  ds_read_b128 a[192:195], v46 offset:3104
  ds_read_b128 a[196:199], v46 offset:3168
  ds_read_b128 a[200:203], v46 offset:3232
  ds_read_b128 a[204:207], v46 offset:3296
  ds_read_b128 a[208:211], v46 offset:3360
  ds_read_b128 a[212:215], v46 offset:3424
  ds_read_b128 a[216:219], v46 offset:3488
  ds_read_b128 a[220:223], v46 offset:3552
  s_waitcnt lgkmcnt(4)
  ds_read_b128 a[224:227], v46 offset:3616
  ds_read_b128 a[228:231], v46 offset:3680
  ds_read_b128 a[232:235], v46 offset:3744
  ds_read_b128 a[236:239], v46 offset:3808
  ds_read_b128 a[240:243], v46 offset:3872
  ds_read_b128 a[244:247], v46 offset:3936
  ds_read_b128 a[248:251], v46 offset:4000
  ds_read_b128 a[252:255], v46 offset:4064
  s_waitcnt lgkmcnt(4)
  v_lshlrev_b32 v49, 4, v47
  v_add_u32 v49, v49, v4
  v_sub_u32 v49, 2047, v49
  v_lshl_add_u32 v49, v48, 3, v49
  v_and_b32 v50, 1, v49
  v_lshrrev_b32 v49, 1, v49
  v_lshlrev_b32 v49, 2, v49
  v_mul_u32_u24 v50, 4224, v50
  v_add3_u32 v49, v49, v50, s17
  v_add_u32 v49, 4608, v49
  v_subrev_u32 v52, 896, v49
  v_subrev_u32 v53, 1856, v49
  v_subrev_u32 v54, 2816, v49
  v_subrev_u32 v55, 3776, v49
  v_subrev_u32 v56, 4736, v49
  s_waitcnt lgkmcnt(0)
  ds_read2_b32 v[92:93], v52 offset0:224 offset1:225
  ds_read2_b32 v[94:95], v52 offset0:226 offset1:227
  ds_read2_b32 v[96:97], v52 offset0:208 offset1:209
  ds_read2_b32 v[98:99], v52 offset0:210 offset1:211
  ds_read2_b32 v[100:101], v52 offset0:192 offset1:193
  ds_read2_b32 v[102:103], v52 offset0:194 offset1:195
  ds_read2_b32 v[104:105], v52 offset0:176 offset1:177
  ds_read2_b32 v[106:107], v52 offset0:178 offset1:179
  s_waitcnt lgkmcnt(6)
  v_mfma_f32_16x16x32_bf16 v[60:63], v[92:95], a[28:31], 0
  v_mfma_f32_16x16x32_bf16 v[64:67], v[92:95], a[60:63], 0
  v_mfma_f32_16x16x32_bf16 v[68:71], v[92:95], a[92:95], 0
  v_mfma_f32_16x16x32_bf16 v[72:75], v[92:95], a[124:127], 0
  v_mfma_f32_16x16x32_bf16 v[76:79], v[92:95], a[156:159], 0
  v_mfma_f32_16x16x32_bf16 v[80:83], v[92:95], a[188:191], 0
  v_mfma_f32_16x16x32_bf16 v[84:87], v[92:95], a[220:223], 0
  v_mfma_f32_16x16x32_bf16 v[88:91], v[92:95], a[252:255], 0
  ds_read2_b32 v[92:93], v52 offset0:160 offset1:161
  ds_read2_b32 v[94:95], v52 offset0:162 offset1:163
  s_waitcnt lgkmcnt(6)
  v_mfma_f32_16x16x32_bf16 v[60:63], v[96:99], a[24:27], v[60:63]
  v_mfma_f32_16x16x32_bf16 v[64:67], v[96:99], a[56:59], v[64:67]
  v_mfma_f32_16x16x32_bf16 v[68:71], v[96:99], a[88:91], v[68:71]
  v_mfma_f32_16x16x32_bf16 v[72:75], v[96:99], a[120:123], v[72:75]
  v_mfma_f32_16x16x32_bf16 v[76:79], v[96:99], a[152:155], v[76:79]
  v_mfma_f32_16x16x32_bf16 v[80:83], v[96:99], a[184:187], v[80:83]
  v_mfma_f32_16x16x32_bf16 v[84:87], v[96:99], a[216:219], v[84:87]
  v_mfma_f32_16x16x32_bf16 v[88:91], v[96:99], a[248:251], v[88:91]
  ds_read2_b32 v[96:97], v52 offset0:144 offset1:145
  ds_read2_b32 v[98:99], v52 offset0:146 offset1:147
  s_waitcnt lgkmcnt(6)
  v_mfma_f32_16x16x32_bf16 v[60:63], v[100:103], a[20:23], v[60:63]
  v_mfma_f32_16x16x32_bf16 v[64:67], v[100:103], a[52:55], v[64:67]
  v_mfma_f32_16x16x32_bf16 v[68:71], v[100:103], a[84:87], v[68:71]
  v_mfma_f32_16x16x32_bf16 v[72:75], v[100:103], a[116:119], v[72:75]
  v_mfma_f32_16x16x32_bf16 v[76:79], v[100:103], a[148:151], v[76:79]
  v_mfma_f32_16x16x32_bf16 v[80:83], v[100:103], a[180:183], v[80:83]
  v_mfma_f32_16x16x32_bf16 v[84:87], v[100:103], a[212:215], v[84:87]
  v_mfma_f32_16x16x32_bf16 v[88:91], v[100:103], a[244:247], v[88:91]
  ds_read2_b32 v[100:101], v52 offset0:128 offset1:129
  ds_read2_b32 v[102:103], v52 offset0:130 offset1:131
  s_waitcnt lgkmcnt(6)
  v_mfma_f32_16x16x32_bf16 v[60:63], v[104:107], a[16:19], v[60:63]
  v_mfma_f32_16x16x32_bf16 v[64:67], v[104:107], a[48:51], v[64:67]
  v_mfma_f32_16x16x32_bf16 v[68:71], v[104:107], a[80:83], v[68:71]
  v_mfma_f32_16x16x32_bf16 v[72:75], v[104:107], a[112:115], v[72:75]
  v_mfma_f32_16x16x32_bf16 v[76:79], v[104:107], a[144:147], v[76:79]
  v_mfma_f32_16x16x32_bf16 v[80:83], v[104:107], a[176:179], v[80:83]
  v_mfma_f32_16x16x32_bf16 v[84:87], v[104:107], a[208:211], v[84:87]
  v_mfma_f32_16x16x32_bf16 v[88:91], v[104:107], a[240:243], v[88:91]
  ds_read2_b32 v[104:105], v52 offset0:112 offset1:113
  ds_read2_b32 v[106:107], v52 offset0:114 offset1:115
  s_waitcnt lgkmcnt(6)
  v_mfma_f32_16x16x32_bf16 v[60:63], v[92:95], a[12:15], v[60:63]
  v_mfma_f32_16x16x32_bf16 v[64:67], v[92:95], a[44:47], v[64:67]
  v_mfma_f32_16x16x32_bf16 v[68:71], v[92:95], a[76:79], v[68:71]
  v_mfma_f32_16x16x32_bf16 v[72:75], v[92:95], a[108:111], v[72:75]
  v_mfma_f32_16x16x32_bf16 v[76:79], v[92:95], a[140:143], v[76:79]
  v_mfma_f32_16x16x32_bf16 v[80:83], v[92:95], a[172:175], v[80:83]
  v_mfma_f32_16x16x32_bf16 v[84:87], v[92:95], a[204:207], v[84:87]
  v_mfma_f32_16x16x32_bf16 v[88:91], v[92:95], a[236:239], v[88:91]
  ds_read2_b32 v[92:93], v52 offset0:96 offset1:97
  ds_read2_b32 v[94:95], v52 offset0:98 offset1:99
  s_waitcnt lgkmcnt(6)
  v_mfma_f32_16x16x32_bf16 v[60:63], v[96:99], a[8:11], v[60:63]
  v_mfma_f32_16x16x32_bf16 v[64:67], v[96:99], a[40:43], v[64:67]
  v_mfma_f32_16x16x32_bf16 v[68:71], v[96:99], a[72:75], v[68:71]
  v_mfma_f32_16x16x32_bf16 v[72:75], v[96:99], a[104:107], v[72:75]
  v_mfma_f32_16x16x32_bf16 v[76:79], v[96:99], a[136:139], v[76:79]
  v_mfma_f32_16x16x32_bf16 v[80:83], v[96:99], a[168:171], v[80:83]
  v_mfma_f32_16x16x32_bf16 v[84:87], v[96:99], a[200:203], v[84:87]
  v_mfma_f32_16x16x32_bf16 v[88:91], v[96:99], a[232:235], v[88:91]
  ds_read2_b32 v[96:97], v52 offset0:80 offset1:81
  ds_read2_b32 v[98:99], v52 offset0:82 offset1:83
  s_waitcnt lgkmcnt(6)
  v_mfma_f32_16x16x32_bf16 v[60:63], v[100:103], a[4:7], v[60:63]
  v_mfma_f32_16x16x32_bf16 v[64:67], v[100:103], a[36:39], v[64:67]
  v_mfma_f32_16x16x32_bf16 v[68:71], v[100:103], a[68:71], v[68:71]
  v_mfma_f32_16x16x32_bf16 v[72:75], v[100:103], a[100:103], v[72:75]
  v_mfma_f32_16x16x32_bf16 v[76:79], v[100:103], a[132:135], v[76:79]
  v_mfma_f32_16x16x32_bf16 v[80:83], v[100:103], a[164:167], v[80:83]
  v_mfma_f32_16x16x32_bf16 v[84:87], v[100:103], a[196:199], v[84:87]
  v_mfma_f32_16x16x32_bf16 v[88:91], v[100:103], a[228:231], v[88:91]
  ds_read2_b32 v[100:101], v52 offset0:64 offset1:65
  ds_read2_b32 v[102:103], v52 offset0:66 offset1:67
  s_waitcnt lgkmcnt(6)
  v_mfma_f32_16x16x32_bf16 v[60:63], v[104:107], a[0:3], v[60:63]
  v_mfma_f32_16x16x32_bf16 v[64:67], v[104:107], a[32:35], v[64:67]
  v_mfma_f32_16x16x32_bf16 v[68:71], v[104:107], a[64:67], v[68:71]
  v_mfma_f32_16x16x32_bf16 v[72:75], v[104:107], a[96:99], v[72:75]
  v_mfma_f32_16x16x32_bf16 v[76:79], v[104:107], a[128:131], v[76:79]
  v_mfma_f32_16x16x32_bf16 v[80:83], v[104:107], a[160:163], v[80:83]
  v_mfma_f32_16x16x32_bf16 v[84:87], v[104:107], a[192:195], v[84:87]
  v_mfma_f32_16x16x32_bf16 v[88:91], v[104:107], a[224:227], v[88:91]
  ds_read2_b32 v[104:105], v52 offset0:48 offset1:49
  ds_read2_b32 v[106:107], v52 offset0:50 offset1:51
  s_waitcnt lgkmcnt(6)
  v_mfma_f32_16x16x32_bf16 v[64:67], v[92:95], a[28:31], v[64:67]
  v_mfma_f32_16x16x32_bf16 v[68:71], v[92:95], a[60:63], v[68:71]
  v_mfma_f32_16x16x32_bf16 v[72:75], v[92:95], a[92:95], v[72:75]
  v_mfma_f32_16x16x32_bf16 v[76:79], v[92:95], a[124:127], v[76:79]
  v_mfma_f32_16x16x32_bf16 v[80:83], v[92:95], a[156:159], v[80:83]
  v_mfma_f32_16x16x32_bf16 v[84:87], v[92:95], a[188:191], v[84:87]
  v_mfma_f32_16x16x32_bf16 v[88:91], v[92:95], a[220:223], v[88:91]
  ds_read2_b32 v[92:93], v52 offset0:32 offset1:33
  ds_read2_b32 v[94:95], v52 offset0:34 offset1:35
  s_waitcnt lgkmcnt(6)
  v_mfma_f32_16x16x32_bf16 v[64:67], v[96:99], a[24:27], v[64:67]
  v_mfma_f32_16x16x32_bf16 v[68:71], v[96:99], a[56:59], v[68:71]
  v_mfma_f32_16x16x32_bf16 v[72:75], v[96:99], a[88:91], v[72:75]
  v_mfma_f32_16x16x32_bf16 v[76:79], v[96:99], a[120:123], v[76:79]
  v_mfma_f32_16x16x32_bf16 v[80:83], v[96:99], a[152:155], v[80:83]
  v_mfma_f32_16x16x32_bf16 v[84:87], v[96:99], a[184:187], v[84:87]
  v_mfma_f32_16x16x32_bf16 v[88:91], v[96:99], a[216:219], v[88:91]
  ds_read2_b32 v[96:97], v52 offset0:16 offset1:17
  ds_read2_b32 v[98:99], v52 offset0:18 offset1:19
  s_waitcnt lgkmcnt(6)
  v_mfma_f32_16x16x32_bf16 v[64:67], v[100:103], a[20:23], v[64:67]
  v_mfma_f32_16x16x32_bf16 v[68:71], v[100:103], a[52:55], v[68:71]
  v_mfma_f32_16x16x32_bf16 v[72:75], v[100:103], a[84:87], v[72:75]
  v_mfma_f32_16x16x32_bf16 v[76:79], v[100:103], a[116:119], v[76:79]
  v_mfma_f32_16x16x32_bf16 v[80:83], v[100:103], a[148:151], v[80:83]
  v_mfma_f32_16x16x32_bf16 v[84:87], v[100:103], a[180:183], v[84:87]
  v_mfma_f32_16x16x32_bf16 v[88:91], v[100:103], a[212:215], v[88:91]
  ds_read2_b32 v[100:101], v52 offset0:0 offset1:1
  ds_read2_b32 v[102:103], v52 offset0:2 offset1:3
  s_waitcnt lgkmcnt(6)
  v_mfma_f32_16x16x32_bf16 v[64:67], v[104:107], a[16:19], v[64:67]
  v_mfma_f32_16x16x32_bf16 v[68:71], v[104:107], a[48:51], v[68:71]
  v_mfma_f32_16x16x32_bf16 v[72:75], v[104:107], a[80:83], v[72:75]
  v_mfma_f32_16x16x32_bf16 v[76:79], v[104:107], a[112:115], v[76:79]
  v_mfma_f32_16x16x32_bf16 v[80:83], v[104:107], a[144:147], v[80:83]
  v_mfma_f32_16x16x32_bf16 v[84:87], v[104:107], a[176:179], v[84:87]
  v_mfma_f32_16x16x32_bf16 v[88:91], v[104:107], a[208:211], v[88:91]
  ds_read2_b32 v[104:105], v53 offset0:224 offset1:225
  ds_read2_b32 v[106:107], v53 offset0:226 offset1:227
  s_waitcnt lgkmcnt(6)
  v_mfma_f32_16x16x32_bf16 v[64:67], v[92:95], a[12:15], v[64:67]
  v_mfma_f32_16x16x32_bf16 v[68:71], v[92:95], a[44:47], v[68:71]
  v_mfma_f32_16x16x32_bf16 v[72:75], v[92:95], a[76:79], v[72:75]
  v_mfma_f32_16x16x32_bf16 v[76:79], v[92:95], a[108:111], v[76:79]
  v_mfma_f32_16x16x32_bf16 v[80:83], v[92:95], a[140:143], v[80:83]
  v_mfma_f32_16x16x32_bf16 v[84:87], v[92:95], a[172:175], v[84:87]
  v_mfma_f32_16x16x32_bf16 v[88:91], v[92:95], a[204:207], v[88:91]
  ds_read2_b32 v[92:93], v53 offset0:208 offset1:209
  ds_read2_b32 v[94:95], v53 offset0:210 offset1:211
  s_waitcnt lgkmcnt(6)
  v_mfma_f32_16x16x32_bf16 v[64:67], v[96:99], a[8:11], v[64:67]
  v_mfma_f32_16x16x32_bf16 v[68:71], v[96:99], a[40:43], v[68:71]
  v_mfma_f32_16x16x32_bf16 v[72:75], v[96:99], a[72:75], v[72:75]
  v_mfma_f32_16x16x32_bf16 v[76:79], v[96:99], a[104:107], v[76:79]
  v_mfma_f32_16x16x32_bf16 v[80:83], v[96:99], a[136:139], v[80:83]
  v_mfma_f32_16x16x32_bf16 v[84:87], v[96:99], a[168:171], v[84:87]
  v_mfma_f32_16x16x32_bf16 v[88:91], v[96:99], a[200:203], v[88:91]
  ds_read2_b32 v[96:97], v53 offset0:192 offset1:193
  ds_read2_b32 v[98:99], v53 offset0:194 offset1:195
  s_waitcnt lgkmcnt(6)
  v_mfma_f32_16x16x32_bf16 v[64:67], v[100:103], a[4:7], v[64:67]
  v_mfma_f32_16x16x32_bf16 v[68:71], v[100:103], a[36:39], v[68:71]
  v_mfma_f32_16x16x32_bf16 v[72:75], v[100:103], a[68:71], v[72:75]
  v_mfma_f32_16x16x32_bf16 v[76:79], v[100:103], a[100:103], v[76:79]
  v_mfma_f32_16x16x32_bf16 v[80:83], v[100:103], a[132:135], v[80:83]
  v_mfma_f32_16x16x32_bf16 v[84:87], v[100:103], a[164:167], v[84:87]
  v_mfma_f32_16x16x32_bf16 v[88:91], v[100:103], a[196:199], v[88:91]
  ds_read2_b32 v[100:101], v53 offset0:176 offset1:177
  ds_read2_b32 v[102:103], v53 offset0:178 offset1:179
  s_waitcnt lgkmcnt(6)
  v_mfma_f32_16x16x32_bf16 v[64:67], v[104:107], a[0:3], v[64:67]
  v_mfma_f32_16x16x32_bf16 v[68:71], v[104:107], a[32:35], v[68:71]
  v_mfma_f32_16x16x32_bf16 v[72:75], v[104:107], a[64:67], v[72:75]
  v_mfma_f32_16x16x32_bf16 v[76:79], v[104:107], a[96:99], v[76:79]
  v_mfma_f32_16x16x32_bf16 v[80:83], v[104:107], a[128:131], v[80:83]
  v_mfma_f32_16x16x32_bf16 v[84:87], v[104:107], a[160:163], v[84:87]
  v_mfma_f32_16x16x32_bf16 v[88:91], v[104:107], a[192:195], v[88:91]
  ds_read2_b32 v[104:105], v53 offset0:160 offset1:161
  ds_read2_b32 v[106:107], v53 offset0:162 offset1:163
  s_waitcnt lgkmcnt(6)
  v_mfma_f32_16x16x32_bf16 v[68:71], v[92:95], a[28:31], v[68:71]
  v_mfma_f32_16x16x32_bf16 v[72:75], v[92:95], a[60:63], v[72:75]
  v_mfma_f32_16x16x32_bf16 v[76:79], v[92:95], a[92:95], v[76:79]
  v_mfma_f32_16x16x32_bf16 v[80:83], v[92:95], a[124:127], v[80:83]
  v_mfma_f32_16x16x32_bf16 v[84:87], v[92:95], a[156:159], v[84:87]
  v_mfma_f32_16x16x32_bf16 v[88:91], v[92:95], a[188:191], v[88:91]
  ds_read2_b32 v[92:93], v53 offset0:144 offset1:145
  ds_read2_b32 v[94:95], v53 offset0:146 offset1:147
  s_waitcnt lgkmcnt(6)
  v_mfma_f32_16x16x32_bf16 v[68:71], v[96:99], a[24:27], v[68:71]
  v_mfma_f32_16x16x32_bf16 v[72:75], v[96:99], a[56:59], v[72:75]
  v_mfma_f32_16x16x32_bf16 v[76:79], v[96:99], a[88:91], v[76:79]
  v_mfma_f32_16x16x32_bf16 v[80:83], v[96:99], a[120:123], v[80:83]
  v_mfma_f32_16x16x32_bf16 v[84:87], v[96:99], a[152:155], v[84:87]
  v_mfma_f32_16x16x32_bf16 v[88:91], v[96:99], a[184:187], v[88:91]
  ds_read2_b32 v[96:97], v53 offset0:128 offset1:129
  ds_read2_b32 v[98:99], v53 offset0:130 offset1:131
  s_waitcnt lgkmcnt(6)
  v_mfma_f32_16x16x32_bf16 v[68:71], v[100:103], a[20:23], v[68:71]
  v_mfma_f32_16x16x32_bf16 v[72:75], v[100:103], a[52:55], v[72:75]
  v_mfma_f32_16x16x32_bf16 v[76:79], v[100:103], a[84:87], v[76:79]
  v_mfma_f32_16x16x32_bf16 v[80:83], v[100:103], a[116:119], v[80:83]
  v_mfma_f32_16x16x32_bf16 v[84:87], v[100:103], a[148:151], v[84:87]
  v_mfma_f32_16x16x32_bf16 v[88:91], v[100:103], a[180:183], v[88:91]
  ds_read2_b32 v[100:101], v53 offset0:112 offset1:113
  ds_read2_b32 v[102:103], v53 offset0:114 offset1:115
  s_waitcnt lgkmcnt(6)
  v_mfma_f32_16x16x32_bf16 v[68:71], v[104:107], a[16:19], v[68:71]
  v_mfma_f32_16x16x32_bf16 v[72:75], v[104:107], a[48:51], v[72:75]
  v_mfma_f32_16x16x32_bf16 v[76:79], v[104:107], a[80:83], v[76:79]
  v_mfma_f32_16x16x32_bf16 v[80:83], v[104:107], a[112:115], v[80:83]
  v_mfma_f32_16x16x32_bf16 v[84:87], v[104:107], a[144:147], v[84:87]
  v_mfma_f32_16x16x32_bf16 v[88:91], v[104:107], a[176:179], v[88:91]
  ds_read2_b32 v[104:105], v53 offset0:96 offset1:97
  ds_read2_b32 v[106:107], v53 offset0:98 offset1:99
  s_waitcnt lgkmcnt(6)
  v_mfma_f32_16x16x32_bf16 v[68:71], v[92:95], a[12:15], v[68:71]
  v_mfma_f32_16x16x32_bf16 v[72:75], v[92:95], a[44:47], v[72:75]
  v_mfma_f32_16x16x32_bf16 v[76:79], v[92:95], a[76:79], v[76:79]
  v_mfma_f32_16x16x32_bf16 v[80:83], v[92:95], a[108:111], v[80:83]
  v_mfma_f32_16x16x32_bf16 v[84:87], v[92:95], a[140:143], v[84:87]
  v_mfma_f32_16x16x32_bf16 v[88:91], v[92:95], a[172:175], v[88:91]
  ds_read2_b32 v[92:93], v53 offset0:80 offset1:81
  ds_read2_b32 v[94:95], v53 offset0:82 offset1:83
  s_waitcnt lgkmcnt(6)
  v_mfma_f32_16x16x32_bf16 v[68:71], v[96:99], a[8:11], v[68:71]
  v_mfma_f32_16x16x32_bf16 v[72:75], v[96:99], a[40:43], v[72:75]
  v_mfma_f32_16x16x32_bf16 v[76:79], v[96:99], a[72:75], v[76:79]
  v_mfma_f32_16x16x32_bf16 v[80:83], v[96:99], a[104:107], v[80:83]
  v_mfma_f32_16x16x32_bf16 v[84:87], v[96:99], a[136:139], v[84:87]
  v_mfma_f32_16x16x32_bf16 v[88:91], v[96:99], a[168:171], v[88:91]
  ds_read2_b32 v[96:97], v53 offset0:64 offset1:65
  ds_read2_b32 v[98:99], v53 offset0:66 offset1:67
  s_waitcnt lgkmcnt(6)
  v_mfma_f32_16x16x32_bf16 v[68:71], v[100:103], a[4:7], v[68:71]
  v_mfma_f32_16x16x32_bf16 v[72:75], v[100:103], a[36:39], v[72:75]
  v_mfma_f32_16x16x32_bf16 v[76:79], v[100:103], a[68:71], v[76:79]
  v_mfma_f32_16x16x32_bf16 v[80:83], v[100:103], a[100:103], v[80:83]
  v_mfma_f32_16x16x32_bf16 v[84:87], v[100:103], a[132:135], v[84:87]
  v_mfma_f32_16x16x32_bf16 v[88:91], v[100:103], a[164:167], v[88:91]
  ds_read2_b32 v[100:101], v53 offset0:48 offset1:49
  ds_read2_b32 v[102:103], v53 offset0:50 offset1:51
  s_waitcnt lgkmcnt(6)
  v_mfma_f32_16x16x32_bf16 v[68:71], v[104:107], a[0:3], v[68:71]
  v_mfma_f32_16x16x32_bf16 v[72:75], v[104:107], a[32:35], v[72:75]
  v_mfma_f32_16x16x32_bf16 v[76:79], v[104:107], a[64:67], v[76:79]
  v_mfma_f32_16x16x32_bf16 v[80:83], v[104:107], a[96:99], v[80:83]
  v_mfma_f32_16x16x32_bf16 v[84:87], v[104:107], a[128:131], v[84:87]
  v_mfma_f32_16x16x32_bf16 v[88:91], v[104:107], a[160:163], v[88:91]
  ds_read2_b32 v[104:105], v53 offset0:32 offset1:33
  ds_read2_b32 v[106:107], v53 offset0:34 offset1:35
  s_waitcnt lgkmcnt(6)
  v_mfma_f32_16x16x32_bf16 v[72:75], v[92:95], a[28:31], v[72:75]
  v_mfma_f32_16x16x32_bf16 v[76:79], v[92:95], a[60:63], v[76:79]
  v_mfma_f32_16x16x32_bf16 v[80:83], v[92:95], a[92:95], v[80:83]
  v_mfma_f32_16x16x32_bf16 v[84:87], v[92:95], a[124:127], v[84:87]
  v_mfma_f32_16x16x32_bf16 v[88:91], v[92:95], a[156:159], v[88:91]
  ds_read2_b32 v[92:93], v53 offset0:16 offset1:17
  ds_read2_b32 v[94:95], v53 offset0:18 offset1:19
  s_waitcnt lgkmcnt(6)
  v_mfma_f32_16x16x32_bf16 v[72:75], v[96:99], a[24:27], v[72:75]
  v_mfma_f32_16x16x32_bf16 v[76:79], v[96:99], a[56:59], v[76:79]
  v_mfma_f32_16x16x32_bf16 v[80:83], v[96:99], a[88:91], v[80:83]
  v_mfma_f32_16x16x32_bf16 v[84:87], v[96:99], a[120:123], v[84:87]
  v_mfma_f32_16x16x32_bf16 v[88:91], v[96:99], a[152:155], v[88:91]
  ds_read2_b32 v[96:97], v53 offset0:0 offset1:1
  ds_read2_b32 v[98:99], v53 offset0:2 offset1:3
  s_waitcnt lgkmcnt(6)
  v_mfma_f32_16x16x32_bf16 v[72:75], v[100:103], a[20:23], v[72:75]
  v_mfma_f32_16x16x32_bf16 v[76:79], v[100:103], a[52:55], v[76:79]
  v_mfma_f32_16x16x32_bf16 v[80:83], v[100:103], a[84:87], v[80:83]
  v_mfma_f32_16x16x32_bf16 v[84:87], v[100:103], a[116:119], v[84:87]
  v_mfma_f32_16x16x32_bf16 v[88:91], v[100:103], a[148:151], v[88:91]
  ds_read2_b32 v[100:101], v54 offset0:224 offset1:225
  ds_read2_b32 v[102:103], v54 offset0:226 offset1:227
  s_waitcnt lgkmcnt(6)
  v_mfma_f32_16x16x32_bf16 v[72:75], v[104:107], a[16:19], v[72:75]
  v_mfma_f32_16x16x32_bf16 v[76:79], v[104:107], a[48:51], v[76:79]
  v_mfma_f32_16x16x32_bf16 v[80:83], v[104:107], a[80:83], v[80:83]
  v_mfma_f32_16x16x32_bf16 v[84:87], v[104:107], a[112:115], v[84:87]
  v_mfma_f32_16x16x32_bf16 v[88:91], v[104:107], a[144:147], v[88:91]
  ds_read2_b32 v[104:105], v54 offset0:208 offset1:209
  ds_read2_b32 v[106:107], v54 offset0:210 offset1:211
  s_waitcnt lgkmcnt(6)
  v_mfma_f32_16x16x32_bf16 v[72:75], v[92:95], a[12:15], v[72:75]
  v_mfma_f32_16x16x32_bf16 v[76:79], v[92:95], a[44:47], v[76:79]
  v_mfma_f32_16x16x32_bf16 v[80:83], v[92:95], a[76:79], v[80:83]
  v_mfma_f32_16x16x32_bf16 v[84:87], v[92:95], a[108:111], v[84:87]
  v_mfma_f32_16x16x32_bf16 v[88:91], v[92:95], a[140:143], v[88:91]
  ds_read2_b32 v[92:93], v54 offset0:192 offset1:193
  ds_read2_b32 v[94:95], v54 offset0:194 offset1:195
  s_waitcnt lgkmcnt(6)
  v_mfma_f32_16x16x32_bf16 v[72:75], v[96:99], a[8:11], v[72:75]
  v_mfma_f32_16x16x32_bf16 v[76:79], v[96:99], a[40:43], v[76:79]
  v_mfma_f32_16x16x32_bf16 v[80:83], v[96:99], a[72:75], v[80:83]
  v_mfma_f32_16x16x32_bf16 v[84:87], v[96:99], a[104:107], v[84:87]
  v_mfma_f32_16x16x32_bf16 v[88:91], v[96:99], a[136:139], v[88:91]
  ds_read2_b32 v[96:97], v54 offset0:176 offset1:177
  ds_read2_b32 v[98:99], v54 offset0:178 offset1:179
  s_waitcnt lgkmcnt(6)
  v_mfma_f32_16x16x32_bf16 v[72:75], v[100:103], a[4:7], v[72:75]
  v_mfma_f32_16x16x32_bf16 v[76:79], v[100:103], a[36:39], v[76:79]
  v_mfma_f32_16x16x32_bf16 v[80:83], v[100:103], a[68:71], v[80:83]
  v_mfma_f32_16x16x32_bf16 v[84:87], v[100:103], a[100:103], v[84:87]
  v_mfma_f32_16x16x32_bf16 v[88:91], v[100:103], a[132:135], v[88:91]
  ds_read2_b32 v[100:101], v54 offset0:160 offset1:161
  ds_read2_b32 v[102:103], v54 offset0:162 offset1:163
  s_waitcnt lgkmcnt(6)
  v_mfma_f32_16x16x32_bf16 v[72:75], v[104:107], a[0:3], v[72:75]
  v_mfma_f32_16x16x32_bf16 v[76:79], v[104:107], a[32:35], v[76:79]
  v_mfma_f32_16x16x32_bf16 v[80:83], v[104:107], a[64:67], v[80:83]
  v_mfma_f32_16x16x32_bf16 v[84:87], v[104:107], a[96:99], v[84:87]
  v_mfma_f32_16x16x32_bf16 v[88:91], v[104:107], a[128:131], v[88:91]
  ds_read2_b32 v[104:105], v54 offset0:144 offset1:145
  ds_read2_b32 v[106:107], v54 offset0:146 offset1:147
  s_waitcnt lgkmcnt(6)
  v_mfma_f32_16x16x32_bf16 v[76:79], v[92:95], a[28:31], v[76:79]
  v_mfma_f32_16x16x32_bf16 v[80:83], v[92:95], a[60:63], v[80:83]
  v_mfma_f32_16x16x32_bf16 v[84:87], v[92:95], a[92:95], v[84:87]
  v_mfma_f32_16x16x32_bf16 v[88:91], v[92:95], a[124:127], v[88:91]
  ds_read2_b32 v[92:93], v54 offset0:128 offset1:129
  ds_read2_b32 v[94:95], v54 offset0:130 offset1:131
  s_waitcnt lgkmcnt(6)
  v_mfma_f32_16x16x32_bf16 v[76:79], v[96:99], a[24:27], v[76:79]
  v_mfma_f32_16x16x32_bf16 v[80:83], v[96:99], a[56:59], v[80:83]
  v_mfma_f32_16x16x32_bf16 v[84:87], v[96:99], a[88:91], v[84:87]
  v_mfma_f32_16x16x32_bf16 v[88:91], v[96:99], a[120:123], v[88:91]
  ds_read2_b32 v[96:97], v54 offset0:112 offset1:113
  ds_read2_b32 v[98:99], v54 offset0:114 offset1:115
  s_waitcnt lgkmcnt(6)
  v_mfma_f32_16x16x32_bf16 v[76:79], v[100:103], a[20:23], v[76:79]
  v_mfma_f32_16x16x32_bf16 v[80:83], v[100:103], a[52:55], v[80:83]
  v_mfma_f32_16x16x32_bf16 v[84:87], v[100:103], a[84:87], v[84:87]
  v_mfma_f32_16x16x32_bf16 v[88:91], v[100:103], a[116:119], v[88:91]
  ds_read2_b32 v[100:101], v54 offset0:96 offset1:97
  ds_read2_b32 v[102:103], v54 offset0:98 offset1:99
  s_waitcnt lgkmcnt(6)
  v_mfma_f32_16x16x32_bf16 v[76:79], v[104:107], a[16:19], v[76:79]
  v_mfma_f32_16x16x32_bf16 v[80:83], v[104:107], a[48:51], v[80:83]
  v_mfma_f32_16x16x32_bf16 v[84:87], v[104:107], a[80:83], v[84:87]
  v_mfma_f32_16x16x32_bf16 v[88:91], v[104:107], a[112:115], v[88:91]
  ds_read2_b32 v[104:105], v54 offset0:80 offset1:81
  ds_read2_b32 v[106:107], v54 offset0:82 offset1:83
  s_waitcnt lgkmcnt(6)
  v_mfma_f32_16x16x32_bf16 v[76:79], v[92:95], a[12:15], v[76:79]
  v_mfma_f32_16x16x32_bf16 v[80:83], v[92:95], a[44:47], v[80:83]
  v_mfma_f32_16x16x32_bf16 v[84:87], v[92:95], a[76:79], v[84:87]
  v_mfma_f32_16x16x32_bf16 v[88:91], v[92:95], a[108:111], v[88:91]
  ds_read2_b32 v[92:93], v54 offset0:64 offset1:65
  ds_read2_b32 v[94:95], v54 offset0:66 offset1:67
  s_waitcnt lgkmcnt(6)
  v_mfma_f32_16x16x32_bf16 v[76:79], v[96:99], a[8:11], v[76:79]
  v_mfma_f32_16x16x32_bf16 v[80:83], v[96:99], a[40:43], v[80:83]
  v_mfma_f32_16x16x32_bf16 v[84:87], v[96:99], a[72:75], v[84:87]
  v_mfma_f32_16x16x32_bf16 v[88:91], v[96:99], a[104:107], v[88:91]
  ds_read2_b32 v[96:97], v54 offset0:48 offset1:49
  ds_read2_b32 v[98:99], v54 offset0:50 offset1:51
  s_waitcnt lgkmcnt(6)
  v_mfma_f32_16x16x32_bf16 v[76:79], v[100:103], a[4:7], v[76:79]
  v_mfma_f32_16x16x32_bf16 v[80:83], v[100:103], a[36:39], v[80:83]
  v_mfma_f32_16x16x32_bf16 v[84:87], v[100:103], a[68:71], v[84:87]
  v_mfma_f32_16x16x32_bf16 v[88:91], v[100:103], a[100:103], v[88:91]
  ds_read2_b32 v[100:101], v54 offset0:32 offset1:33
  ds_read2_b32 v[102:103], v54 offset0:34 offset1:35
  s_waitcnt lgkmcnt(6)
  v_mfma_f32_16x16x32_bf16 v[76:79], v[104:107], a[0:3], v[76:79]
  v_mfma_f32_16x16x32_bf16 v[80:83], v[104:107], a[32:35], v[80:83]
  v_mfma_f32_16x16x32_bf16 v[84:87], v[104:107], a[64:67], v[84:87]
  v_mfma_f32_16x16x32_bf16 v[88:91], v[104:107], a[96:99], v[88:91]
  ds_read2_b32 v[104:105], v54 offset0:16 offset1:17
  ds_read2_b32 v[106:107], v54 offset0:18 offset1:19
  s_waitcnt lgkmcnt(6)
  v_mfma_f32_16x16x32_bf16 v[80:83], v[92:95], a[28:31], v[80:83]
  v_mfma_f32_16x16x32_bf16 v[84:87], v[92:95], a[60:63], v[84:87]
  v_mfma_f32_16x16x32_bf16 v[88:91], v[92:95], a[92:95], v[88:91]
  ds_read2_b32 v[92:93], v54 offset0:0 offset1:1
  ds_read2_b32 v[94:95], v54 offset0:2 offset1:3
  s_waitcnt lgkmcnt(6)
  v_mfma_f32_16x16x32_bf16 v[80:83], v[96:99], a[24:27], v[80:83]
  v_mfma_f32_16x16x32_bf16 v[84:87], v[96:99], a[56:59], v[84:87]
  v_mfma_f32_16x16x32_bf16 v[88:91], v[96:99], a[88:91], v[88:91]
  ds_read2_b32 v[96:97], v55 offset0:224 offset1:225
  ds_read2_b32 v[98:99], v55 offset0:226 offset1:227
  s_waitcnt lgkmcnt(6)
  v_mfma_f32_16x16x32_bf16 v[80:83], v[100:103], a[20:23], v[80:83]
  v_mfma_f32_16x16x32_bf16 v[84:87], v[100:103], a[52:55], v[84:87]
  v_mfma_f32_16x16x32_bf16 v[88:91], v[100:103], a[84:87], v[88:91]
  ds_read2_b32 v[100:101], v55 offset0:208 offset1:209
  ds_read2_b32 v[102:103], v55 offset0:210 offset1:211
  s_waitcnt lgkmcnt(6)
  v_mfma_f32_16x16x32_bf16 v[80:83], v[104:107], a[16:19], v[80:83]
  v_mfma_f32_16x16x32_bf16 v[84:87], v[104:107], a[48:51], v[84:87]
  v_mfma_f32_16x16x32_bf16 v[88:91], v[104:107], a[80:83], v[88:91]
  ds_read2_b32 v[104:105], v55 offset0:192 offset1:193
  ds_read2_b32 v[106:107], v55 offset0:194 offset1:195
  s_waitcnt lgkmcnt(6)
  v_mfma_f32_16x16x32_bf16 v[80:83], v[92:95], a[12:15], v[80:83]
  v_mfma_f32_16x16x32_bf16 v[84:87], v[92:95], a[44:47], v[84:87]
  v_mfma_f32_16x16x32_bf16 v[88:91], v[92:95], a[76:79], v[88:91]
  ds_read2_b32 v[92:93], v55 offset0:176 offset1:177
  ds_read2_b32 v[94:95], v55 offset0:178 offset1:179
  s_waitcnt lgkmcnt(6)
  v_mfma_f32_16x16x32_bf16 v[80:83], v[96:99], a[8:11], v[80:83]
  v_mfma_f32_16x16x32_bf16 v[84:87], v[96:99], a[40:43], v[84:87]
  v_mfma_f32_16x16x32_bf16 v[88:91], v[96:99], a[72:75], v[88:91]
  ds_read2_b32 v[96:97], v55 offset0:160 offset1:161
  ds_read2_b32 v[98:99], v55 offset0:162 offset1:163
  s_waitcnt lgkmcnt(6)
  v_mfma_f32_16x16x32_bf16 v[80:83], v[100:103], a[4:7], v[80:83]
  v_mfma_f32_16x16x32_bf16 v[84:87], v[100:103], a[36:39], v[84:87]
  v_mfma_f32_16x16x32_bf16 v[88:91], v[100:103], a[68:71], v[88:91]
  ds_read2_b32 v[100:101], v55 offset0:144 offset1:145
  ds_read2_b32 v[102:103], v55 offset0:146 offset1:147
  s_waitcnt lgkmcnt(6)
  v_mfma_f32_16x16x32_bf16 v[80:83], v[104:107], a[0:3], v[80:83]
  v_mfma_f32_16x16x32_bf16 v[84:87], v[104:107], a[32:35], v[84:87]
  v_mfma_f32_16x16x32_bf16 v[88:91], v[104:107], a[64:67], v[88:91]
  ds_read2_b32 v[104:105], v55 offset0:128 offset1:129
  ds_read2_b32 v[106:107], v55 offset0:130 offset1:131
  s_waitcnt lgkmcnt(6)
  v_mfma_f32_16x16x32_bf16 v[84:87], v[92:95], a[28:31], v[84:87]
  v_mfma_f32_16x16x32_bf16 v[88:91], v[92:95], a[60:63], v[88:91]
  ds_read2_b32 v[92:93], v55 offset0:112 offset1:113
  ds_read2_b32 v[94:95], v55 offset0:114 offset1:115
  s_waitcnt lgkmcnt(6)
  v_mfma_f32_16x16x32_bf16 v[84:87], v[96:99], a[24:27], v[84:87]
  v_mfma_f32_16x16x32_bf16 v[88:91], v[96:99], a[56:59], v[88:91]
  ds_read2_b32 v[96:97], v55 offset0:96 offset1:97
  ds_read2_b32 v[98:99], v55 offset0:98 offset1:99
  s_waitcnt lgkmcnt(6)
  v_mfma_f32_16x16x32_bf16 v[84:87], v[100:103], a[20:23], v[84:87]
  v_mfma_f32_16x16x32_bf16 v[88:91], v[100:103], a[52:55], v[88:91]
  ds_read2_b32 v[100:101], v55 offset0:80 offset1:81
  ds_read2_b32 v[102:103], v55 offset0:82 offset1:83
  s_waitcnt lgkmcnt(6)
  v_mfma_f32_16x16x32_bf16 v[84:87], v[104:107], a[16:19], v[84:87]
  v_mfma_f32_16x16x32_bf16 v[88:91], v[104:107], a[48:51], v[88:91]
  ds_read2_b32 v[104:105], v55 offset0:64 offset1:65
  ds_read2_b32 v[106:107], v55 offset0:66 offset1:67
  s_waitcnt lgkmcnt(6)
  v_mfma_f32_16x16x32_bf16 v[84:87], v[92:95], a[12:15], v[84:87]
  v_mfma_f32_16x16x32_bf16 v[88:91], v[92:95], a[44:47], v[88:91]
  ds_read2_b32 v[92:93], v55 offset0:48 offset1:49
  ds_read2_b32 v[94:95], v55 offset0:50 offset1:51
  s_waitcnt lgkmcnt(6)
  v_mfma_f32_16x16x32_bf16 v[84:87], v[96:99], a[8:11], v[84:87]
  v_mfma_f32_16x16x32_bf16 v[88:91], v[96:99], a[40:43], v[88:91]
  ds_read2_b32 v[96:97], v55 offset0:32 offset1:33
  ds_read2_b32 v[98:99], v55 offset0:34 offset1:35
  s_waitcnt lgkmcnt(6)
  v_mfma_f32_16x16x32_bf16 v[84:87], v[100:103], a[4:7], v[84:87]
  v_mfma_f32_16x16x32_bf16 v[88:91], v[100:103], a[36:39], v[88:91]
  ds_read2_b32 v[100:101], v55 offset0:16 offset1:17
  ds_read2_b32 v[102:103], v55 offset0:18 offset1:19
  s_waitcnt lgkmcnt(6)
  v_mfma_f32_16x16x32_bf16 v[84:87], v[104:107], a[0:3], v[84:87]
  v_mfma_f32_16x16x32_bf16 v[88:91], v[104:107], a[32:35], v[88:91]
  ds_read2_b32 v[104:105], v55 offset0:0 offset1:1
  ds_read2_b32 v[106:107], v55 offset0:2 offset1:3
  s_waitcnt lgkmcnt(6)
  v_mfma_f32_16x16x32_bf16 v[88:91], v[92:95], a[28:31], v[88:91]
  ds_read2_b32 v[92:93], v56 offset0:224 offset1:225
  ds_read2_b32 v[94:95], v56 offset0:226 offset1:227
  s_waitcnt lgkmcnt(6)
  v_mfma_f32_16x16x32_bf16 v[88:91], v[96:99], a[24:27], v[88:91]
  ds_read2_b32 v[96:97], v56 offset0:208 offset1:209
  ds_read2_b32 v[98:99], v56 offset0:210 offset1:211
  s_waitcnt lgkmcnt(6)
  v_mfma_f32_16x16x32_bf16 v[88:91], v[100:103], a[20:23], v[88:91]
  ds_read2_b32 v[100:101], v56 offset0:192 offset1:193
  ds_read2_b32 v[102:103], v56 offset0:194 offset1:195
  s_waitcnt lgkmcnt(6)
  v_mfma_f32_16x16x32_bf16 v[88:91], v[104:107], a[16:19], v[88:91]
  ds_read2_b32 v[104:105], v56 offset0:176 offset1:177
  ds_read2_b32 v[106:107], v56 offset0:178 offset1:179
  s_waitcnt lgkmcnt(6)
  v_mfma_f32_16x16x32_bf16 v[88:91], v[92:95], a[12:15], v[88:91]
  s_waitcnt lgkmcnt(4)
  v_mfma_f32_16x16x32_bf16 v[88:91], v[96:99], a[8:11], v[88:91]
  s_waitcnt lgkmcnt(2)
  v_mfma_f32_16x16x32_bf16 v[88:91], v[100:103], a[4:7], v[88:91]
  s_waitcnt lgkmcnt(0)
  v_mfma_f32_16x16x32_bf16 v[88:91], v[104:107], a[0:3], v[88:91]
  v_lshlrev_b32 v46, 5, v4
  v_lshl_add_u32 v46, v3, 3, v46
  v_add_u32 v46, s17, v46
  ds_read_b64 v[108:109], v46 offset:512
  ds_read_b64 v[110:111], v46 offset:1024
  ds_read_b64 v[112:113], v46 offset:1536
  ds_read_b64 v[114:115], v46 offset:2048
  ds_read_b64 v[116:117], v46 offset:2560
  ds_read_b64 v[118:119], v46 offset:3072
  ds_read_b64 v[120:121], v46 offset:3584
  ds_read_b64 v[122:123], v46 offset:4096
  s_waitcnt lgkmcnt(0)
  v_lshlrev_b32 v124, 16, v108
  v_and_b32 v125, 0xffff0000, v108
  v_lshlrev_b32 v126, 16, v109
  v_and_b32 v127, 0xffff0000, v109
  v_mul_f32 v124, v124, v33
  v_mul_f32 v125, v125, v33
  v_mul_f32 v126, v126, v33
  v_mul_f32 v127, v127, v33
  v_cvt_pk_bf16_f32 v128, v124, v125
  v_cvt_pk_bf16_f32 v129, v126, v127
  v_cvt_pk_bf16_f32 v130, v60, v61
  v_cvt_pk_bf16_f32 v131, v62, v63
  v_lshlrev_b32 v124, 16, v128
  v_and_b32 v125, 0xffff0000, v128
  v_lshlrev_b32 v132, 16, v130
  v_and_b32 v133, 0xffff0000, v130
  v_lshlrev_b32 v126, 16, v129
  v_and_b32 v127, 0xffff0000, v129
  v_lshlrev_b32 v134, 16, v131
  v_and_b32 v135, 0xffff0000, v131
  v_add_f32 v124, v124, v132
  v_add_f32 v125, v125, v133
  v_add_f32 v126, v126, v134
  v_add_f32 v127, v127, v135
  v_cvt_pk_bf16_f32 v108, v124, v125
  v_cvt_pk_bf16_f32 v109, v126, v127
  ds_write_b64 v46, v[108:109] offset:512
  v_lshlrev_b32 v124, 16, v110
  v_and_b32 v125, 0xffff0000, v110
  v_lshlrev_b32 v126, 16, v111
  v_and_b32 v127, 0xffff0000, v111
  v_mul_f32 v124, v124, v33
  v_mul_f32 v125, v125, v33
  v_mul_f32 v126, v126, v33
  v_mul_f32 v127, v127, v33
  v_cvt_pk_bf16_f32 v128, v124, v125
  v_cvt_pk_bf16_f32 v129, v126, v127
  v_cvt_pk_bf16_f32 v130, v64, v65
  v_cvt_pk_bf16_f32 v131, v66, v67
  v_lshlrev_b32 v124, 16, v128
  v_and_b32 v125, 0xffff0000, v128
  v_lshlrev_b32 v132, 16, v130
  v_and_b32 v133, 0xffff0000, v130
  v_lshlrev_b32 v126, 16, v129
  v_and_b32 v127, 0xffff0000, v129
  v_lshlrev_b32 v134, 16, v131
  v_and_b32 v135, 0xffff0000, v131
  v_add_f32 v124, v124, v132
  v_add_f32 v125, v125, v133
  v_add_f32 v126, v126, v134
  v_add_f32 v127, v127, v135
  v_cvt_pk_bf16_f32 v110, v124, v125
  v_cvt_pk_bf16_f32 v111, v126, v127
  ds_write_b64 v46, v[110:111] offset:1024
  v_lshlrev_b32 v124, 16, v112
  v_and_b32 v125, 0xffff0000, v112
  v_lshlrev_b32 v126, 16, v113
  v_and_b32 v127, 0xffff0000, v113
  v_mul_f32 v124, v124, v33
  v_mul_f32 v125, v125, v33
  v_mul_f32 v126, v126, v33
  v_mul_f32 v127, v127, v33
  v_cvt_pk_bf16_f32 v128, v124, v125
  v_cvt_pk_bf16_f32 v129, v126, v127
  v_cvt_pk_bf16_f32 v130, v68, v69
  v_cvt_pk_bf16_f32 v131, v70, v71
  v_lshlrev_b32 v124, 16, v128
  v_and_b32 v125, 0xffff0000, v128
  v_lshlrev_b32 v132, 16, v130
  v_and_b32 v133, 0xffff0000, v130
  v_lshlrev_b32 v126, 16, v129
  v_and_b32 v127, 0xffff0000, v129
  v_lshlrev_b32 v134, 16, v131
  v_and_b32 v135, 0xffff0000, v131
  v_add_f32 v124, v124, v132
  v_add_f32 v125, v125, v133
  v_add_f32 v126, v126, v134
  v_add_f32 v127, v127, v135
  v_cvt_pk_bf16_f32 v112, v124, v125
  v_cvt_pk_bf16_f32 v113, v126, v127
  ds_write_b64 v46, v[112:113] offset:1536
  v_lshlrev_b32 v124, 16, v114
  v_and_b32 v125, 0xffff0000, v114
  v_lshlrev_b32 v126, 16, v115
  v_and_b32 v127, 0xffff0000, v115
  v_mul_f32 v124, v124, v33
  v_mul_f32 v125, v125, v33
  v_mul_f32 v126, v126, v33
  v_mul_f32 v127, v127, v33
  v_cvt_pk_bf16_f32 v128, v124, v125
  v_cvt_pk_bf16_f32 v129, v126, v127
  v_cvt_pk_bf16_f32 v130, v72, v73
  v_cvt_pk_bf16_f32 v131, v74, v75
  v_lshlrev_b32 v124, 16, v128
  v_and_b32 v125, 0xffff0000, v128
  v_lshlrev_b32 v132, 16, v130
  v_and_b32 v133, 0xffff0000, v130
  v_lshlrev_b32 v126, 16, v129
  v_and_b32 v127, 0xffff0000, v129
  v_lshlrev_b32 v134, 16, v131
  v_and_b32 v135, 0xffff0000, v131
  v_add_f32 v124, v124, v132
  v_add_f32 v125, v125, v133
  v_add_f32 v126, v126, v134
  v_add_f32 v127, v127, v135
  v_cvt_pk_bf16_f32 v114, v124, v125
  v_cvt_pk_bf16_f32 v115, v126, v127
  ds_write_b64 v46, v[114:115] offset:2048
  v_lshlrev_b32 v124, 16, v116
  v_and_b32 v125, 0xffff0000, v116
  v_lshlrev_b32 v126, 16, v117
  v_and_b32 v127, 0xffff0000, v117
  v_mul_f32 v124, v124, v33
  v_mul_f32 v125, v125, v33
  v_mul_f32 v126, v126, v33
  v_mul_f32 v127, v127, v33
  v_cvt_pk_bf16_f32 v128, v124, v125
  v_cvt_pk_bf16_f32 v129, v126, v127
  v_cvt_pk_bf16_f32 v130, v76, v77
  v_cvt_pk_bf16_f32 v131, v78, v79
  v_lshlrev_b32 v124, 16, v128
  v_and_b32 v125, 0xffff0000, v128
  v_lshlrev_b32 v132, 16, v130
  v_and_b32 v133, 0xffff0000, v130
  v_lshlrev_b32 v126, 16, v129
  v_and_b32 v127, 0xffff0000, v129
  v_lshlrev_b32 v134, 16, v131
  v_and_b32 v135, 0xffff0000, v131
  v_add_f32 v124, v124, v132
  v_add_f32 v125, v125, v133
  v_add_f32 v126, v126, v134
  v_add_f32 v127, v127, v135
  v_cvt_pk_bf16_f32 v116, v124, v125
  v_cvt_pk_bf16_f32 v117, v126, v127
  ds_write_b64 v46, v[116:117] offset:2560
  v_lshlrev_b32 v124, 16, v118
  v_and_b32 v125, 0xffff0000, v118
  v_lshlrev_b32 v126, 16, v119
  v_and_b32 v127, 0xffff0000, v119
  v_mul_f32 v124, v124, v33
  v_mul_f32 v125, v125, v33
  v_mul_f32 v126, v126, v33
  v_mul_f32 v127, v127, v33
  v_cvt_pk_bf16_f32 v128, v124, v125
  v_cvt_pk_bf16_f32 v129, v126, v127
  v_cvt_pk_bf16_f32 v130, v80, v81
  v_cvt_pk_bf16_f32 v131, v82, v83
  v_lshlrev_b32 v124, 16, v128
  v_and_b32 v125, 0xffff0000, v128
  v_lshlrev_b32 v132, 16, v130
  v_and_b32 v133, 0xffff0000, v130
  v_lshlrev_b32 v126, 16, v129
  v_and_b32 v127, 0xffff0000, v129
  v_lshlrev_b32 v134, 16, v131
  v_and_b32 v135, 0xffff0000, v131
  v_add_f32 v124, v124, v132
  v_add_f32 v125, v125, v133
  v_add_f32 v126, v126, v134
  v_add_f32 v127, v127, v135
  v_cvt_pk_bf16_f32 v118, v124, v125
  v_cvt_pk_bf16_f32 v119, v126, v127
  ds_write_b64 v46, v[118:119] offset:3072
  v_lshlrev_b32 v124, 16, v120
  v_and_b32 v125, 0xffff0000, v120
  v_lshlrev_b32 v126, 16, v121
  v_and_b32 v127, 0xffff0000, v121
  v_mul_f32 v124, v124, v33
  v_mul_f32 v125, v125, v33
  v_mul_f32 v126, v126, v33
  v_mul_f32 v127, v127, v33
  v_cvt_pk_bf16_f32 v128, v124, v125
  v_cvt_pk_bf16_f32 v129, v126, v127
  v_cvt_pk_bf16_f32 v130, v84, v85
  v_cvt_pk_bf16_f32 v131, v86, v87
  v_lshlrev_b32 v124, 16, v128
  v_and_b32 v125, 0xffff0000, v128
  v_lshlrev_b32 v132, 16, v130
  v_and_b32 v133, 0xffff0000, v130
  v_lshlrev_b32 v126, 16, v129
  v_and_b32 v127, 0xffff0000, v129
  v_lshlrev_b32 v134, 16, v131
  v_and_b32 v135, 0xffff0000, v131
  v_add_f32 v124, v124, v132
  v_add_f32 v125, v125, v133
  v_add_f32 v126, v126, v134
  v_add_f32 v127, v127, v135
  v_cvt_pk_bf16_f32 v120, v124, v125
  v_cvt_pk_bf16_f32 v121, v126, v127
  ds_write_b64 v46, v[120:121] offset:3584
  v_lshlrev_b32 v124, 16, v122
  v_and_b32 v125, 0xffff0000, v122
  v_lshlrev_b32 v126, 16, v123
  v_and_b32 v127, 0xffff0000, v123
  v_mul_f32 v124, v124, v33
  v_mul_f32 v125, v125, v33
  v_mul_f32 v126, v126, v33
  v_mul_f32 v127, v127, v33
  v_cvt_pk_bf16_f32 v128, v124, v125
  v_cvt_pk_bf16_f32 v129, v126, v127
  v_cvt_pk_bf16_f32 v130, v88, v89
  v_cvt_pk_bf16_f32 v131, v90, v91
  v_lshlrev_b32 v124, 16, v128
  v_and_b32 v125, 0xffff0000, v128
  v_lshlrev_b32 v132, 16, v130
  v_and_b32 v133, 0xffff0000, v130
  v_lshlrev_b32 v126, 16, v129
  v_and_b32 v127, 0xffff0000, v129
  v_lshlrev_b32 v134, 16, v131
  v_and_b32 v135, 0xffff0000, v131
  v_add_f32 v124, v124, v132
  v_add_f32 v125, v125, v133
  v_add_f32 v126, v126, v134
  v_add_f32 v127, v127, v135
  v_cvt_pk_bf16_f32 v122, v124, v125
  v_cvt_pk_bf16_f32 v123, v126, v127
  ds_write_b64 v46, v[122:123] offset:4096
  s_waitcnt lgkmcnt(0)
  s_barrier
  v_lshlrev_b32 v6, 3, v0
  v_mul_u32_u24 v5, 7168, v0
  v_add_u32 v36, 512, v6
  ds_read_b64 v[8:9], v36
  v_add_u32 v36, 25088, v6
  ds_read_b64 v[10:11], v36
  v_add_u32 v36, 49664, v6
  ds_read_b64 v[12:13], v36
  v_add_u32 v36, 74240, v6
  ds_read_b64 v[14:15], v36
  s_waitcnt lgkmcnt(0)
  s_add_u32 s22, s21, 0
  s_add_u32 s23, s22, 3584
  v_perm_b32 v16, v10, v8, s24
  v_perm_b32 v17, v14, v12, s24
  buffer_store_dwordx2 v[16:17], v5, s[92:95], s22 offen offset:0
  v_perm_b32 v18, v10, v8, s25
  v_perm_b32 v19, v14, v12, s25
  buffer_store_dwordx2 v[18:19], v5, s[92:95], s22 offen offset:1792
  v_perm_b32 v20, v11, v9, s24
  v_perm_b32 v21, v15, v13, s24
  buffer_store_dwordx2 v[20:21], v5, s[92:95], s23 offen offset:0
  v_perm_b32 v22, v11, v9, s25
  v_perm_b32 v23, v15, v13, s25
  buffer_store_dwordx2 v[22:23], v5, s[92:95], s23 offen offset:1792
  v_add_u32 v36, 2560, v6
  ds_read_b64 v[8:9], v36
  v_add_u32 v36, 27136, v6
  ds_read_b64 v[10:11], v36
  v_add_u32 v36, 51712, v6
  ds_read_b64 v[12:13], v36
  v_add_u32 v36, 76288, v6
  ds_read_b64 v[14:15], v36
  s_waitcnt lgkmcnt(0)
  s_add_u32 s22, s21, 1835008
  s_add_u32 s23, s22, 3584
  v_perm_b32 v24, v10, v8, s24
  v_perm_b32 v25, v14, v12, s24
  buffer_store_dwordx2 v[24:25], v5, s[92:95], s22 offen offset:0
  v_perm_b32 v26, v10, v8, s25
  v_perm_b32 v27, v14, v12, s25
  buffer_store_dwordx2 v[26:27], v5, s[92:95], s22 offen offset:1792
  v_perm_b32 v28, v11, v9, s24
  v_perm_b32 v29, v15, v13, s24
  buffer_store_dwordx2 v[28:29], v5, s[92:95], s23 offen offset:0
  v_perm_b32 v30, v11, v9, s25
  v_perm_b32 v31, v15, v13, s25
  buffer_store_dwordx2 v[30:31], v5, s[92:95], s23 offen offset:1792
  s_branch wk_loop
wk_tok:
  s_sub_u32 s3, s3, 864
  s_and_b32 s18, s3, 3
  s_lshr_b32 s17, s3, 2
  s_cmp_lt_u32 s17, 8
  s_cbranch_scc1 wk_tokp
  s_sub_u32 s17, s17, 64
  s_cmp_ge_i32 s17, 56
  s_cbranch_scc1 wk_toko
  s_add_u32 s20, s17, 56
  s_lshr_b32 s17, s20, 1
  s_bitcmp0_b32 s20, 0
  s_cbranch_scc1 wk_toko
  s_add_u32 s17, s17, 8
wk_tokp:
  s_lshl_b32 s20, s18, 2
  s_add_u32 s20, s20, s16
  s_lshl_b32 s21, s17, 4
  s_add_u32 s21, s21, s20
  s_mul_i32 s21, s21, 28672
  s_add_u32 s21, s21, 12845056
  s_mul_i32 s23, s17, 28672
  s_add_u32 s23, s23, 73400320
  s_mul_i32 s24, s17, 7168
  s_add_u32 s24, s24, 88068096
  s_lshr_b32 s25, s17, 3
  s_lshl_b32 s25, s25, 4
  s_add_u32 s25, s25, s20
  s_lshl_b32 s25, s25, 7
  s_add_u32 s25, s25, 88545280
  v_mov_b32 v60, 0
  s_mov_b32 s30, 0
wp_wf:
  buffer_load_dword v61, v60, s[8:11], s25 offen sc1
  s_waitcnt vmcnt(0)
  v_cmp_ne_u32 vcc, 56, v61
  s_cbranch_vccz wp_wf_ok
  s_sleep 4
  s_cmp_ge_u32 s17, 56
  s_cbranch_scc1 wp_wf_bo
  s_sleep 127
wp_wf_bo:
  s_add_u32 s30, s30, 1
  s_cmp_lt_u32 s30, 30000
  s_cbranch_scc1 wp_wf
  s_branch wp_abort
wp_wf_ok:
  s_add_u32 s22, s21, 0
  buffer_load_dwordx4 a[0:3], v2, s[8:11], s22 offen offset:0 sc1
  buffer_load_dwordx4 a[4:7], v2, s[8:11], s22 offen offset:1024 sc1
  buffer_load_dwordx4 a[8:11], v2, s[8:11], s22 offen offset:2048 sc1
  buffer_load_dwordx4 a[12:15], v2, s[8:11], s22 offen offset:3072 sc1
  s_add_u32 s22, s21, 4096
  buffer_load_dwordx4 a[16:19], v2, s[8:11], s22 offen offset:0 sc1
  buffer_load_dwordx4 a[20:23], v2, s[8:11], s22 offen offset:1024 sc1
  buffer_load_dwordx4 a[24:27], v2, s[8:11], s22 offen offset:2048 sc1
  buffer_load_dwordx4 a[28:31], v2, s[8:11], s22 offen offset:3072 sc1
  s_add_u32 s22, s21, 8192
  buffer_load_dwordx4 a[32:35], v2, s[8:11], s22 offen offset:0 sc1
  buffer_load_dwordx4 a[36:39], v2, s[8:11], s22 offen offset:1024 sc1
  buffer_load_dwordx4 a[40:43], v2, s[8:11], s22 offen offset:2048 sc1
  buffer_load_dwordx4 a[44:47], v2, s[8:11], s22 offen offset:3072 sc1
  s_add_u32 s22, s21, 12288
  buffer_load_dwordx4 a[48:51], v2, s[8:11], s22 offen offset:0 sc1
  buffer_load_dwordx4 a[52:55], v2, s[8:11], s22 offen offset:1024 sc1
  buffer_load_dwordx4 a[56:59], v2, s[8:11], s22 offen offset:2048 sc1
  buffer_load_dwordx4 a[60:63], v2, s[8:11], s22 offen offset:3072 sc1
  s_add_u32 s22, s21, 16384
  buffer_load_dwordx4 a[64:67], v2, s[8:11], s22 offen offset:0 sc1
  buffer_load_dwordx4 a[68:71], v2, s[8:11], s22 offen offset:1024 sc1
  buffer_load_dwordx4 a[72:75], v2, s[8:11], s22 offen offset:2048 sc1
  buffer_load_dwordx4 a[76:79], v2, s[8:11], s22 offen offset:3072 sc1
  s_add_u32 s22, s21, 20480
  buffer_load_dwordx4 a[80:83], v2, s[8:11], s22 offen offset:0 sc1
  buffer_load_dwordx4 a[84:87], v2, s[8:11], s22 offen offset:1024 sc1
  buffer_load_dwordx4 a[88:91], v2, s[8:11], s22 offen offset:2048 sc1
  buffer_load_dwordx4 a[92:95], v2, s[8:11], s22 offen offset:3072 sc1
  s_add_u32 s22, s21, 24576
  buffer_load_dwordx4 a[96:99], v2, s[8:11], s22 offen offset:0 sc1
  buffer_load_dwordx4 a[100:103], v2, s[8:11], s22 offen offset:1024 sc1
  buffer_load_dwordx4 a[104:107], v2, s[8:11], s22 offen offset:2048 sc1
  buffer_load_dwordx4 a[108:111], v2, s[8:11], s22 offen offset:3072 sc1
  s_add_u32 s22, s23, 0
  buffer_load_dwordx4 a[112:115], v2, s[8:11], s22 offen offset:0 sc1
  buffer_load_dwordx4 a[116:119], v2, s[8:11], s22 offen offset:1024 sc1
  buffer_load_dwordx4 a[120:123], v2, s[8:11], s22 offen offset:2048 sc1
  buffer_load_dwordx4 a[124:127], v2, s[8:11], s22 offen offset:3072 sc1
  s_add_u32 s22, s23, 4096
  buffer_load_dwordx4 a[128:131], v2, s[8:11], s22 offen offset:0 sc1
  buffer_load_dwordx4 a[132:135], v2, s[8:11], s22 offen offset:1024 sc1
  buffer_load_dwordx4 a[136:139], v2, s[8:11], s22 offen offset:2048 sc1
  buffer_load_dwordx4 a[140:143], v2, s[8:11], s22 offen offset:3072 sc1
  s_add_u32 s22, s23, 8192
  buffer_load_dwordx4 a[144:147], v2, s[8:11], s22 offen offset:0 sc1
  buffer_load_dwordx4 a[148:151], v2, s[8:11], s22 offen offset:1024 sc1
  buffer_load_dwordx4 a[152:155], v2, s[8:11], s22 offen offset:2048 sc1
  buffer_load_dwordx4 a[156:159], v2, s[8:11], s22 offen offset:3072 sc1
  s_add_u32 s22, s23, 12288
  buffer_load_dwordx4 a[160:163], v2, s[8:11], s22 offen offset:0 sc1
  buffer_load_dwordx4 a[164:167], v2, s[8:11], s22 offen offset:1024 sc1
  buffer_load_dwordx4 a[168:171], v2, s[8:11], s22 offen offset:2048 sc1
  buffer_load_dwordx4 a[172:175], v2, s[8:11], s22 offen offset:3072 sc1
  s_add_u32 s22, s23, 16384
  buffer_load_dwordx4 a[176:179], v2, s[8:11], s22 offen offset:0 sc1
  buffer_load_dwordx4 a[180:183], v2, s[8:11], s22 offen offset:1024 sc1
  buffer_load_dwordx4 a[184:187], v2, s[8:11], s22 offen offset:2048 sc1
  buffer_load_dwordx4 a[188:191], v2, s[8:11], s22 offen offset:3072 sc1
  s_add_u32 s22, s23, 20480
  buffer_load_dwordx4 a[192:195], v2, s[8:11], s22 offen offset:0 sc1
  buffer_load_dwordx4 a[196:199], v2, s[8:11], s22 offen offset:1024 sc1
  buffer_load_dwordx4 a[200:203], v2, s[8:11], s22 offen offset:2048 sc1
  buffer_load_dwordx4 a[204:207], v2, s[8:11], s22 offen offset:3072 sc1
  s_add_u32 s22, s23, 24576
  buffer_load_dwordx4 a[208:211], v2, s[8:11], s22 offen offset:0 sc1
  buffer_load_dwordx4 a[212:215], v2, s[8:11], s22 offen offset:1024 sc1
  buffer_load_dwordx4 a[216:219], v2, s[8:11], s22 offen offset:2048 sc1
  buffer_load_dwordx4 a[220:223], v2, s[8:11], s22 offen offset:3072 sc1
  v_lshl_add_u32 v5, v3, 2, 0
  v_cmp_le_u32 s[40:41], v5, v4
  v_lshl_add_u32 v5, v3, 2, 1
  v_cmp_le_u32 s[42:43], v5, v4
  v_lshl_add_u32 v5, v3, 2, 2
  v_cmp_le_u32 s[44:45], v5, v4
  v_lshl_add_u32 v5, v3, 2, 3
  v_cmp_le_u32 s[46:47], v5, v4
  v_cmp_gt_u32 s[48:49], 2, v3
  v_mov_b32 v6, 0xff800000
  s_waitcnt vmcnt(0)
  v_mfma_f32_16x16x32_bf16 v[8:11], a[112:115], a[0:3], 0
  v_mfma_f32_16x16x32_bf16 v[12:15], a[112:115], a[56:59], 0
  v_mfma_f32_16x16x32_bf16 v[16:19], a[168:171], a[56:59], 0
  v_mfma_f32_16x16x32_bf16 v[8:11], a[116:119], a[4:7], v[8:11]
  v_mfma_f32_16x16x32_bf16 v[12:15], a[116:119], a[60:63], v[12:15]
  v_mfma_f32_16x16x32_bf16 v[16:19], a[172:175], a[60:63], v[16:19]
  v_mfma_f32_16x16x32_bf16 v[8:11], a[120:123], a[8:11], v[8:11]
  v_mfma_f32_16x16x32_bf16 v[12:15], a[120:123], a[64:67], v[12:15]
  v_mfma_f32_16x16x32_bf16 v[16:19], a[176:179], a[64:67], v[16:19]
  v_mfma_f32_16x16x32_bf16 v[8:11], a[124:127], a[12:15], v[8:11]
  v_mfma_f32_16x16x32_bf16 v[12:15], a[124:127], a[68:71], v[12:15]
  v_mfma_f32_16x16x32_bf16 v[16:19], a[180:183], a[68:71], v[16:19]
  v_mfma_f32_16x16x32_bf16 v[8:11], a[128:131], a[16:19], v[8:11]
  v_mfma_f32_16x16x32_bf16 v[12:15], a[128:131], a[72:75], v[12:15]
  v_mfma_f32_16x16x32_bf16 v[16:19], a[184:187], a[72:75], v[16:19]
  v_mfma_f32_16x16x32_bf16 v[8:11], a[132:135], a[20:23], v[8:11]
  v_mfma_f32_16x16x32_bf16 v[12:15], a[132:135], a[76:79], v[12:15]
  v_mfma_f32_16x16x32_bf16 v[16:19], a[188:191], a[76:79], v[16:19]
  v_mfma_f32_16x16x32_bf16 v[8:11], a[136:139], a[24:27], v[8:11]
  v_mfma_f32_16x16x32_bf16 v[12:15], a[136:139], a[80:83], v[12:15]
  v_mfma_f32_16x16x32_bf16 v[16:19], a[192:195], a[80:83], v[16:19]
  v_mfma_f32_16x16x32_bf16 v[8:11], a[140:143], a[28:31], v[8:11]
  v_mfma_f32_16x16x32_bf16 v[12:15], a[140:143], a[84:87], v[12:15]
  v_mfma_f32_16x16x32_bf16 v[16:19], a[196:199], a[84:87], v[16:19]
  v_mfma_f32_16x16x32_bf16 v[8:11], a[144:147], a[32:35], v[8:11]
  v_mfma_f32_16x16x32_bf16 v[12:15], a[144:147], a[88:91], v[12:15]
  v_mfma_f32_16x16x32_bf16 v[16:19], a[200:203], a[88:91], v[16:19]
  v_mfma_f32_16x16x32_bf16 v[8:11], a[148:151], a[36:39], v[8:11]
  v_mfma_f32_16x16x32_bf16 v[12:15], a[148:151], a[92:95], v[12:15]
  v_mfma_f32_16x16x32_bf16 v[16:19], a[204:207], a[92:95], v[16:19]
  v_mfma_f32_16x16x32_bf16 v[8:11], a[152:155], a[40:43], v[8:11]
  v_mfma_f32_16x16x32_bf16 v[12:15], a[152:155], a[96:99], v[12:15]
  v_mfma_f32_16x16x32_bf16 v[16:19], a[208:211], a[96:99], v[16:19]
  v_mfma_f32_16x16x32_bf16 v[8:11], a[156:159], a[44:47], v[8:11]
  v_mfma_f32_16x16x32_bf16 v[12:15], a[156:159], a[100:103], v[12:15]
  v_mfma_f32_16x16x32_bf16 v[16:19], a[212:215], a[100:103], v[16:19]
  v_mfma_f32_16x16x32_bf16 v[8:11], a[160:163], a[48:51], v[8:11]
  v_mfma_f32_16x16x32_bf16 v[12:15], a[160:163], a[104:107], v[12:15]
  v_mfma_f32_16x16x32_bf16 v[16:19], a[216:219], a[104:107], v[16:19]
  v_mfma_f32_16x16x32_bf16 v[8:11], a[164:167], a[52:55], v[8:11]
  v_mfma_f32_16x16x32_bf16 v[12:15], a[164:167], a[108:111], v[12:15]
  v_mfma_f32_16x16x32_bf16 v[16:19], a[220:223], a[108:111], v[16:19]
  s_mul_i32 s22, s20, 448
  v_mov_b32 v62, s22
  s_mov_b32 s30, 0
wp_pm:
  s_cmp_ge_u32 s17, 64
  s_cbranch_scc1 wp_pf
  v_mov_b32 v61, 0
  s_mov_b64 exec, 1
  buffer_atomic_or v61, v62, s[8:11], s24 offen sc0
  s_mov_b64 exec, -1
  s_waitcnt vmcnt(0)
  v_cmp_eq_u32 vcc, -1, v61
  s_cbranch_vccnz wp_pr
wp_pf:
  s_add_u32 s22, s24, 4096
  buffer_load_dwordx4 v[64:67], v2, s[8:11], s24 offen offset:0 sc1
  buffer_load_dwordx4 v[68:71], v2, s[8:11], s24 offen offset:1024 sc1
  buffer_load_dwordx4 v[72:75], v2, s[8:11], s24 offen offset:2048 sc1
  buffer_load_dwordx4 v[76:79], v2, s[8:11], s24 offen offset:3072 sc1
  buffer_load_dwordx4 v[80:83], v2, s[8:11], s22 offen offset:0 sc1
  buffer_load_dwordx4 v[84:87], v2, s[8:11], s22 offen offset:1024 sc1
  buffer_load_dwordx4 v[88:91], v2, s[8:11], s22 offen offset:2048 sc1
  s_waitcnt vmcnt(0)
  v_max_u32 v61, v64, v65
  v_max3_u32 v61, v61, v66, v67
  v_max3_u32 v61, v61, v68, v69
  v_max3_u32 v61, v61, v70, v71
  v_max3_u32 v61, v61, v72, v73
  v_max3_u32 v61, v61, v74, v75
  v_max3_u32 v61, v61, v76, v77
  v_max3_u32 v61, v61, v78, v79
  v_max3_u32 v61, v61, v80, v81
  v_max3_u32 v61, v61, v82, v83
  v_max3_u32 v61, v61, v84, v85
  v_max3_u32 v61, v61, v86, v87
  v_max3_u32 v61, v61, v88, v89
  v_max3_u32 v61, v61, v90, v91
  v_cmp_eq_u32 vcc, -1, v61
  s_cbranch_vccz wp_pk
wp_pr:
  s_sleep 4
  s_cmp_ge_u32 s17, 56
  s_cbranch_scc1 wp_pm_bo
  s_sleep 127
wp_pm_bo:
  s_add_u32 s30, s30, 1
  s_cmp_lt_u32 s30, 30000
  s_cbranch_scc1 wp_pm
  s_branch wp_abort
wp_pk:
  buffer_load_dword v250, v251, s[12:15], 0 offen sc1
  v_mfma_f32_16x16x32_bf16 v[20:23], v[64:67], a[0:3], 0
  v_mfma_f32_16x16x32_bf16 v[24:27], v[64:67], a[4:7], 0
  v_mfma_f32_16x16x32_bf16 v[28:31], v[64:67], a[56:59], 0
  v_mfma_f32_16x16x32_bf16 v[32:35], v[64:67], a[60:63], 0
  v_mfma_f32_16x16x32_bf16 v[20:23], v[68:71], a[8:11], v[20:23]
  v_mfma_f32_16x16x32_bf16 v[24:27], v[68:71], a[12:15], v[24:27]
  v_mfma_f32_16x16x32_bf16 v[28:31], v[68:71], a[64:67], v[28:31]
  v_mfma_f32_16x16x32_bf16 v[32:35], v[68:71], a[68:71], v[32:35]
  v_mfma_f32_16x16x32_bf16 v[20:23], v[72:75], a[16:19], v[20:23]
  v_mfma_f32_16x16x32_bf16 v[24:27], v[72:75], a[20:23], v[24:27]
  v_mfma_f32_16x16x32_bf16 v[28:31], v[72:75], a[72:75], v[28:31]
  v_mfma_f32_16x16x32_bf16 v[32:35], v[72:75], a[76:79], v[32:35]
  v_mfma_f32_16x16x32_bf16 v[20:23], v[76:79], a[24:27], v[20:23]
  v_mfma_f32_16x16x32_bf16 v[24:27], v[76:79], a[28:31], v[24:27]
  v_mfma_f32_16x16x32_bf16 v[28:31], v[76:79], a[80:83], v[28:31]
  v_mfma_f32_16x16x32_bf16 v[32:35], v[76:79], a[84:87], v[32:35]
  v_mfma_f32_16x16x32_bf16 v[20:23], v[80:83], a[32:35], v[20:23]
  v_mfma_f32_16x16x32_bf16 v[24:27], v[80:83], a[36:39], v[24:27]
  v_mfma_f32_16x16x32_bf16 v[28:31], v[80:83], a[88:91], v[28:31]
  v_mfma_f32_16x16x32_bf16 v[32:35], v[80:83], a[92:95], v[32:35]
  v_mfma_f32_16x16x32_bf16 v[20:23], v[84:87], a[40:43], v[20:23]
  v_mfma_f32_16x16x32_bf16 v[24:27], v[84:87], a[44:47], v[24:27]
  v_mfma_f32_16x16x32_bf16 v[28:31], v[84:87], a[96:99], v[28:31]
  v_mfma_f32_16x16x32_bf16 v[32:35], v[84:87], a[100:103], v[32:35]
  v_mfma_f32_16x16x32_bf16 v[20:23], v[88:91], a[48:51], v[20:23]
  v_mfma_f32_16x16x32_bf16 v[24:27], v[88:91], a[52:55], v[24:27]
  v_mfma_f32_16x16x32_bf16 v[28:31], v[88:91], a[104:107], v[28:31]
  v_mfma_f32_16x16x32_bf16 v[32:35], v[88:91], a[108:111], v[32:35]
  s_lshl_b32 s25, s17, 1
  s_mul_i32 s25, s25, 20480
  s_add_u32 s25, s25, 85446656
  s_lshl_b32 s26, s20, 10
  s_add_u32 s26, s26, s25
  s_lshl_b32 s27, s18, 10
  s_add_u32 s27, s27, s25
  s_lshr_b32 s28, s16, 1
  s_lshl_b32 s28, s28, 3
  s_add_u32 s27, s27, s28
  s_add_u32 s27, s27, 16384
  s_and_b32 s28, s16, 1
  s_cmp_eq_u32 s28, 0
  s_cselect_b32 s50, -1, 0
  s_cselect_b32 s51, 0, -1
  v_cndmask_b32 v8, v6, v8, s[40:41]
  v_cndmask_b32 v9, v6, v9, s[42:43]
  v_cndmask_b32 v10, v6, v10, s[44:45]
  v_cndmask_b32 v11, v6, v11, s[46:47]
  v_cndmask_b32 v20, v24, v20, s[48:49]
  v_cndmask_b32 v21, v25, v21, s[48:49]
  v_cndmask_b32 v22, v26, v22, s[48:49]
  v_cndmask_b32 v23, v27, v23, s[48:49]
  v_mov_b32 v24, v20
  v_mov_b32 v25, v21
  v_mov_b32 v26, v22
  v_mov_b32 v27, v23
  v_permlane32_swap_b32 v20, v24
  v_permlane32_swap_b32 v21, v25
  v_permlane32_swap_b32 v22, v26
  v_permlane32_swap_b32 v23, v27
  v_add_f32 v20, v20, v24
  v_add_f32 v21, v21, v25
  v_add_f32 v22, v22, v26
  v_add_f32 v23, v23, v27
  v_max3_f32 v40, v8, v9, v10
  v_max3_f32 v40, v40, v11, v20
  v_max3_f32 v40, v40, v21, v22
  v_max_f32 v40, v40, v23
  v_mov_b32 v41, v40
  s_nop 1
  v_permlane16_swap_b32 v40, v41
  v_max_f32 v40, v40, v41
  v_mov_b32 v41, v40
  s_nop 1
  v_permlane32_swap_b32 v40, v41
  v_max_f32 v40, v40, v41
  v_sub_f32 v8, v8, v40
  v_sub_f32 v9, v9, v40
  v_sub_f32 v10, v10, v40
  v_sub_f32 v11, v11, v40
  v_sub_f32 v20, v20, v40
  v_sub_f32 v21, v21, v40
  v_sub_f32 v22, v22, v40
  v_sub_f32 v23, v23, v40
  v_exp_f32 v8, v8
  v_exp_f32 v9, v9
  v_exp_f32 v10, v10
  v_exp_f32 v11, v11
  v_exp_f32 v20, v20
  v_exp_f32 v21, v21
  v_exp_f32 v22, v22
  v_exp_f32 v23, v23
  v_add_f32 v42, v20, v21
  v_add_f32 v43, v22, v23
  v_add_f32 v42, v42, v43
  v_mul_f32 v42, 0.5, v42
  v_add_f32 v42, v42, v8
  v_add_f32 v42, v42, v9
  v_add_f32 v42, v42, v10
  v_add_f32 v42, v42, v11
  v_mov_b32 v41, v42
  s_nop 1
  v_permlane16_swap_b32 v42, v41
  v_add_f32 v42, v42, v41
  v_mov_b32 v41, v42
  s_nop 1
  v_permlane32_swap_b32 v42, v41
  v_add_f32 v42, v42, v41
  v_rcp_f32 v42, v42
  s_nop 0
  v_mul_f32 v8, v8, v42
  v_mul_f32 v9, v9, v42
  v_mul_f32 v10, v10, v42
  v_mul_f32 v11, v11, v42
  v_mul_f32 v20, v20, v42
  v_mul_f32 v21, v21, v42
  v_mul_f32 v22, v22, v42
  v_mul_f32 v23, v23, v42
  v_cvt_pk_bf16_f32 v44, v8, v9
  v_cvt_pk_bf16_f32 v45, v10, v11
  v_mov_b32 v46, 0
  v_mov_b32 v47, 0
  v_cvt_pk_bf16_f32 v48, v20, v21
  v_cvt_pk_bf16_f32 v49, v22, v23
  buffer_store_dwordx4 v[44:47], v2, s[8:11], s26 offen sc1
  s_mov_b64 exec, s[50:51]
  buffer_store_dwordx2 v[48:49], v2, s[8:11], s27 offen sc1
  s_mov_b64 exec, -1
  s_add_u32 s26, s26, 20480
  s_add_u32 s27, s27, 20480
  v_cndmask_b32 v16, v6, v16, s[40:41]
  v_cndmask_b32 v17, v6, v17, s[42:43]
  v_cndmask_b32 v18, v6, v18, s[44:45]
  v_cndmask_b32 v19, v6, v19, s[46:47]
  v_cndmask_b32 v28, v32, v28, s[48:49]
  v_cndmask_b32 v29, v33, v29, s[48:49]
  v_cndmask_b32 v30, v34, v30, s[48:49]
  v_cndmask_b32 v31, v35, v31, s[48:49]
  v_mov_b32 v32, v28
  v_mov_b32 v33, v29
  v_mov_b32 v34, v30
  v_mov_b32 v35, v31
  v_permlane32_swap_b32 v28, v32
  v_permlane32_swap_b32 v29, v33
  v_permlane32_swap_b32 v30, v34
  v_permlane32_swap_b32 v31, v35
  v_add_f32 v28, v28, v32
  v_add_f32 v29, v29, v33
  v_add_f32 v30, v30, v34
  v_add_f32 v31, v31, v35
  v_max3_f32 v40, v12, v13, v14
  v_max3_f32 v40, v40, v15, v16
  v_max3_f32 v40, v40, v17, v18
  v_max3_f32 v40, v40, v19, v28
  v_max3_f32 v40, v40, v29, v30
  v_max_f32 v40, v40, v31
  v_mov_b32 v41, v40
  s_nop 1
  v_permlane16_swap_b32 v40, v41
  v_max_f32 v40, v40, v41
  v_mov_b32 v41, v40
  s_nop 1
  v_permlane32_swap_b32 v40, v41
  v_max_f32 v40, v40, v41
  v_sub_f32 v12, v12, v40
  v_sub_f32 v13, v13, v40
  v_sub_f32 v14, v14, v40
  v_sub_f32 v15, v15, v40
  v_sub_f32 v16, v16, v40
  v_sub_f32 v17, v17, v40
  v_sub_f32 v18, v18, v40
  v_sub_f32 v19, v19, v40
  v_sub_f32 v28, v28, v40
  v_sub_f32 v29, v29, v40
  v_sub_f32 v30, v30, v40
  v_sub_f32 v31, v31, v40
  v_exp_f32 v12, v12
  v_exp_f32 v13, v13
  v_exp_f32 v14, v14
  v_exp_f32 v15, v15
  v_exp_f32 v16, v16
  v_exp_f32 v17, v17
  v_exp_f32 v18, v18
  v_exp_f32 v19, v19
  v_exp_f32 v28, v28
  v_exp_f32 v29, v29
  v_exp_f32 v30, v30
  v_exp_f32 v31, v31
  v_add_f32 v42, v28, v29
  v_add_f32 v43, v30, v31
  v_add_f32 v42, v42, v43
  v_mul_f32 v42, 0.5, v42
  v_add_f32 v42, v42, v12
  v_add_f32 v42, v42, v13
  v_add_f32 v42, v42, v14
  v_add_f32 v42, v42, v15
  v_add_f32 v42, v42, v16
  v_add_f32 v42, v42, v17
  v_add_f32 v42, v42, v18
  v_add_f32 v42, v42, v19
  v_mov_b32 v41, v42
  s_nop 1
  v_permlane16_swap_b32 v42, v41
  v_add_f32 v42, v42, v41
  v_mov_b32 v41, v42
  s_nop 1
  v_permlane32_swap_b32 v42, v41
  v_add_f32 v42, v42, v41
  v_rcp_f32 v42, v42
  s_nop 0
  v_mul_f32 v12, v12, v42
  v_mul_f32 v13, v13, v42
  v_mul_f32 v14, v14, v42
  v_mul_f32 v15, v15, v42
  v_mul_f32 v16, v16, v42
  v_mul_f32 v17, v17, v42
  v_mul_f32 v18, v18, v42
  v_mul_f32 v19, v19, v42
  v_mul_f32 v28, v28, v42
  v_mul_f32 v29, v29, v42
  v_mul_f32 v30, v30, v42
  v_mul_f32 v31, v31, v42
  v_cvt_pk_bf16_f32 v52, v12, v13
  v_cvt_pk_bf16_f32 v53, v14, v15
  v_cvt_pk_bf16_f32 v54, v16, v17
  v_cvt_pk_bf16_f32 v55, v18, v19
  v_cvt_pk_bf16_f32 v56, v28, v29
  v_cvt_pk_bf16_f32 v57, v30, v31
  buffer_store_dwordx4 v[52:55], v2, s[8:11], s26 offen sc1
  s_mov_b64 exec, s[50:51]
  buffer_store_dwordx2 v[56:57], v2, s[8:11], s27 offen sc1
  s_mov_b64 exec, -1
  s_lshl_b32 s25, s17, 7
  s_add_u32 s25, s25, 88561664
  v_mov_b32 v5, 1
  v_mov_b32 v6, 0
  s_waitcnt vmcnt(0)
  s_mov_b64 exec, 1
  buffer_atomic_add v5, v6, s[8:11], s25 offen
  s_mov_b64 exec, -1
  s_branch wk_loop
wk_toko:
  s_lshl_b32 s20, s18, 2
  s_add_u32 s20, s20, s16
  s_mul_i32 s24, s20, 65
  s_add_u32 s24, s24, s17
  s_lshl_b32 s24, s24, 13
  s_add_u32 s24, s24, 76935168
  s_lshl_b32 s21, s20, 6
  s_add_u32 s21, s21, s17
  s_mul_i32 s21, s21, 28672
  s_add_u32 s21, s21, 42205184
  s_lshl_b32 s25, s17, 1
  s_mul_i32 s25, s25, 20480
  s_add_u32 s25, s25, 85446656
  v_mul_u32_u24 v7, 28, v3
  v_add_u32 v5, v7, v4
  v_lshlrev_b32 v5, 4, v5
  v_add_u32 v6, 16, v4
  v_min_u32 v6, 27, v6
  v_add_u32 v6, v7, v6
  v_lshlrev_b32 v6, 4, v6
  v_lshrrev_b32 v8, 1, v3
  v_lshl_add_u32 v8, v8, 4, v4
  v_lshlrev_b32 v8, 4, v8
  v_and_b32 v9, 1, v3
  v_lshl_add_u32 v7, v9, 3, v8
  s_lshr_b32 s26, s17, 3
  s_lshl_b32 s26, s26, 4
  s_add_u32 s26, s26, s20
  s_lshl_b32 s26, s26, 7
  s_add_u32 s26, s26, 88528896
  v_mov_b32 v60, 0
  s_mov_b32 s30, 0
wo_wv:
  buffer_load_dword v61, v60, s[8:11], s26 offen sc1
  s_waitcnt vmcnt(0)
  v_cmp_ne_u32 vcc, 56, v61
  s_cbranch_vccz wo_wv_ok
  s_sleep 4
  s_cmp_ge_u32 s17, 56
  s_cbranch_scc1 wo_wv_bo
  s_sleep 127
wo_wv_bo:
  s_add_u32 s30, s30, 1
  s_cmp_lt_u32 s30, 30000
  s_cbranch_scc1 wo_wv
  s_branch wo_abort
wo_wv_ok:
  s_add_u32 s22, s21, 0
  buffer_load_dwordx4 a[0:3], v5, s[8:11], s22 offen offset:0 sc1
  buffer_load_dwordx4 a[4:7], v6, s[8:11], s22 offen offset:0 sc1
  buffer_load_dwordx4 a[8:11], v5, s[8:11], s22 offen offset:1792 sc1
  buffer_load_dwordx4 a[12:15], v6, s[8:11], s22 offen offset:1792 sc1
  s_add_u32 s22, s21, 3584
  buffer_load_dwordx4 a[16:19], v5, s[8:11], s22 offen offset:0 sc1
  buffer_load_dwordx4 a[20:23], v6, s[8:11], s22 offen offset:0 sc1
  buffer_load_dwordx4 a[24:27], v5, s[8:11], s22 offen offset:1792 sc1
  buffer_load_dwordx4 a[28:31], v6, s[8:11], s22 offen offset:1792 sc1
  s_add_u32 s22, s21, 7168
  buffer_load_dwordx4 a[32:35], v5, s[8:11], s22 offen offset:0 sc1
  buffer_load_dwordx4 a[36:39], v6, s[8:11], s22 offen offset:0 sc1
  buffer_load_dwordx4 a[40:43], v5, s[8:11], s22 offen offset:1792 sc1
  buffer_load_dwordx4 a[44:47], v6, s[8:11], s22 offen offset:1792 sc1
  s_add_u32 s22, s21, 10752
  buffer_load_dwordx4 a[48:51], v5, s[8:11], s22 offen offset:0 sc1
  buffer_load_dwordx4 a[52:55], v6, s[8:11], s22 offen offset:0 sc1
  buffer_load_dwordx4 a[56:59], v5, s[8:11], s22 offen offset:1792 sc1
  buffer_load_dwordx4 a[60:63], v6, s[8:11], s22 offen offset:1792 sc1
  s_add_u32 s22, s21, 14336
  buffer_load_dwordx4 a[64:67], v5, s[8:11], s22 offen offset:0 sc1
  buffer_load_dwordx4 a[68:71], v6, s[8:11], s22 offen offset:0 sc1
  buffer_load_dwordx4 a[72:75], v5, s[8:11], s22 offen offset:1792 sc1
  buffer_load_dwordx4 a[76:79], v6, s[8:11], s22 offen offset:1792 sc1
  s_add_u32 s22, s21, 17920
  buffer_load_dwordx4 a[80:83], v5, s[8:11], s22 offen offset:0 sc1
  buffer_load_dwordx4 a[84:87], v6, s[8:11], s22 offen offset:0 sc1
  buffer_load_dwordx4 a[88:91], v5, s[8:11], s22 offen offset:1792 sc1
  buffer_load_dwordx4 a[92:95], v6, s[8:11], s22 offen offset:1792 sc1
  s_add_u32 s22, s21, 21504
  buffer_load_dwordx4 a[96:99], v5, s[8:11], s22 offen offset:0 sc1
  buffer_load_dwordx4 a[100:103], v6, s[8:11], s22 offen offset:0 sc1
  buffer_load_dwordx4 a[104:107], v5, s[8:11], s22 offen offset:1792 sc1
  buffer_load_dwordx4 a[108:111], v6, s[8:11], s22 offen offset:1792 sc1
  s_add_u32 s22, s21, 25088
  buffer_load_dwordx4 a[112:115], v5, s[8:11], s22 offen offset:0 sc1
  buffer_load_dwordx4 a[116:119], v6, s[8:11], s22 offen offset:0 sc1
  buffer_load_dwordx4 a[120:123], v5, s[8:11], s22 offen offset:1792 sc1
  buffer_load_dwordx4 a[124:127], v6, s[8:11], s22 offen offset:1792 sc1
  s_lshl_b32 s26, s20, 6
  s_add_u32 s26, s26, s17
  s_lshl_b32 s26, s26, 4
  s_add_u32 s26, s26, 88569856
  v_lshlrev_b32 v60, 2, v3
  s_mov_b32 s30, 0
wo_wt:
  buffer_load_dword v61, v60, s[8:11], s26 offen sc1
  s_waitcnt vmcnt(0)
  v_cmp_ne_u32 vcc, 1, v61
  s_cbranch_vccz wo_wt_ok
  s_sleep 4
  s_cmp_ge_u32 s17, 56
  s_cbranch_scc1 wo_wt_bo
  s_sleep 127
wo_wt_bo:
  s_add_u32 s30, s30, 1
  s_cmp_lt_u32 s30, 30000
  s_cbranch_scc1 wo_wt
  s_branch wo_abort
wo_wt_ok:
  s_add_u32 s22, s24, 0
  buffer_load_dwordx2 v[28:29], v7, s[8:11], s22 offen offset:0 sc1
  buffer_load_dwordx2 v[30:31], v7, s[8:11], s22 offen offset:512 sc1
  buffer_load_dwordx2 v[32:33], v7, s[8:11], s22 offen offset:1024 sc1
  buffer_load_dwordx2 v[34:35], v7, s[8:11], s22 offen offset:1536 sc1
  buffer_load_dwordx2 v[36:37], v7, s[8:11], s22 offen offset:2048 sc1
  buffer_load_dwordx2 v[38:39], v7, s[8:11], s22 offen offset:2560 sc1
  buffer_load_dwordx2 v[40:41], v7, s[8:11], s22 offen offset:3072 sc1
  buffer_load_dwordx2 v[42:43], v7, s[8:11], s22 offen offset:3584 sc1
  s_add_u32 s22, s24, 4096
  buffer_load_dwordx2 v[44:45], v7, s[8:11], s22 offen offset:0 sc1
  buffer_load_dwordx2 v[46:47], v7, s[8:11], s22 offen offset:512 sc1
  buffer_load_dwordx2 v[48:49], v7, s[8:11], s22 offen offset:1024 sc1
  buffer_load_dwordx2 v[50:51], v7, s[8:11], s22 offen offset:1536 sc1
  buffer_load_dwordx2 v[52:53], v7, s[8:11], s22 offen offset:2048 sc1
  buffer_load_dwordx2 v[54:55], v7, s[8:11], s22 offen offset:2560 sc1
  buffer_load_dwordx2 v[56:57], v7, s[8:11], s22 offen offset:3072 sc1
  buffer_load_dwordx2 v[58:59], v7, s[8:11], s22 offen offset:3584 sc1
  s_lshl_b32 s26, s17, 7
  s_add_u32 s26, s26, 88561664
  v_mov_b32 v60, 0
  s_mov_b32 s30, 0
wo_wp:
  buffer_load_dword v61, v60, s[8:11], s26 offen sc1
  s_waitcnt vmcnt(0)
  v_cmp_ne_u32 vcc, 16, v61
  s_cbranch_vccz wo_wp_ok
  s_sleep 2
  s_cmp_ge_u32 s17, 56
  s_cbranch_scc1 wo_wp_bo
  s_sleep 127
wo_wp_bo:
  s_add_u32 s30, s30, 1
  s_cmp_lt_u32 s30, 30000
  s_cbranch_scc1 wo_wp
  s_branch wo_abort
wo_wp_ok:
  buffer_load_dword v250, v251, s[12:15], 0 offen sc1
  s_add_u32 s26, s25, 0
  s_add_u32 s27, s25, 20480
  buffer_load_dwordx4 a[128:131], v2, s[8:11], s26 offen offset:0 sc1
  buffer_load_dwordx4 a[132:135], v2, s[8:11], s27 offen offset:0 sc1
  buffer_load_dwordx4 a[136:139], v2, s[8:11], s26 offen offset:1024 sc1
  buffer_load_dwordx4 a[140:143], v2, s[8:11], s27 offen offset:1024 sc1
  buffer_load_dwordx4 a[144:147], v2, s[8:11], s26 offen offset:2048 sc1
  buffer_load_dwordx4 a[148:151], v2, s[8:11], s27 offen offset:2048 sc1
  buffer_load_dwordx4 a[152:155], v2, s[8:11], s26 offen offset:3072 sc1
  buffer_load_dwordx4 a[156:159], v2, s[8:11], s27 offen offset:3072 sc1
  s_add_u32 s26, s25, 4096
  s_add_u32 s27, s25, 24576
  buffer_load_dwordx4 a[160:163], v2, s[8:11], s26 offen offset:0 sc1
  buffer_load_dwordx4 a[164:167], v2, s[8:11], s27 offen offset:0 sc1
  buffer_load_dwordx4 a[168:171], v2, s[8:11], s26 offen offset:1024 sc1
  buffer_load_dwordx4 a[172:175], v2, s[8:11], s27 offen offset:1024 sc1
  buffer_load_dwordx4 a[176:179], v2, s[8:11], s26 offen offset:2048 sc1
  buffer_load_dwordx4 a[180:183], v2, s[8:11], s27 offen offset:2048 sc1
  buffer_load_dwordx4 a[184:187], v2, s[8:11], s26 offen offset:3072 sc1
  buffer_load_dwordx4 a[188:191], v2, s[8:11], s27 offen offset:3072 sc1
  s_add_u32 s26, s25, 8192
  s_add_u32 s27, s25, 28672
  buffer_load_dwordx4 a[192:195], v2, s[8:11], s26 offen offset:0 sc1
  buffer_load_dwordx4 a[196:199], v2, s[8:11], s27 offen offset:0 sc1
  buffer_load_dwordx4 a[200:203], v2, s[8:11], s26 offen offset:1024 sc1
  buffer_load_dwordx4 a[204:207], v2, s[8:11], s27 offen offset:1024 sc1
  buffer_load_dwordx4 a[208:211], v2, s[8:11], s26 offen offset:2048 sc1
  buffer_load_dwordx4 a[212:215], v2, s[8:11], s27 offen offset:2048 sc1
  buffer_load_dwordx4 a[216:219], v2, s[8:11], s26 offen offset:3072 sc1
  buffer_load_dwordx4 a[220:223], v2, s[8:11], s27 offen offset:3072 sc1
  s_add_u32 s26, s25, 12288
  s_add_u32 s27, s25, 32768
  buffer_load_dwordx4 a[224:227], v2, s[8:11], s26 offen offset:0 sc1
  buffer_load_dwordx4 a[228:231], v2, s[8:11], s27 offen offset:0 sc1
  buffer_load_dwordx4 a[232:235], v2, s[8:11], s26 offen offset:1024 sc1
  buffer_load_dwordx4 a[236:239], v2, s[8:11], s27 offen offset:1024 sc1
  buffer_load_dwordx4 a[240:243], v2, s[8:11], s26 offen offset:2048 sc1
  buffer_load_dwordx4 a[244:247], v2, s[8:11], s27 offen offset:2048 sc1
  buffer_load_dwordx4 a[248:251], v2, s[8:11], s26 offen offset:3072 sc1
  buffer_load_dwordx4 a[252:255], v2, s[8:11], s27 offen offset:3072 sc1
  s_add_u32 s26, s25, 16384
  s_add_u32 s27, s25, 36864
  buffer_load_dwordx4 v[64:67], v2, s[8:11], s26 offen offset:0 sc1
  buffer_load_dwordx4 v[68:71], v2, s[8:11], s27 offen offset:0 sc1
  buffer_load_dwordx4 v[72:75], v2, s[8:11], s26 offen offset:1024 sc1
  buffer_load_dwordx4 v[76:79], v2, s[8:11], s27 offen offset:1024 sc1
  buffer_load_dwordx4 v[80:83], v2, s[8:11], s26 offen offset:2048 sc1
  buffer_load_dwordx4 v[84:87], v2, s[8:11], s27 offen offset:2048 sc1
  buffer_load_dwordx4 v[88:91], v2, s[8:11], s26 offen offset:3072 sc1
  buffer_load_dwordx4 v[92:95], v2, s[8:11], s27 offen offset:3072 sc1
  s_waitcnt vmcnt(38)
  v_mfma_f32_16x16x32_bf16 v[12:15], a[0:3], a[128:131], 0
  v_mfma_f32_16x16x32_bf16 v[16:19], a[0:3], a[132:135], 0
  v_mfma_f32_16x16x32_bf16 v[20:23], a[4:7], a[128:131], 0
  v_mfma_f32_16x16x32_bf16 v[24:27], a[4:7], a[132:135], 0
  s_waitcnt vmcnt(36)
  v_mfma_f32_16x16x32_bf16 v[12:15], a[8:11], a[136:139], v[12:15]
  v_mfma_f32_16x16x32_bf16 v[16:19], a[8:11], a[140:143], v[16:19]
  v_mfma_f32_16x16x32_bf16 v[20:23], a[12:15], a[136:139], v[20:23]
  v_mfma_f32_16x16x32_bf16 v[24:27], a[12:15], a[140:143], v[24:27]
  s_waitcnt vmcnt(34)
  v_mfma_f32_16x16x32_bf16 v[12:15], a[16:19], a[144:147], v[12:15]
  v_mfma_f32_16x16x32_bf16 v[16:19], a[16:19], a[148:151], v[16:19]
  v_mfma_f32_16x16x32_bf16 v[20:23], a[20:23], a[144:147], v[20:23]
  v_mfma_f32_16x16x32_bf16 v[24:27], a[20:23], a[148:151], v[24:27]
  s_waitcnt vmcnt(32)
  v_mfma_f32_16x16x32_bf16 v[12:15], a[24:27], a[152:155], v[12:15]
  v_mfma_f32_16x16x32_bf16 v[16:19], a[24:27], a[156:159], v[16:19]
  v_mfma_f32_16x16x32_bf16 v[20:23], a[28:31], a[152:155], v[20:23]
  v_mfma_f32_16x16x32_bf16 v[24:27], a[28:31], a[156:159], v[24:27]
  s_waitcnt vmcnt(30)
  v_mfma_f32_16x16x32_bf16 v[12:15], a[32:35], a[160:163], v[12:15]
  v_mfma_f32_16x16x32_bf16 v[16:19], a[32:35], a[164:167], v[16:19]
  v_mfma_f32_16x16x32_bf16 v[20:23], a[36:39], a[160:163], v[20:23]
  v_mfma_f32_16x16x32_bf16 v[24:27], a[36:39], a[164:167], v[24:27]
  s_waitcnt vmcnt(28)
  v_mfma_f32_16x16x32_bf16 v[12:15], a[40:43], a[168:171], v[12:15]
  v_mfma_f32_16x16x32_bf16 v[16:19], a[40:43], a[172:175], v[16:19]
  v_mfma_f32_16x16x32_bf16 v[20:23], a[44:47], a[168:171], v[20:23]
  v_mfma_f32_16x16x32_bf16 v[24:27], a[44:47], a[172:175], v[24:27]
  s_waitcnt vmcnt(26)
  v_mfma_f32_16x16x32_bf16 v[12:15], a[48:51], a[176:179], v[12:15]
  v_mfma_f32_16x16x32_bf16 v[16:19], a[48:51], a[180:183], v[16:19]
  v_mfma_f32_16x16x32_bf16 v[20:23], a[52:55], a[176:179], v[20:23]
  v_mfma_f32_16x16x32_bf16 v[24:27], a[52:55], a[180:183], v[24:27]
  s_waitcnt vmcnt(24)
  v_mfma_f32_16x16x32_bf16 v[12:15], a[56:59], a[184:187], v[12:15]
  v_mfma_f32_16x16x32_bf16 v[16:19], a[56:59], a[188:191], v[16:19]
  v_mfma_f32_16x16x32_bf16 v[20:23], a[60:63], a[184:187], v[20:23]
  v_mfma_f32_16x16x32_bf16 v[24:27], a[60:63], a[188:191], v[24:27]
  s_waitcnt vmcnt(22)
  v_mfma_f32_16x16x32_bf16 v[12:15], a[64:67], a[192:195], v[12:15]
  v_mfma_f32_16x16x32_bf16 v[16:19], a[64:67], a[196:199], v[16:19]
  v_mfma_f32_16x16x32_bf16 v[20:23], a[68:71], a[192:195], v[20:23]
  v_mfma_f32_16x16x32_bf16 v[24:27], a[68:71], a[196:199], v[24:27]
  s_waitcnt vmcnt(20)
  v_mfma_f32_16x16x32_bf16 v[12:15], a[72:75], a[200:203], v[12:15]
  v_mfma_f32_16x16x32_bf16 v[16:19], a[72:75], a[204:207], v[16:19]
  v_mfma_f32_16x16x32_bf16 v[20:23], a[76:79], a[200:203], v[20:23]
  v_mfma_f32_16x16x32_bf16 v[24:27], a[76:79], a[204:207], v[24:27]
  s_waitcnt vmcnt(18)
  v_mfma_f32_16x16x32_bf16 v[12:15], a[80:83], a[208:211], v[12:15]
  v_mfma_f32_16x16x32_bf16 v[16:19], a[80:83], a[212:215], v[16:19]
  v_mfma_f32_16x16x32_bf16 v[20:23], a[84:87], a[208:211], v[20:23]
  v_mfma_f32_16x16x32_bf16 v[24:27], a[84:87], a[212:215], v[24:27]
  s_waitcnt vmcnt(16)
  v_mfma_f32_16x16x32_bf16 v[12:15], a[88:91], a[216:219], v[12:15]
  v_mfma_f32_16x16x32_bf16 v[16:19], a[88:91], a[220:223], v[16:19]
  v_mfma_f32_16x16x32_bf16 v[20:23], a[92:95], a[216:219], v[20:23]
  v_mfma_f32_16x16x32_bf16 v[24:27], a[92:95], a[220:223], v[24:27]
  s_waitcnt vmcnt(14)
  v_mfma_f32_16x16x32_bf16 v[12:15], a[96:99], a[224:227], v[12:15]
  v_mfma_f32_16x16x32_bf16 v[16:19], a[96:99], a[228:231], v[16:19]
  v_mfma_f32_16x16x32_bf16 v[20:23], a[100:103], a[224:227], v[20:23]
  v_mfma_f32_16x16x32_bf16 v[24:27], a[100:103], a[228:231], v[24:27]
  s_waitcnt vmcnt(12)
  v_mfma_f32_16x16x32_bf16 v[12:15], a[104:107], a[232:235], v[12:15]
  v_mfma_f32_16x16x32_bf16 v[16:19], a[104:107], a[236:239], v[16:19]
  v_mfma_f32_16x16x32_bf16 v[20:23], a[108:111], a[232:235], v[20:23]
  v_mfma_f32_16x16x32_bf16 v[24:27], a[108:111], a[236:239], v[24:27]
  s_waitcnt vmcnt(10)
  v_mfma_f32_16x16x32_bf16 v[12:15], a[112:115], a[240:243], v[12:15]
  v_mfma_f32_16x16x32_bf16 v[16:19], a[112:115], a[244:247], v[16:19]
  v_mfma_f32_16x16x32_bf16 v[20:23], a[116:119], a[240:243], v[20:23]
  v_mfma_f32_16x16x32_bf16 v[24:27], a[116:119], a[244:247], v[24:27]
  s_waitcnt vmcnt(8)
  v_mfma_f32_16x16x32_bf16 v[12:15], a[120:123], a[248:251], v[12:15]
  v_mfma_f32_16x16x32_bf16 v[16:19], a[120:123], a[252:255], v[16:19]
  v_mfma_f32_16x16x32_bf16 v[20:23], a[124:127], a[248:251], v[20:23]
  v_mfma_f32_16x16x32_bf16 v[24:27], a[124:127], a[252:255], v[24:27]
  s_waitcnt vmcnt(0)
  v_mfma_f32_16x16x32_bf16 v[12:15], v[28:31], v[64:67], v[12:15]
  v_mfma_f32_16x16x32_bf16 v[16:19], v[28:31], v[68:71], v[16:19]
  v_mfma_f32_16x16x32_bf16 v[20:23], v[32:35], v[64:67], v[20:23]
  v_mfma_f32_16x16x32_bf16 v[24:27], v[32:35], v[68:71], v[24:27]
  v_mfma_f32_16x16x32_bf16 v[12:15], v[36:39], v[72:75], v[12:15]
  v_mfma_f32_16x16x32_bf16 v[16:19], v[36:39], v[76:79], v[16:19]
  v_mfma_f32_16x16x32_bf16 v[20:23], v[40:43], v[72:75], v[20:23]
  v_mfma_f32_16x16x32_bf16 v[24:27], v[40:43], v[76:79], v[24:27]
  v_mfma_f32_16x16x32_bf16 v[12:15], v[44:47], v[80:83], v[12:15]
  v_mfma_f32_16x16x32_bf16 v[16:19], v[44:47], v[84:87], v[16:19]
  v_mfma_f32_16x16x32_bf16 v[20:23], v[48:51], v[80:83], v[20:23]
  v_mfma_f32_16x16x32_bf16 v[24:27], v[48:51], v[84:87], v[24:27]
  v_mfma_f32_16x16x32_bf16 v[12:15], v[52:55], v[88:91], v[12:15]
  v_mfma_f32_16x16x32_bf16 v[16:19], v[52:55], v[92:95], v[16:19]
  v_mfma_f32_16x16x32_bf16 v[20:23], v[56:59], v[88:91], v[20:23]
  v_mfma_f32_16x16x32_bf16 v[24:27], v[56:59], v[92:95], v[24:27]
  v_mul_u32_u24 v8, 1792, v4
  v_lshl_add_u32 v8, v3, 3, v8
  s_mul_i32 s26, s17, 57344
  s_mul_i32 s22, s20, 56
  s_add_u32 s26, s26, s22
  s_add_u32 s26, s26, 896
  s_add_u32 s27, s26, 28672
  v_cvt_pk_bf16_f32 v96, v12, v13
  v_cvt_pk_bf16_f32 v97, v14, v15
  v_cvt_pk_bf16_f32 v98, v16, v17
  v_cvt_pk_bf16_f32 v99, v18, v19
  buffer_store_dwordx2 v[96:97], v8, s[92:95], s26 offen offset:0
  buffer_store_dwordx2 v[98:99], v8, s[92:95], s27 offen offset:0
  v_cvt_pk_bf16_f32 v100, v20, v21
  v_cvt_pk_bf16_f32 v101, v22, v23
  v_cvt_pk_bf16_f32 v102, v24, v25
  v_cvt_pk_bf16_f32 v103, v26, v27
  s_mov_b32 exec_hi, 0xffff
  buffer_store_dwordx2 v[100:101], v8, s[92:95], s26 offen offset:32
  buffer_store_dwordx2 v[102:103], v8, s[92:95], s27 offen offset:32
  s_mov_b64 exec, -1
  s_branch wk_loop
wp_abort:
wo_abort:
  s_branch cA_abort
ch_end:
  s_endpgm

.section .rodata,"a"
.p2align 6
.amdhsa_kernel main_kernel
  .amdhsa_next_free_vgpr 512
  .amdhsa_next_free_sgpr 102
  .amdhsa_accum_offset 256
  .amdhsa_group_segment_fixed_size 0
  .amdhsa_kernarg_size 136
  .amdhsa_user_sgpr_count 2
  .amdhsa_user_sgpr_kernarg_segment_ptr 1
  .amdhsa_system_sgpr_workgroup_id_x 1
.end_amdhsa_kernel
```

```asm
; @launch kernel=main_kernel grid=(256,1,1) block=(256,1,1) lds=163840
.amdgcn_target "amdgcn-amd-amdhsa--gfx950"
.text
.globl main_kernel
.p2align 8
.type main_kernel,@function
main_kernel:
  s_cmp_ge_u32 s2, 256
  s_cbranch_scc1 ch_end
  s_load_dwordx4 s[4:7], s[0:1], 120
  s_load_dwordx2 s[92:93], s[0:1], 112
  s_load_dwordx8 s[36:43], s[0:1], 56
  s_load_dwordx4 s[44:47], s[0:1], 88
  s_memrealtime s[88:89]
  s_getpc_b64 s[98:99]
pf_main_kernel_1:
  s_sub_u32 s98, s98, pf_main_kernel_1-main_kernel
  s_subb_u32 s99, s99, 0
  s_lshr_b32 s20, s2, 3
  v_lshl_add_u32 v60, v0, 5, s20
  v_lshlrev_b32 v60, 7, v60
  v_min_u32 v60, ch_end-main_kernel-4, v60
  v_cmp_gt_u32 vcc, 32, v0
  s_and_saveexec_b64 s[22:23], vcc
  s_cbranch_execz pf_main_kernel_1_n
  global_load_dword v62, v60, s[98:99]
pf_main_kernel_1_n:
  s_mov_b64 exec, -1
  s_getreg_b32 s67, hwreg(HW_REG_XCC_ID)
  s_and_b32 s67, s67, 7
  v_lshrrev_b32 v1, 6, v0
  s_nop 0
  v_readfirstlane_b32 s16, v1
  s_mov_b32 s66, 0
  s_mov_b32 s68, 0
  s_mov_b32 s69, 0
  s_mov_b32 s96, 0
  s_mov_b32 s97, 0
  s_mov_b32 s101, 0x5eed0000
  s_sub_u32 s20, s67, 0
  s_lshr_b32 s21, s2, 3
  s_and_b32 s20, s20, 7
  s_lshl_b32 s3, s20, 5
  s_add_u32 s3, s3, s21
  s_waitcnt lgkmcnt(0)
  s_mov_b32 s8, s6
  s_and_b32 s9, s7, 0xffff
  s_mov_b32 s10, 0x10000000
  s_mov_b32 s11, 0x20000
  s_mov_b32 s12, s4
  s_and_b32 s13, s5, 0xffff
  s_mov_b32 s14, 256
  s_mov_b32 s15, 0x20000
  s_or_b32 s88, s88, 1
  s_and_b32 s93, s93, 0xffff
  s_mov_b32 s94, 3670016
  s_mov_b32 s95, 0x20000
m_start:
  s_cmp_ge_u32 s3, 32
  s_cbranch_scc1 m_bjob
  v_and_b32 v1, 63, v0
  v_lshlrev_b32 v2, 4, v1
  v_lshrrev_b32 v116, 4, v1
  v_and_b32 v117, 15, v1
  v_mov_b32 v3, 0x4444
  v_mov_b32 v118, 0xeeee
  v_cmp_lt_u32 vcc, 7, v117
  s_nop 1
  v_cndmask_b32 v3, v3, v118, vcc
  s_and_b32 s17, s3, 15
  s_cmp_ge_u32 s3, 16
  s_cbranch_scc1 m_val
  s_mov_b32 s60, s42
  s_and_b32 s61, s43, 0xffff
  s_mov_b32 s62, 3670016
  s_mov_b32 s63, 0x20000
  v_lshrrev_b32 v24, 5, v1
  v_and_b32 v25, 31, v1
  s_lshl_b32 s26, s17, 9
  s_lshl_b32 s25, s16, 12
  v_xor_b32 v26, v25, v24
  v_lshlrev_b32 v26, 4, v26
  v_lshl_add_u32 v26, v24, 13, v26
  v_xor_b32 v100, 0, v26
  v_xor_b32 v101, 0, v26
  v_add_u32 v101, 15360, v101
  v_xor_b32 v102, 32, v26
  v_add_u32 v102, 30720, v102
  v_xor_b32 v103, 32, v26
  v_add_u32 v103, 46080, v103
  s_lshl_b32 s23, s16, 19
  s_add_u32 s23, s23, s26
  s_add_u32 m0, s25, 16384
  s_nop 0
  buffer_load_dwordx4 v100, s[60:63], s23 offen offset:0 lds
  buffer_load_dwordx4 v101, s[60:63], s23 offen offset:1024 lds
  buffer_load_dwordx4 v102, s[60:63], s23 offen offset:2048 lds
  buffer_load_dwordx4 v103, s[60:63], s23 offen offset:3072 lds
  s_add_u32 m0, s25, 32768
  s_add_u32 s23, s23, 65536
  buffer_load_dwordx4 v100, s[60:63], s23 offen offset:0 lds
  buffer_load_dwordx4 v101, s[60:63], s23 offen offset:1024 lds
  buffer_load_dwordx4 v102, s[60:63], s23 offen offset:2048 lds
  buffer_load_dwordx4 v103, s[60:63], s23 offen offset:3072 lds
  v_xor_b32 v100, 64, v100
  v_xor_b32 v101, 64, v101
  v_xor_b32 v102, 64, v102
  v_xor_b32 v103, 64, v103
  s_add_u32 m0, s25, 49152
  s_add_u32 s23, s23, 65536
  buffer_load_dwordx4 v100, s[60:63], s23 offen offset:0 lds
  buffer_load_dwordx4 v101, s[60:63], s23 offen offset:1024 lds
  buffer_load_dwordx4 v102, s[60:63], s23 offen offset:2048 lds
  buffer_load_dwordx4 v103, s[60:63], s23 offen offset:3072 lds
  s_add_u32 m0, s25, 65536
  s_add_u32 s23, s23, 65536
  buffer_load_dwordx4 v100, s[60:63], s23 offen offset:0 lds
  buffer_load_dwordx4 v101, s[60:63], s23 offen offset:1024 lds
  buffer_load_dwordx4 v102, s[60:63], s23 offen offset:2048 lds
  buffer_load_dwordx4 v103, s[60:63], s23 offen offset:3072 lds
  v_xor_b32 v100, 192, v100
  v_xor_b32 v101, 192, v101
  v_xor_b32 v102, 192, v102
  v_xor_b32 v103, 192, v103
  s_add_u32 m0, s25, 81920
  s_add_u32 s23, s23, 65536
  buffer_load_dwordx4 v100, s[60:63], s23 offen offset:0 lds
  buffer_load_dwordx4 v101, s[60:63], s23 offen offset:1024 lds
  buffer_load_dwordx4 v102, s[60:63], s23 offen offset:2048 lds
  buffer_load_dwordx4 v103, s[60:63], s23 offen offset:3072 lds
  s_add_u32 m0, s25, 98304
  s_add_u32 s23, s23, 65536
  buffer_load_dwordx4 v100, s[60:63], s23 offen offset:0 lds
  buffer_load_dwordx4 v101, s[60:63], s23 offen offset:1024 lds
  buffer_load_dwordx4 v102, s[60:63], s23 offen offset:2048 lds
  buffer_load_dwordx4 v103, s[60:63], s23 offen offset:3072 lds
  v_xor_b32 v100, 64, v100
  v_xor_b32 v101, 64, v101
  v_xor_b32 v102, 64, v102
  v_xor_b32 v103, 64, v103
  s_add_u32 m0, s25, 114688
  s_add_u32 s23, s23, 65536
  buffer_load_dwordx4 v100, s[60:63], s23 offen offset:0 lds
  buffer_load_dwordx4 v101, s[60:63], s23 offen offset:1024 lds
  buffer_load_dwordx4 v102, s[60:63], s23 offen offset:2048 lds
  buffer_load_dwordx4 v103, s[60:63], s23 offen offset:3072 lds
  s_add_u32 m0, s25, 131072
  s_add_u32 s23, s23, 65536
  buffer_load_dwordx4 v100, s[60:63], s23 offen offset:0 lds
  buffer_load_dwordx4 v101, s[60:63], s23 offen offset:1024 lds
  buffer_load_dwordx4 v102, s[60:63], s23 offen offset:2048 lds
  buffer_load_dwordx4 v103, s[60:63], s23 offen offset:3072 lds
  s_mov_b32 s56, s40
  s_and_b32 s57, s41, 0xffff
  s_mov_b32 s58, 3670016
  s_mov_b32 s59, 0x20000
  s_lshl_b32 s21, s16, 16
  s_add_u32 s27, s26, s21
  s_lshr_b32 s20, s16, 1
  s_lshl_b32 s20, s20, 6
  v_xor_b32 v26, s20, v26
  v_xor_b32 v4, 0, v26
  v_xor_b32 v5, 32, v26
  v_add_u32 v5, 15360, v5
  v_xor_b32 v6, 128, v26
  v_add_u32 v6, 30720, v6
  v_xor_b32 v7, 160, v26
  v_add_u32 v7, 46080, v7
  s_add_u32 s22, s27, 0
  s_add_u32 m0, s25, 0
  s_nop 0
  buffer_load_dwordx4 v4, s[56:59], s22 offen offset:0 lds
  buffer_load_dwordx4 v5, s[56:59], s22 offen offset:1024 lds
  buffer_load_dwordx4 v6, s[56:59], s22 offen offset:2048 lds
  buffer_load_dwordx4 v7, s[56:59], s22 offen offset:3072 lds
  s_cmp_lg_u32 s66, 0
  s_cbranch_scc1 sc_ci
  s_cmp_lg_u32 s16, 0
  s_cbranch_scc1 w0_2
  s_lshr_b32 s70, s3, 5
  s_and_b32 s71, s70, 4
  s_mul_i32 s71, s71, 12
  s_lshl_b32 s70, s70, 2
  s_add_u32 s70, s70, s71
  s_lshl_b32 s71, 1, s3
  v_mov_b32 v248, s71
  v_mov_b32 v249, 32
  s_mov_b64 exec, 1
  buffer_atomic_or v248, v249, s[12:15], s70 offen sc0
  buffer_load_dwordx2 v[250:251], v249, s[12:15], 0 offen offset:96 sc1
  s_mov_b64 exec, -1
w0_2:
sc_ci:
  v_and_b32 v26, 15, v25
  v_xor_b32 v27, v26, v24
  v_lshlrev_b32 v27, 4, v27
  v_bfe_u32 v28, v25, 2, 1
  v_lshlrev_b32 v28, 4, v28
  v_lshrrev_b32 v29, 3, v25
  v_lshl_add_u32 v28, v29, 2, v28
  v_and_b32 v29, 3, v25
  v_add_u32 v28, v28, v29
  v_lshl_add_u32 v28, v28, 9, v27
  v_lshrrev_b32 v29, 2, v26
  v_lshlrev_b32 v29, 15, v29
  v_bfe_u32 v30, v26, 1, 1
  v_lshl_add_u32 v29, v30, 11, v29
  v_lshrrev_b32 v30, 4, v25
  v_lshl_add_u32 v29, v30, 10, v29
  v_and_b32 v31, 1, v26
  v_lshl_add_u32 v29, v31, 9, v29
  v_add_u32 v29, v29, v27
  v_add_u32 v29, s25, v29
  v_xor_b32 v8, 0, v28
  v_xor_b32 v104, 0, v29
  v_xor_b32 v9, 32, v28
  v_xor_b32 v105, 32, v29
  v_xor_b32 v10, 64, v28
  v_xor_b32 v106, 64, v29
  v_xor_b32 v11, 96, v28
  v_xor_b32 v107, 96, v29
  v_xor_b32 v12, 128, v28
  v_xor_b32 v108, 128, v29
  v_xor_b32 v13, 160, v28
  v_xor_b32 v109, 160, v29
  v_xor_b32 v14, 192, v28
  v_xor_b32 v110, 192, v29
  v_xor_b32 v15, 224, v28
  v_xor_b32 v111, 224, v29
  s_mov_b32 s52, 1035512379
  s_waitcnt vmcnt(4)
  ds_read_b128 v[120:123], v104 offset:16384
  ds_read_b128 v[124:127], v105 offset:16384
  ds_read_b128 v[128:131], v106 offset:16384
  ds_read_b128 v[132:135], v107 offset:16384
  ds_read_b128 v[136:139], v108 offset:16384
  ds_read_b128 v[140:143], v109 offset:16384
  ds_read_b128 v[144:147], v110 offset:16384
  ds_read_b128 v[148:151], v111 offset:16384
  s_waitcnt lgkmcnt(4)
  ds_read_b128 v[152:155], v104 offset:16640
  ds_read_b128 v[156:159], v105 offset:16640
  ds_read_b128 v[160:163], v106 offset:16640
  ds_read_b128 v[164:167], v107 offset:16640
  ds_read_b128 v[168:171], v108 offset:16640
  ds_read_b128 v[172:175], v109 offset:16640
  ds_read_b128 v[176:179], v110 offset:16640
  ds_read_b128 v[180:183], v111 offset:16640
  s_waitcnt lgkmcnt(4)
  ds_read_b128 v[184:187], v104 offset:32768
  ds_read_b128 v[188:191], v105 offset:32768
  ds_read_b128 v[192:195], v106 offset:32768
  ds_read_b128 v[196:199], v107 offset:32768
  ds_read_b128 v[200:203], v108 offset:32768
  ds_read_b128 v[204:207], v109 offset:32768
  ds_read_b128 v[208:211], v110 offset:32768
  ds_read_b128 v[212:215], v111 offset:32768
  s_waitcnt lgkmcnt(4)
  ds_read_b128 v[216:219], v104 offset:33024
  ds_read_b128 v[220:223], v105 offset:33024
  ds_read_b128 v[224:227], v106 offset:33024
  ds_read_b128 v[228:231], v107 offset:33024
  ds_read_b128 v[232:235], v108 offset:33024
  ds_read_b128 v[236:239], v109 offset:33024
  ds_read_b128 v[240:243], v110 offset:33024
  ds_read_b128 v[244:247], v111 offset:33024
  s_waitcnt lgkmcnt(4)
  s_waitcnt lgkmcnt(0)
  s_add_u32 s22, s27, 262144
  s_add_u32 m0, s25, 16384
  s_nop 0
  buffer_load_dwordx4 v4, s[56:59], s22 offen offset:0 lds
  buffer_load_dwordx4 v5, s[56:59], s22 offen offset:1024 lds
  buffer_load_dwordx4 v6, s[56:59], s22 offen offset:2048 lds
  buffer_load_dwordx4 v7, s[56:59], s22 offen offset:3072 lds
  s_add_u32 s22, s27, 524288
  s_add_u32 m0, s25, 32768
  s_nop 0
  buffer_load_dwordx4 v4, s[56:59], s22 offen offset:0 lds
  buffer_load_dwordx4 v5, s[56:59], s22 offen offset:1024 lds
  buffer_load_dwordx4 v6, s[56:59], s22 offen offset:2048 lds
  buffer_load_dwordx4 v7, s[56:59], s22 offen offset:3072 lds
  s_add_u32 s22, s27, 786432
  s_add_u32 m0, s25, 49152
  s_nop 0
  buffer_load_dwordx4 v4, s[56:59], s22 offen offset:0 lds
  buffer_load_dwordx4 v5, s[56:59], s22 offen offset:1024 lds
  buffer_load_dwordx4 v6, s[56:59], s22 offen offset:2048 lds
  buffer_load_dwordx4 v7, s[56:59], s22 offen offset:3072 lds
  s_cmp_lg_u32 s66, 0
  s_cbranch_scc1 sc_cf
  s_cmp_lg_u32 s16, 0
  s_cbranch_scc1 w0_3
  s_waitcnt vmcnt(12)
  v_readfirstlane_b32 s70, v250
  s_cmp_lg_u32 s70, 0
  s_cbranch_scc1 sc_nz
  v_mov_b32 v249, 128
  v_mov_b32 v250, s88
  v_mov_b32 v251, s89
  v_mov_b32 v252, 0
  v_mov_b32 v253, 0
  s_mov_b64 exec, 1
  buffer_atomic_cmpswap_x2 v[250:253], v249, s[12:15], 0 offen sc0
  s_mov_b64 exec, -1
  s_waitcnt vmcnt(0)
  v_readfirstlane_b32 s70, v250
  s_cmp_lg_u32 s70, 0
  s_cbranch_scc1 sc_nz
  v_mov_b32 v250, s88
  v_mov_b32 v251, s89
sc_nz:
w0_3:
  v_mov_b32 v249, 160000
  s_add_u32 s101, s101, 1
  s_barrier
  s_mov_b64 exec, 1
  s_cmp_lg_u32 s16, 0
  s_cbranch_scc1 w0_4
  ds_write_b32 v249, v248 offset:0
  ds_write_b32 v249, v250 offset:4
  ds_write_b32 v249, v251 offset:8
  s_waitcnt lgkmcnt(0)
  v_mov_b32 v248, s101
  ds_write_b32 v249, v248 offset:16
  s_waitcnt lgkmcnt(0)
w0_4:
  s_mov_b64 exec, -1
  s_barrier
  ds_read_b32 v248, v249 offset:0
  ds_read_b32 v250, v249 offset:4
  ds_read_b32 v251, v249 offset:8
  ds_read_b32 v249, v249 offset:16
  s_waitcnt lgkmcnt(0)
  v_readfirstlane_b32 s70, v248
  v_readfirstlane_b32 s88, v250
  v_readfirstlane_b32 s89, v251
  v_cmp_ne_u32 vcc, s101, v249
  s_cbranch_vccnz ch_end
  s_mov_b32 s66, 1
  s_bitcmp1_b32 s70, s3
  s_cbranch_scc1 m_reclaim
sc_cf:
  s_cmp_lg_u32 s16, 0
  s_cbranch_scc1 w0_5
  s_cmp_eq_u32 s67, 0
  s_cselect_b32 s20, 1, 0x10001
  v_mov_b32 v248, s20
  v_mov_b32 v249, 0
  s_mov_b64 exec, 1
  buffer_atomic_add v248, v249, s[12:15], 0 offen
  s_mov_b64 exec, -1
w0_5:
  s_lshl_b32 s28, s17, 7
  s_add_u32 s28, s28, 88621120
  v_min_u32 v113, 32, v2
  s_mov_b32 s29, 88590336
  v_add_u32 v112, 1024, v2
  v_min_u32 v112, 1776, v112
  s_waitcnt vmcnt(8)
  s_barrier
  ds_read_b128 v[16:19], v8 offset:0
  ds_read_b128 v[20:23], v9 offset:0
  ds_read_b128 v[24:27], v10 offset:0
  ds_read_b128 v[28:31], v11 offset:0
  s_waitcnt lgkmcnt(3)
  v_mfma_f32_32x32x16_bf16 v[32:47], v[16:19], v[120:123], 0
  s_add_u32 s22, s27, 1048576
  s_add_u32 m0, s25, 65536
  s_nop 0
  buffer_load_dwordx4 v4, s[56:59], s22 offen offset:0 lds
  v_mfma_f32_32x32x16_bf16 v[48:63], v[16:19], v[184:187], 0
  ds_read_b128 v[16:19], v12 offset:0
  s_waitcnt lgkmcnt(3)
  v_mfma_f32_32x32x16_bf16 v[32:47], v[20:23], v[124:127], v[32:47]
  buffer_load_dwordx4 v5, s[56:59], s22 offen offset:1024 lds
  v_mfma_f32_32x32x16_bf16 v[48:63], v[20:23], v[188:191], v[48:63]
  ds_read_b128 v[20:23], v13 offset:0
  s_waitcnt lgkmcnt(3)
  v_mfma_f32_32x32x16_bf16 v[32:47], v[24:27], v[128:131], v[32:47]
  buffer_load_dwordx4 v6, s[56:59], s22 offen offset:2048 lds
  v_mfma_f32_32x32x16_bf16 v[48:63], v[24:27], v[192:195], v[48:63]
  ds_read_b128 v[24:27], v14 offset:0
  s_waitcnt lgkmcnt(3)
  v_mfma_f32_32x32x16_bf16 v[32:47], v[28:31], v[132:135], v[32:47]
  buffer_load_dwordx4 v7, s[56:59], s22 offen offset:3072 lds
  v_mfma_f32_32x32x16_bf16 v[48:63], v[28:31], v[196:199], v[48:63]
  ds_read_b128 v[28:31], v15 offset:0
  s_waitcnt lgkmcnt(3)
  v_mfma_f32_32x32x16_bf16 v[32:47], v[16:19], v[136:139], v[32:47]
  s_add_u32 s22, s27, 1310720
  s_add_u32 m0, s25, 81920
  s_nop 0
  buffer_load_dwordx4 v4, s[56:59], s22 offen offset:0 lds
  v_mfma_f32_32x32x16_bf16 v[48:63], v[16:19], v[200:203], v[48:63]
  ds_read_b128 v[16:19], v8 offset:256
  s_waitcnt lgkmcnt(3)
  v_mfma_f32_32x32x16_bf16 v[32:47], v[20:23], v[140:143], v[32:47]
  buffer_load_dwordx4 v5, s[56:59], s22 offen offset:1024 lds
  v_mfma_f32_32x32x16_bf16 v[48:63], v[20:23], v[204:207], v[48:63]
  ds_read_b128 v[20:23], v9 offset:256
  s_waitcnt lgkmcnt(3)
  v_mfma_f32_32x32x16_bf16 v[32:47], v[24:27], v[144:147], v[32:47]
  buffer_load_dwordx4 v6, s[56:59], s22 offen offset:2048 lds
  v_mfma_f32_32x32x16_bf16 v[48:63], v[24:27], v[208:211], v[48:63]
  ds_read_b128 v[24:27], v10 offset:256
  s_waitcnt lgkmcnt(3)
  v_mfma_f32_32x32x16_bf16 v[32:47], v[28:31], v[148:151], v[32:47]
  buffer_load_dwordx4 v7, s[56:59], s22 offen offset:3072 lds
  v_mfma_f32_32x32x16_bf16 v[48:63], v[28:31], v[212:215], v[48:63]
  ds_read_b128 v[28:31], v11 offset:256
  s_waitcnt lgkmcnt(3)
  v_mfma_f32_32x32x16_bf16 v[32:47], v[16:19], v[152:155], v[32:47]
  s_add_u32 s22, s27, 1572864
  s_add_u32 m0, s25, 98304
  s_nop 0
  buffer_load_dwordx4 v4, s[56:59], s22 offen offset:0 lds
  v_mfma_f32_32x32x16_bf16 v[48:63], v[16:19], v[216:219], v[48:63]
  ds_read_b128 v[16:19], v12 offset:256
  s_waitcnt lgkmcnt(3)
  v_mfma_f32_32x32x16_bf16 v[32:47], v[20:23], v[156:159], v[32:47]
  buffer_load_dwordx4 v5, s[56:59], s22 offen offset:1024 lds
  v_mfma_f32_32x32x16_bf16 v[48:63], v[20:23], v[220:223], v[48:63]
  ds_read_b128 v[20:23], v13 offset:256
  s_waitcnt lgkmcnt(3)
  v_mfma_f32_32x32x16_bf16 v[32:47], v[24:27], v[160:163], v[32:47]
  buffer_load_dwordx4 v6, s[56:59], s22 offen offset:2048 lds
  v_mfma_f32_32x32x16_bf16 v[48:63], v[24:27], v[224:227], v[48:63]
  ds_read_b128 v[24:27], v14 offset:256
  s_waitcnt lgkmcnt(3)
  v_mfma_f32_32x32x16_bf16 v[32:47], v[28:31], v[164:167], v[32:47]
  buffer_load_dwordx4 v7, s[56:59], s22 offen offset:3072 lds
  v_mfma_f32_32x32x16_bf16 v[48:63], v[28:31], v[228:231], v[48:63]
  ds_read_b128 v[28:31], v15 offset:256
  s_waitcnt lgkmcnt(3)
  v_mfma_f32_32x32x16_bf16 v[32:47], v[16:19], v[168:171], v[32:47]
  s_add_u32 s22, s27, 1835008
  s_add_u32 m0, s25, 114688
  s_nop 0
  buffer_load_dwordx4 v4, s[56:59], s22 offen offset:0 lds
  v_mfma_f32_32x32x16_bf16 v[48:63], v[16:19], v[232:235], v[48:63]
  ds_read_b128 v[16:19], v8 offset:16384
  s_waitcnt lgkmcnt(3)
  v_mfma_f32_32x32x16_bf16 v[32:47], v[20:23], v[172:175], v[32:47]
  buffer_load_dwordx4 v5, s[56:59], s22 offen offset:1024 lds
  v_mfma_f32_32x32x16_bf16 v[48:63], v[20:23], v[236:239], v[48:63]
  ds_read_b128 v[20:23], v9 offset:16384
  s_waitcnt lgkmcnt(3)
  v_mfma_f32_32x32x16_bf16 v[32:47], v[24:27], v[176:179], v[32:47]
  buffer_load_dwordx4 v6, s[56:59], s22 offen offset:2048 lds
  v_mfma_f32_32x32x16_bf16 v[48:63], v[24:27], v[240:243], v[48:63]
  ds_read_b128 v[24:27], v10 offset:16384
  s_waitcnt lgkmcnt(3)
  v_mfma_f32_32x32x16_bf16 v[32:47], v[28:31], v[180:183], v[32:47]
  buffer_load_dwordx4 v7, s[56:59], s22 offen offset:3072 lds
  v_mfma_f32_32x32x16_bf16 v[48:63], v[28:31], v[244:247], v[48:63]
  s_waitcnt vmcnt(16)
  s_barrier
  ds_read_b128 v[28:31], v11 offset:16384
  s_waitcnt lgkmcnt(3)
  v_mfma_f32_32x32x16_bf16 v[64:79], v[16:19], v[120:123], 0
  s_add_u32 s22, s27, 2097152
  s_add_u32 m0, s25, 131072
  s_nop 0
  buffer_load_dwordx4 v4, s[56:59], s22 offen offset:0 lds
  v_mfma_f32_32x32x16_bf16 v[80:95], v[16:19], v[184:187], 0
  ds_read_b128 v[16:19], v12 offset:16384
  s_waitcnt lgkmcnt(3)
  v_mfma_f32_32x32x16_bf16 v[64:79], v[20:23], v[124:127], v[64:79]
  buffer_load_dwordx4 v5, s[56:59], s22 offen offset:1024 lds
  v_mul_f32 v32, s52, v32
  v_mul_f32 v33, s52, v33
  v_cvt_pk_bf16_f32 v32, v32, v33
  v_mfma_f32_32x32x16_bf16 v[80:95], v[20:23], v[188:191], v[80:95]
  v_mul_f32 v34, s52, v34
  v_mul_f32 v35, s52, v35
  ds_read_b128 v[20:23], v13 offset:16384
  s_waitcnt lgkmcnt(3)
  v_mfma_f32_32x32x16_bf16 v[64:79], v[24:27], v[128:131], v[64:79]
  buffer_load_dwordx4 v6, s[56:59], s22 offen offset:2048 lds
  v_cvt_pk_bf16_f32 v33, v34, v35
  v_mul_f32 v36, s52, v36
  v_mul_f32 v37, s52, v37
  v_mfma_f32_32x32x16_bf16 v[80:95], v[24:27], v[192:195], v[80:95]
  v_cvt_pk_bf16_f32 v34, v36, v37
  v_mul_f32 v38, s52, v38
  ds_read_b128 v[24:27], v14 offset:16384
  s_waitcnt lgkmcnt(3)
  v_mfma_f32_32x32x16_bf16 v[64:79], v[28:31], v[132:135], v[64:79]
  buffer_load_dwordx4 v7, s[56:59], s22 offen offset:3072 lds
  v_mul_f32 v39, s52, v39
  v_cvt_pk_bf16_f32 v35, v38, v39
  v_mul_f32 v40, s52, v40
  v_mfma_f32_32x32x16_bf16 v[80:95], v[28:31], v[196:199], v[80:95]
  v_mul_f32 v41, s52, v41
  v_cvt_pk_bf16_f32 v40, v40, v41
  ds_read_b128 v[28:31], v15 offset:16384
  s_waitcnt lgkmcnt(3)
  v_mfma_f32_32x32x16_bf16 v[64:79], v[16:19], v[136:139], v[64:79]
  s_add_u32 s22, s27, 2359296
  s_add_u32 m0, s25, 0
  s_nop 0
  buffer_load_dwordx4 v4, s[56:59], s22 offen offset:0 lds
  v_mul_f32 v42, s52, v42
  v_mul_f32 v43, s52, v43
  v_cvt_pk_bf16_f32 v41, v42, v43
  v_mfma_f32_32x32x16_bf16 v[80:95], v[16:19], v[200:203], v[80:95]
  v_mul_f32 v44, s52, v44
  v_mul_f32 v45, s52, v45
  ds_read_b128 v[16:19], v8 offset:16640
  s_waitcnt lgkmcnt(3)
  v_mfma_f32_32x32x16_bf16 v[64:79], v[20:23], v[140:143], v[64:79]
  buffer_load_dwordx4 v5, s[56:59], s22 offen offset:1024 lds
  v_cvt_pk_bf16_f32 v42, v44, v45
  v_mul_f32 v46, s52, v46
  v_mul_f32 v47, s52, v47
  v_mfma_f32_32x32x16_bf16 v[80:95], v[20:23], v[204:207], v[80:95]
  v_cvt_pk_bf16_f32 v43, v46, v47
  v_permlane16_swap_b32 v32, v40
  ds_read_b128 v[20:23], v9 offset:16640
  s_waitcnt lgkmcnt(3)
  v_mfma_f32_32x32x16_bf16 v[64:79], v[24:27], v[144:147], v[64:79]
  buffer_load_dwordx4 v6, s[56:59], s22 offen offset:2048 lds
  v_permlane16_swap_b32 v33, v41
  v_permlane16_swap_b32 v34, v42
  v_permlane16_swap_b32 v35, v43
  v_mfma_f32_32x32x16_bf16 v[80:95], v[24:27], v[208:211], v[80:95]
  v_accvgpr_write_b32 a0, v32
  v_accvgpr_write_b32 a1, v33
  ds_read_b128 v[24:27], v10 offset:16640
  s_waitcnt lgkmcnt(3)
  v_mfma_f32_32x32x16_bf16 v[64:79], v[28:31], v[148:151], v[64:79]
  buffer_load_dwordx4 v7, s[56:59], s22 offen offset:3072 lds
  v_accvgpr_write_b32 a2, v34
  v_accvgpr_write_b32 a3, v35
  v_accvgpr_write_b32 a56, v40
  v_mfma_f32_32x32x16_bf16 v[80:95], v[28:31], v[212:215], v[80:95]
  v_accvgpr_write_b32 a57, v41
  v_accvgpr_write_b32 a58, v42
  ds_read_b128 v[28:31], v11 offset:16640
  s_waitcnt lgkmcnt(3)
  v_mfma_f32_32x32x16_bf16 v[64:79], v[16:19], v[152:155], v[64:79]
  v_accvgpr_write_b32 a59, v43
  v_mul_f32 v48, s52, v48
  v_mul_f32 v49, s52, v49
  v_mfma_f32_32x32x16_bf16 v[80:95], v[16:19], v[216:219], v[80:95]
  v_cvt_pk_bf16_f32 v48, v48, v49
  v_mul_f32 v50, s52, v50
  ds_read_b128 v[16:19], v12 offset:16640
  s_waitcnt lgkmcnt(3)
  v_mfma_f32_32x32x16_bf16 v[64:79], v[20:23], v[156:159], v[64:79]
  v_mul_f32 v51, s52, v51
  v_cvt_pk_bf16_f32 v49, v50, v51
  v_mul_f32 v52, s52, v52
  v_mfma_f32_32x32x16_bf16 v[80:95], v[20:23], v[220:223], v[80:95]
  v_mul_f32 v53, s52, v53
  v_cvt_pk_bf16_f32 v50, v52, v53
  ds_read_b128 v[20:23], v13 offset:16640
  s_waitcnt lgkmcnt(3)
  v_mfma_f32_32x32x16_bf16 v[64:79], v[24:27], v[160:163], v[64:79]
  v_mul_f32 v54, s52, v54
  v_mul_f32 v55, s52, v55
  v_cvt_pk_bf16_f32 v51, v54, v55
  v_mfma_f32_32x32x16_bf16 v[80:95], v[24:27], v[224:227], v[80:95]
  v_mul_f32 v56, s52, v56
  v_mul_f32 v57, s52, v57
  ds_read_b128 v[24:27], v14 offset:16640
  s_waitcnt lgkmcnt(3)
  v_mfma_f32_32x32x16_bf16 v[64:79], v[28:31], v[164:167], v[64:79]
  v_cvt_pk_bf16_f32 v56, v56, v57
  v_mul_f32 v58, s52, v58
  v_mul_f32 v59, s52, v59
  v_mfma_f32_32x32x16_bf16 v[80:95], v[28:31], v[228:231], v[80:95]
  v_cvt_pk_bf16_f32 v57, v58, v59
  v_mul_f32 v60, s52, v60
  ds_read_b128 v[28:31], v15 offset:16640
  s_waitcnt lgkmcnt(3)
  v_mfma_f32_32x32x16_bf16 v[64:79], v[16:19], v[168:171], v[64:79]
  v_mul_f32 v61, s52, v61
  v_cvt_pk_bf16_f32 v58, v60, v61
  v_mul_f32 v62, s52, v62
  v_mfma_f32_32x32x16_bf16 v[80:95], v[16:19], v[232:235], v[80:95]
  v_mul_f32 v63, s52, v63
  v_cvt_pk_bf16_f32 v59, v62, v63
  ds_read_b128 v[16:19], v8 offset:32768
  s_waitcnt lgkmcnt(3)
  v_mfma_f32_32x32x16_bf16 v[64:79], v[20:23], v[172:175], v[64:79]
  v_permlane16_swap_b32 v48, v56
  v_permlane16_swap_b32 v49, v57
  v_permlane16_swap_b32 v50, v58
  v_mfma_f32_32x32x16_bf16 v[80:95], v[20:23], v[236:239], v[80:95]
  v_permlane16_swap_b32 v51, v59
  v_accvgpr_write_b32 a112, v48
  ds_read_b128 v[20:23], v9 offset:32768
  s_waitcnt lgkmcnt(3)
  v_mfma_f32_32x32x16_bf16 v[64:79], v[24:27], v[176:179], v[64:79]
  v_accvgpr_write_b32 a113, v49
  v_accvgpr_write_b32 a114, v50
  v_accvgpr_write_b32 a115, v51
  v_mfma_f32_32x32x16_bf16 v[80:95], v[24:27], v[240:243], v[80:95]
  v_accvgpr_write_b32 a168, v56
  v_accvgpr_write_b32 a169, v57
  ds_read_b128 v[24:27], v10 offset:32768
  s_waitcnt lgkmcnt(3)
  v_mfma_f32_32x32x16_bf16 v[64:79], v[28:31], v[180:183], v[64:79]
  v_accvgpr_write_b32 a170, v58
  v_accvgpr_write_b32 a171, v59
  v_mfma_f32_32x32x16_bf16 v[80:95], v[28:31], v[244:247], v[80:95]
  ds_read_b128 v[28:31], v11 offset:32768
  s_waitcnt lgkmcnt(3)
  v_mfma_f32_32x32x16_bf16 v[32:47], v[16:19], v[120:123], 0
  v_mfma_f32_32x32x16_bf16 v[48:63], v[16:19], v[184:187], 0
  ds_read_b128 v[16:19], v12 offset:32768
  s_waitcnt lgkmcnt(3)
  v_mfma_f32_32x32x16_bf16 v[32:47], v[20:23], v[124:127], v[32:47]
  v_mul_f32 v64, s52, v64
  v_mul_f32 v65, s52, v65
  v_cvt_pk_bf16_f32 v64, v64, v65
  v_mfma_f32_32x32x16_bf16 v[48:63], v[20:23], v[188:191], v[48:63]
  v_mul_f32 v66, s52, v66
  v_mul_f32 v67, s52, v67
  ds_read_b128 v[20:23], v13 offset:32768
  s_waitcnt lgkmcnt(3)
  v_mfma_f32_32x32x16_bf16 v[32:47], v[24:27], v[128:131], v[32:47]
  v_cvt_pk_bf16_f32 v65, v66, v67
  v_mul_f32 v68, s52, v68
  v_mul_f32 v69, s52, v69
  v_mfma_f32_32x32x16_bf16 v[48:63], v[24:27], v[192:195], v[48:63]
  v_cvt_pk_bf16_f32 v66, v68, v69
  v_mul_f32 v70, s52, v70
  ds_read_b128 v[24:27], v14 offset:32768
  s_waitcnt lgkmcnt(3)
  v_mfma_f32_32x32x16_bf16 v[32:47], v[28:31], v[132:135], v[32:47]
  v_mul_f32 v71, s52, v71
  v_cvt_pk_bf16_f32 v67, v70, v71
  v_mul_f32 v72, s52, v72
  v_mfma_f32_32x32x16_bf16 v[48:63], v[28:31], v[196:199], v[48:63]
  v_mul_f32 v73, s52, v73
  v_cvt_pk_bf16_f32 v72, v72, v73
  ds_read_b128 v[28:31], v15 offset:32768
  s_waitcnt lgkmcnt(3)
  v_mfma_f32_32x32x16_bf16 v[32:47], v[16:19], v[136:139], v[32:47]
  v_mul_f32 v74, s52, v74
  v_mul_f32 v75, s52, v75
  v_cvt_pk_bf16_f32 v73, v74, v75
  v_mfma_f32_32x32x16_bf16 v[48:63], v[16:19], v[200:203], v[48:63]
  v_mul_f32 v76, s52, v76
  v_mul_f32 v77, s52, v77
  ds_read_b128 v[16:19], v8 offset:33024
  s_waitcnt lgkmcnt(3)
  v_mfma_f32_32x32x16_bf16 v[32:47], v[20:23], v[140:143], v[32:47]
  v_cvt_pk_bf16_f32 v74, v76, v77
  v_mul_f32 v78, s52, v78
  v_mul_f32 v79, s52, v79
  v_mfma_f32_32x32x16_bf16 v[48:63], v[20:23], v[204:207], v[48:63]
  v_cvt_pk_bf16_f32 v75, v78, v79
  v_permlane16_swap_b32 v64, v72
  ds_read_b128 v[20:23], v9 offset:33024
  s_waitcnt lgkmcnt(3)
  v_mfma_f32_32x32x16_bf16 v[32:47], v[24:27], v[144:147], v[32:47]
  v_permlane16_swap_b32 v65, v73
  v_permlane16_swap_b32 v66, v74
  v_permlane16_swap_b32 v67, v75
  v_mfma_f32_32x32x16_bf16 v[48:63], v[24:27], v[208:211], v[48:63]
  v_accvgpr_write_b32 a4, v64
  v_accvgpr_write_b32 a5, v65
  ds_read_b128 v[24:27], v10 offset:33024
  s_waitcnt lgkmcnt(3)
  v_mfma_f32_32x32x16_bf16 v[32:47], v[28:31], v[148:151], v[32:47]
  v_accvgpr_write_b32 a6, v66
  v_accvgpr_write_b32 a7, v67
  v_accvgpr_write_b32 a60, v72
  v_mfma_f32_32x32x16_bf16 v[48:63], v[28:31], v[212:215], v[48:63]
  v_accvgpr_write_b32 a61, v73
  v_accvgpr_write_b32 a62, v74
  ds_read_b128 v[28:31], v11 offset:33024
  s_waitcnt lgkmcnt(3)
  v_mfma_f32_32x32x16_bf16 v[32:47], v[16:19], v[152:155], v[32:47]
  v_accvgpr_write_b32 a63, v75
  v_mul_f32 v80, s52, v80
  v_mul_f32 v81, s52, v81
  v_mfma_f32_32x32x16_bf16 v[48:63], v[16:19], v[216:219], v[48:63]
  v_cvt_pk_bf16_f32 v80, v80, v81
  v_mul_f32 v82, s52, v82
  ds_read_b128 v[16:19], v12 offset:33024
  s_waitcnt lgkmcnt(3)
  v_mfma_f32_32x32x16_bf16 v[32:47], v[20:23], v[156:159], v[32:47]
  v_mul_f32 v83, s52, v83
  v_cvt_pk_bf16_f32 v81, v82, v83
  v_mul_f32 v84, s52, v84
  v_mfma_f32_32x32x16_bf16 v[48:63], v[20:23], v[220:223], v[48:63]
  v_mul_f32 v85, s52, v85
  v_cvt_pk_bf16_f32 v82, v84, v85
  ds_read_b128 v[20:23], v13 offset:33024
  s_waitcnt lgkmcnt(3)
  v_mfma_f32_32x32x16_bf16 v[32:47], v[24:27], v[160:163], v[32:47]
  v_mul_f32 v86, s52, v86
  v_mul_f32 v87, s52, v87
  v_cvt_pk_bf16_f32 v83, v86, v87
  v_mfma_f32_32x32x16_bf16 v[48:63], v[24:27], v[224:227], v[48:63]
  v_mul_f32 v88, s52, v88
  v_mul_f32 v89, s52, v89
  ds_read_b128 v[24:27], v14 offset:33024
  s_waitcnt lgkmcnt(3)
  v_mfma_f32_32x32x16_bf16 v[32:47], v[28:31], v[164:167], v[32:47]
  v_cvt_pk_bf16_f32 v88, v88, v89
  v_mul_f32 v90, s52, v90
  v_mul_f32 v91, s52, v91
  v_mfma_f32_32x32x16_bf16 v[48:63], v[28:31], v[228:231], v[48:63]
  v_cvt_pk_bf16_f32 v89, v90, v91
  v_mul_f32 v92, s52, v92
  ds_read_b128 v[28:31], v15 offset:33024
  s_waitcnt lgkmcnt(3)
  v_mfma_f32_32x32x16_bf16 v[32:47], v[16:19], v[168:171], v[32:47]
  v_mul_f32 v93, s52, v93
  v_cvt_pk_bf16_f32 v90, v92, v93
  v_mul_f32 v94, s52, v94
  v_mfma_f32_32x32x16_bf16 v[48:63], v[16:19], v[232:235], v[48:63]
  v_mul_f32 v95, s52, v95
  v_cvt_pk_bf16_f32 v91, v94, v95
  ds_read_b128 v[16:19], v8 offset:49152
  s_waitcnt lgkmcnt(3)
  v_mfma_f32_32x32x16_bf16 v[32:47], v[20:23], v[172:175], v[32:47]
  v_permlane16_swap_b32 v80, v88
  v_permlane16_swap_b32 v81, v89
  v_permlane16_swap_b32 v82, v90
  v_mfma_f32_32x32x16_bf16 v[48:63], v[20:23], v[236:239], v[48:63]
  v_permlane16_swap_b32 v83, v91
  v_accvgpr_write_b32 a116, v80
  ds_read_b128 v[20:23], v9 offset:49152
  s_waitcnt lgkmcnt(3)
  v_mfma_f32_32x32x16_bf16 v[32:47], v[24:27], v[176:179], v[32:47]
  v_accvgpr_write_b32 a117, v81
  v_accvgpr_write_b32 a118, v82
  v_accvgpr_write_b32 a119, v83
  v_mfma_f32_32x32x16_bf16 v[48:63], v[24:27], v[240:243], v[48:63]
  v_accvgpr_write_b32 a172, v88
  v_accvgpr_write_b32 a173, v89
  ds_read_b128 v[24:27], v10 offset:49152
  s_waitcnt lgkmcnt(3)
  v_mfma_f32_32x32x16_bf16 v[32:47], v[28:31], v[180:183], v[32:47]
  v_accvgpr_write_b32 a174, v90
  v_accvgpr_write_b32 a175, v91
  v_mfma_f32_32x32x16_bf16 v[48:63], v[28:31], v[244:247], v[48:63]
  s_waitcnt vmcnt(16)
  s_barrier
  ds_read_b128 v[28:31], v11 offset:49152
  s_waitcnt lgkmcnt(3)
  v_mfma_f32_32x32x16_bf16 v[64:79], v[16:19], v[120:123], 0
  s_add_u32 s22, s27, 2621440
  s_add_u32 m0, s25, 16384
  s_nop 0
  buffer_load_dwordx4 v4, s[56:59], s22 offen offset:0 lds
  v_mfma_f32_32x32x16_bf16 v[80:95], v[16:19], v[184:187], 0
  ds_read_b128 v[16:19], v12 offset:49152
  s_waitcnt lgkmcnt(3)
  v_mfma_f32_32x32x16_bf16 v[64:79], v[20:23], v[124:127], v[64:79]
  buffer_load_dwordx4 v5, s[56:59], s22 offen offset:1024 lds
  v_mul_f32 v32, s52, v32
  v_mul_f32 v33, s52, v33
  v_cvt_pk_bf16_f32 v32, v32, v33
  v_mfma_f32_32x32x16_bf16 v[80:95], v[20:23], v[188:191], v[80:95]
  v_mul_f32 v34, s52, v34
  v_mul_f32 v35, s52, v35
  ds_read_b128 v[20:23], v13 offset:49152
  s_waitcnt lgkmcnt(3)
  v_mfma_f32_32x32x16_bf16 v[64:79], v[24:27], v[128:131], v[64:79]
  buffer_load_dwordx4 v6, s[56:59], s22 offen offset:2048 lds
  v_cvt_pk_bf16_f32 v33, v34, v35
  v_mul_f32 v36, s52, v36
  v_mul_f32 v37, s52, v37
  v_mfma_f32_32x32x16_bf16 v[80:95], v[24:27], v[192:195], v[80:95]
  v_cvt_pk_bf16_f32 v34, v36, v37
  v_mul_f32 v38, s52, v38
  ds_read_b128 v[24:27], v14 offset:49152
  s_waitcnt lgkmcnt(3)
  v_mfma_f32_32x32x16_bf16 v[64:79], v[28:31], v[132:135], v[64:79]
  buffer_load_dwordx4 v7, s[56:59], s22 offen offset:3072 lds
  v_mul_f32 v39, s52, v39
  v_cvt_pk_bf16_f32 v35, v38, v39
  v_mul_f32 v40, s52, v40
  v_mfma_f32_32x32x16_bf16 v[80:95], v[28:31], v[196:199], v[80:95]
  v_mul_f32 v41, s52, v41
  v_cvt_pk_bf16_f32 v40, v40, v41
  ds_read_b128 v[28:31], v15 offset:49152
  s_waitcnt lgkmcnt(3)
  v_mfma_f32_32x32x16_bf16 v[64:79], v[16:19], v[136:139], v[64:79]
  s_add_u32 s22, s27, 2883584
  s_add_u32 m0, s25, 32768
  s_nop 0
  buffer_load_dwordx4 v4, s[56:59], s22 offen offset:0 lds
  v_mul_f32 v42, s52, v42
  v_mul_f32 v43, s52, v43
  v_cvt_pk_bf16_f32 v41, v42, v43
  v_mfma_f32_32x32x16_bf16 v[80:95], v[16:19], v[200:203], v[80:95]
  v_mul_f32 v44, s52, v44
  v_mul_f32 v45, s52, v45
  ds_read_b128 v[16:19], v8 offset:49408
  s_waitcnt lgkmcnt(3)
  v_mfma_f32_32x32x16_bf16 v[64:79], v[20:23], v[140:143], v[64:79]
  buffer_load_dwordx4 v5, s[56:59], s22 offen offset:1024 lds
  v_cvt_pk_bf16_f32 v42, v44, v45
  v_mul_f32 v46, s52, v46
  v_mul_f32 v47, s52, v47
  v_mfma_f32_32x32x16_bf16 v[80:95], v[20:23], v[204:207], v[80:95]
  v_cvt_pk_bf16_f32 v43, v46, v47
  v_permlane16_swap_b32 v32, v40
  ds_read_b128 v[20:23], v9 offset:49408
  s_waitcnt lgkmcnt(3)
  v_mfma_f32_32x32x16_bf16 v[64:79], v[24:27], v[144:147], v[64:79]
  buffer_load_dwordx4 v6, s[56:59], s22 offen offset:2048 lds
  v_permlane16_swap_b32 v33, v41
  v_permlane16_swap_b32 v34, v42
  v_permlane16_swap_b32 v35, v43
  v_mfma_f32_32x32x16_bf16 v[80:95], v[24:27], v[208:211], v[80:95]
  v_accvgpr_write_b32 a8, v32
  v_accvgpr_write_b32 a9, v33
  ds_read_b128 v[24:27], v10 offset:49408
  s_waitcnt lgkmcnt(3)
  v_mfma_f32_32x32x16_bf16 v[64:79], v[28:31], v[148:151], v[64:79]
  buffer_load_dwordx4 v7, s[56:59], s22 offen offset:3072 lds
  v_accvgpr_write_b32 a10, v34
  v_accvgpr_write_b32 a11, v35
  v_accvgpr_write_b32 a64, v40
  v_mfma_f32_32x32x16_bf16 v[80:95], v[28:31], v[212:215], v[80:95]
  v_accvgpr_write_b32 a65, v41
  v_accvgpr_write_b32 a66, v42
  ds_read_b128 v[28:31], v11 offset:49408
  s_waitcnt lgkmcnt(3)
  v_mfma_f32_32x32x16_bf16 v[64:79], v[16:19], v[152:155], v[64:79]
  v_accvgpr_write_b32 a67, v43
  v_mul_f32 v48, s52, v48
  v_mul_f32 v49, s52, v49
  v_mfma_f32_32x32x16_bf16 v[80:95], v[16:19], v[216:219], v[80:95]
  v_cvt_pk_bf16_f32 v48, v48, v49
  v_mul_f32 v50, s52, v50
  ds_read_b128 v[16:19], v12 offset:49408
  s_waitcnt lgkmcnt(3)
  v_mfma_f32_32x32x16_bf16 v[64:79], v[20:23], v[156:159], v[64:79]
  v_mul_f32 v51, s52, v51
  v_cvt_pk_bf16_f32 v49, v50, v51
  v_mul_f32 v52, s52, v52
  v_mfma_f32_32x32x16_bf16 v[80:95], v[20:23], v[220:223], v[80:95]
  v_mul_f32 v53, s52, v53
  v_cvt_pk_bf16_f32 v50, v52, v53
  ds_read_b128 v[20:23], v13 offset:49408
  s_waitcnt lgkmcnt(3)
  v_mfma_f32_32x32x16_bf16 v[64:79], v[24:27], v[160:163], v[64:79]
  v_mul_f32 v54, s52, v54
  v_mul_f32 v55, s52, v55
  v_cvt_pk_bf16_f32 v51, v54, v55
  v_mfma_f32_32x32x16_bf16 v[80:95], v[24:27], v[224:227], v[80:95]
  v_mul_f32 v56, s52, v56
  v_mul_f32 v57, s52, v57
  ds_read_b128 v[24:27], v14 offset:49408
  s_waitcnt lgkmcnt(3)
  v_mfma_f32_32x32x16_bf16 v[64:79], v[28:31], v[164:167], v[64:79]
  v_cvt_pk_bf16_f32 v56, v56, v57
  v_mul_f32 v58, s52, v58
  v_mul_f32 v59, s52, v59
  v_mfma_f32_32x32x16_bf16 v[80:95], v[28:31], v[228:231], v[80:95]
  v_cvt_pk_bf16_f32 v57, v58, v59
  v_mul_f32 v60, s52, v60
  ds_read_b128 v[28:31], v15 offset:49408
  s_waitcnt lgkmcnt(3)
  v_mfma_f32_32x32x16_bf16 v[64:79], v[16:19], v[168:171], v[64:79]
  v_mul_f32 v61, s52, v61
  v_cvt_pk_bf16_f32 v58, v60, v61
  v_mul_f32 v62, s52, v62
  v_mfma_f32_32x32x16_bf16 v[80:95], v[16:19], v[232:235], v[80:95]
  v_mul_f32 v63, s52, v63
  v_cvt_pk_bf16_f32 v59, v62, v63
  v_xor_b32 v8, 65536, v8
  ds_read_b128 v[16:19], v8 offset:0
  s_waitcnt lgkmcnt(3)
  v_mfma_f32_32x32x16_bf16 v[64:79], v[20:23], v[172:175], v[64:79]
  v_permlane16_swap_b32 v48, v56
  v_permlane16_swap_b32 v49, v57
  v_permlane16_swap_b32 v50, v58
  v_mfma_f32_32x32x16_bf16 v[80:95], v[20:23], v[236:239], v[80:95]
  v_permlane16_swap_b32 v51, v59
  v_accvgpr_write_b32 a120, v48
  v_xor_b32 v9, 65536, v9
  ds_read_b128 v[20:23], v9 offset:0
  s_waitcnt lgkmcnt(3)
  v_mfma_f32_32x32x16_bf16 v[64:79], v[24:27], v[176:179], v[64:79]
  v_accvgpr_write_b32 a121, v49
  v_accvgpr_write_b32 a122, v50
  v_accvgpr_write_b32 a123, v51
  v_mfma_f32_32x32x16_bf16 v[80:95], v[24:27], v[240:243], v[80:95]
  v_accvgpr_write_b32 a176, v56
  v_accvgpr_write_b32 a177, v57
  v_xor_b32 v10, 65536, v10
  ds_read_b128 v[24:27], v10 offset:0
  s_waitcnt lgkmcnt(3)
  v_mfma_f32_32x32x16_bf16 v[64:79], v[28:31], v[180:183], v[64:79]
  v_accvgpr_write_b32 a178, v58
  v_accvgpr_write_b32 a179, v59
  v_mfma_f32_32x32x16_bf16 v[80:95], v[28:31], v[244:247], v[80:95]
  v_xor_b32 v11, 65536, v11
  ds_read_b128 v[28:31], v11 offset:0
  s_waitcnt lgkmcnt(3)
  v_mfma_f32_32x32x16_bf16 v[32:47], v[16:19], v[120:123], 0
  v_mfma_f32_32x32x16_bf16 v[48:63], v[16:19], v[184:187], 0
  v_xor_b32 v12, 65536, v12
  ds_read_b128 v[16:19], v12 offset:0
  s_waitcnt lgkmcnt(3)
  v_mfma_f32_32x32x16_bf16 v[32:47], v[20:23], v[124:127], v[32:47]
  v_mul_f32 v64, s52, v64
  v_mul_f32 v65, s52, v65
  v_cvt_pk_bf16_f32 v64, v64, v65
  v_mfma_f32_32x32x16_bf16 v[48:63], v[20:23], v[188:191], v[48:63]
  v_mul_f32 v66, s52, v66
  v_mul_f32 v67, s52, v67
  v_xor_b32 v13, 65536, v13
  ds_read_b128 v[20:23], v13 offset:0
  s_waitcnt lgkmcnt(3)
  v_mfma_f32_32x32x16_bf16 v[32:47], v[24:27], v[128:131], v[32:47]
  v_cvt_pk_bf16_f32 v65, v66, v67
  v_mul_f32 v68, s52, v68
  v_mul_f32 v69, s52, v69
  v_mfma_f32_32x32x16_bf16 v[48:63], v[24:27], v[192:195], v[48:63]
  v_cvt_pk_bf16_f32 v66, v68, v69
  v_mul_f32 v70, s52, v70
  v_xor_b32 v14, 65536, v14
  ds_read_b128 v[24:27], v14 offset:0
  s_waitcnt lgkmcnt(3)
  v_mfma_f32_32x32x16_bf16 v[32:47], v[28:31], v[132:135], v[32:47]
  v_mul_f32 v71, s52, v71
  v_cvt_pk_bf16_f32 v67, v70, v71
  v_mul_f32 v72, s52, v72
  v_mfma_f32_32x32x16_bf16 v[48:63], v[28:31], v[196:199], v[48:63]
  v_mul_f32 v73, s52, v73
  v_cvt_pk_bf16_f32 v72, v72, v73
  v_xor_b32 v15, 65536, v15
  ds_read_b128 v[28:31], v15 offset:0
  s_waitcnt lgkmcnt(3)
  v_mfma_f32_32x32x16_bf16 v[32:47], v[16:19], v[136:139], v[32:47]
  v_mul_f32 v74, s52, v74
  v_mul_f32 v75, s52, v75
  v_cvt_pk_bf16_f32 v73, v74, v75
  v_mfma_f32_32x32x16_bf16 v[48:63], v[16:19], v[200:203], v[48:63]
  v_mul_f32 v76, s52, v76
  v_mul_f32 v77, s52, v77
  ds_read_b128 v[16:19], v8 offset:256
  s_waitcnt lgkmcnt(3)
  v_mfma_f32_32x32x16_bf16 v[32:47], v[20:23], v[140:143], v[32:47]
  v_cvt_pk_bf16_f32 v74, v76, v77
  v_mul_f32 v78, s52, v78
  v_mul_f32 v79, s52, v79
  v_mfma_f32_32x32x16_bf16 v[48:63], v[20:23], v[204:207], v[48:63]
  v_cvt_pk_bf16_f32 v75, v78, v79
  v_permlane16_swap_b32 v64, v72
  ds_read_b128 v[20:23], v9 offset:256
  s_waitcnt lgkmcnt(3)
  v_mfma_f32_32x32x16_bf16 v[32:47], v[24:27], v[144:147], v[32:47]
  v_permlane16_swap_b32 v65, v73
  v_permlane16_swap_b32 v66, v74
  v_permlane16_swap_b32 v67, v75
  v_mfma_f32_32x32x16_bf16 v[48:63], v[24:27], v[208:211], v[48:63]
  v_accvgpr_write_b32 a12, v64
  v_accvgpr_write_b32 a13, v65
  ds_read_b128 v[24:27], v10 offset:256
  s_waitcnt lgkmcnt(3)
  v_mfma_f32_32x32x16_bf16 v[32:47], v[28:31], v[148:151], v[32:47]
  v_accvgpr_write_b32 a14, v66
  v_accvgpr_write_b32 a15, v67
  v_accvgpr_write_b32 a68, v72
  v_mfma_f32_32x32x16_bf16 v[48:63], v[28:31], v[212:215], v[48:63]
  v_accvgpr_write_b32 a69, v73
  v_accvgpr_write_b32 a70, v74
  ds_read_b128 v[28:31], v11 offset:256
  s_waitcnt lgkmcnt(3)
  v_mfma_f32_32x32x16_bf16 v[32:47], v[16:19], v[152:155], v[32:47]
  v_accvgpr_write_b32 a71, v75
  v_mul_f32 v80, s52, v80
  v_mul_f32 v81, s52, v81
  v_mfma_f32_32x32x16_bf16 v[48:63], v[16:19], v[216:219], v[48:63]
  v_cvt_pk_bf16_f32 v80, v80, v81
  v_mul_f32 v82, s52, v82
  ds_read_b128 v[16:19], v12 offset:256
  s_waitcnt lgkmcnt(3)
  v_mfma_f32_32x32x16_bf16 v[32:47], v[20:23], v[156:159], v[32:47]
  v_mul_f32 v83, s52, v83
  v_cvt_pk_bf16_f32 v81, v82, v83
  v_mul_f32 v84, s52, v84
  v_mfma_f32_32x32x16_bf16 v[48:63], v[20:23], v[220:223], v[48:63]
  v_mul_f32 v85, s52, v85
  v_cvt_pk_bf16_f32 v82, v84, v85
  ds_read_b128 v[20:23], v13 offset:256
  s_waitcnt lgkmcnt(3)
  v_mfma_f32_32x32x16_bf16 v[32:47], v[24:27], v[160:163], v[32:47]
  v_mul_f32 v86, s52, v86
  v_mul_f32 v87, s52, v87
  v_cvt_pk_bf16_f32 v83, v86, v87
  v_mfma_f32_32x32x16_bf16 v[48:63], v[24:27], v[224:227], v[48:63]
  v_mul_f32 v88, s52, v88
  v_mul_f32 v89, s52, v89
  ds_read_b128 v[24:27], v14 offset:256
  s_waitcnt lgkmcnt(3)
  v_mfma_f32_32x32x16_bf16 v[32:47], v[28:31], v[164:167], v[32:47]
  v_cvt_pk_bf16_f32 v88, v88, v89
  v_mul_f32 v90, s52, v90
  v_mul_f32 v91, s52, v91
  v_mfma_f32_32x32x16_bf16 v[48:63], v[28:31], v[228:231], v[48:63]
  v_cvt_pk_bf16_f32 v89, v90, v91
  v_mul_f32 v92, s52, v92
  ds_read_b128 v[28:31], v15 offset:256
  s_waitcnt lgkmcnt(3)
  v_mfma_f32_32x32x16_bf16 v[32:47], v[16:19], v[168:171], v[32:47]
  v_mul_f32 v93, s52, v93
  v_cvt_pk_bf16_f32 v90, v92, v93
  v_mul_f32 v94, s52, v94
  v_mfma_f32_32x32x16_bf16 v[48:63], v[16:19], v[232:235], v[48:63]
  v_mul_f32 v95, s52, v95
  v_cvt_pk_bf16_f32 v91, v94, v95
  ds_read_b128 v[16:19], v8 offset:16384
  s_waitcnt lgkmcnt(3)
  v_mfma_f32_32x32x16_bf16 v[32:47], v[20:23], v[172:175], v[32:47]
  v_permlane16_swap_b32 v80, v88
  v_permlane16_swap_b32 v81, v89
  v_permlane16_swap_b32 v82, v90
  v_mfma_f32_32x32x16_bf16 v[48:63], v[20:23], v[236:239], v[48:63]
  v_permlane16_swap_b32 v83, v91
  v_accvgpr_write_b32 a124, v80
  ds_read_b128 v[20:23], v9 offset:16384
  s_waitcnt lgkmcnt(3)
  v_mfma_f32_32x32x16_bf16 v[32:47], v[24:27], v[176:179], v[32:47]
  v_accvgpr_write_b32 a125, v81
  v_accvgpr_write_b32 a126, v82
  v_accvgpr_write_b32 a127, v83
  v_mfma_f32_32x32x16_bf16 v[48:63], v[24:27], v[240:243], v[48:63]
  v_accvgpr_write_b32 a180, v88
  v_accvgpr_write_b32 a181, v89
  ds_read_b128 v[24:27], v10 offset:16384
  s_waitcnt lgkmcnt(3)
  v_mfma_f32_32x32x16_bf16 v[32:47], v[28:31], v[180:183], v[32:47]
  v_accvgpr_write_b32 a182, v90
  v_accvgpr_write_b32 a183, v91
  v_mfma_f32_32x32x16_bf16 v[48:63], v[28:31], v[244:247], v[48:63]
  s_waitcnt vmcnt(16)
  s_barrier
  ds_read_b128 v[28:31], v11 offset:16384
  s_waitcnt lgkmcnt(3)
  v_mfma_f32_32x32x16_bf16 v[64:79], v[16:19], v[120:123], 0
  s_add_u32 s22, s27, 3145728
  s_add_u32 m0, s25, 49152
  s_nop 0
  buffer_load_dwordx4 v4, s[56:59], s22 offen offset:0 lds
  v_mfma_f32_32x32x16_bf16 v[80:95], v[16:19], v[184:187], 0
  ds_read_b128 v[16:19], v12 offset:16384
  s_waitcnt lgkmcnt(3)
  v_mfma_f32_32x32x16_bf16 v[64:79], v[20:23], v[124:127], v[64:79]
  buffer_load_dwordx4 v5, s[56:59], s22 offen offset:1024 lds
  v_mul_f32 v32, s52, v32
  v_mul_f32 v33, s52, v33
  v_cvt_pk_bf16_f32 v32, v32, v33
  v_mfma_f32_32x32x16_bf16 v[80:95], v[20:23], v[188:191], v[80:95]
  v_mul_f32 v34, s52, v34
  v_mul_f32 v35, s52, v35
  ds_read_b128 v[20:23], v13 offset:16384
  s_waitcnt lgkmcnt(3)
  v_mfma_f32_32x32x16_bf16 v[64:79], v[24:27], v[128:131], v[64:79]
  buffer_load_dwordx4 v6, s[56:59], s22 offen offset:2048 lds
  v_cvt_pk_bf16_f32 v33, v34, v35
  v_mul_f32 v36, s52, v36
  v_mul_f32 v37, s52, v37
  v_mfma_f32_32x32x16_bf16 v[80:95], v[24:27], v[192:195], v[80:95]
  v_cvt_pk_bf16_f32 v34, v36, v37
  v_mul_f32 v38, s52, v38
  ds_read_b128 v[24:27], v14 offset:16384
  s_waitcnt lgkmcnt(3)
  v_mfma_f32_32x32x16_bf16 v[64:79], v[28:31], v[132:135], v[64:79]
  buffer_load_dwordx4 v7, s[56:59], s22 offen offset:3072 lds
  v_mul_f32 v39, s52, v39
  v_cvt_pk_bf16_f32 v35, v38, v39
  v_mul_f32 v40, s52, v40
  v_mfma_f32_32x32x16_bf16 v[80:95], v[28:31], v[196:199], v[80:95]
  v_mul_f32 v41, s52, v41
  v_cvt_pk_bf16_f32 v40, v40, v41
  ds_read_b128 v[28:31], v15 offset:16384
  s_waitcnt lgkmcnt(3)
  v_mfma_f32_32x32x16_bf16 v[64:79], v[16:19], v[136:139], v[64:79]
  s_add_u32 s22, s27, 3407872
  s_add_u32 m0, s25, 65536
  s_nop 0
  buffer_load_dwordx4 v4, s[56:59], s22 offen offset:0 lds
  v_mul_f32 v42, s52, v42
  v_mul_f32 v43, s52, v43
  v_cvt_pk_bf16_f32 v41, v42, v43
  v_mfma_f32_32x32x16_bf16 v[80:95], v[16:19], v[200:203], v[80:95]
  v_mul_f32 v44, s52, v44
  v_mul_f32 v45, s52, v45
  ds_read_b128 v[16:19], v8 offset:16640
  s_waitcnt lgkmcnt(3)
  v_mfma_f32_32x32x16_bf16 v[64:79], v[20:23], v[140:143], v[64:79]
  buffer_load_dwordx4 v5, s[56:59], s22 offen offset:1024 lds
  v_cvt_pk_bf16_f32 v42, v44, v45
  v_mul_f32 v46, s52, v46
  v_mul_f32 v47, s52, v47
  v_mfma_f32_32x32x16_bf16 v[80:95], v[20:23], v[204:207], v[80:95]
  v_cvt_pk_bf16_f32 v43, v46, v47
  v_permlane16_swap_b32 v32, v40
  ds_read_b128 v[20:23], v9 offset:16640
  s_waitcnt lgkmcnt(3)
  v_mfma_f32_32x32x16_bf16 v[64:79], v[24:27], v[144:147], v[64:79]
  buffer_load_dwordx4 v6, s[56:59], s22 offen offset:2048 lds
  v_permlane16_swap_b32 v33, v41
  v_permlane16_swap_b32 v34, v42
  v_permlane16_swap_b32 v35, v43
  v_mfma_f32_32x32x16_bf16 v[80:95], v[24:27], v[208:211], v[80:95]
  v_accvgpr_write_b32 a16, v32
  v_accvgpr_write_b32 a17, v33
  ds_read_b128 v[24:27], v10 offset:16640
  s_waitcnt lgkmcnt(3)
  v_mfma_f32_32x32x16_bf16 v[64:79], v[28:31], v[148:151], v[64:79]
  buffer_load_dwordx4 v7, s[56:59], s22 offen offset:3072 lds
  v_accvgpr_write_b32 a18, v34
  v_accvgpr_write_b32 a19, v35
  v_accvgpr_write_b32 a72, v40
  v_mfma_f32_32x32x16_bf16 v[80:95], v[28:31], v[212:215], v[80:95]
  v_accvgpr_write_b32 a73, v41
  v_accvgpr_write_b32 a74, v42
  ds_read_b128 v[28:31], v11 offset:16640
  s_waitcnt lgkmcnt(3)
  v_mfma_f32_32x32x16_bf16 v[64:79], v[16:19], v[152:155], v[64:79]
  v_accvgpr_write_b32 a75, v43
  v_mul_f32 v48, s52, v48
  v_mul_f32 v49, s52, v49
  v_mfma_f32_32x32x16_bf16 v[80:95], v[16:19], v[216:219], v[80:95]
  v_cvt_pk_bf16_f32 v48, v48, v49
  v_mul_f32 v50, s52, v50
  ds_read_b128 v[16:19], v12 offset:16640
  s_waitcnt lgkmcnt(3)
  v_mfma_f32_32x32x16_bf16 v[64:79], v[20:23], v[156:159], v[64:79]
  v_mul_f32 v51, s52, v51
  v_cvt_pk_bf16_f32 v49, v50, v51
  v_mul_f32 v52, s52, v52
  v_mfma_f32_32x32x16_bf16 v[80:95], v[20:23], v[220:223], v[80:95]
  v_mul_f32 v53, s52, v53
  v_cvt_pk_bf16_f32 v50, v52, v53
  ds_read_b128 v[20:23], v13 offset:16640
  s_waitcnt lgkmcnt(3)
  v_mfma_f32_32x32x16_bf16 v[64:79], v[24:27], v[160:163], v[64:79]
  v_mul_f32 v54, s52, v54
  v_mul_f32 v55, s52, v55
  v_cvt_pk_bf16_f32 v51, v54, v55
  v_mfma_f32_32x32x16_bf16 v[80:95], v[24:27], v[224:227], v[80:95]
  v_mul_f32 v56, s52, v56
  v_mul_f32 v57, s52, v57
  ds_read_b128 v[24:27], v14 offset:16640
  s_waitcnt lgkmcnt(3)
  v_mfma_f32_32x32x16_bf16 v[64:79], v[28:31], v[164:167], v[64:79]
  v_cvt_pk_bf16_f32 v56, v56, v57
  v_mul_f32 v58, s52, v58
  v_mul_f32 v59, s52, v59
  v_mfma_f32_32x32x16_bf16 v[80:95], v[28:31], v[228:231], v[80:95]
  v_cvt_pk_bf16_f32 v57, v58, v59
  v_mul_f32 v60, s52, v60
  ds_read_b128 v[28:31], v15 offset:16640
  s_waitcnt lgkmcnt(3)
  v_mfma_f32_32x32x16_bf16 v[64:79], v[16:19], v[168:171], v[64:79]
  v_mul_f32 v61, s52, v61
  v_cvt_pk_bf16_f32 v58, v60, v61
  v_mul_f32 v62, s52, v62
  v_mfma_f32_32x32x16_bf16 v[80:95], v[16:19], v[232:235], v[80:95]
  v_mul_f32 v63, s52, v63
  v_cvt_pk_bf16_f32 v59, v62, v63
  ds_read_b128 v[16:19], v8 offset:32768
  s_waitcnt lgkmcnt(3)
  v_mfma_f32_32x32x16_bf16 v[64:79], v[20:23], v[172:175], v[64:79]
  v_permlane16_swap_b32 v48, v56
  v_permlane16_swap_b32 v49, v57
  v_permlane16_swap_b32 v50, v58
  v_mfma_f32_32x32x16_bf16 v[80:95], v[20:23], v[236:239], v[80:95]
  v_permlane16_swap_b32 v51, v59
  v_accvgpr_write_b32 a128, v48
  ds_read_b128 v[20:23], v9 offset:32768
  s_waitcnt lgkmcnt(3)
  v_mfma_f32_32x32x16_bf16 v[64:79], v[24:27], v[176:179], v[64:79]
  v_accvgpr_write_b32 a129, v49
  v_accvgpr_write_b32 a130, v50
  v_accvgpr_write_b32 a131, v51
  v_mfma_f32_32x32x16_bf16 v[80:95], v[24:27], v[240:243], v[80:95]
  v_accvgpr_write_b32 a184, v56
  v_accvgpr_write_b32 a185, v57
  ds_read_b128 v[24:27], v10 offset:32768
  s_waitcnt lgkmcnt(3)
  v_mfma_f32_32x32x16_bf16 v[64:79], v[28:31], v[180:183], v[64:79]
  v_accvgpr_write_b32 a186, v58
  v_accvgpr_write_b32 a187, v59
  v_mfma_f32_32x32x16_bf16 v[80:95], v[28:31], v[244:247], v[80:95]
  ds_read_b128 v[28:31], v11 offset:32768
  s_waitcnt lgkmcnt(3)
  v_mfma_f32_32x32x16_bf16 v[32:47], v[16:19], v[120:123], 0
  v_mfma_f32_32x32x16_bf16 v[48:63], v[16:19], v[184:187], 0
  ds_read_b128 v[16:19], v12 offset:32768
  s_waitcnt lgkmcnt(3)
  v_mfma_f32_32x32x16_bf16 v[32:47], v[20:23], v[124:127], v[32:47]
  v_mul_f32 v64, s52, v64
  v_mul_f32 v65, s52, v65
  v_cvt_pk_bf16_f32 v64, v64, v65
  v_mfma_f32_32x32x16_bf16 v[48:63], v[20:23], v[188:191], v[48:63]
  v_mul_f32 v66, s52, v66
  v_mul_f32 v67, s52, v67
  ds_read_b128 v[20:23], v13 offset:32768
  s_waitcnt lgkmcnt(3)
  v_mfma_f32_32x32x16_bf16 v[32:47], v[24:27], v[128:131], v[32:47]
  v_cvt_pk_bf16_f32 v65, v66, v67
  v_mul_f32 v68, s52, v68
  v_mul_f32 v69, s52, v69
  v_mfma_f32_32x32x16_bf16 v[48:63], v[24:27], v[192:195], v[48:63]
  v_cvt_pk_bf16_f32 v66, v68, v69
  v_mul_f32 v70, s52, v70
  ds_read_b128 v[24:27], v14 offset:32768
  s_waitcnt lgkmcnt(3)
  v_mfma_f32_32x32x16_bf16 v[32:47], v[28:31], v[132:135], v[32:47]
  v_mul_f32 v71, s52, v71
  v_cvt_pk_bf16_f32 v67, v70, v71
  v_mul_f32 v72, s52, v72
  v_mfma_f32_32x32x16_bf16 v[48:63], v[28:31], v[196:199], v[48:63]
  v_mul_f32 v73, s52, v73
  v_cvt_pk_bf16_f32 v72, v72, v73
  ds_read_b128 v[28:31], v15 offset:32768
  s_waitcnt lgkmcnt(3)
  v_mfma_f32_32x32x16_bf16 v[32:47], v[16:19], v[136:139], v[32:47]
  v_mul_f32 v74, s52, v74
  v_mul_f32 v75, s52, v75
  v_cvt_pk_bf16_f32 v73, v74, v75
  v_mfma_f32_32x32x16_bf16 v[48:63], v[16:19], v[200:203], v[48:63]
  v_mul_f32 v76, s52, v76
  v_mul_f32 v77, s52, v77
  ds_read_b128 v[16:19], v8 offset:33024
  s_waitcnt lgkmcnt(3)
  v_mfma_f32_32x32x16_bf16 v[32:47], v[20:23], v[140:143], v[32:47]
  v_cvt_pk_bf16_f32 v74, v76, v77
  v_mul_f32 v78, s52, v78
  v_mul_f32 v79, s52, v79
  v_mfma_f32_32x32x16_bf16 v[48:63], v[20:23], v[204:207], v[48:63]
  v_cvt_pk_bf16_f32 v75, v78, v79
  v_permlane16_swap_b32 v64, v72
  ds_read_b128 v[20:23], v9 offset:33024
  s_waitcnt lgkmcnt(3)
  v_mfma_f32_32x32x16_bf16 v[32:47], v[24:27], v[144:147], v[32:47]
  v_permlane16_swap_b32 v65, v73
  v_permlane16_swap_b32 v66, v74
  v_permlane16_swap_b32 v67, v75
  v_mfma_f32_32x32x16_bf16 v[48:63], v[24:27], v[208:211], v[48:63]
  v_accvgpr_write_b32 a20, v64
  v_accvgpr_write_b32 a21, v65
  ds_read_b128 v[24:27], v10 offset:33024
  s_waitcnt lgkmcnt(3)
  v_mfma_f32_32x32x16_bf16 v[32:47], v[28:31], v[148:151], v[32:47]
  v_accvgpr_write_b32 a22, v66
  v_accvgpr_write_b32 a23, v67
  v_accvgpr_write_b32 a76, v72
  v_mfma_f32_32x32x16_bf16 v[48:63], v[28:31], v[212:215], v[48:63]
  v_accvgpr_write_b32 a77, v73
  v_accvgpr_write_b32 a78, v74
  ds_read_b128 v[28:31], v11 offset:33024
  s_waitcnt lgkmcnt(3)
  v_mfma_f32_32x32x16_bf16 v[32:47], v[16:19], v[152:155], v[32:47]
  v_accvgpr_write_b32 a79, v75
  v_mul_f32 v80, s52, v80
  v_mul_f32 v81, s52, v81
  v_mfma_f32_32x32x16_bf16 v[48:63], v[16:19], v[216:219], v[48:63]
  v_cvt_pk_bf16_f32 v80, v80, v81
  v_mul_f32 v82, s52, v82
  ds_read_b128 v[16:19], v12 offset:33024
  s_waitcnt lgkmcnt(3)
  v_mfma_f32_32x32x16_bf16 v[32:47], v[20:23], v[156:159], v[32:47]
  v_mul_f32 v83, s52, v83
  v_cvt_pk_bf16_f32 v81, v82, v83
  v_mul_f32 v84, s52, v84
  v_mfma_f32_32x32x16_bf16 v[48:63], v[20:23], v[220:223], v[48:63]
  v_mul_f32 v85, s52, v85
  v_cvt_pk_bf16_f32 v82, v84, v85
  ds_read_b128 v[20:23], v13 offset:33024
  s_waitcnt lgkmcnt(3)
  v_mfma_f32_32x32x16_bf16 v[32:47], v[24:27], v[160:163], v[32:47]
  v_mul_f32 v86, s52, v86
  v_mul_f32 v87, s52, v87
  v_cvt_pk_bf16_f32 v83, v86, v87
  v_mfma_f32_32x32x16_bf16 v[48:63], v[24:27], v[224:227], v[48:63]
  v_mul_f32 v88, s52, v88
  v_mul_f32 v89, s52, v89
  ds_read_b128 v[24:27], v14 offset:33024
  s_waitcnt lgkmcnt(3)
  v_mfma_f32_32x32x16_bf16 v[32:47], v[28:31], v[164:167], v[32:47]
  v_cvt_pk_bf16_f32 v88, v88, v89
  v_mul_f32 v90, s52, v90
  v_mul_f32 v91, s52, v91
  v_mfma_f32_32x32x16_bf16 v[48:63], v[28:31], v[228:231], v[48:63]
  v_cvt_pk_bf16_f32 v89, v90, v91
  v_mul_f32 v92, s52, v92
  ds_read_b128 v[28:31], v15 offset:33024
  s_waitcnt lgkmcnt(3)
  v_mfma_f32_32x32x16_bf16 v[32:47], v[16:19], v[168:171], v[32:47]
  v_mul_f32 v93, s52, v93
  v_cvt_pk_bf16_f32 v90, v92, v93
  v_mul_f32 v94, s52, v94
  v_mfma_f32_32x32x16_bf16 v[48:63], v[16:19], v[232:235], v[48:63]
  v_mul_f32 v95, s52, v95
  v_cvt_pk_bf16_f32 v91, v94, v95
  ds_read_b128 v[16:19], v8 offset:49152
  s_waitcnt lgkmcnt(3)
  v_mfma_f32_32x32x16_bf16 v[32:47], v[20:23], v[172:175], v[32:47]
  v_permlane16_swap_b32 v80, v88
  v_permlane16_swap_b32 v81, v89
  v_permlane16_swap_b32 v82, v90
  v_mfma_f32_32x32x16_bf16 v[48:63], v[20:23], v[236:239], v[48:63]
  v_permlane16_swap_b32 v83, v91
  v_accvgpr_write_b32 a132, v80
  ds_read_b128 v[20:23], v9 offset:49152
  s_waitcnt lgkmcnt(3)
  v_mfma_f32_32x32x16_bf16 v[32:47], v[24:27], v[176:179], v[32:47]
  v_accvgpr_write_b32 a133, v81
  v_accvgpr_write_b32 a134, v82
  v_accvgpr_write_b32 a135, v83
  v_mfma_f32_32x32x16_bf16 v[48:63], v[24:27], v[240:243], v[48:63]
  v_accvgpr_write_b32 a188, v88
  v_accvgpr_write_b32 a189, v89
  ds_read_b128 v[24:27], v10 offset:49152
  s_waitcnt lgkmcnt(3)
  v_mfma_f32_32x32x16_bf16 v[32:47], v[28:31], v[180:183], v[32:47]
  v_accvgpr_write_b32 a190, v90
  v_accvgpr_write_b32 a191, v91
  v_mfma_f32_32x32x16_bf16 v[48:63], v[28:31], v[244:247], v[48:63]
  s_waitcnt vmcnt(16)
  s_barrier
  ds_read_b128 v[28:31], v11 offset:49152
  s_waitcnt lgkmcnt(3)
  v_mfma_f32_32x32x16_bf16 v[64:79], v[16:19], v[120:123], 0
  v_mfma_f32_32x32x16_bf16 v[80:95], v[16:19], v[184:187], 0
  ds_read_b128 v[16:19], v12 offset:49152
  s_waitcnt lgkmcnt(3)
  v_mfma_f32_32x32x16_bf16 v[64:79], v[20:23], v[124:127], v[64:79]
  v_mul_f32 v32, s52, v32
  v_mul_f32 v33, s52, v33
  v_cvt_pk_bf16_f32 v32, v32, v33
  v_mfma_f32_32x32x16_bf16 v[80:95], v[20:23], v[188:191], v[80:95]
  v_mul_f32 v34, s52, v34
  v_mul_f32 v35, s52, v35
  ds_read_b128 v[20:23], v13 offset:49152
  s_waitcnt lgkmcnt(3)
  v_mfma_f32_32x32x16_bf16 v[64:79], v[24:27], v[128:131], v[64:79]
  v_cvt_pk_bf16_f32 v33, v34, v35
  v_mul_f32 v36, s52, v36
  v_mul_f32 v37, s52, v37
  v_mfma_f32_32x32x16_bf16 v[80:95], v[24:27], v[192:195], v[80:95]
  v_cvt_pk_bf16_f32 v34, v36, v37
  v_mul_f32 v38, s52, v38
  ds_read_b128 v[24:27], v14 offset:49152
  s_waitcnt lgkmcnt(3)
  v_mfma_f32_32x32x16_bf16 v[64:79], v[28:31], v[132:135], v[64:79]
  v_mul_f32 v39, s52, v39
  v_cvt_pk_bf16_f32 v35, v38, v39
  v_mul_f32 v40, s52, v40
  v_mfma_f32_32x32x16_bf16 v[80:95], v[28:31], v[196:199], v[80:95]
  v_mul_f32 v41, s52, v41
  v_cvt_pk_bf16_f32 v40, v40, v41
  ds_read_b128 v[28:31], v15 offset:49152
  s_waitcnt lgkmcnt(3)
  v_mfma_f32_32x32x16_bf16 v[64:79], v[16:19], v[136:139], v[64:79]
  v_mul_f32 v42, s52, v42
  v_mul_f32 v43, s52, v43
  v_cvt_pk_bf16_f32 v41, v42, v43
  v_mfma_f32_32x32x16_bf16 v[80:95], v[16:19], v[200:203], v[80:95]
  v_mul_f32 v44, s52, v44
  v_mul_f32 v45, s52, v45
  ds_read_b128 v[16:19], v8 offset:49408
  s_waitcnt lgkmcnt(3)
  v_mfma_f32_32x32x16_bf16 v[64:79], v[20:23], v[140:143], v[64:79]
  v_cvt_pk_bf16_f32 v42, v44, v45
  v_mul_f32 v46, s52, v46
  v_mul_f32 v47, s52, v47
  v_mfma_f32_32x32x16_bf16 v[80:95], v[20:23], v[204:207], v[80:95]
  v_cvt_pk_bf16_f32 v43, v46, v47
  v_permlane16_swap_b32 v32, v40
  ds_read_b128 v[20:23], v9 offset:49408
  s_waitcnt lgkmcnt(3)
  v_mfma_f32_32x32x16_bf16 v[64:79], v[24:27], v[144:147], v[64:79]
  v_permlane16_swap_b32 v33, v41
  v_permlane16_swap_b32 v34, v42
  v_permlane16_swap_b32 v35, v43
  v_mfma_f32_32x32x16_bf16 v[80:95], v[24:27], v[208:211], v[80:95]
  v_accvgpr_write_b32 a24, v32
  v_accvgpr_write_b32 a25, v33
  ds_read_b128 v[24:27], v10 offset:49408
  s_waitcnt lgkmcnt(3)
  v_mfma_f32_32x32x16_bf16 v[64:79], v[28:31], v[148:151], v[64:79]
  v_accvgpr_write_b32 a26, v34
  v_accvgpr_write_b32 a27, v35
  v_accvgpr_write_b32 a80, v40
  v_mfma_f32_32x32x16_bf16 v[80:95], v[28:31], v[212:215], v[80:95]
  v_accvgpr_write_b32 a81, v41
  v_accvgpr_write_b32 a82, v42
  ds_read_b128 v[28:31], v11 offset:49408
  s_waitcnt lgkmcnt(3)
  v_mfma_f32_32x32x16_bf16 v[64:79], v[16:19], v[152:155], v[64:79]
  v_accvgpr_write_b32 a83, v43
  v_mul_f32 v48, s52, v48
  v_mul_f32 v49, s52, v49
  v_mfma_f32_32x32x16_bf16 v[80:95], v[16:19], v[216:219], v[80:95]
  v_cvt_pk_bf16_f32 v48, v48, v49
  v_mul_f32 v50, s52, v50
  ds_read_b128 v[16:19], v12 offset:49408
  s_waitcnt lgkmcnt(3)
  v_mfma_f32_32x32x16_bf16 v[64:79], v[20:23], v[156:159], v[64:79]
  v_mul_f32 v51, s52, v51
  v_cvt_pk_bf16_f32 v49, v50, v51
  v_mul_f32 v52, s52, v52
  v_mfma_f32_32x32x16_bf16 v[80:95], v[20:23], v[220:223], v[80:95]
  v_mul_f32 v53, s52, v53
  v_cvt_pk_bf16_f32 v50, v52, v53
  ds_read_b128 v[20:23], v13 offset:49408
  s_waitcnt lgkmcnt(3)
  v_mfma_f32_32x32x16_bf16 v[64:79], v[24:27], v[160:163], v[64:79]
  v_mul_f32 v54, s52, v54
  v_mul_f32 v55, s52, v55
  v_cvt_pk_bf16_f32 v51, v54, v55
  v_mfma_f32_32x32x16_bf16 v[80:95], v[24:27], v[224:227], v[80:95]
  v_mul_f32 v56, s52, v56
  v_mul_f32 v57, s52, v57
  ds_read_b128 v[24:27], v14 offset:49408
  s_waitcnt lgkmcnt(3)
  v_mfma_f32_32x32x16_bf16 v[64:79], v[28:31], v[164:167], v[64:79]
  v_cvt_pk_bf16_f32 v56, v56, v57
  v_mul_f32 v58, s52, v58
  v_mul_f32 v59, s52, v59
  v_mfma_f32_32x32x16_bf16 v[80:95], v[28:31], v[228:231], v[80:95]
  v_cvt_pk_bf16_f32 v57, v58, v59
  v_mul_f32 v60, s52, v60
  ds_read_b128 v[28:31], v15 offset:49408
  s_waitcnt lgkmcnt(3)
  v_mfma_f32_32x32x16_bf16 v[64:79], v[16:19], v[168:171], v[64:79]
  v_mul_f32 v61, s52, v61
  v_cvt_pk_bf16_f32 v58, v60, v61
  v_mul_f32 v62, s52, v62
  v_mfma_f32_32x32x16_bf16 v[80:95], v[16:19], v[232:235], v[80:95]
  v_mul_f32 v63, s52, v63
  v_cvt_pk_bf16_f32 v59, v62, v63
  v_xor_b32 v8, 196608, v8
  ds_read_b128 v[16:19], v8 offset:0
  s_waitcnt lgkmcnt(3)
  v_mfma_f32_32x32x16_bf16 v[64:79], v[20:23], v[172:175], v[64:79]
  v_permlane16_swap_b32 v48, v56
  v_permlane16_swap_b32 v49, v57
  v_permlane16_swap_b32 v50, v58
  v_mfma_f32_32x32x16_bf16 v[80:95], v[20:23], v[236:239], v[80:95]
  v_permlane16_swap_b32 v51, v59
  v_accvgpr_write_b32 a136, v48
  v_xor_b32 v9, 196608, v9
  ds_read_b128 v[20:23], v9 offset:0
  s_waitcnt lgkmcnt(3)
  v_mfma_f32_32x32x16_bf16 v[64:79], v[24:27], v[176:179], v[64:79]
  v_accvgpr_write_b32 a137, v49
  v_accvgpr_write_b32 a138, v50
  v_accvgpr_write_b32 a139, v51
  v_mfma_f32_32x32x16_bf16 v[80:95], v[24:27], v[240:243], v[80:95]
  v_accvgpr_write_b32 a192, v56
  v_accvgpr_write_b32 a193, v57
  v_xor_b32 v10, 196608, v10
  ds_read_b128 v[24:27], v10 offset:0
  s_waitcnt lgkmcnt(3)
  v_mfma_f32_32x32x16_bf16 v[64:79], v[28:31], v[180:183], v[64:79]
  v_accvgpr_write_b32 a194, v58
  v_accvgpr_write_b32 a195, v59
  v_mfma_f32_32x32x16_bf16 v[80:95], v[28:31], v[244:247], v[80:95]
  v_xor_b32 v11, 196608, v11
  ds_read_b128 v[28:31], v11 offset:0
  s_waitcnt lgkmcnt(3)
  v_mfma_f32_32x32x16_bf16 v[32:47], v[16:19], v[120:123], 0
  v_mfma_f32_32x32x16_bf16 v[48:63], v[16:19], v[184:187], 0
  v_xor_b32 v12, 196608, v12
  ds_read_b128 v[16:19], v12 offset:0
  s_waitcnt lgkmcnt(3)
  v_mfma_f32_32x32x16_bf16 v[32:47], v[20:23], v[124:127], v[32:47]
  v_mul_f32 v64, s52, v64
  v_mul_f32 v65, s52, v65
  v_cvt_pk_bf16_f32 v64, v64, v65
  v_mfma_f32_32x32x16_bf16 v[48:63], v[20:23], v[188:191], v[48:63]
  v_mul_f32 v66, s52, v66
  v_mul_f32 v67, s52, v67
  v_xor_b32 v13, 196608, v13
  ds_read_b128 v[20:23], v13 offset:0
  s_waitcnt lgkmcnt(3)
  v_mfma_f32_32x32x16_bf16 v[32:47], v[24:27], v[128:131], v[32:47]
  v_cvt_pk_bf16_f32 v65, v66, v67
  v_mul_f32 v68, s52, v68
  v_mul_f32 v69, s52, v69
  v_mfma_f32_32x32x16_bf16 v[48:63], v[24:27], v[192:195], v[48:63]
  v_cvt_pk_bf16_f32 v66, v68, v69
  v_mul_f32 v70, s52, v70
  v_xor_b32 v14, 196608, v14
  ds_read_b128 v[24:27], v14 offset:0
  s_waitcnt lgkmcnt(3)
  v_mfma_f32_32x32x16_bf16 v[32:47], v[28:31], v[132:135], v[32:47]
  v_mul_f32 v71, s52, v71
  v_cvt_pk_bf16_f32 v67, v70, v71
  v_mul_f32 v72, s52, v72
  v_mfma_f32_32x32x16_bf16 v[48:63], v[28:31], v[196:199], v[48:63]
  v_mul_f32 v73, s52, v73
  v_cvt_pk_bf16_f32 v72, v72, v73
  v_xor_b32 v15, 196608, v15
  ds_read_b128 v[28:31], v15 offset:0
  s_waitcnt lgkmcnt(3)
  v_mfma_f32_32x32x16_bf16 v[32:47], v[16:19], v[136:139], v[32:47]
  v_mul_f32 v74, s52, v74
  v_mul_f32 v75, s52, v75
  v_cvt_pk_bf16_f32 v73, v74, v75
  v_mfma_f32_32x32x16_bf16 v[48:63], v[16:19], v[200:203], v[48:63]
  v_mul_f32 v76, s52, v76
  v_mul_f32 v77, s52, v77
  ds_read_b128 v[16:19], v8 offset:256
  s_waitcnt lgkmcnt(3)
  v_mfma_f32_32x32x16_bf16 v[32:47], v[20:23], v[140:143], v[32:47]
  v_cvt_pk_bf16_f32 v74, v76, v77
  v_mul_f32 v78, s52, v78
  v_mul_f32 v79, s52, v79
  v_mfma_f32_32x32x16_bf16 v[48:63], v[20:23], v[204:207], v[48:63]
  v_cvt_pk_bf16_f32 v75, v78, v79
  v_permlane16_swap_b32 v64, v72
  ds_read_b128 v[20:23], v9 offset:256
  s_waitcnt lgkmcnt(3)
  v_mfma_f32_32x32x16_bf16 v[32:47], v[24:27], v[144:147], v[32:47]
  v_permlane16_swap_b32 v65, v73
  v_permlane16_swap_b32 v66, v74
  v_permlane16_swap_b32 v67, v75
  v_mfma_f32_32x32x16_bf16 v[48:63], v[24:27], v[208:211], v[48:63]
  v_accvgpr_write_b32 a28, v64
  v_accvgpr_write_b32 a29, v65
  ds_read_b128 v[24:27], v10 offset:256
  s_waitcnt lgkmcnt(3)
  v_mfma_f32_32x32x16_bf16 v[32:47], v[28:31], v[148:151], v[32:47]
  v_accvgpr_write_b32 a30, v66
  v_accvgpr_write_b32 a31, v67
  v_accvgpr_write_b32 a84, v72
  v_mfma_f32_32x32x16_bf16 v[48:63], v[28:31], v[212:215], v[48:63]
  v_accvgpr_write_b32 a85, v73
  v_accvgpr_write_b32 a86, v74
  ds_read_b128 v[28:31], v11 offset:256
  s_waitcnt lgkmcnt(3)
  v_mfma_f32_32x32x16_bf16 v[32:47], v[16:19], v[152:155], v[32:47]
  v_accvgpr_write_b32 a87, v75
  v_mul_f32 v80, s52, v80
  v_mul_f32 v81, s52, v81
  v_mfma_f32_32x32x16_bf16 v[48:63], v[16:19], v[216:219], v[48:63]
  v_cvt_pk_bf16_f32 v80, v80, v81
  v_mul_f32 v82, s52, v82
  ds_read_b128 v[16:19], v12 offset:256
  s_waitcnt lgkmcnt(3)
  v_mfma_f32_32x32x16_bf16 v[32:47], v[20:23], v[156:159], v[32:47]
  v_mul_f32 v83, s52, v83
  v_cvt_pk_bf16_f32 v81, v82, v83
  v_mul_f32 v84, s52, v84
  v_mfma_f32_32x32x16_bf16 v[48:63], v[20:23], v[220:223], v[48:63]
  v_mul_f32 v85, s52, v85
  v_cvt_pk_bf16_f32 v82, v84, v85
  ds_read_b128 v[20:23], v13 offset:256
  s_waitcnt lgkmcnt(3)
  v_mfma_f32_32x32x16_bf16 v[32:47], v[24:27], v[160:163], v[32:47]
  v_mul_f32 v86, s52, v86
  v_mul_f32 v87, s52, v87
  v_cvt_pk_bf16_f32 v83, v86, v87
  v_mfma_f32_32x32x16_bf16 v[48:63], v[24:27], v[224:227], v[48:63]
  v_mul_f32 v88, s52, v88
  v_mul_f32 v89, s52, v89
  ds_read_b128 v[24:27], v14 offset:256
  s_waitcnt lgkmcnt(3)
  v_mfma_f32_32x32x16_bf16 v[32:47], v[28:31], v[164:167], v[32:47]
  v_cvt_pk_bf16_f32 v88, v88, v89
  v_mul_f32 v90, s52, v90
  v_mul_f32 v91, s52, v91
  v_mfma_f32_32x32x16_bf16 v[48:63], v[28:31], v[228:231], v[48:63]
  v_cvt_pk_bf16_f32 v89, v90, v91
  v_mul_f32 v92, s52, v92
  ds_read_b128 v[28:31], v15 offset:256
  s_waitcnt lgkmcnt(3)
  v_mfma_f32_32x32x16_bf16 v[32:47], v[16:19], v[168:171], v[32:47]
  v_mul_f32 v93, s52, v93
  v_cvt_pk_bf16_f32 v90, v92, v93
  v_mul_f32 v94, s52, v94
  v_mfma_f32_32x32x16_bf16 v[48:63], v[16:19], v[232:235], v[48:63]
  v_mul_f32 v95, s52, v95
  v_cvt_pk_bf16_f32 v91, v94, v95
  v_xor_b32 v8, 131072, v8
  ds_read_b128 v[16:19], v8 offset:0
  s_waitcnt lgkmcnt(3)
  v_mfma_f32_32x32x16_bf16 v[32:47], v[20:23], v[172:175], v[32:47]
  v_permlane16_swap_b32 v80, v88
  v_permlane16_swap_b32 v81, v89
  v_permlane16_swap_b32 v82, v90
  v_mfma_f32_32x32x16_bf16 v[48:63], v[20:23], v[236:239], v[48:63]
  v_permlane16_swap_b32 v83, v91
  v_accvgpr_write_b32 a140, v80
  v_xor_b32 v9, 131072, v9
  ds_read_b128 v[20:23], v9 offset:0
  s_waitcnt lgkmcnt(3)
  v_mfma_f32_32x32x16_bf16 v[32:47], v[24:27], v[176:179], v[32:47]
  v_accvgpr_write_b32 a141, v81
  v_accvgpr_write_b32 a142, v82
  v_accvgpr_write_b32 a143, v83
  v_mfma_f32_32x32x16_bf16 v[48:63], v[24:27], v[240:243], v[48:63]
  v_accvgpr_write_b32 a196, v88
  v_accvgpr_write_b32 a197, v89
  v_xor_b32 v10, 131072, v10
  ds_read_b128 v[24:27], v10 offset:0
  s_waitcnt lgkmcnt(3)
  v_mfma_f32_32x32x16_bf16 v[32:47], v[28:31], v[180:183], v[32:47]
  v_accvgpr_write_b32 a198, v90
  v_accvgpr_write_b32 a199, v91
  v_mfma_f32_32x32x16_bf16 v[48:63], v[28:31], v[244:247], v[48:63]
  s_waitcnt vmcnt(8)
  s_barrier
  v_xor_b32 v11, 131072, v11
  ds_read_b128 v[28:31], v11 offset:0
  s_waitcnt lgkmcnt(3)
  v_mfma_f32_32x32x16_bf16 v[64:79], v[16:19], v[120:123], 0
  v_mfma_f32_32x32x16_bf16 v[80:95], v[16:19], v[184:187], 0
  v_xor_b32 v12, 131072, v12
  ds_read_b128 v[16:19], v12 offset:0
  s_waitcnt lgkmcnt(3)
  v_mfma_f32_32x32x16_bf16 v[64:79], v[20:23], v[124:127], v[64:79]
  v_mul_f32 v32, s52, v32
  v_mul_f32 v33, s52, v33
  v_cvt_pk_bf16_f32 v32, v32, v33
  v_mfma_f32_32x32x16_bf16 v[80:95], v[20:23], v[188:191], v[80:95]
  v_mul_f32 v34, s52, v34
  v_mul_f32 v35, s52, v35
  v_xor_b32 v13, 131072, v13
  ds_read_b128 v[20:23], v13 offset:0
  s_waitcnt lgkmcnt(3)
  v_mfma_f32_32x32x16_bf16 v[64:79], v[24:27], v[128:131], v[64:79]
  v_cvt_pk_bf16_f32 v33, v34, v35
  v_mul_f32 v36, s52, v36
  v_mul_f32 v37, s52, v37
  v_mfma_f32_32x32x16_bf16 v[80:95], v[24:27], v[192:195], v[80:95]
  v_cvt_pk_bf16_f32 v34, v36, v37
  v_mul_f32 v38, s52, v38
  v_xor_b32 v14, 131072, v14
  ds_read_b128 v[24:27], v14 offset:0
  s_waitcnt lgkmcnt(3)
  v_mfma_f32_32x32x16_bf16 v[64:79], v[28:31], v[132:135], v[64:79]
  v_mul_f32 v39, s52, v39
  v_cvt_pk_bf16_f32 v35, v38, v39
  v_mul_f32 v40, s52, v40
  v_mfma_f32_32x32x16_bf16 v[80:95], v[28:31], v[196:199], v[80:95]
  v_mul_f32 v41, s52, v41
  v_cvt_pk_bf16_f32 v40, v40, v41
  v_xor_b32 v15, 131072, v15
  ds_read_b128 v[28:31], v15 offset:0
  s_waitcnt lgkmcnt(3)
  v_mfma_f32_32x32x16_bf16 v[64:79], v[16:19], v[136:139], v[64:79]
  v_mul_f32 v42, s52, v42
  v_mul_f32 v43, s52, v43
  v_cvt_pk_bf16_f32 v41, v42, v43
  v_mfma_f32_32x32x16_bf16 v[80:95], v[16:19], v[200:203], v[80:95]
  v_mul_f32 v44, s52, v44
  v_mul_f32 v45, s52, v45
  ds_read_b128 v[16:19], v8 offset:256
  s_waitcnt lgkmcnt(3)
  v_mfma_f32_32x32x16_bf16 v[64:79], v[20:23], v[140:143], v[64:79]
  v_cvt_pk_bf16_f32 v42, v44, v45
  v_mul_f32 v46, s52, v46
  v_mul_f32 v47, s52, v47
  v_mfma_f32_32x32x16_bf16 v[80:95], v[20:23], v[204:207], v[80:95]
  v_cvt_pk_bf16_f32 v43, v46, v47
  v_permlane16_swap_b32 v32, v40
  ds_read_b128 v[20:23], v9 offset:256
  s_waitcnt lgkmcnt(3)
  v_mfma_f32_32x32x16_bf16 v[64:79], v[24:27], v[144:147], v[64:79]
  v_permlane16_swap_b32 v33, v41
  v_permlane16_swap_b32 v34, v42
  v_permlane16_swap_b32 v35, v43
  v_mfma_f32_32x32x16_bf16 v[80:95], v[24:27], v[208:211], v[80:95]
  v_accvgpr_write_b32 a32, v32
  v_accvgpr_write_b32 a33, v33
  ds_read_b128 v[24:27], v10 offset:256
  s_waitcnt lgkmcnt(3)
  v_mfma_f32_32x32x16_bf16 v[64:79], v[28:31], v[148:151], v[64:79]
  v_accvgpr_write_b32 a34, v34
  v_accvgpr_write_b32 a35, v35
  v_accvgpr_write_b32 a88, v40
  v_mfma_f32_32x32x16_bf16 v[80:95], v[28:31], v[212:215], v[80:95]
  v_accvgpr_write_b32 a89, v41
  v_accvgpr_write_b32 a90, v42
  ds_read_b128 v[28:31], v11 offset:256
  s_waitcnt lgkmcnt(3)
  v_mfma_f32_32x32x16_bf16 v[64:79], v[16:19], v[152:155], v[64:79]
  v_accvgpr_write_b32 a91, v43
  v_mul_f32 v48, s52, v48
  v_mul_f32 v49, s52, v49
  v_mfma_f32_32x32x16_bf16 v[80:95], v[16:19], v[216:219], v[80:95]
  v_cvt_pk_bf16_f32 v48, v48, v49
  v_mul_f32 v50, s52, v50
  ds_read_b128 v[16:19], v12 offset:256
  s_waitcnt lgkmcnt(3)
  v_mfma_f32_32x32x16_bf16 v[64:79], v[20:23], v[156:159], v[64:79]
  v_mul_f32 v51, s52, v51
  v_cvt_pk_bf16_f32 v49, v50, v51
  v_mul_f32 v52, s52, v52
  v_mfma_f32_32x32x16_bf16 v[80:95], v[20:23], v[220:223], v[80:95]
  v_mul_f32 v53, s52, v53
  v_cvt_pk_bf16_f32 v50, v52, v53
  ds_read_b128 v[20:23], v13 offset:256
  s_waitcnt lgkmcnt(3)
  v_mfma_f32_32x32x16_bf16 v[64:79], v[24:27], v[160:163], v[64:79]
  v_mul_f32 v54, s52, v54
  v_mul_f32 v55, s52, v55
  v_cvt_pk_bf16_f32 v51, v54, v55
  v_mfma_f32_32x32x16_bf16 v[80:95], v[24:27], v[224:227], v[80:95]
  v_mul_f32 v56, s52, v56
  v_mul_f32 v57, s52, v57
  ds_read_b128 v[24:27], v14 offset:256
  s_waitcnt lgkmcnt(3)
  v_mfma_f32_32x32x16_bf16 v[64:79], v[28:31], v[164:167], v[64:79]
  v_cvt_pk_bf16_f32 v56, v56, v57
  v_mul_f32 v58, s52, v58
  v_mul_f32 v59, s52, v59
  v_mfma_f32_32x32x16_bf16 v[80:95], v[28:31], v[228:231], v[80:95]
  v_cvt_pk_bf16_f32 v57, v58, v59
  v_mul_f32 v60, s52, v60
  ds_read_b128 v[28:31], v15 offset:256
  s_waitcnt lgkmcnt(3)
  v_mfma_f32_32x32x16_bf16 v[64:79], v[16:19], v[168:171], v[64:79]
  v_mul_f32 v61, s52, v61
  v_cvt_pk_bf16_f32 v58, v60, v61
  v_mul_f32 v62, s52, v62
  v_mfma_f32_32x32x16_bf16 v[80:95], v[16:19], v[232:235], v[80:95]
  v_mul_f32 v63, s52, v63
  v_cvt_pk_bf16_f32 v59, v62, v63
  ds_read_b128 v[16:19], v8 offset:16384
  s_waitcnt lgkmcnt(3)
  v_mfma_f32_32x32x16_bf16 v[64:79], v[20:23], v[172:175], v[64:79]
  v_permlane16_swap_b32 v48, v56
  v_permlane16_swap_b32 v49, v57
  v_permlane16_swap_b32 v50, v58
  v_mfma_f32_32x32x16_bf16 v[80:95], v[20:23], v[236:239], v[80:95]
  v_permlane16_swap_b32 v51, v59
  v_accvgpr_write_b32 a144, v48
  ds_read_b128 v[20:23], v9 offset:16384
  s_waitcnt lgkmcnt(3)
  v_mfma_f32_32x32x16_bf16 v[64:79], v[24:27], v[176:179], v[64:79]
  v_accvgpr_write_b32 a145, v49
  v_accvgpr_write_b32 a146, v50
  v_accvgpr_write_b32 a147, v51
  v_mfma_f32_32x32x16_bf16 v[80:95], v[24:27], v[240:243], v[80:95]
  v_accvgpr_write_b32 a200, v56
  v_accvgpr_write_b32 a201, v57
  ds_read_b128 v[24:27], v10 offset:16384
  s_waitcnt lgkmcnt(3)
  v_mfma_f32_32x32x16_bf16 v[64:79], v[28:31], v[180:183], v[64:79]
  v_accvgpr_write_b32 a202, v58
  v_accvgpr_write_b32 a203, v59
  v_mfma_f32_32x32x16_bf16 v[80:95], v[28:31], v[244:247], v[80:95]
  ds_read_b128 v[28:31], v11 offset:16384
  s_waitcnt lgkmcnt(3)
  v_mfma_f32_32x32x16_bf16 v[32:47], v[16:19], v[120:123], 0
  v_mfma_f32_32x32x16_bf16 v[48:63], v[16:19], v[184:187], 0
  ds_read_b128 v[16:19], v12 offset:16384
  s_waitcnt lgkmcnt(3)
  v_mfma_f32_32x32x16_bf16 v[32:47], v[20:23], v[124:127], v[32:47]
  v_mul_f32 v64, s52, v64
  v_mul_f32 v65, s52, v65
  v_cvt_pk_bf16_f32 v64, v64, v65
  v_mfma_f32_32x32x16_bf16 v[48:63], v[20:23], v[188:191], v[48:63]
  v_mul_f32 v66, s52, v66
  v_mul_f32 v67, s52, v67
  ds_read_b128 v[20:23], v13 offset:16384
  s_waitcnt lgkmcnt(3)
  v_mfma_f32_32x32x16_bf16 v[32:47], v[24:27], v[128:131], v[32:47]
  v_cvt_pk_bf16_f32 v65, v66, v67
  v_mul_f32 v68, s52, v68
  v_mul_f32 v69, s52, v69
  v_mfma_f32_32x32x16_bf16 v[48:63], v[24:27], v[192:195], v[48:63]
  v_cvt_pk_bf16_f32 v66, v68, v69
  v_mul_f32 v70, s52, v70
  ds_read_b128 v[24:27], v14 offset:16384
  s_waitcnt lgkmcnt(3)
  v_mfma_f32_32x32x16_bf16 v[32:47], v[28:31], v[132:135], v[32:47]
  v_mul_f32 v71, s52, v71
  v_cvt_pk_bf16_f32 v67, v70, v71
  v_mul_f32 v72, s52, v72
  v_mfma_f32_32x32x16_bf16 v[48:63], v[28:31], v[196:199], v[48:63]
  v_mul_f32 v73, s52, v73
  v_cvt_pk_bf16_f32 v72, v72, v73
  ds_read_b128 v[28:31], v15 offset:16384
  s_waitcnt lgkmcnt(3)
  v_mfma_f32_32x32x16_bf16 v[32:47], v[16:19], v[136:139], v[32:47]
  v_mul_f32 v74, s52, v74
  v_mul_f32 v75, s52, v75
  v_cvt_pk_bf16_f32 v73, v74, v75
  v_mfma_f32_32x32x16_bf16 v[48:63], v[16:19], v[200:203], v[48:63]
  v_mul_f32 v76, s52, v76
  v_mul_f32 v77, s52, v77
  ds_read_b128 v[16:19], v8 offset:16640
  s_waitcnt lgkmcnt(3)
  v_mfma_f32_32x32x16_bf16 v[32:47], v[20:23], v[140:143], v[32:47]
  v_cvt_pk_bf16_f32 v74, v76, v77
  v_mul_f32 v78, s52, v78
  v_mul_f32 v79, s52, v79
  v_mfma_f32_32x32x16_bf16 v[48:63], v[20:23], v[204:207], v[48:63]
  v_cvt_pk_bf16_f32 v75, v78, v79
  v_permlane16_swap_b32 v64, v72
  ds_read_b128 v[20:23], v9 offset:16640
  s_waitcnt lgkmcnt(3)
  v_mfma_f32_32x32x16_bf16 v[32:47], v[24:27], v[144:147], v[32:47]
  v_permlane16_swap_b32 v65, v73
  v_permlane16_swap_b32 v66, v74
  v_permlane16_swap_b32 v67, v75
  v_mfma_f32_32x32x16_bf16 v[48:63], v[24:27], v[208:211], v[48:63]
  v_accvgpr_write_b32 a36, v64
  v_accvgpr_write_b32 a37, v65
  ds_read_b128 v[24:27], v10 offset:16640
  s_waitcnt lgkmcnt(3)
  v_mfma_f32_32x32x16_bf16 v[32:47], v[28:31], v[148:151], v[32:47]
  v_accvgpr_write_b32 a38, v66
  v_accvgpr_write_b32 a39, v67
  v_accvgpr_write_b32 a92, v72
  v_mfma_f32_32x32x16_bf16 v[48:63], v[28:31], v[212:215], v[48:63]
  v_accvgpr_write_b32 a93, v73
  v_accvgpr_write_b32 a94, v74
  ds_read_b128 v[28:31], v11 offset:16640
  s_waitcnt lgkmcnt(3)
  v_mfma_f32_32x32x16_bf16 v[32:47], v[16:19], v[152:155], v[32:47]
  v_accvgpr_write_b32 a95, v75
  v_mul_f32 v80, s52, v80
  v_mul_f32 v81, s52, v81
  v_mfma_f32_32x32x16_bf16 v[48:63], v[16:19], v[216:219], v[48:63]
  v_cvt_pk_bf16_f32 v80, v80, v81
  v_mul_f32 v82, s52, v82
  ds_read_b128 v[16:19], v12 offset:16640
  s_waitcnt lgkmcnt(3)
  v_mfma_f32_32x32x16_bf16 v[32:47], v[20:23], v[156:159], v[32:47]
  v_mul_f32 v83, s52, v83
  v_cvt_pk_bf16_f32 v81, v82, v83
  v_mul_f32 v84, s52, v84
  v_mfma_f32_32x32x16_bf16 v[48:63], v[20:23], v[220:223], v[48:63]
  v_mul_f32 v85, s52, v85
  v_cvt_pk_bf16_f32 v82, v84, v85
  ds_read_b128 v[20:23], v13 offset:16640
  s_waitcnt lgkmcnt(3)
  v_mfma_f32_32x32x16_bf16 v[32:47], v[24:27], v[160:163], v[32:47]
  v_mul_f32 v86, s52, v86
  v_mul_f32 v87, s52, v87
  v_cvt_pk_bf16_f32 v83, v86, v87
  v_mfma_f32_32x32x16_bf16 v[48:63], v[24:27], v[224:227], v[48:63]
  v_mul_f32 v88, s52, v88
  v_mul_f32 v89, s52, v89
  ds_read_b128 v[24:27], v14 offset:16640
  s_waitcnt lgkmcnt(3)
  v_mfma_f32_32x32x16_bf16 v[32:47], v[28:31], v[164:167], v[32:47]
  v_cvt_pk_bf16_f32 v88, v88, v89
  v_mul_f32 v90, s52, v90
  v_mul_f32 v91, s52, v91
  v_mfma_f32_32x32x16_bf16 v[48:63], v[28:31], v[228:231], v[48:63]
  v_cvt_pk_bf16_f32 v89, v90, v91
  v_mul_f32 v92, s52, v92
  ds_read_b128 v[28:31], v15 offset:16640
  s_waitcnt lgkmcnt(3)
  v_mfma_f32_32x32x16_bf16 v[32:47], v[16:19], v[168:171], v[32:47]
  v_mul_f32 v93, s52, v93
  v_cvt_pk_bf16_f32 v90, v92, v93
  v_mul_f32 v94, s52, v94
  v_mfma_f32_32x32x16_bf16 v[48:63], v[16:19], v[232:235], v[48:63]
  v_mul_f32 v95, s52, v95
  v_cvt_pk_bf16_f32 v91, v94, v95
  ds_read_b128 v[16:19], v8 offset:32768
  s_waitcnt lgkmcnt(3)
  v_mfma_f32_32x32x16_bf16 v[32:47], v[20:23], v[172:175], v[32:47]
  v_permlane16_swap_b32 v80, v88
  v_permlane16_swap_b32 v81, v89
  v_permlane16_swap_b32 v82, v90
  v_mfma_f32_32x32x16_bf16 v[48:63], v[20:23], v[236:239], v[48:63]
  v_permlane16_swap_b32 v83, v91
  v_accvgpr_write_b32 a148, v80
  ds_read_b128 v[20:23], v9 offset:32768
  s_waitcnt lgkmcnt(3)
  v_mfma_f32_32x32x16_bf16 v[32:47], v[24:27], v[176:179], v[32:47]
  v_accvgpr_write_b32 a149, v81
  v_accvgpr_write_b32 a150, v82
  v_accvgpr_write_b32 a151, v83
  v_mfma_f32_32x32x16_bf16 v[48:63], v[24:27], v[240:243], v[48:63]
  v_accvgpr_write_b32 a204, v88
  v_accvgpr_write_b32 a205, v89
  ds_read_b128 v[24:27], v10 offset:32768
  s_waitcnt lgkmcnt(3)
  v_mfma_f32_32x32x16_bf16 v[32:47], v[28:31], v[180:183], v[32:47]
  v_accvgpr_write_b32 a206, v90
  v_accvgpr_write_b32 a207, v91
  v_mfma_f32_32x32x16_bf16 v[48:63], v[28:31], v[244:247], v[48:63]
  s_waitcnt vmcnt(0)
  s_barrier
  ds_read_b128 v[28:31], v11 offset:32768
  s_waitcnt lgkmcnt(3)
  v_mfma_f32_32x32x16_bf16 v[64:79], v[16:19], v[120:123], 0
  v_mfma_f32_32x32x16_bf16 v[80:95], v[16:19], v[184:187], 0
  ds_read_b128 v[16:19], v12 offset:32768
  s_waitcnt lgkmcnt(3)
  v_mfma_f32_32x32x16_bf16 v[64:79], v[20:23], v[124:127], v[64:79]
  v_mul_f32 v32, s52, v32
  v_mul_f32 v33, s52, v33
  v_cvt_pk_bf16_f32 v32, v32, v33
  v_mfma_f32_32x32x16_bf16 v[80:95], v[20:23], v[188:191], v[80:95]
  v_mul_f32 v34, s52, v34
  v_mul_f32 v35, s52, v35
  ds_read_b128 v[20:23], v13 offset:32768
  s_waitcnt lgkmcnt(3)
  v_mfma_f32_32x32x16_bf16 v[64:79], v[24:27], v[128:131], v[64:79]
  v_cvt_pk_bf16_f32 v33, v34, v35
  v_mul_f32 v36, s52, v36
  v_mul_f32 v37, s52, v37
  v_mfma_f32_32x32x16_bf16 v[80:95], v[24:27], v[192:195], v[80:95]
  v_cvt_pk_bf16_f32 v34, v36, v37
  v_mul_f32 v38, s52, v38
  ds_read_b128 v[24:27], v14 offset:32768
  s_waitcnt lgkmcnt(3)
  v_mfma_f32_32x32x16_bf16 v[64:79], v[28:31], v[132:135], v[64:79]
  v_mul_f32 v39, s52, v39
  v_cvt_pk_bf16_f32 v35, v38, v39
  v_mul_f32 v40, s52, v40
  v_mfma_f32_32x32x16_bf16 v[80:95], v[28:31], v[196:199], v[80:95]
  v_mul_f32 v41, s52, v41
  v_cvt_pk_bf16_f32 v40, v40, v41
  ds_read_b128 v[28:31], v15 offset:32768
  s_waitcnt lgkmcnt(3)
  v_mfma_f32_32x32x16_bf16 v[64:79], v[16:19], v[136:139], v[64:79]
  v_mul_f32 v42, s52, v42
  v_mul_f32 v43, s52, v43
  v_cvt_pk_bf16_f32 v41, v42, v43
  v_mfma_f32_32x32x16_bf16 v[80:95], v[16:19], v[200:203], v[80:95]
  v_mul_f32 v44, s52, v44
  v_mul_f32 v45, s52, v45
  ds_read_b128 v[16:19], v8 offset:33024
  s_waitcnt lgkmcnt(3)
  v_mfma_f32_32x32x16_bf16 v[64:79], v[20:23], v[140:143], v[64:79]
  v_cvt_pk_bf16_f32 v42, v44, v45
  v_mul_f32 v46, s52, v46
  v_mul_f32 v47, s52, v47
  v_mfma_f32_32x32x16_bf16 v[80:95], v[20:23], v[204:207], v[80:95]
  v_cvt_pk_bf16_f32 v43, v46, v47
  v_permlane16_swap_b32 v32, v40
  ds_read_b128 v[20:23], v9 offset:33024
  s_waitcnt lgkmcnt(3)
  v_mfma_f32_32x32x16_bf16 v[64:79], v[24:27], v[144:147], v[64:79]
  v_permlane16_swap_b32 v33, v41
  v_permlane16_swap_b32 v34, v42
  v_permlane16_swap_b32 v35, v43
  v_mfma_f32_32x32x16_bf16 v[80:95], v[24:27], v[208:211], v[80:95]
  v_accvgpr_write_b32 a40, v32
  v_accvgpr_write_b32 a41, v33
  ds_read_b128 v[24:27], v10 offset:33024
  s_waitcnt lgkmcnt(3)
  v_mfma_f32_32x32x16_bf16 v[64:79], v[28:31], v[148:151], v[64:79]
  v_accvgpr_write_b32 a42, v34
  v_accvgpr_write_b32 a43, v35
  v_accvgpr_write_b32 a96, v40
  v_mfma_f32_32x32x16_bf16 v[80:95], v[28:31], v[212:215], v[80:95]
  v_accvgpr_write_b32 a97, v41
  v_accvgpr_write_b32 a98, v42
  ds_read_b128 v[28:31], v11 offset:33024
  s_waitcnt lgkmcnt(3)
  v_mfma_f32_32x32x16_bf16 v[64:79], v[16:19], v[152:155], v[64:79]
  v_accvgpr_write_b32 a99, v43
  v_mul_f32 v48, s52, v48
  v_mul_f32 v49, s52, v49
  v_mfma_f32_32x32x16_bf16 v[80:95], v[16:19], v[216:219], v[80:95]
  v_cvt_pk_bf16_f32 v48, v48, v49
  v_mul_f32 v50, s52, v50
  ds_read_b128 v[16:19], v12 offset:33024
  s_waitcnt lgkmcnt(3)
  v_mfma_f32_32x32x16_bf16 v[64:79], v[20:23], v[156:159], v[64:79]
  v_mul_f32 v51, s52, v51
  v_cvt_pk_bf16_f32 v49, v50, v51
  v_mul_f32 v52, s52, v52
  v_mfma_f32_32x32x16_bf16 v[80:95], v[20:23], v[220:223], v[80:95]
  v_mul_f32 v53, s52, v53
  v_cvt_pk_bf16_f32 v50, v52, v53
  ds_read_b128 v[20:23], v13 offset:33024
  s_waitcnt lgkmcnt(3)
  v_mfma_f32_32x32x16_bf16 v[64:79], v[24:27], v[160:163], v[64:79]
  v_mul_f32 v54, s52, v54
  v_mul_f32 v55, s52, v55
  v_cvt_pk_bf16_f32 v51, v54, v55
  v_mfma_f32_32x32x16_bf16 v[80:95], v[24:27], v[224:227], v[80:95]
  v_mul_f32 v56, s52, v56
  v_mul_f32 v57, s52, v57
  ds_read_b128 v[24:27], v14 offset:33024
  s_waitcnt lgkmcnt(3)
  v_mfma_f32_32x32x16_bf16 v[64:79], v[28:31], v[164:167], v[64:79]
  v_cvt_pk_bf16_f32 v56, v56, v57
  v_mul_f32 v58, s52, v58
  v_mul_f32 v59, s52, v59
  v_mfma_f32_32x32x16_bf16 v[80:95], v[28:31], v[228:231], v[80:95]
  v_cvt_pk_bf16_f32 v57, v58, v59
  v_mul_f32 v60, s52, v60
  ds_read_b128 v[28:31], v15 offset:33024
  s_waitcnt lgkmcnt(3)
  v_mfma_f32_32x32x16_bf16 v[64:79], v[16:19], v[168:171], v[64:79]
  v_mul_f32 v61, s52, v61
  v_cvt_pk_bf16_f32 v58, v60, v61
  v_mul_f32 v62, s52, v62
  v_mfma_f32_32x32x16_bf16 v[80:95], v[16:19], v[232:235], v[80:95]
  v_mul_f32 v63, s52, v63
  v_cvt_pk_bf16_f32 v59, v62, v63
  ds_read_b128 v[16:19], v8 offset:49152
  s_waitcnt lgkmcnt(3)
  v_mfma_f32_32x32x16_bf16 v[64:79], v[20:23], v[172:175], v[64:79]
  v_permlane16_swap_b32 v48, v56
  v_permlane16_swap_b32 v49, v57
  v_permlane16_swap_b32 v50, v58
  v_mfma_f32_32x32x16_bf16 v[80:95], v[20:23], v[236:239], v[80:95]
  v_permlane16_swap_b32 v51, v59
  v_accvgpr_write_b32 a152, v48
  ds_read_b128 v[20:23], v9 offset:49152
  s_waitcnt lgkmcnt(3)
  v_mfma_f32_32x32x16_bf16 v[64:79], v[24:27], v[176:179], v[64:79]
  v_accvgpr_write_b32 a153, v49
  v_accvgpr_write_b32 a154, v50
  v_accvgpr_write_b32 a155, v51
  v_mfma_f32_32x32x16_bf16 v[80:95], v[24:27], v[240:243], v[80:95]
  v_accvgpr_write_b32 a208, v56
  v_accvgpr_write_b32 a209, v57
  ds_read_b128 v[24:27], v10 offset:49152
  s_waitcnt lgkmcnt(3)
  v_mfma_f32_32x32x16_bf16 v[64:79], v[28:31], v[180:183], v[64:79]
  v_accvgpr_write_b32 a210, v58
  v_accvgpr_write_b32 a211, v59
  v_mfma_f32_32x32x16_bf16 v[80:95], v[28:31], v[244:247], v[80:95]
  ds_read_b128 v[28:31], v11 offset:49152
  s_waitcnt lgkmcnt(3)
  v_mfma_f32_32x32x16_bf16 v[32:47], v[16:19], v[120:123], 0
  v_mfma_f32_32x32x16_bf16 v[48:63], v[16:19], v[184:187], 0
  ds_read_b128 v[16:19], v12 offset:49152
  s_waitcnt lgkmcnt(3)
  v_mfma_f32_32x32x16_bf16 v[32:47], v[20:23], v[124:127], v[32:47]
  v_mul_f32 v64, s52, v64
  v_mul_f32 v65, s52, v65
  v_cvt_pk_bf16_f32 v64, v64, v65
  v_mfma_f32_32x32x16_bf16 v[48:63], v[20:23], v[188:191], v[48:63]
  v_mul_f32 v66, s52, v66
  v_mul_f32 v67, s52, v67
  ds_read_b128 v[20:23], v13 offset:49152
  s_waitcnt lgkmcnt(3)
  v_mfma_f32_32x32x16_bf16 v[32:47], v[24:27], v[128:131], v[32:47]
  v_cvt_pk_bf16_f32 v65, v66, v67
  v_mul_f32 v68, s52, v68
  v_mul_f32 v69, s52, v69
  v_mfma_f32_32x32x16_bf16 v[48:63], v[24:27], v[192:195], v[48:63]
  v_cvt_pk_bf16_f32 v66, v68, v69
  v_mul_f32 v70, s52, v70
  ds_read_b128 v[24:27], v14 offset:49152
  s_waitcnt lgkmcnt(3)
  v_mfma_f32_32x32x16_bf16 v[32:47], v[28:31], v[132:135], v[32:47]
  v_mul_f32 v71, s52, v71
  v_cvt_pk_bf16_f32 v67, v70, v71
  v_mul_f32 v72, s52, v72
  v_mfma_f32_32x32x16_bf16 v[48:63], v[28:31], v[196:199], v[48:63]
  v_mul_f32 v73, s52, v73
  v_cvt_pk_bf16_f32 v72, v72, v73
  ds_read_b128 v[28:31], v15 offset:49152
  s_waitcnt lgkmcnt(3)
  v_mfma_f32_32x32x16_bf16 v[32:47], v[16:19], v[136:139], v[32:47]
  v_mul_f32 v74, s52, v74
  v_mul_f32 v75, s52, v75
  v_cvt_pk_bf16_f32 v73, v74, v75
  v_mfma_f32_32x32x16_bf16 v[48:63], v[16:19], v[200:203], v[48:63]
  v_mul_f32 v76, s52, v76
  v_mul_f32 v77, s52, v77
  ds_read_b128 v[16:19], v8 offset:49408
  s_waitcnt lgkmcnt(3)
  v_mfma_f32_32x32x16_bf16 v[32:47], v[20:23], v[140:143], v[32:47]
  v_cvt_pk_bf16_f32 v74, v76, v77
  v_mul_f32 v78, s52, v78
  v_mul_f32 v79, s52, v79
  v_mfma_f32_32x32x16_bf16 v[48:63], v[20:23], v[204:207], v[48:63]
  v_cvt_pk_bf16_f32 v75, v78, v79
  v_permlane16_swap_b32 v64, v72
  ds_read_b128 v[20:23], v9 offset:49408
  s_waitcnt lgkmcnt(3)
  v_mfma_f32_32x32x16_bf16 v[32:47], v[24:27], v[144:147], v[32:47]
  v_permlane16_swap_b32 v65, v73
  v_permlane16_swap_b32 v66, v74
  v_permlane16_swap_b32 v67, v75
  v_mfma_f32_32x32x16_bf16 v[48:63], v[24:27], v[208:211], v[48:63]
  v_accvgpr_write_b32 a44, v64
  v_accvgpr_write_b32 a45, v65
  ds_read_b128 v[24:27], v10 offset:49408
  s_waitcnt lgkmcnt(3)
  v_mfma_f32_32x32x16_bf16 v[32:47], v[28:31], v[148:151], v[32:47]
  v_accvgpr_write_b32 a46, v66
  v_accvgpr_write_b32 a47, v67
  v_accvgpr_write_b32 a100, v72
  v_mfma_f32_32x32x16_bf16 v[48:63], v[28:31], v[212:215], v[48:63]
  v_accvgpr_write_b32 a101, v73
  v_accvgpr_write_b32 a102, v74
  ds_read_b128 v[28:31], v11 offset:49408
  s_waitcnt lgkmcnt(3)
  v_mfma_f32_32x32x16_bf16 v[32:47], v[16:19], v[152:155], v[32:47]
  v_accvgpr_write_b32 a103, v75
  v_mul_f32 v80, s52, v80
  v_mul_f32 v81, s52, v81
  v_mfma_f32_32x32x16_bf16 v[48:63], v[16:19], v[216:219], v[48:63]
  v_cvt_pk_bf16_f32 v80, v80, v81
  v_mul_f32 v82, s52, v82
  ds_read_b128 v[16:19], v12 offset:49408
  s_waitcnt lgkmcnt(3)
  v_mfma_f32_32x32x16_bf16 v[32:47], v[20:23], v[156:159], v[32:47]
  v_mul_f32 v83, s52, v83
  v_cvt_pk_bf16_f32 v81, v82, v83
  v_mul_f32 v84, s52, v84
  v_mfma_f32_32x32x16_bf16 v[48:63], v[20:23], v[220:223], v[48:63]
  v_mul_f32 v85, s52, v85
  v_cvt_pk_bf16_f32 v82, v84, v85
  ds_read_b128 v[20:23], v13 offset:49408
  s_waitcnt lgkmcnt(3)
  v_mfma_f32_32x32x16_bf16 v[32:47], v[24:27], v[160:163], v[32:47]
  v_mul_f32 v86, s52, v86
  v_mul_f32 v87, s52, v87
  v_cvt_pk_bf16_f32 v83, v86, v87
  v_mfma_f32_32x32x16_bf16 v[48:63], v[24:27], v[224:227], v[48:63]
  v_mul_f32 v88, s52, v88
  v_mul_f32 v89, s52, v89
  ds_read_b128 v[24:27], v14 offset:49408
  s_waitcnt lgkmcnt(3)
  v_mfma_f32_32x32x16_bf16 v[32:47], v[28:31], v[164:167], v[32:47]
  v_cvt_pk_bf16_f32 v88, v88, v89
  v_mul_f32 v90, s52, v90
  v_mul_f32 v91, s52, v91
  v_mfma_f32_32x32x16_bf16 v[48:63], v[28:31], v[228:231], v[48:63]
  v_cvt_pk_bf16_f32 v89, v90, v91
  v_mul_f32 v92, s52, v92
  ds_read_b128 v[28:31], v15 offset:49408
  s_waitcnt lgkmcnt(3)
  v_mfma_f32_32x32x16_bf16 v[32:47], v[16:19], v[168:171], v[32:47]
  v_mul_f32 v93, s52, v93
  v_cvt_pk_bf16_f32 v90, v92, v93
  v_mul_f32 v94, s52, v94
  v_mfma_f32_32x32x16_bf16 v[48:63], v[16:19], v[232:235], v[48:63]
  v_mul_f32 v95, s52, v95
  v_cvt_pk_bf16_f32 v91, v94, v95
  v_xor_b32 v8, 65536, v8
  ds_read_b128 v[16:19], v8 offset:0
  s_waitcnt lgkmcnt(3)
  v_mfma_f32_32x32x16_bf16 v[32:47], v[20:23], v[172:175], v[32:47]
  v_permlane16_swap_b32 v80, v88
  v_permlane16_swap_b32 v81, v89
  v_permlane16_swap_b32 v82, v90
  v_mfma_f32_32x32x16_bf16 v[48:63], v[20:23], v[236:239], v[48:63]
  v_permlane16_swap_b32 v83, v91
  v_accvgpr_write_b32 a156, v80
  v_xor_b32 v9, 65536, v9
  ds_read_b128 v[20:23], v9 offset:0
  s_waitcnt lgkmcnt(3)
  v_mfma_f32_32x32x16_bf16 v[32:47], v[24:27], v[176:179], v[32:47]
  v_accvgpr_write_b32 a157, v81
  v_accvgpr_write_b32 a158, v82
  v_accvgpr_write_b32 a159, v83
  v_mfma_f32_32x32x16_bf16 v[48:63], v[24:27], v[240:243], v[48:63]
  v_accvgpr_write_b32 a212, v88
  v_accvgpr_write_b32 a213, v89
  v_xor_b32 v10, 65536, v10
  ds_read_b128 v[24:27], v10 offset:0
  s_waitcnt lgkmcnt(3)
  v_mfma_f32_32x32x16_bf16 v[32:47], v[28:31], v[180:183], v[32:47]
  v_accvgpr_write_b32 a214, v90
  v_accvgpr_write_b32 a215, v91
  v_mfma_f32_32x32x16_bf16 v[48:63], v[28:31], v[244:247], v[48:63]
  v_xor_b32 v11, 65536, v11
  ds_read_b128 v[28:31], v11 offset:0
  s_waitcnt lgkmcnt(3)
  v_mfma_f32_32x32x16_bf16 v[64:79], v[16:19], v[120:123], 0
  buffer_load_dwordx4 v[100:103], v113, s[8:11], s28 offen sc1
  v_mfma_f32_32x32x16_bf16 v[80:95], v[16:19], v[184:187], 0
  v_xor_b32 v12, 65536, v12
  ds_read_b128 v[16:19], v12 offset:0
  s_waitcnt lgkmcnt(3)
  v_mfma_f32_32x32x16_bf16 v[64:79], v[20:23], v[124:127], v[64:79]
  buffer_load_dwordx4 v[104:107], v2, s[8:11], s29 offen sc1
  v_mul_f32 v32, s52, v32
  v_mul_f32 v33, s52, v33
  v_cvt_pk_bf16_f32 v32, v32, v33
  v_mfma_f32_32x32x16_bf16 v[80:95], v[20:23], v[188:191], v[80:95]
  v_mul_f32 v34, s52, v34
  v_mul_f32 v35, s52, v35
  v_xor_b32 v13, 65536, v13
  ds_read_b128 v[20:23], v13 offset:0
  s_waitcnt lgkmcnt(3)
  v_mfma_f32_32x32x16_bf16 v[64:79], v[24:27], v[128:131], v[64:79]
  buffer_load_dwordx4 v[108:111], v112, s[8:11], s29 offen sc1
  v_cvt_pk_bf16_f32 v33, v34, v35
  v_mul_f32 v36, s52, v36
  v_mul_f32 v37, s52, v37
  v_mfma_f32_32x32x16_bf16 v[80:95], v[24:27], v[192:195], v[80:95]
  v_cvt_pk_bf16_f32 v34, v36, v37
  v_mul_f32 v38, s52, v38
  v_xor_b32 v14, 65536, v14
  ds_read_b128 v[24:27], v14 offset:0
  s_waitcnt lgkmcnt(3)
  v_mfma_f32_32x32x16_bf16 v[64:79], v[28:31], v[132:135], v[64:79]
  v_mul_f32 v39, s52, v39
  v_cvt_pk_bf16_f32 v35, v38, v39
  v_mul_f32 v40, s52, v40
  v_mfma_f32_32x32x16_bf16 v[80:95], v[28:31], v[196:199], v[80:95]
  v_mul_f32 v41, s52, v41
  v_cvt_pk_bf16_f32 v40, v40, v41
  v_xor_b32 v15, 65536, v15
  ds_read_b128 v[28:31], v15 offset:0
  s_waitcnt lgkmcnt(3)
  v_mfma_f32_32x32x16_bf16 v[64:79], v[16:19], v[136:139], v[64:79]
  v_mul_f32 v42, s52, v42
  v_mul_f32 v43, s52, v43
  v_cvt_pk_bf16_f32 v41, v42, v43
  v_mfma_f32_32x32x16_bf16 v[80:95], v[16:19], v[200:203], v[80:95]
  v_mul_f32 v44, s52, v44
  v_mul_f32 v45, s52, v45
  ds_read_b128 v[16:19], v8 offset:256
  s_waitcnt lgkmcnt(3)
  v_mfma_f32_32x32x16_bf16 v[64:79], v[20:23], v[140:143], v[64:79]
  v_cvt_pk_bf16_f32 v42, v44, v45
  v_mul_f32 v46, s52, v46
  v_mul_f32 v47, s52, v47
  v_mfma_f32_32x32x16_bf16 v[80:95], v[20:23], v[204:207], v[80:95]
  v_cvt_pk_bf16_f32 v43, v46, v47
  v_permlane16_swap_b32 v32, v40
  ds_read_b128 v[20:23], v9 offset:256
  s_waitcnt lgkmcnt(3)
  v_mfma_f32_32x32x16_bf16 v[64:79], v[24:27], v[144:147], v[64:79]
  v_permlane16_swap_b32 v33, v41
  v_permlane16_swap_b32 v34, v42
  v_permlane16_swap_b32 v35, v43
  v_mfma_f32_32x32x16_bf16 v[80:95], v[24:27], v[208:211], v[80:95]
  v_accvgpr_write_b32 a48, v32
  v_accvgpr_write_b32 a49, v33
  ds_read_b128 v[24:27], v10 offset:256
  s_waitcnt lgkmcnt(3)
  v_mfma_f32_32x32x16_bf16 v[64:79], v[28:31], v[148:151], v[64:79]
  v_accvgpr_write_b32 a50, v34
  v_accvgpr_write_b32 a51, v35
  v_accvgpr_write_b32 a104, v40
  v_mfma_f32_32x32x16_bf16 v[80:95], v[28:31], v[212:215], v[80:95]
  v_accvgpr_write_b32 a105, v41
  v_accvgpr_write_b32 a106, v42
  ds_read_b128 v[28:31], v11 offset:256
  s_waitcnt lgkmcnt(3)
  v_mfma_f32_32x32x16_bf16 v[64:79], v[16:19], v[152:155], v[64:79]
  v_accvgpr_write_b32 a107, v43
  v_mul_f32 v48, s52, v48
  v_mul_f32 v49, s52, v49
  v_mfma_f32_32x32x16_bf16 v[80:95], v[16:19], v[216:219], v[80:95]
  v_cvt_pk_bf16_f32 v48, v48, v49
  v_mul_f32 v50, s52, v50
  ds_read_b128 v[16:19], v12 offset:256
  s_waitcnt lgkmcnt(3)
  v_mfma_f32_32x32x16_bf16 v[64:79], v[20:23], v[156:159], v[64:79]
  v_mul_f32 v51, s52, v51
  v_cvt_pk_bf16_f32 v49, v50, v51
  v_mul_f32 v52, s52, v52
  v_mfma_f32_32x32x16_bf16 v[80:95], v[20:23], v[220:223], v[80:95]
  v_mul_f32 v53, s52, v53
  v_cvt_pk_bf16_f32 v50, v52, v53
  ds_read_b128 v[20:23], v13 offset:256
  s_waitcnt lgkmcnt(3)
  v_mfma_f32_32x32x16_bf16 v[64:79], v[24:27], v[160:163], v[64:79]
  v_mul_f32 v54, s52, v54
  v_mul_f32 v55, s52, v55
  v_cvt_pk_bf16_f32 v51, v54, v55
  v_mfma_f32_32x32x16_bf16 v[80:95], v[24:27], v[224:227], v[80:95]
  v_mul_f32 v56, s52, v56
  v_mul_f32 v57, s52, v57
  ds_read_b128 v[24:27], v14 offset:256
  s_waitcnt lgkmcnt(3)
  v_mfma_f32_32x32x16_bf16 v[64:79], v[28:31], v[164:167], v[64:79]
  v_cvt_pk_bf16_f32 v56, v56, v57
  v_mul_f32 v58, s52, v58
  v_mul_f32 v59, s52, v59
  v_mfma_f32_32x32x16_bf16 v[80:95], v[28:31], v[228:231], v[80:95]
  v_cvt_pk_bf16_f32 v57, v58, v59
  v_mul_f32 v60, s52, v60
  ds_read_b128 v[28:31], v15 offset:256
  s_waitcnt lgkmcnt(3)
  v_mfma_f32_32x32x16_bf16 v[64:79], v[16:19], v[168:171], v[64:79]
  v_mul_f32 v61, s52, v61
  v_cvt_pk_bf16_f32 v58, v60, v61
  v_mul_f32 v62, s52, v62
  v_mfma_f32_32x32x16_bf16 v[80:95], v[16:19], v[232:235], v[80:95]
  v_mul_f32 v63, s52, v63
  v_cvt_pk_bf16_f32 v59, v62, v63
  s_waitcnt lgkmcnt(2)
  v_mfma_f32_32x32x16_bf16 v[64:79], v[20:23], v[172:175], v[64:79]
  v_permlane16_swap_b32 v48, v56
  v_permlane16_swap_b32 v49, v57
  v_permlane16_swap_b32 v50, v58
  v_mfma_f32_32x32x16_bf16 v[80:95], v[20:23], v[236:239], v[80:95]
  v_permlane16_swap_b32 v51, v59
  v_accvgpr_write_b32 a160, v48
  s_waitcnt lgkmcnt(1)
  v_mfma_f32_32x32x16_bf16 v[64:79], v[24:27], v[176:179], v[64:79]
  v_accvgpr_write_b32 a161, v49
  v_accvgpr_write_b32 a162, v50
  v_accvgpr_write_b32 a163, v51
  v_mfma_f32_32x32x16_bf16 v[80:95], v[24:27], v[240:243], v[80:95]
  v_accvgpr_write_b32 a216, v56
  v_accvgpr_write_b32 a217, v57
  s_waitcnt lgkmcnt(0)
  v_mfma_f32_32x32x16_bf16 v[64:79], v[28:31], v[180:183], v[64:79]
  v_accvgpr_write_b32 a218, v58
  v_accvgpr_write_b32 a219, v59
  v_mfma_f32_32x32x16_bf16 v[80:95], v[28:31], v[244:247], v[80:95]
  s_nop 4
  v_mul_f32 v64, s52, v64
  v_mul_f32 v65, s52, v65
  v_cvt_pk_bf16_f32 v64, v64, v65
  v_mul_f32 v66, s52, v66
  v_mul_f32 v67, s52, v67
  v_cvt_pk_bf16_f32 v65, v66, v67
  v_mul_f32 v68, s52, v68
  v_mul_f32 v69, s52, v69
  v_cvt_pk_bf16_f32 v66, v68, v69
  v_mul_f32 v70, s52, v70
  v_mul_f32 v71, s52, v71
  v_cvt_pk_bf16_f32 v67, v70, v71
  v_mul_f32 v72, s52, v72
  v_mul_f32 v73, s52, v73
  v_cvt_pk_bf16_f32 v72, v72, v73
  v_mul_f32 v74, s52, v74
  v_mul_f32 v75, s52, v75
  v_cvt_pk_bf16_f32 v73, v74, v75
  v_mul_f32 v76, s52, v76
  v_mul_f32 v77, s52, v77
  v_cvt_pk_bf16_f32 v74, v76, v77
  v_mul_f32 v78, s52, v78
  v_mul_f32 v79, s52, v79
  v_cvt_pk_bf16_f32 v75, v78, v79
  v_permlane16_swap_b32 v64, v72
  v_permlane16_swap_b32 v65, v73
  v_permlane16_swap_b32 v66, v74
  v_permlane16_swap_b32 v67, v75
  v_accvgpr_write_b32 a52, v64
  v_accvgpr_write_b32 a53, v65
  v_accvgpr_write_b32 a54, v66
  v_accvgpr_write_b32 a55, v67
  v_accvgpr_write_b32 a108, v72
  v_accvgpr_write_b32 a109, v73
  v_accvgpr_write_b32 a110, v74
  v_accvgpr_write_b32 a111, v75
  v_mul_f32 v80, s52, v80
  v_mul_f32 v81, s52, v81
  v_cvt_pk_bf16_f32 v80, v80, v81
  v_mul_f32 v82, s52, v82
  v_mul_f32 v83, s52, v83
  v_cvt_pk_bf16_f32 v81, v82, v83
  v_mul_f32 v84, s52, v84
  v_mul_f32 v85, s52, v85
  v_cvt_pk_bf16_f32 v82, v84, v85
  v_mul_f32 v86, s52, v86
  v_mul_f32 v87, s52, v87
  v_cvt_pk_bf16_f32 v83, v86, v87
  v_mul_f32 v88, s52, v88
  v_mul_f32 v89, s52, v89
  v_cvt_pk_bf16_f32 v88, v88, v89
  v_mul_f32 v90, s52, v90
  v_mul_f32 v91, s52, v91
  v_cvt_pk_bf16_f32 v89, v90, v91
  v_mul_f32 v92, s52, v92
  v_mul_f32 v93, s52, v93
  v_cvt_pk_bf16_f32 v90, v92, v93
  v_mul_f32 v94, s52, v94
  v_mul_f32 v95, s52, v95
  v_cvt_pk_bf16_f32 v91, v94, v95
  v_permlane16_swap_b32 v80, v88
  v_permlane16_swap_b32 v81, v89
  v_permlane16_swap_b32 v82, v90
  v_permlane16_swap_b32 v83, v91
  v_accvgpr_write_b32 a164, v80
  v_accvgpr_write_b32 a165, v81
  v_accvgpr_write_b32 a166, v82
  v_accvgpr_write_b32 a167, v83
  v_accvgpr_write_b32 a220, v88
  v_accvgpr_write_b32 a221, v89
  v_accvgpr_write_b32 a222, v90
  v_accvgpr_write_b32 a223, v91
  s_mov_b32 s30, 0
  s_branch sc_aw_w
sc_aw:
  buffer_load_dwordx4 v[100:103], v113, s[8:11], s28 offen sc1
  buffer_load_dwordx4 v[104:107], v2, s[8:11], s29 offen sc1
  buffer_load_dwordx4 v[108:111], v112, s[8:11], s29 offen sc1
sc_aw_w:
  s_waitcnt vmcnt(0)
  v_cmp_ne_u64 vcc, s[88:89], v[100:101]
  s_cbranch_vccnz sc_aw_no
  v_cmp_ne_u64 vcc, s[88:89], v[102:103]
  s_cbranch_vccnz sc_aw_no
  v_cmp_ne_u64 vcc, s[88:89], v[104:105]
  s_cbranch_vccnz sc_aw_no
  v_cmp_ne_u64 vcc, s[88:89], v[106:107]
  s_cbranch_vccnz sc_aw_no
  v_cmp_ne_u64 vcc, s[88:89], v[108:109]
  s_cbranch_vccnz sc_aw_no
  v_cmp_ne_u64 vcc, s[88:89], v[110:111]
  s_cbranch_vccnz sc_aw_no
  s_branch sc_aw_ok
sc_aw_no:
  s_sleep 1
  s_add_u32 s30, s30, 1
  s_cmp_lt_u32 s30, 50000
  s_cbranch_scc1 sc_aw
  s_branch cA_abort
sc_aw_ok:
  s_barrier
  s_branch m_role
m_val:
  s_cmp_lg_u32 s16, 0
  s_cbranch_scc1 w0_6
  v_mov_b32 v233, 128
  v_mov_b32 v234, s88
  v_mov_b32 v235, s89
  v_mov_b32 v236, 0
  v_mov_b32 v237, 0
  s_mov_b64 exec, 1
  buffer_atomic_cmpswap_x2 v[234:237], v233, s[12:15], 0 offen sc0
  s_mov_b64 exec, -1
w0_6:
  s_cmp_lg_u32 s66, 0
  s_cbranch_scc1 va_ci
  s_cmp_lg_u32 s16, 0
  s_cbranch_scc1 w0_7
  s_lshr_b32 s70, s3, 5
  s_and_b32 s71, s70, 4
  s_mul_i32 s71, s71, 12
  s_lshl_b32 s70, s70, 2
  s_add_u32 s70, s70, s71
  s_lshl_b32 s71, 1, s3
  v_mov_b32 v242, s71
  v_mov_b32 v243, 32
  s_mov_b64 exec, 1
  buffer_atomic_or v242, v243, s[12:15], s70 offen sc0
  buffer_load_dwordx2 v[244:245], v243, s[12:15], 0 offen offset:96 sc1
  s_mov_b64 exec, -1
w0_7:
va_ci:
  s_mov_b32 s56, s40
  s_and_b32 s57, s41, 0xffff
  s_mov_b32 s58, 3670016
  s_mov_b32 s59, 0x20000
  v_lshrrev_b32 v24, 5, v1
  v_and_b32 v25, 31, v1
  v_lshlrev_b32 v25, 4, v25
  v_lshl_add_u32 v24, v24, 13, v25
  s_mov_b32 s60, s42
  s_and_b32 s61, s43, 0xffff
  s_mov_b32 s62, 3670016
  s_mov_b32 s63, 0x20000
  s_lshl_b32 s22, s17, 9
  s_lshl_b32 s23, s16, 19
  s_add_u32 s23, s22, s23
  s_add_u32 s21, s23, 262144
  buffer_load_dwordx4 v[28:31], v24, s[60:63], s21 offen
  s_add_u32 s21, s23, 278528
  buffer_load_dwordx4 v[28:31], v24, s[60:63], s21 offen
  s_add_u32 s21, s23, 294912
  buffer_load_dwordx4 v[28:31], v24, s[60:63], s21 offen
  s_add_u32 s21, s23, 311296
  buffer_load_dwordx4 v[28:31], v24, s[60:63], s21 offen
  s_add_u32 s21, s23, 327680
  buffer_load_dwordx4 v[28:31], v24, s[60:63], s21 offen
  s_add_u32 s21, s23, 344064
  buffer_load_dwordx4 v[28:31], v24, s[60:63], s21 offen
  s_add_u32 s21, s23, 360448
  buffer_load_dwordx4 v[28:31], v24, s[60:63], s21 offen
  s_add_u32 s21, s23, 376832
  buffer_load_dwordx4 v[28:31], v24, s[60:63], s21 offen
  s_add_u32 s21, s23, 393216
  buffer_load_dwordx4 v[28:31], v24, s[60:63], s21 offen
  s_add_u32 s21, s23, 409600
  buffer_load_dwordx4 v[28:31], v24, s[60:63], s21 offen
  s_add_u32 s21, s23, 425984
  buffer_load_dwordx4 v[28:31], v24, s[60:63], s21 offen
  s_add_u32 s21, s23, 442368
  buffer_load_dwordx4 v[28:31], v24, s[60:63], s21 offen
  s_add_u32 s21, s23, 458752
  buffer_load_dwordx4 v[28:31], v24, s[60:63], s21 offen
  s_add_u32 s21, s23, 475136
  buffer_load_dwordx4 v[28:31], v24, s[60:63], s21 offen
  s_add_u32 s21, s23, 491520
  buffer_load_dwordx4 v[28:31], v24, s[60:63], s21 offen
  s_add_u32 s21, s23, 507904
  buffer_load_dwordx4 v[28:31], v24, s[60:63], s21 offen
  s_lshl_b32 s23, s16, 14
  s_add_u32 s22, s22, s23
  s_mov_b32 s30, 0
va_pf:
  buffer_load_dwordx4 v[28:31], v24, s[56:59], s22 offen
  s_waitcnt vmcnt(40)
  s_add_u32 s22, s22, 65536
  s_add_u32 s30, s30, 1
  s_cmp_lt_u32 s30, 28
  s_cbranch_scc1 va_pf
  s_cmp_lg_u32 s66, 0
  s_cbranch_scc1 va_cf
  s_cmp_lg_u32 s16, 0
  s_cbranch_scc1 w0_8
  s_waitcnt vmcnt(40)
  v_readfirstlane_b32 s70, v244
  s_cmp_lg_u32 s70, 0
  s_cbranch_scc1 va_nz
  v_mov_b32 v243, 128
  v_mov_b32 v244, s88
  v_mov_b32 v245, s89
  v_mov_b32 v246, 0
  v_mov_b32 v247, 0
  s_mov_b64 exec, 1
  buffer_atomic_cmpswap_x2 v[244:247], v243, s[12:15], 0 offen sc0
  s_mov_b64 exec, -1
  s_waitcnt vmcnt(0)
  v_readfirstlane_b32 s70, v244
  s_cmp_lg_u32 s70, 0
  s_cbranch_scc1 va_nz
  v_mov_b32 v244, s88
  v_mov_b32 v245, s89
va_nz:
w0_8:
  v_mov_b32 v243, 160000
  s_add_u32 s101, s101, 1
  s_barrier
  s_mov_b64 exec, 1
  s_cmp_lg_u32 s16, 0
  s_cbranch_scc1 w0_9
  ds_write_b32 v243, v242 offset:0
  ds_write_b32 v243, v244 offset:4
  ds_write_b32 v243, v245 offset:8
  s_waitcnt lgkmcnt(0)
  v_mov_b32 v242, s101
  ds_write_b32 v243, v242 offset:16
  s_waitcnt lgkmcnt(0)
w0_9:
  s_mov_b64 exec, -1
  s_barrier
  ds_read_b32 v242, v243 offset:0
  ds_read_b32 v244, v243 offset:4
  ds_read_b32 v245, v243 offset:8
  ds_read_b32 v243, v243 offset:16
  s_waitcnt lgkmcnt(0)
  v_readfirstlane_b32 s70, v242
  v_readfirstlane_b32 s88, v244
  v_readfirstlane_b32 s89, v245
  v_cmp_ne_u32 vcc, s101, v243
  s_cbranch_vccnz ch_end
  s_mov_b32 s66, 1
  s_bitcmp1_b32 s70, s3
  s_cbranch_scc1 m_reclaim
va_cf:
  s_cmp_lg_u32 s16, 0
  s_cbranch_scc1 w0_10
  s_cmp_eq_u32 s67, 0
  s_cselect_b32 s20, 1, 0x10001
  v_mov_b32 v242, s20
  v_mov_b32 v243, 0
  s_mov_b64 exec, 1
  buffer_atomic_add v242, v243, s[12:15], 0 offen
  s_mov_b64 exec, -1
w0_10:
m_role:
  s_mov_b32 s17, s3
  v_and_b32 v1, 63, v0
  v_lshlrev_b32 v2, 4, v1
  v_lshrrev_b32 v116, 4, v1
  v_and_b32 v117, 15, v1
  v_mov_b32 v3, 0x4444
  v_mov_b32 v118, 0xeeee
  v_cmp_lt_u32 vcc, 7, v117
  s_nop 1
  v_cndmask_b32 v3, v3, v118, vcc
  s_mov_b32 s19, 0
  s_mov_b32 s20, 75235328
  s_lshr_b32 s22, s17, 4
  s_lshl_b32 s22, s22, 2
  s_add_u32 s22, s22, s16
  s_and_b32 s17, s17, 15
  s_cmp_eq_u32 s22, 0
  s_cbranch_scc1 ch_init0
  s_cmp_eq_u32 s22, 1
  s_cbranch_scc1 ch_init1
  s_cmp_eq_u32 s22, 2
  s_cbranch_scc1 ch_init2
  s_cmp_eq_u32 s22, 3
  s_cbranch_scc1 ch_init3
  s_cmp_eq_u32 s22, 4
  s_cbranch_scc1 ch_init4
  s_cmp_eq_u32 s22, 5
  s_cbranch_scc1 ch_init5
  s_cmp_eq_u32 s22, 6
  s_cbranch_scc1 ch_init6
  s_cmp_eq_u32 s22, 7
  s_cbranch_scc1 ch_init7
  s_branch ch_end
ch_init0:
  s_mul_i32 s31, s17, 401408
  s_add_u32 s31, s31, 0
  s_add_u32 s22, s31, 229376
  buffer_load_dwordx4 a[224:227], v2, s[8:11], s22 offen offset:0 sc1
  buffer_load_dwordx4 a[228:231], v2, s[8:11], s22 offen offset:1024 sc1
  buffer_load_dwordx4 a[232:235], v2, s[8:11], s22 offen offset:2048 sc1
  buffer_load_dwordx4 a[236:239], v2, s[8:11], s22 offen offset:3072 sc1
  s_add_u32 s22, s31, 233472
  buffer_load_dwordx4 a[240:243], v2, s[8:11], s22 offen offset:0 sc1
  buffer_load_dwordx4 a[244:247], v2, s[8:11], s22 offen offset:1024 sc1
  buffer_load_dwordx4 a[248:251], v2, s[8:11], s22 offen offset:2048 sc1
  buffer_load_dwordx4 a[252:255], v2, s[8:11], s22 offen offset:3072 sc1
  s_add_u32 s22, s31, 237568
  buffer_load_dwordx4 v[120:123], v2, s[8:11], s22 offen offset:0 sc1
  buffer_load_dwordx4 v[124:127], v2, s[8:11], s22 offen offset:1024 sc1
  buffer_load_dwordx4 v[128:131], v2, s[8:11], s22 offen offset:2048 sc1
  buffer_load_dwordx4 v[132:135], v2, s[8:11], s22 offen offset:3072 sc1
  s_add_u32 s22, s31, 241664
  buffer_load_dwordx4 v[136:139], v2, s[8:11], s22 offen offset:0 sc1
  buffer_load_dwordx4 v[140:143], v2, s[8:11], s22 offen offset:1024 sc1
  buffer_load_dwordx4 v[144:147], v2, s[8:11], s22 offen offset:2048 sc1
  buffer_load_dwordx4 v[148:151], v2, s[8:11], s22 offen offset:3072 sc1
  s_add_u32 s22, s31, 245760
  buffer_load_dwordx4 v[152:155], v2, s[8:11], s22 offen offset:0 sc1
  buffer_load_dwordx4 v[156:159], v2, s[8:11], s22 offen offset:1024 sc1
  buffer_load_dwordx4 v[160:163], v2, s[8:11], s22 offen offset:2048 sc1
  buffer_load_dwordx4 v[164:167], v2, s[8:11], s22 offen offset:3072 sc1
  s_add_u32 s22, s31, 249856
  buffer_load_dwordx4 v[168:171], v2, s[8:11], s22 offen offset:0 sc1
  buffer_load_dwordx4 v[172:175], v2, s[8:11], s22 offen offset:1024 sc1
  buffer_load_dwordx4 v[176:179], v2, s[8:11], s22 offen offset:2048 sc1
  buffer_load_dwordx4 v[180:183], v2, s[8:11], s22 offen offset:3072 sc1
  s_add_u32 s22, s31, 253952
  buffer_load_dwordx4 v[184:187], v2, s[8:11], s22 offen offset:0 sc1
  buffer_load_dwordx4 v[188:191], v2, s[8:11], s22 offen offset:1024 sc1
  buffer_load_dwordx4 v[192:195], v2, s[8:11], s22 offen offset:2048 sc1
  buffer_load_dwordx4 v[196:199], v2, s[8:11], s22 offen offset:3072 sc1
  s_add_u32 s22, s31, 344064
  buffer_load_dwordx4 v[200:203], v2, s[8:11], s22 offen offset:0 sc1
  buffer_load_dwordx4 v[204:207], v2, s[8:11], s22 offen offset:1024 sc1
  buffer_load_dwordx4 v[208:211], v2, s[8:11], s22 offen offset:2048 sc1
  buffer_load_dwordx4 v[212:215], v2, s[8:11], s22 offen offset:3072 sc1
  s_waitcnt vmcnt(24)
  s_add_u32 s22, s31, 348160
  buffer_load_dwordx4 v[216:219], v2, s[8:11], s22 offen offset:0 sc1
  buffer_load_dwordx4 v[220:223], v2, s[8:11], s22 offen offset:1024 sc1
  buffer_load_dwordx4 v[224:227], v2, s[8:11], s22 offen offset:2048 sc1
  buffer_load_dwordx4 v[228:231], v2, s[8:11], s22 offen offset:3072 sc1
  s_add_u32 s22, s31, 352256
  buffer_load_dwordx4 v[232:235], v2, s[8:11], s22 offen offset:0 sc1
  buffer_load_dwordx4 v[236:239], v2, s[8:11], s22 offen offset:1024 sc1
  buffer_load_dwordx4 v[240:243], v2, s[8:11], s22 offen offset:2048 sc1
  buffer_load_dwordx4 v[244:247], v2, s[8:11], s22 offen offset:3072 sc1
  s_add_u32 s22, s31, 356352
  buffer_load_dwordx4 v[248:251], v2, s[8:11], s22 offen offset:0 sc1
  buffer_load_dwordx4 v[252:255], v2, s[8:11], s22 offen offset:1024 sc1
  s_mov_b32 s24, 71565312
  s_mov_b32 s25, 0
  s_add_u32 m0, s25, 0
  s_nop 0
  buffer_load_dwordx4 v2, s[8:11], s24 offen offset:0 sc1 lds
  buffer_load_dwordx4 v2, s[8:11], s24 offen offset:1024 sc1 lds
  buffer_load_dwordx4 v2, s[8:11], s24 offen offset:2048 sc1 lds
  buffer_load_dwordx4 v2, s[8:11], s24 offen offset:3072 sc1 lds
  s_add_u32 m0, s25, 4096
  s_add_u32 s22, s24, 4096
  buffer_load_dwordx4 v2, s[8:11], s22 offen offset:0 sc1 lds
  buffer_load_dwordx4 v2, s[8:11], s22 offen offset:1024 sc1 lds
  buffer_load_dwordx4 v2, s[8:11], s22 offen offset:2048 sc1 lds
  v_and_b32 v64, 7, v117
  v_and_b32 v65, 1, v116
  v_lshlrev_b32 v65, 2, v65
  v_sub_u32 v64, v64, v65
  v_lshrrev_b32 v65, 3, v117
  v_lshl_add_u32 v66, v65, 2, v64
  v_cmp_gt_u32 vcc, 4, v64
  v_mov_b32 v67, 99
  s_nop 0
  v_cndmask_b32 v66, v67, v66, vcc
  v_mov_b32 v68, 0x3f80
  v_mov_b32 v69, 0x3f800000
  v_mov_b32 v4, 0
  v_cmp_eq_u32 vcc, 0, v66
  s_nop 1
  v_cndmask_b32 v4, v4, v68, vcc
  v_cmp_eq_u32 vcc, 1, v66
  s_nop 1
  v_cndmask_b32 v4, v4, v69, vcc
  v_mov_b32 v5, 0
  v_cmp_eq_u32 vcc, 2, v66
  s_nop 1
  v_cndmask_b32 v5, v5, v68, vcc
  v_cmp_eq_u32 vcc, 3, v66
  s_nop 1
  v_cndmask_b32 v5, v5, v69, vcc
  v_mov_b32 v6, 0
  v_cmp_eq_u32 vcc, 4, v66
  s_nop 1
  v_cndmask_b32 v6, v6, v68, vcc
  v_cmp_eq_u32 vcc, 5, v66
  s_nop 1
  v_cndmask_b32 v6, v6, v69, vcc
  v_mov_b32 v7, 0
  v_cmp_eq_u32 vcc, 6, v66
  s_nop 1
  v_cndmask_b32 v7, v7, v68, vcc
  v_cmp_eq_u32 vcc, 7, v66
  s_nop 1
  v_cndmask_b32 v7, v7, v69, vcc
  v_lshrrev_b32 v64, 1, v116
  v_lshrrev_b32 v65, 3, v117
  v_cmp_eq_u32 s[26:27], v64, v65
  v_and_b32 v66, 1, v116
  v_add_u32 v64, 0, v64
  v_lshrrev_b32 v67, 1, v116
  v_lshlrev_b32 v67, 8, v67
  v_lshl_add_u32 v67, v66, 9, v67
  v_lshl_add_u32 v67, v117, 4, v67
  v_add_u32 v112, 57344, v67
  v_and_b32 v68, 7, v117
  v_lshlrev_b32 v67, 8, v64
  v_lshl_add_u32 v67, v68, 5, v67
  v_lshl_add_u32 v67, v66, 4, v67
  v_add_u32 v113, 65536, v67
  v_lshrrev_b32 v64, 5, v1
  v_and_b32 v65, 31, v1
  v_lshrrev_b32 v66, 3, v65
  v_and_b32 v67, 7, v65
  v_and_b32 v68, 3, v67
  v_lshl_add_u32 v68, v66, 2, v68
  v_lshrrev_b32 v69, 2, v67
  v_lshl_add_u32 v68, v69, 4, v68
  v_lshlrev_b32 v69, 11, v64
  v_lshl_add_u32 v69, v68, 4, v69
  v_add_u32 v114, 57344, v69
  v_add_u32 v70, 0, v64
  v_lshlrev_b32 v69, 9, v66
  v_lshl_add_u32 v69, v70, 5, v69
  v_lshl_add_u32 v69, v67, 2, v69
  v_add_u32 v115, 65536, v69
  v_and_b32 v71, 1, v1
  v_cmp_eq_u32 s[38:39], 0, v71
  v_cmp_gt_u32 vcc, 8, v65
  s_or_b64 s[28:29], s[38:39], vcc
  v_lshrrev_b32 v72, 1, v67
  v_lshlrev_b32 v72, 2, v72
  v_lshl_add_u32 v72, v70, 4, v72
  s_lshl_b32 s22, s17, 9
  s_add_u32 s22, s22, 9216
  v_lshl_add_u32 v73, v66, 7, v72
  v_add_u32 v73, s22, v73
  s_lshl_b32 s22, s17, 7
  s_add_u32 s22, s22, 7168
  v_add_u32 v74, s22, v72
  v_bfe_u32 v72, v65, 1, 1
  v_lshlrev_b32 v72, 7, v72
  v_lshl_add_u32 v72, v70, 4, v72
  v_bfe_u32 v73, v65, 2, 2
  v_lshl_add_u32 v72, v73, 2, v72
  v_lshrrev_b32 v73, 4, v65
  v_lshl_add_u32 v73, v73, 8, v72
  s_lshl_b32 s22, s17, 9
  s_add_u32 s22, s22, 9216
  v_add_u32 v73, s22, v73
  s_lshr_b32 s22, s17, 1
  s_lshl_b32 s22, s22, 8
  s_and_b32 s34, s17, 1
  s_lshl_b32 s34, s34, 3
  s_add_u32 s22, s22, s34
  s_add_u32 s22, s22, 7168
  v_add_u32 v74, s22, v72
  v_lshlrev_b32 v0, 2, v65
  s_and_b32 s22, s17, 31
  s_lshl_b32 s22, s22, 7
  s_add_u32 s22, s22, 21504
  v_add_u32 v0, s22, v0
  v_cndmask_b32 v1, v74, v73, s[38:39]
  s_lshl_b32 s36, s17, 2
  s_add_u32 s36, s36, 17408
  s_mov_b32 s37, 0x3e800000
  v_mov_b32 v64, 0
  v_mov_b32 v65, 0
  v_mov_b32 v66, 0
  v_mov_b32 v67, 0
  v_mov_b32 v68, 0
  v_mov_b32 v69, 0
  v_mov_b32 v70, 0
  v_mov_b32 v71, 0
  v_mov_b32 v72, 0
  v_mov_b32 v73, 0
  v_mov_b32 v74, 0
  v_mov_b32 v75, 0
  v_mov_b32 v76, 0
  v_mov_b32 v77, 0
  v_mov_b32 v78, 0
  v_mov_b32 v79, 0
  v_mov_b32 v80, 0
  v_mov_b32 v81, 0
  v_mov_b32 v82, 0
  v_mov_b32 v83, 0
  v_mov_b32 v84, 0
  v_mov_b32 v85, 0
  v_mov_b32 v86, 0
  v_mov_b32 v87, 0
  v_mov_b32 v88, 0
  v_mov_b32 v89, 0
  v_mov_b32 v90, 0
  v_mov_b32 v91, 0
  v_mov_b32 v92, 0
  v_mov_b32 v93, 0
  v_mov_b32 v94, 0
  v_mov_b32 v95, 0
  v_mov_b32 v96, 0
  v_mov_b32 v97, 0
  v_mov_b32 v98, 0
  v_mov_b32 v99, 0
  v_mov_b32 v100, 0
  v_mov_b32 v101, 0
  v_mov_b32 v102, 0
  v_mov_b32 v103, 0
  v_mov_b32 v104, 0
  v_mov_b32 v105, 0
  v_mov_b32 v106, 0
  v_mov_b32 v107, 0
  v_mov_b32 v108, 0
  v_mov_b32 v109, 0
  v_mov_b32 v110, 0
  v_mov_b32 v111, 0
  v_and_b32 v118, 1, v116
  v_cmp_eq_u32 vcc, 0, v118
  v_mov_b32 v118, 12288
  v_mov_b32 v119, 8192
  v_cndmask_b32 v118, v118, v119, vcc
  v_lshrrev_b32 v116, 1, v116
  v_lshl_add_u32 v118, v116, 9, v118
  v_lshl_add_u32 v117, v117, 4, v118
  s_mov_b32 s57, 28672
  s_mov_b32 s56, 0x42800000
  v_mov_b32 v116, v2
  s_mul_i32 s35, s17, 1835008
  s_add_u32 s35, s35, 42262528
  s_mov_b32 s30, 0
  v_mov_b32 v36, 0
ch_md0:
  buffer_load_dword v37, v36, s[12:15], 0 offen sc1
  s_waitcnt vmcnt(0)
  v_readfirstlane_b32 s22, v37
  s_and_b32 s31, s22, 0xffff
  s_cmp_ge_u32 s31, 32
  s_cbranch_scc1 ch_go0
  s_sleep 2
  s_add_u32 s30, s30, 1
  s_cmp_lt_u32 s30, 50000
  s_cbranch_scc1 ch_md0
  s_branch ch_end
ch_go0:
  s_mov_b32 s31, 0
  s_lshr_b32 s22, s22, 16
  s_cmp_lg_u32 s22, 0
  s_cbranch_scc1 cB_sc0_loop
  s_branch cA_sc0_loop
ch_init1:
  s_mul_i32 s31, s17, 401408
  s_add_u32 s31, s31, 0
  s_add_u32 s22, s31, 258048
  buffer_load_dwordx4 a[224:227], v2, s[8:11], s22 offen offset:0 sc1
  buffer_load_dwordx4 a[228:231], v2, s[8:11], s22 offen offset:1024 sc1
  buffer_load_dwordx4 a[232:235], v2, s[8:11], s22 offen offset:2048 sc1
  buffer_load_dwordx4 a[236:239], v2, s[8:11], s22 offen offset:3072 sc1
  s_add_u32 s22, s31, 262144
  buffer_load_dwordx4 a[240:243], v2, s[8:11], s22 offen offset:0 sc1
  buffer_load_dwordx4 a[244:247], v2, s[8:11], s22 offen offset:1024 sc1
  buffer_load_dwordx4 a[248:251], v2, s[8:11], s22 offen offset:2048 sc1
  buffer_load_dwordx4 a[252:255], v2, s[8:11], s22 offen offset:3072 sc1
  s_add_u32 s22, s31, 266240
  buffer_load_dwordx4 v[120:123], v2, s[8:11], s22 offen offset:0 sc1
  buffer_load_dwordx4 v[124:127], v2, s[8:11], s22 offen offset:1024 sc1
  buffer_load_dwordx4 v[128:131], v2, s[8:11], s22 offen offset:2048 sc1
  buffer_load_dwordx4 v[132:135], v2, s[8:11], s22 offen offset:3072 sc1
  s_add_u32 s22, s31, 270336
  buffer_load_dwordx4 v[136:139], v2, s[8:11], s22 offen offset:0 sc1
  buffer_load_dwordx4 v[140:143], v2, s[8:11], s22 offen offset:1024 sc1
  buffer_load_dwordx4 v[144:147], v2, s[8:11], s22 offen offset:2048 sc1
  buffer_load_dwordx4 v[148:151], v2, s[8:11], s22 offen offset:3072 sc1
  s_add_u32 s22, s31, 274432
  buffer_load_dwordx4 v[152:155], v2, s[8:11], s22 offen offset:0 sc1
  buffer_load_dwordx4 v[156:159], v2, s[8:11], s22 offen offset:1024 sc1
  buffer_load_dwordx4 v[160:163], v2, s[8:11], s22 offen offset:2048 sc1
  buffer_load_dwordx4 v[164:167], v2, s[8:11], s22 offen offset:3072 sc1
  s_add_u32 s22, s31, 278528
  buffer_load_dwordx4 v[168:171], v2, s[8:11], s22 offen offset:0 sc1
  buffer_load_dwordx4 v[172:175], v2, s[8:11], s22 offen offset:1024 sc1
  buffer_load_dwordx4 v[176:179], v2, s[8:11], s22 offen offset:2048 sc1
  buffer_load_dwordx4 v[180:183], v2, s[8:11], s22 offen offset:3072 sc1
  s_add_u32 s22, s31, 282624
  buffer_load_dwordx4 v[184:187], v2, s[8:11], s22 offen offset:0 sc1
  buffer_load_dwordx4 v[188:191], v2, s[8:11], s22 offen offset:1024 sc1
  buffer_load_dwordx4 v[192:195], v2, s[8:11], s22 offen offset:2048 sc1
  buffer_load_dwordx4 v[196:199], v2, s[8:11], s22 offen offset:3072 sc1
  s_add_u32 s22, s31, 356352
  buffer_load_dwordx4 v[200:203], v2, s[8:11], s22 offen offset:2048 sc1
  buffer_load_dwordx4 v[204:207], v2, s[8:11], s22 offen offset:3072 sc1
  s_add_u32 s22, s31, 360448
  buffer_load_dwordx4 v[208:211], v2, s[8:11], s22 offen offset:0 sc1
  buffer_load_dwordx4 v[212:215], v2, s[8:11], s22 offen offset:1024 sc1
  s_waitcnt vmcnt(24)
  buffer_load_dwordx4 v[216:219], v2, s[8:11], s22 offen offset:2048 sc1
  buffer_load_dwordx4 v[220:223], v2, s[8:11], s22 offen offset:3072 sc1
  s_add_u32 s22, s31, 364544
  buffer_load_dwordx4 v[224:227], v2, s[8:11], s22 offen offset:0 sc1
  buffer_load_dwordx4 v[228:231], v2, s[8:11], s22 offen offset:1024 sc1
  buffer_load_dwordx4 v[232:235], v2, s[8:11], s22 offen offset:2048 sc1
  buffer_load_dwordx4 v[236:239], v2, s[8:11], s22 offen offset:3072 sc1
  s_add_u32 s22, s31, 368640
  buffer_load_dwordx4 v[240:243], v2, s[8:11], s22 offen offset:0 sc1
  buffer_load_dwordx4 v[244:247], v2, s[8:11], s22 offen offset:1024 sc1
  buffer_load_dwordx4 v[248:251], v2, s[8:11], s22 offen offset:2048 sc1
  buffer_load_dwordx4 v[252:255], v2, s[8:11], s22 offen offset:3072 sc1
  s_mov_b32 s24, 71572480
  s_mov_b32 s25, 0
  s_add_u32 m0, s25, 7168
  s_nop 0
  buffer_load_dwordx4 v2, s[8:11], s24 offen offset:0 sc1 lds
  buffer_load_dwordx4 v2, s[8:11], s24 offen offset:1024 sc1 lds
  buffer_load_dwordx4 v2, s[8:11], s24 offen offset:2048 sc1 lds
  buffer_load_dwordx4 v2, s[8:11], s24 offen offset:3072 sc1 lds
  s_add_u32 m0, s25, 11264
  s_add_u32 s22, s24, 4096
  buffer_load_dwordx4 v2, s[8:11], s22 offen offset:0 sc1 lds
  buffer_load_dwordx4 v2, s[8:11], s22 offen offset:1024 sc1 lds
  buffer_load_dwordx4 v2, s[8:11], s22 offen offset:2048 sc1 lds
  v_and_b32 v64, 7, v117
  v_and_b32 v65, 1, v116
  v_lshlrev_b32 v65, 2, v65
  v_sub_u32 v64, v64, v65
  v_lshrrev_b32 v65, 3, v117
  v_lshl_add_u32 v66, v65, 2, v64
  v_cmp_gt_u32 vcc, 4, v64
  v_mov_b32 v67, 99
  s_nop 0
  v_cndmask_b32 v66, v67, v66, vcc
  v_mov_b32 v68, 0x3f80
  v_mov_b32 v69, 0x3f800000
  v_mov_b32 v4, 0
  v_cmp_eq_u32 vcc, 0, v66
  s_nop 1
  v_cndmask_b32 v4, v4, v68, vcc
  v_cmp_eq_u32 vcc, 1, v66
  s_nop 1
  v_cndmask_b32 v4, v4, v69, vcc
  v_mov_b32 v5, 0
  v_cmp_eq_u32 vcc, 2, v66
  s_nop 1
  v_cndmask_b32 v5, v5, v68, vcc
  v_cmp_eq_u32 vcc, 3, v66
  s_nop 1
  v_cndmask_b32 v5, v5, v69, vcc
  v_mov_b32 v6, 0
  v_cmp_eq_u32 vcc, 4, v66
  s_nop 1
  v_cndmask_b32 v6, v6, v68, vcc
  v_cmp_eq_u32 vcc, 5, v66
  s_nop 1
  v_cndmask_b32 v6, v6, v69, vcc
  v_mov_b32 v7, 0
  v_cmp_eq_u32 vcc, 6, v66
  s_nop 1
  v_cndmask_b32 v7, v7, v68, vcc
  v_cmp_eq_u32 vcc, 7, v66
  s_nop 1
  v_cndmask_b32 v7, v7, v69, vcc
  v_lshrrev_b32 v64, 1, v116
  v_lshrrev_b32 v65, 3, v117
  v_cmp_eq_u32 s[26:27], v64, v65
  v_and_b32 v66, 1, v116
  v_add_u32 v64, 2, v64
  v_lshrrev_b32 v67, 1, v116
  v_lshlrev_b32 v67, 8, v67
  v_lshl_add_u32 v67, v66, 9, v67
  v_lshl_add_u32 v67, v117, 4, v67
  v_add_u32 v112, 58368, v67
  v_and_b32 v68, 7, v117
  v_lshlrev_b32 v67, 8, v64
  v_lshl_add_u32 v67, v68, 5, v67
  v_lshl_add_u32 v67, v66, 4, v67
  v_add_u32 v113, 65536, v67
  v_lshrrev_b32 v64, 5, v1
  v_and_b32 v65, 31, v1
  v_lshrrev_b32 v66, 3, v65
  v_and_b32 v67, 7, v65
  v_and_b32 v68, 3, v67
  v_lshl_add_u32 v68, v66, 2, v68
  v_lshrrev_b32 v69, 2, v67
  v_lshl_add_u32 v68, v69, 4, v68
  v_lshlrev_b32 v69, 11, v64
  v_lshl_add_u32 v69, v68, 4, v69
  v_add_u32 v114, 57352, v69
  v_add_u32 v70, 2, v64
  v_lshlrev_b32 v69, 9, v66
  v_lshl_add_u32 v69, v70, 5, v69
  v_lshl_add_u32 v69, v67, 2, v69
  v_add_u32 v115, 65536, v69
  v_and_b32 v71, 1, v1
  v_cmp_eq_u32 s[38:39], 0, v71
  v_cmp_gt_u32 vcc, 8, v65
  s_or_b64 s[28:29], s[38:39], vcc
  v_lshrrev_b32 v72, 1, v67
  v_lshlrev_b32 v72, 2, v72
  v_lshl_add_u32 v72, v70, 4, v72
  s_lshl_b32 s22, s17, 9
  s_add_u32 s22, s22, 9216
  v_lshl_add_u32 v73, v66, 7, v72
  v_add_u32 v73, s22, v73
  s_lshl_b32 s22, s17, 7
  s_add_u32 s22, s22, 7168
  v_add_u32 v74, s22, v72
  v_bfe_u32 v72, v65, 1, 1
  v_lshlrev_b32 v72, 7, v72
  v_lshl_add_u32 v72, v70, 4, v72
  v_bfe_u32 v73, v65, 2, 2
  v_lshl_add_u32 v72, v73, 2, v72
  v_lshrrev_b32 v73, 4, v65
  v_lshl_add_u32 v73, v73, 8, v72
  s_lshl_b32 s22, s17, 9
  s_add_u32 s22, s22, 9216
  v_add_u32 v73, s22, v73
  s_lshr_b32 s22, s17, 1
  s_lshl_b32 s22, s22, 8
  s_and_b32 s34, s17, 1
  s_lshl_b32 s34, s34, 3
  s_add_u32 s22, s22, s34
  s_add_u32 s22, s22, 7168
  v_add_u32 v74, s22, v72
  v_lshlrev_b32 v0, 2, v65
  s_and_b32 s22, s17, 31
  s_lshl_b32 s22, s22, 7
  s_add_u32 s22, s22, 21504
  v_add_u32 v0, s22, v0
  v_cndmask_b32 v1, v74, v73, s[38:39]
  s_lshl_b32 s36, s17, 2
  s_add_u32 s36, s36, 17408
  s_mov_b32 s37, 0x3e800000
  v_mov_b32 v64, 0
  v_mov_b32 v65, 0
  v_mov_b32 v66, 0
  v_mov_b32 v67, 0
  v_mov_b32 v68, 0
  v_mov_b32 v69, 0
  v_mov_b32 v70, 0
  v_mov_b32 v71, 0
  v_mov_b32 v72, 0
  v_mov_b32 v73, 0
  v_mov_b32 v74, 0
  v_mov_b32 v75, 0
  v_mov_b32 v76, 0
  v_mov_b32 v77, 0
  v_mov_b32 v78, 0
  v_mov_b32 v79, 0
  v_mov_b32 v80, 0
  v_mov_b32 v81, 0
  v_mov_b32 v82, 0
  v_mov_b32 v83, 0
  v_mov_b32 v84, 0
  v_mov_b32 v85, 0
  v_mov_b32 v86, 0
  v_mov_b32 v87, 0
  v_mov_b32 v88, 0
  v_mov_b32 v89, 0
  v_mov_b32 v90, 0
  v_mov_b32 v91, 0
  v_mov_b32 v92, 0
  v_mov_b32 v93, 0
  v_mov_b32 v94, 0
  v_mov_b32 v95, 0
  v_mov_b32 v96, 0
  v_mov_b32 v97, 0
  v_mov_b32 v98, 0
  v_mov_b32 v99, 0
  v_mov_b32 v100, 0
  v_mov_b32 v101, 0
  v_mov_b32 v102, 0
  v_mov_b32 v103, 0
  v_mov_b32 v104, 0
  v_mov_b32 v105, 0
  v_mov_b32 v106, 0
  v_mov_b32 v107, 0
  v_mov_b32 v108, 0
  v_mov_b32 v109, 0
  v_mov_b32 v110, 0
  v_mov_b32 v111, 0
  v_and_b32 v118, 1, v116
  v_cmp_eq_u32 vcc, 0, v118
  v_mov_b32 v118, 12288
  v_mov_b32 v119, 8448
  v_cndmask_b32 v118, v118, v119, vcc
  v_lshrrev_b32 v116, 1, v116
  v_lshl_add_u32 v118, v116, 9, v118
  v_lshl_add_u32 v117, v117, 4, v118
  s_mov_b32 s57, 28672
  s_mov_b32 s56, 0x42800000
  v_mov_b32 v116, v2
  v_lshrrev_b32 v0, 4, v2
  v_min_u32 v0, 12, v0
  s_mul_i32 s22, s17, 13
  v_add_u32 v0, s22, v0
  v_lshlrev_b32 v0, 7, v0
  v_add_u32 v0, 51200, v0
  s_mov_b32 s22, 75209728
  buffer_load_dword v119, v0, s[8:11], s22 offen sc1
  s_mov_b32 s22, 75184128
  buffer_load_dword v119, v0, s[8:11], s22 offen sc1
  s_mul_i32 s35, s17, 1835008
  s_add_u32 s35, s35, 42269696
  s_mov_b32 s30, 0
  v_mov_b32 v36, 0
ch_md1:
  buffer_load_dword v37, v36, s[12:15], 0 offen sc1
  s_waitcnt vmcnt(0)
  v_readfirstlane_b32 s22, v37
  s_and_b32 s31, s22, 0xffff
  s_cmp_ge_u32 s31, 32
  s_cbranch_scc1 ch_go1
  s_sleep 2
  s_add_u32 s30, s30, 1
  s_cmp_lt_u32 s30, 50000
  s_cbranch_scc1 ch_md1
  s_branch ch_end
ch_go1:
  s_mov_b32 s31, 0
  s_lshr_b32 s22, s22, 16
  s_cmp_lg_u32 s22, 0
  s_cbranch_scc1 cB_sc1_loop
  s_branch cA_sc1_loop
ch_init2:
  s_mul_i32 s31, s17, 401408
  s_add_u32 s31, s31, 0
  s_add_u32 s22, s31, 286720
  buffer_load_dwordx4 a[224:227], v2, s[8:11], s22 offen offset:0 sc1
  buffer_load_dwordx4 a[228:231], v2, s[8:11], s22 offen offset:1024 sc1
  buffer_load_dwordx4 a[232:235], v2, s[8:11], s22 offen offset:2048 sc1
  buffer_load_dwordx4 a[236:239], v2, s[8:11], s22 offen offset:3072 sc1
  s_add_u32 s22, s31, 290816
  buffer_load_dwordx4 a[240:243], v2, s[8:11], s22 offen offset:0 sc1
  buffer_load_dwordx4 a[244:247], v2, s[8:11], s22 offen offset:1024 sc1
  buffer_load_dwordx4 a[248:251], v2, s[8:11], s22 offen offset:2048 sc1
  buffer_load_dwordx4 a[252:255], v2, s[8:11], s22 offen offset:3072 sc1
  s_add_u32 s22, s31, 294912
  buffer_load_dwordx4 v[120:123], v2, s[8:11], s22 offen offset:0 sc1
  buffer_load_dwordx4 v[124:127], v2, s[8:11], s22 offen offset:1024 sc1
  buffer_load_dwordx4 v[128:131], v2, s[8:11], s22 offen offset:2048 sc1
  buffer_load_dwordx4 v[132:135], v2, s[8:11], s22 offen offset:3072 sc1
  s_add_u32 s22, s31, 299008
  buffer_load_dwordx4 v[136:139], v2, s[8:11], s22 offen offset:0 sc1
  buffer_load_dwordx4 v[140:143], v2, s[8:11], s22 offen offset:1024 sc1
  buffer_load_dwordx4 v[144:147], v2, s[8:11], s22 offen offset:2048 sc1
  buffer_load_dwordx4 v[148:151], v2, s[8:11], s22 offen offset:3072 sc1
  s_add_u32 s22, s31, 303104
  buffer_load_dwordx4 v[152:155], v2, s[8:11], s22 offen offset:0 sc1
  buffer_load_dwordx4 v[156:159], v2, s[8:11], s22 offen offset:1024 sc1
  buffer_load_dwordx4 v[160:163], v2, s[8:11], s22 offen offset:2048 sc1
  buffer_load_dwordx4 v[164:167], v2, s[8:11], s22 offen offset:3072 sc1
  s_add_u32 s22, s31, 307200
  buffer_load_dwordx4 v[168:171], v2, s[8:11], s22 offen offset:0 sc1
  buffer_load_dwordx4 v[172:175], v2, s[8:11], s22 offen offset:1024 sc1
  buffer_load_dwordx4 v[176:179], v2, s[8:11], s22 offen offset:2048 sc1
  buffer_load_dwordx4 v[180:183], v2, s[8:11], s22 offen offset:3072 sc1
  s_add_u32 s22, s31, 311296
  buffer_load_dwordx4 v[184:187], v2, s[8:11], s22 offen offset:0 sc1
  buffer_load_dwordx4 v[188:191], v2, s[8:11], s22 offen offset:1024 sc1
  buffer_load_dwordx4 v[192:195], v2, s[8:11], s22 offen offset:2048 sc1
  buffer_load_dwordx4 v[196:199], v2, s[8:11], s22 offen offset:3072 sc1
  s_add_u32 s22, s31, 372736
  buffer_load_dwordx4 v[200:203], v2, s[8:11], s22 offen offset:0 sc1
  buffer_load_dwordx4 v[204:207], v2, s[8:11], s22 offen offset:1024 sc1
  buffer_load_dwordx4 v[208:211], v2, s[8:11], s22 offen offset:2048 sc1
  buffer_load_dwordx4 v[212:215], v2, s[8:11], s22 offen offset:3072 sc1
  s_waitcnt vmcnt(24)
  s_add_u32 s22, s31, 376832
  buffer_load_dwordx4 v[216:219], v2, s[8:11], s22 offen offset:0 sc1
  buffer_load_dwordx4 v[220:223], v2, s[8:11], s22 offen offset:1024 sc1
  buffer_load_dwordx4 v[224:227], v2, s[8:11], s22 offen offset:2048 sc1
  buffer_load_dwordx4 v[228:231], v2, s[8:11], s22 offen offset:3072 sc1
  s_add_u32 s22, s31, 380928
  buffer_load_dwordx4 v[232:235], v2, s[8:11], s22 offen offset:0 sc1
  buffer_load_dwordx4 v[236:239], v2, s[8:11], s22 offen offset:1024 sc1
  buffer_load_dwordx4 v[240:243], v2, s[8:11], s22 offen offset:2048 sc1
  buffer_load_dwordx4 v[244:247], v2, s[8:11], s22 offen offset:3072 sc1
  s_add_u32 s22, s31, 385024
  buffer_load_dwordx4 v[248:251], v2, s[8:11], s22 offen offset:0 sc1
  buffer_load_dwordx4 v[252:255], v2, s[8:11], s22 offen offset:1024 sc1
  s_mov_b32 s24, 71579648
  s_mov_b32 s25, 0
  s_add_u32 m0, s25, 14336
  s_nop 0
  buffer_load_dwordx4 v2, s[8:11], s24 offen offset:0 sc1 lds
  buffer_load_dwordx4 v2, s[8:11], s24 offen offset:1024 sc1 lds
  buffer_load_dwordx4 v2, s[8:11], s24 offen offset:2048 sc1 lds
  buffer_load_dwordx4 v2, s[8:11], s24 offen offset:3072 sc1 lds
  s_add_u32 m0, s25, 18432
  s_add_u32 s22, s24, 4096
  buffer_load_dwordx4 v2, s[8:11], s22 offen offset:0 sc1 lds
  buffer_load_dwordx4 v2, s[8:11], s22 offen offset:1024 sc1 lds
  buffer_load_dwordx4 v2, s[8:11], s22 offen offset:2048 sc1 lds
  v_and_b32 v64, 7, v117
  v_and_b32 v65, 1, v116
  v_lshlrev_b32 v65, 2, v65
  v_sub_u32 v64, v64, v65
  v_lshrrev_b32 v65, 3, v117
  v_lshl_add_u32 v66, v65, 2, v64
  v_cmp_gt_u32 vcc, 4, v64
  v_mov_b32 v67, 99
  s_nop 0
  v_cndmask_b32 v66, v67, v66, vcc
  v_mov_b32 v68, 0x3f80
  v_mov_b32 v69, 0x3f800000
  v_mov_b32 v4, 0
  v_cmp_eq_u32 vcc, 0, v66
  s_nop 1
  v_cndmask_b32 v4, v4, v68, vcc
  v_cmp_eq_u32 vcc, 1, v66
  s_nop 1
  v_cndmask_b32 v4, v4, v69, vcc
  v_mov_b32 v5, 0
  v_cmp_eq_u32 vcc, 2, v66
  s_nop 1
  v_cndmask_b32 v5, v5, v68, vcc
  v_cmp_eq_u32 vcc, 3, v66
  s_nop 1
  v_cndmask_b32 v5, v5, v69, vcc
  v_mov_b32 v6, 0
  v_cmp_eq_u32 vcc, 4, v66
  s_nop 1
  v_cndmask_b32 v6, v6, v68, vcc
  v_cmp_eq_u32 vcc, 5, v66
  s_nop 1
  v_cndmask_b32 v6, v6, v69, vcc
  v_mov_b32 v7, 0
  v_cmp_eq_u32 vcc, 6, v66
  s_nop 1
  v_cndmask_b32 v7, v7, v68, vcc
  v_cmp_eq_u32 vcc, 7, v66
  s_nop 1
  v_cndmask_b32 v7, v7, v69, vcc
  v_lshrrev_b32 v64, 1, v116
  v_lshrrev_b32 v65, 3, v117
  v_cmp_eq_u32 s[26:27], v64, v65
  v_and_b32 v66, 1, v116
  v_add_u32 v64, 4, v64
  v_lshrrev_b32 v67, 1, v116
  v_lshlrev_b32 v67, 8, v67
  v_lshl_add_u32 v67, v66, 9, v67
  v_lshl_add_u32 v67, v117, 4, v67
  v_add_u32 v112, 59392, v67
  v_and_b32 v68, 7, v117
  v_lshlrev_b32 v67, 8, v64
  v_lshl_add_u32 v67, v68, 5, v67
  v_lshl_add_u32 v67, v66, 4, v67
  v_add_u32 v113, 65536, v67
  v_lshrrev_b32 v64, 5, v1
  v_and_b32 v65, 31, v1
  v_lshrrev_b32 v66, 3, v65
  v_and_b32 v67, 7, v65
  v_and_b32 v68, 3, v67
  v_lshl_add_u32 v68, v66, 2, v68
  v_lshrrev_b32 v69, 2, v67
  v_lshl_add_u32 v68, v69, 4, v68
  v_lshlrev_b32 v69, 11, v64
  v_lshl_add_u32 v69, v68, 4, v69
  v_add_u32 v114, 57856, v69
  v_add_u32 v70, 4, v64
  v_lshlrev_b32 v69, 9, v66
  v_lshl_add_u32 v69, v70, 5, v69
  v_lshl_add_u32 v69, v67, 2, v69
  v_add_u32 v115, 65536, v69
  v_and_b32 v71, 1, v1
  v_cmp_eq_u32 s[38:39], 0, v71
  v_cmp_gt_u32 vcc, 8, v65
  s_or_b64 s[28:29], s[38:39], vcc
  v_lshrrev_b32 v72, 1, v67
  v_lshlrev_b32 v72, 2, v72
  v_lshl_add_u32 v72, v70, 4, v72
  s_lshl_b32 s22, s17, 9
  s_add_u32 s22, s22, 9216
  v_lshl_add_u32 v73, v66, 7, v72
  v_add_u32 v73, s22, v73
  s_lshl_b32 s22, s17, 7
  s_add_u32 s22, s22, 7168
  v_add_u32 v74, s22, v72
  v_bfe_u32 v72, v65, 1, 1
  v_lshlrev_b32 v72, 7, v72
  v_lshl_add_u32 v72, v70, 4, v72
  v_bfe_u32 v73, v65, 2, 2
  v_lshl_add_u32 v72, v73, 2, v72
  v_lshrrev_b32 v73, 4, v65
  v_lshl_add_u32 v73, v73, 8, v72
  s_lshl_b32 s22, s17, 9
  s_add_u32 s22, s22, 9216
  v_add_u32 v73, s22, v73
  s_lshr_b32 s22, s17, 1
  s_lshl_b32 s22, s22, 8
  s_and_b32 s34, s17, 1
  s_lshl_b32 s34, s34, 3
  s_add_u32 s22, s22, s34
  s_add_u32 s22, s22, 7168
  v_add_u32 v74, s22, v72
  v_lshlrev_b32 v0, 2, v65
  s_and_b32 s22, s17, 31
  s_lshl_b32 s22, s22, 7
  s_add_u32 s22, s22, 21504
  v_add_u32 v0, s22, v0
  v_cndmask_b32 v1, v74, v73, s[38:39]
  s_lshl_b32 s36, s17, 2
  s_add_u32 s36, s36, 17408
  s_mov_b32 s37, 0x3e800000
  v_mov_b32 v64, 0
  v_mov_b32 v65, 0
  v_mov_b32 v66, 0
  v_mov_b32 v67, 0
  v_mov_b32 v68, 0
  v_mov_b32 v69, 0
  v_mov_b32 v70, 0
  v_mov_b32 v71, 0
  v_mov_b32 v72, 0
  v_mov_b32 v73, 0
  v_mov_b32 v74, 0
  v_mov_b32 v75, 0
  v_mov_b32 v76, 0
  v_mov_b32 v77, 0
  v_mov_b32 v78, 0
  v_mov_b32 v79, 0
  v_mov_b32 v80, 0
  v_mov_b32 v81, 0
  v_mov_b32 v82, 0
  v_mov_b32 v83, 0
  v_mov_b32 v84, 0
  v_mov_b32 v85, 0
  v_mov_b32 v86, 0
  v_mov_b32 v87, 0
  v_mov_b32 v88, 0
  v_mov_b32 v89, 0
  v_mov_b32 v90, 0
  v_mov_b32 v91, 0
  v_mov_b32 v92, 0
  v_mov_b32 v93, 0
  v_mov_b32 v94, 0
  v_mov_b32 v95, 0
  v_mov_b32 v96, 0
  v_mov_b32 v97, 0
  v_mov_b32 v98, 0
  v_mov_b32 v99, 0
  v_mov_b32 v100, 0
  v_mov_b32 v101, 0
  v_mov_b32 v102, 0
  v_mov_b32 v103, 0
  v_mov_b32 v104, 0
  v_mov_b32 v105, 0
  v_mov_b32 v106, 0
  v_mov_b32 v107, 0
  v_mov_b32 v108, 0
  v_mov_b32 v109, 0
  v_mov_b32 v110, 0
  v_mov_b32 v111, 0
  v_and_b32 v118, 1, v116
  v_cmp_eq_u32 vcc, 0, v118
  v_mov_b32 v118, 12544
  v_mov_b32 v119, 10240
  v_cndmask_b32 v118, v118, v119, vcc
  v_lshrrev_b32 v116, 1, v116
  v_lshl_add_u32 v118, v116, 9, v118
  v_lshl_add_u32 v117, v117, 4, v118
  s_mov_b32 s57, 28672
  s_mov_b32 s56, 0x42800000
  v_mov_b32 v116, v2
  v_lshrrev_b32 v0, 4, v2
  v_min_u32 v0, 13, v0
  s_mul_i32 s22, s17, 14
  v_add_u32 v0, s22, v0
  v_lshlrev_b32 v0, 7, v0
  v_add_u32 v0, 43008, v0
  s_mov_b32 s22, 71550976
  buffer_load_dword v119, v0, s[8:11], s22 offen sc1
  s_mov_b32 s22, 71522304
  buffer_load_dword v119, v0, s[8:11], s22 offen sc1
  s_mul_i32 s35, s17, 1835008
  s_add_u32 s35, s35, 42276864
  s_mov_b32 s30, 0
  v_mov_b32 v36, 0
ch_md2:
  buffer_load_dword v37, v36, s[12:15], 0 offen sc1
  s_waitcnt vmcnt(0)
  v_readfirstlane_b32 s22, v37
  s_and_b32 s31, s22, 0xffff
  s_cmp_ge_u32 s31, 32
  s_cbranch_scc1 ch_go2
  s_sleep 2
  s_add_u32 s30, s30, 1
  s_cmp_lt_u32 s30, 50000
  s_cbranch_scc1 ch_md2
  s_branch ch_end
ch_go2:
  s_mov_b32 s31, 0
  s_lshr_b32 s22, s22, 16
  s_cmp_lg_u32 s22, 0
  s_cbranch_scc1 cB_sc2_loop
  s_branch cA_sc2_loop
ch_init3:
  s_mul_i32 s31, s17, 401408
  s_add_u32 s31, s31, 0
  s_add_u32 s22, s31, 315392
  buffer_load_dwordx4 a[224:227], v2, s[8:11], s22 offen offset:0 sc1
  buffer_load_dwordx4 a[228:231], v2, s[8:11], s22 offen offset:1024 sc1
  buffer_load_dwordx4 a[232:235], v2, s[8:11], s22 offen offset:2048 sc1
  buffer_load_dwordx4 a[236:239], v2, s[8:11], s22 offen offset:3072 sc1
  s_add_u32 s22, s31, 319488
  buffer_load_dwordx4 a[240:243], v2, s[8:11], s22 offen offset:0 sc1
  buffer_load_dwordx4 a[244:247], v2, s[8:11], s22 offen offset:1024 sc1
  buffer_load_dwordx4 a[248:251], v2, s[8:11], s22 offen offset:2048 sc1
  buffer_load_dwordx4 a[252:255], v2, s[8:11], s22 offen offset:3072 sc1
  s_add_u32 s22, s31, 323584
  buffer_load_dwordx4 v[120:123], v2, s[8:11], s22 offen offset:0 sc1
  buffer_load_dwordx4 v[124:127], v2, s[8:11], s22 offen offset:1024 sc1
  buffer_load_dwordx4 v[128:131], v2, s[8:11], s22 offen offset:2048 sc1
  buffer_load_dwordx4 v[132:135], v2, s[8:11], s22 offen offset:3072 sc1
  s_add_u32 s22, s31, 327680
  buffer_load_dwordx4 v[136:139], v2, s[8:11], s22 offen offset:0 sc1
  buffer_load_dwordx4 v[140:143], v2, s[8:11], s22 offen offset:1024 sc1
  buffer_load_dwordx4 v[144:147], v2, s[8:11], s22 offen offset:2048 sc1
  buffer_load_dwordx4 v[148:151], v2, s[8:11], s22 offen offset:3072 sc1
  s_add_u32 s22, s31, 331776
  buffer_load_dwordx4 v[152:155], v2, s[8:11], s22 offen offset:0 sc1
  buffer_load_dwordx4 v[156:159], v2, s[8:11], s22 offen offset:1024 sc1
  buffer_load_dwordx4 v[160:163], v2, s[8:11], s22 offen offset:2048 sc1
  buffer_load_dwordx4 v[164:167], v2, s[8:11], s22 offen offset:3072 sc1
  s_add_u32 s22, s31, 335872
  buffer_load_dwordx4 v[168:171], v2, s[8:11], s22 offen offset:0 sc1
  buffer_load_dwordx4 v[172:175], v2, s[8:11], s22 offen offset:1024 sc1
  buffer_load_dwordx4 v[176:179], v2, s[8:11], s22 offen offset:2048 sc1
  buffer_load_dwordx4 v[180:183], v2, s[8:11], s22 offen offset:3072 sc1
  s_add_u32 s22, s31, 339968
  buffer_load_dwordx4 v[184:187], v2, s[8:11], s22 offen offset:0 sc1
  buffer_load_dwordx4 v[188:191], v2, s[8:11], s22 offen offset:1024 sc1
  buffer_load_dwordx4 v[192:195], v2, s[8:11], s22 offen offset:2048 sc1
  buffer_load_dwordx4 v[196:199], v2, s[8:11], s22 offen offset:3072 sc1
  s_add_u32 s22, s31, 385024
  buffer_load_dwordx4 v[200:203], v2, s[8:11], s22 offen offset:2048 sc1
  buffer_load_dwordx4 v[204:207], v2, s[8:11], s22 offen offset:3072 sc1
  s_add_u32 s22, s31, 389120
  buffer_load_dwordx4 v[208:211], v2, s[8:11], s22 offen offset:0 sc1
  buffer_load_dwordx4 v[212:215], v2, s[8:11], s22 offen offset:1024 sc1
  s_waitcnt vmcnt(24)
  buffer_load_dwordx4 v[216:219], v2, s[8:11], s22 offen offset:2048 sc1
  buffer_load_dwordx4 v[220:223], v2, s[8:11], s22 offen offset:3072 sc1
  s_add_u32 s22, s31, 393216
  buffer_load_dwordx4 v[224:227], v2, s[8:11], s22 offen offset:0 sc1
  buffer_load_dwordx4 v[228:231], v2, s[8:11], s22 offen offset:1024 sc1
  buffer_load_dwordx4 v[232:235], v2, s[8:11], s22 offen offset:2048 sc1
  buffer_load_dwordx4 v[236:239], v2, s[8:11], s22 offen offset:3072 sc1
  s_add_u32 s22, s31, 397312
  buffer_load_dwordx4 v[240:243], v2, s[8:11], s22 offen offset:0 sc1
  buffer_load_dwordx4 v[244:247], v2, s[8:11], s22 offen offset:1024 sc1
  buffer_load_dwordx4 v[248:251], v2, s[8:11], s22 offen offset:2048 sc1
  buffer_load_dwordx4 v[252:255], v2, s[8:11], s22 offen offset:3072 sc1
  s_mov_b32 s24, 71586816
  s_mov_b32 s25, 0
  s_add_u32 m0, s25, 21504
  s_nop 0
  buffer_load_dwordx4 v2, s[8:11], s24 offen offset:0 sc1 lds
  buffer_load_dwordx4 v2, s[8:11], s24 offen offset:1024 sc1 lds
  buffer_load_dwordx4 v2, s[8:11], s24 offen offset:2048 sc1 lds
  buffer_load_dwordx4 v2, s[8:11], s24 offen offset:3072 sc1 lds
  s_add_u32 m0, s25, 25600
  s_add_u32 s22, s24, 4096
  buffer_load_dwordx4 v2, s[8:11], s22 offen offset:0 sc1 lds
  buffer_load_dwordx4 v2, s[8:11], s22 offen offset:1024 sc1 lds
  buffer_load_dwordx4 v2, s[8:11], s22 offen offset:2048 sc1 lds
  v_and_b32 v64, 7, v117
  v_and_b32 v65, 1, v116
  v_lshlrev_b32 v65, 2, v65
  v_sub_u32 v64, v64, v65
  v_lshrrev_b32 v65, 3, v117
  v_lshl_add_u32 v66, v65, 2, v64
  v_cmp_gt_u32 vcc, 4, v64
  v_mov_b32 v67, 99
  s_nop 0
  v_cndmask_b32 v66, v67, v66, vcc
  v_mov_b32 v68, 0x3f80
  v_mov_b32 v69, 0x3f800000
  v_mov_b32 v4, 0
  v_cmp_eq_u32 vcc, 0, v66
  s_nop 1
  v_cndmask_b32 v4, v4, v68, vcc
  v_cmp_eq_u32 vcc, 1, v66
  s_nop 1
  v_cndmask_b32 v4, v4, v69, vcc
  v_mov_b32 v5, 0
  v_cmp_eq_u32 vcc, 2, v66
  s_nop 1
  v_cndmask_b32 v5, v5, v68, vcc
  v_cmp_eq_u32 vcc, 3, v66
  s_nop 1
  v_cndmask_b32 v5, v5, v69, vcc
  v_mov_b32 v6, 0
  v_cmp_eq_u32 vcc, 4, v66
  s_nop 1
  v_cndmask_b32 v6, v6, v68, vcc
  v_cmp_eq_u32 vcc, 5, v66
  s_nop 1
  v_cndmask_b32 v6, v6, v69, vcc
  v_mov_b32 v7, 0
  v_cmp_eq_u32 vcc, 6, v66
  s_nop 1
  v_cndmask_b32 v7, v7, v68, vcc
  v_cmp_eq_u32 vcc, 7, v66
  s_nop 1
  v_cndmask_b32 v7, v7, v69, vcc
  v_lshrrev_b32 v64, 1, v116
  v_lshrrev_b32 v65, 3, v117
  v_cmp_eq_u32 s[26:27], v64, v65
  v_and_b32 v66, 1, v116
  v_add_u32 v64, 6, v64
  v_lshrrev_b32 v67, 1, v116
  v_lshlrev_b32 v67, 8, v67
  v_lshl_add_u32 v67, v66, 9, v67
  v_lshl_add_u32 v67, v117, 4, v67
  v_add_u32 v112, 60416, v67
  v_and_b32 v68, 7, v117
  v_lshlrev_b32 v67, 8, v64
  v_lshl_add_u32 v67, v68, 5, v67
  v_lshl_add_u32 v67, v66, 4, v67
  v_add_u32 v113, 65536, v67
  v_lshrrev_b32 v64, 5, v1
  v_and_b32 v65, 31, v1
  v_lshrrev_b32 v66, 3, v65
  v_and_b32 v67, 7, v65
  v_and_b32 v68, 3, v67
  v_lshl_add_u32 v68, v66, 2, v68
  v_lshrrev_b32 v69, 2, v67
  v_lshl_add_u32 v68, v69, 4, v68
  v_lshlrev_b32 v69, 11, v64
  v_lshl_add_u32 v69, v68, 4, v69
  v_add_u32 v114, 57864, v69
  v_add_u32 v70, 6, v64
  v_lshlrev_b32 v69, 9, v66
  v_lshl_add_u32 v69, v70, 5, v69
  v_lshl_add_u32 v69, v67, 2, v69
  v_add_u32 v115, 65536, v69
  v_and_b32 v71, 1, v1
  v_cmp_eq_u32 s[38:39], 0, v71
  v_cmp_gt_u32 vcc, 8, v65
  s_or_b64 s[28:29], s[38:39], vcc
  v_lshrrev_b32 v72, 1, v67
  v_lshlrev_b32 v72, 2, v72
  v_lshl_add_u32 v72, v70, 4, v72
  s_lshl_b32 s22, s17, 9
  s_add_u32 s22, s22, 9216
  v_lshl_add_u32 v73, v66, 7, v72
  v_add_u32 v73, s22, v73
  s_lshl_b32 s22, s17, 7
  s_add_u32 s22, s22, 7168
  v_add_u32 v74, s22, v72
  v_bfe_u32 v72, v65, 1, 1
  v_lshlrev_b32 v72, 7, v72
  v_lshl_add_u32 v72, v70, 4, v72
  v_bfe_u32 v73, v65, 2, 2
  v_lshl_add_u32 v72, v73, 2, v72
  v_lshrrev_b32 v73, 4, v65
  v_lshl_add_u32 v73, v73, 8, v72
  s_lshl_b32 s22, s17, 9
  s_add_u32 s22, s22, 9216
  v_add_u32 v73, s22, v73
  s_lshr_b32 s22, s17, 1
  s_lshl_b32 s22, s22, 8
  s_and_b32 s34, s17, 1
  s_lshl_b32 s34, s34, 3
  s_add_u32 s22, s22, s34
  s_add_u32 s22, s22, 7168
  v_add_u32 v74, s22, v72
  v_lshlrev_b32 v0, 2, v65
  s_and_b32 s22, s17, 31
  s_lshl_b32 s22, s22, 7
  s_add_u32 s22, s22, 21504
  v_add_u32 v0, s22, v0
  v_cndmask_b32 v1, v74, v73, s[38:39]
  s_lshl_b32 s36, s17, 2
  s_add_u32 s36, s36, 17408
  s_mov_b32 s37, 0x3e800000
  v_mov_b32 v64, 0
  v_mov_b32 v65, 0
  v_mov_b32 v66, 0
  v_mov_b32 v67, 0
  v_mov_b32 v68, 0
  v_mov_b32 v69, 0
  v_mov_b32 v70, 0
  v_mov_b32 v71, 0
  v_mov_b32 v72, 0
  v_mov_b32 v73, 0
  v_mov_b32 v74, 0
  v_mov_b32 v75, 0
  v_mov_b32 v76, 0
  v_mov_b32 v77, 0
  v_mov_b32 v78, 0
  v_mov_b32 v79, 0
  v_mov_b32 v80, 0
  v_mov_b32 v81, 0
  v_mov_b32 v82, 0
  v_mov_b32 v83, 0
  v_mov_b32 v84, 0
  v_mov_b32 v85, 0
  v_mov_b32 v86, 0
  v_mov_b32 v87, 0
  v_mov_b32 v88, 0
  v_mov_b32 v89, 0
  v_mov_b32 v90, 0
  v_mov_b32 v91, 0
  v_mov_b32 v92, 0
  v_mov_b32 v93, 0
  v_mov_b32 v94, 0
  v_mov_b32 v95, 0
  v_mov_b32 v96, 0
  v_mov_b32 v97, 0
  v_mov_b32 v98, 0
  v_mov_b32 v99, 0
  v_mov_b32 v100, 0
  v_mov_b32 v101, 0
  v_mov_b32 v102, 0
  v_mov_b32 v103, 0
  v_mov_b32 v104, 0
  v_mov_b32 v105, 0
  v_mov_b32 v106, 0
  v_mov_b32 v107, 0
  v_mov_b32 v108, 0
  v_mov_b32 v109, 0
  v_mov_b32 v110, 0
  v_mov_b32 v111, 0
  v_and_b32 v118, 1, v116
  v_cmp_eq_u32 vcc, 0, v118
  v_mov_b32 v118, 12544
  v_mov_b32 v119, 10496
  v_cndmask_b32 v118, v118, v119, vcc
  v_lshrrev_b32 v116, 1, v116
  v_lshl_add_u32 v118, v116, 9, v118
  v_lshl_add_u32 v117, v117, 4, v118
  s_mov_b32 s57, 28672
  s_mov_b32 s56, 0x42800000
  v_mov_b32 v116, v2
  s_mul_i32 s35, s17, 1835008
  s_add_u32 s35, s35, 42284032
  s_mov_b32 s30, 0
  v_mov_b32 v36, 0
ch_md3:
  buffer_load_dword v37, v36, s[12:15], 0 offen sc1
  s_waitcnt vmcnt(0)
  v_readfirstlane_b32 s22, v37
  s_and_b32 s31, s22, 0xffff
  s_cmp_ge_u32 s31, 32
  s_cbranch_scc1 ch_go3
  s_sleep 2
  s_add_u32 s30, s30, 1
  s_cmp_lt_u32 s30, 50000
  s_cbranch_scc1 ch_md3
  s_branch ch_end
ch_go3:
  s_mov_b32 s31, 0
  s_lshr_b32 s22, s22, 16
  s_cmp_lg_u32 s22, 0
  s_cbranch_scc1 cB_sc3_loop
  s_branch cA_sc3_loop
ch_init4:
  s_mul_i32 s31, s17, 401408
  s_add_u32 s31, s31, 6422528
  s_mul_i32 s22, s17, 28
  s_add_u32 s23, s22, 27
  s_lshr_b32 s22, s22, 6
  s_lshr_b32 s23, s23, 6
  s_sub_u32 s23, s23, s22
  s_lshl_b32 s23, s23, 8
  v_and_b32 v36, s23, v2
  v_med3_u32 v37, v117, 0, 3
  v_lshl_add_u32 v36, v37, 4, v36
  s_lshl_b32 s22, s22, 8
  s_add_u32 s22, s22, 88588288
  s_mov_b32 s30, 0
va_bw_11:
  buffer_load_dwordx4 v[40:43], v36, s[8:11], s22 offen sc1
  s_waitcnt vmcnt(0)
  v_cmp_ne_u64 vcc, s[88:89], v[40:41]
  s_cbranch_vccnz va_bw_11_no
  v_cmp_ne_u64 vcc, s[88:89], v[42:43]
  s_cbranch_vccnz va_bw_11_no
  s_branch va_bw_11_ok
va_bw_11_no:
  s_sleep 2
  s_add_u32 s30, s30, 1
  s_cmp_lt_u32 s30, 50000
  s_cbranch_scc1 va_bw_11
  s_branch cA_abort
va_bw_11_ok:
  s_add_u32 s22, s31, 0
  buffer_load_dwordx4 a[0:3], v2, s[8:11], s22 offen offset:0 sc1
  buffer_load_dwordx4 a[4:7], v2, s[8:11], s22 offen offset:1024 sc1
  buffer_load_dwordx4 a[8:11], v2, s[8:11], s22 offen offset:2048 sc1
  buffer_load_dwordx4 a[12:15], v2, s[8:11], s22 offen offset:3072 sc1
  s_add_u32 s22, s31, 4096
  buffer_load_dwordx4 a[16:19], v2, s[8:11], s22 offen offset:0 sc1
  buffer_load_dwordx4 a[20:23], v2, s[8:11], s22 offen offset:1024 sc1
  buffer_load_dwordx4 a[24:27], v2, s[8:11], s22 offen offset:2048 sc1
  buffer_load_dwordx4 a[28:31], v2, s[8:11], s22 offen offset:3072 sc1
  s_add_u32 s22, s31, 8192
  buffer_load_dwordx4 a[32:35], v2, s[8:11], s22 offen offset:0 sc1
  buffer_load_dwordx4 a[36:39], v2, s[8:11], s22 offen offset:1024 sc1
  buffer_load_dwordx4 a[40:43], v2, s[8:11], s22 offen offset:2048 sc1
  buffer_load_dwordx4 a[44:47], v2, s[8:11], s22 offen offset:3072 sc1
  s_add_u32 s22, s31, 12288
  buffer_load_dwordx4 a[48:51], v2, s[8:11], s22 offen offset:0 sc1
  buffer_load_dwordx4 a[52:55], v2, s[8:11], s22 offen offset:1024 sc1
  buffer_load_dwordx4 a[56:59], v2, s[8:11], s22 offen offset:2048 sc1
  buffer_load_dwordx4 a[60:63], v2, s[8:11], s22 offen offset:3072 sc1
  s_add_u32 s22, s31, 16384
  buffer_load_dwordx4 a[64:67], v2, s[8:11], s22 offen offset:0 sc1
  buffer_load_dwordx4 a[68:71], v2, s[8:11], s22 offen offset:1024 sc1
  buffer_load_dwordx4 a[72:75], v2, s[8:11], s22 offen offset:2048 sc1
  buffer_load_dwordx4 a[76:79], v2, s[8:11], s22 offen offset:3072 sc1
  s_add_u32 s22, s31, 20480
  buffer_load_dwordx4 a[80:83], v2, s[8:11], s22 offen offset:0 sc1
  buffer_load_dwordx4 a[84:87], v2, s[8:11], s22 offen offset:1024 sc1
  buffer_load_dwordx4 a[88:91], v2, s[8:11], s22 offen offset:2048 sc1
  buffer_load_dwordx4 a[92:95], v2, s[8:11], s22 offen offset:3072 sc1
  s_add_u32 s22, s31, 24576
  buffer_load_dwordx4 a[96:99], v2, s[8:11], s22 offen offset:0 sc1
  buffer_load_dwordx4 a[100:103], v2, s[8:11], s22 offen offset:1024 sc1
  buffer_load_dwordx4 a[104:107], v2, s[8:11], s22 offen offset:2048 sc1
  buffer_load_dwordx4 a[108:111], v2, s[8:11], s22 offen offset:3072 sc1
  s_add_u32 s22, s31, 28672
  buffer_load_dwordx4 a[112:115], v2, s[8:11], s22 offen offset:0 sc1
  buffer_load_dwordx4 a[116:119], v2, s[8:11], s22 offen offset:1024 sc1
  buffer_load_dwordx4 a[120:123], v2, s[8:11], s22 offen offset:2048 sc1
  buffer_load_dwordx4 a[124:127], v2, s[8:11], s22 offen offset:3072 sc1
  s_waitcnt vmcnt(24)
  s_add_u32 s22, s31, 32768
  buffer_load_dwordx4 a[128:131], v2, s[8:11], s22 offen offset:0 sc1
  buffer_load_dwordx4 a[132:135], v2, s[8:11], s22 offen offset:1024 sc1
  buffer_load_dwordx4 a[136:139], v2, s[8:11], s22 offen offset:2048 sc1
  buffer_load_dwordx4 a[140:143], v2, s[8:11], s22 offen offset:3072 sc1
  s_add_u32 s22, s31, 36864
  buffer_load_dwordx4 a[144:147], v2, s[8:11], s22 offen offset:0 sc1
  buffer_load_dwordx4 a[148:151], v2, s[8:11], s22 offen offset:1024 sc1
  buffer_load_dwordx4 a[152:155], v2, s[8:11], s22 offen offset:2048 sc1
  buffer_load_dwordx4 a[156:159], v2, s[8:11], s22 offen offset:3072 sc1
  s_add_u32 s22, s31, 40960
  buffer_load_dwordx4 a[160:163], v2, s[8:11], s22 offen offset:0 sc1
  buffer_load_dwordx4 a[164:167], v2, s[8:11], s22 offen offset:1024 sc1
  buffer_load_dwordx4 a[168:171], v2, s[8:11], s22 offen offset:2048 sc1
  buffer_load_dwordx4 a[172:175], v2, s[8:11], s22 offen offset:3072 sc1
  s_add_u32 s22, s31, 45056
  buffer_load_dwordx4 a[176:179], v2, s[8:11], s22 offen offset:0 sc1
  buffer_load_dwordx4 a[180:183], v2, s[8:11], s22 offen offset:1024 sc1
  buffer_load_dwordx4 a[184:187], v2, s[8:11], s22 offen offset:2048 sc1
  buffer_load_dwordx4 a[188:191], v2, s[8:11], s22 offen offset:3072 sc1
  s_add_u32 s22, s31, 49152
  buffer_load_dwordx4 a[192:195], v2, s[8:11], s22 offen offset:0 sc1
  buffer_load_dwordx4 a[196:199], v2, s[8:11], s22 offen offset:1024 sc1
  buffer_load_dwordx4 a[200:203], v2, s[8:11], s22 offen offset:2048 sc1
  buffer_load_dwordx4 a[204:207], v2, s[8:11], s22 offen offset:3072 sc1
  s_add_u32 s22, s31, 53248
  buffer_load_dwordx4 a[208:211], v2, s[8:11], s22 offen offset:0 sc1
  buffer_load_dwordx4 a[212:215], v2, s[8:11], s22 offen offset:1024 sc1
  buffer_load_dwordx4 a[216:219], v2, s[8:11], s22 offen offset:2048 sc1
  buffer_load_dwordx4 a[220:223], v2, s[8:11], s22 offen offset:3072 sc1
  s_add_u32 s22, s31, 57344
  buffer_load_dwordx4 a[224:227], v2, s[8:11], s22 offen offset:0 sc1
  buffer_load_dwordx4 a[228:231], v2, s[8:11], s22 offen offset:1024 sc1
  buffer_load_dwordx4 a[232:235], v2, s[8:11], s22 offen offset:2048 sc1
  buffer_load_dwordx4 a[236:239], v2, s[8:11], s22 offen offset:3072 sc1
  s_add_u32 s22, s31, 61440
  buffer_load_dwordx4 a[240:243], v2, s[8:11], s22 offen offset:0 sc1
  buffer_load_dwordx4 a[244:247], v2, s[8:11], s22 offen offset:1024 sc1
  buffer_load_dwordx4 a[248:251], v2, s[8:11], s22 offen offset:2048 sc1
  buffer_load_dwordx4 a[252:255], v2, s[8:11], s22 offen offset:3072 sc1
  s_waitcnt vmcnt(24)
  s_add_u32 s22, s31, 65536
  buffer_load_dwordx4 v[176:179], v2, s[8:11], s22 offen offset:0 sc1
  buffer_load_dwordx4 v[180:183], v2, s[8:11], s22 offen offset:1024 sc1
  buffer_load_dwordx4 v[184:187], v2, s[8:11], s22 offen offset:2048 sc1
  buffer_load_dwordx4 v[188:191], v2, s[8:11], s22 offen offset:3072 sc1
  s_add_u32 s22, s31, 69632
  buffer_load_dwordx4 v[192:195], v2, s[8:11], s22 offen offset:0 sc1
  buffer_load_dwordx4 v[196:199], v2, s[8:11], s22 offen offset:1024 sc1
  buffer_load_dwordx4 v[200:203], v2, s[8:11], s22 offen offset:2048 sc1
  buffer_load_dwordx4 v[204:207], v2, s[8:11], s22 offen offset:3072 sc1
  s_add_u32 s22, s31, 73728
  buffer_load_dwordx4 v[208:211], v2, s[8:11], s22 offen offset:0 sc1
  buffer_load_dwordx4 v[212:215], v2, s[8:11], s22 offen offset:1024 sc1
  buffer_load_dwordx4 v[216:219], v2, s[8:11], s22 offen offset:2048 sc1
  buffer_load_dwordx4 v[220:223], v2, s[8:11], s22 offen offset:3072 sc1
  s_add_u32 s22, s31, 77824
  buffer_load_dwordx4 v[224:227], v2, s[8:11], s22 offen offset:0 sc1
  buffer_load_dwordx4 v[228:231], v2, s[8:11], s22 offen offset:1024 sc1
  buffer_load_dwordx4 v[232:235], v2, s[8:11], s22 offen offset:2048 sc1
  buffer_load_dwordx4 v[236:239], v2, s[8:11], s22 offen offset:3072 sc1
  s_add_u32 s22, s31, 81920
  buffer_load_dwordx4 v[240:243], v2, s[8:11], s22 offen offset:0 sc1
  buffer_load_dwordx4 v[244:247], v2, s[8:11], s22 offen offset:1024 sc1
  buffer_load_dwordx4 v[248:251], v2, s[8:11], s22 offen offset:2048 sc1
  buffer_load_dwordx4 v[252:255], v2, s[8:11], s22 offen offset:3072 sc1
  s_mul_i32 s22, s17, 28
  s_add_u32 s23, s22, 27
  s_lshr_b32 s22, s22, 6
  s_lshr_b32 s23, s23, 6
  s_sub_u32 s23, s23, s22
  s_lshl_b32 s23, s23, 8
  v_and_b32 v36, s23, v2
  v_med3_u32 v37, v117, 10, 11
  v_lshl_add_u32 v36, v37, 4, v36
  s_lshl_b32 s22, s22, 8
  s_add_u32 s22, s22, 88588288
  s_mov_b32 s30, 0
va_bw_12:
  buffer_load_dwordx4 v[40:43], v36, s[8:11], s22 offen sc1
  s_waitcnt vmcnt(0)
  v_cmp_ne_u64 vcc, s[88:89], v[40:41]
  s_cbranch_vccnz va_bw_12_no
  v_cmp_ne_u64 vcc, s[88:89], v[42:43]
  s_cbranch_vccnz va_bw_12_no
  s_branch va_bw_12_ok
va_bw_12_no:
  s_sleep 2
  s_add_u32 s30, s30, 1
  s_cmp_lt_u32 s30, 50000
  s_cbranch_scc1 va_bw_12
  s_branch cA_abort
va_bw_12_ok:
  s_mov_b32 m0, 16384
  s_add_u32 s22, s31, 272384
  buffer_load_dwordx4 v2, s[8:11], s22 offen offset:0 sc1 lds
  buffer_load_dwordx4 v2, s[8:11], s22 offen offset:1024 sc1 lds
  buffer_load_dwordx4 v2, s[8:11], s22 offen offset:2048 sc1 lds
  buffer_load_dwordx4 v2, s[8:11], s22 offen offset:3072 sc1 lds
  s_mov_b32 m0, 20480
  s_add_u32 s22, s31, 276480
  buffer_load_dwordx4 v2, s[8:11], s22 offen offset:0 sc1 lds
  buffer_load_dwordx4 v2, s[8:11], s22 offen offset:1024 sc1 lds
  buffer_load_dwordx4 v2, s[8:11], s22 offen offset:2048 sc1 lds
  buffer_load_dwordx4 v2, s[8:11], s22 offen offset:3072 sc1 lds
  s_mov_b32 m0, 24576
  s_add_u32 s22, s31, 280576
  buffer_load_dwordx4 v2, s[8:11], s22 offen offset:0 sc1 lds
  buffer_load_dwordx4 v2, s[8:11], s22 offen offset:1024 sc1 lds
  buffer_load_dwordx4 v2, s[8:11], s22 offen offset:2048 sc1 lds
  buffer_load_dwordx4 v2, s[8:11], s22 offen offset:3072 sc1 lds
  s_mov_b32 m0, 28672
  s_add_u32 s22, s31, 284672
  buffer_load_dwordx4 v2, s[8:11], s22 offen offset:0 sc1 lds
  buffer_load_dwordx4 v2, s[8:11], s22 offen offset:1024 sc1 lds
  v_mov_b32 v72, v116
  v_mov_b32 v73, v117
  v_lshrrev_b32 v65, 1, v72
  v_and_b32 v66, 1, v72
  v_add_u32 v67, 0, v65
  v_lshl_add_u32 v67, v67, 4, v73
  v_mul_u32_u24 v68, 2341, v67
  v_lshrrev_b32 v68, 16, v68
  v_mul_u32_u24 v69, 28, v68
  v_sub_u32 v69, v67, v69
  v_lshrrev_b32 v70, 4, v69
  v_and_b32 v69, 15, v69
  v_and_b32 v71, 1, v69
  v_lshrrev_b32 v69, 1, v69
  v_lshl_add_u32 v69, v71, 3, v69
  v_lshlrev_b32 v71, 12, v70
  v_lshl_add_u32 v71, v68, 8, v71
  v_lshl_add_u32 v71, v69, 4, v71
  v_lshl_add_u32 v60, v66, 3, v71
  v_add_u32 v67, 2, v65
  v_lshl_add_u32 v67, v67, 4, v73
  v_mul_u32_u24 v68, 2341, v67
  v_lshrrev_b32 v68, 16, v68
  v_mul_u32_u24 v69, 28, v68
  v_sub_u32 v69, v67, v69
  v_lshrrev_b32 v70, 4, v69
  v_and_b32 v69, 15, v69
  v_and_b32 v71, 1, v69
  v_lshrrev_b32 v69, 1, v69
  v_lshl_add_u32 v69, v71, 3, v69
  v_lshlrev_b32 v71, 12, v70
  v_lshl_add_u32 v71, v68, 8, v71
  v_lshl_add_u32 v71, v69, 4, v71
  v_lshl_add_u32 v61, v66, 3, v71
  v_add_u32 v67, 4, v65
  v_lshl_add_u32 v67, v67, 4, v73
  v_mul_u32_u24 v68, 2341, v67
  v_lshrrev_b32 v68, 16, v68
  v_mul_u32_u24 v69, 28, v68
  v_sub_u32 v69, v67, v69
  v_lshrrev_b32 v70, 4, v69
  v_and_b32 v69, 15, v69
  v_and_b32 v71, 1, v69
  v_lshrrev_b32 v69, 1, v69
  v_lshl_add_u32 v69, v71, 3, v69
  v_lshlrev_b32 v71, 12, v70
  v_lshl_add_u32 v71, v68, 8, v71
  v_lshl_add_u32 v71, v69, 4, v71
  v_lshl_add_u32 v62, v66, 3, v71
  v_and_b32 v0, 31, v1
  v_lshlrev_b32 v0, 2, v0
  v_add_u32 v0, 21504, v0
  v_lshlrev_b32 v4, 2, v73
  s_and_b32 s22, s17, 15
  s_lshl_b32 s22, s22, 7
  s_add_u32 s22, s22, 17408
  v_add_u32 v4, s22, v4
  v_and_b32 v64, 7, v73
  v_lshlrev_b32 v5, 4, v64
  v_lshl_add_u32 v5, v72, 7, v5
  v_lshrrev_b32 v65, 3, v73
  v_lshl_add_u32 v5, v65, 9, v5
  s_lshl_b32 s22, s17, 3
  s_add_u32 s22, s22, 21504
  v_lshl_add_u32 v7, v2, 3, s22
  v_add_u32 v65, 0, v73
  v_min_u32 v65, 27, v65
  v_mad_u32_u24 v65, v72, 28, v65
  v_lshlrev_b32 v6, 4, v65
  s_lshr_b32 s22, s17, 1
  s_mul_i32 s22, s22, 7
  s_and_b32 s34, s17, 1
  s_lshl_b32 s35, s34, 2
  v_add_u32 v70, s35, v72
  v_mov_b32 v71, s34
  v_mov_b32 v69, 0
  v_cmp_eq_u32 vcc, 3, v72
  s_nop 1
  v_cndmask_b32 v70, v70, v72, vcc
  v_cndmask_b32 v69, v69, v71, vcc
  v_add_u32 v70, s22, v70
  v_lshrrev_b32 v68, 1, v70
  v_lshlrev_b32 v68, 8, v68
  v_lshl_add_u32 v68, v69, 7, v68
  v_and_b32 v69, 1, v70
  v_lshl_add_u32 v68, v69, 3, v68
  v_lshl_add_u32 v1, v64, 4, v68
  v_cmp_gt_u32 s[26:27], 8, v73
  v_lshrrev_b32 v65, 3, v73
  v_lshl_add_u32 v66, v64, 1, v65
  v_add_u32 v66, 0, v66
  v_min_u32 v66, 27, v66
  v_mad_u32_u24 v66, v72, 28, v66
  v_lshlrev_b32 v6, 4, v66
  s_mul_i32 s22, s17, 28
  s_add_u32 s22, s22, 0
  v_lshl_add_u32 v70, v64, 1, s22
  v_lshrrev_b32 v68, 4, v70
  v_lshlrev_b32 v68, 8, v68
  v_bfe_u32 v69, v70, 1, 1
  v_lshl_add_u32 v68, v69, 7, v68
  v_bfe_u32 v69, v70, 2, 2
  v_lshl_add_u32 v68, v69, 2, v68
  v_and_b32 v69, 1, v72
  v_lshl_add_u32 v65, v69, 2, v65
  v_lshrrev_b32 v69, 1, v72
  v_lshl_add_u32 v65, v69, 1, v65
  v_lshl_add_u32 v1, v65, 4, v68
  v_cmp_gt_u32 s[26:27], 6, v64
  v_mov_b32 v156, 0
  v_mov_b32 v157, 0
  v_mov_b32 v158, 0
  v_mov_b32 v159, 0
  ds_write_b128 v2, v[156:159] offset:0
  ds_write_b128 v2, v[156:159] offset:1024
  ds_write_b128 v2, v[156:159] offset:2048
  ds_write_b128 v2, v[156:159] offset:3072
  s_mul_i32 s22, s17, 1835008
  s_add_u32 s25, s22, 42205184
  s_lshl_b32 s35, s17, 7
  s_add_u32 s35, s35, 88526848
  s_mov_b32 s38, 0
  v_mov_b32 v175, 0
  s_lshl_b32 s22, 0, 11
  s_add_u32 s22, s22, 88590336
  v_add_u32 v36, 1024, v2
  v_min_u32 v36, 1776, v36
  s_mov_b32 s30, 0
va_iw4:
  buffer_load_dwordx4 v[40:43], v2, s[8:11], s22 offen sc1
  buffer_load_dwordx4 v[44:47], v36, s[8:11], s22 offen sc1
  s_waitcnt vmcnt(0)
  v_cmp_ne_u64 vcc, s[88:89], v[40:41]
  s_cbranch_vccnz va_iw4_no
  v_cmp_ne_u64 vcc, s[88:89], v[42:43]
  s_cbranch_vccnz va_iw4_no
  v_cmp_ne_u64 vcc, s[88:89], v[44:45]
  s_cbranch_vccnz va_iw4_no
  v_cmp_ne_u64 vcc, s[88:89], v[46:47]
  s_cbranch_vccnz va_iw4_no
  s_branch va_iw4_ok
va_iw4_no:
  s_sleep 2
  s_add_u32 s30, s30, 1
  s_cmp_lt_u32 s30, 50000
  s_cbranch_scc1 va_iw4
  s_branch cA_abort
va_iw4_ok:
  s_mov_b32 s30, 0
  v_mov_b32 v36, 0
ch_md4:
  buffer_load_dword v37, v36, s[12:15], 0 offen sc1
  s_waitcnt vmcnt(0)
  v_readfirstlane_b32 s22, v37
  s_and_b32 s31, s22, 0xffff
  s_cmp_ge_u32 s31, 32
  s_cbranch_scc1 ch_go4
  s_sleep 2
  s_add_u32 s30, s30, 1
  s_cmp_lt_u32 s30, 50000
  s_cbranch_scc1 ch_md4
  s_branch ch_end
ch_go4:
  s_mov_b32 s31, 0
  v_mov_b32 v36, 0
  v_mov_b32 v37, 0
  v_mov_b32 v38, 0
  v_mov_b32 v39, 0
  v_mov_b32 v40, 0
  v_mov_b32 v41, 0
  v_mov_b32 v42, 0
  v_mov_b32 v43, 0
  v_mov_b32 v44, 0
  v_mov_b32 v45, 0
  v_mov_b32 v46, 0
  v_mov_b32 v47, 0
  v_mov_b32 v48, 0
  v_mov_b32 v49, 0
  v_mov_b32 v50, 0
  v_mov_b32 v51, 0
  v_mov_b32 v52, 0
  v_mov_b32 v53, 0
  v_mov_b32 v54, 0
  v_mov_b32 v55, 0
  v_mov_b32 v56, 0
  v_mov_b32 v57, 0
  v_mov_b32 v58, 0
  v_mov_b32 v59, 0
  s_lshr_b32 s22, s22, 16
  s_cmp_lg_u32 s22, 0
  s_cbranch_scc1 cB_va0_loop
  s_branch cA_va0_loop
ch_init5:
  s_mul_i32 s31, s17, 401408
  s_add_u32 s31, s31, 6422528
  s_mul_i32 s22, s17, 28
  s_add_u32 s23, s22, 27
  s_lshr_b32 s22, s22, 6
  s_lshr_b32 s23, s23, 6
  s_sub_u32 s23, s23, s22
  s_lshl_b32 s23, s23, 8
  v_and_b32 v36, s23, v2
  v_med3_u32 v37, v117, 3, 6
  v_lshl_add_u32 v36, v37, 4, v36
  s_lshl_b32 s22, s22, 8
  s_add_u32 s22, s22, 88588288
  s_mov_b32 s30, 0
va_bw_13:
  buffer_load_dwordx4 v[40:43], v36, s[8:11], s22 offen sc1
  s_waitcnt vmcnt(0)
  v_cmp_ne_u64 vcc, s[88:89], v[40:41]
  s_cbranch_vccnz va_bw_13_no
  v_cmp_ne_u64 vcc, s[88:89], v[42:43]
  s_cbranch_vccnz va_bw_13_no
  s_branch va_bw_13_ok
va_bw_13_no:
  s_sleep 2
  s_add_u32 s30, s30, 1
  s_cmp_lt_u32 s30, 50000
  s_cbranch_scc1 va_bw_13
  s_branch cA_abort
va_bw_13_ok:
  s_add_u32 s22, s31, 86016
  buffer_load_dwordx4 a[0:3], v2, s[8:11], s22 offen offset:0 sc1
  buffer_load_dwordx4 a[4:7], v2, s[8:11], s22 offen offset:1024 sc1
  buffer_load_dwordx4 a[8:11], v2, s[8:11], s22 offen offset:2048 sc1
  buffer_load_dwordx4 a[12:15], v2, s[8:11], s22 offen offset:3072 sc1
  s_add_u32 s22, s31, 90112
  buffer_load_dwordx4 a[16:19], v2, s[8:11], s22 offen offset:0 sc1
  buffer_load_dwordx4 a[20:23], v2, s[8:11], s22 offen offset:1024 sc1
  buffer_load_dwordx4 a[24:27], v2, s[8:11], s22 offen offset:2048 sc1
  buffer_load_dwordx4 a[28:31], v2, s[8:11], s22 offen offset:3072 sc1
  s_add_u32 s22, s31, 94208
  buffer_load_dwordx4 a[32:35], v2, s[8:11], s22 offen offset:0 sc1
  buffer_load_dwordx4 a[36:39], v2, s[8:11], s22 offen offset:1024 sc1
  buffer_load_dwordx4 a[40:43], v2, s[8:11], s22 offen offset:2048 sc1
  buffer_load_dwordx4 a[44:47], v2, s[8:11], s22 offen offset:3072 sc1
  s_add_u32 s22, s31, 98304
  buffer_load_dwordx4 a[48:51], v2, s[8:11], s22 offen offset:0 sc1
  buffer_load_dwordx4 a[52:55], v2, s[8:11], s22 offen offset:1024 sc1
  buffer_load_dwordx4 a[56:59], v2, s[8:11], s22 offen offset:2048 sc1
  buffer_load_dwordx4 a[60:63], v2, s[8:11], s22 offen offset:3072 sc1
  s_add_u32 s22, s31, 102400
  buffer_load_dwordx4 a[64:67], v2, s[8:11], s22 offen offset:0 sc1
  buffer_load_dwordx4 a[68:71], v2, s[8:11], s22 offen offset:1024 sc1
  buffer_load_dwordx4 a[72:75], v2, s[8:11], s22 offen offset:2048 sc1
  buffer_load_dwordx4 a[76:79], v2, s[8:11], s22 offen offset:3072 sc1
  s_add_u32 s22, s31, 106496
  buffer_load_dwordx4 a[80:83], v2, s[8:11], s22 offen offset:0 sc1
  buffer_load_dwordx4 a[84:87], v2, s[8:11], s22 offen offset:1024 sc1
  buffer_load_dwordx4 a[88:91], v2, s[8:11], s22 offen offset:2048 sc1
  buffer_load_dwordx4 a[92:95], v2, s[8:11], s22 offen offset:3072 sc1
  s_add_u32 s22, s31, 110592
  buffer_load_dwordx4 a[96:99], v2, s[8:11], s22 offen offset:0 sc1
  buffer_load_dwordx4 a[100:103], v2, s[8:11], s22 offen offset:1024 sc1
  buffer_load_dwordx4 a[104:107], v2, s[8:11], s22 offen offset:2048 sc1
  buffer_load_dwordx4 a[108:111], v2, s[8:11], s22 offen offset:3072 sc1
  s_add_u32 s22, s31, 114688
  buffer_load_dwordx4 a[112:115], v2, s[8:11], s22 offen offset:0 sc1
  buffer_load_dwordx4 a[116:119], v2, s[8:11], s22 offen offset:1024 sc1
  buffer_load_dwordx4 a[120:123], v2, s[8:11], s22 offen offset:2048 sc1
  buffer_load_dwordx4 a[124:127], v2, s[8:11], s22 offen offset:3072 sc1
  s_waitcnt vmcnt(24)
  s_add_u32 s22, s31, 118784
  buffer_load_dwordx4 a[128:131], v2, s[8:11], s22 offen offset:0 sc1
  buffer_load_dwordx4 a[132:135], v2, s[8:11], s22 offen offset:1024 sc1
  buffer_load_dwordx4 a[136:139], v2, s[8:11], s22 offen offset:2048 sc1
  buffer_load_dwordx4 a[140:143], v2, s[8:11], s22 offen offset:3072 sc1
  s_add_u32 s22, s31, 122880
  buffer_load_dwordx4 a[144:147], v2, s[8:11], s22 offen offset:0 sc1
  buffer_load_dwordx4 a[148:151], v2, s[8:11], s22 offen offset:1024 sc1
  buffer_load_dwordx4 a[152:155], v2, s[8:11], s22 offen offset:2048 sc1
  buffer_load_dwordx4 a[156:159], v2, s[8:11], s22 offen offset:3072 sc1
  s_add_u32 s22, s31, 126976
  buffer_load_dwordx4 a[160:163], v2, s[8:11], s22 offen offset:0 sc1
  buffer_load_dwordx4 a[164:167], v2, s[8:11], s22 offen offset:1024 sc1
  buffer_load_dwordx4 a[168:171], v2, s[8:11], s22 offen offset:2048 sc1
  buffer_load_dwordx4 a[172:175], v2, s[8:11], s22 offen offset:3072 sc1
  s_add_u32 s22, s31, 131072
  buffer_load_dwordx4 a[176:179], v2, s[8:11], s22 offen offset:0 sc1
  buffer_load_dwordx4 a[180:183], v2, s[8:11], s22 offen offset:1024 sc1
  buffer_load_dwordx4 a[184:187], v2, s[8:11], s22 offen offset:2048 sc1
  buffer_load_dwordx4 a[188:191], v2, s[8:11], s22 offen offset:3072 sc1
  s_add_u32 s22, s31, 135168
  buffer_load_dwordx4 a[192:195], v2, s[8:11], s22 offen offset:0 sc1
  buffer_load_dwordx4 a[196:199], v2, s[8:11], s22 offen offset:1024 sc1
  buffer_load_dwordx4 a[200:203], v2, s[8:11], s22 offen offset:2048 sc1
  buffer_load_dwordx4 a[204:207], v2, s[8:11], s22 offen offset:3072 sc1
  s_add_u32 s22, s31, 139264
  buffer_load_dwordx4 a[208:211], v2, s[8:11], s22 offen offset:0 sc1
  buffer_load_dwordx4 a[212:215], v2, s[8:11], s22 offen offset:1024 sc1
  buffer_load_dwordx4 a[216:219], v2, s[8:11], s22 offen offset:2048 sc1
  buffer_load_dwordx4 a[220:223], v2, s[8:11], s22 offen offset:3072 sc1
  s_add_u32 s22, s31, 143360
  buffer_load_dwordx4 a[224:227], v2, s[8:11], s22 offen offset:0 sc1
  buffer_load_dwordx4 a[228:231], v2, s[8:11], s22 offen offset:1024 sc1
  buffer_load_dwordx4 a[232:235], v2, s[8:11], s22 offen offset:2048 sc1
  buffer_load_dwordx4 a[236:239], v2, s[8:11], s22 offen offset:3072 sc1
  s_add_u32 s22, s31, 147456
  buffer_load_dwordx4 a[240:243], v2, s[8:11], s22 offen offset:0 sc1
  buffer_load_dwordx4 a[244:247], v2, s[8:11], s22 offen offset:1024 sc1
  buffer_load_dwordx4 a[248:251], v2, s[8:11], s22 offen offset:2048 sc1
  buffer_load_dwordx4 a[252:255], v2, s[8:11], s22 offen offset:3072 sc1
  s_waitcnt vmcnt(24)
  s_add_u32 s22, s31, 151552
  buffer_load_dwordx4 v[176:179], v2, s[8:11], s22 offen offset:0 sc1
  buffer_load_dwordx4 v[180:183], v2, s[8:11], s22 offen offset:1024 sc1
  buffer_load_dwordx4 v[184:187], v2, s[8:11], s22 offen offset:2048 sc1
  buffer_load_dwordx4 v[188:191], v2, s[8:11], s22 offen offset:3072 sc1
  s_add_u32 s22, s31, 155648
  buffer_load_dwordx4 v[192:195], v2, s[8:11], s22 offen offset:0 sc1
  buffer_load_dwordx4 v[196:199], v2, s[8:11], s22 offen offset:1024 sc1
  buffer_load_dwordx4 v[200:203], v2, s[8:11], s22 offen offset:2048 sc1
  buffer_load_dwordx4 v[204:207], v2, s[8:11], s22 offen offset:3072 sc1
  s_add_u32 s22, s31, 159744
  buffer_load_dwordx4 v[208:211], v2, s[8:11], s22 offen offset:0 sc1
  buffer_load_dwordx4 v[212:215], v2, s[8:11], s22 offen offset:1024 sc1
  buffer_load_dwordx4 v[216:219], v2, s[8:11], s22 offen offset:2048 sc1
  buffer_load_dwordx4 v[220:223], v2, s[8:11], s22 offen offset:3072 sc1
  s_add_u32 s22, s31, 163840
  buffer_load_dwordx4 v[224:227], v2, s[8:11], s22 offen offset:0 sc1
  buffer_load_dwordx4 v[228:231], v2, s[8:11], s22 offen offset:1024 sc1
  buffer_load_dwordx4 v[232:235], v2, s[8:11], s22 offen offset:2048 sc1
  buffer_load_dwordx4 v[236:239], v2, s[8:11], s22 offen offset:3072 sc1
  s_add_u32 s22, s31, 167936
  buffer_load_dwordx4 v[240:243], v2, s[8:11], s22 offen offset:0 sc1
  buffer_load_dwordx4 v[244:247], v2, s[8:11], s22 offen offset:1024 sc1
  buffer_load_dwordx4 v[248:251], v2, s[8:11], s22 offen offset:2048 sc1
  buffer_load_dwordx4 v[252:255], v2, s[8:11], s22 offen offset:3072 sc1
  s_mul_i32 s22, s17, 28
  s_add_u32 s23, s22, 27
  s_lshr_b32 s22, s22, 6
  s_lshr_b32 s23, s23, 6
  s_sub_u32 s23, s23, s22
  s_lshl_b32 s23, s23, 8
  v_and_b32 v36, s23, v2
  v_med3_u32 v37, v117, 15, 15
  v_lshl_add_u32 v36, v37, 4, v36
  s_lshl_b32 s22, s22, 8
  s_add_u32 s22, s22, 88588288
  s_mov_b32 s30, 0
va_bw_14:
  buffer_load_dwordx4 v[40:43], v36, s[8:11], s22 offen sc1
  s_waitcnt vmcnt(0)
  v_cmp_ne_u64 vcc, s[88:89], v[40:41]
  s_cbranch_vccnz va_bw_14_no
  v_cmp_ne_u64 vcc, s[88:89], v[42:43]
  s_cbranch_vccnz va_bw_14_no
  s_branch va_bw_14_ok
va_bw_14_no:
  s_sleep 2
  s_add_u32 s30, s30, 1
  s_cmp_lt_u32 s30, 50000
  s_cbranch_scc1 va_bw_14
  s_branch cA_abort
va_bw_14_ok:
  s_mov_b32 m0, 59392
  s_add_u32 s22, s31, 387072
  buffer_load_dwordx4 v2, s[8:11], s22 offen offset:0 sc1 lds
  buffer_load_dwordx4 v2, s[8:11], s22 offen offset:1024 sc1 lds
  buffer_load_dwordx4 v2, s[8:11], s22 offen offset:2048 sc1 lds
  buffer_load_dwordx4 v2, s[8:11], s22 offen offset:3072 sc1 lds
  s_mov_b32 m0, 63488
  s_add_u32 s22, s31, 391168
  buffer_load_dwordx4 v2, s[8:11], s22 offen offset:0 sc1 lds
  buffer_load_dwordx4 v2, s[8:11], s22 offen offset:1024 sc1 lds
  buffer_load_dwordx4 v2, s[8:11], s22 offen offset:2048 sc1 lds
  buffer_load_dwordx4 v2, s[8:11], s22 offen offset:3072 sc1 lds
  s_mov_b32 m0, 67584
  s_add_u32 s22, s31, 395264
  buffer_load_dwordx4 v2, s[8:11], s22 offen offset:0 sc1 lds
  buffer_load_dwordx4 v2, s[8:11], s22 offen offset:1024 sc1 lds
  buffer_load_dwordx4 v2, s[8:11], s22 offen offset:2048 sc1 lds
  buffer_load_dwordx4 v2, s[8:11], s22 offen offset:3072 sc1 lds
  s_mov_b32 m0, 71680
  s_add_u32 s22, s31, 399360
  buffer_load_dwordx4 v2, s[8:11], s22 offen offset:0 sc1 lds
  buffer_load_dwordx4 v2, s[8:11], s22 offen offset:1024 sc1 lds
  v_mov_b32 v72, v116
  v_mov_b32 v73, v117
  v_lshrrev_b32 v65, 1, v72
  v_and_b32 v66, 1, v72
  v_add_u32 v67, 6, v65
  v_lshl_add_u32 v67, v67, 4, v73
  v_mul_u32_u24 v68, 2341, v67
  v_lshrrev_b32 v68, 16, v68
  v_mul_u32_u24 v69, 28, v68
  v_sub_u32 v69, v67, v69
  v_lshrrev_b32 v70, 4, v69
  v_and_b32 v69, 15, v69
  v_and_b32 v71, 1, v69
  v_lshrrev_b32 v69, 1, v69
  v_lshl_add_u32 v69, v71, 3, v69
  v_lshlrev_b32 v71, 12, v70
  v_lshl_add_u32 v71, v68, 8, v71
  v_lshl_add_u32 v71, v69, 4, v71
  v_lshl_add_u32 v60, v66, 3, v71
  v_add_u32 v67, 8, v65
  v_lshl_add_u32 v67, v67, 4, v73
  v_mul_u32_u24 v68, 2341, v67
  v_lshrrev_b32 v68, 16, v68
  v_mul_u32_u24 v69, 28, v68
  v_sub_u32 v69, v67, v69
  v_lshrrev_b32 v70, 4, v69
  v_and_b32 v69, 15, v69
  v_and_b32 v71, 1, v69
  v_lshrrev_b32 v69, 1, v69
  v_lshl_add_u32 v69, v71, 3, v69
  v_lshlrev_b32 v71, 12, v70
  v_lshl_add_u32 v71, v68, 8, v71
  v_lshl_add_u32 v71, v69, 4, v71
  v_lshl_add_u32 v61, v66, 3, v71
  v_add_u32 v67, 10, v65
  v_lshl_add_u32 v67, v67, 4, v73
  v_mul_u32_u24 v68, 2341, v67
  v_lshrrev_b32 v68, 16, v68
  v_mul_u32_u24 v69, 28, v68
  v_sub_u32 v69, v67, v69
  v_lshrrev_b32 v70, 4, v69
  v_and_b32 v69, 15, v69
  v_and_b32 v71, 1, v69
  v_lshrrev_b32 v69, 1, v69
  v_lshl_add_u32 v69, v71, 3, v69
  v_lshlrev_b32 v71, 12, v70
  v_lshl_add_u32 v71, v68, 8, v71
  v_lshl_add_u32 v71, v69, 4, v71
  v_lshl_add_u32 v62, v66, 3, v71
  v_and_b32 v0, 31, v1
  v_lshlrev_b32 v0, 2, v0
  v_add_u32 v0, 21504, v0
  v_lshlrev_b32 v4, 2, v73
  s_and_b32 s22, s17, 15
  s_lshl_b32 s22, s22, 7
  s_add_u32 s22, s22, 17408
  v_add_u32 v4, s22, v4
  v_and_b32 v64, 7, v73
  v_lshlrev_b32 v5, 4, v64
  v_lshl_add_u32 v5, v72, 7, v5
  v_lshrrev_b32 v65, 3, v73
  v_lshl_add_u32 v5, v65, 9, v5
  s_lshl_b32 s22, s17, 3
  s_add_u32 s22, s22, 21508
  v_lshl_add_u32 v7, v2, 3, s22
  v_add_u32 v65, 16, v73
  v_min_u32 v65, 27, v65
  v_mad_u32_u24 v65, v72, 28, v65
  v_lshlrev_b32 v6, 4, v65
  s_lshr_b32 s22, s17, 1
  s_mul_i32 s22, s22, 7
  s_and_b32 s34, s17, 1
  s_lshl_b32 s35, s34, 2
  v_add_u32 v70, s35, v72
  v_mov_b32 v71, s34
  v_mov_b32 v69, 1
  v_cmp_eq_u32 vcc, 3, v72
  s_nop 1
  v_cndmask_b32 v70, v70, v72, vcc
  v_cndmask_b32 v69, v69, v71, vcc
  v_add_u32 v70, s22, v70
  v_lshrrev_b32 v68, 1, v70
  v_lshlrev_b32 v68, 8, v68
  v_lshl_add_u32 v68, v69, 7, v68
  v_and_b32 v69, 1, v70
  v_lshl_add_u32 v68, v69, 3, v68
  v_lshl_add_u32 v1, v64, 4, v68
  v_cmp_gt_u32 s[26:27], 8, v73
  v_cmp_gt_u32 vcc, 3, v72
  s_and_b64 s[26:27], s[26:27], vcc
  v_lshrrev_b32 v65, 3, v73
  v_lshl_add_u32 v66, v64, 1, v65
  v_add_u32 v66, 16, v66
  v_min_u32 v66, 27, v66
  v_mad_u32_u24 v66, v72, 28, v66
  v_lshlrev_b32 v6, 4, v66
  s_mul_i32 s22, s17, 28
  s_add_u32 s22, s22, 16
  v_lshl_add_u32 v70, v64, 1, s22
  v_lshrrev_b32 v68, 4, v70
  v_lshlrev_b32 v68, 8, v68
  v_bfe_u32 v69, v70, 1, 1
  v_lshl_add_u32 v68, v69, 7, v68
  v_bfe_u32 v69, v70, 2, 2
  v_lshl_add_u32 v68, v69, 2, v68
  v_and_b32 v69, 1, v72
  v_lshl_add_u32 v65, v69, 2, v65
  v_lshrrev_b32 v69, 1, v72
  v_lshl_add_u32 v65, v69, 1, v65
  v_lshl_add_u32 v1, v65, 4, v68
  v_cmp_gt_u32 s[26:27], 6, v64
  v_mov_b32 v156, 0
  v_mov_b32 v157, 0
  v_mov_b32 v158, 0
  v_mov_b32 v159, 0
  ds_write_b128 v2, v[156:159] offset:4096
  ds_write_b128 v2, v[156:159] offset:5120
  ds_write_b128 v2, v[156:159] offset:6144
  ds_write_b128 v2, v[156:159] offset:7168
  s_mul_i32 s22, s17, 1835008
  s_add_u32 s25, s22, 42205184
  s_lshl_b32 s35, s17, 7
  s_add_u32 s35, s35, 88526848
  s_mov_b32 s38, 0
  v_mov_b32 v175, 0
  s_lshl_b32 s22, 0, 11
  s_add_u32 s22, s22, 88590336
  v_add_u32 v36, 1024, v2
  v_min_u32 v36, 1776, v36
  s_mov_b32 s30, 0
va_iw5:
  buffer_load_dwordx4 v[40:43], v2, s[8:11], s22 offen sc1
  buffer_load_dwordx4 v[44:47], v36, s[8:11], s22 offen sc1
  s_waitcnt vmcnt(0)
  v_cmp_ne_u64 vcc, s[88:89], v[40:41]
  s_cbranch_vccnz va_iw5_no
  v_cmp_ne_u64 vcc, s[88:89], v[42:43]
  s_cbranch_vccnz va_iw5_no
  v_cmp_ne_u64 vcc, s[88:89], v[44:45]
  s_cbranch_vccnz va_iw5_no
  v_cmp_ne_u64 vcc, s[88:89], v[46:47]
  s_cbranch_vccnz va_iw5_no
  s_branch va_iw5_ok
va_iw5_no:
  s_sleep 2
  s_add_u32 s30, s30, 1
  s_cmp_lt_u32 s30, 50000
  s_cbranch_scc1 va_iw5
  s_branch cA_abort
va_iw5_ok:
  s_mov_b32 s30, 0
  v_mov_b32 v36, 0
ch_md5:
  buffer_load_dword v37, v36, s[12:15], 0 offen sc1
  s_waitcnt vmcnt(0)
  v_readfirstlane_b32 s22, v37
  s_and_b32 s31, s22, 0xffff
  s_cmp_ge_u32 s31, 32
  s_cbranch_scc1 ch_go5
  s_sleep 2
  s_add_u32 s30, s30, 1
  s_cmp_lt_u32 s30, 50000
  s_cbranch_scc1 ch_md5
  s_branch ch_end
ch_go5:
  s_mov_b32 s31, 0
  v_mov_b32 v36, 0
  v_mov_b32 v37, 0
  v_mov_b32 v38, 0
  v_mov_b32 v39, 0
  v_mov_b32 v40, 0
  v_mov_b32 v41, 0
  v_mov_b32 v42, 0
  v_mov_b32 v43, 0
  v_mov_b32 v44, 0
  v_mov_b32 v45, 0
  v_mov_b32 v46, 0
  v_mov_b32 v47, 0
  v_mov_b32 v48, 0
  v_mov_b32 v49, 0
  v_mov_b32 v50, 0
  v_mov_b32 v51, 0
  v_mov_b32 v52, 0
  v_mov_b32 v53, 0
  v_mov_b32 v54, 0
  v_mov_b32 v55, 0
  v_mov_b32 v56, 0
  v_mov_b32 v57, 0
  v_mov_b32 v58, 0
  v_mov_b32 v59, 0
  s_lshr_b32 s22, s22, 16
  s_cmp_lg_u32 s22, 0
  s_cbranch_scc1 cB_va1_loop
  s_branch cA_va1_loop
ch_init6:
  s_mul_i32 s31, s17, 401408
  s_add_u32 s31, s31, 6422528
  s_mul_i32 s22, s17, 28
  s_add_u32 s23, s22, 27
  s_lshr_b32 s22, s22, 6
  s_lshr_b32 s23, s23, 6
  s_sub_u32 s23, s23, s22
  s_lshl_b32 s23, s23, 8
  v_and_b32 v36, s23, v2
  v_med3_u32 v37, v117, 6, 10
  v_lshl_add_u32 v36, v37, 4, v36
  s_lshl_b32 s22, s22, 8
  s_add_u32 s22, s22, 88588288
  s_mov_b32 s30, 0
va_bw_15:
  buffer_load_dwordx4 v[40:43], v36, s[8:11], s22 offen sc1
  s_waitcnt vmcnt(0)
  v_cmp_ne_u64 vcc, s[88:89], v[40:41]
  s_cbranch_vccnz va_bw_15_no
  v_cmp_ne_u64 vcc, s[88:89], v[42:43]
  s_cbranch_vccnz va_bw_15_no
  s_branch va_bw_15_ok
va_bw_15_no:
  s_sleep 2
  s_add_u32 s30, s30, 1
  s_cmp_lt_u32 s30, 50000
  s_cbranch_scc1 va_bw_15
  s_branch cA_abort
va_bw_15_ok:
  s_add_u32 s22, s31, 172032
  buffer_load_dwordx4 a[0:3], v2, s[8:11], s22 offen offset:0 sc1
  buffer_load_dwordx4 a[4:7], v2, s[8:11], s22 offen offset:1024 sc1
  buffer_load_dwordx4 a[8:11], v2, s[8:11], s22 offen offset:2048 sc1
  buffer_load_dwordx4 a[12:15], v2, s[8:11], s22 offen offset:3072 sc1
  s_add_u32 s22, s31, 176128
  buffer_load_dwordx4 a[16:19], v2, s[8:11], s22 offen offset:0 sc1
  buffer_load_dwordx4 a[20:23], v2, s[8:11], s22 offen offset:1024 sc1
  buffer_load_dwordx4 a[24:27], v2, s[8:11], s22 offen offset:2048 sc1
  buffer_load_dwordx4 a[28:31], v2, s[8:11], s22 offen offset:3072 sc1
  s_add_u32 s22, s31, 180224
  buffer_load_dwordx4 a[32:35], v2, s[8:11], s22 offen offset:0 sc1
  buffer_load_dwordx4 a[36:39], v2, s[8:11], s22 offen offset:1024 sc1
  buffer_load_dwordx4 a[40:43], v2, s[8:11], s22 offen offset:2048 sc1
  buffer_load_dwordx4 a[44:47], v2, s[8:11], s22 offen offset:3072 sc1
  s_add_u32 s22, s31, 184320
  buffer_load_dwordx4 a[48:51], v2, s[8:11], s22 offen offset:0 sc1
  buffer_load_dwordx4 a[52:55], v2, s[8:11], s22 offen offset:1024 sc1
  buffer_load_dwordx4 a[56:59], v2, s[8:11], s22 offen offset:2048 sc1
  buffer_load_dwordx4 a[60:63], v2, s[8:11], s22 offen offset:3072 sc1
  s_add_u32 s22, s31, 188416
  buffer_load_dwordx4 a[64:67], v2, s[8:11], s22 offen offset:0 sc1
  buffer_load_dwordx4 a[68:71], v2, s[8:11], s22 offen offset:1024 sc1
  buffer_load_dwordx4 a[72:75], v2, s[8:11], s22 offen offset:2048 sc1
  buffer_load_dwordx4 a[76:79], v2, s[8:11], s22 offen offset:3072 sc1
  s_add_u32 s22, s31, 192512
  buffer_load_dwordx4 a[80:83], v2, s[8:11], s22 offen offset:0 sc1
  buffer_load_dwordx4 a[84:87], v2, s[8:11], s22 offen offset:1024 sc1
  buffer_load_dwordx4 a[88:91], v2, s[8:11], s22 offen offset:2048 sc1
  buffer_load_dwordx4 a[92:95], v2, s[8:11], s22 offen offset:3072 sc1
  s_add_u32 s22, s31, 196608
  buffer_load_dwordx4 a[96:99], v2, s[8:11], s22 offen offset:0 sc1
  buffer_load_dwordx4 a[100:103], v2, s[8:11], s22 offen offset:1024 sc1
  buffer_load_dwordx4 a[104:107], v2, s[8:11], s22 offen offset:2048 sc1
  buffer_load_dwordx4 a[108:111], v2, s[8:11], s22 offen offset:3072 sc1
  s_add_u32 s22, s31, 200704
  buffer_load_dwordx4 a[112:115], v2, s[8:11], s22 offen offset:0 sc1
  buffer_load_dwordx4 a[116:119], v2, s[8:11], s22 offen offset:1024 sc1
  buffer_load_dwordx4 a[120:123], v2, s[8:11], s22 offen offset:2048 sc1
  buffer_load_dwordx4 a[124:127], v2, s[8:11], s22 offen offset:3072 sc1
  s_waitcnt vmcnt(24)
  s_add_u32 s22, s31, 204800
  buffer_load_dwordx4 a[128:131], v2, s[8:11], s22 offen offset:0 sc1
  buffer_load_dwordx4 a[132:135], v2, s[8:11], s22 offen offset:1024 sc1
  buffer_load_dwordx4 a[136:139], v2, s[8:11], s22 offen offset:2048 sc1
  buffer_load_dwordx4 a[140:143], v2, s[8:11], s22 offen offset:3072 sc1
  s_add_u32 s22, s31, 208896
  buffer_load_dwordx4 a[144:147], v2, s[8:11], s22 offen offset:0 sc1
  buffer_load_dwordx4 a[148:151], v2, s[8:11], s22 offen offset:1024 sc1
  buffer_load_dwordx4 a[152:155], v2, s[8:11], s22 offen offset:2048 sc1
  buffer_load_dwordx4 a[156:159], v2, s[8:11], s22 offen offset:3072 sc1
  s_add_u32 s22, s31, 212992
  buffer_load_dwordx4 a[160:163], v2, s[8:11], s22 offen offset:0 sc1
  buffer_load_dwordx4 a[164:167], v2, s[8:11], s22 offen offset:1024 sc1
  buffer_load_dwordx4 a[168:171], v2, s[8:11], s22 offen offset:2048 sc1
  buffer_load_dwordx4 a[172:175], v2, s[8:11], s22 offen offset:3072 sc1
  s_add_u32 s22, s31, 217088
  buffer_load_dwordx4 a[176:179], v2, s[8:11], s22 offen offset:0 sc1
  buffer_load_dwordx4 a[180:183], v2, s[8:11], s22 offen offset:1024 sc1
  buffer_load_dwordx4 a[184:187], v2, s[8:11], s22 offen offset:2048 sc1
  buffer_load_dwordx4 a[188:191], v2, s[8:11], s22 offen offset:3072 sc1
  s_add_u32 s22, s31, 221184
  buffer_load_dwordx4 a[192:195], v2, s[8:11], s22 offen offset:0 sc1
  buffer_load_dwordx4 a[196:199], v2, s[8:11], s22 offen offset:1024 sc1
  buffer_load_dwordx4 a[200:203], v2, s[8:11], s22 offen offset:2048 sc1
  buffer_load_dwordx4 a[204:207], v2, s[8:11], s22 offen offset:3072 sc1
  s_add_u32 s22, s31, 225280
  buffer_load_dwordx4 a[208:211], v2, s[8:11], s22 offen offset:0 sc1
  buffer_load_dwordx4 a[212:215], v2, s[8:11], s22 offen offset:1024 sc1
  buffer_load_dwordx4 a[216:219], v2, s[8:11], s22 offen offset:2048 sc1
  buffer_load_dwordx4 a[220:223], v2, s[8:11], s22 offen offset:3072 sc1
  s_add_u32 s22, s31, 229376
  buffer_load_dwordx4 a[224:227], v2, s[8:11], s22 offen offset:0 sc1
  buffer_load_dwordx4 a[228:231], v2, s[8:11], s22 offen offset:1024 sc1
  buffer_load_dwordx4 a[232:235], v2, s[8:11], s22 offen offset:2048 sc1
  buffer_load_dwordx4 a[236:239], v2, s[8:11], s22 offen offset:3072 sc1
  s_add_u32 s22, s31, 233472
  buffer_load_dwordx4 a[240:243], v2, s[8:11], s22 offen offset:0 sc1
  buffer_load_dwordx4 a[244:247], v2, s[8:11], s22 offen offset:1024 sc1
  buffer_load_dwordx4 a[248:251], v2, s[8:11], s22 offen offset:2048 sc1
  buffer_load_dwordx4 a[252:255], v2, s[8:11], s22 offen offset:3072 sc1
  s_waitcnt vmcnt(24)
  s_add_u32 s22, s31, 237568
  buffer_load_dwordx4 v[120:123], v2, s[8:11], s22 offen offset:0 sc1
  buffer_load_dwordx4 v[124:127], v2, s[8:11], s22 offen offset:1024 sc1
  buffer_load_dwordx4 v[128:131], v2, s[8:11], s22 offen offset:2048 sc1
  buffer_load_dwordx4 v[132:135], v2, s[8:11], s22 offen offset:3072 sc1
  s_add_u32 s22, s31, 241664
  buffer_load_dwordx4 v[136:139], v2, s[8:11], s22 offen offset:0 sc1
  buffer_load_dwordx4 v[140:143], v2, s[8:11], s22 offen offset:1024 sc1
  buffer_load_dwordx4 v[144:147], v2, s[8:11], s22 offen offset:2048 sc1
  buffer_load_dwordx4 v[148:151], v2, s[8:11], s22 offen offset:3072 sc1
  s_add_u32 s22, s31, 245760
  buffer_load_dwordx4 v[152:155], v2, s[8:11], s22 offen offset:0 sc1
  buffer_load_dwordx4 v[156:159], v2, s[8:11], s22 offen offset:1024 sc1
  buffer_load_dwordx4 v[160:163], v2, s[8:11], s22 offen offset:2048 sc1
  buffer_load_dwordx4 v[164:167], v2, s[8:11], s22 offen offset:3072 sc1
  s_add_u32 s22, s31, 249856
  buffer_load_dwordx4 v[168:171], v2, s[8:11], s22 offen offset:0 sc1
  buffer_load_dwordx4 v[172:175], v2, s[8:11], s22 offen offset:1024 sc1
  buffer_load_dwordx4 v[176:179], v2, s[8:11], s22 offen offset:2048 sc1
  buffer_load_dwordx4 v[180:183], v2, s[8:11], s22 offen offset:3072 sc1
  s_add_u32 s22, s31, 253952
  buffer_load_dwordx4 v[184:187], v2, s[8:11], s22 offen offset:0 sc1
  buffer_load_dwordx4 v[188:191], v2, s[8:11], s22 offen offset:1024 sc1
  buffer_load_dwordx4 v[192:195], v2, s[8:11], s22 offen offset:2048 sc1
  buffer_load_dwordx4 v[196:199], v2, s[8:11], s22 offen offset:3072 sc1
  s_add_u32 s22, s31, 258048
  buffer_load_dwordx4 v[200:203], v2, s[8:11], s22 offen offset:0 sc1
  buffer_load_dwordx4 v[204:207], v2, s[8:11], s22 offen offset:1024 sc1
  buffer_load_dwordx4 v[208:211], v2, s[8:11], s22 offen offset:2048 sc1
  buffer_load_dwordx4 v[212:215], v2, s[8:11], s22 offen offset:3072 sc1
  s_add_u32 s22, s31, 262144
  buffer_load_dwordx4 v[216:219], v2, s[8:11], s22 offen offset:0 sc1
  buffer_load_dwordx4 v[220:223], v2, s[8:11], s22 offen offset:1024 sc1
  buffer_load_dwordx4 v[224:227], v2, s[8:11], s22 offen offset:2048 sc1
  buffer_load_dwordx4 v[228:231], v2, s[8:11], s22 offen offset:3072 sc1
  s_add_u32 s22, s31, 266240
  buffer_load_dwordx4 v[232:235], v2, s[8:11], s22 offen offset:0 sc1
  buffer_load_dwordx4 v[236:239], v2, s[8:11], s22 offen offset:1024 sc1
  buffer_load_dwordx4 v[240:243], v2, s[8:11], s22 offen offset:2048 sc1
  buffer_load_dwordx4 v[244:247], v2, s[8:11], s22 offen offset:3072 sc1
  s_waitcnt vmcnt(24)
  s_add_u32 s22, s31, 270336
  buffer_load_dwordx4 v[248:251], v2, s[8:11], s22 offen offset:0 sc1
  buffer_load_dwordx4 v[252:255], v2, s[8:11], s22 offen offset:1024 sc1
  v_mov_b32 v72, v116
  v_mov_b32 v73, v117
  v_lshrrev_b32 v65, 1, v72
  v_and_b32 v66, 1, v72
  v_add_u32 v67, 12, v65
  v_lshl_add_u32 v67, v67, 4, v73
  v_mul_u32_u24 v68, 2341, v67
  v_lshrrev_b32 v68, 16, v68
  v_mul_u32_u24 v69, 28, v68
  v_sub_u32 v69, v67, v69
  v_lshrrev_b32 v70, 4, v69
  v_and_b32 v69, 15, v69
  v_and_b32 v71, 1, v69
  v_lshrrev_b32 v69, 1, v69
  v_lshl_add_u32 v69, v71, 3, v69
  v_lshlrev_b32 v71, 12, v70
  v_lshl_add_u32 v71, v68, 8, v71
  v_lshl_add_u32 v71, v69, 4, v71
  v_lshl_add_u32 v112, v66, 3, v71
  v_add_u32 v67, 14, v65
  v_lshl_add_u32 v67, v67, 4, v73
  v_mul_u32_u24 v68, 2341, v67
  v_lshrrev_b32 v68, 16, v68
  v_mul_u32_u24 v69, 28, v68
  v_sub_u32 v69, v67, v69
  v_lshrrev_b32 v70, 4, v69
  v_and_b32 v69, 15, v69
  v_and_b32 v71, 1, v69
  v_lshrrev_b32 v69, 1, v69
  v_lshl_add_u32 v69, v71, 3, v69
  v_lshlrev_b32 v71, 12, v70
  v_lshl_add_u32 v71, v68, 8, v71
  v_lshl_add_u32 v71, v69, 4, v71
  v_lshl_add_u32 v113, v66, 3, v71
  v_add_u32 v67, 16, v65
  v_lshl_add_u32 v67, v67, 4, v73
  v_mul_u32_u24 v68, 2341, v67
  v_lshrrev_b32 v68, 16, v68
  v_mul_u32_u24 v69, 28, v68
  v_sub_u32 v69, v67, v69
  v_lshrrev_b32 v70, 4, v69
  v_and_b32 v69, 15, v69
  v_and_b32 v71, 1, v69
  v_lshrrev_b32 v69, 1, v69
  v_lshl_add_u32 v69, v71, 3, v69
  v_lshlrev_b32 v71, 12, v70
  v_lshl_add_u32 v71, v68, 8, v71
  v_lshl_add_u32 v71, v69, 4, v71
  v_lshl_add_u32 v114, v66, 3, v71
  v_add_u32 v67, 18, v65
  v_lshl_add_u32 v67, v67, 4, v73
  v_mul_u32_u24 v68, 2341, v67
  v_lshrrev_b32 v68, 16, v68
  v_mul_u32_u24 v69, 28, v68
  v_sub_u32 v69, v67, v69
  v_lshrrev_b32 v70, 4, v69
  v_and_b32 v69, 15, v69
  v_and_b32 v71, 1, v69
  v_lshrrev_b32 v69, 1, v69
  v_lshl_add_u32 v69, v71, 3, v69
  v_lshlrev_b32 v71, 12, v70
  v_lshl_add_u32 v71, v68, 8, v71
  v_lshl_add_u32 v71, v69, 4, v71
  v_lshl_add_u32 v115, v66, 3, v71
  s_mul_i32 s24, s17, 532480
  s_add_u32 s24, s24, 76926976
  s_mul_i32 s34, s17, 640
  s_add_u32 s34, s34, 88569856
  s_mul_i32 s36, s17, 448
  v_add_u32 v0, s36, v2
  v_add_u32 v0, 8192, v0
  s_add_u32 s36, s36, 88068096
  v_cmp_gt_u32 s[26:27], 28, v1
  v_and_b32 v119, 31, v1
  v_lshlrev_b32 v119, 2, v119
  s_add_u32 s22, s17, 16
  s_and_b32 s22, s22, 31
  s_lshl_b32 s22, s22, 7
  s_add_u32 s22, s22, 21504
  v_add_u32 v119, s22, v119
  v_min_u32 v118, 12, v1
  s_mul_i32 s22, s17, 13
  v_add_u32 v118, s22, v118
  v_lshlrev_b32 v118, 7, v118
  v_add_u32 v118, 51200, v118
  s_mov_b32 s39, 71565312
  v_add_u32 v1, 16384, v2
  v_mov_b32 v117, 1
  s_mul_i32 s38, s17, 1104
  s_add_u32 s38, s38, 25600
  s_lshl_b32 s22, 0, 11
  s_add_u32 s22, s22, 88590336
  v_add_u32 v36, 1024, v2
  v_min_u32 v36, 1776, v36
  s_mov_b32 s30, 0
va_iw6:
  buffer_load_dwordx4 v[40:43], v2, s[8:11], s22 offen sc1
  buffer_load_dwordx4 v[44:47], v36, s[8:11], s22 offen sc1
  s_waitcnt vmcnt(0)
  v_cmp_ne_u64 vcc, s[88:89], v[40:41]
  s_cbranch_vccnz va_iw6_no
  v_cmp_ne_u64 vcc, s[88:89], v[42:43]
  s_cbranch_vccnz va_iw6_no
  v_cmp_ne_u64 vcc, s[88:89], v[44:45]
  s_cbranch_vccnz va_iw6_no
  v_cmp_ne_u64 vcc, s[88:89], v[46:47]
  s_cbranch_vccnz va_iw6_no
  s_branch va_iw6_ok
va_iw6_no:
  s_sleep 2
  s_add_u32 s30, s30, 1
  s_cmp_lt_u32 s30, 50000
  s_cbranch_scc1 va_iw6
  s_branch cA_abort
va_iw6_ok:
  s_mov_b32 s30, 0
  v_mov_b32 v36, 0
ch_md6:
  buffer_load_dword v37, v36, s[12:15], 0 offen sc1
  s_waitcnt vmcnt(0)
  v_readfirstlane_b32 s22, v37
  s_and_b32 s31, s22, 0xffff
  s_cmp_ge_u32 s31, 32
  s_cbranch_scc1 ch_go6
  s_sleep 2
  s_add_u32 s30, s30, 1
  s_cmp_lt_u32 s30, 50000
  s_cbranch_scc1 ch_md6
  s_branch ch_end
ch_go6:
  s_mov_b32 s31, 0
  s_lshr_b32 s22, s22, 16
  s_cmp_lg_u32 s22, 0
  s_cbranch_scc1 cB_va2_loop
  s_branch cA_va2_loop
ch_init7:
  s_mul_i32 s31, s17, 401408
  s_add_u32 s31, s31, 6422528
  s_mul_i32 s22, s17, 28
  s_add_u32 s23, s22, 27
  s_lshr_b32 s22, s22, 6
  s_lshr_b32 s23, s23, 6
  s_sub_u32 s23, s23, s22
  s_lshl_b32 s23, s23, 8
  v_and_b32 v36, s23, v2
  v_med3_u32 v37, v117, 11, 15
  v_lshl_add_u32 v36, v37, 4, v36
  s_lshl_b32 s22, s22, 8
  s_add_u32 s22, s22, 88588288
  s_mov_b32 s30, 0
va_bw_16:
  buffer_load_dwordx4 v[40:43], v36, s[8:11], s22 offen sc1
  s_waitcnt vmcnt(0)
  v_cmp_ne_u64 vcc, s[88:89], v[40:41]
  s_cbranch_vccnz va_bw_16_no
  v_cmp_ne_u64 vcc, s[88:89], v[42:43]
  s_cbranch_vccnz va_bw_16_no
  s_branch va_bw_16_ok
va_bw_16_no:
  s_sleep 2
  s_add_u32 s30, s30, 1
  s_cmp_lt_u32 s30, 50000
  s_cbranch_scc1 va_bw_16
  s_branch cA_abort
va_bw_16_ok:
  s_add_u32 s22, s31, 286720
  buffer_load_dwordx4 a[0:3], v2, s[8:11], s22 offen offset:0 sc1
  buffer_load_dwordx4 a[4:7], v2, s[8:11], s22 offen offset:1024 sc1
  buffer_load_dwordx4 a[8:11], v2, s[8:11], s22 offen offset:2048 sc1
  buffer_load_dwordx4 a[12:15], v2, s[8:11], s22 offen offset:3072 sc1
  s_add_u32 s22, s31, 290816
  buffer_load_dwordx4 a[16:19], v2, s[8:11], s22 offen offset:0 sc1
  buffer_load_dwordx4 a[20:23], v2, s[8:11], s22 offen offset:1024 sc1
  buffer_load_dwordx4 a[24:27], v2, s[8:11], s22 offen offset:2048 sc1
  buffer_load_dwordx4 a[28:31], v2, s[8:11], s22 offen offset:3072 sc1
  s_add_u32 s22, s31, 294912
  buffer_load_dwordx4 a[32:35], v2, s[8:11], s22 offen offset:0 sc1
  buffer_load_dwordx4 a[36:39], v2, s[8:11], s22 offen offset:1024 sc1
  buffer_load_dwordx4 a[40:43], v2, s[8:11], s22 offen offset:2048 sc1
  buffer_load_dwordx4 a[44:47], v2, s[8:11], s22 offen offset:3072 sc1
  s_add_u32 s22, s31, 299008
  buffer_load_dwordx4 a[48:51], v2, s[8:11], s22 offen offset:0 sc1
  buffer_load_dwordx4 a[52:55], v2, s[8:11], s22 offen offset:1024 sc1
  buffer_load_dwordx4 a[56:59], v2, s[8:11], s22 offen offset:2048 sc1
  buffer_load_dwordx4 a[60:63], v2, s[8:11], s22 offen offset:3072 sc1
  s_add_u32 s22, s31, 303104
  buffer_load_dwordx4 a[64:67], v2, s[8:11], s22 offen offset:0 sc1
  buffer_load_dwordx4 a[68:71], v2, s[8:11], s22 offen offset:1024 sc1
  buffer_load_dwordx4 a[72:75], v2, s[8:11], s22 offen offset:2048 sc1
  buffer_load_dwordx4 a[76:79], v2, s[8:11], s22 offen offset:3072 sc1
  s_add_u32 s22, s31, 307200
  buffer_load_dwordx4 a[80:83], v2, s[8:11], s22 offen offset:0 sc1
  buffer_load_dwordx4 a[84:87], v2, s[8:11], s22 offen offset:1024 sc1
  buffer_load_dwordx4 a[88:91], v2, s[8:11], s22 offen offset:2048 sc1
  buffer_load_dwordx4 a[92:95], v2, s[8:11], s22 offen offset:3072 sc1
  s_add_u32 s22, s31, 311296
  buffer_load_dwordx4 a[96:99], v2, s[8:11], s22 offen offset:0 sc1
  buffer_load_dwordx4 a[100:103], v2, s[8:11], s22 offen offset:1024 sc1
  buffer_load_dwordx4 a[104:107], v2, s[8:11], s22 offen offset:2048 sc1
  buffer_load_dwordx4 a[108:111], v2, s[8:11], s22 offen offset:3072 sc1
  s_add_u32 s22, s31, 315392
  buffer_load_dwordx4 a[112:115], v2, s[8:11], s22 offen offset:0 sc1
  buffer_load_dwordx4 a[116:119], v2, s[8:11], s22 offen offset:1024 sc1
  buffer_load_dwordx4 a[120:123], v2, s[8:11], s22 offen offset:2048 sc1
  buffer_load_dwordx4 a[124:127], v2, s[8:11], s22 offen offset:3072 sc1
  s_waitcnt vmcnt(24)
  s_add_u32 s22, s31, 319488
  buffer_load_dwordx4 a[128:131], v2, s[8:11], s22 offen offset:0 sc1
  buffer_load_dwordx4 a[132:135], v2, s[8:11], s22 offen offset:1024 sc1
  buffer_load_dwordx4 a[136:139], v2, s[8:11], s22 offen offset:2048 sc1
  buffer_load_dwordx4 a[140:143], v2, s[8:11], s22 offen offset:3072 sc1
  s_add_u32 s22, s31, 323584
  buffer_load_dwordx4 a[144:147], v2, s[8:11], s22 offen offset:0 sc1
  buffer_load_dwordx4 a[148:151], v2, s[8:11], s22 offen offset:1024 sc1
  buffer_load_dwordx4 a[152:155], v2, s[8:11], s22 offen offset:2048 sc1
  buffer_load_dwordx4 a[156:159], v2, s[8:11], s22 offen offset:3072 sc1
  s_add_u32 s22, s31, 327680
  buffer_load_dwordx4 a[160:163], v2, s[8:11], s22 offen offset:0 sc1
  buffer_load_dwordx4 a[164:167], v2, s[8:11], s22 offen offset:1024 sc1
  buffer_load_dwordx4 a[168:171], v2, s[8:11], s22 offen offset:2048 sc1
  buffer_load_dwordx4 a[172:175], v2, s[8:11], s22 offen offset:3072 sc1
  s_add_u32 s22, s31, 331776
  buffer_load_dwordx4 a[176:179], v2, s[8:11], s22 offen offset:0 sc1
  buffer_load_dwordx4 a[180:183], v2, s[8:11], s22 offen offset:1024 sc1
  buffer_load_dwordx4 a[184:187], v2, s[8:11], s22 offen offset:2048 sc1
  buffer_load_dwordx4 a[188:191], v2, s[8:11], s22 offen offset:3072 sc1
  s_add_u32 s22, s31, 335872
  buffer_load_dwordx4 a[192:195], v2, s[8:11], s22 offen offset:0 sc1
  buffer_load_dwordx4 a[196:199], v2, s[8:11], s22 offen offset:1024 sc1
  buffer_load_dwordx4 a[200:203], v2, s[8:11], s22 offen offset:2048 sc1
  buffer_load_dwordx4 a[204:207], v2, s[8:11], s22 offen offset:3072 sc1
  s_add_u32 s22, s31, 339968
  buffer_load_dwordx4 a[208:211], v2, s[8:11], s22 offen offset:0 sc1
  buffer_load_dwordx4 a[212:215], v2, s[8:11], s22 offen offset:1024 sc1
  buffer_load_dwordx4 a[216:219], v2, s[8:11], s22 offen offset:2048 sc1
  buffer_load_dwordx4 a[220:223], v2, s[8:11], s22 offen offset:3072 sc1
  s_add_u32 s22, s31, 344064
  buffer_load_dwordx4 a[224:227], v2, s[8:11], s22 offen offset:0 sc1
  buffer_load_dwordx4 a[228:231], v2, s[8:11], s22 offen offset:1024 sc1
  buffer_load_dwordx4 a[232:235], v2, s[8:11], s22 offen offset:2048 sc1
  buffer_load_dwordx4 a[236:239], v2, s[8:11], s22 offen offset:3072 sc1
  s_add_u32 s22, s31, 348160
  buffer_load_dwordx4 a[240:243], v2, s[8:11], s22 offen offset:0 sc1
  buffer_load_dwordx4 a[244:247], v2, s[8:11], s22 offen offset:1024 sc1
  buffer_load_dwordx4 a[248:251], v2, s[8:11], s22 offen offset:2048 sc1
  buffer_load_dwordx4 a[252:255], v2, s[8:11], s22 offen offset:3072 sc1
  s_waitcnt vmcnt(24)
  s_add_u32 s22, s31, 352256
  buffer_load_dwordx4 v[120:123], v2, s[8:11], s22 offen offset:0 sc1
  buffer_load_dwordx4 v[124:127], v2, s[8:11], s22 offen offset:1024 sc1
  buffer_load_dwordx4 v[128:131], v2, s[8:11], s22 offen offset:2048 sc1
  buffer_load_dwordx4 v[132:135], v2, s[8:11], s22 offen offset:3072 sc1
  s_add_u32 s22, s31, 356352
  buffer_load_dwordx4 v[136:139], v2, s[8:11], s22 offen offset:0 sc1
  buffer_load_dwordx4 v[140:143], v2, s[8:11], s22 offen offset:1024 sc1
  buffer_load_dwordx4 v[144:147], v2, s[8:11], s22 offen offset:2048 sc1
  buffer_load_dwordx4 v[148:151], v2, s[8:11], s22 offen offset:3072 sc1
  s_add_u32 s22, s31, 360448
  buffer_load_dwordx4 v[152:155], v2, s[8:11], s22 offen offset:0 sc1
  buffer_load_dwordx4 v[156:159], v2, s[8:11], s22 offen offset:1024 sc1
  buffer_load_dwordx4 v[160:163], v2, s[8:11], s22 offen offset:2048 sc1
  buffer_load_dwordx4 v[164:167], v2, s[8:11], s22 offen offset:3072 sc1
  s_add_u32 s22, s31, 364544
  buffer_load_dwordx4 v[168:171], v2, s[8:11], s22 offen offset:0 sc1
  buffer_load_dwordx4 v[172:175], v2, s[8:11], s22 offen offset:1024 sc1
  buffer_load_dwordx4 v[176:179], v2, s[8:11], s22 offen offset:2048 sc1
  buffer_load_dwordx4 v[180:183], v2, s[8:11], s22 offen offset:3072 sc1
  s_add_u32 s22, s31, 368640
  buffer_load_dwordx4 v[184:187], v2, s[8:11], s22 offen offset:0 sc1
  buffer_load_dwordx4 v[188:191], v2, s[8:11], s22 offen offset:1024 sc1
  buffer_load_dwordx4 v[192:195], v2, s[8:11], s22 offen offset:2048 sc1
  buffer_load_dwordx4 v[196:199], v2, s[8:11], s22 offen offset:3072 sc1
  s_add_u32 s22, s31, 372736
  buffer_load_dwordx4 v[200:203], v2, s[8:11], s22 offen offset:0 sc1
  buffer_load_dwordx4 v[204:207], v2, s[8:11], s22 offen offset:1024 sc1
  buffer_load_dwordx4 v[208:211], v2, s[8:11], s22 offen offset:2048 sc1
  buffer_load_dwordx4 v[212:215], v2, s[8:11], s22 offen offset:3072 sc1
  s_add_u32 s22, s31, 376832
  buffer_load_dwordx4 v[216:219], v2, s[8:11], s22 offen offset:0 sc1
  buffer_load_dwordx4 v[220:223], v2, s[8:11], s22 offen offset:1024 sc1
  buffer_load_dwordx4 v[224:227], v2, s[8:11], s22 offen offset:2048 sc1
  buffer_load_dwordx4 v[228:231], v2, s[8:11], s22 offen offset:3072 sc1
  s_add_u32 s22, s31, 380928
  buffer_load_dwordx4 v[232:235], v2, s[8:11], s22 offen offset:0 sc1
  buffer_load_dwordx4 v[236:239], v2, s[8:11], s22 offen offset:1024 sc1
  buffer_load_dwordx4 v[240:243], v2, s[8:11], s22 offen offset:2048 sc1
  buffer_load_dwordx4 v[244:247], v2, s[8:11], s22 offen offset:3072 sc1
  s_waitcnt vmcnt(24)
  s_add_u32 s22, s31, 385024
  buffer_load_dwordx4 v[248:251], v2, s[8:11], s22 offen offset:0 sc1
  buffer_load_dwordx4 v[252:255], v2, s[8:11], s22 offen offset:1024 sc1
  v_mov_b32 v72, v116
  v_mov_b32 v73, v117
  v_lshrrev_b32 v65, 1, v72
  v_and_b32 v66, 1, v72
  v_add_u32 v67, 20, v65
  v_lshl_add_u32 v67, v67, 4, v73
  v_mul_u32_u24 v68, 2341, v67
  v_lshrrev_b32 v68, 16, v68
  v_mul_u32_u24 v69, 28, v68
  v_sub_u32 v69, v67, v69
  v_lshrrev_b32 v70, 4, v69
  v_and_b32 v69, 15, v69
  v_and_b32 v71, 1, v69
  v_lshrrev_b32 v69, 1, v69
  v_lshl_add_u32 v69, v71, 3, v69
  v_lshlrev_b32 v71, 12, v70
  v_lshl_add_u32 v71, v68, 8, v71
  v_lshl_add_u32 v71, v69, 4, v71
  v_lshl_add_u32 v112, v66, 3, v71
  v_add_u32 v67, 22, v65
  v_lshl_add_u32 v67, v67, 4, v73
  v_mul_u32_u24 v68, 2341, v67
  v_lshrrev_b32 v68, 16, v68
  v_mul_u32_u24 v69, 28, v68
  v_sub_u32 v69, v67, v69
  v_lshrrev_b32 v70, 4, v69
  v_and_b32 v69, 15, v69
  v_and_b32 v71, 1, v69
  v_lshrrev_b32 v69, 1, v69
  v_lshl_add_u32 v69, v71, 3, v69
  v_lshlrev_b32 v71, 12, v70
  v_lshl_add_u32 v71, v68, 8, v71
  v_lshl_add_u32 v71, v69, 4, v71
  v_lshl_add_u32 v113, v66, 3, v71
  v_add_u32 v67, 24, v65
  v_lshl_add_u32 v67, v67, 4, v73
  v_mul_u32_u24 v68, 2341, v67
  v_lshrrev_b32 v68, 16, v68
  v_mul_u32_u24 v69, 28, v68
  v_sub_u32 v69, v67, v69
  v_lshrrev_b32 v70, 4, v69
  v_and_b32 v69, 15, v69
  v_and_b32 v71, 1, v69
  v_lshrrev_b32 v69, 1, v69
  v_lshl_add_u32 v69, v71, 3, v69
  v_lshlrev_b32 v71, 12, v70
  v_lshl_add_u32 v71, v68, 8, v71
  v_lshl_add_u32 v71, v69, 4, v71
  v_lshl_add_u32 v114, v66, 3, v71
  v_add_u32 v67, 26, v65
  v_lshl_add_u32 v67, v67, 4, v73
  v_mul_u32_u24 v68, 2341, v67
  v_lshrrev_b32 v68, 16, v68
  v_mul_u32_u24 v69, 28, v68
  v_sub_u32 v69, v67, v69
  v_lshrrev_b32 v70, 4, v69
  v_and_b32 v69, 15, v69
  v_and_b32 v71, 1, v69
  v_lshrrev_b32 v69, 1, v69
  v_lshl_add_u32 v69, v71, 3, v69
  v_lshlrev_b32 v71, 12, v70
  v_lshl_add_u32 v71, v68, 8, v71
  v_lshl_add_u32 v71, v69, 4, v71
  v_lshl_add_u32 v115, v66, 3, v71
  s_mul_i32 s24, s17, 532480
  s_add_u32 s24, s24, 76931072
  s_mul_i32 s34, s17, 640
  s_add_u32 s34, s34, 88569860
  s_mul_i32 s36, s17, 448
  v_add_u32 v0, s36, v2
  v_add_u32 v0, 8192, v0
  s_add_u32 s36, s36, 88068096
  v_cmp_gt_u32 s[26:27], 28, v1
  v_and_b32 v119, 31, v1
  v_lshlrev_b32 v119, 2, v119
  s_add_u32 s22, s17, 16
  s_and_b32 s22, s22, 31
  s_lshl_b32 s22, s22, 7
  s_add_u32 s22, s22, 21504
  v_add_u32 v119, s22, v119
  v_min_u32 v118, 13, v1
  s_mul_i32 s22, s17, 14
  v_add_u32 v118, s22, v118
  v_lshlrev_b32 v118, 7, v118
  v_add_u32 v118, 57344, v118
  s_mov_b32 s39, 71565312
  v_add_u32 v1, 59392, v2
  v_mov_b32 v117, 1
  s_mul_i32 s38, s17, 1104
  s_add_u32 s38, s38, 26624
  s_lshl_b32 s22, 0, 11
  s_add_u32 s22, s22, 88590336
  v_add_u32 v36, 1024, v2
  v_min_u32 v36, 1776, v36
  s_mov_b32 s30, 0
va_iw7:
  buffer_load_dwordx4 v[40:43], v2, s[8:11], s22 offen sc1
  buffer_load_dwordx4 v[44:47], v36, s[8:11], s22 offen sc1
  s_waitcnt vmcnt(0)
  v_cmp_ne_u64 vcc, s[88:89], v[40:41]
  s_cbranch_vccnz va_iw7_no
  v_cmp_ne_u64 vcc, s[88:89], v[42:43]
  s_cbranch_vccnz va_iw7_no
  v_cmp_ne_u64 vcc, s[88:89], v[44:45]
  s_cbranch_vccnz va_iw7_no
  v_cmp_ne_u64 vcc, s[88:89], v[46:47]
  s_cbranch_vccnz va_iw7_no
  s_branch va_iw7_ok
va_iw7_no:
  s_sleep 2
  s_add_u32 s30, s30, 1
  s_cmp_lt_u32 s30, 50000
  s_cbranch_scc1 va_iw7
  s_branch cA_abort
va_iw7_ok:
  s_mov_b32 s30, 0
  v_mov_b32 v36, 0
ch_md7:
  buffer_load_dword v37, v36, s[12:15], 0 offen sc1
  s_waitcnt vmcnt(0)
  v_readfirstlane_b32 s22, v37
  s_and_b32 s31, s22, 0xffff
  s_cmp_ge_u32 s31, 32
  s_cbranch_scc1 ch_go7
  s_sleep 2
  s_add_u32 s30, s30, 1
  s_cmp_lt_u32 s30, 50000
  s_cbranch_scc1 ch_md7
  s_branch ch_end
ch_go7:
  s_mov_b32 s31, 0
  s_lshr_b32 s22, s22, 16
  s_cmp_lg_u32 s22, 0
  s_cbranch_scc1 cB_va3_loop
  s_branch cA_va3_loop
.p2align 6

cA_sc0_loop:
  s_add_u32 s23, s20, 4096
  s_add_u32 s21, s20, 25600
  v_mov_b32 v48, 0
  v_mov_b32 v49, 0
  v_mov_b32 v50, 0
  v_mov_b32 v51, 0
  v_mov_b32 v52, 0
  v_mov_b32 v53, 0
  v_mov_b32 v54, 0
  v_mov_b32 v55, 0
  v_mov_b32 v56, 0
  v_mov_b32 v57, 0
  v_mov_b32 v58, 0
  v_mov_b32 v59, 0
  v_mov_b32 v60, 0
  v_mov_b32 v61, 0
  v_mov_b32 v62, 0
  v_mov_b32 v63, 0
  v_mov_b32 v88, 0
  v_mov_b32 v89, 0
  v_mov_b32 v90, 0
  v_mov_b32 v91, 0
  v_mov_b32 v92, 0
  v_mov_b32 v93, 0
  v_mov_b32 v94, 0
  v_mov_b32 v95, 0
  v_mov_b32 v66, 0
  v_mov_b32 v67, 0
  s_mov_b32 s30, 0
  s_mov_b32 s62, 0
  buffer_load_dword v68, v0, s[8:11], s20 offen sc1
  s_nop 7
  buffer_load_dword v69, v0, s[8:11], s20 offen sc1
  s_nop 7
  buffer_load_dword v70, v0, s[8:11], s20 offen sc1
  s_nop 7
  buffer_load_dword v71, v0, s[8:11], s20 offen sc1
  s_nop 7
  buffer_load_dword v72, v0, s[8:11], s20 offen sc1
cA_sc0_fp_l:
  s_waitcnt vmcnt(4)
  v_cmp_eq_u32 vcc, -1, v68
  s_cbranch_vccz cA_sc0_fp_d
  buffer_load_dword v68, v0, s[8:11], s20 offen sc1
  s_waitcnt vmcnt(4)
  v_cmp_eq_u32 vcc, -1, v69
  s_cbranch_vccz cA_sc0_fp_d
  buffer_load_dword v69, v0, s[8:11], s20 offen sc1
  s_waitcnt vmcnt(4)
  v_cmp_eq_u32 vcc, -1, v70
  s_cbranch_vccz cA_sc0_fp_d
  buffer_load_dword v70, v0, s[8:11], s20 offen sc1
  s_waitcnt vmcnt(4)
  v_cmp_eq_u32 vcc, -1, v71
  s_cbranch_vccz cA_sc0_fp_d
  buffer_load_dword v71, v0, s[8:11], s20 offen sc1
  s_waitcnt vmcnt(4)
  v_cmp_eq_u32 vcc, -1, v72
  s_cbranch_vccz cA_sc0_fp_d
  buffer_load_dword v72, v0, s[8:11], s20 offen sc1
  s_add_u32 s30, s30, 1
  s_cmp_lt_u32 s30, 400000
  s_cbranch_scc1 cA_sc0_fp_l
  s_branch cA_abort
cA_sc0_fp_d:
  buffer_load_dwordx4 v[8:11], v2, s[8:11], s20 offen offset:0
  s_barrier
  s_branch cA_sc0_ld1
cA_sc0_ld:
  buffer_load_dwordx4 v[8:11], v2, s[8:11], s20 offen offset:0
cA_sc0_ld1:
  v_mov_b32 v36, 0
  v_mov_b32 v37, 0
  v_mov_b32 v38, 0
  v_mov_b32 v39, 0
  buffer_load_dwordx4 v[12:15], v2, s[8:11], s20 offen offset:1024
  v_mov_b32 v40, 0
  v_mov_b32 v41, 0
  v_mov_b32 v42, 0
  v_mov_b32 v43, 0
  buffer_load_dwordx4 v[16:19], v2, s[8:11], s20 offen offset:2048
  v_mov_b32 v44, 0
  v_mov_b32 v45, 0
  v_mov_b32 v46, 0
  v_mov_b32 v47, 0
  ds_read_b128 v[96:99], v117 offset:0
  ds_read_b128 v[100:103], v117 offset:1024
  ds_read_b128 v[104:107], v117 offset:14336
  ds_read_b128 v[108:111], v117 offset:15360
  s_waitcnt vmcnt(2)
  v_smfmac_f32_16x16x64_bf16 v[36:39], v[8:11], a[0:7], v3
  v_smfmac_f32_16x16x64_bf16 v[40:43], v[8:11], a[56:63], v3
  buffer_load_dwordx4 v[20:23], v2, s[8:11], s20 offen offset:3072
  v_smfmac_f32_16x16x64_bf16 v[44:47], v[8:11], a[112:119], v3
  v_smfmac_f32_16x16x64_bf16 v[48:51], v[8:11], a[168:175], v3
  v_smfmac_f32_16x16x64_bf16 v[52:55], v[8:11], a[224:231], v3
  buffer_load_dwordx4 v[24:27], v2, s[8:11], s23 offen offset:0
  v_smfmac_f32_16x16x64_bf16 v[56:59], v[8:11], v[144:151], v3
  v_smfmac_f32_16x16x64_bf16 v[60:63], v[8:11], v[200:207], v3
  s_waitcnt vmcnt(3)
  v_smfmac_f32_16x16x64_bf16 v[36:39], v[12:15], a[8:15], v3
  v_smfmac_f32_16x16x64_bf16 v[40:43], v[12:15], a[64:71], v3
  buffer_load_dwordx4 v[28:31], v2, s[8:11], s23 offen offset:1024
  v_smfmac_f32_16x16x64_bf16 v[44:47], v[12:15], a[120:127], v3
  v_smfmac_f32_16x16x64_bf16 v[48:51], v[12:15], a[176:183], v3
  v_smfmac_f32_16x16x64_bf16 v[52:55], v[12:15], a[232:239], v3
  buffer_load_dwordx4 v[32:35], v2, s[8:11], s23 offen offset:2048
  v_smfmac_f32_16x16x64_bf16 v[56:59], v[12:15], v[152:159], v3
  v_smfmac_f32_16x16x64_bf16 v[60:63], v[12:15], v[208:215], v3
  s_waitcnt vmcnt(4)
  v_smfmac_f32_16x16x64_bf16 v[36:39], v[16:19], a[16:23], v3
  v_smfmac_f32_16x16x64_bf16 v[40:43], v[16:19], a[72:79], v3
  v_smfmac_f32_16x16x64_bf16 v[44:47], v[16:19], a[128:135], v3
  v_smfmac_f32_16x16x64_bf16 v[48:51], v[16:19], a[184:191], v3
  v_smfmac_f32_16x16x64_bf16 v[52:55], v[16:19], a[240:247], v3
  v_smfmac_f32_16x16x64_bf16 v[56:59], v[16:19], v[160:167], v3
  v_smfmac_f32_16x16x64_bf16 v[60:63], v[16:19], v[216:223], v3
  s_waitcnt vmcnt(3)
  v_smfmac_f32_16x16x64_bf16 v[36:39], v[20:23], a[24:31], v3
  v_smfmac_f32_16x16x64_bf16 v[40:43], v[20:23], a[80:87], v3
  v_smfmac_f32_16x16x64_bf16 v[44:47], v[20:23], a[136:143], v3
  v_smfmac_f32_16x16x64_bf16 v[48:51], v[20:23], a[192:199], v3
  v_smfmac_f32_16x16x64_bf16 v[52:55], v[20:23], a[248:255], v3
  v_smfmac_f32_16x16x64_bf16 v[56:59], v[20:23], v[168:175], v3
  v_smfmac_f32_16x16x64_bf16 v[60:63], v[20:23], v[224:231], v3
  s_waitcnt vmcnt(0)
cA_sc0_ph2:
  v_smfmac_f32_16x16x64_bf16 v[60:63], v[24:27], v[232:239], v3
  ds_read_b128 v[12:15], v116 offset:0
  ds_read_b128 v[16:19], v116 offset:1024
  v_smfmac_f32_16x16x64_bf16 v[60:63], v[28:31], v[240:247], v3
  v_smfmac_f32_16x16x64_bf16 v[60:63], v[32:35], v[248:255], v3
  v_mov_b32 v80, v24
  v_smfmac_f32_16x16x64_bf16 v[52:55], v[24:27], v[120:127], v3
  v_mov_b32 v81, v25
  v_smfmac_f32_16x16x64_bf16 v[52:55], v[28:31], v[128:135], v3
  v_mov_b32 v82, v32
  v_smfmac_f32_16x16x64_bf16 v[52:55], v[32:35], v[136:143], v3
  v_cvt_pk_bf16_f32 v64, v60, v61
  v_smfmac_f32_16x16x64_bf16 v[56:59], v[24:27], v[176:183], v3
  v_cvt_pk_bf16_f32 v65, v62, v63
  v_smfmac_f32_16x16x64_bf16 v[56:59], v[28:31], v[184:191], v3
  v_mov_b32 v83, v33
  v_mfma_f32_16x16x32_bf16 v[68:71], v[64:67], v[4:7], 0
  v_smfmac_f32_16x16x64_bf16 v[56:59], v[32:35], v[192:199], v3
  v_cvt_pk_bf16_f32 v64, v52, v53
  v_smfmac_f32_16x16x64_bf16 v[36:39], v[24:27], a[32:39], v3
  v_cvt_pk_bf16_f32 v65, v54, v55
  v_smfmac_f32_16x16x64_bf16 v[36:39], v[28:31], a[40:47], v3
  v_cvt_pk_bf16_f32 v78, v68, v69
  v_smfmac_f32_16x16x64_bf16 v[36:39], v[32:35], a[48:55], v3
  v_cvt_pk_bf16_f32 v79, v70, v71
  v_cvt_pk_bf16_f32 v66, v56, v57
  v_smfmac_f32_16x16x64_bf16 v[40:43], v[24:27], a[88:95], v3
  v_cvt_pk_bf16_f32 v67, v58, v59
  v_smfmac_f32_16x16x64_bf16 v[40:43], v[28:31], a[96:103], v3
  v_mfma_f32_16x16x32_bf16 v[72:75], v[64:67], v[4:7], 0
  ds_read_b128 v[52:55], v116 offset:14336
  ds_read_b128 v[56:59], v116 offset:15360
  v_smfmac_f32_16x16x64_bf16 v[40:43], v[32:35], a[104:111], v3
  v_cvt_pk_bf16_f32 v64, v36, v37
  v_smfmac_f32_16x16x64_bf16 v[44:47], v[24:27], a[144:151], v3
  v_cvt_pk_bf16_f32 v65, v38, v39
  v_smfmac_f32_16x16x64_bf16 v[44:47], v[28:31], a[152:159], v3
  v_cvt_pk_bf16_f32 v76, v72, v73
  v_smfmac_f32_16x16x64_bf16 v[44:47], v[32:35], a[160:167], v3
  v_cvt_pk_bf16_f32 v77, v74, v75
  v_cvt_pk_bf16_f32 v66, v40, v41
  v_smfmac_f32_16x16x64_bf16 v[48:51], v[24:27], a[200:207], v3
  v_cvt_pk_bf16_f32 v67, v42, v43
  v_smfmac_f32_16x16x64_bf16 v[48:51], v[28:31], a[208:215], v3
  v_mfma_f32_16x16x32_bf16 v[68:71], v[64:67], v[4:7], 0
  v_smfmac_f32_16x16x64_bf16 v[48:51], v[32:35], a[216:223], v3
  v_cvt_pk_bf16_f32 v64, v44, v45
  v_mfma_f32_16x16x32_bf16 v[84:87], v[80:83], v[76:79], 0
  v_cvt_pk_bf16_f32 v65, v46, v47
  s_waitcnt lgkmcnt(0)
  v_smfmac_f32_16x16x64_bf16 v[88:91], v[76:79], v[96:103], v3
  v_cvt_pk_bf16_f32 v60, v68, v69
  v_cvt_pk_bf16_f32 v61, v70, v71
  v_cvt_pk_bf16_f32 v66, v48, v49
  v_cvt_pk_bf16_f32 v67, v50, v51
  s_nop 1
  v_mfma_f32_16x16x32_bf16 v[72:75], v[64:67], v[4:7], 0
  v_smfmac_f32_16x16x64_bf16 v[92:95], v[76:79], v[104:111], v3
  s_nop 4
  v_cvt_pk_bf16_f32 v62, v72, v73
  v_cvt_pk_bf16_f32 v63, v74, v75
  s_nop 1
  v_mfma_f32_16x16x32_bf16 v[84:87], v[8:11], v[60:63], v[84:87]
  v_smfmac_f32_16x16x64_bf16 v[88:91], v[60:63], v[12:19], v3
  v_smfmac_f32_16x16x64_bf16 v[92:95], v[60:63], v[52:59], v3
  s_mov_b64 exec, s[26:27]
  s_nop 0
  ds_write_b128 v113, v[84:87]
  s_mov_b64 exec, -1
  s_nop 0
  v_cmp_u_f32 vcc, v88, v89
  s_nop 1
  v_permlane32_swap_b32 v88, v92
  v_permlane32_swap_b32 v89, v93
  v_permlane32_swap_b32 v90, v94
  v_permlane32_swap_b32 v91, v95
  v_add_f32 v88, v88, v92
  v_add_f32 v89, v89, v93
  v_add_f32 v90, v90, v94
  v_add_f32 v91, v91, v95
  ds_write_b128 v112, v[88:91]
  s_cbranch_vccnz cA_sc0_retry
cA_sc0_cont:
  s_waitcnt lgkmcnt(0)
  s_barrier
  ds_read_b64 v[36:37], v114 offset:0
  ds_read_b64 v[38:39], v114 offset:1024
  ds_read2_b32 v[44:45], v115 offset0:0 offset1:64
  s_waitcnt lgkmcnt(0)
  v_add_f32 v44, v44, v45
  v_add_f32 v36, v36, v38
  v_add_f32 v37, v37, v39
  v_add_f32_dpp v44, v44, v44 row_ror:8 row_mask:0xf bank_mask:0xf
  v_mov_b32 v45, v44
  v_permlane32_swap_b32 v36, v37
  v_add_f32 v36, v36, v37
  v_permlane16_swap_b32 v44, v45
  v_add_f32 v44, v44, v45
  v_exp_f32 v48, v36
  v_exp_f32 v49, v44
  v_add_f32 v50, abs(v36), abs(v44)
  v_fma_f32 v39, v49, s37, v48
  v_cmp_ngt_f32 vcc, s56, v50
  v_cndmask_b32 v41, v48, v49, s[38:39]
  v_add_f32_dpp v39, v39, v39 quad_perm:[1,0,3,2] row_mask:0xf bank_mask:0xf
  v_cndmask_b32 v40, v49, v48, s[38:39]
  v_mov_b32_dpp v46, v41 quad_perm:[1,0,3,2] row_mask:0xf bank_mask:0xf
  v_add_f32_dpp v39, v39, v39 quad_perm:[2,3,0,1] row_mask:0xf bank_mask:0xf
  v_cndmask_b32 v42, v46, v40, s[38:39]
  v_cndmask_b32 v43, v40, v46, s[38:39]
  v_add_f32_dpp v39, v39, v39 row_half_mirror row_mask:0xf bank_mask:0xf
  s_cbranch_vccnz cA_sc0_slow
  s_nop 0
  v_add_f32_dpp v39, v39, v39 row_mirror row_mask:0xf bank_mask:0xf
  v_mov_b32 v47, v39
  s_nop 1
  v_permlane16_swap_b32 v39, v47
  v_add_f32 v39, v39, v47
  v_rcp_f32 v39, v39
  s_mov_b64 exec, s[28:29]
  v_mul_f32 v42, v42, v39
  v_mul_f32 v43, v43, v39
  v_cvt_pk_bf16_f32 v42, v42, v43
cA_sc0_pst:
  buffer_store_dword v42, v1, s[8:11], s20 offen
  s_mov_b64 exec, -1
  s_barrier
  s_add_u32 s24, s24, 28672
  s_add_u32 s35, s35, 28672
  s_xor_b32 s25, s25, 28672
  s_add_u32 m0, s25, 0
  s_nop 0
  buffer_load_dwordx4 v2, s[8:11], s24 offen offset:0 sc1 lds
  buffer_load_dwordx4 v2, s[8:11], s24 offen offset:1024 sc1 lds
  buffer_load_dwordx4 v2, s[8:11], s24 offen offset:2048 sc1 lds
  buffer_load_dwordx4 v2, s[8:11], s24 offen offset:3072 sc1 lds
  s_add_u32 m0, s25, 4096
  s_add_u32 s22, s24, 4096
  buffer_load_dwordx4 v2, s[8:11], s22 offen offset:0 sc1 lds
  buffer_load_dwordx4 v2, s[8:11], s22 offen offset:1024 sc1 lds
  buffer_load_dwordx4 v2, s[8:11], s22 offen offset:2048 sc1 lds
  v_xor_b32 v116, 28672, v116
  v_add_u32 v117, s57, v117
  s_sub_u32 s57, 0, s57
  s_add_u32 s19, s19, 1
  s_mov_b32 s20, s21
  s_cmp_lt_u32 s19, 63
  s_cbranch_scc1 cA_sc0_loop
  s_branch cA_done
cA_sc0_slow:
  v_max_f32 v50, v36, v44
  s_nop 1
  v_max_f32_dpp v50, v50, v50 quad_perm:[1,0,3,2] row_mask:0xf bank_mask:0xf
  s_nop 1
  v_max_f32_dpp v50, v50, v50 quad_perm:[2,3,0,1] row_mask:0xf bank_mask:0xf
  s_nop 1
  v_max_f32_dpp v50, v50, v50 row_half_mirror row_mask:0xf bank_mask:0xf
  s_nop 1
  v_max_f32_dpp v50, v50, v50 row_mirror row_mask:0xf bank_mask:0xf
  v_mov_b32 v47, v50
  s_nop 1
  v_permlane16_swap_b32 v50, v47
  v_max_f32 v50, v50, v47
  v_sub_f32 v48, v36, v50
  v_sub_f32 v49, v44, v50
  v_exp_f32 v48, v48
  v_exp_f32 v49, v49
  s_add_u32 s31, s31, 0x100
  v_fma_f32 v39, v49, s37, v48
  v_cndmask_b32 v41, v48, v49, s[38:39]
  s_nop 0
  v_add_f32_dpp v39, v39, v39 quad_perm:[1,0,3,2] row_mask:0xf bank_mask:0xf
  v_cndmask_b32 v40, v49, v48, s[38:39]
  v_mov_b32_dpp v46, v41 quad_perm:[1,0,3,2] row_mask:0xf bank_mask:0xf
  v_add_f32_dpp v39, v39, v39 quad_perm:[2,3,0,1] row_mask:0xf bank_mask:0xf
  v_cndmask_b32 v42, v46, v40, s[38:39]
  v_cndmask_b32 v43, v40, v46, s[38:39]
  v_add_f32_dpp v39, v39, v39 row_half_mirror row_mask:0xf bank_mask:0xf
  s_nop 1
  v_add_f32_dpp v39, v39, v39 row_mirror row_mask:0xf bank_mask:0xf
  v_mov_b32 v47, v39
  s_nop 1
  v_permlane16_swap_b32 v39, v47
  v_add_f32 v39, v39, v47
  v_rcp_f32 v39, v39
  s_mov_b64 exec, s[28:29]
  v_mul_f32 v42, v42, v39
  v_mul_f32 v43, v43, v39
  v_cvt_pk_bf16_f32 v42, v42, v43
  v_min_u32 v42, -2, v42
  s_branch cA_sc0_pst
cA_sc0_retry:
  s_cmp_lg_u32 s62, 0
  s_cbranch_scc1 cA_sc0_cont
  s_waitcnt vmcnt(0) lgkmcnt(0)
cA_sc0_rv:
  buffer_load_dwordx4 v[8:11], v2, s[8:11], s20 offen offset:0 sc1
  buffer_load_dwordx4 v[12:15], v2, s[8:11], s20 offen offset:1024 sc1
  buffer_load_dwordx4 v[16:19], v2, s[8:11], s20 offen offset:2048 sc1
  buffer_load_dwordx4 v[20:23], v2, s[8:11], s20 offen offset:3072 sc1
  buffer_load_dwordx4 v[24:27], v2, s[8:11], s23 offen offset:0 sc1
  buffer_load_dwordx4 v[28:31], v2, s[8:11], s23 offen offset:1024 sc1
  buffer_load_dwordx4 v[32:35], v2, s[8:11], s23 offen offset:2048 sc1
  s_waitcnt vmcnt(0)
  v_max3_u32 v118, v8, v9, v10
  v_max3_u32 v118, v118, v11, v12
  v_max3_u32 v118, v118, v13, v14
  v_max3_u32 v118, v118, v15, v16
  v_max3_u32 v118, v118, v17, v18
  v_max3_u32 v118, v118, v19, v20
  v_max3_u32 v118, v118, v21, v22
  v_max3_u32 v118, v118, v23, v24
  v_max3_u32 v118, v118, v25, v26
  v_max3_u32 v118, v118, v27, v28
  v_max3_u32 v118, v118, v29, v30
  v_max3_u32 v118, v118, v31, v32
  v_max3_u32 v118, v118, v33, v34
  v_max_u32 v118, v118, v35
  v_cmp_eq_u32 vcc, -1, v118
  s_cbranch_vccz cA_sc0_rk
  s_add_u32 s30, s30, 1
  s_cmp_lt_u32 s30, 400000
  s_cbranch_scc1 cA_sc0_rv
  s_branch cA_abort
cA_sc0_rk:
  s_mov_b32 s62, 1
  v_mov_b32 v36, 0
  v_mov_b32 v37, 0
  v_mov_b32 v38, 0
  v_mov_b32 v39, 0
  v_mov_b32 v40, 0
  v_mov_b32 v41, 0
  v_mov_b32 v42, 0
  v_mov_b32 v43, 0
  v_mov_b32 v44, 0
  v_mov_b32 v45, 0
  v_mov_b32 v46, 0
  v_mov_b32 v47, 0
  v_mov_b32 v48, 0
  v_mov_b32 v49, 0
  v_mov_b32 v50, 0
  v_mov_b32 v51, 0
  v_mov_b32 v52, 0
  v_mov_b32 v53, 0
  v_mov_b32 v54, 0
  v_mov_b32 v55, 0
  v_mov_b32 v56, 0
  v_mov_b32 v57, 0
  v_mov_b32 v58, 0
  v_mov_b32 v59, 0
  v_mov_b32 v60, 0
  v_mov_b32 v61, 0
  v_mov_b32 v62, 0
  v_mov_b32 v63, 0
  v_mov_b32 v88, 0
  v_mov_b32 v89, 0
  v_mov_b32 v90, 0
  v_mov_b32 v91, 0
  v_mov_b32 v92, 0
  v_mov_b32 v93, 0
  v_mov_b32 v94, 0
  v_mov_b32 v95, 0
  v_mov_b32 v66, 0
  v_mov_b32 v67, 0
  s_add_u32 s31, s31, 1
  ds_read_b128 v[96:99], v117 offset:0
  ds_read_b128 v[100:103], v117 offset:1024
  ds_read_b128 v[104:107], v117 offset:14336
  ds_read_b128 v[108:111], v117 offset:15360
  v_smfmac_f32_16x16x64_bf16 v[36:39], v[8:11], a[0:7], v3
  v_smfmac_f32_16x16x64_bf16 v[40:43], v[8:11], a[56:63], v3
  v_smfmac_f32_16x16x64_bf16 v[44:47], v[8:11], a[112:119], v3
  v_smfmac_f32_16x16x64_bf16 v[48:51], v[8:11], a[168:175], v3
  v_smfmac_f32_16x16x64_bf16 v[52:55], v[8:11], a[224:231], v3
  v_smfmac_f32_16x16x64_bf16 v[56:59], v[8:11], v[144:151], v3
  v_smfmac_f32_16x16x64_bf16 v[60:63], v[8:11], v[200:207], v3
  v_smfmac_f32_16x16x64_bf16 v[36:39], v[12:15], a[8:15], v3
  v_smfmac_f32_16x16x64_bf16 v[40:43], v[12:15], a[64:71], v3
  v_smfmac_f32_16x16x64_bf16 v[44:47], v[12:15], a[120:127], v3
  v_smfmac_f32_16x16x64_bf16 v[48:51], v[12:15], a[176:183], v3
  v_smfmac_f32_16x16x64_bf16 v[52:55], v[12:15], a[232:239], v3
  v_smfmac_f32_16x16x64_bf16 v[56:59], v[12:15], v[152:159], v3
  v_smfmac_f32_16x16x64_bf16 v[60:63], v[12:15], v[208:215], v3
  v_smfmac_f32_16x16x64_bf16 v[36:39], v[16:19], a[16:23], v3
  v_smfmac_f32_16x16x64_bf16 v[40:43], v[16:19], a[72:79], v3
  v_smfmac_f32_16x16x64_bf16 v[44:47], v[16:19], a[128:135], v3
  v_smfmac_f32_16x16x64_bf16 v[48:51], v[16:19], a[184:191], v3
  v_smfmac_f32_16x16x64_bf16 v[52:55], v[16:19], a[240:247], v3
  v_smfmac_f32_16x16x64_bf16 v[56:59], v[16:19], v[160:167], v3
  v_smfmac_f32_16x16x64_bf16 v[60:63], v[16:19], v[216:223], v3
  v_smfmac_f32_16x16x64_bf16 v[36:39], v[20:23], a[24:31], v3
  v_smfmac_f32_16x16x64_bf16 v[40:43], v[20:23], a[80:87], v3
  v_smfmac_f32_16x16x64_bf16 v[44:47], v[20:23], a[136:143], v3
  v_smfmac_f32_16x16x64_bf16 v[48:51], v[20:23], a[192:199], v3
  v_smfmac_f32_16x16x64_bf16 v[52:55], v[20:23], a[248:255], v3
  v_smfmac_f32_16x16x64_bf16 v[56:59], v[20:23], v[168:175], v3
  v_smfmac_f32_16x16x64_bf16 v[60:63], v[20:23], v[224:231], v3
  s_branch cA_sc0_ph2
.p2align 6

cA_sc1_loop:
  s_add_u32 s23, s20, 4096
  s_add_u32 s21, s20, 25600
  v_mov_b32 v48, 0
  v_mov_b32 v49, 0
  v_mov_b32 v50, 0
  v_mov_b32 v51, 0
  v_mov_b32 v52, 0
  v_mov_b32 v53, 0
  v_mov_b32 v54, 0
  v_mov_b32 v55, 0
  v_mov_b32 v56, 0
  v_mov_b32 v57, 0
  v_mov_b32 v58, 0
  v_mov_b32 v59, 0
  v_mov_b32 v60, 0
  v_mov_b32 v61, 0
  v_mov_b32 v62, 0
  v_mov_b32 v63, 0
  v_mov_b32 v88, 0
  v_mov_b32 v89, 0
  v_mov_b32 v90, 0
  v_mov_b32 v91, 0
  v_mov_b32 v92, 0
  v_mov_b32 v93, 0
  v_mov_b32 v94, 0
  v_mov_b32 v95, 0
  v_mov_b32 v64, 0
  v_mov_b32 v65, 0
  s_mov_b32 s30, 0
  s_mov_b32 s62, 0
  s_waitcnt vmcnt(0)
  s_barrier
cA_sc1_ld:
  buffer_load_dwordx4 v[8:11], v2, s[8:11], s20 offen offset:0
  v_mov_b32 v36, 0
  v_mov_b32 v37, 0
  v_mov_b32 v38, 0
  v_mov_b32 v39, 0
  buffer_load_dwordx4 v[12:15], v2, s[8:11], s20 offen offset:1024
  v_mov_b32 v40, 0
  v_mov_b32 v41, 0
  v_mov_b32 v42, 0
  v_mov_b32 v43, 0
  buffer_load_dwordx4 v[16:19], v2, s[8:11], s20 offen offset:2048
  v_mov_b32 v44, 0
  v_mov_b32 v45, 0
  v_mov_b32 v46, 0
  v_mov_b32 v47, 0
  ds_read_b128 v[96:99], v117 offset:0
  ds_read_b128 v[100:103], v117 offset:1024
  ds_read_b128 v[104:107], v117 offset:14336
  ds_read_b128 v[108:111], v117 offset:15360
  s_waitcnt vmcnt(2)
  v_smfmac_f32_16x16x64_bf16 v[36:39], v[8:11], a[0:7], v3
  v_smfmac_f32_16x16x64_bf16 v[40:43], v[8:11], a[56:63], v3
  buffer_load_dwordx4 v[20:23], v2, s[8:11], s20 offen offset:3072
  v_smfmac_f32_16x16x64_bf16 v[44:47], v[8:11], a[112:119], v3
  v_smfmac_f32_16x16x64_bf16 v[48:51], v[8:11], a[168:175], v3
  v_smfmac_f32_16x16x64_bf16 v[52:55], v[8:11], a[224:231], v3
  buffer_load_dwordx4 v[24:27], v2, s[8:11], s23 offen offset:0
  v_smfmac_f32_16x16x64_bf16 v[56:59], v[8:11], v[144:151], v3
  v_smfmac_f32_16x16x64_bf16 v[60:63], v[8:11], v[200:207], v3
  s_waitcnt vmcnt(3)
  v_smfmac_f32_16x16x64_bf16 v[36:39], v[12:15], a[8:15], v3
  v_smfmac_f32_16x16x64_bf16 v[40:43], v[12:15], a[64:71], v3
  buffer_load_dwordx4 v[28:31], v2, s[8:11], s23 offen offset:1024
  v_smfmac_f32_16x16x64_bf16 v[44:47], v[12:15], a[120:127], v3
  v_smfmac_f32_16x16x64_bf16 v[48:51], v[12:15], a[176:183], v3
  v_smfmac_f32_16x16x64_bf16 v[52:55], v[12:15], a[232:239], v3
  buffer_load_dwordx4 v[32:35], v2, s[8:11], s23 offen offset:2048
  v_smfmac_f32_16x16x64_bf16 v[56:59], v[12:15], v[152:159], v3
  v_smfmac_f32_16x16x64_bf16 v[60:63], v[12:15], v[208:215], v3
  s_waitcnt vmcnt(4)
  v_smfmac_f32_16x16x64_bf16 v[36:39], v[16:19], a[16:23], v3
  v_smfmac_f32_16x16x64_bf16 v[40:43], v[16:19], a[72:79], v3
  v_smfmac_f32_16x16x64_bf16 v[44:47], v[16:19], a[128:135], v3
  v_smfmac_f32_16x16x64_bf16 v[48:51], v[16:19], a[184:191], v3
  v_smfmac_f32_16x16x64_bf16 v[52:55], v[16:19], a[240:247], v3
  v_smfmac_f32_16x16x64_bf16 v[56:59], v[16:19], v[160:167], v3
  v_smfmac_f32_16x16x64_bf16 v[60:63], v[16:19], v[216:223], v3
  s_waitcnt vmcnt(3)
  v_smfmac_f32_16x16x64_bf16 v[36:39], v[20:23], a[24:31], v3
  v_smfmac_f32_16x16x64_bf16 v[40:43], v[20:23], a[80:87], v3
  v_smfmac_f32_16x16x64_bf16 v[44:47], v[20:23], a[136:143], v3
  v_smfmac_f32_16x16x64_bf16 v[48:51], v[20:23], a[192:199], v3
  v_smfmac_f32_16x16x64_bf16 v[52:55], v[20:23], a[248:255], v3
  v_smfmac_f32_16x16x64_bf16 v[56:59], v[20:23], v[168:175], v3
  v_smfmac_f32_16x16x64_bf16 v[60:63], v[20:23], v[224:231], v3
  s_waitcnt vmcnt(0)
cA_sc1_ph2:
  v_smfmac_f32_16x16x64_bf16 v[60:63], v[24:27], v[232:239], v3
  ds_read_b128 v[16:19], v116 offset:2048
  ds_read_b128 v[20:23], v116 offset:3072
  v_smfmac_f32_16x16x64_bf16 v[60:63], v[28:31], v[240:247], v3
  buffer_load_dword v119, v0, s[8:11], s20 offen sc1
  v_smfmac_f32_16x16x64_bf16 v[60:63], v[32:35], v[248:255], v3
  v_mov_b32 v80, v26
  v_smfmac_f32_16x16x64_bf16 v[52:55], v[24:27], v[120:127], v3
  v_mov_b32 v81, v27
  v_smfmac_f32_16x16x64_bf16 v[52:55], v[28:31], v[128:135], v3
  v_mov_b32 v82, v32
  v_smfmac_f32_16x16x64_bf16 v[52:55], v[32:35], v[136:143], v3
  v_cvt_pk_bf16_f32 v66, v60, v61
  v_smfmac_f32_16x16x64_bf16 v[56:59], v[24:27], v[176:183], v3
  v_cvt_pk_bf16_f32 v67, v62, v63
  v_smfmac_f32_16x16x64_bf16 v[56:59], v[28:31], v[184:191], v3
  v_mov_b32 v83, v33
  v_mfma_f32_16x16x32_bf16 v[68:71], v[64:67], v[4:7], 0
  v_smfmac_f32_16x16x64_bf16 v[56:59], v[32:35], v[192:199], v3
  v_cvt_pk_bf16_f32 v64, v52, v53
  v_smfmac_f32_16x16x64_bf16 v[36:39], v[24:27], a[32:39], v3
  v_cvt_pk_bf16_f32 v65, v54, v55
  v_smfmac_f32_16x16x64_bf16 v[36:39], v[28:31], a[40:47], v3
  v_cvt_pk_bf16_f32 v78, v68, v69
  v_smfmac_f32_16x16x64_bf16 v[36:39], v[32:35], a[48:55], v3
  v_cvt_pk_bf16_f32 v79, v70, v71
  v_cvt_pk_bf16_f32 v66, v56, v57
  v_smfmac_f32_16x16x64_bf16 v[40:43], v[24:27], a[88:95], v3
  v_cvt_pk_bf16_f32 v67, v58, v59
  v_smfmac_f32_16x16x64_bf16 v[40:43], v[28:31], a[96:103], v3
  v_mfma_f32_16x16x32_bf16 v[72:75], v[64:67], v[4:7], 0
  ds_read_b128 v[52:55], v116 offset:16384
  ds_read_b128 v[56:59], v116 offset:17408
  v_smfmac_f32_16x16x64_bf16 v[40:43], v[32:35], a[104:111], v3
  v_cvt_pk_bf16_f32 v64, v36, v37
  v_smfmac_f32_16x16x64_bf16 v[44:47], v[24:27], a[144:151], v3
  v_cvt_pk_bf16_f32 v65, v38, v39
  v_smfmac_f32_16x16x64_bf16 v[44:47], v[28:31], a[152:159], v3
  v_cvt_pk_bf16_f32 v76, v72, v73
  v_smfmac_f32_16x16x64_bf16 v[44:47], v[32:35], a[160:167], v3
  v_cvt_pk_bf16_f32 v77, v74, v75
  v_cvt_pk_bf16_f32 v66, v40, v41
  v_smfmac_f32_16x16x64_bf16 v[48:51], v[24:27], a[200:207], v3
  v_cvt_pk_bf16_f32 v67, v42, v43
  v_smfmac_f32_16x16x64_bf16 v[48:51], v[28:31], a[208:215], v3
  v_mfma_f32_16x16x32_bf16 v[68:71], v[64:67], v[4:7], 0
  v_smfmac_f32_16x16x64_bf16 v[48:51], v[32:35], a[216:223], v3
  v_cvt_pk_bf16_f32 v64, v44, v45
  v_mfma_f32_16x16x32_bf16 v[84:87], v[80:83], v[76:79], 0
  v_cvt_pk_bf16_f32 v65, v46, v47
  s_waitcnt lgkmcnt(0)
  v_smfmac_f32_16x16x64_bf16 v[88:91], v[76:79], v[96:103], v3
  v_cvt_pk_bf16_f32 v60, v68, v69
  v_cvt_pk_bf16_f32 v61, v70, v71
  v_cvt_pk_bf16_f32 v66, v48, v49
  v_cvt_pk_bf16_f32 v67, v50, v51
  s_nop 1
  v_mfma_f32_16x16x32_bf16 v[72:75], v[64:67], v[4:7], 0
  v_smfmac_f32_16x16x64_bf16 v[92:95], v[76:79], v[104:111], v3
  s_nop 4
  v_cvt_pk_bf16_f32 v62, v72, v73
  v_cvt_pk_bf16_f32 v63, v74, v75
  s_nop 1
  v_mfma_f32_16x16x32_bf16 v[84:87], v[12:15], v[60:63], v[84:87]
  v_smfmac_f32_16x16x64_bf16 v[88:91], v[60:63], v[16:23], v3
  v_smfmac_f32_16x16x64_bf16 v[92:95], v[60:63], v[52:59], v3
  s_mov_b64 exec, s[26:27]
  s_nop 0
  ds_write_b128 v113, v[84:87]
  s_mov_b64 exec, -1
  s_nop 0
  v_cmp_u_f32 vcc, v88, v89
  s_nop 1
  v_permlane32_swap_b32 v88, v92
  v_permlane32_swap_b32 v89, v93
  v_permlane32_swap_b32 v90, v94
  v_permlane32_swap_b32 v91, v95
  v_add_f32 v88, v88, v92
  v_add_f32 v89, v89, v93
  v_add_f32 v90, v90, v94
  v_add_f32 v91, v91, v95
  ds_write_b128 v112, v[88:91]
  s_cbranch_vccnz cA_sc1_retry
cA_sc1_cont:
  s_waitcnt lgkmcnt(0)
  s_barrier
  ds_read_b64 v[36:37], v114 offset:0
  ds_read_b64 v[38:39], v114 offset:1024
  ds_read2_b32 v[44:45], v115 offset0:0 offset1:64
  s_waitcnt lgkmcnt(0)
  v_add_f32 v44, v44, v45
  v_add_f32 v36, v36, v38
  v_add_f32 v37, v37, v39
  v_add_f32_dpp v44, v44, v44 row_ror:8 row_mask:0xf bank_mask:0xf
  v_mov_b32 v45, v44
  v_permlane32_swap_b32 v36, v37
  v_add_f32 v36, v36, v37
  v_permlane16_swap_b32 v44, v45
  v_add_f32 v44, v44, v45
  v_exp_f32 v48, v36
  v_exp_f32 v49, v44
  v_add_f32 v50, abs(v36), abs(v44)
  v_fma_f32 v39, v49, s37, v48
  v_cmp_ngt_f32 vcc, s56, v50
  v_cndmask_b32 v41, v48, v49, s[38:39]
  v_add_f32_dpp v39, v39, v39 quad_perm:[1,0,3,2] row_mask:0xf bank_mask:0xf
  v_cndmask_b32 v40, v49, v48, s[38:39]
  v_mov_b32_dpp v46, v41 quad_perm:[1,0,3,2] row_mask:0xf bank_mask:0xf
  v_add_f32_dpp v39, v39, v39 quad_perm:[2,3,0,1] row_mask:0xf bank_mask:0xf
  v_cndmask_b32 v42, v46, v40, s[38:39]
  v_cndmask_b32 v43, v40, v46, s[38:39]
  v_add_f32_dpp v39, v39, v39 row_half_mirror row_mask:0xf bank_mask:0xf
  s_cbranch_vccnz cA_sc1_slow
  s_nop 0
  v_add_f32_dpp v39, v39, v39 row_mirror row_mask:0xf bank_mask:0xf
  v_mov_b32 v47, v39
  s_nop 1
  v_permlane16_swap_b32 v39, v47
  v_add_f32 v39, v39, v47
  v_rcp_f32 v39, v39
  s_mov_b64 exec, s[28:29]
  v_mul_f32 v42, v42, v39
  v_mul_f32 v43, v43, v39
  v_cvt_pk_bf16_f32 v42, v42, v43
cA_sc1_pst:
  buffer_store_dword v42, v1, s[8:11], s20 offen
  s_mov_b64 exec, -1
  s_barrier
  s_add_u32 s24, s24, 28672
  s_add_u32 s35, s35, 28672
  s_xor_b32 s25, s25, 28672
  s_add_u32 m0, s25, 7168
  s_nop 0
  buffer_load_dwordx4 v2, s[8:11], s24 offen offset:0 sc1 lds
  buffer_load_dwordx4 v2, s[8:11], s24 offen offset:1024 sc1 lds
  buffer_load_dwordx4 v2, s[8:11], s24 offen offset:2048 sc1 lds
  buffer_load_dwordx4 v2, s[8:11], s24 offen offset:3072 sc1 lds
  s_add_u32 m0, s25, 11264
  s_add_u32 s22, s24, 4096
  buffer_load_dwordx4 v2, s[8:11], s22 offen offset:0 sc1 lds
  buffer_load_dwordx4 v2, s[8:11], s22 offen offset:1024 sc1 lds
  buffer_load_dwordx4 v2, s[8:11], s22 offen offset:2048 sc1 lds
  v_xor_b32 v116, 28672, v116
  v_add_u32 v117, s57, v117
  s_sub_u32 s57, 0, s57
  s_add_u32 s19, s19, 1
  s_mov_b32 s20, s21
  s_cmp_lt_u32 s19, 63
  s_cbranch_scc1 cA_sc1_loop
  s_branch cA_done
cA_sc1_slow:
  v_max_f32 v50, v36, v44
  s_nop 1
  v_max_f32_dpp v50, v50, v50 quad_perm:[1,0,3,2] row_mask:0xf bank_mask:0xf
  s_nop 1
  v_max_f32_dpp v50, v50, v50 quad_perm:[2,3,0,1] row_mask:0xf bank_mask:0xf
  s_nop 1
  v_max_f32_dpp v50, v50, v50 row_half_mirror row_mask:0xf bank_mask:0xf
  s_nop 1
  v_max_f32_dpp v50, v50, v50 row_mirror row_mask:0xf bank_mask:0xf
  v_mov_b32 v47, v50
  s_nop 1
  v_permlane16_swap_b32 v50, v47
  v_max_f32 v50, v50, v47
  v_sub_f32 v48, v36, v50
  v_sub_f32 v49, v44, v50
  v_exp_f32 v48, v48
  v_exp_f32 v49, v49
  s_add_u32 s31, s31, 0x100
  v_fma_f32 v39, v49, s37, v48
  v_cndmask_b32 v41, v48, v49, s[38:39]
  s_nop 0
  v_add_f32_dpp v39, v39, v39 quad_perm:[1,0,3,2] row_mask:0xf bank_mask:0xf
  v_cndmask_b32 v40, v49, v48, s[38:39]
  v_mov_b32_dpp v46, v41 quad_perm:[1,0,3,2] row_mask:0xf bank_mask:0xf
  v_add_f32_dpp v39, v39, v39 quad_perm:[2,3,0,1] row_mask:0xf bank_mask:0xf
  v_cndmask_b32 v42, v46, v40, s[38:39]
  v_cndmask_b32 v43, v40, v46, s[38:39]
  v_add_f32_dpp v39, v39, v39 row_half_mirror row_mask:0xf bank_mask:0xf
  s_nop 1
  v_add_f32_dpp v39, v39, v39 row_mirror row_mask:0xf bank_mask:0xf
  v_mov_b32 v47, v39
  s_nop 1
  v_permlane16_swap_b32 v39, v47
  v_add_f32 v39, v39, v47
  v_rcp_f32 v39, v39
  s_mov_b64 exec, s[28:29]
  v_mul_f32 v42, v42, v39
  v_mul_f32 v43, v43, v39
  v_cvt_pk_bf16_f32 v42, v42, v43
  v_min_u32 v42, -2, v42
  s_branch cA_sc1_pst
cA_sc1_retry:
  s_cmp_lg_u32 s62, 0
  s_cbranch_scc1 cA_sc1_cont
  s_waitcnt vmcnt(0) lgkmcnt(0)
cA_sc1_rv:
  buffer_load_dwordx4 v[8:11], v2, s[8:11], s20 offen offset:0 sc1
  buffer_load_dwordx4 v[12:15], v2, s[8:11], s20 offen offset:1024 sc1
  buffer_load_dwordx4 v[16:19], v2, s[8:11], s20 offen offset:2048 sc1
  buffer_load_dwordx4 v[20:23], v2, s[8:11], s20 offen offset:3072 sc1
  buffer_load_dwordx4 v[24:27], v2, s[8:11], s23 offen offset:0 sc1
  buffer_load_dwordx4 v[28:31], v2, s[8:11], s23 offen offset:1024 sc1
  buffer_load_dwordx4 v[32:35], v2, s[8:11], s23 offen offset:2048 sc1
  s_waitcnt vmcnt(0)
  v_max3_u32 v118, v8, v9, v10
  v_max3_u32 v118, v118, v11, v12
  v_max3_u32 v118, v118, v13, v14
  v_max3_u32 v118, v118, v15, v16
  v_max3_u32 v118, v118, v17, v18
  v_max3_u32 v118, v118, v19, v20
  v_max3_u32 v118, v118, v21, v22
  v_max3_u32 v118, v118, v23, v24
  v_max3_u32 v118, v118, v25, v26
  v_max3_u32 v118, v118, v27, v28
  v_max3_u32 v118, v118, v29, v30
  v_max3_u32 v118, v118, v31, v32
  v_max3_u32 v118, v118, v33, v34
  v_max_u32 v118, v118, v35
  v_cmp_eq_u32 vcc, -1, v118
  s_cbranch_vccz cA_sc1_rk
  s_add_u32 s30, s30, 1
  s_cmp_lt_u32 s30, 400000
  s_cbranch_scc1 cA_sc1_rv
  s_branch cA_abort
cA_sc1_rk:
  s_mov_b32 s62, 1
  v_mov_b32 v36, 0
  v_mov_b32 v37, 0
  v_mov_b32 v38, 0
  v_mov_b32 v39, 0
  v_mov_b32 v40, 0
  v_mov_b32 v41, 0
  v_mov_b32 v42, 0
  v_mov_b32 v43, 0
  v_mov_b32 v44, 0
  v_mov_b32 v45, 0
  v_mov_b32 v46, 0
  v_mov_b32 v47, 0
  v_mov_b32 v48, 0
  v_mov_b32 v49, 0
  v_mov_b32 v50, 0
  v_mov_b32 v51, 0
  v_mov_b32 v52, 0
  v_mov_b32 v53, 0
  v_mov_b32 v54, 0
  v_mov_b32 v55, 0
  v_mov_b32 v56, 0
  v_mov_b32 v57, 0
  v_mov_b32 v58, 0
  v_mov_b32 v59, 0
  v_mov_b32 v60, 0
  v_mov_b32 v61, 0
  v_mov_b32 v62, 0
  v_mov_b32 v63, 0
  v_mov_b32 v88, 0
  v_mov_b32 v89, 0
  v_mov_b32 v90, 0
  v_mov_b32 v91, 0
  v_mov_b32 v92, 0
  v_mov_b32 v93, 0
  v_mov_b32 v94, 0
  v_mov_b32 v95, 0
  v_mov_b32 v64, 0
  v_mov_b32 v65, 0
  s_add_u32 s31, s31, 1
  ds_read_b128 v[96:99], v117 offset:0
  ds_read_b128 v[100:103], v117 offset:1024
  ds_read_b128 v[104:107], v117 offset:14336
  ds_read_b128 v[108:111], v117 offset:15360
  v_smfmac_f32_16x16x64_bf16 v[36:39], v[8:11], a[0:7], v3
  v_smfmac_f32_16x16x64_bf16 v[40:43], v[8:11], a[56:63], v3
  v_smfmac_f32_16x16x64_bf16 v[44:47], v[8:11], a[112:119], v3
  v_smfmac_f32_16x16x64_bf16 v[48:51], v[8:11], a[168:175], v3
  v_smfmac_f32_16x16x64_bf16 v[52:55], v[8:11], a[224:231], v3
  v_smfmac_f32_16x16x64_bf16 v[56:59], v[8:11], v[144:151], v3
  v_smfmac_f32_16x16x64_bf16 v[60:63], v[8:11], v[200:207], v3
  v_smfmac_f32_16x16x64_bf16 v[36:39], v[12:15], a[8:15], v3
  v_smfmac_f32_16x16x64_bf16 v[40:43], v[12:15], a[64:71], v3
  v_smfmac_f32_16x16x64_bf16 v[44:47], v[12:15], a[120:127], v3
  v_smfmac_f32_16x16x64_bf16 v[48:51], v[12:15], a[176:183], v3
  v_smfmac_f32_16x16x64_bf16 v[52:55], v[12:15], a[232:239], v3
  v_smfmac_f32_16x16x64_bf16 v[56:59], v[12:15], v[152:159], v3
  v_smfmac_f32_16x16x64_bf16 v[60:63], v[12:15], v[208:215], v3
  v_smfmac_f32_16x16x64_bf16 v[36:39], v[16:19], a[16:23], v3
  v_smfmac_f32_16x16x64_bf16 v[40:43], v[16:19], a[72:79], v3
  v_smfmac_f32_16x16x64_bf16 v[44:47], v[16:19], a[128:135], v3
  v_smfmac_f32_16x16x64_bf16 v[48:51], v[16:19], a[184:191], v3
  v_smfmac_f32_16x16x64_bf16 v[52:55], v[16:19], a[240:247], v3
  v_smfmac_f32_16x16x64_bf16 v[56:59], v[16:19], v[160:167], v3
  v_smfmac_f32_16x16x64_bf16 v[60:63], v[16:19], v[216:223], v3
  v_smfmac_f32_16x16x64_bf16 v[36:39], v[20:23], a[24:31], v3
  v_smfmac_f32_16x16x64_bf16 v[40:43], v[20:23], a[80:87], v3
  v_smfmac_f32_16x16x64_bf16 v[44:47], v[20:23], a[136:143], v3
  v_smfmac_f32_16x16x64_bf16 v[48:51], v[20:23], a[192:199], v3
  v_smfmac_f32_16x16x64_bf16 v[52:55], v[20:23], a[248:255], v3
  v_smfmac_f32_16x16x64_bf16 v[56:59], v[20:23], v[168:175], v3
  v_smfmac_f32_16x16x64_bf16 v[60:63], v[20:23], v[224:231], v3
  s_branch cA_sc1_ph2
.p2align 6

cA_sc2_loop:
  s_add_u32 s23, s20, 4096
  s_add_u32 s21, s20, 25600
  v_mov_b32 v48, 0
  v_mov_b32 v49, 0
  v_mov_b32 v50, 0
  v_mov_b32 v51, 0
  v_mov_b32 v52, 0
  v_mov_b32 v53, 0
  v_mov_b32 v54, 0
  v_mov_b32 v55, 0
  v_mov_b32 v56, 0
  v_mov_b32 v57, 0
  v_mov_b32 v58, 0
  v_mov_b32 v59, 0
  v_mov_b32 v60, 0
  v_mov_b32 v61, 0
  v_mov_b32 v62, 0
  v_mov_b32 v63, 0
  v_mov_b32 v88, 0
  v_mov_b32 v89, 0
  v_mov_b32 v90, 0
  v_mov_b32 v91, 0
  v_mov_b32 v92, 0
  v_mov_b32 v93, 0
  v_mov_b32 v94, 0
  v_mov_b32 v95, 0
  v_mov_b32 v66, 0
  v_mov_b32 v67, 0
  s_mov_b32 s30, 0
  s_mov_b32 s62, 0
  s_waitcnt vmcnt(0)
  s_barrier
cA_sc2_ld:
  buffer_load_dwordx4 v[8:11], v2, s[8:11], s20 offen offset:0
  v_mov_b32 v36, 0
  v_mov_b32 v37, 0
  v_mov_b32 v38, 0
  v_mov_b32 v39, 0
  buffer_load_dwordx4 v[12:15], v2, s[8:11], s20 offen offset:1024
  v_mov_b32 v40, 0
  v_mov_b32 v41, 0
  v_mov_b32 v42, 0
  v_mov_b32 v43, 0
  buffer_load_dwordx4 v[16:19], v2, s[8:11], s20 offen offset:2048
  v_mov_b32 v44, 0
  v_mov_b32 v45, 0
  v_mov_b32 v46, 0
  v_mov_b32 v47, 0
  ds_read_b128 v[96:99], v117 offset:0
  ds_read_b128 v[100:103], v117 offset:1024
  ds_read_b128 v[104:107], v117 offset:14336
  ds_read_b128 v[108:111], v117 offset:15360
  s_waitcnt vmcnt(2)
  v_smfmac_f32_16x16x64_bf16 v[36:39], v[8:11], a[0:7], v3
  v_smfmac_f32_16x16x64_bf16 v[40:43], v[8:11], a[56:63], v3
  buffer_load_dwordx4 v[20:23], v2, s[8:11], s20 offen offset:3072
  v_smfmac_f32_16x16x64_bf16 v[44:47], v[8:11], a[112:119], v3
  v_smfmac_f32_16x16x64_bf16 v[48:51], v[8:11], a[168:175], v3
  v_smfmac_f32_16x16x64_bf16 v[52:55], v[8:11], a[224:231], v3
  buffer_load_dwordx4 v[24:27], v2, s[8:11], s23 offen offset:0
  v_smfmac_f32_16x16x64_bf16 v[56:59], v[8:11], v[144:151], v3
  v_smfmac_f32_16x16x64_bf16 v[60:63], v[8:11], v[200:207], v3
  s_waitcnt vmcnt(3)
  v_smfmac_f32_16x16x64_bf16 v[36:39], v[12:15], a[8:15], v3
  v_smfmac_f32_16x16x64_bf16 v[40:43], v[12:15], a[64:71], v3
  buffer_load_dwordx4 v[28:31], v2, s[8:11], s23 offen offset:1024
  v_smfmac_f32_16x16x64_bf16 v[44:47], v[12:15], a[120:127], v3
  v_smfmac_f32_16x16x64_bf16 v[48:51], v[12:15], a[176:183], v3
  v_smfmac_f32_16x16x64_bf16 v[52:55], v[12:15], a[232:239], v3
  buffer_load_dwordx4 v[32:35], v2, s[8:11], s23 offen offset:2048
  v_smfmac_f32_16x16x64_bf16 v[56:59], v[12:15], v[152:159], v3
  v_smfmac_f32_16x16x64_bf16 v[60:63], v[12:15], v[208:215], v3
  s_waitcnt vmcnt(4)
  v_smfmac_f32_16x16x64_bf16 v[36:39], v[16:19], a[16:23], v3
  v_smfmac_f32_16x16x64_bf16 v[40:43], v[16:19], a[72:79], v3
  v_smfmac_f32_16x16x64_bf16 v[44:47], v[16:19], a[128:135], v3
  v_smfmac_f32_16x16x64_bf16 v[48:51], v[16:19], a[184:191], v3
  v_smfmac_f32_16x16x64_bf16 v[52:55], v[16:19], a[240:247], v3
  v_smfmac_f32_16x16x64_bf16 v[56:59], v[16:19], v[160:167], v3
  v_smfmac_f32_16x16x64_bf16 v[60:63], v[16:19], v[216:223], v3
  s_waitcnt vmcnt(3)
  v_smfmac_f32_16x16x64_bf16 v[36:39], v[20:23], a[24:31], v3
  v_smfmac_f32_16x16x64_bf16 v[40:43], v[20:23], a[80:87], v3
  v_smfmac_f32_16x16x64_bf16 v[44:47], v[20:23], a[136:143], v3
  v_smfmac_f32_16x16x64_bf16 v[48:51], v[20:23], a[192:199], v3
  v_smfmac_f32_16x16x64_bf16 v[52:55], v[20:23], a[248:255], v3
  v_smfmac_f32_16x16x64_bf16 v[56:59], v[20:23], v[168:175], v3
  v_smfmac_f32_16x16x64_bf16 v[60:63], v[20:23], v[224:231], v3
  s_waitcnt vmcnt(0)
cA_sc2_ph2:
  v_smfmac_f32_16x16x64_bf16 v[60:63], v[24:27], v[232:239], v3
  ds_read_b128 v[8:11], v116 offset:4096
  ds_read_b128 v[12:15], v116 offset:5120
  v_smfmac_f32_16x16x64_bf16 v[60:63], v[28:31], v[240:247], v3
  buffer_load_dword v119, v0, s[8:11], s24 offen sc1
  v_smfmac_f32_16x16x64_bf16 v[60:63], v[32:35], v[248:255], v3
  v_mov_b32 v80, v28
  v_smfmac_f32_16x16x64_bf16 v[52:55], v[24:27], v[120:127], v3
  v_mov_b32 v81, v29
  v_smfmac_f32_16x16x64_bf16 v[52:55], v[28:31], v[128:135], v3
  v_mov_b32 v82, v34
  v_smfmac_f32_16x16x64_bf16 v[52:55], v[32:35], v[136:143], v3
  v_cvt_pk_bf16_f32 v64, v60, v61
  v_smfmac_f32_16x16x64_bf16 v[56:59], v[24:27], v[176:183], v3
  v_cvt_pk_bf16_f32 v65, v62, v63
  v_smfmac_f32_16x16x64_bf16 v[56:59], v[28:31], v[184:191], v3
  v_mov_b32 v83, v35
  v_mfma_f32_16x16x32_bf16 v[68:71], v[64:67], v[4:7], 0
  v_smfmac_f32_16x16x64_bf16 v[56:59], v[32:35], v[192:199], v3
  v_cvt_pk_bf16_f32 v64, v52, v53
  v_smfmac_f32_16x16x64_bf16 v[36:39], v[24:27], a[32:39], v3
  v_cvt_pk_bf16_f32 v65, v54, v55
  v_smfmac_f32_16x16x64_bf16 v[36:39], v[28:31], a[40:47], v3
  v_cvt_pk_bf16_f32 v78, v68, v69
  v_smfmac_f32_16x16x64_bf16 v[36:39], v[32:35], a[48:55], v3
  v_cvt_pk_bf16_f32 v79, v70, v71
  v_cvt_pk_bf16_f32 v66, v56, v57
  v_smfmac_f32_16x16x64_bf16 v[40:43], v[24:27], a[88:95], v3
  v_cvt_pk_bf16_f32 v67, v58, v59
  v_smfmac_f32_16x16x64_bf16 v[40:43], v[28:31], a[96:103], v3
  v_mfma_f32_16x16x32_bf16 v[72:75], v[64:67], v[4:7], 0
  ds_read_b128 v[52:55], v116 offset:18432
  ds_read_b128 v[56:59], v116 offset:19456
  v_smfmac_f32_16x16x64_bf16 v[40:43], v[32:35], a[104:111], v3
  v_cvt_pk_bf16_f32 v64, v36, v37
  v_smfmac_f32_16x16x64_bf16 v[44:47], v[24:27], a[144:151], v3
  v_cvt_pk_bf16_f32 v65, v38, v39
  v_smfmac_f32_16x16x64_bf16 v[44:47], v[28:31], a[152:159], v3
  v_cvt_pk_bf16_f32 v76, v72, v73
  v_smfmac_f32_16x16x64_bf16 v[44:47], v[32:35], a[160:167], v3
  v_cvt_pk_bf16_f32 v77, v74, v75
  v_cvt_pk_bf16_f32 v66, v40, v41
  v_smfmac_f32_16x16x64_bf16 v[48:51], v[24:27], a[200:207], v3
  v_cvt_pk_bf16_f32 v67, v42, v43
  v_smfmac_f32_16x16x64_bf16 v[48:51], v[28:31], a[208:215], v3
  v_mfma_f32_16x16x32_bf16 v[68:71], v[64:67], v[4:7], 0
  v_smfmac_f32_16x16x64_bf16 v[48:51], v[32:35], a[216:223], v3
  v_cvt_pk_bf16_f32 v64, v44, v45
  v_mfma_f32_16x16x32_bf16 v[84:87], v[80:83], v[76:79], 0
  v_cvt_pk_bf16_f32 v65, v46, v47
  s_waitcnt lgkmcnt(0)
  v_smfmac_f32_16x16x64_bf16 v[88:91], v[76:79], v[96:103], v3
  v_cvt_pk_bf16_f32 v60, v68, v69
  v_cvt_pk_bf16_f32 v61, v70, v71
  v_cvt_pk_bf16_f32 v66, v48, v49
  v_cvt_pk_bf16_f32 v67, v50, v51
  s_nop 1
  v_mfma_f32_16x16x32_bf16 v[72:75], v[64:67], v[4:7], 0
  v_smfmac_f32_16x16x64_bf16 v[92:95], v[76:79], v[104:111], v3
  s_nop 4
  v_cvt_pk_bf16_f32 v62, v72, v73
  v_cvt_pk_bf16_f32 v63, v74, v75
  s_nop 1
  v_mfma_f32_16x16x32_bf16 v[84:87], v[16:19], v[60:63], v[84:87]
  v_smfmac_f32_16x16x64_bf16 v[88:91], v[60:63], v[8:15], v3
  v_smfmac_f32_16x16x64_bf16 v[92:95], v[60:63], v[52:59], v3
  s_mov_b64 exec, s[26:27]
  s_nop 0
  ds_write_b128 v113, v[84:87]
  s_mov_b64 exec, -1
  s_nop 0
  v_cmp_u_f32 vcc, v88, v89
  s_nop 1
  v_permlane32_swap_b32 v88, v92
  v_permlane32_swap_b32 v89, v93
  v_permlane32_swap_b32 v90, v94
  v_permlane32_swap_b32 v91, v95
  v_add_f32 v88, v88, v92
  v_add_f32 v89, v89, v93
  v_add_f32 v90, v90, v94
  v_add_f32 v91, v91, v95
  ds_write_b128 v112, v[88:91]
  s_cbranch_vccnz cA_sc2_retry
cA_sc2_cont:
  s_waitcnt lgkmcnt(0)
  s_barrier
  ds_read_b64 v[36:37], v114 offset:0
  ds_read_b64 v[38:39], v114 offset:1024
  ds_read2_b32 v[44:45], v115 offset0:0 offset1:64
  v_lshl_add_u32 v56, v2, 3, s36
  s_waitcnt lgkmcnt(0)
  v_add_f32 v44, v44, v45
  v_add_f32 v36, v36, v38
  v_add_f32 v37, v37, v39
  v_add_f32_dpp v44, v44, v44 row_ror:8 row_mask:0xf bank_mask:0xf
  v_mov_b32 v45, v44
  s_mov_b64 exec, 65535
  buffer_store_dword v2, v56, s[8:11], s20 offen
  s_mov_b64 exec, -1
  v_permlane32_swap_b32 v36, v37
  v_add_f32 v36, v36, v37
  v_permlane16_swap_b32 v44, v45
  v_add_f32 v44, v44, v45
  v_exp_f32 v48, v36
  v_exp_f32 v49, v44
  v_add_f32 v50, abs(v36), abs(v44)
  v_fma_f32 v39, v49, s37, v48
  v_cmp_ngt_f32 vcc, s56, v50
  v_cndmask_b32 v41, v48, v49, s[38:39]
  v_add_f32_dpp v39, v39, v39 quad_perm:[1,0,3,2] row_mask:0xf bank_mask:0xf
  v_cndmask_b32 v40, v49, v48, s[38:39]
  v_mov_b32_dpp v46, v41 quad_perm:[1,0,3,2] row_mask:0xf bank_mask:0xf
  v_add_f32_dpp v39, v39, v39 quad_perm:[2,3,0,1] row_mask:0xf bank_mask:0xf
  v_cndmask_b32 v42, v46, v40, s[38:39]
  v_cndmask_b32 v43, v40, v46, s[38:39]
  v_add_f32_dpp v39, v39, v39 row_half_mirror row_mask:0xf bank_mask:0xf
  s_cbranch_vccnz cA_sc2_slow
  s_nop 0
  v_add_f32_dpp v39, v39, v39 row_mirror row_mask:0xf bank_mask:0xf
  v_mov_b32 v47, v39
  s_nop 1
  v_permlane16_swap_b32 v39, v47
  v_add_f32 v39, v39, v47
  v_rcp_f32 v39, v39
  s_mov_b64 exec, s[28:29]
  v_mul_f32 v42, v42, v39
  v_mul_f32 v43, v43, v39
  v_cvt_pk_bf16_f32 v42, v42, v43
cA_sc2_pst:
  buffer_store_dword v42, v1, s[8:11], s20 offen
  s_mov_b64 exec, -1
  s_barrier
  s_add_u32 s24, s24, 28672
  s_add_u32 s35, s35, 28672
  s_xor_b32 s25, s25, 28672
  s_add_u32 m0, s25, 14336
  s_nop 0
  buffer_load_dwordx4 v2, s[8:11], s24 offen offset:0 sc1 lds
  buffer_load_dwordx4 v2, s[8:11], s24 offen offset:1024 sc1 lds
  buffer_load_dwordx4 v2, s[8:11], s24 offen offset:2048 sc1 lds
  buffer_load_dwordx4 v2, s[8:11], s24 offen offset:3072 sc1 lds
  s_add_u32 m0, s25, 18432
  s_add_u32 s22, s24, 4096
  buffer_load_dwordx4 v2, s[8:11], s22 offen offset:0 sc1 lds
  buffer_load_dwordx4 v2, s[8:11], s22 offen offset:1024 sc1 lds
  buffer_load_dwordx4 v2, s[8:11], s22 offen offset:2048 sc1 lds
  v_xor_b32 v116, 28672, v116
  v_add_u32 v117, s57, v117
  s_sub_u32 s57, 0, s57
  s_add_u32 s19, s19, 1
  s_mov_b32 s20, s21
  s_cmp_lt_u32 s19, 63
  s_cbranch_scc1 cA_sc2_loop
  s_branch cA_done
cA_sc2_slow:
  v_max_f32 v50, v36, v44
  s_nop 1
  v_max_f32_dpp v50, v50, v50 quad_perm:[1,0,3,2] row_mask:0xf bank_mask:0xf
  s_nop 1
  v_max_f32_dpp v50, v50, v50 quad_perm:[2,3,0,1] row_mask:0xf bank_mask:0xf
  s_nop 1
  v_max_f32_dpp v50, v50, v50 row_half_mirror row_mask:0xf bank_mask:0xf
  s_nop 1
  v_max_f32_dpp v50, v50, v50 row_mirror row_mask:0xf bank_mask:0xf
  v_mov_b32 v47, v50
  s_nop 1
  v_permlane16_swap_b32 v50, v47
  v_max_f32 v50, v50, v47
  v_sub_f32 v48, v36, v50
  v_sub_f32 v49, v44, v50
  v_exp_f32 v48, v48
  v_exp_f32 v49, v49
  s_add_u32 s31, s31, 0x100
  v_fma_f32 v39, v49, s37, v48
  v_cndmask_b32 v41, v48, v49, s[38:39]
  s_nop 0
  v_add_f32_dpp v39, v39, v39 quad_perm:[1,0,3,2] row_mask:0xf bank_mask:0xf
  v_cndmask_b32 v40, v49, v48, s[38:39]
  v_mov_b32_dpp v46, v41 quad_perm:[1,0,3,2] row_mask:0xf bank_mask:0xf
  v_add_f32_dpp v39, v39, v39 quad_perm:[2,3,0,1] row_mask:0xf bank_mask:0xf
  v_cndmask_b32 v42, v46, v40, s[38:39]
  v_cndmask_b32 v43, v40, v46, s[38:39]
  v_add_f32_dpp v39, v39, v39 row_half_mirror row_mask:0xf bank_mask:0xf
  s_nop 1
  v_add_f32_dpp v39, v39, v39 row_mirror row_mask:0xf bank_mask:0xf
  v_mov_b32 v47, v39
  s_nop 1
  v_permlane16_swap_b32 v39, v47
  v_add_f32 v39, v39, v47
  v_rcp_f32 v39, v39
  s_mov_b64 exec, s[28:29]
  v_mul_f32 v42, v42, v39
  v_mul_f32 v43, v43, v39
  v_cvt_pk_bf16_f32 v42, v42, v43
  v_min_u32 v42, -2, v42
  s_branch cA_sc2_pst
cA_sc2_retry:
  s_cmp_lg_u32 s62, 0
  s_cbranch_scc1 cA_sc2_cont
  s_waitcnt vmcnt(0) lgkmcnt(0)
cA_sc2_rv:
  buffer_load_dwordx4 v[8:11], v2, s[8:11], s20 offen offset:0 sc1
  buffer_load_dwordx4 v[12:15], v2, s[8:11], s20 offen offset:1024 sc1
  buffer_load_dwordx4 v[16:19], v2, s[8:11], s20 offen offset:2048 sc1
  buffer_load_dwordx4 v[20:23], v2, s[8:11], s20 offen offset:3072 sc1
  buffer_load_dwordx4 v[24:27], v2, s[8:11], s23 offen offset:0 sc1
  buffer_load_dwordx4 v[28:31], v2, s[8:11], s23 offen offset:1024 sc1
  buffer_load_dwordx4 v[32:35], v2, s[8:11], s23 offen offset:2048 sc1
  s_waitcnt vmcnt(0)
  v_max3_u32 v118, v8, v9, v10
  v_max3_u32 v118, v118, v11, v12
  v_max3_u32 v118, v118, v13, v14
  v_max3_u32 v118, v118, v15, v16
  v_max3_u32 v118, v118, v17, v18
  v_max3_u32 v118, v118, v19, v20
  v_max3_u32 v118, v118, v21, v22
  v_max3_u32 v118, v118, v23, v24
  v_max3_u32 v118, v118, v25, v26
  v_max3_u32 v118, v118, v27, v28
  v_max3_u32 v118, v118, v29, v30
  v_max3_u32 v118, v118, v31, v32
  v_max3_u32 v118, v118, v33, v34
  v_max_u32 v118, v118, v35
  v_cmp_eq_u32 vcc, -1, v118
  s_cbranch_vccz cA_sc2_rk
  s_add_u32 s30, s30, 1
  s_cmp_lt_u32 s30, 400000
  s_cbranch_scc1 cA_sc2_rv
  s_branch cA_abort
cA_sc2_rk:
  s_mov_b32 s62, 1
  v_mov_b32 v36, 0
  v_mov_b32 v37, 0
  v_mov_b32 v38, 0
  v_mov_b32 v39, 0
  v_mov_b32 v40, 0
  v_mov_b32 v41, 0
  v_mov_b32 v42, 0
  v_mov_b32 v43, 0
  v_mov_b32 v44, 0
  v_mov_b32 v45, 0
  v_mov_b32 v46, 0
  v_mov_b32 v47, 0
  v_mov_b32 v48, 0
  v_mov_b32 v49, 0
  v_mov_b32 v50, 0
  v_mov_b32 v51, 0
  v_mov_b32 v52, 0
  v_mov_b32 v53, 0
  v_mov_b32 v54, 0
  v_mov_b32 v55, 0
  v_mov_b32 v56, 0
  v_mov_b32 v57, 0
  v_mov_b32 v58, 0
  v_mov_b32 v59, 0
  v_mov_b32 v60, 0
  v_mov_b32 v61, 0
  v_mov_b32 v62, 0
  v_mov_b32 v63, 0
  v_mov_b32 v88, 0
  v_mov_b32 v89, 0
  v_mov_b32 v90, 0
  v_mov_b32 v91, 0
  v_mov_b32 v92, 0
  v_mov_b32 v93, 0
  v_mov_b32 v94, 0
  v_mov_b32 v95, 0
  v_mov_b32 v66, 0
  v_mov_b32 v67, 0
  s_add_u32 s31, s31, 1
  ds_read_b128 v[96:99], v117 offset:0
  ds_read_b128 v[100:103], v117 offset:1024
  ds_read_b128 v[104:107], v117 offset:14336
  ds_read_b128 v[108:111], v117 offset:15360
  v_smfmac_f32_16x16x64_bf16 v[36:39], v[8:11], a[0:7], v3
  v_smfmac_f32_16x16x64_bf16 v[40:43], v[8:11], a[56:63], v3
  v_smfmac_f32_16x16x64_bf16 v[44:47], v[8:11], a[112:119], v3
  v_smfmac_f32_16x16x64_bf16 v[48:51], v[8:11], a[168:175], v3
  v_smfmac_f32_16x16x64_bf16 v[52:55], v[8:11], a[224:231], v3
  v_smfmac_f32_16x16x64_bf16 v[56:59], v[8:11], v[144:151], v3
  v_smfmac_f32_16x16x64_bf16 v[60:63], v[8:11], v[200:207], v3
  v_smfmac_f32_16x16x64_bf16 v[36:39], v[12:15], a[8:15], v3
  v_smfmac_f32_16x16x64_bf16 v[40:43], v[12:15], a[64:71], v3
  v_smfmac_f32_16x16x64_bf16 v[44:47], v[12:15], a[120:127], v3
  v_smfmac_f32_16x16x64_bf16 v[48:51], v[12:15], a[176:183], v3
  v_smfmac_f32_16x16x64_bf16 v[52:55], v[12:15], a[232:239], v3
  v_smfmac_f32_16x16x64_bf16 v[56:59], v[12:15], v[152:159], v3
  v_smfmac_f32_16x16x64_bf16 v[60:63], v[12:15], v[208:215], v3
  v_smfmac_f32_16x16x64_bf16 v[36:39], v[16:19], a[16:23], v3
  v_smfmac_f32_16x16x64_bf16 v[40:43], v[16:19], a[72:79], v3
  v_smfmac_f32_16x16x64_bf16 v[44:47], v[16:19], a[128:135], v3
  v_smfmac_f32_16x16x64_bf16 v[48:51], v[16:19], a[184:191], v3
  v_smfmac_f32_16x16x64_bf16 v[52:55], v[16:19], a[240:247], v3
  v_smfmac_f32_16x16x64_bf16 v[56:59], v[16:19], v[160:167], v3
  v_smfmac_f32_16x16x64_bf16 v[60:63], v[16:19], v[216:223], v3
  v_smfmac_f32_16x16x64_bf16 v[36:39], v[20:23], a[24:31], v3
  v_smfmac_f32_16x16x64_bf16 v[40:43], v[20:23], a[80:87], v3
  v_smfmac_f32_16x16x64_bf16 v[44:47], v[20:23], a[136:143], v3
  v_smfmac_f32_16x16x64_bf16 v[48:51], v[20:23], a[192:199], v3
  v_smfmac_f32_16x16x64_bf16 v[52:55], v[20:23], a[248:255], v3
  v_smfmac_f32_16x16x64_bf16 v[56:59], v[20:23], v[168:175], v3
  v_smfmac_f32_16x16x64_bf16 v[60:63], v[20:23], v[224:231], v3
  s_branch cA_sc2_ph2
.p2align 6

cA_sc3_loop:
  s_add_u32 s23, s20, 4096
  s_add_u32 s21, s20, 25600
  v_mov_b32 v48, 0
  v_mov_b32 v49, 0
  v_mov_b32 v50, 0
  v_mov_b32 v51, 0
  v_mov_b32 v52, 0
  v_mov_b32 v53, 0
  v_mov_b32 v54, 0
  v_mov_b32 v55, 0
  v_mov_b32 v56, 0
  v_mov_b32 v57, 0
  v_mov_b32 v58, 0
  v_mov_b32 v59, 0
  v_mov_b32 v60, 0
  v_mov_b32 v61, 0
  v_mov_b32 v62, 0
  v_mov_b32 v63, 0
  v_mov_b32 v88, 0
  v_mov_b32 v89, 0
  v_mov_b32 v90, 0
  v_mov_b32 v91, 0
  v_mov_b32 v92, 0
  v_mov_b32 v93, 0
  v_mov_b32 v94, 0
  v_mov_b32 v95, 0
  v_mov_b32 v64, 0
  v_mov_b32 v65, 0
  s_mov_b32 s30, 0
  s_mov_b32 s62, 0
  s_waitcnt vmcnt(0)
  s_barrier
cA_sc3_ld:
  buffer_load_dwordx4 v[8:11], v2, s[8:11], s20 offen offset:0
  v_mov_b32 v36, 0
  v_mov_b32 v37, 0
  v_mov_b32 v38, 0
  v_mov_b32 v39, 0
  buffer_load_dwordx4 v[12:15], v2, s[8:11], s20 offen offset:1024
  v_mov_b32 v40, 0
  v_mov_b32 v41, 0
  v_mov_b32 v42, 0
  v_mov_b32 v43, 0
  buffer_load_dwordx4 v[16:19], v2, s[8:11], s20 offen offset:2048
  v_mov_b32 v44, 0
  v_mov_b32 v45, 0
  v_mov_b32 v46, 0
  v_mov_b32 v47, 0
  ds_read_b128 v[96:99], v117 offset:0
  ds_read_b128 v[100:103], v117 offset:1024
  ds_read_b128 v[104:107], v117 offset:14336
  ds_read_b128 v[108:111], v117 offset:15360
  s_waitcnt vmcnt(2)
  v_smfmac_f32_16x16x64_bf16 v[36:39], v[8:11], a[0:7], v3
  v_smfmac_f32_16x16x64_bf16 v[40:43], v[8:11], a[56:63], v3
  buffer_load_dwordx4 v[20:23], v2, s[8:11], s20 offen offset:3072
  v_smfmac_f32_16x16x64_bf16 v[44:47], v[8:11], a[112:119], v3
  v_smfmac_f32_16x16x64_bf16 v[48:51], v[8:11], a[168:175], v3
  v_smfmac_f32_16x16x64_bf16 v[52:55], v[8:11], a[224:231], v3
  buffer_load_dwordx4 v[24:27], v2, s[8:11], s23 offen offset:0
  v_smfmac_f32_16x16x64_bf16 v[56:59], v[8:11], v[144:151], v3
  v_smfmac_f32_16x16x64_bf16 v[60:63], v[8:11], v[200:207], v3
  s_waitcnt vmcnt(3)
  v_smfmac_f32_16x16x64_bf16 v[36:39], v[12:15], a[8:15], v3
  v_smfmac_f32_16x16x64_bf16 v[40:43], v[12:15], a[64:71], v3
  buffer_load_dwordx4 v[28:31], v2, s[8:11], s23 offen offset:1024
  v_smfmac_f32_16x16x64_bf16 v[44:47], v[12:15], a[120:127], v3
  v_smfmac_f32_16x16x64_bf16 v[48:51], v[12:15], a[176:183], v3
  v_smfmac_f32_16x16x64_bf16 v[52:55], v[12:15], a[232:239], v3
  buffer_load_dwordx4 v[32:35], v2, s[8:11], s23 offen offset:2048
  v_smfmac_f32_16x16x64_bf16 v[56:59], v[12:15], v[152:159], v3
  v_smfmac_f32_16x16x64_bf16 v[60:63], v[12:15], v[208:215], v3
  s_waitcnt vmcnt(4)
  v_smfmac_f32_16x16x64_bf16 v[36:39], v[16:19], a[16:23], v3
  v_smfmac_f32_16x16x64_bf16 v[40:43], v[16:19], a[72:79], v3
  v_smfmac_f32_16x16x64_bf16 v[44:47], v[16:19], a[128:135], v3
  v_smfmac_f32_16x16x64_bf16 v[48:51], v[16:19], a[184:191], v3
  v_smfmac_f32_16x16x64_bf16 v[52:55], v[16:19], a[240:247], v3
  v_smfmac_f32_16x16x64_bf16 v[56:59], v[16:19], v[160:167], v3
  v_smfmac_f32_16x16x64_bf16 v[60:63], v[16:19], v[216:223], v3
  s_waitcnt vmcnt(3)
  v_smfmac_f32_16x16x64_bf16 v[36:39], v[20:23], a[24:31], v3
  v_smfmac_f32_16x16x64_bf16 v[40:43], v[20:23], a[80:87], v3
  v_smfmac_f32_16x16x64_bf16 v[44:47], v[20:23], a[136:143], v3
  v_smfmac_f32_16x16x64_bf16 v[48:51], v[20:23], a[192:199], v3
  v_smfmac_f32_16x16x64_bf16 v[52:55], v[20:23], a[248:255], v3
  v_smfmac_f32_16x16x64_bf16 v[56:59], v[20:23], v[168:175], v3
  v_smfmac_f32_16x16x64_bf16 v[60:63], v[20:23], v[224:231], v3
  s_waitcnt vmcnt(0)
cA_sc3_ph2:
  v_smfmac_f32_16x16x64_bf16 v[60:63], v[24:27], v[232:239], v3
  ds_read_b128 v[8:11], v116 offset:6144
  ds_read_b128 v[12:15], v116 offset:7168
  v_smfmac_f32_16x16x64_bf16 v[60:63], v[28:31], v[240:247], v3
  v_smfmac_f32_16x16x64_bf16 v[60:63], v[32:35], v[248:255], v3
  v_mov_b32 v80, v30
  v_smfmac_f32_16x16x64_bf16 v[52:55], v[24:27], v[120:127], v3
  v_mov_b32 v81, v31
  v_smfmac_f32_16x16x64_bf16 v[52:55], v[28:31], v[128:135], v3
  v_mov_b32 v82, v34
  v_smfmac_f32_16x16x64_bf16 v[52:55], v[32:35], v[136:143], v3
  v_cvt_pk_bf16_f32 v66, v60, v61
  v_smfmac_f32_16x16x64_bf16 v[56:59], v[24:27], v[176:183], v3
  v_cvt_pk_bf16_f32 v67, v62, v63
  v_smfmac_f32_16x16x64_bf16 v[56:59], v[28:31], v[184:191], v3
  v_mov_b32 v83, v35
  v_mfma_f32_16x16x32_bf16 v[68:71], v[64:67], v[4:7], 0
  v_smfmac_f32_16x16x64_bf16 v[56:59], v[32:35], v[192:199], v3
  v_cvt_pk_bf16_f32 v64, v52, v53
  v_smfmac_f32_16x16x64_bf16 v[36:39], v[24:27], a[32:39], v3
  v_cvt_pk_bf16_f32 v65, v54, v55
  v_smfmac_f32_16x16x64_bf16 v[36:39], v[28:31], a[40:47], v3
  v_cvt_pk_bf16_f32 v78, v68, v69
  v_smfmac_f32_16x16x64_bf16 v[36:39], v[32:35], a[48:55], v3
  v_cvt_pk_bf16_f32 v79, v70, v71
  v_cvt_pk_bf16_f32 v66, v56, v57
  v_smfmac_f32_16x16x64_bf16 v[40:43], v[24:27], a[88:95], v3
  v_cvt_pk_bf16_f32 v67, v58, v59
  v_smfmac_f32_16x16x64_bf16 v[40:43], v[28:31], a[96:103], v3
  v_mfma_f32_16x16x32_bf16 v[72:75], v[64:67], v[4:7], 0
  ds_read_b128 v[52:55], v116 offset:20480
  ds_read_b128 v[56:59], v116 offset:21504
  v_smfmac_f32_16x16x64_bf16 v[40:43], v[32:35], a[104:111], v3
  v_cvt_pk_bf16_f32 v64, v36, v37
  v_smfmac_f32_16x16x64_bf16 v[44:47], v[24:27], a[144:151], v3
  v_cvt_pk_bf16_f32 v65, v38, v39
  v_smfmac_f32_16x16x64_bf16 v[44:47], v[28:31], a[152:159], v3
  v_cvt_pk_bf16_f32 v76, v72, v73
  v_smfmac_f32_16x16x64_bf16 v[44:47], v[32:35], a[160:167], v3
  v_cvt_pk_bf16_f32 v77, v74, v75
  v_cvt_pk_bf16_f32 v66, v40, v41
  v_smfmac_f32_16x16x64_bf16 v[48:51], v[24:27], a[200:207], v3
  v_cvt_pk_bf16_f32 v67, v42, v43
  v_smfmac_f32_16x16x64_bf16 v[48:51], v[28:31], a[208:215], v3
  v_mfma_f32_16x16x32_bf16 v[68:71], v[64:67], v[4:7], 0
  v_smfmac_f32_16x16x64_bf16 v[48:51], v[32:35], a[216:223], v3
  v_cvt_pk_bf16_f32 v64, v44, v45
  v_mfma_f32_16x16x32_bf16 v[84:87], v[80:83], v[76:79], 0
  v_cvt_pk_bf16_f32 v65, v46, v47
  s_waitcnt lgkmcnt(0)
  v_smfmac_f32_16x16x64_bf16 v[88:91], v[76:79], v[96:103], v3
  v_cvt_pk_bf16_f32 v60, v68, v69
  v_cvt_pk_bf16_f32 v61, v70, v71
  v_cvt_pk_bf16_f32 v66, v48, v49
  v_cvt_pk_bf16_f32 v67, v50, v51
  s_nop 1
  v_mfma_f32_16x16x32_bf16 v[72:75], v[64:67], v[4:7], 0
  v_smfmac_f32_16x16x64_bf16 v[92:95], v[76:79], v[104:111], v3
  s_nop 4
  v_cvt_pk_bf16_f32 v62, v72, v73
  v_cvt_pk_bf16_f32 v63, v74, v75
  s_nop 1
  v_mfma_f32_16x16x32_bf16 v[84:87], v[20:23], v[60:63], v[84:87]
  v_smfmac_f32_16x16x64_bf16 v[88:91], v[60:63], v[8:15], v3
  v_smfmac_f32_16x16x64_bf16 v[92:95], v[60:63], v[52:59], v3
  s_mov_b64 exec, s[26:27]
  s_nop 0
  ds_write_b128 v113, v[84:87]
  s_mov_b64 exec, -1
  s_nop 0
  v_cmp_u_f32 vcc, v88, v89
  s_nop 1
  v_permlane32_swap_b32 v88, v92
  v_permlane32_swap_b32 v89, v93
  v_permlane32_swap_b32 v90, v94
  v_permlane32_swap_b32 v91, v95
  v_add_f32 v88, v88, v92
  v_add_f32 v89, v89, v93
  v_add_f32 v90, v90, v94
  v_add_f32 v91, v91, v95
  ds_write_b128 v112, v[88:91]
  s_cbranch_vccnz cA_sc3_retry
cA_sc3_cont:
  s_waitcnt lgkmcnt(0)
  s_barrier
  ds_read_b64 v[36:37], v114 offset:0
  ds_read_b64 v[38:39], v114 offset:1024
  ds_read2_b32 v[44:45], v115 offset0:0 offset1:64
  s_waitcnt lgkmcnt(0)
  v_add_f32 v44, v44, v45
  v_add_f32 v36, v36, v38
  v_add_f32 v37, v37, v39
  v_add_f32_dpp v44, v44, v44 row_ror:8 row_mask:0xf bank_mask:0xf
  v_mov_b32 v45, v44
  v_permlane32_swap_b32 v36, v37
  v_add_f32 v36, v36, v37
  v_permlane16_swap_b32 v44, v45
  v_add_f32 v44, v44, v45
  v_exp_f32 v48, v36
  v_exp_f32 v49, v44
  v_add_f32 v50, abs(v36), abs(v44)
  v_fma_f32 v39, v49, s37, v48
  v_cmp_ngt_f32 vcc, s56, v50
  v_cndmask_b32 v41, v48, v49, s[38:39]
  v_add_f32_dpp v39, v39, v39 quad_perm:[1,0,3,2] row_mask:0xf bank_mask:0xf
  v_cndmask_b32 v40, v49, v48, s[38:39]
  v_mov_b32_dpp v46, v41 quad_perm:[1,0,3,2] row_mask:0xf bank_mask:0xf
  v_add_f32_dpp v39, v39, v39 quad_perm:[2,3,0,1] row_mask:0xf bank_mask:0xf
  v_cndmask_b32 v42, v46, v40, s[38:39]
  v_cndmask_b32 v43, v40, v46, s[38:39]
  v_add_f32_dpp v39, v39, v39 row_half_mirror row_mask:0xf bank_mask:0xf
  s_cbranch_vccnz cA_sc3_slow
  s_nop 0
  v_add_f32_dpp v39, v39, v39 row_mirror row_mask:0xf bank_mask:0xf
  v_mov_b32 v47, v39
  s_nop 1
  v_permlane16_swap_b32 v39, v47
  v_add_f32 v39, v39, v47
  v_rcp_f32 v39, v39
  s_mov_b64 exec, s[28:29]
  v_mul_f32 v42, v42, v39
  v_mul_f32 v43, v43, v39
  v_cvt_pk_bf16_f32 v42, v42, v43
cA_sc3_pst:
  buffer_store_dword v42, v1, s[8:11], s20 offen
  s_mov_b64 exec, -1
  s_barrier
  s_add_u32 s24, s24, 28672
  s_add_u32 s35, s35, 28672
  s_xor_b32 s25, s25, 28672
  s_add_u32 m0, s25, 21504
  s_nop 0
  buffer_load_dwordx4 v2, s[8:11], s24 offen offset:0 sc1 lds
  buffer_load_dwordx4 v2, s[8:11], s24 offen offset:1024 sc1 lds
  buffer_load_dwordx4 v2, s[8:11], s24 offen offset:2048 sc1 lds
  buffer_load_dwordx4 v2, s[8:11], s24 offen offset:3072 sc1 lds
  s_add_u32 m0, s25, 25600
  s_add_u32 s22, s24, 4096
  buffer_load_dwordx4 v2, s[8:11], s22 offen offset:0 sc1 lds
  buffer_load_dwordx4 v2, s[8:11], s22 offen offset:1024 sc1 lds
  buffer_load_dwordx4 v2, s[8:11], s22 offen offset:2048 sc1 lds
  v_xor_b32 v116, 28672, v116
  v_add_u32 v117, s57, v117
  s_sub_u32 s57, 0, s57
  s_add_u32 s19, s19, 1
  s_mov_b32 s20, s21
  s_cmp_lt_u32 s19, 63
  s_cbranch_scc1 cA_sc3_loop
  s_branch cA_done
cA_sc3_slow:
  v_max_f32 v50, v36, v44
  s_nop 1
  v_max_f32_dpp v50, v50, v50 quad_perm:[1,0,3,2] row_mask:0xf bank_mask:0xf
  s_nop 1
  v_max_f32_dpp v50, v50, v50 quad_perm:[2,3,0,1] row_mask:0xf bank_mask:0xf
  s_nop 1
  v_max_f32_dpp v50, v50, v50 row_half_mirror row_mask:0xf bank_mask:0xf
  s_nop 1
  v_max_f32_dpp v50, v50, v50 row_mirror row_mask:0xf bank_mask:0xf
  v_mov_b32 v47, v50
  s_nop 1
  v_permlane16_swap_b32 v50, v47
  v_max_f32 v50, v50, v47
  v_sub_f32 v48, v36, v50
  v_sub_f32 v49, v44, v50
  v_exp_f32 v48, v48
  v_exp_f32 v49, v49
  s_add_u32 s31, s31, 0x100
  v_fma_f32 v39, v49, s37, v48
  v_cndmask_b32 v41, v48, v49, s[38:39]
  s_nop 0
  v_add_f32_dpp v39, v39, v39 quad_perm:[1,0,3,2] row_mask:0xf bank_mask:0xf
  v_cndmask_b32 v40, v49, v48, s[38:39]
  v_mov_b32_dpp v46, v41 quad_perm:[1,0,3,2] row_mask:0xf bank_mask:0xf
  v_add_f32_dpp v39, v39, v39 quad_perm:[2,3,0,1] row_mask:0xf bank_mask:0xf
  v_cndmask_b32 v42, v46, v40, s[38:39]
  v_cndmask_b32 v43, v40, v46, s[38:39]
  v_add_f32_dpp v39, v39, v39 row_half_mirror row_mask:0xf bank_mask:0xf
  s_nop 1
  v_add_f32_dpp v39, v39, v39 row_mirror row_mask:0xf bank_mask:0xf
  v_mov_b32 v47, v39
  s_nop 1
  v_permlane16_swap_b32 v39, v47
  v_add_f32 v39, v39, v47
  v_rcp_f32 v39, v39
  s_mov_b64 exec, s[28:29]
  v_mul_f32 v42, v42, v39
  v_mul_f32 v43, v43, v39
  v_cvt_pk_bf16_f32 v42, v42, v43
  v_min_u32 v42, -2, v42
  s_branch cA_sc3_pst
cA_sc3_retry:
  s_cmp_lg_u32 s62, 0
  s_cbranch_scc1 cA_sc3_cont
  s_waitcnt vmcnt(0) lgkmcnt(0)
cA_sc3_rv:
  buffer_load_dwordx4 v[8:11], v2, s[8:11], s20 offen offset:0 sc1
  buffer_load_dwordx4 v[12:15], v2, s[8:11], s20 offen offset:1024 sc1
  buffer_load_dwordx4 v[16:19], v2, s[8:11], s20 offen offset:2048 sc1
  buffer_load_dwordx4 v[20:23], v2, s[8:11], s20 offen offset:3072 sc1
  buffer_load_dwordx4 v[24:27], v2, s[8:11], s23 offen offset:0 sc1
  buffer_load_dwordx4 v[28:31], v2, s[8:11], s23 offen offset:1024 sc1
  buffer_load_dwordx4 v[32:35], v2, s[8:11], s23 offen offset:2048 sc1
  s_waitcnt vmcnt(0)
  v_max3_u32 v118, v8, v9, v10
  v_max3_u32 v118, v118, v11, v12
  v_max3_u32 v118, v118, v13, v14
  v_max3_u32 v118, v118, v15, v16
  v_max3_u32 v118, v118, v17, v18
  v_max3_u32 v118, v118, v19, v20
  v_max3_u32 v118, v118, v21, v22
  v_max3_u32 v118, v118, v23, v24
  v_max3_u32 v118, v118, v25, v26
  v_max3_u32 v118, v118, v27, v28
  v_max3_u32 v118, v118, v29, v30
  v_max3_u32 v118, v118, v31, v32
  v_max3_u32 v118, v118, v33, v34
  v_max_u32 v118, v118, v35
  v_cmp_eq_u32 vcc, -1, v118
  s_cbranch_vccz cA_sc3_rk
  s_add_u32 s30, s30, 1
  s_cmp_lt_u32 s30, 400000
  s_cbranch_scc1 cA_sc3_rv
  s_branch cA_abort
cA_sc3_rk:
  s_mov_b32 s62, 1
  v_mov_b32 v36, 0
  v_mov_b32 v37, 0
  v_mov_b32 v38, 0
  v_mov_b32 v39, 0
  v_mov_b32 v40, 0
  v_mov_b32 v41, 0
  v_mov_b32 v42, 0
  v_mov_b32 v43, 0
  v_mov_b32 v44, 0
  v_mov_b32 v45, 0
  v_mov_b32 v46, 0
  v_mov_b32 v47, 0
  v_mov_b32 v48, 0
  v_mov_b32 v49, 0
  v_mov_b32 v50, 0
  v_mov_b32 v51, 0
  v_mov_b32 v52, 0
  v_mov_b32 v53, 0
  v_mov_b32 v54, 0
  v_mov_b32 v55, 0
  v_mov_b32 v56, 0
  v_mov_b32 v57, 0
  v_mov_b32 v58, 0
  v_mov_b32 v59, 0
  v_mov_b32 v60, 0
  v_mov_b32 v61, 0
  v_mov_b32 v62, 0
  v_mov_b32 v63, 0
  v_mov_b32 v88, 0
  v_mov_b32 v89, 0
  v_mov_b32 v90, 0
  v_mov_b32 v91, 0
  v_mov_b32 v92, 0
  v_mov_b32 v93, 0
  v_mov_b32 v94, 0
  v_mov_b32 v95, 0
  v_mov_b32 v64, 0
  v_mov_b32 v65, 0
  s_add_u32 s31, s31, 1
  ds_read_b128 v[96:99], v117 offset:0
  ds_read_b128 v[100:103], v117 offset:1024
  ds_read_b128 v[104:107], v117 offset:14336
  ds_read_b128 v[108:111], v117 offset:15360
  v_smfmac_f32_16x16x64_bf16 v[36:39], v[8:11], a[0:7], v3
  v_smfmac_f32_16x16x64_bf16 v[40:43], v[8:11], a[56:63], v3
  v_smfmac_f32_16x16x64_bf16 v[44:47], v[8:11], a[112:119], v3
  v_smfmac_f32_16x16x64_bf16 v[48:51], v[8:11], a[168:175], v3
  v_smfmac_f32_16x16x64_bf16 v[52:55], v[8:11], a[224:231], v3
  v_smfmac_f32_16x16x64_bf16 v[56:59], v[8:11], v[144:151], v3
  v_smfmac_f32_16x16x64_bf16 v[60:63], v[8:11], v[200:207], v3
  v_smfmac_f32_16x16x64_bf16 v[36:39], v[12:15], a[8:15], v3
  v_smfmac_f32_16x16x64_bf16 v[40:43], v[12:15], a[64:71], v3
  v_smfmac_f32_16x16x64_bf16 v[44:47], v[12:15], a[120:127], v3
  v_smfmac_f32_16x16x64_bf16 v[48:51], v[12:15], a[176:183], v3
  v_smfmac_f32_16x16x64_bf16 v[52:55], v[12:15], a[232:239], v3
  v_smfmac_f32_16x16x64_bf16 v[56:59], v[12:15], v[152:159], v3
  v_smfmac_f32_16x16x64_bf16 v[60:63], v[12:15], v[208:215], v3
  v_smfmac_f32_16x16x64_bf16 v[36:39], v[16:19], a[16:23], v3
  v_smfmac_f32_16x16x64_bf16 v[40:43], v[16:19], a[72:79], v3
  v_smfmac_f32_16x16x64_bf16 v[44:47], v[16:19], a[128:135], v3
  v_smfmac_f32_16x16x64_bf16 v[48:51], v[16:19], a[184:191], v3
  v_smfmac_f32_16x16x64_bf16 v[52:55], v[16:19], a[240:247], v3
  v_smfmac_f32_16x16x64_bf16 v[56:59], v[16:19], v[160:167], v3
  v_smfmac_f32_16x16x64_bf16 v[60:63], v[16:19], v[216:223], v3
  v_smfmac_f32_16x16x64_bf16 v[36:39], v[20:23], a[24:31], v3
  v_smfmac_f32_16x16x64_bf16 v[40:43], v[20:23], a[80:87], v3
  v_smfmac_f32_16x16x64_bf16 v[44:47], v[20:23], a[136:143], v3
  v_smfmac_f32_16x16x64_bf16 v[48:51], v[20:23], a[192:199], v3
  v_smfmac_f32_16x16x64_bf16 v[52:55], v[20:23], a[248:255], v3
  v_smfmac_f32_16x16x64_bf16 v[56:59], v[20:23], v[168:175], v3
  v_smfmac_f32_16x16x64_bf16 v[60:63], v[20:23], v[224:231], v3
  s_branch cA_sc3_ph2
.p2align 6

cA_va0_loop:
  s_add_u32 s23, s20, 4096
  s_add_u32 s21, s20, 25600
  s_mov_b32 s30, 0
  s_cmp_lg_u32 s19, s38
  s_cbranch_scc1 cA_va0_vok
  s_branch cA_va0_voc
cA_va0_vow:
  buffer_load_dword v175, off, s[8:11], s35 sc1
  s_waitcnt vmcnt(0)
cA_va0_voc:
  v_readfirstlane_b32 s22, v175
  s_cmp_eq_u32 s22, 56
  s_cbranch_scc1 cA_va0_vod
  s_sleep 1
  s_add_u32 s30, s30, 1
  s_cmp_lt_u32 s30, 400000
  s_cbranch_scc1 cA_va0_vow
  s_branch cA_abort
cA_va0_vod:
  s_add_u32 s35, s35, 2048
  s_add_u32 s38, s19, 8
  s_and_b32 s38, s38, -8
  s_cmp_eq_u32 s19, 0
  s_cselect_b32 s38, 4, s38
cA_va0_vok:
  s_cmp_eq_u32 s19, 63
  s_cbranch_scc1 cA_done
  s_barrier
  s_add_u32 s22, s25, 0
  buffer_load_dwordx4 v[80:83], v6, s[8:11], s22 offen offset:0 sc1
  buffer_load_dwordx4 v[84:87], v6, s[8:11], s22 offen offset:1792 sc1
  s_add_u32 s22, s25, 3584
  buffer_load_dwordx4 v[88:91], v6, s[8:11], s22 offen offset:0 sc1
  buffer_load_dwordx4 v[92:95], v6, s[8:11], s22 offen offset:1792 sc1
  s_add_u32 s22, s25, 7168
  buffer_load_dwordx4 v[96:99], v6, s[8:11], s22 offen offset:0 sc1
  buffer_load_dwordx4 v[100:103], v6, s[8:11], s22 offen offset:1792 sc1
  s_add_u32 s22, s25, 10752
  buffer_load_dwordx4 v[104:107], v6, s[8:11], s22 offen offset:0 sc1
  buffer_load_dwordx4 v[108:111], v6, s[8:11], s22 offen offset:1792 sc1
  s_add_u32 s22, s25, 14336
  buffer_load_dwordx4 v[112:115], v6, s[8:11], s22 offen offset:0 sc1
  buffer_load_dwordx4 v[116:119], v6, s[8:11], s22 offen offset:1792 sc1
  s_add_u32 s22, s25, 17920
  buffer_load_dwordx4 v[120:123], v6, s[8:11], s22 offen offset:0 sc1
  buffer_load_dwordx4 v[124:127], v6, s[8:11], s22 offen offset:1792 sc1
  s_add_u32 s22, s25, 21504
  buffer_load_dwordx4 v[128:131], v6, s[8:11], s22 offen offset:0 sc1
  buffer_load_dwordx4 v[132:135], v6, s[8:11], s22 offen offset:1792 sc1
  s_add_u32 s22, s25, 25088
  buffer_load_dwordx4 v[136:139], v6, s[8:11], s22 offen offset:0 sc1
  buffer_load_dwordx4 v[140:143], v6, s[8:11], s22 offen offset:1792 sc1
  buffer_load_dword v175, off, s[8:11], s35 sc1
  s_barrier
  ds_read_b128 v[8:11], v2 offset:8192
  ds_read_b128 v[12:15], v2 offset:9216
  ds_read_b128 v[16:19], v2 offset:10240
  ds_read_b128 v[20:23], v2 offset:11264
  ds_read_b128 v[24:27], v2 offset:12288
  ds_read_b128 v[28:31], v2 offset:13312
  ds_read_b128 v[32:35], v2 offset:14336
  s_waitcnt lgkmcnt(0)
  v_smfmac_f32_16x16x64_bf16 v[36:39], v[8:11], a[0:7], v3
  v_smfmac_f32_16x16x64_bf16 v[36:39], v[12:15], a[8:15], v3
  v_smfmac_f32_16x16x64_bf16 v[36:39], v[16:19], a[16:23], v3
  v_smfmac_f32_16x16x64_bf16 v[36:39], v[20:23], a[24:31], v3
  v_smfmac_f32_16x16x64_bf16 v[36:39], v[24:27], a[32:39], v3
  v_smfmac_f32_16x16x64_bf16 v[36:39], v[28:31], a[40:47], v3
  v_smfmac_f32_16x16x64_bf16 v[36:39], v[32:35], a[48:55], v3
  v_smfmac_f32_16x16x64_bf16 v[40:43], v[8:11], a[56:63], v3
  v_smfmac_f32_16x16x64_bf16 v[40:43], v[12:15], a[64:71], v3
  v_smfmac_f32_16x16x64_bf16 v[40:43], v[16:19], a[72:79], v3
  v_smfmac_f32_16x16x64_bf16 v[40:43], v[20:23], a[80:87], v3
  v_smfmac_f32_16x16x64_bf16 v[40:43], v[24:27], a[88:95], v3
  v_smfmac_f32_16x16x64_bf16 v[40:43], v[28:31], a[96:103], v3
  v_smfmac_f32_16x16x64_bf16 v[40:43], v[32:35], a[104:111], v3
  v_smfmac_f32_16x16x64_bf16 v[44:47], v[8:11], a[112:119], v3
  v_smfmac_f32_16x16x64_bf16 v[44:47], v[12:15], a[120:127], v3
  v_smfmac_f32_16x16x64_bf16 v[44:47], v[16:19], a[128:135], v3
  v_smfmac_f32_16x16x64_bf16 v[44:47], v[20:23], a[136:143], v3
  v_permlane32_swap_b32 v36, v40
  v_smfmac_f32_16x16x64_bf16 v[44:47], v[24:27], a[144:151], v3
  v_permlane32_swap_b32 v37, v41
  v_smfmac_f32_16x16x64_bf16 v[44:47], v[28:31], a[152:159], v3
  v_permlane32_swap_b32 v38, v42
  v_smfmac_f32_16x16x64_bf16 v[44:47], v[32:35], a[160:167], v3
  v_permlane32_swap_b32 v39, v43
  v_smfmac_f32_16x16x64_bf16 v[48:51], v[8:11], a[168:175], v3
  v_add_f32 v36, v36, v40
  v_smfmac_f32_16x16x64_bf16 v[48:51], v[12:15], a[176:183], v3
  v_add_f32 v37, v37, v41
  v_smfmac_f32_16x16x64_bf16 v[48:51], v[16:19], a[184:191], v3
  v_add_f32 v38, v38, v42
  v_smfmac_f32_16x16x64_bf16 v[48:51], v[20:23], a[192:199], v3
  v_add_f32 v39, v39, v43
  v_smfmac_f32_16x16x64_bf16 v[48:51], v[24:27], a[200:207], v3
  v_cvt_pk_bf16_f32 v40, v36, v37
  v_smfmac_f32_16x16x64_bf16 v[48:51], v[28:31], a[208:215], v3
  v_cvt_pk_bf16_f32 v41, v38, v39
  v_smfmac_f32_16x16x64_bf16 v[48:51], v[32:35], a[216:223], v3
  ds_write_b64 v60, v[40:41]
  v_smfmac_f32_16x16x64_bf16 v[52:55], v[8:11], a[224:231], v3
  v_smfmac_f32_16x16x64_bf16 v[52:55], v[12:15], a[232:239], v3
  v_smfmac_f32_16x16x64_bf16 v[52:55], v[16:19], a[240:247], v3
  v_smfmac_f32_16x16x64_bf16 v[52:55], v[20:23], a[248:255], v3
  v_permlane32_swap_b32 v44, v48
  v_smfmac_f32_16x16x64_bf16 v[52:55], v[24:27], v[176:183], v3
  v_permlane32_swap_b32 v45, v49
  v_smfmac_f32_16x16x64_bf16 v[52:55], v[28:31], v[184:191], v3
  v_permlane32_swap_b32 v46, v50
  v_smfmac_f32_16x16x64_bf16 v[52:55], v[32:35], v[192:199], v3
  v_permlane32_swap_b32 v47, v51
  v_smfmac_f32_16x16x64_bf16 v[56:59], v[8:11], v[200:207], v3
  v_add_f32 v44, v44, v48
  v_smfmac_f32_16x16x64_bf16 v[56:59], v[12:15], v[208:215], v3
  v_add_f32 v45, v45, v49
  v_smfmac_f32_16x16x64_bf16 v[56:59], v[16:19], v[216:223], v3
  v_add_f32 v46, v46, v50
  v_smfmac_f32_16x16x64_bf16 v[56:59], v[20:23], v[224:231], v3
  v_add_f32 v47, v47, v51
  v_smfmac_f32_16x16x64_bf16 v[56:59], v[24:27], v[232:239], v3
  v_cvt_pk_bf16_f32 v48, v44, v45
  v_smfmac_f32_16x16x64_bf16 v[56:59], v[28:31], v[240:247], v3
  v_cvt_pk_bf16_f32 v49, v46, v47
  v_smfmac_f32_16x16x64_bf16 v[56:59], v[32:35], v[248:255], v3
  ds_write_b64 v61, v[48:49]
  s_nop 6
  v_permlane32_swap_b32 v52, v56
  v_permlane32_swap_b32 v53, v57
  v_permlane32_swap_b32 v54, v58
  v_permlane32_swap_b32 v55, v59
  v_add_f32 v52, v52, v56
  v_add_f32 v53, v53, v57
  v_add_f32 v54, v54, v58
  v_add_f32 v55, v55, v59
  v_cvt_pk_bf16_f32 v56, v52, v53
  v_cvt_pk_bf16_f32 v57, v54, v55
  ds_write_b64 v62, v[56:57]
  s_cmp_eq_u32 s19, 63
  s_cbranch_scc1 cA_va0_last
  s_add_u32 s22, s20, 9216
  s_add_u32 s34, s20, 13312
  s_add_u32 s36, s20, 7168
  s_mov_b32 s37, 0
  v_mov_b32 v156, 0
  v_mov_b32 v157, 0
  v_mov_b32 v158, 0
  v_mov_b32 v159, 0
  buffer_load_dword v164, v4, s[8:11], s20 offen sc1
  s_nop 7
  buffer_load_dword v165, v4, s[8:11], s20 offen sc1
  s_nop 7
  buffer_load_dword v166, v4, s[8:11], s20 offen sc1
  s_nop 7
  buffer_load_dword v167, v4, s[8:11], s20 offen sc1
  s_nop 7
  buffer_load_dword v168, v4, s[8:11], s20 offen sc1
cA_va0_fw_l:
  s_waitcnt vmcnt(4)
  v_cmp_eq_u32 vcc, -1, v164
  s_cbranch_vccz cA_va0_fw_d
  buffer_load_dword v164, v4, s[8:11], s20 offen sc1
  s_waitcnt vmcnt(4)
  v_cmp_eq_u32 vcc, -1, v165
  s_cbranch_vccz cA_va0_fw_d
  buffer_load_dword v165, v4, s[8:11], s20 offen sc1
  s_waitcnt vmcnt(4)
  v_cmp_eq_u32 vcc, -1, v166
  s_cbranch_vccz cA_va0_fw_d
  buffer_load_dword v166, v4, s[8:11], s20 offen sc1
  s_waitcnt vmcnt(4)
  v_cmp_eq_u32 vcc, -1, v167
  s_cbranch_vccz cA_va0_fw_d
  buffer_load_dword v167, v4, s[8:11], s20 offen sc1
  s_waitcnt vmcnt(4)
  v_cmp_eq_u32 vcc, -1, v168
  s_cbranch_vccz cA_va0_fw_d
  buffer_load_dword v168, v4, s[8:11], s20 offen sc1
  s_add_u32 s30, s30, 1
  s_cmp_lt_u32 s30, 400000
  s_cbranch_scc1 cA_va0_fw_l
  s_branch cA_abort
cA_va0_fw_d:
  s_waitcnt lgkmcnt(0)
  buffer_load_dwordx4 v[8:11], v2, s[8:11], s22 offen offset:0
  v_mov_b32 v36, 0
  v_mov_b32 v37, 0
  v_mov_b32 v38, 0
  buffer_load_dwordx4 v[12:15], v2, s[8:11], s22 offen offset:1024
  v_mov_b32 v39, 0
  v_mov_b32 v40, 0
  v_mov_b32 v41, 0
  buffer_load_dwordx4 v[16:19], v2, s[8:11], s22 offen offset:2048
  v_mov_b32 v42, 0
  v_mov_b32 v43, 0
  v_mov_b32 v44, 0
  buffer_load_dwordx4 v[20:23], v2, s[8:11], s22 offen offset:3072
  v_mov_b32 v45, 0
  v_mov_b32 v46, 0
  v_mov_b32 v47, 0
  buffer_load_dwordx4 v[24:27], v2, s[8:11], s34 offen offset:0
  v_mov_b32 v48, 0
  v_mov_b32 v49, 0
  v_mov_b32 v50, 0
  buffer_load_dwordx4 v[28:31], v2, s[8:11], s34 offen offset:1024
  v_mov_b32 v51, 0
  v_mov_b32 v52, 0
  v_mov_b32 v53, 0
  buffer_load_dwordx4 v[32:35], v2, s[8:11], s34 offen offset:2048
  v_mov_b32 v54, 0
  v_mov_b32 v55, 0
  v_mov_b32 v56, 0
  buffer_load_dwordx4 v[144:147], v2, s[8:11], s34 offen offset:3072
  v_mov_b32 v57, 0
  v_mov_b32 v58, 0
  v_mov_b32 v59, 0
  buffer_load_dwordx4 v[148:151], v2, s[8:11], s36 offen offset:0
  buffer_load_dwordx4 v[152:155], v2, s[8:11], s36 offen offset:1024
  s_barrier
  ds_read_b128 v[64:67], v2 offset:0
  ds_read_b128 v[68:71], v2 offset:1024
  ds_read_b128 v[72:75], v2 offset:2048
  ds_read_b128 v[76:79], v2 offset:3072
  s_waitcnt vmcnt(9)
  v_smfmac_f32_16x16x64_bf16 v[156:159], v[8:11], v[80:87], v3
  s_waitcnt vmcnt(8)
  v_smfmac_f32_16x16x64_bf16 v[156:159], v[12:15], v[88:95], v3
  s_waitcnt vmcnt(7)
  v_smfmac_f32_16x16x64_bf16 v[156:159], v[16:19], v[96:103], v3
  s_waitcnt vmcnt(6)
  v_smfmac_f32_16x16x64_bf16 v[156:159], v[20:23], v[104:111], v3
  s_waitcnt vmcnt(5)
  v_smfmac_f32_16x16x64_bf16 v[156:159], v[24:27], v[112:119], v3
  s_mov_b32 exec_hi, 0
  buffer_store_dword v2, v7, s[8:11], s21 offen
  s_mov_b64 exec, -1
  s_waitcnt vmcnt(5)
  v_smfmac_f32_16x16x64_bf16 v[156:159], v[28:31], v[120:127], v3
  s_waitcnt vmcnt(4)
  v_smfmac_f32_16x16x64_bf16 v[156:159], v[32:35], v[128:135], v3
  s_waitcnt vmcnt(3)
  v_smfmac_f32_16x16x64_bf16 v[156:159], v[144:147], v[136:143], v3
  s_waitcnt vmcnt(2) lgkmcnt(0)
  v_smfmac_f32_16x16x64_bf16 v[156:159], v[148:151], v[64:71], v3
  s_waitcnt vmcnt(1)
  v_smfmac_f32_16x16x64_bf16 v[156:159], v[152:155], v[72:79], v3
cA_va0_ep:
  s_nop 7
  v_permlane32_swap_b32 v156, v158
  v_permlane32_swap_b32 v157, v159
  v_add_f32 v160, v156, v158
  v_add_f32 v161, v157, v159
  v_cmp_u_f32 vcc, v160, v161
  v_mov_b32_dpp v162, v160 row_ror:8 row_mask:0xf bank_mask:0xf
  v_mov_b32_dpp v160, v161 row_ror:8 row_mask:0xf bank_mask:0xc
  s_cbranch_vccnz cA_va0_rp
  v_mov_b32_dpp v161, v162 quad_perm:[0,1,2,3] row_mask:0xf bank_mask:0x3
  v_cvt_pk_bf16_f32 v160, v160, v161
cA_va0_pc:
  buffer_store_dword v160, v1, s[8:11], s21 offen
  s_cmp_lg_u32 s19, 62
  s_cbranch_scc1 cA_va0_nl
  s_mov_b32 s22, 88519680
  buffer_store_dword v160, v1, s[8:11], s22 offen sc1
  s_mov_b64 exec, -1
  s_branch cA_done
cA_va0_nl:
  s_mov_b64 exec, -1
  s_add_u32 s25, s25, 28672
  s_add_u32 s19, s19, 1
  s_mov_b32 s20, s21
  s_branch cA_va0_loop
cA_va0_last:
  s_waitcnt lgkmcnt(0)
  s_barrier
  s_branch cA_done
cA_va0_rp:
  s_cmp_eq_u32 s37, 0
  s_cbranch_scc1 cA_va0_rv
  v_mov_b32_dpp v161, v162 quad_perm:[0,1,2,3] row_mask:0xf bank_mask:0x3
  v_cvt_pk_bf16_f32 v160, v160, v161
  v_min_u32 v160, -2, v160
  s_branch cA_va0_pc
cA_va0_rv:
  buffer_load_dwordx4 v[8:11], v2, s[8:11], s22 offen offset:0 sc1
  buffer_load_dwordx4 v[12:15], v2, s[8:11], s22 offen offset:1024 sc1
  buffer_load_dwordx4 v[16:19], v2, s[8:11], s22 offen offset:2048 sc1
  buffer_load_dwordx4 v[20:23], v2, s[8:11], s22 offen offset:3072 sc1
  buffer_load_dwordx4 v[24:27], v2, s[8:11], s34 offen offset:0 sc1
  buffer_load_dwordx4 v[28:31], v2, s[8:11], s34 offen offset:1024 sc1
  buffer_load_dwordx4 v[32:35], v2, s[8:11], s34 offen offset:2048 sc1
  buffer_load_dwordx4 v[144:147], v2, s[8:11], s34 offen offset:3072 sc1
  buffer_load_dwordx4 v[148:151], v2, s[8:11], s36 offen offset:0 sc1
  buffer_load_dwordx4 v[152:155], v2, s[8:11], s36 offen offset:1024 sc1
  s_waitcnt vmcnt(0)
  v_max3_u32 v63, v8, v9, v10
  v_max3_u32 v63, v63, v11, v12
  v_max3_u32 v63, v63, v13, v14
  v_max3_u32 v63, v63, v15, v16
  v_max3_u32 v63, v63, v17, v18
  v_max3_u32 v63, v63, v19, v20
  v_max3_u32 v63, v63, v21, v22
  v_max3_u32 v63, v63, v23, v24
  v_max3_u32 v63, v63, v25, v26
  v_max3_u32 v63, v63, v27, v28
  v_max3_u32 v63, v63, v29, v30
  v_max3_u32 v63, v63, v31, v32
  v_max3_u32 v63, v63, v33, v34
  v_max3_u32 v63, v63, v35, v144
  v_max3_u32 v63, v63, v145, v146
  v_max3_u32 v63, v63, v147, v148
  v_max3_u32 v63, v63, v149, v150
  v_max3_u32 v63, v63, v151, v152
  v_max3_u32 v63, v63, v153, v154
  v_max_u32 v63, v63, v155
  v_cmp_eq_u32 vcc, -1, v63
  s_cbranch_vccz cA_va0_rk
  s_add_u32 s30, s30, 1
  s_cmp_lt_u32 s30, 400000
  s_cbranch_scc1 cA_va0_rv
  s_branch cA_abort
cA_va0_rk:
  s_mov_b32 s37, 1
  s_add_u32 s31, s31, 0x10000
  v_mov_b32 v156, 0
  v_mov_b32 v157, 0
  v_mov_b32 v158, 0
  v_mov_b32 v159, 0
  s_nop 1
  v_smfmac_f32_16x16x64_bf16 v[156:159], v[8:11], v[80:87], v3
  v_smfmac_f32_16x16x64_bf16 v[156:159], v[12:15], v[88:95], v3
  v_smfmac_f32_16x16x64_bf16 v[156:159], v[16:19], v[96:103], v3
  v_smfmac_f32_16x16x64_bf16 v[156:159], v[20:23], v[104:111], v3
  v_smfmac_f32_16x16x64_bf16 v[156:159], v[24:27], v[112:119], v3
  v_smfmac_f32_16x16x64_bf16 v[156:159], v[28:31], v[120:127], v3
  v_smfmac_f32_16x16x64_bf16 v[156:159], v[32:35], v[128:135], v3
  v_smfmac_f32_16x16x64_bf16 v[156:159], v[144:147], v[136:143], v3
  v_smfmac_f32_16x16x64_bf16 v[156:159], v[148:151], v[64:71], v3
  v_smfmac_f32_16x16x64_bf16 v[156:159], v[152:155], v[72:79], v3
  s_nop 7
  s_branch cA_va0_ep
.p2align 6

cA_va1_loop:
  s_add_u32 s23, s20, 4096
  s_add_u32 s21, s20, 25600
  s_mov_b32 s30, 0
  s_cmp_lg_u32 s19, s38
  s_cbranch_scc1 cA_va1_vok
  s_branch cA_va1_voc
cA_va1_vow:
  buffer_load_dword v175, off, s[8:11], s35 sc1
  s_waitcnt vmcnt(0)
cA_va1_voc:
  v_readfirstlane_b32 s22, v175
  s_cmp_eq_u32 s22, 56
  s_cbranch_scc1 cA_va1_vod
  s_sleep 1
  s_add_u32 s30, s30, 1
  s_cmp_lt_u32 s30, 400000
  s_cbranch_scc1 cA_va1_vow
  s_branch cA_abort
cA_va1_vod:
  s_add_u32 s35, s35, 2048
  s_add_u32 s38, s19, 8
  s_and_b32 s38, s38, -8
  s_cmp_eq_u32 s19, 0
  s_cselect_b32 s38, 4, s38
cA_va1_vok:
  s_cmp_eq_u32 s19, 63
  s_cbranch_scc1 cA_done
  s_barrier
  s_add_u32 s22, s25, 0
  buffer_load_dwordx4 v[80:83], v6, s[8:11], s22 offen offset:0 sc1
  buffer_load_dwordx4 v[84:87], v6, s[8:11], s22 offen offset:1792 sc1
  s_add_u32 s22, s25, 3584
  buffer_load_dwordx4 v[88:91], v6, s[8:11], s22 offen offset:0 sc1
  buffer_load_dwordx4 v[92:95], v6, s[8:11], s22 offen offset:1792 sc1
  s_add_u32 s22, s25, 7168
  buffer_load_dwordx4 v[96:99], v6, s[8:11], s22 offen offset:0 sc1
  buffer_load_dwordx4 v[100:103], v6, s[8:11], s22 offen offset:1792 sc1
  s_add_u32 s22, s25, 10752
  buffer_load_dwordx4 v[104:107], v6, s[8:11], s22 offen offset:0 sc1
  buffer_load_dwordx4 v[108:111], v6, s[8:11], s22 offen offset:1792 sc1
  s_add_u32 s22, s25, 14336
  buffer_load_dwordx4 v[112:115], v6, s[8:11], s22 offen offset:0 sc1
  buffer_load_dwordx4 v[116:119], v6, s[8:11], s22 offen offset:1792 sc1
  s_add_u32 s22, s25, 17920
  buffer_load_dwordx4 v[120:123], v6, s[8:11], s22 offen offset:0 sc1
  buffer_load_dwordx4 v[124:127], v6, s[8:11], s22 offen offset:1792 sc1
  s_add_u32 s22, s25, 21504
  buffer_load_dwordx4 v[128:131], v6, s[8:11], s22 offen offset:0 sc1
  buffer_load_dwordx4 v[132:135], v6, s[8:11], s22 offen offset:1792 sc1
  s_add_u32 s22, s25, 25088
  buffer_load_dwordx4 v[136:139], v6, s[8:11], s22 offen offset:0 sc1
  buffer_load_dwordx4 v[140:143], v6, s[8:11], s22 offen offset:1792 sc1
  buffer_load_dword v175, off, s[8:11], s35 sc1
  s_barrier
  ds_read_b128 v[8:11], v2 offset:8192
  ds_read_b128 v[12:15], v2 offset:9216
  ds_read_b128 v[16:19], v2 offset:10240
  ds_read_b128 v[20:23], v2 offset:11264
  ds_read_b128 v[24:27], v2 offset:12288
  ds_read_b128 v[28:31], v2 offset:13312
  ds_read_b128 v[32:35], v2 offset:14336
  s_waitcnt lgkmcnt(0)
  v_smfmac_f32_16x16x64_bf16 v[36:39], v[8:11], a[0:7], v3
  v_smfmac_f32_16x16x64_bf16 v[36:39], v[12:15], a[8:15], v3
  v_smfmac_f32_16x16x64_bf16 v[36:39], v[16:19], a[16:23], v3
  v_smfmac_f32_16x16x64_bf16 v[36:39], v[20:23], a[24:31], v3
  v_smfmac_f32_16x16x64_bf16 v[36:39], v[24:27], a[32:39], v3
  v_smfmac_f32_16x16x64_bf16 v[36:39], v[28:31], a[40:47], v3
  v_smfmac_f32_16x16x64_bf16 v[36:39], v[32:35], a[48:55], v3
  v_smfmac_f32_16x16x64_bf16 v[40:43], v[8:11], a[56:63], v3
  v_smfmac_f32_16x16x64_bf16 v[40:43], v[12:15], a[64:71], v3
  v_smfmac_f32_16x16x64_bf16 v[40:43], v[16:19], a[72:79], v3
  v_smfmac_f32_16x16x64_bf16 v[40:43], v[20:23], a[80:87], v3
  v_smfmac_f32_16x16x64_bf16 v[40:43], v[24:27], a[88:95], v3
  v_smfmac_f32_16x16x64_bf16 v[40:43], v[28:31], a[96:103], v3
  v_smfmac_f32_16x16x64_bf16 v[40:43], v[32:35], a[104:111], v3
  v_smfmac_f32_16x16x64_bf16 v[44:47], v[8:11], a[112:119], v3
  v_smfmac_f32_16x16x64_bf16 v[44:47], v[12:15], a[120:127], v3
  v_smfmac_f32_16x16x64_bf16 v[44:47], v[16:19], a[128:135], v3
  v_smfmac_f32_16x16x64_bf16 v[44:47], v[20:23], a[136:143], v3
  v_permlane32_swap_b32 v36, v40
  v_smfmac_f32_16x16x64_bf16 v[44:47], v[24:27], a[144:151], v3
  v_permlane32_swap_b32 v37, v41
  v_smfmac_f32_16x16x64_bf16 v[44:47], v[28:31], a[152:159], v3
  v_permlane32_swap_b32 v38, v42
  v_smfmac_f32_16x16x64_bf16 v[44:47], v[32:35], a[160:167], v3
  v_permlane32_swap_b32 v39, v43
  v_smfmac_f32_16x16x64_bf16 v[48:51], v[8:11], a[168:175], v3
  v_add_f32 v36, v36, v40
  v_smfmac_f32_16x16x64_bf16 v[48:51], v[12:15], a[176:183], v3
  v_add_f32 v37, v37, v41
  v_smfmac_f32_16x16x64_bf16 v[48:51], v[16:19], a[184:191], v3
  v_add_f32 v38, v38, v42
  v_smfmac_f32_16x16x64_bf16 v[48:51], v[20:23], a[192:199], v3
  v_add_f32 v39, v39, v43
  v_smfmac_f32_16x16x64_bf16 v[48:51], v[24:27], a[200:207], v3
  v_cvt_pk_bf16_f32 v40, v36, v37
  v_smfmac_f32_16x16x64_bf16 v[48:51], v[28:31], a[208:215], v3
  v_cvt_pk_bf16_f32 v41, v38, v39
  v_smfmac_f32_16x16x64_bf16 v[48:51], v[32:35], a[216:223], v3
  ds_write_b64 v60, v[40:41]
  v_smfmac_f32_16x16x64_bf16 v[52:55], v[8:11], a[224:231], v3
  v_smfmac_f32_16x16x64_bf16 v[52:55], v[12:15], a[232:239], v3
  v_smfmac_f32_16x16x64_bf16 v[52:55], v[16:19], a[240:247], v3
  v_smfmac_f32_16x16x64_bf16 v[52:55], v[20:23], a[248:255], v3
  v_permlane32_swap_b32 v44, v48
  v_smfmac_f32_16x16x64_bf16 v[52:55], v[24:27], v[176:183], v3
  v_permlane32_swap_b32 v45, v49
  v_smfmac_f32_16x16x64_bf16 v[52:55], v[28:31], v[184:191], v3
  v_permlane32_swap_b32 v46, v50
  v_smfmac_f32_16x16x64_bf16 v[52:55], v[32:35], v[192:199], v3
  v_permlane32_swap_b32 v47, v51
  v_smfmac_f32_16x16x64_bf16 v[56:59], v[8:11], v[200:207], v3
  v_add_f32 v44, v44, v48
  v_smfmac_f32_16x16x64_bf16 v[56:59], v[12:15], v[208:215], v3
  v_add_f32 v45, v45, v49
  v_smfmac_f32_16x16x64_bf16 v[56:59], v[16:19], v[216:223], v3
  v_add_f32 v46, v46, v50
  v_smfmac_f32_16x16x64_bf16 v[56:59], v[20:23], v[224:231], v3
  v_add_f32 v47, v47, v51
  v_smfmac_f32_16x16x64_bf16 v[56:59], v[24:27], v[232:239], v3
  v_cvt_pk_bf16_f32 v48, v44, v45
  v_smfmac_f32_16x16x64_bf16 v[56:59], v[28:31], v[240:247], v3
  v_cvt_pk_bf16_f32 v49, v46, v47
  v_smfmac_f32_16x16x64_bf16 v[56:59], v[32:35], v[248:255], v3
  ds_write_b64 v61, v[48:49]
  s_nop 6
  v_permlane32_swap_b32 v52, v56
  v_permlane32_swap_b32 v53, v57
  v_permlane32_swap_b32 v54, v58
  v_permlane32_swap_b32 v55, v59
  v_add_f32 v52, v52, v56
  v_add_f32 v53, v53, v57
  v_add_f32 v54, v54, v58
  v_add_f32 v55, v55, v59
  v_cvt_pk_bf16_f32 v56, v52, v53
  v_cvt_pk_bf16_f32 v57, v54, v55
  ds_write_b64 v62, v[56:57]
  s_cmp_eq_u32 s19, 63
  s_cbranch_scc1 cA_va1_last
  s_add_u32 s22, s20, 9216
  s_add_u32 s34, s20, 13312
  s_add_u32 s36, s20, 7168
  s_mov_b32 s37, 0
  v_mov_b32 v156, 0
  v_mov_b32 v157, 0
  v_mov_b32 v158, 0
  v_mov_b32 v159, 0
  buffer_load_dword v164, v4, s[8:11], s20 offen sc1
  s_nop 7
  buffer_load_dword v165, v4, s[8:11], s20 offen sc1
  s_nop 7
  buffer_load_dword v166, v4, s[8:11], s20 offen sc1
  s_nop 7
  buffer_load_dword v167, v4, s[8:11], s20 offen sc1
  s_nop 7
  buffer_load_dword v168, v4, s[8:11], s20 offen sc1
cA_va1_fw_l:
  s_waitcnt vmcnt(4)
  v_cmp_eq_u32 vcc, -1, v164
  s_cbranch_vccz cA_va1_fw_d
  buffer_load_dword v164, v4, s[8:11], s20 offen sc1
  s_waitcnt vmcnt(4)
  v_cmp_eq_u32 vcc, -1, v165
  s_cbranch_vccz cA_va1_fw_d
  buffer_load_dword v165, v4, s[8:11], s20 offen sc1
  s_waitcnt vmcnt(4)
  v_cmp_eq_u32 vcc, -1, v166
  s_cbranch_vccz cA_va1_fw_d
  buffer_load_dword v166, v4, s[8:11], s20 offen sc1
  s_waitcnt vmcnt(4)
  v_cmp_eq_u32 vcc, -1, v167
  s_cbranch_vccz cA_va1_fw_d
  buffer_load_dword v167, v4, s[8:11], s20 offen sc1
  s_waitcnt vmcnt(4)
  v_cmp_eq_u32 vcc, -1, v168
  s_cbranch_vccz cA_va1_fw_d
  buffer_load_dword v168, v4, s[8:11], s20 offen sc1
  s_add_u32 s30, s30, 1
  s_cmp_lt_u32 s30, 400000
  s_cbranch_scc1 cA_va1_fw_l
  s_branch cA_abort
cA_va1_fw_d:
  s_waitcnt lgkmcnt(0)
  buffer_load_dwordx4 v[8:11], v2, s[8:11], s22 offen offset:0
  v_mov_b32 v36, 0
  v_mov_b32 v37, 0
  v_mov_b32 v38, 0
  buffer_load_dwordx4 v[12:15], v2, s[8:11], s22 offen offset:1024
  v_mov_b32 v39, 0
  v_mov_b32 v40, 0
  v_mov_b32 v41, 0
  buffer_load_dwordx4 v[16:19], v2, s[8:11], s22 offen offset:2048
  v_mov_b32 v42, 0
  v_mov_b32 v43, 0
  v_mov_b32 v44, 0
  buffer_load_dwordx4 v[20:23], v2, s[8:11], s22 offen offset:3072
  v_mov_b32 v45, 0
  v_mov_b32 v46, 0
  v_mov_b32 v47, 0
  buffer_load_dwordx4 v[24:27], v2, s[8:11], s34 offen offset:0
  v_mov_b32 v48, 0
  v_mov_b32 v49, 0
  v_mov_b32 v50, 0
  buffer_load_dwordx4 v[28:31], v2, s[8:11], s34 offen offset:1024
  v_mov_b32 v51, 0
  v_mov_b32 v52, 0
  v_mov_b32 v53, 0
  buffer_load_dwordx4 v[32:35], v2, s[8:11], s34 offen offset:2048
  v_mov_b32 v54, 0
  v_mov_b32 v55, 0
  v_mov_b32 v56, 0
  buffer_load_dwordx4 v[144:147], v2, s[8:11], s34 offen offset:3072
  v_mov_b32 v57, 0
  v_mov_b32 v58, 0
  v_mov_b32 v59, 0
  buffer_load_dwordx4 v[148:151], v2, s[8:11], s36 offen offset:0
  buffer_load_dwordx4 v[152:155], v2, s[8:11], s36 offen offset:1024
  s_barrier
  ds_read_b128 v[64:67], v2 offset:4096
  ds_read_b128 v[68:71], v2 offset:5120
  ds_read_b128 v[72:75], v2 offset:6144
  ds_read_b128 v[76:79], v2 offset:7168
  s_waitcnt vmcnt(9)
  v_smfmac_f32_16x16x64_bf16 v[156:159], v[8:11], v[80:87], v3
  s_waitcnt vmcnt(8)
  v_smfmac_f32_16x16x64_bf16 v[156:159], v[12:15], v[88:95], v3
  s_waitcnt vmcnt(7)
  v_smfmac_f32_16x16x64_bf16 v[156:159], v[16:19], v[96:103], v3
  s_waitcnt vmcnt(6)
  v_smfmac_f32_16x16x64_bf16 v[156:159], v[20:23], v[104:111], v3
  s_waitcnt vmcnt(5)
  v_smfmac_f32_16x16x64_bf16 v[156:159], v[24:27], v[112:119], v3
  s_mov_b32 exec_hi, 0
  buffer_store_dword v2, v7, s[8:11], s21 offen
  s_mov_b64 exec, -1
  s_waitcnt vmcnt(5)
  v_smfmac_f32_16x16x64_bf16 v[156:159], v[28:31], v[120:127], v3
  s_waitcnt vmcnt(4)
  v_smfmac_f32_16x16x64_bf16 v[156:159], v[32:35], v[128:135], v3
  s_waitcnt vmcnt(3)
  v_smfmac_f32_16x16x64_bf16 v[156:159], v[144:147], v[136:143], v3
  s_waitcnt vmcnt(2) lgkmcnt(0)
  v_smfmac_f32_16x16x64_bf16 v[156:159], v[148:151], v[64:71], v3
  s_waitcnt vmcnt(1)
  v_smfmac_f32_16x16x64_bf16 v[156:159], v[152:155], v[72:79], v3
cA_va1_ep:
  s_nop 7
  v_permlane32_swap_b32 v156, v158
  v_permlane32_swap_b32 v157, v159
  v_add_f32 v160, v156, v158
  v_add_f32 v161, v157, v159
  v_cmp_u_f32 vcc, v160, v161
  v_mov_b32_dpp v162, v160 row_ror:8 row_mask:0xf bank_mask:0xf
  v_mov_b32_dpp v160, v161 row_ror:8 row_mask:0xf bank_mask:0xc
  s_cbranch_vccnz cA_va1_rp
  v_mov_b32_dpp v161, v162 quad_perm:[0,1,2,3] row_mask:0xf bank_mask:0x3
  v_cvt_pk_bf16_f32 v160, v160, v161
cA_va1_pc:
  s_mov_b64 exec, s[26:27]
  buffer_store_dword v160, v1, s[8:11], s21 offen
  s_cmp_lg_u32 s19, 62
  s_cbranch_scc1 cA_va1_nl
  s_mov_b32 s22, 88519680
  buffer_store_dword v160, v1, s[8:11], s22 offen sc1
  s_mov_b64 exec, -1
  s_branch cA_done
cA_va1_nl:
  s_mov_b64 exec, -1
  s_add_u32 s25, s25, 28672
  s_add_u32 s19, s19, 1
  s_mov_b32 s20, s21
  s_branch cA_va1_loop
cA_va1_last:
  s_waitcnt lgkmcnt(0)
  s_barrier
  s_branch cA_done
cA_va1_rp:
  s_cmp_eq_u32 s37, 0
  s_cbranch_scc1 cA_va1_rv
  v_mov_b32_dpp v161, v162 quad_perm:[0,1,2,3] row_mask:0xf bank_mask:0x3
  v_cvt_pk_bf16_f32 v160, v160, v161
  v_min_u32 v160, -2, v160
  s_branch cA_va1_pc
cA_va1_rv:
  buffer_load_dwordx4 v[8:11], v2, s[8:11], s22 offen offset:0 sc1
  buffer_load_dwordx4 v[12:15], v2, s[8:11], s22 offen offset:1024 sc1
  buffer_load_dwordx4 v[16:19], v2, s[8:11], s22 offen offset:2048 sc1
  buffer_load_dwordx4 v[20:23], v2, s[8:11], s22 offen offset:3072 sc1
  buffer_load_dwordx4 v[24:27], v2, s[8:11], s34 offen offset:0 sc1
  buffer_load_dwordx4 v[28:31], v2, s[8:11], s34 offen offset:1024 sc1
  buffer_load_dwordx4 v[32:35], v2, s[8:11], s34 offen offset:2048 sc1
  buffer_load_dwordx4 v[144:147], v2, s[8:11], s34 offen offset:3072 sc1
  buffer_load_dwordx4 v[148:151], v2, s[8:11], s36 offen offset:0 sc1
  buffer_load_dwordx4 v[152:155], v2, s[8:11], s36 offen offset:1024 sc1
  s_waitcnt vmcnt(0)
  v_max3_u32 v63, v8, v9, v10
  v_max3_u32 v63, v63, v11, v12
  v_max3_u32 v63, v63, v13, v14
  v_max3_u32 v63, v63, v15, v16
  v_max3_u32 v63, v63, v17, v18
  v_max3_u32 v63, v63, v19, v20
  v_max3_u32 v63, v63, v21, v22
  v_max3_u32 v63, v63, v23, v24
  v_max3_u32 v63, v63, v25, v26
  v_max3_u32 v63, v63, v27, v28
  v_max3_u32 v63, v63, v29, v30
  v_max3_u32 v63, v63, v31, v32
  v_max3_u32 v63, v63, v33, v34
  v_max3_u32 v63, v63, v35, v144
  v_max3_u32 v63, v63, v145, v146
  v_max3_u32 v63, v63, v147, v148
  v_max3_u32 v63, v63, v149, v150
  v_max3_u32 v63, v63, v151, v152
  v_max3_u32 v63, v63, v153, v154
  v_max_u32 v63, v63, v155
  v_cmp_eq_u32 vcc, -1, v63
  s_cbranch_vccz cA_va1_rk
  s_add_u32 s30, s30, 1
  s_cmp_lt_u32 s30, 400000
  s_cbranch_scc1 cA_va1_rv
  s_branch cA_abort
cA_va1_rk:
  s_mov_b32 s37, 1
  s_add_u32 s31, s31, 0x10000
  v_mov_b32 v156, 0
  v_mov_b32 v157, 0
  v_mov_b32 v158, 0
  v_mov_b32 v159, 0
  s_nop 1
  v_smfmac_f32_16x16x64_bf16 v[156:159], v[8:11], v[80:87], v3
  v_smfmac_f32_16x16x64_bf16 v[156:159], v[12:15], v[88:95], v3
  v_smfmac_f32_16x16x64_bf16 v[156:159], v[16:19], v[96:103], v3
  v_smfmac_f32_16x16x64_bf16 v[156:159], v[20:23], v[104:111], v3
  v_smfmac_f32_16x16x64_bf16 v[156:159], v[24:27], v[112:119], v3
  v_smfmac_f32_16x16x64_bf16 v[156:159], v[28:31], v[120:127], v3
  v_smfmac_f32_16x16x64_bf16 v[156:159], v[32:35], v[128:135], v3
  v_smfmac_f32_16x16x64_bf16 v[156:159], v[144:147], v[136:143], v3
  v_smfmac_f32_16x16x64_bf16 v[156:159], v[148:151], v[64:71], v3
  v_smfmac_f32_16x16x64_bf16 v[156:159], v[152:155], v[72:79], v3
  s_nop 7
  s_branch cA_va1_ep
.p2align 6

cA_va2_loop:
  s_add_u32 s23, s20, 4096
  s_add_u32 s21, s20, 25600
  v_mov_b32 v36, 0
  v_mov_b32 v37, 0
  v_mov_b32 v38, 0
  v_mov_b32 v39, 0
  v_mov_b32 v40, 0
  v_mov_b32 v41, 0
  v_mov_b32 v42, 0
  v_mov_b32 v43, 0
  v_mov_b32 v44, 0
  v_mov_b32 v45, 0
  v_mov_b32 v46, 0
  v_mov_b32 v47, 0
  v_mov_b32 v48, 0
  v_mov_b32 v49, 0
  v_mov_b32 v50, 0
  v_mov_b32 v51, 0
  v_mov_b32 v52, 0
  v_mov_b32 v53, 0
  v_mov_b32 v54, 0
  v_mov_b32 v55, 0
  v_mov_b32 v56, 0
  v_mov_b32 v57, 0
  v_mov_b32 v58, 0
  v_mov_b32 v59, 0
  v_mov_b32 v60, 0
  v_mov_b32 v61, 0
  v_mov_b32 v62, 0
  v_mov_b32 v63, 0
  v_mov_b32 v64, 0
  v_mov_b32 v65, 0
  v_mov_b32 v66, 0
  v_mov_b32 v67, 0
  s_mov_b32 s30, 0
  buffer_load_dword v76, v119, s[8:11], s20 offen sc1
  buffer_load_dword v77, v119, s[8:11], s20 offen sc1
  buffer_load_dword v78, v119, s[8:11], s20 offen sc1
cA_va2_fp_l:
  s_waitcnt vmcnt(2)
  v_cmp_eq_u32 vcc, -1, v76
  s_cbranch_vccz cA_va2_fp_d
  buffer_load_dword v76, v119, s[8:11], s20 offen sc1
  s_waitcnt vmcnt(2)
  v_cmp_eq_u32 vcc, -1, v77
  s_cbranch_vccz cA_va2_fp_d
  buffer_load_dword v77, v119, s[8:11], s20 offen sc1
  s_waitcnt vmcnt(2)
  v_cmp_eq_u32 vcc, -1, v78
  s_cbranch_vccz cA_va2_fp_d
  buffer_load_dword v78, v119, s[8:11], s20 offen sc1
  s_add_u32 s30, s30, 1
  s_cmp_lt_u32 s30, 400000
  s_cbranch_scc1 cA_va2_fp_l
  s_branch cA_abort
cA_va2_fp_d:
  buffer_load_dwordx4 v[8:11], v2, s[8:11], s20 offen offset:0 sc1
  buffer_load_dwordx4 v[12:15], v2, s[8:11], s20 offen offset:1024 sc1
  buffer_load_dwordx4 v[16:19], v2, s[8:11], s20 offen offset:2048 sc1
  buffer_load_dwordx4 v[20:23], v2, s[8:11], s20 offen offset:3072 sc1
  s_barrier
cA_va2_ld:
  s_waitcnt vmcnt(0)
  v_max3_u32 v84, v8, v9, v10
  v_max3_u32 v84, v84, v11, v12
  v_max3_u32 v84, v84, v13, v14
  v_max3_u32 v84, v84, v15, v16
  v_max3_u32 v84, v84, v17, v18
  v_max3_u32 v84, v84, v19, v20
  v_max3_u32 v84, v84, v21, v22
  v_max_u32 v84, v84, v23
  v_cmp_eq_u32 vcc, -1, v84
  ds_write_b128 v2, v[8:11] offset:8192
  ds_write_b128 v2, v[12:15] offset:9216
  ds_write_b128 v2, v[16:19] offset:10240
  ds_write_b128 v2, v[20:23] offset:11264
  s_cbranch_vccnz cA_va2_retry
  s_waitcnt lgkmcnt(0)
  s_barrier
  ds_read_b128 v[24:27], v2 offset:12288
  ds_read_b128 v[28:31], v2 offset:13312
  ds_read_b128 v[32:35], v2 offset:14336
  ds_read_b128 v[92:95], v0
  s_waitcnt lgkmcnt(0)
  s_mov_b64 exec, s[26:27]
  buffer_store_dwordx4 v[92:95], v2, s[8:11], s36 offen sc1
  s_mov_b64 exec, -1
  s_add_u32 s36, s36, 7168
  s_cmp_eq_u32 s19, 63
  s_cbranch_scc1 cA_done
  ds_read_b128 v[76:79], v1 offset:0
  ds_read_b128 v[80:83], v1 offset:1024
  ds_read_b128 v[84:87], v1 offset:2048
  ds_read_b128 v[88:91], v1 offset:3072
  ds_read_b128 v[92:95], v1 offset:4096
  ds_read_b128 v[96:99], v1 offset:5120
  v_smfmac_f32_16x16x64_bf16 v[60:63], v[8:11], v[200:207], v3
  v_smfmac_f32_16x16x64_bf16 v[60:63], v[12:15], v[208:215], v3
  s_waitcnt lgkmcnt(4)
  v_smfmac_f32_16x16x64_bf16 v[64:67], v[8:11], v[76:83], v3
  ds_read_b128 v[76:79], v1 offset:6144
  ds_read_b128 v[80:83], v1 offset:7168
  v_smfmac_f32_16x16x64_bf16 v[60:63], v[16:19], v[216:223], v3
  v_smfmac_f32_16x16x64_bf16 v[60:63], v[20:23], v[224:231], v3
  s_waitcnt lgkmcnt(4)
  v_smfmac_f32_16x16x64_bf16 v[64:67], v[12:15], v[84:91], v3
  ds_read_b128 v[84:87], v1 offset:8192
  ds_read_b128 v[88:91], v1 offset:9216
  v_smfmac_f32_16x16x64_bf16 v[60:63], v[24:27], v[232:239], v3
  v_smfmac_f32_16x16x64_bf16 v[60:63], v[28:31], v[240:247], v3
  s_waitcnt lgkmcnt(4)
  v_smfmac_f32_16x16x64_bf16 v[64:67], v[16:19], v[92:99], v3
  ds_read_b128 v[92:95], v1 offset:10240
  ds_read_b128 v[96:99], v1 offset:11264
  v_smfmac_f32_16x16x64_bf16 v[60:63], v[32:35], v[248:255], v3
  v_smfmac_f32_16x16x64_bf16 v[36:39], v[8:11], a[0:7], v3
  s_waitcnt lgkmcnt(4)
  v_smfmac_f32_16x16x64_bf16 v[64:67], v[20:23], v[76:83], v3
  ds_read_b128 v[76:79], v1 offset:12288
  ds_read_b128 v[80:83], v1 offset:13312
  v_smfmac_f32_16x16x64_bf16 v[36:39], v[12:15], a[8:15], v3
  v_smfmac_f32_16x16x64_bf16 v[36:39], v[16:19], a[16:23], v3
  s_waitcnt lgkmcnt(4)
  v_smfmac_f32_16x16x64_bf16 v[64:67], v[24:27], v[84:91], v3
  v_smfmac_f32_16x16x64_bf16 v[36:39], v[20:23], a[24:31], v3
  v_smfmac_f32_16x16x64_bf16 v[36:39], v[24:27], a[32:39], v3
  s_waitcnt lgkmcnt(2)
  v_smfmac_f32_16x16x64_bf16 v[64:67], v[28:31], v[92:99], v3
  v_smfmac_f32_16x16x64_bf16 v[36:39], v[28:31], a[40:47], v3
  v_smfmac_f32_16x16x64_bf16 v[36:39], v[32:35], a[48:55], v3
  s_waitcnt lgkmcnt(0)
  v_smfmac_f32_16x16x64_bf16 v[64:67], v[32:35], v[76:83], v3
  v_smfmac_f32_16x16x64_bf16 v[40:43], v[8:11], a[56:63], v3
  v_smfmac_f32_16x16x64_bf16 v[40:43], v[12:15], a[64:71], v3
  v_smfmac_f32_16x16x64_bf16 v[40:43], v[16:19], a[72:79], v3
  v_smfmac_f32_16x16x64_bf16 v[40:43], v[20:23], a[80:87], v3
  v_permlane32_swap_b32 v60, v64
  v_smfmac_f32_16x16x64_bf16 v[40:43], v[24:27], a[88:95], v3
  v_permlane32_swap_b32 v61, v65
  v_smfmac_f32_16x16x64_bf16 v[40:43], v[28:31], a[96:103], v3
  v_permlane32_swap_b32 v62, v66
  v_smfmac_f32_16x16x64_bf16 v[40:43], v[32:35], a[104:111], v3
  v_permlane32_swap_b32 v63, v67
  v_smfmac_f32_16x16x64_bf16 v[44:47], v[8:11], a[112:119], v3
  v_smfmac_f32_16x16x64_bf16 v[44:47], v[12:15], a[120:127], v3
  v_smfmac_f32_16x16x64_bf16 v[44:47], v[16:19], a[128:135], v3
  v_smfmac_f32_16x16x64_bf16 v[44:47], v[20:23], a[136:143], v3
  v_add_f32 v60, v60, v64
  v_add_f32 v61, v61, v65
  v_smfmac_f32_16x16x64_bf16 v[44:47], v[24:27], a[144:151], v3
  v_add_f32 v62, v62, v66
  v_add_f32 v63, v63, v67
  v_smfmac_f32_16x16x64_bf16 v[44:47], v[28:31], a[152:159], v3
  v_cvt_pk_bf16_f32 v64, v60, v61
  v_cvt_pk_bf16_f32 v65, v62, v63
  v_smfmac_f32_16x16x64_bf16 v[44:47], v[32:35], a[160:167], v3
  ds_write_b64 v115, v[64:65]
  v_smfmac_f32_16x16x64_bf16 v[48:51], v[8:11], a[168:175], v3
  v_permlane32_swap_b32 v36, v40
  v_smfmac_f32_16x16x64_bf16 v[48:51], v[12:15], a[176:183], v3
  v_permlane32_swap_b32 v37, v41
  v_smfmac_f32_16x16x64_bf16 v[48:51], v[16:19], a[184:191], v3
  v_permlane32_swap_b32 v38, v42
  v_smfmac_f32_16x16x64_bf16 v[48:51], v[20:23], a[192:199], v3
  v_permlane32_swap_b32 v39, v43
  v_smfmac_f32_16x16x64_bf16 v[48:51], v[24:27], a[200:207], v3
  v_add_f32 v36, v36, v40
  v_smfmac_f32_16x16x64_bf16 v[48:51], v[28:31], a[208:215], v3
  v_add_f32 v37, v37, v41
  v_smfmac_f32_16x16x64_bf16 v[48:51], v[32:35], a[216:223], v3
  v_add_f32 v38, v38, v42
  v_smfmac_f32_16x16x64_bf16 v[52:55], v[8:11], a[224:231], v3
  v_smfmac_f32_16x16x64_bf16 v[52:55], v[12:15], a[232:239], v3
  v_smfmac_f32_16x16x64_bf16 v[52:55], v[16:19], a[240:247], v3
  v_smfmac_f32_16x16x64_bf16 v[52:55], v[20:23], a[248:255], v3
  v_add_f32 v39, v39, v43
  v_cvt_pk_bf16_f32 v40, v36, v37
  v_smfmac_f32_16x16x64_bf16 v[52:55], v[24:27], v[120:127], v3
  v_cvt_pk_bf16_f32 v41, v38, v39
  v_smfmac_f32_16x16x64_bf16 v[52:55], v[28:31], v[128:135], v3
  ds_write_b64 v112, v[40:41]
  v_smfmac_f32_16x16x64_bf16 v[52:55], v[32:35], v[136:143], v3
  v_permlane32_swap_b32 v44, v48
  v_smfmac_f32_16x16x64_bf16 v[56:59], v[8:11], v[144:151], v3
  v_permlane32_swap_b32 v45, v49
  v_smfmac_f32_16x16x64_bf16 v[56:59], v[12:15], v[152:159], v3
  v_permlane32_swap_b32 v46, v50
  v_smfmac_f32_16x16x64_bf16 v[56:59], v[16:19], v[160:167], v3
  v_permlane32_swap_b32 v47, v51
  v_smfmac_f32_16x16x64_bf16 v[56:59], v[20:23], v[168:175], v3
  v_add_f32 v44, v44, v48
  v_smfmac_f32_16x16x64_bf16 v[56:59], v[24:27], v[176:183], v3
  v_add_f32 v45, v45, v49
  v_smfmac_f32_16x16x64_bf16 v[56:59], v[28:31], v[184:191], v3
  v_add_f32 v46, v46, v50
  v_smfmac_f32_16x16x64_bf16 v[56:59], v[32:35], v[192:199], v3
  v_add_f32 v47, v47, v51
  v_cvt_pk_bf16_f32 v48, v44, v45
  v_cvt_pk_bf16_f32 v49, v46, v47
  ds_write_b64 v113, v[48:49]
  s_nop 3
  v_permlane32_swap_b32 v52, v56
  v_permlane32_swap_b32 v53, v57
  v_permlane32_swap_b32 v54, v58
  v_permlane32_swap_b32 v55, v59
  v_add_f32 v52, v52, v56
  v_add_f32 v53, v53, v57
  v_add_f32 v54, v54, v58
  v_add_f32 v55, v55, v59
  v_cvt_pk_bf16_f32 v56, v52, v53
  v_cvt_pk_bf16_f32 v57, v54, v55
  ds_write_b64 v114, v[56:57]
  s_waitcnt lgkmcnt(0)
  s_barrier
  s_cmp_eq_u32 s19, 62
  s_cbranch_scc1 cA_done
  s_waitcnt vmcnt(0) lgkmcnt(0)
  s_add_u32 s19, s19, 1
  s_mov_b32 s20, s21
  s_branch cA_va2_loop
cA_va2_retry:
  s_waitcnt lgkmcnt(0)
  buffer_load_dwordx4 v[8:11], v2, s[8:11], s20 offen offset:0 sc1
  buffer_load_dwordx4 v[12:15], v2, s[8:11], s20 offen offset:1024 sc1
  buffer_load_dwordx4 v[16:19], v2, s[8:11], s20 offen offset:2048 sc1
  buffer_load_dwordx4 v[20:23], v2, s[8:11], s20 offen offset:3072 sc1
  s_add_u32 s31, s31, 1
  s_add_u32 s30, s30, 1
  s_cmp_lt_u32 s30, 400000
  s_cbranch_scc1 cA_va2_ld
  s_branch cA_abort
cA_va2_last:
  s_waitcnt lgkmcnt(0)
  buffer_store_dwordx4 v[100:103], v2, s[8:11], s24 offen offset:0 sc1
  buffer_store_dwordx4 v[104:107], v2, s[8:11], s24 offen offset:1024 sc1
  buffer_store_dwordx4 v[108:111], v2, s[8:11], s24 offen offset:2048 sc1
  buffer_store_dwordx4 v[4:7], v2, s[8:11], s24 offen offset:3072 sc1
  s_add_u32 s24, s24, 8192
  s_waitcnt vmcnt(0)
  s_mov_b64 exec, 1
  buffer_store_dword v117, v2, s[8:11], s34 offen sc1
  s_mov_b64 exec, -1
  s_add_u32 s34, s34, 8
  s_mov_b64 exec, 1
  buffer_store_dword v117, v2, s[8:11], s34 offen sc1
  s_mov_b64 exec, -1
  s_add_u32 s34, s34, 8
  s_branch cA_done
.p2align 6

cA_va3_loop:
  s_add_u32 s23, s20, 4096
  s_add_u32 s21, s20, 25600
  v_mov_b32 v36, 0
  v_mov_b32 v37, 0
  v_mov_b32 v38, 0
  v_mov_b32 v39, 0
  v_mov_b32 v40, 0
  v_mov_b32 v41, 0
  v_mov_b32 v42, 0
  v_mov_b32 v43, 0
  v_mov_b32 v44, 0
  v_mov_b32 v45, 0
  v_mov_b32 v46, 0
  v_mov_b32 v47, 0
  v_mov_b32 v48, 0
  v_mov_b32 v49, 0
  v_mov_b32 v50, 0
  v_mov_b32 v51, 0
  v_mov_b32 v52, 0
  v_mov_b32 v53, 0
  v_mov_b32 v54, 0
  v_mov_b32 v55, 0
  v_mov_b32 v56, 0
  v_mov_b32 v57, 0
  v_mov_b32 v58, 0
  v_mov_b32 v59, 0
  v_mov_b32 v60, 0
  v_mov_b32 v61, 0
  v_mov_b32 v62, 0
  v_mov_b32 v63, 0
  v_mov_b32 v64, 0
  v_mov_b32 v65, 0
  v_mov_b32 v66, 0
  v_mov_b32 v67, 0
  s_mov_b32 s30, 0
  buffer_load_dword v76, v119, s[8:11], s20 offen sc1
  buffer_load_dword v77, v119, s[8:11], s20 offen sc1
  buffer_load_dword v78, v119, s[8:11], s20 offen sc1
cA_va3_fp_l:
  s_waitcnt vmcnt(2)
  v_cmp_eq_u32 vcc, -1, v76
  s_cbranch_vccz cA_va3_fp_d
  buffer_load_dword v76, v119, s[8:11], s20 offen sc1
  s_waitcnt vmcnt(2)
  v_cmp_eq_u32 vcc, -1, v77
  s_cbranch_vccz cA_va3_fp_d
  buffer_load_dword v77, v119, s[8:11], s20 offen sc1
  s_waitcnt vmcnt(2)
  v_cmp_eq_u32 vcc, -1, v78
  s_cbranch_vccz cA_va3_fp_d
  buffer_load_dword v78, v119, s[8:11], s20 offen sc1
  s_add_u32 s30, s30, 1
  s_cmp_lt_u32 s30, 400000
  s_cbranch_scc1 cA_va3_fp_l
  s_branch cA_abort
cA_va3_fp_d:
  buffer_load_dwordx4 v[24:27], v2, s[8:11], s23 offen offset:0 sc1
  buffer_load_dwordx4 v[28:31], v2, s[8:11], s23 offen offset:1024 sc1
  buffer_load_dwordx4 v[32:35], v2, s[8:11], s23 offen offset:2048 sc1
  s_barrier
cA_va3_ld:
  s_waitcnt vmcnt(0)
  v_max3_u32 v84, v24, v25, v26
  v_max3_u32 v84, v84, v27, v28
  v_max3_u32 v84, v84, v29, v30
  v_max3_u32 v84, v84, v31, v32
  v_max3_u32 v84, v84, v33, v34
  v_max_u32 v84, v84, v35
  v_cmp_eq_u32 vcc, -1, v84
  ds_write_b128 v2, v[24:27] offset:12288
  ds_write_b128 v2, v[28:31] offset:13312
  ds_write_b128 v2, v[32:35] offset:14336
  s_cbranch_vccnz cA_va3_retry
  s_waitcnt lgkmcnt(0)
  s_barrier
  ds_read_b128 v[8:11], v2 offset:8192
  ds_read_b128 v[12:15], v2 offset:9216
  ds_read_b128 v[16:19], v2 offset:10240
  ds_read_b128 v[20:23], v2 offset:11264
  s_waitcnt lgkmcnt(0)
  s_cmp_eq_u32 s19, 63
  s_cbranch_scc1 cA_done
  ds_read_b128 v[76:79], v1 offset:0
  ds_read_b128 v[80:83], v1 offset:1024
  ds_read_b128 v[84:87], v1 offset:2048
  ds_read_b128 v[88:91], v1 offset:3072
  ds_read_b128 v[92:95], v1 offset:4096
  ds_read_b128 v[96:99], v1 offset:5120
  v_smfmac_f32_16x16x64_bf16 v[60:63], v[8:11], v[200:207], v3
  v_smfmac_f32_16x16x64_bf16 v[60:63], v[12:15], v[208:215], v3
  s_waitcnt lgkmcnt(4)
  v_smfmac_f32_16x16x64_bf16 v[64:67], v[8:11], v[76:83], v3
  ds_read_b128 v[76:79], v1 offset:6144
  ds_read_b128 v[80:83], v1 offset:7168
  v_smfmac_f32_16x16x64_bf16 v[60:63], v[16:19], v[216:223], v3
  v_smfmac_f32_16x16x64_bf16 v[60:63], v[20:23], v[224:231], v3
  s_waitcnt lgkmcnt(4)
  v_smfmac_f32_16x16x64_bf16 v[64:67], v[12:15], v[84:91], v3
  ds_read_b128 v[84:87], v1 offset:8192
  ds_read_b128 v[88:91], v1 offset:9216
  v_smfmac_f32_16x16x64_bf16 v[60:63], v[24:27], v[232:239], v3
  v_smfmac_f32_16x16x64_bf16 v[60:63], v[28:31], v[240:247], v3
  s_waitcnt lgkmcnt(4)
  v_smfmac_f32_16x16x64_bf16 v[64:67], v[16:19], v[92:99], v3
  ds_read_b128 v[92:95], v1 offset:10240
  ds_read_b128 v[96:99], v1 offset:11264
  v_smfmac_f32_16x16x64_bf16 v[60:63], v[32:35], v[248:255], v3
  v_smfmac_f32_16x16x64_bf16 v[36:39], v[8:11], a[0:7], v3
  s_waitcnt lgkmcnt(4)
  v_smfmac_f32_16x16x64_bf16 v[64:67], v[20:23], v[76:83], v3
  ds_read_b128 v[76:79], v1 offset:12288
  ds_read_b128 v[80:83], v1 offset:13312
  v_smfmac_f32_16x16x64_bf16 v[36:39], v[12:15], a[8:15], v3
  v_smfmac_f32_16x16x64_bf16 v[36:39], v[16:19], a[16:23], v3
  s_waitcnt lgkmcnt(4)
  v_smfmac_f32_16x16x64_bf16 v[64:67], v[24:27], v[84:91], v3
  v_smfmac_f32_16x16x64_bf16 v[36:39], v[20:23], a[24:31], v3
  v_smfmac_f32_16x16x64_bf16 v[36:39], v[24:27], a[32:39], v3
  s_waitcnt lgkmcnt(2)
  v_smfmac_f32_16x16x64_bf16 v[64:67], v[28:31], v[92:99], v3
  v_smfmac_f32_16x16x64_bf16 v[36:39], v[28:31], a[40:47], v3
  v_smfmac_f32_16x16x64_bf16 v[36:39], v[32:35], a[48:55], v3
  s_waitcnt lgkmcnt(0)
  v_smfmac_f32_16x16x64_bf16 v[64:67], v[32:35], v[76:83], v3
  v_smfmac_f32_16x16x64_bf16 v[40:43], v[8:11], a[56:63], v3
  v_smfmac_f32_16x16x64_bf16 v[40:43], v[12:15], a[64:71], v3
  v_smfmac_f32_16x16x64_bf16 v[40:43], v[16:19], a[72:79], v3
  v_smfmac_f32_16x16x64_bf16 v[40:43], v[20:23], a[80:87], v3
  v_permlane32_swap_b32 v60, v64
  v_smfmac_f32_16x16x64_bf16 v[40:43], v[24:27], a[88:95], v3
  v_permlane32_swap_b32 v61, v65
  v_smfmac_f32_16x16x64_bf16 v[40:43], v[28:31], a[96:103], v3
  v_permlane32_swap_b32 v62, v66
  v_smfmac_f32_16x16x64_bf16 v[40:43], v[32:35], a[104:111], v3
  v_permlane32_swap_b32 v63, v67
  v_smfmac_f32_16x16x64_bf16 v[44:47], v[8:11], a[112:119], v3
  v_smfmac_f32_16x16x64_bf16 v[44:47], v[12:15], a[120:127], v3
  v_smfmac_f32_16x16x64_bf16 v[44:47], v[16:19], a[128:135], v3
  v_smfmac_f32_16x16x64_bf16 v[44:47], v[20:23], a[136:143], v3
  v_add_f32 v60, v60, v64
  v_add_f32 v61, v61, v65
  v_smfmac_f32_16x16x64_bf16 v[44:47], v[24:27], a[144:151], v3
  v_add_f32 v62, v62, v66
  v_add_f32 v63, v63, v67
  v_smfmac_f32_16x16x64_bf16 v[44:47], v[28:31], a[152:159], v3
  v_cvt_pk_bf16_f32 v64, v60, v61
  v_cvt_pk_bf16_f32 v65, v62, v63
  v_smfmac_f32_16x16x64_bf16 v[44:47], v[32:35], a[160:167], v3
  ds_write_b64 v115, v[64:65]
  v_smfmac_f32_16x16x64_bf16 v[48:51], v[8:11], a[168:175], v3
  v_permlane32_swap_b32 v36, v40
  v_smfmac_f32_16x16x64_bf16 v[48:51], v[12:15], a[176:183], v3
  v_permlane32_swap_b32 v37, v41
  v_smfmac_f32_16x16x64_bf16 v[48:51], v[16:19], a[184:191], v3
  v_permlane32_swap_b32 v38, v42
  v_smfmac_f32_16x16x64_bf16 v[48:51], v[20:23], a[192:199], v3
  v_permlane32_swap_b32 v39, v43
  v_smfmac_f32_16x16x64_bf16 v[48:51], v[24:27], a[200:207], v3
  v_add_f32 v36, v36, v40
  v_smfmac_f32_16x16x64_bf16 v[48:51], v[28:31], a[208:215], v3
  v_add_f32 v37, v37, v41
  v_smfmac_f32_16x16x64_bf16 v[48:51], v[32:35], a[216:223], v3
  v_add_f32 v38, v38, v42
  v_smfmac_f32_16x16x64_bf16 v[52:55], v[8:11], a[224:231], v3
  v_smfmac_f32_16x16x64_bf16 v[52:55], v[12:15], a[232:239], v3
  v_smfmac_f32_16x16x64_bf16 v[52:55], v[16:19], a[240:247], v3
  v_smfmac_f32_16x16x64_bf16 v[52:55], v[20:23], a[248:255], v3
  v_add_f32 v39, v39, v43
  v_cvt_pk_bf16_f32 v40, v36, v37
  v_smfmac_f32_16x16x64_bf16 v[52:55], v[24:27], v[120:127], v3
  v_cvt_pk_bf16_f32 v41, v38, v39
  v_smfmac_f32_16x16x64_bf16 v[52:55], v[28:31], v[128:135], v3
  ds_write_b64 v112, v[40:41]
  v_smfmac_f32_16x16x64_bf16 v[52:55], v[32:35], v[136:143], v3
  v_permlane32_swap_b32 v44, v48
  v_smfmac_f32_16x16x64_bf16 v[56:59], v[8:11], v[144:151], v3
  v_permlane32_swap_b32 v45, v49
  v_smfmac_f32_16x16x64_bf16 v[56:59], v[12:15], v[152:159], v3
  v_permlane32_swap_b32 v46, v50
  v_smfmac_f32_16x16x64_bf16 v[56:59], v[16:19], v[160:167], v3
  v_permlane32_swap_b32 v47, v51
  v_smfmac_f32_16x16x64_bf16 v[56:59], v[20:23], v[168:175], v3
  v_add_f32 v44, v44, v48
  v_smfmac_f32_16x16x64_bf16 v[56:59], v[24:27], v[176:183], v3
  v_add_f32 v45, v45, v49
  v_smfmac_f32_16x16x64_bf16 v[56:59], v[28:31], v[184:191], v3
  v_add_f32 v46, v46, v50
  v_smfmac_f32_16x16x64_bf16 v[56:59], v[32:35], v[192:199], v3
  v_add_f32 v47, v47, v51
  v_cvt_pk_bf16_f32 v48, v44, v45
  v_cvt_pk_bf16_f32 v49, v46, v47
  ds_write_b64 v113, v[48:49]
  s_nop 3
  v_permlane32_swap_b32 v52, v56
  v_permlane32_swap_b32 v53, v57
  v_permlane32_swap_b32 v54, v58
  v_permlane32_swap_b32 v55, v59
  v_add_f32 v52, v52, v56
  v_add_f32 v53, v53, v57
  v_add_f32 v54, v54, v58
  v_add_f32 v55, v55, v59
  v_cvt_pk_bf16_f32 v56, v52, v53
  v_cvt_pk_bf16_f32 v57, v54, v55
  ds_write_b64 v114, v[56:57]
  s_waitcnt lgkmcnt(0)
  s_barrier
  s_cmp_eq_u32 s19, 62
  s_cbranch_scc1 cA_done
  s_waitcnt vmcnt(0) lgkmcnt(0)
  s_add_u32 s19, s19, 1
  s_mov_b32 s20, s21
  s_branch cA_va3_loop
cA_va3_retry:
  s_waitcnt lgkmcnt(0)
  buffer_load_dwordx4 v[24:27], v2, s[8:11], s23 offen offset:0 sc1
  buffer_load_dwordx4 v[28:31], v2, s[8:11], s23 offen offset:1024 sc1
  buffer_load_dwordx4 v[32:35], v2, s[8:11], s23 offen offset:2048 sc1
  s_add_u32 s31, s31, 1
  s_add_u32 s30, s30, 1
  s_cmp_lt_u32 s30, 400000
  s_cbranch_scc1 cA_va3_ld
  s_branch cA_abort
cA_va3_last:
  s_waitcnt lgkmcnt(0)
  buffer_store_dwordx4 v[100:103], v2, s[8:11], s24 offen offset:0 sc1
  buffer_store_dwordx4 v[104:107], v2, s[8:11], s24 offen offset:1024 sc1
  buffer_store_dwordx4 v[108:111], v2, s[8:11], s24 offen offset:2048 sc1
  buffer_store_dwordx4 v[4:7], v2, s[8:11], s24 offen offset:3072 sc1
  s_add_u32 s24, s24, 8192
  s_waitcnt vmcnt(0)
  s_mov_b64 exec, 1
  buffer_store_dword v117, v2, s[8:11], s34 offen sc1
  s_mov_b64 exec, -1
  s_add_u32 s34, s34, 8
  s_mov_b64 exec, 1
  buffer_store_dword v117, v2, s[8:11], s34 offen sc1
  s_mov_b64 exec, -1
  s_add_u32 s34, s34, 8
  s_branch cA_done
cA_abort:
  v_mov_b32 v4, 0xdead
  v_mov_b32 v5, 16
  buffer_store_dword v4, v5, s[12:15], 0 offen
  s_branch ch_end
cA_done:
  s_branch ch_end
.p2align 6

cB_sc0_loop:
  s_add_u32 s23, s20, 4096
  s_add_u32 s21, s20, 25600
  v_mov_b32 v48, 0
  v_mov_b32 v49, 0
  v_mov_b32 v50, 0
  v_mov_b32 v51, 0
  v_mov_b32 v52, 0
  v_mov_b32 v53, 0
  v_mov_b32 v54, 0
  v_mov_b32 v55, 0
  v_mov_b32 v56, 0
  v_mov_b32 v57, 0
  v_mov_b32 v58, 0
  v_mov_b32 v59, 0
  v_mov_b32 v60, 0
  v_mov_b32 v61, 0
  v_mov_b32 v62, 0
  v_mov_b32 v63, 0
  v_mov_b32 v88, 0
  v_mov_b32 v89, 0
  v_mov_b32 v90, 0
  v_mov_b32 v91, 0
  v_mov_b32 v92, 0
  v_mov_b32 v93, 0
  v_mov_b32 v94, 0
  v_mov_b32 v95, 0
  v_mov_b32 v66, 0
  v_mov_b32 v67, 0
  s_mov_b32 s30, 0
  s_mov_b32 s62, 0
  buffer_load_dword v68, v0, s[8:11], s20 offen sc1
  s_nop 7
  buffer_load_dword v69, v0, s[8:11], s20 offen sc1
  s_nop 7
  buffer_load_dword v70, v0, s[8:11], s20 offen sc1
  s_nop 7
  buffer_load_dword v71, v0, s[8:11], s20 offen sc1
  s_nop 7
  buffer_load_dword v72, v0, s[8:11], s20 offen sc1
cB_sc0_fp_l:
  s_waitcnt vmcnt(4)
  v_cmp_eq_u32 vcc, -1, v68
  s_cbranch_vccz cB_sc0_fp_d
  buffer_load_dword v68, v0, s[8:11], s20 offen sc1
  s_waitcnt vmcnt(4)
  v_cmp_eq_u32 vcc, -1, v69
  s_cbranch_vccz cB_sc0_fp_d
  buffer_load_dword v69, v0, s[8:11], s20 offen sc1
  s_waitcnt vmcnt(4)
  v_cmp_eq_u32 vcc, -1, v70
  s_cbranch_vccz cB_sc0_fp_d
  buffer_load_dword v70, v0, s[8:11], s20 offen sc1
  s_waitcnt vmcnt(4)
  v_cmp_eq_u32 vcc, -1, v71
  s_cbranch_vccz cB_sc0_fp_d
  buffer_load_dword v71, v0, s[8:11], s20 offen sc1
  s_waitcnt vmcnt(4)
  v_cmp_eq_u32 vcc, -1, v72
  s_cbranch_vccz cB_sc0_fp_d
  buffer_load_dword v72, v0, s[8:11], s20 offen sc1
  s_add_u32 s30, s30, 1
  s_cmp_lt_u32 s30, 400000
  s_cbranch_scc1 cB_sc0_fp_l
  s_branch cB_abort
cB_sc0_fp_d:
  buffer_load_dwordx4 v[8:11], v2, s[8:11], s20 offen offset:0 sc1
  s_barrier
  s_branch cB_sc0_ld1
cB_sc0_ld:
  buffer_load_dwordx4 v[8:11], v2, s[8:11], s20 offen offset:0 sc1
cB_sc0_ld1:
  v_mov_b32 v36, 0
  v_mov_b32 v37, 0
  v_mov_b32 v38, 0
  v_mov_b32 v39, 0
  buffer_load_dwordx4 v[12:15], v2, s[8:11], s20 offen offset:1024 sc1
  v_mov_b32 v40, 0
  v_mov_b32 v41, 0
  v_mov_b32 v42, 0
  v_mov_b32 v43, 0
  buffer_load_dwordx4 v[16:19], v2, s[8:11], s20 offen offset:2048 sc1
  v_mov_b32 v44, 0
  v_mov_b32 v45, 0
  v_mov_b32 v46, 0
  v_mov_b32 v47, 0
  ds_read_b128 v[96:99], v117 offset:0
  ds_read_b128 v[100:103], v117 offset:1024
  ds_read_b128 v[104:107], v117 offset:14336
  ds_read_b128 v[108:111], v117 offset:15360
  s_waitcnt vmcnt(2)
  v_smfmac_f32_16x16x64_bf16 v[36:39], v[8:11], a[0:7], v3
  v_smfmac_f32_16x16x64_bf16 v[40:43], v[8:11], a[56:63], v3
  buffer_load_dwordx4 v[20:23], v2, s[8:11], s20 offen offset:3072 sc1
  v_smfmac_f32_16x16x64_bf16 v[44:47], v[8:11], a[112:119], v3
  v_smfmac_f32_16x16x64_bf16 v[48:51], v[8:11], a[168:175], v3
  v_smfmac_f32_16x16x64_bf16 v[52:55], v[8:11], a[224:231], v3
  buffer_load_dwordx4 v[24:27], v2, s[8:11], s23 offen offset:0 sc1
  v_smfmac_f32_16x16x64_bf16 v[56:59], v[8:11], v[144:151], v3
  v_smfmac_f32_16x16x64_bf16 v[60:63], v[8:11], v[200:207], v3
  s_waitcnt vmcnt(3)
  v_smfmac_f32_16x16x64_bf16 v[36:39], v[12:15], a[8:15], v3
  v_smfmac_f32_16x16x64_bf16 v[40:43], v[12:15], a[64:71], v3
  buffer_load_dwordx4 v[28:31], v2, s[8:11], s23 offen offset:1024 sc1
  v_smfmac_f32_16x16x64_bf16 v[44:47], v[12:15], a[120:127], v3
  v_smfmac_f32_16x16x64_bf16 v[48:51], v[12:15], a[176:183], v3
  v_smfmac_f32_16x16x64_bf16 v[52:55], v[12:15], a[232:239], v3
  buffer_load_dwordx4 v[32:35], v2, s[8:11], s23 offen offset:2048 sc1
  v_smfmac_f32_16x16x64_bf16 v[56:59], v[12:15], v[152:159], v3
  v_smfmac_f32_16x16x64_bf16 v[60:63], v[12:15], v[208:215], v3
  s_waitcnt vmcnt(4)
  v_smfmac_f32_16x16x64_bf16 v[36:39], v[16:19], a[16:23], v3
  v_smfmac_f32_16x16x64_bf16 v[40:43], v[16:19], a[72:79], v3
  v_smfmac_f32_16x16x64_bf16 v[44:47], v[16:19], a[128:135], v3
  v_smfmac_f32_16x16x64_bf16 v[48:51], v[16:19], a[184:191], v3
  v_smfmac_f32_16x16x64_bf16 v[52:55], v[16:19], a[240:247], v3
  v_smfmac_f32_16x16x64_bf16 v[56:59], v[16:19], v[160:167], v3
  v_smfmac_f32_16x16x64_bf16 v[60:63], v[16:19], v[216:223], v3
  s_waitcnt vmcnt(3)
  v_smfmac_f32_16x16x64_bf16 v[36:39], v[20:23], a[24:31], v3
  v_smfmac_f32_16x16x64_bf16 v[40:43], v[20:23], a[80:87], v3
  v_smfmac_f32_16x16x64_bf16 v[44:47], v[20:23], a[136:143], v3
  v_smfmac_f32_16x16x64_bf16 v[48:51], v[20:23], a[192:199], v3
  v_smfmac_f32_16x16x64_bf16 v[52:55], v[20:23], a[248:255], v3
  v_smfmac_f32_16x16x64_bf16 v[56:59], v[20:23], v[168:175], v3
  v_smfmac_f32_16x16x64_bf16 v[60:63], v[20:23], v[224:231], v3
  s_waitcnt vmcnt(0)
cB_sc0_ph2:
  v_smfmac_f32_16x16x64_bf16 v[60:63], v[24:27], v[232:239], v3
  ds_read_b128 v[12:15], v116 offset:0
  ds_read_b128 v[16:19], v116 offset:1024
  v_smfmac_f32_16x16x64_bf16 v[60:63], v[28:31], v[240:247], v3
  v_smfmac_f32_16x16x64_bf16 v[60:63], v[32:35], v[248:255], v3
  v_mov_b32 v80, v24
  v_smfmac_f32_16x16x64_bf16 v[52:55], v[24:27], v[120:127], v3
  v_mov_b32 v81, v25
  v_smfmac_f32_16x16x64_bf16 v[52:55], v[28:31], v[128:135], v3
  v_mov_b32 v82, v32
  v_smfmac_f32_16x16x64_bf16 v[52:55], v[32:35], v[136:143], v3
  v_cvt_pk_bf16_f32 v64, v60, v61
  v_smfmac_f32_16x16x64_bf16 v[56:59], v[24:27], v[176:183], v3
  v_cvt_pk_bf16_f32 v65, v62, v63
  v_smfmac_f32_16x16x64_bf16 v[56:59], v[28:31], v[184:191], v3
  v_mov_b32 v83, v33
  v_mfma_f32_16x16x32_bf16 v[68:71], v[64:67], v[4:7], 0
  v_smfmac_f32_16x16x64_bf16 v[56:59], v[32:35], v[192:199], v3
  v_cvt_pk_bf16_f32 v64, v52, v53
  v_smfmac_f32_16x16x64_bf16 v[36:39], v[24:27], a[32:39], v3
  v_cvt_pk_bf16_f32 v65, v54, v55
  v_smfmac_f32_16x16x64_bf16 v[36:39], v[28:31], a[40:47], v3
  v_cvt_pk_bf16_f32 v78, v68, v69
  v_smfmac_f32_16x16x64_bf16 v[36:39], v[32:35], a[48:55], v3
  v_cvt_pk_bf16_f32 v79, v70, v71
  v_cvt_pk_bf16_f32 v66, v56, v57
  v_smfmac_f32_16x16x64_bf16 v[40:43], v[24:27], a[88:95], v3
  v_cvt_pk_bf16_f32 v67, v58, v59
  v_smfmac_f32_16x16x64_bf16 v[40:43], v[28:31], a[96:103], v3
  v_mfma_f32_16x16x32_bf16 v[72:75], v[64:67], v[4:7], 0
  ds_read_b128 v[52:55], v116 offset:14336
  ds_read_b128 v[56:59], v116 offset:15360
  v_smfmac_f32_16x16x64_bf16 v[40:43], v[32:35], a[104:111], v3
  v_cvt_pk_bf16_f32 v64, v36, v37
  v_smfmac_f32_16x16x64_bf16 v[44:47], v[24:27], a[144:151], v3
  v_cvt_pk_bf16_f32 v65, v38, v39
  v_smfmac_f32_16x16x64_bf16 v[44:47], v[28:31], a[152:159], v3
  v_cvt_pk_bf16_f32 v76, v72, v73
  v_smfmac_f32_16x16x64_bf16 v[44:47], v[32:35], a[160:167], v3
  v_cvt_pk_bf16_f32 v77, v74, v75
  v_cvt_pk_bf16_f32 v66, v40, v41
  v_smfmac_f32_16x16x64_bf16 v[48:51], v[24:27], a[200:207], v3
  v_cvt_pk_bf16_f32 v67, v42, v43
  v_smfmac_f32_16x16x64_bf16 v[48:51], v[28:31], a[208:215], v3
  v_mfma_f32_16x16x32_bf16 v[68:71], v[64:67], v[4:7], 0
  v_smfmac_f32_16x16x64_bf16 v[48:51], v[32:35], a[216:223], v3
  v_cvt_pk_bf16_f32 v64, v44, v45
  v_mfma_f32_16x16x32_bf16 v[84:87], v[80:83], v[76:79], 0
  v_cvt_pk_bf16_f32 v65, v46, v47
  s_waitcnt lgkmcnt(0)
  v_smfmac_f32_16x16x64_bf16 v[88:91], v[76:79], v[96:103], v3
  v_cvt_pk_bf16_f32 v60, v68, v69
  v_cvt_pk_bf16_f32 v61, v70, v71
  v_cvt_pk_bf16_f32 v66, v48, v49
  v_cvt_pk_bf16_f32 v67, v50, v51
  s_nop 1
  v_mfma_f32_16x16x32_bf16 v[72:75], v[64:67], v[4:7], 0
  v_smfmac_f32_16x16x64_bf16 v[92:95], v[76:79], v[104:111], v3
  s_nop 4
  v_cvt_pk_bf16_f32 v62, v72, v73
  v_cvt_pk_bf16_f32 v63, v74, v75
  s_nop 1
  v_mfma_f32_16x16x32_bf16 v[84:87], v[8:11], v[60:63], v[84:87]
  v_smfmac_f32_16x16x64_bf16 v[88:91], v[60:63], v[12:19], v3
  v_smfmac_f32_16x16x64_bf16 v[92:95], v[60:63], v[52:59], v3
  s_mov_b64 exec, s[26:27]
  s_nop 0
  ds_write_b128 v113, v[84:87]
  s_mov_b64 exec, -1
  s_nop 0
  v_cmp_u_f32 vcc, v88, v89
  s_nop 1
  v_permlane32_swap_b32 v88, v92
  v_permlane32_swap_b32 v89, v93
  v_permlane32_swap_b32 v90, v94
  v_permlane32_swap_b32 v91, v95
  v_add_f32 v88, v88, v92
  v_add_f32 v89, v89, v93
  v_add_f32 v90, v90, v94
  v_add_f32 v91, v91, v95
  ds_write_b128 v112, v[88:91]
  s_cbranch_vccnz cB_sc0_retry
cB_sc0_cont:
  s_waitcnt lgkmcnt(0)
  s_barrier
  ds_read_b64 v[36:37], v114 offset:0
  ds_read_b64 v[38:39], v114 offset:1024
  ds_read2_b32 v[44:45], v115 offset0:0 offset1:64
  s_waitcnt lgkmcnt(0)
  v_add_f32 v44, v44, v45
  v_add_f32 v36, v36, v38
  v_add_f32 v37, v37, v39
  v_add_f32_dpp v44, v44, v44 row_ror:8 row_mask:0xf bank_mask:0xf
  v_mov_b32 v45, v44
  v_permlane32_swap_b32 v36, v37
  v_add_f32 v36, v36, v37
  v_permlane16_swap_b32 v44, v45
  v_add_f32 v44, v44, v45
  v_exp_f32 v48, v36
  v_exp_f32 v49, v44
  v_add_f32 v50, abs(v36), abs(v44)
  v_fma_f32 v39, v49, s37, v48
  v_cmp_ngt_f32 vcc, s56, v50
  v_cndmask_b32 v41, v48, v49, s[38:39]
  v_add_f32_dpp v39, v39, v39 quad_perm:[1,0,3,2] row_mask:0xf bank_mask:0xf
  v_cndmask_b32 v40, v49, v48, s[38:39]
  v_mov_b32_dpp v46, v41 quad_perm:[1,0,3,2] row_mask:0xf bank_mask:0xf
  v_add_f32_dpp v39, v39, v39 quad_perm:[2,3,0,1] row_mask:0xf bank_mask:0xf
  v_cndmask_b32 v42, v46, v40, s[38:39]
  v_cndmask_b32 v43, v40, v46, s[38:39]
  v_add_f32_dpp v39, v39, v39 row_half_mirror row_mask:0xf bank_mask:0xf
  s_cbranch_vccnz cB_sc0_slow
  s_nop 0
  v_add_f32_dpp v39, v39, v39 row_mirror row_mask:0xf bank_mask:0xf
  v_mov_b32 v47, v39
  s_nop 1
  v_permlane16_swap_b32 v39, v47
  v_add_f32 v39, v39, v47
  v_rcp_f32 v39, v39
  s_mov_b64 exec, s[28:29]
  v_mul_f32 v42, v42, v39
  v_mul_f32 v43, v43, v39
  v_cvt_pk_bf16_f32 v42, v42, v43
cB_sc0_pst:
  buffer_store_dword v42, v1, s[8:11], s20 offen sc1
  s_mov_b64 exec, -1
  s_barrier
  s_add_u32 s24, s24, 28672
  s_add_u32 s35, s35, 28672
  s_xor_b32 s25, s25, 28672
  s_add_u32 m0, s25, 0
  s_nop 0
  buffer_load_dwordx4 v2, s[8:11], s24 offen offset:0 sc1 lds
  buffer_load_dwordx4 v2, s[8:11], s24 offen offset:1024 sc1 lds
  buffer_load_dwordx4 v2, s[8:11], s24 offen offset:2048 sc1 lds
  buffer_load_dwordx4 v2, s[8:11], s24 offen offset:3072 sc1 lds
  s_add_u32 m0, s25, 4096
  s_add_u32 s22, s24, 4096
  buffer_load_dwordx4 v2, s[8:11], s22 offen offset:0 sc1 lds
  buffer_load_dwordx4 v2, s[8:11], s22 offen offset:1024 sc1 lds
  buffer_load_dwordx4 v2, s[8:11], s22 offen offset:2048 sc1 lds
  v_xor_b32 v116, 28672, v116
  v_add_u32 v117, s57, v117
  s_sub_u32 s57, 0, s57
  s_add_u32 s19, s19, 1
  s_mov_b32 s20, s21
  s_cmp_lt_u32 s19, 63
  s_cbranch_scc1 cB_sc0_loop
  s_branch cB_done
cB_sc0_slow:
  v_max_f32 v50, v36, v44
  s_nop 1
  v_max_f32_dpp v50, v50, v50 quad_perm:[1,0,3,2] row_mask:0xf bank_mask:0xf
  s_nop 1
  v_max_f32_dpp v50, v50, v50 quad_perm:[2,3,0,1] row_mask:0xf bank_mask:0xf
  s_nop 1
  v_max_f32_dpp v50, v50, v50 row_half_mirror row_mask:0xf bank_mask:0xf
  s_nop 1
  v_max_f32_dpp v50, v50, v50 row_mirror row_mask:0xf bank_mask:0xf
  v_mov_b32 v47, v50
  s_nop 1
  v_permlane16_swap_b32 v50, v47
  v_max_f32 v50, v50, v47
  v_sub_f32 v48, v36, v50
  v_sub_f32 v49, v44, v50
  v_exp_f32 v48, v48
  v_exp_f32 v49, v49
  s_add_u32 s31, s31, 0x100
  v_fma_f32 v39, v49, s37, v48
  v_cndmask_b32 v41, v48, v49, s[38:39]
  s_nop 0
  v_add_f32_dpp v39, v39, v39 quad_perm:[1,0,3,2] row_mask:0xf bank_mask:0xf
  v_cndmask_b32 v40, v49, v48, s[38:39]
  v_mov_b32_dpp v46, v41 quad_perm:[1,0,3,2] row_mask:0xf bank_mask:0xf
  v_add_f32_dpp v39, v39, v39 quad_perm:[2,3,0,1] row_mask:0xf bank_mask:0xf
  v_cndmask_b32 v42, v46, v40, s[38:39]
  v_cndmask_b32 v43, v40, v46, s[38:39]
  v_add_f32_dpp v39, v39, v39 row_half_mirror row_mask:0xf bank_mask:0xf
  s_nop 1
  v_add_f32_dpp v39, v39, v39 row_mirror row_mask:0xf bank_mask:0xf
  v_mov_b32 v47, v39
  s_nop 1
  v_permlane16_swap_b32 v39, v47
  v_add_f32 v39, v39, v47
  v_rcp_f32 v39, v39
  s_mov_b64 exec, s[28:29]
  v_mul_f32 v42, v42, v39
  v_mul_f32 v43, v43, v39
  v_cvt_pk_bf16_f32 v42, v42, v43
  v_min_u32 v42, -2, v42
  s_branch cB_sc0_pst
cB_sc0_retry:
  s_cmp_lg_u32 s62, 0
  s_cbranch_scc1 cB_sc0_cont
  s_waitcnt vmcnt(0) lgkmcnt(0)
cB_sc0_rv:
  buffer_load_dwordx4 v[8:11], v2, s[8:11], s20 offen offset:0 sc1
  buffer_load_dwordx4 v[12:15], v2, s[8:11], s20 offen offset:1024 sc1
  buffer_load_dwordx4 v[16:19], v2, s[8:11], s20 offen offset:2048 sc1
  buffer_load_dwordx4 v[20:23], v2, s[8:11], s20 offen offset:3072 sc1
  buffer_load_dwordx4 v[24:27], v2, s[8:11], s23 offen offset:0 sc1
  buffer_load_dwordx4 v[28:31], v2, s[8:11], s23 offen offset:1024 sc1
  buffer_load_dwordx4 v[32:35], v2, s[8:11], s23 offen offset:2048 sc1
  s_waitcnt vmcnt(0)
  v_max3_u32 v118, v8, v9, v10
  v_max3_u32 v118, v118, v11, v12
  v_max3_u32 v118, v118, v13, v14
  v_max3_u32 v118, v118, v15, v16
  v_max3_u32 v118, v118, v17, v18
  v_max3_u32 v118, v118, v19, v20
  v_max3_u32 v118, v118, v21, v22
  v_max3_u32 v118, v118, v23, v24
  v_max3_u32 v118, v118, v25, v26
  v_max3_u32 v118, v118, v27, v28
  v_max3_u32 v118, v118, v29, v30
  v_max3_u32 v118, v118, v31, v32
  v_max3_u32 v118, v118, v33, v34
  v_max_u32 v118, v118, v35
  v_cmp_eq_u32 vcc, -1, v118
  s_cbranch_vccz cB_sc0_rk
  s_add_u32 s30, s30, 1
  s_cmp_lt_u32 s30, 400000
  s_cbranch_scc1 cB_sc0_rv
  s_branch cB_abort
cB_sc0_rk:
  s_mov_b32 s62, 1
  v_mov_b32 v36, 0
  v_mov_b32 v37, 0
  v_mov_b32 v38, 0
  v_mov_b32 v39, 0
  v_mov_b32 v40, 0
  v_mov_b32 v41, 0
  v_mov_b32 v42, 0
  v_mov_b32 v43, 0
  v_mov_b32 v44, 0
  v_mov_b32 v45, 0
  v_mov_b32 v46, 0
  v_mov_b32 v47, 0
  v_mov_b32 v48, 0
  v_mov_b32 v49, 0
  v_mov_b32 v50, 0
  v_mov_b32 v51, 0
  v_mov_b32 v52, 0
  v_mov_b32 v53, 0
  v_mov_b32 v54, 0
  v_mov_b32 v55, 0
  v_mov_b32 v56, 0
  v_mov_b32 v57, 0
  v_mov_b32 v58, 0
  v_mov_b32 v59, 0
  v_mov_b32 v60, 0
  v_mov_b32 v61, 0
  v_mov_b32 v62, 0
  v_mov_b32 v63, 0
  v_mov_b32 v88, 0
  v_mov_b32 v89, 0
  v_mov_b32 v90, 0
  v_mov_b32 v91, 0
  v_mov_b32 v92, 0
  v_mov_b32 v93, 0
  v_mov_b32 v94, 0
  v_mov_b32 v95, 0
  v_mov_b32 v66, 0
  v_mov_b32 v67, 0
  s_add_u32 s31, s31, 1
  ds_read_b128 v[96:99], v117 offset:0
  ds_read_b128 v[100:103], v117 offset:1024
  ds_read_b128 v[104:107], v117 offset:14336
  ds_read_b128 v[108:111], v117 offset:15360
  v_smfmac_f32_16x16x64_bf16 v[36:39], v[8:11], a[0:7], v3
  v_smfmac_f32_16x16x64_bf16 v[40:43], v[8:11], a[56:63], v3
  v_smfmac_f32_16x16x64_bf16 v[44:47], v[8:11], a[112:119], v3
  v_smfmac_f32_16x16x64_bf16 v[48:51], v[8:11], a[168:175], v3
  v_smfmac_f32_16x16x64_bf16 v[52:55], v[8:11], a[224:231], v3
  v_smfmac_f32_16x16x64_bf16 v[56:59], v[8:11], v[144:151], v3
  v_smfmac_f32_16x16x64_bf16 v[60:63], v[8:11], v[200:207], v3
  v_smfmac_f32_16x16x64_bf16 v[36:39], v[12:15], a[8:15], v3
  v_smfmac_f32_16x16x64_bf16 v[40:43], v[12:15], a[64:71], v3
  v_smfmac_f32_16x16x64_bf16 v[44:47], v[12:15], a[120:127], v3
  v_smfmac_f32_16x16x64_bf16 v[48:51], v[12:15], a[176:183], v3
  v_smfmac_f32_16x16x64_bf16 v[52:55], v[12:15], a[232:239], v3
  v_smfmac_f32_16x16x64_bf16 v[56:59], v[12:15], v[152:159], v3
  v_smfmac_f32_16x16x64_bf16 v[60:63], v[12:15], v[208:215], v3
  v_smfmac_f32_16x16x64_bf16 v[36:39], v[16:19], a[16:23], v3
  v_smfmac_f32_16x16x64_bf16 v[40:43], v[16:19], a[72:79], v3
  v_smfmac_f32_16x16x64_bf16 v[44:47], v[16:19], a[128:135], v3
  v_smfmac_f32_16x16x64_bf16 v[48:51], v[16:19], a[184:191], v3
  v_smfmac_f32_16x16x64_bf16 v[52:55], v[16:19], a[240:247], v3
  v_smfmac_f32_16x16x64_bf16 v[56:59], v[16:19], v[160:167], v3
  v_smfmac_f32_16x16x64_bf16 v[60:63], v[16:19], v[216:223], v3
  v_smfmac_f32_16x16x64_bf16 v[36:39], v[20:23], a[24:31], v3
  v_smfmac_f32_16x16x64_bf16 v[40:43], v[20:23], a[80:87], v3
  v_smfmac_f32_16x16x64_bf16 v[44:47], v[20:23], a[136:143], v3
  v_smfmac_f32_16x16x64_bf16 v[48:51], v[20:23], a[192:199], v3
  v_smfmac_f32_16x16x64_bf16 v[52:55], v[20:23], a[248:255], v3
  v_smfmac_f32_16x16x64_bf16 v[56:59], v[20:23], v[168:175], v3
  v_smfmac_f32_16x16x64_bf16 v[60:63], v[20:23], v[224:231], v3
  s_branch cB_sc0_ph2
.p2align 6

cB_sc1_loop:
  s_add_u32 s23, s20, 4096
  s_add_u32 s21, s20, 25600
  v_mov_b32 v48, 0
  v_mov_b32 v49, 0
  v_mov_b32 v50, 0
  v_mov_b32 v51, 0
  v_mov_b32 v52, 0
  v_mov_b32 v53, 0
  v_mov_b32 v54, 0
  v_mov_b32 v55, 0
  v_mov_b32 v56, 0
  v_mov_b32 v57, 0
  v_mov_b32 v58, 0
  v_mov_b32 v59, 0
  v_mov_b32 v60, 0
  v_mov_b32 v61, 0
  v_mov_b32 v62, 0
  v_mov_b32 v63, 0
  v_mov_b32 v88, 0
  v_mov_b32 v89, 0
  v_mov_b32 v90, 0
  v_mov_b32 v91, 0
  v_mov_b32 v92, 0
  v_mov_b32 v93, 0
  v_mov_b32 v94, 0
  v_mov_b32 v95, 0
  v_mov_b32 v64, 0
  v_mov_b32 v65, 0
  s_mov_b32 s30, 0
  s_mov_b32 s62, 0
  s_waitcnt vmcnt(0)
  s_barrier
cB_sc1_ld:
  buffer_load_dwordx4 v[8:11], v2, s[8:11], s20 offen offset:0 sc1
  v_mov_b32 v36, 0
  v_mov_b32 v37, 0
  v_mov_b32 v38, 0
  v_mov_b32 v39, 0
  buffer_load_dwordx4 v[12:15], v2, s[8:11], s20 offen offset:1024 sc1
  v_mov_b32 v40, 0
  v_mov_b32 v41, 0
  v_mov_b32 v42, 0
  v_mov_b32 v43, 0
  buffer_load_dwordx4 v[16:19], v2, s[8:11], s20 offen offset:2048 sc1
  v_mov_b32 v44, 0
  v_mov_b32 v45, 0
  v_mov_b32 v46, 0
  v_mov_b32 v47, 0
  ds_read_b128 v[96:99], v117 offset:0
  ds_read_b128 v[100:103], v117 offset:1024
  ds_read_b128 v[104:107], v117 offset:14336
  ds_read_b128 v[108:111], v117 offset:15360
  s_waitcnt vmcnt(2)
  v_smfmac_f32_16x16x64_bf16 v[36:39], v[8:11], a[0:7], v3
  v_smfmac_f32_16x16x64_bf16 v[40:43], v[8:11], a[56:63], v3
  buffer_load_dwordx4 v[20:23], v2, s[8:11], s20 offen offset:3072 sc1
  v_smfmac_f32_16x16x64_bf16 v[44:47], v[8:11], a[112:119], v3
  v_smfmac_f32_16x16x64_bf16 v[48:51], v[8:11], a[168:175], v3
  v_smfmac_f32_16x16x64_bf16 v[52:55], v[8:11], a[224:231], v3
  buffer_load_dwordx4 v[24:27], v2, s[8:11], s23 offen offset:0 sc1
  v_smfmac_f32_16x16x64_bf16 v[56:59], v[8:11], v[144:151], v3
  v_smfmac_f32_16x16x64_bf16 v[60:63], v[8:11], v[200:207], v3
  s_waitcnt vmcnt(3)
  v_smfmac_f32_16x16x64_bf16 v[36:39], v[12:15], a[8:15], v3
  v_smfmac_f32_16x16x64_bf16 v[40:43], v[12:15], a[64:71], v3
  buffer_load_dwordx4 v[28:31], v2, s[8:11], s23 offen offset:1024 sc1
  v_smfmac_f32_16x16x64_bf16 v[44:47], v[12:15], a[120:127], v3
  v_smfmac_f32_16x16x64_bf16 v[48:51], v[12:15], a[176:183], v3
  v_smfmac_f32_16x16x64_bf16 v[52:55], v[12:15], a[232:239], v3
  buffer_load_dwordx4 v[32:35], v2, s[8:11], s23 offen offset:2048 sc1
  v_smfmac_f32_16x16x64_bf16 v[56:59], v[12:15], v[152:159], v3
  v_smfmac_f32_16x16x64_bf16 v[60:63], v[12:15], v[208:215], v3
  s_waitcnt vmcnt(4)
  v_smfmac_f32_16x16x64_bf16 v[36:39], v[16:19], a[16:23], v3
  v_smfmac_f32_16x16x64_bf16 v[40:43], v[16:19], a[72:79], v3
  v_smfmac_f32_16x16x64_bf16 v[44:47], v[16:19], a[128:135], v3
  v_smfmac_f32_16x16x64_bf16 v[48:51], v[16:19], a[184:191], v3
  v_smfmac_f32_16x16x64_bf16 v[52:55], v[16:19], a[240:247], v3
  v_smfmac_f32_16x16x64_bf16 v[56:59], v[16:19], v[160:167], v3
  v_smfmac_f32_16x16x64_bf16 v[60:63], v[16:19], v[216:223], v3
  s_waitcnt vmcnt(3)
  v_smfmac_f32_16x16x64_bf16 v[36:39], v[20:23], a[24:31], v3
  v_smfmac_f32_16x16x64_bf16 v[40:43], v[20:23], a[80:87], v3
  v_smfmac_f32_16x16x64_bf16 v[44:47], v[20:23], a[136:143], v3
  v_smfmac_f32_16x16x64_bf16 v[48:51], v[20:23], a[192:199], v3
  v_smfmac_f32_16x16x64_bf16 v[52:55], v[20:23], a[248:255], v3
  v_smfmac_f32_16x16x64_bf16 v[56:59], v[20:23], v[168:175], v3
  v_smfmac_f32_16x16x64_bf16 v[60:63], v[20:23], v[224:231], v3
  s_waitcnt vmcnt(0)
cB_sc1_ph2:
  v_smfmac_f32_16x16x64_bf16 v[60:63], v[24:27], v[232:239], v3
  ds_read_b128 v[16:19], v116 offset:2048
  ds_read_b128 v[20:23], v116 offset:3072
  v_smfmac_f32_16x16x64_bf16 v[60:63], v[28:31], v[240:247], v3
  buffer_load_dword v119, v0, s[8:11], s20 offen sc1
  v_smfmac_f32_16x16x64_bf16 v[60:63], v[32:35], v[248:255], v3
  v_mov_b32 v80, v26
  v_smfmac_f32_16x16x64_bf16 v[52:55], v[24:27], v[120:127], v3
  v_mov_b32 v81, v27
  v_smfmac_f32_16x16x64_bf16 v[52:55], v[28:31], v[128:135], v3
  v_mov_b32 v82, v32
  v_smfmac_f32_16x16x64_bf16 v[52:55], v[32:35], v[136:143], v3
  v_cvt_pk_bf16_f32 v66, v60, v61
  v_smfmac_f32_16x16x64_bf16 v[56:59], v[24:27], v[176:183], v3
  v_cvt_pk_bf16_f32 v67, v62, v63
  v_smfmac_f32_16x16x64_bf16 v[56:59], v[28:31], v[184:191], v3
  v_mov_b32 v83, v33
  v_mfma_f32_16x16x32_bf16 v[68:71], v[64:67], v[4:7], 0
  v_smfmac_f32_16x16x64_bf16 v[56:59], v[32:35], v[192:199], v3
  v_cvt_pk_bf16_f32 v64, v52, v53
  v_smfmac_f32_16x16x64_bf16 v[36:39], v[24:27], a[32:39], v3
  v_cvt_pk_bf16_f32 v65, v54, v55
  v_smfmac_f32_16x16x64_bf16 v[36:39], v[28:31], a[40:47], v3
  v_cvt_pk_bf16_f32 v78, v68, v69
  v_smfmac_f32_16x16x64_bf16 v[36:39], v[32:35], a[48:55], v3
  v_cvt_pk_bf16_f32 v79, v70, v71
  v_cvt_pk_bf16_f32 v66, v56, v57
  v_smfmac_f32_16x16x64_bf16 v[40:43], v[24:27], a[88:95], v3
  v_cvt_pk_bf16_f32 v67, v58, v59
  v_smfmac_f32_16x16x64_bf16 v[40:43], v[28:31], a[96:103], v3
  v_mfma_f32_16x16x32_bf16 v[72:75], v[64:67], v[4:7], 0
  ds_read_b128 v[52:55], v116 offset:16384
  ds_read_b128 v[56:59], v116 offset:17408
  v_smfmac_f32_16x16x64_bf16 v[40:43], v[32:35], a[104:111], v3
  v_cvt_pk_bf16_f32 v64, v36, v37
  v_smfmac_f32_16x16x64_bf16 v[44:47], v[24:27], a[144:151], v3
  v_cvt_pk_bf16_f32 v65, v38, v39
  v_smfmac_f32_16x16x64_bf16 v[44:47], v[28:31], a[152:159], v3
  v_cvt_pk_bf16_f32 v76, v72, v73
  v_smfmac_f32_16x16x64_bf16 v[44:47], v[32:35], a[160:167], v3
  v_cvt_pk_bf16_f32 v77, v74, v75
  v_cvt_pk_bf16_f32 v66, v40, v41
  v_smfmac_f32_16x16x64_bf16 v[48:51], v[24:27], a[200:207], v3
  v_cvt_pk_bf16_f32 v67, v42, v43
  v_smfmac_f32_16x16x64_bf16 v[48:51], v[28:31], a[208:215], v3
  v_mfma_f32_16x16x32_bf16 v[68:71], v[64:67], v[4:7], 0
  v_smfmac_f32_16x16x64_bf16 v[48:51], v[32:35], a[216:223], v3
  v_cvt_pk_bf16_f32 v64, v44, v45
  v_mfma_f32_16x16x32_bf16 v[84:87], v[80:83], v[76:79], 0
  v_cvt_pk_bf16_f32 v65, v46, v47
  s_waitcnt lgkmcnt(0)
  v_smfmac_f32_16x16x64_bf16 v[88:91], v[76:79], v[96:103], v3
  v_cvt_pk_bf16_f32 v60, v68, v69
  v_cvt_pk_bf16_f32 v61, v70, v71
  v_cvt_pk_bf16_f32 v66, v48, v49
  v_cvt_pk_bf16_f32 v67, v50, v51
  s_nop 1
  v_mfma_f32_16x16x32_bf16 v[72:75], v[64:67], v[4:7], 0
  v_smfmac_f32_16x16x64_bf16 v[92:95], v[76:79], v[104:111], v3
  s_nop 4
  v_cvt_pk_bf16_f32 v62, v72, v73
  v_cvt_pk_bf16_f32 v63, v74, v75
  s_nop 1
  v_mfma_f32_16x16x32_bf16 v[84:87], v[12:15], v[60:63], v[84:87]
  v_smfmac_f32_16x16x64_bf16 v[88:91], v[60:63], v[16:23], v3
  v_smfmac_f32_16x16x64_bf16 v[92:95], v[60:63], v[52:59], v3
  s_mov_b64 exec, s[26:27]
  s_nop 0
  ds_write_b128 v113, v[84:87]
  s_mov_b64 exec, -1
  s_nop 0
  v_cmp_u_f32 vcc, v88, v89
  s_nop 1
  v_permlane32_swap_b32 v88, v92
  v_permlane32_swap_b32 v89, v93
  v_permlane32_swap_b32 v90, v94
  v_permlane32_swap_b32 v91, v95
  v_add_f32 v88, v88, v92
  v_add_f32 v89, v89, v93
  v_add_f32 v90, v90, v94
  v_add_f32 v91, v91, v95
  ds_write_b128 v112, v[88:91]
  s_cbranch_vccnz cB_sc1_retry
cB_sc1_cont:
  s_waitcnt lgkmcnt(0)
  s_barrier
  ds_read_b64 v[36:37], v114 offset:0
  ds_read_b64 v[38:39], v114 offset:1024
  ds_read2_b32 v[44:45], v115 offset0:0 offset1:64
  s_waitcnt lgkmcnt(0)
  v_add_f32 v44, v44, v45
  v_add_f32 v36, v36, v38
  v_add_f32 v37, v37, v39
  v_add_f32_dpp v44, v44, v44 row_ror:8 row_mask:0xf bank_mask:0xf
  v_mov_b32 v45, v44
  v_permlane32_swap_b32 v36, v37
  v_add_f32 v36, v36, v37
  v_permlane16_swap_b32 v44, v45
  v_add_f32 v44, v44, v45
  v_exp_f32 v48, v36
  v_exp_f32 v49, v44
  v_add_f32 v50, abs(v36), abs(v44)
  v_fma_f32 v39, v49, s37, v48
  v_cmp_ngt_f32 vcc, s56, v50
  v_cndmask_b32 v41, v48, v49, s[38:39]
  v_add_f32_dpp v39, v39, v39 quad_perm:[1,0,3,2] row_mask:0xf bank_mask:0xf
  v_cndmask_b32 v40, v49, v48, s[38:39]
  v_mov_b32_dpp v46, v41 quad_perm:[1,0,3,2] row_mask:0xf bank_mask:0xf
  v_add_f32_dpp v39, v39, v39 quad_perm:[2,3,0,1] row_mask:0xf bank_mask:0xf
  v_cndmask_b32 v42, v46, v40, s[38:39]
  v_cndmask_b32 v43, v40, v46, s[38:39]
  v_add_f32_dpp v39, v39, v39 row_half_mirror row_mask:0xf bank_mask:0xf
  s_cbranch_vccnz cB_sc1_slow
  s_nop 0
  v_add_f32_dpp v39, v39, v39 row_mirror row_mask:0xf bank_mask:0xf
  v_mov_b32 v47, v39
  s_nop 1
  v_permlane16_swap_b32 v39, v47
  v_add_f32 v39, v39, v47
  v_rcp_f32 v39, v39
  s_mov_b64 exec, s[28:29]
  v_mul_f32 v42, v42, v39
  v_mul_f32 v43, v43, v39
  v_cvt_pk_bf16_f32 v42, v42, v43
cB_sc1_pst:
  buffer_store_dword v42, v1, s[8:11], s20 offen sc1
  s_mov_b64 exec, -1
  s_barrier
  s_add_u32 s24, s24, 28672
  s_add_u32 s35, s35, 28672
  s_xor_b32 s25, s25, 28672
  s_add_u32 m0, s25, 7168
  s_nop 0
  buffer_load_dwordx4 v2, s[8:11], s24 offen offset:0 sc1 lds
  buffer_load_dwordx4 v2, s[8:11], s24 offen offset:1024 sc1 lds
  buffer_load_dwordx4 v2, s[8:11], s24 offen offset:2048 sc1 lds
  buffer_load_dwordx4 v2, s[8:11], s24 offen offset:3072 sc1 lds
  s_add_u32 m0, s25, 11264
  s_add_u32 s22, s24, 4096
  buffer_load_dwordx4 v2, s[8:11], s22 offen offset:0 sc1 lds
  buffer_load_dwordx4 v2, s[8:11], s22 offen offset:1024 sc1 lds
  buffer_load_dwordx4 v2, s[8:11], s22 offen offset:2048 sc1 lds
  v_xor_b32 v116, 28672, v116
  v_add_u32 v117, s57, v117
  s_sub_u32 s57, 0, s57
  s_add_u32 s19, s19, 1
  s_mov_b32 s20, s21
  s_cmp_lt_u32 s19, 63
  s_cbranch_scc1 cB_sc1_loop
  s_branch cB_done
cB_sc1_slow:
  v_max_f32 v50, v36, v44
  s_nop 1
  v_max_f32_dpp v50, v50, v50 quad_perm:[1,0,3,2] row_mask:0xf bank_mask:0xf
  s_nop 1
  v_max_f32_dpp v50, v50, v50 quad_perm:[2,3,0,1] row_mask:0xf bank_mask:0xf
  s_nop 1
  v_max_f32_dpp v50, v50, v50 row_half_mirror row_mask:0xf bank_mask:0xf
  s_nop 1
  v_max_f32_dpp v50, v50, v50 row_mirror row_mask:0xf bank_mask:0xf
  v_mov_b32 v47, v50
  s_nop 1
  v_permlane16_swap_b32 v50, v47
  v_max_f32 v50, v50, v47
  v_sub_f32 v48, v36, v50
  v_sub_f32 v49, v44, v50
  v_exp_f32 v48, v48
  v_exp_f32 v49, v49
  s_add_u32 s31, s31, 0x100
  v_fma_f32 v39, v49, s37, v48
  v_cndmask_b32 v41, v48, v49, s[38:39]
  s_nop 0
  v_add_f32_dpp v39, v39, v39 quad_perm:[1,0,3,2] row_mask:0xf bank_mask:0xf
  v_cndmask_b32 v40, v49, v48, s[38:39]
  v_mov_b32_dpp v46, v41 quad_perm:[1,0,3,2] row_mask:0xf bank_mask:0xf
  v_add_f32_dpp v39, v39, v39 quad_perm:[2,3,0,1] row_mask:0xf bank_mask:0xf
  v_cndmask_b32 v42, v46, v40, s[38:39]
  v_cndmask_b32 v43, v40, v46, s[38:39]
  v_add_f32_dpp v39, v39, v39 row_half_mirror row_mask:0xf bank_mask:0xf
  s_nop 1
  v_add_f32_dpp v39, v39, v39 row_mirror row_mask:0xf bank_mask:0xf
  v_mov_b32 v47, v39
  s_nop 1
  v_permlane16_swap_b32 v39, v47
  v_add_f32 v39, v39, v47
  v_rcp_f32 v39, v39
  s_mov_b64 exec, s[28:29]
  v_mul_f32 v42, v42, v39
  v_mul_f32 v43, v43, v39
  v_cvt_pk_bf16_f32 v42, v42, v43
  v_min_u32 v42, -2, v42
  s_branch cB_sc1_pst
cB_sc1_retry:
  s_cmp_lg_u32 s62, 0
  s_cbranch_scc1 cB_sc1_cont
  s_waitcnt vmcnt(0) lgkmcnt(0)
cB_sc1_rv:
  buffer_load_dwordx4 v[8:11], v2, s[8:11], s20 offen offset:0 sc1
  buffer_load_dwordx4 v[12:15], v2, s[8:11], s20 offen offset:1024 sc1
  buffer_load_dwordx4 v[16:19], v2, s[8:11], s20 offen offset:2048 sc1
  buffer_load_dwordx4 v[20:23], v2, s[8:11], s20 offen offset:3072 sc1
  buffer_load_dwordx4 v[24:27], v2, s[8:11], s23 offen offset:0 sc1
  buffer_load_dwordx4 v[28:31], v2, s[8:11], s23 offen offset:1024 sc1
  buffer_load_dwordx4 v[32:35], v2, s[8:11], s23 offen offset:2048 sc1
  s_waitcnt vmcnt(0)
  v_max3_u32 v118, v8, v9, v10
  v_max3_u32 v118, v118, v11, v12
  v_max3_u32 v118, v118, v13, v14
  v_max3_u32 v118, v118, v15, v16
  v_max3_u32 v118, v118, v17, v18
  v_max3_u32 v118, v118, v19, v20
  v_max3_u32 v118, v118, v21, v22
  v_max3_u32 v118, v118, v23, v24
  v_max3_u32 v118, v118, v25, v26
  v_max3_u32 v118, v118, v27, v28
  v_max3_u32 v118, v118, v29, v30
  v_max3_u32 v118, v118, v31, v32
  v_max3_u32 v118, v118, v33, v34
  v_max_u32 v118, v118, v35
  v_cmp_eq_u32 vcc, -1, v118
  s_cbranch_vccz cB_sc1_rk
  s_add_u32 s30, s30, 1
  s_cmp_lt_u32 s30, 400000
  s_cbranch_scc1 cB_sc1_rv
  s_branch cB_abort
cB_sc1_rk:
  s_mov_b32 s62, 1
  v_mov_b32 v36, 0
  v_mov_b32 v37, 0
  v_mov_b32 v38, 0
  v_mov_b32 v39, 0
  v_mov_b32 v40, 0
  v_mov_b32 v41, 0
  v_mov_b32 v42, 0
  v_mov_b32 v43, 0
  v_mov_b32 v44, 0
  v_mov_b32 v45, 0
  v_mov_b32 v46, 0
  v_mov_b32 v47, 0
  v_mov_b32 v48, 0
  v_mov_b32 v49, 0
  v_mov_b32 v50, 0
  v_mov_b32 v51, 0
  v_mov_b32 v52, 0
  v_mov_b32 v53, 0
  v_mov_b32 v54, 0
  v_mov_b32 v55, 0
  v_mov_b32 v56, 0
  v_mov_b32 v57, 0
  v_mov_b32 v58, 0
  v_mov_b32 v59, 0
  v_mov_b32 v60, 0
  v_mov_b32 v61, 0
  v_mov_b32 v62, 0
  v_mov_b32 v63, 0
  v_mov_b32 v88, 0
  v_mov_b32 v89, 0
  v_mov_b32 v90, 0
  v_mov_b32 v91, 0
  v_mov_b32 v92, 0
  v_mov_b32 v93, 0
  v_mov_b32 v94, 0
  v_mov_b32 v95, 0
  v_mov_b32 v64, 0
  v_mov_b32 v65, 0
  s_add_u32 s31, s31, 1
  ds_read_b128 v[96:99], v117 offset:0
  ds_read_b128 v[100:103], v117 offset:1024
  ds_read_b128 v[104:107], v117 offset:14336
  ds_read_b128 v[108:111], v117 offset:15360
  v_smfmac_f32_16x16x64_bf16 v[36:39], v[8:11], a[0:7], v3
  v_smfmac_f32_16x16x64_bf16 v[40:43], v[8:11], a[56:63], v3
  v_smfmac_f32_16x16x64_bf16 v[44:47], v[8:11], a[112:119], v3
  v_smfmac_f32_16x16x64_bf16 v[48:51], v[8:11], a[168:175], v3
  v_smfmac_f32_16x16x64_bf16 v[52:55], v[8:11], a[224:231], v3
  v_smfmac_f32_16x16x64_bf16 v[56:59], v[8:11], v[144:151], v3
  v_smfmac_f32_16x16x64_bf16 v[60:63], v[8:11], v[200:207], v3
  v_smfmac_f32_16x16x64_bf16 v[36:39], v[12:15], a[8:15], v3
  v_smfmac_f32_16x16x64_bf16 v[40:43], v[12:15], a[64:71], v3
  v_smfmac_f32_16x16x64_bf16 v[44:47], v[12:15], a[120:127], v3
  v_smfmac_f32_16x16x64_bf16 v[48:51], v[12:15], a[176:183], v3
  v_smfmac_f32_16x16x64_bf16 v[52:55], v[12:15], a[232:239], v3
  v_smfmac_f32_16x16x64_bf16 v[56:59], v[12:15], v[152:159], v3
  v_smfmac_f32_16x16x64_bf16 v[60:63], v[12:15], v[208:215], v3
  v_smfmac_f32_16x16x64_bf16 v[36:39], v[16:19], a[16:23], v3
  v_smfmac_f32_16x16x64_bf16 v[40:43], v[16:19], a[72:79], v3
  v_smfmac_f32_16x16x64_bf16 v[44:47], v[16:19], a[128:135], v3
  v_smfmac_f32_16x16x64_bf16 v[48:51], v[16:19], a[184:191], v3
  v_smfmac_f32_16x16x64_bf16 v[52:55], v[16:19], a[240:247], v3
  v_smfmac_f32_16x16x64_bf16 v[56:59], v[16:19], v[160:167], v3
  v_smfmac_f32_16x16x64_bf16 v[60:63], v[16:19], v[216:223], v3
  v_smfmac_f32_16x16x64_bf16 v[36:39], v[20:23], a[24:31], v3
  v_smfmac_f32_16x16x64_bf16 v[40:43], v[20:23], a[80:87], v3
  v_smfmac_f32_16x16x64_bf16 v[44:47], v[20:23], a[136:143], v3
  v_smfmac_f32_16x16x64_bf16 v[48:51], v[20:23], a[192:199], v3
  v_smfmac_f32_16x16x64_bf16 v[52:55], v[20:23], a[248:255], v3
  v_smfmac_f32_16x16x64_bf16 v[56:59], v[20:23], v[168:175], v3
  v_smfmac_f32_16x16x64_bf16 v[60:63], v[20:23], v[224:231], v3
  s_branch cB_sc1_ph2
.p2align 6

cB_sc2_loop:
  s_add_u32 s23, s20, 4096
  s_add_u32 s21, s20, 25600
  v_mov_b32 v48, 0
  v_mov_b32 v49, 0
  v_mov_b32 v50, 0
  v_mov_b32 v51, 0
  v_mov_b32 v52, 0
  v_mov_b32 v53, 0
  v_mov_b32 v54, 0
  v_mov_b32 v55, 0
  v_mov_b32 v56, 0
  v_mov_b32 v57, 0
  v_mov_b32 v58, 0
  v_mov_b32 v59, 0
  v_mov_b32 v60, 0
  v_mov_b32 v61, 0
  v_mov_b32 v62, 0
  v_mov_b32 v63, 0
  v_mov_b32 v88, 0
  v_mov_b32 v89, 0
  v_mov_b32 v90, 0
  v_mov_b32 v91, 0
  v_mov_b32 v92, 0
  v_mov_b32 v93, 0
  v_mov_b32 v94, 0
  v_mov_b32 v95, 0
  v_mov_b32 v66, 0
  v_mov_b32 v67, 0
  s_mov_b32 s30, 0
  s_mov_b32 s62, 0
  s_waitcnt vmcnt(0)
  s_barrier
cB_sc2_ld:
  buffer_load_dwordx4 v[8:11], v2, s[8:11], s20 offen offset:0 sc1
  v_mov_b32 v36, 0
  v_mov_b32 v37, 0
  v_mov_b32 v38, 0
  v_mov_b32 v39, 0
  buffer_load_dwordx4 v[12:15], v2, s[8:11], s20 offen offset:1024 sc1
  v_mov_b32 v40, 0
  v_mov_b32 v41, 0
  v_mov_b32 v42, 0
  v_mov_b32 v43, 0
  buffer_load_dwordx4 v[16:19], v2, s[8:11], s20 offen offset:2048 sc1
  v_mov_b32 v44, 0
  v_mov_b32 v45, 0
  v_mov_b32 v46, 0
  v_mov_b32 v47, 0
  ds_read_b128 v[96:99], v117 offset:0
  ds_read_b128 v[100:103], v117 offset:1024
  ds_read_b128 v[104:107], v117 offset:14336
  ds_read_b128 v[108:111], v117 offset:15360
  s_waitcnt vmcnt(2)
  v_smfmac_f32_16x16x64_bf16 v[36:39], v[8:11], a[0:7], v3
  v_smfmac_f32_16x16x64_bf16 v[40:43], v[8:11], a[56:63], v3
  buffer_load_dwordx4 v[20:23], v2, s[8:11], s20 offen offset:3072 sc1
  v_smfmac_f32_16x16x64_bf16 v[44:47], v[8:11], a[112:119], v3
  v_smfmac_f32_16x16x64_bf16 v[48:51], v[8:11], a[168:175], v3
  v_smfmac_f32_16x16x64_bf16 v[52:55], v[8:11], a[224:231], v3
  buffer_load_dwordx4 v[24:27], v2, s[8:11], s23 offen offset:0 sc1
  v_smfmac_f32_16x16x64_bf16 v[56:59], v[8:11], v[144:151], v3
  v_smfmac_f32_16x16x64_bf16 v[60:63], v[8:11], v[200:207], v3
  s_waitcnt vmcnt(3)
  v_smfmac_f32_16x16x64_bf16 v[36:39], v[12:15], a[8:15], v3
  v_smfmac_f32_16x16x64_bf16 v[40:43], v[12:15], a[64:71], v3
  buffer_load_dwordx4 v[28:31], v2, s[8:11], s23 offen offset:1024 sc1
  v_smfmac_f32_16x16x64_bf16 v[44:47], v[12:15], a[120:127], v3
  v_smfmac_f32_16x16x64_bf16 v[48:51], v[12:15], a[176:183], v3
  v_smfmac_f32_16x16x64_bf16 v[52:55], v[12:15], a[232:239], v3
  buffer_load_dwordx4 v[32:35], v2, s[8:11], s23 offen offset:2048 sc1
  v_smfmac_f32_16x16x64_bf16 v[56:59], v[12:15], v[152:159], v3
  v_smfmac_f32_16x16x64_bf16 v[60:63], v[12:15], v[208:215], v3
  s_waitcnt vmcnt(4)
  v_smfmac_f32_16x16x64_bf16 v[36:39], v[16:19], a[16:23], v3
  v_smfmac_f32_16x16x64_bf16 v[40:43], v[16:19], a[72:79], v3
  v_smfmac_f32_16x16x64_bf16 v[44:47], v[16:19], a[128:135], v3
  v_smfmac_f32_16x16x64_bf16 v[48:51], v[16:19], a[184:191], v3
  v_smfmac_f32_16x16x64_bf16 v[52:55], v[16:19], a[240:247], v3
  v_smfmac_f32_16x16x64_bf16 v[56:59], v[16:19], v[160:167], v3
  v_smfmac_f32_16x16x64_bf16 v[60:63], v[16:19], v[216:223], v3
  s_waitcnt vmcnt(3)
  v_smfmac_f32_16x16x64_bf16 v[36:39], v[20:23], a[24:31], v3
  v_smfmac_f32_16x16x64_bf16 v[40:43], v[20:23], a[80:87], v3
  v_smfmac_f32_16x16x64_bf16 v[44:47], v[20:23], a[136:143], v3
  v_smfmac_f32_16x16x64_bf16 v[48:51], v[20:23], a[192:199], v3
  v_smfmac_f32_16x16x64_bf16 v[52:55], v[20:23], a[248:255], v3
  v_smfmac_f32_16x16x64_bf16 v[56:59], v[20:23], v[168:175], v3
  v_smfmac_f32_16x16x64_bf16 v[60:63], v[20:23], v[224:231], v3
  s_waitcnt vmcnt(0)
cB_sc2_ph2:
  v_smfmac_f32_16x16x64_bf16 v[60:63], v[24:27], v[232:239], v3
  ds_read_b128 v[8:11], v116 offset:4096
  ds_read_b128 v[12:15], v116 offset:5120
  v_smfmac_f32_16x16x64_bf16 v[60:63], v[28:31], v[240:247], v3
  buffer_load_dword v119, v0, s[8:11], s24 offen sc1
  v_smfmac_f32_16x16x64_bf16 v[60:63], v[32:35], v[248:255], v3
  v_mov_b32 v80, v28
  v_smfmac_f32_16x16x64_bf16 v[52:55], v[24:27], v[120:127], v3
  v_mov_b32 v81, v29
  v_smfmac_f32_16x16x64_bf16 v[52:55], v[28:31], v[128:135], v3
  v_mov_b32 v82, v34
  v_smfmac_f32_16x16x64_bf16 v[52:55], v[32:35], v[136:143], v3
  v_cvt_pk_bf16_f32 v64, v60, v61
  v_smfmac_f32_16x16x64_bf16 v[56:59], v[24:27], v[176:183], v3
  v_cvt_pk_bf16_f32 v65, v62, v63
  v_smfmac_f32_16x16x64_bf16 v[56:59], v[28:31], v[184:191], v3
  v_mov_b32 v83, v35
  v_mfma_f32_16x16x32_bf16 v[68:71], v[64:67], v[4:7], 0
  v_smfmac_f32_16x16x64_bf16 v[56:59], v[32:35], v[192:199], v3
  v_cvt_pk_bf16_f32 v64, v52, v53
  v_smfmac_f32_16x16x64_bf16 v[36:39], v[24:27], a[32:39], v3
  v_cvt_pk_bf16_f32 v65, v54, v55
  v_smfmac_f32_16x16x64_bf16 v[36:39], v[28:31], a[40:47], v3
  v_cvt_pk_bf16_f32 v78, v68, v69
  v_smfmac_f32_16x16x64_bf16 v[36:39], v[32:35], a[48:55], v3
  v_cvt_pk_bf16_f32 v79, v70, v71
  v_cvt_pk_bf16_f32 v66, v56, v57
  v_smfmac_f32_16x16x64_bf16 v[40:43], v[24:27], a[88:95], v3
  v_cvt_pk_bf16_f32 v67, v58, v59
  v_smfmac_f32_16x16x64_bf16 v[40:43], v[28:31], a[96:103], v3
  v_mfma_f32_16x16x32_bf16 v[72:75], v[64:67], v[4:7], 0
  ds_read_b128 v[52:55], v116 offset:18432
  ds_read_b128 v[56:59], v116 offset:19456
  v_smfmac_f32_16x16x64_bf16 v[40:43], v[32:35], a[104:111], v3
  v_cvt_pk_bf16_f32 v64, v36, v37
  v_smfmac_f32_16x16x64_bf16 v[44:47], v[24:27], a[144:151], v3
  v_cvt_pk_bf16_f32 v65, v38, v39
  v_smfmac_f32_16x16x64_bf16 v[44:47], v[28:31], a[152:159], v3
  v_cvt_pk_bf16_f32 v76, v72, v73
  v_smfmac_f32_16x16x64_bf16 v[44:47], v[32:35], a[160:167], v3
  v_cvt_pk_bf16_f32 v77, v74, v75
  v_cvt_pk_bf16_f32 v66, v40, v41
  v_smfmac_f32_16x16x64_bf16 v[48:51], v[24:27], a[200:207], v3
  v_cvt_pk_bf16_f32 v67, v42, v43
  v_smfmac_f32_16x16x64_bf16 v[48:51], v[28:31], a[208:215], v3
  v_mfma_f32_16x16x32_bf16 v[68:71], v[64:67], v[4:7], 0
  v_smfmac_f32_16x16x64_bf16 v[48:51], v[32:35], a[216:223], v3
  v_cvt_pk_bf16_f32 v64, v44, v45
  v_mfma_f32_16x16x32_bf16 v[84:87], v[80:83], v[76:79], 0
  v_cvt_pk_bf16_f32 v65, v46, v47
  s_waitcnt lgkmcnt(0)
  v_smfmac_f32_16x16x64_bf16 v[88:91], v[76:79], v[96:103], v3
  v_cvt_pk_bf16_f32 v60, v68, v69
  v_cvt_pk_bf16_f32 v61, v70, v71
  v_cvt_pk_bf16_f32 v66, v48, v49
  v_cvt_pk_bf16_f32 v67, v50, v51
  s_nop 1
  v_mfma_f32_16x16x32_bf16 v[72:75], v[64:67], v[4:7], 0
  v_smfmac_f32_16x16x64_bf16 v[92:95], v[76:79], v[104:111], v3
  s_nop 4
  v_cvt_pk_bf16_f32 v62, v72, v73
  v_cvt_pk_bf16_f32 v63, v74, v75
  s_nop 1
  v_mfma_f32_16x16x32_bf16 v[84:87], v[16:19], v[60:63], v[84:87]
  v_smfmac_f32_16x16x64_bf16 v[88:91], v[60:63], v[8:15], v3
  v_smfmac_f32_16x16x64_bf16 v[92:95], v[60:63], v[52:59], v3
  s_mov_b64 exec, s[26:27]
  s_nop 0
  ds_write_b128 v113, v[84:87]
  s_mov_b64 exec, -1
  s_nop 0
  v_cmp_u_f32 vcc, v88, v89
  s_nop 1
  v_permlane32_swap_b32 v88, v92
  v_permlane32_swap_b32 v89, v93
  v_permlane32_swap_b32 v90, v94
  v_permlane32_swap_b32 v91, v95
  v_add_f32 v88, v88, v92
  v_add_f32 v89, v89, v93
  v_add_f32 v90, v90, v94
  v_add_f32 v91, v91, v95
  ds_write_b128 v112, v[88:91]
  s_cbranch_vccnz cB_sc2_retry
cB_sc2_cont:
  s_waitcnt lgkmcnt(0)
  s_barrier
  ds_read_b64 v[36:37], v114 offset:0
  ds_read_b64 v[38:39], v114 offset:1024
  ds_read2_b32 v[44:45], v115 offset0:0 offset1:64
  v_lshl_add_u32 v56, v2, 3, s36
  s_waitcnt lgkmcnt(0)
  v_add_f32 v44, v44, v45
  v_add_f32 v36, v36, v38
  v_add_f32 v37, v37, v39
  v_add_f32_dpp v44, v44, v44 row_ror:8 row_mask:0xf bank_mask:0xf
  v_mov_b32 v45, v44
  s_mov_b64 exec, 65535
  buffer_store_dword v2, v56, s[8:11], s20 offen sc1
  s_mov_b64 exec, -1
  v_permlane32_swap_b32 v36, v37
  v_add_f32 v36, v36, v37
  v_permlane16_swap_b32 v44, v45
  v_add_f32 v44, v44, v45
  v_exp_f32 v48, v36
  v_exp_f32 v49, v44
  v_add_f32 v50, abs(v36), abs(v44)
  v_fma_f32 v39, v49, s37, v48
  v_cmp_ngt_f32 vcc, s56, v50
  v_cndmask_b32 v41, v48, v49, s[38:39]
  v_add_f32_dpp v39, v39, v39 quad_perm:[1,0,3,2] row_mask:0xf bank_mask:0xf
  v_cndmask_b32 v40, v49, v48, s[38:39]
  v_mov_b32_dpp v46, v41 quad_perm:[1,0,3,2] row_mask:0xf bank_mask:0xf
  v_add_f32_dpp v39, v39, v39 quad_perm:[2,3,0,1] row_mask:0xf bank_mask:0xf
  v_cndmask_b32 v42, v46, v40, s[38:39]
  v_cndmask_b32 v43, v40, v46, s[38:39]
  v_add_f32_dpp v39, v39, v39 row_half_mirror row_mask:0xf bank_mask:0xf
  s_cbranch_vccnz cB_sc2_slow
  s_nop 0
  v_add_f32_dpp v39, v39, v39 row_mirror row_mask:0xf bank_mask:0xf
  v_mov_b32 v47, v39
  s_nop 1
  v_permlane16_swap_b32 v39, v47
  v_add_f32 v39, v39, v47
  v_rcp_f32 v39, v39
  s_mov_b64 exec, s[28:29]
  v_mul_f32 v42, v42, v39
  v_mul_f32 v43, v43, v39
  v_cvt_pk_bf16_f32 v42, v42, v43
cB_sc2_pst:
  buffer_store_dword v42, v1, s[8:11], s20 offen sc1
  s_mov_b64 exec, -1
  s_barrier
  s_add_u32 s24, s24, 28672
  s_add_u32 s35, s35, 28672
  s_xor_b32 s25, s25, 28672
  s_add_u32 m0, s25, 14336
  s_nop 0
  buffer_load_dwordx4 v2, s[8:11], s24 offen offset:0 sc1 lds
  buffer_load_dwordx4 v2, s[8:11], s24 offen offset:1024 sc1 lds
  buffer_load_dwordx4 v2, s[8:11], s24 offen offset:2048 sc1 lds
  buffer_load_dwordx4 v2, s[8:11], s24 offen offset:3072 sc1 lds
  s_add_u32 m0, s25, 18432
  s_add_u32 s22, s24, 4096
  buffer_load_dwordx4 v2, s[8:11], s22 offen offset:0 sc1 lds
  buffer_load_dwordx4 v2, s[8:11], s22 offen offset:1024 sc1 lds
  buffer_load_dwordx4 v2, s[8:11], s22 offen offset:2048 sc1 lds
  v_xor_b32 v116, 28672, v116
  v_add_u32 v117, s57, v117
  s_sub_u32 s57, 0, s57
  s_add_u32 s19, s19, 1
  s_mov_b32 s20, s21
  s_cmp_lt_u32 s19, 63
  s_cbranch_scc1 cB_sc2_loop
  s_branch cB_done
cB_sc2_slow:
  v_max_f32 v50, v36, v44
  s_nop 1
  v_max_f32_dpp v50, v50, v50 quad_perm:[1,0,3,2] row_mask:0xf bank_mask:0xf
  s_nop 1
  v_max_f32_dpp v50, v50, v50 quad_perm:[2,3,0,1] row_mask:0xf bank_mask:0xf
  s_nop 1
  v_max_f32_dpp v50, v50, v50 row_half_mirror row_mask:0xf bank_mask:0xf
  s_nop 1
  v_max_f32_dpp v50, v50, v50 row_mirror row_mask:0xf bank_mask:0xf
  v_mov_b32 v47, v50
  s_nop 1
  v_permlane16_swap_b32 v50, v47
  v_max_f32 v50, v50, v47
  v_sub_f32 v48, v36, v50
  v_sub_f32 v49, v44, v50
  v_exp_f32 v48, v48
  v_exp_f32 v49, v49
  s_add_u32 s31, s31, 0x100
  v_fma_f32 v39, v49, s37, v48
  v_cndmask_b32 v41, v48, v49, s[38:39]
  s_nop 0
  v_add_f32_dpp v39, v39, v39 quad_perm:[1,0,3,2] row_mask:0xf bank_mask:0xf
  v_cndmask_b32 v40, v49, v48, s[38:39]
  v_mov_b32_dpp v46, v41 quad_perm:[1,0,3,2] row_mask:0xf bank_mask:0xf
  v_add_f32_dpp v39, v39, v39 quad_perm:[2,3,0,1] row_mask:0xf bank_mask:0xf
  v_cndmask_b32 v42, v46, v40, s[38:39]
  v_cndmask_b32 v43, v40, v46, s[38:39]
  v_add_f32_dpp v39, v39, v39 row_half_mirror row_mask:0xf bank_mask:0xf
  s_nop 1
  v_add_f32_dpp v39, v39, v39 row_mirror row_mask:0xf bank_mask:0xf
  v_mov_b32 v47, v39
  s_nop 1
  v_permlane16_swap_b32 v39, v47
  v_add_f32 v39, v39, v47
  v_rcp_f32 v39, v39
  s_mov_b64 exec, s[28:29]
  v_mul_f32 v42, v42, v39
  v_mul_f32 v43, v43, v39
  v_cvt_pk_bf16_f32 v42, v42, v43
  v_min_u32 v42, -2, v42
  s_branch cB_sc2_pst
cB_sc2_retry:
  s_cmp_lg_u32 s62, 0
  s_cbranch_scc1 cB_sc2_cont
  s_waitcnt vmcnt(0) lgkmcnt(0)
cB_sc2_rv:
  buffer_load_dwordx4 v[8:11], v2, s[8:11], s20 offen offset:0 sc1
  buffer_load_dwordx4 v[12:15], v2, s[8:11], s20 offen offset:1024 sc1
  buffer_load_dwordx4 v[16:19], v2, s[8:11], s20 offen offset:2048 sc1
  buffer_load_dwordx4 v[20:23], v2, s[8:11], s20 offen offset:3072 sc1
  buffer_load_dwordx4 v[24:27], v2, s[8:11], s23 offen offset:0 sc1
  buffer_load_dwordx4 v[28:31], v2, s[8:11], s23 offen offset:1024 sc1
  buffer_load_dwordx4 v[32:35], v2, s[8:11], s23 offen offset:2048 sc1
  s_waitcnt vmcnt(0)
  v_max3_u32 v118, v8, v9, v10
  v_max3_u32 v118, v118, v11, v12
  v_max3_u32 v118, v118, v13, v14
  v_max3_u32 v118, v118, v15, v16
  v_max3_u32 v118, v118, v17, v18
  v_max3_u32 v118, v118, v19, v20
  v_max3_u32 v118, v118, v21, v22
  v_max3_u32 v118, v118, v23, v24
  v_max3_u32 v118, v118, v25, v26
  v_max3_u32 v118, v118, v27, v28
  v_max3_u32 v118, v118, v29, v30
  v_max3_u32 v118, v118, v31, v32
  v_max3_u32 v118, v118, v33, v34
  v_max_u32 v118, v118, v35
  v_cmp_eq_u32 vcc, -1, v118
  s_cbranch_vccz cB_sc2_rk
  s_add_u32 s30, s30, 1
  s_cmp_lt_u32 s30, 400000
  s_cbranch_scc1 cB_sc2_rv
  s_branch cB_abort
cB_sc2_rk:
  s_mov_b32 s62, 1
  v_mov_b32 v36, 0
  v_mov_b32 v37, 0
  v_mov_b32 v38, 0
  v_mov_b32 v39, 0
  v_mov_b32 v40, 0
  v_mov_b32 v41, 0
  v_mov_b32 v42, 0
  v_mov_b32 v43, 0
  v_mov_b32 v44, 0
  v_mov_b32 v45, 0
  v_mov_b32 v46, 0
  v_mov_b32 v47, 0
  v_mov_b32 v48, 0
  v_mov_b32 v49, 0
  v_mov_b32 v50, 0
  v_mov_b32 v51, 0
  v_mov_b32 v52, 0
  v_mov_b32 v53, 0
  v_mov_b32 v54, 0
  v_mov_b32 v55, 0
  v_mov_b32 v56, 0
  v_mov_b32 v57, 0
  v_mov_b32 v58, 0
  v_mov_b32 v59, 0
  v_mov_b32 v60, 0
  v_mov_b32 v61, 0
  v_mov_b32 v62, 0
  v_mov_b32 v63, 0
  v_mov_b32 v88, 0
  v_mov_b32 v89, 0
  v_mov_b32 v90, 0
  v_mov_b32 v91, 0
  v_mov_b32 v92, 0
  v_mov_b32 v93, 0
  v_mov_b32 v94, 0
  v_mov_b32 v95, 0
  v_mov_b32 v66, 0
  v_mov_b32 v67, 0
  s_add_u32 s31, s31, 1
  ds_read_b128 v[96:99], v117 offset:0
  ds_read_b128 v[100:103], v117 offset:1024
  ds_read_b128 v[104:107], v117 offset:14336
  ds_read_b128 v[108:111], v117 offset:15360
  v_smfmac_f32_16x16x64_bf16 v[36:39], v[8:11], a[0:7], v3
  v_smfmac_f32_16x16x64_bf16 v[40:43], v[8:11], a[56:63], v3
  v_smfmac_f32_16x16x64_bf16 v[44:47], v[8:11], a[112:119], v3
  v_smfmac_f32_16x16x64_bf16 v[48:51], v[8:11], a[168:175], v3
  v_smfmac_f32_16x16x64_bf16 v[52:55], v[8:11], a[224:231], v3
  v_smfmac_f32_16x16x64_bf16 v[56:59], v[8:11], v[144:151], v3
  v_smfmac_f32_16x16x64_bf16 v[60:63], v[8:11], v[200:207], v3
  v_smfmac_f32_16x16x64_bf16 v[36:39], v[12:15], a[8:15], v3
  v_smfmac_f32_16x16x64_bf16 v[40:43], v[12:15], a[64:71], v3
  v_smfmac_f32_16x16x64_bf16 v[44:47], v[12:15], a[120:127], v3
  v_smfmac_f32_16x16x64_bf16 v[48:51], v[12:15], a[176:183], v3
  v_smfmac_f32_16x16x64_bf16 v[52:55], v[12:15], a[232:239], v3
  v_smfmac_f32_16x16x64_bf16 v[56:59], v[12:15], v[152:159], v3
  v_smfmac_f32_16x16x64_bf16 v[60:63], v[12:15], v[208:215], v3
  v_smfmac_f32_16x16x64_bf16 v[36:39], v[16:19], a[16:23], v3
  v_smfmac_f32_16x16x64_bf16 v[40:43], v[16:19], a[72:79], v3
  v_smfmac_f32_16x16x64_bf16 v[44:47], v[16:19], a[128:135], v3
  v_smfmac_f32_16x16x64_bf16 v[48:51], v[16:19], a[184:191], v3
  v_smfmac_f32_16x16x64_bf16 v[52:55], v[16:19], a[240:247], v3
  v_smfmac_f32_16x16x64_bf16 v[56:59], v[16:19], v[160:167], v3
  v_smfmac_f32_16x16x64_bf16 v[60:63], v[16:19], v[216:223], v3
  v_smfmac_f32_16x16x64_bf16 v[36:39], v[20:23], a[24:31], v3
  v_smfmac_f32_16x16x64_bf16 v[40:43], v[20:23], a[80:87], v3
  v_smfmac_f32_16x16x64_bf16 v[44:47], v[20:23], a[136:143], v3
  v_smfmac_f32_16x16x64_bf16 v[48:51], v[20:23], a[192:199], v3
  v_smfmac_f32_16x16x64_bf16 v[52:55], v[20:23], a[248:255], v3
  v_smfmac_f32_16x16x64_bf16 v[56:59], v[20:23], v[168:175], v3
  v_smfmac_f32_16x16x64_bf16 v[60:63], v[20:23], v[224:231], v3
  s_branch cB_sc2_ph2
.p2align 6

cB_sc3_loop:
  s_add_u32 s23, s20, 4096
  s_add_u32 s21, s20, 25600
  v_mov_b32 v48, 0
  v_mov_b32 v49, 0
  v_mov_b32 v50, 0
  v_mov_b32 v51, 0
  v_mov_b32 v52, 0
  v_mov_b32 v53, 0
  v_mov_b32 v54, 0
  v_mov_b32 v55, 0
  v_mov_b32 v56, 0
  v_mov_b32 v57, 0
  v_mov_b32 v58, 0
  v_mov_b32 v59, 0
  v_mov_b32 v60, 0
  v_mov_b32 v61, 0
  v_mov_b32 v62, 0
  v_mov_b32 v63, 0
  v_mov_b32 v88, 0
  v_mov_b32 v89, 0
  v_mov_b32 v90, 0
  v_mov_b32 v91, 0
  v_mov_b32 v92, 0
  v_mov_b32 v93, 0
  v_mov_b32 v94, 0
  v_mov_b32 v95, 0
  v_mov_b32 v64, 0
  v_mov_b32 v65, 0
  s_mov_b32 s30, 0
  s_mov_b32 s62, 0
  s_waitcnt vmcnt(0)
  s_barrier
cB_sc3_ld:
  buffer_load_dwordx4 v[8:11], v2, s[8:11], s20 offen offset:0 sc1
  v_mov_b32 v36, 0
  v_mov_b32 v37, 0
  v_mov_b32 v38, 0
  v_mov_b32 v39, 0
  buffer_load_dwordx4 v[12:15], v2, s[8:11], s20 offen offset:1024 sc1
  v_mov_b32 v40, 0
  v_mov_b32 v41, 0
  v_mov_b32 v42, 0
  v_mov_b32 v43, 0
  buffer_load_dwordx4 v[16:19], v2, s[8:11], s20 offen offset:2048 sc1
  v_mov_b32 v44, 0
  v_mov_b32 v45, 0
  v_mov_b32 v46, 0
  v_mov_b32 v47, 0
  ds_read_b128 v[96:99], v117 offset:0
  ds_read_b128 v[100:103], v117 offset:1024
  ds_read_b128 v[104:107], v117 offset:14336
  ds_read_b128 v[108:111], v117 offset:15360
  s_waitcnt vmcnt(2)
  v_smfmac_f32_16x16x64_bf16 v[36:39], v[8:11], a[0:7], v3
  v_smfmac_f32_16x16x64_bf16 v[40:43], v[8:11], a[56:63], v3
  buffer_load_dwordx4 v[20:23], v2, s[8:11], s20 offen offset:3072 sc1
  v_smfmac_f32_16x16x64_bf16 v[44:47], v[8:11], a[112:119], v3
  v_smfmac_f32_16x16x64_bf16 v[48:51], v[8:11], a[168:175], v3
  v_smfmac_f32_16x16x64_bf16 v[52:55], v[8:11], a[224:231], v3
  buffer_load_dwordx4 v[24:27], v2, s[8:11], s23 offen offset:0 sc1
  v_smfmac_f32_16x16x64_bf16 v[56:59], v[8:11], v[144:151], v3
  v_smfmac_f32_16x16x64_bf16 v[60:63], v[8:11], v[200:207], v3
  s_waitcnt vmcnt(3)
  v_smfmac_f32_16x16x64_bf16 v[36:39], v[12:15], a[8:15], v3
  v_smfmac_f32_16x16x64_bf16 v[40:43], v[12:15], a[64:71], v3
  buffer_load_dwordx4 v[28:31], v2, s[8:11], s23 offen offset:1024 sc1
  v_smfmac_f32_16x16x64_bf16 v[44:47], v[12:15], a[120:127], v3
  v_smfmac_f32_16x16x64_bf16 v[48:51], v[12:15], a[176:183], v3
  v_smfmac_f32_16x16x64_bf16 v[52:55], v[12:15], a[232:239], v3
  buffer_load_dwordx4 v[32:35], v2, s[8:11], s23 offen offset:2048 sc1
  v_smfmac_f32_16x16x64_bf16 v[56:59], v[12:15], v[152:159], v3
  v_smfmac_f32_16x16x64_bf16 v[60:63], v[12:15], v[208:215], v3
  s_waitcnt vmcnt(4)
  v_smfmac_f32_16x16x64_bf16 v[36:39], v[16:19], a[16:23], v3
  v_smfmac_f32_16x16x64_bf16 v[40:43], v[16:19], a[72:79], v3
  v_smfmac_f32_16x16x64_bf16 v[44:47], v[16:19], a[128:135], v3
  v_smfmac_f32_16x16x64_bf16 v[48:51], v[16:19], a[184:191], v3
  v_smfmac_f32_16x16x64_bf16 v[52:55], v[16:19], a[240:247], v3
  v_smfmac_f32_16x16x64_bf16 v[56:59], v[16:19], v[160:167], v3
  v_smfmac_f32_16x16x64_bf16 v[60:63], v[16:19], v[216:223], v3
  s_waitcnt vmcnt(3)
  v_smfmac_f32_16x16x64_bf16 v[36:39], v[20:23], a[24:31], v3
  v_smfmac_f32_16x16x64_bf16 v[40:43], v[20:23], a[80:87], v3
  v_smfmac_f32_16x16x64_bf16 v[44:47], v[20:23], a[136:143], v3
  v_smfmac_f32_16x16x64_bf16 v[48:51], v[20:23], a[192:199], v3
  v_smfmac_f32_16x16x64_bf16 v[52:55], v[20:23], a[248:255], v3
  v_smfmac_f32_16x16x64_bf16 v[56:59], v[20:23], v[168:175], v3
  v_smfmac_f32_16x16x64_bf16 v[60:63], v[20:23], v[224:231], v3
  s_waitcnt vmcnt(0)
cB_sc3_ph2:
  v_smfmac_f32_16x16x64_bf16 v[60:63], v[24:27], v[232:239], v3
  ds_read_b128 v[8:11], v116 offset:6144
  ds_read_b128 v[12:15], v116 offset:7168
  v_smfmac_f32_16x16x64_bf16 v[60:63], v[28:31], v[240:247], v3
  v_smfmac_f32_16x16x64_bf16 v[60:63], v[32:35], v[248:255], v3
  v_mov_b32 v80, v30
  v_smfmac_f32_16x16x64_bf16 v[52:55], v[24:27], v[120:127], v3
  v_mov_b32 v81, v31
  v_smfmac_f32_16x16x64_bf16 v[52:55], v[28:31], v[128:135], v3
  v_mov_b32 v82, v34
  v_smfmac_f32_16x16x64_bf16 v[52:55], v[32:35], v[136:143], v3
  v_cvt_pk_bf16_f32 v66, v60, v61
  v_smfmac_f32_16x16x64_bf16 v[56:59], v[24:27], v[176:183], v3
  v_cvt_pk_bf16_f32 v67, v62, v63
  v_smfmac_f32_16x16x64_bf16 v[56:59], v[28:31], v[184:191], v3
  v_mov_b32 v83, v35
  v_mfma_f32_16x16x32_bf16 v[68:71], v[64:67], v[4:7], 0
  v_smfmac_f32_16x16x64_bf16 v[56:59], v[32:35], v[192:199], v3
  v_cvt_pk_bf16_f32 v64, v52, v53
  v_smfmac_f32_16x16x64_bf16 v[36:39], v[24:27], a[32:39], v3
  v_cvt_pk_bf16_f32 v65, v54, v55
  v_smfmac_f32_16x16x64_bf16 v[36:39], v[28:31], a[40:47], v3
  v_cvt_pk_bf16_f32 v78, v68, v69
  v_smfmac_f32_16x16x64_bf16 v[36:39], v[32:35], a[48:55], v3
  v_cvt_pk_bf16_f32 v79, v70, v71
  v_cvt_pk_bf16_f32 v66, v56, v57
  v_smfmac_f32_16x16x64_bf16 v[40:43], v[24:27], a[88:95], v3
  v_cvt_pk_bf16_f32 v67, v58, v59
  v_smfmac_f32_16x16x64_bf16 v[40:43], v[28:31], a[96:103], v3
  v_mfma_f32_16x16x32_bf16 v[72:75], v[64:67], v[4:7], 0
  ds_read_b128 v[52:55], v116 offset:20480
  ds_read_b128 v[56:59], v116 offset:21504
  v_smfmac_f32_16x16x64_bf16 v[40:43], v[32:35], a[104:111], v3
  v_cvt_pk_bf16_f32 v64, v36, v37
  v_smfmac_f32_16x16x64_bf16 v[44:47], v[24:27], a[144:151], v3
  v_cvt_pk_bf16_f32 v65, v38, v39
  v_smfmac_f32_16x16x64_bf16 v[44:47], v[28:31], a[152:159], v3
  v_cvt_pk_bf16_f32 v76, v72, v73
  v_smfmac_f32_16x16x64_bf16 v[44:47], v[32:35], a[160:167], v3
  v_cvt_pk_bf16_f32 v77, v74, v75
  v_cvt_pk_bf16_f32 v66, v40, v41
  v_smfmac_f32_16x16x64_bf16 v[48:51], v[24:27], a[200:207], v3
  v_cvt_pk_bf16_f32 v67, v42, v43
  v_smfmac_f32_16x16x64_bf16 v[48:51], v[28:31], a[208:215], v3
  v_mfma_f32_16x16x32_bf16 v[68:71], v[64:67], v[4:7], 0
  v_smfmac_f32_16x16x64_bf16 v[48:51], v[32:35], a[216:223], v3
  v_cvt_pk_bf16_f32 v64, v44, v45
  v_mfma_f32_16x16x32_bf16 v[84:87], v[80:83], v[76:79], 0
  v_cvt_pk_bf16_f32 v65, v46, v47
  s_waitcnt lgkmcnt(0)
  v_smfmac_f32_16x16x64_bf16 v[88:91], v[76:79], v[96:103], v3
  v_cvt_pk_bf16_f32 v60, v68, v69
  v_cvt_pk_bf16_f32 v61, v70, v71
  v_cvt_pk_bf16_f32 v66, v48, v49
  v_cvt_pk_bf16_f32 v67, v50, v51
  s_nop 1
  v_mfma_f32_16x16x32_bf16 v[72:75], v[64:67], v[4:7], 0
  v_smfmac_f32_16x16x64_bf16 v[92:95], v[76:79], v[104:111], v3
  s_nop 4
  v_cvt_pk_bf16_f32 v62, v72, v73
  v_cvt_pk_bf16_f32 v63, v74, v75
  s_nop 1
  v_mfma_f32_16x16x32_bf16 v[84:87], v[20:23], v[60:63], v[84:87]
  v_smfmac_f32_16x16x64_bf16 v[88:91], v[60:63], v[8:15], v3
  v_smfmac_f32_16x16x64_bf16 v[92:95], v[60:63], v[52:59], v3
  s_mov_b64 exec, s[26:27]
  s_nop 0
  ds_write_b128 v113, v[84:87]
  s_mov_b64 exec, -1
  s_nop 0
  v_cmp_u_f32 vcc, v88, v89
  s_nop 1
  v_permlane32_swap_b32 v88, v92
  v_permlane32_swap_b32 v89, v93
  v_permlane32_swap_b32 v90, v94
  v_permlane32_swap_b32 v91, v95
  v_add_f32 v88, v88, v92
  v_add_f32 v89, v89, v93
  v_add_f32 v90, v90, v94
  v_add_f32 v91, v91, v95
  ds_write_b128 v112, v[88:91]
  s_cbranch_vccnz cB_sc3_retry
cB_sc3_cont:
  s_waitcnt lgkmcnt(0)
  s_barrier
  ds_read_b64 v[36:37], v114 offset:0
  ds_read_b64 v[38:39], v114 offset:1024
  ds_read2_b32 v[44:45], v115 offset0:0 offset1:64
  s_waitcnt lgkmcnt(0)
  v_add_f32 v44, v44, v45
  v_add_f32 v36, v36, v38
  v_add_f32 v37, v37, v39
  v_add_f32_dpp v44, v44, v44 row_ror:8 row_mask:0xf bank_mask:0xf
  v_mov_b32 v45, v44
  v_permlane32_swap_b32 v36, v37
  v_add_f32 v36, v36, v37
  v_permlane16_swap_b32 v44, v45
  v_add_f32 v44, v44, v45
  v_exp_f32 v48, v36
  v_exp_f32 v49, v44
  v_add_f32 v50, abs(v36), abs(v44)
  v_fma_f32 v39, v49, s37, v48
  v_cmp_ngt_f32 vcc, s56, v50
  v_cndmask_b32 v41, v48, v49, s[38:39]
  v_add_f32_dpp v39, v39, v39 quad_perm:[1,0,3,2] row_mask:0xf bank_mask:0xf
  v_cndmask_b32 v40, v49, v48, s[38:39]
  v_mov_b32_dpp v46, v41 quad_perm:[1,0,3,2] row_mask:0xf bank_mask:0xf
  v_add_f32_dpp v39, v39, v39 quad_perm:[2,3,0,1] row_mask:0xf bank_mask:0xf
  v_cndmask_b32 v42, v46, v40, s[38:39]
  v_cndmask_b32 v43, v40, v46, s[38:39]
  v_add_f32_dpp v39, v39, v39 row_half_mirror row_mask:0xf bank_mask:0xf
  s_cbranch_vccnz cB_sc3_slow
  s_nop 0
  v_add_f32_dpp v39, v39, v39 row_mirror row_mask:0xf bank_mask:0xf
  v_mov_b32 v47, v39
  s_nop 1
  v_permlane16_swap_b32 v39, v47
  v_add_f32 v39, v39, v47
  v_rcp_f32 v39, v39
  s_mov_b64 exec, s[28:29]
  v_mul_f32 v42, v42, v39
  v_mul_f32 v43, v43, v39
  v_cvt_pk_bf16_f32 v42, v42, v43
cB_sc3_pst:
  buffer_store_dword v42, v1, s[8:11], s20 offen sc1
  s_mov_b64 exec, -1
  s_barrier
  s_add_u32 s24, s24, 28672
  s_add_u32 s35, s35, 28672
  s_xor_b32 s25, s25, 28672
  s_add_u32 m0, s25, 21504
  s_nop 0
  buffer_load_dwordx4 v2, s[8:11], s24 offen offset:0 sc1 lds
  buffer_load_dwordx4 v2, s[8:11], s24 offen offset:1024 sc1 lds
  buffer_load_dwordx4 v2, s[8:11], s24 offen offset:2048 sc1 lds
  buffer_load_dwordx4 v2, s[8:11], s24 offen offset:3072 sc1 lds
  s_add_u32 m0, s25, 25600
  s_add_u32 s22, s24, 4096
  buffer_load_dwordx4 v2, s[8:11], s22 offen offset:0 sc1 lds
  buffer_load_dwordx4 v2, s[8:11], s22 offen offset:1024 sc1 lds
  buffer_load_dwordx4 v2, s[8:11], s22 offen offset:2048 sc1 lds
  v_xor_b32 v116, 28672, v116
  v_add_u32 v117, s57, v117
  s_sub_u32 s57, 0, s57
  s_add_u32 s19, s19, 1
  s_mov_b32 s20, s21
  s_cmp_lt_u32 s19, 63
  s_cbranch_scc1 cB_sc3_loop
  s_branch cB_done
cB_sc3_slow:
  v_max_f32 v50, v36, v44
  s_nop 1
  v_max_f32_dpp v50, v50, v50 quad_perm:[1,0,3,2] row_mask:0xf bank_mask:0xf
  s_nop 1
  v_max_f32_dpp v50, v50, v50 quad_perm:[2,3,0,1] row_mask:0xf bank_mask:0xf
  s_nop 1
  v_max_f32_dpp v50, v50, v50 row_half_mirror row_mask:0xf bank_mask:0xf
  s_nop 1
  v_max_f32_dpp v50, v50, v50 row_mirror row_mask:0xf bank_mask:0xf
  v_mov_b32 v47, v50
  s_nop 1
  v_permlane16_swap_b32 v50, v47
  v_max_f32 v50, v50, v47
  v_sub_f32 v48, v36, v50
  v_sub_f32 v49, v44, v50
  v_exp_f32 v48, v48
  v_exp_f32 v49, v49
  s_add_u32 s31, s31, 0x100
  v_fma_f32 v39, v49, s37, v48
  v_cndmask_b32 v41, v48, v49, s[38:39]
  s_nop 0
  v_add_f32_dpp v39, v39, v39 quad_perm:[1,0,3,2] row_mask:0xf bank_mask:0xf
  v_cndmask_b32 v40, v49, v48, s[38:39]
  v_mov_b32_dpp v46, v41 quad_perm:[1,0,3,2] row_mask:0xf bank_mask:0xf
  v_add_f32_dpp v39, v39, v39 quad_perm:[2,3,0,1] row_mask:0xf bank_mask:0xf
  v_cndmask_b32 v42, v46, v40, s[38:39]
  v_cndmask_b32 v43, v40, v46, s[38:39]
  v_add_f32_dpp v39, v39, v39 row_half_mirror row_mask:0xf bank_mask:0xf
  s_nop 1
  v_add_f32_dpp v39, v39, v39 row_mirror row_mask:0xf bank_mask:0xf
  v_mov_b32 v47, v39
  s_nop 1
  v_permlane16_swap_b32 v39, v47
  v_add_f32 v39, v39, v47
  v_rcp_f32 v39, v39
  s_mov_b64 exec, s[28:29]
  v_mul_f32 v42, v42, v39
  v_mul_f32 v43, v43, v39
  v_cvt_pk_bf16_f32 v42, v42, v43
  v_min_u32 v42, -2, v42
  s_branch cB_sc3_pst
cB_sc3_retry:
  s_cmp_lg_u32 s62, 0
  s_cbranch_scc1 cB_sc3_cont
  s_waitcnt vmcnt(0) lgkmcnt(0)
cB_sc3_rv:
  buffer_load_dwordx4 v[8:11], v2, s[8:11], s20 offen offset:0 sc1
  buffer_load_dwordx4 v[12:15], v2, s[8:11], s20 offen offset:1024 sc1
  buffer_load_dwordx4 v[16:19], v2, s[8:11], s20 offen offset:2048 sc1
  buffer_load_dwordx4 v[20:23], v2, s[8:11], s20 offen offset:3072 sc1
  buffer_load_dwordx4 v[24:27], v2, s[8:11], s23 offen offset:0 sc1
  buffer_load_dwordx4 v[28:31], v2, s[8:11], s23 offen offset:1024 sc1
  buffer_load_dwordx4 v[32:35], v2, s[8:11], s23 offen offset:2048 sc1
  s_waitcnt vmcnt(0)
  v_max3_u32 v118, v8, v9, v10
  v_max3_u32 v118, v118, v11, v12
  v_max3_u32 v118, v118, v13, v14
  v_max3_u32 v118, v118, v15, v16
  v_max3_u32 v118, v118, v17, v18
  v_max3_u32 v118, v118, v19, v20
  v_max3_u32 v118, v118, v21, v22
  v_max3_u32 v118, v118, v23, v24
  v_max3_u32 v118, v118, v25, v26
  v_max3_u32 v118, v118, v27, v28
  v_max3_u32 v118, v118, v29, v30
  v_max3_u32 v118, v118, v31, v32
  v_max3_u32 v118, v118, v33, v34
  v_max_u32 v118, v118, v35
  v_cmp_eq_u32 vcc, -1, v118
  s_cbranch_vccz cB_sc3_rk
  s_add_u32 s30, s30, 1
  s_cmp_lt_u32 s30, 400000
  s_cbranch_scc1 cB_sc3_rv
  s_branch cB_abort
cB_sc3_rk:
  s_mov_b32 s62, 1
  v_mov_b32 v36, 0
  v_mov_b32 v37, 0
  v_mov_b32 v38, 0
  v_mov_b32 v39, 0
  v_mov_b32 v40, 0
  v_mov_b32 v41, 0
  v_mov_b32 v42, 0
  v_mov_b32 v43, 0
  v_mov_b32 v44, 0
  v_mov_b32 v45, 0
  v_mov_b32 v46, 0
  v_mov_b32 v47, 0
  v_mov_b32 v48, 0
  v_mov_b32 v49, 0
  v_mov_b32 v50, 0
  v_mov_b32 v51, 0
  v_mov_b32 v52, 0
  v_mov_b32 v53, 0
  v_mov_b32 v54, 0
  v_mov_b32 v55, 0
  v_mov_b32 v56, 0
  v_mov_b32 v57, 0
  v_mov_b32 v58, 0
  v_mov_b32 v59, 0
  v_mov_b32 v60, 0
  v_mov_b32 v61, 0
  v_mov_b32 v62, 0
  v_mov_b32 v63, 0
  v_mov_b32 v88, 0
  v_mov_b32 v89, 0
  v_mov_b32 v90, 0
  v_mov_b32 v91, 0
  v_mov_b32 v92, 0
  v_mov_b32 v93, 0
  v_mov_b32 v94, 0
  v_mov_b32 v95, 0
  v_mov_b32 v64, 0
  v_mov_b32 v65, 0
  s_add_u32 s31, s31, 1
  ds_read_b128 v[96:99], v117 offset:0
  ds_read_b128 v[100:103], v117 offset:1024
  ds_read_b128 v[104:107], v117 offset:14336
  ds_read_b128 v[108:111], v117 offset:15360
  v_smfmac_f32_16x16x64_bf16 v[36:39], v[8:11], a[0:7], v3
  v_smfmac_f32_16x16x64_bf16 v[40:43], v[8:11], a[56:63], v3
  v_smfmac_f32_16x16x64_bf16 v[44:47], v[8:11], a[112:119], v3
  v_smfmac_f32_16x16x64_bf16 v[48:51], v[8:11], a[168:175], v3
  v_smfmac_f32_16x16x64_bf16 v[52:55], v[8:11], a[224:231], v3
  v_smfmac_f32_16x16x64_bf16 v[56:59], v[8:11], v[144:151], v3
  v_smfmac_f32_16x16x64_bf16 v[60:63], v[8:11], v[200:207], v3
  v_smfmac_f32_16x16x64_bf16 v[36:39], v[12:15], a[8:15], v3
  v_smfmac_f32_16x16x64_bf16 v[40:43], v[12:15], a[64:71], v3
  v_smfmac_f32_16x16x64_bf16 v[44:47], v[12:15], a[120:127], v3
  v_smfmac_f32_16x16x64_bf16 v[48:51], v[12:15], a[176:183], v3
  v_smfmac_f32_16x16x64_bf16 v[52:55], v[12:15], a[232:239], v3
  v_smfmac_f32_16x16x64_bf16 v[56:59], v[12:15], v[152:159], v3
  v_smfmac_f32_16x16x64_bf16 v[60:63], v[12:15], v[208:215], v3
  v_smfmac_f32_16x16x64_bf16 v[36:39], v[16:19], a[16:23], v3
  v_smfmac_f32_16x16x64_bf16 v[40:43], v[16:19], a[72:79], v3
  v_smfmac_f32_16x16x64_bf16 v[44:47], v[16:19], a[128:135], v3
  v_smfmac_f32_16x16x64_bf16 v[48:51], v[16:19], a[184:191], v3
  v_smfmac_f32_16x16x64_bf16 v[52:55], v[16:19], a[240:247], v3
  v_smfmac_f32_16x16x64_bf16 v[56:59], v[16:19], v[160:167], v3
  v_smfmac_f32_16x16x64_bf16 v[60:63], v[16:19], v[216:223], v3
  v_smfmac_f32_16x16x64_bf16 v[36:39], v[20:23], a[24:31], v3
  v_smfmac_f32_16x16x64_bf16 v[40:43], v[20:23], a[80:87], v3
  v_smfmac_f32_16x16x64_bf16 v[44:47], v[20:23], a[136:143], v3
  v_smfmac_f32_16x16x64_bf16 v[48:51], v[20:23], a[192:199], v3
  v_smfmac_f32_16x16x64_bf16 v[52:55], v[20:23], a[248:255], v3
  v_smfmac_f32_16x16x64_bf16 v[56:59], v[20:23], v[168:175], v3
  v_smfmac_f32_16x16x64_bf16 v[60:63], v[20:23], v[224:231], v3
  s_branch cB_sc3_ph2
.p2align 6

cB_va0_loop:
  s_add_u32 s23, s20, 4096
  s_add_u32 s21, s20, 25600
  s_mov_b32 s30, 0
  s_cmp_lg_u32 s19, s38
  s_cbranch_scc1 cB_va0_vok
  s_branch cB_va0_voc
cB_va0_vow:
  buffer_load_dword v175, off, s[8:11], s35 sc1
  s_waitcnt vmcnt(0)
cB_va0_voc:
  v_readfirstlane_b32 s22, v175
  s_cmp_eq_u32 s22, 56
  s_cbranch_scc1 cB_va0_vod
  s_sleep 1
  s_add_u32 s30, s30, 1
  s_cmp_lt_u32 s30, 400000
  s_cbranch_scc1 cB_va0_vow
  s_branch cB_abort
cB_va0_vod:
  s_add_u32 s35, s35, 2048
  s_add_u32 s38, s19, 8
  s_and_b32 s38, s38, -8
  s_cmp_eq_u32 s19, 0
  s_cselect_b32 s38, 4, s38
cB_va0_vok:
  s_cmp_eq_u32 s19, 63
  s_cbranch_scc1 cB_done
  s_barrier
  s_add_u32 s22, s25, 0
  buffer_load_dwordx4 v[80:83], v6, s[8:11], s22 offen offset:0 sc1
  buffer_load_dwordx4 v[84:87], v6, s[8:11], s22 offen offset:1792 sc1
  s_add_u32 s22, s25, 3584
  buffer_load_dwordx4 v[88:91], v6, s[8:11], s22 offen offset:0 sc1
  buffer_load_dwordx4 v[92:95], v6, s[8:11], s22 offen offset:1792 sc1
  s_add_u32 s22, s25, 7168
  buffer_load_dwordx4 v[96:99], v6, s[8:11], s22 offen offset:0 sc1
  buffer_load_dwordx4 v[100:103], v6, s[8:11], s22 offen offset:1792 sc1
  s_add_u32 s22, s25, 10752
  buffer_load_dwordx4 v[104:107], v6, s[8:11], s22 offen offset:0 sc1
  buffer_load_dwordx4 v[108:111], v6, s[8:11], s22 offen offset:1792 sc1
  s_add_u32 s22, s25, 14336
  buffer_load_dwordx4 v[112:115], v6, s[8:11], s22 offen offset:0 sc1
  buffer_load_dwordx4 v[116:119], v6, s[8:11], s22 offen offset:1792 sc1
  s_add_u32 s22, s25, 17920
  buffer_load_dwordx4 v[120:123], v6, s[8:11], s22 offen offset:0 sc1
  buffer_load_dwordx4 v[124:127], v6, s[8:11], s22 offen offset:1792 sc1
  s_add_u32 s22, s25, 21504
  buffer_load_dwordx4 v[128:131], v6, s[8:11], s22 offen offset:0 sc1
  buffer_load_dwordx4 v[132:135], v6, s[8:11], s22 offen offset:1792 sc1
  s_add_u32 s22, s25, 25088
  buffer_load_dwordx4 v[136:139], v6, s[8:11], s22 offen offset:0 sc1
  buffer_load_dwordx4 v[140:143], v6, s[8:11], s22 offen offset:1792 sc1
  buffer_load_dword v175, off, s[8:11], s35 sc1
  s_barrier
  ds_read_b128 v[8:11], v2 offset:8192
  ds_read_b128 v[12:15], v2 offset:9216
  ds_read_b128 v[16:19], v2 offset:10240
  ds_read_b128 v[20:23], v2 offset:11264
  ds_read_b128 v[24:27], v2 offset:12288
  ds_read_b128 v[28:31], v2 offset:13312
  ds_read_b128 v[32:35], v2 offset:14336
  s_waitcnt lgkmcnt(0)
  v_smfmac_f32_16x16x64_bf16 v[36:39], v[8:11], a[0:7], v3
  v_smfmac_f32_16x16x64_bf16 v[36:39], v[12:15], a[8:15], v3
  v_smfmac_f32_16x16x64_bf16 v[36:39], v[16:19], a[16:23], v3
  v_smfmac_f32_16x16x64_bf16 v[36:39], v[20:23], a[24:31], v3
  v_smfmac_f32_16x16x64_bf16 v[36:39], v[24:27], a[32:39], v3
  v_smfmac_f32_16x16x64_bf16 v[36:39], v[28:31], a[40:47], v3
  v_smfmac_f32_16x16x64_bf16 v[36:39], v[32:35], a[48:55], v3
  v_smfmac_f32_16x16x64_bf16 v[40:43], v[8:11], a[56:63], v3
  v_smfmac_f32_16x16x64_bf16 v[40:43], v[12:15], a[64:71], v3
  v_smfmac_f32_16x16x64_bf16 v[40:43], v[16:19], a[72:79], v3
  v_smfmac_f32_16x16x64_bf16 v[40:43], v[20:23], a[80:87], v3
  v_smfmac_f32_16x16x64_bf16 v[40:43], v[24:27], a[88:95], v3
  v_smfmac_f32_16x16x64_bf16 v[40:43], v[28:31], a[96:103], v3
  v_smfmac_f32_16x16x64_bf16 v[40:43], v[32:35], a[104:111], v3
  v_smfmac_f32_16x16x64_bf16 v[44:47], v[8:11], a[112:119], v3
  v_smfmac_f32_16x16x64_bf16 v[44:47], v[12:15], a[120:127], v3
  v_smfmac_f32_16x16x64_bf16 v[44:47], v[16:19], a[128:135], v3
  v_smfmac_f32_16x16x64_bf16 v[44:47], v[20:23], a[136:143], v3
  v_permlane32_swap_b32 v36, v40
  v_smfmac_f32_16x16x64_bf16 v[44:47], v[24:27], a[144:151], v3
  v_permlane32_swap_b32 v37, v41
  v_smfmac_f32_16x16x64_bf16 v[44:47], v[28:31], a[152:159], v3
  v_permlane32_swap_b32 v38, v42
  v_smfmac_f32_16x16x64_bf16 v[44:47], v[32:35], a[160:167], v3
  v_permlane32_swap_b32 v39, v43
  v_smfmac_f32_16x16x64_bf16 v[48:51], v[8:11], a[168:175], v3
  v_add_f32 v36, v36, v40
  v_smfmac_f32_16x16x64_bf16 v[48:51], v[12:15], a[176:183], v3
  v_add_f32 v37, v37, v41
  v_smfmac_f32_16x16x64_bf16 v[48:51], v[16:19], a[184:191], v3
  v_add_f32 v38, v38, v42
  v_smfmac_f32_16x16x64_bf16 v[48:51], v[20:23], a[192:199], v3
  v_add_f32 v39, v39, v43
  v_smfmac_f32_16x16x64_bf16 v[48:51], v[24:27], a[200:207], v3
  v_cvt_pk_bf16_f32 v40, v36, v37
  v_smfmac_f32_16x16x64_bf16 v[48:51], v[28:31], a[208:215], v3
  v_cvt_pk_bf16_f32 v41, v38, v39
  v_smfmac_f32_16x16x64_bf16 v[48:51], v[32:35], a[216:223], v3
  ds_write_b64 v60, v[40:41]
  v_smfmac_f32_16x16x64_bf16 v[52:55], v[8:11], a[224:231], v3
  v_smfmac_f32_16x16x64_bf16 v[52:55], v[12:15], a[232:239], v3
  v_smfmac_f32_16x16x64_bf16 v[52:55], v[16:19], a[240:247], v3
  v_smfmac_f32_16x16x64_bf16 v[52:55], v[20:23], a[248:255], v3
  v_permlane32_swap_b32 v44, v48
  v_smfmac_f32_16x16x64_bf16 v[52:55], v[24:27], v[176:183], v3
  v_permlane32_swap_b32 v45, v49
  v_smfmac_f32_16x16x64_bf16 v[52:55], v[28:31], v[184:191], v3
  v_permlane32_swap_b32 v46, v50
  v_smfmac_f32_16x16x64_bf16 v[52:55], v[32:35], v[192:199], v3
  v_permlane32_swap_b32 v47, v51
  v_smfmac_f32_16x16x64_bf16 v[56:59], v[8:11], v[200:207], v3
  v_add_f32 v44, v44, v48
  v_smfmac_f32_16x16x64_bf16 v[56:59], v[12:15], v[208:215], v3
  v_add_f32 v45, v45, v49
  v_smfmac_f32_16x16x64_bf16 v[56:59], v[16:19], v[216:223], v3
  v_add_f32 v46, v46, v50
  v_smfmac_f32_16x16x64_bf16 v[56:59], v[20:23], v[224:231], v3
  v_add_f32 v47, v47, v51
  v_smfmac_f32_16x16x64_bf16 v[56:59], v[24:27], v[232:239], v3
  v_cvt_pk_bf16_f32 v48, v44, v45
  v_smfmac_f32_16x16x64_bf16 v[56:59], v[28:31], v[240:247], v3
  v_cvt_pk_bf16_f32 v49, v46, v47
  v_smfmac_f32_16x16x64_bf16 v[56:59], v[32:35], v[248:255], v3
  ds_write_b64 v61, v[48:49]
  s_nop 6
  v_permlane32_swap_b32 v52, v56
  v_permlane32_swap_b32 v53, v57
  v_permlane32_swap_b32 v54, v58
  v_permlane32_swap_b32 v55, v59
  v_add_f32 v52, v52, v56
  v_add_f32 v53, v53, v57
  v_add_f32 v54, v54, v58
  v_add_f32 v55, v55, v59
  v_cvt_pk_bf16_f32 v56, v52, v53
  v_cvt_pk_bf16_f32 v57, v54, v55
  ds_write_b64 v62, v[56:57]
  s_cmp_eq_u32 s19, 63
  s_cbranch_scc1 cB_va0_last
  s_add_u32 s22, s20, 9216
  s_add_u32 s34, s20, 13312
  s_add_u32 s36, s20, 7168
  s_mov_b32 s37, 0
  v_mov_b32 v156, 0
  v_mov_b32 v157, 0
  v_mov_b32 v158, 0
  v_mov_b32 v159, 0
  buffer_load_dword v164, v4, s[8:11], s20 offen sc1
  s_nop 7
  buffer_load_dword v165, v4, s[8:11], s20 offen sc1
  s_nop 7
  buffer_load_dword v166, v4, s[8:11], s20 offen sc1
  s_nop 7
  buffer_load_dword v167, v4, s[8:11], s20 offen sc1
  s_nop 7
  buffer_load_dword v168, v4, s[8:11], s20 offen sc1
cB_va0_fw_l:
  s_waitcnt vmcnt(4)
  v_cmp_eq_u32 vcc, -1, v164
  s_cbranch_vccz cB_va0_fw_d
  buffer_load_dword v164, v4, s[8:11], s20 offen sc1
  s_waitcnt vmcnt(4)
  v_cmp_eq_u32 vcc, -1, v165
  s_cbranch_vccz cB_va0_fw_d
  buffer_load_dword v165, v4, s[8:11], s20 offen sc1
  s_waitcnt vmcnt(4)
  v_cmp_eq_u32 vcc, -1, v166
  s_cbranch_vccz cB_va0_fw_d
  buffer_load_dword v166, v4, s[8:11], s20 offen sc1
  s_waitcnt vmcnt(4)
  v_cmp_eq_u32 vcc, -1, v167
  s_cbranch_vccz cB_va0_fw_d
  buffer_load_dword v167, v4, s[8:11], s20 offen sc1
  s_waitcnt vmcnt(4)
  v_cmp_eq_u32 vcc, -1, v168
  s_cbranch_vccz cB_va0_fw_d
  buffer_load_dword v168, v4, s[8:11], s20 offen sc1
  s_add_u32 s30, s30, 1
  s_cmp_lt_u32 s30, 400000
  s_cbranch_scc1 cB_va0_fw_l
  s_branch cB_abort
cB_va0_fw_d:
  s_waitcnt lgkmcnt(0)
  buffer_load_dwordx4 v[8:11], v2, s[8:11], s22 offen offset:0 sc1
  v_mov_b32 v36, 0
  v_mov_b32 v37, 0
  v_mov_b32 v38, 0
  buffer_load_dwordx4 v[12:15], v2, s[8:11], s22 offen offset:1024 sc1
  v_mov_b32 v39, 0
  v_mov_b32 v40, 0
  v_mov_b32 v41, 0
  buffer_load_dwordx4 v[16:19], v2, s[8:11], s22 offen offset:2048 sc1
  v_mov_b32 v42, 0
  v_mov_b32 v43, 0
  v_mov_b32 v44, 0
  buffer_load_dwordx4 v[20:23], v2, s[8:11], s22 offen offset:3072 sc1
  v_mov_b32 v45, 0
  v_mov_b32 v46, 0
  v_mov_b32 v47, 0
  buffer_load_dwordx4 v[24:27], v2, s[8:11], s34 offen offset:0 sc1
  v_mov_b32 v48, 0
  v_mov_b32 v49, 0
  v_mov_b32 v50, 0
  buffer_load_dwordx4 v[28:31], v2, s[8:11], s34 offen offset:1024 sc1
  v_mov_b32 v51, 0
  v_mov_b32 v52, 0
  v_mov_b32 v53, 0
  buffer_load_dwordx4 v[32:35], v2, s[8:11], s34 offen offset:2048 sc1
  v_mov_b32 v54, 0
  v_mov_b32 v55, 0
  v_mov_b32 v56, 0
  buffer_load_dwordx4 v[144:147], v2, s[8:11], s34 offen offset:3072 sc1
  v_mov_b32 v57, 0
  v_mov_b32 v58, 0
  v_mov_b32 v59, 0
  buffer_load_dwordx4 v[148:151], v2, s[8:11], s36 offen offset:0 sc1
  buffer_load_dwordx4 v[152:155], v2, s[8:11], s36 offen offset:1024 sc1
  s_barrier
  ds_read_b128 v[64:67], v2 offset:0
  ds_read_b128 v[68:71], v2 offset:1024
  ds_read_b128 v[72:75], v2 offset:2048
  ds_read_b128 v[76:79], v2 offset:3072
  s_waitcnt vmcnt(9)
  v_smfmac_f32_16x16x64_bf16 v[156:159], v[8:11], v[80:87], v3
  s_waitcnt vmcnt(8)
  v_smfmac_f32_16x16x64_bf16 v[156:159], v[12:15], v[88:95], v3
  s_waitcnt vmcnt(7)
  v_smfmac_f32_16x16x64_bf16 v[156:159], v[16:19], v[96:103], v3
  s_waitcnt vmcnt(6)
  v_smfmac_f32_16x16x64_bf16 v[156:159], v[20:23], v[104:111], v3
  s_waitcnt vmcnt(5)
  v_smfmac_f32_16x16x64_bf16 v[156:159], v[24:27], v[112:119], v3
  s_mov_b32 exec_hi, 0
  buffer_store_dword v2, v7, s[8:11], s21 offen sc1
  s_mov_b64 exec, -1
  s_waitcnt vmcnt(5)
  v_smfmac_f32_16x16x64_bf16 v[156:159], v[28:31], v[120:127], v3
  s_waitcnt vmcnt(4)
  v_smfmac_f32_16x16x64_bf16 v[156:159], v[32:35], v[128:135], v3
  s_waitcnt vmcnt(3)
  v_smfmac_f32_16x16x64_bf16 v[156:159], v[144:147], v[136:143], v3
  s_waitcnt vmcnt(2) lgkmcnt(0)
  v_smfmac_f32_16x16x64_bf16 v[156:159], v[148:151], v[64:71], v3
  s_waitcnt vmcnt(1)
  v_smfmac_f32_16x16x64_bf16 v[156:159], v[152:155], v[72:79], v3
cB_va0_ep:
  s_nop 7
  v_permlane32_swap_b32 v156, v158
  v_permlane32_swap_b32 v157, v159
  v_add_f32 v160, v156, v158
  v_add_f32 v161, v157, v159
  v_cmp_u_f32 vcc, v160, v161
  v_mov_b32_dpp v162, v160 row_ror:8 row_mask:0xf bank_mask:0xf
  v_mov_b32_dpp v160, v161 row_ror:8 row_mask:0xf bank_mask:0xc
  s_cbranch_vccnz cB_va0_rp
  v_mov_b32_dpp v161, v162 quad_perm:[0,1,2,3] row_mask:0xf bank_mask:0x3
  v_cvt_pk_bf16_f32 v160, v160, v161
cB_va0_pc:
  buffer_store_dword v160, v1, s[8:11], s21 offen sc1
  s_cmp_lg_u32 s19, 62
  s_cbranch_scc1 cB_va0_nl
  s_mov_b32 s22, 88519680
  buffer_store_dword v160, v1, s[8:11], s22 offen sc1
  s_mov_b64 exec, -1
  s_branch cB_done
cB_va0_nl:
  s_mov_b64 exec, -1
  s_add_u32 s25, s25, 28672
  s_add_u32 s19, s19, 1
  s_mov_b32 s20, s21
  s_branch cB_va0_loop
cB_va0_last:
  s_waitcnt lgkmcnt(0)
  s_barrier
  s_branch cB_done
cB_va0_rp:
  s_cmp_eq_u32 s37, 0
  s_cbranch_scc1 cB_va0_rv
  v_mov_b32_dpp v161, v162 quad_perm:[0,1,2,3] row_mask:0xf bank_mask:0x3
  v_cvt_pk_bf16_f32 v160, v160, v161
  v_min_u32 v160, -2, v160
  s_branch cB_va0_pc
cB_va0_rv:
  buffer_load_dwordx4 v[8:11], v2, s[8:11], s22 offen offset:0 sc1
  buffer_load_dwordx4 v[12:15], v2, s[8:11], s22 offen offset:1024 sc1
  buffer_load_dwordx4 v[16:19], v2, s[8:11], s22 offen offset:2048 sc1
  buffer_load_dwordx4 v[20:23], v2, s[8:11], s22 offen offset:3072 sc1
  buffer_load_dwordx4 v[24:27], v2, s[8:11], s34 offen offset:0 sc1
  buffer_load_dwordx4 v[28:31], v2, s[8:11], s34 offen offset:1024 sc1
  buffer_load_dwordx4 v[32:35], v2, s[8:11], s34 offen offset:2048 sc1
  buffer_load_dwordx4 v[144:147], v2, s[8:11], s34 offen offset:3072 sc1
  buffer_load_dwordx4 v[148:151], v2, s[8:11], s36 offen offset:0 sc1
  buffer_load_dwordx4 v[152:155], v2, s[8:11], s36 offen offset:1024 sc1
  s_waitcnt vmcnt(0)
  v_max3_u32 v63, v8, v9, v10
  v_max3_u32 v63, v63, v11, v12
  v_max3_u32 v63, v63, v13, v14
  v_max3_u32 v63, v63, v15, v16
  v_max3_u32 v63, v63, v17, v18
  v_max3_u32 v63, v63, v19, v20
  v_max3_u32 v63, v63, v21, v22
  v_max3_u32 v63, v63, v23, v24
  v_max3_u32 v63, v63, v25, v26
  v_max3_u32 v63, v63, v27, v28
  v_max3_u32 v63, v63, v29, v30
  v_max3_u32 v63, v63, v31, v32
  v_max3_u32 v63, v63, v33, v34
  v_max3_u32 v63, v63, v35, v144
  v_max3_u32 v63, v63, v145, v146
  v_max3_u32 v63, v63, v147, v148
  v_max3_u32 v63, v63, v149, v150
  v_max3_u32 v63, v63, v151, v152
  v_max3_u32 v63, v63, v153, v154
  v_max_u32 v63, v63, v155
  v_cmp_eq_u32 vcc, -1, v63
  s_cbranch_vccz cB_va0_rk
  s_add_u32 s30, s30, 1
  s_cmp_lt_u32 s30, 400000
  s_cbranch_scc1 cB_va0_rv
  s_branch cB_abort
cB_va0_rk:
  s_mov_b32 s37, 1
  s_add_u32 s31, s31, 0x10000
  v_mov_b32 v156, 0
  v_mov_b32 v157, 0
  v_mov_b32 v158, 0
  v_mov_b32 v159, 0
  s_nop 1
  v_smfmac_f32_16x16x64_bf16 v[156:159], v[8:11], v[80:87], v3
  v_smfmac_f32_16x16x64_bf16 v[156:159], v[12:15], v[88:95], v3
  v_smfmac_f32_16x16x64_bf16 v[156:159], v[16:19], v[96:103], v3
  v_smfmac_f32_16x16x64_bf16 v[156:159], v[20:23], v[104:111], v3
  v_smfmac_f32_16x16x64_bf16 v[156:159], v[24:27], v[112:119], v3
  v_smfmac_f32_16x16x64_bf16 v[156:159], v[28:31], v[120:127], v3
  v_smfmac_f32_16x16x64_bf16 v[156:159], v[32:35], v[128:135], v3
  v_smfmac_f32_16x16x64_bf16 v[156:159], v[144:147], v[136:143], v3
  v_smfmac_f32_16x16x64_bf16 v[156:159], v[148:151], v[64:71], v3
  v_smfmac_f32_16x16x64_bf16 v[156:159], v[152:155], v[72:79], v3
  s_nop 7
  s_branch cB_va0_ep
.p2align 6

cB_va1_loop:
  s_add_u32 s23, s20, 4096
  s_add_u32 s21, s20, 25600
  s_mov_b32 s30, 0
  s_cmp_lg_u32 s19, s38
  s_cbranch_scc1 cB_va1_vok
  s_branch cB_va1_voc
cB_va1_vow:
  buffer_load_dword v175, off, s[8:11], s35 sc1
  s_waitcnt vmcnt(0)
cB_va1_voc:
  v_readfirstlane_b32 s22, v175
  s_cmp_eq_u32 s22, 56
  s_cbranch_scc1 cB_va1_vod
  s_sleep 1
  s_add_u32 s30, s30, 1
  s_cmp_lt_u32 s30, 400000
  s_cbranch_scc1 cB_va1_vow
  s_branch cB_abort
cB_va1_vod:
  s_add_u32 s35, s35, 2048
  s_add_u32 s38, s19, 8
  s_and_b32 s38, s38, -8
  s_cmp_eq_u32 s19, 0
  s_cselect_b32 s38, 4, s38
cB_va1_vok:
  s_cmp_eq_u32 s19, 63
  s_cbranch_scc1 cB_done
  s_barrier
  s_add_u32 s22, s25, 0
  buffer_load_dwordx4 v[80:83], v6, s[8:11], s22 offen offset:0 sc1
  buffer_load_dwordx4 v[84:87], v6, s[8:11], s22 offen offset:1792 sc1
  s_add_u32 s22, s25, 3584
  buffer_load_dwordx4 v[88:91], v6, s[8:11], s22 offen offset:0 sc1
  buffer_load_dwordx4 v[92:95], v6, s[8:11], s22 offen offset:1792 sc1
  s_add_u32 s22, s25, 7168
  buffer_load_dwordx4 v[96:99], v6, s[8:11], s22 offen offset:0 sc1
  buffer_load_dwordx4 v[100:103], v6, s[8:11], s22 offen offset:1792 sc1
  s_add_u32 s22, s25, 10752
  buffer_load_dwordx4 v[104:107], v6, s[8:11], s22 offen offset:0 sc1
  buffer_load_dwordx4 v[108:111], v6, s[8:11], s22 offen offset:1792 sc1
  s_add_u32 s22, s25, 14336
  buffer_load_dwordx4 v[112:115], v6, s[8:11], s22 offen offset:0 sc1
  buffer_load_dwordx4 v[116:119], v6, s[8:11], s22 offen offset:1792 sc1
  s_add_u32 s22, s25, 17920
  buffer_load_dwordx4 v[120:123], v6, s[8:11], s22 offen offset:0 sc1
  buffer_load_dwordx4 v[124:127], v6, s[8:11], s22 offen offset:1792 sc1
  s_add_u32 s22, s25, 21504
  buffer_load_dwordx4 v[128:131], v6, s[8:11], s22 offen offset:0 sc1
  buffer_load_dwordx4 v[132:135], v6, s[8:11], s22 offen offset:1792 sc1
  s_add_u32 s22, s25, 25088
  buffer_load_dwordx4 v[136:139], v6, s[8:11], s22 offen offset:0 sc1
  buffer_load_dwordx4 v[140:143], v6, s[8:11], s22 offen offset:1792 sc1
  buffer_load_dword v175, off, s[8:11], s35 sc1
  s_barrier
  ds_read_b128 v[8:11], v2 offset:8192
  ds_read_b128 v[12:15], v2 offset:9216
  ds_read_b128 v[16:19], v2 offset:10240
  ds_read_b128 v[20:23], v2 offset:11264
  ds_read_b128 v[24:27], v2 offset:12288
  ds_read_b128 v[28:31], v2 offset:13312
  ds_read_b128 v[32:35], v2 offset:14336
  s_waitcnt lgkmcnt(0)
  v_smfmac_f32_16x16x64_bf16 v[36:39], v[8:11], a[0:7], v3
  v_smfmac_f32_16x16x64_bf16 v[36:39], v[12:15], a[8:15], v3
  v_smfmac_f32_16x16x64_bf16 v[36:39], v[16:19], a[16:23], v3
  v_smfmac_f32_16x16x64_bf16 v[36:39], v[20:23], a[24:31], v3
  v_smfmac_f32_16x16x64_bf16 v[36:39], v[24:27], a[32:39], v3
  v_smfmac_f32_16x16x64_bf16 v[36:39], v[28:31], a[40:47], v3
  v_smfmac_f32_16x16x64_bf16 v[36:39], v[32:35], a[48:55], v3
  v_smfmac_f32_16x16x64_bf16 v[40:43], v[8:11], a[56:63], v3
  v_smfmac_f32_16x16x64_bf16 v[40:43], v[12:15], a[64:71], v3
  v_smfmac_f32_16x16x64_bf16 v[40:43], v[16:19], a[72:79], v3
  v_smfmac_f32_16x16x64_bf16 v[40:43], v[20:23], a[80:87], v3
  v_smfmac_f32_16x16x64_bf16 v[40:43], v[24:27], a[88:95], v3
  v_smfmac_f32_16x16x64_bf16 v[40:43], v[28:31], a[96:103], v3
  v_smfmac_f32_16x16x64_bf16 v[40:43], v[32:35], a[104:111], v3
  v_smfmac_f32_16x16x64_bf16 v[44:47], v[8:11], a[112:119], v3
  v_smfmac_f32_16x16x64_bf16 v[44:47], v[12:15], a[120:127], v3
  v_smfmac_f32_16x16x64_bf16 v[44:47], v[16:19], a[128:135], v3
  v_smfmac_f32_16x16x64_bf16 v[44:47], v[20:23], a[136:143], v3
  v_permlane32_swap_b32 v36, v40
  v_smfmac_f32_16x16x64_bf16 v[44:47], v[24:27], a[144:151], v3
  v_permlane32_swap_b32 v37, v41
  v_smfmac_f32_16x16x64_bf16 v[44:47], v[28:31], a[152:159], v3
  v_permlane32_swap_b32 v38, v42
  v_smfmac_f32_16x16x64_bf16 v[44:47], v[32:35], a[160:167], v3
  v_permlane32_swap_b32 v39, v43
  v_smfmac_f32_16x16x64_bf16 v[48:51], v[8:11], a[168:175], v3
  v_add_f32 v36, v36, v40
  v_smfmac_f32_16x16x64_bf16 v[48:51], v[12:15], a[176:183], v3
  v_add_f32 v37, v37, v41
  v_smfmac_f32_16x16x64_bf16 v[48:51], v[16:19], a[184:191], v3
  v_add_f32 v38, v38, v42
  v_smfmac_f32_16x16x64_bf16 v[48:51], v[20:23], a[192:199], v3
  v_add_f32 v39, v39, v43
  v_smfmac_f32_16x16x64_bf16 v[48:51], v[24:27], a[200:207], v3
  v_cvt_pk_bf16_f32 v40, v36, v37
  v_smfmac_f32_16x16x64_bf16 v[48:51], v[28:31], a[208:215], v3
  v_cvt_pk_bf16_f32 v41, v38, v39
  v_smfmac_f32_16x16x64_bf16 v[48:51], v[32:35], a[216:223], v3
  ds_write_b64 v60, v[40:41]
  v_smfmac_f32_16x16x64_bf16 v[52:55], v[8:11], a[224:231], v3
  v_smfmac_f32_16x16x64_bf16 v[52:55], v[12:15], a[232:239], v3
  v_smfmac_f32_16x16x64_bf16 v[52:55], v[16:19], a[240:247], v3
  v_smfmac_f32_16x16x64_bf16 v[52:55], v[20:23], a[248:255], v3
  v_permlane32_swap_b32 v44, v48
  v_smfmac_f32_16x16x64_bf16 v[52:55], v[24:27], v[176:183], v3
  v_permlane32_swap_b32 v45, v49
  v_smfmac_f32_16x16x64_bf16 v[52:55], v[28:31], v[184:191], v3
  v_permlane32_swap_b32 v46, v50
  v_smfmac_f32_16x16x64_bf16 v[52:55], v[32:35], v[192:199], v3
  v_permlane32_swap_b32 v47, v51
  v_smfmac_f32_16x16x64_bf16 v[56:59], v[8:11], v[200:207], v3
  v_add_f32 v44, v44, v48
  v_smfmac_f32_16x16x64_bf16 v[56:59], v[12:15], v[208:215], v3
  v_add_f32 v45, v45, v49
  v_smfmac_f32_16x16x64_bf16 v[56:59], v[16:19], v[216:223], v3
  v_add_f32 v46, v46, v50
  v_smfmac_f32_16x16x64_bf16 v[56:59], v[20:23], v[224:231], v3
  v_add_f32 v47, v47, v51
  v_smfmac_f32_16x16x64_bf16 v[56:59], v[24:27], v[232:239], v3
  v_cvt_pk_bf16_f32 v48, v44, v45
  v_smfmac_f32_16x16x64_bf16 v[56:59], v[28:31], v[240:247], v3
  v_cvt_pk_bf16_f32 v49, v46, v47
  v_smfmac_f32_16x16x64_bf16 v[56:59], v[32:35], v[248:255], v3
  ds_write_b64 v61, v[48:49]
  s_nop 6
  v_permlane32_swap_b32 v52, v56
  v_permlane32_swap_b32 v53, v57
  v_permlane32_swap_b32 v54, v58
  v_permlane32_swap_b32 v55, v59
  v_add_f32 v52, v52, v56
  v_add_f32 v53, v53, v57
  v_add_f32 v54, v54, v58
  v_add_f32 v55, v55, v59
  v_cvt_pk_bf16_f32 v56, v52, v53
  v_cvt_pk_bf16_f32 v57, v54, v55
  ds_write_b64 v62, v[56:57]
  s_cmp_eq_u32 s19, 63
  s_cbranch_scc1 cB_va1_last
  s_add_u32 s22, s20, 9216
  s_add_u32 s34, s20, 13312
  s_add_u32 s36, s20, 7168
  s_mov_b32 s37, 0
  v_mov_b32 v156, 0
  v_mov_b32 v157, 0
  v_mov_b32 v158, 0
  v_mov_b32 v159, 0
  buffer_load_dword v164, v4, s[8:11], s20 offen sc1
  s_nop 7
  buffer_load_dword v165, v4, s[8:11], s20 offen sc1
  s_nop 7
  buffer_load_dword v166, v4, s[8:11], s20 offen sc1
  s_nop 7
  buffer_load_dword v167, v4, s[8:11], s20 offen sc1
  s_nop 7
  buffer_load_dword v168, v4, s[8:11], s20 offen sc1
cB_va1_fw_l:
  s_waitcnt vmcnt(4)
  v_cmp_eq_u32 vcc, -1, v164
  s_cbranch_vccz cB_va1_fw_d
  buffer_load_dword v164, v4, s[8:11], s20 offen sc1
  s_waitcnt vmcnt(4)
  v_cmp_eq_u32 vcc, -1, v165
  s_cbranch_vccz cB_va1_fw_d
  buffer_load_dword v165, v4, s[8:11], s20 offen sc1
  s_waitcnt vmcnt(4)
  v_cmp_eq_u32 vcc, -1, v166
  s_cbranch_vccz cB_va1_fw_d
  buffer_load_dword v166, v4, s[8:11], s20 offen sc1
  s_waitcnt vmcnt(4)
  v_cmp_eq_u32 vcc, -1, v167
  s_cbranch_vccz cB_va1_fw_d
  buffer_load_dword v167, v4, s[8:11], s20 offen sc1
  s_waitcnt vmcnt(4)
  v_cmp_eq_u32 vcc, -1, v168
  s_cbranch_vccz cB_va1_fw_d
  buffer_load_dword v168, v4, s[8:11], s20 offen sc1
  s_add_u32 s30, s30, 1
  s_cmp_lt_u32 s30, 400000
  s_cbranch_scc1 cB_va1_fw_l
  s_branch cB_abort
cB_va1_fw_d:
  s_waitcnt lgkmcnt(0)
  buffer_load_dwordx4 v[8:11], v2, s[8:11], s22 offen offset:0 sc1
  v_mov_b32 v36, 0
  v_mov_b32 v37, 0
  v_mov_b32 v38, 0
  buffer_load_dwordx4 v[12:15], v2, s[8:11], s22 offen offset:1024 sc1
  v_mov_b32 v39, 0
  v_mov_b32 v40, 0
  v_mov_b32 v41, 0
  buffer_load_dwordx4 v[16:19], v2, s[8:11], s22 offen offset:2048 sc1
  v_mov_b32 v42, 0
  v_mov_b32 v43, 0
  v_mov_b32 v44, 0
  buffer_load_dwordx4 v[20:23], v2, s[8:11], s22 offen offset:3072 sc1
  v_mov_b32 v45, 0
  v_mov_b32 v46, 0
  v_mov_b32 v47, 0
  buffer_load_dwordx4 v[24:27], v2, s[8:11], s34 offen offset:0 sc1
  v_mov_b32 v48, 0
  v_mov_b32 v49, 0
  v_mov_b32 v50, 0
  buffer_load_dwordx4 v[28:31], v2, s[8:11], s34 offen offset:1024 sc1
  v_mov_b32 v51, 0
  v_mov_b32 v52, 0
  v_mov_b32 v53, 0
  buffer_load_dwordx4 v[32:35], v2, s[8:11], s34 offen offset:2048 sc1
  v_mov_b32 v54, 0
  v_mov_b32 v55, 0
  v_mov_b32 v56, 0
  buffer_load_dwordx4 v[144:147], v2, s[8:11], s34 offen offset:3072 sc1
  v_mov_b32 v57, 0
  v_mov_b32 v58, 0
  v_mov_b32 v59, 0
  buffer_load_dwordx4 v[148:151], v2, s[8:11], s36 offen offset:0 sc1
  buffer_load_dwordx4 v[152:155], v2, s[8:11], s36 offen offset:1024 sc1
  s_barrier
  ds_read_b128 v[64:67], v2 offset:4096
  ds_read_b128 v[68:71], v2 offset:5120
  ds_read_b128 v[72:75], v2 offset:6144
  ds_read_b128 v[76:79], v2 offset:7168
  s_waitcnt vmcnt(9)
  v_smfmac_f32_16x16x64_bf16 v[156:159], v[8:11], v[80:87], v3
  s_waitcnt vmcnt(8)
  v_smfmac_f32_16x16x64_bf16 v[156:159], v[12:15], v[88:95], v3
  s_waitcnt vmcnt(7)
  v_smfmac_f32_16x16x64_bf16 v[156:159], v[16:19], v[96:103], v3
  s_waitcnt vmcnt(6)
  v_smfmac_f32_16x16x64_bf16 v[156:159], v[20:23], v[104:111], v3
  s_waitcnt vmcnt(5)
  v_smfmac_f32_16x16x64_bf16 v[156:159], v[24:27], v[112:119], v3
  s_mov_b32 exec_hi, 0
  buffer_store_dword v2, v7, s[8:11], s21 offen sc1
  s_mov_b64 exec, -1
  s_waitcnt vmcnt(5)
  v_smfmac_f32_16x16x64_bf16 v[156:159], v[28:31], v[120:127], v3
  s_waitcnt vmcnt(4)
  v_smfmac_f32_16x16x64_bf16 v[156:159], v[32:35], v[128:135], v3
  s_waitcnt vmcnt(3)
  v_smfmac_f32_16x16x64_bf16 v[156:159], v[144:147], v[136:143], v3
  s_waitcnt vmcnt(2) lgkmcnt(0)
  v_smfmac_f32_16x16x64_bf16 v[156:159], v[148:151], v[64:71], v3
  s_waitcnt vmcnt(1)
  v_smfmac_f32_16x16x64_bf16 v[156:159], v[152:155], v[72:79], v3
cB_va1_ep:
  s_nop 7
  v_permlane32_swap_b32 v156, v158
  v_permlane32_swap_b32 v157, v159
  v_add_f32 v160, v156, v158
  v_add_f32 v161, v157, v159
  v_cmp_u_f32 vcc, v160, v161
  v_mov_b32_dpp v162, v160 row_ror:8 row_mask:0xf bank_mask:0xf
  v_mov_b32_dpp v160, v161 row_ror:8 row_mask:0xf bank_mask:0xc
  s_cbranch_vccnz cB_va1_rp
  v_mov_b32_dpp v161, v162 quad_perm:[0,1,2,3] row_mask:0xf bank_mask:0x3
  v_cvt_pk_bf16_f32 v160, v160, v161
cB_va1_pc:
  s_mov_b64 exec, s[26:27]
  buffer_store_dword v160, v1, s[8:11], s21 offen sc1
  s_cmp_lg_u32 s19, 62
  s_cbranch_scc1 cB_va1_nl
  s_mov_b32 s22, 88519680
  buffer_store_dword v160, v1, s[8:11], s22 offen sc1
  s_mov_b64 exec, -1
  s_branch cB_done
cB_va1_nl:
  s_mov_b64 exec, -1
  s_add_u32 s25, s25, 28672
  s_add_u32 s19, s19, 1
  s_mov_b32 s20, s21
  s_branch cB_va1_loop
cB_va1_last:
  s_waitcnt lgkmcnt(0)
  s_barrier
  s_branch cB_done
cB_va1_rp:
  s_cmp_eq_u32 s37, 0
  s_cbranch_scc1 cB_va1_rv
  v_mov_b32_dpp v161, v162 quad_perm:[0,1,2,3] row_mask:0xf bank_mask:0x3
  v_cvt_pk_bf16_f32 v160, v160, v161
  v_min_u32 v160, -2, v160
  s_branch cB_va1_pc
cB_va1_rv:
  buffer_load_dwordx4 v[8:11], v2, s[8:11], s22 offen offset:0 sc1
  buffer_load_dwordx4 v[12:15], v2, s[8:11], s22 offen offset:1024 sc1
  buffer_load_dwordx4 v[16:19], v2, s[8:11], s22 offen offset:2048 sc1
  buffer_load_dwordx4 v[20:23], v2, s[8:11], s22 offen offset:3072 sc1
  buffer_load_dwordx4 v[24:27], v2, s[8:11], s34 offen offset:0 sc1
  buffer_load_dwordx4 v[28:31], v2, s[8:11], s34 offen offset:1024 sc1
  buffer_load_dwordx4 v[32:35], v2, s[8:11], s34 offen offset:2048 sc1
  buffer_load_dwordx4 v[144:147], v2, s[8:11], s34 offen offset:3072 sc1
  buffer_load_dwordx4 v[148:151], v2, s[8:11], s36 offen offset:0 sc1
  buffer_load_dwordx4 v[152:155], v2, s[8:11], s36 offen offset:1024 sc1
  s_waitcnt vmcnt(0)
  v_max3_u32 v63, v8, v9, v10
  v_max3_u32 v63, v63, v11, v12
  v_max3_u32 v63, v63, v13, v14
  v_max3_u32 v63, v63, v15, v16
  v_max3_u32 v63, v63, v17, v18
  v_max3_u32 v63, v63, v19, v20
  v_max3_u32 v63, v63, v21, v22
  v_max3_u32 v63, v63, v23, v24
  v_max3_u32 v63, v63, v25, v26
  v_max3_u32 v63, v63, v27, v28
  v_max3_u32 v63, v63, v29, v30
  v_max3_u32 v63, v63, v31, v32
  v_max3_u32 v63, v63, v33, v34
  v_max3_u32 v63, v63, v35, v144
  v_max3_u32 v63, v63, v145, v146
  v_max3_u32 v63, v63, v147, v148
  v_max3_u32 v63, v63, v149, v150
  v_max3_u32 v63, v63, v151, v152
  v_max3_u32 v63, v63, v153, v154
  v_max_u32 v63, v63, v155
  v_cmp_eq_u32 vcc, -1, v63
  s_cbranch_vccz cB_va1_rk
  s_add_u32 s30, s30, 1
  s_cmp_lt_u32 s30, 400000
  s_cbranch_scc1 cB_va1_rv
  s_branch cB_abort
cB_va1_rk:
  s_mov_b32 s37, 1
  s_add_u32 s31, s31, 0x10000
  v_mov_b32 v156, 0
  v_mov_b32 v157, 0
  v_mov_b32 v158, 0
  v_mov_b32 v159, 0
  s_nop 1
  v_smfmac_f32_16x16x64_bf16 v[156:159], v[8:11], v[80:87], v3
  v_smfmac_f32_16x16x64_bf16 v[156:159], v[12:15], v[88:95], v3
  v_smfmac_f32_16x16x64_bf16 v[156:159], v[16:19], v[96:103], v3
  v_smfmac_f32_16x16x64_bf16 v[156:159], v[20:23], v[104:111], v3
  v_smfmac_f32_16x16x64_bf16 v[156:159], v[24:27], v[112:119], v3
  v_smfmac_f32_16x16x64_bf16 v[156:159], v[28:31], v[120:127], v3
  v_smfmac_f32_16x16x64_bf16 v[156:159], v[32:35], v[128:135], v3
  v_smfmac_f32_16x16x64_bf16 v[156:159], v[144:147], v[136:143], v3
  v_smfmac_f32_16x16x64_bf16 v[156:159], v[148:151], v[64:71], v3
  v_smfmac_f32_16x16x64_bf16 v[156:159], v[152:155], v[72:79], v3
  s_nop 7
  s_branch cB_va1_ep
.p2align 6

cB_va2_loop:
  s_add_u32 s23, s20, 4096
  s_add_u32 s21, s20, 25600
  v_mov_b32 v36, 0
  v_mov_b32 v37, 0
  v_mov_b32 v38, 0
  v_mov_b32 v39, 0
  v_mov_b32 v40, 0
  v_mov_b32 v41, 0
  v_mov_b32 v42, 0
  v_mov_b32 v43, 0
  v_mov_b32 v44, 0
  v_mov_b32 v45, 0
  v_mov_b32 v46, 0
  v_mov_b32 v47, 0
  v_mov_b32 v48, 0
  v_mov_b32 v49, 0
  v_mov_b32 v50, 0
  v_mov_b32 v51, 0
  v_mov_b32 v52, 0
  v_mov_b32 v53, 0
  v_mov_b32 v54, 0
  v_mov_b32 v55, 0
  v_mov_b32 v56, 0
  v_mov_b32 v57, 0
  v_mov_b32 v58, 0
  v_mov_b32 v59, 0
  v_mov_b32 v60, 0
  v_mov_b32 v61, 0
  v_mov_b32 v62, 0
  v_mov_b32 v63, 0
  v_mov_b32 v64, 0
  v_mov_b32 v65, 0
  v_mov_b32 v66, 0
  v_mov_b32 v67, 0
  s_mov_b32 s30, 0
  buffer_load_dword v76, v119, s[8:11], s20 offen sc1
  buffer_load_dword v77, v119, s[8:11], s20 offen sc1
  buffer_load_dword v78, v119, s[8:11], s20 offen sc1
cB_va2_fp_l:
  s_waitcnt vmcnt(2)
  v_cmp_eq_u32 vcc, -1, v76
  s_cbranch_vccz cB_va2_fp_d
  buffer_load_dword v76, v119, s[8:11], s20 offen sc1
  s_waitcnt vmcnt(2)
  v_cmp_eq_u32 vcc, -1, v77
  s_cbranch_vccz cB_va2_fp_d
  buffer_load_dword v77, v119, s[8:11], s20 offen sc1
  s_waitcnt vmcnt(2)
  v_cmp_eq_u32 vcc, -1, v78
  s_cbranch_vccz cB_va2_fp_d
  buffer_load_dword v78, v119, s[8:11], s20 offen sc1
  s_add_u32 s30, s30, 1
  s_cmp_lt_u32 s30, 400000
  s_cbranch_scc1 cB_va2_fp_l
  s_branch cB_abort
cB_va2_fp_d:
  buffer_load_dwordx4 v[8:11], v2, s[8:11], s20 offen offset:0 sc1
  buffer_load_dwordx4 v[12:15], v2, s[8:11], s20 offen offset:1024 sc1
  buffer_load_dwordx4 v[16:19], v2, s[8:11], s20 offen offset:2048 sc1
  buffer_load_dwordx4 v[20:23], v2, s[8:11], s20 offen offset:3072 sc1
  s_barrier
cB_va2_ld:
  s_waitcnt vmcnt(0)
  v_max3_u32 v84, v8, v9, v10
  v_max3_u32 v84, v84, v11, v12
  v_max3_u32 v84, v84, v13, v14
  v_max3_u32 v84, v84, v15, v16
  v_max3_u32 v84, v84, v17, v18
  v_max3_u32 v84, v84, v19, v20
  v_max3_u32 v84, v84, v21, v22
  v_max_u32 v84, v84, v23
  v_cmp_eq_u32 vcc, -1, v84
  ds_write_b128 v2, v[8:11] offset:8192
  ds_write_b128 v2, v[12:15] offset:9216
  ds_write_b128 v2, v[16:19] offset:10240
  ds_write_b128 v2, v[20:23] offset:11264
  s_cbranch_vccnz cB_va2_retry
  s_waitcnt lgkmcnt(0)
  s_barrier
  ds_read_b128 v[24:27], v2 offset:12288
  ds_read_b128 v[28:31], v2 offset:13312
  ds_read_b128 v[32:35], v2 offset:14336
  ds_read_b128 v[92:95], v0
  s_waitcnt lgkmcnt(0)
  s_mov_b64 exec, s[26:27]
  buffer_store_dwordx4 v[92:95], v2, s[8:11], s36 offen sc1
  s_mov_b64 exec, -1
  s_add_u32 s36, s36, 7168
  s_cmp_eq_u32 s19, 63
  s_cbranch_scc1 cB_done
  ds_read_b128 v[76:79], v1 offset:0
  ds_read_b128 v[80:83], v1 offset:1024
  ds_read_b128 v[84:87], v1 offset:2048
  ds_read_b128 v[88:91], v1 offset:3072
  ds_read_b128 v[92:95], v1 offset:4096
  ds_read_b128 v[96:99], v1 offset:5120
  v_smfmac_f32_16x16x64_bf16 v[60:63], v[8:11], v[200:207], v3
  v_smfmac_f32_16x16x64_bf16 v[60:63], v[12:15], v[208:215], v3
  s_waitcnt lgkmcnt(4)
  v_smfmac_f32_16x16x64_bf16 v[64:67], v[8:11], v[76:83], v3
  ds_read_b128 v[76:79], v1 offset:6144
  ds_read_b128 v[80:83], v1 offset:7168
  v_smfmac_f32_16x16x64_bf16 v[60:63], v[16:19], v[216:223], v3
  v_smfmac_f32_16x16x64_bf16 v[60:63], v[20:23], v[224:231], v3
  s_waitcnt lgkmcnt(4)
  v_smfmac_f32_16x16x64_bf16 v[64:67], v[12:15], v[84:91], v3
  ds_read_b128 v[84:87], v1 offset:8192
  ds_read_b128 v[88:91], v1 offset:9216
  v_smfmac_f32_16x16x64_bf16 v[60:63], v[24:27], v[232:239], v3
  v_smfmac_f32_16x16x64_bf16 v[60:63], v[28:31], v[240:247], v3
  s_waitcnt lgkmcnt(4)
  v_smfmac_f32_16x16x64_bf16 v[64:67], v[16:19], v[92:99], v3
  ds_read_b128 v[92:95], v1 offset:10240
  ds_read_b128 v[96:99], v1 offset:11264
  v_smfmac_f32_16x16x64_bf16 v[60:63], v[32:35], v[248:255], v3
  v_smfmac_f32_16x16x64_bf16 v[36:39], v[8:11], a[0:7], v3
  s_waitcnt lgkmcnt(4)
  v_smfmac_f32_16x16x64_bf16 v[64:67], v[20:23], v[76:83], v3
  ds_read_b128 v[76:79], v1 offset:12288
  ds_read_b128 v[80:83], v1 offset:13312
  v_smfmac_f32_16x16x64_bf16 v[36:39], v[12:15], a[8:15], v3
  v_smfmac_f32_16x16x64_bf16 v[36:39], v[16:19], a[16:23], v3
  s_waitcnt lgkmcnt(4)
  v_smfmac_f32_16x16x64_bf16 v[64:67], v[24:27], v[84:91], v3
  v_smfmac_f32_16x16x64_bf16 v[36:39], v[20:23], a[24:31], v3
  v_smfmac_f32_16x16x64_bf16 v[36:39], v[24:27], a[32:39], v3
  s_waitcnt lgkmcnt(2)
  v_smfmac_f32_16x16x64_bf16 v[64:67], v[28:31], v[92:99], v3
  v_smfmac_f32_16x16x64_bf16 v[36:39], v[28:31], a[40:47], v3
  v_smfmac_f32_16x16x64_bf16 v[36:39], v[32:35], a[48:55], v3
  s_waitcnt lgkmcnt(0)
  v_smfmac_f32_16x16x64_bf16 v[64:67], v[32:35], v[76:83], v3
  v_smfmac_f32_16x16x64_bf16 v[40:43], v[8:11], a[56:63], v3
  v_smfmac_f32_16x16x64_bf16 v[40:43], v[12:15], a[64:71], v3
  v_smfmac_f32_16x16x64_bf16 v[40:43], v[16:19], a[72:79], v3
  v_smfmac_f32_16x16x64_bf16 v[40:43], v[20:23], a[80:87], v3
  v_permlane32_swap_b32 v60, v64
  v_smfmac_f32_16x16x64_bf16 v[40:43], v[24:27], a[88:95], v3
  v_permlane32_swap_b32 v61, v65
  v_smfmac_f32_16x16x64_bf16 v[40:43], v[28:31], a[96:103], v3
  v_permlane32_swap_b32 v62, v66
  v_smfmac_f32_16x16x64_bf16 v[40:43], v[32:35], a[104:111], v3
  v_permlane32_swap_b32 v63, v67
  v_smfmac_f32_16x16x64_bf16 v[44:47], v[8:11], a[112:119], v3
  v_smfmac_f32_16x16x64_bf16 v[44:47], v[12:15], a[120:127], v3
  v_smfmac_f32_16x16x64_bf16 v[44:47], v[16:19], a[128:135], v3
  v_smfmac_f32_16x16x64_bf16 v[44:47], v[20:23], a[136:143], v3
  v_add_f32 v60, v60, v64
  v_add_f32 v61, v61, v65
  v_smfmac_f32_16x16x64_bf16 v[44:47], v[24:27], a[144:151], v3
  v_add_f32 v62, v62, v66
  v_add_f32 v63, v63, v67
  v_smfmac_f32_16x16x64_bf16 v[44:47], v[28:31], a[152:159], v3
  v_cvt_pk_bf16_f32 v64, v60, v61
  v_cvt_pk_bf16_f32 v65, v62, v63
  v_smfmac_f32_16x16x64_bf16 v[44:47], v[32:35], a[160:167], v3
  ds_write_b64 v115, v[64:65]
  v_smfmac_f32_16x16x64_bf16 v[48:51], v[8:11], a[168:175], v3
  v_permlane32_swap_b32 v36, v40
  v_smfmac_f32_16x16x64_bf16 v[48:51], v[12:15], a[176:183], v3
  v_permlane32_swap_b32 v37, v41
  v_smfmac_f32_16x16x64_bf16 v[48:51], v[16:19], a[184:191], v3
  v_permlane32_swap_b32 v38, v42
  v_smfmac_f32_16x16x64_bf16 v[48:51], v[20:23], a[192:199], v3
  v_permlane32_swap_b32 v39, v43
  v_smfmac_f32_16x16x64_bf16 v[48:51], v[24:27], a[200:207], v3
  v_add_f32 v36, v36, v40
  v_smfmac_f32_16x16x64_bf16 v[48:51], v[28:31], a[208:215], v3
  v_add_f32 v37, v37, v41
  v_smfmac_f32_16x16x64_bf16 v[48:51], v[32:35], a[216:223], v3
  v_add_f32 v38, v38, v42
  v_smfmac_f32_16x16x64_bf16 v[52:55], v[8:11], a[224:231], v3
  v_smfmac_f32_16x16x64_bf16 v[52:55], v[12:15], a[232:239], v3
  v_smfmac_f32_16x16x64_bf16 v[52:55], v[16:19], a[240:247], v3
  v_smfmac_f32_16x16x64_bf16 v[52:55], v[20:23], a[248:255], v3
  v_add_f32 v39, v39, v43
  v_cvt_pk_bf16_f32 v40, v36, v37
  v_smfmac_f32_16x16x64_bf16 v[52:55], v[24:27], v[120:127], v3
  v_cvt_pk_bf16_f32 v41, v38, v39
  v_smfmac_f32_16x16x64_bf16 v[52:55], v[28:31], v[128:135], v3
  ds_write_b64 v112, v[40:41]
  v_smfmac_f32_16x16x64_bf16 v[52:55], v[32:35], v[136:143], v3
  v_permlane32_swap_b32 v44, v48
  v_smfmac_f32_16x16x64_bf16 v[56:59], v[8:11], v[144:151], v3
  v_permlane32_swap_b32 v45, v49
  v_smfmac_f32_16x16x64_bf16 v[56:59], v[12:15], v[152:159], v3
  v_permlane32_swap_b32 v46, v50
  v_smfmac_f32_16x16x64_bf16 v[56:59], v[16:19], v[160:167], v3
  v_permlane32_swap_b32 v47, v51
  v_smfmac_f32_16x16x64_bf16 v[56:59], v[20:23], v[168:175], v3
  v_add_f32 v44, v44, v48
  v_smfmac_f32_16x16x64_bf16 v[56:59], v[24:27], v[176:183], v3
  v_add_f32 v45, v45, v49
  v_smfmac_f32_16x16x64_bf16 v[56:59], v[28:31], v[184:191], v3
  v_add_f32 v46, v46, v50
  v_smfmac_f32_16x16x64_bf16 v[56:59], v[32:35], v[192:199], v3
  v_add_f32 v47, v47, v51
  v_cvt_pk_bf16_f32 v48, v44, v45
  v_cvt_pk_bf16_f32 v49, v46, v47
  ds_write_b64 v113, v[48:49]
  s_nop 3
  v_permlane32_swap_b32 v52, v56
  v_permlane32_swap_b32 v53, v57
  v_permlane32_swap_b32 v54, v58
  v_permlane32_swap_b32 v55, v59
  v_add_f32 v52, v52, v56
  v_add_f32 v53, v53, v57
  v_add_f32 v54, v54, v58
  v_add_f32 v55, v55, v59
  v_cvt_pk_bf16_f32 v56, v52, v53
  v_cvt_pk_bf16_f32 v57, v54, v55
  ds_write_b64 v114, v[56:57]
  s_waitcnt lgkmcnt(0)
  s_barrier
  s_cmp_eq_u32 s19, 62
  s_cbranch_scc1 cB_done
  s_waitcnt vmcnt(0) lgkmcnt(0)
  s_add_u32 s19, s19, 1
  s_mov_b32 s20, s21
  s_branch cB_va2_loop
cB_va2_retry:
  s_waitcnt lgkmcnt(0)
  buffer_load_dwordx4 v[8:11], v2, s[8:11], s20 offen offset:0 sc1
  buffer_load_dwordx4 v[12:15], v2, s[8:11], s20 offen offset:1024 sc1
  buffer_load_dwordx4 v[16:19], v2, s[8:11], s20 offen offset:2048 sc1
  buffer_load_dwordx4 v[20:23], v2, s[8:11], s20 offen offset:3072 sc1
  s_add_u32 s31, s31, 1
  s_add_u32 s30, s30, 1
  s_cmp_lt_u32 s30, 400000
  s_cbranch_scc1 cB_va2_ld
  s_branch cB_abort
cB_va2_last:
  s_waitcnt lgkmcnt(0)
  buffer_store_dwordx4 v[100:103], v2, s[8:11], s24 offen offset:0 sc1
  buffer_store_dwordx4 v[104:107], v2, s[8:11], s24 offen offset:1024 sc1
  buffer_store_dwordx4 v[108:111], v2, s[8:11], s24 offen offset:2048 sc1
  buffer_store_dwordx4 v[4:7], v2, s[8:11], s24 offen offset:3072 sc1
  s_add_u32 s24, s24, 8192
  s_waitcnt vmcnt(0)
  s_mov_b64 exec, 1
  buffer_store_dword v117, v2, s[8:11], s34 offen sc1
  s_mov_b64 exec, -1
  s_add_u32 s34, s34, 8
  s_mov_b64 exec, 1
  buffer_store_dword v117, v2, s[8:11], s34 offen sc1
  s_mov_b64 exec, -1
  s_add_u32 s34, s34, 8
  s_branch cB_done
.p2align 6

cB_va3_loop:
  s_add_u32 s23, s20, 4096
  s_add_u32 s21, s20, 25600
  v_mov_b32 v36, 0
  v_mov_b32 v37, 0
  v_mov_b32 v38, 0
  v_mov_b32 v39, 0
  v_mov_b32 v40, 0
  v_mov_b32 v41, 0
  v_mov_b32 v42, 0
  v_mov_b32 v43, 0
  v_mov_b32 v44, 0
  v_mov_b32 v45, 0
  v_mov_b32 v46, 0
  v_mov_b32 v47, 0
  v_mov_b32 v48, 0
  v_mov_b32 v49, 0
  v_mov_b32 v50, 0
  v_mov_b32 v51, 0
  v_mov_b32 v52, 0
  v_mov_b32 v53, 0
  v_mov_b32 v54, 0
  v_mov_b32 v55, 0
  v_mov_b32 v56, 0
  v_mov_b32 v57, 0
  v_mov_b32 v58, 0
  v_mov_b32 v59, 0
  v_mov_b32 v60, 0
  v_mov_b32 v61, 0
  v_mov_b32 v62, 0
  v_mov_b32 v63, 0
  v_mov_b32 v64, 0
  v_mov_b32 v65, 0
  v_mov_b32 v66, 0
  v_mov_b32 v67, 0
  s_mov_b32 s30, 0
  buffer_load_dword v76, v119, s[8:11], s20 offen sc1
  buffer_load_dword v77, v119, s[8:11], s20 offen sc1
  buffer_load_dword v78, v119, s[8:11], s20 offen sc1
cB_va3_fp_l:
  s_waitcnt vmcnt(2)
  v_cmp_eq_u32 vcc, -1, v76
  s_cbranch_vccz cB_va3_fp_d
  buffer_load_dword v76, v119, s[8:11], s20 offen sc1
  s_waitcnt vmcnt(2)
  v_cmp_eq_u32 vcc, -1, v77
  s_cbranch_vccz cB_va3_fp_d
  buffer_load_dword v77, v119, s[8:11], s20 offen sc1
  s_waitcnt vmcnt(2)
  v_cmp_eq_u32 vcc, -1, v78
  s_cbranch_vccz cB_va3_fp_d
  buffer_load_dword v78, v119, s[8:11], s20 offen sc1
  s_add_u32 s30, s30, 1
  s_cmp_lt_u32 s30, 400000
  s_cbranch_scc1 cB_va3_fp_l
  s_branch cB_abort
cB_va3_fp_d:
  buffer_load_dwordx4 v[24:27], v2, s[8:11], s23 offen offset:0 sc1
  buffer_load_dwordx4 v[28:31], v2, s[8:11], s23 offen offset:1024 sc1
  buffer_load_dwordx4 v[32:35], v2, s[8:11], s23 offen offset:2048 sc1
  s_barrier
cB_va3_ld:
  s_waitcnt vmcnt(0)
  v_max3_u32 v84, v24, v25, v26
  v_max3_u32 v84, v84, v27, v28
  v_max3_u32 v84, v84, v29, v30
  v_max3_u32 v84, v84, v31, v32
  v_max3_u32 v84, v84, v33, v34
  v_max_u32 v84, v84, v35
  v_cmp_eq_u32 vcc, -1, v84
  ds_write_b128 v2, v[24:27] offset:12288
  ds_write_b128 v2, v[28:31] offset:13312
  ds_write_b128 v2, v[32:35] offset:14336
  s_cbranch_vccnz cB_va3_retry
  s_waitcnt lgkmcnt(0)
  s_barrier
  ds_read_b128 v[8:11], v2 offset:8192
  ds_read_b128 v[12:15], v2 offset:9216
  ds_read_b128 v[16:19], v2 offset:10240
  ds_read_b128 v[20:23], v2 offset:11264
  s_waitcnt lgkmcnt(0)
  s_cmp_eq_u32 s19, 63
  s_cbranch_scc1 cB_done
  ds_read_b128 v[76:79], v1 offset:0
  ds_read_b128 v[80:83], v1 offset:1024
  ds_read_b128 v[84:87], v1 offset:2048
  ds_read_b128 v[88:91], v1 offset:3072
  ds_read_b128 v[92:95], v1 offset:4096
  ds_read_b128 v[96:99], v1 offset:5120
  v_smfmac_f32_16x16x64_bf16 v[60:63], v[8:11], v[200:207], v3
  v_smfmac_f32_16x16x64_bf16 v[60:63], v[12:15], v[208:215], v3
  s_waitcnt lgkmcnt(4)
  v_smfmac_f32_16x16x64_bf16 v[64:67], v[8:11], v[76:83], v3
  ds_read_b128 v[76:79], v1 offset:6144
  ds_read_b128 v[80:83], v1 offset:7168
  v_smfmac_f32_16x16x64_bf16 v[60:63], v[16:19], v[216:223], v3
  v_smfmac_f32_16x16x64_bf16 v[60:63], v[20:23], v[224:231], v3
  s_waitcnt lgkmcnt(4)
  v_smfmac_f32_16x16x64_bf16 v[64:67], v[12:15], v[84:91], v3
  ds_read_b128 v[84:87], v1 offset:8192
  ds_read_b128 v[88:91], v1 offset:9216
  v_smfmac_f32_16x16x64_bf16 v[60:63], v[24:27], v[232:239], v3
  v_smfmac_f32_16x16x64_bf16 v[60:63], v[28:31], v[240:247], v3
  s_waitcnt lgkmcnt(4)
  v_smfmac_f32_16x16x64_bf16 v[64:67], v[16:19], v[92:99], v3
  ds_read_b128 v[92:95], v1 offset:10240
  ds_read_b128 v[96:99], v1 offset:11264
  v_smfmac_f32_16x16x64_bf16 v[60:63], v[32:35], v[248:255], v3
  v_smfmac_f32_16x16x64_bf16 v[36:39], v[8:11], a[0:7], v3
  s_waitcnt lgkmcnt(4)
  v_smfmac_f32_16x16x64_bf16 v[64:67], v[20:23], v[76:83], v3
  ds_read_b128 v[76:79], v1 offset:12288
  ds_read_b128 v[80:83], v1 offset:13312
  v_smfmac_f32_16x16x64_bf16 v[36:39], v[12:15], a[8:15], v3
  v_smfmac_f32_16x16x64_bf16 v[36:39], v[16:19], a[16:23], v3
  s_waitcnt lgkmcnt(4)
  v_smfmac_f32_16x16x64_bf16 v[64:67], v[24:27], v[84:91], v3
  v_smfmac_f32_16x16x64_bf16 v[36:39], v[20:23], a[24:31], v3
  v_smfmac_f32_16x16x64_bf16 v[36:39], v[24:27], a[32:39], v3
  s_waitcnt lgkmcnt(2)
  v_smfmac_f32_16x16x64_bf16 v[64:67], v[28:31], v[92:99], v3
  v_smfmac_f32_16x16x64_bf16 v[36:39], v[28:31], a[40:47], v3
  v_smfmac_f32_16x16x64_bf16 v[36:39], v[32:35], a[48:55], v3
  s_waitcnt lgkmcnt(0)
  v_smfmac_f32_16x16x64_bf16 v[64:67], v[32:35], v[76:83], v3
  v_smfmac_f32_16x16x64_bf16 v[40:43], v[8:11], a[56:63], v3
  v_smfmac_f32_16x16x64_bf16 v[40:43], v[12:15], a[64:71], v3
  v_smfmac_f32_16x16x64_bf16 v[40:43], v[16:19], a[72:79], v3
  v_smfmac_f32_16x16x64_bf16 v[40:43], v[20:23], a[80:87], v3
  v_permlane32_swap_b32 v60, v64
  v_smfmac_f32_16x16x64_bf16 v[40:43], v[24:27], a[88:95], v3
  v_permlane32_swap_b32 v61, v65
  v_smfmac_f32_16x16x64_bf16 v[40:43], v[28:31], a[96:103], v3
  v_permlane32_swap_b32 v62, v66
  v_smfmac_f32_16x16x64_bf16 v[40:43], v[32:35], a[104:111], v3
  v_permlane32_swap_b32 v63, v67
  v_smfmac_f32_16x16x64_bf16 v[44:47], v[8:11], a[112:119], v3
  v_smfmac_f32_16x16x64_bf16 v[44:47], v[12:15], a[120:127], v3
  v_smfmac_f32_16x16x64_bf16 v[44:47], v[16:19], a[128:135], v3
  v_smfmac_f32_16x16x64_bf16 v[44:47], v[20:23], a[136:143], v3
  v_add_f32 v60, v60, v64
  v_add_f32 v61, v61, v65
  v_smfmac_f32_16x16x64_bf16 v[44:47], v[24:27], a[144:151], v3
  v_add_f32 v62, v62, v66
  v_add_f32 v63, v63, v67
  v_smfmac_f32_16x16x64_bf16 v[44:47], v[28:31], a[152:159], v3
  v_cvt_pk_bf16_f32 v64, v60, v61
  v_cvt_pk_bf16_f32 v65, v62, v63
  v_smfmac_f32_16x16x64_bf16 v[44:47], v[32:35], a[160:167], v3
  ds_write_b64 v115, v[64:65]
  v_smfmac_f32_16x16x64_bf16 v[48:51], v[8:11], a[168:175], v3
  v_permlane32_swap_b32 v36, v40
  v_smfmac_f32_16x16x64_bf16 v[48:51], v[12:15], a[176:183], v3
  v_permlane32_swap_b32 v37, v41
  v_smfmac_f32_16x16x64_bf16 v[48:51], v[16:19], a[184:191], v3
  v_permlane32_swap_b32 v38, v42
  v_smfmac_f32_16x16x64_bf16 v[48:51], v[20:23], a[192:199], v3
  v_permlane32_swap_b32 v39, v43
  v_smfmac_f32_16x16x64_bf16 v[48:51], v[24:27], a[200:207], v3
  v_add_f32 v36, v36, v40
  v_smfmac_f32_16x16x64_bf16 v[48:51], v[28:31], a[208:215], v3
  v_add_f32 v37, v37, v41
  v_smfmac_f32_16x16x64_bf16 v[48:51], v[32:35], a[216:223], v3
  v_add_f32 v38, v38, v42
  v_smfmac_f32_16x16x64_bf16 v[52:55], v[8:11], a[224:231], v3
  v_smfmac_f32_16x16x64_bf16 v[52:55], v[12:15], a[232:239], v3
  v_smfmac_f32_16x16x64_bf16 v[52:55], v[16:19], a[240:247], v3
  v_smfmac_f32_16x16x64_bf16 v[52:55], v[20:23], a[248:255], v3
  v_add_f32 v39, v39, v43
  v_cvt_pk_bf16_f32 v40, v36, v37
  v_smfmac_f32_16x16x64_bf16 v[52:55], v[24:27], v[120:127], v3
  v_cvt_pk_bf16_f32 v41, v38, v39
  v_smfmac_f32_16x16x64_bf16 v[52:55], v[28:31], v[128:135], v3
  ds_write_b64 v112, v[40:41]
  v_smfmac_f32_16x16x64_bf16 v[52:55], v[32:35], v[136:143], v3
  v_permlane32_swap_b32 v44, v48
  v_smfmac_f32_16x16x64_bf16 v[56:59], v[8:11], v[144:151], v3
  v_permlane32_swap_b32 v45, v49
  v_smfmac_f32_16x16x64_bf16 v[56:59], v[12:15], v[152:159], v3
  v_permlane32_swap_b32 v46, v50
  v_smfmac_f32_16x16x64_bf16 v[56:59], v[16:19], v[160:167], v3
  v_permlane32_swap_b32 v47, v51
  v_smfmac_f32_16x16x64_bf16 v[56:59], v[20:23], v[168:175], v3
  v_add_f32 v44, v44, v48
  v_smfmac_f32_16x16x64_bf16 v[56:59], v[24:27], v[176:183], v3
  v_add_f32 v45, v45, v49
  v_smfmac_f32_16x16x64_bf16 v[56:59], v[28:31], v[184:191], v3
  v_add_f32 v46, v46, v50
  v_smfmac_f32_16x16x64_bf16 v[56:59], v[32:35], v[192:199], v3
  v_add_f32 v47, v47, v51
  v_cvt_pk_bf16_f32 v48, v44, v45
  v_cvt_pk_bf16_f32 v49, v46, v47
  ds_write_b64 v113, v[48:49]
  s_nop 3
  v_permlane32_swap_b32 v52, v56
  v_permlane32_swap_b32 v53, v57
  v_permlane32_swap_b32 v54, v58
  v_permlane32_swap_b32 v55, v59
  v_add_f32 v52, v52, v56
  v_add_f32 v53, v53, v57
  v_add_f32 v54, v54, v58
  v_add_f32 v55, v55, v59
  v_cvt_pk_bf16_f32 v56, v52, v53
  v_cvt_pk_bf16_f32 v57, v54, v55
  ds_write_b64 v114, v[56:57]
  s_waitcnt lgkmcnt(0)
  s_barrier
  s_cmp_eq_u32 s19, 62
  s_cbranch_scc1 cB_done
  s_waitcnt vmcnt(0) lgkmcnt(0)
  s_add_u32 s19, s19, 1
  s_mov_b32 s20, s21
  s_branch cB_va3_loop
cB_va3_retry:
  s_waitcnt lgkmcnt(0)
  buffer_load_dwordx4 v[24:27], v2, s[8:11], s23 offen offset:0 sc1
  buffer_load_dwordx4 v[28:31], v2, s[8:11], s23 offen offset:1024 sc1
  buffer_load_dwordx4 v[32:35], v2, s[8:11], s23 offen offset:2048 sc1
  s_add_u32 s31, s31, 1
  s_add_u32 s30, s30, 1
  s_cmp_lt_u32 s30, 400000
  s_cbranch_scc1 cB_va3_ld
  s_branch cB_abort
cB_va3_last:
  s_waitcnt lgkmcnt(0)
  buffer_store_dwordx4 v[100:103], v2, s[8:11], s24 offen offset:0 sc1
  buffer_store_dwordx4 v[104:107], v2, s[8:11], s24 offen offset:1024 sc1
  buffer_store_dwordx4 v[108:111], v2, s[8:11], s24 offen offset:2048 sc1
  buffer_store_dwordx4 v[4:7], v2, s[8:11], s24 offen offset:3072 sc1
  s_add_u32 s24, s24, 8192
  s_waitcnt vmcnt(0)
  s_mov_b64 exec, 1
  buffer_store_dword v117, v2, s[8:11], s34 offen sc1
  s_mov_b64 exec, -1
  s_add_u32 s34, s34, 8
  s_mov_b64 exec, 1
  buffer_store_dword v117, v2, s[8:11], s34 offen sc1
  s_mov_b64 exec, -1
  s_add_u32 s34, s34, 8
  s_branch cB_done
cB_abort:
  v_mov_b32 v4, 0xdead
  v_mov_b32 v5, 16
  buffer_store_dword v4, v5, s[12:15], 0 offen
  s_branch ch_end
cB_done:
  s_branch ch_end
m_reclaim:
  s_waitcnt vmcnt(0)
  s_lshr_b32 s20, s3, 5
  s_cmp_lg_u32 s16, 0
  s_cbranch_scc1 w0_17
  s_mov_b32 s21, 0
  s_mov_b64 exec, 1
rc_l:
  s_cmp_lg_u32 s70, -1
  s_cbranch_scc1 rc_t
  s_add_u32 s20, s20, 1
  s_cmp_lt_u32 s20, 8
  s_cselect_b32 s20, s20, 0
  s_mov_b32 s70, 0
  s_mov_b32 s3, -1
  s_add_u32 s21, s21, 1
  s_cmp_ge_u32 s21, 9
  s_cbranch_scc1 rc_d
rc_t:
  s_ff0_i32_b32 s22, s70
  s_lshl_b32 s23, 1, s22
  s_and_b32 s71, s20, 4
  s_mul_i32 s71, s71, 12
  s_lshl_b32 s3, s20, 2
  s_add_u32 s3, s3, s71
  v_mov_b32 v242, s23
  v_mov_b32 v243, 32
  buffer_atomic_or v242, v243, s[12:15], s3 offen sc0
  s_waitcnt vmcnt(0)
  v_readfirstlane_b32 s70, v242
  s_lshl_b32 s3, s20, 5
  s_add_u32 s3, s3, s22
  s_bitcmp1_b32 s70, s22
  s_cbranch_scc1 rc_l
rc_d:
  s_mov_b64 exec, -1
  v_mov_b32 v242, s3
w0_17:
  v_mov_b32 v250, 160000
  s_add_u32 s101, s101, 1
  s_barrier
  s_mov_b64 exec, 1
  s_cmp_lg_u32 s16, 0
  s_cbranch_scc1 w0_18
  ds_write_b32 v250, v242 offset:0
  s_waitcnt lgkmcnt(0)
  v_mov_b32 v242, s101
  ds_write_b32 v250, v242 offset:16
  s_waitcnt lgkmcnt(0)
w0_18:
  s_mov_b64 exec, -1
  s_barrier
  ds_read_b32 v242, v250 offset:0
  ds_read_b32 v250, v250 offset:16
  s_waitcnt lgkmcnt(0)
  v_readfirstlane_b32 s3, v242
  v_cmp_ne_u32 vcc, s101, v250
  s_cbranch_vccnz ch_end
  s_cmp_lg_u32 s3, -1
  s_cbranch_scc1 m_start
  v_mov_b32 v250, 0
  s_branch wk_ask
m_bjob:
  v_and_b32 v1, 63, v0
  v_lshlrev_b32 v2, 4, v1
  v_lshrrev_b32 v3, 4, v1
  v_and_b32 v4, 15, v1
  s_sub_u32 s18, s3, 32
  s_mul_i32 s17, s18, 4682
  s_lshr_b32 s17, s17, 16
  s_mul_i32 s20, s17, 14
  s_sub_u32 s19, s18, s20
  s_cmp_ge_u32 s19, 7
  s_cselect_b32 s31, 7, 0
  s_sub_u32 s19, s19, s31
  s_mov_b32 s60, s44
  s_and_b32 s61, s45, 0xffff
  s_mov_b32 s62, 3670016
  s_mov_b32 s63, 0x20000
  s_mov_b32 s56, s46
  s_and_b32 s57, s47, 0xffff
  s_mov_b32 s58, 3670016
  s_mov_b32 s59, 0x20000
  s_lshl_b32 s30, s16, 13
  s_mul_i32 s27, s17, 229376
  s_lshl_b32 s29, s19, 7
  s_add_u32 s27, s27, s29
  v_lshrrev_b32 v7, 3, v1
  v_and_b32 v8, 7, v1
  s_lshl_b32 s29, s16, 6
  v_add_u32 v7, s29, v7
  v_mul_u32_u24 v7, 896, v7
  v_lshl_add_u32 v7, v8, 4, v7
  s_add_u32 m0, s30, 0
  s_add_u32 s22, s27, 0
  buffer_load_dwordx4 v7, s[56:59], s22 offen offset:0 lds
  s_add_u32 s22, s27, 6144
  buffer_load_dwordx4 v7, s[56:59], s22 offen offset:1024 lds
  s_add_u32 s22, s27, 12288
  buffer_load_dwordx4 v7, s[56:59], s22 offen offset:2048 lds
  s_add_u32 s22, s27, 18432
  buffer_load_dwordx4 v7, s[56:59], s22 offen offset:3072 lds
  s_add_u32 m0, s30, 4096
  s_add_u32 s22, s27, 28672
  buffer_load_dwordx4 v7, s[56:59], s22 offen offset:0 lds
  s_add_u32 s22, s27, 34816
  buffer_load_dwordx4 v7, s[56:59], s22 offen offset:1024 lds
  s_add_u32 s22, s27, 40960
  buffer_load_dwordx4 v7, s[56:59], s22 offen offset:2048 lds
  s_add_u32 s22, s27, 47104
  buffer_load_dwordx4 v7, s[56:59], s22 offen offset:3072 lds
  v_lshrrev_b32 v5, 5, v1
  v_and_b32 v6, 31, v1
  s_lshl_b32 s25, s16, 15
  s_add_u32 s25, s25, 32768
  s_lshl_b32 s26, s17, 9
  s_add_u32 s28, s19, s16
  s_cmp_ge_u32 s28, 7
  s_cselect_b32 s20, 7, 0
  s_sub_u32 s28, s28, s20
  s_add_u32 s28, s28, s31
  s_add_u32 s29, s19, s16
  s_add_u32 s29, s29, 4
  s_cmp_ge_u32 s29, 7
  s_cselect_b32 s20, 7, 0
  s_sub_u32 s29, s29, s20
  s_add_u32 s29, s29, s31
  s_lshl_b32 s32, s28, 18
  s_add_u32 s32, s32, s26
  s_lshl_b32 s33, s29, 18
  s_add_u32 s33, s33, s26
  v_xor_b32 v8, v6, v5
  v_lshlrev_b32 v8, 4, v8
  v_lshl_add_u32 v8, v5, 13, v8
  v_xor_b32 v12, 0, v8
  v_xor_b32 v13, 32, v8
  v_add_u32 v13, 15360, v13
  v_xor_b32 v14, 0, v8
  v_add_u32 v14, 30720, v14
  v_xor_b32 v15, 32, v8
  v_add_u32 v15, 46080, v15
  s_add_u32 s20, s16, 0
  s_and_b32 s20, s20, 3
  s_mul_i32 s21, s20, 65600
  s_lshl_b32 s20, s20, 12
  s_add_u32 s48, s20, s25
  s_mov_b32 m0, s48
  v_xor_b32 v16, s21, v12
  buffer_load_dwordx4 v16, s[60:63], s32 offen offset:0 lds
  v_xor_b32 v17, s21, v13
  buffer_load_dwordx4 v17, s[60:63], s32 offen offset:1024 lds
  v_xor_b32 v18, s21, v14
  buffer_load_dwordx4 v18, s[60:63], s32 offen offset:2048 lds
  v_xor_b32 v19, s21, v15
  buffer_load_dwordx4 v19, s[60:63], s32 offen offset:3072 lds
  s_add_u32 s20, s16, 1
  s_and_b32 s20, s20, 3
  s_mul_i32 s21, s20, 65600
  s_lshl_b32 s20, s20, 12
  s_add_u32 s49, s20, s25
  s_mov_b32 m0, s49
  v_xor_b32 v20, s21, v12
  buffer_load_dwordx4 v20, s[60:63], s32 offen offset:0 lds
  v_xor_b32 v21, s21, v13
  buffer_load_dwordx4 v21, s[60:63], s32 offen offset:1024 lds
  v_xor_b32 v22, s21, v14
  buffer_load_dwordx4 v22, s[60:63], s32 offen offset:2048 lds
  v_xor_b32 v23, s21, v15
  buffer_load_dwordx4 v23, s[60:63], s32 offen offset:3072 lds
  s_add_u32 s20, s16, 2
  s_and_b32 s20, s20, 3
  s_mul_i32 s21, s20, 65600
  s_lshl_b32 s20, s20, 12
  s_add_u32 s50, s20, s25
  s_mov_b32 m0, s50
  v_xor_b32 v24, s21, v12
  buffer_load_dwordx4 v24, s[60:63], s32 offen offset:0 lds
  v_xor_b32 v25, s21, v13
  buffer_load_dwordx4 v25, s[60:63], s32 offen offset:1024 lds
  v_xor_b32 v26, s21, v14
  buffer_load_dwordx4 v26, s[60:63], s32 offen offset:2048 lds
  v_xor_b32 v27, s21, v15
  buffer_load_dwordx4 v27, s[60:63], s32 offen offset:3072 lds
  s_add_u32 s20, s16, 3
  s_and_b32 s20, s20, 3
  s_mul_i32 s21, s20, 65600
  s_lshl_b32 s20, s20, 12
  s_add_u32 s51, s20, s25
  s_mov_b32 m0, s51
  v_xor_b32 v28, s21, v12
  buffer_load_dwordx4 v28, s[60:63], s32 offen offset:0 lds
  v_xor_b32 v29, s21, v13
  buffer_load_dwordx4 v29, s[60:63], s32 offen offset:1024 lds
  v_xor_b32 v30, s21, v14
  buffer_load_dwordx4 v30, s[60:63], s32 offen offset:2048 lds
  v_xor_b32 v31, s21, v15
  buffer_load_dwordx4 v31, s[60:63], s32 offen offset:3072 lds
  s_cmp_eq_u32 s16, 3
  s_cbranch_scc1 bj_np1
  s_add_u32 m0, s48, 16384
  s_nop 0
  buffer_load_dwordx4 v16, s[60:63], s33 offen offset:0 lds
  buffer_load_dwordx4 v17, s[60:63], s33 offen offset:1024 lds
  buffer_load_dwordx4 v18, s[60:63], s33 offen offset:2048 lds
  buffer_load_dwordx4 v19, s[60:63], s33 offen offset:3072 lds
  s_add_u32 m0, s49, 16384
  s_nop 0
  buffer_load_dwordx4 v20, s[60:63], s33 offen offset:0 lds
  buffer_load_dwordx4 v21, s[60:63], s33 offen offset:1024 lds
  buffer_load_dwordx4 v22, s[60:63], s33 offen offset:2048 lds
  buffer_load_dwordx4 v23, s[60:63], s33 offen offset:3072 lds
  s_add_u32 m0, s50, 16384
  s_nop 0
  buffer_load_dwordx4 v24, s[60:63], s33 offen offset:0 lds
  buffer_load_dwordx4 v25, s[60:63], s33 offen offset:1024 lds
  buffer_load_dwordx4 v26, s[60:63], s33 offen offset:2048 lds
  buffer_load_dwordx4 v27, s[60:63], s33 offen offset:3072 lds
  s_add_u32 m0, s51, 16384
  s_nop 0
  buffer_load_dwordx4 v28, s[60:63], s33 offen offset:0 lds
  buffer_load_dwordx4 v29, s[60:63], s33 offen offset:1024 lds
  buffer_load_dwordx4 v30, s[60:63], s33 offen offset:2048 lds
  buffer_load_dwordx4 v31, s[60:63], s33 offen offset:3072 lds
bj_np1:
  s_mov_b32 s52, s36
  s_and_b32 s53, s37, 0xffff
  s_mov_b32 s54, 1835008
  s_mov_b32 s55, 0x20000
  s_lshl_b32 s20, s18, 8
  v_add_u32 v95, s20, v0
  s_mov_b32 s21, 9586981
  v_mul_hi_u32 v6, v95, s21
  v_mul_u32_u24 v7, 448, v6
  v_sub_u32 v7, v95, v7
  v_lshrrev_b32 v8, 4, v7
  v_and_b32 v7, 15, v7
  v_lshl_add_u32 v9, v6, 4, v7
  v_mul_u32_u24 v9, 896, v9
  v_lshl_add_u32 v9, v8, 5, v9
  buffer_load_dwordx4 v[84:87], v9, s[52:55], 0 offen
  buffer_load_dwordx4 v[88:91], v9, s[52:55], 0 offen offset:16
  v_mul_u32_u24 v6, 14336, v6
  v_lshl_add_u32 v6, v7, 4, v6
  v_lshl_add_u32 v92, v8, 9, v6
  v_lshrrev_b32 v7, 2, v8
  v_lshl_add_u32 v6, v7, 11, v6
  v_and_b32 v7, 3, v8
  v_lshl_add_u32 v93, v7, 8, v6
  s_mov_b32 s72, s38
  s_and_b32 s73, s39, 0xffff
  s_mov_b32 s74, 7168
  s_mov_b32 s75, 0x20000
  v_min_u32 v6, 223, v0
  v_lshrrev_b32 v7, 3, v6
  v_and_b32 v6, 7, v6
  v_mul_u32_u24 v9, 896, v6
  v_lshl_add_u32 v9, v7, 5, v9
  buffer_load_dwordx4 v[36:39], v9, s[72:75], 0 offen
  buffer_load_dwordx4 v[40:43], v9, s[72:75], 0 offen offset:16
  v_lshlrev_b32 v7, 8, v7
  v_lshl_add_u32 v94, v6, 4, v7
  s_cmp_lt_u32 s16, 2
  s_cselect_b32 s20, s40, s42
  s_cselect_b32 s21, s41, s43
  s_mov_b32 s72, s20
  s_and_b32 s73, s21, 0xffff
  s_mov_b32 s74, 3670016
  s_mov_b32 s75, 0x20000
  s_add_u32 s20, s19, s31
  s_lshl_b32 s21, s20, 5
  s_lshl_b32 s22, s16, 4
  s_add_u32 s21, s21, s22
  s_mul_i32 s20, s20, 14
  s_add_u32 s20, s20, 250
  s_cmp_lt_u32 s16, 2
  s_cselect_b32 s20, s21, s20
  s_lshl_b32 s20, s20, 13
  s_add_u32 s20, s20, s26
  v_lshlrev_b32 v6, 13, v4
  v_lshl_add_u32 v6, v3, 7, v6
  buffer_load_dword v51, v6, s[72:75], s20 offen
  s_cmp_lg_u32 s66, 0
  s_cbranch_scc1 bj_ci
  s_cmp_lg_u32 s16, 0
  s_cbranch_scc1 w0_19
  s_lshr_b32 s70, s3, 5
  s_and_b32 s71, s70, 4
  s_mul_i32 s71, s71, 12
  s_lshl_b32 s70, s70, 2
  s_add_u32 s70, s70, s71
  s_lshl_b32 s71, 1, s3
  v_mov_b32 v44, s71
  v_mov_b32 v45, 32
  s_mov_b64 exec, 1
  buffer_atomic_or v44, v45, s[12:15], s70 offen sc0
  buffer_load_dwordx2 v[46:47], v45, s[12:15], 0 offen offset:96 sc1
  s_mov_b64 exec, -1
w0_19:
bj_ci:
  s_lshl_b32 s30, s19, 6
  s_add_u32 s30, s30, 0
  v_add_u32 v8, s30, v4
  v_mul_u32_u24 v10, 2341, v8
  v_lshrrev_b32 v10, 16, v10
  v_mul_u32_u24 v11, 28, v10
  v_sub_u32 v32, v8, v11
  s_mul_i32 s30, s17, 28
  v_add_u32 v32, s30, v32
  v_lshrrev_b32 v33, 4, v32
  v_and_b32 v32, 15, v32
  s_mov_b32 s30, 401408
  v_mul_lo_u32 v10, v10, s30
  v_mul_u32_u24 v33, 14336, v33
  v_add_u32 v10, v10, v33
  v_lshl_add_u32 v10, v3, 8, v10
  v_lshl_add_u32 v10, v32, 4, v10
  v_add_u32 v12, 6422528, v10
  s_lshl_b32 s30, s19, 6
  s_add_u32 s30, s30, 16
  v_add_u32 v8, s30, v4
  v_mul_u32_u24 v10, 2341, v8
  v_lshrrev_b32 v10, 16, v10
  v_mul_u32_u24 v11, 28, v10
  v_sub_u32 v32, v8, v11
  s_mul_i32 s30, s17, 28
  v_add_u32 v32, s30, v32
  v_lshrrev_b32 v33, 4, v32
  v_and_b32 v32, 15, v32
  s_mov_b32 s30, 401408
  v_mul_lo_u32 v10, v10, s30
  v_mul_u32_u24 v33, 14336, v33
  v_add_u32 v10, v10, v33
  v_lshl_add_u32 v10, v3, 8, v10
  v_lshl_add_u32 v10, v32, 4, v10
  v_add_u32 v13, 6422528, v10
  s_lshl_b32 s30, s19, 6
  s_add_u32 s30, s30, 32
  v_add_u32 v8, s30, v4
  v_mul_u32_u24 v10, 2341, v8
  v_lshrrev_b32 v10, 16, v10
  v_mul_u32_u24 v11, 28, v10
  v_sub_u32 v32, v8, v11
  s_mul_i32 s30, s17, 28
  v_add_u32 v32, s30, v32
  v_lshrrev_b32 v33, 4, v32
  v_and_b32 v32, 15, v32
  s_mov_b32 s30, 401408
  v_mul_lo_u32 v10, v10, s30
  v_mul_u32_u24 v33, 14336, v33
  v_add_u32 v10, v10, v33
  v_lshl_add_u32 v10, v3, 8, v10
  v_lshl_add_u32 v10, v32, 4, v10
  v_add_u32 v14, 6422528, v10
  s_lshl_b32 s30, s19, 6
  s_add_u32 s30, s30, 48
  v_add_u32 v8, s30, v4
  v_mul_u32_u24 v10, 2341, v8
  v_lshrrev_b32 v10, 16, v10
  v_mul_u32_u24 v11, 28, v10
  v_sub_u32 v32, v8, v11
  s_mul_i32 s30, s17, 28
  v_add_u32 v32, s30, v32
  v_lshrrev_b32 v33, 4, v32
  v_and_b32 v32, 15, v32
  s_mov_b32 s30, 401408
  v_mul_lo_u32 v10, v10, s30
  v_mul_u32_u24 v33, 14336, v33
  v_add_u32 v10, v10, v33
  v_lshl_add_u32 v10, v3, 8, v10
  v_lshl_add_u32 v10, v32, 4, v10
  v_add_u32 v15, 6422528, v10
  v_lshrrev_b32 v7, 2, v4
  v_lshlrev_b32 v7, 3, v7
  v_and_b32 v8, 3, v4
  v_add_u32 v7, v7, v8
  v_xor_b32 v10, v3, v4
  v_lshlrev_b32 v10, 4, v10
  v_lshl_add_u32 v10, v7, 9, v10
  v_add_u32 v10, s25, v10
  v_xor_b32 v32, 0, v10
  v_xor_b32 v33, 64, v10
  v_xor_b32 v34, 128, v10
  v_xor_b32 v35, 192, v10
  v_lshrrev_b32 v7, 2, v4
  v_lshl_add_u32 v7, v3, 3, v7
  v_lshlrev_b32 v7, 7, v7
  v_and_b32 v8, 3, v4
  v_lshl_add_u32 v7, v8, 3, v7
  s_waitcnt vmcnt(37)
  s_cmp_lg_u32 s16, 3
  s_cbranch_scc1 w3_20
  s_waitcnt vmcnt(21)
w3_20:
  s_barrier
  ds_read_b64_tr_b16 v[128:129], v7 offset:0
  ds_read_b64_tr_b16 v[130:131], v7 offset:512
  ds_read_b64_tr_b16 v[132:133], v7 offset:4096
  ds_read_b64_tr_b16 v[134:135], v7 offset:4608
  ds_read_b64_tr_b16 v[136:137], v7 offset:8192
  ds_read_b64_tr_b16 v[138:139], v7 offset:8704
  ds_read_b64_tr_b16 v[140:141], v7 offset:12288
  ds_read_b64_tr_b16 v[142:143], v7 offset:12800
  s_waitcnt lgkmcnt(6)
  ds_read_b64_tr_b16 v[144:145], v7 offset:16384
  ds_read_b64_tr_b16 v[146:147], v7 offset:16896
  ds_read_b64_tr_b16 v[148:149], v7 offset:20480
  ds_read_b64_tr_b16 v[150:151], v7 offset:20992
  ds_read_b64_tr_b16 v[152:153], v7 offset:24576
  ds_read_b64_tr_b16 v[154:155], v7 offset:25088
  ds_read_b64_tr_b16 v[156:157], v7 offset:28672
  ds_read_b64_tr_b16 v[158:159], v7 offset:29184
  s_waitcnt lgkmcnt(6)
  ds_read_b64_tr_b16 v[160:161], v7 offset:32
  ds_read_b64_tr_b16 v[162:163], v7 offset:544
  ds_read_b64_tr_b16 v[164:165], v7 offset:4128
  ds_read_b64_tr_b16 v[166:167], v7 offset:4640
  ds_read_b64_tr_b16 v[168:169], v7 offset:8224
  ds_read_b64_tr_b16 v[170:171], v7 offset:8736
  ds_read_b64_tr_b16 v[172:173], v7 offset:12320
  ds_read_b64_tr_b16 v[174:175], v7 offset:12832
  s_waitcnt lgkmcnt(6)
  ds_read_b64_tr_b16 v[176:177], v7 offset:16416
  ds_read_b64_tr_b16 v[178:179], v7 offset:16928
  ds_read_b64_tr_b16 v[180:181], v7 offset:20512
  ds_read_b64_tr_b16 v[182:183], v7 offset:21024
  ds_read_b64_tr_b16 v[184:185], v7 offset:24608
  ds_read_b64_tr_b16 v[186:187], v7 offset:25120
  ds_read_b64_tr_b16 v[188:189], v7 offset:28704
  ds_read_b64_tr_b16 v[190:191], v7 offset:29216
  s_waitcnt lgkmcnt(6)
  ds_read_b64_tr_b16 v[192:193], v7 offset:64
  ds_read_b64_tr_b16 v[194:195], v7 offset:576
  ds_read_b64_tr_b16 v[196:197], v7 offset:4160
  ds_read_b64_tr_b16 v[198:199], v7 offset:4672
  ds_read_b64_tr_b16 v[200:201], v7 offset:8256
  ds_read_b64_tr_b16 v[202:203], v7 offset:8768
  ds_read_b64_tr_b16 v[204:205], v7 offset:12352
  ds_read_b64_tr_b16 v[206:207], v7 offset:12864
  s_waitcnt lgkmcnt(6)
  ds_read_b64_tr_b16 v[208:209], v7 offset:16448
  ds_read_b64_tr_b16 v[210:211], v7 offset:16960
  ds_read_b64_tr_b16 v[212:213], v7 offset:20544
  ds_read_b64_tr_b16 v[214:215], v7 offset:21056
  ds_read_b64_tr_b16 v[216:217], v7 offset:24640
  ds_read_b64_tr_b16 v[218:219], v7 offset:25152
  ds_read_b64_tr_b16 v[220:221], v7 offset:28736
  ds_read_b64_tr_b16 v[222:223], v7 offset:29248
  s_waitcnt lgkmcnt(6)
  ds_read_b64_tr_b16 v[224:225], v7 offset:96
  ds_read_b64_tr_b16 v[226:227], v7 offset:608
  ds_read_b64_tr_b16 v[228:229], v7 offset:4192
  ds_read_b64_tr_b16 v[230:231], v7 offset:4704
  ds_read_b64_tr_b16 v[232:233], v7 offset:8288
  ds_read_b64_tr_b16 v[234:235], v7 offset:8800
  ds_read_b64_tr_b16 v[236:237], v7 offset:12384
  ds_read_b64_tr_b16 v[238:239], v7 offset:12896
  s_waitcnt lgkmcnt(6)
  ds_read_b64_tr_b16 v[240:241], v7 offset:16480
  ds_read_b64_tr_b16 v[242:243], v7 offset:16992
  ds_read_b64_tr_b16 v[244:245], v7 offset:20576
  ds_read_b64_tr_b16 v[246:247], v7 offset:21088
  ds_read_b64_tr_b16 v[248:249], v7 offset:24672
  ds_read_b64_tr_b16 v[250:251], v7 offset:25184
  ds_read_b64_tr_b16 v[252:253], v7 offset:28768
  ds_read_b64_tr_b16 v[254:255], v7 offset:29280
  s_waitcnt lgkmcnt(6)
  s_waitcnt vmcnt(21) lgkmcnt(0)
  s_cmp_lg_u32 s16, 3
  s_cbranch_scc1 w3_21
  s_waitcnt vmcnt(5)
w3_21:
  ds_read_b128 v[52:55], v32 offset:0
  ds_read_b128 v[56:59], v33 offset:0
  ds_read_b128 v[60:63], v34 offset:0
  ds_read_b128 v[64:67], v35 offset:0
  s_waitcnt lgkmcnt(3)
  v_mfma_f32_16x16x32_bf16 v[96:99], v[52:55], v[128:131], 0
  v_mfma_f32_16x16x32_bf16 v[100:103], v[52:55], v[160:163], 0
  v_mfma_f32_16x16x32_bf16 v[104:107], v[52:55], v[192:195], 0
  v_mfma_f32_16x16x32_bf16 v[108:111], v[52:55], v[224:227], 0
  ds_read_b128 v[52:55], v32 offset:256
  s_waitcnt lgkmcnt(3)
  v_mfma_f32_16x16x32_bf16 v[96:99], v[56:59], v[132:135], v[96:99]
  v_mfma_f32_16x16x32_bf16 v[100:103], v[56:59], v[164:167], v[100:103]
  v_mfma_f32_16x16x32_bf16 v[104:107], v[56:59], v[196:199], v[104:107]
  v_mfma_f32_16x16x32_bf16 v[108:111], v[56:59], v[228:231], v[108:111]
  ds_read_b128 v[56:59], v33 offset:256
  s_waitcnt lgkmcnt(3)
  v_mfma_f32_16x16x32_bf16 v[96:99], v[60:63], v[136:139], v[96:99]
  v_mfma_f32_16x16x32_bf16 v[100:103], v[60:63], v[168:171], v[100:103]
  v_mfma_f32_16x16x32_bf16 v[104:107], v[60:63], v[200:203], v[104:107]
  v_mfma_f32_16x16x32_bf16 v[108:111], v[60:63], v[232:235], v[108:111]
  ds_read_b128 v[60:63], v34 offset:256
  s_waitcnt lgkmcnt(3)
  v_mfma_f32_16x16x32_bf16 v[96:99], v[64:67], v[140:143], v[96:99]
  v_mfma_f32_16x16x32_bf16 v[100:103], v[64:67], v[172:175], v[100:103]
  v_mfma_f32_16x16x32_bf16 v[104:107], v[64:67], v[204:207], v[104:107]
  v_mfma_f32_16x16x32_bf16 v[108:111], v[64:67], v[236:239], v[108:111]
  ds_read_b128 v[64:67], v35 offset:256
  s_waitcnt lgkmcnt(3)
  v_mfma_f32_16x16x32_bf16 v[96:99], v[52:55], v[144:147], v[96:99]
  v_mfma_f32_16x16x32_bf16 v[100:103], v[52:55], v[176:179], v[100:103]
  v_mfma_f32_16x16x32_bf16 v[104:107], v[52:55], v[208:211], v[104:107]
  v_mfma_f32_16x16x32_bf16 v[108:111], v[52:55], v[240:243], v[108:111]
  ds_read_b128 v[52:55], v32 offset:2048
  s_waitcnt lgkmcnt(3)
  v_mfma_f32_16x16x32_bf16 v[96:99], v[56:59], v[148:151], v[96:99]
  v_mfma_f32_16x16x32_bf16 v[100:103], v[56:59], v[180:183], v[100:103]
  v_mfma_f32_16x16x32_bf16 v[104:107], v[56:59], v[212:215], v[104:107]
  v_mfma_f32_16x16x32_bf16 v[108:111], v[56:59], v[244:247], v[108:111]
  ds_read_b128 v[56:59], v33 offset:2048
  s_waitcnt lgkmcnt(3)
  v_mfma_f32_16x16x32_bf16 v[96:99], v[60:63], v[152:155], v[96:99]
  v_mfma_f32_16x16x32_bf16 v[100:103], v[60:63], v[184:187], v[100:103]
  v_mfma_f32_16x16x32_bf16 v[104:107], v[60:63], v[216:219], v[104:107]
  v_mfma_f32_16x16x32_bf16 v[108:111], v[60:63], v[248:251], v[108:111]
  ds_read_b128 v[60:63], v34 offset:2048
  s_waitcnt lgkmcnt(3)
  v_mfma_f32_16x16x32_bf16 v[96:99], v[64:67], v[156:159], v[96:99]
  v_mfma_f32_16x16x32_bf16 v[100:103], v[64:67], v[188:191], v[100:103]
  v_mfma_f32_16x16x32_bf16 v[104:107], v[64:67], v[220:223], v[104:107]
  v_mfma_f32_16x16x32_bf16 v[108:111], v[64:67], v[252:255], v[108:111]
  ds_read_b128 v[64:67], v35 offset:2048
  s_waitcnt lgkmcnt(3)
  v_mfma_f32_16x16x32_bf16 v[112:115], v[52:55], v[128:131], 0
  v_mfma_f32_16x16x32_bf16 v[116:119], v[52:55], v[160:163], 0
  v_mfma_f32_16x16x32_bf16 v[120:123], v[52:55], v[192:195], 0
  v_mfma_f32_16x16x32_bf16 v[124:127], v[52:55], v[224:227], 0
  ds_read_b128 v[52:55], v32 offset:2304
  s_waitcnt lgkmcnt(3)
  v_mfma_f32_16x16x32_bf16 v[112:115], v[56:59], v[132:135], v[112:115]
  v_mfma_f32_16x16x32_bf16 v[116:119], v[56:59], v[164:167], v[116:119]
  v_mfma_f32_16x16x32_bf16 v[120:123], v[56:59], v[196:199], v[120:123]
  v_mfma_f32_16x16x32_bf16 v[124:127], v[56:59], v[228:231], v[124:127]
  ds_read_b128 v[56:59], v33 offset:2304
  s_waitcnt lgkmcnt(3)
  v_mfma_f32_16x16x32_bf16 v[112:115], v[60:63], v[136:139], v[112:115]
  v_mfma_f32_16x16x32_bf16 v[116:119], v[60:63], v[168:171], v[116:119]
  v_mfma_f32_16x16x32_bf16 v[120:123], v[60:63], v[200:203], v[120:123]
  v_mfma_f32_16x16x32_bf16 v[124:127], v[60:63], v[232:235], v[124:127]
  ds_read_b128 v[60:63], v34 offset:2304
  s_waitcnt lgkmcnt(3)
  v_mfma_f32_16x16x32_bf16 v[112:115], v[64:67], v[140:143], v[112:115]
  v_mfma_f32_16x16x32_bf16 v[116:119], v[64:67], v[172:175], v[116:119]
  v_mfma_f32_16x16x32_bf16 v[120:123], v[64:67], v[204:207], v[120:123]
  v_mfma_f32_16x16x32_bf16 v[124:127], v[64:67], v[236:239], v[124:127]
  ds_read_b128 v[64:67], v35 offset:2304
  s_waitcnt lgkmcnt(3)
  v_mfma_f32_16x16x32_bf16 v[112:115], v[52:55], v[144:147], v[112:115]
  v_mfma_f32_16x16x32_bf16 v[116:119], v[52:55], v[176:179], v[116:119]
  v_mfma_f32_16x16x32_bf16 v[120:123], v[52:55], v[208:211], v[120:123]
  v_mfma_f32_16x16x32_bf16 v[124:127], v[52:55], v[240:243], v[124:127]
  s_waitcnt lgkmcnt(2)
  v_mfma_f32_16x16x32_bf16 v[112:115], v[56:59], v[148:151], v[112:115]
  v_mfma_f32_16x16x32_bf16 v[116:119], v[56:59], v[180:183], v[116:119]
  v_mfma_f32_16x16x32_bf16 v[120:123], v[56:59], v[212:215], v[120:123]
  v_mfma_f32_16x16x32_bf16 v[124:127], v[56:59], v[244:247], v[124:127]
  s_waitcnt lgkmcnt(1)
  v_mfma_f32_16x16x32_bf16 v[112:115], v[60:63], v[152:155], v[112:115]
  v_mfma_f32_16x16x32_bf16 v[116:119], v[60:63], v[184:187], v[116:119]
  v_mfma_f32_16x16x32_bf16 v[120:123], v[60:63], v[216:219], v[120:123]
  v_mfma_f32_16x16x32_bf16 v[124:127], v[60:63], v[248:251], v[124:127]
  s_waitcnt lgkmcnt(0)
  v_mfma_f32_16x16x32_bf16 v[112:115], v[64:67], v[156:159], v[112:115]
  v_mfma_f32_16x16x32_bf16 v[116:119], v[64:67], v[188:191], v[116:119]
  v_mfma_f32_16x16x32_bf16 v[120:123], v[64:67], v[220:223], v[120:123]
  v_mfma_f32_16x16x32_bf16 v[124:127], v[64:67], v[252:255], v[124:127]
  s_cmp_lg_u32 s66, 0
  s_cbranch_scc1 bj_cf
  s_cmp_lg_u32 s16, 0
  s_cbranch_scc1 w0_22
  s_waitcnt vmcnt(0)
  v_readfirstlane_b32 s70, v46
  s_cmp_lg_u32 s70, 0
  s_cbranch_scc1 bj_nz
  v_mov_b32 v45, 128
  v_mov_b32 v46, s88
  v_mov_b32 v47, s89
  v_mov_b32 v48, 0
  v_mov_b32 v49, 0
  s_mov_b64 exec, 1
  buffer_atomic_cmpswap_x2 v[46:49], v45, s[12:15], 0 offen sc0
  s_mov_b64 exec, -1
  s_waitcnt vmcnt(0)
  v_readfirstlane_b32 s70, v46
  s_cmp_lg_u32 s70, 0
  s_cbranch_scc1 bj_nz
  v_mov_b32 v46, s88
  v_mov_b32 v47, s89
bj_nz:
w0_22:
  v_mov_b32 v45, 160000
  s_add_u32 s101, s101, 1
  s_barrier
  s_mov_b64 exec, 1
  s_cmp_lg_u32 s16, 0
  s_cbranch_scc1 w0_23
  ds_write_b32 v45, v44 offset:0
  ds_write_b32 v45, v46 offset:4
  ds_write_b32 v45, v47 offset:8
  s_waitcnt lgkmcnt(0)
  v_mov_b32 v44, s101
  ds_write_b32 v45, v44 offset:16
  s_waitcnt lgkmcnt(0)
w0_23:
  s_mov_b64 exec, -1
  s_barrier
  ds_read_b32 v44, v45 offset:0
  ds_read_b32 v46, v45 offset:4
  ds_read_b32 v47, v45 offset:8
  ds_read_b32 v45, v45 offset:16
  s_waitcnt lgkmcnt(0)
  v_readfirstlane_b32 s70, v44
  v_readfirstlane_b32 s88, v46
  v_readfirstlane_b32 s89, v47
  v_cmp_ne_u32 vcc, s101, v45
  s_cbranch_vccnz ch_end
  s_mov_b32 s66, 1
  s_bitcmp1_b32 s70, s3
  s_cbranch_scc1 m_reclaim
bj_cf:
  s_lshl_b32 s30, s28, 10
  v_cvt_pk_bf16_f32 v68, v96, v97
  v_cvt_pk_bf16_f32 v69, v98, v99
  v_cvt_pk_bf16_f32 v70, v112, v113
  v_cvt_pk_bf16_f32 v71, v114, v115
  buffer_store_dwordx4 v[68:71], v12, s[8:11], s30 offen sc1
  v_cvt_pk_bf16_f32 v72, v100, v101
  v_cvt_pk_bf16_f32 v73, v102, v103
  v_cvt_pk_bf16_f32 v74, v116, v117
  v_cvt_pk_bf16_f32 v75, v118, v119
  buffer_store_dwordx4 v[72:75], v13, s[8:11], s30 offen sc1
  v_cvt_pk_bf16_f32 v76, v104, v105
  v_cvt_pk_bf16_f32 v77, v106, v107
  v_cvt_pk_bf16_f32 v78, v120, v121
  v_cvt_pk_bf16_f32 v79, v122, v123
  buffer_store_dwordx4 v[76:79], v14, s[8:11], s30 offen sc1
  v_cvt_pk_bf16_f32 v80, v108, v109
  v_cvt_pk_bf16_f32 v81, v110, v111
  v_cvt_pk_bf16_f32 v82, v124, v125
  v_cvt_pk_bf16_f32 v83, v126, v127
  buffer_store_dwordx4 v[80:83], v15, s[8:11], s30 offen sc1
  s_cmp_eq_u32 s16, 3
  s_cbranch_scc1 bj_w3
  s_waitcnt vmcnt(9)
  ds_read_b128 v[52:55], v32 offset:16384
  ds_read_b128 v[56:59], v33 offset:16384
  ds_read_b128 v[60:63], v34 offset:16384
  ds_read_b128 v[64:67], v35 offset:16384
  s_waitcnt lgkmcnt(3)
  v_mfma_f32_16x16x32_bf16 v[96:99], v[52:55], v[128:131], 0
  v_mfma_f32_16x16x32_bf16 v[100:103], v[52:55], v[160:163], 0
  v_mfma_f32_16x16x32_bf16 v[104:107], v[52:55], v[192:195], 0
  v_mfma_f32_16x16x32_bf16 v[108:111], v[52:55], v[224:227], 0
  ds_read_b128 v[52:55], v32 offset:16640
  s_waitcnt lgkmcnt(3)
  v_mfma_f32_16x16x32_bf16 v[96:99], v[56:59], v[132:135], v[96:99]
  v_mfma_f32_16x16x32_bf16 v[100:103], v[56:59], v[164:167], v[100:103]
  v_mfma_f32_16x16x32_bf16 v[104:107], v[56:59], v[196:199], v[104:107]
  v_mfma_f32_16x16x32_bf16 v[108:111], v[56:59], v[228:231], v[108:111]
  ds_read_b128 v[56:59], v33 offset:16640
  s_waitcnt lgkmcnt(3)
  v_mfma_f32_16x16x32_bf16 v[96:99], v[60:63], v[136:139], v[96:99]
  v_mfma_f32_16x16x32_bf16 v[100:103], v[60:63], v[168:171], v[100:103]
  v_mfma_f32_16x16x32_bf16 v[104:107], v[60:63], v[200:203], v[104:107]
  v_mfma_f32_16x16x32_bf16 v[108:111], v[60:63], v[232:235], v[108:111]
  ds_read_b128 v[60:63], v34 offset:16640
  s_waitcnt lgkmcnt(3)
  v_mfma_f32_16x16x32_bf16 v[96:99], v[64:67], v[140:143], v[96:99]
  v_mfma_f32_16x16x32_bf16 v[100:103], v[64:67], v[172:175], v[100:103]
  v_mfma_f32_16x16x32_bf16 v[104:107], v[64:67], v[204:207], v[104:107]
  v_mfma_f32_16x16x32_bf16 v[108:111], v[64:67], v[236:239], v[108:111]
  ds_read_b128 v[64:67], v35 offset:16640
  s_waitcnt lgkmcnt(3)
  v_mfma_f32_16x16x32_bf16 v[96:99], v[52:55], v[144:147], v[96:99]
  v_mfma_f32_16x16x32_bf16 v[100:103], v[52:55], v[176:179], v[100:103]
  v_mfma_f32_16x16x32_bf16 v[104:107], v[52:55], v[208:211], v[104:107]
  v_mfma_f32_16x16x32_bf16 v[108:111], v[52:55], v[240:243], v[108:111]
  ds_read_b128 v[52:55], v32 offset:18432
  s_waitcnt lgkmcnt(3)
  v_mfma_f32_16x16x32_bf16 v[96:99], v[56:59], v[148:151], v[96:99]
  v_mfma_f32_16x16x32_bf16 v[100:103], v[56:59], v[180:183], v[100:103]
  v_mfma_f32_16x16x32_bf16 v[104:107], v[56:59], v[212:215], v[104:107]
  v_mfma_f32_16x16x32_bf16 v[108:111], v[56:59], v[244:247], v[108:111]
  ds_read_b128 v[56:59], v33 offset:18432
  s_waitcnt lgkmcnt(3)
  v_mfma_f32_16x16x32_bf16 v[96:99], v[60:63], v[152:155], v[96:99]
  v_mfma_f32_16x16x32_bf16 v[100:103], v[60:63], v[184:187], v[100:103]
  v_mfma_f32_16x16x32_bf16 v[104:107], v[60:63], v[216:219], v[104:107]
  v_mfma_f32_16x16x32_bf16 v[108:111], v[60:63], v[248:251], v[108:111]
  ds_read_b128 v[60:63], v34 offset:18432
  s_waitcnt lgkmcnt(3)
  v_mfma_f32_16x16x32_bf16 v[96:99], v[64:67], v[156:159], v[96:99]
  v_mfma_f32_16x16x32_bf16 v[100:103], v[64:67], v[188:191], v[100:103]
  v_mfma_f32_16x16x32_bf16 v[104:107], v[64:67], v[220:223], v[104:107]
  v_mfma_f32_16x16x32_bf16 v[108:111], v[64:67], v[252:255], v[108:111]
  ds_read_b128 v[64:67], v35 offset:18432
  s_waitcnt lgkmcnt(3)
  v_mfma_f32_16x16x32_bf16 v[112:115], v[52:55], v[128:131], 0
  v_mfma_f32_16x16x32_bf16 v[116:119], v[52:55], v[160:163], 0
  v_mfma_f32_16x16x32_bf16 v[120:123], v[52:55], v[192:195], 0
  v_mfma_f32_16x16x32_bf16 v[124:127], v[52:55], v[224:227], 0
  ds_read_b128 v[52:55], v32 offset:18688
  s_waitcnt lgkmcnt(3)
  v_mfma_f32_16x16x32_bf16 v[112:115], v[56:59], v[132:135], v[112:115]
  v_mfma_f32_16x16x32_bf16 v[116:119], v[56:59], v[164:167], v[116:119]
  v_mfma_f32_16x16x32_bf16 v[120:123], v[56:59], v[196:199], v[120:123]
  v_mfma_f32_16x16x32_bf16 v[124:127], v[56:59], v[228:231], v[124:127]
  ds_read_b128 v[56:59], v33 offset:18688
  s_waitcnt lgkmcnt(3)
  v_mfma_f32_16x16x32_bf16 v[112:115], v[60:63], v[136:139], v[112:115]
  v_mfma_f32_16x16x32_bf16 v[116:119], v[60:63], v[168:171], v[116:119]
  v_mfma_f32_16x16x32_bf16 v[120:123], v[60:63], v[200:203], v[120:123]
  v_mfma_f32_16x16x32_bf16 v[124:127], v[60:63], v[232:235], v[124:127]
  ds_read_b128 v[60:63], v34 offset:18688
  s_waitcnt lgkmcnt(3)
  v_mfma_f32_16x16x32_bf16 v[112:115], v[64:67], v[140:143], v[112:115]
  v_mfma_f32_16x16x32_bf16 v[116:119], v[64:67], v[172:175], v[116:119]
  v_mfma_f32_16x16x32_bf16 v[120:123], v[64:67], v[204:207], v[120:123]
  v_mfma_f32_16x16x32_bf16 v[124:127], v[64:67], v[236:239], v[124:127]
  ds_read_b128 v[64:67], v35 offset:18688
  s_waitcnt lgkmcnt(3)
  v_mfma_f32_16x16x32_bf16 v[112:115], v[52:55], v[144:147], v[112:115]
  v_mfma_f32_16x16x32_bf16 v[116:119], v[52:55], v[176:179], v[116:119]
  v_mfma_f32_16x16x32_bf16 v[120:123], v[52:55], v[208:211], v[120:123]
  v_mfma_f32_16x16x32_bf16 v[124:127], v[52:55], v[240:243], v[124:127]
  s_waitcnt lgkmcnt(2)
  v_mfma_f32_16x16x32_bf16 v[112:115], v[56:59], v[148:151], v[112:115]
  v_mfma_f32_16x16x32_bf16 v[116:119], v[56:59], v[180:183], v[116:119]
  v_mfma_f32_16x16x32_bf16 v[120:123], v[56:59], v[212:215], v[120:123]
  v_mfma_f32_16x16x32_bf16 v[124:127], v[56:59], v[244:247], v[124:127]
  s_waitcnt lgkmcnt(1)
  v_mfma_f32_16x16x32_bf16 v[112:115], v[60:63], v[152:155], v[112:115]
  v_mfma_f32_16x16x32_bf16 v[116:119], v[60:63], v[184:187], v[116:119]
  v_mfma_f32_16x16x32_bf16 v[120:123], v[60:63], v[216:219], v[120:123]
  v_mfma_f32_16x16x32_bf16 v[124:127], v[60:63], v[248:251], v[124:127]
  s_waitcnt lgkmcnt(0)
  v_mfma_f32_16x16x32_bf16 v[112:115], v[64:67], v[156:159], v[112:115]
  v_mfma_f32_16x16x32_bf16 v[116:119], v[64:67], v[188:191], v[116:119]
  v_mfma_f32_16x16x32_bf16 v[120:123], v[64:67], v[220:223], v[120:123]
  v_mfma_f32_16x16x32_bf16 v[124:127], v[64:67], v[252:255], v[124:127]
  s_lshl_b32 s30, s29, 10
  v_cvt_pk_bf16_f32 v68, v96, v97
  v_cvt_pk_bf16_f32 v69, v98, v99
  v_cvt_pk_bf16_f32 v70, v112, v113
  v_cvt_pk_bf16_f32 v71, v114, v115
  buffer_store_dwordx4 v[68:71], v12, s[8:11], s30 offen sc1
  v_cvt_pk_bf16_f32 v72, v100, v101
  v_cvt_pk_bf16_f32 v73, v102, v103
  v_cvt_pk_bf16_f32 v74, v116, v117
  v_cvt_pk_bf16_f32 v75, v118, v119
  buffer_store_dwordx4 v[72:75], v13, s[8:11], s30 offen sc1
  v_cvt_pk_bf16_f32 v76, v104, v105
  v_cvt_pk_bf16_f32 v77, v106, v107
  v_cvt_pk_bf16_f32 v78, v120, v121
  v_cvt_pk_bf16_f32 v79, v122, v123
  buffer_store_dwordx4 v[76:79], v14, s[8:11], s30 offen sc1
  v_cvt_pk_bf16_f32 v80, v108, v109
  v_cvt_pk_bf16_f32 v81, v110, v111
  v_cvt_pk_bf16_f32 v82, v124, v125
  v_cvt_pk_bf16_f32 v83, v126, v127
  buffer_store_dwordx4 v[80:83], v15, s[8:11], s30 offen sc1
bj_w3:
  s_lshl_b32 s77, s19, 8
  s_lshl_b32 s21, s17, 4
  s_add_u32 s77, s77, s21
  s_cmp_lg_u32 s31, 0
  s_cselect_b32 s21, 8, 0
  s_add_u32 s77, s77, s21
  s_add_u32 s77, s77, 88588288
  s_add_u32 s78, s77, 2048
  s_cmp_lt_u32 s19, 3
  s_cbranch_scc1 bj_a1
  s_waitcnt vmcnt(4)
  v_mov_b32 v96, v84
  v_mov_b32 v100, v85
  v_min_u32 v104, -2, v36
  v_min_u32 v108, -2, v37
  v_mov_b32 v97, v86
  v_mov_b32 v101, v87
  v_min_u32 v105, -2, v38
  v_min_u32 v109, -2, v39
  v_mov_b32 v98, v88
  v_mov_b32 v102, v89
  v_min_u32 v106, -2, v40
  v_min_u32 v110, -2, v41
  v_mov_b32 v99, v90
  v_mov_b32 v103, v91
  v_min_u32 v107, -2, v42
  v_min_u32 v111, -2, v43
  s_mov_b32 s20, 71565312
  s_mov_b32 s21, 73400320
  buffer_store_dwordx4 v[84:87], v92, s[8:11], s20 offen sc1
  buffer_store_dwordx4 v[88:91], v92, s[8:11], s20 offen offset:256 sc1
  buffer_store_dwordx4 v[96:99], v93, s[8:11], s21 offen sc1
  buffer_store_dwordx4 v[100:103], v93, s[8:11], s21 offen offset:1024 sc1
  s_cmp_lg_u32 s18, 0
  s_cbranch_scc1 bi_nm
  s_mov_b32 s20, 75235328
  s_mov_b32 s21, 88068096
  buffer_store_dwordx4 v[104:107], v94, s[8:11], s20 offen sc1
  buffer_store_dwordx4 v[108:111], v94, s[8:11], s20 offen offset:128 sc1
  buffer_store_dwordx4 v[104:107], v94, s[8:11], s21 offen sc1
  buffer_store_dwordx4 v[108:111], v94, s[8:11], s21 offen offset:128 sc1
bi_nm:
  s_waitcnt vmcnt(4)
  s_mov_b32 s23, 75235328
  v_add_u32 v6, 448, v95
  v_subrev_u32 v7, 1344, v6
  v_mov_b32 v52, -1
  v_mov_b32 v9, 0
  v_cmp_gt_u32 vcc, 256, v7
  s_nop 1
  v_cndmask_b32 v52, v52, v9, vcc
  v_mov_b32 v53, v52
  v_mov_b32 v54, v52
  v_mov_b32 v55, v52
  v_lshlrev_b32 v8, 4, v6
  v_mov_b32 v9, 0x10000000
  v_cmp_lt_u32 vcc, 105599, v6
  s_nop 1
  v_cndmask_b32 v8, v8, v9, vcc
  buffer_store_dwordx4 v[52:55], v8, s[8:11], s23 offen sc1
  v_add_u32 v6, 57792, v95
  v_subrev_u32 v7, 1344, v6
  v_mov_b32 v56, -1
  v_mov_b32 v9, 0
  v_cmp_gt_u32 vcc, 256, v7
  s_nop 1
  v_cndmask_b32 v56, v56, v9, vcc
  v_mov_b32 v57, v56
  v_mov_b32 v58, v56
  v_mov_b32 v59, v56
  v_lshlrev_b32 v8, 4, v6
  v_mov_b32 v9, 0x10000000
  v_cmp_lt_u32 vcc, 105599, v6
  s_nop 1
  v_cndmask_b32 v8, v8, v9, vcc
  buffer_store_dwordx4 v[56:59], v8, s[8:11], s23 offen sc1
  s_mov_b32 s23, 87945216
  v_add_u32 v6, 448, v95
  v_cmp_gt_u32 vcc, 7680, v95
  s_nop 1
  v_cndmask_b32 v6, v6, v95, vcc
  v_subrev_u32 v7, 36352, v6
  v_mov_b32 v60, -1
  v_mov_b32 v9, 0
  v_cmp_gt_u32 vcc, 1048576, v7
  s_nop 1
  v_cndmask_b32 v60, v60, v9, vcc
  v_mov_b32 v61, v60
  v_mov_b32 v62, v60
  v_mov_b32 v63, v60
  v_lshlrev_b32 v8, 4, v6
  v_mov_b32 v9, 0x10000000
  v_cmp_lt_u32 vcc, 40191, v6
  s_nop 1
  v_cndmask_b32 v8, v8, v9, vcc
  buffer_store_dwordx4 v[60:63], v8, s[8:11], s23 offen sc1
  s_barrier
  s_cmp_lg_u32 s16, 0
  s_cbranch_scc1 pub_24
  v_mul_u32_u24 v26, 2048, v1
  v_mov_b32 v24, s88
  v_mov_b32 v25, s89
  s_mov_b64 exec, 1
  buffer_store_dwordx2 v[24:25], v26, s[8:11], s77 offen sc1
  s_mov_b64 exec, -1
pub_24:
  s_waitcnt vmcnt(0)
  s_barrier
  s_cmp_lg_u32 s16, 0
  s_cbranch_scc1 pub_25
  v_mul_u32_u24 v26, 2048, v1
  v_mov_b32 v24, s88
  v_mov_b32 v25, s89
  s_mov_b64 exec, 511
  buffer_store_dwordx2 v[24:25], v26, s[8:11], s78 offen sc1
  s_mov_b64 exec, -1
pub_25:
  s_branch bj_end
bj_a1:
  s_add_u32 s19, s19, 4
  s_waitcnt vmcnt(4)
  v_mov_b32 v96, v84
  v_mov_b32 v100, v85
  v_min_u32 v104, -2, v36
  v_min_u32 v108, -2, v37
  v_mov_b32 v97, v86
  v_mov_b32 v101, v87
  v_min_u32 v105, -2, v38
  v_min_u32 v109, -2, v39
  v_mov_b32 v98, v88
  v_mov_b32 v102, v89
  v_min_u32 v106, -2, v40
  v_min_u32 v110, -2, v41
  v_mov_b32 v99, v90
  v_mov_b32 v103, v91
  v_min_u32 v107, -2, v42
  v_min_u32 v111, -2, v43
  s_mov_b32 s20, 71565312
  s_mov_b32 s21, 73400320
  buffer_store_dwordx4 v[84:87], v92, s[8:11], s20 offen sc1
  buffer_store_dwordx4 v[88:91], v92, s[8:11], s20 offen offset:256 sc1
  buffer_store_dwordx4 v[96:99], v93, s[8:11], s21 offen sc1
  buffer_store_dwordx4 v[100:103], v93, s[8:11], s21 offen offset:1024 sc1
  s_cmp_lg_u32 s18, 0
  s_cbranch_scc1 bk_nm
  s_mov_b32 s20, 75235328
  s_mov_b32 s21, 88068096
  buffer_store_dwordx4 v[104:107], v94, s[8:11], s20 offen sc1
  buffer_store_dwordx4 v[108:111], v94, s[8:11], s20 offen offset:128 sc1
  buffer_store_dwordx4 v[104:107], v94, s[8:11], s21 offen sc1
  buffer_store_dwordx4 v[108:111], v94, s[8:11], s21 offen offset:128 sc1
bk_nm:
  s_mov_b32 s23, 75235328
  v_add_u32 v6, 448, v95
  v_subrev_u32 v7, 1344, v6
  v_mov_b32 v52, -1
  v_mov_b32 v9, 0
  v_cmp_gt_u32 vcc, 256, v7
  s_nop 1
  v_cndmask_b32 v52, v52, v9, vcc
  v_mov_b32 v53, v52
  v_mov_b32 v54, v52
  v_mov_b32 v55, v52
  v_lshlrev_b32 v8, 4, v6
  v_mov_b32 v9, 0x10000000
  v_cmp_lt_u32 vcc, 105599, v6
  s_nop 1
  v_cndmask_b32 v8, v8, v9, vcc
  buffer_store_dwordx4 v[52:55], v8, s[8:11], s23 offen sc1
  v_add_u32 v6, 57792, v95
  v_subrev_u32 v7, 1344, v6
  v_mov_b32 v56, -1
  v_mov_b32 v9, 0
  v_cmp_gt_u32 vcc, 256, v7
  s_nop 1
  v_cndmask_b32 v56, v56, v9, vcc
  v_mov_b32 v57, v56
  v_mov_b32 v58, v56
  v_mov_b32 v59, v56
  v_lshlrev_b32 v8, 4, v6
  v_mov_b32 v9, 0x10000000
  v_cmp_lt_u32 vcc, 105599, v6
  s_nop 1
  v_cndmask_b32 v8, v8, v9, vcc
  buffer_store_dwordx4 v[56:59], v8, s[8:11], s23 offen sc1
  s_mov_b32 s23, 87945216
  v_add_u32 v6, 448, v95
  v_cmp_gt_u32 vcc, 7680, v95
  s_nop 1
  v_cndmask_b32 v6, v6, v95, vcc
  v_subrev_u32 v7, 36352, v6
  v_mov_b32 v60, -1
  v_mov_b32 v9, 0
  v_cmp_gt_u32 vcc, 1048576, v7
  s_nop 1
  v_cndmask_b32 v60, v60, v9, vcc
  v_mov_b32 v61, v60
  v_mov_b32 v62, v60
  v_mov_b32 v63, v60
  v_lshlrev_b32 v8, 4, v6
  v_mov_b32 v9, 0x10000000
  v_cmp_lt_u32 vcc, 40191, v6
  s_nop 1
  v_cndmask_b32 v8, v8, v9, vcc
  buffer_store_dwordx4 v[60:63], v8, s[8:11], s23 offen sc1
  s_barrier
  s_mov_b32 s60, s40
  s_and_b32 s61, s41, 0xffff
  s_mov_b32 s62, 3670016
  s_mov_b32 s63, 0x20000
  s_mov_b32 s56, s42
  s_and_b32 s57, s43, 0xffff
  s_mov_b32 s58, 3670016
  s_mov_b32 s59, 0x20000
  s_lshl_b32 s30, s16, 13
  s_lshl_b32 s27, s19, 19
  s_lshl_b32 s29, s16, 17
  s_add_u32 s27, s27, s29
  s_lshl_b32 s29, s17, 9
  s_add_u32 s27, s27, s29
  v_lshrrev_b32 v5, 5, v1
  v_and_b32 v6, 31, v1
  v_xor_b32 v6, v6, v5
  v_lshlrev_b32 v6, 4, v6
  v_lshl_add_u32 v6, v5, 13, v6
  s_add_u32 m0, s30, 0
  s_add_u32 s22, s27, 0
  v_xor_b32 v7, 0, v6
  buffer_load_dwordx4 v7, s[56:59], s22 offen offset:0 lds
  s_add_u32 s22, s27, 15360
  v_xor_b32 v7, 32, v6
  buffer_load_dwordx4 v7, s[56:59], s22 offen offset:1024 lds
  s_add_u32 s22, s27, 30720
  v_xor_b32 v7, 64, v6
  buffer_load_dwordx4 v7, s[56:59], s22 offen offset:2048 lds
  s_add_u32 s22, s27, 46080
  v_xor_b32 v7, 96, v6
  buffer_load_dwordx4 v7, s[56:59], s22 offen offset:3072 lds
  s_add_u32 m0, s30, 4096
  s_add_u32 s22, s27, 65536
  v_xor_b32 v7, 128, v6
  buffer_load_dwordx4 v7, s[56:59], s22 offen offset:0 lds
  s_add_u32 s22, s27, 80896
  v_xor_b32 v7, 160, v6
  buffer_load_dwordx4 v7, s[56:59], s22 offen offset:1024 lds
  s_add_u32 s22, s27, 96256
  v_xor_b32 v7, 192, v6
  buffer_load_dwordx4 v7, s[56:59], s22 offen offset:2048 lds
  s_add_u32 s22, s27, 111616
  v_xor_b32 v7, 224, v6
  buffer_load_dwordx4 v7, s[56:59], s22 offen offset:3072 lds
  s_waitcnt vmcnt(8)
  s_barrier
  s_cmp_lg_u32 s16, 0
  s_cbranch_scc1 pub_26
  v_mul_u32_u24 v46, 2048, v1
  v_mov_b32 v44, s88
  v_mov_b32 v45, s89
  s_mov_b64 exec, 1
  buffer_store_dwordx2 v[44:45], v46, s[8:11], s77 offen sc1
  s_mov_b64 exec, -1
pub_26:
  s_cmp_lg_u32 s16, 0
  s_cbranch_scc1 w0_27
  v_mul_u32_u24 v50, 2048, v1
  v_mov_b32 v48, s88
  v_mov_b32 v49, s89
  s_mov_b64 exec, 511
  buffer_store_dwordx2 v[48:49], v50, s[8:11], s78 offen sc1
  s_mov_b64 exec, -1
w0_27:
  v_lshrrev_b32 v5, 5, v1
  v_and_b32 v6, 31, v1
  s_lshl_b32 s25, s16, 15
  s_add_u32 s25, s25, 32768
  s_lshl_b32 s26, s17, 9
  s_add_u32 s28, s19, s16
  s_cmp_ge_u32 s28, 7
  s_cselect_b32 s20, 7, 0
  s_sub_u32 s28, s28, s20
  s_add_u32 s28, s28, s31
  s_add_u32 s29, s19, s16
  s_add_u32 s29, s29, 4
  s_cmp_ge_u32 s29, 7
  s_cselect_b32 s20, 7, 0
  s_sub_u32 s29, s29, s20
  s_add_u32 s29, s29, s31
  s_lshl_b32 s32, s28, 18
  s_add_u32 s32, s32, s26
  s_lshl_b32 s33, s29, 18
  s_add_u32 s33, s33, s26
  v_xor_b32 v8, v6, v5
  v_lshlrev_b32 v8, 4, v8
  v_lshl_add_u32 v8, v5, 13, v8
  v_xor_b32 v12, 0, v8
  v_xor_b32 v13, 32, v8
  v_add_u32 v13, 15360, v13
  v_xor_b32 v14, 0, v8
  v_add_u32 v14, 30720, v14
  v_xor_b32 v15, 32, v8
  v_add_u32 v15, 46080, v15
  s_add_u32 s20, s16, 0
  s_and_b32 s20, s20, 3
  s_mul_i32 s21, s20, 65600
  s_lshl_b32 s20, s20, 12
  s_add_u32 s48, s20, s25
  s_mov_b32 m0, s48
  v_xor_b32 v16, s21, v12
  buffer_load_dwordx4 v16, s[60:63], s32 offen offset:0 lds
  v_xor_b32 v17, s21, v13
  buffer_load_dwordx4 v17, s[60:63], s32 offen offset:1024 lds
  v_xor_b32 v18, s21, v14
  buffer_load_dwordx4 v18, s[60:63], s32 offen offset:2048 lds
  v_xor_b32 v19, s21, v15
  buffer_load_dwordx4 v19, s[60:63], s32 offen offset:3072 lds
  s_add_u32 s20, s16, 1
  s_and_b32 s20, s20, 3
  s_mul_i32 s21, s20, 65600
  s_lshl_b32 s20, s20, 12
  s_add_u32 s49, s20, s25
  s_mov_b32 m0, s49
  v_xor_b32 v20, s21, v12
  buffer_load_dwordx4 v20, s[60:63], s32 offen offset:0 lds
  v_xor_b32 v21, s21, v13
  buffer_load_dwordx4 v21, s[60:63], s32 offen offset:1024 lds
  v_xor_b32 v22, s21, v14
  buffer_load_dwordx4 v22, s[60:63], s32 offen offset:2048 lds
  v_xor_b32 v23, s21, v15
  buffer_load_dwordx4 v23, s[60:63], s32 offen offset:3072 lds
  s_add_u32 s20, s16, 2
  s_and_b32 s20, s20, 3
  s_mul_i32 s21, s20, 65600
  s_lshl_b32 s20, s20, 12
  s_add_u32 s50, s20, s25
  s_mov_b32 m0, s50
  v_xor_b32 v24, s21, v12
  buffer_load_dwordx4 v24, s[60:63], s32 offen offset:0 lds
  v_xor_b32 v25, s21, v13
  buffer_load_dwordx4 v25, s[60:63], s32 offen offset:1024 lds
  v_xor_b32 v26, s21, v14
  buffer_load_dwordx4 v26, s[60:63], s32 offen offset:2048 lds
  v_xor_b32 v27, s21, v15
  buffer_load_dwordx4 v27, s[60:63], s32 offen offset:3072 lds
  s_add_u32 s20, s16, 3
  s_and_b32 s20, s20, 3
  s_mul_i32 s21, s20, 65600
  s_lshl_b32 s20, s20, 12
  s_add_u32 s51, s20, s25
  s_mov_b32 m0, s51
  v_xor_b32 v28, s21, v12
  buffer_load_dwordx4 v28, s[60:63], s32 offen offset:0 lds
  v_xor_b32 v29, s21, v13
  buffer_load_dwordx4 v29, s[60:63], s32 offen offset:1024 lds
  v_xor_b32 v30, s21, v14
  buffer_load_dwordx4 v30, s[60:63], s32 offen offset:2048 lds
  v_xor_b32 v31, s21, v15
  buffer_load_dwordx4 v31, s[60:63], s32 offen offset:3072 lds
  s_cmp_eq_u32 s16, 3
  s_cbranch_scc1 ak_np1
  s_add_u32 m0, s48, 16384
  s_nop 0
  buffer_load_dwordx4 v16, s[60:63], s33 offen offset:0 lds
  buffer_load_dwordx4 v17, s[60:63], s33 offen offset:1024 lds
  buffer_load_dwordx4 v18, s[60:63], s33 offen offset:2048 lds
  buffer_load_dwordx4 v19, s[60:63], s33 offen offset:3072 lds
  s_add_u32 m0, s49, 16384
  s_nop 0
  buffer_load_dwordx4 v20, s[60:63], s33 offen offset:0 lds
  buffer_load_dwordx4 v21, s[60:63], s33 offen offset:1024 lds
  buffer_load_dwordx4 v22, s[60:63], s33 offen offset:2048 lds
  buffer_load_dwordx4 v23, s[60:63], s33 offen offset:3072 lds
  s_add_u32 m0, s50, 16384
  s_nop 0
  buffer_load_dwordx4 v24, s[60:63], s33 offen offset:0 lds
  buffer_load_dwordx4 v25, s[60:63], s33 offen offset:1024 lds
  buffer_load_dwordx4 v26, s[60:63], s33 offen offset:2048 lds
  buffer_load_dwordx4 v27, s[60:63], s33 offen offset:3072 lds
  s_add_u32 m0, s51, 16384
  s_nop 0
  buffer_load_dwordx4 v28, s[60:63], s33 offen offset:0 lds
  buffer_load_dwordx4 v29, s[60:63], s33 offen offset:1024 lds
  buffer_load_dwordx4 v30, s[60:63], s33 offen offset:2048 lds
  buffer_load_dwordx4 v31, s[60:63], s33 offen offset:3072 lds
ak_np1:
  s_mov_b32 s79, 1
  s_branch aj_run
bj_end:
  s_cmp_lg_u32 s16, 0
  s_cbranch_scc1 w0_28
w0_28:
  s_mov_b32 s3, s68
  s_cmp_lg_u32 s69, 0
  s_cbranch_scc1 wk_have
  v_mov_b32 v250, 0
  s_branch wk_ask
wk_loop:
  s_waitcnt vmcnt(0) lgkmcnt(0)
  s_cmp_eq_u32 s96, 1
  s_cbranch_scc1 wk_ask
  s_mov_b32 s96, 1
  s_cmp_lg_u32 s16, 0
  s_cbranch_scc1 w0_29
  s_mov_b32 s30, 0
  v_mov_b32 v243, 32
sf_l:
  buffer_load_dword v242, v243, s[12:15], 0 offen sc1
  s_waitcnt vmcnt(0)
  v_readfirstlane_b32 s70, v242
  s_cmp_eq_u32 s70, -1
  s_cbranch_scc1 sf_d
  s_sleep 16
  s_add_u32 s30, s30, 1
  s_cmp_lt_u32 s30, 64
  s_cbranch_scc1 sf_l
  s_mov_b32 s20, 0
  s_mov_b32 s21, 0
  s_mov_b64 exec, 1
sf_c_l:
  s_cmp_lg_u32 s70, -1
  s_cbranch_scc1 sf_c_t
  s_add_u32 s20, s20, 1
  s_cmp_lt_u32 s20, 8
  s_cselect_b32 s20, s20, 0
  s_mov_b32 s70, 0
  s_mov_b32 s3, -1
  s_add_u32 s21, s21, 1
  s_cmp_ge_u32 s21, 1
  s_cbranch_scc1 sf_c_d
sf_c_t:
  s_ff0_i32_b32 s22, s70
  s_lshl_b32 s23, 1, s22
  s_and_b32 s71, s20, 4
  s_mul_i32 s71, s71, 12
  s_lshl_b32 s3, s20, 2
  s_add_u32 s3, s3, s71
  v_mov_b32 v242, s23
  v_mov_b32 v243, 32
  buffer_atomic_or v242, v243, s[12:15], s3 offen sc0
  s_waitcnt vmcnt(0)
  v_readfirstlane_b32 s70, v242
  s_lshl_b32 s3, s20, 5
  s_add_u32 s3, s3, s22
  s_bitcmp1_b32 s70, s22
  s_cbranch_scc1 sf_c_l
sf_c_d:
  s_mov_b64 exec, -1
  v_mov_b32 v242, s3
sf_d:
w0_29:
  v_mov_b32 v243, 160000
  s_add_u32 s101, s101, 1
  s_barrier
  s_mov_b64 exec, 1
  s_cmp_lg_u32 s16, 0
  s_cbranch_scc1 w0_30
  ds_write_b32 v243, v242 offset:0
  s_waitcnt lgkmcnt(0)
  v_mov_b32 v242, s101
  ds_write_b32 v243, v242 offset:16
  s_waitcnt lgkmcnt(0)
w0_30:
  s_mov_b64 exec, -1
  s_barrier
  ds_read_b32 v242, v243 offset:0
  ds_read_b32 v243, v243 offset:16
  s_waitcnt lgkmcnt(0)
  v_readfirstlane_b32 s3, v242
  v_cmp_ne_u32 vcc, s101, v243
  s_cbranch_vccnz ch_end
  s_cmp_eq_u32 s3, -1
  s_cbranch_scc1 wk_ask
  s_load_dwordx8 s[36:43], s[0:1], 56
  s_load_dwordx4 s[44:47], s[0:1], 88
  s_getreg_b32 s67, hwreg(HW_REG_XCC_ID)
  s_and_b32 s67, s67, 7
  s_mov_b32 s66, 1
  s_waitcnt lgkmcnt(0)
  s_branch m_start
wk_ask:
  v_readfirstlane_b32 s22, v250
  s_cmp_ge_u32 s22, 1376
  s_cbranch_scc1 wk_next
  s_cmp_lg_u32 s16, 0
  s_cbranch_scc1 w0_31
  v_mov_b32 v250, 1
  v_mov_b32 v251, 192
  s_mov_b64 exec, 1
  buffer_atomic_add v250, v251, s[12:15], 0 offen sc0
  s_mov_b64 exec, -1
w0_31:
wk_next:
  s_waitcnt vmcnt(0)
  v_mov_b32 v6, 160000
  s_add_u32 s101, s101, 1
  s_barrier
  s_mov_b64 exec, 1
  s_cmp_lg_u32 s16, 0
  s_cbranch_scc1 w0_32
  ds_write_b32 v6, v250 offset:0
  s_waitcnt lgkmcnt(0)
  v_mov_b32 v250, s101
  ds_write_b32 v6, v250 offset:16
  s_waitcnt lgkmcnt(0)
w0_32:
  s_mov_b64 exec, -1
  s_barrier
  ds_read_b32 v250, v6 offset:0
  ds_read_b32 v6, v6 offset:16
  s_waitcnt lgkmcnt(0)
  v_readfirstlane_b32 s3, v250
  v_cmp_ne_u32 vcc, s101, v6
  s_cbranch_vccnz ch_end
wk_have:
  s_cmp_ge_u32 s3, 1376
  s_cbranch_scc1 ch_end
  v_mov_b32 v250, 0
  v_mov_b32 v251, 192
  v_and_b32 v1, 63, v0
  v_lshlrev_b32 v2, 4, v1
  v_lshrrev_b32 v3, 4, v1
  v_and_b32 v4, 15, v1
  s_cmp_lg_u32 s97, 0
  s_cbranch_scc1 wk_go
  s_mov_b32 s68, s3
  s_mov_b32 s69, 1
  s_cmp_lg_u32 s16, 0
  s_cbranch_scc1 w0_33
  s_add_u32 s20, s67, 1
  s_lshl_b32 s22, s20, 11
  s_add_u32 s22, s22, 88590336
  v_add_u32 v24, 1024, v2
  v_min_u32 v24, 1776, v24
  s_mov_b32 s30, 0
wk_af:
  buffer_load_dwordx4 v[28:31], v2, s[8:11], s22 offen sc1
  buffer_load_dwordx4 v[32:35], v24, s[8:11], s22 offen sc1
  s_waitcnt vmcnt(0)
  v_cmp_ne_u64 vcc, s[88:89], v[28:29]
  s_cbranch_vccnz wk_af_no
  v_cmp_ne_u64 vcc, s[88:89], v[30:31]
  s_cbranch_vccnz wk_af_no
  v_cmp_ne_u64 vcc, s[88:89], v[32:33]
  s_cbranch_vccnz wk_af_no
  v_cmp_ne_u64 vcc, s[88:89], v[34:35]
  s_cbranch_vccnz wk_af_no
  s_branch wk_af_ok
wk_af_no:
  s_sleep 4
  s_add_u32 s30, s30, 1
  s_and_b32 s20, s30, 63
  s_cbranch_scc1 wk_ns
  s_mov_b32 s20, 1
  s_mov_b32 s70, 0
  s_mov_b32 s21, 0
  s_mov_b64 exec, 1
wk_st_l:
  s_cmp_lg_u32 s70, -1
  s_cbranch_scc1 wk_st_t
  s_add_u32 s20, s20, 1
  s_cmp_lt_u32 s20, 8
  s_cselect_b32 s20, s20, 1
  s_mov_b32 s70, 0
  s_mov_b32 s3, -1
  s_add_u32 s21, s21, 1
  s_cmp_ge_u32 s21, 7
  s_cbranch_scc1 wk_st_d
wk_st_t:
  s_ff0_i32_b32 s22, s70
  s_lshl_b32 s23, 1, s22
  s_and_b32 s71, s20, 4
  s_mul_i32 s71, s71, 12
  s_lshl_b32 s3, s20, 2
  s_add_u32 s3, s3, s71
  v_mov_b32 v242, s23
  v_mov_b32 v243, 32
  buffer_atomic_or v242, v243, s[12:15], s3 offen sc0
  s_waitcnt vmcnt(0)
  v_readfirstlane_b32 s70, v242
  s_lshl_b32 s3, s20, 5
  s_add_u32 s3, s3, s22
  s_bitcmp1_b32 s70, s22
  s_cbranch_scc1 wk_st_l
wk_st_d:
  s_mov_b64 exec, -1
  v_mov_b32 v242, s3
  s_cmp_lg_u32 s3, -1
  s_cbranch_scc1 wk_pd
  s_add_u32 s20, s67, 1
  s_lshl_b32 s22, s20, 11
  s_add_u32 s22, s22, 88590336
wk_ns:
  s_cmp_lt_u32 s30, 50000
  s_cbranch_scc1 wk_af
  s_branch cA_abort
wk_af_ok:
  v_mov_b32 v242, -1
wk_pd:
w0_33:
  v_mov_b32 v243, 160000
  s_add_u32 s101, s101, 1
  s_barrier
  s_mov_b64 exec, 1
  s_cmp_lg_u32 s16, 0
  s_cbranch_scc1 w0_34
  ds_write_b32 v243, v242 offset:0
  s_waitcnt lgkmcnt(0)
  v_mov_b32 v242, s101
  ds_write_b32 v243, v242 offset:16
  s_waitcnt lgkmcnt(0)
w0_34:
  s_mov_b64 exec, -1
  s_barrier
  ds_read_b32 v242, v243 offset:0
  ds_read_b32 v243, v243 offset:16
  s_waitcnt lgkmcnt(0)
  v_readfirstlane_b32 s3, v242
  v_cmp_ne_u32 vcc, s101, v243
  s_cbranch_vccnz ch_end
  s_cmp_lg_u32 s3, -1
  s_cbranch_scc1 m_bjob
  s_mov_b32 s3, s68
  s_mov_b32 s97, 1
wk_go:
  s_cmp_ge_u32 s3, 864
  s_cbranch_scc1 wk_tok
  s_cmp_ge_u32 s3, 752
  s_cbranch_scc1 wk_s4d
  s_cmp_ge_u32 s3, 624
  s_cbranch_scc1 wk_f
  s_cmp_ge_u32 s3, 560
  s_cbranch_scc1 wk_vf
  s_cmp_ge_u32 s3, 496
  s_cbranch_scc1 wk_vh
  s_cmp_ge_u32 s3, 368
  s_cbranch_scc1 wk_a
  s_cmp_ge_u32 s3, 336
  s_cbranch_scc1 wk_srv
  s_cmp_ge_u32 s3, 224
  s_cbranch_scc1 wk_v7
  s_sub_u32 s20, s3, 0
  s_cmp_ge_u32 s20, 112
  s_cselect_b32 s18, 1, 0
  s_cselect_b32 s21, 112, 0
  s_sub_u32 s20, s20, s21
  s_and_b32 s17, s20, 15
  s_add_u32 s17, s17, 16
  s_lshr_b32 s34, s20, 4
  s_lshl_b32 s34, s34, 1
  s_add_u32 s35, s34, 2
  s_lshl_b32 s20, s18, 3
  s_lshl_b32 s21, s16, 1
  s_add_u32 s20, s20, s21
  s_mul_i32 s21, s20, 14336
  s_add_u32 s21, s21, 71565312
  s_add_u32 s22, s21, 0
  buffer_load_dwordx4 a[0:3], v2, s[8:11], s22 offen offset:0 sc1
  buffer_load_dwordx4 a[4:7], v2, s[8:11], s22 offen offset:1024 sc1
  buffer_load_dwordx4 a[8:11], v2, s[8:11], s22 offen offset:2048 sc1
  buffer_load_dwordx4 a[12:15], v2, s[8:11], s22 offen offset:3072 sc1
  s_add_u32 s22, s21, 4096
  buffer_load_dwordx4 a[16:19], v2, s[8:11], s22 offen offset:0 sc1
  buffer_load_dwordx4 a[20:23], v2, s[8:11], s22 offen offset:1024 sc1
  buffer_load_dwordx4 a[24:27], v2, s[8:11], s22 offen offset:2048 sc1
  buffer_load_dwordx4 a[28:31], v2, s[8:11], s22 offen offset:3072 sc1
  s_add_u32 s22, s21, 8192
  buffer_load_dwordx4 a[32:35], v2, s[8:11], s22 offen offset:0 sc1
  buffer_load_dwordx4 a[36:39], v2, s[8:11], s22 offen offset:1024 sc1
  buffer_load_dwordx4 a[40:43], v2, s[8:11], s22 offen offset:2048 sc1
  buffer_load_dwordx4 a[44:47], v2, s[8:11], s22 offen offset:3072 sc1
  s_add_u32 s22, s21, 12288
  buffer_load_dwordx4 a[48:51], v2, s[8:11], s22 offen offset:0 sc1
  buffer_load_dwordx4 a[52:55], v2, s[8:11], s22 offen offset:1024 sc1
  buffer_load_dwordx4 a[56:59], v2, s[8:11], s22 offen offset:2048 sc1
  buffer_load_dwordx4 a[60:63], v2, s[8:11], s22 offen offset:3072 sc1
  s_add_u32 s22, s21, 16384
  buffer_load_dwordx4 a[64:67], v2, s[8:11], s22 offen offset:0 sc1
  buffer_load_dwordx4 a[68:71], v2, s[8:11], s22 offen offset:1024 sc1
  buffer_load_dwordx4 a[72:75], v2, s[8:11], s22 offen offset:2048 sc1
  buffer_load_dwordx4 a[76:79], v2, s[8:11], s22 offen offset:3072 sc1
  s_add_u32 s22, s21, 20480
  buffer_load_dwordx4 a[80:83], v2, s[8:11], s22 offen offset:0 sc1
  buffer_load_dwordx4 a[84:87], v2, s[8:11], s22 offen offset:1024 sc1
  buffer_load_dwordx4 a[88:91], v2, s[8:11], s22 offen offset:2048 sc1
  buffer_load_dwordx4 a[92:95], v2, s[8:11], s22 offen offset:3072 sc1
  s_add_u32 s22, s21, 24576
  buffer_load_dwordx4 a[96:99], v2, s[8:11], s22 offen offset:0 sc1
  buffer_load_dwordx4 a[100:103], v2, s[8:11], s22 offen offset:1024 sc1
  buffer_load_dwordx4 a[104:107], v2, s[8:11], s22 offen offset:2048 sc1
  buffer_load_dwordx4 a[108:111], v2, s[8:11], s22 offen offset:3072 sc1
  s_waitcnt vmcnt(40)
  s_mul_i32 s23, s17, 401408
  s_and_b32 s22, s16, 1
  s_mul_i32 s22, s22, 7168
  s_add_u32 s23, s23, s22
  s_add_u32 s23, s23, 0
  s_lshr_b32 s22, s16, 1
  s_mul_i32 s22, s22, 14336
  s_add_u32 s23, s23, s22
  s_mul_i32 s27, s16, 7168
  s_lshr_b32 s28, s20, 1
wf_vo:
  s_sub_u32 s29, s17, 16
  s_lshl_b32 s29, s29, 6
  s_add_u32 s29, s29, s28
  s_mul_i32 s29, s29, 28672
  s_add_u32 s29, s29, 42205184
  v_mul_u32_u24 v6, 28, v3
  s_mov_b32 s31, 0
  s_lshl_b32 s24, s34, 1
  s_mul_i32 s24, s24, 14336
  s_add_u32 s24, s24, s23
  s_cmp_lt_u32 s34, s35
  s_cselect_b32 s24, s24, 0x10000000
  s_add_u32 m0, s31, s27
  s_nop 0
  buffer_load_dwordx4 v2, s[8:11], s24 offen offset:0 sc1 lds
  buffer_load_dwordx4 v2, s[8:11], s24 offen offset:1024 sc1 lds
  buffer_load_dwordx4 v2, s[8:11], s24 offen offset:2048 sc1 lds
  buffer_load_dwordx4 v2, s[8:11], s24 offen offset:3072 sc1 lds
  s_add_u32 m0, m0, 4096
  s_add_u32 s24, s24, 4096
  buffer_load_dwordx4 v2, s[8:11], s24 offen offset:0 sc1 lds
  buffer_load_dwordx4 v2, s[8:11], s24 offen offset:1024 sc1 lds
  buffer_load_dwordx4 v2, s[8:11], s24 offen offset:2048 sc1 lds
  s_add_u32 s30, s34, 1
  s_mov_b32 s31, 28672
  s_lshl_b32 s24, s30, 1
  s_mul_i32 s24, s24, 14336
  s_add_u32 s24, s24, s23
  s_cmp_lt_u32 s30, s35
  s_cselect_b32 s24, s24, 0x10000000
  s_add_u32 m0, s31, s27
  s_nop 0
  buffer_load_dwordx4 v2, s[8:11], s24 offen offset:0 sc1 lds
  buffer_load_dwordx4 v2, s[8:11], s24 offen offset:1024 sc1 lds
  buffer_load_dwordx4 v2, s[8:11], s24 offen offset:2048 sc1 lds
  buffer_load_dwordx4 v2, s[8:11], s24 offen offset:3072 sc1 lds
  s_add_u32 m0, m0, 4096
  s_add_u32 s24, s24, 4096
  buffer_load_dwordx4 v2, s[8:11], s24 offen offset:0 sc1 lds
  buffer_load_dwordx4 v2, s[8:11], s24 offen offset:1024 sc1 lds
  buffer_load_dwordx4 v2, s[8:11], s24 offen offset:2048 sc1 lds
  s_mov_b32 s19, s34
  s_mov_b32 s32, 0
  s_mov_b32 s33, 57344
  s_waitcnt vmcnt(7)
  s_branch wf_vo_in
wf_vo_loop:
  s_waitcnt vmcnt(9)
wf_vo_in:
  s_barrier
  s_add_u32 s30, s19, 2
  s_lshl_b32 s24, s30, 1
  s_mul_i32 s24, s24, 14336
  s_add_u32 s24, s24, s23
  s_cmp_lt_u32 s30, s35
  s_cselect_b32 s24, s24, 0x10000000
  s_add_u32 m0, s33, s27
  s_nop 0
  buffer_load_dwordx4 v2, s[8:11], s24 offen offset:0 sc1 lds
  buffer_load_dwordx4 v2, s[8:11], s24 offen offset:1024 sc1 lds
  buffer_load_dwordx4 v2, s[8:11], s24 offen offset:2048 sc1 lds
  buffer_load_dwordx4 v2, s[8:11], s24 offen offset:3072 sc1 lds
  s_add_u32 m0, m0, 4096
  s_add_u32 s24, s24, 4096
  buffer_load_dwordx4 v2, s[8:11], s24 offen offset:0 sc1 lds
  buffer_load_dwordx4 v2, s[8:11], s24 offen offset:1024 sc1 lds
  buffer_load_dwordx4 v2, s[8:11], s24 offen offset:2048 sc1 lds
  v_add_u32 v5, s32, v2
  ds_read_b128 v[8:11], v5 offset:0
  ds_read_b128 v[12:15], v5 offset:14336
  ds_read_b128 v[16:19], v5 offset:1024
  ds_read_b128 v[20:23], v5 offset:15360
  ds_read_b128 v[24:27], v5 offset:2048
  ds_read_b128 v[28:31], v5 offset:16384
  ds_read_b128 v[32:35], v5 offset:3072
  s_waitcnt lgkmcnt(6)
  v_mfma_f32_16x16x32_bf16 v[40:43], a[0:3], v[8:11], 0
  v_mfma_f32_16x16x32_bf16 v[44:47], a[56:59], v[8:11], 0
  ds_read_b128 v[36:39], v5 offset:17408
  s_waitcnt lgkmcnt(6)
  v_mfma_f32_16x16x32_bf16 v[56:59], a[0:3], v[12:15], 0
  v_mfma_f32_16x16x32_bf16 v[60:63], a[56:59], v[12:15], 0
  ds_read_b128 v[8:11], v5 offset:4096
  s_waitcnt lgkmcnt(6)
  v_mfma_f32_16x16x32_bf16 v[40:43], a[4:7], v[16:19], v[40:43]
  v_mfma_f32_16x16x32_bf16 v[44:47], a[60:63], v[16:19], v[44:47]
  ds_read_b128 v[12:15], v5 offset:18432
  s_waitcnt lgkmcnt(6)
  v_mfma_f32_16x16x32_bf16 v[56:59], a[4:7], v[20:23], v[56:59]
  v_mfma_f32_16x16x32_bf16 v[60:63], a[60:63], v[20:23], v[60:63]
  ds_read_b128 v[16:19], v5 offset:5120
  s_waitcnt lgkmcnt(6)
  v_mfma_f32_16x16x32_bf16 v[40:43], a[8:11], v[24:27], v[40:43]
  v_mfma_f32_16x16x32_bf16 v[44:47], a[64:67], v[24:27], v[44:47]
  ds_read_b128 v[20:23], v5 offset:19456
  s_waitcnt lgkmcnt(6)
  v_mfma_f32_16x16x32_bf16 v[56:59], a[8:11], v[28:31], v[56:59]
  v_mfma_f32_16x16x32_bf16 v[60:63], a[64:67], v[28:31], v[60:63]
  ds_read_b128 v[24:27], v5 offset:6144
  s_waitcnt lgkmcnt(6)
  v_mfma_f32_16x16x32_bf16 v[40:43], a[12:15], v[32:35], v[40:43]
  v_mfma_f32_16x16x32_bf16 v[44:47], a[68:71], v[32:35], v[44:47]
  ds_read_b128 v[28:31], v5 offset:20480
  s_waitcnt lgkmcnt(6)
  v_mfma_f32_16x16x32_bf16 v[56:59], a[12:15], v[36:39], v[56:59]
  v_mfma_f32_16x16x32_bf16 v[60:63], a[68:71], v[36:39], v[60:63]
  ds_read_b128 v[32:35], v5 offset:7168
  s_waitcnt lgkmcnt(6)
  v_mfma_f32_16x16x32_bf16 v[40:43], a[16:19], v[8:11], v[40:43]
  v_mfma_f32_16x16x32_bf16 v[44:47], a[72:75], v[8:11], v[44:47]
  ds_read_b128 v[36:39], v5 offset:21504
  s_waitcnt lgkmcnt(6)
  v_mfma_f32_16x16x32_bf16 v[56:59], a[16:19], v[12:15], v[56:59]
  v_mfma_f32_16x16x32_bf16 v[60:63], a[72:75], v[12:15], v[60:63]
  ds_read_b128 v[8:11], v5 offset:8192
  s_waitcnt lgkmcnt(6)
  v_mfma_f32_16x16x32_bf16 v[40:43], a[20:23], v[16:19], v[40:43]
  v_mfma_f32_16x16x32_bf16 v[44:47], a[76:79], v[16:19], v[44:47]
  ds_read_b128 v[12:15], v5 offset:22528
  s_waitcnt lgkmcnt(6)
  v_mfma_f32_16x16x32_bf16 v[56:59], a[20:23], v[20:23], v[56:59]
  v_mfma_f32_16x16x32_bf16 v[60:63], a[76:79], v[20:23], v[60:63]
  ds_read_b128 v[16:19], v5 offset:9216
  s_waitcnt lgkmcnt(6)
  v_mfma_f32_16x16x32_bf16 v[40:43], a[24:27], v[24:27], v[40:43]
  v_mfma_f32_16x16x32_bf16 v[44:47], a[80:83], v[24:27], v[44:47]
  ds_read_b128 v[20:23], v5 offset:23552
  s_waitcnt lgkmcnt(6)
  v_mfma_f32_16x16x32_bf16 v[56:59], a[24:27], v[28:31], v[56:59]
  v_mfma_f32_16x16x32_bf16 v[60:63], a[80:83], v[28:31], v[60:63]
  ds_read_b128 v[24:27], v5 offset:10240
  s_waitcnt lgkmcnt(6)
  v_mfma_f32_16x16x32_bf16 v[40:43], a[28:31], v[32:35], v[40:43]
  v_mfma_f32_16x16x32_bf16 v[44:47], a[84:87], v[32:35], v[44:47]
  ds_read_b128 v[28:31], v5 offset:24576
  s_waitcnt lgkmcnt(6)
  v_mfma_f32_16x16x32_bf16 v[56:59], a[28:31], v[36:39], v[56:59]
  v_mfma_f32_16x16x32_bf16 v[60:63], a[84:87], v[36:39], v[60:63]
  ds_read_b128 v[32:35], v5 offset:11264
  s_waitcnt lgkmcnt(6)
  v_mfma_f32_16x16x32_bf16 v[40:43], a[32:35], v[8:11], v[40:43]
  v_mfma_f32_16x16x32_bf16 v[44:47], a[88:91], v[8:11], v[44:47]
  ds_read_b128 v[36:39], v5 offset:25600
  s_waitcnt lgkmcnt(6)
  v_mfma_f32_16x16x32_bf16 v[56:59], a[32:35], v[12:15], v[56:59]
  v_mfma_f32_16x16x32_bf16 v[60:63], a[88:91], v[12:15], v[60:63]
  ds_read_b128 v[8:11], v5 offset:12288
  s_waitcnt lgkmcnt(6)
  v_mfma_f32_16x16x32_bf16 v[40:43], a[36:39], v[16:19], v[40:43]
  v_mfma_f32_16x16x32_bf16 v[44:47], a[92:95], v[16:19], v[44:47]
  ds_read_b128 v[12:15], v5 offset:26624
  s_waitcnt lgkmcnt(6)
  v_mfma_f32_16x16x32_bf16 v[56:59], a[36:39], v[20:23], v[56:59]
  v_mfma_f32_16x16x32_bf16 v[60:63], a[92:95], v[20:23], v[60:63]
  ds_read_b128 v[16:19], v5 offset:13312
  s_waitcnt lgkmcnt(6)
  v_mfma_f32_16x16x32_bf16 v[40:43], a[40:43], v[24:27], v[40:43]
  v_mfma_f32_16x16x32_bf16 v[44:47], a[96:99], v[24:27], v[44:47]
  ds_read_b128 v[20:23], v5 offset:27648
  s_waitcnt lgkmcnt(6)
  v_mfma_f32_16x16x32_bf16 v[56:59], a[40:43], v[28:31], v[56:59]
  v_mfma_f32_16x16x32_bf16 v[60:63], a[96:99], v[28:31], v[60:63]
  s_waitcnt lgkmcnt(5)
  v_mfma_f32_16x16x32_bf16 v[40:43], a[44:47], v[32:35], v[40:43]
  v_mfma_f32_16x16x32_bf16 v[44:47], a[100:103], v[32:35], v[44:47]
  s_waitcnt lgkmcnt(4)
  v_mfma_f32_16x16x32_bf16 v[56:59], a[44:47], v[36:39], v[56:59]
  v_mfma_f32_16x16x32_bf16 v[60:63], a[100:103], v[36:39], v[60:63]
  s_waitcnt lgkmcnt(3)
  v_mfma_f32_16x16x32_bf16 v[40:43], a[48:51], v[8:11], v[40:43]
  v_mfma_f32_16x16x32_bf16 v[44:47], a[104:107], v[8:11], v[44:47]
  s_waitcnt lgkmcnt(2)
  v_mfma_f32_16x16x32_bf16 v[56:59], a[48:51], v[12:15], v[56:59]
  v_mfma_f32_16x16x32_bf16 v[60:63], a[104:107], v[12:15], v[60:63]
  s_waitcnt lgkmcnt(1)
  v_mfma_f32_16x16x32_bf16 v[40:43], a[52:55], v[16:19], v[40:43]
  v_mfma_f32_16x16x32_bf16 v[44:47], a[108:111], v[16:19], v[44:47]
  s_waitcnt lgkmcnt(0)
  v_mfma_f32_16x16x32_bf16 v[56:59], a[52:55], v[20:23], v[56:59]
  v_mfma_f32_16x16x32_bf16 v[60:63], a[108:111], v[20:23], v[60:63]
  s_add_u32 s25, s29, 28672
  s_lshl_b32 s24, s19, 5
  s_add_u32 s24, s24, 0
  v_add_u32 v88, s24, v4
  v_mul_u32_u24 v89, 2341, v88
  v_lshrrev_b32 v89, 16, v89
  v_mul_u32_u24 v89, 84, v89
  v_add3_u32 v88, v88, v89, v6
  v_lshlrev_b32 v90, 4, v88
  v_cvt_pk_bf16_f32 v72, v40, v41
  v_cvt_pk_bf16_f32 v73, v42, v43
  v_cvt_pk_bf16_f32 v74, v44, v45
  v_cvt_pk_bf16_f32 v75, v46, v47
  buffer_store_dwordx4 v[72:75], v90, s[8:11], s29 offen sc1
  s_lshl_b32 s24, s19, 5
  s_add_u32 s24, s24, 16
  v_add_u32 v88, s24, v4
  v_mul_u32_u24 v89, 2341, v88
  v_lshrrev_b32 v89, 16, v89
  v_mul_u32_u24 v89, 84, v89
  v_add3_u32 v88, v88, v89, v6
  v_lshlrev_b32 v91, 4, v88
  v_cvt_pk_bf16_f32 v80, v56, v57
  v_cvt_pk_bf16_f32 v81, v58, v59
  v_cvt_pk_bf16_f32 v82, v60, v61
  v_cvt_pk_bf16_f32 v83, v62, v63
  buffer_store_dwordx4 v[80:83], v91, s[8:11], s29 offen sc1
  s_mov_b32 s33, s32
  s_add_u32 s32, s32, 28672
  s_cmp_eq_u32 s32, 86016
  s_cselect_b32 s32, 0, s32
  s_add_u32 s19, s19, 1
  s_cmp_lt_u32 s19, s35
  s_cbranch_scc1 wf_vo_loop
  s_branch wf_done
wf_done:
  s_lshr_b32 s20, s18, 1
  s_lshl_b32 s20, s20, 4
  s_and_b32 s21, s17, 15
  s_add_u32 s20, s20, s21
  s_lshl_b32 s20, s20, 7
  s_cmp_lt_u32 s17, 16
  s_cselect_b32 s21, 16384, 0
  s_add_u32 s20, s20, s21
  s_add_u32 s20, s20, 88528896
  s_sub_u32 s21, s35, s34
  s_lshr_b32 s21, s21, 1
  v_mov_b32 v5, s21
  v_mov_b32 v6, 0
  s_waitcnt vmcnt(0)
  s_mov_b64 exec, 1
  s_cmp_lg_u32 s18, 0
  s_cbranch_scc1 wf_h1
  v_mov_b32 v7, 2
  s_sub_u32 s21, s20, 2048
  buffer_atomic_add v7, v6, s[8:11], s21 offen
wf_h1:
  buffer_atomic_add v5, v6, s[8:11], s20 offen
  s_mov_b64 exec, -1
  s_branch wk_loop
wk_v7:
  s_sub_u32 s20, s3, 224
  s_mov_b32 s18, 1
  s_and_b32 s17, s20, 15
  s_add_u32 s17, s17, 16
  s_lshr_b32 s34, s20, 4
  s_lshl_b32 s34, s34, 1
  s_add_u32 s35, s34, 2
  s_branch wk_gemm
wk_vh:
  s_sub_u32 s20, s3, 496
  s_and_b32 s17, s20, 15
  s_add_u32 s17, s17, 16
  s_lshr_b32 s18, s20, 5
  s_add_u32 s18, s18, 2
  s_bitcmp1_b32 s20, 4
  s_cselect_b32 s34, 7, 0
  s_add_u32 s35, s34, 7
  s_branch wk_gemm
wk_vf:
  s_sub_u32 s20, s3, 560
  s_and_b32 s17, s20, 15
  s_add_u32 s17, s17, 16
  s_lshr_b32 s18, s20, 4
  s_add_u32 s18, s18, 4
  s_mov_b32 s34, 0
  s_mov_b32 s35, 14
  s_branch wk_gemm
wk_f:
  s_sub_u32 s20, s3, 624
  s_and_b32 s17, s20, 15
  s_lshr_b32 s18, s20, 4
  s_mov_b32 s34, 0
  s_mov_b32 s35, 14
  s_lshl_b32 s22, s17, 7
  s_add_u32 s22, s22, 88621056
  v_min_u32 v24, 96, v2
  s_mov_b32 s30, 0
wk_aw:
  buffer_load_dwordx4 v[28:31], v24, s[8:11], s22 offen sc1
  s_waitcnt vmcnt(0)
  v_cmp_ne_u64 vcc, s[88:89], v[28:29]
  s_cbranch_vccnz wk_aw_no
  v_cmp_ne_u64 vcc, s[88:89], v[30:31]
  s_cbranch_vccnz wk_aw_no
  s_branch wk_aw_ok
wk_aw_no:
  s_sleep 6
  s_add_u32 s30, s30, 1
  s_cmp_lt_u32 s30, 50000
  s_cbranch_scc1 wk_aw
  s_branch cA_abort
wk_aw_ok:
wk_gemm:
  s_lshl_b32 s20, s18, 4
  s_lshl_b32 s21, s16, 2
  s_add_u32 s20, s20, s21
  s_mul_i32 s21, s20, 14336
  s_add_u32 s21, s21, 71565312
  s_add_u32 s22, s21, 0
  buffer_load_dwordx4 a[0:3], v2, s[8:11], s22 offen offset:0 sc1
  buffer_load_dwordx4 a[4:7], v2, s[8:11], s22 offen offset:1024 sc1
  buffer_load_dwordx4 a[8:11], v2, s[8:11], s22 offen offset:2048 sc1
  buffer_load_dwordx4 a[12:15], v2, s[8:11], s22 offen offset:3072 sc1
  s_add_u32 s22, s21, 4096
  buffer_load_dwordx4 a[16:19], v2, s[8:11], s22 offen offset:0 sc1
  buffer_load_dwordx4 a[20:23], v2, s[8:11], s22 offen offset:1024 sc1
  buffer_load_dwordx4 a[24:27], v2, s[8:11], s22 offen offset:2048 sc1
  buffer_load_dwordx4 a[28:31], v2, s[8:11], s22 offen offset:3072 sc1
  s_add_u32 s22, s21, 8192
  buffer_load_dwordx4 a[32:35], v2, s[8:11], s22 offen offset:0 sc1
  buffer_load_dwordx4 a[36:39], v2, s[8:11], s22 offen offset:1024 sc1
  buffer_load_dwordx4 a[40:43], v2, s[8:11], s22 offen offset:2048 sc1
  buffer_load_dwordx4 a[44:47], v2, s[8:11], s22 offen offset:3072 sc1
  s_add_u32 s22, s21, 12288
  buffer_load_dwordx4 a[48:51], v2, s[8:11], s22 offen offset:0 sc1
  buffer_load_dwordx4 a[52:55], v2, s[8:11], s22 offen offset:1024 sc1
  buffer_load_dwordx4 a[56:59], v2, s[8:11], s22 offen offset:2048 sc1
  buffer_load_dwordx4 a[60:63], v2, s[8:11], s22 offen offset:3072 sc1
  s_add_u32 s22, s21, 16384
  buffer_load_dwordx4 a[64:67], v2, s[8:11], s22 offen offset:0 sc1
  buffer_load_dwordx4 a[68:71], v2, s[8:11], s22 offen offset:1024 sc1
  buffer_load_dwordx4 a[72:75], v2, s[8:11], s22 offen offset:2048 sc1
  buffer_load_dwordx4 a[76:79], v2, s[8:11], s22 offen offset:3072 sc1
  s_add_u32 s22, s21, 20480
  buffer_load_dwordx4 a[80:83], v2, s[8:11], s22 offen offset:0 sc1
  buffer_load_dwordx4 a[84:87], v2, s[8:11], s22 offen offset:1024 sc1
  buffer_load_dwordx4 a[88:91], v2, s[8:11], s22 offen offset:2048 sc1
  buffer_load_dwordx4 a[92:95], v2, s[8:11], s22 offen offset:3072 sc1
  s_add_u32 s22, s21, 24576
  buffer_load_dwordx4 a[96:99], v2, s[8:11], s22 offen offset:0 sc1
  buffer_load_dwordx4 a[100:103], v2, s[8:11], s22 offen offset:1024 sc1
  buffer_load_dwordx4 a[104:107], v2, s[8:11], s22 offen offset:2048 sc1
  buffer_load_dwordx4 a[108:111], v2, s[8:11], s22 offen offset:3072 sc1
  s_add_u32 s22, s21, 28672
  buffer_load_dwordx4 a[112:115], v2, s[8:11], s22 offen offset:0 sc1
  buffer_load_dwordx4 a[116:119], v2, s[8:11], s22 offen offset:1024 sc1
  buffer_load_dwordx4 a[120:123], v2, s[8:11], s22 offen offset:2048 sc1
  buffer_load_dwordx4 a[124:127], v2, s[8:11], s22 offen offset:3072 sc1
  s_add_u32 s22, s21, 32768
  buffer_load_dwordx4 a[128:131], v2, s[8:11], s22 offen offset:0 sc1
  buffer_load_dwordx4 a[132:135], v2, s[8:11], s22 offen offset:1024 sc1
  buffer_load_dwordx4 a[136:139], v2, s[8:11], s22 offen offset:2048 sc1
  buffer_load_dwordx4 a[140:143], v2, s[8:11], s22 offen offset:3072 sc1
  s_add_u32 s22, s21, 36864
  buffer_load_dwordx4 a[144:147], v2, s[8:11], s22 offen offset:0 sc1
  buffer_load_dwordx4 a[148:151], v2, s[8:11], s22 offen offset:1024 sc1
  buffer_load_dwordx4 a[152:155], v2, s[8:11], s22 offen offset:2048 sc1
  buffer_load_dwordx4 a[156:159], v2, s[8:11], s22 offen offset:3072 sc1
  s_add_u32 s22, s21, 40960
  buffer_load_dwordx4 a[160:163], v2, s[8:11], s22 offen offset:0 sc1
  buffer_load_dwordx4 a[164:167], v2, s[8:11], s22 offen offset:1024 sc1
  buffer_load_dwordx4 a[168:171], v2, s[8:11], s22 offen offset:2048 sc1
  buffer_load_dwordx4 a[172:175], v2, s[8:11], s22 offen offset:3072 sc1
  s_add_u32 s22, s21, 45056
  buffer_load_dwordx4 a[176:179], v2, s[8:11], s22 offen offset:0 sc1
  buffer_load_dwordx4 a[180:183], v2, s[8:11], s22 offen offset:1024 sc1
  buffer_load_dwordx4 a[184:187], v2, s[8:11], s22 offen offset:2048 sc1
  buffer_load_dwordx4 a[188:191], v2, s[8:11], s22 offen offset:3072 sc1
  s_add_u32 s22, s21, 49152
  buffer_load_dwordx4 a[192:195], v2, s[8:11], s22 offen offset:0 sc1
  buffer_load_dwordx4 a[196:199], v2, s[8:11], s22 offen offset:1024 sc1
  buffer_load_dwordx4 a[200:203], v2, s[8:11], s22 offen offset:2048 sc1
  buffer_load_dwordx4 a[204:207], v2, s[8:11], s22 offen offset:3072 sc1
  s_add_u32 s22, s21, 53248
  buffer_load_dwordx4 a[208:211], v2, s[8:11], s22 offen offset:0 sc1
  buffer_load_dwordx4 a[212:215], v2, s[8:11], s22 offen offset:1024 sc1
  buffer_load_dwordx4 a[216:219], v2, s[8:11], s22 offen offset:2048 sc1
  buffer_load_dwordx4 a[220:223], v2, s[8:11], s22 offen offset:3072 sc1
  s_waitcnt vmcnt(40)
  s_mul_i32 s23, s17, 401408
  s_and_b32 s22, s16, 1
  s_mul_i32 s22, s22, 7168
  s_add_u32 s23, s23, s22
  s_add_u32 s23, s23, 0
  s_lshr_b32 s22, s16, 1
  s_mul_i32 s22, s22, 14336
  s_add_u32 s23, s23, s22
  s_mul_i32 s27, s16, 7168
  s_lshr_b32 s28, s20, 1
  s_cmp_lt_u32 s17, 16
  s_cbranch_scc0 wg_vo
  s_add_u32 s23, s23, s22
  s_lshl_b32 s29, s28, 4
  s_add_u32 s29, s29, s17
  s_mul_i32 s29, s29, 28672
  s_add_u32 s29, s29, 12845056
  s_mov_b32 s31, 0
  s_lshr_b32 s24, s34, 1
  s_lshl_b32 s24, s24, 2
  s_and_b32 s25, s34, 1
  s_add_u32 s24, s24, s25
  s_mul_i32 s24, s24, 14336
  s_add_u32 s24, s24, s23
  s_cmp_lt_u32 s34, s35
  s_cselect_b32 s24, s24, 0x10000000
  s_add_u32 m0, s31, s27
  s_nop 0
  buffer_load_dwordx4 v2, s[8:11], s24 offen offset:0 sc1 lds
  buffer_load_dwordx4 v2, s[8:11], s24 offen offset:1024 sc1 lds
  buffer_load_dwordx4 v2, s[8:11], s24 offen offset:2048 sc1 lds
  buffer_load_dwordx4 v2, s[8:11], s24 offen offset:3072 sc1 lds
  s_add_u32 m0, m0, 4096
  s_add_u32 s24, s24, 4096
  buffer_load_dwordx4 v2, s[8:11], s24 offen offset:0 sc1 lds
  buffer_load_dwordx4 v2, s[8:11], s24 offen offset:1024 sc1 lds
  buffer_load_dwordx4 v2, s[8:11], s24 offen offset:2048 sc1 lds
  s_add_u32 s30, s34, 1
  s_mov_b32 s31, 28672
  s_lshr_b32 s24, s30, 1
  s_lshl_b32 s24, s24, 2
  s_and_b32 s25, s30, 1
  s_add_u32 s24, s24, s25
  s_mul_i32 s24, s24, 14336
  s_add_u32 s24, s24, s23
  s_cmp_lt_u32 s30, s35
  s_cselect_b32 s24, s24, 0x10000000
  s_add_u32 m0, s31, s27
  s_nop 0
  buffer_load_dwordx4 v2, s[8:11], s24 offen offset:0 sc1 lds
  buffer_load_dwordx4 v2, s[8:11], s24 offen offset:1024 sc1 lds
  buffer_load_dwordx4 v2, s[8:11], s24 offen offset:2048 sc1 lds
  buffer_load_dwordx4 v2, s[8:11], s24 offen offset:3072 sc1 lds
  s_add_u32 m0, m0, 4096
  s_add_u32 s24, s24, 4096
  buffer_load_dwordx4 v2, s[8:11], s24 offen offset:0 sc1 lds
  buffer_load_dwordx4 v2, s[8:11], s24 offen offset:1024 sc1 lds
  buffer_load_dwordx4 v2, s[8:11], s24 offen offset:2048 sc1 lds
  s_mov_b32 s19, s34
  s_mov_b32 s32, 0
  s_mov_b32 s33, 57344
  s_waitcnt vmcnt(7)
  s_branch wg_f_in
wg_f_loop:
  s_waitcnt vmcnt(11)
wg_f_in:
  s_barrier
  s_add_u32 s30, s19, 2
  s_lshr_b32 s24, s30, 1
  s_lshl_b32 s24, s24, 2
  s_and_b32 s25, s30, 1
  s_add_u32 s24, s24, s25
  s_mul_i32 s24, s24, 14336
  s_add_u32 s24, s24, s23
  s_cmp_lt_u32 s30, s35
  s_cselect_b32 s24, s24, 0x10000000
  s_add_u32 m0, s33, s27
  s_nop 0
  buffer_load_dwordx4 v2, s[8:11], s24 offen offset:0 sc1 lds
  buffer_load_dwordx4 v2, s[8:11], s24 offen offset:1024 sc1 lds
  buffer_load_dwordx4 v2, s[8:11], s24 offen offset:2048 sc1 lds
  buffer_load_dwordx4 v2, s[8:11], s24 offen offset:3072 sc1 lds
  s_add_u32 m0, m0, 4096
  s_add_u32 s24, s24, 4096
  buffer_load_dwordx4 v2, s[8:11], s24 offen offset:0 sc1 lds
  buffer_load_dwordx4 v2, s[8:11], s24 offen offset:1024 sc1 lds
  buffer_load_dwordx4 v2, s[8:11], s24 offen offset:2048 sc1 lds
  v_add_u32 v5, s32, v2
  ds_read_b128 v[8:11], v5 offset:0
  ds_read_b128 v[12:15], v5 offset:14336
  ds_read_b128 v[16:19], v5 offset:1024
  ds_read_b128 v[20:23], v5 offset:15360
  ds_read_b128 v[24:27], v5 offset:2048
  ds_read_b128 v[28:31], v5 offset:16384
  ds_read_b128 v[32:35], v5 offset:3072
  s_waitcnt lgkmcnt(6)
  v_mfma_f32_16x16x32_bf16 v[40:43], v[8:11], a[0:3], 0
  v_mfma_f32_16x16x32_bf16 v[44:47], v[8:11], a[56:59], 0
  v_mfma_f32_16x16x32_bf16 v[48:51], v[8:11], a[112:115], 0
  v_mfma_f32_16x16x32_bf16 v[52:55], v[8:11], a[168:171], 0
  ds_read_b128 v[36:39], v5 offset:17408
  s_waitcnt lgkmcnt(6)
  v_mfma_f32_16x16x32_bf16 v[56:59], v[12:15], a[0:3], 0
  v_mfma_f32_16x16x32_bf16 v[60:63], v[12:15], a[56:59], 0
  v_mfma_f32_16x16x32_bf16 v[64:67], v[12:15], a[112:115], 0
  v_mfma_f32_16x16x32_bf16 v[68:71], v[12:15], a[168:171], 0
  ds_read_b128 v[8:11], v5 offset:4096
  s_waitcnt lgkmcnt(6)
  v_mfma_f32_16x16x32_bf16 v[40:43], v[16:19], a[4:7], v[40:43]
  v_mfma_f32_16x16x32_bf16 v[44:47], v[16:19], a[60:63], v[44:47]
  v_mfma_f32_16x16x32_bf16 v[48:51], v[16:19], a[116:119], v[48:51]
  v_mfma_f32_16x16x32_bf16 v[52:55], v[16:19], a[172:175], v[52:55]
  ds_read_b128 v[12:15], v5 offset:18432
  s_waitcnt lgkmcnt(6)
  v_mfma_f32_16x16x32_bf16 v[56:59], v[20:23], a[4:7], v[56:59]
  v_mfma_f32_16x16x32_bf16 v[60:63], v[20:23], a[60:63], v[60:63]
  v_mfma_f32_16x16x32_bf16 v[64:67], v[20:23], a[116:119], v[64:67]
  v_mfma_f32_16x16x32_bf16 v[68:71], v[20:23], a[172:175], v[68:71]
  ds_read_b128 v[16:19], v5 offset:5120
  s_waitcnt lgkmcnt(6)
  v_mfma_f32_16x16x32_bf16 v[40:43], v[24:27], a[8:11], v[40:43]
  v_mfma_f32_16x16x32_bf16 v[44:47], v[24:27], a[64:67], v[44:47]
  v_mfma_f32_16x16x32_bf16 v[48:51], v[24:27], a[120:123], v[48:51]
  v_mfma_f32_16x16x32_bf16 v[52:55], v[24:27], a[176:179], v[52:55]
  ds_read_b128 v[20:23], v5 offset:19456
  s_waitcnt lgkmcnt(6)
  v_mfma_f32_16x16x32_bf16 v[56:59], v[28:31], a[8:11], v[56:59]
  v_mfma_f32_16x16x32_bf16 v[60:63], v[28:31], a[64:67], v[60:63]
  v_mfma_f32_16x16x32_bf16 v[64:67], v[28:31], a[120:123], v[64:67]
  v_mfma_f32_16x16x32_bf16 v[68:71], v[28:31], a[176:179], v[68:71]
  ds_read_b128 v[24:27], v5 offset:6144
  s_waitcnt lgkmcnt(6)
  v_mfma_f32_16x16x32_bf16 v[40:43], v[32:35], a[12:15], v[40:43]
  v_mfma_f32_16x16x32_bf16 v[44:47], v[32:35], a[68:71], v[44:47]
  v_mfma_f32_16x16x32_bf16 v[48:51], v[32:35], a[124:127], v[48:51]
  v_mfma_f32_16x16x32_bf16 v[52:55], v[32:35], a[180:183], v[52:55]
  ds_read_b128 v[28:31], v5 offset:20480
  s_waitcnt lgkmcnt(6)
  v_mfma_f32_16x16x32_bf16 v[56:59], v[36:39], a[12:15], v[56:59]
  v_mfma_f32_16x16x32_bf16 v[60:63], v[36:39], a[68:71], v[60:63]
  v_mfma_f32_16x16x32_bf16 v[64:67], v[36:39], a[124:127], v[64:67]
  v_mfma_f32_16x16x32_bf16 v[68:71], v[36:39], a[180:183], v[68:71]
  ds_read_b128 v[32:35], v5 offset:7168
  s_waitcnt lgkmcnt(6)
  v_mfma_f32_16x16x32_bf16 v[40:43], v[8:11], a[16:19], v[40:43]
  v_mfma_f32_16x16x32_bf16 v[44:47], v[8:11], a[72:75], v[44:47]
  v_mfma_f32_16x16x32_bf16 v[48:51], v[8:11], a[128:131], v[48:51]
  v_mfma_f32_16x16x32_bf16 v[52:55], v[8:11], a[184:187], v[52:55]
  ds_read_b128 v[36:39], v5 offset:21504
  s_waitcnt lgkmcnt(6)
  v_mfma_f32_16x16x32_bf16 v[56:59], v[12:15], a[16:19], v[56:59]
  v_mfma_f32_16x16x32_bf16 v[60:63], v[12:15], a[72:75], v[60:63]
  v_mfma_f32_16x16x32_bf16 v[64:67], v[12:15], a[128:131], v[64:67]
  v_mfma_f32_16x16x32_bf16 v[68:71], v[12:15], a[184:187], v[68:71]
  ds_read_b128 v[8:11], v5 offset:8192
  s_waitcnt lgkmcnt(6)
  v_mfma_f32_16x16x32_bf16 v[40:43], v[16:19], a[20:23], v[40:43]
  v_mfma_f32_16x16x32_bf16 v[44:47], v[16:19], a[76:79], v[44:47]
  v_mfma_f32_16x16x32_bf16 v[48:51], v[16:19], a[132:135], v[48:51]
  v_mfma_f32_16x16x32_bf16 v[52:55], v[16:19], a[188:191], v[52:55]
  ds_read_b128 v[12:15], v5 offset:22528
  s_waitcnt lgkmcnt(6)
  v_mfma_f32_16x16x32_bf16 v[56:59], v[20:23], a[20:23], v[56:59]
  v_mfma_f32_16x16x32_bf16 v[60:63], v[20:23], a[76:79], v[60:63]
  v_mfma_f32_16x16x32_bf16 v[64:67], v[20:23], a[132:135], v[64:67]
  v_mfma_f32_16x16x32_bf16 v[68:71], v[20:23], a[188:191], v[68:71]
  ds_read_b128 v[16:19], v5 offset:9216
  s_waitcnt lgkmcnt(6)
  v_mfma_f32_16x16x32_bf16 v[40:43], v[24:27], a[24:27], v[40:43]
  v_mfma_f32_16x16x32_bf16 v[44:47], v[24:27], a[80:83], v[44:47]
  v_mfma_f32_16x16x32_bf16 v[48:51], v[24:27], a[136:139], v[48:51]
  v_mfma_f32_16x16x32_bf16 v[52:55], v[24:27], a[192:195], v[52:55]
  ds_read_b128 v[20:23], v5 offset:23552
  s_waitcnt lgkmcnt(6)
  v_mfma_f32_16x16x32_bf16 v[56:59], v[28:31], a[24:27], v[56:59]
  v_mfma_f32_16x16x32_bf16 v[60:63], v[28:31], a[80:83], v[60:63]
  v_mfma_f32_16x16x32_bf16 v[64:67], v[28:31], a[136:139], v[64:67]
  v_mfma_f32_16x16x32_bf16 v[68:71], v[28:31], a[192:195], v[68:71]
  ds_read_b128 v[24:27], v5 offset:10240
  s_waitcnt lgkmcnt(6)
  v_mfma_f32_16x16x32_bf16 v[40:43], v[32:35], a[28:31], v[40:43]
  v_mfma_f32_16x16x32_bf16 v[44:47], v[32:35], a[84:87], v[44:47]
  v_mfma_f32_16x16x32_bf16 v[48:51], v[32:35], a[140:143], v[48:51]
  v_mfma_f32_16x16x32_bf16 v[52:55], v[32:35], a[196:199], v[52:55]
  ds_read_b128 v[28:31], v5 offset:24576
  s_waitcnt lgkmcnt(6)
  v_mfma_f32_16x16x32_bf16 v[56:59], v[36:39], a[28:31], v[56:59]
  v_mfma_f32_16x16x32_bf16 v[60:63], v[36:39], a[84:87], v[60:63]
  v_mfma_f32_16x16x32_bf16 v[64:67], v[36:39], a[140:143], v[64:67]
  v_mfma_f32_16x16x32_bf16 v[68:71], v[36:39], a[196:199], v[68:71]
  ds_read_b128 v[32:35], v5 offset:11264
  s_waitcnt lgkmcnt(6)
  v_mfma_f32_16x16x32_bf16 v[40:43], v[8:11], a[32:35], v[40:43]
  v_mfma_f32_16x16x32_bf16 v[44:47], v[8:11], a[88:91], v[44:47]
  v_mfma_f32_16x16x32_bf16 v[48:51], v[8:11], a[144:147], v[48:51]
  v_mfma_f32_16x16x32_bf16 v[52:55], v[8:11], a[200:203], v[52:55]
  ds_read_b128 v[36:39], v5 offset:25600
  s_waitcnt lgkmcnt(6)
  v_mfma_f32_16x16x32_bf16 v[56:59], v[12:15], a[32:35], v[56:59]
  v_mfma_f32_16x16x32_bf16 v[60:63], v[12:15], a[88:91], v[60:63]
  v_mfma_f32_16x16x32_bf16 v[64:67], v[12:15], a[144:147], v[64:67]
  v_mfma_f32_16x16x32_bf16 v[68:71], v[12:15], a[200:203], v[68:71]
  ds_read_b128 v[8:11], v5 offset:12288
  s_waitcnt lgkmcnt(6)
  v_mfma_f32_16x16x32_bf16 v[40:43], v[16:19], a[36:39], v[40:43]
  v_mfma_f32_16x16x32_bf16 v[44:47], v[16:19], a[92:95], v[44:47]
  v_mfma_f32_16x16x32_bf16 v[48:51], v[16:19], a[148:151], v[48:51]
  v_mfma_f32_16x16x32_bf16 v[52:55], v[16:19], a[204:207], v[52:55]
  ds_read_b128 v[12:15], v5 offset:26624
  s_waitcnt lgkmcnt(6)
  v_mfma_f32_16x16x32_bf16 v[56:59], v[20:23], a[36:39], v[56:59]
  v_mfma_f32_16x16x32_bf16 v[60:63], v[20:23], a[92:95], v[60:63]
  v_mfma_f32_16x16x32_bf16 v[64:67], v[20:23], a[148:151], v[64:67]
  v_mfma_f32_16x16x32_bf16 v[68:71], v[20:23], a[204:207], v[68:71]
  ds_read_b128 v[16:19], v5 offset:13312
  s_waitcnt lgkmcnt(6)
  v_mfma_f32_16x16x32_bf16 v[40:43], v[24:27], a[40:43], v[40:43]
  v_mfma_f32_16x16x32_bf16 v[44:47], v[24:27], a[96:99], v[44:47]
  v_mfma_f32_16x16x32_bf16 v[48:51], v[24:27], a[152:155], v[48:51]
  v_mfma_f32_16x16x32_bf16 v[52:55], v[24:27], a[208:211], v[52:55]
  ds_read_b128 v[20:23], v5 offset:27648
  s_waitcnt lgkmcnt(6)
  v_mfma_f32_16x16x32_bf16 v[56:59], v[28:31], a[40:43], v[56:59]
  v_mfma_f32_16x16x32_bf16 v[60:63], v[28:31], a[96:99], v[60:63]
  v_mfma_f32_16x16x32_bf16 v[64:67], v[28:31], a[152:155], v[64:67]
  v_mfma_f32_16x16x32_bf16 v[68:71], v[28:31], a[208:211], v[68:71]
  s_waitcnt lgkmcnt(5)
  v_mfma_f32_16x16x32_bf16 v[40:43], v[32:35], a[44:47], v[40:43]
  v_mfma_f32_16x16x32_bf16 v[44:47], v[32:35], a[100:103], v[44:47]
  v_mfma_f32_16x16x32_bf16 v[48:51], v[32:35], a[156:159], v[48:51]
  v_mfma_f32_16x16x32_bf16 v[52:55], v[32:35], a[212:215], v[52:55]
  s_waitcnt lgkmcnt(4)
  v_mfma_f32_16x16x32_bf16 v[56:59], v[36:39], a[44:47], v[56:59]
  v_mfma_f32_16x16x32_bf16 v[60:63], v[36:39], a[100:103], v[60:63]
  v_mfma_f32_16x16x32_bf16 v[64:67], v[36:39], a[156:159], v[64:67]
  v_mfma_f32_16x16x32_bf16 v[68:71], v[36:39], a[212:215], v[68:71]
  s_waitcnt lgkmcnt(3)
  v_mfma_f32_16x16x32_bf16 v[40:43], v[8:11], a[48:51], v[40:43]
  v_mfma_f32_16x16x32_bf16 v[44:47], v[8:11], a[104:107], v[44:47]
  v_mfma_f32_16x16x32_bf16 v[48:51], v[8:11], a[160:163], v[48:51]
  v_mfma_f32_16x16x32_bf16 v[52:55], v[8:11], a[216:219], v[52:55]
  s_waitcnt lgkmcnt(2)
  v_mfma_f32_16x16x32_bf16 v[56:59], v[12:15], a[48:51], v[56:59]
  v_mfma_f32_16x16x32_bf16 v[60:63], v[12:15], a[104:107], v[60:63]
  v_mfma_f32_16x16x32_bf16 v[64:67], v[12:15], a[160:163], v[64:67]
  v_mfma_f32_16x16x32_bf16 v[68:71], v[12:15], a[216:219], v[68:71]
  s_waitcnt lgkmcnt(1)
  v_mfma_f32_16x16x32_bf16 v[40:43], v[16:19], a[52:55], v[40:43]
  v_mfma_f32_16x16x32_bf16 v[44:47], v[16:19], a[108:111], v[44:47]
  v_mfma_f32_16x16x32_bf16 v[48:51], v[16:19], a[164:167], v[48:51]
  v_mfma_f32_16x16x32_bf16 v[52:55], v[16:19], a[220:223], v[52:55]
  s_waitcnt lgkmcnt(0)
  v_mfma_f32_16x16x32_bf16 v[56:59], v[20:23], a[52:55], v[56:59]
  v_mfma_f32_16x16x32_bf16 v[60:63], v[20:23], a[108:111], v[60:63]
  v_mfma_f32_16x16x32_bf16 v[64:67], v[20:23], a[164:167], v[64:67]
  v_mfma_f32_16x16x32_bf16 v[68:71], v[20:23], a[220:223], v[68:71]
  s_lshl_b32 s24, s19, 10
  s_add_u32 s24, s24, s29
  v_cvt_pk_bf16_f32 v72, v40, v41
  v_cvt_pk_bf16_f32 v73, v42, v43
  v_cvt_pk_bf16_f32 v74, v56, v57
  v_cvt_pk_bf16_f32 v75, v58, v59
  s_add_u32 s25, s24, 0
  buffer_store_dwordx4 v[72:75], v2, s[8:11], s25 offen sc1
  v_cvt_pk_bf16_f32 v76, v44, v45
  v_cvt_pk_bf16_f32 v77, v46, v47
  v_cvt_pk_bf16_f32 v78, v60, v61
  v_cvt_pk_bf16_f32 v79, v62, v63
  s_add_u32 s25, s24, 14336
  buffer_store_dwordx4 v[76:79], v2, s[8:11], s25 offen sc1
  v_cvt_pk_bf16_f32 v80, v48, v49
  v_cvt_pk_bf16_f32 v81, v50, v51
  v_cvt_pk_bf16_f32 v82, v64, v65
  v_cvt_pk_bf16_f32 v83, v66, v67
  s_add_u32 s25, s24, 458752
  buffer_store_dwordx4 v[80:83], v2, s[8:11], s25 offen sc1
  v_cvt_pk_bf16_f32 v84, v52, v53
  v_cvt_pk_bf16_f32 v85, v54, v55
  v_cvt_pk_bf16_f32 v86, v68, v69
  v_cvt_pk_bf16_f32 v87, v70, v71
  s_add_u32 s25, s24, 473088
  buffer_store_dwordx4 v[84:87], v2, s[8:11], s25 offen sc1
  s_mov_b32 s33, s32
  s_add_u32 s32, s32, 28672
  s_cmp_eq_u32 s32, 86016
  s_cselect_b32 s32, 0, s32
  s_add_u32 s19, s19, 1
  s_cmp_lt_u32 s19, s35
  s_cbranch_scc1 wg_f_loop
  s_branch wg_done
wg_vo:
  s_sub_u32 s29, s17, 16
  s_lshl_b32 s29, s29, 6
  s_add_u32 s29, s29, s28
  s_mul_i32 s29, s29, 28672
  s_add_u32 s29, s29, 42205184
  v_mul_u32_u24 v6, 28, v3
  s_mov_b32 s31, 0
  s_lshl_b32 s24, s34, 1
  s_mul_i32 s24, s24, 14336
  s_add_u32 s24, s24, s23
  s_cmp_lt_u32 s34, s35
  s_cselect_b32 s24, s24, 0x10000000
  s_add_u32 m0, s31, s27
  s_nop 0
  buffer_load_dwordx4 v2, s[8:11], s24 offen offset:0 sc1 lds
  buffer_load_dwordx4 v2, s[8:11], s24 offen offset:1024 sc1 lds
  buffer_load_dwordx4 v2, s[8:11], s24 offen offset:2048 sc1 lds
  buffer_load_dwordx4 v2, s[8:11], s24 offen offset:3072 sc1 lds
  s_add_u32 m0, m0, 4096
  s_add_u32 s24, s24, 4096
  buffer_load_dwordx4 v2, s[8:11], s24 offen offset:0 sc1 lds
  buffer_load_dwordx4 v2, s[8:11], s24 offen offset:1024 sc1 lds
  buffer_load_dwordx4 v2, s[8:11], s24 offen offset:2048 sc1 lds
  s_add_u32 s30, s34, 1
  s_mov_b32 s31, 28672
  s_lshl_b32 s24, s30, 1
  s_mul_i32 s24, s24, 14336
  s_add_u32 s24, s24, s23
  s_cmp_lt_u32 s30, s35
  s_cselect_b32 s24, s24, 0x10000000
  s_add_u32 m0, s31, s27
  s_nop 0
  buffer_load_dwordx4 v2, s[8:11], s24 offen offset:0 sc1 lds
  buffer_load_dwordx4 v2, s[8:11], s24 offen offset:1024 sc1 lds
  buffer_load_dwordx4 v2, s[8:11], s24 offen offset:2048 sc1 lds
  buffer_load_dwordx4 v2, s[8:11], s24 offen offset:3072 sc1 lds
  s_add_u32 m0, m0, 4096
  s_add_u32 s24, s24, 4096
  buffer_load_dwordx4 v2, s[8:11], s24 offen offset:0 sc1 lds
  buffer_load_dwordx4 v2, s[8:11], s24 offen offset:1024 sc1 lds
  buffer_load_dwordx4 v2, s[8:11], s24 offen offset:2048 sc1 lds
  s_mov_b32 s19, s34
  s_mov_b32 s32, 0
  s_mov_b32 s33, 57344
  s_waitcnt vmcnt(7)
  s_branch wg_vo_in
wg_vo_loop:
  s_waitcnt vmcnt(11)
wg_vo_in:
  s_barrier
  s_add_u32 s30, s19, 2
  s_lshl_b32 s24, s30, 1
  s_mul_i32 s24, s24, 14336
  s_add_u32 s24, s24, s23
  s_cmp_lt_u32 s30, s35
  s_cselect_b32 s24, s24, 0x10000000
  s_add_u32 m0, s33, s27
  s_nop 0
  buffer_load_dwordx4 v2, s[8:11], s24 offen offset:0 sc1 lds
  buffer_load_dwordx4 v2, s[8:11], s24 offen offset:1024 sc1 lds
  buffer_load_dwordx4 v2, s[8:11], s24 offen offset:2048 sc1 lds
  buffer_load_dwordx4 v2, s[8:11], s24 offen offset:3072 sc1 lds
  s_add_u32 m0, m0, 4096
  s_add_u32 s24, s24, 4096
  buffer_load_dwordx4 v2, s[8:11], s24 offen offset:0 sc1 lds
  buffer_load_dwordx4 v2, s[8:11], s24 offen offset:1024 sc1 lds
  buffer_load_dwordx4 v2, s[8:11], s24 offen offset:2048 sc1 lds
  v_add_u32 v5, s32, v2
  ds_read_b128 v[8:11], v5 offset:0
  ds_read_b128 v[12:15], v5 offset:14336
  ds_read_b128 v[16:19], v5 offset:1024
  ds_read_b128 v[20:23], v5 offset:15360
  ds_read_b128 v[24:27], v5 offset:2048
  ds_read_b128 v[28:31], v5 offset:16384
  ds_read_b128 v[32:35], v5 offset:3072
  s_waitcnt lgkmcnt(6)
  v_mfma_f32_16x16x32_bf16 v[40:43], a[0:3], v[8:11], 0
  v_mfma_f32_16x16x32_bf16 v[44:47], a[56:59], v[8:11], 0
  v_mfma_f32_16x16x32_bf16 v[48:51], a[112:115], v[8:11], 0
  v_mfma_f32_16x16x32_bf16 v[52:55], a[168:171], v[8:11], 0
  ds_read_b128 v[36:39], v5 offset:17408
  s_waitcnt lgkmcnt(6)
  v_mfma_f32_16x16x32_bf16 v[56:59], a[0:3], v[12:15], 0
  v_mfma_f32_16x16x32_bf16 v[60:63], a[56:59], v[12:15], 0
  v_mfma_f32_16x16x32_bf16 v[64:67], a[112:115], v[12:15], 0
  v_mfma_f32_16x16x32_bf16 v[68:71], a[168:171], v[12:15], 0
  ds_read_b128 v[8:11], v5 offset:4096
  s_waitcnt lgkmcnt(6)
  v_mfma_f32_16x16x32_bf16 v[40:43], a[4:7], v[16:19], v[40:43]
  v_mfma_f32_16x16x32_bf16 v[44:47], a[60:63], v[16:19], v[44:47]
  v_mfma_f32_16x16x32_bf16 v[48:51], a[116:119], v[16:19], v[48:51]
  v_mfma_f32_16x16x32_bf16 v[52:55], a[172:175], v[16:19], v[52:55]
  ds_read_b128 v[12:15], v5 offset:18432
  s_waitcnt lgkmcnt(6)
  v_mfma_f32_16x16x32_bf16 v[56:59], a[4:7], v[20:23], v[56:59]
  v_mfma_f32_16x16x32_bf16 v[60:63], a[60:63], v[20:23], v[60:63]
  v_mfma_f32_16x16x32_bf16 v[64:67], a[116:119], v[20:23], v[64:67]
  v_mfma_f32_16x16x32_bf16 v[68:71], a[172:175], v[20:23], v[68:71]
  ds_read_b128 v[16:19], v5 offset:5120
  s_waitcnt lgkmcnt(6)
  v_mfma_f32_16x16x32_bf16 v[40:43], a[8:11], v[24:27], v[40:43]
  v_mfma_f32_16x16x32_bf16 v[44:47], a[64:67], v[24:27], v[44:47]
  v_mfma_f32_16x16x32_bf16 v[48:51], a[120:123], v[24:27], v[48:51]
  v_mfma_f32_16x16x32_bf16 v[52:55], a[176:179], v[24:27], v[52:55]
  ds_read_b128 v[20:23], v5 offset:19456
  s_waitcnt lgkmcnt(6)
  v_mfma_f32_16x16x32_bf16 v[56:59], a[8:11], v[28:31], v[56:59]
  v_mfma_f32_16x16x32_bf16 v[60:63], a[64:67], v[28:31], v[60:63]
  v_mfma_f32_16x16x32_bf16 v[64:67], a[120:123], v[28:31], v[64:67]
  v_mfma_f32_16x16x32_bf16 v[68:71], a[176:179], v[28:31], v[68:71]
  ds_read_b128 v[24:27], v5 offset:6144
  s_waitcnt lgkmcnt(6)
  v_mfma_f32_16x16x32_bf16 v[40:43], a[12:15], v[32:35], v[40:43]
  v_mfma_f32_16x16x32_bf16 v[44:47], a[68:71], v[32:35], v[44:47]
  v_mfma_f32_16x16x32_bf16 v[48:51], a[124:127], v[32:35], v[48:51]
  v_mfma_f32_16x16x32_bf16 v[52:55], a[180:183], v[32:35], v[52:55]
  ds_read_b128 v[28:31], v5 offset:20480
  s_waitcnt lgkmcnt(6)
  v_mfma_f32_16x16x32_bf16 v[56:59], a[12:15], v[36:39], v[56:59]
  v_mfma_f32_16x16x32_bf16 v[60:63], a[68:71], v[36:39], v[60:63]
  v_mfma_f32_16x16x32_bf16 v[64:67], a[124:127], v[36:39], v[64:67]
  v_mfma_f32_16x16x32_bf16 v[68:71], a[180:183], v[36:39], v[68:71]
  ds_read_b128 v[32:35], v5 offset:7168
  s_waitcnt lgkmcnt(6)
  v_mfma_f32_16x16x32_bf16 v[40:43], a[16:19], v[8:11], v[40:43]
  v_mfma_f32_16x16x32_bf16 v[44:47], a[72:75], v[8:11], v[44:47]
  v_mfma_f32_16x16x32_bf16 v[48:51], a[128:131], v[8:11], v[48:51]
  v_mfma_f32_16x16x32_bf16 v[52:55], a[184:187], v[8:11], v[52:55]
  ds_read_b128 v[36:39], v5 offset:21504
  s_waitcnt lgkmcnt(6)
  v_mfma_f32_16x16x32_bf16 v[56:59], a[16:19], v[12:15], v[56:59]
  v_mfma_f32_16x16x32_bf16 v[60:63], a[72:75], v[12:15], v[60:63]
  v_mfma_f32_16x16x32_bf16 v[64:67], a[128:131], v[12:15], v[64:67]
  v_mfma_f32_16x16x32_bf16 v[68:71], a[184:187], v[12:15], v[68:71]
  ds_read_b128 v[8:11], v5 offset:8192
  s_waitcnt lgkmcnt(6)
  v_mfma_f32_16x16x32_bf16 v[40:43], a[20:23], v[16:19], v[40:43]
  v_mfma_f32_16x16x32_bf16 v[44:47], a[76:79], v[16:19], v[44:47]
  v_mfma_f32_16x16x32_bf16 v[48:51], a[132:135], v[16:19], v[48:51]
  v_mfma_f32_16x16x32_bf16 v[52:55], a[188:191], v[16:19], v[52:55]
  ds_read_b128 v[12:15], v5 offset:22528
  s_waitcnt lgkmcnt(6)
  v_mfma_f32_16x16x32_bf16 v[56:59], a[20:23], v[20:23], v[56:59]
  v_mfma_f32_16x16x32_bf16 v[60:63], a[76:79], v[20:23], v[60:63]
  v_mfma_f32_16x16x32_bf16 v[64:67], a[132:135], v[20:23], v[64:67]
  v_mfma_f32_16x16x32_bf16 v[68:71], a[188:191], v[20:23], v[68:71]
  ds_read_b128 v[16:19], v5 offset:9216
  s_waitcnt lgkmcnt(6)
  v_mfma_f32_16x16x32_bf16 v[40:43], a[24:27], v[24:27], v[40:43]
  v_mfma_f32_16x16x32_bf16 v[44:47], a[80:83], v[24:27], v[44:47]
  v_mfma_f32_16x16x32_bf16 v[48:51], a[136:139], v[24:27], v[48:51]
  v_mfma_f32_16x16x32_bf16 v[52:55], a[192:195], v[24:27], v[52:55]
  ds_read_b128 v[20:23], v5 offset:23552
  s_waitcnt lgkmcnt(6)
  v_mfma_f32_16x16x32_bf16 v[56:59], a[24:27], v[28:31], v[56:59]
  v_mfma_f32_16x16x32_bf16 v[60:63], a[80:83], v[28:31], v[60:63]
  v_mfma_f32_16x16x32_bf16 v[64:67], a[136:139], v[28:31], v[64:67]
  v_mfma_f32_16x16x32_bf16 v[68:71], a[192:195], v[28:31], v[68:71]
  ds_read_b128 v[24:27], v5 offset:10240
  s_waitcnt lgkmcnt(6)
  v_mfma_f32_16x16x32_bf16 v[40:43], a[28:31], v[32:35], v[40:43]
  v_mfma_f32_16x16x32_bf16 v[44:47], a[84:87], v[32:35], v[44:47]
  v_mfma_f32_16x16x32_bf16 v[48:51], a[140:143], v[32:35], v[48:51]
  v_mfma_f32_16x16x32_bf16 v[52:55], a[196:199], v[32:35], v[52:55]
  ds_read_b128 v[28:31], v5 offset:24576
  s_waitcnt lgkmcnt(6)
  v_mfma_f32_16x16x32_bf16 v[56:59], a[28:31], v[36:39], v[56:59]
  v_mfma_f32_16x16x32_bf16 v[60:63], a[84:87], v[36:39], v[60:63]
  v_mfma_f32_16x16x32_bf16 v[64:67], a[140:143], v[36:39], v[64:67]
  v_mfma_f32_16x16x32_bf16 v[68:71], a[196:199], v[36:39], v[68:71]
  ds_read_b128 v[32:35], v5 offset:11264
  s_waitcnt lgkmcnt(6)
  v_mfma_f32_16x16x32_bf16 v[40:43], a[32:35], v[8:11], v[40:43]
  v_mfma_f32_16x16x32_bf16 v[44:47], a[88:91], v[8:11], v[44:47]
  v_mfma_f32_16x16x32_bf16 v[48:51], a[144:147], v[8:11], v[48:51]
  v_mfma_f32_16x16x32_bf16 v[52:55], a[200:203], v[8:11], v[52:55]
  ds_read_b128 v[36:39], v5 offset:25600
  s_waitcnt lgkmcnt(6)
  v_mfma_f32_16x16x32_bf16 v[56:59], a[32:35], v[12:15], v[56:59]
  v_mfma_f32_16x16x32_bf16 v[60:63], a[88:91], v[12:15], v[60:63]
  v_mfma_f32_16x16x32_bf16 v[64:67], a[144:147], v[12:15], v[64:67]
  v_mfma_f32_16x16x32_bf16 v[68:71], a[200:203], v[12:15], v[68:71]
  ds_read_b128 v[8:11], v5 offset:12288
  s_waitcnt lgkmcnt(6)
  v_mfma_f32_16x16x32_bf16 v[40:43], a[36:39], v[16:19], v[40:43]
  v_mfma_f32_16x16x32_bf16 v[44:47], a[92:95], v[16:19], v[44:47]
  v_mfma_f32_16x16x32_bf16 v[48:51], a[148:151], v[16:19], v[48:51]
  v_mfma_f32_16x16x32_bf16 v[52:55], a[204:207], v[16:19], v[52:55]
  ds_read_b128 v[12:15], v5 offset:26624
  s_waitcnt lgkmcnt(6)
  v_mfma_f32_16x16x32_bf16 v[56:59], a[36:39], v[20:23], v[56:59]
  v_mfma_f32_16x16x32_bf16 v[60:63], a[92:95], v[20:23], v[60:63]
  v_mfma_f32_16x16x32_bf16 v[64:67], a[148:151], v[20:23], v[64:67]
  v_mfma_f32_16x16x32_bf16 v[68:71], a[204:207], v[20:23], v[68:71]
  ds_read_b128 v[16:19], v5 offset:13312
  s_waitcnt lgkmcnt(6)
  v_mfma_f32_16x16x32_bf16 v[40:43], a[40:43], v[24:27], v[40:43]
  v_mfma_f32_16x16x32_bf16 v[44:47], a[96:99], v[24:27], v[44:47]
  v_mfma_f32_16x16x32_bf16 v[48:51], a[152:155], v[24:27], v[48:51]
  v_mfma_f32_16x16x32_bf16 v[52:55], a[208:211], v[24:27], v[52:55]
  ds_read_b128 v[20:23], v5 offset:27648
  s_waitcnt lgkmcnt(6)
  v_mfma_f32_16x16x32_bf16 v[56:59], a[40:43], v[28:31], v[56:59]
  v_mfma_f32_16x16x32_bf16 v[60:63], a[96:99], v[28:31], v[60:63]
  v_mfma_f32_16x16x32_bf16 v[64:67], a[152:155], v[28:31], v[64:67]
  v_mfma_f32_16x16x32_bf16 v[68:71], a[208:211], v[28:31], v[68:71]
  s_waitcnt lgkmcnt(5)
  v_mfma_f32_16x16x32_bf16 v[40:43], a[44:47], v[32:35], v[40:43]
  v_mfma_f32_16x16x32_bf16 v[44:47], a[100:103], v[32:35], v[44:47]
  v_mfma_f32_16x16x32_bf16 v[48:51], a[156:159], v[32:35], v[48:51]
  v_mfma_f32_16x16x32_bf16 v[52:55], a[212:215], v[32:35], v[52:55]
  s_waitcnt lgkmcnt(4)
  v_mfma_f32_16x16x32_bf16 v[56:59], a[44:47], v[36:39], v[56:59]
  v_mfma_f32_16x16x32_bf16 v[60:63], a[100:103], v[36:39], v[60:63]
  v_mfma_f32_16x16x32_bf16 v[64:67], a[156:159], v[36:39], v[64:67]
  v_mfma_f32_16x16x32_bf16 v[68:71], a[212:215], v[36:39], v[68:71]
  s_waitcnt lgkmcnt(3)
  v_mfma_f32_16x16x32_bf16 v[40:43], a[48:51], v[8:11], v[40:43]
  v_mfma_f32_16x16x32_bf16 v[44:47], a[104:107], v[8:11], v[44:47]
  v_mfma_f32_16x16x32_bf16 v[48:51], a[160:163], v[8:11], v[48:51]
  v_mfma_f32_16x16x32_bf16 v[52:55], a[216:219], v[8:11], v[52:55]
  s_waitcnt lgkmcnt(2)
  v_mfma_f32_16x16x32_bf16 v[56:59], a[48:51], v[12:15], v[56:59]
  v_mfma_f32_16x16x32_bf16 v[60:63], a[104:107], v[12:15], v[60:63]
  v_mfma_f32_16x16x32_bf16 v[64:67], a[160:163], v[12:15], v[64:67]
  v_mfma_f32_16x16x32_bf16 v[68:71], a[216:219], v[12:15], v[68:71]
  s_waitcnt lgkmcnt(1)
  v_mfma_f32_16x16x32_bf16 v[40:43], a[52:55], v[16:19], v[40:43]
  v_mfma_f32_16x16x32_bf16 v[44:47], a[108:111], v[16:19], v[44:47]
  v_mfma_f32_16x16x32_bf16 v[48:51], a[164:167], v[16:19], v[48:51]
  v_mfma_f32_16x16x32_bf16 v[52:55], a[220:223], v[16:19], v[52:55]
  s_waitcnt lgkmcnt(0)
  v_mfma_f32_16x16x32_bf16 v[56:59], a[52:55], v[20:23], v[56:59]
  v_mfma_f32_16x16x32_bf16 v[60:63], a[108:111], v[20:23], v[60:63]
  v_mfma_f32_16x16x32_bf16 v[64:67], a[164:167], v[20:23], v[64:67]
  v_mfma_f32_16x16x32_bf16 v[68:71], a[220:223], v[20:23], v[68:71]
  s_add_u32 s25, s29, 28672
  s_lshl_b32 s24, s19, 5
  s_add_u32 s24, s24, 0
  v_add_u32 v88, s24, v4
  v_mul_u32_u24 v89, 2341, v88
  v_lshrrev_b32 v89, 16, v89
  v_mul_u32_u24 v89, 84, v89
  v_add3_u32 v88, v88, v89, v6
  v_lshlrev_b32 v90, 4, v88
  v_cvt_pk_bf16_f32 v72, v40, v41
  v_cvt_pk_bf16_f32 v73, v42, v43
  v_cvt_pk_bf16_f32 v74, v44, v45
  v_cvt_pk_bf16_f32 v75, v46, v47
  buffer_store_dwordx4 v[72:75], v90, s[8:11], s29 offen sc1
  v_cvt_pk_bf16_f32 v76, v48, v49
  v_cvt_pk_bf16_f32 v77, v50, v51
  v_cvt_pk_bf16_f32 v78, v52, v53
  v_cvt_pk_bf16_f32 v79, v54, v55
  buffer_store_dwordx4 v[76:79], v90, s[8:11], s25 offen sc1
  s_lshl_b32 s24, s19, 5
  s_add_u32 s24, s24, 16
  v_add_u32 v88, s24, v4
  v_mul_u32_u24 v89, 2341, v88
  v_lshrrev_b32 v89, 16, v89
  v_mul_u32_u24 v89, 84, v89
  v_add3_u32 v88, v88, v89, v6
  v_lshlrev_b32 v91, 4, v88
  v_cvt_pk_bf16_f32 v80, v56, v57
  v_cvt_pk_bf16_f32 v81, v58, v59
  v_cvt_pk_bf16_f32 v82, v60, v61
  v_cvt_pk_bf16_f32 v83, v62, v63
  buffer_store_dwordx4 v[80:83], v91, s[8:11], s29 offen sc1
  v_cvt_pk_bf16_f32 v84, v64, v65
  v_cvt_pk_bf16_f32 v85, v66, v67
  v_cvt_pk_bf16_f32 v86, v68, v69
  v_cvt_pk_bf16_f32 v87, v70, v71
  buffer_store_dwordx4 v[84:87], v91, s[8:11], s25 offen sc1
  s_mov_b32 s33, s32
  s_add_u32 s32, s32, 28672
  s_cmp_eq_u32 s32, 86016
  s_cselect_b32 s32, 0, s32
  s_add_u32 s19, s19, 1
  s_cmp_lt_u32 s19, s35
  s_cbranch_scc1 wg_vo_loop
  s_branch wg_done
wg_done:
  s_lshl_b32 s20, s18, 4
  s_and_b32 s21, s17, 15
  s_add_u32 s20, s20, s21
  s_lshl_b32 s20, s20, 7
  s_cmp_lt_u32 s17, 16
  s_cselect_b32 s21, 16384, 0
  s_add_u32 s20, s20, s21
  s_add_u32 s20, s20, 88528896
  s_sub_u32 s21, s35, s34
  v_mov_b32 v5, s21
  v_mov_b32 v6, 0
  s_waitcnt vmcnt(0)
  s_mov_b64 exec, 1
  buffer_atomic_add v5, v6, s[8:11], s20 offen
  s_mov_b64 exec, -1
  s_branch wk_loop
wk_a:
  s_load_dwordx8 s[36:43], s[0:1], 56
  s_load_dwordx4 s[44:47], s[0:1], 88
  s_sub_u32 s3, s3, 368
  s_and_b32 s17, s3, 15
  s_lshr_b32 s19, s3, 5
  s_bitcmp1_b32 s3, 4
  s_cselect_b32 s31, 7, 0
  s_waitcnt lgkmcnt(0)
  s_mov_b32 s60, s40
  s_and_b32 s61, s41, 0xffff
  s_mov_b32 s62, 3670016
  s_mov_b32 s63, 0x20000
  s_mov_b32 s56, s42
  s_and_b32 s57, s43, 0xffff
  s_mov_b32 s58, 3670016
  s_mov_b32 s59, 0x20000
  s_lshl_b32 s30, s16, 13
  s_lshl_b32 s27, s19, 19
  s_lshl_b32 s29, s16, 17
  s_add_u32 s27, s27, s29
  s_lshl_b32 s29, s17, 9
  s_add_u32 s27, s27, s29
  v_lshrrev_b32 v5, 5, v1
  v_and_b32 v6, 31, v1
  v_xor_b32 v6, v6, v5
  v_lshlrev_b32 v6, 4, v6
  v_lshl_add_u32 v6, v5, 13, v6
  s_add_u32 m0, s30, 0
  s_add_u32 s22, s27, 0
  v_xor_b32 v7, 0, v6
  buffer_load_dwordx4 v7, s[56:59], s22 offen offset:0 lds
  s_add_u32 s22, s27, 15360
  v_xor_b32 v7, 32, v6
  buffer_load_dwordx4 v7, s[56:59], s22 offen offset:1024 lds
  s_add_u32 s22, s27, 30720
  v_xor_b32 v7, 64, v6
  buffer_load_dwordx4 v7, s[56:59], s22 offen offset:2048 lds
  s_add_u32 s22, s27, 46080
  v_xor_b32 v7, 96, v6
  buffer_load_dwordx4 v7, s[56:59], s22 offen offset:3072 lds
  s_add_u32 m0, s30, 4096
  s_add_u32 s22, s27, 65536
  v_xor_b32 v7, 128, v6
  buffer_load_dwordx4 v7, s[56:59], s22 offen offset:0 lds
  s_add_u32 s22, s27, 80896
  v_xor_b32 v7, 160, v6
  buffer_load_dwordx4 v7, s[56:59], s22 offen offset:1024 lds
  s_add_u32 s22, s27, 96256
  v_xor_b32 v7, 192, v6
  buffer_load_dwordx4 v7, s[56:59], s22 offen offset:2048 lds
  s_add_u32 s22, s27, 111616
  v_xor_b32 v7, 224, v6
  buffer_load_dwordx4 v7, s[56:59], s22 offen offset:3072 lds
  v_lshrrev_b32 v5, 5, v1
  v_and_b32 v6, 31, v1
  s_lshl_b32 s25, s16, 15
  s_add_u32 s25, s25, 32768
  s_lshl_b32 s26, s17, 9
  s_add_u32 s28, s19, s16
  s_cmp_ge_u32 s28, 7
  s_cselect_b32 s20, 7, 0
  s_sub_u32 s28, s28, s20
  s_add_u32 s28, s28, s31
  s_add_u32 s29, s19, s16
  s_add_u32 s29, s29, 4
  s_cmp_ge_u32 s29, 7
  s_cselect_b32 s20, 7, 0
  s_sub_u32 s29, s29, s20
  s_add_u32 s29, s29, s31
  s_lshl_b32 s32, s28, 18
  s_add_u32 s32, s32, s26
  s_lshl_b32 s33, s29, 18
  s_add_u32 s33, s33, s26
  v_xor_b32 v8, v6, v5
  v_lshlrev_b32 v8, 4, v8
  v_lshl_add_u32 v8, v5, 13, v8
  v_xor_b32 v12, 0, v8
  v_xor_b32 v13, 32, v8
  v_add_u32 v13, 15360, v13
  v_xor_b32 v14, 0, v8
  v_add_u32 v14, 30720, v14
  v_xor_b32 v15, 32, v8
  v_add_u32 v15, 46080, v15
  s_add_u32 s20, s16, 0
  s_and_b32 s20, s20, 3
  s_mul_i32 s21, s20, 65600
  s_lshl_b32 s20, s20, 12
  s_add_u32 s48, s20, s25
  s_mov_b32 m0, s48
  v_xor_b32 v16, s21, v12
  buffer_load_dwordx4 v16, s[60:63], s32 offen offset:0 lds
  v_xor_b32 v17, s21, v13
  buffer_load_dwordx4 v17, s[60:63], s32 offen offset:1024 lds
  v_xor_b32 v18, s21, v14
  buffer_load_dwordx4 v18, s[60:63], s32 offen offset:2048 lds
  v_xor_b32 v19, s21, v15
  buffer_load_dwordx4 v19, s[60:63], s32 offen offset:3072 lds
  s_add_u32 s20, s16, 1
  s_and_b32 s20, s20, 3
  s_mul_i32 s21, s20, 65600
  s_lshl_b32 s20, s20, 12
  s_add_u32 s49, s20, s25
  s_mov_b32 m0, s49
  v_xor_b32 v20, s21, v12
  buffer_load_dwordx4 v20, s[60:63], s32 offen offset:0 lds
  v_xor_b32 v21, s21, v13
  buffer_load_dwordx4 v21, s[60:63], s32 offen offset:1024 lds
  v_xor_b32 v22, s21, v14
  buffer_load_dwordx4 v22, s[60:63], s32 offen offset:2048 lds
  v_xor_b32 v23, s21, v15
  buffer_load_dwordx4 v23, s[60:63], s32 offen offset:3072 lds
  s_add_u32 s20, s16, 2
  s_and_b32 s20, s20, 3
  s_mul_i32 s21, s20, 65600
  s_lshl_b32 s20, s20, 12
  s_add_u32 s50, s20, s25
  s_mov_b32 m0, s50
  v_xor_b32 v24, s21, v12
  buffer_load_dwordx4 v24, s[60:63], s32 offen offset:0 lds
  v_xor_b32 v25, s21, v13
  buffer_load_dwordx4 v25, s[60:63], s32 offen offset:1024 lds
  v_xor_b32 v26, s21, v14
  buffer_load_dwordx4 v26, s[60:63], s32 offen offset:2048 lds
  v_xor_b32 v27, s21, v15
  buffer_load_dwordx4 v27, s[60:63], s32 offen offset:3072 lds
  s_add_u32 s20, s16, 3
  s_and_b32 s20, s20, 3
  s_mul_i32 s21, s20, 65600
  s_lshl_b32 s20, s20, 12
  s_add_u32 s51, s20, s25
  s_mov_b32 m0, s51
  v_xor_b32 v28, s21, v12
  buffer_load_dwordx4 v28, s[60:63], s32 offen offset:0 lds
  v_xor_b32 v29, s21, v13
  buffer_load_dwordx4 v29, s[60:63], s32 offen offset:1024 lds
  v_xor_b32 v30, s21, v14
  buffer_load_dwordx4 v30, s[60:63], s32 offen offset:2048 lds
  v_xor_b32 v31, s21, v15
  buffer_load_dwordx4 v31, s[60:63], s32 offen offset:3072 lds
  s_cmp_eq_u32 s16, 3
  s_cbranch_scc1 aj_np1
  s_add_u32 m0, s48, 16384
  s_nop 0
  buffer_load_dwordx4 v16, s[60:63], s33 offen offset:0 lds
  buffer_load_dwordx4 v17, s[60:63], s33 offen offset:1024 lds
  buffer_load_dwordx4 v18, s[60:63], s33 offen offset:2048 lds
  buffer_load_dwordx4 v19, s[60:63], s33 offen offset:3072 lds
  s_add_u32 m0, s49, 16384
  s_nop 0
  buffer_load_dwordx4 v20, s[60:63], s33 offen offset:0 lds
  buffer_load_dwordx4 v21, s[60:63], s33 offen offset:1024 lds
  buffer_load_dwordx4 v22, s[60:63], s33 offen offset:2048 lds
  buffer_load_dwordx4 v23, s[60:63], s33 offen offset:3072 lds
  s_add_u32 m0, s50, 16384
  s_nop 0
  buffer_load_dwordx4 v24, s[60:63], s33 offen offset:0 lds
  buffer_load_dwordx4 v25, s[60:63], s33 offen offset:1024 lds
  buffer_load_dwordx4 v26, s[60:63], s33 offen offset:2048 lds
  buffer_load_dwordx4 v27, s[60:63], s33 offen offset:3072 lds
  s_add_u32 m0, s51, 16384
  s_nop 0
  buffer_load_dwordx4 v28, s[60:63], s33 offen offset:0 lds
  buffer_load_dwordx4 v29, s[60:63], s33 offen offset:1024 lds
  buffer_load_dwordx4 v30, s[60:63], s33 offen offset:2048 lds
  buffer_load_dwordx4 v31, s[60:63], s33 offen offset:3072 lds
aj_np1:
  s_mov_b32 s79, 0
aj_run:
  s_mul_i32 s30, s17, 401408
  s_mul_i32 s20, s19, 57344
  s_add_u32 s30, s30, s20
  v_add_u32 v12, s30, v2
  v_add_u32 v13, 14336, v12
  v_add_u32 v14, 28672, v12
  v_add_u32 v15, 43008, v12
  v_lshrrev_b32 v7, 2, v4
  v_lshlrev_b32 v7, 3, v7
  v_and_b32 v8, 3, v4
  v_add_u32 v7, v7, v8
  v_xor_b32 v10, v3, v4
  v_lshlrev_b32 v10, 4, v10
  v_lshl_add_u32 v10, v7, 9, v10
  v_add_u32 v10, s25, v10
  v_xor_b32 v32, 0, v10
  v_xor_b32 v33, 64, v10
  v_xor_b32 v34, 128, v10
  v_xor_b32 v35, 192, v10
  v_and_b32 v8, 2, v4
  v_lshlrev_b32 v8, 1, v8
  v_and_b32 v9, 1, v4
  v_add_u32 v8, v8, v9
  v_lshrrev_b32 v7, 2, v4
  v_lshl_add_u32 v7, v7, 4, v8
  v_xor_b32 v8, v8, v3
  v_lshlrev_b32 v8, 4, v8
  v_lshl_add_u32 v7, v7, 9, v8
  s_mov_b32 s24, 1035512379
  s_waitcnt vmcnt(32)
  s_cmp_lg_u32 s16, 3
  s_cbranch_scc1 w3_35
  s_waitcnt vmcnt(16)
w3_35:
  s_barrier
  v_xor_b32 v8, 0, v7
  ds_read_b128 v[128:131], v8 offset:0
  v_xor_b32 v9, 64, v7
  ds_read_b128 v[132:135], v9 offset:0
  v_xor_b32 v10, 128, v7
  ds_read_b128 v[136:139], v10 offset:0
  v_xor_b32 v11, 192, v7
  ds_read_b128 v[140:143], v11 offset:0
  ds_read_b128 v[144:147], v8 offset:256
  ds_read_b128 v[148:151], v9 offset:256
  ds_read_b128 v[152:155], v10 offset:256
  ds_read_b128 v[156:159], v11 offset:256
  s_waitcnt lgkmcnt(4)
  v_xor_b32 v8, 32, v7
  ds_read_b128 v[160:163], v8 offset:1024
  v_xor_b32 v9, 96, v7
  ds_read_b128 v[164:167], v9 offset:1024
  v_xor_b32 v10, 160, v7
  ds_read_b128 v[168:171], v10 offset:1024
  v_xor_b32 v11, 224, v7
  ds_read_b128 v[172:175], v11 offset:1024
  ds_read_b128 v[176:179], v8 offset:1280
  ds_read_b128 v[180:183], v9 offset:1280
  ds_read_b128 v[184:187], v10 offset:1280
  ds_read_b128 v[188:191], v11 offset:1280
  s_waitcnt lgkmcnt(4)
  v_xor_b32 v8, 128, v7
  ds_read_b128 v[192:195], v8 offset:4096
  v_xor_b32 v9, 192, v7
  ds_read_b128 v[196:199], v9 offset:4096
  v_xor_b32 v10, 0, v7
  ds_read_b128 v[200:203], v10 offset:4096
  v_xor_b32 v11, 64, v7
  ds_read_b128 v[204:207], v11 offset:4096
  ds_read_b128 v[208:211], v8 offset:4352
  ds_read_b128 v[212:215], v9 offset:4352
  ds_read_b128 v[216:219], v10 offset:4352
  ds_read_b128 v[220:223], v11 offset:4352
  s_waitcnt lgkmcnt(4)
  v_xor_b32 v8, 160, v7
  ds_read_b128 v[224:227], v8 offset:5120
  v_xor_b32 v9, 224, v7
  ds_read_b128 v[228:231], v9 offset:5120
  v_xor_b32 v10, 32, v7
  ds_read_b128 v[232:235], v10 offset:5120
  v_xor_b32 v11, 96, v7
  ds_read_b128 v[236:239], v11 offset:5120
  ds_read_b128 v[240:243], v8 offset:5376
  ds_read_b128 v[244:247], v9 offset:5376
  ds_read_b128 v[248:251], v10 offset:5376
  ds_read_b128 v[252:255], v11 offset:5376
  s_waitcnt lgkmcnt(4)
  s_waitcnt vmcnt(16) lgkmcnt(0)
  s_cmp_lg_u32 s16, 3
  s_cbranch_scc1 w3_36
  s_waitcnt vmcnt(0)
w3_36:
  ds_read_b128 v[52:55], v32 offset:0
  ds_read_b128 v[56:59], v33 offset:0
  ds_read_b128 v[60:63], v34 offset:0
  ds_read_b128 v[64:67], v35 offset:0
  s_waitcnt lgkmcnt(3)
  v_mfma_f32_16x16x32_bf16 v[96:99], v[52:55], v[128:131], 0
  v_mfma_f32_16x16x32_bf16 v[100:103], v[52:55], v[160:163], 0
  v_mfma_f32_16x16x32_bf16 v[104:107], v[52:55], v[192:195], 0
  v_mfma_f32_16x16x32_bf16 v[108:111], v[52:55], v[224:227], 0
  ds_read_b128 v[52:55], v32 offset:256
  s_waitcnt lgkmcnt(3)
  v_mfma_f32_16x16x32_bf16 v[96:99], v[56:59], v[132:135], v[96:99]
  v_mfma_f32_16x16x32_bf16 v[100:103], v[56:59], v[164:167], v[100:103]
  v_mfma_f32_16x16x32_bf16 v[104:107], v[56:59], v[196:199], v[104:107]
  v_mfma_f32_16x16x32_bf16 v[108:111], v[56:59], v[228:231], v[108:111]
  ds_read_b128 v[56:59], v33 offset:256
  s_waitcnt lgkmcnt(3)
  v_mfma_f32_16x16x32_bf16 v[96:99], v[60:63], v[136:139], v[96:99]
  v_mfma_f32_16x16x32_bf16 v[100:103], v[60:63], v[168:171], v[100:103]
  v_mfma_f32_16x16x32_bf16 v[104:107], v[60:63], v[200:203], v[104:107]
  v_mfma_f32_16x16x32_bf16 v[108:111], v[60:63], v[232:235], v[108:111]
  ds_read_b128 v[60:63], v34 offset:256
  s_waitcnt lgkmcnt(3)
  v_mfma_f32_16x16x32_bf16 v[96:99], v[64:67], v[140:143], v[96:99]
  v_mfma_f32_16x16x32_bf16 v[100:103], v[64:67], v[172:175], v[100:103]
  v_mfma_f32_16x16x32_bf16 v[104:107], v[64:67], v[204:207], v[104:107]
  v_mfma_f32_16x16x32_bf16 v[108:111], v[64:67], v[236:239], v[108:111]
  ds_read_b128 v[64:67], v35 offset:256
  s_waitcnt lgkmcnt(3)
  v_mfma_f32_16x16x32_bf16 v[96:99], v[52:55], v[144:147], v[96:99]
  v_mfma_f32_16x16x32_bf16 v[100:103], v[52:55], v[176:179], v[100:103]
  v_mfma_f32_16x16x32_bf16 v[104:107], v[52:55], v[208:211], v[104:107]
  v_mfma_f32_16x16x32_bf16 v[108:111], v[52:55], v[240:243], v[108:111]
  ds_read_b128 v[52:55], v32 offset:2048
  s_waitcnt lgkmcnt(3)
  v_mfma_f32_16x16x32_bf16 v[96:99], v[56:59], v[148:151], v[96:99]
  v_mfma_f32_16x16x32_bf16 v[100:103], v[56:59], v[180:183], v[100:103]
  v_mfma_f32_16x16x32_bf16 v[104:107], v[56:59], v[212:215], v[104:107]
  v_mfma_f32_16x16x32_bf16 v[108:111], v[56:59], v[244:247], v[108:111]
  ds_read_b128 v[56:59], v33 offset:2048
  s_waitcnt lgkmcnt(3)
  v_mfma_f32_16x16x32_bf16 v[96:99], v[60:63], v[152:155], v[96:99]
  v_mfma_f32_16x16x32_bf16 v[100:103], v[60:63], v[184:187], v[100:103]
  v_mfma_f32_16x16x32_bf16 v[104:107], v[60:63], v[216:219], v[104:107]
  v_mfma_f32_16x16x32_bf16 v[108:111], v[60:63], v[248:251], v[108:111]
  ds_read_b128 v[60:63], v34 offset:2048
  s_waitcnt lgkmcnt(3)
  v_mfma_f32_16x16x32_bf16 v[96:99], v[64:67], v[156:159], v[96:99]
  v_mfma_f32_16x16x32_bf16 v[100:103], v[64:67], v[188:191], v[100:103]
  v_mfma_f32_16x16x32_bf16 v[104:107], v[64:67], v[220:223], v[104:107]
  v_mfma_f32_16x16x32_bf16 v[108:111], v[64:67], v[252:255], v[108:111]
  ds_read_b128 v[64:67], v35 offset:2048
  s_waitcnt lgkmcnt(3)
  v_mfma_f32_16x16x32_bf16 v[112:115], v[52:55], v[128:131], 0
  v_mfma_f32_16x16x32_bf16 v[116:119], v[52:55], v[160:163], 0
  v_mfma_f32_16x16x32_bf16 v[120:123], v[52:55], v[192:195], 0
  v_mfma_f32_16x16x32_bf16 v[124:127], v[52:55], v[224:227], 0
  ds_read_b128 v[52:55], v32 offset:2304
  s_waitcnt lgkmcnt(3)
  v_mfma_f32_16x16x32_bf16 v[112:115], v[56:59], v[132:135], v[112:115]
  v_mfma_f32_16x16x32_bf16 v[116:119], v[56:59], v[164:167], v[116:119]
  v_mfma_f32_16x16x32_bf16 v[120:123], v[56:59], v[196:199], v[120:123]
  v_mfma_f32_16x16x32_bf16 v[124:127], v[56:59], v[228:231], v[124:127]
  ds_read_b128 v[56:59], v33 offset:2304
  s_waitcnt lgkmcnt(3)
  v_mfma_f32_16x16x32_bf16 v[112:115], v[60:63], v[136:139], v[112:115]
  v_mfma_f32_16x16x32_bf16 v[116:119], v[60:63], v[168:171], v[116:119]
  v_mfma_f32_16x16x32_bf16 v[120:123], v[60:63], v[200:203], v[120:123]
  v_mfma_f32_16x16x32_bf16 v[124:127], v[60:63], v[232:235], v[124:127]
  ds_read_b128 v[60:63], v34 offset:2304
  s_waitcnt lgkmcnt(3)
  v_mfma_f32_16x16x32_bf16 v[112:115], v[64:67], v[140:143], v[112:115]
  v_mfma_f32_16x16x32_bf16 v[116:119], v[64:67], v[172:175], v[116:119]
  v_mfma_f32_16x16x32_bf16 v[120:123], v[64:67], v[204:207], v[120:123]
  v_mfma_f32_16x16x32_bf16 v[124:127], v[64:67], v[236:239], v[124:127]
  ds_read_b128 v[64:67], v35 offset:2304
  s_waitcnt lgkmcnt(3)
  v_mfma_f32_16x16x32_bf16 v[112:115], v[52:55], v[144:147], v[112:115]
  v_mfma_f32_16x16x32_bf16 v[116:119], v[52:55], v[176:179], v[116:119]
  v_mfma_f32_16x16x32_bf16 v[120:123], v[52:55], v[208:211], v[120:123]
  v_mfma_f32_16x16x32_bf16 v[124:127], v[52:55], v[240:243], v[124:127]
  s_waitcnt lgkmcnt(2)
  v_mfma_f32_16x16x32_bf16 v[112:115], v[56:59], v[148:151], v[112:115]
  v_mfma_f32_16x16x32_bf16 v[116:119], v[56:59], v[180:183], v[116:119]
  v_mfma_f32_16x16x32_bf16 v[120:123], v[56:59], v[212:215], v[120:123]
  v_mfma_f32_16x16x32_bf16 v[124:127], v[56:59], v[244:247], v[124:127]
  s_waitcnt lgkmcnt(1)
  v_mfma_f32_16x16x32_bf16 v[112:115], v[60:63], v[152:155], v[112:115]
  v_mfma_f32_16x16x32_bf16 v[116:119], v[60:63], v[184:187], v[116:119]
  v_mfma_f32_16x16x32_bf16 v[120:123], v[60:63], v[216:219], v[120:123]
  v_mfma_f32_16x16x32_bf16 v[124:127], v[60:63], v[248:251], v[124:127]
  s_waitcnt lgkmcnt(0)
  v_mfma_f32_16x16x32_bf16 v[112:115], v[64:67], v[156:159], v[112:115]
  v_mfma_f32_16x16x32_bf16 v[116:119], v[64:67], v[188:191], v[116:119]
  v_mfma_f32_16x16x32_bf16 v[120:123], v[64:67], v[220:223], v[120:123]
  v_mfma_f32_16x16x32_bf16 v[124:127], v[64:67], v[252:255], v[124:127]
  s_lshl_b32 s30, s28, 10
  v_mul_f32 v96, s24, v96
  v_mul_f32 v97, s24, v97
  v_mul_f32 v98, s24, v98
  v_mul_f32 v99, s24, v99
  v_cvt_pk_bf16_f32 v68, v96, v97
  v_cvt_pk_bf16_f32 v69, v98, v99
  v_mul_f32 v112, s24, v112
  v_mul_f32 v113, s24, v113
  v_mul_f32 v114, s24, v114
  v_mul_f32 v115, s24, v115
  v_cvt_pk_bf16_f32 v70, v112, v113
  v_cvt_pk_bf16_f32 v71, v114, v115
  buffer_store_dwordx4 v[68:71], v12, s[8:11], s30 offen sc1
  v_mul_f32 v100, s24, v100
  v_mul_f32 v101, s24, v101
  v_mul_f32 v102, s24, v102
  v_mul_f32 v103, s24, v103
  v_cvt_pk_bf16_f32 v72, v100, v101
  v_cvt_pk_bf16_f32 v73, v102, v103
  v_mul_f32 v116, s24, v116
  v_mul_f32 v117, s24, v117
  v_mul_f32 v118, s24, v118
  v_mul_f32 v119, s24, v119
  v_cvt_pk_bf16_f32 v74, v116, v117
  v_cvt_pk_bf16_f32 v75, v118, v119
  buffer_store_dwordx4 v[72:75], v13, s[8:11], s30 offen sc1
  v_mul_f32 v104, s24, v104
  v_mul_f32 v105, s24, v105
  v_mul_f32 v106, s24, v106
  v_mul_f32 v107, s24, v107
  v_cvt_pk_bf16_f32 v76, v104, v105
  v_cvt_pk_bf16_f32 v77, v106, v107
  v_mul_f32 v120, s24, v120
  v_mul_f32 v121, s24, v121
  v_mul_f32 v122, s24, v122
  v_mul_f32 v123, s24, v123
  v_cvt_pk_bf16_f32 v78, v120, v121
  v_cvt_pk_bf16_f32 v79, v122, v123
  buffer_store_dwordx4 v[76:79], v14, s[8:11], s30 offen sc1
  v_mul_f32 v108, s24, v108
  v_mul_f32 v109, s24, v109
  v_mul_f32 v110, s24, v110
  v_mul_f32 v111, s24, v111
  v_cvt_pk_bf16_f32 v80, v108, v109
  v_cvt_pk_bf16_f32 v81, v110, v111
  v_mul_f32 v124, s24, v124
  v_mul_f32 v125, s24, v125
  v_mul_f32 v126, s24, v126
  v_mul_f32 v127, s24, v127
  v_cvt_pk_bf16_f32 v82, v124, v125
  v_cvt_pk_bf16_f32 v83, v126, v127
  buffer_store_dwordx4 v[80:83], v15, s[8:11], s30 offen sc1
  s_cmp_eq_u32 s16, 3
  s_cbranch_scc1 aj_w3
  s_waitcnt vmcnt(4)
  ds_read_b128 v[52:55], v32 offset:16384
  ds_read_b128 v[56:59], v33 offset:16384
  ds_read_b128 v[60:63], v34 offset:16384
  ds_read_b128 v[64:67], v35 offset:16384
  s_waitcnt lgkmcnt(3)
  v_mfma_f32_16x16x32_bf16 v[96:99], v[52:55], v[128:131], 0
  v_mfma_f32_16x16x32_bf16 v[100:103], v[52:55], v[160:163], 0
  v_mfma_f32_16x16x32_bf16 v[104:107], v[52:55], v[192:195], 0
  v_mfma_f32_16x16x32_bf16 v[108:111], v[52:55], v[224:227], 0
  ds_read_b128 v[52:55], v32 offset:16640
  s_waitcnt lgkmcnt(3)
  v_mfma_f32_16x16x32_bf16 v[96:99], v[56:59], v[132:135], v[96:99]
  v_mfma_f32_16x16x32_bf16 v[100:103], v[56:59], v[164:167], v[100:103]
  v_mfma_f32_16x16x32_bf16 v[104:107], v[56:59], v[196:199], v[104:107]
  v_mfma_f32_16x16x32_bf16 v[108:111], v[56:59], v[228:231], v[108:111]
  ds_read_b128 v[56:59], v33 offset:16640
  s_waitcnt lgkmcnt(3)
  v_mfma_f32_16x16x32_bf16 v[96:99], v[60:63], v[136:139], v[96:99]
  v_mfma_f32_16x16x32_bf16 v[100:103], v[60:63], v[168:171], v[100:103]
  v_mfma_f32_16x16x32_bf16 v[104:107], v[60:63], v[200:203], v[104:107]
  v_mfma_f32_16x16x32_bf16 v[108:111], v[60:63], v[232:235], v[108:111]
  ds_read_b128 v[60:63], v34 offset:16640
  s_waitcnt lgkmcnt(3)
  v_mfma_f32_16x16x32_bf16 v[96:99], v[64:67], v[140:143], v[96:99]
  v_mfma_f32_16x16x32_bf16 v[100:103], v[64:67], v[172:175], v[100:103]
  v_mfma_f32_16x16x32_bf16 v[104:107], v[64:67], v[204:207], v[104:107]
  v_mfma_f32_16x16x32_bf16 v[108:111], v[64:67], v[236:239], v[108:111]
  ds_read_b128 v[64:67], v35 offset:16640
  s_waitcnt lgkmcnt(3)
  v_mfma_f32_16x16x32_bf16 v[96:99], v[52:55], v[144:147], v[96:99]
  v_mfma_f32_16x16x32_bf16 v[100:103], v[52:55], v[176:179], v[100:103]
  v_mfma_f32_16x16x32_bf16 v[104:107], v[52:55], v[208:211], v[104:107]
  v_mfma_f32_16x16x32_bf16 v[108:111], v[52:55], v[240:243], v[108:111]
  ds_read_b128 v[52:55], v32 offset:18432
  s_waitcnt lgkmcnt(3)
  v_mfma_f32_16x16x32_bf16 v[96:99], v[56:59], v[148:151], v[96:99]
  v_mfma_f32_16x16x32_bf16 v[100:103], v[56:59], v[180:183], v[100:103]
  v_mfma_f32_16x16x32_bf16 v[104:107], v[56:59], v[212:215], v[104:107]
  v_mfma_f32_16x16x32_bf16 v[108:111], v[56:59], v[244:247], v[108:111]
  ds_read_b128 v[56:59], v33 offset:18432
  s_waitcnt lgkmcnt(3)
  v_mfma_f32_16x16x32_bf16 v[96:99], v[60:63], v[152:155], v[96:99]
  v_mfma_f32_16x16x32_bf16 v[100:103], v[60:63], v[184:187], v[100:103]
  v_mfma_f32_16x16x32_bf16 v[104:107], v[60:63], v[216:219], v[104:107]
  v_mfma_f32_16x16x32_bf16 v[108:111], v[60:63], v[248:251], v[108:111]
  ds_read_b128 v[60:63], v34 offset:18432
  s_waitcnt lgkmcnt(3)
  v_mfma_f32_16x16x32_bf16 v[96:99], v[64:67], v[156:159], v[96:99]
  v_mfma_f32_16x16x32_bf16 v[100:103], v[64:67], v[188:191], v[100:103]
  v_mfma_f32_16x16x32_bf16 v[104:107], v[64:67], v[220:223], v[104:107]
  v_mfma_f32_16x16x32_bf16 v[108:111], v[64:67], v[252:255], v[108:111]
  ds_read_b128 v[64:67], v35 offset:18432
  s_waitcnt lgkmcnt(3)
  v_mfma_f32_16x16x32_bf16 v[112:115], v[52:55], v[128:131], 0
  v_mfma_f32_16x16x32_bf16 v[116:119], v[52:55], v[160:163], 0
  v_mfma_f32_16x16x32_bf16 v[120:123], v[52:55], v[192:195], 0
  v_mfma_f32_16x16x32_bf16 v[124:127], v[52:55], v[224:227], 0
  ds_read_b128 v[52:55], v32 offset:18688
  s_waitcnt lgkmcnt(3)
  v_mfma_f32_16x16x32_bf16 v[112:115], v[56:59], v[132:135], v[112:115]
  v_mfma_f32_16x16x32_bf16 v[116:119], v[56:59], v[164:167], v[116:119]
  v_mfma_f32_16x16x32_bf16 v[120:123], v[56:59], v[196:199], v[120:123]
  v_mfma_f32_16x16x32_bf16 v[124:127], v[56:59], v[228:231], v[124:127]
  ds_read_b128 v[56:59], v33 offset:18688
  s_waitcnt lgkmcnt(3)
  v_mfma_f32_16x16x32_bf16 v[112:115], v[60:63], v[136:139], v[112:115]
  v_mfma_f32_16x16x32_bf16 v[116:119], v[60:63], v[168:171], v[116:119]
  v_mfma_f32_16x16x32_bf16 v[120:123], v[60:63], v[200:203], v[120:123]
  v_mfma_f32_16x16x32_bf16 v[124:127], v[60:63], v[232:235], v[124:127]
  ds_read_b128 v[60:63], v34 offset:18688
  s_waitcnt lgkmcnt(3)
  v_mfma_f32_16x16x32_bf16 v[112:115], v[64:67], v[140:143], v[112:115]
  v_mfma_f32_16x16x32_bf16 v[116:119], v[64:67], v[172:175], v[116:119]
  v_mfma_f32_16x16x32_bf16 v[120:123], v[64:67], v[204:207], v[120:123]
  v_mfma_f32_16x16x32_bf16 v[124:127], v[64:67], v[236:239], v[124:127]
  ds_read_b128 v[64:67], v35 offset:18688
  s_waitcnt lgkmcnt(3)
  v_mfma_f32_16x16x32_bf16 v[112:115], v[52:55], v[144:147], v[112:115]
  v_mfma_f32_16x16x32_bf16 v[116:119], v[52:55], v[176:179], v[116:119]
  v_mfma_f32_16x16x32_bf16 v[120:123], v[52:55], v[208:211], v[120:123]
  v_mfma_f32_16x16x32_bf16 v[124:127], v[52:55], v[240:243], v[124:127]
  s_waitcnt lgkmcnt(2)
  v_mfma_f32_16x16x32_bf16 v[112:115], v[56:59], v[148:151], v[112:115]
  v_mfma_f32_16x16x32_bf16 v[116:119], v[56:59], v[180:183], v[116:119]
  v_mfma_f32_16x16x32_bf16 v[120:123], v[56:59], v[212:215], v[120:123]
  v_mfma_f32_16x16x32_bf16 v[124:127], v[56:59], v[244:247], v[124:127]
  s_waitcnt lgkmcnt(1)
  v_mfma_f32_16x16x32_bf16 v[112:115], v[60:63], v[152:155], v[112:115]
  v_mfma_f32_16x16x32_bf16 v[116:119], v[60:63], v[184:187], v[116:119]
  v_mfma_f32_16x16x32_bf16 v[120:123], v[60:63], v[216:219], v[120:123]
  v_mfma_f32_16x16x32_bf16 v[124:127], v[60:63], v[248:251], v[124:127]
  s_waitcnt lgkmcnt(0)
  v_mfma_f32_16x16x32_bf16 v[112:115], v[64:67], v[156:159], v[112:115]
  v_mfma_f32_16x16x32_bf16 v[116:119], v[64:67], v[188:191], v[116:119]
  v_mfma_f32_16x16x32_bf16 v[120:123], v[64:67], v[220:223], v[120:123]
  v_mfma_f32_16x16x32_bf16 v[124:127], v[64:67], v[252:255], v[124:127]
  s_lshl_b32 s30, s29, 10
  v_mul_f32 v96, s24, v96
  v_mul_f32 v97, s24, v97
  v_mul_f32 v98, s24, v98
  v_mul_f32 v99, s24, v99
  v_cvt_pk_bf16_f32 v68, v96, v97
  v_cvt_pk_bf16_f32 v69, v98, v99
  v_mul_f32 v112, s24, v112
  v_mul_f32 v113, s24, v113
  v_mul_f32 v114, s24, v114
  v_mul_f32 v115, s24, v115
  v_cvt_pk_bf16_f32 v70, v112, v113
  v_cvt_pk_bf16_f32 v71, v114, v115
  buffer_store_dwordx4 v[68:71], v12, s[8:11], s30 offen sc1
  v_mul_f32 v100, s24, v100
  v_mul_f32 v101, s24, v101
  v_mul_f32 v102, s24, v102
  v_mul_f32 v103, s24, v103
  v_cvt_pk_bf16_f32 v72, v100, v101
  v_cvt_pk_bf16_f32 v73, v102, v103
  v_mul_f32 v116, s24, v116
  v_mul_f32 v117, s24, v117
  v_mul_f32 v118, s24, v118
  v_mul_f32 v119, s24, v119
  v_cvt_pk_bf16_f32 v74, v116, v117
  v_cvt_pk_bf16_f32 v75, v118, v119
  buffer_store_dwordx4 v[72:75], v13, s[8:11], s30 offen sc1
  v_mul_f32 v104, s24, v104
  v_mul_f32 v105, s24, v105
  v_mul_f32 v106, s24, v106
  v_mul_f32 v107, s24, v107
  v_cvt_pk_bf16_f32 v76, v104, v105
  v_cvt_pk_bf16_f32 v77, v106, v107
  v_mul_f32 v120, s24, v120
  v_mul_f32 v121, s24, v121
  v_mul_f32 v122, s24, v122
  v_mul_f32 v123, s24, v123
  v_cvt_pk_bf16_f32 v78, v120, v121
  v_cvt_pk_bf16_f32 v79, v122, v123
  buffer_store_dwordx4 v[76:79], v14, s[8:11], s30 offen sc1
  v_mul_f32 v108, s24, v108
  v_mul_f32 v109, s24, v109
  v_mul_f32 v110, s24, v110
  v_mul_f32 v111, s24, v111
  v_cvt_pk_bf16_f32 v80, v108, v109
  v_cvt_pk_bf16_f32 v81, v110, v111
  v_mul_f32 v124, s24, v124
  v_mul_f32 v125, s24, v125
  v_mul_f32 v126, s24, v126
  v_mul_f32 v127, s24, v127
  v_cvt_pk_bf16_f32 v82, v124, v125
  v_cvt_pk_bf16_f32 v83, v126, v127
  buffer_store_dwordx4 v[80:83], v15, s[8:11], s30 offen sc1
aj_w3:
  s_lshl_b32 s28, s17, 7
  s_lshl_b32 s21, s19, 4
  s_add_u32 s28, s28, s21
  s_cmp_lg_u32 s31, 0
  s_cselect_b32 s21, 8, 0
  s_add_u32 s28, s28, s21
  s_add_u32 s28, s28, 88621056
  s_waitcnt vmcnt(0)
  s_barrier
  s_cmp_lg_u32 s16, 0
  s_cbranch_scc1 pub_37
  v_mul_u32_u24 v26, 2048, v1
  v_mov_b32 v24, s88
  v_mov_b32 v25, s89
  s_mov_b64 exec, 1
  buffer_store_dwordx2 v[24:25], v26, s[8:11], s28 offen sc1
  s_mov_b64 exec, -1
pub_37:
  s_cmp_lg_u32 s79, 0
  s_cbranch_scc1 bj_end
  v_mov_b32 v250, 0
  s_branch wk_loop
wk_srv:
  s_sub_u32 s3, s3, 336
  s_and_b32 s18, s3, 15
  s_lshr_b32 s19, s3, 4
  s_and_b32 s19, s19, 1
  s_mul_i32 s20, s18, 401408
  s_mul_i32 s21, s16, 100352
  s_add_u32 s20, s20, s21
  s_add_u32 s20, s20, 6422528
  s_add_u32 s22, s20, 0
  buffer_load_dwordx4 a[0:3], v2, s[8:11], s22 offen offset:0 sc1
  buffer_load_dwordx4 a[4:7], v2, s[8:11], s22 offen offset:1024 sc1
  buffer_load_dwordx4 a[8:11], v2, s[8:11], s22 offen offset:2048 sc1
  buffer_load_dwordx4 a[12:15], v2, s[8:11], s22 offen offset:3072 sc1
  s_add_u32 s22, s20, 4096
  buffer_load_dwordx4 a[16:19], v2, s[8:11], s22 offen offset:0 sc1
  buffer_load_dwordx4 a[20:23], v2, s[8:11], s22 offen offset:1024 sc1
  buffer_load_dwordx4 a[24:27], v2, s[8:11], s22 offen offset:2048 sc1
  buffer_load_dwordx4 a[28:31], v2, s[8:11], s22 offen offset:3072 sc1
  s_add_u32 s22, s20, 8192
  buffer_load_dwordx4 a[32:35], v2, s[8:11], s22 offen offset:0 sc1
  buffer_load_dwordx4 a[36:39], v2, s[8:11], s22 offen offset:1024 sc1
  buffer_load_dwordx4 a[40:43], v2, s[8:11], s22 offen offset:2048 sc1
  buffer_load_dwordx4 a[44:47], v2, s[8:11], s22 offen offset:3072 sc1
  s_add_u32 s22, s20, 12288
  buffer_load_dwordx4 a[48:51], v2, s[8:11], s22 offen offset:0 sc1
  buffer_load_dwordx4 a[52:55], v2, s[8:11], s22 offen offset:1024 sc1
  buffer_load_dwordx4 a[56:59], v2, s[8:11], s22 offen offset:2048 sc1
  buffer_load_dwordx4 a[60:63], v2, s[8:11], s22 offen offset:3072 sc1
  s_add_u32 s22, s20, 16384
  buffer_load_dwordx4 a[64:67], v2, s[8:11], s22 offen offset:0 sc1
  buffer_load_dwordx4 a[68:71], v2, s[8:11], s22 offen offset:1024 sc1
  buffer_load_dwordx4 a[72:75], v2, s[8:11], s22 offen offset:2048 sc1
  buffer_load_dwordx4 a[76:79], v2, s[8:11], s22 offen offset:3072 sc1
  s_add_u32 s22, s20, 20480
  buffer_load_dwordx4 a[80:83], v2, s[8:11], s22 offen offset:0 sc1
  buffer_load_dwordx4 a[84:87], v2, s[8:11], s22 offen offset:1024 sc1
  buffer_load_dwordx4 a[88:91], v2, s[8:11], s22 offen offset:2048 sc1
  buffer_load_dwordx4 a[92:95], v2, s[8:11], s22 offen offset:3072 sc1
  s_add_u32 s22, s20, 24576
  buffer_load_dwordx4 a[96:99], v2, s[8:11], s22 offen offset:0 sc1
  buffer_load_dwordx4 a[100:103], v2, s[8:11], s22 offen offset:1024 sc1
  buffer_load_dwordx4 a[104:107], v2, s[8:11], s22 offen offset:2048 sc1
  buffer_load_dwordx4 a[108:111], v2, s[8:11], s22 offen offset:3072 sc1
  s_add_u32 s22, s20, 28672
  buffer_load_dwordx4 a[112:115], v2, s[8:11], s22 offen offset:0 sc1
  buffer_load_dwordx4 a[116:119], v2, s[8:11], s22 offen offset:1024 sc1
  buffer_load_dwordx4 a[120:123], v2, s[8:11], s22 offen offset:2048 sc1
  buffer_load_dwordx4 a[124:127], v2, s[8:11], s22 offen offset:3072 sc1
  s_waitcnt vmcnt(24)
  s_add_u32 s22, s20, 32768
  buffer_load_dwordx4 a[128:131], v2, s[8:11], s22 offen offset:0 sc1
  buffer_load_dwordx4 a[132:135], v2, s[8:11], s22 offen offset:1024 sc1
  buffer_load_dwordx4 a[136:139], v2, s[8:11], s22 offen offset:2048 sc1
  buffer_load_dwordx4 a[140:143], v2, s[8:11], s22 offen offset:3072 sc1
  s_add_u32 s22, s20, 36864
  buffer_load_dwordx4 a[144:147], v2, s[8:11], s22 offen offset:0 sc1
  buffer_load_dwordx4 a[148:151], v2, s[8:11], s22 offen offset:1024 sc1
  buffer_load_dwordx4 a[152:155], v2, s[8:11], s22 offen offset:2048 sc1
  buffer_load_dwordx4 a[156:159], v2, s[8:11], s22 offen offset:3072 sc1
  s_add_u32 s22, s20, 40960
  buffer_load_dwordx4 a[160:163], v2, s[8:11], s22 offen offset:0 sc1
  buffer_load_dwordx4 a[164:167], v2, s[8:11], s22 offen offset:1024 sc1
  buffer_load_dwordx4 a[168:171], v2, s[8:11], s22 offen offset:2048 sc1
  buffer_load_dwordx4 a[172:175], v2, s[8:11], s22 offen offset:3072 sc1
  s_add_u32 s22, s20, 45056
  buffer_load_dwordx4 a[176:179], v2, s[8:11], s22 offen offset:0 sc1
  buffer_load_dwordx4 a[180:183], v2, s[8:11], s22 offen offset:1024 sc1
  buffer_load_dwordx4 a[184:187], v2, s[8:11], s22 offen offset:2048 sc1
  buffer_load_dwordx4 a[188:191], v2, s[8:11], s22 offen offset:3072 sc1
  s_add_u32 s22, s20, 49152
  buffer_load_dwordx4 a[192:195], v2, s[8:11], s22 offen offset:0 sc1
  buffer_load_dwordx4 a[196:199], v2, s[8:11], s22 offen offset:1024 sc1
  buffer_load_dwordx4 a[200:203], v2, s[8:11], s22 offen offset:2048 sc1
  buffer_load_dwordx4 a[204:207], v2, s[8:11], s22 offen offset:3072 sc1
  s_add_u32 s22, s20, 53248
  buffer_load_dwordx4 a[208:211], v2, s[8:11], s22 offen offset:0 sc1
  buffer_load_dwordx4 a[212:215], v2, s[8:11], s22 offen offset:1024 sc1
  buffer_load_dwordx4 a[216:219], v2, s[8:11], s22 offen offset:2048 sc1
  buffer_load_dwordx4 a[220:223], v2, s[8:11], s22 offen offset:3072 sc1
  s_add_u32 s22, s20, 57344
  buffer_load_dwordx4 a[224:227], v2, s[8:11], s22 offen offset:0 sc1
  buffer_load_dwordx4 a[228:231], v2, s[8:11], s22 offen offset:1024 sc1
  buffer_load_dwordx4 a[232:235], v2, s[8:11], s22 offen offset:2048 sc1
  buffer_load_dwordx4 a[236:239], v2, s[8:11], s22 offen offset:3072 sc1
  s_add_u32 s22, s20, 61440
  buffer_load_dwordx4 a[240:243], v2, s[8:11], s22 offen offset:0 sc1
  buffer_load_dwordx4 a[244:247], v2, s[8:11], s22 offen offset:1024 sc1
  buffer_load_dwordx4 a[248:251], v2, s[8:11], s22 offen offset:2048 sc1
  buffer_load_dwordx4 a[252:255], v2, s[8:11], s22 offen offset:3072 sc1
  s_waitcnt vmcnt(24)
  s_add_u32 s22, s20, 65536
  buffer_load_dwordx4 v[120:123], v2, s[8:11], s22 offen offset:0 sc1
  buffer_load_dwordx4 v[124:127], v2, s[8:11], s22 offen offset:1024 sc1
  buffer_load_dwordx4 v[128:131], v2, s[8:11], s22 offen offset:2048 sc1
  buffer_load_dwordx4 v[132:135], v2, s[8:11], s22 offen offset:3072 sc1
  s_add_u32 s22, s20, 69632
  buffer_load_dwordx4 v[136:139], v2, s[8:11], s22 offen offset:0 sc1
  buffer_load_dwordx4 v[140:143], v2, s[8:11], s22 offen offset:1024 sc1
  buffer_load_dwordx4 v[144:147], v2, s[8:11], s22 offen offset:2048 sc1
  buffer_load_dwordx4 v[148:151], v2, s[8:11], s22 offen offset:3072 sc1
  s_add_u32 s22, s20, 73728
  buffer_load_dwordx4 v[152:155], v2, s[8:11], s22 offen offset:0 sc1
  buffer_load_dwordx4 v[156:159], v2, s[8:11], s22 offen offset:1024 sc1
  buffer_load_dwordx4 v[160:163], v2, s[8:11], s22 offen offset:2048 sc1
  buffer_load_dwordx4 v[164:167], v2, s[8:11], s22 offen offset:3072 sc1
  s_add_u32 s22, s20, 77824
  buffer_load_dwordx4 v[168:171], v2, s[8:11], s22 offen offset:0 sc1
  buffer_load_dwordx4 v[172:175], v2, s[8:11], s22 offen offset:1024 sc1
  buffer_load_dwordx4 v[176:179], v2, s[8:11], s22 offen offset:2048 sc1
  buffer_load_dwordx4 v[180:183], v2, s[8:11], s22 offen offset:3072 sc1
  s_add_u32 s22, s20, 81920
  buffer_load_dwordx4 v[184:187], v2, s[8:11], s22 offen offset:0 sc1
  buffer_load_dwordx4 v[188:191], v2, s[8:11], s22 offen offset:1024 sc1
  buffer_load_dwordx4 v[192:195], v2, s[8:11], s22 offen offset:2048 sc1
  buffer_load_dwordx4 v[196:199], v2, s[8:11], s22 offen offset:3072 sc1
  s_add_u32 s22, s20, 86016
  buffer_load_dwordx4 v[200:203], v2, s[8:11], s22 offen offset:0 sc1
  buffer_load_dwordx4 v[204:207], v2, s[8:11], s22 offen offset:1024 sc1
  buffer_load_dwordx4 v[208:211], v2, s[8:11], s22 offen offset:2048 sc1
  buffer_load_dwordx4 v[212:215], v2, s[8:11], s22 offen offset:3072 sc1
  s_add_u32 s22, s20, 90112
  buffer_load_dwordx4 v[216:219], v2, s[8:11], s22 offen offset:0 sc1
  buffer_load_dwordx4 v[220:223], v2, s[8:11], s22 offen offset:1024 sc1
  buffer_load_dwordx4 v[224:227], v2, s[8:11], s22 offen offset:2048 sc1
  buffer_load_dwordx4 v[228:231], v2, s[8:11], s22 offen offset:3072 sc1
  s_add_u32 s22, s20, 94208
  buffer_load_dwordx4 v[232:235], v2, s[8:11], s22 offen offset:0 sc1
  buffer_load_dwordx4 v[236:239], v2, s[8:11], s22 offen offset:1024 sc1
  buffer_load_dwordx4 v[240:243], v2, s[8:11], s22 offen offset:2048 sc1
  buffer_load_dwordx4 v[244:247], v2, s[8:11], s22 offen offset:3072 sc1
  s_waitcnt vmcnt(24)
  s_add_u32 s22, s20, 98304
  buffer_load_dwordx4 v[248:251], v2, s[8:11], s22 offen offset:0 sc1
  buffer_load_dwordx4 v[252:255], v2, s[8:11], s22 offen offset:1024 sc1
  v_mov_b32 v5, 0x4444
  v_mov_b32 v6, 0xeeee
  v_cmp_lt_u32 vcc, 7, v4
  s_nop 1
  v_cndmask_b32 v5, v5, v6, vcc
  s_lshl_b32 s23, s16, 11
  v_lshrrev_b32 v80, 1, v3
  v_and_b32 v81, 1, v3
  v_add_u32 v82, 0, v80
  v_lshl_add_u32 v82, v82, 4, v4
  v_mul_u32_u24 v83, 2341, v82
  v_lshrrev_b32 v83, 16, v83
  v_mul_u32_u24 v84, 28, v83
  v_sub_u32 v84, v82, v84
  v_lshrrev_b32 v85, 4, v84
  v_and_b32 v84, 15, v84
  v_lshlrev_b32 v86, 10, v85
  v_lshl_add_u32 v86, v83, 8, v86
  v_lshl_add_u32 v86, v84, 4, v86
  v_lshl_add_u32 v86, v81, 3, v86
  v_add_u32 v72, s23, v86
  v_add_u32 v82, 2, v80
  v_lshl_add_u32 v82, v82, 4, v4
  v_mul_u32_u24 v83, 2341, v82
  v_lshrrev_b32 v83, 16, v83
  v_mul_u32_u24 v84, 28, v83
  v_sub_u32 v84, v82, v84
  v_lshrrev_b32 v85, 4, v84
  v_and_b32 v84, 15, v84
  v_lshlrev_b32 v86, 10, v85
  v_lshl_add_u32 v86, v83, 8, v86
  v_lshl_add_u32 v86, v84, 4, v86
  v_lshl_add_u32 v86, v81, 3, v86
  v_add_u32 v73, s23, v86
  v_add_u32 v82, 4, v80
  v_lshl_add_u32 v82, v82, 4, v4
  v_mul_u32_u24 v83, 2341, v82
  v_lshrrev_b32 v83, 16, v83
  v_mul_u32_u24 v84, 28, v83
  v_sub_u32 v84, v82, v84
  v_lshrrev_b32 v85, 4, v84
  v_and_b32 v84, 15, v84
  v_lshlrev_b32 v86, 10, v85
  v_lshl_add_u32 v86, v83, 8, v86
  v_lshl_add_u32 v86, v84, 4, v86
  v_lshl_add_u32 v86, v81, 3, v86
  v_add_u32 v74, s23, v86
  v_mov_b32 v82, 6
  v_lshl_add_u32 v82, v82, 4, v4
  v_mul_u32_u24 v83, 2341, v82
  v_lshrrev_b32 v83, 16, v83
  v_mul_u32_u24 v84, 28, v83
  v_sub_u32 v84, v82, v84
  v_lshrrev_b32 v85, 4, v84
  v_and_b32 v84, 15, v84
  v_lshlrev_b32 v86, 10, v85
  v_lshl_add_u32 v86, v83, 8, v86
  v_lshl_add_u32 v86, v84, 4, v86
  v_lshl_add_u32 v86, v81, 3, v86
  v_add_u32 v75, s23, v86
  v_add_u32 v76, s23, v2
  s_mul_i32 s27, s18, 448
  v_mov_b32 v77, s27
  v_mov_b32 v78, 1
  s_mov_b32 s17, s19
  s_mul_i32 s24, s19, 7168
  s_add_u32 s24, s24, 88068096
  s_mul_i32 s25, s18, 65
  s_add_u32 s25, s25, s19
  s_lshl_b32 s25, s25, 13
  s_add_u32 s25, s25, s23
  s_add_u32 s25, s25, 76935168
  s_lshl_b32 s26, s18, 6
  s_add_u32 s26, s26, s19
  s_lshl_b32 s26, s26, 4
  s_lshl_b32 s27, s16, 2
  s_add_u32 s26, s26, s27
  s_add_u32 s26, s26, 88569856
ws_loop:
  v_mov_b32 v36, 0
  v_mov_b32 v37, 0
  v_mov_b32 v38, 0
  v_mov_b32 v39, 0
  v_mov_b32 v40, 0
  v_mov_b32 v41, 0
  v_mov_b32 v42, 0
  v_mov_b32 v43, 0
  v_mov_b32 v44, 0
  v_mov_b32 v45, 0
  v_mov_b32 v46, 0
  v_mov_b32 v47, 0
  v_mov_b32 v48, 0
  v_mov_b32 v49, 0
  v_mov_b32 v50, 0
  v_mov_b32 v51, 0
  v_mov_b32 v52, 0
  v_mov_b32 v53, 0
  v_mov_b32 v54, 0
  v_mov_b32 v55, 0
  v_mov_b32 v56, 0
  v_mov_b32 v57, 0
  v_mov_b32 v58, 0
  v_mov_b32 v59, 0
  v_mov_b32 v60, 0
  v_mov_b32 v61, 0
  v_mov_b32 v62, 0
  v_mov_b32 v63, 0
  s_mov_b32 s30, 0
ws_pm:
  s_cmp_ge_u32 s17, 61
  s_cbranch_scc1 mp_38a
  v_mov_b32 v79, 0
  s_mov_b64 exec, 1
  buffer_atomic_or v79, v77, s[8:11], s24 offen sc0
  s_mov_b64 exec, -1
  s_branch mp_38b
mp_38a:
  buffer_load_dword v79, v77, s[8:11], s24 offen sc1
mp_38b:
  s_waitcnt vmcnt(0)
  v_cmp_eq_u32 vcc, -1, v79
  s_cbranch_vccnz ws_pr
ws_fl:
  s_add_u32 s22, s24, 4096
  buffer_load_dwordx4 v[8:11], v2, s[8:11], s24 offen offset:0 sc1
  buffer_load_dwordx4 v[12:15], v2, s[8:11], s24 offen offset:1024 sc1
  buffer_load_dwordx4 v[16:19], v2, s[8:11], s24 offen offset:2048 sc1
  buffer_load_dwordx4 v[20:23], v2, s[8:11], s24 offen offset:3072 sc1
  buffer_load_dwordx4 v[24:27], v2, s[8:11], s22 offen offset:0 sc1
  buffer_load_dwordx4 v[28:31], v2, s[8:11], s22 offen offset:1024 sc1
  buffer_load_dwordx4 v[32:35], v2, s[8:11], s22 offen offset:2048 sc1
  s_waitcnt vmcnt(0)
  v_max_u32 v79, v8, v9
  v_max3_u32 v79, v79, v10, v11
  v_max3_u32 v79, v79, v12, v13
  v_max3_u32 v79, v79, v14, v15
  v_max3_u32 v79, v79, v16, v17
  v_max3_u32 v79, v79, v18, v19
  v_max3_u32 v79, v79, v20, v21
  v_max3_u32 v79, v79, v22, v23
  v_max3_u32 v79, v79, v24, v25
  v_max3_u32 v79, v79, v26, v27
  v_max3_u32 v79, v79, v28, v29
  v_max3_u32 v79, v79, v30, v31
  v_max3_u32 v79, v79, v32, v33
  v_max3_u32 v79, v79, v34, v35
  v_cmp_eq_u32 vcc, -1, v79
  s_cbranch_vccz ws_pk
ws_pr:
  s_sleep 1
  s_cmp_ge_u32 s17, 61
  s_cbranch_scc1 ws_sh
  s_sleep 6
ws_sh:
  s_add_u32 s30, s30, 1
  s_cmp_lt_u32 s30, 30000
  s_cbranch_scc1 ws_pm
  s_branch cA_abort
ws_pk:
  v_smfmac_f32_16x16x64_bf16 v[36:39], v[8:11], a[0:7], v5
  v_smfmac_f32_16x16x64_bf16 v[36:39], v[12:15], a[8:15], v5
  v_smfmac_f32_16x16x64_bf16 v[36:39], v[16:19], a[16:23], v5
  v_smfmac_f32_16x16x64_bf16 v[36:39], v[20:23], a[24:31], v5
  v_smfmac_f32_16x16x64_bf16 v[36:39], v[24:27], a[32:39], v5
  v_smfmac_f32_16x16x64_bf16 v[36:39], v[28:31], a[40:47], v5
  v_smfmac_f32_16x16x64_bf16 v[36:39], v[32:35], a[48:55], v5
  v_smfmac_f32_16x16x64_bf16 v[40:43], v[8:11], a[56:63], v5
  v_smfmac_f32_16x16x64_bf16 v[40:43], v[12:15], a[64:71], v5
  v_smfmac_f32_16x16x64_bf16 v[40:43], v[16:19], a[72:79], v5
  v_smfmac_f32_16x16x64_bf16 v[40:43], v[20:23], a[80:87], v5
  v_smfmac_f32_16x16x64_bf16 v[40:43], v[24:27], a[88:95], v5
  v_smfmac_f32_16x16x64_bf16 v[40:43], v[28:31], a[96:103], v5
  v_smfmac_f32_16x16x64_bf16 v[40:43], v[32:35], a[104:111], v5
  v_smfmac_f32_16x16x64_bf16 v[44:47], v[8:11], a[112:119], v5
  v_smfmac_f32_16x16x64_bf16 v[44:47], v[12:15], a[120:127], v5
  v_smfmac_f32_16x16x64_bf16 v[44:47], v[16:19], a[128:135], v5
  v_smfmac_f32_16x16x64_bf16 v[44:47], v[20:23], a[136:143], v5
  v_smfmac_f32_16x16x64_bf16 v[44:47], v[24:27], a[144:151], v5
  v_smfmac_f32_16x16x64_bf16 v[44:47], v[28:31], a[152:159], v5
  v_smfmac_f32_16x16x64_bf16 v[44:47], v[32:35], a[160:167], v5
  v_smfmac_f32_16x16x64_bf16 v[48:51], v[8:11], a[168:175], v5
  v_smfmac_f32_16x16x64_bf16 v[48:51], v[12:15], a[176:183], v5
  v_smfmac_f32_16x16x64_bf16 v[48:51], v[16:19], a[184:191], v5
  v_smfmac_f32_16x16x64_bf16 v[48:51], v[20:23], a[192:199], v5
  v_smfmac_f32_16x16x64_bf16 v[48:51], v[24:27], a[200:207], v5
  v_smfmac_f32_16x16x64_bf16 v[48:51], v[28:31], a[208:215], v5
  v_smfmac_f32_16x16x64_bf16 v[48:51], v[32:35], a[216:223], v5
  v_smfmac_f32_16x16x64_bf16 v[52:55], v[8:11], a[224:231], v5
  v_smfmac_f32_16x16x64_bf16 v[52:55], v[12:15], a[232:239], v5
  v_smfmac_f32_16x16x64_bf16 v[52:55], v[16:19], a[240:247], v5
  v_smfmac_f32_16x16x64_bf16 v[52:55], v[20:23], a[248:255], v5
  v_smfmac_f32_16x16x64_bf16 v[52:55], v[24:27], v[120:127], v5
  v_smfmac_f32_16x16x64_bf16 v[52:55], v[28:31], v[128:135], v5
  v_smfmac_f32_16x16x64_bf16 v[52:55], v[32:35], v[136:143], v5
  v_smfmac_f32_16x16x64_bf16 v[56:59], v[8:11], v[144:151], v5
  v_smfmac_f32_16x16x64_bf16 v[56:59], v[12:15], v[152:159], v5
  v_smfmac_f32_16x16x64_bf16 v[56:59], v[16:19], v[160:167], v5
  v_smfmac_f32_16x16x64_bf16 v[56:59], v[20:23], v[168:175], v5
  v_smfmac_f32_16x16x64_bf16 v[56:59], v[24:27], v[176:183], v5
  v_smfmac_f32_16x16x64_bf16 v[56:59], v[28:31], v[184:191], v5
  v_smfmac_f32_16x16x64_bf16 v[56:59], v[32:35], v[192:199], v5
  v_smfmac_f32_16x16x64_bf16 v[60:63], v[8:11], v[200:207], v5
  v_smfmac_f32_16x16x64_bf16 v[60:63], v[12:15], v[208:215], v5
  v_smfmac_f32_16x16x64_bf16 v[60:63], v[16:19], v[216:223], v5
  v_smfmac_f32_16x16x64_bf16 v[60:63], v[20:23], v[224:231], v5
  v_smfmac_f32_16x16x64_bf16 v[60:63], v[24:27], v[232:239], v5
  v_smfmac_f32_16x16x64_bf16 v[60:63], v[28:31], v[240:247], v5
  v_smfmac_f32_16x16x64_bf16 v[60:63], v[32:35], v[248:255], v5
  v_permlane32_swap_b32 v36, v40
  v_permlane32_swap_b32 v37, v41
  v_permlane32_swap_b32 v38, v42
  v_permlane32_swap_b32 v39, v43
  v_add_f32 v36, v36, v40
  v_add_f32 v37, v37, v41
  v_add_f32 v38, v38, v42
  v_add_f32 v39, v39, v43
  v_cvt_pk_bf16_f32 v40, v36, v37
  v_cvt_pk_bf16_f32 v41, v38, v39
  ds_write_b64 v72, v[40:41]
  v_permlane32_swap_b32 v44, v48
  v_permlane32_swap_b32 v45, v49
  v_permlane32_swap_b32 v46, v50
  v_permlane32_swap_b32 v47, v51
  v_add_f32 v44, v44, v48
  v_add_f32 v45, v45, v49
  v_add_f32 v46, v46, v50
  v_add_f32 v47, v47, v51
  v_cvt_pk_bf16_f32 v48, v44, v45
  v_cvt_pk_bf16_f32 v49, v46, v47
  ds_write_b64 v73, v[48:49]
  v_permlane32_swap_b32 v52, v56
  v_permlane32_swap_b32 v53, v57
  v_permlane32_swap_b32 v54, v58
  v_permlane32_swap_b32 v55, v59
  v_add_f32 v52, v52, v56
  v_add_f32 v53, v53, v57
  v_add_f32 v54, v54, v58
  v_add_f32 v55, v55, v59
  v_cvt_pk_bf16_f32 v56, v52, v53
  v_cvt_pk_bf16_f32 v57, v54, v55
  ds_write_b64 v74, v[56:57]
  v_mov_b32 v64, v60
  v_mov_b32 v65, v61
  v_mov_b32 v66, v62
  v_mov_b32 v67, v63
  v_permlane32_swap_b32 v60, v64
  v_permlane32_swap_b32 v61, v65
  v_permlane32_swap_b32 v62, v66
  v_permlane32_swap_b32 v63, v67
  v_add_f32 v60, v60, v64
  v_add_f32 v61, v61, v65
  v_add_f32 v62, v62, v66
  v_add_f32 v63, v63, v67
  v_cvt_pk_bf16_f32 v64, v60, v61
  v_cvt_pk_bf16_f32 v65, v62, v63
  ds_write_b64 v75, v[64:65]
  s_waitcnt lgkmcnt(0)
  ds_read_b128 v[64:67], v76
  ds_read_b128 v[68:71], v76 offset:1024
  s_waitcnt lgkmcnt(0)
  buffer_store_dwordx4 v[64:67], v2, s[8:11], s25 offen sc1
  buffer_store_dwordx4 v[68:71], v2, s[8:11], s25 offen offset:1024 sc1
  s_waitcnt vmcnt(0)
  s_mov_b64 exec, 1
  buffer_store_dword v78, v2, s[8:11], s26 offen sc1
  s_mov_b64 exec, -1
  s_add_u32 s24, s24, 14336
  s_add_u32 s25, s25, 16384
  s_add_u32 s26, s26, 32
  s_add_u32 s17, s17, 2
  s_cmp_lt_u32 s17, 64
  s_cbranch_scc1 ws_loop
  v_mov_b32 v250, 0
  s_branch wk_loop
wk_s4d:
  s_cmp_lg_u32 s16, 0
  s_cbranch_scc1 w0_39
  s_getreg_b32 s20, hwreg(HW_REG_XCC_ID)
  s_sub_u32 s20, s20, 1
  s_and_b32 s20, s20, 7
  s_mov_b64 exec, 1
s4_l:
  s_cmp_ge_u32 s20, 7
  s_cselect_b32 s20, 0, s20
  s_lshl_b32 s21, s20, 7
  s_add_u32 s21, s21, 88586240
  v_mov_b32 v242, 1
  buffer_atomic_add v242, off, s[8:11], s21 sc0
  s_waitcnt vmcnt(0)
  v_readfirstlane_b32 s21, v242
  s_lshl_b32 s22, s20, 4
  s_add_u32 s20, s20, 1
  s_cmp_ge_u32 s21, 16
  s_cbranch_scc1 s4_l
  v_add_u32 v242, s22, v242
  s_mov_b64 exec, -1
w0_39:
  v_mov_b32 v243, 160000
  s_add_u32 s101, s101, 1
  s_barrier
  s_mov_b64 exec, 1
  s_cmp_lg_u32 s16, 0
  s_cbranch_scc1 w0_40
  ds_write_b32 v243, v242 offset:0
  s_waitcnt lgkmcnt(0)
  v_mov_b32 v242, s101
  ds_write_b32 v243, v242 offset:16
  s_waitcnt lgkmcnt(0)
w0_40:
  s_mov_b64 exec, -1
  s_barrier
  ds_read_b32 v242, v243 offset:0
  ds_read_b32 v243, v243 offset:16
  s_waitcnt lgkmcnt(0)
  v_readfirstlane_b32 s3, v242
  v_cmp_ne_u32 vcc, s101, v243
  s_cbranch_vccnz ch_end
  s_load_dwordx8 s[40:47], s[0:1], 0
  s_load_dwordx4 s[48:51], s[0:1], 32
  s_load_dwordx2 s[52:53], s[0:1], 48
  s_load_dwordx2 s[54:55], s[0:1], 112
  v_lshrrev_b32 v1, 6, v0
  s_nop 0
  v_readfirstlane_b32 s16, v1
  v_and_b32 v1, 63, v0
  v_lshrrev_b32 v3, 4, v1
  v_and_b32 v4, 15, v1
  s_mul_i32 s17, s16, 24576
  s_waitcnt lgkmcnt(0)
  s_mov_b32 s60, s40
  s_and_b32 s61, s41, 0xffff
  s_mov_b32 s62, 1835008
  s_mov_b32 s63, 0x20000
  s_mov_b32 s64, s42
  s_and_b32 s65, s43, 0xffff
  s_mov_b32 s66, 229376
  s_mov_b32 s67, 0x20000
  s_mov_b32 s68, s44
  s_and_b32 s69, s45, 0xffff
  s_mov_b32 s70, 229376
  s_mov_b32 s71, 0x20000
  s_mov_b32 s72, s46
  s_and_b32 s73, s47, 0xffff
  s_mov_b32 s74, 229376
  s_mov_b32 s75, 0x20000
  s_mov_b32 s76, s48
  s_and_b32 s77, s49, 0xffff
  s_mov_b32 s78, 229376
  s_mov_b32 s79, 0x20000
  s_mov_b32 s80, s50
  s_and_b32 s81, s51, 0xffff
  s_mov_b32 s82, 896
  s_mov_b32 s83, 0x20000
  s_mov_b32 s84, s52
  s_and_b32 s85, s53, 0xffff
  s_mov_b32 s86, 896
  s_mov_b32 s87, 0x20000
  s_mov_b32 s92, s54
  s_and_b32 s93, s55, 0xffff
  s_mov_b32 s94, 3670016
  s_mov_b32 s95, 0x20000
  v_lshlrev_b32 v5, 5, v1
  v_sub_u32 v5, 2047, v5
  s_add_u32 s18, s17, 13056
  v_subrev_u32 v6, 0, v5
  v_max_i32 v7, 0, v6
  v_cvt_f32_u32 v7, v7
  v_cvt_pk_bf16_f32 v8, v7, v7
  v_and_b32 v7, 0xffff0000, v8
  v_lshrrev_b32 v8, 23, v7
  v_subrev_u32 v8, 134, v8
  v_max_i32 v8, 0, v8
  v_cvt_u32_f32 v7, v7
  v_lshrrev_b32 v7, v8, v7
  v_lshl_add_u32 v7, v8, 8, v7
  v_lshl_add_u32 v200, v7, 2, s18
  v_subrev_u32 v6, 1, v5
  v_max_i32 v7, 0, v6
  v_cvt_f32_u32 v7, v7
  v_cvt_pk_bf16_f32 v8, v7, v7
  v_and_b32 v7, 0xffff0000, v8
  v_lshrrev_b32 v8, 23, v7
  v_subrev_u32 v8, 134, v8
  v_max_i32 v8, 0, v8
  v_cvt_u32_f32 v7, v7
  v_lshrrev_b32 v7, v8, v7
  v_lshl_add_u32 v7, v8, 8, v7
  v_lshl_add_u32 v201, v7, 2, s18
  v_subrev_u32 v6, 2, v5
  v_max_i32 v7, 0, v6
  v_cvt_f32_u32 v7, v7
  v_cvt_pk_bf16_f32 v8, v7, v7
  v_and_b32 v7, 0xffff0000, v8
  v_lshrrev_b32 v8, 23, v7
  v_subrev_u32 v8, 134, v8
  v_max_i32 v8, 0, v8
  v_cvt_u32_f32 v7, v7
  v_lshrrev_b32 v7, v8, v7
  v_lshl_add_u32 v7, v8, 8, v7
  v_lshl_add_u32 v202, v7, 2, s18
  v_subrev_u32 v6, 3, v5
  v_max_i32 v7, 0, v6
  v_cvt_f32_u32 v7, v7
  v_cvt_pk_bf16_f32 v8, v7, v7
  v_and_b32 v7, 0xffff0000, v8
  v_lshrrev_b32 v8, 23, v7
  v_subrev_u32 v8, 134, v8
  v_max_i32 v8, 0, v8
  v_cvt_u32_f32 v7, v7
  v_lshrrev_b32 v7, v8, v7
  v_lshl_add_u32 v7, v8, 8, v7
  v_lshl_add_u32 v203, v7, 2, s18
  v_subrev_u32 v6, 4, v5
  v_max_i32 v7, 0, v6
  v_cvt_f32_u32 v7, v7
  v_cvt_pk_bf16_f32 v8, v7, v7
  v_and_b32 v7, 0xffff0000, v8
  v_lshrrev_b32 v8, 23, v7
  v_subrev_u32 v8, 134, v8
  v_max_i32 v8, 0, v8
  v_cvt_u32_f32 v7, v7
  v_lshrrev_b32 v7, v8, v7
  v_lshl_add_u32 v7, v8, 8, v7
  v_lshl_add_u32 v204, v7, 2, s18
  v_subrev_u32 v6, 5, v5
  v_max_i32 v7, 0, v6
  v_cvt_f32_u32 v7, v7
  v_cvt_pk_bf16_f32 v8, v7, v7
  v_and_b32 v7, 0xffff0000, v8
  v_lshrrev_b32 v8, 23, v7
  v_subrev_u32 v8, 134, v8
  v_max_i32 v8, 0, v8
  v_cvt_u32_f32 v7, v7
  v_lshrrev_b32 v7, v8, v7
  v_lshl_add_u32 v7, v8, 8, v7
  v_lshl_add_u32 v205, v7, 2, s18
  v_subrev_u32 v6, 6, v5
  v_max_i32 v7, 0, v6
  v_cvt_f32_u32 v7, v7
  v_cvt_pk_bf16_f32 v8, v7, v7
  v_and_b32 v7, 0xffff0000, v8
  v_lshrrev_b32 v8, 23, v7
  v_subrev_u32 v8, 134, v8
  v_max_i32 v8, 0, v8
  v_cvt_u32_f32 v7, v7
  v_lshrrev_b32 v7, v8, v7
  v_lshl_add_u32 v7, v8, 8, v7
  v_lshl_add_u32 v206, v7, 2, s18
  v_subrev_u32 v6, 7, v5
  v_max_i32 v7, 0, v6
  v_cvt_f32_u32 v7, v7
  v_cvt_pk_bf16_f32 v8, v7, v7
  v_and_b32 v7, 0xffff0000, v8
  v_lshrrev_b32 v8, 23, v7
  v_subrev_u32 v8, 134, v8
  v_max_i32 v8, 0, v8
  v_cvt_u32_f32 v7, v7
  v_lshrrev_b32 v7, v8, v7
  v_lshl_add_u32 v7, v8, 8, v7
  v_lshl_add_u32 v207, v7, 2, s18
  v_subrev_u32 v6, 8, v5
  v_max_i32 v7, 0, v6
  v_cvt_f32_u32 v7, v7
  v_cvt_pk_bf16_f32 v8, v7, v7
  v_and_b32 v7, 0xffff0000, v8
  v_lshrrev_b32 v8, 23, v7
  v_subrev_u32 v8, 134, v8
  v_max_i32 v8, 0, v8
  v_cvt_u32_f32 v7, v7
  v_lshrrev_b32 v7, v8, v7
  v_lshl_add_u32 v7, v8, 8, v7
  v_lshl_add_u32 v208, v7, 2, s18
  v_subrev_u32 v6, 9, v5
  v_max_i32 v7, 0, v6
  v_cvt_f32_u32 v7, v7
  v_cvt_pk_bf16_f32 v8, v7, v7
  v_and_b32 v7, 0xffff0000, v8
  v_lshrrev_b32 v8, 23, v7
  v_subrev_u32 v8, 134, v8
  v_max_i32 v8, 0, v8
  v_cvt_u32_f32 v7, v7
  v_lshrrev_b32 v7, v8, v7
  v_lshl_add_u32 v7, v8, 8, v7
  v_lshl_add_u32 v209, v7, 2, s18
  v_subrev_u32 v6, 10, v5
  v_max_i32 v7, 0, v6
  v_cvt_f32_u32 v7, v7
  v_cvt_pk_bf16_f32 v8, v7, v7
  v_and_b32 v7, 0xffff0000, v8
  v_lshrrev_b32 v8, 23, v7
  v_subrev_u32 v8, 134, v8
  v_max_i32 v8, 0, v8
  v_cvt_u32_f32 v7, v7
  v_lshrrev_b32 v7, v8, v7
  v_lshl_add_u32 v7, v8, 8, v7
  v_lshl_add_u32 v210, v7, 2, s18
  v_subrev_u32 v6, 11, v5
  v_max_i32 v7, 0, v6
  v_cvt_f32_u32 v7, v7
  v_cvt_pk_bf16_f32 v8, v7, v7
  v_and_b32 v7, 0xffff0000, v8
  v_lshrrev_b32 v8, 23, v7
  v_subrev_u32 v8, 134, v8
  v_max_i32 v8, 0, v8
  v_cvt_u32_f32 v7, v7
  v_lshrrev_b32 v7, v8, v7
  v_lshl_add_u32 v7, v8, 8, v7
  v_lshl_add_u32 v211, v7, 2, s18
  v_subrev_u32 v6, 12, v5
  v_max_i32 v7, 0, v6
  v_cvt_f32_u32 v7, v7
  v_cvt_pk_bf16_f32 v8, v7, v7
  v_and_b32 v7, 0xffff0000, v8
  v_lshrrev_b32 v8, 23, v7
  v_subrev_u32 v8, 134, v8
  v_max_i32 v8, 0, v8
  v_cvt_u32_f32 v7, v7
  v_lshrrev_b32 v7, v8, v7
  v_lshl_add_u32 v7, v8, 8, v7
  v_lshl_add_u32 v212, v7, 2, s18
  v_subrev_u32 v6, 13, v5
  v_max_i32 v7, 0, v6
  v_cvt_f32_u32 v7, v7
  v_cvt_pk_bf16_f32 v8, v7, v7
  v_and_b32 v7, 0xffff0000, v8
  v_lshrrev_b32 v8, 23, v7
  v_subrev_u32 v8, 134, v8
  v_max_i32 v8, 0, v8
  v_cvt_u32_f32 v7, v7
  v_lshrrev_b32 v7, v8, v7
  v_lshl_add_u32 v7, v8, 8, v7
  v_lshl_add_u32 v213, v7, 2, s18
  v_subrev_u32 v6, 14, v5
  v_max_i32 v7, 0, v6
  v_cvt_f32_u32 v7, v7
  v_cvt_pk_bf16_f32 v8, v7, v7
  v_and_b32 v7, 0xffff0000, v8
  v_lshrrev_b32 v8, 23, v7
  v_subrev_u32 v8, 134, v8
  v_max_i32 v8, 0, v8
  v_cvt_u32_f32 v7, v7
  v_lshrrev_b32 v7, v8, v7
  v_lshl_add_u32 v7, v8, 8, v7
  v_lshl_add_u32 v214, v7, 2, s18
  v_subrev_u32 v6, 15, v5
  v_max_i32 v7, 0, v6
  v_cvt_f32_u32 v7, v7
  v_cvt_pk_bf16_f32 v8, v7, v7
  v_and_b32 v7, 0xffff0000, v8
  v_lshrrev_b32 v8, 23, v7
  v_subrev_u32 v8, 134, v8
  v_max_i32 v8, 0, v8
  v_cvt_u32_f32 v7, v7
  v_lshrrev_b32 v7, v8, v7
  v_lshl_add_u32 v7, v8, 8, v7
  v_lshl_add_u32 v215, v7, 2, s18
  v_subrev_u32 v6, 16, v5
  v_max_i32 v7, 0, v6
  v_cvt_f32_u32 v7, v7
  v_cvt_pk_bf16_f32 v8, v7, v7
  v_and_b32 v7, 0xffff0000, v8
  v_lshrrev_b32 v8, 23, v7
  v_subrev_u32 v8, 134, v8
  v_max_i32 v8, 0, v8
  v_cvt_u32_f32 v7, v7
  v_lshrrev_b32 v7, v8, v7
  v_lshl_add_u32 v7, v8, 8, v7
  v_lshl_add_u32 v216, v7, 2, s18
  v_subrev_u32 v6, 17, v5
  v_max_i32 v7, 0, v6
  v_cvt_f32_u32 v7, v7
  v_cvt_pk_bf16_f32 v8, v7, v7
  v_and_b32 v7, 0xffff0000, v8
  v_lshrrev_b32 v8, 23, v7
  v_subrev_u32 v8, 134, v8
  v_max_i32 v8, 0, v8
  v_cvt_u32_f32 v7, v7
  v_lshrrev_b32 v7, v8, v7
  v_lshl_add_u32 v7, v8, 8, v7
  v_lshl_add_u32 v217, v7, 2, s18
  v_subrev_u32 v6, 18, v5
  v_max_i32 v7, 0, v6
  v_cvt_f32_u32 v7, v7
  v_cvt_pk_bf16_f32 v8, v7, v7
  v_and_b32 v7, 0xffff0000, v8
  v_lshrrev_b32 v8, 23, v7
  v_subrev_u32 v8, 134, v8
  v_max_i32 v8, 0, v8
  v_cvt_u32_f32 v7, v7
  v_lshrrev_b32 v7, v8, v7
  v_lshl_add_u32 v7, v8, 8, v7
  v_lshl_add_u32 v218, v7, 2, s18
  v_subrev_u32 v6, 19, v5
  v_max_i32 v7, 0, v6
  v_cvt_f32_u32 v7, v7
  v_cvt_pk_bf16_f32 v8, v7, v7
  v_and_b32 v7, 0xffff0000, v8
  v_lshrrev_b32 v8, 23, v7
  v_subrev_u32 v8, 134, v8
  v_max_i32 v8, 0, v8
  v_cvt_u32_f32 v7, v7
  v_lshrrev_b32 v7, v8, v7
  v_lshl_add_u32 v7, v8, 8, v7
  v_lshl_add_u32 v219, v7, 2, s18
  v_subrev_u32 v6, 20, v5
  v_max_i32 v7, 0, v6
  v_cvt_f32_u32 v7, v7
  v_cvt_pk_bf16_f32 v8, v7, v7
  v_and_b32 v7, 0xffff0000, v8
  v_lshrrev_b32 v8, 23, v7
  v_subrev_u32 v8, 134, v8
  v_max_i32 v8, 0, v8
  v_cvt_u32_f32 v7, v7
  v_lshrrev_b32 v7, v8, v7
  v_lshl_add_u32 v7, v8, 8, v7
  v_lshl_add_u32 v220, v7, 2, s18
  v_subrev_u32 v6, 21, v5
  v_max_i32 v7, 0, v6
  v_cvt_f32_u32 v7, v7
  v_cvt_pk_bf16_f32 v8, v7, v7
  v_and_b32 v7, 0xffff0000, v8
  v_lshrrev_b32 v8, 23, v7
  v_subrev_u32 v8, 134, v8
  v_max_i32 v8, 0, v8
  v_cvt_u32_f32 v7, v7
  v_lshrrev_b32 v7, v8, v7
  v_lshl_add_u32 v7, v8, 8, v7
  v_lshl_add_u32 v221, v7, 2, s18
  v_subrev_u32 v6, 22, v5
  v_max_i32 v7, 0, v6
  v_cvt_f32_u32 v7, v7
  v_cvt_pk_bf16_f32 v8, v7, v7
  v_and_b32 v7, 0xffff0000, v8
  v_lshrrev_b32 v8, 23, v7
  v_subrev_u32 v8, 134, v8
  v_max_i32 v8, 0, v8
  v_cvt_u32_f32 v7, v7
  v_lshrrev_b32 v7, v8, v7
  v_lshl_add_u32 v7, v8, 8, v7
  v_lshl_add_u32 v222, v7, 2, s18
  v_subrev_u32 v6, 23, v5
  v_max_i32 v7, 0, v6
  v_cvt_f32_u32 v7, v7
  v_cvt_pk_bf16_f32 v8, v7, v7
  v_and_b32 v7, 0xffff0000, v8
  v_lshrrev_b32 v8, 23, v7
  v_subrev_u32 v8, 134, v8
  v_max_i32 v8, 0, v8
  v_cvt_u32_f32 v7, v7
  v_lshrrev_b32 v7, v8, v7
  v_lshl_add_u32 v7, v8, 8, v7
  v_lshl_add_u32 v223, v7, 2, s18
  v_subrev_u32 v6, 24, v5
  v_max_i32 v7, 0, v6
  v_cvt_f32_u32 v7, v7
  v_cvt_pk_bf16_f32 v8, v7, v7
  v_and_b32 v7, 0xffff0000, v8
  v_lshrrev_b32 v8, 23, v7
  v_subrev_u32 v8, 134, v8
  v_max_i32 v8, 0, v8
  v_cvt_u32_f32 v7, v7
  v_lshrrev_b32 v7, v8, v7
  v_lshl_add_u32 v7, v8, 8, v7
  v_lshl_add_u32 v224, v7, 2, s18
  v_subrev_u32 v6, 25, v5
  v_max_i32 v7, 0, v6
  v_cvt_f32_u32 v7, v7
  v_cvt_pk_bf16_f32 v8, v7, v7
  v_and_b32 v7, 0xffff0000, v8
  v_lshrrev_b32 v8, 23, v7
  v_subrev_u32 v8, 134, v8
  v_max_i32 v8, 0, v8
  v_cvt_u32_f32 v7, v7
  v_lshrrev_b32 v7, v8, v7
  v_lshl_add_u32 v7, v8, 8, v7
  v_lshl_add_u32 v225, v7, 2, s18
  v_subrev_u32 v6, 26, v5
  v_max_i32 v7, 0, v6
  v_cvt_f32_u32 v7, v7
  v_cvt_pk_bf16_f32 v8, v7, v7
  v_and_b32 v7, 0xffff0000, v8
  v_lshrrev_b32 v8, 23, v7
  v_subrev_u32 v8, 134, v8
  v_max_i32 v8, 0, v8
  v_cvt_u32_f32 v7, v7
  v_lshrrev_b32 v7, v8, v7
  v_lshl_add_u32 v7, v8, 8, v7
  v_lshl_add_u32 v226, v7, 2, s18
  v_subrev_u32 v6, 27, v5
  v_max_i32 v7, 0, v6
  v_cvt_f32_u32 v7, v7
  v_cvt_pk_bf16_f32 v8, v7, v7
  v_and_b32 v7, 0xffff0000, v8
  v_lshrrev_b32 v8, 23, v7
  v_subrev_u32 v8, 134, v8
  v_max_i32 v8, 0, v8
  v_cvt_u32_f32 v7, v7
  v_lshrrev_b32 v7, v8, v7
  v_lshl_add_u32 v7, v8, 8, v7
  v_lshl_add_u32 v227, v7, 2, s18
  v_subrev_u32 v6, 28, v5
  v_max_i32 v7, 0, v6
  v_cvt_f32_u32 v7, v7
  v_cvt_pk_bf16_f32 v8, v7, v7
  v_and_b32 v7, 0xffff0000, v8
  v_lshrrev_b32 v8, 23, v7
  v_subrev_u32 v8, 134, v8
  v_max_i32 v8, 0, v8
  v_cvt_u32_f32 v7, v7
  v_lshrrev_b32 v7, v8, v7
  v_lshl_add_u32 v7, v8, 8, v7
  v_lshl_add_u32 v228, v7, 2, s18
  v_subrev_u32 v6, 29, v5
  v_max_i32 v7, 0, v6
  v_cvt_f32_u32 v7, v7
  v_cvt_pk_bf16_f32 v8, v7, v7
  v_and_b32 v7, 0xffff0000, v8
  v_lshrrev_b32 v8, 23, v7
  v_subrev_u32 v8, 134, v8
  v_max_i32 v8, 0, v8
  v_cvt_u32_f32 v7, v7
  v_lshrrev_b32 v7, v8, v7
  v_lshl_add_u32 v7, v8, 8, v7
  v_lshl_add_u32 v229, v7, 2, s18
  v_subrev_u32 v6, 30, v5
  v_max_i32 v7, 0, v6
  v_cvt_f32_u32 v7, v7
  v_cvt_pk_bf16_f32 v8, v7, v7
  v_and_b32 v7, 0xffff0000, v8
  v_lshrrev_b32 v8, 23, v7
  v_subrev_u32 v8, 134, v8
  v_max_i32 v8, 0, v8
  v_cvt_u32_f32 v7, v7
  v_lshrrev_b32 v7, v8, v7
  v_lshl_add_u32 v7, v8, 8, v7
  v_lshl_add_u32 v230, v7, 2, s18
  v_subrev_u32 v6, 31, v5
  v_max_i32 v7, 0, v6
  v_cvt_f32_u32 v7, v7
  v_cvt_pk_bf16_f32 v8, v7, v7
  v_and_b32 v7, 0xffff0000, v8
  v_lshrrev_b32 v8, 23, v7
  v_subrev_u32 v8, 134, v8
  v_max_i32 v8, 0, v8
  v_cvt_u32_f32 v7, v7
  v_lshrrev_b32 v7, v8, v7
  v_lshl_add_u32 v7, v8, 8, v7
  v_lshl_add_u32 v231, v7, 2, s18
  v_subrev_u32 v6, 32, v5
  v_max_i32 v7, 0, v6
  v_cvt_f32_u32 v7, v7
  v_cvt_pk_bf16_f32 v8, v7, v7
  v_and_b32 v7, 0xffff0000, v8
  v_lshrrev_b32 v8, 23, v7
  v_subrev_u32 v8, 134, v8
  v_max_i32 v8, 0, v8
  v_cvt_u32_f32 v7, v7
  v_lshrrev_b32 v7, v8, v7
  v_lshl_add_u32 v7, v8, 8, v7
  v_mov_b32 v8, 1280
  v_cmp_gt_i32 vcc, 0, v6
  s_nop 1
  v_cndmask_b32 v7, v7, v8, vcc
  v_lshl_add_u32 v232, v7, 2, s18
  v_mov_b32 v8, 0
  v_mov_b32 v9, 0
  v_lshlrev_b32 v5, 3, v1
  v_add_u32 v5, s17, v5
  ds_write_b64 v5, v[8:9]
  v_and_b32 v6, 15, v1
  v_lshlrev_b32 v6, 3, v6
  v_add_u32 v6, s17, v6
  ds_write_b64 v6, v[8:9] offset:8704
  ds_write_b64 v6, v[8:9] offset:12928
  v_mov_b32 v6, s17
  ds_write_b64 v6, v[8:9] offset:18176
  s_lshl_b32 s19, s3, 2
  s_add_u32 s20, s19, s16
  s_lshl_b32 s21, s3, 3
  v_mul_u32_u24 v5, 3584, v0
  v_mul_u32_u24 v141, 1792, v0
  s_lshl_b32 s22, s20, 9
  v_lshlrev_b32 v6, 3, v1
  buffer_load_dwordx2 v[24:25], v6, s[64:67], s22 offen
  buffer_load_dwordx2 v[26:27], v6, s[68:71], s22 offen
  buffer_load_dwordx2 v[28:29], v6, s[72:75], s22 offen
  buffer_load_dwordx2 v[30:31], v6, s[76:79], s22 offen
  s_lshl_b32 s22, s20, 1
  v_mov_b32 v7, 0
  buffer_load_ushort v32, v7, s[80:83], s22 offen
  buffer_load_ushort v33, v7, s[84:87], s22 offen
  s_mov_b32 s24, 0x05040100
  s_mov_b32 s25, 0x07060302
  s_barrier
  s_waitcnt vmcnt(0)
  s_mov_b32 s26, 1069066811
  s_mov_b32 s27, 1042479491
  v_lshlrev_b32 v32, 16, v32
  v_lshlrev_b32 v33, 16, v33
  v_mul_f32 v32, s26, v32
  v_exp_f32 v32, v32
  s_nop 0
  v_cvt_pk_bf16_f32 v34, v32, v32
  v_and_b32 v32, 0xffff0000, v34
  v_lshlrev_b32 v37, 6, v1
  v_add_u32 v37, s17, v37
  v_lshlrev_b32 v40, 16, v24
  v_lshlrev_b32 v41, 16, v26
  v_lshlrev_b32 v42, 16, v28
  v_lshlrev_b32 v43, 16, v30
  v_mul_f32 v40, s26, v40
  v_exp_f32 v40, v40
  s_nop 0
  v_cvt_pk_bf16_f32 v34, v40, v40
  v_and_b32 v40, 0xffff0000, v34
  v_mul_f32 v40, v40, v32
  v_mul_f32 v40, s26, v40
  v_sub_f32 v40, 0, v40
  v_mul_f32 v41, v41, v32
  v_mul_f32 v41, s27, v41
  v_mul_f32 v42, v42, v32
  v_mul_f32 v43, v43, v32
  v_add_f32 v42, v42, v42
  v_add_f32 v43, v43, v43
  ds_write_b128 v37, v[40:43] offset:18240
  v_and_b32 v40, 0xffff0000, v24
  v_and_b32 v41, 0xffff0000, v26
  v_and_b32 v42, 0xffff0000, v28
  v_and_b32 v43, 0xffff0000, v30
  v_mul_f32 v40, s26, v40
  v_exp_f32 v40, v40
  s_nop 0
  v_cvt_pk_bf16_f32 v34, v40, v40
  v_and_b32 v40, 0xffff0000, v34
  v_mul_f32 v40, v40, v32
  v_mul_f32 v40, s26, v40
  v_sub_f32 v40, 0, v40
  v_mul_f32 v41, v41, v32
  v_mul_f32 v41, s27, v41
  v_mul_f32 v42, v42, v32
  v_mul_f32 v43, v43, v32
  v_add_f32 v42, v42, v42
  v_add_f32 v43, v43, v43
  ds_write_b128 v37, v[40:43] offset:18256
  v_lshlrev_b32 v40, 16, v25
  v_lshlrev_b32 v41, 16, v27
  v_lshlrev_b32 v42, 16, v29
  v_lshlrev_b32 v43, 16, v31
  v_mul_f32 v40, s26, v40
  v_exp_f32 v40, v40
  s_nop 0
  v_cvt_pk_bf16_f32 v34, v40, v40
  v_and_b32 v40, 0xffff0000, v34
  v_mul_f32 v40, v40, v32
  v_mul_f32 v40, s26, v40
  v_sub_f32 v40, 0, v40
  v_mul_f32 v41, v41, v32
  v_mul_f32 v41, s27, v41
  v_mul_f32 v42, v42, v32
  v_mul_f32 v43, v43, v32
  v_add_f32 v42, v42, v42
  v_add_f32 v43, v43, v43
  ds_write_b128 v37, v[40:43] offset:18272
  v_and_b32 v40, 0xffff0000, v25
  v_and_b32 v41, 0xffff0000, v27
  v_and_b32 v42, 0xffff0000, v29
  v_and_b32 v43, 0xffff0000, v31
  v_mul_f32 v40, s26, v40
  v_exp_f32 v40, v40
  s_nop 0
  v_cvt_pk_bf16_f32 v34, v40, v40
  v_and_b32 v40, 0xffff0000, v34
  v_mul_f32 v40, v40, v32
  v_mul_f32 v40, s26, v40
  v_sub_f32 v40, 0, v40
  v_mul_f32 v41, v41, v32
  v_mul_f32 v41, s27, v41
  v_mul_f32 v42, v42, v32
  v_mul_f32 v43, v43, v32
  v_add_f32 v42, v42, v42
  v_add_f32 v43, v43, v43
  ds_write_b128 v37, v[40:43] offset:18288
  v_cvt_f32_u32 v44, v4
  v_lshlrev_b32 v45, 4, v4
  v_cvt_f32_u32 v45, v45
  v_lshlrev_b32 v46, 4, v3
  v_add_u32 v46, s17, v46
  v_mov_b32 v48, 0
  v_mov_b32 v49, 0
  v_mov_b32 v50, 0
  v_mov_b32 v51, 0
  v_mov_b32 v52, 0
  v_mov_b32 v53, 0
  v_mov_b32 v54, 0
  v_mov_b32 v55, 0
  v_mov_b32 v56, 0
  v_mov_b32 v57, 0
  v_mov_b32 v58, 0
  v_mov_b32 v59, 0
  v_mov_b32 v60, 0
  v_mov_b32 v61, 0
  v_mov_b32 v62, 0
  v_mov_b32 v63, 0
  v_mov_b32 v64, 0
  v_mov_b32 v65, 0
  v_mov_b32 v66, 0
  v_mov_b32 v67, 0
  s_waitcnt lgkmcnt(0)
  ds_read_b128 v[68:71], v46 offset:18240
  s_add_u32 s22, s21, 0
  buffer_load_dwordx2 v[8:9], v5, s[60:63], s22 offen offset:0
  s_mov_b32 s28, 0
  s_call_b64 s[30:31], wk_kl
  s_mov_b32 s28, 0
  s_call_b64 s[30:31], wk_kl
  s_add_u32 s22, s21, 0
  buffer_load_dwordx2 v[10:11], v5, s[60:63], s22 offen offset:896
  s_mov_b32 s28, 0
  s_call_b64 s[30:31], wk_kl
  s_mov_b32 s28, 0
  s_call_b64 s[30:31], wk_kl
  s_add_u32 s22, s21, 0
  buffer_load_dwordx2 v[12:13], v5, s[60:63], s22 offen offset:1792
  s_mov_b32 s28, 0
  s_call_b64 s[30:31], wk_kl
  s_mov_b32 s28, 0
  s_call_b64 s[30:31], wk_kl
  s_add_u32 s22, s21, 0
  buffer_load_dwordx2 v[14:15], v5, s[60:63], s22 offen offset:2688
  s_mov_b32 s28, 0
  s_call_b64 s[30:31], wk_kl
  s_mov_b32 s28, 0
  s_call_b64 s[30:31], wk_kl
  s_add_u32 s22, s21, 917504
  buffer_load_dwordx2 v[16:17], v5, s[60:63], s22 offen offset:0
  s_mov_b32 s28, 0
  s_call_b64 s[30:31], wk_kl
  s_mov_b32 s28, 0
  s_call_b64 s[30:31], wk_kl
  s_add_u32 s22, s21, 917504
  buffer_load_dwordx2 v[18:19], v5, s[60:63], s22 offen offset:896
  s_mov_b32 s28, 0
  s_call_b64 s[30:31], wk_kl
  s_mov_b32 s28, 0
  s_call_b64 s[30:31], wk_kl
  s_add_u32 s22, s21, 917504
  buffer_load_dwordx2 v[20:21], v5, s[60:63], s22 offen offset:1792
  s_mov_b32 s28, 0
  s_call_b64 s[30:31], wk_kl
  s_mov_b32 s28, 0
  s_call_b64 s[30:31], wk_kl
  s_add_u32 s22, s21, 917504
  buffer_load_dwordx2 v[22:23], v5, s[60:63], s22 offen offset:2688
  s_mov_b32 s28, 0
  s_call_b64 s[30:31], wk_kl
  s_mov_b32 s28, 0
  s_call_b64 s[30:31], wk_kl
  s_branch wk_kd
wk_kl:
  s_waitcnt lgkmcnt(0)
  v_mov_b32 v72, v68
  v_mov_b32 v73, v69
  v_mov_b32 v74, v70
  v_mov_b32 v75, v71
  v_add_u32 v46, 64, v46
  ds_read_b128 v[68:71], v46 offset:18240
  v_mul_f32 v80, v72, v45
  v_mul_f32 v81, v73, v45
  v_exp_f32 v80, v80
  v_fract_f32 v81, v81
  v_cos_f32 v76, v81
  v_sin_f32 v77, v81
  v_mul_f32 v76, v76, v80
  v_mul_f32 v77, v77, v80
  v_mul_f32 v80, v72, v44
  v_mul_f32 v81, v73, v44
  v_exp_f32 v80, v80
  v_fract_f32 v81, v81
  v_cos_f32 v78, v81
  v_sin_f32 v79, v81
  v_mul_f32 v78, v78, v80
  v_mul_f32 v79, v79, v80
  v_mul_f32 v82, v74, v76
  v_mul_f32 v83, v74, v77
  v_fma_f32 v82, -v75, v77, v82
  v_fma_f32 v83, -v75, v76, -v83
  v_mul_f32 v86, v76, v76
  v_mul_f32 v87, v76, v77
  v_fma_f32 v86, -v77, v77, v86
  v_add_f32 v87, v87, v87
  v_mfma_f32_16x16x4_f32 v[48:51], v82, v78, v[48:51]
  v_mul_f32 v88, v78, v78
  v_mul_f32 v89, v78, v79
  v_fma_f32 v88, -v79, v79, v88
  v_add_f32 v89, v89, v89
  v_mfma_f32_16x16x4_f32 v[48:51], v83, v79, v[48:51]
  v_mul_f32 v84, v74, v86
  v_mul_f32 v85, v74, v87
  v_fma_f32 v84, -v75, v87, v84
  v_fma_f32 v85, -v75, v86, -v85
  v_mul_f32 v76, v86, v86
  v_mul_f32 v77, v86, v87
  v_fma_f32 v76, -v87, v87, v76
  v_add_f32 v77, v77, v77
  v_mfma_f32_16x16x4_f32 v[52:55], v84, v88, v[52:55]
  v_mul_f32 v78, v88, v88
  v_mul_f32 v79, v88, v89
  v_fma_f32 v78, -v89, v89, v78
  v_add_f32 v79, v79, v79
  v_mfma_f32_16x16x4_f32 v[52:55], v85, v89, v[52:55]
  v_mul_f32 v82, v74, v76
  v_mul_f32 v83, v74, v77
  v_fma_f32 v82, -v75, v77, v82
  v_fma_f32 v83, -v75, v76, -v83
  v_mul_f32 v86, v76, v76
  v_mul_f32 v87, v76, v77
  v_fma_f32 v86, -v77, v77, v86
  v_add_f32 v87, v87, v87
  v_mfma_f32_16x16x4_f32 v[56:59], v82, v78, v[56:59]
  v_mul_f32 v88, v78, v78
  v_mul_f32 v89, v78, v79
  v_fma_f32 v88, -v79, v79, v88
  v_add_f32 v89, v89, v89
  v_mfma_f32_16x16x4_f32 v[56:59], v83, v79, v[56:59]
  v_mul_f32 v84, v74, v86
  v_mul_f32 v85, v74, v87
  v_fma_f32 v84, -v75, v87, v84
  v_fma_f32 v85, -v75, v86, -v85
  v_mul_f32 v76, v86, v86
  v_mul_f32 v77, v86, v87
  v_fma_f32 v76, -v87, v87, v76
  v_add_f32 v77, v77, v77
  v_mfma_f32_16x16x4_f32 v[60:63], v84, v88, v[60:63]
  v_mfma_f32_16x16x4_f32 v[60:63], v85, v89, v[60:63]
  v_mul_f32 v82, v74, v76
  v_fma_f32 v82, -v75, v77, v82
  s_nop 1
  v_mfma_f32_16x16x4_f32 v[64:67], v82, v88, v[64:67]
  s_add_u32 s28, s28, 1
  s_cmp_lt_u32 s28, 4
  s_cbranch_scc1 wk_kl
  s_setpc_b64 s[30:31]
wk_kd:
  s_nop 15
  s_nop 3
  s_waitcnt vmcnt(0)
  v_lshlrev_b32 v6, 3, v0
  v_perm_b32 v34, v10, v8, s24
  v_perm_b32 v35, v14, v12, s24
  v_add_u32 v36, 512, v6
  ds_write_b64 v36, v[34:35]
  v_perm_b32 v34, v10, v8, s25
  v_perm_b32 v35, v14, v12, s25
  v_add_u32 v36, 25088, v6
  ds_write_b64 v36, v[34:35]
  v_perm_b32 v34, v11, v9, s24
  v_perm_b32 v35, v15, v13, s24
  v_add_u32 v36, 49664, v6
  ds_write_b64 v36, v[34:35]
  v_perm_b32 v34, v11, v9, s25
  v_perm_b32 v35, v15, v13, s25
  v_add_u32 v36, 74240, v6
  ds_write_b64 v36, v[34:35]
  v_perm_b32 v34, v18, v16, s24
  v_perm_b32 v35, v22, v20, s24
  v_add_u32 v36, 2560, v6
  ds_write_b64 v36, v[34:35]
  v_perm_b32 v34, v18, v16, s25
  v_perm_b32 v35, v22, v20, s25
  v_add_u32 v36, 27136, v6
  ds_write_b64 v36, v[34:35]
  v_perm_b32 v34, v19, v17, s24
  v_perm_b32 v35, v23, v21, s24
  v_add_u32 v36, 51712, v6
  ds_write_b64 v36, v[34:35]
  v_perm_b32 v34, v19, v17, s25
  v_perm_b32 v35, v23, v21, s25
  v_add_u32 v36, 76288, v6
  ds_write_b64 v36, v[34:35]
  v_lshlrev_b32 v46, 8, v3
  v_lshl_add_u32 v46, v4, 2, v46
  v_add_u32 v46, s17, v46
  ds_write_b32 v46, v48 offset:13056
  ds_write_b32 v46, v49 offset:13120
  ds_write_b32 v46, v50 offset:13184
  ds_write_b32 v46, v51 offset:13248
  s_waitcnt lgkmcnt(8)
  ds_write_b32 v46, v52 offset:14080
  ds_write_b32 v46, v53 offset:14144
  ds_write_b32 v46, v54 offset:14208
  ds_write_b32 v46, v55 offset:14272
  s_waitcnt lgkmcnt(8)
  ds_write_b32 v46, v56 offset:15104
  ds_write_b32 v46, v57 offset:15168
  ds_write_b32 v46, v58 offset:15232
  ds_write_b32 v46, v59 offset:15296
  s_waitcnt lgkmcnt(8)
  ds_write_b32 v46, v60 offset:16128
  ds_write_b32 v46, v61 offset:16192
  ds_write_b32 v46, v62 offset:16256
  ds_write_b32 v46, v63 offset:16320
  s_waitcnt lgkmcnt(8)
  ds_write_b32 v46, v64 offset:17152
  ds_write_b32 v46, v65 offset:17216
  ds_write_b32 v46, v66 offset:17280
  ds_write_b32 v46, v67 offset:17344
  s_waitcnt lgkmcnt(8)
  s_waitcnt lgkmcnt(0)
  ds_read_b32 v48, v200
  ds_read_b32 v49, v201
  ds_read_b32 v50, v202
  ds_read_b32 v51, v203
  ds_read_b32 v52, v204
  ds_read_b32 v53, v205
  ds_read_b32 v54, v206
  ds_read_b32 v55, v207
  s_waitcnt lgkmcnt(4)
  ds_read_b32 v56, v208
  ds_read_b32 v57, v209
  ds_read_b32 v58, v210
  ds_read_b32 v59, v211
  ds_read_b32 v60, v212
  ds_read_b32 v61, v213
  ds_read_b32 v62, v214
  ds_read_b32 v63, v215
  s_waitcnt lgkmcnt(4)
  ds_read_b32 v64, v216
  ds_read_b32 v65, v217
  ds_read_b32 v66, v218
  ds_read_b32 v67, v219
  ds_read_b32 v68, v220
  ds_read_b32 v69, v221
  ds_read_b32 v70, v222
  ds_read_b32 v71, v223
  s_waitcnt lgkmcnt(4)
  ds_read_b32 v72, v224
  ds_read_b32 v73, v225
  ds_read_b32 v74, v226
  ds_read_b32 v75, v227
  ds_read_b32 v76, v228
  ds_read_b32 v77, v229
  ds_read_b32 v78, v230
  ds_read_b32 v79, v231
  s_waitcnt lgkmcnt(4)
  ds_read_b32 v80, v232
  s_waitcnt lgkmcnt(0)
  v_lshlrev_b32 v46, 6, v1
  v_add_u32 v46, s17, v46
  v_cvt_pk_bf16_f32 v84, v48, v49
  v_cvt_pk_bf16_f32 v88, v49, v50
  v_cvt_pk_bf16_f32 v85, v50, v51
  v_cvt_pk_bf16_f32 v89, v51, v52
  v_cvt_pk_bf16_f32 v86, v52, v53
  v_cvt_pk_bf16_f32 v90, v53, v54
  v_cvt_pk_bf16_f32 v87, v54, v55
  v_cvt_pk_bf16_f32 v91, v55, v56
  ds_write_b128 v46, v[84:87] offset:4608
  ds_write_b128 v46, v[88:91] offset:8832
  s_waitcnt lgkmcnt(0)
  v_cvt_pk_bf16_f32 v84, v56, v57
  v_cvt_pk_bf16_f32 v88, v57, v58
  v_cvt_pk_bf16_f32 v85, v58, v59
  v_cvt_pk_bf16_f32 v89, v59, v60
  v_cvt_pk_bf16_f32 v86, v60, v61
  v_cvt_pk_bf16_f32 v90, v61, v62
  v_cvt_pk_bf16_f32 v87, v62, v63
  v_cvt_pk_bf16_f32 v91, v63, v64
  ds_write_b128 v46, v[84:87] offset:4624
  ds_write_b128 v46, v[88:91] offset:8848
  s_waitcnt lgkmcnt(0)
  v_cvt_pk_bf16_f32 v84, v64, v65
  v_cvt_pk_bf16_f32 v88, v65, v66
  v_cvt_pk_bf16_f32 v85, v66, v67
  v_cvt_pk_bf16_f32 v89, v67, v68
  v_cvt_pk_bf16_f32 v86, v68, v69
  v_cvt_pk_bf16_f32 v90, v69, v70
  v_cvt_pk_bf16_f32 v87, v70, v71
  v_cvt_pk_bf16_f32 v91, v71, v72
  ds_write_b128 v46, v[84:87] offset:4640
  ds_write_b128 v46, v[88:91] offset:8864
  s_waitcnt lgkmcnt(0)
  v_cvt_pk_bf16_f32 v84, v72, v73
  v_cvt_pk_bf16_f32 v88, v73, v74
  v_cvt_pk_bf16_f32 v85, v74, v75
  v_cvt_pk_bf16_f32 v89, v75, v76
  v_cvt_pk_bf16_f32 v86, v76, v77
  v_cvt_pk_bf16_f32 v90, v77, v78
  v_cvt_pk_bf16_f32 v87, v78, v79
  v_cvt_pk_bf16_f32 v91, v79, v80
  ds_write_b128 v46, v[84:87] offset:4656
  ds_write_b128 v46, v[88:91] offset:8880
  s_waitcnt lgkmcnt(0)
  s_barrier
  v_lshrrev_b32 v47, 1, v3
  v_sub_u32 v46, v4, v47
  v_add_u32 v46, 1, v46
  v_lshlrev_b32 v46, 5, v46
  v_and_b32 v48, 1, v3
  v_lshl_add_u32 v46, v48, 4, v46
  v_add_u32 v46, s17, v46
  ds_read_b128 a[0:3], v46 offset:32
  ds_read_b128 a[4:7], v46 offset:96
  ds_read_b128 a[8:11], v46 offset:160
  ds_read_b128 a[12:15], v46 offset:224
  ds_read_b128 a[16:19], v46 offset:288
  ds_read_b128 a[20:23], v46 offset:352
  ds_read_b128 a[24:27], v46 offset:416
  ds_read_b128 a[28:31], v46 offset:480
  s_waitcnt lgkmcnt(4)
  ds_read_b128 a[32:35], v46 offset:544
  ds_read_b128 a[36:39], v46 offset:608
  ds_read_b128 a[40:43], v46 offset:672
  ds_read_b128 a[44:47], v46 offset:736
  ds_read_b128 a[48:51], v46 offset:800
  ds_read_b128 a[52:55], v46 offset:864
  ds_read_b128 a[56:59], v46 offset:928
  ds_read_b128 a[60:63], v46 offset:992
  s_waitcnt lgkmcnt(4)
  ds_read_b128 a[64:67], v46 offset:1056
  ds_read_b128 a[68:71], v46 offset:1120
  ds_read_b128 a[72:75], v46 offset:1184
  ds_read_b128 a[76:79], v46 offset:1248
  ds_read_b128 a[80:83], v46 offset:1312
  ds_read_b128 a[84:87], v46 offset:1376
  ds_read_b128 a[88:91], v46 offset:1440
  ds_read_b128 a[92:95], v46 offset:1504
  s_waitcnt lgkmcnt(4)
  ds_read_b128 a[96:99], v46 offset:1568
  ds_read_b128 a[100:103], v46 offset:1632
  ds_read_b128 a[104:107], v46 offset:1696
  ds_read_b128 a[108:111], v46 offset:1760
  ds_read_b128 a[112:115], v46 offset:1824
  ds_read_b128 a[116:119], v46 offset:1888
  ds_read_b128 a[120:123], v46 offset:1952
  ds_read_b128 a[124:127], v46 offset:2016
  s_waitcnt lgkmcnt(4)
  ds_read_b128 a[128:131], v46 offset:2080
  ds_read_b128 a[132:135], v46 offset:2144
  ds_read_b128 a[136:139], v46 offset:2208
  ds_read_b128 a[140:143], v46 offset:2272
  ds_read_b128 a[144:147], v46 offset:2336
  ds_read_b128 a[148:151], v46 offset:2400
  ds_read_b128 a[152:155], v46 offset:2464
  ds_read_b128 a[156:159], v46 offset:2528
  s_waitcnt lgkmcnt(4)
  ds_read_b128 a[160:163], v46 offset:2592
  ds_read_b128 a[164:167], v46 offset:2656
  ds_read_b128 a[168:171], v46 offset:2720
  ds_read_b128 a[172:175], v46 offset:2784
  ds_read_b128 a[176:179], v46 offset:2848
  ds_read_b128 a[180:183], v46 offset:2912
  ds_read_b128 a[184:187], v46 offset:2976
  ds_read_b128 a[188:191], v46 offset:3040
  s_waitcnt lgkmcnt(4)
  ds_read_b128 a[192:195], v46 offset:3104
  ds_read_b128 a[196:199], v46 offset:3168
  ds_read_b128 a[200:203], v46 offset:3232
  ds_read_b128 a[204:207], v46 offset:3296
  ds_read_b128 a[208:211], v46 offset:3360
  ds_read_b128 a[212:215], v46 offset:3424
  ds_read_b128 a[216:219], v46 offset:3488
  ds_read_b128 a[220:223], v46 offset:3552
  s_waitcnt lgkmcnt(4)
  ds_read_b128 a[224:227], v46 offset:3616
  ds_read_b128 a[228:231], v46 offset:3680
  ds_read_b128 a[232:235], v46 offset:3744
  ds_read_b128 a[236:239], v46 offset:3808
  ds_read_b128 a[240:243], v46 offset:3872
  ds_read_b128 a[244:247], v46 offset:3936
  ds_read_b128 a[248:251], v46 offset:4000
  ds_read_b128 a[252:255], v46 offset:4064
  s_waitcnt lgkmcnt(4)
  v_lshlrev_b32 v49, 4, v47
  v_add_u32 v49, v49, v4
  v_sub_u32 v49, 2047, v49
  v_lshl_add_u32 v49, v48, 3, v49
  v_and_b32 v50, 1, v49
  v_lshrrev_b32 v49, 1, v49
  v_lshlrev_b32 v49, 2, v49
  v_mul_u32_u24 v50, 4224, v50
  v_add3_u32 v49, v49, v50, s17
  v_add_u32 v49, 4608, v49
  v_subrev_u32 v52, 896, v49
  v_subrev_u32 v53, 1856, v49
  v_subrev_u32 v54, 2816, v49
  v_subrev_u32 v55, 3776, v49
  v_subrev_u32 v56, 4736, v49
  s_waitcnt lgkmcnt(0)
  ds_read2_b32 v[92:93], v52 offset0:224 offset1:225
  ds_read2_b32 v[94:95], v52 offset0:226 offset1:227
  ds_read2_b32 v[96:97], v52 offset0:208 offset1:209
  ds_read2_b32 v[98:99], v52 offset0:210 offset1:211
  ds_read2_b32 v[100:101], v52 offset0:192 offset1:193
  ds_read2_b32 v[102:103], v52 offset0:194 offset1:195
  ds_read2_b32 v[104:105], v52 offset0:176 offset1:177
  ds_read2_b32 v[106:107], v52 offset0:178 offset1:179
  s_waitcnt lgkmcnt(6)
  v_mfma_f32_16x16x32_bf16 v[60:63], v[92:95], a[28:31], 0
  v_mfma_f32_16x16x32_bf16 v[64:67], v[92:95], a[60:63], 0
  v_mfma_f32_16x16x32_bf16 v[68:71], v[92:95], a[92:95], 0
  v_mfma_f32_16x16x32_bf16 v[72:75], v[92:95], a[124:127], 0
  v_mfma_f32_16x16x32_bf16 v[76:79], v[92:95], a[156:159], 0
  v_mfma_f32_16x16x32_bf16 v[80:83], v[92:95], a[188:191], 0
  v_mfma_f32_16x16x32_bf16 v[84:87], v[92:95], a[220:223], 0
  v_mfma_f32_16x16x32_bf16 v[88:91], v[92:95], a[252:255], 0
  ds_read2_b32 v[92:93], v52 offset0:160 offset1:161
  ds_read2_b32 v[94:95], v52 offset0:162 offset1:163
  s_waitcnt lgkmcnt(6)
  v_mfma_f32_16x16x32_bf16 v[60:63], v[96:99], a[24:27], v[60:63]
  v_mfma_f32_16x16x32_bf16 v[64:67], v[96:99], a[56:59], v[64:67]
  v_mfma_f32_16x16x32_bf16 v[68:71], v[96:99], a[88:91], v[68:71]
  v_mfma_f32_16x16x32_bf16 v[72:75], v[96:99], a[120:123], v[72:75]
  v_mfma_f32_16x16x32_bf16 v[76:79], v[96:99], a[152:155], v[76:79]
  v_mfma_f32_16x16x32_bf16 v[80:83], v[96:99], a[184:187], v[80:83]
  v_mfma_f32_16x16x32_bf16 v[84:87], v[96:99], a[216:219], v[84:87]
  v_mfma_f32_16x16x32_bf16 v[88:91], v[96:99], a[248:251], v[88:91]
  ds_read2_b32 v[96:97], v52 offset0:144 offset1:145
  ds_read2_b32 v[98:99], v52 offset0:146 offset1:147
  s_waitcnt lgkmcnt(6)
  v_mfma_f32_16x16x32_bf16 v[60:63], v[100:103], a[20:23], v[60:63]
  v_mfma_f32_16x16x32_bf16 v[64:67], v[100:103], a[52:55], v[64:67]
  v_mfma_f32_16x16x32_bf16 v[68:71], v[100:103], a[84:87], v[68:71]
  v_mfma_f32_16x16x32_bf16 v[72:75], v[100:103], a[116:119], v[72:75]
  v_mfma_f32_16x16x32_bf16 v[76:79], v[100:103], a[148:151], v[76:79]
  v_mfma_f32_16x16x32_bf16 v[80:83], v[100:103], a[180:183], v[80:83]
  v_mfma_f32_16x16x32_bf16 v[84:87], v[100:103], a[212:215], v[84:87]
  v_mfma_f32_16x16x32_bf16 v[88:91], v[100:103], a[244:247], v[88:91]
  ds_read2_b32 v[100:101], v52 offset0:128 offset1:129
  ds_read2_b32 v[102:103], v52 offset0:130 offset1:131
  s_waitcnt lgkmcnt(6)
  v_mfma_f32_16x16x32_bf16 v[60:63], v[104:107], a[16:19], v[60:63]
  v_mfma_f32_16x16x32_bf16 v[64:67], v[104:107], a[48:51], v[64:67]
  v_mfma_f32_16x16x32_bf16 v[68:71], v[104:107], a[80:83], v[68:71]
  v_mfma_f32_16x16x32_bf16 v[72:75], v[104:107], a[112:115], v[72:75]
  v_mfma_f32_16x16x32_bf16 v[76:79], v[104:107], a[144:147], v[76:79]
  v_mfma_f32_16x16x32_bf16 v[80:83], v[104:107], a[176:179], v[80:83]
  v_mfma_f32_16x16x32_bf16 v[84:87], v[104:107], a[208:211], v[84:87]
  v_mfma_f32_16x16x32_bf16 v[88:91], v[104:107], a[240:243], v[88:91]
  ds_read2_b32 v[104:105], v52 offset0:112 offset1:113
  ds_read2_b32 v[106:107], v52 offset0:114 offset1:115
  s_waitcnt lgkmcnt(6)
  v_mfma_f32_16x16x32_bf16 v[60:63], v[92:95], a[12:15], v[60:63]
  v_mfma_f32_16x16x32_bf16 v[64:67], v[92:95], a[44:47], v[64:67]
  v_mfma_f32_16x16x32_bf16 v[68:71], v[92:95], a[76:79], v[68:71]
  v_mfma_f32_16x16x32_bf16 v[72:75], v[92:95], a[108:111], v[72:75]
  v_mfma_f32_16x16x32_bf16 v[76:79], v[92:95], a[140:143], v[76:79]
  v_mfma_f32_16x16x32_bf16 v[80:83], v[92:95], a[172:175], v[80:83]
  v_mfma_f32_16x16x32_bf16 v[84:87], v[92:95], a[204:207], v[84:87]
  v_mfma_f32_16x16x32_bf16 v[88:91], v[92:95], a[236:239], v[88:91]
  ds_read2_b32 v[92:93], v52 offset0:96 offset1:97
  ds_read2_b32 v[94:95], v52 offset0:98 offset1:99
  s_waitcnt lgkmcnt(6)
  v_mfma_f32_16x16x32_bf16 v[60:63], v[96:99], a[8:11], v[60:63]
  v_mfma_f32_16x16x32_bf16 v[64:67], v[96:99], a[40:43], v[64:67]
  v_mfma_f32_16x16x32_bf16 v[68:71], v[96:99], a[72:75], v[68:71]
  v_mfma_f32_16x16x32_bf16 v[72:75], v[96:99], a[104:107], v[72:75]
  v_mfma_f32_16x16x32_bf16 v[76:79], v[96:99], a[136:139], v[76:79]
  v_mfma_f32_16x16x32_bf16 v[80:83], v[96:99], a[168:171], v[80:83]
  v_mfma_f32_16x16x32_bf16 v[84:87], v[96:99], a[200:203], v[84:87]
  v_mfma_f32_16x16x32_bf16 v[88:91], v[96:99], a[232:235], v[88:91]
  ds_read2_b32 v[96:97], v52 offset0:80 offset1:81
  ds_read2_b32 v[98:99], v52 offset0:82 offset1:83
  s_waitcnt lgkmcnt(6)
  v_mfma_f32_16x16x32_bf16 v[60:63], v[100:103], a[4:7], v[60:63]
  v_mfma_f32_16x16x32_bf16 v[64:67], v[100:103], a[36:39], v[64:67]
  v_mfma_f32_16x16x32_bf16 v[68:71], v[100:103], a[68:71], v[68:71]
  v_mfma_f32_16x16x32_bf16 v[72:75], v[100:103], a[100:103], v[72:75]
  v_mfma_f32_16x16x32_bf16 v[76:79], v[100:103], a[132:135], v[76:79]
  v_mfma_f32_16x16x32_bf16 v[80:83], v[100:103], a[164:167], v[80:83]
  v_mfma_f32_16x16x32_bf16 v[84:87], v[100:103], a[196:199], v[84:87]
  v_mfma_f32_16x16x32_bf16 v[88:91], v[100:103], a[228:231], v[88:91]
  ds_read2_b32 v[100:101], v52 offset0:64 offset1:65
  ds_read2_b32 v[102:103], v52 offset0:66 offset1:67
  s_waitcnt lgkmcnt(6)
  v_mfma_f32_16x16x32_bf16 v[60:63], v[104:107], a[0:3], v[60:63]
  v_mfma_f32_16x16x32_bf16 v[64:67], v[104:107], a[32:35], v[64:67]
  v_mfma_f32_16x16x32_bf16 v[68:71], v[104:107], a[64:67], v[68:71]
  v_mfma_f32_16x16x32_bf16 v[72:75], v[104:107], a[96:99], v[72:75]
  v_mfma_f32_16x16x32_bf16 v[76:79], v[104:107], a[128:131], v[76:79]
  v_mfma_f32_16x16x32_bf16 v[80:83], v[104:107], a[160:163], v[80:83]
  v_mfma_f32_16x16x32_bf16 v[84:87], v[104:107], a[192:195], v[84:87]
  v_mfma_f32_16x16x32_bf16 v[88:91], v[104:107], a[224:227], v[88:91]
  ds_read2_b32 v[104:105], v52 offset0:48 offset1:49
  ds_read2_b32 v[106:107], v52 offset0:50 offset1:51
  s_waitcnt lgkmcnt(6)
  v_mfma_f32_16x16x32_bf16 v[64:67], v[92:95], a[28:31], v[64:67]
  v_mfma_f32_16x16x32_bf16 v[68:71], v[92:95], a[60:63], v[68:71]
  v_mfma_f32_16x16x32_bf16 v[72:75], v[92:95], a[92:95], v[72:75]
  v_mfma_f32_16x16x32_bf16 v[76:79], v[92:95], a[124:127], v[76:79]
  v_mfma_f32_16x16x32_bf16 v[80:83], v[92:95], a[156:159], v[80:83]
  v_mfma_f32_16x16x32_bf16 v[84:87], v[92:95], a[188:191], v[84:87]
  v_mfma_f32_16x16x32_bf16 v[88:91], v[92:95], a[220:223], v[88:91]
  ds_read2_b32 v[92:93], v52 offset0:32 offset1:33
  ds_read2_b32 v[94:95], v52 offset0:34 offset1:35
  s_waitcnt lgkmcnt(6)
  v_mfma_f32_16x16x32_bf16 v[64:67], v[96:99], a[24:27], v[64:67]
  v_mfma_f32_16x16x32_bf16 v[68:71], v[96:99], a[56:59], v[68:71]
  v_mfma_f32_16x16x32_bf16 v[72:75], v[96:99], a[88:91], v[72:75]
  v_mfma_f32_16x16x32_bf16 v[76:79], v[96:99], a[120:123], v[76:79]
  v_mfma_f32_16x16x32_bf16 v[80:83], v[96:99], a[152:155], v[80:83]
  v_mfma_f32_16x16x32_bf16 v[84:87], v[96:99], a[184:187], v[84:87]
  v_mfma_f32_16x16x32_bf16 v[88:91], v[96:99], a[216:219], v[88:91]
  ds_read2_b32 v[96:97], v52 offset0:16 offset1:17
  ds_read2_b32 v[98:99], v52 offset0:18 offset1:19
  s_waitcnt lgkmcnt(6)
  v_mfma_f32_16x16x32_bf16 v[64:67], v[100:103], a[20:23], v[64:67]
  v_mfma_f32_16x16x32_bf16 v[68:71], v[100:103], a[52:55], v[68:71]
  v_mfma_f32_16x16x32_bf16 v[72:75], v[100:103], a[84:87], v[72:75]
  v_mfma_f32_16x16x32_bf16 v[76:79], v[100:103], a[116:119], v[76:79]
  v_mfma_f32_16x16x32_bf16 v[80:83], v[100:103], a[148:151], v[80:83]
  v_mfma_f32_16x16x32_bf16 v[84:87], v[100:103], a[180:183], v[84:87]
  v_mfma_f32_16x16x32_bf16 v[88:91], v[100:103], a[212:215], v[88:91]
  ds_read2_b32 v[100:101], v52 offset0:0 offset1:1
  ds_read2_b32 v[102:103], v52 offset0:2 offset1:3
  s_waitcnt lgkmcnt(6)
  v_mfma_f32_16x16x32_bf16 v[64:67], v[104:107], a[16:19], v[64:67]
  v_mfma_f32_16x16x32_bf16 v[68:71], v[104:107], a[48:51], v[68:71]
  v_mfma_f32_16x16x32_bf16 v[72:75], v[104:107], a[80:83], v[72:75]
  v_mfma_f32_16x16x32_bf16 v[76:79], v[104:107], a[112:115], v[76:79]
  v_mfma_f32_16x16x32_bf16 v[80:83], v[104:107], a[144:147], v[80:83]
  v_mfma_f32_16x16x32_bf16 v[84:87], v[104:107], a[176:179], v[84:87]
  v_mfma_f32_16x16x32_bf16 v[88:91], v[104:107], a[208:211], v[88:91]
  ds_read2_b32 v[104:105], v53 offset0:224 offset1:225
  ds_read2_b32 v[106:107], v53 offset0:226 offset1:227
  s_waitcnt lgkmcnt(6)
  v_mfma_f32_16x16x32_bf16 v[64:67], v[92:95], a[12:15], v[64:67]
  v_mfma_f32_16x16x32_bf16 v[68:71], v[92:95], a[44:47], v[68:71]
  v_mfma_f32_16x16x32_bf16 v[72:75], v[92:95], a[76:79], v[72:75]
  v_mfma_f32_16x16x32_bf16 v[76:79], v[92:95], a[108:111], v[76:79]
  v_mfma_f32_16x16x32_bf16 v[80:83], v[92:95], a[140:143], v[80:83]
  v_mfma_f32_16x16x32_bf16 v[84:87], v[92:95], a[172:175], v[84:87]
  v_mfma_f32_16x16x32_bf16 v[88:91], v[92:95], a[204:207], v[88:91]
  ds_read2_b32 v[92:93], v53 offset0:208 offset1:209
  ds_read2_b32 v[94:95], v53 offset0:210 offset1:211
  s_waitcnt lgkmcnt(6)
  v_mfma_f32_16x16x32_bf16 v[64:67], v[96:99], a[8:11], v[64:67]
  v_mfma_f32_16x16x32_bf16 v[68:71], v[96:99], a[40:43], v[68:71]
  v_mfma_f32_16x16x32_bf16 v[72:75], v[96:99], a[72:75], v[72:75]
  v_mfma_f32_16x16x32_bf16 v[76:79], v[96:99], a[104:107], v[76:79]
  v_mfma_f32_16x16x32_bf16 v[80:83], v[96:99], a[136:139], v[80:83]
  v_mfma_f32_16x16x32_bf16 v[84:87], v[96:99], a[168:171], v[84:87]
  v_mfma_f32_16x16x32_bf16 v[88:91], v[96:99], a[200:203], v[88:91]
  ds_read2_b32 v[96:97], v53 offset0:192 offset1:193
  ds_read2_b32 v[98:99], v53 offset0:194 offset1:195
  s_waitcnt lgkmcnt(6)
  v_mfma_f32_16x16x32_bf16 v[64:67], v[100:103], a[4:7], v[64:67]
  v_mfma_f32_16x16x32_bf16 v[68:71], v[100:103], a[36:39], v[68:71]
  v_mfma_f32_16x16x32_bf16 v[72:75], v[100:103], a[68:71], v[72:75]
  v_mfma_f32_16x16x32_bf16 v[76:79], v[100:103], a[100:103], v[76:79]
  v_mfma_f32_16x16x32_bf16 v[80:83], v[100:103], a[132:135], v[80:83]
  v_mfma_f32_16x16x32_bf16 v[84:87], v[100:103], a[164:167], v[84:87]
  v_mfma_f32_16x16x32_bf16 v[88:91], v[100:103], a[196:199], v[88:91]
  ds_read2_b32 v[100:101], v53 offset0:176 offset1:177
  ds_read2_b32 v[102:103], v53 offset0:178 offset1:179
  s_waitcnt lgkmcnt(6)
  v_mfma_f32_16x16x32_bf16 v[64:67], v[104:107], a[0:3], v[64:67]
  v_mfma_f32_16x16x32_bf16 v[68:71], v[104:107], a[32:35], v[68:71]
  v_mfma_f32_16x16x32_bf16 v[72:75], v[104:107], a[64:67], v[72:75]
  v_mfma_f32_16x16x32_bf16 v[76:79], v[104:107], a[96:99], v[76:79]
  v_mfma_f32_16x16x32_bf16 v[80:83], v[104:107], a[128:131], v[80:83]
  v_mfma_f32_16x16x32_bf16 v[84:87], v[104:107], a[160:163], v[84:87]
  v_mfma_f32_16x16x32_bf16 v[88:91], v[104:107], a[192:195], v[88:91]
  ds_read2_b32 v[104:105], v53 offset0:160 offset1:161
  ds_read2_b32 v[106:107], v53 offset0:162 offset1:163
  s_waitcnt lgkmcnt(6)
  v_mfma_f32_16x16x32_bf16 v[68:71], v[92:95], a[28:31], v[68:71]
  v_mfma_f32_16x16x32_bf16 v[72:75], v[92:95], a[60:63], v[72:75]
  v_mfma_f32_16x16x32_bf16 v[76:79], v[92:95], a[92:95], v[76:79]
  v_mfma_f32_16x16x32_bf16 v[80:83], v[92:95], a[124:127], v[80:83]
  v_mfma_f32_16x16x32_bf16 v[84:87], v[92:95], a[156:159], v[84:87]
  v_mfma_f32_16x16x32_bf16 v[88:91], v[92:95], a[188:191], v[88:91]
  ds_read2_b32 v[92:93], v53 offset0:144 offset1:145
  ds_read2_b32 v[94:95], v53 offset0:146 offset1:147
  s_waitcnt lgkmcnt(6)
  v_mfma_f32_16x16x32_bf16 v[68:71], v[96:99], a[24:27], v[68:71]
  v_mfma_f32_16x16x32_bf16 v[72:75], v[96:99], a[56:59], v[72:75]
  v_mfma_f32_16x16x32_bf16 v[76:79], v[96:99], a[88:91], v[76:79]
  v_mfma_f32_16x16x32_bf16 v[80:83], v[96:99], a[120:123], v[80:83]
  v_mfma_f32_16x16x32_bf16 v[84:87], v[96:99], a[152:155], v[84:87]
  v_mfma_f32_16x16x32_bf16 v[88:91], v[96:99], a[184:187], v[88:91]
  ds_read2_b32 v[96:97], v53 offset0:128 offset1:129
  ds_read2_b32 v[98:99], v53 offset0:130 offset1:131
  s_waitcnt lgkmcnt(6)
  v_mfma_f32_16x16x32_bf16 v[68:71], v[100:103], a[20:23], v[68:71]
  v_mfma_f32_16x16x32_bf16 v[72:75], v[100:103], a[52:55], v[72:75]
  v_mfma_f32_16x16x32_bf16 v[76:79], v[100:103], a[84:87], v[76:79]
  v_mfma_f32_16x16x32_bf16 v[80:83], v[100:103], a[116:119], v[80:83]
  v_mfma_f32_16x16x32_bf16 v[84:87], v[100:103], a[148:151], v[84:87]
  v_mfma_f32_16x16x32_bf16 v[88:91], v[100:103], a[180:183], v[88:91]
  ds_read2_b32 v[100:101], v53 offset0:112 offset1:113
  ds_read2_b32 v[102:103], v53 offset0:114 offset1:115
  s_waitcnt lgkmcnt(6)
  v_mfma_f32_16x16x32_bf16 v[68:71], v[104:107], a[16:19], v[68:71]
  v_mfma_f32_16x16x32_bf16 v[72:75], v[104:107], a[48:51], v[72:75]
  v_mfma_f32_16x16x32_bf16 v[76:79], v[104:107], a[80:83], v[76:79]
  v_mfma_f32_16x16x32_bf16 v[80:83], v[104:107], a[112:115], v[80:83]
  v_mfma_f32_16x16x32_bf16 v[84:87], v[104:107], a[144:147], v[84:87]
  v_mfma_f32_16x16x32_bf16 v[88:91], v[104:107], a[176:179], v[88:91]
  ds_read2_b32 v[104:105], v53 offset0:96 offset1:97
  ds_read2_b32 v[106:107], v53 offset0:98 offset1:99
  s_waitcnt lgkmcnt(6)
  v_mfma_f32_16x16x32_bf16 v[68:71], v[92:95], a[12:15], v[68:71]
  v_mfma_f32_16x16x32_bf16 v[72:75], v[92:95], a[44:47], v[72:75]
  v_mfma_f32_16x16x32_bf16 v[76:79], v[92:95], a[76:79], v[76:79]
  v_mfma_f32_16x16x32_bf16 v[80:83], v[92:95], a[108:111], v[80:83]
  v_mfma_f32_16x16x32_bf16 v[84:87], v[92:95], a[140:143], v[84:87]
  v_mfma_f32_16x16x32_bf16 v[88:91], v[92:95], a[172:175], v[88:91]
  ds_read2_b32 v[92:93], v53 offset0:80 offset1:81
  ds_read2_b32 v[94:95], v53 offset0:82 offset1:83
  s_waitcnt lgkmcnt(6)
  v_mfma_f32_16x16x32_bf16 v[68:71], v[96:99], a[8:11], v[68:71]
  v_mfma_f32_16x16x32_bf16 v[72:75], v[96:99], a[40:43], v[72:75]
  v_mfma_f32_16x16x32_bf16 v[76:79], v[96:99], a[72:75], v[76:79]
  v_mfma_f32_16x16x32_bf16 v[80:83], v[96:99], a[104:107], v[80:83]
  v_mfma_f32_16x16x32_bf16 v[84:87], v[96:99], a[136:139], v[84:87]
  v_mfma_f32_16x16x32_bf16 v[88:91], v[96:99], a[168:171], v[88:91]
  ds_read2_b32 v[96:97], v53 offset0:64 offset1:65
  ds_read2_b32 v[98:99], v53 offset0:66 offset1:67
  s_waitcnt lgkmcnt(6)
  v_mfma_f32_16x16x32_bf16 v[68:71], v[100:103], a[4:7], v[68:71]
  v_mfma_f32_16x16x32_bf16 v[72:75], v[100:103], a[36:39], v[72:75]
  v_mfma_f32_16x16x32_bf16 v[76:79], v[100:103], a[68:71], v[76:79]
  v_mfma_f32_16x16x32_bf16 v[80:83], v[100:103], a[100:103], v[80:83]
  v_mfma_f32_16x16x32_bf16 v[84:87], v[100:103], a[132:135], v[84:87]
  v_mfma_f32_16x16x32_bf16 v[88:91], v[100:103], a[164:167], v[88:91]
  ds_read2_b32 v[100:101], v53 offset0:48 offset1:49
  ds_read2_b32 v[102:103], v53 offset0:50 offset1:51
  s_waitcnt lgkmcnt(6)
  v_mfma_f32_16x16x32_bf16 v[68:71], v[104:107], a[0:3], v[68:71]
  v_mfma_f32_16x16x32_bf16 v[72:75], v[104:107], a[32:35], v[72:75]
  v_mfma_f32_16x16x32_bf16 v[76:79], v[104:107], a[64:67], v[76:79]
  v_mfma_f32_16x16x32_bf16 v[80:83], v[104:107], a[96:99], v[80:83]
  v_mfma_f32_16x16x32_bf16 v[84:87], v[104:107], a[128:131], v[84:87]
  v_mfma_f32_16x16x32_bf16 v[88:91], v[104:107], a[160:163], v[88:91]
  ds_read2_b32 v[104:105], v53 offset0:32 offset1:33
  ds_read2_b32 v[106:107], v53 offset0:34 offset1:35
  s_waitcnt lgkmcnt(6)
  v_mfma_f32_16x16x32_bf16 v[72:75], v[92:95], a[28:31], v[72:75]
  v_mfma_f32_16x16x32_bf16 v[76:79], v[92:95], a[60:63], v[76:79]
  v_mfma_f32_16x16x32_bf16 v[80:83], v[92:95], a[92:95], v[80:83]
  v_mfma_f32_16x16x32_bf16 v[84:87], v[92:95], a[124:127], v[84:87]
  v_mfma_f32_16x16x32_bf16 v[88:91], v[92:95], a[156:159], v[88:91]
  ds_read2_b32 v[92:93], v53 offset0:16 offset1:17
  ds_read2_b32 v[94:95], v53 offset0:18 offset1:19
  s_waitcnt lgkmcnt(6)
  v_mfma_f32_16x16x32_bf16 v[72:75], v[96:99], a[24:27], v[72:75]
  v_mfma_f32_16x16x32_bf16 v[76:79], v[96:99], a[56:59], v[76:79]
  v_mfma_f32_16x16x32_bf16 v[80:83], v[96:99], a[88:91], v[80:83]
  v_mfma_f32_16x16x32_bf16 v[84:87], v[96:99], a[120:123], v[84:87]
  v_mfma_f32_16x16x32_bf16 v[88:91], v[96:99], a[152:155], v[88:91]
  ds_read2_b32 v[96:97], v53 offset0:0 offset1:1
  ds_read2_b32 v[98:99], v53 offset0:2 offset1:3
  s_waitcnt lgkmcnt(6)
  v_mfma_f32_16x16x32_bf16 v[72:75], v[100:103], a[20:23], v[72:75]
  v_mfma_f32_16x16x32_bf16 v[76:79], v[100:103], a[52:55], v[76:79]
  v_mfma_f32_16x16x32_bf16 v[80:83], v[100:103], a[84:87], v[80:83]
  v_mfma_f32_16x16x32_bf16 v[84:87], v[100:103], a[116:119], v[84:87]
  v_mfma_f32_16x16x32_bf16 v[88:91], v[100:103], a[148:151], v[88:91]
  ds_read2_b32 v[100:101], v54 offset0:224 offset1:225
  ds_read2_b32 v[102:103], v54 offset0:226 offset1:227
  s_waitcnt lgkmcnt(6)
  v_mfma_f32_16x16x32_bf16 v[72:75], v[104:107], a[16:19], v[72:75]
  v_mfma_f32_16x16x32_bf16 v[76:79], v[104:107], a[48:51], v[76:79]
  v_mfma_f32_16x16x32_bf16 v[80:83], v[104:107], a[80:83], v[80:83]
  v_mfma_f32_16x16x32_bf16 v[84:87], v[104:107], a[112:115], v[84:87]
  v_mfma_f32_16x16x32_bf16 v[88:91], v[104:107], a[144:147], v[88:91]
  ds_read2_b32 v[104:105], v54 offset0:208 offset1:209
  ds_read2_b32 v[106:107], v54 offset0:210 offset1:211
  s_waitcnt lgkmcnt(6)
  v_mfma_f32_16x16x32_bf16 v[72:75], v[92:95], a[12:15], v[72:75]
  v_mfma_f32_16x16x32_bf16 v[76:79], v[92:95], a[44:47], v[76:79]
  v_mfma_f32_16x16x32_bf16 v[80:83], v[92:95], a[76:79], v[80:83]
  v_mfma_f32_16x16x32_bf16 v[84:87], v[92:95], a[108:111], v[84:87]
  v_mfma_f32_16x16x32_bf16 v[88:91], v[92:95], a[140:143], v[88:91]
  ds_read2_b32 v[92:93], v54 offset0:192 offset1:193
  ds_read2_b32 v[94:95], v54 offset0:194 offset1:195
  s_waitcnt lgkmcnt(6)
  v_mfma_f32_16x16x32_bf16 v[72:75], v[96:99], a[8:11], v[72:75]
  v_mfma_f32_16x16x32_bf16 v[76:79], v[96:99], a[40:43], v[76:79]
  v_mfma_f32_16x16x32_bf16 v[80:83], v[96:99], a[72:75], v[80:83]
  v_mfma_f32_16x16x32_bf16 v[84:87], v[96:99], a[104:107], v[84:87]
  v_mfma_f32_16x16x32_bf16 v[88:91], v[96:99], a[136:139], v[88:91]
  ds_read2_b32 v[96:97], v54 offset0:176 offset1:177
  ds_read2_b32 v[98:99], v54 offset0:178 offset1:179
  s_waitcnt lgkmcnt(6)
  v_mfma_f32_16x16x32_bf16 v[72:75], v[100:103], a[4:7], v[72:75]
  v_mfma_f32_16x16x32_bf16 v[76:79], v[100:103], a[36:39], v[76:79]
  v_mfma_f32_16x16x32_bf16 v[80:83], v[100:103], a[68:71], v[80:83]
  v_mfma_f32_16x16x32_bf16 v[84:87], v[100:103], a[100:103], v[84:87]
  v_mfma_f32_16x16x32_bf16 v[88:91], v[100:103], a[132:135], v[88:91]
  ds_read2_b32 v[100:101], v54 offset0:160 offset1:161
  ds_read2_b32 v[102:103], v54 offset0:162 offset1:163
  s_waitcnt lgkmcnt(6)
  v_mfma_f32_16x16x32_bf16 v[72:75], v[104:107], a[0:3], v[72:75]
  v_mfma_f32_16x16x32_bf16 v[76:79], v[104:107], a[32:35], v[76:79]
  v_mfma_f32_16x16x32_bf16 v[80:83], v[104:107], a[64:67], v[80:83]
  v_mfma_f32_16x16x32_bf16 v[84:87], v[104:107], a[96:99], v[84:87]
  v_mfma_f32_16x16x32_bf16 v[88:91], v[104:107], a[128:131], v[88:91]
  ds_read2_b32 v[104:105], v54 offset0:144 offset1:145
  ds_read2_b32 v[106:107], v54 offset0:146 offset1:147
  s_waitcnt lgkmcnt(6)
  v_mfma_f32_16x16x32_bf16 v[76:79], v[92:95], a[28:31], v[76:79]
  v_mfma_f32_16x16x32_bf16 v[80:83], v[92:95], a[60:63], v[80:83]
  v_mfma_f32_16x16x32_bf16 v[84:87], v[92:95], a[92:95], v[84:87]
  v_mfma_f32_16x16x32_bf16 v[88:91], v[92:95], a[124:127], v[88:91]
  ds_read2_b32 v[92:93], v54 offset0:128 offset1:129
  ds_read2_b32 v[94:95], v54 offset0:130 offset1:131
  s_waitcnt lgkmcnt(6)
  v_mfma_f32_16x16x32_bf16 v[76:79], v[96:99], a[24:27], v[76:79]
  v_mfma_f32_16x16x32_bf16 v[80:83], v[96:99], a[56:59], v[80:83]
  v_mfma_f32_16x16x32_bf16 v[84:87], v[96:99], a[88:91], v[84:87]
  v_mfma_f32_16x16x32_bf16 v[88:91], v[96:99], a[120:123], v[88:91]
  ds_read2_b32 v[96:97], v54 offset0:112 offset1:113
  ds_read2_b32 v[98:99], v54 offset0:114 offset1:115
  s_waitcnt lgkmcnt(6)
  v_mfma_f32_16x16x32_bf16 v[76:79], v[100:103], a[20:23], v[76:79]
  v_mfma_f32_16x16x32_bf16 v[80:83], v[100:103], a[52:55], v[80:83]
  v_mfma_f32_16x16x32_bf16 v[84:87], v[100:103], a[84:87], v[84:87]
  v_mfma_f32_16x16x32_bf16 v[88:91], v[100:103], a[116:119], v[88:91]
  ds_read2_b32 v[100:101], v54 offset0:96 offset1:97
  ds_read2_b32 v[102:103], v54 offset0:98 offset1:99
  s_waitcnt lgkmcnt(6)
  v_mfma_f32_16x16x32_bf16 v[76:79], v[104:107], a[16:19], v[76:79]
  v_mfma_f32_16x16x32_bf16 v[80:83], v[104:107], a[48:51], v[80:83]
  v_mfma_f32_16x16x32_bf16 v[84:87], v[104:107], a[80:83], v[84:87]
  v_mfma_f32_16x16x32_bf16 v[88:91], v[104:107], a[112:115], v[88:91]
  ds_read2_b32 v[104:105], v54 offset0:80 offset1:81
  ds_read2_b32 v[106:107], v54 offset0:82 offset1:83
  s_waitcnt lgkmcnt(6)
  v_mfma_f32_16x16x32_bf16 v[76:79], v[92:95], a[12:15], v[76:79]
  v_mfma_f32_16x16x32_bf16 v[80:83], v[92:95], a[44:47], v[80:83]
  v_mfma_f32_16x16x32_bf16 v[84:87], v[92:95], a[76:79], v[84:87]
  v_mfma_f32_16x16x32_bf16 v[88:91], v[92:95], a[108:111], v[88:91]
  ds_read2_b32 v[92:93], v54 offset0:64 offset1:65
  ds_read2_b32 v[94:95], v54 offset0:66 offset1:67
  s_waitcnt lgkmcnt(6)
  v_mfma_f32_16x16x32_bf16 v[76:79], v[96:99], a[8:11], v[76:79]
  v_mfma_f32_16x16x32_bf16 v[80:83], v[96:99], a[40:43], v[80:83]
  v_mfma_f32_16x16x32_bf16 v[84:87], v[96:99], a[72:75], v[84:87]
  v_mfma_f32_16x16x32_bf16 v[88:91], v[96:99], a[104:107], v[88:91]
  ds_read2_b32 v[96:97], v54 offset0:48 offset1:49
  ds_read2_b32 v[98:99], v54 offset0:50 offset1:51
  s_waitcnt lgkmcnt(6)
  v_mfma_f32_16x16x32_bf16 v[76:79], v[100:103], a[4:7], v[76:79]
  v_mfma_f32_16x16x32_bf16 v[80:83], v[100:103], a[36:39], v[80:83]
  v_mfma_f32_16x16x32_bf16 v[84:87], v[100:103], a[68:71], v[84:87]
  v_mfma_f32_16x16x32_bf16 v[88:91], v[100:103], a[100:103], v[88:91]
  ds_read2_b32 v[100:101], v54 offset0:32 offset1:33
  ds_read2_b32 v[102:103], v54 offset0:34 offset1:35
  s_waitcnt lgkmcnt(6)
  v_mfma_f32_16x16x32_bf16 v[76:79], v[104:107], a[0:3], v[76:79]
  v_mfma_f32_16x16x32_bf16 v[80:83], v[104:107], a[32:35], v[80:83]
  v_mfma_f32_16x16x32_bf16 v[84:87], v[104:107], a[64:67], v[84:87]
  v_mfma_f32_16x16x32_bf16 v[88:91], v[104:107], a[96:99], v[88:91]
  ds_read2_b32 v[104:105], v54 offset0:16 offset1:17
  ds_read2_b32 v[106:107], v54 offset0:18 offset1:19
  s_waitcnt lgkmcnt(6)
  v_mfma_f32_16x16x32_bf16 v[80:83], v[92:95], a[28:31], v[80:83]
  v_mfma_f32_16x16x32_bf16 v[84:87], v[92:95], a[60:63], v[84:87]
  v_mfma_f32_16x16x32_bf16 v[88:91], v[92:95], a[92:95], v[88:91]
  ds_read2_b32 v[92:93], v54 offset0:0 offset1:1
  ds_read2_b32 v[94:95], v54 offset0:2 offset1:3
  s_waitcnt lgkmcnt(6)
  v_mfma_f32_16x16x32_bf16 v[80:83], v[96:99], a[24:27], v[80:83]
  v_mfma_f32_16x16x32_bf16 v[84:87], v[96:99], a[56:59], v[84:87]
  v_mfma_f32_16x16x32_bf16 v[88:91], v[96:99], a[88:91], v[88:91]
  ds_read2_b32 v[96:97], v55 offset0:224 offset1:225
  ds_read2_b32 v[98:99], v55 offset0:226 offset1:227
  s_waitcnt lgkmcnt(6)
  v_mfma_f32_16x16x32_bf16 v[80:83], v[100:103], a[20:23], v[80:83]
  v_mfma_f32_16x16x32_bf16 v[84:87], v[100:103], a[52:55], v[84:87]
  v_mfma_f32_16x16x32_bf16 v[88:91], v[100:103], a[84:87], v[88:91]
  ds_read2_b32 v[100:101], v55 offset0:208 offset1:209
  ds_read2_b32 v[102:103], v55 offset0:210 offset1:211
  s_waitcnt lgkmcnt(6)
  v_mfma_f32_16x16x32_bf16 v[80:83], v[104:107], a[16:19], v[80:83]
  v_mfma_f32_16x16x32_bf16 v[84:87], v[104:107], a[48:51], v[84:87]
  v_mfma_f32_16x16x32_bf16 v[88:91], v[104:107], a[80:83], v[88:91]
  ds_read2_b32 v[104:105], v55 offset0:192 offset1:193
  ds_read2_b32 v[106:107], v55 offset0:194 offset1:195
  s_waitcnt lgkmcnt(6)
  v_mfma_f32_16x16x32_bf16 v[80:83], v[92:95], a[12:15], v[80:83]
  v_mfma_f32_16x16x32_bf16 v[84:87], v[92:95], a[44:47], v[84:87]
  v_mfma_f32_16x16x32_bf16 v[88:91], v[92:95], a[76:79], v[88:91]
  ds_read2_b32 v[92:93], v55 offset0:176 offset1:177
  ds_read2_b32 v[94:95], v55 offset0:178 offset1:179
  s_waitcnt lgkmcnt(6)
  v_mfma_f32_16x16x32_bf16 v[80:83], v[96:99], a[8:11], v[80:83]
  v_mfma_f32_16x16x32_bf16 v[84:87], v[96:99], a[40:43], v[84:87]
  v_mfma_f32_16x16x32_bf16 v[88:91], v[96:99], a[72:75], v[88:91]
  ds_read2_b32 v[96:97], v55 offset0:160 offset1:161
  ds_read2_b32 v[98:99], v55 offset0:162 offset1:163
  s_waitcnt lgkmcnt(6)
  v_mfma_f32_16x16x32_bf16 v[80:83], v[100:103], a[4:7], v[80:83]
  v_mfma_f32_16x16x32_bf16 v[84:87], v[100:103], a[36:39], v[84:87]
  v_mfma_f32_16x16x32_bf16 v[88:91], v[100:103], a[68:71], v[88:91]
  ds_read2_b32 v[100:101], v55 offset0:144 offset1:145
  ds_read2_b32 v[102:103], v55 offset0:146 offset1:147
  s_waitcnt lgkmcnt(6)
  v_mfma_f32_16x16x32_bf16 v[80:83], v[104:107], a[0:3], v[80:83]
  v_mfma_f32_16x16x32_bf16 v[84:87], v[104:107], a[32:35], v[84:87]
  v_mfma_f32_16x16x32_bf16 v[88:91], v[104:107], a[64:67], v[88:91]
  ds_read2_b32 v[104:105], v55 offset0:128 offset1:129
  ds_read2_b32 v[106:107], v55 offset0:130 offset1:131
  s_waitcnt lgkmcnt(6)
  v_mfma_f32_16x16x32_bf16 v[84:87], v[92:95], a[28:31], v[84:87]
  v_mfma_f32_16x16x32_bf16 v[88:91], v[92:95], a[60:63], v[88:91]
  ds_read2_b32 v[92:93], v55 offset0:112 offset1:113
  ds_read2_b32 v[94:95], v55 offset0:114 offset1:115
  s_waitcnt lgkmcnt(6)
  v_mfma_f32_16x16x32_bf16 v[84:87], v[96:99], a[24:27], v[84:87]
  v_mfma_f32_16x16x32_bf16 v[88:91], v[96:99], a[56:59], v[88:91]
  ds_read2_b32 v[96:97], v55 offset0:96 offset1:97
  ds_read2_b32 v[98:99], v55 offset0:98 offset1:99
  s_waitcnt lgkmcnt(6)
  v_mfma_f32_16x16x32_bf16 v[84:87], v[100:103], a[20:23], v[84:87]
  v_mfma_f32_16x16x32_bf16 v[88:91], v[100:103], a[52:55], v[88:91]
  ds_read2_b32 v[100:101], v55 offset0:80 offset1:81
  ds_read2_b32 v[102:103], v55 offset0:82 offset1:83
  s_waitcnt lgkmcnt(6)
  v_mfma_f32_16x16x32_bf16 v[84:87], v[104:107], a[16:19], v[84:87]
  v_mfma_f32_16x16x32_bf16 v[88:91], v[104:107], a[48:51], v[88:91]
  ds_read2_b32 v[104:105], v55 offset0:64 offset1:65
  ds_read2_b32 v[106:107], v55 offset0:66 offset1:67
  s_waitcnt lgkmcnt(6)
  v_mfma_f32_16x16x32_bf16 v[84:87], v[92:95], a[12:15], v[84:87]
  v_mfma_f32_16x16x32_bf16 v[88:91], v[92:95], a[44:47], v[88:91]
  ds_read2_b32 v[92:93], v55 offset0:48 offset1:49
  ds_read2_b32 v[94:95], v55 offset0:50 offset1:51
  s_waitcnt lgkmcnt(6)
  v_mfma_f32_16x16x32_bf16 v[84:87], v[96:99], a[8:11], v[84:87]
  v_mfma_f32_16x16x32_bf16 v[88:91], v[96:99], a[40:43], v[88:91]
  ds_read2_b32 v[96:97], v55 offset0:32 offset1:33
  ds_read2_b32 v[98:99], v55 offset0:34 offset1:35
  s_waitcnt lgkmcnt(6)
  v_mfma_f32_16x16x32_bf16 v[84:87], v[100:103], a[4:7], v[84:87]
  v_mfma_f32_16x16x32_bf16 v[88:91], v[100:103], a[36:39], v[88:91]
  ds_read2_b32 v[100:101], v55 offset0:16 offset1:17
  ds_read2_b32 v[102:103], v55 offset0:18 offset1:19
  s_waitcnt lgkmcnt(6)
  v_mfma_f32_16x16x32_bf16 v[84:87], v[104:107], a[0:3], v[84:87]
  v_mfma_f32_16x16x32_bf16 v[88:91], v[104:107], a[32:35], v[88:91]
  ds_read2_b32 v[104:105], v55 offset0:0 offset1:1
  ds_read2_b32 v[106:107], v55 offset0:2 offset1:3
  s_waitcnt lgkmcnt(6)
  v_mfma_f32_16x16x32_bf16 v[88:91], v[92:95], a[28:31], v[88:91]
  ds_read2_b32 v[92:93], v56 offset0:224 offset1:225
  ds_read2_b32 v[94:95], v56 offset0:226 offset1:227
  s_waitcnt lgkmcnt(6)
  v_mfma_f32_16x16x32_bf16 v[88:91], v[96:99], a[24:27], v[88:91]
  ds_read2_b32 v[96:97], v56 offset0:208 offset1:209
  ds_read2_b32 v[98:99], v56 offset0:210 offset1:211
  s_waitcnt lgkmcnt(6)
  v_mfma_f32_16x16x32_bf16 v[88:91], v[100:103], a[20:23], v[88:91]
  ds_read2_b32 v[100:101], v56 offset0:192 offset1:193
  ds_read2_b32 v[102:103], v56 offset0:194 offset1:195
  s_waitcnt lgkmcnt(6)
  v_mfma_f32_16x16x32_bf16 v[88:91], v[104:107], a[16:19], v[88:91]
  ds_read2_b32 v[104:105], v56 offset0:176 offset1:177
  ds_read2_b32 v[106:107], v56 offset0:178 offset1:179
  s_waitcnt lgkmcnt(6)
  v_mfma_f32_16x16x32_bf16 v[88:91], v[92:95], a[12:15], v[88:91]
  s_waitcnt lgkmcnt(4)
  v_mfma_f32_16x16x32_bf16 v[88:91], v[96:99], a[8:11], v[88:91]
  s_waitcnt lgkmcnt(2)
  v_mfma_f32_16x16x32_bf16 v[88:91], v[100:103], a[4:7], v[88:91]
  s_waitcnt lgkmcnt(0)
  v_mfma_f32_16x16x32_bf16 v[88:91], v[104:107], a[0:3], v[88:91]
  v_lshlrev_b32 v46, 5, v4
  v_lshl_add_u32 v46, v3, 3, v46
  v_add_u32 v46, s17, v46
  ds_read_b64 v[108:109], v46 offset:512
  ds_read_b64 v[110:111], v46 offset:1024
  ds_read_b64 v[112:113], v46 offset:1536
  ds_read_b64 v[114:115], v46 offset:2048
  ds_read_b64 v[116:117], v46 offset:2560
  ds_read_b64 v[118:119], v46 offset:3072
  ds_read_b64 v[120:121], v46 offset:3584
  ds_read_b64 v[122:123], v46 offset:4096
  s_waitcnt lgkmcnt(0)
  v_lshlrev_b32 v124, 16, v108
  v_and_b32 v125, 0xffff0000, v108
  v_lshlrev_b32 v126, 16, v109
  v_and_b32 v127, 0xffff0000, v109
  v_mul_f32 v124, v124, v33
  v_mul_f32 v125, v125, v33
  v_mul_f32 v126, v126, v33
  v_mul_f32 v127, v127, v33
  v_cvt_pk_bf16_f32 v128, v124, v125
  v_cvt_pk_bf16_f32 v129, v126, v127
  v_cvt_pk_bf16_f32 v130, v60, v61
  v_cvt_pk_bf16_f32 v131, v62, v63
  v_lshlrev_b32 v124, 16, v128
  v_and_b32 v125, 0xffff0000, v128
  v_lshlrev_b32 v132, 16, v130
  v_and_b32 v133, 0xffff0000, v130
  v_lshlrev_b32 v126, 16, v129
  v_and_b32 v127, 0xffff0000, v129
  v_lshlrev_b32 v134, 16, v131
  v_and_b32 v135, 0xffff0000, v131
  v_add_f32 v124, v124, v132
  v_add_f32 v125, v125, v133
  v_add_f32 v126, v126, v134
  v_add_f32 v127, v127, v135
  v_cvt_pk_bf16_f32 v108, v124, v125
  v_cvt_pk_bf16_f32 v109, v126, v127
  ds_write_b64 v46, v[108:109] offset:512
  v_lshlrev_b32 v124, 16, v110
  v_and_b32 v125, 0xffff0000, v110
  v_lshlrev_b32 v126, 16, v111
  v_and_b32 v127, 0xffff0000, v111
  v_mul_f32 v124, v124, v33
  v_mul_f32 v125, v125, v33
  v_mul_f32 v126, v126, v33
  v_mul_f32 v127, v127, v33
  v_cvt_pk_bf16_f32 v128, v124, v125
  v_cvt_pk_bf16_f32 v129, v126, v127
  v_cvt_pk_bf16_f32 v130, v64, v65
  v_cvt_pk_bf16_f32 v131, v66, v67
  v_lshlrev_b32 v124, 16, v128
  v_and_b32 v125, 0xffff0000, v128
  v_lshlrev_b32 v132, 16, v130
  v_and_b32 v133, 0xffff0000, v130
  v_lshlrev_b32 v126, 16, v129
  v_and_b32 v127, 0xffff0000, v129
  v_lshlrev_b32 v134, 16, v131
  v_and_b32 v135, 0xffff0000, v131
  v_add_f32 v124, v124, v132
  v_add_f32 v125, v125, v133
  v_add_f32 v126, v126, v134
  v_add_f32 v127, v127, v135
  v_cvt_pk_bf16_f32 v110, v124, v125
  v_cvt_pk_bf16_f32 v111, v126, v127
  ds_write_b64 v46, v[110:111] offset:1024
  v_lshlrev_b32 v124, 16, v112
  v_and_b32 v125, 0xffff0000, v112
  v_lshlrev_b32 v126, 16, v113
  v_and_b32 v127, 0xffff0000, v113
  v_mul_f32 v124, v124, v33
  v_mul_f32 v125, v125, v33
  v_mul_f32 v126, v126, v33
  v_mul_f32 v127, v127, v33
  v_cvt_pk_bf16_f32 v128, v124, v125
  v_cvt_pk_bf16_f32 v129, v126, v127
  v_cvt_pk_bf16_f32 v130, v68, v69
  v_cvt_pk_bf16_f32 v131, v70, v71
  v_lshlrev_b32 v124, 16, v128
  v_and_b32 v125, 0xffff0000, v128
  v_lshlrev_b32 v132, 16, v130
  v_and_b32 v133, 0xffff0000, v130
  v_lshlrev_b32 v126, 16, v129
  v_and_b32 v127, 0xffff0000, v129
  v_lshlrev_b32 v134, 16, v131
  v_and_b32 v135, 0xffff0000, v131
  v_add_f32 v124, v124, v132
  v_add_f32 v125, v125, v133
  v_add_f32 v126, v126, v134
  v_add_f32 v127, v127, v135
  v_cvt_pk_bf16_f32 v112, v124, v125
  v_cvt_pk_bf16_f32 v113, v126, v127
  ds_write_b64 v46, v[112:113] offset:1536
  v_lshlrev_b32 v124, 16, v114
  v_and_b32 v125, 0xffff0000, v114
  v_lshlrev_b32 v126, 16, v115
  v_and_b32 v127, 0xffff0000, v115
  v_mul_f32 v124, v124, v33
  v_mul_f32 v125, v125, v33
  v_mul_f32 v126, v126, v33
  v_mul_f32 v127, v127, v33
  v_cvt_pk_bf16_f32 v128, v124, v125
  v_cvt_pk_bf16_f32 v129, v126, v127
  v_cvt_pk_bf16_f32 v130, v72, v73
  v_cvt_pk_bf16_f32 v131, v74, v75
  v_lshlrev_b32 v124, 16, v128
  v_and_b32 v125, 0xffff0000, v128
  v_lshlrev_b32 v132, 16, v130
  v_and_b32 v133, 0xffff0000, v130
  v_lshlrev_b32 v126, 16, v129
  v_and_b32 v127, 0xffff0000, v129
  v_lshlrev_b32 v134, 16, v131
  v_and_b32 v135, 0xffff0000, v131
  v_add_f32 v124, v124, v132
  v_add_f32 v125, v125, v133
  v_add_f32 v126, v126, v134
  v_add_f32 v127, v127, v135
  v_cvt_pk_bf16_f32 v114, v124, v125
  v_cvt_pk_bf16_f32 v115, v126, v127
  ds_write_b64 v46, v[114:115] offset:2048
  v_lshlrev_b32 v124, 16, v116
  v_and_b32 v125, 0xffff0000, v116
  v_lshlrev_b32 v126, 16, v117
  v_and_b32 v127, 0xffff0000, v117
  v_mul_f32 v124, v124, v33
  v_mul_f32 v125, v125, v33
  v_mul_f32 v126, v126, v33
  v_mul_f32 v127, v127, v33
  v_cvt_pk_bf16_f32 v128, v124, v125
  v_cvt_pk_bf16_f32 v129, v126, v127
  v_cvt_pk_bf16_f32 v130, v76, v77
  v_cvt_pk_bf16_f32 v131, v78, v79
  v_lshlrev_b32 v124, 16, v128
  v_and_b32 v125, 0xffff0000, v128
  v_lshlrev_b32 v132, 16, v130
  v_and_b32 v133, 0xffff0000, v130
  v_lshlrev_b32 v126, 16, v129
  v_and_b32 v127, 0xffff0000, v129
  v_lshlrev_b32 v134, 16, v131
  v_and_b32 v135, 0xffff0000, v131
  v_add_f32 v124, v124, v132
  v_add_f32 v125, v125, v133
  v_add_f32 v126, v126, v134
  v_add_f32 v127, v127, v135
  v_cvt_pk_bf16_f32 v116, v124, v125
  v_cvt_pk_bf16_f32 v117, v126, v127
  ds_write_b64 v46, v[116:117] offset:2560
  v_lshlrev_b32 v124, 16, v118
  v_and_b32 v125, 0xffff0000, v118
  v_lshlrev_b32 v126, 16, v119
  v_and_b32 v127, 0xffff0000, v119
  v_mul_f32 v124, v124, v33
  v_mul_f32 v125, v125, v33
  v_mul_f32 v126, v126, v33
  v_mul_f32 v127, v127, v33
  v_cvt_pk_bf16_f32 v128, v124, v125
  v_cvt_pk_bf16_f32 v129, v126, v127
  v_cvt_pk_bf16_f32 v130, v80, v81
  v_cvt_pk_bf16_f32 v131, v82, v83
  v_lshlrev_b32 v124, 16, v128
  v_and_b32 v125, 0xffff0000, v128
  v_lshlrev_b32 v132, 16, v130
  v_and_b32 v133, 0xffff0000, v130
  v_lshlrev_b32 v126, 16, v129
  v_and_b32 v127, 0xffff0000, v129
  v_lshlrev_b32 v134, 16, v131
  v_and_b32 v135, 0xffff0000, v131
  v_add_f32 v124, v124, v132
  v_add_f32 v125, v125, v133
  v_add_f32 v126, v126, v134
  v_add_f32 v127, v127, v135
  v_cvt_pk_bf16_f32 v118, v124, v125
  v_cvt_pk_bf16_f32 v119, v126, v127
  ds_write_b64 v46, v[118:119] offset:3072
  v_lshlrev_b32 v124, 16, v120
  v_and_b32 v125, 0xffff0000, v120
  v_lshlrev_b32 v126, 16, v121
  v_and_b32 v127, 0xffff0000, v121
  v_mul_f32 v124, v124, v33
  v_mul_f32 v125, v125, v33
  v_mul_f32 v126, v126, v33
  v_mul_f32 v127, v127, v33
  v_cvt_pk_bf16_f32 v128, v124, v125
  v_cvt_pk_bf16_f32 v129, v126, v127
  v_cvt_pk_bf16_f32 v130, v84, v85
  v_cvt_pk_bf16_f32 v131, v86, v87
  v_lshlrev_b32 v124, 16, v128
  v_and_b32 v125, 0xffff0000, v128
  v_lshlrev_b32 v132, 16, v130
  v_and_b32 v133, 0xffff0000, v130
  v_lshlrev_b32 v126, 16, v129
  v_and_b32 v127, 0xffff0000, v129
  v_lshlrev_b32 v134, 16, v131
  v_and_b32 v135, 0xffff0000, v131
  v_add_f32 v124, v124, v132
  v_add_f32 v125, v125, v133
  v_add_f32 v126, v126, v134
  v_add_f32 v127, v127, v135
  v_cvt_pk_bf16_f32 v120, v124, v125
  v_cvt_pk_bf16_f32 v121, v126, v127
  ds_write_b64 v46, v[120:121] offset:3584
  v_lshlrev_b32 v124, 16, v122
  v_and_b32 v125, 0xffff0000, v122
  v_lshlrev_b32 v126, 16, v123
  v_and_b32 v127, 0xffff0000, v123
  v_mul_f32 v124, v124, v33
  v_mul_f32 v125, v125, v33
  v_mul_f32 v126, v126, v33
  v_mul_f32 v127, v127, v33
  v_cvt_pk_bf16_f32 v128, v124, v125
  v_cvt_pk_bf16_f32 v129, v126, v127
  v_cvt_pk_bf16_f32 v130, v88, v89
  v_cvt_pk_bf16_f32 v131, v90, v91
  v_lshlrev_b32 v124, 16, v128
  v_and_b32 v125, 0xffff0000, v128
  v_lshlrev_b32 v132, 16, v130
  v_and_b32 v133, 0xffff0000, v130
  v_lshlrev_b32 v126, 16, v129
  v_and_b32 v127, 0xffff0000, v129
  v_lshlrev_b32 v134, 16, v131
  v_and_b32 v135, 0xffff0000, v131
  v_add_f32 v124, v124, v132
  v_add_f32 v125, v125, v133
  v_add_f32 v126, v126, v134
  v_add_f32 v127, v127, v135
  v_cvt_pk_bf16_f32 v122, v124, v125
  v_cvt_pk_bf16_f32 v123, v126, v127
  ds_write_b64 v46, v[122:123] offset:4096
  s_waitcnt lgkmcnt(0)
  s_barrier
  v_lshlrev_b32 v6, 3, v0
  v_mul_u32_u24 v5, 7168, v0
  v_add_u32 v36, 512, v6
  ds_read_b64 v[8:9], v36
  v_add_u32 v36, 25088, v6
  ds_read_b64 v[10:11], v36
  v_add_u32 v36, 49664, v6
  ds_read_b64 v[12:13], v36
  v_add_u32 v36, 74240, v6
  ds_read_b64 v[14:15], v36
  s_waitcnt lgkmcnt(0)
  s_add_u32 s22, s21, 0
  s_add_u32 s23, s22, 3584
  v_perm_b32 v16, v10, v8, s24
  v_perm_b32 v17, v14, v12, s24
  buffer_store_dwordx2 v[16:17], v5, s[92:95], s22 offen offset:0
  v_perm_b32 v18, v10, v8, s25
  v_perm_b32 v19, v14, v12, s25
  buffer_store_dwordx2 v[18:19], v5, s[92:95], s22 offen offset:1792
  v_perm_b32 v20, v11, v9, s24
  v_perm_b32 v21, v15, v13, s24
  buffer_store_dwordx2 v[20:21], v5, s[92:95], s23 offen offset:0
  v_perm_b32 v22, v11, v9, s25
  v_perm_b32 v23, v15, v13, s25
  buffer_store_dwordx2 v[22:23], v5, s[92:95], s23 offen offset:1792
  v_add_u32 v36, 2560, v6
  ds_read_b64 v[8:9], v36
  v_add_u32 v36, 27136, v6
  ds_read_b64 v[10:11], v36
  v_add_u32 v36, 51712, v6
  ds_read_b64 v[12:13], v36
  v_add_u32 v36, 76288, v6
  ds_read_b64 v[14:15], v36
  s_waitcnt lgkmcnt(0)
  s_add_u32 s22, s21, 1835008
  s_add_u32 s23, s22, 3584
  v_perm_b32 v24, v10, v8, s24
  v_perm_b32 v25, v14, v12, s24
  buffer_store_dwordx2 v[24:25], v5, s[92:95], s22 offen offset:0
  v_perm_b32 v26, v10, v8, s25
  v_perm_b32 v27, v14, v12, s25
  buffer_store_dwordx2 v[26:27], v5, s[92:95], s22 offen offset:1792
  v_perm_b32 v28, v11, v9, s24
  v_perm_b32 v29, v15, v13, s24
  buffer_store_dwordx2 v[28:29], v5, s[92:95], s23 offen offset:0
  v_perm_b32 v30, v11, v9, s25
  v_perm_b32 v31, v15, v13, s25
  buffer_store_dwordx2 v[30:31], v5, s[92:95], s23 offen offset:1792
  s_cmp_lg_u32 s16, 0
  s_cbranch_scc1 w0_41
w0_41:
  s_branch wk_loop
wk_tok:
  s_sub_u32 s3, s3, 864
  s_and_b32 s18, s3, 3
  s_lshr_b32 s17, s3, 2
  s_cmp_lt_u32 s17, 8
  s_cbranch_scc1 wk_tokp
  s_sub_u32 s17, s17, 64
  s_cmp_ge_i32 s17, 56
  s_cbranch_scc1 wk_toko
  s_add_u32 s20, s17, 56
  s_lshr_b32 s17, s20, 1
  s_bitcmp0_b32 s20, 0
  s_cbranch_scc1 wk_toko
  s_add_u32 s17, s17, 8
wk_tokp:
  s_lshl_b32 s20, s18, 2
  s_add_u32 s20, s20, s16
  s_lshl_b32 s21, s17, 4
  s_add_u32 s21, s21, s20
  s_mul_i32 s21, s21, 28672
  s_add_u32 s21, s21, 12845056
  s_mul_i32 s23, s17, 28672
  s_add_u32 s23, s23, 73400320
  s_mul_i32 s24, s17, 7168
  s_add_u32 s24, s24, 88068096
  s_lshr_b32 s25, s17, 3
  s_lshl_b32 s25, s25, 4
  s_add_u32 s25, s25, s20
  s_lshl_b32 s25, s25, 7
  s_add_u32 s25, s25, 88545280
  v_mov_b32 v60, 0
  s_mov_b32 s30, 0
wp_wf:
  buffer_load_dword v61, v60, s[8:11], s25 offen sc1
  s_waitcnt vmcnt(0)
  v_cmp_ne_u32 vcc, 56, v61
  s_cbranch_vccz wp_wf_ok
  s_sleep 1
  s_cmp_ge_u32 s17, 61
  s_cbranch_scc1 wp_wf_bo
  s_sleep 4
  s_cmp_ge_u32 s17, 56
  s_cbranch_scc1 wp_wf_bo
  s_sleep 127
wp_wf_bo:
  s_add_u32 s30, s30, 1
  s_cmp_lt_u32 s30, 30000
  s_cbranch_scc1 wp_wf
  s_branch wp_abort
wp_wf_ok:
  s_add_u32 s22, s21, 0
  buffer_load_dwordx4 a[0:3], v2, s[8:11], s22 offen offset:0 sc1
  buffer_load_dwordx4 a[4:7], v2, s[8:11], s22 offen offset:1024 sc1
  buffer_load_dwordx4 a[8:11], v2, s[8:11], s22 offen offset:2048 sc1
  buffer_load_dwordx4 a[12:15], v2, s[8:11], s22 offen offset:3072 sc1
  s_add_u32 s22, s21, 4096
  buffer_load_dwordx4 a[16:19], v2, s[8:11], s22 offen offset:0 sc1
  buffer_load_dwordx4 a[20:23], v2, s[8:11], s22 offen offset:1024 sc1
  buffer_load_dwordx4 a[24:27], v2, s[8:11], s22 offen offset:2048 sc1
  buffer_load_dwordx4 a[28:31], v2, s[8:11], s22 offen offset:3072 sc1
  s_add_u32 s22, s21, 8192
  buffer_load_dwordx4 a[32:35], v2, s[8:11], s22 offen offset:0 sc1
  buffer_load_dwordx4 a[36:39], v2, s[8:11], s22 offen offset:1024 sc1
  buffer_load_dwordx4 a[40:43], v2, s[8:11], s22 offen offset:2048 sc1
  buffer_load_dwordx4 a[44:47], v2, s[8:11], s22 offen offset:3072 sc1
  s_add_u32 s22, s21, 12288
  buffer_load_dwordx4 a[48:51], v2, s[8:11], s22 offen offset:0 sc1
  buffer_load_dwordx4 a[52:55], v2, s[8:11], s22 offen offset:1024 sc1
  buffer_load_dwordx4 a[56:59], v2, s[8:11], s22 offen offset:2048 sc1
  buffer_load_dwordx4 a[60:63], v2, s[8:11], s22 offen offset:3072 sc1
  s_add_u32 s22, s21, 16384
  buffer_load_dwordx4 a[64:67], v2, s[8:11], s22 offen offset:0 sc1
  buffer_load_dwordx4 a[68:71], v2, s[8:11], s22 offen offset:1024 sc1
  buffer_load_dwordx4 a[72:75], v2, s[8:11], s22 offen offset:2048 sc1
  buffer_load_dwordx4 a[76:79], v2, s[8:11], s22 offen offset:3072 sc1
  s_add_u32 s22, s21, 20480
  buffer_load_dwordx4 a[80:83], v2, s[8:11], s22 offen offset:0 sc1
  buffer_load_dwordx4 a[84:87], v2, s[8:11], s22 offen offset:1024 sc1
  buffer_load_dwordx4 a[88:91], v2, s[8:11], s22 offen offset:2048 sc1
  buffer_load_dwordx4 a[92:95], v2, s[8:11], s22 offen offset:3072 sc1
  s_add_u32 s22, s21, 24576
  buffer_load_dwordx4 a[96:99], v2, s[8:11], s22 offen offset:0 sc1
  buffer_load_dwordx4 a[100:103], v2, s[8:11], s22 offen offset:1024 sc1
  buffer_load_dwordx4 a[104:107], v2, s[8:11], s22 offen offset:2048 sc1
  buffer_load_dwordx4 a[108:111], v2, s[8:11], s22 offen offset:3072 sc1
  s_add_u32 s22, s23, 0
  buffer_load_dwordx4 a[112:115], v2, s[8:11], s22 offen offset:0 sc1
  buffer_load_dwordx4 a[116:119], v2, s[8:11], s22 offen offset:1024 sc1
  buffer_load_dwordx4 a[120:123], v2, s[8:11], s22 offen offset:2048 sc1
  buffer_load_dwordx4 a[124:127], v2, s[8:11], s22 offen offset:3072 sc1
  s_add_u32 s22, s23, 4096
  buffer_load_dwordx4 a[128:131], v2, s[8:11], s22 offen offset:0 sc1
  buffer_load_dwordx4 a[132:135], v2, s[8:11], s22 offen offset:1024 sc1
  buffer_load_dwordx4 a[136:139], v2, s[8:11], s22 offen offset:2048 sc1
  buffer_load_dwordx4 a[140:143], v2, s[8:11], s22 offen offset:3072 sc1
  s_add_u32 s22, s23, 8192
  buffer_load_dwordx4 a[144:147], v2, s[8:11], s22 offen offset:0 sc1
  buffer_load_dwordx4 a[148:151], v2, s[8:11], s22 offen offset:1024 sc1
  buffer_load_dwordx4 a[152:155], v2, s[8:11], s22 offen offset:2048 sc1
  buffer_load_dwordx4 a[156:159], v2, s[8:11], s22 offen offset:3072 sc1
  s_add_u32 s22, s23, 12288
  buffer_load_dwordx4 a[160:163], v2, s[8:11], s22 offen offset:0 sc1
  buffer_load_dwordx4 a[164:167], v2, s[8:11], s22 offen offset:1024 sc1
  buffer_load_dwordx4 a[168:171], v2, s[8:11], s22 offen offset:2048 sc1
  buffer_load_dwordx4 a[172:175], v2, s[8:11], s22 offen offset:3072 sc1
  s_add_u32 s22, s23, 16384
  buffer_load_dwordx4 a[176:179], v2, s[8:11], s22 offen offset:0 sc1
  buffer_load_dwordx4 a[180:183], v2, s[8:11], s22 offen offset:1024 sc1
  buffer_load_dwordx4 a[184:187], v2, s[8:11], s22 offen offset:2048 sc1
  buffer_load_dwordx4 a[188:191], v2, s[8:11], s22 offen offset:3072 sc1
  s_add_u32 s22, s23, 20480
  buffer_load_dwordx4 a[192:195], v2, s[8:11], s22 offen offset:0 sc1
  buffer_load_dwordx4 a[196:199], v2, s[8:11], s22 offen offset:1024 sc1
  buffer_load_dwordx4 a[200:203], v2, s[8:11], s22 offen offset:2048 sc1
  buffer_load_dwordx4 a[204:207], v2, s[8:11], s22 offen offset:3072 sc1
  s_add_u32 s22, s23, 24576
  buffer_load_dwordx4 a[208:211], v2, s[8:11], s22 offen offset:0 sc1
  buffer_load_dwordx4 a[212:215], v2, s[8:11], s22 offen offset:1024 sc1
  buffer_load_dwordx4 a[216:219], v2, s[8:11], s22 offen offset:2048 sc1
  buffer_load_dwordx4 a[220:223], v2, s[8:11], s22 offen offset:3072 sc1
  v_lshl_add_u32 v5, v3, 2, 0
  v_cmp_le_u32 s[40:41], v5, v4
  v_lshl_add_u32 v5, v3, 2, 1
  v_cmp_le_u32 s[42:43], v5, v4
  v_lshl_add_u32 v5, v3, 2, 2
  v_cmp_le_u32 s[44:45], v5, v4
  v_lshl_add_u32 v5, v3, 2, 3
  v_cmp_le_u32 s[46:47], v5, v4
  v_cmp_gt_u32 s[48:49], 2, v3
  v_mov_b32 v6, 0xff800000
  s_waitcnt vmcnt(0)
  v_mfma_f32_16x16x32_bf16 v[8:11], a[112:115], a[0:3], 0
  v_mfma_f32_16x16x32_bf16 v[12:15], a[112:115], a[56:59], 0
  v_mfma_f32_16x16x32_bf16 v[16:19], a[168:171], a[56:59], 0
  v_mfma_f32_16x16x32_bf16 v[8:11], a[116:119], a[4:7], v[8:11]
  v_mfma_f32_16x16x32_bf16 v[12:15], a[116:119], a[60:63], v[12:15]
  v_mfma_f32_16x16x32_bf16 v[16:19], a[172:175], a[60:63], v[16:19]
  v_mfma_f32_16x16x32_bf16 v[8:11], a[120:123], a[8:11], v[8:11]
  v_mfma_f32_16x16x32_bf16 v[12:15], a[120:123], a[64:67], v[12:15]
  v_mfma_f32_16x16x32_bf16 v[16:19], a[176:179], a[64:67], v[16:19]
  v_mfma_f32_16x16x32_bf16 v[8:11], a[124:127], a[12:15], v[8:11]
  v_mfma_f32_16x16x32_bf16 v[12:15], a[124:127], a[68:71], v[12:15]
  v_mfma_f32_16x16x32_bf16 v[16:19], a[180:183], a[68:71], v[16:19]
  v_mfma_f32_16x16x32_bf16 v[8:11], a[128:131], a[16:19], v[8:11]
  v_mfma_f32_16x16x32_bf16 v[12:15], a[128:131], a[72:75], v[12:15]
  v_mfma_f32_16x16x32_bf16 v[16:19], a[184:187], a[72:75], v[16:19]
  v_mfma_f32_16x16x32_bf16 v[8:11], a[132:135], a[20:23], v[8:11]
  v_mfma_f32_16x16x32_bf16 v[12:15], a[132:135], a[76:79], v[12:15]
  v_mfma_f32_16x16x32_bf16 v[16:19], a[188:191], a[76:79], v[16:19]
  v_mfma_f32_16x16x32_bf16 v[8:11], a[136:139], a[24:27], v[8:11]
  v_mfma_f32_16x16x32_bf16 v[12:15], a[136:139], a[80:83], v[12:15]
  v_mfma_f32_16x16x32_bf16 v[16:19], a[192:195], a[80:83], v[16:19]
  v_mfma_f32_16x16x32_bf16 v[8:11], a[140:143], a[28:31], v[8:11]
  v_mfma_f32_16x16x32_bf16 v[12:15], a[140:143], a[84:87], v[12:15]
  v_mfma_f32_16x16x32_bf16 v[16:19], a[196:199], a[84:87], v[16:19]
  v_mfma_f32_16x16x32_bf16 v[8:11], a[144:147], a[32:35], v[8:11]
  v_mfma_f32_16x16x32_bf16 v[12:15], a[144:147], a[88:91], v[12:15]
  v_mfma_f32_16x16x32_bf16 v[16:19], a[200:203], a[88:91], v[16:19]
  v_mfma_f32_16x16x32_bf16 v[8:11], a[148:151], a[36:39], v[8:11]
  v_mfma_f32_16x16x32_bf16 v[12:15], a[148:151], a[92:95], v[12:15]
  v_mfma_f32_16x16x32_bf16 v[16:19], a[204:207], a[92:95], v[16:19]
  v_mfma_f32_16x16x32_bf16 v[8:11], a[152:155], a[40:43], v[8:11]
  v_mfma_f32_16x16x32_bf16 v[12:15], a[152:155], a[96:99], v[12:15]
  v_mfma_f32_16x16x32_bf16 v[16:19], a[208:211], a[96:99], v[16:19]
  v_mfma_f32_16x16x32_bf16 v[8:11], a[156:159], a[44:47], v[8:11]
  v_mfma_f32_16x16x32_bf16 v[12:15], a[156:159], a[100:103], v[12:15]
  v_mfma_f32_16x16x32_bf16 v[16:19], a[212:215], a[100:103], v[16:19]
  v_mfma_f32_16x16x32_bf16 v[8:11], a[160:163], a[48:51], v[8:11]
  v_mfma_f32_16x16x32_bf16 v[12:15], a[160:163], a[104:107], v[12:15]
  v_mfma_f32_16x16x32_bf16 v[16:19], a[216:219], a[104:107], v[16:19]
  v_mfma_f32_16x16x32_bf16 v[8:11], a[164:167], a[52:55], v[8:11]
  v_mfma_f32_16x16x32_bf16 v[12:15], a[164:167], a[108:111], v[12:15]
  v_mfma_f32_16x16x32_bf16 v[16:19], a[220:223], a[108:111], v[16:19]
  s_mul_i32 s22, s20, 448
  v_mov_b32 v62, s22
  s_mov_b32 s30, 0
wp_pm:
  s_cmp_ge_u32 s17, 64
  s_cbranch_scc1 wp_pf
  s_cmp_ge_u32 s17, 61
  s_cbranch_scc1 mp_42a
  v_mov_b32 v61, 0
  s_mov_b64 exec, 1
  buffer_atomic_or v61, v62, s[8:11], s24 offen sc0
  s_mov_b64 exec, -1
  s_branch mp_42b
mp_42a:
  buffer_load_dword v61, v62, s[8:11], s24 offen sc1
mp_42b:
  s_waitcnt vmcnt(0)
  v_cmp_eq_u32 vcc, -1, v61
  s_cbranch_vccnz wp_pr
wp_pf:
  s_add_u32 s22, s24, 4096
  buffer_load_dwordx4 v[64:67], v2, s[8:11], s24 offen offset:0 sc1
  buffer_load_dwordx4 v[68:71], v2, s[8:11], s24 offen offset:1024 sc1
  buffer_load_dwordx4 v[72:75], v2, s[8:11], s24 offen offset:2048 sc1
  buffer_load_dwordx4 v[76:79], v2, s[8:11], s24 offen offset:3072 sc1
  buffer_load_dwordx4 v[80:83], v2, s[8:11], s22 offen offset:0 sc1
  buffer_load_dwordx4 v[84:87], v2, s[8:11], s22 offen offset:1024 sc1
  buffer_load_dwordx4 v[88:91], v2, s[8:11], s22 offen offset:2048 sc1
  s_waitcnt vmcnt(0)
  v_max_u32 v61, v64, v65
  v_max3_u32 v61, v61, v66, v67
  v_max3_u32 v61, v61, v68, v69
  v_max3_u32 v61, v61, v70, v71
  v_max3_u32 v61, v61, v72, v73
  v_max3_u32 v61, v61, v74, v75
  v_max3_u32 v61, v61, v76, v77
  v_max3_u32 v61, v61, v78, v79
  v_max3_u32 v61, v61, v80, v81
  v_max3_u32 v61, v61, v82, v83
  v_max3_u32 v61, v61, v84, v85
  v_max3_u32 v61, v61, v86, v87
  v_max3_u32 v61, v61, v88, v89
  v_max3_u32 v61, v61, v90, v91
  v_cmp_eq_u32 vcc, -1, v61
  s_cbranch_vccz wp_pk
wp_pr:
  s_sleep 1
  s_cmp_ge_u32 s17, 61
  s_cbranch_scc1 wp_pm_bo
  s_sleep 4
  s_cmp_ge_u32 s17, 56
  s_cbranch_scc1 wp_pm_bo
  s_sleep 127
wp_pm_bo:
  s_add_u32 s30, s30, 1
  s_cmp_lt_u32 s30, 30000
  s_cbranch_scc1 wp_pm
  s_branch wp_abort
wp_pk:
  buffer_load_dword v250, v251, s[12:15], 0 offen sc1
  v_mfma_f32_16x16x32_bf16 v[20:23], v[64:67], a[0:3], 0
  v_mfma_f32_16x16x32_bf16 v[24:27], v[64:67], a[4:7], 0
  v_mfma_f32_16x16x32_bf16 v[28:31], v[64:67], a[56:59], 0
  v_mfma_f32_16x16x32_bf16 v[32:35], v[64:67], a[60:63], 0
  v_mfma_f32_16x16x32_bf16 v[20:23], v[68:71], a[8:11], v[20:23]
  v_mfma_f32_16x16x32_bf16 v[24:27], v[68:71], a[12:15], v[24:27]
  v_mfma_f32_16x16x32_bf16 v[28:31], v[68:71], a[64:67], v[28:31]
  v_mfma_f32_16x16x32_bf16 v[32:35], v[68:71], a[68:71], v[32:35]
  v_mfma_f32_16x16x32_bf16 v[20:23], v[72:75], a[16:19], v[20:23]
  v_mfma_f32_16x16x32_bf16 v[24:27], v[72:75], a[20:23], v[24:27]
  v_mfma_f32_16x16x32_bf16 v[28:31], v[72:75], a[72:75], v[28:31]
  v_mfma_f32_16x16x32_bf16 v[32:35], v[72:75], a[76:79], v[32:35]
  v_mfma_f32_16x16x32_bf16 v[20:23], v[76:79], a[24:27], v[20:23]
  v_mfma_f32_16x16x32_bf16 v[24:27], v[76:79], a[28:31], v[24:27]
  v_mfma_f32_16x16x32_bf16 v[28:31], v[76:79], a[80:83], v[28:31]
  v_mfma_f32_16x16x32_bf16 v[32:35], v[76:79], a[84:87], v[32:35]
  v_mfma_f32_16x16x32_bf16 v[20:23], v[80:83], a[32:35], v[20:23]
  v_mfma_f32_16x16x32_bf16 v[24:27], v[80:83], a[36:39], v[24:27]
  v_mfma_f32_16x16x32_bf16 v[28:31], v[80:83], a[88:91], v[28:31]
  v_mfma_f32_16x16x32_bf16 v[32:35], v[80:83], a[92:95], v[32:35]
  v_mfma_f32_16x16x32_bf16 v[20:23], v[84:87], a[40:43], v[20:23]
  v_mfma_f32_16x16x32_bf16 v[24:27], v[84:87], a[44:47], v[24:27]
  v_mfma_f32_16x16x32_bf16 v[28:31], v[84:87], a[96:99], v[28:31]
  v_mfma_f32_16x16x32_bf16 v[32:35], v[84:87], a[100:103], v[32:35]
  v_mfma_f32_16x16x32_bf16 v[20:23], v[88:91], a[48:51], v[20:23]
  v_mfma_f32_16x16x32_bf16 v[24:27], v[88:91], a[52:55], v[24:27]
  v_mfma_f32_16x16x32_bf16 v[28:31], v[88:91], a[104:107], v[28:31]
  v_mfma_f32_16x16x32_bf16 v[32:35], v[88:91], a[108:111], v[32:35]
  s_lshl_b32 s25, s17, 1
  s_mul_i32 s25, s25, 20480
  s_add_u32 s25, s25, 85446656
  s_lshl_b32 s26, s20, 10
  s_add_u32 s26, s26, s25
  s_lshl_b32 s27, s18, 10
  s_add_u32 s27, s27, s25
  s_lshr_b32 s28, s16, 1
  s_lshl_b32 s28, s28, 3
  s_add_u32 s27, s27, s28
  s_add_u32 s27, s27, 16384
  s_and_b32 s28, s16, 1
  s_cmp_eq_u32 s28, 0
  s_cselect_b32 s50, -1, 0
  s_cselect_b32 s51, 0, -1
  v_cndmask_b32 v8, v6, v8, s[40:41]
  v_cndmask_b32 v9, v6, v9, s[42:43]
  v_cndmask_b32 v10, v6, v10, s[44:45]
  v_cndmask_b32 v11, v6, v11, s[46:47]
  v_cndmask_b32 v20, v24, v20, s[48:49]
  v_cndmask_b32 v21, v25, v21, s[48:49]
  v_cndmask_b32 v22, v26, v22, s[48:49]
  v_cndmask_b32 v23, v27, v23, s[48:49]
  v_mov_b32 v24, v20
  v_mov_b32 v25, v21
  v_mov_b32 v26, v22
  v_mov_b32 v27, v23
  v_permlane32_swap_b32 v20, v24
  v_permlane32_swap_b32 v21, v25
  v_permlane32_swap_b32 v22, v26
  v_permlane32_swap_b32 v23, v27
  v_add_f32 v20, v20, v24
  v_add_f32 v21, v21, v25
  v_add_f32 v22, v22, v26
  v_add_f32 v23, v23, v27
  v_max3_f32 v40, v8, v9, v10
  v_max3_f32 v40, v40, v11, v20
  v_max3_f32 v40, v40, v21, v22
  v_max_f32 v40, v40, v23
  v_mov_b32 v41, v40
  s_nop 1
  v_permlane16_swap_b32 v40, v41
  v_max_f32 v40, v40, v41
  v_mov_b32 v41, v40
  s_nop 1
  v_permlane32_swap_b32 v40, v41
  v_max_f32 v40, v40, v41
  v_sub_f32 v8, v8, v40
  v_sub_f32 v9, v9, v40
  v_sub_f32 v10, v10, v40
  v_sub_f32 v11, v11, v40
  v_sub_f32 v20, v20, v40
  v_sub_f32 v21, v21, v40
  v_sub_f32 v22, v22, v40
  v_sub_f32 v23, v23, v40
  v_exp_f32 v8, v8
  v_exp_f32 v9, v9
  v_exp_f32 v10, v10
  v_exp_f32 v11, v11
  v_exp_f32 v20, v20
  v_exp_f32 v21, v21
  v_exp_f32 v22, v22
  v_exp_f32 v23, v23
  v_add_f32 v42, v20, v21
  v_add_f32 v43, v22, v23
  v_add_f32 v42, v42, v43
  v_mul_f32 v42, 0.5, v42
  v_add_f32 v42, v42, v8
  v_add_f32 v42, v42, v9
  v_add_f32 v42, v42, v10
  v_add_f32 v42, v42, v11
  v_mov_b32 v41, v42
  s_nop 1
  v_permlane16_swap_b32 v42, v41
  v_add_f32 v42, v42, v41
  v_mov_b32 v41, v42
  s_nop 1
  v_permlane32_swap_b32 v42, v41
  v_add_f32 v42, v42, v41
  v_rcp_f32 v42, v42
  s_nop 0
  v_mul_f32 v8, v8, v42
  v_mul_f32 v9, v9, v42
  v_mul_f32 v10, v10, v42
  v_mul_f32 v11, v11, v42
  v_mul_f32 v20, v20, v42
  v_mul_f32 v21, v21, v42
  v_mul_f32 v22, v22, v42
  v_mul_f32 v23, v23, v42
  v_cvt_pk_bf16_f32 v44, v8, v9
  v_cvt_pk_bf16_f32 v45, v10, v11
  v_mov_b32 v46, 0
  v_mov_b32 v47, 0
  v_cvt_pk_bf16_f32 v48, v20, v21
  v_cvt_pk_bf16_f32 v49, v22, v23
  v_min_u32 v44, -2, v44
  v_min_u32 v45, -2, v45
  v_min_u32 v46, -2, v46
  v_min_u32 v47, -2, v47
  v_min_u32 v48, -2, v48
  v_min_u32 v49, -2, v49
  buffer_store_dwordx4 v[44:47], v2, s[8:11], s26 offen sc1
  s_mov_b64 exec, s[50:51]
  buffer_store_dwordx2 v[48:49], v2, s[8:11], s27 offen sc1
  s_mov_b64 exec, -1
  s_add_u32 s26, s26, 20480
  s_add_u32 s27, s27, 20480
  v_cndmask_b32 v16, v6, v16, s[40:41]
  v_cndmask_b32 v17, v6, v17, s[42:43]
  v_cndmask_b32 v18, v6, v18, s[44:45]
  v_cndmask_b32 v19, v6, v19, s[46:47]
  v_cndmask_b32 v28, v32, v28, s[48:49]
  v_cndmask_b32 v29, v33, v29, s[48:49]
  v_cndmask_b32 v30, v34, v30, s[48:49]
  v_cndmask_b32 v31, v35, v31, s[48:49]
  v_mov_b32 v32, v28
  v_mov_b32 v33, v29
  v_mov_b32 v34, v30
  v_mov_b32 v35, v31
  v_permlane32_swap_b32 v28, v32
  v_permlane32_swap_b32 v29, v33
  v_permlane32_swap_b32 v30, v34
  v_permlane32_swap_b32 v31, v35
  v_add_f32 v28, v28, v32
  v_add_f32 v29, v29, v33
  v_add_f32 v30, v30, v34
  v_add_f32 v31, v31, v35
  v_max3_f32 v40, v12, v13, v14
  v_max3_f32 v40, v40, v15, v16
  v_max3_f32 v40, v40, v17, v18
  v_max3_f32 v40, v40, v19, v28
  v_max3_f32 v40, v40, v29, v30
  v_max_f32 v40, v40, v31
  v_mov_b32 v41, v40
  s_nop 1
  v_permlane16_swap_b32 v40, v41
  v_max_f32 v40, v40, v41
  v_mov_b32 v41, v40
  s_nop 1
  v_permlane32_swap_b32 v40, v41
  v_max_f32 v40, v40, v41
  v_sub_f32 v12, v12, v40
  v_sub_f32 v13, v13, v40
  v_sub_f32 v14, v14, v40
  v_sub_f32 v15, v15, v40
  v_sub_f32 v16, v16, v40
  v_sub_f32 v17, v17, v40
  v_sub_f32 v18, v18, v40
  v_sub_f32 v19, v19, v40
  v_sub_f32 v28, v28, v40
  v_sub_f32 v29, v29, v40
  v_sub_f32 v30, v30, v40
  v_sub_f32 v31, v31, v40
  v_exp_f32 v12, v12
  v_exp_f32 v13, v13
  v_exp_f32 v14, v14
  v_exp_f32 v15, v15
  v_exp_f32 v16, v16
  v_exp_f32 v17, v17
  v_exp_f32 v18, v18
  v_exp_f32 v19, v19
  v_exp_f32 v28, v28
  v_exp_f32 v29, v29
  v_exp_f32 v30, v30
  v_exp_f32 v31, v31
  v_add_f32 v42, v28, v29
  v_add_f32 v43, v30, v31
  v_add_f32 v42, v42, v43
  v_mul_f32 v42, 0.5, v42
  v_add_f32 v42, v42, v12
  v_add_f32 v42, v42, v13
  v_add_f32 v42, v42, v14
  v_add_f32 v42, v42, v15
  v_add_f32 v42, v42, v16
  v_add_f32 v42, v42, v17
  v_add_f32 v42, v42, v18
  v_add_f32 v42, v42, v19
  v_mov_b32 v41, v42
  s_nop 1
  v_permlane16_swap_b32 v42, v41
  v_add_f32 v42, v42, v41
  v_mov_b32 v41, v42
  s_nop 1
  v_permlane32_swap_b32 v42, v41
  v_add_f32 v42, v42, v41
  v_rcp_f32 v42, v42
  s_nop 0
  v_mul_f32 v12, v12, v42
  v_mul_f32 v13, v13, v42
  v_mul_f32 v14, v14, v42
  v_mul_f32 v15, v15, v42
  v_mul_f32 v16, v16, v42
  v_mul_f32 v17, v17, v42
  v_mul_f32 v18, v18, v42
  v_mul_f32 v19, v19, v42
  v_mul_f32 v28, v28, v42
  v_mul_f32 v29, v29, v42
  v_mul_f32 v30, v30, v42
  v_mul_f32 v31, v31, v42
  v_cvt_pk_bf16_f32 v52, v12, v13
  v_cvt_pk_bf16_f32 v53, v14, v15
  v_cvt_pk_bf16_f32 v54, v16, v17
  v_cvt_pk_bf16_f32 v55, v18, v19
  v_cvt_pk_bf16_f32 v56, v28, v29
  v_cvt_pk_bf16_f32 v57, v30, v31
  v_min_u32 v52, -2, v52
  v_min_u32 v53, -2, v53
  v_min_u32 v54, -2, v54
  v_min_u32 v55, -2, v55
  v_min_u32 v56, -2, v56
  v_min_u32 v57, -2, v57
  buffer_store_dwordx4 v[52:55], v2, s[8:11], s26 offen sc1
  s_mov_b64 exec, s[50:51]
  buffer_store_dwordx2 v[56:57], v2, s[8:11], s27 offen sc1
  s_mov_b64 exec, -1
  s_lshl_b32 s25, s17, 7
  s_add_u32 s25, s25, 88561664
  v_mov_b32 v5, 1
  v_mov_b32 v6, 0
  s_waitcnt vmcnt(0)
  s_mov_b64 exec, 1
  buffer_atomic_add v5, v6, s[8:11], s25 offen
  s_mov_b64 exec, -1
  s_branch wk_loop
wk_toko:
  s_lshl_b32 s20, s18, 2
  s_add_u32 s20, s20, s16
  s_mul_i32 s24, s20, 65
  s_add_u32 s24, s24, s17
  s_lshl_b32 s24, s24, 13
  s_add_u32 s24, s24, 76935168
  s_lshl_b32 s21, s20, 6
  s_add_u32 s21, s21, s17
  s_mul_i32 s21, s21, 28672
  s_add_u32 s21, s21, 42205184
  s_lshl_b32 s25, s17, 1
  s_mul_i32 s25, s25, 20480
  s_add_u32 s25, s25, 85446656
  v_lshrrev_b32 v8, 5, v1
  v_and_b32 v9, 31, v1
  v_min_u32 v5, 27, v9
  v_mad_u32_u24 v5, v8, 28, v5
  v_lshlrev_b32 v5, 4, v5
  v_lshrrev_b32 v10, 4, v9
  v_lshlrev_b32 v7, 10, v10
  v_lshl_add_u32 v7, v4, 4, v7
  v_lshl_add_u32 v7, v8, 3, v7
  v_mul_u32_u24 v6, 20480, v10
  v_lshl_add_u32 v6, v8, 8, v6
  v_lshl_add_u32 v6, v4, 4, v6
  s_lshr_b32 s26, s17, 3
  s_lshl_b32 s26, s26, 4
  s_add_u32 s26, s26, s20
  s_lshl_b32 s26, s26, 7
  s_add_u32 s26, s26, 88528896
  v_mov_b32 v60, 0
  s_mov_b32 s30, 0
wo_wv:
  buffer_load_dword v61, v60, s[8:11], s26 offen sc1
  s_waitcnt vmcnt(0)
  v_cmp_ne_u32 vcc, 56, v61
  s_cbranch_vccz wo_wv_ok
  s_sleep 1
  s_cmp_ge_u32 s17, 61
  s_cbranch_scc1 wo_wv_bo
  s_sleep 4
  s_cmp_ge_u32 s17, 56
  s_cbranch_scc1 wo_wv_bo
  s_sleep 127
wo_wv_bo:
  s_add_u32 s30, s30, 1
  s_cmp_lt_u32 s30, 30000
  s_cbranch_scc1 wo_wv
  s_branch wo_abort
wo_wv_ok:
  s_add_u32 s22, s21, 0
  buffer_load_dwordx4 a[0:3], v5, s[8:11], s22 offen offset:0 sc1
  buffer_load_dwordx4 a[4:7], v5, s[8:11], s22 offen offset:896 sc1
  buffer_load_dwordx4 a[8:11], v5, s[8:11], s22 offen offset:1792 sc1
  buffer_load_dwordx4 a[12:15], v5, s[8:11], s22 offen offset:2688 sc1
  s_add_u32 s22, s21, 3584
  buffer_load_dwordx4 a[16:19], v5, s[8:11], s22 offen offset:0 sc1
  buffer_load_dwordx4 a[20:23], v5, s[8:11], s22 offen offset:896 sc1
  buffer_load_dwordx4 a[24:27], v5, s[8:11], s22 offen offset:1792 sc1
  buffer_load_dwordx4 a[28:31], v5, s[8:11], s22 offen offset:2688 sc1
  s_add_u32 s22, s21, 7168
  buffer_load_dwordx4 a[32:35], v5, s[8:11], s22 offen offset:0 sc1
  buffer_load_dwordx4 a[36:39], v5, s[8:11], s22 offen offset:896 sc1
  buffer_load_dwordx4 a[40:43], v5, s[8:11], s22 offen offset:1792 sc1
  buffer_load_dwordx4 a[44:47], v5, s[8:11], s22 offen offset:2688 sc1
  s_add_u32 s22, s21, 10752
  buffer_load_dwordx4 a[48:51], v5, s[8:11], s22 offen offset:0 sc1
  buffer_load_dwordx4 a[52:55], v5, s[8:11], s22 offen offset:896 sc1
  buffer_load_dwordx4 a[56:59], v5, s[8:11], s22 offen offset:1792 sc1
  buffer_load_dwordx4 a[60:63], v5, s[8:11], s22 offen offset:2688 sc1
  s_add_u32 s22, s21, 14336
  buffer_load_dwordx4 a[64:67], v5, s[8:11], s22 offen offset:0 sc1
  buffer_load_dwordx4 a[68:71], v5, s[8:11], s22 offen offset:896 sc1
  buffer_load_dwordx4 a[72:75], v5, s[8:11], s22 offen offset:1792 sc1
  buffer_load_dwordx4 a[76:79], v5, s[8:11], s22 offen offset:2688 sc1
  s_add_u32 s22, s21, 17920
  buffer_load_dwordx4 a[80:83], v5, s[8:11], s22 offen offset:0 sc1
  buffer_load_dwordx4 a[84:87], v5, s[8:11], s22 offen offset:896 sc1
  buffer_load_dwordx4 a[88:91], v5, s[8:11], s22 offen offset:1792 sc1
  buffer_load_dwordx4 a[92:95], v5, s[8:11], s22 offen offset:2688 sc1
  s_add_u32 s22, s21, 21504
  buffer_load_dwordx4 a[96:99], v5, s[8:11], s22 offen offset:0 sc1
  buffer_load_dwordx4 a[100:103], v5, s[8:11], s22 offen offset:896 sc1
  buffer_load_dwordx4 a[104:107], v5, s[8:11], s22 offen offset:1792 sc1
  buffer_load_dwordx4 a[108:111], v5, s[8:11], s22 offen offset:2688 sc1
  s_add_u32 s22, s21, 25088
  buffer_load_dwordx4 a[112:115], v5, s[8:11], s22 offen offset:0 sc1
  buffer_load_dwordx4 a[116:119], v5, s[8:11], s22 offen offset:896 sc1
  buffer_load_dwordx4 a[120:123], v5, s[8:11], s22 offen offset:1792 sc1
  buffer_load_dwordx4 a[124:127], v5, s[8:11], s22 offen offset:2688 sc1
  s_cmp_ge_u32 s17, 61
  s_cbranch_scc1 wo_lm
  s_lshl_b32 s26, s17, 7
  s_add_u32 s26, s26, 88561664
  v_mov_b32 v60, 0
  s_mov_b32 s30, 0
wo_wp:
  buffer_load_dword v61, v60, s[8:11], s26 offen sc1
  s_waitcnt vmcnt(0)
  v_cmp_ne_u32 vcc, 16, v61
  s_cbranch_vccz wo_wp_ok
  s_sleep 2
  s_cmp_ge_u32 s17, 61
  s_cbranch_scc1 wo_wp_bo
  s_sleep 4
  s_cmp_ge_u32 s17, 56
  s_cbranch_scc1 wo_wp_bo
  s_sleep 127
wo_wp_bo:
  s_add_u32 s30, s30, 1
  s_cmp_lt_u32 s30, 30000
  s_cbranch_scc1 wo_wp
  s_branch wo_abort
wo_wp_ok:
  s_branch wo_lp
wo_lm:
  s_mul_i32 s26, s17, 7168
  s_add_u32 s26, s26, 88068096
  v_mov_b32 v60, 0
  s_mov_b32 s30, 0
wo_wm:
  buffer_load_dword v61, v60, s[8:11], s26 offen sc1
  s_waitcnt vmcnt(0)
  v_cmp_eq_u32 vcc, -1, v61
  s_cbranch_vccz wo_wm_ok
  s_sleep 2
  s_cmp_ge_u32 s17, 61
  s_cbranch_scc1 wo_wm_bo
  s_sleep 4
  s_cmp_ge_u32 s17, 56
  s_cbranch_scc1 wo_wm_bo
  s_sleep 127
wo_wm_bo:
  s_add_u32 s30, s30, 1
  s_cmp_lt_u32 s30, 30000
  s_cbranch_scc1 wo_wm
  s_branch wo_abort
wo_wm_ok:
wo_lp:
  s_mul_i32 s26, s16, 10240
  s_add_u32 s27, s25, s26
  v_add_u32 v11, s26, v2
  s_lshl_b32 s26, s20, 6
  s_add_u32 s26, s26, s17
  s_lshl_b32 s26, s26, 4
  s_add_u32 s26, s26, 88569856
  v_lshlrev_b32 v60, 2, v3
  s_mov_b32 s30, 0
wo_pl:
  s_add_u32 s22, s27, 0
  buffer_load_dwordx4 v[128:131], v2, s[8:11], s22 offen offset:0 sc1
  buffer_load_dwordx4 v[132:135], v2, s[8:11], s22 offen offset:1024 sc1
  buffer_load_dwordx4 v[136:139], v2, s[8:11], s22 offen offset:2048 sc1
  buffer_load_dwordx4 v[140:143], v2, s[8:11], s22 offen offset:3072 sc1
  s_add_u32 s22, s27, 4096
  buffer_load_dwordx4 v[144:147], v2, s[8:11], s22 offen offset:0 sc1
  buffer_load_dwordx4 v[148:151], v2, s[8:11], s22 offen offset:1024 sc1
  buffer_load_dwordx4 v[152:155], v2, s[8:11], s22 offen offset:2048 sc1
  buffer_load_dwordx4 v[156:159], v2, s[8:11], s22 offen offset:3072 sc1
  s_add_u32 s22, s27, 8192
  buffer_load_dwordx4 v[160:163], v2, s[8:11], s22 offen offset:0 sc1
  buffer_load_dwordx4 v[164:167], v2, s[8:11], s22 offen offset:1024 sc1
  buffer_load_dword v61, v60, s[8:11], s26 offen sc1
  s_waitcnt vmcnt(1)
  v_max_u32 v62, v128, v129
  v_max3_u32 v62, v62, v130, v131
  v_max3_u32 v62, v62, v132, v133
  v_max3_u32 v62, v62, v134, v135
  v_max3_u32 v62, v62, v136, v137
  v_max3_u32 v62, v62, v138, v139
  v_max3_u32 v62, v62, v140, v141
  v_max3_u32 v62, v62, v142, v143
  v_max3_u32 v62, v62, v144, v145
  v_max3_u32 v62, v62, v146, v147
  v_max3_u32 v62, v62, v148, v149
  v_max3_u32 v62, v62, v150, v151
  v_max3_u32 v62, v62, v152, v153
  v_max3_u32 v62, v62, v154, v155
  v_max3_u32 v62, v62, v156, v157
  v_max3_u32 v62, v62, v158, v159
  v_max3_u32 v62, v62, v160, v161
  v_max3_u32 v62, v62, v162, v163
  v_max3_u32 v62, v62, v164, v165
  v_max3_u32 v62, v62, v166, v167
  v_cmp_eq_u32 vcc, -1, v62
  s_cbranch_vccz wo_pk
  s_add_u32 s30, s30, 1
  s_cmp_lt_u32 s30, 30000
  s_cbranch_scc1 wo_pl
  s_branch wo_abort
wo_pk:
  ds_write_b128 v11, v[128:131] offset:0
  ds_write_b128 v11, v[132:135] offset:1024
  ds_write_b128 v11, v[136:139] offset:2048
  ds_write_b128 v11, v[140:143] offset:3072
  ds_write_b128 v11, v[144:147] offset:4096
  ds_write_b128 v11, v[148:151] offset:5120
  ds_write_b128 v11, v[152:155] offset:6144
  ds_write_b128 v11, v[156:159] offset:7168
  ds_write_b128 v11, v[160:163] offset:8192
  ds_write_b128 v11, v[164:167] offset:9216
  s_waitcnt vmcnt(0)
  v_cmp_ne_u32 vcc, 1, v61
  s_mov_b32 s28, 0
  s_cbranch_vccnz wo_nt
  s_add_u32 s22, s24, 0
  buffer_load_dwordx2 v[28:29], v7, s[8:11], s22 offen offset:0 sc1
  buffer_load_dwordx2 v[30:31], v7, s[8:11], s22 offen offset:512 sc1
  buffer_load_dwordx2 v[32:33], v7, s[8:11], s22 offen offset:256 sc1
  buffer_load_dwordx2 v[34:35], v7, s[8:11], s22 offen offset:768 sc1
  buffer_load_dwordx2 v[36:37], v7, s[8:11], s22 offen offset:2048 sc1
  buffer_load_dwordx2 v[38:39], v7, s[8:11], s22 offen offset:2560 sc1
  buffer_load_dwordx2 v[40:41], v7, s[8:11], s22 offen offset:2304 sc1
  buffer_load_dwordx2 v[42:43], v7, s[8:11], s22 offen offset:2816 sc1
  s_add_u32 s22, s24, 4096
  buffer_load_dwordx2 v[44:45], v7, s[8:11], s22 offen offset:0 sc1
  buffer_load_dwordx2 v[46:47], v7, s[8:11], s22 offen offset:512 sc1
  buffer_load_dwordx2 v[48:49], v7, s[8:11], s22 offen offset:256 sc1
  buffer_load_dwordx2 v[50:51], v7, s[8:11], s22 offen offset:768 sc1
  buffer_load_dwordx2 v[52:53], v7, s[8:11], s22 offen offset:2048 sc1
  buffer_load_dwordx2 v[54:55], v7, s[8:11], s22 offen offset:2560 sc1
  buffer_load_dwordx2 v[56:57], v7, s[8:11], s22 offen offset:2304 sc1
  buffer_load_dwordx2 v[58:59], v7, s[8:11], s22 offen offset:2816 sc1
  s_mov_b32 s28, 1
wo_nt:
  buffer_load_dword v250, v251, s[12:15], 0 offen sc1
  s_waitcnt lgkmcnt(0)
  s_barrier
  buffer_load_dword v61, v60, s[8:11], s26 offen sc1
  ds_read_b128 v[64:67], v6 offset:0
  ds_read_b128 v[68:71], v6 offset:512
  ds_read_b128 v[72:75], v6 offset:1024
  ds_read_b128 v[76:79], v6 offset:1536
  ds_read_b128 v[80:83], v6 offset:2048
  ds_read_b128 v[84:87], v6 offset:2560
  ds_read_b128 v[88:91], v6 offset:3072
  s_waitcnt lgkmcnt(6)
  v_mfma_f32_32x32x16_bf16 v[12:27], a[0:3], v[64:67], 0
  ds_read_b128 v[92:95], v6 offset:3584
  s_waitcnt lgkmcnt(6)
  v_mfma_f32_32x32x16_bf16 v[12:27], a[4:7], v[68:71], v[12:27]
  ds_read_b128 v[64:67], v6 offset:4096
  s_waitcnt lgkmcnt(6)
  v_mfma_f32_32x32x16_bf16 v[12:27], a[8:11], v[72:75], v[12:27]
  ds_read_b128 v[68:71], v6 offset:4608
  s_waitcnt lgkmcnt(6)
  v_mfma_f32_32x32x16_bf16 v[12:27], a[12:15], v[76:79], v[12:27]
  ds_read_b128 v[72:75], v6 offset:5120
  s_waitcnt lgkmcnt(6)
  v_mfma_f32_32x32x16_bf16 v[12:27], a[16:19], v[80:83], v[12:27]
  ds_read_b128 v[76:79], v6 offset:5632
  s_waitcnt lgkmcnt(6)
  v_mfma_f32_32x32x16_bf16 v[12:27], a[20:23], v[84:87], v[12:27]
  ds_read_b128 v[80:83], v6 offset:6144
  s_waitcnt lgkmcnt(6)
  v_mfma_f32_32x32x16_bf16 v[12:27], a[24:27], v[88:91], v[12:27]
  ds_read_b128 v[84:87], v6 offset:6656
  s_waitcnt lgkmcnt(6)
  v_mfma_f32_32x32x16_bf16 v[12:27], a[28:31], v[92:95], v[12:27]
  ds_read_b128 v[88:91], v6 offset:7168
  s_waitcnt lgkmcnt(6)
  v_mfma_f32_32x32x16_bf16 v[12:27], a[32:35], v[64:67], v[12:27]
  ds_read_b128 v[92:95], v6 offset:7680
  s_waitcnt lgkmcnt(6)
  v_mfma_f32_32x32x16_bf16 v[12:27], a[36:39], v[68:71], v[12:27]
  ds_read_b128 v[64:67], v6 offset:8192
  s_waitcnt lgkmcnt(6)
  v_mfma_f32_32x32x16_bf16 v[12:27], a[40:43], v[72:75], v[12:27]
  ds_read_b128 v[68:71], v6 offset:8704
  s_waitcnt lgkmcnt(6)
  v_mfma_f32_32x32x16_bf16 v[12:27], a[44:47], v[76:79], v[12:27]
  ds_read_b128 v[72:75], v6 offset:9216
  s_waitcnt lgkmcnt(6)
  v_mfma_f32_32x32x16_bf16 v[12:27], a[48:51], v[80:83], v[12:27]
  ds_read_b128 v[76:79], v6 offset:9728
  s_waitcnt lgkmcnt(6)
  v_mfma_f32_32x32x16_bf16 v[12:27], a[52:55], v[84:87], v[12:27]
  ds_read_b128 v[80:83], v6 offset:10240
  s_waitcnt lgkmcnt(6)
  v_mfma_f32_32x32x16_bf16 v[12:27], a[56:59], v[88:91], v[12:27]
  ds_read_b128 v[84:87], v6 offset:10752
  s_waitcnt lgkmcnt(6)
  v_mfma_f32_32x32x16_bf16 v[12:27], a[60:63], v[92:95], v[12:27]
  ds_read_b128 v[88:91], v6 offset:11264
  s_waitcnt lgkmcnt(6)
  v_mfma_f32_32x32x16_bf16 v[12:27], a[64:67], v[64:67], v[12:27]
  ds_read_b128 v[92:95], v6 offset:11776
  s_waitcnt lgkmcnt(6)
  v_mfma_f32_32x32x16_bf16 v[12:27], a[68:71], v[68:71], v[12:27]
  ds_read_b128 v[64:67], v6 offset:12288
  s_waitcnt lgkmcnt(6)
  v_mfma_f32_32x32x16_bf16 v[12:27], a[72:75], v[72:75], v[12:27]
  ds_read_b128 v[68:71], v6 offset:12800
  s_waitcnt lgkmcnt(6)
  v_mfma_f32_32x32x16_bf16 v[12:27], a[76:79], v[76:79], v[12:27]
  s_cmp_lg_u32 s28, 0
  s_cbranch_scc1 wo_h2
  s_waitcnt vmcnt(0)
  v_cmp_ne_u32 vcc, 1, v61
  s_cbranch_vccnz wo_h2
  s_add_u32 s22, s24, 0
  buffer_load_dwordx2 v[28:29], v7, s[8:11], s22 offen offset:0 sc1
  buffer_load_dwordx2 v[30:31], v7, s[8:11], s22 offen offset:512 sc1
  buffer_load_dwordx2 v[32:33], v7, s[8:11], s22 offen offset:256 sc1
  buffer_load_dwordx2 v[34:35], v7, s[8:11], s22 offen offset:768 sc1
  buffer_load_dwordx2 v[36:37], v7, s[8:11], s22 offen offset:2048 sc1
  buffer_load_dwordx2 v[38:39], v7, s[8:11], s22 offen offset:2560 sc1
  buffer_load_dwordx2 v[40:41], v7, s[8:11], s22 offen offset:2304 sc1
  buffer_load_dwordx2 v[42:43], v7, s[8:11], s22 offen offset:2816 sc1
  s_add_u32 s22, s24, 4096
  buffer_load_dwordx2 v[44:45], v7, s[8:11], s22 offen offset:0 sc1
  buffer_load_dwordx2 v[46:47], v7, s[8:11], s22 offen offset:512 sc1
  buffer_load_dwordx2 v[48:49], v7, s[8:11], s22 offen offset:256 sc1
  buffer_load_dwordx2 v[50:51], v7, s[8:11], s22 offen offset:768 sc1
  buffer_load_dwordx2 v[52:53], v7, s[8:11], s22 offen offset:2048 sc1
  buffer_load_dwordx2 v[54:55], v7, s[8:11], s22 offen offset:2560 sc1
  buffer_load_dwordx2 v[56:57], v7, s[8:11], s22 offen offset:2304 sc1
  buffer_load_dwordx2 v[58:59], v7, s[8:11], s22 offen offset:2816 sc1
  s_mov_b32 s28, 1
wo_h2:
  ds_read_b128 v[72:75], v6 offset:13312
  s_waitcnt lgkmcnt(6)
  v_mfma_f32_32x32x16_bf16 v[12:27], a[80:83], v[80:83], v[12:27]
  ds_read_b128 v[76:79], v6 offset:13824
  s_waitcnt lgkmcnt(6)
  v_mfma_f32_32x32x16_bf16 v[12:27], a[84:87], v[84:87], v[12:27]
  ds_read_b128 v[80:83], v6 offset:14336
  s_waitcnt lgkmcnt(6)
  v_mfma_f32_32x32x16_bf16 v[12:27], a[88:91], v[88:91], v[12:27]
  ds_read_b128 v[84:87], v6 offset:14848
  s_waitcnt lgkmcnt(6)
  v_mfma_f32_32x32x16_bf16 v[12:27], a[92:95], v[92:95], v[12:27]
  ds_read_b128 v[88:91], v6 offset:15360
  s_waitcnt lgkmcnt(6)
  v_mfma_f32_32x32x16_bf16 v[12:27], a[96:99], v[64:67], v[12:27]
  ds_read_b128 v[92:95], v6 offset:15872
  s_waitcnt lgkmcnt(6)
  v_mfma_f32_32x32x16_bf16 v[12:27], a[100:103], v[68:71], v[12:27]
  ds_read_b128 v[64:67], v6 offset:16384
  s_waitcnt lgkmcnt(6)
  v_mfma_f32_32x32x16_bf16 v[12:27], a[104:107], v[72:75], v[12:27]
  ds_read_b128 v[68:71], v6 offset:16896
  s_waitcnt lgkmcnt(6)
  v_mfma_f32_32x32x16_bf16 v[12:27], a[108:111], v[76:79], v[12:27]
  ds_read_b128 v[72:75], v6 offset:17408
  s_waitcnt lgkmcnt(6)
  v_mfma_f32_32x32x16_bf16 v[12:27], a[112:115], v[80:83], v[12:27]
  ds_read_b128 v[76:79], v6 offset:17920
  s_waitcnt lgkmcnt(6)
  v_mfma_f32_32x32x16_bf16 v[12:27], a[116:119], v[84:87], v[12:27]
  ds_read_b128 v[80:83], v6 offset:18432
  s_waitcnt lgkmcnt(6)
  v_mfma_f32_32x32x16_bf16 v[12:27], a[120:123], v[88:91], v[12:27]
  ds_read_b128 v[84:87], v6 offset:18944
  s_waitcnt lgkmcnt(6)
  v_mfma_f32_32x32x16_bf16 v[12:27], a[124:127], v[92:95], v[12:27]
  s_cmp_lg_u32 s28, 0
  s_cbranch_scc1 wo_ht
  v_lshlrev_b32 v60, 2, v3
  s_mov_b32 s30, 0
wo_wt:
  buffer_load_dword v61, v60, s[8:11], s26 offen sc1
  s_waitcnt vmcnt(0)
  v_cmp_ne_u32 vcc, 1, v61
  s_cbranch_vccz wo_wt_ok
  s_sleep 1
  s_cmp_ge_u32 s17, 61
  s_cbranch_scc1 wo_wt_bo
  s_sleep 4
  s_cmp_ge_u32 s17, 56
  s_cbranch_scc1 wo_wt_bo
  s_sleep 127
wo_wt_bo:
  s_add_u32 s30, s30, 1
  s_cmp_lt_u32 s30, 30000
  s_cbranch_scc1 wo_wt
  s_branch wo_abort
wo_wt_ok:
  s_add_u32 s22, s24, 0
  buffer_load_dwordx2 v[28:29], v7, s[8:11], s22 offen offset:0 sc1
  buffer_load_dwordx2 v[30:31], v7, s[8:11], s22 offen offset:512 sc1
  buffer_load_dwordx2 v[32:33], v7, s[8:11], s22 offen offset:256 sc1
  buffer_load_dwordx2 v[34:35], v7, s[8:11], s22 offen offset:768 sc1
  buffer_load_dwordx2 v[36:37], v7, s[8:11], s22 offen offset:2048 sc1
  buffer_load_dwordx2 v[38:39], v7, s[8:11], s22 offen offset:2560 sc1
  buffer_load_dwordx2 v[40:41], v7, s[8:11], s22 offen offset:2304 sc1
  buffer_load_dwordx2 v[42:43], v7, s[8:11], s22 offen offset:2816 sc1
  s_add_u32 s22, s24, 4096
  buffer_load_dwordx2 v[44:45], v7, s[8:11], s22 offen offset:0 sc1
  buffer_load_dwordx2 v[46:47], v7, s[8:11], s22 offen offset:512 sc1
  buffer_load_dwordx2 v[48:49], v7, s[8:11], s22 offen offset:256 sc1
  buffer_load_dwordx2 v[50:51], v7, s[8:11], s22 offen offset:768 sc1
  buffer_load_dwordx2 v[52:53], v7, s[8:11], s22 offen offset:2048 sc1
  buffer_load_dwordx2 v[54:55], v7, s[8:11], s22 offen offset:2560 sc1
  buffer_load_dwordx2 v[56:57], v7, s[8:11], s22 offen offset:2304 sc1
  buffer_load_dwordx2 v[58:59], v7, s[8:11], s22 offen offset:2816 sc1
wo_ht:
  ds_read_b128 v[88:91], v6 offset:19456
  s_waitcnt lgkmcnt(6) vmcnt(0)
  v_mfma_f32_32x32x16_bf16 v[12:27], v[28:31], v[64:67], v[12:27]
  ds_read_b128 v[92:95], v6 offset:19968
  s_waitcnt lgkmcnt(6)
  v_mfma_f32_32x32x16_bf16 v[12:27], v[32:35], v[68:71], v[12:27]
  s_waitcnt lgkmcnt(5)
  v_mfma_f32_32x32x16_bf16 v[12:27], v[36:39], v[72:75], v[12:27]
  s_waitcnt lgkmcnt(4)
  v_mfma_f32_32x32x16_bf16 v[12:27], v[40:43], v[76:79], v[12:27]
  s_waitcnt lgkmcnt(3)
  v_mfma_f32_32x32x16_bf16 v[12:27], v[44:47], v[80:83], v[12:27]
  s_waitcnt lgkmcnt(2)
  v_mfma_f32_32x32x16_bf16 v[12:27], v[48:51], v[84:87], v[12:27]
  s_waitcnt lgkmcnt(1)
  v_mfma_f32_32x32x16_bf16 v[12:27], v[52:55], v[88:91], v[12:27]
  s_waitcnt lgkmcnt(0)
  v_mfma_f32_32x32x16_bf16 v[12:27], v[56:59], v[92:95], v[12:27]
  v_mul_u32_u24 v9, 240, v9
  s_movk_i32 s23, 240
  v_lshl_add_u32 v8, v8, 3, v9
  s_mul_i32 s22, s16, 56
  v_add_u32 v8, s22, v8
  v_min_u32 v11, 223, v0
  v_mul_u32_u24 v9, 4682, v11
  v_lshrrev_b32 v9, 16, v9
  v_mul_u32_u24 v10, 14, v9
  v_sub_u32 v10, v11, v10
  v_lshlrev_b32 v10, 4, v10
  v_mad_u32_u24 v11, v9, s23, v10
  v_mul_u32_u24 v9, 1792, v9
  v_add_u32 v10, v9, v10
  s_mul_i32 s26, s17, 57344
  s_mul_i32 s22, s18, 224
  s_add_u32 s26, s26, s22
  s_add_u32 s26, s26, 896
  s_add_u32 s27, s26, 28672
  v_cvt_pk_bf16_f32 v96, v12, v13
  v_cvt_pk_bf16_f32 v97, v14, v15
  ds_write_b64 v8, v[96:97] offset:49152
  v_cvt_pk_bf16_f32 v98, v16, v17
  v_cvt_pk_bf16_f32 v99, v18, v19
  ds_write_b64 v8, v[98:99] offset:49168
  v_cvt_pk_bf16_f32 v100, v20, v21
  v_cvt_pk_bf16_f32 v101, v22, v23
  ds_write_b64 v8, v[100:101] offset:49184
  v_cvt_pk_bf16_f32 v102, v24, v25
  v_cvt_pk_bf16_f32 v103, v26, v27
  s_mov_b32 exec_hi, 0
  ds_write_b64 v8, v[102:103] offset:49200
  s_mov_b64 exec, -1
  s_waitcnt lgkmcnt(0)
  s_barrier
  ds_read_b128 v[104:107], v11 offset:49152
  ds_read_b128 v[108:111], v11 offset:52992
  s_cmp_lg_u32 s16, 3
  s_cselect_b32 exec_hi, -1, 0
  s_waitcnt lgkmcnt(1)
  buffer_store_dwordx4 v[104:107], v10, s[92:95], s26 offen
  s_waitcnt lgkmcnt(0)
  buffer_store_dwordx4 v[108:111], v10, s[92:95], s27 offen
  s_mov_b64 exec, -1
  v_readfirstlane_b32 s22, v250
  s_cmp_ge_u32 s22, 1376
  s_cbranch_scc1 ch_end
  s_branch wk_loop
wp_abort:
wo_abort:
  s_branch cA_abort
ch_end:
  s_endpgm

.section .rodata,"a"
.p2align 6
.amdhsa_kernel main_kernel
  .amdhsa_next_free_vgpr 512
  .amdhsa_next_free_sgpr 102
  .amdhsa_accum_offset 256
  .amdhsa_group_segment_fixed_size 0
  .amdhsa_kernarg_size 136
  .amdhsa_user_sgpr_count 2
  .amdhsa_user_sgpr_kernarg_segment_ptr 1
  .amdhsa_system_sgpr_workgroup_id_x 1
.end_amdhsa_kernel
```

```asm
; @launch kernel=main_kernel grid=(256,1,1) block=(256,1,1) lds=163840
.amdgcn_target "amdgcn-amd-amdhsa--gfx950"
.text
.globl main_kernel
.p2align 8
.type main_kernel,@function
main_kernel:
  s_cmp_ge_u32 s2, 256
  s_cbranch_scc1 ch_end
  s_load_dwordx4 s[4:7], s[0:1], 120
  s_load_dwordx2 s[92:93], s[0:1], 112
  s_load_dwordx8 s[36:43], s[0:1], 56
  s_load_dwordx4 s[44:47], s[0:1], 88
  s_memrealtime s[88:89]
  s_getpc_b64 s[98:99]
pf_main_kernel_1:
  s_sub_u32 s98, s98, pf_main_kernel_1-main_kernel
  s_subb_u32 s99, s99, 0
  s_lshr_b32 s20, s2, 3
  v_lshl_add_u32 v60, v0, 5, s20
  v_lshlrev_b32 v60, 7, v60
  v_min_u32 v60, ch_end-main_kernel-4, v60
  v_cmp_gt_u32 vcc, 32, v0
  s_and_saveexec_b64 s[22:23], vcc
  s_cbranch_execz pf_main_kernel_1_n
  global_load_dword v62, v60, s[98:99]
pf_main_kernel_1_n:
  s_mov_b64 exec, -1
  s_getreg_b32 s67, hwreg(HW_REG_XCC_ID)
  s_and_b32 s67, s67, 7
  v_lshrrev_b32 v1, 6, v0
  s_nop 0
  v_readfirstlane_b32 s16, v1
  s_mov_b32 s66, 0
  s_mov_b32 s68, 0
  s_mov_b32 s69, 0
  s_mov_b32 s96, 0
  s_mov_b32 s97, 0
  s_mov_b32 s101, 0x5eed0000
  s_sub_u32 s20, s67, 0
  s_lshr_b32 s21, s2, 3
  s_and_b32 s20, s20, 7
  s_lshl_b32 s3, s20, 5
  s_add_u32 s3, s3, s21
  s_waitcnt lgkmcnt(0)
  s_mov_b32 s8, s6
  s_and_b32 s9, s7, 0xffff
  s_mov_b32 s10, 0x10000000
  s_mov_b32 s11, 0x20000
  s_mov_b32 s12, s4
  s_and_b32 s13, s5, 0xffff
  s_mov_b32 s14, 256
  s_mov_b32 s15, 0x20000
  s_or_b32 s88, s88, 1
  s_and_b32 s93, s93, 0xffff
  s_mov_b32 s94, 3670016
  s_mov_b32 s95, 0x20000
m_start:
  s_cmp_ge_u32 s3, 32
  s_cbranch_scc1 m_bjob
  v_and_b32 v1, 63, v0
  v_lshlrev_b32 v2, 4, v1
  v_lshrrev_b32 v116, 4, v1
  v_and_b32 v117, 15, v1
  v_mov_b32 v3, 0x4444
  v_mov_b32 v118, 0xeeee
  v_cmp_lt_u32 vcc, 7, v117
  s_nop 1
  v_cndmask_b32 v3, v3, v118, vcc
  s_and_b32 s17, s3, 15
  s_cmp_ge_u32 s3, 16
  s_cbranch_scc1 m_val
  s_mov_b32 s60, s42
  s_and_b32 s61, s43, 0xffff
  s_mov_b32 s62, 3670016
  s_mov_b32 s63, 0x20000
  v_lshrrev_b32 v24, 5, v1
  v_and_b32 v25, 31, v1
  s_lshl_b32 s26, s17, 9
  s_lshl_b32 s25, s16, 12
  v_xor_b32 v26, v25, v24
  v_lshlrev_b32 v26, 4, v26
  v_lshl_add_u32 v26, v24, 13, v26
  v_xor_b32 v100, 0, v26
  v_xor_b32 v101, 0, v26
  v_add_u32 v101, 15360, v101
  v_xor_b32 v102, 32, v26
  v_add_u32 v102, 30720, v102
  v_xor_b32 v103, 32, v26
  v_add_u32 v103, 46080, v103
  s_lshl_b32 s23, s16, 19
  s_add_u32 s23, s23, s26
  s_add_u32 m0, s25, 16384
  s_nop 0
  buffer_load_dwordx4 v100, s[60:63], s23 offen offset:0 lds
  buffer_load_dwordx4 v101, s[60:63], s23 offen offset:1024 lds
  buffer_load_dwordx4 v102, s[60:63], s23 offen offset:2048 lds
  buffer_load_dwordx4 v103, s[60:63], s23 offen offset:3072 lds
  s_add_u32 m0, s25, 32768
  s_add_u32 s23, s23, 65536
  buffer_load_dwordx4 v100, s[60:63], s23 offen offset:0 lds
  buffer_load_dwordx4 v101, s[60:63], s23 offen offset:1024 lds
  buffer_load_dwordx4 v102, s[60:63], s23 offen offset:2048 lds
  buffer_load_dwordx4 v103, s[60:63], s23 offen offset:3072 lds
  v_xor_b32 v100, 64, v100
  v_xor_b32 v101, 64, v101
  v_xor_b32 v102, 64, v102
  v_xor_b32 v103, 64, v103
  s_add_u32 m0, s25, 49152
  s_add_u32 s23, s23, 65536
  buffer_load_dwordx4 v100, s[60:63], s23 offen offset:0 lds
  buffer_load_dwordx4 v101, s[60:63], s23 offen offset:1024 lds
  buffer_load_dwordx4 v102, s[60:63], s23 offen offset:2048 lds
  buffer_load_dwordx4 v103, s[60:63], s23 offen offset:3072 lds
  s_add_u32 m0, s25, 65536
  s_add_u32 s23, s23, 65536
  buffer_load_dwordx4 v100, s[60:63], s23 offen offset:0 lds
  buffer_load_dwordx4 v101, s[60:63], s23 offen offset:1024 lds
  buffer_load_dwordx4 v102, s[60:63], s23 offen offset:2048 lds
  buffer_load_dwordx4 v103, s[60:63], s23 offen offset:3072 lds
  v_xor_b32 v100, 192, v100
  v_xor_b32 v101, 192, v101
  v_xor_b32 v102, 192, v102
  v_xor_b32 v103, 192, v103
  s_add_u32 m0, s25, 81920
  s_add_u32 s23, s23, 65536
  buffer_load_dwordx4 v100, s[60:63], s23 offen offset:0 lds
  buffer_load_dwordx4 v101, s[60:63], s23 offen offset:1024 lds
  buffer_load_dwordx4 v102, s[60:63], s23 offen offset:2048 lds
  buffer_load_dwordx4 v103, s[60:63], s23 offen offset:3072 lds
  s_add_u32 m0, s25, 98304
  s_add_u32 s23, s23, 65536
  buffer_load_dwordx4 v100, s[60:63], s23 offen offset:0 lds
  buffer_load_dwordx4 v101, s[60:63], s23 offen offset:1024 lds
  buffer_load_dwordx4 v102, s[60:63], s23 offen offset:2048 lds
  buffer_load_dwordx4 v103, s[60:63], s23 offen offset:3072 lds
  v_xor_b32 v100, 64, v100
  v_xor_b32 v101, 64, v101
  v_xor_b32 v102, 64, v102
  v_xor_b32 v103, 64, v103
  s_add_u32 m0, s25, 114688
  s_add_u32 s23, s23, 65536
  buffer_load_dwordx4 v100, s[60:63], s23 offen offset:0 lds
  buffer_load_dwordx4 v101, s[60:63], s23 offen offset:1024 lds
  buffer_load_dwordx4 v102, s[60:63], s23 offen offset:2048 lds
  buffer_load_dwordx4 v103, s[60:63], s23 offen offset:3072 lds
  s_add_u32 m0, s25, 131072
  s_add_u32 s23, s23, 65536
  buffer_load_dwordx4 v100, s[60:63], s23 offen offset:0 lds
  buffer_load_dwordx4 v101, s[60:63], s23 offen offset:1024 lds
  buffer_load_dwordx4 v102, s[60:63], s23 offen offset:2048 lds
  buffer_load_dwordx4 v103, s[60:63], s23 offen offset:3072 lds
  s_mov_b32 s56, s40
  s_and_b32 s57, s41, 0xffff
  s_mov_b32 s58, 3670016
  s_mov_b32 s59, 0x20000
  s_lshl_b32 s21, s16, 16
  s_add_u32 s27, s26, s21
  s_lshr_b32 s20, s16, 1
  s_lshl_b32 s20, s20, 6
  v_xor_b32 v26, s20, v26
  v_xor_b32 v4, 0, v26
  v_xor_b32 v5, 32, v26
  v_add_u32 v5, 15360, v5
  v_xor_b32 v6, 128, v26
  v_add_u32 v6, 30720, v6
  v_xor_b32 v7, 160, v26
  v_add_u32 v7, 46080, v7
  s_add_u32 s22, s27, 0
  s_add_u32 m0, s25, 0
  s_nop 0
  buffer_load_dwordx4 v4, s[56:59], s22 offen offset:0 lds
  buffer_load_dwordx4 v5, s[56:59], s22 offen offset:1024 lds
  buffer_load_dwordx4 v6, s[56:59], s22 offen offset:2048 lds
  buffer_load_dwordx4 v7, s[56:59], s22 offen offset:3072 lds
  s_cmp_lg_u32 s66, 0
  s_cbranch_scc1 sc_ci
  s_cmp_lg_u32 s16, 0
  s_cbranch_scc1 w0_2
  s_lshr_b32 s70, s3, 5
  s_and_b32 s71, s70, 4
  s_mul_i32 s71, s71, 12
  s_lshl_b32 s70, s70, 2
  s_add_u32 s70, s70, s71
  s_lshl_b32 s71, 1, s3
  v_mov_b32 v248, s71
  v_mov_b32 v249, 32
  s_mov_b64 exec, 1
  buffer_atomic_or v248, v249, s[12:15], s70 offen sc0
  buffer_load_dwordx2 v[250:251], v249, s[12:15], 0 offen offset:96 sc1
  s_mov_b64 exec, -1
w0_2:
sc_ci:
  v_and_b32 v26, 15, v25
  v_xor_b32 v27, v26, v24
  v_lshlrev_b32 v27, 4, v27
  v_bfe_u32 v28, v25, 2, 1
  v_lshlrev_b32 v28, 4, v28
  v_lshrrev_b32 v29, 3, v25
  v_lshl_add_u32 v28, v29, 2, v28
  v_and_b32 v29, 3, v25
  v_add_u32 v28, v28, v29
  v_lshl_add_u32 v28, v28, 9, v27
  v_lshrrev_b32 v29, 2, v26
  v_lshlrev_b32 v29, 15, v29
  v_bfe_u32 v30, v26, 1, 1
  v_lshl_add_u32 v29, v30, 11, v29
  v_lshrrev_b32 v30, 4, v25
  v_lshl_add_u32 v29, v30, 10, v29
  v_and_b32 v31, 1, v26
  v_lshl_add_u32 v29, v31, 9, v29
  v_add_u32 v29, v29, v27
  v_add_u32 v29, s25, v29
  v_xor_b32 v8, 0, v28
  v_xor_b32 v104, 0, v29
  v_xor_b32 v9, 32, v28
  v_xor_b32 v105, 32, v29
  v_xor_b32 v10, 64, v28
  v_xor_b32 v106, 64, v29
  v_xor_b32 v11, 96, v28
  v_xor_b32 v107, 96, v29
  v_xor_b32 v12, 128, v28
  v_xor_b32 v108, 128, v29
  v_xor_b32 v13, 160, v28
  v_xor_b32 v109, 160, v29
  v_xor_b32 v14, 192, v28
  v_xor_b32 v110, 192, v29
  v_xor_b32 v15, 224, v28
  v_xor_b32 v111, 224, v29
  s_mov_b32 s52, 1035512379
  s_waitcnt vmcnt(4)
  ds_read_b128 v[120:123], v104 offset:16384
  ds_read_b128 v[124:127], v105 offset:16384
  ds_read_b128 v[128:131], v106 offset:16384
  ds_read_b128 v[132:135], v107 offset:16384
  ds_read_b128 v[136:139], v108 offset:16384
  ds_read_b128 v[140:143], v109 offset:16384
  ds_read_b128 v[144:147], v110 offset:16384
  ds_read_b128 v[148:151], v111 offset:16384
  s_waitcnt lgkmcnt(4)
  ds_read_b128 v[152:155], v104 offset:16640
  ds_read_b128 v[156:159], v105 offset:16640
  ds_read_b128 v[160:163], v106 offset:16640
  ds_read_b128 v[164:167], v107 offset:16640
  ds_read_b128 v[168:171], v108 offset:16640
  ds_read_b128 v[172:175], v109 offset:16640
  ds_read_b128 v[176:179], v110 offset:16640
  ds_read_b128 v[180:183], v111 offset:16640
  s_waitcnt lgkmcnt(4)
  ds_read_b128 v[184:187], v104 offset:32768
  ds_read_b128 v[188:191], v105 offset:32768
  ds_read_b128 v[192:195], v106 offset:32768
  ds_read_b128 v[196:199], v107 offset:32768
  ds_read_b128 v[200:203], v108 offset:32768
  ds_read_b128 v[204:207], v109 offset:32768
  ds_read_b128 v[208:211], v110 offset:32768
  ds_read_b128 v[212:215], v111 offset:32768
  s_waitcnt lgkmcnt(4)
  ds_read_b128 v[216:219], v104 offset:33024
  ds_read_b128 v[220:223], v105 offset:33024
  ds_read_b128 v[224:227], v106 offset:33024
  ds_read_b128 v[228:231], v107 offset:33024
  ds_read_b128 v[232:235], v108 offset:33024
  ds_read_b128 v[236:239], v109 offset:33024
  ds_read_b128 v[240:243], v110 offset:33024
  ds_read_b128 v[244:247], v111 offset:33024
  s_waitcnt lgkmcnt(4)
  s_waitcnt lgkmcnt(0)
  s_add_u32 s22, s27, 262144
  s_add_u32 m0, s25, 16384
  s_nop 0
  buffer_load_dwordx4 v4, s[56:59], s22 offen offset:0 lds
  buffer_load_dwordx4 v5, s[56:59], s22 offen offset:1024 lds
  buffer_load_dwordx4 v6, s[56:59], s22 offen offset:2048 lds
  buffer_load_dwordx4 v7, s[56:59], s22 offen offset:3072 lds
  s_add_u32 s22, s27, 524288
  s_add_u32 m0, s25, 32768
  s_nop 0
  buffer_load_dwordx4 v4, s[56:59], s22 offen offset:0 lds
  buffer_load_dwordx4 v5, s[56:59], s22 offen offset:1024 lds
  buffer_load_dwordx4 v6, s[56:59], s22 offen offset:2048 lds
  buffer_load_dwordx4 v7, s[56:59], s22 offen offset:3072 lds
  s_add_u32 s22, s27, 786432
  s_add_u32 m0, s25, 49152
  s_nop 0
  buffer_load_dwordx4 v4, s[56:59], s22 offen offset:0 lds
  buffer_load_dwordx4 v5, s[56:59], s22 offen offset:1024 lds
  buffer_load_dwordx4 v6, s[56:59], s22 offen offset:2048 lds
  buffer_load_dwordx4 v7, s[56:59], s22 offen offset:3072 lds
  s_cmp_lg_u32 s66, 0
  s_cbranch_scc1 sc_cf
  s_cmp_lg_u32 s16, 0
  s_cbranch_scc1 w0_3
  s_waitcnt vmcnt(12)
  v_readfirstlane_b32 s70, v250
  s_cmp_lg_u32 s70, 0
  s_cbranch_scc1 sc_nz
  v_mov_b32 v249, 128
  v_mov_b32 v250, s88
  v_mov_b32 v251, s89
  v_mov_b32 v252, 0
  v_mov_b32 v253, 0
  s_mov_b64 exec, 1
  buffer_atomic_cmpswap_x2 v[250:253], v249, s[12:15], 0 offen sc0
  s_mov_b64 exec, -1
  s_waitcnt vmcnt(0)
  v_readfirstlane_b32 s70, v250
  s_cmp_lg_u32 s70, 0
  s_cbranch_scc1 sc_nz
  v_mov_b32 v250, s88
  v_mov_b32 v251, s89
sc_nz:
w0_3:
  v_mov_b32 v249, 160000
  s_add_u32 s101, s101, 1
  s_barrier
  s_mov_b64 exec, 1
  s_cmp_lg_u32 s16, 0
  s_cbranch_scc1 w0_4
  ds_write_b32 v249, v248 offset:0
  ds_write_b32 v249, v250 offset:4
  ds_write_b32 v249, v251 offset:8
  s_waitcnt lgkmcnt(0)
  v_mov_b32 v248, s101
  ds_write_b32 v249, v248 offset:16
  s_waitcnt lgkmcnt(0)
w0_4:
  s_mov_b64 exec, -1
  s_barrier
  ds_read_b32 v248, v249 offset:0
  ds_read_b32 v250, v249 offset:4
  ds_read_b32 v251, v249 offset:8
  ds_read_b32 v249, v249 offset:16
  s_waitcnt lgkmcnt(0)
  v_readfirstlane_b32 s70, v248
  v_readfirstlane_b32 s88, v250
  v_readfirstlane_b32 s89, v251
  v_cmp_ne_u32 vcc, s101, v249
  s_cbranch_vccnz ch_end
  s_mov_b32 s66, 1
  s_bitcmp1_b32 s70, s3
  s_cbranch_scc1 m_reclaim
sc_cf:
  s_cmp_lg_u32 s16, 0
  s_cbranch_scc1 w0_5
  s_cmp_eq_u32 s67, 0
  s_cselect_b32 s20, 1, 0x10001
  v_mov_b32 v248, s20
  v_mov_b32 v249, 0
  s_mov_b64 exec, 1
  buffer_atomic_add v248, v249, s[12:15], 0 offen
  s_mov_b64 exec, -1
w0_5:
  s_lshl_b32 s28, s17, 7
  s_add_u32 s28, s28, 88621120
  v_min_u32 v113, 32, v2
  s_mov_b32 s29, 88590336
  v_add_u32 v112, 1024, v2
  v_min_u32 v112, 1776, v112
  s_waitcnt vmcnt(8)
  s_barrier
  ds_read_b128 v[16:19], v8 offset:0
  ds_read_b128 v[20:23], v9 offset:0
  ds_read_b128 v[24:27], v10 offset:0
  ds_read_b128 v[28:31], v11 offset:0
  s_waitcnt lgkmcnt(3)
  v_mfma_f32_32x32x16_bf16 v[32:47], v[16:19], v[120:123], 0
  s_add_u32 s22, s27, 1048576
  s_add_u32 m0, s25, 65536
  s_nop 0
  buffer_load_dwordx4 v4, s[56:59], s22 offen offset:0 lds
  v_mfma_f32_32x32x16_bf16 v[48:63], v[16:19], v[184:187], 0
  ds_read_b128 v[16:19], v12 offset:0
  s_waitcnt lgkmcnt(3)
  v_mfma_f32_32x32x16_bf16 v[32:47], v[20:23], v[124:127], v[32:47]
  buffer_load_dwordx4 v5, s[56:59], s22 offen offset:1024 lds
  v_mfma_f32_32x32x16_bf16 v[48:63], v[20:23], v[188:191], v[48:63]
  ds_read_b128 v[20:23], v13 offset:0
  s_waitcnt lgkmcnt(3)
  v_mfma_f32_32x32x16_bf16 v[32:47], v[24:27], v[128:131], v[32:47]
  buffer_load_dwordx4 v6, s[56:59], s22 offen offset:2048 lds
  v_mfma_f32_32x32x16_bf16 v[48:63], v[24:27], v[192:195], v[48:63]
  ds_read_b128 v[24:27], v14 offset:0
  s_waitcnt lgkmcnt(3)
  v_mfma_f32_32x32x16_bf16 v[32:47], v[28:31], v[132:135], v[32:47]
  buffer_load_dwordx4 v7, s[56:59], s22 offen offset:3072 lds
  v_mfma_f32_32x32x16_bf16 v[48:63], v[28:31], v[196:199], v[48:63]
  ds_read_b128 v[28:31], v15 offset:0
  s_waitcnt lgkmcnt(3)
  v_mfma_f32_32x32x16_bf16 v[32:47], v[16:19], v[136:139], v[32:47]
  s_add_u32 s22, s27, 1310720
  s_add_u32 m0, s25, 81920
  s_nop 0
  buffer_load_dwordx4 v4, s[56:59], s22 offen offset:0 lds
  v_mfma_f32_32x32x16_bf16 v[48:63], v[16:19], v[200:203], v[48:63]
  ds_read_b128 v[16:19], v8 offset:256
  s_waitcnt lgkmcnt(3)
  v_mfma_f32_32x32x16_bf16 v[32:47], v[20:23], v[140:143], v[32:47]
  buffer_load_dwordx4 v5, s[56:59], s22 offen offset:1024 lds
  v_mfma_f32_32x32x16_bf16 v[48:63], v[20:23], v[204:207], v[48:63]
  ds_read_b128 v[20:23], v9 offset:256
  s_waitcnt lgkmcnt(3)
  v_mfma_f32_32x32x16_bf16 v[32:47], v[24:27], v[144:147], v[32:47]
  buffer_load_dwordx4 v6, s[56:59], s22 offen offset:2048 lds
  v_mfma_f32_32x32x16_bf16 v[48:63], v[24:27], v[208:211], v[48:63]
  ds_read_b128 v[24:27], v10 offset:256
  s_waitcnt lgkmcnt(3)
  v_mfma_f32_32x32x16_bf16 v[32:47], v[28:31], v[148:151], v[32:47]
  buffer_load_dwordx4 v7, s[56:59], s22 offen offset:3072 lds
  v_mfma_f32_32x32x16_bf16 v[48:63], v[28:31], v[212:215], v[48:63]
  ds_read_b128 v[28:31], v11 offset:256
  s_waitcnt lgkmcnt(3)
  v_mfma_f32_32x32x16_bf16 v[32:47], v[16:19], v[152:155], v[32:47]
  s_add_u32 s22, s27, 1572864
  s_add_u32 m0, s25, 98304
  s_nop 0
  buffer_load_dwordx4 v4, s[56:59], s22 offen offset:0 lds
  v_mfma_f32_32x32x16_bf16 v[48:63], v[16:19], v[216:219], v[48:63]
  ds_read_b128 v[16:19], v12 offset:256
  s_waitcnt lgkmcnt(3)
  v_mfma_f32_32x32x16_bf16 v[32:47], v[20:23], v[156:159], v[32:47]
  buffer_load_dwordx4 v5, s[56:59], s22 offen offset:1024 lds
  v_mfma_f32_32x32x16_bf16 v[48:63], v[20:23], v[220:223], v[48:63]
  ds_read_b128 v[20:23], v13 offset:256
  s_waitcnt lgkmcnt(3)
  v_mfma_f32_32x32x16_bf16 v[32:47], v[24:27], v[160:163], v[32:47]
  buffer_load_dwordx4 v6, s[56:59], s22 offen offset:2048 lds
  v_mfma_f32_32x32x16_bf16 v[48:63], v[24:27], v[224:227], v[48:63]
  ds_read_b128 v[24:27], v14 offset:256
  s_waitcnt lgkmcnt(3)
  v_mfma_f32_32x32x16_bf16 v[32:47], v[28:31], v[164:167], v[32:47]
  buffer_load_dwordx4 v7, s[56:59], s22 offen offset:3072 lds
  v_mfma_f32_32x32x16_bf16 v[48:63], v[28:31], v[228:231], v[48:63]
  ds_read_b128 v[28:31], v15 offset:256
  s_waitcnt lgkmcnt(3)
  v_mfma_f32_32x32x16_bf16 v[32:47], v[16:19], v[168:171], v[32:47]
  s_add_u32 s22, s27, 1835008
  s_add_u32 m0, s25, 114688
  s_nop 0
  buffer_load_dwordx4 v4, s[56:59], s22 offen offset:0 lds
  v_mfma_f32_32x32x16_bf16 v[48:63], v[16:19], v[232:235], v[48:63]
  ds_read_b128 v[16:19], v8 offset:16384
  s_waitcnt lgkmcnt(3)
  v_mfma_f32_32x32x16_bf16 v[32:47], v[20:23], v[172:175], v[32:47]
  buffer_load_dwordx4 v5, s[56:59], s22 offen offset:1024 lds
  v_mfma_f32_32x32x16_bf16 v[48:63], v[20:23], v[236:239], v[48:63]
  ds_read_b128 v[20:23], v9 offset:16384
  s_waitcnt lgkmcnt(3)
  v_mfma_f32_32x32x16_bf16 v[32:47], v[24:27], v[176:179], v[32:47]
  buffer_load_dwordx4 v6, s[56:59], s22 offen offset:2048 lds
  v_mfma_f32_32x32x16_bf16 v[48:63], v[24:27], v[240:243], v[48:63]
  ds_read_b128 v[24:27], v10 offset:16384
  s_waitcnt lgkmcnt(3)
  v_mfma_f32_32x32x16_bf16 v[32:47], v[28:31], v[180:183], v[32:47]
  buffer_load_dwordx4 v7, s[56:59], s22 offen offset:3072 lds
  v_mfma_f32_32x32x16_bf16 v[48:63], v[28:31], v[244:247], v[48:63]
  s_waitcnt vmcnt(16)
  s_barrier
  ds_read_b128 v[28:31], v11 offset:16384
  s_waitcnt lgkmcnt(3)
  v_mfma_f32_32x32x16_bf16 v[64:79], v[16:19], v[120:123], 0
  s_add_u32 s22, s27, 2097152
  s_add_u32 m0, s25, 131072
  s_nop 0
  buffer_load_dwordx4 v4, s[56:59], s22 offen offset:0 lds
  v_mfma_f32_32x32x16_bf16 v[80:95], v[16:19], v[184:187], 0
  ds_read_b128 v[16:19], v12 offset:16384
  s_waitcnt lgkmcnt(3)
  v_mfma_f32_32x32x16_bf16 v[64:79], v[20:23], v[124:127], v[64:79]
  buffer_load_dwordx4 v5, s[56:59], s22 offen offset:1024 lds
  v_mul_f32 v32, s52, v32
  v_mul_f32 v33, s52, v33
  v_cvt_pk_bf16_f32 v32, v32, v33
  v_mfma_f32_32x32x16_bf16 v[80:95], v[20:23], v[188:191], v[80:95]
  v_mul_f32 v34, s52, v34
  v_mul_f32 v35, s52, v35
  ds_read_b128 v[20:23], v13 offset:16384
  s_waitcnt lgkmcnt(3)
  v_mfma_f32_32x32x16_bf16 v[64:79], v[24:27], v[128:131], v[64:79]
  buffer_load_dwordx4 v6, s[56:59], s22 offen offset:2048 lds
  v_cvt_pk_bf16_f32 v33, v34, v35
  v_mul_f32 v36, s52, v36
  v_mul_f32 v37, s52, v37
  v_mfma_f32_32x32x16_bf16 v[80:95], v[24:27], v[192:195], v[80:95]
  v_cvt_pk_bf16_f32 v34, v36, v37
  v_mul_f32 v38, s52, v38
  ds_read_b128 v[24:27], v14 offset:16384
  s_waitcnt lgkmcnt(3)
  v_mfma_f32_32x32x16_bf16 v[64:79], v[28:31], v[132:135], v[64:79]
  buffer_load_dwordx4 v7, s[56:59], s22 offen offset:3072 lds
  v_mul_f32 v39, s52, v39
  v_cvt_pk_bf16_f32 v35, v38, v39
  v_mul_f32 v40, s52, v40
  v_mfma_f32_32x32x16_bf16 v[80:95], v[28:31], v[196:199], v[80:95]
  v_mul_f32 v41, s52, v41
  v_cvt_pk_bf16_f32 v40, v40, v41
  ds_read_b128 v[28:31], v15 offset:16384
  s_waitcnt lgkmcnt(3)
  v_mfma_f32_32x32x16_bf16 v[64:79], v[16:19], v[136:139], v[64:79]
  s_add_u32 s22, s27, 2359296
  s_add_u32 m0, s25, 0
  s_nop 0
  buffer_load_dwordx4 v4, s[56:59], s22 offen offset:0 lds
  v_mul_f32 v42, s52, v42
  v_mul_f32 v43, s52, v43
  v_cvt_pk_bf16_f32 v41, v42, v43
  v_mfma_f32_32x32x16_bf16 v[80:95], v[16:19], v[200:203], v[80:95]
  v_mul_f32 v44, s52, v44
  v_mul_f32 v45, s52, v45
  ds_read_b128 v[16:19], v8 offset:16640
  s_waitcnt lgkmcnt(3)
  v_mfma_f32_32x32x16_bf16 v[64:79], v[20:23], v[140:143], v[64:79]
  buffer_load_dwordx4 v5, s[56:59], s22 offen offset:1024 lds
  v_cvt_pk_bf16_f32 v42, v44, v45
  v_mul_f32 v46, s52, v46
  v_mul_f32 v47, s52, v47
  v_mfma_f32_32x32x16_bf16 v[80:95], v[20:23], v[204:207], v[80:95]
  v_cvt_pk_bf16_f32 v43, v46, v47
  v_permlane16_swap_b32 v32, v40
  ds_read_b128 v[20:23], v9 offset:16640
  s_waitcnt lgkmcnt(3)
  v_mfma_f32_32x32x16_bf16 v[64:79], v[24:27], v[144:147], v[64:79]
  buffer_load_dwordx4 v6, s[56:59], s22 offen offset:2048 lds
  v_permlane16_swap_b32 v33, v41
  v_permlane16_swap_b32 v34, v42
  v_permlane16_swap_b32 v35, v43
  v_mfma_f32_32x32x16_bf16 v[80:95], v[24:27], v[208:211], v[80:95]
  v_accvgpr_write_b32 a0, v32
  v_accvgpr_write_b32 a1, v33
  ds_read_b128 v[24:27], v10 offset:16640
  s_waitcnt lgkmcnt(3)
  v_mfma_f32_32x32x16_bf16 v[64:79], v[28:31], v[148:151], v[64:79]
  buffer_load_dwordx4 v7, s[56:59], s22 offen offset:3072 lds
  v_accvgpr_write_b32 a2, v34
  v_accvgpr_write_b32 a3, v35
  v_accvgpr_write_b32 a56, v40
  v_mfma_f32_32x32x16_bf16 v[80:95], v[28:31], v[212:215], v[80:95]
  v_accvgpr_write_b32 a57, v41
  v_accvgpr_write_b32 a58, v42
  ds_read_b128 v[28:31], v11 offset:16640
  s_waitcnt lgkmcnt(3)
  v_mfma_f32_32x32x16_bf16 v[64:79], v[16:19], v[152:155], v[64:79]
  v_accvgpr_write_b32 a59, v43
  v_mul_f32 v48, s52, v48
  v_mul_f32 v49, s52, v49
  v_mfma_f32_32x32x16_bf16 v[80:95], v[16:19], v[216:219], v[80:95]
  v_cvt_pk_bf16_f32 v48, v48, v49
  v_mul_f32 v50, s52, v50
  ds_read_b128 v[16:19], v12 offset:16640
  s_waitcnt lgkmcnt(3)
  v_mfma_f32_32x32x16_bf16 v[64:79], v[20:23], v[156:159], v[64:79]
  v_mul_f32 v51, s52, v51
  v_cvt_pk_bf16_f32 v49, v50, v51
  v_mul_f32 v52, s52, v52
  v_mfma_f32_32x32x16_bf16 v[80:95], v[20:23], v[220:223], v[80:95]
  v_mul_f32 v53, s52, v53
  v_cvt_pk_bf16_f32 v50, v52, v53
  ds_read_b128 v[20:23], v13 offset:16640
  s_waitcnt lgkmcnt(3)
  v_mfma_f32_32x32x16_bf16 v[64:79], v[24:27], v[160:163], v[64:79]
  v_mul_f32 v54, s52, v54
  v_mul_f32 v55, s52, v55
  v_cvt_pk_bf16_f32 v51, v54, v55
  v_mfma_f32_32x32x16_bf16 v[80:95], v[24:27], v[224:227], v[80:95]
  v_mul_f32 v56, s52, v56
  v_mul_f32 v57, s52, v57
  ds_read_b128 v[24:27], v14 offset:16640
  s_waitcnt lgkmcnt(3)
  v_mfma_f32_32x32x16_bf16 v[64:79], v[28:31], v[164:167], v[64:79]
  v_cvt_pk_bf16_f32 v56, v56, v57
  v_mul_f32 v58, s52, v58
  v_mul_f32 v59, s52, v59
  v_mfma_f32_32x32x16_bf16 v[80:95], v[28:31], v[228:231], v[80:95]
  v_cvt_pk_bf16_f32 v57, v58, v59
  v_mul_f32 v60, s52, v60
  ds_read_b128 v[28:31], v15 offset:16640
  s_waitcnt lgkmcnt(3)
  v_mfma_f32_32x32x16_bf16 v[64:79], v[16:19], v[168:171], v[64:79]
  v_mul_f32 v61, s52, v61
  v_cvt_pk_bf16_f32 v58, v60, v61
  v_mul_f32 v62, s52, v62
  v_mfma_f32_32x32x16_bf16 v[80:95], v[16:19], v[232:235], v[80:95]
  v_mul_f32 v63, s52, v63
  v_cvt_pk_bf16_f32 v59, v62, v63
  ds_read_b128 v[16:19], v8 offset:32768
  s_waitcnt lgkmcnt(3)
  v_mfma_f32_32x32x16_bf16 v[64:79], v[20:23], v[172:175], v[64:79]
  v_permlane16_swap_b32 v48, v56
  v_permlane16_swap_b32 v49, v57
  v_permlane16_swap_b32 v50, v58
  v_mfma_f32_32x32x16_bf16 v[80:95], v[20:23], v[236:239], v[80:95]
  v_permlane16_swap_b32 v51, v59
  v_accvgpr_write_b32 a112, v48
  ds_read_b128 v[20:23], v9 offset:32768
  s_waitcnt lgkmcnt(3)
  v_mfma_f32_32x32x16_bf16 v[64:79], v[24:27], v[176:179], v[64:79]
  v_accvgpr_write_b32 a113, v49
  v_accvgpr_write_b32 a114, v50
  v_accvgpr_write_b32 a115, v51
  v_mfma_f32_32x32x16_bf16 v[80:95], v[24:27], v[240:243], v[80:95]
  v_accvgpr_write_b32 a168, v56
  v_accvgpr_write_b32 a169, v57
  ds_read_b128 v[24:27], v10 offset:32768
  s_waitcnt lgkmcnt(3)
  v_mfma_f32_32x32x16_bf16 v[64:79], v[28:31], v[180:183], v[64:79]
  v_accvgpr_write_b32 a170, v58
  v_accvgpr_write_b32 a171, v59
  v_mfma_f32_32x32x16_bf16 v[80:95], v[28:31], v[244:247], v[80:95]
  ds_read_b128 v[28:31], v11 offset:32768
  s_waitcnt lgkmcnt(3)
  v_mfma_f32_32x32x16_bf16 v[32:47], v[16:19], v[120:123], 0
  v_mfma_f32_32x32x16_bf16 v[48:63], v[16:19], v[184:187], 0
  ds_read_b128 v[16:19], v12 offset:32768
  s_waitcnt lgkmcnt(3)
  v_mfma_f32_32x32x16_bf16 v[32:47], v[20:23], v[124:127], v[32:47]
  v_mul_f32 v64, s52, v64
  v_mul_f32 v65, s52, v65
  v_cvt_pk_bf16_f32 v64, v64, v65
  v_mfma_f32_32x32x16_bf16 v[48:63], v[20:23], v[188:191], v[48:63]
  v_mul_f32 v66, s52, v66
  v_mul_f32 v67, s52, v67
  ds_read_b128 v[20:23], v13 offset:32768
  s_waitcnt lgkmcnt(3)
  v_mfma_f32_32x32x16_bf16 v[32:47], v[24:27], v[128:131], v[32:47]
  v_cvt_pk_bf16_f32 v65, v66, v67
  v_mul_f32 v68, s52, v68
  v_mul_f32 v69, s52, v69
  v_mfma_f32_32x32x16_bf16 v[48:63], v[24:27], v[192:195], v[48:63]
  v_cvt_pk_bf16_f32 v66, v68, v69
  v_mul_f32 v70, s52, v70
  ds_read_b128 v[24:27], v14 offset:32768
  s_waitcnt lgkmcnt(3)
  v_mfma_f32_32x32x16_bf16 v[32:47], v[28:31], v[132:135], v[32:47]
  v_mul_f32 v71, s52, v71
  v_cvt_pk_bf16_f32 v67, v70, v71
  v_mul_f32 v72, s52, v72
  v_mfma_f32_32x32x16_bf16 v[48:63], v[28:31], v[196:199], v[48:63]
  v_mul_f32 v73, s52, v73
  v_cvt_pk_bf16_f32 v72, v72, v73
  ds_read_b128 v[28:31], v15 offset:32768
  s_waitcnt lgkmcnt(3)
  v_mfma_f32_32x32x16_bf16 v[32:47], v[16:19], v[136:139], v[32:47]
  v_mul_f32 v74, s52, v74
  v_mul_f32 v75, s52, v75
  v_cvt_pk_bf16_f32 v73, v74, v75
  v_mfma_f32_32x32x16_bf16 v[48:63], v[16:19], v[200:203], v[48:63]
  v_mul_f32 v76, s52, v76
  v_mul_f32 v77, s52, v77
  ds_read_b128 v[16:19], v8 offset:33024
  s_waitcnt lgkmcnt(3)
  v_mfma_f32_32x32x16_bf16 v[32:47], v[20:23], v[140:143], v[32:47]
  v_cvt_pk_bf16_f32 v74, v76, v77
  v_mul_f32 v78, s52, v78
  v_mul_f32 v79, s52, v79
  v_mfma_f32_32x32x16_bf16 v[48:63], v[20:23], v[204:207], v[48:63]
  v_cvt_pk_bf16_f32 v75, v78, v79
  v_permlane16_swap_b32 v64, v72
  ds_read_b128 v[20:23], v9 offset:33024
  s_waitcnt lgkmcnt(3)
  v_mfma_f32_32x32x16_bf16 v[32:47], v[24:27], v[144:147], v[32:47]
  v_permlane16_swap_b32 v65, v73
  v_permlane16_swap_b32 v66, v74
  v_permlane16_swap_b32 v67, v75
  v_mfma_f32_32x32x16_bf16 v[48:63], v[24:27], v[208:211], v[48:63]
  v_accvgpr_write_b32 a4, v64
  v_accvgpr_write_b32 a5, v65
  ds_read_b128 v[24:27], v10 offset:33024
  s_waitcnt lgkmcnt(3)
  v_mfma_f32_32x32x16_bf16 v[32:47], v[28:31], v[148:151], v[32:47]
  v_accvgpr_write_b32 a6, v66
  v_accvgpr_write_b32 a7, v67
  v_accvgpr_write_b32 a60, v72
  v_mfma_f32_32x32x16_bf16 v[48:63], v[28:31], v[212:215], v[48:63]
  v_accvgpr_write_b32 a61, v73
  v_accvgpr_write_b32 a62, v74
  ds_read_b128 v[28:31], v11 offset:33024
  s_waitcnt lgkmcnt(3)
  v_mfma_f32_32x32x16_bf16 v[32:47], v[16:19], v[152:155], v[32:47]
  v_accvgpr_write_b32 a63, v75
  v_mul_f32 v80, s52, v80
  v_mul_f32 v81, s52, v81
  v_mfma_f32_32x32x16_bf16 v[48:63], v[16:19], v[216:219], v[48:63]
  v_cvt_pk_bf16_f32 v80, v80, v81
  v_mul_f32 v82, s52, v82
  ds_read_b128 v[16:19], v12 offset:33024
  s_waitcnt lgkmcnt(3)
  v_mfma_f32_32x32x16_bf16 v[32:47], v[20:23], v[156:159], v[32:47]
  v_mul_f32 v83, s52, v83
  v_cvt_pk_bf16_f32 v81, v82, v83
  v_mul_f32 v84, s52, v84
  v_mfma_f32_32x32x16_bf16 v[48:63], v[20:23], v[220:223], v[48:63]
  v_mul_f32 v85, s52, v85
  v_cvt_pk_bf16_f32 v82, v84, v85
  ds_read_b128 v[20:23], v13 offset:33024
  s_waitcnt lgkmcnt(3)
  v_mfma_f32_32x32x16_bf16 v[32:47], v[24:27], v[160:163], v[32:47]
  v_mul_f32 v86, s52, v86
  v_mul_f32 v87, s52, v87
  v_cvt_pk_bf16_f32 v83, v86, v87
  v_mfma_f32_32x32x16_bf16 v[48:63], v[24:27], v[224:227], v[48:63]
  v_mul_f32 v88, s52, v88
  v_mul_f32 v89, s52, v89
  ds_read_b128 v[24:27], v14 offset:33024
  s_waitcnt lgkmcnt(3)
  v_mfma_f32_32x32x16_bf16 v[32:47], v[28:31], v[164:167], v[32:47]
  v_cvt_pk_bf16_f32 v88, v88, v89
  v_mul_f32 v90, s52, v90
  v_mul_f32 v91, s52, v91
  v_mfma_f32_32x32x16_bf16 v[48:63], v[28:31], v[228:231], v[48:63]
  v_cvt_pk_bf16_f32 v89, v90, v91
  v_mul_f32 v92, s52, v92
  ds_read_b128 v[28:31], v15 offset:33024
  s_waitcnt lgkmcnt(3)
  v_mfma_f32_32x32x16_bf16 v[32:47], v[16:19], v[168:171], v[32:47]
  v_mul_f32 v93, s52, v93
  v_cvt_pk_bf16_f32 v90, v92, v93
  v_mul_f32 v94, s52, v94
  v_mfma_f32_32x32x16_bf16 v[48:63], v[16:19], v[232:235], v[48:63]
  v_mul_f32 v95, s52, v95
  v_cvt_pk_bf16_f32 v91, v94, v95
  ds_read_b128 v[16:19], v8 offset:49152
  s_waitcnt lgkmcnt(3)
  v_mfma_f32_32x32x16_bf16 v[32:47], v[20:23], v[172:175], v[32:47]
  v_permlane16_swap_b32 v80, v88
  v_permlane16_swap_b32 v81, v89
  v_permlane16_swap_b32 v82, v90
  v_mfma_f32_32x32x16_bf16 v[48:63], v[20:23], v[236:239], v[48:63]
  v_permlane16_swap_b32 v83, v91
  v_accvgpr_write_b32 a116, v80
  ds_read_b128 v[20:23], v9 offset:49152
  s_waitcnt lgkmcnt(3)
  v_mfma_f32_32x32x16_bf16 v[32:47], v[24:27], v[176:179], v[32:47]
  v_accvgpr_write_b32 a117, v81
  v_accvgpr_write_b32 a118, v82
  v_accvgpr_write_b32 a119, v83
  v_mfma_f32_32x32x16_bf16 v[48:63], v[24:27], v[240:243], v[48:63]
  v_accvgpr_write_b32 a172, v88
  v_accvgpr_write_b32 a173, v89
  ds_read_b128 v[24:27], v10 offset:49152
  s_waitcnt lgkmcnt(3)
  v_mfma_f32_32x32x16_bf16 v[32:47], v[28:31], v[180:183], v[32:47]
  v_accvgpr_write_b32 a174, v90
  v_accvgpr_write_b32 a175, v91
  v_mfma_f32_32x32x16_bf16 v[48:63], v[28:31], v[244:247], v[48:63]
  s_waitcnt vmcnt(16)
  s_barrier
  ds_read_b128 v[28:31], v11 offset:49152
  s_waitcnt lgkmcnt(3)
  v_mfma_f32_32x32x16_bf16 v[64:79], v[16:19], v[120:123], 0
  s_add_u32 s22, s27, 2621440
  s_add_u32 m0, s25, 16384
  s_nop 0
  buffer_load_dwordx4 v4, s[56:59], s22 offen offset:0 lds
  v_mfma_f32_32x32x16_bf16 v[80:95], v[16:19], v[184:187], 0
  ds_read_b128 v[16:19], v12 offset:49152
  s_waitcnt lgkmcnt(3)
  v_mfma_f32_32x32x16_bf16 v[64:79], v[20:23], v[124:127], v[64:79]
  buffer_load_dwordx4 v5, s[56:59], s22 offen offset:1024 lds
  v_mul_f32 v32, s52, v32
  v_mul_f32 v33, s52, v33
  v_cvt_pk_bf16_f32 v32, v32, v33
  v_mfma_f32_32x32x16_bf16 v[80:95], v[20:23], v[188:191], v[80:95]
  v_mul_f32 v34, s52, v34
  v_mul_f32 v35, s52, v35
  ds_read_b128 v[20:23], v13 offset:49152
  s_waitcnt lgkmcnt(3)
  v_mfma_f32_32x32x16_bf16 v[64:79], v[24:27], v[128:131], v[64:79]
  buffer_load_dwordx4 v6, s[56:59], s22 offen offset:2048 lds
  v_cvt_pk_bf16_f32 v33, v34, v35
  v_mul_f32 v36, s52, v36
  v_mul_f32 v37, s52, v37
  v_mfma_f32_32x32x16_bf16 v[80:95], v[24:27], v[192:195], v[80:95]
  v_cvt_pk_bf16_f32 v34, v36, v37
  v_mul_f32 v38, s52, v38
  ds_read_b128 v[24:27], v14 offset:49152
  s_waitcnt lgkmcnt(3)
  v_mfma_f32_32x32x16_bf16 v[64:79], v[28:31], v[132:135], v[64:79]
  buffer_load_dwordx4 v7, s[56:59], s22 offen offset:3072 lds
  v_mul_f32 v39, s52, v39
  v_cvt_pk_bf16_f32 v35, v38, v39
  v_mul_f32 v40, s52, v40
  v_mfma_f32_32x32x16_bf16 v[80:95], v[28:31], v[196:199], v[80:95]
  v_mul_f32 v41, s52, v41
  v_cvt_pk_bf16_f32 v40, v40, v41
  ds_read_b128 v[28:31], v15 offset:49152
  s_waitcnt lgkmcnt(3)
  v_mfma_f32_32x32x16_bf16 v[64:79], v[16:19], v[136:139], v[64:79]
  s_add_u32 s22, s27, 2883584
  s_add_u32 m0, s25, 32768
  s_nop 0
  buffer_load_dwordx4 v4, s[56:59], s22 offen offset:0 lds
  v_mul_f32 v42, s52, v42
  v_mul_f32 v43, s52, v43
  v_cvt_pk_bf16_f32 v41, v42, v43
  v_mfma_f32_32x32x16_bf16 v[80:95], v[16:19], v[200:203], v[80:95]
  v_mul_f32 v44, s52, v44
  v_mul_f32 v45, s52, v45
  ds_read_b128 v[16:19], v8 offset:49408
  s_waitcnt lgkmcnt(3)
  v_mfma_f32_32x32x16_bf16 v[64:79], v[20:23], v[140:143], v[64:79]
  buffer_load_dwordx4 v5, s[56:59], s22 offen offset:1024 lds
  v_cvt_pk_bf16_f32 v42, v44, v45
  v_mul_f32 v46, s52, v46
  v_mul_f32 v47, s52, v47
  v_mfma_f32_32x32x16_bf16 v[80:95], v[20:23], v[204:207], v[80:95]
  v_cvt_pk_bf16_f32 v43, v46, v47
  v_permlane16_swap_b32 v32, v40
  ds_read_b128 v[20:23], v9 offset:49408
  s_waitcnt lgkmcnt(3)
  v_mfma_f32_32x32x16_bf16 v[64:79], v[24:27], v[144:147], v[64:79]
  buffer_load_dwordx4 v6, s[56:59], s22 offen offset:2048 lds
  v_permlane16_swap_b32 v33, v41
  v_permlane16_swap_b32 v34, v42
  v_permlane16_swap_b32 v35, v43
  v_mfma_f32_32x32x16_bf16 v[80:95], v[24:27], v[208:211], v[80:95]
  v_accvgpr_write_b32 a8, v32
  v_accvgpr_write_b32 a9, v33
  ds_read_b128 v[24:27], v10 offset:49408
  s_waitcnt lgkmcnt(3)
  v_mfma_f32_32x32x16_bf16 v[64:79], v[28:31], v[148:151], v[64:79]
  buffer_load_dwordx4 v7, s[56:59], s22 offen offset:3072 lds
  v_accvgpr_write_b32 a10, v34
  v_accvgpr_write_b32 a11, v35
  v_accvgpr_write_b32 a64, v40
  v_mfma_f32_32x32x16_bf16 v[80:95], v[28:31], v[212:215], v[80:95]
  v_accvgpr_write_b32 a65, v41
  v_accvgpr_write_b32 a66, v42
  ds_read_b128 v[28:31], v11 offset:49408
  s_waitcnt lgkmcnt(3)
  v_mfma_f32_32x32x16_bf16 v[64:79], v[16:19], v[152:155], v[64:79]
  v_accvgpr_write_b32 a67, v43
  v_mul_f32 v48, s52, v48
  v_mul_f32 v49, s52, v49
  v_mfma_f32_32x32x16_bf16 v[80:95], v[16:19], v[216:219], v[80:95]
  v_cvt_pk_bf16_f32 v48, v48, v49
  v_mul_f32 v50, s52, v50
  ds_read_b128 v[16:19], v12 offset:49408
  s_waitcnt lgkmcnt(3)
  v_mfma_f32_32x32x16_bf16 v[64:79], v[20:23], v[156:159], v[64:79]
  v_mul_f32 v51, s52, v51
  v_cvt_pk_bf16_f32 v49, v50, v51
  v_mul_f32 v52, s52, v52
  v_mfma_f32_32x32x16_bf16 v[80:95], v[20:23], v[220:223], v[80:95]
  v_mul_f32 v53, s52, v53
  v_cvt_pk_bf16_f32 v50, v52, v53
  ds_read_b128 v[20:23], v13 offset:49408
  s_waitcnt lgkmcnt(3)
  v_mfma_f32_32x32x16_bf16 v[64:79], v[24:27], v[160:163], v[64:79]
  v_mul_f32 v54, s52, v54
  v_mul_f32 v55, s52, v55
  v_cvt_pk_bf16_f32 v51, v54, v55
  v_mfma_f32_32x32x16_bf16 v[80:95], v[24:27], v[224:227], v[80:95]
  v_mul_f32 v56, s52, v56
  v_mul_f32 v57, s52, v57
  ds_read_b128 v[24:27], v14 offset:49408
  s_waitcnt lgkmcnt(3)
  v_mfma_f32_32x32x16_bf16 v[64:79], v[28:31], v[164:167], v[64:79]
  v_cvt_pk_bf16_f32 v56, v56, v57
  v_mul_f32 v58, s52, v58
  v_mul_f32 v59, s52, v59
  v_mfma_f32_32x32x16_bf16 v[80:95], v[28:31], v[228:231], v[80:95]
  v_cvt_pk_bf16_f32 v57, v58, v59
  v_mul_f32 v60, s52, v60
  ds_read_b128 v[28:31], v15 offset:49408
  s_waitcnt lgkmcnt(3)
  v_mfma_f32_32x32x16_bf16 v[64:79], v[16:19], v[168:171], v[64:79]
  v_mul_f32 v61, s52, v61
  v_cvt_pk_bf16_f32 v58, v60, v61
  v_mul_f32 v62, s52, v62
  v_mfma_f32_32x32x16_bf16 v[80:95], v[16:19], v[232:235], v[80:95]
  v_mul_f32 v63, s52, v63
  v_cvt_pk_bf16_f32 v59, v62, v63
  v_xor_b32 v8, 65536, v8
  ds_read_b128 v[16:19], v8 offset:0
  s_waitcnt lgkmcnt(3)
  v_mfma_f32_32x32x16_bf16 v[64:79], v[20:23], v[172:175], v[64:79]
  v_permlane16_swap_b32 v48, v56
  v_permlane16_swap_b32 v49, v57
  v_permlane16_swap_b32 v50, v58
  v_mfma_f32_32x32x16_bf16 v[80:95], v[20:23], v[236:239], v[80:95]
  v_permlane16_swap_b32 v51, v59
  v_accvgpr_write_b32 a120, v48
  v_xor_b32 v9, 65536, v9
  ds_read_b128 v[20:23], v9 offset:0
  s_waitcnt lgkmcnt(3)
  v_mfma_f32_32x32x16_bf16 v[64:79], v[24:27], v[176:179], v[64:79]
  v_accvgpr_write_b32 a121, v49
  v_accvgpr_write_b32 a122, v50
  v_accvgpr_write_b32 a123, v51
  v_mfma_f32_32x32x16_bf16 v[80:95], v[24:27], v[240:243], v[80:95]
  v_accvgpr_write_b32 a176, v56
  v_accvgpr_write_b32 a177, v57
  v_xor_b32 v10, 65536, v10
  ds_read_b128 v[24:27], v10 offset:0
  s_waitcnt lgkmcnt(3)
  v_mfma_f32_32x32x16_bf16 v[64:79], v[28:31], v[180:183], v[64:79]
  v_accvgpr_write_b32 a178, v58
  v_accvgpr_write_b32 a179, v59
  v_mfma_f32_32x32x16_bf16 v[80:95], v[28:31], v[244:247], v[80:95]
  v_xor_b32 v11, 65536, v11
  ds_read_b128 v[28:31], v11 offset:0
  s_waitcnt lgkmcnt(3)
  v_mfma_f32_32x32x16_bf16 v[32:47], v[16:19], v[120:123], 0
  v_mfma_f32_32x32x16_bf16 v[48:63], v[16:19], v[184:187], 0
  v_xor_b32 v12, 65536, v12
  ds_read_b128 v[16:19], v12 offset:0
  s_waitcnt lgkmcnt(3)
  v_mfma_f32_32x32x16_bf16 v[32:47], v[20:23], v[124:127], v[32:47]
  v_mul_f32 v64, s52, v64
  v_mul_f32 v65, s52, v65
  v_cvt_pk_bf16_f32 v64, v64, v65
  v_mfma_f32_32x32x16_bf16 v[48:63], v[20:23], v[188:191], v[48:63]
  v_mul_f32 v66, s52, v66
  v_mul_f32 v67, s52, v67
  v_xor_b32 v13, 65536, v13
  ds_read_b128 v[20:23], v13 offset:0
  s_waitcnt lgkmcnt(3)
  v_mfma_f32_32x32x16_bf16 v[32:47], v[24:27], v[128:131], v[32:47]
  v_cvt_pk_bf16_f32 v65, v66, v67
  v_mul_f32 v68, s52, v68
  v_mul_f32 v69, s52, v69
  v_mfma_f32_32x32x16_bf16 v[48:63], v[24:27], v[192:195], v[48:63]
  v_cvt_pk_bf16_f32 v66, v68, v69
  v_mul_f32 v70, s52, v70
  v_xor_b32 v14, 65536, v14
  ds_read_b128 v[24:27], v14 offset:0
  s_waitcnt lgkmcnt(3)
  v_mfma_f32_32x32x16_bf16 v[32:47], v[28:31], v[132:135], v[32:47]
  v_mul_f32 v71, s52, v71
  v_cvt_pk_bf16_f32 v67, v70, v71
  v_mul_f32 v72, s52, v72
  v_mfma_f32_32x32x16_bf16 v[48:63], v[28:31], v[196:199], v[48:63]
  v_mul_f32 v73, s52, v73
  v_cvt_pk_bf16_f32 v72, v72, v73
  v_xor_b32 v15, 65536, v15
  ds_read_b128 v[28:31], v15 offset:0
  s_waitcnt lgkmcnt(3)
  v_mfma_f32_32x32x16_bf16 v[32:47], v[16:19], v[136:139], v[32:47]
  v_mul_f32 v74, s52, v74
  v_mul_f32 v75, s52, v75
  v_cvt_pk_bf16_f32 v73, v74, v75
  v_mfma_f32_32x32x16_bf16 v[48:63], v[16:19], v[200:203], v[48:63]
  v_mul_f32 v76, s52, v76
  v_mul_f32 v77, s52, v77
  ds_read_b128 v[16:19], v8 offset:256
  s_waitcnt lgkmcnt(3)
  v_mfma_f32_32x32x16_bf16 v[32:47], v[20:23], v[140:143], v[32:47]
  v_cvt_pk_bf16_f32 v74, v76, v77
  v_mul_f32 v78, s52, v78
  v_mul_f32 v79, s52, v79
  v_mfma_f32_32x32x16_bf16 v[48:63], v[20:23], v[204:207], v[48:63]
  v_cvt_pk_bf16_f32 v75, v78, v79
  v_permlane16_swap_b32 v64, v72
  ds_read_b128 v[20:23], v9 offset:256
  s_waitcnt lgkmcnt(3)
  v_mfma_f32_32x32x16_bf16 v[32:47], v[24:27], v[144:147], v[32:47]
  v_permlane16_swap_b32 v65, v73
  v_permlane16_swap_b32 v66, v74
  v_permlane16_swap_b32 v67, v75
  v_mfma_f32_32x32x16_bf16 v[48:63], v[24:27], v[208:211], v[48:63]
  v_accvgpr_write_b32 a12, v64
  v_accvgpr_write_b32 a13, v65
  ds_read_b128 v[24:27], v10 offset:256
  s_waitcnt lgkmcnt(3)
  v_mfma_f32_32x32x16_bf16 v[32:47], v[28:31], v[148:151], v[32:47]
  v_accvgpr_write_b32 a14, v66
  v_accvgpr_write_b32 a15, v67
  v_accvgpr_write_b32 a68, v72
  v_mfma_f32_32x32x16_bf16 v[48:63], v[28:31], v[212:215], v[48:63]
  v_accvgpr_write_b32 a69, v73
  v_accvgpr_write_b32 a70, v74
  ds_read_b128 v[28:31], v11 offset:256
  s_waitcnt lgkmcnt(3)
  v_mfma_f32_32x32x16_bf16 v[32:47], v[16:19], v[152:155], v[32:47]
  v_accvgpr_write_b32 a71, v75
  v_mul_f32 v80, s52, v80
  v_mul_f32 v81, s52, v81
  v_mfma_f32_32x32x16_bf16 v[48:63], v[16:19], v[216:219], v[48:63]
  v_cvt_pk_bf16_f32 v80, v80, v81
  v_mul_f32 v82, s52, v82
  ds_read_b128 v[16:19], v12 offset:256
  s_waitcnt lgkmcnt(3)
  v_mfma_f32_32x32x16_bf16 v[32:47], v[20:23], v[156:159], v[32:47]
  v_mul_f32 v83, s52, v83
  v_cvt_pk_bf16_f32 v81, v82, v83
  v_mul_f32 v84, s52, v84
  v_mfma_f32_32x32x16_bf16 v[48:63], v[20:23], v[220:223], v[48:63]
  v_mul_f32 v85, s52, v85
  v_cvt_pk_bf16_f32 v82, v84, v85
  ds_read_b128 v[20:23], v13 offset:256
  s_waitcnt lgkmcnt(3)
  v_mfma_f32_32x32x16_bf16 v[32:47], v[24:27], v[160:163], v[32:47]
  v_mul_f32 v86, s52, v86
  v_mul_f32 v87, s52, v87
  v_cvt_pk_bf16_f32 v83, v86, v87
  v_mfma_f32_32x32x16_bf16 v[48:63], v[24:27], v[224:227], v[48:63]
  v_mul_f32 v88, s52, v88
  v_mul_f32 v89, s52, v89
  ds_read_b128 v[24:27], v14 offset:256
  s_waitcnt lgkmcnt(3)
  v_mfma_f32_32x32x16_bf16 v[32:47], v[28:31], v[164:167], v[32:47]
  v_cvt_pk_bf16_f32 v88, v88, v89
  v_mul_f32 v90, s52, v90
  v_mul_f32 v91, s52, v91
  v_mfma_f32_32x32x16_bf16 v[48:63], v[28:31], v[228:231], v[48:63]
  v_cvt_pk_bf16_f32 v89, v90, v91
  v_mul_f32 v92, s52, v92
  ds_read_b128 v[28:31], v15 offset:256
  s_waitcnt lgkmcnt(3)
  v_mfma_f32_32x32x16_bf16 v[32:47], v[16:19], v[168:171], v[32:47]
  v_mul_f32 v93, s52, v93
  v_cvt_pk_bf16_f32 v90, v92, v93
  v_mul_f32 v94, s52, v94
  v_mfma_f32_32x32x16_bf16 v[48:63], v[16:19], v[232:235], v[48:63]
  v_mul_f32 v95, s52, v95
  v_cvt_pk_bf16_f32 v91, v94, v95
  ds_read_b128 v[16:19], v8 offset:16384
  s_waitcnt lgkmcnt(3)
  v_mfma_f32_32x32x16_bf16 v[32:47], v[20:23], v[172:175], v[32:47]
  v_permlane16_swap_b32 v80, v88
  v_permlane16_swap_b32 v81, v89
  v_permlane16_swap_b32 v82, v90
  v_mfma_f32_32x32x16_bf16 v[48:63], v[20:23], v[236:239], v[48:63]
  v_permlane16_swap_b32 v83, v91
  v_accvgpr_write_b32 a124, v80
  ds_read_b128 v[20:23], v9 offset:16384
  s_waitcnt lgkmcnt(3)
  v_mfma_f32_32x32x16_bf16 v[32:47], v[24:27], v[176:179], v[32:47]
  v_accvgpr_write_b32 a125, v81
  v_accvgpr_write_b32 a126, v82
  v_accvgpr_write_b32 a127, v83
  v_mfma_f32_32x32x16_bf16 v[48:63], v[24:27], v[240:243], v[48:63]
  v_accvgpr_write_b32 a180, v88
  v_accvgpr_write_b32 a181, v89
  ds_read_b128 v[24:27], v10 offset:16384
  s_waitcnt lgkmcnt(3)
  v_mfma_f32_32x32x16_bf16 v[32:47], v[28:31], v[180:183], v[32:47]
  v_accvgpr_write_b32 a182, v90
  v_accvgpr_write_b32 a183, v91
  v_mfma_f32_32x32x16_bf16 v[48:63], v[28:31], v[244:247], v[48:63]
  s_waitcnt vmcnt(16)
  s_barrier
  ds_read_b128 v[28:31], v11 offset:16384
  s_waitcnt lgkmcnt(3)
  v_mfma_f32_32x32x16_bf16 v[64:79], v[16:19], v[120:123], 0
  s_add_u32 s22, s27, 3145728
  s_add_u32 m0, s25, 49152
  s_nop 0
  buffer_load_dwordx4 v4, s[56:59], s22 offen offset:0 lds
  v_mfma_f32_32x32x16_bf16 v[80:95], v[16:19], v[184:187], 0
  ds_read_b128 v[16:19], v12 offset:16384
  s_waitcnt lgkmcnt(3)
  v_mfma_f32_32x32x16_bf16 v[64:79], v[20:23], v[124:127], v[64:79]
  buffer_load_dwordx4 v5, s[56:59], s22 offen offset:1024 lds
  v_mul_f32 v32, s52, v32
  v_mul_f32 v33, s52, v33
  v_cvt_pk_bf16_f32 v32, v32, v33
  v_mfma_f32_32x32x16_bf16 v[80:95], v[20:23], v[188:191], v[80:95]
  v_mul_f32 v34, s52, v34
  v_mul_f32 v35, s52, v35
  ds_read_b128 v[20:23], v13 offset:16384
  s_waitcnt lgkmcnt(3)
  v_mfma_f32_32x32x16_bf16 v[64:79], v[24:27], v[128:131], v[64:79]
  buffer_load_dwordx4 v6, s[56:59], s22 offen offset:2048 lds
  v_cvt_pk_bf16_f32 v33, v34, v35
  v_mul_f32 v36, s52, v36
  v_mul_f32 v37, s52, v37
  v_mfma_f32_32x32x16_bf16 v[80:95], v[24:27], v[192:195], v[80:95]
  v_cvt_pk_bf16_f32 v34, v36, v37
  v_mul_f32 v38, s52, v38
  ds_read_b128 v[24:27], v14 offset:16384
  s_waitcnt lgkmcnt(3)
  v_mfma_f32_32x32x16_bf16 v[64:79], v[28:31], v[132:135], v[64:79]
  buffer_load_dwordx4 v7, s[56:59], s22 offen offset:3072 lds
  v_mul_f32 v39, s52, v39
  v_cvt_pk_bf16_f32 v35, v38, v39
  v_mul_f32 v40, s52, v40
  v_mfma_f32_32x32x16_bf16 v[80:95], v[28:31], v[196:199], v[80:95]
  v_mul_f32 v41, s52, v41
  v_cvt_pk_bf16_f32 v40, v40, v41
  ds_read_b128 v[28:31], v15 offset:16384
  s_waitcnt lgkmcnt(3)
  v_mfma_f32_32x32x16_bf16 v[64:79], v[16:19], v[136:139], v[64:79]
  s_add_u32 s22, s27, 3407872
  s_add_u32 m0, s25, 65536
  s_nop 0
  buffer_load_dwordx4 v4, s[56:59], s22 offen offset:0 lds
  v_mul_f32 v42, s52, v42
  v_mul_f32 v43, s52, v43
  v_cvt_pk_bf16_f32 v41, v42, v43
  v_mfma_f32_32x32x16_bf16 v[80:95], v[16:19], v[200:203], v[80:95]
  v_mul_f32 v44, s52, v44
  v_mul_f32 v45, s52, v45
  ds_read_b128 v[16:19], v8 offset:16640
  s_waitcnt lgkmcnt(3)
  v_mfma_f32_32x32x16_bf16 v[64:79], v[20:23], v[140:143], v[64:79]
  buffer_load_dwordx4 v5, s[56:59], s22 offen offset:1024 lds
  v_cvt_pk_bf16_f32 v42, v44, v45
  v_mul_f32 v46, s52, v46
  v_mul_f32 v47, s52, v47
  v_mfma_f32_32x32x16_bf16 v[80:95], v[20:23], v[204:207], v[80:95]
  v_cvt_pk_bf16_f32 v43, v46, v47
  v_permlane16_swap_b32 v32, v40
  ds_read_b128 v[20:23], v9 offset:16640
  s_waitcnt lgkmcnt(3)
  v_mfma_f32_32x32x16_bf16 v[64:79], v[24:27], v[144:147], v[64:79]
  buffer_load_dwordx4 v6, s[56:59], s22 offen offset:2048 lds
  v_permlane16_swap_b32 v33, v41
  v_permlane16_swap_b32 v34, v42
  v_permlane16_swap_b32 v35, v43
  v_mfma_f32_32x32x16_bf16 v[80:95], v[24:27], v[208:211], v[80:95]
  v_accvgpr_write_b32 a16, v32
  v_accvgpr_write_b32 a17, v33
  ds_read_b128 v[24:27], v10 offset:16640
  s_waitcnt lgkmcnt(3)
  v_mfma_f32_32x32x16_bf16 v[64:79], v[28:31], v[148:151], v[64:79]
  buffer_load_dwordx4 v7, s[56:59], s22 offen offset:3072 lds
  v_accvgpr_write_b32 a18, v34
  v_accvgpr_write_b32 a19, v35
  v_accvgpr_write_b32 a72, v40
  v_mfma_f32_32x32x16_bf16 v[80:95], v[28:31], v[212:215], v[80:95]
  v_accvgpr_write_b32 a73, v41
  v_accvgpr_write_b32 a74, v42
  ds_read_b128 v[28:31], v11 offset:16640
  s_waitcnt lgkmcnt(3)
  v_mfma_f32_32x32x16_bf16 v[64:79], v[16:19], v[152:155], v[64:79]
  v_accvgpr_write_b32 a75, v43
  v_mul_f32 v48, s52, v48
  v_mul_f32 v49, s52, v49
  v_mfma_f32_32x32x16_bf16 v[80:95], v[16:19], v[216:219], v[80:95]
  v_cvt_pk_bf16_f32 v48, v48, v49
  v_mul_f32 v50, s52, v50
  ds_read_b128 v[16:19], v12 offset:16640
  s_waitcnt lgkmcnt(3)
  v_mfma_f32_32x32x16_bf16 v[64:79], v[20:23], v[156:159], v[64:79]
  v_mul_f32 v51, s52, v51
  v_cvt_pk_bf16_f32 v49, v50, v51
  v_mul_f32 v52, s52, v52
  v_mfma_f32_32x32x16_bf16 v[80:95], v[20:23], v[220:223], v[80:95]
  v_mul_f32 v53, s52, v53
  v_cvt_pk_bf16_f32 v50, v52, v53
  ds_read_b128 v[20:23], v13 offset:16640
  s_waitcnt lgkmcnt(3)
  v_mfma_f32_32x32x16_bf16 v[64:79], v[24:27], v[160:163], v[64:79]
  v_mul_f32 v54, s52, v54
  v_mul_f32 v55, s52, v55
  v_cvt_pk_bf16_f32 v51, v54, v55
  v_mfma_f32_32x32x16_bf16 v[80:95], v[24:27], v[224:227], v[80:95]
  v_mul_f32 v56, s52, v56
  v_mul_f32 v57, s52, v57
  ds_read_b128 v[24:27], v14 offset:16640
  s_waitcnt lgkmcnt(3)
  v_mfma_f32_32x32x16_bf16 v[64:79], v[28:31], v[164:167], v[64:79]
  v_cvt_pk_bf16_f32 v56, v56, v57
  v_mul_f32 v58, s52, v58
  v_mul_f32 v59, s52, v59
  v_mfma_f32_32x32x16_bf16 v[80:95], v[28:31], v[228:231], v[80:95]
  v_cvt_pk_bf16_f32 v57, v58, v59
  v_mul_f32 v60, s52, v60
  ds_read_b128 v[28:31], v15 offset:16640
  s_waitcnt lgkmcnt(3)
  v_mfma_f32_32x32x16_bf16 v[64:79], v[16:19], v[168:171], v[64:79]
  v_mul_f32 v61, s52, v61
  v_cvt_pk_bf16_f32 v58, v60, v61
  v_mul_f32 v62, s52, v62
  v_mfma_f32_32x32x16_bf16 v[80:95], v[16:19], v[232:235], v[80:95]
  v_mul_f32 v63, s52, v63
  v_cvt_pk_bf16_f32 v59, v62, v63
  ds_read_b128 v[16:19], v8 offset:32768
  s_waitcnt lgkmcnt(3)
  v_mfma_f32_32x32x16_bf16 v[64:79], v[20:23], v[172:175], v[64:79]
  v_permlane16_swap_b32 v48, v56
  v_permlane16_swap_b32 v49, v57
  v_permlane16_swap_b32 v50, v58
  v_mfma_f32_32x32x16_bf16 v[80:95], v[20:23], v[236:239], v[80:95]
  v_permlane16_swap_b32 v51, v59
  v_accvgpr_write_b32 a128, v48
  ds_read_b128 v[20:23], v9 offset:32768
  s_waitcnt lgkmcnt(3)
  v_mfma_f32_32x32x16_bf16 v[64:79], v[24:27], v[176:179], v[64:79]
  v_accvgpr_write_b32 a129, v49
  v_accvgpr_write_b32 a130, v50
  v_accvgpr_write_b32 a131, v51
  v_mfma_f32_32x32x16_bf16 v[80:95], v[24:27], v[240:243], v[80:95]
  v_accvgpr_write_b32 a184, v56
  v_accvgpr_write_b32 a185, v57
  ds_read_b128 v[24:27], v10 offset:32768
  s_waitcnt lgkmcnt(3)
  v_mfma_f32_32x32x16_bf16 v[64:79], v[28:31], v[180:183], v[64:79]
  v_accvgpr_write_b32 a186, v58
  v_accvgpr_write_b32 a187, v59
  v_mfma_f32_32x32x16_bf16 v[80:95], v[28:31], v[244:247], v[80:95]
  ds_read_b128 v[28:31], v11 offset:32768
  s_waitcnt lgkmcnt(3)
  v_mfma_f32_32x32x16_bf16 v[32:47], v[16:19], v[120:123], 0
  v_mfma_f32_32x32x16_bf16 v[48:63], v[16:19], v[184:187], 0
  ds_read_b128 v[16:19], v12 offset:32768
  s_waitcnt lgkmcnt(3)
  v_mfma_f32_32x32x16_bf16 v[32:47], v[20:23], v[124:127], v[32:47]
  v_mul_f32 v64, s52, v64
  v_mul_f32 v65, s52, v65
  v_cvt_pk_bf16_f32 v64, v64, v65
  v_mfma_f32_32x32x16_bf16 v[48:63], v[20:23], v[188:191], v[48:63]
  v_mul_f32 v66, s52, v66
  v_mul_f32 v67, s52, v67
  ds_read_b128 v[20:23], v13 offset:32768
  s_waitcnt lgkmcnt(3)
  v_mfma_f32_32x32x16_bf16 v[32:47], v[24:27], v[128:131], v[32:47]
  v_cvt_pk_bf16_f32 v65, v66, v67
  v_mul_f32 v68, s52, v68
  v_mul_f32 v69, s52, v69
  v_mfma_f32_32x32x16_bf16 v[48:63], v[24:27], v[192:195], v[48:63]
  v_cvt_pk_bf16_f32 v66, v68, v69
  v_mul_f32 v70, s52, v70
  ds_read_b128 v[24:27], v14 offset:32768
  s_waitcnt lgkmcnt(3)
  v_mfma_f32_32x32x16_bf16 v[32:47], v[28:31], v[132:135], v[32:47]
  v_mul_f32 v71, s52, v71
  v_cvt_pk_bf16_f32 v67, v70, v71
  v_mul_f32 v72, s52, v72
  v_mfma_f32_32x32x16_bf16 v[48:63], v[28:31], v[196:199], v[48:63]
  v_mul_f32 v73, s52, v73
  v_cvt_pk_bf16_f32 v72, v72, v73
  ds_read_b128 v[28:31], v15 offset:32768
  s_waitcnt lgkmcnt(3)
  v_mfma_f32_32x32x16_bf16 v[32:47], v[16:19], v[136:139], v[32:47]
  v_mul_f32 v74, s52, v74
  v_mul_f32 v75, s52, v75
  v_cvt_pk_bf16_f32 v73, v74, v75
  v_mfma_f32_32x32x16_bf16 v[48:63], v[16:19], v[200:203], v[48:63]
  v_mul_f32 v76, s52, v76
  v_mul_f32 v77, s52, v77
  ds_read_b128 v[16:19], v8 offset:33024
  s_waitcnt lgkmcnt(3)
  v_mfma_f32_32x32x16_bf16 v[32:47], v[20:23], v[140:143], v[32:47]
  v_cvt_pk_bf16_f32 v74, v76, v77
  v_mul_f32 v78, s52, v78
  v_mul_f32 v79, s52, v79
  v_mfma_f32_32x32x16_bf16 v[48:63], v[20:23], v[204:207], v[48:63]
  v_cvt_pk_bf16_f32 v75, v78, v79
  v_permlane16_swap_b32 v64, v72
  ds_read_b128 v[20:23], v9 offset:33024
  s_waitcnt lgkmcnt(3)
  v_mfma_f32_32x32x16_bf16 v[32:47], v[24:27], v[144:147], v[32:47]
  v_permlane16_swap_b32 v65, v73
  v_permlane16_swap_b32 v66, v74
  v_permlane16_swap_b32 v67, v75
  v_mfma_f32_32x32x16_bf16 v[48:63], v[24:27], v[208:211], v[48:63]
  v_accvgpr_write_b32 a20, v64
  v_accvgpr_write_b32 a21, v65
  ds_read_b128 v[24:27], v10 offset:33024
  s_waitcnt lgkmcnt(3)
  v_mfma_f32_32x32x16_bf16 v[32:47], v[28:31], v[148:151], v[32:47]
  v_accvgpr_write_b32 a22, v66
  v_accvgpr_write_b32 a23, v67
  v_accvgpr_write_b32 a76, v72
  v_mfma_f32_32x32x16_bf16 v[48:63], v[28:31], v[212:215], v[48:63]
  v_accvgpr_write_b32 a77, v73
  v_accvgpr_write_b32 a78, v74
  ds_read_b128 v[28:31], v11 offset:33024
  s_waitcnt lgkmcnt(3)
  v_mfma_f32_32x32x16_bf16 v[32:47], v[16:19], v[152:155], v[32:47]
  v_accvgpr_write_b32 a79, v75
  v_mul_f32 v80, s52, v80
  v_mul_f32 v81, s52, v81
  v_mfma_f32_32x32x16_bf16 v[48:63], v[16:19], v[216:219], v[48:63]
  v_cvt_pk_bf16_f32 v80, v80, v81
  v_mul_f32 v82, s52, v82
  ds_read_b128 v[16:19], v12 offset:33024
  s_waitcnt lgkmcnt(3)
  v_mfma_f32_32x32x16_bf16 v[32:47], v[20:23], v[156:159], v[32:47]
  v_mul_f32 v83, s52, v83
  v_cvt_pk_bf16_f32 v81, v82, v83
  v_mul_f32 v84, s52, v84
  v_mfma_f32_32x32x16_bf16 v[48:63], v[20:23], v[220:223], v[48:63]
  v_mul_f32 v85, s52, v85
  v_cvt_pk_bf16_f32 v82, v84, v85
  ds_read_b128 v[20:23], v13 offset:33024
  s_waitcnt lgkmcnt(3)
  v_mfma_f32_32x32x16_bf16 v[32:47], v[24:27], v[160:163], v[32:47]
  v_mul_f32 v86, s52, v86
  v_mul_f32 v87, s52, v87
  v_cvt_pk_bf16_f32 v83, v86, v87
  v_mfma_f32_32x32x16_bf16 v[48:63], v[24:27], v[224:227], v[48:63]
  v_mul_f32 v88, s52, v88
  v_mul_f32 v89, s52, v89
  ds_read_b128 v[24:27], v14 offset:33024
  s_waitcnt lgkmcnt(3)
  v_mfma_f32_32x32x16_bf16 v[32:47], v[28:31], v[164:167], v[32:47]
  v_cvt_pk_bf16_f32 v88, v88, v89
  v_mul_f32 v90, s52, v90
  v_mul_f32 v91, s52, v91
  v_mfma_f32_32x32x16_bf16 v[48:63], v[28:31], v[228:231], v[48:63]
  v_cvt_pk_bf16_f32 v89, v90, v91
  v_mul_f32 v92, s52, v92
  ds_read_b128 v[28:31], v15 offset:33024
  s_waitcnt lgkmcnt(3)
  v_mfma_f32_32x32x16_bf16 v[32:47], v[16:19], v[168:171], v[32:47]
  v_mul_f32 v93, s52, v93
  v_cvt_pk_bf16_f32 v90, v92, v93
  v_mul_f32 v94, s52, v94
  v_mfma_f32_32x32x16_bf16 v[48:63], v[16:19], v[232:235], v[48:63]
  v_mul_f32 v95, s52, v95
  v_cvt_pk_bf16_f32 v91, v94, v95
  ds_read_b128 v[16:19], v8 offset:49152
  s_waitcnt lgkmcnt(3)
  v_mfma_f32_32x32x16_bf16 v[32:47], v[20:23], v[172:175], v[32:47]
  v_permlane16_swap_b32 v80, v88
  v_permlane16_swap_b32 v81, v89
  v_permlane16_swap_b32 v82, v90
  v_mfma_f32_32x32x16_bf16 v[48:63], v[20:23], v[236:239], v[48:63]
  v_permlane16_swap_b32 v83, v91
  v_accvgpr_write_b32 a132, v80
  ds_read_b128 v[20:23], v9 offset:49152
  s_waitcnt lgkmcnt(3)
  v_mfma_f32_32x32x16_bf16 v[32:47], v[24:27], v[176:179], v[32:47]
  v_accvgpr_write_b32 a133, v81
  v_accvgpr_write_b32 a134, v82
  v_accvgpr_write_b32 a135, v83
  v_mfma_f32_32x32x16_bf16 v[48:63], v[24:27], v[240:243], v[48:63]
  v_accvgpr_write_b32 a188, v88
  v_accvgpr_write_b32 a189, v89
  ds_read_b128 v[24:27], v10 offset:49152
  s_waitcnt lgkmcnt(3)
  v_mfma_f32_32x32x16_bf16 v[32:47], v[28:31], v[180:183], v[32:47]
  v_accvgpr_write_b32 a190, v90
  v_accvgpr_write_b32 a191, v91
  v_mfma_f32_32x32x16_bf16 v[48:63], v[28:31], v[244:247], v[48:63]
  s_waitcnt vmcnt(16)
  s_barrier
  ds_read_b128 v[28:31], v11 offset:49152
  s_waitcnt lgkmcnt(3)
  v_mfma_f32_32x32x16_bf16 v[64:79], v[16:19], v[120:123], 0
  v_mfma_f32_32x32x16_bf16 v[80:95], v[16:19], v[184:187], 0
  ds_read_b128 v[16:19], v12 offset:49152
  s_waitcnt lgkmcnt(3)
  v_mfma_f32_32x32x16_bf16 v[64:79], v[20:23], v[124:127], v[64:79]
  v_mul_f32 v32, s52, v32
  v_mul_f32 v33, s52, v33
  v_cvt_pk_bf16_f32 v32, v32, v33
  v_mfma_f32_32x32x16_bf16 v[80:95], v[20:23], v[188:191], v[80:95]
  v_mul_f32 v34, s52, v34
  v_mul_f32 v35, s52, v35
  ds_read_b128 v[20:23], v13 offset:49152
  s_waitcnt lgkmcnt(3)
  v_mfma_f32_32x32x16_bf16 v[64:79], v[24:27], v[128:131], v[64:79]
  v_cvt_pk_bf16_f32 v33, v34, v35
  v_mul_f32 v36, s52, v36
  v_mul_f32 v37, s52, v37
  v_mfma_f32_32x32x16_bf16 v[80:95], v[24:27], v[192:195], v[80:95]
  v_cvt_pk_bf16_f32 v34, v36, v37
  v_mul_f32 v38, s52, v38
  ds_read_b128 v[24:27], v14 offset:49152
  s_waitcnt lgkmcnt(3)
  v_mfma_f32_32x32x16_bf16 v[64:79], v[28:31], v[132:135], v[64:79]
  v_mul_f32 v39, s52, v39
  v_cvt_pk_bf16_f32 v35, v38, v39
  v_mul_f32 v40, s52, v40
  v_mfma_f32_32x32x16_bf16 v[80:95], v[28:31], v[196:199], v[80:95]
  v_mul_f32 v41, s52, v41
  v_cvt_pk_bf16_f32 v40, v40, v41
  ds_read_b128 v[28:31], v15 offset:49152
  s_waitcnt lgkmcnt(3)
  v_mfma_f32_32x32x16_bf16 v[64:79], v[16:19], v[136:139], v[64:79]
  v_mul_f32 v42, s52, v42
  v_mul_f32 v43, s52, v43
  v_cvt_pk_bf16_f32 v41, v42, v43
  v_mfma_f32_32x32x16_bf16 v[80:95], v[16:19], v[200:203], v[80:95]
  v_mul_f32 v44, s52, v44
  v_mul_f32 v45, s52, v45
  ds_read_b128 v[16:19], v8 offset:49408
  s_waitcnt lgkmcnt(3)
  v_mfma_f32_32x32x16_bf16 v[64:79], v[20:23], v[140:143], v[64:79]
  v_cvt_pk_bf16_f32 v42, v44, v45
  v_mul_f32 v46, s52, v46
  v_mul_f32 v47, s52, v47
  v_mfma_f32_32x32x16_bf16 v[80:95], v[20:23], v[204:207], v[80:95]
  v_cvt_pk_bf16_f32 v43, v46, v47
  v_permlane16_swap_b32 v32, v40
  ds_read_b128 v[20:23], v9 offset:49408
  s_waitcnt lgkmcnt(3)
  v_mfma_f32_32x32x16_bf16 v[64:79], v[24:27], v[144:147], v[64:79]
  v_permlane16_swap_b32 v33, v41
  v_permlane16_swap_b32 v34, v42
  v_permlane16_swap_b32 v35, v43
  v_mfma_f32_32x32x16_bf16 v[80:95], v[24:27], v[208:211], v[80:95]
  v_accvgpr_write_b32 a24, v32
  v_accvgpr_write_b32 a25, v33
  ds_read_b128 v[24:27], v10 offset:49408
  s_waitcnt lgkmcnt(3)
  v_mfma_f32_32x32x16_bf16 v[64:79], v[28:31], v[148:151], v[64:79]
  v_accvgpr_write_b32 a26, v34
  v_accvgpr_write_b32 a27, v35
  v_accvgpr_write_b32 a80, v40
  v_mfma_f32_32x32x16_bf16 v[80:95], v[28:31], v[212:215], v[80:95]
  v_accvgpr_write_b32 a81, v41
  v_accvgpr_write_b32 a82, v42
  ds_read_b128 v[28:31], v11 offset:49408
  s_waitcnt lgkmcnt(3)
  v_mfma_f32_32x32x16_bf16 v[64:79], v[16:19], v[152:155], v[64:79]
  v_accvgpr_write_b32 a83, v43
  v_mul_f32 v48, s52, v48
  v_mul_f32 v49, s52, v49
  v_mfma_f32_32x32x16_bf16 v[80:95], v[16:19], v[216:219], v[80:95]
  v_cvt_pk_bf16_f32 v48, v48, v49
  v_mul_f32 v50, s52, v50
  ds_read_b128 v[16:19], v12 offset:49408
  s_waitcnt lgkmcnt(3)
  v_mfma_f32_32x32x16_bf16 v[64:79], v[20:23], v[156:159], v[64:79]
  v_mul_f32 v51, s52, v51
  v_cvt_pk_bf16_f32 v49, v50, v51
  v_mul_f32 v52, s52, v52
  v_mfma_f32_32x32x16_bf16 v[80:95], v[20:23], v[220:223], v[80:95]
  v_mul_f32 v53, s52, v53
  v_cvt_pk_bf16_f32 v50, v52, v53
  ds_read_b128 v[20:23], v13 offset:49408
  s_waitcnt lgkmcnt(3)
  v_mfma_f32_32x32x16_bf16 v[64:79], v[24:27], v[160:163], v[64:79]
  v_mul_f32 v54, s52, v54
  v_mul_f32 v55, s52, v55
  v_cvt_pk_bf16_f32 v51, v54, v55
  v_mfma_f32_32x32x16_bf16 v[80:95], v[24:27], v[224:227], v[80:95]
  v_mul_f32 v56, s52, v56
  v_mul_f32 v57, s52, v57
  ds_read_b128 v[24:27], v14 offset:49408
  s_waitcnt lgkmcnt(3)
  v_mfma_f32_32x32x16_bf16 v[64:79], v[28:31], v[164:167], v[64:79]
  v_cvt_pk_bf16_f32 v56, v56, v57
  v_mul_f32 v58, s52, v58
  v_mul_f32 v59, s52, v59
  v_mfma_f32_32x32x16_bf16 v[80:95], v[28:31], v[228:231], v[80:95]
  v_cvt_pk_bf16_f32 v57, v58, v59
  v_mul_f32 v60, s52, v60
  ds_read_b128 v[28:31], v15 offset:49408
  s_waitcnt lgkmcnt(3)
  v_mfma_f32_32x32x16_bf16 v[64:79], v[16:19], v[168:171], v[64:79]
  v_mul_f32 v61, s52, v61
  v_cvt_pk_bf16_f32 v58, v60, v61
  v_mul_f32 v62, s52, v62
  v_mfma_f32_32x32x16_bf16 v[80:95], v[16:19], v[232:235], v[80:95]
  v_mul_f32 v63, s52, v63
  v_cvt_pk_bf16_f32 v59, v62, v63
  v_xor_b32 v8, 196608, v8
  ds_read_b128 v[16:19], v8 offset:0
  s_waitcnt lgkmcnt(3)
  v_mfma_f32_32x32x16_bf16 v[64:79], v[20:23], v[172:175], v[64:79]
  v_permlane16_swap_b32 v48, v56
  v_permlane16_swap_b32 v49, v57
  v_permlane16_swap_b32 v50, v58
  v_mfma_f32_32x32x16_bf16 v[80:95], v[20:23], v[236:239], v[80:95]
  v_permlane16_swap_b32 v51, v59
  v_accvgpr_write_b32 a136, v48
  v_xor_b32 v9, 196608, v9
  ds_read_b128 v[20:23], v9 offset:0
  s_waitcnt lgkmcnt(3)
  v_mfma_f32_32x32x16_bf16 v[64:79], v[24:27], v[176:179], v[64:79]
  v_accvgpr_write_b32 a137, v49
  v_accvgpr_write_b32 a138, v50
  v_accvgpr_write_b32 a139, v51
  v_mfma_f32_32x32x16_bf16 v[80:95], v[24:27], v[240:243], v[80:95]
  v_accvgpr_write_b32 a192, v56
  v_accvgpr_write_b32 a193, v57
  v_xor_b32 v10, 196608, v10
  ds_read_b128 v[24:27], v10 offset:0
  s_waitcnt lgkmcnt(3)
  v_mfma_f32_32x32x16_bf16 v[64:79], v[28:31], v[180:183], v[64:79]
  v_accvgpr_write_b32 a194, v58
  v_accvgpr_write_b32 a195, v59
  v_mfma_f32_32x32x16_bf16 v[80:95], v[28:31], v[244:247], v[80:95]
  v_xor_b32 v11, 196608, v11
  ds_read_b128 v[28:31], v11 offset:0
  s_waitcnt lgkmcnt(3)
  v_mfma_f32_32x32x16_bf16 v[32:47], v[16:19], v[120:123], 0
  v_mfma_f32_32x32x16_bf16 v[48:63], v[16:19], v[184:187], 0
  v_xor_b32 v12, 196608, v12
  ds_read_b128 v[16:19], v12 offset:0
  s_waitcnt lgkmcnt(3)
  v_mfma_f32_32x32x16_bf16 v[32:47], v[20:23], v[124:127], v[32:47]
  v_mul_f32 v64, s52, v64
  v_mul_f32 v65, s52, v65
  v_cvt_pk_bf16_f32 v64, v64, v65
  v_mfma_f32_32x32x16_bf16 v[48:63], v[20:23], v[188:191], v[48:63]
  v_mul_f32 v66, s52, v66
  v_mul_f32 v67, s52, v67
  v_xor_b32 v13, 196608, v13
  ds_read_b128 v[20:23], v13 offset:0
  s_waitcnt lgkmcnt(3)
  v_mfma_f32_32x32x16_bf16 v[32:47], v[24:27], v[128:131], v[32:47]
  v_cvt_pk_bf16_f32 v65, v66, v67
  v_mul_f32 v68, s52, v68
  v_mul_f32 v69, s52, v69
  v_mfma_f32_32x32x16_bf16 v[48:63], v[24:27], v[192:195], v[48:63]
  v_cvt_pk_bf16_f32 v66, v68, v69
  v_mul_f32 v70, s52, v70
  v_xor_b32 v14, 196608, v14
  ds_read_b128 v[24:27], v14 offset:0
  s_waitcnt lgkmcnt(3)
  v_mfma_f32_32x32x16_bf16 v[32:47], v[28:31], v[132:135], v[32:47]
  v_mul_f32 v71, s52, v71
  v_cvt_pk_bf16_f32 v67, v70, v71
  v_mul_f32 v72, s52, v72
  v_mfma_f32_32x32x16_bf16 v[48:63], v[28:31], v[196:199], v[48:63]
  v_mul_f32 v73, s52, v73
  v_cvt_pk_bf16_f32 v72, v72, v73
  v_xor_b32 v15, 196608, v15
  ds_read_b128 v[28:31], v15 offset:0
  s_waitcnt lgkmcnt(3)
  v_mfma_f32_32x32x16_bf16 v[32:47], v[16:19], v[136:139], v[32:47]
  v_mul_f32 v74, s52, v74
  v_mul_f32 v75, s52, v75
  v_cvt_pk_bf16_f32 v73, v74, v75
  v_mfma_f32_32x32x16_bf16 v[48:63], v[16:19], v[200:203], v[48:63]
  v_mul_f32 v76, s52, v76
  v_mul_f32 v77, s52, v77
  ds_read_b128 v[16:19], v8 offset:256
  s_waitcnt lgkmcnt(3)
  v_mfma_f32_32x32x16_bf16 v[32:47], v[20:23], v[140:143], v[32:47]
  v_cvt_pk_bf16_f32 v74, v76, v77
  v_mul_f32 v78, s52, v78
  v_mul_f32 v79, s52, v79
  v_mfma_f32_32x32x16_bf16 v[48:63], v[20:23], v[204:207], v[48:63]
  v_cvt_pk_bf16_f32 v75, v78, v79
  v_permlane16_swap_b32 v64, v72
  ds_read_b128 v[20:23], v9 offset:256
  s_waitcnt lgkmcnt(3)
  v_mfma_f32_32x32x16_bf16 v[32:47], v[24:27], v[144:147], v[32:47]
  v_permlane16_swap_b32 v65, v73
  v_permlane16_swap_b32 v66, v74
  v_permlane16_swap_b32 v67, v75
  v_mfma_f32_32x32x16_bf16 v[48:63], v[24:27], v[208:211], v[48:63]
  v_accvgpr_write_b32 a28, v64
  v_accvgpr_write_b32 a29, v65
  ds_read_b128 v[24:27], v10 offset:256
  s_waitcnt lgkmcnt(3)
  v_mfma_f32_32x32x16_bf16 v[32:47], v[28:31], v[148:151], v[32:47]
  v_accvgpr_write_b32 a30, v66
  v_accvgpr_write_b32 a31, v67
  v_accvgpr_write_b32 a84, v72
  v_mfma_f32_32x32x16_bf16 v[48:63], v[28:31], v[212:215], v[48:63]
  v_accvgpr_write_b32 a85, v73
  v_accvgpr_write_b32 a86, v74
  ds_read_b128 v[28:31], v11 offset:256
  s_waitcnt lgkmcnt(3)
  v_mfma_f32_32x32x16_bf16 v[32:47], v[16:19], v[152:155], v[32:47]
  v_accvgpr_write_b32 a87, v75
  v_mul_f32 v80, s52, v80
  v_mul_f32 v81, s52, v81
  v_mfma_f32_32x32x16_bf16 v[48:63], v[16:19], v[216:219], v[48:63]
  v_cvt_pk_bf16_f32 v80, v80, v81
  v_mul_f32 v82, s52, v82
  ds_read_b128 v[16:19], v12 offset:256
  s_waitcnt lgkmcnt(3)
  v_mfma_f32_32x32x16_bf16 v[32:47], v[20:23], v[156:159], v[32:47]
  v_mul_f32 v83, s52, v83
  v_cvt_pk_bf16_f32 v81, v82, v83
  v_mul_f32 v84, s52, v84
  v_mfma_f32_32x32x16_bf16 v[48:63], v[20:23], v[220:223], v[48:63]
  v_mul_f32 v85, s52, v85
  v_cvt_pk_bf16_f32 v82, v84, v85
  ds_read_b128 v[20:23], v13 offset:256
  s_waitcnt lgkmcnt(3)
  v_mfma_f32_32x32x16_bf16 v[32:47], v[24:27], v[160:163], v[32:47]
  v_mul_f32 v86, s52, v86
  v_mul_f32 v87, s52, v87
  v_cvt_pk_bf16_f32 v83, v86, v87
  v_mfma_f32_32x32x16_bf16 v[48:63], v[24:27], v[224:227], v[48:63]
  v_mul_f32 v88, s52, v88
  v_mul_f32 v89, s52, v89
  ds_read_b128 v[24:27], v14 offset:256
  s_waitcnt lgkmcnt(3)
  v_mfma_f32_32x32x16_bf16 v[32:47], v[28:31], v[164:167], v[32:47]
  v_cvt_pk_bf16_f32 v88, v88, v89
  v_mul_f32 v90, s52, v90
  v_mul_f32 v91, s52, v91
  v_mfma_f32_32x32x16_bf16 v[48:63], v[28:31], v[228:231], v[48:63]
  v_cvt_pk_bf16_f32 v89, v90, v91
  v_mul_f32 v92, s52, v92
  ds_read_b128 v[28:31], v15 offset:256
  s_waitcnt lgkmcnt(3)
  v_mfma_f32_32x32x16_bf16 v[32:47], v[16:19], v[168:171], v[32:47]
  v_mul_f32 v93, s52, v93
  v_cvt_pk_bf16_f32 v90, v92, v93
  v_mul_f32 v94, s52, v94
  v_mfma_f32_32x32x16_bf16 v[48:63], v[16:19], v[232:235], v[48:63]
  v_mul_f32 v95, s52, v95
  v_cvt_pk_bf16_f32 v91, v94, v95
  v_xor_b32 v8, 131072, v8
  ds_read_b128 v[16:19], v8 offset:0
  s_waitcnt lgkmcnt(3)
  v_mfma_f32_32x32x16_bf16 v[32:47], v[20:23], v[172:175], v[32:47]
  v_permlane16_swap_b32 v80, v88
  v_permlane16_swap_b32 v81, v89
  v_permlane16_swap_b32 v82, v90
  v_mfma_f32_32x32x16_bf16 v[48:63], v[20:23], v[236:239], v[48:63]
  v_permlane16_swap_b32 v83, v91
  v_accvgpr_write_b32 a140, v80
  v_xor_b32 v9, 131072, v9
  ds_read_b128 v[20:23], v9 offset:0
  s_waitcnt lgkmcnt(3)
  v_mfma_f32_32x32x16_bf16 v[32:47], v[24:27], v[176:179], v[32:47]
  v_accvgpr_write_b32 a141, v81
  v_accvgpr_write_b32 a142, v82
  v_accvgpr_write_b32 a143, v83
  v_mfma_f32_32x32x16_bf16 v[48:63], v[24:27], v[240:243], v[48:63]
  v_accvgpr_write_b32 a196, v88
  v_accvgpr_write_b32 a197, v89
  v_xor_b32 v10, 131072, v10
  ds_read_b128 v[24:27], v10 offset:0
  s_waitcnt lgkmcnt(3)
  v_mfma_f32_32x32x16_bf16 v[32:47], v[28:31], v[180:183], v[32:47]
  v_accvgpr_write_b32 a198, v90
  v_accvgpr_write_b32 a199, v91
  v_mfma_f32_32x32x16_bf16 v[48:63], v[28:31], v[244:247], v[48:63]
  s_waitcnt vmcnt(8)
  s_barrier
  v_xor_b32 v11, 131072, v11
  ds_read_b128 v[28:31], v11 offset:0
  s_waitcnt lgkmcnt(3)
  v_mfma_f32_32x32x16_bf16 v[64:79], v[16:19], v[120:123], 0
  v_mfma_f32_32x32x16_bf16 v[80:95], v[16:19], v[184:187], 0
  v_xor_b32 v12, 131072, v12
  ds_read_b128 v[16:19], v12 offset:0
  s_waitcnt lgkmcnt(3)
  v_mfma_f32_32x32x16_bf16 v[64:79], v[20:23], v[124:127], v[64:79]
  v_mul_f32 v32, s52, v32
  v_mul_f32 v33, s52, v33
  v_cvt_pk_bf16_f32 v32, v32, v33
  v_mfma_f32_32x32x16_bf16 v[80:95], v[20:23], v[188:191], v[80:95]
  v_mul_f32 v34, s52, v34
  v_mul_f32 v35, s52, v35
  v_xor_b32 v13, 131072, v13
  ds_read_b128 v[20:23], v13 offset:0
  s_waitcnt lgkmcnt(3)
  v_mfma_f32_32x32x16_bf16 v[64:79], v[24:27], v[128:131], v[64:79]
  v_cvt_pk_bf16_f32 v33, v34, v35
  v_mul_f32 v36, s52, v36
  v_mul_f32 v37, s52, v37
  v_mfma_f32_32x32x16_bf16 v[80:95], v[24:27], v[192:195], v[80:95]
  v_cvt_pk_bf16_f32 v34, v36, v37
  v_mul_f32 v38, s52, v38
  v_xor_b32 v14, 131072, v14
  ds_read_b128 v[24:27], v14 offset:0
  s_waitcnt lgkmcnt(3)
  v_mfma_f32_32x32x16_bf16 v[64:79], v[28:31], v[132:135], v[64:79]
  v_mul_f32 v39, s52, v39
  v_cvt_pk_bf16_f32 v35, v38, v39
  v_mul_f32 v40, s52, v40
  v_mfma_f32_32x32x16_bf16 v[80:95], v[28:31], v[196:199], v[80:95]
  v_mul_f32 v41, s52, v41
  v_cvt_pk_bf16_f32 v40, v40, v41
  v_xor_b32 v15, 131072, v15
  ds_read_b128 v[28:31], v15 offset:0
  s_waitcnt lgkmcnt(3)
  v_mfma_f32_32x32x16_bf16 v[64:79], v[16:19], v[136:139], v[64:79]
  v_mul_f32 v42, s52, v42
  v_mul_f32 v43, s52, v43
  v_cvt_pk_bf16_f32 v41, v42, v43
  v_mfma_f32_32x32x16_bf16 v[80:95], v[16:19], v[200:203], v[80:95]
  v_mul_f32 v44, s52, v44
  v_mul_f32 v45, s52, v45
  ds_read_b128 v[16:19], v8 offset:256
  s_waitcnt lgkmcnt(3)
  v_mfma_f32_32x32x16_bf16 v[64:79], v[20:23], v[140:143], v[64:79]
  v_cvt_pk_bf16_f32 v42, v44, v45
  v_mul_f32 v46, s52, v46
  v_mul_f32 v47, s52, v47
  v_mfma_f32_32x32x16_bf16 v[80:95], v[20:23], v[204:207], v[80:95]
  v_cvt_pk_bf16_f32 v43, v46, v47
  v_permlane16_swap_b32 v32, v40
  ds_read_b128 v[20:23], v9 offset:256
  s_waitcnt lgkmcnt(3)
  v_mfma_f32_32x32x16_bf16 v[64:79], v[24:27], v[144:147], v[64:79]
  v_permlane16_swap_b32 v33, v41
  v_permlane16_swap_b32 v34, v42
  v_permlane16_swap_b32 v35, v43
  v_mfma_f32_32x32x16_bf16 v[80:95], v[24:27], v[208:211], v[80:95]
  v_accvgpr_write_b32 a32, v32
  v_accvgpr_write_b32 a33, v33
  ds_read_b128 v[24:27], v10 offset:256
  s_waitcnt lgkmcnt(3)
  v_mfma_f32_32x32x16_bf16 v[64:79], v[28:31], v[148:151], v[64:79]
  v_accvgpr_write_b32 a34, v34
  v_accvgpr_write_b32 a35, v35
  v_accvgpr_write_b32 a88, v40
  v_mfma_f32_32x32x16_bf16 v[80:95], v[28:31], v[212:215], v[80:95]
  v_accvgpr_write_b32 a89, v41
  v_accvgpr_write_b32 a90, v42
  ds_read_b128 v[28:31], v11 offset:256
  s_waitcnt lgkmcnt(3)
  v_mfma_f32_32x32x16_bf16 v[64:79], v[16:19], v[152:155], v[64:79]
  v_accvgpr_write_b32 a91, v43
  v_mul_f32 v48, s52, v48
  v_mul_f32 v49, s52, v49
  v_mfma_f32_32x32x16_bf16 v[80:95], v[16:19], v[216:219], v[80:95]
  v_cvt_pk_bf16_f32 v48, v48, v49
  v_mul_f32 v50, s52, v50
  ds_read_b128 v[16:19], v12 offset:256
  s_waitcnt lgkmcnt(3)
  v_mfma_f32_32x32x16_bf16 v[64:79], v[20:23], v[156:159], v[64:79]
  v_mul_f32 v51, s52, v51
  v_cvt_pk_bf16_f32 v49, v50, v51
  v_mul_f32 v52, s52, v52
  v_mfma_f32_32x32x16_bf16 v[80:95], v[20:23], v[220:223], v[80:95]
  v_mul_f32 v53, s52, v53
  v_cvt_pk_bf16_f32 v50, v52, v53
  ds_read_b128 v[20:23], v13 offset:256
  s_waitcnt lgkmcnt(3)
  v_mfma_f32_32x32x16_bf16 v[64:79], v[24:27], v[160:163], v[64:79]
  v_mul_f32 v54, s52, v54
  v_mul_f32 v55, s52, v55
  v_cvt_pk_bf16_f32 v51, v54, v55
  v_mfma_f32_32x32x16_bf16 v[80:95], v[24:27], v[224:227], v[80:95]
  v_mul_f32 v56, s52, v56
  v_mul_f32 v57, s52, v57
  ds_read_b128 v[24:27], v14 offset:256
  s_waitcnt lgkmcnt(3)
  v_mfma_f32_32x32x16_bf16 v[64:79], v[28:31], v[164:167], v[64:79]
  v_cvt_pk_bf16_f32 v56, v56, v57
  v_mul_f32 v58, s52, v58
  v_mul_f32 v59, s52, v59
  v_mfma_f32_32x32x16_bf16 v[80:95], v[28:31], v[228:231], v[80:95]
  v_cvt_pk_bf16_f32 v57, v58, v59
  v_mul_f32 v60, s52, v60
  ds_read_b128 v[28:31], v15 offset:256
  s_waitcnt lgkmcnt(3)
  v_mfma_f32_32x32x16_bf16 v[64:79], v[16:19], v[168:171], v[64:79]
  v_mul_f32 v61, s52, v61
  v_cvt_pk_bf16_f32 v58, v60, v61
  v_mul_f32 v62, s52, v62
  v_mfma_f32_32x32x16_bf16 v[80:95], v[16:19], v[232:235], v[80:95]
  v_mul_f32 v63, s52, v63
  v_cvt_pk_bf16_f32 v59, v62, v63
  ds_read_b128 v[16:19], v8 offset:16384
  s_waitcnt lgkmcnt(3)
  v_mfma_f32_32x32x16_bf16 v[64:79], v[20:23], v[172:175], v[64:79]
  v_permlane16_swap_b32 v48, v56
  v_permlane16_swap_b32 v49, v57
  v_permlane16_swap_b32 v50, v58
  v_mfma_f32_32x32x16_bf16 v[80:95], v[20:23], v[236:239], v[80:95]
  v_permlane16_swap_b32 v51, v59
  v_accvgpr_write_b32 a144, v48
  ds_read_b128 v[20:23], v9 offset:16384
  s_waitcnt lgkmcnt(3)
  v_mfma_f32_32x32x16_bf16 v[64:79], v[24:27], v[176:179], v[64:79]
  v_accvgpr_write_b32 a145, v49
  v_accvgpr_write_b32 a146, v50
  v_accvgpr_write_b32 a147, v51
  v_mfma_f32_32x32x16_bf16 v[80:95], v[24:27], v[240:243], v[80:95]
  v_accvgpr_write_b32 a200, v56
  v_accvgpr_write_b32 a201, v57
  ds_read_b128 v[24:27], v10 offset:16384
  s_waitcnt lgkmcnt(3)
  v_mfma_f32_32x32x16_bf16 v[64:79], v[28:31], v[180:183], v[64:79]
  v_accvgpr_write_b32 a202, v58
  v_accvgpr_write_b32 a203, v59
  v_mfma_f32_32x32x16_bf16 v[80:95], v[28:31], v[244:247], v[80:95]
  ds_read_b128 v[28:31], v11 offset:16384
  s_waitcnt lgkmcnt(3)
  v_mfma_f32_32x32x16_bf16 v[32:47], v[16:19], v[120:123], 0
  v_mfma_f32_32x32x16_bf16 v[48:63], v[16:19], v[184:187], 0
  ds_read_b128 v[16:19], v12 offset:16384
  s_waitcnt lgkmcnt(3)
  v_mfma_f32_32x32x16_bf16 v[32:47], v[20:23], v[124:127], v[32:47]
  v_mul_f32 v64, s52, v64
  v_mul_f32 v65, s52, v65
  v_cvt_pk_bf16_f32 v64, v64, v65
  v_mfma_f32_32x32x16_bf16 v[48:63], v[20:23], v[188:191], v[48:63]
  v_mul_f32 v66, s52, v66
  v_mul_f32 v67, s52, v67
  ds_read_b128 v[20:23], v13 offset:16384
  s_waitcnt lgkmcnt(3)
  v_mfma_f32_32x32x16_bf16 v[32:47], v[24:27], v[128:131], v[32:47]
  v_cvt_pk_bf16_f32 v65, v66, v67
  v_mul_f32 v68, s52, v68
  v_mul_f32 v69, s52, v69
  v_mfma_f32_32x32x16_bf16 v[48:63], v[24:27], v[192:195], v[48:63]
  v_cvt_pk_bf16_f32 v66, v68, v69
  v_mul_f32 v70, s52, v70
  ds_read_b128 v[24:27], v14 offset:16384
  s_waitcnt lgkmcnt(3)
  v_mfma_f32_32x32x16_bf16 v[32:47], v[28:31], v[132:135], v[32:47]
  v_mul_f32 v71, s52, v71
  v_cvt_pk_bf16_f32 v67, v70, v71
  v_mul_f32 v72, s52, v72
  v_mfma_f32_32x32x16_bf16 v[48:63], v[28:31], v[196:199], v[48:63]
  v_mul_f32 v73, s52, v73
  v_cvt_pk_bf16_f32 v72, v72, v73
  ds_read_b128 v[28:31], v15 offset:16384
  s_waitcnt lgkmcnt(3)
  v_mfma_f32_32x32x16_bf16 v[32:47], v[16:19], v[136:139], v[32:47]
  v_mul_f32 v74, s52, v74
  v_mul_f32 v75, s52, v75
  v_cvt_pk_bf16_f32 v73, v74, v75
  v_mfma_f32_32x32x16_bf16 v[48:63], v[16:19], v[200:203], v[48:63]
  v_mul_f32 v76, s52, v76
  v_mul_f32 v77, s52, v77
  ds_read_b128 v[16:19], v8 offset:16640
  s_waitcnt lgkmcnt(3)
  v_mfma_f32_32x32x16_bf16 v[32:47], v[20:23], v[140:143], v[32:47]
  v_cvt_pk_bf16_f32 v74, v76, v77
  v_mul_f32 v78, s52, v78
  v_mul_f32 v79, s52, v79
  v_mfma_f32_32x32x16_bf16 v[48:63], v[20:23], v[204:207], v[48:63]
  v_cvt_pk_bf16_f32 v75, v78, v79
  v_permlane16_swap_b32 v64, v72
  ds_read_b128 v[20:23], v9 offset:16640
  s_waitcnt lgkmcnt(3)
  v_mfma_f32_32x32x16_bf16 v[32:47], v[24:27], v[144:147], v[32:47]
  v_permlane16_swap_b32 v65, v73
  v_permlane16_swap_b32 v66, v74
  v_permlane16_swap_b32 v67, v75
  v_mfma_f32_32x32x16_bf16 v[48:63], v[24:27], v[208:211], v[48:63]
  v_accvgpr_write_b32 a36, v64
  v_accvgpr_write_b32 a37, v65
  ds_read_b128 v[24:27], v10 offset:16640
  s_waitcnt lgkmcnt(3)
  v_mfma_f32_32x32x16_bf16 v[32:47], v[28:31], v[148:151], v[32:47]
  v_accvgpr_write_b32 a38, v66
  v_accvgpr_write_b32 a39, v67
  v_accvgpr_write_b32 a92, v72
  v_mfma_f32_32x32x16_bf16 v[48:63], v[28:31], v[212:215], v[48:63]
  v_accvgpr_write_b32 a93, v73
  v_accvgpr_write_b32 a94, v74
  ds_read_b128 v[28:31], v11 offset:16640
  s_waitcnt lgkmcnt(3)
  v_mfma_f32_32x32x16_bf16 v[32:47], v[16:19], v[152:155], v[32:47]
  v_accvgpr_write_b32 a95, v75
  v_mul_f32 v80, s52, v80
  v_mul_f32 v81, s52, v81
  v_mfma_f32_32x32x16_bf16 v[48:63], v[16:19], v[216:219], v[48:63]
  v_cvt_pk_bf16_f32 v80, v80, v81
  v_mul_f32 v82, s52, v82
  ds_read_b128 v[16:19], v12 offset:16640
  s_waitcnt lgkmcnt(3)
  v_mfma_f32_32x32x16_bf16 v[32:47], v[20:23], v[156:159], v[32:47]
  v_mul_f32 v83, s52, v83
  v_cvt_pk_bf16_f32 v81, v82, v83
  v_mul_f32 v84, s52, v84
  v_mfma_f32_32x32x16_bf16 v[48:63], v[20:23], v[220:223], v[48:63]
  v_mul_f32 v85, s52, v85
  v_cvt_pk_bf16_f32 v82, v84, v85
  ds_read_b128 v[20:23], v13 offset:16640
  s_waitcnt lgkmcnt(3)
  v_mfma_f32_32x32x16_bf16 v[32:47], v[24:27], v[160:163], v[32:47]
  v_mul_f32 v86, s52, v86
  v_mul_f32 v87, s52, v87
  v_cvt_pk_bf16_f32 v83, v86, v87
  v_mfma_f32_32x32x16_bf16 v[48:63], v[24:27], v[224:227], v[48:63]
  v_mul_f32 v88, s52, v88
  v_mul_f32 v89, s52, v89
  ds_read_b128 v[24:27], v14 offset:16640
  s_waitcnt lgkmcnt(3)
  v_mfma_f32_32x32x16_bf16 v[32:47], v[28:31], v[164:167], v[32:47]
  v_cvt_pk_bf16_f32 v88, v88, v89
  v_mul_f32 v90, s52, v90
  v_mul_f32 v91, s52, v91
  v_mfma_f32_32x32x16_bf16 v[48:63], v[28:31], v[228:231], v[48:63]
  v_cvt_pk_bf16_f32 v89, v90, v91
  v_mul_f32 v92, s52, v92
  ds_read_b128 v[28:31], v15 offset:16640
  s_waitcnt lgkmcnt(3)
  v_mfma_f32_32x32x16_bf16 v[32:47], v[16:19], v[168:171], v[32:47]
  v_mul_f32 v93, s52, v93
  v_cvt_pk_bf16_f32 v90, v92, v93
  v_mul_f32 v94, s52, v94
  v_mfma_f32_32x32x16_bf16 v[48:63], v[16:19], v[232:235], v[48:63]
  v_mul_f32 v95, s52, v95
  v_cvt_pk_bf16_f32 v91, v94, v95
  ds_read_b128 v[16:19], v8 offset:32768
  s_waitcnt lgkmcnt(3)
  v_mfma_f32_32x32x16_bf16 v[32:47], v[20:23], v[172:175], v[32:47]
  v_permlane16_swap_b32 v80, v88
  v_permlane16_swap_b32 v81, v89
  v_permlane16_swap_b32 v82, v90
  v_mfma_f32_32x32x16_bf16 v[48:63], v[20:23], v[236:239], v[48:63]
  v_permlane16_swap_b32 v83, v91
  v_accvgpr_write_b32 a148, v80
  ds_read_b128 v[20:23], v9 offset:32768
  s_waitcnt lgkmcnt(3)
  v_mfma_f32_32x32x16_bf16 v[32:47], v[24:27], v[176:179], v[32:47]
  v_accvgpr_write_b32 a149, v81
  v_accvgpr_write_b32 a150, v82
  v_accvgpr_write_b32 a151, v83
  v_mfma_f32_32x32x16_bf16 v[48:63], v[24:27], v[240:243], v[48:63]
  v_accvgpr_write_b32 a204, v88
  v_accvgpr_write_b32 a205, v89
  ds_read_b128 v[24:27], v10 offset:32768
  s_waitcnt lgkmcnt(3)
  v_mfma_f32_32x32x16_bf16 v[32:47], v[28:31], v[180:183], v[32:47]
  v_accvgpr_write_b32 a206, v90
  v_accvgpr_write_b32 a207, v91
  v_mfma_f32_32x32x16_bf16 v[48:63], v[28:31], v[244:247], v[48:63]
  s_waitcnt vmcnt(0)
  s_barrier
  ds_read_b128 v[28:31], v11 offset:32768
  s_waitcnt lgkmcnt(3)
  v_mfma_f32_32x32x16_bf16 v[64:79], v[16:19], v[120:123], 0
  v_mfma_f32_32x32x16_bf16 v[80:95], v[16:19], v[184:187], 0
  ds_read_b128 v[16:19], v12 offset:32768
  s_waitcnt lgkmcnt(3)
  v_mfma_f32_32x32x16_bf16 v[64:79], v[20:23], v[124:127], v[64:79]
  v_mul_f32 v32, s52, v32
  v_mul_f32 v33, s52, v33
  v_cvt_pk_bf16_f32 v32, v32, v33
  v_mfma_f32_32x32x16_bf16 v[80:95], v[20:23], v[188:191], v[80:95]
  v_mul_f32 v34, s52, v34
  v_mul_f32 v35, s52, v35
  ds_read_b128 v[20:23], v13 offset:32768
  s_waitcnt lgkmcnt(3)
  v_mfma_f32_32x32x16_bf16 v[64:79], v[24:27], v[128:131], v[64:79]
  v_cvt_pk_bf16_f32 v33, v34, v35
  v_mul_f32 v36, s52, v36
  v_mul_f32 v37, s52, v37
  v_mfma_f32_32x32x16_bf16 v[80:95], v[24:27], v[192:195], v[80:95]
  v_cvt_pk_bf16_f32 v34, v36, v37
  v_mul_f32 v38, s52, v38
  ds_read_b128 v[24:27], v14 offset:32768
  s_waitcnt lgkmcnt(3)
  v_mfma_f32_32x32x16_bf16 v[64:79], v[28:31], v[132:135], v[64:79]
  v_mul_f32 v39, s52, v39
  v_cvt_pk_bf16_f32 v35, v38, v39
  v_mul_f32 v40, s52, v40
  v_mfma_f32_32x32x16_bf16 v[80:95], v[28:31], v[196:199], v[80:95]
  v_mul_f32 v41, s52, v41
  v_cvt_pk_bf16_f32 v40, v40, v41
  ds_read_b128 v[28:31], v15 offset:32768
  s_waitcnt lgkmcnt(3)
  v_mfma_f32_32x32x16_bf16 v[64:79], v[16:19], v[136:139], v[64:79]
  v_mul_f32 v42, s52, v42
  v_mul_f32 v43, s52, v43
  v_cvt_pk_bf16_f32 v41, v42, v43
  v_mfma_f32_32x32x16_bf16 v[80:95], v[16:19], v[200:203], v[80:95]
  v_mul_f32 v44, s52, v44
  v_mul_f32 v45, s52, v45
  ds_read_b128 v[16:19], v8 offset:33024
  s_waitcnt lgkmcnt(3)
  v_mfma_f32_32x32x16_bf16 v[64:79], v[20:23], v[140:143], v[64:79]
  v_cvt_pk_bf16_f32 v42, v44, v45
  v_mul_f32 v46, s52, v46
  v_mul_f32 v47, s52, v47
  v_mfma_f32_32x32x16_bf16 v[80:95], v[20:23], v[204:207], v[80:95]
  v_cvt_pk_bf16_f32 v43, v46, v47
  v_permlane16_swap_b32 v32, v40
  ds_read_b128 v[20:23], v9 offset:33024
  s_waitcnt lgkmcnt(3)
  v_mfma_f32_32x32x16_bf16 v[64:79], v[24:27], v[144:147], v[64:79]
  v_permlane16_swap_b32 v33, v41
  v_permlane16_swap_b32 v34, v42
  v_permlane16_swap_b32 v35, v43
  v_mfma_f32_32x32x16_bf16 v[80:95], v[24:27], v[208:211], v[80:95]
  v_accvgpr_write_b32 a40, v32
  v_accvgpr_write_b32 a41, v33
  ds_read_b128 v[24:27], v10 offset:33024
  s_waitcnt lgkmcnt(3)
  v_mfma_f32_32x32x16_bf16 v[64:79], v[28:31], v[148:151], v[64:79]
  v_accvgpr_write_b32 a42, v34
  v_accvgpr_write_b32 a43, v35
  v_accvgpr_write_b32 a96, v40
  v_mfma_f32_32x32x16_bf16 v[80:95], v[28:31], v[212:215], v[80:95]
  v_accvgpr_write_b32 a97, v41
  v_accvgpr_write_b32 a98, v42
  ds_read_b128 v[28:31], v11 offset:33024
  s_waitcnt lgkmcnt(3)
  v_mfma_f32_32x32x16_bf16 v[64:79], v[16:19], v[152:155], v[64:79]
  v_accvgpr_write_b32 a99, v43
  v_mul_f32 v48, s52, v48
  v_mul_f32 v49, s52, v49
  v_mfma_f32_32x32x16_bf16 v[80:95], v[16:19], v[216:219], v[80:95]
  v_cvt_pk_bf16_f32 v48, v48, v49
  v_mul_f32 v50, s52, v50
  ds_read_b128 v[16:19], v12 offset:33024
  s_waitcnt lgkmcnt(3)
  v_mfma_f32_32x32x16_bf16 v[64:79], v[20:23], v[156:159], v[64:79]
  v_mul_f32 v51, s52, v51
  v_cvt_pk_bf16_f32 v49, v50, v51
  v_mul_f32 v52, s52, v52
  v_mfma_f32_32x32x16_bf16 v[80:95], v[20:23], v[220:223], v[80:95]
  v_mul_f32 v53, s52, v53
  v_cvt_pk_bf16_f32 v50, v52, v53
  ds_read_b128 v[20:23], v13 offset:33024
  s_waitcnt lgkmcnt(3)
  v_mfma_f32_32x32x16_bf16 v[64:79], v[24:27], v[160:163], v[64:79]
  v_mul_f32 v54, s52, v54
  v_mul_f32 v55, s52, v55
  v_cvt_pk_bf16_f32 v51, v54, v55
  v_mfma_f32_32x32x16_bf16 v[80:95], v[24:27], v[224:227], v[80:95]
  v_mul_f32 v56, s52, v56
  v_mul_f32 v57, s52, v57
  ds_read_b128 v[24:27], v14 offset:33024
  s_waitcnt lgkmcnt(3)
  v_mfma_f32_32x32x16_bf16 v[64:79], v[28:31], v[164:167], v[64:79]
  v_cvt_pk_bf16_f32 v56, v56, v57
  v_mul_f32 v58, s52, v58
  v_mul_f32 v59, s52, v59
  v_mfma_f32_32x32x16_bf16 v[80:95], v[28:31], v[228:231], v[80:95]
  v_cvt_pk_bf16_f32 v57, v58, v59
  v_mul_f32 v60, s52, v60
  ds_read_b128 v[28:31], v15 offset:33024
  s_waitcnt lgkmcnt(3)
  v_mfma_f32_32x32x16_bf16 v[64:79], v[16:19], v[168:171], v[64:79]
  v_mul_f32 v61, s52, v61
  v_cvt_pk_bf16_f32 v58, v60, v61
  v_mul_f32 v62, s52, v62
  v_mfma_f32_32x32x16_bf16 v[80:95], v[16:19], v[232:235], v[80:95]
  v_mul_f32 v63, s52, v63
  v_cvt_pk_bf16_f32 v59, v62, v63
  ds_read_b128 v[16:19], v8 offset:49152
  s_waitcnt lgkmcnt(3)
  v_mfma_f32_32x32x16_bf16 v[64:79], v[20:23], v[172:175], v[64:79]
  v_permlane16_swap_b32 v48, v56
  v_permlane16_swap_b32 v49, v57
  v_permlane16_swap_b32 v50, v58
  v_mfma_f32_32x32x16_bf16 v[80:95], v[20:23], v[236:239], v[80:95]
  v_permlane16_swap_b32 v51, v59
  v_accvgpr_write_b32 a152, v48
  ds_read_b128 v[20:23], v9 offset:49152
  s_waitcnt lgkmcnt(3)
  v_mfma_f32_32x32x16_bf16 v[64:79], v[24:27], v[176:179], v[64:79]
  v_accvgpr_write_b32 a153, v49
  v_accvgpr_write_b32 a154, v50
  v_accvgpr_write_b32 a155, v51
  v_mfma_f32_32x32x16_bf16 v[80:95], v[24:27], v[240:243], v[80:95]
  v_accvgpr_write_b32 a208, v56
  v_accvgpr_write_b32 a209, v57
  ds_read_b128 v[24:27], v10 offset:49152
  s_waitcnt lgkmcnt(3)
  v_mfma_f32_32x32x16_bf16 v[64:79], v[28:31], v[180:183], v[64:79]
  v_accvgpr_write_b32 a210, v58
  v_accvgpr_write_b32 a211, v59
  v_mfma_f32_32x32x16_bf16 v[80:95], v[28:31], v[244:247], v[80:95]
  ds_read_b128 v[28:31], v11 offset:49152
  s_waitcnt lgkmcnt(3)
  v_mfma_f32_32x32x16_bf16 v[32:47], v[16:19], v[120:123], 0
  v_mfma_f32_32x32x16_bf16 v[48:63], v[16:19], v[184:187], 0
  ds_read_b128 v[16:19], v12 offset:49152
  s_waitcnt lgkmcnt(3)
  v_mfma_f32_32x32x16_bf16 v[32:47], v[20:23], v[124:127], v[32:47]
  v_mul_f32 v64, s52, v64
  v_mul_f32 v65, s52, v65
  v_cvt_pk_bf16_f32 v64, v64, v65
  v_mfma_f32_32x32x16_bf16 v[48:63], v[20:23], v[188:191], v[48:63]
  v_mul_f32 v66, s52, v66
  v_mul_f32 v67, s52, v67
  ds_read_b128 v[20:23], v13 offset:49152
  s_waitcnt lgkmcnt(3)
  v_mfma_f32_32x32x16_bf16 v[32:47], v[24:27], v[128:131], v[32:47]
  v_cvt_pk_bf16_f32 v65, v66, v67
  v_mul_f32 v68, s52, v68
  v_mul_f32 v69, s52, v69
  v_mfma_f32_32x32x16_bf16 v[48:63], v[24:27], v[192:195], v[48:63]
  v_cvt_pk_bf16_f32 v66, v68, v69
  v_mul_f32 v70, s52, v70
  ds_read_b128 v[24:27], v14 offset:49152
  s_waitcnt lgkmcnt(3)
  v_mfma_f32_32x32x16_bf16 v[32:47], v[28:31], v[132:135], v[32:47]
  v_mul_f32 v71, s52, v71
  v_cvt_pk_bf16_f32 v67, v70, v71
  v_mul_f32 v72, s52, v72
  v_mfma_f32_32x32x16_bf16 v[48:63], v[28:31], v[196:199], v[48:63]
  v_mul_f32 v73, s52, v73
  v_cvt_pk_bf16_f32 v72, v72, v73
  ds_read_b128 v[28:31], v15 offset:49152
  s_waitcnt lgkmcnt(3)
  v_mfma_f32_32x32x16_bf16 v[32:47], v[16:19], v[136:139], v[32:47]
  v_mul_f32 v74, s52, v74
  v_mul_f32 v75, s52, v75
  v_cvt_pk_bf16_f32 v73, v74, v75
  v_mfma_f32_32x32x16_bf16 v[48:63], v[16:19], v[200:203], v[48:63]
  v_mul_f32 v76, s52, v76
  v_mul_f32 v77, s52, v77
  ds_read_b128 v[16:19], v8 offset:49408
  s_waitcnt lgkmcnt(3)
  v_mfma_f32_32x32x16_bf16 v[32:47], v[20:23], v[140:143], v[32:47]
  v_cvt_pk_bf16_f32 v74, v76, v77
  v_mul_f32 v78, s52, v78
  v_mul_f32 v79, s52, v79
  v_mfma_f32_32x32x16_bf16 v[48:63], v[20:23], v[204:207], v[48:63]
  v_cvt_pk_bf16_f32 v75, v78, v79
  v_permlane16_swap_b32 v64, v72
  ds_read_b128 v[20:23], v9 offset:49408
  s_waitcnt lgkmcnt(3)
  v_mfma_f32_32x32x16_bf16 v[32:47], v[24:27], v[144:147], v[32:47]
  v_permlane16_swap_b32 v65, v73
  v_permlane16_swap_b32 v66, v74
  v_permlane16_swap_b32 v67, v75
  v_mfma_f32_32x32x16_bf16 v[48:63], v[24:27], v[208:211], v[48:63]
  v_accvgpr_write_b32 a44, v64
  v_accvgpr_write_b32 a45, v65
  ds_read_b128 v[24:27], v10 offset:49408
  s_waitcnt lgkmcnt(3)
  v_mfma_f32_32x32x16_bf16 v[32:47], v[28:31], v[148:151], v[32:47]
  v_accvgpr_write_b32 a46, v66
  v_accvgpr_write_b32 a47, v67
  v_accvgpr_write_b32 a100, v72
  v_mfma_f32_32x32x16_bf16 v[48:63], v[28:31], v[212:215], v[48:63]
  v_accvgpr_write_b32 a101, v73
  v_accvgpr_write_b32 a102, v74
  ds_read_b128 v[28:31], v11 offset:49408
  s_waitcnt lgkmcnt(3)
  v_mfma_f32_32x32x16_bf16 v[32:47], v[16:19], v[152:155], v[32:47]
  v_accvgpr_write_b32 a103, v75
  v_mul_f32 v80, s52, v80
  v_mul_f32 v81, s52, v81
  v_mfma_f32_32x32x16_bf16 v[48:63], v[16:19], v[216:219], v[48:63]
  v_cvt_pk_bf16_f32 v80, v80, v81
  v_mul_f32 v82, s52, v82
  ds_read_b128 v[16:19], v12 offset:49408
  s_waitcnt lgkmcnt(3)
  v_mfma_f32_32x32x16_bf16 v[32:47], v[20:23], v[156:159], v[32:47]
  v_mul_f32 v83, s52, v83
  v_cvt_pk_bf16_f32 v81, v82, v83
  v_mul_f32 v84, s52, v84
  v_mfma_f32_32x32x16_bf16 v[48:63], v[20:23], v[220:223], v[48:63]
  v_mul_f32 v85, s52, v85
  v_cvt_pk_bf16_f32 v82, v84, v85
  ds_read_b128 v[20:23], v13 offset:49408
  s_waitcnt lgkmcnt(3)
  v_mfma_f32_32x32x16_bf16 v[32:47], v[24:27], v[160:163], v[32:47]
  v_mul_f32 v86, s52, v86
  v_mul_f32 v87, s52, v87
  v_cvt_pk_bf16_f32 v83, v86, v87
  v_mfma_f32_32x32x16_bf16 v[48:63], v[24:27], v[224:227], v[48:63]
  v_mul_f32 v88, s52, v88
  v_mul_f32 v89, s52, v89
  ds_read_b128 v[24:27], v14 offset:49408
  s_waitcnt lgkmcnt(3)
  v_mfma_f32_32x32x16_bf16 v[32:47], v[28:31], v[164:167], v[32:47]
  v_cvt_pk_bf16_f32 v88, v88, v89
  v_mul_f32 v90, s52, v90
  v_mul_f32 v91, s52, v91
  v_mfma_f32_32x32x16_bf16 v[48:63], v[28:31], v[228:231], v[48:63]
  v_cvt_pk_bf16_f32 v89, v90, v91
  v_mul_f32 v92, s52, v92
  ds_read_b128 v[28:31], v15 offset:49408
  s_waitcnt lgkmcnt(3)
  v_mfma_f32_32x32x16_bf16 v[32:47], v[16:19], v[168:171], v[32:47]
  v_mul_f32 v93, s52, v93
  v_cvt_pk_bf16_f32 v90, v92, v93
  v_mul_f32 v94, s52, v94
  v_mfma_f32_32x32x16_bf16 v[48:63], v[16:19], v[232:235], v[48:63]
  v_mul_f32 v95, s52, v95
  v_cvt_pk_bf16_f32 v91, v94, v95
  v_xor_b32 v8, 65536, v8
  ds_read_b128 v[16:19], v8 offset:0
  s_waitcnt lgkmcnt(3)
  v_mfma_f32_32x32x16_bf16 v[32:47], v[20:23], v[172:175], v[32:47]
  v_permlane16_swap_b32 v80, v88
  v_permlane16_swap_b32 v81, v89
  v_permlane16_swap_b32 v82, v90
  v_mfma_f32_32x32x16_bf16 v[48:63], v[20:23], v[236:239], v[48:63]
  v_permlane16_swap_b32 v83, v91
  v_accvgpr_write_b32 a156, v80
  v_xor_b32 v9, 65536, v9
  ds_read_b128 v[20:23], v9 offset:0
  s_waitcnt lgkmcnt(3)
  v_mfma_f32_32x32x16_bf16 v[32:47], v[24:27], v[176:179], v[32:47]
  v_accvgpr_write_b32 a157, v81
  v_accvgpr_write_b32 a158, v82
  v_accvgpr_write_b32 a159, v83
  v_mfma_f32_32x32x16_bf16 v[48:63], v[24:27], v[240:243], v[48:63]
  v_accvgpr_write_b32 a212, v88
  v_accvgpr_write_b32 a213, v89
  v_xor_b32 v10, 65536, v10
  ds_read_b128 v[24:27], v10 offset:0
  s_waitcnt lgkmcnt(3)
  v_mfma_f32_32x32x16_bf16 v[32:47], v[28:31], v[180:183], v[32:47]
  v_accvgpr_write_b32 a214, v90
  v_accvgpr_write_b32 a215, v91
  v_mfma_f32_32x32x16_bf16 v[48:63], v[28:31], v[244:247], v[48:63]
  v_xor_b32 v11, 65536, v11
  ds_read_b128 v[28:31], v11 offset:0
  s_waitcnt lgkmcnt(3)
  v_mfma_f32_32x32x16_bf16 v[64:79], v[16:19], v[120:123], 0
  buffer_load_dwordx4 v[100:103], v113, s[8:11], s28 offen sc1
  v_mfma_f32_32x32x16_bf16 v[80:95], v[16:19], v[184:187], 0
  v_xor_b32 v12, 65536, v12
  ds_read_b128 v[16:19], v12 offset:0
  s_waitcnt lgkmcnt(3)
  v_mfma_f32_32x32x16_bf16 v[64:79], v[20:23], v[124:127], v[64:79]
  buffer_load_dwordx4 v[104:107], v2, s[8:11], s29 offen sc1
  v_mul_f32 v32, s52, v32
  v_mul_f32 v33, s52, v33
  v_cvt_pk_bf16_f32 v32, v32, v33
  v_mfma_f32_32x32x16_bf16 v[80:95], v[20:23], v[188:191], v[80:95]
  v_mul_f32 v34, s52, v34
  v_mul_f32 v35, s52, v35
  v_xor_b32 v13, 65536, v13
  ds_read_b128 v[20:23], v13 offset:0
  s_waitcnt lgkmcnt(3)
  v_mfma_f32_32x32x16_bf16 v[64:79], v[24:27], v[128:131], v[64:79]
  buffer_load_dwordx4 v[108:111], v112, s[8:11], s29 offen sc1
  v_cvt_pk_bf16_f32 v33, v34, v35
  v_mul_f32 v36, s52, v36
  v_mul_f32 v37, s52, v37
  v_mfma_f32_32x32x16_bf16 v[80:95], v[24:27], v[192:195], v[80:95]
  v_cvt_pk_bf16_f32 v34, v36, v37
  v_mul_f32 v38, s52, v38
  v_xor_b32 v14, 65536, v14
  ds_read_b128 v[24:27], v14 offset:0
  s_waitcnt lgkmcnt(3)
  v_mfma_f32_32x32x16_bf16 v[64:79], v[28:31], v[132:135], v[64:79]
  v_mul_f32 v39, s52, v39
  v_cvt_pk_bf16_f32 v35, v38, v39
  v_mul_f32 v40, s52, v40
  v_mfma_f32_32x32x16_bf16 v[80:95], v[28:31], v[196:199], v[80:95]
  v_mul_f32 v41, s52, v41
  v_cvt_pk_bf16_f32 v40, v40, v41
  v_xor_b32 v15, 65536, v15
  ds_read_b128 v[28:31], v15 offset:0
  s_waitcnt lgkmcnt(3)
  v_mfma_f32_32x32x16_bf16 v[64:79], v[16:19], v[136:139], v[64:79]
  v_mul_f32 v42, s52, v42
  v_mul_f32 v43, s52, v43
  v_cvt_pk_bf16_f32 v41, v42, v43
  v_mfma_f32_32x32x16_bf16 v[80:95], v[16:19], v[200:203], v[80:95]
  v_mul_f32 v44, s52, v44
  v_mul_f32 v45, s52, v45
  ds_read_b128 v[16:19], v8 offset:256
  s_waitcnt lgkmcnt(3)
  v_mfma_f32_32x32x16_bf16 v[64:79], v[20:23], v[140:143], v[64:79]
  v_cvt_pk_bf16_f32 v42, v44, v45
  v_mul_f32 v46, s52, v46
  v_mul_f32 v47, s52, v47
  v_mfma_f32_32x32x16_bf16 v[80:95], v[20:23], v[204:207], v[80:95]
  v_cvt_pk_bf16_f32 v43, v46, v47
  v_permlane16_swap_b32 v32, v40
  ds_read_b128 v[20:23], v9 offset:256
  s_waitcnt lgkmcnt(3)
  v_mfma_f32_32x32x16_bf16 v[64:79], v[24:27], v[144:147], v[64:79]
  v_permlane16_swap_b32 v33, v41
  v_permlane16_swap_b32 v34, v42
  v_permlane16_swap_b32 v35, v43
  v_mfma_f32_32x32x16_bf16 v[80:95], v[24:27], v[208:211], v[80:95]
  v_accvgpr_write_b32 a48, v32
  v_accvgpr_write_b32 a49, v33
  ds_read_b128 v[24:27], v10 offset:256
  s_waitcnt lgkmcnt(3)
  v_mfma_f32_32x32x16_bf16 v[64:79], v[28:31], v[148:151], v[64:79]
  v_accvgpr_write_b32 a50, v34
  v_accvgpr_write_b32 a51, v35
  v_accvgpr_write_b32 a104, v40
  v_mfma_f32_32x32x16_bf16 v[80:95], v[28:31], v[212:215], v[80:95]
  v_accvgpr_write_b32 a105, v41
  v_accvgpr_write_b32 a106, v42
  ds_read_b128 v[28:31], v11 offset:256
  s_waitcnt lgkmcnt(3)
  v_mfma_f32_32x32x16_bf16 v[64:79], v[16:19], v[152:155], v[64:79]
  v_accvgpr_write_b32 a107, v43
  v_mul_f32 v48, s52, v48
  v_mul_f32 v49, s52, v49
  v_mfma_f32_32x32x16_bf16 v[80:95], v[16:19], v[216:219], v[80:95]
  v_cvt_pk_bf16_f32 v48, v48, v49
  v_mul_f32 v50, s52, v50
  ds_read_b128 v[16:19], v12 offset:256
  s_waitcnt lgkmcnt(3)
  v_mfma_f32_32x32x16_bf16 v[64:79], v[20:23], v[156:159], v[64:79]
  v_mul_f32 v51, s52, v51
  v_cvt_pk_bf16_f32 v49, v50, v51
  v_mul_f32 v52, s52, v52
  v_mfma_f32_32x32x16_bf16 v[80:95], v[20:23], v[220:223], v[80:95]
  v_mul_f32 v53, s52, v53
  v_cvt_pk_bf16_f32 v50, v52, v53
  ds_read_b128 v[20:23], v13 offset:256
  s_waitcnt lgkmcnt(3)
  v_mfma_f32_32x32x16_bf16 v[64:79], v[24:27], v[160:163], v[64:79]
  v_mul_f32 v54, s52, v54
  v_mul_f32 v55, s52, v55
  v_cvt_pk_bf16_f32 v51, v54, v55
  v_mfma_f32_32x32x16_bf16 v[80:95], v[24:27], v[224:227], v[80:95]
  v_mul_f32 v56, s52, v56
  v_mul_f32 v57, s52, v57
  ds_read_b128 v[24:27], v14 offset:256
  s_waitcnt lgkmcnt(3)
  v_mfma_f32_32x32x16_bf16 v[64:79], v[28:31], v[164:167], v[64:79]
  v_cvt_pk_bf16_f32 v56, v56, v57
  v_mul_f32 v58, s52, v58
  v_mul_f32 v59, s52, v59
  v_mfma_f32_32x32x16_bf16 v[80:95], v[28:31], v[228:231], v[80:95]
  v_cvt_pk_bf16_f32 v57, v58, v59
  v_mul_f32 v60, s52, v60
  ds_read_b128 v[28:31], v15 offset:256
  s_waitcnt lgkmcnt(3)
  v_mfma_f32_32x32x16_bf16 v[64:79], v[16:19], v[168:171], v[64:79]
  v_mul_f32 v61, s52, v61
  v_cvt_pk_bf16_f32 v58, v60, v61
  v_mul_f32 v62, s52, v62
  v_mfma_f32_32x32x16_bf16 v[80:95], v[16:19], v[232:235], v[80:95]
  v_mul_f32 v63, s52, v63
  v_cvt_pk_bf16_f32 v59, v62, v63
  s_waitcnt lgkmcnt(2)
  v_mfma_f32_32x32x16_bf16 v[64:79], v[20:23], v[172:175], v[64:79]
  v_permlane16_swap_b32 v48, v56
  v_permlane16_swap_b32 v49, v57
  v_permlane16_swap_b32 v50, v58
  v_mfma_f32_32x32x16_bf16 v[80:95], v[20:23], v[236:239], v[80:95]
  v_permlane16_swap_b32 v51, v59
  v_accvgpr_write_b32 a160, v48
  s_waitcnt lgkmcnt(1)
  v_mfma_f32_32x32x16_bf16 v[64:79], v[24:27], v[176:179], v[64:79]
  v_accvgpr_write_b32 a161, v49
  v_accvgpr_write_b32 a162, v50
  v_accvgpr_write_b32 a163, v51
  v_mfma_f32_32x32x16_bf16 v[80:95], v[24:27], v[240:243], v[80:95]
  v_accvgpr_write_b32 a216, v56
  v_accvgpr_write_b32 a217, v57
  s_waitcnt lgkmcnt(0)
  v_mfma_f32_32x32x16_bf16 v[64:79], v[28:31], v[180:183], v[64:79]
  v_accvgpr_write_b32 a218, v58
  v_accvgpr_write_b32 a219, v59
  v_mfma_f32_32x32x16_bf16 v[80:95], v[28:31], v[244:247], v[80:95]
  s_nop 4
  v_mul_f32 v64, s52, v64
  v_mul_f32 v65, s52, v65
  v_cvt_pk_bf16_f32 v64, v64, v65
  v_mul_f32 v66, s52, v66
  v_mul_f32 v67, s52, v67
  v_cvt_pk_bf16_f32 v65, v66, v67
  v_mul_f32 v68, s52, v68
  v_mul_f32 v69, s52, v69
  v_cvt_pk_bf16_f32 v66, v68, v69
  v_mul_f32 v70, s52, v70
  v_mul_f32 v71, s52, v71
  v_cvt_pk_bf16_f32 v67, v70, v71
  v_mul_f32 v72, s52, v72
  v_mul_f32 v73, s52, v73
  v_cvt_pk_bf16_f32 v72, v72, v73
  v_mul_f32 v74, s52, v74
  v_mul_f32 v75, s52, v75
  v_cvt_pk_bf16_f32 v73, v74, v75
  v_mul_f32 v76, s52, v76
  v_mul_f32 v77, s52, v77
  v_cvt_pk_bf16_f32 v74, v76, v77
  v_mul_f32 v78, s52, v78
  v_mul_f32 v79, s52, v79
  v_cvt_pk_bf16_f32 v75, v78, v79
  v_permlane16_swap_b32 v64, v72
  v_permlane16_swap_b32 v65, v73
  v_permlane16_swap_b32 v66, v74
  v_permlane16_swap_b32 v67, v75
  v_accvgpr_write_b32 a52, v64
  v_accvgpr_write_b32 a53, v65
  v_accvgpr_write_b32 a54, v66
  v_accvgpr_write_b32 a55, v67
  v_accvgpr_write_b32 a108, v72
  v_accvgpr_write_b32 a109, v73
  v_accvgpr_write_b32 a110, v74
  v_accvgpr_write_b32 a111, v75
  v_mul_f32 v80, s52, v80
  v_mul_f32 v81, s52, v81
  v_cvt_pk_bf16_f32 v80, v80, v81
  v_mul_f32 v82, s52, v82
  v_mul_f32 v83, s52, v83
  v_cvt_pk_bf16_f32 v81, v82, v83
  v_mul_f32 v84, s52, v84
  v_mul_f32 v85, s52, v85
  v_cvt_pk_bf16_f32 v82, v84, v85
  v_mul_f32 v86, s52, v86
  v_mul_f32 v87, s52, v87
  v_cvt_pk_bf16_f32 v83, v86, v87
  v_mul_f32 v88, s52, v88
  v_mul_f32 v89, s52, v89
  v_cvt_pk_bf16_f32 v88, v88, v89
  v_mul_f32 v90, s52, v90
  v_mul_f32 v91, s52, v91
  v_cvt_pk_bf16_f32 v89, v90, v91
  v_mul_f32 v92, s52, v92
  v_mul_f32 v93, s52, v93
  v_cvt_pk_bf16_f32 v90, v92, v93
  v_mul_f32 v94, s52, v94
  v_mul_f32 v95, s52, v95
  v_cvt_pk_bf16_f32 v91, v94, v95
  v_permlane16_swap_b32 v80, v88
  v_permlane16_swap_b32 v81, v89
  v_permlane16_swap_b32 v82, v90
  v_permlane16_swap_b32 v83, v91
  v_accvgpr_write_b32 a164, v80
  v_accvgpr_write_b32 a165, v81
  v_accvgpr_write_b32 a166, v82
  v_accvgpr_write_b32 a167, v83
  v_accvgpr_write_b32 a220, v88
  v_accvgpr_write_b32 a221, v89
  v_accvgpr_write_b32 a222, v90
  v_accvgpr_write_b32 a223, v91
  s_mov_b32 s30, 0
  s_branch sc_aw_w
sc_aw:
  buffer_load_dwordx4 v[100:103], v113, s[8:11], s28 offen sc1
  buffer_load_dwordx4 v[104:107], v2, s[8:11], s29 offen sc1
  buffer_load_dwordx4 v[108:111], v112, s[8:11], s29 offen sc1
sc_aw_w:
  s_waitcnt vmcnt(0)
  v_cmp_ne_u64 vcc, s[88:89], v[100:101]
  s_cbranch_vccnz sc_aw_no
  v_cmp_ne_u64 vcc, s[88:89], v[102:103]
  s_cbranch_vccnz sc_aw_no
  v_cmp_ne_u64 vcc, s[88:89], v[104:105]
  s_cbranch_vccnz sc_aw_no
  v_cmp_ne_u64 vcc, s[88:89], v[106:107]
  s_cbranch_vccnz sc_aw_no
  v_cmp_ne_u64 vcc, s[88:89], v[108:109]
  s_cbranch_vccnz sc_aw_no
  v_cmp_ne_u64 vcc, s[88:89], v[110:111]
  s_cbranch_vccnz sc_aw_no
  s_branch sc_aw_ok
sc_aw_no:
  s_sleep 1
  s_add_u32 s30, s30, 1
  s_cmp_lt_u32 s30, 50000
  s_cbranch_scc1 sc_aw
  s_branch cA_abort
sc_aw_ok:
  s_barrier
  s_branch m_role
m_val:
  s_cmp_lg_u32 s16, 0
  s_cbranch_scc1 w0_6
  v_mov_b32 v233, 128
  v_mov_b32 v234, s88
  v_mov_b32 v235, s89
  v_mov_b32 v236, 0
  v_mov_b32 v237, 0
  s_mov_b64 exec, 1
  buffer_atomic_cmpswap_x2 v[234:237], v233, s[12:15], 0 offen sc0
  s_mov_b64 exec, -1
w0_6:
  s_cmp_lg_u32 s66, 0
  s_cbranch_scc1 va_ci
  s_cmp_lg_u32 s16, 0
  s_cbranch_scc1 w0_7
  s_lshr_b32 s70, s3, 5
  s_and_b32 s71, s70, 4
  s_mul_i32 s71, s71, 12
  s_lshl_b32 s70, s70, 2
  s_add_u32 s70, s70, s71
  s_lshl_b32 s71, 1, s3
  v_mov_b32 v242, s71
  v_mov_b32 v243, 32
  s_mov_b64 exec, 1
  buffer_atomic_or v242, v243, s[12:15], s70 offen sc0
  buffer_load_dwordx2 v[244:245], v243, s[12:15], 0 offen offset:96 sc1
  s_mov_b64 exec, -1
w0_7:
va_ci:
  s_mov_b32 s56, s40
  s_and_b32 s57, s41, 0xffff
  s_mov_b32 s58, 3670016
  s_mov_b32 s59, 0x20000
  v_lshrrev_b32 v24, 5, v1
  v_and_b32 v25, 31, v1
  v_lshlrev_b32 v25, 4, v25
  v_lshl_add_u32 v24, v24, 13, v25
  s_mov_b32 s60, s42
  s_and_b32 s61, s43, 0xffff
  s_mov_b32 s62, 3670016
  s_mov_b32 s63, 0x20000
  s_lshl_b32 s22, s17, 9
  s_lshl_b32 s23, s16, 19
  s_add_u32 s23, s22, s23
  s_add_u32 s21, s23, 262144
  buffer_load_dwordx4 v[28:31], v24, s[60:63], s21 offen
  s_add_u32 s21, s23, 278528
  buffer_load_dwordx4 v[28:31], v24, s[60:63], s21 offen
  s_add_u32 s21, s23, 294912
  buffer_load_dwordx4 v[28:31], v24, s[60:63], s21 offen
  s_add_u32 s21, s23, 311296
  buffer_load_dwordx4 v[28:31], v24, s[60:63], s21 offen
  s_add_u32 s21, s23, 327680
  buffer_load_dwordx4 v[28:31], v24, s[60:63], s21 offen
  s_add_u32 s21, s23, 344064
  buffer_load_dwordx4 v[28:31], v24, s[60:63], s21 offen
  s_add_u32 s21, s23, 360448
  buffer_load_dwordx4 v[28:31], v24, s[60:63], s21 offen
  s_add_u32 s21, s23, 376832
  buffer_load_dwordx4 v[28:31], v24, s[60:63], s21 offen
  s_add_u32 s21, s23, 393216
  buffer_load_dwordx4 v[28:31], v24, s[60:63], s21 offen
  s_add_u32 s21, s23, 409600
  buffer_load_dwordx4 v[28:31], v24, s[60:63], s21 offen
  s_add_u32 s21, s23, 425984
  buffer_load_dwordx4 v[28:31], v24, s[60:63], s21 offen
  s_add_u32 s21, s23, 442368
  buffer_load_dwordx4 v[28:31], v24, s[60:63], s21 offen
  s_add_u32 s21, s23, 458752
  buffer_load_dwordx4 v[28:31], v24, s[60:63], s21 offen
  s_add_u32 s21, s23, 475136
  buffer_load_dwordx4 v[28:31], v24, s[60:63], s21 offen
  s_add_u32 s21, s23, 491520
  buffer_load_dwordx4 v[28:31], v24, s[60:63], s21 offen
  s_add_u32 s21, s23, 507904
  buffer_load_dwordx4 v[28:31], v24, s[60:63], s21 offen
  s_lshl_b32 s23, s16, 14
  s_add_u32 s22, s22, s23
  s_mov_b32 s30, 0
va_pf:
  buffer_load_dwordx4 v[28:31], v24, s[56:59], s22 offen
  s_waitcnt vmcnt(40)
  s_add_u32 s22, s22, 65536
  s_add_u32 s30, s30, 1
  s_cmp_lt_u32 s30, 28
  s_cbranch_scc1 va_pf
  s_cmp_lg_u32 s66, 0
  s_cbranch_scc1 va_cf
  s_cmp_lg_u32 s16, 0
  s_cbranch_scc1 w0_8
  s_waitcnt vmcnt(40)
  v_readfirstlane_b32 s70, v244
  s_cmp_lg_u32 s70, 0
  s_cbranch_scc1 va_nz
  v_mov_b32 v243, 128
  v_mov_b32 v244, s88
  v_mov_b32 v245, s89
  v_mov_b32 v246, 0
  v_mov_b32 v247, 0
  s_mov_b64 exec, 1
  buffer_atomic_cmpswap_x2 v[244:247], v243, s[12:15], 0 offen sc0
  s_mov_b64 exec, -1
  s_waitcnt vmcnt(0)
  v_readfirstlane_b32 s70, v244
  s_cmp_lg_u32 s70, 0
  s_cbranch_scc1 va_nz
  v_mov_b32 v244, s88
  v_mov_b32 v245, s89
va_nz:
w0_8:
  v_mov_b32 v243, 160000
  s_add_u32 s101, s101, 1
  s_barrier
  s_mov_b64 exec, 1
  s_cmp_lg_u32 s16, 0
  s_cbranch_scc1 w0_9
  ds_write_b32 v243, v242 offset:0
  ds_write_b32 v243, v244 offset:4
  ds_write_b32 v243, v245 offset:8
  s_waitcnt lgkmcnt(0)
  v_mov_b32 v242, s101
  ds_write_b32 v243, v242 offset:16
  s_waitcnt lgkmcnt(0)
w0_9:
  s_mov_b64 exec, -1
  s_barrier
  ds_read_b32 v242, v243 offset:0
  ds_read_b32 v244, v243 offset:4
  ds_read_b32 v245, v243 offset:8
  ds_read_b32 v243, v243 offset:16
  s_waitcnt lgkmcnt(0)
  v_readfirstlane_b32 s70, v242
  v_readfirstlane_b32 s88, v244
  v_readfirstlane_b32 s89, v245
  v_cmp_ne_u32 vcc, s101, v243
  s_cbranch_vccnz ch_end
  s_mov_b32 s66, 1
  s_bitcmp1_b32 s70, s3
  s_cbranch_scc1 m_reclaim
va_cf:
  s_cmp_lg_u32 s16, 0
  s_cbranch_scc1 w0_10
  s_cmp_eq_u32 s67, 0
  s_cselect_b32 s20, 1, 0x10001
  v_mov_b32 v242, s20
  v_mov_b32 v243, 0
  s_mov_b64 exec, 1
  buffer_atomic_add v242, v243, s[12:15], 0 offen
  s_mov_b64 exec, -1
w0_10:
m_role:
  s_mov_b32 s17, s3
  v_and_b32 v1, 63, v0
  v_lshlrev_b32 v2, 4, v1
  v_lshrrev_b32 v116, 4, v1
  v_and_b32 v117, 15, v1
  v_mov_b32 v3, 0x4444
  v_mov_b32 v118, 0xeeee
  v_cmp_lt_u32 vcc, 7, v117
  s_nop 1
  v_cndmask_b32 v3, v3, v118, vcc
  s_mov_b32 s19, 0
  s_mov_b32 s20, 75235328
  s_lshr_b32 s22, s17, 4
  s_lshl_b32 s22, s22, 2
  s_add_u32 s22, s22, s16
  s_and_b32 s17, s17, 15
  s_cmp_eq_u32 s22, 0
  s_cbranch_scc1 ch_init0
  s_cmp_eq_u32 s22, 1
  s_cbranch_scc1 ch_init1
  s_cmp_eq_u32 s22, 2
  s_cbranch_scc1 ch_init2
  s_cmp_eq_u32 s22, 3
  s_cbranch_scc1 ch_init3
  s_cmp_eq_u32 s22, 4
  s_cbranch_scc1 ch_init4
  s_cmp_eq_u32 s22, 5
  s_cbranch_scc1 ch_init5
  s_cmp_eq_u32 s22, 6
  s_cbranch_scc1 ch_init6
  s_cmp_eq_u32 s22, 7
  s_cbranch_scc1 ch_init7
  s_branch ch_end
ch_init0:
  s_mul_i32 s31, s17, 401408
  s_add_u32 s31, s31, 0
  s_add_u32 s22, s31, 229376
  buffer_load_dwordx4 a[224:227], v2, s[8:11], s22 offen offset:0 sc1
  buffer_load_dwordx4 a[228:231], v2, s[8:11], s22 offen offset:1024 sc1
  buffer_load_dwordx4 a[232:235], v2, s[8:11], s22 offen offset:2048 sc1
  buffer_load_dwordx4 a[236:239], v2, s[8:11], s22 offen offset:3072 sc1
  s_add_u32 s22, s31, 233472
  buffer_load_dwordx4 a[240:243], v2, s[8:11], s22 offen offset:0 sc1
  buffer_load_dwordx4 a[244:247], v2, s[8:11], s22 offen offset:1024 sc1
  buffer_load_dwordx4 a[248:251], v2, s[8:11], s22 offen offset:2048 sc1
  buffer_load_dwordx4 a[252:255], v2, s[8:11], s22 offen offset:3072 sc1
  s_add_u32 s22, s31, 237568
  buffer_load_dwordx4 v[120:123], v2, s[8:11], s22 offen offset:0 sc1
  buffer_load_dwordx4 v[124:127], v2, s[8:11], s22 offen offset:1024 sc1
  buffer_load_dwordx4 v[128:131], v2, s[8:11], s22 offen offset:2048 sc1
  buffer_load_dwordx4 v[132:135], v2, s[8:11], s22 offen offset:3072 sc1
  s_add_u32 s22, s31, 241664
  buffer_load_dwordx4 v[136:139], v2, s[8:11], s22 offen offset:0 sc1
  buffer_load_dwordx4 v[140:143], v2, s[8:11], s22 offen offset:1024 sc1
  buffer_load_dwordx4 v[144:147], v2, s[8:11], s22 offen offset:2048 sc1
  buffer_load_dwordx4 v[148:151], v2, s[8:11], s22 offen offset:3072 sc1
  s_add_u32 s22, s31, 245760
  buffer_load_dwordx4 v[152:155], v2, s[8:11], s22 offen offset:0 sc1
  buffer_load_dwordx4 v[156:159], v2, s[8:11], s22 offen offset:1024 sc1
  buffer_load_dwordx4 v[160:163], v2, s[8:11], s22 offen offset:2048 sc1
  buffer_load_dwordx4 v[164:167], v2, s[8:11], s22 offen offset:3072 sc1
  s_add_u32 s22, s31, 249856
  buffer_load_dwordx4 v[168:171], v2, s[8:11], s22 offen offset:0 sc1
  buffer_load_dwordx4 v[172:175], v2, s[8:11], s22 offen offset:1024 sc1
  buffer_load_dwordx4 v[176:179], v2, s[8:11], s22 offen offset:2048 sc1
  buffer_load_dwordx4 v[180:183], v2, s[8:11], s22 offen offset:3072 sc1
  s_add_u32 s22, s31, 253952
  buffer_load_dwordx4 v[184:187], v2, s[8:11], s22 offen offset:0 sc1
  buffer_load_dwordx4 v[188:191], v2, s[8:11], s22 offen offset:1024 sc1
  buffer_load_dwordx4 v[192:195], v2, s[8:11], s22 offen offset:2048 sc1
  buffer_load_dwordx4 v[196:199], v2, s[8:11], s22 offen offset:3072 sc1
  s_add_u32 s22, s31, 344064
  buffer_load_dwordx4 v[200:203], v2, s[8:11], s22 offen offset:0 sc1
  buffer_load_dwordx4 v[204:207], v2, s[8:11], s22 offen offset:1024 sc1
  buffer_load_dwordx4 v[208:211], v2, s[8:11], s22 offen offset:2048 sc1
  buffer_load_dwordx4 v[212:215], v2, s[8:11], s22 offen offset:3072 sc1
  s_waitcnt vmcnt(24)
  s_add_u32 s22, s31, 348160
  buffer_load_dwordx4 v[216:219], v2, s[8:11], s22 offen offset:0 sc1
  buffer_load_dwordx4 v[220:223], v2, s[8:11], s22 offen offset:1024 sc1
  buffer_load_dwordx4 v[224:227], v2, s[8:11], s22 offen offset:2048 sc1
  buffer_load_dwordx4 v[228:231], v2, s[8:11], s22 offen offset:3072 sc1
  s_add_u32 s22, s31, 352256
  buffer_load_dwordx4 v[232:235], v2, s[8:11], s22 offen offset:0 sc1
  buffer_load_dwordx4 v[236:239], v2, s[8:11], s22 offen offset:1024 sc1
  buffer_load_dwordx4 v[240:243], v2, s[8:11], s22 offen offset:2048 sc1
  buffer_load_dwordx4 v[244:247], v2, s[8:11], s22 offen offset:3072 sc1
  s_add_u32 s22, s31, 356352
  buffer_load_dwordx4 v[248:251], v2, s[8:11], s22 offen offset:0 sc1
  buffer_load_dwordx4 v[252:255], v2, s[8:11], s22 offen offset:1024 sc1
  s_mov_b32 s24, 71565312
  s_mov_b32 s25, 0
  s_add_u32 m0, s25, 0
  s_nop 0
  buffer_load_dwordx4 v2, s[8:11], s24 offen offset:0 sc1 lds
  buffer_load_dwordx4 v2, s[8:11], s24 offen offset:1024 sc1 lds
  buffer_load_dwordx4 v2, s[8:11], s24 offen offset:2048 sc1 lds
  buffer_load_dwordx4 v2, s[8:11], s24 offen offset:3072 sc1 lds
  s_add_u32 m0, s25, 4096
  s_add_u32 s22, s24, 4096
  buffer_load_dwordx4 v2, s[8:11], s22 offen offset:0 sc1 lds
  buffer_load_dwordx4 v2, s[8:11], s22 offen offset:1024 sc1 lds
  buffer_load_dwordx4 v2, s[8:11], s22 offen offset:2048 sc1 lds
  v_and_b32 v64, 7, v117
  v_and_b32 v65, 1, v116
  v_lshlrev_b32 v65, 2, v65
  v_sub_u32 v64, v64, v65
  v_lshrrev_b32 v65, 3, v117
  v_lshl_add_u32 v66, v65, 2, v64
  v_cmp_gt_u32 vcc, 4, v64
  v_mov_b32 v67, 99
  s_nop 0
  v_cndmask_b32 v66, v67, v66, vcc
  v_mov_b32 v68, 0x3f80
  v_mov_b32 v69, 0x3f800000
  v_mov_b32 v4, 0
  v_cmp_eq_u32 vcc, 0, v66
  s_nop 1
  v_cndmask_b32 v4, v4, v68, vcc
  v_cmp_eq_u32 vcc, 1, v66
  s_nop 1
  v_cndmask_b32 v4, v4, v69, vcc
  v_mov_b32 v5, 0
  v_cmp_eq_u32 vcc, 2, v66
  s_nop 1
  v_cndmask_b32 v5, v5, v68, vcc
  v_cmp_eq_u32 vcc, 3, v66
  s_nop 1
  v_cndmask_b32 v5, v5, v69, vcc
  v_mov_b32 v6, 0
  v_cmp_eq_u32 vcc, 4, v66
  s_nop 1
  v_cndmask_b32 v6, v6, v68, vcc
  v_cmp_eq_u32 vcc, 5, v66
  s_nop 1
  v_cndmask_b32 v6, v6, v69, vcc
  v_mov_b32 v7, 0
  v_cmp_eq_u32 vcc, 6, v66
  s_nop 1
  v_cndmask_b32 v7, v7, v68, vcc
  v_cmp_eq_u32 vcc, 7, v66
  s_nop 1
  v_cndmask_b32 v7, v7, v69, vcc
  v_lshrrev_b32 v64, 1, v116
  v_lshrrev_b32 v65, 3, v117
  v_cmp_eq_u32 s[26:27], v64, v65
  v_and_b32 v66, 1, v116
  v_add_u32 v64, 0, v64
  v_lshrrev_b32 v67, 1, v116
  v_lshlrev_b32 v67, 8, v67
  v_lshl_add_u32 v67, v66, 9, v67
  v_lshl_add_u32 v67, v117, 4, v67
  v_add_u32 v112, 57344, v67
  v_and_b32 v68, 7, v117
  v_lshlrev_b32 v67, 8, v64
  v_lshl_add_u32 v67, v68, 5, v67
  v_lshl_add_u32 v67, v66, 4, v67
  v_add_u32 v113, 65536, v67
  v_lshrrev_b32 v64, 5, v1
  v_and_b32 v65, 31, v1
  v_lshrrev_b32 v66, 3, v65
  v_and_b32 v67, 7, v65
  v_and_b32 v68, 3, v67
  v_lshl_add_u32 v68, v66, 2, v68
  v_lshrrev_b32 v69, 2, v67
  v_lshl_add_u32 v68, v69, 4, v68
  v_lshlrev_b32 v69, 11, v64
  v_lshl_add_u32 v69, v68, 4, v69
  v_add_u32 v114, 57344, v69
  v_add_u32 v70, 0, v64
  v_lshlrev_b32 v69, 9, v66
  v_lshl_add_u32 v69, v70, 5, v69
  v_lshl_add_u32 v69, v67, 2, v69
  v_add_u32 v115, 65536, v69
  v_and_b32 v71, 1, v1
  v_cmp_eq_u32 s[38:39], 0, v71
  v_cmp_gt_u32 vcc, 8, v65
  s_or_b64 s[28:29], s[38:39], vcc
  v_lshrrev_b32 v72, 1, v67
  v_lshlrev_b32 v72, 2, v72
  v_lshl_add_u32 v72, v70, 4, v72
  s_lshl_b32 s22, s17, 9
  s_add_u32 s22, s22, 9216
  v_lshl_add_u32 v73, v66, 7, v72
  v_add_u32 v73, s22, v73
  s_lshl_b32 s22, s17, 7
  s_add_u32 s22, s22, 7168
  v_add_u32 v74, s22, v72
  v_bfe_u32 v72, v65, 1, 1
  v_lshlrev_b32 v72, 7, v72
  v_lshl_add_u32 v72, v70, 4, v72
  v_bfe_u32 v73, v65, 2, 2
  v_lshl_add_u32 v72, v73, 2, v72
  v_lshrrev_b32 v73, 4, v65
  v_lshl_add_u32 v73, v73, 8, v72
  s_lshl_b32 s22, s17, 9
  s_add_u32 s22, s22, 9216
  v_add_u32 v73, s22, v73
  s_lshr_b32 s22, s17, 1
  s_lshl_b32 s22, s22, 8
  s_and_b32 s34, s17, 1
  s_lshl_b32 s34, s34, 3
  s_add_u32 s22, s22, s34
  s_add_u32 s22, s22, 7168
  v_add_u32 v74, s22, v72
  v_lshlrev_b32 v0, 2, v65
  s_and_b32 s22, s17, 31
  s_lshl_b32 s22, s22, 7
  s_add_u32 s22, s22, 21504
  v_add_u32 v0, s22, v0
  v_cndmask_b32 v1, v74, v73, s[38:39]
  s_lshl_b32 s36, s17, 2
  s_add_u32 s36, s36, 17408
  s_mov_b32 s37, 0x3e800000
  v_mov_b32 v64, 0
  v_mov_b32 v65, 0
  v_mov_b32 v66, 0
  v_mov_b32 v67, 0
  v_mov_b32 v68, 0
  v_mov_b32 v69, 0
  v_mov_b32 v70, 0
  v_mov_b32 v71, 0
  v_mov_b32 v72, 0
  v_mov_b32 v73, 0
  v_mov_b32 v74, 0
  v_mov_b32 v75, 0
  v_mov_b32 v76, 0
  v_mov_b32 v77, 0
  v_mov_b32 v78, 0
  v_mov_b32 v79, 0
  v_mov_b32 v80, 0
  v_mov_b32 v81, 0
  v_mov_b32 v82, 0
  v_mov_b32 v83, 0
  v_mov_b32 v84, 0
  v_mov_b32 v85, 0
  v_mov_b32 v86, 0
  v_mov_b32 v87, 0
  v_mov_b32 v88, 0
  v_mov_b32 v89, 0
  v_mov_b32 v90, 0
  v_mov_b32 v91, 0
  v_mov_b32 v92, 0
  v_mov_b32 v93, 0
  v_mov_b32 v94, 0
  v_mov_b32 v95, 0
  v_mov_b32 v96, 0
  v_mov_b32 v97, 0
  v_mov_b32 v98, 0
  v_mov_b32 v99, 0
  v_mov_b32 v100, 0
  v_mov_b32 v101, 0
  v_mov_b32 v102, 0
  v_mov_b32 v103, 0
  v_mov_b32 v104, 0
  v_mov_b32 v105, 0
  v_mov_b32 v106, 0
  v_mov_b32 v107, 0
  v_mov_b32 v108, 0
  v_mov_b32 v109, 0
  v_mov_b32 v110, 0
  v_mov_b32 v111, 0
  v_and_b32 v118, 1, v116
  v_cmp_eq_u32 vcc, 0, v118
  v_mov_b32 v118, 12288
  v_mov_b32 v119, 8192
  v_cndmask_b32 v118, v118, v119, vcc
  v_lshrrev_b32 v116, 1, v116
  v_lshl_add_u32 v118, v116, 9, v118
  v_lshl_add_u32 v117, v117, 4, v118
  s_mov_b32 s57, 28672
  s_mov_b32 s56, 0x42800000
  v_mov_b32 v116, v2
  s_mul_i32 s35, s17, 1835008
  s_add_u32 s35, s35, 42262528
  s_mov_b32 s30, 0
  v_mov_b32 v36, 0
ch_md0:
  buffer_load_dword v37, v36, s[12:15], 0 offen sc1
  s_waitcnt vmcnt(0)
  v_readfirstlane_b32 s22, v37
  s_and_b32 s31, s22, 0xffff
  s_cmp_ge_u32 s31, 32
  s_cbranch_scc1 ch_go0
  s_sleep 2
  s_add_u32 s30, s30, 1
  s_cmp_lt_u32 s30, 50000
  s_cbranch_scc1 ch_md0
  s_branch ch_end
ch_go0:
  s_mov_b32 s31, 0
  s_lshr_b32 s22, s22, 16
  s_cmp_lg_u32 s22, 0
  s_cbranch_scc1 cB_sc0_loop
  s_branch cA_sc0_loop
ch_init1:
  s_mul_i32 s31, s17, 401408
  s_add_u32 s31, s31, 0
  s_add_u32 s22, s31, 258048
  buffer_load_dwordx4 a[224:227], v2, s[8:11], s22 offen offset:0 sc1
  buffer_load_dwordx4 a[228:231], v2, s[8:11], s22 offen offset:1024 sc1
  buffer_load_dwordx4 a[232:235], v2, s[8:11], s22 offen offset:2048 sc1
  buffer_load_dwordx4 a[236:239], v2, s[8:11], s22 offen offset:3072 sc1
  s_add_u32 s22, s31, 262144
  buffer_load_dwordx4 a[240:243], v2, s[8:11], s22 offen offset:0 sc1
  buffer_load_dwordx4 a[244:247], v2, s[8:11], s22 offen offset:1024 sc1
  buffer_load_dwordx4 a[248:251], v2, s[8:11], s22 offen offset:2048 sc1
  buffer_load_dwordx4 a[252:255], v2, s[8:11], s22 offen offset:3072 sc1
  s_add_u32 s22, s31, 266240
  buffer_load_dwordx4 v[120:123], v2, s[8:11], s22 offen offset:0 sc1
  buffer_load_dwordx4 v[124:127], v2, s[8:11], s22 offen offset:1024 sc1
  buffer_load_dwordx4 v[128:131], v2, s[8:11], s22 offen offset:2048 sc1
  buffer_load_dwordx4 v[132:135], v2, s[8:11], s22 offen offset:3072 sc1
  s_add_u32 s22, s31, 270336
  buffer_load_dwordx4 v[136:139], v2, s[8:11], s22 offen offset:0 sc1
  buffer_load_dwordx4 v[140:143], v2, s[8:11], s22 offen offset:1024 sc1
  buffer_load_dwordx4 v[144:147], v2, s[8:11], s22 offen offset:2048 sc1
  buffer_load_dwordx4 v[148:151], v2, s[8:11], s22 offen offset:3072 sc1
  s_add_u32 s22, s31, 274432
  buffer_load_dwordx4 v[152:155], v2, s[8:11], s22 offen offset:0 sc1
  buffer_load_dwordx4 v[156:159], v2, s[8:11], s22 offen offset:1024 sc1
  buffer_load_dwordx4 v[160:163], v2, s[8:11], s22 offen offset:2048 sc1
  buffer_load_dwordx4 v[164:167], v2, s[8:11], s22 offen offset:3072 sc1
  s_add_u32 s22, s31, 278528
  buffer_load_dwordx4 v[168:171], v2, s[8:11], s22 offen offset:0 sc1
  buffer_load_dwordx4 v[172:175], v2, s[8:11], s22 offen offset:1024 sc1
  buffer_load_dwordx4 v[176:179], v2, s[8:11], s22 offen offset:2048 sc1
  buffer_load_dwordx4 v[180:183], v2, s[8:11], s22 offen offset:3072 sc1
  s_add_u32 s22, s31, 282624
  buffer_load_dwordx4 v[184:187], v2, s[8:11], s22 offen offset:0 sc1
  buffer_load_dwordx4 v[188:191], v2, s[8:11], s22 offen offset:1024 sc1
  buffer_load_dwordx4 v[192:195], v2, s[8:11], s22 offen offset:2048 sc1
  buffer_load_dwordx4 v[196:199], v2, s[8:11], s22 offen offset:3072 sc1
  s_add_u32 s22, s31, 356352
  buffer_load_dwordx4 v[200:203], v2, s[8:11], s22 offen offset:2048 sc1
  buffer_load_dwordx4 v[204:207], v2, s[8:11], s22 offen offset:3072 sc1
  s_add_u32 s22, s31, 360448
  buffer_load_dwordx4 v[208:211], v2, s[8:11], s22 offen offset:0 sc1
  buffer_load_dwordx4 v[212:215], v2, s[8:11], s22 offen offset:1024 sc1
  s_waitcnt vmcnt(24)
  buffer_load_dwordx4 v[216:219], v2, s[8:11], s22 offen offset:2048 sc1
  buffer_load_dwordx4 v[220:223], v2, s[8:11], s22 offen offset:3072 sc1
  s_add_u32 s22, s31, 364544
  buffer_load_dwordx4 v[224:227], v2, s[8:11], s22 offen offset:0 sc1
  buffer_load_dwordx4 v[228:231], v2, s[8:11], s22 offen offset:1024 sc1
  buffer_load_dwordx4 v[232:235], v2, s[8:11], s22 offen offset:2048 sc1
  buffer_load_dwordx4 v[236:239], v2, s[8:11], s22 offen offset:3072 sc1
  s_add_u32 s22, s31, 368640
  buffer_load_dwordx4 v[240:243], v2, s[8:11], s22 offen offset:0 sc1
  buffer_load_dwordx4 v[244:247], v2, s[8:11], s22 offen offset:1024 sc1
  buffer_load_dwordx4 v[248:251], v2, s[8:11], s22 offen offset:2048 sc1
  buffer_load_dwordx4 v[252:255], v2, s[8:11], s22 offen offset:3072 sc1
  s_mov_b32 s24, 71572480
  s_mov_b32 s25, 0
  s_add_u32 m0, s25, 7168
  s_nop 0
  buffer_load_dwordx4 v2, s[8:11], s24 offen offset:0 sc1 lds
  buffer_load_dwordx4 v2, s[8:11], s24 offen offset:1024 sc1 lds
  buffer_load_dwordx4 v2, s[8:11], s24 offen offset:2048 sc1 lds
  buffer_load_dwordx4 v2, s[8:11], s24 offen offset:3072 sc1 lds
  s_add_u32 m0, s25, 11264
  s_add_u32 s22, s24, 4096
  buffer_load_dwordx4 v2, s[8:11], s22 offen offset:0 sc1 lds
  buffer_load_dwordx4 v2, s[8:11], s22 offen offset:1024 sc1 lds
  buffer_load_dwordx4 v2, s[8:11], s22 offen offset:2048 sc1 lds
  v_and_b32 v64, 7, v117
  v_and_b32 v65, 1, v116
  v_lshlrev_b32 v65, 2, v65
  v_sub_u32 v64, v64, v65
  v_lshrrev_b32 v65, 3, v117
  v_lshl_add_u32 v66, v65, 2, v64
  v_cmp_gt_u32 vcc, 4, v64
  v_mov_b32 v67, 99
  s_nop 0
  v_cndmask_b32 v66, v67, v66, vcc
  v_mov_b32 v68, 0x3f80
  v_mov_b32 v69, 0x3f800000
  v_mov_b32 v4, 0
  v_cmp_eq_u32 vcc, 0, v66
  s_nop 1
  v_cndmask_b32 v4, v4, v68, vcc
  v_cmp_eq_u32 vcc, 1, v66
  s_nop 1
  v_cndmask_b32 v4, v4, v69, vcc
  v_mov_b32 v5, 0
  v_cmp_eq_u32 vcc, 2, v66
  s_nop 1
  v_cndmask_b32 v5, v5, v68, vcc
  v_cmp_eq_u32 vcc, 3, v66
  s_nop 1
  v_cndmask_b32 v5, v5, v69, vcc
  v_mov_b32 v6, 0
  v_cmp_eq_u32 vcc, 4, v66
  s_nop 1
  v_cndmask_b32 v6, v6, v68, vcc
  v_cmp_eq_u32 vcc, 5, v66
  s_nop 1
  v_cndmask_b32 v6, v6, v69, vcc
  v_mov_b32 v7, 0
  v_cmp_eq_u32 vcc, 6, v66
  s_nop 1
  v_cndmask_b32 v7, v7, v68, vcc
  v_cmp_eq_u32 vcc, 7, v66
  s_nop 1
  v_cndmask_b32 v7, v7, v69, vcc
  v_lshrrev_b32 v64, 1, v116
  v_lshrrev_b32 v65, 3, v117
  v_cmp_eq_u32 s[26:27], v64, v65
  v_and_b32 v66, 1, v116
  v_add_u32 v64, 2, v64
  v_lshrrev_b32 v67, 1, v116
  v_lshlrev_b32 v67, 8, v67
  v_lshl_add_u32 v67, v66, 9, v67
  v_lshl_add_u32 v67, v117, 4, v67
  v_add_u32 v112, 58368, v67
  v_and_b32 v68, 7, v117
  v_lshlrev_b32 v67, 8, v64
  v_lshl_add_u32 v67, v68, 5, v67
  v_lshl_add_u32 v67, v66, 4, v67
  v_add_u32 v113, 65536, v67
  v_lshrrev_b32 v64, 5, v1
  v_and_b32 v65, 31, v1
  v_lshrrev_b32 v66, 3, v65
  v_and_b32 v67, 7, v65
  v_and_b32 v68, 3, v67
  v_lshl_add_u32 v68, v66, 2, v68
  v_lshrrev_b32 v69, 2, v67
  v_lshl_add_u32 v68, v69, 4, v68
  v_lshlrev_b32 v69, 11, v64
  v_lshl_add_u32 v69, v68, 4, v69
  v_add_u32 v114, 57352, v69
  v_add_u32 v70, 2, v64
  v_lshlrev_b32 v69, 9, v66
  v_lshl_add_u32 v69, v70, 5, v69
  v_lshl_add_u32 v69, v67, 2, v69
  v_add_u32 v115, 65536, v69
  v_and_b32 v71, 1, v1
  v_cmp_eq_u32 s[38:39], 0, v71
  v_cmp_gt_u32 vcc, 8, v65
  s_or_b64 s[28:29], s[38:39], vcc
  v_lshrrev_b32 v72, 1, v67
  v_lshlrev_b32 v72, 2, v72
  v_lshl_add_u32 v72, v70, 4, v72
  s_lshl_b32 s22, s17, 9
  s_add_u32 s22, s22, 9216
  v_lshl_add_u32 v73, v66, 7, v72
  v_add_u32 v73, s22, v73
  s_lshl_b32 s22, s17, 7
  s_add_u32 s22, s22, 7168
  v_add_u32 v74, s22, v72
  v_bfe_u32 v72, v65, 1, 1
  v_lshlrev_b32 v72, 7, v72
  v_lshl_add_u32 v72, v70, 4, v72
  v_bfe_u32 v73, v65, 2, 2
  v_lshl_add_u32 v72, v73, 2, v72
  v_lshrrev_b32 v73, 4, v65
  v_lshl_add_u32 v73, v73, 8, v72
  s_lshl_b32 s22, s17, 9
  s_add_u32 s22, s22, 9216
  v_add_u32 v73, s22, v73
  s_lshr_b32 s22, s17, 1
  s_lshl_b32 s22, s22, 8
  s_and_b32 s34, s17, 1
  s_lshl_b32 s34, s34, 3
  s_add_u32 s22, s22, s34
  s_add_u32 s22, s22, 7168
  v_add_u32 v74, s22, v72
  v_lshlrev_b32 v0, 2, v65
  s_and_b32 s22, s17, 31
  s_lshl_b32 s22, s22, 7
  s_add_u32 s22, s22, 21504
  v_add_u32 v0, s22, v0
  v_cndmask_b32 v1, v74, v73, s[38:39]
  s_lshl_b32 s36, s17, 2
  s_add_u32 s36, s36, 17408
  s_mov_b32 s37, 0x3e800000
  v_mov_b32 v64, 0
  v_mov_b32 v65, 0
  v_mov_b32 v66, 0
  v_mov_b32 v67, 0
  v_mov_b32 v68, 0
  v_mov_b32 v69, 0
  v_mov_b32 v70, 0
  v_mov_b32 v71, 0
  v_mov_b32 v72, 0
  v_mov_b32 v73, 0
  v_mov_b32 v74, 0
  v_mov_b32 v75, 0
  v_mov_b32 v76, 0
  v_mov_b32 v77, 0
  v_mov_b32 v78, 0
  v_mov_b32 v79, 0
  v_mov_b32 v80, 0
  v_mov_b32 v81, 0
  v_mov_b32 v82, 0
  v_mov_b32 v83, 0
  v_mov_b32 v84, 0
  v_mov_b32 v85, 0
  v_mov_b32 v86, 0
  v_mov_b32 v87, 0
  v_mov_b32 v88, 0
  v_mov_b32 v89, 0
  v_mov_b32 v90, 0
  v_mov_b32 v91, 0
  v_mov_b32 v92, 0
  v_mov_b32 v93, 0
  v_mov_b32 v94, 0
  v_mov_b32 v95, 0
  v_mov_b32 v96, 0
  v_mov_b32 v97, 0
  v_mov_b32 v98, 0
  v_mov_b32 v99, 0
  v_mov_b32 v100, 0
  v_mov_b32 v101, 0
  v_mov_b32 v102, 0
  v_mov_b32 v103, 0
  v_mov_b32 v104, 0
  v_mov_b32 v105, 0
  v_mov_b32 v106, 0
  v_mov_b32 v107, 0
  v_mov_b32 v108, 0
  v_mov_b32 v109, 0
  v_mov_b32 v110, 0
  v_mov_b32 v111, 0
  v_and_b32 v118, 1, v116
  v_cmp_eq_u32 vcc, 0, v118
  v_mov_b32 v118, 12288
  v_mov_b32 v119, 8448
  v_cndmask_b32 v118, v118, v119, vcc
  v_lshrrev_b32 v116, 1, v116
  v_lshl_add_u32 v118, v116, 9, v118
  v_lshl_add_u32 v117, v117, 4, v118
  s_mov_b32 s57, 28672
  s_mov_b32 s56, 0x42800000
  v_mov_b32 v116, v2
  v_lshrrev_b32 v0, 4, v2
  v_min_u32 v0, 12, v0
  s_mul_i32 s22, s17, 13
  v_add_u32 v0, s22, v0
  v_lshlrev_b32 v0, 7, v0
  v_add_u32 v0, 51200, v0
  s_mov_b32 s22, 75209728
  buffer_load_dword v119, v0, s[8:11], s22 offen sc1
  s_mov_b32 s22, 75184128
  buffer_load_dword v119, v0, s[8:11], s22 offen sc1
  s_mul_i32 s35, s17, 1835008
  s_add_u32 s35, s35, 42269696
  s_mov_b32 s30, 0
  v_mov_b32 v36, 0
ch_md1:
  buffer_load_dword v37, v36, s[12:15], 0 offen sc1
  s_waitcnt vmcnt(0)
  v_readfirstlane_b32 s22, v37
  s_and_b32 s31, s22, 0xffff
  s_cmp_ge_u32 s31, 32
  s_cbranch_scc1 ch_go1
  s_sleep 2
  s_add_u32 s30, s30, 1
  s_cmp_lt_u32 s30, 50000
  s_cbranch_scc1 ch_md1
  s_branch ch_end
ch_go1:
  s_mov_b32 s31, 0
  s_lshr_b32 s22, s22, 16
  s_cmp_lg_u32 s22, 0
  s_cbranch_scc1 cB_sc1_loop
  s_branch cA_sc1_loop
ch_init2:
  s_mul_i32 s31, s17, 401408
  s_add_u32 s31, s31, 0
  s_add_u32 s22, s31, 286720
  buffer_load_dwordx4 a[224:227], v2, s[8:11], s22 offen offset:0 sc1
  buffer_load_dwordx4 a[228:231], v2, s[8:11], s22 offen offset:1024 sc1
  buffer_load_dwordx4 a[232:235], v2, s[8:11], s22 offen offset:2048 sc1
  buffer_load_dwordx4 a[236:239], v2, s[8:11], s22 offen offset:3072 sc1
  s_add_u32 s22, s31, 290816
  buffer_load_dwordx4 a[240:243], v2, s[8:11], s22 offen offset:0 sc1
  buffer_load_dwordx4 a[244:247], v2, s[8:11], s22 offen offset:1024 sc1
  buffer_load_dwordx4 a[248:251], v2, s[8:11], s22 offen offset:2048 sc1
  buffer_load_dwordx4 a[252:255], v2, s[8:11], s22 offen offset:3072 sc1
  s_add_u32 s22, s31, 294912
  buffer_load_dwordx4 v[120:123], v2, s[8:11], s22 offen offset:0 sc1
  buffer_load_dwordx4 v[124:127], v2, s[8:11], s22 offen offset:1024 sc1
  buffer_load_dwordx4 v[128:131], v2, s[8:11], s22 offen offset:2048 sc1
  buffer_load_dwordx4 v[132:135], v2, s[8:11], s22 offen offset:3072 sc1
  s_add_u32 s22, s31, 299008
  buffer_load_dwordx4 v[136:139], v2, s[8:11], s22 offen offset:0 sc1
  buffer_load_dwordx4 v[140:143], v2, s[8:11], s22 offen offset:1024 sc1
  buffer_load_dwordx4 v[144:147], v2, s[8:11], s22 offen offset:2048 sc1
  buffer_load_dwordx4 v[148:151], v2, s[8:11], s22 offen offset:3072 sc1
  s_add_u32 s22, s31, 303104
  buffer_load_dwordx4 v[152:155], v2, s[8:11], s22 offen offset:0 sc1
  buffer_load_dwordx4 v[156:159], v2, s[8:11], s22 offen offset:1024 sc1
  buffer_load_dwordx4 v[160:163], v2, s[8:11], s22 offen offset:2048 sc1
  buffer_load_dwordx4 v[164:167], v2, s[8:11], s22 offen offset:3072 sc1
  s_add_u32 s22, s31, 307200
  buffer_load_dwordx4 v[168:171], v2, s[8:11], s22 offen offset:0 sc1
  buffer_load_dwordx4 v[172:175], v2, s[8:11], s22 offen offset:1024 sc1
  buffer_load_dwordx4 v[176:179], v2, s[8:11], s22 offen offset:2048 sc1
  buffer_load_dwordx4 v[180:183], v2, s[8:11], s22 offen offset:3072 sc1
  s_add_u32 s22, s31, 311296
  buffer_load_dwordx4 v[184:187], v2, s[8:11], s22 offen offset:0 sc1
  buffer_load_dwordx4 v[188:191], v2, s[8:11], s22 offen offset:1024 sc1
  buffer_load_dwordx4 v[192:195], v2, s[8:11], s22 offen offset:2048 sc1
  buffer_load_dwordx4 v[196:199], v2, s[8:11], s22 offen offset:3072 sc1
  s_add_u32 s22, s31, 372736
  buffer_load_dwordx4 v[200:203], v2, s[8:11], s22 offen offset:0 sc1
  buffer_load_dwordx4 v[204:207], v2, s[8:11], s22 offen offset:1024 sc1
  buffer_load_dwordx4 v[208:211], v2, s[8:11], s22 offen offset:2048 sc1
  buffer_load_dwordx4 v[212:215], v2, s[8:11], s22 offen offset:3072 sc1
  s_waitcnt vmcnt(24)
  s_add_u32 s22, s31, 376832
  buffer_load_dwordx4 v[216:219], v2, s[8:11], s22 offen offset:0 sc1
  buffer_load_dwordx4 v[220:223], v2, s[8:11], s22 offen offset:1024 sc1
  buffer_load_dwordx4 v[224:227], v2, s[8:11], s22 offen offset:2048 sc1
  buffer_load_dwordx4 v[228:231], v2, s[8:11], s22 offen offset:3072 sc1
  s_add_u32 s22, s31, 380928
  buffer_load_dwordx4 v[232:235], v2, s[8:11], s22 offen offset:0 sc1
  buffer_load_dwordx4 v[236:239], v2, s[8:11], s22 offen offset:1024 sc1
  buffer_load_dwordx4 v[240:243], v2, s[8:11], s22 offen offset:2048 sc1
  buffer_load_dwordx4 v[244:247], v2, s[8:11], s22 offen offset:3072 sc1
  s_add_u32 s22, s31, 385024
  buffer_load_dwordx4 v[248:251], v2, s[8:11], s22 offen offset:0 sc1
  buffer_load_dwordx4 v[252:255], v2, s[8:11], s22 offen offset:1024 sc1
  s_mov_b32 s24, 71579648
  s_mov_b32 s25, 0
  s_add_u32 m0, s25, 14336
  s_nop 0
  buffer_load_dwordx4 v2, s[8:11], s24 offen offset:0 sc1 lds
  buffer_load_dwordx4 v2, s[8:11], s24 offen offset:1024 sc1 lds
  buffer_load_dwordx4 v2, s[8:11], s24 offen offset:2048 sc1 lds
  buffer_load_dwordx4 v2, s[8:11], s24 offen offset:3072 sc1 lds
  s_add_u32 m0, s25, 18432
  s_add_u32 s22, s24, 4096
  buffer_load_dwordx4 v2, s[8:11], s22 offen offset:0 sc1 lds
  buffer_load_dwordx4 v2, s[8:11], s22 offen offset:1024 sc1 lds
  buffer_load_dwordx4 v2, s[8:11], s22 offen offset:2048 sc1 lds
  v_and_b32 v64, 7, v117
  v_and_b32 v65, 1, v116
  v_lshlrev_b32 v65, 2, v65
  v_sub_u32 v64, v64, v65
  v_lshrrev_b32 v65, 3, v117
  v_lshl_add_u32 v66, v65, 2, v64
  v_cmp_gt_u32 vcc, 4, v64
  v_mov_b32 v67, 99
  s_nop 0
  v_cndmask_b32 v66, v67, v66, vcc
  v_mov_b32 v68, 0x3f80
  v_mov_b32 v69, 0x3f800000
  v_mov_b32 v4, 0
  v_cmp_eq_u32 vcc, 0, v66
  s_nop 1
  v_cndmask_b32 v4, v4, v68, vcc
  v_cmp_eq_u32 vcc, 1, v66
  s_nop 1
  v_cndmask_b32 v4, v4, v69, vcc
  v_mov_b32 v5, 0
  v_cmp_eq_u32 vcc, 2, v66
  s_nop 1
  v_cndmask_b32 v5, v5, v68, vcc
  v_cmp_eq_u32 vcc, 3, v66
  s_nop 1
  v_cndmask_b32 v5, v5, v69, vcc
  v_mov_b32 v6, 0
  v_cmp_eq_u32 vcc, 4, v66
  s_nop 1
  v_cndmask_b32 v6, v6, v68, vcc
  v_cmp_eq_u32 vcc, 5, v66
  s_nop 1
  v_cndmask_b32 v6, v6, v69, vcc
  v_mov_b32 v7, 0
  v_cmp_eq_u32 vcc, 6, v66
  s_nop 1
  v_cndmask_b32 v7, v7, v68, vcc
  v_cmp_eq_u32 vcc, 7, v66
  s_nop 1
  v_cndmask_b32 v7, v7, v69, vcc
  v_lshrrev_b32 v64, 1, v116
  v_lshrrev_b32 v65, 3, v117
  v_cmp_eq_u32 s[26:27], v64, v65
  v_and_b32 v66, 1, v116
  v_add_u32 v64, 4, v64
  v_lshrrev_b32 v67, 1, v116
  v_lshlrev_b32 v67, 8, v67
  v_lshl_add_u32 v67, v66, 9, v67
  v_lshl_add_u32 v67, v117, 4, v67
  v_add_u32 v112, 59392, v67
  v_and_b32 v68, 7, v117
  v_lshlrev_b32 v67, 8, v64
  v_lshl_add_u32 v67, v68, 5, v67
  v_lshl_add_u32 v67, v66, 4, v67
  v_add_u32 v113, 65536, v67
  v_lshrrev_b32 v64, 5, v1
  v_and_b32 v65, 31, v1
  v_lshrrev_b32 v66, 3, v65
  v_and_b32 v67, 7, v65
  v_and_b32 v68, 3, v67
  v_lshl_add_u32 v68, v66, 2, v68
  v_lshrrev_b32 v69, 2, v67
  v_lshl_add_u32 v68, v69, 4, v68
  v_lshlrev_b32 v69, 11, v64
  v_lshl_add_u32 v69, v68, 4, v69
  v_add_u32 v114, 57856, v69
  v_add_u32 v70, 4, v64
  v_lshlrev_b32 v69, 9, v66
  v_lshl_add_u32 v69, v70, 5, v69
  v_lshl_add_u32 v69, v67, 2, v69
  v_add_u32 v115, 65536, v69
  v_and_b32 v71, 1, v1
  v_cmp_eq_u32 s[38:39], 0, v71
  v_cmp_gt_u32 vcc, 8, v65
  s_or_b64 s[28:29], s[38:39], vcc
  v_lshrrev_b32 v72, 1, v67
  v_lshlrev_b32 v72, 2, v72
  v_lshl_add_u32 v72, v70, 4, v72
  s_lshl_b32 s22, s17, 9
  s_add_u32 s22, s22, 9216
  v_lshl_add_u32 v73, v66, 7, v72
  v_add_u32 v73, s22, v73
  s_lshl_b32 s22, s17, 7
  s_add_u32 s22, s22, 7168
  v_add_u32 v74, s22, v72
  v_bfe_u32 v72, v65, 1, 1
  v_lshlrev_b32 v72, 7, v72
  v_lshl_add_u32 v72, v70, 4, v72
  v_bfe_u32 v73, v65, 2, 2
  v_lshl_add_u32 v72, v73, 2, v72
  v_lshrrev_b32 v73, 4, v65
  v_lshl_add_u32 v73, v73, 8, v72
  s_lshl_b32 s22, s17, 9
  s_add_u32 s22, s22, 9216
  v_add_u32 v73, s22, v73
  s_lshr_b32 s22, s17, 1
  s_lshl_b32 s22, s22, 8
  s_and_b32 s34, s17, 1
  s_lshl_b32 s34, s34, 3
  s_add_u32 s22, s22, s34
  s_add_u32 s22, s22, 7168
  v_add_u32 v74, s22, v72
  v_lshlrev_b32 v0, 2, v65
  s_and_b32 s22, s17, 31
  s_lshl_b32 s22, s22, 7
  s_add_u32 s22, s22, 21504
  v_add_u32 v0, s22, v0
  v_cndmask_b32 v1, v74, v73, s[38:39]
  s_lshl_b32 s36, s17, 2
  s_add_u32 s36, s36, 17408
  s_mov_b32 s37, 0x3e800000
  v_mov_b32 v64, 0
  v_mov_b32 v65, 0
  v_mov_b32 v66, 0
  v_mov_b32 v67, 0
  v_mov_b32 v68, 0
  v_mov_b32 v69, 0
  v_mov_b32 v70, 0
  v_mov_b32 v71, 0
  v_mov_b32 v72, 0
  v_mov_b32 v73, 0
  v_mov_b32 v74, 0
  v_mov_b32 v75, 0
  v_mov_b32 v76, 0
  v_mov_b32 v77, 0
  v_mov_b32 v78, 0
  v_mov_b32 v79, 0
  v_mov_b32 v80, 0
  v_mov_b32 v81, 0
  v_mov_b32 v82, 0
  v_mov_b32 v83, 0
  v_mov_b32 v84, 0
  v_mov_b32 v85, 0
  v_mov_b32 v86, 0
  v_mov_b32 v87, 0
  v_mov_b32 v88, 0
  v_mov_b32 v89, 0
  v_mov_b32 v90, 0
  v_mov_b32 v91, 0
  v_mov_b32 v92, 0
  v_mov_b32 v93, 0
  v_mov_b32 v94, 0
  v_mov_b32 v95, 0
  v_mov_b32 v96, 0
  v_mov_b32 v97, 0
  v_mov_b32 v98, 0
  v_mov_b32 v99, 0
  v_mov_b32 v100, 0
  v_mov_b32 v101, 0
  v_mov_b32 v102, 0
  v_mov_b32 v103, 0
  v_mov_b32 v104, 0
  v_mov_b32 v105, 0
  v_mov_b32 v106, 0
  v_mov_b32 v107, 0
  v_mov_b32 v108, 0
  v_mov_b32 v109, 0
  v_mov_b32 v110, 0
  v_mov_b32 v111, 0
  v_and_b32 v118, 1, v116
  v_cmp_eq_u32 vcc, 0, v118
  v_mov_b32 v118, 12544
  v_mov_b32 v119, 10240
  v_cndmask_b32 v118, v118, v119, vcc
  v_lshrrev_b32 v116, 1, v116
  v_lshl_add_u32 v118, v116, 9, v118
  v_lshl_add_u32 v117, v117, 4, v118
  s_mov_b32 s57, 28672
  s_mov_b32 s56, 0x42800000
  v_mov_b32 v116, v2
  v_lshrrev_b32 v0, 4, v2
  v_min_u32 v0, 13, v0
  s_mul_i32 s22, s17, 14
  v_add_u32 v0, s22, v0
  v_lshlrev_b32 v0, 7, v0
  v_add_u32 v0, 43008, v0
  s_mov_b32 s22, 71550976
  buffer_load_dword v119, v0, s[8:11], s22 offen sc1
  s_mov_b32 s22, 71522304
  buffer_load_dword v119, v0, s[8:11], s22 offen sc1
  s_mul_i32 s35, s17, 1835008
  s_add_u32 s35, s35, 42276864
  s_mov_b32 s30, 0
  v_mov_b32 v36, 0
ch_md2:
  buffer_load_dword v37, v36, s[12:15], 0 offen sc1
  s_waitcnt vmcnt(0)
  v_readfirstlane_b32 s22, v37
  s_and_b32 s31, s22, 0xffff
  s_cmp_ge_u32 s31, 32
  s_cbranch_scc1 ch_go2
  s_sleep 2
  s_add_u32 s30, s30, 1
  s_cmp_lt_u32 s30, 50000
  s_cbranch_scc1 ch_md2
  s_branch ch_end
ch_go2:
  s_mov_b32 s31, 0
  s_lshr_b32 s22, s22, 16
  s_cmp_lg_u32 s22, 0
  s_cbranch_scc1 cB_sc2_loop
  s_branch cA_sc2_loop
ch_init3:
  s_mul_i32 s31, s17, 401408
  s_add_u32 s31, s31, 0
  s_add_u32 s22, s31, 315392
  buffer_load_dwordx4 a[224:227], v2, s[8:11], s22 offen offset:0 sc1
  buffer_load_dwordx4 a[228:231], v2, s[8:11], s22 offen offset:1024 sc1
  buffer_load_dwordx4 a[232:235], v2, s[8:11], s22 offen offset:2048 sc1
  buffer_load_dwordx4 a[236:239], v2, s[8:11], s22 offen offset:3072 sc1
  s_add_u32 s22, s31, 319488
  buffer_load_dwordx4 a[240:243], v2, s[8:11], s22 offen offset:0 sc1
  buffer_load_dwordx4 a[244:247], v2, s[8:11], s22 offen offset:1024 sc1
  buffer_load_dwordx4 a[248:251], v2, s[8:11], s22 offen offset:2048 sc1
  buffer_load_dwordx4 a[252:255], v2, s[8:11], s22 offen offset:3072 sc1
  s_add_u32 s22, s31, 323584
  buffer_load_dwordx4 v[120:123], v2, s[8:11], s22 offen offset:0 sc1
  buffer_load_dwordx4 v[124:127], v2, s[8:11], s22 offen offset:1024 sc1
  buffer_load_dwordx4 v[128:131], v2, s[8:11], s22 offen offset:2048 sc1
  buffer_load_dwordx4 v[132:135], v2, s[8:11], s22 offen offset:3072 sc1
  s_add_u32 s22, s31, 327680
  buffer_load_dwordx4 v[136:139], v2, s[8:11], s22 offen offset:0 sc1
  buffer_load_dwordx4 v[140:143], v2, s[8:11], s22 offen offset:1024 sc1
  buffer_load_dwordx4 v[144:147], v2, s[8:11], s22 offen offset:2048 sc1
  buffer_load_dwordx4 v[148:151], v2, s[8:11], s22 offen offset:3072 sc1
  s_add_u32 s22, s31, 331776
  buffer_load_dwordx4 v[152:155], v2, s[8:11], s22 offen offset:0 sc1
  buffer_load_dwordx4 v[156:159], v2, s[8:11], s22 offen offset:1024 sc1
  buffer_load_dwordx4 v[160:163], v2, s[8:11], s22 offen offset:2048 sc1
  buffer_load_dwordx4 v[164:167], v2, s[8:11], s22 offen offset:3072 sc1
  s_add_u32 s22, s31, 335872
  buffer_load_dwordx4 v[168:171], v2, s[8:11], s22 offen offset:0 sc1
  buffer_load_dwordx4 v[172:175], v2, s[8:11], s22 offen offset:1024 sc1
  buffer_load_dwordx4 v[176:179], v2, s[8:11], s22 offen offset:2048 sc1
  buffer_load_dwordx4 v[180:183], v2, s[8:11], s22 offen offset:3072 sc1
  s_add_u32 s22, s31, 339968
  buffer_load_dwordx4 v[184:187], v2, s[8:11], s22 offen offset:0 sc1
  buffer_load_dwordx4 v[188:191], v2, s[8:11], s22 offen offset:1024 sc1
  buffer_load_dwordx4 v[192:195], v2, s[8:11], s22 offen offset:2048 sc1
  buffer_load_dwordx4 v[196:199], v2, s[8:11], s22 offen offset:3072 sc1
  s_add_u32 s22, s31, 385024
  buffer_load_dwordx4 v[200:203], v2, s[8:11], s22 offen offset:2048 sc1
  buffer_load_dwordx4 v[204:207], v2, s[8:11], s22 offen offset:3072 sc1
  s_add_u32 s22, s31, 389120
  buffer_load_dwordx4 v[208:211], v2, s[8:11], s22 offen offset:0 sc1
  buffer_load_dwordx4 v[212:215], v2, s[8:11], s22 offen offset:1024 sc1
  s_waitcnt vmcnt(24)
  buffer_load_dwordx4 v[216:219], v2, s[8:11], s22 offen offset:2048 sc1
  buffer_load_dwordx4 v[220:223], v2, s[8:11], s22 offen offset:3072 sc1
  s_add_u32 s22, s31, 393216
  buffer_load_dwordx4 v[224:227], v2, s[8:11], s22 offen offset:0 sc1
  buffer_load_dwordx4 v[228:231], v2, s[8:11], s22 offen offset:1024 sc1
  buffer_load_dwordx4 v[232:235], v2, s[8:11], s22 offen offset:2048 sc1
  buffer_load_dwordx4 v[236:239], v2, s[8:11], s22 offen offset:3072 sc1
  s_add_u32 s22, s31, 397312
  buffer_load_dwordx4 v[240:243], v2, s[8:11], s22 offen offset:0 sc1
  buffer_load_dwordx4 v[244:247], v2, s[8:11], s22 offen offset:1024 sc1
  buffer_load_dwordx4 v[248:251], v2, s[8:11], s22 offen offset:2048 sc1
  buffer_load_dwordx4 v[252:255], v2, s[8:11], s22 offen offset:3072 sc1
  s_mov_b32 s24, 71586816
  s_mov_b32 s25, 0
  s_add_u32 m0, s25, 21504
  s_nop 0
  buffer_load_dwordx4 v2, s[8:11], s24 offen offset:0 sc1 lds
  buffer_load_dwordx4 v2, s[8:11], s24 offen offset:1024 sc1 lds
  buffer_load_dwordx4 v2, s[8:11], s24 offen offset:2048 sc1 lds
  buffer_load_dwordx4 v2, s[8:11], s24 offen offset:3072 sc1 lds
  s_add_u32 m0, s25, 25600
  s_add_u32 s22, s24, 4096
  buffer_load_dwordx4 v2, s[8:11], s22 offen offset:0 sc1 lds
  buffer_load_dwordx4 v2, s[8:11], s22 offen offset:1024 sc1 lds
  buffer_load_dwordx4 v2, s[8:11], s22 offen offset:2048 sc1 lds
  v_and_b32 v64, 7, v117
  v_and_b32 v65, 1, v116
  v_lshlrev_b32 v65, 2, v65
  v_sub_u32 v64, v64, v65
  v_lshrrev_b32 v65, 3, v117
  v_lshl_add_u32 v66, v65, 2, v64
  v_cmp_gt_u32 vcc, 4, v64
  v_mov_b32 v67, 99
  s_nop 0
  v_cndmask_b32 v66, v67, v66, vcc
  v_mov_b32 v68, 0x3f80
  v_mov_b32 v69, 0x3f800000
  v_mov_b32 v4, 0
  v_cmp_eq_u32 vcc, 0, v66
  s_nop 1
  v_cndmask_b32 v4, v4, v68, vcc
  v_cmp_eq_u32 vcc, 1, v66
  s_nop 1
  v_cndmask_b32 v4, v4, v69, vcc
  v_mov_b32 v5, 0
  v_cmp_eq_u32 vcc, 2, v66
  s_nop 1
  v_cndmask_b32 v5, v5, v68, vcc
  v_cmp_eq_u32 vcc, 3, v66
  s_nop 1
  v_cndmask_b32 v5, v5, v69, vcc
  v_mov_b32 v6, 0
  v_cmp_eq_u32 vcc, 4, v66
  s_nop 1
  v_cndmask_b32 v6, v6, v68, vcc
  v_cmp_eq_u32 vcc, 5, v66
  s_nop 1
  v_cndmask_b32 v6, v6, v69, vcc
  v_mov_b32 v7, 0
  v_cmp_eq_u32 vcc, 6, v66
  s_nop 1
  v_cndmask_b32 v7, v7, v68, vcc
  v_cmp_eq_u32 vcc, 7, v66
  s_nop 1
  v_cndmask_b32 v7, v7, v69, vcc
  v_lshrrev_b32 v64, 1, v116
  v_lshrrev_b32 v65, 3, v117
  v_cmp_eq_u32 s[26:27], v64, v65
  v_and_b32 v66, 1, v116
  v_add_u32 v64, 6, v64
  v_lshrrev_b32 v67, 1, v116
  v_lshlrev_b32 v67, 8, v67
  v_lshl_add_u32 v67, v66, 9, v67
  v_lshl_add_u32 v67, v117, 4, v67
  v_add_u32 v112, 60416, v67
  v_and_b32 v68, 7, v117
  v_lshlrev_b32 v67, 8, v64
  v_lshl_add_u32 v67, v68, 5, v67
  v_lshl_add_u32 v67, v66, 4, v67
  v_add_u32 v113, 65536, v67
  v_lshrrev_b32 v64, 5, v1
  v_and_b32 v65, 31, v1
  v_lshrrev_b32 v66, 3, v65
  v_and_b32 v67, 7, v65
  v_and_b32 v68, 3, v67
  v_lshl_add_u32 v68, v66, 2, v68
  v_lshrrev_b32 v69, 2, v67
  v_lshl_add_u32 v68, v69, 4, v68
  v_lshlrev_b32 v69, 11, v64
  v_lshl_add_u32 v69, v68, 4, v69
  v_add_u32 v114, 57864, v69
  v_add_u32 v70, 6, v64
  v_lshlrev_b32 v69, 9, v66
  v_lshl_add_u32 v69, v70, 5, v69
  v_lshl_add_u32 v69, v67, 2, v69
  v_add_u32 v115, 65536, v69
  v_and_b32 v71, 1, v1
  v_cmp_eq_u32 s[38:39], 0, v71
  v_cmp_gt_u32 vcc, 8, v65
  s_or_b64 s[28:29], s[38:39], vcc
  v_lshrrev_b32 v72, 1, v67
  v_lshlrev_b32 v72, 2, v72
  v_lshl_add_u32 v72, v70, 4, v72
  s_lshl_b32 s22, s17, 9
  s_add_u32 s22, s22, 9216
  v_lshl_add_u32 v73, v66, 7, v72
  v_add_u32 v73, s22, v73
  s_lshl_b32 s22, s17, 7
  s_add_u32 s22, s22, 7168
  v_add_u32 v74, s22, v72
  v_bfe_u32 v72, v65, 1, 1
  v_lshlrev_b32 v72, 7, v72
  v_lshl_add_u32 v72, v70, 4, v72
  v_bfe_u32 v73, v65, 2, 2
  v_lshl_add_u32 v72, v73, 2, v72
  v_lshrrev_b32 v73, 4, v65
  v_lshl_add_u32 v73, v73, 8, v72
  s_lshl_b32 s22, s17, 9
  s_add_u32 s22, s22, 9216
  v_add_u32 v73, s22, v73
  s_lshr_b32 s22, s17, 1
  s_lshl_b32 s22, s22, 8
  s_and_b32 s34, s17, 1
  s_lshl_b32 s34, s34, 3
  s_add_u32 s22, s22, s34
  s_add_u32 s22, s22, 7168
  v_add_u32 v74, s22, v72
  v_lshlrev_b32 v0, 2, v65
  s_and_b32 s22, s17, 31
  s_lshl_b32 s22, s22, 7
  s_add_u32 s22, s22, 21504
  v_add_u32 v0, s22, v0
  v_cndmask_b32 v1, v74, v73, s[38:39]
  s_lshl_b32 s36, s17, 2
  s_add_u32 s36, s36, 17408
  s_mov_b32 s37, 0x3e800000
  v_mov_b32 v64, 0
  v_mov_b32 v65, 0
  v_mov_b32 v66, 0
  v_mov_b32 v67, 0
  v_mov_b32 v68, 0
  v_mov_b32 v69, 0
  v_mov_b32 v70, 0
  v_mov_b32 v71, 0
  v_mov_b32 v72, 0
  v_mov_b32 v73, 0
  v_mov_b32 v74, 0
  v_mov_b32 v75, 0
  v_mov_b32 v76, 0
  v_mov_b32 v77, 0
  v_mov_b32 v78, 0
  v_mov_b32 v79, 0
  v_mov_b32 v80, 0
  v_mov_b32 v81, 0
  v_mov_b32 v82, 0
  v_mov_b32 v83, 0
  v_mov_b32 v84, 0
  v_mov_b32 v85, 0
  v_mov_b32 v86, 0
  v_mov_b32 v87, 0
  v_mov_b32 v88, 0
  v_mov_b32 v89, 0
  v_mov_b32 v90, 0
  v_mov_b32 v91, 0
  v_mov_b32 v92, 0
  v_mov_b32 v93, 0
  v_mov_b32 v94, 0
  v_mov_b32 v95, 0
  v_mov_b32 v96, 0
  v_mov_b32 v97, 0
  v_mov_b32 v98, 0
  v_mov_b32 v99, 0
  v_mov_b32 v100, 0
  v_mov_b32 v101, 0
  v_mov_b32 v102, 0
  v_mov_b32 v103, 0
  v_mov_b32 v104, 0
  v_mov_b32 v105, 0
  v_mov_b32 v106, 0
  v_mov_b32 v107, 0
  v_mov_b32 v108, 0
  v_mov_b32 v109, 0
  v_mov_b32 v110, 0
  v_mov_b32 v111, 0
  v_and_b32 v118, 1, v116
  v_cmp_eq_u32 vcc, 0, v118
  v_mov_b32 v118, 12544
  v_mov_b32 v119, 10496
  v_cndmask_b32 v118, v118, v119, vcc
  v_lshrrev_b32 v116, 1, v116
  v_lshl_add_u32 v118, v116, 9, v118
  v_lshl_add_u32 v117, v117, 4, v118
  s_mov_b32 s57, 28672
  s_mov_b32 s56, 0x42800000
  v_mov_b32 v116, v2
  s_mul_i32 s35, s17, 1835008
  s_add_u32 s35, s35, 42284032
  s_mov_b32 s30, 0
  v_mov_b32 v36, 0
ch_md3:
  buffer_load_dword v37, v36, s[12:15], 0 offen sc1
  s_waitcnt vmcnt(0)
  v_readfirstlane_b32 s22, v37
  s_and_b32 s31, s22, 0xffff
  s_cmp_ge_u32 s31, 32
  s_cbranch_scc1 ch_go3
  s_sleep 2
  s_add_u32 s30, s30, 1
  s_cmp_lt_u32 s30, 50000
  s_cbranch_scc1 ch_md3
  s_branch ch_end
ch_go3:
  s_mov_b32 s31, 0
  s_lshr_b32 s22, s22, 16
  s_cmp_lg_u32 s22, 0
  s_cbranch_scc1 cB_sc3_loop
  s_branch cA_sc3_loop
ch_init4:
  s_mul_i32 s31, s17, 401408
  s_add_u32 s31, s31, 6422528
  s_mul_i32 s22, s17, 28
  s_add_u32 s23, s22, 27
  s_lshr_b32 s22, s22, 6
  s_lshr_b32 s23, s23, 6
  s_sub_u32 s23, s23, s22
  s_lshl_b32 s23, s23, 8
  v_and_b32 v36, s23, v2
  v_med3_u32 v37, v117, 0, 3
  v_lshl_add_u32 v36, v37, 4, v36
  s_lshl_b32 s22, s22, 8
  s_add_u32 s22, s22, 88588288
  s_mov_b32 s30, 0
va_bw_11:
  buffer_load_dwordx4 v[40:43], v36, s[8:11], s22 offen sc1
  s_waitcnt vmcnt(0)
  v_cmp_ne_u64 vcc, s[88:89], v[40:41]
  s_cbranch_vccnz va_bw_11_no
  v_cmp_ne_u64 vcc, s[88:89], v[42:43]
  s_cbranch_vccnz va_bw_11_no
  s_branch va_bw_11_ok
va_bw_11_no:
  s_sleep 2
  s_add_u32 s30, s30, 1
  s_cmp_lt_u32 s30, 50000
  s_cbranch_scc1 va_bw_11
  s_branch cA_abort
va_bw_11_ok:
  s_add_u32 s22, s31, 0
  buffer_load_dwordx4 a[0:3], v2, s[8:11], s22 offen offset:0 sc1
  buffer_load_dwordx4 a[4:7], v2, s[8:11], s22 offen offset:1024 sc1
  buffer_load_dwordx4 a[8:11], v2, s[8:11], s22 offen offset:2048 sc1
  buffer_load_dwordx4 a[12:15], v2, s[8:11], s22 offen offset:3072 sc1
  s_add_u32 s22, s31, 4096
  buffer_load_dwordx4 a[16:19], v2, s[8:11], s22 offen offset:0 sc1
  buffer_load_dwordx4 a[20:23], v2, s[8:11], s22 offen offset:1024 sc1
  buffer_load_dwordx4 a[24:27], v2, s[8:11], s22 offen offset:2048 sc1
  buffer_load_dwordx4 a[28:31], v2, s[8:11], s22 offen offset:3072 sc1
  s_add_u32 s22, s31, 8192
  buffer_load_dwordx4 a[32:35], v2, s[8:11], s22 offen offset:0 sc1
  buffer_load_dwordx4 a[36:39], v2, s[8:11], s22 offen offset:1024 sc1
  buffer_load_dwordx4 a[40:43], v2, s[8:11], s22 offen offset:2048 sc1
  buffer_load_dwordx4 a[44:47], v2, s[8:11], s22 offen offset:3072 sc1
  s_add_u32 s22, s31, 12288
  buffer_load_dwordx4 a[48:51], v2, s[8:11], s22 offen offset:0 sc1
  buffer_load_dwordx4 a[52:55], v2, s[8:11], s22 offen offset:1024 sc1
  buffer_load_dwordx4 a[56:59], v2, s[8:11], s22 offen offset:2048 sc1
  buffer_load_dwordx4 a[60:63], v2, s[8:11], s22 offen offset:3072 sc1
  s_add_u32 s22, s31, 16384
  buffer_load_dwordx4 a[64:67], v2, s[8:11], s22 offen offset:0 sc1
  buffer_load_dwordx4 a[68:71], v2, s[8:11], s22 offen offset:1024 sc1
  buffer_load_dwordx4 a[72:75], v2, s[8:11], s22 offen offset:2048 sc1
  buffer_load_dwordx4 a[76:79], v2, s[8:11], s22 offen offset:3072 sc1
  s_add_u32 s22, s31, 20480
  buffer_load_dwordx4 a[80:83], v2, s[8:11], s22 offen offset:0 sc1
  buffer_load_dwordx4 a[84:87], v2, s[8:11], s22 offen offset:1024 sc1
  buffer_load_dwordx4 a[88:91], v2, s[8:11], s22 offen offset:2048 sc1
  buffer_load_dwordx4 a[92:95], v2, s[8:11], s22 offen offset:3072 sc1
  s_add_u32 s22, s31, 24576
  buffer_load_dwordx4 a[96:99], v2, s[8:11], s22 offen offset:0 sc1
  buffer_load_dwordx4 a[100:103], v2, s[8:11], s22 offen offset:1024 sc1
  buffer_load_dwordx4 a[104:107], v2, s[8:11], s22 offen offset:2048 sc1
  buffer_load_dwordx4 a[108:111], v2, s[8:11], s22 offen offset:3072 sc1
  s_add_u32 s22, s31, 28672
  buffer_load_dwordx4 a[112:115], v2, s[8:11], s22 offen offset:0 sc1
  buffer_load_dwordx4 a[116:119], v2, s[8:11], s22 offen offset:1024 sc1
  buffer_load_dwordx4 a[120:123], v2, s[8:11], s22 offen offset:2048 sc1
  buffer_load_dwordx4 a[124:127], v2, s[8:11], s22 offen offset:3072 sc1
  s_waitcnt vmcnt(24)
  s_add_u32 s22, s31, 32768
  buffer_load_dwordx4 a[128:131], v2, s[8:11], s22 offen offset:0 sc1
  buffer_load_dwordx4 a[132:135], v2, s[8:11], s22 offen offset:1024 sc1
  buffer_load_dwordx4 a[136:139], v2, s[8:11], s22 offen offset:2048 sc1
  buffer_load_dwordx4 a[140:143], v2, s[8:11], s22 offen offset:3072 sc1
  s_add_u32 s22, s31, 36864
  buffer_load_dwordx4 a[144:147], v2, s[8:11], s22 offen offset:0 sc1
  buffer_load_dwordx4 a[148:151], v2, s[8:11], s22 offen offset:1024 sc1
  buffer_load_dwordx4 a[152:155], v2, s[8:11], s22 offen offset:2048 sc1
  buffer_load_dwordx4 a[156:159], v2, s[8:11], s22 offen offset:3072 sc1
  s_add_u32 s22, s31, 40960
  buffer_load_dwordx4 a[160:163], v2, s[8:11], s22 offen offset:0 sc1
  buffer_load_dwordx4 a[164:167], v2, s[8:11], s22 offen offset:1024 sc1
  buffer_load_dwordx4 a[168:171], v2, s[8:11], s22 offen offset:2048 sc1
  buffer_load_dwordx4 a[172:175], v2, s[8:11], s22 offen offset:3072 sc1
  s_add_u32 s22, s31, 45056
  buffer_load_dwordx4 a[176:179], v2, s[8:11], s22 offen offset:0 sc1
  buffer_load_dwordx4 a[180:183], v2, s[8:11], s22 offen offset:1024 sc1
  buffer_load_dwordx4 a[184:187], v2, s[8:11], s22 offen offset:2048 sc1
  buffer_load_dwordx4 a[188:191], v2, s[8:11], s22 offen offset:3072 sc1
  s_add_u32 s22, s31, 49152
  buffer_load_dwordx4 a[192:195], v2, s[8:11], s22 offen offset:0 sc1
  buffer_load_dwordx4 a[196:199], v2, s[8:11], s22 offen offset:1024 sc1
  buffer_load_dwordx4 a[200:203], v2, s[8:11], s22 offen offset:2048 sc1
  buffer_load_dwordx4 a[204:207], v2, s[8:11], s22 offen offset:3072 sc1
  s_add_u32 s22, s31, 53248
  buffer_load_dwordx4 a[208:211], v2, s[8:11], s22 offen offset:0 sc1
  buffer_load_dwordx4 a[212:215], v2, s[8:11], s22 offen offset:1024 sc1
  buffer_load_dwordx4 a[216:219], v2, s[8:11], s22 offen offset:2048 sc1
  buffer_load_dwordx4 a[220:223], v2, s[8:11], s22 offen offset:3072 sc1
  s_add_u32 s22, s31, 57344
  buffer_load_dwordx4 a[224:227], v2, s[8:11], s22 offen offset:0 sc1
  buffer_load_dwordx4 a[228:231], v2, s[8:11], s22 offen offset:1024 sc1
  buffer_load_dwordx4 a[232:235], v2, s[8:11], s22 offen offset:2048 sc1
  buffer_load_dwordx4 a[236:239], v2, s[8:11], s22 offen offset:3072 sc1
  s_add_u32 s22, s31, 61440
  buffer_load_dwordx4 a[240:243], v2, s[8:11], s22 offen offset:0 sc1
  buffer_load_dwordx4 a[244:247], v2, s[8:11], s22 offen offset:1024 sc1
  buffer_load_dwordx4 a[248:251], v2, s[8:11], s22 offen offset:2048 sc1
  buffer_load_dwordx4 a[252:255], v2, s[8:11], s22 offen offset:3072 sc1
  s_waitcnt vmcnt(24)
  s_add_u32 s22, s31, 65536
  buffer_load_dwordx4 v[176:179], v2, s[8:11], s22 offen offset:0 sc1
  buffer_load_dwordx4 v[180:183], v2, s[8:11], s22 offen offset:1024 sc1
  buffer_load_dwordx4 v[184:187], v2, s[8:11], s22 offen offset:2048 sc1
  buffer_load_dwordx4 v[188:191], v2, s[8:11], s22 offen offset:3072 sc1
  s_add_u32 s22, s31, 69632
  buffer_load_dwordx4 v[192:195], v2, s[8:11], s22 offen offset:0 sc1
  buffer_load_dwordx4 v[196:199], v2, s[8:11], s22 offen offset:1024 sc1
  buffer_load_dwordx4 v[200:203], v2, s[8:11], s22 offen offset:2048 sc1
  buffer_load_dwordx4 v[204:207], v2, s[8:11], s22 offen offset:3072 sc1
  s_add_u32 s22, s31, 73728
  buffer_load_dwordx4 v[208:211], v2, s[8:11], s22 offen offset:0 sc1
  buffer_load_dwordx4 v[212:215], v2, s[8:11], s22 offen offset:1024 sc1
  buffer_load_dwordx4 v[216:219], v2, s[8:11], s22 offen offset:2048 sc1
  buffer_load_dwordx4 v[220:223], v2, s[8:11], s22 offen offset:3072 sc1
  s_add_u32 s22, s31, 77824
  buffer_load_dwordx4 v[224:227], v2, s[8:11], s22 offen offset:0 sc1
  buffer_load_dwordx4 v[228:231], v2, s[8:11], s22 offen offset:1024 sc1
  buffer_load_dwordx4 v[232:235], v2, s[8:11], s22 offen offset:2048 sc1
  buffer_load_dwordx4 v[236:239], v2, s[8:11], s22 offen offset:3072 sc1
  s_add_u32 s22, s31, 81920
  buffer_load_dwordx4 v[240:243], v2, s[8:11], s22 offen offset:0 sc1
  buffer_load_dwordx4 v[244:247], v2, s[8:11], s22 offen offset:1024 sc1
  buffer_load_dwordx4 v[248:251], v2, s[8:11], s22 offen offset:2048 sc1
  buffer_load_dwordx4 v[252:255], v2, s[8:11], s22 offen offset:3072 sc1
  s_mul_i32 s22, s17, 28
  s_add_u32 s23, s22, 27
  s_lshr_b32 s22, s22, 6
  s_lshr_b32 s23, s23, 6
  s_sub_u32 s23, s23, s22
  s_lshl_b32 s23, s23, 8
  v_and_b32 v36, s23, v2
  v_med3_u32 v37, v117, 10, 11
  v_lshl_add_u32 v36, v37, 4, v36
  s_lshl_b32 s22, s22, 8
  s_add_u32 s22, s22, 88588288
  s_mov_b32 s30, 0
va_bw_12:
  buffer_load_dwordx4 v[40:43], v36, s[8:11], s22 offen sc1
  s_waitcnt vmcnt(0)
  v_cmp_ne_u64 vcc, s[88:89], v[40:41]
  s_cbranch_vccnz va_bw_12_no
  v_cmp_ne_u64 vcc, s[88:89], v[42:43]
  s_cbranch_vccnz va_bw_12_no
  s_branch va_bw_12_ok
va_bw_12_no:
  s_sleep 2
  s_add_u32 s30, s30, 1
  s_cmp_lt_u32 s30, 50000
  s_cbranch_scc1 va_bw_12
  s_branch cA_abort
va_bw_12_ok:
  s_mov_b32 m0, 16384
  s_add_u32 s22, s31, 272384
  buffer_load_dwordx4 v2, s[8:11], s22 offen offset:0 sc1 lds
  buffer_load_dwordx4 v2, s[8:11], s22 offen offset:1024 sc1 lds
  buffer_load_dwordx4 v2, s[8:11], s22 offen offset:2048 sc1 lds
  buffer_load_dwordx4 v2, s[8:11], s22 offen offset:3072 sc1 lds
  s_mov_b32 m0, 20480
  s_add_u32 s22, s31, 276480
  buffer_load_dwordx4 v2, s[8:11], s22 offen offset:0 sc1 lds
  buffer_load_dwordx4 v2, s[8:11], s22 offen offset:1024 sc1 lds
  buffer_load_dwordx4 v2, s[8:11], s22 offen offset:2048 sc1 lds
  buffer_load_dwordx4 v2, s[8:11], s22 offen offset:3072 sc1 lds
  s_mov_b32 m0, 24576
  s_add_u32 s22, s31, 280576
  buffer_load_dwordx4 v2, s[8:11], s22 offen offset:0 sc1 lds
  buffer_load_dwordx4 v2, s[8:11], s22 offen offset:1024 sc1 lds
  buffer_load_dwordx4 v2, s[8:11], s22 offen offset:2048 sc1 lds
  buffer_load_dwordx4 v2, s[8:11], s22 offen offset:3072 sc1 lds
  s_mov_b32 m0, 28672
  s_add_u32 s22, s31, 284672
  buffer_load_dwordx4 v2, s[8:11], s22 offen offset:0 sc1 lds
  buffer_load_dwordx4 v2, s[8:11], s22 offen offset:1024 sc1 lds
  v_mov_b32 v72, v116
  v_mov_b32 v73, v117
  v_lshrrev_b32 v65, 1, v72
  v_and_b32 v66, 1, v72
  v_add_u32 v67, 0, v65
  v_lshl_add_u32 v67, v67, 4, v73
  v_mul_u32_u24 v68, 2341, v67
  v_lshrrev_b32 v68, 16, v68
  v_mul_u32_u24 v69, 28, v68
  v_sub_u32 v69, v67, v69
  v_lshrrev_b32 v70, 4, v69
  v_and_b32 v69, 15, v69
  v_and_b32 v71, 1, v69
  v_lshrrev_b32 v69, 1, v69
  v_lshl_add_u32 v69, v71, 3, v69
  v_lshlrev_b32 v71, 12, v70
  v_lshl_add_u32 v71, v68, 8, v71
  v_lshl_add_u32 v71, v69, 4, v71
  v_lshl_add_u32 v60, v66, 3, v71
  v_add_u32 v67, 2, v65
  v_lshl_add_u32 v67, v67, 4, v73
  v_mul_u32_u24 v68, 2341, v67
  v_lshrrev_b32 v68, 16, v68
  v_mul_u32_u24 v69, 28, v68
  v_sub_u32 v69, v67, v69
  v_lshrrev_b32 v70, 4, v69
  v_and_b32 v69, 15, v69
  v_and_b32 v71, 1, v69
  v_lshrrev_b32 v69, 1, v69
  v_lshl_add_u32 v69, v71, 3, v69
  v_lshlrev_b32 v71, 12, v70
  v_lshl_add_u32 v71, v68, 8, v71
  v_lshl_add_u32 v71, v69, 4, v71
  v_lshl_add_u32 v61, v66, 3, v71
  v_add_u32 v67, 4, v65
  v_lshl_add_u32 v67, v67, 4, v73
  v_mul_u32_u24 v68, 2341, v67
  v_lshrrev_b32 v68, 16, v68
  v_mul_u32_u24 v69, 28, v68
  v_sub_u32 v69, v67, v69
  v_lshrrev_b32 v70, 4, v69
  v_and_b32 v69, 15, v69
  v_and_b32 v71, 1, v69
  v_lshrrev_b32 v69, 1, v69
  v_lshl_add_u32 v69, v71, 3, v69
  v_lshlrev_b32 v71, 12, v70
  v_lshl_add_u32 v71, v68, 8, v71
  v_lshl_add_u32 v71, v69, 4, v71
  v_lshl_add_u32 v62, v66, 3, v71
  v_and_b32 v0, 31, v1
  v_lshlrev_b32 v0, 2, v0
  v_add_u32 v0, 21504, v0
  v_lshlrev_b32 v4, 2, v73
  s_and_b32 s22, s17, 15
  s_lshl_b32 s22, s22, 7
  s_add_u32 s22, s22, 17408
  v_add_u32 v4, s22, v4
  v_and_b32 v64, 7, v73
  v_lshlrev_b32 v5, 4, v64
  v_lshl_add_u32 v5, v72, 7, v5
  v_lshrrev_b32 v65, 3, v73
  v_lshl_add_u32 v5, v65, 9, v5
  s_lshl_b32 s22, s17, 3
  s_add_u32 s22, s22, 21504
  v_lshl_add_u32 v7, v2, 3, s22
  v_add_u32 v65, 0, v73
  v_min_u32 v65, 27, v65
  v_mad_u32_u24 v65, v72, 28, v65
  v_lshlrev_b32 v6, 4, v65
  s_lshr_b32 s22, s17, 1
  s_mul_i32 s22, s22, 7
  s_and_b32 s34, s17, 1
  s_lshl_b32 s35, s34, 2
  v_add_u32 v70, s35, v72
  v_mov_b32 v71, s34
  v_mov_b32 v69, 0
  v_cmp_eq_u32 vcc, 3, v72
  s_nop 1
  v_cndmask_b32 v70, v70, v72, vcc
  v_cndmask_b32 v69, v69, v71, vcc
  v_add_u32 v70, s22, v70
  v_lshrrev_b32 v68, 1, v70
  v_lshlrev_b32 v68, 8, v68
  v_lshl_add_u32 v68, v69, 7, v68
  v_and_b32 v69, 1, v70
  v_lshl_add_u32 v68, v69, 3, v68
  v_lshl_add_u32 v1, v64, 4, v68
  v_cmp_gt_u32 s[26:27], 8, v73
  v_lshrrev_b32 v65, 3, v73
  v_lshl_add_u32 v66, v64, 1, v65
  v_add_u32 v66, 0, v66
  v_min_u32 v66, 27, v66
  v_mad_u32_u24 v66, v72, 28, v66
  v_lshlrev_b32 v6, 4, v66
  s_mul_i32 s22, s17, 28
  s_add_u32 s22, s22, 0
  v_lshl_add_u32 v70, v64, 1, s22
  v_lshrrev_b32 v68, 4, v70
  v_lshlrev_b32 v68, 8, v68
  v_bfe_u32 v69, v70, 1, 1
  v_lshl_add_u32 v68, v69, 7, v68
  v_bfe_u32 v69, v70, 2, 2
  v_lshl_add_u32 v68, v69, 2, v68
  v_and_b32 v69, 1, v72
  v_lshl_add_u32 v65, v69, 2, v65
  v_lshrrev_b32 v69, 1, v72
  v_lshl_add_u32 v65, v69, 1, v65
  v_lshl_add_u32 v1, v65, 4, v68
  v_cmp_gt_u32 s[26:27], 6, v64
  v_mov_b32 v156, 0
  v_mov_b32 v157, 0
  v_mov_b32 v158, 0
  v_mov_b32 v159, 0
  ds_write_b128 v2, v[156:159] offset:0
  ds_write_b128 v2, v[156:159] offset:1024
  ds_write_b128 v2, v[156:159] offset:2048
  ds_write_b128 v2, v[156:159] offset:3072
  s_mul_i32 s22, s17, 1835008
  s_add_u32 s25, s22, 42205184
  s_lshl_b32 s35, s17, 7
  s_add_u32 s35, s35, 88526848
  s_mov_b32 s38, 0
  v_mov_b32 v175, 0
  s_lshl_b32 s22, 0, 11
  s_add_u32 s22, s22, 88590336
  v_add_u32 v36, 1024, v2
  v_min_u32 v36, 1776, v36
  s_mov_b32 s30, 0
va_iw4:
  buffer_load_dwordx4 v[40:43], v2, s[8:11], s22 offen sc1
  buffer_load_dwordx4 v[44:47], v36, s[8:11], s22 offen sc1
  s_waitcnt vmcnt(0)
  v_cmp_ne_u64 vcc, s[88:89], v[40:41]
  s_cbranch_vccnz va_iw4_no
  v_cmp_ne_u64 vcc, s[88:89], v[42:43]
  s_cbranch_vccnz va_iw4_no
  v_cmp_ne_u64 vcc, s[88:89], v[44:45]
  s_cbranch_vccnz va_iw4_no
  v_cmp_ne_u64 vcc, s[88:89], v[46:47]
  s_cbranch_vccnz va_iw4_no
  s_branch va_iw4_ok
va_iw4_no:
  s_sleep 2
  s_add_u32 s30, s30, 1
  s_cmp_lt_u32 s30, 50000
  s_cbranch_scc1 va_iw4
  s_branch cA_abort
va_iw4_ok:
  s_mov_b32 s30, 0
  v_mov_b32 v36, 0
ch_md4:
  buffer_load_dword v37, v36, s[12:15], 0 offen sc1
  s_waitcnt vmcnt(0)
  v_readfirstlane_b32 s22, v37
  s_and_b32 s31, s22, 0xffff
  s_cmp_ge_u32 s31, 32
  s_cbranch_scc1 ch_go4
  s_sleep 2
  s_add_u32 s30, s30, 1
  s_cmp_lt_u32 s30, 50000
  s_cbranch_scc1 ch_md4
  s_branch ch_end
ch_go4:
  s_mov_b32 s31, 0
  v_mov_b32 v36, 0
  v_mov_b32 v37, 0
  v_mov_b32 v38, 0
  v_mov_b32 v39, 0
  v_mov_b32 v40, 0
  v_mov_b32 v41, 0
  v_mov_b32 v42, 0
  v_mov_b32 v43, 0
  v_mov_b32 v44, 0
  v_mov_b32 v45, 0
  v_mov_b32 v46, 0
  v_mov_b32 v47, 0
  v_mov_b32 v48, 0
  v_mov_b32 v49, 0
  v_mov_b32 v50, 0
  v_mov_b32 v51, 0
  v_mov_b32 v52, 0
  v_mov_b32 v53, 0
  v_mov_b32 v54, 0
  v_mov_b32 v55, 0
  v_mov_b32 v56, 0
  v_mov_b32 v57, 0
  v_mov_b32 v58, 0
  v_mov_b32 v59, 0
  s_lshr_b32 s22, s22, 16
  s_cmp_lg_u32 s22, 0
  s_cbranch_scc1 cB_va0_loop
  s_branch cA_va0_loop
ch_init5:
  s_mul_i32 s31, s17, 401408
  s_add_u32 s31, s31, 6422528
  s_mul_i32 s22, s17, 28
  s_add_u32 s23, s22, 27
  s_lshr_b32 s22, s22, 6
  s_lshr_b32 s23, s23, 6
  s_sub_u32 s23, s23, s22
  s_lshl_b32 s23, s23, 8
  v_and_b32 v36, s23, v2
  v_med3_u32 v37, v117, 3, 6
  v_lshl_add_u32 v36, v37, 4, v36
  s_lshl_b32 s22, s22, 8
  s_add_u32 s22, s22, 88588288
  s_mov_b32 s30, 0
va_bw_13:
  buffer_load_dwordx4 v[40:43], v36, s[8:11], s22 offen sc1
  s_waitcnt vmcnt(0)
  v_cmp_ne_u64 vcc, s[88:89], v[40:41]
  s_cbranch_vccnz va_bw_13_no
  v_cmp_ne_u64 vcc, s[88:89], v[42:43]
  s_cbranch_vccnz va_bw_13_no
  s_branch va_bw_13_ok
va_bw_13_no:
  s_sleep 2
  s_add_u32 s30, s30, 1
  s_cmp_lt_u32 s30, 50000
  s_cbranch_scc1 va_bw_13
  s_branch cA_abort
va_bw_13_ok:
  s_add_u32 s22, s31, 86016
  buffer_load_dwordx4 a[0:3], v2, s[8:11], s22 offen offset:0 sc1
  buffer_load_dwordx4 a[4:7], v2, s[8:11], s22 offen offset:1024 sc1
  buffer_load_dwordx4 a[8:11], v2, s[8:11], s22 offen offset:2048 sc1
  buffer_load_dwordx4 a[12:15], v2, s[8:11], s22 offen offset:3072 sc1
  s_add_u32 s22, s31, 90112
  buffer_load_dwordx4 a[16:19], v2, s[8:11], s22 offen offset:0 sc1
  buffer_load_dwordx4 a[20:23], v2, s[8:11], s22 offen offset:1024 sc1
  buffer_load_dwordx4 a[24:27], v2, s[8:11], s22 offen offset:2048 sc1
  buffer_load_dwordx4 a[28:31], v2, s[8:11], s22 offen offset:3072 sc1
  s_add_u32 s22, s31, 94208
  buffer_load_dwordx4 a[32:35], v2, s[8:11], s22 offen offset:0 sc1
  buffer_load_dwordx4 a[36:39], v2, s[8:11], s22 offen offset:1024 sc1
  buffer_load_dwordx4 a[40:43], v2, s[8:11], s22 offen offset:2048 sc1
  buffer_load_dwordx4 a[44:47], v2, s[8:11], s22 offen offset:3072 sc1
  s_add_u32 s22, s31, 98304
  buffer_load_dwordx4 a[48:51], v2, s[8:11], s22 offen offset:0 sc1
  buffer_load_dwordx4 a[52:55], v2, s[8:11], s22 offen offset:1024 sc1
  buffer_load_dwordx4 a[56:59], v2, s[8:11], s22 offen offset:2048 sc1
  buffer_load_dwordx4 a[60:63], v2, s[8:11], s22 offen offset:3072 sc1
  s_add_u32 s22, s31, 102400
  buffer_load_dwordx4 a[64:67], v2, s[8:11], s22 offen offset:0 sc1
  buffer_load_dwordx4 a[68:71], v2, s[8:11], s22 offen offset:1024 sc1
  buffer_load_dwordx4 a[72:75], v2, s[8:11], s22 offen offset:2048 sc1
  buffer_load_dwordx4 a[76:79], v2, s[8:11], s22 offen offset:3072 sc1
  s_add_u32 s22, s31, 106496
  buffer_load_dwordx4 a[80:83], v2, s[8:11], s22 offen offset:0 sc1
  buffer_load_dwordx4 a[84:87], v2, s[8:11], s22 offen offset:1024 sc1
  buffer_load_dwordx4 a[88:91], v2, s[8:11], s22 offen offset:2048 sc1
  buffer_load_dwordx4 a[92:95], v2, s[8:11], s22 offen offset:3072 sc1
  s_add_u32 s22, s31, 110592
  buffer_load_dwordx4 a[96:99], v2, s[8:11], s22 offen offset:0 sc1
  buffer_load_dwordx4 a[100:103], v2, s[8:11], s22 offen offset:1024 sc1
  buffer_load_dwordx4 a[104:107], v2, s[8:11], s22 offen offset:2048 sc1
  buffer_load_dwordx4 a[108:111], v2, s[8:11], s22 offen offset:3072 sc1
  s_add_u32 s22, s31, 114688
  buffer_load_dwordx4 a[112:115], v2, s[8:11], s22 offen offset:0 sc1
  buffer_load_dwordx4 a[116:119], v2, s[8:11], s22 offen offset:1024 sc1
  buffer_load_dwordx4 a[120:123], v2, s[8:11], s22 offen offset:2048 sc1
  buffer_load_dwordx4 a[124:127], v2, s[8:11], s22 offen offset:3072 sc1
  s_waitcnt vmcnt(24)
  s_add_u32 s22, s31, 118784
  buffer_load_dwordx4 a[128:131], v2, s[8:11], s22 offen offset:0 sc1
  buffer_load_dwordx4 a[132:135], v2, s[8:11], s22 offen offset:1024 sc1
  buffer_load_dwordx4 a[136:139], v2, s[8:11], s22 offen offset:2048 sc1
  buffer_load_dwordx4 a[140:143], v2, s[8:11], s22 offen offset:3072 sc1
  s_add_u32 s22, s31, 122880
  buffer_load_dwordx4 a[144:147], v2, s[8:11], s22 offen offset:0 sc1
  buffer_load_dwordx4 a[148:151], v2, s[8:11], s22 offen offset:1024 sc1
  buffer_load_dwordx4 a[152:155], v2, s[8:11], s22 offen offset:2048 sc1
  buffer_load_dwordx4 a[156:159], v2, s[8:11], s22 offen offset:3072 sc1
  s_add_u32 s22, s31, 126976
  buffer_load_dwordx4 a[160:163], v2, s[8:11], s22 offen offset:0 sc1
  buffer_load_dwordx4 a[164:167], v2, s[8:11], s22 offen offset:1024 sc1
  buffer_load_dwordx4 a[168:171], v2, s[8:11], s22 offen offset:2048 sc1
  buffer_load_dwordx4 a[172:175], v2, s[8:11], s22 offen offset:3072 sc1
  s_add_u32 s22, s31, 131072
  buffer_load_dwordx4 a[176:179], v2, s[8:11], s22 offen offset:0 sc1
  buffer_load_dwordx4 a[180:183], v2, s[8:11], s22 offen offset:1024 sc1
  buffer_load_dwordx4 a[184:187], v2, s[8:11], s22 offen offset:2048 sc1
  buffer_load_dwordx4 a[188:191], v2, s[8:11], s22 offen offset:3072 sc1
  s_add_u32 s22, s31, 135168
  buffer_load_dwordx4 a[192:195], v2, s[8:11], s22 offen offset:0 sc1
  buffer_load_dwordx4 a[196:199], v2, s[8:11], s22 offen offset:1024 sc1
  buffer_load_dwordx4 a[200:203], v2, s[8:11], s22 offen offset:2048 sc1
  buffer_load_dwordx4 a[204:207], v2, s[8:11], s22 offen offset:3072 sc1
  s_add_u32 s22, s31, 139264
  buffer_load_dwordx4 a[208:211], v2, s[8:11], s22 offen offset:0 sc1
  buffer_load_dwordx4 a[212:215], v2, s[8:11], s22 offen offset:1024 sc1
  buffer_load_dwordx4 a[216:219], v2, s[8:11], s22 offen offset:2048 sc1
  buffer_load_dwordx4 a[220:223], v2, s[8:11], s22 offen offset:3072 sc1
  s_add_u32 s22, s31, 143360
  buffer_load_dwordx4 a[224:227], v2, s[8:11], s22 offen offset:0 sc1
  buffer_load_dwordx4 a[228:231], v2, s[8:11], s22 offen offset:1024 sc1
  buffer_load_dwordx4 a[232:235], v2, s[8:11], s22 offen offset:2048 sc1
  buffer_load_dwordx4 a[236:239], v2, s[8:11], s22 offen offset:3072 sc1
  s_add_u32 s22, s31, 147456
  buffer_load_dwordx4 a[240:243], v2, s[8:11], s22 offen offset:0 sc1
  buffer_load_dwordx4 a[244:247], v2, s[8:11], s22 offen offset:1024 sc1
  buffer_load_dwordx4 a[248:251], v2, s[8:11], s22 offen offset:2048 sc1
  buffer_load_dwordx4 a[252:255], v2, s[8:11], s22 offen offset:3072 sc1
  s_waitcnt vmcnt(24)
  s_add_u32 s22, s31, 151552
  buffer_load_dwordx4 v[176:179], v2, s[8:11], s22 offen offset:0 sc1
  buffer_load_dwordx4 v[180:183], v2, s[8:11], s22 offen offset:1024 sc1
  buffer_load_dwordx4 v[184:187], v2, s[8:11], s22 offen offset:2048 sc1
  buffer_load_dwordx4 v[188:191], v2, s[8:11], s22 offen offset:3072 sc1
  s_add_u32 s22, s31, 155648
  buffer_load_dwordx4 v[192:195], v2, s[8:11], s22 offen offset:0 sc1
  buffer_load_dwordx4 v[196:199], v2, s[8:11], s22 offen offset:1024 sc1
  buffer_load_dwordx4 v[200:203], v2, s[8:11], s22 offen offset:2048 sc1
  buffer_load_dwordx4 v[204:207], v2, s[8:11], s22 offen offset:3072 sc1
  s_add_u32 s22, s31, 159744
  buffer_load_dwordx4 v[208:211], v2, s[8:11], s22 offen offset:0 sc1
  buffer_load_dwordx4 v[212:215], v2, s[8:11], s22 offen offset:1024 sc1
  buffer_load_dwordx4 v[216:219], v2, s[8:11], s22 offen offset:2048 sc1
  buffer_load_dwordx4 v[220:223], v2, s[8:11], s22 offen offset:3072 sc1
  s_add_u32 s22, s31, 163840
  buffer_load_dwordx4 v[224:227], v2, s[8:11], s22 offen offset:0 sc1
  buffer_load_dwordx4 v[228:231], v2, s[8:11], s22 offen offset:1024 sc1
  buffer_load_dwordx4 v[232:235], v2, s[8:11], s22 offen offset:2048 sc1
  buffer_load_dwordx4 v[236:239], v2, s[8:11], s22 offen offset:3072 sc1
  s_add_u32 s22, s31, 167936
  buffer_load_dwordx4 v[240:243], v2, s[8:11], s22 offen offset:0 sc1
  buffer_load_dwordx4 v[244:247], v2, s[8:11], s22 offen offset:1024 sc1
  buffer_load_dwordx4 v[248:251], v2, s[8:11], s22 offen offset:2048 sc1
  buffer_load_dwordx4 v[252:255], v2, s[8:11], s22 offen offset:3072 sc1
  s_mul_i32 s22, s17, 28
  s_add_u32 s23, s22, 27
  s_lshr_b32 s22, s22, 6
  s_lshr_b32 s23, s23, 6
  s_sub_u32 s23, s23, s22
  s_lshl_b32 s23, s23, 8
  v_and_b32 v36, s23, v2
  v_med3_u32 v37, v117, 15, 15
  v_lshl_add_u32 v36, v37, 4, v36
  s_lshl_b32 s22, s22, 8
  s_add_u32 s22, s22, 88588288
  s_mov_b32 s30, 0
va_bw_14:
  buffer_load_dwordx4 v[40:43], v36, s[8:11], s22 offen sc1
  s_waitcnt vmcnt(0)
  v_cmp_ne_u64 vcc, s[88:89], v[40:41]
  s_cbranch_vccnz va_bw_14_no
  v_cmp_ne_u64 vcc, s[88:89], v[42:43]
  s_cbranch_vccnz va_bw_14_no
  s_branch va_bw_14_ok
va_bw_14_no:
  s_sleep 2
  s_add_u32 s30, s30, 1
  s_cmp_lt_u32 s30, 50000
  s_cbranch_scc1 va_bw_14
  s_branch cA_abort
va_bw_14_ok:
  s_mov_b32 m0, 59392
  s_add_u32 s22, s31, 387072
  buffer_load_dwordx4 v2, s[8:11], s22 offen offset:0 sc1 lds
  buffer_load_dwordx4 v2, s[8:11], s22 offen offset:1024 sc1 lds
  buffer_load_dwordx4 v2, s[8:11], s22 offen offset:2048 sc1 lds
  buffer_load_dwordx4 v2, s[8:11], s22 offen offset:3072 sc1 lds
  s_mov_b32 m0, 63488
  s_add_u32 s22, s31, 391168
  buffer_load_dwordx4 v2, s[8:11], s22 offen offset:0 sc1 lds
  buffer_load_dwordx4 v2, s[8:11], s22 offen offset:1024 sc1 lds
  buffer_load_dwordx4 v2, s[8:11], s22 offen offset:2048 sc1 lds
  buffer_load_dwordx4 v2, s[8:11], s22 offen offset:3072 sc1 lds
  s_mov_b32 m0, 67584
  s_add_u32 s22, s31, 395264
  buffer_load_dwordx4 v2, s[8:11], s22 offen offset:0 sc1 lds
  buffer_load_dwordx4 v2, s[8:11], s22 offen offset:1024 sc1 lds
  buffer_load_dwordx4 v2, s[8:11], s22 offen offset:2048 sc1 lds
  buffer_load_dwordx4 v2, s[8:11], s22 offen offset:3072 sc1 lds
  s_mov_b32 m0, 71680
  s_add_u32 s22, s31, 399360
  buffer_load_dwordx4 v2, s[8:11], s22 offen offset:0 sc1 lds
  buffer_load_dwordx4 v2, s[8:11], s22 offen offset:1024 sc1 lds
  v_mov_b32 v72, v116
  v_mov_b32 v73, v117
  v_lshrrev_b32 v65, 1, v72
  v_and_b32 v66, 1, v72
  v_add_u32 v67, 6, v65
  v_lshl_add_u32 v67, v67, 4, v73
  v_mul_u32_u24 v68, 2341, v67
  v_lshrrev_b32 v68, 16, v68
  v_mul_u32_u24 v69, 28, v68
  v_sub_u32 v69, v67, v69
  v_lshrrev_b32 v70, 4, v69
  v_and_b32 v69, 15, v69
  v_and_b32 v71, 1, v69
  v_lshrrev_b32 v69, 1, v69
  v_lshl_add_u32 v69, v71, 3, v69
  v_lshlrev_b32 v71, 12, v70
  v_lshl_add_u32 v71, v68, 8, v71
  v_lshl_add_u32 v71, v69, 4, v71
  v_lshl_add_u32 v60, v66, 3, v71
  v_add_u32 v67, 8, v65
  v_lshl_add_u32 v67, v67, 4, v73
  v_mul_u32_u24 v68, 2341, v67
  v_lshrrev_b32 v68, 16, v68
  v_mul_u32_u24 v69, 28, v68
  v_sub_u32 v69, v67, v69
  v_lshrrev_b32 v70, 4, v69
  v_and_b32 v69, 15, v69
  v_and_b32 v71, 1, v69
  v_lshrrev_b32 v69, 1, v69
  v_lshl_add_u32 v69, v71, 3, v69
  v_lshlrev_b32 v71, 12, v70
  v_lshl_add_u32 v71, v68, 8, v71
  v_lshl_add_u32 v71, v69, 4, v71
  v_lshl_add_u32 v61, v66, 3, v71
  v_add_u32 v67, 10, v65
  v_lshl_add_u32 v67, v67, 4, v73
  v_mul_u32_u24 v68, 2341, v67
  v_lshrrev_b32 v68, 16, v68
  v_mul_u32_u24 v69, 28, v68
  v_sub_u32 v69, v67, v69
  v_lshrrev_b32 v70, 4, v69
  v_and_b32 v69, 15, v69
  v_and_b32 v71, 1, v69
  v_lshrrev_b32 v69, 1, v69
  v_lshl_add_u32 v69, v71, 3, v69
  v_lshlrev_b32 v71, 12, v70
  v_lshl_add_u32 v71, v68, 8, v71
  v_lshl_add_u32 v71, v69, 4, v71
  v_lshl_add_u32 v62, v66, 3, v71
  v_and_b32 v0, 31, v1
  v_lshlrev_b32 v0, 2, v0
  v_add_u32 v0, 21504, v0
  v_lshlrev_b32 v4, 2, v73
  s_and_b32 s22, s17, 15
  s_lshl_b32 s22, s22, 7
  s_add_u32 s22, s22, 17408
  v_add_u32 v4, s22, v4
  v_and_b32 v64, 7, v73
  v_lshlrev_b32 v5, 4, v64
  v_lshl_add_u32 v5, v72, 7, v5
  v_lshrrev_b32 v65, 3, v73
  v_lshl_add_u32 v5, v65, 9, v5
  s_lshl_b32 s22, s17, 3
  s_add_u32 s22, s22, 21508
  v_lshl_add_u32 v7, v2, 3, s22
  v_add_u32 v65, 16, v73
  v_min_u32 v65, 27, v65
  v_mad_u32_u24 v65, v72, 28, v65
  v_lshlrev_b32 v6, 4, v65
  s_lshr_b32 s22, s17, 1
  s_mul_i32 s22, s22, 7
  s_and_b32 s34, s17, 1
  s_lshl_b32 s35, s34, 2
  v_add_u32 v70, s35, v72
  v_mov_b32 v71, s34
  v_mov_b32 v69, 1
  v_cmp_eq_u32 vcc, 3, v72
  s_nop 1
  v_cndmask_b32 v70, v70, v72, vcc
  v_cndmask_b32 v69, v69, v71, vcc
  v_add_u32 v70, s22, v70
  v_lshrrev_b32 v68, 1, v70
  v_lshlrev_b32 v68, 8, v68
  v_lshl_add_u32 v68, v69, 7, v68
  v_and_b32 v69, 1, v70
  v_lshl_add_u32 v68, v69, 3, v68
  v_lshl_add_u32 v1, v64, 4, v68
  v_cmp_gt_u32 s[26:27], 8, v73
  v_cmp_gt_u32 vcc, 3, v72
  s_and_b64 s[26:27], s[26:27], vcc
  v_lshrrev_b32 v65, 3, v73
  v_lshl_add_u32 v66, v64, 1, v65
  v_add_u32 v66, 16, v66
  v_min_u32 v66, 27, v66
  v_mad_u32_u24 v66, v72, 28, v66
  v_lshlrev_b32 v6, 4, v66
  s_mul_i32 s22, s17, 28
  s_add_u32 s22, s22, 16
  v_lshl_add_u32 v70, v64, 1, s22
  v_lshrrev_b32 v68, 4, v70
  v_lshlrev_b32 v68, 8, v68
  v_bfe_u32 v69, v70, 1, 1
  v_lshl_add_u32 v68, v69, 7, v68
  v_bfe_u32 v69, v70, 2, 2
  v_lshl_add_u32 v68, v69, 2, v68
  v_and_b32 v69, 1, v72
  v_lshl_add_u32 v65, v69, 2, v65
  v_lshrrev_b32 v69, 1, v72
  v_lshl_add_u32 v65, v69, 1, v65
  v_lshl_add_u32 v1, v65, 4, v68
  v_cmp_gt_u32 s[26:27], 6, v64
  v_mov_b32 v156, 0
  v_mov_b32 v157, 0
  v_mov_b32 v158, 0
  v_mov_b32 v159, 0
  ds_write_b128 v2, v[156:159] offset:4096
  ds_write_b128 v2, v[156:159] offset:5120
  ds_write_b128 v2, v[156:159] offset:6144
  ds_write_b128 v2, v[156:159] offset:7168
  s_mul_i32 s22, s17, 1835008
  s_add_u32 s25, s22, 42205184
  s_lshl_b32 s35, s17, 7
  s_add_u32 s35, s35, 88526848
  s_mov_b32 s38, 0
  v_mov_b32 v175, 0
  s_lshl_b32 s22, 0, 11
  s_add_u32 s22, s22, 88590336
  v_add_u32 v36, 1024, v2
  v_min_u32 v36, 1776, v36
  s_mov_b32 s30, 0
va_iw5:
  buffer_load_dwordx4 v[40:43], v2, s[8:11], s22 offen sc1
  buffer_load_dwordx4 v[44:47], v36, s[8:11], s22 offen sc1
  s_waitcnt vmcnt(0)
  v_cmp_ne_u64 vcc, s[88:89], v[40:41]
  s_cbranch_vccnz va_iw5_no
  v_cmp_ne_u64 vcc, s[88:89], v[42:43]
  s_cbranch_vccnz va_iw5_no
  v_cmp_ne_u64 vcc, s[88:89], v[44:45]
  s_cbranch_vccnz va_iw5_no
  v_cmp_ne_u64 vcc, s[88:89], v[46:47]
  s_cbranch_vccnz va_iw5_no
  s_branch va_iw5_ok
va_iw5_no:
  s_sleep 2
  s_add_u32 s30, s30, 1
  s_cmp_lt_u32 s30, 50000
  s_cbranch_scc1 va_iw5
  s_branch cA_abort
va_iw5_ok:
  s_mov_b32 s30, 0
  v_mov_b32 v36, 0
ch_md5:
  buffer_load_dword v37, v36, s[12:15], 0 offen sc1
  s_waitcnt vmcnt(0)
  v_readfirstlane_b32 s22, v37
  s_and_b32 s31, s22, 0xffff
  s_cmp_ge_u32 s31, 32
  s_cbranch_scc1 ch_go5
  s_sleep 2
  s_add_u32 s30, s30, 1
  s_cmp_lt_u32 s30, 50000
  s_cbranch_scc1 ch_md5
  s_branch ch_end
ch_go5:
  s_mov_b32 s31, 0
  v_mov_b32 v36, 0
  v_mov_b32 v37, 0
  v_mov_b32 v38, 0
  v_mov_b32 v39, 0
  v_mov_b32 v40, 0
  v_mov_b32 v41, 0
  v_mov_b32 v42, 0
  v_mov_b32 v43, 0
  v_mov_b32 v44, 0
  v_mov_b32 v45, 0
  v_mov_b32 v46, 0
  v_mov_b32 v47, 0
  v_mov_b32 v48, 0
  v_mov_b32 v49, 0
  v_mov_b32 v50, 0
  v_mov_b32 v51, 0
  v_mov_b32 v52, 0
  v_mov_b32 v53, 0
  v_mov_b32 v54, 0
  v_mov_b32 v55, 0
  v_mov_b32 v56, 0
  v_mov_b32 v57, 0
  v_mov_b32 v58, 0
  v_mov_b32 v59, 0
  s_lshr_b32 s22, s22, 16
  s_cmp_lg_u32 s22, 0
  s_cbranch_scc1 cB_va1_loop
  s_branch cA_va1_loop
ch_init6:
  s_mul_i32 s31, s17, 401408
  s_add_u32 s31, s31, 6422528
  s_mul_i32 s22, s17, 28
  s_add_u32 s23, s22, 27
  s_lshr_b32 s22, s22, 6
  s_lshr_b32 s23, s23, 6
  s_sub_u32 s23, s23, s22
  s_lshl_b32 s23, s23, 8
  v_and_b32 v36, s23, v2
  v_med3_u32 v37, v117, 6, 10
  v_lshl_add_u32 v36, v37, 4, v36
  s_lshl_b32 s22, s22, 8
  s_add_u32 s22, s22, 88588288
  s_mov_b32 s30, 0
va_bw_15:
  buffer_load_dwordx4 v[40:43], v36, s[8:11], s22 offen sc1
  s_waitcnt vmcnt(0)
  v_cmp_ne_u64 vcc, s[88:89], v[40:41]
  s_cbranch_vccnz va_bw_15_no
  v_cmp_ne_u64 vcc, s[88:89], v[42:43]
  s_cbranch_vccnz va_bw_15_no
  s_branch va_bw_15_ok
va_bw_15_no:
  s_sleep 2
  s_add_u32 s30, s30, 1
  s_cmp_lt_u32 s30, 50000
  s_cbranch_scc1 va_bw_15
  s_branch cA_abort
va_bw_15_ok:
  s_add_u32 s22, s31, 172032
  buffer_load_dwordx4 a[0:3], v2, s[8:11], s22 offen offset:0 sc1
  buffer_load_dwordx4 a[4:7], v2, s[8:11], s22 offen offset:1024 sc1
  buffer_load_dwordx4 a[8:11], v2, s[8:11], s22 offen offset:2048 sc1
  buffer_load_dwordx4 a[12:15], v2, s[8:11], s22 offen offset:3072 sc1
  s_add_u32 s22, s31, 176128
  buffer_load_dwordx4 a[16:19], v2, s[8:11], s22 offen offset:0 sc1
  buffer_load_dwordx4 a[20:23], v2, s[8:11], s22 offen offset:1024 sc1
  buffer_load_dwordx4 a[24:27], v2, s[8:11], s22 offen offset:2048 sc1
  buffer_load_dwordx4 a[28:31], v2, s[8:11], s22 offen offset:3072 sc1
  s_add_u32 s22, s31, 180224
  buffer_load_dwordx4 a[32:35], v2, s[8:11], s22 offen offset:0 sc1
  buffer_load_dwordx4 a[36:39], v2, s[8:11], s22 offen offset:1024 sc1
  buffer_load_dwordx4 a[40:43], v2, s[8:11], s22 offen offset:2048 sc1
  buffer_load_dwordx4 a[44:47], v2, s[8:11], s22 offen offset:3072 sc1
  s_add_u32 s22, s31, 184320
  buffer_load_dwordx4 a[48:51], v2, s[8:11], s22 offen offset:0 sc1
  buffer_load_dwordx4 a[52:55], v2, s[8:11], s22 offen offset:1024 sc1
  buffer_load_dwordx4 a[56:59], v2, s[8:11], s22 offen offset:2048 sc1
  buffer_load_dwordx4 a[60:63], v2, s[8:11], s22 offen offset:3072 sc1
  s_add_u32 s22, s31, 188416
  buffer_load_dwordx4 a[64:67], v2, s[8:11], s22 offen offset:0 sc1
  buffer_load_dwordx4 a[68:71], v2, s[8:11], s22 offen offset:1024 sc1
  buffer_load_dwordx4 a[72:75], v2, s[8:11], s22 offen offset:2048 sc1
  buffer_load_dwordx4 a[76:79], v2, s[8:11], s22 offen offset:3072 sc1
  s_add_u32 s22, s31, 192512
  buffer_load_dwordx4 a[80:83], v2, s[8:11], s22 offen offset:0 sc1
  buffer_load_dwordx4 a[84:87], v2, s[8:11], s22 offen offset:1024 sc1
  buffer_load_dwordx4 a[88:91], v2, s[8:11], s22 offen offset:2048 sc1
  buffer_load_dwordx4 a[92:95], v2, s[8:11], s22 offen offset:3072 sc1
  s_add_u32 s22, s31, 196608
  buffer_load_dwordx4 a[96:99], v2, s[8:11], s22 offen offset:0 sc1
  buffer_load_dwordx4 a[100:103], v2, s[8:11], s22 offen offset:1024 sc1
  buffer_load_dwordx4 a[104:107], v2, s[8:11], s22 offen offset:2048 sc1
  buffer_load_dwordx4 a[108:111], v2, s[8:11], s22 offen offset:3072 sc1
  s_add_u32 s22, s31, 200704
  buffer_load_dwordx4 a[112:115], v2, s[8:11], s22 offen offset:0 sc1
  buffer_load_dwordx4 a[116:119], v2, s[8:11], s22 offen offset:1024 sc1
  buffer_load_dwordx4 a[120:123], v2, s[8:11], s22 offen offset:2048 sc1
  buffer_load_dwordx4 a[124:127], v2, s[8:11], s22 offen offset:3072 sc1
  s_waitcnt vmcnt(24)
  s_add_u32 s22, s31, 204800
  buffer_load_dwordx4 a[128:131], v2, s[8:11], s22 offen offset:0 sc1
  buffer_load_dwordx4 a[132:135], v2, s[8:11], s22 offen offset:1024 sc1
  buffer_load_dwordx4 a[136:139], v2, s[8:11], s22 offen offset:2048 sc1
  buffer_load_dwordx4 a[140:143], v2, s[8:11], s22 offen offset:3072 sc1
  s_add_u32 s22, s31, 208896
  buffer_load_dwordx4 a[144:147], v2, s[8:11], s22 offen offset:0 sc1
  buffer_load_dwordx4 a[148:151], v2, s[8:11], s22 offen offset:1024 sc1
  buffer_load_dwordx4 a[152:155], v2, s[8:11], s22 offen offset:2048 sc1
  buffer_load_dwordx4 a[156:159], v2, s[8:11], s22 offen offset:3072 sc1
  s_add_u32 s22, s31, 212992
  buffer_load_dwordx4 a[160:163], v2, s[8:11], s22 offen offset:0 sc1
  buffer_load_dwordx4 a[164:167], v2, s[8:11], s22 offen offset:1024 sc1
  buffer_load_dwordx4 a[168:171], v2, s[8:11], s22 offen offset:2048 sc1
  buffer_load_dwordx4 a[172:175], v2, s[8:11], s22 offen offset:3072 sc1
  s_add_u32 s22, s31, 217088
  buffer_load_dwordx4 a[176:179], v2, s[8:11], s22 offen offset:0 sc1
  buffer_load_dwordx4 a[180:183], v2, s[8:11], s22 offen offset:1024 sc1
  buffer_load_dwordx4 a[184:187], v2, s[8:11], s22 offen offset:2048 sc1
  buffer_load_dwordx4 a[188:191], v2, s[8:11], s22 offen offset:3072 sc1
  s_add_u32 s22, s31, 221184
  buffer_load_dwordx4 a[192:195], v2, s[8:11], s22 offen offset:0 sc1
  buffer_load_dwordx4 a[196:199], v2, s[8:11], s22 offen offset:1024 sc1
  buffer_load_dwordx4 a[200:203], v2, s[8:11], s22 offen offset:2048 sc1
  buffer_load_dwordx4 a[204:207], v2, s[8:11], s22 offen offset:3072 sc1
  s_add_u32 s22, s31, 225280
  buffer_load_dwordx4 a[208:211], v2, s[8:11], s22 offen offset:0 sc1
  buffer_load_dwordx4 a[212:215], v2, s[8:11], s22 offen offset:1024 sc1
  buffer_load_dwordx4 a[216:219], v2, s[8:11], s22 offen offset:2048 sc1
  buffer_load_dwordx4 a[220:223], v2, s[8:11], s22 offen offset:3072 sc1
  s_add_u32 s22, s31, 229376
  buffer_load_dwordx4 a[224:227], v2, s[8:11], s22 offen offset:0 sc1
  buffer_load_dwordx4 a[228:231], v2, s[8:11], s22 offen offset:1024 sc1
  buffer_load_dwordx4 a[232:235], v2, s[8:11], s22 offen offset:2048 sc1
  buffer_load_dwordx4 a[236:239], v2, s[8:11], s22 offen offset:3072 sc1
  s_add_u32 s22, s31, 233472
  buffer_load_dwordx4 a[240:243], v2, s[8:11], s22 offen offset:0 sc1
  buffer_load_dwordx4 a[244:247], v2, s[8:11], s22 offen offset:1024 sc1
  buffer_load_dwordx4 a[248:251], v2, s[8:11], s22 offen offset:2048 sc1
  buffer_load_dwordx4 a[252:255], v2, s[8:11], s22 offen offset:3072 sc1
  s_waitcnt vmcnt(24)
  s_add_u32 s22, s31, 237568
  buffer_load_dwordx4 v[120:123], v2, s[8:11], s22 offen offset:0 sc1
  buffer_load_dwordx4 v[124:127], v2, s[8:11], s22 offen offset:1024 sc1
  buffer_load_dwordx4 v[128:131], v2, s[8:11], s22 offen offset:2048 sc1
  buffer_load_dwordx4 v[132:135], v2, s[8:11], s22 offen offset:3072 sc1
  s_add_u32 s22, s31, 241664
  buffer_load_dwordx4 v[136:139], v2, s[8:11], s22 offen offset:0 sc1
  buffer_load_dwordx4 v[140:143], v2, s[8:11], s22 offen offset:1024 sc1
  buffer_load_dwordx4 v[144:147], v2, s[8:11], s22 offen offset:2048 sc1
  buffer_load_dwordx4 v[148:151], v2, s[8:11], s22 offen offset:3072 sc1
  s_add_u32 s22, s31, 245760
  buffer_load_dwordx4 v[152:155], v2, s[8:11], s22 offen offset:0 sc1
  buffer_load_dwordx4 v[156:159], v2, s[8:11], s22 offen offset:1024 sc1
  buffer_load_dwordx4 v[160:163], v2, s[8:11], s22 offen offset:2048 sc1
  buffer_load_dwordx4 v[164:167], v2, s[8:11], s22 offen offset:3072 sc1
  s_add_u32 s22, s31, 249856
  buffer_load_dwordx4 v[168:171], v2, s[8:11], s22 offen offset:0 sc1
  buffer_load_dwordx4 v[172:175], v2, s[8:11], s22 offen offset:1024 sc1
  buffer_load_dwordx4 v[176:179], v2, s[8:11], s22 offen offset:2048 sc1
  buffer_load_dwordx4 v[180:183], v2, s[8:11], s22 offen offset:3072 sc1
  s_add_u32 s22, s31, 253952
  buffer_load_dwordx4 v[184:187], v2, s[8:11], s22 offen offset:0 sc1
  buffer_load_dwordx4 v[188:191], v2, s[8:11], s22 offen offset:1024 sc1
  buffer_load_dwordx4 v[192:195], v2, s[8:11], s22 offen offset:2048 sc1
  buffer_load_dwordx4 v[196:199], v2, s[8:11], s22 offen offset:3072 sc1
  s_add_u32 s22, s31, 258048
  buffer_load_dwordx4 v[200:203], v2, s[8:11], s22 offen offset:0 sc1
  buffer_load_dwordx4 v[204:207], v2, s[8:11], s22 offen offset:1024 sc1
  buffer_load_dwordx4 v[208:211], v2, s[8:11], s22 offen offset:2048 sc1
  buffer_load_dwordx4 v[212:215], v2, s[8:11], s22 offen offset:3072 sc1
  s_add_u32 s22, s31, 262144
  buffer_load_dwordx4 v[216:219], v2, s[8:11], s22 offen offset:0 sc1
  buffer_load_dwordx4 v[220:223], v2, s[8:11], s22 offen offset:1024 sc1
  buffer_load_dwordx4 v[224:227], v2, s[8:11], s22 offen offset:2048 sc1
  buffer_load_dwordx4 v[228:231], v2, s[8:11], s22 offen offset:3072 sc1
  s_add_u32 s22, s31, 266240
  buffer_load_dwordx4 v[232:235], v2, s[8:11], s22 offen offset:0 sc1
  buffer_load_dwordx4 v[236:239], v2, s[8:11], s22 offen offset:1024 sc1
  buffer_load_dwordx4 v[240:243], v2, s[8:11], s22 offen offset:2048 sc1
  buffer_load_dwordx4 v[244:247], v2, s[8:11], s22 offen offset:3072 sc1
  s_waitcnt vmcnt(24)
  s_add_u32 s22, s31, 270336
  buffer_load_dwordx4 v[248:251], v2, s[8:11], s22 offen offset:0 sc1
  buffer_load_dwordx4 v[252:255], v2, s[8:11], s22 offen offset:1024 sc1
  v_mov_b32 v72, v116
  v_mov_b32 v73, v117
  v_lshrrev_b32 v65, 1, v72
  v_and_b32 v66, 1, v72
  v_add_u32 v67, 12, v65
  v_lshl_add_u32 v67, v67, 4, v73
  v_mul_u32_u24 v68, 2341, v67
  v_lshrrev_b32 v68, 16, v68
  v_mul_u32_u24 v69, 28, v68
  v_sub_u32 v69, v67, v69
  v_lshrrev_b32 v70, 4, v69
  v_and_b32 v69, 15, v69
  v_and_b32 v71, 1, v69
  v_lshrrev_b32 v69, 1, v69
  v_lshl_add_u32 v69, v71, 3, v69
  v_lshlrev_b32 v71, 12, v70
  v_lshl_add_u32 v71, v68, 8, v71
  v_lshl_add_u32 v71, v69, 4, v71
  v_lshl_add_u32 v112, v66, 3, v71
  v_add_u32 v67, 14, v65
  v_lshl_add_u32 v67, v67, 4, v73
  v_mul_u32_u24 v68, 2341, v67
  v_lshrrev_b32 v68, 16, v68
  v_mul_u32_u24 v69, 28, v68
  v_sub_u32 v69, v67, v69
  v_lshrrev_b32 v70, 4, v69
  v_and_b32 v69, 15, v69
  v_and_b32 v71, 1, v69
  v_lshrrev_b32 v69, 1, v69
  v_lshl_add_u32 v69, v71, 3, v69
  v_lshlrev_b32 v71, 12, v70
  v_lshl_add_u32 v71, v68, 8, v71
  v_lshl_add_u32 v71, v69, 4, v71
  v_lshl_add_u32 v113, v66, 3, v71
  v_add_u32 v67, 16, v65
  v_lshl_add_u32 v67, v67, 4, v73
  v_mul_u32_u24 v68, 2341, v67
  v_lshrrev_b32 v68, 16, v68
  v_mul_u32_u24 v69, 28, v68
  v_sub_u32 v69, v67, v69
  v_lshrrev_b32 v70, 4, v69
  v_and_b32 v69, 15, v69
  v_and_b32 v71, 1, v69
  v_lshrrev_b32 v69, 1, v69
  v_lshl_add_u32 v69, v71, 3, v69
  v_lshlrev_b32 v71, 12, v70
  v_lshl_add_u32 v71, v68, 8, v71
  v_lshl_add_u32 v71, v69, 4, v71
  v_lshl_add_u32 v114, v66, 3, v71
  v_add_u32 v67, 18, v65
  v_lshl_add_u32 v67, v67, 4, v73
  v_mul_u32_u24 v68, 2341, v67
  v_lshrrev_b32 v68, 16, v68
  v_mul_u32_u24 v69, 28, v68
  v_sub_u32 v69, v67, v69
  v_lshrrev_b32 v70, 4, v69
  v_and_b32 v69, 15, v69
  v_and_b32 v71, 1, v69
  v_lshrrev_b32 v69, 1, v69
  v_lshl_add_u32 v69, v71, 3, v69
  v_lshlrev_b32 v71, 12, v70
  v_lshl_add_u32 v71, v68, 8, v71
  v_lshl_add_u32 v71, v69, 4, v71
  v_lshl_add_u32 v115, v66, 3, v71
  s_mul_i32 s24, s17, 532480
  s_add_u32 s24, s24, 76926976
  s_mul_i32 s34, s17, 640
  s_add_u32 s34, s34, 88569856
  s_mul_i32 s36, s17, 448
  v_add_u32 v0, s36, v2
  v_add_u32 v0, 8192, v0
  s_add_u32 s36, s36, 88068096
  v_cmp_gt_u32 s[26:27], 28, v1
  v_and_b32 v119, 31, v1
  v_lshlrev_b32 v119, 2, v119
  s_add_u32 s22, s17, 16
  s_and_b32 s22, s22, 31
  s_lshl_b32 s22, s22, 7
  s_add_u32 s22, s22, 21504
  v_add_u32 v119, s22, v119
  v_min_u32 v118, 12, v1
  s_mul_i32 s22, s17, 13
  v_add_u32 v118, s22, v118
  v_lshlrev_b32 v118, 7, v118
  v_add_u32 v118, 51200, v118
  s_mov_b32 s39, 71565312
  v_add_u32 v1, 16384, v2
  v_mov_b32 v117, 1
  s_mul_i32 s38, s17, 1104
  s_add_u32 s38, s38, 25600
  s_lshl_b32 s22, 0, 11
  s_add_u32 s22, s22, 88590336
  v_add_u32 v36, 1024, v2
  v_min_u32 v36, 1776, v36
  s_mov_b32 s30, 0
va_iw6:
  buffer_load_dwordx4 v[40:43], v2, s[8:11], s22 offen sc1
  buffer_load_dwordx4 v[44:47], v36, s[8:11], s22 offen sc1
  s_waitcnt vmcnt(0)
  v_cmp_ne_u64 vcc, s[88:89], v[40:41]
  s_cbranch_vccnz va_iw6_no
  v_cmp_ne_u64 vcc, s[88:89], v[42:43]
  s_cbranch_vccnz va_iw6_no
  v_cmp_ne_u64 vcc, s[88:89], v[44:45]
  s_cbranch_vccnz va_iw6_no
  v_cmp_ne_u64 vcc, s[88:89], v[46:47]
  s_cbranch_vccnz va_iw6_no
  s_branch va_iw6_ok
va_iw6_no:
  s_sleep 2
  s_add_u32 s30, s30, 1
  s_cmp_lt_u32 s30, 50000
  s_cbranch_scc1 va_iw6
  s_branch cA_abort
va_iw6_ok:
  s_mov_b32 s30, 0
  v_mov_b32 v36, 0
ch_md6:
  buffer_load_dword v37, v36, s[12:15], 0 offen sc1
  s_waitcnt vmcnt(0)
  v_readfirstlane_b32 s22, v37
  s_and_b32 s31, s22, 0xffff
  s_cmp_ge_u32 s31, 32
  s_cbranch_scc1 ch_go6
  s_sleep 2
  s_add_u32 s30, s30, 1
  s_cmp_lt_u32 s30, 50000
  s_cbranch_scc1 ch_md6
  s_branch ch_end
ch_go6:
  s_mov_b32 s31, 0
  s_lshr_b32 s22, s22, 16
  s_cmp_lg_u32 s22, 0
  s_cbranch_scc1 cB_va2_loop
  s_branch cA_va2_loop
ch_init7:
  s_mul_i32 s31, s17, 401408
  s_add_u32 s31, s31, 6422528
  s_mul_i32 s22, s17, 28
  s_add_u32 s23, s22, 27
  s_lshr_b32 s22, s22, 6
  s_lshr_b32 s23, s23, 6
  s_sub_u32 s23, s23, s22
  s_lshl_b32 s23, s23, 8
  v_and_b32 v36, s23, v2
  v_med3_u32 v37, v117, 11, 15
  v_lshl_add_u32 v36, v37, 4, v36
  s_lshl_b32 s22, s22, 8
  s_add_u32 s22, s22, 88588288
  s_mov_b32 s30, 0
va_bw_16:
  buffer_load_dwordx4 v[40:43], v36, s[8:11], s22 offen sc1
  s_waitcnt vmcnt(0)
  v_cmp_ne_u64 vcc, s[88:89], v[40:41]
  s_cbranch_vccnz va_bw_16_no
  v_cmp_ne_u64 vcc, s[88:89], v[42:43]
  s_cbranch_vccnz va_bw_16_no
  s_branch va_bw_16_ok
va_bw_16_no:
  s_sleep 2
  s_add_u32 s30, s30, 1
  s_cmp_lt_u32 s30, 50000
  s_cbranch_scc1 va_bw_16
  s_branch cA_abort
va_bw_16_ok:
  s_add_u32 s22, s31, 286720
  buffer_load_dwordx4 a[0:3], v2, s[8:11], s22 offen offset:0 sc1
  buffer_load_dwordx4 a[4:7], v2, s[8:11], s22 offen offset:1024 sc1
  buffer_load_dwordx4 a[8:11], v2, s[8:11], s22 offen offset:2048 sc1
  buffer_load_dwordx4 a[12:15], v2, s[8:11], s22 offen offset:3072 sc1
  s_add_u32 s22, s31, 290816
  buffer_load_dwordx4 a[16:19], v2, s[8:11], s22 offen offset:0 sc1
  buffer_load_dwordx4 a[20:23], v2, s[8:11], s22 offen offset:1024 sc1
  buffer_load_dwordx4 a[24:27], v2, s[8:11], s22 offen offset:2048 sc1
  buffer_load_dwordx4 a[28:31], v2, s[8:11], s22 offen offset:3072 sc1
  s_add_u32 s22, s31, 294912
  buffer_load_dwordx4 a[32:35], v2, s[8:11], s22 offen offset:0 sc1
  buffer_load_dwordx4 a[36:39], v2, s[8:11], s22 offen offset:1024 sc1
  buffer_load_dwordx4 a[40:43], v2, s[8:11], s22 offen offset:2048 sc1
  buffer_load_dwordx4 a[44:47], v2, s[8:11], s22 offen offset:3072 sc1
  s_add_u32 s22, s31, 299008
  buffer_load_dwordx4 a[48:51], v2, s[8:11], s22 offen offset:0 sc1
  buffer_load_dwordx4 a[52:55], v2, s[8:11], s22 offen offset:1024 sc1
  buffer_load_dwordx4 a[56:59], v2, s[8:11], s22 offen offset:2048 sc1
  buffer_load_dwordx4 a[60:63], v2, s[8:11], s22 offen offset:3072 sc1
  s_add_u32 s22, s31, 303104
  buffer_load_dwordx4 a[64:67], v2, s[8:11], s22 offen offset:0 sc1
  buffer_load_dwordx4 a[68:71], v2, s[8:11], s22 offen offset:1024 sc1
  buffer_load_dwordx4 a[72:75], v2, s[8:11], s22 offen offset:2048 sc1
  buffer_load_dwordx4 a[76:79], v2, s[8:11], s22 offen offset:3072 sc1
  s_add_u32 s22, s31, 307200
  buffer_load_dwordx4 a[80:83], v2, s[8:11], s22 offen offset:0 sc1
  buffer_load_dwordx4 a[84:87], v2, s[8:11], s22 offen offset:1024 sc1
  buffer_load_dwordx4 a[88:91], v2, s[8:11], s22 offen offset:2048 sc1
  buffer_load_dwordx4 a[92:95], v2, s[8:11], s22 offen offset:3072 sc1
  s_add_u32 s22, s31, 311296
  buffer_load_dwordx4 a[96:99], v2, s[8:11], s22 offen offset:0 sc1
  buffer_load_dwordx4 a[100:103], v2, s[8:11], s22 offen offset:1024 sc1
  buffer_load_dwordx4 a[104:107], v2, s[8:11], s22 offen offset:2048 sc1
  buffer_load_dwordx4 a[108:111], v2, s[8:11], s22 offen offset:3072 sc1
  s_add_u32 s22, s31, 315392
  buffer_load_dwordx4 a[112:115], v2, s[8:11], s22 offen offset:0 sc1
  buffer_load_dwordx4 a[116:119], v2, s[8:11], s22 offen offset:1024 sc1
  buffer_load_dwordx4 a[120:123], v2, s[8:11], s22 offen offset:2048 sc1
  buffer_load_dwordx4 a[124:127], v2, s[8:11], s22 offen offset:3072 sc1
  s_waitcnt vmcnt(24)
  s_add_u32 s22, s31, 319488
  buffer_load_dwordx4 a[128:131], v2, s[8:11], s22 offen offset:0 sc1
  buffer_load_dwordx4 a[132:135], v2, s[8:11], s22 offen offset:1024 sc1
  buffer_load_dwordx4 a[136:139], v2, s[8:11], s22 offen offset:2048 sc1
  buffer_load_dwordx4 a[140:143], v2, s[8:11], s22 offen offset:3072 sc1
  s_add_u32 s22, s31, 323584
  buffer_load_dwordx4 a[144:147], v2, s[8:11], s22 offen offset:0 sc1
  buffer_load_dwordx4 a[148:151], v2, s[8:11], s22 offen offset:1024 sc1
  buffer_load_dwordx4 a[152:155], v2, s[8:11], s22 offen offset:2048 sc1
  buffer_load_dwordx4 a[156:159], v2, s[8:11], s22 offen offset:3072 sc1
  s_add_u32 s22, s31, 327680
  buffer_load_dwordx4 a[160:163], v2, s[8:11], s22 offen offset:0 sc1
  buffer_load_dwordx4 a[164:167], v2, s[8:11], s22 offen offset:1024 sc1
  buffer_load_dwordx4 a[168:171], v2, s[8:11], s22 offen offset:2048 sc1
  buffer_load_dwordx4 a[172:175], v2, s[8:11], s22 offen offset:3072 sc1
  s_add_u32 s22, s31, 331776
  buffer_load_dwordx4 a[176:179], v2, s[8:11], s22 offen offset:0 sc1
  buffer_load_dwordx4 a[180:183], v2, s[8:11], s22 offen offset:1024 sc1
  buffer_load_dwordx4 a[184:187], v2, s[8:11], s22 offen offset:2048 sc1
  buffer_load_dwordx4 a[188:191], v2, s[8:11], s22 offen offset:3072 sc1
  s_add_u32 s22, s31, 335872
  buffer_load_dwordx4 a[192:195], v2, s[8:11], s22 offen offset:0 sc1
  buffer_load_dwordx4 a[196:199], v2, s[8:11], s22 offen offset:1024 sc1
  buffer_load_dwordx4 a[200:203], v2, s[8:11], s22 offen offset:2048 sc1
  buffer_load_dwordx4 a[204:207], v2, s[8:11], s22 offen offset:3072 sc1
  s_add_u32 s22, s31, 339968
  buffer_load_dwordx4 a[208:211], v2, s[8:11], s22 offen offset:0 sc1
  buffer_load_dwordx4 a[212:215], v2, s[8:11], s22 offen offset:1024 sc1
  buffer_load_dwordx4 a[216:219], v2, s[8:11], s22 offen offset:2048 sc1
  buffer_load_dwordx4 a[220:223], v2, s[8:11], s22 offen offset:3072 sc1
  s_add_u32 s22, s31, 344064
  buffer_load_dwordx4 a[224:227], v2, s[8:11], s22 offen offset:0 sc1
  buffer_load_dwordx4 a[228:231], v2, s[8:11], s22 offen offset:1024 sc1
  buffer_load_dwordx4 a[232:235], v2, s[8:11], s22 offen offset:2048 sc1
  buffer_load_dwordx4 a[236:239], v2, s[8:11], s22 offen offset:3072 sc1
  s_add_u32 s22, s31, 348160
  buffer_load_dwordx4 a[240:243], v2, s[8:11], s22 offen offset:0 sc1
  buffer_load_dwordx4 a[244:247], v2, s[8:11], s22 offen offset:1024 sc1
  buffer_load_dwordx4 a[248:251], v2, s[8:11], s22 offen offset:2048 sc1
  buffer_load_dwordx4 a[252:255], v2, s[8:11], s22 offen offset:3072 sc1
  s_waitcnt vmcnt(24)
  s_add_u32 s22, s31, 352256
  buffer_load_dwordx4 v[120:123], v2, s[8:11], s22 offen offset:0 sc1
  buffer_load_dwordx4 v[124:127], v2, s[8:11], s22 offen offset:1024 sc1
  buffer_load_dwordx4 v[128:131], v2, s[8:11], s22 offen offset:2048 sc1
  buffer_load_dwordx4 v[132:135], v2, s[8:11], s22 offen offset:3072 sc1
  s_add_u32 s22, s31, 356352
  buffer_load_dwordx4 v[136:139], v2, s[8:11], s22 offen offset:0 sc1
  buffer_load_dwordx4 v[140:143], v2, s[8:11], s22 offen offset:1024 sc1
  buffer_load_dwordx4 v[144:147], v2, s[8:11], s22 offen offset:2048 sc1
  buffer_load_dwordx4 v[148:151], v2, s[8:11], s22 offen offset:3072 sc1
  s_add_u32 s22, s31, 360448
  buffer_load_dwordx4 v[152:155], v2, s[8:11], s22 offen offset:0 sc1
  buffer_load_dwordx4 v[156:159], v2, s[8:11], s22 offen offset:1024 sc1
  buffer_load_dwordx4 v[160:163], v2, s[8:11], s22 offen offset:2048 sc1
  buffer_load_dwordx4 v[164:167], v2, s[8:11], s22 offen offset:3072 sc1
  s_add_u32 s22, s31, 364544
  buffer_load_dwordx4 v[168:171], v2, s[8:11], s22 offen offset:0 sc1
  buffer_load_dwordx4 v[172:175], v2, s[8:11], s22 offen offset:1024 sc1
  buffer_load_dwordx4 v[176:179], v2, s[8:11], s22 offen offset:2048 sc1
  buffer_load_dwordx4 v[180:183], v2, s[8:11], s22 offen offset:3072 sc1
  s_add_u32 s22, s31, 368640
  buffer_load_dwordx4 v[184:187], v2, s[8:11], s22 offen offset:0 sc1
  buffer_load_dwordx4 v[188:191], v2, s[8:11], s22 offen offset:1024 sc1
  buffer_load_dwordx4 v[192:195], v2, s[8:11], s22 offen offset:2048 sc1
  buffer_load_dwordx4 v[196:199], v2, s[8:11], s22 offen offset:3072 sc1
  s_add_u32 s22, s31, 372736
  buffer_load_dwordx4 v[200:203], v2, s[8:11], s22 offen offset:0 sc1
  buffer_load_dwordx4 v[204:207], v2, s[8:11], s22 offen offset:1024 sc1
  buffer_load_dwordx4 v[208:211], v2, s[8:11], s22 offen offset:2048 sc1
  buffer_load_dwordx4 v[212:215], v2, s[8:11], s22 offen offset:3072 sc1
  s_add_u32 s22, s31, 376832
  buffer_load_dwordx4 v[216:219], v2, s[8:11], s22 offen offset:0 sc1
  buffer_load_dwordx4 v[220:223], v2, s[8:11], s22 offen offset:1024 sc1
  buffer_load_dwordx4 v[224:227], v2, s[8:11], s22 offen offset:2048 sc1
  buffer_load_dwordx4 v[228:231], v2, s[8:11], s22 offen offset:3072 sc1
  s_add_u32 s22, s31, 380928
  buffer_load_dwordx4 v[232:235], v2, s[8:11], s22 offen offset:0 sc1
  buffer_load_dwordx4 v[236:239], v2, s[8:11], s22 offen offset:1024 sc1
  buffer_load_dwordx4 v[240:243], v2, s[8:11], s22 offen offset:2048 sc1
  buffer_load_dwordx4 v[244:247], v2, s[8:11], s22 offen offset:3072 sc1
  s_waitcnt vmcnt(24)
  s_add_u32 s22, s31, 385024
  buffer_load_dwordx4 v[248:251], v2, s[8:11], s22 offen offset:0 sc1
  buffer_load_dwordx4 v[252:255], v2, s[8:11], s22 offen offset:1024 sc1
  v_mov_b32 v72, v116
  v_mov_b32 v73, v117
  v_lshrrev_b32 v65, 1, v72
  v_and_b32 v66, 1, v72
  v_add_u32 v67, 20, v65
  v_lshl_add_u32 v67, v67, 4, v73
  v_mul_u32_u24 v68, 2341, v67
  v_lshrrev_b32 v68, 16, v68
  v_mul_u32_u24 v69, 28, v68
  v_sub_u32 v69, v67, v69
  v_lshrrev_b32 v70, 4, v69
  v_and_b32 v69, 15, v69
  v_and_b32 v71, 1, v69
  v_lshrrev_b32 v69, 1, v69
  v_lshl_add_u32 v69, v71, 3, v69
  v_lshlrev_b32 v71, 12, v70
  v_lshl_add_u32 v71, v68, 8, v71
  v_lshl_add_u32 v71, v69, 4, v71
  v_lshl_add_u32 v112, v66, 3, v71
  v_add_u32 v67, 22, v65
  v_lshl_add_u32 v67, v67, 4, v73
  v_mul_u32_u24 v68, 2341, v67
  v_lshrrev_b32 v68, 16, v68
  v_mul_u32_u24 v69, 28, v68
  v_sub_u32 v69, v67, v69
  v_lshrrev_b32 v70, 4, v69
  v_and_b32 v69, 15, v69
  v_and_b32 v71, 1, v69
  v_lshrrev_b32 v69, 1, v69
  v_lshl_add_u32 v69, v71, 3, v69
  v_lshlrev_b32 v71, 12, v70
  v_lshl_add_u32 v71, v68, 8, v71
  v_lshl_add_u32 v71, v69, 4, v71
  v_lshl_add_u32 v113, v66, 3, v71
  v_add_u32 v67, 24, v65
  v_lshl_add_u32 v67, v67, 4, v73
  v_mul_u32_u24 v68, 2341, v67
  v_lshrrev_b32 v68, 16, v68
  v_mul_u32_u24 v69, 28, v68
  v_sub_u32 v69, v67, v69
  v_lshrrev_b32 v70, 4, v69
  v_and_b32 v69, 15, v69
  v_and_b32 v71, 1, v69
  v_lshrrev_b32 v69, 1, v69
  v_lshl_add_u32 v69, v71, 3, v69
  v_lshlrev_b32 v71, 12, v70
  v_lshl_add_u32 v71, v68, 8, v71
  v_lshl_add_u32 v71, v69, 4, v71
  v_lshl_add_u32 v114, v66, 3, v71
  v_add_u32 v67, 26, v65
  v_lshl_add_u32 v67, v67, 4, v73
  v_mul_u32_u24 v68, 2341, v67
  v_lshrrev_b32 v68, 16, v68
  v_mul_u32_u24 v69, 28, v68
  v_sub_u32 v69, v67, v69
  v_lshrrev_b32 v70, 4, v69
  v_and_b32 v69, 15, v69
  v_and_b32 v71, 1, v69
  v_lshrrev_b32 v69, 1, v69
  v_lshl_add_u32 v69, v71, 3, v69
  v_lshlrev_b32 v71, 12, v70
  v_lshl_add_u32 v71, v68, 8, v71
  v_lshl_add_u32 v71, v69, 4, v71
  v_lshl_add_u32 v115, v66, 3, v71
  s_mul_i32 s24, s17, 532480
  s_add_u32 s24, s24, 76931072
  s_mul_i32 s34, s17, 640
  s_add_u32 s34, s34, 88569860
  s_mul_i32 s36, s17, 448
  v_add_u32 v0, s36, v2
  v_add_u32 v0, 8192, v0
  s_add_u32 s36, s36, 88068096
  v_cmp_gt_u32 s[26:27], 28, v1
  v_and_b32 v119, 31, v1
  v_lshlrev_b32 v119, 2, v119
  s_add_u32 s22, s17, 16
  s_and_b32 s22, s22, 31
  s_lshl_b32 s22, s22, 7
  s_add_u32 s22, s22, 21504
  v_add_u32 v119, s22, v119
  v_min_u32 v118, 13, v1
  s_mul_i32 s22, s17, 14
  v_add_u32 v118, s22, v118
  v_lshlrev_b32 v118, 7, v118
  v_add_u32 v118, 57344, v118
  s_mov_b32 s39, 71565312
  v_add_u32 v1, 59392, v2
  v_mov_b32 v117, 1
  s_mul_i32 s38, s17, 1104
  s_add_u32 s38, s38, 26624
  s_lshl_b32 s22, 0, 11
  s_add_u32 s22, s22, 88590336
  v_add_u32 v36, 1024, v2
  v_min_u32 v36, 1776, v36
  s_mov_b32 s30, 0
va_iw7:
  buffer_load_dwordx4 v[40:43], v2, s[8:11], s22 offen sc1
  buffer_load_dwordx4 v[44:47], v36, s[8:11], s22 offen sc1
  s_waitcnt vmcnt(0)
  v_cmp_ne_u64 vcc, s[88:89], v[40:41]
  s_cbranch_vccnz va_iw7_no
  v_cmp_ne_u64 vcc, s[88:89], v[42:43]
  s_cbranch_vccnz va_iw7_no
  v_cmp_ne_u64 vcc, s[88:89], v[44:45]
  s_cbranch_vccnz va_iw7_no
  v_cmp_ne_u64 vcc, s[88:89], v[46:47]
  s_cbranch_vccnz va_iw7_no
  s_branch va_iw7_ok
va_iw7_no:
  s_sleep 2
  s_add_u32 s30, s30, 1
  s_cmp_lt_u32 s30, 50000
  s_cbranch_scc1 va_iw7
  s_branch cA_abort
va_iw7_ok:
  s_mov_b32 s30, 0
  v_mov_b32 v36, 0
ch_md7:
  buffer_load_dword v37, v36, s[12:15], 0 offen sc1
  s_waitcnt vmcnt(0)
  v_readfirstlane_b32 s22, v37
  s_and_b32 s31, s22, 0xffff
  s_cmp_ge_u32 s31, 32
  s_cbranch_scc1 ch_go7
  s_sleep 2
  s_add_u32 s30, s30, 1
  s_cmp_lt_u32 s30, 50000
  s_cbranch_scc1 ch_md7
  s_branch ch_end
ch_go7:
  s_mov_b32 s31, 0
  s_lshr_b32 s22, s22, 16
  s_cmp_lg_u32 s22, 0
  s_cbranch_scc1 cB_va3_loop
  s_branch cA_va3_loop
.p2align 6

cA_sc0_loop:
  s_add_u32 s23, s20, 4096
  s_add_u32 s21, s20, 25600
  v_mov_b32 v48, 0
  v_mov_b32 v49, 0
  v_mov_b32 v50, 0
  v_mov_b32 v51, 0
  v_mov_b32 v52, 0
  v_mov_b32 v53, 0
  v_mov_b32 v54, 0
  v_mov_b32 v55, 0
  v_mov_b32 v56, 0
  v_mov_b32 v57, 0
  v_mov_b32 v58, 0
  v_mov_b32 v59, 0
  v_mov_b32 v60, 0
  v_mov_b32 v61, 0
  v_mov_b32 v62, 0
  v_mov_b32 v63, 0
  v_mov_b32 v88, 0
  v_mov_b32 v89, 0
  v_mov_b32 v90, 0
  v_mov_b32 v91, 0
  v_mov_b32 v92, 0
  v_mov_b32 v93, 0
  v_mov_b32 v94, 0
  v_mov_b32 v95, 0
  v_mov_b32 v66, 0
  v_mov_b32 v67, 0
  s_mov_b32 s30, 0
  s_mov_b32 s62, 0
  buffer_load_dword v68, v0, s[8:11], s20 offen sc1
  s_nop 7
  buffer_load_dword v69, v0, s[8:11], s20 offen sc1
  s_nop 7
  buffer_load_dword v70, v0, s[8:11], s20 offen sc1
  s_nop 7
  buffer_load_dword v71, v0, s[8:11], s20 offen sc1
  s_nop 7
  buffer_load_dword v72, v0, s[8:11], s20 offen sc1
cA_sc0_fp_l:
  s_waitcnt vmcnt(4)
  v_cmp_eq_u32 vcc, -1, v68
  s_cbranch_vccz cA_sc0_fp_d
  buffer_load_dword v68, v0, s[8:11], s20 offen sc1
  s_waitcnt vmcnt(4)
  v_cmp_eq_u32 vcc, -1, v69
  s_cbranch_vccz cA_sc0_fp_d
  buffer_load_dword v69, v0, s[8:11], s20 offen sc1
  s_waitcnt vmcnt(4)
  v_cmp_eq_u32 vcc, -1, v70
  s_cbranch_vccz cA_sc0_fp_d
  buffer_load_dword v70, v0, s[8:11], s20 offen sc1
  s_waitcnt vmcnt(4)
  v_cmp_eq_u32 vcc, -1, v71
  s_cbranch_vccz cA_sc0_fp_d
  buffer_load_dword v71, v0, s[8:11], s20 offen sc1
  s_waitcnt vmcnt(4)
  v_cmp_eq_u32 vcc, -1, v72
  s_cbranch_vccz cA_sc0_fp_d
  buffer_load_dword v72, v0, s[8:11], s20 offen sc1
  s_add_u32 s30, s30, 1
  s_cmp_lt_u32 s30, 400000
  s_cbranch_scc1 cA_sc0_fp_l
  s_branch cA_abort
cA_sc0_fp_d:
  buffer_load_dwordx4 v[8:11], v2, s[8:11], s20 offen offset:0
  s_barrier
  s_branch cA_sc0_ld1
cA_sc0_ld:
  buffer_load_dwordx4 v[8:11], v2, s[8:11], s20 offen offset:0
cA_sc0_ld1:
  v_mov_b32 v36, 0
  v_mov_b32 v37, 0
  v_mov_b32 v38, 0
  v_mov_b32 v39, 0
  buffer_load_dwordx4 v[12:15], v2, s[8:11], s20 offen offset:1024
  v_mov_b32 v40, 0
  v_mov_b32 v41, 0
  v_mov_b32 v42, 0
  v_mov_b32 v43, 0
  buffer_load_dwordx4 v[16:19], v2, s[8:11], s20 offen offset:2048
  v_mov_b32 v44, 0
  v_mov_b32 v45, 0
  v_mov_b32 v46, 0
  v_mov_b32 v47, 0
  ds_read_b128 v[96:99], v117 offset:0
  ds_read_b128 v[100:103], v117 offset:1024
  ds_read_b128 v[104:107], v117 offset:14336
  ds_read_b128 v[108:111], v117 offset:15360
  s_waitcnt vmcnt(2)
  v_smfmac_f32_16x16x64_bf16 v[36:39], v[8:11], a[0:7], v3
  v_smfmac_f32_16x16x64_bf16 v[40:43], v[8:11], a[56:63], v3
  buffer_load_dwordx4 v[20:23], v2, s[8:11], s20 offen offset:3072
  v_smfmac_f32_16x16x64_bf16 v[44:47], v[8:11], a[112:119], v3
  v_smfmac_f32_16x16x64_bf16 v[48:51], v[8:11], a[168:175], v3
  v_smfmac_f32_16x16x64_bf16 v[52:55], v[8:11], a[224:231], v3
  buffer_load_dwordx4 v[24:27], v2, s[8:11], s23 offen offset:0
  v_smfmac_f32_16x16x64_bf16 v[56:59], v[8:11], v[144:151], v3
  v_smfmac_f32_16x16x64_bf16 v[60:63], v[8:11], v[200:207], v3
  s_waitcnt vmcnt(3)
  v_smfmac_f32_16x16x64_bf16 v[36:39], v[12:15], a[8:15], v3
  v_smfmac_f32_16x16x64_bf16 v[40:43], v[12:15], a[64:71], v3
  buffer_load_dwordx4 v[28:31], v2, s[8:11], s23 offen offset:1024
  v_smfmac_f32_16x16x64_bf16 v[44:47], v[12:15], a[120:127], v3
  v_smfmac_f32_16x16x64_bf16 v[48:51], v[12:15], a[176:183], v3
  v_smfmac_f32_16x16x64_bf16 v[52:55], v[12:15], a[232:239], v3
  buffer_load_dwordx4 v[32:35], v2, s[8:11], s23 offen offset:2048
  v_smfmac_f32_16x16x64_bf16 v[56:59], v[12:15], v[152:159], v3
  v_smfmac_f32_16x16x64_bf16 v[60:63], v[12:15], v[208:215], v3
  s_waitcnt vmcnt(4)
  v_smfmac_f32_16x16x64_bf16 v[36:39], v[16:19], a[16:23], v3
  v_smfmac_f32_16x16x64_bf16 v[40:43], v[16:19], a[72:79], v3
  v_smfmac_f32_16x16x64_bf16 v[44:47], v[16:19], a[128:135], v3
  v_smfmac_f32_16x16x64_bf16 v[48:51], v[16:19], a[184:191], v3
  v_smfmac_f32_16x16x64_bf16 v[52:55], v[16:19], a[240:247], v3
  v_smfmac_f32_16x16x64_bf16 v[56:59], v[16:19], v[160:167], v3
  v_smfmac_f32_16x16x64_bf16 v[60:63], v[16:19], v[216:223], v3
  s_waitcnt vmcnt(3)
  v_smfmac_f32_16x16x64_bf16 v[36:39], v[20:23], a[24:31], v3
  v_smfmac_f32_16x16x64_bf16 v[40:43], v[20:23], a[80:87], v3
  v_smfmac_f32_16x16x64_bf16 v[44:47], v[20:23], a[136:143], v3
  v_smfmac_f32_16x16x64_bf16 v[48:51], v[20:23], a[192:199], v3
  v_smfmac_f32_16x16x64_bf16 v[52:55], v[20:23], a[248:255], v3
  v_smfmac_f32_16x16x64_bf16 v[56:59], v[20:23], v[168:175], v3
  v_smfmac_f32_16x16x64_bf16 v[60:63], v[20:23], v[224:231], v3
  s_waitcnt vmcnt(0)
cA_sc0_ph2:
  v_smfmac_f32_16x16x64_bf16 v[60:63], v[24:27], v[232:239], v3
  ds_read_b128 v[12:15], v116 offset:0
  ds_read_b128 v[16:19], v116 offset:1024
  v_smfmac_f32_16x16x64_bf16 v[60:63], v[28:31], v[240:247], v3
  v_smfmac_f32_16x16x64_bf16 v[60:63], v[32:35], v[248:255], v3
  v_mov_b32 v80, v24
  v_smfmac_f32_16x16x64_bf16 v[52:55], v[24:27], v[120:127], v3
  v_mov_b32 v81, v25
  v_smfmac_f32_16x16x64_bf16 v[52:55], v[28:31], v[128:135], v3
  v_mov_b32 v82, v32
  v_smfmac_f32_16x16x64_bf16 v[52:55], v[32:35], v[136:143], v3
  v_cvt_pk_bf16_f32 v64, v60, v61
  v_smfmac_f32_16x16x64_bf16 v[56:59], v[24:27], v[176:183], v3
  v_cvt_pk_bf16_f32 v65, v62, v63
  v_smfmac_f32_16x16x64_bf16 v[56:59], v[28:31], v[184:191], v3
  v_mov_b32 v83, v33
  v_mfma_f32_16x16x32_bf16 v[68:71], v[64:67], v[4:7], 0
  v_smfmac_f32_16x16x64_bf16 v[56:59], v[32:35], v[192:199], v3
  v_cvt_pk_bf16_f32 v64, v52, v53
  v_smfmac_f32_16x16x64_bf16 v[36:39], v[24:27], a[32:39], v3
  v_cvt_pk_bf16_f32 v65, v54, v55
  v_smfmac_f32_16x16x64_bf16 v[36:39], v[28:31], a[40:47], v3
  v_cvt_pk_bf16_f32 v78, v68, v69
  v_smfmac_f32_16x16x64_bf16 v[36:39], v[32:35], a[48:55], v3
  v_cvt_pk_bf16_f32 v79, v70, v71
  v_cvt_pk_bf16_f32 v66, v56, v57
  v_smfmac_f32_16x16x64_bf16 v[40:43], v[24:27], a[88:95], v3
  v_cvt_pk_bf16_f32 v67, v58, v59
  v_smfmac_f32_16x16x64_bf16 v[40:43], v[28:31], a[96:103], v3
  v_mfma_f32_16x16x32_bf16 v[72:75], v[64:67], v[4:7], 0
  ds_read_b128 v[52:55], v116 offset:14336
  ds_read_b128 v[56:59], v116 offset:15360
  v_smfmac_f32_16x16x64_bf16 v[40:43], v[32:35], a[104:111], v3
  v_cvt_pk_bf16_f32 v64, v36, v37
  v_smfmac_f32_16x16x64_bf16 v[44:47], v[24:27], a[144:151], v3
  v_cvt_pk_bf16_f32 v65, v38, v39
  v_smfmac_f32_16x16x64_bf16 v[44:47], v[28:31], a[152:159], v3
  v_cvt_pk_bf16_f32 v76, v72, v73
  v_smfmac_f32_16x16x64_bf16 v[44:47], v[32:35], a[160:167], v3
  v_cvt_pk_bf16_f32 v77, v74, v75
  v_cvt_pk_bf16_f32 v66, v40, v41
  v_smfmac_f32_16x16x64_bf16 v[48:51], v[24:27], a[200:207], v3
  v_cvt_pk_bf16_f32 v67, v42, v43
  v_smfmac_f32_16x16x64_bf16 v[48:51], v[28:31], a[208:215], v3
  v_mfma_f32_16x16x32_bf16 v[68:71], v[64:67], v[4:7], 0
  v_smfmac_f32_16x16x64_bf16 v[48:51], v[32:35], a[216:223], v3
  v_cvt_pk_bf16_f32 v64, v44, v45
  v_mfma_f32_16x16x32_bf16 v[84:87], v[80:83], v[76:79], 0
  v_cvt_pk_bf16_f32 v65, v46, v47
  s_waitcnt lgkmcnt(0)
  v_smfmac_f32_16x16x64_bf16 v[88:91], v[76:79], v[96:103], v3
  v_cvt_pk_bf16_f32 v60, v68, v69
  v_cvt_pk_bf16_f32 v61, v70, v71
  v_cvt_pk_bf16_f32 v66, v48, v49
  v_cvt_pk_bf16_f32 v67, v50, v51
  s_nop 1
  v_mfma_f32_16x16x32_bf16 v[72:75], v[64:67], v[4:7], 0
  v_smfmac_f32_16x16x64_bf16 v[92:95], v[76:79], v[104:111], v3
  s_nop 4
  v_cvt_pk_bf16_f32 v62, v72, v73
  v_cvt_pk_bf16_f32 v63, v74, v75
  s_nop 1
  v_mfma_f32_16x16x32_bf16 v[84:87], v[8:11], v[60:63], v[84:87]
  v_smfmac_f32_16x16x64_bf16 v[88:91], v[60:63], v[12:19], v3
  v_smfmac_f32_16x16x64_bf16 v[92:95], v[60:63], v[52:59], v3
  s_mov_b64 exec, s[26:27]
  s_nop 0
  ds_write_b128 v113, v[84:87]
  s_mov_b64 exec, -1
  s_nop 0
  v_cmp_u_f32 vcc, v88, v89
  s_nop 1
  v_permlane32_swap_b32 v88, v92
  v_permlane32_swap_b32 v89, v93
  v_permlane32_swap_b32 v90, v94
  v_permlane32_swap_b32 v91, v95
  v_add_f32 v88, v88, v92
  v_add_f32 v89, v89, v93
  v_add_f32 v90, v90, v94
  v_add_f32 v91, v91, v95
  ds_write_b128 v112, v[88:91]
  s_cbranch_vccnz cA_sc0_retry
cA_sc0_cont:
  s_waitcnt lgkmcnt(0)
  s_barrier
  ds_read_b64 v[36:37], v114 offset:0
  ds_read_b64 v[38:39], v114 offset:1024
  ds_read2_b32 v[44:45], v115 offset0:0 offset1:64
  s_waitcnt lgkmcnt(0)
  v_add_f32 v44, v44, v45
  v_add_f32 v36, v36, v38
  v_add_f32 v37, v37, v39
  v_add_f32_dpp v44, v44, v44 row_ror:8 row_mask:0xf bank_mask:0xf
  v_mov_b32 v45, v44
  v_permlane32_swap_b32 v36, v37
  v_add_f32 v36, v36, v37
  v_permlane16_swap_b32 v44, v45
  v_add_f32 v44, v44, v45
  v_exp_f32 v48, v36
  v_exp_f32 v49, v44
  v_add_f32 v50, abs(v36), abs(v44)
  v_fma_f32 v39, v49, s37, v48
  v_cmp_ngt_f32 vcc, s56, v50
  v_cndmask_b32 v41, v48, v49, s[38:39]
  v_add_f32_dpp v39, v39, v39 quad_perm:[1,0,3,2] row_mask:0xf bank_mask:0xf
  v_cndmask_b32 v40, v49, v48, s[38:39]
  v_mov_b32_dpp v46, v41 quad_perm:[1,0,3,2] row_mask:0xf bank_mask:0xf
  v_add_f32_dpp v39, v39, v39 quad_perm:[2,3,0,1] row_mask:0xf bank_mask:0xf
  v_cndmask_b32 v42, v46, v40, s[38:39]
  v_cndmask_b32 v43, v40, v46, s[38:39]
  v_add_f32_dpp v39, v39, v39 row_half_mirror row_mask:0xf bank_mask:0xf
  s_cbranch_vccnz cA_sc0_slow
  s_nop 0
  v_add_f32_dpp v39, v39, v39 row_mirror row_mask:0xf bank_mask:0xf
  v_mov_b32 v47, v39
  s_nop 1
  v_permlane16_swap_b32 v39, v47
  v_add_f32 v39, v39, v47
  v_rcp_f32 v39, v39
  s_mov_b64 exec, s[28:29]
  v_mul_f32 v42, v42, v39
  v_mul_f32 v43, v43, v39
  v_cvt_pk_bf16_f32 v42, v42, v43
cA_sc0_pst:
  buffer_store_dword v42, v1, s[8:11], s20 offen
  s_mov_b64 exec, -1
  s_barrier
  s_add_u32 s24, s24, 28672
  s_add_u32 s35, s35, 28672
  s_xor_b32 s25, s25, 28672
  s_add_u32 m0, s25, 0
  s_nop 0
  buffer_load_dwordx4 v2, s[8:11], s24 offen offset:0 sc1 lds
  buffer_load_dwordx4 v2, s[8:11], s24 offen offset:1024 sc1 lds
  buffer_load_dwordx4 v2, s[8:11], s24 offen offset:2048 sc1 lds
  buffer_load_dwordx4 v2, s[8:11], s24 offen offset:3072 sc1 lds
  s_add_u32 m0, s25, 4096
  s_add_u32 s22, s24, 4096
  buffer_load_dwordx4 v2, s[8:11], s22 offen offset:0 sc1 lds
  buffer_load_dwordx4 v2, s[8:11], s22 offen offset:1024 sc1 lds
  buffer_load_dwordx4 v2, s[8:11], s22 offen offset:2048 sc1 lds
  v_xor_b32 v116, 28672, v116
  v_add_u32 v117, s57, v117
  s_sub_u32 s57, 0, s57
  s_add_u32 s19, s19, 1
  s_mov_b32 s20, s21
  s_cmp_lt_u32 s19, 63
  s_cbranch_scc1 cA_sc0_loop
  s_branch cA_done
cA_sc0_slow:
  v_max_f32 v50, v36, v44
  s_nop 1
  v_max_f32_dpp v50, v50, v50 quad_perm:[1,0,3,2] row_mask:0xf bank_mask:0xf
  s_nop 1
  v_max_f32_dpp v50, v50, v50 quad_perm:[2,3,0,1] row_mask:0xf bank_mask:0xf
  s_nop 1
  v_max_f32_dpp v50, v50, v50 row_half_mirror row_mask:0xf bank_mask:0xf
  s_nop 1
  v_max_f32_dpp v50, v50, v50 row_mirror row_mask:0xf bank_mask:0xf
  v_mov_b32 v47, v50
  s_nop 1
  v_permlane16_swap_b32 v50, v47
  v_max_f32 v50, v50, v47
  v_sub_f32 v48, v36, v50
  v_sub_f32 v49, v44, v50
  v_exp_f32 v48, v48
  v_exp_f32 v49, v49
  s_add_u32 s31, s31, 0x100
  v_fma_f32 v39, v49, s37, v48
  v_cndmask_b32 v41, v48, v49, s[38:39]
  s_nop 0
  v_add_f32_dpp v39, v39, v39 quad_perm:[1,0,3,2] row_mask:0xf bank_mask:0xf
  v_cndmask_b32 v40, v49, v48, s[38:39]
  v_mov_b32_dpp v46, v41 quad_perm:[1,0,3,2] row_mask:0xf bank_mask:0xf
  v_add_f32_dpp v39, v39, v39 quad_perm:[2,3,0,1] row_mask:0xf bank_mask:0xf
  v_cndmask_b32 v42, v46, v40, s[38:39]
  v_cndmask_b32 v43, v40, v46, s[38:39]
  v_add_f32_dpp v39, v39, v39 row_half_mirror row_mask:0xf bank_mask:0xf
  s_nop 1
  v_add_f32_dpp v39, v39, v39 row_mirror row_mask:0xf bank_mask:0xf
  v_mov_b32 v47, v39
  s_nop 1
  v_permlane16_swap_b32 v39, v47
  v_add_f32 v39, v39, v47
  v_rcp_f32 v39, v39
  s_mov_b64 exec, s[28:29]
  v_mul_f32 v42, v42, v39
  v_mul_f32 v43, v43, v39
  v_cvt_pk_bf16_f32 v42, v42, v43
  v_min_u32 v42, -2, v42
  s_branch cA_sc0_pst
cA_sc0_retry:
  s_cmp_lg_u32 s62, 0
  s_cbranch_scc1 cA_sc0_cont
  s_waitcnt vmcnt(0) lgkmcnt(0)
cA_sc0_rv:
  buffer_load_dwordx4 v[8:11], v2, s[8:11], s20 offen offset:0 sc1
  buffer_load_dwordx4 v[12:15], v2, s[8:11], s20 offen offset:1024 sc1
  buffer_load_dwordx4 v[16:19], v2, s[8:11], s20 offen offset:2048 sc1
  buffer_load_dwordx4 v[20:23], v2, s[8:11], s20 offen offset:3072 sc1
  buffer_load_dwordx4 v[24:27], v2, s[8:11], s23 offen offset:0 sc1
  buffer_load_dwordx4 v[28:31], v2, s[8:11], s23 offen offset:1024 sc1
  buffer_load_dwordx4 v[32:35], v2, s[8:11], s23 offen offset:2048 sc1
  s_waitcnt vmcnt(0)
  v_max3_u32 v118, v8, v9, v10
  v_max3_u32 v118, v118, v11, v12
  v_max3_u32 v118, v118, v13, v14
  v_max3_u32 v118, v118, v15, v16
  v_max3_u32 v118, v118, v17, v18
  v_max3_u32 v118, v118, v19, v20
  v_max3_u32 v118, v118, v21, v22
  v_max3_u32 v118, v118, v23, v24
  v_max3_u32 v118, v118, v25, v26
  v_max3_u32 v118, v118, v27, v28
  v_max3_u32 v118, v118, v29, v30
  v_max3_u32 v118, v118, v31, v32
  v_max3_u32 v118, v118, v33, v34
  v_max_u32 v118, v118, v35
  v_cmp_eq_u32 vcc, -1, v118
  s_cbranch_vccz cA_sc0_rk
  s_add_u32 s30, s30, 1
  s_cmp_lt_u32 s30, 400000
  s_cbranch_scc1 cA_sc0_rv
  s_branch cA_abort
cA_sc0_rk:
  s_mov_b32 s62, 1
  v_mov_b32 v36, 0
  v_mov_b32 v37, 0
  v_mov_b32 v38, 0
  v_mov_b32 v39, 0
  v_mov_b32 v40, 0
  v_mov_b32 v41, 0
  v_mov_b32 v42, 0
  v_mov_b32 v43, 0
  v_mov_b32 v44, 0
  v_mov_b32 v45, 0
  v_mov_b32 v46, 0
  v_mov_b32 v47, 0
  v_mov_b32 v48, 0
  v_mov_b32 v49, 0
  v_mov_b32 v50, 0
  v_mov_b32 v51, 0
  v_mov_b32 v52, 0
  v_mov_b32 v53, 0
  v_mov_b32 v54, 0
  v_mov_b32 v55, 0
  v_mov_b32 v56, 0
  v_mov_b32 v57, 0
  v_mov_b32 v58, 0
  v_mov_b32 v59, 0
  v_mov_b32 v60, 0
  v_mov_b32 v61, 0
  v_mov_b32 v62, 0
  v_mov_b32 v63, 0
  v_mov_b32 v88, 0
  v_mov_b32 v89, 0
  v_mov_b32 v90, 0
  v_mov_b32 v91, 0
  v_mov_b32 v92, 0
  v_mov_b32 v93, 0
  v_mov_b32 v94, 0
  v_mov_b32 v95, 0
  v_mov_b32 v66, 0
  v_mov_b32 v67, 0
  s_add_u32 s31, s31, 1
  ds_read_b128 v[96:99], v117 offset:0
  ds_read_b128 v[100:103], v117 offset:1024
  ds_read_b128 v[104:107], v117 offset:14336
  ds_read_b128 v[108:111], v117 offset:15360
  v_smfmac_f32_16x16x64_bf16 v[36:39], v[8:11], a[0:7], v3
  v_smfmac_f32_16x16x64_bf16 v[40:43], v[8:11], a[56:63], v3
  v_smfmac_f32_16x16x64_bf16 v[44:47], v[8:11], a[112:119], v3
  v_smfmac_f32_16x16x64_bf16 v[48:51], v[8:11], a[168:175], v3
  v_smfmac_f32_16x16x64_bf16 v[52:55], v[8:11], a[224:231], v3
  v_smfmac_f32_16x16x64_bf16 v[56:59], v[8:11], v[144:151], v3
  v_smfmac_f32_16x16x64_bf16 v[60:63], v[8:11], v[200:207], v3
  v_smfmac_f32_16x16x64_bf16 v[36:39], v[12:15], a[8:15], v3
  v_smfmac_f32_16x16x64_bf16 v[40:43], v[12:15], a[64:71], v3
  v_smfmac_f32_16x16x64_bf16 v[44:47], v[12:15], a[120:127], v3
  v_smfmac_f32_16x16x64_bf16 v[48:51], v[12:15], a[176:183], v3
  v_smfmac_f32_16x16x64_bf16 v[52:55], v[12:15], a[232:239], v3
  v_smfmac_f32_16x16x64_bf16 v[56:59], v[12:15], v[152:159], v3
  v_smfmac_f32_16x16x64_bf16 v[60:63], v[12:15], v[208:215], v3
  v_smfmac_f32_16x16x64_bf16 v[36:39], v[16:19], a[16:23], v3
  v_smfmac_f32_16x16x64_bf16 v[40:43], v[16:19], a[72:79], v3
  v_smfmac_f32_16x16x64_bf16 v[44:47], v[16:19], a[128:135], v3
  v_smfmac_f32_16x16x64_bf16 v[48:51], v[16:19], a[184:191], v3
  v_smfmac_f32_16x16x64_bf16 v[52:55], v[16:19], a[240:247], v3
  v_smfmac_f32_16x16x64_bf16 v[56:59], v[16:19], v[160:167], v3
  v_smfmac_f32_16x16x64_bf16 v[60:63], v[16:19], v[216:223], v3
  v_smfmac_f32_16x16x64_bf16 v[36:39], v[20:23], a[24:31], v3
  v_smfmac_f32_16x16x64_bf16 v[40:43], v[20:23], a[80:87], v3
  v_smfmac_f32_16x16x64_bf16 v[44:47], v[20:23], a[136:143], v3
  v_smfmac_f32_16x16x64_bf16 v[48:51], v[20:23], a[192:199], v3
  v_smfmac_f32_16x16x64_bf16 v[52:55], v[20:23], a[248:255], v3
  v_smfmac_f32_16x16x64_bf16 v[56:59], v[20:23], v[168:175], v3
  v_smfmac_f32_16x16x64_bf16 v[60:63], v[20:23], v[224:231], v3
  s_branch cA_sc0_ph2
.p2align 6

cA_sc1_loop:
  s_add_u32 s23, s20, 4096
  s_add_u32 s21, s20, 25600
  v_mov_b32 v48, 0
  v_mov_b32 v49, 0
  v_mov_b32 v50, 0
  v_mov_b32 v51, 0
  v_mov_b32 v52, 0
  v_mov_b32 v53, 0
  v_mov_b32 v54, 0
  v_mov_b32 v55, 0
  v_mov_b32 v56, 0
  v_mov_b32 v57, 0
  v_mov_b32 v58, 0
  v_mov_b32 v59, 0
  v_mov_b32 v60, 0
  v_mov_b32 v61, 0
  v_mov_b32 v62, 0
  v_mov_b32 v63, 0
  v_mov_b32 v88, 0
  v_mov_b32 v89, 0
  v_mov_b32 v90, 0
  v_mov_b32 v91, 0
  v_mov_b32 v92, 0
  v_mov_b32 v93, 0
  v_mov_b32 v94, 0
  v_mov_b32 v95, 0
  v_mov_b32 v64, 0
  v_mov_b32 v65, 0
  s_mov_b32 s30, 0
  s_mov_b32 s62, 0
  s_waitcnt vmcnt(0)
  s_barrier
cA_sc1_ld:
  buffer_load_dwordx4 v[8:11], v2, s[8:11], s20 offen offset:0
  v_mov_b32 v36, 0
  v_mov_b32 v37, 0
  v_mov_b32 v38, 0
  v_mov_b32 v39, 0
  buffer_load_dwordx4 v[12:15], v2, s[8:11], s20 offen offset:1024
  v_mov_b32 v40, 0
  v_mov_b32 v41, 0
  v_mov_b32 v42, 0
  v_mov_b32 v43, 0
  buffer_load_dwordx4 v[16:19], v2, s[8:11], s20 offen offset:2048
  v_mov_b32 v44, 0
  v_mov_b32 v45, 0
  v_mov_b32 v46, 0
  v_mov_b32 v47, 0
  ds_read_b128 v[96:99], v117 offset:0
  ds_read_b128 v[100:103], v117 offset:1024
  ds_read_b128 v[104:107], v117 offset:14336
  ds_read_b128 v[108:111], v117 offset:15360
  s_waitcnt vmcnt(2)
  v_smfmac_f32_16x16x64_bf16 v[36:39], v[8:11], a[0:7], v3
  v_smfmac_f32_16x16x64_bf16 v[40:43], v[8:11], a[56:63], v3
  buffer_load_dwordx4 v[20:23], v2, s[8:11], s20 offen offset:3072
  v_smfmac_f32_16x16x64_bf16 v[44:47], v[8:11], a[112:119], v3
  v_smfmac_f32_16x16x64_bf16 v[48:51], v[8:11], a[168:175], v3
  v_smfmac_f32_16x16x64_bf16 v[52:55], v[8:11], a[224:231], v3
  buffer_load_dwordx4 v[24:27], v2, s[8:11], s23 offen offset:0
  v_smfmac_f32_16x16x64_bf16 v[56:59], v[8:11], v[144:151], v3
  v_smfmac_f32_16x16x64_bf16 v[60:63], v[8:11], v[200:207], v3
  s_waitcnt vmcnt(3)
  v_smfmac_f32_16x16x64_bf16 v[36:39], v[12:15], a[8:15], v3
  v_smfmac_f32_16x16x64_bf16 v[40:43], v[12:15], a[64:71], v3
  buffer_load_dwordx4 v[28:31], v2, s[8:11], s23 offen offset:1024
  v_smfmac_f32_16x16x64_bf16 v[44:47], v[12:15], a[120:127], v3
  v_smfmac_f32_16x16x64_bf16 v[48:51], v[12:15], a[176:183], v3
  v_smfmac_f32_16x16x64_bf16 v[52:55], v[12:15], a[232:239], v3
  buffer_load_dwordx4 v[32:35], v2, s[8:11], s23 offen offset:2048
  v_smfmac_f32_16x16x64_bf16 v[56:59], v[12:15], v[152:159], v3
  v_smfmac_f32_16x16x64_bf16 v[60:63], v[12:15], v[208:215], v3
  s_waitcnt vmcnt(4)
  v_smfmac_f32_16x16x64_bf16 v[36:39], v[16:19], a[16:23], v3
  v_smfmac_f32_16x16x64_bf16 v[40:43], v[16:19], a[72:79], v3
  v_smfmac_f32_16x16x64_bf16 v[44:47], v[16:19], a[128:135], v3
  v_smfmac_f32_16x16x64_bf16 v[48:51], v[16:19], a[184:191], v3
  v_smfmac_f32_16x16x64_bf16 v[52:55], v[16:19], a[240:247], v3
  v_smfmac_f32_16x16x64_bf16 v[56:59], v[16:19], v[160:167], v3
  v_smfmac_f32_16x16x64_bf16 v[60:63], v[16:19], v[216:223], v3
  s_waitcnt vmcnt(3)
  v_smfmac_f32_16x16x64_bf16 v[36:39], v[20:23], a[24:31], v3
  v_smfmac_f32_16x16x64_bf16 v[40:43], v[20:23], a[80:87], v3
  v_smfmac_f32_16x16x64_bf16 v[44:47], v[20:23], a[136:143], v3
  v_smfmac_f32_16x16x64_bf16 v[48:51], v[20:23], a[192:199], v3
  v_smfmac_f32_16x16x64_bf16 v[52:55], v[20:23], a[248:255], v3
  v_smfmac_f32_16x16x64_bf16 v[56:59], v[20:23], v[168:175], v3
  v_smfmac_f32_16x16x64_bf16 v[60:63], v[20:23], v[224:231], v3
  s_waitcnt vmcnt(0)
cA_sc1_ph2:
  v_smfmac_f32_16x16x64_bf16 v[60:63], v[24:27], v[232:239], v3
  ds_read_b128 v[16:19], v116 offset:2048
  ds_read_b128 v[20:23], v116 offset:3072
  v_smfmac_f32_16x16x64_bf16 v[60:63], v[28:31], v[240:247], v3
  buffer_load_dword v119, v0, s[8:11], s20 offen sc1
  v_smfmac_f32_16x16x64_bf16 v[60:63], v[32:35], v[248:255], v3
  v_mov_b32 v80, v26
  v_smfmac_f32_16x16x64_bf16 v[52:55], v[24:27], v[120:127], v3
  v_mov_b32 v81, v27
  v_smfmac_f32_16x16x64_bf16 v[52:55], v[28:31], v[128:135], v3
  v_mov_b32 v82, v32
  v_smfmac_f32_16x16x64_bf16 v[52:55], v[32:35], v[136:143], v3
  v_cvt_pk_bf16_f32 v66, v60, v61
  v_smfmac_f32_16x16x64_bf16 v[56:59], v[24:27], v[176:183], v3
  v_cvt_pk_bf16_f32 v67, v62, v63
  v_smfmac_f32_16x16x64_bf16 v[56:59], v[28:31], v[184:191], v3
  v_mov_b32 v83, v33
  v_mfma_f32_16x16x32_bf16 v[68:71], v[64:67], v[4:7], 0
  v_smfmac_f32_16x16x64_bf16 v[56:59], v[32:35], v[192:199], v3
  v_cvt_pk_bf16_f32 v64, v52, v53
  v_smfmac_f32_16x16x64_bf16 v[36:39], v[24:27], a[32:39], v3
  v_cvt_pk_bf16_f32 v65, v54, v55
  v_smfmac_f32_16x16x64_bf16 v[36:39], v[28:31], a[40:47], v3
  v_cvt_pk_bf16_f32 v78, v68, v69
  v_smfmac_f32_16x16x64_bf16 v[36:39], v[32:35], a[48:55], v3
  v_cvt_pk_bf16_f32 v79, v70, v71
  v_cvt_pk_bf16_f32 v66, v56, v57
  v_smfmac_f32_16x16x64_bf16 v[40:43], v[24:27], a[88:95], v3
  v_cvt_pk_bf16_f32 v67, v58, v59
  v_smfmac_f32_16x16x64_bf16 v[40:43], v[28:31], a[96:103], v3
  v_mfma_f32_16x16x32_bf16 v[72:75], v[64:67], v[4:7], 0
  ds_read_b128 v[52:55], v116 offset:16384
  ds_read_b128 v[56:59], v116 offset:17408
  v_smfmac_f32_16x16x64_bf16 v[40:43], v[32:35], a[104:111], v3
  v_cvt_pk_bf16_f32 v64, v36, v37
  v_smfmac_f32_16x16x64_bf16 v[44:47], v[24:27], a[144:151], v3
  v_cvt_pk_bf16_f32 v65, v38, v39
  v_smfmac_f32_16x16x64_bf16 v[44:47], v[28:31], a[152:159], v3
  v_cvt_pk_bf16_f32 v76, v72, v73
  v_smfmac_f32_16x16x64_bf16 v[44:47], v[32:35], a[160:167], v3
  v_cvt_pk_bf16_f32 v77, v74, v75
  v_cvt_pk_bf16_f32 v66, v40, v41
  v_smfmac_f32_16x16x64_bf16 v[48:51], v[24:27], a[200:207], v3
  v_cvt_pk_bf16_f32 v67, v42, v43
  v_smfmac_f32_16x16x64_bf16 v[48:51], v[28:31], a[208:215], v3
  v_mfma_f32_16x16x32_bf16 v[68:71], v[64:67], v[4:7], 0
  v_smfmac_f32_16x16x64_bf16 v[48:51], v[32:35], a[216:223], v3
  v_cvt_pk_bf16_f32 v64, v44, v45
  v_mfma_f32_16x16x32_bf16 v[84:87], v[80:83], v[76:79], 0
  v_cvt_pk_bf16_f32 v65, v46, v47
  s_waitcnt lgkmcnt(0)
  v_smfmac_f32_16x16x64_bf16 v[88:91], v[76:79], v[96:103], v3
  v_cvt_pk_bf16_f32 v60, v68, v69
  v_cvt_pk_bf16_f32 v61, v70, v71
  v_cvt_pk_bf16_f32 v66, v48, v49
  v_cvt_pk_bf16_f32 v67, v50, v51
  s_nop 1
  v_mfma_f32_16x16x32_bf16 v[72:75], v[64:67], v[4:7], 0
  v_smfmac_f32_16x16x64_bf16 v[92:95], v[76:79], v[104:111], v3
  s_nop 4
  v_cvt_pk_bf16_f32 v62, v72, v73
  v_cvt_pk_bf16_f32 v63, v74, v75
  s_nop 1
  v_mfma_f32_16x16x32_bf16 v[84:87], v[12:15], v[60:63], v[84:87]
  v_smfmac_f32_16x16x64_bf16 v[88:91], v[60:63], v[16:23], v3
  v_smfmac_f32_16x16x64_bf16 v[92:95], v[60:63], v[52:59], v3
  s_mov_b64 exec, s[26:27]
  s_nop 0
  ds_write_b128 v113, v[84:87]
  s_mov_b64 exec, -1
  s_nop 0
  v_cmp_u_f32 vcc, v88, v89
  s_nop 1
  v_permlane32_swap_b32 v88, v92
  v_permlane32_swap_b32 v89, v93
  v_permlane32_swap_b32 v90, v94
  v_permlane32_swap_b32 v91, v95
  v_add_f32 v88, v88, v92
  v_add_f32 v89, v89, v93
  v_add_f32 v90, v90, v94
  v_add_f32 v91, v91, v95
  ds_write_b128 v112, v[88:91]
  s_cbranch_vccnz cA_sc1_retry
cA_sc1_cont:
  s_waitcnt lgkmcnt(0)
  s_barrier
  ds_read_b64 v[36:37], v114 offset:0
  ds_read_b64 v[38:39], v114 offset:1024
  ds_read2_b32 v[44:45], v115 offset0:0 offset1:64
  s_waitcnt lgkmcnt(0)
  v_add_f32 v44, v44, v45
  v_add_f32 v36, v36, v38
  v_add_f32 v37, v37, v39
  v_add_f32_dpp v44, v44, v44 row_ror:8 row_mask:0xf bank_mask:0xf
  v_mov_b32 v45, v44
  v_permlane32_swap_b32 v36, v37
  v_add_f32 v36, v36, v37
  v_permlane16_swap_b32 v44, v45
  v_add_f32 v44, v44, v45
  v_exp_f32 v48, v36
  v_exp_f32 v49, v44
  v_add_f32 v50, abs(v36), abs(v44)
  v_fma_f32 v39, v49, s37, v48
  v_cmp_ngt_f32 vcc, s56, v50
  v_cndmask_b32 v41, v48, v49, s[38:39]
  v_add_f32_dpp v39, v39, v39 quad_perm:[1,0,3,2] row_mask:0xf bank_mask:0xf
  v_cndmask_b32 v40, v49, v48, s[38:39]
  v_mov_b32_dpp v46, v41 quad_perm:[1,0,3,2] row_mask:0xf bank_mask:0xf
  v_add_f32_dpp v39, v39, v39 quad_perm:[2,3,0,1] row_mask:0xf bank_mask:0xf
  v_cndmask_b32 v42, v46, v40, s[38:39]
  v_cndmask_b32 v43, v40, v46, s[38:39]
  v_add_f32_dpp v39, v39, v39 row_half_mirror row_mask:0xf bank_mask:0xf
  s_cbranch_vccnz cA_sc1_slow
  s_nop 0
  v_add_f32_dpp v39, v39, v39 row_mirror row_mask:0xf bank_mask:0xf
  v_mov_b32 v47, v39
  s_nop 1
  v_permlane16_swap_b32 v39, v47
  v_add_f32 v39, v39, v47
  v_rcp_f32 v39, v39
  s_mov_b64 exec, s[28:29]
  v_mul_f32 v42, v42, v39
  v_mul_f32 v43, v43, v39
  v_cvt_pk_bf16_f32 v42, v42, v43
cA_sc1_pst:
  buffer_store_dword v42, v1, s[8:11], s20 offen
  s_mov_b64 exec, -1
  s_barrier
  s_add_u32 s24, s24, 28672
  s_add_u32 s35, s35, 28672
  s_xor_b32 s25, s25, 28672
  s_add_u32 m0, s25, 7168
  s_nop 0
  buffer_load_dwordx4 v2, s[8:11], s24 offen offset:0 sc1 lds
  buffer_load_dwordx4 v2, s[8:11], s24 offen offset:1024 sc1 lds
  buffer_load_dwordx4 v2, s[8:11], s24 offen offset:2048 sc1 lds
  buffer_load_dwordx4 v2, s[8:11], s24 offen offset:3072 sc1 lds
  s_add_u32 m0, s25, 11264
  s_add_u32 s22, s24, 4096
  buffer_load_dwordx4 v2, s[8:11], s22 offen offset:0 sc1 lds
  buffer_load_dwordx4 v2, s[8:11], s22 offen offset:1024 sc1 lds
  buffer_load_dwordx4 v2, s[8:11], s22 offen offset:2048 sc1 lds
  v_xor_b32 v116, 28672, v116
  v_add_u32 v117, s57, v117
  s_sub_u32 s57, 0, s57
  s_add_u32 s19, s19, 1
  s_mov_b32 s20, s21
  s_cmp_lt_u32 s19, 63
  s_cbranch_scc1 cA_sc1_loop
  s_branch cA_done
cA_sc1_slow:
  v_max_f32 v50, v36, v44
  s_nop 1
  v_max_f32_dpp v50, v50, v50 quad_perm:[1,0,3,2] row_mask:0xf bank_mask:0xf
  s_nop 1
  v_max_f32_dpp v50, v50, v50 quad_perm:[2,3,0,1] row_mask:0xf bank_mask:0xf
  s_nop 1
  v_max_f32_dpp v50, v50, v50 row_half_mirror row_mask:0xf bank_mask:0xf
  s_nop 1
  v_max_f32_dpp v50, v50, v50 row_mirror row_mask:0xf bank_mask:0xf
  v_mov_b32 v47, v50
  s_nop 1
  v_permlane16_swap_b32 v50, v47
  v_max_f32 v50, v50, v47
  v_sub_f32 v48, v36, v50
  v_sub_f32 v49, v44, v50
  v_exp_f32 v48, v48
  v_exp_f32 v49, v49
  s_add_u32 s31, s31, 0x100
  v_fma_f32 v39, v49, s37, v48
  v_cndmask_b32 v41, v48, v49, s[38:39]
  s_nop 0
  v_add_f32_dpp v39, v39, v39 quad_perm:[1,0,3,2] row_mask:0xf bank_mask:0xf
  v_cndmask_b32 v40, v49, v48, s[38:39]
  v_mov_b32_dpp v46, v41 quad_perm:[1,0,3,2] row_mask:0xf bank_mask:0xf
  v_add_f32_dpp v39, v39, v39 quad_perm:[2,3,0,1] row_mask:0xf bank_mask:0xf
  v_cndmask_b32 v42, v46, v40, s[38:39]
  v_cndmask_b32 v43, v40, v46, s[38:39]
  v_add_f32_dpp v39, v39, v39 row_half_mirror row_mask:0xf bank_mask:0xf
  s_nop 1
  v_add_f32_dpp v39, v39, v39 row_mirror row_mask:0xf bank_mask:0xf
  v_mov_b32 v47, v39
  s_nop 1
  v_permlane16_swap_b32 v39, v47
  v_add_f32 v39, v39, v47
  v_rcp_f32 v39, v39
  s_mov_b64 exec, s[28:29]
  v_mul_f32 v42, v42, v39
  v_mul_f32 v43, v43, v39
  v_cvt_pk_bf16_f32 v42, v42, v43
  v_min_u32 v42, -2, v42
  s_branch cA_sc1_pst
cA_sc1_retry:
  s_cmp_lg_u32 s62, 0
  s_cbranch_scc1 cA_sc1_cont
  s_waitcnt vmcnt(0) lgkmcnt(0)
cA_sc1_rv:
  buffer_load_dwordx4 v[8:11], v2, s[8:11], s20 offen offset:0 sc1
  buffer_load_dwordx4 v[12:15], v2, s[8:11], s20 offen offset:1024 sc1
  buffer_load_dwordx4 v[16:19], v2, s[8:11], s20 offen offset:2048 sc1
  buffer_load_dwordx4 v[20:23], v2, s[8:11], s20 offen offset:3072 sc1
  buffer_load_dwordx4 v[24:27], v2, s[8:11], s23 offen offset:0 sc1
  buffer_load_dwordx4 v[28:31], v2, s[8:11], s23 offen offset:1024 sc1
  buffer_load_dwordx4 v[32:35], v2, s[8:11], s23 offen offset:2048 sc1
  s_waitcnt vmcnt(0)
  v_max3_u32 v118, v8, v9, v10
  v_max3_u32 v118, v118, v11, v12
  v_max3_u32 v118, v118, v13, v14
  v_max3_u32 v118, v118, v15, v16
  v_max3_u32 v118, v118, v17, v18
  v_max3_u32 v118, v118, v19, v20
  v_max3_u32 v118, v118, v21, v22
  v_max3_u32 v118, v118, v23, v24
  v_max3_u32 v118, v118, v25, v26
  v_max3_u32 v118, v118, v27, v28
  v_max3_u32 v118, v118, v29, v30
  v_max3_u32 v118, v118, v31, v32
  v_max3_u32 v118, v118, v33, v34
  v_max_u32 v118, v118, v35
  v_cmp_eq_u32 vcc, -1, v118
  s_cbranch_vccz cA_sc1_rk
  s_add_u32 s30, s30, 1
  s_cmp_lt_u32 s30, 400000
  s_cbranch_scc1 cA_sc1_rv
  s_branch cA_abort
cA_sc1_rk:
  s_mov_b32 s62, 1
  v_mov_b32 v36, 0
  v_mov_b32 v37, 0
  v_mov_b32 v38, 0
  v_mov_b32 v39, 0
  v_mov_b32 v40, 0
  v_mov_b32 v41, 0
  v_mov_b32 v42, 0
  v_mov_b32 v43, 0
  v_mov_b32 v44, 0
  v_mov_b32 v45, 0
  v_mov_b32 v46, 0
  v_mov_b32 v47, 0
  v_mov_b32 v48, 0
  v_mov_b32 v49, 0
  v_mov_b32 v50, 0
  v_mov_b32 v51, 0
  v_mov_b32 v52, 0
  v_mov_b32 v53, 0
  v_mov_b32 v54, 0
  v_mov_b32 v55, 0
  v_mov_b32 v56, 0
  v_mov_b32 v57, 0
  v_mov_b32 v58, 0
  v_mov_b32 v59, 0
  v_mov_b32 v60, 0
  v_mov_b32 v61, 0
  v_mov_b32 v62, 0
  v_mov_b32 v63, 0
  v_mov_b32 v88, 0
  v_mov_b32 v89, 0
  v_mov_b32 v90, 0
  v_mov_b32 v91, 0
  v_mov_b32 v92, 0
  v_mov_b32 v93, 0
  v_mov_b32 v94, 0
  v_mov_b32 v95, 0
  v_mov_b32 v64, 0
  v_mov_b32 v65, 0
  s_add_u32 s31, s31, 1
  ds_read_b128 v[96:99], v117 offset:0
  ds_read_b128 v[100:103], v117 offset:1024
  ds_read_b128 v[104:107], v117 offset:14336
  ds_read_b128 v[108:111], v117 offset:15360
  v_smfmac_f32_16x16x64_bf16 v[36:39], v[8:11], a[0:7], v3
  v_smfmac_f32_16x16x64_bf16 v[40:43], v[8:11], a[56:63], v3
  v_smfmac_f32_16x16x64_bf16 v[44:47], v[8:11], a[112:119], v3
  v_smfmac_f32_16x16x64_bf16 v[48:51], v[8:11], a[168:175], v3
  v_smfmac_f32_16x16x64_bf16 v[52:55], v[8:11], a[224:231], v3
  v_smfmac_f32_16x16x64_bf16 v[56:59], v[8:11], v[144:151], v3
  v_smfmac_f32_16x16x64_bf16 v[60:63], v[8:11], v[200:207], v3
  v_smfmac_f32_16x16x64_bf16 v[36:39], v[12:15], a[8:15], v3
  v_smfmac_f32_16x16x64_bf16 v[40:43], v[12:15], a[64:71], v3
  v_smfmac_f32_16x16x64_bf16 v[44:47], v[12:15], a[120:127], v3
  v_smfmac_f32_16x16x64_bf16 v[48:51], v[12:15], a[176:183], v3
  v_smfmac_f32_16x16x64_bf16 v[52:55], v[12:15], a[232:239], v3
  v_smfmac_f32_16x16x64_bf16 v[56:59], v[12:15], v[152:159], v3
  v_smfmac_f32_16x16x64_bf16 v[60:63], v[12:15], v[208:215], v3
  v_smfmac_f32_16x16x64_bf16 v[36:39], v[16:19], a[16:23], v3
  v_smfmac_f32_16x16x64_bf16 v[40:43], v[16:19], a[72:79], v3
  v_smfmac_f32_16x16x64_bf16 v[44:47], v[16:19], a[128:135], v3
  v_smfmac_f32_16x16x64_bf16 v[48:51], v[16:19], a[184:191], v3
  v_smfmac_f32_16x16x64_bf16 v[52:55], v[16:19], a[240:247], v3
  v_smfmac_f32_16x16x64_bf16 v[56:59], v[16:19], v[160:167], v3
  v_smfmac_f32_16x16x64_bf16 v[60:63], v[16:19], v[216:223], v3
  v_smfmac_f32_16x16x64_bf16 v[36:39], v[20:23], a[24:31], v3
  v_smfmac_f32_16x16x64_bf16 v[40:43], v[20:23], a[80:87], v3
  v_smfmac_f32_16x16x64_bf16 v[44:47], v[20:23], a[136:143], v3
  v_smfmac_f32_16x16x64_bf16 v[48:51], v[20:23], a[192:199], v3
  v_smfmac_f32_16x16x64_bf16 v[52:55], v[20:23], a[248:255], v3
  v_smfmac_f32_16x16x64_bf16 v[56:59], v[20:23], v[168:175], v3
  v_smfmac_f32_16x16x64_bf16 v[60:63], v[20:23], v[224:231], v3
  s_branch cA_sc1_ph2
.p2align 6

cA_sc2_loop:
  s_add_u32 s23, s20, 4096
  s_add_u32 s21, s20, 25600
  v_mov_b32 v48, 0
  v_mov_b32 v49, 0
  v_mov_b32 v50, 0
  v_mov_b32 v51, 0
  v_mov_b32 v52, 0
  v_mov_b32 v53, 0
  v_mov_b32 v54, 0
  v_mov_b32 v55, 0
  v_mov_b32 v56, 0
  v_mov_b32 v57, 0
  v_mov_b32 v58, 0
  v_mov_b32 v59, 0
  v_mov_b32 v60, 0
  v_mov_b32 v61, 0
  v_mov_b32 v62, 0
  v_mov_b32 v63, 0
  v_mov_b32 v88, 0
  v_mov_b32 v89, 0
  v_mov_b32 v90, 0
  v_mov_b32 v91, 0
  v_mov_b32 v92, 0
  v_mov_b32 v93, 0
  v_mov_b32 v94, 0
  v_mov_b32 v95, 0
  v_mov_b32 v66, 0
  v_mov_b32 v67, 0
  s_mov_b32 s30, 0
  s_mov_b32 s62, 0
  s_waitcnt vmcnt(0)
  s_barrier
cA_sc2_ld:
  buffer_load_dwordx4 v[8:11], v2, s[8:11], s20 offen offset:0
  v_mov_b32 v36, 0
  v_mov_b32 v37, 0
  v_mov_b32 v38, 0
  v_mov_b32 v39, 0
  buffer_load_dwordx4 v[12:15], v2, s[8:11], s20 offen offset:1024
  v_mov_b32 v40, 0
  v_mov_b32 v41, 0
  v_mov_b32 v42, 0
  v_mov_b32 v43, 0
  buffer_load_dwordx4 v[16:19], v2, s[8:11], s20 offen offset:2048
  v_mov_b32 v44, 0
  v_mov_b32 v45, 0
  v_mov_b32 v46, 0
  v_mov_b32 v47, 0
  ds_read_b128 v[96:99], v117 offset:0
  ds_read_b128 v[100:103], v117 offset:1024
  ds_read_b128 v[104:107], v117 offset:14336
  ds_read_b128 v[108:111], v117 offset:15360
  s_waitcnt vmcnt(2)
  v_smfmac_f32_16x16x64_bf16 v[36:39], v[8:11], a[0:7], v3
  v_smfmac_f32_16x16x64_bf16 v[40:43], v[8:11], a[56:63], v3
  buffer_load_dwordx4 v[20:23], v2, s[8:11], s20 offen offset:3072
  v_smfmac_f32_16x16x64_bf16 v[44:47], v[8:11], a[112:119], v3
  v_smfmac_f32_16x16x64_bf16 v[48:51], v[8:11], a[168:175], v3
  v_smfmac_f32_16x16x64_bf16 v[52:55], v[8:11], a[224:231], v3
  buffer_load_dwordx4 v[24:27], v2, s[8:11], s23 offen offset:0
  v_smfmac_f32_16x16x64_bf16 v[56:59], v[8:11], v[144:151], v3
  v_smfmac_f32_16x16x64_bf16 v[60:63], v[8:11], v[200:207], v3
  s_waitcnt vmcnt(3)
  v_smfmac_f32_16x16x64_bf16 v[36:39], v[12:15], a[8:15], v3
  v_smfmac_f32_16x16x64_bf16 v[40:43], v[12:15], a[64:71], v3
  buffer_load_dwordx4 v[28:31], v2, s[8:11], s23 offen offset:1024
  v_smfmac_f32_16x16x64_bf16 v[44:47], v[12:15], a[120:127], v3
  v_smfmac_f32_16x16x64_bf16 v[48:51], v[12:15], a[176:183], v3
  v_smfmac_f32_16x16x64_bf16 v[52:55], v[12:15], a[232:239], v3
  buffer_load_dwordx4 v[32:35], v2, s[8:11], s23 offen offset:2048
  v_smfmac_f32_16x16x64_bf16 v[56:59], v[12:15], v[152:159], v3
  v_smfmac_f32_16x16x64_bf16 v[60:63], v[12:15], v[208:215], v3
  s_waitcnt vmcnt(4)
  v_smfmac_f32_16x16x64_bf16 v[36:39], v[16:19], a[16:23], v3
  v_smfmac_f32_16x16x64_bf16 v[40:43], v[16:19], a[72:79], v3
  v_smfmac_f32_16x16x64_bf16 v[44:47], v[16:19], a[128:135], v3
  v_smfmac_f32_16x16x64_bf16 v[48:51], v[16:19], a[184:191], v3
  v_smfmac_f32_16x16x64_bf16 v[52:55], v[16:19], a[240:247], v3
  v_smfmac_f32_16x16x64_bf16 v[56:59], v[16:19], v[160:167], v3
  v_smfmac_f32_16x16x64_bf16 v[60:63], v[16:19], v[216:223], v3
  s_waitcnt vmcnt(3)
  v_smfmac_f32_16x16x64_bf16 v[36:39], v[20:23], a[24:31], v3
  v_smfmac_f32_16x16x64_bf16 v[40:43], v[20:23], a[80:87], v3
  v_smfmac_f32_16x16x64_bf16 v[44:47], v[20:23], a[136:143], v3
  v_smfmac_f32_16x16x64_bf16 v[48:51], v[20:23], a[192:199], v3
  v_smfmac_f32_16x16x64_bf16 v[52:55], v[20:23], a[248:255], v3
  v_smfmac_f32_16x16x64_bf16 v[56:59], v[20:23], v[168:175], v3
  v_smfmac_f32_16x16x64_bf16 v[60:63], v[20:23], v[224:231], v3
  s_waitcnt vmcnt(0)
cA_sc2_ph2:
  v_smfmac_f32_16x16x64_bf16 v[60:63], v[24:27], v[232:239], v3
  ds_read_b128 v[8:11], v116 offset:4096
  ds_read_b128 v[12:15], v116 offset:5120
  v_smfmac_f32_16x16x64_bf16 v[60:63], v[28:31], v[240:247], v3
  buffer_load_dword v119, v0, s[8:11], s24 offen sc1
  v_smfmac_f32_16x16x64_bf16 v[60:63], v[32:35], v[248:255], v3
  v_mov_b32 v80, v28
  v_smfmac_f32_16x16x64_bf16 v[52:55], v[24:27], v[120:127], v3
  v_mov_b32 v81, v29
  v_smfmac_f32_16x16x64_bf16 v[52:55], v[28:31], v[128:135], v3
  v_mov_b32 v82, v34
  v_smfmac_f32_16x16x64_bf16 v[52:55], v[32:35], v[136:143], v3
  v_cvt_pk_bf16_f32 v64, v60, v61
  v_smfmac_f32_16x16x64_bf16 v[56:59], v[24:27], v[176:183], v3
  v_cvt_pk_bf16_f32 v65, v62, v63
  v_smfmac_f32_16x16x64_bf16 v[56:59], v[28:31], v[184:191], v3
  v_mov_b32 v83, v35
  v_mfma_f32_16x16x32_bf16 v[68:71], v[64:67], v[4:7], 0
  v_smfmac_f32_16x16x64_bf16 v[56:59], v[32:35], v[192:199], v3
  v_cvt_pk_bf16_f32 v64, v52, v53
  v_smfmac_f32_16x16x64_bf16 v[36:39], v[24:27], a[32:39], v3
  v_cvt_pk_bf16_f32 v65, v54, v55
  v_smfmac_f32_16x16x64_bf16 v[36:39], v[28:31], a[40:47], v3
  v_cvt_pk_bf16_f32 v78, v68, v69
  v_smfmac_f32_16x16x64_bf16 v[36:39], v[32:35], a[48:55], v3
  v_cvt_pk_bf16_f32 v79, v70, v71
  v_cvt_pk_bf16_f32 v66, v56, v57
  v_smfmac_f32_16x16x64_bf16 v[40:43], v[24:27], a[88:95], v3
  v_cvt_pk_bf16_f32 v67, v58, v59
  v_smfmac_f32_16x16x64_bf16 v[40:43], v[28:31], a[96:103], v3
  v_mfma_f32_16x16x32_bf16 v[72:75], v[64:67], v[4:7], 0
  ds_read_b128 v[52:55], v116 offset:18432
  ds_read_b128 v[56:59], v116 offset:19456
  v_smfmac_f32_16x16x64_bf16 v[40:43], v[32:35], a[104:111], v3
  v_cvt_pk_bf16_f32 v64, v36, v37
  v_smfmac_f32_16x16x64_bf16 v[44:47], v[24:27], a[144:151], v3
  v_cvt_pk_bf16_f32 v65, v38, v39
  v_smfmac_f32_16x16x64_bf16 v[44:47], v[28:31], a[152:159], v3
  v_cvt_pk_bf16_f32 v76, v72, v73
  v_smfmac_f32_16x16x64_bf16 v[44:47], v[32:35], a[160:167], v3
  v_cvt_pk_bf16_f32 v77, v74, v75
  v_cvt_pk_bf16_f32 v66, v40, v41
  v_smfmac_f32_16x16x64_bf16 v[48:51], v[24:27], a[200:207], v3
  v_cvt_pk_bf16_f32 v67, v42, v43
  v_smfmac_f32_16x16x64_bf16 v[48:51], v[28:31], a[208:215], v3
  v_mfma_f32_16x16x32_bf16 v[68:71], v[64:67], v[4:7], 0
  v_smfmac_f32_16x16x64_bf16 v[48:51], v[32:35], a[216:223], v3
  v_cvt_pk_bf16_f32 v64, v44, v45
  v_mfma_f32_16x16x32_bf16 v[84:87], v[80:83], v[76:79], 0
  v_cvt_pk_bf16_f32 v65, v46, v47
  s_waitcnt lgkmcnt(0)
  v_smfmac_f32_16x16x64_bf16 v[88:91], v[76:79], v[96:103], v3
  v_cvt_pk_bf16_f32 v60, v68, v69
  v_cvt_pk_bf16_f32 v61, v70, v71
  v_cvt_pk_bf16_f32 v66, v48, v49
  v_cvt_pk_bf16_f32 v67, v50, v51
  s_nop 1
  v_mfma_f32_16x16x32_bf16 v[72:75], v[64:67], v[4:7], 0
  v_smfmac_f32_16x16x64_bf16 v[92:95], v[76:79], v[104:111], v3
  s_nop 4
  v_cvt_pk_bf16_f32 v62, v72, v73
  v_cvt_pk_bf16_f32 v63, v74, v75
  s_nop 1
  v_mfma_f32_16x16x32_bf16 v[84:87], v[16:19], v[60:63], v[84:87]
  v_smfmac_f32_16x16x64_bf16 v[88:91], v[60:63], v[8:15], v3
  v_smfmac_f32_16x16x64_bf16 v[92:95], v[60:63], v[52:59], v3
  s_mov_b64 exec, s[26:27]
  s_nop 0
  ds_write_b128 v113, v[84:87]
  s_mov_b64 exec, -1
  s_nop 0
  v_cmp_u_f32 vcc, v88, v89
  s_nop 1
  v_permlane32_swap_b32 v88, v92
  v_permlane32_swap_b32 v89, v93
  v_permlane32_swap_b32 v90, v94
  v_permlane32_swap_b32 v91, v95
  v_add_f32 v88, v88, v92
  v_add_f32 v89, v89, v93
  v_add_f32 v90, v90, v94
  v_add_f32 v91, v91, v95
  ds_write_b128 v112, v[88:91]
  s_cbranch_vccnz cA_sc2_retry
cA_sc2_cont:
  s_waitcnt lgkmcnt(0)
  s_barrier
  ds_read_b64 v[36:37], v114 offset:0
  ds_read_b64 v[38:39], v114 offset:1024
  ds_read2_b32 v[44:45], v115 offset0:0 offset1:64
  v_lshl_add_u32 v56, v2, 3, s36
  s_waitcnt lgkmcnt(0)
  v_add_f32 v44, v44, v45
  v_add_f32 v36, v36, v38
  v_add_f32 v37, v37, v39
  v_add_f32_dpp v44, v44, v44 row_ror:8 row_mask:0xf bank_mask:0xf
  v_mov_b32 v45, v44
  s_mov_b64 exec, 65535
  buffer_store_dword v2, v56, s[8:11], s20 offen
  s_mov_b64 exec, -1
  v_permlane32_swap_b32 v36, v37
  v_add_f32 v36, v36, v37
  v_permlane16_swap_b32 v44, v45
  v_add_f32 v44, v44, v45
  v_exp_f32 v48, v36
  v_exp_f32 v49, v44
  v_add_f32 v50, abs(v36), abs(v44)
  v_fma_f32 v39, v49, s37, v48
  v_cmp_ngt_f32 vcc, s56, v50
  v_cndmask_b32 v41, v48, v49, s[38:39]
  v_add_f32_dpp v39, v39, v39 quad_perm:[1,0,3,2] row_mask:0xf bank_mask:0xf
  v_cndmask_b32 v40, v49, v48, s[38:39]
  v_mov_b32_dpp v46, v41 quad_perm:[1,0,3,2] row_mask:0xf bank_mask:0xf
  v_add_f32_dpp v39, v39, v39 quad_perm:[2,3,0,1] row_mask:0xf bank_mask:0xf
  v_cndmask_b32 v42, v46, v40, s[38:39]
  v_cndmask_b32 v43, v40, v46, s[38:39]
  v_add_f32_dpp v39, v39, v39 row_half_mirror row_mask:0xf bank_mask:0xf
  s_cbranch_vccnz cA_sc2_slow
  s_nop 0
  v_add_f32_dpp v39, v39, v39 row_mirror row_mask:0xf bank_mask:0xf
  v_mov_b32 v47, v39
  s_nop 1
  v_permlane16_swap_b32 v39, v47
  v_add_f32 v39, v39, v47
  v_rcp_f32 v39, v39
  s_mov_b64 exec, s[28:29]
  v_mul_f32 v42, v42, v39
  v_mul_f32 v43, v43, v39
  v_cvt_pk_bf16_f32 v42, v42, v43
cA_sc2_pst:
  buffer_store_dword v42, v1, s[8:11], s20 offen
  s_mov_b64 exec, -1
  s_barrier
  s_add_u32 s24, s24, 28672
  s_add_u32 s35, s35, 28672
  s_xor_b32 s25, s25, 28672
  s_add_u32 m0, s25, 14336
  s_nop 0
  buffer_load_dwordx4 v2, s[8:11], s24 offen offset:0 sc1 lds
  buffer_load_dwordx4 v2, s[8:11], s24 offen offset:1024 sc1 lds
  buffer_load_dwordx4 v2, s[8:11], s24 offen offset:2048 sc1 lds
  buffer_load_dwordx4 v2, s[8:11], s24 offen offset:3072 sc1 lds
  s_add_u32 m0, s25, 18432
  s_add_u32 s22, s24, 4096
  buffer_load_dwordx4 v2, s[8:11], s22 offen offset:0 sc1 lds
  buffer_load_dwordx4 v2, s[8:11], s22 offen offset:1024 sc1 lds
  buffer_load_dwordx4 v2, s[8:11], s22 offen offset:2048 sc1 lds
  v_xor_b32 v116, 28672, v116
  v_add_u32 v117, s57, v117
  s_sub_u32 s57, 0, s57
  s_add_u32 s19, s19, 1
  s_mov_b32 s20, s21
  s_cmp_lt_u32 s19, 63
  s_cbranch_scc1 cA_sc2_loop
  s_branch cA_done
cA_sc2_slow:
  v_max_f32 v50, v36, v44
  s_nop 1
  v_max_f32_dpp v50, v50, v50 quad_perm:[1,0,3,2] row_mask:0xf bank_mask:0xf
  s_nop 1
  v_max_f32_dpp v50, v50, v50 quad_perm:[2,3,0,1] row_mask:0xf bank_mask:0xf
  s_nop 1
  v_max_f32_dpp v50, v50, v50 row_half_mirror row_mask:0xf bank_mask:0xf
  s_nop 1
  v_max_f32_dpp v50, v50, v50 row_mirror row_mask:0xf bank_mask:0xf
  v_mov_b32 v47, v50
  s_nop 1
  v_permlane16_swap_b32 v50, v47
  v_max_f32 v50, v50, v47
  v_sub_f32 v48, v36, v50
  v_sub_f32 v49, v44, v50
  v_exp_f32 v48, v48
  v_exp_f32 v49, v49
  s_add_u32 s31, s31, 0x100
  v_fma_f32 v39, v49, s37, v48
  v_cndmask_b32 v41, v48, v49, s[38:39]
  s_nop 0
  v_add_f32_dpp v39, v39, v39 quad_perm:[1,0,3,2] row_mask:0xf bank_mask:0xf
  v_cndmask_b32 v40, v49, v48, s[38:39]
  v_mov_b32_dpp v46, v41 quad_perm:[1,0,3,2] row_mask:0xf bank_mask:0xf
  v_add_f32_dpp v39, v39, v39 quad_perm:[2,3,0,1] row_mask:0xf bank_mask:0xf
  v_cndmask_b32 v42, v46, v40, s[38:39]
  v_cndmask_b32 v43, v40, v46, s[38:39]
  v_add_f32_dpp v39, v39, v39 row_half_mirror row_mask:0xf bank_mask:0xf
  s_nop 1
  v_add_f32_dpp v39, v39, v39 row_mirror row_mask:0xf bank_mask:0xf
  v_mov_b32 v47, v39
  s_nop 1
  v_permlane16_swap_b32 v39, v47
  v_add_f32 v39, v39, v47
  v_rcp_f32 v39, v39
  s_mov_b64 exec, s[28:29]
  v_mul_f32 v42, v42, v39
  v_mul_f32 v43, v43, v39
  v_cvt_pk_bf16_f32 v42, v42, v43
  v_min_u32 v42, -2, v42
  s_branch cA_sc2_pst
cA_sc2_retry:
  s_cmp_lg_u32 s62, 0
  s_cbranch_scc1 cA_sc2_cont
  s_waitcnt vmcnt(0) lgkmcnt(0)
cA_sc2_rv:
  buffer_load_dwordx4 v[8:11], v2, s[8:11], s20 offen offset:0 sc1
  buffer_load_dwordx4 v[12:15], v2, s[8:11], s20 offen offset:1024 sc1
  buffer_load_dwordx4 v[16:19], v2, s[8:11], s20 offen offset:2048 sc1
  buffer_load_dwordx4 v[20:23], v2, s[8:11], s20 offen offset:3072 sc1
  buffer_load_dwordx4 v[24:27], v2, s[8:11], s23 offen offset:0 sc1
  buffer_load_dwordx4 v[28:31], v2, s[8:11], s23 offen offset:1024 sc1
  buffer_load_dwordx4 v[32:35], v2, s[8:11], s23 offen offset:2048 sc1
  s_waitcnt vmcnt(0)
  v_max3_u32 v118, v8, v9, v10
  v_max3_u32 v118, v118, v11, v12
  v_max3_u32 v118, v118, v13, v14
  v_max3_u32 v118, v118, v15, v16
  v_max3_u32 v118, v118, v17, v18
  v_max3_u32 v118, v118, v19, v20
  v_max3_u32 v118, v118, v21, v22
  v_max3_u32 v118, v118, v23, v24
  v_max3_u32 v118, v118, v25, v26
  v_max3_u32 v118, v118, v27, v28
  v_max3_u32 v118, v118, v29, v30
  v_max3_u32 v118, v118, v31, v32
  v_max3_u32 v118, v118, v33, v34
  v_max_u32 v118, v118, v35
  v_cmp_eq_u32 vcc, -1, v118
  s_cbranch_vccz cA_sc2_rk
  s_add_u32 s30, s30, 1
  s_cmp_lt_u32 s30, 400000
  s_cbranch_scc1 cA_sc2_rv
  s_branch cA_abort
cA_sc2_rk:
  s_mov_b32 s62, 1
  v_mov_b32 v36, 0
  v_mov_b32 v37, 0
  v_mov_b32 v38, 0
  v_mov_b32 v39, 0
  v_mov_b32 v40, 0
  v_mov_b32 v41, 0
  v_mov_b32 v42, 0
  v_mov_b32 v43, 0
  v_mov_b32 v44, 0
  v_mov_b32 v45, 0
  v_mov_b32 v46, 0
  v_mov_b32 v47, 0
  v_mov_b32 v48, 0
  v_mov_b32 v49, 0
  v_mov_b32 v50, 0
  v_mov_b32 v51, 0
  v_mov_b32 v52, 0
  v_mov_b32 v53, 0
  v_mov_b32 v54, 0
  v_mov_b32 v55, 0
  v_mov_b32 v56, 0
  v_mov_b32 v57, 0
  v_mov_b32 v58, 0
  v_mov_b32 v59, 0
  v_mov_b32 v60, 0
  v_mov_b32 v61, 0
  v_mov_b32 v62, 0
  v_mov_b32 v63, 0
  v_mov_b32 v88, 0
  v_mov_b32 v89, 0
  v_mov_b32 v90, 0
  v_mov_b32 v91, 0
  v_mov_b32 v92, 0
  v_mov_b32 v93, 0
  v_mov_b32 v94, 0
  v_mov_b32 v95, 0
  v_mov_b32 v66, 0
  v_mov_b32 v67, 0
  s_add_u32 s31, s31, 1
  ds_read_b128 v[96:99], v117 offset:0
  ds_read_b128 v[100:103], v117 offset:1024
  ds_read_b128 v[104:107], v117 offset:14336
  ds_read_b128 v[108:111], v117 offset:15360
  v_smfmac_f32_16x16x64_bf16 v[36:39], v[8:11], a[0:7], v3
  v_smfmac_f32_16x16x64_bf16 v[40:43], v[8:11], a[56:63], v3
  v_smfmac_f32_16x16x64_bf16 v[44:47], v[8:11], a[112:119], v3
  v_smfmac_f32_16x16x64_bf16 v[48:51], v[8:11], a[168:175], v3
  v_smfmac_f32_16x16x64_bf16 v[52:55], v[8:11], a[224:231], v3
  v_smfmac_f32_16x16x64_bf16 v[56:59], v[8:11], v[144:151], v3
  v_smfmac_f32_16x16x64_bf16 v[60:63], v[8:11], v[200:207], v3
  v_smfmac_f32_16x16x64_bf16 v[36:39], v[12:15], a[8:15], v3
  v_smfmac_f32_16x16x64_bf16 v[40:43], v[12:15], a[64:71], v3
  v_smfmac_f32_16x16x64_bf16 v[44:47], v[12:15], a[120:127], v3
  v_smfmac_f32_16x16x64_bf16 v[48:51], v[12:15], a[176:183], v3
  v_smfmac_f32_16x16x64_bf16 v[52:55], v[12:15], a[232:239], v3
  v_smfmac_f32_16x16x64_bf16 v[56:59], v[12:15], v[152:159], v3
  v_smfmac_f32_16x16x64_bf16 v[60:63], v[12:15], v[208:215], v3
  v_smfmac_f32_16x16x64_bf16 v[36:39], v[16:19], a[16:23], v3
  v_smfmac_f32_16x16x64_bf16 v[40:43], v[16:19], a[72:79], v3
  v_smfmac_f32_16x16x64_bf16 v[44:47], v[16:19], a[128:135], v3
  v_smfmac_f32_16x16x64_bf16 v[48:51], v[16:19], a[184:191], v3
  v_smfmac_f32_16x16x64_bf16 v[52:55], v[16:19], a[240:247], v3
  v_smfmac_f32_16x16x64_bf16 v[56:59], v[16:19], v[160:167], v3
  v_smfmac_f32_16x16x64_bf16 v[60:63], v[16:19], v[216:223], v3
  v_smfmac_f32_16x16x64_bf16 v[36:39], v[20:23], a[24:31], v3
  v_smfmac_f32_16x16x64_bf16 v[40:43], v[20:23], a[80:87], v3
  v_smfmac_f32_16x16x64_bf16 v[44:47], v[20:23], a[136:143], v3
  v_smfmac_f32_16x16x64_bf16 v[48:51], v[20:23], a[192:199], v3
  v_smfmac_f32_16x16x64_bf16 v[52:55], v[20:23], a[248:255], v3
  v_smfmac_f32_16x16x64_bf16 v[56:59], v[20:23], v[168:175], v3
  v_smfmac_f32_16x16x64_bf16 v[60:63], v[20:23], v[224:231], v3
  s_branch cA_sc2_ph2
.p2align 6

cA_sc3_loop:
  s_add_u32 s23, s20, 4096
  s_add_u32 s21, s20, 25600
  v_mov_b32 v48, 0
  v_mov_b32 v49, 0
  v_mov_b32 v50, 0
  v_mov_b32 v51, 0
  v_mov_b32 v52, 0
  v_mov_b32 v53, 0
  v_mov_b32 v54, 0
  v_mov_b32 v55, 0
  v_mov_b32 v56, 0
  v_mov_b32 v57, 0
  v_mov_b32 v58, 0
  v_mov_b32 v59, 0
  v_mov_b32 v60, 0
  v_mov_b32 v61, 0
  v_mov_b32 v62, 0
  v_mov_b32 v63, 0
  v_mov_b32 v88, 0
  v_mov_b32 v89, 0
  v_mov_b32 v90, 0
  v_mov_b32 v91, 0
  v_mov_b32 v92, 0
  v_mov_b32 v93, 0
  v_mov_b32 v94, 0
  v_mov_b32 v95, 0
  v_mov_b32 v64, 0
  v_mov_b32 v65, 0
  s_mov_b32 s30, 0
  s_mov_b32 s62, 0
  s_waitcnt vmcnt(0)
  s_barrier
cA_sc3_ld:
  buffer_load_dwordx4 v[8:11], v2, s[8:11], s20 offen offset:0
  v_mov_b32 v36, 0
  v_mov_b32 v37, 0
  v_mov_b32 v38, 0
  v_mov_b32 v39, 0
  buffer_load_dwordx4 v[12:15], v2, s[8:11], s20 offen offset:1024
  v_mov_b32 v40, 0
  v_mov_b32 v41, 0
  v_mov_b32 v42, 0
  v_mov_b32 v43, 0
  buffer_load_dwordx4 v[16:19], v2, s[8:11], s20 offen offset:2048
  v_mov_b32 v44, 0
  v_mov_b32 v45, 0
  v_mov_b32 v46, 0
  v_mov_b32 v47, 0
  ds_read_b128 v[96:99], v117 offset:0
  ds_read_b128 v[100:103], v117 offset:1024
  ds_read_b128 v[104:107], v117 offset:14336
  ds_read_b128 v[108:111], v117 offset:15360
  s_waitcnt vmcnt(2)
  v_smfmac_f32_16x16x64_bf16 v[36:39], v[8:11], a[0:7], v3
  v_smfmac_f32_16x16x64_bf16 v[40:43], v[8:11], a[56:63], v3
  buffer_load_dwordx4 v[20:23], v2, s[8:11], s20 offen offset:3072
  v_smfmac_f32_16x16x64_bf16 v[44:47], v[8:11], a[112:119], v3
  v_smfmac_f32_16x16x64_bf16 v[48:51], v[8:11], a[168:175], v3
  v_smfmac_f32_16x16x64_bf16 v[52:55], v[8:11], a[224:231], v3
  buffer_load_dwordx4 v[24:27], v2, s[8:11], s23 offen offset:0
  v_smfmac_f32_16x16x64_bf16 v[56:59], v[8:11], v[144:151], v3
  v_smfmac_f32_16x16x64_bf16 v[60:63], v[8:11], v[200:207], v3
  s_waitcnt vmcnt(3)
  v_smfmac_f32_16x16x64_bf16 v[36:39], v[12:15], a[8:15], v3
  v_smfmac_f32_16x16x64_bf16 v[40:43], v[12:15], a[64:71], v3
  buffer_load_dwordx4 v[28:31], v2, s[8:11], s23 offen offset:1024
  v_smfmac_f32_16x16x64_bf16 v[44:47], v[12:15], a[120:127], v3
  v_smfmac_f32_16x16x64_bf16 v[48:51], v[12:15], a[176:183], v3
  v_smfmac_f32_16x16x64_bf16 v[52:55], v[12:15], a[232:239], v3
  buffer_load_dwordx4 v[32:35], v2, s[8:11], s23 offen offset:2048
  v_smfmac_f32_16x16x64_bf16 v[56:59], v[12:15], v[152:159], v3
  v_smfmac_f32_16x16x64_bf16 v[60:63], v[12:15], v[208:215], v3
  s_waitcnt vmcnt(4)
  v_smfmac_f32_16x16x64_bf16 v[36:39], v[16:19], a[16:23], v3
  v_smfmac_f32_16x16x64_bf16 v[40:43], v[16:19], a[72:79], v3
  v_smfmac_f32_16x16x64_bf16 v[44:47], v[16:19], a[128:135], v3
  v_smfmac_f32_16x16x64_bf16 v[48:51], v[16:19], a[184:191], v3
  v_smfmac_f32_16x16x64_bf16 v[52:55], v[16:19], a[240:247], v3
  v_smfmac_f32_16x16x64_bf16 v[56:59], v[16:19], v[160:167], v3
  v_smfmac_f32_16x16x64_bf16 v[60:63], v[16:19], v[216:223], v3
  s_waitcnt vmcnt(3)
  v_smfmac_f32_16x16x64_bf16 v[36:39], v[20:23], a[24:31], v3
  v_smfmac_f32_16x16x64_bf16 v[40:43], v[20:23], a[80:87], v3
  v_smfmac_f32_16x16x64_bf16 v[44:47], v[20:23], a[136:143], v3
  v_smfmac_f32_16x16x64_bf16 v[48:51], v[20:23], a[192:199], v3
  v_smfmac_f32_16x16x64_bf16 v[52:55], v[20:23], a[248:255], v3
  v_smfmac_f32_16x16x64_bf16 v[56:59], v[20:23], v[168:175], v3
  v_smfmac_f32_16x16x64_bf16 v[60:63], v[20:23], v[224:231], v3
  s_waitcnt vmcnt(0)
cA_sc3_ph2:
  v_smfmac_f32_16x16x64_bf16 v[60:63], v[24:27], v[232:239], v3
  ds_read_b128 v[8:11], v116 offset:6144
  ds_read_b128 v[12:15], v116 offset:7168
  v_smfmac_f32_16x16x64_bf16 v[60:63], v[28:31], v[240:247], v3
  v_smfmac_f32_16x16x64_bf16 v[60:63], v[32:35], v[248:255], v3
  v_mov_b32 v80, v30
  v_smfmac_f32_16x16x64_bf16 v[52:55], v[24:27], v[120:127], v3
  v_mov_b32 v81, v31
  v_smfmac_f32_16x16x64_bf16 v[52:55], v[28:31], v[128:135], v3
  v_mov_b32 v82, v34
  v_smfmac_f32_16x16x64_bf16 v[52:55], v[32:35], v[136:143], v3
  v_cvt_pk_bf16_f32 v66, v60, v61
  v_smfmac_f32_16x16x64_bf16 v[56:59], v[24:27], v[176:183], v3
  v_cvt_pk_bf16_f32 v67, v62, v63
  v_smfmac_f32_16x16x64_bf16 v[56:59], v[28:31], v[184:191], v3
  v_mov_b32 v83, v35
  v_mfma_f32_16x16x32_bf16 v[68:71], v[64:67], v[4:7], 0
  v_smfmac_f32_16x16x64_bf16 v[56:59], v[32:35], v[192:199], v3
  v_cvt_pk_bf16_f32 v64, v52, v53
  v_smfmac_f32_16x16x64_bf16 v[36:39], v[24:27], a[32:39], v3
  v_cvt_pk_bf16_f32 v65, v54, v55
  v_smfmac_f32_16x16x64_bf16 v[36:39], v[28:31], a[40:47], v3
  v_cvt_pk_bf16_f32 v78, v68, v69
  v_smfmac_f32_16x16x64_bf16 v[36:39], v[32:35], a[48:55], v3
  v_cvt_pk_bf16_f32 v79, v70, v71
  v_cvt_pk_bf16_f32 v66, v56, v57
  v_smfmac_f32_16x16x64_bf16 v[40:43], v[24:27], a[88:95], v3
  v_cvt_pk_bf16_f32 v67, v58, v59
  v_smfmac_f32_16x16x64_bf16 v[40:43], v[28:31], a[96:103], v3
  v_mfma_f32_16x16x32_bf16 v[72:75], v[64:67], v[4:7], 0
  ds_read_b128 v[52:55], v116 offset:20480
  ds_read_b128 v[56:59], v116 offset:21504
  v_smfmac_f32_16x16x64_bf16 v[40:43], v[32:35], a[104:111], v3
  v_cvt_pk_bf16_f32 v64, v36, v37
  v_smfmac_f32_16x16x64_bf16 v[44:47], v[24:27], a[144:151], v3
  v_cvt_pk_bf16_f32 v65, v38, v39
  v_smfmac_f32_16x16x64_bf16 v[44:47], v[28:31], a[152:159], v3
  v_cvt_pk_bf16_f32 v76, v72, v73
  v_smfmac_f32_16x16x64_bf16 v[44:47], v[32:35], a[160:167], v3
  v_cvt_pk_bf16_f32 v77, v74, v75
  v_cvt_pk_bf16_f32 v66, v40, v41
  v_smfmac_f32_16x16x64_bf16 v[48:51], v[24:27], a[200:207], v3
  v_cvt_pk_bf16_f32 v67, v42, v43
  v_smfmac_f32_16x16x64_bf16 v[48:51], v[28:31], a[208:215], v3
  v_mfma_f32_16x16x32_bf16 v[68:71], v[64:67], v[4:7], 0
  v_smfmac_f32_16x16x64_bf16 v[48:51], v[32:35], a[216:223], v3
  v_cvt_pk_bf16_f32 v64, v44, v45
  v_mfma_f32_16x16x32_bf16 v[84:87], v[80:83], v[76:79], 0
  v_cvt_pk_bf16_f32 v65, v46, v47
  s_waitcnt lgkmcnt(0)
  v_smfmac_f32_16x16x64_bf16 v[88:91], v[76:79], v[96:103], v3
  v_cvt_pk_bf16_f32 v60, v68, v69
  v_cvt_pk_bf16_f32 v61, v70, v71
  v_cvt_pk_bf16_f32 v66, v48, v49
  v_cvt_pk_bf16_f32 v67, v50, v51
  s_nop 1
  v_mfma_f32_16x16x32_bf16 v[72:75], v[64:67], v[4:7], 0
  v_smfmac_f32_16x16x64_bf16 v[92:95], v[76:79], v[104:111], v3
  s_nop 4
  v_cvt_pk_bf16_f32 v62, v72, v73
  v_cvt_pk_bf16_f32 v63, v74, v75
  s_nop 1
  v_mfma_f32_16x16x32_bf16 v[84:87], v[20:23], v[60:63], v[84:87]
  v_smfmac_f32_16x16x64_bf16 v[88:91], v[60:63], v[8:15], v3
  v_smfmac_f32_16x16x64_bf16 v[92:95], v[60:63], v[52:59], v3
  s_mov_b64 exec, s[26:27]
  s_nop 0
  ds_write_b128 v113, v[84:87]
  s_mov_b64 exec, -1
  s_nop 0
  v_cmp_u_f32 vcc, v88, v89
  s_nop 1
  v_permlane32_swap_b32 v88, v92
  v_permlane32_swap_b32 v89, v93
  v_permlane32_swap_b32 v90, v94
  v_permlane32_swap_b32 v91, v95
  v_add_f32 v88, v88, v92
  v_add_f32 v89, v89, v93
  v_add_f32 v90, v90, v94
  v_add_f32 v91, v91, v95
  ds_write_b128 v112, v[88:91]
  s_cbranch_vccnz cA_sc3_retry
cA_sc3_cont:
  s_waitcnt lgkmcnt(0)
  s_barrier
  ds_read_b64 v[36:37], v114 offset:0
  ds_read_b64 v[38:39], v114 offset:1024
  ds_read2_b32 v[44:45], v115 offset0:0 offset1:64
  s_waitcnt lgkmcnt(0)
  v_add_f32 v44, v44, v45
  v_add_f32 v36, v36, v38
  v_add_f32 v37, v37, v39
  v_add_f32_dpp v44, v44, v44 row_ror:8 row_mask:0xf bank_mask:0xf
  v_mov_b32 v45, v44
  v_permlane32_swap_b32 v36, v37
  v_add_f32 v36, v36, v37
  v_permlane16_swap_b32 v44, v45
  v_add_f32 v44, v44, v45
  v_exp_f32 v48, v36
  v_exp_f32 v49, v44
  v_add_f32 v50, abs(v36), abs(v44)
  v_fma_f32 v39, v49, s37, v48
  v_cmp_ngt_f32 vcc, s56, v50
  v_cndmask_b32 v41, v48, v49, s[38:39]
  v_add_f32_dpp v39, v39, v39 quad_perm:[1,0,3,2] row_mask:0xf bank_mask:0xf
  v_cndmask_b32 v40, v49, v48, s[38:39]
  v_mov_b32_dpp v46, v41 quad_perm:[1,0,3,2] row_mask:0xf bank_mask:0xf
  v_add_f32_dpp v39, v39, v39 quad_perm:[2,3,0,1] row_mask:0xf bank_mask:0xf
  v_cndmask_b32 v42, v46, v40, s[38:39]
  v_cndmask_b32 v43, v40, v46, s[38:39]
  v_add_f32_dpp v39, v39, v39 row_half_mirror row_mask:0xf bank_mask:0xf
  s_cbranch_vccnz cA_sc3_slow
  s_nop 0
  v_add_f32_dpp v39, v39, v39 row_mirror row_mask:0xf bank_mask:0xf
  v_mov_b32 v47, v39
  s_nop 1
  v_permlane16_swap_b32 v39, v47
  v_add_f32 v39, v39, v47
  v_rcp_f32 v39, v39
  s_mov_b64 exec, s[28:29]
  v_mul_f32 v42, v42, v39
  v_mul_f32 v43, v43, v39
  v_cvt_pk_bf16_f32 v42, v42, v43
cA_sc3_pst:
  buffer_store_dword v42, v1, s[8:11], s20 offen
  s_mov_b64 exec, -1
  s_barrier
  s_add_u32 s24, s24, 28672
  s_add_u32 s35, s35, 28672
  s_xor_b32 s25, s25, 28672
  s_add_u32 m0, s25, 21504
  s_nop 0
  buffer_load_dwordx4 v2, s[8:11], s24 offen offset:0 sc1 lds
  buffer_load_dwordx4 v2, s[8:11], s24 offen offset:1024 sc1 lds
  buffer_load_dwordx4 v2, s[8:11], s24 offen offset:2048 sc1 lds
  buffer_load_dwordx4 v2, s[8:11], s24 offen offset:3072 sc1 lds
  s_add_u32 m0, s25, 25600
  s_add_u32 s22, s24, 4096
  buffer_load_dwordx4 v2, s[8:11], s22 offen offset:0 sc1 lds
  buffer_load_dwordx4 v2, s[8:11], s22 offen offset:1024 sc1 lds
  buffer_load_dwordx4 v2, s[8:11], s22 offen offset:2048 sc1 lds
  v_xor_b32 v116, 28672, v116
  v_add_u32 v117, s57, v117
  s_sub_u32 s57, 0, s57
  s_add_u32 s19, s19, 1
  s_mov_b32 s20, s21
  s_cmp_lt_u32 s19, 63
  s_cbranch_scc1 cA_sc3_loop
  s_branch cA_done
cA_sc3_slow:
  v_max_f32 v50, v36, v44
  s_nop 1
  v_max_f32_dpp v50, v50, v50 quad_perm:[1,0,3,2] row_mask:0xf bank_mask:0xf
  s_nop 1
  v_max_f32_dpp v50, v50, v50 quad_perm:[2,3,0,1] row_mask:0xf bank_mask:0xf
  s_nop 1
  v_max_f32_dpp v50, v50, v50 row_half_mirror row_mask:0xf bank_mask:0xf
  s_nop 1
  v_max_f32_dpp v50, v50, v50 row_mirror row_mask:0xf bank_mask:0xf
  v_mov_b32 v47, v50
  s_nop 1
  v_permlane16_swap_b32 v50, v47
  v_max_f32 v50, v50, v47
  v_sub_f32 v48, v36, v50
  v_sub_f32 v49, v44, v50
  v_exp_f32 v48, v48
  v_exp_f32 v49, v49
  s_add_u32 s31, s31, 0x100
  v_fma_f32 v39, v49, s37, v48
  v_cndmask_b32 v41, v48, v49, s[38:39]
  s_nop 0
  v_add_f32_dpp v39, v39, v39 quad_perm:[1,0,3,2] row_mask:0xf bank_mask:0xf
  v_cndmask_b32 v40, v49, v48, s[38:39]
  v_mov_b32_dpp v46, v41 quad_perm:[1,0,3,2] row_mask:0xf bank_mask:0xf
  v_add_f32_dpp v39, v39, v39 quad_perm:[2,3,0,1] row_mask:0xf bank_mask:0xf
  v_cndmask_b32 v42, v46, v40, s[38:39]
  v_cndmask_b32 v43, v40, v46, s[38:39]
  v_add_f32_dpp v39, v39, v39 row_half_mirror row_mask:0xf bank_mask:0xf
  s_nop 1
  v_add_f32_dpp v39, v39, v39 row_mirror row_mask:0xf bank_mask:0xf
  v_mov_b32 v47, v39
  s_nop 1
  v_permlane16_swap_b32 v39, v47
  v_add_f32 v39, v39, v47
  v_rcp_f32 v39, v39
  s_mov_b64 exec, s[28:29]
  v_mul_f32 v42, v42, v39
  v_mul_f32 v43, v43, v39
  v_cvt_pk_bf16_f32 v42, v42, v43
  v_min_u32 v42, -2, v42
  s_branch cA_sc3_pst
cA_sc3_retry:
  s_cmp_lg_u32 s62, 0
  s_cbranch_scc1 cA_sc3_cont
  s_waitcnt vmcnt(0) lgkmcnt(0)
cA_sc3_rv:
  buffer_load_dwordx4 v[8:11], v2, s[8:11], s20 offen offset:0 sc1
  buffer_load_dwordx4 v[12:15], v2, s[8:11], s20 offen offset:1024 sc1
  buffer_load_dwordx4 v[16:19], v2, s[8:11], s20 offen offset:2048 sc1
  buffer_load_dwordx4 v[20:23], v2, s[8:11], s20 offen offset:3072 sc1
  buffer_load_dwordx4 v[24:27], v2, s[8:11], s23 offen offset:0 sc1
  buffer_load_dwordx4 v[28:31], v2, s[8:11], s23 offen offset:1024 sc1
  buffer_load_dwordx4 v[32:35], v2, s[8:11], s23 offen offset:2048 sc1
  s_waitcnt vmcnt(0)
  v_max3_u32 v118, v8, v9, v10
  v_max3_u32 v118, v118, v11, v12
  v_max3_u32 v118, v118, v13, v14
  v_max3_u32 v118, v118, v15, v16
  v_max3_u32 v118, v118, v17, v18
  v_max3_u32 v118, v118, v19, v20
  v_max3_u32 v118, v118, v21, v22
  v_max3_u32 v118, v118, v23, v24
  v_max3_u32 v118, v118, v25, v26
  v_max3_u32 v118, v118, v27, v28
  v_max3_u32 v118, v118, v29, v30
  v_max3_u32 v118, v118, v31, v32
  v_max3_u32 v118, v118, v33, v34
  v_max_u32 v118, v118, v35
  v_cmp_eq_u32 vcc, -1, v118
  s_cbranch_vccz cA_sc3_rk
  s_add_u32 s30, s30, 1
  s_cmp_lt_u32 s30, 400000
  s_cbranch_scc1 cA_sc3_rv
  s_branch cA_abort
cA_sc3_rk:
  s_mov_b32 s62, 1
  v_mov_b32 v36, 0
  v_mov_b32 v37, 0
  v_mov_b32 v38, 0
  v_mov_b32 v39, 0
  v_mov_b32 v40, 0
  v_mov_b32 v41, 0
  v_mov_b32 v42, 0
  v_mov_b32 v43, 0
  v_mov_b32 v44, 0
  v_mov_b32 v45, 0
  v_mov_b32 v46, 0
  v_mov_b32 v47, 0
  v_mov_b32 v48, 0
  v_mov_b32 v49, 0
  v_mov_b32 v50, 0
  v_mov_b32 v51, 0
  v_mov_b32 v52, 0
  v_mov_b32 v53, 0
  v_mov_b32 v54, 0
  v_mov_b32 v55, 0
  v_mov_b32 v56, 0
  v_mov_b32 v57, 0
  v_mov_b32 v58, 0
  v_mov_b32 v59, 0
  v_mov_b32 v60, 0
  v_mov_b32 v61, 0
  v_mov_b32 v62, 0
  v_mov_b32 v63, 0
  v_mov_b32 v88, 0
  v_mov_b32 v89, 0
  v_mov_b32 v90, 0
  v_mov_b32 v91, 0
  v_mov_b32 v92, 0
  v_mov_b32 v93, 0
  v_mov_b32 v94, 0
  v_mov_b32 v95, 0
  v_mov_b32 v64, 0
  v_mov_b32 v65, 0
  s_add_u32 s31, s31, 1
  ds_read_b128 v[96:99], v117 offset:0
  ds_read_b128 v[100:103], v117 offset:1024
  ds_read_b128 v[104:107], v117 offset:14336
  ds_read_b128 v[108:111], v117 offset:15360
  v_smfmac_f32_16x16x64_bf16 v[36:39], v[8:11], a[0:7], v3
  v_smfmac_f32_16x16x64_bf16 v[40:43], v[8:11], a[56:63], v3
  v_smfmac_f32_16x16x64_bf16 v[44:47], v[8:11], a[112:119], v3
  v_smfmac_f32_16x16x64_bf16 v[48:51], v[8:11], a[168:175], v3
  v_smfmac_f32_16x16x64_bf16 v[52:55], v[8:11], a[224:231], v3
  v_smfmac_f32_16x16x64_bf16 v[56:59], v[8:11], v[144:151], v3
  v_smfmac_f32_16x16x64_bf16 v[60:63], v[8:11], v[200:207], v3
  v_smfmac_f32_16x16x64_bf16 v[36:39], v[12:15], a[8:15], v3
  v_smfmac_f32_16x16x64_bf16 v[40:43], v[12:15], a[64:71], v3
  v_smfmac_f32_16x16x64_bf16 v[44:47], v[12:15], a[120:127], v3
  v_smfmac_f32_16x16x64_bf16 v[48:51], v[12:15], a[176:183], v3
  v_smfmac_f32_16x16x64_bf16 v[52:55], v[12:15], a[232:239], v3
  v_smfmac_f32_16x16x64_bf16 v[56:59], v[12:15], v[152:159], v3
  v_smfmac_f32_16x16x64_bf16 v[60:63], v[12:15], v[208:215], v3
  v_smfmac_f32_16x16x64_bf16 v[36:39], v[16:19], a[16:23], v3
  v_smfmac_f32_16x16x64_bf16 v[40:43], v[16:19], a[72:79], v3
  v_smfmac_f32_16x16x64_bf16 v[44:47], v[16:19], a[128:135], v3
  v_smfmac_f32_16x16x64_bf16 v[48:51], v[16:19], a[184:191], v3
  v_smfmac_f32_16x16x64_bf16 v[52:55], v[16:19], a[240:247], v3
  v_smfmac_f32_16x16x64_bf16 v[56:59], v[16:19], v[160:167], v3
  v_smfmac_f32_16x16x64_bf16 v[60:63], v[16:19], v[216:223], v3
  v_smfmac_f32_16x16x64_bf16 v[36:39], v[20:23], a[24:31], v3
  v_smfmac_f32_16x16x64_bf16 v[40:43], v[20:23], a[80:87], v3
  v_smfmac_f32_16x16x64_bf16 v[44:47], v[20:23], a[136:143], v3
  v_smfmac_f32_16x16x64_bf16 v[48:51], v[20:23], a[192:199], v3
  v_smfmac_f32_16x16x64_bf16 v[52:55], v[20:23], a[248:255], v3
  v_smfmac_f32_16x16x64_bf16 v[56:59], v[20:23], v[168:175], v3
  v_smfmac_f32_16x16x64_bf16 v[60:63], v[20:23], v[224:231], v3
  s_branch cA_sc3_ph2
.p2align 6

cA_va0_loop:
  s_add_u32 s23, s20, 4096
  s_add_u32 s21, s20, 25600
  s_mov_b32 s30, 0
  s_cmp_lg_u32 s19, s38
  s_cbranch_scc1 cA_va0_vok
  s_branch cA_va0_voc
cA_va0_vow:
  buffer_load_dword v175, off, s[8:11], s35 sc1
  s_waitcnt vmcnt(0)
cA_va0_voc:
  v_readfirstlane_b32 s22, v175
  s_cmp_eq_u32 s22, 56
  s_cbranch_scc1 cA_va0_vod
  s_sleep 1
  s_add_u32 s30, s30, 1
  s_cmp_lt_u32 s30, 400000
  s_cbranch_scc1 cA_va0_vow
  s_branch cA_abort
cA_va0_vod:
  s_add_u32 s35, s35, 2048
  s_add_u32 s38, s19, 8
  s_and_b32 s38, s38, -8
  s_cmp_eq_u32 s19, 0
  s_cselect_b32 s38, 4, s38
cA_va0_vok:
  s_cmp_eq_u32 s19, 63
  s_cbranch_scc1 cA_done
  s_barrier
  s_add_u32 s22, s25, 0
  buffer_load_dwordx4 v[80:83], v6, s[8:11], s22 offen offset:0 sc1
  buffer_load_dwordx4 v[84:87], v6, s[8:11], s22 offen offset:1792 sc1
  s_add_u32 s22, s25, 3584
  buffer_load_dwordx4 v[88:91], v6, s[8:11], s22 offen offset:0 sc1
  buffer_load_dwordx4 v[92:95], v6, s[8:11], s22 offen offset:1792 sc1
  s_add_u32 s22, s25, 7168
  buffer_load_dwordx4 v[96:99], v6, s[8:11], s22 offen offset:0 sc1
  buffer_load_dwordx4 v[100:103], v6, s[8:11], s22 offen offset:1792 sc1
  s_add_u32 s22, s25, 10752
  buffer_load_dwordx4 v[104:107], v6, s[8:11], s22 offen offset:0 sc1
  buffer_load_dwordx4 v[108:111], v6, s[8:11], s22 offen offset:1792 sc1
  s_add_u32 s22, s25, 14336
  buffer_load_dwordx4 v[112:115], v6, s[8:11], s22 offen offset:0 sc1
  buffer_load_dwordx4 v[116:119], v6, s[8:11], s22 offen offset:1792 sc1
  s_add_u32 s22, s25, 17920
  buffer_load_dwordx4 v[120:123], v6, s[8:11], s22 offen offset:0 sc1
  buffer_load_dwordx4 v[124:127], v6, s[8:11], s22 offen offset:1792 sc1
  s_add_u32 s22, s25, 21504
  buffer_load_dwordx4 v[128:131], v6, s[8:11], s22 offen offset:0 sc1
  buffer_load_dwordx4 v[132:135], v6, s[8:11], s22 offen offset:1792 sc1
  s_add_u32 s22, s25, 25088
  buffer_load_dwordx4 v[136:139], v6, s[8:11], s22 offen offset:0 sc1
  buffer_load_dwordx4 v[140:143], v6, s[8:11], s22 offen offset:1792 sc1
  buffer_load_dword v175, off, s[8:11], s35 sc1
  s_barrier
  ds_read_b128 v[8:11], v2 offset:8192
  ds_read_b128 v[12:15], v2 offset:9216
  ds_read_b128 v[16:19], v2 offset:10240
  ds_read_b128 v[20:23], v2 offset:11264
  ds_read_b128 v[24:27], v2 offset:12288
  ds_read_b128 v[28:31], v2 offset:13312
  ds_read_b128 v[32:35], v2 offset:14336
  s_waitcnt lgkmcnt(0)
  v_smfmac_f32_16x16x64_bf16 v[36:39], v[8:11], a[0:7], v3
  v_smfmac_f32_16x16x64_bf16 v[36:39], v[12:15], a[8:15], v3
  v_smfmac_f32_16x16x64_bf16 v[36:39], v[16:19], a[16:23], v3
  v_smfmac_f32_16x16x64_bf16 v[36:39], v[20:23], a[24:31], v3
  v_smfmac_f32_16x16x64_bf16 v[36:39], v[24:27], a[32:39], v3
  v_smfmac_f32_16x16x64_bf16 v[36:39], v[28:31], a[40:47], v3
  v_smfmac_f32_16x16x64_bf16 v[36:39], v[32:35], a[48:55], v3
  v_smfmac_f32_16x16x64_bf16 v[40:43], v[8:11], a[56:63], v3
  v_smfmac_f32_16x16x64_bf16 v[40:43], v[12:15], a[64:71], v3
  v_smfmac_f32_16x16x64_bf16 v[40:43], v[16:19], a[72:79], v3
  v_smfmac_f32_16x16x64_bf16 v[40:43], v[20:23], a[80:87], v3
  v_smfmac_f32_16x16x64_bf16 v[40:43], v[24:27], a[88:95], v3
  v_smfmac_f32_16x16x64_bf16 v[40:43], v[28:31], a[96:103], v3
  v_smfmac_f32_16x16x64_bf16 v[40:43], v[32:35], a[104:111], v3
  v_smfmac_f32_16x16x64_bf16 v[44:47], v[8:11], a[112:119], v3
  v_smfmac_f32_16x16x64_bf16 v[44:47], v[12:15], a[120:127], v3
  v_smfmac_f32_16x16x64_bf16 v[44:47], v[16:19], a[128:135], v3
  v_smfmac_f32_16x16x64_bf16 v[44:47], v[20:23], a[136:143], v3
  v_permlane32_swap_b32 v36, v40
  v_smfmac_f32_16x16x64_bf16 v[44:47], v[24:27], a[144:151], v3
  v_permlane32_swap_b32 v37, v41
  v_smfmac_f32_16x16x64_bf16 v[44:47], v[28:31], a[152:159], v3
  v_permlane32_swap_b32 v38, v42
  v_smfmac_f32_16x16x64_bf16 v[44:47], v[32:35], a[160:167], v3
  v_permlane32_swap_b32 v39, v43
  v_smfmac_f32_16x16x64_bf16 v[48:51], v[8:11], a[168:175], v3
  v_add_f32 v36, v36, v40
  v_smfmac_f32_16x16x64_bf16 v[48:51], v[12:15], a[176:183], v3
  v_add_f32 v37, v37, v41
  v_smfmac_f32_16x16x64_bf16 v[48:51], v[16:19], a[184:191], v3
  v_add_f32 v38, v38, v42
  v_smfmac_f32_16x16x64_bf16 v[48:51], v[20:23], a[192:199], v3
  v_add_f32 v39, v39, v43
  v_smfmac_f32_16x16x64_bf16 v[48:51], v[24:27], a[200:207], v3
  v_cvt_pk_bf16_f32 v40, v36, v37
  v_smfmac_f32_16x16x64_bf16 v[48:51], v[28:31], a[208:215], v3
  v_cvt_pk_bf16_f32 v41, v38, v39
  v_smfmac_f32_16x16x64_bf16 v[48:51], v[32:35], a[216:223], v3
  ds_write_b64 v60, v[40:41]
  v_smfmac_f32_16x16x64_bf16 v[52:55], v[8:11], a[224:231], v3
  v_smfmac_f32_16x16x64_bf16 v[52:55], v[12:15], a[232:239], v3
  v_smfmac_f32_16x16x64_bf16 v[52:55], v[16:19], a[240:247], v3
  v_smfmac_f32_16x16x64_bf16 v[52:55], v[20:23], a[248:255], v3
  v_permlane32_swap_b32 v44, v48
  v_smfmac_f32_16x16x64_bf16 v[52:55], v[24:27], v[176:183], v3
  v_permlane32_swap_b32 v45, v49
  v_smfmac_f32_16x16x64_bf16 v[52:55], v[28:31], v[184:191], v3
  v_permlane32_swap_b32 v46, v50
  v_smfmac_f32_16x16x64_bf16 v[52:55], v[32:35], v[192:199], v3
  v_permlane32_swap_b32 v47, v51
  v_smfmac_f32_16x16x64_bf16 v[56:59], v[8:11], v[200:207], v3
  v_add_f32 v44, v44, v48
  v_smfmac_f32_16x16x64_bf16 v[56:59], v[12:15], v[208:215], v3
  v_add_f32 v45, v45, v49
  v_smfmac_f32_16x16x64_bf16 v[56:59], v[16:19], v[216:223], v3
  v_add_f32 v46, v46, v50
  v_smfmac_f32_16x16x64_bf16 v[56:59], v[20:23], v[224:231], v3
  v_add_f32 v47, v47, v51
  v_smfmac_f32_16x16x64_bf16 v[56:59], v[24:27], v[232:239], v3
  v_cvt_pk_bf16_f32 v48, v44, v45
  v_smfmac_f32_16x16x64_bf16 v[56:59], v[28:31], v[240:247], v3
  v_cvt_pk_bf16_f32 v49, v46, v47
  v_smfmac_f32_16x16x64_bf16 v[56:59], v[32:35], v[248:255], v3
  ds_write_b64 v61, v[48:49]
  s_nop 6
  v_permlane32_swap_b32 v52, v56
  v_permlane32_swap_b32 v53, v57
  v_permlane32_swap_b32 v54, v58
  v_permlane32_swap_b32 v55, v59
  v_add_f32 v52, v52, v56
  v_add_f32 v53, v53, v57
  v_add_f32 v54, v54, v58
  v_add_f32 v55, v55, v59
  v_cvt_pk_bf16_f32 v56, v52, v53
  v_cvt_pk_bf16_f32 v57, v54, v55
  ds_write_b64 v62, v[56:57]
  s_cmp_eq_u32 s19, 63
  s_cbranch_scc1 cA_va0_last
  s_add_u32 s22, s20, 9216
  s_add_u32 s34, s20, 13312
  s_add_u32 s36, s20, 7168
  s_mov_b32 s37, 0
  v_mov_b32 v156, 0
  v_mov_b32 v157, 0
  v_mov_b32 v158, 0
  v_mov_b32 v159, 0
  buffer_load_dword v164, v4, s[8:11], s20 offen sc1
  s_nop 7
  buffer_load_dword v165, v4, s[8:11], s20 offen sc1
  s_nop 7
  buffer_load_dword v166, v4, s[8:11], s20 offen sc1
  s_nop 7
  buffer_load_dword v167, v4, s[8:11], s20 offen sc1
  s_nop 7
  buffer_load_dword v168, v4, s[8:11], s20 offen sc1
cA_va0_fw_l:
  s_waitcnt vmcnt(4)
  v_cmp_eq_u32 vcc, -1, v164
  s_cbranch_vccz cA_va0_fw_d
  buffer_load_dword v164, v4, s[8:11], s20 offen sc1
  s_waitcnt vmcnt(4)
  v_cmp_eq_u32 vcc, -1, v165
  s_cbranch_vccz cA_va0_fw_d
  buffer_load_dword v165, v4, s[8:11], s20 offen sc1
  s_waitcnt vmcnt(4)
  v_cmp_eq_u32 vcc, -1, v166
  s_cbranch_vccz cA_va0_fw_d
  buffer_load_dword v166, v4, s[8:11], s20 offen sc1
  s_waitcnt vmcnt(4)
  v_cmp_eq_u32 vcc, -1, v167
  s_cbranch_vccz cA_va0_fw_d
  buffer_load_dword v167, v4, s[8:11], s20 offen sc1
  s_waitcnt vmcnt(4)
  v_cmp_eq_u32 vcc, -1, v168
  s_cbranch_vccz cA_va0_fw_d
  buffer_load_dword v168, v4, s[8:11], s20 offen sc1
  s_add_u32 s30, s30, 1
  s_cmp_lt_u32 s30, 400000
  s_cbranch_scc1 cA_va0_fw_l
  s_branch cA_abort
cA_va0_fw_d:
  s_waitcnt lgkmcnt(0)
  buffer_load_dwordx4 v[8:11], v2, s[8:11], s22 offen offset:0
  v_mov_b32 v36, 0
  v_mov_b32 v37, 0
  v_mov_b32 v38, 0
  buffer_load_dwordx4 v[12:15], v2, s[8:11], s22 offen offset:1024
  v_mov_b32 v39, 0
  v_mov_b32 v40, 0
  v_mov_b32 v41, 0
  buffer_load_dwordx4 v[16:19], v2, s[8:11], s22 offen offset:2048
  v_mov_b32 v42, 0
  v_mov_b32 v43, 0
  v_mov_b32 v44, 0
  buffer_load_dwordx4 v[20:23], v2, s[8:11], s22 offen offset:3072
  v_mov_b32 v45, 0
  v_mov_b32 v46, 0
  v_mov_b32 v47, 0
  buffer_load_dwordx4 v[24:27], v2, s[8:11], s34 offen offset:0
  v_mov_b32 v48, 0
  v_mov_b32 v49, 0
  v_mov_b32 v50, 0
  buffer_load_dwordx4 v[28:31], v2, s[8:11], s34 offen offset:1024
  v_mov_b32 v51, 0
  v_mov_b32 v52, 0
  v_mov_b32 v53, 0
  buffer_load_dwordx4 v[32:35], v2, s[8:11], s34 offen offset:2048
  v_mov_b32 v54, 0
  v_mov_b32 v55, 0
  v_mov_b32 v56, 0
  buffer_load_dwordx4 v[144:147], v2, s[8:11], s34 offen offset:3072
  v_mov_b32 v57, 0
  v_mov_b32 v58, 0
  v_mov_b32 v59, 0
  buffer_load_dwordx4 v[148:151], v2, s[8:11], s36 offen offset:0
  buffer_load_dwordx4 v[152:155], v2, s[8:11], s36 offen offset:1024
  s_barrier
  ds_read_b128 v[64:67], v2 offset:0
  ds_read_b128 v[68:71], v2 offset:1024
  ds_read_b128 v[72:75], v2 offset:2048
  ds_read_b128 v[76:79], v2 offset:3072
  s_waitcnt vmcnt(9)
  v_smfmac_f32_16x16x64_bf16 v[156:159], v[8:11], v[80:87], v3
  s_waitcnt vmcnt(8)
  v_smfmac_f32_16x16x64_bf16 v[156:159], v[12:15], v[88:95], v3
  s_waitcnt vmcnt(7)
  v_smfmac_f32_16x16x64_bf16 v[156:159], v[16:19], v[96:103], v3
  s_waitcnt vmcnt(6)
  v_smfmac_f32_16x16x64_bf16 v[156:159], v[20:23], v[104:111], v3
  s_waitcnt vmcnt(5)
  v_smfmac_f32_16x16x64_bf16 v[156:159], v[24:27], v[112:119], v3
  s_mov_b32 exec_hi, 0
  buffer_store_dword v2, v7, s[8:11], s21 offen
  s_mov_b64 exec, -1
  s_waitcnt vmcnt(5)
  v_smfmac_f32_16x16x64_bf16 v[156:159], v[28:31], v[120:127], v3
  s_waitcnt vmcnt(4)
  v_smfmac_f32_16x16x64_bf16 v[156:159], v[32:35], v[128:135], v3
  s_waitcnt vmcnt(3)
  v_smfmac_f32_16x16x64_bf16 v[156:159], v[144:147], v[136:143], v3
  s_waitcnt vmcnt(2) lgkmcnt(0)
  v_smfmac_f32_16x16x64_bf16 v[156:159], v[148:151], v[64:71], v3
  s_waitcnt vmcnt(1)
  v_smfmac_f32_16x16x64_bf16 v[156:159], v[152:155], v[72:79], v3
cA_va0_ep:
  s_nop 7
  v_permlane32_swap_b32 v156, v158
  v_permlane32_swap_b32 v157, v159
  v_add_f32 v160, v156, v158
  v_add_f32 v161, v157, v159
  v_cmp_u_f32 vcc, v160, v161
  v_mov_b32_dpp v162, v160 row_ror:8 row_mask:0xf bank_mask:0xf
  v_mov_b32_dpp v160, v161 row_ror:8 row_mask:0xf bank_mask:0xc
  s_cbranch_vccnz cA_va0_rp
  v_mov_b32_dpp v161, v162 quad_perm:[0,1,2,3] row_mask:0xf bank_mask:0x3
  v_cvt_pk_bf16_f32 v160, v160, v161
cA_va0_pc:
  buffer_store_dword v160, v1, s[8:11], s21 offen
  s_cmp_lg_u32 s19, 62
  s_cbranch_scc1 cA_va0_nl
  s_mov_b32 s22, 88519680
  buffer_store_dword v160, v1, s[8:11], s22 offen sc1
  s_mov_b64 exec, -1
  s_branch cA_done
cA_va0_nl:
  s_mov_b64 exec, -1
  s_add_u32 s25, s25, 28672
  s_add_u32 s19, s19, 1
  s_mov_b32 s20, s21
  s_branch cA_va0_loop
cA_va0_last:
  s_waitcnt lgkmcnt(0)
  s_barrier
  s_branch cA_done
cA_va0_rp:
  s_cmp_eq_u32 s37, 0
  s_cbranch_scc1 cA_va0_rv
  v_mov_b32_dpp v161, v162 quad_perm:[0,1,2,3] row_mask:0xf bank_mask:0x3
  v_cvt_pk_bf16_f32 v160, v160, v161
  v_min_u32 v160, -2, v160
  s_branch cA_va0_pc
cA_va0_rv:
  buffer_load_dwordx4 v[8:11], v2, s[8:11], s22 offen offset:0 sc1
  buffer_load_dwordx4 v[12:15], v2, s[8:11], s22 offen offset:1024 sc1
  buffer_load_dwordx4 v[16:19], v2, s[8:11], s22 offen offset:2048 sc1
  buffer_load_dwordx4 v[20:23], v2, s[8:11], s22 offen offset:3072 sc1
  buffer_load_dwordx4 v[24:27], v2, s[8:11], s34 offen offset:0 sc1
  buffer_load_dwordx4 v[28:31], v2, s[8:11], s34 offen offset:1024 sc1
  buffer_load_dwordx4 v[32:35], v2, s[8:11], s34 offen offset:2048 sc1
  buffer_load_dwordx4 v[144:147], v2, s[8:11], s34 offen offset:3072 sc1
  buffer_load_dwordx4 v[148:151], v2, s[8:11], s36 offen offset:0 sc1
  buffer_load_dwordx4 v[152:155], v2, s[8:11], s36 offen offset:1024 sc1
  s_waitcnt vmcnt(0)
  v_max3_u32 v63, v8, v9, v10
  v_max3_u32 v63, v63, v11, v12
  v_max3_u32 v63, v63, v13, v14
  v_max3_u32 v63, v63, v15, v16
  v_max3_u32 v63, v63, v17, v18
  v_max3_u32 v63, v63, v19, v20
  v_max3_u32 v63, v63, v21, v22
  v_max3_u32 v63, v63, v23, v24
  v_max3_u32 v63, v63, v25, v26
  v_max3_u32 v63, v63, v27, v28
  v_max3_u32 v63, v63, v29, v30
  v_max3_u32 v63, v63, v31, v32
  v_max3_u32 v63, v63, v33, v34
  v_max3_u32 v63, v63, v35, v144
  v_max3_u32 v63, v63, v145, v146
  v_max3_u32 v63, v63, v147, v148
  v_max3_u32 v63, v63, v149, v150
  v_max3_u32 v63, v63, v151, v152
  v_max3_u32 v63, v63, v153, v154
  v_max_u32 v63, v63, v155
  v_cmp_eq_u32 vcc, -1, v63
  s_cbranch_vccz cA_va0_rk
  s_add_u32 s30, s30, 1
  s_cmp_lt_u32 s30, 400000
  s_cbranch_scc1 cA_va0_rv
  s_branch cA_abort
cA_va0_rk:
  s_mov_b32 s37, 1
  s_add_u32 s31, s31, 0x10000
  v_mov_b32 v156, 0
  v_mov_b32 v157, 0
  v_mov_b32 v158, 0
  v_mov_b32 v159, 0
  s_nop 1
  v_smfmac_f32_16x16x64_bf16 v[156:159], v[8:11], v[80:87], v3
  v_smfmac_f32_16x16x64_bf16 v[156:159], v[12:15], v[88:95], v3
  v_smfmac_f32_16x16x64_bf16 v[156:159], v[16:19], v[96:103], v3
  v_smfmac_f32_16x16x64_bf16 v[156:159], v[20:23], v[104:111], v3
  v_smfmac_f32_16x16x64_bf16 v[156:159], v[24:27], v[112:119], v3
  v_smfmac_f32_16x16x64_bf16 v[156:159], v[28:31], v[120:127], v3
  v_smfmac_f32_16x16x64_bf16 v[156:159], v[32:35], v[128:135], v3
  v_smfmac_f32_16x16x64_bf16 v[156:159], v[144:147], v[136:143], v3
  v_smfmac_f32_16x16x64_bf16 v[156:159], v[148:151], v[64:71], v3
  v_smfmac_f32_16x16x64_bf16 v[156:159], v[152:155], v[72:79], v3
  s_nop 7
  s_branch cA_va0_ep
.p2align 6

cA_va1_loop:
  s_add_u32 s23, s20, 4096
  s_add_u32 s21, s20, 25600
  s_mov_b32 s30, 0
  s_cmp_lg_u32 s19, s38
  s_cbranch_scc1 cA_va1_vok
  s_branch cA_va1_voc
cA_va1_vow:
  buffer_load_dword v175, off, s[8:11], s35 sc1
  s_waitcnt vmcnt(0)
cA_va1_voc:
  v_readfirstlane_b32 s22, v175
  s_cmp_eq_u32 s22, 56
  s_cbranch_scc1 cA_va1_vod
  s_sleep 1
  s_add_u32 s30, s30, 1
  s_cmp_lt_u32 s30, 400000
  s_cbranch_scc1 cA_va1_vow
  s_branch cA_abort
cA_va1_vod:
  s_add_u32 s35, s35, 2048
  s_add_u32 s38, s19, 8
  s_and_b32 s38, s38, -8
  s_cmp_eq_u32 s19, 0
  s_cselect_b32 s38, 4, s38
cA_va1_vok:
  s_cmp_eq_u32 s19, 63
  s_cbranch_scc1 cA_done
  s_barrier
  s_add_u32 s22, s25, 0
  buffer_load_dwordx4 v[80:83], v6, s[8:11], s22 offen offset:0 sc1
  buffer_load_dwordx4 v[84:87], v6, s[8:11], s22 offen offset:1792 sc1
  s_add_u32 s22, s25, 3584
  buffer_load_dwordx4 v[88:91], v6, s[8:11], s22 offen offset:0 sc1
  buffer_load_dwordx4 v[92:95], v6, s[8:11], s22 offen offset:1792 sc1
  s_add_u32 s22, s25, 7168
  buffer_load_dwordx4 v[96:99], v6, s[8:11], s22 offen offset:0 sc1
  buffer_load_dwordx4 v[100:103], v6, s[8:11], s22 offen offset:1792 sc1
  s_add_u32 s22, s25, 10752
  buffer_load_dwordx4 v[104:107], v6, s[8:11], s22 offen offset:0 sc1
  buffer_load_dwordx4 v[108:111], v6, s[8:11], s22 offen offset:1792 sc1
  s_add_u32 s22, s25, 14336
  buffer_load_dwordx4 v[112:115], v6, s[8:11], s22 offen offset:0 sc1
  buffer_load_dwordx4 v[116:119], v6, s[8:11], s22 offen offset:1792 sc1
  s_add_u32 s22, s25, 17920
  buffer_load_dwordx4 v[120:123], v6, s[8:11], s22 offen offset:0 sc1
  buffer_load_dwordx4 v[124:127], v6, s[8:11], s22 offen offset:1792 sc1
  s_add_u32 s22, s25, 21504
  buffer_load_dwordx4 v[128:131], v6, s[8:11], s22 offen offset:0 sc1
  buffer_load_dwordx4 v[132:135], v6, s[8:11], s22 offen offset:1792 sc1
  s_add_u32 s22, s25, 25088
  buffer_load_dwordx4 v[136:139], v6, s[8:11], s22 offen offset:0 sc1
  buffer_load_dwordx4 v[140:143], v6, s[8:11], s22 offen offset:1792 sc1
  buffer_load_dword v175, off, s[8:11], s35 sc1
  s_barrier
  ds_read_b128 v[8:11], v2 offset:8192
  ds_read_b128 v[12:15], v2 offset:9216
  ds_read_b128 v[16:19], v2 offset:10240
  ds_read_b128 v[20:23], v2 offset:11264
  ds_read_b128 v[24:27], v2 offset:12288
  ds_read_b128 v[28:31], v2 offset:13312
  ds_read_b128 v[32:35], v2 offset:14336
  s_waitcnt lgkmcnt(0)
  v_smfmac_f32_16x16x64_bf16 v[36:39], v[8:11], a[0:7], v3
  v_smfmac_f32_16x16x64_bf16 v[36:39], v[12:15], a[8:15], v3
  v_smfmac_f32_16x16x64_bf16 v[36:39], v[16:19], a[16:23], v3
  v_smfmac_f32_16x16x64_bf16 v[36:39], v[20:23], a[24:31], v3
  v_smfmac_f32_16x16x64_bf16 v[36:39], v[24:27], a[32:39], v3
  v_smfmac_f32_16x16x64_bf16 v[36:39], v[28:31], a[40:47], v3
  v_smfmac_f32_16x16x64_bf16 v[36:39], v[32:35], a[48:55], v3
  v_smfmac_f32_16x16x64_bf16 v[40:43], v[8:11], a[56:63], v3
  v_smfmac_f32_16x16x64_bf16 v[40:43], v[12:15], a[64:71], v3
  v_smfmac_f32_16x16x64_bf16 v[40:43], v[16:19], a[72:79], v3
  v_smfmac_f32_16x16x64_bf16 v[40:43], v[20:23], a[80:87], v3
  v_smfmac_f32_16x16x64_bf16 v[40:43], v[24:27], a[88:95], v3
  v_smfmac_f32_16x16x64_bf16 v[40:43], v[28:31], a[96:103], v3
  v_smfmac_f32_16x16x64_bf16 v[40:43], v[32:35], a[104:111], v3
  v_smfmac_f32_16x16x64_bf16 v[44:47], v[8:11], a[112:119], v3
  v_smfmac_f32_16x16x64_bf16 v[44:47], v[12:15], a[120:127], v3
  v_smfmac_f32_16x16x64_bf16 v[44:47], v[16:19], a[128:135], v3
  v_smfmac_f32_16x16x64_bf16 v[44:47], v[20:23], a[136:143], v3
  v_permlane32_swap_b32 v36, v40
  v_smfmac_f32_16x16x64_bf16 v[44:47], v[24:27], a[144:151], v3
  v_permlane32_swap_b32 v37, v41
  v_smfmac_f32_16x16x64_bf16 v[44:47], v[28:31], a[152:159], v3
  v_permlane32_swap_b32 v38, v42
  v_smfmac_f32_16x16x64_bf16 v[44:47], v[32:35], a[160:167], v3
  v_permlane32_swap_b32 v39, v43
  v_smfmac_f32_16x16x64_bf16 v[48:51], v[8:11], a[168:175], v3
  v_add_f32 v36, v36, v40
  v_smfmac_f32_16x16x64_bf16 v[48:51], v[12:15], a[176:183], v3
  v_add_f32 v37, v37, v41
  v_smfmac_f32_16x16x64_bf16 v[48:51], v[16:19], a[184:191], v3
  v_add_f32 v38, v38, v42
  v_smfmac_f32_16x16x64_bf16 v[48:51], v[20:23], a[192:199], v3
  v_add_f32 v39, v39, v43
  v_smfmac_f32_16x16x64_bf16 v[48:51], v[24:27], a[200:207], v3
  v_cvt_pk_bf16_f32 v40, v36, v37
  v_smfmac_f32_16x16x64_bf16 v[48:51], v[28:31], a[208:215], v3
  v_cvt_pk_bf16_f32 v41, v38, v39
  v_smfmac_f32_16x16x64_bf16 v[48:51], v[32:35], a[216:223], v3
  ds_write_b64 v60, v[40:41]
  v_smfmac_f32_16x16x64_bf16 v[52:55], v[8:11], a[224:231], v3
  v_smfmac_f32_16x16x64_bf16 v[52:55], v[12:15], a[232:239], v3
  v_smfmac_f32_16x16x64_bf16 v[52:55], v[16:19], a[240:247], v3
  v_smfmac_f32_16x16x64_bf16 v[52:55], v[20:23], a[248:255], v3
  v_permlane32_swap_b32 v44, v48
  v_smfmac_f32_16x16x64_bf16 v[52:55], v[24:27], v[176:183], v3
  v_permlane32_swap_b32 v45, v49
  v_smfmac_f32_16x16x64_bf16 v[52:55], v[28:31], v[184:191], v3
  v_permlane32_swap_b32 v46, v50
  v_smfmac_f32_16x16x64_bf16 v[52:55], v[32:35], v[192:199], v3
  v_permlane32_swap_b32 v47, v51
  v_smfmac_f32_16x16x64_bf16 v[56:59], v[8:11], v[200:207], v3
  v_add_f32 v44, v44, v48
  v_smfmac_f32_16x16x64_bf16 v[56:59], v[12:15], v[208:215], v3
  v_add_f32 v45, v45, v49
  v_smfmac_f32_16x16x64_bf16 v[56:59], v[16:19], v[216:223], v3
  v_add_f32 v46, v46, v50
  v_smfmac_f32_16x16x64_bf16 v[56:59], v[20:23], v[224:231], v3
  v_add_f32 v47, v47, v51
  v_smfmac_f32_16x16x64_bf16 v[56:59], v[24:27], v[232:239], v3
  v_cvt_pk_bf16_f32 v48, v44, v45
  v_smfmac_f32_16x16x64_bf16 v[56:59], v[28:31], v[240:247], v3
  v_cvt_pk_bf16_f32 v49, v46, v47
  v_smfmac_f32_16x16x64_bf16 v[56:59], v[32:35], v[248:255], v3
  ds_write_b64 v61, v[48:49]
  s_nop 6
  v_permlane32_swap_b32 v52, v56
  v_permlane32_swap_b32 v53, v57
  v_permlane32_swap_b32 v54, v58
  v_permlane32_swap_b32 v55, v59
  v_add_f32 v52, v52, v56
  v_add_f32 v53, v53, v57
  v_add_f32 v54, v54, v58
  v_add_f32 v55, v55, v59
  v_cvt_pk_bf16_f32 v56, v52, v53
  v_cvt_pk_bf16_f32 v57, v54, v55
  ds_write_b64 v62, v[56:57]
  s_cmp_eq_u32 s19, 63
  s_cbranch_scc1 cA_va1_last
  s_add_u32 s22, s20, 9216
  s_add_u32 s34, s20, 13312
  s_add_u32 s36, s20, 7168
  s_mov_b32 s37, 0
  v_mov_b32 v156, 0
  v_mov_b32 v157, 0
  v_mov_b32 v158, 0
  v_mov_b32 v159, 0
  buffer_load_dword v164, v4, s[8:11], s20 offen sc1
  s_nop 7
  buffer_load_dword v165, v4, s[8:11], s20 offen sc1
  s_nop 7
  buffer_load_dword v166, v4, s[8:11], s20 offen sc1
  s_nop 7
  buffer_load_dword v167, v4, s[8:11], s20 offen sc1
  s_nop 7
  buffer_load_dword v168, v4, s[8:11], s20 offen sc1
cA_va1_fw_l:
  s_waitcnt vmcnt(4)
  v_cmp_eq_u32 vcc, -1, v164
  s_cbranch_vccz cA_va1_fw_d
  buffer_load_dword v164, v4, s[8:11], s20 offen sc1
  s_waitcnt vmcnt(4)
  v_cmp_eq_u32 vcc, -1, v165
  s_cbranch_vccz cA_va1_fw_d
  buffer_load_dword v165, v4, s[8:11], s20 offen sc1
  s_waitcnt vmcnt(4)
  v_cmp_eq_u32 vcc, -1, v166
  s_cbranch_vccz cA_va1_fw_d
  buffer_load_dword v166, v4, s[8:11], s20 offen sc1
  s_waitcnt vmcnt(4)
  v_cmp_eq_u32 vcc, -1, v167
  s_cbranch_vccz cA_va1_fw_d
  buffer_load_dword v167, v4, s[8:11], s20 offen sc1
  s_waitcnt vmcnt(4)
  v_cmp_eq_u32 vcc, -1, v168
  s_cbranch_vccz cA_va1_fw_d
  buffer_load_dword v168, v4, s[8:11], s20 offen sc1
  s_add_u32 s30, s30, 1
  s_cmp_lt_u32 s30, 400000
  s_cbranch_scc1 cA_va1_fw_l
  s_branch cA_abort
cA_va1_fw_d:
  s_waitcnt lgkmcnt(0)
  buffer_load_dwordx4 v[8:11], v2, s[8:11], s22 offen offset:0
  v_mov_b32 v36, 0
  v_mov_b32 v37, 0
  v_mov_b32 v38, 0
  buffer_load_dwordx4 v[12:15], v2, s[8:11], s22 offen offset:1024
  v_mov_b32 v39, 0
  v_mov_b32 v40, 0
  v_mov_b32 v41, 0
  buffer_load_dwordx4 v[16:19], v2, s[8:11], s22 offen offset:2048
  v_mov_b32 v42, 0
  v_mov_b32 v43, 0
  v_mov_b32 v44, 0
  buffer_load_dwordx4 v[20:23], v2, s[8:11], s22 offen offset:3072
  v_mov_b32 v45, 0
  v_mov_b32 v46, 0
  v_mov_b32 v47, 0
  buffer_load_dwordx4 v[24:27], v2, s[8:11], s34 offen offset:0
  v_mov_b32 v48, 0
  v_mov_b32 v49, 0
  v_mov_b32 v50, 0
  buffer_load_dwordx4 v[28:31], v2, s[8:11], s34 offen offset:1024
  v_mov_b32 v51, 0
  v_mov_b32 v52, 0
  v_mov_b32 v53, 0
  buffer_load_dwordx4 v[32:35], v2, s[8:11], s34 offen offset:2048
  v_mov_b32 v54, 0
  v_mov_b32 v55, 0
  v_mov_b32 v56, 0
  buffer_load_dwordx4 v[144:147], v2, s[8:11], s34 offen offset:3072
  v_mov_b32 v57, 0
  v_mov_b32 v58, 0
  v_mov_b32 v59, 0
  buffer_load_dwordx4 v[148:151], v2, s[8:11], s36 offen offset:0
  buffer_load_dwordx4 v[152:155], v2, s[8:11], s36 offen offset:1024
  s_barrier
  ds_read_b128 v[64:67], v2 offset:4096
  ds_read_b128 v[68:71], v2 offset:5120
  ds_read_b128 v[72:75], v2 offset:6144
  ds_read_b128 v[76:79], v2 offset:7168
  s_waitcnt vmcnt(9)
  v_smfmac_f32_16x16x64_bf16 v[156:159], v[8:11], v[80:87], v3
  s_waitcnt vmcnt(8)
  v_smfmac_f32_16x16x64_bf16 v[156:159], v[12:15], v[88:95], v3
  s_waitcnt vmcnt(7)
  v_smfmac_f32_16x16x64_bf16 v[156:159], v[16:19], v[96:103], v3
  s_waitcnt vmcnt(6)
  v_smfmac_f32_16x16x64_bf16 v[156:159], v[20:23], v[104:111], v3
  s_waitcnt vmcnt(5)
  v_smfmac_f32_16x16x64_bf16 v[156:159], v[24:27], v[112:119], v3
  s_mov_b32 exec_hi, 0
  buffer_store_dword v2, v7, s[8:11], s21 offen
  s_mov_b64 exec, -1
  s_waitcnt vmcnt(5)
  v_smfmac_f32_16x16x64_bf16 v[156:159], v[28:31], v[120:127], v3
  s_waitcnt vmcnt(4)
  v_smfmac_f32_16x16x64_bf16 v[156:159], v[32:35], v[128:135], v3
  s_waitcnt vmcnt(3)
  v_smfmac_f32_16x16x64_bf16 v[156:159], v[144:147], v[136:143], v3
  s_waitcnt vmcnt(2) lgkmcnt(0)
  v_smfmac_f32_16x16x64_bf16 v[156:159], v[148:151], v[64:71], v3
  s_waitcnt vmcnt(1)
  v_smfmac_f32_16x16x64_bf16 v[156:159], v[152:155], v[72:79], v3
cA_va1_ep:
  s_nop 7
  v_permlane32_swap_b32 v156, v158
  v_permlane32_swap_b32 v157, v159
  v_add_f32 v160, v156, v158
  v_add_f32 v161, v157, v159
  v_cmp_u_f32 vcc, v160, v161
  v_mov_b32_dpp v162, v160 row_ror:8 row_mask:0xf bank_mask:0xf
  v_mov_b32_dpp v160, v161 row_ror:8 row_mask:0xf bank_mask:0xc
  s_cbranch_vccnz cA_va1_rp
  v_mov_b32_dpp v161, v162 quad_perm:[0,1,2,3] row_mask:0xf bank_mask:0x3
  v_cvt_pk_bf16_f32 v160, v160, v161
cA_va1_pc:
  s_mov_b64 exec, s[26:27]
  buffer_store_dword v160, v1, s[8:11], s21 offen
  s_cmp_lg_u32 s19, 62
  s_cbranch_scc1 cA_va1_nl
  s_mov_b32 s22, 88519680
  buffer_store_dword v160, v1, s[8:11], s22 offen sc1
  s_mov_b64 exec, -1
  s_branch cA_done
cA_va1_nl:
  s_mov_b64 exec, -1
  s_add_u32 s25, s25, 28672
  s_add_u32 s19, s19, 1
  s_mov_b32 s20, s21
  s_branch cA_va1_loop
cA_va1_last:
  s_waitcnt lgkmcnt(0)
  s_barrier
  s_branch cA_done
cA_va1_rp:
  s_cmp_eq_u32 s37, 0
  s_cbranch_scc1 cA_va1_rv
  v_mov_b32_dpp v161, v162 quad_perm:[0,1,2,3] row_mask:0xf bank_mask:0x3
  v_cvt_pk_bf16_f32 v160, v160, v161
  v_min_u32 v160, -2, v160
  s_branch cA_va1_pc
cA_va1_rv:
  buffer_load_dwordx4 v[8:11], v2, s[8:11], s22 offen offset:0 sc1
  buffer_load_dwordx4 v[12:15], v2, s[8:11], s22 offen offset:1024 sc1
  buffer_load_dwordx4 v[16:19], v2, s[8:11], s22 offen offset:2048 sc1
  buffer_load_dwordx4 v[20:23], v2, s[8:11], s22 offen offset:3072 sc1
  buffer_load_dwordx4 v[24:27], v2, s[8:11], s34 offen offset:0 sc1
  buffer_load_dwordx4 v[28:31], v2, s[8:11], s34 offen offset:1024 sc1
  buffer_load_dwordx4 v[32:35], v2, s[8:11], s34 offen offset:2048 sc1
  buffer_load_dwordx4 v[144:147], v2, s[8:11], s34 offen offset:3072 sc1
  buffer_load_dwordx4 v[148:151], v2, s[8:11], s36 offen offset:0 sc1
  buffer_load_dwordx4 v[152:155], v2, s[8:11], s36 offen offset:1024 sc1
  s_waitcnt vmcnt(0)
  v_max3_u32 v63, v8, v9, v10
  v_max3_u32 v63, v63, v11, v12
  v_max3_u32 v63, v63, v13, v14
  v_max3_u32 v63, v63, v15, v16
  v_max3_u32 v63, v63, v17, v18
  v_max3_u32 v63, v63, v19, v20
  v_max3_u32 v63, v63, v21, v22
  v_max3_u32 v63, v63, v23, v24
  v_max3_u32 v63, v63, v25, v26
  v_max3_u32 v63, v63, v27, v28
  v_max3_u32 v63, v63, v29, v30
  v_max3_u32 v63, v63, v31, v32
  v_max3_u32 v63, v63, v33, v34
  v_max3_u32 v63, v63, v35, v144
  v_max3_u32 v63, v63, v145, v146
  v_max3_u32 v63, v63, v147, v148
  v_max3_u32 v63, v63, v149, v150
  v_max3_u32 v63, v63, v151, v152
  v_max3_u32 v63, v63, v153, v154
  v_max_u32 v63, v63, v155
  v_cmp_eq_u32 vcc, -1, v63
  s_cbranch_vccz cA_va1_rk
  s_add_u32 s30, s30, 1
  s_cmp_lt_u32 s30, 400000
  s_cbranch_scc1 cA_va1_rv
  s_branch cA_abort
cA_va1_rk:
  s_mov_b32 s37, 1
  s_add_u32 s31, s31, 0x10000
  v_mov_b32 v156, 0
  v_mov_b32 v157, 0
  v_mov_b32 v158, 0
  v_mov_b32 v159, 0
  s_nop 1
  v_smfmac_f32_16x16x64_bf16 v[156:159], v[8:11], v[80:87], v3
  v_smfmac_f32_16x16x64_bf16 v[156:159], v[12:15], v[88:95], v3
  v_smfmac_f32_16x16x64_bf16 v[156:159], v[16:19], v[96:103], v3
  v_smfmac_f32_16x16x64_bf16 v[156:159], v[20:23], v[104:111], v3
  v_smfmac_f32_16x16x64_bf16 v[156:159], v[24:27], v[112:119], v3
  v_smfmac_f32_16x16x64_bf16 v[156:159], v[28:31], v[120:127], v3
  v_smfmac_f32_16x16x64_bf16 v[156:159], v[32:35], v[128:135], v3
  v_smfmac_f32_16x16x64_bf16 v[156:159], v[144:147], v[136:143], v3
  v_smfmac_f32_16x16x64_bf16 v[156:159], v[148:151], v[64:71], v3
  v_smfmac_f32_16x16x64_bf16 v[156:159], v[152:155], v[72:79], v3
  s_nop 7
  s_branch cA_va1_ep
.p2align 6

cA_va2_loop:
  s_add_u32 s23, s20, 4096
  s_add_u32 s21, s20, 25600
  v_mov_b32 v36, 0
  v_mov_b32 v37, 0
  v_mov_b32 v38, 0
  v_mov_b32 v39, 0
  v_mov_b32 v40, 0
  v_mov_b32 v41, 0
  v_mov_b32 v42, 0
  v_mov_b32 v43, 0
  v_mov_b32 v44, 0
  v_mov_b32 v45, 0
  v_mov_b32 v46, 0
  v_mov_b32 v47, 0
  v_mov_b32 v48, 0
  v_mov_b32 v49, 0
  v_mov_b32 v50, 0
  v_mov_b32 v51, 0
  v_mov_b32 v52, 0
  v_mov_b32 v53, 0
  v_mov_b32 v54, 0
  v_mov_b32 v55, 0
  v_mov_b32 v56, 0
  v_mov_b32 v57, 0
  v_mov_b32 v58, 0
  v_mov_b32 v59, 0
  v_mov_b32 v60, 0
  v_mov_b32 v61, 0
  v_mov_b32 v62, 0
  v_mov_b32 v63, 0
  v_mov_b32 v64, 0
  v_mov_b32 v65, 0
  v_mov_b32 v66, 0
  v_mov_b32 v67, 0
  s_mov_b32 s30, 0
  buffer_load_dword v76, v119, s[8:11], s20 offen sc1
  buffer_load_dword v77, v119, s[8:11], s20 offen sc1
  buffer_load_dword v78, v119, s[8:11], s20 offen sc1
cA_va2_fp_l:
  s_waitcnt vmcnt(2)
  v_cmp_eq_u32 vcc, -1, v76
  s_cbranch_vccz cA_va2_fp_d
  buffer_load_dword v76, v119, s[8:11], s20 offen sc1
  s_waitcnt vmcnt(2)
  v_cmp_eq_u32 vcc, -1, v77
  s_cbranch_vccz cA_va2_fp_d
  buffer_load_dword v77, v119, s[8:11], s20 offen sc1
  s_waitcnt vmcnt(2)
  v_cmp_eq_u32 vcc, -1, v78
  s_cbranch_vccz cA_va2_fp_d
  buffer_load_dword v78, v119, s[8:11], s20 offen sc1
  s_add_u32 s30, s30, 1
  s_cmp_lt_u32 s30, 400000
  s_cbranch_scc1 cA_va2_fp_l
  s_branch cA_abort
cA_va2_fp_d:
  buffer_load_dwordx4 v[8:11], v2, s[8:11], s20 offen offset:0 sc1
  buffer_load_dwordx4 v[12:15], v2, s[8:11], s20 offen offset:1024 sc1
  buffer_load_dwordx4 v[16:19], v2, s[8:11], s20 offen offset:2048 sc1
  buffer_load_dwordx4 v[20:23], v2, s[8:11], s20 offen offset:3072 sc1
  s_barrier
cA_va2_ld:
  s_waitcnt vmcnt(0)
  v_max3_u32 v84, v8, v9, v10
  v_max3_u32 v84, v84, v11, v12
  v_max3_u32 v84, v84, v13, v14
  v_max3_u32 v84, v84, v15, v16
  v_max3_u32 v84, v84, v17, v18
  v_max3_u32 v84, v84, v19, v20
  v_max3_u32 v84, v84, v21, v22
  v_max_u32 v84, v84, v23
  v_cmp_eq_u32 vcc, -1, v84
  ds_write_b128 v2, v[8:11] offset:8192
  ds_write_b128 v2, v[12:15] offset:9216
  ds_write_b128 v2, v[16:19] offset:10240
  ds_write_b128 v2, v[20:23] offset:11264
  s_cbranch_vccnz cA_va2_retry
  s_waitcnt lgkmcnt(0)
  s_barrier
  ds_read_b128 v[24:27], v2 offset:12288
  ds_read_b128 v[28:31], v2 offset:13312
  ds_read_b128 v[32:35], v2 offset:14336
  ds_read_b128 v[92:95], v0
  s_waitcnt lgkmcnt(0)
  s_mov_b64 exec, s[26:27]
  buffer_store_dwordx4 v[92:95], v2, s[8:11], s36 offen sc1
  s_mov_b64 exec, -1
  s_add_u32 s36, s36, 7168
  s_cmp_eq_u32 s19, 63
  s_cbranch_scc1 cA_done
  ds_read_b128 v[76:79], v1 offset:0
  ds_read_b128 v[80:83], v1 offset:1024
  ds_read_b128 v[84:87], v1 offset:2048
  ds_read_b128 v[88:91], v1 offset:3072
  ds_read_b128 v[92:95], v1 offset:4096
  ds_read_b128 v[96:99], v1 offset:5120
  v_smfmac_f32_16x16x64_bf16 v[60:63], v[8:11], v[200:207], v3
  v_smfmac_f32_16x16x64_bf16 v[60:63], v[12:15], v[208:215], v3
  s_waitcnt lgkmcnt(4)
  v_smfmac_f32_16x16x64_bf16 v[64:67], v[8:11], v[76:83], v3
  ds_read_b128 v[76:79], v1 offset:6144
  ds_read_b128 v[80:83], v1 offset:7168
  v_smfmac_f32_16x16x64_bf16 v[60:63], v[16:19], v[216:223], v3
  v_smfmac_f32_16x16x64_bf16 v[60:63], v[20:23], v[224:231], v3
  s_waitcnt lgkmcnt(4)
  v_smfmac_f32_16x16x64_bf16 v[64:67], v[12:15], v[84:91], v3
  ds_read_b128 v[84:87], v1 offset:8192
  ds_read_b128 v[88:91], v1 offset:9216
  v_smfmac_f32_16x16x64_bf16 v[60:63], v[24:27], v[232:239], v3
  v_smfmac_f32_16x16x64_bf16 v[60:63], v[28:31], v[240:247], v3
  s_waitcnt lgkmcnt(4)
  v_smfmac_f32_16x16x64_bf16 v[64:67], v[16:19], v[92:99], v3
  ds_read_b128 v[92:95], v1 offset:10240
  ds_read_b128 v[96:99], v1 offset:11264
  v_smfmac_f32_16x16x64_bf16 v[60:63], v[32:35], v[248:255], v3
  v_smfmac_f32_16x16x64_bf16 v[36:39], v[8:11], a[0:7], v3
  s_waitcnt lgkmcnt(4)
  v_smfmac_f32_16x16x64_bf16 v[64:67], v[20:23], v[76:83], v3
  ds_read_b128 v[76:79], v1 offset:12288
  ds_read_b128 v[80:83], v1 offset:13312
  v_smfmac_f32_16x16x64_bf16 v[36:39], v[12:15], a[8:15], v3
  v_smfmac_f32_16x16x64_bf16 v[36:39], v[16:19], a[16:23], v3
  s_waitcnt lgkmcnt(4)
  v_smfmac_f32_16x16x64_bf16 v[64:67], v[24:27], v[84:91], v3
  v_smfmac_f32_16x16x64_bf16 v[36:39], v[20:23], a[24:31], v3
  v_smfmac_f32_16x16x64_bf16 v[36:39], v[24:27], a[32:39], v3
  s_waitcnt lgkmcnt(2)
  v_smfmac_f32_16x16x64_bf16 v[64:67], v[28:31], v[92:99], v3
  v_smfmac_f32_16x16x64_bf16 v[36:39], v[28:31], a[40:47], v3
  v_smfmac_f32_16x16x64_bf16 v[36:39], v[32:35], a[48:55], v3
  s_waitcnt lgkmcnt(0)
  v_smfmac_f32_16x16x64_bf16 v[64:67], v[32:35], v[76:83], v3
  v_smfmac_f32_16x16x64_bf16 v[40:43], v[8:11], a[56:63], v3
  v_smfmac_f32_16x16x64_bf16 v[40:43], v[12:15], a[64:71], v3
  v_smfmac_f32_16x16x64_bf16 v[40:43], v[16:19], a[72:79], v3
  v_smfmac_f32_16x16x64_bf16 v[40:43], v[20:23], a[80:87], v3
  v_permlane32_swap_b32 v60, v64
  v_smfmac_f32_16x16x64_bf16 v[40:43], v[24:27], a[88:95], v3
  v_permlane32_swap_b32 v61, v65
  v_smfmac_f32_16x16x64_bf16 v[40:43], v[28:31], a[96:103], v3
  v_permlane32_swap_b32 v62, v66
  v_smfmac_f32_16x16x64_bf16 v[40:43], v[32:35], a[104:111], v3
  v_permlane32_swap_b32 v63, v67
  v_smfmac_f32_16x16x64_bf16 v[44:47], v[8:11], a[112:119], v3
  v_smfmac_f32_16x16x64_bf16 v[44:47], v[12:15], a[120:127], v3
  v_smfmac_f32_16x16x64_bf16 v[44:47], v[16:19], a[128:135], v3
  v_smfmac_f32_16x16x64_bf16 v[44:47], v[20:23], a[136:143], v3
  v_add_f32 v60, v60, v64
  v_add_f32 v61, v61, v65
  v_smfmac_f32_16x16x64_bf16 v[44:47], v[24:27], a[144:151], v3
  v_add_f32 v62, v62, v66
  v_add_f32 v63, v63, v67
  v_smfmac_f32_16x16x64_bf16 v[44:47], v[28:31], a[152:159], v3
  v_cvt_pk_bf16_f32 v64, v60, v61
  v_cvt_pk_bf16_f32 v65, v62, v63
  v_smfmac_f32_16x16x64_bf16 v[44:47], v[32:35], a[160:167], v3
  ds_write_b64 v115, v[64:65]
  v_smfmac_f32_16x16x64_bf16 v[48:51], v[8:11], a[168:175], v3
  v_permlane32_swap_b32 v36, v40
  v_smfmac_f32_16x16x64_bf16 v[48:51], v[12:15], a[176:183], v3
  v_permlane32_swap_b32 v37, v41
  v_smfmac_f32_16x16x64_bf16 v[48:51], v[16:19], a[184:191], v3
  v_permlane32_swap_b32 v38, v42
  v_smfmac_f32_16x16x64_bf16 v[48:51], v[20:23], a[192:199], v3
  v_permlane32_swap_b32 v39, v43
  v_smfmac_f32_16x16x64_bf16 v[48:51], v[24:27], a[200:207], v3
  v_add_f32 v36, v36, v40
  v_smfmac_f32_16x16x64_bf16 v[48:51], v[28:31], a[208:215], v3
  v_add_f32 v37, v37, v41
  v_smfmac_f32_16x16x64_bf16 v[48:51], v[32:35], a[216:223], v3
  v_add_f32 v38, v38, v42
  v_smfmac_f32_16x16x64_bf16 v[52:55], v[8:11], a[224:231], v3
  v_smfmac_f32_16x16x64_bf16 v[52:55], v[12:15], a[232:239], v3
  v_smfmac_f32_16x16x64_bf16 v[52:55], v[16:19], a[240:247], v3
  v_smfmac_f32_16x16x64_bf16 v[52:55], v[20:23], a[248:255], v3
  v_add_f32 v39, v39, v43
  v_cvt_pk_bf16_f32 v40, v36, v37
  v_smfmac_f32_16x16x64_bf16 v[52:55], v[24:27], v[120:127], v3
  v_cvt_pk_bf16_f32 v41, v38, v39
  v_smfmac_f32_16x16x64_bf16 v[52:55], v[28:31], v[128:135], v3
  ds_write_b64 v112, v[40:41]
  v_smfmac_f32_16x16x64_bf16 v[52:55], v[32:35], v[136:143], v3
  v_permlane32_swap_b32 v44, v48
  v_smfmac_f32_16x16x64_bf16 v[56:59], v[8:11], v[144:151], v3
  v_permlane32_swap_b32 v45, v49
  v_smfmac_f32_16x16x64_bf16 v[56:59], v[12:15], v[152:159], v3
  v_permlane32_swap_b32 v46, v50
  v_smfmac_f32_16x16x64_bf16 v[56:59], v[16:19], v[160:167], v3
  v_permlane32_swap_b32 v47, v51
  v_smfmac_f32_16x16x64_bf16 v[56:59], v[20:23], v[168:175], v3
  v_add_f32 v44, v44, v48
  v_smfmac_f32_16x16x64_bf16 v[56:59], v[24:27], v[176:183], v3
  v_add_f32 v45, v45, v49
  v_smfmac_f32_16x16x64_bf16 v[56:59], v[28:31], v[184:191], v3
  v_add_f32 v46, v46, v50
  v_smfmac_f32_16x16x64_bf16 v[56:59], v[32:35], v[192:199], v3
  v_add_f32 v47, v47, v51
  v_cvt_pk_bf16_f32 v48, v44, v45
  v_cvt_pk_bf16_f32 v49, v46, v47
  ds_write_b64 v113, v[48:49]
  s_nop 3
  v_permlane32_swap_b32 v52, v56
  v_permlane32_swap_b32 v53, v57
  v_permlane32_swap_b32 v54, v58
  v_permlane32_swap_b32 v55, v59
  v_add_f32 v52, v52, v56
  v_add_f32 v53, v53, v57
  v_add_f32 v54, v54, v58
  v_add_f32 v55, v55, v59
  v_cvt_pk_bf16_f32 v56, v52, v53
  v_cvt_pk_bf16_f32 v57, v54, v55
  ds_write_b64 v114, v[56:57]
  s_waitcnt lgkmcnt(0)
  s_barrier
  s_cmp_eq_u32 s19, 62
  s_cbranch_scc1 cA_done
  s_waitcnt vmcnt(0) lgkmcnt(0)
  s_add_u32 s19, s19, 1
  s_mov_b32 s20, s21
  s_branch cA_va2_loop
cA_va2_retry:
  s_waitcnt lgkmcnt(0)
  buffer_load_dwordx4 v[8:11], v2, s[8:11], s20 offen offset:0 sc1
  buffer_load_dwordx4 v[12:15], v2, s[8:11], s20 offen offset:1024 sc1
  buffer_load_dwordx4 v[16:19], v2, s[8:11], s20 offen offset:2048 sc1
  buffer_load_dwordx4 v[20:23], v2, s[8:11], s20 offen offset:3072 sc1
  s_add_u32 s31, s31, 1
  s_add_u32 s30, s30, 1
  s_cmp_lt_u32 s30, 400000
  s_cbranch_scc1 cA_va2_ld
  s_branch cA_abort
cA_va2_last:
  s_waitcnt lgkmcnt(0)
  buffer_store_dwordx4 v[100:103], v2, s[8:11], s24 offen offset:0 sc1
  buffer_store_dwordx4 v[104:107], v2, s[8:11], s24 offen offset:1024 sc1
  buffer_store_dwordx4 v[108:111], v2, s[8:11], s24 offen offset:2048 sc1
  buffer_store_dwordx4 v[4:7], v2, s[8:11], s24 offen offset:3072 sc1
  s_add_u32 s24, s24, 8192
  s_waitcnt vmcnt(0)
  s_mov_b64 exec, 1
  buffer_store_dword v117, v2, s[8:11], s34 offen sc1
  s_mov_b64 exec, -1
  s_add_u32 s34, s34, 8
  s_mov_b64 exec, 1
  buffer_store_dword v117, v2, s[8:11], s34 offen sc1
  s_mov_b64 exec, -1
  s_add_u32 s34, s34, 8
  s_branch cA_done
.p2align 6

cA_va3_loop:
  s_add_u32 s23, s20, 4096
  s_add_u32 s21, s20, 25600
  v_mov_b32 v36, 0
  v_mov_b32 v37, 0
  v_mov_b32 v38, 0
  v_mov_b32 v39, 0
  v_mov_b32 v40, 0
  v_mov_b32 v41, 0
  v_mov_b32 v42, 0
  v_mov_b32 v43, 0
  v_mov_b32 v44, 0
  v_mov_b32 v45, 0
  v_mov_b32 v46, 0
  v_mov_b32 v47, 0
  v_mov_b32 v48, 0
  v_mov_b32 v49, 0
  v_mov_b32 v50, 0
  v_mov_b32 v51, 0
  v_mov_b32 v52, 0
  v_mov_b32 v53, 0
  v_mov_b32 v54, 0
  v_mov_b32 v55, 0
  v_mov_b32 v56, 0
  v_mov_b32 v57, 0
  v_mov_b32 v58, 0
  v_mov_b32 v59, 0
  v_mov_b32 v60, 0
  v_mov_b32 v61, 0
  v_mov_b32 v62, 0
  v_mov_b32 v63, 0
  v_mov_b32 v64, 0
  v_mov_b32 v65, 0
  v_mov_b32 v66, 0
  v_mov_b32 v67, 0
  s_mov_b32 s30, 0
  buffer_load_dword v76, v119, s[8:11], s20 offen sc1
  buffer_load_dword v77, v119, s[8:11], s20 offen sc1
  buffer_load_dword v78, v119, s[8:11], s20 offen sc1
cA_va3_fp_l:
  s_waitcnt vmcnt(2)
  v_cmp_eq_u32 vcc, -1, v76
  s_cbranch_vccz cA_va3_fp_d
  buffer_load_dword v76, v119, s[8:11], s20 offen sc1
  s_waitcnt vmcnt(2)
  v_cmp_eq_u32 vcc, -1, v77
  s_cbranch_vccz cA_va3_fp_d
  buffer_load_dword v77, v119, s[8:11], s20 offen sc1
  s_waitcnt vmcnt(2)
  v_cmp_eq_u32 vcc, -1, v78
  s_cbranch_vccz cA_va3_fp_d
  buffer_load_dword v78, v119, s[8:11], s20 offen sc1
  s_add_u32 s30, s30, 1
  s_cmp_lt_u32 s30, 400000
  s_cbranch_scc1 cA_va3_fp_l
  s_branch cA_abort
cA_va3_fp_d:
  buffer_load_dwordx4 v[24:27], v2, s[8:11], s23 offen offset:0 sc1
  buffer_load_dwordx4 v[28:31], v2, s[8:11], s23 offen offset:1024 sc1
  buffer_load_dwordx4 v[32:35], v2, s[8:11], s23 offen offset:2048 sc1
  s_barrier
cA_va3_ld:
  s_waitcnt vmcnt(0)
  v_max3_u32 v84, v24, v25, v26
  v_max3_u32 v84, v84, v27, v28
  v_max3_u32 v84, v84, v29, v30
  v_max3_u32 v84, v84, v31, v32
  v_max3_u32 v84, v84, v33, v34
  v_max_u32 v84, v84, v35
  v_cmp_eq_u32 vcc, -1, v84
  ds_write_b128 v2, v[24:27] offset:12288
  ds_write_b128 v2, v[28:31] offset:13312
  ds_write_b128 v2, v[32:35] offset:14336
  s_cbranch_vccnz cA_va3_retry
  s_waitcnt lgkmcnt(0)
  s_barrier
  ds_read_b128 v[8:11], v2 offset:8192
  ds_read_b128 v[12:15], v2 offset:9216
  ds_read_b128 v[16:19], v2 offset:10240
  ds_read_b128 v[20:23], v2 offset:11264
  s_waitcnt lgkmcnt(0)
  s_cmp_eq_u32 s19, 63
  s_cbranch_scc1 cA_done
  ds_read_b128 v[76:79], v1 offset:0
  ds_read_b128 v[80:83], v1 offset:1024
  ds_read_b128 v[84:87], v1 offset:2048
  ds_read_b128 v[88:91], v1 offset:3072
  ds_read_b128 v[92:95], v1 offset:4096
  ds_read_b128 v[96:99], v1 offset:5120
  v_smfmac_f32_16x16x64_bf16 v[60:63], v[8:11], v[200:207], v3
  v_smfmac_f32_16x16x64_bf16 v[60:63], v[12:15], v[208:215], v3
  s_waitcnt lgkmcnt(4)
  v_smfmac_f32_16x16x64_bf16 v[64:67], v[8:11], v[76:83], v3
  ds_read_b128 v[76:79], v1 offset:6144
  ds_read_b128 v[80:83], v1 offset:7168
  v_smfmac_f32_16x16x64_bf16 v[60:63], v[16:19], v[216:223], v3
  v_smfmac_f32_16x16x64_bf16 v[60:63], v[20:23], v[224:231], v3
  s_waitcnt lgkmcnt(4)
  v_smfmac_f32_16x16x64_bf16 v[64:67], v[12:15], v[84:91], v3
  ds_read_b128 v[84:87], v1 offset:8192
  ds_read_b128 v[88:91], v1 offset:9216
  v_smfmac_f32_16x16x64_bf16 v[60:63], v[24:27], v[232:239], v3
  v_smfmac_f32_16x16x64_bf16 v[60:63], v[28:31], v[240:247], v3
  s_waitcnt lgkmcnt(4)
  v_smfmac_f32_16x16x64_bf16 v[64:67], v[16:19], v[92:99], v3
  ds_read_b128 v[92:95], v1 offset:10240
  ds_read_b128 v[96:99], v1 offset:11264
  v_smfmac_f32_16x16x64_bf16 v[60:63], v[32:35], v[248:255], v3
  v_smfmac_f32_16x16x64_bf16 v[36:39], v[8:11], a[0:7], v3
  s_waitcnt lgkmcnt(4)
  v_smfmac_f32_16x16x64_bf16 v[64:67], v[20:23], v[76:83], v3
  ds_read_b128 v[76:79], v1 offset:12288
  ds_read_b128 v[80:83], v1 offset:13312
  v_smfmac_f32_16x16x64_bf16 v[36:39], v[12:15], a[8:15], v3
  v_smfmac_f32_16x16x64_bf16 v[36:39], v[16:19], a[16:23], v3
  s_waitcnt lgkmcnt(4)
  v_smfmac_f32_16x16x64_bf16 v[64:67], v[24:27], v[84:91], v3
  v_smfmac_f32_16x16x64_bf16 v[36:39], v[20:23], a[24:31], v3
  v_smfmac_f32_16x16x64_bf16 v[36:39], v[24:27], a[32:39], v3
  s_waitcnt lgkmcnt(2)
  v_smfmac_f32_16x16x64_bf16 v[64:67], v[28:31], v[92:99], v3
  v_smfmac_f32_16x16x64_bf16 v[36:39], v[28:31], a[40:47], v3
  v_smfmac_f32_16x16x64_bf16 v[36:39], v[32:35], a[48:55], v3
  s_waitcnt lgkmcnt(0)
  v_smfmac_f32_16x16x64_bf16 v[64:67], v[32:35], v[76:83], v3
  v_smfmac_f32_16x16x64_bf16 v[40:43], v[8:11], a[56:63], v3
  v_smfmac_f32_16x16x64_bf16 v[40:43], v[12:15], a[64:71], v3
  v_smfmac_f32_16x16x64_bf16 v[40:43], v[16:19], a[72:79], v3
  v_smfmac_f32_16x16x64_bf16 v[40:43], v[20:23], a[80:87], v3
  v_permlane32_swap_b32 v60, v64
  v_smfmac_f32_16x16x64_bf16 v[40:43], v[24:27], a[88:95], v3
  v_permlane32_swap_b32 v61, v65
  v_smfmac_f32_16x16x64_bf16 v[40:43], v[28:31], a[96:103], v3
  v_permlane32_swap_b32 v62, v66
  v_smfmac_f32_16x16x64_bf16 v[40:43], v[32:35], a[104:111], v3
  v_permlane32_swap_b32 v63, v67
  v_smfmac_f32_16x16x64_bf16 v[44:47], v[8:11], a[112:119], v3
  v_smfmac_f32_16x16x64_bf16 v[44:47], v[12:15], a[120:127], v3
  v_smfmac_f32_16x16x64_bf16 v[44:47], v[16:19], a[128:135], v3
  v_smfmac_f32_16x16x64_bf16 v[44:47], v[20:23], a[136:143], v3
  v_add_f32 v60, v60, v64
  v_add_f32 v61, v61, v65
  v_smfmac_f32_16x16x64_bf16 v[44:47], v[24:27], a[144:151], v3
  v_add_f32 v62, v62, v66
  v_add_f32 v63, v63, v67
  v_smfmac_f32_16x16x64_bf16 v[44:47], v[28:31], a[152:159], v3
  v_cvt_pk_bf16_f32 v64, v60, v61
  v_cvt_pk_bf16_f32 v65, v62, v63
  v_smfmac_f32_16x16x64_bf16 v[44:47], v[32:35], a[160:167], v3
  ds_write_b64 v115, v[64:65]
  v_smfmac_f32_16x16x64_bf16 v[48:51], v[8:11], a[168:175], v3
  v_permlane32_swap_b32 v36, v40
  v_smfmac_f32_16x16x64_bf16 v[48:51], v[12:15], a[176:183], v3
  v_permlane32_swap_b32 v37, v41
  v_smfmac_f32_16x16x64_bf16 v[48:51], v[16:19], a[184:191], v3
  v_permlane32_swap_b32 v38, v42
  v_smfmac_f32_16x16x64_bf16 v[48:51], v[20:23], a[192:199], v3
  v_permlane32_swap_b32 v39, v43
  v_smfmac_f32_16x16x64_bf16 v[48:51], v[24:27], a[200:207], v3
  v_add_f32 v36, v36, v40
  v_smfmac_f32_16x16x64_bf16 v[48:51], v[28:31], a[208:215], v3
  v_add_f32 v37, v37, v41
  v_smfmac_f32_16x16x64_bf16 v[48:51], v[32:35], a[216:223], v3
  v_add_f32 v38, v38, v42
  v_smfmac_f32_16x16x64_bf16 v[52:55], v[8:11], a[224:231], v3
  v_smfmac_f32_16x16x64_bf16 v[52:55], v[12:15], a[232:239], v3
  v_smfmac_f32_16x16x64_bf16 v[52:55], v[16:19], a[240:247], v3
  v_smfmac_f32_16x16x64_bf16 v[52:55], v[20:23], a[248:255], v3
  v_add_f32 v39, v39, v43
  v_cvt_pk_bf16_f32 v40, v36, v37
  v_smfmac_f32_16x16x64_bf16 v[52:55], v[24:27], v[120:127], v3
  v_cvt_pk_bf16_f32 v41, v38, v39
  v_smfmac_f32_16x16x64_bf16 v[52:55], v[28:31], v[128:135], v3
  ds_write_b64 v112, v[40:41]
  v_smfmac_f32_16x16x64_bf16 v[52:55], v[32:35], v[136:143], v3
  v_permlane32_swap_b32 v44, v48
  v_smfmac_f32_16x16x64_bf16 v[56:59], v[8:11], v[144:151], v3
  v_permlane32_swap_b32 v45, v49
  v_smfmac_f32_16x16x64_bf16 v[56:59], v[12:15], v[152:159], v3
  v_permlane32_swap_b32 v46, v50
  v_smfmac_f32_16x16x64_bf16 v[56:59], v[16:19], v[160:167], v3
  v_permlane32_swap_b32 v47, v51
  v_smfmac_f32_16x16x64_bf16 v[56:59], v[20:23], v[168:175], v3
  v_add_f32 v44, v44, v48
  v_smfmac_f32_16x16x64_bf16 v[56:59], v[24:27], v[176:183], v3
  v_add_f32 v45, v45, v49
  v_smfmac_f32_16x16x64_bf16 v[56:59], v[28:31], v[184:191], v3
  v_add_f32 v46, v46, v50
  v_smfmac_f32_16x16x64_bf16 v[56:59], v[32:35], v[192:199], v3
  v_add_f32 v47, v47, v51
  v_cvt_pk_bf16_f32 v48, v44, v45
  v_cvt_pk_bf16_f32 v49, v46, v47
  ds_write_b64 v113, v[48:49]
  s_nop 3
  v_permlane32_swap_b32 v52, v56
  v_permlane32_swap_b32 v53, v57
  v_permlane32_swap_b32 v54, v58
  v_permlane32_swap_b32 v55, v59
  v_add_f32 v52, v52, v56
  v_add_f32 v53, v53, v57
  v_add_f32 v54, v54, v58
  v_add_f32 v55, v55, v59
  v_cvt_pk_bf16_f32 v56, v52, v53
  v_cvt_pk_bf16_f32 v57, v54, v55
  ds_write_b64 v114, v[56:57]
  s_waitcnt lgkmcnt(0)
  s_barrier
  s_cmp_eq_u32 s19, 62
  s_cbranch_scc1 cA_done
  s_waitcnt vmcnt(0) lgkmcnt(0)
  s_add_u32 s19, s19, 1
  s_mov_b32 s20, s21
  s_branch cA_va3_loop
cA_va3_retry:
  s_waitcnt lgkmcnt(0)
  buffer_load_dwordx4 v[24:27], v2, s[8:11], s23 offen offset:0 sc1
  buffer_load_dwordx4 v[28:31], v2, s[8:11], s23 offen offset:1024 sc1
  buffer_load_dwordx4 v[32:35], v2, s[8:11], s23 offen offset:2048 sc1
  s_add_u32 s31, s31, 1
  s_add_u32 s30, s30, 1
  s_cmp_lt_u32 s30, 400000
  s_cbranch_scc1 cA_va3_ld
  s_branch cA_abort
cA_va3_last:
  s_waitcnt lgkmcnt(0)
  buffer_store_dwordx4 v[100:103], v2, s[8:11], s24 offen offset:0 sc1
  buffer_store_dwordx4 v[104:107], v2, s[8:11], s24 offen offset:1024 sc1
  buffer_store_dwordx4 v[108:111], v2, s[8:11], s24 offen offset:2048 sc1
  buffer_store_dwordx4 v[4:7], v2, s[8:11], s24 offen offset:3072 sc1
  s_add_u32 s24, s24, 8192
  s_waitcnt vmcnt(0)
  s_mov_b64 exec, 1
  buffer_store_dword v117, v2, s[8:11], s34 offen sc1
  s_mov_b64 exec, -1
  s_add_u32 s34, s34, 8
  s_mov_b64 exec, 1
  buffer_store_dword v117, v2, s[8:11], s34 offen sc1
  s_mov_b64 exec, -1
  s_add_u32 s34, s34, 8
  s_branch cA_done
cA_abort:
  v_mov_b32 v4, 0xdead
  v_mov_b32 v5, 16
  buffer_store_dword v4, v5, s[12:15], 0 offen
  s_branch ch_end
cA_done:
  s_branch ch_end
.p2align 6

cB_sc0_loop:
  s_add_u32 s23, s20, 4096
  s_add_u32 s21, s20, 25600
  v_mov_b32 v48, 0
  v_mov_b32 v49, 0
  v_mov_b32 v50, 0
  v_mov_b32 v51, 0
  v_mov_b32 v52, 0
  v_mov_b32 v53, 0
  v_mov_b32 v54, 0
  v_mov_b32 v55, 0
  v_mov_b32 v56, 0
  v_mov_b32 v57, 0
  v_mov_b32 v58, 0
  v_mov_b32 v59, 0
  v_mov_b32 v60, 0
  v_mov_b32 v61, 0
  v_mov_b32 v62, 0
  v_mov_b32 v63, 0
  v_mov_b32 v88, 0
  v_mov_b32 v89, 0
  v_mov_b32 v90, 0
  v_mov_b32 v91, 0
  v_mov_b32 v92, 0
  v_mov_b32 v93, 0
  v_mov_b32 v94, 0
  v_mov_b32 v95, 0
  v_mov_b32 v66, 0
  v_mov_b32 v67, 0
  s_mov_b32 s30, 0
  s_mov_b32 s62, 0
  buffer_load_dword v68, v0, s[8:11], s20 offen sc1
  s_nop 7
  buffer_load_dword v69, v0, s[8:11], s20 offen sc1
  s_nop 7
  buffer_load_dword v70, v0, s[8:11], s20 offen sc1
  s_nop 7
  buffer_load_dword v71, v0, s[8:11], s20 offen sc1
  s_nop 7
  buffer_load_dword v72, v0, s[8:11], s20 offen sc1
cB_sc0_fp_l:
  s_waitcnt vmcnt(4)
  v_cmp_eq_u32 vcc, -1, v68
  s_cbranch_vccz cB_sc0_fp_d
  buffer_load_dword v68, v0, s[8:11], s20 offen sc1
  s_waitcnt vmcnt(4)
  v_cmp_eq_u32 vcc, -1, v69
  s_cbranch_vccz cB_sc0_fp_d
  buffer_load_dword v69, v0, s[8:11], s20 offen sc1
  s_waitcnt vmcnt(4)
  v_cmp_eq_u32 vcc, -1, v70
  s_cbranch_vccz cB_sc0_fp_d
  buffer_load_dword v70, v0, s[8:11], s20 offen sc1
  s_waitcnt vmcnt(4)
  v_cmp_eq_u32 vcc, -1, v71
  s_cbranch_vccz cB_sc0_fp_d
  buffer_load_dword v71, v0, s[8:11], s20 offen sc1
  s_waitcnt vmcnt(4)
  v_cmp_eq_u32 vcc, -1, v72
  s_cbranch_vccz cB_sc0_fp_d
  buffer_load_dword v72, v0, s[8:11], s20 offen sc1
  s_add_u32 s30, s30, 1
  s_cmp_lt_u32 s30, 400000
  s_cbranch_scc1 cB_sc0_fp_l
  s_branch cB_abort
cB_sc0_fp_d:
  buffer_load_dwordx4 v[8:11], v2, s[8:11], s20 offen offset:0 sc1
  s_barrier
  s_branch cB_sc0_ld1
cB_sc0_ld:
  buffer_load_dwordx4 v[8:11], v2, s[8:11], s20 offen offset:0 sc1
cB_sc0_ld1:
  v_mov_b32 v36, 0
  v_mov_b32 v37, 0
  v_mov_b32 v38, 0
  v_mov_b32 v39, 0
  buffer_load_dwordx4 v[12:15], v2, s[8:11], s20 offen offset:1024 sc1
  v_mov_b32 v40, 0
  v_mov_b32 v41, 0
  v_mov_b32 v42, 0
  v_mov_b32 v43, 0
  buffer_load_dwordx4 v[16:19], v2, s[8:11], s20 offen offset:2048 sc1
  v_mov_b32 v44, 0
  v_mov_b32 v45, 0
  v_mov_b32 v46, 0
  v_mov_b32 v47, 0
  ds_read_b128 v[96:99], v117 offset:0
  ds_read_b128 v[100:103], v117 offset:1024
  ds_read_b128 v[104:107], v117 offset:14336
  ds_read_b128 v[108:111], v117 offset:15360
  s_waitcnt vmcnt(2)
  v_smfmac_f32_16x16x64_bf16 v[36:39], v[8:11], a[0:7], v3
  v_smfmac_f32_16x16x64_bf16 v[40:43], v[8:11], a[56:63], v3
  buffer_load_dwordx4 v[20:23], v2, s[8:11], s20 offen offset:3072 sc1
  v_smfmac_f32_16x16x64_bf16 v[44:47], v[8:11], a[112:119], v3
  v_smfmac_f32_16x16x64_bf16 v[48:51], v[8:11], a[168:175], v3
  v_smfmac_f32_16x16x64_bf16 v[52:55], v[8:11], a[224:231], v3
  buffer_load_dwordx4 v[24:27], v2, s[8:11], s23 offen offset:0 sc1
  v_smfmac_f32_16x16x64_bf16 v[56:59], v[8:11], v[144:151], v3
  v_smfmac_f32_16x16x64_bf16 v[60:63], v[8:11], v[200:207], v3
  s_waitcnt vmcnt(3)
  v_smfmac_f32_16x16x64_bf16 v[36:39], v[12:15], a[8:15], v3
  v_smfmac_f32_16x16x64_bf16 v[40:43], v[12:15], a[64:71], v3
  buffer_load_dwordx4 v[28:31], v2, s[8:11], s23 offen offset:1024 sc1
  v_smfmac_f32_16x16x64_bf16 v[44:47], v[12:15], a[120:127], v3
  v_smfmac_f32_16x16x64_bf16 v[48:51], v[12:15], a[176:183], v3
  v_smfmac_f32_16x16x64_bf16 v[52:55], v[12:15], a[232:239], v3
  buffer_load_dwordx4 v[32:35], v2, s[8:11], s23 offen offset:2048 sc1
  v_smfmac_f32_16x16x64_bf16 v[56:59], v[12:15], v[152:159], v3
  v_smfmac_f32_16x16x64_bf16 v[60:63], v[12:15], v[208:215], v3
  s_waitcnt vmcnt(4)
  v_smfmac_f32_16x16x64_bf16 v[36:39], v[16:19], a[16:23], v3
  v_smfmac_f32_16x16x64_bf16 v[40:43], v[16:19], a[72:79], v3
  v_smfmac_f32_16x16x64_bf16 v[44:47], v[16:19], a[128:135], v3
  v_smfmac_f32_16x16x64_bf16 v[48:51], v[16:19], a[184:191], v3
  v_smfmac_f32_16x16x64_bf16 v[52:55], v[16:19], a[240:247], v3
  v_smfmac_f32_16x16x64_bf16 v[56:59], v[16:19], v[160:167], v3
  v_smfmac_f32_16x16x64_bf16 v[60:63], v[16:19], v[216:223], v3
  s_waitcnt vmcnt(3)
  v_smfmac_f32_16x16x64_bf16 v[36:39], v[20:23], a[24:31], v3
  v_smfmac_f32_16x16x64_bf16 v[40:43], v[20:23], a[80:87], v3
  v_smfmac_f32_16x16x64_bf16 v[44:47], v[20:23], a[136:143], v3
  v_smfmac_f32_16x16x64_bf16 v[48:51], v[20:23], a[192:199], v3
  v_smfmac_f32_16x16x64_bf16 v[52:55], v[20:23], a[248:255], v3
  v_smfmac_f32_16x16x64_bf16 v[56:59], v[20:23], v[168:175], v3
  v_smfmac_f32_16x16x64_bf16 v[60:63], v[20:23], v[224:231], v3
  s_waitcnt vmcnt(0)
cB_sc0_ph2:
  v_smfmac_f32_16x16x64_bf16 v[60:63], v[24:27], v[232:239], v3
  ds_read_b128 v[12:15], v116 offset:0
  ds_read_b128 v[16:19], v116 offset:1024
  v_smfmac_f32_16x16x64_bf16 v[60:63], v[28:31], v[240:247], v3
  v_smfmac_f32_16x16x64_bf16 v[60:63], v[32:35], v[248:255], v3
  v_mov_b32 v80, v24
  v_smfmac_f32_16x16x64_bf16 v[52:55], v[24:27], v[120:127], v3
  v_mov_b32 v81, v25
  v_smfmac_f32_16x16x64_bf16 v[52:55], v[28:31], v[128:135], v3
  v_mov_b32 v82, v32
  v_smfmac_f32_16x16x64_bf16 v[52:55], v[32:35], v[136:143], v3
  v_cvt_pk_bf16_f32 v64, v60, v61
  v_smfmac_f32_16x16x64_bf16 v[56:59], v[24:27], v[176:183], v3
  v_cvt_pk_bf16_f32 v65, v62, v63
  v_smfmac_f32_16x16x64_bf16 v[56:59], v[28:31], v[184:191], v3
  v_mov_b32 v83, v33
  v_mfma_f32_16x16x32_bf16 v[68:71], v[64:67], v[4:7], 0
  v_smfmac_f32_16x16x64_bf16 v[56:59], v[32:35], v[192:199], v3
  v_cvt_pk_bf16_f32 v64, v52, v53
  v_smfmac_f32_16x16x64_bf16 v[36:39], v[24:27], a[32:39], v3
  v_cvt_pk_bf16_f32 v65, v54, v55
  v_smfmac_f32_16x16x64_bf16 v[36:39], v[28:31], a[40:47], v3
  v_cvt_pk_bf16_f32 v78, v68, v69
  v_smfmac_f32_16x16x64_bf16 v[36:39], v[32:35], a[48:55], v3
  v_cvt_pk_bf16_f32 v79, v70, v71
  v_cvt_pk_bf16_f32 v66, v56, v57
  v_smfmac_f32_16x16x64_bf16 v[40:43], v[24:27], a[88:95], v3
  v_cvt_pk_bf16_f32 v67, v58, v59
  v_smfmac_f32_16x16x64_bf16 v[40:43], v[28:31], a[96:103], v3
  v_mfma_f32_16x16x32_bf16 v[72:75], v[64:67], v[4:7], 0
  ds_read_b128 v[52:55], v116 offset:14336
  ds_read_b128 v[56:59], v116 offset:15360
  v_smfmac_f32_16x16x64_bf16 v[40:43], v[32:35], a[104:111], v3
  v_cvt_pk_bf16_f32 v64, v36, v37
  v_smfmac_f32_16x16x64_bf16 v[44:47], v[24:27], a[144:151], v3
  v_cvt_pk_bf16_f32 v65, v38, v39
  v_smfmac_f32_16x16x64_bf16 v[44:47], v[28:31], a[152:159], v3
  v_cvt_pk_bf16_f32 v76, v72, v73
  v_smfmac_f32_16x16x64_bf16 v[44:47], v[32:35], a[160:167], v3
  v_cvt_pk_bf16_f32 v77, v74, v75
  v_cvt_pk_bf16_f32 v66, v40, v41
  v_smfmac_f32_16x16x64_bf16 v[48:51], v[24:27], a[200:207], v3
  v_cvt_pk_bf16_f32 v67, v42, v43
  v_smfmac_f32_16x16x64_bf16 v[48:51], v[28:31], a[208:215], v3
  v_mfma_f32_16x16x32_bf16 v[68:71], v[64:67], v[4:7], 0
  v_smfmac_f32_16x16x64_bf16 v[48:51], v[32:35], a[216:223], v3
  v_cvt_pk_bf16_f32 v64, v44, v45
  v_mfma_f32_16x16x32_bf16 v[84:87], v[80:83], v[76:79], 0
  v_cvt_pk_bf16_f32 v65, v46, v47
  s_waitcnt lgkmcnt(0)
  v_smfmac_f32_16x16x64_bf16 v[88:91], v[76:79], v[96:103], v3
  v_cvt_pk_bf16_f32 v60, v68, v69
  v_cvt_pk_bf16_f32 v61, v70, v71
  v_cvt_pk_bf16_f32 v66, v48, v49
  v_cvt_pk_bf16_f32 v67, v50, v51
  s_nop 1
  v_mfma_f32_16x16x32_bf16 v[72:75], v[64:67], v[4:7], 0
  v_smfmac_f32_16x16x64_bf16 v[92:95], v[76:79], v[104:111], v3
  s_nop 4
  v_cvt_pk_bf16_f32 v62, v72, v73
  v_cvt_pk_bf16_f32 v63, v74, v75
  s_nop 1
  v_mfma_f32_16x16x32_bf16 v[84:87], v[8:11], v[60:63], v[84:87]
  v_smfmac_f32_16x16x64_bf16 v[88:91], v[60:63], v[12:19], v3
  v_smfmac_f32_16x16x64_bf16 v[92:95], v[60:63], v[52:59], v3
  s_mov_b64 exec, s[26:27]
  s_nop 0
  ds_write_b128 v113, v[84:87]
  s_mov_b64 exec, -1
  s_nop 0
  v_cmp_u_f32 vcc, v88, v89
  s_nop 1
  v_permlane32_swap_b32 v88, v92
  v_permlane32_swap_b32 v89, v93
  v_permlane32_swap_b32 v90, v94
  v_permlane32_swap_b32 v91, v95
  v_add_f32 v88, v88, v92
  v_add_f32 v89, v89, v93
  v_add_f32 v90, v90, v94
  v_add_f32 v91, v91, v95
  ds_write_b128 v112, v[88:91]
  s_cbranch_vccnz cB_sc0_retry
cB_sc0_cont:
  s_waitcnt lgkmcnt(0)
  s_barrier
  ds_read_b64 v[36:37], v114 offset:0
  ds_read_b64 v[38:39], v114 offset:1024
  ds_read2_b32 v[44:45], v115 offset0:0 offset1:64
  s_waitcnt lgkmcnt(0)
  v_add_f32 v44, v44, v45
  v_add_f32 v36, v36, v38
  v_add_f32 v37, v37, v39
  v_add_f32_dpp v44, v44, v44 row_ror:8 row_mask:0xf bank_mask:0xf
  v_mov_b32 v45, v44
  v_permlane32_swap_b32 v36, v37
  v_add_f32 v36, v36, v37
  v_permlane16_swap_b32 v44, v45
  v_add_f32 v44, v44, v45
  v_exp_f32 v48, v36
  v_exp_f32 v49, v44
  v_add_f32 v50, abs(v36), abs(v44)
  v_fma_f32 v39, v49, s37, v48
  v_cmp_ngt_f32 vcc, s56, v50
  v_cndmask_b32 v41, v48, v49, s[38:39]
  v_add_f32_dpp v39, v39, v39 quad_perm:[1,0,3,2] row_mask:0xf bank_mask:0xf
  v_cndmask_b32 v40, v49, v48, s[38:39]
  v_mov_b32_dpp v46, v41 quad_perm:[1,0,3,2] row_mask:0xf bank_mask:0xf
  v_add_f32_dpp v39, v39, v39 quad_perm:[2,3,0,1] row_mask:0xf bank_mask:0xf
  v_cndmask_b32 v42, v46, v40, s[38:39]
  v_cndmask_b32 v43, v40, v46, s[38:39]
  v_add_f32_dpp v39, v39, v39 row_half_mirror row_mask:0xf bank_mask:0xf
  s_cbranch_vccnz cB_sc0_slow
  s_nop 0
  v_add_f32_dpp v39, v39, v39 row_mirror row_mask:0xf bank_mask:0xf
  v_mov_b32 v47, v39
  s_nop 1
  v_permlane16_swap_b32 v39, v47
  v_add_f32 v39, v39, v47
  v_rcp_f32 v39, v39
  s_mov_b64 exec, s[28:29]
  v_mul_f32 v42, v42, v39
  v_mul_f32 v43, v43, v39
  v_cvt_pk_bf16_f32 v42, v42, v43
cB_sc0_pst:
  buffer_store_dword v42, v1, s[8:11], s20 offen sc1
  s_mov_b64 exec, -1
  s_barrier
  s_add_u32 s24, s24, 28672
  s_add_u32 s35, s35, 28672
  s_xor_b32 s25, s25, 28672
  s_add_u32 m0, s25, 0
  s_nop 0
  buffer_load_dwordx4 v2, s[8:11], s24 offen offset:0 sc1 lds
  buffer_load_dwordx4 v2, s[8:11], s24 offen offset:1024 sc1 lds
  buffer_load_dwordx4 v2, s[8:11], s24 offen offset:2048 sc1 lds
  buffer_load_dwordx4 v2, s[8:11], s24 offen offset:3072 sc1 lds
  s_add_u32 m0, s25, 4096
  s_add_u32 s22, s24, 4096
  buffer_load_dwordx4 v2, s[8:11], s22 offen offset:0 sc1 lds
  buffer_load_dwordx4 v2, s[8:11], s22 offen offset:1024 sc1 lds
  buffer_load_dwordx4 v2, s[8:11], s22 offen offset:2048 sc1 lds
  v_xor_b32 v116, 28672, v116
  v_add_u32 v117, s57, v117
  s_sub_u32 s57, 0, s57
  s_add_u32 s19, s19, 1
  s_mov_b32 s20, s21
  s_cmp_lt_u32 s19, 63
  s_cbranch_scc1 cB_sc0_loop
  s_branch cB_done
cB_sc0_slow:
  v_max_f32 v50, v36, v44
  s_nop 1
  v_max_f32_dpp v50, v50, v50 quad_perm:[1,0,3,2] row_mask:0xf bank_mask:0xf
  s_nop 1
  v_max_f32_dpp v50, v50, v50 quad_perm:[2,3,0,1] row_mask:0xf bank_mask:0xf
  s_nop 1
  v_max_f32_dpp v50, v50, v50 row_half_mirror row_mask:0xf bank_mask:0xf
  s_nop 1
  v_max_f32_dpp v50, v50, v50 row_mirror row_mask:0xf bank_mask:0xf
  v_mov_b32 v47, v50
  s_nop 1
  v_permlane16_swap_b32 v50, v47
  v_max_f32 v50, v50, v47
  v_sub_f32 v48, v36, v50
  v_sub_f32 v49, v44, v50
  v_exp_f32 v48, v48
  v_exp_f32 v49, v49
  s_add_u32 s31, s31, 0x100
  v_fma_f32 v39, v49, s37, v48
  v_cndmask_b32 v41, v48, v49, s[38:39]
  s_nop 0
  v_add_f32_dpp v39, v39, v39 quad_perm:[1,0,3,2] row_mask:0xf bank_mask:0xf
  v_cndmask_b32 v40, v49, v48, s[38:39]
  v_mov_b32_dpp v46, v41 quad_perm:[1,0,3,2] row_mask:0xf bank_mask:0xf
  v_add_f32_dpp v39, v39, v39 quad_perm:[2,3,0,1] row_mask:0xf bank_mask:0xf
  v_cndmask_b32 v42, v46, v40, s[38:39]
  v_cndmask_b32 v43, v40, v46, s[38:39]
  v_add_f32_dpp v39, v39, v39 row_half_mirror row_mask:0xf bank_mask:0xf
  s_nop 1
  v_add_f32_dpp v39, v39, v39 row_mirror row_mask:0xf bank_mask:0xf
  v_mov_b32 v47, v39
  s_nop 1
  v_permlane16_swap_b32 v39, v47
  v_add_f32 v39, v39, v47
  v_rcp_f32 v39, v39
  s_mov_b64 exec, s[28:29]
  v_mul_f32 v42, v42, v39
  v_mul_f32 v43, v43, v39
  v_cvt_pk_bf16_f32 v42, v42, v43
  v_min_u32 v42, -2, v42
  s_branch cB_sc0_pst
cB_sc0_retry:
  s_cmp_lg_u32 s62, 0
  s_cbranch_scc1 cB_sc0_cont
  s_waitcnt vmcnt(0) lgkmcnt(0)
cB_sc0_rv:
  buffer_load_dwordx4 v[8:11], v2, s[8:11], s20 offen offset:0 sc1
  buffer_load_dwordx4 v[12:15], v2, s[8:11], s20 offen offset:1024 sc1
  buffer_load_dwordx4 v[16:19], v2, s[8:11], s20 offen offset:2048 sc1
  buffer_load_dwordx4 v[20:23], v2, s[8:11], s20 offen offset:3072 sc1
  buffer_load_dwordx4 v[24:27], v2, s[8:11], s23 offen offset:0 sc1
  buffer_load_dwordx4 v[28:31], v2, s[8:11], s23 offen offset:1024 sc1
  buffer_load_dwordx4 v[32:35], v2, s[8:11], s23 offen offset:2048 sc1
  s_waitcnt vmcnt(0)
  v_max3_u32 v118, v8, v9, v10
  v_max3_u32 v118, v118, v11, v12
  v_max3_u32 v118, v118, v13, v14
  v_max3_u32 v118, v118, v15, v16
  v_max3_u32 v118, v118, v17, v18
  v_max3_u32 v118, v118, v19, v20
  v_max3_u32 v118, v118, v21, v22
  v_max3_u32 v118, v118, v23, v24
  v_max3_u32 v118, v118, v25, v26
  v_max3_u32 v118, v118, v27, v28
  v_max3_u32 v118, v118, v29, v30
  v_max3_u32 v118, v118, v31, v32
  v_max3_u32 v118, v118, v33, v34
  v_max_u32 v118, v118, v35
  v_cmp_eq_u32 vcc, -1, v118
  s_cbranch_vccz cB_sc0_rk
  s_add_u32 s30, s30, 1
  s_cmp_lt_u32 s30, 400000
  s_cbranch_scc1 cB_sc0_rv
  s_branch cB_abort
cB_sc0_rk:
  s_mov_b32 s62, 1
  v_mov_b32 v36, 0
  v_mov_b32 v37, 0
  v_mov_b32 v38, 0
  v_mov_b32 v39, 0
  v_mov_b32 v40, 0
  v_mov_b32 v41, 0
  v_mov_b32 v42, 0
  v_mov_b32 v43, 0
  v_mov_b32 v44, 0
  v_mov_b32 v45, 0
  v_mov_b32 v46, 0
  v_mov_b32 v47, 0
  v_mov_b32 v48, 0
  v_mov_b32 v49, 0
  v_mov_b32 v50, 0
  v_mov_b32 v51, 0
  v_mov_b32 v52, 0
  v_mov_b32 v53, 0
  v_mov_b32 v54, 0
  v_mov_b32 v55, 0
  v_mov_b32 v56, 0
  v_mov_b32 v57, 0
  v_mov_b32 v58, 0
  v_mov_b32 v59, 0
  v_mov_b32 v60, 0
  v_mov_b32 v61, 0
  v_mov_b32 v62, 0
  v_mov_b32 v63, 0
  v_mov_b32 v88, 0
  v_mov_b32 v89, 0
  v_mov_b32 v90, 0
  v_mov_b32 v91, 0
  v_mov_b32 v92, 0
  v_mov_b32 v93, 0
  v_mov_b32 v94, 0
  v_mov_b32 v95, 0
  v_mov_b32 v66, 0
  v_mov_b32 v67, 0
  s_add_u32 s31, s31, 1
  ds_read_b128 v[96:99], v117 offset:0
  ds_read_b128 v[100:103], v117 offset:1024
  ds_read_b128 v[104:107], v117 offset:14336
  ds_read_b128 v[108:111], v117 offset:15360
  v_smfmac_f32_16x16x64_bf16 v[36:39], v[8:11], a[0:7], v3
  v_smfmac_f32_16x16x64_bf16 v[40:43], v[8:11], a[56:63], v3
  v_smfmac_f32_16x16x64_bf16 v[44:47], v[8:11], a[112:119], v3
  v_smfmac_f32_16x16x64_bf16 v[48:51], v[8:11], a[168:175], v3
  v_smfmac_f32_16x16x64_bf16 v[52:55], v[8:11], a[224:231], v3
  v_smfmac_f32_16x16x64_bf16 v[56:59], v[8:11], v[144:151], v3
  v_smfmac_f32_16x16x64_bf16 v[60:63], v[8:11], v[200:207], v3
  v_smfmac_f32_16x16x64_bf16 v[36:39], v[12:15], a[8:15], v3
  v_smfmac_f32_16x16x64_bf16 v[40:43], v[12:15], a[64:71], v3
  v_smfmac_f32_16x16x64_bf16 v[44:47], v[12:15], a[120:127], v3
  v_smfmac_f32_16x16x64_bf16 v[48:51], v[12:15], a[176:183], v3
  v_smfmac_f32_16x16x64_bf16 v[52:55], v[12:15], a[232:239], v3
  v_smfmac_f32_16x16x64_bf16 v[56:59], v[12:15], v[152:159], v3
  v_smfmac_f32_16x16x64_bf16 v[60:63], v[12:15], v[208:215], v3
  v_smfmac_f32_16x16x64_bf16 v[36:39], v[16:19], a[16:23], v3
  v_smfmac_f32_16x16x64_bf16 v[40:43], v[16:19], a[72:79], v3
  v_smfmac_f32_16x16x64_bf16 v[44:47], v[16:19], a[128:135], v3
  v_smfmac_f32_16x16x64_bf16 v[48:51], v[16:19], a[184:191], v3
  v_smfmac_f32_16x16x64_bf16 v[52:55], v[16:19], a[240:247], v3
  v_smfmac_f32_16x16x64_bf16 v[56:59], v[16:19], v[160:167], v3
  v_smfmac_f32_16x16x64_bf16 v[60:63], v[16:19], v[216:223], v3
  v_smfmac_f32_16x16x64_bf16 v[36:39], v[20:23], a[24:31], v3
  v_smfmac_f32_16x16x64_bf16 v[40:43], v[20:23], a[80:87], v3
  v_smfmac_f32_16x16x64_bf16 v[44:47], v[20:23], a[136:143], v3
  v_smfmac_f32_16x16x64_bf16 v[48:51], v[20:23], a[192:199], v3
  v_smfmac_f32_16x16x64_bf16 v[52:55], v[20:23], a[248:255], v3
  v_smfmac_f32_16x16x64_bf16 v[56:59], v[20:23], v[168:175], v3
  v_smfmac_f32_16x16x64_bf16 v[60:63], v[20:23], v[224:231], v3
  s_branch cB_sc0_ph2
.p2align 6

cB_sc1_loop:
  s_add_u32 s23, s20, 4096
  s_add_u32 s21, s20, 25600
  v_mov_b32 v48, 0
  v_mov_b32 v49, 0
  v_mov_b32 v50, 0
  v_mov_b32 v51, 0
  v_mov_b32 v52, 0
  v_mov_b32 v53, 0
  v_mov_b32 v54, 0
  v_mov_b32 v55, 0
  v_mov_b32 v56, 0
  v_mov_b32 v57, 0
  v_mov_b32 v58, 0
  v_mov_b32 v59, 0
  v_mov_b32 v60, 0
  v_mov_b32 v61, 0
  v_mov_b32 v62, 0
  v_mov_b32 v63, 0
  v_mov_b32 v88, 0
  v_mov_b32 v89, 0
  v_mov_b32 v90, 0
  v_mov_b32 v91, 0
  v_mov_b32 v92, 0
  v_mov_b32 v93, 0
  v_mov_b32 v94, 0
  v_mov_b32 v95, 0
  v_mov_b32 v64, 0
  v_mov_b32 v65, 0
  s_mov_b32 s30, 0
  s_mov_b32 s62, 0
  s_waitcnt vmcnt(0)
  s_barrier
cB_sc1_ld:
  buffer_load_dwordx4 v[8:11], v2, s[8:11], s20 offen offset:0 sc1
  v_mov_b32 v36, 0
  v_mov_b32 v37, 0
  v_mov_b32 v38, 0
  v_mov_b32 v39, 0
  buffer_load_dwordx4 v[12:15], v2, s[8:11], s20 offen offset:1024 sc1
  v_mov_b32 v40, 0
  v_mov_b32 v41, 0
  v_mov_b32 v42, 0
  v_mov_b32 v43, 0
  buffer_load_dwordx4 v[16:19], v2, s[8:11], s20 offen offset:2048 sc1
  v_mov_b32 v44, 0
  v_mov_b32 v45, 0
  v_mov_b32 v46, 0
  v_mov_b32 v47, 0
  ds_read_b128 v[96:99], v117 offset:0
  ds_read_b128 v[100:103], v117 offset:1024
  ds_read_b128 v[104:107], v117 offset:14336
  ds_read_b128 v[108:111], v117 offset:15360
  s_waitcnt vmcnt(2)
  v_smfmac_f32_16x16x64_bf16 v[36:39], v[8:11], a[0:7], v3
  v_smfmac_f32_16x16x64_bf16 v[40:43], v[8:11], a[56:63], v3
  buffer_load_dwordx4 v[20:23], v2, s[8:11], s20 offen offset:3072 sc1
  v_smfmac_f32_16x16x64_bf16 v[44:47], v[8:11], a[112:119], v3
  v_smfmac_f32_16x16x64_bf16 v[48:51], v[8:11], a[168:175], v3
  v_smfmac_f32_16x16x64_bf16 v[52:55], v[8:11], a[224:231], v3
  buffer_load_dwordx4 v[24:27], v2, s[8:11], s23 offen offset:0 sc1
  v_smfmac_f32_16x16x64_bf16 v[56:59], v[8:11], v[144:151], v3
  v_smfmac_f32_16x16x64_bf16 v[60:63], v[8:11], v[200:207], v3
  s_waitcnt vmcnt(3)
  v_smfmac_f32_16x16x64_bf16 v[36:39], v[12:15], a[8:15], v3
  v_smfmac_f32_16x16x64_bf16 v[40:43], v[12:15], a[64:71], v3
  buffer_load_dwordx4 v[28:31], v2, s[8:11], s23 offen offset:1024 sc1
  v_smfmac_f32_16x16x64_bf16 v[44:47], v[12:15], a[120:127], v3
  v_smfmac_f32_16x16x64_bf16 v[48:51], v[12:15], a[176:183], v3
  v_smfmac_f32_16x16x64_bf16 v[52:55], v[12:15], a[232:239], v3
  buffer_load_dwordx4 v[32:35], v2, s[8:11], s23 offen offset:2048 sc1
  v_smfmac_f32_16x16x64_bf16 v[56:59], v[12:15], v[152:159], v3
  v_smfmac_f32_16x16x64_bf16 v[60:63], v[12:15], v[208:215], v3
  s_waitcnt vmcnt(4)
  v_smfmac_f32_16x16x64_bf16 v[36:39], v[16:19], a[16:23], v3
  v_smfmac_f32_16x16x64_bf16 v[40:43], v[16:19], a[72:79], v3
  v_smfmac_f32_16x16x64_bf16 v[44:47], v[16:19], a[128:135], v3
  v_smfmac_f32_16x16x64_bf16 v[48:51], v[16:19], a[184:191], v3
  v_smfmac_f32_16x16x64_bf16 v[52:55], v[16:19], a[240:247], v3
  v_smfmac_f32_16x16x64_bf16 v[56:59], v[16:19], v[160:167], v3
  v_smfmac_f32_16x16x64_bf16 v[60:63], v[16:19], v[216:223], v3
  s_waitcnt vmcnt(3)
  v_smfmac_f32_16x16x64_bf16 v[36:39], v[20:23], a[24:31], v3
  v_smfmac_f32_16x16x64_bf16 v[40:43], v[20:23], a[80:87], v3
  v_smfmac_f32_16x16x64_bf16 v[44:47], v[20:23], a[136:143], v3
  v_smfmac_f32_16x16x64_bf16 v[48:51], v[20:23], a[192:199], v3
  v_smfmac_f32_16x16x64_bf16 v[52:55], v[20:23], a[248:255], v3
  v_smfmac_f32_16x16x64_bf16 v[56:59], v[20:23], v[168:175], v3
  v_smfmac_f32_16x16x64_bf16 v[60:63], v[20:23], v[224:231], v3
  s_waitcnt vmcnt(0)
cB_sc1_ph2:
  v_smfmac_f32_16x16x64_bf16 v[60:63], v[24:27], v[232:239], v3
  ds_read_b128 v[16:19], v116 offset:2048
  ds_read_b128 v[20:23], v116 offset:3072
  v_smfmac_f32_16x16x64_bf16 v[60:63], v[28:31], v[240:247], v3
  buffer_load_dword v119, v0, s[8:11], s20 offen sc1
  v_smfmac_f32_16x16x64_bf16 v[60:63], v[32:35], v[248:255], v3
  v_mov_b32 v80, v26
  v_smfmac_f32_16x16x64_bf16 v[52:55], v[24:27], v[120:127], v3
  v_mov_b32 v81, v27
  v_smfmac_f32_16x16x64_bf16 v[52:55], v[28:31], v[128:135], v3
  v_mov_b32 v82, v32
  v_smfmac_f32_16x16x64_bf16 v[52:55], v[32:35], v[136:143], v3
  v_cvt_pk_bf16_f32 v66, v60, v61
  v_smfmac_f32_16x16x64_bf16 v[56:59], v[24:27], v[176:183], v3
  v_cvt_pk_bf16_f32 v67, v62, v63
  v_smfmac_f32_16x16x64_bf16 v[56:59], v[28:31], v[184:191], v3
  v_mov_b32 v83, v33
  v_mfma_f32_16x16x32_bf16 v[68:71], v[64:67], v[4:7], 0
  v_smfmac_f32_16x16x64_bf16 v[56:59], v[32:35], v[192:199], v3
  v_cvt_pk_bf16_f32 v64, v52, v53
  v_smfmac_f32_16x16x64_bf16 v[36:39], v[24:27], a[32:39], v3
  v_cvt_pk_bf16_f32 v65, v54, v55
  v_smfmac_f32_16x16x64_bf16 v[36:39], v[28:31], a[40:47], v3
  v_cvt_pk_bf16_f32 v78, v68, v69
  v_smfmac_f32_16x16x64_bf16 v[36:39], v[32:35], a[48:55], v3
  v_cvt_pk_bf16_f32 v79, v70, v71
  v_cvt_pk_bf16_f32 v66, v56, v57
  v_smfmac_f32_16x16x64_bf16 v[40:43], v[24:27], a[88:95], v3
  v_cvt_pk_bf16_f32 v67, v58, v59
  v_smfmac_f32_16x16x64_bf16 v[40:43], v[28:31], a[96:103], v3
  v_mfma_f32_16x16x32_bf16 v[72:75], v[64:67], v[4:7], 0
  ds_read_b128 v[52:55], v116 offset:16384
  ds_read_b128 v[56:59], v116 offset:17408
  v_smfmac_f32_16x16x64_bf16 v[40:43], v[32:35], a[104:111], v3
  v_cvt_pk_bf16_f32 v64, v36, v37
  v_smfmac_f32_16x16x64_bf16 v[44:47], v[24:27], a[144:151], v3
  v_cvt_pk_bf16_f32 v65, v38, v39
  v_smfmac_f32_16x16x64_bf16 v[44:47], v[28:31], a[152:159], v3
  v_cvt_pk_bf16_f32 v76, v72, v73
  v_smfmac_f32_16x16x64_bf16 v[44:47], v[32:35], a[160:167], v3
  v_cvt_pk_bf16_f32 v77, v74, v75
  v_cvt_pk_bf16_f32 v66, v40, v41
  v_smfmac_f32_16x16x64_bf16 v[48:51], v[24:27], a[200:207], v3
  v_cvt_pk_bf16_f32 v67, v42, v43
  v_smfmac_f32_16x16x64_bf16 v[48:51], v[28:31], a[208:215], v3
  v_mfma_f32_16x16x32_bf16 v[68:71], v[64:67], v[4:7], 0
  v_smfmac_f32_16x16x64_bf16 v[48:51], v[32:35], a[216:223], v3
  v_cvt_pk_bf16_f32 v64, v44, v45
  v_mfma_f32_16x16x32_bf16 v[84:87], v[80:83], v[76:79], 0
  v_cvt_pk_bf16_f32 v65, v46, v47
  s_waitcnt lgkmcnt(0)
  v_smfmac_f32_16x16x64_bf16 v[88:91], v[76:79], v[96:103], v3
  v_cvt_pk_bf16_f32 v60, v68, v69
  v_cvt_pk_bf16_f32 v61, v70, v71
  v_cvt_pk_bf16_f32 v66, v48, v49
  v_cvt_pk_bf16_f32 v67, v50, v51
  s_nop 1
  v_mfma_f32_16x16x32_bf16 v[72:75], v[64:67], v[4:7], 0
  v_smfmac_f32_16x16x64_bf16 v[92:95], v[76:79], v[104:111], v3
  s_nop 4
  v_cvt_pk_bf16_f32 v62, v72, v73
  v_cvt_pk_bf16_f32 v63, v74, v75
  s_nop 1
  v_mfma_f32_16x16x32_bf16 v[84:87], v[12:15], v[60:63], v[84:87]
  v_smfmac_f32_16x16x64_bf16 v[88:91], v[60:63], v[16:23], v3
  v_smfmac_f32_16x16x64_bf16 v[92:95], v[60:63], v[52:59], v3
  s_mov_b64 exec, s[26:27]
  s_nop 0
  ds_write_b128 v113, v[84:87]
  s_mov_b64 exec, -1
  s_nop 0
  v_cmp_u_f32 vcc, v88, v89
  s_nop 1
  v_permlane32_swap_b32 v88, v92
  v_permlane32_swap_b32 v89, v93
  v_permlane32_swap_b32 v90, v94
  v_permlane32_swap_b32 v91, v95
  v_add_f32 v88, v88, v92
  v_add_f32 v89, v89, v93
  v_add_f32 v90, v90, v94
  v_add_f32 v91, v91, v95
  ds_write_b128 v112, v[88:91]
  s_cbranch_vccnz cB_sc1_retry
cB_sc1_cont:
  s_waitcnt lgkmcnt(0)
  s_barrier
  ds_read_b64 v[36:37], v114 offset:0
  ds_read_b64 v[38:39], v114 offset:1024
  ds_read2_b32 v[44:45], v115 offset0:0 offset1:64
  s_waitcnt lgkmcnt(0)
  v_add_f32 v44, v44, v45
  v_add_f32 v36, v36, v38
  v_add_f32 v37, v37, v39
  v_add_f32_dpp v44, v44, v44 row_ror:8 row_mask:0xf bank_mask:0xf
  v_mov_b32 v45, v44
  v_permlane32_swap_b32 v36, v37
  v_add_f32 v36, v36, v37
  v_permlane16_swap_b32 v44, v45
  v_add_f32 v44, v44, v45
  v_exp_f32 v48, v36
  v_exp_f32 v49, v44
  v_add_f32 v50, abs(v36), abs(v44)
  v_fma_f32 v39, v49, s37, v48
  v_cmp_ngt_f32 vcc, s56, v50
  v_cndmask_b32 v41, v48, v49, s[38:39]
  v_add_f32_dpp v39, v39, v39 quad_perm:[1,0,3,2] row_mask:0xf bank_mask:0xf
  v_cndmask_b32 v40, v49, v48, s[38:39]
  v_mov_b32_dpp v46, v41 quad_perm:[1,0,3,2] row_mask:0xf bank_mask:0xf
  v_add_f32_dpp v39, v39, v39 quad_perm:[2,3,0,1] row_mask:0xf bank_mask:0xf
  v_cndmask_b32 v42, v46, v40, s[38:39]
  v_cndmask_b32 v43, v40, v46, s[38:39]
  v_add_f32_dpp v39, v39, v39 row_half_mirror row_mask:0xf bank_mask:0xf
  s_cbranch_vccnz cB_sc1_slow
  s_nop 0
  v_add_f32_dpp v39, v39, v39 row_mirror row_mask:0xf bank_mask:0xf
  v_mov_b32 v47, v39
  s_nop 1
  v_permlane16_swap_b32 v39, v47
  v_add_f32 v39, v39, v47
  v_rcp_f32 v39, v39
  s_mov_b64 exec, s[28:29]
  v_mul_f32 v42, v42, v39
  v_mul_f32 v43, v43, v39
  v_cvt_pk_bf16_f32 v42, v42, v43
cB_sc1_pst:
  buffer_store_dword v42, v1, s[8:11], s20 offen sc1
  s_mov_b64 exec, -1
  s_barrier
  s_add_u32 s24, s24, 28672
  s_add_u32 s35, s35, 28672
  s_xor_b32 s25, s25, 28672
  s_add_u32 m0, s25, 7168
  s_nop 0
  buffer_load_dwordx4 v2, s[8:11], s24 offen offset:0 sc1 lds
  buffer_load_dwordx4 v2, s[8:11], s24 offen offset:1024 sc1 lds
  buffer_load_dwordx4 v2, s[8:11], s24 offen offset:2048 sc1 lds
  buffer_load_dwordx4 v2, s[8:11], s24 offen offset:3072 sc1 lds
  s_add_u32 m0, s25, 11264
  s_add_u32 s22, s24, 4096
  buffer_load_dwordx4 v2, s[8:11], s22 offen offset:0 sc1 lds
  buffer_load_dwordx4 v2, s[8:11], s22 offen offset:1024 sc1 lds
  buffer_load_dwordx4 v2, s[8:11], s22 offen offset:2048 sc1 lds
  v_xor_b32 v116, 28672, v116
  v_add_u32 v117, s57, v117
  s_sub_u32 s57, 0, s57
  s_add_u32 s19, s19, 1
  s_mov_b32 s20, s21
  s_cmp_lt_u32 s19, 63
  s_cbranch_scc1 cB_sc1_loop
  s_branch cB_done
cB_sc1_slow:
  v_max_f32 v50, v36, v44
  s_nop 1
  v_max_f32_dpp v50, v50, v50 quad_perm:[1,0,3,2] row_mask:0xf bank_mask:0xf
  s_nop 1
  v_max_f32_dpp v50, v50, v50 quad_perm:[2,3,0,1] row_mask:0xf bank_mask:0xf
  s_nop 1
  v_max_f32_dpp v50, v50, v50 row_half_mirror row_mask:0xf bank_mask:0xf
  s_nop 1
  v_max_f32_dpp v50, v50, v50 row_mirror row_mask:0xf bank_mask:0xf
  v_mov_b32 v47, v50
  s_nop 1
  v_permlane16_swap_b32 v50, v47
  v_max_f32 v50, v50, v47
  v_sub_f32 v48, v36, v50
  v_sub_f32 v49, v44, v50
  v_exp_f32 v48, v48
  v_exp_f32 v49, v49
  s_add_u32 s31, s31, 0x100
  v_fma_f32 v39, v49, s37, v48
  v_cndmask_b32 v41, v48, v49, s[38:39]
  s_nop 0
  v_add_f32_dpp v39, v39, v39 quad_perm:[1,0,3,2] row_mask:0xf bank_mask:0xf
  v_cndmask_b32 v40, v49, v48, s[38:39]
  v_mov_b32_dpp v46, v41 quad_perm:[1,0,3,2] row_mask:0xf bank_mask:0xf
  v_add_f32_dpp v39, v39, v39 quad_perm:[2,3,0,1] row_mask:0xf bank_mask:0xf
  v_cndmask_b32 v42, v46, v40, s[38:39]
  v_cndmask_b32 v43, v40, v46, s[38:39]
  v_add_f32_dpp v39, v39, v39 row_half_mirror row_mask:0xf bank_mask:0xf
  s_nop 1
  v_add_f32_dpp v39, v39, v39 row_mirror row_mask:0xf bank_mask:0xf
  v_mov_b32 v47, v39
  s_nop 1
  v_permlane16_swap_b32 v39, v47
  v_add_f32 v39, v39, v47
  v_rcp_f32 v39, v39
  s_mov_b64 exec, s[28:29]
  v_mul_f32 v42, v42, v39
  v_mul_f32 v43, v43, v39
  v_cvt_pk_bf16_f32 v42, v42, v43
  v_min_u32 v42, -2, v42
  s_branch cB_sc1_pst
cB_sc1_retry:
  s_cmp_lg_u32 s62, 0
  s_cbranch_scc1 cB_sc1_cont
  s_waitcnt vmcnt(0) lgkmcnt(0)
cB_sc1_rv:
  buffer_load_dwordx4 v[8:11], v2, s[8:11], s20 offen offset:0 sc1
  buffer_load_dwordx4 v[12:15], v2, s[8:11], s20 offen offset:1024 sc1
  buffer_load_dwordx4 v[16:19], v2, s[8:11], s20 offen offset:2048 sc1
  buffer_load_dwordx4 v[20:23], v2, s[8:11], s20 offen offset:3072 sc1
  buffer_load_dwordx4 v[24:27], v2, s[8:11], s23 offen offset:0 sc1
  buffer_load_dwordx4 v[28:31], v2, s[8:11], s23 offen offset:1024 sc1
  buffer_load_dwordx4 v[32:35], v2, s[8:11], s23 offen offset:2048 sc1
  s_waitcnt vmcnt(0)
  v_max3_u32 v118, v8, v9, v10
  v_max3_u32 v118, v118, v11, v12
  v_max3_u32 v118, v118, v13, v14
  v_max3_u32 v118, v118, v15, v16
  v_max3_u32 v118, v118, v17, v18
  v_max3_u32 v118, v118, v19, v20
  v_max3_u32 v118, v118, v21, v22
  v_max3_u32 v118, v118, v23, v24
  v_max3_u32 v118, v118, v25, v26
  v_max3_u32 v118, v118, v27, v28
  v_max3_u32 v118, v118, v29, v30
  v_max3_u32 v118, v118, v31, v32
  v_max3_u32 v118, v118, v33, v34
  v_max_u32 v118, v118, v35
  v_cmp_eq_u32 vcc, -1, v118
  s_cbranch_vccz cB_sc1_rk
  s_add_u32 s30, s30, 1
  s_cmp_lt_u32 s30, 400000
  s_cbranch_scc1 cB_sc1_rv
  s_branch cB_abort
cB_sc1_rk:
  s_mov_b32 s62, 1
  v_mov_b32 v36, 0
  v_mov_b32 v37, 0
  v_mov_b32 v38, 0
  v_mov_b32 v39, 0
  v_mov_b32 v40, 0
  v_mov_b32 v41, 0
  v_mov_b32 v42, 0
  v_mov_b32 v43, 0
  v_mov_b32 v44, 0
  v_mov_b32 v45, 0
  v_mov_b32 v46, 0
  v_mov_b32 v47, 0
  v_mov_b32 v48, 0
  v_mov_b32 v49, 0
  v_mov_b32 v50, 0
  v_mov_b32 v51, 0
  v_mov_b32 v52, 0
  v_mov_b32 v53, 0
  v_mov_b32 v54, 0
  v_mov_b32 v55, 0
  v_mov_b32 v56, 0
  v_mov_b32 v57, 0
  v_mov_b32 v58, 0
  v_mov_b32 v59, 0
  v_mov_b32 v60, 0
  v_mov_b32 v61, 0
  v_mov_b32 v62, 0
  v_mov_b32 v63, 0
  v_mov_b32 v88, 0
  v_mov_b32 v89, 0
  v_mov_b32 v90, 0
  v_mov_b32 v91, 0
  v_mov_b32 v92, 0
  v_mov_b32 v93, 0
  v_mov_b32 v94, 0
  v_mov_b32 v95, 0
  v_mov_b32 v64, 0
  v_mov_b32 v65, 0
  s_add_u32 s31, s31, 1
  ds_read_b128 v[96:99], v117 offset:0
  ds_read_b128 v[100:103], v117 offset:1024
  ds_read_b128 v[104:107], v117 offset:14336
  ds_read_b128 v[108:111], v117 offset:15360
  v_smfmac_f32_16x16x64_bf16 v[36:39], v[8:11], a[0:7], v3
  v_smfmac_f32_16x16x64_bf16 v[40:43], v[8:11], a[56:63], v3
  v_smfmac_f32_16x16x64_bf16 v[44:47], v[8:11], a[112:119], v3
  v_smfmac_f32_16x16x64_bf16 v[48:51], v[8:11], a[168:175], v3
  v_smfmac_f32_16x16x64_bf16 v[52:55], v[8:11], a[224:231], v3
  v_smfmac_f32_16x16x64_bf16 v[56:59], v[8:11], v[144:151], v3
  v_smfmac_f32_16x16x64_bf16 v[60:63], v[8:11], v[200:207], v3
  v_smfmac_f32_16x16x64_bf16 v[36:39], v[12:15], a[8:15], v3
  v_smfmac_f32_16x16x64_bf16 v[40:43], v[12:15], a[64:71], v3
  v_smfmac_f32_16x16x64_bf16 v[44:47], v[12:15], a[120:127], v3
  v_smfmac_f32_16x16x64_bf16 v[48:51], v[12:15], a[176:183], v3
  v_smfmac_f32_16x16x64_bf16 v[52:55], v[12:15], a[232:239], v3
  v_smfmac_f32_16x16x64_bf16 v[56:59], v[12:15], v[152:159], v3
  v_smfmac_f32_16x16x64_bf16 v[60:63], v[12:15], v[208:215], v3
  v_smfmac_f32_16x16x64_bf16 v[36:39], v[16:19], a[16:23], v3
  v_smfmac_f32_16x16x64_bf16 v[40:43], v[16:19], a[72:79], v3
  v_smfmac_f32_16x16x64_bf16 v[44:47], v[16:19], a[128:135], v3
  v_smfmac_f32_16x16x64_bf16 v[48:51], v[16:19], a[184:191], v3
  v_smfmac_f32_16x16x64_bf16 v[52:55], v[16:19], a[240:247], v3
  v_smfmac_f32_16x16x64_bf16 v[56:59], v[16:19], v[160:167], v3
  v_smfmac_f32_16x16x64_bf16 v[60:63], v[16:19], v[216:223], v3
  v_smfmac_f32_16x16x64_bf16 v[36:39], v[20:23], a[24:31], v3
  v_smfmac_f32_16x16x64_bf16 v[40:43], v[20:23], a[80:87], v3
  v_smfmac_f32_16x16x64_bf16 v[44:47], v[20:23], a[136:143], v3
  v_smfmac_f32_16x16x64_bf16 v[48:51], v[20:23], a[192:199], v3
  v_smfmac_f32_16x16x64_bf16 v[52:55], v[20:23], a[248:255], v3
  v_smfmac_f32_16x16x64_bf16 v[56:59], v[20:23], v[168:175], v3
  v_smfmac_f32_16x16x64_bf16 v[60:63], v[20:23], v[224:231], v3
  s_branch cB_sc1_ph2
.p2align 6

cB_sc2_loop:
  s_add_u32 s23, s20, 4096
  s_add_u32 s21, s20, 25600
  v_mov_b32 v48, 0
  v_mov_b32 v49, 0
  v_mov_b32 v50, 0
  v_mov_b32 v51, 0
  v_mov_b32 v52, 0
  v_mov_b32 v53, 0
  v_mov_b32 v54, 0
  v_mov_b32 v55, 0
  v_mov_b32 v56, 0
  v_mov_b32 v57, 0
  v_mov_b32 v58, 0
  v_mov_b32 v59, 0
  v_mov_b32 v60, 0
  v_mov_b32 v61, 0
  v_mov_b32 v62, 0
  v_mov_b32 v63, 0
  v_mov_b32 v88, 0
  v_mov_b32 v89, 0
  v_mov_b32 v90, 0
  v_mov_b32 v91, 0
  v_mov_b32 v92, 0
  v_mov_b32 v93, 0
  v_mov_b32 v94, 0
  v_mov_b32 v95, 0
  v_mov_b32 v66, 0
  v_mov_b32 v67, 0
  s_mov_b32 s30, 0
  s_mov_b32 s62, 0
  s_waitcnt vmcnt(0)
  s_barrier
cB_sc2_ld:
  buffer_load_dwordx4 v[8:11], v2, s[8:11], s20 offen offset:0 sc1
  v_mov_b32 v36, 0
  v_mov_b32 v37, 0
  v_mov_b32 v38, 0
  v_mov_b32 v39, 0
  buffer_load_dwordx4 v[12:15], v2, s[8:11], s20 offen offset:1024 sc1
  v_mov_b32 v40, 0
  v_mov_b32 v41, 0
  v_mov_b32 v42, 0
  v_mov_b32 v43, 0
  buffer_load_dwordx4 v[16:19], v2, s[8:11], s20 offen offset:2048 sc1
  v_mov_b32 v44, 0
  v_mov_b32 v45, 0
  v_mov_b32 v46, 0
  v_mov_b32 v47, 0
  ds_read_b128 v[96:99], v117 offset:0
  ds_read_b128 v[100:103], v117 offset:1024
  ds_read_b128 v[104:107], v117 offset:14336
  ds_read_b128 v[108:111], v117 offset:15360
  s_waitcnt vmcnt(2)
  v_smfmac_f32_16x16x64_bf16 v[36:39], v[8:11], a[0:7], v3
  v_smfmac_f32_16x16x64_bf16 v[40:43], v[8:11], a[56:63], v3
  buffer_load_dwordx4 v[20:23], v2, s[8:11], s20 offen offset:3072 sc1
  v_smfmac_f32_16x16x64_bf16 v[44:47], v[8:11], a[112:119], v3
  v_smfmac_f32_16x16x64_bf16 v[48:51], v[8:11], a[168:175], v3
  v_smfmac_f32_16x16x64_bf16 v[52:55], v[8:11], a[224:231], v3
  buffer_load_dwordx4 v[24:27], v2, s[8:11], s23 offen offset:0 sc1
  v_smfmac_f32_16x16x64_bf16 v[56:59], v[8:11], v[144:151], v3
  v_smfmac_f32_16x16x64_bf16 v[60:63], v[8:11], v[200:207], v3
  s_waitcnt vmcnt(3)
  v_smfmac_f32_16x16x64_bf16 v[36:39], v[12:15], a[8:15], v3
  v_smfmac_f32_16x16x64_bf16 v[40:43], v[12:15], a[64:71], v3
  buffer_load_dwordx4 v[28:31], v2, s[8:11], s23 offen offset:1024 sc1
  v_smfmac_f32_16x16x64_bf16 v[44:47], v[12:15], a[120:127], v3
  v_smfmac_f32_16x16x64_bf16 v[48:51], v[12:15], a[176:183], v3
  v_smfmac_f32_16x16x64_bf16 v[52:55], v[12:15], a[232:239], v3
  buffer_load_dwordx4 v[32:35], v2, s[8:11], s23 offen offset:2048 sc1
  v_smfmac_f32_16x16x64_bf16 v[56:59], v[12:15], v[152:159], v3
  v_smfmac_f32_16x16x64_bf16 v[60:63], v[12:15], v[208:215], v3
  s_waitcnt vmcnt(4)
  v_smfmac_f32_16x16x64_bf16 v[36:39], v[16:19], a[16:23], v3
  v_smfmac_f32_16x16x64_bf16 v[40:43], v[16:19], a[72:79], v3
  v_smfmac_f32_16x16x64_bf16 v[44:47], v[16:19], a[128:135], v3
  v_smfmac_f32_16x16x64_bf16 v[48:51], v[16:19], a[184:191], v3
  v_smfmac_f32_16x16x64_bf16 v[52:55], v[16:19], a[240:247], v3
  v_smfmac_f32_16x16x64_bf16 v[56:59], v[16:19], v[160:167], v3
  v_smfmac_f32_16x16x64_bf16 v[60:63], v[16:19], v[216:223], v3
  s_waitcnt vmcnt(3)
  v_smfmac_f32_16x16x64_bf16 v[36:39], v[20:23], a[24:31], v3
  v_smfmac_f32_16x16x64_bf16 v[40:43], v[20:23], a[80:87], v3
  v_smfmac_f32_16x16x64_bf16 v[44:47], v[20:23], a[136:143], v3
  v_smfmac_f32_16x16x64_bf16 v[48:51], v[20:23], a[192:199], v3
  v_smfmac_f32_16x16x64_bf16 v[52:55], v[20:23], a[248:255], v3
  v_smfmac_f32_16x16x64_bf16 v[56:59], v[20:23], v[168:175], v3
  v_smfmac_f32_16x16x64_bf16 v[60:63], v[20:23], v[224:231], v3
  s_waitcnt vmcnt(0)
cB_sc2_ph2:
  v_smfmac_f32_16x16x64_bf16 v[60:63], v[24:27], v[232:239], v3
  ds_read_b128 v[8:11], v116 offset:4096
  ds_read_b128 v[12:15], v116 offset:5120
  v_smfmac_f32_16x16x64_bf16 v[60:63], v[28:31], v[240:247], v3
  buffer_load_dword v119, v0, s[8:11], s24 offen sc1
  v_smfmac_f32_16x16x64_bf16 v[60:63], v[32:35], v[248:255], v3
  v_mov_b32 v80, v28
  v_smfmac_f32_16x16x64_bf16 v[52:55], v[24:27], v[120:127], v3
  v_mov_b32 v81, v29
  v_smfmac_f32_16x16x64_bf16 v[52:55], v[28:31], v[128:135], v3
  v_mov_b32 v82, v34
  v_smfmac_f32_16x16x64_bf16 v[52:55], v[32:35], v[136:143], v3
  v_cvt_pk_bf16_f32 v64, v60, v61
  v_smfmac_f32_16x16x64_bf16 v[56:59], v[24:27], v[176:183], v3
  v_cvt_pk_bf16_f32 v65, v62, v63
  v_smfmac_f32_16x16x64_bf16 v[56:59], v[28:31], v[184:191], v3
  v_mov_b32 v83, v35
  v_mfma_f32_16x16x32_bf16 v[68:71], v[64:67], v[4:7], 0
  v_smfmac_f32_16x16x64_bf16 v[56:59], v[32:35], v[192:199], v3
  v_cvt_pk_bf16_f32 v64, v52, v53
  v_smfmac_f32_16x16x64_bf16 v[36:39], v[24:27], a[32:39], v3
  v_cvt_pk_bf16_f32 v65, v54, v55
  v_smfmac_f32_16x16x64_bf16 v[36:39], v[28:31], a[40:47], v3
  v_cvt_pk_bf16_f32 v78, v68, v69
  v_smfmac_f32_16x16x64_bf16 v[36:39], v[32:35], a[48:55], v3
  v_cvt_pk_bf16_f32 v79, v70, v71
  v_cvt_pk_bf16_f32 v66, v56, v57
  v_smfmac_f32_16x16x64_bf16 v[40:43], v[24:27], a[88:95], v3
  v_cvt_pk_bf16_f32 v67, v58, v59
  v_smfmac_f32_16x16x64_bf16 v[40:43], v[28:31], a[96:103], v3
  v_mfma_f32_16x16x32_bf16 v[72:75], v[64:67], v[4:7], 0
  ds_read_b128 v[52:55], v116 offset:18432
  ds_read_b128 v[56:59], v116 offset:19456
  v_smfmac_f32_16x16x64_bf16 v[40:43], v[32:35], a[104:111], v3
  v_cvt_pk_bf16_f32 v64, v36, v37
  v_smfmac_f32_16x16x64_bf16 v[44:47], v[24:27], a[144:151], v3
  v_cvt_pk_bf16_f32 v65, v38, v39
  v_smfmac_f32_16x16x64_bf16 v[44:47], v[28:31], a[152:159], v3
  v_cvt_pk_bf16_f32 v76, v72, v73
  v_smfmac_f32_16x16x64_bf16 v[44:47], v[32:35], a[160:167], v3
  v_cvt_pk_bf16_f32 v77, v74, v75
  v_cvt_pk_bf16_f32 v66, v40, v41
  v_smfmac_f32_16x16x64_bf16 v[48:51], v[24:27], a[200:207], v3
  v_cvt_pk_bf16_f32 v67, v42, v43
  v_smfmac_f32_16x16x64_bf16 v[48:51], v[28:31], a[208:215], v3
  v_mfma_f32_16x16x32_bf16 v[68:71], v[64:67], v[4:7], 0
  v_smfmac_f32_16x16x64_bf16 v[48:51], v[32:35], a[216:223], v3
  v_cvt_pk_bf16_f32 v64, v44, v45
  v_mfma_f32_16x16x32_bf16 v[84:87], v[80:83], v[76:79], 0
  v_cvt_pk_bf16_f32 v65, v46, v47
  s_waitcnt lgkmcnt(0)
  v_smfmac_f32_16x16x64_bf16 v[88:91], v[76:79], v[96:103], v3
  v_cvt_pk_bf16_f32 v60, v68, v69
  v_cvt_pk_bf16_f32 v61, v70, v71
  v_cvt_pk_bf16_f32 v66, v48, v49
  v_cvt_pk_bf16_f32 v67, v50, v51
  s_nop 1
  v_mfma_f32_16x16x32_bf16 v[72:75], v[64:67], v[4:7], 0
  v_smfmac_f32_16x16x64_bf16 v[92:95], v[76:79], v[104:111], v3
  s_nop 4
  v_cvt_pk_bf16_f32 v62, v72, v73
  v_cvt_pk_bf16_f32 v63, v74, v75
  s_nop 1
  v_mfma_f32_16x16x32_bf16 v[84:87], v[16:19], v[60:63], v[84:87]
  v_smfmac_f32_16x16x64_bf16 v[88:91], v[60:63], v[8:15], v3
  v_smfmac_f32_16x16x64_bf16 v[92:95], v[60:63], v[52:59], v3
  s_mov_b64 exec, s[26:27]
  s_nop 0
  ds_write_b128 v113, v[84:87]
  s_mov_b64 exec, -1
  s_nop 0
  v_cmp_u_f32 vcc, v88, v89
  s_nop 1
  v_permlane32_swap_b32 v88, v92
  v_permlane32_swap_b32 v89, v93
  v_permlane32_swap_b32 v90, v94
  v_permlane32_swap_b32 v91, v95
  v_add_f32 v88, v88, v92
  v_add_f32 v89, v89, v93
  v_add_f32 v90, v90, v94
  v_add_f32 v91, v91, v95
  ds_write_b128 v112, v[88:91]
  s_cbranch_vccnz cB_sc2_retry
cB_sc2_cont:
  s_waitcnt lgkmcnt(0)
  s_barrier
  ds_read_b64 v[36:37], v114 offset:0
  ds_read_b64 v[38:39], v114 offset:1024
  ds_read2_b32 v[44:45], v115 offset0:0 offset1:64
  v_lshl_add_u32 v56, v2, 3, s36
  s_waitcnt lgkmcnt(0)
  v_add_f32 v44, v44, v45
  v_add_f32 v36, v36, v38
  v_add_f32 v37, v37, v39
  v_add_f32_dpp v44, v44, v44 row_ror:8 row_mask:0xf bank_mask:0xf
  v_mov_b32 v45, v44
  s_mov_b64 exec, 65535
  buffer_store_dword v2, v56, s[8:11], s20 offen sc1
  s_mov_b64 exec, -1
  v_permlane32_swap_b32 v36, v37
  v_add_f32 v36, v36, v37
  v_permlane16_swap_b32 v44, v45
  v_add_f32 v44, v44, v45
  v_exp_f32 v48, v36
  v_exp_f32 v49, v44
  v_add_f32 v50, abs(v36), abs(v44)
  v_fma_f32 v39, v49, s37, v48
  v_cmp_ngt_f32 vcc, s56, v50
  v_cndmask_b32 v41, v48, v49, s[38:39]
  v_add_f32_dpp v39, v39, v39 quad_perm:[1,0,3,2] row_mask:0xf bank_mask:0xf
  v_cndmask_b32 v40, v49, v48, s[38:39]
  v_mov_b32_dpp v46, v41 quad_perm:[1,0,3,2] row_mask:0xf bank_mask:0xf
  v_add_f32_dpp v39, v39, v39 quad_perm:[2,3,0,1] row_mask:0xf bank_mask:0xf
  v_cndmask_b32 v42, v46, v40, s[38:39]
  v_cndmask_b32 v43, v40, v46, s[38:39]
  v_add_f32_dpp v39, v39, v39 row_half_mirror row_mask:0xf bank_mask:0xf
  s_cbranch_vccnz cB_sc2_slow
  s_nop 0
  v_add_f32_dpp v39, v39, v39 row_mirror row_mask:0xf bank_mask:0xf
  v_mov_b32 v47, v39
  s_nop 1
  v_permlane16_swap_b32 v39, v47
  v_add_f32 v39, v39, v47
  v_rcp_f32 v39, v39
  s_mov_b64 exec, s[28:29]
  v_mul_f32 v42, v42, v39
  v_mul_f32 v43, v43, v39
  v_cvt_pk_bf16_f32 v42, v42, v43
cB_sc2_pst:
  buffer_store_dword v42, v1, s[8:11], s20 offen sc1
  s_mov_b64 exec, -1
  s_barrier
  s_add_u32 s24, s24, 28672
  s_add_u32 s35, s35, 28672
  s_xor_b32 s25, s25, 28672
  s_add_u32 m0, s25, 14336
  s_nop 0
  buffer_load_dwordx4 v2, s[8:11], s24 offen offset:0 sc1 lds
  buffer_load_dwordx4 v2, s[8:11], s24 offen offset:1024 sc1 lds
  buffer_load_dwordx4 v2, s[8:11], s24 offen offset:2048 sc1 lds
  buffer_load_dwordx4 v2, s[8:11], s24 offen offset:3072 sc1 lds
  s_add_u32 m0, s25, 18432
  s_add_u32 s22, s24, 4096
  buffer_load_dwordx4 v2, s[8:11], s22 offen offset:0 sc1 lds
  buffer_load_dwordx4 v2, s[8:11], s22 offen offset:1024 sc1 lds
  buffer_load_dwordx4 v2, s[8:11], s22 offen offset:2048 sc1 lds
  v_xor_b32 v116, 28672, v116
  v_add_u32 v117, s57, v117
  s_sub_u32 s57, 0, s57
  s_add_u32 s19, s19, 1
  s_mov_b32 s20, s21
  s_cmp_lt_u32 s19, 63
  s_cbranch_scc1 cB_sc2_loop
  s_branch cB_done
cB_sc2_slow:
  v_max_f32 v50, v36, v44
  s_nop 1
  v_max_f32_dpp v50, v50, v50 quad_perm:[1,0,3,2] row_mask:0xf bank_mask:0xf
  s_nop 1
  v_max_f32_dpp v50, v50, v50 quad_perm:[2,3,0,1] row_mask:0xf bank_mask:0xf
  s_nop 1
  v_max_f32_dpp v50, v50, v50 row_half_mirror row_mask:0xf bank_mask:0xf
  s_nop 1
  v_max_f32_dpp v50, v50, v50 row_mirror row_mask:0xf bank_mask:0xf
  v_mov_b32 v47, v50
  s_nop 1
  v_permlane16_swap_b32 v50, v47
  v_max_f32 v50, v50, v47
  v_sub_f32 v48, v36, v50
  v_sub_f32 v49, v44, v50
  v_exp_f32 v48, v48
  v_exp_f32 v49, v49
  s_add_u32 s31, s31, 0x100
  v_fma_f32 v39, v49, s37, v48
  v_cndmask_b32 v41, v48, v49, s[38:39]
  s_nop 0
  v_add_f32_dpp v39, v39, v39 quad_perm:[1,0,3,2] row_mask:0xf bank_mask:0xf
  v_cndmask_b32 v40, v49, v48, s[38:39]
  v_mov_b32_dpp v46, v41 quad_perm:[1,0,3,2] row_mask:0xf bank_mask:0xf
  v_add_f32_dpp v39, v39, v39 quad_perm:[2,3,0,1] row_mask:0xf bank_mask:0xf
  v_cndmask_b32 v42, v46, v40, s[38:39]
  v_cndmask_b32 v43, v40, v46, s[38:39]
  v_add_f32_dpp v39, v39, v39 row_half_mirror row_mask:0xf bank_mask:0xf
  s_nop 1
  v_add_f32_dpp v39, v39, v39 row_mirror row_mask:0xf bank_mask:0xf
  v_mov_b32 v47, v39
  s_nop 1
  v_permlane16_swap_b32 v39, v47
  v_add_f32 v39, v39, v47
  v_rcp_f32 v39, v39
  s_mov_b64 exec, s[28:29]
  v_mul_f32 v42, v42, v39
  v_mul_f32 v43, v43, v39
  v_cvt_pk_bf16_f32 v42, v42, v43
  v_min_u32 v42, -2, v42
  s_branch cB_sc2_pst
cB_sc2_retry:
  s_cmp_lg_u32 s62, 0
  s_cbranch_scc1 cB_sc2_cont
  s_waitcnt vmcnt(0) lgkmcnt(0)
cB_sc2_rv:
  buffer_load_dwordx4 v[8:11], v2, s[8:11], s20 offen offset:0 sc1
  buffer_load_dwordx4 v[12:15], v2, s[8:11], s20 offen offset:1024 sc1
  buffer_load_dwordx4 v[16:19], v2, s[8:11], s20 offen offset:2048 sc1
  buffer_load_dwordx4 v[20:23], v2, s[8:11], s20 offen offset:3072 sc1
  buffer_load_dwordx4 v[24:27], v2, s[8:11], s23 offen offset:0 sc1
  buffer_load_dwordx4 v[28:31], v2, s[8:11], s23 offen offset:1024 sc1
  buffer_load_dwordx4 v[32:35], v2, s[8:11], s23 offen offset:2048 sc1
  s_waitcnt vmcnt(0)
  v_max3_u32 v118, v8, v9, v10
  v_max3_u32 v118, v118, v11, v12
  v_max3_u32 v118, v118, v13, v14
  v_max3_u32 v118, v118, v15, v16
  v_max3_u32 v118, v118, v17, v18
  v_max3_u32 v118, v118, v19, v20
  v_max3_u32 v118, v118, v21, v22
  v_max3_u32 v118, v118, v23, v24
  v_max3_u32 v118, v118, v25, v26
  v_max3_u32 v118, v118, v27, v28
  v_max3_u32 v118, v118, v29, v30
  v_max3_u32 v118, v118, v31, v32
  v_max3_u32 v118, v118, v33, v34
  v_max_u32 v118, v118, v35
  v_cmp_eq_u32 vcc, -1, v118
  s_cbranch_vccz cB_sc2_rk
  s_add_u32 s30, s30, 1
  s_cmp_lt_u32 s30, 400000
  s_cbranch_scc1 cB_sc2_rv
  s_branch cB_abort
cB_sc2_rk:
  s_mov_b32 s62, 1
  v_mov_b32 v36, 0
  v_mov_b32 v37, 0
  v_mov_b32 v38, 0
  v_mov_b32 v39, 0
  v_mov_b32 v40, 0
  v_mov_b32 v41, 0
  v_mov_b32 v42, 0
  v_mov_b32 v43, 0
  v_mov_b32 v44, 0
  v_mov_b32 v45, 0
  v_mov_b32 v46, 0
  v_mov_b32 v47, 0
  v_mov_b32 v48, 0
  v_mov_b32 v49, 0
  v_mov_b32 v50, 0
  v_mov_b32 v51, 0
  v_mov_b32 v52, 0
  v_mov_b32 v53, 0
  v_mov_b32 v54, 0
  v_mov_b32 v55, 0
  v_mov_b32 v56, 0
  v_mov_b32 v57, 0
  v_mov_b32 v58, 0
  v_mov_b32 v59, 0
  v_mov_b32 v60, 0
  v_mov_b32 v61, 0
  v_mov_b32 v62, 0
  v_mov_b32 v63, 0
  v_mov_b32 v88, 0
  v_mov_b32 v89, 0
  v_mov_b32 v90, 0
  v_mov_b32 v91, 0
  v_mov_b32 v92, 0
  v_mov_b32 v93, 0
  v_mov_b32 v94, 0
  v_mov_b32 v95, 0
  v_mov_b32 v66, 0
  v_mov_b32 v67, 0
  s_add_u32 s31, s31, 1
  ds_read_b128 v[96:99], v117 offset:0
  ds_read_b128 v[100:103], v117 offset:1024
  ds_read_b128 v[104:107], v117 offset:14336
  ds_read_b128 v[108:111], v117 offset:15360
  v_smfmac_f32_16x16x64_bf16 v[36:39], v[8:11], a[0:7], v3
  v_smfmac_f32_16x16x64_bf16 v[40:43], v[8:11], a[56:63], v3
  v_smfmac_f32_16x16x64_bf16 v[44:47], v[8:11], a[112:119], v3
  v_smfmac_f32_16x16x64_bf16 v[48:51], v[8:11], a[168:175], v3
  v_smfmac_f32_16x16x64_bf16 v[52:55], v[8:11], a[224:231], v3
  v_smfmac_f32_16x16x64_bf16 v[56:59], v[8:11], v[144:151], v3
  v_smfmac_f32_16x16x64_bf16 v[60:63], v[8:11], v[200:207], v3
  v_smfmac_f32_16x16x64_bf16 v[36:39], v[12:15], a[8:15], v3
  v_smfmac_f32_16x16x64_bf16 v[40:43], v[12:15], a[64:71], v3
  v_smfmac_f32_16x16x64_bf16 v[44:47], v[12:15], a[120:127], v3
  v_smfmac_f32_16x16x64_bf16 v[48:51], v[12:15], a[176:183], v3
  v_smfmac_f32_16x16x64_bf16 v[52:55], v[12:15], a[232:239], v3
  v_smfmac_f32_16x16x64_bf16 v[56:59], v[12:15], v[152:159], v3
  v_smfmac_f32_16x16x64_bf16 v[60:63], v[12:15], v[208:215], v3
  v_smfmac_f32_16x16x64_bf16 v[36:39], v[16:19], a[16:23], v3
  v_smfmac_f32_16x16x64_bf16 v[40:43], v[16:19], a[72:79], v3
  v_smfmac_f32_16x16x64_bf16 v[44:47], v[16:19], a[128:135], v3
  v_smfmac_f32_16x16x64_bf16 v[48:51], v[16:19], a[184:191], v3
  v_smfmac_f32_16x16x64_bf16 v[52:55], v[16:19], a[240:247], v3
  v_smfmac_f32_16x16x64_bf16 v[56:59], v[16:19], v[160:167], v3
  v_smfmac_f32_16x16x64_bf16 v[60:63], v[16:19], v[216:223], v3
  v_smfmac_f32_16x16x64_bf16 v[36:39], v[20:23], a[24:31], v3
  v_smfmac_f32_16x16x64_bf16 v[40:43], v[20:23], a[80:87], v3
  v_smfmac_f32_16x16x64_bf16 v[44:47], v[20:23], a[136:143], v3
  v_smfmac_f32_16x16x64_bf16 v[48:51], v[20:23], a[192:199], v3
  v_smfmac_f32_16x16x64_bf16 v[52:55], v[20:23], a[248:255], v3
  v_smfmac_f32_16x16x64_bf16 v[56:59], v[20:23], v[168:175], v3
  v_smfmac_f32_16x16x64_bf16 v[60:63], v[20:23], v[224:231], v3
  s_branch cB_sc2_ph2
.p2align 6

cB_sc3_loop:
  s_add_u32 s23, s20, 4096
  s_add_u32 s21, s20, 25600
  v_mov_b32 v48, 0
  v_mov_b32 v49, 0
  v_mov_b32 v50, 0
  v_mov_b32 v51, 0
  v_mov_b32 v52, 0
  v_mov_b32 v53, 0
  v_mov_b32 v54, 0
  v_mov_b32 v55, 0
  v_mov_b32 v56, 0
  v_mov_b32 v57, 0
  v_mov_b32 v58, 0
  v_mov_b32 v59, 0
  v_mov_b32 v60, 0
  v_mov_b32 v61, 0
  v_mov_b32 v62, 0
  v_mov_b32 v63, 0
  v_mov_b32 v88, 0
  v_mov_b32 v89, 0
  v_mov_b32 v90, 0
  v_mov_b32 v91, 0
  v_mov_b32 v92, 0
  v_mov_b32 v93, 0
  v_mov_b32 v94, 0
  v_mov_b32 v95, 0
  v_mov_b32 v64, 0
  v_mov_b32 v65, 0
  s_mov_b32 s30, 0
  s_mov_b32 s62, 0
  s_waitcnt vmcnt(0)
  s_barrier
cB_sc3_ld:
  buffer_load_dwordx4 v[8:11], v2, s[8:11], s20 offen offset:0 sc1
  v_mov_b32 v36, 0
  v_mov_b32 v37, 0
  v_mov_b32 v38, 0
  v_mov_b32 v39, 0
  buffer_load_dwordx4 v[12:15], v2, s[8:11], s20 offen offset:1024 sc1
  v_mov_b32 v40, 0
  v_mov_b32 v41, 0
  v_mov_b32 v42, 0
  v_mov_b32 v43, 0
  buffer_load_dwordx4 v[16:19], v2, s[8:11], s20 offen offset:2048 sc1
  v_mov_b32 v44, 0
  v_mov_b32 v45, 0
  v_mov_b32 v46, 0
  v_mov_b32 v47, 0
  ds_read_b128 v[96:99], v117 offset:0
  ds_read_b128 v[100:103], v117 offset:1024
  ds_read_b128 v[104:107], v117 offset:14336
  ds_read_b128 v[108:111], v117 offset:15360
  s_waitcnt vmcnt(2)
  v_smfmac_f32_16x16x64_bf16 v[36:39], v[8:11], a[0:7], v3
  v_smfmac_f32_16x16x64_bf16 v[40:43], v[8:11], a[56:63], v3
  buffer_load_dwordx4 v[20:23], v2, s[8:11], s20 offen offset:3072 sc1
  v_smfmac_f32_16x16x64_bf16 v[44:47], v[8:11], a[112:119], v3
  v_smfmac_f32_16x16x64_bf16 v[48:51], v[8:11], a[168:175], v3
  v_smfmac_f32_16x16x64_bf16 v[52:55], v[8:11], a[224:231], v3
  buffer_load_dwordx4 v[24:27], v2, s[8:11], s23 offen offset:0 sc1
  v_smfmac_f32_16x16x64_bf16 v[56:59], v[8:11], v[144:151], v3
  v_smfmac_f32_16x16x64_bf16 v[60:63], v[8:11], v[200:207], v3
  s_waitcnt vmcnt(3)
  v_smfmac_f32_16x16x64_bf16 v[36:39], v[12:15], a[8:15], v3
  v_smfmac_f32_16x16x64_bf16 v[40:43], v[12:15], a[64:71], v3
  buffer_load_dwordx4 v[28:31], v2, s[8:11], s23 offen offset:1024 sc1
  v_smfmac_f32_16x16x64_bf16 v[44:47], v[12:15], a[120:127], v3
  v_smfmac_f32_16x16x64_bf16 v[48:51], v[12:15], a[176:183], v3
  v_smfmac_f32_16x16x64_bf16 v[52:55], v[12:15], a[232:239], v3
  buffer_load_dwordx4 v[32:35], v2, s[8:11], s23 offen offset:2048 sc1
  v_smfmac_f32_16x16x64_bf16 v[56:59], v[12:15], v[152:159], v3
  v_smfmac_f32_16x16x64_bf16 v[60:63], v[12:15], v[208:215], v3
  s_waitcnt vmcnt(4)
  v_smfmac_f32_16x16x64_bf16 v[36:39], v[16:19], a[16:23], v3
  v_smfmac_f32_16x16x64_bf16 v[40:43], v[16:19], a[72:79], v3
  v_smfmac_f32_16x16x64_bf16 v[44:47], v[16:19], a[128:135], v3
  v_smfmac_f32_16x16x64_bf16 v[48:51], v[16:19], a[184:191], v3
  v_smfmac_f32_16x16x64_bf16 v[52:55], v[16:19], a[240:247], v3
  v_smfmac_f32_16x16x64_bf16 v[56:59], v[16:19], v[160:167], v3
  v_smfmac_f32_16x16x64_bf16 v[60:63], v[16:19], v[216:223], v3
  s_waitcnt vmcnt(3)
  v_smfmac_f32_16x16x64_bf16 v[36:39], v[20:23], a[24:31], v3
  v_smfmac_f32_16x16x64_bf16 v[40:43], v[20:23], a[80:87], v3
  v_smfmac_f32_16x16x64_bf16 v[44:47], v[20:23], a[136:143], v3
  v_smfmac_f32_16x16x64_bf16 v[48:51], v[20:23], a[192:199], v3
  v_smfmac_f32_16x16x64_bf16 v[52:55], v[20:23], a[248:255], v3
  v_smfmac_f32_16x16x64_bf16 v[56:59], v[20:23], v[168:175], v3
  v_smfmac_f32_16x16x64_bf16 v[60:63], v[20:23], v[224:231], v3
  s_waitcnt vmcnt(0)
cB_sc3_ph2:
  v_smfmac_f32_16x16x64_bf16 v[60:63], v[24:27], v[232:239], v3
  ds_read_b128 v[8:11], v116 offset:6144
  ds_read_b128 v[12:15], v116 offset:7168
  v_smfmac_f32_16x16x64_bf16 v[60:63], v[28:31], v[240:247], v3
  v_smfmac_f32_16x16x64_bf16 v[60:63], v[32:35], v[248:255], v3
  v_mov_b32 v80, v30
  v_smfmac_f32_16x16x64_bf16 v[52:55], v[24:27], v[120:127], v3
  v_mov_b32 v81, v31
  v_smfmac_f32_16x16x64_bf16 v[52:55], v[28:31], v[128:135], v3
  v_mov_b32 v82, v34
  v_smfmac_f32_16x16x64_bf16 v[52:55], v[32:35], v[136:143], v3
  v_cvt_pk_bf16_f32 v66, v60, v61
  v_smfmac_f32_16x16x64_bf16 v[56:59], v[24:27], v[176:183], v3
  v_cvt_pk_bf16_f32 v67, v62, v63
  v_smfmac_f32_16x16x64_bf16 v[56:59], v[28:31], v[184:191], v3
  v_mov_b32 v83, v35
  v_mfma_f32_16x16x32_bf16 v[68:71], v[64:67], v[4:7], 0
  v_smfmac_f32_16x16x64_bf16 v[56:59], v[32:35], v[192:199], v3
  v_cvt_pk_bf16_f32 v64, v52, v53
  v_smfmac_f32_16x16x64_bf16 v[36:39], v[24:27], a[32:39], v3
  v_cvt_pk_bf16_f32 v65, v54, v55
  v_smfmac_f32_16x16x64_bf16 v[36:39], v[28:31], a[40:47], v3
  v_cvt_pk_bf16_f32 v78, v68, v69
  v_smfmac_f32_16x16x64_bf16 v[36:39], v[32:35], a[48:55], v3
  v_cvt_pk_bf16_f32 v79, v70, v71
  v_cvt_pk_bf16_f32 v66, v56, v57
  v_smfmac_f32_16x16x64_bf16 v[40:43], v[24:27], a[88:95], v3
  v_cvt_pk_bf16_f32 v67, v58, v59
  v_smfmac_f32_16x16x64_bf16 v[40:43], v[28:31], a[96:103], v3
  v_mfma_f32_16x16x32_bf16 v[72:75], v[64:67], v[4:7], 0
  ds_read_b128 v[52:55], v116 offset:20480
  ds_read_b128 v[56:59], v116 offset:21504
  v_smfmac_f32_16x16x64_bf16 v[40:43], v[32:35], a[104:111], v3
  v_cvt_pk_bf16_f32 v64, v36, v37
  v_smfmac_f32_16x16x64_bf16 v[44:47], v[24:27], a[144:151], v3
  v_cvt_pk_bf16_f32 v65, v38, v39
  v_smfmac_f32_16x16x64_bf16 v[44:47], v[28:31], a[152:159], v3
  v_cvt_pk_bf16_f32 v76, v72, v73
  v_smfmac_f32_16x16x64_bf16 v[44:47], v[32:35], a[160:167], v3
  v_cvt_pk_bf16_f32 v77, v74, v75
  v_cvt_pk_bf16_f32 v66, v40, v41
  v_smfmac_f32_16x16x64_bf16 v[48:51], v[24:27], a[200:207], v3
  v_cvt_pk_bf16_f32 v67, v42, v43
  v_smfmac_f32_16x16x64_bf16 v[48:51], v[28:31], a[208:215], v3
  v_mfma_f32_16x16x32_bf16 v[68:71], v[64:67], v[4:7], 0
  v_smfmac_f32_16x16x64_bf16 v[48:51], v[32:35], a[216:223], v3
  v_cvt_pk_bf16_f32 v64, v44, v45
  v_mfma_f32_16x16x32_bf16 v[84:87], v[80:83], v[76:79], 0
  v_cvt_pk_bf16_f32 v65, v46, v47
  s_waitcnt lgkmcnt(0)
  v_smfmac_f32_16x16x64_bf16 v[88:91], v[76:79], v[96:103], v3
  v_cvt_pk_bf16_f32 v60, v68, v69
  v_cvt_pk_bf16_f32 v61, v70, v71
  v_cvt_pk_bf16_f32 v66, v48, v49
  v_cvt_pk_bf16_f32 v67, v50, v51
  s_nop 1
  v_mfma_f32_16x16x32_bf16 v[72:75], v[64:67], v[4:7], 0
  v_smfmac_f32_16x16x64_bf16 v[92:95], v[76:79], v[104:111], v3
  s_nop 4
  v_cvt_pk_bf16_f32 v62, v72, v73
  v_cvt_pk_bf16_f32 v63, v74, v75
  s_nop 1
  v_mfma_f32_16x16x32_bf16 v[84:87], v[20:23], v[60:63], v[84:87]
  v_smfmac_f32_16x16x64_bf16 v[88:91], v[60:63], v[8:15], v3
  v_smfmac_f32_16x16x64_bf16 v[92:95], v[60:63], v[52:59], v3
  s_mov_b64 exec, s[26:27]
  s_nop 0
  ds_write_b128 v113, v[84:87]
  s_mov_b64 exec, -1
  s_nop 0
  v_cmp_u_f32 vcc, v88, v89
  s_nop 1
  v_permlane32_swap_b32 v88, v92
  v_permlane32_swap_b32 v89, v93
  v_permlane32_swap_b32 v90, v94
  v_permlane32_swap_b32 v91, v95
  v_add_f32 v88, v88, v92
  v_add_f32 v89, v89, v93
  v_add_f32 v90, v90, v94
  v_add_f32 v91, v91, v95
  ds_write_b128 v112, v[88:91]
  s_cbranch_vccnz cB_sc3_retry
cB_sc3_cont:
  s_waitcnt lgkmcnt(0)
  s_barrier
  ds_read_b64 v[36:37], v114 offset:0
  ds_read_b64 v[38:39], v114 offset:1024
  ds_read2_b32 v[44:45], v115 offset0:0 offset1:64
  s_waitcnt lgkmcnt(0)
  v_add_f32 v44, v44, v45
  v_add_f32 v36, v36, v38
  v_add_f32 v37, v37, v39
  v_add_f32_dpp v44, v44, v44 row_ror:8 row_mask:0xf bank_mask:0xf
  v_mov_b32 v45, v44
  v_permlane32_swap_b32 v36, v37
  v_add_f32 v36, v36, v37
  v_permlane16_swap_b32 v44, v45
  v_add_f32 v44, v44, v45
  v_exp_f32 v48, v36
  v_exp_f32 v49, v44
  v_add_f32 v50, abs(v36), abs(v44)
  v_fma_f32 v39, v49, s37, v48
  v_cmp_ngt_f32 vcc, s56, v50
  v_cndmask_b32 v41, v48, v49, s[38:39]
  v_add_f32_dpp v39, v39, v39 quad_perm:[1,0,3,2] row_mask:0xf bank_mask:0xf
  v_cndmask_b32 v40, v49, v48, s[38:39]
  v_mov_b32_dpp v46, v41 quad_perm:[1,0,3,2] row_mask:0xf bank_mask:0xf
  v_add_f32_dpp v39, v39, v39 quad_perm:[2,3,0,1] row_mask:0xf bank_mask:0xf
  v_cndmask_b32 v42, v46, v40, s[38:39]
  v_cndmask_b32 v43, v40, v46, s[38:39]
  v_add_f32_dpp v39, v39, v39 row_half_mirror row_mask:0xf bank_mask:0xf
  s_cbranch_vccnz cB_sc3_slow
  s_nop 0
  v_add_f32_dpp v39, v39, v39 row_mirror row_mask:0xf bank_mask:0xf
  v_mov_b32 v47, v39
  s_nop 1
  v_permlane16_swap_b32 v39, v47
  v_add_f32 v39, v39, v47
  v_rcp_f32 v39, v39
  s_mov_b64 exec, s[28:29]
  v_mul_f32 v42, v42, v39
  v_mul_f32 v43, v43, v39
  v_cvt_pk_bf16_f32 v42, v42, v43
cB_sc3_pst:
  buffer_store_dword v42, v1, s[8:11], s20 offen sc1
  s_mov_b64 exec, -1
  s_barrier
  s_add_u32 s24, s24, 28672
  s_add_u32 s35, s35, 28672
  s_xor_b32 s25, s25, 28672
  s_add_u32 m0, s25, 21504
  s_nop 0
  buffer_load_dwordx4 v2, s[8:11], s24 offen offset:0 sc1 lds
  buffer_load_dwordx4 v2, s[8:11], s24 offen offset:1024 sc1 lds
  buffer_load_dwordx4 v2, s[8:11], s24 offen offset:2048 sc1 lds
  buffer_load_dwordx4 v2, s[8:11], s24 offen offset:3072 sc1 lds
  s_add_u32 m0, s25, 25600
  s_add_u32 s22, s24, 4096
  buffer_load_dwordx4 v2, s[8:11], s22 offen offset:0 sc1 lds
  buffer_load_dwordx4 v2, s[8:11], s22 offen offset:1024 sc1 lds
  buffer_load_dwordx4 v2, s[8:11], s22 offen offset:2048 sc1 lds
  v_xor_b32 v116, 28672, v116
  v_add_u32 v117, s57, v117
  s_sub_u32 s57, 0, s57
  s_add_u32 s19, s19, 1
  s_mov_b32 s20, s21
  s_cmp_lt_u32 s19, 63
  s_cbranch_scc1 cB_sc3_loop
  s_branch cB_done
cB_sc3_slow:
  v_max_f32 v50, v36, v44
  s_nop 1
  v_max_f32_dpp v50, v50, v50 quad_perm:[1,0,3,2] row_mask:0xf bank_mask:0xf
  s_nop 1
  v_max_f32_dpp v50, v50, v50 quad_perm:[2,3,0,1] row_mask:0xf bank_mask:0xf
  s_nop 1
  v_max_f32_dpp v50, v50, v50 row_half_mirror row_mask:0xf bank_mask:0xf
  s_nop 1
  v_max_f32_dpp v50, v50, v50 row_mirror row_mask:0xf bank_mask:0xf
  v_mov_b32 v47, v50
  s_nop 1
  v_permlane16_swap_b32 v50, v47
  v_max_f32 v50, v50, v47
  v_sub_f32 v48, v36, v50
  v_sub_f32 v49, v44, v50
  v_exp_f32 v48, v48
  v_exp_f32 v49, v49
  s_add_u32 s31, s31, 0x100
  v_fma_f32 v39, v49, s37, v48
  v_cndmask_b32 v41, v48, v49, s[38:39]
  s_nop 0
  v_add_f32_dpp v39, v39, v39 quad_perm:[1,0,3,2] row_mask:0xf bank_mask:0xf
  v_cndmask_b32 v40, v49, v48, s[38:39]
  v_mov_b32_dpp v46, v41 quad_perm:[1,0,3,2] row_mask:0xf bank_mask:0xf
  v_add_f32_dpp v39, v39, v39 quad_perm:[2,3,0,1] row_mask:0xf bank_mask:0xf
  v_cndmask_b32 v42, v46, v40, s[38:39]
  v_cndmask_b32 v43, v40, v46, s[38:39]
  v_add_f32_dpp v39, v39, v39 row_half_mirror row_mask:0xf bank_mask:0xf
  s_nop 1
  v_add_f32_dpp v39, v39, v39 row_mirror row_mask:0xf bank_mask:0xf
  v_mov_b32 v47, v39
  s_nop 1
  v_permlane16_swap_b32 v39, v47
  v_add_f32 v39, v39, v47
  v_rcp_f32 v39, v39
  s_mov_b64 exec, s[28:29]
  v_mul_f32 v42, v42, v39
  v_mul_f32 v43, v43, v39
  v_cvt_pk_bf16_f32 v42, v42, v43
  v_min_u32 v42, -2, v42
  s_branch cB_sc3_pst
cB_sc3_retry:
  s_cmp_lg_u32 s62, 0
  s_cbranch_scc1 cB_sc3_cont
  s_waitcnt vmcnt(0) lgkmcnt(0)
cB_sc3_rv:
  buffer_load_dwordx4 v[8:11], v2, s[8:11], s20 offen offset:0 sc1
  buffer_load_dwordx4 v[12:15], v2, s[8:11], s20 offen offset:1024 sc1
  buffer_load_dwordx4 v[16:19], v2, s[8:11], s20 offen offset:2048 sc1
  buffer_load_dwordx4 v[20:23], v2, s[8:11], s20 offen offset:3072 sc1
  buffer_load_dwordx4 v[24:27], v2, s[8:11], s23 offen offset:0 sc1
  buffer_load_dwordx4 v[28:31], v2, s[8:11], s23 offen offset:1024 sc1
  buffer_load_dwordx4 v[32:35], v2, s[8:11], s23 offen offset:2048 sc1
  s_waitcnt vmcnt(0)
  v_max3_u32 v118, v8, v9, v10
  v_max3_u32 v118, v118, v11, v12
  v_max3_u32 v118, v118, v13, v14
  v_max3_u32 v118, v118, v15, v16
  v_max3_u32 v118, v118, v17, v18
  v_max3_u32 v118, v118, v19, v20
  v_max3_u32 v118, v118, v21, v22
  v_max3_u32 v118, v118, v23, v24
  v_max3_u32 v118, v118, v25, v26
  v_max3_u32 v118, v118, v27, v28
  v_max3_u32 v118, v118, v29, v30
  v_max3_u32 v118, v118, v31, v32
  v_max3_u32 v118, v118, v33, v34
  v_max_u32 v118, v118, v35
  v_cmp_eq_u32 vcc, -1, v118
  s_cbranch_vccz cB_sc3_rk
  s_add_u32 s30, s30, 1
  s_cmp_lt_u32 s30, 400000
  s_cbranch_scc1 cB_sc3_rv
  s_branch cB_abort
cB_sc3_rk:
  s_mov_b32 s62, 1
  v_mov_b32 v36, 0
  v_mov_b32 v37, 0
  v_mov_b32 v38, 0
  v_mov_b32 v39, 0
  v_mov_b32 v40, 0
  v_mov_b32 v41, 0
  v_mov_b32 v42, 0
  v_mov_b32 v43, 0
  v_mov_b32 v44, 0
  v_mov_b32 v45, 0
  v_mov_b32 v46, 0
  v_mov_b32 v47, 0
  v_mov_b32 v48, 0
  v_mov_b32 v49, 0
  v_mov_b32 v50, 0
  v_mov_b32 v51, 0
  v_mov_b32 v52, 0
  v_mov_b32 v53, 0
  v_mov_b32 v54, 0
  v_mov_b32 v55, 0
  v_mov_b32 v56, 0
  v_mov_b32 v57, 0
  v_mov_b32 v58, 0
  v_mov_b32 v59, 0
  v_mov_b32 v60, 0
  v_mov_b32 v61, 0
  v_mov_b32 v62, 0
  v_mov_b32 v63, 0
  v_mov_b32 v88, 0
  v_mov_b32 v89, 0
  v_mov_b32 v90, 0
  v_mov_b32 v91, 0
  v_mov_b32 v92, 0
  v_mov_b32 v93, 0
  v_mov_b32 v94, 0
  v_mov_b32 v95, 0
  v_mov_b32 v64, 0
  v_mov_b32 v65, 0
  s_add_u32 s31, s31, 1
  ds_read_b128 v[96:99], v117 offset:0
  ds_read_b128 v[100:103], v117 offset:1024
  ds_read_b128 v[104:107], v117 offset:14336
  ds_read_b128 v[108:111], v117 offset:15360
  v_smfmac_f32_16x16x64_bf16 v[36:39], v[8:11], a[0:7], v3
  v_smfmac_f32_16x16x64_bf16 v[40:43], v[8:11], a[56:63], v3
  v_smfmac_f32_16x16x64_bf16 v[44:47], v[8:11], a[112:119], v3
  v_smfmac_f32_16x16x64_bf16 v[48:51], v[8:11], a[168:175], v3
  v_smfmac_f32_16x16x64_bf16 v[52:55], v[8:11], a[224:231], v3
  v_smfmac_f32_16x16x64_bf16 v[56:59], v[8:11], v[144:151], v3
  v_smfmac_f32_16x16x64_bf16 v[60:63], v[8:11], v[200:207], v3
  v_smfmac_f32_16x16x64_bf16 v[36:39], v[12:15], a[8:15], v3
  v_smfmac_f32_16x16x64_bf16 v[40:43], v[12:15], a[64:71], v3
  v_smfmac_f32_16x16x64_bf16 v[44:47], v[12:15], a[120:127], v3
  v_smfmac_f32_16x16x64_bf16 v[48:51], v[12:15], a[176:183], v3
  v_smfmac_f32_16x16x64_bf16 v[52:55], v[12:15], a[232:239], v3
  v_smfmac_f32_16x16x64_bf16 v[56:59], v[12:15], v[152:159], v3
  v_smfmac_f32_16x16x64_bf16 v[60:63], v[12:15], v[208:215], v3
  v_smfmac_f32_16x16x64_bf16 v[36:39], v[16:19], a[16:23], v3
  v_smfmac_f32_16x16x64_bf16 v[40:43], v[16:19], a[72:79], v3
  v_smfmac_f32_16x16x64_bf16 v[44:47], v[16:19], a[128:135], v3
  v_smfmac_f32_16x16x64_bf16 v[48:51], v[16:19], a[184:191], v3
  v_smfmac_f32_16x16x64_bf16 v[52:55], v[16:19], a[240:247], v3
  v_smfmac_f32_16x16x64_bf16 v[56:59], v[16:19], v[160:167], v3
  v_smfmac_f32_16x16x64_bf16 v[60:63], v[16:19], v[216:223], v3
  v_smfmac_f32_16x16x64_bf16 v[36:39], v[20:23], a[24:31], v3
  v_smfmac_f32_16x16x64_bf16 v[40:43], v[20:23], a[80:87], v3
  v_smfmac_f32_16x16x64_bf16 v[44:47], v[20:23], a[136:143], v3
  v_smfmac_f32_16x16x64_bf16 v[48:51], v[20:23], a[192:199], v3
  v_smfmac_f32_16x16x64_bf16 v[52:55], v[20:23], a[248:255], v3
  v_smfmac_f32_16x16x64_bf16 v[56:59], v[20:23], v[168:175], v3
  v_smfmac_f32_16x16x64_bf16 v[60:63], v[20:23], v[224:231], v3
  s_branch cB_sc3_ph2
.p2align 6

cB_va0_loop:
  s_add_u32 s23, s20, 4096
  s_add_u32 s21, s20, 25600
  s_mov_b32 s30, 0
  s_cmp_lg_u32 s19, s38
  s_cbranch_scc1 cB_va0_vok
  s_branch cB_va0_voc
cB_va0_vow:
  buffer_load_dword v175, off, s[8:11], s35 sc1
  s_waitcnt vmcnt(0)
cB_va0_voc:
  v_readfirstlane_b32 s22, v175
  s_cmp_eq_u32 s22, 56
  s_cbranch_scc1 cB_va0_vod
  s_sleep 1
  s_add_u32 s30, s30, 1
  s_cmp_lt_u32 s30, 400000
  s_cbranch_scc1 cB_va0_vow
  s_branch cB_abort
cB_va0_vod:
  s_add_u32 s35, s35, 2048
  s_add_u32 s38, s19, 8
  s_and_b32 s38, s38, -8
  s_cmp_eq_u32 s19, 0
  s_cselect_b32 s38, 4, s38
cB_va0_vok:
  s_cmp_eq_u32 s19, 63
  s_cbranch_scc1 cB_done
  s_barrier
  s_add_u32 s22, s25, 0
  buffer_load_dwordx4 v[80:83], v6, s[8:11], s22 offen offset:0 sc1
  buffer_load_dwordx4 v[84:87], v6, s[8:11], s22 offen offset:1792 sc1
  s_add_u32 s22, s25, 3584
  buffer_load_dwordx4 v[88:91], v6, s[8:11], s22 offen offset:0 sc1
  buffer_load_dwordx4 v[92:95], v6, s[8:11], s22 offen offset:1792 sc1
  s_add_u32 s22, s25, 7168
  buffer_load_dwordx4 v[96:99], v6, s[8:11], s22 offen offset:0 sc1
  buffer_load_dwordx4 v[100:103], v6, s[8:11], s22 offen offset:1792 sc1
  s_add_u32 s22, s25, 10752
  buffer_load_dwordx4 v[104:107], v6, s[8:11], s22 offen offset:0 sc1
  buffer_load_dwordx4 v[108:111], v6, s[8:11], s22 offen offset:1792 sc1
  s_add_u32 s22, s25, 14336
  buffer_load_dwordx4 v[112:115], v6, s[8:11], s22 offen offset:0 sc1
  buffer_load_dwordx4 v[116:119], v6, s[8:11], s22 offen offset:1792 sc1
  s_add_u32 s22, s25, 17920
  buffer_load_dwordx4 v[120:123], v6, s[8:11], s22 offen offset:0 sc1
  buffer_load_dwordx4 v[124:127], v6, s[8:11], s22 offen offset:1792 sc1
  s_add_u32 s22, s25, 21504
  buffer_load_dwordx4 v[128:131], v6, s[8:11], s22 offen offset:0 sc1
  buffer_load_dwordx4 v[132:135], v6, s[8:11], s22 offen offset:1792 sc1
  s_add_u32 s22, s25, 25088
  buffer_load_dwordx4 v[136:139], v6, s[8:11], s22 offen offset:0 sc1
  buffer_load_dwordx4 v[140:143], v6, s[8:11], s22 offen offset:1792 sc1
  buffer_load_dword v175, off, s[8:11], s35 sc1
  s_barrier
  ds_read_b128 v[8:11], v2 offset:8192
  ds_read_b128 v[12:15], v2 offset:9216
  ds_read_b128 v[16:19], v2 offset:10240
  ds_read_b128 v[20:23], v2 offset:11264
  ds_read_b128 v[24:27], v2 offset:12288
  ds_read_b128 v[28:31], v2 offset:13312
  ds_read_b128 v[32:35], v2 offset:14336
  s_waitcnt lgkmcnt(0)
  v_smfmac_f32_16x16x64_bf16 v[36:39], v[8:11], a[0:7], v3
  v_smfmac_f32_16x16x64_bf16 v[36:39], v[12:15], a[8:15], v3
  v_smfmac_f32_16x16x64_bf16 v[36:39], v[16:19], a[16:23], v3
  v_smfmac_f32_16x16x64_bf16 v[36:39], v[20:23], a[24:31], v3
  v_smfmac_f32_16x16x64_bf16 v[36:39], v[24:27], a[32:39], v3
  v_smfmac_f32_16x16x64_bf16 v[36:39], v[28:31], a[40:47], v3
  v_smfmac_f32_16x16x64_bf16 v[36:39], v[32:35], a[48:55], v3
  v_smfmac_f32_16x16x64_bf16 v[40:43], v[8:11], a[56:63], v3
  v_smfmac_f32_16x16x64_bf16 v[40:43], v[12:15], a[64:71], v3
  v_smfmac_f32_16x16x64_bf16 v[40:43], v[16:19], a[72:79], v3
  v_smfmac_f32_16x16x64_bf16 v[40:43], v[20:23], a[80:87], v3
  v_smfmac_f32_16x16x64_bf16 v[40:43], v[24:27], a[88:95], v3
  v_smfmac_f32_16x16x64_bf16 v[40:43], v[28:31], a[96:103], v3
  v_smfmac_f32_16x16x64_bf16 v[40:43], v[32:35], a[104:111], v3
  v_smfmac_f32_16x16x64_bf16 v[44:47], v[8:11], a[112:119], v3
  v_smfmac_f32_16x16x64_bf16 v[44:47], v[12:15], a[120:127], v3
  v_smfmac_f32_16x16x64_bf16 v[44:47], v[16:19], a[128:135], v3
  v_smfmac_f32_16x16x64_bf16 v[44:47], v[20:23], a[136:143], v3
  v_permlane32_swap_b32 v36, v40
  v_smfmac_f32_16x16x64_bf16 v[44:47], v[24:27], a[144:151], v3
  v_permlane32_swap_b32 v37, v41
  v_smfmac_f32_16x16x64_bf16 v[44:47], v[28:31], a[152:159], v3
  v_permlane32_swap_b32 v38, v42
  v_smfmac_f32_16x16x64_bf16 v[44:47], v[32:35], a[160:167], v3
  v_permlane32_swap_b32 v39, v43
  v_smfmac_f32_16x16x64_bf16 v[48:51], v[8:11], a[168:175], v3
  v_add_f32 v36, v36, v40
  v_smfmac_f32_16x16x64_bf16 v[48:51], v[12:15], a[176:183], v3
  v_add_f32 v37, v37, v41
  v_smfmac_f32_16x16x64_bf16 v[48:51], v[16:19], a[184:191], v3
  v_add_f32 v38, v38, v42
  v_smfmac_f32_16x16x64_bf16 v[48:51], v[20:23], a[192:199], v3
  v_add_f32 v39, v39, v43
  v_smfmac_f32_16x16x64_bf16 v[48:51], v[24:27], a[200:207], v3
  v_cvt_pk_bf16_f32 v40, v36, v37
  v_smfmac_f32_16x16x64_bf16 v[48:51], v[28:31], a[208:215], v3
  v_cvt_pk_bf16_f32 v41, v38, v39
  v_smfmac_f32_16x16x64_bf16 v[48:51], v[32:35], a[216:223], v3
  ds_write_b64 v60, v[40:41]
  v_smfmac_f32_16x16x64_bf16 v[52:55], v[8:11], a[224:231], v3
  v_smfmac_f32_16x16x64_bf16 v[52:55], v[12:15], a[232:239], v3
  v_smfmac_f32_16x16x64_bf16 v[52:55], v[16:19], a[240:247], v3
  v_smfmac_f32_16x16x64_bf16 v[52:55], v[20:23], a[248:255], v3
  v_permlane32_swap_b32 v44, v48
  v_smfmac_f32_16x16x64_bf16 v[52:55], v[24:27], v[176:183], v3
  v_permlane32_swap_b32 v45, v49
  v_smfmac_f32_16x16x64_bf16 v[52:55], v[28:31], v[184:191], v3
  v_permlane32_swap_b32 v46, v50
  v_smfmac_f32_16x16x64_bf16 v[52:55], v[32:35], v[192:199], v3
  v_permlane32_swap_b32 v47, v51
  v_smfmac_f32_16x16x64_bf16 v[56:59], v[8:11], v[200:207], v3
  v_add_f32 v44, v44, v48
  v_smfmac_f32_16x16x64_bf16 v[56:59], v[12:15], v[208:215], v3
  v_add_f32 v45, v45, v49
  v_smfmac_f32_16x16x64_bf16 v[56:59], v[16:19], v[216:223], v3
  v_add_f32 v46, v46, v50
  v_smfmac_f32_16x16x64_bf16 v[56:59], v[20:23], v[224:231], v3
  v_add_f32 v47, v47, v51
  v_smfmac_f32_16x16x64_bf16 v[56:59], v[24:27], v[232:239], v3
  v_cvt_pk_bf16_f32 v48, v44, v45
  v_smfmac_f32_16x16x64_bf16 v[56:59], v[28:31], v[240:247], v3
  v_cvt_pk_bf16_f32 v49, v46, v47
  v_smfmac_f32_16x16x64_bf16 v[56:59], v[32:35], v[248:255], v3
  ds_write_b64 v61, v[48:49]
  s_nop 6
  v_permlane32_swap_b32 v52, v56
  v_permlane32_swap_b32 v53, v57
  v_permlane32_swap_b32 v54, v58
  v_permlane32_swap_b32 v55, v59
  v_add_f32 v52, v52, v56
  v_add_f32 v53, v53, v57
  v_add_f32 v54, v54, v58
  v_add_f32 v55, v55, v59
  v_cvt_pk_bf16_f32 v56, v52, v53
  v_cvt_pk_bf16_f32 v57, v54, v55
  ds_write_b64 v62, v[56:57]
  s_cmp_eq_u32 s19, 63
  s_cbranch_scc1 cB_va0_last
  s_add_u32 s22, s20, 9216
  s_add_u32 s34, s20, 13312
  s_add_u32 s36, s20, 7168
  s_mov_b32 s37, 0
  v_mov_b32 v156, 0
  v_mov_b32 v157, 0
  v_mov_b32 v158, 0
  v_mov_b32 v159, 0
  buffer_load_dword v164, v4, s[8:11], s20 offen sc1
  s_nop 7
  buffer_load_dword v165, v4, s[8:11], s20 offen sc1
  s_nop 7
  buffer_load_dword v166, v4, s[8:11], s20 offen sc1
  s_nop 7
  buffer_load_dword v167, v4, s[8:11], s20 offen sc1
  s_nop 7
  buffer_load_dword v168, v4, s[8:11], s20 offen sc1
cB_va0_fw_l:
  s_waitcnt vmcnt(4)
  v_cmp_eq_u32 vcc, -1, v164
  s_cbranch_vccz cB_va0_fw_d
  buffer_load_dword v164, v4, s[8:11], s20 offen sc1
  s_waitcnt vmcnt(4)
  v_cmp_eq_u32 vcc, -1, v165
  s_cbranch_vccz cB_va0_fw_d
  buffer_load_dword v165, v4, s[8:11], s20 offen sc1
  s_waitcnt vmcnt(4)
  v_cmp_eq_u32 vcc, -1, v166
  s_cbranch_vccz cB_va0_fw_d
  buffer_load_dword v166, v4, s[8:11], s20 offen sc1
  s_waitcnt vmcnt(4)
  v_cmp_eq_u32 vcc, -1, v167
  s_cbranch_vccz cB_va0_fw_d
  buffer_load_dword v167, v4, s[8:11], s20 offen sc1
  s_waitcnt vmcnt(4)
  v_cmp_eq_u32 vcc, -1, v168
  s_cbranch_vccz cB_va0_fw_d
  buffer_load_dword v168, v4, s[8:11], s20 offen sc1
  s_add_u32 s30, s30, 1
  s_cmp_lt_u32 s30, 400000
  s_cbranch_scc1 cB_va0_fw_l
  s_branch cB_abort
cB_va0_fw_d:
  s_waitcnt lgkmcnt(0)
  buffer_load_dwordx4 v[8:11], v2, s[8:11], s22 offen offset:0 sc1
  v_mov_b32 v36, 0
  v_mov_b32 v37, 0
  v_mov_b32 v38, 0
  buffer_load_dwordx4 v[12:15], v2, s[8:11], s22 offen offset:1024 sc1
  v_mov_b32 v39, 0
  v_mov_b32 v40, 0
  v_mov_b32 v41, 0
  buffer_load_dwordx4 v[16:19], v2, s[8:11], s22 offen offset:2048 sc1
  v_mov_b32 v42, 0
  v_mov_b32 v43, 0
  v_mov_b32 v44, 0
  buffer_load_dwordx4 v[20:23], v2, s[8:11], s22 offen offset:3072 sc1
  v_mov_b32 v45, 0
  v_mov_b32 v46, 0
  v_mov_b32 v47, 0
  buffer_load_dwordx4 v[24:27], v2, s[8:11], s34 offen offset:0 sc1
  v_mov_b32 v48, 0
  v_mov_b32 v49, 0
  v_mov_b32 v50, 0
  buffer_load_dwordx4 v[28:31], v2, s[8:11], s34 offen offset:1024 sc1
  v_mov_b32 v51, 0
  v_mov_b32 v52, 0
  v_mov_b32 v53, 0
  buffer_load_dwordx4 v[32:35], v2, s[8:11], s34 offen offset:2048 sc1
  v_mov_b32 v54, 0
  v_mov_b32 v55, 0
  v_mov_b32 v56, 0
  buffer_load_dwordx4 v[144:147], v2, s[8:11], s34 offen offset:3072 sc1
  v_mov_b32 v57, 0
  v_mov_b32 v58, 0
  v_mov_b32 v59, 0
  buffer_load_dwordx4 v[148:151], v2, s[8:11], s36 offen offset:0 sc1
  buffer_load_dwordx4 v[152:155], v2, s[8:11], s36 offen offset:1024 sc1
  s_barrier
  ds_read_b128 v[64:67], v2 offset:0
  ds_read_b128 v[68:71], v2 offset:1024
  ds_read_b128 v[72:75], v2 offset:2048
  ds_read_b128 v[76:79], v2 offset:3072
  s_waitcnt vmcnt(9)
  v_smfmac_f32_16x16x64_bf16 v[156:159], v[8:11], v[80:87], v3
  s_waitcnt vmcnt(8)
  v_smfmac_f32_16x16x64_bf16 v[156:159], v[12:15], v[88:95], v3
  s_waitcnt vmcnt(7)
  v_smfmac_f32_16x16x64_bf16 v[156:159], v[16:19], v[96:103], v3
  s_waitcnt vmcnt(6)
  v_smfmac_f32_16x16x64_bf16 v[156:159], v[20:23], v[104:111], v3
  s_waitcnt vmcnt(5)
  v_smfmac_f32_16x16x64_bf16 v[156:159], v[24:27], v[112:119], v3
  s_mov_b32 exec_hi, 0
  buffer_store_dword v2, v7, s[8:11], s21 offen sc1
  s_mov_b64 exec, -1
  s_waitcnt vmcnt(5)
  v_smfmac_f32_16x16x64_bf16 v[156:159], v[28:31], v[120:127], v3
  s_waitcnt vmcnt(4)
  v_smfmac_f32_16x16x64_bf16 v[156:159], v[32:35], v[128:135], v3
  s_waitcnt vmcnt(3)
  v_smfmac_f32_16x16x64_bf16 v[156:159], v[144:147], v[136:143], v3
  s_waitcnt vmcnt(2) lgkmcnt(0)
  v_smfmac_f32_16x16x64_bf16 v[156:159], v[148:151], v[64:71], v3
  s_waitcnt vmcnt(1)
  v_smfmac_f32_16x16x64_bf16 v[156:159], v[152:155], v[72:79], v3
cB_va0_ep:
  s_nop 7
  v_permlane32_swap_b32 v156, v158
  v_permlane32_swap_b32 v157, v159
  v_add_f32 v160, v156, v158
  v_add_f32 v161, v157, v159
  v_cmp_u_f32 vcc, v160, v161
  v_mov_b32_dpp v162, v160 row_ror:8 row_mask:0xf bank_mask:0xf
  v_mov_b32_dpp v160, v161 row_ror:8 row_mask:0xf bank_mask:0xc
  s_cbranch_vccnz cB_va0_rp
  v_mov_b32_dpp v161, v162 quad_perm:[0,1,2,3] row_mask:0xf bank_mask:0x3
  v_cvt_pk_bf16_f32 v160, v160, v161
cB_va0_pc:
  buffer_store_dword v160, v1, s[8:11], s21 offen sc1
  s_cmp_lg_u32 s19, 62
  s_cbranch_scc1 cB_va0_nl
  s_mov_b32 s22, 88519680
  buffer_store_dword v160, v1, s[8:11], s22 offen sc1
  s_mov_b64 exec, -1
  s_branch cB_done
cB_va0_nl:
  s_mov_b64 exec, -1
  s_add_u32 s25, s25, 28672
  s_add_u32 s19, s19, 1
  s_mov_b32 s20, s21
  s_branch cB_va0_loop
cB_va0_last:
  s_waitcnt lgkmcnt(0)
  s_barrier
  s_branch cB_done
cB_va0_rp:
  s_cmp_eq_u32 s37, 0
  s_cbranch_scc1 cB_va0_rv
  v_mov_b32_dpp v161, v162 quad_perm:[0,1,2,3] row_mask:0xf bank_mask:0x3
  v_cvt_pk_bf16_f32 v160, v160, v161
  v_min_u32 v160, -2, v160
  s_branch cB_va0_pc
cB_va0_rv:
  buffer_load_dwordx4 v[8:11], v2, s[8:11], s22 offen offset:0 sc1
  buffer_load_dwordx4 v[12:15], v2, s[8:11], s22 offen offset:1024 sc1
  buffer_load_dwordx4 v[16:19], v2, s[8:11], s22 offen offset:2048 sc1
  buffer_load_dwordx4 v[20:23], v2, s[8:11], s22 offen offset:3072 sc1
  buffer_load_dwordx4 v[24:27], v2, s[8:11], s34 offen offset:0 sc1
  buffer_load_dwordx4 v[28:31], v2, s[8:11], s34 offen offset:1024 sc1
  buffer_load_dwordx4 v[32:35], v2, s[8:11], s34 offen offset:2048 sc1
  buffer_load_dwordx4 v[144:147], v2, s[8:11], s34 offen offset:3072 sc1
  buffer_load_dwordx4 v[148:151], v2, s[8:11], s36 offen offset:0 sc1
  buffer_load_dwordx4 v[152:155], v2, s[8:11], s36 offen offset:1024 sc1
  s_waitcnt vmcnt(0)
  v_max3_u32 v63, v8, v9, v10
  v_max3_u32 v63, v63, v11, v12
  v_max3_u32 v63, v63, v13, v14
  v_max3_u32 v63, v63, v15, v16
  v_max3_u32 v63, v63, v17, v18
  v_max3_u32 v63, v63, v19, v20
  v_max3_u32 v63, v63, v21, v22
  v_max3_u32 v63, v63, v23, v24
  v_max3_u32 v63, v63, v25, v26
  v_max3_u32 v63, v63, v27, v28
  v_max3_u32 v63, v63, v29, v30
  v_max3_u32 v63, v63, v31, v32
  v_max3_u32 v63, v63, v33, v34
  v_max3_u32 v63, v63, v35, v144
  v_max3_u32 v63, v63, v145, v146
  v_max3_u32 v63, v63, v147, v148
  v_max3_u32 v63, v63, v149, v150
  v_max3_u32 v63, v63, v151, v152
  v_max3_u32 v63, v63, v153, v154
  v_max_u32 v63, v63, v155
  v_cmp_eq_u32 vcc, -1, v63
  s_cbranch_vccz cB_va0_rk
  s_add_u32 s30, s30, 1
  s_cmp_lt_u32 s30, 400000
  s_cbranch_scc1 cB_va0_rv
  s_branch cB_abort
cB_va0_rk:
  s_mov_b32 s37, 1
  s_add_u32 s31, s31, 0x10000
  v_mov_b32 v156, 0
  v_mov_b32 v157, 0
  v_mov_b32 v158, 0
  v_mov_b32 v159, 0
  s_nop 1
  v_smfmac_f32_16x16x64_bf16 v[156:159], v[8:11], v[80:87], v3
  v_smfmac_f32_16x16x64_bf16 v[156:159], v[12:15], v[88:95], v3
  v_smfmac_f32_16x16x64_bf16 v[156:159], v[16:19], v[96:103], v3
  v_smfmac_f32_16x16x64_bf16 v[156:159], v[20:23], v[104:111], v3
  v_smfmac_f32_16x16x64_bf16 v[156:159], v[24:27], v[112:119], v3
  v_smfmac_f32_16x16x64_bf16 v[156:159], v[28:31], v[120:127], v3
  v_smfmac_f32_16x16x64_bf16 v[156:159], v[32:35], v[128:135], v3
  v_smfmac_f32_16x16x64_bf16 v[156:159], v[144:147], v[136:143], v3
  v_smfmac_f32_16x16x64_bf16 v[156:159], v[148:151], v[64:71], v3
  v_smfmac_f32_16x16x64_bf16 v[156:159], v[152:155], v[72:79], v3
  s_nop 7
  s_branch cB_va0_ep
.p2align 6

cB_va1_loop:
  s_add_u32 s23, s20, 4096
  s_add_u32 s21, s20, 25600
  s_mov_b32 s30, 0
  s_cmp_lg_u32 s19, s38
  s_cbranch_scc1 cB_va1_vok
  s_branch cB_va1_voc
cB_va1_vow:
  buffer_load_dword v175, off, s[8:11], s35 sc1
  s_waitcnt vmcnt(0)
cB_va1_voc:
  v_readfirstlane_b32 s22, v175
  s_cmp_eq_u32 s22, 56
  s_cbranch_scc1 cB_va1_vod
  s_sleep 1
  s_add_u32 s30, s30, 1
  s_cmp_lt_u32 s30, 400000
  s_cbranch_scc1 cB_va1_vow
  s_branch cB_abort
cB_va1_vod:
  s_add_u32 s35, s35, 2048
  s_add_u32 s38, s19, 8
  s_and_b32 s38, s38, -8
  s_cmp_eq_u32 s19, 0
  s_cselect_b32 s38, 4, s38
cB_va1_vok:
  s_cmp_eq_u32 s19, 63
  s_cbranch_scc1 cB_done
  s_barrier
  s_add_u32 s22, s25, 0
  buffer_load_dwordx4 v[80:83], v6, s[8:11], s22 offen offset:0 sc1
  buffer_load_dwordx4 v[84:87], v6, s[8:11], s22 offen offset:1792 sc1
  s_add_u32 s22, s25, 3584
  buffer_load_dwordx4 v[88:91], v6, s[8:11], s22 offen offset:0 sc1
  buffer_load_dwordx4 v[92:95], v6, s[8:11], s22 offen offset:1792 sc1
  s_add_u32 s22, s25, 7168
  buffer_load_dwordx4 v[96:99], v6, s[8:11], s22 offen offset:0 sc1
  buffer_load_dwordx4 v[100:103], v6, s[8:11], s22 offen offset:1792 sc1
  s_add_u32 s22, s25, 10752
  buffer_load_dwordx4 v[104:107], v6, s[8:11], s22 offen offset:0 sc1
  buffer_load_dwordx4 v[108:111], v6, s[8:11], s22 offen offset:1792 sc1
  s_add_u32 s22, s25, 14336
  buffer_load_dwordx4 v[112:115], v6, s[8:11], s22 offen offset:0 sc1
  buffer_load_dwordx4 v[116:119], v6, s[8:11], s22 offen offset:1792 sc1
  s_add_u32 s22, s25, 17920
  buffer_load_dwordx4 v[120:123], v6, s[8:11], s22 offen offset:0 sc1
  buffer_load_dwordx4 v[124:127], v6, s[8:11], s22 offen offset:1792 sc1
  s_add_u32 s22, s25, 21504
  buffer_load_dwordx4 v[128:131], v6, s[8:11], s22 offen offset:0 sc1
  buffer_load_dwordx4 v[132:135], v6, s[8:11], s22 offen offset:1792 sc1
  s_add_u32 s22, s25, 25088
  buffer_load_dwordx4 v[136:139], v6, s[8:11], s22 offen offset:0 sc1
  buffer_load_dwordx4 v[140:143], v6, s[8:11], s22 offen offset:1792 sc1
  buffer_load_dword v175, off, s[8:11], s35 sc1
  s_barrier
  ds_read_b128 v[8:11], v2 offset:8192
  ds_read_b128 v[12:15], v2 offset:9216
  ds_read_b128 v[16:19], v2 offset:10240
  ds_read_b128 v[20:23], v2 offset:11264
  ds_read_b128 v[24:27], v2 offset:12288
  ds_read_b128 v[28:31], v2 offset:13312
  ds_read_b128 v[32:35], v2 offset:14336
  s_waitcnt lgkmcnt(0)
  v_smfmac_f32_16x16x64_bf16 v[36:39], v[8:11], a[0:7], v3
  v_smfmac_f32_16x16x64_bf16 v[36:39], v[12:15], a[8:15], v3
  v_smfmac_f32_16x16x64_bf16 v[36:39], v[16:19], a[16:23], v3
  v_smfmac_f32_16x16x64_bf16 v[36:39], v[20:23], a[24:31], v3
  v_smfmac_f32_16x16x64_bf16 v[36:39], v[24:27], a[32:39], v3
  v_smfmac_f32_16x16x64_bf16 v[36:39], v[28:31], a[40:47], v3
  v_smfmac_f32_16x16x64_bf16 v[36:39], v[32:35], a[48:55], v3
  v_smfmac_f32_16x16x64_bf16 v[40:43], v[8:11], a[56:63], v3
  v_smfmac_f32_16x16x64_bf16 v[40:43], v[12:15], a[64:71], v3
  v_smfmac_f32_16x16x64_bf16 v[40:43], v[16:19], a[72:79], v3
  v_smfmac_f32_16x16x64_bf16 v[40:43], v[20:23], a[80:87], v3
  v_smfmac_f32_16x16x64_bf16 v[40:43], v[24:27], a[88:95], v3
  v_smfmac_f32_16x16x64_bf16 v[40:43], v[28:31], a[96:103], v3
  v_smfmac_f32_16x16x64_bf16 v[40:43], v[32:35], a[104:111], v3
  v_smfmac_f32_16x16x64_bf16 v[44:47], v[8:11], a[112:119], v3
  v_smfmac_f32_16x16x64_bf16 v[44:47], v[12:15], a[120:127], v3
  v_smfmac_f32_16x16x64_bf16 v[44:47], v[16:19], a[128:135], v3
  v_smfmac_f32_16x16x64_bf16 v[44:47], v[20:23], a[136:143], v3
  v_permlane32_swap_b32 v36, v40
  v_smfmac_f32_16x16x64_bf16 v[44:47], v[24:27], a[144:151], v3
  v_permlane32_swap_b32 v37, v41
  v_smfmac_f32_16x16x64_bf16 v[44:47], v[28:31], a[152:159], v3
  v_permlane32_swap_b32 v38, v42
  v_smfmac_f32_16x16x64_bf16 v[44:47], v[32:35], a[160:167], v3
  v_permlane32_swap_b32 v39, v43
  v_smfmac_f32_16x16x64_bf16 v[48:51], v[8:11], a[168:175], v3
  v_add_f32 v36, v36, v40
  v_smfmac_f32_16x16x64_bf16 v[48:51], v[12:15], a[176:183], v3
  v_add_f32 v37, v37, v41
  v_smfmac_f32_16x16x64_bf16 v[48:51], v[16:19], a[184:191], v3
  v_add_f32 v38, v38, v42
  v_smfmac_f32_16x16x64_bf16 v[48:51], v[20:23], a[192:199], v3
  v_add_f32 v39, v39, v43
  v_smfmac_f32_16x16x64_bf16 v[48:51], v[24:27], a[200:207], v3
  v_cvt_pk_bf16_f32 v40, v36, v37
  v_smfmac_f32_16x16x64_bf16 v[48:51], v[28:31], a[208:215], v3
  v_cvt_pk_bf16_f32 v41, v38, v39
  v_smfmac_f32_16x16x64_bf16 v[48:51], v[32:35], a[216:223], v3
  ds_write_b64 v60, v[40:41]
  v_smfmac_f32_16x16x64_bf16 v[52:55], v[8:11], a[224:231], v3
  v_smfmac_f32_16x16x64_bf16 v[52:55], v[12:15], a[232:239], v3
  v_smfmac_f32_16x16x64_bf16 v[52:55], v[16:19], a[240:247], v3
  v_smfmac_f32_16x16x64_bf16 v[52:55], v[20:23], a[248:255], v3
  v_permlane32_swap_b32 v44, v48
  v_smfmac_f32_16x16x64_bf16 v[52:55], v[24:27], v[176:183], v3
  v_permlane32_swap_b32 v45, v49
  v_smfmac_f32_16x16x64_bf16 v[52:55], v[28:31], v[184:191], v3
  v_permlane32_swap_b32 v46, v50
  v_smfmac_f32_16x16x64_bf16 v[52:55], v[32:35], v[192:199], v3
  v_permlane32_swap_b32 v47, v51
  v_smfmac_f32_16x16x64_bf16 v[56:59], v[8:11], v[200:207], v3
  v_add_f32 v44, v44, v48
  v_smfmac_f32_16x16x64_bf16 v[56:59], v[12:15], v[208:215], v3
  v_add_f32 v45, v45, v49
  v_smfmac_f32_16x16x64_bf16 v[56:59], v[16:19], v[216:223], v3
  v_add_f32 v46, v46, v50
  v_smfmac_f32_16x16x64_bf16 v[56:59], v[20:23], v[224:231], v3
  v_add_f32 v47, v47, v51
  v_smfmac_f32_16x16x64_bf16 v[56:59], v[24:27], v[232:239], v3
  v_cvt_pk_bf16_f32 v48, v44, v45
  v_smfmac_f32_16x16x64_bf16 v[56:59], v[28:31], v[240:247], v3
  v_cvt_pk_bf16_f32 v49, v46, v47
  v_smfmac_f32_16x16x64_bf16 v[56:59], v[32:35], v[248:255], v3
  ds_write_b64 v61, v[48:49]
  s_nop 6
  v_permlane32_swap_b32 v52, v56
  v_permlane32_swap_b32 v53, v57
  v_permlane32_swap_b32 v54, v58
  v_permlane32_swap_b32 v55, v59
  v_add_f32 v52, v52, v56
  v_add_f32 v53, v53, v57
  v_add_f32 v54, v54, v58
  v_add_f32 v55, v55, v59
  v_cvt_pk_bf16_f32 v56, v52, v53
  v_cvt_pk_bf16_f32 v57, v54, v55
  ds_write_b64 v62, v[56:57]
  s_cmp_eq_u32 s19, 63
  s_cbranch_scc1 cB_va1_last
  s_add_u32 s22, s20, 9216
  s_add_u32 s34, s20, 13312
  s_add_u32 s36, s20, 7168
  s_mov_b32 s37, 0
  v_mov_b32 v156, 0
  v_mov_b32 v157, 0
  v_mov_b32 v158, 0
  v_mov_b32 v159, 0
  buffer_load_dword v164, v4, s[8:11], s20 offen sc1
  s_nop 7
  buffer_load_dword v165, v4, s[8:11], s20 offen sc1
  s_nop 7
  buffer_load_dword v166, v4, s[8:11], s20 offen sc1
  s_nop 7
  buffer_load_dword v167, v4, s[8:11], s20 offen sc1
  s_nop 7
  buffer_load_dword v168, v4, s[8:11], s20 offen sc1
cB_va1_fw_l:
  s_waitcnt vmcnt(4)
  v_cmp_eq_u32 vcc, -1, v164
  s_cbranch_vccz cB_va1_fw_d
  buffer_load_dword v164, v4, s[8:11], s20 offen sc1
  s_waitcnt vmcnt(4)
  v_cmp_eq_u32 vcc, -1, v165
  s_cbranch_vccz cB_va1_fw_d
  buffer_load_dword v165, v4, s[8:11], s20 offen sc1
  s_waitcnt vmcnt(4)
  v_cmp_eq_u32 vcc, -1, v166
  s_cbranch_vccz cB_va1_fw_d
  buffer_load_dword v166, v4, s[8:11], s20 offen sc1
  s_waitcnt vmcnt(4)
  v_cmp_eq_u32 vcc, -1, v167
  s_cbranch_vccz cB_va1_fw_d
  buffer_load_dword v167, v4, s[8:11], s20 offen sc1
  s_waitcnt vmcnt(4)
  v_cmp_eq_u32 vcc, -1, v168
  s_cbranch_vccz cB_va1_fw_d
  buffer_load_dword v168, v4, s[8:11], s20 offen sc1
  s_add_u32 s30, s30, 1
  s_cmp_lt_u32 s30, 400000
  s_cbranch_scc1 cB_va1_fw_l
  s_branch cB_abort
cB_va1_fw_d:
  s_waitcnt lgkmcnt(0)
  buffer_load_dwordx4 v[8:11], v2, s[8:11], s22 offen offset:0 sc1
  v_mov_b32 v36, 0
  v_mov_b32 v37, 0
  v_mov_b32 v38, 0
  buffer_load_dwordx4 v[12:15], v2, s[8:11], s22 offen offset:1024 sc1
  v_mov_b32 v39, 0
  v_mov_b32 v40, 0
  v_mov_b32 v41, 0
  buffer_load_dwordx4 v[16:19], v2, s[8:11], s22 offen offset:2048 sc1
  v_mov_b32 v42, 0
  v_mov_b32 v43, 0
  v_mov_b32 v44, 0
  buffer_load_dwordx4 v[20:23], v2, s[8:11], s22 offen offset:3072 sc1
  v_mov_b32 v45, 0
  v_mov_b32 v46, 0
  v_mov_b32 v47, 0
  buffer_load_dwordx4 v[24:27], v2, s[8:11], s34 offen offset:0 sc1
  v_mov_b32 v48, 0
  v_mov_b32 v49, 0
  v_mov_b32 v50, 0
  buffer_load_dwordx4 v[28:31], v2, s[8:11], s34 offen offset:1024 sc1
  v_mov_b32 v51, 0
  v_mov_b32 v52, 0
  v_mov_b32 v53, 0
  buffer_load_dwordx4 v[32:35], v2, s[8:11], s34 offen offset:2048 sc1
  v_mov_b32 v54, 0
  v_mov_b32 v55, 0
  v_mov_b32 v56, 0
  buffer_load_dwordx4 v[144:147], v2, s[8:11], s34 offen offset:3072 sc1
  v_mov_b32 v57, 0
  v_mov_b32 v58, 0
  v_mov_b32 v59, 0
  buffer_load_dwordx4 v[148:151], v2, s[8:11], s36 offen offset:0 sc1
  buffer_load_dwordx4 v[152:155], v2, s[8:11], s36 offen offset:1024 sc1
  s_barrier
  ds_read_b128 v[64:67], v2 offset:4096
  ds_read_b128 v[68:71], v2 offset:5120
  ds_read_b128 v[72:75], v2 offset:6144
  ds_read_b128 v[76:79], v2 offset:7168
  s_waitcnt vmcnt(9)
  v_smfmac_f32_16x16x64_bf16 v[156:159], v[8:11], v[80:87], v3
  s_waitcnt vmcnt(8)
  v_smfmac_f32_16x16x64_bf16 v[156:159], v[12:15], v[88:95], v3
  s_waitcnt vmcnt(7)
  v_smfmac_f32_16x16x64_bf16 v[156:159], v[16:19], v[96:103], v3
  s_waitcnt vmcnt(6)
  v_smfmac_f32_16x16x64_bf16 v[156:159], v[20:23], v[104:111], v3
  s_waitcnt vmcnt(5)
  v_smfmac_f32_16x16x64_bf16 v[156:159], v[24:27], v[112:119], v3
  s_mov_b32 exec_hi, 0
  buffer_store_dword v2, v7, s[8:11], s21 offen sc1
  s_mov_b64 exec, -1
  s_waitcnt vmcnt(5)
  v_smfmac_f32_16x16x64_bf16 v[156:159], v[28:31], v[120:127], v3
  s_waitcnt vmcnt(4)
  v_smfmac_f32_16x16x64_bf16 v[156:159], v[32:35], v[128:135], v3
  s_waitcnt vmcnt(3)
  v_smfmac_f32_16x16x64_bf16 v[156:159], v[144:147], v[136:143], v3
  s_waitcnt vmcnt(2) lgkmcnt(0)
  v_smfmac_f32_16x16x64_bf16 v[156:159], v[148:151], v[64:71], v3
  s_waitcnt vmcnt(1)
  v_smfmac_f32_16x16x64_bf16 v[156:159], v[152:155], v[72:79], v3
cB_va1_ep:
  s_nop 7
  v_permlane32_swap_b32 v156, v158
  v_permlane32_swap_b32 v157, v159
  v_add_f32 v160, v156, v158
  v_add_f32 v161, v157, v159
  v_cmp_u_f32 vcc, v160, v161
  v_mov_b32_dpp v162, v160 row_ror:8 row_mask:0xf bank_mask:0xf
  v_mov_b32_dpp v160, v161 row_ror:8 row_mask:0xf bank_mask:0xc
  s_cbranch_vccnz cB_va1_rp
  v_mov_b32_dpp v161, v162 quad_perm:[0,1,2,3] row_mask:0xf bank_mask:0x3
  v_cvt_pk_bf16_f32 v160, v160, v161
cB_va1_pc:
  s_mov_b64 exec, s[26:27]
  buffer_store_dword v160, v1, s[8:11], s21 offen sc1
  s_cmp_lg_u32 s19, 62
  s_cbranch_scc1 cB_va1_nl
  s_mov_b32 s22, 88519680
  buffer_store_dword v160, v1, s[8:11], s22 offen sc1
  s_mov_b64 exec, -1
  s_branch cB_done
cB_va1_nl:
  s_mov_b64 exec, -1
  s_add_u32 s25, s25, 28672
  s_add_u32 s19, s19, 1
  s_mov_b32 s20, s21
  s_branch cB_va1_loop
cB_va1_last:
  s_waitcnt lgkmcnt(0)
  s_barrier
  s_branch cB_done
cB_va1_rp:
  s_cmp_eq_u32 s37, 0
  s_cbranch_scc1 cB_va1_rv
  v_mov_b32_dpp v161, v162 quad_perm:[0,1,2,3] row_mask:0xf bank_mask:0x3
  v_cvt_pk_bf16_f32 v160, v160, v161
  v_min_u32 v160, -2, v160
  s_branch cB_va1_pc
cB_va1_rv:
  buffer_load_dwordx4 v[8:11], v2, s[8:11], s22 offen offset:0 sc1
  buffer_load_dwordx4 v[12:15], v2, s[8:11], s22 offen offset:1024 sc1
  buffer_load_dwordx4 v[16:19], v2, s[8:11], s22 offen offset:2048 sc1
  buffer_load_dwordx4 v[20:23], v2, s[8:11], s22 offen offset:3072 sc1
  buffer_load_dwordx4 v[24:27], v2, s[8:11], s34 offen offset:0 sc1
  buffer_load_dwordx4 v[28:31], v2, s[8:11], s34 offen offset:1024 sc1
  buffer_load_dwordx4 v[32:35], v2, s[8:11], s34 offen offset:2048 sc1
  buffer_load_dwordx4 v[144:147], v2, s[8:11], s34 offen offset:3072 sc1
  buffer_load_dwordx4 v[148:151], v2, s[8:11], s36 offen offset:0 sc1
  buffer_load_dwordx4 v[152:155], v2, s[8:11], s36 offen offset:1024 sc1
  s_waitcnt vmcnt(0)
  v_max3_u32 v63, v8, v9, v10
  v_max3_u32 v63, v63, v11, v12
  v_max3_u32 v63, v63, v13, v14
  v_max3_u32 v63, v63, v15, v16
  v_max3_u32 v63, v63, v17, v18
  v_max3_u32 v63, v63, v19, v20
  v_max3_u32 v63, v63, v21, v22
  v_max3_u32 v63, v63, v23, v24
  v_max3_u32 v63, v63, v25, v26
  v_max3_u32 v63, v63, v27, v28
  v_max3_u32 v63, v63, v29, v30
  v_max3_u32 v63, v63, v31, v32
  v_max3_u32 v63, v63, v33, v34
  v_max3_u32 v63, v63, v35, v144
  v_max3_u32 v63, v63, v145, v146
  v_max3_u32 v63, v63, v147, v148
  v_max3_u32 v63, v63, v149, v150
  v_max3_u32 v63, v63, v151, v152
  v_max3_u32 v63, v63, v153, v154
  v_max_u32 v63, v63, v155
  v_cmp_eq_u32 vcc, -1, v63
  s_cbranch_vccz cB_va1_rk
  s_add_u32 s30, s30, 1
  s_cmp_lt_u32 s30, 400000
  s_cbranch_scc1 cB_va1_rv
  s_branch cB_abort
cB_va1_rk:
  s_mov_b32 s37, 1
  s_add_u32 s31, s31, 0x10000
  v_mov_b32 v156, 0
  v_mov_b32 v157, 0
  v_mov_b32 v158, 0
  v_mov_b32 v159, 0
  s_nop 1
  v_smfmac_f32_16x16x64_bf16 v[156:159], v[8:11], v[80:87], v3
  v_smfmac_f32_16x16x64_bf16 v[156:159], v[12:15], v[88:95], v3
  v_smfmac_f32_16x16x64_bf16 v[156:159], v[16:19], v[96:103], v3
  v_smfmac_f32_16x16x64_bf16 v[156:159], v[20:23], v[104:111], v3
  v_smfmac_f32_16x16x64_bf16 v[156:159], v[24:27], v[112:119], v3
  v_smfmac_f32_16x16x64_bf16 v[156:159], v[28:31], v[120:127], v3
  v_smfmac_f32_16x16x64_bf16 v[156:159], v[32:35], v[128:135], v3
  v_smfmac_f32_16x16x64_bf16 v[156:159], v[144:147], v[136:143], v3
  v_smfmac_f32_16x16x64_bf16 v[156:159], v[148:151], v[64:71], v3
  v_smfmac_f32_16x16x64_bf16 v[156:159], v[152:155], v[72:79], v3
  s_nop 7
  s_branch cB_va1_ep
.p2align 6

cB_va2_loop:
  s_add_u32 s23, s20, 4096
  s_add_u32 s21, s20, 25600
  v_mov_b32 v36, 0
  v_mov_b32 v37, 0
  v_mov_b32 v38, 0
  v_mov_b32 v39, 0
  v_mov_b32 v40, 0
  v_mov_b32 v41, 0
  v_mov_b32 v42, 0
  v_mov_b32 v43, 0
  v_mov_b32 v44, 0
  v_mov_b32 v45, 0
  v_mov_b32 v46, 0
  v_mov_b32 v47, 0
  v_mov_b32 v48, 0
  v_mov_b32 v49, 0
  v_mov_b32 v50, 0
  v_mov_b32 v51, 0
  v_mov_b32 v52, 0
  v_mov_b32 v53, 0
  v_mov_b32 v54, 0
  v_mov_b32 v55, 0
  v_mov_b32 v56, 0
  v_mov_b32 v57, 0
  v_mov_b32 v58, 0
  v_mov_b32 v59, 0
  v_mov_b32 v60, 0
  v_mov_b32 v61, 0
  v_mov_b32 v62, 0
  v_mov_b32 v63, 0
  v_mov_b32 v64, 0
  v_mov_b32 v65, 0
  v_mov_b32 v66, 0
  v_mov_b32 v67, 0
  s_mov_b32 s30, 0
  buffer_load_dword v76, v119, s[8:11], s20 offen sc1
  buffer_load_dword v77, v119, s[8:11], s20 offen sc1
  buffer_load_dword v78, v119, s[8:11], s20 offen sc1
cB_va2_fp_l:
  s_waitcnt vmcnt(2)
  v_cmp_eq_u32 vcc, -1, v76
  s_cbranch_vccz cB_va2_fp_d
  buffer_load_dword v76, v119, s[8:11], s20 offen sc1
  s_waitcnt vmcnt(2)
  v_cmp_eq_u32 vcc, -1, v77
  s_cbranch_vccz cB_va2_fp_d
  buffer_load_dword v77, v119, s[8:11], s20 offen sc1
  s_waitcnt vmcnt(2)
  v_cmp_eq_u32 vcc, -1, v78
  s_cbranch_vccz cB_va2_fp_d
  buffer_load_dword v78, v119, s[8:11], s20 offen sc1
  s_add_u32 s30, s30, 1
  s_cmp_lt_u32 s30, 400000
  s_cbranch_scc1 cB_va2_fp_l
  s_branch cB_abort
cB_va2_fp_d:
  buffer_load_dwordx4 v[8:11], v2, s[8:11], s20 offen offset:0 sc1
  buffer_load_dwordx4 v[12:15], v2, s[8:11], s20 offen offset:1024 sc1
  buffer_load_dwordx4 v[16:19], v2, s[8:11], s20 offen offset:2048 sc1
  buffer_load_dwordx4 v[20:23], v2, s[8:11], s20 offen offset:3072 sc1
  s_barrier
cB_va2_ld:
  s_waitcnt vmcnt(0)
  v_max3_u32 v84, v8, v9, v10
  v_max3_u32 v84, v84, v11, v12
  v_max3_u32 v84, v84, v13, v14
  v_max3_u32 v84, v84, v15, v16
  v_max3_u32 v84, v84, v17, v18
  v_max3_u32 v84, v84, v19, v20
  v_max3_u32 v84, v84, v21, v22
  v_max_u32 v84, v84, v23
  v_cmp_eq_u32 vcc, -1, v84
  ds_write_b128 v2, v[8:11] offset:8192
  ds_write_b128 v2, v[12:15] offset:9216
  ds_write_b128 v2, v[16:19] offset:10240
  ds_write_b128 v2, v[20:23] offset:11264
  s_cbranch_vccnz cB_va2_retry
  s_waitcnt lgkmcnt(0)
  s_barrier
  ds_read_b128 v[24:27], v2 offset:12288
  ds_read_b128 v[28:31], v2 offset:13312
  ds_read_b128 v[32:35], v2 offset:14336
  ds_read_b128 v[92:95], v0
  s_waitcnt lgkmcnt(0)
  s_mov_b64 exec, s[26:27]
  buffer_store_dwordx4 v[92:95], v2, s[8:11], s36 offen sc1
  s_mov_b64 exec, -1
  s_add_u32 s36, s36, 7168
  s_cmp_eq_u32 s19, 63
  s_cbranch_scc1 cB_done
  ds_read_b128 v[76:79], v1 offset:0
  ds_read_b128 v[80:83], v1 offset:1024
  ds_read_b128 v[84:87], v1 offset:2048
  ds_read_b128 v[88:91], v1 offset:3072
  ds_read_b128 v[92:95], v1 offset:4096
  ds_read_b128 v[96:99], v1 offset:5120
  v_smfmac_f32_16x16x64_bf16 v[60:63], v[8:11], v[200:207], v3
  v_smfmac_f32_16x16x64_bf16 v[60:63], v[12:15], v[208:215], v3
  s_waitcnt lgkmcnt(4)
  v_smfmac_f32_16x16x64_bf16 v[64:67], v[8:11], v[76:83], v3
  ds_read_b128 v[76:79], v1 offset:6144
  ds_read_b128 v[80:83], v1 offset:7168
  v_smfmac_f32_16x16x64_bf16 v[60:63], v[16:19], v[216:223], v3
  v_smfmac_f32_16x16x64_bf16 v[60:63], v[20:23], v[224:231], v3
  s_waitcnt lgkmcnt(4)
  v_smfmac_f32_16x16x64_bf16 v[64:67], v[12:15], v[84:91], v3
  ds_read_b128 v[84:87], v1 offset:8192
  ds_read_b128 v[88:91], v1 offset:9216
  v_smfmac_f32_16x16x64_bf16 v[60:63], v[24:27], v[232:239], v3
  v_smfmac_f32_16x16x64_bf16 v[60:63], v[28:31], v[240:247], v3
  s_waitcnt lgkmcnt(4)
  v_smfmac_f32_16x16x64_bf16 v[64:67], v[16:19], v[92:99], v3
  ds_read_b128 v[92:95], v1 offset:10240
  ds_read_b128 v[96:99], v1 offset:11264
  v_smfmac_f32_16x16x64_bf16 v[60:63], v[32:35], v[248:255], v3
  v_smfmac_f32_16x16x64_bf16 v[36:39], v[8:11], a[0:7], v3
  s_waitcnt lgkmcnt(4)
  v_smfmac_f32_16x16x64_bf16 v[64:67], v[20:23], v[76:83], v3
  ds_read_b128 v[76:79], v1 offset:12288
  ds_read_b128 v[80:83], v1 offset:13312
  v_smfmac_f32_16x16x64_bf16 v[36:39], v[12:15], a[8:15], v3
  v_smfmac_f32_16x16x64_bf16 v[36:39], v[16:19], a[16:23], v3
  s_waitcnt lgkmcnt(4)
  v_smfmac_f32_16x16x64_bf16 v[64:67], v[24:27], v[84:91], v3
  v_smfmac_f32_16x16x64_bf16 v[36:39], v[20:23], a[24:31], v3
  v_smfmac_f32_16x16x64_bf16 v[36:39], v[24:27], a[32:39], v3
  s_waitcnt lgkmcnt(2)
  v_smfmac_f32_16x16x64_bf16 v[64:67], v[28:31], v[92:99], v3
  v_smfmac_f32_16x16x64_bf16 v[36:39], v[28:31], a[40:47], v3
  v_smfmac_f32_16x16x64_bf16 v[36:39], v[32:35], a[48:55], v3
  s_waitcnt lgkmcnt(0)
  v_smfmac_f32_16x16x64_bf16 v[64:67], v[32:35], v[76:83], v3
  v_smfmac_f32_16x16x64_bf16 v[40:43], v[8:11], a[56:63], v3
  v_smfmac_f32_16x16x64_bf16 v[40:43], v[12:15], a[64:71], v3
  v_smfmac_f32_16x16x64_bf16 v[40:43], v[16:19], a[72:79], v3
  v_smfmac_f32_16x16x64_bf16 v[40:43], v[20:23], a[80:87], v3
  v_permlane32_swap_b32 v60, v64
  v_smfmac_f32_16x16x64_bf16 v[40:43], v[24:27], a[88:95], v3
  v_permlane32_swap_b32 v61, v65
  v_smfmac_f32_16x16x64_bf16 v[40:43], v[28:31], a[96:103], v3
  v_permlane32_swap_b32 v62, v66
  v_smfmac_f32_16x16x64_bf16 v[40:43], v[32:35], a[104:111], v3
  v_permlane32_swap_b32 v63, v67
  v_smfmac_f32_16x16x64_bf16 v[44:47], v[8:11], a[112:119], v3
  v_smfmac_f32_16x16x64_bf16 v[44:47], v[12:15], a[120:127], v3
  v_smfmac_f32_16x16x64_bf16 v[44:47], v[16:19], a[128:135], v3
  v_smfmac_f32_16x16x64_bf16 v[44:47], v[20:23], a[136:143], v3
  v_add_f32 v60, v60, v64
  v_add_f32 v61, v61, v65
  v_smfmac_f32_16x16x64_bf16 v[44:47], v[24:27], a[144:151], v3
  v_add_f32 v62, v62, v66
  v_add_f32 v63, v63, v67
  v_smfmac_f32_16x16x64_bf16 v[44:47], v[28:31], a[152:159], v3
  v_cvt_pk_bf16_f32 v64, v60, v61
  v_cvt_pk_bf16_f32 v65, v62, v63
  v_smfmac_f32_16x16x64_bf16 v[44:47], v[32:35], a[160:167], v3
  ds_write_b64 v115, v[64:65]
  v_smfmac_f32_16x16x64_bf16 v[48:51], v[8:11], a[168:175], v3
  v_permlane32_swap_b32 v36, v40
  v_smfmac_f32_16x16x64_bf16 v[48:51], v[12:15], a[176:183], v3
  v_permlane32_swap_b32 v37, v41
  v_smfmac_f32_16x16x64_bf16 v[48:51], v[16:19], a[184:191], v3
  v_permlane32_swap_b32 v38, v42
  v_smfmac_f32_16x16x64_bf16 v[48:51], v[20:23], a[192:199], v3
  v_permlane32_swap_b32 v39, v43
  v_smfmac_f32_16x16x64_bf16 v[48:51], v[24:27], a[200:207], v3
  v_add_f32 v36, v36, v40
  v_smfmac_f32_16x16x64_bf16 v[48:51], v[28:31], a[208:215], v3
  v_add_f32 v37, v37, v41
  v_smfmac_f32_16x16x64_bf16 v[48:51], v[32:35], a[216:223], v3
  v_add_f32 v38, v38, v42
  v_smfmac_f32_16x16x64_bf16 v[52:55], v[8:11], a[224:231], v3
  v_smfmac_f32_16x16x64_bf16 v[52:55], v[12:15], a[232:239], v3
  v_smfmac_f32_16x16x64_bf16 v[52:55], v[16:19], a[240:247], v3
  v_smfmac_f32_16x16x64_bf16 v[52:55], v[20:23], a[248:255], v3
  v_add_f32 v39, v39, v43
  v_cvt_pk_bf16_f32 v40, v36, v37
  v_smfmac_f32_16x16x64_bf16 v[52:55], v[24:27], v[120:127], v3
  v_cvt_pk_bf16_f32 v41, v38, v39
  v_smfmac_f32_16x16x64_bf16 v[52:55], v[28:31], v[128:135], v3
  ds_write_b64 v112, v[40:41]
  v_smfmac_f32_16x16x64_bf16 v[52:55], v[32:35], v[136:143], v3
  v_permlane32_swap_b32 v44, v48
  v_smfmac_f32_16x16x64_bf16 v[56:59], v[8:11], v[144:151], v3
  v_permlane32_swap_b32 v45, v49
  v_smfmac_f32_16x16x64_bf16 v[56:59], v[12:15], v[152:159], v3
  v_permlane32_swap_b32 v46, v50
  v_smfmac_f32_16x16x64_bf16 v[56:59], v[16:19], v[160:167], v3
  v_permlane32_swap_b32 v47, v51
  v_smfmac_f32_16x16x64_bf16 v[56:59], v[20:23], v[168:175], v3
  v_add_f32 v44, v44, v48
  v_smfmac_f32_16x16x64_bf16 v[56:59], v[24:27], v[176:183], v3
  v_add_f32 v45, v45, v49
  v_smfmac_f32_16x16x64_bf16 v[56:59], v[28:31], v[184:191], v3
  v_add_f32 v46, v46, v50
  v_smfmac_f32_16x16x64_bf16 v[56:59], v[32:35], v[192:199], v3
  v_add_f32 v47, v47, v51
  v_cvt_pk_bf16_f32 v48, v44, v45
  v_cvt_pk_bf16_f32 v49, v46, v47
  ds_write_b64 v113, v[48:49]
  s_nop 3
  v_permlane32_swap_b32 v52, v56
  v_permlane32_swap_b32 v53, v57
  v_permlane32_swap_b32 v54, v58
  v_permlane32_swap_b32 v55, v59
  v_add_f32 v52, v52, v56
  v_add_f32 v53, v53, v57
  v_add_f32 v54, v54, v58
  v_add_f32 v55, v55, v59
  v_cvt_pk_bf16_f32 v56, v52, v53
  v_cvt_pk_bf16_f32 v57, v54, v55
  ds_write_b64 v114, v[56:57]
  s_waitcnt lgkmcnt(0)
  s_barrier
  s_cmp_eq_u32 s19, 62
  s_cbranch_scc1 cB_done
  s_waitcnt vmcnt(0) lgkmcnt(0)
  s_add_u32 s19, s19, 1
  s_mov_b32 s20, s21
  s_branch cB_va2_loop
cB_va2_retry:
  s_waitcnt lgkmcnt(0)
  buffer_load_dwordx4 v[8:11], v2, s[8:11], s20 offen offset:0 sc1
  buffer_load_dwordx4 v[12:15], v2, s[8:11], s20 offen offset:1024 sc1
  buffer_load_dwordx4 v[16:19], v2, s[8:11], s20 offen offset:2048 sc1
  buffer_load_dwordx4 v[20:23], v2, s[8:11], s20 offen offset:3072 sc1
  s_add_u32 s31, s31, 1
  s_add_u32 s30, s30, 1
  s_cmp_lt_u32 s30, 400000
  s_cbranch_scc1 cB_va2_ld
  s_branch cB_abort
cB_va2_last:
  s_waitcnt lgkmcnt(0)
  buffer_store_dwordx4 v[100:103], v2, s[8:11], s24 offen offset:0 sc1
  buffer_store_dwordx4 v[104:107], v2, s[8:11], s24 offen offset:1024 sc1
  buffer_store_dwordx4 v[108:111], v2, s[8:11], s24 offen offset:2048 sc1
  buffer_store_dwordx4 v[4:7], v2, s[8:11], s24 offen offset:3072 sc1
  s_add_u32 s24, s24, 8192
  s_waitcnt vmcnt(0)
  s_mov_b64 exec, 1
  buffer_store_dword v117, v2, s[8:11], s34 offen sc1
  s_mov_b64 exec, -1
  s_add_u32 s34, s34, 8
  s_mov_b64 exec, 1
  buffer_store_dword v117, v2, s[8:11], s34 offen sc1
  s_mov_b64 exec, -1
  s_add_u32 s34, s34, 8
  s_branch cB_done
.p2align 6

cB_va3_loop:
  s_add_u32 s23, s20, 4096
  s_add_u32 s21, s20, 25600
  v_mov_b32 v36, 0
  v_mov_b32 v37, 0
  v_mov_b32 v38, 0
  v_mov_b32 v39, 0
  v_mov_b32 v40, 0
  v_mov_b32 v41, 0
  v_mov_b32 v42, 0
  v_mov_b32 v43, 0
  v_mov_b32 v44, 0
  v_mov_b32 v45, 0
  v_mov_b32 v46, 0
  v_mov_b32 v47, 0
  v_mov_b32 v48, 0
  v_mov_b32 v49, 0
  v_mov_b32 v50, 0
  v_mov_b32 v51, 0
  v_mov_b32 v52, 0
  v_mov_b32 v53, 0
  v_mov_b32 v54, 0
  v_mov_b32 v55, 0
  v_mov_b32 v56, 0
  v_mov_b32 v57, 0
  v_mov_b32 v58, 0
  v_mov_b32 v59, 0
  v_mov_b32 v60, 0
  v_mov_b32 v61, 0
  v_mov_b32 v62, 0
  v_mov_b32 v63, 0
  v_mov_b32 v64, 0
  v_mov_b32 v65, 0
  v_mov_b32 v66, 0
  v_mov_b32 v67, 0
  s_mov_b32 s30, 0
  buffer_load_dword v76, v119, s[8:11], s20 offen sc1
  buffer_load_dword v77, v119, s[8:11], s20 offen sc1
  buffer_load_dword v78, v119, s[8:11], s20 offen sc1
cB_va3_fp_l:
  s_waitcnt vmcnt(2)
  v_cmp_eq_u32 vcc, -1, v76
  s_cbranch_vccz cB_va3_fp_d
  buffer_load_dword v76, v119, s[8:11], s20 offen sc1
  s_waitcnt vmcnt(2)
  v_cmp_eq_u32 vcc, -1, v77
  s_cbranch_vccz cB_va3_fp_d
  buffer_load_dword v77, v119, s[8:11], s20 offen sc1
  s_waitcnt vmcnt(2)
  v_cmp_eq_u32 vcc, -1, v78
  s_cbranch_vccz cB_va3_fp_d
  buffer_load_dword v78, v119, s[8:11], s20 offen sc1
  s_add_u32 s30, s30, 1
  s_cmp_lt_u32 s30, 400000
  s_cbranch_scc1 cB_va3_fp_l
  s_branch cB_abort
cB_va3_fp_d:
  buffer_load_dwordx4 v[24:27], v2, s[8:11], s23 offen offset:0 sc1
  buffer_load_dwordx4 v[28:31], v2, s[8:11], s23 offen offset:1024 sc1
  buffer_load_dwordx4 v[32:35], v2, s[8:11], s23 offen offset:2048 sc1
  s_barrier
cB_va3_ld:
  s_waitcnt vmcnt(0)
  v_max3_u32 v84, v24, v25, v26
  v_max3_u32 v84, v84, v27, v28
  v_max3_u32 v84, v84, v29, v30
  v_max3_u32 v84, v84, v31, v32
  v_max3_u32 v84, v84, v33, v34
  v_max_u32 v84, v84, v35
  v_cmp_eq_u32 vcc, -1, v84
  ds_write_b128 v2, v[24:27] offset:12288
  ds_write_b128 v2, v[28:31] offset:13312
  ds_write_b128 v2, v[32:35] offset:14336
  s_cbranch_vccnz cB_va3_retry
  s_waitcnt lgkmcnt(0)
  s_barrier
  ds_read_b128 v[8:11], v2 offset:8192
  ds_read_b128 v[12:15], v2 offset:9216
  ds_read_b128 v[16:19], v2 offset:10240
  ds_read_b128 v[20:23], v2 offset:11264
  s_waitcnt lgkmcnt(0)
  s_cmp_eq_u32 s19, 63
  s_cbranch_scc1 cB_done
  ds_read_b128 v[76:79], v1 offset:0
  ds_read_b128 v[80:83], v1 offset:1024
  ds_read_b128 v[84:87], v1 offset:2048
  ds_read_b128 v[88:91], v1 offset:3072
  ds_read_b128 v[92:95], v1 offset:4096
  ds_read_b128 v[96:99], v1 offset:5120
  v_smfmac_f32_16x16x64_bf16 v[60:63], v[8:11], v[200:207], v3
  v_smfmac_f32_16x16x64_bf16 v[60:63], v[12:15], v[208:215], v3
  s_waitcnt lgkmcnt(4)
  v_smfmac_f32_16x16x64_bf16 v[64:67], v[8:11], v[76:83], v3
  ds_read_b128 v[76:79], v1 offset:6144
  ds_read_b128 v[80:83], v1 offset:7168
  v_smfmac_f32_16x16x64_bf16 v[60:63], v[16:19], v[216:223], v3
  v_smfmac_f32_16x16x64_bf16 v[60:63], v[20:23], v[224:231], v3
  s_waitcnt lgkmcnt(4)
  v_smfmac_f32_16x16x64_bf16 v[64:67], v[12:15], v[84:91], v3
  ds_read_b128 v[84:87], v1 offset:8192
  ds_read_b128 v[88:91], v1 offset:9216
  v_smfmac_f32_16x16x64_bf16 v[60:63], v[24:27], v[232:239], v3
  v_smfmac_f32_16x16x64_bf16 v[60:63], v[28:31], v[240:247], v3
  s_waitcnt lgkmcnt(4)
  v_smfmac_f32_16x16x64_bf16 v[64:67], v[16:19], v[92:99], v3
  ds_read_b128 v[92:95], v1 offset:10240
  ds_read_b128 v[96:99], v1 offset:11264
  v_smfmac_f32_16x16x64_bf16 v[60:63], v[32:35], v[248:255], v3
  v_smfmac_f32_16x16x64_bf16 v[36:39], v[8:11], a[0:7], v3
  s_waitcnt lgkmcnt(4)
  v_smfmac_f32_16x16x64_bf16 v[64:67], v[20:23], v[76:83], v3
  ds_read_b128 v[76:79], v1 offset:12288
  ds_read_b128 v[80:83], v1 offset:13312
  v_smfmac_f32_16x16x64_bf16 v[36:39], v[12:15], a[8:15], v3
  v_smfmac_f32_16x16x64_bf16 v[36:39], v[16:19], a[16:23], v3
  s_waitcnt lgkmcnt(4)
  v_smfmac_f32_16x16x64_bf16 v[64:67], v[24:27], v[84:91], v3
  v_smfmac_f32_16x16x64_bf16 v[36:39], v[20:23], a[24:31], v3
  v_smfmac_f32_16x16x64_bf16 v[36:39], v[24:27], a[32:39], v3
  s_waitcnt lgkmcnt(2)
  v_smfmac_f32_16x16x64_bf16 v[64:67], v[28:31], v[92:99], v3
  v_smfmac_f32_16x16x64_bf16 v[36:39], v[28:31], a[40:47], v3
  v_smfmac_f32_16x16x64_bf16 v[36:39], v[32:35], a[48:55], v3
  s_waitcnt lgkmcnt(0)
  v_smfmac_f32_16x16x64_bf16 v[64:67], v[32:35], v[76:83], v3
  v_smfmac_f32_16x16x64_bf16 v[40:43], v[8:11], a[56:63], v3
  v_smfmac_f32_16x16x64_bf16 v[40:43], v[12:15], a[64:71], v3
  v_smfmac_f32_16x16x64_bf16 v[40:43], v[16:19], a[72:79], v3
  v_smfmac_f32_16x16x64_bf16 v[40:43], v[20:23], a[80:87], v3
  v_permlane32_swap_b32 v60, v64
  v_smfmac_f32_16x16x64_bf16 v[40:43], v[24:27], a[88:95], v3
  v_permlane32_swap_b32 v61, v65
  v_smfmac_f32_16x16x64_bf16 v[40:43], v[28:31], a[96:103], v3
  v_permlane32_swap_b32 v62, v66
  v_smfmac_f32_16x16x64_bf16 v[40:43], v[32:35], a[104:111], v3
  v_permlane32_swap_b32 v63, v67
  v_smfmac_f32_16x16x64_bf16 v[44:47], v[8:11], a[112:119], v3
  v_smfmac_f32_16x16x64_bf16 v[44:47], v[12:15], a[120:127], v3
  v_smfmac_f32_16x16x64_bf16 v[44:47], v[16:19], a[128:135], v3
  v_smfmac_f32_16x16x64_bf16 v[44:47], v[20:23], a[136:143], v3
  v_add_f32 v60, v60, v64
  v_add_f32 v61, v61, v65
  v_smfmac_f32_16x16x64_bf16 v[44:47], v[24:27], a[144:151], v3
  v_add_f32 v62, v62, v66
  v_add_f32 v63, v63, v67
  v_smfmac_f32_16x16x64_bf16 v[44:47], v[28:31], a[152:159], v3
  v_cvt_pk_bf16_f32 v64, v60, v61
  v_cvt_pk_bf16_f32 v65, v62, v63
  v_smfmac_f32_16x16x64_bf16 v[44:47], v[32:35], a[160:167], v3
  ds_write_b64 v115, v[64:65]
  v_smfmac_f32_16x16x64_bf16 v[48:51], v[8:11], a[168:175], v3
  v_permlane32_swap_b32 v36, v40
  v_smfmac_f32_16x16x64_bf16 v[48:51], v[12:15], a[176:183], v3
  v_permlane32_swap_b32 v37, v41
  v_smfmac_f32_16x16x64_bf16 v[48:51], v[16:19], a[184:191], v3
  v_permlane32_swap_b32 v38, v42
  v_smfmac_f32_16x16x64_bf16 v[48:51], v[20:23], a[192:199], v3
  v_permlane32_swap_b32 v39, v43
  v_smfmac_f32_16x16x64_bf16 v[48:51], v[24:27], a[200:207], v3
  v_add_f32 v36, v36, v40
  v_smfmac_f32_16x16x64_bf16 v[48:51], v[28:31], a[208:215], v3
  v_add_f32 v37, v37, v41
  v_smfmac_f32_16x16x64_bf16 v[48:51], v[32:35], a[216:223], v3
  v_add_f32 v38, v38, v42
  v_smfmac_f32_16x16x64_bf16 v[52:55], v[8:11], a[224:231], v3
  v_smfmac_f32_16x16x64_bf16 v[52:55], v[12:15], a[232:239], v3
  v_smfmac_f32_16x16x64_bf16 v[52:55], v[16:19], a[240:247], v3
  v_smfmac_f32_16x16x64_bf16 v[52:55], v[20:23], a[248:255], v3
  v_add_f32 v39, v39, v43
  v_cvt_pk_bf16_f32 v40, v36, v37
  v_smfmac_f32_16x16x64_bf16 v[52:55], v[24:27], v[120:127], v3
  v_cvt_pk_bf16_f32 v41, v38, v39
  v_smfmac_f32_16x16x64_bf16 v[52:55], v[28:31], v[128:135], v3
  ds_write_b64 v112, v[40:41]
  v_smfmac_f32_16x16x64_bf16 v[52:55], v[32:35], v[136:143], v3
  v_permlane32_swap_b32 v44, v48
  v_smfmac_f32_16x16x64_bf16 v[56:59], v[8:11], v[144:151], v3
  v_permlane32_swap_b32 v45, v49
  v_smfmac_f32_16x16x64_bf16 v[56:59], v[12:15], v[152:159], v3
  v_permlane32_swap_b32 v46, v50
  v_smfmac_f32_16x16x64_bf16 v[56:59], v[16:19], v[160:167], v3
  v_permlane32_swap_b32 v47, v51
  v_smfmac_f32_16x16x64_bf16 v[56:59], v[20:23], v[168:175], v3
  v_add_f32 v44, v44, v48
  v_smfmac_f32_16x16x64_bf16 v[56:59], v[24:27], v[176:183], v3
  v_add_f32 v45, v45, v49
  v_smfmac_f32_16x16x64_bf16 v[56:59], v[28:31], v[184:191], v3
  v_add_f32 v46, v46, v50
  v_smfmac_f32_16x16x64_bf16 v[56:59], v[32:35], v[192:199], v3
  v_add_f32 v47, v47, v51
  v_cvt_pk_bf16_f32 v48, v44, v45
  v_cvt_pk_bf16_f32 v49, v46, v47
  ds_write_b64 v113, v[48:49]
  s_nop 3
  v_permlane32_swap_b32 v52, v56
  v_permlane32_swap_b32 v53, v57
  v_permlane32_swap_b32 v54, v58
  v_permlane32_swap_b32 v55, v59
  v_add_f32 v52, v52, v56
  v_add_f32 v53, v53, v57
  v_add_f32 v54, v54, v58
  v_add_f32 v55, v55, v59
  v_cvt_pk_bf16_f32 v56, v52, v53
  v_cvt_pk_bf16_f32 v57, v54, v55
  ds_write_b64 v114, v[56:57]
  s_waitcnt lgkmcnt(0)
  s_barrier
  s_cmp_eq_u32 s19, 62
  s_cbranch_scc1 cB_done
  s_waitcnt vmcnt(0) lgkmcnt(0)
  s_add_u32 s19, s19, 1
  s_mov_b32 s20, s21
  s_branch cB_va3_loop
cB_va3_retry:
  s_waitcnt lgkmcnt(0)
  buffer_load_dwordx4 v[24:27], v2, s[8:11], s23 offen offset:0 sc1
  buffer_load_dwordx4 v[28:31], v2, s[8:11], s23 offen offset:1024 sc1
  buffer_load_dwordx4 v[32:35], v2, s[8:11], s23 offen offset:2048 sc1
  s_add_u32 s31, s31, 1
  s_add_u32 s30, s30, 1
  s_cmp_lt_u32 s30, 400000
  s_cbranch_scc1 cB_va3_ld
  s_branch cB_abort
cB_va3_last:
  s_waitcnt lgkmcnt(0)
  buffer_store_dwordx4 v[100:103], v2, s[8:11], s24 offen offset:0 sc1
  buffer_store_dwordx4 v[104:107], v2, s[8:11], s24 offen offset:1024 sc1
  buffer_store_dwordx4 v[108:111], v2, s[8:11], s24 offen offset:2048 sc1
  buffer_store_dwordx4 v[4:7], v2, s[8:11], s24 offen offset:3072 sc1
  s_add_u32 s24, s24, 8192
  s_waitcnt vmcnt(0)
  s_mov_b64 exec, 1
  buffer_store_dword v117, v2, s[8:11], s34 offen sc1
  s_mov_b64 exec, -1
  s_add_u32 s34, s34, 8
  s_mov_b64 exec, 1
  buffer_store_dword v117, v2, s[8:11], s34 offen sc1
  s_mov_b64 exec, -1
  s_add_u32 s34, s34, 8
  s_branch cB_done
cB_abort:
  v_mov_b32 v4, 0xdead
  v_mov_b32 v5, 16
  buffer_store_dword v4, v5, s[12:15], 0 offen
  s_branch ch_end
cB_done:
  s_branch ch_end
m_reclaim:
  s_waitcnt vmcnt(0)
  s_lshr_b32 s20, s3, 5
  s_cmp_lg_u32 s16, 0
  s_cbranch_scc1 w0_17
  s_mov_b32 s21, 0
  s_mov_b64 exec, 1
rc_l:
  s_cmp_lg_u32 s70, -1
  s_cbranch_scc1 rc_t
  s_add_u32 s20, s20, 1
  s_cmp_lt_u32 s20, 8
  s_cselect_b32 s20, s20, 0
  s_mov_b32 s70, 0
  s_mov_b32 s3, -1
  s_add_u32 s21, s21, 1
  s_cmp_ge_u32 s21, 9
  s_cbranch_scc1 rc_d
rc_t:
  s_ff0_i32_b32 s22, s70
  s_lshl_b32 s23, 1, s22
  s_and_b32 s71, s20, 4
  s_mul_i32 s71, s71, 12
  s_lshl_b32 s3, s20, 2
  s_add_u32 s3, s3, s71
  v_mov_b32 v242, s23
  v_mov_b32 v243, 32
  buffer_atomic_or v242, v243, s[12:15], s3 offen sc0
  s_waitcnt vmcnt(0)
  v_readfirstlane_b32 s70, v242
  s_lshl_b32 s3, s20, 5
  s_add_u32 s3, s3, s22
  s_bitcmp1_b32 s70, s22
  s_cbranch_scc1 rc_l
rc_d:
  s_mov_b64 exec, -1
  v_mov_b32 v242, s3
w0_17:
  v_mov_b32 v250, 160000
  s_add_u32 s101, s101, 1
  s_barrier
  s_mov_b64 exec, 1
  s_cmp_lg_u32 s16, 0
  s_cbranch_scc1 w0_18
  ds_write_b32 v250, v242 offset:0
  s_waitcnt lgkmcnt(0)
  v_mov_b32 v242, s101
  ds_write_b32 v250, v242 offset:16
  s_waitcnt lgkmcnt(0)
w0_18:
  s_mov_b64 exec, -1
  s_barrier
  ds_read_b32 v242, v250 offset:0
  ds_read_b32 v250, v250 offset:16
  s_waitcnt lgkmcnt(0)
  v_readfirstlane_b32 s3, v242
  v_cmp_ne_u32 vcc, s101, v250
  s_cbranch_vccnz ch_end
  s_cmp_lg_u32 s3, -1
  s_cbranch_scc1 m_start
  v_mov_b32 v250, 0
  s_branch wk_ask
m_bjob:
  v_and_b32 v1, 63, v0
  v_lshlrev_b32 v2, 4, v1
  v_lshrrev_b32 v3, 4, v1
  v_and_b32 v4, 15, v1
  s_sub_u32 s18, s3, 32
  s_mul_i32 s17, s18, 4682
  s_lshr_b32 s17, s17, 16
  s_mul_i32 s20, s17, 14
  s_sub_u32 s19, s18, s20
  s_cmp_ge_u32 s19, 7
  s_cselect_b32 s31, 7, 0
  s_sub_u32 s19, s19, s31
  s_mov_b32 s60, s44
  s_and_b32 s61, s45, 0xffff
  s_mov_b32 s62, 3670016
  s_mov_b32 s63, 0x20000
  s_mov_b32 s56, s46
  s_and_b32 s57, s47, 0xffff
  s_mov_b32 s58, 3670016
  s_mov_b32 s59, 0x20000
  s_lshl_b32 s30, s16, 13
  s_mul_i32 s27, s17, 229376
  s_lshl_b32 s29, s19, 7
  s_add_u32 s27, s27, s29
  v_lshrrev_b32 v7, 3, v1
  v_and_b32 v8, 7, v1
  s_lshl_b32 s29, s16, 6
  v_add_u32 v7, s29, v7
  v_mul_u32_u24 v7, 896, v7
  v_lshl_add_u32 v7, v8, 4, v7
  s_add_u32 m0, s30, 0
  s_add_u32 s22, s27, 0
  buffer_load_dwordx4 v7, s[56:59], s22 offen offset:0 lds
  s_add_u32 s22, s27, 6144
  buffer_load_dwordx4 v7, s[56:59], s22 offen offset:1024 lds
  s_add_u32 s22, s27, 12288
  buffer_load_dwordx4 v7, s[56:59], s22 offen offset:2048 lds
  s_add_u32 s22, s27, 18432
  buffer_load_dwordx4 v7, s[56:59], s22 offen offset:3072 lds
  s_add_u32 m0, s30, 4096
  s_add_u32 s22, s27, 28672
  buffer_load_dwordx4 v7, s[56:59], s22 offen offset:0 lds
  s_add_u32 s22, s27, 34816
  buffer_load_dwordx4 v7, s[56:59], s22 offen offset:1024 lds
  s_add_u32 s22, s27, 40960
  buffer_load_dwordx4 v7, s[56:59], s22 offen offset:2048 lds
  s_add_u32 s22, s27, 47104
  buffer_load_dwordx4 v7, s[56:59], s22 offen offset:3072 lds
  v_lshrrev_b32 v5, 5, v1
  v_and_b32 v6, 31, v1
  s_lshl_b32 s25, s16, 15
  s_add_u32 s25, s25, 32768
  s_lshl_b32 s26, s17, 9
  s_add_u32 s28, s19, s16
  s_cmp_ge_u32 s28, 7
  s_cselect_b32 s20, 7, 0
  s_sub_u32 s28, s28, s20
  s_add_u32 s28, s28, s31
  s_add_u32 s29, s19, s16
  s_add_u32 s29, s29, 4
  s_cmp_ge_u32 s29, 7
  s_cselect_b32 s20, 7, 0
  s_sub_u32 s29, s29, s20
  s_add_u32 s29, s29, s31
  s_lshl_b32 s32, s28, 18
  s_add_u32 s32, s32, s26
  s_lshl_b32 s33, s29, 18
  s_add_u32 s33, s33, s26
  v_xor_b32 v8, v6, v5
  v_lshlrev_b32 v8, 4, v8
  v_lshl_add_u32 v8, v5, 13, v8
  v_xor_b32 v12, 0, v8
  v_xor_b32 v13, 32, v8
  v_add_u32 v13, 15360, v13
  v_xor_b32 v14, 0, v8
  v_add_u32 v14, 30720, v14
  v_xor_b32 v15, 32, v8
  v_add_u32 v15, 46080, v15
  s_add_u32 s20, s16, 0
  s_and_b32 s20, s20, 3
  s_mul_i32 s21, s20, 65600
  s_lshl_b32 s20, s20, 12
  s_add_u32 s48, s20, s25
  s_mov_b32 m0, s48
  v_xor_b32 v16, s21, v12
  buffer_load_dwordx4 v16, s[60:63], s32 offen offset:0 lds
  v_xor_b32 v17, s21, v13
  buffer_load_dwordx4 v17, s[60:63], s32 offen offset:1024 lds
  v_xor_b32 v18, s21, v14
  buffer_load_dwordx4 v18, s[60:63], s32 offen offset:2048 lds
  v_xor_b32 v19, s21, v15
  buffer_load_dwordx4 v19, s[60:63], s32 offen offset:3072 lds
  s_add_u32 s20, s16, 1
  s_and_b32 s20, s20, 3
  s_mul_i32 s21, s20, 65600
  s_lshl_b32 s20, s20, 12
  s_add_u32 s49, s20, s25
  s_mov_b32 m0, s49
  v_xor_b32 v20, s21, v12
  buffer_load_dwordx4 v20, s[60:63], s32 offen offset:0 lds
  v_xor_b32 v21, s21, v13
  buffer_load_dwordx4 v21, s[60:63], s32 offen offset:1024 lds
  v_xor_b32 v22, s21, v14
  buffer_load_dwordx4 v22, s[60:63], s32 offen offset:2048 lds
  v_xor_b32 v23, s21, v15
  buffer_load_dwordx4 v23, s[60:63], s32 offen offset:3072 lds
  s_add_u32 s20, s16, 2
  s_and_b32 s20, s20, 3
  s_mul_i32 s21, s20, 65600
  s_lshl_b32 s20, s20, 12
  s_add_u32 s50, s20, s25
  s_mov_b32 m0, s50
  v_xor_b32 v24, s21, v12
  buffer_load_dwordx4 v24, s[60:63], s32 offen offset:0 lds
  v_xor_b32 v25, s21, v13
  buffer_load_dwordx4 v25, s[60:63], s32 offen offset:1024 lds
  v_xor_b32 v26, s21, v14
  buffer_load_dwordx4 v26, s[60:63], s32 offen offset:2048 lds
  v_xor_b32 v27, s21, v15
  buffer_load_dwordx4 v27, s[60:63], s32 offen offset:3072 lds
  s_add_u32 s20, s16, 3
  s_and_b32 s20, s20, 3
  s_mul_i32 s21, s20, 65600
  s_lshl_b32 s20, s20, 12
  s_add_u32 s51, s20, s25
  s_mov_b32 m0, s51
  v_xor_b32 v28, s21, v12
  buffer_load_dwordx4 v28, s[60:63], s32 offen offset:0 lds
  v_xor_b32 v29, s21, v13
  buffer_load_dwordx4 v29, s[60:63], s32 offen offset:1024 lds
  v_xor_b32 v30, s21, v14
  buffer_load_dwordx4 v30, s[60:63], s32 offen offset:2048 lds
  v_xor_b32 v31, s21, v15
  buffer_load_dwordx4 v31, s[60:63], s32 offen offset:3072 lds
  s_cmp_eq_u32 s16, 3
  s_cbranch_scc1 bj_np1
  s_add_u32 m0, s48, 16384
  s_nop 0
  buffer_load_dwordx4 v16, s[60:63], s33 offen offset:0 lds
  buffer_load_dwordx4 v17, s[60:63], s33 offen offset:1024 lds
  buffer_load_dwordx4 v18, s[60:63], s33 offen offset:2048 lds
  buffer_load_dwordx4 v19, s[60:63], s33 offen offset:3072 lds
  s_add_u32 m0, s49, 16384
  s_nop 0
  buffer_load_dwordx4 v20, s[60:63], s33 offen offset:0 lds
  buffer_load_dwordx4 v21, s[60:63], s33 offen offset:1024 lds
  buffer_load_dwordx4 v22, s[60:63], s33 offen offset:2048 lds
  buffer_load_dwordx4 v23, s[60:63], s33 offen offset:3072 lds
  s_add_u32 m0, s50, 16384
  s_nop 0
  buffer_load_dwordx4 v24, s[60:63], s33 offen offset:0 lds
  buffer_load_dwordx4 v25, s[60:63], s33 offen offset:1024 lds
  buffer_load_dwordx4 v26, s[60:63], s33 offen offset:2048 lds
  buffer_load_dwordx4 v27, s[60:63], s33 offen offset:3072 lds
  s_add_u32 m0, s51, 16384
  s_nop 0
  buffer_load_dwordx4 v28, s[60:63], s33 offen offset:0 lds
  buffer_load_dwordx4 v29, s[60:63], s33 offen offset:1024 lds
  buffer_load_dwordx4 v30, s[60:63], s33 offen offset:2048 lds
  buffer_load_dwordx4 v31, s[60:63], s33 offen offset:3072 lds
bj_np1:
  s_mov_b32 s52, s36
  s_and_b32 s53, s37, 0xffff
  s_mov_b32 s54, 1835008
  s_mov_b32 s55, 0x20000
  s_lshl_b32 s20, s18, 8
  v_add_u32 v95, s20, v0
  s_mov_b32 s21, 9586981
  v_mul_hi_u32 v6, v95, s21
  v_mul_u32_u24 v7, 448, v6
  v_sub_u32 v7, v95, v7
  v_lshrrev_b32 v8, 4, v7
  v_and_b32 v7, 15, v7
  v_lshl_add_u32 v9, v6, 4, v7
  v_mul_u32_u24 v9, 896, v9
  v_lshl_add_u32 v9, v8, 5, v9
  buffer_load_dwordx4 v[84:87], v9, s[52:55], 0 offen
  buffer_load_dwordx4 v[88:91], v9, s[52:55], 0 offen offset:16
  v_mul_u32_u24 v6, 14336, v6
  v_lshl_add_u32 v6, v7, 4, v6
  v_lshl_add_u32 v92, v8, 9, v6
  v_lshrrev_b32 v7, 2, v8
  v_lshl_add_u32 v6, v7, 11, v6
  v_and_b32 v7, 3, v8
  v_lshl_add_u32 v93, v7, 8, v6
  s_mov_b32 s72, s38
  s_and_b32 s73, s39, 0xffff
  s_mov_b32 s74, 7168
  s_mov_b32 s75, 0x20000
  v_min_u32 v6, 223, v0
  v_lshrrev_b32 v7, 3, v6
  v_and_b32 v6, 7, v6
  v_mul_u32_u24 v9, 896, v6
  v_lshl_add_u32 v9, v7, 5, v9
  buffer_load_dwordx4 v[36:39], v9, s[72:75], 0 offen
  buffer_load_dwordx4 v[40:43], v9, s[72:75], 0 offen offset:16
  v_lshlrev_b32 v7, 8, v7
  v_lshl_add_u32 v94, v6, 4, v7
  s_cmp_lt_u32 s16, 2
  s_cselect_b32 s20, s40, s42
  s_cselect_b32 s21, s41, s43
  s_mov_b32 s72, s20
  s_and_b32 s73, s21, 0xffff
  s_mov_b32 s74, 3670016
  s_mov_b32 s75, 0x20000
  s_add_u32 s20, s19, s31
  s_lshl_b32 s21, s20, 5
  s_lshl_b32 s22, s16, 4
  s_add_u32 s21, s21, s22
  s_mul_i32 s20, s20, 14
  s_add_u32 s20, s20, 250
  s_cmp_lt_u32 s16, 2
  s_cselect_b32 s20, s21, s20
  s_lshl_b32 s20, s20, 13
  s_add_u32 s20, s20, s26
  v_lshlrev_b32 v6, 13, v4
  v_lshl_add_u32 v6, v3, 7, v6
  buffer_load_dword v51, v6, s[72:75], s20 offen
  s_cmp_lg_u32 s66, 0
  s_cbranch_scc1 bj_ci
  s_cmp_lg_u32 s16, 0
  s_cbranch_scc1 w0_19
  s_lshr_b32 s70, s3, 5
  s_and_b32 s71, s70, 4
  s_mul_i32 s71, s71, 12
  s_lshl_b32 s70, s70, 2
  s_add_u32 s70, s70, s71
  s_lshl_b32 s71, 1, s3
  v_mov_b32 v44, s71
  v_mov_b32 v45, 32
  s_mov_b64 exec, 1
  buffer_atomic_or v44, v45, s[12:15], s70 offen sc0
  buffer_load_dwordx2 v[46:47], v45, s[12:15], 0 offen offset:96 sc1
  s_mov_b64 exec, -1
w0_19:
bj_ci:
  s_lshl_b32 s30, s19, 6
  s_add_u32 s30, s30, 0
  v_add_u32 v8, s30, v4
  v_mul_u32_u24 v10, 2341, v8
  v_lshrrev_b32 v10, 16, v10
  v_mul_u32_u24 v11, 28, v10
  v_sub_u32 v32, v8, v11
  s_mul_i32 s30, s17, 28
  v_add_u32 v32, s30, v32
  v_lshrrev_b32 v33, 4, v32
  v_and_b32 v32, 15, v32
  s_mov_b32 s30, 401408
  v_mul_lo_u32 v10, v10, s30
  v_mul_u32_u24 v33, 14336, v33
  v_add_u32 v10, v10, v33
  v_lshl_add_u32 v10, v3, 8, v10
  v_lshl_add_u32 v10, v32, 4, v10
  v_add_u32 v12, 6422528, v10
  s_lshl_b32 s30, s19, 6
  s_add_u32 s30, s30, 16
  v_add_u32 v8, s30, v4
  v_mul_u32_u24 v10, 2341, v8
  v_lshrrev_b32 v10, 16, v10
  v_mul_u32_u24 v11, 28, v10
  v_sub_u32 v32, v8, v11
  s_mul_i32 s30, s17, 28
  v_add_u32 v32, s30, v32
  v_lshrrev_b32 v33, 4, v32
  v_and_b32 v32, 15, v32
  s_mov_b32 s30, 401408
  v_mul_lo_u32 v10, v10, s30
  v_mul_u32_u24 v33, 14336, v33
  v_add_u32 v10, v10, v33
  v_lshl_add_u32 v10, v3, 8, v10
  v_lshl_add_u32 v10, v32, 4, v10
  v_add_u32 v13, 6422528, v10
  s_lshl_b32 s30, s19, 6
  s_add_u32 s30, s30, 32
  v_add_u32 v8, s30, v4
  v_mul_u32_u24 v10, 2341, v8
  v_lshrrev_b32 v10, 16, v10
  v_mul_u32_u24 v11, 28, v10
  v_sub_u32 v32, v8, v11
  s_mul_i32 s30, s17, 28
  v_add_u32 v32, s30, v32
  v_lshrrev_b32 v33, 4, v32
  v_and_b32 v32, 15, v32
  s_mov_b32 s30, 401408
  v_mul_lo_u32 v10, v10, s30
  v_mul_u32_u24 v33, 14336, v33
  v_add_u32 v10, v10, v33
  v_lshl_add_u32 v10, v3, 8, v10
  v_lshl_add_u32 v10, v32, 4, v10
  v_add_u32 v14, 6422528, v10
  s_lshl_b32 s30, s19, 6
  s_add_u32 s30, s30, 48
  v_add_u32 v8, s30, v4
  v_mul_u32_u24 v10, 2341, v8
  v_lshrrev_b32 v10, 16, v10
  v_mul_u32_u24 v11, 28, v10
  v_sub_u32 v32, v8, v11
  s_mul_i32 s30, s17, 28
  v_add_u32 v32, s30, v32
  v_lshrrev_b32 v33, 4, v32
  v_and_b32 v32, 15, v32
  s_mov_b32 s30, 401408
  v_mul_lo_u32 v10, v10, s30
  v_mul_u32_u24 v33, 14336, v33
  v_add_u32 v10, v10, v33
  v_lshl_add_u32 v10, v3, 8, v10
  v_lshl_add_u32 v10, v32, 4, v10
  v_add_u32 v15, 6422528, v10
  v_lshrrev_b32 v7, 2, v4
  v_lshlrev_b32 v7, 3, v7
  v_and_b32 v8, 3, v4
  v_add_u32 v7, v7, v8
  v_xor_b32 v10, v3, v4
  v_lshlrev_b32 v10, 4, v10
  v_lshl_add_u32 v10, v7, 9, v10
  v_add_u32 v10, s25, v10
  v_xor_b32 v32, 0, v10
  v_xor_b32 v33, 64, v10
  v_xor_b32 v34, 128, v10
  v_xor_b32 v35, 192, v10
  v_lshrrev_b32 v7, 2, v4
  v_lshl_add_u32 v7, v3, 3, v7
  v_lshlrev_b32 v7, 7, v7
  v_and_b32 v8, 3, v4
  v_lshl_add_u32 v7, v8, 3, v7
  s_waitcnt vmcnt(37)
  s_cmp_lg_u32 s16, 3
  s_cbranch_scc1 w3_20
  s_waitcnt vmcnt(21)
w3_20:
  s_barrier
  ds_read_b64_tr_b16 v[128:129], v7 offset:0
  ds_read_b64_tr_b16 v[130:131], v7 offset:512
  ds_read_b64_tr_b16 v[132:133], v7 offset:4096
  ds_read_b64_tr_b16 v[134:135], v7 offset:4608
  ds_read_b64_tr_b16 v[136:137], v7 offset:8192
  ds_read_b64_tr_b16 v[138:139], v7 offset:8704
  ds_read_b64_tr_b16 v[140:141], v7 offset:12288
  ds_read_b64_tr_b16 v[142:143], v7 offset:12800
  s_waitcnt lgkmcnt(6)
  ds_read_b64_tr_b16 v[144:145], v7 offset:16384
  ds_read_b64_tr_b16 v[146:147], v7 offset:16896
  ds_read_b64_tr_b16 v[148:149], v7 offset:20480
  ds_read_b64_tr_b16 v[150:151], v7 offset:20992
  ds_read_b64_tr_b16 v[152:153], v7 offset:24576
  ds_read_b64_tr_b16 v[154:155], v7 offset:25088
  ds_read_b64_tr_b16 v[156:157], v7 offset:28672
  ds_read_b64_tr_b16 v[158:159], v7 offset:29184
  s_waitcnt lgkmcnt(6)
  ds_read_b64_tr_b16 v[160:161], v7 offset:32
  ds_read_b64_tr_b16 v[162:163], v7 offset:544
  ds_read_b64_tr_b16 v[164:165], v7 offset:4128
  ds_read_b64_tr_b16 v[166:167], v7 offset:4640
  ds_read_b64_tr_b16 v[168:169], v7 offset:8224
  ds_read_b64_tr_b16 v[170:171], v7 offset:8736
  ds_read_b64_tr_b16 v[172:173], v7 offset:12320
  ds_read_b64_tr_b16 v[174:175], v7 offset:12832
  s_waitcnt lgkmcnt(6)
  ds_read_b64_tr_b16 v[176:177], v7 offset:16416
  ds_read_b64_tr_b16 v[178:179], v7 offset:16928
  ds_read_b64_tr_b16 v[180:181], v7 offset:20512
  ds_read_b64_tr_b16 v[182:183], v7 offset:21024
  ds_read_b64_tr_b16 v[184:185], v7 offset:24608
  ds_read_b64_tr_b16 v[186:187], v7 offset:25120
  ds_read_b64_tr_b16 v[188:189], v7 offset:28704
  ds_read_b64_tr_b16 v[190:191], v7 offset:29216
  s_waitcnt lgkmcnt(6)
  ds_read_b64_tr_b16 v[192:193], v7 offset:64
  ds_read_b64_tr_b16 v[194:195], v7 offset:576
  ds_read_b64_tr_b16 v[196:197], v7 offset:4160
  ds_read_b64_tr_b16 v[198:199], v7 offset:4672
  ds_read_b64_tr_b16 v[200:201], v7 offset:8256
  ds_read_b64_tr_b16 v[202:203], v7 offset:8768
  ds_read_b64_tr_b16 v[204:205], v7 offset:12352
  ds_read_b64_tr_b16 v[206:207], v7 offset:12864
  s_waitcnt lgkmcnt(6)
  ds_read_b64_tr_b16 v[208:209], v7 offset:16448
  ds_read_b64_tr_b16 v[210:211], v7 offset:16960
  ds_read_b64_tr_b16 v[212:213], v7 offset:20544
  ds_read_b64_tr_b16 v[214:215], v7 offset:21056
  ds_read_b64_tr_b16 v[216:217], v7 offset:24640
  ds_read_b64_tr_b16 v[218:219], v7 offset:25152
  ds_read_b64_tr_b16 v[220:221], v7 offset:28736
  ds_read_b64_tr_b16 v[222:223], v7 offset:29248
  s_waitcnt lgkmcnt(6)
  ds_read_b64_tr_b16 v[224:225], v7 offset:96
  ds_read_b64_tr_b16 v[226:227], v7 offset:608
  ds_read_b64_tr_b16 v[228:229], v7 offset:4192
  ds_read_b64_tr_b16 v[230:231], v7 offset:4704
  ds_read_b64_tr_b16 v[232:233], v7 offset:8288
  ds_read_b64_tr_b16 v[234:235], v7 offset:8800
  ds_read_b64_tr_b16 v[236:237], v7 offset:12384
  ds_read_b64_tr_b16 v[238:239], v7 offset:12896
  s_waitcnt lgkmcnt(6)
  ds_read_b64_tr_b16 v[240:241], v7 offset:16480
  ds_read_b64_tr_b16 v[242:243], v7 offset:16992
  ds_read_b64_tr_b16 v[244:245], v7 offset:20576
  ds_read_b64_tr_b16 v[246:247], v7 offset:21088
  ds_read_b64_tr_b16 v[248:249], v7 offset:24672
  ds_read_b64_tr_b16 v[250:251], v7 offset:25184
  ds_read_b64_tr_b16 v[252:253], v7 offset:28768
  ds_read_b64_tr_b16 v[254:255], v7 offset:29280
  s_waitcnt lgkmcnt(6)
  s_waitcnt vmcnt(21) lgkmcnt(0)
  s_cmp_lg_u32 s16, 3
  s_cbranch_scc1 w3_21
  s_waitcnt vmcnt(5)
w3_21:
  ds_read_b128 v[52:55], v32 offset:0
  ds_read_b128 v[56:59], v33 offset:0
  ds_read_b128 v[60:63], v34 offset:0
  ds_read_b128 v[64:67], v35 offset:0
  s_waitcnt lgkmcnt(3)
  v_mfma_f32_16x16x32_bf16 v[96:99], v[52:55], v[128:131], 0
  v_mfma_f32_16x16x32_bf16 v[100:103], v[52:55], v[160:163], 0
  v_mfma_f32_16x16x32_bf16 v[104:107], v[52:55], v[192:195], 0
  v_mfma_f32_16x16x32_bf16 v[108:111], v[52:55], v[224:227], 0
  ds_read_b128 v[52:55], v32 offset:256
  s_waitcnt lgkmcnt(3)
  v_mfma_f32_16x16x32_bf16 v[96:99], v[56:59], v[132:135], v[96:99]
  v_mfma_f32_16x16x32_bf16 v[100:103], v[56:59], v[164:167], v[100:103]
  v_mfma_f32_16x16x32_bf16 v[104:107], v[56:59], v[196:199], v[104:107]
  v_mfma_f32_16x16x32_bf16 v[108:111], v[56:59], v[228:231], v[108:111]
  ds_read_b128 v[56:59], v33 offset:256
  s_waitcnt lgkmcnt(3)
  v_mfma_f32_16x16x32_bf16 v[96:99], v[60:63], v[136:139], v[96:99]
  v_mfma_f32_16x16x32_bf16 v[100:103], v[60:63], v[168:171], v[100:103]
  v_mfma_f32_16x16x32_bf16 v[104:107], v[60:63], v[200:203], v[104:107]
  v_mfma_f32_16x16x32_bf16 v[108:111], v[60:63], v[232:235], v[108:111]
  ds_read_b128 v[60:63], v34 offset:256
  s_waitcnt lgkmcnt(3)
  v_mfma_f32_16x16x32_bf16 v[96:99], v[64:67], v[140:143], v[96:99]
  v_mfma_f32_16x16x32_bf16 v[100:103], v[64:67], v[172:175], v[100:103]
  v_mfma_f32_16x16x32_bf16 v[104:107], v[64:67], v[204:207], v[104:107]
  v_mfma_f32_16x16x32_bf16 v[108:111], v[64:67], v[236:239], v[108:111]
  ds_read_b128 v[64:67], v35 offset:256
  s_waitcnt lgkmcnt(3)
  v_mfma_f32_16x16x32_bf16 v[96:99], v[52:55], v[144:147], v[96:99]
  v_mfma_f32_16x16x32_bf16 v[100:103], v[52:55], v[176:179], v[100:103]
  v_mfma_f32_16x16x32_bf16 v[104:107], v[52:55], v[208:211], v[104:107]
  v_mfma_f32_16x16x32_bf16 v[108:111], v[52:55], v[240:243], v[108:111]
  ds_read_b128 v[52:55], v32 offset:2048
  s_waitcnt lgkmcnt(3)
  v_mfma_f32_16x16x32_bf16 v[96:99], v[56:59], v[148:151], v[96:99]
  v_mfma_f32_16x16x32_bf16 v[100:103], v[56:59], v[180:183], v[100:103]
  v_mfma_f32_16x16x32_bf16 v[104:107], v[56:59], v[212:215], v[104:107]
  v_mfma_f32_16x16x32_bf16 v[108:111], v[56:59], v[244:247], v[108:111]
  ds_read_b128 v[56:59], v33 offset:2048
  s_waitcnt lgkmcnt(3)
  v_mfma_f32_16x16x32_bf16 v[96:99], v[60:63], v[152:155], v[96:99]
  v_mfma_f32_16x16x32_bf16 v[100:103], v[60:63], v[184:187], v[100:103]
  v_mfma_f32_16x16x32_bf16 v[104:107], v[60:63], v[216:219], v[104:107]
  v_mfma_f32_16x16x32_bf16 v[108:111], v[60:63], v[248:251], v[108:111]
  ds_read_b128 v[60:63], v34 offset:2048
  s_waitcnt lgkmcnt(3)
  v_mfma_f32_16x16x32_bf16 v[96:99], v[64:67], v[156:159], v[96:99]
  v_mfma_f32_16x16x32_bf16 v[100:103], v[64:67], v[188:191], v[100:103]
  v_mfma_f32_16x16x32_bf16 v[104:107], v[64:67], v[220:223], v[104:107]
  v_mfma_f32_16x16x32_bf16 v[108:111], v[64:67], v[252:255], v[108:111]
  ds_read_b128 v[64:67], v35 offset:2048
  s_waitcnt lgkmcnt(3)
  v_mfma_f32_16x16x32_bf16 v[112:115], v[52:55], v[128:131], 0
  v_mfma_f32_16x16x32_bf16 v[116:119], v[52:55], v[160:163], 0
  v_mfma_f32_16x16x32_bf16 v[120:123], v[52:55], v[192:195], 0
  v_mfma_f32_16x16x32_bf16 v[124:127], v[52:55], v[224:227], 0
  ds_read_b128 v[52:55], v32 offset:2304
  s_waitcnt lgkmcnt(3)
  v_mfma_f32_16x16x32_bf16 v[112:115], v[56:59], v[132:135], v[112:115]
  v_mfma_f32_16x16x32_bf16 v[116:119], v[56:59], v[164:167], v[116:119]
  v_mfma_f32_16x16x32_bf16 v[120:123], v[56:59], v[196:199], v[120:123]
  v_mfma_f32_16x16x32_bf16 v[124:127], v[56:59], v[228:231], v[124:127]
  ds_read_b128 v[56:59], v33 offset:2304
  s_waitcnt lgkmcnt(3)
  v_mfma_f32_16x16x32_bf16 v[112:115], v[60:63], v[136:139], v[112:115]
  v_mfma_f32_16x16x32_bf16 v[116:119], v[60:63], v[168:171], v[116:119]
  v_mfma_f32_16x16x32_bf16 v[120:123], v[60:63], v[200:203], v[120:123]
  v_mfma_f32_16x16x32_bf16 v[124:127], v[60:63], v[232:235], v[124:127]
  ds_read_b128 v[60:63], v34 offset:2304
  s_waitcnt lgkmcnt(3)
  v_mfma_f32_16x16x32_bf16 v[112:115], v[64:67], v[140:143], v[112:115]
  v_mfma_f32_16x16x32_bf16 v[116:119], v[64:67], v[172:175], v[116:119]
  v_mfma_f32_16x16x32_bf16 v[120:123], v[64:67], v[204:207], v[120:123]
  v_mfma_f32_16x16x32_bf16 v[124:127], v[64:67], v[236:239], v[124:127]
  ds_read_b128 v[64:67], v35 offset:2304
  s_waitcnt lgkmcnt(3)
  v_mfma_f32_16x16x32_bf16 v[112:115], v[52:55], v[144:147], v[112:115]
  v_mfma_f32_16x16x32_bf16 v[116:119], v[52:55], v[176:179], v[116:119]
  v_mfma_f32_16x16x32_bf16 v[120:123], v[52:55], v[208:211], v[120:123]
  v_mfma_f32_16x16x32_bf16 v[124:127], v[52:55], v[240:243], v[124:127]
  s_waitcnt lgkmcnt(2)
  v_mfma_f32_16x16x32_bf16 v[112:115], v[56:59], v[148:151], v[112:115]
  v_mfma_f32_16x16x32_bf16 v[116:119], v[56:59], v[180:183], v[116:119]
  v_mfma_f32_16x16x32_bf16 v[120:123], v[56:59], v[212:215], v[120:123]
  v_mfma_f32_16x16x32_bf16 v[124:127], v[56:59], v[244:247], v[124:127]
  s_waitcnt lgkmcnt(1)
  v_mfma_f32_16x16x32_bf16 v[112:115], v[60:63], v[152:155], v[112:115]
  v_mfma_f32_16x16x32_bf16 v[116:119], v[60:63], v[184:187], v[116:119]
  v_mfma_f32_16x16x32_bf16 v[120:123], v[60:63], v[216:219], v[120:123]
  v_mfma_f32_16x16x32_bf16 v[124:127], v[60:63], v[248:251], v[124:127]
  s_waitcnt lgkmcnt(0)
  v_mfma_f32_16x16x32_bf16 v[112:115], v[64:67], v[156:159], v[112:115]
  v_mfma_f32_16x16x32_bf16 v[116:119], v[64:67], v[188:191], v[116:119]
  v_mfma_f32_16x16x32_bf16 v[120:123], v[64:67], v[220:223], v[120:123]
  v_mfma_f32_16x16x32_bf16 v[124:127], v[64:67], v[252:255], v[124:127]
  s_cmp_lg_u32 s66, 0
  s_cbranch_scc1 bj_cf
  s_cmp_lg_u32 s16, 0
  s_cbranch_scc1 w0_22
  s_waitcnt vmcnt(0)
  v_readfirstlane_b32 s70, v46
  s_cmp_lg_u32 s70, 0
  s_cbranch_scc1 bj_nz
  v_mov_b32 v45, 128
  v_mov_b32 v46, s88
  v_mov_b32 v47, s89
  v_mov_b32 v48, 0
  v_mov_b32 v49, 0
  s_mov_b64 exec, 1
  buffer_atomic_cmpswap_x2 v[46:49], v45, s[12:15], 0 offen sc0
  s_mov_b64 exec, -1
  s_waitcnt vmcnt(0)
  v_readfirstlane_b32 s70, v46
  s_cmp_lg_u32 s70, 0
  s_cbranch_scc1 bj_nz
  v_mov_b32 v46, s88
  v_mov_b32 v47, s89
bj_nz:
w0_22:
  v_mov_b32 v45, 160000
  s_add_u32 s101, s101, 1
  s_barrier
  s_mov_b64 exec, 1
  s_cmp_lg_u32 s16, 0
  s_cbranch_scc1 w0_23
  ds_write_b32 v45, v44 offset:0
  ds_write_b32 v45, v46 offset:4
  ds_write_b32 v45, v47 offset:8
  s_waitcnt lgkmcnt(0)
  v_mov_b32 v44, s101
  ds_write_b32 v45, v44 offset:16
  s_waitcnt lgkmcnt(0)
w0_23:
  s_mov_b64 exec, -1
  s_barrier
  ds_read_b32 v44, v45 offset:0
  ds_read_b32 v46, v45 offset:4
  ds_read_b32 v47, v45 offset:8
  ds_read_b32 v45, v45 offset:16
  s_waitcnt lgkmcnt(0)
  v_readfirstlane_b32 s70, v44
  v_readfirstlane_b32 s88, v46
  v_readfirstlane_b32 s89, v47
  v_cmp_ne_u32 vcc, s101, v45
  s_cbranch_vccnz ch_end
  s_mov_b32 s66, 1
  s_bitcmp1_b32 s70, s3
  s_cbranch_scc1 m_reclaim
bj_cf:
  s_lshl_b32 s30, s28, 10
  v_cvt_pk_bf16_f32 v68, v96, v97
  v_cvt_pk_bf16_f32 v69, v98, v99
  v_cvt_pk_bf16_f32 v70, v112, v113
  v_cvt_pk_bf16_f32 v71, v114, v115
  buffer_store_dwordx4 v[68:71], v12, s[8:11], s30 offen sc1
  v_cvt_pk_bf16_f32 v72, v100, v101
  v_cvt_pk_bf16_f32 v73, v102, v103
  v_cvt_pk_bf16_f32 v74, v116, v117
  v_cvt_pk_bf16_f32 v75, v118, v119
  buffer_store_dwordx4 v[72:75], v13, s[8:11], s30 offen sc1
  v_cvt_pk_bf16_f32 v76, v104, v105
  v_cvt_pk_bf16_f32 v77, v106, v107
  v_cvt_pk_bf16_f32 v78, v120, v121
  v_cvt_pk_bf16_f32 v79, v122, v123
  buffer_store_dwordx4 v[76:79], v14, s[8:11], s30 offen sc1
  v_cvt_pk_bf16_f32 v80, v108, v109
  v_cvt_pk_bf16_f32 v81, v110, v111
  v_cvt_pk_bf16_f32 v82, v124, v125
  v_cvt_pk_bf16_f32 v83, v126, v127
  buffer_store_dwordx4 v[80:83], v15, s[8:11], s30 offen sc1
  s_cmp_eq_u32 s16, 3
  s_cbranch_scc1 bj_w3
  s_waitcnt vmcnt(9)
  ds_read_b128 v[52:55], v32 offset:16384
  ds_read_b128 v[56:59], v33 offset:16384
  ds_read_b128 v[60:63], v34 offset:16384
  ds_read_b128 v[64:67], v35 offset:16384
  s_waitcnt lgkmcnt(3)
  v_mfma_f32_16x16x32_bf16 v[96:99], v[52:55], v[128:131], 0
  v_mfma_f32_16x16x32_bf16 v[100:103], v[52:55], v[160:163], 0
  v_mfma_f32_16x16x32_bf16 v[104:107], v[52:55], v[192:195], 0
  v_mfma_f32_16x16x32_bf16 v[108:111], v[52:55], v[224:227], 0
  ds_read_b128 v[52:55], v32 offset:16640
  s_waitcnt lgkmcnt(3)
  v_mfma_f32_16x16x32_bf16 v[96:99], v[56:59], v[132:135], v[96:99]
  v_mfma_f32_16x16x32_bf16 v[100:103], v[56:59], v[164:167], v[100:103]
  v_mfma_f32_16x16x32_bf16 v[104:107], v[56:59], v[196:199], v[104:107]
  v_mfma_f32_16x16x32_bf16 v[108:111], v[56:59], v[228:231], v[108:111]
  ds_read_b128 v[56:59], v33 offset:16640
  s_waitcnt lgkmcnt(3)
  v_mfma_f32_16x16x32_bf16 v[96:99], v[60:63], v[136:139], v[96:99]
  v_mfma_f32_16x16x32_bf16 v[100:103], v[60:63], v[168:171], v[100:103]
  v_mfma_f32_16x16x32_bf16 v[104:107], v[60:63], v[200:203], v[104:107]
  v_mfma_f32_16x16x32_bf16 v[108:111], v[60:63], v[232:235], v[108:111]
  ds_read_b128 v[60:63], v34 offset:16640
  s_waitcnt lgkmcnt(3)
  v_mfma_f32_16x16x32_bf16 v[96:99], v[64:67], v[140:143], v[96:99]
  v_mfma_f32_16x16x32_bf16 v[100:103], v[64:67], v[172:175], v[100:103]
  v_mfma_f32_16x16x32_bf16 v[104:107], v[64:67], v[204:207], v[104:107]
  v_mfma_f32_16x16x32_bf16 v[108:111], v[64:67], v[236:239], v[108:111]
  ds_read_b128 v[64:67], v35 offset:16640
  s_waitcnt lgkmcnt(3)
  v_mfma_f32_16x16x32_bf16 v[96:99], v[52:55], v[144:147], v[96:99]
  v_mfma_f32_16x16x32_bf16 v[100:103], v[52:55], v[176:179], v[100:103]
  v_mfma_f32_16x16x32_bf16 v[104:107], v[52:55], v[208:211], v[104:107]
  v_mfma_f32_16x16x32_bf16 v[108:111], v[52:55], v[240:243], v[108:111]
  ds_read_b128 v[52:55], v32 offset:18432
  s_waitcnt lgkmcnt(3)
  v_mfma_f32_16x16x32_bf16 v[96:99], v[56:59], v[148:151], v[96:99]
  v_mfma_f32_16x16x32_bf16 v[100:103], v[56:59], v[180:183], v[100:103]
  v_mfma_f32_16x16x32_bf16 v[104:107], v[56:59], v[212:215], v[104:107]
  v_mfma_f32_16x16x32_bf16 v[108:111], v[56:59], v[244:247], v[108:111]
  ds_read_b128 v[56:59], v33 offset:18432
  s_waitcnt lgkmcnt(3)
  v_mfma_f32_16x16x32_bf16 v[96:99], v[60:63], v[152:155], v[96:99]
  v_mfma_f32_16x16x32_bf16 v[100:103], v[60:63], v[184:187], v[100:103]
  v_mfma_f32_16x16x32_bf16 v[104:107], v[60:63], v[216:219], v[104:107]
  v_mfma_f32_16x16x32_bf16 v[108:111], v[60:63], v[248:251], v[108:111]
  ds_read_b128 v[60:63], v34 offset:18432
  s_waitcnt lgkmcnt(3)
  v_mfma_f32_16x16x32_bf16 v[96:99], v[64:67], v[156:159], v[96:99]
  v_mfma_f32_16x16x32_bf16 v[100:103], v[64:67], v[188:191], v[100:103]
  v_mfma_f32_16x16x32_bf16 v[104:107], v[64:67], v[220:223], v[104:107]
  v_mfma_f32_16x16x32_bf16 v[108:111], v[64:67], v[252:255], v[108:111]
  ds_read_b128 v[64:67], v35 offset:18432
  s_waitcnt lgkmcnt(3)
  v_mfma_f32_16x16x32_bf16 v[112:115], v[52:55], v[128:131], 0
  v_mfma_f32_16x16x32_bf16 v[116:119], v[52:55], v[160:163], 0
  v_mfma_f32_16x16x32_bf16 v[120:123], v[52:55], v[192:195], 0
  v_mfma_f32_16x16x32_bf16 v[124:127], v[52:55], v[224:227], 0
  ds_read_b128 v[52:55], v32 offset:18688
  s_waitcnt lgkmcnt(3)
  v_mfma_f32_16x16x32_bf16 v[112:115], v[56:59], v[132:135], v[112:115]
  v_mfma_f32_16x16x32_bf16 v[116:119], v[56:59], v[164:167], v[116:119]
  v_mfma_f32_16x16x32_bf16 v[120:123], v[56:59], v[196:199], v[120:123]
  v_mfma_f32_16x16x32_bf16 v[124:127], v[56:59], v[228:231], v[124:127]
  ds_read_b128 v[56:59], v33 offset:18688
  s_waitcnt lgkmcnt(3)
  v_mfma_f32_16x16x32_bf16 v[112:115], v[60:63], v[136:139], v[112:115]
  v_mfma_f32_16x16x32_bf16 v[116:119], v[60:63], v[168:171], v[116:119]
  v_mfma_f32_16x16x32_bf16 v[120:123], v[60:63], v[200:203], v[120:123]
  v_mfma_f32_16x16x32_bf16 v[124:127], v[60:63], v[232:235], v[124:127]
  ds_read_b128 v[60:63], v34 offset:18688
  s_waitcnt lgkmcnt(3)
  v_mfma_f32_16x16x32_bf16 v[112:115], v[64:67], v[140:143], v[112:115]
  v_mfma_f32_16x16x32_bf16 v[116:119], v[64:67], v[172:175], v[116:119]
  v_mfma_f32_16x16x32_bf16 v[120:123], v[64:67], v[204:207], v[120:123]
  v_mfma_f32_16x16x32_bf16 v[124:127], v[64:67], v[236:239], v[124:127]
  ds_read_b128 v[64:67], v35 offset:18688
  s_waitcnt lgkmcnt(3)
  v_mfma_f32_16x16x32_bf16 v[112:115], v[52:55], v[144:147], v[112:115]
  v_mfma_f32_16x16x32_bf16 v[116:119], v[52:55], v[176:179], v[116:119]
  v_mfma_f32_16x16x32_bf16 v[120:123], v[52:55], v[208:211], v[120:123]
  v_mfma_f32_16x16x32_bf16 v[124:127], v[52:55], v[240:243], v[124:127]
  s_waitcnt lgkmcnt(2)
  v_mfma_f32_16x16x32_bf16 v[112:115], v[56:59], v[148:151], v[112:115]
  v_mfma_f32_16x16x32_bf16 v[116:119], v[56:59], v[180:183], v[116:119]
  v_mfma_f32_16x16x32_bf16 v[120:123], v[56:59], v[212:215], v[120:123]
  v_mfma_f32_16x16x32_bf16 v[124:127], v[56:59], v[244:247], v[124:127]
  s_waitcnt lgkmcnt(1)
  v_mfma_f32_16x16x32_bf16 v[112:115], v[60:63], v[152:155], v[112:115]
  v_mfma_f32_16x16x32_bf16 v[116:119], v[60:63], v[184:187], v[116:119]
  v_mfma_f32_16x16x32_bf16 v[120:123], v[60:63], v[216:219], v[120:123]
  v_mfma_f32_16x16x32_bf16 v[124:127], v[60:63], v[248:251], v[124:127]
  s_waitcnt lgkmcnt(0)
  v_mfma_f32_16x16x32_bf16 v[112:115], v[64:67], v[156:159], v[112:115]
  v_mfma_f32_16x16x32_bf16 v[116:119], v[64:67], v[188:191], v[116:119]
  v_mfma_f32_16x16x32_bf16 v[120:123], v[64:67], v[220:223], v[120:123]
  v_mfma_f32_16x16x32_bf16 v[124:127], v[64:67], v[252:255], v[124:127]
  s_lshl_b32 s30, s29, 10
  v_cvt_pk_bf16_f32 v68, v96, v97
  v_cvt_pk_bf16_f32 v69, v98, v99
  v_cvt_pk_bf16_f32 v70, v112, v113
  v_cvt_pk_bf16_f32 v71, v114, v115
  buffer_store_dwordx4 v[68:71], v12, s[8:11], s30 offen sc1
  v_cvt_pk_bf16_f32 v72, v100, v101
  v_cvt_pk_bf16_f32 v73, v102, v103
  v_cvt_pk_bf16_f32 v74, v116, v117
  v_cvt_pk_bf16_f32 v75, v118, v119
  buffer_store_dwordx4 v[72:75], v13, s[8:11], s30 offen sc1
  v_cvt_pk_bf16_f32 v76, v104, v105
  v_cvt_pk_bf16_f32 v77, v106, v107
  v_cvt_pk_bf16_f32 v78, v120, v121
  v_cvt_pk_bf16_f32 v79, v122, v123
  buffer_store_dwordx4 v[76:79], v14, s[8:11], s30 offen sc1
  v_cvt_pk_bf16_f32 v80, v108, v109
  v_cvt_pk_bf16_f32 v81, v110, v111
  v_cvt_pk_bf16_f32 v82, v124, v125
  v_cvt_pk_bf16_f32 v83, v126, v127
  buffer_store_dwordx4 v[80:83], v15, s[8:11], s30 offen sc1
bj_w3:
  s_lshl_b32 s77, s19, 8
  s_lshl_b32 s21, s17, 4
  s_add_u32 s77, s77, s21
  s_cmp_lg_u32 s31, 0
  s_cselect_b32 s21, 8, 0
  s_add_u32 s77, s77, s21
  s_add_u32 s77, s77, 88588288
  s_add_u32 s78, s77, 2048
  s_cmp_lt_u32 s19, 3
  s_cbranch_scc1 bj_a1
  s_waitcnt vmcnt(4)
  v_mov_b32 v96, v84
  v_mov_b32 v100, v85
  v_min_u32 v104, -2, v36
  v_min_u32 v108, -2, v37
  v_mov_b32 v97, v86
  v_mov_b32 v101, v87
  v_min_u32 v105, -2, v38
  v_min_u32 v109, -2, v39
  v_mov_b32 v98, v88
  v_mov_b32 v102, v89
  v_min_u32 v106, -2, v40
  v_min_u32 v110, -2, v41
  v_mov_b32 v99, v90
  v_mov_b32 v103, v91
  v_min_u32 v107, -2, v42
  v_min_u32 v111, -2, v43
  s_mov_b32 s20, 71565312
  s_mov_b32 s21, 73400320
  buffer_store_dwordx4 v[84:87], v92, s[8:11], s20 offen sc1
  buffer_store_dwordx4 v[88:91], v92, s[8:11], s20 offen offset:256 sc1
  buffer_store_dwordx4 v[96:99], v93, s[8:11], s21 offen sc1
  buffer_store_dwordx4 v[100:103], v93, s[8:11], s21 offen offset:1024 sc1
  s_cmp_lg_u32 s18, 0
  s_cbranch_scc1 bi_nm
  s_mov_b32 s20, 75235328
  s_mov_b32 s21, 88068096
  buffer_store_dwordx4 v[104:107], v94, s[8:11], s20 offen sc1
  buffer_store_dwordx4 v[108:111], v94, s[8:11], s20 offen offset:128 sc1
  buffer_store_dwordx4 v[104:107], v94, s[8:11], s21 offen sc1
  buffer_store_dwordx4 v[108:111], v94, s[8:11], s21 offen offset:128 sc1
bi_nm:
  s_waitcnt vmcnt(4)
  s_mov_b32 s23, 75235328
  v_add_u32 v6, 448, v95
  v_subrev_u32 v7, 1344, v6
  v_mov_b32 v52, -1
  v_mov_b32 v9, 0
  v_cmp_gt_u32 vcc, 256, v7
  s_nop 1
  v_cndmask_b32 v52, v52, v9, vcc
  v_mov_b32 v53, v52
  v_mov_b32 v54, v52
  v_mov_b32 v55, v52
  v_lshlrev_b32 v8, 4, v6
  v_mov_b32 v9, 0x10000000
  v_cmp_lt_u32 vcc, 105599, v6
  s_nop 1
  v_cndmask_b32 v8, v8, v9, vcc
  buffer_store_dwordx4 v[52:55], v8, s[8:11], s23 offen sc1
  v_add_u32 v6, 57792, v95
  v_subrev_u32 v7, 1344, v6
  v_mov_b32 v56, -1
  v_mov_b32 v9, 0
  v_cmp_gt_u32 vcc, 256, v7
  s_nop 1
  v_cndmask_b32 v56, v56, v9, vcc
  v_mov_b32 v57, v56
  v_mov_b32 v58, v56
  v_mov_b32 v59, v56
  v_lshlrev_b32 v8, 4, v6
  v_mov_b32 v9, 0x10000000
  v_cmp_lt_u32 vcc, 105599, v6
  s_nop 1
  v_cndmask_b32 v8, v8, v9, vcc
  buffer_store_dwordx4 v[56:59], v8, s[8:11], s23 offen sc1
  s_mov_b32 s23, 87945216
  v_add_u32 v6, 448, v95
  v_cmp_gt_u32 vcc, 7680, v95
  s_nop 1
  v_cndmask_b32 v6, v6, v95, vcc
  v_subrev_u32 v7, 36352, v6
  v_mov_b32 v60, -1
  v_mov_b32 v9, 0
  v_cmp_gt_u32 vcc, 1048576, v7
  s_nop 1
  v_cndmask_b32 v60, v60, v9, vcc
  v_mov_b32 v61, v60
  v_mov_b32 v62, v60
  v_mov_b32 v63, v60
  v_lshlrev_b32 v8, 4, v6
  v_mov_b32 v9, 0x10000000
  v_cmp_lt_u32 vcc, 40191, v6
  s_nop 1
  v_cndmask_b32 v8, v8, v9, vcc
  buffer_store_dwordx4 v[60:63], v8, s[8:11], s23 offen sc1
  s_barrier
  s_cmp_lg_u32 s16, 0
  s_cbranch_scc1 pub_24
  v_mul_u32_u24 v26, 2048, v1
  v_mov_b32 v24, s88
  v_mov_b32 v25, s89
  s_mov_b64 exec, 1
  buffer_store_dwordx2 v[24:25], v26, s[8:11], s77 offen sc1
  s_mov_b64 exec, -1
pub_24:
  s_waitcnt vmcnt(0)
  s_barrier
  s_cmp_lg_u32 s16, 0
  s_cbranch_scc1 pub_25
  v_mul_u32_u24 v26, 2048, v1
  v_mov_b32 v24, s88
  v_mov_b32 v25, s89
  s_mov_b64 exec, 511
  buffer_store_dwordx2 v[24:25], v26, s[8:11], s78 offen sc1
  s_mov_b64 exec, -1
pub_25:
  s_branch bj_end
bj_a1:
  s_add_u32 s19, s19, 4
  s_waitcnt vmcnt(4)
  v_mov_b32 v96, v84
  v_mov_b32 v100, v85
  v_min_u32 v104, -2, v36
  v_min_u32 v108, -2, v37
  v_mov_b32 v97, v86
  v_mov_b32 v101, v87
  v_min_u32 v105, -2, v38
  v_min_u32 v109, -2, v39
  v_mov_b32 v98, v88
  v_mov_b32 v102, v89
  v_min_u32 v106, -2, v40
  v_min_u32 v110, -2, v41
  v_mov_b32 v99, v90
  v_mov_b32 v103, v91
  v_min_u32 v107, -2, v42
  v_min_u32 v111, -2, v43
  s_mov_b32 s20, 71565312
  s_mov_b32 s21, 73400320
  buffer_store_dwordx4 v[84:87], v92, s[8:11], s20 offen sc1
  buffer_store_dwordx4 v[88:91], v92, s[8:11], s20 offen offset:256 sc1
  buffer_store_dwordx4 v[96:99], v93, s[8:11], s21 offen sc1
  buffer_store_dwordx4 v[100:103], v93, s[8:11], s21 offen offset:1024 sc1
  s_cmp_lg_u32 s18, 0
  s_cbranch_scc1 bk_nm
  s_mov_b32 s20, 75235328
  s_mov_b32 s21, 88068096
  buffer_store_dwordx4 v[104:107], v94, s[8:11], s20 offen sc1
  buffer_store_dwordx4 v[108:111], v94, s[8:11], s20 offen offset:128 sc1
  buffer_store_dwordx4 v[104:107], v94, s[8:11], s21 offen sc1
  buffer_store_dwordx4 v[108:111], v94, s[8:11], s21 offen offset:128 sc1
bk_nm:
  s_mov_b32 s23, 75235328
  v_add_u32 v6, 448, v95
  v_subrev_u32 v7, 1344, v6
  v_mov_b32 v52, -1
  v_mov_b32 v9, 0
  v_cmp_gt_u32 vcc, 256, v7
  s_nop 1
  v_cndmask_b32 v52, v52, v9, vcc
  v_mov_b32 v53, v52
  v_mov_b32 v54, v52
  v_mov_b32 v55, v52
  v_lshlrev_b32 v8, 4, v6
  v_mov_b32 v9, 0x10000000
  v_cmp_lt_u32 vcc, 105599, v6
  s_nop 1
  v_cndmask_b32 v8, v8, v9, vcc
  buffer_store_dwordx4 v[52:55], v8, s[8:11], s23 offen sc1
  v_add_u32 v6, 57792, v95
  v_subrev_u32 v7, 1344, v6
  v_mov_b32 v56, -1
  v_mov_b32 v9, 0
  v_cmp_gt_u32 vcc, 256, v7
  s_nop 1
  v_cndmask_b32 v56, v56, v9, vcc
  v_mov_b32 v57, v56
  v_mov_b32 v58, v56
  v_mov_b32 v59, v56
  v_lshlrev_b32 v8, 4, v6
  v_mov_b32 v9, 0x10000000
  v_cmp_lt_u32 vcc, 105599, v6
  s_nop 1
  v_cndmask_b32 v8, v8, v9, vcc
  buffer_store_dwordx4 v[56:59], v8, s[8:11], s23 offen sc1
  s_mov_b32 s23, 87945216
  v_add_u32 v6, 448, v95
  v_cmp_gt_u32 vcc, 7680, v95
  s_nop 1
  v_cndmask_b32 v6, v6, v95, vcc
  v_subrev_u32 v7, 36352, v6
  v_mov_b32 v60, -1
  v_mov_b32 v9, 0
  v_cmp_gt_u32 vcc, 1048576, v7
  s_nop 1
  v_cndmask_b32 v60, v60, v9, vcc
  v_mov_b32 v61, v60
  v_mov_b32 v62, v60
  v_mov_b32 v63, v60
  v_lshlrev_b32 v8, 4, v6
  v_mov_b32 v9, 0x10000000
  v_cmp_lt_u32 vcc, 40191, v6
  s_nop 1
  v_cndmask_b32 v8, v8, v9, vcc
  buffer_store_dwordx4 v[60:63], v8, s[8:11], s23 offen sc1
  s_barrier
  s_mov_b32 s60, s40
  s_and_b32 s61, s41, 0xffff
  s_mov_b32 s62, 3670016
  s_mov_b32 s63, 0x20000
  s_mov_b32 s56, s42
  s_and_b32 s57, s43, 0xffff
  s_mov_b32 s58, 3670016
  s_mov_b32 s59, 0x20000
  s_lshl_b32 s30, s16, 13
  s_lshl_b32 s27, s19, 19
  s_lshl_b32 s29, s16, 17
  s_add_u32 s27, s27, s29
  s_lshl_b32 s29, s17, 9
  s_add_u32 s27, s27, s29
  v_lshrrev_b32 v5, 5, v1
  v_and_b32 v6, 31, v1
  v_xor_b32 v6, v6, v5
  v_lshlrev_b32 v6, 4, v6
  v_lshl_add_u32 v6, v5, 13, v6
  s_add_u32 m0, s30, 0
  s_add_u32 s22, s27, 0
  v_xor_b32 v7, 0, v6
  buffer_load_dwordx4 v7, s[56:59], s22 offen offset:0 lds
  s_add_u32 s22, s27, 15360
  v_xor_b32 v7, 32, v6
  buffer_load_dwordx4 v7, s[56:59], s22 offen offset:1024 lds
  s_add_u32 s22, s27, 30720
  v_xor_b32 v7, 64, v6
  buffer_load_dwordx4 v7, s[56:59], s22 offen offset:2048 lds
  s_add_u32 s22, s27, 46080
  v_xor_b32 v7, 96, v6
  buffer_load_dwordx4 v7, s[56:59], s22 offen offset:3072 lds
  s_add_u32 m0, s30, 4096
  s_add_u32 s22, s27, 65536
  v_xor_b32 v7, 128, v6
  buffer_load_dwordx4 v7, s[56:59], s22 offen offset:0 lds
  s_add_u32 s22, s27, 80896
  v_xor_b32 v7, 160, v6
  buffer_load_dwordx4 v7, s[56:59], s22 offen offset:1024 lds
  s_add_u32 s22, s27, 96256
  v_xor_b32 v7, 192, v6
  buffer_load_dwordx4 v7, s[56:59], s22 offen offset:2048 lds
  s_add_u32 s22, s27, 111616
  v_xor_b32 v7, 224, v6
  buffer_load_dwordx4 v7, s[56:59], s22 offen offset:3072 lds
  s_waitcnt vmcnt(8)
  s_barrier
  s_cmp_lg_u32 s16, 0
  s_cbranch_scc1 pub_26
  v_mul_u32_u24 v46, 2048, v1
  v_mov_b32 v44, s88
  v_mov_b32 v45, s89
  s_mov_b64 exec, 1
  buffer_store_dwordx2 v[44:45], v46, s[8:11], s77 offen sc1
  s_mov_b64 exec, -1
pub_26:
  s_cmp_lg_u32 s16, 0
  s_cbranch_scc1 w0_27
  v_mul_u32_u24 v50, 2048, v1
  v_mov_b32 v48, s88
  v_mov_b32 v49, s89
  s_mov_b64 exec, 511
  buffer_store_dwordx2 v[48:49], v50, s[8:11], s78 offen sc1
  s_mov_b64 exec, -1
w0_27:
  v_lshrrev_b32 v5, 5, v1
  v_and_b32 v6, 31, v1
  s_lshl_b32 s25, s16, 15
  s_add_u32 s25, s25, 32768
  s_lshl_b32 s26, s17, 9
  s_add_u32 s28, s19, s16
  s_cmp_ge_u32 s28, 7
  s_cselect_b32 s20, 7, 0
  s_sub_u32 s28, s28, s20
  s_add_u32 s28, s28, s31
  s_add_u32 s29, s19, s16
  s_add_u32 s29, s29, 4
  s_cmp_ge_u32 s29, 7
  s_cselect_b32 s20, 7, 0
  s_sub_u32 s29, s29, s20
  s_add_u32 s29, s29, s31
  s_lshl_b32 s32, s28, 18
  s_add_u32 s32, s32, s26
  s_lshl_b32 s33, s29, 18
  s_add_u32 s33, s33, s26
  v_xor_b32 v8, v6, v5
  v_lshlrev_b32 v8, 4, v8
  v_lshl_add_u32 v8, v5, 13, v8
  v_xor_b32 v12, 0, v8
  v_xor_b32 v13, 32, v8
  v_add_u32 v13, 15360, v13
  v_xor_b32 v14, 0, v8
  v_add_u32 v14, 30720, v14
  v_xor_b32 v15, 32, v8
  v_add_u32 v15, 46080, v15
  s_add_u32 s20, s16, 0
  s_and_b32 s20, s20, 3
  s_mul_i32 s21, s20, 65600
  s_lshl_b32 s20, s20, 12
  s_add_u32 s48, s20, s25
  s_mov_b32 m0, s48
  v_xor_b32 v16, s21, v12
  buffer_load_dwordx4 v16, s[60:63], s32 offen offset:0 lds
  v_xor_b32 v17, s21, v13
  buffer_load_dwordx4 v17, s[60:63], s32 offen offset:1024 lds
  v_xor_b32 v18, s21, v14
  buffer_load_dwordx4 v18, s[60:63], s32 offen offset:2048 lds
  v_xor_b32 v19, s21, v15
  buffer_load_dwordx4 v19, s[60:63], s32 offen offset:3072 lds
  s_add_u32 s20, s16, 1
  s_and_b32 s20, s20, 3
  s_mul_i32 s21, s20, 65600
  s_lshl_b32 s20, s20, 12
  s_add_u32 s49, s20, s25
  s_mov_b32 m0, s49
  v_xor_b32 v20, s21, v12
  buffer_load_dwordx4 v20, s[60:63], s32 offen offset:0 lds
  v_xor_b32 v21, s21, v13
  buffer_load_dwordx4 v21, s[60:63], s32 offen offset:1024 lds
  v_xor_b32 v22, s21, v14
  buffer_load_dwordx4 v22, s[60:63], s32 offen offset:2048 lds
  v_xor_b32 v23, s21, v15
  buffer_load_dwordx4 v23, s[60:63], s32 offen offset:3072 lds
  s_add_u32 s20, s16, 2
  s_and_b32 s20, s20, 3
  s_mul_i32 s21, s20, 65600
  s_lshl_b32 s20, s20, 12
  s_add_u32 s50, s20, s25
  s_mov_b32 m0, s50
  v_xor_b32 v24, s21, v12
  buffer_load_dwordx4 v24, s[60:63], s32 offen offset:0 lds
  v_xor_b32 v25, s21, v13
  buffer_load_dwordx4 v25, s[60:63], s32 offen offset:1024 lds
  v_xor_b32 v26, s21, v14
  buffer_load_dwordx4 v26, s[60:63], s32 offen offset:2048 lds
  v_xor_b32 v27, s21, v15
  buffer_load_dwordx4 v27, s[60:63], s32 offen offset:3072 lds
  s_add_u32 s20, s16, 3
  s_and_b32 s20, s20, 3
  s_mul_i32 s21, s20, 65600
  s_lshl_b32 s20, s20, 12
  s_add_u32 s51, s20, s25
  s_mov_b32 m0, s51
  v_xor_b32 v28, s21, v12
  buffer_load_dwordx4 v28, s[60:63], s32 offen offset:0 lds
  v_xor_b32 v29, s21, v13
  buffer_load_dwordx4 v29, s[60:63], s32 offen offset:1024 lds
  v_xor_b32 v30, s21, v14
  buffer_load_dwordx4 v30, s[60:63], s32 offen offset:2048 lds
  v_xor_b32 v31, s21, v15
  buffer_load_dwordx4 v31, s[60:63], s32 offen offset:3072 lds
  s_cmp_eq_u32 s16, 3
  s_cbranch_scc1 ak_np1
  s_add_u32 m0, s48, 16384
  s_nop 0
  buffer_load_dwordx4 v16, s[60:63], s33 offen offset:0 lds
  buffer_load_dwordx4 v17, s[60:63], s33 offen offset:1024 lds
  buffer_load_dwordx4 v18, s[60:63], s33 offen offset:2048 lds
  buffer_load_dwordx4 v19, s[60:63], s33 offen offset:3072 lds
  s_add_u32 m0, s49, 16384
  s_nop 0
  buffer_load_dwordx4 v20, s[60:63], s33 offen offset:0 lds
  buffer_load_dwordx4 v21, s[60:63], s33 offen offset:1024 lds
  buffer_load_dwordx4 v22, s[60:63], s33 offen offset:2048 lds
  buffer_load_dwordx4 v23, s[60:63], s33 offen offset:3072 lds
  s_add_u32 m0, s50, 16384
  s_nop 0
  buffer_load_dwordx4 v24, s[60:63], s33 offen offset:0 lds
  buffer_load_dwordx4 v25, s[60:63], s33 offen offset:1024 lds
  buffer_load_dwordx4 v26, s[60:63], s33 offen offset:2048 lds
  buffer_load_dwordx4 v27, s[60:63], s33 offen offset:3072 lds
  s_add_u32 m0, s51, 16384
  s_nop 0
  buffer_load_dwordx4 v28, s[60:63], s33 offen offset:0 lds
  buffer_load_dwordx4 v29, s[60:63], s33 offen offset:1024 lds
  buffer_load_dwordx4 v30, s[60:63], s33 offen offset:2048 lds
  buffer_load_dwordx4 v31, s[60:63], s33 offen offset:3072 lds
ak_np1:
  s_mov_b32 s79, 1
  s_branch aj_run
bj_end:
  s_and_b32 s20, s18, 3
  s_lshl_b32 s20, s20, 3
  s_add_u32 s20, s20, 8
  s_cmp_eq_u32 s16, 0
  s_cselect_b32 s20, 0, s20
  s_cmp_ge_u32 s16, 2
  s_cselect_b32 s20, 112, s20
  s_load_dwordx2 s[72:73], s[0:1], s20
  s_lshr_b32 s21, s18, 2
  s_lshl_b32 s21, s21, 12
  s_mov_b32 s74, 229376
  s_lshl_b32 s22, s18, 13
  s_cmp_eq_u32 s16, 0
  s_cselect_b32 s21, s22, s21
  s_cselect_b32 s74, 1835008, s74
  s_lshl_b32 s22, s18, 1
  s_add_u32 s22, s22, s16
  s_sub_u32 s22, s22, 2
  s_lshl_b32 s22, s22, 13
  s_cmp_ge_u32 s16, 2
  s_cselect_b32 s21, s22, s21
  s_cselect_b32 s74, 3670016, s74
  v_lshlrev_b32 v6, 3, v2
  s_cmp_eq_u32 s16, 1
  s_cselect_b32 exec_hi, 0, -1
  s_waitcnt lgkmcnt(0)
  s_and_b32 s73, s73, 0xffff
  s_mov_b32 s75, 0x20000
  buffer_load_dword v7, v6, s[72:75], s21 offen
  s_mov_b64 exec, -1
  s_cmp_lg_u32 s16, 0
  s_cbranch_scc1 w0_28
w0_28:
  s_mov_b32 s3, s68
  s_cmp_lg_u32 s69, 0
  s_cbranch_scc1 wk_have
  v_mov_b32 v250, 0
  s_branch wk_ask
wk_loop:
  s_waitcnt vmcnt(0) lgkmcnt(0)
  s_cmp_eq_u32 s96, 1
  s_cbranch_scc1 wk_ask
  s_mov_b32 s96, 1
  s_cmp_lg_u32 s16, 0
  s_cbranch_scc1 w0_29
  s_mov_b32 s30, 0
  v_mov_b32 v243, 32
sf_l:
  buffer_load_dword v242, v243, s[12:15], 0 offen sc1
  s_waitcnt vmcnt(0)
  v_readfirstlane_b32 s70, v242
  s_cmp_eq_u32 s70, -1
  s_cbranch_scc1 sf_d
  s_sleep 16
  s_add_u32 s30, s30, 1
  s_cmp_lt_u32 s30, 64
  s_cbranch_scc1 sf_l
  s_mov_b32 s20, 0
  s_mov_b32 s21, 0
  s_mov_b64 exec, 1
sf_c_l:
  s_cmp_lg_u32 s70, -1
  s_cbranch_scc1 sf_c_t
  s_add_u32 s20, s20, 1
  s_cmp_lt_u32 s20, 8
  s_cselect_b32 s20, s20, 0
  s_mov_b32 s70, 0
  s_mov_b32 s3, -1
  s_add_u32 s21, s21, 1
  s_cmp_ge_u32 s21, 1
  s_cbranch_scc1 sf_c_d
sf_c_t:
  s_ff0_i32_b32 s22, s70
  s_lshl_b32 s23, 1, s22
  s_and_b32 s71, s20, 4
  s_mul_i32 s71, s71, 12
  s_lshl_b32 s3, s20, 2
  s_add_u32 s3, s3, s71
  v_mov_b32 v242, s23
  v_mov_b32 v243, 32
  buffer_atomic_or v242, v243, s[12:15], s3 offen sc0
  s_waitcnt vmcnt(0)
  v_readfirstlane_b32 s70, v242
  s_lshl_b32 s3, s20, 5
  s_add_u32 s3, s3, s22
  s_bitcmp1_b32 s70, s22
  s_cbranch_scc1 sf_c_l
sf_c_d:
  s_mov_b64 exec, -1
  v_mov_b32 v242, s3
sf_d:
w0_29:
  v_mov_b32 v243, 160000
  s_add_u32 s101, s101, 1
  s_barrier
  s_mov_b64 exec, 1
  s_cmp_lg_u32 s16, 0
  s_cbranch_scc1 w0_30
  ds_write_b32 v243, v242 offset:0
  s_waitcnt lgkmcnt(0)
  v_mov_b32 v242, s101
  ds_write_b32 v243, v242 offset:16
  s_waitcnt lgkmcnt(0)
w0_30:
  s_mov_b64 exec, -1
  s_barrier
  ds_read_b32 v242, v243 offset:0
  ds_read_b32 v243, v243 offset:16
  s_waitcnt lgkmcnt(0)
  v_readfirstlane_b32 s3, v242
  v_cmp_ne_u32 vcc, s101, v243
  s_cbranch_vccnz ch_end
  s_cmp_eq_u32 s3, -1
  s_cbranch_scc1 wk_ask
  s_load_dwordx8 s[36:43], s[0:1], 56
  s_load_dwordx4 s[44:47], s[0:1], 88
  s_getreg_b32 s67, hwreg(HW_REG_XCC_ID)
  s_and_b32 s67, s67, 7
  s_mov_b32 s66, 1
  s_waitcnt lgkmcnt(0)
  s_branch m_start
wk_ask:
  v_readfirstlane_b32 s22, v250
  s_cmp_ge_u32 s22, 1376
  s_cbranch_scc1 wk_next
  s_cmp_lg_u32 s16, 0
  s_cbranch_scc1 w0_31
  v_mov_b32 v250, 1
  v_mov_b32 v251, 192
  s_mov_b64 exec, 1
  buffer_atomic_add v250, v251, s[12:15], 0 offen sc0
  s_mov_b64 exec, -1
w0_31:
wk_next:
  s_waitcnt vmcnt(0)
  v_mov_b32 v6, 160000
  s_add_u32 s101, s101, 1
  s_barrier
  s_mov_b64 exec, 1
  s_cmp_lg_u32 s16, 0
  s_cbranch_scc1 w0_32
  ds_write_b32 v6, v250 offset:0
  s_waitcnt lgkmcnt(0)
  v_mov_b32 v250, s101
  ds_write_b32 v6, v250 offset:16
  s_waitcnt lgkmcnt(0)
w0_32:
  s_mov_b64 exec, -1
  s_barrier
  ds_read_b32 v250, v6 offset:0
  ds_read_b32 v6, v6 offset:16
  s_waitcnt lgkmcnt(0)
  v_readfirstlane_b32 s3, v250
  v_cmp_ne_u32 vcc, s101, v6
  s_cbranch_vccnz ch_end
wk_have:
  s_cmp_ge_u32 s3, 1376
  s_cbranch_scc1 ch_end
  v_mov_b32 v250, 0
  v_mov_b32 v251, 192
  v_and_b32 v1, 63, v0
  v_lshlrev_b32 v2, 4, v1
  v_lshrrev_b32 v3, 4, v1
  v_and_b32 v4, 15, v1
  s_cmp_lg_u32 s97, 0
  s_cbranch_scc1 wk_go
  s_mov_b32 s68, s3
  s_mov_b32 s69, 1
  s_cmp_lg_u32 s16, 0
  s_cbranch_scc1 w0_33
  s_add_u32 s20, s67, 1
  s_lshl_b32 s22, s20, 11
  s_add_u32 s22, s22, 88590336
  v_add_u32 v24, 1024, v2
  v_min_u32 v24, 1776, v24
  s_mov_b32 s30, 0
wk_af:
  buffer_load_dwordx4 v[28:31], v2, s[8:11], s22 offen sc1
  buffer_load_dwordx4 v[32:35], v24, s[8:11], s22 offen sc1
  s_waitcnt vmcnt(0)
  v_cmp_ne_u64 vcc, s[88:89], v[28:29]
  s_cbranch_vccnz wk_af_no
  v_cmp_ne_u64 vcc, s[88:89], v[30:31]
  s_cbranch_vccnz wk_af_no
  v_cmp_ne_u64 vcc, s[88:89], v[32:33]
  s_cbranch_vccnz wk_af_no
  v_cmp_ne_u64 vcc, s[88:89], v[34:35]
  s_cbranch_vccnz wk_af_no
  s_branch wk_af_ok
wk_af_no:
  s_sleep 4
  s_add_u32 s30, s30, 1
  s_and_b32 s20, s30, 63
  s_cbranch_scc1 wk_ns
  s_mov_b32 s20, 1
  s_mov_b32 s70, 0
  s_mov_b32 s21, 0
  s_mov_b64 exec, 1
wk_st_l:
  s_cmp_lg_u32 s70, -1
  s_cbranch_scc1 wk_st_t
  s_add_u32 s20, s20, 1
  s_cmp_lt_u32 s20, 8
  s_cselect_b32 s20, s20, 1
  s_mov_b32 s70, 0
  s_mov_b32 s3, -1
  s_add_u32 s21, s21, 1
  s_cmp_ge_u32 s21, 7
  s_cbranch_scc1 wk_st_d
wk_st_t:
  s_ff0_i32_b32 s22, s70
  s_lshl_b32 s23, 1, s22
  s_and_b32 s71, s20, 4
  s_mul_i32 s71, s71, 12
  s_lshl_b32 s3, s20, 2
  s_add_u32 s3, s3, s71
  v_mov_b32 v242, s23
  v_mov_b32 v243, 32
  buffer_atomic_or v242, v243, s[12:15], s3 offen sc0
  s_waitcnt vmcnt(0)
  v_readfirstlane_b32 s70, v242
  s_lshl_b32 s3, s20, 5
  s_add_u32 s3, s3, s22
  s_bitcmp1_b32 s70, s22
  s_cbranch_scc1 wk_st_l
wk_st_d:
  s_mov_b64 exec, -1
  v_mov_b32 v242, s3
  s_cmp_lg_u32 s3, -1
  s_cbranch_scc1 wk_pd
  s_add_u32 s20, s67, 1
  s_lshl_b32 s22, s20, 11
  s_add_u32 s22, s22, 88590336
wk_ns:
  s_cmp_lt_u32 s30, 50000
  s_cbranch_scc1 wk_af
  s_branch cA_abort
wk_af_ok:
  v_mov_b32 v242, -1
wk_pd:
w0_33:
  v_mov_b32 v243, 160000
  s_add_u32 s101, s101, 1
  s_barrier
  s_mov_b64 exec, 1
  s_cmp_lg_u32 s16, 0
  s_cbranch_scc1 w0_34
  ds_write_b32 v243, v242 offset:0
  s_waitcnt lgkmcnt(0)
  v_mov_b32 v242, s101
  ds_write_b32 v243, v242 offset:16
  s_waitcnt lgkmcnt(0)
w0_34:
  s_mov_b64 exec, -1
  s_barrier
  ds_read_b32 v242, v243 offset:0
  ds_read_b32 v243, v243 offset:16
  s_waitcnt lgkmcnt(0)
  v_readfirstlane_b32 s3, v242
  v_cmp_ne_u32 vcc, s101, v243
  s_cbranch_vccnz ch_end
  s_cmp_lg_u32 s3, -1
  s_cbranch_scc1 m_bjob
  s_mov_b32 s3, s68
  s_mov_b32 s97, 1
wk_go:
  s_cmp_ge_u32 s3, 864
  s_cbranch_scc1 wk_tok
  s_cmp_ge_u32 s3, 752
  s_cbranch_scc1 wk_s4d
  s_cmp_ge_u32 s3, 624
  s_cbranch_scc1 wk_f
  s_cmp_ge_u32 s3, 560
  s_cbranch_scc1 wk_vf
  s_cmp_ge_u32 s3, 496
  s_cbranch_scc1 wk_vh
  s_cmp_ge_u32 s3, 368
  s_cbranch_scc1 wk_a
  s_cmp_ge_u32 s3, 336
  s_cbranch_scc1 wk_srv
  s_cmp_ge_u32 s3, 224
  s_cbranch_scc1 wk_v7
  s_sub_u32 s20, s3, 0
  s_cmp_ge_u32 s20, 112
  s_cselect_b32 s18, 1, 0
  s_cselect_b32 s21, 112, 0
  s_sub_u32 s20, s20, s21
  s_and_b32 s17, s20, 15
  s_add_u32 s17, s17, 16
  s_lshr_b32 s34, s20, 4
  s_lshl_b32 s34, s34, 1
  s_add_u32 s35, s34, 2
  s_lshl_b32 s20, s18, 3
  s_lshl_b32 s21, s16, 1
  s_add_u32 s20, s20, s21
  s_mul_i32 s21, s20, 14336
  s_add_u32 s21, s21, 71565312
  s_add_u32 s22, s21, 0
  buffer_load_dwordx4 a[0:3], v2, s[8:11], s22 offen offset:0 sc1
  buffer_load_dwordx4 a[4:7], v2, s[8:11], s22 offen offset:1024 sc1
  buffer_load_dwordx4 a[8:11], v2, s[8:11], s22 offen offset:2048 sc1
  buffer_load_dwordx4 a[12:15], v2, s[8:11], s22 offen offset:3072 sc1
  s_add_u32 s22, s21, 4096
  buffer_load_dwordx4 a[16:19], v2, s[8:11], s22 offen offset:0 sc1
  buffer_load_dwordx4 a[20:23], v2, s[8:11], s22 offen offset:1024 sc1
  buffer_load_dwordx4 a[24:27], v2, s[8:11], s22 offen offset:2048 sc1
  buffer_load_dwordx4 a[28:31], v2, s[8:11], s22 offen offset:3072 sc1
  s_add_u32 s22, s21, 8192
  buffer_load_dwordx4 a[32:35], v2, s[8:11], s22 offen offset:0 sc1
  buffer_load_dwordx4 a[36:39], v2, s[8:11], s22 offen offset:1024 sc1
  buffer_load_dwordx4 a[40:43], v2, s[8:11], s22 offen offset:2048 sc1
  buffer_load_dwordx4 a[44:47], v2, s[8:11], s22 offen offset:3072 sc1
  s_add_u32 s22, s21, 12288
  buffer_load_dwordx4 a[48:51], v2, s[8:11], s22 offen offset:0 sc1
  buffer_load_dwordx4 a[52:55], v2, s[8:11], s22 offen offset:1024 sc1
  buffer_load_dwordx4 a[56:59], v2, s[8:11], s22 offen offset:2048 sc1
  buffer_load_dwordx4 a[60:63], v2, s[8:11], s22 offen offset:3072 sc1
  s_add_u32 s22, s21, 16384
  buffer_load_dwordx4 a[64:67], v2, s[8:11], s22 offen offset:0 sc1
  buffer_load_dwordx4 a[68:71], v2, s[8:11], s22 offen offset:1024 sc1
  buffer_load_dwordx4 a[72:75], v2, s[8:11], s22 offen offset:2048 sc1
  buffer_load_dwordx4 a[76:79], v2, s[8:11], s22 offen offset:3072 sc1
  s_add_u32 s22, s21, 20480
  buffer_load_dwordx4 a[80:83], v2, s[8:11], s22 offen offset:0 sc1
  buffer_load_dwordx4 a[84:87], v2, s[8:11], s22 offen offset:1024 sc1
  buffer_load_dwordx4 a[88:91], v2, s[8:11], s22 offen offset:2048 sc1
  buffer_load_dwordx4 a[92:95], v2, s[8:11], s22 offen offset:3072 sc1
  s_add_u32 s22, s21, 24576
  buffer_load_dwordx4 a[96:99], v2, s[8:11], s22 offen offset:0 sc1
  buffer_load_dwordx4 a[100:103], v2, s[8:11], s22 offen offset:1024 sc1
  buffer_load_dwordx4 a[104:107], v2, s[8:11], s22 offen offset:2048 sc1
  buffer_load_dwordx4 a[108:111], v2, s[8:11], s22 offen offset:3072 sc1
  s_waitcnt vmcnt(40)
  s_mul_i32 s23, s17, 401408
  s_and_b32 s22, s16, 1
  s_mul_i32 s22, s22, 7168
  s_add_u32 s23, s23, s22
  s_add_u32 s23, s23, 0
  s_lshr_b32 s22, s16, 1
  s_mul_i32 s22, s22, 14336
  s_add_u32 s23, s23, s22
  s_mul_i32 s27, s16, 7168
  s_lshr_b32 s28, s20, 1
wf_vo:
  s_sub_u32 s29, s17, 16
  s_lshl_b32 s29, s29, 6
  s_add_u32 s29, s29, s28
  s_mul_i32 s29, s29, 28672
  s_add_u32 s29, s29, 42205184
  v_mul_u32_u24 v6, 28, v3
  s_mov_b32 s31, 0
  s_lshl_b32 s24, s34, 1
  s_mul_i32 s24, s24, 14336
  s_add_u32 s24, s24, s23
  s_cmp_lt_u32 s34, s35
  s_cselect_b32 s24, s24, 0x10000000
  s_add_u32 m0, s31, s27
  s_nop 0
  buffer_load_dwordx4 v2, s[8:11], s24 offen offset:0 sc1 lds
  buffer_load_dwordx4 v2, s[8:11], s24 offen offset:1024 sc1 lds
  buffer_load_dwordx4 v2, s[8:11], s24 offen offset:2048 sc1 lds
  buffer_load_dwordx4 v2, s[8:11], s24 offen offset:3072 sc1 lds
  s_add_u32 m0, m0, 4096
  s_add_u32 s24, s24, 4096
  buffer_load_dwordx4 v2, s[8:11], s24 offen offset:0 sc1 lds
  buffer_load_dwordx4 v2, s[8:11], s24 offen offset:1024 sc1 lds
  buffer_load_dwordx4 v2, s[8:11], s24 offen offset:2048 sc1 lds
  s_add_u32 s30, s34, 1
  s_mov_b32 s31, 28672
  s_lshl_b32 s24, s30, 1
  s_mul_i32 s24, s24, 14336
  s_add_u32 s24, s24, s23
  s_cmp_lt_u32 s30, s35
  s_cselect_b32 s24, s24, 0x10000000
  s_add_u32 m0, s31, s27
  s_nop 0
  buffer_load_dwordx4 v2, s[8:11], s24 offen offset:0 sc1 lds
  buffer_load_dwordx4 v2, s[8:11], s24 offen offset:1024 sc1 lds
  buffer_load_dwordx4 v2, s[8:11], s24 offen offset:2048 sc1 lds
  buffer_load_dwordx4 v2, s[8:11], s24 offen offset:3072 sc1 lds
  s_add_u32 m0, m0, 4096
  s_add_u32 s24, s24, 4096
  buffer_load_dwordx4 v2, s[8:11], s24 offen offset:0 sc1 lds
  buffer_load_dwordx4 v2, s[8:11], s24 offen offset:1024 sc1 lds
  buffer_load_dwordx4 v2, s[8:11], s24 offen offset:2048 sc1 lds
  s_mov_b32 s19, s34
  s_mov_b32 s32, 0
  s_mov_b32 s33, 57344
  s_waitcnt vmcnt(7)
  s_branch wf_vo_in
wf_vo_loop:
  s_waitcnt vmcnt(9)
wf_vo_in:
  s_barrier
  s_add_u32 s30, s19, 2
  s_lshl_b32 s24, s30, 1
  s_mul_i32 s24, s24, 14336
  s_add_u32 s24, s24, s23
  s_cmp_lt_u32 s30, s35
  s_cselect_b32 s24, s24, 0x10000000
  s_add_u32 m0, s33, s27
  s_nop 0
  buffer_load_dwordx4 v2, s[8:11], s24 offen offset:0 sc1 lds
  buffer_load_dwordx4 v2, s[8:11], s24 offen offset:1024 sc1 lds
  buffer_load_dwordx4 v2, s[8:11], s24 offen offset:2048 sc1 lds
  buffer_load_dwordx4 v2, s[8:11], s24 offen offset:3072 sc1 lds
  s_add_u32 m0, m0, 4096
  s_add_u32 s24, s24, 4096
  buffer_load_dwordx4 v2, s[8:11], s24 offen offset:0 sc1 lds
  buffer_load_dwordx4 v2, s[8:11], s24 offen offset:1024 sc1 lds
  buffer_load_dwordx4 v2, s[8:11], s24 offen offset:2048 sc1 lds
  v_add_u32 v5, s32, v2
  ds_read_b128 v[8:11], v5 offset:0
  ds_read_b128 v[12:15], v5 offset:14336
  ds_read_b128 v[16:19], v5 offset:1024
  ds_read_b128 v[20:23], v5 offset:15360
  ds_read_b128 v[24:27], v5 offset:2048
  ds_read_b128 v[28:31], v5 offset:16384
  ds_read_b128 v[32:35], v5 offset:3072
  s_waitcnt lgkmcnt(6)
  v_mfma_f32_16x16x32_bf16 v[40:43], a[0:3], v[8:11], 0
  v_mfma_f32_16x16x32_bf16 v[44:47], a[56:59], v[8:11], 0
  ds_read_b128 v[36:39], v5 offset:17408
  s_waitcnt lgkmcnt(6)
  v_mfma_f32_16x16x32_bf16 v[56:59], a[0:3], v[12:15], 0
  v_mfma_f32_16x16x32_bf16 v[60:63], a[56:59], v[12:15], 0
  ds_read_b128 v[8:11], v5 offset:4096
  s_waitcnt lgkmcnt(6)
  v_mfma_f32_16x16x32_bf16 v[40:43], a[4:7], v[16:19], v[40:43]
  v_mfma_f32_16x16x32_bf16 v[44:47], a[60:63], v[16:19], v[44:47]
  ds_read_b128 v[12:15], v5 offset:18432
  s_waitcnt lgkmcnt(6)
  v_mfma_f32_16x16x32_bf16 v[56:59], a[4:7], v[20:23], v[56:59]
  v_mfma_f32_16x16x32_bf16 v[60:63], a[60:63], v[20:23], v[60:63]
  ds_read_b128 v[16:19], v5 offset:5120
  s_waitcnt lgkmcnt(6)
  v_mfma_f32_16x16x32_bf16 v[40:43], a[8:11], v[24:27], v[40:43]
  v_mfma_f32_16x16x32_bf16 v[44:47], a[64:67], v[24:27], v[44:47]
  ds_read_b128 v[20:23], v5 offset:19456
  s_waitcnt lgkmcnt(6)
  v_mfma_f32_16x16x32_bf16 v[56:59], a[8:11], v[28:31], v[56:59]
  v_mfma_f32_16x16x32_bf16 v[60:63], a[64:67], v[28:31], v[60:63]
  ds_read_b128 v[24:27], v5 offset:6144
  s_waitcnt lgkmcnt(6)
  v_mfma_f32_16x16x32_bf16 v[40:43], a[12:15], v[32:35], v[40:43]
  v_mfma_f32_16x16x32_bf16 v[44:47], a[68:71], v[32:35], v[44:47]
  ds_read_b128 v[28:31], v5 offset:20480
  s_waitcnt lgkmcnt(6)
  v_mfma_f32_16x16x32_bf16 v[56:59], a[12:15], v[36:39], v[56:59]
  v_mfma_f32_16x16x32_bf16 v[60:63], a[68:71], v[36:39], v[60:63]
  ds_read_b128 v[32:35], v5 offset:7168
  s_waitcnt lgkmcnt(6)
  v_mfma_f32_16x16x32_bf16 v[40:43], a[16:19], v[8:11], v[40:43]
  v_mfma_f32_16x16x32_bf16 v[44:47], a[72:75], v[8:11], v[44:47]
  ds_read_b128 v[36:39], v5 offset:21504
  s_waitcnt lgkmcnt(6)
  v_mfma_f32_16x16x32_bf16 v[56:59], a[16:19], v[12:15], v[56:59]
  v_mfma_f32_16x16x32_bf16 v[60:63], a[72:75], v[12:15], v[60:63]
  ds_read_b128 v[8:11], v5 offset:8192
  s_waitcnt lgkmcnt(6)
  v_mfma_f32_16x16x32_bf16 v[40:43], a[20:23], v[16:19], v[40:43]
  v_mfma_f32_16x16x32_bf16 v[44:47], a[76:79], v[16:19], v[44:47]
  ds_read_b128 v[12:15], v5 offset:22528
  s_waitcnt lgkmcnt(6)
  v_mfma_f32_16x16x32_bf16 v[56:59], a[20:23], v[20:23], v[56:59]
  v_mfma_f32_16x16x32_bf16 v[60:63], a[76:79], v[20:23], v[60:63]
  ds_read_b128 v[16:19], v5 offset:9216
  s_waitcnt lgkmcnt(6)
  v_mfma_f32_16x16x32_bf16 v[40:43], a[24:27], v[24:27], v[40:43]
  v_mfma_f32_16x16x32_bf16 v[44:47], a[80:83], v[24:27], v[44:47]
  ds_read_b128 v[20:23], v5 offset:23552
  s_waitcnt lgkmcnt(6)
  v_mfma_f32_16x16x32_bf16 v[56:59], a[24:27], v[28:31], v[56:59]
  v_mfma_f32_16x16x32_bf16 v[60:63], a[80:83], v[28:31], v[60:63]
  ds_read_b128 v[24:27], v5 offset:10240
  s_waitcnt lgkmcnt(6)
  v_mfma_f32_16x16x32_bf16 v[40:43], a[28:31], v[32:35], v[40:43]
  v_mfma_f32_16x16x32_bf16 v[44:47], a[84:87], v[32:35], v[44:47]
  ds_read_b128 v[28:31], v5 offset:24576
  s_waitcnt lgkmcnt(6)
  v_mfma_f32_16x16x32_bf16 v[56:59], a[28:31], v[36:39], v[56:59]
  v_mfma_f32_16x16x32_bf16 v[60:63], a[84:87], v[36:39], v[60:63]
  ds_read_b128 v[32:35], v5 offset:11264
  s_waitcnt lgkmcnt(6)
  v_mfma_f32_16x16x32_bf16 v[40:43], a[32:35], v[8:11], v[40:43]
  v_mfma_f32_16x16x32_bf16 v[44:47], a[88:91], v[8:11], v[44:47]
  ds_read_b128 v[36:39], v5 offset:25600
  s_waitcnt lgkmcnt(6)
  v_mfma_f32_16x16x32_bf16 v[56:59], a[32:35], v[12:15], v[56:59]
  v_mfma_f32_16x16x32_bf16 v[60:63], a[88:91], v[12:15], v[60:63]
  ds_read_b128 v[8:11], v5 offset:12288
  s_waitcnt lgkmcnt(6)
  v_mfma_f32_16x16x32_bf16 v[40:43], a[36:39], v[16:19], v[40:43]
  v_mfma_f32_16x16x32_bf16 v[44:47], a[92:95], v[16:19], v[44:47]
  ds_read_b128 v[12:15], v5 offset:26624
  s_waitcnt lgkmcnt(6)
  v_mfma_f32_16x16x32_bf16 v[56:59], a[36:39], v[20:23], v[56:59]
  v_mfma_f32_16x16x32_bf16 v[60:63], a[92:95], v[20:23], v[60:63]
  ds_read_b128 v[16:19], v5 offset:13312
  s_waitcnt lgkmcnt(6)
  v_mfma_f32_16x16x32_bf16 v[40:43], a[40:43], v[24:27], v[40:43]
  v_mfma_f32_16x16x32_bf16 v[44:47], a[96:99], v[24:27], v[44:47]
  ds_read_b128 v[20:23], v5 offset:27648
  s_waitcnt lgkmcnt(6)
  v_mfma_f32_16x16x32_bf16 v[56:59], a[40:43], v[28:31], v[56:59]
  v_mfma_f32_16x16x32_bf16 v[60:63], a[96:99], v[28:31], v[60:63]
  s_waitcnt lgkmcnt(5)
  v_mfma_f32_16x16x32_bf16 v[40:43], a[44:47], v[32:35], v[40:43]
  v_mfma_f32_16x16x32_bf16 v[44:47], a[100:103], v[32:35], v[44:47]
  s_waitcnt lgkmcnt(4)
  v_mfma_f32_16x16x32_bf16 v[56:59], a[44:47], v[36:39], v[56:59]
  v_mfma_f32_16x16x32_bf16 v[60:63], a[100:103], v[36:39], v[60:63]
  s_waitcnt lgkmcnt(3)
  v_mfma_f32_16x16x32_bf16 v[40:43], a[48:51], v[8:11], v[40:43]
  v_mfma_f32_16x16x32_bf16 v[44:47], a[104:107], v[8:11], v[44:47]
  s_waitcnt lgkmcnt(2)
  v_mfma_f32_16x16x32_bf16 v[56:59], a[48:51], v[12:15], v[56:59]
  v_mfma_f32_16x16x32_bf16 v[60:63], a[104:107], v[12:15], v[60:63]
  s_waitcnt lgkmcnt(1)
  v_mfma_f32_16x16x32_bf16 v[40:43], a[52:55], v[16:19], v[40:43]
  v_mfma_f32_16x16x32_bf16 v[44:47], a[108:111], v[16:19], v[44:47]
  s_waitcnt lgkmcnt(0)
  v_mfma_f32_16x16x32_bf16 v[56:59], a[52:55], v[20:23], v[56:59]
  v_mfma_f32_16x16x32_bf16 v[60:63], a[108:111], v[20:23], v[60:63]
  s_add_u32 s25, s29, 28672
  s_lshl_b32 s24, s19, 5
  s_add_u32 s24, s24, 0
  v_add_u32 v88, s24, v4
  v_mul_u32_u24 v89, 2341, v88
  v_lshrrev_b32 v89, 16, v89
  v_mul_u32_u24 v89, 84, v89
  v_add3_u32 v88, v88, v89, v6
  v_lshlrev_b32 v90, 4, v88
  v_cvt_pk_bf16_f32 v72, v40, v41
  v_cvt_pk_bf16_f32 v73, v42, v43
  v_cvt_pk_bf16_f32 v74, v44, v45
  v_cvt_pk_bf16_f32 v75, v46, v47
  buffer_store_dwordx4 v[72:75], v90, s[8:11], s29 offen sc1
  s_lshl_b32 s24, s19, 5
  s_add_u32 s24, s24, 16
  v_add_u32 v88, s24, v4
  v_mul_u32_u24 v89, 2341, v88
  v_lshrrev_b32 v89, 16, v89
  v_mul_u32_u24 v89, 84, v89
  v_add3_u32 v88, v88, v89, v6
  v_lshlrev_b32 v91, 4, v88
  v_cvt_pk_bf16_f32 v80, v56, v57
  v_cvt_pk_bf16_f32 v81, v58, v59
  v_cvt_pk_bf16_f32 v82, v60, v61
  v_cvt_pk_bf16_f32 v83, v62, v63
  buffer_store_dwordx4 v[80:83], v91, s[8:11], s29 offen sc1
  s_mov_b32 s33, s32
  s_add_u32 s32, s32, 28672
  s_cmp_eq_u32 s32, 86016
  s_cselect_b32 s32, 0, s32
  s_add_u32 s19, s19, 1
  s_cmp_lt_u32 s19, s35
  s_cbranch_scc1 wf_vo_loop
  s_branch wf_done
wf_done:
  s_lshr_b32 s20, s18, 1
  s_lshl_b32 s20, s20, 4
  s_and_b32 s21, s17, 15
  s_add_u32 s20, s20, s21
  s_lshl_b32 s20, s20, 7
  s_cmp_lt_u32 s17, 16
  s_cselect_b32 s21, 16384, 0
  s_add_u32 s20, s20, s21
  s_add_u32 s20, s20, 88528896
  s_sub_u32 s21, s35, s34
  s_lshr_b32 s21, s21, 1
  v_mov_b32 v5, s21
  v_mov_b32 v6, 0
  s_waitcnt vmcnt(0)
  s_mov_b64 exec, 1
  s_cmp_lg_u32 s18, 0
  s_cbranch_scc1 wf_h1
  v_mov_b32 v7, 2
  s_sub_u32 s21, s20, 2048
  buffer_atomic_add v7, v6, s[8:11], s21 offen
wf_h1:
  buffer_atomic_add v5, v6, s[8:11], s20 offen
  s_mov_b64 exec, -1
  s_branch wk_loop
wk_v7:
  s_sub_u32 s20, s3, 224
  s_mov_b32 s18, 1
  s_and_b32 s17, s20, 15
  s_add_u32 s17, s17, 16
  s_lshr_b32 s34, s20, 4
  s_lshl_b32 s34, s34, 1
  s_add_u32 s35, s34, 2
  s_branch wk_gemm
wk_vh:
  s_sub_u32 s20, s3, 496
  s_and_b32 s17, s20, 15
  s_add_u32 s17, s17, 16
  s_lshr_b32 s18, s20, 5
  s_add_u32 s18, s18, 2
  s_bitcmp1_b32 s20, 4
  s_cselect_b32 s34, 7, 0
  s_add_u32 s35, s34, 7
  s_branch wk_gemm
wk_vf:
  s_sub_u32 s20, s3, 560
  s_and_b32 s17, s20, 15
  s_add_u32 s17, s17, 16
  s_lshr_b32 s18, s20, 4
  s_add_u32 s18, s18, 4
  s_mov_b32 s34, 0
  s_mov_b32 s35, 14
  s_branch wk_gemm
wk_f:
  s_sub_u32 s20, s3, 624
  s_and_b32 s17, s20, 15
  s_lshr_b32 s18, s20, 4
  s_mov_b32 s34, 0
  s_mov_b32 s35, 14
  s_lshl_b32 s22, s17, 7
  s_add_u32 s22, s22, 88621056
  v_min_u32 v24, 96, v2
  s_mov_b32 s30, 0
wk_aw:
  buffer_load_dwordx4 v[28:31], v24, s[8:11], s22 offen sc1
  s_waitcnt vmcnt(0)
  v_cmp_ne_u64 vcc, s[88:89], v[28:29]
  s_cbranch_vccnz wk_aw_no
  v_cmp_ne_u64 vcc, s[88:89], v[30:31]
  s_cbranch_vccnz wk_aw_no
  s_branch wk_aw_ok
wk_aw_no:
  s_sleep 6
  s_add_u32 s30, s30, 1
  s_cmp_lt_u32 s30, 50000
  s_cbranch_scc1 wk_aw
  s_branch cA_abort
wk_aw_ok:
wk_gemm:
  s_lshl_b32 s20, s18, 4
  s_lshl_b32 s21, s16, 2
  s_add_u32 s20, s20, s21
  s_mul_i32 s21, s20, 14336
  s_add_u32 s21, s21, 71565312
  s_add_u32 s22, s21, 0
  buffer_load_dwordx4 a[0:3], v2, s[8:11], s22 offen offset:0 sc1
  buffer_load_dwordx4 a[4:7], v2, s[8:11], s22 offen offset:1024 sc1
  buffer_load_dwordx4 a[8:11], v2, s[8:11], s22 offen offset:2048 sc1
  buffer_load_dwordx4 a[12:15], v2, s[8:11], s22 offen offset:3072 sc1
  s_add_u32 s22, s21, 4096
  buffer_load_dwordx4 a[16:19], v2, s[8:11], s22 offen offset:0 sc1
  buffer_load_dwordx4 a[20:23], v2, s[8:11], s22 offen offset:1024 sc1
  buffer_load_dwordx4 a[24:27], v2, s[8:11], s22 offen offset:2048 sc1
  buffer_load_dwordx4 a[28:31], v2, s[8:11], s22 offen offset:3072 sc1
  s_add_u32 s22, s21, 8192
  buffer_load_dwordx4 a[32:35], v2, s[8:11], s22 offen offset:0 sc1
  buffer_load_dwordx4 a[36:39], v2, s[8:11], s22 offen offset:1024 sc1
  buffer_load_dwordx4 a[40:43], v2, s[8:11], s22 offen offset:2048 sc1
  buffer_load_dwordx4 a[44:47], v2, s[8:11], s22 offen offset:3072 sc1
  s_add_u32 s22, s21, 12288
  buffer_load_dwordx4 a[48:51], v2, s[8:11], s22 offen offset:0 sc1
  buffer_load_dwordx4 a[52:55], v2, s[8:11], s22 offen offset:1024 sc1
  buffer_load_dwordx4 a[56:59], v2, s[8:11], s22 offen offset:2048 sc1
  buffer_load_dwordx4 a[60:63], v2, s[8:11], s22 offen offset:3072 sc1
  s_add_u32 s22, s21, 16384
  buffer_load_dwordx4 a[64:67], v2, s[8:11], s22 offen offset:0 sc1
  buffer_load_dwordx4 a[68:71], v2, s[8:11], s22 offen offset:1024 sc1
  buffer_load_dwordx4 a[72:75], v2, s[8:11], s22 offen offset:2048 sc1
  buffer_load_dwordx4 a[76:79], v2, s[8:11], s22 offen offset:3072 sc1
  s_add_u32 s22, s21, 20480
  buffer_load_dwordx4 a[80:83], v2, s[8:11], s22 offen offset:0 sc1
  buffer_load_dwordx4 a[84:87], v2, s[8:11], s22 offen offset:1024 sc1
  buffer_load_dwordx4 a[88:91], v2, s[8:11], s22 offen offset:2048 sc1
  buffer_load_dwordx4 a[92:95], v2, s[8:11], s22 offen offset:3072 sc1
  s_add_u32 s22, s21, 24576
  buffer_load_dwordx4 a[96:99], v2, s[8:11], s22 offen offset:0 sc1
  buffer_load_dwordx4 a[100:103], v2, s[8:11], s22 offen offset:1024 sc1
  buffer_load_dwordx4 a[104:107], v2, s[8:11], s22 offen offset:2048 sc1
  buffer_load_dwordx4 a[108:111], v2, s[8:11], s22 offen offset:3072 sc1
  s_add_u32 s22, s21, 28672
  buffer_load_dwordx4 a[112:115], v2, s[8:11], s22 offen offset:0 sc1
  buffer_load_dwordx4 a[116:119], v2, s[8:11], s22 offen offset:1024 sc1
  buffer_load_dwordx4 a[120:123], v2, s[8:11], s22 offen offset:2048 sc1
  buffer_load_dwordx4 a[124:127], v2, s[8:11], s22 offen offset:3072 sc1
  s_add_u32 s22, s21, 32768
  buffer_load_dwordx4 a[128:131], v2, s[8:11], s22 offen offset:0 sc1
  buffer_load_dwordx4 a[132:135], v2, s[8:11], s22 offen offset:1024 sc1
  buffer_load_dwordx4 a[136:139], v2, s[8:11], s22 offen offset:2048 sc1
  buffer_load_dwordx4 a[140:143], v2, s[8:11], s22 offen offset:3072 sc1
  s_add_u32 s22, s21, 36864
  buffer_load_dwordx4 a[144:147], v2, s[8:11], s22 offen offset:0 sc1
  buffer_load_dwordx4 a[148:151], v2, s[8:11], s22 offen offset:1024 sc1
  buffer_load_dwordx4 a[152:155], v2, s[8:11], s22 offen offset:2048 sc1
  buffer_load_dwordx4 a[156:159], v2, s[8:11], s22 offen offset:3072 sc1
  s_add_u32 s22, s21, 40960
  buffer_load_dwordx4 a[160:163], v2, s[8:11], s22 offen offset:0 sc1
  buffer_load_dwordx4 a[164:167], v2, s[8:11], s22 offen offset:1024 sc1
  buffer_load_dwordx4 a[168:171], v2, s[8:11], s22 offen offset:2048 sc1
  buffer_load_dwordx4 a[172:175], v2, s[8:11], s22 offen offset:3072 sc1
  s_add_u32 s22, s21, 45056
  buffer_load_dwordx4 a[176:179], v2, s[8:11], s22 offen offset:0 sc1
  buffer_load_dwordx4 a[180:183], v2, s[8:11], s22 offen offset:1024 sc1
  buffer_load_dwordx4 a[184:187], v2, s[8:11], s22 offen offset:2048 sc1
  buffer_load_dwordx4 a[188:191], v2, s[8:11], s22 offen offset:3072 sc1
  s_add_u32 s22, s21, 49152
  buffer_load_dwordx4 a[192:195], v2, s[8:11], s22 offen offset:0 sc1
  buffer_load_dwordx4 a[196:199], v2, s[8:11], s22 offen offset:1024 sc1
  buffer_load_dwordx4 a[200:203], v2, s[8:11], s22 offen offset:2048 sc1
  buffer_load_dwordx4 a[204:207], v2, s[8:11], s22 offen offset:3072 sc1
  s_add_u32 s22, s21, 53248
  buffer_load_dwordx4 a[208:211], v2, s[8:11], s22 offen offset:0 sc1
  buffer_load_dwordx4 a[212:215], v2, s[8:11], s22 offen offset:1024 sc1
  buffer_load_dwordx4 a[216:219], v2, s[8:11], s22 offen offset:2048 sc1
  buffer_load_dwordx4 a[220:223], v2, s[8:11], s22 offen offset:3072 sc1
  s_waitcnt vmcnt(40)
  s_mul_i32 s23, s17, 401408
  s_and_b32 s22, s16, 1
  s_mul_i32 s22, s22, 7168
  s_add_u32 s23, s23, s22
  s_add_u32 s23, s23, 0
  s_lshr_b32 s22, s16, 1
  s_mul_i32 s22, s22, 14336
  s_add_u32 s23, s23, s22
  s_mul_i32 s27, s16, 7168
  s_lshr_b32 s28, s20, 1
  s_cmp_lt_u32 s17, 16
  s_cbranch_scc0 wg_vo
  s_add_u32 s23, s23, s22
  s_lshl_b32 s29, s28, 4
  s_add_u32 s29, s29, s17
  s_mul_i32 s29, s29, 28672
  s_add_u32 s29, s29, 12845056
  s_mov_b32 s31, 0
  s_lshr_b32 s24, s34, 1
  s_lshl_b32 s24, s24, 2
  s_and_b32 s25, s34, 1
  s_add_u32 s24, s24, s25
  s_mul_i32 s24, s24, 14336
  s_add_u32 s24, s24, s23
  s_cmp_lt_u32 s34, s35
  s_cselect_b32 s24, s24, 0x10000000
  s_add_u32 m0, s31, s27
  s_nop 0
  buffer_load_dwordx4 v2, s[8:11], s24 offen offset:0 sc1 lds
  buffer_load_dwordx4 v2, s[8:11], s24 offen offset:1024 sc1 lds
  buffer_load_dwordx4 v2, s[8:11], s24 offen offset:2048 sc1 lds
  buffer_load_dwordx4 v2, s[8:11], s24 offen offset:3072 sc1 lds
  s_add_u32 m0, m0, 4096
  s_add_u32 s24, s24, 4096
  buffer_load_dwordx4 v2, s[8:11], s24 offen offset:0 sc1 lds
  buffer_load_dwordx4 v2, s[8:11], s24 offen offset:1024 sc1 lds
  buffer_load_dwordx4 v2, s[8:11], s24 offen offset:2048 sc1 lds
  s_add_u32 s30, s34, 1
  s_mov_b32 s31, 28672
  s_lshr_b32 s24, s30, 1
  s_lshl_b32 s24, s24, 2
  s_and_b32 s25, s30, 1
  s_add_u32 s24, s24, s25
  s_mul_i32 s24, s24, 14336
  s_add_u32 s24, s24, s23
  s_cmp_lt_u32 s30, s35
  s_cselect_b32 s24, s24, 0x10000000
  s_add_u32 m0, s31, s27
  s_nop 0
  buffer_load_dwordx4 v2, s[8:11], s24 offen offset:0 sc1 lds
  buffer_load_dwordx4 v2, s[8:11], s24 offen offset:1024 sc1 lds
  buffer_load_dwordx4 v2, s[8:11], s24 offen offset:2048 sc1 lds
  buffer_load_dwordx4 v2, s[8:11], s24 offen offset:3072 sc1 lds
  s_add_u32 m0, m0, 4096
  s_add_u32 s24, s24, 4096
  buffer_load_dwordx4 v2, s[8:11], s24 offen offset:0 sc1 lds
  buffer_load_dwordx4 v2, s[8:11], s24 offen offset:1024 sc1 lds
  buffer_load_dwordx4 v2, s[8:11], s24 offen offset:2048 sc1 lds
  s_mov_b32 s19, s34
  s_mov_b32 s32, 0
  s_mov_b32 s33, 57344
  s_waitcnt vmcnt(7)
  s_branch wg_f_in
wg_f_loop:
  s_waitcnt vmcnt(11)
wg_f_in:
  s_barrier
  s_add_u32 s30, s19, 2
  s_lshr_b32 s24, s30, 1
  s_lshl_b32 s24, s24, 2
  s_and_b32 s25, s30, 1
  s_add_u32 s24, s24, s25
  s_mul_i32 s24, s24, 14336
  s_add_u32 s24, s24, s23
  s_cmp_lt_u32 s30, s35
  s_cselect_b32 s24, s24, 0x10000000
  s_add_u32 m0, s33, s27
  s_nop 0
  buffer_load_dwordx4 v2, s[8:11], s24 offen offset:0 sc1 lds
  buffer_load_dwordx4 v2, s[8:11], s24 offen offset:1024 sc1 lds
  buffer_load_dwordx4 v2, s[8:11], s24 offen offset:2048 sc1 lds
  buffer_load_dwordx4 v2, s[8:11], s24 offen offset:3072 sc1 lds
  s_add_u32 m0, m0, 4096
  s_add_u32 s24, s24, 4096
  buffer_load_dwordx4 v2, s[8:11], s24 offen offset:0 sc1 lds
  buffer_load_dwordx4 v2, s[8:11], s24 offen offset:1024 sc1 lds
  buffer_load_dwordx4 v2, s[8:11], s24 offen offset:2048 sc1 lds
  v_add_u32 v5, s32, v2
  ds_read_b128 v[8:11], v5 offset:0
  ds_read_b128 v[12:15], v5 offset:14336
  ds_read_b128 v[16:19], v5 offset:1024
  ds_read_b128 v[20:23], v5 offset:15360
  ds_read_b128 v[24:27], v5 offset:2048
  ds_read_b128 v[28:31], v5 offset:16384
  ds_read_b128 v[32:35], v5 offset:3072
  s_waitcnt lgkmcnt(6)
  v_mfma_f32_16x16x32_bf16 v[40:43], v[8:11], a[0:3], 0
  v_mfma_f32_16x16x32_bf16 v[44:47], v[8:11], a[56:59], 0
  v_mfma_f32_16x16x32_bf16 v[48:51], v[8:11], a[112:115], 0
  v_mfma_f32_16x16x32_bf16 v[52:55], v[8:11], a[168:171], 0
  ds_read_b128 v[36:39], v5 offset:17408
  s_waitcnt lgkmcnt(6)
  v_mfma_f32_16x16x32_bf16 v[56:59], v[12:15], a[0:3], 0
  v_mfma_f32_16x16x32_bf16 v[60:63], v[12:15], a[56:59], 0
  v_mfma_f32_16x16x32_bf16 v[64:67], v[12:15], a[112:115], 0
  v_mfma_f32_16x16x32_bf16 v[68:71], v[12:15], a[168:171], 0
  ds_read_b128 v[8:11], v5 offset:4096
  s_waitcnt lgkmcnt(6)
  v_mfma_f32_16x16x32_bf16 v[40:43], v[16:19], a[4:7], v[40:43]
  v_mfma_f32_16x16x32_bf16 v[44:47], v[16:19], a[60:63], v[44:47]
  v_mfma_f32_16x16x32_bf16 v[48:51], v[16:19], a[116:119], v[48:51]
  v_mfma_f32_16x16x32_bf16 v[52:55], v[16:19], a[172:175], v[52:55]
  ds_read_b128 v[12:15], v5 offset:18432
  s_waitcnt lgkmcnt(6)
  v_mfma_f32_16x16x32_bf16 v[56:59], v[20:23], a[4:7], v[56:59]
  v_mfma_f32_16x16x32_bf16 v[60:63], v[20:23], a[60:63], v[60:63]
  v_mfma_f32_16x16x32_bf16 v[64:67], v[20:23], a[116:119], v[64:67]
  v_mfma_f32_16x16x32_bf16 v[68:71], v[20:23], a[172:175], v[68:71]
  ds_read_b128 v[16:19], v5 offset:5120
  s_waitcnt lgkmcnt(6)
  v_mfma_f32_16x16x32_bf16 v[40:43], v[24:27], a[8:11], v[40:43]
  v_mfma_f32_16x16x32_bf16 v[44:47], v[24:27], a[64:67], v[44:47]
  v_mfma_f32_16x16x32_bf16 v[48:51], v[24:27], a[120:123], v[48:51]
  v_mfma_f32_16x16x32_bf16 v[52:55], v[24:27], a[176:179], v[52:55]
  ds_read_b128 v[20:23], v5 offset:19456
  s_waitcnt lgkmcnt(6)
  v_mfma_f32_16x16x32_bf16 v[56:59], v[28:31], a[8:11], v[56:59]
  v_mfma_f32_16x16x32_bf16 v[60:63], v[28:31], a[64:67], v[60:63]
  v_mfma_f32_16x16x32_bf16 v[64:67], v[28:31], a[120:123], v[64:67]
  v_mfma_f32_16x16x32_bf16 v[68:71], v[28:31], a[176:179], v[68:71]
  ds_read_b128 v[24:27], v5 offset:6144
  s_waitcnt lgkmcnt(6)
  v_mfma_f32_16x16x32_bf16 v[40:43], v[32:35], a[12:15], v[40:43]
  v_mfma_f32_16x16x32_bf16 v[44:47], v[32:35], a[68:71], v[44:47]
  v_mfma_f32_16x16x32_bf16 v[48:51], v[32:35], a[124:127], v[48:51]
  v_mfma_f32_16x16x32_bf16 v[52:55], v[32:35], a[180:183], v[52:55]
  ds_read_b128 v[28:31], v5 offset:20480
  s_waitcnt lgkmcnt(6)
  v_mfma_f32_16x16x32_bf16 v[56:59], v[36:39], a[12:15], v[56:59]
  v_mfma_f32_16x16x32_bf16 v[60:63], v[36:39], a[68:71], v[60:63]
  v_mfma_f32_16x16x32_bf16 v[64:67], v[36:39], a[124:127], v[64:67]
  v_mfma_f32_16x16x32_bf16 v[68:71], v[36:39], a[180:183], v[68:71]
  ds_read_b128 v[32:35], v5 offset:7168
  s_waitcnt lgkmcnt(6)
  v_mfma_f32_16x16x32_bf16 v[40:43], v[8:11], a[16:19], v[40:43]
  v_mfma_f32_16x16x32_bf16 v[44:47], v[8:11], a[72:75], v[44:47]
  v_mfma_f32_16x16x32_bf16 v[48:51], v[8:11], a[128:131], v[48:51]
  v_mfma_f32_16x16x32_bf16 v[52:55], v[8:11], a[184:187], v[52:55]
  ds_read_b128 v[36:39], v5 offset:21504
  s_waitcnt lgkmcnt(6)
  v_mfma_f32_16x16x32_bf16 v[56:59], v[12:15], a[16:19], v[56:59]
  v_mfma_f32_16x16x32_bf16 v[60:63], v[12:15], a[72:75], v[60:63]
  v_mfma_f32_16x16x32_bf16 v[64:67], v[12:15], a[128:131], v[64:67]
  v_mfma_f32_16x16x32_bf16 v[68:71], v[12:15], a[184:187], v[68:71]
  ds_read_b128 v[8:11], v5 offset:8192
  s_waitcnt lgkmcnt(6)
  v_mfma_f32_16x16x32_bf16 v[40:43], v[16:19], a[20:23], v[40:43]
  v_mfma_f32_16x16x32_bf16 v[44:47], v[16:19], a[76:79], v[44:47]
  v_mfma_f32_16x16x32_bf16 v[48:51], v[16:19], a[132:135], v[48:51]
  v_mfma_f32_16x16x32_bf16 v[52:55], v[16:19], a[188:191], v[52:55]
  ds_read_b128 v[12:15], v5 offset:22528
  s_waitcnt lgkmcnt(6)
  v_mfma_f32_16x16x32_bf16 v[56:59], v[20:23], a[20:23], v[56:59]
  v_mfma_f32_16x16x32_bf16 v[60:63], v[20:23], a[76:79], v[60:63]
  v_mfma_f32_16x16x32_bf16 v[64:67], v[20:23], a[132:135], v[64:67]
  v_mfma_f32_16x16x32_bf16 v[68:71], v[20:23], a[188:191], v[68:71]
  ds_read_b128 v[16:19], v5 offset:9216
  s_waitcnt lgkmcnt(6)
  v_mfma_f32_16x16x32_bf16 v[40:43], v[24:27], a[24:27], v[40:43]
  v_mfma_f32_16x16x32_bf16 v[44:47], v[24:27], a[80:83], v[44:47]
  v_mfma_f32_16x16x32_bf16 v[48:51], v[24:27], a[136:139], v[48:51]
  v_mfma_f32_16x16x32_bf16 v[52:55], v[24:27], a[192:195], v[52:55]
  ds_read_b128 v[20:23], v5 offset:23552
  s_waitcnt lgkmcnt(6)
  v_mfma_f32_16x16x32_bf16 v[56:59], v[28:31], a[24:27], v[56:59]
  v_mfma_f32_16x16x32_bf16 v[60:63], v[28:31], a[80:83], v[60:63]
  v_mfma_f32_16x16x32_bf16 v[64:67], v[28:31], a[136:139], v[64:67]
  v_mfma_f32_16x16x32_bf16 v[68:71], v[28:31], a[192:195], v[68:71]
  ds_read_b128 v[24:27], v5 offset:10240
  s_waitcnt lgkmcnt(6)
  v_mfma_f32_16x16x32_bf16 v[40:43], v[32:35], a[28:31], v[40:43]
  v_mfma_f32_16x16x32_bf16 v[44:47], v[32:35], a[84:87], v[44:47]
  v_mfma_f32_16x16x32_bf16 v[48:51], v[32:35], a[140:143], v[48:51]
  v_mfma_f32_16x16x32_bf16 v[52:55], v[32:35], a[196:199], v[52:55]
  ds_read_b128 v[28:31], v5 offset:24576
  s_waitcnt lgkmcnt(6)
  v_mfma_f32_16x16x32_bf16 v[56:59], v[36:39], a[28:31], v[56:59]
  v_mfma_f32_16x16x32_bf16 v[60:63], v[36:39], a[84:87], v[60:63]
  v_mfma_f32_16x16x32_bf16 v[64:67], v[36:39], a[140:143], v[64:67]
  v_mfma_f32_16x16x32_bf16 v[68:71], v[36:39], a[196:199], v[68:71]
  ds_read_b128 v[32:35], v5 offset:11264
  s_waitcnt lgkmcnt(6)
  v_mfma_f32_16x16x32_bf16 v[40:43], v[8:11], a[32:35], v[40:43]
  v_mfma_f32_16x16x32_bf16 v[44:47], v[8:11], a[88:91], v[44:47]
  v_mfma_f32_16x16x32_bf16 v[48:51], v[8:11], a[144:147], v[48:51]
  v_mfma_f32_16x16x32_bf16 v[52:55], v[8:11], a[200:203], v[52:55]
  ds_read_b128 v[36:39], v5 offset:25600
  s_waitcnt lgkmcnt(6)
  v_mfma_f32_16x16x32_bf16 v[56:59], v[12:15], a[32:35], v[56:59]
  v_mfma_f32_16x16x32_bf16 v[60:63], v[12:15], a[88:91], v[60:63]
  v_mfma_f32_16x16x32_bf16 v[64:67], v[12:15], a[144:147], v[64:67]
  v_mfma_f32_16x16x32_bf16 v[68:71], v[12:15], a[200:203], v[68:71]
  ds_read_b128 v[8:11], v5 offset:12288
  s_waitcnt lgkmcnt(6)
  v_mfma_f32_16x16x32_bf16 v[40:43], v[16:19], a[36:39], v[40:43]
  v_mfma_f32_16x16x32_bf16 v[44:47], v[16:19], a[92:95], v[44:47]
  v_mfma_f32_16x16x32_bf16 v[48:51], v[16:19], a[148:151], v[48:51]
  v_mfma_f32_16x16x32_bf16 v[52:55], v[16:19], a[204:207], v[52:55]
  ds_read_b128 v[12:15], v5 offset:26624
  s_waitcnt lgkmcnt(6)
  v_mfma_f32_16x16x32_bf16 v[56:59], v[20:23], a[36:39], v[56:59]
  v_mfma_f32_16x16x32_bf16 v[60:63], v[20:23], a[92:95], v[60:63]
  v_mfma_f32_16x16x32_bf16 v[64:67], v[20:23], a[148:151], v[64:67]
  v_mfma_f32_16x16x32_bf16 v[68:71], v[20:23], a[204:207], v[68:71]
  ds_read_b128 v[16:19], v5 offset:13312
  s_waitcnt lgkmcnt(6)
  v_mfma_f32_16x16x32_bf16 v[40:43], v[24:27], a[40:43], v[40:43]
  v_mfma_f32_16x16x32_bf16 v[44:47], v[24:27], a[96:99], v[44:47]
  v_mfma_f32_16x16x32_bf16 v[48:51], v[24:27], a[152:155], v[48:51]
  v_mfma_f32_16x16x32_bf16 v[52:55], v[24:27], a[208:211], v[52:55]
  ds_read_b128 v[20:23], v5 offset:27648
  s_waitcnt lgkmcnt(6)
  v_mfma_f32_16x16x32_bf16 v[56:59], v[28:31], a[40:43], v[56:59]
  v_mfma_f32_16x16x32_bf16 v[60:63], v[28:31], a[96:99], v[60:63]
  v_mfma_f32_16x16x32_bf16 v[64:67], v[28:31], a[152:155], v[64:67]
  v_mfma_f32_16x16x32_bf16 v[68:71], v[28:31], a[208:211], v[68:71]
  s_waitcnt lgkmcnt(5)
  v_mfma_f32_16x16x32_bf16 v[40:43], v[32:35], a[44:47], v[40:43]
  v_mfma_f32_16x16x32_bf16 v[44:47], v[32:35], a[100:103], v[44:47]
  v_mfma_f32_16x16x32_bf16 v[48:51], v[32:35], a[156:159], v[48:51]
  v_mfma_f32_16x16x32_bf16 v[52:55], v[32:35], a[212:215], v[52:55]
  s_waitcnt lgkmcnt(4)
  v_mfma_f32_16x16x32_bf16 v[56:59], v[36:39], a[44:47], v[56:59]
  v_mfma_f32_16x16x32_bf16 v[60:63], v[36:39], a[100:103], v[60:63]
  v_mfma_f32_16x16x32_bf16 v[64:67], v[36:39], a[156:159], v[64:67]
  v_mfma_f32_16x16x32_bf16 v[68:71], v[36:39], a[212:215], v[68:71]
  s_waitcnt lgkmcnt(3)
  v_mfma_f32_16x16x32_bf16 v[40:43], v[8:11], a[48:51], v[40:43]
  v_mfma_f32_16x16x32_bf16 v[44:47], v[8:11], a[104:107], v[44:47]
  v_mfma_f32_16x16x32_bf16 v[48:51], v[8:11], a[160:163], v[48:51]
  v_mfma_f32_16x16x32_bf16 v[52:55], v[8:11], a[216:219], v[52:55]
  s_waitcnt lgkmcnt(2)
  v_mfma_f32_16x16x32_bf16 v[56:59], v[12:15], a[48:51], v[56:59]
  v_mfma_f32_16x16x32_bf16 v[60:63], v[12:15], a[104:107], v[60:63]
  v_mfma_f32_16x16x32_bf16 v[64:67], v[12:15], a[160:163], v[64:67]
  v_mfma_f32_16x16x32_bf16 v[68:71], v[12:15], a[216:219], v[68:71]
  s_waitcnt lgkmcnt(1)
  v_mfma_f32_16x16x32_bf16 v[40:43], v[16:19], a[52:55], v[40:43]
  v_mfma_f32_16x16x32_bf16 v[44:47], v[16:19], a[108:111], v[44:47]
  v_mfma_f32_16x16x32_bf16 v[48:51], v[16:19], a[164:167], v[48:51]
  v_mfma_f32_16x16x32_bf16 v[52:55], v[16:19], a[220:223], v[52:55]
  s_waitcnt lgkmcnt(0)
  v_mfma_f32_16x16x32_bf16 v[56:59], v[20:23], a[52:55], v[56:59]
  v_mfma_f32_16x16x32_bf16 v[60:63], v[20:23], a[108:111], v[60:63]
  v_mfma_f32_16x16x32_bf16 v[64:67], v[20:23], a[164:167], v[64:67]
  v_mfma_f32_16x16x32_bf16 v[68:71], v[20:23], a[220:223], v[68:71]
  s_lshl_b32 s24, s19, 10
  s_add_u32 s24, s24, s29
  v_cvt_pk_bf16_f32 v72, v40, v41
  v_cvt_pk_bf16_f32 v73, v42, v43
  v_cvt_pk_bf16_f32 v74, v56, v57
  v_cvt_pk_bf16_f32 v75, v58, v59
  s_add_u32 s25, s24, 0
  buffer_store_dwordx4 v[72:75], v2, s[8:11], s25 offen sc1
  v_cvt_pk_bf16_f32 v76, v44, v45
  v_cvt_pk_bf16_f32 v77, v46, v47
  v_cvt_pk_bf16_f32 v78, v60, v61
  v_cvt_pk_bf16_f32 v79, v62, v63
  s_add_u32 s25, s24, 14336
  buffer_store_dwordx4 v[76:79], v2, s[8:11], s25 offen sc1
  v_cvt_pk_bf16_f32 v80, v48, v49
  v_cvt_pk_bf16_f32 v81, v50, v51
  v_cvt_pk_bf16_f32 v82, v64, v65
  v_cvt_pk_bf16_f32 v83, v66, v67
  s_add_u32 s25, s24, 458752
  buffer_store_dwordx4 v[80:83], v2, s[8:11], s25 offen sc1
  v_cvt_pk_bf16_f32 v84, v52, v53
  v_cvt_pk_bf16_f32 v85, v54, v55
  v_cvt_pk_bf16_f32 v86, v68, v69
  v_cvt_pk_bf16_f32 v87, v70, v71
  s_add_u32 s25, s24, 473088
  buffer_store_dwordx4 v[84:87], v2, s[8:11], s25 offen sc1
  s_mov_b32 s33, s32
  s_add_u32 s32, s32, 28672
  s_cmp_eq_u32 s32, 86016
  s_cselect_b32 s32, 0, s32
  s_add_u32 s19, s19, 1
  s_cmp_lt_u32 s19, s35
  s_cbranch_scc1 wg_f_loop
  s_branch wg_done
wg_vo:
  s_sub_u32 s29, s17, 16
  s_lshl_b32 s29, s29, 6
  s_add_u32 s29, s29, s28
  s_mul_i32 s29, s29, 28672
  s_add_u32 s29, s29, 42205184
  v_mul_u32_u24 v6, 28, v3
  s_mov_b32 s31, 0
  s_lshl_b32 s24, s34, 1
  s_mul_i32 s24, s24, 14336
  s_add_u32 s24, s24, s23
  s_cmp_lt_u32 s34, s35
  s_cselect_b32 s24, s24, 0x10000000
  s_add_u32 m0, s31, s27
  s_nop 0
  buffer_load_dwordx4 v2, s[8:11], s24 offen offset:0 sc1 lds
  buffer_load_dwordx4 v2, s[8:11], s24 offen offset:1024 sc1 lds
  buffer_load_dwordx4 v2, s[8:11], s24 offen offset:2048 sc1 lds
  buffer_load_dwordx4 v2, s[8:11], s24 offen offset:3072 sc1 lds
  s_add_u32 m0, m0, 4096
  s_add_u32 s24, s24, 4096
  buffer_load_dwordx4 v2, s[8:11], s24 offen offset:0 sc1 lds
  buffer_load_dwordx4 v2, s[8:11], s24 offen offset:1024 sc1 lds
  buffer_load_dwordx4 v2, s[8:11], s24 offen offset:2048 sc1 lds
  s_add_u32 s30, s34, 1
  s_mov_b32 s31, 28672
  s_lshl_b32 s24, s30, 1
  s_mul_i32 s24, s24, 14336
  s_add_u32 s24, s24, s23
  s_cmp_lt_u32 s30, s35
  s_cselect_b32 s24, s24, 0x10000000
  s_add_u32 m0, s31, s27
  s_nop 0
  buffer_load_dwordx4 v2, s[8:11], s24 offen offset:0 sc1 lds
  buffer_load_dwordx4 v2, s[8:11], s24 offen offset:1024 sc1 lds
  buffer_load_dwordx4 v2, s[8:11], s24 offen offset:2048 sc1 lds
  buffer_load_dwordx4 v2, s[8:11], s24 offen offset:3072 sc1 lds
  s_add_u32 m0, m0, 4096
  s_add_u32 s24, s24, 4096
  buffer_load_dwordx4 v2, s[8:11], s24 offen offset:0 sc1 lds
  buffer_load_dwordx4 v2, s[8:11], s24 offen offset:1024 sc1 lds
  buffer_load_dwordx4 v2, s[8:11], s24 offen offset:2048 sc1 lds
  s_mov_b32 s19, s34
  s_mov_b32 s32, 0
  s_mov_b32 s33, 57344
  s_waitcnt vmcnt(7)
  s_branch wg_vo_in
wg_vo_loop:
  s_waitcnt vmcnt(11)
wg_vo_in:
  s_barrier
  s_add_u32 s30, s19, 2
  s_lshl_b32 s24, s30, 1
  s_mul_i32 s24, s24, 14336
  s_add_u32 s24, s24, s23
  s_cmp_lt_u32 s30, s35
  s_cselect_b32 s24, s24, 0x10000000
  s_add_u32 m0, s33, s27
  s_nop 0
  buffer_load_dwordx4 v2, s[8:11], s24 offen offset:0 sc1 lds
  buffer_load_dwordx4 v2, s[8:11], s24 offen offset:1024 sc1 lds
  buffer_load_dwordx4 v2, s[8:11], s24 offen offset:2048 sc1 lds
  buffer_load_dwordx4 v2, s[8:11], s24 offen offset:3072 sc1 lds
  s_add_u32 m0, m0, 4096
  s_add_u32 s24, s24, 4096
  buffer_load_dwordx4 v2, s[8:11], s24 offen offset:0 sc1 lds
  buffer_load_dwordx4 v2, s[8:11], s24 offen offset:1024 sc1 lds
  buffer_load_dwordx4 v2, s[8:11], s24 offen offset:2048 sc1 lds
  v_add_u32 v5, s32, v2
  ds_read_b128 v[8:11], v5 offset:0
  ds_read_b128 v[12:15], v5 offset:14336
  ds_read_b128 v[16:19], v5 offset:1024
  ds_read_b128 v[20:23], v5 offset:15360
  ds_read_b128 v[24:27], v5 offset:2048
  ds_read_b128 v[28:31], v5 offset:16384
  ds_read_b128 v[32:35], v5 offset:3072
  s_waitcnt lgkmcnt(6)
  v_mfma_f32_16x16x32_bf16 v[40:43], a[0:3], v[8:11], 0
  v_mfma_f32_16x16x32_bf16 v[44:47], a[56:59], v[8:11], 0
  v_mfma_f32_16x16x32_bf16 v[48:51], a[112:115], v[8:11], 0
  v_mfma_f32_16x16x32_bf16 v[52:55], a[168:171], v[8:11], 0
  ds_read_b128 v[36:39], v5 offset:17408
  s_waitcnt lgkmcnt(6)
  v_mfma_f32_16x16x32_bf16 v[56:59], a[0:3], v[12:15], 0
  v_mfma_f32_16x16x32_bf16 v[60:63], a[56:59], v[12:15], 0
  v_mfma_f32_16x16x32_bf16 v[64:67], a[112:115], v[12:15], 0
  v_mfma_f32_16x16x32_bf16 v[68:71], a[168:171], v[12:15], 0
  ds_read_b128 v[8:11], v5 offset:4096
  s_waitcnt lgkmcnt(6)
  v_mfma_f32_16x16x32_bf16 v[40:43], a[4:7], v[16:19], v[40:43]
  v_mfma_f32_16x16x32_bf16 v[44:47], a[60:63], v[16:19], v[44:47]
  v_mfma_f32_16x16x32_bf16 v[48:51], a[116:119], v[16:19], v[48:51]
  v_mfma_f32_16x16x32_bf16 v[52:55], a[172:175], v[16:19], v[52:55]
  ds_read_b128 v[12:15], v5 offset:18432
  s_waitcnt lgkmcnt(6)
  v_mfma_f32_16x16x32_bf16 v[56:59], a[4:7], v[20:23], v[56:59]
  v_mfma_f32_16x16x32_bf16 v[60:63], a[60:63], v[20:23], v[60:63]
  v_mfma_f32_16x16x32_bf16 v[64:67], a[116:119], v[20:23], v[64:67]
  v_mfma_f32_16x16x32_bf16 v[68:71], a[172:175], v[20:23], v[68:71]
  ds_read_b128 v[16:19], v5 offset:5120
  s_waitcnt lgkmcnt(6)
  v_mfma_f32_16x16x32_bf16 v[40:43], a[8:11], v[24:27], v[40:43]
  v_mfma_f32_16x16x32_bf16 v[44:47], a[64:67], v[24:27], v[44:47]
  v_mfma_f32_16x16x32_bf16 v[48:51], a[120:123], v[24:27], v[48:51]
  v_mfma_f32_16x16x32_bf16 v[52:55], a[176:179], v[24:27], v[52:55]
  ds_read_b128 v[20:23], v5 offset:19456
  s_waitcnt lgkmcnt(6)
  v_mfma_f32_16x16x32_bf16 v[56:59], a[8:11], v[28:31], v[56:59]
  v_mfma_f32_16x16x32_bf16 v[60:63], a[64:67], v[28:31], v[60:63]
  v_mfma_f32_16x16x32_bf16 v[64:67], a[120:123], v[28:31], v[64:67]
  v_mfma_f32_16x16x32_bf16 v[68:71], a[176:179], v[28:31], v[68:71]
  ds_read_b128 v[24:27], v5 offset:6144
  s_waitcnt lgkmcnt(6)
  v_mfma_f32_16x16x32_bf16 v[40:43], a[12:15], v[32:35], v[40:43]
  v_mfma_f32_16x16x32_bf16 v[44:47], a[68:71], v[32:35], v[44:47]
  v_mfma_f32_16x16x32_bf16 v[48:51], a[124:127], v[32:35], v[48:51]
  v_mfma_f32_16x16x32_bf16 v[52:55], a[180:183], v[32:35], v[52:55]
  ds_read_b128 v[28:31], v5 offset:20480
  s_waitcnt lgkmcnt(6)
  v_mfma_f32_16x16x32_bf16 v[56:59], a[12:15], v[36:39], v[56:59]
  v_mfma_f32_16x16x32_bf16 v[60:63], a[68:71], v[36:39], v[60:63]
  v_mfma_f32_16x16x32_bf16 v[64:67], a[124:127], v[36:39], v[64:67]
  v_mfma_f32_16x16x32_bf16 v[68:71], a[180:183], v[36:39], v[68:71]
  ds_read_b128 v[32:35], v5 offset:7168
  s_waitcnt lgkmcnt(6)
  v_mfma_f32_16x16x32_bf16 v[40:43], a[16:19], v[8:11], v[40:43]
  v_mfma_f32_16x16x32_bf16 v[44:47], a[72:75], v[8:11], v[44:47]
  v_mfma_f32_16x16x32_bf16 v[48:51], a[128:131], v[8:11], v[48:51]
  v_mfma_f32_16x16x32_bf16 v[52:55], a[184:187], v[8:11], v[52:55]
  ds_read_b128 v[36:39], v5 offset:21504
  s_waitcnt lgkmcnt(6)
  v_mfma_f32_16x16x32_bf16 v[56:59], a[16:19], v[12:15], v[56:59]
  v_mfma_f32_16x16x32_bf16 v[60:63], a[72:75], v[12:15], v[60:63]
  v_mfma_f32_16x16x32_bf16 v[64:67], a[128:131], v[12:15], v[64:67]
  v_mfma_f32_16x16x32_bf16 v[68:71], a[184:187], v[12:15], v[68:71]
  ds_read_b128 v[8:11], v5 offset:8192
  s_waitcnt lgkmcnt(6)
  v_mfma_f32_16x16x32_bf16 v[40:43], a[20:23], v[16:19], v[40:43]
  v_mfma_f32_16x16x32_bf16 v[44:47], a[76:79], v[16:19], v[44:47]
  v_mfma_f32_16x16x32_bf16 v[48:51], a[132:135], v[16:19], v[48:51]
  v_mfma_f32_16x16x32_bf16 v[52:55], a[188:191], v[16:19], v[52:55]
  ds_read_b128 v[12:15], v5 offset:22528
  s_waitcnt lgkmcnt(6)
  v_mfma_f32_16x16x32_bf16 v[56:59], a[20:23], v[20:23], v[56:59]
  v_mfma_f32_16x16x32_bf16 v[60:63], a[76:79], v[20:23], v[60:63]
  v_mfma_f32_16x16x32_bf16 v[64:67], a[132:135], v[20:23], v[64:67]
  v_mfma_f32_16x16x32_bf16 v[68:71], a[188:191], v[20:23], v[68:71]
  ds_read_b128 v[16:19], v5 offset:9216
  s_waitcnt lgkmcnt(6)
  v_mfma_f32_16x16x32_bf16 v[40:43], a[24:27], v[24:27], v[40:43]
  v_mfma_f32_16x16x32_bf16 v[44:47], a[80:83], v[24:27], v[44:47]
  v_mfma_f32_16x16x32_bf16 v[48:51], a[136:139], v[24:27], v[48:51]
  v_mfma_f32_16x16x32_bf16 v[52:55], a[192:195], v[24:27], v[52:55]
  ds_read_b128 v[20:23], v5 offset:23552
  s_waitcnt lgkmcnt(6)
  v_mfma_f32_16x16x32_bf16 v[56:59], a[24:27], v[28:31], v[56:59]
  v_mfma_f32_16x16x32_bf16 v[60:63], a[80:83], v[28:31], v[60:63]
  v_mfma_f32_16x16x32_bf16 v[64:67], a[136:139], v[28:31], v[64:67]
  v_mfma_f32_16x16x32_bf16 v[68:71], a[192:195], v[28:31], v[68:71]
  ds_read_b128 v[24:27], v5 offset:10240
  s_waitcnt lgkmcnt(6)
  v_mfma_f32_16x16x32_bf16 v[40:43], a[28:31], v[32:35], v[40:43]
  v_mfma_f32_16x16x32_bf16 v[44:47], a[84:87], v[32:35], v[44:47]
  v_mfma_f32_16x16x32_bf16 v[48:51], a[140:143], v[32:35], v[48:51]
  v_mfma_f32_16x16x32_bf16 v[52:55], a[196:199], v[32:35], v[52:55]
  ds_read_b128 v[28:31], v5 offset:24576
  s_waitcnt lgkmcnt(6)
  v_mfma_f32_16x16x32_bf16 v[56:59], a[28:31], v[36:39], v[56:59]
  v_mfma_f32_16x16x32_bf16 v[60:63], a[84:87], v[36:39], v[60:63]
  v_mfma_f32_16x16x32_bf16 v[64:67], a[140:143], v[36:39], v[64:67]
  v_mfma_f32_16x16x32_bf16 v[68:71], a[196:199], v[36:39], v[68:71]
  ds_read_b128 v[32:35], v5 offset:11264
  s_waitcnt lgkmcnt(6)
  v_mfma_f32_16x16x32_bf16 v[40:43], a[32:35], v[8:11], v[40:43]
  v_mfma_f32_16x16x32_bf16 v[44:47], a[88:91], v[8:11], v[44:47]
  v_mfma_f32_16x16x32_bf16 v[48:51], a[144:147], v[8:11], v[48:51]
  v_mfma_f32_16x16x32_bf16 v[52:55], a[200:203], v[8:11], v[52:55]
  ds_read_b128 v[36:39], v5 offset:25600
  s_waitcnt lgkmcnt(6)
  v_mfma_f32_16x16x32_bf16 v[56:59], a[32:35], v[12:15], v[56:59]
  v_mfma_f32_16x16x32_bf16 v[60:63], a[88:91], v[12:15], v[60:63]
  v_mfma_f32_16x16x32_bf16 v[64:67], a[144:147], v[12:15], v[64:67]
  v_mfma_f32_16x16x32_bf16 v[68:71], a[200:203], v[12:15], v[68:71]
  ds_read_b128 v[8:11], v5 offset:12288
  s_waitcnt lgkmcnt(6)
  v_mfma_f32_16x16x32_bf16 v[40:43], a[36:39], v[16:19], v[40:43]
  v_mfma_f32_16x16x32_bf16 v[44:47], a[92:95], v[16:19], v[44:47]
  v_mfma_f32_16x16x32_bf16 v[48:51], a[148:151], v[16:19], v[48:51]
  v_mfma_f32_16x16x32_bf16 v[52:55], a[204:207], v[16:19], v[52:55]
  ds_read_b128 v[12:15], v5 offset:26624
  s_waitcnt lgkmcnt(6)
  v_mfma_f32_16x16x32_bf16 v[56:59], a[36:39], v[20:23], v[56:59]
  v_mfma_f32_16x16x32_bf16 v[60:63], a[92:95], v[20:23], v[60:63]
  v_mfma_f32_16x16x32_bf16 v[64:67], a[148:151], v[20:23], v[64:67]
  v_mfma_f32_16x16x32_bf16 v[68:71], a[204:207], v[20:23], v[68:71]
  ds_read_b128 v[16:19], v5 offset:13312
  s_waitcnt lgkmcnt(6)
  v_mfma_f32_16x16x32_bf16 v[40:43], a[40:43], v[24:27], v[40:43]
  v_mfma_f32_16x16x32_bf16 v[44:47], a[96:99], v[24:27], v[44:47]
  v_mfma_f32_16x16x32_bf16 v[48:51], a[152:155], v[24:27], v[48:51]
  v_mfma_f32_16x16x32_bf16 v[52:55], a[208:211], v[24:27], v[52:55]
  ds_read_b128 v[20:23], v5 offset:27648
  s_waitcnt lgkmcnt(6)
  v_mfma_f32_16x16x32_bf16 v[56:59], a[40:43], v[28:31], v[56:59]
  v_mfma_f32_16x16x32_bf16 v[60:63], a[96:99], v[28:31], v[60:63]
  v_mfma_f32_16x16x32_bf16 v[64:67], a[152:155], v[28:31], v[64:67]
  v_mfma_f32_16x16x32_bf16 v[68:71], a[208:211], v[28:31], v[68:71]
  s_waitcnt lgkmcnt(5)
  v_mfma_f32_16x16x32_bf16 v[40:43], a[44:47], v[32:35], v[40:43]
  v_mfma_f32_16x16x32_bf16 v[44:47], a[100:103], v[32:35], v[44:47]
  v_mfma_f32_16x16x32_bf16 v[48:51], a[156:159], v[32:35], v[48:51]
  v_mfma_f32_16x16x32_bf16 v[52:55], a[212:215], v[32:35], v[52:55]
  s_waitcnt lgkmcnt(4)
  v_mfma_f32_16x16x32_bf16 v[56:59], a[44:47], v[36:39], v[56:59]
  v_mfma_f32_16x16x32_bf16 v[60:63], a[100:103], v[36:39], v[60:63]
  v_mfma_f32_16x16x32_bf16 v[64:67], a[156:159], v[36:39], v[64:67]
  v_mfma_f32_16x16x32_bf16 v[68:71], a[212:215], v[36:39], v[68:71]
  s_waitcnt lgkmcnt(3)
  v_mfma_f32_16x16x32_bf16 v[40:43], a[48:51], v[8:11], v[40:43]
  v_mfma_f32_16x16x32_bf16 v[44:47], a[104:107], v[8:11], v[44:47]
  v_mfma_f32_16x16x32_bf16 v[48:51], a[160:163], v[8:11], v[48:51]
  v_mfma_f32_16x16x32_bf16 v[52:55], a[216:219], v[8:11], v[52:55]
  s_waitcnt lgkmcnt(2)
  v_mfma_f32_16x16x32_bf16 v[56:59], a[48:51], v[12:15], v[56:59]
  v_mfma_f32_16x16x32_bf16 v[60:63], a[104:107], v[12:15], v[60:63]
  v_mfma_f32_16x16x32_bf16 v[64:67], a[160:163], v[12:15], v[64:67]
  v_mfma_f32_16x16x32_bf16 v[68:71], a[216:219], v[12:15], v[68:71]
  s_waitcnt lgkmcnt(1)
  v_mfma_f32_16x16x32_bf16 v[40:43], a[52:55], v[16:19], v[40:43]
  v_mfma_f32_16x16x32_bf16 v[44:47], a[108:111], v[16:19], v[44:47]
  v_mfma_f32_16x16x32_bf16 v[48:51], a[164:167], v[16:19], v[48:51]
  v_mfma_f32_16x16x32_bf16 v[52:55], a[220:223], v[16:19], v[52:55]
  s_waitcnt lgkmcnt(0)
  v_mfma_f32_16x16x32_bf16 v[56:59], a[52:55], v[20:23], v[56:59]
  v_mfma_f32_16x16x32_bf16 v[60:63], a[108:111], v[20:23], v[60:63]
  v_mfma_f32_16x16x32_bf16 v[64:67], a[164:167], v[20:23], v[64:67]
  v_mfma_f32_16x16x32_bf16 v[68:71], a[220:223], v[20:23], v[68:71]
  s_add_u32 s25, s29, 28672
  s_lshl_b32 s24, s19, 5
  s_add_u32 s24, s24, 0
  v_add_u32 v88, s24, v4
  v_mul_u32_u24 v89, 2341, v88
  v_lshrrev_b32 v89, 16, v89
  v_mul_u32_u24 v89, 84, v89
  v_add3_u32 v88, v88, v89, v6
  v_lshlrev_b32 v90, 4, v88
  v_cvt_pk_bf16_f32 v72, v40, v41
  v_cvt_pk_bf16_f32 v73, v42, v43
  v_cvt_pk_bf16_f32 v74, v44, v45
  v_cvt_pk_bf16_f32 v75, v46, v47
  buffer_store_dwordx4 v[72:75], v90, s[8:11], s29 offen sc1
  v_cvt_pk_bf16_f32 v76, v48, v49
  v_cvt_pk_bf16_f32 v77, v50, v51
  v_cvt_pk_bf16_f32 v78, v52, v53
  v_cvt_pk_bf16_f32 v79, v54, v55
  buffer_store_dwordx4 v[76:79], v90, s[8:11], s25 offen sc1
  s_lshl_b32 s24, s19, 5
  s_add_u32 s24, s24, 16
  v_add_u32 v88, s24, v4
  v_mul_u32_u24 v89, 2341, v88
  v_lshrrev_b32 v89, 16, v89
  v_mul_u32_u24 v89, 84, v89
  v_add3_u32 v88, v88, v89, v6
  v_lshlrev_b32 v91, 4, v88
  v_cvt_pk_bf16_f32 v80, v56, v57
  v_cvt_pk_bf16_f32 v81, v58, v59
  v_cvt_pk_bf16_f32 v82, v60, v61
  v_cvt_pk_bf16_f32 v83, v62, v63
  buffer_store_dwordx4 v[80:83], v91, s[8:11], s29 offen sc1
  v_cvt_pk_bf16_f32 v84, v64, v65
  v_cvt_pk_bf16_f32 v85, v66, v67
  v_cvt_pk_bf16_f32 v86, v68, v69
  v_cvt_pk_bf16_f32 v87, v70, v71
  buffer_store_dwordx4 v[84:87], v91, s[8:11], s25 offen sc1
  s_mov_b32 s33, s32
  s_add_u32 s32, s32, 28672
  s_cmp_eq_u32 s32, 86016
  s_cselect_b32 s32, 0, s32
  s_add_u32 s19, s19, 1
  s_cmp_lt_u32 s19, s35
  s_cbranch_scc1 wg_vo_loop
  s_branch wg_done
wg_done:
  s_lshl_b32 s20, s18, 4
  s_and_b32 s21, s17, 15
  s_add_u32 s20, s20, s21
  s_lshl_b32 s20, s20, 7
  s_cmp_lt_u32 s17, 16
  s_cselect_b32 s21, 16384, 0
  s_add_u32 s20, s20, s21
  s_add_u32 s20, s20, 88528896
  s_sub_u32 s21, s35, s34
  v_mov_b32 v5, s21
  v_mov_b32 v6, 0
  s_waitcnt vmcnt(0)
  s_mov_b64 exec, 1
  buffer_atomic_add v5, v6, s[8:11], s20 offen
  s_mov_b64 exec, -1
  s_branch wk_loop
wk_a:
  s_load_dwordx8 s[36:43], s[0:1], 56
  s_load_dwordx4 s[44:47], s[0:1], 88
  s_sub_u32 s3, s3, 368
  s_and_b32 s17, s3, 15
  s_lshr_b32 s19, s3, 5
  s_bitcmp1_b32 s3, 4
  s_cselect_b32 s31, 7, 0
  s_waitcnt lgkmcnt(0)
  s_mov_b32 s60, s40
  s_and_b32 s61, s41, 0xffff
  s_mov_b32 s62, 3670016
  s_mov_b32 s63, 0x20000
  s_mov_b32 s56, s42
  s_and_b32 s57, s43, 0xffff
  s_mov_b32 s58, 3670016
  s_mov_b32 s59, 0x20000
  s_lshl_b32 s30, s16, 13
  s_lshl_b32 s27, s19, 19
  s_lshl_b32 s29, s16, 17
  s_add_u32 s27, s27, s29
  s_lshl_b32 s29, s17, 9
  s_add_u32 s27, s27, s29
  v_lshrrev_b32 v5, 5, v1
  v_and_b32 v6, 31, v1
  v_xor_b32 v6, v6, v5
  v_lshlrev_b32 v6, 4, v6
  v_lshl_add_u32 v6, v5, 13, v6
  s_add_u32 m0, s30, 0
  s_add_u32 s22, s27, 0
  v_xor_b32 v7, 0, v6
  buffer_load_dwordx4 v7, s[56:59], s22 offen offset:0 lds
  s_add_u32 s22, s27, 15360
  v_xor_b32 v7, 32, v6
  buffer_load_dwordx4 v7, s[56:59], s22 offen offset:1024 lds
  s_add_u32 s22, s27, 30720
  v_xor_b32 v7, 64, v6
  buffer_load_dwordx4 v7, s[56:59], s22 offen offset:2048 lds
  s_add_u32 s22, s27, 46080
  v_xor_b32 v7, 96, v6
  buffer_load_dwordx4 v7, s[56:59], s22 offen offset:3072 lds
  s_add_u32 m0, s30, 4096
  s_add_u32 s22, s27, 65536
  v_xor_b32 v7, 128, v6
  buffer_load_dwordx4 v7, s[56:59], s22 offen offset:0 lds
  s_add_u32 s22, s27, 80896
  v_xor_b32 v7, 160, v6
  buffer_load_dwordx4 v7, s[56:59], s22 offen offset:1024 lds
  s_add_u32 s22, s27, 96256
  v_xor_b32 v7, 192, v6
  buffer_load_dwordx4 v7, s[56:59], s22 offen offset:2048 lds
  s_add_u32 s22, s27, 111616
  v_xor_b32 v7, 224, v6
  buffer_load_dwordx4 v7, s[56:59], s22 offen offset:3072 lds
  v_lshrrev_b32 v5, 5, v1
  v_and_b32 v6, 31, v1
  s_lshl_b32 s25, s16, 15
  s_add_u32 s25, s25, 32768
  s_lshl_b32 s26, s17, 9
  s_add_u32 s28, s19, s16
  s_cmp_ge_u32 s28, 7
  s_cselect_b32 s20, 7, 0
  s_sub_u32 s28, s28, s20
  s_add_u32 s28, s28, s31
  s_add_u32 s29, s19, s16
  s_add_u32 s29, s29, 4
  s_cmp_ge_u32 s29, 7
  s_cselect_b32 s20, 7, 0
  s_sub_u32 s29, s29, s20
  s_add_u32 s29, s29, s31
  s_lshl_b32 s32, s28, 18
  s_add_u32 s32, s32, s26
  s_lshl_b32 s33, s29, 18
  s_add_u32 s33, s33, s26
  v_xor_b32 v8, v6, v5
  v_lshlrev_b32 v8, 4, v8
  v_lshl_add_u32 v8, v5, 13, v8
  v_xor_b32 v12, 0, v8
  v_xor_b32 v13, 32, v8
  v_add_u32 v13, 15360, v13
  v_xor_b32 v14, 0, v8
  v_add_u32 v14, 30720, v14
  v_xor_b32 v15, 32, v8
  v_add_u32 v15, 46080, v15
  s_add_u32 s20, s16, 0
  s_and_b32 s20, s20, 3
  s_mul_i32 s21, s20, 65600
  s_lshl_b32 s20, s20, 12
  s_add_u32 s48, s20, s25
  s_mov_b32 m0, s48
  v_xor_b32 v16, s21, v12
  buffer_load_dwordx4 v16, s[60:63], s32 offen offset:0 lds
  v_xor_b32 v17, s21, v13
  buffer_load_dwordx4 v17, s[60:63], s32 offen offset:1024 lds
  v_xor_b32 v18, s21, v14
  buffer_load_dwordx4 v18, s[60:63], s32 offen offset:2048 lds
  v_xor_b32 v19, s21, v15
  buffer_load_dwordx4 v19, s[60:63], s32 offen offset:3072 lds
  s_add_u32 s20, s16, 1
  s_and_b32 s20, s20, 3
  s_mul_i32 s21, s20, 65600
  s_lshl_b32 s20, s20, 12
  s_add_u32 s49, s20, s25
  s_mov_b32 m0, s49
  v_xor_b32 v20, s21, v12
  buffer_load_dwordx4 v20, s[60:63], s32 offen offset:0 lds
  v_xor_b32 v21, s21, v13
  buffer_load_dwordx4 v21, s[60:63], s32 offen offset:1024 lds
  v_xor_b32 v22, s21, v14
  buffer_load_dwordx4 v22, s[60:63], s32 offen offset:2048 lds
  v_xor_b32 v23, s21, v15
  buffer_load_dwordx4 v23, s[60:63], s32 offen offset:3072 lds
  s_add_u32 s20, s16, 2
  s_and_b32 s20, s20, 3
  s_mul_i32 s21, s20, 65600
  s_lshl_b32 s20, s20, 12
  s_add_u32 s50, s20, s25
  s_mov_b32 m0, s50
  v_xor_b32 v24, s21, v12
  buffer_load_dwordx4 v24, s[60:63], s32 offen offset:0 lds
  v_xor_b32 v25, s21, v13
  buffer_load_dwordx4 v25, s[60:63], s32 offen offset:1024 lds
  v_xor_b32 v26, s21, v14
  buffer_load_dwordx4 v26, s[60:63], s32 offen offset:2048 lds
  v_xor_b32 v27, s21, v15
  buffer_load_dwordx4 v27, s[60:63], s32 offen offset:3072 lds
  s_add_u32 s20, s16, 3
  s_and_b32 s20, s20, 3
  s_mul_i32 s21, s20, 65600
  s_lshl_b32 s20, s20, 12
  s_add_u32 s51, s20, s25
  s_mov_b32 m0, s51
  v_xor_b32 v28, s21, v12
  buffer_load_dwordx4 v28, s[60:63], s32 offen offset:0 lds
  v_xor_b32 v29, s21, v13
  buffer_load_dwordx4 v29, s[60:63], s32 offen offset:1024 lds
  v_xor_b32 v30, s21, v14
  buffer_load_dwordx4 v30, s[60:63], s32 offen offset:2048 lds
  v_xor_b32 v31, s21, v15
  buffer_load_dwordx4 v31, s[60:63], s32 offen offset:3072 lds
  s_cmp_eq_u32 s16, 3
  s_cbranch_scc1 aj_np1
  s_add_u32 m0, s48, 16384
  s_nop 0
  buffer_load_dwordx4 v16, s[60:63], s33 offen offset:0 lds
  buffer_load_dwordx4 v17, s[60:63], s33 offen offset:1024 lds
  buffer_load_dwordx4 v18, s[60:63], s33 offen offset:2048 lds
  buffer_load_dwordx4 v19, s[60:63], s33 offen offset:3072 lds
  s_add_u32 m0, s49, 16384
  s_nop 0
  buffer_load_dwordx4 v20, s[60:63], s33 offen offset:0 lds
  buffer_load_dwordx4 v21, s[60:63], s33 offen offset:1024 lds
  buffer_load_dwordx4 v22, s[60:63], s33 offen offset:2048 lds
  buffer_load_dwordx4 v23, s[60:63], s33 offen offset:3072 lds
  s_add_u32 m0, s50, 16384
  s_nop 0
  buffer_load_dwordx4 v24, s[60:63], s33 offen offset:0 lds
  buffer_load_dwordx4 v25, s[60:63], s33 offen offset:1024 lds
  buffer_load_dwordx4 v26, s[60:63], s33 offen offset:2048 lds
  buffer_load_dwordx4 v27, s[60:63], s33 offen offset:3072 lds
  s_add_u32 m0, s51, 16384
  s_nop 0
  buffer_load_dwordx4 v28, s[60:63], s33 offen offset:0 lds
  buffer_load_dwordx4 v29, s[60:63], s33 offen offset:1024 lds
  buffer_load_dwordx4 v30, s[60:63], s33 offen offset:2048 lds
  buffer_load_dwordx4 v31, s[60:63], s33 offen offset:3072 lds
aj_np1:
  s_mov_b32 s79, 0
aj_run:
  s_mul_i32 s30, s17, 401408
  s_mul_i32 s20, s19, 57344
  s_add_u32 s30, s30, s20
  v_add_u32 v12, s30, v2
  v_add_u32 v13, 14336, v12
  v_add_u32 v14, 28672, v12
  v_add_u32 v15, 43008, v12
  v_lshrrev_b32 v7, 2, v4
  v_lshlrev_b32 v7, 3, v7
  v_and_b32 v8, 3, v4
  v_add_u32 v7, v7, v8
  v_xor_b32 v10, v3, v4
  v_lshlrev_b32 v10, 4, v10
  v_lshl_add_u32 v10, v7, 9, v10
  v_add_u32 v10, s25, v10
  v_xor_b32 v32, 0, v10
  v_xor_b32 v33, 64, v10
  v_xor_b32 v34, 128, v10
  v_xor_b32 v35, 192, v10
  v_and_b32 v8, 2, v4
  v_lshlrev_b32 v8, 1, v8
  v_and_b32 v9, 1, v4
  v_add_u32 v8, v8, v9
  v_lshrrev_b32 v7, 2, v4
  v_lshl_add_u32 v7, v7, 4, v8
  v_xor_b32 v8, v8, v3
  v_lshlrev_b32 v8, 4, v8
  v_lshl_add_u32 v7, v7, 9, v8
  s_mov_b32 s24, 1035512379
  s_waitcnt vmcnt(32)
  s_cmp_lg_u32 s16, 3
  s_cbranch_scc1 w3_35
  s_waitcnt vmcnt(16)
w3_35:
  s_barrier
  v_xor_b32 v8, 0, v7
  ds_read_b128 v[128:131], v8 offset:0
  v_xor_b32 v9, 64, v7
  ds_read_b128 v[132:135], v9 offset:0
  v_xor_b32 v10, 128, v7
  ds_read_b128 v[136:139], v10 offset:0
  v_xor_b32 v11, 192, v7
  ds_read_b128 v[140:143], v11 offset:0
  ds_read_b128 v[144:147], v8 offset:256
  ds_read_b128 v[148:151], v9 offset:256
  ds_read_b128 v[152:155], v10 offset:256
  ds_read_b128 v[156:159], v11 offset:256
  s_waitcnt lgkmcnt(4)
  v_xor_b32 v8, 32, v7
  ds_read_b128 v[160:163], v8 offset:1024
  v_xor_b32 v9, 96, v7
  ds_read_b128 v[164:167], v9 offset:1024
  v_xor_b32 v10, 160, v7
  ds_read_b128 v[168:171], v10 offset:1024
  v_xor_b32 v11, 224, v7
  ds_read_b128 v[172:175], v11 offset:1024
  ds_read_b128 v[176:179], v8 offset:1280
  ds_read_b128 v[180:183], v9 offset:1280
  ds_read_b128 v[184:187], v10 offset:1280
  ds_read_b128 v[188:191], v11 offset:1280
  s_waitcnt lgkmcnt(4)
  v_xor_b32 v8, 128, v7
  ds_read_b128 v[192:195], v8 offset:4096
  v_xor_b32 v9, 192, v7
  ds_read_b128 v[196:199], v9 offset:4096
  v_xor_b32 v10, 0, v7
  ds_read_b128 v[200:203], v10 offset:4096
  v_xor_b32 v11, 64, v7
  ds_read_b128 v[204:207], v11 offset:4096
  ds_read_b128 v[208:211], v8 offset:4352
  ds_read_b128 v[212:215], v9 offset:4352
  ds_read_b128 v[216:219], v10 offset:4352
  ds_read_b128 v[220:223], v11 offset:4352
  s_waitcnt lgkmcnt(4)
  v_xor_b32 v8, 160, v7
  ds_read_b128 v[224:227], v8 offset:5120
  v_xor_b32 v9, 224, v7
  ds_read_b128 v[228:231], v9 offset:5120
  v_xor_b32 v10, 32, v7
  ds_read_b128 v[232:235], v10 offset:5120
  v_xor_b32 v11, 96, v7
  ds_read_b128 v[236:239], v11 offset:5120
  ds_read_b128 v[240:243], v8 offset:5376
  ds_read_b128 v[244:247], v9 offset:5376
  ds_read_b128 v[248:251], v10 offset:5376
  ds_read_b128 v[252:255], v11 offset:5376
  s_waitcnt lgkmcnt(4)
  s_waitcnt vmcnt(16) lgkmcnt(0)
  s_cmp_lg_u32 s16, 3
  s_cbranch_scc1 w3_36
  s_waitcnt vmcnt(0)
w3_36:
  ds_read_b128 v[52:55], v32 offset:0
  ds_read_b128 v[56:59], v33 offset:0
  ds_read_b128 v[60:63], v34 offset:0
  ds_read_b128 v[64:67], v35 offset:0
  s_waitcnt lgkmcnt(3)
  v_mfma_f32_16x16x32_bf16 v[96:99], v[52:55], v[128:131], 0
  v_mfma_f32_16x16x32_bf16 v[100:103], v[52:55], v[160:163], 0
  v_mfma_f32_16x16x32_bf16 v[104:107], v[52:55], v[192:195], 0
  v_mfma_f32_16x16x32_bf16 v[108:111], v[52:55], v[224:227], 0
  ds_read_b128 v[52:55], v32 offset:256
  s_waitcnt lgkmcnt(3)
  v_mfma_f32_16x16x32_bf16 v[96:99], v[56:59], v[132:135], v[96:99]
  v_mfma_f32_16x16x32_bf16 v[100:103], v[56:59], v[164:167], v[100:103]
  v_mfma_f32_16x16x32_bf16 v[104:107], v[56:59], v[196:199], v[104:107]
  v_mfma_f32_16x16x32_bf16 v[108:111], v[56:59], v[228:231], v[108:111]
  ds_read_b128 v[56:59], v33 offset:256
  s_waitcnt lgkmcnt(3)
  v_mfma_f32_16x16x32_bf16 v[96:99], v[60:63], v[136:139], v[96:99]
  v_mfma_f32_16x16x32_bf16 v[100:103], v[60:63], v[168:171], v[100:103]
  v_mfma_f32_16x16x32_bf16 v[104:107], v[60:63], v[200:203], v[104:107]
  v_mfma_f32_16x16x32_bf16 v[108:111], v[60:63], v[232:235], v[108:111]
  ds_read_b128 v[60:63], v34 offset:256
  s_waitcnt lgkmcnt(3)
  v_mfma_f32_16x16x32_bf16 v[96:99], v[64:67], v[140:143], v[96:99]
  v_mfma_f32_16x16x32_bf16 v[100:103], v[64:67], v[172:175], v[100:103]
  v_mfma_f32_16x16x32_bf16 v[104:107], v[64:67], v[204:207], v[104:107]
  v_mfma_f32_16x16x32_bf16 v[108:111], v[64:67], v[236:239], v[108:111]
  ds_read_b128 v[64:67], v35 offset:256
  s_waitcnt lgkmcnt(3)
  v_mfma_f32_16x16x32_bf16 v[96:99], v[52:55], v[144:147], v[96:99]
  v_mfma_f32_16x16x32_bf16 v[100:103], v[52:55], v[176:179], v[100:103]
  v_mfma_f32_16x16x32_bf16 v[104:107], v[52:55], v[208:211], v[104:107]
  v_mfma_f32_16x16x32_bf16 v[108:111], v[52:55], v[240:243], v[108:111]
  ds_read_b128 v[52:55], v32 offset:2048
  s_waitcnt lgkmcnt(3)
  v_mfma_f32_16x16x32_bf16 v[96:99], v[56:59], v[148:151], v[96:99]
  v_mfma_f32_16x16x32_bf16 v[100:103], v[56:59], v[180:183], v[100:103]
  v_mfma_f32_16x16x32_bf16 v[104:107], v[56:59], v[212:215], v[104:107]
  v_mfma_f32_16x16x32_bf16 v[108:111], v[56:59], v[244:247], v[108:111]
  ds_read_b128 v[56:59], v33 offset:2048
  s_waitcnt lgkmcnt(3)
  v_mfma_f32_16x16x32_bf16 v[96:99], v[60:63], v[152:155], v[96:99]
  v_mfma_f32_16x16x32_bf16 v[100:103], v[60:63], v[184:187], v[100:103]
  v_mfma_f32_16x16x32_bf16 v[104:107], v[60:63], v[216:219], v[104:107]
  v_mfma_f32_16x16x32_bf16 v[108:111], v[60:63], v[248:251], v[108:111]
  ds_read_b128 v[60:63], v34 offset:2048
  s_waitcnt lgkmcnt(3)
  v_mfma_f32_16x16x32_bf16 v[96:99], v[64:67], v[156:159], v[96:99]
  v_mfma_f32_16x16x32_bf16 v[100:103], v[64:67], v[188:191], v[100:103]
  v_mfma_f32_16x16x32_bf16 v[104:107], v[64:67], v[220:223], v[104:107]
  v_mfma_f32_16x16x32_bf16 v[108:111], v[64:67], v[252:255], v[108:111]
  ds_read_b128 v[64:67], v35 offset:2048
  s_waitcnt lgkmcnt(3)
  v_mfma_f32_16x16x32_bf16 v[112:115], v[52:55], v[128:131], 0
  v_mfma_f32_16x16x32_bf16 v[116:119], v[52:55], v[160:163], 0
  v_mfma_f32_16x16x32_bf16 v[120:123], v[52:55], v[192:195], 0
  v_mfma_f32_16x16x32_bf16 v[124:127], v[52:55], v[224:227], 0
  ds_read_b128 v[52:55], v32 offset:2304
  s_waitcnt lgkmcnt(3)
  v_mfma_f32_16x16x32_bf16 v[112:115], v[56:59], v[132:135], v[112:115]
  v_mfma_f32_16x16x32_bf16 v[116:119], v[56:59], v[164:167], v[116:119]
  v_mfma_f32_16x16x32_bf16 v[120:123], v[56:59], v[196:199], v[120:123]
  v_mfma_f32_16x16x32_bf16 v[124:127], v[56:59], v[228:231], v[124:127]
  ds_read_b128 v[56:59], v33 offset:2304
  s_waitcnt lgkmcnt(3)
  v_mfma_f32_16x16x32_bf16 v[112:115], v[60:63], v[136:139], v[112:115]
  v_mfma_f32_16x16x32_bf16 v[116:119], v[60:63], v[168:171], v[116:119]
  v_mfma_f32_16x16x32_bf16 v[120:123], v[60:63], v[200:203], v[120:123]
  v_mfma_f32_16x16x32_bf16 v[124:127], v[60:63], v[232:235], v[124:127]
  ds_read_b128 v[60:63], v34 offset:2304
  s_waitcnt lgkmcnt(3)
  v_mfma_f32_16x16x32_bf16 v[112:115], v[64:67], v[140:143], v[112:115]
  v_mfma_f32_16x16x32_bf16 v[116:119], v[64:67], v[172:175], v[116:119]
  v_mfma_f32_16x16x32_bf16 v[120:123], v[64:67], v[204:207], v[120:123]
  v_mfma_f32_16x16x32_bf16 v[124:127], v[64:67], v[236:239], v[124:127]
  ds_read_b128 v[64:67], v35 offset:2304
  s_waitcnt lgkmcnt(3)
  v_mfma_f32_16x16x32_bf16 v[112:115], v[52:55], v[144:147], v[112:115]
  v_mfma_f32_16x16x32_bf16 v[116:119], v[52:55], v[176:179], v[116:119]
  v_mfma_f32_16x16x32_bf16 v[120:123], v[52:55], v[208:211], v[120:123]
  v_mfma_f32_16x16x32_bf16 v[124:127], v[52:55], v[240:243], v[124:127]
  s_waitcnt lgkmcnt(2)
  v_mfma_f32_16x16x32_bf16 v[112:115], v[56:59], v[148:151], v[112:115]
  v_mfma_f32_16x16x32_bf16 v[116:119], v[56:59], v[180:183], v[116:119]
  v_mfma_f32_16x16x32_bf16 v[120:123], v[56:59], v[212:215], v[120:123]
  v_mfma_f32_16x16x32_bf16 v[124:127], v[56:59], v[244:247], v[124:127]
  s_waitcnt lgkmcnt(1)
  v_mfma_f32_16x16x32_bf16 v[112:115], v[60:63], v[152:155], v[112:115]
  v_mfma_f32_16x16x32_bf16 v[116:119], v[60:63], v[184:187], v[116:119]
  v_mfma_f32_16x16x32_bf16 v[120:123], v[60:63], v[216:219], v[120:123]
  v_mfma_f32_16x16x32_bf16 v[124:127], v[60:63], v[248:251], v[124:127]
  s_waitcnt lgkmcnt(0)
  v_mfma_f32_16x16x32_bf16 v[112:115], v[64:67], v[156:159], v[112:115]
  v_mfma_f32_16x16x32_bf16 v[116:119], v[64:67], v[188:191], v[116:119]
  v_mfma_f32_16x16x32_bf16 v[120:123], v[64:67], v[220:223], v[120:123]
  v_mfma_f32_16x16x32_bf16 v[124:127], v[64:67], v[252:255], v[124:127]
  s_lshl_b32 s30, s28, 10
  v_mul_f32 v96, s24, v96
  v_mul_f32 v97, s24, v97
  v_mul_f32 v98, s24, v98
  v_mul_f32 v99, s24, v99
  v_cvt_pk_bf16_f32 v68, v96, v97
  v_cvt_pk_bf16_f32 v69, v98, v99
  v_mul_f32 v112, s24, v112
  v_mul_f32 v113, s24, v113
  v_mul_f32 v114, s24, v114
  v_mul_f32 v115, s24, v115
  v_cvt_pk_bf16_f32 v70, v112, v113
  v_cvt_pk_bf16_f32 v71, v114, v115
  buffer_store_dwordx4 v[68:71], v12, s[8:11], s30 offen sc1
  v_mul_f32 v100, s24, v100
  v_mul_f32 v101, s24, v101
  v_mul_f32 v102, s24, v102
  v_mul_f32 v103, s24, v103
  v_cvt_pk_bf16_f32 v72, v100, v101
  v_cvt_pk_bf16_f32 v73, v102, v103
  v_mul_f32 v116, s24, v116
  v_mul_f32 v117, s24, v117
  v_mul_f32 v118, s24, v118
  v_mul_f32 v119, s24, v119
  v_cvt_pk_bf16_f32 v74, v116, v117
  v_cvt_pk_bf16_f32 v75, v118, v119
  buffer_store_dwordx4 v[72:75], v13, s[8:11], s30 offen sc1
  v_mul_f32 v104, s24, v104
  v_mul_f32 v105, s24, v105
  v_mul_f32 v106, s24, v106
  v_mul_f32 v107, s24, v107
  v_cvt_pk_bf16_f32 v76, v104, v105
  v_cvt_pk_bf16_f32 v77, v106, v107
  v_mul_f32 v120, s24, v120
  v_mul_f32 v121, s24, v121
  v_mul_f32 v122, s24, v122
  v_mul_f32 v123, s24, v123
  v_cvt_pk_bf16_f32 v78, v120, v121
  v_cvt_pk_bf16_f32 v79, v122, v123
  buffer_store_dwordx4 v[76:79], v14, s[8:11], s30 offen sc1
  v_mul_f32 v108, s24, v108
  v_mul_f32 v109, s24, v109
  v_mul_f32 v110, s24, v110
  v_mul_f32 v111, s24, v111
  v_cvt_pk_bf16_f32 v80, v108, v109
  v_cvt_pk_bf16_f32 v81, v110, v111
  v_mul_f32 v124, s24, v124
  v_mul_f32 v125, s24, v125
  v_mul_f32 v126, s24, v126
  v_mul_f32 v127, s24, v127
  v_cvt_pk_bf16_f32 v82, v124, v125
  v_cvt_pk_bf16_f32 v83, v126, v127
  buffer_store_dwordx4 v[80:83], v15, s[8:11], s30 offen sc1
  s_cmp_eq_u32 s16, 3
  s_cbranch_scc1 aj_w3
  s_waitcnt vmcnt(4)
  ds_read_b128 v[52:55], v32 offset:16384
  ds_read_b128 v[56:59], v33 offset:16384
  ds_read_b128 v[60:63], v34 offset:16384
  ds_read_b128 v[64:67], v35 offset:16384
  s_waitcnt lgkmcnt(3)
  v_mfma_f32_16x16x32_bf16 v[96:99], v[52:55], v[128:131], 0
  v_mfma_f32_16x16x32_bf16 v[100:103], v[52:55], v[160:163], 0
  v_mfma_f32_16x16x32_bf16 v[104:107], v[52:55], v[192:195], 0
  v_mfma_f32_16x16x32_bf16 v[108:111], v[52:55], v[224:227], 0
  ds_read_b128 v[52:55], v32 offset:16640
  s_waitcnt lgkmcnt(3)
  v_mfma_f32_16x16x32_bf16 v[96:99], v[56:59], v[132:135], v[96:99]
  v_mfma_f32_16x16x32_bf16 v[100:103], v[56:59], v[164:167], v[100:103]
  v_mfma_f32_16x16x32_bf16 v[104:107], v[56:59], v[196:199], v[104:107]
  v_mfma_f32_16x16x32_bf16 v[108:111], v[56:59], v[228:231], v[108:111]
  ds_read_b128 v[56:59], v33 offset:16640
  s_waitcnt lgkmcnt(3)
  v_mfma_f32_16x16x32_bf16 v[96:99], v[60:63], v[136:139], v[96:99]
  v_mfma_f32_16x16x32_bf16 v[100:103], v[60:63], v[168:171], v[100:103]
  v_mfma_f32_16x16x32_bf16 v[104:107], v[60:63], v[200:203], v[104:107]
  v_mfma_f32_16x16x32_bf16 v[108:111], v[60:63], v[232:235], v[108:111]
  ds_read_b128 v[60:63], v34 offset:16640
  s_waitcnt lgkmcnt(3)
  v_mfma_f32_16x16x32_bf16 v[96:99], v[64:67], v[140:143], v[96:99]
  v_mfma_f32_16x16x32_bf16 v[100:103], v[64:67], v[172:175], v[100:103]
  v_mfma_f32_16x16x32_bf16 v[104:107], v[64:67], v[204:207], v[104:107]
  v_mfma_f32_16x16x32_bf16 v[108:111], v[64:67], v[236:239], v[108:111]
  ds_read_b128 v[64:67], v35 offset:16640
  s_waitcnt lgkmcnt(3)
  v_mfma_f32_16x16x32_bf16 v[96:99], v[52:55], v[144:147], v[96:99]
  v_mfma_f32_16x16x32_bf16 v[100:103], v[52:55], v[176:179], v[100:103]
  v_mfma_f32_16x16x32_bf16 v[104:107], v[52:55], v[208:211], v[104:107]
  v_mfma_f32_16x16x32_bf16 v[108:111], v[52:55], v[240:243], v[108:111]
  ds_read_b128 v[52:55], v32 offset:18432
  s_waitcnt lgkmcnt(3)
  v_mfma_f32_16x16x32_bf16 v[96:99], v[56:59], v[148:151], v[96:99]
  v_mfma_f32_16x16x32_bf16 v[100:103], v[56:59], v[180:183], v[100:103]
  v_mfma_f32_16x16x32_bf16 v[104:107], v[56:59], v[212:215], v[104:107]
  v_mfma_f32_16x16x32_bf16 v[108:111], v[56:59], v[244:247], v[108:111]
  ds_read_b128 v[56:59], v33 offset:18432
  s_waitcnt lgkmcnt(3)
  v_mfma_f32_16x16x32_bf16 v[96:99], v[60:63], v[152:155], v[96:99]
  v_mfma_f32_16x16x32_bf16 v[100:103], v[60:63], v[184:187], v[100:103]
  v_mfma_f32_16x16x32_bf16 v[104:107], v[60:63], v[216:219], v[104:107]
  v_mfma_f32_16x16x32_bf16 v[108:111], v[60:63], v[248:251], v[108:111]
  ds_read_b128 v[60:63], v34 offset:18432
  s_waitcnt lgkmcnt(3)
  v_mfma_f32_16x16x32_bf16 v[96:99], v[64:67], v[156:159], v[96:99]
  v_mfma_f32_16x16x32_bf16 v[100:103], v[64:67], v[188:191], v[100:103]
  v_mfma_f32_16x16x32_bf16 v[104:107], v[64:67], v[220:223], v[104:107]
  v_mfma_f32_16x16x32_bf16 v[108:111], v[64:67], v[252:255], v[108:111]
  ds_read_b128 v[64:67], v35 offset:18432
  s_waitcnt lgkmcnt(3)
  v_mfma_f32_16x16x32_bf16 v[112:115], v[52:55], v[128:131], 0
  v_mfma_f32_16x16x32_bf16 v[116:119], v[52:55], v[160:163], 0
  v_mfma_f32_16x16x32_bf16 v[120:123], v[52:55], v[192:195], 0
  v_mfma_f32_16x16x32_bf16 v[124:127], v[52:55], v[224:227], 0
  ds_read_b128 v[52:55], v32 offset:18688
  s_waitcnt lgkmcnt(3)
  v_mfma_f32_16x16x32_bf16 v[112:115], v[56:59], v[132:135], v[112:115]
  v_mfma_f32_16x16x32_bf16 v[116:119], v[56:59], v[164:167], v[116:119]
  v_mfma_f32_16x16x32_bf16 v[120:123], v[56:59], v[196:199], v[120:123]
  v_mfma_f32_16x16x32_bf16 v[124:127], v[56:59], v[228:231], v[124:127]
  ds_read_b128 v[56:59], v33 offset:18688
  s_waitcnt lgkmcnt(3)
  v_mfma_f32_16x16x32_bf16 v[112:115], v[60:63], v[136:139], v[112:115]
  v_mfma_f32_16x16x32_bf16 v[116:119], v[60:63], v[168:171], v[116:119]
  v_mfma_f32_16x16x32_bf16 v[120:123], v[60:63], v[200:203], v[120:123]
  v_mfma_f32_16x16x32_bf16 v[124:127], v[60:63], v[232:235], v[124:127]
  ds_read_b128 v[60:63], v34 offset:18688
  s_waitcnt lgkmcnt(3)
  v_mfma_f32_16x16x32_bf16 v[112:115], v[64:67], v[140:143], v[112:115]
  v_mfma_f32_16x16x32_bf16 v[116:119], v[64:67], v[172:175], v[116:119]
  v_mfma_f32_16x16x32_bf16 v[120:123], v[64:67], v[204:207], v[120:123]
  v_mfma_f32_16x16x32_bf16 v[124:127], v[64:67], v[236:239], v[124:127]
  ds_read_b128 v[64:67], v35 offset:18688
  s_waitcnt lgkmcnt(3)
  v_mfma_f32_16x16x32_bf16 v[112:115], v[52:55], v[144:147], v[112:115]
  v_mfma_f32_16x16x32_bf16 v[116:119], v[52:55], v[176:179], v[116:119]
  v_mfma_f32_16x16x32_bf16 v[120:123], v[52:55], v[208:211], v[120:123]
  v_mfma_f32_16x16x32_bf16 v[124:127], v[52:55], v[240:243], v[124:127]
  s_waitcnt lgkmcnt(2)
  v_mfma_f32_16x16x32_bf16 v[112:115], v[56:59], v[148:151], v[112:115]
  v_mfma_f32_16x16x32_bf16 v[116:119], v[56:59], v[180:183], v[116:119]
  v_mfma_f32_16x16x32_bf16 v[120:123], v[56:59], v[212:215], v[120:123]
  v_mfma_f32_16x16x32_bf16 v[124:127], v[56:59], v[244:247], v[124:127]
  s_waitcnt lgkmcnt(1)
  v_mfma_f32_16x16x32_bf16 v[112:115], v[60:63], v[152:155], v[112:115]
  v_mfma_f32_16x16x32_bf16 v[116:119], v[60:63], v[184:187], v[116:119]
  v_mfma_f32_16x16x32_bf16 v[120:123], v[60:63], v[216:219], v[120:123]
  v_mfma_f32_16x16x32_bf16 v[124:127], v[60:63], v[248:251], v[124:127]
  s_waitcnt lgkmcnt(0)
  v_mfma_f32_16x16x32_bf16 v[112:115], v[64:67], v[156:159], v[112:115]
  v_mfma_f32_16x16x32_bf16 v[116:119], v[64:67], v[188:191], v[116:119]
  v_mfma_f32_16x16x32_bf16 v[120:123], v[64:67], v[220:223], v[120:123]
  v_mfma_f32_16x16x32_bf16 v[124:127], v[64:67], v[252:255], v[124:127]
  s_lshl_b32 s30, s29, 10
  v_mul_f32 v96, s24, v96
  v_mul_f32 v97, s24, v97
  v_mul_f32 v98, s24, v98
  v_mul_f32 v99, s24, v99
  v_cvt_pk_bf16_f32 v68, v96, v97
  v_cvt_pk_bf16_f32 v69, v98, v99
  v_mul_f32 v112, s24, v112
  v_mul_f32 v113, s24, v113
  v_mul_f32 v114, s24, v114
  v_mul_f32 v115, s24, v115
  v_cvt_pk_bf16_f32 v70, v112, v113
  v_cvt_pk_bf16_f32 v71, v114, v115
  buffer_store_dwordx4 v[68:71], v12, s[8:11], s30 offen sc1
  v_mul_f32 v100, s24, v100
  v_mul_f32 v101, s24, v101
  v_mul_f32 v102, s24, v102
  v_mul_f32 v103, s24, v103
  v_cvt_pk_bf16_f32 v72, v100, v101
  v_cvt_pk_bf16_f32 v73, v102, v103
  v_mul_f32 v116, s24, v116
  v_mul_f32 v117, s24, v117
  v_mul_f32 v118, s24, v118
  v_mul_f32 v119, s24, v119
  v_cvt_pk_bf16_f32 v74, v116, v117
  v_cvt_pk_bf16_f32 v75, v118, v119
  buffer_store_dwordx4 v[72:75], v13, s[8:11], s30 offen sc1
  v_mul_f32 v104, s24, v104
  v_mul_f32 v105, s24, v105
  v_mul_f32 v106, s24, v106
  v_mul_f32 v107, s24, v107
  v_cvt_pk_bf16_f32 v76, v104, v105
  v_cvt_pk_bf16_f32 v77, v106, v107
  v_mul_f32 v120, s24, v120
  v_mul_f32 v121, s24, v121
  v_mul_f32 v122, s24, v122
  v_mul_f32 v123, s24, v123
  v_cvt_pk_bf16_f32 v78, v120, v121
  v_cvt_pk_bf16_f32 v79, v122, v123
  buffer_store_dwordx4 v[76:79], v14, s[8:11], s30 offen sc1
  v_mul_f32 v108, s24, v108
  v_mul_f32 v109, s24, v109
  v_mul_f32 v110, s24, v110
  v_mul_f32 v111, s24, v111
  v_cvt_pk_bf16_f32 v80, v108, v109
  v_cvt_pk_bf16_f32 v81, v110, v111
  v_mul_f32 v124, s24, v124
  v_mul_f32 v125, s24, v125
  v_mul_f32 v126, s24, v126
  v_mul_f32 v127, s24, v127
  v_cvt_pk_bf16_f32 v82, v124, v125
  v_cvt_pk_bf16_f32 v83, v126, v127
  buffer_store_dwordx4 v[80:83], v15, s[8:11], s30 offen sc1
aj_w3:
  s_lshl_b32 s28, s17, 7
  s_lshl_b32 s21, s19, 4
  s_add_u32 s28, s28, s21
  s_cmp_lg_u32 s31, 0
  s_cselect_b32 s21, 8, 0
  s_add_u32 s28, s28, s21
  s_add_u32 s28, s28, 88621056
  s_waitcnt vmcnt(0)
  s_barrier
  s_cmp_lg_u32 s16, 0
  s_cbranch_scc1 pub_37
  v_mul_u32_u24 v26, 2048, v1
  v_mov_b32 v24, s88
  v_mov_b32 v25, s89
  s_mov_b64 exec, 1
  buffer_store_dwordx2 v[24:25], v26, s[8:11], s28 offen sc1
  s_mov_b64 exec, -1
pub_37:
  s_cmp_lg_u32 s79, 0
  s_cbranch_scc1 bj_end
  v_mov_b32 v250, 0
  s_branch wk_loop
wk_srv:
  s_sub_u32 s3, s3, 336
  s_and_b32 s18, s3, 15
  s_lshr_b32 s19, s3, 4
  s_and_b32 s19, s19, 1
  s_mul_i32 s20, s18, 401408
  s_mul_i32 s21, s16, 100352
  s_add_u32 s20, s20, s21
  s_add_u32 s20, s20, 6422528
  s_add_u32 s22, s20, 0
  buffer_load_dwordx4 a[0:3], v2, s[8:11], s22 offen offset:0 sc1
  buffer_load_dwordx4 a[4:7], v2, s[8:11], s22 offen offset:1024 sc1
  buffer_load_dwordx4 a[8:11], v2, s[8:11], s22 offen offset:2048 sc1
  buffer_load_dwordx4 a[12:15], v2, s[8:11], s22 offen offset:3072 sc1
  s_add_u32 s22, s20, 4096
  buffer_load_dwordx4 a[16:19], v2, s[8:11], s22 offen offset:0 sc1
  buffer_load_dwordx4 a[20:23], v2, s[8:11], s22 offen offset:1024 sc1
  buffer_load_dwordx4 a[24:27], v2, s[8:11], s22 offen offset:2048 sc1
  buffer_load_dwordx4 a[28:31], v2, s[8:11], s22 offen offset:3072 sc1
  s_add_u32 s22, s20, 8192
  buffer_load_dwordx4 a[32:35], v2, s[8:11], s22 offen offset:0 sc1
  buffer_load_dwordx4 a[36:39], v2, s[8:11], s22 offen offset:1024 sc1
  buffer_load_dwordx4 a[40:43], v2, s[8:11], s22 offen offset:2048 sc1
  buffer_load_dwordx4 a[44:47], v2, s[8:11], s22 offen offset:3072 sc1
  s_add_u32 s22, s20, 12288
  buffer_load_dwordx4 a[48:51], v2, s[8:11], s22 offen offset:0 sc1
  buffer_load_dwordx4 a[52:55], v2, s[8:11], s22 offen offset:1024 sc1
  buffer_load_dwordx4 a[56:59], v2, s[8:11], s22 offen offset:2048 sc1
  buffer_load_dwordx4 a[60:63], v2, s[8:11], s22 offen offset:3072 sc1
  s_add_u32 s22, s20, 16384
  buffer_load_dwordx4 a[64:67], v2, s[8:11], s22 offen offset:0 sc1
  buffer_load_dwordx4 a[68:71], v2, s[8:11], s22 offen offset:1024 sc1
  buffer_load_dwordx4 a[72:75], v2, s[8:11], s22 offen offset:2048 sc1
  buffer_load_dwordx4 a[76:79], v2, s[8:11], s22 offen offset:3072 sc1
  s_add_u32 s22, s20, 20480
  buffer_load_dwordx4 a[80:83], v2, s[8:11], s22 offen offset:0 sc1
  buffer_load_dwordx4 a[84:87], v2, s[8:11], s22 offen offset:1024 sc1
  buffer_load_dwordx4 a[88:91], v2, s[8:11], s22 offen offset:2048 sc1
  buffer_load_dwordx4 a[92:95], v2, s[8:11], s22 offen offset:3072 sc1
  s_add_u32 s22, s20, 24576
  buffer_load_dwordx4 a[96:99], v2, s[8:11], s22 offen offset:0 sc1
  buffer_load_dwordx4 a[100:103], v2, s[8:11], s22 offen offset:1024 sc1
  buffer_load_dwordx4 a[104:107], v2, s[8:11], s22 offen offset:2048 sc1
  buffer_load_dwordx4 a[108:111], v2, s[8:11], s22 offen offset:3072 sc1
  s_add_u32 s22, s20, 28672
  buffer_load_dwordx4 a[112:115], v2, s[8:11], s22 offen offset:0 sc1
  buffer_load_dwordx4 a[116:119], v2, s[8:11], s22 offen offset:1024 sc1
  buffer_load_dwordx4 a[120:123], v2, s[8:11], s22 offen offset:2048 sc1
  buffer_load_dwordx4 a[124:127], v2, s[8:11], s22 offen offset:3072 sc1
  s_waitcnt vmcnt(24)
  s_add_u32 s22, s20, 32768
  buffer_load_dwordx4 a[128:131], v2, s[8:11], s22 offen offset:0 sc1
  buffer_load_dwordx4 a[132:135], v2, s[8:11], s22 offen offset:1024 sc1
  buffer_load_dwordx4 a[136:139], v2, s[8:11], s22 offen offset:2048 sc1
  buffer_load_dwordx4 a[140:143], v2, s[8:11], s22 offen offset:3072 sc1
  s_add_u32 s22, s20, 36864
  buffer_load_dwordx4 a[144:147], v2, s[8:11], s22 offen offset:0 sc1
  buffer_load_dwordx4 a[148:151], v2, s[8:11], s22 offen offset:1024 sc1
  buffer_load_dwordx4 a[152:155], v2, s[8:11], s22 offen offset:2048 sc1
  buffer_load_dwordx4 a[156:159], v2, s[8:11], s22 offen offset:3072 sc1
  s_add_u32 s22, s20, 40960
  buffer_load_dwordx4 a[160:163], v2, s[8:11], s22 offen offset:0 sc1
  buffer_load_dwordx4 a[164:167], v2, s[8:11], s22 offen offset:1024 sc1
  buffer_load_dwordx4 a[168:171], v2, s[8:11], s22 offen offset:2048 sc1
  buffer_load_dwordx4 a[172:175], v2, s[8:11], s22 offen offset:3072 sc1
  s_add_u32 s22, s20, 45056
  buffer_load_dwordx4 a[176:179], v2, s[8:11], s22 offen offset:0 sc1
  buffer_load_dwordx4 a[180:183], v2, s[8:11], s22 offen offset:1024 sc1
  buffer_load_dwordx4 a[184:187], v2, s[8:11], s22 offen offset:2048 sc1
  buffer_load_dwordx4 a[188:191], v2, s[8:11], s22 offen offset:3072 sc1
  s_add_u32 s22, s20, 49152
  buffer_load_dwordx4 a[192:195], v2, s[8:11], s22 offen offset:0 sc1
  buffer_load_dwordx4 a[196:199], v2, s[8:11], s22 offen offset:1024 sc1
  buffer_load_dwordx4 a[200:203], v2, s[8:11], s22 offen offset:2048 sc1
  buffer_load_dwordx4 a[204:207], v2, s[8:11], s22 offen offset:3072 sc1
  s_add_u32 s22, s20, 53248
  buffer_load_dwordx4 a[208:211], v2, s[8:11], s22 offen offset:0 sc1
  buffer_load_dwordx4 a[212:215], v2, s[8:11], s22 offen offset:1024 sc1
  buffer_load_dwordx4 a[216:219], v2, s[8:11], s22 offen offset:2048 sc1
  buffer_load_dwordx4 a[220:223], v2, s[8:11], s22 offen offset:3072 sc1
  s_add_u32 s22, s20, 57344
  buffer_load_dwordx4 a[224:227], v2, s[8:11], s22 offen offset:0 sc1
  buffer_load_dwordx4 a[228:231], v2, s[8:11], s22 offen offset:1024 sc1
  buffer_load_dwordx4 a[232:235], v2, s[8:11], s22 offen offset:2048 sc1
  buffer_load_dwordx4 a[236:239], v2, s[8:11], s22 offen offset:3072 sc1
  s_add_u32 s22, s20, 61440
  buffer_load_dwordx4 a[240:243], v2, s[8:11], s22 offen offset:0 sc1
  buffer_load_dwordx4 a[244:247], v2, s[8:11], s22 offen offset:1024 sc1
  buffer_load_dwordx4 a[248:251], v2, s[8:11], s22 offen offset:2048 sc1
  buffer_load_dwordx4 a[252:255], v2, s[8:11], s22 offen offset:3072 sc1
  s_waitcnt vmcnt(24)
  s_add_u32 s22, s20, 65536
  buffer_load_dwordx4 v[120:123], v2, s[8:11], s22 offen offset:0 sc1
  buffer_load_dwordx4 v[124:127], v2, s[8:11], s22 offen offset:1024 sc1
  buffer_load_dwordx4 v[128:131], v2, s[8:11], s22 offen offset:2048 sc1
  buffer_load_dwordx4 v[132:135], v2, s[8:11], s22 offen offset:3072 sc1
  s_add_u32 s22, s20, 69632
  buffer_load_dwordx4 v[136:139], v2, s[8:11], s22 offen offset:0 sc1
  buffer_load_dwordx4 v[140:143], v2, s[8:11], s22 offen offset:1024 sc1
  buffer_load_dwordx4 v[144:147], v2, s[8:11], s22 offen offset:2048 sc1
  buffer_load_dwordx4 v[148:151], v2, s[8:11], s22 offen offset:3072 sc1
  s_add_u32 s22, s20, 73728
  buffer_load_dwordx4 v[152:155], v2, s[8:11], s22 offen offset:0 sc1
  buffer_load_dwordx4 v[156:159], v2, s[8:11], s22 offen offset:1024 sc1
  buffer_load_dwordx4 v[160:163], v2, s[8:11], s22 offen offset:2048 sc1
  buffer_load_dwordx4 v[164:167], v2, s[8:11], s22 offen offset:3072 sc1
  s_add_u32 s22, s20, 77824
  buffer_load_dwordx4 v[168:171], v2, s[8:11], s22 offen offset:0 sc1
  buffer_load_dwordx4 v[172:175], v2, s[8:11], s22 offen offset:1024 sc1
  buffer_load_dwordx4 v[176:179], v2, s[8:11], s22 offen offset:2048 sc1
  buffer_load_dwordx4 v[180:183], v2, s[8:11], s22 offen offset:3072 sc1
  s_add_u32 s22, s20, 81920
  buffer_load_dwordx4 v[184:187], v2, s[8:11], s22 offen offset:0 sc1
  buffer_load_dwordx4 v[188:191], v2, s[8:11], s22 offen offset:1024 sc1
  buffer_load_dwordx4 v[192:195], v2, s[8:11], s22 offen offset:2048 sc1
  buffer_load_dwordx4 v[196:199], v2, s[8:11], s22 offen offset:3072 sc1
  s_add_u32 s22, s20, 86016
  buffer_load_dwordx4 v[200:203], v2, s[8:11], s22 offen offset:0 sc1
  buffer_load_dwordx4 v[204:207], v2, s[8:11], s22 offen offset:1024 sc1
  buffer_load_dwordx4 v[208:211], v2, s[8:11], s22 offen offset:2048 sc1
  buffer_load_dwordx4 v[212:215], v2, s[8:11], s22 offen offset:3072 sc1
  s_add_u32 s22, s20, 90112
  buffer_load_dwordx4 v[216:219], v2, s[8:11], s22 offen offset:0 sc1
  buffer_load_dwordx4 v[220:223], v2, s[8:11], s22 offen offset:1024 sc1
  buffer_load_dwordx4 v[224:227], v2, s[8:11], s22 offen offset:2048 sc1
  buffer_load_dwordx4 v[228:231], v2, s[8:11], s22 offen offset:3072 sc1
  s_add_u32 s22, s20, 94208
  buffer_load_dwordx4 v[232:235], v2, s[8:11], s22 offen offset:0 sc1
  buffer_load_dwordx4 v[236:239], v2, s[8:11], s22 offen offset:1024 sc1
  buffer_load_dwordx4 v[240:243], v2, s[8:11], s22 offen offset:2048 sc1
  buffer_load_dwordx4 v[244:247], v2, s[8:11], s22 offen offset:3072 sc1
  s_waitcnt vmcnt(24)
  s_add_u32 s22, s20, 98304
  buffer_load_dwordx4 v[248:251], v2, s[8:11], s22 offen offset:0 sc1
  buffer_load_dwordx4 v[252:255], v2, s[8:11], s22 offen offset:1024 sc1
  v_mov_b32 v5, 0x4444
  v_mov_b32 v6, 0xeeee
  v_cmp_lt_u32 vcc, 7, v4
  s_nop 1
  v_cndmask_b32 v5, v5, v6, vcc
  s_lshl_b32 s23, s16, 11
  v_lshrrev_b32 v80, 1, v3
  v_and_b32 v81, 1, v3
  v_add_u32 v82, 0, v80
  v_lshl_add_u32 v82, v82, 4, v4
  v_mul_u32_u24 v83, 2341, v82
  v_lshrrev_b32 v83, 16, v83
  v_mul_u32_u24 v84, 28, v83
  v_sub_u32 v84, v82, v84
  v_lshrrev_b32 v85, 4, v84
  v_and_b32 v84, 15, v84
  v_lshlrev_b32 v86, 10, v85
  v_lshl_add_u32 v86, v83, 8, v86
  v_lshl_add_u32 v86, v84, 4, v86
  v_lshl_add_u32 v86, v81, 3, v86
  v_add_u32 v72, s23, v86
  v_add_u32 v82, 2, v80
  v_lshl_add_u32 v82, v82, 4, v4
  v_mul_u32_u24 v83, 2341, v82
  v_lshrrev_b32 v83, 16, v83
  v_mul_u32_u24 v84, 28, v83
  v_sub_u32 v84, v82, v84
  v_lshrrev_b32 v85, 4, v84
  v_and_b32 v84, 15, v84
  v_lshlrev_b32 v86, 10, v85
  v_lshl_add_u32 v86, v83, 8, v86
  v_lshl_add_u32 v86, v84, 4, v86
  v_lshl_add_u32 v86, v81, 3, v86
  v_add_u32 v73, s23, v86
  v_add_u32 v82, 4, v80
  v_lshl_add_u32 v82, v82, 4, v4
  v_mul_u32_u24 v83, 2341, v82
  v_lshrrev_b32 v83, 16, v83
  v_mul_u32_u24 v84, 28, v83
  v_sub_u32 v84, v82, v84
  v_lshrrev_b32 v85, 4, v84
  v_and_b32 v84, 15, v84
  v_lshlrev_b32 v86, 10, v85
  v_lshl_add_u32 v86, v83, 8, v86
  v_lshl_add_u32 v86, v84, 4, v86
  v_lshl_add_u32 v86, v81, 3, v86
  v_add_u32 v74, s23, v86
  v_mov_b32 v82, 6
  v_lshl_add_u32 v82, v82, 4, v4
  v_mul_u32_u24 v83, 2341, v82
  v_lshrrev_b32 v83, 16, v83
  v_mul_u32_u24 v84, 28, v83
  v_sub_u32 v84, v82, v84
  v_lshrrev_b32 v85, 4, v84
  v_and_b32 v84, 15, v84
  v_lshlrev_b32 v86, 10, v85
  v_lshl_add_u32 v86, v83, 8, v86
  v_lshl_add_u32 v86, v84, 4, v86
  v_lshl_add_u32 v86, v81, 3, v86
  v_add_u32 v75, s23, v86
  v_add_u32 v76, s23, v2
  s_mul_i32 s27, s18, 448
  v_mov_b32 v77, s27
  v_mov_b32 v78, 1
  s_mov_b32 s17, s19
  s_mul_i32 s24, s19, 7168
  s_add_u32 s24, s24, 88068096
  s_mul_i32 s25, s18, 65
  s_add_u32 s25, s25, s19
  s_lshl_b32 s25, s25, 13
  s_add_u32 s25, s25, s23
  s_add_u32 s25, s25, 76935168
  s_lshl_b32 s26, s18, 6
  s_add_u32 s26, s26, s19
  s_lshl_b32 s26, s26, 4
  s_lshl_b32 s27, s16, 2
  s_add_u32 s26, s26, s27
  s_add_u32 s26, s26, 88569856
ws_loop:
  v_mov_b32 v36, 0
  v_mov_b32 v37, 0
  v_mov_b32 v38, 0
  v_mov_b32 v39, 0
  v_mov_b32 v40, 0
  v_mov_b32 v41, 0
  v_mov_b32 v42, 0
  v_mov_b32 v43, 0
  v_mov_b32 v44, 0
  v_mov_b32 v45, 0
  v_mov_b32 v46, 0
  v_mov_b32 v47, 0
  v_mov_b32 v48, 0
  v_mov_b32 v49, 0
  v_mov_b32 v50, 0
  v_mov_b32 v51, 0
  v_mov_b32 v52, 0
  v_mov_b32 v53, 0
  v_mov_b32 v54, 0
  v_mov_b32 v55, 0
  v_mov_b32 v56, 0
  v_mov_b32 v57, 0
  v_mov_b32 v58, 0
  v_mov_b32 v59, 0
  v_mov_b32 v60, 0
  v_mov_b32 v61, 0
  v_mov_b32 v62, 0
  v_mov_b32 v63, 0
  s_mov_b32 s30, 0
ws_pm:
  s_cmp_ge_u32 s17, 61
  s_cbranch_scc1 mp_38a
  v_mov_b32 v79, 0
  s_mov_b64 exec, 1
  buffer_atomic_or v79, v77, s[8:11], s24 offen sc0
  s_mov_b64 exec, -1
  s_branch mp_38b
mp_38a:
  buffer_load_dword v79, v77, s[8:11], s24 offen sc1
mp_38b:
  s_waitcnt vmcnt(0)
  v_cmp_eq_u32 vcc, -1, v79
  s_cbranch_vccnz ws_pr
ws_fl:
  s_add_u32 s22, s24, 4096
  buffer_load_dwordx4 v[8:11], v2, s[8:11], s24 offen offset:0 sc1
  buffer_load_dwordx4 v[12:15], v2, s[8:11], s24 offen offset:1024 sc1
  buffer_load_dwordx4 v[16:19], v2, s[8:11], s24 offen offset:2048 sc1
  buffer_load_dwordx4 v[20:23], v2, s[8:11], s24 offen offset:3072 sc1
  buffer_load_dwordx4 v[24:27], v2, s[8:11], s22 offen offset:0 sc1
  buffer_load_dwordx4 v[28:31], v2, s[8:11], s22 offen offset:1024 sc1
  buffer_load_dwordx4 v[32:35], v2, s[8:11], s22 offen offset:2048 sc1
  s_waitcnt vmcnt(0)
  v_max_u32 v79, v8, v9
  v_max3_u32 v79, v79, v10, v11
  v_max3_u32 v79, v79, v12, v13
  v_max3_u32 v79, v79, v14, v15
  v_max3_u32 v79, v79, v16, v17
  v_max3_u32 v79, v79, v18, v19
  v_max3_u32 v79, v79, v20, v21
  v_max3_u32 v79, v79, v22, v23
  v_max3_u32 v79, v79, v24, v25
  v_max3_u32 v79, v79, v26, v27
  v_max3_u32 v79, v79, v28, v29
  v_max3_u32 v79, v79, v30, v31
  v_max3_u32 v79, v79, v32, v33
  v_max3_u32 v79, v79, v34, v35
  v_cmp_eq_u32 vcc, -1, v79
  s_cbranch_vccz ws_pk
ws_pr:
  s_sleep 1
  s_cmp_ge_u32 s17, 61
  s_cbranch_scc1 ws_sh
  s_sleep 6
ws_sh:
  s_add_u32 s30, s30, 1
  s_cmp_lt_u32 s30, 30000
  s_cbranch_scc1 ws_pm
  s_branch cA_abort
ws_pk:
  v_smfmac_f32_16x16x64_bf16 v[36:39], v[8:11], a[0:7], v5
  v_smfmac_f32_16x16x64_bf16 v[36:39], v[12:15], a[8:15], v5
  v_smfmac_f32_16x16x64_bf16 v[36:39], v[16:19], a[16:23], v5
  v_smfmac_f32_16x16x64_bf16 v[36:39], v[20:23], a[24:31], v5
  v_smfmac_f32_16x16x64_bf16 v[36:39], v[24:27], a[32:39], v5
  v_smfmac_f32_16x16x64_bf16 v[36:39], v[28:31], a[40:47], v5
  v_smfmac_f32_16x16x64_bf16 v[36:39], v[32:35], a[48:55], v5
  v_smfmac_f32_16x16x64_bf16 v[40:43], v[8:11], a[56:63], v5
  v_smfmac_f32_16x16x64_bf16 v[40:43], v[12:15], a[64:71], v5
  v_smfmac_f32_16x16x64_bf16 v[40:43], v[16:19], a[72:79], v5
  v_smfmac_f32_16x16x64_bf16 v[40:43], v[20:23], a[80:87], v5
  v_smfmac_f32_16x16x64_bf16 v[40:43], v[24:27], a[88:95], v5
  v_smfmac_f32_16x16x64_bf16 v[40:43], v[28:31], a[96:103], v5
  v_smfmac_f32_16x16x64_bf16 v[40:43], v[32:35], a[104:111], v5
  v_smfmac_f32_16x16x64_bf16 v[44:47], v[8:11], a[112:119], v5
  v_smfmac_f32_16x16x64_bf16 v[44:47], v[12:15], a[120:127], v5
  v_smfmac_f32_16x16x64_bf16 v[44:47], v[16:19], a[128:135], v5
  v_smfmac_f32_16x16x64_bf16 v[44:47], v[20:23], a[136:143], v5
  v_smfmac_f32_16x16x64_bf16 v[44:47], v[24:27], a[144:151], v5
  v_smfmac_f32_16x16x64_bf16 v[44:47], v[28:31], a[152:159], v5
  v_smfmac_f32_16x16x64_bf16 v[44:47], v[32:35], a[160:167], v5
  v_smfmac_f32_16x16x64_bf16 v[48:51], v[8:11], a[168:175], v5
  v_smfmac_f32_16x16x64_bf16 v[48:51], v[12:15], a[176:183], v5
  v_smfmac_f32_16x16x64_bf16 v[48:51], v[16:19], a[184:191], v5
  v_smfmac_f32_16x16x64_bf16 v[48:51], v[20:23], a[192:199], v5
  v_smfmac_f32_16x16x64_bf16 v[48:51], v[24:27], a[200:207], v5
  v_smfmac_f32_16x16x64_bf16 v[48:51], v[28:31], a[208:215], v5
  v_smfmac_f32_16x16x64_bf16 v[48:51], v[32:35], a[216:223], v5
  v_smfmac_f32_16x16x64_bf16 v[52:55], v[8:11], a[224:231], v5
  v_smfmac_f32_16x16x64_bf16 v[52:55], v[12:15], a[232:239], v5
  v_smfmac_f32_16x16x64_bf16 v[52:55], v[16:19], a[240:247], v5
  v_smfmac_f32_16x16x64_bf16 v[52:55], v[20:23], a[248:255], v5
  v_smfmac_f32_16x16x64_bf16 v[52:55], v[24:27], v[120:127], v5
  v_smfmac_f32_16x16x64_bf16 v[52:55], v[28:31], v[128:135], v5
  v_smfmac_f32_16x16x64_bf16 v[52:55], v[32:35], v[136:143], v5
  v_smfmac_f32_16x16x64_bf16 v[56:59], v[8:11], v[144:151], v5
  v_smfmac_f32_16x16x64_bf16 v[56:59], v[12:15], v[152:159], v5
  v_smfmac_f32_16x16x64_bf16 v[56:59], v[16:19], v[160:167], v5
  v_smfmac_f32_16x16x64_bf16 v[56:59], v[20:23], v[168:175], v5
  v_smfmac_f32_16x16x64_bf16 v[56:59], v[24:27], v[176:183], v5
  v_smfmac_f32_16x16x64_bf16 v[56:59], v[28:31], v[184:191], v5
  v_smfmac_f32_16x16x64_bf16 v[56:59], v[32:35], v[192:199], v5
  v_smfmac_f32_16x16x64_bf16 v[60:63], v[8:11], v[200:207], v5
  v_smfmac_f32_16x16x64_bf16 v[60:63], v[12:15], v[208:215], v5
  v_smfmac_f32_16x16x64_bf16 v[60:63], v[16:19], v[216:223], v5
  v_smfmac_f32_16x16x64_bf16 v[60:63], v[20:23], v[224:231], v5
  v_smfmac_f32_16x16x64_bf16 v[60:63], v[24:27], v[232:239], v5
  v_smfmac_f32_16x16x64_bf16 v[60:63], v[28:31], v[240:247], v5
  v_smfmac_f32_16x16x64_bf16 v[60:63], v[32:35], v[248:255], v5
  v_permlane32_swap_b32 v36, v40
  v_permlane32_swap_b32 v37, v41
  v_permlane32_swap_b32 v38, v42
  v_permlane32_swap_b32 v39, v43
  v_add_f32 v36, v36, v40
  v_add_f32 v37, v37, v41
  v_add_f32 v38, v38, v42
  v_add_f32 v39, v39, v43
  v_cvt_pk_bf16_f32 v40, v36, v37
  v_cvt_pk_bf16_f32 v41, v38, v39
  ds_write_b64 v72, v[40:41]
  v_permlane32_swap_b32 v44, v48
  v_permlane32_swap_b32 v45, v49
  v_permlane32_swap_b32 v46, v50
  v_permlane32_swap_b32 v47, v51
  v_add_f32 v44, v44, v48
  v_add_f32 v45, v45, v49
  v_add_f32 v46, v46, v50
  v_add_f32 v47, v47, v51
  v_cvt_pk_bf16_f32 v48, v44, v45
  v_cvt_pk_bf16_f32 v49, v46, v47
  ds_write_b64 v73, v[48:49]
  v_permlane32_swap_b32 v52, v56
  v_permlane32_swap_b32 v53, v57
  v_permlane32_swap_b32 v54, v58
  v_permlane32_swap_b32 v55, v59
  v_add_f32 v52, v52, v56
  v_add_f32 v53, v53, v57
  v_add_f32 v54, v54, v58
  v_add_f32 v55, v55, v59
  v_cvt_pk_bf16_f32 v56, v52, v53
  v_cvt_pk_bf16_f32 v57, v54, v55
  ds_write_b64 v74, v[56:57]
  v_mov_b32 v64, v60
  v_mov_b32 v65, v61
  v_mov_b32 v66, v62
  v_mov_b32 v67, v63
  v_permlane32_swap_b32 v60, v64
  v_permlane32_swap_b32 v61, v65
  v_permlane32_swap_b32 v62, v66
  v_permlane32_swap_b32 v63, v67
  v_add_f32 v60, v60, v64
  v_add_f32 v61, v61, v65
  v_add_f32 v62, v62, v66
  v_add_f32 v63, v63, v67
  v_cvt_pk_bf16_f32 v64, v60, v61
  v_cvt_pk_bf16_f32 v65, v62, v63
  ds_write_b64 v75, v[64:65]
  s_waitcnt lgkmcnt(0)
  ds_read_b128 v[64:67], v76
  ds_read_b128 v[68:71], v76 offset:1024
  s_waitcnt lgkmcnt(0)
  buffer_store_dwordx4 v[64:67], v2, s[8:11], s25 offen sc1
  buffer_store_dwordx4 v[68:71], v2, s[8:11], s25 offen offset:1024 sc1
  s_waitcnt vmcnt(0)
  s_mov_b64 exec, 1
  buffer_store_dword v78, v2, s[8:11], s26 offen sc1
  s_mov_b64 exec, -1
  s_add_u32 s24, s24, 14336
  s_add_u32 s25, s25, 16384
  s_add_u32 s26, s26, 32
  s_add_u32 s17, s17, 2
  s_cmp_lt_u32 s17, 64
  s_cbranch_scc1 ws_loop
  v_mov_b32 v250, 0
  s_branch wk_loop
wk_s4d:
  s_cmp_lg_u32 s16, 0
  s_cbranch_scc1 w0_39
  s_getreg_b32 s20, hwreg(HW_REG_XCC_ID)
  s_sub_u32 s20, s20, 1
  s_and_b32 s20, s20, 7
  s_mov_b64 exec, 1
s4_l:
  s_cmp_ge_u32 s20, 7
  s_cselect_b32 s20, 0, s20
  s_lshl_b32 s21, s20, 7
  s_add_u32 s21, s21, 88586240
  v_mov_b32 v242, 1
  buffer_atomic_add v242, off, s[8:11], s21 sc0
  s_waitcnt vmcnt(0)
  v_readfirstlane_b32 s21, v242
  s_lshl_b32 s22, s20, 4
  s_add_u32 s20, s20, 1
  s_cmp_ge_u32 s21, 16
  s_cbranch_scc1 s4_l
  v_add_u32 v242, s22, v242
  s_mov_b64 exec, -1
w0_39:
  v_mov_b32 v243, 160000
  s_add_u32 s101, s101, 1
  s_barrier
  s_mov_b64 exec, 1
  s_cmp_lg_u32 s16, 0
  s_cbranch_scc1 w0_40
  ds_write_b32 v243, v242 offset:0
  s_waitcnt lgkmcnt(0)
  v_mov_b32 v242, s101
  ds_write_b32 v243, v242 offset:16
  s_waitcnt lgkmcnt(0)
w0_40:
  s_mov_b64 exec, -1
  s_barrier
  ds_read_b32 v242, v243 offset:0
  ds_read_b32 v243, v243 offset:16
  s_waitcnt lgkmcnt(0)
  v_readfirstlane_b32 s3, v242
  v_cmp_ne_u32 vcc, s101, v243
  s_cbranch_vccnz ch_end
  s_load_dwordx8 s[40:47], s[0:1], 0
  s_load_dwordx4 s[48:51], s[0:1], 32
  s_load_dwordx2 s[52:53], s[0:1], 48
  s_load_dwordx2 s[54:55], s[0:1], 112
  v_lshrrev_b32 v1, 6, v0
  s_nop 0
  v_readfirstlane_b32 s16, v1
  v_and_b32 v1, 63, v0
  v_lshrrev_b32 v3, 4, v1
  v_and_b32 v4, 15, v1
  s_mul_i32 s17, s16, 24576
  s_waitcnt lgkmcnt(0)
  s_mov_b32 s60, s40
  s_and_b32 s61, s41, 0xffff
  s_mov_b32 s62, 1835008
  s_mov_b32 s63, 0x20000
  s_mov_b32 s64, s42
  s_and_b32 s65, s43, 0xffff
  s_mov_b32 s66, 229376
  s_mov_b32 s67, 0x20000
  s_mov_b32 s68, s44
  s_and_b32 s69, s45, 0xffff
  s_mov_b32 s70, 229376
  s_mov_b32 s71, 0x20000
  s_mov_b32 s72, s46
  s_and_b32 s73, s47, 0xffff
  s_mov_b32 s74, 229376
  s_mov_b32 s75, 0x20000
  s_mov_b32 s76, s48
  s_and_b32 s77, s49, 0xffff
  s_mov_b32 s78, 229376
  s_mov_b32 s79, 0x20000
  s_mov_b32 s80, s50
  s_and_b32 s81, s51, 0xffff
  s_mov_b32 s82, 896
  s_mov_b32 s83, 0x20000
  s_mov_b32 s84, s52
  s_and_b32 s85, s53, 0xffff
  s_mov_b32 s86, 896
  s_mov_b32 s87, 0x20000
  s_mov_b32 s92, s54
  s_and_b32 s93, s55, 0xffff
  s_mov_b32 s94, 3670016
  s_mov_b32 s95, 0x20000
  v_lshlrev_b32 v5, 5, v1
  v_sub_u32 v5, 2047, v5
  s_add_u32 s18, s17, 13056
  v_subrev_u32 v6, 0, v5
  v_max_i32 v7, 0, v6
  v_cvt_f32_u32 v7, v7
  v_cvt_pk_bf16_f32 v8, v7, v7
  v_and_b32 v7, 0xffff0000, v8
  v_lshrrev_b32 v8, 23, v7
  v_subrev_u32 v8, 134, v8
  v_max_i32 v8, 0, v8
  v_cvt_u32_f32 v7, v7
  v_lshrrev_b32 v7, v8, v7
  v_lshl_add_u32 v7, v8, 8, v7
  v_lshl_add_u32 v200, v7, 2, s18
  v_subrev_u32 v6, 1, v5
  v_max_i32 v7, 0, v6
  v_cvt_f32_u32 v7, v7
  v_cvt_pk_bf16_f32 v8, v7, v7
  v_and_b32 v7, 0xffff0000, v8
  v_lshrrev_b32 v8, 23, v7
  v_subrev_u32 v8, 134, v8
  v_max_i32 v8, 0, v8
  v_cvt_u32_f32 v7, v7
  v_lshrrev_b32 v7, v8, v7
  v_lshl_add_u32 v7, v8, 8, v7
  v_lshl_add_u32 v201, v7, 2, s18
  v_subrev_u32 v6, 2, v5
  v_max_i32 v7, 0, v6
  v_cvt_f32_u32 v7, v7
  v_cvt_pk_bf16_f32 v8, v7, v7
  v_and_b32 v7, 0xffff0000, v8
  v_lshrrev_b32 v8, 23, v7
  v_subrev_u32 v8, 134, v8
  v_max_i32 v8, 0, v8
  v_cvt_u32_f32 v7, v7
  v_lshrrev_b32 v7, v8, v7
  v_lshl_add_u32 v7, v8, 8, v7
  v_lshl_add_u32 v202, v7, 2, s18
  v_subrev_u32 v6, 3, v5
  v_max_i32 v7, 0, v6
  v_cvt_f32_u32 v7, v7
  v_cvt_pk_bf16_f32 v8, v7, v7
  v_and_b32 v7, 0xffff0000, v8
  v_lshrrev_b32 v8, 23, v7
  v_subrev_u32 v8, 134, v8
  v_max_i32 v8, 0, v8
  v_cvt_u32_f32 v7, v7
  v_lshrrev_b32 v7, v8, v7
  v_lshl_add_u32 v7, v8, 8, v7
  v_lshl_add_u32 v203, v7, 2, s18
  v_subrev_u32 v6, 4, v5
  v_max_i32 v7, 0, v6
  v_cvt_f32_u32 v7, v7
  v_cvt_pk_bf16_f32 v8, v7, v7
  v_and_b32 v7, 0xffff0000, v8
  v_lshrrev_b32 v8, 23, v7
  v_subrev_u32 v8, 134, v8
  v_max_i32 v8, 0, v8
  v_cvt_u32_f32 v7, v7
  v_lshrrev_b32 v7, v8, v7
  v_lshl_add_u32 v7, v8, 8, v7
  v_lshl_add_u32 v204, v7, 2, s18
  v_subrev_u32 v6, 5, v5
  v_max_i32 v7, 0, v6
  v_cvt_f32_u32 v7, v7
  v_cvt_pk_bf16_f32 v8, v7, v7
  v_and_b32 v7, 0xffff0000, v8
  v_lshrrev_b32 v8, 23, v7
  v_subrev_u32 v8, 134, v8
  v_max_i32 v8, 0, v8
  v_cvt_u32_f32 v7, v7
  v_lshrrev_b32 v7, v8, v7
  v_lshl_add_u32 v7, v8, 8, v7
  v_lshl_add_u32 v205, v7, 2, s18
  v_subrev_u32 v6, 6, v5
  v_max_i32 v7, 0, v6
  v_cvt_f32_u32 v7, v7
  v_cvt_pk_bf16_f32 v8, v7, v7
  v_and_b32 v7, 0xffff0000, v8
  v_lshrrev_b32 v8, 23, v7
  v_subrev_u32 v8, 134, v8
  v_max_i32 v8, 0, v8
  v_cvt_u32_f32 v7, v7
  v_lshrrev_b32 v7, v8, v7
  v_lshl_add_u32 v7, v8, 8, v7
  v_lshl_add_u32 v206, v7, 2, s18
  v_subrev_u32 v6, 7, v5
  v_max_i32 v7, 0, v6
  v_cvt_f32_u32 v7, v7
  v_cvt_pk_bf16_f32 v8, v7, v7
  v_and_b32 v7, 0xffff0000, v8
  v_lshrrev_b32 v8, 23, v7
  v_subrev_u32 v8, 134, v8
  v_max_i32 v8, 0, v8
  v_cvt_u32_f32 v7, v7
  v_lshrrev_b32 v7, v8, v7
  v_lshl_add_u32 v7, v8, 8, v7
  v_lshl_add_u32 v207, v7, 2, s18
  v_subrev_u32 v6, 8, v5
  v_max_i32 v7, 0, v6
  v_cvt_f32_u32 v7, v7
  v_cvt_pk_bf16_f32 v8, v7, v7
  v_and_b32 v7, 0xffff0000, v8
  v_lshrrev_b32 v8, 23, v7
  v_subrev_u32 v8, 134, v8
  v_max_i32 v8, 0, v8
  v_cvt_u32_f32 v7, v7
  v_lshrrev_b32 v7, v8, v7
  v_lshl_add_u32 v7, v8, 8, v7
  v_lshl_add_u32 v208, v7, 2, s18
  v_subrev_u32 v6, 9, v5
  v_max_i32 v7, 0, v6
  v_cvt_f32_u32 v7, v7
  v_cvt_pk_bf16_f32 v8, v7, v7
  v_and_b32 v7, 0xffff0000, v8
  v_lshrrev_b32 v8, 23, v7
  v_subrev_u32 v8, 134, v8
  v_max_i32 v8, 0, v8
  v_cvt_u32_f32 v7, v7
  v_lshrrev_b32 v7, v8, v7
  v_lshl_add_u32 v7, v8, 8, v7
  v_lshl_add_u32 v209, v7, 2, s18
  v_subrev_u32 v6, 10, v5
  v_max_i32 v7, 0, v6
  v_cvt_f32_u32 v7, v7
  v_cvt_pk_bf16_f32 v8, v7, v7
  v_and_b32 v7, 0xffff0000, v8
  v_lshrrev_b32 v8, 23, v7
  v_subrev_u32 v8, 134, v8
  v_max_i32 v8, 0, v8
  v_cvt_u32_f32 v7, v7
  v_lshrrev_b32 v7, v8, v7
  v_lshl_add_u32 v7, v8, 8, v7
  v_lshl_add_u32 v210, v7, 2, s18
  v_subrev_u32 v6, 11, v5
  v_max_i32 v7, 0, v6
  v_cvt_f32_u32 v7, v7
  v_cvt_pk_bf16_f32 v8, v7, v7
  v_and_b32 v7, 0xffff0000, v8
  v_lshrrev_b32 v8, 23, v7
  v_subrev_u32 v8, 134, v8
  v_max_i32 v8, 0, v8
  v_cvt_u32_f32 v7, v7
  v_lshrrev_b32 v7, v8, v7
  v_lshl_add_u32 v7, v8, 8, v7
  v_lshl_add_u32 v211, v7, 2, s18
  v_subrev_u32 v6, 12, v5
  v_max_i32 v7, 0, v6
  v_cvt_f32_u32 v7, v7
  v_cvt_pk_bf16_f32 v8, v7, v7
  v_and_b32 v7, 0xffff0000, v8
  v_lshrrev_b32 v8, 23, v7
  v_subrev_u32 v8, 134, v8
  v_max_i32 v8, 0, v8
  v_cvt_u32_f32 v7, v7
  v_lshrrev_b32 v7, v8, v7
  v_lshl_add_u32 v7, v8, 8, v7
  v_lshl_add_u32 v212, v7, 2, s18
  v_subrev_u32 v6, 13, v5
  v_max_i32 v7, 0, v6
  v_cvt_f32_u32 v7, v7
  v_cvt_pk_bf16_f32 v8, v7, v7
  v_and_b32 v7, 0xffff0000, v8
  v_lshrrev_b32 v8, 23, v7
  v_subrev_u32 v8, 134, v8
  v_max_i32 v8, 0, v8
  v_cvt_u32_f32 v7, v7
  v_lshrrev_b32 v7, v8, v7
  v_lshl_add_u32 v7, v8, 8, v7
  v_lshl_add_u32 v213, v7, 2, s18
  v_subrev_u32 v6, 14, v5
  v_max_i32 v7, 0, v6
  v_cvt_f32_u32 v7, v7
  v_cvt_pk_bf16_f32 v8, v7, v7
  v_and_b32 v7, 0xffff0000, v8
  v_lshrrev_b32 v8, 23, v7
  v_subrev_u32 v8, 134, v8
  v_max_i32 v8, 0, v8
  v_cvt_u32_f32 v7, v7
  v_lshrrev_b32 v7, v8, v7
  v_lshl_add_u32 v7, v8, 8, v7
  v_lshl_add_u32 v214, v7, 2, s18
  v_subrev_u32 v6, 15, v5
  v_max_i32 v7, 0, v6
  v_cvt_f32_u32 v7, v7
  v_cvt_pk_bf16_f32 v8, v7, v7
  v_and_b32 v7, 0xffff0000, v8
  v_lshrrev_b32 v8, 23, v7
  v_subrev_u32 v8, 134, v8
  v_max_i32 v8, 0, v8
  v_cvt_u32_f32 v7, v7
  v_lshrrev_b32 v7, v8, v7
  v_lshl_add_u32 v7, v8, 8, v7
  v_lshl_add_u32 v215, v7, 2, s18
  v_subrev_u32 v6, 16, v5
  v_max_i32 v7, 0, v6
  v_cvt_f32_u32 v7, v7
  v_cvt_pk_bf16_f32 v8, v7, v7
  v_and_b32 v7, 0xffff0000, v8
  v_lshrrev_b32 v8, 23, v7
  v_subrev_u32 v8, 134, v8
  v_max_i32 v8, 0, v8
  v_cvt_u32_f32 v7, v7
  v_lshrrev_b32 v7, v8, v7
  v_lshl_add_u32 v7, v8, 8, v7
  v_lshl_add_u32 v216, v7, 2, s18
  v_subrev_u32 v6, 17, v5
  v_max_i32 v7, 0, v6
  v_cvt_f32_u32 v7, v7
  v_cvt_pk_bf16_f32 v8, v7, v7
  v_and_b32 v7, 0xffff0000, v8
  v_lshrrev_b32 v8, 23, v7
  v_subrev_u32 v8, 134, v8
  v_max_i32 v8, 0, v8
  v_cvt_u32_f32 v7, v7
  v_lshrrev_b32 v7, v8, v7
  v_lshl_add_u32 v7, v8, 8, v7
  v_lshl_add_u32 v217, v7, 2, s18
  v_subrev_u32 v6, 18, v5
  v_max_i32 v7, 0, v6
  v_cvt_f32_u32 v7, v7
  v_cvt_pk_bf16_f32 v8, v7, v7
  v_and_b32 v7, 0xffff0000, v8
  v_lshrrev_b32 v8, 23, v7
  v_subrev_u32 v8, 134, v8
  v_max_i32 v8, 0, v8
  v_cvt_u32_f32 v7, v7
  v_lshrrev_b32 v7, v8, v7
  v_lshl_add_u32 v7, v8, 8, v7
  v_lshl_add_u32 v218, v7, 2, s18
  v_subrev_u32 v6, 19, v5
  v_max_i32 v7, 0, v6
  v_cvt_f32_u32 v7, v7
  v_cvt_pk_bf16_f32 v8, v7, v7
  v_and_b32 v7, 0xffff0000, v8
  v_lshrrev_b32 v8, 23, v7
  v_subrev_u32 v8, 134, v8
  v_max_i32 v8, 0, v8
  v_cvt_u32_f32 v7, v7
  v_lshrrev_b32 v7, v8, v7
  v_lshl_add_u32 v7, v8, 8, v7
  v_lshl_add_u32 v219, v7, 2, s18
  v_subrev_u32 v6, 20, v5
  v_max_i32 v7, 0, v6
  v_cvt_f32_u32 v7, v7
  v_cvt_pk_bf16_f32 v8, v7, v7
  v_and_b32 v7, 0xffff0000, v8
  v_lshrrev_b32 v8, 23, v7
  v_subrev_u32 v8, 134, v8
  v_max_i32 v8, 0, v8
  v_cvt_u32_f32 v7, v7
  v_lshrrev_b32 v7, v8, v7
  v_lshl_add_u32 v7, v8, 8, v7
  v_lshl_add_u32 v220, v7, 2, s18
  v_subrev_u32 v6, 21, v5
  v_max_i32 v7, 0, v6
  v_cvt_f32_u32 v7, v7
  v_cvt_pk_bf16_f32 v8, v7, v7
  v_and_b32 v7, 0xffff0000, v8
  v_lshrrev_b32 v8, 23, v7
  v_subrev_u32 v8, 134, v8
  v_max_i32 v8, 0, v8
  v_cvt_u32_f32 v7, v7
  v_lshrrev_b32 v7, v8, v7
  v_lshl_add_u32 v7, v8, 8, v7
  v_lshl_add_u32 v221, v7, 2, s18
  v_subrev_u32 v6, 22, v5
  v_max_i32 v7, 0, v6
  v_cvt_f32_u32 v7, v7
  v_cvt_pk_bf16_f32 v8, v7, v7
  v_and_b32 v7, 0xffff0000, v8
  v_lshrrev_b32 v8, 23, v7
  v_subrev_u32 v8, 134, v8
  v_max_i32 v8, 0, v8
  v_cvt_u32_f32 v7, v7
  v_lshrrev_b32 v7, v8, v7
  v_lshl_add_u32 v7, v8, 8, v7
  v_lshl_add_u32 v222, v7, 2, s18
  v_subrev_u32 v6, 23, v5
  v_max_i32 v7, 0, v6
  v_cvt_f32_u32 v7, v7
  v_cvt_pk_bf16_f32 v8, v7, v7
  v_and_b32 v7, 0xffff0000, v8
  v_lshrrev_b32 v8, 23, v7
  v_subrev_u32 v8, 134, v8
  v_max_i32 v8, 0, v8
  v_cvt_u32_f32 v7, v7
  v_lshrrev_b32 v7, v8, v7
  v_lshl_add_u32 v7, v8, 8, v7
  v_lshl_add_u32 v223, v7, 2, s18
  v_subrev_u32 v6, 24, v5
  v_max_i32 v7, 0, v6
  v_cvt_f32_u32 v7, v7
  v_cvt_pk_bf16_f32 v8, v7, v7
  v_and_b32 v7, 0xffff0000, v8
  v_lshrrev_b32 v8, 23, v7
  v_subrev_u32 v8, 134, v8
  v_max_i32 v8, 0, v8
  v_cvt_u32_f32 v7, v7
  v_lshrrev_b32 v7, v8, v7
  v_lshl_add_u32 v7, v8, 8, v7
  v_lshl_add_u32 v224, v7, 2, s18
  v_subrev_u32 v6, 25, v5
  v_max_i32 v7, 0, v6
  v_cvt_f32_u32 v7, v7
  v_cvt_pk_bf16_f32 v8, v7, v7
  v_and_b32 v7, 0xffff0000, v8
  v_lshrrev_b32 v8, 23, v7
  v_subrev_u32 v8, 134, v8
  v_max_i32 v8, 0, v8
  v_cvt_u32_f32 v7, v7
  v_lshrrev_b32 v7, v8, v7
  v_lshl_add_u32 v7, v8, 8, v7
  v_lshl_add_u32 v225, v7, 2, s18
  v_subrev_u32 v6, 26, v5
  v_max_i32 v7, 0, v6
  v_cvt_f32_u32 v7, v7
  v_cvt_pk_bf16_f32 v8, v7, v7
  v_and_b32 v7, 0xffff0000, v8
  v_lshrrev_b32 v8, 23, v7
  v_subrev_u32 v8, 134, v8
  v_max_i32 v8, 0, v8
  v_cvt_u32_f32 v7, v7
  v_lshrrev_b32 v7, v8, v7
  v_lshl_add_u32 v7, v8, 8, v7
  v_lshl_add_u32 v226, v7, 2, s18
  v_subrev_u32 v6, 27, v5
  v_max_i32 v7, 0, v6
  v_cvt_f32_u32 v7, v7
  v_cvt_pk_bf16_f32 v8, v7, v7
  v_and_b32 v7, 0xffff0000, v8
  v_lshrrev_b32 v8, 23, v7
  v_subrev_u32 v8, 134, v8
  v_max_i32 v8, 0, v8
  v_cvt_u32_f32 v7, v7
  v_lshrrev_b32 v7, v8, v7
  v_lshl_add_u32 v7, v8, 8, v7
  v_lshl_add_u32 v227, v7, 2, s18
  v_subrev_u32 v6, 28, v5
  v_max_i32 v7, 0, v6
  v_cvt_f32_u32 v7, v7
  v_cvt_pk_bf16_f32 v8, v7, v7
  v_and_b32 v7, 0xffff0000, v8
  v_lshrrev_b32 v8, 23, v7
  v_subrev_u32 v8, 134, v8
  v_max_i32 v8, 0, v8
  v_cvt_u32_f32 v7, v7
  v_lshrrev_b32 v7, v8, v7
  v_lshl_add_u32 v7, v8, 8, v7
  v_lshl_add_u32 v228, v7, 2, s18
  v_subrev_u32 v6, 29, v5
  v_max_i32 v7, 0, v6
  v_cvt_f32_u32 v7, v7
  v_cvt_pk_bf16_f32 v8, v7, v7
  v_and_b32 v7, 0xffff0000, v8
  v_lshrrev_b32 v8, 23, v7
  v_subrev_u32 v8, 134, v8
  v_max_i32 v8, 0, v8
  v_cvt_u32_f32 v7, v7
  v_lshrrev_b32 v7, v8, v7
  v_lshl_add_u32 v7, v8, 8, v7
  v_lshl_add_u32 v229, v7, 2, s18
  v_subrev_u32 v6, 30, v5
  v_max_i32 v7, 0, v6
  v_cvt_f32_u32 v7, v7
  v_cvt_pk_bf16_f32 v8, v7, v7
  v_and_b32 v7, 0xffff0000, v8
  v_lshrrev_b32 v8, 23, v7
  v_subrev_u32 v8, 134, v8
  v_max_i32 v8, 0, v8
  v_cvt_u32_f32 v7, v7
  v_lshrrev_b32 v7, v8, v7
  v_lshl_add_u32 v7, v8, 8, v7
  v_lshl_add_u32 v230, v7, 2, s18
  v_subrev_u32 v6, 31, v5
  v_max_i32 v7, 0, v6
  v_cvt_f32_u32 v7, v7
  v_cvt_pk_bf16_f32 v8, v7, v7
  v_and_b32 v7, 0xffff0000, v8
  v_lshrrev_b32 v8, 23, v7
  v_subrev_u32 v8, 134, v8
  v_max_i32 v8, 0, v8
  v_cvt_u32_f32 v7, v7
  v_lshrrev_b32 v7, v8, v7
  v_lshl_add_u32 v7, v8, 8, v7
  v_lshl_add_u32 v231, v7, 2, s18
  v_subrev_u32 v6, 32, v5
  v_max_i32 v7, 0, v6
  v_cvt_f32_u32 v7, v7
  v_cvt_pk_bf16_f32 v8, v7, v7
  v_and_b32 v7, 0xffff0000, v8
  v_lshrrev_b32 v8, 23, v7
  v_subrev_u32 v8, 134, v8
  v_max_i32 v8, 0, v8
  v_cvt_u32_f32 v7, v7
  v_lshrrev_b32 v7, v8, v7
  v_lshl_add_u32 v7, v8, 8, v7
  v_mov_b32 v8, 1280
  v_cmp_gt_i32 vcc, 0, v6
  s_nop 1
  v_cndmask_b32 v7, v7, v8, vcc
  v_lshl_add_u32 v232, v7, 2, s18
  v_mov_b32 v8, 0
  v_mov_b32 v9, 0
  v_lshlrev_b32 v5, 3, v1
  v_add_u32 v5, s17, v5
  ds_write_b64 v5, v[8:9]
  v_and_b32 v6, 15, v1
  v_lshlrev_b32 v6, 3, v6
  v_add_u32 v6, s17, v6
  ds_write_b64 v6, v[8:9] offset:8704
  ds_write_b64 v6, v[8:9] offset:12928
  v_mov_b32 v6, s17
  ds_write_b64 v6, v[8:9] offset:18176
  s_lshl_b32 s19, s3, 2
  s_add_u32 s20, s19, s16
  s_lshl_b32 s21, s3, 3
  v_mul_u32_u24 v5, 3584, v0
  v_mul_u32_u24 v141, 1792, v0
  s_lshl_b32 s22, s20, 9
  v_lshlrev_b32 v6, 3, v1
  buffer_load_dwordx2 v[24:25], v6, s[64:67], s22 offen
  buffer_load_dwordx2 v[26:27], v6, s[68:71], s22 offen
  buffer_load_dwordx2 v[28:29], v6, s[72:75], s22 offen
  buffer_load_dwordx2 v[30:31], v6, s[76:79], s22 offen
  s_lshl_b32 s22, s20, 1
  v_mov_b32 v7, 0
  buffer_load_ushort v32, v7, s[80:83], s22 offen
  buffer_load_ushort v33, v7, s[84:87], s22 offen
  s_mov_b32 s24, 0x05040100
  s_mov_b32 s25, 0x07060302
  s_barrier
  s_waitcnt vmcnt(0)
  s_mov_b32 s26, 1069066811
  s_mov_b32 s27, 1042479491
  v_lshlrev_b32 v32, 16, v32
  v_lshlrev_b32 v33, 16, v33
  v_mul_f32 v32, s26, v32
  v_exp_f32 v32, v32
  s_nop 0
  v_cvt_pk_bf16_f32 v34, v32, v32
  v_and_b32 v32, 0xffff0000, v34
  v_lshlrev_b32 v37, 6, v1
  v_add_u32 v37, s17, v37
  v_lshlrev_b32 v40, 16, v24
  v_lshlrev_b32 v41, 16, v26
  v_lshlrev_b32 v42, 16, v28
  v_lshlrev_b32 v43, 16, v30
  v_mul_f32 v40, s26, v40
  v_exp_f32 v40, v40
  s_nop 0
  v_cvt_pk_bf16_f32 v34, v40, v40
  v_and_b32 v40, 0xffff0000, v34
  v_mul_f32 v40, v40, v32
  v_mul_f32 v40, s26, v40
  v_sub_f32 v40, 0, v40
  v_mul_f32 v41, v41, v32
  v_mul_f32 v41, s27, v41
  v_mul_f32 v42, v42, v32
  v_mul_f32 v43, v43, v32
  v_add_f32 v42, v42, v42
  v_add_f32 v43, v43, v43
  ds_write_b128 v37, v[40:43] offset:18240
  v_and_b32 v40, 0xffff0000, v24
  v_and_b32 v41, 0xffff0000, v26
  v_and_b32 v42, 0xffff0000, v28
  v_and_b32 v43, 0xffff0000, v30
  v_mul_f32 v40, s26, v40
  v_exp_f32 v40, v40
  s_nop 0
  v_cvt_pk_bf16_f32 v34, v40, v40
  v_and_b32 v40, 0xffff0000, v34
  v_mul_f32 v40, v40, v32
  v_mul_f32 v40, s26, v40
  v_sub_f32 v40, 0, v40
  v_mul_f32 v41, v41, v32
  v_mul_f32 v41, s27, v41
  v_mul_f32 v42, v42, v32
  v_mul_f32 v43, v43, v32
  v_add_f32 v42, v42, v42
  v_add_f32 v43, v43, v43
  ds_write_b128 v37, v[40:43] offset:18256
  v_lshlrev_b32 v40, 16, v25
  v_lshlrev_b32 v41, 16, v27
  v_lshlrev_b32 v42, 16, v29
  v_lshlrev_b32 v43, 16, v31
  v_mul_f32 v40, s26, v40
  v_exp_f32 v40, v40
  s_nop 0
  v_cvt_pk_bf16_f32 v34, v40, v40
  v_and_b32 v40, 0xffff0000, v34
  v_mul_f32 v40, v40, v32
  v_mul_f32 v40, s26, v40
  v_sub_f32 v40, 0, v40
  v_mul_f32 v41, v41, v32
  v_mul_f32 v41, s27, v41
  v_mul_f32 v42, v42, v32
  v_mul_f32 v43, v43, v32
  v_add_f32 v42, v42, v42
  v_add_f32 v43, v43, v43
  ds_write_b128 v37, v[40:43] offset:18272
  v_and_b32 v40, 0xffff0000, v25
  v_and_b32 v41, 0xffff0000, v27
  v_and_b32 v42, 0xffff0000, v29
  v_and_b32 v43, 0xffff0000, v31
  v_mul_f32 v40, s26, v40
  v_exp_f32 v40, v40
  s_nop 0
  v_cvt_pk_bf16_f32 v34, v40, v40
  v_and_b32 v40, 0xffff0000, v34
  v_mul_f32 v40, v40, v32
  v_mul_f32 v40, s26, v40
  v_sub_f32 v40, 0, v40
  v_mul_f32 v41, v41, v32
  v_mul_f32 v41, s27, v41
  v_mul_f32 v42, v42, v32
  v_mul_f32 v43, v43, v32
  v_add_f32 v42, v42, v42
  v_add_f32 v43, v43, v43
  ds_write_b128 v37, v[40:43] offset:18288
  v_cvt_f32_u32 v44, v4
  v_lshlrev_b32 v45, 4, v4
  v_cvt_f32_u32 v45, v45
  v_lshlrev_b32 v46, 4, v3
  v_add_u32 v46, s17, v46
  v_mov_b32 v48, 0
  v_mov_b32 v49, 0
  v_mov_b32 v50, 0
  v_mov_b32 v51, 0
  v_mov_b32 v52, 0
  v_mov_b32 v53, 0
  v_mov_b32 v54, 0
  v_mov_b32 v55, 0
  v_mov_b32 v56, 0
  v_mov_b32 v57, 0
  v_mov_b32 v58, 0
  v_mov_b32 v59, 0
  v_mov_b32 v60, 0
  v_mov_b32 v61, 0
  v_mov_b32 v62, 0
  v_mov_b32 v63, 0
  v_mov_b32 v64, 0
  v_mov_b32 v65, 0
  v_mov_b32 v66, 0
  v_mov_b32 v67, 0
  s_waitcnt lgkmcnt(0)
  ds_read_b128 v[68:71], v46 offset:18240
  s_add_u32 s22, s21, 0
  buffer_load_dwordx2 v[8:9], v5, s[60:63], s22 offen offset:0
  s_mov_b32 s28, 0
  s_call_b64 s[30:31], wk_kl
  s_mov_b32 s28, 0
  s_call_b64 s[30:31], wk_kl
  s_add_u32 s22, s21, 0
  buffer_load_dwordx2 v[10:11], v5, s[60:63], s22 offen offset:896
  s_mov_b32 s28, 0
  s_call_b64 s[30:31], wk_kl
  s_mov_b32 s28, 0
  s_call_b64 s[30:31], wk_kl
  s_add_u32 s22, s21, 0
  buffer_load_dwordx2 v[12:13], v5, s[60:63], s22 offen offset:1792
  s_mov_b32 s28, 0
  s_call_b64 s[30:31], wk_kl
  s_mov_b32 s28, 0
  s_call_b64 s[30:31], wk_kl
  s_add_u32 s22, s21, 0
  buffer_load_dwordx2 v[14:15], v5, s[60:63], s22 offen offset:2688
  s_mov_b32 s28, 0
  s_call_b64 s[30:31], wk_kl
  s_mov_b32 s28, 0
  s_call_b64 s[30:31], wk_kl
  s_add_u32 s22, s21, 917504
  buffer_load_dwordx2 v[16:17], v5, s[60:63], s22 offen offset:0
  s_mov_b32 s28, 0
  s_call_b64 s[30:31], wk_kl
  s_mov_b32 s28, 0
  s_call_b64 s[30:31], wk_kl
  s_add_u32 s22, s21, 917504
  buffer_load_dwordx2 v[18:19], v5, s[60:63], s22 offen offset:896
  s_mov_b32 s28, 0
  s_call_b64 s[30:31], wk_kl
  s_mov_b32 s28, 0
  s_call_b64 s[30:31], wk_kl
  s_add_u32 s22, s21, 917504
  buffer_load_dwordx2 v[20:21], v5, s[60:63], s22 offen offset:1792
  s_mov_b32 s28, 0
  s_call_b64 s[30:31], wk_kl
  s_mov_b32 s28, 0
  s_call_b64 s[30:31], wk_kl
  s_add_u32 s22, s21, 917504
  buffer_load_dwordx2 v[22:23], v5, s[60:63], s22 offen offset:2688
  s_mov_b32 s28, 0
  s_call_b64 s[30:31], wk_kl
  s_mov_b32 s28, 0
  s_call_b64 s[30:31], wk_kl
  s_branch wk_kd
wk_kl:
  s_waitcnt lgkmcnt(0)
  v_mov_b32 v72, v68
  v_mov_b32 v73, v69
  v_mov_b32 v74, v70
  v_mov_b32 v75, v71
  v_add_u32 v46, 64, v46
  ds_read_b128 v[68:71], v46 offset:18240
  v_mul_f32 v80, v72, v45
  v_mul_f32 v81, v73, v45
  v_exp_f32 v80, v80
  v_fract_f32 v81, v81
  v_cos_f32 v76, v81
  v_sin_f32 v77, v81
  v_mul_f32 v76, v76, v80
  v_mul_f32 v77, v77, v80
  v_mul_f32 v80, v72, v44
  v_mul_f32 v81, v73, v44
  v_exp_f32 v80, v80
  v_fract_f32 v81, v81
  v_cos_f32 v78, v81
  v_sin_f32 v79, v81
  v_mul_f32 v78, v78, v80
  v_mul_f32 v79, v79, v80
  v_mul_f32 v82, v74, v76
  v_mul_f32 v83, v74, v77
  v_fma_f32 v82, -v75, v77, v82
  v_fma_f32 v83, -v75, v76, -v83
  v_mul_f32 v86, v76, v76
  v_mul_f32 v87, v76, v77
  v_fma_f32 v86, -v77, v77, v86
  v_add_f32 v87, v87, v87
  v_mfma_f32_16x16x4_f32 v[48:51], v82, v78, v[48:51]
  v_mul_f32 v88, v78, v78
  v_mul_f32 v89, v78, v79
  v_fma_f32 v88, -v79, v79, v88
  v_add_f32 v89, v89, v89
  v_mfma_f32_16x16x4_f32 v[48:51], v83, v79, v[48:51]
  v_mul_f32 v84, v74, v86
  v_mul_f32 v85, v74, v87
  v_fma_f32 v84, -v75, v87, v84
  v_fma_f32 v85, -v75, v86, -v85
  v_mul_f32 v76, v86, v86
  v_mul_f32 v77, v86, v87
  v_fma_f32 v76, -v87, v87, v76
  v_add_f32 v77, v77, v77
  v_mfma_f32_16x16x4_f32 v[52:55], v84, v88, v[52:55]
  v_mul_f32 v78, v88, v88
  v_mul_f32 v79, v88, v89
  v_fma_f32 v78, -v89, v89, v78
  v_add_f32 v79, v79, v79
  v_mfma_f32_16x16x4_f32 v[52:55], v85, v89, v[52:55]
  v_mul_f32 v82, v74, v76
  v_mul_f32 v83, v74, v77
  v_fma_f32 v82, -v75, v77, v82
  v_fma_f32 v83, -v75, v76, -v83
  v_mul_f32 v86, v76, v76
  v_mul_f32 v87, v76, v77
  v_fma_f32 v86, -v77, v77, v86
  v_add_f32 v87, v87, v87
  v_mfma_f32_16x16x4_f32 v[56:59], v82, v78, v[56:59]
  v_mul_f32 v88, v78, v78
  v_mul_f32 v89, v78, v79
  v_fma_f32 v88, -v79, v79, v88
  v_add_f32 v89, v89, v89
  v_mfma_f32_16x16x4_f32 v[56:59], v83, v79, v[56:59]
  v_mul_f32 v84, v74, v86
  v_mul_f32 v85, v74, v87
  v_fma_f32 v84, -v75, v87, v84
  v_fma_f32 v85, -v75, v86, -v85
  v_mul_f32 v76, v86, v86
  v_mul_f32 v77, v86, v87
  v_fma_f32 v76, -v87, v87, v76
  v_add_f32 v77, v77, v77
  v_mfma_f32_16x16x4_f32 v[60:63], v84, v88, v[60:63]
  v_mfma_f32_16x16x4_f32 v[60:63], v85, v89, v[60:63]
  v_mul_f32 v82, v74, v76
  v_fma_f32 v82, -v75, v77, v82
  s_nop 1
  v_mfma_f32_16x16x4_f32 v[64:67], v82, v88, v[64:67]
  s_add_u32 s28, s28, 1
  s_cmp_lt_u32 s28, 4
  s_cbranch_scc1 wk_kl
  s_setpc_b64 s[30:31]
wk_kd:
  s_nop 15
  s_nop 3
  s_waitcnt vmcnt(0)
  v_lshlrev_b32 v6, 3, v0
  v_perm_b32 v34, v10, v8, s24
  v_perm_b32 v35, v14, v12, s24
  v_add_u32 v36, 512, v6
  ds_write_b64 v36, v[34:35]
  v_perm_b32 v34, v10, v8, s25
  v_perm_b32 v35, v14, v12, s25
  v_add_u32 v36, 25088, v6
  ds_write_b64 v36, v[34:35]
  v_perm_b32 v34, v11, v9, s24
  v_perm_b32 v35, v15, v13, s24
  v_add_u32 v36, 49664, v6
  ds_write_b64 v36, v[34:35]
  v_perm_b32 v34, v11, v9, s25
  v_perm_b32 v35, v15, v13, s25
  v_add_u32 v36, 74240, v6
  ds_write_b64 v36, v[34:35]
  v_perm_b32 v34, v18, v16, s24
  v_perm_b32 v35, v22, v20, s24
  v_add_u32 v36, 2560, v6
  ds_write_b64 v36, v[34:35]
  v_perm_b32 v34, v18, v16, s25
  v_perm_b32 v35, v22, v20, s25
  v_add_u32 v36, 27136, v6
  ds_write_b64 v36, v[34:35]
  v_perm_b32 v34, v19, v17, s24
  v_perm_b32 v35, v23, v21, s24
  v_add_u32 v36, 51712, v6
  ds_write_b64 v36, v[34:35]
  v_perm_b32 v34, v19, v17, s25
  v_perm_b32 v35, v23, v21, s25
  v_add_u32 v36, 76288, v6
  ds_write_b64 v36, v[34:35]
  v_lshlrev_b32 v46, 8, v3
  v_lshl_add_u32 v46, v4, 2, v46
  v_add_u32 v46, s17, v46
  ds_write_b32 v46, v48 offset:13056
  ds_write_b32 v46, v49 offset:13120
  ds_write_b32 v46, v50 offset:13184
  ds_write_b32 v46, v51 offset:13248
  s_waitcnt lgkmcnt(8)
  ds_write_b32 v46, v52 offset:14080
  ds_write_b32 v46, v53 offset:14144
  ds_write_b32 v46, v54 offset:14208
  ds_write_b32 v46, v55 offset:14272
  s_waitcnt lgkmcnt(8)
  ds_write_b32 v46, v56 offset:15104
  ds_write_b32 v46, v57 offset:15168
  ds_write_b32 v46, v58 offset:15232
  ds_write_b32 v46, v59 offset:15296
  s_waitcnt lgkmcnt(8)
  ds_write_b32 v46, v60 offset:16128
  ds_write_b32 v46, v61 offset:16192
  ds_write_b32 v46, v62 offset:16256
  ds_write_b32 v46, v63 offset:16320
  s_waitcnt lgkmcnt(8)
  ds_write_b32 v46, v64 offset:17152
  ds_write_b32 v46, v65 offset:17216
  ds_write_b32 v46, v66 offset:17280
  ds_write_b32 v46, v67 offset:17344
  s_waitcnt lgkmcnt(8)
  s_waitcnt lgkmcnt(0)
  ds_read_b32 v48, v200
  ds_read_b32 v49, v201
  ds_read_b32 v50, v202
  ds_read_b32 v51, v203
  ds_read_b32 v52, v204
  ds_read_b32 v53, v205
  ds_read_b32 v54, v206
  ds_read_b32 v55, v207
  s_waitcnt lgkmcnt(4)
  ds_read_b32 v56, v208
  ds_read_b32 v57, v209
  ds_read_b32 v58, v210
  ds_read_b32 v59, v211
  ds_read_b32 v60, v212
  ds_read_b32 v61, v213
  ds_read_b32 v62, v214
  ds_read_b32 v63, v215
  s_waitcnt lgkmcnt(4)
  ds_read_b32 v64, v216
  ds_read_b32 v65, v217
  ds_read_b32 v66, v218
  ds_read_b32 v67, v219
  ds_read_b32 v68, v220
  ds_read_b32 v69, v221
  ds_read_b32 v70, v222
  ds_read_b32 v71, v223
  s_waitcnt lgkmcnt(4)
  ds_read_b32 v72, v224
  ds_read_b32 v73, v225
  ds_read_b32 v74, v226
  ds_read_b32 v75, v227
  ds_read_b32 v76, v228
  ds_read_b32 v77, v229
  ds_read_b32 v78, v230
  ds_read_b32 v79, v231
  s_waitcnt lgkmcnt(4)
  ds_read_b32 v80, v232
  s_waitcnt lgkmcnt(0)
  v_lshlrev_b32 v46, 6, v1
  v_add_u32 v46, s17, v46
  v_cvt_pk_bf16_f32 v84, v48, v49
  v_cvt_pk_bf16_f32 v88, v49, v50
  v_cvt_pk_bf16_f32 v85, v50, v51
  v_cvt_pk_bf16_f32 v89, v51, v52
  v_cvt_pk_bf16_f32 v86, v52, v53
  v_cvt_pk_bf16_f32 v90, v53, v54
  v_cvt_pk_bf16_f32 v87, v54, v55
  v_cvt_pk_bf16_f32 v91, v55, v56
  ds_write_b128 v46, v[84:87] offset:4608
  ds_write_b128 v46, v[88:91] offset:8832
  s_waitcnt lgkmcnt(0)
  v_cvt_pk_bf16_f32 v84, v56, v57
  v_cvt_pk_bf16_f32 v88, v57, v58
  v_cvt_pk_bf16_f32 v85, v58, v59
  v_cvt_pk_bf16_f32 v89, v59, v60
  v_cvt_pk_bf16_f32 v86, v60, v61
  v_cvt_pk_bf16_f32 v90, v61, v62
  v_cvt_pk_bf16_f32 v87, v62, v63
  v_cvt_pk_bf16_f32 v91, v63, v64
  ds_write_b128 v46, v[84:87] offset:4624
  ds_write_b128 v46, v[88:91] offset:8848
  s_waitcnt lgkmcnt(0)
  v_cvt_pk_bf16_f32 v84, v64, v65
  v_cvt_pk_bf16_f32 v88, v65, v66
  v_cvt_pk_bf16_f32 v85, v66, v67
  v_cvt_pk_bf16_f32 v89, v67, v68
  v_cvt_pk_bf16_f32 v86, v68, v69
  v_cvt_pk_bf16_f32 v90, v69, v70
  v_cvt_pk_bf16_f32 v87, v70, v71
  v_cvt_pk_bf16_f32 v91, v71, v72
  ds_write_b128 v46, v[84:87] offset:4640
  ds_write_b128 v46, v[88:91] offset:8864
  s_waitcnt lgkmcnt(0)
  v_cvt_pk_bf16_f32 v84, v72, v73
  v_cvt_pk_bf16_f32 v88, v73, v74
  v_cvt_pk_bf16_f32 v85, v74, v75
  v_cvt_pk_bf16_f32 v89, v75, v76
  v_cvt_pk_bf16_f32 v86, v76, v77
  v_cvt_pk_bf16_f32 v90, v77, v78
  v_cvt_pk_bf16_f32 v87, v78, v79
  v_cvt_pk_bf16_f32 v91, v79, v80
  ds_write_b128 v46, v[84:87] offset:4656
  ds_write_b128 v46, v[88:91] offset:8880
  s_waitcnt lgkmcnt(0)
  s_barrier
  v_lshrrev_b32 v47, 1, v3
  v_sub_u32 v46, v4, v47
  v_add_u32 v46, 1, v46
  v_lshlrev_b32 v46, 5, v46
  v_and_b32 v48, 1, v3
  v_lshl_add_u32 v46, v48, 4, v46
  v_add_u32 v46, s17, v46
  ds_read_b128 a[0:3], v46 offset:32
  ds_read_b128 a[4:7], v46 offset:96
  ds_read_b128 a[8:11], v46 offset:160
  ds_read_b128 a[12:15], v46 offset:224
  ds_read_b128 a[16:19], v46 offset:288
  ds_read_b128 a[20:23], v46 offset:352
  ds_read_b128 a[24:27], v46 offset:416
  ds_read_b128 a[28:31], v46 offset:480
  s_waitcnt lgkmcnt(4)
  ds_read_b128 a[32:35], v46 offset:544
  ds_read_b128 a[36:39], v46 offset:608
  ds_read_b128 a[40:43], v46 offset:672
  ds_read_b128 a[44:47], v46 offset:736
  ds_read_b128 a[48:51], v46 offset:800
  ds_read_b128 a[52:55], v46 offset:864
  ds_read_b128 a[56:59], v46 offset:928
  ds_read_b128 a[60:63], v46 offset:992
  s_waitcnt lgkmcnt(4)
  ds_read_b128 a[64:67], v46 offset:1056
  ds_read_b128 a[68:71], v46 offset:1120
  ds_read_b128 a[72:75], v46 offset:1184
  ds_read_b128 a[76:79], v46 offset:1248
  ds_read_b128 a[80:83], v46 offset:1312
  ds_read_b128 a[84:87], v46 offset:1376
  ds_read_b128 a[88:91], v46 offset:1440
  ds_read_b128 a[92:95], v46 offset:1504
  s_waitcnt lgkmcnt(4)
  ds_read_b128 a[96:99], v46 offset:1568
  ds_read_b128 a[100:103], v46 offset:1632
  ds_read_b128 a[104:107], v46 offset:1696
  ds_read_b128 a[108:111], v46 offset:1760
  ds_read_b128 a[112:115], v46 offset:1824
  ds_read_b128 a[116:119], v46 offset:1888
  ds_read_b128 a[120:123], v46 offset:1952
  ds_read_b128 a[124:127], v46 offset:2016
  s_waitcnt lgkmcnt(4)
  ds_read_b128 a[128:131], v46 offset:2080
  ds_read_b128 a[132:135], v46 offset:2144
  ds_read_b128 a[136:139], v46 offset:2208
  ds_read_b128 a[140:143], v46 offset:2272
  ds_read_b128 a[144:147], v46 offset:2336
  ds_read_b128 a[148:151], v46 offset:2400
  ds_read_b128 a[152:155], v46 offset:2464
  ds_read_b128 a[156:159], v46 offset:2528
  s_waitcnt lgkmcnt(4)
  ds_read_b128 a[160:163], v46 offset:2592
  ds_read_b128 a[164:167], v46 offset:2656
  ds_read_b128 a[168:171], v46 offset:2720
  ds_read_b128 a[172:175], v46 offset:2784
  ds_read_b128 a[176:179], v46 offset:2848
  ds_read_b128 a[180:183], v46 offset:2912
  ds_read_b128 a[184:187], v46 offset:2976
  ds_read_b128 a[188:191], v46 offset:3040
  s_waitcnt lgkmcnt(4)
  ds_read_b128 a[192:195], v46 offset:3104
  ds_read_b128 a[196:199], v46 offset:3168
  ds_read_b128 a[200:203], v46 offset:3232
  ds_read_b128 a[204:207], v46 offset:3296
  ds_read_b128 a[208:211], v46 offset:3360
  ds_read_b128 a[212:215], v46 offset:3424
  ds_read_b128 a[216:219], v46 offset:3488
  ds_read_b128 a[220:223], v46 offset:3552
  s_waitcnt lgkmcnt(4)
  ds_read_b128 a[224:227], v46 offset:3616
  ds_read_b128 a[228:231], v46 offset:3680
  ds_read_b128 a[232:235], v46 offset:3744
  ds_read_b128 a[236:239], v46 offset:3808
  ds_read_b128 a[240:243], v46 offset:3872
  ds_read_b128 a[244:247], v46 offset:3936
  ds_read_b128 a[248:251], v46 offset:4000
  ds_read_b128 a[252:255], v46 offset:4064
  s_waitcnt lgkmcnt(4)
  v_lshlrev_b32 v49, 4, v47
  v_add_u32 v49, v49, v4
  v_sub_u32 v49, 2047, v49
  v_lshl_add_u32 v49, v48, 3, v49
  v_and_b32 v50, 1, v49
  v_lshrrev_b32 v49, 1, v49
  v_lshlrev_b32 v49, 2, v49
  v_mul_u32_u24 v50, 4224, v50
  v_add3_u32 v49, v49, v50, s17
  v_add_u32 v49, 4608, v49
  v_subrev_u32 v52, 896, v49
  v_subrev_u32 v53, 1856, v49
  v_subrev_u32 v54, 2816, v49
  v_subrev_u32 v55, 3776, v49
  v_subrev_u32 v56, 4736, v49
  s_waitcnt lgkmcnt(0)
  ds_read2_b32 v[92:93], v52 offset0:224 offset1:225
  ds_read2_b32 v[94:95], v52 offset0:226 offset1:227
  ds_read2_b32 v[96:97], v52 offset0:208 offset1:209
  ds_read2_b32 v[98:99], v52 offset0:210 offset1:211
  ds_read2_b32 v[100:101], v52 offset0:192 offset1:193
  ds_read2_b32 v[102:103], v52 offset0:194 offset1:195
  ds_read2_b32 v[104:105], v52 offset0:176 offset1:177
  ds_read2_b32 v[106:107], v52 offset0:178 offset1:179
  s_waitcnt lgkmcnt(6)
  v_mfma_f32_16x16x32_bf16 v[60:63], v[92:95], a[28:31], 0
  v_mfma_f32_16x16x32_bf16 v[64:67], v[92:95], a[60:63], 0
  v_mfma_f32_16x16x32_bf16 v[68:71], v[92:95], a[92:95], 0
  v_mfma_f32_16x16x32_bf16 v[72:75], v[92:95], a[124:127], 0
  v_mfma_f32_16x16x32_bf16 v[76:79], v[92:95], a[156:159], 0
  v_mfma_f32_16x16x32_bf16 v[80:83], v[92:95], a[188:191], 0
  v_mfma_f32_16x16x32_bf16 v[84:87], v[92:95], a[220:223], 0
  v_mfma_f32_16x16x32_bf16 v[88:91], v[92:95], a[252:255], 0
  ds_read2_b32 v[92:93], v52 offset0:160 offset1:161
  ds_read2_b32 v[94:95], v52 offset0:162 offset1:163
  s_waitcnt lgkmcnt(6)
  v_mfma_f32_16x16x32_bf16 v[60:63], v[96:99], a[24:27], v[60:63]
  v_mfma_f32_16x16x32_bf16 v[64:67], v[96:99], a[56:59], v[64:67]
  v_mfma_f32_16x16x32_bf16 v[68:71], v[96:99], a[88:91], v[68:71]
  v_mfma_f32_16x16x32_bf16 v[72:75], v[96:99], a[120:123], v[72:75]
  v_mfma_f32_16x16x32_bf16 v[76:79], v[96:99], a[152:155], v[76:79]
  v_mfma_f32_16x16x32_bf16 v[80:83], v[96:99], a[184:187], v[80:83]
  v_mfma_f32_16x16x32_bf16 v[84:87], v[96:99], a[216:219], v[84:87]
  v_mfma_f32_16x16x32_bf16 v[88:91], v[96:99], a[248:251], v[88:91]
  ds_read2_b32 v[96:97], v52 offset0:144 offset1:145
  ds_read2_b32 v[98:99], v52 offset0:146 offset1:147
  s_waitcnt lgkmcnt(6)
  v_mfma_f32_16x16x32_bf16 v[60:63], v[100:103], a[20:23], v[60:63]
  v_mfma_f32_16x16x32_bf16 v[64:67], v[100:103], a[52:55], v[64:67]
  v_mfma_f32_16x16x32_bf16 v[68:71], v[100:103], a[84:87], v[68:71]
  v_mfma_f32_16x16x32_bf16 v[72:75], v[100:103], a[116:119], v[72:75]
  v_mfma_f32_16x16x32_bf16 v[76:79], v[100:103], a[148:151], v[76:79]
  v_mfma_f32_16x16x32_bf16 v[80:83], v[100:103], a[180:183], v[80:83]
  v_mfma_f32_16x16x32_bf16 v[84:87], v[100:103], a[212:215], v[84:87]
  v_mfma_f32_16x16x32_bf16 v[88:91], v[100:103], a[244:247], v[88:91]
  ds_read2_b32 v[100:101], v52 offset0:128 offset1:129
  ds_read2_b32 v[102:103], v52 offset0:130 offset1:131
  s_waitcnt lgkmcnt(6)
  v_mfma_f32_16x16x32_bf16 v[60:63], v[104:107], a[16:19], v[60:63]
  v_mfma_f32_16x16x32_bf16 v[64:67], v[104:107], a[48:51], v[64:67]
  v_mfma_f32_16x16x32_bf16 v[68:71], v[104:107], a[80:83], v[68:71]
  v_mfma_f32_16x16x32_bf16 v[72:75], v[104:107], a[112:115], v[72:75]
  v_mfma_f32_16x16x32_bf16 v[76:79], v[104:107], a[144:147], v[76:79]
  v_mfma_f32_16x16x32_bf16 v[80:83], v[104:107], a[176:179], v[80:83]
  v_mfma_f32_16x16x32_bf16 v[84:87], v[104:107], a[208:211], v[84:87]
  v_mfma_f32_16x16x32_bf16 v[88:91], v[104:107], a[240:243], v[88:91]
  ds_read2_b32 v[104:105], v52 offset0:112 offset1:113
  ds_read2_b32 v[106:107], v52 offset0:114 offset1:115
  s_waitcnt lgkmcnt(6)
  v_mfma_f32_16x16x32_bf16 v[60:63], v[92:95], a[12:15], v[60:63]
  v_mfma_f32_16x16x32_bf16 v[64:67], v[92:95], a[44:47], v[64:67]
  v_mfma_f32_16x16x32_bf16 v[68:71], v[92:95], a[76:79], v[68:71]
  v_mfma_f32_16x16x32_bf16 v[72:75], v[92:95], a[108:111], v[72:75]
  v_mfma_f32_16x16x32_bf16 v[76:79], v[92:95], a[140:143], v[76:79]
  v_mfma_f32_16x16x32_bf16 v[80:83], v[92:95], a[172:175], v[80:83]
  v_mfma_f32_16x16x32_bf16 v[84:87], v[92:95], a[204:207], v[84:87]
  v_mfma_f32_16x16x32_bf16 v[88:91], v[92:95], a[236:239], v[88:91]
  ds_read2_b32 v[92:93], v52 offset0:96 offset1:97
  ds_read2_b32 v[94:95], v52 offset0:98 offset1:99
  s_waitcnt lgkmcnt(6)
  v_mfma_f32_16x16x32_bf16 v[60:63], v[96:99], a[8:11], v[60:63]
  v_mfma_f32_16x16x32_bf16 v[64:67], v[96:99], a[40:43], v[64:67]
  v_mfma_f32_16x16x32_bf16 v[68:71], v[96:99], a[72:75], v[68:71]
  v_mfma_f32_16x16x32_bf16 v[72:75], v[96:99], a[104:107], v[72:75]
  v_mfma_f32_16x16x32_bf16 v[76:79], v[96:99], a[136:139], v[76:79]
  v_mfma_f32_16x16x32_bf16 v[80:83], v[96:99], a[168:171], v[80:83]
  v_mfma_f32_16x16x32_bf16 v[84:87], v[96:99], a[200:203], v[84:87]
  v_mfma_f32_16x16x32_bf16 v[88:91], v[96:99], a[232:235], v[88:91]
  ds_read2_b32 v[96:97], v52 offset0:80 offset1:81
  ds_read2_b32 v[98:99], v52 offset0:82 offset1:83
  s_waitcnt lgkmcnt(6)
  v_mfma_f32_16x16x32_bf16 v[60:63], v[100:103], a[4:7], v[60:63]
  v_mfma_f32_16x16x32_bf16 v[64:67], v[100:103], a[36:39], v[64:67]
  v_mfma_f32_16x16x32_bf16 v[68:71], v[100:103], a[68:71], v[68:71]
  v_mfma_f32_16x16x32_bf16 v[72:75], v[100:103], a[100:103], v[72:75]
  v_mfma_f32_16x16x32_bf16 v[76:79], v[100:103], a[132:135], v[76:79]
  v_mfma_f32_16x16x32_bf16 v[80:83], v[100:103], a[164:167], v[80:83]
  v_mfma_f32_16x16x32_bf16 v[84:87], v[100:103], a[196:199], v[84:87]
  v_mfma_f32_16x16x32_bf16 v[88:91], v[100:103], a[228:231], v[88:91]
  ds_read2_b32 v[100:101], v52 offset0:64 offset1:65
  ds_read2_b32 v[102:103], v52 offset0:66 offset1:67
  s_waitcnt lgkmcnt(6)
  v_mfma_f32_16x16x32_bf16 v[60:63], v[104:107], a[0:3], v[60:63]
  v_mfma_f32_16x16x32_bf16 v[64:67], v[104:107], a[32:35], v[64:67]
  v_mfma_f32_16x16x32_bf16 v[68:71], v[104:107], a[64:67], v[68:71]
  v_mfma_f32_16x16x32_bf16 v[72:75], v[104:107], a[96:99], v[72:75]
  v_mfma_f32_16x16x32_bf16 v[76:79], v[104:107], a[128:131], v[76:79]
  v_mfma_f32_16x16x32_bf16 v[80:83], v[104:107], a[160:163], v[80:83]
  v_mfma_f32_16x16x32_bf16 v[84:87], v[104:107], a[192:195], v[84:87]
  v_mfma_f32_16x16x32_bf16 v[88:91], v[104:107], a[224:227], v[88:91]
  ds_read2_b32 v[104:105], v52 offset0:48 offset1:49
  ds_read2_b32 v[106:107], v52 offset0:50 offset1:51
  s_waitcnt lgkmcnt(6)
  v_mfma_f32_16x16x32_bf16 v[64:67], v[92:95], a[28:31], v[64:67]
  v_mfma_f32_16x16x32_bf16 v[68:71], v[92:95], a[60:63], v[68:71]
  v_mfma_f32_16x16x32_bf16 v[72:75], v[92:95], a[92:95], v[72:75]
  v_mfma_f32_16x16x32_bf16 v[76:79], v[92:95], a[124:127], v[76:79]
  v_mfma_f32_16x16x32_bf16 v[80:83], v[92:95], a[156:159], v[80:83]
  v_mfma_f32_16x16x32_bf16 v[84:87], v[92:95], a[188:191], v[84:87]
  v_mfma_f32_16x16x32_bf16 v[88:91], v[92:95], a[220:223], v[88:91]
  ds_read2_b32 v[92:93], v52 offset0:32 offset1:33
  ds_read2_b32 v[94:95], v52 offset0:34 offset1:35
  s_waitcnt lgkmcnt(6)
  v_mfma_f32_16x16x32_bf16 v[64:67], v[96:99], a[24:27], v[64:67]
  v_mfma_f32_16x16x32_bf16 v[68:71], v[96:99], a[56:59], v[68:71]
  v_mfma_f32_16x16x32_bf16 v[72:75], v[96:99], a[88:91], v[72:75]
  v_mfma_f32_16x16x32_bf16 v[76:79], v[96:99], a[120:123], v[76:79]
  v_mfma_f32_16x16x32_bf16 v[80:83], v[96:99], a[152:155], v[80:83]
  v_mfma_f32_16x16x32_bf16 v[84:87], v[96:99], a[184:187], v[84:87]
  v_mfma_f32_16x16x32_bf16 v[88:91], v[96:99], a[216:219], v[88:91]
  ds_read2_b32 v[96:97], v52 offset0:16 offset1:17
  ds_read2_b32 v[98:99], v52 offset0:18 offset1:19
  s_waitcnt lgkmcnt(6)
  v_mfma_f32_16x16x32_bf16 v[64:67], v[100:103], a[20:23], v[64:67]
  v_mfma_f32_16x16x32_bf16 v[68:71], v[100:103], a[52:55], v[68:71]
  v_mfma_f32_16x16x32_bf16 v[72:75], v[100:103], a[84:87], v[72:75]
  v_mfma_f32_16x16x32_bf16 v[76:79], v[100:103], a[116:119], v[76:79]
  v_mfma_f32_16x16x32_bf16 v[80:83], v[100:103], a[148:151], v[80:83]
  v_mfma_f32_16x16x32_bf16 v[84:87], v[100:103], a[180:183], v[84:87]
  v_mfma_f32_16x16x32_bf16 v[88:91], v[100:103], a[212:215], v[88:91]
  ds_read2_b32 v[100:101], v52 offset0:0 offset1:1
  ds_read2_b32 v[102:103], v52 offset0:2 offset1:3
  s_waitcnt lgkmcnt(6)
  v_mfma_f32_16x16x32_bf16 v[64:67], v[104:107], a[16:19], v[64:67]
  v_mfma_f32_16x16x32_bf16 v[68:71], v[104:107], a[48:51], v[68:71]
  v_mfma_f32_16x16x32_bf16 v[72:75], v[104:107], a[80:83], v[72:75]
  v_mfma_f32_16x16x32_bf16 v[76:79], v[104:107], a[112:115], v[76:79]
  v_mfma_f32_16x16x32_bf16 v[80:83], v[104:107], a[144:147], v[80:83]
  v_mfma_f32_16x16x32_bf16 v[84:87], v[104:107], a[176:179], v[84:87]
  v_mfma_f32_16x16x32_bf16 v[88:91], v[104:107], a[208:211], v[88:91]
  ds_read2_b32 v[104:105], v53 offset0:224 offset1:225
  ds_read2_b32 v[106:107], v53 offset0:226 offset1:227
  s_waitcnt lgkmcnt(6)
  v_mfma_f32_16x16x32_bf16 v[64:67], v[92:95], a[12:15], v[64:67]
  v_mfma_f32_16x16x32_bf16 v[68:71], v[92:95], a[44:47], v[68:71]
  v_mfma_f32_16x16x32_bf16 v[72:75], v[92:95], a[76:79], v[72:75]
  v_mfma_f32_16x16x32_bf16 v[76:79], v[92:95], a[108:111], v[76:79]
  v_mfma_f32_16x16x32_bf16 v[80:83], v[92:95], a[140:143], v[80:83]
  v_mfma_f32_16x16x32_bf16 v[84:87], v[92:95], a[172:175], v[84:87]
  v_mfma_f32_16x16x32_bf16 v[88:91], v[92:95], a[204:207], v[88:91]
  ds_read2_b32 v[92:93], v53 offset0:208 offset1:209
  ds_read2_b32 v[94:95], v53 offset0:210 offset1:211
  s_waitcnt lgkmcnt(6)
  v_mfma_f32_16x16x32_bf16 v[64:67], v[96:99], a[8:11], v[64:67]
  v_mfma_f32_16x16x32_bf16 v[68:71], v[96:99], a[40:43], v[68:71]
  v_mfma_f32_16x16x32_bf16 v[72:75], v[96:99], a[72:75], v[72:75]
  v_mfma_f32_16x16x32_bf16 v[76:79], v[96:99], a[104:107], v[76:79]
  v_mfma_f32_16x16x32_bf16 v[80:83], v[96:99], a[136:139], v[80:83]
  v_mfma_f32_16x16x32_bf16 v[84:87], v[96:99], a[168:171], v[84:87]
  v_mfma_f32_16x16x32_bf16 v[88:91], v[96:99], a[200:203], v[88:91]
  ds_read2_b32 v[96:97], v53 offset0:192 offset1:193
  ds_read2_b32 v[98:99], v53 offset0:194 offset1:195
  s_waitcnt lgkmcnt(6)
  v_mfma_f32_16x16x32_bf16 v[64:67], v[100:103], a[4:7], v[64:67]
  v_mfma_f32_16x16x32_bf16 v[68:71], v[100:103], a[36:39], v[68:71]
  v_mfma_f32_16x16x32_bf16 v[72:75], v[100:103], a[68:71], v[72:75]
  v_mfma_f32_16x16x32_bf16 v[76:79], v[100:103], a[100:103], v[76:79]
  v_mfma_f32_16x16x32_bf16 v[80:83], v[100:103], a[132:135], v[80:83]
  v_mfma_f32_16x16x32_bf16 v[84:87], v[100:103], a[164:167], v[84:87]
  v_mfma_f32_16x16x32_bf16 v[88:91], v[100:103], a[196:199], v[88:91]
  ds_read2_b32 v[100:101], v53 offset0:176 offset1:177
  ds_read2_b32 v[102:103], v53 offset0:178 offset1:179
  s_waitcnt lgkmcnt(6)
  v_mfma_f32_16x16x32_bf16 v[64:67], v[104:107], a[0:3], v[64:67]
  v_mfma_f32_16x16x32_bf16 v[68:71], v[104:107], a[32:35], v[68:71]
  v_mfma_f32_16x16x32_bf16 v[72:75], v[104:107], a[64:67], v[72:75]
  v_mfma_f32_16x16x32_bf16 v[76:79], v[104:107], a[96:99], v[76:79]
  v_mfma_f32_16x16x32_bf16 v[80:83], v[104:107], a[128:131], v[80:83]
  v_mfma_f32_16x16x32_bf16 v[84:87], v[104:107], a[160:163], v[84:87]
  v_mfma_f32_16x16x32_bf16 v[88:91], v[104:107], a[192:195], v[88:91]
  ds_read2_b32 v[104:105], v53 offset0:160 offset1:161
  ds_read2_b32 v[106:107], v53 offset0:162 offset1:163
  s_waitcnt lgkmcnt(6)
  v_mfma_f32_16x16x32_bf16 v[68:71], v[92:95], a[28:31], v[68:71]
  v_mfma_f32_16x16x32_bf16 v[72:75], v[92:95], a[60:63], v[72:75]
  v_mfma_f32_16x16x32_bf16 v[76:79], v[92:95], a[92:95], v[76:79]
  v_mfma_f32_16x16x32_bf16 v[80:83], v[92:95], a[124:127], v[80:83]
  v_mfma_f32_16x16x32_bf16 v[84:87], v[92:95], a[156:159], v[84:87]
  v_mfma_f32_16x16x32_bf16 v[88:91], v[92:95], a[188:191], v[88:91]
  ds_read2_b32 v[92:93], v53 offset0:144 offset1:145
  ds_read2_b32 v[94:95], v53 offset0:146 offset1:147
  s_waitcnt lgkmcnt(6)
  v_mfma_f32_16x16x32_bf16 v[68:71], v[96:99], a[24:27], v[68:71]
  v_mfma_f32_16x16x32_bf16 v[72:75], v[96:99], a[56:59], v[72:75]
  v_mfma_f32_16x16x32_bf16 v[76:79], v[96:99], a[88:91], v[76:79]
  v_mfma_f32_16x16x32_bf16 v[80:83], v[96:99], a[120:123], v[80:83]
  v_mfma_f32_16x16x32_bf16 v[84:87], v[96:99], a[152:155], v[84:87]
  v_mfma_f32_16x16x32_bf16 v[88:91], v[96:99], a[184:187], v[88:91]
  ds_read2_b32 v[96:97], v53 offset0:128 offset1:129
  ds_read2_b32 v[98:99], v53 offset0:130 offset1:131
  s_waitcnt lgkmcnt(6)
  v_mfma_f32_16x16x32_bf16 v[68:71], v[100:103], a[20:23], v[68:71]
  v_mfma_f32_16x16x32_bf16 v[72:75], v[100:103], a[52:55], v[72:75]
  v_mfma_f32_16x16x32_bf16 v[76:79], v[100:103], a[84:87], v[76:79]
  v_mfma_f32_16x16x32_bf16 v[80:83], v[100:103], a[116:119], v[80:83]
  v_mfma_f32_16x16x32_bf16 v[84:87], v[100:103], a[148:151], v[84:87]
  v_mfma_f32_16x16x32_bf16 v[88:91], v[100:103], a[180:183], v[88:91]
  ds_read2_b32 v[100:101], v53 offset0:112 offset1:113
  ds_read2_b32 v[102:103], v53 offset0:114 offset1:115
  s_waitcnt lgkmcnt(6)
  v_mfma_f32_16x16x32_bf16 v[68:71], v[104:107], a[16:19], v[68:71]
  v_mfma_f32_16x16x32_bf16 v[72:75], v[104:107], a[48:51], v[72:75]
  v_mfma_f32_16x16x32_bf16 v[76:79], v[104:107], a[80:83], v[76:79]
  v_mfma_f32_16x16x32_bf16 v[80:83], v[104:107], a[112:115], v[80:83]
  v_mfma_f32_16x16x32_bf16 v[84:87], v[104:107], a[144:147], v[84:87]
  v_mfma_f32_16x16x32_bf16 v[88:91], v[104:107], a[176:179], v[88:91]
  ds_read2_b32 v[104:105], v53 offset0:96 offset1:97
  ds_read2_b32 v[106:107], v53 offset0:98 offset1:99
  s_waitcnt lgkmcnt(6)
  v_mfma_f32_16x16x32_bf16 v[68:71], v[92:95], a[12:15], v[68:71]
  v_mfma_f32_16x16x32_bf16 v[72:75], v[92:95], a[44:47], v[72:75]
  v_mfma_f32_16x16x32_bf16 v[76:79], v[92:95], a[76:79], v[76:79]
  v_mfma_f32_16x16x32_bf16 v[80:83], v[92:95], a[108:111], v[80:83]
  v_mfma_f32_16x16x32_bf16 v[84:87], v[92:95], a[140:143], v[84:87]
  v_mfma_f32_16x16x32_bf16 v[88:91], v[92:95], a[172:175], v[88:91]
  ds_read2_b32 v[92:93], v53 offset0:80 offset1:81
  ds_read2_b32 v[94:95], v53 offset0:82 offset1:83
  s_waitcnt lgkmcnt(6)
  v_mfma_f32_16x16x32_bf16 v[68:71], v[96:99], a[8:11], v[68:71]
  v_mfma_f32_16x16x32_bf16 v[72:75], v[96:99], a[40:43], v[72:75]
  v_mfma_f32_16x16x32_bf16 v[76:79], v[96:99], a[72:75], v[76:79]
  v_mfma_f32_16x16x32_bf16 v[80:83], v[96:99], a[104:107], v[80:83]
  v_mfma_f32_16x16x32_bf16 v[84:87], v[96:99], a[136:139], v[84:87]
  v_mfma_f32_16x16x32_bf16 v[88:91], v[96:99], a[168:171], v[88:91]
  ds_read2_b32 v[96:97], v53 offset0:64 offset1:65
  ds_read2_b32 v[98:99], v53 offset0:66 offset1:67
  s_waitcnt lgkmcnt(6)
  v_mfma_f32_16x16x32_bf16 v[68:71], v[100:103], a[4:7], v[68:71]
  v_mfma_f32_16x16x32_bf16 v[72:75], v[100:103], a[36:39], v[72:75]
  v_mfma_f32_16x16x32_bf16 v[76:79], v[100:103], a[68:71], v[76:79]
  v_mfma_f32_16x16x32_bf16 v[80:83], v[100:103], a[100:103], v[80:83]
  v_mfma_f32_16x16x32_bf16 v[84:87], v[100:103], a[132:135], v[84:87]
  v_mfma_f32_16x16x32_bf16 v[88:91], v[100:103], a[164:167], v[88:91]
  ds_read2_b32 v[100:101], v53 offset0:48 offset1:49
  ds_read2_b32 v[102:103], v53 offset0:50 offset1:51
  s_waitcnt lgkmcnt(6)
  v_mfma_f32_16x16x32_bf16 v[68:71], v[104:107], a[0:3], v[68:71]
  v_mfma_f32_16x16x32_bf16 v[72:75], v[104:107], a[32:35], v[72:75]
  v_mfma_f32_16x16x32_bf16 v[76:79], v[104:107], a[64:67], v[76:79]
  v_mfma_f32_16x16x32_bf16 v[80:83], v[104:107], a[96:99], v[80:83]
  v_mfma_f32_16x16x32_bf16 v[84:87], v[104:107], a[128:131], v[84:87]
  v_mfma_f32_16x16x32_bf16 v[88:91], v[104:107], a[160:163], v[88:91]
  ds_read2_b32 v[104:105], v53 offset0:32 offset1:33
  ds_read2_b32 v[106:107], v53 offset0:34 offset1:35
  s_waitcnt lgkmcnt(6)
  v_mfma_f32_16x16x32_bf16 v[72:75], v[92:95], a[28:31], v[72:75]
  v_mfma_f32_16x16x32_bf16 v[76:79], v[92:95], a[60:63], v[76:79]
  v_mfma_f32_16x16x32_bf16 v[80:83], v[92:95], a[92:95], v[80:83]
  v_mfma_f32_16x16x32_bf16 v[84:87], v[92:95], a[124:127], v[84:87]
  v_mfma_f32_16x16x32_bf16 v[88:91], v[92:95], a[156:159], v[88:91]
  ds_read2_b32 v[92:93], v53 offset0:16 offset1:17
  ds_read2_b32 v[94:95], v53 offset0:18 offset1:19
  s_waitcnt lgkmcnt(6)
  v_mfma_f32_16x16x32_bf16 v[72:75], v[96:99], a[24:27], v[72:75]
  v_mfma_f32_16x16x32_bf16 v[76:79], v[96:99], a[56:59], v[76:79]
  v_mfma_f32_16x16x32_bf16 v[80:83], v[96:99], a[88:91], v[80:83]
  v_mfma_f32_16x16x32_bf16 v[84:87], v[96:99], a[120:123], v[84:87]
  v_mfma_f32_16x16x32_bf16 v[88:91], v[96:99], a[152:155], v[88:91]
  ds_read2_b32 v[96:97], v53 offset0:0 offset1:1
  ds_read2_b32 v[98:99], v53 offset0:2 offset1:3
  s_waitcnt lgkmcnt(6)
  v_mfma_f32_16x16x32_bf16 v[72:75], v[100:103], a[20:23], v[72:75]
  v_mfma_f32_16x16x32_bf16 v[76:79], v[100:103], a[52:55], v[76:79]
  v_mfma_f32_16x16x32_bf16 v[80:83], v[100:103], a[84:87], v[80:83]
  v_mfma_f32_16x16x32_bf16 v[84:87], v[100:103], a[116:119], v[84:87]
  v_mfma_f32_16x16x32_bf16 v[88:91], v[100:103], a[148:151], v[88:91]
  ds_read2_b32 v[100:101], v54 offset0:224 offset1:225
  ds_read2_b32 v[102:103], v54 offset0:226 offset1:227
  s_waitcnt lgkmcnt(6)
  v_mfma_f32_16x16x32_bf16 v[72:75], v[104:107], a[16:19], v[72:75]
  v_mfma_f32_16x16x32_bf16 v[76:79], v[104:107], a[48:51], v[76:79]
  v_mfma_f32_16x16x32_bf16 v[80:83], v[104:107], a[80:83], v[80:83]
  v_mfma_f32_16x16x32_bf16 v[84:87], v[104:107], a[112:115], v[84:87]
  v_mfma_f32_16x16x32_bf16 v[88:91], v[104:107], a[144:147], v[88:91]
  ds_read2_b32 v[104:105], v54 offset0:208 offset1:209
  ds_read2_b32 v[106:107], v54 offset0:210 offset1:211
  s_waitcnt lgkmcnt(6)
  v_mfma_f32_16x16x32_bf16 v[72:75], v[92:95], a[12:15], v[72:75]
  v_mfma_f32_16x16x32_bf16 v[76:79], v[92:95], a[44:47], v[76:79]
  v_mfma_f32_16x16x32_bf16 v[80:83], v[92:95], a[76:79], v[80:83]
  v_mfma_f32_16x16x32_bf16 v[84:87], v[92:95], a[108:111], v[84:87]
  v_mfma_f32_16x16x32_bf16 v[88:91], v[92:95], a[140:143], v[88:91]
  ds_read2_b32 v[92:93], v54 offset0:192 offset1:193
  ds_read2_b32 v[94:95], v54 offset0:194 offset1:195
  s_waitcnt lgkmcnt(6)
  v_mfma_f32_16x16x32_bf16 v[72:75], v[96:99], a[8:11], v[72:75]
  v_mfma_f32_16x16x32_bf16 v[76:79], v[96:99], a[40:43], v[76:79]
  v_mfma_f32_16x16x32_bf16 v[80:83], v[96:99], a[72:75], v[80:83]
  v_mfma_f32_16x16x32_bf16 v[84:87], v[96:99], a[104:107], v[84:87]
  v_mfma_f32_16x16x32_bf16 v[88:91], v[96:99], a[136:139], v[88:91]
  ds_read2_b32 v[96:97], v54 offset0:176 offset1:177
  ds_read2_b32 v[98:99], v54 offset0:178 offset1:179
  s_waitcnt lgkmcnt(6)
  v_mfma_f32_16x16x32_bf16 v[72:75], v[100:103], a[4:7], v[72:75]
  v_mfma_f32_16x16x32_bf16 v[76:79], v[100:103], a[36:39], v[76:79]
  v_mfma_f32_16x16x32_bf16 v[80:83], v[100:103], a[68:71], v[80:83]
  v_mfma_f32_16x16x32_bf16 v[84:87], v[100:103], a[100:103], v[84:87]
  v_mfma_f32_16x16x32_bf16 v[88:91], v[100:103], a[132:135], v[88:91]
  ds_read2_b32 v[100:101], v54 offset0:160 offset1:161
  ds_read2_b32 v[102:103], v54 offset0:162 offset1:163
  s_waitcnt lgkmcnt(6)
  v_mfma_f32_16x16x32_bf16 v[72:75], v[104:107], a[0:3], v[72:75]
  v_mfma_f32_16x16x32_bf16 v[76:79], v[104:107], a[32:35], v[76:79]
  v_mfma_f32_16x16x32_bf16 v[80:83], v[104:107], a[64:67], v[80:83]
  v_mfma_f32_16x16x32_bf16 v[84:87], v[104:107], a[96:99], v[84:87]
  v_mfma_f32_16x16x32_bf16 v[88:91], v[104:107], a[128:131], v[88:91]
  ds_read2_b32 v[104:105], v54 offset0:144 offset1:145
  ds_read2_b32 v[106:107], v54 offset0:146 offset1:147
  s_waitcnt lgkmcnt(6)
  v_mfma_f32_16x16x32_bf16 v[76:79], v[92:95], a[28:31], v[76:79]
  v_mfma_f32_16x16x32_bf16 v[80:83], v[92:95], a[60:63], v[80:83]
  v_mfma_f32_16x16x32_bf16 v[84:87], v[92:95], a[92:95], v[84:87]
  v_mfma_f32_16x16x32_bf16 v[88:91], v[92:95], a[124:127], v[88:91]
  ds_read2_b32 v[92:93], v54 offset0:128 offset1:129
  ds_read2_b32 v[94:95], v54 offset0:130 offset1:131
  s_waitcnt lgkmcnt(6)
  v_mfma_f32_16x16x32_bf16 v[76:79], v[96:99], a[24:27], v[76:79]
  v_mfma_f32_16x16x32_bf16 v[80:83], v[96:99], a[56:59], v[80:83]
  v_mfma_f32_16x16x32_bf16 v[84:87], v[96:99], a[88:91], v[84:87]
  v_mfma_f32_16x16x32_bf16 v[88:91], v[96:99], a[120:123], v[88:91]
  ds_read2_b32 v[96:97], v54 offset0:112 offset1:113
  ds_read2_b32 v[98:99], v54 offset0:114 offset1:115
  s_waitcnt lgkmcnt(6)
  v_mfma_f32_16x16x32_bf16 v[76:79], v[100:103], a[20:23], v[76:79]
  v_mfma_f32_16x16x32_bf16 v[80:83], v[100:103], a[52:55], v[80:83]
  v_mfma_f32_16x16x32_bf16 v[84:87], v[100:103], a[84:87], v[84:87]
  v_mfma_f32_16x16x32_bf16 v[88:91], v[100:103], a[116:119], v[88:91]
  ds_read2_b32 v[100:101], v54 offset0:96 offset1:97
  ds_read2_b32 v[102:103], v54 offset0:98 offset1:99
  s_waitcnt lgkmcnt(6)
  v_mfma_f32_16x16x32_bf16 v[76:79], v[104:107], a[16:19], v[76:79]
  v_mfma_f32_16x16x32_bf16 v[80:83], v[104:107], a[48:51], v[80:83]
  v_mfma_f32_16x16x32_bf16 v[84:87], v[104:107], a[80:83], v[84:87]
  v_mfma_f32_16x16x32_bf16 v[88:91], v[104:107], a[112:115], v[88:91]
  ds_read2_b32 v[104:105], v54 offset0:80 offset1:81
  ds_read2_b32 v[106:107], v54 offset0:82 offset1:83
  s_waitcnt lgkmcnt(6)
  v_mfma_f32_16x16x32_bf16 v[76:79], v[92:95], a[12:15], v[76:79]
  v_mfma_f32_16x16x32_bf16 v[80:83], v[92:95], a[44:47], v[80:83]
  v_mfma_f32_16x16x32_bf16 v[84:87], v[92:95], a[76:79], v[84:87]
  v_mfma_f32_16x16x32_bf16 v[88:91], v[92:95], a[108:111], v[88:91]
  ds_read2_b32 v[92:93], v54 offset0:64 offset1:65
  ds_read2_b32 v[94:95], v54 offset0:66 offset1:67
  s_waitcnt lgkmcnt(6)
  v_mfma_f32_16x16x32_bf16 v[76:79], v[96:99], a[8:11], v[76:79]
  v_mfma_f32_16x16x32_bf16 v[80:83], v[96:99], a[40:43], v[80:83]
  v_mfma_f32_16x16x32_bf16 v[84:87], v[96:99], a[72:75], v[84:87]
  v_mfma_f32_16x16x32_bf16 v[88:91], v[96:99], a[104:107], v[88:91]
  ds_read2_b32 v[96:97], v54 offset0:48 offset1:49
  ds_read2_b32 v[98:99], v54 offset0:50 offset1:51
  s_waitcnt lgkmcnt(6)
  v_mfma_f32_16x16x32_bf16 v[76:79], v[100:103], a[4:7], v[76:79]
  v_mfma_f32_16x16x32_bf16 v[80:83], v[100:103], a[36:39], v[80:83]
  v_mfma_f32_16x16x32_bf16 v[84:87], v[100:103], a[68:71], v[84:87]
  v_mfma_f32_16x16x32_bf16 v[88:91], v[100:103], a[100:103], v[88:91]
  ds_read2_b32 v[100:101], v54 offset0:32 offset1:33
  ds_read2_b32 v[102:103], v54 offset0:34 offset1:35
  s_waitcnt lgkmcnt(6)
  v_mfma_f32_16x16x32_bf16 v[76:79], v[104:107], a[0:3], v[76:79]
  v_mfma_f32_16x16x32_bf16 v[80:83], v[104:107], a[32:35], v[80:83]
  v_mfma_f32_16x16x32_bf16 v[84:87], v[104:107], a[64:67], v[84:87]
  v_mfma_f32_16x16x32_bf16 v[88:91], v[104:107], a[96:99], v[88:91]
  ds_read2_b32 v[104:105], v54 offset0:16 offset1:17
  ds_read2_b32 v[106:107], v54 offset0:18 offset1:19
  s_waitcnt lgkmcnt(6)
  v_mfma_f32_16x16x32_bf16 v[80:83], v[92:95], a[28:31], v[80:83]
  v_mfma_f32_16x16x32_bf16 v[84:87], v[92:95], a[60:63], v[84:87]
  v_mfma_f32_16x16x32_bf16 v[88:91], v[92:95], a[92:95], v[88:91]
  ds_read2_b32 v[92:93], v54 offset0:0 offset1:1
  ds_read2_b32 v[94:95], v54 offset0:2 offset1:3
  s_waitcnt lgkmcnt(6)
  v_mfma_f32_16x16x32_bf16 v[80:83], v[96:99], a[24:27], v[80:83]
  v_mfma_f32_16x16x32_bf16 v[84:87], v[96:99], a[56:59], v[84:87]
  v_mfma_f32_16x16x32_bf16 v[88:91], v[96:99], a[88:91], v[88:91]
  ds_read2_b32 v[96:97], v55 offset0:224 offset1:225
  ds_read2_b32 v[98:99], v55 offset0:226 offset1:227
  s_waitcnt lgkmcnt(6)
  v_mfma_f32_16x16x32_bf16 v[80:83], v[100:103], a[20:23], v[80:83]
  v_mfma_f32_16x16x32_bf16 v[84:87], v[100:103], a[52:55], v[84:87]
  v_mfma_f32_16x16x32_bf16 v[88:91], v[100:103], a[84:87], v[88:91]
  ds_read2_b32 v[100:101], v55 offset0:208 offset1:209
  ds_read2_b32 v[102:103], v55 offset0:210 offset1:211
  s_waitcnt lgkmcnt(6)
  v_mfma_f32_16x16x32_bf16 v[80:83], v[104:107], a[16:19], v[80:83]
  v_mfma_f32_16x16x32_bf16 v[84:87], v[104:107], a[48:51], v[84:87]
  v_mfma_f32_16x16x32_bf16 v[88:91], v[104:107], a[80:83], v[88:91]
  ds_read2_b32 v[104:105], v55 offset0:192 offset1:193
  ds_read2_b32 v[106:107], v55 offset0:194 offset1:195
  s_waitcnt lgkmcnt(6)
  v_mfma_f32_16x16x32_bf16 v[80:83], v[92:95], a[12:15], v[80:83]
  v_mfma_f32_16x16x32_bf16 v[84:87], v[92:95], a[44:47], v[84:87]
  v_mfma_f32_16x16x32_bf16 v[88:91], v[92:95], a[76:79], v[88:91]
  ds_read2_b32 v[92:93], v55 offset0:176 offset1:177
  ds_read2_b32 v[94:95], v55 offset0:178 offset1:179
  s_waitcnt lgkmcnt(6)
  v_mfma_f32_16x16x32_bf16 v[80:83], v[96:99], a[8:11], v[80:83]
  v_mfma_f32_16x16x32_bf16 v[84:87], v[96:99], a[40:43], v[84:87]
  v_mfma_f32_16x16x32_bf16 v[88:91], v[96:99], a[72:75], v[88:91]
  ds_read2_b32 v[96:97], v55 offset0:160 offset1:161
  ds_read2_b32 v[98:99], v55 offset0:162 offset1:163
  s_waitcnt lgkmcnt(6)
  v_mfma_f32_16x16x32_bf16 v[80:83], v[100:103], a[4:7], v[80:83]
  v_mfma_f32_16x16x32_bf16 v[84:87], v[100:103], a[36:39], v[84:87]
  v_mfma_f32_16x16x32_bf16 v[88:91], v[100:103], a[68:71], v[88:91]
  ds_read2_b32 v[100:101], v55 offset0:144 offset1:145
  ds_read2_b32 v[102:103], v55 offset0:146 offset1:147
  s_waitcnt lgkmcnt(6)
  v_mfma_f32_16x16x32_bf16 v[80:83], v[104:107], a[0:3], v[80:83]
  v_mfma_f32_16x16x32_bf16 v[84:87], v[104:107], a[32:35], v[84:87]
  v_mfma_f32_16x16x32_bf16 v[88:91], v[104:107], a[64:67], v[88:91]
  ds_read2_b32 v[104:105], v55 offset0:128 offset1:129
  ds_read2_b32 v[106:107], v55 offset0:130 offset1:131
  s_waitcnt lgkmcnt(6)
  v_mfma_f32_16x16x32_bf16 v[84:87], v[92:95], a[28:31], v[84:87]
  v_mfma_f32_16x16x32_bf16 v[88:91], v[92:95], a[60:63], v[88:91]
  ds_read2_b32 v[92:93], v55 offset0:112 offset1:113
  ds_read2_b32 v[94:95], v55 offset0:114 offset1:115
  s_waitcnt lgkmcnt(6)
  v_mfma_f32_16x16x32_bf16 v[84:87], v[96:99], a[24:27], v[84:87]
  v_mfma_f32_16x16x32_bf16 v[88:91], v[96:99], a[56:59], v[88:91]
  ds_read2_b32 v[96:97], v55 offset0:96 offset1:97
  ds_read2_b32 v[98:99], v55 offset0:98 offset1:99
  s_waitcnt lgkmcnt(6)
  v_mfma_f32_16x16x32_bf16 v[84:87], v[100:103], a[20:23], v[84:87]
  v_mfma_f32_16x16x32_bf16 v[88:91], v[100:103], a[52:55], v[88:91]
  ds_read2_b32 v[100:101], v55 offset0:80 offset1:81
  ds_read2_b32 v[102:103], v55 offset0:82 offset1:83
  s_waitcnt lgkmcnt(6)
  v_mfma_f32_16x16x32_bf16 v[84:87], v[104:107], a[16:19], v[84:87]
  v_mfma_f32_16x16x32_bf16 v[88:91], v[104:107], a[48:51], v[88:91]
  ds_read2_b32 v[104:105], v55 offset0:64 offset1:65
  ds_read2_b32 v[106:107], v55 offset0:66 offset1:67
  s_waitcnt lgkmcnt(6)
  v_mfma_f32_16x16x32_bf16 v[84:87], v[92:95], a[12:15], v[84:87]
  v_mfma_f32_16x16x32_bf16 v[88:91], v[92:95], a[44:47], v[88:91]
  ds_read2_b32 v[92:93], v55 offset0:48 offset1:49
  ds_read2_b32 v[94:95], v55 offset0:50 offset1:51
  s_waitcnt lgkmcnt(6)
  v_mfma_f32_16x16x32_bf16 v[84:87], v[96:99], a[8:11], v[84:87]
  v_mfma_f32_16x16x32_bf16 v[88:91], v[96:99], a[40:43], v[88:91]
  ds_read2_b32 v[96:97], v55 offset0:32 offset1:33
  ds_read2_b32 v[98:99], v55 offset0:34 offset1:35
  s_waitcnt lgkmcnt(6)
  v_mfma_f32_16x16x32_bf16 v[84:87], v[100:103], a[4:7], v[84:87]
  v_mfma_f32_16x16x32_bf16 v[88:91], v[100:103], a[36:39], v[88:91]
  ds_read2_b32 v[100:101], v55 offset0:16 offset1:17
  ds_read2_b32 v[102:103], v55 offset0:18 offset1:19
  s_waitcnt lgkmcnt(6)
  v_mfma_f32_16x16x32_bf16 v[84:87], v[104:107], a[0:3], v[84:87]
  v_mfma_f32_16x16x32_bf16 v[88:91], v[104:107], a[32:35], v[88:91]
  ds_read2_b32 v[104:105], v55 offset0:0 offset1:1
  ds_read2_b32 v[106:107], v55 offset0:2 offset1:3
  s_waitcnt lgkmcnt(6)
  v_mfma_f32_16x16x32_bf16 v[88:91], v[92:95], a[28:31], v[88:91]
  ds_read2_b32 v[92:93], v56 offset0:224 offset1:225
  ds_read2_b32 v[94:95], v56 offset0:226 offset1:227
  s_waitcnt lgkmcnt(6)
  v_mfma_f32_16x16x32_bf16 v[88:91], v[96:99], a[24:27], v[88:91]
  ds_read2_b32 v[96:97], v56 offset0:208 offset1:209
  ds_read2_b32 v[98:99], v56 offset0:210 offset1:211
  s_waitcnt lgkmcnt(6)
  v_mfma_f32_16x16x32_bf16 v[88:91], v[100:103], a[20:23], v[88:91]
  ds_read2_b32 v[100:101], v56 offset0:192 offset1:193
  ds_read2_b32 v[102:103], v56 offset0:194 offset1:195
  s_waitcnt lgkmcnt(6)
  v_mfma_f32_16x16x32_bf16 v[88:91], v[104:107], a[16:19], v[88:91]
  ds_read2_b32 v[104:105], v56 offset0:176 offset1:177
  ds_read2_b32 v[106:107], v56 offset0:178 offset1:179
  s_waitcnt lgkmcnt(6)
  v_mfma_f32_16x16x32_bf16 v[88:91], v[92:95], a[12:15], v[88:91]
  s_waitcnt lgkmcnt(4)
  v_mfma_f32_16x16x32_bf16 v[88:91], v[96:99], a[8:11], v[88:91]
  s_waitcnt lgkmcnt(2)
  v_mfma_f32_16x16x32_bf16 v[88:91], v[100:103], a[4:7], v[88:91]
  s_waitcnt lgkmcnt(0)
  v_mfma_f32_16x16x32_bf16 v[88:91], v[104:107], a[0:3], v[88:91]
  v_lshlrev_b32 v46, 5, v4
  v_lshl_add_u32 v46, v3, 3, v46
  v_add_u32 v46, s17, v46
  ds_read_b64 v[108:109], v46 offset:512
  ds_read_b64 v[110:111], v46 offset:1024
  ds_read_b64 v[112:113], v46 offset:1536
  ds_read_b64 v[114:115], v46 offset:2048
  ds_read_b64 v[116:117], v46 offset:2560
  ds_read_b64 v[118:119], v46 offset:3072
  ds_read_b64 v[120:121], v46 offset:3584
  ds_read_b64 v[122:123], v46 offset:4096
  s_waitcnt lgkmcnt(0)
  v_lshlrev_b32 v124, 16, v108
  v_and_b32 v125, 0xffff0000, v108
  v_lshlrev_b32 v126, 16, v109
  v_and_b32 v127, 0xffff0000, v109
  v_mul_f32 v124, v124, v33
  v_mul_f32 v125, v125, v33
  v_mul_f32 v126, v126, v33
  v_mul_f32 v127, v127, v33
  v_cvt_pk_bf16_f32 v128, v124, v125
  v_cvt_pk_bf16_f32 v129, v126, v127
  v_cvt_pk_bf16_f32 v130, v60, v61
  v_cvt_pk_bf16_f32 v131, v62, v63
  v_lshlrev_b32 v124, 16, v128
  v_and_b32 v125, 0xffff0000, v128
  v_lshlrev_b32 v132, 16, v130
  v_and_b32 v133, 0xffff0000, v130
  v_lshlrev_b32 v126, 16, v129
  v_and_b32 v127, 0xffff0000, v129
  v_lshlrev_b32 v134, 16, v131
  v_and_b32 v135, 0xffff0000, v131
  v_add_f32 v124, v124, v132
  v_add_f32 v125, v125, v133
  v_add_f32 v126, v126, v134
  v_add_f32 v127, v127, v135
  v_cvt_pk_bf16_f32 v108, v124, v125
  v_cvt_pk_bf16_f32 v109, v126, v127
  ds_write_b64 v46, v[108:109] offset:512
  v_lshlrev_b32 v124, 16, v110
  v_and_b32 v125, 0xffff0000, v110
  v_lshlrev_b32 v126, 16, v111
  v_and_b32 v127, 0xffff0000, v111
  v_mul_f32 v124, v124, v33
  v_mul_f32 v125, v125, v33
  v_mul_f32 v126, v126, v33
  v_mul_f32 v127, v127, v33
  v_cvt_pk_bf16_f32 v128, v124, v125
  v_cvt_pk_bf16_f32 v129, v126, v127
  v_cvt_pk_bf16_f32 v130, v64, v65
  v_cvt_pk_bf16_f32 v131, v66, v67
  v_lshlrev_b32 v124, 16, v128
  v_and_b32 v125, 0xffff0000, v128
  v_lshlrev_b32 v132, 16, v130
  v_and_b32 v133, 0xffff0000, v130
  v_lshlrev_b32 v126, 16, v129
  v_and_b32 v127, 0xffff0000, v129
  v_lshlrev_b32 v134, 16, v131
  v_and_b32 v135, 0xffff0000, v131
  v_add_f32 v124, v124, v132
  v_add_f32 v125, v125, v133
  v_add_f32 v126, v126, v134
  v_add_f32 v127, v127, v135
  v_cvt_pk_bf16_f32 v110, v124, v125
  v_cvt_pk_bf16_f32 v111, v126, v127
  ds_write_b64 v46, v[110:111] offset:1024
  v_lshlrev_b32 v124, 16, v112
  v_and_b32 v125, 0xffff0000, v112
  v_lshlrev_b32 v126, 16, v113
  v_and_b32 v127, 0xffff0000, v113
  v_mul_f32 v124, v124, v33
  v_mul_f32 v125, v125, v33
  v_mul_f32 v126, v126, v33
  v_mul_f32 v127, v127, v33
  v_cvt_pk_bf16_f32 v128, v124, v125
  v_cvt_pk_bf16_f32 v129, v126, v127
  v_cvt_pk_bf16_f32 v130, v68, v69
  v_cvt_pk_bf16_f32 v131, v70, v71
  v_lshlrev_b32 v124, 16, v128
  v_and_b32 v125, 0xffff0000, v128
  v_lshlrev_b32 v132, 16, v130
  v_and_b32 v133, 0xffff0000, v130
  v_lshlrev_b32 v126, 16, v129
  v_and_b32 v127, 0xffff0000, v129
  v_lshlrev_b32 v134, 16, v131
  v_and_b32 v135, 0xffff0000, v131
  v_add_f32 v124, v124, v132
  v_add_f32 v125, v125, v133
  v_add_f32 v126, v126, v134
  v_add_f32 v127, v127, v135
  v_cvt_pk_bf16_f32 v112, v124, v125
  v_cvt_pk_bf16_f32 v113, v126, v127
  ds_write_b64 v46, v[112:113] offset:1536
  v_lshlrev_b32 v124, 16, v114
  v_and_b32 v125, 0xffff0000, v114
  v_lshlrev_b32 v126, 16, v115
  v_and_b32 v127, 0xffff0000, v115
  v_mul_f32 v124, v124, v33
  v_mul_f32 v125, v125, v33
  v_mul_f32 v126, v126, v33
  v_mul_f32 v127, v127, v33
  v_cvt_pk_bf16_f32 v128, v124, v125
  v_cvt_pk_bf16_f32 v129, v126, v127
  v_cvt_pk_bf16_f32 v130, v72, v73
  v_cvt_pk_bf16_f32 v131, v74, v75
  v_lshlrev_b32 v124, 16, v128
  v_and_b32 v125, 0xffff0000, v128
  v_lshlrev_b32 v132, 16, v130
  v_and_b32 v133, 0xffff0000, v130
  v_lshlrev_b32 v126, 16, v129
  v_and_b32 v127, 0xffff0000, v129
  v_lshlrev_b32 v134, 16, v131
  v_and_b32 v135, 0xffff0000, v131
  v_add_f32 v124, v124, v132
  v_add_f32 v125, v125, v133
  v_add_f32 v126, v126, v134
  v_add_f32 v127, v127, v135
  v_cvt_pk_bf16_f32 v114, v124, v125
  v_cvt_pk_bf16_f32 v115, v126, v127
  ds_write_b64 v46, v[114:115] offset:2048
  v_lshlrev_b32 v124, 16, v116
  v_and_b32 v125, 0xffff0000, v116
  v_lshlrev_b32 v126, 16, v117
  v_and_b32 v127, 0xffff0000, v117
  v_mul_f32 v124, v124, v33
  v_mul_f32 v125, v125, v33
  v_mul_f32 v126, v126, v33
  v_mul_f32 v127, v127, v33
  v_cvt_pk_bf16_f32 v128, v124, v125
  v_cvt_pk_bf16_f32 v129, v126, v127
  v_cvt_pk_bf16_f32 v130, v76, v77
  v_cvt_pk_bf16_f32 v131, v78, v79
  v_lshlrev_b32 v124, 16, v128
  v_and_b32 v125, 0xffff0000, v128
  v_lshlrev_b32 v132, 16, v130
  v_and_b32 v133, 0xffff0000, v130
  v_lshlrev_b32 v126, 16, v129
  v_and_b32 v127, 0xffff0000, v129
  v_lshlrev_b32 v134, 16, v131
  v_and_b32 v135, 0xffff0000, v131
  v_add_f32 v124, v124, v132
  v_add_f32 v125, v125, v133
  v_add_f32 v126, v126, v134
  v_add_f32 v127, v127, v135
  v_cvt_pk_bf16_f32 v116, v124, v125
  v_cvt_pk_bf16_f32 v117, v126, v127
  ds_write_b64 v46, v[116:117] offset:2560
  v_lshlrev_b32 v124, 16, v118
  v_and_b32 v125, 0xffff0000, v118
  v_lshlrev_b32 v126, 16, v119
  v_and_b32 v127, 0xffff0000, v119
  v_mul_f32 v124, v124, v33
  v_mul_f32 v125, v125, v33
  v_mul_f32 v126, v126, v33
  v_mul_f32 v127, v127, v33
  v_cvt_pk_bf16_f32 v128, v124, v125
  v_cvt_pk_bf16_f32 v129, v126, v127
  v_cvt_pk_bf16_f32 v130, v80, v81
  v_cvt_pk_bf16_f32 v131, v82, v83
  v_lshlrev_b32 v124, 16, v128
  v_and_b32 v125, 0xffff0000, v128
  v_lshlrev_b32 v132, 16, v130
  v_and_b32 v133, 0xffff0000, v130
  v_lshlrev_b32 v126, 16, v129
  v_and_b32 v127, 0xffff0000, v129
  v_lshlrev_b32 v134, 16, v131
  v_and_b32 v135, 0xffff0000, v131
  v_add_f32 v124, v124, v132
  v_add_f32 v125, v125, v133
  v_add_f32 v126, v126, v134
  v_add_f32 v127, v127, v135
  v_cvt_pk_bf16_f32 v118, v124, v125
  v_cvt_pk_bf16_f32 v119, v126, v127
  ds_write_b64 v46, v[118:119] offset:3072
  v_lshlrev_b32 v124, 16, v120
  v_and_b32 v125, 0xffff0000, v120
  v_lshlrev_b32 v126, 16, v121
  v_and_b32 v127, 0xffff0000, v121
  v_mul_f32 v124, v124, v33
  v_mul_f32 v125, v125, v33
  v_mul_f32 v126, v126, v33
  v_mul_f32 v127, v127, v33
  v_cvt_pk_bf16_f32 v128, v124, v125
  v_cvt_pk_bf16_f32 v129, v126, v127
  v_cvt_pk_bf16_f32 v130, v84, v85
  v_cvt_pk_bf16_f32 v131, v86, v87
  v_lshlrev_b32 v124, 16, v128
  v_and_b32 v125, 0xffff0000, v128
  v_lshlrev_b32 v132, 16, v130
  v_and_b32 v133, 0xffff0000, v130
  v_lshlrev_b32 v126, 16, v129
  v_and_b32 v127, 0xffff0000, v129
  v_lshlrev_b32 v134, 16, v131
  v_and_b32 v135, 0xffff0000, v131
  v_add_f32 v124, v124, v132
  v_add_f32 v125, v125, v133
  v_add_f32 v126, v126, v134
  v_add_f32 v127, v127, v135
  v_cvt_pk_bf16_f32 v120, v124, v125
  v_cvt_pk_bf16_f32 v121, v126, v127
  ds_write_b64 v46, v[120:121] offset:3584
  v_lshlrev_b32 v124, 16, v122
  v_and_b32 v125, 0xffff0000, v122
  v_lshlrev_b32 v126, 16, v123
  v_and_b32 v127, 0xffff0000, v123
  v_mul_f32 v124, v124, v33
  v_mul_f32 v125, v125, v33
  v_mul_f32 v126, v126, v33
  v_mul_f32 v127, v127, v33
  v_cvt_pk_bf16_f32 v128, v124, v125
  v_cvt_pk_bf16_f32 v129, v126, v127
  v_cvt_pk_bf16_f32 v130, v88, v89
  v_cvt_pk_bf16_f32 v131, v90, v91
  v_lshlrev_b32 v124, 16, v128
  v_and_b32 v125, 0xffff0000, v128
  v_lshlrev_b32 v132, 16, v130
  v_and_b32 v133, 0xffff0000, v130
  v_lshlrev_b32 v126, 16, v129
  v_and_b32 v127, 0xffff0000, v129
  v_lshlrev_b32 v134, 16, v131
  v_and_b32 v135, 0xffff0000, v131
  v_add_f32 v124, v124, v132
  v_add_f32 v125, v125, v133
  v_add_f32 v126, v126, v134
  v_add_f32 v127, v127, v135
  v_cvt_pk_bf16_f32 v122, v124, v125
  v_cvt_pk_bf16_f32 v123, v126, v127
  ds_write_b64 v46, v[122:123] offset:4096
  s_waitcnt lgkmcnt(0)
  s_barrier
  v_lshlrev_b32 v6, 3, v0
  v_mul_u32_u24 v5, 7168, v0
  v_add_u32 v36, 512, v6
  ds_read_b64 v[8:9], v36
  v_add_u32 v36, 25088, v6
  ds_read_b64 v[10:11], v36
  v_add_u32 v36, 49664, v6
  ds_read_b64 v[12:13], v36
  v_add_u32 v36, 74240, v6
  ds_read_b64 v[14:15], v36
  s_waitcnt lgkmcnt(0)
  s_add_u32 s22, s21, 0
  s_add_u32 s23, s22, 3584
  v_perm_b32 v16, v10, v8, s24
  v_perm_b32 v17, v14, v12, s24
  buffer_store_dwordx2 v[16:17], v5, s[92:95], s22 offen offset:0
  v_perm_b32 v18, v10, v8, s25
  v_perm_b32 v19, v14, v12, s25
  buffer_store_dwordx2 v[18:19], v5, s[92:95], s22 offen offset:1792
  v_perm_b32 v20, v11, v9, s24
  v_perm_b32 v21, v15, v13, s24
  buffer_store_dwordx2 v[20:21], v5, s[92:95], s23 offen offset:0
  v_perm_b32 v22, v11, v9, s25
  v_perm_b32 v23, v15, v13, s25
  buffer_store_dwordx2 v[22:23], v5, s[92:95], s23 offen offset:1792
  v_add_u32 v36, 2560, v6
  ds_read_b64 v[8:9], v36
  v_add_u32 v36, 27136, v6
  ds_read_b64 v[10:11], v36
  v_add_u32 v36, 51712, v6
  ds_read_b64 v[12:13], v36
  v_add_u32 v36, 76288, v6
  ds_read_b64 v[14:15], v36
  s_waitcnt lgkmcnt(0)
  s_add_u32 s22, s21, 1835008
  s_add_u32 s23, s22, 3584
  v_perm_b32 v24, v10, v8, s24
  v_perm_b32 v25, v14, v12, s24
  buffer_store_dwordx2 v[24:25], v5, s[92:95], s22 offen offset:0
  v_perm_b32 v26, v10, v8, s25
  v_perm_b32 v27, v14, v12, s25
  buffer_store_dwordx2 v[26:27], v5, s[92:95], s22 offen offset:1792
  v_perm_b32 v28, v11, v9, s24
  v_perm_b32 v29, v15, v13, s24
  buffer_store_dwordx2 v[28:29], v5, s[92:95], s23 offen offset:0
  v_perm_b32 v30, v11, v9, s25
  v_perm_b32 v31, v15, v13, s25
  buffer_store_dwordx2 v[30:31], v5, s[92:95], s23 offen offset:1792
  s_cmp_lg_u32 s16, 0
  s_cbranch_scc1 w0_41
w0_41:
  s_branch wk_loop
wk_tok:
  s_sub_u32 s3, s3, 864
  s_and_b32 s18, s3, 3
  s_lshr_b32 s17, s3, 2
  s_cmp_lt_u32 s17, 8
  s_cbranch_scc1 wk_tokp
  s_sub_u32 s17, s17, 64
  s_cmp_ge_i32 s17, 56
  s_cbranch_scc1 wk_toko
  s_add_u32 s20, s17, 56
  s_lshr_b32 s17, s20, 1
  s_bitcmp0_b32 s20, 0
  s_cbranch_scc1 wk_toko
  s_add_u32 s17, s17, 8
wk_tokp:
  s_lshl_b32 s20, s18, 2
  s_add_u32 s20, s20, s16
  s_lshl_b32 s21, s17, 4
  s_add_u32 s21, s21, s20
  s_mul_i32 s21, s21, 28672
  s_add_u32 s21, s21, 12845056
  s_mul_i32 s23, s17, 28672
  s_add_u32 s23, s23, 73400320
  s_mul_i32 s24, s17, 7168
  s_add_u32 s24, s24, 88068096
  s_lshr_b32 s25, s17, 3
  s_lshl_b32 s25, s25, 4
  s_add_u32 s25, s25, s20
  s_lshl_b32 s25, s25, 7
  s_add_u32 s25, s25, 88545280
  v_mov_b32 v60, 0
  s_mov_b32 s30, 0
wp_wf:
  buffer_load_dword v61, v60, s[8:11], s25 offen sc1
  s_waitcnt vmcnt(0)
  v_cmp_ne_u32 vcc, 56, v61
  s_cbranch_vccz wp_wf_ok
  s_sleep 1
  s_cmp_ge_u32 s17, 61
  s_cbranch_scc1 wp_wf_bo
  s_sleep 4
  s_cmp_ge_u32 s17, 56
  s_cbranch_scc1 wp_wf_bo
  s_sleep 127
wp_wf_bo:
  s_add_u32 s30, s30, 1
  s_cmp_lt_u32 s30, 30000
  s_cbranch_scc1 wp_wf
  s_branch wp_abort
wp_wf_ok:
  s_add_u32 s22, s21, 0
  buffer_load_dwordx4 a[0:3], v2, s[8:11], s22 offen offset:0 sc1
  buffer_load_dwordx4 a[4:7], v2, s[8:11], s22 offen offset:1024 sc1
  buffer_load_dwordx4 a[8:11], v2, s[8:11], s22 offen offset:2048 sc1
  buffer_load_dwordx4 a[12:15], v2, s[8:11], s22 offen offset:3072 sc1
  s_add_u32 s22, s21, 4096
  buffer_load_dwordx4 a[16:19], v2, s[8:11], s22 offen offset:0 sc1
  buffer_load_dwordx4 a[20:23], v2, s[8:11], s22 offen offset:1024 sc1
  buffer_load_dwordx4 a[24:27], v2, s[8:11], s22 offen offset:2048 sc1
  buffer_load_dwordx4 a[28:31], v2, s[8:11], s22 offen offset:3072 sc1
  s_add_u32 s22, s21, 8192
  buffer_load_dwordx4 a[32:35], v2, s[8:11], s22 offen offset:0 sc1
  buffer_load_dwordx4 a[36:39], v2, s[8:11], s22 offen offset:1024 sc1
  buffer_load_dwordx4 a[40:43], v2, s[8:11], s22 offen offset:2048 sc1
  buffer_load_dwordx4 a[44:47], v2, s[8:11], s22 offen offset:3072 sc1
  s_add_u32 s22, s21, 12288
  buffer_load_dwordx4 a[48:51], v2, s[8:11], s22 offen offset:0 sc1
  buffer_load_dwordx4 a[52:55], v2, s[8:11], s22 offen offset:1024 sc1
  buffer_load_dwordx4 a[56:59], v2, s[8:11], s22 offen offset:2048 sc1
  buffer_load_dwordx4 a[60:63], v2, s[8:11], s22 offen offset:3072 sc1
  s_add_u32 s22, s21, 16384
  buffer_load_dwordx4 a[64:67], v2, s[8:11], s22 offen offset:0 sc1
  buffer_load_dwordx4 a[68:71], v2, s[8:11], s22 offen offset:1024 sc1
  buffer_load_dwordx4 a[72:75], v2, s[8:11], s22 offen offset:2048 sc1
  buffer_load_dwordx4 a[76:79], v2, s[8:11], s22 offen offset:3072 sc1
  s_add_u32 s22, s21, 20480
  buffer_load_dwordx4 a[80:83], v2, s[8:11], s22 offen offset:0 sc1
  buffer_load_dwordx4 a[84:87], v2, s[8:11], s22 offen offset:1024 sc1
  buffer_load_dwordx4 a[88:91], v2, s[8:11], s22 offen offset:2048 sc1
  buffer_load_dwordx4 a[92:95], v2, s[8:11], s22 offen offset:3072 sc1
  s_add_u32 s22, s21, 24576
  buffer_load_dwordx4 a[96:99], v2, s[8:11], s22 offen offset:0 sc1
  buffer_load_dwordx4 a[100:103], v2, s[8:11], s22 offen offset:1024 sc1
  buffer_load_dwordx4 a[104:107], v2, s[8:11], s22 offen offset:2048 sc1
  buffer_load_dwordx4 a[108:111], v2, s[8:11], s22 offen offset:3072 sc1
  s_add_u32 s22, s23, 0
  buffer_load_dwordx4 a[112:115], v2, s[8:11], s22 offen offset:0 sc1
  buffer_load_dwordx4 a[116:119], v2, s[8:11], s22 offen offset:1024 sc1
  buffer_load_dwordx4 a[120:123], v2, s[8:11], s22 offen offset:2048 sc1
  buffer_load_dwordx4 a[124:127], v2, s[8:11], s22 offen offset:3072 sc1
  s_add_u32 s22, s23, 4096
  buffer_load_dwordx4 a[128:131], v2, s[8:11], s22 offen offset:0 sc1
  buffer_load_dwordx4 a[132:135], v2, s[8:11], s22 offen offset:1024 sc1
  buffer_load_dwordx4 a[136:139], v2, s[8:11], s22 offen offset:2048 sc1
  buffer_load_dwordx4 a[140:143], v2, s[8:11], s22 offen offset:3072 sc1
  s_add_u32 s22, s23, 8192
  buffer_load_dwordx4 a[144:147], v2, s[8:11], s22 offen offset:0 sc1
  buffer_load_dwordx4 a[148:151], v2, s[8:11], s22 offen offset:1024 sc1
  buffer_load_dwordx4 a[152:155], v2, s[8:11], s22 offen offset:2048 sc1
  buffer_load_dwordx4 a[156:159], v2, s[8:11], s22 offen offset:3072 sc1
  s_add_u32 s22, s23, 12288
  buffer_load_dwordx4 a[160:163], v2, s[8:11], s22 offen offset:0 sc1
  buffer_load_dwordx4 a[164:167], v2, s[8:11], s22 offen offset:1024 sc1
  buffer_load_dwordx4 a[168:171], v2, s[8:11], s22 offen offset:2048 sc1
  buffer_load_dwordx4 a[172:175], v2, s[8:11], s22 offen offset:3072 sc1
  s_add_u32 s22, s23, 16384
  buffer_load_dwordx4 a[176:179], v2, s[8:11], s22 offen offset:0 sc1
  buffer_load_dwordx4 a[180:183], v2, s[8:11], s22 offen offset:1024 sc1
  buffer_load_dwordx4 a[184:187], v2, s[8:11], s22 offen offset:2048 sc1
  buffer_load_dwordx4 a[188:191], v2, s[8:11], s22 offen offset:3072 sc1
  s_add_u32 s22, s23, 20480
  buffer_load_dwordx4 a[192:195], v2, s[8:11], s22 offen offset:0 sc1
  buffer_load_dwordx4 a[196:199], v2, s[8:11], s22 offen offset:1024 sc1
  buffer_load_dwordx4 a[200:203], v2, s[8:11], s22 offen offset:2048 sc1
  buffer_load_dwordx4 a[204:207], v2, s[8:11], s22 offen offset:3072 sc1
  s_add_u32 s22, s23, 24576
  buffer_load_dwordx4 a[208:211], v2, s[8:11], s22 offen offset:0 sc1
  buffer_load_dwordx4 a[212:215], v2, s[8:11], s22 offen offset:1024 sc1
  buffer_load_dwordx4 a[216:219], v2, s[8:11], s22 offen offset:2048 sc1
  buffer_load_dwordx4 a[220:223], v2, s[8:11], s22 offen offset:3072 sc1
  v_lshl_add_u32 v5, v3, 2, 0
  v_cmp_le_u32 s[40:41], v5, v4
  v_lshl_add_u32 v5, v3, 2, 1
  v_cmp_le_u32 s[42:43], v5, v4
  v_lshl_add_u32 v5, v3, 2, 2
  v_cmp_le_u32 s[44:45], v5, v4
  v_lshl_add_u32 v5, v3, 2, 3
  v_cmp_le_u32 s[46:47], v5, v4
  v_cmp_gt_u32 s[48:49], 2, v3
  v_mov_b32 v6, 0xff800000
  s_waitcnt vmcnt(0)
  v_mfma_f32_16x16x32_bf16 v[8:11], a[112:115], a[0:3], 0
  v_mfma_f32_16x16x32_bf16 v[12:15], a[112:115], a[56:59], 0
  v_mfma_f32_16x16x32_bf16 v[16:19], a[168:171], a[56:59], 0
  v_mfma_f32_16x16x32_bf16 v[8:11], a[116:119], a[4:7], v[8:11]
  v_mfma_f32_16x16x32_bf16 v[12:15], a[116:119], a[60:63], v[12:15]
  v_mfma_f32_16x16x32_bf16 v[16:19], a[172:175], a[60:63], v[16:19]
  v_mfma_f32_16x16x32_bf16 v[8:11], a[120:123], a[8:11], v[8:11]
  v_mfma_f32_16x16x32_bf16 v[12:15], a[120:123], a[64:67], v[12:15]
  v_mfma_f32_16x16x32_bf16 v[16:19], a[176:179], a[64:67], v[16:19]
  v_mfma_f32_16x16x32_bf16 v[8:11], a[124:127], a[12:15], v[8:11]
  v_mfma_f32_16x16x32_bf16 v[12:15], a[124:127], a[68:71], v[12:15]
  v_mfma_f32_16x16x32_bf16 v[16:19], a[180:183], a[68:71], v[16:19]
  v_mfma_f32_16x16x32_bf16 v[8:11], a[128:131], a[16:19], v[8:11]
  v_mfma_f32_16x16x32_bf16 v[12:15], a[128:131], a[72:75], v[12:15]
  v_mfma_f32_16x16x32_bf16 v[16:19], a[184:187], a[72:75], v[16:19]
  v_mfma_f32_16x16x32_bf16 v[8:11], a[132:135], a[20:23], v[8:11]
  v_mfma_f32_16x16x32_bf16 v[12:15], a[132:135], a[76:79], v[12:15]
  v_mfma_f32_16x16x32_bf16 v[16:19], a[188:191], a[76:79], v[16:19]
  v_mfma_f32_16x16x32_bf16 v[8:11], a[136:139], a[24:27], v[8:11]
  v_mfma_f32_16x16x32_bf16 v[12:15], a[136:139], a[80:83], v[12:15]
  v_mfma_f32_16x16x32_bf16 v[16:19], a[192:195], a[80:83], v[16:19]
  v_mfma_f32_16x16x32_bf16 v[8:11], a[140:143], a[28:31], v[8:11]
  v_mfma_f32_16x16x32_bf16 v[12:15], a[140:143], a[84:87], v[12:15]
  v_mfma_f32_16x16x32_bf16 v[16:19], a[196:199], a[84:87], v[16:19]
  v_mfma_f32_16x16x32_bf16 v[8:11], a[144:147], a[32:35], v[8:11]
  v_mfma_f32_16x16x32_bf16 v[12:15], a[144:147], a[88:91], v[12:15]
  v_mfma_f32_16x16x32_bf16 v[16:19], a[200:203], a[88:91], v[16:19]
  v_mfma_f32_16x16x32_bf16 v[8:11], a[148:151], a[36:39], v[8:11]
  v_mfma_f32_16x16x32_bf16 v[12:15], a[148:151], a[92:95], v[12:15]
  v_mfma_f32_16x16x32_bf16 v[16:19], a[204:207], a[92:95], v[16:19]
  v_mfma_f32_16x16x32_bf16 v[8:11], a[152:155], a[40:43], v[8:11]
  v_mfma_f32_16x16x32_bf16 v[12:15], a[152:155], a[96:99], v[12:15]
  v_mfma_f32_16x16x32_bf16 v[16:19], a[208:211], a[96:99], v[16:19]
  v_mfma_f32_16x16x32_bf16 v[8:11], a[156:159], a[44:47], v[8:11]
  v_mfma_f32_16x16x32_bf16 v[12:15], a[156:159], a[100:103], v[12:15]
  v_mfma_f32_16x16x32_bf16 v[16:19], a[212:215], a[100:103], v[16:19]
  v_mfma_f32_16x16x32_bf16 v[8:11], a[160:163], a[48:51], v[8:11]
  v_mfma_f32_16x16x32_bf16 v[12:15], a[160:163], a[104:107], v[12:15]
  v_mfma_f32_16x16x32_bf16 v[16:19], a[216:219], a[104:107], v[16:19]
  v_mfma_f32_16x16x32_bf16 v[8:11], a[164:167], a[52:55], v[8:11]
  v_mfma_f32_16x16x32_bf16 v[12:15], a[164:167], a[108:111], v[12:15]
  v_mfma_f32_16x16x32_bf16 v[16:19], a[220:223], a[108:111], v[16:19]
  s_mul_i32 s22, s20, 448
  v_mov_b32 v62, s22
  s_mov_b32 s30, 0
wp_pm:
  s_cmp_ge_u32 s17, 64
  s_cbranch_scc1 wp_pf
  s_cmp_ge_u32 s17, 61
  s_cbranch_scc1 mp_42a
  v_mov_b32 v61, 0
  s_mov_b64 exec, 1
  buffer_atomic_or v61, v62, s[8:11], s24 offen sc0
  s_mov_b64 exec, -1
  s_branch mp_42b
mp_42a:
  buffer_load_dword v61, v62, s[8:11], s24 offen sc1
mp_42b:
  s_waitcnt vmcnt(0)
  v_cmp_eq_u32 vcc, -1, v61
  s_cbranch_vccnz wp_pr
wp_pf:
  s_add_u32 s22, s24, 4096
  buffer_load_dwordx4 v[64:67], v2, s[8:11], s24 offen offset:0 sc1
  buffer_load_dwordx4 v[68:71], v2, s[8:11], s24 offen offset:1024 sc1
  buffer_load_dwordx4 v[72:75], v2, s[8:11], s24 offen offset:2048 sc1
  buffer_load_dwordx4 v[76:79], v2, s[8:11], s24 offen offset:3072 sc1
  buffer_load_dwordx4 v[80:83], v2, s[8:11], s22 offen offset:0 sc1
  buffer_load_dwordx4 v[84:87], v2, s[8:11], s22 offen offset:1024 sc1
  buffer_load_dwordx4 v[88:91], v2, s[8:11], s22 offen offset:2048 sc1
  s_waitcnt vmcnt(0)
  v_max_u32 v61, v64, v65
  v_max3_u32 v61, v61, v66, v67
  v_max3_u32 v61, v61, v68, v69
  v_max3_u32 v61, v61, v70, v71
  v_max3_u32 v61, v61, v72, v73
  v_max3_u32 v61, v61, v74, v75
  v_max3_u32 v61, v61, v76, v77
  v_max3_u32 v61, v61, v78, v79
  v_max3_u32 v61, v61, v80, v81
  v_max3_u32 v61, v61, v82, v83
  v_max3_u32 v61, v61, v84, v85
  v_max3_u32 v61, v61, v86, v87
  v_max3_u32 v61, v61, v88, v89
  v_max3_u32 v61, v61, v90, v91
  v_cmp_eq_u32 vcc, -1, v61
  s_cbranch_vccz wp_pk
wp_pr:
  s_sleep 1
  s_cmp_ge_u32 s17, 61
  s_cbranch_scc1 wp_pm_bo
  s_sleep 4
  s_cmp_ge_u32 s17, 56
  s_cbranch_scc1 wp_pm_bo
  s_sleep 127
wp_pm_bo:
  s_add_u32 s30, s30, 1
  s_cmp_lt_u32 s30, 30000
  s_cbranch_scc1 wp_pm
  s_branch wp_abort
wp_pk:
  buffer_load_dword v250, v251, s[12:15], 0 offen sc1
  v_mfma_f32_16x16x32_bf16 v[20:23], v[64:67], a[0:3], 0
  v_mfma_f32_16x16x32_bf16 v[24:27], v[64:67], a[4:7], 0
  v_mfma_f32_16x16x32_bf16 v[28:31], v[64:67], a[56:59], 0
  v_mfma_f32_16x16x32_bf16 v[32:35], v[64:67], a[60:63], 0
  v_mfma_f32_16x16x32_bf16 v[20:23], v[68:71], a[8:11], v[20:23]
  v_mfma_f32_16x16x32_bf16 v[24:27], v[68:71], a[12:15], v[24:27]
  v_mfma_f32_16x16x32_bf16 v[28:31], v[68:71], a[64:67], v[28:31]
  v_mfma_f32_16x16x32_bf16 v[32:35], v[68:71], a[68:71], v[32:35]
  v_mfma_f32_16x16x32_bf16 v[20:23], v[72:75], a[16:19], v[20:23]
  v_mfma_f32_16x16x32_bf16 v[24:27], v[72:75], a[20:23], v[24:27]
  v_mfma_f32_16x16x32_bf16 v[28:31], v[72:75], a[72:75], v[28:31]
  v_mfma_f32_16x16x32_bf16 v[32:35], v[72:75], a[76:79], v[32:35]
  v_mfma_f32_16x16x32_bf16 v[20:23], v[76:79], a[24:27], v[20:23]
  v_mfma_f32_16x16x32_bf16 v[24:27], v[76:79], a[28:31], v[24:27]
  v_mfma_f32_16x16x32_bf16 v[28:31], v[76:79], a[80:83], v[28:31]
  v_mfma_f32_16x16x32_bf16 v[32:35], v[76:79], a[84:87], v[32:35]
  v_mfma_f32_16x16x32_bf16 v[20:23], v[80:83], a[32:35], v[20:23]
  v_mfma_f32_16x16x32_bf16 v[24:27], v[80:83], a[36:39], v[24:27]
  v_mfma_f32_16x16x32_bf16 v[28:31], v[80:83], a[88:91], v[28:31]
  v_mfma_f32_16x16x32_bf16 v[32:35], v[80:83], a[92:95], v[32:35]
  v_mfma_f32_16x16x32_bf16 v[20:23], v[84:87], a[40:43], v[20:23]
  v_mfma_f32_16x16x32_bf16 v[24:27], v[84:87], a[44:47], v[24:27]
  v_mfma_f32_16x16x32_bf16 v[28:31], v[84:87], a[96:99], v[28:31]
  v_mfma_f32_16x16x32_bf16 v[32:35], v[84:87], a[100:103], v[32:35]
  v_mfma_f32_16x16x32_bf16 v[20:23], v[88:91], a[48:51], v[20:23]
  v_mfma_f32_16x16x32_bf16 v[24:27], v[88:91], a[52:55], v[24:27]
  v_mfma_f32_16x16x32_bf16 v[28:31], v[88:91], a[104:107], v[28:31]
  v_mfma_f32_16x16x32_bf16 v[32:35], v[88:91], a[108:111], v[32:35]
  s_lshl_b32 s25, s17, 1
  s_mul_i32 s25, s25, 20480
  s_add_u32 s25, s25, 85446656
  s_lshl_b32 s26, s20, 10
  s_add_u32 s26, s26, s25
  s_lshl_b32 s27, s18, 10
  s_add_u32 s27, s27, s25
  s_lshr_b32 s28, s16, 1
  s_lshl_b32 s28, s28, 3
  s_add_u32 s27, s27, s28
  s_add_u32 s27, s27, 16384
  s_and_b32 s28, s16, 1
  s_cmp_eq_u32 s28, 0
  s_cselect_b32 s50, -1, 0
  s_cselect_b32 s51, 0, -1
  v_cndmask_b32 v8, v6, v8, s[40:41]
  v_cndmask_b32 v9, v6, v9, s[42:43]
  v_cndmask_b32 v10, v6, v10, s[44:45]
  v_cndmask_b32 v11, v6, v11, s[46:47]
  v_cndmask_b32 v20, v24, v20, s[48:49]
  v_cndmask_b32 v21, v25, v21, s[48:49]
  v_cndmask_b32 v22, v26, v22, s[48:49]
  v_cndmask_b32 v23, v27, v23, s[48:49]
  v_mov_b32 v24, v20
  v_mov_b32 v25, v21
  v_mov_b32 v26, v22
  v_mov_b32 v27, v23
  v_permlane32_swap_b32 v20, v24
  v_permlane32_swap_b32 v21, v25
  v_permlane32_swap_b32 v22, v26
  v_permlane32_swap_b32 v23, v27
  v_add_f32 v20, v20, v24
  v_add_f32 v21, v21, v25
  v_add_f32 v22, v22, v26
  v_add_f32 v23, v23, v27
  v_max3_f32 v40, v8, v9, v10
  v_max3_f32 v40, v40, v11, v20
  v_max3_f32 v40, v40, v21, v22
  v_max_f32 v40, v40, v23
  v_mov_b32 v41, v40
  s_nop 1
  v_permlane16_swap_b32 v40, v41
  v_max_f32 v40, v40, v41
  v_mov_b32 v41, v40
  s_nop 1
  v_permlane32_swap_b32 v40, v41
  v_max_f32 v40, v40, v41
  v_sub_f32 v8, v8, v40
  v_sub_f32 v9, v9, v40
  v_sub_f32 v10, v10, v40
  v_sub_f32 v11, v11, v40
  v_sub_f32 v20, v20, v40
  v_sub_f32 v21, v21, v40
  v_sub_f32 v22, v22, v40
  v_sub_f32 v23, v23, v40
  v_exp_f32 v8, v8
  v_exp_f32 v9, v9
  v_exp_f32 v10, v10
  v_exp_f32 v11, v11
  v_exp_f32 v20, v20
  v_exp_f32 v21, v21
  v_exp_f32 v22, v22
  v_exp_f32 v23, v23
  v_add_f32 v42, v20, v21
  v_add_f32 v43, v22, v23
  v_add_f32 v42, v42, v43
  v_mul_f32 v42, 0.5, v42
  v_add_f32 v42, v42, v8
  v_add_f32 v42, v42, v9
  v_add_f32 v42, v42, v10
  v_add_f32 v42, v42, v11
  v_mov_b32 v41, v42
  s_nop 1
  v_permlane16_swap_b32 v42, v41
  v_add_f32 v42, v42, v41
  v_mov_b32 v41, v42
  s_nop 1
  v_permlane32_swap_b32 v42, v41
  v_add_f32 v42, v42, v41
  v_rcp_f32 v42, v42
  s_nop 0
  v_mul_f32 v8, v8, v42
  v_mul_f32 v9, v9, v42
  v_mul_f32 v10, v10, v42
  v_mul_f32 v11, v11, v42
  v_mul_f32 v20, v20, v42
  v_mul_f32 v21, v21, v42
  v_mul_f32 v22, v22, v42
  v_mul_f32 v23, v23, v42
  v_cvt_pk_bf16_f32 v44, v8, v9
  v_cvt_pk_bf16_f32 v45, v10, v11
  v_mov_b32 v46, 0
  v_mov_b32 v47, 0
  v_cvt_pk_bf16_f32 v48, v20, v21
  v_cvt_pk_bf16_f32 v49, v22, v23
  v_min_u32 v44, -2, v44
  v_min_u32 v45, -2, v45
  v_min_u32 v46, -2, v46
  v_min_u32 v47, -2, v47
  v_min_u32 v48, -2, v48
  v_min_u32 v49, -2, v49
  buffer_store_dwordx4 v[44:47], v2, s[8:11], s26 offen sc1
  s_mov_b64 exec, s[50:51]
  buffer_store_dwordx2 v[48:49], v2, s[8:11], s27 offen sc1
  s_mov_b64 exec, -1
  s_add_u32 s26, s26, 20480
  s_add_u32 s27, s27, 20480
  v_cndmask_b32 v16, v6, v16, s[40:41]
  v_cndmask_b32 v17, v6, v17, s[42:43]
  v_cndmask_b32 v18, v6, v18, s[44:45]
  v_cndmask_b32 v19, v6, v19, s[46:47]
  v_cndmask_b32 v28, v32, v28, s[48:49]
  v_cndmask_b32 v29, v33, v29, s[48:49]
  v_cndmask_b32 v30, v34, v30, s[48:49]
  v_cndmask_b32 v31, v35, v31, s[48:49]
  v_mov_b32 v32, v28
  v_mov_b32 v33, v29
  v_mov_b32 v34, v30
  v_mov_b32 v35, v31
  v_permlane32_swap_b32 v28, v32
  v_permlane32_swap_b32 v29, v33
  v_permlane32_swap_b32 v30, v34
  v_permlane32_swap_b32 v31, v35
  v_add_f32 v28, v28, v32
  v_add_f32 v29, v29, v33
  v_add_f32 v30, v30, v34
  v_add_f32 v31, v31, v35
  v_max3_f32 v40, v12, v13, v14
  v_max3_f32 v40, v40, v15, v16
  v_max3_f32 v40, v40, v17, v18
  v_max3_f32 v40, v40, v19, v28
  v_max3_f32 v40, v40, v29, v30
  v_max_f32 v40, v40, v31
  v_mov_b32 v41, v40
  s_nop 1
  v_permlane16_swap_b32 v40, v41
  v_max_f32 v40, v40, v41
  v_mov_b32 v41, v40
  s_nop 1
  v_permlane32_swap_b32 v40, v41
  v_max_f32 v40, v40, v41
  v_sub_f32 v12, v12, v40
  v_sub_f32 v13, v13, v40
  v_sub_f32 v14, v14, v40
  v_sub_f32 v15, v15, v40
  v_sub_f32 v16, v16, v40
  v_sub_f32 v17, v17, v40
  v_sub_f32 v18, v18, v40
  v_sub_f32 v19, v19, v40
  v_sub_f32 v28, v28, v40
  v_sub_f32 v29, v29, v40
  v_sub_f32 v30, v30, v40
  v_sub_f32 v31, v31, v40
  v_exp_f32 v12, v12
  v_exp_f32 v13, v13
  v_exp_f32 v14, v14
  v_exp_f32 v15, v15
  v_exp_f32 v16, v16
  v_exp_f32 v17, v17
  v_exp_f32 v18, v18
  v_exp_f32 v19, v19
  v_exp_f32 v28, v28
  v_exp_f32 v29, v29
  v_exp_f32 v30, v30
  v_exp_f32 v31, v31
  v_add_f32 v42, v28, v29
  v_add_f32 v43, v30, v31
  v_add_f32 v42, v42, v43
  v_mul_f32 v42, 0.5, v42
  v_add_f32 v42, v42, v12
  v_add_f32 v42, v42, v13
  v_add_f32 v42, v42, v14
  v_add_f32 v42, v42, v15
  v_add_f32 v42, v42, v16
  v_add_f32 v42, v42, v17
  v_add_f32 v42, v42, v18
  v_add_f32 v42, v42, v19
  v_mov_b32 v41, v42
  s_nop 1
  v_permlane16_swap_b32 v42, v41
  v_add_f32 v42, v42, v41
  v_mov_b32 v41, v42
  s_nop 1
  v_permlane32_swap_b32 v42, v41
  v_add_f32 v42, v42, v41
  v_rcp_f32 v42, v42
  s_nop 0
  v_mul_f32 v12, v12, v42
  v_mul_f32 v13, v13, v42
  v_mul_f32 v14, v14, v42
  v_mul_f32 v15, v15, v42
  v_mul_f32 v16, v16, v42
  v_mul_f32 v17, v17, v42
  v_mul_f32 v18, v18, v42
  v_mul_f32 v19, v19, v42
  v_mul_f32 v28, v28, v42
  v_mul_f32 v29, v29, v42
  v_mul_f32 v30, v30, v42
  v_mul_f32 v31, v31, v42
  v_cvt_pk_bf16_f32 v52, v12, v13
  v_cvt_pk_bf16_f32 v53, v14, v15
  v_cvt_pk_bf16_f32 v54, v16, v17
  v_cvt_pk_bf16_f32 v55, v18, v19
  v_cvt_pk_bf16_f32 v56, v28, v29
  v_cvt_pk_bf16_f32 v57, v30, v31
  v_min_u32 v52, -2, v52
  v_min_u32 v53, -2, v53
  v_min_u32 v54, -2, v54
  v_min_u32 v55, -2, v55
  v_min_u32 v56, -2, v56
  v_min_u32 v57, -2, v57
  buffer_store_dwordx4 v[52:55], v2, s[8:11], s26 offen sc1
  s_mov_b64 exec, s[50:51]
  buffer_store_dwordx2 v[56:57], v2, s[8:11], s27 offen sc1
  s_mov_b64 exec, -1
  s_lshl_b32 s25, s17, 7
  s_add_u32 s25, s25, 88561664
  v_mov_b32 v5, 1
  v_mov_b32 v6, 0
  s_waitcnt vmcnt(0)
  s_mov_b64 exec, 1
  buffer_atomic_add v5, v6, s[8:11], s25 offen
  s_mov_b64 exec, -1
  s_branch wk_loop
wk_toko:
  s_lshl_b32 s20, s18, 2
  s_add_u32 s20, s20, s16
  s_mul_i32 s24, s20, 65
  s_add_u32 s24, s24, s17
  s_lshl_b32 s24, s24, 13
  s_add_u32 s24, s24, 76935168
  s_lshl_b32 s21, s20, 6
  s_add_u32 s21, s21, s17
  s_mul_i32 s21, s21, 28672
  s_add_u32 s21, s21, 42205184
  s_lshl_b32 s25, s17, 1
  s_mul_i32 s25, s25, 20480
  s_add_u32 s25, s25, 85446656
  v_lshrrev_b32 v8, 5, v1
  v_and_b32 v9, 31, v1
  v_min_u32 v5, 27, v9
  v_mad_u32_u24 v5, v8, 28, v5
  v_lshlrev_b32 v5, 4, v5
  v_lshrrev_b32 v10, 4, v9
  v_lshlrev_b32 v7, 10, v10
  v_lshl_add_u32 v7, v4, 4, v7
  v_lshl_add_u32 v7, v8, 3, v7
  v_mul_u32_u24 v6, 20480, v10
  v_lshl_add_u32 v6, v8, 8, v6
  v_lshl_add_u32 v6, v4, 4, v6
  s_lshr_b32 s26, s17, 3
  s_lshl_b32 s26, s26, 4
  s_add_u32 s26, s26, s20
  s_lshl_b32 s26, s26, 7
  s_add_u32 s26, s26, 88528896
  v_mov_b32 v60, 0
  s_mov_b32 s30, 0
wo_wv:
  buffer_load_dword v61, v60, s[8:11], s26 offen sc1
  s_waitcnt vmcnt(0)
  v_cmp_ne_u32 vcc, 56, v61
  s_cbranch_vccz wo_wv_ok
  s_sleep 1
  s_cmp_ge_u32 s17, 61
  s_cbranch_scc1 wo_wv_bo
  s_sleep 4
  s_cmp_ge_u32 s17, 56
  s_cbranch_scc1 wo_wv_bo
  s_sleep 127
wo_wv_bo:
  s_add_u32 s30, s30, 1
  s_cmp_lt_u32 s30, 30000
  s_cbranch_scc1 wo_wv
  s_branch wo_abort
wo_wv_ok:
  s_add_u32 s22, s21, 0
  buffer_load_dwordx4 a[0:3], v5, s[8:11], s22 offen offset:0 sc1
  buffer_load_dwordx4 a[4:7], v5, s[8:11], s22 offen offset:896 sc1
  buffer_load_dwordx4 a[8:11], v5, s[8:11], s22 offen offset:1792 sc1
  buffer_load_dwordx4 a[12:15], v5, s[8:11], s22 offen offset:2688 sc1
  s_add_u32 s22, s21, 3584
  buffer_load_dwordx4 a[16:19], v5, s[8:11], s22 offen offset:0 sc1
  buffer_load_dwordx4 a[20:23], v5, s[8:11], s22 offen offset:896 sc1
  buffer_load_dwordx4 a[24:27], v5, s[8:11], s22 offen offset:1792 sc1
  buffer_load_dwordx4 a[28:31], v5, s[8:11], s22 offen offset:2688 sc1
  s_add_u32 s22, s21, 7168
  buffer_load_dwordx4 a[32:35], v5, s[8:11], s22 offen offset:0 sc1
  buffer_load_dwordx4 a[36:39], v5, s[8:11], s22 offen offset:896 sc1
  buffer_load_dwordx4 a[40:43], v5, s[8:11], s22 offen offset:1792 sc1
  buffer_load_dwordx4 a[44:47], v5, s[8:11], s22 offen offset:2688 sc1
  s_add_u32 s22, s21, 10752
  buffer_load_dwordx4 a[48:51], v5, s[8:11], s22 offen offset:0 sc1
  buffer_load_dwordx4 a[52:55], v5, s[8:11], s22 offen offset:896 sc1
  buffer_load_dwordx4 a[56:59], v5, s[8:11], s22 offen offset:1792 sc1
  buffer_load_dwordx4 a[60:63], v5, s[8:11], s22 offen offset:2688 sc1
  s_add_u32 s22, s21, 14336
  buffer_load_dwordx4 a[64:67], v5, s[8:11], s22 offen offset:0 sc1
  buffer_load_dwordx4 a[68:71], v5, s[8:11], s22 offen offset:896 sc1
  buffer_load_dwordx4 a[72:75], v5, s[8:11], s22 offen offset:1792 sc1
  buffer_load_dwordx4 a[76:79], v5, s[8:11], s22 offen offset:2688 sc1
  s_add_u32 s22, s21, 17920
  buffer_load_dwordx4 a[80:83], v5, s[8:11], s22 offen offset:0 sc1
  buffer_load_dwordx4 a[84:87], v5, s[8:11], s22 offen offset:896 sc1
  buffer_load_dwordx4 a[88:91], v5, s[8:11], s22 offen offset:1792 sc1
  buffer_load_dwordx4 a[92:95], v5, s[8:11], s22 offen offset:2688 sc1
  s_add_u32 s22, s21, 21504
  buffer_load_dwordx4 a[96:99], v5, s[8:11], s22 offen offset:0 sc1
  buffer_load_dwordx4 a[100:103], v5, s[8:11], s22 offen offset:896 sc1
  buffer_load_dwordx4 a[104:107], v5, s[8:11], s22 offen offset:1792 sc1
  buffer_load_dwordx4 a[108:111], v5, s[8:11], s22 offen offset:2688 sc1
  s_add_u32 s22, s21, 25088
  buffer_load_dwordx4 a[112:115], v5, s[8:11], s22 offen offset:0 sc1
  buffer_load_dwordx4 a[116:119], v5, s[8:11], s22 offen offset:896 sc1
  buffer_load_dwordx4 a[120:123], v5, s[8:11], s22 offen offset:1792 sc1
  buffer_load_dwordx4 a[124:127], v5, s[8:11], s22 offen offset:2688 sc1
  s_cmp_ge_u32 s17, 61
  s_cbranch_scc1 wo_lm
  s_lshl_b32 s26, s17, 7
  s_add_u32 s26, s26, 88561664
  v_mov_b32 v60, 0
  s_mov_b32 s30, 0
wo_wp:
  buffer_load_dword v61, v60, s[8:11], s26 offen sc1
  s_waitcnt vmcnt(0)
  v_cmp_ne_u32 vcc, 16, v61
  s_cbranch_vccz wo_wp_ok
  s_sleep 2
  s_cmp_ge_u32 s17, 61
  s_cbranch_scc1 wo_wp_bo
  s_sleep 4
  s_cmp_ge_u32 s17, 56
  s_cbranch_scc1 wo_wp_bo
  s_sleep 127
wo_wp_bo:
  s_add_u32 s30, s30, 1
  s_cmp_lt_u32 s30, 30000
  s_cbranch_scc1 wo_wp
  s_branch wo_abort
wo_wp_ok:
  s_branch wo_lp
wo_lm:
  s_mul_i32 s26, s17, 7168
  s_add_u32 s26, s26, 88068096
  v_mov_b32 v60, 0
  s_mov_b32 s30, 0
wo_wm:
  buffer_load_dword v61, v60, s[8:11], s26 offen sc1
  s_waitcnt vmcnt(0)
  v_cmp_eq_u32 vcc, -1, v61
  s_cbranch_vccz wo_wm_ok
  s_sleep 2
  s_cmp_ge_u32 s17, 61
  s_cbranch_scc1 wo_wm_bo
  s_sleep 4
  s_cmp_ge_u32 s17, 56
  s_cbranch_scc1 wo_wm_bo
  s_sleep 127
wo_wm_bo:
  s_add_u32 s30, s30, 1
  s_cmp_lt_u32 s30, 30000
  s_cbranch_scc1 wo_wm
  s_branch wo_abort
wo_wm_ok:
wo_lp:
  s_mul_i32 s26, s16, 10240
  s_add_u32 s27, s25, s26
  v_add_u32 v11, s26, v2
  s_lshl_b32 s26, s20, 6
  s_add_u32 s26, s26, s17
  s_lshl_b32 s26, s26, 4
  s_add_u32 s26, s26, 88569856
  v_lshlrev_b32 v60, 2, v3
  s_mov_b32 s30, 0
wo_pl:
  s_add_u32 s22, s27, 0
  buffer_load_dwordx4 v[128:131], v2, s[8:11], s22 offen offset:0 sc1
  buffer_load_dwordx4 v[132:135], v2, s[8:11], s22 offen offset:1024 sc1
  buffer_load_dwordx4 v[136:139], v2, s[8:11], s22 offen offset:2048 sc1
  buffer_load_dwordx4 v[140:143], v2, s[8:11], s22 offen offset:3072 sc1
  s_add_u32 s22, s27, 4096
  buffer_load_dwordx4 v[144:147], v2, s[8:11], s22 offen offset:0 sc1
  buffer_load_dwordx4 v[148:151], v2, s[8:11], s22 offen offset:1024 sc1
  buffer_load_dwordx4 v[152:155], v2, s[8:11], s22 offen offset:2048 sc1
  buffer_load_dwordx4 v[156:159], v2, s[8:11], s22 offen offset:3072 sc1
  s_add_u32 s22, s27, 8192
  buffer_load_dwordx4 v[160:163], v2, s[8:11], s22 offen offset:0 sc1
  buffer_load_dwordx4 v[164:167], v2, s[8:11], s22 offen offset:1024 sc1
  buffer_load_dword v61, v60, s[8:11], s26 offen sc1
  s_waitcnt vmcnt(1)
  v_max_u32 v62, v128, v129
  v_max3_u32 v62, v62, v130, v131
  v_max3_u32 v62, v62, v132, v133
  v_max3_u32 v62, v62, v134, v135
  v_max3_u32 v62, v62, v136, v137
  v_max3_u32 v62, v62, v138, v139
  v_max3_u32 v62, v62, v140, v141
  v_max3_u32 v62, v62, v142, v143
  v_max3_u32 v62, v62, v144, v145
  v_max3_u32 v62, v62, v146, v147
  v_max3_u32 v62, v62, v148, v149
  v_max3_u32 v62, v62, v150, v151
  v_max3_u32 v62, v62, v152, v153
  v_max3_u32 v62, v62, v154, v155
  v_max3_u32 v62, v62, v156, v157
  v_max3_u32 v62, v62, v158, v159
  v_max3_u32 v62, v62, v160, v161
  v_max3_u32 v62, v62, v162, v163
  v_max3_u32 v62, v62, v164, v165
  v_max3_u32 v62, v62, v166, v167
  v_cmp_eq_u32 vcc, -1, v62
  s_cbranch_vccz wo_pk
  s_add_u32 s30, s30, 1
  s_cmp_lt_u32 s30, 30000
  s_cbranch_scc1 wo_pl
  s_branch wo_abort
wo_pk:
  ds_write_b128 v11, v[128:131] offset:0
  ds_write_b128 v11, v[132:135] offset:1024
  ds_write_b128 v11, v[136:139] offset:2048
  ds_write_b128 v11, v[140:143] offset:3072
  ds_write_b128 v11, v[144:147] offset:4096
  ds_write_b128 v11, v[148:151] offset:5120
  ds_write_b128 v11, v[152:155] offset:6144
  ds_write_b128 v11, v[156:159] offset:7168
  ds_write_b128 v11, v[160:163] offset:8192
  ds_write_b128 v11, v[164:167] offset:9216
  s_waitcnt vmcnt(0)
  v_cmp_ne_u32 vcc, 1, v61
  s_mov_b32 s28, 0
  s_cbranch_vccnz wo_nt
  s_add_u32 s22, s24, 0
  buffer_load_dwordx2 v[28:29], v7, s[8:11], s22 offen offset:0 sc1
  buffer_load_dwordx2 v[30:31], v7, s[8:11], s22 offen offset:512 sc1
  buffer_load_dwordx2 v[32:33], v7, s[8:11], s22 offen offset:256 sc1
  buffer_load_dwordx2 v[34:35], v7, s[8:11], s22 offen offset:768 sc1
  buffer_load_dwordx2 v[36:37], v7, s[8:11], s22 offen offset:2048 sc1
  buffer_load_dwordx2 v[38:39], v7, s[8:11], s22 offen offset:2560 sc1
  buffer_load_dwordx2 v[40:41], v7, s[8:11], s22 offen offset:2304 sc1
  buffer_load_dwordx2 v[42:43], v7, s[8:11], s22 offen offset:2816 sc1
  s_add_u32 s22, s24, 4096
  buffer_load_dwordx2 v[44:45], v7, s[8:11], s22 offen offset:0 sc1
  buffer_load_dwordx2 v[46:47], v7, s[8:11], s22 offen offset:512 sc1
  buffer_load_dwordx2 v[48:49], v7, s[8:11], s22 offen offset:256 sc1
  buffer_load_dwordx2 v[50:51], v7, s[8:11], s22 offen offset:768 sc1
  buffer_load_dwordx2 v[52:53], v7, s[8:11], s22 offen offset:2048 sc1
  buffer_load_dwordx2 v[54:55], v7, s[8:11], s22 offen offset:2560 sc1
  buffer_load_dwordx2 v[56:57], v7, s[8:11], s22 offen offset:2304 sc1
  buffer_load_dwordx2 v[58:59], v7, s[8:11], s22 offen offset:2816 sc1
  s_mov_b32 s28, 1
wo_nt:
  buffer_load_dword v250, v251, s[12:15], 0 offen sc1
  s_waitcnt lgkmcnt(0)
  s_barrier
  buffer_load_dword v61, v60, s[8:11], s26 offen sc1
  ds_read_b128 v[64:67], v6 offset:0
  ds_read_b128 v[68:71], v6 offset:512
  ds_read_b128 v[72:75], v6 offset:1024
  ds_read_b128 v[76:79], v6 offset:1536
  ds_read_b128 v[80:83], v6 offset:2048
  ds_read_b128 v[84:87], v6 offset:2560
  ds_read_b128 v[88:91], v6 offset:3072
  s_waitcnt lgkmcnt(6)
  v_mfma_f32_32x32x16_bf16 v[12:27], a[0:3], v[64:67], 0
  ds_read_b128 v[92:95], v6 offset:3584
  s_waitcnt lgkmcnt(6)
  v_mfma_f32_32x32x16_bf16 v[12:27], a[4:7], v[68:71], v[12:27]
  ds_read_b128 v[64:67], v6 offset:4096
  s_waitcnt lgkmcnt(6)
  v_mfma_f32_32x32x16_bf16 v[12:27], a[8:11], v[72:75], v[12:27]
  ds_read_b128 v[68:71], v6 offset:4608
  s_waitcnt lgkmcnt(6)
  v_mfma_f32_32x32x16_bf16 v[12:27], a[12:15], v[76:79], v[12:27]
  ds_read_b128 v[72:75], v6 offset:5120
  s_waitcnt lgkmcnt(6)
  v_mfma_f32_32x32x16_bf16 v[12:27], a[16:19], v[80:83], v[12:27]
  ds_read_b128 v[76:79], v6 offset:5632
  s_waitcnt lgkmcnt(6)
  v_mfma_f32_32x32x16_bf16 v[12:27], a[20:23], v[84:87], v[12:27]
  ds_read_b128 v[80:83], v6 offset:6144
  s_waitcnt lgkmcnt(6)
  v_mfma_f32_32x32x16_bf16 v[12:27], a[24:27], v[88:91], v[12:27]
  ds_read_b128 v[84:87], v6 offset:6656
  s_waitcnt lgkmcnt(6)
  v_mfma_f32_32x32x16_bf16 v[12:27], a[28:31], v[92:95], v[12:27]
  ds_read_b128 v[88:91], v6 offset:7168
  s_waitcnt lgkmcnt(6)
  v_mfma_f32_32x32x16_bf16 v[12:27], a[32:35], v[64:67], v[12:27]
  ds_read_b128 v[92:95], v6 offset:7680
  s_waitcnt lgkmcnt(6)
  v_mfma_f32_32x32x16_bf16 v[12:27], a[36:39], v[68:71], v[12:27]
  ds_read_b128 v[64:67], v6 offset:8192
  s_waitcnt lgkmcnt(6)
  v_mfma_f32_32x32x16_bf16 v[12:27], a[40:43], v[72:75], v[12:27]
  ds_read_b128 v[68:71], v6 offset:8704
  s_waitcnt lgkmcnt(6)
  v_mfma_f32_32x32x16_bf16 v[12:27], a[44:47], v[76:79], v[12:27]
  ds_read_b128 v[72:75], v6 offset:9216
  s_waitcnt lgkmcnt(6)
  v_mfma_f32_32x32x16_bf16 v[12:27], a[48:51], v[80:83], v[12:27]
  ds_read_b128 v[76:79], v6 offset:9728
  s_waitcnt lgkmcnt(6)
  v_mfma_f32_32x32x16_bf16 v[12:27], a[52:55], v[84:87], v[12:27]
  ds_read_b128 v[80:83], v6 offset:10240
  s_waitcnt lgkmcnt(6)
  v_mfma_f32_32x32x16_bf16 v[12:27], a[56:59], v[88:91], v[12:27]
  ds_read_b128 v[84:87], v6 offset:10752
  s_waitcnt lgkmcnt(6)
  v_mfma_f32_32x32x16_bf16 v[12:27], a[60:63], v[92:95], v[12:27]
  ds_read_b128 v[88:91], v6 offset:11264
  s_waitcnt lgkmcnt(6)
  v_mfma_f32_32x32x16_bf16 v[12:27], a[64:67], v[64:67], v[12:27]
  ds_read_b128 v[92:95], v6 offset:11776
  s_waitcnt lgkmcnt(6)
  v_mfma_f32_32x32x16_bf16 v[12:27], a[68:71], v[68:71], v[12:27]
  ds_read_b128 v[64:67], v6 offset:12288
  s_waitcnt lgkmcnt(6)
  v_mfma_f32_32x32x16_bf16 v[12:27], a[72:75], v[72:75], v[12:27]
  ds_read_b128 v[68:71], v6 offset:12800
  s_waitcnt lgkmcnt(6)
  v_mfma_f32_32x32x16_bf16 v[12:27], a[76:79], v[76:79], v[12:27]
  s_cmp_lg_u32 s28, 0
  s_cbranch_scc1 wo_h2
  s_waitcnt vmcnt(0)
  v_cmp_ne_u32 vcc, 1, v61
  s_cbranch_vccnz wo_h2
  s_add_u32 s22, s24, 0
  buffer_load_dwordx2 v[28:29], v7, s[8:11], s22 offen offset:0 sc1
  buffer_load_dwordx2 v[30:31], v7, s[8:11], s22 offen offset:512 sc1
  buffer_load_dwordx2 v[32:33], v7, s[8:11], s22 offen offset:256 sc1
  buffer_load_dwordx2 v[34:35], v7, s[8:11], s22 offen offset:768 sc1
  buffer_load_dwordx2 v[36:37], v7, s[8:11], s22 offen offset:2048 sc1
  buffer_load_dwordx2 v[38:39], v7, s[8:11], s22 offen offset:2560 sc1
  buffer_load_dwordx2 v[40:41], v7, s[8:11], s22 offen offset:2304 sc1
  buffer_load_dwordx2 v[42:43], v7, s[8:11], s22 offen offset:2816 sc1
  s_add_u32 s22, s24, 4096
  buffer_load_dwordx2 v[44:45], v7, s[8:11], s22 offen offset:0 sc1
  buffer_load_dwordx2 v[46:47], v7, s[8:11], s22 offen offset:512 sc1
  buffer_load_dwordx2 v[48:49], v7, s[8:11], s22 offen offset:256 sc1
  buffer_load_dwordx2 v[50:51], v7, s[8:11], s22 offen offset:768 sc1
  buffer_load_dwordx2 v[52:53], v7, s[8:11], s22 offen offset:2048 sc1
  buffer_load_dwordx2 v[54:55], v7, s[8:11], s22 offen offset:2560 sc1
  buffer_load_dwordx2 v[56:57], v7, s[8:11], s22 offen offset:2304 sc1
  buffer_load_dwordx2 v[58:59], v7, s[8:11], s22 offen offset:2816 sc1
  s_mov_b32 s28, 1
wo_h2:
  ds_read_b128 v[72:75], v6 offset:13312
  s_waitcnt lgkmcnt(6)
  v_mfma_f32_32x32x16_bf16 v[12:27], a[80:83], v[80:83], v[12:27]
  ds_read_b128 v[76:79], v6 offset:13824
  s_waitcnt lgkmcnt(6)
  v_mfma_f32_32x32x16_bf16 v[12:27], a[84:87], v[84:87], v[12:27]
  ds_read_b128 v[80:83], v6 offset:14336
  s_waitcnt lgkmcnt(6)
  v_mfma_f32_32x32x16_bf16 v[12:27], a[88:91], v[88:91], v[12:27]
  ds_read_b128 v[84:87], v6 offset:14848
  s_waitcnt lgkmcnt(6)
  v_mfma_f32_32x32x16_bf16 v[12:27], a[92:95], v[92:95], v[12:27]
  ds_read_b128 v[88:91], v6 offset:15360
  s_waitcnt lgkmcnt(6)
  v_mfma_f32_32x32x16_bf16 v[12:27], a[96:99], v[64:67], v[12:27]
  ds_read_b128 v[92:95], v6 offset:15872
  s_waitcnt lgkmcnt(6)
  v_mfma_f32_32x32x16_bf16 v[12:27], a[100:103], v[68:71], v[12:27]
  ds_read_b128 v[64:67], v6 offset:16384
  s_waitcnt lgkmcnt(6)
  v_mfma_f32_32x32x16_bf16 v[12:27], a[104:107], v[72:75], v[12:27]
  ds_read_b128 v[68:71], v6 offset:16896
  s_waitcnt lgkmcnt(6)
  v_mfma_f32_32x32x16_bf16 v[12:27], a[108:111], v[76:79], v[12:27]
  ds_read_b128 v[72:75], v6 offset:17408
  s_waitcnt lgkmcnt(6)
  v_mfma_f32_32x32x16_bf16 v[12:27], a[112:115], v[80:83], v[12:27]
  ds_read_b128 v[76:79], v6 offset:17920
  s_waitcnt lgkmcnt(6)
  v_mfma_f32_32x32x16_bf16 v[12:27], a[116:119], v[84:87], v[12:27]
  ds_read_b128 v[80:83], v6 offset:18432
  s_waitcnt lgkmcnt(6)
  v_mfma_f32_32x32x16_bf16 v[12:27], a[120:123], v[88:91], v[12:27]
  ds_read_b128 v[84:87], v6 offset:18944
  s_waitcnt lgkmcnt(6)
  v_mfma_f32_32x32x16_bf16 v[12:27], a[124:127], v[92:95], v[12:27]
  s_cmp_lg_u32 s28, 0
  s_cbranch_scc1 wo_ht
  v_lshlrev_b32 v60, 2, v3
  s_mov_b32 s30, 0
wo_wt:
  buffer_load_dword v61, v60, s[8:11], s26 offen sc1
  s_waitcnt vmcnt(0)
  v_cmp_ne_u32 vcc, 1, v61
  s_cbranch_vccz wo_wt_ok
  s_sleep 1
  s_cmp_ge_u32 s17, 61
  s_cbranch_scc1 wo_wt_bo
  s_sleep 4
  s_cmp_ge_u32 s17, 56
  s_cbranch_scc1 wo_wt_bo
  s_sleep 127
wo_wt_bo:
  s_add_u32 s30, s30, 1
  s_cmp_lt_u32 s30, 30000
  s_cbranch_scc1 wo_wt
  s_branch wo_abort
wo_wt_ok:
  s_add_u32 s22, s24, 0
  buffer_load_dwordx2 v[28:29], v7, s[8:11], s22 offen offset:0 sc1
  buffer_load_dwordx2 v[30:31], v7, s[8:11], s22 offen offset:512 sc1
  buffer_load_dwordx2 v[32:33], v7, s[8:11], s22 offen offset:256 sc1
  buffer_load_dwordx2 v[34:35], v7, s[8:11], s22 offen offset:768 sc1
  buffer_load_dwordx2 v[36:37], v7, s[8:11], s22 offen offset:2048 sc1
  buffer_load_dwordx2 v[38:39], v7, s[8:11], s22 offen offset:2560 sc1
  buffer_load_dwordx2 v[40:41], v7, s[8:11], s22 offen offset:2304 sc1
  buffer_load_dwordx2 v[42:43], v7, s[8:11], s22 offen offset:2816 sc1
  s_add_u32 s22, s24, 4096
  buffer_load_dwordx2 v[44:45], v7, s[8:11], s22 offen offset:0 sc1
  buffer_load_dwordx2 v[46:47], v7, s[8:11], s22 offen offset:512 sc1
  buffer_load_dwordx2 v[48:49], v7, s[8:11], s22 offen offset:256 sc1
  buffer_load_dwordx2 v[50:51], v7, s[8:11], s22 offen offset:768 sc1
  buffer_load_dwordx2 v[52:53], v7, s[8:11], s22 offen offset:2048 sc1
  buffer_load_dwordx2 v[54:55], v7, s[8:11], s22 offen offset:2560 sc1
  buffer_load_dwordx2 v[56:57], v7, s[8:11], s22 offen offset:2304 sc1
  buffer_load_dwordx2 v[58:59], v7, s[8:11], s22 offen offset:2816 sc1
wo_ht:
  ds_read_b128 v[88:91], v6 offset:19456
  s_waitcnt lgkmcnt(6) vmcnt(0)
  v_mfma_f32_32x32x16_bf16 v[12:27], v[28:31], v[64:67], v[12:27]
  ds_read_b128 v[92:95], v6 offset:19968
  s_waitcnt lgkmcnt(6)
  v_mfma_f32_32x32x16_bf16 v[12:27], v[32:35], v[68:71], v[12:27]
  s_waitcnt lgkmcnt(5)
  v_mfma_f32_32x32x16_bf16 v[12:27], v[36:39], v[72:75], v[12:27]
  s_waitcnt lgkmcnt(4)
  v_mfma_f32_32x32x16_bf16 v[12:27], v[40:43], v[76:79], v[12:27]
  s_waitcnt lgkmcnt(3)
  v_mfma_f32_32x32x16_bf16 v[12:27], v[44:47], v[80:83], v[12:27]
  s_waitcnt lgkmcnt(2)
  v_mfma_f32_32x32x16_bf16 v[12:27], v[48:51], v[84:87], v[12:27]
  s_waitcnt lgkmcnt(1)
  v_mfma_f32_32x32x16_bf16 v[12:27], v[52:55], v[88:91], v[12:27]
  s_waitcnt lgkmcnt(0)
  v_mfma_f32_32x32x16_bf16 v[12:27], v[56:59], v[92:95], v[12:27]
  v_mul_u32_u24 v9, 240, v9
  s_movk_i32 s23, 240
  v_lshl_add_u32 v8, v8, 3, v9
  s_mul_i32 s22, s16, 56
  v_add_u32 v8, s22, v8
  v_min_u32 v11, 223, v0
  v_mul_u32_u24 v9, 4682, v11
  v_lshrrev_b32 v9, 16, v9
  v_mul_u32_u24 v10, 14, v9
  v_sub_u32 v10, v11, v10
  v_lshlrev_b32 v10, 4, v10
  v_mad_u32_u24 v11, v9, s23, v10
  v_mul_u32_u24 v9, 1792, v9
  v_add_u32 v10, v9, v10
  s_mul_i32 s26, s17, 57344
  s_mul_i32 s22, s18, 224
  s_add_u32 s26, s26, s22
  s_add_u32 s26, s26, 896
  s_add_u32 s27, s26, 28672
  v_cvt_pk_bf16_f32 v96, v12, v13
  v_cvt_pk_bf16_f32 v97, v14, v15
  ds_write_b64 v8, v[96:97] offset:49152
  v_cvt_pk_bf16_f32 v98, v16, v17
  v_cvt_pk_bf16_f32 v99, v18, v19
  ds_write_b64 v8, v[98:99] offset:49168
  v_cvt_pk_bf16_f32 v100, v20, v21
  v_cvt_pk_bf16_f32 v101, v22, v23
  ds_write_b64 v8, v[100:101] offset:49184
  v_cvt_pk_bf16_f32 v102, v24, v25
  v_cvt_pk_bf16_f32 v103, v26, v27
  s_mov_b32 exec_hi, 0
  ds_write_b64 v8, v[102:103] offset:49200
  s_mov_b64 exec, -1
  s_waitcnt lgkmcnt(0)
  s_barrier
  ds_read_b128 v[104:107], v11 offset:49152
  ds_read_b128 v[108:111], v11 offset:52992
  s_cmp_lg_u32 s16, 3
  s_cselect_b32 exec_hi, -1, 0
  s_waitcnt lgkmcnt(1)
  buffer_store_dwordx4 v[104:107], v10, s[92:95], s26 offen
  s_waitcnt lgkmcnt(0)
  buffer_store_dwordx4 v[108:111], v10, s[92:95], s27 offen
  s_mov_b64 exec, -1
  v_readfirstlane_b32 s22, v250
  s_cmp_ge_u32 s22, 1376
  s_cbranch_scc1 ch_end
  s_branch wk_loop
wp_abort:
wo_abort:
  s_branch cA_abort
ch_end:
  s_endpgm

.section .rodata,"a"
.p2align 6
.amdhsa_kernel main_kernel
  .amdhsa_next_free_vgpr 512
  .amdhsa_next_free_sgpr 102
  .amdhsa_accum_offset 256
  .amdhsa_group_segment_fixed_size 0
  .amdhsa_kernarg_size 136
  .amdhsa_user_sgpr_count 2
  .amdhsa_user_sgpr_kernarg_segment_ptr 1
  .amdhsa_system_sgpr_workgroup_id_x 1
.end_amdhsa_kernel
```

```asm
; @launch kernel=main_kernel grid=(256,1,1) block=(256,1,1) lds=163840
.amdgcn_target "amdgcn-amd-amdhsa--gfx950"
.text
.globl main_kernel
.p2align 8
.type main_kernel,@function
main_kernel:
  s_cmp_ge_u32 s2, 256
  s_cbranch_scc1 ch_end
  s_load_dwordx4 s[4:7], s[0:1], 120
  s_load_dwordx2 s[92:93], s[0:1], 112
  s_load_dwordx8 s[36:43], s[0:1], 56
  s_load_dwordx4 s[44:47], s[0:1], 88
  s_memrealtime s[88:89]
  s_getpc_b64 s[98:99]
pf_main_kernel_1:
  s_sub_u32 s98, s98, pf_main_kernel_1-main_kernel
  s_subb_u32 s99, s99, 0
  s_lshr_b32 s20, s2, 3
  v_lshl_add_u32 v60, v0, 5, s20
  v_lshlrev_b32 v60, 7, v60
  v_min_u32 v60, ch_end-main_kernel-4, v60
  v_cmp_gt_u32 vcc, 32, v0
  s_and_saveexec_b64 s[22:23], vcc
  s_cbranch_execz pf_main_kernel_1_n
  global_load_dword v62, v60, s[98:99]
pf_main_kernel_1_n:
  s_mov_b64 exec, -1
  s_getreg_b32 s67, hwreg(HW_REG_XCC_ID)
  s_and_b32 s67, s67, 7
  v_lshrrev_b32 v1, 6, v0
  s_nop 0
  v_readfirstlane_b32 s16, v1
  s_mov_b32 s66, 0
  s_mov_b32 s68, 0
  s_mov_b32 s69, 0
  s_mov_b32 s96, 0
  s_mov_b32 s97, 0
  s_mov_b32 s101, 0x5eed0000
  s_sub_u32 s20, s67, 0
  s_lshr_b32 s21, s2, 3
  s_and_b32 s20, s20, 7
  s_lshl_b32 s3, s20, 5
  s_add_u32 s3, s3, s21
  s_waitcnt lgkmcnt(0)
  s_mov_b32 s8, s6
  s_and_b32 s9, s7, 0xffff
  s_mov_b32 s10, 0x10000000
  s_mov_b32 s11, 0x20000
  s_mov_b32 s12, s4
  s_and_b32 s13, s5, 0xffff
  s_mov_b32 s14, 256
  s_mov_b32 s15, 0x20000
  s_or_b32 s88, s88, 1
  s_and_b32 s93, s93, 0xffff
  s_mov_b32 s94, 3670016
  s_mov_b32 s95, 0x20000
m_start:
  s_cmp_ge_u32 s3, 32
  s_cbranch_scc1 m_bjob
  v_and_b32 v1, 63, v0
  v_lshlrev_b32 v2, 4, v1
  v_lshrrev_b32 v116, 4, v1
  v_and_b32 v117, 15, v1
  v_mov_b32 v3, 0x4444
  v_mov_b32 v118, 0xeeee
  v_cmp_lt_u32 vcc, 7, v117
  s_nop 1
  v_cndmask_b32 v3, v3, v118, vcc
  s_and_b32 s17, s3, 15
  s_cmp_ge_u32 s3, 16
  s_cbranch_scc1 m_val
  s_mov_b32 s60, s42
  s_and_b32 s61, s43, 0xffff
  s_mov_b32 s62, 3670016
  s_mov_b32 s63, 0x20000
  v_lshrrev_b32 v24, 5, v1
  v_and_b32 v25, 31, v1
  s_lshl_b32 s26, s17, 9
  s_lshl_b32 s25, s16, 12
  v_xor_b32 v26, v25, v24
  v_lshlrev_b32 v26, 4, v26
  v_lshl_add_u32 v26, v24, 13, v26
  v_xor_b32 v100, 0, v26
  v_xor_b32 v101, 0, v26
  v_add_u32 v101, 15360, v101
  v_xor_b32 v102, 32, v26
  v_add_u32 v102, 30720, v102
  v_xor_b32 v103, 32, v26
  v_add_u32 v103, 46080, v103
  s_lshl_b32 s23, s16, 19
  s_add_u32 s23, s23, s26
  s_add_u32 m0, s25, 16384
  s_nop 0
  buffer_load_dwordx4 v100, s[60:63], s23 offen offset:0 lds
  buffer_load_dwordx4 v101, s[60:63], s23 offen offset:1024 lds
  buffer_load_dwordx4 v102, s[60:63], s23 offen offset:2048 lds
  buffer_load_dwordx4 v103, s[60:63], s23 offen offset:3072 lds
  s_add_u32 m0, s25, 32768
  s_add_u32 s23, s23, 65536
  buffer_load_dwordx4 v100, s[60:63], s23 offen offset:0 lds
  buffer_load_dwordx4 v101, s[60:63], s23 offen offset:1024 lds
  buffer_load_dwordx4 v102, s[60:63], s23 offen offset:2048 lds
  buffer_load_dwordx4 v103, s[60:63], s23 offen offset:3072 lds
  v_xor_b32 v100, 64, v100
  v_xor_b32 v101, 64, v101
  v_xor_b32 v102, 64, v102
  v_xor_b32 v103, 64, v103
  s_add_u32 m0, s25, 49152
  s_add_u32 s23, s23, 65536
  buffer_load_dwordx4 v100, s[60:63], s23 offen offset:0 lds
  buffer_load_dwordx4 v101, s[60:63], s23 offen offset:1024 lds
  buffer_load_dwordx4 v102, s[60:63], s23 offen offset:2048 lds
  buffer_load_dwordx4 v103, s[60:63], s23 offen offset:3072 lds
  s_add_u32 m0, s25, 65536
  s_add_u32 s23, s23, 65536
  buffer_load_dwordx4 v100, s[60:63], s23 offen offset:0 lds
  buffer_load_dwordx4 v101, s[60:63], s23 offen offset:1024 lds
  buffer_load_dwordx4 v102, s[60:63], s23 offen offset:2048 lds
  buffer_load_dwordx4 v103, s[60:63], s23 offen offset:3072 lds
  v_xor_b32 v100, 192, v100
  v_xor_b32 v101, 192, v101
  v_xor_b32 v102, 192, v102
  v_xor_b32 v103, 192, v103
  s_add_u32 m0, s25, 81920
  s_add_u32 s23, s23, 65536
  buffer_load_dwordx4 v100, s[60:63], s23 offen offset:0 lds
  buffer_load_dwordx4 v101, s[60:63], s23 offen offset:1024 lds
  buffer_load_dwordx4 v102, s[60:63], s23 offen offset:2048 lds
  buffer_load_dwordx4 v103, s[60:63], s23 offen offset:3072 lds
  s_add_u32 m0, s25, 98304
  s_add_u32 s23, s23, 65536
  buffer_load_dwordx4 v100, s[60:63], s23 offen offset:0 lds
  buffer_load_dwordx4 v101, s[60:63], s23 offen offset:1024 lds
  buffer_load_dwordx4 v102, s[60:63], s23 offen offset:2048 lds
  buffer_load_dwordx4 v103, s[60:63], s23 offen offset:3072 lds
  v_xor_b32 v100, 64, v100
  v_xor_b32 v101, 64, v101
  v_xor_b32 v102, 64, v102
  v_xor_b32 v103, 64, v103
  s_add_u32 m0, s25, 114688
  s_add_u32 s23, s23, 65536
  buffer_load_dwordx4 v100, s[60:63], s23 offen offset:0 lds
  buffer_load_dwordx4 v101, s[60:63], s23 offen offset:1024 lds
  buffer_load_dwordx4 v102, s[60:63], s23 offen offset:2048 lds
  buffer_load_dwordx4 v103, s[60:63], s23 offen offset:3072 lds
  s_add_u32 m0, s25, 131072
  s_add_u32 s23, s23, 65536
  buffer_load_dwordx4 v100, s[60:63], s23 offen offset:0 lds
  buffer_load_dwordx4 v101, s[60:63], s23 offen offset:1024 lds
  buffer_load_dwordx4 v102, s[60:63], s23 offen offset:2048 lds
  buffer_load_dwordx4 v103, s[60:63], s23 offen offset:3072 lds
  s_mov_b32 s56, s40
  s_and_b32 s57, s41, 0xffff
  s_mov_b32 s58, 3670016
  s_mov_b32 s59, 0x20000
  s_lshl_b32 s21, s16, 16
  s_add_u32 s27, s26, s21
  s_lshr_b32 s20, s16, 1
  s_lshl_b32 s20, s20, 6
  v_xor_b32 v26, s20, v26
  v_xor_b32 v4, 0, v26
  v_xor_b32 v5, 32, v26
  v_add_u32 v5, 15360, v5
  v_xor_b32 v6, 128, v26
  v_add_u32 v6, 30720, v6
  v_xor_b32 v7, 160, v26
  v_add_u32 v7, 46080, v7
  s_add_u32 s22, s27, 0
  s_add_u32 m0, s25, 0
  s_nop 0
  buffer_load_dwordx4 v4, s[56:59], s22 offen offset:0 lds
  buffer_load_dwordx4 v5, s[56:59], s22 offen offset:1024 lds
  buffer_load_dwordx4 v6, s[56:59], s22 offen offset:2048 lds
  buffer_load_dwordx4 v7, s[56:59], s22 offen offset:3072 lds
  s_cmp_lg_u32 s66, 0
  s_cbranch_scc1 sc_ci
  s_cmp_lg_u32 s16, 0
  s_cbranch_scc1 w0_2
  s_lshr_b32 s70, s3, 5
  s_and_b32 s71, s70, 4
  s_mul_i32 s71, s71, 12
  s_lshl_b32 s70, s70, 2
  s_add_u32 s70, s70, s71
  s_lshl_b32 s71, 1, s3
  v_mov_b32 v248, s71
  v_mov_b32 v249, 32
  s_mov_b64 exec, 1
  buffer_atomic_or v248, v249, s[12:15], s70 offen sc0
  buffer_load_dwordx2 v[250:251], v249, s[12:15], 0 offen offset:96 sc1
  s_mov_b64 exec, -1
w0_2:
sc_ci:
  v_and_b32 v26, 15, v25
  v_xor_b32 v27, v26, v24
  v_lshlrev_b32 v27, 4, v27
  v_bfe_u32 v28, v25, 2, 1
  v_lshlrev_b32 v28, 4, v28
  v_lshrrev_b32 v29, 3, v25
  v_lshl_add_u32 v28, v29, 2, v28
  v_and_b32 v29, 3, v25
  v_add_u32 v28, v28, v29
  v_lshl_add_u32 v28, v28, 9, v27
  v_lshrrev_b32 v29, 2, v26
  v_lshlrev_b32 v29, 15, v29
  v_bfe_u32 v30, v26, 1, 1
  v_lshl_add_u32 v29, v30, 11, v29
  v_lshrrev_b32 v30, 4, v25
  v_lshl_add_u32 v29, v30, 10, v29
  v_and_b32 v31, 1, v26
  v_lshl_add_u32 v29, v31, 9, v29
  v_add_u32 v29, v29, v27
  v_add_u32 v29, s25, v29
  v_xor_b32 v8, 0, v28
  v_xor_b32 v104, 0, v29
  v_xor_b32 v9, 32, v28
  v_xor_b32 v105, 32, v29
  v_xor_b32 v10, 64, v28
  v_xor_b32 v106, 64, v29
  v_xor_b32 v11, 96, v28
  v_xor_b32 v107, 96, v29
  v_xor_b32 v12, 128, v28
  v_xor_b32 v108, 128, v29
  v_xor_b32 v13, 160, v28
  v_xor_b32 v109, 160, v29
  v_xor_b32 v14, 192, v28
  v_xor_b32 v110, 192, v29
  v_xor_b32 v15, 224, v28
  v_xor_b32 v111, 224, v29
  s_mov_b32 s52, 1035512379
  s_waitcnt vmcnt(4)
  ds_read_b128 v[120:123], v104 offset:16384
  ds_read_b128 v[124:127], v105 offset:16384
  ds_read_b128 v[128:131], v106 offset:16384
  ds_read_b128 v[132:135], v107 offset:16384
  ds_read_b128 v[136:139], v108 offset:16384
  ds_read_b128 v[140:143], v109 offset:16384
  ds_read_b128 v[144:147], v110 offset:16384
  ds_read_b128 v[148:151], v111 offset:16384
  s_waitcnt lgkmcnt(4)
  ds_read_b128 v[152:155], v104 offset:16640
  ds_read_b128 v[156:159], v105 offset:16640
  ds_read_b128 v[160:163], v106 offset:16640
  ds_read_b128 v[164:167], v107 offset:16640
  ds_read_b128 v[168:171], v108 offset:16640
  ds_read_b128 v[172:175], v109 offset:16640
  ds_read_b128 v[176:179], v110 offset:16640
  ds_read_b128 v[180:183], v111 offset:16640
  s_waitcnt lgkmcnt(4)
  ds_read_b128 v[184:187], v104 offset:32768
  ds_read_b128 v[188:191], v105 offset:32768
  ds_read_b128 v[192:195], v106 offset:32768
  ds_read_b128 v[196:199], v107 offset:32768
  ds_read_b128 v[200:203], v108 offset:32768
  ds_read_b128 v[204:207], v109 offset:32768
  ds_read_b128 v[208:211], v110 offset:32768
  ds_read_b128 v[212:215], v111 offset:32768
  s_waitcnt lgkmcnt(4)
  ds_read_b128 v[216:219], v104 offset:33024
  ds_read_b128 v[220:223], v105 offset:33024
  ds_read_b128 v[224:227], v106 offset:33024
  ds_read_b128 v[228:231], v107 offset:33024
  ds_read_b128 v[232:235], v108 offset:33024
  ds_read_b128 v[236:239], v109 offset:33024
  ds_read_b128 v[240:243], v110 offset:33024
  ds_read_b128 v[244:247], v111 offset:33024
  s_waitcnt lgkmcnt(4)
  s_waitcnt lgkmcnt(0)
  s_add_u32 s22, s27, 262144
  s_add_u32 m0, s25, 16384
  s_nop 0
  buffer_load_dwordx4 v4, s[56:59], s22 offen offset:0 lds
  buffer_load_dwordx4 v5, s[56:59], s22 offen offset:1024 lds
  buffer_load_dwordx4 v6, s[56:59], s22 offen offset:2048 lds
  buffer_load_dwordx4 v7, s[56:59], s22 offen offset:3072 lds
  s_add_u32 s22, s27, 524288
  s_add_u32 m0, s25, 32768
  s_nop 0
  buffer_load_dwordx4 v4, s[56:59], s22 offen offset:0 lds
  buffer_load_dwordx4 v5, s[56:59], s22 offen offset:1024 lds
  buffer_load_dwordx4 v6, s[56:59], s22 offen offset:2048 lds
  buffer_load_dwordx4 v7, s[56:59], s22 offen offset:3072 lds
  s_add_u32 s22, s27, 786432
  s_add_u32 m0, s25, 49152
  s_nop 0
  buffer_load_dwordx4 v4, s[56:59], s22 offen offset:0 lds
  buffer_load_dwordx4 v5, s[56:59], s22 offen offset:1024 lds
  buffer_load_dwordx4 v6, s[56:59], s22 offen offset:2048 lds
  buffer_load_dwordx4 v7, s[56:59], s22 offen offset:3072 lds
  s_cmp_lg_u32 s66, 0
  s_cbranch_scc1 sc_cf
  s_cmp_lg_u32 s16, 0
  s_cbranch_scc1 w0_3
  s_waitcnt vmcnt(12)
  v_readfirstlane_b32 s70, v250
  s_cmp_lg_u32 s70, 0
  s_cbranch_scc1 sc_nz
  v_mov_b32 v249, 128
  v_mov_b32 v250, s88
  v_mov_b32 v251, s89
  v_mov_b32 v252, 0
  v_mov_b32 v253, 0
  s_mov_b64 exec, 1
  buffer_atomic_cmpswap_x2 v[250:253], v249, s[12:15], 0 offen sc0
  s_mov_b64 exec, -1
  s_waitcnt vmcnt(0)
  v_readfirstlane_b32 s70, v250
  s_cmp_lg_u32 s70, 0
  s_cbranch_scc1 sc_nz
  v_mov_b32 v250, s88
  v_mov_b32 v251, s89
sc_nz:
w0_3:
  v_mov_b32 v249, 160000
  s_add_u32 s101, s101, 1
  s_barrier
  s_mov_b64 exec, 1
  s_cmp_lg_u32 s16, 0
  s_cbranch_scc1 w0_4
  ds_write_b32 v249, v248 offset:0
  ds_write_b32 v249, v250 offset:4
  ds_write_b32 v249, v251 offset:8
  s_waitcnt lgkmcnt(0)
  v_mov_b32 v248, s101
  ds_write_b32 v249, v248 offset:16
  s_waitcnt lgkmcnt(0)
w0_4:
  s_mov_b64 exec, -1
  s_barrier
  ds_read_b32 v248, v249 offset:0
  ds_read_b32 v250, v249 offset:4
  ds_read_b32 v251, v249 offset:8
  ds_read_b32 v249, v249 offset:16
  s_waitcnt lgkmcnt(0)
  v_readfirstlane_b32 s70, v248
  v_readfirstlane_b32 s88, v250
  v_readfirstlane_b32 s89, v251
  v_cmp_ne_u32 vcc, s101, v249
  s_cbranch_vccnz ch_end
  s_mov_b32 s66, 1
  s_bitcmp1_b32 s70, s3
  s_cbranch_scc1 m_reclaim
sc_cf:
  s_cmp_lg_u32 s16, 0
  s_cbranch_scc1 w0_5
  s_cmp_eq_u32 s67, 0
  s_cselect_b32 s20, 1, 0x10001
  v_mov_b32 v248, s20
  v_mov_b32 v249, 0
  s_mov_b64 exec, 1
  buffer_atomic_add v248, v249, s[12:15], 0 offen
  s_mov_b64 exec, -1
w0_5:
  s_lshl_b32 s28, s17, 7
  s_add_u32 s28, s28, 88623104
  v_min_u32 v113, 96, v2
  s_mov_b32 s29, 88590336
  v_add_u32 v112, 1024, v2
  v_min_u32 v112, 1776, v112
  s_mul_i32 s32, s17, 401408
  s_mul_i32 s33, s16, 14336
  s_add_u32 s32, s32, s33
  s_add_u32 s33, s32, s33
  s_add_u32 s32, s32, 344064
  s_add_u32 s33, s33, 229376
  s_waitcnt vmcnt(8)
  s_barrier
  ds_read_b128 v[16:19], v8 offset:0
  ds_read_b128 v[20:23], v9 offset:0
  ds_read_b128 v[24:27], v10 offset:0
  ds_read_b128 v[28:31], v11 offset:0
  s_waitcnt lgkmcnt(3)
  v_mfma_f32_32x32x16_bf16 v[32:47], v[16:19], v[120:123], 0
  s_add_u32 s22, s27, 1048576
  s_add_u32 m0, s25, 65536
  s_nop 0
  buffer_load_dwordx4 v4, s[56:59], s22 offen offset:0 lds
  v_mfma_f32_32x32x16_bf16 v[48:63], v[16:19], v[184:187], 0
  ds_read_b128 v[16:19], v12 offset:0
  s_waitcnt lgkmcnt(3)
  v_mfma_f32_32x32x16_bf16 v[32:47], v[20:23], v[124:127], v[32:47]
  buffer_load_dwordx4 v5, s[56:59], s22 offen offset:1024 lds
  v_mfma_f32_32x32x16_bf16 v[48:63], v[20:23], v[188:191], v[48:63]
  ds_read_b128 v[20:23], v13 offset:0
  s_waitcnt lgkmcnt(3)
  v_mfma_f32_32x32x16_bf16 v[32:47], v[24:27], v[128:131], v[32:47]
  buffer_load_dwordx4 v6, s[56:59], s22 offen offset:2048 lds
  v_mfma_f32_32x32x16_bf16 v[48:63], v[24:27], v[192:195], v[48:63]
  ds_read_b128 v[24:27], v14 offset:0
  s_waitcnt lgkmcnt(3)
  v_mfma_f32_32x32x16_bf16 v[32:47], v[28:31], v[132:135], v[32:47]
  buffer_load_dwordx4 v7, s[56:59], s22 offen offset:3072 lds
  v_mfma_f32_32x32x16_bf16 v[48:63], v[28:31], v[196:199], v[48:63]
  ds_read_b128 v[28:31], v15 offset:0
  s_waitcnt lgkmcnt(3)
  v_mfma_f32_32x32x16_bf16 v[32:47], v[16:19], v[136:139], v[32:47]
  s_add_u32 s22, s27, 1310720
  s_add_u32 m0, s25, 81920
  s_nop 0
  buffer_load_dwordx4 v4, s[56:59], s22 offen offset:0 lds
  v_mfma_f32_32x32x16_bf16 v[48:63], v[16:19], v[200:203], v[48:63]
  ds_read_b128 v[16:19], v8 offset:256
  s_waitcnt lgkmcnt(3)
  v_mfma_f32_32x32x16_bf16 v[32:47], v[20:23], v[140:143], v[32:47]
  buffer_load_dwordx4 v5, s[56:59], s22 offen offset:1024 lds
  v_mfma_f32_32x32x16_bf16 v[48:63], v[20:23], v[204:207], v[48:63]
  ds_read_b128 v[20:23], v9 offset:256
  s_waitcnt lgkmcnt(3)
  v_mfma_f32_32x32x16_bf16 v[32:47], v[24:27], v[144:147], v[32:47]
  buffer_load_dwordx4 v6, s[56:59], s22 offen offset:2048 lds
  v_mfma_f32_32x32x16_bf16 v[48:63], v[24:27], v[208:211], v[48:63]
  ds_read_b128 v[24:27], v10 offset:256
  s_waitcnt lgkmcnt(3)
  v_mfma_f32_32x32x16_bf16 v[32:47], v[28:31], v[148:151], v[32:47]
  buffer_load_dwordx4 v7, s[56:59], s22 offen offset:3072 lds
  v_mfma_f32_32x32x16_bf16 v[48:63], v[28:31], v[212:215], v[48:63]
  ds_read_b128 v[28:31], v11 offset:256
  s_waitcnt lgkmcnt(3)
  v_mfma_f32_32x32x16_bf16 v[32:47], v[16:19], v[152:155], v[32:47]
  s_add_u32 s22, s27, 1572864
  s_add_u32 m0, s25, 98304
  s_nop 0
  buffer_load_dwordx4 v4, s[56:59], s22 offen offset:0 lds
  v_mfma_f32_32x32x16_bf16 v[48:63], v[16:19], v[216:219], v[48:63]
  ds_read_b128 v[16:19], v12 offset:256
  s_waitcnt lgkmcnt(3)
  v_mfma_f32_32x32x16_bf16 v[32:47], v[20:23], v[156:159], v[32:47]
  buffer_load_dwordx4 v5, s[56:59], s22 offen offset:1024 lds
  v_mfma_f32_32x32x16_bf16 v[48:63], v[20:23], v[220:223], v[48:63]
  ds_read_b128 v[20:23], v13 offset:256
  s_waitcnt lgkmcnt(3)
  v_mfma_f32_32x32x16_bf16 v[32:47], v[24:27], v[160:163], v[32:47]
  buffer_load_dwordx4 v6, s[56:59], s22 offen offset:2048 lds
  v_mfma_f32_32x32x16_bf16 v[48:63], v[24:27], v[224:227], v[48:63]
  ds_read_b128 v[24:27], v14 offset:256
  s_waitcnt lgkmcnt(3)
  v_mfma_f32_32x32x16_bf16 v[32:47], v[28:31], v[164:167], v[32:47]
  buffer_load_dwordx4 v7, s[56:59], s22 offen offset:3072 lds
  v_mfma_f32_32x32x16_bf16 v[48:63], v[28:31], v[228:231], v[48:63]
  ds_read_b128 v[28:31], v15 offset:256
  s_waitcnt lgkmcnt(3)
  v_mfma_f32_32x32x16_bf16 v[32:47], v[16:19], v[168:171], v[32:47]
  s_add_u32 s22, s27, 1835008
  s_add_u32 m0, s25, 114688
  s_nop 0
  buffer_load_dwordx4 v4, s[56:59], s22 offen offset:0 lds
  v_mfma_f32_32x32x16_bf16 v[48:63], v[16:19], v[232:235], v[48:63]
  ds_read_b128 v[16:19], v8 offset:16384
  s_waitcnt lgkmcnt(3)
  v_mfma_f32_32x32x16_bf16 v[32:47], v[20:23], v[172:175], v[32:47]
  buffer_load_dwordx4 v5, s[56:59], s22 offen offset:1024 lds
  v_mfma_f32_32x32x16_bf16 v[48:63], v[20:23], v[236:239], v[48:63]
  ds_read_b128 v[20:23], v9 offset:16384
  s_waitcnt lgkmcnt(3)
  v_mfma_f32_32x32x16_bf16 v[32:47], v[24:27], v[176:179], v[32:47]
  buffer_load_dwordx4 v6, s[56:59], s22 offen offset:2048 lds
  v_mfma_f32_32x32x16_bf16 v[48:63], v[24:27], v[240:243], v[48:63]
  ds_read_b128 v[24:27], v10 offset:16384
  s_waitcnt lgkmcnt(3)
  v_mfma_f32_32x32x16_bf16 v[32:47], v[28:31], v[180:183], v[32:47]
  buffer_load_dwordx4 v7, s[56:59], s22 offen offset:3072 lds
  v_mfma_f32_32x32x16_bf16 v[48:63], v[28:31], v[244:247], v[48:63]
  s_waitcnt vmcnt(16)
  s_barrier
  ds_read_b128 v[28:31], v11 offset:16384
  s_waitcnt lgkmcnt(3)
  v_mfma_f32_32x32x16_bf16 v[64:79], v[16:19], v[120:123], 0
  s_add_u32 s22, s27, 2097152
  s_add_u32 m0, s25, 131072
  s_nop 0
  buffer_load_dwordx4 v4, s[56:59], s22 offen offset:0 lds
  v_mfma_f32_32x32x16_bf16 v[80:95], v[16:19], v[184:187], 0
  ds_read_b128 v[16:19], v12 offset:16384
  s_waitcnt lgkmcnt(3)
  v_mfma_f32_32x32x16_bf16 v[64:79], v[20:23], v[124:127], v[64:79]
  buffer_load_dwordx4 v5, s[56:59], s22 offen offset:1024 lds
  v_mul_f32 v32, s52, v32
  v_mul_f32 v33, s52, v33
  v_cvt_pk_bf16_f32 v32, v32, v33
  v_mfma_f32_32x32x16_bf16 v[80:95], v[20:23], v[188:191], v[80:95]
  v_mul_f32 v34, s52, v34
  v_mul_f32 v35, s52, v35
  ds_read_b128 v[20:23], v13 offset:16384
  s_waitcnt lgkmcnt(3)
  v_mfma_f32_32x32x16_bf16 v[64:79], v[24:27], v[128:131], v[64:79]
  buffer_load_dwordx4 v6, s[56:59], s22 offen offset:2048 lds
  v_cvt_pk_bf16_f32 v33, v34, v35
  v_mul_f32 v36, s52, v36
  v_mul_f32 v37, s52, v37
  v_mfma_f32_32x32x16_bf16 v[80:95], v[24:27], v[192:195], v[80:95]
  v_cvt_pk_bf16_f32 v34, v36, v37
  v_mul_f32 v38, s52, v38
  ds_read_b128 v[24:27], v14 offset:16384
  s_waitcnt lgkmcnt(3)
  v_mfma_f32_32x32x16_bf16 v[64:79], v[28:31], v[132:135], v[64:79]
  buffer_load_dwordx4 v7, s[56:59], s22 offen offset:3072 lds
  v_mul_f32 v39, s52, v39
  v_cvt_pk_bf16_f32 v35, v38, v39
  v_mul_f32 v40, s52, v40
  v_mfma_f32_32x32x16_bf16 v[80:95], v[28:31], v[196:199], v[80:95]
  v_mul_f32 v41, s52, v41
  v_cvt_pk_bf16_f32 v40, v40, v41
  ds_read_b128 v[28:31], v15 offset:16384
  s_waitcnt lgkmcnt(3)
  v_mfma_f32_32x32x16_bf16 v[64:79], v[16:19], v[136:139], v[64:79]
  s_add_u32 s22, s27, 2359296
  s_add_u32 m0, s25, 0
  s_nop 0
  buffer_load_dwordx4 v4, s[56:59], s22 offen offset:0 lds
  v_mul_f32 v42, s52, v42
  v_mul_f32 v43, s52, v43
  v_cvt_pk_bf16_f32 v41, v42, v43
  v_mfma_f32_32x32x16_bf16 v[80:95], v[16:19], v[200:203], v[80:95]
  v_mul_f32 v44, s52, v44
  v_mul_f32 v45, s52, v45
  ds_read_b128 v[16:19], v8 offset:16640
  s_waitcnt lgkmcnt(3)
  v_mfma_f32_32x32x16_bf16 v[64:79], v[20:23], v[140:143], v[64:79]
  buffer_load_dwordx4 v5, s[56:59], s22 offen offset:1024 lds
  v_cvt_pk_bf16_f32 v42, v44, v45
  v_mul_f32 v46, s52, v46
  v_mul_f32 v47, s52, v47
  v_mfma_f32_32x32x16_bf16 v[80:95], v[20:23], v[204:207], v[80:95]
  v_cvt_pk_bf16_f32 v43, v46, v47
  v_permlane16_swap_b32 v32, v40
  ds_read_b128 v[20:23], v9 offset:16640
  s_waitcnt lgkmcnt(3)
  v_mfma_f32_32x32x16_bf16 v[64:79], v[24:27], v[144:147], v[64:79]
  buffer_load_dwordx4 v6, s[56:59], s22 offen offset:2048 lds
  v_permlane16_swap_b32 v33, v41
  v_permlane16_swap_b32 v34, v42
  v_permlane16_swap_b32 v35, v43
  v_mfma_f32_32x32x16_bf16 v[80:95], v[24:27], v[208:211], v[80:95]
  v_accvgpr_write_b32 a0, v32
  v_accvgpr_write_b32 a1, v33
  ds_read_b128 v[24:27], v10 offset:16640
  s_waitcnt lgkmcnt(3)
  v_mfma_f32_32x32x16_bf16 v[64:79], v[28:31], v[148:151], v[64:79]
  buffer_load_dwordx4 v7, s[56:59], s22 offen offset:3072 lds
  v_accvgpr_write_b32 a2, v34
  v_accvgpr_write_b32 a3, v35
  v_accvgpr_write_b32 a56, v40
  v_mfma_f32_32x32x16_bf16 v[80:95], v[28:31], v[212:215], v[80:95]
  v_accvgpr_write_b32 a57, v41
  v_accvgpr_write_b32 a58, v42
  ds_read_b128 v[28:31], v11 offset:16640
  s_waitcnt lgkmcnt(3)
  v_mfma_f32_32x32x16_bf16 v[64:79], v[16:19], v[152:155], v[64:79]
  v_accvgpr_write_b32 a59, v43
  v_mul_f32 v48, s52, v48
  v_mul_f32 v49, s52, v49
  v_mfma_f32_32x32x16_bf16 v[80:95], v[16:19], v[216:219], v[80:95]
  v_cvt_pk_bf16_f32 v48, v48, v49
  v_mul_f32 v50, s52, v50
  ds_read_b128 v[16:19], v12 offset:16640
  s_waitcnt lgkmcnt(3)
  v_mfma_f32_32x32x16_bf16 v[64:79], v[20:23], v[156:159], v[64:79]
  v_mul_f32 v51, s52, v51
  v_cvt_pk_bf16_f32 v49, v50, v51
  v_mul_f32 v52, s52, v52
  v_mfma_f32_32x32x16_bf16 v[80:95], v[20:23], v[220:223], v[80:95]
  v_mul_f32 v53, s52, v53
  v_cvt_pk_bf16_f32 v50, v52, v53
  ds_read_b128 v[20:23], v13 offset:16640
  s_waitcnt lgkmcnt(3)
  v_mfma_f32_32x32x16_bf16 v[64:79], v[24:27], v[160:163], v[64:79]
  v_mul_f32 v54, s52, v54
  v_mul_f32 v55, s52, v55
  v_cvt_pk_bf16_f32 v51, v54, v55
  v_mfma_f32_32x32x16_bf16 v[80:95], v[24:27], v[224:227], v[80:95]
  v_mul_f32 v56, s52, v56
  v_mul_f32 v57, s52, v57
  ds_read_b128 v[24:27], v14 offset:16640
  s_waitcnt lgkmcnt(3)
  v_mfma_f32_32x32x16_bf16 v[64:79], v[28:31], v[164:167], v[64:79]
  v_cvt_pk_bf16_f32 v56, v56, v57
  v_mul_f32 v58, s52, v58
  v_mul_f32 v59, s52, v59
  v_mfma_f32_32x32x16_bf16 v[80:95], v[28:31], v[228:231], v[80:95]
  v_cvt_pk_bf16_f32 v57, v58, v59
  v_mul_f32 v60, s52, v60
  ds_read_b128 v[28:31], v15 offset:16640
  s_waitcnt lgkmcnt(3)
  v_mfma_f32_32x32x16_bf16 v[64:79], v[16:19], v[168:171], v[64:79]
  v_mul_f32 v61, s52, v61
  v_cvt_pk_bf16_f32 v58, v60, v61
  v_mul_f32 v62, s52, v62
  v_mfma_f32_32x32x16_bf16 v[80:95], v[16:19], v[232:235], v[80:95]
  v_mul_f32 v63, s52, v63
  v_cvt_pk_bf16_f32 v59, v62, v63
  ds_read_b128 v[16:19], v8 offset:32768
  s_waitcnt lgkmcnt(3)
  v_mfma_f32_32x32x16_bf16 v[64:79], v[20:23], v[172:175], v[64:79]
  v_permlane16_swap_b32 v48, v56
  v_permlane16_swap_b32 v49, v57
  v_permlane16_swap_b32 v50, v58
  v_mfma_f32_32x32x16_bf16 v[80:95], v[20:23], v[236:239], v[80:95]
  v_permlane16_swap_b32 v51, v59
  v_accvgpr_write_b32 a112, v48
  ds_read_b128 v[20:23], v9 offset:32768
  s_waitcnt lgkmcnt(3)
  v_mfma_f32_32x32x16_bf16 v[64:79], v[24:27], v[176:179], v[64:79]
  v_accvgpr_write_b32 a113, v49
  v_accvgpr_write_b32 a114, v50
  v_accvgpr_write_b32 a115, v51
  v_mfma_f32_32x32x16_bf16 v[80:95], v[24:27], v[240:243], v[80:95]
  v_accvgpr_write_b32 a168, v56
  v_accvgpr_write_b32 a169, v57
  ds_read_b128 v[24:27], v10 offset:32768
  s_waitcnt lgkmcnt(3)
  v_mfma_f32_32x32x16_bf16 v[64:79], v[28:31], v[180:183], v[64:79]
  v_accvgpr_write_b32 a170, v58
  v_accvgpr_write_b32 a171, v59
  v_mfma_f32_32x32x16_bf16 v[80:95], v[28:31], v[244:247], v[80:95]
  ds_read_b128 v[28:31], v11 offset:32768
  s_waitcnt lgkmcnt(3)
  v_mfma_f32_32x32x16_bf16 v[32:47], v[16:19], v[120:123], 0
  v_mfma_f32_32x32x16_bf16 v[48:63], v[16:19], v[184:187], 0
  ds_read_b128 v[16:19], v12 offset:32768
  s_waitcnt lgkmcnt(3)
  v_mfma_f32_32x32x16_bf16 v[32:47], v[20:23], v[124:127], v[32:47]
  v_mul_f32 v64, s52, v64
  v_mul_f32 v65, s52, v65
  v_cvt_pk_bf16_f32 v64, v64, v65
  v_mfma_f32_32x32x16_bf16 v[48:63], v[20:23], v[188:191], v[48:63]
  v_mul_f32 v66, s52, v66
  v_mul_f32 v67, s52, v67
  ds_read_b128 v[20:23], v13 offset:32768
  s_waitcnt lgkmcnt(3)
  v_mfma_f32_32x32x16_bf16 v[32:47], v[24:27], v[128:131], v[32:47]
  v_cvt_pk_bf16_f32 v65, v66, v67
  v_mul_f32 v68, s52, v68
  v_mul_f32 v69, s52, v69
  v_mfma_f32_32x32x16_bf16 v[48:63], v[24:27], v[192:195], v[48:63]
  v_cvt_pk_bf16_f32 v66, v68, v69
  v_mul_f32 v70, s52, v70
  ds_read_b128 v[24:27], v14 offset:32768
  s_waitcnt lgkmcnt(3)
  v_mfma_f32_32x32x16_bf16 v[32:47], v[28:31], v[132:135], v[32:47]
  v_mul_f32 v71, s52, v71
  v_cvt_pk_bf16_f32 v67, v70, v71
  v_mul_f32 v72, s52, v72
  v_mfma_f32_32x32x16_bf16 v[48:63], v[28:31], v[196:199], v[48:63]
  v_mul_f32 v73, s52, v73
  v_cvt_pk_bf16_f32 v72, v72, v73
  ds_read_b128 v[28:31], v15 offset:32768
  s_waitcnt lgkmcnt(3)
  v_mfma_f32_32x32x16_bf16 v[32:47], v[16:19], v[136:139], v[32:47]
  v_mul_f32 v74, s52, v74
  v_mul_f32 v75, s52, v75
  v_cvt_pk_bf16_f32 v73, v74, v75
  v_mfma_f32_32x32x16_bf16 v[48:63], v[16:19], v[200:203], v[48:63]
  v_mul_f32 v76, s52, v76
  v_mul_f32 v77, s52, v77
  ds_read_b128 v[16:19], v8 offset:33024
  s_waitcnt lgkmcnt(3)
  v_mfma_f32_32x32x16_bf16 v[32:47], v[20:23], v[140:143], v[32:47]
  v_cvt_pk_bf16_f32 v74, v76, v77
  v_mul_f32 v78, s52, v78
  v_mul_f32 v79, s52, v79
  v_mfma_f32_32x32x16_bf16 v[48:63], v[20:23], v[204:207], v[48:63]
  v_cvt_pk_bf16_f32 v75, v78, v79
  v_permlane16_swap_b32 v64, v72
  ds_read_b128 v[20:23], v9 offset:33024
  s_waitcnt lgkmcnt(3)
  v_mfma_f32_32x32x16_bf16 v[32:47], v[24:27], v[144:147], v[32:47]
  v_permlane16_swap_b32 v65, v73
  v_permlane16_swap_b32 v66, v74
  v_permlane16_swap_b32 v67, v75
  v_mfma_f32_32x32x16_bf16 v[48:63], v[24:27], v[208:211], v[48:63]
  v_accvgpr_write_b32 a4, v64
  v_accvgpr_write_b32 a5, v65
  ds_read_b128 v[24:27], v10 offset:33024
  s_waitcnt lgkmcnt(3)
  v_mfma_f32_32x32x16_bf16 v[32:47], v[28:31], v[148:151], v[32:47]
  v_accvgpr_write_b32 a6, v66
  v_accvgpr_write_b32 a7, v67
  v_accvgpr_write_b32 a60, v72
  v_mfma_f32_32x32x16_bf16 v[48:63], v[28:31], v[212:215], v[48:63]
  v_accvgpr_write_b32 a61, v73
  v_accvgpr_write_b32 a62, v74
  ds_read_b128 v[28:31], v11 offset:33024
  s_waitcnt lgkmcnt(3)
  v_mfma_f32_32x32x16_bf16 v[32:47], v[16:19], v[152:155], v[32:47]
  v_accvgpr_write_b32 a63, v75
  v_mul_f32 v80, s52, v80
  v_mul_f32 v81, s52, v81
  v_mfma_f32_32x32x16_bf16 v[48:63], v[16:19], v[216:219], v[48:63]
  v_cvt_pk_bf16_f32 v80, v80, v81
  v_mul_f32 v82, s52, v82
  ds_read_b128 v[16:19], v12 offset:33024
  s_waitcnt lgkmcnt(3)
  v_mfma_f32_32x32x16_bf16 v[32:47], v[20:23], v[156:159], v[32:47]
  v_mul_f32 v83, s52, v83
  v_cvt_pk_bf16_f32 v81, v82, v83
  v_mul_f32 v84, s52, v84
  v_mfma_f32_32x32x16_bf16 v[48:63], v[20:23], v[220:223], v[48:63]
  v_mul_f32 v85, s52, v85
  v_cvt_pk_bf16_f32 v82, v84, v85
  ds_read_b128 v[20:23], v13 offset:33024
  s_waitcnt lgkmcnt(3)
  v_mfma_f32_32x32x16_bf16 v[32:47], v[24:27], v[160:163], v[32:47]
  v_mul_f32 v86, s52, v86
  v_mul_f32 v87, s52, v87
  v_cvt_pk_bf16_f32 v83, v86, v87
  v_mfma_f32_32x32x16_bf16 v[48:63], v[24:27], v[224:227], v[48:63]
  v_mul_f32 v88, s52, v88
  v_mul_f32 v89, s52, v89
  ds_read_b128 v[24:27], v14 offset:33024
  s_waitcnt lgkmcnt(3)
  v_mfma_f32_32x32x16_bf16 v[32:47], v[28:31], v[164:167], v[32:47]
  v_cvt_pk_bf16_f32 v88, v88, v89
  v_mul_f32 v90, s52, v90
  v_mul_f32 v91, s52, v91
  v_mfma_f32_32x32x16_bf16 v[48:63], v[28:31], v[228:231], v[48:63]
  v_cvt_pk_bf16_f32 v89, v90, v91
  v_mul_f32 v92, s52, v92
  ds_read_b128 v[28:31], v15 offset:33024
  s_waitcnt lgkmcnt(3)
  v_mfma_f32_32x32x16_bf16 v[32:47], v[16:19], v[168:171], v[32:47]
  v_mul_f32 v93, s52, v93
  v_cvt_pk_bf16_f32 v90, v92, v93
  v_mul_f32 v94, s52, v94
  v_mfma_f32_32x32x16_bf16 v[48:63], v[16:19], v[232:235], v[48:63]
  v_mul_f32 v95, s52, v95
  v_cvt_pk_bf16_f32 v91, v94, v95
  ds_read_b128 v[16:19], v8 offset:49152
  s_waitcnt lgkmcnt(3)
  v_mfma_f32_32x32x16_bf16 v[32:47], v[20:23], v[172:175], v[32:47]
  v_permlane16_swap_b32 v80, v88
  v_permlane16_swap_b32 v81, v89
  v_permlane16_swap_b32 v82, v90
  v_mfma_f32_32x32x16_bf16 v[48:63], v[20:23], v[236:239], v[48:63]
  v_permlane16_swap_b32 v83, v91
  v_accvgpr_write_b32 a116, v80
  ds_read_b128 v[20:23], v9 offset:49152
  s_waitcnt lgkmcnt(3)
  v_mfma_f32_32x32x16_bf16 v[32:47], v[24:27], v[176:179], v[32:47]
  v_accvgpr_write_b32 a117, v81
  v_accvgpr_write_b32 a118, v82
  v_accvgpr_write_b32 a119, v83
  v_mfma_f32_32x32x16_bf16 v[48:63], v[24:27], v[240:243], v[48:63]
  v_accvgpr_write_b32 a172, v88
  v_accvgpr_write_b32 a173, v89
  ds_read_b128 v[24:27], v10 offset:49152
  s_waitcnt lgkmcnt(3)
  v_mfma_f32_32x32x16_bf16 v[32:47], v[28:31], v[180:183], v[32:47]
  v_accvgpr_write_b32 a174, v90
  v_accvgpr_write_b32 a175, v91
  v_mfma_f32_32x32x16_bf16 v[48:63], v[28:31], v[244:247], v[48:63]
  s_waitcnt vmcnt(16)
  s_barrier
  ds_read_b128 v[28:31], v11 offset:49152
  s_waitcnt lgkmcnt(3)
  v_mfma_f32_32x32x16_bf16 v[64:79], v[16:19], v[120:123], 0
  s_add_u32 s22, s27, 2621440
  s_add_u32 m0, s25, 16384
  s_nop 0
  buffer_load_dwordx4 v4, s[56:59], s22 offen offset:0 lds
  v_mfma_f32_32x32x16_bf16 v[80:95], v[16:19], v[184:187], 0
  ds_read_b128 v[16:19], v12 offset:49152
  s_waitcnt lgkmcnt(3)
  v_mfma_f32_32x32x16_bf16 v[64:79], v[20:23], v[124:127], v[64:79]
  buffer_load_dwordx4 v5, s[56:59], s22 offen offset:1024 lds
  v_mul_f32 v32, s52, v32
  v_mul_f32 v33, s52, v33
  v_cvt_pk_bf16_f32 v32, v32, v33
  v_mfma_f32_32x32x16_bf16 v[80:95], v[20:23], v[188:191], v[80:95]
  v_mul_f32 v34, s52, v34
  v_mul_f32 v35, s52, v35
  ds_read_b128 v[20:23], v13 offset:49152
  s_waitcnt lgkmcnt(3)
  v_mfma_f32_32x32x16_bf16 v[64:79], v[24:27], v[128:131], v[64:79]
  buffer_load_dwordx4 v6, s[56:59], s22 offen offset:2048 lds
  v_cvt_pk_bf16_f32 v33, v34, v35
  v_mul_f32 v36, s52, v36
  v_mul_f32 v37, s52, v37
  v_mfma_f32_32x32x16_bf16 v[80:95], v[24:27], v[192:195], v[80:95]
  v_cvt_pk_bf16_f32 v34, v36, v37
  v_mul_f32 v38, s52, v38
  ds_read_b128 v[24:27], v14 offset:49152
  s_waitcnt lgkmcnt(3)
  v_mfma_f32_32x32x16_bf16 v[64:79], v[28:31], v[132:135], v[64:79]
  buffer_load_dwordx4 v7, s[56:59], s22 offen offset:3072 lds
  v_mul_f32 v39, s52, v39
  v_cvt_pk_bf16_f32 v35, v38, v39
  v_mul_f32 v40, s52, v40
  v_mfma_f32_32x32x16_bf16 v[80:95], v[28:31], v[196:199], v[80:95]
  v_mul_f32 v41, s52, v41
  v_cvt_pk_bf16_f32 v40, v40, v41
  ds_read_b128 v[28:31], v15 offset:49152
  s_waitcnt lgkmcnt(3)
  v_mfma_f32_32x32x16_bf16 v[64:79], v[16:19], v[136:139], v[64:79]
  s_add_u32 s22, s27, 2883584
  s_add_u32 m0, s25, 32768
  s_nop 0
  buffer_load_dwordx4 v4, s[56:59], s22 offen offset:0 lds
  v_mul_f32 v42, s52, v42
  v_mul_f32 v43, s52, v43
  v_cvt_pk_bf16_f32 v41, v42, v43
  v_mfma_f32_32x32x16_bf16 v[80:95], v[16:19], v[200:203], v[80:95]
  v_mul_f32 v44, s52, v44
  v_mul_f32 v45, s52, v45
  ds_read_b128 v[16:19], v8 offset:49408
  s_waitcnt lgkmcnt(3)
  v_mfma_f32_32x32x16_bf16 v[64:79], v[20:23], v[140:143], v[64:79]
  buffer_load_dwordx4 v5, s[56:59], s22 offen offset:1024 lds
  v_cvt_pk_bf16_f32 v42, v44, v45
  v_mul_f32 v46, s52, v46
  v_mul_f32 v47, s52, v47
  v_mfma_f32_32x32x16_bf16 v[80:95], v[20:23], v[204:207], v[80:95]
  v_cvt_pk_bf16_f32 v43, v46, v47
  v_permlane16_swap_b32 v32, v40
  ds_read_b128 v[20:23], v9 offset:49408
  s_waitcnt lgkmcnt(3)
  v_mfma_f32_32x32x16_bf16 v[64:79], v[24:27], v[144:147], v[64:79]
  buffer_load_dwordx4 v6, s[56:59], s22 offen offset:2048 lds
  v_permlane16_swap_b32 v33, v41
  v_permlane16_swap_b32 v34, v42
  v_permlane16_swap_b32 v35, v43
  v_mfma_f32_32x32x16_bf16 v[80:95], v[24:27], v[208:211], v[80:95]
  v_accvgpr_write_b32 a8, v32
  v_accvgpr_write_b32 a9, v33
  ds_read_b128 v[24:27], v10 offset:49408
  s_waitcnt lgkmcnt(3)
  v_mfma_f32_32x32x16_bf16 v[64:79], v[28:31], v[148:151], v[64:79]
  buffer_load_dwordx4 v7, s[56:59], s22 offen offset:3072 lds
  v_accvgpr_write_b32 a10, v34
  v_accvgpr_write_b32 a11, v35
  v_accvgpr_write_b32 a64, v40
  v_mfma_f32_32x32x16_bf16 v[80:95], v[28:31], v[212:215], v[80:95]
  v_accvgpr_write_b32 a65, v41
  v_accvgpr_write_b32 a66, v42
  ds_read_b128 v[28:31], v11 offset:49408
  s_waitcnt lgkmcnt(3)
  v_mfma_f32_32x32x16_bf16 v[64:79], v[16:19], v[152:155], v[64:79]
  v_accvgpr_write_b32 a67, v43
  v_mul_f32 v48, s52, v48
  v_mul_f32 v49, s52, v49
  v_mfma_f32_32x32x16_bf16 v[80:95], v[16:19], v[216:219], v[80:95]
  v_cvt_pk_bf16_f32 v48, v48, v49
  v_mul_f32 v50, s52, v50
  ds_read_b128 v[16:19], v12 offset:49408
  s_waitcnt lgkmcnt(3)
  v_mfma_f32_32x32x16_bf16 v[64:79], v[20:23], v[156:159], v[64:79]
  v_mul_f32 v51, s52, v51
  v_cvt_pk_bf16_f32 v49, v50, v51
  v_mul_f32 v52, s52, v52
  v_mfma_f32_32x32x16_bf16 v[80:95], v[20:23], v[220:223], v[80:95]
  v_mul_f32 v53, s52, v53
  v_cvt_pk_bf16_f32 v50, v52, v53
  ds_read_b128 v[20:23], v13 offset:49408
  s_waitcnt lgkmcnt(3)
  v_mfma_f32_32x32x16_bf16 v[64:79], v[24:27], v[160:163], v[64:79]
  v_mul_f32 v54, s52, v54
  v_mul_f32 v55, s52, v55
  v_cvt_pk_bf16_f32 v51, v54, v55
  v_mfma_f32_32x32x16_bf16 v[80:95], v[24:27], v[224:227], v[80:95]
  v_mul_f32 v56, s52, v56
  v_mul_f32 v57, s52, v57
  ds_read_b128 v[24:27], v14 offset:49408
  s_waitcnt lgkmcnt(3)
  v_mfma_f32_32x32x16_bf16 v[64:79], v[28:31], v[164:167], v[64:79]
  v_cvt_pk_bf16_f32 v56, v56, v57
  v_mul_f32 v58, s52, v58
  v_mul_f32 v59, s52, v59
  v_mfma_f32_32x32x16_bf16 v[80:95], v[28:31], v[228:231], v[80:95]
  v_cvt_pk_bf16_f32 v57, v58, v59
  v_mul_f32 v60, s52, v60
  ds_read_b128 v[28:31], v15 offset:49408
  s_waitcnt lgkmcnt(3)
  v_mfma_f32_32x32x16_bf16 v[64:79], v[16:19], v[168:171], v[64:79]
  v_mul_f32 v61, s52, v61
  v_cvt_pk_bf16_f32 v58, v60, v61
  v_mul_f32 v62, s52, v62
  v_mfma_f32_32x32x16_bf16 v[80:95], v[16:19], v[232:235], v[80:95]
  v_mul_f32 v63, s52, v63
  v_cvt_pk_bf16_f32 v59, v62, v63
  v_xor_b32 v8, 65536, v8
  ds_read_b128 v[16:19], v8 offset:0
  s_waitcnt lgkmcnt(3)
  v_mfma_f32_32x32x16_bf16 v[64:79], v[20:23], v[172:175], v[64:79]
  v_permlane16_swap_b32 v48, v56
  v_permlane16_swap_b32 v49, v57
  v_permlane16_swap_b32 v50, v58
  v_mfma_f32_32x32x16_bf16 v[80:95], v[20:23], v[236:239], v[80:95]
  v_permlane16_swap_b32 v51, v59
  v_accvgpr_write_b32 a120, v48
  v_xor_b32 v9, 65536, v9
  ds_read_b128 v[20:23], v9 offset:0
  s_waitcnt lgkmcnt(3)
  v_mfma_f32_32x32x16_bf16 v[64:79], v[24:27], v[176:179], v[64:79]
  v_accvgpr_write_b32 a121, v49
  v_accvgpr_write_b32 a122, v50
  v_accvgpr_write_b32 a123, v51
  v_mfma_f32_32x32x16_bf16 v[80:95], v[24:27], v[240:243], v[80:95]
  v_accvgpr_write_b32 a176, v56
  v_accvgpr_write_b32 a177, v57
  v_xor_b32 v10, 65536, v10
  ds_read_b128 v[24:27], v10 offset:0
  s_waitcnt lgkmcnt(3)
  v_mfma_f32_32x32x16_bf16 v[64:79], v[28:31], v[180:183], v[64:79]
  v_accvgpr_write_b32 a178, v58
  v_accvgpr_write_b32 a179, v59
  v_mfma_f32_32x32x16_bf16 v[80:95], v[28:31], v[244:247], v[80:95]
  v_xor_b32 v11, 65536, v11
  ds_read_b128 v[28:31], v11 offset:0
  s_waitcnt lgkmcnt(3)
  v_mfma_f32_32x32x16_bf16 v[32:47], v[16:19], v[120:123], 0
  v_mfma_f32_32x32x16_bf16 v[48:63], v[16:19], v[184:187], 0
  v_xor_b32 v12, 65536, v12
  ds_read_b128 v[16:19], v12 offset:0
  s_waitcnt lgkmcnt(3)
  v_mfma_f32_32x32x16_bf16 v[32:47], v[20:23], v[124:127], v[32:47]
  v_mul_f32 v64, s52, v64
  v_mul_f32 v65, s52, v65
  v_cvt_pk_bf16_f32 v64, v64, v65
  v_mfma_f32_32x32x16_bf16 v[48:63], v[20:23], v[188:191], v[48:63]
  v_mul_f32 v66, s52, v66
  v_mul_f32 v67, s52, v67
  v_xor_b32 v13, 65536, v13
  ds_read_b128 v[20:23], v13 offset:0
  s_waitcnt lgkmcnt(3)
  v_mfma_f32_32x32x16_bf16 v[32:47], v[24:27], v[128:131], v[32:47]
  v_cvt_pk_bf16_f32 v65, v66, v67
  v_mul_f32 v68, s52, v68
  v_mul_f32 v69, s52, v69
  v_mfma_f32_32x32x16_bf16 v[48:63], v[24:27], v[192:195], v[48:63]
  v_cvt_pk_bf16_f32 v66, v68, v69
  v_mul_f32 v70, s52, v70
  v_xor_b32 v14, 65536, v14
  ds_read_b128 v[24:27], v14 offset:0
  s_waitcnt lgkmcnt(3)
  v_mfma_f32_32x32x16_bf16 v[32:47], v[28:31], v[132:135], v[32:47]
  v_mul_f32 v71, s52, v71
  v_cvt_pk_bf16_f32 v67, v70, v71
  v_mul_f32 v72, s52, v72
  v_mfma_f32_32x32x16_bf16 v[48:63], v[28:31], v[196:199], v[48:63]
  v_mul_f32 v73, s52, v73
  v_cvt_pk_bf16_f32 v72, v72, v73
  v_xor_b32 v15, 65536, v15
  ds_read_b128 v[28:31], v15 offset:0
  s_waitcnt lgkmcnt(3)
  v_mfma_f32_32x32x16_bf16 v[32:47], v[16:19], v[136:139], v[32:47]
  v_mul_f32 v74, s52, v74
  v_mul_f32 v75, s52, v75
  v_cvt_pk_bf16_f32 v73, v74, v75
  v_mfma_f32_32x32x16_bf16 v[48:63], v[16:19], v[200:203], v[48:63]
  v_mul_f32 v76, s52, v76
  v_mul_f32 v77, s52, v77
  ds_read_b128 v[16:19], v8 offset:256
  s_waitcnt lgkmcnt(3)
  v_mfma_f32_32x32x16_bf16 v[32:47], v[20:23], v[140:143], v[32:47]
  v_cvt_pk_bf16_f32 v74, v76, v77
  v_mul_f32 v78, s52, v78
  v_mul_f32 v79, s52, v79
  v_mfma_f32_32x32x16_bf16 v[48:63], v[20:23], v[204:207], v[48:63]
  v_cvt_pk_bf16_f32 v75, v78, v79
  v_permlane16_swap_b32 v64, v72
  ds_read_b128 v[20:23], v9 offset:256
  s_waitcnt lgkmcnt(3)
  v_mfma_f32_32x32x16_bf16 v[32:47], v[24:27], v[144:147], v[32:47]
  v_permlane16_swap_b32 v65, v73
  v_permlane16_swap_b32 v66, v74
  v_permlane16_swap_b32 v67, v75
  v_mfma_f32_32x32x16_bf16 v[48:63], v[24:27], v[208:211], v[48:63]
  v_accvgpr_write_b32 a12, v64
  v_accvgpr_write_b32 a13, v65
  ds_read_b128 v[24:27], v10 offset:256
  s_waitcnt lgkmcnt(3)
  v_mfma_f32_32x32x16_bf16 v[32:47], v[28:31], v[148:151], v[32:47]
  v_accvgpr_write_b32 a14, v66
  v_accvgpr_write_b32 a15, v67
  v_accvgpr_write_b32 a68, v72
  v_mfma_f32_32x32x16_bf16 v[48:63], v[28:31], v[212:215], v[48:63]
  v_accvgpr_write_b32 a69, v73
  v_accvgpr_write_b32 a70, v74
  ds_read_b128 v[28:31], v11 offset:256
  s_waitcnt lgkmcnt(3)
  v_mfma_f32_32x32x16_bf16 v[32:47], v[16:19], v[152:155], v[32:47]
  v_accvgpr_write_b32 a71, v75
  v_mul_f32 v80, s52, v80
  v_mul_f32 v81, s52, v81
  v_mfma_f32_32x32x16_bf16 v[48:63], v[16:19], v[216:219], v[48:63]
  v_cvt_pk_bf16_f32 v80, v80, v81
  v_mul_f32 v82, s52, v82
  ds_read_b128 v[16:19], v12 offset:256
  s_waitcnt lgkmcnt(3)
  v_mfma_f32_32x32x16_bf16 v[32:47], v[20:23], v[156:159], v[32:47]
  v_mul_f32 v83, s52, v83
  v_cvt_pk_bf16_f32 v81, v82, v83
  v_mul_f32 v84, s52, v84
  v_mfma_f32_32x32x16_bf16 v[48:63], v[20:23], v[220:223], v[48:63]
  v_mul_f32 v85, s52, v85
  v_cvt_pk_bf16_f32 v82, v84, v85
  ds_read_b128 v[20:23], v13 offset:256
  s_waitcnt lgkmcnt(3)
  v_mfma_f32_32x32x16_bf16 v[32:47], v[24:27], v[160:163], v[32:47]
  v_mul_f32 v86, s52, v86
  v_mul_f32 v87, s52, v87
  v_cvt_pk_bf16_f32 v83, v86, v87
  v_mfma_f32_32x32x16_bf16 v[48:63], v[24:27], v[224:227], v[48:63]
  v_mul_f32 v88, s52, v88
  v_mul_f32 v89, s52, v89
  ds_read_b128 v[24:27], v14 offset:256
  s_waitcnt lgkmcnt(3)
  v_mfma_f32_32x32x16_bf16 v[32:47], v[28:31], v[164:167], v[32:47]
  v_cvt_pk_bf16_f32 v88, v88, v89
  v_mul_f32 v90, s52, v90
  v_mul_f32 v91, s52, v91
  v_mfma_f32_32x32x16_bf16 v[48:63], v[28:31], v[228:231], v[48:63]
  v_cvt_pk_bf16_f32 v89, v90, v91
  v_mul_f32 v92, s52, v92
  ds_read_b128 v[28:31], v15 offset:256
  s_waitcnt lgkmcnt(3)
  v_mfma_f32_32x32x16_bf16 v[32:47], v[16:19], v[168:171], v[32:47]
  v_mul_f32 v93, s52, v93
  v_cvt_pk_bf16_f32 v90, v92, v93
  v_mul_f32 v94, s52, v94
  v_mfma_f32_32x32x16_bf16 v[48:63], v[16:19], v[232:235], v[48:63]
  v_mul_f32 v95, s52, v95
  v_cvt_pk_bf16_f32 v91, v94, v95
  ds_read_b128 v[16:19], v8 offset:16384
  s_waitcnt lgkmcnt(3)
  v_mfma_f32_32x32x16_bf16 v[32:47], v[20:23], v[172:175], v[32:47]
  v_permlane16_swap_b32 v80, v88
  v_permlane16_swap_b32 v81, v89
  v_permlane16_swap_b32 v82, v90
  v_mfma_f32_32x32x16_bf16 v[48:63], v[20:23], v[236:239], v[48:63]
  v_permlane16_swap_b32 v83, v91
  v_accvgpr_write_b32 a124, v80
  ds_read_b128 v[20:23], v9 offset:16384
  s_waitcnt lgkmcnt(3)
  v_mfma_f32_32x32x16_bf16 v[32:47], v[24:27], v[176:179], v[32:47]
  v_accvgpr_write_b32 a125, v81
  v_accvgpr_write_b32 a126, v82
  v_accvgpr_write_b32 a127, v83
  v_mfma_f32_32x32x16_bf16 v[48:63], v[24:27], v[240:243], v[48:63]
  v_accvgpr_write_b32 a180, v88
  v_accvgpr_write_b32 a181, v89
  ds_read_b128 v[24:27], v10 offset:16384
  s_waitcnt lgkmcnt(3)
  v_mfma_f32_32x32x16_bf16 v[32:47], v[28:31], v[180:183], v[32:47]
  v_accvgpr_write_b32 a182, v90
  v_accvgpr_write_b32 a183, v91
  v_mfma_f32_32x32x16_bf16 v[48:63], v[28:31], v[244:247], v[48:63]
  s_waitcnt vmcnt(16)
  s_barrier
  ds_read_b128 v[28:31], v11 offset:16384
  s_waitcnt lgkmcnt(3)
  v_mfma_f32_32x32x16_bf16 v[64:79], v[16:19], v[120:123], 0
  s_add_u32 s22, s27, 3145728
  s_add_u32 m0, s25, 49152
  s_nop 0
  buffer_load_dwordx4 v4, s[56:59], s22 offen offset:0 lds
  v_mfma_f32_32x32x16_bf16 v[80:95], v[16:19], v[184:187], 0
  ds_read_b128 v[16:19], v12 offset:16384
  s_waitcnt lgkmcnt(3)
  v_mfma_f32_32x32x16_bf16 v[64:79], v[20:23], v[124:127], v[64:79]
  buffer_load_dwordx4 v5, s[56:59], s22 offen offset:1024 lds
  v_mul_f32 v32, s52, v32
  v_mul_f32 v33, s52, v33
  v_cvt_pk_bf16_f32 v32, v32, v33
  v_mfma_f32_32x32x16_bf16 v[80:95], v[20:23], v[188:191], v[80:95]
  v_mul_f32 v34, s52, v34
  v_mul_f32 v35, s52, v35
  ds_read_b128 v[20:23], v13 offset:16384
  s_waitcnt lgkmcnt(3)
  v_mfma_f32_32x32x16_bf16 v[64:79], v[24:27], v[128:131], v[64:79]
  buffer_load_dwordx4 v6, s[56:59], s22 offen offset:2048 lds
  v_cvt_pk_bf16_f32 v33, v34, v35
  v_mul_f32 v36, s52, v36
  v_mul_f32 v37, s52, v37
  v_mfma_f32_32x32x16_bf16 v[80:95], v[24:27], v[192:195], v[80:95]
  v_cvt_pk_bf16_f32 v34, v36, v37
  v_mul_f32 v38, s52, v38
  ds_read_b128 v[24:27], v14 offset:16384
  s_waitcnt lgkmcnt(3)
  v_mfma_f32_32x32x16_bf16 v[64:79], v[28:31], v[132:135], v[64:79]
  buffer_load_dwordx4 v7, s[56:59], s22 offen offset:3072 lds
  v_mul_f32 v39, s52, v39
  v_cvt_pk_bf16_f32 v35, v38, v39
  v_mul_f32 v40, s52, v40
  v_mfma_f32_32x32x16_bf16 v[80:95], v[28:31], v[196:199], v[80:95]
  v_mul_f32 v41, s52, v41
  v_cvt_pk_bf16_f32 v40, v40, v41
  ds_read_b128 v[28:31], v15 offset:16384
  s_waitcnt lgkmcnt(3)
  v_mfma_f32_32x32x16_bf16 v[64:79], v[16:19], v[136:139], v[64:79]
  s_add_u32 s22, s27, 3407872
  s_add_u32 m0, s25, 65536
  s_nop 0
  buffer_load_dwordx4 v4, s[56:59], s22 offen offset:0 lds
  v_mul_f32 v42, s52, v42
  v_mul_f32 v43, s52, v43
  v_cvt_pk_bf16_f32 v41, v42, v43
  v_mfma_f32_32x32x16_bf16 v[80:95], v[16:19], v[200:203], v[80:95]
  v_mul_f32 v44, s52, v44
  v_mul_f32 v45, s52, v45
  ds_read_b128 v[16:19], v8 offset:16640
  s_waitcnt lgkmcnt(3)
  v_mfma_f32_32x32x16_bf16 v[64:79], v[20:23], v[140:143], v[64:79]
  buffer_load_dwordx4 v5, s[56:59], s22 offen offset:1024 lds
  v_cvt_pk_bf16_f32 v42, v44, v45
  v_mul_f32 v46, s52, v46
  v_mul_f32 v47, s52, v47
  v_mfma_f32_32x32x16_bf16 v[80:95], v[20:23], v[204:207], v[80:95]
  v_cvt_pk_bf16_f32 v43, v46, v47
  v_permlane16_swap_b32 v32, v40
  ds_read_b128 v[20:23], v9 offset:16640
  s_waitcnt lgkmcnt(3)
  v_mfma_f32_32x32x16_bf16 v[64:79], v[24:27], v[144:147], v[64:79]
  buffer_load_dwordx4 v6, s[56:59], s22 offen offset:2048 lds
  v_permlane16_swap_b32 v33, v41
  v_permlane16_swap_b32 v34, v42
  v_permlane16_swap_b32 v35, v43
  v_mfma_f32_32x32x16_bf16 v[80:95], v[24:27], v[208:211], v[80:95]
  v_accvgpr_write_b32 a16, v32
  v_accvgpr_write_b32 a17, v33
  ds_read_b128 v[24:27], v10 offset:16640
  s_waitcnt lgkmcnt(3)
  v_mfma_f32_32x32x16_bf16 v[64:79], v[28:31], v[148:151], v[64:79]
  buffer_load_dwordx4 v7, s[56:59], s22 offen offset:3072 lds
  v_accvgpr_write_b32 a18, v34
  v_accvgpr_write_b32 a19, v35
  v_accvgpr_write_b32 a72, v40
  v_mfma_f32_32x32x16_bf16 v[80:95], v[28:31], v[212:215], v[80:95]
  v_accvgpr_write_b32 a73, v41
  v_accvgpr_write_b32 a74, v42
  ds_read_b128 v[28:31], v11 offset:16640
  s_waitcnt lgkmcnt(3)
  v_mfma_f32_32x32x16_bf16 v[64:79], v[16:19], v[152:155], v[64:79]
  v_accvgpr_write_b32 a75, v43
  v_mul_f32 v48, s52, v48
  v_mul_f32 v49, s52, v49
  v_mfma_f32_32x32x16_bf16 v[80:95], v[16:19], v[216:219], v[80:95]
  v_cvt_pk_bf16_f32 v48, v48, v49
  v_mul_f32 v50, s52, v50
  ds_read_b128 v[16:19], v12 offset:16640
  s_waitcnt lgkmcnt(3)
  v_mfma_f32_32x32x16_bf16 v[64:79], v[20:23], v[156:159], v[64:79]
  v_mul_f32 v51, s52, v51
  v_cvt_pk_bf16_f32 v49, v50, v51
  v_mul_f32 v52, s52, v52
  v_mfma_f32_32x32x16_bf16 v[80:95], v[20:23], v[220:223], v[80:95]
  v_mul_f32 v53, s52, v53
  v_cvt_pk_bf16_f32 v50, v52, v53
  ds_read_b128 v[20:23], v13 offset:16640
  s_waitcnt lgkmcnt(3)
  v_mfma_f32_32x32x16_bf16 v[64:79], v[24:27], v[160:163], v[64:79]
  v_mul_f32 v54, s52, v54
  v_mul_f32 v55, s52, v55
  v_cvt_pk_bf16_f32 v51, v54, v55
  v_mfma_f32_32x32x16_bf16 v[80:95], v[24:27], v[224:227], v[80:95]
  v_mul_f32 v56, s52, v56
  v_mul_f32 v57, s52, v57
  ds_read_b128 v[24:27], v14 offset:16640
  s_waitcnt lgkmcnt(3)
  v_mfma_f32_32x32x16_bf16 v[64:79], v[28:31], v[164:167], v[64:79]
  v_cvt_pk_bf16_f32 v56, v56, v57
  v_mul_f32 v58, s52, v58
  v_mul_f32 v59, s52, v59
  v_mfma_f32_32x32x16_bf16 v[80:95], v[28:31], v[228:231], v[80:95]
  v_cvt_pk_bf16_f32 v57, v58, v59
  v_mul_f32 v60, s52, v60
  ds_read_b128 v[28:31], v15 offset:16640
  s_waitcnt lgkmcnt(3)
  v_mfma_f32_32x32x16_bf16 v[64:79], v[16:19], v[168:171], v[64:79]
  v_mul_f32 v61, s52, v61
  v_cvt_pk_bf16_f32 v58, v60, v61
  v_mul_f32 v62, s52, v62
  v_mfma_f32_32x32x16_bf16 v[80:95], v[16:19], v[232:235], v[80:95]
  v_mul_f32 v63, s52, v63
  v_cvt_pk_bf16_f32 v59, v62, v63
  ds_read_b128 v[16:19], v8 offset:32768
  s_waitcnt lgkmcnt(3)
  v_mfma_f32_32x32x16_bf16 v[64:79], v[20:23], v[172:175], v[64:79]
  v_permlane16_swap_b32 v48, v56
  v_permlane16_swap_b32 v49, v57
  v_permlane16_swap_b32 v50, v58
  v_mfma_f32_32x32x16_bf16 v[80:95], v[20:23], v[236:239], v[80:95]
  v_permlane16_swap_b32 v51, v59
  v_accvgpr_write_b32 a128, v48
  ds_read_b128 v[20:23], v9 offset:32768
  s_waitcnt lgkmcnt(3)
  v_mfma_f32_32x32x16_bf16 v[64:79], v[24:27], v[176:179], v[64:79]
  v_accvgpr_write_b32 a129, v49
  v_accvgpr_write_b32 a130, v50
  v_accvgpr_write_b32 a131, v51
  v_mfma_f32_32x32x16_bf16 v[80:95], v[24:27], v[240:243], v[80:95]
  v_accvgpr_write_b32 a184, v56
  v_accvgpr_write_b32 a185, v57
  ds_read_b128 v[24:27], v10 offset:32768
  s_waitcnt lgkmcnt(3)
  v_mfma_f32_32x32x16_bf16 v[64:79], v[28:31], v[180:183], v[64:79]
  v_accvgpr_write_b32 a186, v58
  v_accvgpr_write_b32 a187, v59
  v_mfma_f32_32x32x16_bf16 v[80:95], v[28:31], v[244:247], v[80:95]
  ds_read_b128 v[28:31], v11 offset:32768
  s_waitcnt lgkmcnt(3)
  v_mfma_f32_32x32x16_bf16 v[32:47], v[16:19], v[120:123], 0
  v_mfma_f32_32x32x16_bf16 v[48:63], v[16:19], v[184:187], 0
  ds_read_b128 v[16:19], v12 offset:32768
  s_waitcnt lgkmcnt(3)
  v_mfma_f32_32x32x16_bf16 v[32:47], v[20:23], v[124:127], v[32:47]
  v_mul_f32 v64, s52, v64
  v_mul_f32 v65, s52, v65
  v_cvt_pk_bf16_f32 v64, v64, v65
  v_mfma_f32_32x32x16_bf16 v[48:63], v[20:23], v[188:191], v[48:63]
  v_mul_f32 v66, s52, v66
  v_mul_f32 v67, s52, v67
  ds_read_b128 v[20:23], v13 offset:32768
  s_waitcnt lgkmcnt(3)
  v_mfma_f32_32x32x16_bf16 v[32:47], v[24:27], v[128:131], v[32:47]
  v_cvt_pk_bf16_f32 v65, v66, v67
  v_mul_f32 v68, s52, v68
  v_mul_f32 v69, s52, v69
  v_mfma_f32_32x32x16_bf16 v[48:63], v[24:27], v[192:195], v[48:63]
  v_cvt_pk_bf16_f32 v66, v68, v69
  v_mul_f32 v70, s52, v70
  ds_read_b128 v[24:27], v14 offset:32768
  s_waitcnt lgkmcnt(3)
  v_mfma_f32_32x32x16_bf16 v[32:47], v[28:31], v[132:135], v[32:47]
  v_mul_f32 v71, s52, v71
  v_cvt_pk_bf16_f32 v67, v70, v71
  v_mul_f32 v72, s52, v72
  v_mfma_f32_32x32x16_bf16 v[48:63], v[28:31], v[196:199], v[48:63]
  v_mul_f32 v73, s52, v73
  v_cvt_pk_bf16_f32 v72, v72, v73
  ds_read_b128 v[28:31], v15 offset:32768
  s_waitcnt lgkmcnt(3)
  v_mfma_f32_32x32x16_bf16 v[32:47], v[16:19], v[136:139], v[32:47]
  v_mul_f32 v74, s52, v74
  v_mul_f32 v75, s52, v75
  v_cvt_pk_bf16_f32 v73, v74, v75
  v_mfma_f32_32x32x16_bf16 v[48:63], v[16:19], v[200:203], v[48:63]
  v_mul_f32 v76, s52, v76
  v_mul_f32 v77, s52, v77
  ds_read_b128 v[16:19], v8 offset:33024
  s_waitcnt lgkmcnt(3)
  v_mfma_f32_32x32x16_bf16 v[32:47], v[20:23], v[140:143], v[32:47]
  v_cvt_pk_bf16_f32 v74, v76, v77
  v_mul_f32 v78, s52, v78
  v_mul_f32 v79, s52, v79
  v_mfma_f32_32x32x16_bf16 v[48:63], v[20:23], v[204:207], v[48:63]
  v_cvt_pk_bf16_f32 v75, v78, v79
  v_permlane16_swap_b32 v64, v72
  ds_read_b128 v[20:23], v9 offset:33024
  s_waitcnt lgkmcnt(3)
  v_mfma_f32_32x32x16_bf16 v[32:47], v[24:27], v[144:147], v[32:47]
  v_permlane16_swap_b32 v65, v73
  v_permlane16_swap_b32 v66, v74
  v_permlane16_swap_b32 v67, v75
  v_mfma_f32_32x32x16_bf16 v[48:63], v[24:27], v[208:211], v[48:63]
  v_accvgpr_write_b32 a20, v64
  v_accvgpr_write_b32 a21, v65
  ds_read_b128 v[24:27], v10 offset:33024
  s_waitcnt lgkmcnt(3)
  v_mfma_f32_32x32x16_bf16 v[32:47], v[28:31], v[148:151], v[32:47]
  v_accvgpr_write_b32 a22, v66
  v_accvgpr_write_b32 a23, v67
  v_accvgpr_write_b32 a76, v72
  v_mfma_f32_32x32x16_bf16 v[48:63], v[28:31], v[212:215], v[48:63]
  v_accvgpr_write_b32 a77, v73
  v_accvgpr_write_b32 a78, v74
  ds_read_b128 v[28:31], v11 offset:33024
  s_waitcnt lgkmcnt(3)
  v_mfma_f32_32x32x16_bf16 v[32:47], v[16:19], v[152:155], v[32:47]
  v_accvgpr_write_b32 a79, v75
  v_mul_f32 v80, s52, v80
  v_mul_f32 v81, s52, v81
  v_mfma_f32_32x32x16_bf16 v[48:63], v[16:19], v[216:219], v[48:63]
  v_cvt_pk_bf16_f32 v80, v80, v81
  v_mul_f32 v82, s52, v82
  ds_read_b128 v[16:19], v12 offset:33024
  s_waitcnt lgkmcnt(3)
  v_mfma_f32_32x32x16_bf16 v[32:47], v[20:23], v[156:159], v[32:47]
  v_mul_f32 v83, s52, v83
  v_cvt_pk_bf16_f32 v81, v82, v83
  v_mul_f32 v84, s52, v84
  v_mfma_f32_32x32x16_bf16 v[48:63], v[20:23], v[220:223], v[48:63]
  v_mul_f32 v85, s52, v85
  v_cvt_pk_bf16_f32 v82, v84, v85
  ds_read_b128 v[20:23], v13 offset:33024
  s_waitcnt lgkmcnt(3)
  v_mfma_f32_32x32x16_bf16 v[32:47], v[24:27], v[160:163], v[32:47]
  v_mul_f32 v86, s52, v86
  v_mul_f32 v87, s52, v87
  v_cvt_pk_bf16_f32 v83, v86, v87
  v_mfma_f32_32x32x16_bf16 v[48:63], v[24:27], v[224:227], v[48:63]
  v_mul_f32 v88, s52, v88
  v_mul_f32 v89, s52, v89
  ds_read_b128 v[24:27], v14 offset:33024
  s_waitcnt lgkmcnt(3)
  v_mfma_f32_32x32x16_bf16 v[32:47], v[28:31], v[164:167], v[32:47]
  v_cvt_pk_bf16_f32 v88, v88, v89
  v_mul_f32 v90, s52, v90
  v_mul_f32 v91, s52, v91
  v_mfma_f32_32x32x16_bf16 v[48:63], v[28:31], v[228:231], v[48:63]
  v_cvt_pk_bf16_f32 v89, v90, v91
  v_mul_f32 v92, s52, v92
  ds_read_b128 v[28:31], v15 offset:33024
  s_waitcnt lgkmcnt(3)
  v_mfma_f32_32x32x16_bf16 v[32:47], v[16:19], v[168:171], v[32:47]
  v_mul_f32 v93, s52, v93
  v_cvt_pk_bf16_f32 v90, v92, v93
  v_mul_f32 v94, s52, v94
  v_mfma_f32_32x32x16_bf16 v[48:63], v[16:19], v[232:235], v[48:63]
  v_mul_f32 v95, s52, v95
  v_cvt_pk_bf16_f32 v91, v94, v95
  ds_read_b128 v[16:19], v8 offset:49152
  s_waitcnt lgkmcnt(3)
  v_mfma_f32_32x32x16_bf16 v[32:47], v[20:23], v[172:175], v[32:47]
  v_permlane16_swap_b32 v80, v88
  v_permlane16_swap_b32 v81, v89
  v_permlane16_swap_b32 v82, v90
  v_mfma_f32_32x32x16_bf16 v[48:63], v[20:23], v[236:239], v[48:63]
  v_permlane16_swap_b32 v83, v91
  v_accvgpr_write_b32 a132, v80
  ds_read_b128 v[20:23], v9 offset:49152
  s_waitcnt lgkmcnt(3)
  v_mfma_f32_32x32x16_bf16 v[32:47], v[24:27], v[176:179], v[32:47]
  v_accvgpr_write_b32 a133, v81
  v_accvgpr_write_b32 a134, v82
  v_accvgpr_write_b32 a135, v83
  v_mfma_f32_32x32x16_bf16 v[48:63], v[24:27], v[240:243], v[48:63]
  v_accvgpr_write_b32 a188, v88
  v_accvgpr_write_b32 a189, v89
  ds_read_b128 v[24:27], v10 offset:49152
  s_waitcnt lgkmcnt(3)
  v_mfma_f32_32x32x16_bf16 v[32:47], v[28:31], v[180:183], v[32:47]
  v_accvgpr_write_b32 a190, v90
  v_accvgpr_write_b32 a191, v91
  v_mfma_f32_32x32x16_bf16 v[48:63], v[28:31], v[244:247], v[48:63]
  s_waitcnt vmcnt(16)
  s_barrier
  ds_read_b128 v[28:31], v11 offset:49152
  s_waitcnt lgkmcnt(3)
  v_mfma_f32_32x32x16_bf16 v[64:79], v[16:19], v[120:123], 0
  v_mfma_f32_32x32x16_bf16 v[80:95], v[16:19], v[184:187], 0
  ds_read_b128 v[16:19], v12 offset:49152
  s_waitcnt lgkmcnt(3)
  v_mfma_f32_32x32x16_bf16 v[64:79], v[20:23], v[124:127], v[64:79]
  v_mul_f32 v32, s52, v32
  v_mul_f32 v33, s52, v33
  v_cvt_pk_bf16_f32 v32, v32, v33
  v_mfma_f32_32x32x16_bf16 v[80:95], v[20:23], v[188:191], v[80:95]
  v_mul_f32 v34, s52, v34
  v_mul_f32 v35, s52, v35
  ds_read_b128 v[20:23], v13 offset:49152
  s_waitcnt lgkmcnt(3)
  v_mfma_f32_32x32x16_bf16 v[64:79], v[24:27], v[128:131], v[64:79]
  v_cvt_pk_bf16_f32 v33, v34, v35
  v_mul_f32 v36, s52, v36
  v_mul_f32 v37, s52, v37
  v_mfma_f32_32x32x16_bf16 v[80:95], v[24:27], v[192:195], v[80:95]
  v_cvt_pk_bf16_f32 v34, v36, v37
  v_mul_f32 v38, s52, v38
  ds_read_b128 v[24:27], v14 offset:49152
  s_waitcnt lgkmcnt(3)
  v_mfma_f32_32x32x16_bf16 v[64:79], v[28:31], v[132:135], v[64:79]
  v_mul_f32 v39, s52, v39
  v_cvt_pk_bf16_f32 v35, v38, v39
  v_mul_f32 v40, s52, v40
  v_mfma_f32_32x32x16_bf16 v[80:95], v[28:31], v[196:199], v[80:95]
  v_mul_f32 v41, s52, v41
  v_cvt_pk_bf16_f32 v40, v40, v41
  ds_read_b128 v[28:31], v15 offset:49152
  s_waitcnt lgkmcnt(3)
  v_mfma_f32_32x32x16_bf16 v[64:79], v[16:19], v[136:139], v[64:79]
  v_mul_f32 v42, s52, v42
  v_mul_f32 v43, s52, v43
  v_cvt_pk_bf16_f32 v41, v42, v43
  v_mfma_f32_32x32x16_bf16 v[80:95], v[16:19], v[200:203], v[80:95]
  v_mul_f32 v44, s52, v44
  v_mul_f32 v45, s52, v45
  ds_read_b128 v[16:19], v8 offset:49408
  s_waitcnt lgkmcnt(3)
  v_mfma_f32_32x32x16_bf16 v[64:79], v[20:23], v[140:143], v[64:79]
  v_cvt_pk_bf16_f32 v42, v44, v45
  v_mul_f32 v46, s52, v46
  v_mul_f32 v47, s52, v47
  v_mfma_f32_32x32x16_bf16 v[80:95], v[20:23], v[204:207], v[80:95]
  v_cvt_pk_bf16_f32 v43, v46, v47
  v_permlane16_swap_b32 v32, v40
  ds_read_b128 v[20:23], v9 offset:49408
  s_waitcnt lgkmcnt(3)
  v_mfma_f32_32x32x16_bf16 v[64:79], v[24:27], v[144:147], v[64:79]
  v_permlane16_swap_b32 v33, v41
  v_permlane16_swap_b32 v34, v42
  v_permlane16_swap_b32 v35, v43
  v_mfma_f32_32x32x16_bf16 v[80:95], v[24:27], v[208:211], v[80:95]
  v_accvgpr_write_b32 a24, v32
  v_accvgpr_write_b32 a25, v33
  ds_read_b128 v[24:27], v10 offset:49408
  s_waitcnt lgkmcnt(3)
  v_mfma_f32_32x32x16_bf16 v[64:79], v[28:31], v[148:151], v[64:79]
  v_accvgpr_write_b32 a26, v34
  v_accvgpr_write_b32 a27, v35
  v_accvgpr_write_b32 a80, v40
  v_mfma_f32_32x32x16_bf16 v[80:95], v[28:31], v[212:215], v[80:95]
  v_accvgpr_write_b32 a81, v41
  v_accvgpr_write_b32 a82, v42
  ds_read_b128 v[28:31], v11 offset:49408
  s_waitcnt lgkmcnt(3)
  v_mfma_f32_32x32x16_bf16 v[64:79], v[16:19], v[152:155], v[64:79]
  v_accvgpr_write_b32 a83, v43
  v_mul_f32 v48, s52, v48
  v_mul_f32 v49, s52, v49
  v_mfma_f32_32x32x16_bf16 v[80:95], v[16:19], v[216:219], v[80:95]
  v_cvt_pk_bf16_f32 v48, v48, v49
  v_mul_f32 v50, s52, v50
  ds_read_b128 v[16:19], v12 offset:49408
  s_waitcnt lgkmcnt(3)
  v_mfma_f32_32x32x16_bf16 v[64:79], v[20:23], v[156:159], v[64:79]
  v_mul_f32 v51, s52, v51
  v_cvt_pk_bf16_f32 v49, v50, v51
  v_mul_f32 v52, s52, v52
  v_mfma_f32_32x32x16_bf16 v[80:95], v[20:23], v[220:223], v[80:95]
  v_mul_f32 v53, s52, v53
  v_cvt_pk_bf16_f32 v50, v52, v53
  ds_read_b128 v[20:23], v13 offset:49408
  s_waitcnt lgkmcnt(3)
  v_mfma_f32_32x32x16_bf16 v[64:79], v[24:27], v[160:163], v[64:79]
  v_mul_f32 v54, s52, v54
  v_mul_f32 v55, s52, v55
  v_cvt_pk_bf16_f32 v51, v54, v55
  v_mfma_f32_32x32x16_bf16 v[80:95], v[24:27], v[224:227], v[80:95]
  v_mul_f32 v56, s52, v56
  v_mul_f32 v57, s52, v57
  ds_read_b128 v[24:27], v14 offset:49408
  s_waitcnt lgkmcnt(3)
  v_mfma_f32_32x32x16_bf16 v[64:79], v[28:31], v[164:167], v[64:79]
  v_cvt_pk_bf16_f32 v56, v56, v57
  v_mul_f32 v58, s52, v58
  v_mul_f32 v59, s52, v59
  v_mfma_f32_32x32x16_bf16 v[80:95], v[28:31], v[228:231], v[80:95]
  v_cvt_pk_bf16_f32 v57, v58, v59
  v_mul_f32 v60, s52, v60
  ds_read_b128 v[28:31], v15 offset:49408
  s_waitcnt lgkmcnt(3)
  v_mfma_f32_32x32x16_bf16 v[64:79], v[16:19], v[168:171], v[64:79]
  v_mul_f32 v61, s52, v61
  v_cvt_pk_bf16_f32 v58, v60, v61
  v_mul_f32 v62, s52, v62
  v_mfma_f32_32x32x16_bf16 v[80:95], v[16:19], v[232:235], v[80:95]
  v_mul_f32 v63, s52, v63
  v_cvt_pk_bf16_f32 v59, v62, v63
  v_xor_b32 v8, 196608, v8
  ds_read_b128 v[16:19], v8 offset:0
  s_waitcnt lgkmcnt(3)
  v_mfma_f32_32x32x16_bf16 v[64:79], v[20:23], v[172:175], v[64:79]
  v_permlane16_swap_b32 v48, v56
  v_permlane16_swap_b32 v49, v57
  v_permlane16_swap_b32 v50, v58
  v_mfma_f32_32x32x16_bf16 v[80:95], v[20:23], v[236:239], v[80:95]
  v_permlane16_swap_b32 v51, v59
  v_accvgpr_write_b32 a136, v48
  v_xor_b32 v9, 196608, v9
  ds_read_b128 v[20:23], v9 offset:0
  s_waitcnt lgkmcnt(3)
  v_mfma_f32_32x32x16_bf16 v[64:79], v[24:27], v[176:179], v[64:79]
  v_accvgpr_write_b32 a137, v49
  v_accvgpr_write_b32 a138, v50
  v_accvgpr_write_b32 a139, v51
  v_mfma_f32_32x32x16_bf16 v[80:95], v[24:27], v[240:243], v[80:95]
  v_accvgpr_write_b32 a192, v56
  v_accvgpr_write_b32 a193, v57
  v_xor_b32 v10, 196608, v10
  ds_read_b128 v[24:27], v10 offset:0
  s_waitcnt lgkmcnt(3)
  v_mfma_f32_32x32x16_bf16 v[64:79], v[28:31], v[180:183], v[64:79]
  v_accvgpr_write_b32 a194, v58
  v_accvgpr_write_b32 a195, v59
  v_mfma_f32_32x32x16_bf16 v[80:95], v[28:31], v[244:247], v[80:95]
  v_xor_b32 v11, 196608, v11
  ds_read_b128 v[28:31], v11 offset:0
  s_waitcnt lgkmcnt(3)
  v_mfma_f32_32x32x16_bf16 v[32:47], v[16:19], v[120:123], 0
  v_mfma_f32_32x32x16_bf16 v[48:63], v[16:19], v[184:187], 0
  v_xor_b32 v12, 196608, v12
  ds_read_b128 v[16:19], v12 offset:0
  s_waitcnt lgkmcnt(3)
  v_mfma_f32_32x32x16_bf16 v[32:47], v[20:23], v[124:127], v[32:47]
  v_mul_f32 v64, s52, v64
  v_mul_f32 v65, s52, v65
  v_cvt_pk_bf16_f32 v64, v64, v65
  v_mfma_f32_32x32x16_bf16 v[48:63], v[20:23], v[188:191], v[48:63]
  v_mul_f32 v66, s52, v66
  v_mul_f32 v67, s52, v67
  v_xor_b32 v13, 196608, v13
  ds_read_b128 v[20:23], v13 offset:0
  s_waitcnt lgkmcnt(3)
  v_mfma_f32_32x32x16_bf16 v[32:47], v[24:27], v[128:131], v[32:47]
  v_cvt_pk_bf16_f32 v65, v66, v67
  v_mul_f32 v68, s52, v68
  v_mul_f32 v69, s52, v69
  v_mfma_f32_32x32x16_bf16 v[48:63], v[24:27], v[192:195], v[48:63]
  v_cvt_pk_bf16_f32 v66, v68, v69
  v_mul_f32 v70, s52, v70
  v_xor_b32 v14, 196608, v14
  ds_read_b128 v[24:27], v14 offset:0
  s_waitcnt lgkmcnt(3)
  v_mfma_f32_32x32x16_bf16 v[32:47], v[28:31], v[132:135], v[32:47]
  v_mul_f32 v71, s52, v71
  v_cvt_pk_bf16_f32 v67, v70, v71
  v_mul_f32 v72, s52, v72
  v_mfma_f32_32x32x16_bf16 v[48:63], v[28:31], v[196:199], v[48:63]
  v_mul_f32 v73, s52, v73
  v_cvt_pk_bf16_f32 v72, v72, v73
  v_xor_b32 v15, 196608, v15
  ds_read_b128 v[28:31], v15 offset:0
  s_waitcnt lgkmcnt(3)
  v_mfma_f32_32x32x16_bf16 v[32:47], v[16:19], v[136:139], v[32:47]
  v_mul_f32 v74, s52, v74
  v_mul_f32 v75, s52, v75
  v_cvt_pk_bf16_f32 v73, v74, v75
  v_mfma_f32_32x32x16_bf16 v[48:63], v[16:19], v[200:203], v[48:63]
  v_mul_f32 v76, s52, v76
  v_mul_f32 v77, s52, v77
  ds_read_b128 v[16:19], v8 offset:256
  s_waitcnt lgkmcnt(3)
  v_mfma_f32_32x32x16_bf16 v[32:47], v[20:23], v[140:143], v[32:47]
  v_cvt_pk_bf16_f32 v74, v76, v77
  v_mul_f32 v78, s52, v78
  v_mul_f32 v79, s52, v79
  v_mfma_f32_32x32x16_bf16 v[48:63], v[20:23], v[204:207], v[48:63]
  v_cvt_pk_bf16_f32 v75, v78, v79
  v_permlane16_swap_b32 v64, v72
  ds_read_b128 v[20:23], v9 offset:256
  s_waitcnt lgkmcnt(3)
  v_mfma_f32_32x32x16_bf16 v[32:47], v[24:27], v[144:147], v[32:47]
  v_permlane16_swap_b32 v65, v73
  v_permlane16_swap_b32 v66, v74
  v_permlane16_swap_b32 v67, v75
  v_mfma_f32_32x32x16_bf16 v[48:63], v[24:27], v[208:211], v[48:63]
  v_accvgpr_write_b32 a28, v64
  v_accvgpr_write_b32 a29, v65
  ds_read_b128 v[24:27], v10 offset:256
  s_waitcnt lgkmcnt(3)
  v_mfma_f32_32x32x16_bf16 v[32:47], v[28:31], v[148:151], v[32:47]
  v_accvgpr_write_b32 a30, v66
  v_accvgpr_write_b32 a31, v67
  v_accvgpr_write_b32 a84, v72
  v_mfma_f32_32x32x16_bf16 v[48:63], v[28:31], v[212:215], v[48:63]
  v_accvgpr_write_b32 a85, v73
  v_accvgpr_write_b32 a86, v74
  ds_read_b128 v[28:31], v11 offset:256
  s_waitcnt lgkmcnt(3)
  v_mfma_f32_32x32x16_bf16 v[32:47], v[16:19], v[152:155], v[32:47]
  v_accvgpr_write_b32 a87, v75
  v_mul_f32 v80, s52, v80
  v_mul_f32 v81, s52, v81
  v_mfma_f32_32x32x16_bf16 v[48:63], v[16:19], v[216:219], v[48:63]
  v_cvt_pk_bf16_f32 v80, v80, v81
  v_mul_f32 v82, s52, v82
  ds_read_b128 v[16:19], v12 offset:256
  s_waitcnt lgkmcnt(3)
  v_mfma_f32_32x32x16_bf16 v[32:47], v[20:23], v[156:159], v[32:47]
  v_mul_f32 v83, s52, v83
  v_cvt_pk_bf16_f32 v81, v82, v83
  v_mul_f32 v84, s52, v84
  v_mfma_f32_32x32x16_bf16 v[48:63], v[20:23], v[220:223], v[48:63]
  v_mul_f32 v85, s52, v85
  v_cvt_pk_bf16_f32 v82, v84, v85
  ds_read_b128 v[20:23], v13 offset:256
  s_waitcnt lgkmcnt(3)
  v_mfma_f32_32x32x16_bf16 v[32:47], v[24:27], v[160:163], v[32:47]
  v_mul_f32 v86, s52, v86
  v_mul_f32 v87, s52, v87
  v_cvt_pk_bf16_f32 v83, v86, v87
  v_mfma_f32_32x32x16_bf16 v[48:63], v[24:27], v[224:227], v[48:63]
  v_mul_f32 v88, s52, v88
  v_mul_f32 v89, s52, v89
  ds_read_b128 v[24:27], v14 offset:256
  s_waitcnt lgkmcnt(3)
  v_mfma_f32_32x32x16_bf16 v[32:47], v[28:31], v[164:167], v[32:47]
  v_cvt_pk_bf16_f32 v88, v88, v89
  v_mul_f32 v90, s52, v90
  v_mul_f32 v91, s52, v91
  v_mfma_f32_32x32x16_bf16 v[48:63], v[28:31], v[228:231], v[48:63]
  v_cvt_pk_bf16_f32 v89, v90, v91
  v_mul_f32 v92, s52, v92
  ds_read_b128 v[28:31], v15 offset:256
  s_waitcnt lgkmcnt(3)
  v_mfma_f32_32x32x16_bf16 v[32:47], v[16:19], v[168:171], v[32:47]
  v_mul_f32 v93, s52, v93
  v_cvt_pk_bf16_f32 v90, v92, v93
  v_mul_f32 v94, s52, v94
  v_mfma_f32_32x32x16_bf16 v[48:63], v[16:19], v[232:235], v[48:63]
  v_mul_f32 v95, s52, v95
  v_cvt_pk_bf16_f32 v91, v94, v95
  v_xor_b32 v8, 131072, v8
  ds_read_b128 v[16:19], v8 offset:0
  s_waitcnt lgkmcnt(3)
  v_mfma_f32_32x32x16_bf16 v[32:47], v[20:23], v[172:175], v[32:47]
  v_permlane16_swap_b32 v80, v88
  v_permlane16_swap_b32 v81, v89
  v_permlane16_swap_b32 v82, v90
  v_mfma_f32_32x32x16_bf16 v[48:63], v[20:23], v[236:239], v[48:63]
  v_permlane16_swap_b32 v83, v91
  v_accvgpr_write_b32 a140, v80
  v_xor_b32 v9, 131072, v9
  ds_read_b128 v[20:23], v9 offset:0
  s_waitcnt lgkmcnt(3)
  v_mfma_f32_32x32x16_bf16 v[32:47], v[24:27], v[176:179], v[32:47]
  v_accvgpr_write_b32 a141, v81
  v_accvgpr_write_b32 a142, v82
  v_accvgpr_write_b32 a143, v83
  v_mfma_f32_32x32x16_bf16 v[48:63], v[24:27], v[240:243], v[48:63]
  v_accvgpr_write_b32 a196, v88
  v_accvgpr_write_b32 a197, v89
  v_xor_b32 v10, 131072, v10
  ds_read_b128 v[24:27], v10 offset:0
  s_waitcnt lgkmcnt(3)
  v_mfma_f32_32x32x16_bf16 v[32:47], v[28:31], v[180:183], v[32:47]
  v_accvgpr_write_b32 a198, v90
  v_accvgpr_write_b32 a199, v91
  v_mfma_f32_32x32x16_bf16 v[48:63], v[28:31], v[244:247], v[48:63]
  s_waitcnt vmcnt(8)
  s_barrier
  v_xor_b32 v11, 131072, v11
  ds_read_b128 v[28:31], v11 offset:0
  s_waitcnt lgkmcnt(3)
  v_mfma_f32_32x32x16_bf16 v[64:79], v[16:19], v[120:123], 0
  v_mfma_f32_32x32x16_bf16 v[80:95], v[16:19], v[184:187], 0
  v_xor_b32 v12, 131072, v12
  ds_read_b128 v[16:19], v12 offset:0
  s_waitcnt lgkmcnt(3)
  v_mfma_f32_32x32x16_bf16 v[64:79], v[20:23], v[124:127], v[64:79]
  v_mul_f32 v32, s52, v32
  v_mul_f32 v33, s52, v33
  v_cvt_pk_bf16_f32 v32, v32, v33
  v_mfma_f32_32x32x16_bf16 v[80:95], v[20:23], v[188:191], v[80:95]
  v_mul_f32 v34, s52, v34
  v_mul_f32 v35, s52, v35
  v_xor_b32 v13, 131072, v13
  ds_read_b128 v[20:23], v13 offset:0
  s_waitcnt lgkmcnt(3)
  v_mfma_f32_32x32x16_bf16 v[64:79], v[24:27], v[128:131], v[64:79]
  v_cvt_pk_bf16_f32 v33, v34, v35
  v_mul_f32 v36, s52, v36
  v_mul_f32 v37, s52, v37
  v_mfma_f32_32x32x16_bf16 v[80:95], v[24:27], v[192:195], v[80:95]
  v_cvt_pk_bf16_f32 v34, v36, v37
  v_mul_f32 v38, s52, v38
  v_xor_b32 v14, 131072, v14
  ds_read_b128 v[24:27], v14 offset:0
  s_waitcnt lgkmcnt(3)
  v_mfma_f32_32x32x16_bf16 v[64:79], v[28:31], v[132:135], v[64:79]
  v_mul_f32 v39, s52, v39
  v_cvt_pk_bf16_f32 v35, v38, v39
  v_mul_f32 v40, s52, v40
  v_mfma_f32_32x32x16_bf16 v[80:95], v[28:31], v[196:199], v[80:95]
  v_mul_f32 v41, s52, v41
  v_cvt_pk_bf16_f32 v40, v40, v41
  v_xor_b32 v15, 131072, v15
  ds_read_b128 v[28:31], v15 offset:0
  s_waitcnt lgkmcnt(3)
  v_mfma_f32_32x32x16_bf16 v[64:79], v[16:19], v[136:139], v[64:79]
  v_mul_f32 v42, s52, v42
  v_mul_f32 v43, s52, v43
  v_cvt_pk_bf16_f32 v41, v42, v43
  v_mfma_f32_32x32x16_bf16 v[80:95], v[16:19], v[200:203], v[80:95]
  v_mul_f32 v44, s52, v44
  v_mul_f32 v45, s52, v45
  ds_read_b128 v[16:19], v8 offset:256
  s_waitcnt lgkmcnt(3)
  v_mfma_f32_32x32x16_bf16 v[64:79], v[20:23], v[140:143], v[64:79]
  v_cvt_pk_bf16_f32 v42, v44, v45
  v_mul_f32 v46, s52, v46
  v_mul_f32 v47, s52, v47
  v_mfma_f32_32x32x16_bf16 v[80:95], v[20:23], v[204:207], v[80:95]
  v_cvt_pk_bf16_f32 v43, v46, v47
  v_permlane16_swap_b32 v32, v40
  ds_read_b128 v[20:23], v9 offset:256
  s_waitcnt lgkmcnt(3)
  v_mfma_f32_32x32x16_bf16 v[64:79], v[24:27], v[144:147], v[64:79]
  v_permlane16_swap_b32 v33, v41
  v_permlane16_swap_b32 v34, v42
  v_permlane16_swap_b32 v35, v43
  v_mfma_f32_32x32x16_bf16 v[80:95], v[24:27], v[208:211], v[80:95]
  v_accvgpr_write_b32 a32, v32
  v_accvgpr_write_b32 a33, v33
  ds_read_b128 v[24:27], v10 offset:256
  s_waitcnt lgkmcnt(3)
  v_mfma_f32_32x32x16_bf16 v[64:79], v[28:31], v[148:151], v[64:79]
  v_accvgpr_write_b32 a34, v34
  v_accvgpr_write_b32 a35, v35
  v_accvgpr_write_b32 a88, v40
  v_mfma_f32_32x32x16_bf16 v[80:95], v[28:31], v[212:215], v[80:95]
  v_accvgpr_write_b32 a89, v41
  v_accvgpr_write_b32 a90, v42
  ds_read_b128 v[28:31], v11 offset:256
  s_waitcnt lgkmcnt(3)
  v_mfma_f32_32x32x16_bf16 v[64:79], v[16:19], v[152:155], v[64:79]
  v_accvgpr_write_b32 a91, v43
  v_mul_f32 v48, s52, v48
  v_mul_f32 v49, s52, v49
  v_mfma_f32_32x32x16_bf16 v[80:95], v[16:19], v[216:219], v[80:95]
  v_cvt_pk_bf16_f32 v48, v48, v49
  v_mul_f32 v50, s52, v50
  ds_read_b128 v[16:19], v12 offset:256
  s_waitcnt lgkmcnt(3)
  v_mfma_f32_32x32x16_bf16 v[64:79], v[20:23], v[156:159], v[64:79]
  v_mul_f32 v51, s52, v51
  v_cvt_pk_bf16_f32 v49, v50, v51
  v_mul_f32 v52, s52, v52
  v_mfma_f32_32x32x16_bf16 v[80:95], v[20:23], v[220:223], v[80:95]
  v_mul_f32 v53, s52, v53
  v_cvt_pk_bf16_f32 v50, v52, v53
  ds_read_b128 v[20:23], v13 offset:256
  s_waitcnt lgkmcnt(3)
  v_mfma_f32_32x32x16_bf16 v[64:79], v[24:27], v[160:163], v[64:79]
  v_mul_f32 v54, s52, v54
  v_mul_f32 v55, s52, v55
  v_cvt_pk_bf16_f32 v51, v54, v55
  v_mfma_f32_32x32x16_bf16 v[80:95], v[24:27], v[224:227], v[80:95]
  v_mul_f32 v56, s52, v56
  v_mul_f32 v57, s52, v57
  ds_read_b128 v[24:27], v14 offset:256
  s_waitcnt lgkmcnt(3)
  v_mfma_f32_32x32x16_bf16 v[64:79], v[28:31], v[164:167], v[64:79]
  v_cvt_pk_bf16_f32 v56, v56, v57
  v_mul_f32 v58, s52, v58
  v_mul_f32 v59, s52, v59
  v_mfma_f32_32x32x16_bf16 v[80:95], v[28:31], v[228:231], v[80:95]
  v_cvt_pk_bf16_f32 v57, v58, v59
  v_mul_f32 v60, s52, v60
  ds_read_b128 v[28:31], v15 offset:256
  s_waitcnt lgkmcnt(3)
  v_mfma_f32_32x32x16_bf16 v[64:79], v[16:19], v[168:171], v[64:79]
  v_mul_f32 v61, s52, v61
  v_cvt_pk_bf16_f32 v58, v60, v61
  v_mul_f32 v62, s52, v62
  v_mfma_f32_32x32x16_bf16 v[80:95], v[16:19], v[232:235], v[80:95]
  v_mul_f32 v63, s52, v63
  v_cvt_pk_bf16_f32 v59, v62, v63
  ds_read_b128 v[16:19], v8 offset:16384
  s_waitcnt lgkmcnt(3)
  v_mfma_f32_32x32x16_bf16 v[64:79], v[20:23], v[172:175], v[64:79]
  v_permlane16_swap_b32 v48, v56
  v_permlane16_swap_b32 v49, v57
  v_permlane16_swap_b32 v50, v58
  v_mfma_f32_32x32x16_bf16 v[80:95], v[20:23], v[236:239], v[80:95]
  v_permlane16_swap_b32 v51, v59
  v_accvgpr_write_b32 a144, v48
  ds_read_b128 v[20:23], v9 offset:16384
  s_waitcnt lgkmcnt(3)
  v_mfma_f32_32x32x16_bf16 v[64:79], v[24:27], v[176:179], v[64:79]
  v_accvgpr_write_b32 a145, v49
  v_accvgpr_write_b32 a146, v50
  v_accvgpr_write_b32 a147, v51
  v_mfma_f32_32x32x16_bf16 v[80:95], v[24:27], v[240:243], v[80:95]
  v_accvgpr_write_b32 a200, v56
  v_accvgpr_write_b32 a201, v57
  ds_read_b128 v[24:27], v10 offset:16384
  s_waitcnt lgkmcnt(3)
  v_mfma_f32_32x32x16_bf16 v[64:79], v[28:31], v[180:183], v[64:79]
  v_accvgpr_write_b32 a202, v58
  v_accvgpr_write_b32 a203, v59
  v_mfma_f32_32x32x16_bf16 v[80:95], v[28:31], v[244:247], v[80:95]
  ds_read_b128 v[28:31], v11 offset:16384
  s_waitcnt lgkmcnt(3)
  v_mfma_f32_32x32x16_bf16 v[32:47], v[16:19], v[120:123], 0
  v_mfma_f32_32x32x16_bf16 v[48:63], v[16:19], v[184:187], 0
  ds_read_b128 v[16:19], v12 offset:16384
  s_waitcnt lgkmcnt(3)
  v_mfma_f32_32x32x16_bf16 v[32:47], v[20:23], v[124:127], v[32:47]
  v_mul_f32 v64, s52, v64
  v_mul_f32 v65, s52, v65
  v_cvt_pk_bf16_f32 v64, v64, v65
  v_mfma_f32_32x32x16_bf16 v[48:63], v[20:23], v[188:191], v[48:63]
  v_mul_f32 v66, s52, v66
  v_mul_f32 v67, s52, v67
  ds_read_b128 v[20:23], v13 offset:16384
  s_waitcnt lgkmcnt(3)
  v_mfma_f32_32x32x16_bf16 v[32:47], v[24:27], v[128:131], v[32:47]
  v_cvt_pk_bf16_f32 v65, v66, v67
  v_mul_f32 v68, s52, v68
  v_mul_f32 v69, s52, v69
  v_mfma_f32_32x32x16_bf16 v[48:63], v[24:27], v[192:195], v[48:63]
  v_cvt_pk_bf16_f32 v66, v68, v69
  v_mul_f32 v70, s52, v70
  ds_read_b128 v[24:27], v14 offset:16384
  s_waitcnt lgkmcnt(3)
  v_mfma_f32_32x32x16_bf16 v[32:47], v[28:31], v[132:135], v[32:47]
  v_mul_f32 v71, s52, v71
  v_cvt_pk_bf16_f32 v67, v70, v71
  v_mul_f32 v72, s52, v72
  v_mfma_f32_32x32x16_bf16 v[48:63], v[28:31], v[196:199], v[48:63]
  v_mul_f32 v73, s52, v73
  v_cvt_pk_bf16_f32 v72, v72, v73
  ds_read_b128 v[28:31], v15 offset:16384
  s_waitcnt lgkmcnt(3)
  v_mfma_f32_32x32x16_bf16 v[32:47], v[16:19], v[136:139], v[32:47]
  buffer_load_dwordx4 v[100:103], v113, s[8:11], s28 offen sc1
  v_mul_f32 v74, s52, v74
  v_mul_f32 v75, s52, v75
  v_cvt_pk_bf16_f32 v73, v74, v75
  v_mfma_f32_32x32x16_bf16 v[48:63], v[16:19], v[200:203], v[48:63]
  v_mul_f32 v76, s52, v76
  v_mul_f32 v77, s52, v77
  ds_read_b128 v[16:19], v8 offset:16640
  s_waitcnt lgkmcnt(3)
  v_mfma_f32_32x32x16_bf16 v[32:47], v[20:23], v[140:143], v[32:47]
  v_cvt_pk_bf16_f32 v74, v76, v77
  v_mul_f32 v78, s52, v78
  v_mul_f32 v79, s52, v79
  v_mfma_f32_32x32x16_bf16 v[48:63], v[20:23], v[204:207], v[48:63]
  v_cvt_pk_bf16_f32 v75, v78, v79
  v_permlane16_swap_b32 v64, v72
  ds_read_b128 v[20:23], v9 offset:16640
  s_waitcnt lgkmcnt(3)
  v_mfma_f32_32x32x16_bf16 v[32:47], v[24:27], v[144:147], v[32:47]
  v_permlane16_swap_b32 v65, v73
  v_permlane16_swap_b32 v66, v74
  v_permlane16_swap_b32 v67, v75
  v_mfma_f32_32x32x16_bf16 v[48:63], v[24:27], v[208:211], v[48:63]
  v_accvgpr_write_b32 a36, v64
  v_accvgpr_write_b32 a37, v65
  ds_read_b128 v[24:27], v10 offset:16640
  s_waitcnt lgkmcnt(3)
  v_mfma_f32_32x32x16_bf16 v[32:47], v[28:31], v[148:151], v[32:47]
  v_accvgpr_write_b32 a38, v66
  v_accvgpr_write_b32 a39, v67
  v_accvgpr_write_b32 a92, v72
  v_mfma_f32_32x32x16_bf16 v[48:63], v[28:31], v[212:215], v[48:63]
  v_accvgpr_write_b32 a93, v73
  v_accvgpr_write_b32 a94, v74
  ds_read_b128 v[28:31], v11 offset:16640
  s_waitcnt lgkmcnt(3)
  v_mfma_f32_32x32x16_bf16 v[32:47], v[16:19], v[152:155], v[32:47]
  v_accvgpr_write_b32 a95, v75
  v_mul_f32 v80, s52, v80
  v_mul_f32 v81, s52, v81
  v_mfma_f32_32x32x16_bf16 v[48:63], v[16:19], v[216:219], v[48:63]
  v_cvt_pk_bf16_f32 v80, v80, v81
  v_mul_f32 v82, s52, v82
  ds_read_b128 v[16:19], v12 offset:16640
  s_waitcnt lgkmcnt(3)
  v_mfma_f32_32x32x16_bf16 v[32:47], v[20:23], v[156:159], v[32:47]
  v_mul_f32 v83, s52, v83
  v_cvt_pk_bf16_f32 v81, v82, v83
  v_mul_f32 v84, s52, v84
  v_mfma_f32_32x32x16_bf16 v[48:63], v[20:23], v[220:223], v[48:63]
  v_mul_f32 v85, s52, v85
  v_cvt_pk_bf16_f32 v82, v84, v85
  ds_read_b128 v[20:23], v13 offset:16640
  s_waitcnt lgkmcnt(3)
  v_mfma_f32_32x32x16_bf16 v[32:47], v[24:27], v[160:163], v[32:47]
  v_mul_f32 v86, s52, v86
  v_mul_f32 v87, s52, v87
  v_cvt_pk_bf16_f32 v83, v86, v87
  v_mfma_f32_32x32x16_bf16 v[48:63], v[24:27], v[224:227], v[48:63]
  v_mul_f32 v88, s52, v88
  v_mul_f32 v89, s52, v89
  ds_read_b128 v[24:27], v14 offset:16640
  s_waitcnt lgkmcnt(3)
  v_mfma_f32_32x32x16_bf16 v[32:47], v[28:31], v[164:167], v[32:47]
  v_cvt_pk_bf16_f32 v88, v88, v89
  v_mul_f32 v90, s52, v90
  v_mul_f32 v91, s52, v91
  v_mfma_f32_32x32x16_bf16 v[48:63], v[28:31], v[228:231], v[48:63]
  v_cvt_pk_bf16_f32 v89, v90, v91
  v_mul_f32 v92, s52, v92
  ds_read_b128 v[28:31], v15 offset:16640
  s_waitcnt lgkmcnt(3)
  v_mfma_f32_32x32x16_bf16 v[32:47], v[16:19], v[168:171], v[32:47]
  v_mul_f32 v93, s52, v93
  v_cvt_pk_bf16_f32 v90, v92, v93
  v_mul_f32 v94, s52, v94
  v_mfma_f32_32x32x16_bf16 v[48:63], v[16:19], v[232:235], v[48:63]
  v_mul_f32 v95, s52, v95
  v_cvt_pk_bf16_f32 v91, v94, v95
  ds_read_b128 v[16:19], v8 offset:32768
  s_waitcnt lgkmcnt(3)
  v_mfma_f32_32x32x16_bf16 v[32:47], v[20:23], v[172:175], v[32:47]
  v_permlane16_swap_b32 v80, v88
  v_permlane16_swap_b32 v81, v89
  v_permlane16_swap_b32 v82, v90
  v_mfma_f32_32x32x16_bf16 v[48:63], v[20:23], v[236:239], v[48:63]
  v_permlane16_swap_b32 v83, v91
  v_accvgpr_write_b32 a148, v80
  ds_read_b128 v[20:23], v9 offset:32768
  s_waitcnt lgkmcnt(3)
  v_mfma_f32_32x32x16_bf16 v[32:47], v[24:27], v[176:179], v[32:47]
  v_accvgpr_write_b32 a149, v81
  v_accvgpr_write_b32 a150, v82
  v_accvgpr_write_b32 a151, v83
  v_mfma_f32_32x32x16_bf16 v[48:63], v[24:27], v[240:243], v[48:63]
  v_accvgpr_write_b32 a204, v88
  v_accvgpr_write_b32 a205, v89
  ds_read_b128 v[24:27], v10 offset:32768
  s_waitcnt lgkmcnt(3)
  v_mfma_f32_32x32x16_bf16 v[32:47], v[28:31], v[180:183], v[32:47]
  v_accvgpr_write_b32 a206, v90
  v_accvgpr_write_b32 a207, v91
  v_mfma_f32_32x32x16_bf16 v[48:63], v[28:31], v[244:247], v[48:63]
  s_waitcnt vmcnt(1)
  s_barrier
  ds_read_b128 v[28:31], v11 offset:32768
  s_waitcnt lgkmcnt(3)
  v_mfma_f32_32x32x16_bf16 v[64:79], v[16:19], v[120:123], 0
  s_waitcnt vmcnt(0)
  v_cmp_ne_u64 vcc, s[88:89], v[100:101]
  v_cmp_ne_u64 s[54:55], s[88:89], v[102:103]
  s_add_u32 s48, s33, 14336
  v_mfma_f32_32x32x16_bf16 v[80:95], v[16:19], v[184:187], 0
  ds_read_b128 v[16:19], v12 offset:32768
  s_waitcnt lgkmcnt(3)
  v_mfma_f32_32x32x16_bf16 v[64:79], v[20:23], v[124:127], v[64:79]
  s_or_b64 vcc, vcc, s[54:55]
  s_cselect_b32 s48, 0x10000000, s48
  s_add_u32 s22, s48, 0
  s_add_u32 m0, s25, 0
  s_nop 0
  buffer_load_dwordx4 v2, s[8:11], s22 offen sc1 lds
  v_mul_f32 v32, s52, v32
  v_mul_f32 v33, s52, v33
  v_cvt_pk_bf16_f32 v32, v32, v33
  v_mfma_f32_32x32x16_bf16 v[80:95], v[20:23], v[188:191], v[80:95]
  v_mul_f32 v34, s52, v34
  v_mul_f32 v35, s52, v35
  ds_read_b128 v[20:23], v13 offset:32768
  s_waitcnt lgkmcnt(3)
  v_mfma_f32_32x32x16_bf16 v[64:79], v[24:27], v[128:131], v[64:79]
  s_add_u32 s22, s48, 1024
  s_add_u32 m0, s25, 1024
  s_nop 0
  buffer_load_dwordx4 v2, s[8:11], s22 offen sc1 lds
  v_cvt_pk_bf16_f32 v33, v34, v35
  v_mul_f32 v36, s52, v36
  v_mul_f32 v37, s52, v37
  v_mfma_f32_32x32x16_bf16 v[80:95], v[24:27], v[192:195], v[80:95]
  v_cvt_pk_bf16_f32 v34, v36, v37
  v_mul_f32 v38, s52, v38
  ds_read_b128 v[24:27], v14 offset:32768
  s_waitcnt lgkmcnt(3)
  v_mfma_f32_32x32x16_bf16 v[64:79], v[28:31], v[132:135], v[64:79]
  s_add_u32 s22, s48, 2048
  s_add_u32 m0, s25, 2048
  s_nop 0
  buffer_load_dwordx4 v2, s[8:11], s22 offen sc1 lds
  v_mul_f32 v39, s52, v39
  v_cvt_pk_bf16_f32 v35, v38, v39
  v_mul_f32 v40, s52, v40
  v_mfma_f32_32x32x16_bf16 v[80:95], v[28:31], v[196:199], v[80:95]
  v_mul_f32 v41, s52, v41
  v_cvt_pk_bf16_f32 v40, v40, v41
  ds_read_b128 v[28:31], v15 offset:32768
  s_waitcnt lgkmcnt(3)
  v_mfma_f32_32x32x16_bf16 v[64:79], v[16:19], v[136:139], v[64:79]
  s_add_u32 s22, s48, 3072
  s_add_u32 m0, s25, 3072
  s_nop 0
  buffer_load_dwordx4 v2, s[8:11], s22 offen sc1 lds
  v_mul_f32 v42, s52, v42
  v_mul_f32 v43, s52, v43
  v_cvt_pk_bf16_f32 v41, v42, v43
  v_mfma_f32_32x32x16_bf16 v[80:95], v[16:19], v[200:203], v[80:95]
  v_mul_f32 v44, s52, v44
  v_mul_f32 v45, s52, v45
  ds_read_b128 v[16:19], v8 offset:33024
  s_waitcnt lgkmcnt(3)
  v_mfma_f32_32x32x16_bf16 v[64:79], v[20:23], v[140:143], v[64:79]
  s_add_u32 s22, s48, 4096
  s_add_u32 m0, s25, 16384
  s_nop 0
  buffer_load_dwordx4 v2, s[8:11], s22 offen sc1 lds
  buffer_load_dwordx4 v[100:103], v113, s[8:11], s28 offen sc1
  v_cvt_pk_bf16_f32 v42, v44, v45
  v_mul_f32 v46, s52, v46
  v_mul_f32 v47, s52, v47
  v_mfma_f32_32x32x16_bf16 v[80:95], v[20:23], v[204:207], v[80:95]
  v_cvt_pk_bf16_f32 v43, v46, v47
  v_permlane16_swap_b32 v32, v40
  ds_read_b128 v[20:23], v9 offset:33024
  s_waitcnt lgkmcnt(3)
  v_mfma_f32_32x32x16_bf16 v[64:79], v[24:27], v[144:147], v[64:79]
  s_add_u32 s22, s48, 5120
  s_add_u32 m0, s25, 17408
  s_nop 0
  buffer_load_dwordx4 v2, s[8:11], s22 offen sc1 lds
  v_permlane16_swap_b32 v33, v41
  v_permlane16_swap_b32 v34, v42
  v_permlane16_swap_b32 v35, v43
  v_mfma_f32_32x32x16_bf16 v[80:95], v[24:27], v[208:211], v[80:95]
  v_accvgpr_write_b32 a40, v32
  v_accvgpr_write_b32 a41, v33
  ds_read_b128 v[24:27], v10 offset:33024
  s_waitcnt lgkmcnt(3)
  v_mfma_f32_32x32x16_bf16 v[64:79], v[28:31], v[148:151], v[64:79]
  s_add_u32 s22, s48, 6144
  s_add_u32 m0, s25, 18432
  s_nop 0
  buffer_load_dwordx4 v2, s[8:11], s22 offen sc1 lds
  v_accvgpr_write_b32 a42, v34
  v_accvgpr_write_b32 a43, v35
  v_accvgpr_write_b32 a96, v40
  v_mfma_f32_32x32x16_bf16 v[80:95], v[28:31], v[212:215], v[80:95]
  v_accvgpr_write_b32 a97, v41
  v_accvgpr_write_b32 a98, v42
  ds_read_b128 v[28:31], v11 offset:33024
  s_waitcnt lgkmcnt(3)
  v_mfma_f32_32x32x16_bf16 v[64:79], v[16:19], v[152:155], v[64:79]
  s_add_u32 s22, s48, 7168
  s_add_u32 m0, s25, 19456
  s_nop 0
  buffer_load_dwordx4 v2, s[8:11], s22 offen sc1 lds
  v_accvgpr_write_b32 a99, v43
  v_mul_f32 v48, s52, v48
  v_mul_f32 v49, s52, v49
  v_mfma_f32_32x32x16_bf16 v[80:95], v[16:19], v[216:219], v[80:95]
  v_cvt_pk_bf16_f32 v48, v48, v49
  v_mul_f32 v50, s52, v50
  ds_read_b128 v[16:19], v12 offset:33024
  s_waitcnt lgkmcnt(3)
  v_mfma_f32_32x32x16_bf16 v[64:79], v[20:23], v[156:159], v[64:79]
  s_add_u32 s22, s48, 8192
  s_add_u32 m0, s25, 81920
  s_nop 0
  buffer_load_dwordx4 v2, s[8:11], s22 offen sc1 lds
  v_mul_f32 v51, s52, v51
  v_cvt_pk_bf16_f32 v49, v50, v51
  v_mul_f32 v52, s52, v52
  v_mfma_f32_32x32x16_bf16 v[80:95], v[20:23], v[220:223], v[80:95]
  v_mul_f32 v53, s52, v53
  v_cvt_pk_bf16_f32 v50, v52, v53
  ds_read_b128 v[20:23], v13 offset:33024
  s_waitcnt lgkmcnt(3)
  v_mfma_f32_32x32x16_bf16 v[64:79], v[24:27], v[160:163], v[64:79]
  s_add_u32 s22, s48, 9216
  s_add_u32 m0, s25, 82944
  s_nop 0
  buffer_load_dwordx4 v2, s[8:11], s22 offen sc1 lds
  v_mul_f32 v54, s52, v54
  v_mul_f32 v55, s52, v55
  v_cvt_pk_bf16_f32 v51, v54, v55
  v_mfma_f32_32x32x16_bf16 v[80:95], v[24:27], v[224:227], v[80:95]
  v_mul_f32 v56, s52, v56
  v_mul_f32 v57, s52, v57
  ds_read_b128 v[24:27], v14 offset:33024
  s_waitcnt lgkmcnt(3)
  v_mfma_f32_32x32x16_bf16 v[64:79], v[28:31], v[164:167], v[64:79]
  s_add_u32 s22, s48, 10240
  s_add_u32 m0, s25, 83968
  s_nop 0
  buffer_load_dwordx4 v2, s[8:11], s22 offen sc1 lds
  v_cvt_pk_bf16_f32 v56, v56, v57
  v_mul_f32 v58, s52, v58
  v_mul_f32 v59, s52, v59
  v_mfma_f32_32x32x16_bf16 v[80:95], v[28:31], v[228:231], v[80:95]
  v_cvt_pk_bf16_f32 v57, v58, v59
  v_mul_f32 v60, s52, v60
  ds_read_b128 v[28:31], v15 offset:33024
  s_waitcnt lgkmcnt(3)
  v_mfma_f32_32x32x16_bf16 v[64:79], v[16:19], v[168:171], v[64:79]
  s_add_u32 s22, s48, 11264
  s_add_u32 m0, s25, 84992
  s_nop 0
  buffer_load_dwordx4 v2, s[8:11], s22 offen sc1 lds
  v_mul_f32 v61, s52, v61
  v_cvt_pk_bf16_f32 v58, v60, v61
  v_mul_f32 v62, s52, v62
  v_mfma_f32_32x32x16_bf16 v[80:95], v[16:19], v[232:235], v[80:95]
  v_mul_f32 v63, s52, v63
  v_cvt_pk_bf16_f32 v59, v62, v63
  ds_read_b128 v[16:19], v8 offset:49152
  s_waitcnt lgkmcnt(3)
  v_mfma_f32_32x32x16_bf16 v[64:79], v[20:23], v[172:175], v[64:79]
  s_add_u32 s22, s48, 12288
  s_add_u32 m0, s25, 98304
  s_nop 0
  buffer_load_dwordx4 v2, s[8:11], s22 offen sc1 lds
  v_permlane16_swap_b32 v48, v56
  v_permlane16_swap_b32 v49, v57
  v_permlane16_swap_b32 v50, v58
  v_mfma_f32_32x32x16_bf16 v[80:95], v[20:23], v[236:239], v[80:95]
  v_permlane16_swap_b32 v51, v59
  v_accvgpr_write_b32 a152, v48
  ds_read_b128 v[20:23], v9 offset:49152
  s_waitcnt lgkmcnt(3)
  v_mfma_f32_32x32x16_bf16 v[64:79], v[24:27], v[176:179], v[64:79]
  s_add_u32 s22, s48, 13312
  s_add_u32 m0, s25, 99328
  s_nop 0
  buffer_load_dwordx4 v2, s[8:11], s22 offen sc1 lds
  v_accvgpr_write_b32 a153, v49
  v_accvgpr_write_b32 a154, v50
  v_accvgpr_write_b32 a155, v51
  v_mfma_f32_32x32x16_bf16 v[80:95], v[24:27], v[240:243], v[80:95]
  v_accvgpr_write_b32 a208, v56
  v_accvgpr_write_b32 a209, v57
  ds_read_b128 v[24:27], v10 offset:49152
  s_waitcnt lgkmcnt(3)
  v_mfma_f32_32x32x16_bf16 v[64:79], v[28:31], v[180:183], v[64:79]
  v_accvgpr_write_b32 a210, v58
  v_accvgpr_write_b32 a211, v59
  v_mfma_f32_32x32x16_bf16 v[80:95], v[28:31], v[244:247], v[80:95]
  ds_read_b128 v[28:31], v11 offset:49152
  s_waitcnt lgkmcnt(3)
  v_mfma_f32_32x32x16_bf16 v[32:47], v[16:19], v[120:123], 0
  s_waitcnt vmcnt(9)
  v_cmp_ne_u64 vcc, s[88:89], v[100:101]
  v_cmp_ne_u64 s[54:55], s[88:89], v[102:103]
  s_add_u32 s49, s32, 0
  v_mfma_f32_32x32x16_bf16 v[48:63], v[16:19], v[184:187], 0
  ds_read_b128 v[16:19], v12 offset:49152
  s_waitcnt lgkmcnt(3)
  v_mfma_f32_32x32x16_bf16 v[32:47], v[20:23], v[124:127], v[32:47]
  s_or_b64 vcc, vcc, s[54:55]
  s_cselect_b32 s49, 0x10000000, s49
  s_add_u32 s22, s49, 0
  s_add_u32 m0, s25, 100352
  s_nop 0
  buffer_load_dwordx4 v2, s[8:11], s22 offen sc1 lds
  v_mul_f32 v64, s52, v64
  v_mul_f32 v65, s52, v65
  v_cvt_pk_bf16_f32 v64, v64, v65
  v_mfma_f32_32x32x16_bf16 v[48:63], v[20:23], v[188:191], v[48:63]
  v_mul_f32 v66, s52, v66
  v_mul_f32 v67, s52, v67
  ds_read_b128 v[20:23], v13 offset:49152
  s_waitcnt lgkmcnt(3)
  v_mfma_f32_32x32x16_bf16 v[32:47], v[24:27], v[128:131], v[32:47]
  s_add_u32 s22, s49, 1024
  s_add_u32 m0, s25, 101376
  s_nop 0
  buffer_load_dwordx4 v2, s[8:11], s22 offen sc1 lds
  v_cvt_pk_bf16_f32 v65, v66, v67
  v_mul_f32 v68, s52, v68
  v_mul_f32 v69, s52, v69
  v_mfma_f32_32x32x16_bf16 v[48:63], v[24:27], v[192:195], v[48:63]
  v_cvt_pk_bf16_f32 v66, v68, v69
  v_mul_f32 v70, s52, v70
  ds_read_b128 v[24:27], v14 offset:49152
  s_waitcnt lgkmcnt(3)
  v_mfma_f32_32x32x16_bf16 v[32:47], v[28:31], v[132:135], v[32:47]
  s_add_u32 s22, s49, 2048
  s_add_u32 m0, s25, 114688
  s_nop 0
  buffer_load_dwordx4 v2, s[8:11], s22 offen sc1 lds
  v_mul_f32 v71, s52, v71
  v_cvt_pk_bf16_f32 v67, v70, v71
  v_mul_f32 v72, s52, v72
  v_mfma_f32_32x32x16_bf16 v[48:63], v[28:31], v[196:199], v[48:63]
  v_mul_f32 v73, s52, v73
  v_cvt_pk_bf16_f32 v72, v72, v73
  ds_read_b128 v[28:31], v15 offset:49152
  s_waitcnt lgkmcnt(3)
  v_mfma_f32_32x32x16_bf16 v[32:47], v[16:19], v[136:139], v[32:47]
  s_add_u32 s22, s49, 3072
  s_add_u32 m0, s25, 115712
  s_nop 0
  buffer_load_dwordx4 v2, s[8:11], s22 offen sc1 lds
  v_mul_f32 v74, s52, v74
  v_mul_f32 v75, s52, v75
  v_cvt_pk_bf16_f32 v73, v74, v75
  v_mfma_f32_32x32x16_bf16 v[48:63], v[16:19], v[200:203], v[48:63]
  v_mul_f32 v76, s52, v76
  v_mul_f32 v77, s52, v77
  ds_read_b128 v[16:19], v8 offset:49408
  s_waitcnt lgkmcnt(3)
  v_mfma_f32_32x32x16_bf16 v[32:47], v[20:23], v[140:143], v[32:47]
  s_add_u32 s22, s49, 4096
  s_add_u32 m0, s25, 116736
  s_nop 0
  buffer_load_dwordx4 v2, s[8:11], s22 offen sc1 lds
  buffer_load_dwordx4 v[100:103], v113, s[8:11], s28 offen sc1
  v_cvt_pk_bf16_f32 v74, v76, v77
  v_mul_f32 v78, s52, v78
  v_mul_f32 v79, s52, v79
  v_mfma_f32_32x32x16_bf16 v[48:63], v[20:23], v[204:207], v[48:63]
  v_cvt_pk_bf16_f32 v75, v78, v79
  v_permlane16_swap_b32 v64, v72
  ds_read_b128 v[20:23], v9 offset:49408
  s_waitcnt lgkmcnt(3)
  v_mfma_f32_32x32x16_bf16 v[32:47], v[24:27], v[144:147], v[32:47]
  s_add_u32 s22, s49, 5120
  s_add_u32 m0, s25, 117760
  s_nop 0
  buffer_load_dwordx4 v2, s[8:11], s22 offen sc1 lds
  v_permlane16_swap_b32 v65, v73
  v_permlane16_swap_b32 v66, v74
  v_permlane16_swap_b32 v67, v75
  v_mfma_f32_32x32x16_bf16 v[48:63], v[24:27], v[208:211], v[48:63]
  v_accvgpr_write_b32 a44, v64
  v_accvgpr_write_b32 a45, v65
  ds_read_b128 v[24:27], v10 offset:49408
  s_waitcnt lgkmcnt(3)
  v_mfma_f32_32x32x16_bf16 v[32:47], v[28:31], v[148:151], v[32:47]
  s_add_u32 s22, s49, 6144
  s_add_u32 m0, s25, 131072
  s_nop 0
  buffer_load_dwordx4 v2, s[8:11], s22 offen sc1 lds
  v_accvgpr_write_b32 a46, v66
  v_accvgpr_write_b32 a47, v67
  v_accvgpr_write_b32 a100, v72
  v_mfma_f32_32x32x16_bf16 v[48:63], v[28:31], v[212:215], v[48:63]
  v_accvgpr_write_b32 a101, v73
  v_accvgpr_write_b32 a102, v74
  ds_read_b128 v[28:31], v11 offset:49408
  s_waitcnt lgkmcnt(3)
  v_mfma_f32_32x32x16_bf16 v[32:47], v[16:19], v[152:155], v[32:47]
  s_add_u32 s22, s49, 7168
  s_add_u32 m0, s25, 132096
  s_nop 0
  buffer_load_dwordx4 v2, s[8:11], s22 offen sc1 lds
  v_accvgpr_write_b32 a103, v75
  v_mul_f32 v80, s52, v80
  v_mul_f32 v81, s52, v81
  v_mfma_f32_32x32x16_bf16 v[48:63], v[16:19], v[216:219], v[48:63]
  v_cvt_pk_bf16_f32 v80, v80, v81
  v_mul_f32 v82, s52, v82
  ds_read_b128 v[16:19], v12 offset:49408
  s_waitcnt lgkmcnt(3)
  v_mfma_f32_32x32x16_bf16 v[32:47], v[20:23], v[156:159], v[32:47]
  s_add_u32 s22, s49, 8192
  s_add_u32 m0, s25, 133120
  s_nop 0
  buffer_load_dwordx4 v2, s[8:11], s22 offen sc1 lds
  v_mul_f32 v83, s52, v83
  v_cvt_pk_bf16_f32 v81, v82, v83
  v_mul_f32 v84, s52, v84
  v_mfma_f32_32x32x16_bf16 v[48:63], v[20:23], v[220:223], v[48:63]
  v_mul_f32 v85, s52, v85
  v_cvt_pk_bf16_f32 v82, v84, v85
  ds_read_b128 v[20:23], v13 offset:49408
  s_waitcnt lgkmcnt(3)
  v_mfma_f32_32x32x16_bf16 v[32:47], v[24:27], v[160:163], v[32:47]
  s_add_u32 s22, s49, 9216
  s_add_u32 m0, s25, 134144
  s_nop 0
  buffer_load_dwordx4 v2, s[8:11], s22 offen sc1 lds
  v_mul_f32 v86, s52, v86
  v_mul_f32 v87, s52, v87
  v_cvt_pk_bf16_f32 v83, v86, v87
  v_mfma_f32_32x32x16_bf16 v[48:63], v[24:27], v[224:227], v[48:63]
  v_mul_f32 v88, s52, v88
  v_mul_f32 v89, s52, v89
  ds_read_b128 v[24:27], v14 offset:49408
  s_waitcnt lgkmcnt(3)
  v_mfma_f32_32x32x16_bf16 v[32:47], v[28:31], v[164:167], v[32:47]
  s_add_u32 s22, s49, 10240
  s_add_u32 m0, s25, 147456
  s_nop 0
  buffer_load_dwordx4 v2, s[8:11], s22 offen sc1 lds
  v_cvt_pk_bf16_f32 v88, v88, v89
  v_mul_f32 v90, s52, v90
  v_mul_f32 v91, s52, v91
  v_mfma_f32_32x32x16_bf16 v[48:63], v[28:31], v[228:231], v[48:63]
  v_cvt_pk_bf16_f32 v89, v90, v91
  v_mul_f32 v92, s52, v92
  ds_read_b128 v[28:31], v15 offset:49408
  s_waitcnt lgkmcnt(3)
  v_mfma_f32_32x32x16_bf16 v[32:47], v[16:19], v[168:171], v[32:47]
  s_add_u32 s22, s49, 11264
  s_add_u32 m0, s25, 148480
  s_nop 0
  buffer_load_dwordx4 v2, s[8:11], s22 offen sc1 lds
  v_mul_f32 v93, s52, v93
  v_cvt_pk_bf16_f32 v90, v92, v93
  v_mul_f32 v94, s52, v94
  v_mfma_f32_32x32x16_bf16 v[48:63], v[16:19], v[232:235], v[48:63]
  v_mul_f32 v95, s52, v95
  v_cvt_pk_bf16_f32 v91, v94, v95
  v_xor_b32 v8, 65536, v8
  ds_read_b128 v[16:19], v8 offset:0
  s_waitcnt lgkmcnt(3)
  v_mfma_f32_32x32x16_bf16 v[32:47], v[20:23], v[172:175], v[32:47]
  s_add_u32 s22, s49, 12288
  s_add_u32 m0, s25, 149504
  s_nop 0
  buffer_load_dwordx4 v2, s[8:11], s22 offen sc1 lds
  v_permlane16_swap_b32 v80, v88
  v_permlane16_swap_b32 v81, v89
  v_permlane16_swap_b32 v82, v90
  v_mfma_f32_32x32x16_bf16 v[48:63], v[20:23], v[236:239], v[48:63]
  v_permlane16_swap_b32 v83, v91
  v_accvgpr_write_b32 a156, v80
  v_xor_b32 v9, 65536, v9
  ds_read_b128 v[20:23], v9 offset:0
  s_waitcnt lgkmcnt(3)
  v_mfma_f32_32x32x16_bf16 v[32:47], v[24:27], v[176:179], v[32:47]
  s_add_u32 s22, s49, 13312
  s_add_u32 m0, s25, 150528
  s_nop 0
  buffer_load_dwordx4 v2, s[8:11], s22 offen sc1 lds
  v_accvgpr_write_b32 a157, v81
  v_accvgpr_write_b32 a158, v82
  v_accvgpr_write_b32 a159, v83
  v_mfma_f32_32x32x16_bf16 v[48:63], v[24:27], v[240:243], v[48:63]
  v_accvgpr_write_b32 a212, v88
  v_accvgpr_write_b32 a213, v89
  v_xor_b32 v10, 65536, v10
  ds_read_b128 v[24:27], v10 offset:0
  s_waitcnt lgkmcnt(3)
  v_mfma_f32_32x32x16_bf16 v[32:47], v[28:31], v[180:183], v[32:47]
  v_accvgpr_write_b32 a214, v90
  v_accvgpr_write_b32 a215, v91
  v_mfma_f32_32x32x16_bf16 v[48:63], v[28:31], v[244:247], v[48:63]
  s_barrier
  v_xor_b32 v11, 65536, v11
  ds_read_b128 v[28:31], v11 offset:0
  s_waitcnt lgkmcnt(3)
  v_mfma_f32_32x32x16_bf16 v[64:79], v[16:19], v[120:123], 0
  s_waitcnt vmcnt(9)
  v_cmp_ne_u64 vcc, s[88:89], v[100:101]
  v_cmp_ne_u64 s[54:55], s[88:89], v[102:103]
  s_add_u32 s50, s33, 0
  v_mfma_f32_32x32x16_bf16 v[80:95], v[16:19], v[184:187], 0
  v_xor_b32 v12, 65536, v12
  ds_read_b128 v[16:19], v12 offset:0
  s_waitcnt lgkmcnt(3)
  v_mfma_f32_32x32x16_bf16 v[64:79], v[20:23], v[124:127], v[64:79]
  s_or_b64 vcc, vcc, s[54:55]
  s_cselect_b32 s50, 0x10000000, s50
  s_add_u32 s22, s50, 0
  buffer_load_dwordx4 a[224:227], v2, s[8:11], s22 offen sc1
  v_mul_f32 v32, s52, v32
  v_mul_f32 v33, s52, v33
  v_cvt_pk_bf16_f32 v32, v32, v33
  v_mfma_f32_32x32x16_bf16 v[80:95], v[20:23], v[188:191], v[80:95]
  v_mul_f32 v34, s52, v34
  v_mul_f32 v35, s52, v35
  v_xor_b32 v13, 65536, v13
  ds_read_b128 v[20:23], v13 offset:0
  s_waitcnt lgkmcnt(3)
  v_mfma_f32_32x32x16_bf16 v[64:79], v[24:27], v[128:131], v[64:79]
  s_add_u32 s22, s50, 1024
  buffer_load_dwordx4 a[228:231], v2, s[8:11], s22 offen sc1
  v_cvt_pk_bf16_f32 v33, v34, v35
  v_mul_f32 v36, s52, v36
  v_mul_f32 v37, s52, v37
  v_mfma_f32_32x32x16_bf16 v[80:95], v[24:27], v[192:195], v[80:95]
  v_cvt_pk_bf16_f32 v34, v36, v37
  v_mul_f32 v38, s52, v38
  v_xor_b32 v14, 65536, v14
  ds_read_b128 v[24:27], v14 offset:0
  s_waitcnt lgkmcnt(3)
  v_mfma_f32_32x32x16_bf16 v[64:79], v[28:31], v[132:135], v[64:79]
  s_add_u32 s22, s50, 2048
  buffer_load_dwordx4 a[232:235], v2, s[8:11], s22 offen sc1
  v_mul_f32 v39, s52, v39
  v_cvt_pk_bf16_f32 v35, v38, v39
  v_mul_f32 v40, s52, v40
  v_mfma_f32_32x32x16_bf16 v[80:95], v[28:31], v[196:199], v[80:95]
  v_mul_f32 v41, s52, v41
  v_cvt_pk_bf16_f32 v40, v40, v41
  v_xor_b32 v15, 65536, v15
  ds_read_b128 v[28:31], v15 offset:0
  s_waitcnt lgkmcnt(3)
  v_mfma_f32_32x32x16_bf16 v[64:79], v[16:19], v[136:139], v[64:79]
  s_add_u32 s22, s50, 3072
  buffer_load_dwordx4 a[236:239], v2, s[8:11], s22 offen sc1
  v_mul_f32 v42, s52, v42
  v_mul_f32 v43, s52, v43
  v_cvt_pk_bf16_f32 v41, v42, v43
  v_mfma_f32_32x32x16_bf16 v[80:95], v[16:19], v[200:203], v[80:95]
  v_mul_f32 v44, s52, v44
  v_mul_f32 v45, s52, v45
  ds_read_b128 v[16:19], v8 offset:256
  s_waitcnt lgkmcnt(3)
  v_mfma_f32_32x32x16_bf16 v[64:79], v[20:23], v[140:143], v[64:79]
  s_add_u32 s22, s50, 4096
  buffer_load_dwordx4 a[240:243], v2, s[8:11], s22 offen sc1
  v_cvt_pk_bf16_f32 v42, v44, v45
  v_mul_f32 v46, s52, v46
  v_mul_f32 v47, s52, v47
  v_mfma_f32_32x32x16_bf16 v[80:95], v[20:23], v[204:207], v[80:95]
  v_cvt_pk_bf16_f32 v43, v46, v47
  v_permlane16_swap_b32 v32, v40
  ds_read_b128 v[20:23], v9 offset:256
  s_waitcnt lgkmcnt(3)
  v_mfma_f32_32x32x16_bf16 v[64:79], v[24:27], v[144:147], v[64:79]
  s_add_u32 s22, s50, 5120
  buffer_load_dwordx4 a[244:247], v2, s[8:11], s22 offen sc1
  v_permlane16_swap_b32 v33, v41
  v_permlane16_swap_b32 v34, v42
  v_permlane16_swap_b32 v35, v43
  v_mfma_f32_32x32x16_bf16 v[80:95], v[24:27], v[208:211], v[80:95]
  v_accvgpr_write_b32 a48, v32
  v_accvgpr_write_b32 a49, v33
  ds_read_b128 v[24:27], v10 offset:256
  s_waitcnt lgkmcnt(3)
  v_mfma_f32_32x32x16_bf16 v[64:79], v[28:31], v[148:151], v[64:79]
  s_add_u32 s22, s50, 6144
  buffer_load_dwordx4 a[248:251], v2, s[8:11], s22 offen sc1
  v_accvgpr_write_b32 a50, v34
  v_accvgpr_write_b32 a51, v35
  v_accvgpr_write_b32 a104, v40
  v_mfma_f32_32x32x16_bf16 v[80:95], v[28:31], v[212:215], v[80:95]
  v_accvgpr_write_b32 a105, v41
  v_accvgpr_write_b32 a106, v42
  ds_read_b128 v[28:31], v11 offset:256
  s_waitcnt lgkmcnt(3)
  v_mfma_f32_32x32x16_bf16 v[64:79], v[16:19], v[152:155], v[64:79]
  s_add_u32 s22, s50, 7168
  buffer_load_dwordx4 a[252:255], v2, s[8:11], s22 offen sc1
  v_accvgpr_write_b32 a107, v43
  v_mul_f32 v48, s52, v48
  v_mul_f32 v49, s52, v49
  v_mfma_f32_32x32x16_bf16 v[80:95], v[16:19], v[216:219], v[80:95]
  v_cvt_pk_bf16_f32 v48, v48, v49
  v_mul_f32 v50, s52, v50
  ds_read_b128 v[16:19], v12 offset:256
  s_waitcnt lgkmcnt(3)
  v_mfma_f32_32x32x16_bf16 v[64:79], v[20:23], v[156:159], v[64:79]
  s_add_u32 s22, s50, 8192
  s_add_u32 m0, s25, 32768
  s_nop 0
  buffer_load_dwordx4 v2, s[8:11], s22 offen sc1 lds
  v_mul_f32 v51, s52, v51
  v_cvt_pk_bf16_f32 v49, v50, v51
  v_mul_f32 v52, s52, v52
  v_mfma_f32_32x32x16_bf16 v[80:95], v[20:23], v[220:223], v[80:95]
  v_mul_f32 v53, s52, v53
  v_cvt_pk_bf16_f32 v50, v52, v53
  ds_read_b128 v[20:23], v13 offset:256
  s_waitcnt lgkmcnt(3)
  v_mfma_f32_32x32x16_bf16 v[64:79], v[24:27], v[160:163], v[64:79]
  s_add_u32 s22, s50, 9216
  s_add_u32 m0, s25, 33792
  s_nop 0
  buffer_load_dwordx4 v2, s[8:11], s22 offen sc1 lds
  v_mul_f32 v54, s52, v54
  v_mul_f32 v55, s52, v55
  v_cvt_pk_bf16_f32 v51, v54, v55
  v_mfma_f32_32x32x16_bf16 v[80:95], v[24:27], v[224:227], v[80:95]
  v_mul_f32 v56, s52, v56
  v_mul_f32 v57, s52, v57
  ds_read_b128 v[24:27], v14 offset:256
  s_waitcnt lgkmcnt(3)
  v_mfma_f32_32x32x16_bf16 v[64:79], v[28:31], v[164:167], v[64:79]
  s_add_u32 s22, s50, 10240
  s_add_u32 m0, s25, 34816
  s_nop 0
  buffer_load_dwordx4 v2, s[8:11], s22 offen sc1 lds
  v_cvt_pk_bf16_f32 v56, v56, v57
  v_mul_f32 v58, s52, v58
  v_mul_f32 v59, s52, v59
  v_mfma_f32_32x32x16_bf16 v[80:95], v[28:31], v[228:231], v[80:95]
  v_cvt_pk_bf16_f32 v57, v58, v59
  v_mul_f32 v60, s52, v60
  ds_read_b128 v[28:31], v15 offset:256
  s_waitcnt lgkmcnt(3)
  v_mfma_f32_32x32x16_bf16 v[64:79], v[16:19], v[168:171], v[64:79]
  s_add_u32 s22, s50, 11264
  s_add_u32 m0, s25, 35840
  s_nop 0
  buffer_load_dwordx4 v2, s[8:11], s22 offen sc1 lds
  v_mul_f32 v61, s52, v61
  v_cvt_pk_bf16_f32 v58, v60, v61
  v_mul_f32 v62, s52, v62
  v_mfma_f32_32x32x16_bf16 v[80:95], v[16:19], v[232:235], v[80:95]
  v_mul_f32 v63, s52, v63
  v_cvt_pk_bf16_f32 v59, v62, v63
  s_waitcnt lgkmcnt(2)
  v_mfma_f32_32x32x16_bf16 v[64:79], v[20:23], v[172:175], v[64:79]
  s_add_u32 s22, s50, 12288
  s_add_u32 m0, s25, 49152
  s_nop 0
  buffer_load_dwordx4 v2, s[8:11], s22 offen sc1 lds
  v_permlane16_swap_b32 v48, v56
  v_permlane16_swap_b32 v49, v57
  v_permlane16_swap_b32 v50, v58
  v_mfma_f32_32x32x16_bf16 v[80:95], v[20:23], v[236:239], v[80:95]
  v_permlane16_swap_b32 v51, v59
  v_accvgpr_write_b32 a160, v48
  s_waitcnt lgkmcnt(1)
  v_mfma_f32_32x32x16_bf16 v[64:79], v[24:27], v[176:179], v[64:79]
  s_add_u32 s22, s50, 13312
  s_add_u32 m0, s25, 50176
  s_nop 0
  buffer_load_dwordx4 v2, s[8:11], s22 offen sc1 lds
  v_accvgpr_write_b32 a161, v49
  v_accvgpr_write_b32 a162, v50
  v_accvgpr_write_b32 a163, v51
  v_mfma_f32_32x32x16_bf16 v[80:95], v[24:27], v[240:243], v[80:95]
  v_accvgpr_write_b32 a216, v56
  v_accvgpr_write_b32 a217, v57
  s_waitcnt lgkmcnt(0)
  v_mfma_f32_32x32x16_bf16 v[64:79], v[28:31], v[180:183], v[64:79]
  buffer_load_dwordx4 v[100:103], v113, s[8:11], s28 offen sc1
  buffer_load_dwordx4 v[104:107], v2, s[8:11], s29 offen sc1
  buffer_load_dwordx4 v[108:111], v112, s[8:11], s29 offen sc1
  v_accvgpr_write_b32 a218, v58
  v_accvgpr_write_b32 a219, v59
  v_mfma_f32_32x32x16_bf16 v[80:95], v[28:31], v[244:247], v[80:95]
  s_nop 4
  v_mul_f32 v64, s52, v64
  v_mul_f32 v65, s52, v65
  v_cvt_pk_bf16_f32 v64, v64, v65
  v_mul_f32 v66, s52, v66
  v_mul_f32 v67, s52, v67
  v_cvt_pk_bf16_f32 v65, v66, v67
  v_mul_f32 v68, s52, v68
  v_mul_f32 v69, s52, v69
  v_cvt_pk_bf16_f32 v66, v68, v69
  v_mul_f32 v70, s52, v70
  v_mul_f32 v71, s52, v71
  v_cvt_pk_bf16_f32 v67, v70, v71
  v_mul_f32 v72, s52, v72
  v_mul_f32 v73, s52, v73
  v_cvt_pk_bf16_f32 v72, v72, v73
  v_mul_f32 v74, s52, v74
  v_mul_f32 v75, s52, v75
  v_cvt_pk_bf16_f32 v73, v74, v75
  v_mul_f32 v76, s52, v76
  v_mul_f32 v77, s52, v77
  v_cvt_pk_bf16_f32 v74, v76, v77
  v_mul_f32 v78, s52, v78
  v_mul_f32 v79, s52, v79
  v_cvt_pk_bf16_f32 v75, v78, v79
  v_permlane16_swap_b32 v64, v72
  v_permlane16_swap_b32 v65, v73
  v_permlane16_swap_b32 v66, v74
  v_permlane16_swap_b32 v67, v75
  v_accvgpr_write_b32 a52, v64
  v_accvgpr_write_b32 a53, v65
  v_accvgpr_write_b32 a54, v66
  v_accvgpr_write_b32 a55, v67
  v_accvgpr_write_b32 a108, v72
  v_accvgpr_write_b32 a109, v73
  v_accvgpr_write_b32 a110, v74
  v_accvgpr_write_b32 a111, v75
  v_mul_f32 v80, s52, v80
  v_mul_f32 v81, s52, v81
  v_cvt_pk_bf16_f32 v80, v80, v81
  v_mul_f32 v82, s52, v82
  v_mul_f32 v83, s52, v83
  v_cvt_pk_bf16_f32 v81, v82, v83
  v_mul_f32 v84, s52, v84
  v_mul_f32 v85, s52, v85
  v_cvt_pk_bf16_f32 v82, v84, v85
  v_mul_f32 v86, s52, v86
  v_mul_f32 v87, s52, v87
  v_cvt_pk_bf16_f32 v83, v86, v87
  v_mul_f32 v88, s52, v88
  v_mul_f32 v89, s52, v89
  v_cvt_pk_bf16_f32 v88, v88, v89
  v_mul_f32 v90, s52, v90
  v_mul_f32 v91, s52, v91
  v_cvt_pk_bf16_f32 v89, v90, v91
  v_mul_f32 v92, s52, v92
  v_mul_f32 v93, s52, v93
  v_cvt_pk_bf16_f32 v90, v92, v93
  v_mul_f32 v94, s52, v94
  v_mul_f32 v95, s52, v95
  v_cvt_pk_bf16_f32 v91, v94, v95
  v_permlane16_swap_b32 v80, v88
  v_permlane16_swap_b32 v81, v89
  v_permlane16_swap_b32 v82, v90
  v_permlane16_swap_b32 v83, v91
  v_accvgpr_write_b32 a164, v80
  v_accvgpr_write_b32 a165, v81
  v_accvgpr_write_b32 a166, v82
  v_accvgpr_write_b32 a167, v83
  v_accvgpr_write_b32 a220, v88
  v_accvgpr_write_b32 a221, v89
  v_accvgpr_write_b32 a222, v90
  v_accvgpr_write_b32 a223, v91
  s_mov_b32 s30, 0
  s_branch sc_aw_w
sc_aw:
  buffer_load_dwordx4 v[100:103], v113, s[8:11], s28 offen sc1
  buffer_load_dwordx4 v[104:107], v2, s[8:11], s29 offen sc1
  buffer_load_dwordx4 v[108:111], v112, s[8:11], s29 offen sc1
sc_aw_w:
  s_waitcnt vmcnt(0)
  v_cmp_ne_u64 vcc, s[88:89], v[100:101]
  s_cbranch_vccnz sc_aw_no
  v_cmp_ne_u64 vcc, s[88:89], v[102:103]
  s_cbranch_vccnz sc_aw_no
  v_cmp_ne_u64 vcc, s[88:89], v[104:105]
  s_cbranch_vccnz sc_aw_no
  v_cmp_ne_u64 vcc, s[88:89], v[106:107]
  s_cbranch_vccnz sc_aw_no
  v_cmp_ne_u64 vcc, s[88:89], v[108:109]
  s_cbranch_vccnz sc_aw_no
  v_cmp_ne_u64 vcc, s[88:89], v[110:111]
  s_cbranch_vccnz sc_aw_no
  s_branch sc_aw_ok
sc_aw_no:
  s_sleep 1
  s_add_u32 s30, s30, 1
  s_cmp_lt_u32 s30, 50000
  s_cbranch_scc1 sc_aw
  s_branch cA_abort
sc_aw_ok:
  v_add_u32 v4, s25, v2
  v_add_u32 v5, 0x10000, v4
  v_add_u32 v6, 0x20000, v4
  s_cmp_eq_u32 s48, 0x10000000
  s_cbranch_scc1 sc_d0
  ds_read_b128 v[144:147], v4 offset:0
  ds_read_b128 v[148:151], v4 offset:1024
  ds_read_b128 v[152:155], v4 offset:2048
  ds_read_b128 v[156:159], v4 offset:3072
  ds_read_b128 v[160:163], v4 offset:16384
  ds_read_b128 v[164:167], v4 offset:17408
  ds_read_b128 v[168:171], v4 offset:18432
  ds_read_b128 v[172:175], v4 offset:19456
  ds_read_b128 v[176:179], v5 offset:16384
  ds_read_b128 v[180:183], v5 offset:17408
  ds_read_b128 v[184:187], v5 offset:18432
  ds_read_b128 v[188:191], v5 offset:19456
  ds_read_b128 v[192:195], v5 offset:32768
  ds_read_b128 v[196:199], v5 offset:33792
  s_waitcnt lgkmcnt(0)
  s_branch sc_e0
sc_d0:
  s_add_u32 s22, s33, 12288
  buffer_load_dwordx4 v[144:147], v2, s[8:11], s22 offen offset:2048 sc1
  buffer_load_dwordx4 v[148:151], v2, s[8:11], s22 offen offset:3072 sc1
  s_add_u32 s22, s33, 16384
  buffer_load_dwordx4 v[152:155], v2, s[8:11], s22 offen offset:0 sc1
  buffer_load_dwordx4 v[156:159], v2, s[8:11], s22 offen offset:1024 sc1
  buffer_load_dwordx4 v[160:163], v2, s[8:11], s22 offen offset:2048 sc1
  buffer_load_dwordx4 v[164:167], v2, s[8:11], s22 offen offset:3072 sc1
  s_add_u32 s22, s33, 20480
  buffer_load_dwordx4 v[168:171], v2, s[8:11], s22 offen offset:0 sc1
  buffer_load_dwordx4 v[172:175], v2, s[8:11], s22 offen offset:1024 sc1
  buffer_load_dwordx4 v[176:179], v2, s[8:11], s22 offen offset:2048 sc1
  buffer_load_dwordx4 v[180:183], v2, s[8:11], s22 offen offset:3072 sc1
  s_add_u32 s22, s33, 24576
  buffer_load_dwordx4 v[184:187], v2, s[8:11], s22 offen offset:0 sc1
  buffer_load_dwordx4 v[188:191], v2, s[8:11], s22 offen offset:1024 sc1
  buffer_load_dwordx4 v[192:195], v2, s[8:11], s22 offen offset:2048 sc1
  buffer_load_dwordx4 v[196:199], v2, s[8:11], s22 offen offset:3072 sc1
sc_e0:
  s_cmp_eq_u32 s49, 0x10000000
  s_cbranch_scc1 sc_d1
  ds_read_b128 v[200:203], v5 offset:34816
  ds_read_b128 v[204:207], v5 offset:35840
  ds_read_b128 v[208:211], v5 offset:49152
  ds_read_b128 v[212:215], v5 offset:50176
  ds_read_b128 v[216:219], v5 offset:51200
  ds_read_b128 v[220:223], v5 offset:52224
  ds_read_b128 v[224:227], v6 offset:0
  ds_read_b128 v[228:231], v6 offset:1024
  ds_read_b128 v[232:235], v6 offset:2048
  ds_read_b128 v[236:239], v6 offset:3072
  ds_read_b128 v[240:243], v6 offset:16384
  ds_read_b128 v[244:247], v6 offset:17408
  ds_read_b128 v[248:251], v6 offset:18432
  ds_read_b128 v[252:255], v6 offset:19456
  s_waitcnt lgkmcnt(0)
  s_branch sc_e1
sc_d1:
  s_add_u32 s22, s32, 0
  buffer_load_dwordx4 v[200:203], v2, s[8:11], s22 offen offset:0 sc1
  buffer_load_dwordx4 v[204:207], v2, s[8:11], s22 offen offset:1024 sc1
  buffer_load_dwordx4 v[208:211], v2, s[8:11], s22 offen offset:2048 sc1
  buffer_load_dwordx4 v[212:215], v2, s[8:11], s22 offen offset:3072 sc1
  s_add_u32 s22, s32, 4096
  buffer_load_dwordx4 v[216:219], v2, s[8:11], s22 offen offset:0 sc1
  buffer_load_dwordx4 v[220:223], v2, s[8:11], s22 offen offset:1024 sc1
  buffer_load_dwordx4 v[224:227], v2, s[8:11], s22 offen offset:2048 sc1
  buffer_load_dwordx4 v[228:231], v2, s[8:11], s22 offen offset:3072 sc1
  s_add_u32 s22, s32, 8192
  buffer_load_dwordx4 v[232:235], v2, s[8:11], s22 offen offset:0 sc1
  buffer_load_dwordx4 v[236:239], v2, s[8:11], s22 offen offset:1024 sc1
  buffer_load_dwordx4 v[240:243], v2, s[8:11], s22 offen offset:2048 sc1
  buffer_load_dwordx4 v[244:247], v2, s[8:11], s22 offen offset:3072 sc1
  s_add_u32 s22, s32, 12288
  buffer_load_dwordx4 v[248:251], v2, s[8:11], s22 offen offset:0 sc1
  buffer_load_dwordx4 v[252:255], v2, s[8:11], s22 offen offset:1024 sc1
sc_e1:
  s_cmp_eq_u32 s50, 0x10000000
  s_cbranch_scc1 sc_d2
  ds_read_b128 v[120:123], v4 offset:32768
  ds_read_b128 v[124:127], v4 offset:33792
  ds_read_b128 v[128:131], v4 offset:34816
  ds_read_b128 v[132:135], v4 offset:35840
  ds_read_b128 v[136:139], v4 offset:49152
  ds_read_b128 v[140:143], v4 offset:50176
  s_waitcnt lgkmcnt(0)
  s_branch sc_e2
sc_d2:
  s_add_u32 s22, s33, 0
  buffer_load_dwordx4 a[224:227], v2, s[8:11], s22 offen offset:0 sc1
  buffer_load_dwordx4 a[228:231], v2, s[8:11], s22 offen offset:1024 sc1
  buffer_load_dwordx4 a[232:235], v2, s[8:11], s22 offen offset:2048 sc1
  buffer_load_dwordx4 a[236:239], v2, s[8:11], s22 offen offset:3072 sc1
  s_add_u32 s22, s33, 4096
  buffer_load_dwordx4 a[240:243], v2, s[8:11], s22 offen offset:0 sc1
  buffer_load_dwordx4 a[244:247], v2, s[8:11], s22 offen offset:1024 sc1
  buffer_load_dwordx4 a[248:251], v2, s[8:11], s22 offen offset:2048 sc1
  buffer_load_dwordx4 a[252:255], v2, s[8:11], s22 offen offset:3072 sc1
  s_add_u32 s22, s33, 8192
  buffer_load_dwordx4 v[120:123], v2, s[8:11], s22 offen offset:0 sc1
  buffer_load_dwordx4 v[124:127], v2, s[8:11], s22 offen offset:1024 sc1
  buffer_load_dwordx4 v[128:131], v2, s[8:11], s22 offen offset:2048 sc1
  buffer_load_dwordx4 v[132:135], v2, s[8:11], s22 offen offset:3072 sc1
  s_add_u32 s22, s33, 12288
  buffer_load_dwordx4 v[136:139], v2, s[8:11], s22 offen offset:0 sc1
  buffer_load_dwordx4 v[140:143], v2, s[8:11], s22 offen offset:1024 sc1
sc_e2:
  s_barrier
  s_branch m_role
m_val:
  s_cmp_lg_u32 s16, 0
  s_cbranch_scc1 w0_6
  v_mov_b32 v233, 128
  v_mov_b32 v234, s88
  v_mov_b32 v235, s89
  v_mov_b32 v236, 0
  v_mov_b32 v237, 0
  s_mov_b64 exec, 1
  buffer_atomic_cmpswap_x2 v[234:237], v233, s[12:15], 0 offen sc0
  s_mov_b64 exec, -1
w0_6:
  s_cmp_lg_u32 s66, 0
  s_cbranch_scc1 va_ci
  s_cmp_lg_u32 s16, 0
  s_cbranch_scc1 w0_7
  s_lshr_b32 s70, s3, 5
  s_and_b32 s71, s70, 4
  s_mul_i32 s71, s71, 12
  s_lshl_b32 s70, s70, 2
  s_add_u32 s70, s70, s71
  s_lshl_b32 s71, 1, s3
  v_mov_b32 v242, s71
  v_mov_b32 v243, 32
  s_mov_b64 exec, 1
  buffer_atomic_or v242, v243, s[12:15], s70 offen sc0
  buffer_load_dwordx2 v[244:245], v243, s[12:15], 0 offen offset:96 sc1
  s_mov_b64 exec, -1
w0_7:
va_ci:
  s_mov_b32 s56, s40
  s_and_b32 s57, s41, 0xffff
  s_mov_b32 s58, 3670016
  s_mov_b32 s59, 0x20000
  v_lshrrev_b32 v24, 5, v1
  v_and_b32 v25, 31, v1
  v_lshlrev_b32 v25, 4, v25
  v_lshl_add_u32 v24, v24, 13, v25
  s_mov_b32 s60, s42
  s_and_b32 s61, s43, 0xffff
  s_mov_b32 s62, 3670016
  s_mov_b32 s63, 0x20000
  s_lshl_b32 s22, s17, 9
  s_lshl_b32 s23, s16, 19
  s_add_u32 s23, s22, s23
  s_add_u32 s21, s23, 262144
  buffer_load_dwordx4 v[28:31], v24, s[60:63], s21 offen
  s_add_u32 s21, s23, 278528
  buffer_load_dwordx4 v[28:31], v24, s[60:63], s21 offen
  s_add_u32 s21, s23, 294912
  buffer_load_dwordx4 v[28:31], v24, s[60:63], s21 offen
  s_add_u32 s21, s23, 311296
  buffer_load_dwordx4 v[28:31], v24, s[60:63], s21 offen
  s_add_u32 s21, s23, 327680
  buffer_load_dwordx4 v[28:31], v24, s[60:63], s21 offen
  s_add_u32 s21, s23, 344064
  buffer_load_dwordx4 v[28:31], v24, s[60:63], s21 offen
  s_add_u32 s21, s23, 360448
  buffer_load_dwordx4 v[28:31], v24, s[60:63], s21 offen
  s_add_u32 s21, s23, 376832
  buffer_load_dwordx4 v[28:31], v24, s[60:63], s21 offen
  s_add_u32 s21, s23, 393216
  buffer_load_dwordx4 v[28:31], v24, s[60:63], s21 offen
  s_add_u32 s21, s23, 409600
  buffer_load_dwordx4 v[28:31], v24, s[60:63], s21 offen
  s_add_u32 s21, s23, 425984
  buffer_load_dwordx4 v[28:31], v24, s[60:63], s21 offen
  s_add_u32 s21, s23, 442368
  buffer_load_dwordx4 v[28:31], v24, s[60:63], s21 offen
  s_add_u32 s21, s23, 458752
  buffer_load_dwordx4 v[28:31], v24, s[60:63], s21 offen
  s_add_u32 s21, s23, 475136
  buffer_load_dwordx4 v[28:31], v24, s[60:63], s21 offen
  s_add_u32 s21, s23, 491520
  buffer_load_dwordx4 v[28:31], v24, s[60:63], s21 offen
  s_add_u32 s21, s23, 507904
  buffer_load_dwordx4 v[28:31], v24, s[60:63], s21 offen
  s_lshl_b32 s23, s16, 14
  s_add_u32 s22, s22, s23
  s_mov_b32 s30, 0
va_pf:
  buffer_load_dwordx4 v[28:31], v24, s[56:59], s22 offen
  s_waitcnt vmcnt(40)
  s_add_u32 s22, s22, 65536
  s_add_u32 s30, s30, 1
  s_cmp_lt_u32 s30, 28
  s_cbranch_scc1 va_pf
  s_cmp_lg_u32 s66, 0
  s_cbranch_scc1 va_cf
  s_cmp_lg_u32 s16, 0
  s_cbranch_scc1 w0_8
  s_waitcnt vmcnt(40)
  v_readfirstlane_b32 s70, v244
  s_cmp_lg_u32 s70, 0
  s_cbranch_scc1 va_nz
  v_mov_b32 v243, 128
  v_mov_b32 v244, s88
  v_mov_b32 v245, s89
  v_mov_b32 v246, 0
  v_mov_b32 v247, 0
  s_mov_b64 exec, 1
  buffer_atomic_cmpswap_x2 v[244:247], v243, s[12:15], 0 offen sc0
  s_mov_b64 exec, -1
  s_waitcnt vmcnt(0)
  v_readfirstlane_b32 s70, v244
  s_cmp_lg_u32 s70, 0
  s_cbranch_scc1 va_nz
  v_mov_b32 v244, s88
  v_mov_b32 v245, s89
va_nz:
w0_8:
  v_mov_b32 v243, 160000
  s_add_u32 s101, s101, 1
  s_barrier
  s_mov_b64 exec, 1
  s_cmp_lg_u32 s16, 0
  s_cbranch_scc1 w0_9
  ds_write_b32 v243, v242 offset:0
  ds_write_b32 v243, v244 offset:4
  ds_write_b32 v243, v245 offset:8
  s_waitcnt lgkmcnt(0)
  v_mov_b32 v242, s101
  ds_write_b32 v243, v242 offset:16
  s_waitcnt lgkmcnt(0)
w0_9:
  s_mov_b64 exec, -1
  s_barrier
  ds_read_b32 v242, v243 offset:0
  ds_read_b32 v244, v243 offset:4
  ds_read_b32 v245, v243 offset:8
  ds_read_b32 v243, v243 offset:16
  s_waitcnt lgkmcnt(0)
  v_readfirstlane_b32 s70, v242
  v_readfirstlane_b32 s88, v244
  v_readfirstlane_b32 s89, v245
  v_cmp_ne_u32 vcc, s101, v243
  s_cbranch_vccnz ch_end
  s_mov_b32 s66, 1
  s_bitcmp1_b32 s70, s3
  s_cbranch_scc1 m_reclaim
va_cf:
  s_cmp_lg_u32 s16, 0
  s_cbranch_scc1 w0_10
  s_cmp_eq_u32 s67, 0
  s_cselect_b32 s20, 1, 0x10001
  v_mov_b32 v242, s20
  v_mov_b32 v243, 0
  s_mov_b64 exec, 1
  buffer_atomic_add v242, v243, s[12:15], 0 offen
  s_mov_b64 exec, -1
w0_10:
m_role:
  s_mov_b32 s17, s3
  v_and_b32 v1, 63, v0
  v_lshlrev_b32 v2, 4, v1
  v_lshrrev_b32 v116, 4, v1
  v_and_b32 v117, 15, v1
  v_mov_b32 v3, 0x4444
  v_mov_b32 v118, 0xeeee
  v_cmp_lt_u32 vcc, 7, v117
  s_nop 1
  v_cndmask_b32 v3, v3, v118, vcc
  s_mov_b32 s19, 0
  s_mov_b32 s20, 75235328
  s_lshr_b32 s22, s17, 4
  s_lshl_b32 s22, s22, 2
  s_add_u32 s22, s22, s16
  s_and_b32 s17, s17, 15
  s_cmp_eq_u32 s22, 0
  s_cbranch_scc1 ch_init0
  s_cmp_eq_u32 s22, 1
  s_cbranch_scc1 ch_init1
  s_cmp_eq_u32 s22, 2
  s_cbranch_scc1 ch_init2
  s_cmp_eq_u32 s22, 3
  s_cbranch_scc1 ch_init3
  s_cmp_eq_u32 s22, 4
  s_cbranch_scc1 ch_init4
  s_cmp_eq_u32 s22, 5
  s_cbranch_scc1 ch_init5
  s_cmp_eq_u32 s22, 6
  s_cbranch_scc1 ch_init6
  s_cmp_eq_u32 s22, 7
  s_cbranch_scc1 ch_init7
  s_branch ch_end
ch_init0:
  s_mul_i32 s31, s17, 401408
  s_add_u32 s31, s31, 0
  s_mov_b32 s24, 71565312
  s_mov_b32 s25, 0
  s_add_u32 m0, s25, 0
  s_nop 0
  buffer_load_dwordx4 v2, s[8:11], s24 offen offset:0 sc1 lds
  buffer_load_dwordx4 v2, s[8:11], s24 offen offset:1024 sc1 lds
  buffer_load_dwordx4 v2, s[8:11], s24 offen offset:2048 sc1 lds
  buffer_load_dwordx4 v2, s[8:11], s24 offen offset:3072 sc1 lds
  s_add_u32 m0, s25, 4096
  s_add_u32 s22, s24, 4096
  buffer_load_dwordx4 v2, s[8:11], s22 offen offset:0 sc1 lds
  buffer_load_dwordx4 v2, s[8:11], s22 offen offset:1024 sc1 lds
  buffer_load_dwordx4 v2, s[8:11], s22 offen offset:2048 sc1 lds
  v_and_b32 v64, 7, v117
  v_and_b32 v65, 1, v116
  v_lshlrev_b32 v65, 2, v65
  v_sub_u32 v64, v64, v65
  v_lshrrev_b32 v65, 3, v117
  v_lshl_add_u32 v66, v65, 2, v64
  v_cmp_gt_u32 vcc, 4, v64
  v_mov_b32 v67, 99
  s_nop 0
  v_cndmask_b32 v66, v67, v66, vcc
  v_mov_b32 v68, 0x3f80
  v_mov_b32 v69, 0x3f800000
  v_mov_b32 v4, 0
  v_cmp_eq_u32 vcc, 0, v66
  s_nop 1
  v_cndmask_b32 v4, v4, v68, vcc
  v_cmp_eq_u32 vcc, 1, v66
  s_nop 1
  v_cndmask_b32 v4, v4, v69, vcc
  v_mov_b32 v5, 0
  v_cmp_eq_u32 vcc, 2, v66
  s_nop 1
  v_cndmask_b32 v5, v5, v68, vcc
  v_cmp_eq_u32 vcc, 3, v66
  s_nop 1
  v_cndmask_b32 v5, v5, v69, vcc
  v_mov_b32 v6, 0
  v_cmp_eq_u32 vcc, 4, v66
  s_nop 1
  v_cndmask_b32 v6, v6, v68, vcc
  v_cmp_eq_u32 vcc, 5, v66
  s_nop 1
  v_cndmask_b32 v6, v6, v69, vcc
  v_mov_b32 v7, 0
  v_cmp_eq_u32 vcc, 6, v66
  s_nop 1
  v_cndmask_b32 v7, v7, v68, vcc
  v_cmp_eq_u32 vcc, 7, v66
  s_nop 1
  v_cndmask_b32 v7, v7, v69, vcc
  v_lshrrev_b32 v64, 1, v116
  v_lshrrev_b32 v65, 3, v117
  v_cmp_eq_u32 s[26:27], v64, v65
  v_and_b32 v66, 1, v116
  v_add_u32 v64, 0, v64
  v_lshrrev_b32 v67, 1, v116
  v_lshlrev_b32 v67, 8, v67
  v_lshl_add_u32 v67, v66, 9, v67
  v_lshl_add_u32 v67, v117, 4, v67
  v_add_u32 v112, 57344, v67
  v_and_b32 v68, 7, v117
  v_lshlrev_b32 v67, 8, v64
  v_lshl_add_u32 v67, v68, 5, v67
  v_lshl_add_u32 v67, v66, 4, v67
  v_add_u32 v113, 65536, v67
  v_lshrrev_b32 v64, 5, v1
  v_and_b32 v65, 31, v1
  v_lshrrev_b32 v66, 3, v65
  v_and_b32 v67, 7, v65
  v_and_b32 v68, 3, v67
  v_lshl_add_u32 v68, v66, 2, v68
  v_lshrrev_b32 v69, 2, v67
  v_lshl_add_u32 v68, v69, 4, v68
  v_lshlrev_b32 v69, 11, v64
  v_lshl_add_u32 v69, v68, 4, v69
  v_add_u32 v114, 57344, v69
  v_add_u32 v70, 0, v64
  v_lshlrev_b32 v69, 9, v66
  v_lshl_add_u32 v69, v70, 5, v69
  v_lshl_add_u32 v69, v67, 2, v69
  v_add_u32 v115, 65536, v69
  v_and_b32 v71, 1, v1
  v_cmp_eq_u32 s[38:39], 0, v71
  v_cmp_gt_u32 vcc, 8, v65
  s_or_b64 s[28:29], s[38:39], vcc
  v_lshrrev_b32 v72, 1, v67
  v_lshlrev_b32 v72, 2, v72
  v_lshl_add_u32 v72, v70, 4, v72
  s_lshl_b32 s22, s17, 9
  s_add_u32 s22, s22, 9216
  v_lshl_add_u32 v73, v66, 7, v72
  v_add_u32 v73, s22, v73
  s_lshl_b32 s22, s17, 7
  s_add_u32 s22, s22, 7168
  v_add_u32 v74, s22, v72
  v_bfe_u32 v72, v65, 1, 1
  v_lshlrev_b32 v72, 7, v72
  v_lshl_add_u32 v72, v70, 4, v72
  v_bfe_u32 v73, v65, 2, 2
  v_lshl_add_u32 v72, v73, 2, v72
  v_lshrrev_b32 v73, 4, v65
  v_lshl_add_u32 v73, v73, 8, v72
  s_lshl_b32 s22, s17, 9
  s_add_u32 s22, s22, 9216
  v_add_u32 v73, s22, v73
  s_lshr_b32 s22, s17, 1
  s_lshl_b32 s22, s22, 8
  s_and_b32 s34, s17, 1
  s_lshl_b32 s34, s34, 3
  s_add_u32 s22, s22, s34
  s_add_u32 s22, s22, 7168
  v_add_u32 v74, s22, v72
  v_lshlrev_b32 v0, 2, v65
  s_and_b32 s22, s17, 31
  s_lshl_b32 s22, s22, 7
  s_add_u32 s22, s22, 21504
  v_add_u32 v0, s22, v0
  v_cndmask_b32 v1, v74, v73, s[38:39]
  s_lshl_b32 s36, s17, 2
  s_add_u32 s36, s36, 17408
  s_mov_b32 s37, 0x3e800000
  v_mov_b32 v64, 0
  v_mov_b32 v65, 0
  v_mov_b32 v66, 0
  v_mov_b32 v67, 0
  v_mov_b32 v68, 0
  v_mov_b32 v69, 0
  v_mov_b32 v70, 0
  v_mov_b32 v71, 0
  v_mov_b32 v72, 0
  v_mov_b32 v73, 0
  v_mov_b32 v74, 0
  v_mov_b32 v75, 0
  v_mov_b32 v76, 0
  v_mov_b32 v77, 0
  v_mov_b32 v78, 0
  v_mov_b32 v79, 0
  v_mov_b32 v80, 0
  v_mov_b32 v81, 0
  v_mov_b32 v82, 0
  v_mov_b32 v83, 0
  v_mov_b32 v84, 0
  v_mov_b32 v85, 0
  v_mov_b32 v86, 0
  v_mov_b32 v87, 0
  v_mov_b32 v88, 0
  v_mov_b32 v89, 0
  v_mov_b32 v90, 0
  v_mov_b32 v91, 0
  v_mov_b32 v92, 0
  v_mov_b32 v93, 0
  v_mov_b32 v94, 0
  v_mov_b32 v95, 0
  v_mov_b32 v96, 0
  v_mov_b32 v97, 0
  v_mov_b32 v98, 0
  v_mov_b32 v99, 0
  v_mov_b32 v100, 0
  v_mov_b32 v101, 0
  v_mov_b32 v102, 0
  v_mov_b32 v103, 0
  v_mov_b32 v104, 0
  v_mov_b32 v105, 0
  v_mov_b32 v106, 0
  v_mov_b32 v107, 0
  v_mov_b32 v108, 0
  v_mov_b32 v109, 0
  v_mov_b32 v110, 0
  v_mov_b32 v111, 0
  v_and_b32 v118, 1, v116
  v_cmp_eq_u32 vcc, 0, v118
  v_mov_b32 v118, 12288
  v_mov_b32 v119, 8192
  v_cndmask_b32 v118, v118, v119, vcc
  v_lshrrev_b32 v116, 1, v116
  v_lshl_add_u32 v118, v116, 9, v118
  v_lshl_add_u32 v117, v117, 4, v118
  s_mov_b32 s57, 28672
  s_mov_b32 s56, 0x42800000
  v_mov_b32 v116, v2
  s_mul_i32 s35, s17, 1835008
  s_add_u32 s35, s35, 42262528
  s_mov_b32 s30, 0
  v_mov_b32 v36, 0
ch_md0:
  buffer_load_dword v37, v36, s[12:15], 0 offen sc1
  s_waitcnt vmcnt(0)
  v_readfirstlane_b32 s22, v37
  s_and_b32 s31, s22, 0xffff
  s_cmp_ge_u32 s31, 32
  s_cbranch_scc1 ch_go0
  s_sleep 2
  s_add_u32 s30, s30, 1
  s_cmp_lt_u32 s30, 50000
  s_cbranch_scc1 ch_md0
  s_branch ch_end
ch_go0:
  s_mov_b32 s31, 0
  s_lshr_b32 s22, s22, 16
  s_cmp_lg_u32 s22, 0
  s_cbranch_scc1 cB_sc0_loop
  s_branch cA_sc0_loop
ch_init1:
  s_mul_i32 s31, s17, 401408
  s_add_u32 s31, s31, 0
  s_mov_b32 s24, 71572480
  s_mov_b32 s25, 0
  s_add_u32 m0, s25, 7168
  s_nop 0
  buffer_load_dwordx4 v2, s[8:11], s24 offen offset:0 sc1 lds
  buffer_load_dwordx4 v2, s[8:11], s24 offen offset:1024 sc1 lds
  buffer_load_dwordx4 v2, s[8:11], s24 offen offset:2048 sc1 lds
  buffer_load_dwordx4 v2, s[8:11], s24 offen offset:3072 sc1 lds
  s_add_u32 m0, s25, 11264
  s_add_u32 s22, s24, 4096
  buffer_load_dwordx4 v2, s[8:11], s22 offen offset:0 sc1 lds
  buffer_load_dwordx4 v2, s[8:11], s22 offen offset:1024 sc1 lds
  buffer_load_dwordx4 v2, s[8:11], s22 offen offset:2048 sc1 lds
  v_and_b32 v64, 7, v117
  v_and_b32 v65, 1, v116
  v_lshlrev_b32 v65, 2, v65
  v_sub_u32 v64, v64, v65
  v_lshrrev_b32 v65, 3, v117
  v_lshl_add_u32 v66, v65, 2, v64
  v_cmp_gt_u32 vcc, 4, v64
  v_mov_b32 v67, 99
  s_nop 0
  v_cndmask_b32 v66, v67, v66, vcc
  v_mov_b32 v68, 0x3f80
  v_mov_b32 v69, 0x3f800000
  v_mov_b32 v4, 0
  v_cmp_eq_u32 vcc, 0, v66
  s_nop 1
  v_cndmask_b32 v4, v4, v68, vcc
  v_cmp_eq_u32 vcc, 1, v66
  s_nop 1
  v_cndmask_b32 v4, v4, v69, vcc
  v_mov_b32 v5, 0
  v_cmp_eq_u32 vcc, 2, v66
  s_nop 1
  v_cndmask_b32 v5, v5, v68, vcc
  v_cmp_eq_u32 vcc, 3, v66
  s_nop 1
  v_cndmask_b32 v5, v5, v69, vcc
  v_mov_b32 v6, 0
  v_cmp_eq_u32 vcc, 4, v66
  s_nop 1
  v_cndmask_b32 v6, v6, v68, vcc
  v_cmp_eq_u32 vcc, 5, v66
  s_nop 1
  v_cndmask_b32 v6, v6, v69, vcc
  v_mov_b32 v7, 0
  v_cmp_eq_u32 vcc, 6, v66
  s_nop 1
  v_cndmask_b32 v7, v7, v68, vcc
  v_cmp_eq_u32 vcc, 7, v66
  s_nop 1
  v_cndmask_b32 v7, v7, v69, vcc
  v_lshrrev_b32 v64, 1, v116
  v_lshrrev_b32 v65, 3, v117
  v_cmp_eq_u32 s[26:27], v64, v65
  v_and_b32 v66, 1, v116
  v_add_u32 v64, 2, v64
  v_lshrrev_b32 v67, 1, v116
  v_lshlrev_b32 v67, 8, v67
  v_lshl_add_u32 v67, v66, 9, v67
  v_lshl_add_u32 v67, v117, 4, v67
  v_add_u32 v112, 58368, v67
  v_and_b32 v68, 7, v117
  v_lshlrev_b32 v67, 8, v64
  v_lshl_add_u32 v67, v68, 5, v67
  v_lshl_add_u32 v67, v66, 4, v67
  v_add_u32 v113, 65536, v67
  v_lshrrev_b32 v64, 5, v1
  v_and_b32 v65, 31, v1
  v_lshrrev_b32 v66, 3, v65
  v_and_b32 v67, 7, v65
  v_and_b32 v68, 3, v67
  v_lshl_add_u32 v68, v66, 2, v68
  v_lshrrev_b32 v69, 2, v67
  v_lshl_add_u32 v68, v69, 4, v68
  v_lshlrev_b32 v69, 11, v64
  v_lshl_add_u32 v69, v68, 4, v69
  v_add_u32 v114, 57352, v69
  v_add_u32 v70, 2, v64
  v_lshlrev_b32 v69, 9, v66
  v_lshl_add_u32 v69, v70, 5, v69
  v_lshl_add_u32 v69, v67, 2, v69
  v_add_u32 v115, 65536, v69
  v_and_b32 v71, 1, v1
  v_cmp_eq_u32 s[38:39], 0, v71
  v_cmp_gt_u32 vcc, 8, v65
  s_or_b64 s[28:29], s[38:39], vcc
  v_lshrrev_b32 v72, 1, v67
  v_lshlrev_b32 v72, 2, v72
  v_lshl_add_u32 v72, v70, 4, v72
  s_lshl_b32 s22, s17, 9
  s_add_u32 s22, s22, 9216
  v_lshl_add_u32 v73, v66, 7, v72
  v_add_u32 v73, s22, v73
  s_lshl_b32 s22, s17, 7
  s_add_u32 s22, s22, 7168
  v_add_u32 v74, s22, v72
  v_bfe_u32 v72, v65, 1, 1
  v_lshlrev_b32 v72, 7, v72
  v_lshl_add_u32 v72, v70, 4, v72
  v_bfe_u32 v73, v65, 2, 2
  v_lshl_add_u32 v72, v73, 2, v72
  v_lshrrev_b32 v73, 4, v65
  v_lshl_add_u32 v73, v73, 8, v72
  s_lshl_b32 s22, s17, 9
  s_add_u32 s22, s22, 9216
  v_add_u32 v73, s22, v73
  s_lshr_b32 s22, s17, 1
  s_lshl_b32 s22, s22, 8
  s_and_b32 s34, s17, 1
  s_lshl_b32 s34, s34, 3
  s_add_u32 s22, s22, s34
  s_add_u32 s22, s22, 7168
  v_add_u32 v74, s22, v72
  v_lshlrev_b32 v0, 2, v65
  s_and_b32 s22, s17, 31
  s_lshl_b32 s22, s22, 7
  s_add_u32 s22, s22, 21504
  v_add_u32 v0, s22, v0
  v_cndmask_b32 v1, v74, v73, s[38:39]
  s_lshl_b32 s36, s17, 2
  s_add_u32 s36, s36, 17408
  s_mov_b32 s37, 0x3e800000
  v_mov_b32 v64, 0
  v_mov_b32 v65, 0
  v_mov_b32 v66, 0
  v_mov_b32 v67, 0
  v_mov_b32 v68, 0
  v_mov_b32 v69, 0
  v_mov_b32 v70, 0
  v_mov_b32 v71, 0
  v_mov_b32 v72, 0
  v_mov_b32 v73, 0
  v_mov_b32 v74, 0
  v_mov_b32 v75, 0
  v_mov_b32 v76, 0
  v_mov_b32 v77, 0
  v_mov_b32 v78, 0
  v_mov_b32 v79, 0
  v_mov_b32 v80, 0
  v_mov_b32 v81, 0
  v_mov_b32 v82, 0
  v_mov_b32 v83, 0
  v_mov_b32 v84, 0
  v_mov_b32 v85, 0
  v_mov_b32 v86, 0
  v_mov_b32 v87, 0
  v_mov_b32 v88, 0
  v_mov_b32 v89, 0
  v_mov_b32 v90, 0
  v_mov_b32 v91, 0
  v_mov_b32 v92, 0
  v_mov_b32 v93, 0
  v_mov_b32 v94, 0
  v_mov_b32 v95, 0
  v_mov_b32 v96, 0
  v_mov_b32 v97, 0
  v_mov_b32 v98, 0
  v_mov_b32 v99, 0
  v_mov_b32 v100, 0
  v_mov_b32 v101, 0
  v_mov_b32 v102, 0
  v_mov_b32 v103, 0
  v_mov_b32 v104, 0
  v_mov_b32 v105, 0
  v_mov_b32 v106, 0
  v_mov_b32 v107, 0
  v_mov_b32 v108, 0
  v_mov_b32 v109, 0
  v_mov_b32 v110, 0
  v_mov_b32 v111, 0
  v_and_b32 v118, 1, v116
  v_cmp_eq_u32 vcc, 0, v118
  v_mov_b32 v118, 12288
  v_mov_b32 v119, 8448
  v_cndmask_b32 v118, v118, v119, vcc
  v_lshrrev_b32 v116, 1, v116
  v_lshl_add_u32 v118, v116, 9, v118
  v_lshl_add_u32 v117, v117, 4, v118
  s_mov_b32 s57, 28672
  s_mov_b32 s56, 0x42800000
  v_mov_b32 v116, v2
  v_lshrrev_b32 v0, 4, v2
  v_min_u32 v0, 12, v0
  s_mul_i32 s22, s17, 13
  v_add_u32 v0, s22, v0
  v_lshlrev_b32 v0, 7, v0
  v_add_u32 v0, 51200, v0
  s_mov_b32 s22, 75209728
  buffer_load_dword v119, v0, s[8:11], s22 offen sc1
  s_mov_b32 s22, 75184128
  buffer_load_dword v119, v0, s[8:11], s22 offen sc1
  s_mul_i32 s35, s17, 1835008
  s_add_u32 s35, s35, 42269696
  s_mov_b32 s30, 0
  v_mov_b32 v36, 0
ch_md1:
  buffer_load_dword v37, v36, s[12:15], 0 offen sc1
  s_waitcnt vmcnt(0)
  v_readfirstlane_b32 s22, v37
  s_and_b32 s31, s22, 0xffff
  s_cmp_ge_u32 s31, 32
  s_cbranch_scc1 ch_go1
  s_sleep 2
  s_add_u32 s30, s30, 1
  s_cmp_lt_u32 s30, 50000
  s_cbranch_scc1 ch_md1
  s_branch ch_end
ch_go1:
  s_mov_b32 s31, 0
  s_lshr_b32 s22, s22, 16
  s_cmp_lg_u32 s22, 0
  s_cbranch_scc1 cB_sc1_loop
  s_branch cA_sc1_loop
ch_init2:
  s_mul_i32 s31, s17, 401408
  s_add_u32 s31, s31, 0
  s_mov_b32 s24, 71579648
  s_mov_b32 s25, 0
  s_add_u32 m0, s25, 14336
  s_nop 0
  buffer_load_dwordx4 v2, s[8:11], s24 offen offset:0 sc1 lds
  buffer_load_dwordx4 v2, s[8:11], s24 offen offset:1024 sc1 lds
  buffer_load_dwordx4 v2, s[8:11], s24 offen offset:2048 sc1 lds
  buffer_load_dwordx4 v2, s[8:11], s24 offen offset:3072 sc1 lds
  s_add_u32 m0, s25, 18432
  s_add_u32 s22, s24, 4096
  buffer_load_dwordx4 v2, s[8:11], s22 offen offset:0 sc1 lds
  buffer_load_dwordx4 v2, s[8:11], s22 offen offset:1024 sc1 lds
  buffer_load_dwordx4 v2, s[8:11], s22 offen offset:2048 sc1 lds
  v_and_b32 v64, 7, v117
  v_and_b32 v65, 1, v116
  v_lshlrev_b32 v65, 2, v65
  v_sub_u32 v64, v64, v65
  v_lshrrev_b32 v65, 3, v117
  v_lshl_add_u32 v66, v65, 2, v64
  v_cmp_gt_u32 vcc, 4, v64
  v_mov_b32 v67, 99
  s_nop 0
  v_cndmask_b32 v66, v67, v66, vcc
  v_mov_b32 v68, 0x3f80
  v_mov_b32 v69, 0x3f800000
  v_mov_b32 v4, 0
  v_cmp_eq_u32 vcc, 0, v66
  s_nop 1
  v_cndmask_b32 v4, v4, v68, vcc
  v_cmp_eq_u32 vcc, 1, v66
  s_nop 1
  v_cndmask_b32 v4, v4, v69, vcc
  v_mov_b32 v5, 0
  v_cmp_eq_u32 vcc, 2, v66
  s_nop 1
  v_cndmask_b32 v5, v5, v68, vcc
  v_cmp_eq_u32 vcc, 3, v66
  s_nop 1
  v_cndmask_b32 v5, v5, v69, vcc
  v_mov_b32 v6, 0
  v_cmp_eq_u32 vcc, 4, v66
  s_nop 1
  v_cndmask_b32 v6, v6, v68, vcc
  v_cmp_eq_u32 vcc, 5, v66
  s_nop 1
  v_cndmask_b32 v6, v6, v69, vcc
  v_mov_b32 v7, 0
  v_cmp_eq_u32 vcc, 6, v66
  s_nop 1
  v_cndmask_b32 v7, v7, v68, vcc
  v_cmp_eq_u32 vcc, 7, v66
  s_nop 1
  v_cndmask_b32 v7, v7, v69, vcc
  v_lshrrev_b32 v64, 1, v116
  v_lshrrev_b32 v65, 3, v117
  v_cmp_eq_u32 s[26:27], v64, v65
  v_and_b32 v66, 1, v116
  v_add_u32 v64, 4, v64
  v_lshrrev_b32 v67, 1, v116
  v_lshlrev_b32 v67, 8, v67
  v_lshl_add_u32 v67, v66, 9, v67
  v_lshl_add_u32 v67, v117, 4, v67
  v_add_u32 v112, 59392, v67
  v_and_b32 v68, 7, v117
  v_lshlrev_b32 v67, 8, v64
  v_lshl_add_u32 v67, v68, 5, v67
  v_lshl_add_u32 v67, v66, 4, v67
  v_add_u32 v113, 65536, v67
  v_lshrrev_b32 v64, 5, v1
  v_and_b32 v65, 31, v1
  v_lshrrev_b32 v66, 3, v65
  v_and_b32 v67, 7, v65
  v_and_b32 v68, 3, v67
  v_lshl_add_u32 v68, v66, 2, v68
  v_lshrrev_b32 v69, 2, v67
  v_lshl_add_u32 v68, v69, 4, v68
  v_lshlrev_b32 v69, 11, v64
  v_lshl_add_u32 v69, v68, 4, v69
  v_add_u32 v114, 57856, v69
  v_add_u32 v70, 4, v64
  v_lshlrev_b32 v69, 9, v66
  v_lshl_add_u32 v69, v70, 5, v69
  v_lshl_add_u32 v69, v67, 2, v69
  v_add_u32 v115, 65536, v69
  v_and_b32 v71, 1, v1
  v_cmp_eq_u32 s[38:39], 0, v71
  v_cmp_gt_u32 vcc, 8, v65
  s_or_b64 s[28:29], s[38:39], vcc
  v_lshrrev_b32 v72, 1, v67
  v_lshlrev_b32 v72, 2, v72
  v_lshl_add_u32 v72, v70, 4, v72
  s_lshl_b32 s22, s17, 9
  s_add_u32 s22, s22, 9216
  v_lshl_add_u32 v73, v66, 7, v72
  v_add_u32 v73, s22, v73
  s_lshl_b32 s22, s17, 7
  s_add_u32 s22, s22, 7168
  v_add_u32 v74, s22, v72
  v_bfe_u32 v72, v65, 1, 1
  v_lshlrev_b32 v72, 7, v72
  v_lshl_add_u32 v72, v70, 4, v72
  v_bfe_u32 v73, v65, 2, 2
  v_lshl_add_u32 v72, v73, 2, v72
  v_lshrrev_b32 v73, 4, v65
  v_lshl_add_u32 v73, v73, 8, v72
  s_lshl_b32 s22, s17, 9
  s_add_u32 s22, s22, 9216
  v_add_u32 v73, s22, v73
  s_lshr_b32 s22, s17, 1
  s_lshl_b32 s22, s22, 8
  s_and_b32 s34, s17, 1
  s_lshl_b32 s34, s34, 3
  s_add_u32 s22, s22, s34
  s_add_u32 s22, s22, 7168
  v_add_u32 v74, s22, v72
  v_lshlrev_b32 v0, 2, v65
  s_and_b32 s22, s17, 31
  s_lshl_b32 s22, s22, 7
  s_add_u32 s22, s22, 21504
  v_add_u32 v0, s22, v0
  v_cndmask_b32 v1, v74, v73, s[38:39]
  s_lshl_b32 s36, s17, 2
  s_add_u32 s36, s36, 17408
  s_mov_b32 s37, 0x3e800000
  v_mov_b32 v64, 0
  v_mov_b32 v65, 0
  v_mov_b32 v66, 0
  v_mov_b32 v67, 0
  v_mov_b32 v68, 0
  v_mov_b32 v69, 0
  v_mov_b32 v70, 0
  v_mov_b32 v71, 0
  v_mov_b32 v72, 0
  v_mov_b32 v73, 0
  v_mov_b32 v74, 0
  v_mov_b32 v75, 0
  v_mov_b32 v76, 0
  v_mov_b32 v77, 0
  v_mov_b32 v78, 0
  v_mov_b32 v79, 0
  v_mov_b32 v80, 0
  v_mov_b32 v81, 0
  v_mov_b32 v82, 0
  v_mov_b32 v83, 0
  v_mov_b32 v84, 0
  v_mov_b32 v85, 0
  v_mov_b32 v86, 0
  v_mov_b32 v87, 0
  v_mov_b32 v88, 0
  v_mov_b32 v89, 0
  v_mov_b32 v90, 0
  v_mov_b32 v91, 0
  v_mov_b32 v92, 0
  v_mov_b32 v93, 0
  v_mov_b32 v94, 0
  v_mov_b32 v95, 0
  v_mov_b32 v96, 0
  v_mov_b32 v97, 0
  v_mov_b32 v98, 0
  v_mov_b32 v99, 0
  v_mov_b32 v100, 0
  v_mov_b32 v101, 0
  v_mov_b32 v102, 0
  v_mov_b32 v103, 0
  v_mov_b32 v104, 0
  v_mov_b32 v105, 0
  v_mov_b32 v106, 0
  v_mov_b32 v107, 0
  v_mov_b32 v108, 0
  v_mov_b32 v109, 0
  v_mov_b32 v110, 0
  v_mov_b32 v111, 0
  v_and_b32 v118, 1, v116
  v_cmp_eq_u32 vcc, 0, v118
  v_mov_b32 v118, 12544
  v_mov_b32 v119, 10240
  v_cndmask_b32 v118, v118, v119, vcc
  v_lshrrev_b32 v116, 1, v116
  v_lshl_add_u32 v118, v116, 9, v118
  v_lshl_add_u32 v117, v117, 4, v118
  s_mov_b32 s57, 28672
  s_mov_b32 s56, 0x42800000
  v_mov_b32 v116, v2
  v_lshrrev_b32 v0, 4, v2
  v_min_u32 v0, 13, v0
  s_mul_i32 s22, s17, 14
  v_add_u32 v0, s22, v0
  v_lshlrev_b32 v0, 7, v0
  v_add_u32 v0, 43008, v0
  s_mov_b32 s22, 71550976
  buffer_load_dword v119, v0, s[8:11], s22 offen sc1
  s_mov_b32 s22, 71522304
  buffer_load_dword v119, v0, s[8:11], s22 offen sc1
  s_mul_i32 s35, s17, 1835008
  s_add_u32 s35, s35, 42276864
  s_mov_b32 s30, 0
  v_mov_b32 v36, 0
ch_md2:
  buffer_load_dword v37, v36, s[12:15], 0 offen sc1
  s_waitcnt vmcnt(0)
  v_readfirstlane_b32 s22, v37
  s_and_b32 s31, s22, 0xffff
  s_cmp_ge_u32 s31, 32
  s_cbranch_scc1 ch_go2
  s_sleep 2
  s_add_u32 s30, s30, 1
  s_cmp_lt_u32 s30, 50000
  s_cbranch_scc1 ch_md2
  s_branch ch_end
ch_go2:
  s_mov_b32 s31, 0
  s_lshr_b32 s22, s22, 16
  s_cmp_lg_u32 s22, 0
  s_cbranch_scc1 cB_sc2_loop
  s_branch cA_sc2_loop
ch_init3:
  s_mul_i32 s31, s17, 401408
  s_add_u32 s31, s31, 0
  s_mov_b32 s24, 71586816
  s_mov_b32 s25, 0
  s_add_u32 m0, s25, 21504
  s_nop 0
  buffer_load_dwordx4 v2, s[8:11], s24 offen offset:0 sc1 lds
  buffer_load_dwordx4 v2, s[8:11], s24 offen offset:1024 sc1 lds
  buffer_load_dwordx4 v2, s[8:11], s24 offen offset:2048 sc1 lds
  buffer_load_dwordx4 v2, s[8:11], s24 offen offset:3072 sc1 lds
  s_add_u32 m0, s25, 25600
  s_add_u32 s22, s24, 4096
  buffer_load_dwordx4 v2, s[8:11], s22 offen offset:0 sc1 lds
  buffer_load_dwordx4 v2, s[8:11], s22 offen offset:1024 sc1 lds
  buffer_load_dwordx4 v2, s[8:11], s22 offen offset:2048 sc1 lds
  v_and_b32 v64, 7, v117
  v_and_b32 v65, 1, v116
  v_lshlrev_b32 v65, 2, v65
  v_sub_u32 v64, v64, v65
  v_lshrrev_b32 v65, 3, v117
  v_lshl_add_u32 v66, v65, 2, v64
  v_cmp_gt_u32 vcc, 4, v64
  v_mov_b32 v67, 99
  s_nop 0
  v_cndmask_b32 v66, v67, v66, vcc
  v_mov_b32 v68, 0x3f80
  v_mov_b32 v69, 0x3f800000
  v_mov_b32 v4, 0
  v_cmp_eq_u32 vcc, 0, v66
  s_nop 1
  v_cndmask_b32 v4, v4, v68, vcc
  v_cmp_eq_u32 vcc, 1, v66
  s_nop 1
  v_cndmask_b32 v4, v4, v69, vcc
  v_mov_b32 v5, 0
  v_cmp_eq_u32 vcc, 2, v66
  s_nop 1
  v_cndmask_b32 v5, v5, v68, vcc
  v_cmp_eq_u32 vcc, 3, v66
  s_nop 1
  v_cndmask_b32 v5, v5, v69, vcc
  v_mov_b32 v6, 0
  v_cmp_eq_u32 vcc, 4, v66
  s_nop 1
  v_cndmask_b32 v6, v6, v68, vcc
  v_cmp_eq_u32 vcc, 5, v66
  s_nop 1
  v_cndmask_b32 v6, v6, v69, vcc
  v_mov_b32 v7, 0
  v_cmp_eq_u32 vcc, 6, v66
  s_nop 1
  v_cndmask_b32 v7, v7, v68, vcc
  v_cmp_eq_u32 vcc, 7, v66
  s_nop 1
  v_cndmask_b32 v7, v7, v69, vcc
  v_lshrrev_b32 v64, 1, v116
  v_lshrrev_b32 v65, 3, v117
  v_cmp_eq_u32 s[26:27], v64, v65
  v_and_b32 v66, 1, v116
  v_add_u32 v64, 6, v64
  v_lshrrev_b32 v67, 1, v116
  v_lshlrev_b32 v67, 8, v67
  v_lshl_add_u32 v67, v66, 9, v67
  v_lshl_add_u32 v67, v117, 4, v67
  v_add_u32 v112, 60416, v67
  v_and_b32 v68, 7, v117
  v_lshlrev_b32 v67, 8, v64
  v_lshl_add_u32 v67, v68, 5, v67
  v_lshl_add_u32 v67, v66, 4, v67
  v_add_u32 v113, 65536, v67
  v_lshrrev_b32 v64, 5, v1
  v_and_b32 v65, 31, v1
  v_lshrrev_b32 v66, 3, v65
  v_and_b32 v67, 7, v65
  v_and_b32 v68, 3, v67
  v_lshl_add_u32 v68, v66, 2, v68
  v_lshrrev_b32 v69, 2, v67
  v_lshl_add_u32 v68, v69, 4, v68
  v_lshlrev_b32 v69, 11, v64
  v_lshl_add_u32 v69, v68, 4, v69
  v_add_u32 v114, 57864, v69
  v_add_u32 v70, 6, v64
  v_lshlrev_b32 v69, 9, v66
  v_lshl_add_u32 v69, v70, 5, v69
  v_lshl_add_u32 v69, v67, 2, v69
  v_add_u32 v115, 65536, v69
  v_and_b32 v71, 1, v1
  v_cmp_eq_u32 s[38:39], 0, v71
  v_cmp_gt_u32 vcc, 8, v65
  s_or_b64 s[28:29], s[38:39], vcc
  v_lshrrev_b32 v72, 1, v67
  v_lshlrev_b32 v72, 2, v72
  v_lshl_add_u32 v72, v70, 4, v72
  s_lshl_b32 s22, s17, 9
  s_add_u32 s22, s22, 9216
  v_lshl_add_u32 v73, v66, 7, v72
  v_add_u32 v73, s22, v73
  s_lshl_b32 s22, s17, 7
  s_add_u32 s22, s22, 7168
  v_add_u32 v74, s22, v72
  v_bfe_u32 v72, v65, 1, 1
  v_lshlrev_b32 v72, 7, v72
  v_lshl_add_u32 v72, v70, 4, v72
  v_bfe_u32 v73, v65, 2, 2
  v_lshl_add_u32 v72, v73, 2, v72
  v_lshrrev_b32 v73, 4, v65
  v_lshl_add_u32 v73, v73, 8, v72
  s_lshl_b32 s22, s17, 9
  s_add_u32 s22, s22, 9216
  v_add_u32 v73, s22, v73
  s_lshr_b32 s22, s17, 1
  s_lshl_b32 s22, s22, 8
  s_and_b32 s34, s17, 1
  s_lshl_b32 s34, s34, 3
  s_add_u32 s22, s22, s34
  s_add_u32 s22, s22, 7168
  v_add_u32 v74, s22, v72
  v_lshlrev_b32 v0, 2, v65
  s_and_b32 s22, s17, 31
  s_lshl_b32 s22, s22, 7
  s_add_u32 s22, s22, 21504
  v_add_u32 v0, s22, v0
  v_cndmask_b32 v1, v74, v73, s[38:39]
  s_lshl_b32 s36, s17, 2
  s_add_u32 s36, s36, 17408
  s_mov_b32 s37, 0x3e800000
  v_mov_b32 v64, 0
  v_mov_b32 v65, 0
  v_mov_b32 v66, 0
  v_mov_b32 v67, 0
  v_mov_b32 v68, 0
  v_mov_b32 v69, 0
  v_mov_b32 v70, 0
  v_mov_b32 v71, 0
  v_mov_b32 v72, 0
  v_mov_b32 v73, 0
  v_mov_b32 v74, 0
  v_mov_b32 v75, 0
  v_mov_b32 v76, 0
  v_mov_b32 v77, 0
  v_mov_b32 v78, 0
  v_mov_b32 v79, 0
  v_mov_b32 v80, 0
  v_mov_b32 v81, 0
  v_mov_b32 v82, 0
  v_mov_b32 v83, 0
  v_mov_b32 v84, 0
  v_mov_b32 v85, 0
  v_mov_b32 v86, 0
  v_mov_b32 v87, 0
  v_mov_b32 v88, 0
  v_mov_b32 v89, 0
  v_mov_b32 v90, 0
  v_mov_b32 v91, 0
  v_mov_b32 v92, 0
  v_mov_b32 v93, 0
  v_mov_b32 v94, 0
  v_mov_b32 v95, 0
  v_mov_b32 v96, 0
  v_mov_b32 v97, 0
  v_mov_b32 v98, 0
  v_mov_b32 v99, 0
  v_mov_b32 v100, 0
  v_mov_b32 v101, 0
  v_mov_b32 v102, 0
  v_mov_b32 v103, 0
  v_mov_b32 v104, 0
  v_mov_b32 v105, 0
  v_mov_b32 v106, 0
  v_mov_b32 v107, 0
  v_mov_b32 v108, 0
  v_mov_b32 v109, 0
  v_mov_b32 v110, 0
  v_mov_b32 v111, 0
  v_and_b32 v118, 1, v116
  v_cmp_eq_u32 vcc, 0, v118
  v_mov_b32 v118, 12544
  v_mov_b32 v119, 10496
  v_cndmask_b32 v118, v118, v119, vcc
  v_lshrrev_b32 v116, 1, v116
  v_lshl_add_u32 v118, v116, 9, v118
  v_lshl_add_u32 v117, v117, 4, v118
  s_mov_b32 s57, 28672
  s_mov_b32 s56, 0x42800000
  v_mov_b32 v116, v2
  s_mul_i32 s35, s17, 1835008
  s_add_u32 s35, s35, 42284032
  s_mov_b32 s30, 0
  v_mov_b32 v36, 0
ch_md3:
  buffer_load_dword v37, v36, s[12:15], 0 offen sc1
  s_waitcnt vmcnt(0)
  v_readfirstlane_b32 s22, v37
  s_and_b32 s31, s22, 0xffff
  s_cmp_ge_u32 s31, 32
  s_cbranch_scc1 ch_go3
  s_sleep 2
  s_add_u32 s30, s30, 1
  s_cmp_lt_u32 s30, 50000
  s_cbranch_scc1 ch_md3
  s_branch ch_end
ch_go3:
  s_mov_b32 s31, 0
  s_lshr_b32 s22, s22, 16
  s_cmp_lg_u32 s22, 0
  s_cbranch_scc1 cB_sc3_loop
  s_branch cA_sc3_loop
ch_init4:
  s_mul_i32 s31, s17, 401408
  s_add_u32 s31, s31, 6422528
  s_mul_i32 s22, s17, 28
  s_add_u32 s23, s22, 27
  s_lshr_b32 s22, s22, 6
  s_lshr_b32 s23, s23, 6
  s_sub_u32 s23, s23, s22
  s_lshl_b32 s23, s23, 8
  v_and_b32 v36, s23, v2
  v_med3_u32 v37, v117, 0, 3
  v_lshl_add_u32 v36, v37, 4, v36
  s_lshl_b32 s22, s22, 8
  s_add_u32 s22, s22, 88588288
  s_mov_b32 s30, 0
va_bw_11:
  buffer_load_dwordx4 v[40:43], v36, s[8:11], s22 offen sc1
  s_waitcnt vmcnt(0)
  v_cmp_ne_u64 vcc, s[88:89], v[40:41]
  s_cbranch_vccnz va_bw_11_no
  v_cmp_ne_u64 vcc, s[88:89], v[42:43]
  s_cbranch_vccnz va_bw_11_no
  s_branch va_bw_11_ok
va_bw_11_no:
  s_sleep 2
  s_add_u32 s30, s30, 1
  s_cmp_lt_u32 s30, 50000
  s_cbranch_scc1 va_bw_11
  s_branch cA_abort
va_bw_11_ok:
  s_add_u32 s22, s31, 0
  buffer_load_dwordx4 a[0:3], v2, s[8:11], s22 offen offset:0 sc1
  buffer_load_dwordx4 a[4:7], v2, s[8:11], s22 offen offset:1024 sc1
  buffer_load_dwordx4 a[8:11], v2, s[8:11], s22 offen offset:2048 sc1
  buffer_load_dwordx4 a[12:15], v2, s[8:11], s22 offen offset:3072 sc1
  s_add_u32 s22, s31, 4096
  buffer_load_dwordx4 a[16:19], v2, s[8:11], s22 offen offset:0 sc1
  buffer_load_dwordx4 a[20:23], v2, s[8:11], s22 offen offset:1024 sc1
  buffer_load_dwordx4 a[24:27], v2, s[8:11], s22 offen offset:2048 sc1
  buffer_load_dwordx4 a[28:31], v2, s[8:11], s22 offen offset:3072 sc1
  s_add_u32 s22, s31, 8192
  buffer_load_dwordx4 a[32:35], v2, s[8:11], s22 offen offset:0 sc1
  buffer_load_dwordx4 a[36:39], v2, s[8:11], s22 offen offset:1024 sc1
  buffer_load_dwordx4 a[40:43], v2, s[8:11], s22 offen offset:2048 sc1
  buffer_load_dwordx4 a[44:47], v2, s[8:11], s22 offen offset:3072 sc1
  s_add_u32 s22, s31, 12288
  buffer_load_dwordx4 a[48:51], v2, s[8:11], s22 offen offset:0 sc1
  buffer_load_dwordx4 a[52:55], v2, s[8:11], s22 offen offset:1024 sc1
  buffer_load_dwordx4 a[56:59], v2, s[8:11], s22 offen offset:2048 sc1
  buffer_load_dwordx4 a[60:63], v2, s[8:11], s22 offen offset:3072 sc1
  s_add_u32 s22, s31, 16384
  buffer_load_dwordx4 a[64:67], v2, s[8:11], s22 offen offset:0 sc1
  buffer_load_dwordx4 a[68:71], v2, s[8:11], s22 offen offset:1024 sc1
  buffer_load_dwordx4 a[72:75], v2, s[8:11], s22 offen offset:2048 sc1
  buffer_load_dwordx4 a[76:79], v2, s[8:11], s22 offen offset:3072 sc1
  s_add_u32 s22, s31, 20480
  buffer_load_dwordx4 a[80:83], v2, s[8:11], s22 offen offset:0 sc1
  buffer_load_dwordx4 a[84:87], v2, s[8:11], s22 offen offset:1024 sc1
  buffer_load_dwordx4 a[88:91], v2, s[8:11], s22 offen offset:2048 sc1
  buffer_load_dwordx4 a[92:95], v2, s[8:11], s22 offen offset:3072 sc1
  s_add_u32 s22, s31, 24576
  buffer_load_dwordx4 a[96:99], v2, s[8:11], s22 offen offset:0 sc1
  buffer_load_dwordx4 a[100:103], v2, s[8:11], s22 offen offset:1024 sc1
  buffer_load_dwordx4 a[104:107], v2, s[8:11], s22 offen offset:2048 sc1
  buffer_load_dwordx4 a[108:111], v2, s[8:11], s22 offen offset:3072 sc1
  s_add_u32 s22, s31, 28672
  buffer_load_dwordx4 a[112:115], v2, s[8:11], s22 offen offset:0 sc1
  buffer_load_dwordx4 a[116:119], v2, s[8:11], s22 offen offset:1024 sc1
  buffer_load_dwordx4 a[120:123], v2, s[8:11], s22 offen offset:2048 sc1
  buffer_load_dwordx4 a[124:127], v2, s[8:11], s22 offen offset:3072 sc1
  s_waitcnt vmcnt(24)
  s_add_u32 s22, s31, 32768
  buffer_load_dwordx4 a[128:131], v2, s[8:11], s22 offen offset:0 sc1
  buffer_load_dwordx4 a[132:135], v2, s[8:11], s22 offen offset:1024 sc1
  buffer_load_dwordx4 a[136:139], v2, s[8:11], s22 offen offset:2048 sc1
  buffer_load_dwordx4 a[140:143], v2, s[8:11], s22 offen offset:3072 sc1
  s_add_u32 s22, s31, 36864
  buffer_load_dwordx4 a[144:147], v2, s[8:11], s22 offen offset:0 sc1
  buffer_load_dwordx4 a[148:151], v2, s[8:11], s22 offen offset:1024 sc1
  buffer_load_dwordx4 a[152:155], v2, s[8:11], s22 offen offset:2048 sc1
  buffer_load_dwordx4 a[156:159], v2, s[8:11], s22 offen offset:3072 sc1
  s_add_u32 s22, s31, 40960
  buffer_load_dwordx4 a[160:163], v2, s[8:11], s22 offen offset:0 sc1
  buffer_load_dwordx4 a[164:167], v2, s[8:11], s22 offen offset:1024 sc1
  buffer_load_dwordx4 a[168:171], v2, s[8:11], s22 offen offset:2048 sc1
  buffer_load_dwordx4 a[172:175], v2, s[8:11], s22 offen offset:3072 sc1
  s_add_u32 s22, s31, 45056
  buffer_load_dwordx4 a[176:179], v2, s[8:11], s22 offen offset:0 sc1
  buffer_load_dwordx4 a[180:183], v2, s[8:11], s22 offen offset:1024 sc1
  buffer_load_dwordx4 a[184:187], v2, s[8:11], s22 offen offset:2048 sc1
  buffer_load_dwordx4 a[188:191], v2, s[8:11], s22 offen offset:3072 sc1
  s_add_u32 s22, s31, 49152
  buffer_load_dwordx4 a[192:195], v2, s[8:11], s22 offen offset:0 sc1
  buffer_load_dwordx4 a[196:199], v2, s[8:11], s22 offen offset:1024 sc1
  buffer_load_dwordx4 a[200:203], v2, s[8:11], s22 offen offset:2048 sc1
  buffer_load_dwordx4 a[204:207], v2, s[8:11], s22 offen offset:3072 sc1
  s_add_u32 s22, s31, 53248
  buffer_load_dwordx4 a[208:211], v2, s[8:11], s22 offen offset:0 sc1
  buffer_load_dwordx4 a[212:215], v2, s[8:11], s22 offen offset:1024 sc1
  buffer_load_dwordx4 a[216:219], v2, s[8:11], s22 offen offset:2048 sc1
  buffer_load_dwordx4 a[220:223], v2, s[8:11], s22 offen offset:3072 sc1
  s_add_u32 s22, s31, 57344
  buffer_load_dwordx4 a[224:227], v2, s[8:11], s22 offen offset:0 sc1
  buffer_load_dwordx4 a[228:231], v2, s[8:11], s22 offen offset:1024 sc1
  buffer_load_dwordx4 a[232:235], v2, s[8:11], s22 offen offset:2048 sc1
  buffer_load_dwordx4 a[236:239], v2, s[8:11], s22 offen offset:3072 sc1
  s_add_u32 s22, s31, 61440
  buffer_load_dwordx4 a[240:243], v2, s[8:11], s22 offen offset:0 sc1
  buffer_load_dwordx4 a[244:247], v2, s[8:11], s22 offen offset:1024 sc1
  buffer_load_dwordx4 a[248:251], v2, s[8:11], s22 offen offset:2048 sc1
  buffer_load_dwordx4 a[252:255], v2, s[8:11], s22 offen offset:3072 sc1
  s_waitcnt vmcnt(24)
  s_add_u32 s22, s31, 65536
  buffer_load_dwordx4 v[176:179], v2, s[8:11], s22 offen offset:0 sc1
  buffer_load_dwordx4 v[180:183], v2, s[8:11], s22 offen offset:1024 sc1
  buffer_load_dwordx4 v[184:187], v2, s[8:11], s22 offen offset:2048 sc1
  buffer_load_dwordx4 v[188:191], v2, s[8:11], s22 offen offset:3072 sc1
  s_add_u32 s22, s31, 69632
  buffer_load_dwordx4 v[192:195], v2, s[8:11], s22 offen offset:0 sc1
  buffer_load_dwordx4 v[196:199], v2, s[8:11], s22 offen offset:1024 sc1
  buffer_load_dwordx4 v[200:203], v2, s[8:11], s22 offen offset:2048 sc1
  buffer_load_dwordx4 v[204:207], v2, s[8:11], s22 offen offset:3072 sc1
  s_add_u32 s22, s31, 73728
  buffer_load_dwordx4 v[208:211], v2, s[8:11], s22 offen offset:0 sc1
  buffer_load_dwordx4 v[212:215], v2, s[8:11], s22 offen offset:1024 sc1
  buffer_load_dwordx4 v[216:219], v2, s[8:11], s22 offen offset:2048 sc1
  buffer_load_dwordx4 v[220:223], v2, s[8:11], s22 offen offset:3072 sc1
  s_add_u32 s22, s31, 77824
  buffer_load_dwordx4 v[224:227], v2, s[8:11], s22 offen offset:0 sc1
  buffer_load_dwordx4 v[228:231], v2, s[8:11], s22 offen offset:1024 sc1
  buffer_load_dwordx4 v[232:235], v2, s[8:11], s22 offen offset:2048 sc1
  buffer_load_dwordx4 v[236:239], v2, s[8:11], s22 offen offset:3072 sc1
  s_add_u32 s22, s31, 81920
  buffer_load_dwordx4 v[240:243], v2, s[8:11], s22 offen offset:0 sc1
  buffer_load_dwordx4 v[244:247], v2, s[8:11], s22 offen offset:1024 sc1
  buffer_load_dwordx4 v[248:251], v2, s[8:11], s22 offen offset:2048 sc1
  buffer_load_dwordx4 v[252:255], v2, s[8:11], s22 offen offset:3072 sc1
  s_mul_i32 s22, s17, 28
  s_add_u32 s23, s22, 27
  s_lshr_b32 s22, s22, 6
  s_lshr_b32 s23, s23, 6
  s_sub_u32 s23, s23, s22
  s_lshl_b32 s23, s23, 8
  v_and_b32 v36, s23, v2
  v_med3_u32 v37, v117, 10, 11
  v_lshl_add_u32 v36, v37, 4, v36
  s_lshl_b32 s22, s22, 8
  s_add_u32 s22, s22, 88588288
  s_mov_b32 s30, 0
va_bw_12:
  buffer_load_dwordx4 v[40:43], v36, s[8:11], s22 offen sc1
  s_waitcnt vmcnt(0)
  v_cmp_ne_u64 vcc, s[88:89], v[40:41]
  s_cbranch_vccnz va_bw_12_no
  v_cmp_ne_u64 vcc, s[88:89], v[42:43]
  s_cbranch_vccnz va_bw_12_no
  s_branch va_bw_12_ok
va_bw_12_no:
  s_sleep 2
  s_add_u32 s30, s30, 1
  s_cmp_lt_u32 s30, 50000
  s_cbranch_scc1 va_bw_12
  s_branch cA_abort
va_bw_12_ok:
  s_mov_b32 m0, 16384
  s_add_u32 s22, s31, 272384
  buffer_load_dwordx4 v2, s[8:11], s22 offen offset:0 sc1 lds
  buffer_load_dwordx4 v2, s[8:11], s22 offen offset:1024 sc1 lds
  buffer_load_dwordx4 v2, s[8:11], s22 offen offset:2048 sc1 lds
  buffer_load_dwordx4 v2, s[8:11], s22 offen offset:3072 sc1 lds
  s_mov_b32 m0, 20480
  s_add_u32 s22, s31, 276480
  buffer_load_dwordx4 v2, s[8:11], s22 offen offset:0 sc1 lds
  buffer_load_dwordx4 v2, s[8:11], s22 offen offset:1024 sc1 lds
  buffer_load_dwordx4 v2, s[8:11], s22 offen offset:2048 sc1 lds
  buffer_load_dwordx4 v2, s[8:11], s22 offen offset:3072 sc1 lds
  s_mov_b32 m0, 24576
  s_add_u32 s22, s31, 280576
  buffer_load_dwordx4 v2, s[8:11], s22 offen offset:0 sc1 lds
  buffer_load_dwordx4 v2, s[8:11], s22 offen offset:1024 sc1 lds
  buffer_load_dwordx4 v2, s[8:11], s22 offen offset:2048 sc1 lds
  buffer_load_dwordx4 v2, s[8:11], s22 offen offset:3072 sc1 lds
  s_mov_b32 m0, 28672
  s_add_u32 s22, s31, 284672
  buffer_load_dwordx4 v2, s[8:11], s22 offen offset:0 sc1 lds
  buffer_load_dwordx4 v2, s[8:11], s22 offen offset:1024 sc1 lds
  v_mov_b32 v72, v116
  v_mov_b32 v73, v117
  v_lshrrev_b32 v65, 1, v72
  v_and_b32 v66, 1, v72
  v_add_u32 v67, 0, v65
  v_lshl_add_u32 v67, v67, 4, v73
  v_mul_u32_u24 v68, 2341, v67
  v_lshrrev_b32 v68, 16, v68
  v_mul_u32_u24 v69, 28, v68
  v_sub_u32 v69, v67, v69
  v_lshrrev_b32 v70, 4, v69
  v_and_b32 v69, 15, v69
  v_and_b32 v71, 1, v69
  v_lshrrev_b32 v69, 1, v69
  v_lshl_add_u32 v69, v71, 3, v69
  v_lshlrev_b32 v71, 12, v70
  v_lshl_add_u32 v71, v68, 8, v71
  v_lshl_add_u32 v71, v69, 4, v71
  v_lshl_add_u32 v60, v66, 3, v71
  v_add_u32 v67, 2, v65
  v_lshl_add_u32 v67, v67, 4, v73
  v_mul_u32_u24 v68, 2341, v67
  v_lshrrev_b32 v68, 16, v68
  v_mul_u32_u24 v69, 28, v68
  v_sub_u32 v69, v67, v69
  v_lshrrev_b32 v70, 4, v69
  v_and_b32 v69, 15, v69
  v_and_b32 v71, 1, v69
  v_lshrrev_b32 v69, 1, v69
  v_lshl_add_u32 v69, v71, 3, v69
  v_lshlrev_b32 v71, 12, v70
  v_lshl_add_u32 v71, v68, 8, v71
  v_lshl_add_u32 v71, v69, 4, v71
  v_lshl_add_u32 v61, v66, 3, v71
  v_add_u32 v67, 4, v65
  v_lshl_add_u32 v67, v67, 4, v73
  v_mul_u32_u24 v68, 2341, v67
  v_lshrrev_b32 v68, 16, v68
  v_mul_u32_u24 v69, 28, v68
  v_sub_u32 v69, v67, v69
  v_lshrrev_b32 v70, 4, v69
  v_and_b32 v69, 15, v69
  v_and_b32 v71, 1, v69
  v_lshrrev_b32 v69, 1, v69
  v_lshl_add_u32 v69, v71, 3, v69
  v_lshlrev_b32 v71, 12, v70
  v_lshl_add_u32 v71, v68, 8, v71
  v_lshl_add_u32 v71, v69, 4, v71
  v_lshl_add_u32 v62, v66, 3, v71
  v_and_b32 v0, 31, v1
  v_lshlrev_b32 v0, 2, v0
  v_add_u32 v0, 21504, v0
  v_lshlrev_b32 v4, 2, v73
  s_and_b32 s22, s17, 15
  s_lshl_b32 s22, s22, 7
  s_add_u32 s22, s22, 17408
  v_add_u32 v4, s22, v4
  v_and_b32 v64, 7, v73
  v_lshlrev_b32 v5, 4, v64
  v_lshl_add_u32 v5, v72, 7, v5
  v_lshrrev_b32 v65, 3, v73
  v_lshl_add_u32 v5, v65, 9, v5
  s_lshl_b32 s22, s17, 3
  s_add_u32 s22, s22, 21504
  v_lshl_add_u32 v7, v2, 3, s22
  v_add_u32 v65, 0, v73
  v_min_u32 v65, 27, v65
  v_mad_u32_u24 v65, v72, 28, v65
  v_lshlrev_b32 v6, 4, v65
  s_lshr_b32 s22, s17, 1
  s_mul_i32 s22, s22, 7
  s_and_b32 s34, s17, 1
  s_lshl_b32 s35, s34, 2
  v_add_u32 v70, s35, v72
  v_mov_b32 v71, s34
  v_mov_b32 v69, 0
  v_cmp_eq_u32 vcc, 3, v72
  s_nop 1
  v_cndmask_b32 v70, v70, v72, vcc
  v_cndmask_b32 v69, v69, v71, vcc
  v_add_u32 v70, s22, v70
  v_lshrrev_b32 v68, 1, v70
  v_lshlrev_b32 v68, 8, v68
  v_lshl_add_u32 v68, v69, 7, v68
  v_and_b32 v69, 1, v70
  v_lshl_add_u32 v68, v69, 3, v68
  v_lshl_add_u32 v1, v64, 4, v68
  v_cmp_gt_u32 s[26:27], 8, v73
  v_lshrrev_b32 v65, 3, v73
  v_lshl_add_u32 v66, v64, 1, v65
  v_add_u32 v66, 0, v66
  v_min_u32 v66, 27, v66
  v_mad_u32_u24 v66, v72, 28, v66
  v_lshlrev_b32 v6, 4, v66
  s_mul_i32 s22, s17, 28
  s_add_u32 s22, s22, 0
  v_lshl_add_u32 v70, v64, 1, s22
  v_lshrrev_b32 v68, 4, v70
  v_lshlrev_b32 v68, 8, v68
  v_bfe_u32 v69, v70, 1, 1
  v_lshl_add_u32 v68, v69, 7, v68
  v_bfe_u32 v69, v70, 2, 2
  v_lshl_add_u32 v68, v69, 2, v68
  v_and_b32 v69, 1, v72
  v_lshl_add_u32 v65, v69, 2, v65
  v_lshrrev_b32 v69, 1, v72
  v_lshl_add_u32 v65, v69, 1, v65
  v_lshl_add_u32 v1, v65, 4, v68
  v_cmp_gt_u32 s[26:27], 6, v64
  v_mov_b32 v156, 0
  v_mov_b32 v157, 0
  v_mov_b32 v158, 0
  v_mov_b32 v159, 0
  ds_write_b128 v2, v[156:159] offset:0
  ds_write_b128 v2, v[156:159] offset:1024
  ds_write_b128 v2, v[156:159] offset:2048
  ds_write_b128 v2, v[156:159] offset:3072
  s_mul_i32 s22, s17, 1835008
  s_add_u32 s25, s22, 42205184
  s_lshl_b32 s35, s17, 7
  s_add_u32 s35, s35, 88526848
  s_mov_b32 s38, 0
  v_mov_b32 v175, 0
  s_lshl_b32 s22, 0, 11
  s_add_u32 s22, s22, 88590336
  v_add_u32 v36, 1024, v2
  v_min_u32 v36, 1776, v36
  s_mov_b32 s30, 0
va_iw4:
  buffer_load_dwordx4 v[40:43], v2, s[8:11], s22 offen sc1
  buffer_load_dwordx4 v[44:47], v36, s[8:11], s22 offen sc1
  s_waitcnt vmcnt(0)
  v_cmp_ne_u64 vcc, s[88:89], v[40:41]
  s_cbranch_vccnz va_iw4_no
  v_cmp_ne_u64 vcc, s[88:89], v[42:43]
  s_cbranch_vccnz va_iw4_no
  v_cmp_ne_u64 vcc, s[88:89], v[44:45]
  s_cbranch_vccnz va_iw4_no
  v_cmp_ne_u64 vcc, s[88:89], v[46:47]
  s_cbranch_vccnz va_iw4_no
  s_branch va_iw4_ok
va_iw4_no:
  s_sleep 2
  s_add_u32 s30, s30, 1
  s_cmp_lt_u32 s30, 50000
  s_cbranch_scc1 va_iw4
  s_branch cA_abort
va_iw4_ok:
  s_mov_b32 s30, 0
  v_mov_b32 v36, 0
ch_md4:
  buffer_load_dword v37, v36, s[12:15], 0 offen sc1
  s_waitcnt vmcnt(0)
  v_readfirstlane_b32 s22, v37
  s_and_b32 s31, s22, 0xffff
  s_cmp_ge_u32 s31, 32
  s_cbranch_scc1 ch_go4
  s_sleep 2
  s_add_u32 s30, s30, 1
  s_cmp_lt_u32 s30, 50000
  s_cbranch_scc1 ch_md4
  s_branch ch_end
ch_go4:
  s_mov_b32 s31, 0
  v_mov_b32 v36, 0
  v_mov_b32 v37, 0
  v_mov_b32 v38, 0
  v_mov_b32 v39, 0
  v_mov_b32 v40, 0
  v_mov_b32 v41, 0
  v_mov_b32 v42, 0
  v_mov_b32 v43, 0
  v_mov_b32 v44, 0
  v_mov_b32 v45, 0
  v_mov_b32 v46, 0
  v_mov_b32 v47, 0
  v_mov_b32 v48, 0
  v_mov_b32 v49, 0
  v_mov_b32 v50, 0
  v_mov_b32 v51, 0
  v_mov_b32 v52, 0
  v_mov_b32 v53, 0
  v_mov_b32 v54, 0
  v_mov_b32 v55, 0
  v_mov_b32 v56, 0
  v_mov_b32 v57, 0
  v_mov_b32 v58, 0
  v_mov_b32 v59, 0
  s_lshr_b32 s22, s22, 16
  s_cmp_lg_u32 s22, 0
  s_cbranch_scc1 cB_va0_loop
  s_branch cA_va0_loop
ch_init5:
  s_mul_i32 s31, s17, 401408
  s_add_u32 s31, s31, 6422528
  s_mul_i32 s22, s17, 28
  s_add_u32 s23, s22, 27
  s_lshr_b32 s22, s22, 6
  s_lshr_b32 s23, s23, 6
  s_sub_u32 s23, s23, s22
  s_lshl_b32 s23, s23, 8
  v_and_b32 v36, s23, v2
  v_med3_u32 v37, v117, 3, 6
  v_lshl_add_u32 v36, v37, 4, v36
  s_lshl_b32 s22, s22, 8
  s_add_u32 s22, s22, 88588288
  s_mov_b32 s30, 0
va_bw_13:
  buffer_load_dwordx4 v[40:43], v36, s[8:11], s22 offen sc1
  s_waitcnt vmcnt(0)
  v_cmp_ne_u64 vcc, s[88:89], v[40:41]
  s_cbranch_vccnz va_bw_13_no
  v_cmp_ne_u64 vcc, s[88:89], v[42:43]
  s_cbranch_vccnz va_bw_13_no
  s_branch va_bw_13_ok
va_bw_13_no:
  s_sleep 2
  s_add_u32 s30, s30, 1
  s_cmp_lt_u32 s30, 50000
  s_cbranch_scc1 va_bw_13
  s_branch cA_abort
va_bw_13_ok:
  s_add_u32 s22, s31, 86016
  buffer_load_dwordx4 a[0:3], v2, s[8:11], s22 offen offset:0 sc1
  buffer_load_dwordx4 a[4:7], v2, s[8:11], s22 offen offset:1024 sc1
  buffer_load_dwordx4 a[8:11], v2, s[8:11], s22 offen offset:2048 sc1
  buffer_load_dwordx4 a[12:15], v2, s[8:11], s22 offen offset:3072 sc1
  s_add_u32 s22, s31, 90112
  buffer_load_dwordx4 a[16:19], v2, s[8:11], s22 offen offset:0 sc1
  buffer_load_dwordx4 a[20:23], v2, s[8:11], s22 offen offset:1024 sc1
  buffer_load_dwordx4 a[24:27], v2, s[8:11], s22 offen offset:2048 sc1
  buffer_load_dwordx4 a[28:31], v2, s[8:11], s22 offen offset:3072 sc1
  s_add_u32 s22, s31, 94208
  buffer_load_dwordx4 a[32:35], v2, s[8:11], s22 offen offset:0 sc1
  buffer_load_dwordx4 a[36:39], v2, s[8:11], s22 offen offset:1024 sc1
  buffer_load_dwordx4 a[40:43], v2, s[8:11], s22 offen offset:2048 sc1
  buffer_load_dwordx4 a[44:47], v2, s[8:11], s22 offen offset:3072 sc1
  s_add_u32 s22, s31, 98304
  buffer_load_dwordx4 a[48:51], v2, s[8:11], s22 offen offset:0 sc1
  buffer_load_dwordx4 a[52:55], v2, s[8:11], s22 offen offset:1024 sc1
  buffer_load_dwordx4 a[56:59], v2, s[8:11], s22 offen offset:2048 sc1
  buffer_load_dwordx4 a[60:63], v2, s[8:11], s22 offen offset:3072 sc1
  s_add_u32 s22, s31, 102400
  buffer_load_dwordx4 a[64:67], v2, s[8:11], s22 offen offset:0 sc1
  buffer_load_dwordx4 a[68:71], v2, s[8:11], s22 offen offset:1024 sc1
  buffer_load_dwordx4 a[72:75], v2, s[8:11], s22 offen offset:2048 sc1
  buffer_load_dwordx4 a[76:79], v2, s[8:11], s22 offen offset:3072 sc1
  s_add_u32 s22, s31, 106496
  buffer_load_dwordx4 a[80:83], v2, s[8:11], s22 offen offset:0 sc1
  buffer_load_dwordx4 a[84:87], v2, s[8:11], s22 offen offset:1024 sc1
  buffer_load_dwordx4 a[88:91], v2, s[8:11], s22 offen offset:2048 sc1
  buffer_load_dwordx4 a[92:95], v2, s[8:11], s22 offen offset:3072 sc1
  s_add_u32 s22, s31, 110592
  buffer_load_dwordx4 a[96:99], v2, s[8:11], s22 offen offset:0 sc1
  buffer_load_dwordx4 a[100:103], v2, s[8:11], s22 offen offset:1024 sc1
  buffer_load_dwordx4 a[104:107], v2, s[8:11], s22 offen offset:2048 sc1
  buffer_load_dwordx4 a[108:111], v2, s[8:11], s22 offen offset:3072 sc1
  s_add_u32 s22, s31, 114688
  buffer_load_dwordx4 a[112:115], v2, s[8:11], s22 offen offset:0 sc1
  buffer_load_dwordx4 a[116:119], v2, s[8:11], s22 offen offset:1024 sc1
  buffer_load_dwordx4 a[120:123], v2, s[8:11], s22 offen offset:2048 sc1
  buffer_load_dwordx4 a[124:127], v2, s[8:11], s22 offen offset:3072 sc1
  s_waitcnt vmcnt(24)
  s_add_u32 s22, s31, 118784
  buffer_load_dwordx4 a[128:131], v2, s[8:11], s22 offen offset:0 sc1
  buffer_load_dwordx4 a[132:135], v2, s[8:11], s22 offen offset:1024 sc1
  buffer_load_dwordx4 a[136:139], v2, s[8:11], s22 offen offset:2048 sc1
  buffer_load_dwordx4 a[140:143], v2, s[8:11], s22 offen offset:3072 sc1
  s_add_u32 s22, s31, 122880
  buffer_load_dwordx4 a[144:147], v2, s[8:11], s22 offen offset:0 sc1
  buffer_load_dwordx4 a[148:151], v2, s[8:11], s22 offen offset:1024 sc1
  buffer_load_dwordx4 a[152:155], v2, s[8:11], s22 offen offset:2048 sc1
  buffer_load_dwordx4 a[156:159], v2, s[8:11], s22 offen offset:3072 sc1
  s_add_u32 s22, s31, 126976
  buffer_load_dwordx4 a[160:163], v2, s[8:11], s22 offen offset:0 sc1
  buffer_load_dwordx4 a[164:167], v2, s[8:11], s22 offen offset:1024 sc1
  buffer_load_dwordx4 a[168:171], v2, s[8:11], s22 offen offset:2048 sc1
  buffer_load_dwordx4 a[172:175], v2, s[8:11], s22 offen offset:3072 sc1
  s_add_u32 s22, s31, 131072
  buffer_load_dwordx4 a[176:179], v2, s[8:11], s22 offen offset:0 sc1
  buffer_load_dwordx4 a[180:183], v2, s[8:11], s22 offen offset:1024 sc1
  buffer_load_dwordx4 a[184:187], v2, s[8:11], s22 offen offset:2048 sc1
  buffer_load_dwordx4 a[188:191], v2, s[8:11], s22 offen offset:3072 sc1
  s_add_u32 s22, s31, 135168
  buffer_load_dwordx4 a[192:195], v2, s[8:11], s22 offen offset:0 sc1
  buffer_load_dwordx4 a[196:199], v2, s[8:11], s22 offen offset:1024 sc1
  buffer_load_dwordx4 a[200:203], v2, s[8:11], s22 offen offset:2048 sc1
  buffer_load_dwordx4 a[204:207], v2, s[8:11], s22 offen offset:3072 sc1
  s_add_u32 s22, s31, 139264
  buffer_load_dwordx4 a[208:211], v2, s[8:11], s22 offen offset:0 sc1
  buffer_load_dwordx4 a[212:215], v2, s[8:11], s22 offen offset:1024 sc1
  buffer_load_dwordx4 a[216:219], v2, s[8:11], s22 offen offset:2048 sc1
  buffer_load_dwordx4 a[220:223], v2, s[8:11], s22 offen offset:3072 sc1
  s_add_u32 s22, s31, 143360
  buffer_load_dwordx4 a[224:227], v2, s[8:11], s22 offen offset:0 sc1
  buffer_load_dwordx4 a[228:231], v2, s[8:11], s22 offen offset:1024 sc1
  buffer_load_dwordx4 a[232:235], v2, s[8:11], s22 offen offset:2048 sc1
  buffer_load_dwordx4 a[236:239], v2, s[8:11], s22 offen offset:3072 sc1
  s_add_u32 s22, s31, 147456
  buffer_load_dwordx4 a[240:243], v2, s[8:11], s22 offen offset:0 sc1
  buffer_load_dwordx4 a[244:247], v2, s[8:11], s22 offen offset:1024 sc1
  buffer_load_dwordx4 a[248:251], v2, s[8:11], s22 offen offset:2048 sc1
  buffer_load_dwordx4 a[252:255], v2, s[8:11], s22 offen offset:3072 sc1
  s_waitcnt vmcnt(24)
  s_add_u32 s22, s31, 151552
  buffer_load_dwordx4 v[176:179], v2, s[8:11], s22 offen offset:0 sc1
  buffer_load_dwordx4 v[180:183], v2, s[8:11], s22 offen offset:1024 sc1
  buffer_load_dwordx4 v[184:187], v2, s[8:11], s22 offen offset:2048 sc1
  buffer_load_dwordx4 v[188:191], v2, s[8:11], s22 offen offset:3072 sc1
  s_add_u32 s22, s31, 155648
  buffer_load_dwordx4 v[192:195], v2, s[8:11], s22 offen offset:0 sc1
  buffer_load_dwordx4 v[196:199], v2, s[8:11], s22 offen offset:1024 sc1
  buffer_load_dwordx4 v[200:203], v2, s[8:11], s22 offen offset:2048 sc1
  buffer_load_dwordx4 v[204:207], v2, s[8:11], s22 offen offset:3072 sc1
  s_add_u32 s22, s31, 159744
  buffer_load_dwordx4 v[208:211], v2, s[8:11], s22 offen offset:0 sc1
  buffer_load_dwordx4 v[212:215], v2, s[8:11], s22 offen offset:1024 sc1
  buffer_load_dwordx4 v[216:219], v2, s[8:11], s22 offen offset:2048 sc1
  buffer_load_dwordx4 v[220:223], v2, s[8:11], s22 offen offset:3072 sc1
  s_add_u32 s22, s31, 163840
  buffer_load_dwordx4 v[224:227], v2, s[8:11], s22 offen offset:0 sc1
  buffer_load_dwordx4 v[228:231], v2, s[8:11], s22 offen offset:1024 sc1
  buffer_load_dwordx4 v[232:235], v2, s[8:11], s22 offen offset:2048 sc1
  buffer_load_dwordx4 v[236:239], v2, s[8:11], s22 offen offset:3072 sc1
  s_add_u32 s22, s31, 167936
  buffer_load_dwordx4 v[240:243], v2, s[8:11], s22 offen offset:0 sc1
  buffer_load_dwordx4 v[244:247], v2, s[8:11], s22 offen offset:1024 sc1
  buffer_load_dwordx4 v[248:251], v2, s[8:11], s22 offen offset:2048 sc1
  buffer_load_dwordx4 v[252:255], v2, s[8:11], s22 offen offset:3072 sc1
  s_mul_i32 s22, s17, 28
  s_add_u32 s23, s22, 27
  s_lshr_b32 s22, s22, 6
  s_lshr_b32 s23, s23, 6
  s_sub_u32 s23, s23, s22
  s_lshl_b32 s23, s23, 8
  v_and_b32 v36, s23, v2
  v_med3_u32 v37, v117, 15, 15
  v_lshl_add_u32 v36, v37, 4, v36
  s_lshl_b32 s22, s22, 8
  s_add_u32 s22, s22, 88588288
  s_mov_b32 s30, 0
va_bw_14:
  buffer_load_dwordx4 v[40:43], v36, s[8:11], s22 offen sc1
  s_waitcnt vmcnt(0)
  v_cmp_ne_u64 vcc, s[88:89], v[40:41]
  s_cbranch_vccnz va_bw_14_no
  v_cmp_ne_u64 vcc, s[88:89], v[42:43]
  s_cbranch_vccnz va_bw_14_no
  s_branch va_bw_14_ok
va_bw_14_no:
  s_sleep 2
  s_add_u32 s30, s30, 1
  s_cmp_lt_u32 s30, 50000
  s_cbranch_scc1 va_bw_14
  s_branch cA_abort
va_bw_14_ok:
  s_mov_b32 m0, 59392
  s_add_u32 s22, s31, 387072
  buffer_load_dwordx4 v2, s[8:11], s22 offen offset:0 sc1 lds
  buffer_load_dwordx4 v2, s[8:11], s22 offen offset:1024 sc1 lds
  buffer_load_dwordx4 v2, s[8:11], s22 offen offset:2048 sc1 lds
  buffer_load_dwordx4 v2, s[8:11], s22 offen offset:3072 sc1 lds
  s_mov_b32 m0, 63488
  s_add_u32 s22, s31, 391168
  buffer_load_dwordx4 v2, s[8:11], s22 offen offset:0 sc1 lds
  buffer_load_dwordx4 v2, s[8:11], s22 offen offset:1024 sc1 lds
  buffer_load_dwordx4 v2, s[8:11], s22 offen offset:2048 sc1 lds
  buffer_load_dwordx4 v2, s[8:11], s22 offen offset:3072 sc1 lds
  s_mov_b32 m0, 67584
  s_add_u32 s22, s31, 395264
  buffer_load_dwordx4 v2, s[8:11], s22 offen offset:0 sc1 lds
  buffer_load_dwordx4 v2, s[8:11], s22 offen offset:1024 sc1 lds
  buffer_load_dwordx4 v2, s[8:11], s22 offen offset:2048 sc1 lds
  buffer_load_dwordx4 v2, s[8:11], s22 offen offset:3072 sc1 lds
  s_mov_b32 m0, 71680
  s_add_u32 s22, s31, 399360
  buffer_load_dwordx4 v2, s[8:11], s22 offen offset:0 sc1 lds
  buffer_load_dwordx4 v2, s[8:11], s22 offen offset:1024 sc1 lds
  v_mov_b32 v72, v116
  v_mov_b32 v73, v117
  v_lshrrev_b32 v65, 1, v72
  v_and_b32 v66, 1, v72
  v_add_u32 v67, 6, v65
  v_lshl_add_u32 v67, v67, 4, v73
  v_mul_u32_u24 v68, 2341, v67
  v_lshrrev_b32 v68, 16, v68
  v_mul_u32_u24 v69, 28, v68
  v_sub_u32 v69, v67, v69
  v_lshrrev_b32 v70, 4, v69
  v_and_b32 v69, 15, v69
  v_and_b32 v71, 1, v69
  v_lshrrev_b32 v69, 1, v69
  v_lshl_add_u32 v69, v71, 3, v69
  v_lshlrev_b32 v71, 12, v70
  v_lshl_add_u32 v71, v68, 8, v71
  v_lshl_add_u32 v71, v69, 4, v71
  v_lshl_add_u32 v60, v66, 3, v71
  v_add_u32 v67, 8, v65
  v_lshl_add_u32 v67, v67, 4, v73
  v_mul_u32_u24 v68, 2341, v67
  v_lshrrev_b32 v68, 16, v68
  v_mul_u32_u24 v69, 28, v68
  v_sub_u32 v69, v67, v69
  v_lshrrev_b32 v70, 4, v69
  v_and_b32 v69, 15, v69
  v_and_b32 v71, 1, v69
  v_lshrrev_b32 v69, 1, v69
  v_lshl_add_u32 v69, v71, 3, v69
  v_lshlrev_b32 v71, 12, v70
  v_lshl_add_u32 v71, v68, 8, v71
  v_lshl_add_u32 v71, v69, 4, v71
  v_lshl_add_u32 v61, v66, 3, v71
  v_add_u32 v67, 10, v65
  v_lshl_add_u32 v67, v67, 4, v73
  v_mul_u32_u24 v68, 2341, v67
  v_lshrrev_b32 v68, 16, v68
  v_mul_u32_u24 v69, 28, v68
  v_sub_u32 v69, v67, v69
  v_lshrrev_b32 v70, 4, v69
  v_and_b32 v69, 15, v69
  v_and_b32 v71, 1, v69
  v_lshrrev_b32 v69, 1, v69
  v_lshl_add_u32 v69, v71, 3, v69
  v_lshlrev_b32 v71, 12, v70
  v_lshl_add_u32 v71, v68, 8, v71
  v_lshl_add_u32 v71, v69, 4, v71
  v_lshl_add_u32 v62, v66, 3, v71
  v_and_b32 v0, 31, v1
  v_lshlrev_b32 v0, 2, v0
  v_add_u32 v0, 21504, v0
  v_lshlrev_b32 v4, 2, v73
  s_and_b32 s22, s17, 15
  s_lshl_b32 s22, s22, 7
  s_add_u32 s22, s22, 17408
  v_add_u32 v4, s22, v4
  v_and_b32 v64, 7, v73
  v_lshlrev_b32 v5, 4, v64
  v_lshl_add_u32 v5, v72, 7, v5
  v_lshrrev_b32 v65, 3, v73
  v_lshl_add_u32 v5, v65, 9, v5
  s_lshl_b32 s22, s17, 3
  s_add_u32 s22, s22, 21508
  v_lshl_add_u32 v7, v2, 3, s22
  v_add_u32 v65, 16, v73
  v_min_u32 v65, 27, v65
  v_mad_u32_u24 v65, v72, 28, v65
  v_lshlrev_b32 v6, 4, v65
  s_lshr_b32 s22, s17, 1
  s_mul_i32 s22, s22, 7
  s_and_b32 s34, s17, 1
  s_lshl_b32 s35, s34, 2
  v_add_u32 v70, s35, v72
  v_mov_b32 v71, s34
  v_mov_b32 v69, 1
  v_cmp_eq_u32 vcc, 3, v72
  s_nop 1
  v_cndmask_b32 v70, v70, v72, vcc
  v_cndmask_b32 v69, v69, v71, vcc
  v_add_u32 v70, s22, v70
  v_lshrrev_b32 v68, 1, v70
  v_lshlrev_b32 v68, 8, v68
  v_lshl_add_u32 v68, v69, 7, v68
  v_and_b32 v69, 1, v70
  v_lshl_add_u32 v68, v69, 3, v68
  v_lshl_add_u32 v1, v64, 4, v68
  v_cmp_gt_u32 s[26:27], 8, v73
  v_cmp_gt_u32 vcc, 3, v72
  s_and_b64 s[26:27], s[26:27], vcc
  v_lshrrev_b32 v65, 3, v73
  v_lshl_add_u32 v66, v64, 1, v65
  v_add_u32 v66, 16, v66
  v_min_u32 v66, 27, v66
  v_mad_u32_u24 v66, v72, 28, v66
  v_lshlrev_b32 v6, 4, v66
  s_mul_i32 s22, s17, 28
  s_add_u32 s22, s22, 16
  v_lshl_add_u32 v70, v64, 1, s22
  v_lshrrev_b32 v68, 4, v70
  v_lshlrev_b32 v68, 8, v68
  v_bfe_u32 v69, v70, 1, 1
  v_lshl_add_u32 v68, v69, 7, v68
  v_bfe_u32 v69, v70, 2, 2
  v_lshl_add_u32 v68, v69, 2, v68
  v_and_b32 v69, 1, v72
  v_lshl_add_u32 v65, v69, 2, v65
  v_lshrrev_b32 v69, 1, v72
  v_lshl_add_u32 v65, v69, 1, v65
  v_lshl_add_u32 v1, v65, 4, v68
  v_cmp_gt_u32 s[26:27], 6, v64
  v_mov_b32 v156, 0
  v_mov_b32 v157, 0
  v_mov_b32 v158, 0
  v_mov_b32 v159, 0
  ds_write_b128 v2, v[156:159] offset:4096
  ds_write_b128 v2, v[156:159] offset:5120
  ds_write_b128 v2, v[156:159] offset:6144
  ds_write_b128 v2, v[156:159] offset:7168
  s_mul_i32 s22, s17, 1835008
  s_add_u32 s25, s22, 42205184
  s_lshl_b32 s35, s17, 7
  s_add_u32 s35, s35, 88526848
  s_mov_b32 s38, 0
  v_mov_b32 v175, 0
  s_lshl_b32 s22, 0, 11
  s_add_u32 s22, s22, 88590336
  v_add_u32 v36, 1024, v2
  v_min_u32 v36, 1776, v36
  s_mov_b32 s30, 0
va_iw5:
  buffer_load_dwordx4 v[40:43], v2, s[8:11], s22 offen sc1
  buffer_load_dwordx4 v[44:47], v36, s[8:11], s22 offen sc1
  s_waitcnt vmcnt(0)
  v_cmp_ne_u64 vcc, s[88:89], v[40:41]
  s_cbranch_vccnz va_iw5_no
  v_cmp_ne_u64 vcc, s[88:89], v[42:43]
  s_cbranch_vccnz va_iw5_no
  v_cmp_ne_u64 vcc, s[88:89], v[44:45]
  s_cbranch_vccnz va_iw5_no
  v_cmp_ne_u64 vcc, s[88:89], v[46:47]
  s_cbranch_vccnz va_iw5_no
  s_branch va_iw5_ok
va_iw5_no:
  s_sleep 2
  s_add_u32 s30, s30, 1
  s_cmp_lt_u32 s30, 50000
  s_cbranch_scc1 va_iw5
  s_branch cA_abort
va_iw5_ok:
  s_mov_b32 s30, 0
  v_mov_b32 v36, 0
ch_md5:
  buffer_load_dword v37, v36, s[12:15], 0 offen sc1
  s_waitcnt vmcnt(0)
  v_readfirstlane_b32 s22, v37
  s_and_b32 s31, s22, 0xffff
  s_cmp_ge_u32 s31, 32
  s_cbranch_scc1 ch_go5
  s_sleep 2
  s_add_u32 s30, s30, 1
  s_cmp_lt_u32 s30, 50000
  s_cbranch_scc1 ch_md5
  s_branch ch_end
ch_go5:
  s_mov_b32 s31, 0
  v_mov_b32 v36, 0
  v_mov_b32 v37, 0
  v_mov_b32 v38, 0
  v_mov_b32 v39, 0
  v_mov_b32 v40, 0
  v_mov_b32 v41, 0
  v_mov_b32 v42, 0
  v_mov_b32 v43, 0
  v_mov_b32 v44, 0
  v_mov_b32 v45, 0
  v_mov_b32 v46, 0
  v_mov_b32 v47, 0
  v_mov_b32 v48, 0
  v_mov_b32 v49, 0
  v_mov_b32 v50, 0
  v_mov_b32 v51, 0
  v_mov_b32 v52, 0
  v_mov_b32 v53, 0
  v_mov_b32 v54, 0
  v_mov_b32 v55, 0
  v_mov_b32 v56, 0
  v_mov_b32 v57, 0
  v_mov_b32 v58, 0
  v_mov_b32 v59, 0
  s_lshr_b32 s22, s22, 16
  s_cmp_lg_u32 s22, 0
  s_cbranch_scc1 cB_va1_loop
  s_branch cA_va1_loop
ch_init6:
  s_mul_i32 s31, s17, 401408
  s_add_u32 s31, s31, 6422528
  s_mul_i32 s22, s17, 28
  s_add_u32 s23, s22, 27
  s_lshr_b32 s22, s22, 6
  s_lshr_b32 s23, s23, 6
  s_sub_u32 s23, s23, s22
  s_lshl_b32 s23, s23, 8
  v_and_b32 v36, s23, v2
  v_med3_u32 v37, v117, 6, 10
  v_lshl_add_u32 v36, v37, 4, v36
  s_lshl_b32 s22, s22, 8
  s_add_u32 s22, s22, 88588288
  s_mov_b32 s30, 0
va_bw_15:
  buffer_load_dwordx4 v[40:43], v36, s[8:11], s22 offen sc1
  s_waitcnt vmcnt(0)
  v_cmp_ne_u64 vcc, s[88:89], v[40:41]
  s_cbranch_vccnz va_bw_15_no
  v_cmp_ne_u64 vcc, s[88:89], v[42:43]
  s_cbranch_vccnz va_bw_15_no
  s_branch va_bw_15_ok
va_bw_15_no:
  s_sleep 2
  s_add_u32 s30, s30, 1
  s_cmp_lt_u32 s30, 50000
  s_cbranch_scc1 va_bw_15
  s_branch cA_abort
va_bw_15_ok:
  s_add_u32 s22, s31, 172032
  buffer_load_dwordx4 a[0:3], v2, s[8:11], s22 offen offset:0 sc1
  buffer_load_dwordx4 a[4:7], v2, s[8:11], s22 offen offset:1024 sc1
  buffer_load_dwordx4 a[8:11], v2, s[8:11], s22 offen offset:2048 sc1
  buffer_load_dwordx4 a[12:15], v2, s[8:11], s22 offen offset:3072 sc1
  s_add_u32 s22, s31, 176128
  buffer_load_dwordx4 a[16:19], v2, s[8:11], s22 offen offset:0 sc1
  buffer_load_dwordx4 a[20:23], v2, s[8:11], s22 offen offset:1024 sc1
  buffer_load_dwordx4 a[24:27], v2, s[8:11], s22 offen offset:2048 sc1
  buffer_load_dwordx4 a[28:31], v2, s[8:11], s22 offen offset:3072 sc1
  s_add_u32 s22, s31, 180224
  buffer_load_dwordx4 a[32:35], v2, s[8:11], s22 offen offset:0 sc1
  buffer_load_dwordx4 a[36:39], v2, s[8:11], s22 offen offset:1024 sc1
  buffer_load_dwordx4 a[40:43], v2, s[8:11], s22 offen offset:2048 sc1
  buffer_load_dwordx4 a[44:47], v2, s[8:11], s22 offen offset:3072 sc1
  s_add_u32 s22, s31, 184320
  buffer_load_dwordx4 a[48:51], v2, s[8:11], s22 offen offset:0 sc1
  buffer_load_dwordx4 a[52:55], v2, s[8:11], s22 offen offset:1024 sc1
  buffer_load_dwordx4 a[56:59], v2, s[8:11], s22 offen offset:2048 sc1
  buffer_load_dwordx4 a[60:63], v2, s[8:11], s22 offen offset:3072 sc1
  s_add_u32 s22, s31, 188416
  buffer_load_dwordx4 a[64:67], v2, s[8:11], s22 offen offset:0 sc1
  buffer_load_dwordx4 a[68:71], v2, s[8:11], s22 offen offset:1024 sc1
  buffer_load_dwordx4 a[72:75], v2, s[8:11], s22 offen offset:2048 sc1
  buffer_load_dwordx4 a[76:79], v2, s[8:11], s22 offen offset:3072 sc1
  s_add_u32 s22, s31, 192512
  buffer_load_dwordx4 a[80:83], v2, s[8:11], s22 offen offset:0 sc1
  buffer_load_dwordx4 a[84:87], v2, s[8:11], s22 offen offset:1024 sc1
  buffer_load_dwordx4 a[88:91], v2, s[8:11], s22 offen offset:2048 sc1
  buffer_load_dwordx4 a[92:95], v2, s[8:11], s22 offen offset:3072 sc1
  s_add_u32 s22, s31, 196608
  buffer_load_dwordx4 a[96:99], v2, s[8:11], s22 offen offset:0 sc1
  buffer_load_dwordx4 a[100:103], v2, s[8:11], s22 offen offset:1024 sc1
  buffer_load_dwordx4 a[104:107], v2, s[8:11], s22 offen offset:2048 sc1
  buffer_load_dwordx4 a[108:111], v2, s[8:11], s22 offen offset:3072 sc1
  s_add_u32 s22, s31, 200704
  buffer_load_dwordx4 a[112:115], v2, s[8:11], s22 offen offset:0 sc1
  buffer_load_dwordx4 a[116:119], v2, s[8:11], s22 offen offset:1024 sc1
  buffer_load_dwordx4 a[120:123], v2, s[8:11], s22 offen offset:2048 sc1
  buffer_load_dwordx4 a[124:127], v2, s[8:11], s22 offen offset:3072 sc1
  s_waitcnt vmcnt(24)
  s_add_u32 s22, s31, 204800
  buffer_load_dwordx4 a[128:131], v2, s[8:11], s22 offen offset:0 sc1
  buffer_load_dwordx4 a[132:135], v2, s[8:11], s22 offen offset:1024 sc1
  buffer_load_dwordx4 a[136:139], v2, s[8:11], s22 offen offset:2048 sc1
  buffer_load_dwordx4 a[140:143], v2, s[8:11], s22 offen offset:3072 sc1
  s_add_u32 s22, s31, 208896
  buffer_load_dwordx4 a[144:147], v2, s[8:11], s22 offen offset:0 sc1
  buffer_load_dwordx4 a[148:151], v2, s[8:11], s22 offen offset:1024 sc1
  buffer_load_dwordx4 a[152:155], v2, s[8:11], s22 offen offset:2048 sc1
  buffer_load_dwordx4 a[156:159], v2, s[8:11], s22 offen offset:3072 sc1
  s_add_u32 s22, s31, 212992
  buffer_load_dwordx4 a[160:163], v2, s[8:11], s22 offen offset:0 sc1
  buffer_load_dwordx4 a[164:167], v2, s[8:11], s22 offen offset:1024 sc1
  buffer_load_dwordx4 a[168:171], v2, s[8:11], s22 offen offset:2048 sc1
  buffer_load_dwordx4 a[172:175], v2, s[8:11], s22 offen offset:3072 sc1
  s_add_u32 s22, s31, 217088
  buffer_load_dwordx4 a[176:179], v2, s[8:11], s22 offen offset:0 sc1
  buffer_load_dwordx4 a[180:183], v2, s[8:11], s22 offen offset:1024 sc1
  buffer_load_dwordx4 a[184:187], v2, s[8:11], s22 offen offset:2048 sc1
  buffer_load_dwordx4 a[188:191], v2, s[8:11], s22 offen offset:3072 sc1
  s_add_u32 s22, s31, 221184
  buffer_load_dwordx4 a[192:195], v2, s[8:11], s22 offen offset:0 sc1
  buffer_load_dwordx4 a[196:199], v2, s[8:11], s22 offen offset:1024 sc1
  buffer_load_dwordx4 a[200:203], v2, s[8:11], s22 offen offset:2048 sc1
  buffer_load_dwordx4 a[204:207], v2, s[8:11], s22 offen offset:3072 sc1
  s_add_u32 s22, s31, 225280
  buffer_load_dwordx4 a[208:211], v2, s[8:11], s22 offen offset:0 sc1
  buffer_load_dwordx4 a[212:215], v2, s[8:11], s22 offen offset:1024 sc1
  buffer_load_dwordx4 a[216:219], v2, s[8:11], s22 offen offset:2048 sc1
  buffer_load_dwordx4 a[220:223], v2, s[8:11], s22 offen offset:3072 sc1
  s_add_u32 s22, s31, 229376
  buffer_load_dwordx4 a[224:227], v2, s[8:11], s22 offen offset:0 sc1
  buffer_load_dwordx4 a[228:231], v2, s[8:11], s22 offen offset:1024 sc1
  buffer_load_dwordx4 a[232:235], v2, s[8:11], s22 offen offset:2048 sc1
  buffer_load_dwordx4 a[236:239], v2, s[8:11], s22 offen offset:3072 sc1
  s_add_u32 s22, s31, 233472
  buffer_load_dwordx4 a[240:243], v2, s[8:11], s22 offen offset:0 sc1
  buffer_load_dwordx4 a[244:247], v2, s[8:11], s22 offen offset:1024 sc1
  buffer_load_dwordx4 a[248:251], v2, s[8:11], s22 offen offset:2048 sc1
  buffer_load_dwordx4 a[252:255], v2, s[8:11], s22 offen offset:3072 sc1
  s_waitcnt vmcnt(24)
  s_add_u32 s22, s31, 237568
  buffer_load_dwordx4 v[120:123], v2, s[8:11], s22 offen offset:0 sc1
  buffer_load_dwordx4 v[124:127], v2, s[8:11], s22 offen offset:1024 sc1
  buffer_load_dwordx4 v[128:131], v2, s[8:11], s22 offen offset:2048 sc1
  buffer_load_dwordx4 v[132:135], v2, s[8:11], s22 offen offset:3072 sc1
  s_add_u32 s22, s31, 241664
  buffer_load_dwordx4 v[136:139], v2, s[8:11], s22 offen offset:0 sc1
  buffer_load_dwordx4 v[140:143], v2, s[8:11], s22 offen offset:1024 sc1
  buffer_load_dwordx4 v[144:147], v2, s[8:11], s22 offen offset:2048 sc1
  buffer_load_dwordx4 v[148:151], v2, s[8:11], s22 offen offset:3072 sc1
  s_add_u32 s22, s31, 245760
  buffer_load_dwordx4 v[152:155], v2, s[8:11], s22 offen offset:0 sc1
  buffer_load_dwordx4 v[156:159], v2, s[8:11], s22 offen offset:1024 sc1
  buffer_load_dwordx4 v[160:163], v2, s[8:11], s22 offen offset:2048 sc1
  buffer_load_dwordx4 v[164:167], v2, s[8:11], s22 offen offset:3072 sc1
  s_add_u32 s22, s31, 249856
  buffer_load_dwordx4 v[168:171], v2, s[8:11], s22 offen offset:0 sc1
  buffer_load_dwordx4 v[172:175], v2, s[8:11], s22 offen offset:1024 sc1
  buffer_load_dwordx4 v[176:179], v2, s[8:11], s22 offen offset:2048 sc1
  buffer_load_dwordx4 v[180:183], v2, s[8:11], s22 offen offset:3072 sc1
  s_add_u32 s22, s31, 253952
  buffer_load_dwordx4 v[184:187], v2, s[8:11], s22 offen offset:0 sc1
  buffer_load_dwordx4 v[188:191], v2, s[8:11], s22 offen offset:1024 sc1
  buffer_load_dwordx4 v[192:195], v2, s[8:11], s22 offen offset:2048 sc1
  buffer_load_dwordx4 v[196:199], v2, s[8:11], s22 offen offset:3072 sc1
  s_add_u32 s22, s31, 258048
  buffer_load_dwordx4 v[200:203], v2, s[8:11], s22 offen offset:0 sc1
  buffer_load_dwordx4 v[204:207], v2, s[8:11], s22 offen offset:1024 sc1
  buffer_load_dwordx4 v[208:211], v2, s[8:11], s22 offen offset:2048 sc1
  buffer_load_dwordx4 v[212:215], v2, s[8:11], s22 offen offset:3072 sc1
  s_add_u32 s22, s31, 262144
  buffer_load_dwordx4 v[216:219], v2, s[8:11], s22 offen offset:0 sc1
  buffer_load_dwordx4 v[220:223], v2, s[8:11], s22 offen offset:1024 sc1
  buffer_load_dwordx4 v[224:227], v2, s[8:11], s22 offen offset:2048 sc1
  buffer_load_dwordx4 v[228:231], v2, s[8:11], s22 offen offset:3072 sc1
  s_add_u32 s22, s31, 266240
  buffer_load_dwordx4 v[232:235], v2, s[8:11], s22 offen offset:0 sc1
  buffer_load_dwordx4 v[236:239], v2, s[8:11], s22 offen offset:1024 sc1
  buffer_load_dwordx4 v[240:243], v2, s[8:11], s22 offen offset:2048 sc1
  buffer_load_dwordx4 v[244:247], v2, s[8:11], s22 offen offset:3072 sc1
  s_waitcnt vmcnt(24)
  s_add_u32 s22, s31, 270336
  buffer_load_dwordx4 v[248:251], v2, s[8:11], s22 offen offset:0 sc1
  buffer_load_dwordx4 v[252:255], v2, s[8:11], s22 offen offset:1024 sc1
  v_mov_b32 v72, v116
  v_mov_b32 v73, v117
  v_lshrrev_b32 v65, 1, v72
  v_and_b32 v66, 1, v72
  v_add_u32 v67, 12, v65
  v_lshl_add_u32 v67, v67, 4, v73
  v_mul_u32_u24 v68, 2341, v67
  v_lshrrev_b32 v68, 16, v68
  v_mul_u32_u24 v69, 28, v68
  v_sub_u32 v69, v67, v69
  v_lshrrev_b32 v70, 4, v69
  v_and_b32 v69, 15, v69
  v_and_b32 v71, 1, v69
  v_lshrrev_b32 v69, 1, v69
  v_lshl_add_u32 v69, v71, 3, v69
  v_lshlrev_b32 v71, 12, v70
  v_lshl_add_u32 v71, v68, 8, v71
  v_lshl_add_u32 v71, v69, 4, v71
  v_lshl_add_u32 v112, v66, 3, v71
  v_add_u32 v67, 14, v65
  v_lshl_add_u32 v67, v67, 4, v73
  v_mul_u32_u24 v68, 2341, v67
  v_lshrrev_b32 v68, 16, v68
  v_mul_u32_u24 v69, 28, v68
  v_sub_u32 v69, v67, v69
  v_lshrrev_b32 v70, 4, v69
  v_and_b32 v69, 15, v69
  v_and_b32 v71, 1, v69
  v_lshrrev_b32 v69, 1, v69
  v_lshl_add_u32 v69, v71, 3, v69
  v_lshlrev_b32 v71, 12, v70
  v_lshl_add_u32 v71, v68, 8, v71
  v_lshl_add_u32 v71, v69, 4, v71
  v_lshl_add_u32 v113, v66, 3, v71
  v_add_u32 v67, 16, v65
  v_lshl_add_u32 v67, v67, 4, v73
  v_mul_u32_u24 v68, 2341, v67
  v_lshrrev_b32 v68, 16, v68
  v_mul_u32_u24 v69, 28, v68
  v_sub_u32 v69, v67, v69
  v_lshrrev_b32 v70, 4, v69
  v_and_b32 v69, 15, v69
  v_and_b32 v71, 1, v69
  v_lshrrev_b32 v69, 1, v69
  v_lshl_add_u32 v69, v71, 3, v69
  v_lshlrev_b32 v71, 12, v70
  v_lshl_add_u32 v71, v68, 8, v71
  v_lshl_add_u32 v71, v69, 4, v71
  v_lshl_add_u32 v114, v66, 3, v71
  v_add_u32 v67, 18, v65
  v_lshl_add_u32 v67, v67, 4, v73
  v_mul_u32_u24 v68, 2341, v67
  v_lshrrev_b32 v68, 16, v68
  v_mul_u32_u24 v69, 28, v68
  v_sub_u32 v69, v67, v69
  v_lshrrev_b32 v70, 4, v69
  v_and_b32 v69, 15, v69
  v_and_b32 v71, 1, v69
  v_lshrrev_b32 v69, 1, v69
  v_lshl_add_u32 v69, v71, 3, v69
  v_lshlrev_b32 v71, 12, v70
  v_lshl_add_u32 v71, v68, 8, v71
  v_lshl_add_u32 v71, v69, 4, v71
  v_lshl_add_u32 v115, v66, 3, v71
  s_mul_i32 s24, s17, 532480
  s_add_u32 s24, s24, 76926976
  s_mul_i32 s34, s17, 640
  s_add_u32 s34, s34, 88569856
  s_mul_i32 s36, s17, 448
  v_add_u32 v0, s36, v2
  v_add_u32 v0, 8192, v0
  s_add_u32 s36, s36, 88068096
  v_cmp_gt_u32 s[26:27], 28, v1
  v_and_b32 v119, 31, v1
  v_lshlrev_b32 v119, 2, v119
  s_add_u32 s22, s17, 16
  s_and_b32 s22, s22, 31
  s_lshl_b32 s22, s22, 7
  s_add_u32 s22, s22, 21504
  v_add_u32 v119, s22, v119
  v_min_u32 v118, 12, v1
  s_mul_i32 s22, s17, 13
  v_add_u32 v118, s22, v118
  v_lshlrev_b32 v118, 7, v118
  v_add_u32 v118, 51200, v118
  s_mov_b32 s39, 71565312
  v_add_u32 v1, 16384, v2
  v_mov_b32 v117, 1
  s_mul_i32 s38, s17, 1104
  s_add_u32 s38, s38, 25600
  s_lshl_b32 s22, 0, 11
  s_add_u32 s22, s22, 88590336
  v_add_u32 v36, 1024, v2
  v_min_u32 v36, 1776, v36
  s_mov_b32 s30, 0
va_iw6:
  buffer_load_dwordx4 v[40:43], v2, s[8:11], s22 offen sc1
  buffer_load_dwordx4 v[44:47], v36, s[8:11], s22 offen sc1
  s_waitcnt vmcnt(0)
  v_cmp_ne_u64 vcc, s[88:89], v[40:41]
  s_cbranch_vccnz va_iw6_no
  v_cmp_ne_u64 vcc, s[88:89], v[42:43]
  s_cbranch_vccnz va_iw6_no
  v_cmp_ne_u64 vcc, s[88:89], v[44:45]
  s_cbranch_vccnz va_iw6_no
  v_cmp_ne_u64 vcc, s[88:89], v[46:47]
  s_cbranch_vccnz va_iw6_no
  s_branch va_iw6_ok
va_iw6_no:
  s_sleep 2
  s_add_u32 s30, s30, 1
  s_cmp_lt_u32 s30, 50000
  s_cbranch_scc1 va_iw6
  s_branch cA_abort
va_iw6_ok:
  s_mov_b32 s30, 0
  v_mov_b32 v36, 0
ch_md6:
  buffer_load_dword v37, v36, s[12:15], 0 offen sc1
  s_waitcnt vmcnt(0)
  v_readfirstlane_b32 s22, v37
  s_and_b32 s31, s22, 0xffff
  s_cmp_ge_u32 s31, 32
  s_cbranch_scc1 ch_go6
  s_sleep 2
  s_add_u32 s30, s30, 1
  s_cmp_lt_u32 s30, 50000
  s_cbranch_scc1 ch_md6
  s_branch ch_end
ch_go6:
  s_mov_b32 s31, 0
  s_lshr_b32 s22, s22, 16
  s_cmp_lg_u32 s22, 0
  s_cbranch_scc1 cB_va2_loop
  s_branch cA_va2_loop
ch_init7:
  s_mul_i32 s31, s17, 401408
  s_add_u32 s31, s31, 6422528
  s_mul_i32 s22, s17, 28
  s_add_u32 s23, s22, 27
  s_lshr_b32 s22, s22, 6
  s_lshr_b32 s23, s23, 6
  s_sub_u32 s23, s23, s22
  s_lshl_b32 s23, s23, 8
  v_and_b32 v36, s23, v2
  v_med3_u32 v37, v117, 11, 15
  v_lshl_add_u32 v36, v37, 4, v36
  s_lshl_b32 s22, s22, 8
  s_add_u32 s22, s22, 88588288
  s_mov_b32 s30, 0
va_bw_16:
  buffer_load_dwordx4 v[40:43], v36, s[8:11], s22 offen sc1
  s_waitcnt vmcnt(0)
  v_cmp_ne_u64 vcc, s[88:89], v[40:41]
  s_cbranch_vccnz va_bw_16_no
  v_cmp_ne_u64 vcc, s[88:89], v[42:43]
  s_cbranch_vccnz va_bw_16_no
  s_branch va_bw_16_ok
va_bw_16_no:
  s_sleep 2
  s_add_u32 s30, s30, 1
  s_cmp_lt_u32 s30, 50000
  s_cbranch_scc1 va_bw_16
  s_branch cA_abort
va_bw_16_ok:
  s_add_u32 s22, s31, 286720
  buffer_load_dwordx4 a[0:3], v2, s[8:11], s22 offen offset:0 sc1
  buffer_load_dwordx4 a[4:7], v2, s[8:11], s22 offen offset:1024 sc1
  buffer_load_dwordx4 a[8:11], v2, s[8:11], s22 offen offset:2048 sc1
  buffer_load_dwordx4 a[12:15], v2, s[8:11], s22 offen offset:3072 sc1
  s_add_u32 s22, s31, 290816
  buffer_load_dwordx4 a[16:19], v2, s[8:11], s22 offen offset:0 sc1
  buffer_load_dwordx4 a[20:23], v2, s[8:11], s22 offen offset:1024 sc1
  buffer_load_dwordx4 a[24:27], v2, s[8:11], s22 offen offset:2048 sc1
  buffer_load_dwordx4 a[28:31], v2, s[8:11], s22 offen offset:3072 sc1
  s_add_u32 s22, s31, 294912
  buffer_load_dwordx4 a[32:35], v2, s[8:11], s22 offen offset:0 sc1
  buffer_load_dwordx4 a[36:39], v2, s[8:11], s22 offen offset:1024 sc1
  buffer_load_dwordx4 a[40:43], v2, s[8:11], s22 offen offset:2048 sc1
  buffer_load_dwordx4 a[44:47], v2, s[8:11], s22 offen offset:3072 sc1
  s_add_u32 s22, s31, 299008
  buffer_load_dwordx4 a[48:51], v2, s[8:11], s22 offen offset:0 sc1
  buffer_load_dwordx4 a[52:55], v2, s[8:11], s22 offen offset:1024 sc1
  buffer_load_dwordx4 a[56:59], v2, s[8:11], s22 offen offset:2048 sc1
  buffer_load_dwordx4 a[60:63], v2, s[8:11], s22 offen offset:3072 sc1
  s_add_u32 s22, s31, 303104
  buffer_load_dwordx4 a[64:67], v2, s[8:11], s22 offen offset:0 sc1
  buffer_load_dwordx4 a[68:71], v2, s[8:11], s22 offen offset:1024 sc1
  buffer_load_dwordx4 a[72:75], v2, s[8:11], s22 offen offset:2048 sc1
  buffer_load_dwordx4 a[76:79], v2, s[8:11], s22 offen offset:3072 sc1
  s_add_u32 s22, s31, 307200
  buffer_load_dwordx4 a[80:83], v2, s[8:11], s22 offen offset:0 sc1
  buffer_load_dwordx4 a[84:87], v2, s[8:11], s22 offen offset:1024 sc1
  buffer_load_dwordx4 a[88:91], v2, s[8:11], s22 offen offset:2048 sc1
  buffer_load_dwordx4 a[92:95], v2, s[8:11], s22 offen offset:3072 sc1
  s_add_u32 s22, s31, 311296
  buffer_load_dwordx4 a[96:99], v2, s[8:11], s22 offen offset:0 sc1
  buffer_load_dwordx4 a[100:103], v2, s[8:11], s22 offen offset:1024 sc1
  buffer_load_dwordx4 a[104:107], v2, s[8:11], s22 offen offset:2048 sc1
  buffer_load_dwordx4 a[108:111], v2, s[8:11], s22 offen offset:3072 sc1
  s_add_u32 s22, s31, 315392
  buffer_load_dwordx4 a[112:115], v2, s[8:11], s22 offen offset:0 sc1
  buffer_load_dwordx4 a[116:119], v2, s[8:11], s22 offen offset:1024 sc1
  buffer_load_dwordx4 a[120:123], v2, s[8:11], s22 offen offset:2048 sc1
  buffer_load_dwordx4 a[124:127], v2, s[8:11], s22 offen offset:3072 sc1
  s_waitcnt vmcnt(24)
  s_add_u32 s22, s31, 319488
  buffer_load_dwordx4 a[128:131], v2, s[8:11], s22 offen offset:0 sc1
  buffer_load_dwordx4 a[132:135], v2, s[8:11], s22 offen offset:1024 sc1
  buffer_load_dwordx4 a[136:139], v2, s[8:11], s22 offen offset:2048 sc1
  buffer_load_dwordx4 a[140:143], v2, s[8:11], s22 offen offset:3072 sc1
  s_add_u32 s22, s31, 323584
  buffer_load_dwordx4 a[144:147], v2, s[8:11], s22 offen offset:0 sc1
  buffer_load_dwordx4 a[148:151], v2, s[8:11], s22 offen offset:1024 sc1
  buffer_load_dwordx4 a[152:155], v2, s[8:11], s22 offen offset:2048 sc1
  buffer_load_dwordx4 a[156:159], v2, s[8:11], s22 offen offset:3072 sc1
  s_add_u32 s22, s31, 327680
  buffer_load_dwordx4 a[160:163], v2, s[8:11], s22 offen offset:0 sc1
  buffer_load_dwordx4 a[164:167], v2, s[8:11], s22 offen offset:1024 sc1
  buffer_load_dwordx4 a[168:171], v2, s[8:11], s22 offen offset:2048 sc1
  buffer_load_dwordx4 a[172:175], v2, s[8:11], s22 offen offset:3072 sc1
  s_add_u32 s22, s31, 331776
  buffer_load_dwordx4 a[176:179], v2, s[8:11], s22 offen offset:0 sc1
  buffer_load_dwordx4 a[180:183], v2, s[8:11], s22 offen offset:1024 sc1
  buffer_load_dwordx4 a[184:187], v2, s[8:11], s22 offen offset:2048 sc1
  buffer_load_dwordx4 a[188:191], v2, s[8:11], s22 offen offset:3072 sc1
  s_add_u32 s22, s31, 335872
  buffer_load_dwordx4 a[192:195], v2, s[8:11], s22 offen offset:0 sc1
  buffer_load_dwordx4 a[196:199], v2, s[8:11], s22 offen offset:1024 sc1
  buffer_load_dwordx4 a[200:203], v2, s[8:11], s22 offen offset:2048 sc1
  buffer_load_dwordx4 a[204:207], v2, s[8:11], s22 offen offset:3072 sc1
  s_add_u32 s22, s31, 339968
  buffer_load_dwordx4 a[208:211], v2, s[8:11], s22 offen offset:0 sc1
  buffer_load_dwordx4 a[212:215], v2, s[8:11], s22 offen offset:1024 sc1
  buffer_load_dwordx4 a[216:219], v2, s[8:11], s22 offen offset:2048 sc1
  buffer_load_dwordx4 a[220:223], v2, s[8:11], s22 offen offset:3072 sc1
  s_add_u32 s22, s31, 344064
  buffer_load_dwordx4 a[224:227], v2, s[8:11], s22 offen offset:0 sc1
  buffer_load_dwordx4 a[228:231], v2, s[8:11], s22 offen offset:1024 sc1
  buffer_load_dwordx4 a[232:235], v2, s[8:11], s22 offen offset:2048 sc1
  buffer_load_dwordx4 a[236:239], v2, s[8:11], s22 offen offset:3072 sc1
  s_add_u32 s22, s31, 348160
  buffer_load_dwordx4 a[240:243], v2, s[8:11], s22 offen offset:0 sc1
  buffer_load_dwordx4 a[244:247], v2, s[8:11], s22 offen offset:1024 sc1
  buffer_load_dwordx4 a[248:251], v2, s[8:11], s22 offen offset:2048 sc1
  buffer_load_dwordx4 a[252:255], v2, s[8:11], s22 offen offset:3072 sc1
  s_waitcnt vmcnt(24)
  s_add_u32 s22, s31, 352256
  buffer_load_dwordx4 v[120:123], v2, s[8:11], s22 offen offset:0 sc1
  buffer_load_dwordx4 v[124:127], v2, s[8:11], s22 offen offset:1024 sc1
  buffer_load_dwordx4 v[128:131], v2, s[8:11], s22 offen offset:2048 sc1
  buffer_load_dwordx4 v[132:135], v2, s[8:11], s22 offen offset:3072 sc1
  s_add_u32 s22, s31, 356352
  buffer_load_dwordx4 v[136:139], v2, s[8:11], s22 offen offset:0 sc1
  buffer_load_dwordx4 v[140:143], v2, s[8:11], s22 offen offset:1024 sc1
  buffer_load_dwordx4 v[144:147], v2, s[8:11], s22 offen offset:2048 sc1
  buffer_load_dwordx4 v[148:151], v2, s[8:11], s22 offen offset:3072 sc1
  s_add_u32 s22, s31, 360448
  buffer_load_dwordx4 v[152:155], v2, s[8:11], s22 offen offset:0 sc1
  buffer_load_dwordx4 v[156:159], v2, s[8:11], s22 offen offset:1024 sc1
  buffer_load_dwordx4 v[160:163], v2, s[8:11], s22 offen offset:2048 sc1
  buffer_load_dwordx4 v[164:167], v2, s[8:11], s22 offen offset:3072 sc1
  s_add_u32 s22, s31, 364544
  buffer_load_dwordx4 v[168:171], v2, s[8:11], s22 offen offset:0 sc1
  buffer_load_dwordx4 v[172:175], v2, s[8:11], s22 offen offset:1024 sc1
  buffer_load_dwordx4 v[176:179], v2, s[8:11], s22 offen offset:2048 sc1
  buffer_load_dwordx4 v[180:183], v2, s[8:11], s22 offen offset:3072 sc1
  s_add_u32 s22, s31, 368640
  buffer_load_dwordx4 v[184:187], v2, s[8:11], s22 offen offset:0 sc1
  buffer_load_dwordx4 v[188:191], v2, s[8:11], s22 offen offset:1024 sc1
  buffer_load_dwordx4 v[192:195], v2, s[8:11], s22 offen offset:2048 sc1
  buffer_load_dwordx4 v[196:199], v2, s[8:11], s22 offen offset:3072 sc1
  s_add_u32 s22, s31, 372736
  buffer_load_dwordx4 v[200:203], v2, s[8:11], s22 offen offset:0 sc1
  buffer_load_dwordx4 v[204:207], v2, s[8:11], s22 offen offset:1024 sc1
  buffer_load_dwordx4 v[208:211], v2, s[8:11], s22 offen offset:2048 sc1
  buffer_load_dwordx4 v[212:215], v2, s[8:11], s22 offen offset:3072 sc1
  s_add_u32 s22, s31, 376832
  buffer_load_dwordx4 v[216:219], v2, s[8:11], s22 offen offset:0 sc1
  buffer_load_dwordx4 v[220:223], v2, s[8:11], s22 offen offset:1024 sc1
  buffer_load_dwordx4 v[224:227], v2, s[8:11], s22 offen offset:2048 sc1
  buffer_load_dwordx4 v[228:231], v2, s[8:11], s22 offen offset:3072 sc1
  s_add_u32 s22, s31, 380928
  buffer_load_dwordx4 v[232:235], v2, s[8:11], s22 offen offset:0 sc1
  buffer_load_dwordx4 v[236:239], v2, s[8:11], s22 offen offset:1024 sc1
  buffer_load_dwordx4 v[240:243], v2, s[8:11], s22 offen offset:2048 sc1
  buffer_load_dwordx4 v[244:247], v2, s[8:11], s22 offen offset:3072 sc1
  s_waitcnt vmcnt(24)
  s_add_u32 s22, s31, 385024
  buffer_load_dwordx4 v[248:251], v2, s[8:11], s22 offen offset:0 sc1
  buffer_load_dwordx4 v[252:255], v2, s[8:11], s22 offen offset:1024 sc1
  v_mov_b32 v72, v116
  v_mov_b32 v73, v117
  v_lshrrev_b32 v65, 1, v72
  v_and_b32 v66, 1, v72
  v_add_u32 v67, 20, v65
  v_lshl_add_u32 v67, v67, 4, v73
  v_mul_u32_u24 v68, 2341, v67
  v_lshrrev_b32 v68, 16, v68
  v_mul_u32_u24 v69, 28, v68
  v_sub_u32 v69, v67, v69
  v_lshrrev_b32 v70, 4, v69
  v_and_b32 v69, 15, v69
  v_and_b32 v71, 1, v69
  v_lshrrev_b32 v69, 1, v69
  v_lshl_add_u32 v69, v71, 3, v69
  v_lshlrev_b32 v71, 12, v70
  v_lshl_add_u32 v71, v68, 8, v71
  v_lshl_add_u32 v71, v69, 4, v71
  v_lshl_add_u32 v112, v66, 3, v71
  v_add_u32 v67, 22, v65
  v_lshl_add_u32 v67, v67, 4, v73
  v_mul_u32_u24 v68, 2341, v67
  v_lshrrev_b32 v68, 16, v68
  v_mul_u32_u24 v69, 28, v68
  v_sub_u32 v69, v67, v69
  v_lshrrev_b32 v70, 4, v69
  v_and_b32 v69, 15, v69
  v_and_b32 v71, 1, v69
  v_lshrrev_b32 v69, 1, v69
  v_lshl_add_u32 v69, v71, 3, v69
  v_lshlrev_b32 v71, 12, v70
  v_lshl_add_u32 v71, v68, 8, v71
  v_lshl_add_u32 v71, v69, 4, v71
  v_lshl_add_u32 v113, v66, 3, v71
  v_add_u32 v67, 24, v65
  v_lshl_add_u32 v67, v67, 4, v73
  v_mul_u32_u24 v68, 2341, v67
  v_lshrrev_b32 v68, 16, v68
  v_mul_u32_u24 v69, 28, v68
  v_sub_u32 v69, v67, v69
  v_lshrrev_b32 v70, 4, v69
  v_and_b32 v69, 15, v69
  v_and_b32 v71, 1, v69
  v_lshrrev_b32 v69, 1, v69
  v_lshl_add_u32 v69, v71, 3, v69
  v_lshlrev_b32 v71, 12, v70
  v_lshl_add_u32 v71, v68, 8, v71
  v_lshl_add_u32 v71, v69, 4, v71
  v_lshl_add_u32 v114, v66, 3, v71
  v_add_u32 v67, 26, v65
  v_lshl_add_u32 v67, v67, 4, v73
  v_mul_u32_u24 v68, 2341, v67
  v_lshrrev_b32 v68, 16, v68
  v_mul_u32_u24 v69, 28, v68
  v_sub_u32 v69, v67, v69
  v_lshrrev_b32 v70, 4, v69
  v_and_b32 v69, 15, v69
  v_and_b32 v71, 1, v69
  v_lshrrev_b32 v69, 1, v69
  v_lshl_add_u32 v69, v71, 3, v69
  v_lshlrev_b32 v71, 12, v70
  v_lshl_add_u32 v71, v68, 8, v71
  v_lshl_add_u32 v71, v69, 4, v71
  v_lshl_add_u32 v115, v66, 3, v71
  s_mul_i32 s24, s17, 532480
  s_add_u32 s24, s24, 76931072
  s_mul_i32 s34, s17, 640
  s_add_u32 s34, s34, 88569860
  s_mul_i32 s36, s17, 448
  v_add_u32 v0, s36, v2
  v_add_u32 v0, 8192, v0
  s_add_u32 s36, s36, 88068096
  v_cmp_gt_u32 s[26:27], 28, v1
  v_and_b32 v119, 31, v1
  v_lshlrev_b32 v119, 2, v119
  s_add_u32 s22, s17, 16
  s_and_b32 s22, s22, 31
  s_lshl_b32 s22, s22, 7
  s_add_u32 s22, s22, 21504
  v_add_u32 v119, s22, v119
  v_min_u32 v118, 13, v1
  s_mul_i32 s22, s17, 14
  v_add_u32 v118, s22, v118
  v_lshlrev_b32 v118, 7, v118
  v_add_u32 v118, 57344, v118
  s_mov_b32 s39, 71565312
  v_add_u32 v1, 59392, v2
  v_mov_b32 v117, 1
  s_mul_i32 s38, s17, 1104
  s_add_u32 s38, s38, 26624
  s_lshl_b32 s22, 0, 11
  s_add_u32 s22, s22, 88590336
  v_add_u32 v36, 1024, v2
  v_min_u32 v36, 1776, v36
  s_mov_b32 s30, 0
va_iw7:
  buffer_load_dwordx4 v[40:43], v2, s[8:11], s22 offen sc1
  buffer_load_dwordx4 v[44:47], v36, s[8:11], s22 offen sc1
  s_waitcnt vmcnt(0)
  v_cmp_ne_u64 vcc, s[88:89], v[40:41]
  s_cbranch_vccnz va_iw7_no
  v_cmp_ne_u64 vcc, s[88:89], v[42:43]
  s_cbranch_vccnz va_iw7_no
  v_cmp_ne_u64 vcc, s[88:89], v[44:45]
  s_cbranch_vccnz va_iw7_no
  v_cmp_ne_u64 vcc, s[88:89], v[46:47]
  s_cbranch_vccnz va_iw7_no
  s_branch va_iw7_ok
va_iw7_no:
  s_sleep 2
  s_add_u32 s30, s30, 1
  s_cmp_lt_u32 s30, 50000
  s_cbranch_scc1 va_iw7
  s_branch cA_abort
va_iw7_ok:
  s_mov_b32 s30, 0
  v_mov_b32 v36, 0
ch_md7:
  buffer_load_dword v37, v36, s[12:15], 0 offen sc1
  s_waitcnt vmcnt(0)
  v_readfirstlane_b32 s22, v37
  s_and_b32 s31, s22, 0xffff
  s_cmp_ge_u32 s31, 32
  s_cbranch_scc1 ch_go7
  s_sleep 2
  s_add_u32 s30, s30, 1
  s_cmp_lt_u32 s30, 50000
  s_cbranch_scc1 ch_md7
  s_branch ch_end
ch_go7:
  s_mov_b32 s31, 0
  s_lshr_b32 s22, s22, 16
  s_cmp_lg_u32 s22, 0
  s_cbranch_scc1 cB_va3_loop
  s_branch cA_va3_loop
.p2align 6

cA_sc0_loop:
  s_add_u32 s23, s20, 4096
  s_add_u32 s21, s20, 25600
  v_mov_b32 v48, 0
  v_mov_b32 v49, 0
  v_mov_b32 v50, 0
  v_mov_b32 v51, 0
  v_mov_b32 v52, 0
  v_mov_b32 v53, 0
  v_mov_b32 v54, 0
  v_mov_b32 v55, 0
  v_mov_b32 v56, 0
  v_mov_b32 v57, 0
  v_mov_b32 v58, 0
  v_mov_b32 v59, 0
  v_mov_b32 v60, 0
  v_mov_b32 v61, 0
  v_mov_b32 v62, 0
  v_mov_b32 v63, 0
  v_mov_b32 v88, 0
  v_mov_b32 v89, 0
  v_mov_b32 v90, 0
  v_mov_b32 v91, 0
  v_mov_b32 v92, 0
  v_mov_b32 v93, 0
  v_mov_b32 v94, 0
  v_mov_b32 v95, 0
  v_mov_b32 v66, 0
  v_mov_b32 v67, 0
  s_mov_b32 s30, 0
  s_mov_b32 s62, 0
  buffer_load_dword v68, v0, s[8:11], s20 offen sc1
  s_nop 7
  buffer_load_dword v69, v0, s[8:11], s20 offen sc1
  s_nop 7
  buffer_load_dword v70, v0, s[8:11], s20 offen sc1
  s_nop 7
  buffer_load_dword v71, v0, s[8:11], s20 offen sc1
  s_nop 7
  buffer_load_dword v72, v0, s[8:11], s20 offen sc1
cA_sc0_fp_l:
  s_waitcnt vmcnt(4)
  v_cmp_eq_u32 vcc, -1, v68
  s_cbranch_vccz cA_sc0_fp_d
  buffer_load_dword v68, v0, s[8:11], s20 offen sc1
  s_waitcnt vmcnt(4)
  v_cmp_eq_u32 vcc, -1, v69
  s_cbranch_vccz cA_sc0_fp_d
  buffer_load_dword v69, v0, s[8:11], s20 offen sc1
  s_waitcnt vmcnt(4)
  v_cmp_eq_u32 vcc, -1, v70
  s_cbranch_vccz cA_sc0_fp_d
  buffer_load_dword v70, v0, s[8:11], s20 offen sc1
  s_waitcnt vmcnt(4)
  v_cmp_eq_u32 vcc, -1, v71
  s_cbranch_vccz cA_sc0_fp_d
  buffer_load_dword v71, v0, s[8:11], s20 offen sc1
  s_waitcnt vmcnt(4)
  v_cmp_eq_u32 vcc, -1, v72
  s_cbranch_vccz cA_sc0_fp_d
  buffer_load_dword v72, v0, s[8:11], s20 offen sc1
  s_add_u32 s30, s30, 1
  s_cmp_lt_u32 s30, 400000
  s_cbranch_scc1 cA_sc0_fp_l
  s_branch cA_abort
cA_sc0_fp_d:
  buffer_load_dwordx4 v[8:11], v2, s[8:11], s20 offen offset:0
  s_barrier
  s_branch cA_sc0_ld1
cA_sc0_ld:
  buffer_load_dwordx4 v[8:11], v2, s[8:11], s20 offen offset:0
cA_sc0_ld1:
  v_mov_b32 v36, 0
  v_mov_b32 v37, 0
  v_mov_b32 v38, 0
  v_mov_b32 v39, 0
  buffer_load_dwordx4 v[12:15], v2, s[8:11], s20 offen offset:1024
  v_mov_b32 v40, 0
  v_mov_b32 v41, 0
  v_mov_b32 v42, 0
  v_mov_b32 v43, 0
  buffer_load_dwordx4 v[16:19], v2, s[8:11], s20 offen offset:2048
  v_mov_b32 v44, 0
  v_mov_b32 v45, 0
  v_mov_b32 v46, 0
  v_mov_b32 v47, 0
  ds_read_b128 v[96:99], v117 offset:0
  ds_read_b128 v[100:103], v117 offset:1024
  ds_read_b128 v[104:107], v117 offset:14336
  ds_read_b128 v[108:111], v117 offset:15360
  s_waitcnt vmcnt(2)
  v_smfmac_f32_16x16x64_bf16 v[36:39], v[8:11], a[0:7], v3
  v_smfmac_f32_16x16x64_bf16 v[40:43], v[8:11], a[56:63], v3
  buffer_load_dwordx4 v[20:23], v2, s[8:11], s20 offen offset:3072
  v_smfmac_f32_16x16x64_bf16 v[44:47], v[8:11], a[112:119], v3
  v_smfmac_f32_16x16x64_bf16 v[48:51], v[8:11], a[168:175], v3
  v_smfmac_f32_16x16x64_bf16 v[52:55], v[8:11], a[224:231], v3
  buffer_load_dwordx4 v[24:27], v2, s[8:11], s23 offen offset:0
  v_smfmac_f32_16x16x64_bf16 v[56:59], v[8:11], v[144:151], v3
  v_smfmac_f32_16x16x64_bf16 v[60:63], v[8:11], v[200:207], v3
  s_waitcnt vmcnt(3)
  v_smfmac_f32_16x16x64_bf16 v[36:39], v[12:15], a[8:15], v3
  v_smfmac_f32_16x16x64_bf16 v[40:43], v[12:15], a[64:71], v3
  buffer_load_dwordx4 v[28:31], v2, s[8:11], s23 offen offset:1024
  v_smfmac_f32_16x16x64_bf16 v[44:47], v[12:15], a[120:127], v3
  v_smfmac_f32_16x16x64_bf16 v[48:51], v[12:15], a[176:183], v3
  v_smfmac_f32_16x16x64_bf16 v[52:55], v[12:15], a[232:239], v3
  buffer_load_dwordx4 v[32:35], v2, s[8:11], s23 offen offset:2048
  v_smfmac_f32_16x16x64_bf16 v[56:59], v[12:15], v[152:159], v3
  v_smfmac_f32_16x16x64_bf16 v[60:63], v[12:15], v[208:215], v3
  s_waitcnt vmcnt(4)
  v_smfmac_f32_16x16x64_bf16 v[36:39], v[16:19], a[16:23], v3
  v_smfmac_f32_16x16x64_bf16 v[40:43], v[16:19], a[72:79], v3
  v_smfmac_f32_16x16x64_bf16 v[44:47], v[16:19], a[128:135], v3
  v_smfmac_f32_16x16x64_bf16 v[48:51], v[16:19], a[184:191], v3
  v_smfmac_f32_16x16x64_bf16 v[52:55], v[16:19], a[240:247], v3
  v_smfmac_f32_16x16x64_bf16 v[56:59], v[16:19], v[160:167], v3
  v_smfmac_f32_16x16x64_bf16 v[60:63], v[16:19], v[216:223], v3
  s_waitcnt vmcnt(3)
  v_smfmac_f32_16x16x64_bf16 v[36:39], v[20:23], a[24:31], v3
  v_smfmac_f32_16x16x64_bf16 v[40:43], v[20:23], a[80:87], v3
  v_smfmac_f32_16x16x64_bf16 v[44:47], v[20:23], a[136:143], v3
  v_smfmac_f32_16x16x64_bf16 v[48:51], v[20:23], a[192:199], v3
  v_smfmac_f32_16x16x64_bf16 v[52:55], v[20:23], a[248:255], v3
  v_smfmac_f32_16x16x64_bf16 v[56:59], v[20:23], v[168:175], v3
  v_smfmac_f32_16x16x64_bf16 v[60:63], v[20:23], v[224:231], v3
  s_waitcnt vmcnt(0)
cA_sc0_ph2:
  v_smfmac_f32_16x16x64_bf16 v[60:63], v[24:27], v[232:239], v3
  ds_read_b128 v[12:15], v116 offset:0
  ds_read_b128 v[16:19], v116 offset:1024
  v_smfmac_f32_16x16x64_bf16 v[60:63], v[28:31], v[240:247], v3
  v_smfmac_f32_16x16x64_bf16 v[60:63], v[32:35], v[248:255], v3
  v_mov_b32 v80, v24
  v_smfmac_f32_16x16x64_bf16 v[52:55], v[24:27], v[120:127], v3
  v_mov_b32 v81, v25
  v_smfmac_f32_16x16x64_bf16 v[52:55], v[28:31], v[128:135], v3
  v_mov_b32 v82, v32
  v_smfmac_f32_16x16x64_bf16 v[52:55], v[32:35], v[136:143], v3
  v_cvt_pk_bf16_f32 v64, v60, v61
  v_smfmac_f32_16x16x64_bf16 v[56:59], v[24:27], v[176:183], v3
  v_cvt_pk_bf16_f32 v65, v62, v63
  v_smfmac_f32_16x16x64_bf16 v[56:59], v[28:31], v[184:191], v3
  v_mov_b32 v83, v33
  v_mfma_f32_16x16x32_bf16 v[68:71], v[64:67], v[4:7], 0
  v_smfmac_f32_16x16x64_bf16 v[56:59], v[32:35], v[192:199], v3
  v_cvt_pk_bf16_f32 v64, v52, v53
  v_smfmac_f32_16x16x64_bf16 v[36:39], v[24:27], a[32:39], v3
  v_cvt_pk_bf16_f32 v65, v54, v55
  v_smfmac_f32_16x16x64_bf16 v[36:39], v[28:31], a[40:47], v3
  v_cvt_pk_bf16_f32 v78, v68, v69
  v_smfmac_f32_16x16x64_bf16 v[36:39], v[32:35], a[48:55], v3
  v_cvt_pk_bf16_f32 v79, v70, v71
  v_cvt_pk_bf16_f32 v66, v56, v57
  v_smfmac_f32_16x16x64_bf16 v[40:43], v[24:27], a[88:95], v3
  v_cvt_pk_bf16_f32 v67, v58, v59
  v_smfmac_f32_16x16x64_bf16 v[40:43], v[28:31], a[96:103], v3
  v_mfma_f32_16x16x32_bf16 v[72:75], v[64:67], v[4:7], 0
  ds_read_b128 v[52:55], v116 offset:14336
  ds_read_b128 v[56:59], v116 offset:15360
  v_smfmac_f32_16x16x64_bf16 v[40:43], v[32:35], a[104:111], v3
  v_cvt_pk_bf16_f32 v64, v36, v37
  v_smfmac_f32_16x16x64_bf16 v[44:47], v[24:27], a[144:151], v3
  v_cvt_pk_bf16_f32 v65, v38, v39
  v_smfmac_f32_16x16x64_bf16 v[44:47], v[28:31], a[152:159], v3
  v_cvt_pk_bf16_f32 v76, v72, v73
  v_smfmac_f32_16x16x64_bf16 v[44:47], v[32:35], a[160:167], v3
  v_cvt_pk_bf16_f32 v77, v74, v75
  v_cvt_pk_bf16_f32 v66, v40, v41
  v_smfmac_f32_16x16x64_bf16 v[48:51], v[24:27], a[200:207], v3
  v_cvt_pk_bf16_f32 v67, v42, v43
  v_smfmac_f32_16x16x64_bf16 v[48:51], v[28:31], a[208:215], v3
  v_mfma_f32_16x16x32_bf16 v[68:71], v[64:67], v[4:7], 0
  v_smfmac_f32_16x16x64_bf16 v[48:51], v[32:35], a[216:223], v3
  v_cvt_pk_bf16_f32 v64, v44, v45
  v_mfma_f32_16x16x32_bf16 v[84:87], v[80:83], v[76:79], 0
  v_cvt_pk_bf16_f32 v65, v46, v47
  s_waitcnt lgkmcnt(0)
  v_smfmac_f32_16x16x64_bf16 v[88:91], v[76:79], v[96:103], v3
  v_cvt_pk_bf16_f32 v60, v68, v69
  v_cvt_pk_bf16_f32 v61, v70, v71
  v_cvt_pk_bf16_f32 v66, v48, v49
  v_cvt_pk_bf16_f32 v67, v50, v51
  s_nop 1
  v_mfma_f32_16x16x32_bf16 v[72:75], v[64:67], v[4:7], 0
  v_smfmac_f32_16x16x64_bf16 v[92:95], v[76:79], v[104:111], v3
  s_nop 4
  v_cvt_pk_bf16_f32 v62, v72, v73
  v_cvt_pk_bf16_f32 v63, v74, v75
  s_nop 1
  v_mfma_f32_16x16x32_bf16 v[84:87], v[8:11], v[60:63], v[84:87]
  v_smfmac_f32_16x16x64_bf16 v[88:91], v[60:63], v[12:19], v3
  v_smfmac_f32_16x16x64_bf16 v[92:95], v[60:63], v[52:59], v3
  s_mov_b64 exec, s[26:27]
  s_nop 0
  ds_write_b128 v113, v[84:87]
  s_mov_b64 exec, -1
  s_nop 0
  v_cmp_u_f32 vcc, v88, v89
  s_nop 1
  v_permlane32_swap_b32 v88, v92
  v_permlane32_swap_b32 v89, v93
  v_permlane32_swap_b32 v90, v94
  v_permlane32_swap_b32 v91, v95
  v_add_f32 v88, v88, v92
  v_add_f32 v89, v89, v93
  v_add_f32 v90, v90, v94
  v_add_f32 v91, v91, v95
  ds_write_b128 v112, v[88:91]
  s_cbranch_vccnz cA_sc0_retry
cA_sc0_cont:
  s_waitcnt lgkmcnt(0)
  s_barrier
  ds_read_b64 v[36:37], v114 offset:0
  ds_read_b64 v[38:39], v114 offset:1024
  ds_read2_b32 v[44:45], v115 offset0:0 offset1:64
  s_waitcnt lgkmcnt(0)
  v_add_f32 v44, v44, v45
  v_add_f32 v36, v36, v38
  v_add_f32 v37, v37, v39
  v_add_f32_dpp v44, v44, v44 row_ror:8 row_mask:0xf bank_mask:0xf
  v_mov_b32 v45, v44
  v_permlane32_swap_b32 v36, v37
  v_add_f32 v36, v36, v37
  v_permlane16_swap_b32 v44, v45
  v_add_f32 v44, v44, v45
  v_exp_f32 v48, v36
  v_exp_f32 v49, v44
  v_add_f32 v50, abs(v36), abs(v44)
  v_fma_f32 v39, v49, s37, v48
  v_cmp_ngt_f32 vcc, s56, v50
  v_cndmask_b32 v41, v48, v49, s[38:39]
  v_add_f32_dpp v39, v39, v39 quad_perm:[1,0,3,2] row_mask:0xf bank_mask:0xf
  v_cndmask_b32 v40, v49, v48, s[38:39]
  v_mov_b32_dpp v46, v41 quad_perm:[1,0,3,2] row_mask:0xf bank_mask:0xf
  v_add_f32_dpp v39, v39, v39 quad_perm:[2,3,0,1] row_mask:0xf bank_mask:0xf
  v_cndmask_b32 v42, v46, v40, s[38:39]
  v_cndmask_b32 v43, v40, v46, s[38:39]
  v_add_f32_dpp v39, v39, v39 row_half_mirror row_mask:0xf bank_mask:0xf
  s_cbranch_vccnz cA_sc0_slow
  s_nop 0
  v_add_f32_dpp v39, v39, v39 row_mirror row_mask:0xf bank_mask:0xf
  v_mov_b32 v47, v39
  s_nop 1
  v_permlane16_swap_b32 v39, v47
  v_add_f32 v39, v39, v47
  v_rcp_f32 v39, v39
  s_mov_b64 exec, s[28:29]
  v_mul_f32 v42, v42, v39
  v_mul_f32 v43, v43, v39
  v_cvt_pk_bf16_f32 v42, v42, v43
cA_sc0_pst:
  buffer_store_dword v42, v1, s[8:11], s20 offen
  s_mov_b64 exec, -1
  s_barrier
  s_add_u32 s24, s24, 28672
  s_add_u32 s35, s35, 28672
  s_xor_b32 s25, s25, 28672
  s_add_u32 m0, s25, 0
  s_nop 0
  buffer_load_dwordx4 v2, s[8:11], s24 offen offset:0 sc1 lds
  buffer_load_dwordx4 v2, s[8:11], s24 offen offset:1024 sc1 lds
  buffer_load_dwordx4 v2, s[8:11], s24 offen offset:2048 sc1 lds
  buffer_load_dwordx4 v2, s[8:11], s24 offen offset:3072 sc1 lds
  s_add_u32 m0, s25, 4096
  s_add_u32 s22, s24, 4096
  buffer_load_dwordx4 v2, s[8:11], s22 offen offset:0 sc1 lds
  buffer_load_dwordx4 v2, s[8:11], s22 offen offset:1024 sc1 lds
  buffer_load_dwordx4 v2, s[8:11], s22 offen offset:2048 sc1 lds
  v_xor_b32 v116, 28672, v116
  v_add_u32 v117, s57, v117
  s_sub_u32 s57, 0, s57
  s_add_u32 s19, s19, 1
  s_mov_b32 s20, s21
  s_cmp_lt_u32 s19, 63
  s_cbranch_scc1 cA_sc0_loop
  s_branch cA_done
cA_sc0_slow:
  v_max_f32 v50, v36, v44
  s_nop 1
  v_max_f32_dpp v50, v50, v50 quad_perm:[1,0,3,2] row_mask:0xf bank_mask:0xf
  s_nop 1
  v_max_f32_dpp v50, v50, v50 quad_perm:[2,3,0,1] row_mask:0xf bank_mask:0xf
  s_nop 1
  v_max_f32_dpp v50, v50, v50 row_half_mirror row_mask:0xf bank_mask:0xf
  s_nop 1
  v_max_f32_dpp v50, v50, v50 row_mirror row_mask:0xf bank_mask:0xf
  v_mov_b32 v47, v50
  s_nop 1
  v_permlane16_swap_b32 v50, v47
  v_max_f32 v50, v50, v47
  v_sub_f32 v48, v36, v50
  v_sub_f32 v49, v44, v50
  v_exp_f32 v48, v48
  v_exp_f32 v49, v49
  s_add_u32 s31, s31, 0x100
  v_fma_f32 v39, v49, s37, v48
  v_cndmask_b32 v41, v48, v49, s[38:39]
  s_nop 0
  v_add_f32_dpp v39, v39, v39 quad_perm:[1,0,3,2] row_mask:0xf bank_mask:0xf
  v_cndmask_b32 v40, v49, v48, s[38:39]
  v_mov_b32_dpp v46, v41 quad_perm:[1,0,3,2] row_mask:0xf bank_mask:0xf
  v_add_f32_dpp v39, v39, v39 quad_perm:[2,3,0,1] row_mask:0xf bank_mask:0xf
  v_cndmask_b32 v42, v46, v40, s[38:39]
  v_cndmask_b32 v43, v40, v46, s[38:39]
  v_add_f32_dpp v39, v39, v39 row_half_mirror row_mask:0xf bank_mask:0xf
  s_nop 1
  v_add_f32_dpp v39, v39, v39 row_mirror row_mask:0xf bank_mask:0xf
  v_mov_b32 v47, v39
  s_nop 1
  v_permlane16_swap_b32 v39, v47
  v_add_f32 v39, v39, v47
  v_rcp_f32 v39, v39
  s_mov_b64 exec, s[28:29]
  v_mul_f32 v42, v42, v39
  v_mul_f32 v43, v43, v39
  v_cvt_pk_bf16_f32 v42, v42, v43
  v_min_u32 v42, -2, v42
  s_branch cA_sc0_pst
cA_sc0_retry:
  s_cmp_lg_u32 s62, 0
  s_cbranch_scc1 cA_sc0_cont
  s_waitcnt vmcnt(0) lgkmcnt(0)
cA_sc0_rv:
  buffer_load_dwordx4 v[8:11], v2, s[8:11], s20 offen offset:0 sc1
  buffer_load_dwordx4 v[12:15], v2, s[8:11], s20 offen offset:1024 sc1
  buffer_load_dwordx4 v[16:19], v2, s[8:11], s20 offen offset:2048 sc1
  buffer_load_dwordx4 v[20:23], v2, s[8:11], s20 offen offset:3072 sc1
  buffer_load_dwordx4 v[24:27], v2, s[8:11], s23 offen offset:0 sc1
  buffer_load_dwordx4 v[28:31], v2, s[8:11], s23 offen offset:1024 sc1
  buffer_load_dwordx4 v[32:35], v2, s[8:11], s23 offen offset:2048 sc1
  s_waitcnt vmcnt(0)
  v_max3_u32 v118, v8, v9, v10
  v_max3_u32 v118, v118, v11, v12
  v_max3_u32 v118, v118, v13, v14
  v_max3_u32 v118, v118, v15, v16
  v_max3_u32 v118, v118, v17, v18
  v_max3_u32 v118, v118, v19, v20
  v_max3_u32 v118, v118, v21, v22
  v_max3_u32 v118, v118, v23, v24
  v_max3_u32 v118, v118, v25, v26
  v_max3_u32 v118, v118, v27, v28
  v_max3_u32 v118, v118, v29, v30
  v_max3_u32 v118, v118, v31, v32
  v_max3_u32 v118, v118, v33, v34
  v_max_u32 v118, v118, v35
  v_cmp_eq_u32 vcc, -1, v118
  s_cbranch_vccz cA_sc0_rk
  s_add_u32 s30, s30, 1
  s_cmp_lt_u32 s30, 400000
  s_cbranch_scc1 cA_sc0_rv
  s_branch cA_abort
cA_sc0_rk:
  s_mov_b32 s62, 1
  v_mov_b32 v36, 0
  v_mov_b32 v37, 0
  v_mov_b32 v38, 0
  v_mov_b32 v39, 0
  v_mov_b32 v40, 0
  v_mov_b32 v41, 0
  v_mov_b32 v42, 0
  v_mov_b32 v43, 0
  v_mov_b32 v44, 0
  v_mov_b32 v45, 0
  v_mov_b32 v46, 0
  v_mov_b32 v47, 0
  v_mov_b32 v48, 0
  v_mov_b32 v49, 0
  v_mov_b32 v50, 0
  v_mov_b32 v51, 0
  v_mov_b32 v52, 0
  v_mov_b32 v53, 0
  v_mov_b32 v54, 0
  v_mov_b32 v55, 0
  v_mov_b32 v56, 0
  v_mov_b32 v57, 0
  v_mov_b32 v58, 0
  v_mov_b32 v59, 0
  v_mov_b32 v60, 0
  v_mov_b32 v61, 0
  v_mov_b32 v62, 0
  v_mov_b32 v63, 0
  v_mov_b32 v88, 0
  v_mov_b32 v89, 0
  v_mov_b32 v90, 0
  v_mov_b32 v91, 0
  v_mov_b32 v92, 0
  v_mov_b32 v93, 0
  v_mov_b32 v94, 0
  v_mov_b32 v95, 0
  v_mov_b32 v66, 0
  v_mov_b32 v67, 0
  s_add_u32 s31, s31, 1
  ds_read_b128 v[96:99], v117 offset:0
  ds_read_b128 v[100:103], v117 offset:1024
  ds_read_b128 v[104:107], v117 offset:14336
  ds_read_b128 v[108:111], v117 offset:15360
  v_smfmac_f32_16x16x64_bf16 v[36:39], v[8:11], a[0:7], v3
  v_smfmac_f32_16x16x64_bf16 v[40:43], v[8:11], a[56:63], v3
  v_smfmac_f32_16x16x64_bf16 v[44:47], v[8:11], a[112:119], v3
  v_smfmac_f32_16x16x64_bf16 v[48:51], v[8:11], a[168:175], v3
  v_smfmac_f32_16x16x64_bf16 v[52:55], v[8:11], a[224:231], v3
  v_smfmac_f32_16x16x64_bf16 v[56:59], v[8:11], v[144:151], v3
  v_smfmac_f32_16x16x64_bf16 v[60:63], v[8:11], v[200:207], v3
  v_smfmac_f32_16x16x64_bf16 v[36:39], v[12:15], a[8:15], v3
  v_smfmac_f32_16x16x64_bf16 v[40:43], v[12:15], a[64:71], v3
  v_smfmac_f32_16x16x64_bf16 v[44:47], v[12:15], a[120:127], v3
  v_smfmac_f32_16x16x64_bf16 v[48:51], v[12:15], a[176:183], v3
  v_smfmac_f32_16x16x64_bf16 v[52:55], v[12:15], a[232:239], v3
  v_smfmac_f32_16x16x64_bf16 v[56:59], v[12:15], v[152:159], v3
  v_smfmac_f32_16x16x64_bf16 v[60:63], v[12:15], v[208:215], v3
  v_smfmac_f32_16x16x64_bf16 v[36:39], v[16:19], a[16:23], v3
  v_smfmac_f32_16x16x64_bf16 v[40:43], v[16:19], a[72:79], v3
  v_smfmac_f32_16x16x64_bf16 v[44:47], v[16:19], a[128:135], v3
  v_smfmac_f32_16x16x64_bf16 v[48:51], v[16:19], a[184:191], v3
  v_smfmac_f32_16x16x64_bf16 v[52:55], v[16:19], a[240:247], v3
  v_smfmac_f32_16x16x64_bf16 v[56:59], v[16:19], v[160:167], v3
  v_smfmac_f32_16x16x64_bf16 v[60:63], v[16:19], v[216:223], v3
  v_smfmac_f32_16x16x64_bf16 v[36:39], v[20:23], a[24:31], v3
  v_smfmac_f32_16x16x64_bf16 v[40:43], v[20:23], a[80:87], v3
  v_smfmac_f32_16x16x64_bf16 v[44:47], v[20:23], a[136:143], v3
  v_smfmac_f32_16x16x64_bf16 v[48:51], v[20:23], a[192:199], v3
  v_smfmac_f32_16x16x64_bf16 v[52:55], v[20:23], a[248:255], v3
  v_smfmac_f32_16x16x64_bf16 v[56:59], v[20:23], v[168:175], v3
  v_smfmac_f32_16x16x64_bf16 v[60:63], v[20:23], v[224:231], v3
  s_branch cA_sc0_ph2
.p2align 6

cA_sc1_loop:
  s_add_u32 s23, s20, 4096
  s_add_u32 s21, s20, 25600
  v_mov_b32 v48, 0
  v_mov_b32 v49, 0
  v_mov_b32 v50, 0
  v_mov_b32 v51, 0
  v_mov_b32 v52, 0
  v_mov_b32 v53, 0
  v_mov_b32 v54, 0
  v_mov_b32 v55, 0
  v_mov_b32 v56, 0
  v_mov_b32 v57, 0
  v_mov_b32 v58, 0
  v_mov_b32 v59, 0
  v_mov_b32 v60, 0
  v_mov_b32 v61, 0
  v_mov_b32 v62, 0
  v_mov_b32 v63, 0
  v_mov_b32 v88, 0
  v_mov_b32 v89, 0
  v_mov_b32 v90, 0
  v_mov_b32 v91, 0
  v_mov_b32 v92, 0
  v_mov_b32 v93, 0
  v_mov_b32 v94, 0
  v_mov_b32 v95, 0
  v_mov_b32 v64, 0
  v_mov_b32 v65, 0
  s_mov_b32 s30, 0
  s_mov_b32 s62, 0
  s_waitcnt vmcnt(0)
  s_barrier
cA_sc1_ld:
  buffer_load_dwordx4 v[8:11], v2, s[8:11], s20 offen offset:0
  v_mov_b32 v36, 0
  v_mov_b32 v37, 0
  v_mov_b32 v38, 0
  v_mov_b32 v39, 0
  buffer_load_dwordx4 v[12:15], v2, s[8:11], s20 offen offset:1024
  v_mov_b32 v40, 0
  v_mov_b32 v41, 0
  v_mov_b32 v42, 0
  v_mov_b32 v43, 0
  buffer_load_dwordx4 v[16:19], v2, s[8:11], s20 offen offset:2048
  v_mov_b32 v44, 0
  v_mov_b32 v45, 0
  v_mov_b32 v46, 0
  v_mov_b32 v47, 0
  ds_read_b128 v[96:99], v117 offset:0
  ds_read_b128 v[100:103], v117 offset:1024
  ds_read_b128 v[104:107], v117 offset:14336
  ds_read_b128 v[108:111], v117 offset:15360
  s_waitcnt vmcnt(2)
  v_smfmac_f32_16x16x64_bf16 v[36:39], v[8:11], a[0:7], v3
  v_smfmac_f32_16x16x64_bf16 v[40:43], v[8:11], a[56:63], v3
  buffer_load_dwordx4 v[20:23], v2, s[8:11], s20 offen offset:3072
  v_smfmac_f32_16x16x64_bf16 v[44:47], v[8:11], a[112:119], v3
  v_smfmac_f32_16x16x64_bf16 v[48:51], v[8:11], a[168:175], v3
  v_smfmac_f32_16x16x64_bf16 v[52:55], v[8:11], a[224:231], v3
  buffer_load_dwordx4 v[24:27], v2, s[8:11], s23 offen offset:0
  v_smfmac_f32_16x16x64_bf16 v[56:59], v[8:11], v[144:151], v3
  v_smfmac_f32_16x16x64_bf16 v[60:63], v[8:11], v[200:207], v3
  s_waitcnt vmcnt(3)
  v_smfmac_f32_16x16x64_bf16 v[36:39], v[12:15], a[8:15], v3
  v_smfmac_f32_16x16x64_bf16 v[40:43], v[12:15], a[64:71], v3
  buffer_load_dwordx4 v[28:31], v2, s[8:11], s23 offen offset:1024
  v_smfmac_f32_16x16x64_bf16 v[44:47], v[12:15], a[120:127], v3
  v_smfmac_f32_16x16x64_bf16 v[48:51], v[12:15], a[176:183], v3
  v_smfmac_f32_16x16x64_bf16 v[52:55], v[12:15], a[232:239], v3
  buffer_load_dwordx4 v[32:35], v2, s[8:11], s23 offen offset:2048
  v_smfmac_f32_16x16x64_bf16 v[56:59], v[12:15], v[152:159], v3
  v_smfmac_f32_16x16x64_bf16 v[60:63], v[12:15], v[208:215], v3
  s_waitcnt vmcnt(4)
  v_smfmac_f32_16x16x64_bf16 v[36:39], v[16:19], a[16:23], v3
  v_smfmac_f32_16x16x64_bf16 v[40:43], v[16:19], a[72:79], v3
  v_smfmac_f32_16x16x64_bf16 v[44:47], v[16:19], a[128:135], v3
  v_smfmac_f32_16x16x64_bf16 v[48:51], v[16:19], a[184:191], v3
  v_smfmac_f32_16x16x64_bf16 v[52:55], v[16:19], a[240:247], v3
  v_smfmac_f32_16x16x64_bf16 v[56:59], v[16:19], v[160:167], v3
  v_smfmac_f32_16x16x64_bf16 v[60:63], v[16:19], v[216:223], v3
  s_waitcnt vmcnt(3)
  v_smfmac_f32_16x16x64_bf16 v[36:39], v[20:23], a[24:31], v3
  v_smfmac_f32_16x16x64_bf16 v[40:43], v[20:23], a[80:87], v3
  v_smfmac_f32_16x16x64_bf16 v[44:47], v[20:23], a[136:143], v3
  v_smfmac_f32_16x16x64_bf16 v[48:51], v[20:23], a[192:199], v3
  v_smfmac_f32_16x16x64_bf16 v[52:55], v[20:23], a[248:255], v3
  v_smfmac_f32_16x16x64_bf16 v[56:59], v[20:23], v[168:175], v3
  v_smfmac_f32_16x16x64_bf16 v[60:63], v[20:23], v[224:231], v3
  s_waitcnt vmcnt(0)
cA_sc1_ph2:
  v_smfmac_f32_16x16x64_bf16 v[60:63], v[24:27], v[232:239], v3
  ds_read_b128 v[16:19], v116 offset:2048
  ds_read_b128 v[20:23], v116 offset:3072
  v_smfmac_f32_16x16x64_bf16 v[60:63], v[28:31], v[240:247], v3
  buffer_load_dword v119, v0, s[8:11], s20 offen sc1
  v_smfmac_f32_16x16x64_bf16 v[60:63], v[32:35], v[248:255], v3
  v_mov_b32 v80, v26
  v_smfmac_f32_16x16x64_bf16 v[52:55], v[24:27], v[120:127], v3
  v_mov_b32 v81, v27
  v_smfmac_f32_16x16x64_bf16 v[52:55], v[28:31], v[128:135], v3
  v_mov_b32 v82, v32
  v_smfmac_f32_16x16x64_bf16 v[52:55], v[32:35], v[136:143], v3
  v_cvt_pk_bf16_f32 v66, v60, v61
  v_smfmac_f32_16x16x64_bf16 v[56:59], v[24:27], v[176:183], v3
  v_cvt_pk_bf16_f32 v67, v62, v63
  v_smfmac_f32_16x16x64_bf16 v[56:59], v[28:31], v[184:191], v3
  v_mov_b32 v83, v33
  v_mfma_f32_16x16x32_bf16 v[68:71], v[64:67], v[4:7], 0
  v_smfmac_f32_16x16x64_bf16 v[56:59], v[32:35], v[192:199], v3
  v_cvt_pk_bf16_f32 v64, v52, v53
  v_smfmac_f32_16x16x64_bf16 v[36:39], v[24:27], a[32:39], v3
  v_cvt_pk_bf16_f32 v65, v54, v55
  v_smfmac_f32_16x16x64_bf16 v[36:39], v[28:31], a[40:47], v3
  v_cvt_pk_bf16_f32 v78, v68, v69
  v_smfmac_f32_16x16x64_bf16 v[36:39], v[32:35], a[48:55], v3
  v_cvt_pk_bf16_f32 v79, v70, v71
  v_cvt_pk_bf16_f32 v66, v56, v57
  v_smfmac_f32_16x16x64_bf16 v[40:43], v[24:27], a[88:95], v3
  v_cvt_pk_bf16_f32 v67, v58, v59
  v_smfmac_f32_16x16x64_bf16 v[40:43], v[28:31], a[96:103], v3
  v_mfma_f32_16x16x32_bf16 v[72:75], v[64:67], v[4:7], 0
  ds_read_b128 v[52:55], v116 offset:16384
  ds_read_b128 v[56:59], v116 offset:17408
  v_smfmac_f32_16x16x64_bf16 v[40:43], v[32:35], a[104:111], v3
  v_cvt_pk_bf16_f32 v64, v36, v37
  v_smfmac_f32_16x16x64_bf16 v[44:47], v[24:27], a[144:151], v3
  v_cvt_pk_bf16_f32 v65, v38, v39
  v_smfmac_f32_16x16x64_bf16 v[44:47], v[28:31], a[152:159], v3
  v_cvt_pk_bf16_f32 v76, v72, v73
  v_smfmac_f32_16x16x64_bf16 v[44:47], v[32:35], a[160:167], v3
  v_cvt_pk_bf16_f32 v77, v74, v75
  v_cvt_pk_bf16_f32 v66, v40, v41
  v_smfmac_f32_16x16x64_bf16 v[48:51], v[24:27], a[200:207], v3
  v_cvt_pk_bf16_f32 v67, v42, v43
  v_smfmac_f32_16x16x64_bf16 v[48:51], v[28:31], a[208:215], v3
  v_mfma_f32_16x16x32_bf16 v[68:71], v[64:67], v[4:7], 0
  v_smfmac_f32_16x16x64_bf16 v[48:51], v[32:35], a[216:223], v3
  v_cvt_pk_bf16_f32 v64, v44, v45
  v_mfma_f32_16x16x32_bf16 v[84:87], v[80:83], v[76:79], 0
  v_cvt_pk_bf16_f32 v65, v46, v47
  s_waitcnt lgkmcnt(0)
  v_smfmac_f32_16x16x64_bf16 v[88:91], v[76:79], v[96:103], v3
  v_cvt_pk_bf16_f32 v60, v68, v69
  v_cvt_pk_bf16_f32 v61, v70, v71
  v_cvt_pk_bf16_f32 v66, v48, v49
  v_cvt_pk_bf16_f32 v67, v50, v51
  s_nop 1
  v_mfma_f32_16x16x32_bf16 v[72:75], v[64:67], v[4:7], 0
  v_smfmac_f32_16x16x64_bf16 v[92:95], v[76:79], v[104:111], v3
  s_nop 4
  v_cvt_pk_bf16_f32 v62, v72, v73
  v_cvt_pk_bf16_f32 v63, v74, v75
  s_nop 1
  v_mfma_f32_16x16x32_bf16 v[84:87], v[12:15], v[60:63], v[84:87]
  v_smfmac_f32_16x16x64_bf16 v[88:91], v[60:63], v[16:23], v3
  v_smfmac_f32_16x16x64_bf16 v[92:95], v[60:63], v[52:59], v3
  s_mov_b64 exec, s[26:27]
  s_nop 0
  ds_write_b128 v113, v[84:87]
  s_mov_b64 exec, -1
  s_nop 0
  v_cmp_u_f32 vcc, v88, v89
  s_nop 1
  v_permlane32_swap_b32 v88, v92
  v_permlane32_swap_b32 v89, v93
  v_permlane32_swap_b32 v90, v94
  v_permlane32_swap_b32 v91, v95
  v_add_f32 v88, v88, v92
  v_add_f32 v89, v89, v93
  v_add_f32 v90, v90, v94
  v_add_f32 v91, v91, v95
  ds_write_b128 v112, v[88:91]
  s_cbranch_vccnz cA_sc1_retry
cA_sc1_cont:
  s_waitcnt lgkmcnt(0)
  s_barrier
  ds_read_b64 v[36:37], v114 offset:0
  ds_read_b64 v[38:39], v114 offset:1024
  ds_read2_b32 v[44:45], v115 offset0:0 offset1:64
  s_waitcnt lgkmcnt(0)
  v_add_f32 v44, v44, v45
  v_add_f32 v36, v36, v38
  v_add_f32 v37, v37, v39
  v_add_f32_dpp v44, v44, v44 row_ror:8 row_mask:0xf bank_mask:0xf
  v_mov_b32 v45, v44
  v_permlane32_swap_b32 v36, v37
  v_add_f32 v36, v36, v37
  v_permlane16_swap_b32 v44, v45
  v_add_f32 v44, v44, v45
  v_exp_f32 v48, v36
  v_exp_f32 v49, v44
  v_add_f32 v50, abs(v36), abs(v44)
  v_fma_f32 v39, v49, s37, v48
  v_cmp_ngt_f32 vcc, s56, v50
  v_cndmask_b32 v41, v48, v49, s[38:39]
  v_add_f32_dpp v39, v39, v39 quad_perm:[1,0,3,2] row_mask:0xf bank_mask:0xf
  v_cndmask_b32 v40, v49, v48, s[38:39]
  v_mov_b32_dpp v46, v41 quad_perm:[1,0,3,2] row_mask:0xf bank_mask:0xf
  v_add_f32_dpp v39, v39, v39 quad_perm:[2,3,0,1] row_mask:0xf bank_mask:0xf
  v_cndmask_b32 v42, v46, v40, s[38:39]
  v_cndmask_b32 v43, v40, v46, s[38:39]
  v_add_f32_dpp v39, v39, v39 row_half_mirror row_mask:0xf bank_mask:0xf
  s_cbranch_vccnz cA_sc1_slow
  s_nop 0
  v_add_f32_dpp v39, v39, v39 row_mirror row_mask:0xf bank_mask:0xf
  v_mov_b32 v47, v39
  s_nop 1
  v_permlane16_swap_b32 v39, v47
  v_add_f32 v39, v39, v47
  v_rcp_f32 v39, v39
  s_mov_b64 exec, s[28:29]
  v_mul_f32 v42, v42, v39
  v_mul_f32 v43, v43, v39
  v_cvt_pk_bf16_f32 v42, v42, v43
cA_sc1_pst:
  buffer_store_dword v42, v1, s[8:11], s20 offen
  s_mov_b64 exec, -1
  s_barrier
  s_add_u32 s24, s24, 28672
  s_add_u32 s35, s35, 28672
  s_xor_b32 s25, s25, 28672
  s_add_u32 m0, s25, 7168
  s_nop 0
  buffer_load_dwordx4 v2, s[8:11], s24 offen offset:0 sc1 lds
  buffer_load_dwordx4 v2, s[8:11], s24 offen offset:1024 sc1 lds
  buffer_load_dwordx4 v2, s[8:11], s24 offen offset:2048 sc1 lds
  buffer_load_dwordx4 v2, s[8:11], s24 offen offset:3072 sc1 lds
  s_add_u32 m0, s25, 11264
  s_add_u32 s22, s24, 4096
  buffer_load_dwordx4 v2, s[8:11], s22 offen offset:0 sc1 lds
  buffer_load_dwordx4 v2, s[8:11], s22 offen offset:1024 sc1 lds
  buffer_load_dwordx4 v2, s[8:11], s22 offen offset:2048 sc1 lds
  v_xor_b32 v116, 28672, v116
  v_add_u32 v117, s57, v117
  s_sub_u32 s57, 0, s57
  s_add_u32 s19, s19, 1
  s_mov_b32 s20, s21
  s_cmp_lt_u32 s19, 63
  s_cbranch_scc1 cA_sc1_loop
  s_branch cA_done
cA_sc1_slow:
  v_max_f32 v50, v36, v44
  s_nop 1
  v_max_f32_dpp v50, v50, v50 quad_perm:[1,0,3,2] row_mask:0xf bank_mask:0xf
  s_nop 1
  v_max_f32_dpp v50, v50, v50 quad_perm:[2,3,0,1] row_mask:0xf bank_mask:0xf
  s_nop 1
  v_max_f32_dpp v50, v50, v50 row_half_mirror row_mask:0xf bank_mask:0xf
  s_nop 1
  v_max_f32_dpp v50, v50, v50 row_mirror row_mask:0xf bank_mask:0xf
  v_mov_b32 v47, v50
  s_nop 1
  v_permlane16_swap_b32 v50, v47
  v_max_f32 v50, v50, v47
  v_sub_f32 v48, v36, v50
  v_sub_f32 v49, v44, v50
  v_exp_f32 v48, v48
  v_exp_f32 v49, v49
  s_add_u32 s31, s31, 0x100
  v_fma_f32 v39, v49, s37, v48
  v_cndmask_b32 v41, v48, v49, s[38:39]
  s_nop 0
  v_add_f32_dpp v39, v39, v39 quad_perm:[1,0,3,2] row_mask:0xf bank_mask:0xf
  v_cndmask_b32 v40, v49, v48, s[38:39]
  v_mov_b32_dpp v46, v41 quad_perm:[1,0,3,2] row_mask:0xf bank_mask:0xf
  v_add_f32_dpp v39, v39, v39 quad_perm:[2,3,0,1] row_mask:0xf bank_mask:0xf
  v_cndmask_b32 v42, v46, v40, s[38:39]
  v_cndmask_b32 v43, v40, v46, s[38:39]
  v_add_f32_dpp v39, v39, v39 row_half_mirror row_mask:0xf bank_mask:0xf
  s_nop 1
  v_add_f32_dpp v39, v39, v39 row_mirror row_mask:0xf bank_mask:0xf
  v_mov_b32 v47, v39
  s_nop 1
  v_permlane16_swap_b32 v39, v47
  v_add_f32 v39, v39, v47
  v_rcp_f32 v39, v39
  s_mov_b64 exec, s[28:29]
  v_mul_f32 v42, v42, v39
  v_mul_f32 v43, v43, v39
  v_cvt_pk_bf16_f32 v42, v42, v43
  v_min_u32 v42, -2, v42
  s_branch cA_sc1_pst
cA_sc1_retry:
  s_cmp_lg_u32 s62, 0
  s_cbranch_scc1 cA_sc1_cont
  s_waitcnt vmcnt(0) lgkmcnt(0)
cA_sc1_rv:
  buffer_load_dwordx4 v[8:11], v2, s[8:11], s20 offen offset:0 sc1
  buffer_load_dwordx4 v[12:15], v2, s[8:11], s20 offen offset:1024 sc1
  buffer_load_dwordx4 v[16:19], v2, s[8:11], s20 offen offset:2048 sc1
  buffer_load_dwordx4 v[20:23], v2, s[8:11], s20 offen offset:3072 sc1
  buffer_load_dwordx4 v[24:27], v2, s[8:11], s23 offen offset:0 sc1
  buffer_load_dwordx4 v[28:31], v2, s[8:11], s23 offen offset:1024 sc1
  buffer_load_dwordx4 v[32:35], v2, s[8:11], s23 offen offset:2048 sc1
  s_waitcnt vmcnt(0)
  v_max3_u32 v118, v8, v9, v10
  v_max3_u32 v118, v118, v11, v12
  v_max3_u32 v118, v118, v13, v14
  v_max3_u32 v118, v118, v15, v16
  v_max3_u32 v118, v118, v17, v18
  v_max3_u32 v118, v118, v19, v20
  v_max3_u32 v118, v118, v21, v22
  v_max3_u32 v118, v118, v23, v24
  v_max3_u32 v118, v118, v25, v26
  v_max3_u32 v118, v118, v27, v28
  v_max3_u32 v118, v118, v29, v30
  v_max3_u32 v118, v118, v31, v32
  v_max3_u32 v118, v118, v33, v34
  v_max_u32 v118, v118, v35
  v_cmp_eq_u32 vcc, -1, v118
  s_cbranch_vccz cA_sc1_rk
  s_add_u32 s30, s30, 1
  s_cmp_lt_u32 s30, 400000
  s_cbranch_scc1 cA_sc1_rv
  s_branch cA_abort
cA_sc1_rk:
  s_mov_b32 s62, 1
  v_mov_b32 v36, 0
  v_mov_b32 v37, 0
  v_mov_b32 v38, 0
  v_mov_b32 v39, 0
  v_mov_b32 v40, 0
  v_mov_b32 v41, 0
  v_mov_b32 v42, 0
  v_mov_b32 v43, 0
  v_mov_b32 v44, 0
  v_mov_b32 v45, 0
  v_mov_b32 v46, 0
  v_mov_b32 v47, 0
  v_mov_b32 v48, 0
  v_mov_b32 v49, 0
  v_mov_b32 v50, 0
  v_mov_b32 v51, 0
  v_mov_b32 v52, 0
  v_mov_b32 v53, 0
  v_mov_b32 v54, 0
  v_mov_b32 v55, 0
  v_mov_b32 v56, 0
  v_mov_b32 v57, 0
  v_mov_b32 v58, 0
  v_mov_b32 v59, 0
  v_mov_b32 v60, 0
  v_mov_b32 v61, 0
  v_mov_b32 v62, 0
  v_mov_b32 v63, 0
  v_mov_b32 v88, 0
  v_mov_b32 v89, 0
  v_mov_b32 v90, 0
  v_mov_b32 v91, 0
  v_mov_b32 v92, 0
  v_mov_b32 v93, 0
  v_mov_b32 v94, 0
  v_mov_b32 v95, 0
  v_mov_b32 v64, 0
  v_mov_b32 v65, 0
  s_add_u32 s31, s31, 1
  ds_read_b128 v[96:99], v117 offset:0
  ds_read_b128 v[100:103], v117 offset:1024
  ds_read_b128 v[104:107], v117 offset:14336
  ds_read_b128 v[108:111], v117 offset:15360
  v_smfmac_f32_16x16x64_bf16 v[36:39], v[8:11], a[0:7], v3
  v_smfmac_f32_16x16x64_bf16 v[40:43], v[8:11], a[56:63], v3
  v_smfmac_f32_16x16x64_bf16 v[44:47], v[8:11], a[112:119], v3
  v_smfmac_f32_16x16x64_bf16 v[48:51], v[8:11], a[168:175], v3
  v_smfmac_f32_16x16x64_bf16 v[52:55], v[8:11], a[224:231], v3
  v_smfmac_f32_16x16x64_bf16 v[56:59], v[8:11], v[144:151], v3
  v_smfmac_f32_16x16x64_bf16 v[60:63], v[8:11], v[200:207], v3
  v_smfmac_f32_16x16x64_bf16 v[36:39], v[12:15], a[8:15], v3
  v_smfmac_f32_16x16x64_bf16 v[40:43], v[12:15], a[64:71], v3
  v_smfmac_f32_16x16x64_bf16 v[44:47], v[12:15], a[120:127], v3
  v_smfmac_f32_16x16x64_bf16 v[48:51], v[12:15], a[176:183], v3
  v_smfmac_f32_16x16x64_bf16 v[52:55], v[12:15], a[232:239], v3
  v_smfmac_f32_16x16x64_bf16 v[56:59], v[12:15], v[152:159], v3
  v_smfmac_f32_16x16x64_bf16 v[60:63], v[12:15], v[208:215], v3
  v_smfmac_f32_16x16x64_bf16 v[36:39], v[16:19], a[16:23], v3
  v_smfmac_f32_16x16x64_bf16 v[40:43], v[16:19], a[72:79], v3
  v_smfmac_f32_16x16x64_bf16 v[44:47], v[16:19], a[128:135], v3
  v_smfmac_f32_16x16x64_bf16 v[48:51], v[16:19], a[184:191], v3
  v_smfmac_f32_16x16x64_bf16 v[52:55], v[16:19], a[240:247], v3
  v_smfmac_f32_16x16x64_bf16 v[56:59], v[16:19], v[160:167], v3
  v_smfmac_f32_16x16x64_bf16 v[60:63], v[16:19], v[216:223], v3
  v_smfmac_f32_16x16x64_bf16 v[36:39], v[20:23], a[24:31], v3
  v_smfmac_f32_16x16x64_bf16 v[40:43], v[20:23], a[80:87], v3
  v_smfmac_f32_16x16x64_bf16 v[44:47], v[20:23], a[136:143], v3
  v_smfmac_f32_16x16x64_bf16 v[48:51], v[20:23], a[192:199], v3
  v_smfmac_f32_16x16x64_bf16 v[52:55], v[20:23], a[248:255], v3
  v_smfmac_f32_16x16x64_bf16 v[56:59], v[20:23], v[168:175], v3
  v_smfmac_f32_16x16x64_bf16 v[60:63], v[20:23], v[224:231], v3
  s_branch cA_sc1_ph2
.p2align 6

cA_sc2_loop:
  s_add_u32 s23, s20, 4096
  s_add_u32 s21, s20, 25600
  v_mov_b32 v48, 0
  v_mov_b32 v49, 0
  v_mov_b32 v50, 0
  v_mov_b32 v51, 0
  v_mov_b32 v52, 0
  v_mov_b32 v53, 0
  v_mov_b32 v54, 0
  v_mov_b32 v55, 0
  v_mov_b32 v56, 0
  v_mov_b32 v57, 0
  v_mov_b32 v58, 0
  v_mov_b32 v59, 0
  v_mov_b32 v60, 0
  v_mov_b32 v61, 0
  v_mov_b32 v62, 0
  v_mov_b32 v63, 0
  v_mov_b32 v88, 0
  v_mov_b32 v89, 0
  v_mov_b32 v90, 0
  v_mov_b32 v91, 0
  v_mov_b32 v92, 0
  v_mov_b32 v93, 0
  v_mov_b32 v94, 0
  v_mov_b32 v95, 0
  v_mov_b32 v66, 0
  v_mov_b32 v67, 0
  s_mov_b32 s30, 0
  s_mov_b32 s62, 0
  s_waitcnt vmcnt(0)
  s_barrier
cA_sc2_ld:
  buffer_load_dwordx4 v[8:11], v2, s[8:11], s20 offen offset:0
  v_mov_b32 v36, 0
  v_mov_b32 v37, 0
  v_mov_b32 v38, 0
  v_mov_b32 v39, 0
  buffer_load_dwordx4 v[12:15], v2, s[8:11], s20 offen offset:1024
  v_mov_b32 v40, 0
  v_mov_b32 v41, 0
  v_mov_b32 v42, 0
  v_mov_b32 v43, 0
  buffer_load_dwordx4 v[16:19], v2, s[8:11], s20 offen offset:2048
  v_mov_b32 v44, 0
  v_mov_b32 v45, 0
  v_mov_b32 v46, 0
  v_mov_b32 v47, 0
  ds_read_b128 v[96:99], v117 offset:0
  ds_read_b128 v[100:103], v117 offset:1024
  ds_read_b128 v[104:107], v117 offset:14336
  ds_read_b128 v[108:111], v117 offset:15360
  s_waitcnt vmcnt(2)
  v_smfmac_f32_16x16x64_bf16 v[36:39], v[8:11], a[0:7], v3
  v_smfmac_f32_16x16x64_bf16 v[40:43], v[8:11], a[56:63], v3
  buffer_load_dwordx4 v[20:23], v2, s[8:11], s20 offen offset:3072
  v_smfmac_f32_16x16x64_bf16 v[44:47], v[8:11], a[112:119], v3
  v_smfmac_f32_16x16x64_bf16 v[48:51], v[8:11], a[168:175], v3
  v_smfmac_f32_16x16x64_bf16 v[52:55], v[8:11], a[224:231], v3
  buffer_load_dwordx4 v[24:27], v2, s[8:11], s23 offen offset:0
  v_smfmac_f32_16x16x64_bf16 v[56:59], v[8:11], v[144:151], v3
  v_smfmac_f32_16x16x64_bf16 v[60:63], v[8:11], v[200:207], v3
  s_waitcnt vmcnt(3)
  v_smfmac_f32_16x16x64_bf16 v[36:39], v[12:15], a[8:15], v3
  v_smfmac_f32_16x16x64_bf16 v[40:43], v[12:15], a[64:71], v3
  buffer_load_dwordx4 v[28:31], v2, s[8:11], s23 offen offset:1024
  v_smfmac_f32_16x16x64_bf16 v[44:47], v[12:15], a[120:127], v3
  v_smfmac_f32_16x16x64_bf16 v[48:51], v[12:15], a[176:183], v3
  v_smfmac_f32_16x16x64_bf16 v[52:55], v[12:15], a[232:239], v3
  buffer_load_dwordx4 v[32:35], v2, s[8:11], s23 offen offset:2048
  v_smfmac_f32_16x16x64_bf16 v[56:59], v[12:15], v[152:159], v3
  v_smfmac_f32_16x16x64_bf16 v[60:63], v[12:15], v[208:215], v3
  s_waitcnt vmcnt(4)
  v_smfmac_f32_16x16x64_bf16 v[36:39], v[16:19], a[16:23], v3
  v_smfmac_f32_16x16x64_bf16 v[40:43], v[16:19], a[72:79], v3
  v_smfmac_f32_16x16x64_bf16 v[44:47], v[16:19], a[128:135], v3
  v_smfmac_f32_16x16x64_bf16 v[48:51], v[16:19], a[184:191], v3
  v_smfmac_f32_16x16x64_bf16 v[52:55], v[16:19], a[240:247], v3
  v_smfmac_f32_16x16x64_bf16 v[56:59], v[16:19], v[160:167], v3
  v_smfmac_f32_16x16x64_bf16 v[60:63], v[16:19], v[216:223], v3
  s_waitcnt vmcnt(3)
  v_smfmac_f32_16x16x64_bf16 v[36:39], v[20:23], a[24:31], v3
  v_smfmac_f32_16x16x64_bf16 v[40:43], v[20:23], a[80:87], v3
  v_smfmac_f32_16x16x64_bf16 v[44:47], v[20:23], a[136:143], v3
  v_smfmac_f32_16x16x64_bf16 v[48:51], v[20:23], a[192:199], v3
  v_smfmac_f32_16x16x64_bf16 v[52:55], v[20:23], a[248:255], v3
  v_smfmac_f32_16x16x64_bf16 v[56:59], v[20:23], v[168:175], v3
  v_smfmac_f32_16x16x64_bf16 v[60:63], v[20:23], v[224:231], v3
  s_waitcnt vmcnt(0)
cA_sc2_ph2:
  v_smfmac_f32_16x16x64_bf16 v[60:63], v[24:27], v[232:239], v3
  ds_read_b128 v[8:11], v116 offset:4096
  ds_read_b128 v[12:15], v116 offset:5120
  v_smfmac_f32_16x16x64_bf16 v[60:63], v[28:31], v[240:247], v3
  buffer_load_dword v119, v0, s[8:11], s24 offen sc1
  v_smfmac_f32_16x16x64_bf16 v[60:63], v[32:35], v[248:255], v3
  v_mov_b32 v80, v28
  v_smfmac_f32_16x16x64_bf16 v[52:55], v[24:27], v[120:127], v3
  v_mov_b32 v81, v29
  v_smfmac_f32_16x16x64_bf16 v[52:55], v[28:31], v[128:135], v3
  v_mov_b32 v82, v34
  v_smfmac_f32_16x16x64_bf16 v[52:55], v[32:35], v[136:143], v3
  v_cvt_pk_bf16_f32 v64, v60, v61
  v_smfmac_f32_16x16x64_bf16 v[56:59], v[24:27], v[176:183], v3
  v_cvt_pk_bf16_f32 v65, v62, v63
  v_smfmac_f32_16x16x64_bf16 v[56:59], v[28:31], v[184:191], v3
  v_mov_b32 v83, v35
  v_mfma_f32_16x16x32_bf16 v[68:71], v[64:67], v[4:7], 0
  v_smfmac_f32_16x16x64_bf16 v[56:59], v[32:35], v[192:199], v3
  v_cvt_pk_bf16_f32 v64, v52, v53
  v_smfmac_f32_16x16x64_bf16 v[36:39], v[24:27], a[32:39], v3
  v_cvt_pk_bf16_f32 v65, v54, v55
  v_smfmac_f32_16x16x64_bf16 v[36:39], v[28:31], a[40:47], v3
  v_cvt_pk_bf16_f32 v78, v68, v69
  v_smfmac_f32_16x16x64_bf16 v[36:39], v[32:35], a[48:55], v3
  v_cvt_pk_bf16_f32 v79, v70, v71
  v_cvt_pk_bf16_f32 v66, v56, v57
  v_smfmac_f32_16x16x64_bf16 v[40:43], v[24:27], a[88:95], v3
  v_cvt_pk_bf16_f32 v67, v58, v59
  v_smfmac_f32_16x16x64_bf16 v[40:43], v[28:31], a[96:103], v3
  v_mfma_f32_16x16x32_bf16 v[72:75], v[64:67], v[4:7], 0
  ds_read_b128 v[52:55], v116 offset:18432
  ds_read_b128 v[56:59], v116 offset:19456
  v_smfmac_f32_16x16x64_bf16 v[40:43], v[32:35], a[104:111], v3
  v_cvt_pk_bf16_f32 v64, v36, v37
  v_smfmac_f32_16x16x64_bf16 v[44:47], v[24:27], a[144:151], v3
  v_cvt_pk_bf16_f32 v65, v38, v39
  v_smfmac_f32_16x16x64_bf16 v[44:47], v[28:31], a[152:159], v3
  v_cvt_pk_bf16_f32 v76, v72, v73
  v_smfmac_f32_16x16x64_bf16 v[44:47], v[32:35], a[160:167], v3
  v_cvt_pk_bf16_f32 v77, v74, v75
  v_cvt_pk_bf16_f32 v66, v40, v41
  v_smfmac_f32_16x16x64_bf16 v[48:51], v[24:27], a[200:207], v3
  v_cvt_pk_bf16_f32 v67, v42, v43
  v_smfmac_f32_16x16x64_bf16 v[48:51], v[28:31], a[208:215], v3
  v_mfma_f32_16x16x32_bf16 v[68:71], v[64:67], v[4:7], 0
  v_smfmac_f32_16x16x64_bf16 v[48:51], v[32:35], a[216:223], v3
  v_cvt_pk_bf16_f32 v64, v44, v45
  v_mfma_f32_16x16x32_bf16 v[84:87], v[80:83], v[76:79], 0
  v_cvt_pk_bf16_f32 v65, v46, v47
  s_waitcnt lgkmcnt(0)
  v_smfmac_f32_16x16x64_bf16 v[88:91], v[76:79], v[96:103], v3
  v_cvt_pk_bf16_f32 v60, v68, v69
  v_cvt_pk_bf16_f32 v61, v70, v71
  v_cvt_pk_bf16_f32 v66, v48, v49
  v_cvt_pk_bf16_f32 v67, v50, v51
  s_nop 1
  v_mfma_f32_16x16x32_bf16 v[72:75], v[64:67], v[4:7], 0
  v_smfmac_f32_16x16x64_bf16 v[92:95], v[76:79], v[104:111], v3
  s_nop 4
  v_cvt_pk_bf16_f32 v62, v72, v73
  v_cvt_pk_bf16_f32 v63, v74, v75
  s_nop 1
  v_mfma_f32_16x16x32_bf16 v[84:87], v[16:19], v[60:63], v[84:87]
  v_smfmac_f32_16x16x64_bf16 v[88:91], v[60:63], v[8:15], v3
  v_smfmac_f32_16x16x64_bf16 v[92:95], v[60:63], v[52:59], v3
  s_mov_b64 exec, s[26:27]
  s_nop 0
  ds_write_b128 v113, v[84:87]
  s_mov_b64 exec, -1
  s_nop 0
  v_cmp_u_f32 vcc, v88, v89
  s_nop 1
  v_permlane32_swap_b32 v88, v92
  v_permlane32_swap_b32 v89, v93
  v_permlane32_swap_b32 v90, v94
  v_permlane32_swap_b32 v91, v95
  v_add_f32 v88, v88, v92
  v_add_f32 v89, v89, v93
  v_add_f32 v90, v90, v94
  v_add_f32 v91, v91, v95
  ds_write_b128 v112, v[88:91]
  s_cbranch_vccnz cA_sc2_retry
cA_sc2_cont:
  s_waitcnt lgkmcnt(0)
  s_barrier
  ds_read_b64 v[36:37], v114 offset:0
  ds_read_b64 v[38:39], v114 offset:1024
  ds_read2_b32 v[44:45], v115 offset0:0 offset1:64
  v_lshl_add_u32 v56, v2, 3, s36
  s_waitcnt lgkmcnt(0)
  v_add_f32 v44, v44, v45
  v_add_f32 v36, v36, v38
  v_add_f32 v37, v37, v39
  v_add_f32_dpp v44, v44, v44 row_ror:8 row_mask:0xf bank_mask:0xf
  v_mov_b32 v45, v44
  s_mov_b64 exec, 65535
  buffer_store_dword v2, v56, s[8:11], s20 offen
  s_mov_b64 exec, -1
  v_permlane32_swap_b32 v36, v37
  v_add_f32 v36, v36, v37
  v_permlane16_swap_b32 v44, v45
  v_add_f32 v44, v44, v45
  v_exp_f32 v48, v36
  v_exp_f32 v49, v44
  v_add_f32 v50, abs(v36), abs(v44)
  v_fma_f32 v39, v49, s37, v48
  v_cmp_ngt_f32 vcc, s56, v50
  v_cndmask_b32 v41, v48, v49, s[38:39]
  v_add_f32_dpp v39, v39, v39 quad_perm:[1,0,3,2] row_mask:0xf bank_mask:0xf
  v_cndmask_b32 v40, v49, v48, s[38:39]
  v_mov_b32_dpp v46, v41 quad_perm:[1,0,3,2] row_mask:0xf bank_mask:0xf
  v_add_f32_dpp v39, v39, v39 quad_perm:[2,3,0,1] row_mask:0xf bank_mask:0xf
  v_cndmask_b32 v42, v46, v40, s[38:39]
  v_cndmask_b32 v43, v40, v46, s[38:39]
  v_add_f32_dpp v39, v39, v39 row_half_mirror row_mask:0xf bank_mask:0xf
  s_cbranch_vccnz cA_sc2_slow
  s_nop 0
  v_add_f32_dpp v39, v39, v39 row_mirror row_mask:0xf bank_mask:0xf
  v_mov_b32 v47, v39
  s_nop 1
  v_permlane16_swap_b32 v39, v47
  v_add_f32 v39, v39, v47
  v_rcp_f32 v39, v39
  s_mov_b64 exec, s[28:29]
  v_mul_f32 v42, v42, v39
  v_mul_f32 v43, v43, v39
  v_cvt_pk_bf16_f32 v42, v42, v43
cA_sc2_pst:
  buffer_store_dword v42, v1, s[8:11], s20 offen
  s_mov_b64 exec, -1
  s_barrier
  s_add_u32 s24, s24, 28672
  s_add_u32 s35, s35, 28672
  s_xor_b32 s25, s25, 28672
  s_add_u32 m0, s25, 14336
  s_nop 0
  buffer_load_dwordx4 v2, s[8:11], s24 offen offset:0 sc1 lds
  buffer_load_dwordx4 v2, s[8:11], s24 offen offset:1024 sc1 lds
  buffer_load_dwordx4 v2, s[8:11], s24 offen offset:2048 sc1 lds
  buffer_load_dwordx4 v2, s[8:11], s24 offen offset:3072 sc1 lds
  s_add_u32 m0, s25, 18432
  s_add_u32 s22, s24, 4096
  buffer_load_dwordx4 v2, s[8:11], s22 offen offset:0 sc1 lds
  buffer_load_dwordx4 v2, s[8:11], s22 offen offset:1024 sc1 lds
  buffer_load_dwordx4 v2, s[8:11], s22 offen offset:2048 sc1 lds
  v_xor_b32 v116, 28672, v116
  v_add_u32 v117, s57, v117
  s_sub_u32 s57, 0, s57
  s_add_u32 s19, s19, 1
  s_mov_b32 s20, s21
  s_cmp_lt_u32 s19, 63
  s_cbranch_scc1 cA_sc2_loop
  s_branch cA_done
cA_sc2_slow:
  v_max_f32 v50, v36, v44
  s_nop 1
  v_max_f32_dpp v50, v50, v50 quad_perm:[1,0,3,2] row_mask:0xf bank_mask:0xf
  s_nop 1
  v_max_f32_dpp v50, v50, v50 quad_perm:[2,3,0,1] row_mask:0xf bank_mask:0xf
  s_nop 1
  v_max_f32_dpp v50, v50, v50 row_half_mirror row_mask:0xf bank_mask:0xf
  s_nop 1
  v_max_f32_dpp v50, v50, v50 row_mirror row_mask:0xf bank_mask:0xf
  v_mov_b32 v47, v50
  s_nop 1
  v_permlane16_swap_b32 v50, v47
  v_max_f32 v50, v50, v47
  v_sub_f32 v48, v36, v50
  v_sub_f32 v49, v44, v50
  v_exp_f32 v48, v48
  v_exp_f32 v49, v49
  s_add_u32 s31, s31, 0x100
  v_fma_f32 v39, v49, s37, v48
  v_cndmask_b32 v41, v48, v49, s[38:39]
  s_nop 0
  v_add_f32_dpp v39, v39, v39 quad_perm:[1,0,3,2] row_mask:0xf bank_mask:0xf
  v_cndmask_b32 v40, v49, v48, s[38:39]
  v_mov_b32_dpp v46, v41 quad_perm:[1,0,3,2] row_mask:0xf bank_mask:0xf
  v_add_f32_dpp v39, v39, v39 quad_perm:[2,3,0,1] row_mask:0xf bank_mask:0xf
  v_cndmask_b32 v42, v46, v40, s[38:39]
  v_cndmask_b32 v43, v40, v46, s[38:39]
  v_add_f32_dpp v39, v39, v39 row_half_mirror row_mask:0xf bank_mask:0xf
  s_nop 1
  v_add_f32_dpp v39, v39, v39 row_mirror row_mask:0xf bank_mask:0xf
  v_mov_b32 v47, v39
  s_nop 1
  v_permlane16_swap_b32 v39, v47
  v_add_f32 v39, v39, v47
  v_rcp_f32 v39, v39
  s_mov_b64 exec, s[28:29]
  v_mul_f32 v42, v42, v39
  v_mul_f32 v43, v43, v39
  v_cvt_pk_bf16_f32 v42, v42, v43
  v_min_u32 v42, -2, v42
  s_branch cA_sc2_pst
cA_sc2_retry:
  s_cmp_lg_u32 s62, 0
  s_cbranch_scc1 cA_sc2_cont
  s_waitcnt vmcnt(0) lgkmcnt(0)
cA_sc2_rv:
  buffer_load_dwordx4 v[8:11], v2, s[8:11], s20 offen offset:0 sc1
  buffer_load_dwordx4 v[12:15], v2, s[8:11], s20 offen offset:1024 sc1
  buffer_load_dwordx4 v[16:19], v2, s[8:11], s20 offen offset:2048 sc1
  buffer_load_dwordx4 v[20:23], v2, s[8:11], s20 offen offset:3072 sc1
  buffer_load_dwordx4 v[24:27], v2, s[8:11], s23 offen offset:0 sc1
  buffer_load_dwordx4 v[28:31], v2, s[8:11], s23 offen offset:1024 sc1
  buffer_load_dwordx4 v[32:35], v2, s[8:11], s23 offen offset:2048 sc1
  s_waitcnt vmcnt(0)
  v_max3_u32 v118, v8, v9, v10
  v_max3_u32 v118, v118, v11, v12
  v_max3_u32 v118, v118, v13, v14
  v_max3_u32 v118, v118, v15, v16
  v_max3_u32 v118, v118, v17, v18
  v_max3_u32 v118, v118, v19, v20
  v_max3_u32 v118, v118, v21, v22
  v_max3_u32 v118, v118, v23, v24
  v_max3_u32 v118, v118, v25, v26
  v_max3_u32 v118, v118, v27, v28
  v_max3_u32 v118, v118, v29, v30
  v_max3_u32 v118, v118, v31, v32
  v_max3_u32 v118, v118, v33, v34
  v_max_u32 v118, v118, v35
  v_cmp_eq_u32 vcc, -1, v118
  s_cbranch_vccz cA_sc2_rk
  s_add_u32 s30, s30, 1
  s_cmp_lt_u32 s30, 400000
  s_cbranch_scc1 cA_sc2_rv
  s_branch cA_abort
cA_sc2_rk:
  s_mov_b32 s62, 1
  v_mov_b32 v36, 0
  v_mov_b32 v37, 0
  v_mov_b32 v38, 0
  v_mov_b32 v39, 0
  v_mov_b32 v40, 0
  v_mov_b32 v41, 0
  v_mov_b32 v42, 0
  v_mov_b32 v43, 0
  v_mov_b32 v44, 0
  v_mov_b32 v45, 0
  v_mov_b32 v46, 0
  v_mov_b32 v47, 0
  v_mov_b32 v48, 0
  v_mov_b32 v49, 0
  v_mov_b32 v50, 0
  v_mov_b32 v51, 0
  v_mov_b32 v52, 0
  v_mov_b32 v53, 0
  v_mov_b32 v54, 0
  v_mov_b32 v55, 0
  v_mov_b32 v56, 0
  v_mov_b32 v57, 0
  v_mov_b32 v58, 0
  v_mov_b32 v59, 0
  v_mov_b32 v60, 0
  v_mov_b32 v61, 0
  v_mov_b32 v62, 0
  v_mov_b32 v63, 0
  v_mov_b32 v88, 0
  v_mov_b32 v89, 0
  v_mov_b32 v90, 0
  v_mov_b32 v91, 0
  v_mov_b32 v92, 0
  v_mov_b32 v93, 0
  v_mov_b32 v94, 0
  v_mov_b32 v95, 0
  v_mov_b32 v66, 0
  v_mov_b32 v67, 0
  s_add_u32 s31, s31, 1
  ds_read_b128 v[96:99], v117 offset:0
  ds_read_b128 v[100:103], v117 offset:1024
  ds_read_b128 v[104:107], v117 offset:14336
  ds_read_b128 v[108:111], v117 offset:15360
  v_smfmac_f32_16x16x64_bf16 v[36:39], v[8:11], a[0:7], v3
  v_smfmac_f32_16x16x64_bf16 v[40:43], v[8:11], a[56:63], v3
  v_smfmac_f32_16x16x64_bf16 v[44:47], v[8:11], a[112:119], v3
  v_smfmac_f32_16x16x64_bf16 v[48:51], v[8:11], a[168:175], v3
  v_smfmac_f32_16x16x64_bf16 v[52:55], v[8:11], a[224:231], v3
  v_smfmac_f32_16x16x64_bf16 v[56:59], v[8:11], v[144:151], v3
  v_smfmac_f32_16x16x64_bf16 v[60:63], v[8:11], v[200:207], v3
  v_smfmac_f32_16x16x64_bf16 v[36:39], v[12:15], a[8:15], v3
  v_smfmac_f32_16x16x64_bf16 v[40:43], v[12:15], a[64:71], v3
  v_smfmac_f32_16x16x64_bf16 v[44:47], v[12:15], a[120:127], v3
  v_smfmac_f32_16x16x64_bf16 v[48:51], v[12:15], a[176:183], v3
  v_smfmac_f32_16x16x64_bf16 v[52:55], v[12:15], a[232:239], v3
  v_smfmac_f32_16x16x64_bf16 v[56:59], v[12:15], v[152:159], v3
  v_smfmac_f32_16x16x64_bf16 v[60:63], v[12:15], v[208:215], v3
  v_smfmac_f32_16x16x64_bf16 v[36:39], v[16:19], a[16:23], v3
  v_smfmac_f32_16x16x64_bf16 v[40:43], v[16:19], a[72:79], v3
  v_smfmac_f32_16x16x64_bf16 v[44:47], v[16:19], a[128:135], v3
  v_smfmac_f32_16x16x64_bf16 v[48:51], v[16:19], a[184:191], v3
  v_smfmac_f32_16x16x64_bf16 v[52:55], v[16:19], a[240:247], v3
  v_smfmac_f32_16x16x64_bf16 v[56:59], v[16:19], v[160:167], v3
  v_smfmac_f32_16x16x64_bf16 v[60:63], v[16:19], v[216:223], v3
  v_smfmac_f32_16x16x64_bf16 v[36:39], v[20:23], a[24:31], v3
  v_smfmac_f32_16x16x64_bf16 v[40:43], v[20:23], a[80:87], v3
  v_smfmac_f32_16x16x64_bf16 v[44:47], v[20:23], a[136:143], v3
  v_smfmac_f32_16x16x64_bf16 v[48:51], v[20:23], a[192:199], v3
  v_smfmac_f32_16x16x64_bf16 v[52:55], v[20:23], a[248:255], v3
  v_smfmac_f32_16x16x64_bf16 v[56:59], v[20:23], v[168:175], v3
  v_smfmac_f32_16x16x64_bf16 v[60:63], v[20:23], v[224:231], v3
  s_branch cA_sc2_ph2
.p2align 6

cA_sc3_loop:
  s_add_u32 s23, s20, 4096
  s_add_u32 s21, s20, 25600
  v_mov_b32 v48, 0
  v_mov_b32 v49, 0
  v_mov_b32 v50, 0
  v_mov_b32 v51, 0
  v_mov_b32 v52, 0
  v_mov_b32 v53, 0
  v_mov_b32 v54, 0
  v_mov_b32 v55, 0
  v_mov_b32 v56, 0
  v_mov_b32 v57, 0
  v_mov_b32 v58, 0
  v_mov_b32 v59, 0
  v_mov_b32 v60, 0
  v_mov_b32 v61, 0
  v_mov_b32 v62, 0
  v_mov_b32 v63, 0
  v_mov_b32 v88, 0
  v_mov_b32 v89, 0
  v_mov_b32 v90, 0
  v_mov_b32 v91, 0
  v_mov_b32 v92, 0
  v_mov_b32 v93, 0
  v_mov_b32 v94, 0
  v_mov_b32 v95, 0
  v_mov_b32 v64, 0
  v_mov_b32 v65, 0
  s_mov_b32 s30, 0
  s_mov_b32 s62, 0
  s_waitcnt vmcnt(0)
  s_barrier
cA_sc3_ld:
  buffer_load_dwordx4 v[8:11], v2, s[8:11], s20 offen offset:0
  v_mov_b32 v36, 0
  v_mov_b32 v37, 0
  v_mov_b32 v38, 0
  v_mov_b32 v39, 0
  buffer_load_dwordx4 v[12:15], v2, s[8:11], s20 offen offset:1024
  v_mov_b32 v40, 0
  v_mov_b32 v41, 0
  v_mov_b32 v42, 0
  v_mov_b32 v43, 0
  buffer_load_dwordx4 v[16:19], v2, s[8:11], s20 offen offset:2048
  v_mov_b32 v44, 0
  v_mov_b32 v45, 0
  v_mov_b32 v46, 0
  v_mov_b32 v47, 0
  ds_read_b128 v[96:99], v117 offset:0
  ds_read_b128 v[100:103], v117 offset:1024
  ds_read_b128 v[104:107], v117 offset:14336
  ds_read_b128 v[108:111], v117 offset:15360
  s_waitcnt vmcnt(2)
  v_smfmac_f32_16x16x64_bf16 v[36:39], v[8:11], a[0:7], v3
  v_smfmac_f32_16x16x64_bf16 v[40:43], v[8:11], a[56:63], v3
  buffer_load_dwordx4 v[20:23], v2, s[8:11], s20 offen offset:3072
  v_smfmac_f32_16x16x64_bf16 v[44:47], v[8:11], a[112:119], v3
  v_smfmac_f32_16x16x64_bf16 v[48:51], v[8:11], a[168:175], v3
  v_smfmac_f32_16x16x64_bf16 v[52:55], v[8:11], a[224:231], v3
  buffer_load_dwordx4 v[24:27], v2, s[8:11], s23 offen offset:0
  v_smfmac_f32_16x16x64_bf16 v[56:59], v[8:11], v[144:151], v3
  v_smfmac_f32_16x16x64_bf16 v[60:63], v[8:11], v[200:207], v3
  s_waitcnt vmcnt(3)
  v_smfmac_f32_16x16x64_bf16 v[36:39], v[12:15], a[8:15], v3
  v_smfmac_f32_16x16x64_bf16 v[40:43], v[12:15], a[64:71], v3
  buffer_load_dwordx4 v[28:31], v2, s[8:11], s23 offen offset:1024
  v_smfmac_f32_16x16x64_bf16 v[44:47], v[12:15], a[120:127], v3
  v_smfmac_f32_16x16x64_bf16 v[48:51], v[12:15], a[176:183], v3
  v_smfmac_f32_16x16x64_bf16 v[52:55], v[12:15], a[232:239], v3
  buffer_load_dwordx4 v[32:35], v2, s[8:11], s23 offen offset:2048
  v_smfmac_f32_16x16x64_bf16 v[56:59], v[12:15], v[152:159], v3
  v_smfmac_f32_16x16x64_bf16 v[60:63], v[12:15], v[208:215], v3
  s_waitcnt vmcnt(4)
  v_smfmac_f32_16x16x64_bf16 v[36:39], v[16:19], a[16:23], v3
  v_smfmac_f32_16x16x64_bf16 v[40:43], v[16:19], a[72:79], v3
  v_smfmac_f32_16x16x64_bf16 v[44:47], v[16:19], a[128:135], v3
  v_smfmac_f32_16x16x64_bf16 v[48:51], v[16:19], a[184:191], v3
  v_smfmac_f32_16x16x64_bf16 v[52:55], v[16:19], a[240:247], v3
  v_smfmac_f32_16x16x64_bf16 v[56:59], v[16:19], v[160:167], v3
  v_smfmac_f32_16x16x64_bf16 v[60:63], v[16:19], v[216:223], v3
  s_waitcnt vmcnt(3)
  v_smfmac_f32_16x16x64_bf16 v[36:39], v[20:23], a[24:31], v3
  v_smfmac_f32_16x16x64_bf16 v[40:43], v[20:23], a[80:87], v3
  v_smfmac_f32_16x16x64_bf16 v[44:47], v[20:23], a[136:143], v3
  v_smfmac_f32_16x16x64_bf16 v[48:51], v[20:23], a[192:199], v3
  v_smfmac_f32_16x16x64_bf16 v[52:55], v[20:23], a[248:255], v3
  v_smfmac_f32_16x16x64_bf16 v[56:59], v[20:23], v[168:175], v3
  v_smfmac_f32_16x16x64_bf16 v[60:63], v[20:23], v[224:231], v3
  s_waitcnt vmcnt(0)
cA_sc3_ph2:
  v_smfmac_f32_16x16x64_bf16 v[60:63], v[24:27], v[232:239], v3
  ds_read_b128 v[8:11], v116 offset:6144
  ds_read_b128 v[12:15], v116 offset:7168
  v_smfmac_f32_16x16x64_bf16 v[60:63], v[28:31], v[240:247], v3
  v_smfmac_f32_16x16x64_bf16 v[60:63], v[32:35], v[248:255], v3
  v_mov_b32 v80, v30
  v_smfmac_f32_16x16x64_bf16 v[52:55], v[24:27], v[120:127], v3
  v_mov_b32 v81, v31
  v_smfmac_f32_16x16x64_bf16 v[52:55], v[28:31], v[128:135], v3
  v_mov_b32 v82, v34
  v_smfmac_f32_16x16x64_bf16 v[52:55], v[32:35], v[136:143], v3
  v_cvt_pk_bf16_f32 v66, v60, v61
  v_smfmac_f32_16x16x64_bf16 v[56:59], v[24:27], v[176:183], v3
  v_cvt_pk_bf16_f32 v67, v62, v63
  v_smfmac_f32_16x16x64_bf16 v[56:59], v[28:31], v[184:191], v3
  v_mov_b32 v83, v35
  v_mfma_f32_16x16x32_bf16 v[68:71], v[64:67], v[4:7], 0
  v_smfmac_f32_16x16x64_bf16 v[56:59], v[32:35], v[192:199], v3
  v_cvt_pk_bf16_f32 v64, v52, v53
  v_smfmac_f32_16x16x64_bf16 v[36:39], v[24:27], a[32:39], v3
  v_cvt_pk_bf16_f32 v65, v54, v55
  v_smfmac_f32_16x16x64_bf16 v[36:39], v[28:31], a[40:47], v3
  v_cvt_pk_bf16_f32 v78, v68, v69
  v_smfmac_f32_16x16x64_bf16 v[36:39], v[32:35], a[48:55], v3
  v_cvt_pk_bf16_f32 v79, v70, v71
  v_cvt_pk_bf16_f32 v66, v56, v57
  v_smfmac_f32_16x16x64_bf16 v[40:43], v[24:27], a[88:95], v3
  v_cvt_pk_bf16_f32 v67, v58, v59
  v_smfmac_f32_16x16x64_bf16 v[40:43], v[28:31], a[96:103], v3
  v_mfma_f32_16x16x32_bf16 v[72:75], v[64:67], v[4:7], 0
  ds_read_b128 v[52:55], v116 offset:20480
  ds_read_b128 v[56:59], v116 offset:21504
  v_smfmac_f32_16x16x64_bf16 v[40:43], v[32:35], a[104:111], v3
  v_cvt_pk_bf16_f32 v64, v36, v37
  v_smfmac_f32_16x16x64_bf16 v[44:47], v[24:27], a[144:151], v3
  v_cvt_pk_bf16_f32 v65, v38, v39
  v_smfmac_f32_16x16x64_bf16 v[44:47], v[28:31], a[152:159], v3
  v_cvt_pk_bf16_f32 v76, v72, v73
  v_smfmac_f32_16x16x64_bf16 v[44:47], v[32:35], a[160:167], v3
  v_cvt_pk_bf16_f32 v77, v74, v75
  v_cvt_pk_bf16_f32 v66, v40, v41
  v_smfmac_f32_16x16x64_bf16 v[48:51], v[24:27], a[200:207], v3
  v_cvt_pk_bf16_f32 v67, v42, v43
  v_smfmac_f32_16x16x64_bf16 v[48:51], v[28:31], a[208:215], v3
  v_mfma_f32_16x16x32_bf16 v[68:71], v[64:67], v[4:7], 0
  v_smfmac_f32_16x16x64_bf16 v[48:51], v[32:35], a[216:223], v3
  v_cvt_pk_bf16_f32 v64, v44, v45
  v_mfma_f32_16x16x32_bf16 v[84:87], v[80:83], v[76:79], 0
  v_cvt_pk_bf16_f32 v65, v46, v47
  s_waitcnt lgkmcnt(0)
  v_smfmac_f32_16x16x64_bf16 v[88:91], v[76:79], v[96:103], v3
  v_cvt_pk_bf16_f32 v60, v68, v69
  v_cvt_pk_bf16_f32 v61, v70, v71
  v_cvt_pk_bf16_f32 v66, v48, v49
  v_cvt_pk_bf16_f32 v67, v50, v51
  s_nop 1
  v_mfma_f32_16x16x32_bf16 v[72:75], v[64:67], v[4:7], 0
  v_smfmac_f32_16x16x64_bf16 v[92:95], v[76:79], v[104:111], v3
  s_nop 4
  v_cvt_pk_bf16_f32 v62, v72, v73
  v_cvt_pk_bf16_f32 v63, v74, v75
  s_nop 1
  v_mfma_f32_16x16x32_bf16 v[84:87], v[20:23], v[60:63], v[84:87]
  v_smfmac_f32_16x16x64_bf16 v[88:91], v[60:63], v[8:15], v3
  v_smfmac_f32_16x16x64_bf16 v[92:95], v[60:63], v[52:59], v3
  s_mov_b64 exec, s[26:27]
  s_nop 0
  ds_write_b128 v113, v[84:87]
  s_mov_b64 exec, -1
  s_nop 0
  v_cmp_u_f32 vcc, v88, v89
  s_nop 1
  v_permlane32_swap_b32 v88, v92
  v_permlane32_swap_b32 v89, v93
  v_permlane32_swap_b32 v90, v94
  v_permlane32_swap_b32 v91, v95
  v_add_f32 v88, v88, v92
  v_add_f32 v89, v89, v93
  v_add_f32 v90, v90, v94
  v_add_f32 v91, v91, v95
  ds_write_b128 v112, v[88:91]
  s_cbranch_vccnz cA_sc3_retry
cA_sc3_cont:
  s_waitcnt lgkmcnt(0)
  s_barrier
  ds_read_b64 v[36:37], v114 offset:0
  ds_read_b64 v[38:39], v114 offset:1024
  ds_read2_b32 v[44:45], v115 offset0:0 offset1:64
  s_waitcnt lgkmcnt(0)
  v_add_f32 v44, v44, v45
  v_add_f32 v36, v36, v38
  v_add_f32 v37, v37, v39
  v_add_f32_dpp v44, v44, v44 row_ror:8 row_mask:0xf bank_mask:0xf
  v_mov_b32 v45, v44
  v_permlane32_swap_b32 v36, v37
  v_add_f32 v36, v36, v37
  v_permlane16_swap_b32 v44, v45
  v_add_f32 v44, v44, v45
  v_exp_f32 v48, v36
  v_exp_f32 v49, v44
  v_add_f32 v50, abs(v36), abs(v44)
  v_fma_f32 v39, v49, s37, v48
  v_cmp_ngt_f32 vcc, s56, v50
  v_cndmask_b32 v41, v48, v49, s[38:39]
  v_add_f32_dpp v39, v39, v39 quad_perm:[1,0,3,2] row_mask:0xf bank_mask:0xf
  v_cndmask_b32 v40, v49, v48, s[38:39]
  v_mov_b32_dpp v46, v41 quad_perm:[1,0,3,2] row_mask:0xf bank_mask:0xf
  v_add_f32_dpp v39, v39, v39 quad_perm:[2,3,0,1] row_mask:0xf bank_mask:0xf
  v_cndmask_b32 v42, v46, v40, s[38:39]
  v_cndmask_b32 v43, v40, v46, s[38:39]
  v_add_f32_dpp v39, v39, v39 row_half_mirror row_mask:0xf bank_mask:0xf
  s_cbranch_vccnz cA_sc3_slow
  s_nop 0
  v_add_f32_dpp v39, v39, v39 row_mirror row_mask:0xf bank_mask:0xf
  v_mov_b32 v47, v39
  s_nop 1
  v_permlane16_swap_b32 v39, v47
  v_add_f32 v39, v39, v47
  v_rcp_f32 v39, v39
  s_mov_b64 exec, s[28:29]
  v_mul_f32 v42, v42, v39
  v_mul_f32 v43, v43, v39
  v_cvt_pk_bf16_f32 v42, v42, v43
cA_sc3_pst:
  buffer_store_dword v42, v1, s[8:11], s20 offen
  s_mov_b64 exec, -1
  s_barrier
  s_add_u32 s24, s24, 28672
  s_add_u32 s35, s35, 28672
  s_xor_b32 s25, s25, 28672
  s_add_u32 m0, s25, 21504
  s_nop 0
  buffer_load_dwordx4 v2, s[8:11], s24 offen offset:0 sc1 lds
  buffer_load_dwordx4 v2, s[8:11], s24 offen offset:1024 sc1 lds
  buffer_load_dwordx4 v2, s[8:11], s24 offen offset:2048 sc1 lds
  buffer_load_dwordx4 v2, s[8:11], s24 offen offset:3072 sc1 lds
  s_add_u32 m0, s25, 25600
  s_add_u32 s22, s24, 4096
  buffer_load_dwordx4 v2, s[8:11], s22 offen offset:0 sc1 lds
  buffer_load_dwordx4 v2, s[8:11], s22 offen offset:1024 sc1 lds
  buffer_load_dwordx4 v2, s[8:11], s22 offen offset:2048 sc1 lds
  v_xor_b32 v116, 28672, v116
  v_add_u32 v117, s57, v117
  s_sub_u32 s57, 0, s57
  s_add_u32 s19, s19, 1
  s_mov_b32 s20, s21
  s_cmp_lt_u32 s19, 63
  s_cbranch_scc1 cA_sc3_loop
  s_branch cA_done
cA_sc3_slow:
  v_max_f32 v50, v36, v44
  s_nop 1
  v_max_f32_dpp v50, v50, v50 quad_perm:[1,0,3,2] row_mask:0xf bank_mask:0xf
  s_nop 1
  v_max_f32_dpp v50, v50, v50 quad_perm:[2,3,0,1] row_mask:0xf bank_mask:0xf
  s_nop 1
  v_max_f32_dpp v50, v50, v50 row_half_mirror row_mask:0xf bank_mask:0xf
  s_nop 1
  v_max_f32_dpp v50, v50, v50 row_mirror row_mask:0xf bank_mask:0xf
  v_mov_b32 v47, v50
  s_nop 1
  v_permlane16_swap_b32 v50, v47
  v_max_f32 v50, v50, v47
  v_sub_f32 v48, v36, v50
  v_sub_f32 v49, v44, v50
  v_exp_f32 v48, v48
  v_exp_f32 v49, v49
  s_add_u32 s31, s31, 0x100
  v_fma_f32 v39, v49, s37, v48
  v_cndmask_b32 v41, v48, v49, s[38:39]
  s_nop 0
  v_add_f32_dpp v39, v39, v39 quad_perm:[1,0,3,2] row_mask:0xf bank_mask:0xf
  v_cndmask_b32 v40, v49, v48, s[38:39]
  v_mov_b32_dpp v46, v41 quad_perm:[1,0,3,2] row_mask:0xf bank_mask:0xf
  v_add_f32_dpp v39, v39, v39 quad_perm:[2,3,0,1] row_mask:0xf bank_mask:0xf
  v_cndmask_b32 v42, v46, v40, s[38:39]
  v_cndmask_b32 v43, v40, v46, s[38:39]
  v_add_f32_dpp v39, v39, v39 row_half_mirror row_mask:0xf bank_mask:0xf
  s_nop 1
  v_add_f32_dpp v39, v39, v39 row_mirror row_mask:0xf bank_mask:0xf
  v_mov_b32 v47, v39
  s_nop 1
  v_permlane16_swap_b32 v39, v47
  v_add_f32 v39, v39, v47
  v_rcp_f32 v39, v39
  s_mov_b64 exec, s[28:29]
  v_mul_f32 v42, v42, v39
  v_mul_f32 v43, v43, v39
  v_cvt_pk_bf16_f32 v42, v42, v43
  v_min_u32 v42, -2, v42
  s_branch cA_sc3_pst
cA_sc3_retry:
  s_cmp_lg_u32 s62, 0
  s_cbranch_scc1 cA_sc3_cont
  s_waitcnt vmcnt(0) lgkmcnt(0)
cA_sc3_rv:
  buffer_load_dwordx4 v[8:11], v2, s[8:11], s20 offen offset:0 sc1
  buffer_load_dwordx4 v[12:15], v2, s[8:11], s20 offen offset:1024 sc1
  buffer_load_dwordx4 v[16:19], v2, s[8:11], s20 offen offset:2048 sc1
  buffer_load_dwordx4 v[20:23], v2, s[8:11], s20 offen offset:3072 sc1
  buffer_load_dwordx4 v[24:27], v2, s[8:11], s23 offen offset:0 sc1
  buffer_load_dwordx4 v[28:31], v2, s[8:11], s23 offen offset:1024 sc1
  buffer_load_dwordx4 v[32:35], v2, s[8:11], s23 offen offset:2048 sc1
  s_waitcnt vmcnt(0)
  v_max3_u32 v118, v8, v9, v10
  v_max3_u32 v118, v118, v11, v12
  v_max3_u32 v118, v118, v13, v14
  v_max3_u32 v118, v118, v15, v16
  v_max3_u32 v118, v118, v17, v18
  v_max3_u32 v118, v118, v19, v20
  v_max3_u32 v118, v118, v21, v22
  v_max3_u32 v118, v118, v23, v24
  v_max3_u32 v118, v118, v25, v26
  v_max3_u32 v118, v118, v27, v28
  v_max3_u32 v118, v118, v29, v30
  v_max3_u32 v118, v118, v31, v32
  v_max3_u32 v118, v118, v33, v34
  v_max_u32 v118, v118, v35
  v_cmp_eq_u32 vcc, -1, v118
  s_cbranch_vccz cA_sc3_rk
  s_add_u32 s30, s30, 1
  s_cmp_lt_u32 s30, 400000
  s_cbranch_scc1 cA_sc3_rv
  s_branch cA_abort
cA_sc3_rk:
  s_mov_b32 s62, 1
  v_mov_b32 v36, 0
  v_mov_b32 v37, 0
  v_mov_b32 v38, 0
  v_mov_b32 v39, 0
  v_mov_b32 v40, 0
  v_mov_b32 v41, 0
  v_mov_b32 v42, 0
  v_mov_b32 v43, 0
  v_mov_b32 v44, 0
  v_mov_b32 v45, 0
  v_mov_b32 v46, 0
  v_mov_b32 v47, 0
  v_mov_b32 v48, 0
  v_mov_b32 v49, 0
  v_mov_b32 v50, 0
  v_mov_b32 v51, 0
  v_mov_b32 v52, 0
  v_mov_b32 v53, 0
  v_mov_b32 v54, 0
  v_mov_b32 v55, 0
  v_mov_b32 v56, 0
  v_mov_b32 v57, 0
  v_mov_b32 v58, 0
  v_mov_b32 v59, 0
  v_mov_b32 v60, 0
  v_mov_b32 v61, 0
  v_mov_b32 v62, 0
  v_mov_b32 v63, 0
  v_mov_b32 v88, 0
  v_mov_b32 v89, 0
  v_mov_b32 v90, 0
  v_mov_b32 v91, 0
  v_mov_b32 v92, 0
  v_mov_b32 v93, 0
  v_mov_b32 v94, 0
  v_mov_b32 v95, 0
  v_mov_b32 v64, 0
  v_mov_b32 v65, 0
  s_add_u32 s31, s31, 1
  ds_read_b128 v[96:99], v117 offset:0
  ds_read_b128 v[100:103], v117 offset:1024
  ds_read_b128 v[104:107], v117 offset:14336
  ds_read_b128 v[108:111], v117 offset:15360
  v_smfmac_f32_16x16x64_bf16 v[36:39], v[8:11], a[0:7], v3
  v_smfmac_f32_16x16x64_bf16 v[40:43], v[8:11], a[56:63], v3
  v_smfmac_f32_16x16x64_bf16 v[44:47], v[8:11], a[112:119], v3
  v_smfmac_f32_16x16x64_bf16 v[48:51], v[8:11], a[168:175], v3
  v_smfmac_f32_16x16x64_bf16 v[52:55], v[8:11], a[224:231], v3
  v_smfmac_f32_16x16x64_bf16 v[56:59], v[8:11], v[144:151], v3
  v_smfmac_f32_16x16x64_bf16 v[60:63], v[8:11], v[200:207], v3
  v_smfmac_f32_16x16x64_bf16 v[36:39], v[12:15], a[8:15], v3
  v_smfmac_f32_16x16x64_bf16 v[40:43], v[12:15], a[64:71], v3
  v_smfmac_f32_16x16x64_bf16 v[44:47], v[12:15], a[120:127], v3
  v_smfmac_f32_16x16x64_bf16 v[48:51], v[12:15], a[176:183], v3
  v_smfmac_f32_16x16x64_bf16 v[52:55], v[12:15], a[232:239], v3
  v_smfmac_f32_16x16x64_bf16 v[56:59], v[12:15], v[152:159], v3
  v_smfmac_f32_16x16x64_bf16 v[60:63], v[12:15], v[208:215], v3
  v_smfmac_f32_16x16x64_bf16 v[36:39], v[16:19], a[16:23], v3
  v_smfmac_f32_16x16x64_bf16 v[40:43], v[16:19], a[72:79], v3
  v_smfmac_f32_16x16x64_bf16 v[44:47], v[16:19], a[128:135], v3
  v_smfmac_f32_16x16x64_bf16 v[48:51], v[16:19], a[184:191], v3
  v_smfmac_f32_16x16x64_bf16 v[52:55], v[16:19], a[240:247], v3
  v_smfmac_f32_16x16x64_bf16 v[56:59], v[16:19], v[160:167], v3
  v_smfmac_f32_16x16x64_bf16 v[60:63], v[16:19], v[216:223], v3
  v_smfmac_f32_16x16x64_bf16 v[36:39], v[20:23], a[24:31], v3
  v_smfmac_f32_16x16x64_bf16 v[40:43], v[20:23], a[80:87], v3
  v_smfmac_f32_16x16x64_bf16 v[44:47], v[20:23], a[136:143], v3
  v_smfmac_f32_16x16x64_bf16 v[48:51], v[20:23], a[192:199], v3
  v_smfmac_f32_16x16x64_bf16 v[52:55], v[20:23], a[248:255], v3
  v_smfmac_f32_16x16x64_bf16 v[56:59], v[20:23], v[168:175], v3
  v_smfmac_f32_16x16x64_bf16 v[60:63], v[20:23], v[224:231], v3
  s_branch cA_sc3_ph2
.p2align 6

cA_va0_loop:
  s_add_u32 s23, s20, 4096
  s_add_u32 s21, s20, 25600
  s_mov_b32 s30, 0
  s_cmp_lg_u32 s19, s38
  s_cbranch_scc1 cA_va0_vok
  s_branch cA_va0_voc
cA_va0_vow:
  buffer_load_dword v175, off, s[8:11], s35 sc1
  s_waitcnt vmcnt(0)
cA_va0_voc:
  v_readfirstlane_b32 s22, v175
  s_cmp_eq_u32 s22, 56
  s_cbranch_scc1 cA_va0_vod
  s_sleep 1
  s_add_u32 s30, s30, 1
  s_cmp_lt_u32 s30, 400000
  s_cbranch_scc1 cA_va0_vow
  s_branch cA_abort
cA_va0_vod:
  s_add_u32 s35, s35, 2048
  s_add_u32 s38, s19, 8
  s_and_b32 s38, s38, -8
  s_cmp_eq_u32 s19, 0
  s_cselect_b32 s38, 4, s38
cA_va0_vok:
  s_cmp_eq_u32 s19, 63
  s_cbranch_scc1 cA_done
  s_barrier
  s_add_u32 s22, s25, 0
  buffer_load_dwordx4 v[80:83], v6, s[8:11], s22 offen offset:0 sc1
  buffer_load_dwordx4 v[84:87], v6, s[8:11], s22 offen offset:1792 sc1
  s_add_u32 s22, s25, 3584
  buffer_load_dwordx4 v[88:91], v6, s[8:11], s22 offen offset:0 sc1
  buffer_load_dwordx4 v[92:95], v6, s[8:11], s22 offen offset:1792 sc1
  s_add_u32 s22, s25, 7168
  buffer_load_dwordx4 v[96:99], v6, s[8:11], s22 offen offset:0 sc1
  buffer_load_dwordx4 v[100:103], v6, s[8:11], s22 offen offset:1792 sc1
  s_add_u32 s22, s25, 10752
  buffer_load_dwordx4 v[104:107], v6, s[8:11], s22 offen offset:0 sc1
  buffer_load_dwordx4 v[108:111], v6, s[8:11], s22 offen offset:1792 sc1
  s_add_u32 s22, s25, 14336
  buffer_load_dwordx4 v[112:115], v6, s[8:11], s22 offen offset:0 sc1
  buffer_load_dwordx4 v[116:119], v6, s[8:11], s22 offen offset:1792 sc1
  s_add_u32 s22, s25, 17920
  buffer_load_dwordx4 v[120:123], v6, s[8:11], s22 offen offset:0 sc1
  buffer_load_dwordx4 v[124:127], v6, s[8:11], s22 offen offset:1792 sc1
  s_add_u32 s22, s25, 21504
  buffer_load_dwordx4 v[128:131], v6, s[8:11], s22 offen offset:0 sc1
  buffer_load_dwordx4 v[132:135], v6, s[8:11], s22 offen offset:1792 sc1
  s_add_u32 s22, s25, 25088
  buffer_load_dwordx4 v[136:139], v6, s[8:11], s22 offen offset:0 sc1
  buffer_load_dwordx4 v[140:143], v6, s[8:11], s22 offen offset:1792 sc1
  buffer_load_dword v175, off, s[8:11], s35 sc1
  s_barrier
  ds_read_b128 v[8:11], v2 offset:8192
  ds_read_b128 v[12:15], v2 offset:9216
  ds_read_b128 v[16:19], v2 offset:10240
  ds_read_b128 v[20:23], v2 offset:11264
  ds_read_b128 v[24:27], v2 offset:12288
  ds_read_b128 v[28:31], v2 offset:13312
  ds_read_b128 v[32:35], v2 offset:14336
  s_waitcnt lgkmcnt(0)
  v_smfmac_f32_16x16x64_bf16 v[36:39], v[8:11], a[0:7], v3
  v_smfmac_f32_16x16x64_bf16 v[36:39], v[12:15], a[8:15], v3
  v_smfmac_f32_16x16x64_bf16 v[36:39], v[16:19], a[16:23], v3
  v_smfmac_f32_16x16x64_bf16 v[36:39], v[20:23], a[24:31], v3
  v_smfmac_f32_16x16x64_bf16 v[36:39], v[24:27], a[32:39], v3
  v_smfmac_f32_16x16x64_bf16 v[36:39], v[28:31], a[40:47], v3
  v_smfmac_f32_16x16x64_bf16 v[36:39], v[32:35], a[48:55], v3
  v_smfmac_f32_16x16x64_bf16 v[40:43], v[8:11], a[56:63], v3
  v_smfmac_f32_16x16x64_bf16 v[40:43], v[12:15], a[64:71], v3
  v_smfmac_f32_16x16x64_bf16 v[40:43], v[16:19], a[72:79], v3
  v_smfmac_f32_16x16x64_bf16 v[40:43], v[20:23], a[80:87], v3
  v_smfmac_f32_16x16x64_bf16 v[40:43], v[24:27], a[88:95], v3
  v_smfmac_f32_16x16x64_bf16 v[40:43], v[28:31], a[96:103], v3
  v_smfmac_f32_16x16x64_bf16 v[40:43], v[32:35], a[104:111], v3
  v_smfmac_f32_16x16x64_bf16 v[44:47], v[8:11], a[112:119], v3
  v_smfmac_f32_16x16x64_bf16 v[44:47], v[12:15], a[120:127], v3
  v_smfmac_f32_16x16x64_bf16 v[44:47], v[16:19], a[128:135], v3
  v_smfmac_f32_16x16x64_bf16 v[44:47], v[20:23], a[136:143], v3
  v_permlane32_swap_b32 v36, v40
  v_smfmac_f32_16x16x64_bf16 v[44:47], v[24:27], a[144:151], v3
  v_permlane32_swap_b32 v37, v41
  v_smfmac_f32_16x16x64_bf16 v[44:47], v[28:31], a[152:159], v3
  v_permlane32_swap_b32 v38, v42
  v_smfmac_f32_16x16x64_bf16 v[44:47], v[32:35], a[160:167], v3
  v_permlane32_swap_b32 v39, v43
  v_smfmac_f32_16x16x64_bf16 v[48:51], v[8:11], a[168:175], v3
  v_add_f32 v36, v36, v40
  v_smfmac_f32_16x16x64_bf16 v[48:51], v[12:15], a[176:183], v3
  v_add_f32 v37, v37, v41
  v_smfmac_f32_16x16x64_bf16 v[48:51], v[16:19], a[184:191], v3
  v_add_f32 v38, v38, v42
  v_smfmac_f32_16x16x64_bf16 v[48:51], v[20:23], a[192:199], v3
  v_add_f32 v39, v39, v43
  v_smfmac_f32_16x16x64_bf16 v[48:51], v[24:27], a[200:207], v3
  v_cvt_pk_bf16_f32 v40, v36, v37
  v_smfmac_f32_16x16x64_bf16 v[48:51], v[28:31], a[208:215], v3
  v_cvt_pk_bf16_f32 v41, v38, v39
  v_smfmac_f32_16x16x64_bf16 v[48:51], v[32:35], a[216:223], v3
  ds_write_b64 v60, v[40:41]
  v_smfmac_f32_16x16x64_bf16 v[52:55], v[8:11], a[224:231], v3
  v_smfmac_f32_16x16x64_bf16 v[52:55], v[12:15], a[232:239], v3
  v_smfmac_f32_16x16x64_bf16 v[52:55], v[16:19], a[240:247], v3
  v_smfmac_f32_16x16x64_bf16 v[52:55], v[20:23], a[248:255], v3
  v_permlane32_swap_b32 v44, v48
  v_smfmac_f32_16x16x64_bf16 v[52:55], v[24:27], v[176:183], v3
  v_permlane32_swap_b32 v45, v49
  v_smfmac_f32_16x16x64_bf16 v[52:55], v[28:31], v[184:191], v3
  v_permlane32_swap_b32 v46, v50
  v_smfmac_f32_16x16x64_bf16 v[52:55], v[32:35], v[192:199], v3
  v_permlane32_swap_b32 v47, v51
  v_smfmac_f32_16x16x64_bf16 v[56:59], v[8:11], v[200:207], v3
  v_add_f32 v44, v44, v48
  v_smfmac_f32_16x16x64_bf16 v[56:59], v[12:15], v[208:215], v3
  v_add_f32 v45, v45, v49
  v_smfmac_f32_16x16x64_bf16 v[56:59], v[16:19], v[216:223], v3
  v_add_f32 v46, v46, v50
  v_smfmac_f32_16x16x64_bf16 v[56:59], v[20:23], v[224:231], v3
  v_add_f32 v47, v47, v51
  v_smfmac_f32_16x16x64_bf16 v[56:59], v[24:27], v[232:239], v3
  v_cvt_pk_bf16_f32 v48, v44, v45
  v_smfmac_f32_16x16x64_bf16 v[56:59], v[28:31], v[240:247], v3
  v_cvt_pk_bf16_f32 v49, v46, v47
  v_smfmac_f32_16x16x64_bf16 v[56:59], v[32:35], v[248:255], v3
  ds_write_b64 v61, v[48:49]
  s_nop 6
  v_permlane32_swap_b32 v52, v56
  v_permlane32_swap_b32 v53, v57
  v_permlane32_swap_b32 v54, v58
  v_permlane32_swap_b32 v55, v59
  v_add_f32 v52, v52, v56
  v_add_f32 v53, v53, v57
  v_add_f32 v54, v54, v58
  v_add_f32 v55, v55, v59
  v_cvt_pk_bf16_f32 v56, v52, v53
  v_cvt_pk_bf16_f32 v57, v54, v55
  ds_write_b64 v62, v[56:57]
  s_cmp_eq_u32 s19, 63
  s_cbranch_scc1 cA_va0_last
  s_add_u32 s22, s20, 9216
  s_add_u32 s34, s20, 13312
  s_add_u32 s36, s20, 7168
  s_mov_b32 s37, 0
  v_mov_b32 v156, 0
  v_mov_b32 v157, 0
  v_mov_b32 v158, 0
  v_mov_b32 v159, 0
  buffer_load_dword v164, v4, s[8:11], s20 offen sc1
  s_nop 7
  buffer_load_dword v165, v4, s[8:11], s20 offen sc1
  s_nop 7
  buffer_load_dword v166, v4, s[8:11], s20 offen sc1
  s_nop 7
  buffer_load_dword v167, v4, s[8:11], s20 offen sc1
  s_nop 7
  buffer_load_dword v168, v4, s[8:11], s20 offen sc1
cA_va0_fw_l:
  s_waitcnt vmcnt(4)
  v_cmp_eq_u32 vcc, -1, v164
  s_cbranch_vccz cA_va0_fw_d
  buffer_load_dword v164, v4, s[8:11], s20 offen sc1
  s_waitcnt vmcnt(4)
  v_cmp_eq_u32 vcc, -1, v165
  s_cbranch_vccz cA_va0_fw_d
  buffer_load_dword v165, v4, s[8:11], s20 offen sc1
  s_waitcnt vmcnt(4)
  v_cmp_eq_u32 vcc, -1, v166
  s_cbranch_vccz cA_va0_fw_d
  buffer_load_dword v166, v4, s[8:11], s20 offen sc1
  s_waitcnt vmcnt(4)
  v_cmp_eq_u32 vcc, -1, v167
  s_cbranch_vccz cA_va0_fw_d
  buffer_load_dword v167, v4, s[8:11], s20 offen sc1
  s_waitcnt vmcnt(4)
  v_cmp_eq_u32 vcc, -1, v168
  s_cbranch_vccz cA_va0_fw_d
  buffer_load_dword v168, v4, s[8:11], s20 offen sc1
  s_add_u32 s30, s30, 1
  s_cmp_lt_u32 s30, 400000
  s_cbranch_scc1 cA_va0_fw_l
  s_branch cA_abort
cA_va0_fw_d:
  s_waitcnt lgkmcnt(0)
  buffer_load_dwordx4 v[8:11], v2, s[8:11], s22 offen offset:0
  v_mov_b32 v36, 0
  v_mov_b32 v37, 0
  v_mov_b32 v38, 0
  buffer_load_dwordx4 v[12:15], v2, s[8:11], s22 offen offset:1024
  v_mov_b32 v39, 0
  v_mov_b32 v40, 0
  v_mov_b32 v41, 0
  buffer_load_dwordx4 v[16:19], v2, s[8:11], s22 offen offset:2048
  v_mov_b32 v42, 0
  v_mov_b32 v43, 0
  v_mov_b32 v44, 0
  buffer_load_dwordx4 v[20:23], v2, s[8:11], s22 offen offset:3072
  v_mov_b32 v45, 0
  v_mov_b32 v46, 0
  v_mov_b32 v47, 0
  buffer_load_dwordx4 v[24:27], v2, s[8:11], s34 offen offset:0
  v_mov_b32 v48, 0
  v_mov_b32 v49, 0
  v_mov_b32 v50, 0
  buffer_load_dwordx4 v[28:31], v2, s[8:11], s34 offen offset:1024
  v_mov_b32 v51, 0
  v_mov_b32 v52, 0
  v_mov_b32 v53, 0
  buffer_load_dwordx4 v[32:35], v2, s[8:11], s34 offen offset:2048
  v_mov_b32 v54, 0
  v_mov_b32 v55, 0
  v_mov_b32 v56, 0
  buffer_load_dwordx4 v[144:147], v2, s[8:11], s34 offen offset:3072
  v_mov_b32 v57, 0
  v_mov_b32 v58, 0
  v_mov_b32 v59, 0
  buffer_load_dwordx4 v[148:151], v2, s[8:11], s36 offen offset:0
  buffer_load_dwordx4 v[152:155], v2, s[8:11], s36 offen offset:1024
  s_barrier
  ds_read_b128 v[64:67], v2 offset:0
  ds_read_b128 v[68:71], v2 offset:1024
  ds_read_b128 v[72:75], v2 offset:2048
  ds_read_b128 v[76:79], v2 offset:3072
  s_waitcnt vmcnt(9)
  v_smfmac_f32_16x16x64_bf16 v[156:159], v[8:11], v[80:87], v3
  s_waitcnt vmcnt(8)
  v_smfmac_f32_16x16x64_bf16 v[156:159], v[12:15], v[88:95], v3
  s_waitcnt vmcnt(7)
  v_smfmac_f32_16x16x64_bf16 v[156:159], v[16:19], v[96:103], v3
  s_waitcnt vmcnt(6)
  v_smfmac_f32_16x16x64_bf16 v[156:159], v[20:23], v[104:111], v3
  s_waitcnt vmcnt(5)
  v_smfmac_f32_16x16x64_bf16 v[156:159], v[24:27], v[112:119], v3
  s_mov_b32 exec_hi, 0
  buffer_store_dword v2, v7, s[8:11], s21 offen
  s_mov_b64 exec, -1
  s_waitcnt vmcnt(5)
  v_smfmac_f32_16x16x64_bf16 v[156:159], v[28:31], v[120:127], v3
  s_waitcnt vmcnt(4)
  v_smfmac_f32_16x16x64_bf16 v[156:159], v[32:35], v[128:135], v3
  s_waitcnt vmcnt(3)
  v_smfmac_f32_16x16x64_bf16 v[156:159], v[144:147], v[136:143], v3
  s_waitcnt vmcnt(2) lgkmcnt(0)
  v_smfmac_f32_16x16x64_bf16 v[156:159], v[148:151], v[64:71], v3
  s_waitcnt vmcnt(1)
  v_smfmac_f32_16x16x64_bf16 v[156:159], v[152:155], v[72:79], v3
cA_va0_ep:
  s_nop 7
  v_permlane32_swap_b32 v156, v158
  v_permlane32_swap_b32 v157, v159
  v_add_f32 v160, v156, v158
  v_add_f32 v161, v157, v159
  v_cmp_u_f32 vcc, v160, v161
  v_mov_b32_dpp v162, v160 row_ror:8 row_mask:0xf bank_mask:0xf
  v_mov_b32_dpp v160, v161 row_ror:8 row_mask:0xf bank_mask:0xc
  s_cbranch_vccnz cA_va0_rp
  v_mov_b32_dpp v161, v162 quad_perm:[0,1,2,3] row_mask:0xf bank_mask:0x3
  v_cvt_pk_bf16_f32 v160, v160, v161
cA_va0_pc:
  buffer_store_dword v160, v1, s[8:11], s21 offen
  s_cmp_lg_u32 s19, 62
  s_cbranch_scc1 cA_va0_nl
  s_mov_b32 s22, 88519680
  buffer_store_dword v160, v1, s[8:11], s22 offen sc1
  s_mov_b64 exec, -1
  s_branch cA_done
cA_va0_nl:
  s_mov_b64 exec, -1
  s_add_u32 s25, s25, 28672
  s_add_u32 s19, s19, 1
  s_mov_b32 s20, s21
  s_branch cA_va0_loop
cA_va0_last:
  s_waitcnt lgkmcnt(0)
  s_barrier
  s_branch cA_done
cA_va0_rp:
  s_cmp_eq_u32 s37, 0
  s_cbranch_scc1 cA_va0_rv
  v_mov_b32_dpp v161, v162 quad_perm:[0,1,2,3] row_mask:0xf bank_mask:0x3
  v_cvt_pk_bf16_f32 v160, v160, v161
  v_min_u32 v160, -2, v160
  s_branch cA_va0_pc
cA_va0_rv:
  buffer_load_dwordx4 v[8:11], v2, s[8:11], s22 offen offset:0 sc1
  buffer_load_dwordx4 v[12:15], v2, s[8:11], s22 offen offset:1024 sc1
  buffer_load_dwordx4 v[16:19], v2, s[8:11], s22 offen offset:2048 sc1
  buffer_load_dwordx4 v[20:23], v2, s[8:11], s22 offen offset:3072 sc1
  buffer_load_dwordx4 v[24:27], v2, s[8:11], s34 offen offset:0 sc1
  buffer_load_dwordx4 v[28:31], v2, s[8:11], s34 offen offset:1024 sc1
  buffer_load_dwordx4 v[32:35], v2, s[8:11], s34 offen offset:2048 sc1
  buffer_load_dwordx4 v[144:147], v2, s[8:11], s34 offen offset:3072 sc1
  buffer_load_dwordx4 v[148:151], v2, s[8:11], s36 offen offset:0 sc1
  buffer_load_dwordx4 v[152:155], v2, s[8:11], s36 offen offset:1024 sc1
  s_waitcnt vmcnt(0)
  v_max3_u32 v63, v8, v9, v10
  v_max3_u32 v63, v63, v11, v12
  v_max3_u32 v63, v63, v13, v14
  v_max3_u32 v63, v63, v15, v16
  v_max3_u32 v63, v63, v17, v18
  v_max3_u32 v63, v63, v19, v20
  v_max3_u32 v63, v63, v21, v22
  v_max3_u32 v63, v63, v23, v24
  v_max3_u32 v63, v63, v25, v26
  v_max3_u32 v63, v63, v27, v28
  v_max3_u32 v63, v63, v29, v30
  v_max3_u32 v63, v63, v31, v32
  v_max3_u32 v63, v63, v33, v34
  v_max3_u32 v63, v63, v35, v144
  v_max3_u32 v63, v63, v145, v146
  v_max3_u32 v63, v63, v147, v148
  v_max3_u32 v63, v63, v149, v150
  v_max3_u32 v63, v63, v151, v152
  v_max3_u32 v63, v63, v153, v154
  v_max_u32 v63, v63, v155
  v_cmp_eq_u32 vcc, -1, v63
  s_cbranch_vccz cA_va0_rk
  s_add_u32 s30, s30, 1
  s_cmp_lt_u32 s30, 400000
  s_cbranch_scc1 cA_va0_rv
  s_branch cA_abort
cA_va0_rk:
  s_mov_b32 s37, 1
  s_add_u32 s31, s31, 0x10000
  v_mov_b32 v156, 0
  v_mov_b32 v157, 0
  v_mov_b32 v158, 0
  v_mov_b32 v159, 0
  s_nop 1
  v_smfmac_f32_16x16x64_bf16 v[156:159], v[8:11], v[80:87], v3
  v_smfmac_f32_16x16x64_bf16 v[156:159], v[12:15], v[88:95], v3
  v_smfmac_f32_16x16x64_bf16 v[156:159], v[16:19], v[96:103], v3
  v_smfmac_f32_16x16x64_bf16 v[156:159], v[20:23], v[104:111], v3
  v_smfmac_f32_16x16x64_bf16 v[156:159], v[24:27], v[112:119], v3
  v_smfmac_f32_16x16x64_bf16 v[156:159], v[28:31], v[120:127], v3
  v_smfmac_f32_16x16x64_bf16 v[156:159], v[32:35], v[128:135], v3
  v_smfmac_f32_16x16x64_bf16 v[156:159], v[144:147], v[136:143], v3
  v_smfmac_f32_16x16x64_bf16 v[156:159], v[148:151], v[64:71], v3
  v_smfmac_f32_16x16x64_bf16 v[156:159], v[152:155], v[72:79], v3
  s_nop 7
  s_branch cA_va0_ep
.p2align 6

cA_va1_loop:
  s_add_u32 s23, s20, 4096
  s_add_u32 s21, s20, 25600
  s_mov_b32 s30, 0
  s_cmp_lg_u32 s19, s38
  s_cbranch_scc1 cA_va1_vok
  s_branch cA_va1_voc
cA_va1_vow:
  buffer_load_dword v175, off, s[8:11], s35 sc1
  s_waitcnt vmcnt(0)
cA_va1_voc:
  v_readfirstlane_b32 s22, v175
  s_cmp_eq_u32 s22, 56
  s_cbranch_scc1 cA_va1_vod
  s_sleep 1
  s_add_u32 s30, s30, 1
  s_cmp_lt_u32 s30, 400000
  s_cbranch_scc1 cA_va1_vow
  s_branch cA_abort
cA_va1_vod:
  s_add_u32 s35, s35, 2048
  s_add_u32 s38, s19, 8
  s_and_b32 s38, s38, -8
  s_cmp_eq_u32 s19, 0
  s_cselect_b32 s38, 4, s38
cA_va1_vok:
  s_cmp_eq_u32 s19, 63
  s_cbranch_scc1 cA_done
  s_barrier
  s_add_u32 s22, s25, 0
  buffer_load_dwordx4 v[80:83], v6, s[8:11], s22 offen offset:0 sc1
  buffer_load_dwordx4 v[84:87], v6, s[8:11], s22 offen offset:1792 sc1
  s_add_u32 s22, s25, 3584
  buffer_load_dwordx4 v[88:91], v6, s[8:11], s22 offen offset:0 sc1
  buffer_load_dwordx4 v[92:95], v6, s[8:11], s22 offen offset:1792 sc1
  s_add_u32 s22, s25, 7168
  buffer_load_dwordx4 v[96:99], v6, s[8:11], s22 offen offset:0 sc1
  buffer_load_dwordx4 v[100:103], v6, s[8:11], s22 offen offset:1792 sc1
  s_add_u32 s22, s25, 10752
  buffer_load_dwordx4 v[104:107], v6, s[8:11], s22 offen offset:0 sc1
  buffer_load_dwordx4 v[108:111], v6, s[8:11], s22 offen offset:1792 sc1
  s_add_u32 s22, s25, 14336
  buffer_load_dwordx4 v[112:115], v6, s[8:11], s22 offen offset:0 sc1
  buffer_load_dwordx4 v[116:119], v6, s[8:11], s22 offen offset:1792 sc1
  s_add_u32 s22, s25, 17920
  buffer_load_dwordx4 v[120:123], v6, s[8:11], s22 offen offset:0 sc1
  buffer_load_dwordx4 v[124:127], v6, s[8:11], s22 offen offset:1792 sc1
  s_add_u32 s22, s25, 21504
  buffer_load_dwordx4 v[128:131], v6, s[8:11], s22 offen offset:0 sc1
  buffer_load_dwordx4 v[132:135], v6, s[8:11], s22 offen offset:1792 sc1
  s_add_u32 s22, s25, 25088
  buffer_load_dwordx4 v[136:139], v6, s[8:11], s22 offen offset:0 sc1
  buffer_load_dwordx4 v[140:143], v6, s[8:11], s22 offen offset:1792 sc1
  buffer_load_dword v175, off, s[8:11], s35 sc1
  s_barrier
  ds_read_b128 v[8:11], v2 offset:8192
  ds_read_b128 v[12:15], v2 offset:9216
  ds_read_b128 v[16:19], v2 offset:10240
  ds_read_b128 v[20:23], v2 offset:11264
  ds_read_b128 v[24:27], v2 offset:12288
  ds_read_b128 v[28:31], v2 offset:13312
  ds_read_b128 v[32:35], v2 offset:14336
  s_waitcnt lgkmcnt(0)
  v_smfmac_f32_16x16x64_bf16 v[36:39], v[8:11], a[0:7], v3
  v_smfmac_f32_16x16x64_bf16 v[36:39], v[12:15], a[8:15], v3
  v_smfmac_f32_16x16x64_bf16 v[36:39], v[16:19], a[16:23], v3
  v_smfmac_f32_16x16x64_bf16 v[36:39], v[20:23], a[24:31], v3
  v_smfmac_f32_16x16x64_bf16 v[36:39], v[24:27], a[32:39], v3
  v_smfmac_f32_16x16x64_bf16 v[36:39], v[28:31], a[40:47], v3
  v_smfmac_f32_16x16x64_bf16 v[36:39], v[32:35], a[48:55], v3
  v_smfmac_f32_16x16x64_bf16 v[40:43], v[8:11], a[56:63], v3
  v_smfmac_f32_16x16x64_bf16 v[40:43], v[12:15], a[64:71], v3
  v_smfmac_f32_16x16x64_bf16 v[40:43], v[16:19], a[72:79], v3
  v_smfmac_f32_16x16x64_bf16 v[40:43], v[20:23], a[80:87], v3
  v_smfmac_f32_16x16x64_bf16 v[40:43], v[24:27], a[88:95], v3
  v_smfmac_f32_16x16x64_bf16 v[40:43], v[28:31], a[96:103], v3
  v_smfmac_f32_16x16x64_bf16 v[40:43], v[32:35], a[104:111], v3
  v_smfmac_f32_16x16x64_bf16 v[44:47], v[8:11], a[112:119], v3
  v_smfmac_f32_16x16x64_bf16 v[44:47], v[12:15], a[120:127], v3
  v_smfmac_f32_16x16x64_bf16 v[44:47], v[16:19], a[128:135], v3
  v_smfmac_f32_16x16x64_bf16 v[44:47], v[20:23], a[136:143], v3
  v_permlane32_swap_b32 v36, v40
  v_smfmac_f32_16x16x64_bf16 v[44:47], v[24:27], a[144:151], v3
  v_permlane32_swap_b32 v37, v41
  v_smfmac_f32_16x16x64_bf16 v[44:47], v[28:31], a[152:159], v3
  v_permlane32_swap_b32 v38, v42
  v_smfmac_f32_16x16x64_bf16 v[44:47], v[32:35], a[160:167], v3
  v_permlane32_swap_b32 v39, v43
  v_smfmac_f32_16x16x64_bf16 v[48:51], v[8:11], a[168:175], v3
  v_add_f32 v36, v36, v40
  v_smfmac_f32_16x16x64_bf16 v[48:51], v[12:15], a[176:183], v3
  v_add_f32 v37, v37, v41
  v_smfmac_f32_16x16x64_bf16 v[48:51], v[16:19], a[184:191], v3
  v_add_f32 v38, v38, v42
  v_smfmac_f32_16x16x64_bf16 v[48:51], v[20:23], a[192:199], v3
  v_add_f32 v39, v39, v43
  v_smfmac_f32_16x16x64_bf16 v[48:51], v[24:27], a[200:207], v3
  v_cvt_pk_bf16_f32 v40, v36, v37
  v_smfmac_f32_16x16x64_bf16 v[48:51], v[28:31], a[208:215], v3
  v_cvt_pk_bf16_f32 v41, v38, v39
  v_smfmac_f32_16x16x64_bf16 v[48:51], v[32:35], a[216:223], v3
  ds_write_b64 v60, v[40:41]
  v_smfmac_f32_16x16x64_bf16 v[52:55], v[8:11], a[224:231], v3
  v_smfmac_f32_16x16x64_bf16 v[52:55], v[12:15], a[232:239], v3
  v_smfmac_f32_16x16x64_bf16 v[52:55], v[16:19], a[240:247], v3
  v_smfmac_f32_16x16x64_bf16 v[52:55], v[20:23], a[248:255], v3
  v_permlane32_swap_b32 v44, v48
  v_smfmac_f32_16x16x64_bf16 v[52:55], v[24:27], v[176:183], v3
  v_permlane32_swap_b32 v45, v49
  v_smfmac_f32_16x16x64_bf16 v[52:55], v[28:31], v[184:191], v3
  v_permlane32_swap_b32 v46, v50
  v_smfmac_f32_16x16x64_bf16 v[52:55], v[32:35], v[192:199], v3
  v_permlane32_swap_b32 v47, v51
  v_smfmac_f32_16x16x64_bf16 v[56:59], v[8:11], v[200:207], v3
  v_add_f32 v44, v44, v48
  v_smfmac_f32_16x16x64_bf16 v[56:59], v[12:15], v[208:215], v3
  v_add_f32 v45, v45, v49
  v_smfmac_f32_16x16x64_bf16 v[56:59], v[16:19], v[216:223], v3
  v_add_f32 v46, v46, v50
  v_smfmac_f32_16x16x64_bf16 v[56:59], v[20:23], v[224:231], v3
  v_add_f32 v47, v47, v51
  v_smfmac_f32_16x16x64_bf16 v[56:59], v[24:27], v[232:239], v3
  v_cvt_pk_bf16_f32 v48, v44, v45
  v_smfmac_f32_16x16x64_bf16 v[56:59], v[28:31], v[240:247], v3
  v_cvt_pk_bf16_f32 v49, v46, v47
  v_smfmac_f32_16x16x64_bf16 v[56:59], v[32:35], v[248:255], v3
  ds_write_b64 v61, v[48:49]
  s_nop 6
  v_permlane32_swap_b32 v52, v56
  v_permlane32_swap_b32 v53, v57
  v_permlane32_swap_b32 v54, v58
  v_permlane32_swap_b32 v55, v59
  v_add_f32 v52, v52, v56
  v_add_f32 v53, v53, v57
  v_add_f32 v54, v54, v58
  v_add_f32 v55, v55, v59
  v_cvt_pk_bf16_f32 v56, v52, v53
  v_cvt_pk_bf16_f32 v57, v54, v55
  ds_write_b64 v62, v[56:57]
  s_cmp_eq_u32 s19, 63
  s_cbranch_scc1 cA_va1_last
  s_add_u32 s22, s20, 9216
  s_add_u32 s34, s20, 13312
  s_add_u32 s36, s20, 7168
  s_mov_b32 s37, 0
  v_mov_b32 v156, 0
  v_mov_b32 v157, 0
  v_mov_b32 v158, 0
  v_mov_b32 v159, 0
  buffer_load_dword v164, v4, s[8:11], s20 offen sc1
  s_nop 7
  buffer_load_dword v165, v4, s[8:11], s20 offen sc1
  s_nop 7
  buffer_load_dword v166, v4, s[8:11], s20 offen sc1
  s_nop 7
  buffer_load_dword v167, v4, s[8:11], s20 offen sc1
  s_nop 7
  buffer_load_dword v168, v4, s[8:11], s20 offen sc1
cA_va1_fw_l:
  s_waitcnt vmcnt(4)
  v_cmp_eq_u32 vcc, -1, v164
  s_cbranch_vccz cA_va1_fw_d
  buffer_load_dword v164, v4, s[8:11], s20 offen sc1
  s_waitcnt vmcnt(4)
  v_cmp_eq_u32 vcc, -1, v165
  s_cbranch_vccz cA_va1_fw_d
  buffer_load_dword v165, v4, s[8:11], s20 offen sc1
  s_waitcnt vmcnt(4)
  v_cmp_eq_u32 vcc, -1, v166
  s_cbranch_vccz cA_va1_fw_d
  buffer_load_dword v166, v4, s[8:11], s20 offen sc1
  s_waitcnt vmcnt(4)
  v_cmp_eq_u32 vcc, -1, v167
  s_cbranch_vccz cA_va1_fw_d
  buffer_load_dword v167, v4, s[8:11], s20 offen sc1
  s_waitcnt vmcnt(4)
  v_cmp_eq_u32 vcc, -1, v168
  s_cbranch_vccz cA_va1_fw_d
  buffer_load_dword v168, v4, s[8:11], s20 offen sc1
  s_add_u32 s30, s30, 1
  s_cmp_lt_u32 s30, 400000
  s_cbranch_scc1 cA_va1_fw_l
  s_branch cA_abort
cA_va1_fw_d:
  s_waitcnt lgkmcnt(0)
  buffer_load_dwordx4 v[8:11], v2, s[8:11], s22 offen offset:0
  v_mov_b32 v36, 0
  v_mov_b32 v37, 0
  v_mov_b32 v38, 0
  buffer_load_dwordx4 v[12:15], v2, s[8:11], s22 offen offset:1024
  v_mov_b32 v39, 0
  v_mov_b32 v40, 0
  v_mov_b32 v41, 0
  buffer_load_dwordx4 v[16:19], v2, s[8:11], s22 offen offset:2048
  v_mov_b32 v42, 0
  v_mov_b32 v43, 0
  v_mov_b32 v44, 0
  buffer_load_dwordx4 v[20:23], v2, s[8:11], s22 offen offset:3072
  v_mov_b32 v45, 0
  v_mov_b32 v46, 0
  v_mov_b32 v47, 0
  buffer_load_dwordx4 v[24:27], v2, s[8:11], s34 offen offset:0
  v_mov_b32 v48, 0
  v_mov_b32 v49, 0
  v_mov_b32 v50, 0
  buffer_load_dwordx4 v[28:31], v2, s[8:11], s34 offen offset:1024
  v_mov_b32 v51, 0
  v_mov_b32 v52, 0
  v_mov_b32 v53, 0
  buffer_load_dwordx4 v[32:35], v2, s[8:11], s34 offen offset:2048
  v_mov_b32 v54, 0
  v_mov_b32 v55, 0
  v_mov_b32 v56, 0
  buffer_load_dwordx4 v[144:147], v2, s[8:11], s34 offen offset:3072
  v_mov_b32 v57, 0
  v_mov_b32 v58, 0
  v_mov_b32 v59, 0
  buffer_load_dwordx4 v[148:151], v2, s[8:11], s36 offen offset:0
  buffer_load_dwordx4 v[152:155], v2, s[8:11], s36 offen offset:1024
  s_barrier
  ds_read_b128 v[64:67], v2 offset:4096
  ds_read_b128 v[68:71], v2 offset:5120
  ds_read_b128 v[72:75], v2 offset:6144
  ds_read_b128 v[76:79], v2 offset:7168
  s_waitcnt vmcnt(9)
  v_smfmac_f32_16x16x64_bf16 v[156:159], v[8:11], v[80:87], v3
  s_waitcnt vmcnt(8)
  v_smfmac_f32_16x16x64_bf16 v[156:159], v[12:15], v[88:95], v3
  s_waitcnt vmcnt(7)
  v_smfmac_f32_16x16x64_bf16 v[156:159], v[16:19], v[96:103], v3
  s_waitcnt vmcnt(6)
  v_smfmac_f32_16x16x64_bf16 v[156:159], v[20:23], v[104:111], v3
  s_waitcnt vmcnt(5)
  v_smfmac_f32_16x16x64_bf16 v[156:159], v[24:27], v[112:119], v3
  s_mov_b32 exec_hi, 0
  buffer_store_dword v2, v7, s[8:11], s21 offen
  s_mov_b64 exec, -1
  s_waitcnt vmcnt(5)
  v_smfmac_f32_16x16x64_bf16 v[156:159], v[28:31], v[120:127], v3
  s_waitcnt vmcnt(4)
  v_smfmac_f32_16x16x64_bf16 v[156:159], v[32:35], v[128:135], v3
  s_waitcnt vmcnt(3)
  v_smfmac_f32_16x16x64_bf16 v[156:159], v[144:147], v[136:143], v3
  s_waitcnt vmcnt(2) lgkmcnt(0)
  v_smfmac_f32_16x16x64_bf16 v[156:159], v[148:151], v[64:71], v3
  s_waitcnt vmcnt(1)
  v_smfmac_f32_16x16x64_bf16 v[156:159], v[152:155], v[72:79], v3
cA_va1_ep:
  s_nop 7
  v_permlane32_swap_b32 v156, v158
  v_permlane32_swap_b32 v157, v159
  v_add_f32 v160, v156, v158
  v_add_f32 v161, v157, v159
  v_cmp_u_f32 vcc, v160, v161
  v_mov_b32_dpp v162, v160 row_ror:8 row_mask:0xf bank_mask:0xf
  v_mov_b32_dpp v160, v161 row_ror:8 row_mask:0xf bank_mask:0xc
  s_cbranch_vccnz cA_va1_rp
  v_mov_b32_dpp v161, v162 quad_perm:[0,1,2,3] row_mask:0xf bank_mask:0x3
  v_cvt_pk_bf16_f32 v160, v160, v161
cA_va1_pc:
  s_mov_b64 exec, s[26:27]
  buffer_store_dword v160, v1, s[8:11], s21 offen
  s_cmp_lg_u32 s19, 62
  s_cbranch_scc1 cA_va1_nl
  s_mov_b32 s22, 88519680
  buffer_store_dword v160, v1, s[8:11], s22 offen sc1
  s_mov_b64 exec, -1
  s_branch cA_done
cA_va1_nl:
  s_mov_b64 exec, -1
  s_add_u32 s25, s25, 28672
  s_add_u32 s19, s19, 1
  s_mov_b32 s20, s21
  s_branch cA_va1_loop
cA_va1_last:
  s_waitcnt lgkmcnt(0)
  s_barrier
  s_branch cA_done
cA_va1_rp:
  s_cmp_eq_u32 s37, 0
  s_cbranch_scc1 cA_va1_rv
  v_mov_b32_dpp v161, v162 quad_perm:[0,1,2,3] row_mask:0xf bank_mask:0x3
  v_cvt_pk_bf16_f32 v160, v160, v161
  v_min_u32 v160, -2, v160
  s_branch cA_va1_pc
cA_va1_rv:
  buffer_load_dwordx4 v[8:11], v2, s[8:11], s22 offen offset:0 sc1
  buffer_load_dwordx4 v[12:15], v2, s[8:11], s22 offen offset:1024 sc1
  buffer_load_dwordx4 v[16:19], v2, s[8:11], s22 offen offset:2048 sc1
  buffer_load_dwordx4 v[20:23], v2, s[8:11], s22 offen offset:3072 sc1
  buffer_load_dwordx4 v[24:27], v2, s[8:11], s34 offen offset:0 sc1
  buffer_load_dwordx4 v[28:31], v2, s[8:11], s34 offen offset:1024 sc1
  buffer_load_dwordx4 v[32:35], v2, s[8:11], s34 offen offset:2048 sc1
  buffer_load_dwordx4 v[144:147], v2, s[8:11], s34 offen offset:3072 sc1
  buffer_load_dwordx4 v[148:151], v2, s[8:11], s36 offen offset:0 sc1
  buffer_load_dwordx4 v[152:155], v2, s[8:11], s36 offen offset:1024 sc1
  s_waitcnt vmcnt(0)
  v_max3_u32 v63, v8, v9, v10
  v_max3_u32 v63, v63, v11, v12
  v_max3_u32 v63, v63, v13, v14
  v_max3_u32 v63, v63, v15, v16
  v_max3_u32 v63, v63, v17, v18
  v_max3_u32 v63, v63, v19, v20
  v_max3_u32 v63, v63, v21, v22
  v_max3_u32 v63, v63, v23, v24
  v_max3_u32 v63, v63, v25, v26
  v_max3_u32 v63, v63, v27, v28
  v_max3_u32 v63, v63, v29, v30
  v_max3_u32 v63, v63, v31, v32
  v_max3_u32 v63, v63, v33, v34
  v_max3_u32 v63, v63, v35, v144
  v_max3_u32 v63, v63, v145, v146
  v_max3_u32 v63, v63, v147, v148
  v_max3_u32 v63, v63, v149, v150
  v_max3_u32 v63, v63, v151, v152
  v_max3_u32 v63, v63, v153, v154
  v_max_u32 v63, v63, v155
  v_cmp_eq_u32 vcc, -1, v63
  s_cbranch_vccz cA_va1_rk
  s_add_u32 s30, s30, 1
  s_cmp_lt_u32 s30, 400000
  s_cbranch_scc1 cA_va1_rv
  s_branch cA_abort
cA_va1_rk:
  s_mov_b32 s37, 1
  s_add_u32 s31, s31, 0x10000
  v_mov_b32 v156, 0
  v_mov_b32 v157, 0
  v_mov_b32 v158, 0
  v_mov_b32 v159, 0
  s_nop 1
  v_smfmac_f32_16x16x64_bf16 v[156:159], v[8:11], v[80:87], v3
  v_smfmac_f32_16x16x64_bf16 v[156:159], v[12:15], v[88:95], v3
  v_smfmac_f32_16x16x64_bf16 v[156:159], v[16:19], v[96:103], v3
  v_smfmac_f32_16x16x64_bf16 v[156:159], v[20:23], v[104:111], v3
  v_smfmac_f32_16x16x64_bf16 v[156:159], v[24:27], v[112:119], v3
  v_smfmac_f32_16x16x64_bf16 v[156:159], v[28:31], v[120:127], v3
  v_smfmac_f32_16x16x64_bf16 v[156:159], v[32:35], v[128:135], v3
  v_smfmac_f32_16x16x64_bf16 v[156:159], v[144:147], v[136:143], v3
  v_smfmac_f32_16x16x64_bf16 v[156:159], v[148:151], v[64:71], v3
  v_smfmac_f32_16x16x64_bf16 v[156:159], v[152:155], v[72:79], v3
  s_nop 7
  s_branch cA_va1_ep
.p2align 6

cA_va2_loop:
  s_add_u32 s23, s20, 4096
  s_add_u32 s21, s20, 25600
  v_mov_b32 v36, 0
  v_mov_b32 v37, 0
  v_mov_b32 v38, 0
  v_mov_b32 v39, 0
  v_mov_b32 v40, 0
  v_mov_b32 v41, 0
  v_mov_b32 v42, 0
  v_mov_b32 v43, 0
  v_mov_b32 v44, 0
  v_mov_b32 v45, 0
  v_mov_b32 v46, 0
  v_mov_b32 v47, 0
  v_mov_b32 v48, 0
  v_mov_b32 v49, 0
  v_mov_b32 v50, 0
  v_mov_b32 v51, 0
  v_mov_b32 v52, 0
  v_mov_b32 v53, 0
  v_mov_b32 v54, 0
  v_mov_b32 v55, 0
  v_mov_b32 v56, 0
  v_mov_b32 v57, 0
  v_mov_b32 v58, 0
  v_mov_b32 v59, 0
  v_mov_b32 v60, 0
  v_mov_b32 v61, 0
  v_mov_b32 v62, 0
  v_mov_b32 v63, 0
  v_mov_b32 v64, 0
  v_mov_b32 v65, 0
  v_mov_b32 v66, 0
  v_mov_b32 v67, 0
  s_mov_b32 s30, 0
  buffer_load_dword v76, v119, s[8:11], s20 offen sc1
  buffer_load_dword v77, v119, s[8:11], s20 offen sc1
  buffer_load_dword v78, v119, s[8:11], s20 offen sc1
cA_va2_fp_l:
  s_waitcnt vmcnt(2)
  v_cmp_eq_u32 vcc, -1, v76
  s_cbranch_vccz cA_va2_fp_d
  buffer_load_dword v76, v119, s[8:11], s20 offen sc1
  s_waitcnt vmcnt(2)
  v_cmp_eq_u32 vcc, -1, v77
  s_cbranch_vccz cA_va2_fp_d
  buffer_load_dword v77, v119, s[8:11], s20 offen sc1
  s_waitcnt vmcnt(2)
  v_cmp_eq_u32 vcc, -1, v78
  s_cbranch_vccz cA_va2_fp_d
  buffer_load_dword v78, v119, s[8:11], s20 offen sc1
  s_add_u32 s30, s30, 1
  s_cmp_lt_u32 s30, 400000
  s_cbranch_scc1 cA_va2_fp_l
  s_branch cA_abort
cA_va2_fp_d:
  buffer_load_dwordx4 v[8:11], v2, s[8:11], s20 offen offset:0 sc1
  buffer_load_dwordx4 v[12:15], v2, s[8:11], s20 offen offset:1024 sc1
  buffer_load_dwordx4 v[16:19], v2, s[8:11], s20 offen offset:2048 sc1
  buffer_load_dwordx4 v[20:23], v2, s[8:11], s20 offen offset:3072 sc1
  s_barrier
cA_va2_ld:
  s_waitcnt vmcnt(0)
  v_max3_u32 v84, v8, v9, v10
  v_max3_u32 v84, v84, v11, v12
  v_max3_u32 v84, v84, v13, v14
  v_max3_u32 v84, v84, v15, v16
  v_max3_u32 v84, v84, v17, v18
  v_max3_u32 v84, v84, v19, v20
  v_max3_u32 v84, v84, v21, v22
  v_max_u32 v84, v84, v23
  v_cmp_eq_u32 vcc, -1, v84
  ds_write_b128 v2, v[8:11] offset:8192
  ds_write_b128 v2, v[12:15] offset:9216
  ds_write_b128 v2, v[16:19] offset:10240
  ds_write_b128 v2, v[20:23] offset:11264
  s_cbranch_vccnz cA_va2_retry
  s_waitcnt lgkmcnt(0)
  s_barrier
  ds_read_b128 v[24:27], v2 offset:12288
  ds_read_b128 v[28:31], v2 offset:13312
  ds_read_b128 v[32:35], v2 offset:14336
  ds_read_b128 v[92:95], v0
  s_waitcnt lgkmcnt(0)
  s_mov_b64 exec, s[26:27]
  buffer_store_dwordx4 v[92:95], v2, s[8:11], s36 offen sc1
  s_mov_b64 exec, -1
  s_add_u32 s36, s36, 7168
  s_cmp_eq_u32 s19, 63
  s_cbranch_scc1 cA_done
  ds_read_b128 v[76:79], v1 offset:0
  ds_read_b128 v[80:83], v1 offset:1024
  ds_read_b128 v[84:87], v1 offset:2048
  ds_read_b128 v[88:91], v1 offset:3072
  ds_read_b128 v[92:95], v1 offset:4096
  ds_read_b128 v[96:99], v1 offset:5120
  v_smfmac_f32_16x16x64_bf16 v[60:63], v[8:11], v[200:207], v3
  v_smfmac_f32_16x16x64_bf16 v[60:63], v[12:15], v[208:215], v3
  s_waitcnt lgkmcnt(4)
  v_smfmac_f32_16x16x64_bf16 v[64:67], v[8:11], v[76:83], v3
  ds_read_b128 v[76:79], v1 offset:6144
  ds_read_b128 v[80:83], v1 offset:7168
  v_smfmac_f32_16x16x64_bf16 v[60:63], v[16:19], v[216:223], v3
  v_smfmac_f32_16x16x64_bf16 v[60:63], v[20:23], v[224:231], v3
  s_waitcnt lgkmcnt(4)
  v_smfmac_f32_16x16x64_bf16 v[64:67], v[12:15], v[84:91], v3
  ds_read_b128 v[84:87], v1 offset:8192
  ds_read_b128 v[88:91], v1 offset:9216
  v_smfmac_f32_16x16x64_bf16 v[60:63], v[24:27], v[232:239], v3
  v_smfmac_f32_16x16x64_bf16 v[60:63], v[28:31], v[240:247], v3
  s_waitcnt lgkmcnt(4)
  v_smfmac_f32_16x16x64_bf16 v[64:67], v[16:19], v[92:99], v3
  ds_read_b128 v[92:95], v1 offset:10240
  ds_read_b128 v[96:99], v1 offset:11264
  v_smfmac_f32_16x16x64_bf16 v[60:63], v[32:35], v[248:255], v3
  v_smfmac_f32_16x16x64_bf16 v[36:39], v[8:11], a[0:7], v3
  s_waitcnt lgkmcnt(4)
  v_smfmac_f32_16x16x64_bf16 v[64:67], v[20:23], v[76:83], v3
  ds_read_b128 v[76:79], v1 offset:12288
  ds_read_b128 v[80:83], v1 offset:13312
  v_smfmac_f32_16x16x64_bf16 v[36:39], v[12:15], a[8:15], v3
  v_smfmac_f32_16x16x64_bf16 v[36:39], v[16:19], a[16:23], v3
  s_waitcnt lgkmcnt(4)
  v_smfmac_f32_16x16x64_bf16 v[64:67], v[24:27], v[84:91], v3
  v_smfmac_f32_16x16x64_bf16 v[36:39], v[20:23], a[24:31], v3
  v_smfmac_f32_16x16x64_bf16 v[36:39], v[24:27], a[32:39], v3
  s_waitcnt lgkmcnt(2)
  v_smfmac_f32_16x16x64_bf16 v[64:67], v[28:31], v[92:99], v3
  v_smfmac_f32_16x16x64_bf16 v[36:39], v[28:31], a[40:47], v3
  v_smfmac_f32_16x16x64_bf16 v[36:39], v[32:35], a[48:55], v3
  s_waitcnt lgkmcnt(0)
  v_smfmac_f32_16x16x64_bf16 v[64:67], v[32:35], v[76:83], v3
  v_smfmac_f32_16x16x64_bf16 v[40:43], v[8:11], a[56:63], v3
  v_smfmac_f32_16x16x64_bf16 v[40:43], v[12:15], a[64:71], v3
  v_smfmac_f32_16x16x64_bf16 v[40:43], v[16:19], a[72:79], v3
  v_smfmac_f32_16x16x64_bf16 v[40:43], v[20:23], a[80:87], v3
  v_permlane32_swap_b32 v60, v64
  v_smfmac_f32_16x16x64_bf16 v[40:43], v[24:27], a[88:95], v3
  v_permlane32_swap_b32 v61, v65
  v_smfmac_f32_16x16x64_bf16 v[40:43], v[28:31], a[96:103], v3
  v_permlane32_swap_b32 v62, v66
  v_smfmac_f32_16x16x64_bf16 v[40:43], v[32:35], a[104:111], v3
  v_permlane32_swap_b32 v63, v67
  v_smfmac_f32_16x16x64_bf16 v[44:47], v[8:11], a[112:119], v3
  v_smfmac_f32_16x16x64_bf16 v[44:47], v[12:15], a[120:127], v3
  v_smfmac_f32_16x16x64_bf16 v[44:47], v[16:19], a[128:135], v3
  v_smfmac_f32_16x16x64_bf16 v[44:47], v[20:23], a[136:143], v3
  v_add_f32 v60, v60, v64
  v_add_f32 v61, v61, v65
  v_smfmac_f32_16x16x64_bf16 v[44:47], v[24:27], a[144:151], v3
  v_add_f32 v62, v62, v66
  v_add_f32 v63, v63, v67
  v_smfmac_f32_16x16x64_bf16 v[44:47], v[28:31], a[152:159], v3
  v_cvt_pk_bf16_f32 v64, v60, v61
  v_cvt_pk_bf16_f32 v65, v62, v63
  v_smfmac_f32_16x16x64_bf16 v[44:47], v[32:35], a[160:167], v3
  ds_write_b64 v115, v[64:65]
  v_smfmac_f32_16x16x64_bf16 v[48:51], v[8:11], a[168:175], v3
  v_permlane32_swap_b32 v36, v40
  v_smfmac_f32_16x16x64_bf16 v[48:51], v[12:15], a[176:183], v3
  v_permlane32_swap_b32 v37, v41
  v_smfmac_f32_16x16x64_bf16 v[48:51], v[16:19], a[184:191], v3
  v_permlane32_swap_b32 v38, v42
  v_smfmac_f32_16x16x64_bf16 v[48:51], v[20:23], a[192:199], v3
  v_permlane32_swap_b32 v39, v43
  v_smfmac_f32_16x16x64_bf16 v[48:51], v[24:27], a[200:207], v3
  v_add_f32 v36, v36, v40
  v_smfmac_f32_16x16x64_bf16 v[48:51], v[28:31], a[208:215], v3
  v_add_f32 v37, v37, v41
  v_smfmac_f32_16x16x64_bf16 v[48:51], v[32:35], a[216:223], v3
  v_add_f32 v38, v38, v42
  v_smfmac_f32_16x16x64_bf16 v[52:55], v[8:11], a[224:231], v3
  v_smfmac_f32_16x16x64_bf16 v[52:55], v[12:15], a[232:239], v3
  v_smfmac_f32_16x16x64_bf16 v[52:55], v[16:19], a[240:247], v3
  v_smfmac_f32_16x16x64_bf16 v[52:55], v[20:23], a[248:255], v3
  v_add_f32 v39, v39, v43
  v_cvt_pk_bf16_f32 v40, v36, v37
  v_smfmac_f32_16x16x64_bf16 v[52:55], v[24:27], v[120:127], v3
  v_cvt_pk_bf16_f32 v41, v38, v39
  v_smfmac_f32_16x16x64_bf16 v[52:55], v[28:31], v[128:135], v3
  ds_write_b64 v112, v[40:41]
  v_smfmac_f32_16x16x64_bf16 v[52:55], v[32:35], v[136:143], v3
  v_permlane32_swap_b32 v44, v48
  v_smfmac_f32_16x16x64_bf16 v[56:59], v[8:11], v[144:151], v3
  v_permlane32_swap_b32 v45, v49
  v_smfmac_f32_16x16x64_bf16 v[56:59], v[12:15], v[152:159], v3
  v_permlane32_swap_b32 v46, v50
  v_smfmac_f32_16x16x64_bf16 v[56:59], v[16:19], v[160:167], v3
  v_permlane32_swap_b32 v47, v51
  v_smfmac_f32_16x16x64_bf16 v[56:59], v[20:23], v[168:175], v3
  v_add_f32 v44, v44, v48
  v_smfmac_f32_16x16x64_bf16 v[56:59], v[24:27], v[176:183], v3
  v_add_f32 v45, v45, v49
  v_smfmac_f32_16x16x64_bf16 v[56:59], v[28:31], v[184:191], v3
  v_add_f32 v46, v46, v50
  v_smfmac_f32_16x16x64_bf16 v[56:59], v[32:35], v[192:199], v3
  v_add_f32 v47, v47, v51
  v_cvt_pk_bf16_f32 v48, v44, v45
  v_cvt_pk_bf16_f32 v49, v46, v47
  ds_write_b64 v113, v[48:49]
  s_nop 3
  v_permlane32_swap_b32 v52, v56
  v_permlane32_swap_b32 v53, v57
  v_permlane32_swap_b32 v54, v58
  v_permlane32_swap_b32 v55, v59
  v_add_f32 v52, v52, v56
  v_add_f32 v53, v53, v57
  v_add_f32 v54, v54, v58
  v_add_f32 v55, v55, v59
  v_cvt_pk_bf16_f32 v56, v52, v53
  v_cvt_pk_bf16_f32 v57, v54, v55
  ds_write_b64 v114, v[56:57]
  s_waitcnt lgkmcnt(0)
  s_barrier
  s_cmp_eq_u32 s19, 62
  s_cbranch_scc1 cA_done
  s_waitcnt vmcnt(0) lgkmcnt(0)
  s_add_u32 s19, s19, 1
  s_mov_b32 s20, s21
  s_branch cA_va2_loop
cA_va2_retry:
  s_waitcnt lgkmcnt(0)
  buffer_load_dwordx4 v[8:11], v2, s[8:11], s20 offen offset:0 sc1
  buffer_load_dwordx4 v[12:15], v2, s[8:11], s20 offen offset:1024 sc1
  buffer_load_dwordx4 v[16:19], v2, s[8:11], s20 offen offset:2048 sc1
  buffer_load_dwordx4 v[20:23], v2, s[8:11], s20 offen offset:3072 sc1
  s_add_u32 s31, s31, 1
  s_add_u32 s30, s30, 1
  s_cmp_lt_u32 s30, 400000
  s_cbranch_scc1 cA_va2_ld
  s_branch cA_abort
cA_va2_last:
  s_waitcnt lgkmcnt(0)
  buffer_store_dwordx4 v[100:103], v2, s[8:11], s24 offen offset:0 sc1
  buffer_store_dwordx4 v[104:107], v2, s[8:11], s24 offen offset:1024 sc1
  buffer_store_dwordx4 v[108:111], v2, s[8:11], s24 offen offset:2048 sc1
  buffer_store_dwordx4 v[4:7], v2, s[8:11], s24 offen offset:3072 sc1
  s_add_u32 s24, s24, 8192
  s_waitcnt vmcnt(0)
  s_mov_b64 exec, 1
  buffer_store_dword v117, v2, s[8:11], s34 offen sc1
  s_mov_b64 exec, -1
  s_add_u32 s34, s34, 8
  s_mov_b64 exec, 1
  buffer_store_dword v117, v2, s[8:11], s34 offen sc1
  s_mov_b64 exec, -1
  s_add_u32 s34, s34, 8
  s_branch cA_done
.p2align 6

cA_va3_loop:
  s_add_u32 s23, s20, 4096
  s_add_u32 s21, s20, 25600
  v_mov_b32 v36, 0
  v_mov_b32 v37, 0
  v_mov_b32 v38, 0
  v_mov_b32 v39, 0
  v_mov_b32 v40, 0
  v_mov_b32 v41, 0
  v_mov_b32 v42, 0
  v_mov_b32 v43, 0
  v_mov_b32 v44, 0
  v_mov_b32 v45, 0
  v_mov_b32 v46, 0
  v_mov_b32 v47, 0
  v_mov_b32 v48, 0
  v_mov_b32 v49, 0
  v_mov_b32 v50, 0
  v_mov_b32 v51, 0
  v_mov_b32 v52, 0
  v_mov_b32 v53, 0
  v_mov_b32 v54, 0
  v_mov_b32 v55, 0
  v_mov_b32 v56, 0
  v_mov_b32 v57, 0
  v_mov_b32 v58, 0
  v_mov_b32 v59, 0
  v_mov_b32 v60, 0
  v_mov_b32 v61, 0
  v_mov_b32 v62, 0
  v_mov_b32 v63, 0
  v_mov_b32 v64, 0
  v_mov_b32 v65, 0
  v_mov_b32 v66, 0
  v_mov_b32 v67, 0
  s_mov_b32 s30, 0
  buffer_load_dword v76, v119, s[8:11], s20 offen sc1
  buffer_load_dword v77, v119, s[8:11], s20 offen sc1
  buffer_load_dword v78, v119, s[8:11], s20 offen sc1
cA_va3_fp_l:
  s_waitcnt vmcnt(2)
  v_cmp_eq_u32 vcc, -1, v76
  s_cbranch_vccz cA_va3_fp_d
  buffer_load_dword v76, v119, s[8:11], s20 offen sc1
  s_waitcnt vmcnt(2)
  v_cmp_eq_u32 vcc, -1, v77
  s_cbranch_vccz cA_va3_fp_d
  buffer_load_dword v77, v119, s[8:11], s20 offen sc1
  s_waitcnt vmcnt(2)
  v_cmp_eq_u32 vcc, -1, v78
  s_cbranch_vccz cA_va3_fp_d
  buffer_load_dword v78, v119, s[8:11], s20 offen sc1
  s_add_u32 s30, s30, 1
  s_cmp_lt_u32 s30, 400000
  s_cbranch_scc1 cA_va3_fp_l
  s_branch cA_abort
cA_va3_fp_d:
  buffer_load_dwordx4 v[24:27], v2, s[8:11], s23 offen offset:0 sc1
  buffer_load_dwordx4 v[28:31], v2, s[8:11], s23 offen offset:1024 sc1
  buffer_load_dwordx4 v[32:35], v2, s[8:11], s23 offen offset:2048 sc1
  s_barrier
cA_va3_ld:
  s_waitcnt vmcnt(0)
  v_max3_u32 v84, v24, v25, v26
  v_max3_u32 v84, v84, v27, v28
  v_max3_u32 v84, v84, v29, v30
  v_max3_u32 v84, v84, v31, v32
  v_max3_u32 v84, v84, v33, v34
  v_max_u32 v84, v84, v35
  v_cmp_eq_u32 vcc, -1, v84
  ds_write_b128 v2, v[24:27] offset:12288
  ds_write_b128 v2, v[28:31] offset:13312
  ds_write_b128 v2, v[32:35] offset:14336
  s_cbranch_vccnz cA_va3_retry
  s_waitcnt lgkmcnt(0)
  s_barrier
  ds_read_b128 v[8:11], v2 offset:8192
  ds_read_b128 v[12:15], v2 offset:9216
  ds_read_b128 v[16:19], v2 offset:10240
  ds_read_b128 v[20:23], v2 offset:11264
  s_waitcnt lgkmcnt(0)
  s_cmp_eq_u32 s19, 63
  s_cbranch_scc1 cA_done
  ds_read_b128 v[76:79], v1 offset:0
  ds_read_b128 v[80:83], v1 offset:1024
  ds_read_b128 v[84:87], v1 offset:2048
  ds_read_b128 v[88:91], v1 offset:3072
  ds_read_b128 v[92:95], v1 offset:4096
  ds_read_b128 v[96:99], v1 offset:5120
  v_smfmac_f32_16x16x64_bf16 v[60:63], v[8:11], v[200:207], v3
  v_smfmac_f32_16x16x64_bf16 v[60:63], v[12:15], v[208:215], v3
  s_waitcnt lgkmcnt(4)
  v_smfmac_f32_16x16x64_bf16 v[64:67], v[8:11], v[76:83], v3
  ds_read_b128 v[76:79], v1 offset:6144
  ds_read_b128 v[80:83], v1 offset:7168
  v_smfmac_f32_16x16x64_bf16 v[60:63], v[16:19], v[216:223], v3
  v_smfmac_f32_16x16x64_bf16 v[60:63], v[20:23], v[224:231], v3
  s_waitcnt lgkmcnt(4)
  v_smfmac_f32_16x16x64_bf16 v[64:67], v[12:15], v[84:91], v3
  ds_read_b128 v[84:87], v1 offset:8192
  ds_read_b128 v[88:91], v1 offset:9216
  v_smfmac_f32_16x16x64_bf16 v[60:63], v[24:27], v[232:239], v3
  v_smfmac_f32_16x16x64_bf16 v[60:63], v[28:31], v[240:247], v3
  s_waitcnt lgkmcnt(4)
  v_smfmac_f32_16x16x64_bf16 v[64:67], v[16:19], v[92:99], v3
  ds_read_b128 v[92:95], v1 offset:10240
  ds_read_b128 v[96:99], v1 offset:11264
  v_smfmac_f32_16x16x64_bf16 v[60:63], v[32:35], v[248:255], v3
  v_smfmac_f32_16x16x64_bf16 v[36:39], v[8:11], a[0:7], v3
  s_waitcnt lgkmcnt(4)
  v_smfmac_f32_16x16x64_bf16 v[64:67], v[20:23], v[76:83], v3
  ds_read_b128 v[76:79], v1 offset:12288
  ds_read_b128 v[80:83], v1 offset:13312
  v_smfmac_f32_16x16x64_bf16 v[36:39], v[12:15], a[8:15], v3
  v_smfmac_f32_16x16x64_bf16 v[36:39], v[16:19], a[16:23], v3
  s_waitcnt lgkmcnt(4)
  v_smfmac_f32_16x16x64_bf16 v[64:67], v[24:27], v[84:91], v3
  v_smfmac_f32_16x16x64_bf16 v[36:39], v[20:23], a[24:31], v3
  v_smfmac_f32_16x16x64_bf16 v[36:39], v[24:27], a[32:39], v3
  s_waitcnt lgkmcnt(2)
  v_smfmac_f32_16x16x64_bf16 v[64:67], v[28:31], v[92:99], v3
  v_smfmac_f32_16x16x64_bf16 v[36:39], v[28:31], a[40:47], v3
  v_smfmac_f32_16x16x64_bf16 v[36:39], v[32:35], a[48:55], v3
  s_waitcnt lgkmcnt(0)
  v_smfmac_f32_16x16x64_bf16 v[64:67], v[32:35], v[76:83], v3
  v_smfmac_f32_16x16x64_bf16 v[40:43], v[8:11], a[56:63], v3
  v_smfmac_f32_16x16x64_bf16 v[40:43], v[12:15], a[64:71], v3
  v_smfmac_f32_16x16x64_bf16 v[40:43], v[16:19], a[72:79], v3
  v_smfmac_f32_16x16x64_bf16 v[40:43], v[20:23], a[80:87], v3
  v_permlane32_swap_b32 v60, v64
  v_smfmac_f32_16x16x64_bf16 v[40:43], v[24:27], a[88:95], v3
  v_permlane32_swap_b32 v61, v65
  v_smfmac_f32_16x16x64_bf16 v[40:43], v[28:31], a[96:103], v3
  v_permlane32_swap_b32 v62, v66
  v_smfmac_f32_16x16x64_bf16 v[40:43], v[32:35], a[104:111], v3
  v_permlane32_swap_b32 v63, v67
  v_smfmac_f32_16x16x64_bf16 v[44:47], v[8:11], a[112:119], v3
  v_smfmac_f32_16x16x64_bf16 v[44:47], v[12:15], a[120:127], v3
  v_smfmac_f32_16x16x64_bf16 v[44:47], v[16:19], a[128:135], v3
  v_smfmac_f32_16x16x64_bf16 v[44:47], v[20:23], a[136:143], v3
  v_add_f32 v60, v60, v64
  v_add_f32 v61, v61, v65
  v_smfmac_f32_16x16x64_bf16 v[44:47], v[24:27], a[144:151], v3
  v_add_f32 v62, v62, v66
  v_add_f32 v63, v63, v67
  v_smfmac_f32_16x16x64_bf16 v[44:47], v[28:31], a[152:159], v3
  v_cvt_pk_bf16_f32 v64, v60, v61
  v_cvt_pk_bf16_f32 v65, v62, v63
  v_smfmac_f32_16x16x64_bf16 v[44:47], v[32:35], a[160:167], v3
  ds_write_b64 v115, v[64:65]
  v_smfmac_f32_16x16x64_bf16 v[48:51], v[8:11], a[168:175], v3
  v_permlane32_swap_b32 v36, v40
  v_smfmac_f32_16x16x64_bf16 v[48:51], v[12:15], a[176:183], v3
  v_permlane32_swap_b32 v37, v41
  v_smfmac_f32_16x16x64_bf16 v[48:51], v[16:19], a[184:191], v3
  v_permlane32_swap_b32 v38, v42
  v_smfmac_f32_16x16x64_bf16 v[48:51], v[20:23], a[192:199], v3
  v_permlane32_swap_b32 v39, v43
  v_smfmac_f32_16x16x64_bf16 v[48:51], v[24:27], a[200:207], v3
  v_add_f32 v36, v36, v40
  v_smfmac_f32_16x16x64_bf16 v[48:51], v[28:31], a[208:215], v3
  v_add_f32 v37, v37, v41
  v_smfmac_f32_16x16x64_bf16 v[48:51], v[32:35], a[216:223], v3
  v_add_f32 v38, v38, v42
  v_smfmac_f32_16x16x64_bf16 v[52:55], v[8:11], a[224:231], v3
  v_smfmac_f32_16x16x64_bf16 v[52:55], v[12:15], a[232:239], v3
  v_smfmac_f32_16x16x64_bf16 v[52:55], v[16:19], a[240:247], v3
  v_smfmac_f32_16x16x64_bf16 v[52:55], v[20:23], a[248:255], v3
  v_add_f32 v39, v39, v43
  v_cvt_pk_bf16_f32 v40, v36, v37
  v_smfmac_f32_16x16x64_bf16 v[52:55], v[24:27], v[120:127], v3
  v_cvt_pk_bf16_f32 v41, v38, v39
  v_smfmac_f32_16x16x64_bf16 v[52:55], v[28:31], v[128:135], v3
  ds_write_b64 v112, v[40:41]
  v_smfmac_f32_16x16x64_bf16 v[52:55], v[32:35], v[136:143], v3
  v_permlane32_swap_b32 v44, v48
  v_smfmac_f32_16x16x64_bf16 v[56:59], v[8:11], v[144:151], v3
  v_permlane32_swap_b32 v45, v49
  v_smfmac_f32_16x16x64_bf16 v[56:59], v[12:15], v[152:159], v3
  v_permlane32_swap_b32 v46, v50
  v_smfmac_f32_16x16x64_bf16 v[56:59], v[16:19], v[160:167], v3
  v_permlane32_swap_b32 v47, v51
  v_smfmac_f32_16x16x64_bf16 v[56:59], v[20:23], v[168:175], v3
  v_add_f32 v44, v44, v48
  v_smfmac_f32_16x16x64_bf16 v[56:59], v[24:27], v[176:183], v3
  v_add_f32 v45, v45, v49
  v_smfmac_f32_16x16x64_bf16 v[56:59], v[28:31], v[184:191], v3
  v_add_f32 v46, v46, v50
  v_smfmac_f32_16x16x64_bf16 v[56:59], v[32:35], v[192:199], v3
  v_add_f32 v47, v47, v51
  v_cvt_pk_bf16_f32 v48, v44, v45
  v_cvt_pk_bf16_f32 v49, v46, v47
  ds_write_b64 v113, v[48:49]
  s_nop 3
  v_permlane32_swap_b32 v52, v56
  v_permlane32_swap_b32 v53, v57
  v_permlane32_swap_b32 v54, v58
  v_permlane32_swap_b32 v55, v59
  v_add_f32 v52, v52, v56
  v_add_f32 v53, v53, v57
  v_add_f32 v54, v54, v58
  v_add_f32 v55, v55, v59
  v_cvt_pk_bf16_f32 v56, v52, v53
  v_cvt_pk_bf16_f32 v57, v54, v55
  ds_write_b64 v114, v[56:57]
  s_waitcnt lgkmcnt(0)
  s_barrier
  s_cmp_eq_u32 s19, 62
  s_cbranch_scc1 cA_done
  s_waitcnt vmcnt(0) lgkmcnt(0)
  s_add_u32 s19, s19, 1
  s_mov_b32 s20, s21
  s_branch cA_va3_loop
cA_va3_retry:
  s_waitcnt lgkmcnt(0)
  buffer_load_dwordx4 v[24:27], v2, s[8:11], s23 offen offset:0 sc1
  buffer_load_dwordx4 v[28:31], v2, s[8:11], s23 offen offset:1024 sc1
  buffer_load_dwordx4 v[32:35], v2, s[8:11], s23 offen offset:2048 sc1
  s_add_u32 s31, s31, 1
  s_add_u32 s30, s30, 1
  s_cmp_lt_u32 s30, 400000
  s_cbranch_scc1 cA_va3_ld
  s_branch cA_abort
cA_va3_last:
  s_waitcnt lgkmcnt(0)
  buffer_store_dwordx4 v[100:103], v2, s[8:11], s24 offen offset:0 sc1
  buffer_store_dwordx4 v[104:107], v2, s[8:11], s24 offen offset:1024 sc1
  buffer_store_dwordx4 v[108:111], v2, s[8:11], s24 offen offset:2048 sc1
  buffer_store_dwordx4 v[4:7], v2, s[8:11], s24 offen offset:3072 sc1
  s_add_u32 s24, s24, 8192
  s_waitcnt vmcnt(0)
  s_mov_b64 exec, 1
  buffer_store_dword v117, v2, s[8:11], s34 offen sc1
  s_mov_b64 exec, -1
  s_add_u32 s34, s34, 8
  s_mov_b64 exec, 1
  buffer_store_dword v117, v2, s[8:11], s34 offen sc1
  s_mov_b64 exec, -1
  s_add_u32 s34, s34, 8
  s_branch cA_done
cA_abort:
  v_mov_b32 v4, 0xdead
  v_mov_b32 v5, 16
  buffer_store_dword v4, v5, s[12:15], 0 offen
  s_branch ch_end
cA_done:
  s_branch ch_end
.p2align 6

cB_sc0_loop:
  s_add_u32 s23, s20, 4096
  s_add_u32 s21, s20, 25600
  v_mov_b32 v48, 0
  v_mov_b32 v49, 0
  v_mov_b32 v50, 0
  v_mov_b32 v51, 0
  v_mov_b32 v52, 0
  v_mov_b32 v53, 0
  v_mov_b32 v54, 0
  v_mov_b32 v55, 0
  v_mov_b32 v56, 0
  v_mov_b32 v57, 0
  v_mov_b32 v58, 0
  v_mov_b32 v59, 0
  v_mov_b32 v60, 0
  v_mov_b32 v61, 0
  v_mov_b32 v62, 0
  v_mov_b32 v63, 0
  v_mov_b32 v88, 0
  v_mov_b32 v89, 0
  v_mov_b32 v90, 0
  v_mov_b32 v91, 0
  v_mov_b32 v92, 0
  v_mov_b32 v93, 0
  v_mov_b32 v94, 0
  v_mov_b32 v95, 0
  v_mov_b32 v66, 0
  v_mov_b32 v67, 0
  s_mov_b32 s30, 0
  s_mov_b32 s62, 0
  buffer_load_dword v68, v0, s[8:11], s20 offen sc1
  s_nop 7
  buffer_load_dword v69, v0, s[8:11], s20 offen sc1
  s_nop 7
  buffer_load_dword v70, v0, s[8:11], s20 offen sc1
  s_nop 7
  buffer_load_dword v71, v0, s[8:11], s20 offen sc1
  s_nop 7
  buffer_load_dword v72, v0, s[8:11], s20 offen sc1
cB_sc0_fp_l:
  s_waitcnt vmcnt(4)
  v_cmp_eq_u32 vcc, -1, v68
  s_cbranch_vccz cB_sc0_fp_d
  buffer_load_dword v68, v0, s[8:11], s20 offen sc1
  s_waitcnt vmcnt(4)
  v_cmp_eq_u32 vcc, -1, v69
  s_cbranch_vccz cB_sc0_fp_d
  buffer_load_dword v69, v0, s[8:11], s20 offen sc1
  s_waitcnt vmcnt(4)
  v_cmp_eq_u32 vcc, -1, v70
  s_cbranch_vccz cB_sc0_fp_d
  buffer_load_dword v70, v0, s[8:11], s20 offen sc1
  s_waitcnt vmcnt(4)
  v_cmp_eq_u32 vcc, -1, v71
  s_cbranch_vccz cB_sc0_fp_d
  buffer_load_dword v71, v0, s[8:11], s20 offen sc1
  s_waitcnt vmcnt(4)
  v_cmp_eq_u32 vcc, -1, v72
  s_cbranch_vccz cB_sc0_fp_d
  buffer_load_dword v72, v0, s[8:11], s20 offen sc1
  s_add_u32 s30, s30, 1
  s_cmp_lt_u32 s30, 400000
  s_cbranch_scc1 cB_sc0_fp_l
  s_branch cB_abort
cB_sc0_fp_d:
  buffer_load_dwordx4 v[8:11], v2, s[8:11], s20 offen offset:0 sc1
  s_barrier
  s_branch cB_sc0_ld1
cB_sc0_ld:
  buffer_load_dwordx4 v[8:11], v2, s[8:11], s20 offen offset:0 sc1
cB_sc0_ld1:
  v_mov_b32 v36, 0
  v_mov_b32 v37, 0
  v_mov_b32 v38, 0
  v_mov_b32 v39, 0
  buffer_load_dwordx4 v[12:15], v2, s[8:11], s20 offen offset:1024 sc1
  v_mov_b32 v40, 0
  v_mov_b32 v41, 0
  v_mov_b32 v42, 0
  v_mov_b32 v43, 0
  buffer_load_dwordx4 v[16:19], v2, s[8:11], s20 offen offset:2048 sc1
  v_mov_b32 v44, 0
  v_mov_b32 v45, 0
  v_mov_b32 v46, 0
  v_mov_b32 v47, 0
  ds_read_b128 v[96:99], v117 offset:0
  ds_read_b128 v[100:103], v117 offset:1024
  ds_read_b128 v[104:107], v117 offset:14336
  ds_read_b128 v[108:111], v117 offset:15360
  s_waitcnt vmcnt(2)
  v_smfmac_f32_16x16x64_bf16 v[36:39], v[8:11], a[0:7], v3
  v_smfmac_f32_16x16x64_bf16 v[40:43], v[8:11], a[56:63], v3
  buffer_load_dwordx4 v[20:23], v2, s[8:11], s20 offen offset:3072 sc1
  v_smfmac_f32_16x16x64_bf16 v[44:47], v[8:11], a[112:119], v3
  v_smfmac_f32_16x16x64_bf16 v[48:51], v[8:11], a[168:175], v3
  v_smfmac_f32_16x16x64_bf16 v[52:55], v[8:11], a[224:231], v3
  buffer_load_dwordx4 v[24:27], v2, s[8:11], s23 offen offset:0 sc1
  v_smfmac_f32_16x16x64_bf16 v[56:59], v[8:11], v[144:151], v3
  v_smfmac_f32_16x16x64_bf16 v[60:63], v[8:11], v[200:207], v3
  s_waitcnt vmcnt(3)
  v_smfmac_f32_16x16x64_bf16 v[36:39], v[12:15], a[8:15], v3
  v_smfmac_f32_16x16x64_bf16 v[40:43], v[12:15], a[64:71], v3
  buffer_load_dwordx4 v[28:31], v2, s[8:11], s23 offen offset:1024 sc1
  v_smfmac_f32_16x16x64_bf16 v[44:47], v[12:15], a[120:127], v3
  v_smfmac_f32_16x16x64_bf16 v[48:51], v[12:15], a[176:183], v3
  v_smfmac_f32_16x16x64_bf16 v[52:55], v[12:15], a[232:239], v3
  buffer_load_dwordx4 v[32:35], v2, s[8:11], s23 offen offset:2048 sc1
  v_smfmac_f32_16x16x64_bf16 v[56:59], v[12:15], v[152:159], v3
  v_smfmac_f32_16x16x64_bf16 v[60:63], v[12:15], v[208:215], v3
  s_waitcnt vmcnt(4)
  v_smfmac_f32_16x16x64_bf16 v[36:39], v[16:19], a[16:23], v3
  v_smfmac_f32_16x16x64_bf16 v[40:43], v[16:19], a[72:79], v3
  v_smfmac_f32_16x16x64_bf16 v[44:47], v[16:19], a[128:135], v3
  v_smfmac_f32_16x16x64_bf16 v[48:51], v[16:19], a[184:191], v3
  v_smfmac_f32_16x16x64_bf16 v[52:55], v[16:19], a[240:247], v3
  v_smfmac_f32_16x16x64_bf16 v[56:59], v[16:19], v[160:167], v3
  v_smfmac_f32_16x16x64_bf16 v[60:63], v[16:19], v[216:223], v3
  s_waitcnt vmcnt(3)
  v_smfmac_f32_16x16x64_bf16 v[36:39], v[20:23], a[24:31], v3
  v_smfmac_f32_16x16x64_bf16 v[40:43], v[20:23], a[80:87], v3
  v_smfmac_f32_16x16x64_bf16 v[44:47], v[20:23], a[136:143], v3
  v_smfmac_f32_16x16x64_bf16 v[48:51], v[20:23], a[192:199], v3
  v_smfmac_f32_16x16x64_bf16 v[52:55], v[20:23], a[248:255], v3
  v_smfmac_f32_16x16x64_bf16 v[56:59], v[20:23], v[168:175], v3
  v_smfmac_f32_16x16x64_bf16 v[60:63], v[20:23], v[224:231], v3
  s_waitcnt vmcnt(0)
cB_sc0_ph2:
  v_smfmac_f32_16x16x64_bf16 v[60:63], v[24:27], v[232:239], v3
  ds_read_b128 v[12:15], v116 offset:0
  ds_read_b128 v[16:19], v116 offset:1024
  v_smfmac_f32_16x16x64_bf16 v[60:63], v[28:31], v[240:247], v3
  v_smfmac_f32_16x16x64_bf16 v[60:63], v[32:35], v[248:255], v3
  v_mov_b32 v80, v24
  v_smfmac_f32_16x16x64_bf16 v[52:55], v[24:27], v[120:127], v3
  v_mov_b32 v81, v25
  v_smfmac_f32_16x16x64_bf16 v[52:55], v[28:31], v[128:135], v3
  v_mov_b32 v82, v32
  v_smfmac_f32_16x16x64_bf16 v[52:55], v[32:35], v[136:143], v3
  v_cvt_pk_bf16_f32 v64, v60, v61
  v_smfmac_f32_16x16x64_bf16 v[56:59], v[24:27], v[176:183], v3
  v_cvt_pk_bf16_f32 v65, v62, v63
  v_smfmac_f32_16x16x64_bf16 v[56:59], v[28:31], v[184:191], v3
  v_mov_b32 v83, v33
  v_mfma_f32_16x16x32_bf16 v[68:71], v[64:67], v[4:7], 0
  v_smfmac_f32_16x16x64_bf16 v[56:59], v[32:35], v[192:199], v3
  v_cvt_pk_bf16_f32 v64, v52, v53
  v_smfmac_f32_16x16x64_bf16 v[36:39], v[24:27], a[32:39], v3
  v_cvt_pk_bf16_f32 v65, v54, v55
  v_smfmac_f32_16x16x64_bf16 v[36:39], v[28:31], a[40:47], v3
  v_cvt_pk_bf16_f32 v78, v68, v69
  v_smfmac_f32_16x16x64_bf16 v[36:39], v[32:35], a[48:55], v3
  v_cvt_pk_bf16_f32 v79, v70, v71
  v_cvt_pk_bf16_f32 v66, v56, v57
  v_smfmac_f32_16x16x64_bf16 v[40:43], v[24:27], a[88:95], v3
  v_cvt_pk_bf16_f32 v67, v58, v59
  v_smfmac_f32_16x16x64_bf16 v[40:43], v[28:31], a[96:103], v3
  v_mfma_f32_16x16x32_bf16 v[72:75], v[64:67], v[4:7], 0
  ds_read_b128 v[52:55], v116 offset:14336
  ds_read_b128 v[56:59], v116 offset:15360
  v_smfmac_f32_16x16x64_bf16 v[40:43], v[32:35], a[104:111], v3
  v_cvt_pk_bf16_f32 v64, v36, v37
  v_smfmac_f32_16x16x64_bf16 v[44:47], v[24:27], a[144:151], v3
  v_cvt_pk_bf16_f32 v65, v38, v39
  v_smfmac_f32_16x16x64_bf16 v[44:47], v[28:31], a[152:159], v3
  v_cvt_pk_bf16_f32 v76, v72, v73
  v_smfmac_f32_16x16x64_bf16 v[44:47], v[32:35], a[160:167], v3
  v_cvt_pk_bf16_f32 v77, v74, v75
  v_cvt_pk_bf16_f32 v66, v40, v41
  v_smfmac_f32_16x16x64_bf16 v[48:51], v[24:27], a[200:207], v3
  v_cvt_pk_bf16_f32 v67, v42, v43
  v_smfmac_f32_16x16x64_bf16 v[48:51], v[28:31], a[208:215], v3
  v_mfma_f32_16x16x32_bf16 v[68:71], v[64:67], v[4:7], 0
  v_smfmac_f32_16x16x64_bf16 v[48:51], v[32:35], a[216:223], v3
  v_cvt_pk_bf16_f32 v64, v44, v45
  v_mfma_f32_16x16x32_bf16 v[84:87], v[80:83], v[76:79], 0
  v_cvt_pk_bf16_f32 v65, v46, v47
  s_waitcnt lgkmcnt(0)
  v_smfmac_f32_16x16x64_bf16 v[88:91], v[76:79], v[96:103], v3
  v_cvt_pk_bf16_f32 v60, v68, v69
  v_cvt_pk_bf16_f32 v61, v70, v71
  v_cvt_pk_bf16_f32 v66, v48, v49
  v_cvt_pk_bf16_f32 v67, v50, v51
  s_nop 1
  v_mfma_f32_16x16x32_bf16 v[72:75], v[64:67], v[4:7], 0
  v_smfmac_f32_16x16x64_bf16 v[92:95], v[76:79], v[104:111], v3
  s_nop 4
  v_cvt_pk_bf16_f32 v62, v72, v73
  v_cvt_pk_bf16_f32 v63, v74, v75
  s_nop 1
  v_mfma_f32_16x16x32_bf16 v[84:87], v[8:11], v[60:63], v[84:87]
  v_smfmac_f32_16x16x64_bf16 v[88:91], v[60:63], v[12:19], v3
  v_smfmac_f32_16x16x64_bf16 v[92:95], v[60:63], v[52:59], v3
  s_mov_b64 exec, s[26:27]
  s_nop 0
  ds_write_b128 v113, v[84:87]
  s_mov_b64 exec, -1
  s_nop 0
  v_cmp_u_f32 vcc, v88, v89
  s_nop 1
  v_permlane32_swap_b32 v88, v92
  v_permlane32_swap_b32 v89, v93
  v_permlane32_swap_b32 v90, v94
  v_permlane32_swap_b32 v91, v95
  v_add_f32 v88, v88, v92
  v_add_f32 v89, v89, v93
  v_add_f32 v90, v90, v94
  v_add_f32 v91, v91, v95
  ds_write_b128 v112, v[88:91]
  s_cbranch_vccnz cB_sc0_retry
cB_sc0_cont:
  s_waitcnt lgkmcnt(0)
  s_barrier
  ds_read_b64 v[36:37], v114 offset:0
  ds_read_b64 v[38:39], v114 offset:1024
  ds_read2_b32 v[44:45], v115 offset0:0 offset1:64
  s_waitcnt lgkmcnt(0)
  v_add_f32 v44, v44, v45
  v_add_f32 v36, v36, v38
  v_add_f32 v37, v37, v39
  v_add_f32_dpp v44, v44, v44 row_ror:8 row_mask:0xf bank_mask:0xf
  v_mov_b32 v45, v44
  v_permlane32_swap_b32 v36, v37
  v_add_f32 v36, v36, v37
  v_permlane16_swap_b32 v44, v45
  v_add_f32 v44, v44, v45
  v_exp_f32 v48, v36
  v_exp_f32 v49, v44
  v_add_f32 v50, abs(v36), abs(v44)
  v_fma_f32 v39, v49, s37, v48
  v_cmp_ngt_f32 vcc, s56, v50
  v_cndmask_b32 v41, v48, v49, s[38:39]
  v_add_f32_dpp v39, v39, v39 quad_perm:[1,0,3,2] row_mask:0xf bank_mask:0xf
  v_cndmask_b32 v40, v49, v48, s[38:39]
  v_mov_b32_dpp v46, v41 quad_perm:[1,0,3,2] row_mask:0xf bank_mask:0xf
  v_add_f32_dpp v39, v39, v39 quad_perm:[2,3,0,1] row_mask:0xf bank_mask:0xf
  v_cndmask_b32 v42, v46, v40, s[38:39]
  v_cndmask_b32 v43, v40, v46, s[38:39]
  v_add_f32_dpp v39, v39, v39 row_half_mirror row_mask:0xf bank_mask:0xf
  s_cbranch_vccnz cB_sc0_slow
  s_nop 0
  v_add_f32_dpp v39, v39, v39 row_mirror row_mask:0xf bank_mask:0xf
  v_mov_b32 v47, v39
  s_nop 1
  v_permlane16_swap_b32 v39, v47
  v_add_f32 v39, v39, v47
  v_rcp_f32 v39, v39
  s_mov_b64 exec, s[28:29]
  v_mul_f32 v42, v42, v39
  v_mul_f32 v43, v43, v39
  v_cvt_pk_bf16_f32 v42, v42, v43
cB_sc0_pst:
  buffer_store_dword v42, v1, s[8:11], s20 offen sc1
  s_mov_b64 exec, -1
  s_barrier
  s_add_u32 s24, s24, 28672
  s_add_u32 s35, s35, 28672
  s_xor_b32 s25, s25, 28672
  s_add_u32 m0, s25, 0
  s_nop 0
  buffer_load_dwordx4 v2, s[8:11], s24 offen offset:0 sc1 lds
  buffer_load_dwordx4 v2, s[8:11], s24 offen offset:1024 sc1 lds
  buffer_load_dwordx4 v2, s[8:11], s24 offen offset:2048 sc1 lds
  buffer_load_dwordx4 v2, s[8:11], s24 offen offset:3072 sc1 lds
  s_add_u32 m0, s25, 4096
  s_add_u32 s22, s24, 4096
  buffer_load_dwordx4 v2, s[8:11], s22 offen offset:0 sc1 lds
  buffer_load_dwordx4 v2, s[8:11], s22 offen offset:1024 sc1 lds
  buffer_load_dwordx4 v2, s[8:11], s22 offen offset:2048 sc1 lds
  v_xor_b32 v116, 28672, v116
  v_add_u32 v117, s57, v117
  s_sub_u32 s57, 0, s57
  s_add_u32 s19, s19, 1
  s_mov_b32 s20, s21
  s_cmp_lt_u32 s19, 63
  s_cbranch_scc1 cB_sc0_loop
  s_branch cB_done
cB_sc0_slow:
  v_max_f32 v50, v36, v44
  s_nop 1
  v_max_f32_dpp v50, v50, v50 quad_perm:[1,0,3,2] row_mask:0xf bank_mask:0xf
  s_nop 1
  v_max_f32_dpp v50, v50, v50 quad_perm:[2,3,0,1] row_mask:0xf bank_mask:0xf
  s_nop 1
  v_max_f32_dpp v50, v50, v50 row_half_mirror row_mask:0xf bank_mask:0xf
  s_nop 1
  v_max_f32_dpp v50, v50, v50 row_mirror row_mask:0xf bank_mask:0xf
  v_mov_b32 v47, v50
  s_nop 1
  v_permlane16_swap_b32 v50, v47
  v_max_f32 v50, v50, v47
  v_sub_f32 v48, v36, v50
  v_sub_f32 v49, v44, v50
  v_exp_f32 v48, v48
  v_exp_f32 v49, v49
  s_add_u32 s31, s31, 0x100
  v_fma_f32 v39, v49, s37, v48
  v_cndmask_b32 v41, v48, v49, s[38:39]
  s_nop 0
  v_add_f32_dpp v39, v39, v39 quad_perm:[1,0,3,2] row_mask:0xf bank_mask:0xf
  v_cndmask_b32 v40, v49, v48, s[38:39]
  v_mov_b32_dpp v46, v41 quad_perm:[1,0,3,2] row_mask:0xf bank_mask:0xf
  v_add_f32_dpp v39, v39, v39 quad_perm:[2,3,0,1] row_mask:0xf bank_mask:0xf
  v_cndmask_b32 v42, v46, v40, s[38:39]
  v_cndmask_b32 v43, v40, v46, s[38:39]
  v_add_f32_dpp v39, v39, v39 row_half_mirror row_mask:0xf bank_mask:0xf
  s_nop 1
  v_add_f32_dpp v39, v39, v39 row_mirror row_mask:0xf bank_mask:0xf
  v_mov_b32 v47, v39
  s_nop 1
  v_permlane16_swap_b32 v39, v47
  v_add_f32 v39, v39, v47
  v_rcp_f32 v39, v39
  s_mov_b64 exec, s[28:29]
  v_mul_f32 v42, v42, v39
  v_mul_f32 v43, v43, v39
  v_cvt_pk_bf16_f32 v42, v42, v43
  v_min_u32 v42, -2, v42
  s_branch cB_sc0_pst
cB_sc0_retry:
  s_cmp_lg_u32 s62, 0
  s_cbranch_scc1 cB_sc0_cont
  s_waitcnt vmcnt(0) lgkmcnt(0)
cB_sc0_rv:
  buffer_load_dwordx4 v[8:11], v2, s[8:11], s20 offen offset:0 sc1
  buffer_load_dwordx4 v[12:15], v2, s[8:11], s20 offen offset:1024 sc1
  buffer_load_dwordx4 v[16:19], v2, s[8:11], s20 offen offset:2048 sc1
  buffer_load_dwordx4 v[20:23], v2, s[8:11], s20 offen offset:3072 sc1
  buffer_load_dwordx4 v[24:27], v2, s[8:11], s23 offen offset:0 sc1
  buffer_load_dwordx4 v[28:31], v2, s[8:11], s23 offen offset:1024 sc1
  buffer_load_dwordx4 v[32:35], v2, s[8:11], s23 offen offset:2048 sc1
  s_waitcnt vmcnt(0)
  v_max3_u32 v118, v8, v9, v10
  v_max3_u32 v118, v118, v11, v12
  v_max3_u32 v118, v118, v13, v14
  v_max3_u32 v118, v118, v15, v16
  v_max3_u32 v118, v118, v17, v18
  v_max3_u32 v118, v118, v19, v20
  v_max3_u32 v118, v118, v21, v22
  v_max3_u32 v118, v118, v23, v24
  v_max3_u32 v118, v118, v25, v26
  v_max3_u32 v118, v118, v27, v28
  v_max3_u32 v118, v118, v29, v30
  v_max3_u32 v118, v118, v31, v32
  v_max3_u32 v118, v118, v33, v34
  v_max_u32 v118, v118, v35
  v_cmp_eq_u32 vcc, -1, v118
  s_cbranch_vccz cB_sc0_rk
  s_add_u32 s30, s30, 1
  s_cmp_lt_u32 s30, 400000
  s_cbranch_scc1 cB_sc0_rv
  s_branch cB_abort
cB_sc0_rk:
  s_mov_b32 s62, 1
  v_mov_b32 v36, 0
  v_mov_b32 v37, 0
  v_mov_b32 v38, 0
  v_mov_b32 v39, 0
  v_mov_b32 v40, 0
  v_mov_b32 v41, 0
  v_mov_b32 v42, 0
  v_mov_b32 v43, 0
  v_mov_b32 v44, 0
  v_mov_b32 v45, 0
  v_mov_b32 v46, 0
  v_mov_b32 v47, 0
  v_mov_b32 v48, 0
  v_mov_b32 v49, 0
  v_mov_b32 v50, 0
  v_mov_b32 v51, 0
  v_mov_b32 v52, 0
  v_mov_b32 v53, 0
  v_mov_b32 v54, 0
  v_mov_b32 v55, 0
  v_mov_b32 v56, 0
  v_mov_b32 v57, 0
  v_mov_b32 v58, 0
  v_mov_b32 v59, 0
  v_mov_b32 v60, 0
  v_mov_b32 v61, 0
  v_mov_b32 v62, 0
  v_mov_b32 v63, 0
  v_mov_b32 v88, 0
  v_mov_b32 v89, 0
  v_mov_b32 v90, 0
  v_mov_b32 v91, 0
  v_mov_b32 v92, 0
  v_mov_b32 v93, 0
  v_mov_b32 v94, 0
  v_mov_b32 v95, 0
  v_mov_b32 v66, 0
  v_mov_b32 v67, 0
  s_add_u32 s31, s31, 1
  ds_read_b128 v[96:99], v117 offset:0
  ds_read_b128 v[100:103], v117 offset:1024
  ds_read_b128 v[104:107], v117 offset:14336
  ds_read_b128 v[108:111], v117 offset:15360
  v_smfmac_f32_16x16x64_bf16 v[36:39], v[8:11], a[0:7], v3
  v_smfmac_f32_16x16x64_bf16 v[40:43], v[8:11], a[56:63], v3
  v_smfmac_f32_16x16x64_bf16 v[44:47], v[8:11], a[112:119], v3
  v_smfmac_f32_16x16x64_bf16 v[48:51], v[8:11], a[168:175], v3
  v_smfmac_f32_16x16x64_bf16 v[52:55], v[8:11], a[224:231], v3
  v_smfmac_f32_16x16x64_bf16 v[56:59], v[8:11], v[144:151], v3
  v_smfmac_f32_16x16x64_bf16 v[60:63], v[8:11], v[200:207], v3
  v_smfmac_f32_16x16x64_bf16 v[36:39], v[12:15], a[8:15], v3
  v_smfmac_f32_16x16x64_bf16 v[40:43], v[12:15], a[64:71], v3
  v_smfmac_f32_16x16x64_bf16 v[44:47], v[12:15], a[120:127], v3
  v_smfmac_f32_16x16x64_bf16 v[48:51], v[12:15], a[176:183], v3
  v_smfmac_f32_16x16x64_bf16 v[52:55], v[12:15], a[232:239], v3
  v_smfmac_f32_16x16x64_bf16 v[56:59], v[12:15], v[152:159], v3
  v_smfmac_f32_16x16x64_bf16 v[60:63], v[12:15], v[208:215], v3
  v_smfmac_f32_16x16x64_bf16 v[36:39], v[16:19], a[16:23], v3
  v_smfmac_f32_16x16x64_bf16 v[40:43], v[16:19], a[72:79], v3
  v_smfmac_f32_16x16x64_bf16 v[44:47], v[16:19], a[128:135], v3
  v_smfmac_f32_16x16x64_bf16 v[48:51], v[16:19], a[184:191], v3
  v_smfmac_f32_16x16x64_bf16 v[52:55], v[16:19], a[240:247], v3
  v_smfmac_f32_16x16x64_bf16 v[56:59], v[16:19], v[160:167], v3
  v_smfmac_f32_16x16x64_bf16 v[60:63], v[16:19], v[216:223], v3
  v_smfmac_f32_16x16x64_bf16 v[36:39], v[20:23], a[24:31], v3
  v_smfmac_f32_16x16x64_bf16 v[40:43], v[20:23], a[80:87], v3
  v_smfmac_f32_16x16x64_bf16 v[44:47], v[20:23], a[136:143], v3
  v_smfmac_f32_16x16x64_bf16 v[48:51], v[20:23], a[192:199], v3
  v_smfmac_f32_16x16x64_bf16 v[52:55], v[20:23], a[248:255], v3
  v_smfmac_f32_16x16x64_bf16 v[56:59], v[20:23], v[168:175], v3
  v_smfmac_f32_16x16x64_bf16 v[60:63], v[20:23], v[224:231], v3
  s_branch cB_sc0_ph2
.p2align 6

cB_sc1_loop:
  s_add_u32 s23, s20, 4096
  s_add_u32 s21, s20, 25600
  v_mov_b32 v48, 0
  v_mov_b32 v49, 0
  v_mov_b32 v50, 0
  v_mov_b32 v51, 0
  v_mov_b32 v52, 0
  v_mov_b32 v53, 0
  v_mov_b32 v54, 0
  v_mov_b32 v55, 0
  v_mov_b32 v56, 0
  v_mov_b32 v57, 0
  v_mov_b32 v58, 0
  v_mov_b32 v59, 0
  v_mov_b32 v60, 0
  v_mov_b32 v61, 0
  v_mov_b32 v62, 0
  v_mov_b32 v63, 0
  v_mov_b32 v88, 0
  v_mov_b32 v89, 0
  v_mov_b32 v90, 0
  v_mov_b32 v91, 0
  v_mov_b32 v92, 0
  v_mov_b32 v93, 0
  v_mov_b32 v94, 0
  v_mov_b32 v95, 0
  v_mov_b32 v64, 0
  v_mov_b32 v65, 0
  s_mov_b32 s30, 0
  s_mov_b32 s62, 0
  s_waitcnt vmcnt(0)
  s_barrier
cB_sc1_ld:
  buffer_load_dwordx4 v[8:11], v2, s[8:11], s20 offen offset:0 sc1
  v_mov_b32 v36, 0
  v_mov_b32 v37, 0
  v_mov_b32 v38, 0
  v_mov_b32 v39, 0
  buffer_load_dwordx4 v[12:15], v2, s[8:11], s20 offen offset:1024 sc1
  v_mov_b32 v40, 0
  v_mov_b32 v41, 0
  v_mov_b32 v42, 0
  v_mov_b32 v43, 0
  buffer_load_dwordx4 v[16:19], v2, s[8:11], s20 offen offset:2048 sc1
  v_mov_b32 v44, 0
  v_mov_b32 v45, 0
  v_mov_b32 v46, 0
  v_mov_b32 v47, 0
  ds_read_b128 v[96:99], v117 offset:0
  ds_read_b128 v[100:103], v117 offset:1024
  ds_read_b128 v[104:107], v117 offset:14336
  ds_read_b128 v[108:111], v117 offset:15360
  s_waitcnt vmcnt(2)
  v_smfmac_f32_16x16x64_bf16 v[36:39], v[8:11], a[0:7], v3
  v_smfmac_f32_16x16x64_bf16 v[40:43], v[8:11], a[56:63], v3
  buffer_load_dwordx4 v[20:23], v2, s[8:11], s20 offen offset:3072 sc1
  v_smfmac_f32_16x16x64_bf16 v[44:47], v[8:11], a[112:119], v3
  v_smfmac_f32_16x16x64_bf16 v[48:51], v[8:11], a[168:175], v3
  v_smfmac_f32_16x16x64_bf16 v[52:55], v[8:11], a[224:231], v3
  buffer_load_dwordx4 v[24:27], v2, s[8:11], s23 offen offset:0 sc1
  v_smfmac_f32_16x16x64_bf16 v[56:59], v[8:11], v[144:151], v3
  v_smfmac_f32_16x16x64_bf16 v[60:63], v[8:11], v[200:207], v3
  s_waitcnt vmcnt(3)
  v_smfmac_f32_16x16x64_bf16 v[36:39], v[12:15], a[8:15], v3
  v_smfmac_f32_16x16x64_bf16 v[40:43], v[12:15], a[64:71], v3
  buffer_load_dwordx4 v[28:31], v2, s[8:11], s23 offen offset:1024 sc1
  v_smfmac_f32_16x16x64_bf16 v[44:47], v[12:15], a[120:127], v3
  v_smfmac_f32_16x16x64_bf16 v[48:51], v[12:15], a[176:183], v3
  v_smfmac_f32_16x16x64_bf16 v[52:55], v[12:15], a[232:239], v3
  buffer_load_dwordx4 v[32:35], v2, s[8:11], s23 offen offset:2048 sc1
  v_smfmac_f32_16x16x64_bf16 v[56:59], v[12:15], v[152:159], v3
  v_smfmac_f32_16x16x64_bf16 v[60:63], v[12:15], v[208:215], v3
  s_waitcnt vmcnt(4)
  v_smfmac_f32_16x16x64_bf16 v[36:39], v[16:19], a[16:23], v3
  v_smfmac_f32_16x16x64_bf16 v[40:43], v[16:19], a[72:79], v3
  v_smfmac_f32_16x16x64_bf16 v[44:47], v[16:19], a[128:135], v3
  v_smfmac_f32_16x16x64_bf16 v[48:51], v[16:19], a[184:191], v3
  v_smfmac_f32_16x16x64_bf16 v[52:55], v[16:19], a[240:247], v3
  v_smfmac_f32_16x16x64_bf16 v[56:59], v[16:19], v[160:167], v3
  v_smfmac_f32_16x16x64_bf16 v[60:63], v[16:19], v[216:223], v3
  s_waitcnt vmcnt(3)
  v_smfmac_f32_16x16x64_bf16 v[36:39], v[20:23], a[24:31], v3
  v_smfmac_f32_16x16x64_bf16 v[40:43], v[20:23], a[80:87], v3
  v_smfmac_f32_16x16x64_bf16 v[44:47], v[20:23], a[136:143], v3
  v_smfmac_f32_16x16x64_bf16 v[48:51], v[20:23], a[192:199], v3
  v_smfmac_f32_16x16x64_bf16 v[52:55], v[20:23], a[248:255], v3
  v_smfmac_f32_16x16x64_bf16 v[56:59], v[20:23], v[168:175], v3
  v_smfmac_f32_16x16x64_bf16 v[60:63], v[20:23], v[224:231], v3
  s_waitcnt vmcnt(0)
cB_sc1_ph2:
  v_smfmac_f32_16x16x64_bf16 v[60:63], v[24:27], v[232:239], v3
  ds_read_b128 v[16:19], v116 offset:2048
  ds_read_b128 v[20:23], v116 offset:3072
  v_smfmac_f32_16x16x64_bf16 v[60:63], v[28:31], v[240:247], v3
  buffer_load_dword v119, v0, s[8:11], s20 offen sc1
  v_smfmac_f32_16x16x64_bf16 v[60:63], v[32:35], v[248:255], v3
  v_mov_b32 v80, v26
  v_smfmac_f32_16x16x64_bf16 v[52:55], v[24:27], v[120:127], v3
  v_mov_b32 v81, v27
  v_smfmac_f32_16x16x64_bf16 v[52:55], v[28:31], v[128:135], v3
  v_mov_b32 v82, v32
  v_smfmac_f32_16x16x64_bf16 v[52:55], v[32:35], v[136:143], v3
  v_cvt_pk_bf16_f32 v66, v60, v61
  v_smfmac_f32_16x16x64_bf16 v[56:59], v[24:27], v[176:183], v3
  v_cvt_pk_bf16_f32 v67, v62, v63
  v_smfmac_f32_16x16x64_bf16 v[56:59], v[28:31], v[184:191], v3
  v_mov_b32 v83, v33
  v_mfma_f32_16x16x32_bf16 v[68:71], v[64:67], v[4:7], 0
  v_smfmac_f32_16x16x64_bf16 v[56:59], v[32:35], v[192:199], v3
  v_cvt_pk_bf16_f32 v64, v52, v53
  v_smfmac_f32_16x16x64_bf16 v[36:39], v[24:27], a[32:39], v3
  v_cvt_pk_bf16_f32 v65, v54, v55
  v_smfmac_f32_16x16x64_bf16 v[36:39], v[28:31], a[40:47], v3
  v_cvt_pk_bf16_f32 v78, v68, v69
  v_smfmac_f32_16x16x64_bf16 v[36:39], v[32:35], a[48:55], v3
  v_cvt_pk_bf16_f32 v79, v70, v71
  v_cvt_pk_bf16_f32 v66, v56, v57
  v_smfmac_f32_16x16x64_bf16 v[40:43], v[24:27], a[88:95], v3
  v_cvt_pk_bf16_f32 v67, v58, v59
  v_smfmac_f32_16x16x64_bf16 v[40:43], v[28:31], a[96:103], v3
  v_mfma_f32_16x16x32_bf16 v[72:75], v[64:67], v[4:7], 0
  ds_read_b128 v[52:55], v116 offset:16384
  ds_read_b128 v[56:59], v116 offset:17408
  v_smfmac_f32_16x16x64_bf16 v[40:43], v[32:35], a[104:111], v3
  v_cvt_pk_bf16_f32 v64, v36, v37
  v_smfmac_f32_16x16x64_bf16 v[44:47], v[24:27], a[144:151], v3
  v_cvt_pk_bf16_f32 v65, v38, v39
  v_smfmac_f32_16x16x64_bf16 v[44:47], v[28:31], a[152:159], v3
  v_cvt_pk_bf16_f32 v76, v72, v73
  v_smfmac_f32_16x16x64_bf16 v[44:47], v[32:35], a[160:167], v3
  v_cvt_pk_bf16_f32 v77, v74, v75
  v_cvt_pk_bf16_f32 v66, v40, v41
  v_smfmac_f32_16x16x64_bf16 v[48:51], v[24:27], a[200:207], v3
  v_cvt_pk_bf16_f32 v67, v42, v43
  v_smfmac_f32_16x16x64_bf16 v[48:51], v[28:31], a[208:215], v3
  v_mfma_f32_16x16x32_bf16 v[68:71], v[64:67], v[4:7], 0
  v_smfmac_f32_16x16x64_bf16 v[48:51], v[32:35], a[216:223], v3
  v_cvt_pk_bf16_f32 v64, v44, v45
  v_mfma_f32_16x16x32_bf16 v[84:87], v[80:83], v[76:79], 0
  v_cvt_pk_bf16_f32 v65, v46, v47
  s_waitcnt lgkmcnt(0)
  v_smfmac_f32_16x16x64_bf16 v[88:91], v[76:79], v[96:103], v3
  v_cvt_pk_bf16_f32 v60, v68, v69
  v_cvt_pk_bf16_f32 v61, v70, v71
  v_cvt_pk_bf16_f32 v66, v48, v49
  v_cvt_pk_bf16_f32 v67, v50, v51
  s_nop 1
  v_mfma_f32_16x16x32_bf16 v[72:75], v[64:67], v[4:7], 0
  v_smfmac_f32_16x16x64_bf16 v[92:95], v[76:79], v[104:111], v3
  s_nop 4
  v_cvt_pk_bf16_f32 v62, v72, v73
  v_cvt_pk_bf16_f32 v63, v74, v75
  s_nop 1
  v_mfma_f32_16x16x32_bf16 v[84:87], v[12:15], v[60:63], v[84:87]
  v_smfmac_f32_16x16x64_bf16 v[88:91], v[60:63], v[16:23], v3
  v_smfmac_f32_16x16x64_bf16 v[92:95], v[60:63], v[52:59], v3
  s_mov_b64 exec, s[26:27]
  s_nop 0
  ds_write_b128 v113, v[84:87]
  s_mov_b64 exec, -1
  s_nop 0
  v_cmp_u_f32 vcc, v88, v89
  s_nop 1
  v_permlane32_swap_b32 v88, v92
  v_permlane32_swap_b32 v89, v93
  v_permlane32_swap_b32 v90, v94
  v_permlane32_swap_b32 v91, v95
  v_add_f32 v88, v88, v92
  v_add_f32 v89, v89, v93
  v_add_f32 v90, v90, v94
  v_add_f32 v91, v91, v95
  ds_write_b128 v112, v[88:91]
  s_cbranch_vccnz cB_sc1_retry
cB_sc1_cont:
  s_waitcnt lgkmcnt(0)
  s_barrier
  ds_read_b64 v[36:37], v114 offset:0
  ds_read_b64 v[38:39], v114 offset:1024
  ds_read2_b32 v[44:45], v115 offset0:0 offset1:64
  s_waitcnt lgkmcnt(0)
  v_add_f32 v44, v44, v45
  v_add_f32 v36, v36, v38
  v_add_f32 v37, v37, v39
  v_add_f32_dpp v44, v44, v44 row_ror:8 row_mask:0xf bank_mask:0xf
  v_mov_b32 v45, v44
  v_permlane32_swap_b32 v36, v37
  v_add_f32 v36, v36, v37
  v_permlane16_swap_b32 v44, v45
  v_add_f32 v44, v44, v45
  v_exp_f32 v48, v36
  v_exp_f32 v49, v44
  v_add_f32 v50, abs(v36), abs(v44)
  v_fma_f32 v39, v49, s37, v48
  v_cmp_ngt_f32 vcc, s56, v50
  v_cndmask_b32 v41, v48, v49, s[38:39]
  v_add_f32_dpp v39, v39, v39 quad_perm:[1,0,3,2] row_mask:0xf bank_mask:0xf
  v_cndmask_b32 v40, v49, v48, s[38:39]
  v_mov_b32_dpp v46, v41 quad_perm:[1,0,3,2] row_mask:0xf bank_mask:0xf
  v_add_f32_dpp v39, v39, v39 quad_perm:[2,3,0,1] row_mask:0xf bank_mask:0xf
  v_cndmask_b32 v42, v46, v40, s[38:39]
  v_cndmask_b32 v43, v40, v46, s[38:39]
  v_add_f32_dpp v39, v39, v39 row_half_mirror row_mask:0xf bank_mask:0xf
  s_cbranch_vccnz cB_sc1_slow
  s_nop 0
  v_add_f32_dpp v39, v39, v39 row_mirror row_mask:0xf bank_mask:0xf
  v_mov_b32 v47, v39
  s_nop 1
  v_permlane16_swap_b32 v39, v47
  v_add_f32 v39, v39, v47
  v_rcp_f32 v39, v39
  s_mov_b64 exec, s[28:29]
  v_mul_f32 v42, v42, v39
  v_mul_f32 v43, v43, v39
  v_cvt_pk_bf16_f32 v42, v42, v43
cB_sc1_pst:
  buffer_store_dword v42, v1, s[8:11], s20 offen sc1
  s_mov_b64 exec, -1
  s_barrier
  s_add_u32 s24, s24, 28672
  s_add_u32 s35, s35, 28672
  s_xor_b32 s25, s25, 28672
  s_add_u32 m0, s25, 7168
  s_nop 0
  buffer_load_dwordx4 v2, s[8:11], s24 offen offset:0 sc1 lds
  buffer_load_dwordx4 v2, s[8:11], s24 offen offset:1024 sc1 lds
  buffer_load_dwordx4 v2, s[8:11], s24 offen offset:2048 sc1 lds
  buffer_load_dwordx4 v2, s[8:11], s24 offen offset:3072 sc1 lds
  s_add_u32 m0, s25, 11264
  s_add_u32 s22, s24, 4096
  buffer_load_dwordx4 v2, s[8:11], s22 offen offset:0 sc1 lds
  buffer_load_dwordx4 v2, s[8:11], s22 offen offset:1024 sc1 lds
  buffer_load_dwordx4 v2, s[8:11], s22 offen offset:2048 sc1 lds
  v_xor_b32 v116, 28672, v116
  v_add_u32 v117, s57, v117
  s_sub_u32 s57, 0, s57
  s_add_u32 s19, s19, 1
  s_mov_b32 s20, s21
  s_cmp_lt_u32 s19, 63
  s_cbranch_scc1 cB_sc1_loop
  s_branch cB_done
cB_sc1_slow:
  v_max_f32 v50, v36, v44
  s_nop 1
  v_max_f32_dpp v50, v50, v50 quad_perm:[1,0,3,2] row_mask:0xf bank_mask:0xf
  s_nop 1
  v_max_f32_dpp v50, v50, v50 quad_perm:[2,3,0,1] row_mask:0xf bank_mask:0xf
  s_nop 1
  v_max_f32_dpp v50, v50, v50 row_half_mirror row_mask:0xf bank_mask:0xf
  s_nop 1
  v_max_f32_dpp v50, v50, v50 row_mirror row_mask:0xf bank_mask:0xf
  v_mov_b32 v47, v50
  s_nop 1
  v_permlane16_swap_b32 v50, v47
  v_max_f32 v50, v50, v47
  v_sub_f32 v48, v36, v50
  v_sub_f32 v49, v44, v50
  v_exp_f32 v48, v48
  v_exp_f32 v49, v49
  s_add_u32 s31, s31, 0x100
  v_fma_f32 v39, v49, s37, v48
  v_cndmask_b32 v41, v48, v49, s[38:39]
  s_nop 0
  v_add_f32_dpp v39, v39, v39 quad_perm:[1,0,3,2] row_mask:0xf bank_mask:0xf
  v_cndmask_b32 v40, v49, v48, s[38:39]
  v_mov_b32_dpp v46, v41 quad_perm:[1,0,3,2] row_mask:0xf bank_mask:0xf
  v_add_f32_dpp v39, v39, v39 quad_perm:[2,3,0,1] row_mask:0xf bank_mask:0xf
  v_cndmask_b32 v42, v46, v40, s[38:39]
  v_cndmask_b32 v43, v40, v46, s[38:39]
  v_add_f32_dpp v39, v39, v39 row_half_mirror row_mask:0xf bank_mask:0xf
  s_nop 1
  v_add_f32_dpp v39, v39, v39 row_mirror row_mask:0xf bank_mask:0xf
  v_mov_b32 v47, v39
  s_nop 1
  v_permlane16_swap_b32 v39, v47
  v_add_f32 v39, v39, v47
  v_rcp_f32 v39, v39
  s_mov_b64 exec, s[28:29]
  v_mul_f32 v42, v42, v39
  v_mul_f32 v43, v43, v39
  v_cvt_pk_bf16_f32 v42, v42, v43
  v_min_u32 v42, -2, v42
  s_branch cB_sc1_pst
cB_sc1_retry:
  s_cmp_lg_u32 s62, 0
  s_cbranch_scc1 cB_sc1_cont
  s_waitcnt vmcnt(0) lgkmcnt(0)
cB_sc1_rv:
  buffer_load_dwordx4 v[8:11], v2, s[8:11], s20 offen offset:0 sc1
  buffer_load_dwordx4 v[12:15], v2, s[8:11], s20 offen offset:1024 sc1
  buffer_load_dwordx4 v[16:19], v2, s[8:11], s20 offen offset:2048 sc1
  buffer_load_dwordx4 v[20:23], v2, s[8:11], s20 offen offset:3072 sc1
  buffer_load_dwordx4 v[24:27], v2, s[8:11], s23 offen offset:0 sc1
  buffer_load_dwordx4 v[28:31], v2, s[8:11], s23 offen offset:1024 sc1
  buffer_load_dwordx4 v[32:35], v2, s[8:11], s23 offen offset:2048 sc1
  s_waitcnt vmcnt(0)
  v_max3_u32 v118, v8, v9, v10
  v_max3_u32 v118, v118, v11, v12
  v_max3_u32 v118, v118, v13, v14
  v_max3_u32 v118, v118, v15, v16
  v_max3_u32 v118, v118, v17, v18
  v_max3_u32 v118, v118, v19, v20
  v_max3_u32 v118, v118, v21, v22
  v_max3_u32 v118, v118, v23, v24
  v_max3_u32 v118, v118, v25, v26
  v_max3_u32 v118, v118, v27, v28
  v_max3_u32 v118, v118, v29, v30
  v_max3_u32 v118, v118, v31, v32
  v_max3_u32 v118, v118, v33, v34
  v_max_u32 v118, v118, v35
  v_cmp_eq_u32 vcc, -1, v118
  s_cbranch_vccz cB_sc1_rk
  s_add_u32 s30, s30, 1
  s_cmp_lt_u32 s30, 400000
  s_cbranch_scc1 cB_sc1_rv
  s_branch cB_abort
cB_sc1_rk:
  s_mov_b32 s62, 1
  v_mov_b32 v36, 0
  v_mov_b32 v37, 0
  v_mov_b32 v38, 0
  v_mov_b32 v39, 0
  v_mov_b32 v40, 0
  v_mov_b32 v41, 0
  v_mov_b32 v42, 0
  v_mov_b32 v43, 0
  v_mov_b32 v44, 0
  v_mov_b32 v45, 0
  v_mov_b32 v46, 0
  v_mov_b32 v47, 0
  v_mov_b32 v48, 0
  v_mov_b32 v49, 0
  v_mov_b32 v50, 0
  v_mov_b32 v51, 0
  v_mov_b32 v52, 0
  v_mov_b32 v53, 0
  v_mov_b32 v54, 0
  v_mov_b32 v55, 0
  v_mov_b32 v56, 0
  v_mov_b32 v57, 0
  v_mov_b32 v58, 0
  v_mov_b32 v59, 0
  v_mov_b32 v60, 0
  v_mov_b32 v61, 0
  v_mov_b32 v62, 0
  v_mov_b32 v63, 0
  v_mov_b32 v88, 0
  v_mov_b32 v89, 0
  v_mov_b32 v90, 0
  v_mov_b32 v91, 0
  v_mov_b32 v92, 0
  v_mov_b32 v93, 0
  v_mov_b32 v94, 0
  v_mov_b32 v95, 0
  v_mov_b32 v64, 0
  v_mov_b32 v65, 0
  s_add_u32 s31, s31, 1
  ds_read_b128 v[96:99], v117 offset:0
  ds_read_b128 v[100:103], v117 offset:1024
  ds_read_b128 v[104:107], v117 offset:14336
  ds_read_b128 v[108:111], v117 offset:15360
  v_smfmac_f32_16x16x64_bf16 v[36:39], v[8:11], a[0:7], v3
  v_smfmac_f32_16x16x64_bf16 v[40:43], v[8:11], a[56:63], v3
  v_smfmac_f32_16x16x64_bf16 v[44:47], v[8:11], a[112:119], v3
  v_smfmac_f32_16x16x64_bf16 v[48:51], v[8:11], a[168:175], v3
  v_smfmac_f32_16x16x64_bf16 v[52:55], v[8:11], a[224:231], v3
  v_smfmac_f32_16x16x64_bf16 v[56:59], v[8:11], v[144:151], v3
  v_smfmac_f32_16x16x64_bf16 v[60:63], v[8:11], v[200:207], v3
  v_smfmac_f32_16x16x64_bf16 v[36:39], v[12:15], a[8:15], v3
  v_smfmac_f32_16x16x64_bf16 v[40:43], v[12:15], a[64:71], v3
  v_smfmac_f32_16x16x64_bf16 v[44:47], v[12:15], a[120:127], v3
  v_smfmac_f32_16x16x64_bf16 v[48:51], v[12:15], a[176:183], v3
  v_smfmac_f32_16x16x64_bf16 v[52:55], v[12:15], a[232:239], v3
  v_smfmac_f32_16x16x64_bf16 v[56:59], v[12:15], v[152:159], v3
  v_smfmac_f32_16x16x64_bf16 v[60:63], v[12:15], v[208:215], v3
  v_smfmac_f32_16x16x64_bf16 v[36:39], v[16:19], a[16:23], v3
  v_smfmac_f32_16x16x64_bf16 v[40:43], v[16:19], a[72:79], v3
  v_smfmac_f32_16x16x64_bf16 v[44:47], v[16:19], a[128:135], v3
  v_smfmac_f32_16x16x64_bf16 v[48:51], v[16:19], a[184:191], v3
  v_smfmac_f32_16x16x64_bf16 v[52:55], v[16:19], a[240:247], v3
  v_smfmac_f32_16x16x64_bf16 v[56:59], v[16:19], v[160:167], v3
  v_smfmac_f32_16x16x64_bf16 v[60:63], v[16:19], v[216:223], v3
  v_smfmac_f32_16x16x64_bf16 v[36:39], v[20:23], a[24:31], v3
  v_smfmac_f32_16x16x64_bf16 v[40:43], v[20:23], a[80:87], v3
  v_smfmac_f32_16x16x64_bf16 v[44:47], v[20:23], a[136:143], v3
  v_smfmac_f32_16x16x64_bf16 v[48:51], v[20:23], a[192:199], v3
  v_smfmac_f32_16x16x64_bf16 v[52:55], v[20:23], a[248:255], v3
  v_smfmac_f32_16x16x64_bf16 v[56:59], v[20:23], v[168:175], v3
  v_smfmac_f32_16x16x64_bf16 v[60:63], v[20:23], v[224:231], v3
  s_branch cB_sc1_ph2
.p2align 6

cB_sc2_loop:
  s_add_u32 s23, s20, 4096
  s_add_u32 s21, s20, 25600
  v_mov_b32 v48, 0
  v_mov_b32 v49, 0
  v_mov_b32 v50, 0
  v_mov_b32 v51, 0
  v_mov_b32 v52, 0
  v_mov_b32 v53, 0
  v_mov_b32 v54, 0
  v_mov_b32 v55, 0
  v_mov_b32 v56, 0
  v_mov_b32 v57, 0
  v_mov_b32 v58, 0
  v_mov_b32 v59, 0
  v_mov_b32 v60, 0
  v_mov_b32 v61, 0
  v_mov_b32 v62, 0
  v_mov_b32 v63, 0
  v_mov_b32 v88, 0
  v_mov_b32 v89, 0
  v_mov_b32 v90, 0
  v_mov_b32 v91, 0
  v_mov_b32 v92, 0
  v_mov_b32 v93, 0
  v_mov_b32 v94, 0
  v_mov_b32 v95, 0
  v_mov_b32 v66, 0
  v_mov_b32 v67, 0
  s_mov_b32 s30, 0
  s_mov_b32 s62, 0
  s_waitcnt vmcnt(0)
  s_barrier
cB_sc2_ld:
  buffer_load_dwordx4 v[8:11], v2, s[8:11], s20 offen offset:0 sc1
  v_mov_b32 v36, 0
  v_mov_b32 v37, 0
  v_mov_b32 v38, 0
  v_mov_b32 v39, 0
  buffer_load_dwordx4 v[12:15], v2, s[8:11], s20 offen offset:1024 sc1
  v_mov_b32 v40, 0
  v_mov_b32 v41, 0
  v_mov_b32 v42, 0
  v_mov_b32 v43, 0
  buffer_load_dwordx4 v[16:19], v2, s[8:11], s20 offen offset:2048 sc1
  v_mov_b32 v44, 0
  v_mov_b32 v45, 0
  v_mov_b32 v46, 0
  v_mov_b32 v47, 0
  ds_read_b128 v[96:99], v117 offset:0
  ds_read_b128 v[100:103], v117 offset:1024
  ds_read_b128 v[104:107], v117 offset:14336
  ds_read_b128 v[108:111], v117 offset:15360
  s_waitcnt vmcnt(2)
  v_smfmac_f32_16x16x64_bf16 v[36:39], v[8:11], a[0:7], v3
  v_smfmac_f32_16x16x64_bf16 v[40:43], v[8:11], a[56:63], v3
  buffer_load_dwordx4 v[20:23], v2, s[8:11], s20 offen offset:3072 sc1
  v_smfmac_f32_16x16x64_bf16 v[44:47], v[8:11], a[112:119], v3
  v_smfmac_f32_16x16x64_bf16 v[48:51], v[8:11], a[168:175], v3
  v_smfmac_f32_16x16x64_bf16 v[52:55], v[8:11], a[224:231], v3
  buffer_load_dwordx4 v[24:27], v2, s[8:11], s23 offen offset:0 sc1
  v_smfmac_f32_16x16x64_bf16 v[56:59], v[8:11], v[144:151], v3
  v_smfmac_f32_16x16x64_bf16 v[60:63], v[8:11], v[200:207], v3
  s_waitcnt vmcnt(3)
  v_smfmac_f32_16x16x64_bf16 v[36:39], v[12:15], a[8:15], v3
  v_smfmac_f32_16x16x64_bf16 v[40:43], v[12:15], a[64:71], v3
  buffer_load_dwordx4 v[28:31], v2, s[8:11], s23 offen offset:1024 sc1
  v_smfmac_f32_16x16x64_bf16 v[44:47], v[12:15], a[120:127], v3
  v_smfmac_f32_16x16x64_bf16 v[48:51], v[12:15], a[176:183], v3
  v_smfmac_f32_16x16x64_bf16 v[52:55], v[12:15], a[232:239], v3
  buffer_load_dwordx4 v[32:35], v2, s[8:11], s23 offen offset:2048 sc1
  v_smfmac_f32_16x16x64_bf16 v[56:59], v[12:15], v[152:159], v3
  v_smfmac_f32_16x16x64_bf16 v[60:63], v[12:15], v[208:215], v3
  s_waitcnt vmcnt(4)
  v_smfmac_f32_16x16x64_bf16 v[36:39], v[16:19], a[16:23], v3
  v_smfmac_f32_16x16x64_bf16 v[40:43], v[16:19], a[72:79], v3
  v_smfmac_f32_16x16x64_bf16 v[44:47], v[16:19], a[128:135], v3
  v_smfmac_f32_16x16x64_bf16 v[48:51], v[16:19], a[184:191], v3
  v_smfmac_f32_16x16x64_bf16 v[52:55], v[16:19], a[240:247], v3
  v_smfmac_f32_16x16x64_bf16 v[56:59], v[16:19], v[160:167], v3
  v_smfmac_f32_16x16x64_bf16 v[60:63], v[16:19], v[216:223], v3
  s_waitcnt vmcnt(3)
  v_smfmac_f32_16x16x64_bf16 v[36:39], v[20:23], a[24:31], v3
  v_smfmac_f32_16x16x64_bf16 v[40:43], v[20:23], a[80:87], v3
  v_smfmac_f32_16x16x64_bf16 v[44:47], v[20:23], a[136:143], v3
  v_smfmac_f32_16x16x64_bf16 v[48:51], v[20:23], a[192:199], v3
  v_smfmac_f32_16x16x64_bf16 v[52:55], v[20:23], a[248:255], v3
  v_smfmac_f32_16x16x64_bf16 v[56:59], v[20:23], v[168:175], v3
  v_smfmac_f32_16x16x64_bf16 v[60:63], v[20:23], v[224:231], v3
  s_waitcnt vmcnt(0)
cB_sc2_ph2:
  v_smfmac_f32_16x16x64_bf16 v[60:63], v[24:27], v[232:239], v3
  ds_read_b128 v[8:11], v116 offset:4096
  ds_read_b128 v[12:15], v116 offset:5120
  v_smfmac_f32_16x16x64_bf16 v[60:63], v[28:31], v[240:247], v3
  buffer_load_dword v119, v0, s[8:11], s24 offen sc1
  v_smfmac_f32_16x16x64_bf16 v[60:63], v[32:35], v[248:255], v3
  v_mov_b32 v80, v28
  v_smfmac_f32_16x16x64_bf16 v[52:55], v[24:27], v[120:127], v3
  v_mov_b32 v81, v29
  v_smfmac_f32_16x16x64_bf16 v[52:55], v[28:31], v[128:135], v3
  v_mov_b32 v82, v34
  v_smfmac_f32_16x16x64_bf16 v[52:55], v[32:35], v[136:143], v3
  v_cvt_pk_bf16_f32 v64, v60, v61
  v_smfmac_f32_16x16x64_bf16 v[56:59], v[24:27], v[176:183], v3
  v_cvt_pk_bf16_f32 v65, v62, v63
  v_smfmac_f32_16x16x64_bf16 v[56:59], v[28:31], v[184:191], v3
  v_mov_b32 v83, v35
  v_mfma_f32_16x16x32_bf16 v[68:71], v[64:67], v[4:7], 0
  v_smfmac_f32_16x16x64_bf16 v[56:59], v[32:35], v[192:199], v3
  v_cvt_pk_bf16_f32 v64, v52, v53
  v_smfmac_f32_16x16x64_bf16 v[36:39], v[24:27], a[32:39], v3
  v_cvt_pk_bf16_f32 v65, v54, v55
  v_smfmac_f32_16x16x64_bf16 v[36:39], v[28:31], a[40:47], v3
  v_cvt_pk_bf16_f32 v78, v68, v69
  v_smfmac_f32_16x16x64_bf16 v[36:39], v[32:35], a[48:55], v3
  v_cvt_pk_bf16_f32 v79, v70, v71
  v_cvt_pk_bf16_f32 v66, v56, v57
  v_smfmac_f32_16x16x64_bf16 v[40:43], v[24:27], a[88:95], v3
  v_cvt_pk_bf16_f32 v67, v58, v59
  v_smfmac_f32_16x16x64_bf16 v[40:43], v[28:31], a[96:103], v3
  v_mfma_f32_16x16x32_bf16 v[72:75], v[64:67], v[4:7], 0
  ds_read_b128 v[52:55], v116 offset:18432
  ds_read_b128 v[56:59], v116 offset:19456
  v_smfmac_f32_16x16x64_bf16 v[40:43], v[32:35], a[104:111], v3
  v_cvt_pk_bf16_f32 v64, v36, v37
  v_smfmac_f32_16x16x64_bf16 v[44:47], v[24:27], a[144:151], v3
  v_cvt_pk_bf16_f32 v65, v38, v39
  v_smfmac_f32_16x16x64_bf16 v[44:47], v[28:31], a[152:159], v3
  v_cvt_pk_bf16_f32 v76, v72, v73
  v_smfmac_f32_16x16x64_bf16 v[44:47], v[32:35], a[160:167], v3
  v_cvt_pk_bf16_f32 v77, v74, v75
  v_cvt_pk_bf16_f32 v66, v40, v41
  v_smfmac_f32_16x16x64_bf16 v[48:51], v[24:27], a[200:207], v3
  v_cvt_pk_bf16_f32 v67, v42, v43
  v_smfmac_f32_16x16x64_bf16 v[48:51], v[28:31], a[208:215], v3
  v_mfma_f32_16x16x32_bf16 v[68:71], v[64:67], v[4:7], 0
  v_smfmac_f32_16x16x64_bf16 v[48:51], v[32:35], a[216:223], v3
  v_cvt_pk_bf16_f32 v64, v44, v45
  v_mfma_f32_16x16x32_bf16 v[84:87], v[80:83], v[76:79], 0
  v_cvt_pk_bf16_f32 v65, v46, v47
  s_waitcnt lgkmcnt(0)
  v_smfmac_f32_16x16x64_bf16 v[88:91], v[76:79], v[96:103], v3
  v_cvt_pk_bf16_f32 v60, v68, v69
  v_cvt_pk_bf16_f32 v61, v70, v71
  v_cvt_pk_bf16_f32 v66, v48, v49
  v_cvt_pk_bf16_f32 v67, v50, v51
  s_nop 1
  v_mfma_f32_16x16x32_bf16 v[72:75], v[64:67], v[4:7], 0
  v_smfmac_f32_16x16x64_bf16 v[92:95], v[76:79], v[104:111], v3
  s_nop 4
  v_cvt_pk_bf16_f32 v62, v72, v73
  v_cvt_pk_bf16_f32 v63, v74, v75
  s_nop 1
  v_mfma_f32_16x16x32_bf16 v[84:87], v[16:19], v[60:63], v[84:87]
  v_smfmac_f32_16x16x64_bf16 v[88:91], v[60:63], v[8:15], v3
  v_smfmac_f32_16x16x64_bf16 v[92:95], v[60:63], v[52:59], v3
  s_mov_b64 exec, s[26:27]
  s_nop 0
  ds_write_b128 v113, v[84:87]
  s_mov_b64 exec, -1
  s_nop 0
  v_cmp_u_f32 vcc, v88, v89
  s_nop 1
  v_permlane32_swap_b32 v88, v92
  v_permlane32_swap_b32 v89, v93
  v_permlane32_swap_b32 v90, v94
  v_permlane32_swap_b32 v91, v95
  v_add_f32 v88, v88, v92
  v_add_f32 v89, v89, v93
  v_add_f32 v90, v90, v94
  v_add_f32 v91, v91, v95
  ds_write_b128 v112, v[88:91]
  s_cbranch_vccnz cB_sc2_retry
cB_sc2_cont:
  s_waitcnt lgkmcnt(0)
  s_barrier
  ds_read_b64 v[36:37], v114 offset:0
  ds_read_b64 v[38:39], v114 offset:1024
  ds_read2_b32 v[44:45], v115 offset0:0 offset1:64
  v_lshl_add_u32 v56, v2, 3, s36
  s_waitcnt lgkmcnt(0)
  v_add_f32 v44, v44, v45
  v_add_f32 v36, v36, v38
  v_add_f32 v37, v37, v39
  v_add_f32_dpp v44, v44, v44 row_ror:8 row_mask:0xf bank_mask:0xf
  v_mov_b32 v45, v44
  s_mov_b64 exec, 65535
  buffer_store_dword v2, v56, s[8:11], s20 offen sc1
  s_mov_b64 exec, -1
  v_permlane32_swap_b32 v36, v37
  v_add_f32 v36, v36, v37
  v_permlane16_swap_b32 v44, v45
  v_add_f32 v44, v44, v45
  v_exp_f32 v48, v36
  v_exp_f32 v49, v44
  v_add_f32 v50, abs(v36), abs(v44)
  v_fma_f32 v39, v49, s37, v48
  v_cmp_ngt_f32 vcc, s56, v50
  v_cndmask_b32 v41, v48, v49, s[38:39]
  v_add_f32_dpp v39, v39, v39 quad_perm:[1,0,3,2] row_mask:0xf bank_mask:0xf
  v_cndmask_b32 v40, v49, v48, s[38:39]
  v_mov_b32_dpp v46, v41 quad_perm:[1,0,3,2] row_mask:0xf bank_mask:0xf
  v_add_f32_dpp v39, v39, v39 quad_perm:[2,3,0,1] row_mask:0xf bank_mask:0xf
  v_cndmask_b32 v42, v46, v40, s[38:39]
  v_cndmask_b32 v43, v40, v46, s[38:39]
  v_add_f32_dpp v39, v39, v39 row_half_mirror row_mask:0xf bank_mask:0xf
  s_cbranch_vccnz cB_sc2_slow
  s_nop 0
  v_add_f32_dpp v39, v39, v39 row_mirror row_mask:0xf bank_mask:0xf
  v_mov_b32 v47, v39
  s_nop 1
  v_permlane16_swap_b32 v39, v47
  v_add_f32 v39, v39, v47
  v_rcp_f32 v39, v39
  s_mov_b64 exec, s[28:29]
  v_mul_f32 v42, v42, v39
  v_mul_f32 v43, v43, v39
  v_cvt_pk_bf16_f32 v42, v42, v43
cB_sc2_pst:
  buffer_store_dword v42, v1, s[8:11], s20 offen sc1
  s_mov_b64 exec, -1
  s_barrier
  s_add_u32 s24, s24, 28672
  s_add_u32 s35, s35, 28672
  s_xor_b32 s25, s25, 28672
  s_add_u32 m0, s25, 14336
  s_nop 0
  buffer_load_dwordx4 v2, s[8:11], s24 offen offset:0 sc1 lds
  buffer_load_dwordx4 v2, s[8:11], s24 offen offset:1024 sc1 lds
  buffer_load_dwordx4 v2, s[8:11], s24 offen offset:2048 sc1 lds
  buffer_load_dwordx4 v2, s[8:11], s24 offen offset:3072 sc1 lds
  s_add_u32 m0, s25, 18432
  s_add_u32 s22, s24, 4096
  buffer_load_dwordx4 v2, s[8:11], s22 offen offset:0 sc1 lds
  buffer_load_dwordx4 v2, s[8:11], s22 offen offset:1024 sc1 lds
  buffer_load_dwordx4 v2, s[8:11], s22 offen offset:2048 sc1 lds
  v_xor_b32 v116, 28672, v116
  v_add_u32 v117, s57, v117
  s_sub_u32 s57, 0, s57
  s_add_u32 s19, s19, 1
  s_mov_b32 s20, s21
  s_cmp_lt_u32 s19, 63
  s_cbranch_scc1 cB_sc2_loop
  s_branch cB_done
cB_sc2_slow:
  v_max_f32 v50, v36, v44
  s_nop 1
  v_max_f32_dpp v50, v50, v50 quad_perm:[1,0,3,2] row_mask:0xf bank_mask:0xf
  s_nop 1
  v_max_f32_dpp v50, v50, v50 quad_perm:[2,3,0,1] row_mask:0xf bank_mask:0xf
  s_nop 1
  v_max_f32_dpp v50, v50, v50 row_half_mirror row_mask:0xf bank_mask:0xf
  s_nop 1
  v_max_f32_dpp v50, v50, v50 row_mirror row_mask:0xf bank_mask:0xf
  v_mov_b32 v47, v50
  s_nop 1
  v_permlane16_swap_b32 v50, v47
  v_max_f32 v50, v50, v47
  v_sub_f32 v48, v36, v50
  v_sub_f32 v49, v44, v50
  v_exp_f32 v48, v48
  v_exp_f32 v49, v49
  s_add_u32 s31, s31, 0x100
  v_fma_f32 v39, v49, s37, v48
  v_cndmask_b32 v41, v48, v49, s[38:39]
  s_nop 0
  v_add_f32_dpp v39, v39, v39 quad_perm:[1,0,3,2] row_mask:0xf bank_mask:0xf
  v_cndmask_b32 v40, v49, v48, s[38:39]
  v_mov_b32_dpp v46, v41 quad_perm:[1,0,3,2] row_mask:0xf bank_mask:0xf
  v_add_f32_dpp v39, v39, v39 quad_perm:[2,3,0,1] row_mask:0xf bank_mask:0xf
  v_cndmask_b32 v42, v46, v40, s[38:39]
  v_cndmask_b32 v43, v40, v46, s[38:39]
  v_add_f32_dpp v39, v39, v39 row_half_mirror row_mask:0xf bank_mask:0xf
  s_nop 1
  v_add_f32_dpp v39, v39, v39 row_mirror row_mask:0xf bank_mask:0xf
  v_mov_b32 v47, v39
  s_nop 1
  v_permlane16_swap_b32 v39, v47
  v_add_f32 v39, v39, v47
  v_rcp_f32 v39, v39
  s_mov_b64 exec, s[28:29]
  v_mul_f32 v42, v42, v39
  v_mul_f32 v43, v43, v39
  v_cvt_pk_bf16_f32 v42, v42, v43
  v_min_u32 v42, -2, v42
  s_branch cB_sc2_pst
cB_sc2_retry:
  s_cmp_lg_u32 s62, 0
  s_cbranch_scc1 cB_sc2_cont
  s_waitcnt vmcnt(0) lgkmcnt(0)
cB_sc2_rv:
  buffer_load_dwordx4 v[8:11], v2, s[8:11], s20 offen offset:0 sc1
  buffer_load_dwordx4 v[12:15], v2, s[8:11], s20 offen offset:1024 sc1
  buffer_load_dwordx4 v[16:19], v2, s[8:11], s20 offen offset:2048 sc1
  buffer_load_dwordx4 v[20:23], v2, s[8:11], s20 offen offset:3072 sc1
  buffer_load_dwordx4 v[24:27], v2, s[8:11], s23 offen offset:0 sc1
  buffer_load_dwordx4 v[28:31], v2, s[8:11], s23 offen offset:1024 sc1
  buffer_load_dwordx4 v[32:35], v2, s[8:11], s23 offen offset:2048 sc1
  s_waitcnt vmcnt(0)
  v_max3_u32 v118, v8, v9, v10
  v_max3_u32 v118, v118, v11, v12
  v_max3_u32 v118, v118, v13, v14
  v_max3_u32 v118, v118, v15, v16
  v_max3_u32 v118, v118, v17, v18
  v_max3_u32 v118, v118, v19, v20
  v_max3_u32 v118, v118, v21, v22
  v_max3_u32 v118, v118, v23, v24
  v_max3_u32 v118, v118, v25, v26
  v_max3_u32 v118, v118, v27, v28
  v_max3_u32 v118, v118, v29, v30
  v_max3_u32 v118, v118, v31, v32
  v_max3_u32 v118, v118, v33, v34
  v_max_u32 v118, v118, v35
  v_cmp_eq_u32 vcc, -1, v118
  s_cbranch_vccz cB_sc2_rk
  s_add_u32 s30, s30, 1
  s_cmp_lt_u32 s30, 400000
  s_cbranch_scc1 cB_sc2_rv
  s_branch cB_abort
cB_sc2_rk:
  s_mov_b32 s62, 1
  v_mov_b32 v36, 0
  v_mov_b32 v37, 0
  v_mov_b32 v38, 0
  v_mov_b32 v39, 0
  v_mov_b32 v40, 0
  v_mov_b32 v41, 0
  v_mov_b32 v42, 0
  v_mov_b32 v43, 0
  v_mov_b32 v44, 0
  v_mov_b32 v45, 0
  v_mov_b32 v46, 0
  v_mov_b32 v47, 0
  v_mov_b32 v48, 0
  v_mov_b32 v49, 0
  v_mov_b32 v50, 0
  v_mov_b32 v51, 0
  v_mov_b32 v52, 0
  v_mov_b32 v53, 0
  v_mov_b32 v54, 0
  v_mov_b32 v55, 0
  v_mov_b32 v56, 0
  v_mov_b32 v57, 0
  v_mov_b32 v58, 0
  v_mov_b32 v59, 0
  v_mov_b32 v60, 0
  v_mov_b32 v61, 0
  v_mov_b32 v62, 0
  v_mov_b32 v63, 0
  v_mov_b32 v88, 0
  v_mov_b32 v89, 0
  v_mov_b32 v90, 0
  v_mov_b32 v91, 0
  v_mov_b32 v92, 0
  v_mov_b32 v93, 0
  v_mov_b32 v94, 0
  v_mov_b32 v95, 0
  v_mov_b32 v66, 0
  v_mov_b32 v67, 0
  s_add_u32 s31, s31, 1
  ds_read_b128 v[96:99], v117 offset:0
  ds_read_b128 v[100:103], v117 offset:1024
  ds_read_b128 v[104:107], v117 offset:14336
  ds_read_b128 v[108:111], v117 offset:15360
  v_smfmac_f32_16x16x64_bf16 v[36:39], v[8:11], a[0:7], v3
  v_smfmac_f32_16x16x64_bf16 v[40:43], v[8:11], a[56:63], v3
  v_smfmac_f32_16x16x64_bf16 v[44:47], v[8:11], a[112:119], v3
  v_smfmac_f32_16x16x64_bf16 v[48:51], v[8:11], a[168:175], v3
  v_smfmac_f32_16x16x64_bf16 v[52:55], v[8:11], a[224:231], v3
  v_smfmac_f32_16x16x64_bf16 v[56:59], v[8:11], v[144:151], v3
  v_smfmac_f32_16x16x64_bf16 v[60:63], v[8:11], v[200:207], v3
  v_smfmac_f32_16x16x64_bf16 v[36:39], v[12:15], a[8:15], v3
  v_smfmac_f32_16x16x64_bf16 v[40:43], v[12:15], a[64:71], v3
  v_smfmac_f32_16x16x64_bf16 v[44:47], v[12:15], a[120:127], v3
  v_smfmac_f32_16x16x64_bf16 v[48:51], v[12:15], a[176:183], v3
  v_smfmac_f32_16x16x64_bf16 v[52:55], v[12:15], a[232:239], v3
  v_smfmac_f32_16x16x64_bf16 v[56:59], v[12:15], v[152:159], v3
  v_smfmac_f32_16x16x64_bf16 v[60:63], v[12:15], v[208:215], v3
  v_smfmac_f32_16x16x64_bf16 v[36:39], v[16:19], a[16:23], v3
  v_smfmac_f32_16x16x64_bf16 v[40:43], v[16:19], a[72:79], v3
  v_smfmac_f32_16x16x64_bf16 v[44:47], v[16:19], a[128:135], v3
  v_smfmac_f32_16x16x64_bf16 v[48:51], v[16:19], a[184:191], v3
  v_smfmac_f32_16x16x64_bf16 v[52:55], v[16:19], a[240:247], v3
  v_smfmac_f32_16x16x64_bf16 v[56:59], v[16:19], v[160:167], v3
  v_smfmac_f32_16x16x64_bf16 v[60:63], v[16:19], v[216:223], v3
  v_smfmac_f32_16x16x64_bf16 v[36:39], v[20:23], a[24:31], v3
  v_smfmac_f32_16x16x64_bf16 v[40:43], v[20:23], a[80:87], v3
  v_smfmac_f32_16x16x64_bf16 v[44:47], v[20:23], a[136:143], v3
  v_smfmac_f32_16x16x64_bf16 v[48:51], v[20:23], a[192:199], v3
  v_smfmac_f32_16x16x64_bf16 v[52:55], v[20:23], a[248:255], v3
  v_smfmac_f32_16x16x64_bf16 v[56:59], v[20:23], v[168:175], v3
  v_smfmac_f32_16x16x64_bf16 v[60:63], v[20:23], v[224:231], v3
  s_branch cB_sc2_ph2
.p2align 6

cB_sc3_loop:
  s_add_u32 s23, s20, 4096
  s_add_u32 s21, s20, 25600
  v_mov_b32 v48, 0
  v_mov_b32 v49, 0
  v_mov_b32 v50, 0
  v_mov_b32 v51, 0
  v_mov_b32 v52, 0
  v_mov_b32 v53, 0
  v_mov_b32 v54, 0
  v_mov_b32 v55, 0
  v_mov_b32 v56, 0
  v_mov_b32 v57, 0
  v_mov_b32 v58, 0
  v_mov_b32 v59, 0
  v_mov_b32 v60, 0
  v_mov_b32 v61, 0
  v_mov_b32 v62, 0
  v_mov_b32 v63, 0
  v_mov_b32 v88, 0
  v_mov_b32 v89, 0
  v_mov_b32 v90, 0
  v_mov_b32 v91, 0
  v_mov_b32 v92, 0
  v_mov_b32 v93, 0
  v_mov_b32 v94, 0
  v_mov_b32 v95, 0
  v_mov_b32 v64, 0
  v_mov_b32 v65, 0
  s_mov_b32 s30, 0
  s_mov_b32 s62, 0
  s_waitcnt vmcnt(0)
  s_barrier
cB_sc3_ld:
  buffer_load_dwordx4 v[8:11], v2, s[8:11], s20 offen offset:0 sc1
  v_mov_b32 v36, 0
  v_mov_b32 v37, 0
  v_mov_b32 v38, 0
  v_mov_b32 v39, 0
  buffer_load_dwordx4 v[12:15], v2, s[8:11], s20 offen offset:1024 sc1
  v_mov_b32 v40, 0
  v_mov_b32 v41, 0
  v_mov_b32 v42, 0
  v_mov_b32 v43, 0
  buffer_load_dwordx4 v[16:19], v2, s[8:11], s20 offen offset:2048 sc1
  v_mov_b32 v44, 0
  v_mov_b32 v45, 0
  v_mov_b32 v46, 0
  v_mov_b32 v47, 0
  ds_read_b128 v[96:99], v117 offset:0
  ds_read_b128 v[100:103], v117 offset:1024
  ds_read_b128 v[104:107], v117 offset:14336
  ds_read_b128 v[108:111], v117 offset:15360
  s_waitcnt vmcnt(2)
  v_smfmac_f32_16x16x64_bf16 v[36:39], v[8:11], a[0:7], v3
  v_smfmac_f32_16x16x64_bf16 v[40:43], v[8:11], a[56:63], v3
  buffer_load_dwordx4 v[20:23], v2, s[8:11], s20 offen offset:3072 sc1
  v_smfmac_f32_16x16x64_bf16 v[44:47], v[8:11], a[112:119], v3
  v_smfmac_f32_16x16x64_bf16 v[48:51], v[8:11], a[168:175], v3
  v_smfmac_f32_16x16x64_bf16 v[52:55], v[8:11], a[224:231], v3
  buffer_load_dwordx4 v[24:27], v2, s[8:11], s23 offen offset:0 sc1
  v_smfmac_f32_16x16x64_bf16 v[56:59], v[8:11], v[144:151], v3
  v_smfmac_f32_16x16x64_bf16 v[60:63], v[8:11], v[200:207], v3
  s_waitcnt vmcnt(3)
  v_smfmac_f32_16x16x64_bf16 v[36:39], v[12:15], a[8:15], v3
  v_smfmac_f32_16x16x64_bf16 v[40:43], v[12:15], a[64:71], v3
  buffer_load_dwordx4 v[28:31], v2, s[8:11], s23 offen offset:1024 sc1
  v_smfmac_f32_16x16x64_bf16 v[44:47], v[12:15], a[120:127], v3
  v_smfmac_f32_16x16x64_bf16 v[48:51], v[12:15], a[176:183], v3
  v_smfmac_f32_16x16x64_bf16 v[52:55], v[12:15], a[232:239], v3
  buffer_load_dwordx4 v[32:35], v2, s[8:11], s23 offen offset:2048 sc1
  v_smfmac_f32_16x16x64_bf16 v[56:59], v[12:15], v[152:159], v3
  v_smfmac_f32_16x16x64_bf16 v[60:63], v[12:15], v[208:215], v3
  s_waitcnt vmcnt(4)
  v_smfmac_f32_16x16x64_bf16 v[36:39], v[16:19], a[16:23], v3
  v_smfmac_f32_16x16x64_bf16 v[40:43], v[16:19], a[72:79], v3
  v_smfmac_f32_16x16x64_bf16 v[44:47], v[16:19], a[128:135], v3
  v_smfmac_f32_16x16x64_bf16 v[48:51], v[16:19], a[184:191], v3
  v_smfmac_f32_16x16x64_bf16 v[52:55], v[16:19], a[240:247], v3
  v_smfmac_f32_16x16x64_bf16 v[56:59], v[16:19], v[160:167], v3
  v_smfmac_f32_16x16x64_bf16 v[60:63], v[16:19], v[216:223], v3
  s_waitcnt vmcnt(3)
  v_smfmac_f32_16x16x64_bf16 v[36:39], v[20:23], a[24:31], v3
  v_smfmac_f32_16x16x64_bf16 v[40:43], v[20:23], a[80:87], v3
  v_smfmac_f32_16x16x64_bf16 v[44:47], v[20:23], a[136:143], v3
  v_smfmac_f32_16x16x64_bf16 v[48:51], v[20:23], a[192:199], v3
  v_smfmac_f32_16x16x64_bf16 v[52:55], v[20:23], a[248:255], v3
  v_smfmac_f32_16x16x64_bf16 v[56:59], v[20:23], v[168:175], v3
  v_smfmac_f32_16x16x64_bf16 v[60:63], v[20:23], v[224:231], v3
  s_waitcnt vmcnt(0)
cB_sc3_ph2:
  v_smfmac_f32_16x16x64_bf16 v[60:63], v[24:27], v[232:239], v3
  ds_read_b128 v[8:11], v116 offset:6144
  ds_read_b128 v[12:15], v116 offset:7168
  v_smfmac_f32_16x16x64_bf16 v[60:63], v[28:31], v[240:247], v3
  v_smfmac_f32_16x16x64_bf16 v[60:63], v[32:35], v[248:255], v3
  v_mov_b32 v80, v30
  v_smfmac_f32_16x16x64_bf16 v[52:55], v[24:27], v[120:127], v3
  v_mov_b32 v81, v31
  v_smfmac_f32_16x16x64_bf16 v[52:55], v[28:31], v[128:135], v3
  v_mov_b32 v82, v34
  v_smfmac_f32_16x16x64_bf16 v[52:55], v[32:35], v[136:143], v3
  v_cvt_pk_bf16_f32 v66, v60, v61
  v_smfmac_f32_16x16x64_bf16 v[56:59], v[24:27], v[176:183], v3
  v_cvt_pk_bf16_f32 v67, v62, v63
  v_smfmac_f32_16x16x64_bf16 v[56:59], v[28:31], v[184:191], v3
  v_mov_b32 v83, v35
  v_mfma_f32_16x16x32_bf16 v[68:71], v[64:67], v[4:7], 0
  v_smfmac_f32_16x16x64_bf16 v[56:59], v[32:35], v[192:199], v3
  v_cvt_pk_bf16_f32 v64, v52, v53
  v_smfmac_f32_16x16x64_bf16 v[36:39], v[24:27], a[32:39], v3
  v_cvt_pk_bf16_f32 v65, v54, v55
  v_smfmac_f32_16x16x64_bf16 v[36:39], v[28:31], a[40:47], v3
  v_cvt_pk_bf16_f32 v78, v68, v69
  v_smfmac_f32_16x16x64_bf16 v[36:39], v[32:35], a[48:55], v3
  v_cvt_pk_bf16_f32 v79, v70, v71
  v_cvt_pk_bf16_f32 v66, v56, v57
  v_smfmac_f32_16x16x64_bf16 v[40:43], v[24:27], a[88:95], v3
  v_cvt_pk_bf16_f32 v67, v58, v59
  v_smfmac_f32_16x16x64_bf16 v[40:43], v[28:31], a[96:103], v3
  v_mfma_f32_16x16x32_bf16 v[72:75], v[64:67], v[4:7], 0
  ds_read_b128 v[52:55], v116 offset:20480
  ds_read_b128 v[56:59], v116 offset:21504
  v_smfmac_f32_16x16x64_bf16 v[40:43], v[32:35], a[104:111], v3
  v_cvt_pk_bf16_f32 v64, v36, v37
  v_smfmac_f32_16x16x64_bf16 v[44:47], v[24:27], a[144:151], v3
  v_cvt_pk_bf16_f32 v65, v38, v39
  v_smfmac_f32_16x16x64_bf16 v[44:47], v[28:31], a[152:159], v3
  v_cvt_pk_bf16_f32 v76, v72, v73
  v_smfmac_f32_16x16x64_bf16 v[44:47], v[32:35], a[160:167], v3
  v_cvt_pk_bf16_f32 v77, v74, v75
  v_cvt_pk_bf16_f32 v66, v40, v41
  v_smfmac_f32_16x16x64_bf16 v[48:51], v[24:27], a[200:207], v3
  v_cvt_pk_bf16_f32 v67, v42, v43
  v_smfmac_f32_16x16x64_bf16 v[48:51], v[28:31], a[208:215], v3
  v_mfma_f32_16x16x32_bf16 v[68:71], v[64:67], v[4:7], 0
  v_smfmac_f32_16x16x64_bf16 v[48:51], v[32:35], a[216:223], v3
  v_cvt_pk_bf16_f32 v64, v44, v45
  v_mfma_f32_16x16x32_bf16 v[84:87], v[80:83], v[76:79], 0
  v_cvt_pk_bf16_f32 v65, v46, v47
  s_waitcnt lgkmcnt(0)
  v_smfmac_f32_16x16x64_bf16 v[88:91], v[76:79], v[96:103], v3
  v_cvt_pk_bf16_f32 v60, v68, v69
  v_cvt_pk_bf16_f32 v61, v70, v71
  v_cvt_pk_bf16_f32 v66, v48, v49
  v_cvt_pk_bf16_f32 v67, v50, v51
  s_nop 1
  v_mfma_f32_16x16x32_bf16 v[72:75], v[64:67], v[4:7], 0
  v_smfmac_f32_16x16x64_bf16 v[92:95], v[76:79], v[104:111], v3
  s_nop 4
  v_cvt_pk_bf16_f32 v62, v72, v73
  v_cvt_pk_bf16_f32 v63, v74, v75
  s_nop 1
  v_mfma_f32_16x16x32_bf16 v[84:87], v[20:23], v[60:63], v[84:87]
  v_smfmac_f32_16x16x64_bf16 v[88:91], v[60:63], v[8:15], v3
  v_smfmac_f32_16x16x64_bf16 v[92:95], v[60:63], v[52:59], v3
  s_mov_b64 exec, s[26:27]
  s_nop 0
  ds_write_b128 v113, v[84:87]
  s_mov_b64 exec, -1
  s_nop 0
  v_cmp_u_f32 vcc, v88, v89
  s_nop 1
  v_permlane32_swap_b32 v88, v92
  v_permlane32_swap_b32 v89, v93
  v_permlane32_swap_b32 v90, v94
  v_permlane32_swap_b32 v91, v95
  v_add_f32 v88, v88, v92
  v_add_f32 v89, v89, v93
  v_add_f32 v90, v90, v94
  v_add_f32 v91, v91, v95
  ds_write_b128 v112, v[88:91]
  s_cbranch_vccnz cB_sc3_retry
cB_sc3_cont:
  s_waitcnt lgkmcnt(0)
  s_barrier
  ds_read_b64 v[36:37], v114 offset:0
  ds_read_b64 v[38:39], v114 offset:1024
  ds_read2_b32 v[44:45], v115 offset0:0 offset1:64
  s_waitcnt lgkmcnt(0)
  v_add_f32 v44, v44, v45
  v_add_f32 v36, v36, v38
  v_add_f32 v37, v37, v39
  v_add_f32_dpp v44, v44, v44 row_ror:8 row_mask:0xf bank_mask:0xf
  v_mov_b32 v45, v44
  v_permlane32_swap_b32 v36, v37
  v_add_f32 v36, v36, v37
  v_permlane16_swap_b32 v44, v45
  v_add_f32 v44, v44, v45
  v_exp_f32 v48, v36
  v_exp_f32 v49, v44
  v_add_f32 v50, abs(v36), abs(v44)
  v_fma_f32 v39, v49, s37, v48
  v_cmp_ngt_f32 vcc, s56, v50
  v_cndmask_b32 v41, v48, v49, s[38:39]
  v_add_f32_dpp v39, v39, v39 quad_perm:[1,0,3,2] row_mask:0xf bank_mask:0xf
  v_cndmask_b32 v40, v49, v48, s[38:39]
  v_mov_b32_dpp v46, v41 quad_perm:[1,0,3,2] row_mask:0xf bank_mask:0xf
  v_add_f32_dpp v39, v39, v39 quad_perm:[2,3,0,1] row_mask:0xf bank_mask:0xf
  v_cndmask_b32 v42, v46, v40, s[38:39]
  v_cndmask_b32 v43, v40, v46, s[38:39]
  v_add_f32_dpp v39, v39, v39 row_half_mirror row_mask:0xf bank_mask:0xf
  s_cbranch_vccnz cB_sc3_slow
  s_nop 0
  v_add_f32_dpp v39, v39, v39 row_mirror row_mask:0xf bank_mask:0xf
  v_mov_b32 v47, v39
  s_nop 1
  v_permlane16_swap_b32 v39, v47
  v_add_f32 v39, v39, v47
  v_rcp_f32 v39, v39
  s_mov_b64 exec, s[28:29]
  v_mul_f32 v42, v42, v39
  v_mul_f32 v43, v43, v39
  v_cvt_pk_bf16_f32 v42, v42, v43
cB_sc3_pst:
  buffer_store_dword v42, v1, s[8:11], s20 offen sc1
  s_mov_b64 exec, -1
  s_barrier
  s_add_u32 s24, s24, 28672
  s_add_u32 s35, s35, 28672
  s_xor_b32 s25, s25, 28672
  s_add_u32 m0, s25, 21504
  s_nop 0
  buffer_load_dwordx4 v2, s[8:11], s24 offen offset:0 sc1 lds
  buffer_load_dwordx4 v2, s[8:11], s24 offen offset:1024 sc1 lds
  buffer_load_dwordx4 v2, s[8:11], s24 offen offset:2048 sc1 lds
  buffer_load_dwordx4 v2, s[8:11], s24 offen offset:3072 sc1 lds
  s_add_u32 m0, s25, 25600
  s_add_u32 s22, s24, 4096
  buffer_load_dwordx4 v2, s[8:11], s22 offen offset:0 sc1 lds
  buffer_load_dwordx4 v2, s[8:11], s22 offen offset:1024 sc1 lds
  buffer_load_dwordx4 v2, s[8:11], s22 offen offset:2048 sc1 lds
  v_xor_b32 v116, 28672, v116
  v_add_u32 v117, s57, v117
  s_sub_u32 s57, 0, s57
  s_add_u32 s19, s19, 1
  s_mov_b32 s20, s21
  s_cmp_lt_u32 s19, 63
  s_cbranch_scc1 cB_sc3_loop
  s_branch cB_done
cB_sc3_slow:
  v_max_f32 v50, v36, v44
  s_nop 1
  v_max_f32_dpp v50, v50, v50 quad_perm:[1,0,3,2] row_mask:0xf bank_mask:0xf
  s_nop 1
  v_max_f32_dpp v50, v50, v50 quad_perm:[2,3,0,1] row_mask:0xf bank_mask:0xf
  s_nop 1
  v_max_f32_dpp v50, v50, v50 row_half_mirror row_mask:0xf bank_mask:0xf
  s_nop 1
  v_max_f32_dpp v50, v50, v50 row_mirror row_mask:0xf bank_mask:0xf
  v_mov_b32 v47, v50
  s_nop 1
  v_permlane16_swap_b32 v50, v47
  v_max_f32 v50, v50, v47
  v_sub_f32 v48, v36, v50
  v_sub_f32 v49, v44, v50
  v_exp_f32 v48, v48
  v_exp_f32 v49, v49
  s_add_u32 s31, s31, 0x100
  v_fma_f32 v39, v49, s37, v48
  v_cndmask_b32 v41, v48, v49, s[38:39]
  s_nop 0
  v_add_f32_dpp v39, v39, v39 quad_perm:[1,0,3,2] row_mask:0xf bank_mask:0xf
  v_cndmask_b32 v40, v49, v48, s[38:39]
  v_mov_b32_dpp v46, v41 quad_perm:[1,0,3,2] row_mask:0xf bank_mask:0xf
  v_add_f32_dpp v39, v39, v39 quad_perm:[2,3,0,1] row_mask:0xf bank_mask:0xf
  v_cndmask_b32 v42, v46, v40, s[38:39]
  v_cndmask_b32 v43, v40, v46, s[38:39]
  v_add_f32_dpp v39, v39, v39 row_half_mirror row_mask:0xf bank_mask:0xf
  s_nop 1
  v_add_f32_dpp v39, v39, v39 row_mirror row_mask:0xf bank_mask:0xf
  v_mov_b32 v47, v39
  s_nop 1
  v_permlane16_swap_b32 v39, v47
  v_add_f32 v39, v39, v47
  v_rcp_f32 v39, v39
  s_mov_b64 exec, s[28:29]
  v_mul_f32 v42, v42, v39
  v_mul_f32 v43, v43, v39
  v_cvt_pk_bf16_f32 v42, v42, v43
  v_min_u32 v42, -2, v42
  s_branch cB_sc3_pst
cB_sc3_retry:
  s_cmp_lg_u32 s62, 0
  s_cbranch_scc1 cB_sc3_cont
  s_waitcnt vmcnt(0) lgkmcnt(0)
cB_sc3_rv:
  buffer_load_dwordx4 v[8:11], v2, s[8:11], s20 offen offset:0 sc1
  buffer_load_dwordx4 v[12:15], v2, s[8:11], s20 offen offset:1024 sc1
  buffer_load_dwordx4 v[16:19], v2, s[8:11], s20 offen offset:2048 sc1
  buffer_load_dwordx4 v[20:23], v2, s[8:11], s20 offen offset:3072 sc1
  buffer_load_dwordx4 v[24:27], v2, s[8:11], s23 offen offset:0 sc1
  buffer_load_dwordx4 v[28:31], v2, s[8:11], s23 offen offset:1024 sc1
  buffer_load_dwordx4 v[32:35], v2, s[8:11], s23 offen offset:2048 sc1
  s_waitcnt vmcnt(0)
  v_max3_u32 v118, v8, v9, v10
  v_max3_u32 v118, v118, v11, v12
  v_max3_u32 v118, v118, v13, v14
  v_max3_u32 v118, v118, v15, v16
  v_max3_u32 v118, v118, v17, v18
  v_max3_u32 v118, v118, v19, v20
  v_max3_u32 v118, v118, v21, v22
  v_max3_u32 v118, v118, v23, v24
  v_max3_u32 v118, v118, v25, v26
  v_max3_u32 v118, v118, v27, v28
  v_max3_u32 v118, v118, v29, v30
  v_max3_u32 v118, v118, v31, v32
  v_max3_u32 v118, v118, v33, v34
  v_max_u32 v118, v118, v35
  v_cmp_eq_u32 vcc, -1, v118
  s_cbranch_vccz cB_sc3_rk
  s_add_u32 s30, s30, 1
  s_cmp_lt_u32 s30, 400000
  s_cbranch_scc1 cB_sc3_rv
  s_branch cB_abort
cB_sc3_rk:
  s_mov_b32 s62, 1
  v_mov_b32 v36, 0
  v_mov_b32 v37, 0
  v_mov_b32 v38, 0
  v_mov_b32 v39, 0
  v_mov_b32 v40, 0
  v_mov_b32 v41, 0
  v_mov_b32 v42, 0
  v_mov_b32 v43, 0
  v_mov_b32 v44, 0
  v_mov_b32 v45, 0
  v_mov_b32 v46, 0
  v_mov_b32 v47, 0
  v_mov_b32 v48, 0
  v_mov_b32 v49, 0
  v_mov_b32 v50, 0
  v_mov_b32 v51, 0
  v_mov_b32 v52, 0
  v_mov_b32 v53, 0
  v_mov_b32 v54, 0
  v_mov_b32 v55, 0
  v_mov_b32 v56, 0
  v_mov_b32 v57, 0
  v_mov_b32 v58, 0
  v_mov_b32 v59, 0
  v_mov_b32 v60, 0
  v_mov_b32 v61, 0
  v_mov_b32 v62, 0
  v_mov_b32 v63, 0
  v_mov_b32 v88, 0
  v_mov_b32 v89, 0
  v_mov_b32 v90, 0
  v_mov_b32 v91, 0
  v_mov_b32 v92, 0
  v_mov_b32 v93, 0
  v_mov_b32 v94, 0
  v_mov_b32 v95, 0
  v_mov_b32 v64, 0
  v_mov_b32 v65, 0
  s_add_u32 s31, s31, 1
  ds_read_b128 v[96:99], v117 offset:0
  ds_read_b128 v[100:103], v117 offset:1024
  ds_read_b128 v[104:107], v117 offset:14336
  ds_read_b128 v[108:111], v117 offset:15360
  v_smfmac_f32_16x16x64_bf16 v[36:39], v[8:11], a[0:7], v3
  v_smfmac_f32_16x16x64_bf16 v[40:43], v[8:11], a[56:63], v3
  v_smfmac_f32_16x16x64_bf16 v[44:47], v[8:11], a[112:119], v3
  v_smfmac_f32_16x16x64_bf16 v[48:51], v[8:11], a[168:175], v3
  v_smfmac_f32_16x16x64_bf16 v[52:55], v[8:11], a[224:231], v3
  v_smfmac_f32_16x16x64_bf16 v[56:59], v[8:11], v[144:151], v3
  v_smfmac_f32_16x16x64_bf16 v[60:63], v[8:11], v[200:207], v3
  v_smfmac_f32_16x16x64_bf16 v[36:39], v[12:15], a[8:15], v3
  v_smfmac_f32_16x16x64_bf16 v[40:43], v[12:15], a[64:71], v3
  v_smfmac_f32_16x16x64_bf16 v[44:47], v[12:15], a[120:127], v3
  v_smfmac_f32_16x16x64_bf16 v[48:51], v[12:15], a[176:183], v3
  v_smfmac_f32_16x16x64_bf16 v[52:55], v[12:15], a[232:239], v3
  v_smfmac_f32_16x16x64_bf16 v[56:59], v[12:15], v[152:159], v3
  v_smfmac_f32_16x16x64_bf16 v[60:63], v[12:15], v[208:215], v3
  v_smfmac_f32_16x16x64_bf16 v[36:39], v[16:19], a[16:23], v3
  v_smfmac_f32_16x16x64_bf16 v[40:43], v[16:19], a[72:79], v3
  v_smfmac_f32_16x16x64_bf16 v[44:47], v[16:19], a[128:135], v3
  v_smfmac_f32_16x16x64_bf16 v[48:51], v[16:19], a[184:191], v3
  v_smfmac_f32_16x16x64_bf16 v[52:55], v[16:19], a[240:247], v3
  v_smfmac_f32_16x16x64_bf16 v[56:59], v[16:19], v[160:167], v3
  v_smfmac_f32_16x16x64_bf16 v[60:63], v[16:19], v[216:223], v3
  v_smfmac_f32_16x16x64_bf16 v[36:39], v[20:23], a[24:31], v3
  v_smfmac_f32_16x16x64_bf16 v[40:43], v[20:23], a[80:87], v3
  v_smfmac_f32_16x16x64_bf16 v[44:47], v[20:23], a[136:143], v3
  v_smfmac_f32_16x16x64_bf16 v[48:51], v[20:23], a[192:199], v3
  v_smfmac_f32_16x16x64_bf16 v[52:55], v[20:23], a[248:255], v3
  v_smfmac_f32_16x16x64_bf16 v[56:59], v[20:23], v[168:175], v3
  v_smfmac_f32_16x16x64_bf16 v[60:63], v[20:23], v[224:231], v3
  s_branch cB_sc3_ph2
.p2align 6

cB_va0_loop:
  s_add_u32 s23, s20, 4096
  s_add_u32 s21, s20, 25600
  s_mov_b32 s30, 0
  s_cmp_lg_u32 s19, s38
  s_cbranch_scc1 cB_va0_vok
  s_branch cB_va0_voc
cB_va0_vow:
  buffer_load_dword v175, off, s[8:11], s35 sc1
  s_waitcnt vmcnt(0)
cB_va0_voc:
  v_readfirstlane_b32 s22, v175
  s_cmp_eq_u32 s22, 56
  s_cbranch_scc1 cB_va0_vod
  s_sleep 1
  s_add_u32 s30, s30, 1
  s_cmp_lt_u32 s30, 400000
  s_cbranch_scc1 cB_va0_vow
  s_branch cB_abort
cB_va0_vod:
  s_add_u32 s35, s35, 2048
  s_add_u32 s38, s19, 8
  s_and_b32 s38, s38, -8
  s_cmp_eq_u32 s19, 0
  s_cselect_b32 s38, 4, s38
cB_va0_vok:
  s_cmp_eq_u32 s19, 63
  s_cbranch_scc1 cB_done
  s_barrier
  s_add_u32 s22, s25, 0
  buffer_load_dwordx4 v[80:83], v6, s[8:11], s22 offen offset:0 sc1
  buffer_load_dwordx4 v[84:87], v6, s[8:11], s22 offen offset:1792 sc1
  s_add_u32 s22, s25, 3584
  buffer_load_dwordx4 v[88:91], v6, s[8:11], s22 offen offset:0 sc1
  buffer_load_dwordx4 v[92:95], v6, s[8:11], s22 offen offset:1792 sc1
  s_add_u32 s22, s25, 7168
  buffer_load_dwordx4 v[96:99], v6, s[8:11], s22 offen offset:0 sc1
  buffer_load_dwordx4 v[100:103], v6, s[8:11], s22 offen offset:1792 sc1
  s_add_u32 s22, s25, 10752
  buffer_load_dwordx4 v[104:107], v6, s[8:11], s22 offen offset:0 sc1
  buffer_load_dwordx4 v[108:111], v6, s[8:11], s22 offen offset:1792 sc1
  s_add_u32 s22, s25, 14336
  buffer_load_dwordx4 v[112:115], v6, s[8:11], s22 offen offset:0 sc1
  buffer_load_dwordx4 v[116:119], v6, s[8:11], s22 offen offset:1792 sc1
  s_add_u32 s22, s25, 17920
  buffer_load_dwordx4 v[120:123], v6, s[8:11], s22 offen offset:0 sc1
  buffer_load_dwordx4 v[124:127], v6, s[8:11], s22 offen offset:1792 sc1
  s_add_u32 s22, s25, 21504
  buffer_load_dwordx4 v[128:131], v6, s[8:11], s22 offen offset:0 sc1
  buffer_load_dwordx4 v[132:135], v6, s[8:11], s22 offen offset:1792 sc1
  s_add_u32 s22, s25, 25088
  buffer_load_dwordx4 v[136:139], v6, s[8:11], s22 offen offset:0 sc1
  buffer_load_dwordx4 v[140:143], v6, s[8:11], s22 offen offset:1792 sc1
  buffer_load_dword v175, off, s[8:11], s35 sc1
  s_barrier
  ds_read_b128 v[8:11], v2 offset:8192
  ds_read_b128 v[12:15], v2 offset:9216
  ds_read_b128 v[16:19], v2 offset:10240
  ds_read_b128 v[20:23], v2 offset:11264
  ds_read_b128 v[24:27], v2 offset:12288
  ds_read_b128 v[28:31], v2 offset:13312
  ds_read_b128 v[32:35], v2 offset:14336
  s_waitcnt lgkmcnt(0)
  v_smfmac_f32_16x16x64_bf16 v[36:39], v[8:11], a[0:7], v3
  v_smfmac_f32_16x16x64_bf16 v[36:39], v[12:15], a[8:15], v3
  v_smfmac_f32_16x16x64_bf16 v[36:39], v[16:19], a[16:23], v3
  v_smfmac_f32_16x16x64_bf16 v[36:39], v[20:23], a[24:31], v3
  v_smfmac_f32_16x16x64_bf16 v[36:39], v[24:27], a[32:39], v3
  v_smfmac_f32_16x16x64_bf16 v[36:39], v[28:31], a[40:47], v3
  v_smfmac_f32_16x16x64_bf16 v[36:39], v[32:35], a[48:55], v3
  v_smfmac_f32_16x16x64_bf16 v[40:43], v[8:11], a[56:63], v3
  v_smfmac_f32_16x16x64_bf16 v[40:43], v[12:15], a[64:71], v3
  v_smfmac_f32_16x16x64_bf16 v[40:43], v[16:19], a[72:79], v3
  v_smfmac_f32_16x16x64_bf16 v[40:43], v[20:23], a[80:87], v3
  v_smfmac_f32_16x16x64_bf16 v[40:43], v[24:27], a[88:95], v3
  v_smfmac_f32_16x16x64_bf16 v[40:43], v[28:31], a[96:103], v3
  v_smfmac_f32_16x16x64_bf16 v[40:43], v[32:35], a[104:111], v3
  v_smfmac_f32_16x16x64_bf16 v[44:47], v[8:11], a[112:119], v3
  v_smfmac_f32_16x16x64_bf16 v[44:47], v[12:15], a[120:127], v3
  v_smfmac_f32_16x16x64_bf16 v[44:47], v[16:19], a[128:135], v3
  v_smfmac_f32_16x16x64_bf16 v[44:47], v[20:23], a[136:143], v3
  v_permlane32_swap_b32 v36, v40
  v_smfmac_f32_16x16x64_bf16 v[44:47], v[24:27], a[144:151], v3
  v_permlane32_swap_b32 v37, v41
  v_smfmac_f32_16x16x64_bf16 v[44:47], v[28:31], a[152:159], v3
  v_permlane32_swap_b32 v38, v42
  v_smfmac_f32_16x16x64_bf16 v[44:47], v[32:35], a[160:167], v3
  v_permlane32_swap_b32 v39, v43
  v_smfmac_f32_16x16x64_bf16 v[48:51], v[8:11], a[168:175], v3
  v_add_f32 v36, v36, v40
  v_smfmac_f32_16x16x64_bf16 v[48:51], v[12:15], a[176:183], v3
  v_add_f32 v37, v37, v41
  v_smfmac_f32_16x16x64_bf16 v[48:51], v[16:19], a[184:191], v3
  v_add_f32 v38, v38, v42
  v_smfmac_f32_16x16x64_bf16 v[48:51], v[20:23], a[192:199], v3
  v_add_f32 v39, v39, v43
  v_smfmac_f32_16x16x64_bf16 v[48:51], v[24:27], a[200:207], v3
  v_cvt_pk_bf16_f32 v40, v36, v37
  v_smfmac_f32_16x16x64_bf16 v[48:51], v[28:31], a[208:215], v3
  v_cvt_pk_bf16_f32 v41, v38, v39
  v_smfmac_f32_16x16x64_bf16 v[48:51], v[32:35], a[216:223], v3
  ds_write_b64 v60, v[40:41]
  v_smfmac_f32_16x16x64_bf16 v[52:55], v[8:11], a[224:231], v3
  v_smfmac_f32_16x16x64_bf16 v[52:55], v[12:15], a[232:239], v3
  v_smfmac_f32_16x16x64_bf16 v[52:55], v[16:19], a[240:247], v3
  v_smfmac_f32_16x16x64_bf16 v[52:55], v[20:23], a[248:255], v3
  v_permlane32_swap_b32 v44, v48
  v_smfmac_f32_16x16x64_bf16 v[52:55], v[24:27], v[176:183], v3
  v_permlane32_swap_b32 v45, v49
  v_smfmac_f32_16x16x64_bf16 v[52:55], v[28:31], v[184:191], v3
  v_permlane32_swap_b32 v46, v50
  v_smfmac_f32_16x16x64_bf16 v[52:55], v[32:35], v[192:199], v3
  v_permlane32_swap_b32 v47, v51
  v_smfmac_f32_16x16x64_bf16 v[56:59], v[8:11], v[200:207], v3
  v_add_f32 v44, v44, v48
  v_smfmac_f32_16x16x64_bf16 v[56:59], v[12:15], v[208:215], v3
  v_add_f32 v45, v45, v49
  v_smfmac_f32_16x16x64_bf16 v[56:59], v[16:19], v[216:223], v3
  v_add_f32 v46, v46, v50
  v_smfmac_f32_16x16x64_bf16 v[56:59], v[20:23], v[224:231], v3
  v_add_f32 v47, v47, v51
  v_smfmac_f32_16x16x64_bf16 v[56:59], v[24:27], v[232:239], v3
  v_cvt_pk_bf16_f32 v48, v44, v45
  v_smfmac_f32_16x16x64_bf16 v[56:59], v[28:31], v[240:247], v3
  v_cvt_pk_bf16_f32 v49, v46, v47
  v_smfmac_f32_16x16x64_bf16 v[56:59], v[32:35], v[248:255], v3
  ds_write_b64 v61, v[48:49]
  s_nop 6
  v_permlane32_swap_b32 v52, v56
  v_permlane32_swap_b32 v53, v57
  v_permlane32_swap_b32 v54, v58
  v_permlane32_swap_b32 v55, v59
  v_add_f32 v52, v52, v56
  v_add_f32 v53, v53, v57
  v_add_f32 v54, v54, v58
  v_add_f32 v55, v55, v59
  v_cvt_pk_bf16_f32 v56, v52, v53
  v_cvt_pk_bf16_f32 v57, v54, v55
  ds_write_b64 v62, v[56:57]
  s_cmp_eq_u32 s19, 63
  s_cbranch_scc1 cB_va0_last
  s_add_u32 s22, s20, 9216
  s_add_u32 s34, s20, 13312
  s_add_u32 s36, s20, 7168
  s_mov_b32 s37, 0
  v_mov_b32 v156, 0
  v_mov_b32 v157, 0
  v_mov_b32 v158, 0
  v_mov_b32 v159, 0
  buffer_load_dword v164, v4, s[8:11], s20 offen sc1
  s_nop 7
  buffer_load_dword v165, v4, s[8:11], s20 offen sc1
  s_nop 7
  buffer_load_dword v166, v4, s[8:11], s20 offen sc1
  s_nop 7
  buffer_load_dword v167, v4, s[8:11], s20 offen sc1
  s_nop 7
  buffer_load_dword v168, v4, s[8:11], s20 offen sc1
cB_va0_fw_l:
  s_waitcnt vmcnt(4)
  v_cmp_eq_u32 vcc, -1, v164
  s_cbranch_vccz cB_va0_fw_d
  buffer_load_dword v164, v4, s[8:11], s20 offen sc1
  s_waitcnt vmcnt(4)
  v_cmp_eq_u32 vcc, -1, v165
  s_cbranch_vccz cB_va0_fw_d
  buffer_load_dword v165, v4, s[8:11], s20 offen sc1
  s_waitcnt vmcnt(4)
  v_cmp_eq_u32 vcc, -1, v166
  s_cbranch_vccz cB_va0_fw_d
  buffer_load_dword v166, v4, s[8:11], s20 offen sc1
  s_waitcnt vmcnt(4)
  v_cmp_eq_u32 vcc, -1, v167
  s_cbranch_vccz cB_va0_fw_d
  buffer_load_dword v167, v4, s[8:11], s20 offen sc1
  s_waitcnt vmcnt(4)
  v_cmp_eq_u32 vcc, -1, v168
  s_cbranch_vccz cB_va0_fw_d
  buffer_load_dword v168, v4, s[8:11], s20 offen sc1
  s_add_u32 s30, s30, 1
  s_cmp_lt_u32 s30, 400000
  s_cbranch_scc1 cB_va0_fw_l
  s_branch cB_abort
cB_va0_fw_d:
  s_waitcnt lgkmcnt(0)
  buffer_load_dwordx4 v[8:11], v2, s[8:11], s22 offen offset:0 sc1
  v_mov_b32 v36, 0
  v_mov_b32 v37, 0
  v_mov_b32 v38, 0
  buffer_load_dwordx4 v[12:15], v2, s[8:11], s22 offen offset:1024 sc1
  v_mov_b32 v39, 0
  v_mov_b32 v40, 0
  v_mov_b32 v41, 0
  buffer_load_dwordx4 v[16:19], v2, s[8:11], s22 offen offset:2048 sc1
  v_mov_b32 v42, 0
  v_mov_b32 v43, 0
  v_mov_b32 v44, 0
  buffer_load_dwordx4 v[20:23], v2, s[8:11], s22 offen offset:3072 sc1
  v_mov_b32 v45, 0
  v_mov_b32 v46, 0
  v_mov_b32 v47, 0
  buffer_load_dwordx4 v[24:27], v2, s[8:11], s34 offen offset:0 sc1
  v_mov_b32 v48, 0
  v_mov_b32 v49, 0
  v_mov_b32 v50, 0
  buffer_load_dwordx4 v[28:31], v2, s[8:11], s34 offen offset:1024 sc1
  v_mov_b32 v51, 0
  v_mov_b32 v52, 0
  v_mov_b32 v53, 0
  buffer_load_dwordx4 v[32:35], v2, s[8:11], s34 offen offset:2048 sc1
  v_mov_b32 v54, 0
  v_mov_b32 v55, 0
  v_mov_b32 v56, 0
  buffer_load_dwordx4 v[144:147], v2, s[8:11], s34 offen offset:3072 sc1
  v_mov_b32 v57, 0
  v_mov_b32 v58, 0
  v_mov_b32 v59, 0
  buffer_load_dwordx4 v[148:151], v2, s[8:11], s36 offen offset:0 sc1
  buffer_load_dwordx4 v[152:155], v2, s[8:11], s36 offen offset:1024 sc1
  s_barrier
  ds_read_b128 v[64:67], v2 offset:0
  ds_read_b128 v[68:71], v2 offset:1024
  ds_read_b128 v[72:75], v2 offset:2048
  ds_read_b128 v[76:79], v2 offset:3072
  s_waitcnt vmcnt(9)
  v_smfmac_f32_16x16x64_bf16 v[156:159], v[8:11], v[80:87], v3
  s_waitcnt vmcnt(8)
  v_smfmac_f32_16x16x64_bf16 v[156:159], v[12:15], v[88:95], v3
  s_waitcnt vmcnt(7)
  v_smfmac_f32_16x16x64_bf16 v[156:159], v[16:19], v[96:103], v3
  s_waitcnt vmcnt(6)
  v_smfmac_f32_16x16x64_bf16 v[156:159], v[20:23], v[104:111], v3
  s_waitcnt vmcnt(5)
  v_smfmac_f32_16x16x64_bf16 v[156:159], v[24:27], v[112:119], v3
  s_mov_b32 exec_hi, 0
  buffer_store_dword v2, v7, s[8:11], s21 offen sc1
  s_mov_b64 exec, -1
  s_waitcnt vmcnt(5)
  v_smfmac_f32_16x16x64_bf16 v[156:159], v[28:31], v[120:127], v3
  s_waitcnt vmcnt(4)
  v_smfmac_f32_16x16x64_bf16 v[156:159], v[32:35], v[128:135], v3
  s_waitcnt vmcnt(3)
  v_smfmac_f32_16x16x64_bf16 v[156:159], v[144:147], v[136:143], v3
  s_waitcnt vmcnt(2) lgkmcnt(0)
  v_smfmac_f32_16x16x64_bf16 v[156:159], v[148:151], v[64:71], v3
  s_waitcnt vmcnt(1)
  v_smfmac_f32_16x16x64_bf16 v[156:159], v[152:155], v[72:79], v3
cB_va0_ep:
  s_nop 7
  v_permlane32_swap_b32 v156, v158
  v_permlane32_swap_b32 v157, v159
  v_add_f32 v160, v156, v158
  v_add_f32 v161, v157, v159
  v_cmp_u_f32 vcc, v160, v161
  v_mov_b32_dpp v162, v160 row_ror:8 row_mask:0xf bank_mask:0xf
  v_mov_b32_dpp v160, v161 row_ror:8 row_mask:0xf bank_mask:0xc
  s_cbranch_vccnz cB_va0_rp
  v_mov_b32_dpp v161, v162 quad_perm:[0,1,2,3] row_mask:0xf bank_mask:0x3
  v_cvt_pk_bf16_f32 v160, v160, v161
cB_va0_pc:
  buffer_store_dword v160, v1, s[8:11], s21 offen sc1
  s_cmp_lg_u32 s19, 62
  s_cbranch_scc1 cB_va0_nl
  s_mov_b32 s22, 88519680
  buffer_store_dword v160, v1, s[8:11], s22 offen sc1
  s_mov_b64 exec, -1
  s_branch cB_done
cB_va0_nl:
  s_mov_b64 exec, -1
  s_add_u32 s25, s25, 28672
  s_add_u32 s19, s19, 1
  s_mov_b32 s20, s21
  s_branch cB_va0_loop
cB_va0_last:
  s_waitcnt lgkmcnt(0)
  s_barrier
  s_branch cB_done
cB_va0_rp:
  s_cmp_eq_u32 s37, 0
  s_cbranch_scc1 cB_va0_rv
  v_mov_b32_dpp v161, v162 quad_perm:[0,1,2,3] row_mask:0xf bank_mask:0x3
  v_cvt_pk_bf16_f32 v160, v160, v161
  v_min_u32 v160, -2, v160
  s_branch cB_va0_pc
cB_va0_rv:
  buffer_load_dwordx4 v[8:11], v2, s[8:11], s22 offen offset:0 sc1
  buffer_load_dwordx4 v[12:15], v2, s[8:11], s22 offen offset:1024 sc1
  buffer_load_dwordx4 v[16:19], v2, s[8:11], s22 offen offset:2048 sc1
  buffer_load_dwordx4 v[20:23], v2, s[8:11], s22 offen offset:3072 sc1
  buffer_load_dwordx4 v[24:27], v2, s[8:11], s34 offen offset:0 sc1
  buffer_load_dwordx4 v[28:31], v2, s[8:11], s34 offen offset:1024 sc1
  buffer_load_dwordx4 v[32:35], v2, s[8:11], s34 offen offset:2048 sc1
  buffer_load_dwordx4 v[144:147], v2, s[8:11], s34 offen offset:3072 sc1
  buffer_load_dwordx4 v[148:151], v2, s[8:11], s36 offen offset:0 sc1
  buffer_load_dwordx4 v[152:155], v2, s[8:11], s36 offen offset:1024 sc1
  s_waitcnt vmcnt(0)
  v_max3_u32 v63, v8, v9, v10
  v_max3_u32 v63, v63, v11, v12
  v_max3_u32 v63, v63, v13, v14
  v_max3_u32 v63, v63, v15, v16
  v_max3_u32 v63, v63, v17, v18
  v_max3_u32 v63, v63, v19, v20
  v_max3_u32 v63, v63, v21, v22
  v_max3_u32 v63, v63, v23, v24
  v_max3_u32 v63, v63, v25, v26
  v_max3_u32 v63, v63, v27, v28
  v_max3_u32 v63, v63, v29, v30
  v_max3_u32 v63, v63, v31, v32
  v_max3_u32 v63, v63, v33, v34
  v_max3_u32 v63, v63, v35, v144
  v_max3_u32 v63, v63, v145, v146
  v_max3_u32 v63, v63, v147, v148
  v_max3_u32 v63, v63, v149, v150
  v_max3_u32 v63, v63, v151, v152
  v_max3_u32 v63, v63, v153, v154
  v_max_u32 v63, v63, v155
  v_cmp_eq_u32 vcc, -1, v63
  s_cbranch_vccz cB_va0_rk
  s_add_u32 s30, s30, 1
  s_cmp_lt_u32 s30, 400000
  s_cbranch_scc1 cB_va0_rv
  s_branch cB_abort
cB_va0_rk:
  s_mov_b32 s37, 1
  s_add_u32 s31, s31, 0x10000
  v_mov_b32 v156, 0
  v_mov_b32 v157, 0
  v_mov_b32 v158, 0
  v_mov_b32 v159, 0
  s_nop 1
  v_smfmac_f32_16x16x64_bf16 v[156:159], v[8:11], v[80:87], v3
  v_smfmac_f32_16x16x64_bf16 v[156:159], v[12:15], v[88:95], v3
  v_smfmac_f32_16x16x64_bf16 v[156:159], v[16:19], v[96:103], v3
  v_smfmac_f32_16x16x64_bf16 v[156:159], v[20:23], v[104:111], v3
  v_smfmac_f32_16x16x64_bf16 v[156:159], v[24:27], v[112:119], v3
  v_smfmac_f32_16x16x64_bf16 v[156:159], v[28:31], v[120:127], v3
  v_smfmac_f32_16x16x64_bf16 v[156:159], v[32:35], v[128:135], v3
  v_smfmac_f32_16x16x64_bf16 v[156:159], v[144:147], v[136:143], v3
  v_smfmac_f32_16x16x64_bf16 v[156:159], v[148:151], v[64:71], v3
  v_smfmac_f32_16x16x64_bf16 v[156:159], v[152:155], v[72:79], v3
  s_nop 7
  s_branch cB_va0_ep
.p2align 6

cB_va1_loop:
  s_add_u32 s23, s20, 4096
  s_add_u32 s21, s20, 25600
  s_mov_b32 s30, 0
  s_cmp_lg_u32 s19, s38
  s_cbranch_scc1 cB_va1_vok
  s_branch cB_va1_voc
cB_va1_vow:
  buffer_load_dword v175, off, s[8:11], s35 sc1
  s_waitcnt vmcnt(0)
cB_va1_voc:
  v_readfirstlane_b32 s22, v175
  s_cmp_eq_u32 s22, 56
  s_cbranch_scc1 cB_va1_vod
  s_sleep 1
  s_add_u32 s30, s30, 1
  s_cmp_lt_u32 s30, 400000
  s_cbranch_scc1 cB_va1_vow
  s_branch cB_abort
cB_va1_vod:
  s_add_u32 s35, s35, 2048
  s_add_u32 s38, s19, 8
  s_and_b32 s38, s38, -8
  s_cmp_eq_u32 s19, 0
  s_cselect_b32 s38, 4, s38
cB_va1_vok:
  s_cmp_eq_u32 s19, 63
  s_cbranch_scc1 cB_done
  s_barrier
  s_add_u32 s22, s25, 0
  buffer_load_dwordx4 v[80:83], v6, s[8:11], s22 offen offset:0 sc1
  buffer_load_dwordx4 v[84:87], v6, s[8:11], s22 offen offset:1792 sc1
  s_add_u32 s22, s25, 3584
  buffer_load_dwordx4 v[88:91], v6, s[8:11], s22 offen offset:0 sc1
  buffer_load_dwordx4 v[92:95], v6, s[8:11], s22 offen offset:1792 sc1
  s_add_u32 s22, s25, 7168
  buffer_load_dwordx4 v[96:99], v6, s[8:11], s22 offen offset:0 sc1
  buffer_load_dwordx4 v[100:103], v6, s[8:11], s22 offen offset:1792 sc1
  s_add_u32 s22, s25, 10752
  buffer_load_dwordx4 v[104:107], v6, s[8:11], s22 offen offset:0 sc1
  buffer_load_dwordx4 v[108:111], v6, s[8:11], s22 offen offset:1792 sc1
  s_add_u32 s22, s25, 14336
  buffer_load_dwordx4 v[112:115], v6, s[8:11], s22 offen offset:0 sc1
  buffer_load_dwordx4 v[116:119], v6, s[8:11], s22 offen offset:1792 sc1
  s_add_u32 s22, s25, 17920
  buffer_load_dwordx4 v[120:123], v6, s[8:11], s22 offen offset:0 sc1
  buffer_load_dwordx4 v[124:127], v6, s[8:11], s22 offen offset:1792 sc1
  s_add_u32 s22, s25, 21504
  buffer_load_dwordx4 v[128:131], v6, s[8:11], s22 offen offset:0 sc1
  buffer_load_dwordx4 v[132:135], v6, s[8:11], s22 offen offset:1792 sc1
  s_add_u32 s22, s25, 25088
  buffer_load_dwordx4 v[136:139], v6, s[8:11], s22 offen offset:0 sc1
  buffer_load_dwordx4 v[140:143], v6, s[8:11], s22 offen offset:1792 sc1
  buffer_load_dword v175, off, s[8:11], s35 sc1
  s_barrier
  ds_read_b128 v[8:11], v2 offset:8192
  ds_read_b128 v[12:15], v2 offset:9216
  ds_read_b128 v[16:19], v2 offset:10240
  ds_read_b128 v[20:23], v2 offset:11264
  ds_read_b128 v[24:27], v2 offset:12288
  ds_read_b128 v[28:31], v2 offset:13312
  ds_read_b128 v[32:35], v2 offset:14336
  s_waitcnt lgkmcnt(0)
  v_smfmac_f32_16x16x64_bf16 v[36:39], v[8:11], a[0:7], v3
  v_smfmac_f32_16x16x64_bf16 v[36:39], v[12:15], a[8:15], v3
  v_smfmac_f32_16x16x64_bf16 v[36:39], v[16:19], a[16:23], v3
  v_smfmac_f32_16x16x64_bf16 v[36:39], v[20:23], a[24:31], v3
  v_smfmac_f32_16x16x64_bf16 v[36:39], v[24:27], a[32:39], v3
  v_smfmac_f32_16x16x64_bf16 v[36:39], v[28:31], a[40:47], v3
  v_smfmac_f32_16x16x64_bf16 v[36:39], v[32:35], a[48:55], v3
  v_smfmac_f32_16x16x64_bf16 v[40:43], v[8:11], a[56:63], v3
  v_smfmac_f32_16x16x64_bf16 v[40:43], v[12:15], a[64:71], v3
  v_smfmac_f32_16x16x64_bf16 v[40:43], v[16:19], a[72:79], v3
  v_smfmac_f32_16x16x64_bf16 v[40:43], v[20:23], a[80:87], v3
  v_smfmac_f32_16x16x64_bf16 v[40:43], v[24:27], a[88:95], v3
  v_smfmac_f32_16x16x64_bf16 v[40:43], v[28:31], a[96:103], v3
  v_smfmac_f32_16x16x64_bf16 v[40:43], v[32:35], a[104:111], v3
  v_smfmac_f32_16x16x64_bf16 v[44:47], v[8:11], a[112:119], v3
  v_smfmac_f32_16x16x64_bf16 v[44:47], v[12:15], a[120:127], v3
  v_smfmac_f32_16x16x64_bf16 v[44:47], v[16:19], a[128:135], v3
  v_smfmac_f32_16x16x64_bf16 v[44:47], v[20:23], a[136:143], v3
  v_permlane32_swap_b32 v36, v40
  v_smfmac_f32_16x16x64_bf16 v[44:47], v[24:27], a[144:151], v3
  v_permlane32_swap_b32 v37, v41
  v_smfmac_f32_16x16x64_bf16 v[44:47], v[28:31], a[152:159], v3
  v_permlane32_swap_b32 v38, v42
  v_smfmac_f32_16x16x64_bf16 v[44:47], v[32:35], a[160:167], v3
  v_permlane32_swap_b32 v39, v43
  v_smfmac_f32_16x16x64_bf16 v[48:51], v[8:11], a[168:175], v3
  v_add_f32 v36, v36, v40
  v_smfmac_f32_16x16x64_bf16 v[48:51], v[12:15], a[176:183], v3
  v_add_f32 v37, v37, v41
  v_smfmac_f32_16x16x64_bf16 v[48:51], v[16:19], a[184:191], v3
  v_add_f32 v38, v38, v42
  v_smfmac_f32_16x16x64_bf16 v[48:51], v[20:23], a[192:199], v3
  v_add_f32 v39, v39, v43
  v_smfmac_f32_16x16x64_bf16 v[48:51], v[24:27], a[200:207], v3
  v_cvt_pk_bf16_f32 v40, v36, v37
  v_smfmac_f32_16x16x64_bf16 v[48:51], v[28:31], a[208:215], v3
  v_cvt_pk_bf16_f32 v41, v38, v39
  v_smfmac_f32_16x16x64_bf16 v[48:51], v[32:35], a[216:223], v3
  ds_write_b64 v60, v[40:41]
  v_smfmac_f32_16x16x64_bf16 v[52:55], v[8:11], a[224:231], v3
  v_smfmac_f32_16x16x64_bf16 v[52:55], v[12:15], a[232:239], v3
  v_smfmac_f32_16x16x64_bf16 v[52:55], v[16:19], a[240:247], v3
  v_smfmac_f32_16x16x64_bf16 v[52:55], v[20:23], a[248:255], v3
  v_permlane32_swap_b32 v44, v48
  v_smfmac_f32_16x16x64_bf16 v[52:55], v[24:27], v[176:183], v3
  v_permlane32_swap_b32 v45, v49
  v_smfmac_f32_16x16x64_bf16 v[52:55], v[28:31], v[184:191], v3
  v_permlane32_swap_b32 v46, v50
  v_smfmac_f32_16x16x64_bf16 v[52:55], v[32:35], v[192:199], v3
  v_permlane32_swap_b32 v47, v51
  v_smfmac_f32_16x16x64_bf16 v[56:59], v[8:11], v[200:207], v3
  v_add_f32 v44, v44, v48
  v_smfmac_f32_16x16x64_bf16 v[56:59], v[12:15], v[208:215], v3
  v_add_f32 v45, v45, v49
  v_smfmac_f32_16x16x64_bf16 v[56:59], v[16:19], v[216:223], v3
  v_add_f32 v46, v46, v50
  v_smfmac_f32_16x16x64_bf16 v[56:59], v[20:23], v[224:231], v3
  v_add_f32 v47, v47, v51
  v_smfmac_f32_16x16x64_bf16 v[56:59], v[24:27], v[232:239], v3
  v_cvt_pk_bf16_f32 v48, v44, v45
  v_smfmac_f32_16x16x64_bf16 v[56:59], v[28:31], v[240:247], v3
  v_cvt_pk_bf16_f32 v49, v46, v47
  v_smfmac_f32_16x16x64_bf16 v[56:59], v[32:35], v[248:255], v3
  ds_write_b64 v61, v[48:49]
  s_nop 6
  v_permlane32_swap_b32 v52, v56
  v_permlane32_swap_b32 v53, v57
  v_permlane32_swap_b32 v54, v58
  v_permlane32_swap_b32 v55, v59
  v_add_f32 v52, v52, v56
  v_add_f32 v53, v53, v57
  v_add_f32 v54, v54, v58
  v_add_f32 v55, v55, v59
  v_cvt_pk_bf16_f32 v56, v52, v53
  v_cvt_pk_bf16_f32 v57, v54, v55
  ds_write_b64 v62, v[56:57]
  s_cmp_eq_u32 s19, 63
  s_cbranch_scc1 cB_va1_last
  s_add_u32 s22, s20, 9216
  s_add_u32 s34, s20, 13312
  s_add_u32 s36, s20, 7168
  s_mov_b32 s37, 0
  v_mov_b32 v156, 0
  v_mov_b32 v157, 0
  v_mov_b32 v158, 0
  v_mov_b32 v159, 0
  buffer_load_dword v164, v4, s[8:11], s20 offen sc1
  s_nop 7
  buffer_load_dword v165, v4, s[8:11], s20 offen sc1
  s_nop 7
  buffer_load_dword v166, v4, s[8:11], s20 offen sc1
  s_nop 7
  buffer_load_dword v167, v4, s[8:11], s20 offen sc1
  s_nop 7
  buffer_load_dword v168, v4, s[8:11], s20 offen sc1
cB_va1_fw_l:
  s_waitcnt vmcnt(4)
  v_cmp_eq_u32 vcc, -1, v164
  s_cbranch_vccz cB_va1_fw_d
  buffer_load_dword v164, v4, s[8:11], s20 offen sc1
  s_waitcnt vmcnt(4)
  v_cmp_eq_u32 vcc, -1, v165
  s_cbranch_vccz cB_va1_fw_d
  buffer_load_dword v165, v4, s[8:11], s20 offen sc1
  s_waitcnt vmcnt(4)
  v_cmp_eq_u32 vcc, -1, v166
  s_cbranch_vccz cB_va1_fw_d
  buffer_load_dword v166, v4, s[8:11], s20 offen sc1
  s_waitcnt vmcnt(4)
  v_cmp_eq_u32 vcc, -1, v167
  s_cbranch_vccz cB_va1_fw_d
  buffer_load_dword v167, v4, s[8:11], s20 offen sc1
  s_waitcnt vmcnt(4)
  v_cmp_eq_u32 vcc, -1, v168
  s_cbranch_vccz cB_va1_fw_d
  buffer_load_dword v168, v4, s[8:11], s20 offen sc1
  s_add_u32 s30, s30, 1
  s_cmp_lt_u32 s30, 400000
  s_cbranch_scc1 cB_va1_fw_l
  s_branch cB_abort
cB_va1_fw_d:
  s_waitcnt lgkmcnt(0)
  buffer_load_dwordx4 v[8:11], v2, s[8:11], s22 offen offset:0 sc1
  v_mov_b32 v36, 0
  v_mov_b32 v37, 0
  v_mov_b32 v38, 0
  buffer_load_dwordx4 v[12:15], v2, s[8:11], s22 offen offset:1024 sc1
  v_mov_b32 v39, 0
  v_mov_b32 v40, 0
  v_mov_b32 v41, 0
  buffer_load_dwordx4 v[16:19], v2, s[8:11], s22 offen offset:2048 sc1
  v_mov_b32 v42, 0
  v_mov_b32 v43, 0
  v_mov_b32 v44, 0
  buffer_load_dwordx4 v[20:23], v2, s[8:11], s22 offen offset:3072 sc1
  v_mov_b32 v45, 0
  v_mov_b32 v46, 0
  v_mov_b32 v47, 0
  buffer_load_dwordx4 v[24:27], v2, s[8:11], s34 offen offset:0 sc1
  v_mov_b32 v48, 0
  v_mov_b32 v49, 0
  v_mov_b32 v50, 0
  buffer_load_dwordx4 v[28:31], v2, s[8:11], s34 offen offset:1024 sc1
  v_mov_b32 v51, 0
  v_mov_b32 v52, 0
  v_mov_b32 v53, 0
  buffer_load_dwordx4 v[32:35], v2, s[8:11], s34 offen offset:2048 sc1
  v_mov_b32 v54, 0
  v_mov_b32 v55, 0
  v_mov_b32 v56, 0
  buffer_load_dwordx4 v[144:147], v2, s[8:11], s34 offen offset:3072 sc1
  v_mov_b32 v57, 0
  v_mov_b32 v58, 0
  v_mov_b32 v59, 0
  buffer_load_dwordx4 v[148:151], v2, s[8:11], s36 offen offset:0 sc1
  buffer_load_dwordx4 v[152:155], v2, s[8:11], s36 offen offset:1024 sc1
  s_barrier
  ds_read_b128 v[64:67], v2 offset:4096
  ds_read_b128 v[68:71], v2 offset:5120
  ds_read_b128 v[72:75], v2 offset:6144
  ds_read_b128 v[76:79], v2 offset:7168
  s_waitcnt vmcnt(9)
  v_smfmac_f32_16x16x64_bf16 v[156:159], v[8:11], v[80:87], v3
  s_waitcnt vmcnt(8)
  v_smfmac_f32_16x16x64_bf16 v[156:159], v[12:15], v[88:95], v3
  s_waitcnt vmcnt(7)
  v_smfmac_f32_16x16x64_bf16 v[156:159], v[16:19], v[96:103], v3
  s_waitcnt vmcnt(6)
  v_smfmac_f32_16x16x64_bf16 v[156:159], v[20:23], v[104:111], v3
  s_waitcnt vmcnt(5)
  v_smfmac_f32_16x16x64_bf16 v[156:159], v[24:27], v[112:119], v3
  s_mov_b32 exec_hi, 0
  buffer_store_dword v2, v7, s[8:11], s21 offen sc1
  s_mov_b64 exec, -1
  s_waitcnt vmcnt(5)
  v_smfmac_f32_16x16x64_bf16 v[156:159], v[28:31], v[120:127], v3
  s_waitcnt vmcnt(4)
  v_smfmac_f32_16x16x64_bf16 v[156:159], v[32:35], v[128:135], v3
  s_waitcnt vmcnt(3)
  v_smfmac_f32_16x16x64_bf16 v[156:159], v[144:147], v[136:143], v3
  s_waitcnt vmcnt(2) lgkmcnt(0)
  v_smfmac_f32_16x16x64_bf16 v[156:159], v[148:151], v[64:71], v3
  s_waitcnt vmcnt(1)
  v_smfmac_f32_16x16x64_bf16 v[156:159], v[152:155], v[72:79], v3
cB_va1_ep:
  s_nop 7
  v_permlane32_swap_b32 v156, v158
  v_permlane32_swap_b32 v157, v159
  v_add_f32 v160, v156, v158
  v_add_f32 v161, v157, v159
  v_cmp_u_f32 vcc, v160, v161
  v_mov_b32_dpp v162, v160 row_ror:8 row_mask:0xf bank_mask:0xf
  v_mov_b32_dpp v160, v161 row_ror:8 row_mask:0xf bank_mask:0xc
  s_cbranch_vccnz cB_va1_rp
  v_mov_b32_dpp v161, v162 quad_perm:[0,1,2,3] row_mask:0xf bank_mask:0x3
  v_cvt_pk_bf16_f32 v160, v160, v161
cB_va1_pc:
  s_mov_b64 exec, s[26:27]
  buffer_store_dword v160, v1, s[8:11], s21 offen sc1
  s_cmp_lg_u32 s19, 62
  s_cbranch_scc1 cB_va1_nl
  s_mov_b32 s22, 88519680
  buffer_store_dword v160, v1, s[8:11], s22 offen sc1
  s_mov_b64 exec, -1
  s_branch cB_done
cB_va1_nl:
  s_mov_b64 exec, -1
  s_add_u32 s25, s25, 28672
  s_add_u32 s19, s19, 1
  s_mov_b32 s20, s21
  s_branch cB_va1_loop
cB_va1_last:
  s_waitcnt lgkmcnt(0)
  s_barrier
  s_branch cB_done
cB_va1_rp:
  s_cmp_eq_u32 s37, 0
  s_cbranch_scc1 cB_va1_rv
  v_mov_b32_dpp v161, v162 quad_perm:[0,1,2,3] row_mask:0xf bank_mask:0x3
  v_cvt_pk_bf16_f32 v160, v160, v161
  v_min_u32 v160, -2, v160
  s_branch cB_va1_pc
cB_va1_rv:
  buffer_load_dwordx4 v[8:11], v2, s[8:11], s22 offen offset:0 sc1
  buffer_load_dwordx4 v[12:15], v2, s[8:11], s22 offen offset:1024 sc1
  buffer_load_dwordx4 v[16:19], v2, s[8:11], s22 offen offset:2048 sc1
  buffer_load_dwordx4 v[20:23], v2, s[8:11], s22 offen offset:3072 sc1
  buffer_load_dwordx4 v[24:27], v2, s[8:11], s34 offen offset:0 sc1
  buffer_load_dwordx4 v[28:31], v2, s[8:11], s34 offen offset:1024 sc1
  buffer_load_dwordx4 v[32:35], v2, s[8:11], s34 offen offset:2048 sc1
  buffer_load_dwordx4 v[144:147], v2, s[8:11], s34 offen offset:3072 sc1
  buffer_load_dwordx4 v[148:151], v2, s[8:11], s36 offen offset:0 sc1
  buffer_load_dwordx4 v[152:155], v2, s[8:11], s36 offen offset:1024 sc1
  s_waitcnt vmcnt(0)
  v_max3_u32 v63, v8, v9, v10
  v_max3_u32 v63, v63, v11, v12
  v_max3_u32 v63, v63, v13, v14
  v_max3_u32 v63, v63, v15, v16
  v_max3_u32 v63, v63, v17, v18
  v_max3_u32 v63, v63, v19, v20
  v_max3_u32 v63, v63, v21, v22
  v_max3_u32 v63, v63, v23, v24
  v_max3_u32 v63, v63, v25, v26
  v_max3_u32 v63, v63, v27, v28
  v_max3_u32 v63, v63, v29, v30
  v_max3_u32 v63, v63, v31, v32
  v_max3_u32 v63, v63, v33, v34
  v_max3_u32 v63, v63, v35, v144
  v_max3_u32 v63, v63, v145, v146
  v_max3_u32 v63, v63, v147, v148
  v_max3_u32 v63, v63, v149, v150
  v_max3_u32 v63, v63, v151, v152
  v_max3_u32 v63, v63, v153, v154
  v_max_u32 v63, v63, v155
  v_cmp_eq_u32 vcc, -1, v63
  s_cbranch_vccz cB_va1_rk
  s_add_u32 s30, s30, 1
  s_cmp_lt_u32 s30, 400000
  s_cbranch_scc1 cB_va1_rv
  s_branch cB_abort
cB_va1_rk:
  s_mov_b32 s37, 1
  s_add_u32 s31, s31, 0x10000
  v_mov_b32 v156, 0
  v_mov_b32 v157, 0
  v_mov_b32 v158, 0
  v_mov_b32 v159, 0
  s_nop 1
  v_smfmac_f32_16x16x64_bf16 v[156:159], v[8:11], v[80:87], v3
  v_smfmac_f32_16x16x64_bf16 v[156:159], v[12:15], v[88:95], v3
  v_smfmac_f32_16x16x64_bf16 v[156:159], v[16:19], v[96:103], v3
  v_smfmac_f32_16x16x64_bf16 v[156:159], v[20:23], v[104:111], v3
  v_smfmac_f32_16x16x64_bf16 v[156:159], v[24:27], v[112:119], v3
  v_smfmac_f32_16x16x64_bf16 v[156:159], v[28:31], v[120:127], v3
  v_smfmac_f32_16x16x64_bf16 v[156:159], v[32:35], v[128:135], v3
  v_smfmac_f32_16x16x64_bf16 v[156:159], v[144:147], v[136:143], v3
  v_smfmac_f32_16x16x64_bf16 v[156:159], v[148:151], v[64:71], v3
  v_smfmac_f32_16x16x64_bf16 v[156:159], v[152:155], v[72:79], v3
  s_nop 7
  s_branch cB_va1_ep
.p2align 6

cB_va2_loop:
  s_add_u32 s23, s20, 4096
  s_add_u32 s21, s20, 25600
  v_mov_b32 v36, 0
  v_mov_b32 v37, 0
  v_mov_b32 v38, 0
  v_mov_b32 v39, 0
  v_mov_b32 v40, 0
  v_mov_b32 v41, 0
  v_mov_b32 v42, 0
  v_mov_b32 v43, 0
  v_mov_b32 v44, 0
  v_mov_b32 v45, 0
  v_mov_b32 v46, 0
  v_mov_b32 v47, 0
  v_mov_b32 v48, 0
  v_mov_b32 v49, 0
  v_mov_b32 v50, 0
  v_mov_b32 v51, 0
  v_mov_b32 v52, 0
  v_mov_b32 v53, 0
  v_mov_b32 v54, 0
  v_mov_b32 v55, 0
  v_mov_b32 v56, 0
  v_mov_b32 v57, 0
  v_mov_b32 v58, 0
  v_mov_b32 v59, 0
  v_mov_b32 v60, 0
  v_mov_b32 v61, 0
  v_mov_b32 v62, 0
  v_mov_b32 v63, 0
  v_mov_b32 v64, 0
  v_mov_b32 v65, 0
  v_mov_b32 v66, 0
  v_mov_b32 v67, 0
  s_mov_b32 s30, 0
  buffer_load_dword v76, v119, s[8:11], s20 offen sc1
  buffer_load_dword v77, v119, s[8:11], s20 offen sc1
  buffer_load_dword v78, v119, s[8:11], s20 offen sc1
cB_va2_fp_l:
  s_waitcnt vmcnt(2)
  v_cmp_eq_u32 vcc, -1, v76
  s_cbranch_vccz cB_va2_fp_d
  buffer_load_dword v76, v119, s[8:11], s20 offen sc1
  s_waitcnt vmcnt(2)
  v_cmp_eq_u32 vcc, -1, v77
  s_cbranch_vccz cB_va2_fp_d
  buffer_load_dword v77, v119, s[8:11], s20 offen sc1
  s_waitcnt vmcnt(2)
  v_cmp_eq_u32 vcc, -1, v78
  s_cbranch_vccz cB_va2_fp_d
  buffer_load_dword v78, v119, s[8:11], s20 offen sc1
  s_add_u32 s30, s30, 1
  s_cmp_lt_u32 s30, 400000
  s_cbranch_scc1 cB_va2_fp_l
  s_branch cB_abort
cB_va2_fp_d:
  buffer_load_dwordx4 v[8:11], v2, s[8:11], s20 offen offset:0 sc1
  buffer_load_dwordx4 v[12:15], v2, s[8:11], s20 offen offset:1024 sc1
  buffer_load_dwordx4 v[16:19], v2, s[8:11], s20 offen offset:2048 sc1
  buffer_load_dwordx4 v[20:23], v2, s[8:11], s20 offen offset:3072 sc1
  s_barrier
cB_va2_ld:
  s_waitcnt vmcnt(0)
  v_max3_u32 v84, v8, v9, v10
  v_max3_u32 v84, v84, v11, v12
  v_max3_u32 v84, v84, v13, v14
  v_max3_u32 v84, v84, v15, v16
  v_max3_u32 v84, v84, v17, v18
  v_max3_u32 v84, v84, v19, v20
  v_max3_u32 v84, v84, v21, v22
  v_max_u32 v84, v84, v23
  v_cmp_eq_u32 vcc, -1, v84
  ds_write_b128 v2, v[8:11] offset:8192
  ds_write_b128 v2, v[12:15] offset:9216
  ds_write_b128 v2, v[16:19] offset:10240
  ds_write_b128 v2, v[20:23] offset:11264
  s_cbranch_vccnz cB_va2_retry
  s_waitcnt lgkmcnt(0)
  s_barrier
  ds_read_b128 v[24:27], v2 offset:12288
  ds_read_b128 v[28:31], v2 offset:13312
  ds_read_b128 v[32:35], v2 offset:14336
  ds_read_b128 v[92:95], v0
  s_waitcnt lgkmcnt(0)
  s_mov_b64 exec, s[26:27]
  buffer_store_dwordx4 v[92:95], v2, s[8:11], s36 offen sc1
  s_mov_b64 exec, -1
  s_add_u32 s36, s36, 7168
  s_cmp_eq_u32 s19, 63
  s_cbranch_scc1 cB_done
  ds_read_b128 v[76:79], v1 offset:0
  ds_read_b128 v[80:83], v1 offset:1024
  ds_read_b128 v[84:87], v1 offset:2048
  ds_read_b128 v[88:91], v1 offset:3072
  ds_read_b128 v[92:95], v1 offset:4096
  ds_read_b128 v[96:99], v1 offset:5120
  v_smfmac_f32_16x16x64_bf16 v[60:63], v[8:11], v[200:207], v3
  v_smfmac_f32_16x16x64_bf16 v[60:63], v[12:15], v[208:215], v3
  s_waitcnt lgkmcnt(4)
  v_smfmac_f32_16x16x64_bf16 v[64:67], v[8:11], v[76:83], v3
  ds_read_b128 v[76:79], v1 offset:6144
  ds_read_b128 v[80:83], v1 offset:7168
  v_smfmac_f32_16x16x64_bf16 v[60:63], v[16:19], v[216:223], v3
  v_smfmac_f32_16x16x64_bf16 v[60:63], v[20:23], v[224:231], v3
  s_waitcnt lgkmcnt(4)
  v_smfmac_f32_16x16x64_bf16 v[64:67], v[12:15], v[84:91], v3
  ds_read_b128 v[84:87], v1 offset:8192
  ds_read_b128 v[88:91], v1 offset:9216
  v_smfmac_f32_16x16x64_bf16 v[60:63], v[24:27], v[232:239], v3
  v_smfmac_f32_16x16x64_bf16 v[60:63], v[28:31], v[240:247], v3
  s_waitcnt lgkmcnt(4)
  v_smfmac_f32_16x16x64_bf16 v[64:67], v[16:19], v[92:99], v3
  ds_read_b128 v[92:95], v1 offset:10240
  ds_read_b128 v[96:99], v1 offset:11264
  v_smfmac_f32_16x16x64_bf16 v[60:63], v[32:35], v[248:255], v3
  v_smfmac_f32_16x16x64_bf16 v[36:39], v[8:11], a[0:7], v3
  s_waitcnt lgkmcnt(4)
  v_smfmac_f32_16x16x64_bf16 v[64:67], v[20:23], v[76:83], v3
  ds_read_b128 v[76:79], v1 offset:12288
  ds_read_b128 v[80:83], v1 offset:13312
  v_smfmac_f32_16x16x64_bf16 v[36:39], v[12:15], a[8:15], v3
  v_smfmac_f32_16x16x64_bf16 v[36:39], v[16:19], a[16:23], v3
  s_waitcnt lgkmcnt(4)
  v_smfmac_f32_16x16x64_bf16 v[64:67], v[24:27], v[84:91], v3
  v_smfmac_f32_16x16x64_bf16 v[36:39], v[20:23], a[24:31], v3
  v_smfmac_f32_16x16x64_bf16 v[36:39], v[24:27], a[32:39], v3
  s_waitcnt lgkmcnt(2)
  v_smfmac_f32_16x16x64_bf16 v[64:67], v[28:31], v[92:99], v3
  v_smfmac_f32_16x16x64_bf16 v[36:39], v[28:31], a[40:47], v3
  v_smfmac_f32_16x16x64_bf16 v[36:39], v[32:35], a[48:55], v3
  s_waitcnt lgkmcnt(0)
  v_smfmac_f32_16x16x64_bf16 v[64:67], v[32:35], v[76:83], v3
  v_smfmac_f32_16x16x64_bf16 v[40:43], v[8:11], a[56:63], v3
  v_smfmac_f32_16x16x64_bf16 v[40:43], v[12:15], a[64:71], v3
  v_smfmac_f32_16x16x64_bf16 v[40:43], v[16:19], a[72:79], v3
  v_smfmac_f32_16x16x64_bf16 v[40:43], v[20:23], a[80:87], v3
  v_permlane32_swap_b32 v60, v64
  v_smfmac_f32_16x16x64_bf16 v[40:43], v[24:27], a[88:95], v3
  v_permlane32_swap_b32 v61, v65
  v_smfmac_f32_16x16x64_bf16 v[40:43], v[28:31], a[96:103], v3
  v_permlane32_swap_b32 v62, v66
  v_smfmac_f32_16x16x64_bf16 v[40:43], v[32:35], a[104:111], v3
  v_permlane32_swap_b32 v63, v67
  v_smfmac_f32_16x16x64_bf16 v[44:47], v[8:11], a[112:119], v3
  v_smfmac_f32_16x16x64_bf16 v[44:47], v[12:15], a[120:127], v3
  v_smfmac_f32_16x16x64_bf16 v[44:47], v[16:19], a[128:135], v3
  v_smfmac_f32_16x16x64_bf16 v[44:47], v[20:23], a[136:143], v3
  v_add_f32 v60, v60, v64
  v_add_f32 v61, v61, v65
  v_smfmac_f32_16x16x64_bf16 v[44:47], v[24:27], a[144:151], v3
  v_add_f32 v62, v62, v66
  v_add_f32 v63, v63, v67
  v_smfmac_f32_16x16x64_bf16 v[44:47], v[28:31], a[152:159], v3
  v_cvt_pk_bf16_f32 v64, v60, v61
  v_cvt_pk_bf16_f32 v65, v62, v63
  v_smfmac_f32_16x16x64_bf16 v[44:47], v[32:35], a[160:167], v3
  ds_write_b64 v115, v[64:65]
  v_smfmac_f32_16x16x64_bf16 v[48:51], v[8:11], a[168:175], v3
  v_permlane32_swap_b32 v36, v40
  v_smfmac_f32_16x16x64_bf16 v[48:51], v[12:15], a[176:183], v3
  v_permlane32_swap_b32 v37, v41
  v_smfmac_f32_16x16x64_bf16 v[48:51], v[16:19], a[184:191], v3
  v_permlane32_swap_b32 v38, v42
  v_smfmac_f32_16x16x64_bf16 v[48:51], v[20:23], a[192:199], v3
  v_permlane32_swap_b32 v39, v43
  v_smfmac_f32_16x16x64_bf16 v[48:51], v[24:27], a[200:207], v3
  v_add_f32 v36, v36, v40
  v_smfmac_f32_16x16x64_bf16 v[48:51], v[28:31], a[208:215], v3
  v_add_f32 v37, v37, v41
  v_smfmac_f32_16x16x64_bf16 v[48:51], v[32:35], a[216:223], v3
  v_add_f32 v38, v38, v42
  v_smfmac_f32_16x16x64_bf16 v[52:55], v[8:11], a[224:231], v3
  v_smfmac_f32_16x16x64_bf16 v[52:55], v[12:15], a[232:239], v3
  v_smfmac_f32_16x16x64_bf16 v[52:55], v[16:19], a[240:247], v3
  v_smfmac_f32_16x16x64_bf16 v[52:55], v[20:23], a[248:255], v3
  v_add_f32 v39, v39, v43
  v_cvt_pk_bf16_f32 v40, v36, v37
  v_smfmac_f32_16x16x64_bf16 v[52:55], v[24:27], v[120:127], v3
  v_cvt_pk_bf16_f32 v41, v38, v39
  v_smfmac_f32_16x16x64_bf16 v[52:55], v[28:31], v[128:135], v3
  ds_write_b64 v112, v[40:41]
  v_smfmac_f32_16x16x64_bf16 v[52:55], v[32:35], v[136:143], v3
  v_permlane32_swap_b32 v44, v48
  v_smfmac_f32_16x16x64_bf16 v[56:59], v[8:11], v[144:151], v3
  v_permlane32_swap_b32 v45, v49
  v_smfmac_f32_16x16x64_bf16 v[56:59], v[12:15], v[152:159], v3
  v_permlane32_swap_b32 v46, v50
  v_smfmac_f32_16x16x64_bf16 v[56:59], v[16:19], v[160:167], v3
  v_permlane32_swap_b32 v47, v51
  v_smfmac_f32_16x16x64_bf16 v[56:59], v[20:23], v[168:175], v3
  v_add_f32 v44, v44, v48
  v_smfmac_f32_16x16x64_bf16 v[56:59], v[24:27], v[176:183], v3
  v_add_f32 v45, v45, v49
  v_smfmac_f32_16x16x64_bf16 v[56:59], v[28:31], v[184:191], v3
  v_add_f32 v46, v46, v50
  v_smfmac_f32_16x16x64_bf16 v[56:59], v[32:35], v[192:199], v3
  v_add_f32 v47, v47, v51
  v_cvt_pk_bf16_f32 v48, v44, v45
  v_cvt_pk_bf16_f32 v49, v46, v47
  ds_write_b64 v113, v[48:49]
  s_nop 3
  v_permlane32_swap_b32 v52, v56
  v_permlane32_swap_b32 v53, v57
  v_permlane32_swap_b32 v54, v58
  v_permlane32_swap_b32 v55, v59
  v_add_f32 v52, v52, v56
  v_add_f32 v53, v53, v57
  v_add_f32 v54, v54, v58
  v_add_f32 v55, v55, v59
  v_cvt_pk_bf16_f32 v56, v52, v53
  v_cvt_pk_bf16_f32 v57, v54, v55
  ds_write_b64 v114, v[56:57]
  s_waitcnt lgkmcnt(0)
  s_barrier
  s_cmp_eq_u32 s19, 62
  s_cbranch_scc1 cB_done
  s_waitcnt vmcnt(0) lgkmcnt(0)
  s_add_u32 s19, s19, 1
  s_mov_b32 s20, s21
  s_branch cB_va2_loop
cB_va2_retry:
  s_waitcnt lgkmcnt(0)
  buffer_load_dwordx4 v[8:11], v2, s[8:11], s20 offen offset:0 sc1
  buffer_load_dwordx4 v[12:15], v2, s[8:11], s20 offen offset:1024 sc1
  buffer_load_dwordx4 v[16:19], v2, s[8:11], s20 offen offset:2048 sc1
  buffer_load_dwordx4 v[20:23], v2, s[8:11], s20 offen offset:3072 sc1
  s_add_u32 s31, s31, 1
  s_add_u32 s30, s30, 1
  s_cmp_lt_u32 s30, 400000
  s_cbranch_scc1 cB_va2_ld
  s_branch cB_abort
cB_va2_last:
  s_waitcnt lgkmcnt(0)
  buffer_store_dwordx4 v[100:103], v2, s[8:11], s24 offen offset:0 sc1
  buffer_store_dwordx4 v[104:107], v2, s[8:11], s24 offen offset:1024 sc1
  buffer_store_dwordx4 v[108:111], v2, s[8:11], s24 offen offset:2048 sc1
  buffer_store_dwordx4 v[4:7], v2, s[8:11], s24 offen offset:3072 sc1
  s_add_u32 s24, s24, 8192
  s_waitcnt vmcnt(0)
  s_mov_b64 exec, 1
  buffer_store_dword v117, v2, s[8:11], s34 offen sc1
  s_mov_b64 exec, -1
  s_add_u32 s34, s34, 8
  s_mov_b64 exec, 1
  buffer_store_dword v117, v2, s[8:11], s34 offen sc1
  s_mov_b64 exec, -1
  s_add_u32 s34, s34, 8
  s_branch cB_done
.p2align 6

cB_va3_loop:
  s_add_u32 s23, s20, 4096
  s_add_u32 s21, s20, 25600
  v_mov_b32 v36, 0
  v_mov_b32 v37, 0
  v_mov_b32 v38, 0
  v_mov_b32 v39, 0
  v_mov_b32 v40, 0
  v_mov_b32 v41, 0
  v_mov_b32 v42, 0
  v_mov_b32 v43, 0
  v_mov_b32 v44, 0
  v_mov_b32 v45, 0
  v_mov_b32 v46, 0
  v_mov_b32 v47, 0
  v_mov_b32 v48, 0
  v_mov_b32 v49, 0
  v_mov_b32 v50, 0
  v_mov_b32 v51, 0
  v_mov_b32 v52, 0
  v_mov_b32 v53, 0
  v_mov_b32 v54, 0
  v_mov_b32 v55, 0
  v_mov_b32 v56, 0
  v_mov_b32 v57, 0
  v_mov_b32 v58, 0
  v_mov_b32 v59, 0
  v_mov_b32 v60, 0
  v_mov_b32 v61, 0
  v_mov_b32 v62, 0
  v_mov_b32 v63, 0
  v_mov_b32 v64, 0
  v_mov_b32 v65, 0
  v_mov_b32 v66, 0
  v_mov_b32 v67, 0
  s_mov_b32 s30, 0
  buffer_load_dword v76, v119, s[8:11], s20 offen sc1
  buffer_load_dword v77, v119, s[8:11], s20 offen sc1
  buffer_load_dword v78, v119, s[8:11], s20 offen sc1
cB_va3_fp_l:
  s_waitcnt vmcnt(2)
  v_cmp_eq_u32 vcc, -1, v76
  s_cbranch_vccz cB_va3_fp_d
  buffer_load_dword v76, v119, s[8:11], s20 offen sc1
  s_waitcnt vmcnt(2)
  v_cmp_eq_u32 vcc, -1, v77
  s_cbranch_vccz cB_va3_fp_d
  buffer_load_dword v77, v119, s[8:11], s20 offen sc1
  s_waitcnt vmcnt(2)
  v_cmp_eq_u32 vcc, -1, v78
  s_cbranch_vccz cB_va3_fp_d
  buffer_load_dword v78, v119, s[8:11], s20 offen sc1
  s_add_u32 s30, s30, 1
  s_cmp_lt_u32 s30, 400000
  s_cbranch_scc1 cB_va3_fp_l
  s_branch cB_abort
cB_va3_fp_d:
  buffer_load_dwordx4 v[24:27], v2, s[8:11], s23 offen offset:0 sc1
  buffer_load_dwordx4 v[28:31], v2, s[8:11], s23 offen offset:1024 sc1
  buffer_load_dwordx4 v[32:35], v2, s[8:11], s23 offen offset:2048 sc1
  s_barrier
cB_va3_ld:
  s_waitcnt vmcnt(0)
  v_max3_u32 v84, v24, v25, v26
  v_max3_u32 v84, v84, v27, v28
  v_max3_u32 v84, v84, v29, v30
  v_max3_u32 v84, v84, v31, v32
  v_max3_u32 v84, v84, v33, v34
  v_max_u32 v84, v84, v35
  v_cmp_eq_u32 vcc, -1, v84
  ds_write_b128 v2, v[24:27] offset:12288
  ds_write_b128 v2, v[28:31] offset:13312
  ds_write_b128 v2, v[32:35] offset:14336
  s_cbranch_vccnz cB_va3_retry
  s_waitcnt lgkmcnt(0)
  s_barrier
  ds_read_b128 v[8:11], v2 offset:8192
  ds_read_b128 v[12:15], v2 offset:9216
  ds_read_b128 v[16:19], v2 offset:10240
  ds_read_b128 v[20:23], v2 offset:11264
  s_waitcnt lgkmcnt(0)
  s_cmp_eq_u32 s19, 63
  s_cbranch_scc1 cB_done
  ds_read_b128 v[76:79], v1 offset:0
  ds_read_b128 v[80:83], v1 offset:1024
  ds_read_b128 v[84:87], v1 offset:2048
  ds_read_b128 v[88:91], v1 offset:3072
  ds_read_b128 v[92:95], v1 offset:4096
  ds_read_b128 v[96:99], v1 offset:5120
  v_smfmac_f32_16x16x64_bf16 v[60:63], v[8:11], v[200:207], v3
  v_smfmac_f32_16x16x64_bf16 v[60:63], v[12:15], v[208:215], v3
  s_waitcnt lgkmcnt(4)
  v_smfmac_f32_16x16x64_bf16 v[64:67], v[8:11], v[76:83], v3
  ds_read_b128 v[76:79], v1 offset:6144
  ds_read_b128 v[80:83], v1 offset:7168
  v_smfmac_f32_16x16x64_bf16 v[60:63], v[16:19], v[216:223], v3
  v_smfmac_f32_16x16x64_bf16 v[60:63], v[20:23], v[224:231], v3
  s_waitcnt lgkmcnt(4)
  v_smfmac_f32_16x16x64_bf16 v[64:67], v[12:15], v[84:91], v3
  ds_read_b128 v[84:87], v1 offset:8192
  ds_read_b128 v[88:91], v1 offset:9216
  v_smfmac_f32_16x16x64_bf16 v[60:63], v[24:27], v[232:239], v3
  v_smfmac_f32_16x16x64_bf16 v[60:63], v[28:31], v[240:247], v3
  s_waitcnt lgkmcnt(4)
  v_smfmac_f32_16x16x64_bf16 v[64:67], v[16:19], v[92:99], v3
  ds_read_b128 v[92:95], v1 offset:10240
  ds_read_b128 v[96:99], v1 offset:11264
  v_smfmac_f32_16x16x64_bf16 v[60:63], v[32:35], v[248:255], v3
  v_smfmac_f32_16x16x64_bf16 v[36:39], v[8:11], a[0:7], v3
  s_waitcnt lgkmcnt(4)
  v_smfmac_f32_16x16x64_bf16 v[64:67], v[20:23], v[76:83], v3
  ds_read_b128 v[76:79], v1 offset:12288
  ds_read_b128 v[80:83], v1 offset:13312
  v_smfmac_f32_16x16x64_bf16 v[36:39], v[12:15], a[8:15], v3
  v_smfmac_f32_16x16x64_bf16 v[36:39], v[16:19], a[16:23], v3
  s_waitcnt lgkmcnt(4)
  v_smfmac_f32_16x16x64_bf16 v[64:67], v[24:27], v[84:91], v3
  v_smfmac_f32_16x16x64_bf16 v[36:39], v[20:23], a[24:31], v3
  v_smfmac_f32_16x16x64_bf16 v[36:39], v[24:27], a[32:39], v3
  s_waitcnt lgkmcnt(2)
  v_smfmac_f32_16x16x64_bf16 v[64:67], v[28:31], v[92:99], v3
  v_smfmac_f32_16x16x64_bf16 v[36:39], v[28:31], a[40:47], v3
  v_smfmac_f32_16x16x64_bf16 v[36:39], v[32:35], a[48:55], v3
  s_waitcnt lgkmcnt(0)
  v_smfmac_f32_16x16x64_bf16 v[64:67], v[32:35], v[76:83], v3
  v_smfmac_f32_16x16x64_bf16 v[40:43], v[8:11], a[56:63], v3
  v_smfmac_f32_16x16x64_bf16 v[40:43], v[12:15], a[64:71], v3
  v_smfmac_f32_16x16x64_bf16 v[40:43], v[16:19], a[72:79], v3
  v_smfmac_f32_16x16x64_bf16 v[40:43], v[20:23], a[80:87], v3
  v_permlane32_swap_b32 v60, v64
  v_smfmac_f32_16x16x64_bf16 v[40:43], v[24:27], a[88:95], v3
  v_permlane32_swap_b32 v61, v65
  v_smfmac_f32_16x16x64_bf16 v[40:43], v[28:31], a[96:103], v3
  v_permlane32_swap_b32 v62, v66
  v_smfmac_f32_16x16x64_bf16 v[40:43], v[32:35], a[104:111], v3
  v_permlane32_swap_b32 v63, v67
  v_smfmac_f32_16x16x64_bf16 v[44:47], v[8:11], a[112:119], v3
  v_smfmac_f32_16x16x64_bf16 v[44:47], v[12:15], a[120:127], v3
  v_smfmac_f32_16x16x64_bf16 v[44:47], v[16:19], a[128:135], v3
  v_smfmac_f32_16x16x64_bf16 v[44:47], v[20:23], a[136:143], v3
  v_add_f32 v60, v60, v64
  v_add_f32 v61, v61, v65
  v_smfmac_f32_16x16x64_bf16 v[44:47], v[24:27], a[144:151], v3
  v_add_f32 v62, v62, v66
  v_add_f32 v63, v63, v67
  v_smfmac_f32_16x16x64_bf16 v[44:47], v[28:31], a[152:159], v3
  v_cvt_pk_bf16_f32 v64, v60, v61
  v_cvt_pk_bf16_f32 v65, v62, v63
  v_smfmac_f32_16x16x64_bf16 v[44:47], v[32:35], a[160:167], v3
  ds_write_b64 v115, v[64:65]
  v_smfmac_f32_16x16x64_bf16 v[48:51], v[8:11], a[168:175], v3
  v_permlane32_swap_b32 v36, v40
  v_smfmac_f32_16x16x64_bf16 v[48:51], v[12:15], a[176:183], v3
  v_permlane32_swap_b32 v37, v41
  v_smfmac_f32_16x16x64_bf16 v[48:51], v[16:19], a[184:191], v3
  v_permlane32_swap_b32 v38, v42
  v_smfmac_f32_16x16x64_bf16 v[48:51], v[20:23], a[192:199], v3
  v_permlane32_swap_b32 v39, v43
  v_smfmac_f32_16x16x64_bf16 v[48:51], v[24:27], a[200:207], v3
  v_add_f32 v36, v36, v40
  v_smfmac_f32_16x16x64_bf16 v[48:51], v[28:31], a[208:215], v3
  v_add_f32 v37, v37, v41
  v_smfmac_f32_16x16x64_bf16 v[48:51], v[32:35], a[216:223], v3
  v_add_f32 v38, v38, v42
  v_smfmac_f32_16x16x64_bf16 v[52:55], v[8:11], a[224:231], v3
  v_smfmac_f32_16x16x64_bf16 v[52:55], v[12:15], a[232:239], v3
  v_smfmac_f32_16x16x64_bf16 v[52:55], v[16:19], a[240:247], v3
  v_smfmac_f32_16x16x64_bf16 v[52:55], v[20:23], a[248:255], v3
  v_add_f32 v39, v39, v43
  v_cvt_pk_bf16_f32 v40, v36, v37
  v_smfmac_f32_16x16x64_bf16 v[52:55], v[24:27], v[120:127], v3
  v_cvt_pk_bf16_f32 v41, v38, v39
  v_smfmac_f32_16x16x64_bf16 v[52:55], v[28:31], v[128:135], v3
  ds_write_b64 v112, v[40:41]
  v_smfmac_f32_16x16x64_bf16 v[52:55], v[32:35], v[136:143], v3
  v_permlane32_swap_b32 v44, v48
  v_smfmac_f32_16x16x64_bf16 v[56:59], v[8:11], v[144:151], v3
  v_permlane32_swap_b32 v45, v49
  v_smfmac_f32_16x16x64_bf16 v[56:59], v[12:15], v[152:159], v3
  v_permlane32_swap_b32 v46, v50
  v_smfmac_f32_16x16x64_bf16 v[56:59], v[16:19], v[160:167], v3
  v_permlane32_swap_b32 v47, v51
  v_smfmac_f32_16x16x64_bf16 v[56:59], v[20:23], v[168:175], v3
  v_add_f32 v44, v44, v48
  v_smfmac_f32_16x16x64_bf16 v[56:59], v[24:27], v[176:183], v3
  v_add_f32 v45, v45, v49
  v_smfmac_f32_16x16x64_bf16 v[56:59], v[28:31], v[184:191], v3
  v_add_f32 v46, v46, v50
  v_smfmac_f32_16x16x64_bf16 v[56:59], v[32:35], v[192:199], v3
  v_add_f32 v47, v47, v51
  v_cvt_pk_bf16_f32 v48, v44, v45
  v_cvt_pk_bf16_f32 v49, v46, v47
  ds_write_b64 v113, v[48:49]
  s_nop 3
  v_permlane32_swap_b32 v52, v56
  v_permlane32_swap_b32 v53, v57
  v_permlane32_swap_b32 v54, v58
  v_permlane32_swap_b32 v55, v59
  v_add_f32 v52, v52, v56
  v_add_f32 v53, v53, v57
  v_add_f32 v54, v54, v58
  v_add_f32 v55, v55, v59
  v_cvt_pk_bf16_f32 v56, v52, v53
  v_cvt_pk_bf16_f32 v57, v54, v55
  ds_write_b64 v114, v[56:57]
  s_waitcnt lgkmcnt(0)
  s_barrier
  s_cmp_eq_u32 s19, 62
  s_cbranch_scc1 cB_done
  s_waitcnt vmcnt(0) lgkmcnt(0)
  s_add_u32 s19, s19, 1
  s_mov_b32 s20, s21
  s_branch cB_va3_loop
cB_va3_retry:
  s_waitcnt lgkmcnt(0)
  buffer_load_dwordx4 v[24:27], v2, s[8:11], s23 offen offset:0 sc1
  buffer_load_dwordx4 v[28:31], v2, s[8:11], s23 offen offset:1024 sc1
  buffer_load_dwordx4 v[32:35], v2, s[8:11], s23 offen offset:2048 sc1
  s_add_u32 s31, s31, 1
  s_add_u32 s30, s30, 1
  s_cmp_lt_u32 s30, 400000
  s_cbranch_scc1 cB_va3_ld
  s_branch cB_abort
cB_va3_last:
  s_waitcnt lgkmcnt(0)
  buffer_store_dwordx4 v[100:103], v2, s[8:11], s24 offen offset:0 sc1
  buffer_store_dwordx4 v[104:107], v2, s[8:11], s24 offen offset:1024 sc1
  buffer_store_dwordx4 v[108:111], v2, s[8:11], s24 offen offset:2048 sc1
  buffer_store_dwordx4 v[4:7], v2, s[8:11], s24 offen offset:3072 sc1
  s_add_u32 s24, s24, 8192
  s_waitcnt vmcnt(0)
  s_mov_b64 exec, 1
  buffer_store_dword v117, v2, s[8:11], s34 offen sc1
  s_mov_b64 exec, -1
  s_add_u32 s34, s34, 8
  s_mov_b64 exec, 1
  buffer_store_dword v117, v2, s[8:11], s34 offen sc1
  s_mov_b64 exec, -1
  s_add_u32 s34, s34, 8
  s_branch cB_done
cB_abort:
  v_mov_b32 v4, 0xdead
  v_mov_b32 v5, 16
  buffer_store_dword v4, v5, s[12:15], 0 offen
  s_branch ch_end
cB_done:
  s_branch ch_end
m_reclaim:
  s_waitcnt vmcnt(0)
  s_lshr_b32 s20, s3, 5
  s_cmp_lg_u32 s16, 0
  s_cbranch_scc1 w0_17
  s_mov_b32 s21, 0
  s_mov_b64 exec, 1
rc_l:
  s_cmp_lg_u32 s70, -1
  s_cbranch_scc1 rc_t
  s_add_u32 s20, s20, 1
  s_cmp_lt_u32 s20, 8
  s_cselect_b32 s20, s20, 0
  s_mov_b32 s70, 0
  s_mov_b32 s3, -1
  s_add_u32 s21, s21, 1
  s_cmp_ge_u32 s21, 9
  s_cbranch_scc1 rc_d
rc_t:
  s_ff0_i32_b32 s22, s70
  s_lshl_b32 s23, 1, s22
  s_and_b32 s71, s20, 4
  s_mul_i32 s71, s71, 12
  s_lshl_b32 s3, s20, 2
  s_add_u32 s3, s3, s71
  v_mov_b32 v242, s23
  v_mov_b32 v243, 32
  buffer_atomic_or v242, v243, s[12:15], s3 offen sc0
  s_waitcnt vmcnt(0)
  v_readfirstlane_b32 s70, v242
  s_lshl_b32 s3, s20, 5
  s_add_u32 s3, s3, s22
  s_bitcmp1_b32 s70, s22
  s_cbranch_scc1 rc_l
rc_d:
  s_mov_b64 exec, -1
  v_mov_b32 v242, s3
w0_17:
  v_mov_b32 v250, 160000
  s_add_u32 s101, s101, 1
  s_barrier
  s_mov_b64 exec, 1
  s_cmp_lg_u32 s16, 0
  s_cbranch_scc1 w0_18
  ds_write_b32 v250, v242 offset:0
  s_waitcnt lgkmcnt(0)
  v_mov_b32 v242, s101
  ds_write_b32 v250, v242 offset:16
  s_waitcnt lgkmcnt(0)
w0_18:
  s_mov_b64 exec, -1
  s_barrier
  ds_read_b32 v242, v250 offset:0
  ds_read_b32 v250, v250 offset:16
  s_waitcnt lgkmcnt(0)
  v_readfirstlane_b32 s3, v242
  v_cmp_ne_u32 vcc, s101, v250
  s_cbranch_vccnz ch_end
  s_cmp_lg_u32 s3, -1
  s_cbranch_scc1 m_start
  v_mov_b32 v250, 0
  s_branch wk_ask
m_bjob:
  v_and_b32 v1, 63, v0
  v_lshlrev_b32 v2, 4, v1
  v_lshrrev_b32 v3, 4, v1
  v_and_b32 v4, 15, v1
  s_sub_u32 s18, s3, 32
  s_mul_i32 s17, s18, 4682
  s_lshr_b32 s17, s17, 16
  s_mul_i32 s20, s17, 14
  s_sub_u32 s19, s18, s20
  s_cmp_ge_u32 s19, 7
  s_cselect_b32 s31, 7, 0
  s_sub_u32 s19, s19, s31
  s_mov_b32 s60, s44
  s_and_b32 s61, s45, 0xffff
  s_mov_b32 s62, 3670016
  s_mov_b32 s63, 0x20000
  s_mov_b32 s56, s46
  s_and_b32 s57, s47, 0xffff
  s_mov_b32 s58, 3670016
  s_mov_b32 s59, 0x20000
  s_lshl_b32 s30, s16, 13
  s_mul_i32 s27, s17, 229376
  s_lshl_b32 s29, s19, 7
  s_add_u32 s27, s27, s29
  v_lshrrev_b32 v7, 3, v1
  v_and_b32 v8, 7, v1
  s_lshl_b32 s29, s16, 6
  v_add_u32 v7, s29, v7
  v_mul_u32_u24 v7, 896, v7
  v_lshl_add_u32 v7, v8, 4, v7
  s_add_u32 m0, s30, 0
  s_add_u32 s22, s27, 0
  buffer_load_dwordx4 v7, s[56:59], s22 offen offset:0 lds
  s_add_u32 s22, s27, 6144
  buffer_load_dwordx4 v7, s[56:59], s22 offen offset:1024 lds
  s_add_u32 s22, s27, 12288
  buffer_load_dwordx4 v7, s[56:59], s22 offen offset:2048 lds
  s_add_u32 s22, s27, 18432
  buffer_load_dwordx4 v7, s[56:59], s22 offen offset:3072 lds
  s_add_u32 m0, s30, 4096
  s_add_u32 s22, s27, 28672
  buffer_load_dwordx4 v7, s[56:59], s22 offen offset:0 lds
  s_add_u32 s22, s27, 34816
  buffer_load_dwordx4 v7, s[56:59], s22 offen offset:1024 lds
  s_add_u32 s22, s27, 40960
  buffer_load_dwordx4 v7, s[56:59], s22 offen offset:2048 lds
  s_add_u32 s22, s27, 47104
  buffer_load_dwordx4 v7, s[56:59], s22 offen offset:3072 lds
  v_lshrrev_b32 v5, 5, v1
  v_and_b32 v6, 31, v1
  s_lshl_b32 s25, s16, 15
  s_add_u32 s25, s25, 32768
  s_lshl_b32 s26, s17, 9
  s_add_u32 s28, s19, s16
  s_cmp_ge_u32 s28, 7
  s_cselect_b32 s20, 7, 0
  s_sub_u32 s28, s28, s20
  s_add_u32 s28, s28, s31
  s_add_u32 s29, s19, s16
  s_add_u32 s29, s29, 4
  s_cmp_ge_u32 s29, 7
  s_cselect_b32 s20, 7, 0
  s_sub_u32 s29, s29, s20
  s_add_u32 s29, s29, s31
  s_lshl_b32 s32, s28, 18
  s_add_u32 s32, s32, s26
  s_lshl_b32 s33, s29, 18
  s_add_u32 s33, s33, s26
  v_xor_b32 v8, v6, v5
  v_lshlrev_b32 v8, 4, v8
  v_lshl_add_u32 v8, v5, 13, v8
  v_xor_b32 v12, 0, v8
  v_xor_b32 v13, 32, v8
  v_add_u32 v13, 15360, v13
  v_xor_b32 v14, 0, v8
  v_add_u32 v14, 30720, v14
  v_xor_b32 v15, 32, v8
  v_add_u32 v15, 46080, v15
  s_add_u32 s20, s16, 0
  s_and_b32 s20, s20, 3
  s_mul_i32 s21, s20, 65600
  s_lshl_b32 s20, s20, 12
  s_add_u32 s48, s20, s25
  s_mov_b32 m0, s48
  v_xor_b32 v16, s21, v12
  buffer_load_dwordx4 v16, s[60:63], s32 offen offset:0 lds
  v_xor_b32 v17, s21, v13
  buffer_load_dwordx4 v17, s[60:63], s32 offen offset:1024 lds
  v_xor_b32 v18, s21, v14
  buffer_load_dwordx4 v18, s[60:63], s32 offen offset:2048 lds
  v_xor_b32 v19, s21, v15
  buffer_load_dwordx4 v19, s[60:63], s32 offen offset:3072 lds
  s_add_u32 s20, s16, 1
  s_and_b32 s20, s20, 3
  s_mul_i32 s21, s20, 65600
  s_lshl_b32 s20, s20, 12
  s_add_u32 s49, s20, s25
  s_mov_b32 m0, s49
  v_xor_b32 v20, s21, v12
  buffer_load_dwordx4 v20, s[60:63], s32 offen offset:0 lds
  v_xor_b32 v21, s21, v13
  buffer_load_dwordx4 v21, s[60:63], s32 offen offset:1024 lds
  v_xor_b32 v22, s21, v14
  buffer_load_dwordx4 v22, s[60:63], s32 offen offset:2048 lds
  v_xor_b32 v23, s21, v15
  buffer_load_dwordx4 v23, s[60:63], s32 offen offset:3072 lds
  s_add_u32 s20, s16, 2
  s_and_b32 s20, s20, 3
  s_mul_i32 s21, s20, 65600
  s_lshl_b32 s20, s20, 12
  s_add_u32 s50, s20, s25
  s_mov_b32 m0, s50
  v_xor_b32 v24, s21, v12
  buffer_load_dwordx4 v24, s[60:63], s32 offen offset:0 lds
  v_xor_b32 v25, s21, v13
  buffer_load_dwordx4 v25, s[60:63], s32 offen offset:1024 lds
  v_xor_b32 v26, s21, v14
  buffer_load_dwordx4 v26, s[60:63], s32 offen offset:2048 lds
  v_xor_b32 v27, s21, v15
  buffer_load_dwordx4 v27, s[60:63], s32 offen offset:3072 lds
  s_add_u32 s20, s16, 3
  s_and_b32 s20, s20, 3
  s_mul_i32 s21, s20, 65600
  s_lshl_b32 s20, s20, 12
  s_add_u32 s51, s20, s25
  s_mov_b32 m0, s51
  v_xor_b32 v28, s21, v12
  buffer_load_dwordx4 v28, s[60:63], s32 offen offset:0 lds
  v_xor_b32 v29, s21, v13
  buffer_load_dwordx4 v29, s[60:63], s32 offen offset:1024 lds
  v_xor_b32 v30, s21, v14
  buffer_load_dwordx4 v30, s[60:63], s32 offen offset:2048 lds
  v_xor_b32 v31, s21, v15
  buffer_load_dwordx4 v31, s[60:63], s32 offen offset:3072 lds
  s_cmp_eq_u32 s16, 3
  s_cbranch_scc1 bj_np1
  s_add_u32 m0, s48, 16384
  s_nop 0
  buffer_load_dwordx4 v16, s[60:63], s33 offen offset:0 lds
  buffer_load_dwordx4 v17, s[60:63], s33 offen offset:1024 lds
  buffer_load_dwordx4 v18, s[60:63], s33 offen offset:2048 lds
  buffer_load_dwordx4 v19, s[60:63], s33 offen offset:3072 lds
  s_add_u32 m0, s49, 16384
  s_nop 0
  buffer_load_dwordx4 v20, s[60:63], s33 offen offset:0 lds
  buffer_load_dwordx4 v21, s[60:63], s33 offen offset:1024 lds
  buffer_load_dwordx4 v22, s[60:63], s33 offen offset:2048 lds
  buffer_load_dwordx4 v23, s[60:63], s33 offen offset:3072 lds
  s_add_u32 m0, s50, 16384
  s_nop 0
  buffer_load_dwordx4 v24, s[60:63], s33 offen offset:0 lds
  buffer_load_dwordx4 v25, s[60:63], s33 offen offset:1024 lds
  buffer_load_dwordx4 v26, s[60:63], s33 offen offset:2048 lds
  buffer_load_dwordx4 v27, s[60:63], s33 offen offset:3072 lds
  s_add_u32 m0, s51, 16384
  s_nop 0
  buffer_load_dwordx4 v28, s[60:63], s33 offen offset:0 lds
  buffer_load_dwordx4 v29, s[60:63], s33 offen offset:1024 lds
  buffer_load_dwordx4 v30, s[60:63], s33 offen offset:2048 lds
  buffer_load_dwordx4 v31, s[60:63], s33 offen offset:3072 lds
bj_np1:
  s_mov_b32 s52, s36
  s_and_b32 s53, s37, 0xffff
  s_mov_b32 s54, 1835008
  s_mov_b32 s55, 0x20000
  s_lshl_b32 s20, s18, 8
  v_add_u32 v95, s20, v0
  s_mov_b32 s21, 9586981
  v_mul_hi_u32 v6, v95, s21
  v_mul_u32_u24 v7, 448, v6
  v_sub_u32 v7, v95, v7
  v_lshrrev_b32 v8, 4, v7
  v_and_b32 v7, 15, v7
  v_lshl_add_u32 v9, v6, 4, v7
  v_mul_u32_u24 v9, 896, v9
  v_lshl_add_u32 v9, v8, 5, v9
  buffer_load_dwordx4 v[84:87], v9, s[52:55], 0 offen
  buffer_load_dwordx4 v[88:91], v9, s[52:55], 0 offen offset:16
  v_mul_u32_u24 v6, 14336, v6
  v_lshl_add_u32 v6, v7, 4, v6
  v_lshl_add_u32 v92, v8, 9, v6
  v_lshrrev_b32 v7, 2, v8
  v_lshl_add_u32 v6, v7, 11, v6
  v_and_b32 v7, 3, v8
  v_lshl_add_u32 v93, v7, 8, v6
  s_mov_b32 s72, s38
  s_and_b32 s73, s39, 0xffff
  s_mov_b32 s74, 7168
  s_mov_b32 s75, 0x20000
  v_min_u32 v6, 223, v0
  v_lshrrev_b32 v7, 3, v6
  v_and_b32 v6, 7, v6
  v_mul_u32_u24 v9, 896, v6
  v_lshl_add_u32 v9, v7, 5, v9
  buffer_load_dwordx4 v[36:39], v9, s[72:75], 0 offen
  buffer_load_dwordx4 v[40:43], v9, s[72:75], 0 offen offset:16
  v_lshlrev_b32 v7, 8, v7
  v_lshl_add_u32 v94, v6, 4, v7
  s_cmp_lt_u32 s16, 2
  s_cselect_b32 s20, s40, s42
  s_cselect_b32 s21, s41, s43
  s_mov_b32 s72, s20
  s_and_b32 s73, s21, 0xffff
  s_mov_b32 s74, 3670016
  s_mov_b32 s75, 0x20000
  s_add_u32 s20, s19, s31
  s_lshl_b32 s21, s20, 5
  s_lshl_b32 s22, s16, 4
  s_add_u32 s21, s21, s22
  s_mul_i32 s20, s20, 14
  s_add_u32 s20, s20, 250
  s_cmp_lt_u32 s16, 2
  s_cselect_b32 s20, s21, s20
  s_lshl_b32 s20, s20, 13
  s_add_u32 s20, s20, s26
  v_lshlrev_b32 v6, 13, v4
  v_lshl_add_u32 v6, v3, 7, v6
  buffer_load_dword v51, v6, s[72:75], s20 offen
  s_cmp_lg_u32 s66, 0
  s_cbranch_scc1 bj_ci
  s_cmp_lg_u32 s16, 0
  s_cbranch_scc1 w0_19
  s_lshr_b32 s70, s3, 5
  s_and_b32 s71, s70, 4
  s_mul_i32 s71, s71, 12
  s_lshl_b32 s70, s70, 2
  s_add_u32 s70, s70, s71
  s_lshl_b32 s71, 1, s3
  v_mov_b32 v44, s71
  v_mov_b32 v45, 32
  s_mov_b64 exec, 1
  buffer_atomic_or v44, v45, s[12:15], s70 offen sc0
  buffer_load_dwordx2 v[46:47], v45, s[12:15], 0 offen offset:96 sc1
  s_mov_b64 exec, -1
w0_19:
bj_ci:
  s_lshl_b32 s30, s19, 6
  s_add_u32 s30, s30, 0
  v_add_u32 v8, s30, v4
  v_mul_u32_u24 v10, 2341, v8
  v_lshrrev_b32 v10, 16, v10
  v_mul_u32_u24 v11, 28, v10
  v_sub_u32 v32, v8, v11
  s_mul_i32 s30, s17, 28
  v_add_u32 v32, s30, v32
  v_lshrrev_b32 v33, 4, v32
  v_and_b32 v32, 15, v32
  s_mov_b32 s30, 401408
  v_mul_lo_u32 v10, v10, s30
  v_mul_u32_u24 v33, 14336, v33
  v_add_u32 v10, v10, v33
  v_lshl_add_u32 v10, v3, 8, v10
  v_lshl_add_u32 v10, v32, 4, v10
  v_add_u32 v12, 6422528, v10
  s_lshl_b32 s30, s19, 6
  s_add_u32 s30, s30, 16
  v_add_u32 v8, s30, v4
  v_mul_u32_u24 v10, 2341, v8
  v_lshrrev_b32 v10, 16, v10
  v_mul_u32_u24 v11, 28, v10
  v_sub_u32 v32, v8, v11
  s_mul_i32 s30, s17, 28
  v_add_u32 v32, s30, v32
  v_lshrrev_b32 v33, 4, v32
  v_and_b32 v32, 15, v32
  s_mov_b32 s30, 401408
  v_mul_lo_u32 v10, v10, s30
  v_mul_u32_u24 v33, 14336, v33
  v_add_u32 v10, v10, v33
  v_lshl_add_u32 v10, v3, 8, v10
  v_lshl_add_u32 v10, v32, 4, v10
  v_add_u32 v13, 6422528, v10
  s_lshl_b32 s30, s19, 6
  s_add_u32 s30, s30, 32
  v_add_u32 v8, s30, v4
  v_mul_u32_u24 v10, 2341, v8
  v_lshrrev_b32 v10, 16, v10
  v_mul_u32_u24 v11, 28, v10
  v_sub_u32 v32, v8, v11
  s_mul_i32 s30, s17, 28
  v_add_u32 v32, s30, v32
  v_lshrrev_b32 v33, 4, v32
  v_and_b32 v32, 15, v32
  s_mov_b32 s30, 401408
  v_mul_lo_u32 v10, v10, s30
  v_mul_u32_u24 v33, 14336, v33
  v_add_u32 v10, v10, v33
  v_lshl_add_u32 v10, v3, 8, v10
  v_lshl_add_u32 v10, v32, 4, v10
  v_add_u32 v14, 6422528, v10
  s_lshl_b32 s30, s19, 6
  s_add_u32 s30, s30, 48
  v_add_u32 v8, s30, v4
  v_mul_u32_u24 v10, 2341, v8
  v_lshrrev_b32 v10, 16, v10
  v_mul_u32_u24 v11, 28, v10
  v_sub_u32 v32, v8, v11
  s_mul_i32 s30, s17, 28
  v_add_u32 v32, s30, v32
  v_lshrrev_b32 v33, 4, v32
  v_and_b32 v32, 15, v32
  s_mov_b32 s30, 401408
  v_mul_lo_u32 v10, v10, s30
  v_mul_u32_u24 v33, 14336, v33
  v_add_u32 v10, v10, v33
  v_lshl_add_u32 v10, v3, 8, v10
  v_lshl_add_u32 v10, v32, 4, v10
  v_add_u32 v15, 6422528, v10
  v_lshrrev_b32 v7, 2, v4
  v_lshlrev_b32 v7, 3, v7
  v_and_b32 v8, 3, v4
  v_add_u32 v7, v7, v8
  v_xor_b32 v10, v3, v4
  v_lshlrev_b32 v10, 4, v10
  v_lshl_add_u32 v10, v7, 9, v10
  v_add_u32 v10, s25, v10
  v_xor_b32 v32, 0, v10
  v_xor_b32 v33, 64, v10
  v_xor_b32 v34, 128, v10
  v_xor_b32 v35, 192, v10
  v_lshrrev_b32 v7, 2, v4
  v_lshl_add_u32 v7, v3, 3, v7
  v_lshlrev_b32 v7, 7, v7
  v_and_b32 v8, 3, v4
  v_lshl_add_u32 v7, v8, 3, v7
  s_waitcnt vmcnt(37)
  s_cmp_lg_u32 s16, 3
  s_cbranch_scc1 w3_20
  s_waitcnt vmcnt(21)
w3_20:
  s_barrier
  ds_read_b64_tr_b16 v[128:129], v7 offset:0
  ds_read_b64_tr_b16 v[130:131], v7 offset:512
  ds_read_b64_tr_b16 v[132:133], v7 offset:4096
  ds_read_b64_tr_b16 v[134:135], v7 offset:4608
  ds_read_b64_tr_b16 v[136:137], v7 offset:8192
  ds_read_b64_tr_b16 v[138:139], v7 offset:8704
  ds_read_b64_tr_b16 v[140:141], v7 offset:12288
  ds_read_b64_tr_b16 v[142:143], v7 offset:12800
  s_waitcnt lgkmcnt(6)
  ds_read_b64_tr_b16 v[144:145], v7 offset:16384
  ds_read_b64_tr_b16 v[146:147], v7 offset:16896
  ds_read_b64_tr_b16 v[148:149], v7 offset:20480
  ds_read_b64_tr_b16 v[150:151], v7 offset:20992
  ds_read_b64_tr_b16 v[152:153], v7 offset:24576
  ds_read_b64_tr_b16 v[154:155], v7 offset:25088
  ds_read_b64_tr_b16 v[156:157], v7 offset:28672
  ds_read_b64_tr_b16 v[158:159], v7 offset:29184
  s_waitcnt lgkmcnt(6)
  ds_read_b64_tr_b16 v[160:161], v7 offset:32
  ds_read_b64_tr_b16 v[162:163], v7 offset:544
  ds_read_b64_tr_b16 v[164:165], v7 offset:4128
  ds_read_b64_tr_b16 v[166:167], v7 offset:4640
  ds_read_b64_tr_b16 v[168:169], v7 offset:8224
  ds_read_b64_tr_b16 v[170:171], v7 offset:8736
  ds_read_b64_tr_b16 v[172:173], v7 offset:12320
  ds_read_b64_tr_b16 v[174:175], v7 offset:12832
  s_waitcnt lgkmcnt(6)
  ds_read_b64_tr_b16 v[176:177], v7 offset:16416
  ds_read_b64_tr_b16 v[178:179], v7 offset:16928
  ds_read_b64_tr_b16 v[180:181], v7 offset:20512
  ds_read_b64_tr_b16 v[182:183], v7 offset:21024
  ds_read_b64_tr_b16 v[184:185], v7 offset:24608
  ds_read_b64_tr_b16 v[186:187], v7 offset:25120
  ds_read_b64_tr_b16 v[188:189], v7 offset:28704
  ds_read_b64_tr_b16 v[190:191], v7 offset:29216
  s_waitcnt lgkmcnt(6)
  ds_read_b64_tr_b16 v[192:193], v7 offset:64
  ds_read_b64_tr_b16 v[194:195], v7 offset:576
  ds_read_b64_tr_b16 v[196:197], v7 offset:4160
  ds_read_b64_tr_b16 v[198:199], v7 offset:4672
  ds_read_b64_tr_b16 v[200:201], v7 offset:8256
  ds_read_b64_tr_b16 v[202:203], v7 offset:8768
  ds_read_b64_tr_b16 v[204:205], v7 offset:12352
  ds_read_b64_tr_b16 v[206:207], v7 offset:12864
  s_waitcnt lgkmcnt(6)
  ds_read_b64_tr_b16 v[208:209], v7 offset:16448
  ds_read_b64_tr_b16 v[210:211], v7 offset:16960
  ds_read_b64_tr_b16 v[212:213], v7 offset:20544
  ds_read_b64_tr_b16 v[214:215], v7 offset:21056
  ds_read_b64_tr_b16 v[216:217], v7 offset:24640
  ds_read_b64_tr_b16 v[218:219], v7 offset:25152
  ds_read_b64_tr_b16 v[220:221], v7 offset:28736
  ds_read_b64_tr_b16 v[222:223], v7 offset:29248
  s_waitcnt lgkmcnt(6)
  ds_read_b64_tr_b16 v[224:225], v7 offset:96
  ds_read_b64_tr_b16 v[226:227], v7 offset:608
  ds_read_b64_tr_b16 v[228:229], v7 offset:4192
  ds_read_b64_tr_b16 v[230:231], v7 offset:4704
  ds_read_b64_tr_b16 v[232:233], v7 offset:8288
  ds_read_b64_tr_b16 v[234:235], v7 offset:8800
  ds_read_b64_tr_b16 v[236:237], v7 offset:12384
  ds_read_b64_tr_b16 v[238:239], v7 offset:12896
  s_waitcnt lgkmcnt(6)
  ds_read_b64_tr_b16 v[240:241], v7 offset:16480
  ds_read_b64_tr_b16 v[242:243], v7 offset:16992
  ds_read_b64_tr_b16 v[244:245], v7 offset:20576
  ds_read_b64_tr_b16 v[246:247], v7 offset:21088
  ds_read_b64_tr_b16 v[248:249], v7 offset:24672
  ds_read_b64_tr_b16 v[250:251], v7 offset:25184
  ds_read_b64_tr_b16 v[252:253], v7 offset:28768
  ds_read_b64_tr_b16 v[254:255], v7 offset:29280
  s_waitcnt lgkmcnt(6)
  s_waitcnt vmcnt(21) lgkmcnt(0)
  s_cmp_lg_u32 s16, 3
  s_cbranch_scc1 w3_21
  s_waitcnt vmcnt(5)
w3_21:
  ds_read_b128 v[52:55], v32 offset:0
  ds_read_b128 v[56:59], v33 offset:0
  ds_read_b128 v[60:63], v34 offset:0
  ds_read_b128 v[64:67], v35 offset:0
  s_waitcnt lgkmcnt(3)
  v_mfma_f32_16x16x32_bf16 v[96:99], v[52:55], v[128:131], 0
  v_mfma_f32_16x16x32_bf16 v[100:103], v[52:55], v[160:163], 0
  v_mfma_f32_16x16x32_bf16 v[104:107], v[52:55], v[192:195], 0
  v_mfma_f32_16x16x32_bf16 v[108:111], v[52:55], v[224:227], 0
  ds_read_b128 v[52:55], v32 offset:256
  s_waitcnt lgkmcnt(3)
  v_mfma_f32_16x16x32_bf16 v[96:99], v[56:59], v[132:135], v[96:99]
  v_mfma_f32_16x16x32_bf16 v[100:103], v[56:59], v[164:167], v[100:103]
  v_mfma_f32_16x16x32_bf16 v[104:107], v[56:59], v[196:199], v[104:107]
  v_mfma_f32_16x16x32_bf16 v[108:111], v[56:59], v[228:231], v[108:111]
  ds_read_b128 v[56:59], v33 offset:256
  s_waitcnt lgkmcnt(3)
  v_mfma_f32_16x16x32_bf16 v[96:99], v[60:63], v[136:139], v[96:99]
  v_mfma_f32_16x16x32_bf16 v[100:103], v[60:63], v[168:171], v[100:103]
  v_mfma_f32_16x16x32_bf16 v[104:107], v[60:63], v[200:203], v[104:107]
  v_mfma_f32_16x16x32_bf16 v[108:111], v[60:63], v[232:235], v[108:111]
  ds_read_b128 v[60:63], v34 offset:256
  s_waitcnt lgkmcnt(3)
  v_mfma_f32_16x16x32_bf16 v[96:99], v[64:67], v[140:143], v[96:99]
  v_mfma_f32_16x16x32_bf16 v[100:103], v[64:67], v[172:175], v[100:103]
  v_mfma_f32_16x16x32_bf16 v[104:107], v[64:67], v[204:207], v[104:107]
  v_mfma_f32_16x16x32_bf16 v[108:111], v[64:67], v[236:239], v[108:111]
  ds_read_b128 v[64:67], v35 offset:256
  s_waitcnt lgkmcnt(3)
  v_mfma_f32_16x16x32_bf16 v[96:99], v[52:55], v[144:147], v[96:99]
  v_mfma_f32_16x16x32_bf16 v[100:103], v[52:55], v[176:179], v[100:103]
  v_mfma_f32_16x16x32_bf16 v[104:107], v[52:55], v[208:211], v[104:107]
  v_mfma_f32_16x16x32_bf16 v[108:111], v[52:55], v[240:243], v[108:111]
  ds_read_b128 v[52:55], v32 offset:2048
  s_waitcnt lgkmcnt(3)
  v_mfma_f32_16x16x32_bf16 v[96:99], v[56:59], v[148:151], v[96:99]
  v_mfma_f32_16x16x32_bf16 v[100:103], v[56:59], v[180:183], v[100:103]
  v_mfma_f32_16x16x32_bf16 v[104:107], v[56:59], v[212:215], v[104:107]
  v_mfma_f32_16x16x32_bf16 v[108:111], v[56:59], v[244:247], v[108:111]
  ds_read_b128 v[56:59], v33 offset:2048
  s_waitcnt lgkmcnt(3)
  v_mfma_f32_16x16x32_bf16 v[96:99], v[60:63], v[152:155], v[96:99]
  v_mfma_f32_16x16x32_bf16 v[100:103], v[60:63], v[184:187], v[100:103]
  v_mfma_f32_16x16x32_bf16 v[104:107], v[60:63], v[216:219], v[104:107]
  v_mfma_f32_16x16x32_bf16 v[108:111], v[60:63], v[248:251], v[108:111]
  ds_read_b128 v[60:63], v34 offset:2048
  s_waitcnt lgkmcnt(3)
  v_mfma_f32_16x16x32_bf16 v[96:99], v[64:67], v[156:159], v[96:99]
  v_mfma_f32_16x16x32_bf16 v[100:103], v[64:67], v[188:191], v[100:103]
  v_mfma_f32_16x16x32_bf16 v[104:107], v[64:67], v[220:223], v[104:107]
  v_mfma_f32_16x16x32_bf16 v[108:111], v[64:67], v[252:255], v[108:111]
  ds_read_b128 v[64:67], v35 offset:2048
  s_waitcnt lgkmcnt(3)
  v_mfma_f32_16x16x32_bf16 v[112:115], v[52:55], v[128:131], 0
  v_mfma_f32_16x16x32_bf16 v[116:119], v[52:55], v[160:163], 0
  v_mfma_f32_16x16x32_bf16 v[120:123], v[52:55], v[192:195], 0
  v_mfma_f32_16x16x32_bf16 v[124:127], v[52:55], v[224:227], 0
  ds_read_b128 v[52:55], v32 offset:2304
  s_waitcnt lgkmcnt(3)
  v_mfma_f32_16x16x32_bf16 v[112:115], v[56:59], v[132:135], v[112:115]
  v_mfma_f32_16x16x32_bf16 v[116:119], v[56:59], v[164:167], v[116:119]
  v_mfma_f32_16x16x32_bf16 v[120:123], v[56:59], v[196:199], v[120:123]
  v_mfma_f32_16x16x32_bf16 v[124:127], v[56:59], v[228:231], v[124:127]
  ds_read_b128 v[56:59], v33 offset:2304
  s_waitcnt lgkmcnt(3)
  v_mfma_f32_16x16x32_bf16 v[112:115], v[60:63], v[136:139], v[112:115]
  v_mfma_f32_16x16x32_bf16 v[116:119], v[60:63], v[168:171], v[116:119]
  v_mfma_f32_16x16x32_bf16 v[120:123], v[60:63], v[200:203], v[120:123]
  v_mfma_f32_16x16x32_bf16 v[124:127], v[60:63], v[232:235], v[124:127]
  ds_read_b128 v[60:63], v34 offset:2304
  s_waitcnt lgkmcnt(3)
  v_mfma_f32_16x16x32_bf16 v[112:115], v[64:67], v[140:143], v[112:115]
  v_mfma_f32_16x16x32_bf16 v[116:119], v[64:67], v[172:175], v[116:119]
  v_mfma_f32_16x16x32_bf16 v[120:123], v[64:67], v[204:207], v[120:123]
  v_mfma_f32_16x16x32_bf16 v[124:127], v[64:67], v[236:239], v[124:127]
  ds_read_b128 v[64:67], v35 offset:2304
  s_waitcnt lgkmcnt(3)
  v_mfma_f32_16x16x32_bf16 v[112:115], v[52:55], v[144:147], v[112:115]
  v_mfma_f32_16x16x32_bf16 v[116:119], v[52:55], v[176:179], v[116:119]
  v_mfma_f32_16x16x32_bf16 v[120:123], v[52:55], v[208:211], v[120:123]
  v_mfma_f32_16x16x32_bf16 v[124:127], v[52:55], v[240:243], v[124:127]
  s_waitcnt lgkmcnt(2)
  v_mfma_f32_16x16x32_bf16 v[112:115], v[56:59], v[148:151], v[112:115]
  v_mfma_f32_16x16x32_bf16 v[116:119], v[56:59], v[180:183], v[116:119]
  v_mfma_f32_16x16x32_bf16 v[120:123], v[56:59], v[212:215], v[120:123]
  v_mfma_f32_16x16x32_bf16 v[124:127], v[56:59], v[244:247], v[124:127]
  s_waitcnt lgkmcnt(1)
  v_mfma_f32_16x16x32_bf16 v[112:115], v[60:63], v[152:155], v[112:115]
  v_mfma_f32_16x16x32_bf16 v[116:119], v[60:63], v[184:187], v[116:119]
  v_mfma_f32_16x16x32_bf16 v[120:123], v[60:63], v[216:219], v[120:123]
  v_mfma_f32_16x16x32_bf16 v[124:127], v[60:63], v[248:251], v[124:127]
  s_waitcnt lgkmcnt(0)
  v_mfma_f32_16x16x32_bf16 v[112:115], v[64:67], v[156:159], v[112:115]
  v_mfma_f32_16x16x32_bf16 v[116:119], v[64:67], v[188:191], v[116:119]
  v_mfma_f32_16x16x32_bf16 v[120:123], v[64:67], v[220:223], v[120:123]
  v_mfma_f32_16x16x32_bf16 v[124:127], v[64:67], v[252:255], v[124:127]
  s_cmp_lg_u32 s66, 0
  s_cbranch_scc1 bj_cf
  s_cmp_lg_u32 s16, 0
  s_cbranch_scc1 w0_22
  s_waitcnt vmcnt(0)
  v_readfirstlane_b32 s70, v46
  s_cmp_lg_u32 s70, 0
  s_cbranch_scc1 bj_nz
  v_mov_b32 v45, 128
  v_mov_b32 v46, s88
  v_mov_b32 v47, s89
  v_mov_b32 v48, 0
  v_mov_b32 v49, 0
  s_mov_b64 exec, 1
  buffer_atomic_cmpswap_x2 v[46:49], v45, s[12:15], 0 offen sc0
  s_mov_b64 exec, -1
  s_waitcnt vmcnt(0)
  v_readfirstlane_b32 s70, v46
  s_cmp_lg_u32 s70, 0
  s_cbranch_scc1 bj_nz
  v_mov_b32 v46, s88
  v_mov_b32 v47, s89
bj_nz:
w0_22:
  v_mov_b32 v45, 160000
  s_add_u32 s101, s101, 1
  s_barrier
  s_mov_b64 exec, 1
  s_cmp_lg_u32 s16, 0
  s_cbranch_scc1 w0_23
  ds_write_b32 v45, v44 offset:0
  ds_write_b32 v45, v46 offset:4
  ds_write_b32 v45, v47 offset:8
  s_waitcnt lgkmcnt(0)
  v_mov_b32 v44, s101
  ds_write_b32 v45, v44 offset:16
  s_waitcnt lgkmcnt(0)
w0_23:
  s_mov_b64 exec, -1
  s_barrier
  ds_read_b32 v44, v45 offset:0
  ds_read_b32 v46, v45 offset:4
  ds_read_b32 v47, v45 offset:8
  ds_read_b32 v45, v45 offset:16
  s_waitcnt lgkmcnt(0)
  v_readfirstlane_b32 s70, v44
  v_readfirstlane_b32 s88, v46
  v_readfirstlane_b32 s89, v47
  v_cmp_ne_u32 vcc, s101, v45
  s_cbranch_vccnz ch_end
  s_mov_b32 s66, 1
  s_bitcmp1_b32 s70, s3
  s_cbranch_scc1 m_reclaim
bj_cf:
  s_lshl_b32 s30, s28, 10
  v_cvt_pk_bf16_f32 v68, v96, v97
  v_cvt_pk_bf16_f32 v69, v98, v99
  v_cvt_pk_bf16_f32 v70, v112, v113
  v_cvt_pk_bf16_f32 v71, v114, v115
  buffer_store_dwordx4 v[68:71], v12, s[8:11], s30 offen sc1
  v_cvt_pk_bf16_f32 v72, v100, v101
  v_cvt_pk_bf16_f32 v73, v102, v103
  v_cvt_pk_bf16_f32 v74, v116, v117
  v_cvt_pk_bf16_f32 v75, v118, v119
  buffer_store_dwordx4 v[72:75], v13, s[8:11], s30 offen sc1
  v_cvt_pk_bf16_f32 v76, v104, v105
  v_cvt_pk_bf16_f32 v77, v106, v107
  v_cvt_pk_bf16_f32 v78, v120, v121
  v_cvt_pk_bf16_f32 v79, v122, v123
  buffer_store_dwordx4 v[76:79], v14, s[8:11], s30 offen sc1
  v_cvt_pk_bf16_f32 v80, v108, v109
  v_cvt_pk_bf16_f32 v81, v110, v111
  v_cvt_pk_bf16_f32 v82, v124, v125
  v_cvt_pk_bf16_f32 v83, v126, v127
  buffer_store_dwordx4 v[80:83], v15, s[8:11], s30 offen sc1
  s_cmp_eq_u32 s16, 3
  s_cbranch_scc1 bj_w3
  s_waitcnt vmcnt(9)
  ds_read_b128 v[52:55], v32 offset:16384
  ds_read_b128 v[56:59], v33 offset:16384
  ds_read_b128 v[60:63], v34 offset:16384
  ds_read_b128 v[64:67], v35 offset:16384
  s_waitcnt lgkmcnt(3)
  v_mfma_f32_16x16x32_bf16 v[96:99], v[52:55], v[128:131], 0
  v_mfma_f32_16x16x32_bf16 v[100:103], v[52:55], v[160:163], 0
  v_mfma_f32_16x16x32_bf16 v[104:107], v[52:55], v[192:195], 0
  v_mfma_f32_16x16x32_bf16 v[108:111], v[52:55], v[224:227], 0
  ds_read_b128 v[52:55], v32 offset:16640
  s_waitcnt lgkmcnt(3)
  v_mfma_f32_16x16x32_bf16 v[96:99], v[56:59], v[132:135], v[96:99]
  v_mfma_f32_16x16x32_bf16 v[100:103], v[56:59], v[164:167], v[100:103]
  v_mfma_f32_16x16x32_bf16 v[104:107], v[56:59], v[196:199], v[104:107]
  v_mfma_f32_16x16x32_bf16 v[108:111], v[56:59], v[228:231], v[108:111]
  ds_read_b128 v[56:59], v33 offset:16640
  s_waitcnt lgkmcnt(3)
  v_mfma_f32_16x16x32_bf16 v[96:99], v[60:63], v[136:139], v[96:99]
  v_mfma_f32_16x16x32_bf16 v[100:103], v[60:63], v[168:171], v[100:103]
  v_mfma_f32_16x16x32_bf16 v[104:107], v[60:63], v[200:203], v[104:107]
  v_mfma_f32_16x16x32_bf16 v[108:111], v[60:63], v[232:235], v[108:111]
  ds_read_b128 v[60:63], v34 offset:16640
  s_waitcnt lgkmcnt(3)
  v_mfma_f32_16x16x32_bf16 v[96:99], v[64:67], v[140:143], v[96:99]
  v_mfma_f32_16x16x32_bf16 v[100:103], v[64:67], v[172:175], v[100:103]
  v_mfma_f32_16x16x32_bf16 v[104:107], v[64:67], v[204:207], v[104:107]
  v_mfma_f32_16x16x32_bf16 v[108:111], v[64:67], v[236:239], v[108:111]
  ds_read_b128 v[64:67], v35 offset:16640
  s_waitcnt lgkmcnt(3)
  v_mfma_f32_16x16x32_bf16 v[96:99], v[52:55], v[144:147], v[96:99]
  v_mfma_f32_16x16x32_bf16 v[100:103], v[52:55], v[176:179], v[100:103]
  v_mfma_f32_16x16x32_bf16 v[104:107], v[52:55], v[208:211], v[104:107]
  v_mfma_f32_16x16x32_bf16 v[108:111], v[52:55], v[240:243], v[108:111]
  ds_read_b128 v[52:55], v32 offset:18432
  s_waitcnt lgkmcnt(3)
  v_mfma_f32_16x16x32_bf16 v[96:99], v[56:59], v[148:151], v[96:99]
  v_mfma_f32_16x16x32_bf16 v[100:103], v[56:59], v[180:183], v[100:103]
  v_mfma_f32_16x16x32_bf16 v[104:107], v[56:59], v[212:215], v[104:107]
  v_mfma_f32_16x16x32_bf16 v[108:111], v[56:59], v[244:247], v[108:111]
  ds_read_b128 v[56:59], v33 offset:18432
  s_waitcnt lgkmcnt(3)
  v_mfma_f32_16x16x32_bf16 v[96:99], v[60:63], v[152:155], v[96:99]
  v_mfma_f32_16x16x32_bf16 v[100:103], v[60:63], v[184:187], v[100:103]
  v_mfma_f32_16x16x32_bf16 v[104:107], v[60:63], v[216:219], v[104:107]
  v_mfma_f32_16x16x32_bf16 v[108:111], v[60:63], v[248:251], v[108:111]
  ds_read_b128 v[60:63], v34 offset:18432
  s_waitcnt lgkmcnt(3)
  v_mfma_f32_16x16x32_bf16 v[96:99], v[64:67], v[156:159], v[96:99]
  v_mfma_f32_16x16x32_bf16 v[100:103], v[64:67], v[188:191], v[100:103]
  v_mfma_f32_16x16x32_bf16 v[104:107], v[64:67], v[220:223], v[104:107]
  v_mfma_f32_16x16x32_bf16 v[108:111], v[64:67], v[252:255], v[108:111]
  ds_read_b128 v[64:67], v35 offset:18432
  s_waitcnt lgkmcnt(3)
  v_mfma_f32_16x16x32_bf16 v[112:115], v[52:55], v[128:131], 0
  v_mfma_f32_16x16x32_bf16 v[116:119], v[52:55], v[160:163], 0
  v_mfma_f32_16x16x32_bf16 v[120:123], v[52:55], v[192:195], 0
  v_mfma_f32_16x16x32_bf16 v[124:127], v[52:55], v[224:227], 0
  ds_read_b128 v[52:55], v32 offset:18688
  s_waitcnt lgkmcnt(3)
  v_mfma_f32_16x16x32_bf16 v[112:115], v[56:59], v[132:135], v[112:115]
  v_mfma_f32_16x16x32_bf16 v[116:119], v[56:59], v[164:167], v[116:119]
  v_mfma_f32_16x16x32_bf16 v[120:123], v[56:59], v[196:199], v[120:123]
  v_mfma_f32_16x16x32_bf16 v[124:127], v[56:59], v[228:231], v[124:127]
  ds_read_b128 v[56:59], v33 offset:18688
  s_waitcnt lgkmcnt(3)
  v_mfma_f32_16x16x32_bf16 v[112:115], v[60:63], v[136:139], v[112:115]
  v_mfma_f32_16x16x32_bf16 v[116:119], v[60:63], v[168:171], v[116:119]
  v_mfma_f32_16x16x32_bf16 v[120:123], v[60:63], v[200:203], v[120:123]
  v_mfma_f32_16x16x32_bf16 v[124:127], v[60:63], v[232:235], v[124:127]
  ds_read_b128 v[60:63], v34 offset:18688
  s_waitcnt lgkmcnt(3)
  v_mfma_f32_16x16x32_bf16 v[112:115], v[64:67], v[140:143], v[112:115]
  v_mfma_f32_16x16x32_bf16 v[116:119], v[64:67], v[172:175], v[116:119]
  v_mfma_f32_16x16x32_bf16 v[120:123], v[64:67], v[204:207], v[120:123]
  v_mfma_f32_16x16x32_bf16 v[124:127], v[64:67], v[236:239], v[124:127]
  ds_read_b128 v[64:67], v35 offset:18688
  s_waitcnt lgkmcnt(3)
  v_mfma_f32_16x16x32_bf16 v[112:115], v[52:55], v[144:147], v[112:115]
  v_mfma_f32_16x16x32_bf16 v[116:119], v[52:55], v[176:179], v[116:119]
  v_mfma_f32_16x16x32_bf16 v[120:123], v[52:55], v[208:211], v[120:123]
  v_mfma_f32_16x16x32_bf16 v[124:127], v[52:55], v[240:243], v[124:127]
  s_waitcnt lgkmcnt(2)
  v_mfma_f32_16x16x32_bf16 v[112:115], v[56:59], v[148:151], v[112:115]
  v_mfma_f32_16x16x32_bf16 v[116:119], v[56:59], v[180:183], v[116:119]
  v_mfma_f32_16x16x32_bf16 v[120:123], v[56:59], v[212:215], v[120:123]
  v_mfma_f32_16x16x32_bf16 v[124:127], v[56:59], v[244:247], v[124:127]
  s_waitcnt lgkmcnt(1)
  v_mfma_f32_16x16x32_bf16 v[112:115], v[60:63], v[152:155], v[112:115]
  v_mfma_f32_16x16x32_bf16 v[116:119], v[60:63], v[184:187], v[116:119]
  v_mfma_f32_16x16x32_bf16 v[120:123], v[60:63], v[216:219], v[120:123]
  v_mfma_f32_16x16x32_bf16 v[124:127], v[60:63], v[248:251], v[124:127]
  s_waitcnt lgkmcnt(0)
  v_mfma_f32_16x16x32_bf16 v[112:115], v[64:67], v[156:159], v[112:115]
  v_mfma_f32_16x16x32_bf16 v[116:119], v[64:67], v[188:191], v[116:119]
  v_mfma_f32_16x16x32_bf16 v[120:123], v[64:67], v[220:223], v[120:123]
  v_mfma_f32_16x16x32_bf16 v[124:127], v[64:67], v[252:255], v[124:127]
  s_lshl_b32 s30, s29, 10
  v_cvt_pk_bf16_f32 v68, v96, v97
  v_cvt_pk_bf16_f32 v69, v98, v99
  v_cvt_pk_bf16_f32 v70, v112, v113
  v_cvt_pk_bf16_f32 v71, v114, v115
  buffer_store_dwordx4 v[68:71], v12, s[8:11], s30 offen sc1
  v_cvt_pk_bf16_f32 v72, v100, v101
  v_cvt_pk_bf16_f32 v73, v102, v103
  v_cvt_pk_bf16_f32 v74, v116, v117
  v_cvt_pk_bf16_f32 v75, v118, v119
  buffer_store_dwordx4 v[72:75], v13, s[8:11], s30 offen sc1
  v_cvt_pk_bf16_f32 v76, v104, v105
  v_cvt_pk_bf16_f32 v77, v106, v107
  v_cvt_pk_bf16_f32 v78, v120, v121
  v_cvt_pk_bf16_f32 v79, v122, v123
  buffer_store_dwordx4 v[76:79], v14, s[8:11], s30 offen sc1
  v_cvt_pk_bf16_f32 v80, v108, v109
  v_cvt_pk_bf16_f32 v81, v110, v111
  v_cvt_pk_bf16_f32 v82, v124, v125
  v_cvt_pk_bf16_f32 v83, v126, v127
  buffer_store_dwordx4 v[80:83], v15, s[8:11], s30 offen sc1
bj_w3:
  s_lshl_b32 s77, s19, 8
  s_lshl_b32 s21, s17, 4
  s_add_u32 s77, s77, s21
  s_cmp_lg_u32 s31, 0
  s_cselect_b32 s21, 8, 0
  s_add_u32 s77, s77, s21
  s_add_u32 s77, s77, 88588288
  s_add_u32 s78, s77, 2048
  s_waitcnt vmcnt(4)
  v_mov_b32 v96, v84
  v_mov_b32 v100, v85
  v_min_u32 v104, -2, v36
  v_min_u32 v108, -2, v37
  v_mov_b32 v97, v86
  v_mov_b32 v101, v87
  v_min_u32 v105, -2, v38
  v_min_u32 v109, -2, v39
  v_mov_b32 v98, v88
  v_mov_b32 v102, v89
  v_min_u32 v106, -2, v40
  v_min_u32 v110, -2, v41
  v_mov_b32 v99, v90
  v_mov_b32 v103, v91
  v_min_u32 v107, -2, v42
  v_min_u32 v111, -2, v43
  s_mov_b32 s20, 71565312
  s_mov_b32 s21, 73400320
  buffer_store_dwordx4 v[84:87], v92, s[8:11], s20 offen sc1
  buffer_store_dwordx4 v[88:91], v92, s[8:11], s20 offen offset:256 sc1
  buffer_store_dwordx4 v[96:99], v93, s[8:11], s21 offen sc1
  buffer_store_dwordx4 v[100:103], v93, s[8:11], s21 offen offset:1024 sc1
  s_cmp_lg_u32 s18, 0
  s_cbranch_scc1 bk_nm
  s_mov_b32 s20, 75235328
  s_mov_b32 s21, 88068096
  buffer_store_dwordx4 v[104:107], v94, s[8:11], s20 offen sc1
  buffer_store_dwordx4 v[108:111], v94, s[8:11], s20 offen offset:128 sc1
  buffer_store_dwordx4 v[104:107], v94, s[8:11], s21 offen sc1
  buffer_store_dwordx4 v[108:111], v94, s[8:11], s21 offen offset:128 sc1
bk_nm:
  s_mov_b32 s23, 75235328
  v_add_u32 v6, 448, v95
  v_subrev_u32 v7, 1344, v6
  v_mov_b32 v52, -1
  v_mov_b32 v9, 0
  v_cmp_gt_u32 vcc, 256, v7
  s_nop 1
  v_cndmask_b32 v52, v52, v9, vcc
  v_mov_b32 v53, v52
  v_mov_b32 v54, v52
  v_mov_b32 v55, v52
  v_lshlrev_b32 v8, 4, v6
  v_mov_b32 v9, 0x10000000
  v_cmp_lt_u32 vcc, 105599, v6
  s_nop 1
  v_cndmask_b32 v8, v8, v9, vcc
  buffer_store_dwordx4 v[52:55], v8, s[8:11], s23 offen sc1
  v_add_u32 v6, 57792, v95
  v_subrev_u32 v7, 1344, v6
  v_mov_b32 v56, -1
  v_mov_b32 v9, 0
  v_cmp_gt_u32 vcc, 256, v7
  s_nop 1
  v_cndmask_b32 v56, v56, v9, vcc
  v_mov_b32 v57, v56
  v_mov_b32 v58, v56
  v_mov_b32 v59, v56
  v_lshlrev_b32 v8, 4, v6
  v_mov_b32 v9, 0x10000000
  v_cmp_lt_u32 vcc, 105599, v6
  s_nop 1
  v_cndmask_b32 v8, v8, v9, vcc
  buffer_store_dwordx4 v[56:59], v8, s[8:11], s23 offen sc1
  s_mov_b32 s23, 87945216
  v_add_u32 v6, 448, v95
  v_cmp_gt_u32 vcc, 7680, v95
  s_nop 1
  v_cndmask_b32 v6, v6, v95, vcc
  v_subrev_u32 v7, 36352, v6
  v_mov_b32 v60, -1
  v_mov_b32 v9, 0
  v_cmp_gt_u32 vcc, 1048576, v7
  s_nop 1
  v_cndmask_b32 v60, v60, v9, vcc
  v_mov_b32 v61, v60
  v_mov_b32 v62, v60
  v_mov_b32 v63, v60
  v_lshlrev_b32 v8, 4, v6
  v_mov_b32 v9, 0x10000000
  v_cmp_lt_u32 vcc, 40191, v6
  s_nop 1
  v_cndmask_b32 v8, v8, v9, vcc
  buffer_store_dwordx4 v[60:63], v8, s[8:11], s23 offen sc1
  s_barrier
  s_mov_b32 s56, s40
  s_and_b32 s57, s41, 0xffff
  s_mov_b32 s58, 3670016
  s_mov_b32 s59, 0x20000
  s_mov_b32 s60, s42
  s_and_b32 s61, s43, 0xffff
  s_mov_b32 s62, 3670016
  s_mov_b32 s63, 0x20000
  s_add_u32 s28, s31, s19
  v_lshrrev_b32 v5, 5, v1
  v_and_b32 v6, 31, v1
  v_xor_b32 v6, v6, v5
  v_lshlrev_b32 v6, 4, v6
  v_lshl_add_u32 v6, v5, 13, v6
  s_lshl_b32 s20, s16, 6
  v_xor_b32 v7, s20, v6
  s_lshl_b32 s22, s28, 18
  s_lshl_b32 s21, s16, 16
  s_add_u32 s22, s22, s21
  s_add_u32 s22, s22, s26
  s_lshl_b32 m0, s16, 12
  v_xor_b32 v8, 0, v7
  buffer_load_dwordx4 v8, s[56:59], s22 offen offset:0 lds
  v_xor_b32 v8, 32, v7
  v_add_u32 v8, 15360, v8
  buffer_load_dwordx4 v8, s[56:59], s22 offen offset:1024 lds
  v_xor_b32 v8, 0, v7
  v_add_u32 v8, 30720, v8
  buffer_load_dwordx4 v8, s[56:59], s22 offen offset:2048 lds
  v_xor_b32 v8, 32, v7
  v_add_u32 v8, 46080, v8
  buffer_load_dwordx4 v8, s[56:59], s22 offen offset:3072 lds
  v_xor_b32 v16, 0, v6
  v_xor_b32 v17, 32, v6
  v_add_u32 v17, 31744, v17
  v_xor_b32 v18, 64, v6
  v_add_u32 v18, 129024, v18
  v_xor_b32 v19, 96, v6
  v_add_u32 v19, 160768, v19
  v_xor_b32 v20, 128, v6
  v_add_u32 v20, 262144, v20
  v_xor_b32 v21, 160, v6
  v_add_u32 v21, 293888, v21
  v_xor_b32 v22, 192, v6
  v_add_u32 v22, 391168, v22
  v_xor_b32 v23, 224, v6
  v_add_u32 v23, 422912, v23
  s_lshr_b32 s20, s16, 1
  s_lshl_b32 s20, s20, 16
  s_and_b32 s21, s16, 1
  s_lshl_b32 s21, s21, 14
  s_add_u32 s20, s20, s21
  s_add_u32 s29, s20, s26
  s_mul_i32 s25, s16, 24576
  s_add_u32 s25, s25, 16384
  s_add_u32 s22, s29, 2097152
  s_add_u32 m0, s25, 0
  s_nop 0
  buffer_load_dwordx4 v16, s[60:63], s22 offen offset:0 lds
  buffer_load_dwordx4 v17, s[60:63], s22 offen offset:1024 lds
  buffer_load_dwordx4 v18, s[60:63], s22 offen offset:2048 lds
  buffer_load_dwordx4 v19, s[60:63], s22 offen offset:3072 lds
  s_add_u32 m0, s25, 4096
  s_nop 0
  buffer_load_dwordx4 v20, s[60:63], s22 offen offset:0 lds
  buffer_load_dwordx4 v21, s[60:63], s22 offen offset:1024 lds
  buffer_load_dwordx4 v22, s[60:63], s22 offen offset:2048 lds
  buffer_load_dwordx4 v23, s[60:63], s22 offen offset:3072 lds
  s_waitcnt vmcnt(12)
  s_barrier
  s_cmp_lg_u32 s16, 0
  s_cbranch_scc1 pub_24
  v_mul_u32_u24 v46, 2048, v1
  v_mov_b32 v44, s88
  v_mov_b32 v45, s89
  s_mov_b64 exec, 1
  buffer_store_dwordx2 v[44:45], v46, s[8:11], s77 offen sc1
  s_mov_b64 exec, -1
pub_24:
  s_cmp_lg_u32 s16, 0
  s_cbranch_scc1 w0_25
  v_mul_u32_u24 v50, 2048, v1
  v_mov_b32 v48, s88
  v_mov_b32 v49, s89
  s_mov_b64 exec, 511
  buffer_store_dwordx2 v[48:49], v50, s[8:11], s78 offen sc1
  s_mov_b64 exec, -1
w0_25:
  s_add_u32 s22, s29, 2621440
  s_add_u32 m0, s25, 8192
  s_nop 0
  buffer_load_dwordx4 v16, s[60:63], s22 offen offset:0 lds
  buffer_load_dwordx4 v17, s[60:63], s22 offen offset:1024 lds
  buffer_load_dwordx4 v18, s[60:63], s22 offen offset:2048 lds
  buffer_load_dwordx4 v19, s[60:63], s22 offen offset:3072 lds
  s_add_u32 m0, s25, 12288
  s_nop 0
  buffer_load_dwordx4 v20, s[60:63], s22 offen offset:0 lds
  buffer_load_dwordx4 v21, s[60:63], s22 offen offset:1024 lds
  buffer_load_dwordx4 v22, s[60:63], s22 offen offset:2048 lds
  buffer_load_dwordx4 v23, s[60:63], s22 offen offset:3072 lds
  s_add_u32 s22, s29, 3145728
  s_add_u32 m0, s25, 16384
  s_nop 0
  buffer_load_dwordx4 v16, s[60:63], s22 offen offset:0 lds
  buffer_load_dwordx4 v17, s[60:63], s22 offen offset:1024 lds
  buffer_load_dwordx4 v18, s[60:63], s22 offen offset:2048 lds
  buffer_load_dwordx4 v19, s[60:63], s22 offen offset:3072 lds
  s_add_u32 m0, s25, 20480
  s_nop 0
  buffer_load_dwordx4 v20, s[60:63], s22 offen offset:0 lds
  buffer_load_dwordx4 v21, s[60:63], s22 offen offset:1024 lds
  buffer_load_dwordx4 v22, s[60:63], s22 offen offset:2048 lds
  buffer_load_dwordx4 v23, s[60:63], s22 offen offset:3072 lds
  v_mov_b32 v250, s68
  s_or_b32 s20, s69, s16
  s_cbranch_scc1 bj_ht
  s_cmp_lg_u32 s16, 0
  s_cbranch_scc1 w0_26
  v_mov_b32 v250, 1
  v_mov_b32 v251, 192
  s_mov_b64 exec, 1
  buffer_atomic_add v250, v251, s[12:15], 0 offen sc0
  s_mov_b64 exec, -1
w0_26:
  s_branch bj_h2
bj_ht:
  buffer_load_dword v251, off, s[8:11], s77
bj_h2:
  v_lshrrev_b32 v7, 2, v4
  v_lshlrev_b32 v7, 3, v7
  v_and_b32 v8, 3, v4
  v_add_u32 v7, v7, v8
  v_xor_b32 v10, v3, v4
  v_lshlrev_b32 v10, 4, v10
  v_lshl_add_u32 v11, v4, 9, v10
  v_add_u32 v11, s25, v11
  v_lshl_add_u32 v10, v7, 9, v10
  v_xor_b32 v32, 0, v10
  v_xor_b32 v36, 0, v11
  v_xor_b32 v33, 64, v10
  v_xor_b32 v37, 64, v11
  v_xor_b32 v34, 128, v10
  v_xor_b32 v38, 128, v11
  v_xor_b32 v35, 192, v10
  v_xor_b32 v39, 192, v11
  s_mul_i32 s30, s17, 401408
  s_mul_i32 s20, s16, 14336
  s_add_u32 s30, s30, s20
  s_lshl_b32 s20, s28, 10
  s_add_u32 s30, s30, s20
  s_mov_b32 s24, 1035512379
  s_lshl_b32 s20, s17, 7
  s_lshl_b32 s28, s28, 3
  s_add_u32 s28, s28, s20
  s_add_u32 s28, s28, 88623104
  s_waitcnt vmcnt(1)
  s_barrier
  ds_read_b128 v[128:131], v32 offset:0
  ds_read_b128 v[132:135], v32 offset:2048
  ds_read_b128 v[136:139], v36 offset:0
  ds_read_b128 v[140:143], v36 offset:8192
  ds_read_b128 v[144:147], v36 offset:16384
  ds_read_b128 v[148:151], v33 offset:0
  ds_read_b128 v[152:155], v33 offset:2048
  ds_read_b128 v[156:159], v37 offset:0
  ds_read_b128 v[160:163], v37 offset:8192
  ds_read_b128 v[164:167], v37 offset:16384
  ds_read_b128 v[168:171], v34 offset:0
  ds_read_b128 v[172:175], v34 offset:2048
  ds_read_b128 v[176:179], v38 offset:0
  ds_read_b128 v[180:183], v38 offset:8192
  ds_read_b128 v[184:187], v38 offset:16384
  s_waitcnt lgkmcnt(10)
  v_mfma_f32_16x16x32_bf16 v[96:99], v[128:131], v[136:139], 0
  v_mfma_f32_16x16x32_bf16 v[100:103], v[132:135], v[136:139], 0
  v_mfma_f32_16x16x32_bf16 v[104:107], v[128:131], v[140:143], 0
  v_mfma_f32_16x16x32_bf16 v[108:111], v[132:135], v[140:143], 0
  v_mfma_f32_16x16x32_bf16 v[112:115], v[128:131], v[144:147], 0
  v_mfma_f32_16x16x32_bf16 v[116:119], v[132:135], v[144:147], 0
  ds_read_b128 v[128:131], v35 offset:0
  ds_read_b128 v[132:135], v35 offset:2048
  ds_read_b128 v[136:139], v39 offset:0
  ds_read_b128 v[140:143], v39 offset:8192
  ds_read_b128 v[144:147], v39 offset:16384
  s_waitcnt lgkmcnt(10)
  v_mfma_f32_16x16x32_bf16 v[96:99], v[148:151], v[156:159], v[96:99]
  v_mfma_f32_16x16x32_bf16 v[100:103], v[152:155], v[156:159], v[100:103]
  v_mfma_f32_16x16x32_bf16 v[104:107], v[148:151], v[160:163], v[104:107]
  v_mfma_f32_16x16x32_bf16 v[108:111], v[152:155], v[160:163], v[108:111]
  v_mfma_f32_16x16x32_bf16 v[112:115], v[148:151], v[164:167], v[112:115]
  v_mfma_f32_16x16x32_bf16 v[116:119], v[152:155], v[164:167], v[116:119]
  ds_read_b128 v[148:151], v32 offset:256
  ds_read_b128 v[152:155], v32 offset:2304
  ds_read_b128 v[156:159], v36 offset:256
  ds_read_b128 v[160:163], v36 offset:8448
  ds_read_b128 v[164:167], v36 offset:16640
  s_waitcnt lgkmcnt(10)
  v_mfma_f32_16x16x32_bf16 v[96:99], v[168:171], v[176:179], v[96:99]
  v_mfma_f32_16x16x32_bf16 v[100:103], v[172:175], v[176:179], v[100:103]
  v_mfma_f32_16x16x32_bf16 v[104:107], v[168:171], v[180:183], v[104:107]
  v_mfma_f32_16x16x32_bf16 v[108:111], v[172:175], v[180:183], v[108:111]
  v_mfma_f32_16x16x32_bf16 v[112:115], v[168:171], v[184:187], v[112:115]
  v_mfma_f32_16x16x32_bf16 v[116:119], v[172:175], v[184:187], v[116:119]
  ds_read_b128 v[168:171], v33 offset:256
  ds_read_b128 v[172:175], v33 offset:2304
  ds_read_b128 v[176:179], v37 offset:256
  ds_read_b128 v[180:183], v37 offset:8448
  ds_read_b128 v[184:187], v37 offset:16640
  s_waitcnt lgkmcnt(10)
  v_mfma_f32_16x16x32_bf16 v[96:99], v[128:131], v[136:139], v[96:99]
  v_mfma_f32_16x16x32_bf16 v[100:103], v[132:135], v[136:139], v[100:103]
  v_mfma_f32_16x16x32_bf16 v[104:107], v[128:131], v[140:143], v[104:107]
  v_mfma_f32_16x16x32_bf16 v[108:111], v[132:135], v[140:143], v[108:111]
  v_mfma_f32_16x16x32_bf16 v[112:115], v[128:131], v[144:147], v[112:115]
  v_mfma_f32_16x16x32_bf16 v[116:119], v[132:135], v[144:147], v[116:119]
  ds_read_b128 v[128:131], v34 offset:256
  ds_read_b128 v[132:135], v34 offset:2304
  ds_read_b128 v[136:139], v38 offset:256
  ds_read_b128 v[140:143], v38 offset:8448
  ds_read_b128 v[144:147], v38 offset:16640
  s_waitcnt lgkmcnt(10)
  v_mfma_f32_16x16x32_bf16 v[96:99], v[148:151], v[156:159], v[96:99]
  v_mfma_f32_16x16x32_bf16 v[100:103], v[152:155], v[156:159], v[100:103]
  v_mfma_f32_16x16x32_bf16 v[104:107], v[148:151], v[160:163], v[104:107]
  v_mfma_f32_16x16x32_bf16 v[108:111], v[152:155], v[160:163], v[108:111]
  v_mfma_f32_16x16x32_bf16 v[112:115], v[148:151], v[164:167], v[112:115]
  v_mfma_f32_16x16x32_bf16 v[116:119], v[152:155], v[164:167], v[116:119]
  ds_read_b128 v[148:151], v35 offset:256
  ds_read_b128 v[152:155], v35 offset:2304
  ds_read_b128 v[156:159], v39 offset:256
  ds_read_b128 v[160:163], v39 offset:8448
  ds_read_b128 v[164:167], v39 offset:16640
  s_waitcnt lgkmcnt(10)
  v_mfma_f32_16x16x32_bf16 v[96:99], v[168:171], v[176:179], v[96:99]
  v_mfma_f32_16x16x32_bf16 v[100:103], v[172:175], v[176:179], v[100:103]
  v_mfma_f32_16x16x32_bf16 v[104:107], v[168:171], v[180:183], v[104:107]
  v_mfma_f32_16x16x32_bf16 v[108:111], v[172:175], v[180:183], v[108:111]
  v_mfma_f32_16x16x32_bf16 v[112:115], v[168:171], v[184:187], v[112:115]
  v_mfma_f32_16x16x32_bf16 v[116:119], v[172:175], v[184:187], v[116:119]
  s_waitcnt lgkmcnt(5)
  v_mfma_f32_16x16x32_bf16 v[96:99], v[128:131], v[136:139], v[96:99]
  v_mfma_f32_16x16x32_bf16 v[100:103], v[132:135], v[136:139], v[100:103]
  v_mfma_f32_16x16x32_bf16 v[104:107], v[128:131], v[140:143], v[104:107]
  v_mfma_f32_16x16x32_bf16 v[108:111], v[132:135], v[140:143], v[108:111]
  v_mfma_f32_16x16x32_bf16 v[112:115], v[128:131], v[144:147], v[112:115]
  v_mfma_f32_16x16x32_bf16 v[116:119], v[132:135], v[144:147], v[116:119]
  s_waitcnt lgkmcnt(0)
  v_mfma_f32_16x16x32_bf16 v[96:99], v[148:151], v[156:159], v[96:99]
  v_mfma_f32_16x16x32_bf16 v[100:103], v[152:155], v[156:159], v[100:103]
  v_mfma_f32_16x16x32_bf16 v[104:107], v[148:151], v[160:163], v[104:107]
  v_mfma_f32_16x16x32_bf16 v[108:111], v[152:155], v[160:163], v[108:111]
  v_mfma_f32_16x16x32_bf16 v[112:115], v[148:151], v[164:167], v[112:115]
  v_mfma_f32_16x16x32_bf16 v[116:119], v[152:155], v[164:167], v[116:119]
  v_mul_f32 v96, s24, v96
  v_mul_f32 v97, s24, v97
  v_mul_f32 v98, s24, v98
  v_mul_f32 v99, s24, v99
  v_mul_f32 v100, s24, v100
  v_mul_f32 v101, s24, v101
  v_mul_f32 v102, s24, v102
  v_mul_f32 v103, s24, v103
  v_cvt_pk_bf16_f32 v68, v96, v97
  v_cvt_pk_bf16_f32 v69, v98, v99
  v_cvt_pk_bf16_f32 v70, v100, v101
  v_cvt_pk_bf16_f32 v71, v102, v103
  s_add_u32 s20, s30, 229376
  buffer_store_dwordx4 v[68:71], v2, s[8:11], s20 offen sc1
  v_mul_f32 v104, s24, v104
  v_mul_f32 v105, s24, v105
  v_mul_f32 v106, s24, v106
  v_mul_f32 v107, s24, v107
  v_mul_f32 v108, s24, v108
  v_mul_f32 v109, s24, v109
  v_mul_f32 v110, s24, v110
  v_mul_f32 v111, s24, v111
  v_cvt_pk_bf16_f32 v72, v104, v105
  v_cvt_pk_bf16_f32 v73, v106, v107
  v_cvt_pk_bf16_f32 v74, v108, v109
  v_cvt_pk_bf16_f32 v75, v110, v111
  s_add_u32 s20, s30, 286720
  buffer_store_dwordx4 v[72:75], v2, s[8:11], s20 offen sc1
  v_mul_f32 v112, s24, v112
  v_mul_f32 v113, s24, v113
  v_mul_f32 v114, s24, v114
  v_mul_f32 v115, s24, v115
  v_mul_f32 v116, s24, v116
  v_mul_f32 v117, s24, v117
  v_mul_f32 v118, s24, v118
  v_mul_f32 v119, s24, v119
  v_cvt_pk_bf16_f32 v76, v112, v113
  v_cvt_pk_bf16_f32 v77, v114, v115
  v_cvt_pk_bf16_f32 v78, v116, v117
  v_cvt_pk_bf16_f32 v79, v118, v119
  s_add_u32 s20, s30, 344064
  buffer_store_dwordx4 v[76:79], v2, s[8:11], s20 offen sc1
  s_waitcnt vmcnt(0)
  s_barrier
  s_cmp_lg_u32 s16, 0
  s_cbranch_scc1 pub_27
  v_mul_u32_u24 v26, 2048, v1
  v_mov_b32 v24, s88
  v_mov_b32 v25, s89
  s_mov_b64 exec, 1
  buffer_store_dwordx2 v[24:25], v26, s[8:11], s28 offen sc1
  s_mov_b64 exec, -1
pub_27:
  v_mov_b32 v6, 160000
  s_add_u32 s101, s101, 1
  s_barrier
  s_mov_b64 exec, 1
  s_cmp_lg_u32 s16, 0
  s_cbranch_scc1 w0_28
  ds_write_b32 v6, v250 offset:0
  s_waitcnt lgkmcnt(0)
  v_mov_b32 v250, s101
  ds_write_b32 v6, v250 offset:16
  s_waitcnt lgkmcnt(0)
w0_28:
  s_mov_b64 exec, -1
  s_barrier
  ds_read_b32 v250, v6 offset:0
  ds_read_b32 v6, v6 offset:16
  s_waitcnt lgkmcnt(0)
  v_readfirstlane_b32 s3, v250
  v_cmp_ne_u32 vcc, s101, v6
  s_cbranch_vccnz ch_end
  s_branch wk_have
wk_loop:
  s_waitcnt vmcnt(0) lgkmcnt(0)
  s_cmp_eq_u32 s96, 1
  s_cbranch_scc1 wk_ask
  s_mov_b32 s96, 1
  s_cmp_lg_u32 s16, 0
  s_cbranch_scc1 w0_29
  s_mov_b32 s30, 0
  v_mov_b32 v243, 32
sf_l:
  buffer_load_dword v242, v243, s[12:15], 0 offen sc1
  s_waitcnt vmcnt(0)
  v_readfirstlane_b32 s70, v242
  s_cmp_eq_u32 s70, -1
  s_cbranch_scc1 sf_d
  s_sleep 16
  s_add_u32 s30, s30, 1
  s_cmp_lt_u32 s30, 64
  s_cbranch_scc1 sf_l
  s_mov_b32 s20, 0
  s_mov_b32 s21, 0
  s_mov_b64 exec, 1
sf_c_l:
  s_cmp_lg_u32 s70, -1
  s_cbranch_scc1 sf_c_t
  s_add_u32 s20, s20, 1
  s_cmp_lt_u32 s20, 8
  s_cselect_b32 s20, s20, 0
  s_mov_b32 s70, 0
  s_mov_b32 s3, -1
  s_add_u32 s21, s21, 1
  s_cmp_ge_u32 s21, 1
  s_cbranch_scc1 sf_c_d
sf_c_t:
  s_ff0_i32_b32 s22, s70
  s_lshl_b32 s23, 1, s22
  s_and_b32 s71, s20, 4
  s_mul_i32 s71, s71, 12
  s_lshl_b32 s3, s20, 2
  s_add_u32 s3, s3, s71
  v_mov_b32 v242, s23
  v_mov_b32 v243, 32
  buffer_atomic_or v242, v243, s[12:15], s3 offen sc0
  s_waitcnt vmcnt(0)
  v_readfirstlane_b32 s70, v242
  s_lshl_b32 s3, s20, 5
  s_add_u32 s3, s3, s22
  s_bitcmp1_b32 s70, s22
  s_cbranch_scc1 sf_c_l
sf_c_d:
  s_mov_b64 exec, -1
  v_mov_b32 v242, s3
sf_d:
w0_29:
  v_mov_b32 v243, 160000
  s_add_u32 s101, s101, 1
  s_barrier
  s_mov_b64 exec, 1
  s_cmp_lg_u32 s16, 0
  s_cbranch_scc1 w0_30
  ds_write_b32 v243, v242 offset:0
  s_waitcnt lgkmcnt(0)
  v_mov_b32 v242, s101
  ds_write_b32 v243, v242 offset:16
  s_waitcnt lgkmcnt(0)
w0_30:
  s_mov_b64 exec, -1
  s_barrier
  ds_read_b32 v242, v243 offset:0
  ds_read_b32 v243, v243 offset:16
  s_waitcnt lgkmcnt(0)
  v_readfirstlane_b32 s3, v242
  v_cmp_ne_u32 vcc, s101, v243
  s_cbranch_vccnz ch_end
  s_cmp_eq_u32 s3, -1
  s_cbranch_scc1 wk_ask
  s_load_dwordx8 s[36:43], s[0:1], 56
  s_load_dwordx4 s[44:47], s[0:1], 88
  s_getreg_b32 s67, hwreg(HW_REG_XCC_ID)
  s_and_b32 s67, s67, 7
  s_mov_b32 s66, 1
  s_waitcnt lgkmcnt(0)
  s_branch m_start
wk_ask:
  v_readfirstlane_b32 s22, v250
  s_cmp_ge_u32 s22, 1376
  s_cbranch_scc1 wk_next
  s_cmp_lg_u32 s16, 0
  s_cbranch_scc1 w0_31
  v_mov_b32 v250, 1
  v_mov_b32 v251, 192
  s_mov_b64 exec, 1
  buffer_atomic_add v250, v251, s[12:15], 0 offen sc0
  s_mov_b64 exec, -1
w0_31:
wk_next:
  s_waitcnt vmcnt(0)
  v_mov_b32 v6, 160000
  s_add_u32 s101, s101, 1
  s_barrier
  s_mov_b64 exec, 1
  s_cmp_lg_u32 s16, 0
  s_cbranch_scc1 w0_32
  ds_write_b32 v6, v250 offset:0
  s_waitcnt lgkmcnt(0)
  v_mov_b32 v250, s101
  ds_write_b32 v6, v250 offset:16
  s_waitcnt lgkmcnt(0)
w0_32:
  s_mov_b64 exec, -1
  s_barrier
  ds_read_b32 v250, v6 offset:0
  ds_read_b32 v6, v6 offset:16
  s_waitcnt lgkmcnt(0)
  v_readfirstlane_b32 s3, v250
  v_cmp_ne_u32 vcc, s101, v6
  s_cbranch_vccnz ch_end
wk_have:
  s_cmp_ge_u32 s3, 1376
  s_cbranch_scc1 ch_end
  v_mov_b32 v250, 0
  v_mov_b32 v251, 192
  v_and_b32 v1, 63, v0
  v_lshlrev_b32 v2, 4, v1
  v_lshrrev_b32 v3, 4, v1
  v_and_b32 v4, 15, v1
  s_cmp_lg_u32 s97, 0
  s_cbranch_scc1 wk_go
  s_mov_b32 s68, s3
  s_mov_b32 s69, 1
  s_cmp_lg_u32 s16, 0
  s_cbranch_scc1 w0_33
  s_add_u32 s20, s67, 1
  s_lshl_b32 s22, s20, 11
  s_add_u32 s22, s22, 88590336
  v_add_u32 v24, 1024, v2
  v_min_u32 v24, 1776, v24
  s_mov_b32 s30, 0
wk_af:
  buffer_load_dwordx4 v[28:31], v2, s[8:11], s22 offen sc1
  buffer_load_dwordx4 v[32:35], v24, s[8:11], s22 offen sc1
  s_waitcnt vmcnt(0)
  v_cmp_ne_u64 vcc, s[88:89], v[28:29]
  s_cbranch_vccnz wk_af_no
  v_cmp_ne_u64 vcc, s[88:89], v[30:31]
  s_cbranch_vccnz wk_af_no
  v_cmp_ne_u64 vcc, s[88:89], v[32:33]
  s_cbranch_vccnz wk_af_no
  v_cmp_ne_u64 vcc, s[88:89], v[34:35]
  s_cbranch_vccnz wk_af_no
  s_branch wk_af_ok
wk_af_no:
  s_sleep 4
  s_add_u32 s30, s30, 1
  s_and_b32 s20, s30, 63
  s_cbranch_scc1 wk_ns
  s_mov_b32 s20, 1
  s_mov_b32 s70, 0
  s_mov_b32 s21, 0
  s_mov_b64 exec, 1
wk_st_l:
  s_cmp_lg_u32 s70, -1
  s_cbranch_scc1 wk_st_t
  s_add_u32 s20, s20, 1
  s_cmp_lt_u32 s20, 8
  s_cselect_b32 s20, s20, 1
  s_mov_b32 s70, 0
  s_mov_b32 s3, -1
  s_add_u32 s21, s21, 1
  s_cmp_ge_u32 s21, 7
  s_cbranch_scc1 wk_st_d
wk_st_t:
  s_ff0_i32_b32 s22, s70
  s_lshl_b32 s23, 1, s22
  s_and_b32 s71, s20, 4
  s_mul_i32 s71, s71, 12
  s_lshl_b32 s3, s20, 2
  s_add_u32 s3, s3, s71
  v_mov_b32 v242, s23
  v_mov_b32 v243, 32
  buffer_atomic_or v242, v243, s[12:15], s3 offen sc0
  s_waitcnt vmcnt(0)
  v_readfirstlane_b32 s70, v242
  s_lshl_b32 s3, s20, 5
  s_add_u32 s3, s3, s22
  s_bitcmp1_b32 s70, s22
  s_cbranch_scc1 wk_st_l
wk_st_d:
  s_mov_b64 exec, -1
  v_mov_b32 v242, s3
  s_cmp_lg_u32 s3, -1
  s_cbranch_scc1 wk_pd
  s_add_u32 s20, s67, 1
  s_lshl_b32 s22, s20, 11
  s_add_u32 s22, s22, 88590336
wk_ns:
  s_cmp_lt_u32 s30, 50000
  s_cbranch_scc1 wk_af
  s_branch cA_abort
wk_af_ok:
  v_mov_b32 v242, -1
wk_pd:
w0_33:
  v_mov_b32 v243, 160000
  s_add_u32 s101, s101, 1
  s_barrier
  s_mov_b64 exec, 1
  s_cmp_lg_u32 s16, 0
  s_cbranch_scc1 w0_34
  ds_write_b32 v243, v242 offset:0
  s_waitcnt lgkmcnt(0)
  v_mov_b32 v242, s101
  ds_write_b32 v243, v242 offset:16
  s_waitcnt lgkmcnt(0)
w0_34:
  s_mov_b64 exec, -1
  s_barrier
  ds_read_b32 v242, v243 offset:0
  ds_read_b32 v243, v243 offset:16
  s_waitcnt lgkmcnt(0)
  v_readfirstlane_b32 s3, v242
  v_cmp_ne_u32 vcc, s101, v243
  s_cbranch_vccnz ch_end
  s_cmp_lg_u32 s3, -1
  s_cbranch_scc1 m_bjob
  s_mov_b32 s3, s68
  s_mov_b32 s97, 1
wk_go:
  s_cmp_ge_u32 s3, 864
  s_cbranch_scc1 wk_tok
  s_cmp_ge_u32 s3, 752
  s_cbranch_scc1 wk_s4d
  s_cmp_ge_u32 s3, 624
  s_cbranch_scc1 wk_f
  s_cmp_ge_u32 s3, 560
  s_cbranch_scc1 wk_vf
  s_cmp_ge_u32 s3, 496
  s_cbranch_scc1 wk_vh
  s_cmp_ge_u32 s3, 368
  s_cbranch_scc1 wk_a
  s_cmp_ge_u32 s3, 336
  s_cbranch_scc1 wk_srv
  s_cmp_ge_u32 s3, 224
  s_cbranch_scc1 wk_v7
  s_sub_u32 s20, s3, 0
  s_cmp_ge_u32 s20, 112
  s_cselect_b32 s18, 1, 0
  s_cselect_b32 s21, 112, 0
  s_sub_u32 s20, s20, s21
  s_and_b32 s17, s20, 15
  s_add_u32 s17, s17, 16
  s_lshr_b32 s34, s20, 4
  s_lshl_b32 s34, s34, 1
  s_add_u32 s35, s34, 2
  s_cmp_eq_u32 s18, 0
  s_cbranch_scc1 wf_nw
  s_and_b32 s20, s3, 3
  s_lshl_b32 s20, s20, 3
  s_add_u32 s20, s20, 8
  s_cmp_eq_u32 s16, 0
  s_cselect_b32 s20, 0, s20
  s_cmp_ge_u32 s16, 2
  s_cselect_b32 s20, 112, s20
  s_load_dwordx2 s[72:73], s[0:1], s20
  s_lshr_b32 s21, s3, 2
  s_lshl_b32 s21, s21, 12
  s_mov_b32 s74, 229376
  s_lshl_b32 s22, s3, 13
  s_cmp_eq_u32 s16, 0
  s_cselect_b32 s21, s22, s21
  s_cselect_b32 s74, 1835008, s74
  s_lshl_b32 s22, s3, 1
  s_add_u32 s22, s22, s16
  s_sub_u32 s22, s22, 2
  s_lshl_b32 s22, s22, 13
  s_cmp_ge_u32 s16, 2
  s_cselect_b32 s21, s22, s21
  s_cselect_b32 s74, 3670016, s74
  v_lshlrev_b32 v6, 3, v2
  s_cmp_eq_u32 s16, 1
  s_cselect_b32 exec_hi, 0, -1
  s_waitcnt lgkmcnt(0)
  s_and_b32 s73, s73, 0xffff
  s_mov_b32 s75, 0x20000
  buffer_load_dword v7, v6, s[72:75], s21 offen
  s_mov_b64 exec, -1
  s_sub_u32 s3, s3, 112
  s_and_b32 s20, s3, 3
  s_lshl_b32 s20, s20, 3
  s_add_u32 s20, s20, 8
  s_cmp_eq_u32 s16, 0
  s_cselect_b32 s20, 0, s20
  s_cmp_ge_u32 s16, 2
  s_cselect_b32 s20, 112, s20
  s_load_dwordx2 s[72:73], s[0:1], s20
  s_lshr_b32 s21, s3, 2
  s_lshl_b32 s21, s21, 12
  s_mov_b32 s74, 229376
  s_lshl_b32 s22, s3, 13
  s_cmp_eq_u32 s16, 0
  s_cselect_b32 s21, s22, s21
  s_cselect_b32 s74, 1835008, s74
  s_lshl_b32 s22, s3, 1
  s_add_u32 s22, s22, s16
  s_sub_u32 s22, s22, 2
  s_lshl_b32 s22, s22, 13
  s_cmp_ge_u32 s16, 2
  s_cselect_b32 s21, s22, s21
  s_cselect_b32 s74, 3670016, s74
  v_lshlrev_b32 v6, 3, v2
  s_cmp_eq_u32 s16, 1
  s_cselect_b32 exec_hi, 0, -1
  s_waitcnt lgkmcnt(0)
  s_and_b32 s73, s73, 0xffff
  s_mov_b32 s75, 0x20000
  buffer_load_dword v7, v6, s[72:75], s21 offen
  s_mov_b64 exec, -1
wf_nw:
  s_lshl_b32 s20, s18, 3
  s_lshl_b32 s21, s16, 1
  s_add_u32 s20, s20, s21
  s_mul_i32 s21, s20, 14336
  s_add_u32 s21, s21, 71565312
  s_add_u32 s22, s21, 0
  buffer_load_dwordx4 a[0:3], v2, s[8:11], s22 offen offset:0 sc1
  buffer_load_dwordx4 a[4:7], v2, s[8:11], s22 offen offset:1024 sc1
  buffer_load_dwordx4 a[8:11], v2, s[8:11], s22 offen offset:2048 sc1
  buffer_load_dwordx4 a[12:15], v2, s[8:11], s22 offen offset:3072 sc1
  s_add_u32 s22, s21, 4096
  buffer_load_dwordx4 a[16:19], v2, s[8:11], s22 offen offset:0 sc1
  buffer_load_dwordx4 a[20:23], v2, s[8:11], s22 offen offset:1024 sc1
  buffer_load_dwordx4 a[24:27], v2, s[8:11], s22 offen offset:2048 sc1
  buffer_load_dwordx4 a[28:31], v2, s[8:11], s22 offen offset:3072 sc1
  s_add_u32 s22, s21, 8192
  buffer_load_dwordx4 a[32:35], v2, s[8:11], s22 offen offset:0 sc1
  buffer_load_dwordx4 a[36:39], v2, s[8:11], s22 offen offset:1024 sc1
  buffer_load_dwordx4 a[40:43], v2, s[8:11], s22 offen offset:2048 sc1
  buffer_load_dwordx4 a[44:47], v2, s[8:11], s22 offen offset:3072 sc1
  s_add_u32 s22, s21, 12288
  buffer_load_dwordx4 a[48:51], v2, s[8:11], s22 offen offset:0 sc1
  buffer_load_dwordx4 a[52:55], v2, s[8:11], s22 offen offset:1024 sc1
  buffer_load_dwordx4 a[56:59], v2, s[8:11], s22 offen offset:2048 sc1
  buffer_load_dwordx4 a[60:63], v2, s[8:11], s22 offen offset:3072 sc1
  s_add_u32 s22, s21, 16384
  buffer_load_dwordx4 a[64:67], v2, s[8:11], s22 offen offset:0 sc1
  buffer_load_dwordx4 a[68:71], v2, s[8:11], s22 offen offset:1024 sc1
  buffer_load_dwordx4 a[72:75], v2, s[8:11], s22 offen offset:2048 sc1
  buffer_load_dwordx4 a[76:79], v2, s[8:11], s22 offen offset:3072 sc1
  s_add_u32 s22, s21, 20480
  buffer_load_dwordx4 a[80:83], v2, s[8:11], s22 offen offset:0 sc1
  buffer_load_dwordx4 a[84:87], v2, s[8:11], s22 offen offset:1024 sc1
  buffer_load_dwordx4 a[88:91], v2, s[8:11], s22 offen offset:2048 sc1
  buffer_load_dwordx4 a[92:95], v2, s[8:11], s22 offen offset:3072 sc1
  s_add_u32 s22, s21, 24576
  buffer_load_dwordx4 a[96:99], v2, s[8:11], s22 offen offset:0 sc1
  buffer_load_dwordx4 a[100:103], v2, s[8:11], s22 offen offset:1024 sc1
  buffer_load_dwordx4 a[104:107], v2, s[8:11], s22 offen offset:2048 sc1
  buffer_load_dwordx4 a[108:111], v2, s[8:11], s22 offen offset:3072 sc1
  s_waitcnt vmcnt(40)
  s_mul_i32 s23, s17, 401408
  s_and_b32 s22, s16, 1
  s_mul_i32 s22, s22, 7168
  s_add_u32 s23, s23, s22
  s_add_u32 s23, s23, 0
  s_lshr_b32 s22, s16, 1
  s_mul_i32 s22, s22, 14336
  s_add_u32 s23, s23, s22
  s_mul_i32 s27, s16, 7168
  s_lshr_b32 s28, s20, 1
wf_vo:
  s_sub_u32 s29, s17, 16
  s_lshl_b32 s29, s29, 6
  s_add_u32 s29, s29, s28
  s_mul_i32 s29, s29, 28672
  s_add_u32 s29, s29, 42205184
  v_mul_u32_u24 v6, 28, v3
  s_mov_b32 s31, 0
  s_lshl_b32 s24, s34, 1
  s_mul_i32 s24, s24, 14336
  s_add_u32 s24, s24, s23
  s_cmp_lt_u32 s34, s35
  s_cselect_b32 s24, s24, 0x10000000
  s_add_u32 m0, s31, s27
  s_nop 0
  buffer_load_dwordx4 v2, s[8:11], s24 offen offset:0 sc1 lds
  buffer_load_dwordx4 v2, s[8:11], s24 offen offset:1024 sc1 lds
  buffer_load_dwordx4 v2, s[8:11], s24 offen offset:2048 sc1 lds
  buffer_load_dwordx4 v2, s[8:11], s24 offen offset:3072 sc1 lds
  s_add_u32 m0, m0, 4096
  s_add_u32 s24, s24, 4096
  buffer_load_dwordx4 v2, s[8:11], s24 offen offset:0 sc1 lds
  buffer_load_dwordx4 v2, s[8:11], s24 offen offset:1024 sc1 lds
  buffer_load_dwordx4 v2, s[8:11], s24 offen offset:2048 sc1 lds
  s_add_u32 s30, s34, 1
  s_mov_b32 s31, 28672
  s_lshl_b32 s24, s30, 1
  s_mul_i32 s24, s24, 14336
  s_add_u32 s24, s24, s23
  s_cmp_lt_u32 s30, s35
  s_cselect_b32 s24, s24, 0x10000000
  s_add_u32 m0, s31, s27
  s_nop 0
  buffer_load_dwordx4 v2, s[8:11], s24 offen offset:0 sc1 lds
  buffer_load_dwordx4 v2, s[8:11], s24 offen offset:1024 sc1 lds
  buffer_load_dwordx4 v2, s[8:11], s24 offen offset:2048 sc1 lds
  buffer_load_dwordx4 v2, s[8:11], s24 offen offset:3072 sc1 lds
  s_add_u32 m0, m0, 4096
  s_add_u32 s24, s24, 4096
  buffer_load_dwordx4 v2, s[8:11], s24 offen offset:0 sc1 lds
  buffer_load_dwordx4 v2, s[8:11], s24 offen offset:1024 sc1 lds
  buffer_load_dwordx4 v2, s[8:11], s24 offen offset:2048 sc1 lds
  s_mov_b32 s19, s34
  s_mov_b32 s32, 0
  s_mov_b32 s33, 57344
  s_waitcnt vmcnt(7)
  s_branch wf_vo_in
wf_vo_loop:
  s_waitcnt vmcnt(9)
wf_vo_in:
  s_barrier
  s_add_u32 s30, s19, 2
  s_lshl_b32 s24, s30, 1
  s_mul_i32 s24, s24, 14336
  s_add_u32 s24, s24, s23
  s_cmp_lt_u32 s30, s35
  s_cselect_b32 s24, s24, 0x10000000
  s_add_u32 m0, s33, s27
  s_nop 0
  buffer_load_dwordx4 v2, s[8:11], s24 offen offset:0 sc1 lds
  buffer_load_dwordx4 v2, s[8:11], s24 offen offset:1024 sc1 lds
  buffer_load_dwordx4 v2, s[8:11], s24 offen offset:2048 sc1 lds
  buffer_load_dwordx4 v2, s[8:11], s24 offen offset:3072 sc1 lds
  s_add_u32 m0, m0, 4096
  s_add_u32 s24, s24, 4096
  buffer_load_dwordx4 v2, s[8:11], s24 offen offset:0 sc1 lds
  buffer_load_dwordx4 v2, s[8:11], s24 offen offset:1024 sc1 lds
  buffer_load_dwordx4 v2, s[8:11], s24 offen offset:2048 sc1 lds
  v_add_u32 v5, s32, v2
  ds_read_b128 v[8:11], v5 offset:0
  ds_read_b128 v[12:15], v5 offset:14336
  ds_read_b128 v[16:19], v5 offset:1024
  ds_read_b128 v[20:23], v5 offset:15360
  ds_read_b128 v[24:27], v5 offset:2048
  ds_read_b128 v[28:31], v5 offset:16384
  ds_read_b128 v[32:35], v5 offset:3072
  s_waitcnt lgkmcnt(6)
  v_mfma_f32_16x16x32_bf16 v[40:43], a[0:3], v[8:11], 0
  v_mfma_f32_16x16x32_bf16 v[44:47], a[56:59], v[8:11], 0
  ds_read_b128 v[36:39], v5 offset:17408
  s_waitcnt lgkmcnt(6)
  v_mfma_f32_16x16x32_bf16 v[56:59], a[0:3], v[12:15], 0
  v_mfma_f32_16x16x32_bf16 v[60:63], a[56:59], v[12:15], 0
  ds_read_b128 v[8:11], v5 offset:4096
  s_waitcnt lgkmcnt(6)
  v_mfma_f32_16x16x32_bf16 v[40:43], a[4:7], v[16:19], v[40:43]
  v_mfma_f32_16x16x32_bf16 v[44:47], a[60:63], v[16:19], v[44:47]
  ds_read_b128 v[12:15], v5 offset:18432
  s_waitcnt lgkmcnt(6)
  v_mfma_f32_16x16x32_bf16 v[56:59], a[4:7], v[20:23], v[56:59]
  v_mfma_f32_16x16x32_bf16 v[60:63], a[60:63], v[20:23], v[60:63]
  ds_read_b128 v[16:19], v5 offset:5120
  s_waitcnt lgkmcnt(6)
  v_mfma_f32_16x16x32_bf16 v[40:43], a[8:11], v[24:27], v[40:43]
  v_mfma_f32_16x16x32_bf16 v[44:47], a[64:67], v[24:27], v[44:47]
  ds_read_b128 v[20:23], v5 offset:19456
  s_waitcnt lgkmcnt(6)
  v_mfma_f32_16x16x32_bf16 v[56:59], a[8:11], v[28:31], v[56:59]
  v_mfma_f32_16x16x32_bf16 v[60:63], a[64:67], v[28:31], v[60:63]
  ds_read_b128 v[24:27], v5 offset:6144
  s_waitcnt lgkmcnt(6)
  v_mfma_f32_16x16x32_bf16 v[40:43], a[12:15], v[32:35], v[40:43]
  v_mfma_f32_16x16x32_bf16 v[44:47], a[68:71], v[32:35], v[44:47]
  ds_read_b128 v[28:31], v5 offset:20480
  s_waitcnt lgkmcnt(6)
  v_mfma_f32_16x16x32_bf16 v[56:59], a[12:15], v[36:39], v[56:59]
  v_mfma_f32_16x16x32_bf16 v[60:63], a[68:71], v[36:39], v[60:63]
  ds_read_b128 v[32:35], v5 offset:7168
  s_waitcnt lgkmcnt(6)
  v_mfma_f32_16x16x32_bf16 v[40:43], a[16:19], v[8:11], v[40:43]
  v_mfma_f32_16x16x32_bf16 v[44:47], a[72:75], v[8:11], v[44:47]
  ds_read_b128 v[36:39], v5 offset:21504
  s_waitcnt lgkmcnt(6)
  v_mfma_f32_16x16x32_bf16 v[56:59], a[16:19], v[12:15], v[56:59]
  v_mfma_f32_16x16x32_bf16 v[60:63], a[72:75], v[12:15], v[60:63]
  ds_read_b128 v[8:11], v5 offset:8192
  s_waitcnt lgkmcnt(6)
  v_mfma_f32_16x16x32_bf16 v[40:43], a[20:23], v[16:19], v[40:43]
  v_mfma_f32_16x16x32_bf16 v[44:47], a[76:79], v[16:19], v[44:47]
  ds_read_b128 v[12:15], v5 offset:22528
  s_waitcnt lgkmcnt(6)
  v_mfma_f32_16x16x32_bf16 v[56:59], a[20:23], v[20:23], v[56:59]
  v_mfma_f32_16x16x32_bf16 v[60:63], a[76:79], v[20:23], v[60:63]
  ds_read_b128 v[16:19], v5 offset:9216
  s_waitcnt lgkmcnt(6)
  v_mfma_f32_16x16x32_bf16 v[40:43], a[24:27], v[24:27], v[40:43]
  v_mfma_f32_16x16x32_bf16 v[44:47], a[80:83], v[24:27], v[44:47]
  ds_read_b128 v[20:23], v5 offset:23552
  s_waitcnt lgkmcnt(6)
  v_mfma_f32_16x16x32_bf16 v[56:59], a[24:27], v[28:31], v[56:59]
  v_mfma_f32_16x16x32_bf16 v[60:63], a[80:83], v[28:31], v[60:63]
  ds_read_b128 v[24:27], v5 offset:10240
  s_waitcnt lgkmcnt(6)
  v_mfma_f32_16x16x32_bf16 v[40:43], a[28:31], v[32:35], v[40:43]
  v_mfma_f32_16x16x32_bf16 v[44:47], a[84:87], v[32:35], v[44:47]
  ds_read_b128 v[28:31], v5 offset:24576
  s_waitcnt lgkmcnt(6)
  v_mfma_f32_16x16x32_bf16 v[56:59], a[28:31], v[36:39], v[56:59]
  v_mfma_f32_16x16x32_bf16 v[60:63], a[84:87], v[36:39], v[60:63]
  ds_read_b128 v[32:35], v5 offset:11264
  s_waitcnt lgkmcnt(6)
  v_mfma_f32_16x16x32_bf16 v[40:43], a[32:35], v[8:11], v[40:43]
  v_mfma_f32_16x16x32_bf16 v[44:47], a[88:91], v[8:11], v[44:47]
  ds_read_b128 v[36:39], v5 offset:25600
  s_waitcnt lgkmcnt(6)
  v_mfma_f32_16x16x32_bf16 v[56:59], a[32:35], v[12:15], v[56:59]
  v_mfma_f32_16x16x32_bf16 v[60:63], a[88:91], v[12:15], v[60:63]
  ds_read_b128 v[8:11], v5 offset:12288
  s_waitcnt lgkmcnt(6)
  v_mfma_f32_16x16x32_bf16 v[40:43], a[36:39], v[16:19], v[40:43]
  v_mfma_f32_16x16x32_bf16 v[44:47], a[92:95], v[16:19], v[44:47]
  ds_read_b128 v[12:15], v5 offset:26624
  s_waitcnt lgkmcnt(6)
  v_mfma_f32_16x16x32_bf16 v[56:59], a[36:39], v[20:23], v[56:59]
  v_mfma_f32_16x16x32_bf16 v[60:63], a[92:95], v[20:23], v[60:63]
  ds_read_b128 v[16:19], v5 offset:13312
  s_waitcnt lgkmcnt(6)
  v_mfma_f32_16x16x32_bf16 v[40:43], a[40:43], v[24:27], v[40:43]
  v_mfma_f32_16x16x32_bf16 v[44:47], a[96:99], v[24:27], v[44:47]
  ds_read_b128 v[20:23], v5 offset:27648
  s_waitcnt lgkmcnt(6)
  v_mfma_f32_16x16x32_bf16 v[56:59], a[40:43], v[28:31], v[56:59]
  v_mfma_f32_16x16x32_bf16 v[60:63], a[96:99], v[28:31], v[60:63]
  s_waitcnt lgkmcnt(5)
  v_mfma_f32_16x16x32_bf16 v[40:43], a[44:47], v[32:35], v[40:43]
  v_mfma_f32_16x16x32_bf16 v[44:47], a[100:103], v[32:35], v[44:47]
  s_waitcnt lgkmcnt(4)
  v_mfma_f32_16x16x32_bf16 v[56:59], a[44:47], v[36:39], v[56:59]
  v_mfma_f32_16x16x32_bf16 v[60:63], a[100:103], v[36:39], v[60:63]
  s_waitcnt lgkmcnt(3)
  v_mfma_f32_16x16x32_bf16 v[40:43], a[48:51], v[8:11], v[40:43]
  v_mfma_f32_16x16x32_bf16 v[44:47], a[104:107], v[8:11], v[44:47]
  s_waitcnt lgkmcnt(2)
  v_mfma_f32_16x16x32_bf16 v[56:59], a[48:51], v[12:15], v[56:59]
  v_mfma_f32_16x16x32_bf16 v[60:63], a[104:107], v[12:15], v[60:63]
  s_waitcnt lgkmcnt(1)
  v_mfma_f32_16x16x32_bf16 v[40:43], a[52:55], v[16:19], v[40:43]
  v_mfma_f32_16x16x32_bf16 v[44:47], a[108:111], v[16:19], v[44:47]
  s_waitcnt lgkmcnt(0)
  v_mfma_f32_16x16x32_bf16 v[56:59], a[52:55], v[20:23], v[56:59]
  v_mfma_f32_16x16x32_bf16 v[60:63], a[108:111], v[20:23], v[60:63]
  s_add_u32 s25, s29, 28672
  s_lshl_b32 s24, s19, 5
  s_add_u32 s24, s24, 0
  v_add_u32 v88, s24, v4
  v_mul_u32_u24 v89, 2341, v88
  v_lshrrev_b32 v89, 16, v89
  v_mul_u32_u24 v89, 84, v89
  v_add3_u32 v88, v88, v89, v6
  v_lshlrev_b32 v90, 4, v88
  v_cvt_pk_bf16_f32 v72, v40, v41
  v_cvt_pk_bf16_f32 v73, v42, v43
  v_cvt_pk_bf16_f32 v74, v44, v45
  v_cvt_pk_bf16_f32 v75, v46, v47
  buffer_store_dwordx4 v[72:75], v90, s[8:11], s29 offen sc1
  s_lshl_b32 s24, s19, 5
  s_add_u32 s24, s24, 16
  v_add_u32 v88, s24, v4
  v_mul_u32_u24 v89, 2341, v88
  v_lshrrev_b32 v89, 16, v89
  v_mul_u32_u24 v89, 84, v89
  v_add3_u32 v88, v88, v89, v6
  v_lshlrev_b32 v91, 4, v88
  v_cvt_pk_bf16_f32 v80, v56, v57
  v_cvt_pk_bf16_f32 v81, v58, v59
  v_cvt_pk_bf16_f32 v82, v60, v61
  v_cvt_pk_bf16_f32 v83, v62, v63
  buffer_store_dwordx4 v[80:83], v91, s[8:11], s29 offen sc1
  s_mov_b32 s33, s32
  s_add_u32 s32, s32, 28672
  s_cmp_eq_u32 s32, 86016
  s_cselect_b32 s32, 0, s32
  s_add_u32 s19, s19, 1
  s_cmp_lt_u32 s19, s35
  s_cbranch_scc1 wf_vo_loop
  s_branch wf_done
wf_done:
  s_lshr_b32 s20, s18, 1
  s_lshl_b32 s20, s20, 4
  s_and_b32 s21, s17, 15
  s_add_u32 s20, s20, s21
  s_lshl_b32 s20, s20, 7
  s_cmp_lt_u32 s17, 16
  s_cselect_b32 s21, 16384, 0
  s_add_u32 s20, s20, s21
  s_add_u32 s20, s20, 88528896
  s_sub_u32 s21, s35, s34
  s_lshr_b32 s21, s21, 1
  v_mov_b32 v5, s21
  v_mov_b32 v6, 0
  s_waitcnt vmcnt(0)
  s_mov_b64 exec, 1
  s_cmp_lg_u32 s18, 0
  s_cbranch_scc1 wf_h1
  v_mov_b32 v7, 2
  s_sub_u32 s21, s20, 2048
  buffer_atomic_add v7, v6, s[8:11], s21 offen
wf_h1:
  buffer_atomic_add v5, v6, s[8:11], s20 offen
  s_mov_b64 exec, -1
  s_branch wk_loop
wk_v7:
  s_sub_u32 s20, s3, 224
  s_mov_b32 s18, 1
  s_and_b32 s17, s20, 15
  s_add_u32 s17, s17, 16
  s_lshr_b32 s34, s20, 4
  s_lshl_b32 s34, s34, 1
  s_add_u32 s35, s34, 2
  s_branch wk_gemm
wk_vh:
  s_sub_u32 s20, s3, 496
  s_and_b32 s17, s20, 15
  s_add_u32 s17, s17, 16
  s_lshr_b32 s18, s20, 5
  s_add_u32 s18, s18, 2
  s_bitcmp1_b32 s20, 4
  s_cselect_b32 s34, 7, 0
  s_add_u32 s35, s34, 7
  s_branch wk_gemm
wk_vf:
  s_sub_u32 s20, s3, 560
  s_and_b32 s17, s20, 15
  s_add_u32 s17, s17, 16
  s_lshr_b32 s18, s20, 4
  s_add_u32 s18, s18, 4
  s_mov_b32 s34, 0
  s_mov_b32 s35, 14
  s_branch wk_gemm
wk_f:
  s_sub_u32 s20, s3, 624
  s_and_b32 s17, s20, 15
  s_lshr_b32 s18, s20, 4
  s_mov_b32 s34, 0
  s_mov_b32 s35, 14
  s_lshl_b32 s22, s17, 7
  s_add_u32 s22, s22, 88621056
  s_add_u32 s23, s22, 2048
  v_min_u32 v24, 48, v2
  v_min_u32 v25, 96, v2
  s_mov_b32 s30, 0
wk_aw:
  buffer_load_dwordx4 v[28:31], v24, s[8:11], s22 offen sc1
  buffer_load_dwordx4 v[32:35], v25, s[8:11], s23 offen sc1
  s_waitcnt vmcnt(0)
  v_cmp_ne_u64 vcc, s[88:89], v[28:29]
  s_cbranch_vccnz wk_aw_no
  v_cmp_ne_u64 vcc, s[88:89], v[30:31]
  s_cbranch_vccnz wk_aw_no
  v_cmp_ne_u64 vcc, s[88:89], v[32:33]
  s_cbranch_vccnz wk_aw_no
  v_cmp_ne_u64 vcc, s[88:89], v[34:35]
  s_cbranch_vccnz wk_aw_no
  s_branch wk_aw_ok
wk_aw_no:
  s_sleep 6
  s_add_u32 s30, s30, 1
  s_cmp_lt_u32 s30, 50000
  s_cbranch_scc1 wk_aw
  s_branch cA_abort
wk_aw_ok:
wk_gemm:
  s_lshl_b32 s20, s18, 4
  s_lshl_b32 s21, s16, 2
  s_add_u32 s20, s20, s21
  s_mul_i32 s21, s20, 14336
  s_add_u32 s21, s21, 71565312
  s_add_u32 s22, s21, 0
  buffer_load_dwordx4 a[0:3], v2, s[8:11], s22 offen offset:0 sc1
  buffer_load_dwordx4 a[4:7], v2, s[8:11], s22 offen offset:1024 sc1
  buffer_load_dwordx4 a[8:11], v2, s[8:11], s22 offen offset:2048 sc1
  buffer_load_dwordx4 a[12:15], v2, s[8:11], s22 offen offset:3072 sc1
  s_add_u32 s22, s21, 4096
  buffer_load_dwordx4 a[16:19], v2, s[8:11], s22 offen offset:0 sc1
  buffer_load_dwordx4 a[20:23], v2, s[8:11], s22 offen offset:1024 sc1
  buffer_load_dwordx4 a[24:27], v2, s[8:11], s22 offen offset:2048 sc1
  buffer_load_dwordx4 a[28:31], v2, s[8:11], s22 offen offset:3072 sc1
  s_add_u32 s22, s21, 8192
  buffer_load_dwordx4 a[32:35], v2, s[8:11], s22 offen offset:0 sc1
  buffer_load_dwordx4 a[36:39], v2, s[8:11], s22 offen offset:1024 sc1
  buffer_load_dwordx4 a[40:43], v2, s[8:11], s22 offen offset:2048 sc1
  buffer_load_dwordx4 a[44:47], v2, s[8:11], s22 offen offset:3072 sc1
  s_add_u32 s22, s21, 12288
  buffer_load_dwordx4 a[48:51], v2, s[8:11], s22 offen offset:0 sc1
  buffer_load_dwordx4 a[52:55], v2, s[8:11], s22 offen offset:1024 sc1
  buffer_load_dwordx4 a[56:59], v2, s[8:11], s22 offen offset:2048 sc1
  buffer_load_dwordx4 a[60:63], v2, s[8:11], s22 offen offset:3072 sc1
  s_add_u32 s22, s21, 16384
  buffer_load_dwordx4 a[64:67], v2, s[8:11], s22 offen offset:0 sc1
  buffer_load_dwordx4 a[68:71], v2, s[8:11], s22 offen offset:1024 sc1
  buffer_load_dwordx4 a[72:75], v2, s[8:11], s22 offen offset:2048 sc1
  buffer_load_dwordx4 a[76:79], v2, s[8:11], s22 offen offset:3072 sc1
  s_add_u32 s22, s21, 20480
  buffer_load_dwordx4 a[80:83], v2, s[8:11], s22 offen offset:0 sc1
  buffer_load_dwordx4 a[84:87], v2, s[8:11], s22 offen offset:1024 sc1
  buffer_load_dwordx4 a[88:91], v2, s[8:11], s22 offen offset:2048 sc1
  buffer_load_dwordx4 a[92:95], v2, s[8:11], s22 offen offset:3072 sc1
  s_add_u32 s22, s21, 24576
  buffer_load_dwordx4 a[96:99], v2, s[8:11], s22 offen offset:0 sc1
  buffer_load_dwordx4 a[100:103], v2, s[8:11], s22 offen offset:1024 sc1
  buffer_load_dwordx4 a[104:107], v2, s[8:11], s22 offen offset:2048 sc1
  buffer_load_dwordx4 a[108:111], v2, s[8:11], s22 offen offset:3072 sc1
  s_add_u32 s22, s21, 28672
  buffer_load_dwordx4 a[112:115], v2, s[8:11], s22 offen offset:0 sc1
  buffer_load_dwordx4 a[116:119], v2, s[8:11], s22 offen offset:1024 sc1
  buffer_load_dwordx4 a[120:123], v2, s[8:11], s22 offen offset:2048 sc1
  buffer_load_dwordx4 a[124:127], v2, s[8:11], s22 offen offset:3072 sc1
  s_add_u32 s22, s21, 32768
  buffer_load_dwordx4 a[128:131], v2, s[8:11], s22 offen offset:0 sc1
  buffer_load_dwordx4 a[132:135], v2, s[8:11], s22 offen offset:1024 sc1
  buffer_load_dwordx4 a[136:139], v2, s[8:11], s22 offen offset:2048 sc1
  buffer_load_dwordx4 a[140:143], v2, s[8:11], s22 offen offset:3072 sc1
  s_add_u32 s22, s21, 36864
  buffer_load_dwordx4 a[144:147], v2, s[8:11], s22 offen offset:0 sc1
  buffer_load_dwordx4 a[148:151], v2, s[8:11], s22 offen offset:1024 sc1
  buffer_load_dwordx4 a[152:155], v2, s[8:11], s22 offen offset:2048 sc1
  buffer_load_dwordx4 a[156:159], v2, s[8:11], s22 offen offset:3072 sc1
  s_add_u32 s22, s21, 40960
  buffer_load_dwordx4 a[160:163], v2, s[8:11], s22 offen offset:0 sc1
  buffer_load_dwordx4 a[164:167], v2, s[8:11], s22 offen offset:1024 sc1
  buffer_load_dwordx4 a[168:171], v2, s[8:11], s22 offen offset:2048 sc1
  buffer_load_dwordx4 a[172:175], v2, s[8:11], s22 offen offset:3072 sc1
  s_add_u32 s22, s21, 45056
  buffer_load_dwordx4 a[176:179], v2, s[8:11], s22 offen offset:0 sc1
  buffer_load_dwordx4 a[180:183], v2, s[8:11], s22 offen offset:1024 sc1
  buffer_load_dwordx4 a[184:187], v2, s[8:11], s22 offen offset:2048 sc1
  buffer_load_dwordx4 a[188:191], v2, s[8:11], s22 offen offset:3072 sc1
  s_add_u32 s22, s21, 49152
  buffer_load_dwordx4 a[192:195], v2, s[8:11], s22 offen offset:0 sc1
  buffer_load_dwordx4 a[196:199], v2, s[8:11], s22 offen offset:1024 sc1
  buffer_load_dwordx4 a[200:203], v2, s[8:11], s22 offen offset:2048 sc1
  buffer_load_dwordx4 a[204:207], v2, s[8:11], s22 offen offset:3072 sc1
  s_add_u32 s22, s21, 53248
  buffer_load_dwordx4 a[208:211], v2, s[8:11], s22 offen offset:0 sc1
  buffer_load_dwordx4 a[212:215], v2, s[8:11], s22 offen offset:1024 sc1
  buffer_load_dwordx4 a[216:219], v2, s[8:11], s22 offen offset:2048 sc1
  buffer_load_dwordx4 a[220:223], v2, s[8:11], s22 offen offset:3072 sc1
  s_waitcnt vmcnt(40)
  s_mul_i32 s23, s17, 401408
  s_and_b32 s22, s16, 1
  s_mul_i32 s22, s22, 7168
  s_add_u32 s23, s23, s22
  s_add_u32 s23, s23, 0
  s_lshr_b32 s22, s16, 1
  s_mul_i32 s22, s22, 14336
  s_add_u32 s23, s23, s22
  s_mul_i32 s27, s16, 7168
  s_lshr_b32 s28, s20, 1
  s_cmp_lt_u32 s17, 16
  s_cbranch_scc0 wg_vo
  s_add_u32 s23, s23, s22
  s_lshl_b32 s29, s28, 4
  s_add_u32 s29, s29, s17
  s_mul_i32 s29, s29, 28672
  s_add_u32 s29, s29, 12845056
  s_mov_b32 s31, 0
  s_lshr_b32 s24, s34, 1
  s_lshl_b32 s24, s24, 2
  s_and_b32 s25, s34, 1
  s_add_u32 s24, s24, s25
  s_mul_i32 s24, s24, 14336
  s_add_u32 s24, s24, s23
  s_cmp_lt_u32 s34, s35
  s_cselect_b32 s24, s24, 0x10000000
  s_add_u32 m0, s31, s27
  s_nop 0
  buffer_load_dwordx4 v2, s[8:11], s24 offen offset:0 sc1 lds
  buffer_load_dwordx4 v2, s[8:11], s24 offen offset:1024 sc1 lds
  buffer_load_dwordx4 v2, s[8:11], s24 offen offset:2048 sc1 lds
  buffer_load_dwordx4 v2, s[8:11], s24 offen offset:3072 sc1 lds
  s_add_u32 m0, m0, 4096
  s_add_u32 s24, s24, 4096
  buffer_load_dwordx4 v2, s[8:11], s24 offen offset:0 sc1 lds
  buffer_load_dwordx4 v2, s[8:11], s24 offen offset:1024 sc1 lds
  buffer_load_dwordx4 v2, s[8:11], s24 offen offset:2048 sc1 lds
  s_add_u32 s30, s34, 1
  s_mov_b32 s31, 28672
  s_lshr_b32 s24, s30, 1
  s_lshl_b32 s24, s24, 2
  s_and_b32 s25, s30, 1
  s_add_u32 s24, s24, s25
  s_mul_i32 s24, s24, 14336
  s_add_u32 s24, s24, s23
  s_cmp_lt_u32 s30, s35
  s_cselect_b32 s24, s24, 0x10000000
  s_add_u32 m0, s31, s27
  s_nop 0
  buffer_load_dwordx4 v2, s[8:11], s24 offen offset:0 sc1 lds
  buffer_load_dwordx4 v2, s[8:11], s24 offen offset:1024 sc1 lds
  buffer_load_dwordx4 v2, s[8:11], s24 offen offset:2048 sc1 lds
  buffer_load_dwordx4 v2, s[8:11], s24 offen offset:3072 sc1 lds
  s_add_u32 m0, m0, 4096
  s_add_u32 s24, s24, 4096
  buffer_load_dwordx4 v2, s[8:11], s24 offen offset:0 sc1 lds
  buffer_load_dwordx4 v2, s[8:11], s24 offen offset:1024 sc1 lds
  buffer_load_dwordx4 v2, s[8:11], s24 offen offset:2048 sc1 lds
  s_mov_b32 s19, s34
  s_mov_b32 s32, 0
  s_mov_b32 s33, 57344
  s_waitcnt vmcnt(7)
  s_branch wg_f_in
wg_f_loop:
  s_waitcnt vmcnt(11)
wg_f_in:
  s_barrier
  s_add_u32 s30, s19, 2
  s_lshr_b32 s24, s30, 1
  s_lshl_b32 s24, s24, 2
  s_and_b32 s25, s30, 1
  s_add_u32 s24, s24, s25
  s_mul_i32 s24, s24, 14336
  s_add_u32 s24, s24, s23
  s_cmp_lt_u32 s30, s35
  s_cselect_b32 s24, s24, 0x10000000
  s_add_u32 m0, s33, s27
  s_nop 0
  buffer_load_dwordx4 v2, s[8:11], s24 offen offset:0 sc1 lds
  buffer_load_dwordx4 v2, s[8:11], s24 offen offset:1024 sc1 lds
  buffer_load_dwordx4 v2, s[8:11], s24 offen offset:2048 sc1 lds
  buffer_load_dwordx4 v2, s[8:11], s24 offen offset:3072 sc1 lds
  s_add_u32 m0, m0, 4096
  s_add_u32 s24, s24, 4096
  buffer_load_dwordx4 v2, s[8:11], s24 offen offset:0 sc1 lds
  buffer_load_dwordx4 v2, s[8:11], s24 offen offset:1024 sc1 lds
  buffer_load_dwordx4 v2, s[8:11], s24 offen offset:2048 sc1 lds
  v_add_u32 v5, s32, v2
  ds_read_b128 v[8:11], v5 offset:0
  ds_read_b128 v[12:15], v5 offset:14336
  ds_read_b128 v[16:19], v5 offset:1024
  ds_read_b128 v[20:23], v5 offset:15360
  ds_read_b128 v[24:27], v5 offset:2048
  ds_read_b128 v[28:31], v5 offset:16384
  ds_read_b128 v[32:35], v5 offset:3072
  s_waitcnt lgkmcnt(6)
  v_mfma_f32_16x16x32_bf16 v[40:43], v[8:11], a[0:3], 0
  v_mfma_f32_16x16x32_bf16 v[44:47], v[8:11], a[56:59], 0
  v_mfma_f32_16x16x32_bf16 v[48:51], v[8:11], a[112:115], 0
  v_mfma_f32_16x16x32_bf16 v[52:55], v[8:11], a[168:171], 0
  ds_read_b128 v[36:39], v5 offset:17408
  s_waitcnt lgkmcnt(6)
  v_mfma_f32_16x16x32_bf16 v[56:59], v[12:15], a[0:3], 0
  v_mfma_f32_16x16x32_bf16 v[60:63], v[12:15], a[56:59], 0
  v_mfma_f32_16x16x32_bf16 v[64:67], v[12:15], a[112:115], 0
  v_mfma_f32_16x16x32_bf16 v[68:71], v[12:15], a[168:171], 0
  ds_read_b128 v[8:11], v5 offset:4096
  s_waitcnt lgkmcnt(6)
  v_mfma_f32_16x16x32_bf16 v[40:43], v[16:19], a[4:7], v[40:43]
  v_mfma_f32_16x16x32_bf16 v[44:47], v[16:19], a[60:63], v[44:47]
  v_mfma_f32_16x16x32_bf16 v[48:51], v[16:19], a[116:119], v[48:51]
  v_mfma_f32_16x16x32_bf16 v[52:55], v[16:19], a[172:175], v[52:55]
  ds_read_b128 v[12:15], v5 offset:18432
  s_waitcnt lgkmcnt(6)
  v_mfma_f32_16x16x32_bf16 v[56:59], v[20:23], a[4:7], v[56:59]
  v_mfma_f32_16x16x32_bf16 v[60:63], v[20:23], a[60:63], v[60:63]
  v_mfma_f32_16x16x32_bf16 v[64:67], v[20:23], a[116:119], v[64:67]
  v_mfma_f32_16x16x32_bf16 v[68:71], v[20:23], a[172:175], v[68:71]
  ds_read_b128 v[16:19], v5 offset:5120
  s_waitcnt lgkmcnt(6)
  v_mfma_f32_16x16x32_bf16 v[40:43], v[24:27], a[8:11], v[40:43]
  v_mfma_f32_16x16x32_bf16 v[44:47], v[24:27], a[64:67], v[44:47]
  v_mfma_f32_16x16x32_bf16 v[48:51], v[24:27], a[120:123], v[48:51]
  v_mfma_f32_16x16x32_bf16 v[52:55], v[24:27], a[176:179], v[52:55]
  ds_read_b128 v[20:23], v5 offset:19456
  s_waitcnt lgkmcnt(6)
  v_mfma_f32_16x16x32_bf16 v[56:59], v[28:31], a[8:11], v[56:59]
  v_mfma_f32_16x16x32_bf16 v[60:63], v[28:31], a[64:67], v[60:63]
  v_mfma_f32_16x16x32_bf16 v[64:67], v[28:31], a[120:123], v[64:67]
  v_mfma_f32_16x16x32_bf16 v[68:71], v[28:31], a[176:179], v[68:71]
  ds_read_b128 v[24:27], v5 offset:6144
  s_waitcnt lgkmcnt(6)
  v_mfma_f32_16x16x32_bf16 v[40:43], v[32:35], a[12:15], v[40:43]
  v_mfma_f32_16x16x32_bf16 v[44:47], v[32:35], a[68:71], v[44:47]
  v_mfma_f32_16x16x32_bf16 v[48:51], v[32:35], a[124:127], v[48:51]
  v_mfma_f32_16x16x32_bf16 v[52:55], v[32:35], a[180:183], v[52:55]
  ds_read_b128 v[28:31], v5 offset:20480
  s_waitcnt lgkmcnt(6)
  v_mfma_f32_16x16x32_bf16 v[56:59], v[36:39], a[12:15], v[56:59]
  v_mfma_f32_16x16x32_bf16 v[60:63], v[36:39], a[68:71], v[60:63]
  v_mfma_f32_16x16x32_bf16 v[64:67], v[36:39], a[124:127], v[64:67]
  v_mfma_f32_16x16x32_bf16 v[68:71], v[36:39], a[180:183], v[68:71]
  ds_read_b128 v[32:35], v5 offset:7168
  s_waitcnt lgkmcnt(6)
  v_mfma_f32_16x16x32_bf16 v[40:43], v[8:11], a[16:19], v[40:43]
  v_mfma_f32_16x16x32_bf16 v[44:47], v[8:11], a[72:75], v[44:47]
  v_mfma_f32_16x16x32_bf16 v[48:51], v[8:11], a[128:131], v[48:51]
  v_mfma_f32_16x16x32_bf16 v[52:55], v[8:11], a[184:187], v[52:55]
  ds_read_b128 v[36:39], v5 offset:21504
  s_waitcnt lgkmcnt(6)
  v_mfma_f32_16x16x32_bf16 v[56:59], v[12:15], a[16:19], v[56:59]
  v_mfma_f32_16x16x32_bf16 v[60:63], v[12:15], a[72:75], v[60:63]
  v_mfma_f32_16x16x32_bf16 v[64:67], v[12:15], a[128:131], v[64:67]
  v_mfma_f32_16x16x32_bf16 v[68:71], v[12:15], a[184:187], v[68:71]
  ds_read_b128 v[8:11], v5 offset:8192
  s_waitcnt lgkmcnt(6)
  v_mfma_f32_16x16x32_bf16 v[40:43], v[16:19], a[20:23], v[40:43]
  v_mfma_f32_16x16x32_bf16 v[44:47], v[16:19], a[76:79], v[44:47]
  v_mfma_f32_16x16x32_bf16 v[48:51], v[16:19], a[132:135], v[48:51]
  v_mfma_f32_16x16x32_bf16 v[52:55], v[16:19], a[188:191], v[52:55]
  ds_read_b128 v[12:15], v5 offset:22528
  s_waitcnt lgkmcnt(6)
  v_mfma_f32_16x16x32_bf16 v[56:59], v[20:23], a[20:23], v[56:59]
  v_mfma_f32_16x16x32_bf16 v[60:63], v[20:23], a[76:79], v[60:63]
  v_mfma_f32_16x16x32_bf16 v[64:67], v[20:23], a[132:135], v[64:67]
  v_mfma_f32_16x16x32_bf16 v[68:71], v[20:23], a[188:191], v[68:71]
  ds_read_b128 v[16:19], v5 offset:9216
  s_waitcnt lgkmcnt(6)
  v_mfma_f32_16x16x32_bf16 v[40:43], v[24:27], a[24:27], v[40:43]
  v_mfma_f32_16x16x32_bf16 v[44:47], v[24:27], a[80:83], v[44:47]
  v_mfma_f32_16x16x32_bf16 v[48:51], v[24:27], a[136:139], v[48:51]
  v_mfma_f32_16x16x32_bf16 v[52:55], v[24:27], a[192:195], v[52:55]
  ds_read_b128 v[20:23], v5 offset:23552
  s_waitcnt lgkmcnt(6)
  v_mfma_f32_16x16x32_bf16 v[56:59], v[28:31], a[24:27], v[56:59]
  v_mfma_f32_16x16x32_bf16 v[60:63], v[28:31], a[80:83], v[60:63]
  v_mfma_f32_16x16x32_bf16 v[64:67], v[28:31], a[136:139], v[64:67]
  v_mfma_f32_16x16x32_bf16 v[68:71], v[28:31], a[192:195], v[68:71]
  ds_read_b128 v[24:27], v5 offset:10240
  s_waitcnt lgkmcnt(6)
  v_mfma_f32_16x16x32_bf16 v[40:43], v[32:35], a[28:31], v[40:43]
  v_mfma_f32_16x16x32_bf16 v[44:47], v[32:35], a[84:87], v[44:47]
  v_mfma_f32_16x16x32_bf16 v[48:51], v[32:35], a[140:143], v[48:51]
  v_mfma_f32_16x16x32_bf16 v[52:55], v[32:35], a[196:199], v[52:55]
  ds_read_b128 v[28:31], v5 offset:24576
  s_waitcnt lgkmcnt(6)
  v_mfma_f32_16x16x32_bf16 v[56:59], v[36:39], a[28:31], v[56:59]
  v_mfma_f32_16x16x32_bf16 v[60:63], v[36:39], a[84:87], v[60:63]
  v_mfma_f32_16x16x32_bf16 v[64:67], v[36:39], a[140:143], v[64:67]
  v_mfma_f32_16x16x32_bf16 v[68:71], v[36:39], a[196:199], v[68:71]
  ds_read_b128 v[32:35], v5 offset:11264
  s_waitcnt lgkmcnt(6)
  v_mfma_f32_16x16x32_bf16 v[40:43], v[8:11], a[32:35], v[40:43]
  v_mfma_f32_16x16x32_bf16 v[44:47], v[8:11], a[88:91], v[44:47]
  v_mfma_f32_16x16x32_bf16 v[48:51], v[8:11], a[144:147], v[48:51]
  v_mfma_f32_16x16x32_bf16 v[52:55], v[8:11], a[200:203], v[52:55]
  ds_read_b128 v[36:39], v5 offset:25600
  s_waitcnt lgkmcnt(6)
  v_mfma_f32_16x16x32_bf16 v[56:59], v[12:15], a[32:35], v[56:59]
  v_mfma_f32_16x16x32_bf16 v[60:63], v[12:15], a[88:91], v[60:63]
  v_mfma_f32_16x16x32_bf16 v[64:67], v[12:15], a[144:147], v[64:67]
  v_mfma_f32_16x16x32_bf16 v[68:71], v[12:15], a[200:203], v[68:71]
  ds_read_b128 v[8:11], v5 offset:12288
  s_waitcnt lgkmcnt(6)
  v_mfma_f32_16x16x32_bf16 v[40:43], v[16:19], a[36:39], v[40:43]
  v_mfma_f32_16x16x32_bf16 v[44:47], v[16:19], a[92:95], v[44:47]
  v_mfma_f32_16x16x32_bf16 v[48:51], v[16:19], a[148:151], v[48:51]
  v_mfma_f32_16x16x32_bf16 v[52:55], v[16:19], a[204:207], v[52:55]
  ds_read_b128 v[12:15], v5 offset:26624
  s_waitcnt lgkmcnt(6)
  v_mfma_f32_16x16x32_bf16 v[56:59], v[20:23], a[36:39], v[56:59]
  v_mfma_f32_16x16x32_bf16 v[60:63], v[20:23], a[92:95], v[60:63]
  v_mfma_f32_16x16x32_bf16 v[64:67], v[20:23], a[148:151], v[64:67]
  v_mfma_f32_16x16x32_bf16 v[68:71], v[20:23], a[204:207], v[68:71]
  ds_read_b128 v[16:19], v5 offset:13312
  s_waitcnt lgkmcnt(6)
  v_mfma_f32_16x16x32_bf16 v[40:43], v[24:27], a[40:43], v[40:43]
  v_mfma_f32_16x16x32_bf16 v[44:47], v[24:27], a[96:99], v[44:47]
  v_mfma_f32_16x16x32_bf16 v[48:51], v[24:27], a[152:155], v[48:51]
  v_mfma_f32_16x16x32_bf16 v[52:55], v[24:27], a[208:211], v[52:55]
  ds_read_b128 v[20:23], v5 offset:27648
  s_waitcnt lgkmcnt(6)
  v_mfma_f32_16x16x32_bf16 v[56:59], v[28:31], a[40:43], v[56:59]
  v_mfma_f32_16x16x32_bf16 v[60:63], v[28:31], a[96:99], v[60:63]
  v_mfma_f32_16x16x32_bf16 v[64:67], v[28:31], a[152:155], v[64:67]
  v_mfma_f32_16x16x32_bf16 v[68:71], v[28:31], a[208:211], v[68:71]
  s_waitcnt lgkmcnt(5)
  v_mfma_f32_16x16x32_bf16 v[40:43], v[32:35], a[44:47], v[40:43]
  v_mfma_f32_16x16x32_bf16 v[44:47], v[32:35], a[100:103], v[44:47]
  v_mfma_f32_16x16x32_bf16 v[48:51], v[32:35], a[156:159], v[48:51]
  v_mfma_f32_16x16x32_bf16 v[52:55], v[32:35], a[212:215], v[52:55]
  s_waitcnt lgkmcnt(4)
  v_mfma_f32_16x16x32_bf16 v[56:59], v[36:39], a[44:47], v[56:59]
  v_mfma_f32_16x16x32_bf16 v[60:63], v[36:39], a[100:103], v[60:63]
  v_mfma_f32_16x16x32_bf16 v[64:67], v[36:39], a[156:159], v[64:67]
  v_mfma_f32_16x16x32_bf16 v[68:71], v[36:39], a[212:215], v[68:71]
  s_waitcnt lgkmcnt(3)
  v_mfma_f32_16x16x32_bf16 v[40:43], v[8:11], a[48:51], v[40:43]
  v_mfma_f32_16x16x32_bf16 v[44:47], v[8:11], a[104:107], v[44:47]
  v_mfma_f32_16x16x32_bf16 v[48:51], v[8:11], a[160:163], v[48:51]
  v_mfma_f32_16x16x32_bf16 v[52:55], v[8:11], a[216:219], v[52:55]
  s_waitcnt lgkmcnt(2)
  v_mfma_f32_16x16x32_bf16 v[56:59], v[12:15], a[48:51], v[56:59]
  v_mfma_f32_16x16x32_bf16 v[60:63], v[12:15], a[104:107], v[60:63]
  v_mfma_f32_16x16x32_bf16 v[64:67], v[12:15], a[160:163], v[64:67]
  v_mfma_f32_16x16x32_bf16 v[68:71], v[12:15], a[216:219], v[68:71]
  s_waitcnt lgkmcnt(1)
  v_mfma_f32_16x16x32_bf16 v[40:43], v[16:19], a[52:55], v[40:43]
  v_mfma_f32_16x16x32_bf16 v[44:47], v[16:19], a[108:111], v[44:47]
  v_mfma_f32_16x16x32_bf16 v[48:51], v[16:19], a[164:167], v[48:51]
  v_mfma_f32_16x16x32_bf16 v[52:55], v[16:19], a[220:223], v[52:55]
  s_waitcnt lgkmcnt(0)
  v_mfma_f32_16x16x32_bf16 v[56:59], v[20:23], a[52:55], v[56:59]
  v_mfma_f32_16x16x32_bf16 v[60:63], v[20:23], a[108:111], v[60:63]
  v_mfma_f32_16x16x32_bf16 v[64:67], v[20:23], a[164:167], v[64:67]
  v_mfma_f32_16x16x32_bf16 v[68:71], v[20:23], a[220:223], v[68:71]
  s_lshl_b32 s24, s19, 10
  s_add_u32 s24, s24, s29
  v_cvt_pk_bf16_f32 v72, v40, v41
  v_cvt_pk_bf16_f32 v73, v42, v43
  v_cvt_pk_bf16_f32 v74, v56, v57
  v_cvt_pk_bf16_f32 v75, v58, v59
  s_add_u32 s25, s24, 0
  buffer_store_dwordx4 v[72:75], v2, s[8:11], s25 offen sc1
  v_cvt_pk_bf16_f32 v76, v44, v45
  v_cvt_pk_bf16_f32 v77, v46, v47
  v_cvt_pk_bf16_f32 v78, v60, v61
  v_cvt_pk_bf16_f32 v79, v62, v63
  s_add_u32 s25, s24, 14336
  buffer_store_dwordx4 v[76:79], v2, s[8:11], s25 offen sc1
  v_cvt_pk_bf16_f32 v80, v48, v49
  v_cvt_pk_bf16_f32 v81, v50, v51
  v_cvt_pk_bf16_f32 v82, v64, v65
  v_cvt_pk_bf16_f32 v83, v66, v67
  s_add_u32 s25, s24, 458752
  buffer_store_dwordx4 v[80:83], v2, s[8:11], s25 offen sc1
  v_cvt_pk_bf16_f32 v84, v52, v53
  v_cvt_pk_bf16_f32 v85, v54, v55
  v_cvt_pk_bf16_f32 v86, v68, v69
  v_cvt_pk_bf16_f32 v87, v70, v71
  s_add_u32 s25, s24, 473088
  buffer_store_dwordx4 v[84:87], v2, s[8:11], s25 offen sc1
  s_mov_b32 s33, s32
  s_add_u32 s32, s32, 28672
  s_cmp_eq_u32 s32, 86016
  s_cselect_b32 s32, 0, s32
  s_add_u32 s19, s19, 1
  s_cmp_lt_u32 s19, s35
  s_cbranch_scc1 wg_f_loop
  s_branch wg_done
wg_vo:
  s_sub_u32 s29, s17, 16
  s_lshl_b32 s29, s29, 6
  s_add_u32 s29, s29, s28
  s_mul_i32 s29, s29, 28672
  s_add_u32 s29, s29, 42205184
  v_mul_u32_u24 v6, 28, v3
  s_mov_b32 s31, 0
  s_lshl_b32 s24, s34, 1
  s_mul_i32 s24, s24, 14336
  s_add_u32 s24, s24, s23
  s_cmp_lt_u32 s34, s35
  s_cselect_b32 s24, s24, 0x10000000
  s_add_u32 m0, s31, s27
  s_nop 0
  buffer_load_dwordx4 v2, s[8:11], s24 offen offset:0 sc1 lds
  buffer_load_dwordx4 v2, s[8:11], s24 offen offset:1024 sc1 lds
  buffer_load_dwordx4 v2, s[8:11], s24 offen offset:2048 sc1 lds
  buffer_load_dwordx4 v2, s[8:11], s24 offen offset:3072 sc1 lds
  s_add_u32 m0, m0, 4096
  s_add_u32 s24, s24, 4096
  buffer_load_dwordx4 v2, s[8:11], s24 offen offset:0 sc1 lds
  buffer_load_dwordx4 v2, s[8:11], s24 offen offset:1024 sc1 lds
  buffer_load_dwordx4 v2, s[8:11], s24 offen offset:2048 sc1 lds
  s_add_u32 s30, s34, 1
  s_mov_b32 s31, 28672
  s_lshl_b32 s24, s30, 1
  s_mul_i32 s24, s24, 14336
  s_add_u32 s24, s24, s23
  s_cmp_lt_u32 s30, s35
  s_cselect_b32 s24, s24, 0x10000000
  s_add_u32 m0, s31, s27
  s_nop 0
  buffer_load_dwordx4 v2, s[8:11], s24 offen offset:0 sc1 lds
  buffer_load_dwordx4 v2, s[8:11], s24 offen offset:1024 sc1 lds
  buffer_load_dwordx4 v2, s[8:11], s24 offen offset:2048 sc1 lds
  buffer_load_dwordx4 v2, s[8:11], s24 offen offset:3072 sc1 lds
  s_add_u32 m0, m0, 4096
  s_add_u32 s24, s24, 4096
  buffer_load_dwordx4 v2, s[8:11], s24 offen offset:0 sc1 lds
  buffer_load_dwordx4 v2, s[8:11], s24 offen offset:1024 sc1 lds
  buffer_load_dwordx4 v2, s[8:11], s24 offen offset:2048 sc1 lds
  s_mov_b32 s19, s34
  s_mov_b32 s32, 0
  s_mov_b32 s33, 57344
  s_waitcnt vmcnt(7)
  s_branch wg_vo_in
wg_vo_loop:
  s_waitcnt vmcnt(11)
wg_vo_in:
  s_barrier
  s_add_u32 s30, s19, 2
  s_lshl_b32 s24, s30, 1
  s_mul_i32 s24, s24, 14336
  s_add_u32 s24, s24, s23
  s_cmp_lt_u32 s30, s35
  s_cselect_b32 s24, s24, 0x10000000
  s_add_u32 m0, s33, s27
  s_nop 0
  buffer_load_dwordx4 v2, s[8:11], s24 offen offset:0 sc1 lds
  buffer_load_dwordx4 v2, s[8:11], s24 offen offset:1024 sc1 lds
  buffer_load_dwordx4 v2, s[8:11], s24 offen offset:2048 sc1 lds
  buffer_load_dwordx4 v2, s[8:11], s24 offen offset:3072 sc1 lds
  s_add_u32 m0, m0, 4096
  s_add_u32 s24, s24, 4096
  buffer_load_dwordx4 v2, s[8:11], s24 offen offset:0 sc1 lds
  buffer_load_dwordx4 v2, s[8:11], s24 offen offset:1024 sc1 lds
  buffer_load_dwordx4 v2, s[8:11], s24 offen offset:2048 sc1 lds
  v_add_u32 v5, s32, v2
  ds_read_b128 v[8:11], v5 offset:0
  ds_read_b128 v[12:15], v5 offset:14336
  ds_read_b128 v[16:19], v5 offset:1024
  ds_read_b128 v[20:23], v5 offset:15360
  ds_read_b128 v[24:27], v5 offset:2048
  ds_read_b128 v[28:31], v5 offset:16384
  ds_read_b128 v[32:35], v5 offset:3072
  s_waitcnt lgkmcnt(6)
  v_mfma_f32_16x16x32_bf16 v[40:43], a[0:3], v[8:11], 0
  v_mfma_f32_16x16x32_bf16 v[44:47], a[56:59], v[8:11], 0
  v_mfma_f32_16x16x32_bf16 v[48:51], a[112:115], v[8:11], 0
  v_mfma_f32_16x16x32_bf16 v[52:55], a[168:171], v[8:11], 0
  ds_read_b128 v[36:39], v5 offset:17408
  s_waitcnt lgkmcnt(6)
  v_mfma_f32_16x16x32_bf16 v[56:59], a[0:3], v[12:15], 0
  v_mfma_f32_16x16x32_bf16 v[60:63], a[56:59], v[12:15], 0
  v_mfma_f32_16x16x32_bf16 v[64:67], a[112:115], v[12:15], 0
  v_mfma_f32_16x16x32_bf16 v[68:71], a[168:171], v[12:15], 0
  ds_read_b128 v[8:11], v5 offset:4096
  s_waitcnt lgkmcnt(6)
  v_mfma_f32_16x16x32_bf16 v[40:43], a[4:7], v[16:19], v[40:43]
  v_mfma_f32_16x16x32_bf16 v[44:47], a[60:63], v[16:19], v[44:47]
  v_mfma_f32_16x16x32_bf16 v[48:51], a[116:119], v[16:19], v[48:51]
  v_mfma_f32_16x16x32_bf16 v[52:55], a[172:175], v[16:19], v[52:55]
  ds_read_b128 v[12:15], v5 offset:18432
  s_waitcnt lgkmcnt(6)
  v_mfma_f32_16x16x32_bf16 v[56:59], a[4:7], v[20:23], v[56:59]
  v_mfma_f32_16x16x32_bf16 v[60:63], a[60:63], v[20:23], v[60:63]
  v_mfma_f32_16x16x32_bf16 v[64:67], a[116:119], v[20:23], v[64:67]
  v_mfma_f32_16x16x32_bf16 v[68:71], a[172:175], v[20:23], v[68:71]
  ds_read_b128 v[16:19], v5 offset:5120
  s_waitcnt lgkmcnt(6)
  v_mfma_f32_16x16x32_bf16 v[40:43], a[8:11], v[24:27], v[40:43]
  v_mfma_f32_16x16x32_bf16 v[44:47], a[64:67], v[24:27], v[44:47]
  v_mfma_f32_16x16x32_bf16 v[48:51], a[120:123], v[24:27], v[48:51]
  v_mfma_f32_16x16x32_bf16 v[52:55], a[176:179], v[24:27], v[52:55]
  ds_read_b128 v[20:23], v5 offset:19456
  s_waitcnt lgkmcnt(6)
  v_mfma_f32_16x16x32_bf16 v[56:59], a[8:11], v[28:31], v[56:59]
  v_mfma_f32_16x16x32_bf16 v[60:63], a[64:67], v[28:31], v[60:63]
  v_mfma_f32_16x16x32_bf16 v[64:67], a[120:123], v[28:31], v[64:67]
  v_mfma_f32_16x16x32_bf16 v[68:71], a[176:179], v[28:31], v[68:71]
  ds_read_b128 v[24:27], v5 offset:6144
  s_waitcnt lgkmcnt(6)
  v_mfma_f32_16x16x32_bf16 v[40:43], a[12:15], v[32:35], v[40:43]
  v_mfma_f32_16x16x32_bf16 v[44:47], a[68:71], v[32:35], v[44:47]
  v_mfma_f32_16x16x32_bf16 v[48:51], a[124:127], v[32:35], v[48:51]
  v_mfma_f32_16x16x32_bf16 v[52:55], a[180:183], v[32:35], v[52:55]
  ds_read_b128 v[28:31], v5 offset:20480
  s_waitcnt lgkmcnt(6)
  v_mfma_f32_16x16x32_bf16 v[56:59], a[12:15], v[36:39], v[56:59]
  v_mfma_f32_16x16x32_bf16 v[60:63], a[68:71], v[36:39], v[60:63]
  v_mfma_f32_16x16x32_bf16 v[64:67], a[124:127], v[36:39], v[64:67]
  v_mfma_f32_16x16x32_bf16 v[68:71], a[180:183], v[36:39], v[68:71]
  ds_read_b128 v[32:35], v5 offset:7168
  s_waitcnt lgkmcnt(6)
  v_mfma_f32_16x16x32_bf16 v[40:43], a[16:19], v[8:11], v[40:43]
  v_mfma_f32_16x16x32_bf16 v[44:47], a[72:75], v[8:11], v[44:47]
  v_mfma_f32_16x16x32_bf16 v[48:51], a[128:131], v[8:11], v[48:51]
  v_mfma_f32_16x16x32_bf16 v[52:55], a[184:187], v[8:11], v[52:55]
  ds_read_b128 v[36:39], v5 offset:21504
  s_waitcnt lgkmcnt(6)
  v_mfma_f32_16x16x32_bf16 v[56:59], a[16:19], v[12:15], v[56:59]
  v_mfma_f32_16x16x32_bf16 v[60:63], a[72:75], v[12:15], v[60:63]
  v_mfma_f32_16x16x32_bf16 v[64:67], a[128:131], v[12:15], v[64:67]
  v_mfma_f32_16x16x32_bf16 v[68:71], a[184:187], v[12:15], v[68:71]
  ds_read_b128 v[8:11], v5 offset:8192
  s_waitcnt lgkmcnt(6)
  v_mfma_f32_16x16x32_bf16 v[40:43], a[20:23], v[16:19], v[40:43]
  v_mfma_f32_16x16x32_bf16 v[44:47], a[76:79], v[16:19], v[44:47]
  v_mfma_f32_16x16x32_bf16 v[48:51], a[132:135], v[16:19], v[48:51]
  v_mfma_f32_16x16x32_bf16 v[52:55], a[188:191], v[16:19], v[52:55]
  ds_read_b128 v[12:15], v5 offset:22528
  s_waitcnt lgkmcnt(6)
  v_mfma_f32_16x16x32_bf16 v[56:59], a[20:23], v[20:23], v[56:59]
  v_mfma_f32_16x16x32_bf16 v[60:63], a[76:79], v[20:23], v[60:63]
  v_mfma_f32_16x16x32_bf16 v[64:67], a[132:135], v[20:23], v[64:67]
  v_mfma_f32_16x16x32_bf16 v[68:71], a[188:191], v[20:23], v[68:71]
  ds_read_b128 v[16:19], v5 offset:9216
  s_waitcnt lgkmcnt(6)
  v_mfma_f32_16x16x32_bf16 v[40:43], a[24:27], v[24:27], v[40:43]
  v_mfma_f32_16x16x32_bf16 v[44:47], a[80:83], v[24:27], v[44:47]
  v_mfma_f32_16x16x32_bf16 v[48:51], a[136:139], v[24:27], v[48:51]
  v_mfma_f32_16x16x32_bf16 v[52:55], a[192:195], v[24:27], v[52:55]
  ds_read_b128 v[20:23], v5 offset:23552
  s_waitcnt lgkmcnt(6)
  v_mfma_f32_16x16x32_bf16 v[56:59], a[24:27], v[28:31], v[56:59]
  v_mfma_f32_16x16x32_bf16 v[60:63], a[80:83], v[28:31], v[60:63]
  v_mfma_f32_16x16x32_bf16 v[64:67], a[136:139], v[28:31], v[64:67]
  v_mfma_f32_16x16x32_bf16 v[68:71], a[192:195], v[28:31], v[68:71]
  ds_read_b128 v[24:27], v5 offset:10240
  s_waitcnt lgkmcnt(6)
  v_mfma_f32_16x16x32_bf16 v[40:43], a[28:31], v[32:35], v[40:43]
  v_mfma_f32_16x16x32_bf16 v[44:47], a[84:87], v[32:35], v[44:47]
  v_mfma_f32_16x16x32_bf16 v[48:51], a[140:143], v[32:35], v[48:51]
  v_mfma_f32_16x16x32_bf16 v[52:55], a[196:199], v[32:35], v[52:55]
  ds_read_b128 v[28:31], v5 offset:24576
  s_waitcnt lgkmcnt(6)
  v_mfma_f32_16x16x32_bf16 v[56:59], a[28:31], v[36:39], v[56:59]
  v_mfma_f32_16x16x32_bf16 v[60:63], a[84:87], v[36:39], v[60:63]
  v_mfma_f32_16x16x32_bf16 v[64:67], a[140:143], v[36:39], v[64:67]
  v_mfma_f32_16x16x32_bf16 v[68:71], a[196:199], v[36:39], v[68:71]
  ds_read_b128 v[32:35], v5 offset:11264
  s_waitcnt lgkmcnt(6)
  v_mfma_f32_16x16x32_bf16 v[40:43], a[32:35], v[8:11], v[40:43]
  v_mfma_f32_16x16x32_bf16 v[44:47], a[88:91], v[8:11], v[44:47]
  v_mfma_f32_16x16x32_bf16 v[48:51], a[144:147], v[8:11], v[48:51]
  v_mfma_f32_16x16x32_bf16 v[52:55], a[200:203], v[8:11], v[52:55]
  ds_read_b128 v[36:39], v5 offset:25600
  s_waitcnt lgkmcnt(6)
  v_mfma_f32_16x16x32_bf16 v[56:59], a[32:35], v[12:15], v[56:59]
  v_mfma_f32_16x16x32_bf16 v[60:63], a[88:91], v[12:15], v[60:63]
  v_mfma_f32_16x16x32_bf16 v[64:67], a[144:147], v[12:15], v[64:67]
  v_mfma_f32_16x16x32_bf16 v[68:71], a[200:203], v[12:15], v[68:71]
  ds_read_b128 v[8:11], v5 offset:12288
  s_waitcnt lgkmcnt(6)
  v_mfma_f32_16x16x32_bf16 v[40:43], a[36:39], v[16:19], v[40:43]
  v_mfma_f32_16x16x32_bf16 v[44:47], a[92:95], v[16:19], v[44:47]
  v_mfma_f32_16x16x32_bf16 v[48:51], a[148:151], v[16:19], v[48:51]
  v_mfma_f32_16x16x32_bf16 v[52:55], a[204:207], v[16:19], v[52:55]
  ds_read_b128 v[12:15], v5 offset:26624
  s_waitcnt lgkmcnt(6)
  v_mfma_f32_16x16x32_bf16 v[56:59], a[36:39], v[20:23], v[56:59]
  v_mfma_f32_16x16x32_bf16 v[60:63], a[92:95], v[20:23], v[60:63]
  v_mfma_f32_16x16x32_bf16 v[64:67], a[148:151], v[20:23], v[64:67]
  v_mfma_f32_16x16x32_bf16 v[68:71], a[204:207], v[20:23], v[68:71]
  ds_read_b128 v[16:19], v5 offset:13312
  s_waitcnt lgkmcnt(6)
  v_mfma_f32_16x16x32_bf16 v[40:43], a[40:43], v[24:27], v[40:43]
  v_mfma_f32_16x16x32_bf16 v[44:47], a[96:99], v[24:27], v[44:47]
  v_mfma_f32_16x16x32_bf16 v[48:51], a[152:155], v[24:27], v[48:51]
  v_mfma_f32_16x16x32_bf16 v[52:55], a[208:211], v[24:27], v[52:55]
  ds_read_b128 v[20:23], v5 offset:27648
  s_waitcnt lgkmcnt(6)
  v_mfma_f32_16x16x32_bf16 v[56:59], a[40:43], v[28:31], v[56:59]
  v_mfma_f32_16x16x32_bf16 v[60:63], a[96:99], v[28:31], v[60:63]
  v_mfma_f32_16x16x32_bf16 v[64:67], a[152:155], v[28:31], v[64:67]
  v_mfma_f32_16x16x32_bf16 v[68:71], a[208:211], v[28:31], v[68:71]
  s_waitcnt lgkmcnt(5)
  v_mfma_f32_16x16x32_bf16 v[40:43], a[44:47], v[32:35], v[40:43]
  v_mfma_f32_16x16x32_bf16 v[44:47], a[100:103], v[32:35], v[44:47]
  v_mfma_f32_16x16x32_bf16 v[48:51], a[156:159], v[32:35], v[48:51]
  v_mfma_f32_16x16x32_bf16 v[52:55], a[212:215], v[32:35], v[52:55]
  s_waitcnt lgkmcnt(4)
  v_mfma_f32_16x16x32_bf16 v[56:59], a[44:47], v[36:39], v[56:59]
  v_mfma_f32_16x16x32_bf16 v[60:63], a[100:103], v[36:39], v[60:63]
  v_mfma_f32_16x16x32_bf16 v[64:67], a[156:159], v[36:39], v[64:67]
  v_mfma_f32_16x16x32_bf16 v[68:71], a[212:215], v[36:39], v[68:71]
  s_waitcnt lgkmcnt(3)
  v_mfma_f32_16x16x32_bf16 v[40:43], a[48:51], v[8:11], v[40:43]
  v_mfma_f32_16x16x32_bf16 v[44:47], a[104:107], v[8:11], v[44:47]
  v_mfma_f32_16x16x32_bf16 v[48:51], a[160:163], v[8:11], v[48:51]
  v_mfma_f32_16x16x32_bf16 v[52:55], a[216:219], v[8:11], v[52:55]
  s_waitcnt lgkmcnt(2)
  v_mfma_f32_16x16x32_bf16 v[56:59], a[48:51], v[12:15], v[56:59]
  v_mfma_f32_16x16x32_bf16 v[60:63], a[104:107], v[12:15], v[60:63]
  v_mfma_f32_16x16x32_bf16 v[64:67], a[160:163], v[12:15], v[64:67]
  v_mfma_f32_16x16x32_bf16 v[68:71], a[216:219], v[12:15], v[68:71]
  s_waitcnt lgkmcnt(1)
  v_mfma_f32_16x16x32_bf16 v[40:43], a[52:55], v[16:19], v[40:43]
  v_mfma_f32_16x16x32_bf16 v[44:47], a[108:111], v[16:19], v[44:47]
  v_mfma_f32_16x16x32_bf16 v[48:51], a[164:167], v[16:19], v[48:51]
  v_mfma_f32_16x16x32_bf16 v[52:55], a[220:223], v[16:19], v[52:55]
  s_waitcnt lgkmcnt(0)
  v_mfma_f32_16x16x32_bf16 v[56:59], a[52:55], v[20:23], v[56:59]
  v_mfma_f32_16x16x32_bf16 v[60:63], a[108:111], v[20:23], v[60:63]
  v_mfma_f32_16x16x32_bf16 v[64:67], a[164:167], v[20:23], v[64:67]
  v_mfma_f32_16x16x32_bf16 v[68:71], a[220:223], v[20:23], v[68:71]
  s_add_u32 s25, s29, 28672
  s_lshl_b32 s24, s19, 5
  s_add_u32 s24, s24, 0
  v_add_u32 v88, s24, v4
  v_mul_u32_u24 v89, 2341, v88
  v_lshrrev_b32 v89, 16, v89
  v_mul_u32_u24 v89, 84, v89
  v_add3_u32 v88, v88, v89, v6
  v_lshlrev_b32 v90, 4, v88
  v_cvt_pk_bf16_f32 v72, v40, v41
  v_cvt_pk_bf16_f32 v73, v42, v43
  v_cvt_pk_bf16_f32 v74, v44, v45
  v_cvt_pk_bf16_f32 v75, v46, v47
  buffer_store_dwordx4 v[72:75], v90, s[8:11], s29 offen sc1
  v_cvt_pk_bf16_f32 v76, v48, v49
  v_cvt_pk_bf16_f32 v77, v50, v51
  v_cvt_pk_bf16_f32 v78, v52, v53
  v_cvt_pk_bf16_f32 v79, v54, v55
  buffer_store_dwordx4 v[76:79], v90, s[8:11], s25 offen sc1
  s_lshl_b32 s24, s19, 5
  s_add_u32 s24, s24, 16
  v_add_u32 v88, s24, v4
  v_mul_u32_u24 v89, 2341, v88
  v_lshrrev_b32 v89, 16, v89
  v_mul_u32_u24 v89, 84, v89
  v_add3_u32 v88, v88, v89, v6
  v_lshlrev_b32 v91, 4, v88
  v_cvt_pk_bf16_f32 v80, v56, v57
  v_cvt_pk_bf16_f32 v81, v58, v59
  v_cvt_pk_bf16_f32 v82, v60, v61
  v_cvt_pk_bf16_f32 v83, v62, v63
  buffer_store_dwordx4 v[80:83], v91, s[8:11], s29 offen sc1
  v_cvt_pk_bf16_f32 v84, v64, v65
  v_cvt_pk_bf16_f32 v85, v66, v67
  v_cvt_pk_bf16_f32 v86, v68, v69
  v_cvt_pk_bf16_f32 v87, v70, v71
  buffer_store_dwordx4 v[84:87], v91, s[8:11], s25 offen sc1
  s_mov_b32 s33, s32
  s_add_u32 s32, s32, 28672
  s_cmp_eq_u32 s32, 86016
  s_cselect_b32 s32, 0, s32
  s_add_u32 s19, s19, 1
  s_cmp_lt_u32 s19, s35
  s_cbranch_scc1 wg_vo_loop
  s_branch wg_done
wg_done:
  s_lshl_b32 s20, s18, 4
  s_and_b32 s21, s17, 15
  s_add_u32 s20, s20, s21
  s_lshl_b32 s20, s20, 7
  s_cmp_lt_u32 s17, 16
  s_cselect_b32 s21, 16384, 0
  s_add_u32 s20, s20, s21
  s_add_u32 s20, s20, 88528896
  s_sub_u32 s21, s35, s34
  v_mov_b32 v5, s21
  v_mov_b32 v6, 0
  s_waitcnt vmcnt(0)
  s_mov_b64 exec, 1
  buffer_atomic_add v5, v6, s[8:11], s20 offen
  s_mov_b64 exec, -1
  s_branch wk_loop
wk_a:
  s_load_dwordx8 s[36:43], s[0:1], 56
  s_load_dwordx4 s[44:47], s[0:1], 88
  s_sub_u32 s3, s3, 368
  s_and_b32 s17, s3, 15
  s_lshr_b32 s19, s3, 5
  s_bitcmp1_b32 s3, 4
  s_cselect_b32 s31, 7, 0
  s_waitcnt lgkmcnt(0)
  s_mov_b32 s60, s40
  s_and_b32 s61, s41, 0xffff
  s_mov_b32 s62, 3670016
  s_mov_b32 s63, 0x20000
  s_mov_b32 s56, s42
  s_and_b32 s57, s43, 0xffff
  s_mov_b32 s58, 3670016
  s_mov_b32 s59, 0x20000
  s_lshl_b32 s30, s16, 13
  s_lshl_b32 s27, s19, 19
  s_lshl_b32 s29, s16, 17
  s_add_u32 s27, s27, s29
  s_lshl_b32 s29, s17, 9
  s_add_u32 s27, s27, s29
  v_lshrrev_b32 v5, 5, v1
  v_and_b32 v6, 31, v1
  v_xor_b32 v6, v6, v5
  v_lshlrev_b32 v6, 4, v6
  v_lshl_add_u32 v6, v5, 13, v6
  s_add_u32 m0, s30, 0
  s_add_u32 s22, s27, 0
  v_xor_b32 v7, 0, v6
  buffer_load_dwordx4 v7, s[56:59], s22 offen offset:0 lds
  s_add_u32 s22, s27, 15360
  v_xor_b32 v7, 32, v6
  buffer_load_dwordx4 v7, s[56:59], s22 offen offset:1024 lds
  s_add_u32 s22, s27, 30720
  v_xor_b32 v7, 64, v6
  buffer_load_dwordx4 v7, s[56:59], s22 offen offset:2048 lds
  s_add_u32 s22, s27, 46080
  v_xor_b32 v7, 96, v6
  buffer_load_dwordx4 v7, s[56:59], s22 offen offset:3072 lds
  s_add_u32 m0, s30, 4096
  s_add_u32 s22, s27, 65536
  v_xor_b32 v7, 128, v6
  buffer_load_dwordx4 v7, s[56:59], s22 offen offset:0 lds
  s_add_u32 s22, s27, 80896
  v_xor_b32 v7, 160, v6
  buffer_load_dwordx4 v7, s[56:59], s22 offen offset:1024 lds
  s_add_u32 s22, s27, 96256
  v_xor_b32 v7, 192, v6
  buffer_load_dwordx4 v7, s[56:59], s22 offen offset:2048 lds
  s_add_u32 s22, s27, 111616
  v_xor_b32 v7, 224, v6
  buffer_load_dwordx4 v7, s[56:59], s22 offen offset:3072 lds
  v_lshrrev_b32 v5, 5, v1
  v_and_b32 v6, 31, v1
  s_lshl_b32 s25, s16, 15
  s_add_u32 s25, s25, 32768
  s_lshl_b32 s26, s17, 9
  s_add_u32 s28, s19, s16
  s_cmp_ge_u32 s28, 7
  s_cselect_b32 s20, 7, 0
  s_sub_u32 s28, s28, s20
  s_add_u32 s28, s28, s31
  s_add_u32 s29, s19, s16
  s_add_u32 s29, s29, 4
  s_cmp_ge_u32 s29, 7
  s_cselect_b32 s20, 7, 0
  s_sub_u32 s29, s29, s20
  s_add_u32 s29, s29, s31
  s_lshl_b32 s32, s28, 18
  s_add_u32 s32, s32, s26
  s_lshl_b32 s33, s29, 18
  s_add_u32 s33, s33, s26
  v_xor_b32 v8, v6, v5
  v_lshlrev_b32 v8, 4, v8
  v_lshl_add_u32 v8, v5, 13, v8
  v_xor_b32 v12, 0, v8
  v_xor_b32 v13, 32, v8
  v_add_u32 v13, 15360, v13
  v_xor_b32 v14, 0, v8
  v_add_u32 v14, 30720, v14
  v_xor_b32 v15, 32, v8
  v_add_u32 v15, 46080, v15
  s_add_u32 s20, s16, 0
  s_and_b32 s20, s20, 3
  s_mul_i32 s21, s20, 65600
  s_lshl_b32 s20, s20, 12
  s_add_u32 s48, s20, s25
  s_mov_b32 m0, s48
  v_xor_b32 v16, s21, v12
  buffer_load_dwordx4 v16, s[60:63], s32 offen offset:0 lds
  v_xor_b32 v17, s21, v13
  buffer_load_dwordx4 v17, s[60:63], s32 offen offset:1024 lds
  v_xor_b32 v18, s21, v14
  buffer_load_dwordx4 v18, s[60:63], s32 offen offset:2048 lds
  v_xor_b32 v19, s21, v15
  buffer_load_dwordx4 v19, s[60:63], s32 offen offset:3072 lds
  s_add_u32 s20, s16, 1
  s_and_b32 s20, s20, 3
  s_mul_i32 s21, s20, 65600
  s_lshl_b32 s20, s20, 12
  s_add_u32 s49, s20, s25
  s_mov_b32 m0, s49
  v_xor_b32 v20, s21, v12
  buffer_load_dwordx4 v20, s[60:63], s32 offen offset:0 lds
  v_xor_b32 v21, s21, v13
  buffer_load_dwordx4 v21, s[60:63], s32 offen offset:1024 lds
  v_xor_b32 v22, s21, v14
  buffer_load_dwordx4 v22, s[60:63], s32 offen offset:2048 lds
  v_xor_b32 v23, s21, v15
  buffer_load_dwordx4 v23, s[60:63], s32 offen offset:3072 lds
  s_add_u32 s20, s16, 2
  s_and_b32 s20, s20, 3
  s_mul_i32 s21, s20, 65600
  s_lshl_b32 s20, s20, 12
  s_add_u32 s50, s20, s25
  s_mov_b32 m0, s50
  v_xor_b32 v24, s21, v12
  buffer_load_dwordx4 v24, s[60:63], s32 offen offset:0 lds
  v_xor_b32 v25, s21, v13
  buffer_load_dwordx4 v25, s[60:63], s32 offen offset:1024 lds
  v_xor_b32 v26, s21, v14
  buffer_load_dwordx4 v26, s[60:63], s32 offen offset:2048 lds
  v_xor_b32 v27, s21, v15
  buffer_load_dwordx4 v27, s[60:63], s32 offen offset:3072 lds
  s_add_u32 s20, s16, 3
  s_and_b32 s20, s20, 3
  s_mul_i32 s21, s20, 65600
  s_lshl_b32 s20, s20, 12
  s_add_u32 s51, s20, s25
  s_mov_b32 m0, s51
  v_xor_b32 v28, s21, v12
  buffer_load_dwordx4 v28, s[60:63], s32 offen offset:0 lds
  v_xor_b32 v29, s21, v13
  buffer_load_dwordx4 v29, s[60:63], s32 offen offset:1024 lds
  v_xor_b32 v30, s21, v14
  buffer_load_dwordx4 v30, s[60:63], s32 offen offset:2048 lds
  v_xor_b32 v31, s21, v15
  buffer_load_dwordx4 v31, s[60:63], s32 offen offset:3072 lds
  s_cmp_eq_u32 s16, 3
  s_cbranch_scc1 aj_np1
  s_add_u32 m0, s48, 16384
  s_nop 0
  buffer_load_dwordx4 v16, s[60:63], s33 offen offset:0 lds
  buffer_load_dwordx4 v17, s[60:63], s33 offen offset:1024 lds
  buffer_load_dwordx4 v18, s[60:63], s33 offen offset:2048 lds
  buffer_load_dwordx4 v19, s[60:63], s33 offen offset:3072 lds
  s_add_u32 m0, s49, 16384
  s_nop 0
  buffer_load_dwordx4 v20, s[60:63], s33 offen offset:0 lds
  buffer_load_dwordx4 v21, s[60:63], s33 offen offset:1024 lds
  buffer_load_dwordx4 v22, s[60:63], s33 offen offset:2048 lds
  buffer_load_dwordx4 v23, s[60:63], s33 offen offset:3072 lds
  s_add_u32 m0, s50, 16384
  s_nop 0
  buffer_load_dwordx4 v24, s[60:63], s33 offen offset:0 lds
  buffer_load_dwordx4 v25, s[60:63], s33 offen offset:1024 lds
  buffer_load_dwordx4 v26, s[60:63], s33 offen offset:2048 lds
  buffer_load_dwordx4 v27, s[60:63], s33 offen offset:3072 lds
  s_add_u32 m0, s51, 16384
  s_nop 0
  buffer_load_dwordx4 v28, s[60:63], s33 offen offset:0 lds
  buffer_load_dwordx4 v29, s[60:63], s33 offen offset:1024 lds
  buffer_load_dwordx4 v30, s[60:63], s33 offen offset:2048 lds
  buffer_load_dwordx4 v31, s[60:63], s33 offen offset:3072 lds
aj_np1:
  s_mul_i32 s30, s17, 401408
  s_mul_i32 s20, s19, 57344
  s_add_u32 s30, s30, s20
  v_add_u32 v12, s30, v2
  v_add_u32 v13, 14336, v12
  v_add_u32 v14, 28672, v12
  v_add_u32 v15, 43008, v12
  v_lshrrev_b32 v7, 2, v4
  v_lshlrev_b32 v7, 3, v7
  v_and_b32 v8, 3, v4
  v_add_u32 v7, v7, v8
  v_xor_b32 v10, v3, v4
  v_lshlrev_b32 v10, 4, v10
  v_lshl_add_u32 v10, v7, 9, v10
  v_add_u32 v10, s25, v10
  v_xor_b32 v32, 0, v10
  v_xor_b32 v33, 64, v10
  v_xor_b32 v34, 128, v10
  v_xor_b32 v35, 192, v10
  v_and_b32 v8, 2, v4
  v_lshlrev_b32 v8, 1, v8
  v_and_b32 v9, 1, v4
  v_add_u32 v8, v8, v9
  v_lshrrev_b32 v7, 2, v4
  v_lshl_add_u32 v7, v7, 4, v8
  v_xor_b32 v8, v8, v3
  v_lshlrev_b32 v8, 4, v8
  v_lshl_add_u32 v7, v7, 9, v8
  s_mov_b32 s24, 1035512379
  s_waitcnt vmcnt(32)
  s_cmp_lg_u32 s16, 3
  s_cbranch_scc1 w3_35
  s_waitcnt vmcnt(16)
w3_35:
  s_barrier
  v_xor_b32 v8, 0, v7
  ds_read_b128 v[128:131], v8 offset:0
  v_xor_b32 v9, 64, v7
  ds_read_b128 v[132:135], v9 offset:0
  v_xor_b32 v10, 128, v7
  ds_read_b128 v[136:139], v10 offset:0
  v_xor_b32 v11, 192, v7
  ds_read_b128 v[140:143], v11 offset:0
  ds_read_b128 v[144:147], v8 offset:256
  ds_read_b128 v[148:151], v9 offset:256
  ds_read_b128 v[152:155], v10 offset:256
  ds_read_b128 v[156:159], v11 offset:256
  s_waitcnt lgkmcnt(4)
  v_xor_b32 v8, 32, v7
  ds_read_b128 v[160:163], v8 offset:1024
  v_xor_b32 v9, 96, v7
  ds_read_b128 v[164:167], v9 offset:1024
  v_xor_b32 v10, 160, v7
  ds_read_b128 v[168:171], v10 offset:1024
  v_xor_b32 v11, 224, v7
  ds_read_b128 v[172:175], v11 offset:1024
  ds_read_b128 v[176:179], v8 offset:1280
  ds_read_b128 v[180:183], v9 offset:1280
  ds_read_b128 v[184:187], v10 offset:1280
  ds_read_b128 v[188:191], v11 offset:1280
  s_waitcnt lgkmcnt(4)
  v_xor_b32 v8, 128, v7
  ds_read_b128 v[192:195], v8 offset:4096
  v_xor_b32 v9, 192, v7
  ds_read_b128 v[196:199], v9 offset:4096
  v_xor_b32 v10, 0, v7
  ds_read_b128 v[200:203], v10 offset:4096
  v_xor_b32 v11, 64, v7
  ds_read_b128 v[204:207], v11 offset:4096
  ds_read_b128 v[208:211], v8 offset:4352
  ds_read_b128 v[212:215], v9 offset:4352
  ds_read_b128 v[216:219], v10 offset:4352
  ds_read_b128 v[220:223], v11 offset:4352
  s_waitcnt lgkmcnt(4)
  v_xor_b32 v8, 160, v7
  ds_read_b128 v[224:227], v8 offset:5120
  v_xor_b32 v9, 224, v7
  ds_read_b128 v[228:231], v9 offset:5120
  v_xor_b32 v10, 32, v7
  ds_read_b128 v[232:235], v10 offset:5120
  v_xor_b32 v11, 96, v7
  ds_read_b128 v[236:239], v11 offset:5120
  ds_read_b128 v[240:243], v8 offset:5376
  ds_read_b128 v[244:247], v9 offset:5376
  ds_read_b128 v[248:251], v10 offset:5376
  ds_read_b128 v[252:255], v11 offset:5376
  s_waitcnt lgkmcnt(4)
  s_waitcnt vmcnt(16) lgkmcnt(0)
  s_cmp_lg_u32 s16, 3
  s_cbranch_scc1 w3_36
  s_waitcnt vmcnt(0)
w3_36:
  ds_read_b128 v[52:55], v32 offset:0
  ds_read_b128 v[56:59], v33 offset:0
  ds_read_b128 v[60:63], v34 offset:0
  ds_read_b128 v[64:67], v35 offset:0
  s_waitcnt lgkmcnt(3)
  v_mfma_f32_16x16x32_bf16 v[96:99], v[52:55], v[128:131], 0
  v_mfma_f32_16x16x32_bf16 v[100:103], v[52:55], v[160:163], 0
  v_mfma_f32_16x16x32_bf16 v[104:107], v[52:55], v[192:195], 0
  v_mfma_f32_16x16x32_bf16 v[108:111], v[52:55], v[224:227], 0
  ds_read_b128 v[52:55], v32 offset:256
  s_waitcnt lgkmcnt(3)
  v_mfma_f32_16x16x32_bf16 v[96:99], v[56:59], v[132:135], v[96:99]
  v_mfma_f32_16x16x32_bf16 v[100:103], v[56:59], v[164:167], v[100:103]
  v_mfma_f32_16x16x32_bf16 v[104:107], v[56:59], v[196:199], v[104:107]
  v_mfma_f32_16x16x32_bf16 v[108:111], v[56:59], v[228:231], v[108:111]
  ds_read_b128 v[56:59], v33 offset:256
  s_waitcnt lgkmcnt(3)
  v_mfma_f32_16x16x32_bf16 v[96:99], v[60:63], v[136:139], v[96:99]
  v_mfma_f32_16x16x32_bf16 v[100:103], v[60:63], v[168:171], v[100:103]
  v_mfma_f32_16x16x32_bf16 v[104:107], v[60:63], v[200:203], v[104:107]
  v_mfma_f32_16x16x32_bf16 v[108:111], v[60:63], v[232:235], v[108:111]
  ds_read_b128 v[60:63], v34 offset:256
  s_waitcnt lgkmcnt(3)
  v_mfma_f32_16x16x32_bf16 v[96:99], v[64:67], v[140:143], v[96:99]
  v_mfma_f32_16x16x32_bf16 v[100:103], v[64:67], v[172:175], v[100:103]
  v_mfma_f32_16x16x32_bf16 v[104:107], v[64:67], v[204:207], v[104:107]
  v_mfma_f32_16x16x32_bf16 v[108:111], v[64:67], v[236:239], v[108:111]
  ds_read_b128 v[64:67], v35 offset:256
  s_waitcnt lgkmcnt(3)
  v_mfma_f32_16x16x32_bf16 v[96:99], v[52:55], v[144:147], v[96:99]
  v_mfma_f32_16x16x32_bf16 v[100:103], v[52:55], v[176:179], v[100:103]
  v_mfma_f32_16x16x32_bf16 v[104:107], v[52:55], v[208:211], v[104:107]
  v_mfma_f32_16x16x32_bf16 v[108:111], v[52:55], v[240:243], v[108:111]
  ds_read_b128 v[52:55], v32 offset:2048
  s_waitcnt lgkmcnt(3)
  v_mfma_f32_16x16x32_bf16 v[96:99], v[56:59], v[148:151], v[96:99]
  v_mfma_f32_16x16x32_bf16 v[100:103], v[56:59], v[180:183], v[100:103]
  v_mfma_f32_16x16x32_bf16 v[104:107], v[56:59], v[212:215], v[104:107]
  v_mfma_f32_16x16x32_bf16 v[108:111], v[56:59], v[244:247], v[108:111]
  ds_read_b128 v[56:59], v33 offset:2048
  s_waitcnt lgkmcnt(3)
  v_mfma_f32_16x16x32_bf16 v[96:99], v[60:63], v[152:155], v[96:99]
  v_mfma_f32_16x16x32_bf16 v[100:103], v[60:63], v[184:187], v[100:103]
  v_mfma_f32_16x16x32_bf16 v[104:107], v[60:63], v[216:219], v[104:107]
  v_mfma_f32_16x16x32_bf16 v[108:111], v[60:63], v[248:251], v[108:111]
  ds_read_b128 v[60:63], v34 offset:2048
  s_waitcnt lgkmcnt(3)
  v_mfma_f32_16x16x32_bf16 v[96:99], v[64:67], v[156:159], v[96:99]
  v_mfma_f32_16x16x32_bf16 v[100:103], v[64:67], v[188:191], v[100:103]
  v_mfma_f32_16x16x32_bf16 v[104:107], v[64:67], v[220:223], v[104:107]
  v_mfma_f32_16x16x32_bf16 v[108:111], v[64:67], v[252:255], v[108:111]
  ds_read_b128 v[64:67], v35 offset:2048
  s_waitcnt lgkmcnt(3)
  v_mfma_f32_16x16x32_bf16 v[112:115], v[52:55], v[128:131], 0
  v_mfma_f32_16x16x32_bf16 v[116:119], v[52:55], v[160:163], 0
  v_mfma_f32_16x16x32_bf16 v[120:123], v[52:55], v[192:195], 0
  v_mfma_f32_16x16x32_bf16 v[124:127], v[52:55], v[224:227], 0
  ds_read_b128 v[52:55], v32 offset:2304
  s_waitcnt lgkmcnt(3)
  v_mfma_f32_16x16x32_bf16 v[112:115], v[56:59], v[132:135], v[112:115]
  v_mfma_f32_16x16x32_bf16 v[116:119], v[56:59], v[164:167], v[116:119]
  v_mfma_f32_16x16x32_bf16 v[120:123], v[56:59], v[196:199], v[120:123]
  v_mfma_f32_16x16x32_bf16 v[124:127], v[56:59], v[228:231], v[124:127]
  ds_read_b128 v[56:59], v33 offset:2304
  s_waitcnt lgkmcnt(3)
  v_mfma_f32_16x16x32_bf16 v[112:115], v[60:63], v[136:139], v[112:115]
  v_mfma_f32_16x16x32_bf16 v[116:119], v[60:63], v[168:171], v[116:119]
  v_mfma_f32_16x16x32_bf16 v[120:123], v[60:63], v[200:203], v[120:123]
  v_mfma_f32_16x16x32_bf16 v[124:127], v[60:63], v[232:235], v[124:127]
  ds_read_b128 v[60:63], v34 offset:2304
  s_waitcnt lgkmcnt(3)
  v_mfma_f32_16x16x32_bf16 v[112:115], v[64:67], v[140:143], v[112:115]
  v_mfma_f32_16x16x32_bf16 v[116:119], v[64:67], v[172:175], v[116:119]
  v_mfma_f32_16x16x32_bf16 v[120:123], v[64:67], v[204:207], v[120:123]
  v_mfma_f32_16x16x32_bf16 v[124:127], v[64:67], v[236:239], v[124:127]
  ds_read_b128 v[64:67], v35 offset:2304
  s_waitcnt lgkmcnt(3)
  v_mfma_f32_16x16x32_bf16 v[112:115], v[52:55], v[144:147], v[112:115]
  v_mfma_f32_16x16x32_bf16 v[116:119], v[52:55], v[176:179], v[116:119]
  v_mfma_f32_16x16x32_bf16 v[120:123], v[52:55], v[208:211], v[120:123]
  v_mfma_f32_16x16x32_bf16 v[124:127], v[52:55], v[240:243], v[124:127]
  s_waitcnt lgkmcnt(2)
  v_mfma_f32_16x16x32_bf16 v[112:115], v[56:59], v[148:151], v[112:115]
  v_mfma_f32_16x16x32_bf16 v[116:119], v[56:59], v[180:183], v[116:119]
  v_mfma_f32_16x16x32_bf16 v[120:123], v[56:59], v[212:215], v[120:123]
  v_mfma_f32_16x16x32_bf16 v[124:127], v[56:59], v[244:247], v[124:127]
  s_waitcnt lgkmcnt(1)
  v_mfma_f32_16x16x32_bf16 v[112:115], v[60:63], v[152:155], v[112:115]
  v_mfma_f32_16x16x32_bf16 v[116:119], v[60:63], v[184:187], v[116:119]
  v_mfma_f32_16x16x32_bf16 v[120:123], v[60:63], v[216:219], v[120:123]
  v_mfma_f32_16x16x32_bf16 v[124:127], v[60:63], v[248:251], v[124:127]
  s_waitcnt lgkmcnt(0)
  v_mfma_f32_16x16x32_bf16 v[112:115], v[64:67], v[156:159], v[112:115]
  v_mfma_f32_16x16x32_bf16 v[116:119], v[64:67], v[188:191], v[116:119]
  v_mfma_f32_16x16x32_bf16 v[120:123], v[64:67], v[220:223], v[120:123]
  v_mfma_f32_16x16x32_bf16 v[124:127], v[64:67], v[252:255], v[124:127]
  s_lshl_b32 s30, s28, 10
  v_mul_f32 v96, s24, v96
  v_mul_f32 v97, s24, v97
  v_mul_f32 v98, s24, v98
  v_mul_f32 v99, s24, v99
  v_cvt_pk_bf16_f32 v68, v96, v97
  v_cvt_pk_bf16_f32 v69, v98, v99
  v_mul_f32 v112, s24, v112
  v_mul_f32 v113, s24, v113
  v_mul_f32 v114, s24, v114
  v_mul_f32 v115, s24, v115
  v_cvt_pk_bf16_f32 v70, v112, v113
  v_cvt_pk_bf16_f32 v71, v114, v115
  buffer_store_dwordx4 v[68:71], v12, s[8:11], s30 offen sc1
  v_mul_f32 v100, s24, v100
  v_mul_f32 v101, s24, v101
  v_mul_f32 v102, s24, v102
  v_mul_f32 v103, s24, v103
  v_cvt_pk_bf16_f32 v72, v100, v101
  v_cvt_pk_bf16_f32 v73, v102, v103
  v_mul_f32 v116, s24, v116
  v_mul_f32 v117, s24, v117
  v_mul_f32 v118, s24, v118
  v_mul_f32 v119, s24, v119
  v_cvt_pk_bf16_f32 v74, v116, v117
  v_cvt_pk_bf16_f32 v75, v118, v119
  buffer_store_dwordx4 v[72:75], v13, s[8:11], s30 offen sc1
  v_mul_f32 v104, s24, v104
  v_mul_f32 v105, s24, v105
  v_mul_f32 v106, s24, v106
  v_mul_f32 v107, s24, v107
  v_cvt_pk_bf16_f32 v76, v104, v105
  v_cvt_pk_bf16_f32 v77, v106, v107
  v_mul_f32 v120, s24, v120
  v_mul_f32 v121, s24, v121
  v_mul_f32 v122, s24, v122
  v_mul_f32 v123, s24, v123
  v_cvt_pk_bf16_f32 v78, v120, v121
  v_cvt_pk_bf16_f32 v79, v122, v123
  buffer_store_dwordx4 v[76:79], v14, s[8:11], s30 offen sc1
  v_mul_f32 v108, s24, v108
  v_mul_f32 v109, s24, v109
  v_mul_f32 v110, s24, v110
  v_mul_f32 v111, s24, v111
  v_cvt_pk_bf16_f32 v80, v108, v109
  v_cvt_pk_bf16_f32 v81, v110, v111
  v_mul_f32 v124, s24, v124
  v_mul_f32 v125, s24, v125
  v_mul_f32 v126, s24, v126
  v_mul_f32 v127, s24, v127
  v_cvt_pk_bf16_f32 v82, v124, v125
  v_cvt_pk_bf16_f32 v83, v126, v127
  buffer_store_dwordx4 v[80:83], v15, s[8:11], s30 offen sc1
  s_cmp_eq_u32 s16, 3
  s_cbranch_scc1 aj_w3
  s_waitcnt vmcnt(4)
  ds_read_b128 v[52:55], v32 offset:16384
  ds_read_b128 v[56:59], v33 offset:16384
  ds_read_b128 v[60:63], v34 offset:16384
  ds_read_b128 v[64:67], v35 offset:16384
  s_waitcnt lgkmcnt(3)
  v_mfma_f32_16x16x32_bf16 v[96:99], v[52:55], v[128:131], 0
  v_mfma_f32_16x16x32_bf16 v[100:103], v[52:55], v[160:163], 0
  v_mfma_f32_16x16x32_bf16 v[104:107], v[52:55], v[192:195], 0
  v_mfma_f32_16x16x32_bf16 v[108:111], v[52:55], v[224:227], 0
  ds_read_b128 v[52:55], v32 offset:16640
  s_waitcnt lgkmcnt(3)
  v_mfma_f32_16x16x32_bf16 v[96:99], v[56:59], v[132:135], v[96:99]
  v_mfma_f32_16x16x32_bf16 v[100:103], v[56:59], v[164:167], v[100:103]
  v_mfma_f32_16x16x32_bf16 v[104:107], v[56:59], v[196:199], v[104:107]
  v_mfma_f32_16x16x32_bf16 v[108:111], v[56:59], v[228:231], v[108:111]
  ds_read_b128 v[56:59], v33 offset:16640
  s_waitcnt lgkmcnt(3)
  v_mfma_f32_16x16x32_bf16 v[96:99], v[60:63], v[136:139], v[96:99]
  v_mfma_f32_16x16x32_bf16 v[100:103], v[60:63], v[168:171], v[100:103]
  v_mfma_f32_16x16x32_bf16 v[104:107], v[60:63], v[200:203], v[104:107]
  v_mfma_f32_16x16x32_bf16 v[108:111], v[60:63], v[232:235], v[108:111]
  ds_read_b128 v[60:63], v34 offset:16640
  s_waitcnt lgkmcnt(3)
  v_mfma_f32_16x16x32_bf16 v[96:99], v[64:67], v[140:143], v[96:99]
  v_mfma_f32_16x16x32_bf16 v[100:103], v[64:67], v[172:175], v[100:103]
  v_mfma_f32_16x16x32_bf16 v[104:107], v[64:67], v[204:207], v[104:107]
  v_mfma_f32_16x16x32_bf16 v[108:111], v[64:67], v[236:239], v[108:111]
  ds_read_b128 v[64:67], v35 offset:16640
  s_waitcnt lgkmcnt(3)
  v_mfma_f32_16x16x32_bf16 v[96:99], v[52:55], v[144:147], v[96:99]
  v_mfma_f32_16x16x32_bf16 v[100:103], v[52:55], v[176:179], v[100:103]
  v_mfma_f32_16x16x32_bf16 v[104:107], v[52:55], v[208:211], v[104:107]
  v_mfma_f32_16x16x32_bf16 v[108:111], v[52:55], v[240:243], v[108:111]
  ds_read_b128 v[52:55], v32 offset:18432
  s_waitcnt lgkmcnt(3)
  v_mfma_f32_16x16x32_bf16 v[96:99], v[56:59], v[148:151], v[96:99]
  v_mfma_f32_16x16x32_bf16 v[100:103], v[56:59], v[180:183], v[100:103]
  v_mfma_f32_16x16x32_bf16 v[104:107], v[56:59], v[212:215], v[104:107]
  v_mfma_f32_16x16x32_bf16 v[108:111], v[56:59], v[244:247], v[108:111]
  ds_read_b128 v[56:59], v33 offset:18432
  s_waitcnt lgkmcnt(3)
  v_mfma_f32_16x16x32_bf16 v[96:99], v[60:63], v[152:155], v[96:99]
  v_mfma_f32_16x16x32_bf16 v[100:103], v[60:63], v[184:187], v[100:103]
  v_mfma_f32_16x16x32_bf16 v[104:107], v[60:63], v[216:219], v[104:107]
  v_mfma_f32_16x16x32_bf16 v[108:111], v[60:63], v[248:251], v[108:111]
  ds_read_b128 v[60:63], v34 offset:18432
  s_waitcnt lgkmcnt(3)
  v_mfma_f32_16x16x32_bf16 v[96:99], v[64:67], v[156:159], v[96:99]
  v_mfma_f32_16x16x32_bf16 v[100:103], v[64:67], v[188:191], v[100:103]
  v_mfma_f32_16x16x32_bf16 v[104:107], v[64:67], v[220:223], v[104:107]
  v_mfma_f32_16x16x32_bf16 v[108:111], v[64:67], v[252:255], v[108:111]
  ds_read_b128 v[64:67], v35 offset:18432
  s_waitcnt lgkmcnt(3)
  v_mfma_f32_16x16x32_bf16 v[112:115], v[52:55], v[128:131], 0
  v_mfma_f32_16x16x32_bf16 v[116:119], v[52:55], v[160:163], 0
  v_mfma_f32_16x16x32_bf16 v[120:123], v[52:55], v[192:195], 0
  v_mfma_f32_16x16x32_bf16 v[124:127], v[52:55], v[224:227], 0
  ds_read_b128 v[52:55], v32 offset:18688
  s_waitcnt lgkmcnt(3)
  v_mfma_f32_16x16x32_bf16 v[112:115], v[56:59], v[132:135], v[112:115]
  v_mfma_f32_16x16x32_bf16 v[116:119], v[56:59], v[164:167], v[116:119]
  v_mfma_f32_16x16x32_bf16 v[120:123], v[56:59], v[196:199], v[120:123]
  v_mfma_f32_16x16x32_bf16 v[124:127], v[56:59], v[228:231], v[124:127]
  ds_read_b128 v[56:59], v33 offset:18688
  s_waitcnt lgkmcnt(3)
  v_mfma_f32_16x16x32_bf16 v[112:115], v[60:63], v[136:139], v[112:115]
  v_mfma_f32_16x16x32_bf16 v[116:119], v[60:63], v[168:171], v[116:119]
  v_mfma_f32_16x16x32_bf16 v[120:123], v[60:63], v[200:203], v[120:123]
  v_mfma_f32_16x16x32_bf16 v[124:127], v[60:63], v[232:235], v[124:127]
  ds_read_b128 v[60:63], v34 offset:18688
  s_waitcnt lgkmcnt(3)
  v_mfma_f32_16x16x32_bf16 v[112:115], v[64:67], v[140:143], v[112:115]
  v_mfma_f32_16x16x32_bf16 v[116:119], v[64:67], v[172:175], v[116:119]
  v_mfma_f32_16x16x32_bf16 v[120:123], v[64:67], v[204:207], v[120:123]
  v_mfma_f32_16x16x32_bf16 v[124:127], v[64:67], v[236:239], v[124:127]
  ds_read_b128 v[64:67], v35 offset:18688
  s_waitcnt lgkmcnt(3)
  v_mfma_f32_16x16x32_bf16 v[112:115], v[52:55], v[144:147], v[112:115]
  v_mfma_f32_16x16x32_bf16 v[116:119], v[52:55], v[176:179], v[116:119]
  v_mfma_f32_16x16x32_bf16 v[120:123], v[52:55], v[208:211], v[120:123]
  v_mfma_f32_16x16x32_bf16 v[124:127], v[52:55], v[240:243], v[124:127]
  s_waitcnt lgkmcnt(2)
  v_mfma_f32_16x16x32_bf16 v[112:115], v[56:59], v[148:151], v[112:115]
  v_mfma_f32_16x16x32_bf16 v[116:119], v[56:59], v[180:183], v[116:119]
  v_mfma_f32_16x16x32_bf16 v[120:123], v[56:59], v[212:215], v[120:123]
  v_mfma_f32_16x16x32_bf16 v[124:127], v[56:59], v[244:247], v[124:127]
  s_waitcnt lgkmcnt(1)
  v_mfma_f32_16x16x32_bf16 v[112:115], v[60:63], v[152:155], v[112:115]
  v_mfma_f32_16x16x32_bf16 v[116:119], v[60:63], v[184:187], v[116:119]
  v_mfma_f32_16x16x32_bf16 v[120:123], v[60:63], v[216:219], v[120:123]
  v_mfma_f32_16x16x32_bf16 v[124:127], v[60:63], v[248:251], v[124:127]
  s_waitcnt lgkmcnt(0)
  v_mfma_f32_16x16x32_bf16 v[112:115], v[64:67], v[156:159], v[112:115]
  v_mfma_f32_16x16x32_bf16 v[116:119], v[64:67], v[188:191], v[116:119]
  v_mfma_f32_16x16x32_bf16 v[120:123], v[64:67], v[220:223], v[120:123]
  v_mfma_f32_16x16x32_bf16 v[124:127], v[64:67], v[252:255], v[124:127]
  s_lshl_b32 s30, s29, 10
  v_mul_f32 v96, s24, v96
  v_mul_f32 v97, s24, v97
  v_mul_f32 v98, s24, v98
  v_mul_f32 v99, s24, v99
  v_cvt_pk_bf16_f32 v68, v96, v97
  v_cvt_pk_bf16_f32 v69, v98, v99
  v_mul_f32 v112, s24, v112
  v_mul_f32 v113, s24, v113
  v_mul_f32 v114, s24, v114
  v_mul_f32 v115, s24, v115
  v_cvt_pk_bf16_f32 v70, v112, v113
  v_cvt_pk_bf16_f32 v71, v114, v115
  buffer_store_dwordx4 v[68:71], v12, s[8:11], s30 offen sc1
  v_mul_f32 v100, s24, v100
  v_mul_f32 v101, s24, v101
  v_mul_f32 v102, s24, v102
  v_mul_f32 v103, s24, v103
  v_cvt_pk_bf16_f32 v72, v100, v101
  v_cvt_pk_bf16_f32 v73, v102, v103
  v_mul_f32 v116, s24, v116
  v_mul_f32 v117, s24, v117
  v_mul_f32 v118, s24, v118
  v_mul_f32 v119, s24, v119
  v_cvt_pk_bf16_f32 v74, v116, v117
  v_cvt_pk_bf16_f32 v75, v118, v119
  buffer_store_dwordx4 v[72:75], v13, s[8:11], s30 offen sc1
  v_mul_f32 v104, s24, v104
  v_mul_f32 v105, s24, v105
  v_mul_f32 v106, s24, v106
  v_mul_f32 v107, s24, v107
  v_cvt_pk_bf16_f32 v76, v104, v105
  v_cvt_pk_bf16_f32 v77, v106, v107
  v_mul_f32 v120, s24, v120
  v_mul_f32 v121, s24, v121
  v_mul_f32 v122, s24, v122
  v_mul_f32 v123, s24, v123
  v_cvt_pk_bf16_f32 v78, v120, v121
  v_cvt_pk_bf16_f32 v79, v122, v123
  buffer_store_dwordx4 v[76:79], v14, s[8:11], s30 offen sc1
  v_mul_f32 v108, s24, v108
  v_mul_f32 v109, s24, v109
  v_mul_f32 v110, s24, v110
  v_mul_f32 v111, s24, v111
  v_cvt_pk_bf16_f32 v80, v108, v109
  v_cvt_pk_bf16_f32 v81, v110, v111
  v_mul_f32 v124, s24, v124
  v_mul_f32 v125, s24, v125
  v_mul_f32 v126, s24, v126
  v_mul_f32 v127, s24, v127
  v_cvt_pk_bf16_f32 v82, v124, v125
  v_cvt_pk_bf16_f32 v83, v126, v127
  buffer_store_dwordx4 v[80:83], v15, s[8:11], s30 offen sc1
aj_w3:
  s_lshl_b32 s28, s17, 7
  s_lshl_b32 s21, s19, 4
  s_add_u32 s28, s28, s21
  s_cmp_lg_u32 s31, 0
  s_cselect_b32 s21, 8, 0
  s_add_u32 s28, s28, s21
  s_add_u32 s28, s28, 88621056
  s_waitcnt vmcnt(0)
  s_barrier
  s_cmp_lg_u32 s16, 0
  s_cbranch_scc1 pub_37
  v_mul_u32_u24 v26, 2048, v1
  v_mov_b32 v24, s88
  v_mov_b32 v25, s89
  s_mov_b64 exec, 1
  buffer_store_dwordx2 v[24:25], v26, s[8:11], s28 offen sc1
  s_mov_b64 exec, -1
pub_37:
  v_mov_b32 v250, 0
  s_branch wk_loop
wk_srv:
  s_sub_u32 s3, s3, 336
  s_and_b32 s18, s3, 15
  s_lshr_b32 s19, s3, 4
  s_and_b32 s19, s19, 1
  s_mul_i32 s20, s18, 401408
  s_mul_i32 s21, s16, 100352
  s_add_u32 s20, s20, s21
  s_add_u32 s20, s20, 6422528
  s_add_u32 s22, s20, 0
  buffer_load_dwordx4 a[0:3], v2, s[8:11], s22 offen offset:0 sc1
  buffer_load_dwordx4 a[4:7], v2, s[8:11], s22 offen offset:1024 sc1
  buffer_load_dwordx4 a[8:11], v2, s[8:11], s22 offen offset:2048 sc1
  buffer_load_dwordx4 a[12:15], v2, s[8:11], s22 offen offset:3072 sc1
  s_add_u32 s22, s20, 4096
  buffer_load_dwordx4 a[16:19], v2, s[8:11], s22 offen offset:0 sc1
  buffer_load_dwordx4 a[20:23], v2, s[8:11], s22 offen offset:1024 sc1
  buffer_load_dwordx4 a[24:27], v2, s[8:11], s22 offen offset:2048 sc1
  buffer_load_dwordx4 a[28:31], v2, s[8:11], s22 offen offset:3072 sc1
  s_add_u32 s22, s20, 8192
  buffer_load_dwordx4 a[32:35], v2, s[8:11], s22 offen offset:0 sc1
  buffer_load_dwordx4 a[36:39], v2, s[8:11], s22 offen offset:1024 sc1
  buffer_load_dwordx4 a[40:43], v2, s[8:11], s22 offen offset:2048 sc1
  buffer_load_dwordx4 a[44:47], v2, s[8:11], s22 offen offset:3072 sc1
  s_add_u32 s22, s20, 12288
  buffer_load_dwordx4 a[48:51], v2, s[8:11], s22 offen offset:0 sc1
  buffer_load_dwordx4 a[52:55], v2, s[8:11], s22 offen offset:1024 sc1
  buffer_load_dwordx4 a[56:59], v2, s[8:11], s22 offen offset:2048 sc1
  buffer_load_dwordx4 a[60:63], v2, s[8:11], s22 offen offset:3072 sc1
  s_add_u32 s22, s20, 16384
  buffer_load_dwordx4 a[64:67], v2, s[8:11], s22 offen offset:0 sc1
  buffer_load_dwordx4 a[68:71], v2, s[8:11], s22 offen offset:1024 sc1
  buffer_load_dwordx4 a[72:75], v2, s[8:11], s22 offen offset:2048 sc1
  buffer_load_dwordx4 a[76:79], v2, s[8:11], s22 offen offset:3072 sc1
  s_add_u32 s22, s20, 20480
  buffer_load_dwordx4 a[80:83], v2, s[8:11], s22 offen offset:0 sc1
  buffer_load_dwordx4 a[84:87], v2, s[8:11], s22 offen offset:1024 sc1
  buffer_load_dwordx4 a[88:91], v2, s[8:11], s22 offen offset:2048 sc1
  buffer_load_dwordx4 a[92:95], v2, s[8:11], s22 offen offset:3072 sc1
  s_add_u32 s22, s20, 24576
  buffer_load_dwordx4 a[96:99], v2, s[8:11], s22 offen offset:0 sc1
  buffer_load_dwordx4 a[100:103], v2, s[8:11], s22 offen offset:1024 sc1
  buffer_load_dwordx4 a[104:107], v2, s[8:11], s22 offen offset:2048 sc1
  buffer_load_dwordx4 a[108:111], v2, s[8:11], s22 offen offset:3072 sc1
  s_add_u32 s22, s20, 28672
  buffer_load_dwordx4 a[112:115], v2, s[8:11], s22 offen offset:0 sc1
  buffer_load_dwordx4 a[116:119], v2, s[8:11], s22 offen offset:1024 sc1
  buffer_load_dwordx4 a[120:123], v2, s[8:11], s22 offen offset:2048 sc1
  buffer_load_dwordx4 a[124:127], v2, s[8:11], s22 offen offset:3072 sc1
  s_waitcnt vmcnt(24)
  s_add_u32 s22, s20, 32768
  buffer_load_dwordx4 a[128:131], v2, s[8:11], s22 offen offset:0 sc1
  buffer_load_dwordx4 a[132:135], v2, s[8:11], s22 offen offset:1024 sc1
  buffer_load_dwordx4 a[136:139], v2, s[8:11], s22 offen offset:2048 sc1
  buffer_load_dwordx4 a[140:143], v2, s[8:11], s22 offen offset:3072 sc1
  s_add_u32 s22, s20, 36864
  buffer_load_dwordx4 a[144:147], v2, s[8:11], s22 offen offset:0 sc1
  buffer_load_dwordx4 a[148:151], v2, s[8:11], s22 offen offset:1024 sc1
  buffer_load_dwordx4 a[152:155], v2, s[8:11], s22 offen offset:2048 sc1
  buffer_load_dwordx4 a[156:159], v2, s[8:11], s22 offen offset:3072 sc1
  s_add_u32 s22, s20, 40960
  buffer_load_dwordx4 a[160:163], v2, s[8:11], s22 offen offset:0 sc1
  buffer_load_dwordx4 a[164:167], v2, s[8:11], s22 offen offset:1024 sc1
  buffer_load_dwordx4 a[168:171], v2, s[8:11], s22 offen offset:2048 sc1
  buffer_load_dwordx4 a[172:175], v2, s[8:11], s22 offen offset:3072 sc1
  s_add_u32 s22, s20, 45056
  buffer_load_dwordx4 a[176:179], v2, s[8:11], s22 offen offset:0 sc1
  buffer_load_dwordx4 a[180:183], v2, s[8:11], s22 offen offset:1024 sc1
  buffer_load_dwordx4 a[184:187], v2, s[8:11], s22 offen offset:2048 sc1
  buffer_load_dwordx4 a[188:191], v2, s[8:11], s22 offen offset:3072 sc1
  s_add_u32 s22, s20, 49152
  buffer_load_dwordx4 a[192:195], v2, s[8:11], s22 offen offset:0 sc1
  buffer_load_dwordx4 a[196:199], v2, s[8:11], s22 offen offset:1024 sc1
  buffer_load_dwordx4 a[200:203], v2, s[8:11], s22 offen offset:2048 sc1
  buffer_load_dwordx4 a[204:207], v2, s[8:11], s22 offen offset:3072 sc1
  s_add_u32 s22, s20, 53248
  buffer_load_dwordx4 a[208:211], v2, s[8:11], s22 offen offset:0 sc1
  buffer_load_dwordx4 a[212:215], v2, s[8:11], s22 offen offset:1024 sc1
  buffer_load_dwordx4 a[216:219], v2, s[8:11], s22 offen offset:2048 sc1
  buffer_load_dwordx4 a[220:223], v2, s[8:11], s22 offen offset:3072 sc1
  s_add_u32 s22, s20, 57344
  buffer_load_dwordx4 a[224:227], v2, s[8:11], s22 offen offset:0 sc1
  buffer_load_dwordx4 a[228:231], v2, s[8:11], s22 offen offset:1024 sc1
  buffer_load_dwordx4 a[232:235], v2, s[8:11], s22 offen offset:2048 sc1
  buffer_load_dwordx4 a[236:239], v2, s[8:11], s22 offen offset:3072 sc1
  s_add_u32 s22, s20, 61440
  buffer_load_dwordx4 a[240:243], v2, s[8:11], s22 offen offset:0 sc1
  buffer_load_dwordx4 a[244:247], v2, s[8:11], s22 offen offset:1024 sc1
  buffer_load_dwordx4 a[248:251], v2, s[8:11], s22 offen offset:2048 sc1
  buffer_load_dwordx4 a[252:255], v2, s[8:11], s22 offen offset:3072 sc1
  s_waitcnt vmcnt(24)
  s_add_u32 s22, s20, 65536
  buffer_load_dwordx4 v[120:123], v2, s[8:11], s22 offen offset:0 sc1
  buffer_load_dwordx4 v[124:127], v2, s[8:11], s22 offen offset:1024 sc1
  buffer_load_dwordx4 v[128:131], v2, s[8:11], s22 offen offset:2048 sc1
  buffer_load_dwordx4 v[132:135], v2, s[8:11], s22 offen offset:3072 sc1
  s_add_u32 s22, s20, 69632
  buffer_load_dwordx4 v[136:139], v2, s[8:11], s22 offen offset:0 sc1
  buffer_load_dwordx4 v[140:143], v2, s[8:11], s22 offen offset:1024 sc1
  buffer_load_dwordx4 v[144:147], v2, s[8:11], s22 offen offset:2048 sc1
  buffer_load_dwordx4 v[148:151], v2, s[8:11], s22 offen offset:3072 sc1
  s_add_u32 s22, s20, 73728
  buffer_load_dwordx4 v[152:155], v2, s[8:11], s22 offen offset:0 sc1
  buffer_load_dwordx4 v[156:159], v2, s[8:11], s22 offen offset:1024 sc1
  buffer_load_dwordx4 v[160:163], v2, s[8:11], s22 offen offset:2048 sc1
  buffer_load_dwordx4 v[164:167], v2, s[8:11], s22 offen offset:3072 sc1
  s_add_u32 s22, s20, 77824
  buffer_load_dwordx4 v[168:171], v2, s[8:11], s22 offen offset:0 sc1
  buffer_load_dwordx4 v[172:175], v2, s[8:11], s22 offen offset:1024 sc1
  buffer_load_dwordx4 v[176:179], v2, s[8:11], s22 offen offset:2048 sc1
  buffer_load_dwordx4 v[180:183], v2, s[8:11], s22 offen offset:3072 sc1
  s_add_u32 s22, s20, 81920
  buffer_load_dwordx4 v[184:187], v2, s[8:11], s22 offen offset:0 sc1
  buffer_load_dwordx4 v[188:191], v2, s[8:11], s22 offen offset:1024 sc1
  buffer_load_dwordx4 v[192:195], v2, s[8:11], s22 offen offset:2048 sc1
  buffer_load_dwordx4 v[196:199], v2, s[8:11], s22 offen offset:3072 sc1
  s_add_u32 s22, s20, 86016
  buffer_load_dwordx4 v[200:203], v2, s[8:11], s22 offen offset:0 sc1
  buffer_load_dwordx4 v[204:207], v2, s[8:11], s22 offen offset:1024 sc1
  buffer_load_dwordx4 v[208:211], v2, s[8:11], s22 offen offset:2048 sc1
  buffer_load_dwordx4 v[212:215], v2, s[8:11], s22 offen offset:3072 sc1
  s_add_u32 s22, s20, 90112
  buffer_load_dwordx4 v[216:219], v2, s[8:11], s22 offen offset:0 sc1
  buffer_load_dwordx4 v[220:223], v2, s[8:11], s22 offen offset:1024 sc1
  buffer_load_dwordx4 v[224:227], v2, s[8:11], s22 offen offset:2048 sc1
  buffer_load_dwordx4 v[228:231], v2, s[8:11], s22 offen offset:3072 sc1
  s_add_u32 s22, s20, 94208
  buffer_load_dwordx4 v[232:235], v2, s[8:11], s22 offen offset:0 sc1
  buffer_load_dwordx4 v[236:239], v2, s[8:11], s22 offen offset:1024 sc1
  buffer_load_dwordx4 v[240:243], v2, s[8:11], s22 offen offset:2048 sc1
  buffer_load_dwordx4 v[244:247], v2, s[8:11], s22 offen offset:3072 sc1
  s_waitcnt vmcnt(24)
  s_add_u32 s22, s20, 98304
  buffer_load_dwordx4 v[248:251], v2, s[8:11], s22 offen offset:0 sc1
  buffer_load_dwordx4 v[252:255], v2, s[8:11], s22 offen offset:1024 sc1
  v_mov_b32 v5, 0x4444
  v_mov_b32 v6, 0xeeee
  v_cmp_lt_u32 vcc, 7, v4
  s_nop 1
  v_cndmask_b32 v5, v5, v6, vcc
  s_lshl_b32 s23, s16, 11
  v_lshrrev_b32 v80, 1, v3
  v_and_b32 v81, 1, v3
  v_add_u32 v82, 0, v80
  v_lshl_add_u32 v82, v82, 4, v4
  v_mul_u32_u24 v83, 2341, v82
  v_lshrrev_b32 v83, 16, v83
  v_mul_u32_u24 v84, 28, v83
  v_sub_u32 v84, v82, v84
  v_lshrrev_b32 v85, 4, v84
  v_and_b32 v84, 15, v84
  v_lshlrev_b32 v86, 10, v85
  v_lshl_add_u32 v86, v83, 8, v86
  v_lshl_add_u32 v86, v84, 4, v86
  v_lshl_add_u32 v86, v81, 3, v86
  v_add_u32 v72, s23, v86
  v_add_u32 v82, 2, v80
  v_lshl_add_u32 v82, v82, 4, v4
  v_mul_u32_u24 v83, 2341, v82
  v_lshrrev_b32 v83, 16, v83
  v_mul_u32_u24 v84, 28, v83
  v_sub_u32 v84, v82, v84
  v_lshrrev_b32 v85, 4, v84
  v_and_b32 v84, 15, v84
  v_lshlrev_b32 v86, 10, v85
  v_lshl_add_u32 v86, v83, 8, v86
  v_lshl_add_u32 v86, v84, 4, v86
  v_lshl_add_u32 v86, v81, 3, v86
  v_add_u32 v73, s23, v86
  v_add_u32 v82, 4, v80
  v_lshl_add_u32 v82, v82, 4, v4
  v_mul_u32_u24 v83, 2341, v82
  v_lshrrev_b32 v83, 16, v83
  v_mul_u32_u24 v84, 28, v83
  v_sub_u32 v84, v82, v84
  v_lshrrev_b32 v85, 4, v84
  v_and_b32 v84, 15, v84
  v_lshlrev_b32 v86, 10, v85
  v_lshl_add_u32 v86, v83, 8, v86
  v_lshl_add_u32 v86, v84, 4, v86
  v_lshl_add_u32 v86, v81, 3, v86
  v_add_u32 v74, s23, v86
  v_mov_b32 v82, 6
  v_lshl_add_u32 v82, v82, 4, v4
  v_mul_u32_u24 v83, 2341, v82
  v_lshrrev_b32 v83, 16, v83
  v_mul_u32_u24 v84, 28, v83
  v_sub_u32 v84, v82, v84
  v_lshrrev_b32 v85, 4, v84
  v_and_b32 v84, 15, v84
  v_lshlrev_b32 v86, 10, v85
  v_lshl_add_u32 v86, v83, 8, v86
  v_lshl_add_u32 v86, v84, 4, v86
  v_lshl_add_u32 v86, v81, 3, v86
  v_add_u32 v75, s23, v86
  v_add_u32 v76, s23, v2
  s_mul_i32 s27, s18, 448
  v_mov_b32 v77, s27
  v_mov_b32 v78, 1
  s_mov_b32 s17, s19
  s_mul_i32 s24, s19, 7168
  s_add_u32 s24, s24, 88068096
  s_mul_i32 s25, s18, 65
  s_add_u32 s25, s25, s19
  s_lshl_b32 s25, s25, 13
  s_add_u32 s25, s25, s23
  s_add_u32 s25, s25, 76935168
  s_lshl_b32 s26, s18, 6
  s_add_u32 s26, s26, s19
  s_lshl_b32 s26, s26, 4
  s_lshl_b32 s27, s16, 2
  s_add_u32 s26, s26, s27
  s_add_u32 s26, s26, 88569856
ws_loop:
  v_mov_b32 v36, 0
  v_mov_b32 v37, 0
  v_mov_b32 v38, 0
  v_mov_b32 v39, 0
  v_mov_b32 v40, 0
  v_mov_b32 v41, 0
  v_mov_b32 v42, 0
  v_mov_b32 v43, 0
  v_mov_b32 v44, 0
  v_mov_b32 v45, 0
  v_mov_b32 v46, 0
  v_mov_b32 v47, 0
  v_mov_b32 v48, 0
  v_mov_b32 v49, 0
  v_mov_b32 v50, 0
  v_mov_b32 v51, 0
  v_mov_b32 v52, 0
  v_mov_b32 v53, 0
  v_mov_b32 v54, 0
  v_mov_b32 v55, 0
  v_mov_b32 v56, 0
  v_mov_b32 v57, 0
  v_mov_b32 v58, 0
  v_mov_b32 v59, 0
  v_mov_b32 v60, 0
  v_mov_b32 v61, 0
  v_mov_b32 v62, 0
  v_mov_b32 v63, 0
  s_mov_b32 s30, 0
ws_pm:
  s_cmp_ge_u32 s17, 61
  s_cbranch_scc1 mp_38a
  v_mov_b32 v79, 0
  s_mov_b64 exec, 1
  buffer_atomic_or v79, v77, s[8:11], s24 offen sc0
  s_mov_b64 exec, -1
  s_branch mp_38b
mp_38a:
  buffer_load_dword v79, v77, s[8:11], s24 offen sc1
mp_38b:
  s_waitcnt vmcnt(0)
  v_cmp_eq_u32 vcc, -1, v79
  s_cbranch_vccnz ws_pr
ws_fl:
  s_add_u32 s22, s24, 4096
  buffer_load_dwordx4 v[8:11], v2, s[8:11], s24 offen offset:0 sc1
  buffer_load_dwordx4 v[12:15], v2, s[8:11], s24 offen offset:1024 sc1
  buffer_load_dwordx4 v[16:19], v2, s[8:11], s24 offen offset:2048 sc1
  buffer_load_dwordx4 v[20:23], v2, s[8:11], s24 offen offset:3072 sc1
  buffer_load_dwordx4 v[24:27], v2, s[8:11], s22 offen offset:0 sc1
  buffer_load_dwordx4 v[28:31], v2, s[8:11], s22 offen offset:1024 sc1
  buffer_load_dwordx4 v[32:35], v2, s[8:11], s22 offen offset:2048 sc1
  s_waitcnt vmcnt(0)
  v_max_u32 v79, v8, v9
  v_max3_u32 v79, v79, v10, v11
  v_max3_u32 v79, v79, v12, v13
  v_max3_u32 v79, v79, v14, v15
  v_max3_u32 v79, v79, v16, v17
  v_max3_u32 v79, v79, v18, v19
  v_max3_u32 v79, v79, v20, v21
  v_max3_u32 v79, v79, v22, v23
  v_max3_u32 v79, v79, v24, v25
  v_max3_u32 v79, v79, v26, v27
  v_max3_u32 v79, v79, v28, v29
  v_max3_u32 v79, v79, v30, v31
  v_max3_u32 v79, v79, v32, v33
  v_max3_u32 v79, v79, v34, v35
  v_cmp_eq_u32 vcc, -1, v79
  s_cbranch_vccz ws_pk
ws_pr:
  s_sleep 1
  s_cmp_ge_u32 s17, 61
  s_cbranch_scc1 ws_sh
  s_sleep 6
ws_sh:
  s_add_u32 s30, s30, 1
  s_cmp_lt_u32 s30, 30000
  s_cbranch_scc1 ws_pm
  s_branch cA_abort
ws_pk:
  v_smfmac_f32_16x16x64_bf16 v[36:39], v[8:11], a[0:7], v5
  v_smfmac_f32_16x16x64_bf16 v[36:39], v[12:15], a[8:15], v5
  v_smfmac_f32_16x16x64_bf16 v[36:39], v[16:19], a[16:23], v5
  v_smfmac_f32_16x16x64_bf16 v[36:39], v[20:23], a[24:31], v5
  v_smfmac_f32_16x16x64_bf16 v[36:39], v[24:27], a[32:39], v5
  v_smfmac_f32_16x16x64_bf16 v[36:39], v[28:31], a[40:47], v5
  v_smfmac_f32_16x16x64_bf16 v[36:39], v[32:35], a[48:55], v5
  v_smfmac_f32_16x16x64_bf16 v[40:43], v[8:11], a[56:63], v5
  v_smfmac_f32_16x16x64_bf16 v[40:43], v[12:15], a[64:71], v5
  v_smfmac_f32_16x16x64_bf16 v[40:43], v[16:19], a[72:79], v5
  v_smfmac_f32_16x16x64_bf16 v[40:43], v[20:23], a[80:87], v5
  v_smfmac_f32_16x16x64_bf16 v[40:43], v[24:27], a[88:95], v5
  v_smfmac_f32_16x16x64_bf16 v[40:43], v[28:31], a[96:103], v5
  v_smfmac_f32_16x16x64_bf16 v[40:43], v[32:35], a[104:111], v5
  v_smfmac_f32_16x16x64_bf16 v[44:47], v[8:11], a[112:119], v5
  v_smfmac_f32_16x16x64_bf16 v[44:47], v[12:15], a[120:127], v5
  v_smfmac_f32_16x16x64_bf16 v[44:47], v[16:19], a[128:135], v5
  v_smfmac_f32_16x16x64_bf16 v[44:47], v[20:23], a[136:143], v5
  v_smfmac_f32_16x16x64_bf16 v[44:47], v[24:27], a[144:151], v5
  v_smfmac_f32_16x16x64_bf16 v[44:47], v[28:31], a[152:159], v5
  v_smfmac_f32_16x16x64_bf16 v[44:47], v[32:35], a[160:167], v5
  v_smfmac_f32_16x16x64_bf16 v[48:51], v[8:11], a[168:175], v5
  v_smfmac_f32_16x16x64_bf16 v[48:51], v[12:15], a[176:183], v5
  v_smfmac_f32_16x16x64_bf16 v[48:51], v[16:19], a[184:191], v5
  v_smfmac_f32_16x16x64_bf16 v[48:51], v[20:23], a[192:199], v5
  v_smfmac_f32_16x16x64_bf16 v[48:51], v[24:27], a[200:207], v5
  v_smfmac_f32_16x16x64_bf16 v[48:51], v[28:31], a[208:215], v5
  v_smfmac_f32_16x16x64_bf16 v[48:51], v[32:35], a[216:223], v5
  v_smfmac_f32_16x16x64_bf16 v[52:55], v[8:11], a[224:231], v5
  v_smfmac_f32_16x16x64_bf16 v[52:55], v[12:15], a[232:239], v5
  v_smfmac_f32_16x16x64_bf16 v[52:55], v[16:19], a[240:247], v5
  v_smfmac_f32_16x16x64_bf16 v[52:55], v[20:23], a[248:255], v5
  v_smfmac_f32_16x16x64_bf16 v[52:55], v[24:27], v[120:127], v5
  v_smfmac_f32_16x16x64_bf16 v[52:55], v[28:31], v[128:135], v5
  v_smfmac_f32_16x16x64_bf16 v[52:55], v[32:35], v[136:143], v5
  v_smfmac_f32_16x16x64_bf16 v[56:59], v[8:11], v[144:151], v5
  v_smfmac_f32_16x16x64_bf16 v[56:59], v[12:15], v[152:159], v5
  v_smfmac_f32_16x16x64_bf16 v[56:59], v[16:19], v[160:167], v5
  v_smfmac_f32_16x16x64_bf16 v[56:59], v[20:23], v[168:175], v5
  v_smfmac_f32_16x16x64_bf16 v[56:59], v[24:27], v[176:183], v5
  v_smfmac_f32_16x16x64_bf16 v[56:59], v[28:31], v[184:191], v5
  v_smfmac_f32_16x16x64_bf16 v[56:59], v[32:35], v[192:199], v5
  v_smfmac_f32_16x16x64_bf16 v[60:63], v[8:11], v[200:207], v5
  v_smfmac_f32_16x16x64_bf16 v[60:63], v[12:15], v[208:215], v5
  v_smfmac_f32_16x16x64_bf16 v[60:63], v[16:19], v[216:223], v5
  v_smfmac_f32_16x16x64_bf16 v[60:63], v[20:23], v[224:231], v5
  v_smfmac_f32_16x16x64_bf16 v[60:63], v[24:27], v[232:239], v5
  v_smfmac_f32_16x16x64_bf16 v[60:63], v[28:31], v[240:247], v5
  v_smfmac_f32_16x16x64_bf16 v[60:63], v[32:35], v[248:255], v5
  v_permlane32_swap_b32 v36, v40
  v_permlane32_swap_b32 v37, v41
  v_permlane32_swap_b32 v38, v42
  v_permlane32_swap_b32 v39, v43
  v_add_f32 v36, v36, v40
  v_add_f32 v37, v37, v41
  v_add_f32 v38, v38, v42
  v_add_f32 v39, v39, v43
  v_cvt_pk_bf16_f32 v40, v36, v37
  v_cvt_pk_bf16_f32 v41, v38, v39
  ds_write_b64 v72, v[40:41]
  v_permlane32_swap_b32 v44, v48
  v_permlane32_swap_b32 v45, v49
  v_permlane32_swap_b32 v46, v50
  v_permlane32_swap_b32 v47, v51
  v_add_f32 v44, v44, v48
  v_add_f32 v45, v45, v49
  v_add_f32 v46, v46, v50
  v_add_f32 v47, v47, v51
  v_cvt_pk_bf16_f32 v48, v44, v45
  v_cvt_pk_bf16_f32 v49, v46, v47
  ds_write_b64 v73, v[48:49]
  v_permlane32_swap_b32 v52, v56
  v_permlane32_swap_b32 v53, v57
  v_permlane32_swap_b32 v54, v58
  v_permlane32_swap_b32 v55, v59
  v_add_f32 v52, v52, v56
  v_add_f32 v53, v53, v57
  v_add_f32 v54, v54, v58
  v_add_f32 v55, v55, v59
  v_cvt_pk_bf16_f32 v56, v52, v53
  v_cvt_pk_bf16_f32 v57, v54, v55
  ds_write_b64 v74, v[56:57]
  v_mov_b32 v64, v60
  v_mov_b32 v65, v61
  v_mov_b32 v66, v62
  v_mov_b32 v67, v63
  v_permlane32_swap_b32 v60, v64
  v_permlane32_swap_b32 v61, v65
  v_permlane32_swap_b32 v62, v66
  v_permlane32_swap_b32 v63, v67
  v_add_f32 v60, v60, v64
  v_add_f32 v61, v61, v65
  v_add_f32 v62, v62, v66
  v_add_f32 v63, v63, v67
  v_cvt_pk_bf16_f32 v64, v60, v61
  v_cvt_pk_bf16_f32 v65, v62, v63
  ds_write_b64 v75, v[64:65]
  s_waitcnt lgkmcnt(0)
  ds_read_b128 v[64:67], v76
  ds_read_b128 v[68:71], v76 offset:1024
  s_waitcnt lgkmcnt(0)
  buffer_store_dwordx4 v[64:67], v2, s[8:11], s25 offen sc1
  buffer_store_dwordx4 v[68:71], v2, s[8:11], s25 offen offset:1024 sc1
  s_waitcnt vmcnt(0)
  s_mov_b64 exec, 1
  buffer_store_dword v78, v2, s[8:11], s26 offen sc1
  s_mov_b64 exec, -1
  s_add_u32 s24, s24, 14336
  s_add_u32 s25, s25, 16384
  s_add_u32 s26, s26, 32
  s_add_u32 s17, s17, 2
  s_cmp_lt_u32 s17, 64
  s_cbranch_scc1 ws_loop
  v_mov_b32 v250, 0
  s_branch wk_loop
wk_s4d:
  s_cmp_lg_u32 s16, 0
  s_cbranch_scc1 w0_39
  s_getreg_b32 s20, hwreg(HW_REG_XCC_ID)
  s_sub_u32 s20, s20, 1
  s_and_b32 s20, s20, 7
  s_mov_b64 exec, 1
s4_l:
  s_cmp_ge_u32 s20, 7
  s_cselect_b32 s20, 0, s20
  s_lshl_b32 s21, s20, 7
  s_add_u32 s21, s21, 88586240
  v_mov_b32 v242, 1
  buffer_atomic_add v242, off, s[8:11], s21 sc0
  s_waitcnt vmcnt(0)
  v_readfirstlane_b32 s21, v242
  s_lshl_b32 s22, s20, 4
  s_add_u32 s20, s20, 1
  s_cmp_ge_u32 s21, 16
  s_cbranch_scc1 s4_l
  v_add_u32 v242, s22, v242
  s_mov_b64 exec, -1
w0_39:
  v_mov_b32 v243, 160000
  s_add_u32 s101, s101, 1
  s_barrier
  s_mov_b64 exec, 1
  s_cmp_lg_u32 s16, 0
  s_cbranch_scc1 w0_40
  ds_write_b32 v243, v242 offset:0
  s_waitcnt lgkmcnt(0)
  v_mov_b32 v242, s101
  ds_write_b32 v243, v242 offset:16
  s_waitcnt lgkmcnt(0)
w0_40:
  s_mov_b64 exec, -1
  s_barrier
  ds_read_b32 v242, v243 offset:0
  ds_read_b32 v243, v243 offset:16
  s_waitcnt lgkmcnt(0)
  v_readfirstlane_b32 s3, v242
  v_cmp_ne_u32 vcc, s101, v243
  s_cbranch_vccnz ch_end
  s_load_dwordx8 s[40:47], s[0:1], 0
  s_load_dwordx4 s[48:51], s[0:1], 32
  s_load_dwordx2 s[52:53], s[0:1], 48
  s_load_dwordx2 s[54:55], s[0:1], 112
  v_lshrrev_b32 v1, 6, v0
  s_nop 0
  v_readfirstlane_b32 s16, v1
  v_and_b32 v1, 63, v0
  v_lshrrev_b32 v3, 4, v1
  v_and_b32 v4, 15, v1
  s_mul_i32 s17, s16, 24576
  s_waitcnt lgkmcnt(0)
  s_mov_b32 s60, s40
  s_and_b32 s61, s41, 0xffff
  s_mov_b32 s62, 1835008
  s_mov_b32 s63, 0x20000
  s_mov_b32 s64, s42
  s_and_b32 s65, s43, 0xffff
  s_mov_b32 s66, 229376
  s_mov_b32 s67, 0x20000
  s_mov_b32 s68, s44
  s_and_b32 s69, s45, 0xffff
  s_mov_b32 s70, 229376
  s_mov_b32 s71, 0x20000
  s_mov_b32 s72, s46
  s_and_b32 s73, s47, 0xffff
  s_mov_b32 s74, 229376
  s_mov_b32 s75, 0x20000
  s_mov_b32 s76, s48
  s_and_b32 s77, s49, 0xffff
  s_mov_b32 s78, 229376
  s_mov_b32 s79, 0x20000
  s_mov_b32 s80, s50
  s_and_b32 s81, s51, 0xffff
  s_mov_b32 s82, 896
  s_mov_b32 s83, 0x20000
  s_mov_b32 s84, s52
  s_and_b32 s85, s53, 0xffff
  s_mov_b32 s86, 896
  s_mov_b32 s87, 0x20000
  s_mov_b32 s92, s54
  s_and_b32 s93, s55, 0xffff
  s_mov_b32 s94, 3670016
  s_mov_b32 s95, 0x20000
  v_lshlrev_b32 v5, 5, v1
  v_sub_u32 v5, 2047, v5
  s_add_u32 s18, s17, 13056
  v_subrev_u32 v6, 0, v5
  v_max_i32 v7, 0, v6
  v_cvt_f32_u32 v7, v7
  v_cvt_pk_bf16_f32 v8, v7, v7
  v_and_b32 v7, 0xffff0000, v8
  v_lshrrev_b32 v8, 23, v7
  v_subrev_u32 v8, 134, v8
  v_max_i32 v8, 0, v8
  v_cvt_u32_f32 v7, v7
  v_lshrrev_b32 v7, v8, v7
  v_lshl_add_u32 v7, v8, 8, v7
  v_lshl_add_u32 v200, v7, 2, s18
  v_subrev_u32 v6, 1, v5
  v_max_i32 v7, 0, v6
  v_cvt_f32_u32 v7, v7
  v_cvt_pk_bf16_f32 v8, v7, v7
  v_and_b32 v7, 0xffff0000, v8
  v_lshrrev_b32 v8, 23, v7
  v_subrev_u32 v8, 134, v8
  v_max_i32 v8, 0, v8
  v_cvt_u32_f32 v7, v7
  v_lshrrev_b32 v7, v8, v7
  v_lshl_add_u32 v7, v8, 8, v7
  v_lshl_add_u32 v201, v7, 2, s18
  v_subrev_u32 v6, 2, v5
  v_max_i32 v7, 0, v6
  v_cvt_f32_u32 v7, v7
  v_cvt_pk_bf16_f32 v8, v7, v7
  v_and_b32 v7, 0xffff0000, v8
  v_lshrrev_b32 v8, 23, v7
  v_subrev_u32 v8, 134, v8
  v_max_i32 v8, 0, v8
  v_cvt_u32_f32 v7, v7
  v_lshrrev_b32 v7, v8, v7
  v_lshl_add_u32 v7, v8, 8, v7
  v_lshl_add_u32 v202, v7, 2, s18
  v_subrev_u32 v6, 3, v5
  v_max_i32 v7, 0, v6
  v_cvt_f32_u32 v7, v7
  v_cvt_pk_bf16_f32 v8, v7, v7
  v_and_b32 v7, 0xffff0000, v8
  v_lshrrev_b32 v8, 23, v7
  v_subrev_u32 v8, 134, v8
  v_max_i32 v8, 0, v8
  v_cvt_u32_f32 v7, v7
  v_lshrrev_b32 v7, v8, v7
  v_lshl_add_u32 v7, v8, 8, v7
  v_lshl_add_u32 v203, v7, 2, s18
  v_subrev_u32 v6, 4, v5
  v_max_i32 v7, 0, v6
  v_cvt_f32_u32 v7, v7
  v_cvt_pk_bf16_f32 v8, v7, v7
  v_and_b32 v7, 0xffff0000, v8
  v_lshrrev_b32 v8, 23, v7
  v_subrev_u32 v8, 134, v8
  v_max_i32 v8, 0, v8
  v_cvt_u32_f32 v7, v7
  v_lshrrev_b32 v7, v8, v7
  v_lshl_add_u32 v7, v8, 8, v7
  v_lshl_add_u32 v204, v7, 2, s18
  v_subrev_u32 v6, 5, v5
  v_max_i32 v7, 0, v6
  v_cvt_f32_u32 v7, v7
  v_cvt_pk_bf16_f32 v8, v7, v7
  v_and_b32 v7, 0xffff0000, v8
  v_lshrrev_b32 v8, 23, v7
  v_subrev_u32 v8, 134, v8
  v_max_i32 v8, 0, v8
  v_cvt_u32_f32 v7, v7
  v_lshrrev_b32 v7, v8, v7
  v_lshl_add_u32 v7, v8, 8, v7
  v_lshl_add_u32 v205, v7, 2, s18
  v_subrev_u32 v6, 6, v5
  v_max_i32 v7, 0, v6
  v_cvt_f32_u32 v7, v7
  v_cvt_pk_bf16_f32 v8, v7, v7
  v_and_b32 v7, 0xffff0000, v8
  v_lshrrev_b32 v8, 23, v7
  v_subrev_u32 v8, 134, v8
  v_max_i32 v8, 0, v8
  v_cvt_u32_f32 v7, v7
  v_lshrrev_b32 v7, v8, v7
  v_lshl_add_u32 v7, v8, 8, v7
  v_lshl_add_u32 v206, v7, 2, s18
  v_subrev_u32 v6, 7, v5
  v_max_i32 v7, 0, v6
  v_cvt_f32_u32 v7, v7
  v_cvt_pk_bf16_f32 v8, v7, v7
  v_and_b32 v7, 0xffff0000, v8
  v_lshrrev_b32 v8, 23, v7
  v_subrev_u32 v8, 134, v8
  v_max_i32 v8, 0, v8
  v_cvt_u32_f32 v7, v7
  v_lshrrev_b32 v7, v8, v7
  v_lshl_add_u32 v7, v8, 8, v7
  v_lshl_add_u32 v207, v7, 2, s18
  v_subrev_u32 v6, 8, v5
  v_max_i32 v7, 0, v6
  v_cvt_f32_u32 v7, v7
  v_cvt_pk_bf16_f32 v8, v7, v7
  v_and_b32 v7, 0xffff0000, v8
  v_lshrrev_b32 v8, 23, v7
  v_subrev_u32 v8, 134, v8
  v_max_i32 v8, 0, v8
  v_cvt_u32_f32 v7, v7
  v_lshrrev_b32 v7, v8, v7
  v_lshl_add_u32 v7, v8, 8, v7
  v_lshl_add_u32 v208, v7, 2, s18
  v_subrev_u32 v6, 9, v5
  v_max_i32 v7, 0, v6
  v_cvt_f32_u32 v7, v7
  v_cvt_pk_bf16_f32 v8, v7, v7
  v_and_b32 v7, 0xffff0000, v8
  v_lshrrev_b32 v8, 23, v7
  v_subrev_u32 v8, 134, v8
  v_max_i32 v8, 0, v8
  v_cvt_u32_f32 v7, v7
  v_lshrrev_b32 v7, v8, v7
  v_lshl_add_u32 v7, v8, 8, v7
  v_lshl_add_u32 v209, v7, 2, s18
  v_subrev_u32 v6, 10, v5
  v_max_i32 v7, 0, v6
  v_cvt_f32_u32 v7, v7
  v_cvt_pk_bf16_f32 v8, v7, v7
  v_and_b32 v7, 0xffff0000, v8
  v_lshrrev_b32 v8, 23, v7
  v_subrev_u32 v8, 134, v8
  v_max_i32 v8, 0, v8
  v_cvt_u32_f32 v7, v7
  v_lshrrev_b32 v7, v8, v7
  v_lshl_add_u32 v7, v8, 8, v7
  v_lshl_add_u32 v210, v7, 2, s18
  v_subrev_u32 v6, 11, v5
  v_max_i32 v7, 0, v6
  v_cvt_f32_u32 v7, v7
  v_cvt_pk_bf16_f32 v8, v7, v7
  v_and_b32 v7, 0xffff0000, v8
  v_lshrrev_b32 v8, 23, v7
  v_subrev_u32 v8, 134, v8
  v_max_i32 v8, 0, v8
  v_cvt_u32_f32 v7, v7
  v_lshrrev_b32 v7, v8, v7
  v_lshl_add_u32 v7, v8, 8, v7
  v_lshl_add_u32 v211, v7, 2, s18
  v_subrev_u32 v6, 12, v5
  v_max_i32 v7, 0, v6
  v_cvt_f32_u32 v7, v7
  v_cvt_pk_bf16_f32 v8, v7, v7
  v_and_b32 v7, 0xffff0000, v8
  v_lshrrev_b32 v8, 23, v7
  v_subrev_u32 v8, 134, v8
  v_max_i32 v8, 0, v8
  v_cvt_u32_f32 v7, v7
  v_lshrrev_b32 v7, v8, v7
  v_lshl_add_u32 v7, v8, 8, v7
  v_lshl_add_u32 v212, v7, 2, s18
  v_subrev_u32 v6, 13, v5
  v_max_i32 v7, 0, v6
  v_cvt_f32_u32 v7, v7
  v_cvt_pk_bf16_f32 v8, v7, v7
  v_and_b32 v7, 0xffff0000, v8
  v_lshrrev_b32 v8, 23, v7
  v_subrev_u32 v8, 134, v8
  v_max_i32 v8, 0, v8
  v_cvt_u32_f32 v7, v7
  v_lshrrev_b32 v7, v8, v7
  v_lshl_add_u32 v7, v8, 8, v7
  v_lshl_add_u32 v213, v7, 2, s18
  v_subrev_u32 v6, 14, v5
  v_max_i32 v7, 0, v6
  v_cvt_f32_u32 v7, v7
  v_cvt_pk_bf16_f32 v8, v7, v7
  v_and_b32 v7, 0xffff0000, v8
  v_lshrrev_b32 v8, 23, v7
  v_subrev_u32 v8, 134, v8
  v_max_i32 v8, 0, v8
  v_cvt_u32_f32 v7, v7
  v_lshrrev_b32 v7, v8, v7
  v_lshl_add_u32 v7, v8, 8, v7
  v_lshl_add_u32 v214, v7, 2, s18
  v_subrev_u32 v6, 15, v5
  v_max_i32 v7, 0, v6
  v_cvt_f32_u32 v7, v7
  v_cvt_pk_bf16_f32 v8, v7, v7
  v_and_b32 v7, 0xffff0000, v8
  v_lshrrev_b32 v8, 23, v7
  v_subrev_u32 v8, 134, v8
  v_max_i32 v8, 0, v8
  v_cvt_u32_f32 v7, v7
  v_lshrrev_b32 v7, v8, v7
  v_lshl_add_u32 v7, v8, 8, v7
  v_lshl_add_u32 v215, v7, 2, s18
  v_subrev_u32 v6, 16, v5
  v_max_i32 v7, 0, v6
  v_cvt_f32_u32 v7, v7
  v_cvt_pk_bf16_f32 v8, v7, v7
  v_and_b32 v7, 0xffff0000, v8
  v_lshrrev_b32 v8, 23, v7
  v_subrev_u32 v8, 134, v8
  v_max_i32 v8, 0, v8
  v_cvt_u32_f32 v7, v7
  v_lshrrev_b32 v7, v8, v7
  v_lshl_add_u32 v7, v8, 8, v7
  v_lshl_add_u32 v216, v7, 2, s18
  v_subrev_u32 v6, 17, v5
  v_max_i32 v7, 0, v6
  v_cvt_f32_u32 v7, v7
  v_cvt_pk_bf16_f32 v8, v7, v7
  v_and_b32 v7, 0xffff0000, v8
  v_lshrrev_b32 v8, 23, v7
  v_subrev_u32 v8, 134, v8
  v_max_i32 v8, 0, v8
  v_cvt_u32_f32 v7, v7
  v_lshrrev_b32 v7, v8, v7
  v_lshl_add_u32 v7, v8, 8, v7
  v_lshl_add_u32 v217, v7, 2, s18
  v_subrev_u32 v6, 18, v5
  v_max_i32 v7, 0, v6
  v_cvt_f32_u32 v7, v7
  v_cvt_pk_bf16_f32 v8, v7, v7
  v_and_b32 v7, 0xffff0000, v8
  v_lshrrev_b32 v8, 23, v7
  v_subrev_u32 v8, 134, v8
  v_max_i32 v8, 0, v8
  v_cvt_u32_f32 v7, v7
  v_lshrrev_b32 v7, v8, v7
  v_lshl_add_u32 v7, v8, 8, v7
  v_lshl_add_u32 v218, v7, 2, s18
  v_subrev_u32 v6, 19, v5
  v_max_i32 v7, 0, v6
  v_cvt_f32_u32 v7, v7
  v_cvt_pk_bf16_f32 v8, v7, v7
  v_and_b32 v7, 0xffff0000, v8
  v_lshrrev_b32 v8, 23, v7
  v_subrev_u32 v8, 134, v8
  v_max_i32 v8, 0, v8
  v_cvt_u32_f32 v7, v7
  v_lshrrev_b32 v7, v8, v7
  v_lshl_add_u32 v7, v8, 8, v7
  v_lshl_add_u32 v219, v7, 2, s18
  v_subrev_u32 v6, 20, v5
  v_max_i32 v7, 0, v6
  v_cvt_f32_u32 v7, v7
  v_cvt_pk_bf16_f32 v8, v7, v7
  v_and_b32 v7, 0xffff0000, v8
  v_lshrrev_b32 v8, 23, v7
  v_subrev_u32 v8, 134, v8
  v_max_i32 v8, 0, v8
  v_cvt_u32_f32 v7, v7
  v_lshrrev_b32 v7, v8, v7
  v_lshl_add_u32 v7, v8, 8, v7
  v_lshl_add_u32 v220, v7, 2, s18
  v_subrev_u32 v6, 21, v5
  v_max_i32 v7, 0, v6
  v_cvt_f32_u32 v7, v7
  v_cvt_pk_bf16_f32 v8, v7, v7
  v_and_b32 v7, 0xffff0000, v8
  v_lshrrev_b32 v8, 23, v7
  v_subrev_u32 v8, 134, v8
  v_max_i32 v8, 0, v8
  v_cvt_u32_f32 v7, v7
  v_lshrrev_b32 v7, v8, v7
  v_lshl_add_u32 v7, v8, 8, v7
  v_lshl_add_u32 v221, v7, 2, s18
  v_subrev_u32 v6, 22, v5
  v_max_i32 v7, 0, v6
  v_cvt_f32_u32 v7, v7
  v_cvt_pk_bf16_f32 v8, v7, v7
  v_and_b32 v7, 0xffff0000, v8
  v_lshrrev_b32 v8, 23, v7
  v_subrev_u32 v8, 134, v8
  v_max_i32 v8, 0, v8
  v_cvt_u32_f32 v7, v7
  v_lshrrev_b32 v7, v8, v7
  v_lshl_add_u32 v7, v8, 8, v7
  v_lshl_add_u32 v222, v7, 2, s18
  v_subrev_u32 v6, 23, v5
  v_max_i32 v7, 0, v6
  v_cvt_f32_u32 v7, v7
  v_cvt_pk_bf16_f32 v8, v7, v7
  v_and_b32 v7, 0xffff0000, v8
  v_lshrrev_b32 v8, 23, v7
  v_subrev_u32 v8, 134, v8
  v_max_i32 v8, 0, v8
  v_cvt_u32_f32 v7, v7
  v_lshrrev_b32 v7, v8, v7
  v_lshl_add_u32 v7, v8, 8, v7
  v_lshl_add_u32 v223, v7, 2, s18
  v_subrev_u32 v6, 24, v5
  v_max_i32 v7, 0, v6
  v_cvt_f32_u32 v7, v7
  v_cvt_pk_bf16_f32 v8, v7, v7
  v_and_b32 v7, 0xffff0000, v8
  v_lshrrev_b32 v8, 23, v7
  v_subrev_u32 v8, 134, v8
  v_max_i32 v8, 0, v8
  v_cvt_u32_f32 v7, v7
  v_lshrrev_b32 v7, v8, v7
  v_lshl_add_u32 v7, v8, 8, v7
  v_lshl_add_u32 v224, v7, 2, s18
  v_subrev_u32 v6, 25, v5
  v_max_i32 v7, 0, v6
  v_cvt_f32_u32 v7, v7
  v_cvt_pk_bf16_f32 v8, v7, v7
  v_and_b32 v7, 0xffff0000, v8
  v_lshrrev_b32 v8, 23, v7
  v_subrev_u32 v8, 134, v8
  v_max_i32 v8, 0, v8
  v_cvt_u32_f32 v7, v7
  v_lshrrev_b32 v7, v8, v7
  v_lshl_add_u32 v7, v8, 8, v7
  v_lshl_add_u32 v225, v7, 2, s18
  v_subrev_u32 v6, 26, v5
  v_max_i32 v7, 0, v6
  v_cvt_f32_u32 v7, v7
  v_cvt_pk_bf16_f32 v8, v7, v7
  v_and_b32 v7, 0xffff0000, v8
  v_lshrrev_b32 v8, 23, v7
  v_subrev_u32 v8, 134, v8
  v_max_i32 v8, 0, v8
  v_cvt_u32_f32 v7, v7
  v_lshrrev_b32 v7, v8, v7
  v_lshl_add_u32 v7, v8, 8, v7
  v_lshl_add_u32 v226, v7, 2, s18
  v_subrev_u32 v6, 27, v5
  v_max_i32 v7, 0, v6
  v_cvt_f32_u32 v7, v7
  v_cvt_pk_bf16_f32 v8, v7, v7
  v_and_b32 v7, 0xffff0000, v8
  v_lshrrev_b32 v8, 23, v7
  v_subrev_u32 v8, 134, v8
  v_max_i32 v8, 0, v8
  v_cvt_u32_f32 v7, v7
  v_lshrrev_b32 v7, v8, v7
  v_lshl_add_u32 v7, v8, 8, v7
  v_lshl_add_u32 v227, v7, 2, s18
  v_subrev_u32 v6, 28, v5
  v_max_i32 v7, 0, v6
  v_cvt_f32_u32 v7, v7
  v_cvt_pk_bf16_f32 v8, v7, v7
  v_and_b32 v7, 0xffff0000, v8
  v_lshrrev_b32 v8, 23, v7
  v_subrev_u32 v8, 134, v8
  v_max_i32 v8, 0, v8
  v_cvt_u32_f32 v7, v7
  v_lshrrev_b32 v7, v8, v7
  v_lshl_add_u32 v7, v8, 8, v7
  v_lshl_add_u32 v228, v7, 2, s18
  v_subrev_u32 v6, 29, v5
  v_max_i32 v7, 0, v6
  v_cvt_f32_u32 v7, v7
  v_cvt_pk_bf16_f32 v8, v7, v7
  v_and_b32 v7, 0xffff0000, v8
  v_lshrrev_b32 v8, 23, v7
  v_subrev_u32 v8, 134, v8
  v_max_i32 v8, 0, v8
  v_cvt_u32_f32 v7, v7
  v_lshrrev_b32 v7, v8, v7
  v_lshl_add_u32 v7, v8, 8, v7
  v_lshl_add_u32 v229, v7, 2, s18
  v_subrev_u32 v6, 30, v5
  v_max_i32 v7, 0, v6
  v_cvt_f32_u32 v7, v7
  v_cvt_pk_bf16_f32 v8, v7, v7
  v_and_b32 v7, 0xffff0000, v8
  v_lshrrev_b32 v8, 23, v7
  v_subrev_u32 v8, 134, v8
  v_max_i32 v8, 0, v8
  v_cvt_u32_f32 v7, v7
  v_lshrrev_b32 v7, v8, v7
  v_lshl_add_u32 v7, v8, 8, v7
  v_lshl_add_u32 v230, v7, 2, s18
  v_subrev_u32 v6, 31, v5
  v_max_i32 v7, 0, v6
  v_cvt_f32_u32 v7, v7
  v_cvt_pk_bf16_f32 v8, v7, v7
  v_and_b32 v7, 0xffff0000, v8
  v_lshrrev_b32 v8, 23, v7
  v_subrev_u32 v8, 134, v8
  v_max_i32 v8, 0, v8
  v_cvt_u32_f32 v7, v7
  v_lshrrev_b32 v7, v8, v7
  v_lshl_add_u32 v7, v8, 8, v7
  v_lshl_add_u32 v231, v7, 2, s18
  v_subrev_u32 v6, 32, v5
  v_max_i32 v7, 0, v6
  v_cvt_f32_u32 v7, v7
  v_cvt_pk_bf16_f32 v8, v7, v7
  v_and_b32 v7, 0xffff0000, v8
  v_lshrrev_b32 v8, 23, v7
  v_subrev_u32 v8, 134, v8
  v_max_i32 v8, 0, v8
  v_cvt_u32_f32 v7, v7
  v_lshrrev_b32 v7, v8, v7
  v_lshl_add_u32 v7, v8, 8, v7
  v_mov_b32 v8, 1280
  v_cmp_gt_i32 vcc, 0, v6
  s_nop 1
  v_cndmask_b32 v7, v7, v8, vcc
  v_lshl_add_u32 v232, v7, 2, s18
  v_mov_b32 v8, 0
  v_mov_b32 v9, 0
  v_lshlrev_b32 v5, 3, v1
  v_add_u32 v5, s17, v5
  ds_write_b64 v5, v[8:9]
  v_and_b32 v6, 15, v1
  v_lshlrev_b32 v6, 3, v6
  v_add_u32 v6, s17, v6
  ds_write_b64 v6, v[8:9] offset:8704
  ds_write_b64 v6, v[8:9] offset:12928
  v_mov_b32 v6, s17
  ds_write_b64 v6, v[8:9] offset:18176
  s_lshl_b32 s19, s3, 2
  s_add_u32 s20, s19, s16
  s_lshl_b32 s21, s3, 3
  v_mul_u32_u24 v5, 3584, v0
  v_mul_u32_u24 v141, 1792, v0
  s_lshl_b32 s22, s20, 9
  v_lshlrev_b32 v6, 3, v1
  buffer_load_dwordx2 v[24:25], v6, s[64:67], s22 offen
  buffer_load_dwordx2 v[26:27], v6, s[68:71], s22 offen
  buffer_load_dwordx2 v[28:29], v6, s[72:75], s22 offen
  buffer_load_dwordx2 v[30:31], v6, s[76:79], s22 offen
  s_lshl_b32 s22, s20, 1
  v_mov_b32 v7, 0
  buffer_load_ushort v32, v7, s[80:83], s22 offen
  buffer_load_ushort v33, v7, s[84:87], s22 offen
  s_mov_b32 s24, 0x05040100
  s_mov_b32 s25, 0x07060302
  s_barrier
  s_waitcnt vmcnt(0)
  s_mov_b32 s26, 1069066811
  s_mov_b32 s27, 1042479491
  v_lshlrev_b32 v32, 16, v32
  v_lshlrev_b32 v33, 16, v33
  v_mul_f32 v32, s26, v32
  v_exp_f32 v32, v32
  s_nop 0
  v_cvt_pk_bf16_f32 v34, v32, v32
  v_and_b32 v32, 0xffff0000, v34
  v_lshlrev_b32 v37, 6, v1
  v_add_u32 v37, s17, v37
  v_lshlrev_b32 v40, 16, v24
  v_lshlrev_b32 v41, 16, v26
  v_lshlrev_b32 v42, 16, v28
  v_lshlrev_b32 v43, 16, v30
  v_mul_f32 v40, s26, v40
  v_exp_f32 v40, v40
  s_nop 0
  v_cvt_pk_bf16_f32 v34, v40, v40
  v_and_b32 v40, 0xffff0000, v34
  v_mul_f32 v40, v40, v32
  v_mul_f32 v40, s26, v40
  v_sub_f32 v40, 0, v40
  v_mul_f32 v41, v41, v32
  v_mul_f32 v41, s27, v41
  v_mul_f32 v42, v42, v32
  v_mul_f32 v43, v43, v32
  v_add_f32 v42, v42, v42
  v_add_f32 v43, v43, v43
  ds_write_b128 v37, v[40:43] offset:18240
  v_and_b32 v40, 0xffff0000, v24
  v_and_b32 v41, 0xffff0000, v26
  v_and_b32 v42, 0xffff0000, v28
  v_and_b32 v43, 0xffff0000, v30
  v_mul_f32 v40, s26, v40
  v_exp_f32 v40, v40
  s_nop 0
  v_cvt_pk_bf16_f32 v34, v40, v40
  v_and_b32 v40, 0xffff0000, v34
  v_mul_f32 v40, v40, v32
  v_mul_f32 v40, s26, v40
  v_sub_f32 v40, 0, v40
  v_mul_f32 v41, v41, v32
  v_mul_f32 v41, s27, v41
  v_mul_f32 v42, v42, v32
  v_mul_f32 v43, v43, v32
  v_add_f32 v42, v42, v42
  v_add_f32 v43, v43, v43
  ds_write_b128 v37, v[40:43] offset:18256
  v_lshlrev_b32 v40, 16, v25
  v_lshlrev_b32 v41, 16, v27
  v_lshlrev_b32 v42, 16, v29
  v_lshlrev_b32 v43, 16, v31
  v_mul_f32 v40, s26, v40
  v_exp_f32 v40, v40
  s_nop 0
  v_cvt_pk_bf16_f32 v34, v40, v40
  v_and_b32 v40, 0xffff0000, v34
  v_mul_f32 v40, v40, v32
  v_mul_f32 v40, s26, v40
  v_sub_f32 v40, 0, v40
  v_mul_f32 v41, v41, v32
  v_mul_f32 v41, s27, v41
  v_mul_f32 v42, v42, v32
  v_mul_f32 v43, v43, v32
  v_add_f32 v42, v42, v42
  v_add_f32 v43, v43, v43
  ds_write_b128 v37, v[40:43] offset:18272
  v_and_b32 v40, 0xffff0000, v25
  v_and_b32 v41, 0xffff0000, v27
  v_and_b32 v42, 0xffff0000, v29
  v_and_b32 v43, 0xffff0000, v31
  v_mul_f32 v40, s26, v40
  v_exp_f32 v40, v40
  s_nop 0
  v_cvt_pk_bf16_f32 v34, v40, v40
  v_and_b32 v40, 0xffff0000, v34
  v_mul_f32 v40, v40, v32
  v_mul_f32 v40, s26, v40
  v_sub_f32 v40, 0, v40
  v_mul_f32 v41, v41, v32
  v_mul_f32 v41, s27, v41
  v_mul_f32 v42, v42, v32
  v_mul_f32 v43, v43, v32
  v_add_f32 v42, v42, v42
  v_add_f32 v43, v43, v43
  ds_write_b128 v37, v[40:43] offset:18288
  v_cvt_f32_u32 v44, v4
  v_lshlrev_b32 v45, 4, v4
  v_cvt_f32_u32 v45, v45
  v_lshlrev_b32 v46, 4, v3
  v_add_u32 v46, s17, v46
  v_mov_b32 v48, 0
  v_mov_b32 v49, 0
  v_mov_b32 v50, 0
  v_mov_b32 v51, 0
  v_mov_b32 v52, 0
  v_mov_b32 v53, 0
  v_mov_b32 v54, 0
  v_mov_b32 v55, 0
  v_mov_b32 v56, 0
  v_mov_b32 v57, 0
  v_mov_b32 v58, 0
  v_mov_b32 v59, 0
  v_mov_b32 v60, 0
  v_mov_b32 v61, 0
  v_mov_b32 v62, 0
  v_mov_b32 v63, 0
  v_mov_b32 v64, 0
  v_mov_b32 v65, 0
  v_mov_b32 v66, 0
  v_mov_b32 v67, 0
  s_waitcnt lgkmcnt(0)
  ds_read_b128 v[68:71], v46 offset:18240
  s_add_u32 s22, s21, 0
  buffer_load_dwordx2 v[8:9], v5, s[60:63], s22 offen offset:0
  s_mov_b32 s28, 0
  s_call_b64 s[30:31], wk_kl
  s_mov_b32 s28, 0
  s_call_b64 s[30:31], wk_kl
  s_add_u32 s22, s21, 0
  buffer_load_dwordx2 v[10:11], v5, s[60:63], s22 offen offset:896
  s_mov_b32 s28, 0
  s_call_b64 s[30:31], wk_kl
  s_mov_b32 s28, 0
  s_call_b64 s[30:31], wk_kl
  s_add_u32 s22, s21, 0
  buffer_load_dwordx2 v[12:13], v5, s[60:63], s22 offen offset:1792
  s_mov_b32 s28, 0
  s_call_b64 s[30:31], wk_kl
  s_mov_b32 s28, 0
  s_call_b64 s[30:31], wk_kl
  s_add_u32 s22, s21, 0
  buffer_load_dwordx2 v[14:15], v5, s[60:63], s22 offen offset:2688
  s_mov_b32 s28, 0
  s_call_b64 s[30:31], wk_kl
  s_mov_b32 s28, 0
  s_call_b64 s[30:31], wk_kl
  s_add_u32 s22, s21, 917504
  buffer_load_dwordx2 v[16:17], v5, s[60:63], s22 offen offset:0
  s_mov_b32 s28, 0
  s_call_b64 s[30:31], wk_kl
  s_mov_b32 s28, 0
  s_call_b64 s[30:31], wk_kl
  s_add_u32 s22, s21, 917504
  buffer_load_dwordx2 v[18:19], v5, s[60:63], s22 offen offset:896
  s_mov_b32 s28, 0
  s_call_b64 s[30:31], wk_kl
  s_mov_b32 s28, 0
  s_call_b64 s[30:31], wk_kl
  s_add_u32 s22, s21, 917504
  buffer_load_dwordx2 v[20:21], v5, s[60:63], s22 offen offset:1792
  s_mov_b32 s28, 0
  s_call_b64 s[30:31], wk_kl
  s_mov_b32 s28, 0
  s_call_b64 s[30:31], wk_kl
  s_add_u32 s22, s21, 917504
  buffer_load_dwordx2 v[22:23], v5, s[60:63], s22 offen offset:2688
  s_mov_b32 s28, 0
  s_call_b64 s[30:31], wk_kl
  s_mov_b32 s28, 0
  s_call_b64 s[30:31], wk_kl
  s_branch wk_kd
wk_kl:
  s_waitcnt lgkmcnt(0)
  v_mov_b32 v72, v68
  v_mov_b32 v73, v69
  v_mov_b32 v74, v70
  v_mov_b32 v75, v71
  v_add_u32 v46, 64, v46
  ds_read_b128 v[68:71], v46 offset:18240
  v_mul_f32 v80, v72, v45
  v_mul_f32 v81, v73, v45
  v_exp_f32 v80, v80
  v_fract_f32 v81, v81
  v_cos_f32 v76, v81
  v_sin_f32 v77, v81
  v_mul_f32 v76, v76, v80
  v_mul_f32 v77, v77, v80
  v_mul_f32 v80, v72, v44
  v_mul_f32 v81, v73, v44
  v_exp_f32 v80, v80
  v_fract_f32 v81, v81
  v_cos_f32 v78, v81
  v_sin_f32 v79, v81
  v_mul_f32 v78, v78, v80
  v_mul_f32 v79, v79, v80
  v_mul_f32 v82, v74, v76
  v_mul_f32 v83, v74, v77
  v_fma_f32 v82, -v75, v77, v82
  v_fma_f32 v83, -v75, v76, -v83
  v_mul_f32 v86, v76, v76
  v_mul_f32 v87, v76, v77
  v_fma_f32 v86, -v77, v77, v86
  v_add_f32 v87, v87, v87
  v_mfma_f32_16x16x4_f32 v[48:51], v82, v78, v[48:51]
  v_mul_f32 v88, v78, v78
  v_mul_f32 v89, v78, v79
  v_fma_f32 v88, -v79, v79, v88
  v_add_f32 v89, v89, v89
  v_mfma_f32_16x16x4_f32 v[48:51], v83, v79, v[48:51]
  v_mul_f32 v84, v74, v86
  v_mul_f32 v85, v74, v87
  v_fma_f32 v84, -v75, v87, v84
  v_fma_f32 v85, -v75, v86, -v85
  v_mul_f32 v76, v86, v86
  v_mul_f32 v77, v86, v87
  v_fma_f32 v76, -v87, v87, v76
  v_add_f32 v77, v77, v77
  v_mfma_f32_16x16x4_f32 v[52:55], v84, v88, v[52:55]
  v_mul_f32 v78, v88, v88
  v_mul_f32 v79, v88, v89
  v_fma_f32 v78, -v89, v89, v78
  v_add_f32 v79, v79, v79
  v_mfma_f32_16x16x4_f32 v[52:55], v85, v89, v[52:55]
  v_mul_f32 v82, v74, v76
  v_mul_f32 v83, v74, v77
  v_fma_f32 v82, -v75, v77, v82
  v_fma_f32 v83, -v75, v76, -v83
  v_mul_f32 v86, v76, v76
  v_mul_f32 v87, v76, v77
  v_fma_f32 v86, -v77, v77, v86
  v_add_f32 v87, v87, v87
  v_mfma_f32_16x16x4_f32 v[56:59], v82, v78, v[56:59]
  v_mul_f32 v88, v78, v78
  v_mul_f32 v89, v78, v79
  v_fma_f32 v88, -v79, v79, v88
  v_add_f32 v89, v89, v89
  v_mfma_f32_16x16x4_f32 v[56:59], v83, v79, v[56:59]
  v_mul_f32 v84, v74, v86
  v_mul_f32 v85, v74, v87
  v_fma_f32 v84, -v75, v87, v84
  v_fma_f32 v85, -v75, v86, -v85
  v_mul_f32 v76, v86, v86
  v_mul_f32 v77, v86, v87
  v_fma_f32 v76, -v87, v87, v76
  v_add_f32 v77, v77, v77
  v_mfma_f32_16x16x4_f32 v[60:63], v84, v88, v[60:63]
  v_mfma_f32_16x16x4_f32 v[60:63], v85, v89, v[60:63]
  v_mul_f32 v82, v74, v76
  v_fma_f32 v82, -v75, v77, v82
  s_nop 1
  v_mfma_f32_16x16x4_f32 v[64:67], v82, v88, v[64:67]
  s_add_u32 s28, s28, 1
  s_cmp_lt_u32 s28, 4
  s_cbranch_scc1 wk_kl
  s_setpc_b64 s[30:31]
wk_kd:
  s_nop 15
  s_nop 3
  s_waitcnt vmcnt(0)
  v_lshlrev_b32 v6, 3, v0
  v_perm_b32 v34, v10, v8, s24
  v_perm_b32 v35, v14, v12, s24
  v_add_u32 v36, 512, v6
  ds_write_b64 v36, v[34:35]
  v_perm_b32 v34, v10, v8, s25
  v_perm_b32 v35, v14, v12, s25
  v_add_u32 v36, 25088, v6
  ds_write_b64 v36, v[34:35]
  v_perm_b32 v34, v11, v9, s24
  v_perm_b32 v35, v15, v13, s24
  v_add_u32 v36, 49664, v6
  ds_write_b64 v36, v[34:35]
  v_perm_b32 v34, v11, v9, s25
  v_perm_b32 v35, v15, v13, s25
  v_add_u32 v36, 74240, v6
  ds_write_b64 v36, v[34:35]
  v_perm_b32 v34, v18, v16, s24
  v_perm_b32 v35, v22, v20, s24
  v_add_u32 v36, 2560, v6
  ds_write_b64 v36, v[34:35]
  v_perm_b32 v34, v18, v16, s25
  v_perm_b32 v35, v22, v20, s25
  v_add_u32 v36, 27136, v6
  ds_write_b64 v36, v[34:35]
  v_perm_b32 v34, v19, v17, s24
  v_perm_b32 v35, v23, v21, s24
  v_add_u32 v36, 51712, v6
  ds_write_b64 v36, v[34:35]
  v_perm_b32 v34, v19, v17, s25
  v_perm_b32 v35, v23, v21, s25
  v_add_u32 v36, 76288, v6
  ds_write_b64 v36, v[34:35]
  v_lshlrev_b32 v46, 8, v3
  v_lshl_add_u32 v46, v4, 2, v46
  v_add_u32 v46, s17, v46
  ds_write_b32 v46, v48 offset:13056
  ds_write_b32 v46, v49 offset:13120
  ds_write_b32 v46, v50 offset:13184
  ds_write_b32 v46, v51 offset:13248
  s_waitcnt lgkmcnt(8)
  ds_write_b32 v46, v52 offset:14080
  ds_write_b32 v46, v53 offset:14144
  ds_write_b32 v46, v54 offset:14208
  ds_write_b32 v46, v55 offset:14272
  s_waitcnt lgkmcnt(8)
  ds_write_b32 v46, v56 offset:15104
  ds_write_b32 v46, v57 offset:15168
  ds_write_b32 v46, v58 offset:15232
  ds_write_b32 v46, v59 offset:15296
  s_waitcnt lgkmcnt(8)
  ds_write_b32 v46, v60 offset:16128
  ds_write_b32 v46, v61 offset:16192
  ds_write_b32 v46, v62 offset:16256
  ds_write_b32 v46, v63 offset:16320
  s_waitcnt lgkmcnt(8)
  ds_write_b32 v46, v64 offset:17152
  ds_write_b32 v46, v65 offset:17216
  ds_write_b32 v46, v66 offset:17280
  ds_write_b32 v46, v67 offset:17344
  s_waitcnt lgkmcnt(8)
  s_waitcnt lgkmcnt(0)
  ds_read_b32 v48, v200
  ds_read_b32 v49, v201
  ds_read_b32 v50, v202
  ds_read_b32 v51, v203
  ds_read_b32 v52, v204
  ds_read_b32 v53, v205
  ds_read_b32 v54, v206
  ds_read_b32 v55, v207
  s_waitcnt lgkmcnt(4)
  ds_read_b32 v56, v208
  ds_read_b32 v57, v209
  ds_read_b32 v58, v210
  ds_read_b32 v59, v211
  ds_read_b32 v60, v212
  ds_read_b32 v61, v213
  ds_read_b32 v62, v214
  ds_read_b32 v63, v215
  s_waitcnt lgkmcnt(4)
  ds_read_b32 v64, v216
  ds_read_b32 v65, v217
  ds_read_b32 v66, v218
  ds_read_b32 v67, v219
  ds_read_b32 v68, v220
  ds_read_b32 v69, v221
  ds_read_b32 v70, v222
  ds_read_b32 v71, v223
  s_waitcnt lgkmcnt(4)
  ds_read_b32 v72, v224
  ds_read_b32 v73, v225
  ds_read_b32 v74, v226
  ds_read_b32 v75, v227
  ds_read_b32 v76, v228
  ds_read_b32 v77, v229
  ds_read_b32 v78, v230
  ds_read_b32 v79, v231
  s_waitcnt lgkmcnt(4)
  ds_read_b32 v80, v232
  s_waitcnt lgkmcnt(0)
  v_lshlrev_b32 v46, 6, v1
  v_add_u32 v46, s17, v46
  v_cvt_pk_bf16_f32 v84, v48, v49
  v_cvt_pk_bf16_f32 v88, v49, v50
  v_cvt_pk_bf16_f32 v85, v50, v51
  v_cvt_pk_bf16_f32 v89, v51, v52
  v_cvt_pk_bf16_f32 v86, v52, v53
  v_cvt_pk_bf16_f32 v90, v53, v54
  v_cvt_pk_bf16_f32 v87, v54, v55
  v_cvt_pk_bf16_f32 v91, v55, v56
  ds_write_b128 v46, v[84:87] offset:4608
  ds_write_b128 v46, v[88:91] offset:8832
  s_waitcnt lgkmcnt(0)
  v_cvt_pk_bf16_f32 v84, v56, v57
  v_cvt_pk_bf16_f32 v88, v57, v58
  v_cvt_pk_bf16_f32 v85, v58, v59
  v_cvt_pk_bf16_f32 v89, v59, v60
  v_cvt_pk_bf16_f32 v86, v60, v61
  v_cvt_pk_bf16_f32 v90, v61, v62
  v_cvt_pk_bf16_f32 v87, v62, v63
  v_cvt_pk_bf16_f32 v91, v63, v64
  ds_write_b128 v46, v[84:87] offset:4624
  ds_write_b128 v46, v[88:91] offset:8848
  s_waitcnt lgkmcnt(0)
  v_cvt_pk_bf16_f32 v84, v64, v65
  v_cvt_pk_bf16_f32 v88, v65, v66
  v_cvt_pk_bf16_f32 v85, v66, v67
  v_cvt_pk_bf16_f32 v89, v67, v68
  v_cvt_pk_bf16_f32 v86, v68, v69
  v_cvt_pk_bf16_f32 v90, v69, v70
  v_cvt_pk_bf16_f32 v87, v70, v71
  v_cvt_pk_bf16_f32 v91, v71, v72
  ds_write_b128 v46, v[84:87] offset:4640
  ds_write_b128 v46, v[88:91] offset:8864
  s_waitcnt lgkmcnt(0)
  v_cvt_pk_bf16_f32 v84, v72, v73
  v_cvt_pk_bf16_f32 v88, v73, v74
  v_cvt_pk_bf16_f32 v85, v74, v75
  v_cvt_pk_bf16_f32 v89, v75, v76
  v_cvt_pk_bf16_f32 v86, v76, v77
  v_cvt_pk_bf16_f32 v90, v77, v78
  v_cvt_pk_bf16_f32 v87, v78, v79
  v_cvt_pk_bf16_f32 v91, v79, v80
  ds_write_b128 v46, v[84:87] offset:4656
  ds_write_b128 v46, v[88:91] offset:8880
  s_waitcnt lgkmcnt(0)
  s_barrier
  v_lshrrev_b32 v47, 1, v3
  v_sub_u32 v46, v4, v47
  v_add_u32 v46, 1, v46
  v_lshlrev_b32 v46, 5, v46
  v_and_b32 v48, 1, v3
  v_lshl_add_u32 v46, v48, 4, v46
  v_add_u32 v46, s17, v46
  ds_read_b128 a[0:3], v46 offset:32
  ds_read_b128 a[4:7], v46 offset:96
  ds_read_b128 a[8:11], v46 offset:160
  ds_read_b128 a[12:15], v46 offset:224
  ds_read_b128 a[16:19], v46 offset:288
  ds_read_b128 a[20:23], v46 offset:352
  ds_read_b128 a[24:27], v46 offset:416
  ds_read_b128 a[28:31], v46 offset:480
  s_waitcnt lgkmcnt(4)
  ds_read_b128 a[32:35], v46 offset:544
  ds_read_b128 a[36:39], v46 offset:608
  ds_read_b128 a[40:43], v46 offset:672
  ds_read_b128 a[44:47], v46 offset:736
  ds_read_b128 a[48:51], v46 offset:800
  ds_read_b128 a[52:55], v46 offset:864
  ds_read_b128 a[56:59], v46 offset:928
  ds_read_b128 a[60:63], v46 offset:992
  s_waitcnt lgkmcnt(4)
  ds_read_b128 a[64:67], v46 offset:1056
  ds_read_b128 a[68:71], v46 offset:1120
  ds_read_b128 a[72:75], v46 offset:1184
  ds_read_b128 a[76:79], v46 offset:1248
  ds_read_b128 a[80:83], v46 offset:1312
  ds_read_b128 a[84:87], v46 offset:1376
  ds_read_b128 a[88:91], v46 offset:1440
  ds_read_b128 a[92:95], v46 offset:1504
  s_waitcnt lgkmcnt(4)
  ds_read_b128 a[96:99], v46 offset:1568
  ds_read_b128 a[100:103], v46 offset:1632
  ds_read_b128 a[104:107], v46 offset:1696
  ds_read_b128 a[108:111], v46 offset:1760
  ds_read_b128 a[112:115], v46 offset:1824
  ds_read_b128 a[116:119], v46 offset:1888
  ds_read_b128 a[120:123], v46 offset:1952
  ds_read_b128 a[124:127], v46 offset:2016
  s_waitcnt lgkmcnt(4)
  ds_read_b128 a[128:131], v46 offset:2080
  ds_read_b128 a[132:135], v46 offset:2144
  ds_read_b128 a[136:139], v46 offset:2208
  ds_read_b128 a[140:143], v46 offset:2272
  ds_read_b128 a[144:147], v46 offset:2336
  ds_read_b128 a[148:151], v46 offset:2400
  ds_read_b128 a[152:155], v46 offset:2464
  ds_read_b128 a[156:159], v46 offset:2528
  s_waitcnt lgkmcnt(4)
  ds_read_b128 a[160:163], v46 offset:2592
  ds_read_b128 a[164:167], v46 offset:2656
  ds_read_b128 a[168:171], v46 offset:2720
  ds_read_b128 a[172:175], v46 offset:2784
  ds_read_b128 a[176:179], v46 offset:2848
  ds_read_b128 a[180:183], v46 offset:2912
  ds_read_b128 a[184:187], v46 offset:2976
  ds_read_b128 a[188:191], v46 offset:3040
  s_waitcnt lgkmcnt(4)
  ds_read_b128 a[192:195], v46 offset:3104
  ds_read_b128 a[196:199], v46 offset:3168
  ds_read_b128 a[200:203], v46 offset:3232
  ds_read_b128 a[204:207], v46 offset:3296
  ds_read_b128 a[208:211], v46 offset:3360
  ds_read_b128 a[212:215], v46 offset:3424
  ds_read_b128 a[216:219], v46 offset:3488
  ds_read_b128 a[220:223], v46 offset:3552
  s_waitcnt lgkmcnt(4)
  ds_read_b128 a[224:227], v46 offset:3616
  ds_read_b128 a[228:231], v46 offset:3680
  ds_read_b128 a[232:235], v46 offset:3744
  ds_read_b128 a[236:239], v46 offset:3808
  ds_read_b128 a[240:243], v46 offset:3872
  ds_read_b128 a[244:247], v46 offset:3936
  ds_read_b128 a[248:251], v46 offset:4000
  ds_read_b128 a[252:255], v46 offset:4064
  s_waitcnt lgkmcnt(4)
  v_lshlrev_b32 v49, 4, v47
  v_add_u32 v49, v49, v4
  v_sub_u32 v49, 2047, v49
  v_lshl_add_u32 v49, v48, 3, v49
  v_and_b32 v50, 1, v49
  v_lshrrev_b32 v49, 1, v49
  v_lshlrev_b32 v49, 2, v49
  v_mul_u32_u24 v50, 4224, v50
  v_add3_u32 v49, v49, v50, s17
  v_add_u32 v49, 4608, v49
  v_subrev_u32 v52, 896, v49
  v_subrev_u32 v53, 1856, v49
  v_subrev_u32 v54, 2816, v49
  v_subrev_u32 v55, 3776, v49
  v_subrev_u32 v56, 4736, v49
  s_waitcnt lgkmcnt(0)
  ds_read2_b32 v[92:93], v52 offset0:224 offset1:225
  ds_read2_b32 v[94:95], v52 offset0:226 offset1:227
  ds_read2_b32 v[96:97], v52 offset0:208 offset1:209
  ds_read2_b32 v[98:99], v52 offset0:210 offset1:211
  ds_read2_b32 v[100:101], v52 offset0:192 offset1:193
  ds_read2_b32 v[102:103], v52 offset0:194 offset1:195
  ds_read2_b32 v[104:105], v52 offset0:176 offset1:177
  ds_read2_b32 v[106:107], v52 offset0:178 offset1:179
  s_waitcnt lgkmcnt(6)
  v_mfma_f32_16x16x32_bf16 v[60:63], v[92:95], a[28:31], 0
  v_mfma_f32_16x16x32_bf16 v[64:67], v[92:95], a[60:63], 0
  v_mfma_f32_16x16x32_bf16 v[68:71], v[92:95], a[92:95], 0
  v_mfma_f32_16x16x32_bf16 v[72:75], v[92:95], a[124:127], 0
  v_mfma_f32_16x16x32_bf16 v[76:79], v[92:95], a[156:159], 0
  v_mfma_f32_16x16x32_bf16 v[80:83], v[92:95], a[188:191], 0
  v_mfma_f32_16x16x32_bf16 v[84:87], v[92:95], a[220:223], 0
  v_mfma_f32_16x16x32_bf16 v[88:91], v[92:95], a[252:255], 0
  ds_read2_b32 v[92:93], v52 offset0:160 offset1:161
  ds_read2_b32 v[94:95], v52 offset0:162 offset1:163
  s_waitcnt lgkmcnt(6)
  v_mfma_f32_16x16x32_bf16 v[60:63], v[96:99], a[24:27], v[60:63]
  v_mfma_f32_16x16x32_bf16 v[64:67], v[96:99], a[56:59], v[64:67]
  v_mfma_f32_16x16x32_bf16 v[68:71], v[96:99], a[88:91], v[68:71]
  v_mfma_f32_16x16x32_bf16 v[72:75], v[96:99], a[120:123], v[72:75]
  v_mfma_f32_16x16x32_bf16 v[76:79], v[96:99], a[152:155], v[76:79]
  v_mfma_f32_16x16x32_bf16 v[80:83], v[96:99], a[184:187], v[80:83]
  v_mfma_f32_16x16x32_bf16 v[84:87], v[96:99], a[216:219], v[84:87]
  v_mfma_f32_16x16x32_bf16 v[88:91], v[96:99], a[248:251], v[88:91]
  ds_read2_b32 v[96:97], v52 offset0:144 offset1:145
  ds_read2_b32 v[98:99], v52 offset0:146 offset1:147
  s_waitcnt lgkmcnt(6)
  v_mfma_f32_16x16x32_bf16 v[60:63], v[100:103], a[20:23], v[60:63]
  v_mfma_f32_16x16x32_bf16 v[64:67], v[100:103], a[52:55], v[64:67]
  v_mfma_f32_16x16x32_bf16 v[68:71], v[100:103], a[84:87], v[68:71]
  v_mfma_f32_16x16x32_bf16 v[72:75], v[100:103], a[116:119], v[72:75]
  v_mfma_f32_16x16x32_bf16 v[76:79], v[100:103], a[148:151], v[76:79]
  v_mfma_f32_16x16x32_bf16 v[80:83], v[100:103], a[180:183], v[80:83]
  v_mfma_f32_16x16x32_bf16 v[84:87], v[100:103], a[212:215], v[84:87]
  v_mfma_f32_16x16x32_bf16 v[88:91], v[100:103], a[244:247], v[88:91]
  ds_read2_b32 v[100:101], v52 offset0:128 offset1:129
  ds_read2_b32 v[102:103], v52 offset0:130 offset1:131
  s_waitcnt lgkmcnt(6)
  v_mfma_f32_16x16x32_bf16 v[60:63], v[104:107], a[16:19], v[60:63]
  v_mfma_f32_16x16x32_bf16 v[64:67], v[104:107], a[48:51], v[64:67]
  v_mfma_f32_16x16x32_bf16 v[68:71], v[104:107], a[80:83], v[68:71]
  v_mfma_f32_16x16x32_bf16 v[72:75], v[104:107], a[112:115], v[72:75]
  v_mfma_f32_16x16x32_bf16 v[76:79], v[104:107], a[144:147], v[76:79]
  v_mfma_f32_16x16x32_bf16 v[80:83], v[104:107], a[176:179], v[80:83]
  v_mfma_f32_16x16x32_bf16 v[84:87], v[104:107], a[208:211], v[84:87]
  v_mfma_f32_16x16x32_bf16 v[88:91], v[104:107], a[240:243], v[88:91]
  ds_read2_b32 v[104:105], v52 offset0:112 offset1:113
  ds_read2_b32 v[106:107], v52 offset0:114 offset1:115
  s_waitcnt lgkmcnt(6)
  v_mfma_f32_16x16x32_bf16 v[60:63], v[92:95], a[12:15], v[60:63]
  v_mfma_f32_16x16x32_bf16 v[64:67], v[92:95], a[44:47], v[64:67]
  v_mfma_f32_16x16x32_bf16 v[68:71], v[92:95], a[76:79], v[68:71]
  v_mfma_f32_16x16x32_bf16 v[72:75], v[92:95], a[108:111], v[72:75]
  v_mfma_f32_16x16x32_bf16 v[76:79], v[92:95], a[140:143], v[76:79]
  v_mfma_f32_16x16x32_bf16 v[80:83], v[92:95], a[172:175], v[80:83]
  v_mfma_f32_16x16x32_bf16 v[84:87], v[92:95], a[204:207], v[84:87]
  v_mfma_f32_16x16x32_bf16 v[88:91], v[92:95], a[236:239], v[88:91]
  ds_read2_b32 v[92:93], v52 offset0:96 offset1:97
  ds_read2_b32 v[94:95], v52 offset0:98 offset1:99
  s_waitcnt lgkmcnt(6)
  v_mfma_f32_16x16x32_bf16 v[60:63], v[96:99], a[8:11], v[60:63]
  v_mfma_f32_16x16x32_bf16 v[64:67], v[96:99], a[40:43], v[64:67]
  v_mfma_f32_16x16x32_bf16 v[68:71], v[96:99], a[72:75], v[68:71]
  v_mfma_f32_16x16x32_bf16 v[72:75], v[96:99], a[104:107], v[72:75]
  v_mfma_f32_16x16x32_bf16 v[76:79], v[96:99], a[136:139], v[76:79]
  v_mfma_f32_16x16x32_bf16 v[80:83], v[96:99], a[168:171], v[80:83]
  v_mfma_f32_16x16x32_bf16 v[84:87], v[96:99], a[200:203], v[84:87]
  v_mfma_f32_16x16x32_bf16 v[88:91], v[96:99], a[232:235], v[88:91]
  ds_read2_b32 v[96:97], v52 offset0:80 offset1:81
  ds_read2_b32 v[98:99], v52 offset0:82 offset1:83
  s_waitcnt lgkmcnt(6)
  v_mfma_f32_16x16x32_bf16 v[60:63], v[100:103], a[4:7], v[60:63]
  v_mfma_f32_16x16x32_bf16 v[64:67], v[100:103], a[36:39], v[64:67]
  v_mfma_f32_16x16x32_bf16 v[68:71], v[100:103], a[68:71], v[68:71]
  v_mfma_f32_16x16x32_bf16 v[72:75], v[100:103], a[100:103], v[72:75]
  v_mfma_f32_16x16x32_bf16 v[76:79], v[100:103], a[132:135], v[76:79]
  v_mfma_f32_16x16x32_bf16 v[80:83], v[100:103], a[164:167], v[80:83]
  v_mfma_f32_16x16x32_bf16 v[84:87], v[100:103], a[196:199], v[84:87]
  v_mfma_f32_16x16x32_bf16 v[88:91], v[100:103], a[228:231], v[88:91]
  ds_read2_b32 v[100:101], v52 offset0:64 offset1:65
  ds_read2_b32 v[102:103], v52 offset0:66 offset1:67
  s_waitcnt lgkmcnt(6)
  v_mfma_f32_16x16x32_bf16 v[60:63], v[104:107], a[0:3], v[60:63]
  v_mfma_f32_16x16x32_bf16 v[64:67], v[104:107], a[32:35], v[64:67]
  v_mfma_f32_16x16x32_bf16 v[68:71], v[104:107], a[64:67], v[68:71]
  v_mfma_f32_16x16x32_bf16 v[72:75], v[104:107], a[96:99], v[72:75]
  v_mfma_f32_16x16x32_bf16 v[76:79], v[104:107], a[128:131], v[76:79]
  v_mfma_f32_16x16x32_bf16 v[80:83], v[104:107], a[160:163], v[80:83]
  v_mfma_f32_16x16x32_bf16 v[84:87], v[104:107], a[192:195], v[84:87]
  v_mfma_f32_16x16x32_bf16 v[88:91], v[104:107], a[224:227], v[88:91]
  ds_read2_b32 v[104:105], v52 offset0:48 offset1:49
  ds_read2_b32 v[106:107], v52 offset0:50 offset1:51
  s_waitcnt lgkmcnt(6)
  v_mfma_f32_16x16x32_bf16 v[64:67], v[92:95], a[28:31], v[64:67]
  v_mfma_f32_16x16x32_bf16 v[68:71], v[92:95], a[60:63], v[68:71]
  v_mfma_f32_16x16x32_bf16 v[72:75], v[92:95], a[92:95], v[72:75]
  v_mfma_f32_16x16x32_bf16 v[76:79], v[92:95], a[124:127], v[76:79]
  v_mfma_f32_16x16x32_bf16 v[80:83], v[92:95], a[156:159], v[80:83]
  v_mfma_f32_16x16x32_bf16 v[84:87], v[92:95], a[188:191], v[84:87]
  v_mfma_f32_16x16x32_bf16 v[88:91], v[92:95], a[220:223], v[88:91]
  ds_read2_b32 v[92:93], v52 offset0:32 offset1:33
  ds_read2_b32 v[94:95], v52 offset0:34 offset1:35
  s_waitcnt lgkmcnt(6)
  v_mfma_f32_16x16x32_bf16 v[64:67], v[96:99], a[24:27], v[64:67]
  v_mfma_f32_16x16x32_bf16 v[68:71], v[96:99], a[56:59], v[68:71]
  v_mfma_f32_16x16x32_bf16 v[72:75], v[96:99], a[88:91], v[72:75]
  v_mfma_f32_16x16x32_bf16 v[76:79], v[96:99], a[120:123], v[76:79]
  v_mfma_f32_16x16x32_bf16 v[80:83], v[96:99], a[152:155], v[80:83]
  v_mfma_f32_16x16x32_bf16 v[84:87], v[96:99], a[184:187], v[84:87]
  v_mfma_f32_16x16x32_bf16 v[88:91], v[96:99], a[216:219], v[88:91]
  ds_read2_b32 v[96:97], v52 offset0:16 offset1:17
  ds_read2_b32 v[98:99], v52 offset0:18 offset1:19
  s_waitcnt lgkmcnt(6)
  v_mfma_f32_16x16x32_bf16 v[64:67], v[100:103], a[20:23], v[64:67]
  v_mfma_f32_16x16x32_bf16 v[68:71], v[100:103], a[52:55], v[68:71]
  v_mfma_f32_16x16x32_bf16 v[72:75], v[100:103], a[84:87], v[72:75]
  v_mfma_f32_16x16x32_bf16 v[76:79], v[100:103], a[116:119], v[76:79]
  v_mfma_f32_16x16x32_bf16 v[80:83], v[100:103], a[148:151], v[80:83]
  v_mfma_f32_16x16x32_bf16 v[84:87], v[100:103], a[180:183], v[84:87]
  v_mfma_f32_16x16x32_bf16 v[88:91], v[100:103], a[212:215], v[88:91]
  ds_read2_b32 v[100:101], v52 offset0:0 offset1:1
  ds_read2_b32 v[102:103], v52 offset0:2 offset1:3
  s_waitcnt lgkmcnt(6)
  v_mfma_f32_16x16x32_bf16 v[64:67], v[104:107], a[16:19], v[64:67]
  v_mfma_f32_16x16x32_bf16 v[68:71], v[104:107], a[48:51], v[68:71]
  v_mfma_f32_16x16x32_bf16 v[72:75], v[104:107], a[80:83], v[72:75]
  v_mfma_f32_16x16x32_bf16 v[76:79], v[104:107], a[112:115], v[76:79]
  v_mfma_f32_16x16x32_bf16 v[80:83], v[104:107], a[144:147], v[80:83]
  v_mfma_f32_16x16x32_bf16 v[84:87], v[104:107], a[176:179], v[84:87]
  v_mfma_f32_16x16x32_bf16 v[88:91], v[104:107], a[208:211], v[88:91]
  ds_read2_b32 v[104:105], v53 offset0:224 offset1:225
  ds_read2_b32 v[106:107], v53 offset0:226 offset1:227
  s_waitcnt lgkmcnt(6)
  v_mfma_f32_16x16x32_bf16 v[64:67], v[92:95], a[12:15], v[64:67]
  v_mfma_f32_16x16x32_bf16 v[68:71], v[92:95], a[44:47], v[68:71]
  v_mfma_f32_16x16x32_bf16 v[72:75], v[92:95], a[76:79], v[72:75]
  v_mfma_f32_16x16x32_bf16 v[76:79], v[92:95], a[108:111], v[76:79]
  v_mfma_f32_16x16x32_bf16 v[80:83], v[92:95], a[140:143], v[80:83]
  v_mfma_f32_16x16x32_bf16 v[84:87], v[92:95], a[172:175], v[84:87]
  v_mfma_f32_16x16x32_bf16 v[88:91], v[92:95], a[204:207], v[88:91]
  ds_read2_b32 v[92:93], v53 offset0:208 offset1:209
  ds_read2_b32 v[94:95], v53 offset0:210 offset1:211
  s_waitcnt lgkmcnt(6)
  v_mfma_f32_16x16x32_bf16 v[64:67], v[96:99], a[8:11], v[64:67]
  v_mfma_f32_16x16x32_bf16 v[68:71], v[96:99], a[40:43], v[68:71]
  v_mfma_f32_16x16x32_bf16 v[72:75], v[96:99], a[72:75], v[72:75]
  v_mfma_f32_16x16x32_bf16 v[76:79], v[96:99], a[104:107], v[76:79]
  v_mfma_f32_16x16x32_bf16 v[80:83], v[96:99], a[136:139], v[80:83]
  v_mfma_f32_16x16x32_bf16 v[84:87], v[96:99], a[168:171], v[84:87]
  v_mfma_f32_16x16x32_bf16 v[88:91], v[96:99], a[200:203], v[88:91]
  ds_read2_b32 v[96:97], v53 offset0:192 offset1:193
  ds_read2_b32 v[98:99], v53 offset0:194 offset1:195
  s_waitcnt lgkmcnt(6)
  v_mfma_f32_16x16x32_bf16 v[64:67], v[100:103], a[4:7], v[64:67]
  v_mfma_f32_16x16x32_bf16 v[68:71], v[100:103], a[36:39], v[68:71]
  v_mfma_f32_16x16x32_bf16 v[72:75], v[100:103], a[68:71], v[72:75]
  v_mfma_f32_16x16x32_bf16 v[76:79], v[100:103], a[100:103], v[76:79]
  v_mfma_f32_16x16x32_bf16 v[80:83], v[100:103], a[132:135], v[80:83]
  v_mfma_f32_16x16x32_bf16 v[84:87], v[100:103], a[164:167], v[84:87]
  v_mfma_f32_16x16x32_bf16 v[88:91], v[100:103], a[196:199], v[88:91]
  ds_read2_b32 v[100:101], v53 offset0:176 offset1:177
  ds_read2_b32 v[102:103], v53 offset0:178 offset1:179
  s_waitcnt lgkmcnt(6)
  v_mfma_f32_16x16x32_bf16 v[64:67], v[104:107], a[0:3], v[64:67]
  v_mfma_f32_16x16x32_bf16 v[68:71], v[104:107], a[32:35], v[68:71]
  v_mfma_f32_16x16x32_bf16 v[72:75], v[104:107], a[64:67], v[72:75]
  v_mfma_f32_16x16x32_bf16 v[76:79], v[104:107], a[96:99], v[76:79]
  v_mfma_f32_16x16x32_bf16 v[80:83], v[104:107], a[128:131], v[80:83]
  v_mfma_f32_16x16x32_bf16 v[84:87], v[104:107], a[160:163], v[84:87]
  v_mfma_f32_16x16x32_bf16 v[88:91], v[104:107], a[192:195], v[88:91]
  ds_read2_b32 v[104:105], v53 offset0:160 offset1:161
  ds_read2_b32 v[106:107], v53 offset0:162 offset1:163
  s_waitcnt lgkmcnt(6)
  v_mfma_f32_16x16x32_bf16 v[68:71], v[92:95], a[28:31], v[68:71]
  v_mfma_f32_16x16x32_bf16 v[72:75], v[92:95], a[60:63], v[72:75]
  v_mfma_f32_16x16x32_bf16 v[76:79], v[92:95], a[92:95], v[76:79]
  v_mfma_f32_16x16x32_bf16 v[80:83], v[92:95], a[124:127], v[80:83]
  v_mfma_f32_16x16x32_bf16 v[84:87], v[92:95], a[156:159], v[84:87]
  v_mfma_f32_16x16x32_bf16 v[88:91], v[92:95], a[188:191], v[88:91]
  ds_read2_b32 v[92:93], v53 offset0:144 offset1:145
  ds_read2_b32 v[94:95], v53 offset0:146 offset1:147
  s_waitcnt lgkmcnt(6)
  v_mfma_f32_16x16x32_bf16 v[68:71], v[96:99], a[24:27], v[68:71]
  v_mfma_f32_16x16x32_bf16 v[72:75], v[96:99], a[56:59], v[72:75]
  v_mfma_f32_16x16x32_bf16 v[76:79], v[96:99], a[88:91], v[76:79]
  v_mfma_f32_16x16x32_bf16 v[80:83], v[96:99], a[120:123], v[80:83]
  v_mfma_f32_16x16x32_bf16 v[84:87], v[96:99], a[152:155], v[84:87]
  v_mfma_f32_16x16x32_bf16 v[88:91], v[96:99], a[184:187], v[88:91]
  ds_read2_b32 v[96:97], v53 offset0:128 offset1:129
  ds_read2_b32 v[98:99], v53 offset0:130 offset1:131
  s_waitcnt lgkmcnt(6)
  v_mfma_f32_16x16x32_bf16 v[68:71], v[100:103], a[20:23], v[68:71]
  v_mfma_f32_16x16x32_bf16 v[72:75], v[100:103], a[52:55], v[72:75]
  v_mfma_f32_16x16x32_bf16 v[76:79], v[100:103], a[84:87], v[76:79]
  v_mfma_f32_16x16x32_bf16 v[80:83], v[100:103], a[116:119], v[80:83]
  v_mfma_f32_16x16x32_bf16 v[84:87], v[100:103], a[148:151], v[84:87]
  v_mfma_f32_16x16x32_bf16 v[88:91], v[100:103], a[180:183], v[88:91]
  ds_read2_b32 v[100:101], v53 offset0:112 offset1:113
  ds_read2_b32 v[102:103], v53 offset0:114 offset1:115
  s_waitcnt lgkmcnt(6)
  v_mfma_f32_16x16x32_bf16 v[68:71], v[104:107], a[16:19], v[68:71]
  v_mfma_f32_16x16x32_bf16 v[72:75], v[104:107], a[48:51], v[72:75]
  v_mfma_f32_16x16x32_bf16 v[76:79], v[104:107], a[80:83], v[76:79]
  v_mfma_f32_16x16x32_bf16 v[80:83], v[104:107], a[112:115], v[80:83]
  v_mfma_f32_16x16x32_bf16 v[84:87], v[104:107], a[144:147], v[84:87]
  v_mfma_f32_16x16x32_bf16 v[88:91], v[104:107], a[176:179], v[88:91]
  ds_read2_b32 v[104:105], v53 offset0:96 offset1:97
  ds_read2_b32 v[106:107], v53 offset0:98 offset1:99
  s_waitcnt lgkmcnt(6)
  v_mfma_f32_16x16x32_bf16 v[68:71], v[92:95], a[12:15], v[68:71]
  v_mfma_f32_16x16x32_bf16 v[72:75], v[92:95], a[44:47], v[72:75]
  v_mfma_f32_16x16x32_bf16 v[76:79], v[92:95], a[76:79], v[76:79]
  v_mfma_f32_16x16x32_bf16 v[80:83], v[92:95], a[108:111], v[80:83]
  v_mfma_f32_16x16x32_bf16 v[84:87], v[92:95], a[140:143], v[84:87]
  v_mfma_f32_16x16x32_bf16 v[88:91], v[92:95], a[172:175], v[88:91]
  ds_read2_b32 v[92:93], v53 offset0:80 offset1:81
  ds_read2_b32 v[94:95], v53 offset0:82 offset1:83
  s_waitcnt lgkmcnt(6)
  v_mfma_f32_16x16x32_bf16 v[68:71], v[96:99], a[8:11], v[68:71]
  v_mfma_f32_16x16x32_bf16 v[72:75], v[96:99], a[40:43], v[72:75]
  v_mfma_f32_16x16x32_bf16 v[76:79], v[96:99], a[72:75], v[76:79]
  v_mfma_f32_16x16x32_bf16 v[80:83], v[96:99], a[104:107], v[80:83]
  v_mfma_f32_16x16x32_bf16 v[84:87], v[96:99], a[136:139], v[84:87]
  v_mfma_f32_16x16x32_bf16 v[88:91], v[96:99], a[168:171], v[88:91]
  ds_read2_b32 v[96:97], v53 offset0:64 offset1:65
  ds_read2_b32 v[98:99], v53 offset0:66 offset1:67
  s_waitcnt lgkmcnt(6)
  v_mfma_f32_16x16x32_bf16 v[68:71], v[100:103], a[4:7], v[68:71]
  v_mfma_f32_16x16x32_bf16 v[72:75], v[100:103], a[36:39], v[72:75]
  v_mfma_f32_16x16x32_bf16 v[76:79], v[100:103], a[68:71], v[76:79]
  v_mfma_f32_16x16x32_bf16 v[80:83], v[100:103], a[100:103], v[80:83]
  v_mfma_f32_16x16x32_bf16 v[84:87], v[100:103], a[132:135], v[84:87]
  v_mfma_f32_16x16x32_bf16 v[88:91], v[100:103], a[164:167], v[88:91]
  ds_read2_b32 v[100:101], v53 offset0:48 offset1:49
  ds_read2_b32 v[102:103], v53 offset0:50 offset1:51
  s_waitcnt lgkmcnt(6)
  v_mfma_f32_16x16x32_bf16 v[68:71], v[104:107], a[0:3], v[68:71]
  v_mfma_f32_16x16x32_bf16 v[72:75], v[104:107], a[32:35], v[72:75]
  v_mfma_f32_16x16x32_bf16 v[76:79], v[104:107], a[64:67], v[76:79]
  v_mfma_f32_16x16x32_bf16 v[80:83], v[104:107], a[96:99], v[80:83]
  v_mfma_f32_16x16x32_bf16 v[84:87], v[104:107], a[128:131], v[84:87]
  v_mfma_f32_16x16x32_bf16 v[88:91], v[104:107], a[160:163], v[88:91]
  ds_read2_b32 v[104:105], v53 offset0:32 offset1:33
  ds_read2_b32 v[106:107], v53 offset0:34 offset1:35
  s_waitcnt lgkmcnt(6)
  v_mfma_f32_16x16x32_bf16 v[72:75], v[92:95], a[28:31], v[72:75]
  v_mfma_f32_16x16x32_bf16 v[76:79], v[92:95], a[60:63], v[76:79]
  v_mfma_f32_16x16x32_bf16 v[80:83], v[92:95], a[92:95], v[80:83]
  v_mfma_f32_16x16x32_bf16 v[84:87], v[92:95], a[124:127], v[84:87]
  v_mfma_f32_16x16x32_bf16 v[88:91], v[92:95], a[156:159], v[88:91]
  ds_read2_b32 v[92:93], v53 offset0:16 offset1:17
  ds_read2_b32 v[94:95], v53 offset0:18 offset1:19
  s_waitcnt lgkmcnt(6)
  v_mfma_f32_16x16x32_bf16 v[72:75], v[96:99], a[24:27], v[72:75]
  v_mfma_f32_16x16x32_bf16 v[76:79], v[96:99], a[56:59], v[76:79]
  v_mfma_f32_16x16x32_bf16 v[80:83], v[96:99], a[88:91], v[80:83]
  v_mfma_f32_16x16x32_bf16 v[84:87], v[96:99], a[120:123], v[84:87]
  v_mfma_f32_16x16x32_bf16 v[88:91], v[96:99], a[152:155], v[88:91]
  ds_read2_b32 v[96:97], v53 offset0:0 offset1:1
  ds_read2_b32 v[98:99], v53 offset0:2 offset1:3
  s_waitcnt lgkmcnt(6)
  v_mfma_f32_16x16x32_bf16 v[72:75], v[100:103], a[20:23], v[72:75]
  v_mfma_f32_16x16x32_bf16 v[76:79], v[100:103], a[52:55], v[76:79]
  v_mfma_f32_16x16x32_bf16 v[80:83], v[100:103], a[84:87], v[80:83]
  v_mfma_f32_16x16x32_bf16 v[84:87], v[100:103], a[116:119], v[84:87]
  v_mfma_f32_16x16x32_bf16 v[88:91], v[100:103], a[148:151], v[88:91]
  ds_read2_b32 v[100:101], v54 offset0:224 offset1:225
  ds_read2_b32 v[102:103], v54 offset0:226 offset1:227
  s_waitcnt lgkmcnt(6)
  v_mfma_f32_16x16x32_bf16 v[72:75], v[104:107], a[16:19], v[72:75]
  v_mfma_f32_16x16x32_bf16 v[76:79], v[104:107], a[48:51], v[76:79]
  v_mfma_f32_16x16x32_bf16 v[80:83], v[104:107], a[80:83], v[80:83]
  v_mfma_f32_16x16x32_bf16 v[84:87], v[104:107], a[112:115], v[84:87]
  v_mfma_f32_16x16x32_bf16 v[88:91], v[104:107], a[144:147], v[88:91]
  ds_read2_b32 v[104:105], v54 offset0:208 offset1:209
  ds_read2_b32 v[106:107], v54 offset0:210 offset1:211
  s_waitcnt lgkmcnt(6)
  v_mfma_f32_16x16x32_bf16 v[72:75], v[92:95], a[12:15], v[72:75]
  v_mfma_f32_16x16x32_bf16 v[76:79], v[92:95], a[44:47], v[76:79]
  v_mfma_f32_16x16x32_bf16 v[80:83], v[92:95], a[76:79], v[80:83]
  v_mfma_f32_16x16x32_bf16 v[84:87], v[92:95], a[108:111], v[84:87]
  v_mfma_f32_16x16x32_bf16 v[88:91], v[92:95], a[140:143], v[88:91]
  ds_read2_b32 v[92:93], v54 offset0:192 offset1:193
  ds_read2_b32 v[94:95], v54 offset0:194 offset1:195
  s_waitcnt lgkmcnt(6)
  v_mfma_f32_16x16x32_bf16 v[72:75], v[96:99], a[8:11], v[72:75]
  v_mfma_f32_16x16x32_bf16 v[76:79], v[96:99], a[40:43], v[76:79]
  v_mfma_f32_16x16x32_bf16 v[80:83], v[96:99], a[72:75], v[80:83]
  v_mfma_f32_16x16x32_bf16 v[84:87], v[96:99], a[104:107], v[84:87]
  v_mfma_f32_16x16x32_bf16 v[88:91], v[96:99], a[136:139], v[88:91]
  ds_read2_b32 v[96:97], v54 offset0:176 offset1:177
  ds_read2_b32 v[98:99], v54 offset0:178 offset1:179
  s_waitcnt lgkmcnt(6)
  v_mfma_f32_16x16x32_bf16 v[72:75], v[100:103], a[4:7], v[72:75]
  v_mfma_f32_16x16x32_bf16 v[76:79], v[100:103], a[36:39], v[76:79]
  v_mfma_f32_16x16x32_bf16 v[80:83], v[100:103], a[68:71], v[80:83]
  v_mfma_f32_16x16x32_bf16 v[84:87], v[100:103], a[100:103], v[84:87]
  v_mfma_f32_16x16x32_bf16 v[88:91], v[100:103], a[132:135], v[88:91]
  ds_read2_b32 v[100:101], v54 offset0:160 offset1:161
  ds_read2_b32 v[102:103], v54 offset0:162 offset1:163
  s_waitcnt lgkmcnt(6)
  v_mfma_f32_16x16x32_bf16 v[72:75], v[104:107], a[0:3], v[72:75]
  v_mfma_f32_16x16x32_bf16 v[76:79], v[104:107], a[32:35], v[76:79]
  v_mfma_f32_16x16x32_bf16 v[80:83], v[104:107], a[64:67], v[80:83]
  v_mfma_f32_16x16x32_bf16 v[84:87], v[104:107], a[96:99], v[84:87]
  v_mfma_f32_16x16x32_bf16 v[88:91], v[104:107], a[128:131], v[88:91]
  ds_read2_b32 v[104:105], v54 offset0:144 offset1:145
  ds_read2_b32 v[106:107], v54 offset0:146 offset1:147
  s_waitcnt lgkmcnt(6)
  v_mfma_f32_16x16x32_bf16 v[76:79], v[92:95], a[28:31], v[76:79]
  v_mfma_f32_16x16x32_bf16 v[80:83], v[92:95], a[60:63], v[80:83]
  v_mfma_f32_16x16x32_bf16 v[84:87], v[92:95], a[92:95], v[84:87]
  v_mfma_f32_16x16x32_bf16 v[88:91], v[92:95], a[124:127], v[88:91]
  ds_read2_b32 v[92:93], v54 offset0:128 offset1:129
  ds_read2_b32 v[94:95], v54 offset0:130 offset1:131
  s_waitcnt lgkmcnt(6)
  v_mfma_f32_16x16x32_bf16 v[76:79], v[96:99], a[24:27], v[76:79]
  v_mfma_f32_16x16x32_bf16 v[80:83], v[96:99], a[56:59], v[80:83]
  v_mfma_f32_16x16x32_bf16 v[84:87], v[96:99], a[88:91], v[84:87]
  v_mfma_f32_16x16x32_bf16 v[88:91], v[96:99], a[120:123], v[88:91]
  ds_read2_b32 v[96:97], v54 offset0:112 offset1:113
  ds_read2_b32 v[98:99], v54 offset0:114 offset1:115
  s_waitcnt lgkmcnt(6)
  v_mfma_f32_16x16x32_bf16 v[76:79], v[100:103], a[20:23], v[76:79]
  v_mfma_f32_16x16x32_bf16 v[80:83], v[100:103], a[52:55], v[80:83]
  v_mfma_f32_16x16x32_bf16 v[84:87], v[100:103], a[84:87], v[84:87]
  v_mfma_f32_16x16x32_bf16 v[88:91], v[100:103], a[116:119], v[88:91]
  ds_read2_b32 v[100:101], v54 offset0:96 offset1:97
  ds_read2_b32 v[102:103], v54 offset0:98 offset1:99
  s_waitcnt lgkmcnt(6)
  v_mfma_f32_16x16x32_bf16 v[76:79], v[104:107], a[16:19], v[76:79]
  v_mfma_f32_16x16x32_bf16 v[80:83], v[104:107], a[48:51], v[80:83]
  v_mfma_f32_16x16x32_bf16 v[84:87], v[104:107], a[80:83], v[84:87]
  v_mfma_f32_16x16x32_bf16 v[88:91], v[104:107], a[112:115], v[88:91]
  ds_read2_b32 v[104:105], v54 offset0:80 offset1:81
  ds_read2_b32 v[106:107], v54 offset0:82 offset1:83
  s_waitcnt lgkmcnt(6)
  v_mfma_f32_16x16x32_bf16 v[76:79], v[92:95], a[12:15], v[76:79]
  v_mfma_f32_16x16x32_bf16 v[80:83], v[92:95], a[44:47], v[80:83]
  v_mfma_f32_16x16x32_bf16 v[84:87], v[92:95], a[76:79], v[84:87]
  v_mfma_f32_16x16x32_bf16 v[88:91], v[92:95], a[108:111], v[88:91]
  ds_read2_b32 v[92:93], v54 offset0:64 offset1:65
  ds_read2_b32 v[94:95], v54 offset0:66 offset1:67
  s_waitcnt lgkmcnt(6)
  v_mfma_f32_16x16x32_bf16 v[76:79], v[96:99], a[8:11], v[76:79]
  v_mfma_f32_16x16x32_bf16 v[80:83], v[96:99], a[40:43], v[80:83]
  v_mfma_f32_16x16x32_bf16 v[84:87], v[96:99], a[72:75], v[84:87]
  v_mfma_f32_16x16x32_bf16 v[88:91], v[96:99], a[104:107], v[88:91]
  ds_read2_b32 v[96:97], v54 offset0:48 offset1:49
  ds_read2_b32 v[98:99], v54 offset0:50 offset1:51
  s_waitcnt lgkmcnt(6)
  v_mfma_f32_16x16x32_bf16 v[76:79], v[100:103], a[4:7], v[76:79]
  v_mfma_f32_16x16x32_bf16 v[80:83], v[100:103], a[36:39], v[80:83]
  v_mfma_f32_16x16x32_bf16 v[84:87], v[100:103], a[68:71], v[84:87]
  v_mfma_f32_16x16x32_bf16 v[88:91], v[100:103], a[100:103], v[88:91]
  ds_read2_b32 v[100:101], v54 offset0:32 offset1:33
  ds_read2_b32 v[102:103], v54 offset0:34 offset1:35
  s_waitcnt lgkmcnt(6)
  v_mfma_f32_16x16x32_bf16 v[76:79], v[104:107], a[0:3], v[76:79]
  v_mfma_f32_16x16x32_bf16 v[80:83], v[104:107], a[32:35], v[80:83]
  v_mfma_f32_16x16x32_bf16 v[84:87], v[104:107], a[64:67], v[84:87]
  v_mfma_f32_16x16x32_bf16 v[88:91], v[104:107], a[96:99], v[88:91]
  ds_read2_b32 v[104:105], v54 offset0:16 offset1:17
  ds_read2_b32 v[106:107], v54 offset0:18 offset1:19
  s_waitcnt lgkmcnt(6)
  v_mfma_f32_16x16x32_bf16 v[80:83], v[92:95], a[28:31], v[80:83]
  v_mfma_f32_16x16x32_bf16 v[84:87], v[92:95], a[60:63], v[84:87]
  v_mfma_f32_16x16x32_bf16 v[88:91], v[92:95], a[92:95], v[88:91]
  ds_read2_b32 v[92:93], v54 offset0:0 offset1:1
  ds_read2_b32 v[94:95], v54 offset0:2 offset1:3
  s_waitcnt lgkmcnt(6)
  v_mfma_f32_16x16x32_bf16 v[80:83], v[96:99], a[24:27], v[80:83]
  v_mfma_f32_16x16x32_bf16 v[84:87], v[96:99], a[56:59], v[84:87]
  v_mfma_f32_16x16x32_bf16 v[88:91], v[96:99], a[88:91], v[88:91]
  ds_read2_b32 v[96:97], v55 offset0:224 offset1:225
  ds_read2_b32 v[98:99], v55 offset0:226 offset1:227
  s_waitcnt lgkmcnt(6)
  v_mfma_f32_16x16x32_bf16 v[80:83], v[100:103], a[20:23], v[80:83]
  v_mfma_f32_16x16x32_bf16 v[84:87], v[100:103], a[52:55], v[84:87]
  v_mfma_f32_16x16x32_bf16 v[88:91], v[100:103], a[84:87], v[88:91]
  ds_read2_b32 v[100:101], v55 offset0:208 offset1:209
  ds_read2_b32 v[102:103], v55 offset0:210 offset1:211
  s_waitcnt lgkmcnt(6)
  v_mfma_f32_16x16x32_bf16 v[80:83], v[104:107], a[16:19], v[80:83]
  v_mfma_f32_16x16x32_bf16 v[84:87], v[104:107], a[48:51], v[84:87]
  v_mfma_f32_16x16x32_bf16 v[88:91], v[104:107], a[80:83], v[88:91]
  ds_read2_b32 v[104:105], v55 offset0:192 offset1:193
  ds_read2_b32 v[106:107], v55 offset0:194 offset1:195
  s_waitcnt lgkmcnt(6)
  v_mfma_f32_16x16x32_bf16 v[80:83], v[92:95], a[12:15], v[80:83]
  v_mfma_f32_16x16x32_bf16 v[84:87], v[92:95], a[44:47], v[84:87]
  v_mfma_f32_16x16x32_bf16 v[88:91], v[92:95], a[76:79], v[88:91]
  ds_read2_b32 v[92:93], v55 offset0:176 offset1:177
  ds_read2_b32 v[94:95], v55 offset0:178 offset1:179
  s_waitcnt lgkmcnt(6)
  v_mfma_f32_16x16x32_bf16 v[80:83], v[96:99], a[8:11], v[80:83]
  v_mfma_f32_16x16x32_bf16 v[84:87], v[96:99], a[40:43], v[84:87]
  v_mfma_f32_16x16x32_bf16 v[88:91], v[96:99], a[72:75], v[88:91]
  ds_read2_b32 v[96:97], v55 offset0:160 offset1:161
  ds_read2_b32 v[98:99], v55 offset0:162 offset1:163
  s_waitcnt lgkmcnt(6)
  v_mfma_f32_16x16x32_bf16 v[80:83], v[100:103], a[4:7], v[80:83]
  v_mfma_f32_16x16x32_bf16 v[84:87], v[100:103], a[36:39], v[84:87]
  v_mfma_f32_16x16x32_bf16 v[88:91], v[100:103], a[68:71], v[88:91]
  ds_read2_b32 v[100:101], v55 offset0:144 offset1:145
  ds_read2_b32 v[102:103], v55 offset0:146 offset1:147
  s_waitcnt lgkmcnt(6)
  v_mfma_f32_16x16x32_bf16 v[80:83], v[104:107], a[0:3], v[80:83]
  v_mfma_f32_16x16x32_bf16 v[84:87], v[104:107], a[32:35], v[84:87]
  v_mfma_f32_16x16x32_bf16 v[88:91], v[104:107], a[64:67], v[88:91]
  ds_read2_b32 v[104:105], v55 offset0:128 offset1:129
  ds_read2_b32 v[106:107], v55 offset0:130 offset1:131
  s_waitcnt lgkmcnt(6)
  v_mfma_f32_16x16x32_bf16 v[84:87], v[92:95], a[28:31], v[84:87]
  v_mfma_f32_16x16x32_bf16 v[88:91], v[92:95], a[60:63], v[88:91]
  ds_read2_b32 v[92:93], v55 offset0:112 offset1:113
  ds_read2_b32 v[94:95], v55 offset0:114 offset1:115
  s_waitcnt lgkmcnt(6)
  v_mfma_f32_16x16x32_bf16 v[84:87], v[96:99], a[24:27], v[84:87]
  v_mfma_f32_16x16x32_bf16 v[88:91], v[96:99], a[56:59], v[88:91]
  ds_read2_b32 v[96:97], v55 offset0:96 offset1:97
  ds_read2_b32 v[98:99], v55 offset0:98 offset1:99
  s_waitcnt lgkmcnt(6)
  v_mfma_f32_16x16x32_bf16 v[84:87], v[100:103], a[20:23], v[84:87]
  v_mfma_f32_16x16x32_bf16 v[88:91], v[100:103], a[52:55], v[88:91]
  ds_read2_b32 v[100:101], v55 offset0:80 offset1:81
  ds_read2_b32 v[102:103], v55 offset0:82 offset1:83
  s_waitcnt lgkmcnt(6)
  v_mfma_f32_16x16x32_bf16 v[84:87], v[104:107], a[16:19], v[84:87]
  v_mfma_f32_16x16x32_bf16 v[88:91], v[104:107], a[48:51], v[88:91]
  ds_read2_b32 v[104:105], v55 offset0:64 offset1:65
  ds_read2_b32 v[106:107], v55 offset0:66 offset1:67
  s_waitcnt lgkmcnt(6)
  v_mfma_f32_16x16x32_bf16 v[84:87], v[92:95], a[12:15], v[84:87]
  v_mfma_f32_16x16x32_bf16 v[88:91], v[92:95], a[44:47], v[88:91]
  ds_read2_b32 v[92:93], v55 offset0:48 offset1:49
  ds_read2_b32 v[94:95], v55 offset0:50 offset1:51
  s_waitcnt lgkmcnt(6)
  v_mfma_f32_16x16x32_bf16 v[84:87], v[96:99], a[8:11], v[84:87]
  v_mfma_f32_16x16x32_bf16 v[88:91], v[96:99], a[40:43], v[88:91]
  ds_read2_b32 v[96:97], v55 offset0:32 offset1:33
  ds_read2_b32 v[98:99], v55 offset0:34 offset1:35
  s_waitcnt lgkmcnt(6)
  v_mfma_f32_16x16x32_bf16 v[84:87], v[100:103], a[4:7], v[84:87]
  v_mfma_f32_16x16x32_bf16 v[88:91], v[100:103], a[36:39], v[88:91]
  ds_read2_b32 v[100:101], v55 offset0:16 offset1:17
  ds_read2_b32 v[102:103], v55 offset0:18 offset1:19
  s_waitcnt lgkmcnt(6)
  v_mfma_f32_16x16x32_bf16 v[84:87], v[104:107], a[0:3], v[84:87]
  v_mfma_f32_16x16x32_bf16 v[88:91], v[104:107], a[32:35], v[88:91]
  ds_read2_b32 v[104:105], v55 offset0:0 offset1:1
  ds_read2_b32 v[106:107], v55 offset0:2 offset1:3
  s_waitcnt lgkmcnt(6)
  v_mfma_f32_16x16x32_bf16 v[88:91], v[92:95], a[28:31], v[88:91]
  ds_read2_b32 v[92:93], v56 offset0:224 offset1:225
  ds_read2_b32 v[94:95], v56 offset0:226 offset1:227
  s_waitcnt lgkmcnt(6)
  v_mfma_f32_16x16x32_bf16 v[88:91], v[96:99], a[24:27], v[88:91]
  ds_read2_b32 v[96:97], v56 offset0:208 offset1:209
  ds_read2_b32 v[98:99], v56 offset0:210 offset1:211
  s_waitcnt lgkmcnt(6)
  v_mfma_f32_16x16x32_bf16 v[88:91], v[100:103], a[20:23], v[88:91]
  ds_read2_b32 v[100:101], v56 offset0:192 offset1:193
  ds_read2_b32 v[102:103], v56 offset0:194 offset1:195
  s_waitcnt lgkmcnt(6)
  v_mfma_f32_16x16x32_bf16 v[88:91], v[104:107], a[16:19], v[88:91]
  ds_read2_b32 v[104:105], v56 offset0:176 offset1:177
  ds_read2_b32 v[106:107], v56 offset0:178 offset1:179
  s_waitcnt lgkmcnt(6)
  v_mfma_f32_16x16x32_bf16 v[88:91], v[92:95], a[12:15], v[88:91]
  s_waitcnt lgkmcnt(4)
  v_mfma_f32_16x16x32_bf16 v[88:91], v[96:99], a[8:11], v[88:91]
  s_waitcnt lgkmcnt(2)
  v_mfma_f32_16x16x32_bf16 v[88:91], v[100:103], a[4:7], v[88:91]
  s_waitcnt lgkmcnt(0)
  v_mfma_f32_16x16x32_bf16 v[88:91], v[104:107], a[0:3], v[88:91]
  v_lshlrev_b32 v46, 5, v4
  v_lshl_add_u32 v46, v3, 3, v46
  v_add_u32 v46, s17, v46
  ds_read_b64 v[108:109], v46 offset:512
  ds_read_b64 v[110:111], v46 offset:1024
  ds_read_b64 v[112:113], v46 offset:1536
  ds_read_b64 v[114:115], v46 offset:2048
  ds_read_b64 v[116:117], v46 offset:2560
  ds_read_b64 v[118:119], v46 offset:3072
  ds_read_b64 v[120:121], v46 offset:3584
  ds_read_b64 v[122:123], v46 offset:4096
  s_waitcnt lgkmcnt(0)
  v_lshlrev_b32 v124, 16, v108
  v_and_b32 v125, 0xffff0000, v108
  v_lshlrev_b32 v126, 16, v109
  v_and_b32 v127, 0xffff0000, v109
  v_mul_f32 v124, v124, v33
  v_mul_f32 v125, v125, v33
  v_mul_f32 v126, v126, v33
  v_mul_f32 v127, v127, v33
  v_cvt_pk_bf16_f32 v128, v124, v125
  v_cvt_pk_bf16_f32 v129, v126, v127
  v_cvt_pk_bf16_f32 v130, v60, v61
  v_cvt_pk_bf16_f32 v131, v62, v63
  v_lshlrev_b32 v124, 16, v128
  v_and_b32 v125, 0xffff0000, v128
  v_lshlrev_b32 v132, 16, v130
  v_and_b32 v133, 0xffff0000, v130
  v_lshlrev_b32 v126, 16, v129
  v_and_b32 v127, 0xffff0000, v129
  v_lshlrev_b32 v134, 16, v131
  v_and_b32 v135, 0xffff0000, v131
  v_add_f32 v124, v124, v132
  v_add_f32 v125, v125, v133
  v_add_f32 v126, v126, v134
  v_add_f32 v127, v127, v135
  v_cvt_pk_bf16_f32 v108, v124, v125
  v_cvt_pk_bf16_f32 v109, v126, v127
  ds_write_b64 v46, v[108:109] offset:512
  v_lshlrev_b32 v124, 16, v110
  v_and_b32 v125, 0xffff0000, v110
  v_lshlrev_b32 v126, 16, v111
  v_and_b32 v127, 0xffff0000, v111
  v_mul_f32 v124, v124, v33
  v_mul_f32 v125, v125, v33
  v_mul_f32 v126, v126, v33
  v_mul_f32 v127, v127, v33
  v_cvt_pk_bf16_f32 v128, v124, v125
  v_cvt_pk_bf16_f32 v129, v126, v127
  v_cvt_pk_bf16_f32 v130, v64, v65
  v_cvt_pk_bf16_f32 v131, v66, v67
  v_lshlrev_b32 v124, 16, v128
  v_and_b32 v125, 0xffff0000, v128
  v_lshlrev_b32 v132, 16, v130
  v_and_b32 v133, 0xffff0000, v130
  v_lshlrev_b32 v126, 16, v129
  v_and_b32 v127, 0xffff0000, v129
  v_lshlrev_b32 v134, 16, v131
  v_and_b32 v135, 0xffff0000, v131
  v_add_f32 v124, v124, v132
  v_add_f32 v125, v125, v133
  v_add_f32 v126, v126, v134
  v_add_f32 v127, v127, v135
  v_cvt_pk_bf16_f32 v110, v124, v125
  v_cvt_pk_bf16_f32 v111, v126, v127
  ds_write_b64 v46, v[110:111] offset:1024
  v_lshlrev_b32 v124, 16, v112
  v_and_b32 v125, 0xffff0000, v112
  v_lshlrev_b32 v126, 16, v113
  v_and_b32 v127, 0xffff0000, v113
  v_mul_f32 v124, v124, v33
  v_mul_f32 v125, v125, v33
  v_mul_f32 v126, v126, v33
  v_mul_f32 v127, v127, v33
  v_cvt_pk_bf16_f32 v128, v124, v125
  v_cvt_pk_bf16_f32 v129, v126, v127
  v_cvt_pk_bf16_f32 v130, v68, v69
  v_cvt_pk_bf16_f32 v131, v70, v71
  v_lshlrev_b32 v124, 16, v128
  v_and_b32 v125, 0xffff0000, v128
  v_lshlrev_b32 v132, 16, v130
  v_and_b32 v133, 0xffff0000, v130
  v_lshlrev_b32 v126, 16, v129
  v_and_b32 v127, 0xffff0000, v129
  v_lshlrev_b32 v134, 16, v131
  v_and_b32 v135, 0xffff0000, v131
  v_add_f32 v124, v124, v132
  v_add_f32 v125, v125, v133
  v_add_f32 v126, v126, v134
  v_add_f32 v127, v127, v135
  v_cvt_pk_bf16_f32 v112, v124, v125
  v_cvt_pk_bf16_f32 v113, v126, v127
  ds_write_b64 v46, v[112:113] offset:1536
  v_lshlrev_b32 v124, 16, v114
  v_and_b32 v125, 0xffff0000, v114
  v_lshlrev_b32 v126, 16, v115
  v_and_b32 v127, 0xffff0000, v115
  v_mul_f32 v124, v124, v33
  v_mul_f32 v125, v125, v33
  v_mul_f32 v126, v126, v33
  v_mul_f32 v127, v127, v33
  v_cvt_pk_bf16_f32 v128, v124, v125
  v_cvt_pk_bf16_f32 v129, v126, v127
  v_cvt_pk_bf16_f32 v130, v72, v73
  v_cvt_pk_bf16_f32 v131, v74, v75
  v_lshlrev_b32 v124, 16, v128
  v_and_b32 v125, 0xffff0000, v128
  v_lshlrev_b32 v132, 16, v130
  v_and_b32 v133, 0xffff0000, v130
  v_lshlrev_b32 v126, 16, v129
  v_and_b32 v127, 0xffff0000, v129
  v_lshlrev_b32 v134, 16, v131
  v_and_b32 v135, 0xffff0000, v131
  v_add_f32 v124, v124, v132
  v_add_f32 v125, v125, v133
  v_add_f32 v126, v126, v134
  v_add_f32 v127, v127, v135
  v_cvt_pk_bf16_f32 v114, v124, v125
  v_cvt_pk_bf16_f32 v115, v126, v127
  ds_write_b64 v46, v[114:115] offset:2048
  v_lshlrev_b32 v124, 16, v116
  v_and_b32 v125, 0xffff0000, v116
  v_lshlrev_b32 v126, 16, v117
  v_and_b32 v127, 0xffff0000, v117
  v_mul_f32 v124, v124, v33
  v_mul_f32 v125, v125, v33
  v_mul_f32 v126, v126, v33
  v_mul_f32 v127, v127, v33
  v_cvt_pk_bf16_f32 v128, v124, v125
  v_cvt_pk_bf16_f32 v129, v126, v127
  v_cvt_pk_bf16_f32 v130, v76, v77
  v_cvt_pk_bf16_f32 v131, v78, v79
  v_lshlrev_b32 v124, 16, v128
  v_and_b32 v125, 0xffff0000, v128
  v_lshlrev_b32 v132, 16, v130
  v_and_b32 v133, 0xffff0000, v130
  v_lshlrev_b32 v126, 16, v129
  v_and_b32 v127, 0xffff0000, v129
  v_lshlrev_b32 v134, 16, v131
  v_and_b32 v135, 0xffff0000, v131
  v_add_f32 v124, v124, v132
  v_add_f32 v125, v125, v133
  v_add_f32 v126, v126, v134
  v_add_f32 v127, v127, v135
  v_cvt_pk_bf16_f32 v116, v124, v125
  v_cvt_pk_bf16_f32 v117, v126, v127
  ds_write_b64 v46, v[116:117] offset:2560
  v_lshlrev_b32 v124, 16, v118
  v_and_b32 v125, 0xffff0000, v118
  v_lshlrev_b32 v126, 16, v119
  v_and_b32 v127, 0xffff0000, v119
  v_mul_f32 v124, v124, v33
  v_mul_f32 v125, v125, v33
  v_mul_f32 v126, v126, v33
  v_mul_f32 v127, v127, v33
  v_cvt_pk_bf16_f32 v128, v124, v125
  v_cvt_pk_bf16_f32 v129, v126, v127
  v_cvt_pk_bf16_f32 v130, v80, v81
  v_cvt_pk_bf16_f32 v131, v82, v83
  v_lshlrev_b32 v124, 16, v128
  v_and_b32 v125, 0xffff0000, v128
  v_lshlrev_b32 v132, 16, v130
  v_and_b32 v133, 0xffff0000, v130
  v_lshlrev_b32 v126, 16, v129
  v_and_b32 v127, 0xffff0000, v129
  v_lshlrev_b32 v134, 16, v131
  v_and_b32 v135, 0xffff0000, v131
  v_add_f32 v124, v124, v132
  v_add_f32 v125, v125, v133
  v_add_f32 v126, v126, v134
  v_add_f32 v127, v127, v135
  v_cvt_pk_bf16_f32 v118, v124, v125
  v_cvt_pk_bf16_f32 v119, v126, v127
  ds_write_b64 v46, v[118:119] offset:3072
  v_lshlrev_b32 v124, 16, v120
  v_and_b32 v125, 0xffff0000, v120
  v_lshlrev_b32 v126, 16, v121
  v_and_b32 v127, 0xffff0000, v121
  v_mul_f32 v124, v124, v33
  v_mul_f32 v125, v125, v33
  v_mul_f32 v126, v126, v33
  v_mul_f32 v127, v127, v33
  v_cvt_pk_bf16_f32 v128, v124, v125
  v_cvt_pk_bf16_f32 v129, v126, v127
  v_cvt_pk_bf16_f32 v130, v84, v85
  v_cvt_pk_bf16_f32 v131, v86, v87
  v_lshlrev_b32 v124, 16, v128
  v_and_b32 v125, 0xffff0000, v128
  v_lshlrev_b32 v132, 16, v130
  v_and_b32 v133, 0xffff0000, v130
  v_lshlrev_b32 v126, 16, v129
  v_and_b32 v127, 0xffff0000, v129
  v_lshlrev_b32 v134, 16, v131
  v_and_b32 v135, 0xffff0000, v131
  v_add_f32 v124, v124, v132
  v_add_f32 v125, v125, v133
  v_add_f32 v126, v126, v134
  v_add_f32 v127, v127, v135
  v_cvt_pk_bf16_f32 v120, v124, v125
  v_cvt_pk_bf16_f32 v121, v126, v127
  ds_write_b64 v46, v[120:121] offset:3584
  v_lshlrev_b32 v124, 16, v122
  v_and_b32 v125, 0xffff0000, v122
  v_lshlrev_b32 v126, 16, v123
  v_and_b32 v127, 0xffff0000, v123
  v_mul_f32 v124, v124, v33
  v_mul_f32 v125, v125, v33
  v_mul_f32 v126, v126, v33
  v_mul_f32 v127, v127, v33
  v_cvt_pk_bf16_f32 v128, v124, v125
  v_cvt_pk_bf16_f32 v129, v126, v127
  v_cvt_pk_bf16_f32 v130, v88, v89
  v_cvt_pk_bf16_f32 v131, v90, v91
  v_lshlrev_b32 v124, 16, v128
  v_and_b32 v125, 0xffff0000, v128
  v_lshlrev_b32 v132, 16, v130
  v_and_b32 v133, 0xffff0000, v130
  v_lshlrev_b32 v126, 16, v129
  v_and_b32 v127, 0xffff0000, v129
  v_lshlrev_b32 v134, 16, v131
  v_and_b32 v135, 0xffff0000, v131
  v_add_f32 v124, v124, v132
  v_add_f32 v125, v125, v133
  v_add_f32 v126, v126, v134
  v_add_f32 v127, v127, v135
  v_cvt_pk_bf16_f32 v122, v124, v125
  v_cvt_pk_bf16_f32 v123, v126, v127
  ds_write_b64 v46, v[122:123] offset:4096
  s_waitcnt lgkmcnt(0)
  s_barrier
  v_lshlrev_b32 v6, 3, v0
  v_mul_u32_u24 v5, 7168, v0
  v_add_u32 v36, 512, v6
  ds_read_b64 v[8:9], v36
  v_add_u32 v36, 25088, v6
  ds_read_b64 v[10:11], v36
  v_add_u32 v36, 49664, v6
  ds_read_b64 v[12:13], v36
  v_add_u32 v36, 74240, v6
  ds_read_b64 v[14:15], v36
  s_waitcnt lgkmcnt(0)
  s_add_u32 s22, s21, 0
  s_add_u32 s23, s22, 3584
  v_perm_b32 v16, v10, v8, s24
  v_perm_b32 v17, v14, v12, s24
  buffer_store_dwordx2 v[16:17], v5, s[92:95], s22 offen offset:0
  v_perm_b32 v18, v10, v8, s25
  v_perm_b32 v19, v14, v12, s25
  buffer_store_dwordx2 v[18:19], v5, s[92:95], s22 offen offset:1792
  v_perm_b32 v20, v11, v9, s24
  v_perm_b32 v21, v15, v13, s24
  buffer_store_dwordx2 v[20:21], v5, s[92:95], s23 offen offset:0
  v_perm_b32 v22, v11, v9, s25
  v_perm_b32 v23, v15, v13, s25
  buffer_store_dwordx2 v[22:23], v5, s[92:95], s23 offen offset:1792
  v_add_u32 v36, 2560, v6
  ds_read_b64 v[8:9], v36
  v_add_u32 v36, 27136, v6
  ds_read_b64 v[10:11], v36
  v_add_u32 v36, 51712, v6
  ds_read_b64 v[12:13], v36
  v_add_u32 v36, 76288, v6
  ds_read_b64 v[14:15], v36
  s_waitcnt lgkmcnt(0)
  s_add_u32 s22, s21, 1835008
  s_add_u32 s23, s22, 3584
  v_perm_b32 v24, v10, v8, s24
  v_perm_b32 v25, v14, v12, s24
  buffer_store_dwordx2 v[24:25], v5, s[92:95], s22 offen offset:0
  v_perm_b32 v26, v10, v8, s25
  v_perm_b32 v27, v14, v12, s25
  buffer_store_dwordx2 v[26:27], v5, s[92:95], s22 offen offset:1792
  v_perm_b32 v28, v11, v9, s24
  v_perm_b32 v29, v15, v13, s24
  buffer_store_dwordx2 v[28:29], v5, s[92:95], s23 offen offset:0
  v_perm_b32 v30, v11, v9, s25
  v_perm_b32 v31, v15, v13, s25
  buffer_store_dwordx2 v[30:31], v5, s[92:95], s23 offen offset:1792
  s_branch wk_loop
wk_tok:
  s_sub_u32 s3, s3, 864
  s_and_b32 s18, s3, 3
  s_lshr_b32 s17, s3, 2
  s_cmp_lt_u32 s17, 8
  s_cbranch_scc1 wk_tokp
  s_sub_u32 s17, s17, 64
  s_cmp_ge_i32 s17, 56
  s_cbranch_scc1 wk_toko
  s_add_u32 s20, s17, 56
  s_lshr_b32 s17, s20, 1
  s_bitcmp0_b32 s20, 0
  s_cbranch_scc1 wk_toko
  s_add_u32 s17, s17, 8
wk_tokp:
  s_lshl_b32 s20, s18, 2
  s_add_u32 s20, s20, s16
  s_lshl_b32 s21, s17, 4
  s_add_u32 s21, s21, s20
  s_mul_i32 s21, s21, 28672
  s_add_u32 s21, s21, 12845056
  s_mul_i32 s23, s17, 28672
  s_add_u32 s23, s23, 73400320
  s_mul_i32 s24, s17, 7168
  s_add_u32 s24, s24, 88068096
  s_lshr_b32 s25, s17, 3
  s_lshl_b32 s25, s25, 4
  s_add_u32 s25, s25, s20
  s_lshl_b32 s25, s25, 7
  s_add_u32 s25, s25, 88545280
  v_mov_b32 v60, 0
  s_mov_b32 s30, 0
wp_wf:
  buffer_load_dword v61, v60, s[8:11], s25 offen sc1
  s_waitcnt vmcnt(0)
  v_cmp_ne_u32 vcc, 56, v61
  s_cbranch_vccz wp_wf_ok
  s_sleep 1
  s_cmp_ge_u32 s17, 61
  s_cbranch_scc1 wp_wf_bo
  s_sleep 4
  s_cmp_ge_u32 s17, 56
  s_cbranch_scc1 wp_wf_bo
  s_sleep 40
wp_wf_bo:
  s_add_u32 s30, s30, 1
  s_cmp_lt_u32 s30, 30000
  s_cbranch_scc1 wp_wf
  s_branch wp_abort
wp_wf_ok:
  s_add_u32 s22, s21, 0
  buffer_load_dwordx4 a[0:3], v2, s[8:11], s22 offen offset:0 sc1
  buffer_load_dwordx4 a[4:7], v2, s[8:11], s22 offen offset:1024 sc1
  buffer_load_dwordx4 a[8:11], v2, s[8:11], s22 offen offset:2048 sc1
  buffer_load_dwordx4 a[12:15], v2, s[8:11], s22 offen offset:3072 sc1
  s_add_u32 s22, s21, 4096
  buffer_load_dwordx4 a[16:19], v2, s[8:11], s22 offen offset:0 sc1
  buffer_load_dwordx4 a[20:23], v2, s[8:11], s22 offen offset:1024 sc1
  buffer_load_dwordx4 a[24:27], v2, s[8:11], s22 offen offset:2048 sc1
  buffer_load_dwordx4 a[28:31], v2, s[8:11], s22 offen offset:3072 sc1
  s_add_u32 s22, s21, 8192
  buffer_load_dwordx4 a[32:35], v2, s[8:11], s22 offen offset:0 sc1
  buffer_load_dwordx4 a[36:39], v2, s[8:11], s22 offen offset:1024 sc1
  buffer_load_dwordx4 a[40:43], v2, s[8:11], s22 offen offset:2048 sc1
  buffer_load_dwordx4 a[44:47], v2, s[8:11], s22 offen offset:3072 sc1
  s_add_u32 s22, s21, 12288
  buffer_load_dwordx4 a[48:51], v2, s[8:11], s22 offen offset:0 sc1
  buffer_load_dwordx4 a[52:55], v2, s[8:11], s22 offen offset:1024 sc1
  buffer_load_dwordx4 a[56:59], v2, s[8:11], s22 offen offset:2048 sc1
  buffer_load_dwordx4 a[60:63], v2, s[8:11], s22 offen offset:3072 sc1
  s_add_u32 s22, s21, 16384
  buffer_load_dwordx4 a[64:67], v2, s[8:11], s22 offen offset:0 sc1
  buffer_load_dwordx4 a[68:71], v2, s[8:11], s22 offen offset:1024 sc1
  buffer_load_dwordx4 a[72:75], v2, s[8:11], s22 offen offset:2048 sc1
  buffer_load_dwordx4 a[76:79], v2, s[8:11], s22 offen offset:3072 sc1
  s_add_u32 s22, s21, 20480
  buffer_load_dwordx4 a[80:83], v2, s[8:11], s22 offen offset:0 sc1
  buffer_load_dwordx4 a[84:87], v2, s[8:11], s22 offen offset:1024 sc1
  buffer_load_dwordx4 a[88:91], v2, s[8:11], s22 offen offset:2048 sc1
  buffer_load_dwordx4 a[92:95], v2, s[8:11], s22 offen offset:3072 sc1
  s_add_u32 s22, s21, 24576
  buffer_load_dwordx4 a[96:99], v2, s[8:11], s22 offen offset:0 sc1
  buffer_load_dwordx4 a[100:103], v2, s[8:11], s22 offen offset:1024 sc1
  buffer_load_dwordx4 a[104:107], v2, s[8:11], s22 offen offset:2048 sc1
  buffer_load_dwordx4 a[108:111], v2, s[8:11], s22 offen offset:3072 sc1
  s_add_u32 s22, s23, 0
  buffer_load_dwordx4 a[112:115], v2, s[8:11], s22 offen offset:0 sc1
  buffer_load_dwordx4 a[116:119], v2, s[8:11], s22 offen offset:1024 sc1
  buffer_load_dwordx4 a[120:123], v2, s[8:11], s22 offen offset:2048 sc1
  buffer_load_dwordx4 a[124:127], v2, s[8:11], s22 offen offset:3072 sc1
  s_add_u32 s22, s23, 4096
  buffer_load_dwordx4 a[128:131], v2, s[8:11], s22 offen offset:0 sc1
  buffer_load_dwordx4 a[132:135], v2, s[8:11], s22 offen offset:1024 sc1
  buffer_load_dwordx4 a[136:139], v2, s[8:11], s22 offen offset:2048 sc1
  buffer_load_dwordx4 a[140:143], v2, s[8:11], s22 offen offset:3072 sc1
  s_add_u32 s22, s23, 8192
  buffer_load_dwordx4 a[144:147], v2, s[8:11], s22 offen offset:0 sc1
  buffer_load_dwordx4 a[148:151], v2, s[8:11], s22 offen offset:1024 sc1
  buffer_load_dwordx4 a[152:155], v2, s[8:11], s22 offen offset:2048 sc1
  buffer_load_dwordx4 a[156:159], v2, s[8:11], s22 offen offset:3072 sc1
  s_add_u32 s22, s23, 12288
  buffer_load_dwordx4 a[160:163], v2, s[8:11], s22 offen offset:0 sc1
  buffer_load_dwordx4 a[164:167], v2, s[8:11], s22 offen offset:1024 sc1
  buffer_load_dwordx4 a[168:171], v2, s[8:11], s22 offen offset:2048 sc1
  buffer_load_dwordx4 a[172:175], v2, s[8:11], s22 offen offset:3072 sc1
  s_add_u32 s22, s23, 16384
  buffer_load_dwordx4 a[176:179], v2, s[8:11], s22 offen offset:0 sc1
  buffer_load_dwordx4 a[180:183], v2, s[8:11], s22 offen offset:1024 sc1
  buffer_load_dwordx4 a[184:187], v2, s[8:11], s22 offen offset:2048 sc1
  buffer_load_dwordx4 a[188:191], v2, s[8:11], s22 offen offset:3072 sc1
  s_add_u32 s22, s23, 20480
  buffer_load_dwordx4 a[192:195], v2, s[8:11], s22 offen offset:0 sc1
  buffer_load_dwordx4 a[196:199], v2, s[8:11], s22 offen offset:1024 sc1
  buffer_load_dwordx4 a[200:203], v2, s[8:11], s22 offen offset:2048 sc1
  buffer_load_dwordx4 a[204:207], v2, s[8:11], s22 offen offset:3072 sc1
  s_add_u32 s22, s23, 24576
  buffer_load_dwordx4 a[208:211], v2, s[8:11], s22 offen offset:0 sc1
  buffer_load_dwordx4 a[212:215], v2, s[8:11], s22 offen offset:1024 sc1
  buffer_load_dwordx4 a[216:219], v2, s[8:11], s22 offen offset:2048 sc1
  buffer_load_dwordx4 a[220:223], v2, s[8:11], s22 offen offset:3072 sc1
  v_lshl_add_u32 v5, v3, 2, 0
  v_cmp_le_u32 s[40:41], v5, v4
  v_lshl_add_u32 v5, v3, 2, 1
  v_cmp_le_u32 s[42:43], v5, v4
  v_lshl_add_u32 v5, v3, 2, 2
  v_cmp_le_u32 s[44:45], v5, v4
  v_lshl_add_u32 v5, v3, 2, 3
  v_cmp_le_u32 s[46:47], v5, v4
  v_cmp_gt_u32 s[48:49], 2, v3
  v_mov_b32 v6, 0xff800000
  s_waitcnt vmcnt(0)
  v_mfma_f32_16x16x32_bf16 v[8:11], a[112:115], a[0:3], 0
  v_mfma_f32_16x16x32_bf16 v[12:15], a[112:115], a[56:59], 0
  v_mfma_f32_16x16x32_bf16 v[16:19], a[168:171], a[56:59], 0
  v_mfma_f32_16x16x32_bf16 v[8:11], a[116:119], a[4:7], v[8:11]
  v_mfma_f32_16x16x32_bf16 v[12:15], a[116:119], a[60:63], v[12:15]
  v_mfma_f32_16x16x32_bf16 v[16:19], a[172:175], a[60:63], v[16:19]
  v_mfma_f32_16x16x32_bf16 v[8:11], a[120:123], a[8:11], v[8:11]
  v_mfma_f32_16x16x32_bf16 v[12:15], a[120:123], a[64:67], v[12:15]
  v_mfma_f32_16x16x32_bf16 v[16:19], a[176:179], a[64:67], v[16:19]
  v_mfma_f32_16x16x32_bf16 v[8:11], a[124:127], a[12:15], v[8:11]
  v_mfma_f32_16x16x32_bf16 v[12:15], a[124:127], a[68:71], v[12:15]
  v_mfma_f32_16x16x32_bf16 v[16:19], a[180:183], a[68:71], v[16:19]
  v_mfma_f32_16x16x32_bf16 v[8:11], a[128:131], a[16:19], v[8:11]
  v_mfma_f32_16x16x32_bf16 v[12:15], a[128:131], a[72:75], v[12:15]
  v_mfma_f32_16x16x32_bf16 v[16:19], a[184:187], a[72:75], v[16:19]
  v_mfma_f32_16x16x32_bf16 v[8:11], a[132:135], a[20:23], v[8:11]
  v_mfma_f32_16x16x32_bf16 v[12:15], a[132:135], a[76:79], v[12:15]
  v_mfma_f32_16x16x32_bf16 v[16:19], a[188:191], a[76:79], v[16:19]
  v_mfma_f32_16x16x32_bf16 v[8:11], a[136:139], a[24:27], v[8:11]
  v_mfma_f32_16x16x32_bf16 v[12:15], a[136:139], a[80:83], v[12:15]
  v_mfma_f32_16x16x32_bf16 v[16:19], a[192:195], a[80:83], v[16:19]
  v_mfma_f32_16x16x32_bf16 v[8:11], a[140:143], a[28:31], v[8:11]
  v_mfma_f32_16x16x32_bf16 v[12:15], a[140:143], a[84:87], v[12:15]
  v_mfma_f32_16x16x32_bf16 v[16:19], a[196:199], a[84:87], v[16:19]
  v_mfma_f32_16x16x32_bf16 v[8:11], a[144:147], a[32:35], v[8:11]
  v_mfma_f32_16x16x32_bf16 v[12:15], a[144:147], a[88:91], v[12:15]
  v_mfma_f32_16x16x32_bf16 v[16:19], a[200:203], a[88:91], v[16:19]
  v_mfma_f32_16x16x32_bf16 v[8:11], a[148:151], a[36:39], v[8:11]
  v_mfma_f32_16x16x32_bf16 v[12:15], a[148:151], a[92:95], v[12:15]
  v_mfma_f32_16x16x32_bf16 v[16:19], a[204:207], a[92:95], v[16:19]
  v_mfma_f32_16x16x32_bf16 v[8:11], a[152:155], a[40:43], v[8:11]
  v_mfma_f32_16x16x32_bf16 v[12:15], a[152:155], a[96:99], v[12:15]
  v_mfma_f32_16x16x32_bf16 v[16:19], a[208:211], a[96:99], v[16:19]
  v_mfma_f32_16x16x32_bf16 v[8:11], a[156:159], a[44:47], v[8:11]
  v_mfma_f32_16x16x32_bf16 v[12:15], a[156:159], a[100:103], v[12:15]
  v_mfma_f32_16x16x32_bf16 v[16:19], a[212:215], a[100:103], v[16:19]
  v_mfma_f32_16x16x32_bf16 v[8:11], a[160:163], a[48:51], v[8:11]
  v_mfma_f32_16x16x32_bf16 v[12:15], a[160:163], a[104:107], v[12:15]
  v_mfma_f32_16x16x32_bf16 v[16:19], a[216:219], a[104:107], v[16:19]
  v_mfma_f32_16x16x32_bf16 v[8:11], a[164:167], a[52:55], v[8:11]
  v_mfma_f32_16x16x32_bf16 v[12:15], a[164:167], a[108:111], v[12:15]
  v_mfma_f32_16x16x32_bf16 v[16:19], a[220:223], a[108:111], v[16:19]
  s_mul_i32 s22, s20, 448
  v_mov_b32 v62, s22
  s_mov_b32 s30, 0
wp_pm:
  s_cmp_ge_u32 s17, 64
  s_cbranch_scc1 wp_pf
  s_cmp_ge_u32 s17, 61
  s_cbranch_scc1 mp_41a
  v_mov_b32 v61, 0
  s_mov_b64 exec, 1
  buffer_atomic_or v61, v62, s[8:11], s24 offen sc0
  s_mov_b64 exec, -1
  s_branch mp_41b
mp_41a:
  buffer_load_dword v61, v62, s[8:11], s24 offen sc1
mp_41b:
  s_waitcnt vmcnt(0)
  v_cmp_eq_u32 vcc, -1, v61
  s_cbranch_vccnz wp_pr
wp_pf:
  s_add_u32 s22, s24, 4096
  buffer_load_dwordx4 v[64:67], v2, s[8:11], s24 offen offset:0 sc1
  buffer_load_dwordx4 v[68:71], v2, s[8:11], s24 offen offset:1024 sc1
  buffer_load_dwordx4 v[72:75], v2, s[8:11], s24 offen offset:2048 sc1
  buffer_load_dwordx4 v[76:79], v2, s[8:11], s24 offen offset:3072 sc1
  buffer_load_dwordx4 v[80:83], v2, s[8:11], s22 offen offset:0 sc1
  buffer_load_dwordx4 v[84:87], v2, s[8:11], s22 offen offset:1024 sc1
  buffer_load_dwordx4 v[88:91], v2, s[8:11], s22 offen offset:2048 sc1
  s_waitcnt vmcnt(0)
  v_max_u32 v61, v64, v65
  v_max3_u32 v61, v61, v66, v67
  v_max3_u32 v61, v61, v68, v69
  v_max3_u32 v61, v61, v70, v71
  v_max3_u32 v61, v61, v72, v73
  v_max3_u32 v61, v61, v74, v75
  v_max3_u32 v61, v61, v76, v77
  v_max3_u32 v61, v61, v78, v79
  v_max3_u32 v61, v61, v80, v81
  v_max3_u32 v61, v61, v82, v83
  v_max3_u32 v61, v61, v84, v85
  v_max3_u32 v61, v61, v86, v87
  v_max3_u32 v61, v61, v88, v89
  v_max3_u32 v61, v61, v90, v91
  v_cmp_eq_u32 vcc, -1, v61
  s_cbranch_vccz wp_pk
wp_pr:
  s_sleep 1
  s_cmp_ge_u32 s17, 61
  s_cbranch_scc1 wp_pm_bo
  s_sleep 4
  s_cmp_ge_u32 s17, 56
  s_cbranch_scc1 wp_pm_bo
  s_sleep 40
wp_pm_bo:
  s_add_u32 s30, s30, 1
  s_cmp_lt_u32 s30, 30000
  s_cbranch_scc1 wp_pm
  s_branch wp_abort
wp_pk:
  buffer_load_dword v250, v251, s[12:15], 0 offen sc1
  v_mfma_f32_16x16x32_bf16 v[20:23], v[64:67], a[0:3], 0
  v_mfma_f32_16x16x32_bf16 v[24:27], v[64:67], a[4:7], 0
  v_mfma_f32_16x16x32_bf16 v[28:31], v[64:67], a[56:59], 0
  v_mfma_f32_16x16x32_bf16 v[32:35], v[64:67], a[60:63], 0
  v_mfma_f32_16x16x32_bf16 v[20:23], v[68:71], a[8:11], v[20:23]
  v_mfma_f32_16x16x32_bf16 v[24:27], v[68:71], a[12:15], v[24:27]
  v_mfma_f32_16x16x32_bf16 v[28:31], v[68:71], a[64:67], v[28:31]
  v_mfma_f32_16x16x32_bf16 v[32:35], v[68:71], a[68:71], v[32:35]
  v_mfma_f32_16x16x32_bf16 v[20:23], v[72:75], a[16:19], v[20:23]
  v_mfma_f32_16x16x32_bf16 v[24:27], v[72:75], a[20:23], v[24:27]
  v_mfma_f32_16x16x32_bf16 v[28:31], v[72:75], a[72:75], v[28:31]
  v_mfma_f32_16x16x32_bf16 v[32:35], v[72:75], a[76:79], v[32:35]
  v_mfma_f32_16x16x32_bf16 v[20:23], v[76:79], a[24:27], v[20:23]
  v_mfma_f32_16x16x32_bf16 v[24:27], v[76:79], a[28:31], v[24:27]
  v_mfma_f32_16x16x32_bf16 v[28:31], v[76:79], a[80:83], v[28:31]
  v_mfma_f32_16x16x32_bf16 v[32:35], v[76:79], a[84:87], v[32:35]
  v_mfma_f32_16x16x32_bf16 v[20:23], v[80:83], a[32:35], v[20:23]
  v_mfma_f32_16x16x32_bf16 v[24:27], v[80:83], a[36:39], v[24:27]
  v_mfma_f32_16x16x32_bf16 v[28:31], v[80:83], a[88:91], v[28:31]
  v_mfma_f32_16x16x32_bf16 v[32:35], v[80:83], a[92:95], v[32:35]
  v_mfma_f32_16x16x32_bf16 v[20:23], v[84:87], a[40:43], v[20:23]
  v_mfma_f32_16x16x32_bf16 v[24:27], v[84:87], a[44:47], v[24:27]
  v_mfma_f32_16x16x32_bf16 v[28:31], v[84:87], a[96:99], v[28:31]
  v_mfma_f32_16x16x32_bf16 v[32:35], v[84:87], a[100:103], v[32:35]
  v_mfma_f32_16x16x32_bf16 v[20:23], v[88:91], a[48:51], v[20:23]
  v_mfma_f32_16x16x32_bf16 v[24:27], v[88:91], a[52:55], v[24:27]
  v_mfma_f32_16x16x32_bf16 v[28:31], v[88:91], a[104:107], v[28:31]
  v_mfma_f32_16x16x32_bf16 v[32:35], v[88:91], a[108:111], v[32:35]
  s_lshl_b32 s25, s17, 1
  s_mul_i32 s25, s25, 20480
  s_add_u32 s25, s25, 85446656
  s_lshl_b32 s26, s20, 10
  s_add_u32 s26, s26, s25
  s_lshl_b32 s27, s18, 10
  s_add_u32 s27, s27, s25
  s_lshr_b32 s28, s16, 1
  s_lshl_b32 s28, s28, 3
  s_add_u32 s27, s27, s28
  s_add_u32 s27, s27, 16384
  s_and_b32 s28, s16, 1
  s_cmp_eq_u32 s28, 0
  s_cselect_b32 s50, -1, 0
  s_cselect_b32 s51, 0, -1
  v_cndmask_b32 v8, v6, v8, s[40:41]
  v_cndmask_b32 v9, v6, v9, s[42:43]
  v_cndmask_b32 v10, v6, v10, s[44:45]
  v_cndmask_b32 v11, v6, v11, s[46:47]
  v_cndmask_b32 v20, v24, v20, s[48:49]
  v_cndmask_b32 v21, v25, v21, s[48:49]
  v_cndmask_b32 v22, v26, v22, s[48:49]
  v_cndmask_b32 v23, v27, v23, s[48:49]
  v_mov_b32 v24, v20
  v_mov_b32 v25, v21
  v_mov_b32 v26, v22
  v_mov_b32 v27, v23
  v_permlane32_swap_b32 v20, v24
  v_permlane32_swap_b32 v21, v25
  v_permlane32_swap_b32 v22, v26
  v_permlane32_swap_b32 v23, v27
  v_add_f32 v20, v20, v24
  v_add_f32 v21, v21, v25
  v_add_f32 v22, v22, v26
  v_add_f32 v23, v23, v27
  v_max3_f32 v40, v8, v9, v10
  v_max3_f32 v40, v40, v11, v20
  v_max3_f32 v40, v40, v21, v22
  v_max_f32 v40, v40, v23
  v_mov_b32 v41, v40
  s_nop 1
  v_permlane16_swap_b32 v40, v41
  v_max_f32 v40, v40, v41
  v_mov_b32 v41, v40
  s_nop 1
  v_permlane32_swap_b32 v40, v41
  v_max_f32 v40, v40, v41
  v_sub_f32 v8, v8, v40
  v_sub_f32 v9, v9, v40
  v_sub_f32 v10, v10, v40
  v_sub_f32 v11, v11, v40
  v_sub_f32 v20, v20, v40
  v_sub_f32 v21, v21, v40
  v_sub_f32 v22, v22, v40
  v_sub_f32 v23, v23, v40
  v_exp_f32 v8, v8
  v_exp_f32 v9, v9
  v_exp_f32 v10, v10
  v_exp_f32 v11, v11
  v_exp_f32 v20, v20
  v_exp_f32 v21, v21
  v_exp_f32 v22, v22
  v_exp_f32 v23, v23
  v_add_f32 v42, v20, v21
  v_add_f32 v43, v22, v23
  v_add_f32 v42, v42, v43
  v_mul_f32 v42, 0.5, v42
  v_add_f32 v42, v42, v8
  v_add_f32 v42, v42, v9
  v_add_f32 v42, v42, v10
  v_add_f32 v42, v42, v11
  v_mov_b32 v41, v42
  s_nop 1
  v_permlane16_swap_b32 v42, v41
  v_add_f32 v42, v42, v41
  v_mov_b32 v41, v42
  s_nop 1
  v_permlane32_swap_b32 v42, v41
  v_add_f32 v42, v42, v41
  v_rcp_f32 v42, v42
  s_nop 0
  v_mul_f32 v8, v8, v42
  v_mul_f32 v9, v9, v42
  v_mul_f32 v10, v10, v42
  v_mul_f32 v11, v11, v42
  v_mul_f32 v20, v20, v42
  v_mul_f32 v21, v21, v42
  v_mul_f32 v22, v22, v42
  v_mul_f32 v23, v23, v42
  v_cvt_pk_bf16_f32 v44, v8, v9
  v_cvt_pk_bf16_f32 v45, v10, v11
  v_mov_b32 v46, 0
  v_mov_b32 v47, 0
  v_cvt_pk_bf16_f32 v48, v20, v21
  v_cvt_pk_bf16_f32 v49, v22, v23
  v_min_u32 v44, -2, v44
  v_min_u32 v45, -2, v45
  v_min_u32 v46, -2, v46
  v_min_u32 v47, -2, v47
  v_min_u32 v48, -2, v48
  v_min_u32 v49, -2, v49
  buffer_store_dwordx4 v[44:47], v2, s[8:11], s26 offen sc1
  s_mov_b64 exec, s[50:51]
  buffer_store_dwordx2 v[48:49], v2, s[8:11], s27 offen sc1
  s_mov_b64 exec, -1
  s_add_u32 s26, s26, 20480
  s_add_u32 s27, s27, 20480
  v_cndmask_b32 v16, v6, v16, s[40:41]
  v_cndmask_b32 v17, v6, v17, s[42:43]
  v_cndmask_b32 v18, v6, v18, s[44:45]
  v_cndmask_b32 v19, v6, v19, s[46:47]
  v_cndmask_b32 v28, v32, v28, s[48:49]
  v_cndmask_b32 v29, v33, v29, s[48:49]
  v_cndmask_b32 v30, v34, v30, s[48:49]
  v_cndmask_b32 v31, v35, v31, s[48:49]
  v_mov_b32 v32, v28
  v_mov_b32 v33, v29
  v_mov_b32 v34, v30
  v_mov_b32 v35, v31
  v_permlane32_swap_b32 v28, v32
  v_permlane32_swap_b32 v29, v33
  v_permlane32_swap_b32 v30, v34
  v_permlane32_swap_b32 v31, v35
  v_add_f32 v28, v28, v32
  v_add_f32 v29, v29, v33
  v_add_f32 v30, v30, v34
  v_add_f32 v31, v31, v35
  v_max3_f32 v40, v12, v13, v14
  v_max3_f32 v40, v40, v15, v16
  v_max3_f32 v40, v40, v17, v18
  v_max3_f32 v40, v40, v19, v28
  v_max3_f32 v40, v40, v29, v30
  v_max_f32 v40, v40, v31
  v_mov_b32 v41, v40
  s_nop 1
  v_permlane16_swap_b32 v40, v41
  v_max_f32 v40, v40, v41
  v_mov_b32 v41, v40
  s_nop 1
  v_permlane32_swap_b32 v40, v41
  v_max_f32 v40, v40, v41
  v_sub_f32 v12, v12, v40
  v_sub_f32 v13, v13, v40
  v_sub_f32 v14, v14, v40
  v_sub_f32 v15, v15, v40
  v_sub_f32 v16, v16, v40
  v_sub_f32 v17, v17, v40
  v_sub_f32 v18, v18, v40
  v_sub_f32 v19, v19, v40
  v_sub_f32 v28, v28, v40
  v_sub_f32 v29, v29, v40
  v_sub_f32 v30, v30, v40
  v_sub_f32 v31, v31, v40
  v_exp_f32 v12, v12
  v_exp_f32 v13, v13
  v_exp_f32 v14, v14
  v_exp_f32 v15, v15
  v_exp_f32 v16, v16
  v_exp_f32 v17, v17
  v_exp_f32 v18, v18
  v_exp_f32 v19, v19
  v_exp_f32 v28, v28
  v_exp_f32 v29, v29
  v_exp_f32 v30, v30
  v_exp_f32 v31, v31
  v_add_f32 v42, v28, v29
  v_add_f32 v43, v30, v31
  v_add_f32 v42, v42, v43
  v_mul_f32 v42, 0.5, v42
  v_add_f32 v42, v42, v12
  v_add_f32 v42, v42, v13
  v_add_f32 v42, v42, v14
  v_add_f32 v42, v42, v15
  v_add_f32 v42, v42, v16
  v_add_f32 v42, v42, v17
  v_add_f32 v42, v42, v18
  v_add_f32 v42, v42, v19
  v_mov_b32 v41, v42
  s_nop 1
  v_permlane16_swap_b32 v42, v41
  v_add_f32 v42, v42, v41
  v_mov_b32 v41, v42
  s_nop 1
  v_permlane32_swap_b32 v42, v41
  v_add_f32 v42, v42, v41
  v_rcp_f32 v42, v42
  s_nop 0
  v_mul_f32 v12, v12, v42
  v_mul_f32 v13, v13, v42
  v_mul_f32 v14, v14, v42
  v_mul_f32 v15, v15, v42
  v_mul_f32 v16, v16, v42
  v_mul_f32 v17, v17, v42
  v_mul_f32 v18, v18, v42
  v_mul_f32 v19, v19, v42
  v_mul_f32 v28, v28, v42
  v_mul_f32 v29, v29, v42
  v_mul_f32 v30, v30, v42
  v_mul_f32 v31, v31, v42
  v_cvt_pk_bf16_f32 v52, v12, v13
  v_cvt_pk_bf16_f32 v53, v14, v15
  v_cvt_pk_bf16_f32 v54, v16, v17
  v_cvt_pk_bf16_f32 v55, v18, v19
  v_cvt_pk_bf16_f32 v56, v28, v29
  v_cvt_pk_bf16_f32 v57, v30, v31
  v_min_u32 v52, -2, v52
  v_min_u32 v53, -2, v53
  v_min_u32 v54, -2, v54
  v_min_u32 v55, -2, v55
  v_min_u32 v56, -2, v56
  v_min_u32 v57, -2, v57
  buffer_store_dwordx4 v[52:55], v2, s[8:11], s26 offen sc1
  s_mov_b64 exec, s[50:51]
  buffer_store_dwordx2 v[56:57], v2, s[8:11], s27 offen sc1
  s_mov_b64 exec, -1
  s_lshl_b32 s25, s17, 7
  s_add_u32 s25, s25, 88561664
  v_mov_b32 v5, 1
  v_mov_b32 v6, 0
  s_waitcnt vmcnt(0)
  s_mov_b64 exec, 1
  buffer_atomic_add v5, v6, s[8:11], s25 offen
  s_mov_b64 exec, -1
  s_branch wk_loop
wk_toko:
  s_lshl_b32 s20, s18, 2
  s_add_u32 s20, s20, s16
  s_mul_i32 s24, s20, 65
  s_add_u32 s24, s24, s17
  s_lshl_b32 s24, s24, 13
  s_add_u32 s24, s24, 76935168
  s_lshl_b32 s21, s20, 6
  s_add_u32 s21, s21, s17
  s_mul_i32 s21, s21, 28672
  s_add_u32 s21, s21, 42205184
  s_lshl_b32 s25, s17, 1
  s_mul_i32 s25, s25, 20480
  s_add_u32 s25, s25, 85446656
  v_lshrrev_b32 v8, 5, v1
  v_and_b32 v9, 31, v1
  v_min_u32 v5, 27, v9
  v_mad_u32_u24 v5, v8, 28, v5
  v_lshlrev_b32 v5, 4, v5
  v_lshrrev_b32 v10, 4, v9
  v_lshlrev_b32 v7, 10, v10
  v_lshl_add_u32 v7, v4, 4, v7
  v_lshl_add_u32 v7, v8, 3, v7
  v_mul_u32_u24 v6, 20480, v10
  v_lshl_add_u32 v6, v8, 8, v6
  v_lshl_add_u32 v6, v4, 4, v6
  s_lshr_b32 s26, s17, 3
  s_lshl_b32 s26, s26, 4
  s_add_u32 s26, s26, s20
  s_lshl_b32 s26, s26, 7
  s_add_u32 s26, s26, 88528896
  v_mov_b32 v60, 0
  s_mov_b32 s30, 0
wo_wv:
  buffer_load_dword v61, v60, s[8:11], s26 offen sc1
  s_waitcnt vmcnt(0)
  v_cmp_ne_u32 vcc, 56, v61
  s_cbranch_vccz wo_wv_ok
  s_sleep 1
  s_cmp_ge_u32 s17, 61
  s_cbranch_scc1 wo_wv_bo
  s_sleep 4
  s_cmp_ge_u32 s17, 56
  s_cbranch_scc1 wo_wv_bo
  s_sleep 40
wo_wv_bo:
  s_add_u32 s30, s30, 1
  s_cmp_lt_u32 s30, 30000
  s_cbranch_scc1 wo_wv
  s_branch wo_abort
wo_wv_ok:
  s_add_u32 s22, s21, 0
  buffer_load_dwordx4 a[0:3], v5, s[8:11], s22 offen offset:0 sc1
  buffer_load_dwordx4 a[4:7], v5, s[8:11], s22 offen offset:896 sc1
  buffer_load_dwordx4 a[8:11], v5, s[8:11], s22 offen offset:1792 sc1
  buffer_load_dwordx4 a[12:15], v5, s[8:11], s22 offen offset:2688 sc1
  s_add_u32 s22, s21, 3584
  buffer_load_dwordx4 a[16:19], v5, s[8:11], s22 offen offset:0 sc1
  buffer_load_dwordx4 a[20:23], v5, s[8:11], s22 offen offset:896 sc1
  buffer_load_dwordx4 a[24:27], v5, s[8:11], s22 offen offset:1792 sc1
  buffer_load_dwordx4 a[28:31], v5, s[8:11], s22 offen offset:2688 sc1
  s_add_u32 s22, s21, 7168
  buffer_load_dwordx4 a[32:35], v5, s[8:11], s22 offen offset:0 sc1
  buffer_load_dwordx4 a[36:39], v5, s[8:11], s22 offen offset:896 sc1
  buffer_load_dwordx4 a[40:43], v5, s[8:11], s22 offen offset:1792 sc1
  buffer_load_dwordx4 a[44:47], v5, s[8:11], s22 offen offset:2688 sc1
  s_add_u32 s22, s21, 10752
  buffer_load_dwordx4 a[48:51], v5, s[8:11], s22 offen offset:0 sc1
  buffer_load_dwordx4 a[52:55], v5, s[8:11], s22 offen offset:896 sc1
  buffer_load_dwordx4 a[56:59], v5, s[8:11], s22 offen offset:1792 sc1
  buffer_load_dwordx4 a[60:63], v5, s[8:11], s22 offen offset:2688 sc1
  s_add_u32 s22, s21, 14336
  buffer_load_dwordx4 a[64:67], v5, s[8:11], s22 offen offset:0 sc1
  buffer_load_dwordx4 a[68:71], v5, s[8:11], s22 offen offset:896 sc1
  buffer_load_dwordx4 a[72:75], v5, s[8:11], s22 offen offset:1792 sc1
  buffer_load_dwordx4 a[76:79], v5, s[8:11], s22 offen offset:2688 sc1
  s_add_u32 s22, s21, 17920
  buffer_load_dwordx4 a[80:83], v5, s[8:11], s22 offen offset:0 sc1
  buffer_load_dwordx4 a[84:87], v5, s[8:11], s22 offen offset:896 sc1
  buffer_load_dwordx4 a[88:91], v5, s[8:11], s22 offen offset:1792 sc1
  buffer_load_dwordx4 a[92:95], v5, s[8:11], s22 offen offset:2688 sc1
  s_add_u32 s22, s21, 21504
  buffer_load_dwordx4 a[96:99], v5, s[8:11], s22 offen offset:0 sc1
  buffer_load_dwordx4 a[100:103], v5, s[8:11], s22 offen offset:896 sc1
  buffer_load_dwordx4 a[104:107], v5, s[8:11], s22 offen offset:1792 sc1
  buffer_load_dwordx4 a[108:111], v5, s[8:11], s22 offen offset:2688 sc1
  s_add_u32 s22, s21, 25088
  buffer_load_dwordx4 a[112:115], v5, s[8:11], s22 offen offset:0 sc1
  buffer_load_dwordx4 a[116:119], v5, s[8:11], s22 offen offset:896 sc1
  buffer_load_dwordx4 a[120:123], v5, s[8:11], s22 offen offset:1792 sc1
  buffer_load_dwordx4 a[124:127], v5, s[8:11], s22 offen offset:2688 sc1
  s_cmp_ge_u32 s17, 61
  s_cbranch_scc1 wo_lm
  s_lshl_b32 s26, s17, 7
  s_add_u32 s26, s26, 88561664
  v_mov_b32 v60, 0
  s_mov_b32 s30, 0
wo_wp:
  buffer_load_dword v61, v60, s[8:11], s26 offen sc1
  s_waitcnt vmcnt(0)
  v_cmp_ne_u32 vcc, 16, v61
  s_cbranch_vccz wo_wp_ok
  s_sleep 2
  s_cmp_ge_u32 s17, 61
  s_cbranch_scc1 wo_wp_bo
  s_sleep 4
  s_cmp_ge_u32 s17, 56
  s_cbranch_scc1 wo_wp_bo
  s_sleep 40
wo_wp_bo:
  s_add_u32 s30, s30, 1
  s_cmp_lt_u32 s30, 30000
  s_cbranch_scc1 wo_wp
  s_branch wo_abort
wo_wp_ok:
  s_branch wo_lp
wo_lm:
  s_mul_i32 s26, s17, 7168
  s_add_u32 s26, s26, 88068096
  v_mov_b32 v60, 0
  s_mov_b32 s30, 0
wo_wm:
  buffer_load_dword v61, v60, s[8:11], s26 offen sc1
  s_waitcnt vmcnt(0)
  v_cmp_eq_u32 vcc, -1, v61
  s_cbranch_vccz wo_wm_ok
  s_sleep 2
  s_cmp_ge_u32 s17, 61
  s_cbranch_scc1 wo_wm_bo
  s_sleep 4
  s_cmp_ge_u32 s17, 56
  s_cbranch_scc1 wo_wm_bo
  s_sleep 40
wo_wm_bo:
  s_add_u32 s30, s30, 1
  s_cmp_lt_u32 s30, 30000
  s_cbranch_scc1 wo_wm
  s_branch wo_abort
wo_wm_ok:
wo_lp:
  s_mul_i32 s26, s16, 10240
  s_add_u32 s27, s25, s26
  v_add_u32 v11, s26, v2
  s_lshl_b32 s26, s20, 6
  s_add_u32 s26, s26, s17
  s_lshl_b32 s26, s26, 4
  s_add_u32 s26, s26, 88569856
  v_lshlrev_b32 v60, 2, v3
  s_mov_b32 s30, 0
wo_pl:
  s_add_u32 s22, s27, 0
  buffer_load_dwordx4 v[128:131], v2, s[8:11], s22 offen offset:0 sc1
  buffer_load_dwordx4 v[132:135], v2, s[8:11], s22 offen offset:1024 sc1
  buffer_load_dwordx4 v[136:139], v2, s[8:11], s22 offen offset:2048 sc1
  buffer_load_dwordx4 v[140:143], v2, s[8:11], s22 offen offset:3072 sc1
  s_add_u32 s22, s27, 4096
  buffer_load_dwordx4 v[144:147], v2, s[8:11], s22 offen offset:0 sc1
  buffer_load_dwordx4 v[148:151], v2, s[8:11], s22 offen offset:1024 sc1
  buffer_load_dwordx4 v[152:155], v2, s[8:11], s22 offen offset:2048 sc1
  buffer_load_dwordx4 v[156:159], v2, s[8:11], s22 offen offset:3072 sc1
  s_add_u32 s22, s27, 8192
  buffer_load_dwordx4 v[160:163], v2, s[8:11], s22 offen offset:0 sc1
  buffer_load_dwordx4 v[164:167], v2, s[8:11], s22 offen offset:1024 sc1
  buffer_load_dword v61, v60, s[8:11], s26 offen sc1
  s_waitcnt vmcnt(1)
  v_max_u32 v62, v128, v129
  v_max3_u32 v62, v62, v130, v131
  v_max3_u32 v62, v62, v132, v133
  v_max3_u32 v62, v62, v134, v135
  v_max3_u32 v62, v62, v136, v137
  v_max3_u32 v62, v62, v138, v139
  v_max3_u32 v62, v62, v140, v141
  v_max3_u32 v62, v62, v142, v143
  v_max3_u32 v62, v62, v144, v145
  v_max3_u32 v62, v62, v146, v147
  v_max3_u32 v62, v62, v148, v149
  v_max3_u32 v62, v62, v150, v151
  v_max3_u32 v62, v62, v152, v153
  v_max3_u32 v62, v62, v154, v155
  v_max3_u32 v62, v62, v156, v157
  v_max3_u32 v62, v62, v158, v159
  v_max3_u32 v62, v62, v160, v161
  v_max3_u32 v62, v62, v162, v163
  v_max3_u32 v62, v62, v164, v165
  v_max3_u32 v62, v62, v166, v167
  v_cmp_eq_u32 vcc, -1, v62
  s_cbranch_vccz wo_pk
  s_add_u32 s30, s30, 1
  s_cmp_lt_u32 s30, 30000
  s_cbranch_scc1 wo_pl
  s_branch wo_abort
wo_pk:
  ds_write_b128 v11, v[128:131] offset:0
  ds_write_b128 v11, v[132:135] offset:1024
  ds_write_b128 v11, v[136:139] offset:2048
  ds_write_b128 v11, v[140:143] offset:3072
  ds_write_b128 v11, v[144:147] offset:4096
  ds_write_b128 v11, v[148:151] offset:5120
  ds_write_b128 v11, v[152:155] offset:6144
  ds_write_b128 v11, v[156:159] offset:7168
  ds_write_b128 v11, v[160:163] offset:8192
  ds_write_b128 v11, v[164:167] offset:9216
  s_waitcnt vmcnt(0)
  v_cmp_ne_u32 vcc, 1, v61
  s_mov_b32 s28, 0
  s_cbranch_vccnz wo_nt
  s_add_u32 s22, s24, 0
  buffer_load_dwordx2 v[28:29], v7, s[8:11], s22 offen offset:0 sc1
  buffer_load_dwordx2 v[30:31], v7, s[8:11], s22 offen offset:512 sc1
  buffer_load_dwordx2 v[32:33], v7, s[8:11], s22 offen offset:256 sc1
  buffer_load_dwordx2 v[34:35], v7, s[8:11], s22 offen offset:768 sc1
  buffer_load_dwordx2 v[36:37], v7, s[8:11], s22 offen offset:2048 sc1
  buffer_load_dwordx2 v[38:39], v7, s[8:11], s22 offen offset:2560 sc1
  buffer_load_dwordx2 v[40:41], v7, s[8:11], s22 offen offset:2304 sc1
  buffer_load_dwordx2 v[42:43], v7, s[8:11], s22 offen offset:2816 sc1
  s_add_u32 s22, s24, 4096
  buffer_load_dwordx2 v[44:45], v7, s[8:11], s22 offen offset:0 sc1
  buffer_load_dwordx2 v[46:47], v7, s[8:11], s22 offen offset:512 sc1
  buffer_load_dwordx2 v[48:49], v7, s[8:11], s22 offen offset:256 sc1
  buffer_load_dwordx2 v[50:51], v7, s[8:11], s22 offen offset:768 sc1
  buffer_load_dwordx2 v[52:53], v7, s[8:11], s22 offen offset:2048 sc1
  buffer_load_dwordx2 v[54:55], v7, s[8:11], s22 offen offset:2560 sc1
  buffer_load_dwordx2 v[56:57], v7, s[8:11], s22 offen offset:2304 sc1
  buffer_load_dwordx2 v[58:59], v7, s[8:11], s22 offen offset:2816 sc1
  s_mov_b32 s28, 1
wo_nt:
  buffer_load_dword v250, v251, s[12:15], 0 offen sc1
  s_waitcnt lgkmcnt(0)
  s_barrier
  buffer_load_dword v61, v60, s[8:11], s26 offen sc1
  ds_read_b128 v[64:67], v6 offset:0
  ds_read_b128 v[68:71], v6 offset:512
  ds_read_b128 v[72:75], v6 offset:1024
  ds_read_b128 v[76:79], v6 offset:1536
  ds_read_b128 v[80:83], v6 offset:2048
  ds_read_b128 v[84:87], v6 offset:2560
  ds_read_b128 v[88:91], v6 offset:3072
  s_waitcnt lgkmcnt(6)
  v_mfma_f32_32x32x16_bf16 v[12:27], a[0:3], v[64:67], 0
  ds_read_b128 v[92:95], v6 offset:3584
  s_waitcnt lgkmcnt(6)
  v_mfma_f32_32x32x16_bf16 v[12:27], a[4:7], v[68:71], v[12:27]
  ds_read_b128 v[64:67], v6 offset:4096
  s_waitcnt lgkmcnt(6)
  v_mfma_f32_32x32x16_bf16 v[12:27], a[8:11], v[72:75], v[12:27]
  ds_read_b128 v[68:71], v6 offset:4608
  s_waitcnt lgkmcnt(6)
  v_mfma_f32_32x32x16_bf16 v[12:27], a[12:15], v[76:79], v[12:27]
  ds_read_b128 v[72:75], v6 offset:5120
  s_waitcnt lgkmcnt(6)
  v_mfma_f32_32x32x16_bf16 v[12:27], a[16:19], v[80:83], v[12:27]
  ds_read_b128 v[76:79], v6 offset:5632
  s_waitcnt lgkmcnt(6)
  v_mfma_f32_32x32x16_bf16 v[12:27], a[20:23], v[84:87], v[12:27]
  ds_read_b128 v[80:83], v6 offset:6144
  s_waitcnt lgkmcnt(6)
  v_mfma_f32_32x32x16_bf16 v[12:27], a[24:27], v[88:91], v[12:27]
  ds_read_b128 v[84:87], v6 offset:6656
  s_waitcnt lgkmcnt(6)
  v_mfma_f32_32x32x16_bf16 v[12:27], a[28:31], v[92:95], v[12:27]
  ds_read_b128 v[88:91], v6 offset:7168
  s_waitcnt lgkmcnt(6)
  v_mfma_f32_32x32x16_bf16 v[12:27], a[32:35], v[64:67], v[12:27]
  ds_read_b128 v[92:95], v6 offset:7680
  s_waitcnt lgkmcnt(6)
  v_mfma_f32_32x32x16_bf16 v[12:27], a[36:39], v[68:71], v[12:27]
  ds_read_b128 v[64:67], v6 offset:8192
  s_waitcnt lgkmcnt(6)
  v_mfma_f32_32x32x16_bf16 v[12:27], a[40:43], v[72:75], v[12:27]
  ds_read_b128 v[68:71], v6 offset:8704
  s_waitcnt lgkmcnt(6)
  v_mfma_f32_32x32x16_bf16 v[12:27], a[44:47], v[76:79], v[12:27]
  ds_read_b128 v[72:75], v6 offset:9216
  s_waitcnt lgkmcnt(6)
  v_mfma_f32_32x32x16_bf16 v[12:27], a[48:51], v[80:83], v[12:27]
  ds_read_b128 v[76:79], v6 offset:9728
  s_waitcnt lgkmcnt(6)
  v_mfma_f32_32x32x16_bf16 v[12:27], a[52:55], v[84:87], v[12:27]
  ds_read_b128 v[80:83], v6 offset:10240
  s_waitcnt lgkmcnt(6)
  v_mfma_f32_32x32x16_bf16 v[12:27], a[56:59], v[88:91], v[12:27]
  ds_read_b128 v[84:87], v6 offset:10752
  s_waitcnt lgkmcnt(6)
  v_mfma_f32_32x32x16_bf16 v[12:27], a[60:63], v[92:95], v[12:27]
  ds_read_b128 v[88:91], v6 offset:11264
  s_waitcnt lgkmcnt(6)
  v_mfma_f32_32x32x16_bf16 v[12:27], a[64:67], v[64:67], v[12:27]
  ds_read_b128 v[92:95], v6 offset:11776
  s_waitcnt lgkmcnt(6)
  v_mfma_f32_32x32x16_bf16 v[12:27], a[68:71], v[68:71], v[12:27]
  ds_read_b128 v[64:67], v6 offset:12288
  s_waitcnt lgkmcnt(6)
  v_mfma_f32_32x32x16_bf16 v[12:27], a[72:75], v[72:75], v[12:27]
  ds_read_b128 v[68:71], v6 offset:12800
  s_waitcnt lgkmcnt(6)
  v_mfma_f32_32x32x16_bf16 v[12:27], a[76:79], v[76:79], v[12:27]
  s_cmp_lg_u32 s28, 0
  s_cbranch_scc1 wo_h2
  s_waitcnt vmcnt(0)
  v_cmp_ne_u32 vcc, 1, v61
  s_cbranch_vccnz wo_h2
  s_add_u32 s22, s24, 0
  buffer_load_dwordx2 v[28:29], v7, s[8:11], s22 offen offset:0 sc1
  buffer_load_dwordx2 v[30:31], v7, s[8:11], s22 offen offset:512 sc1
  buffer_load_dwordx2 v[32:33], v7, s[8:11], s22 offen offset:256 sc1
  buffer_load_dwordx2 v[34:35], v7, s[8:11], s22 offen offset:768 sc1
  buffer_load_dwordx2 v[36:37], v7, s[8:11], s22 offen offset:2048 sc1
  buffer_load_dwordx2 v[38:39], v7, s[8:11], s22 offen offset:2560 sc1
  buffer_load_dwordx2 v[40:41], v7, s[8:11], s22 offen offset:2304 sc1
  buffer_load_dwordx2 v[42:43], v7, s[8:11], s22 offen offset:2816 sc1
  s_add_u32 s22, s24, 4096
  buffer_load_dwordx2 v[44:45], v7, s[8:11], s22 offen offset:0 sc1
  buffer_load_dwordx2 v[46:47], v7, s[8:11], s22 offen offset:512 sc1
  buffer_load_dwordx2 v[48:49], v7, s[8:11], s22 offen offset:256 sc1
  buffer_load_dwordx2 v[50:51], v7, s[8:11], s22 offen offset:768 sc1
  buffer_load_dwordx2 v[52:53], v7, s[8:11], s22 offen offset:2048 sc1
  buffer_load_dwordx2 v[54:55], v7, s[8:11], s22 offen offset:2560 sc1
  buffer_load_dwordx2 v[56:57], v7, s[8:11], s22 offen offset:2304 sc1
  buffer_load_dwordx2 v[58:59], v7, s[8:11], s22 offen offset:2816 sc1
  s_mov_b32 s28, 1
wo_h2:
  ds_read_b128 v[72:75], v6 offset:13312
  s_waitcnt lgkmcnt(6)
  v_mfma_f32_32x32x16_bf16 v[12:27], a[80:83], v[80:83], v[12:27]
  ds_read_b128 v[76:79], v6 offset:13824
  s_waitcnt lgkmcnt(6)
  v_mfma_f32_32x32x16_bf16 v[12:27], a[84:87], v[84:87], v[12:27]
  ds_read_b128 v[80:83], v6 offset:14336
  s_waitcnt lgkmcnt(6)
  v_mfma_f32_32x32x16_bf16 v[12:27], a[88:91], v[88:91], v[12:27]
  ds_read_b128 v[84:87], v6 offset:14848
  s_waitcnt lgkmcnt(6)
  v_mfma_f32_32x32x16_bf16 v[12:27], a[92:95], v[92:95], v[12:27]
  ds_read_b128 v[88:91], v6 offset:15360
  s_waitcnt lgkmcnt(6)
  v_mfma_f32_32x32x16_bf16 v[12:27], a[96:99], v[64:67], v[12:27]
  ds_read_b128 v[92:95], v6 offset:15872
  s_waitcnt lgkmcnt(6)
  v_mfma_f32_32x32x16_bf16 v[12:27], a[100:103], v[68:71], v[12:27]
  ds_read_b128 v[64:67], v6 offset:16384
  s_waitcnt lgkmcnt(6)
  v_mfma_f32_32x32x16_bf16 v[12:27], a[104:107], v[72:75], v[12:27]
  ds_read_b128 v[68:71], v6 offset:16896
  s_waitcnt lgkmcnt(6)
  v_mfma_f32_32x32x16_bf16 v[12:27], a[108:111], v[76:79], v[12:27]
  ds_read_b128 v[72:75], v6 offset:17408
  s_waitcnt lgkmcnt(6)
  v_mfma_f32_32x32x16_bf16 v[12:27], a[112:115], v[80:83], v[12:27]
  ds_read_b128 v[76:79], v6 offset:17920
  s_waitcnt lgkmcnt(6)
  v_mfma_f32_32x32x16_bf16 v[12:27], a[116:119], v[84:87], v[12:27]
  ds_read_b128 v[80:83], v6 offset:18432
  s_waitcnt lgkmcnt(6)
  v_mfma_f32_32x32x16_bf16 v[12:27], a[120:123], v[88:91], v[12:27]
  ds_read_b128 v[84:87], v6 offset:18944
  s_waitcnt lgkmcnt(6)
  v_mfma_f32_32x32x16_bf16 v[12:27], a[124:127], v[92:95], v[12:27]
  s_cmp_lg_u32 s28, 0
  s_cbranch_scc1 wo_ht
  v_lshlrev_b32 v60, 2, v3
  s_mov_b32 s30, 0
wo_wt:
  buffer_load_dword v61, v60, s[8:11], s26 offen sc1
  s_waitcnt vmcnt(0)
  v_cmp_ne_u32 vcc, 1, v61
  s_cbranch_vccz wo_wt_ok
  s_sleep 1
  s_cmp_ge_u32 s17, 61
  s_cbranch_scc1 wo_wt_bo
  s_sleep 4
  s_cmp_ge_u32 s17, 56
  s_cbranch_scc1 wo_wt_bo
  s_sleep 40
wo_wt_bo:
  s_add_u32 s30, s30, 1
  s_cmp_lt_u32 s30, 30000
  s_cbranch_scc1 wo_wt
  s_branch wo_abort
wo_wt_ok:
  s_add_u32 s22, s24, 0
  buffer_load_dwordx2 v[28:29], v7, s[8:11], s22 offen offset:0 sc1
  buffer_load_dwordx2 v[30:31], v7, s[8:11], s22 offen offset:512 sc1
  buffer_load_dwordx2 v[32:33], v7, s[8:11], s22 offen offset:256 sc1
  buffer_load_dwordx2 v[34:35], v7, s[8:11], s22 offen offset:768 sc1
  buffer_load_dwordx2 v[36:37], v7, s[8:11], s22 offen offset:2048 sc1
  buffer_load_dwordx2 v[38:39], v7, s[8:11], s22 offen offset:2560 sc1
  buffer_load_dwordx2 v[40:41], v7, s[8:11], s22 offen offset:2304 sc1
  buffer_load_dwordx2 v[42:43], v7, s[8:11], s22 offen offset:2816 sc1
  s_add_u32 s22, s24, 4096
  buffer_load_dwordx2 v[44:45], v7, s[8:11], s22 offen offset:0 sc1
  buffer_load_dwordx2 v[46:47], v7, s[8:11], s22 offen offset:512 sc1
  buffer_load_dwordx2 v[48:49], v7, s[8:11], s22 offen offset:256 sc1
  buffer_load_dwordx2 v[50:51], v7, s[8:11], s22 offen offset:768 sc1
  buffer_load_dwordx2 v[52:53], v7, s[8:11], s22 offen offset:2048 sc1
  buffer_load_dwordx2 v[54:55], v7, s[8:11], s22 offen offset:2560 sc1
  buffer_load_dwordx2 v[56:57], v7, s[8:11], s22 offen offset:2304 sc1
  buffer_load_dwordx2 v[58:59], v7, s[8:11], s22 offen offset:2816 sc1
wo_ht:
  ds_read_b128 v[88:91], v6 offset:19456
  s_waitcnt lgkmcnt(6) vmcnt(0)
  v_mfma_f32_32x32x16_bf16 v[12:27], v[28:31], v[64:67], v[12:27]
  ds_read_b128 v[92:95], v6 offset:19968
  s_waitcnt lgkmcnt(6)
  v_mfma_f32_32x32x16_bf16 v[12:27], v[32:35], v[68:71], v[12:27]
  s_waitcnt lgkmcnt(5)
  v_mfma_f32_32x32x16_bf16 v[12:27], v[36:39], v[72:75], v[12:27]
  s_waitcnt lgkmcnt(4)
  v_mfma_f32_32x32x16_bf16 v[12:27], v[40:43], v[76:79], v[12:27]
  s_waitcnt lgkmcnt(3)
  v_mfma_f32_32x32x16_bf16 v[12:27], v[44:47], v[80:83], v[12:27]
  s_waitcnt lgkmcnt(2)
  v_mfma_f32_32x32x16_bf16 v[12:27], v[48:51], v[84:87], v[12:27]
  s_waitcnt lgkmcnt(1)
  v_mfma_f32_32x32x16_bf16 v[12:27], v[52:55], v[88:91], v[12:27]
  s_waitcnt lgkmcnt(0)
  v_mfma_f32_32x32x16_bf16 v[12:27], v[56:59], v[92:95], v[12:27]
  v_mul_u32_u24 v9, 240, v9
  s_movk_i32 s23, 240
  v_lshl_add_u32 v8, v8, 3, v9
  s_mul_i32 s22, s16, 56
  v_add_u32 v8, s22, v8
  v_min_u32 v11, 223, v0
  v_mul_u32_u24 v9, 4682, v11
  v_lshrrev_b32 v9, 16, v9
  v_mul_u32_u24 v10, 14, v9
  v_sub_u32 v10, v11, v10
  v_lshlrev_b32 v10, 4, v10
  v_mad_u32_u24 v11, v9, s23, v10
  v_mul_u32_u24 v9, 1792, v9
  v_add_u32 v10, v9, v10
  s_mul_i32 s26, s17, 57344
  s_mul_i32 s22, s18, 224
  s_add_u32 s26, s26, s22
  s_add_u32 s26, s26, 896
  s_add_u32 s27, s26, 28672
  v_cvt_pk_bf16_f32 v96, v12, v13
  v_cvt_pk_bf16_f32 v97, v14, v15
  ds_write_b64 v8, v[96:97] offset:49152
  v_cvt_pk_bf16_f32 v98, v16, v17
  v_cvt_pk_bf16_f32 v99, v18, v19
  ds_write_b64 v8, v[98:99] offset:49168
  v_cvt_pk_bf16_f32 v100, v20, v21
  v_cvt_pk_bf16_f32 v101, v22, v23
  ds_write_b64 v8, v[100:101] offset:49184
  v_cvt_pk_bf16_f32 v102, v24, v25
  v_cvt_pk_bf16_f32 v103, v26, v27
  s_mov_b32 exec_hi, 0
  ds_write_b64 v8, v[102:103] offset:49200
  s_mov_b64 exec, -1
  s_waitcnt lgkmcnt(0)
  s_barrier
  ds_read_b128 v[104:107], v11 offset:49152
  ds_read_b128 v[108:111], v11 offset:52992
  s_cmp_lg_u32 s16, 3
  s_cselect_b32 exec_hi, -1, 0
  s_waitcnt lgkmcnt(1)
  buffer_store_dwordx4 v[104:107], v10, s[92:95], s26 offen
  s_waitcnt lgkmcnt(0)
  buffer_store_dwordx4 v[108:111], v10, s[92:95], s27 offen
  s_mov_b64 exec, -1
  v_readfirstlane_b32 s22, v250
  s_cmp_ge_u32 s22, 1376
  s_cbranch_scc1 ch_end
  s_branch wk_loop
wp_abort:
wo_abort:
  s_branch cA_abort
ch_end:
  s_endpgm

.section .rodata,"a"
.p2align 6
.amdhsa_kernel main_kernel
  .amdhsa_next_free_vgpr 512
  .amdhsa_next_free_sgpr 102
  .amdhsa_accum_offset 256
  .amdhsa_group_segment_fixed_size 0
  .amdhsa_kernarg_size 136
  .amdhsa_user_sgpr_count 2
  .amdhsa_user_sgpr_kernarg_segment_ptr 1
  .amdhsa_system_sgpr_workgroup_id_x 1
.end_amdhsa_kernel
```

```asm
; @launch kernel=main_kernel grid=(256,1,1) block=(256,1,1) lds=163840
.amdgcn_target "amdgcn-amd-amdhsa--gfx950"
.text
.globl main_kernel
.p2align 8
.type main_kernel,@function
main_kernel:
  s_cmp_ge_u32 s2, 256
  s_cbranch_scc1 ch_end
  s_load_dwordx4 s[4:7], s[0:1], 120
  s_load_dwordx2 s[92:93], s[0:1], 112
  s_load_dwordx8 s[36:43], s[0:1], 56
  s_load_dwordx4 s[44:47], s[0:1], 88
  s_memrealtime s[88:89]
  s_getpc_b64 s[98:99]
pf_main_kernel_1:
  s_sub_u32 s98, s98, pf_main_kernel_1-main_kernel
  s_subb_u32 s99, s99, 0
  s_lshr_b32 s20, s2, 3
  v_lshl_add_u32 v60, v0, 5, s20
  v_lshlrev_b32 v60, 7, v60
  v_min_u32 v60, ch_end-main_kernel-4, v60
  v_cmp_gt_u32 vcc, 32, v0
  s_and_saveexec_b64 s[22:23], vcc
  s_cbranch_execz pf_main_kernel_1_n
  global_load_dword v62, v60, s[98:99]
pf_main_kernel_1_n:
  s_mov_b64 exec, -1
  s_getreg_b32 s67, hwreg(HW_REG_XCC_ID)
  s_and_b32 s67, s67, 7
  v_lshrrev_b32 v1, 6, v0
  s_nop 0
  v_readfirstlane_b32 s16, v1
  s_mov_b32 s66, 0
  s_mov_b32 s68, 0
  s_mov_b32 s69, 0
  s_mov_b32 s96, 0
  s_mov_b32 s97, 0
  s_mov_b32 s101, 0x5eed0000
  s_sub_u32 s20, s67, 0
  s_lshr_b32 s21, s2, 3
  s_and_b32 s20, s20, 7
  s_lshl_b32 s3, s20, 5
  s_add_u32 s3, s3, s21
  s_waitcnt lgkmcnt(0)
  s_mov_b32 s8, s6
  s_and_b32 s9, s7, 0xffff
  s_mov_b32 s10, 0x10000000
  s_mov_b32 s11, 0x20000
  s_mov_b32 s12, s4
  s_and_b32 s13, s5, 0xffff
  s_mov_b32 s14, 256
  s_mov_b32 s15, 0x20000
  s_or_b32 s88, s88, 1
  s_and_b32 s93, s93, 0xffff
  s_mov_b32 s94, 3670016
  s_mov_b32 s95, 0x20000
m_start:
  s_cmp_ge_u32 s3, 32
  s_cbranch_scc1 m_bjob
  v_and_b32 v1, 63, v0
  v_lshlrev_b32 v2, 4, v1
  v_lshrrev_b32 v116, 4, v1
  v_and_b32 v117, 15, v1
  v_mov_b32 v3, 0x4444
  v_mov_b32 v118, 0xeeee
  v_cmp_lt_u32 vcc, 7, v117
  s_nop 1
  v_cndmask_b32 v3, v3, v118, vcc
  s_and_b32 s17, s3, 15
  s_cmp_ge_u32 s3, 16
  s_cbranch_scc1 m_val
  s_mov_b32 s60, s42
  s_and_b32 s61, s43, 0xffff
  s_mov_b32 s62, 3670016
  s_mov_b32 s63, 0x20000
  v_lshrrev_b32 v24, 5, v1
  v_and_b32 v25, 31, v1
  s_lshl_b32 s26, s17, 9
  s_lshl_b32 s25, s16, 12
  v_xor_b32 v26, v25, v24
  v_lshlrev_b32 v26, 4, v26
  v_lshl_add_u32 v26, v24, 13, v26
  v_xor_b32 v100, 0, v26
  v_xor_b32 v101, 0, v26
  v_add_u32 v101, 15360, v101
  v_xor_b32 v102, 32, v26
  v_add_u32 v102, 30720, v102
  v_xor_b32 v103, 32, v26
  v_add_u32 v103, 46080, v103
  s_lshl_b32 s23, s16, 19
  s_add_u32 s23, s23, s26
  s_add_u32 m0, s25, 16384
  s_nop 0
  buffer_load_dwordx4 v100, s[60:63], s23 offen offset:0 lds
  buffer_load_dwordx4 v101, s[60:63], s23 offen offset:1024 lds
  buffer_load_dwordx4 v102, s[60:63], s23 offen offset:2048 lds
  buffer_load_dwordx4 v103, s[60:63], s23 offen offset:3072 lds
  s_add_u32 m0, s25, 32768
  s_add_u32 s23, s23, 65536
  buffer_load_dwordx4 v100, s[60:63], s23 offen offset:0 lds
  buffer_load_dwordx4 v101, s[60:63], s23 offen offset:1024 lds
  buffer_load_dwordx4 v102, s[60:63], s23 offen offset:2048 lds
  buffer_load_dwordx4 v103, s[60:63], s23 offen offset:3072 lds
  v_xor_b32 v100, 64, v100
  v_xor_b32 v101, 64, v101
  v_xor_b32 v102, 64, v102
  v_xor_b32 v103, 64, v103
  s_add_u32 m0, s25, 49152
  s_add_u32 s23, s23, 65536
  buffer_load_dwordx4 v100, s[60:63], s23 offen offset:0 lds
  buffer_load_dwordx4 v101, s[60:63], s23 offen offset:1024 lds
  buffer_load_dwordx4 v102, s[60:63], s23 offen offset:2048 lds
  buffer_load_dwordx4 v103, s[60:63], s23 offen offset:3072 lds
  s_add_u32 m0, s25, 65536
  s_add_u32 s23, s23, 65536
  buffer_load_dwordx4 v100, s[60:63], s23 offen offset:0 lds
  buffer_load_dwordx4 v101, s[60:63], s23 offen offset:1024 lds
  buffer_load_dwordx4 v102, s[60:63], s23 offen offset:2048 lds
  buffer_load_dwordx4 v103, s[60:63], s23 offen offset:3072 lds
  v_xor_b32 v100, 192, v100
  v_xor_b32 v101, 192, v101
  v_xor_b32 v102, 192, v102
  v_xor_b32 v103, 192, v103
  s_add_u32 m0, s25, 81920
  s_add_u32 s23, s23, 65536
  buffer_load_dwordx4 v100, s[60:63], s23 offen offset:0 lds
  buffer_load_dwordx4 v101, s[60:63], s23 offen offset:1024 lds
  buffer_load_dwordx4 v102, s[60:63], s23 offen offset:2048 lds
  buffer_load_dwordx4 v103, s[60:63], s23 offen offset:3072 lds
  s_add_u32 m0, s25, 98304
  s_add_u32 s23, s23, 65536
  buffer_load_dwordx4 v100, s[60:63], s23 offen offset:0 lds
  buffer_load_dwordx4 v101, s[60:63], s23 offen offset:1024 lds
  buffer_load_dwordx4 v102, s[60:63], s23 offen offset:2048 lds
  buffer_load_dwordx4 v103, s[60:63], s23 offen offset:3072 lds
  v_xor_b32 v100, 64, v100
  v_xor_b32 v101, 64, v101
  v_xor_b32 v102, 64, v102
  v_xor_b32 v103, 64, v103
  s_add_u32 m0, s25, 114688
  s_add_u32 s23, s23, 65536
  buffer_load_dwordx4 v100, s[60:63], s23 offen offset:0 lds
  buffer_load_dwordx4 v101, s[60:63], s23 offen offset:1024 lds
  buffer_load_dwordx4 v102, s[60:63], s23 offen offset:2048 lds
  buffer_load_dwordx4 v103, s[60:63], s23 offen offset:3072 lds
  s_add_u32 m0, s25, 131072
  s_add_u32 s23, s23, 65536
  buffer_load_dwordx4 v100, s[60:63], s23 offen offset:0 lds
  buffer_load_dwordx4 v101, s[60:63], s23 offen offset:1024 lds
  buffer_load_dwordx4 v102, s[60:63], s23 offen offset:2048 lds
  buffer_load_dwordx4 v103, s[60:63], s23 offen offset:3072 lds
  s_mov_b32 s56, s40
  s_and_b32 s57, s41, 0xffff
  s_mov_b32 s58, 3670016
  s_mov_b32 s59, 0x20000
  s_lshl_b32 s21, s16, 16
  s_add_u32 s27, s26, s21
  s_lshr_b32 s20, s16, 1
  s_lshl_b32 s20, s20, 6
  v_xor_b32 v26, s20, v26
  v_xor_b32 v4, 0, v26
  v_xor_b32 v5, 32, v26
  v_add_u32 v5, 15360, v5
  v_xor_b32 v6, 128, v26
  v_add_u32 v6, 30720, v6
  v_xor_b32 v7, 160, v26
  v_add_u32 v7, 46080, v7
  s_add_u32 s22, s27, 0
  s_add_u32 m0, s25, 0
  s_nop 0
  buffer_load_dwordx4 v4, s[56:59], s22 offen offset:0 lds
  buffer_load_dwordx4 v5, s[56:59], s22 offen offset:1024 lds
  buffer_load_dwordx4 v6, s[56:59], s22 offen offset:2048 lds
  buffer_load_dwordx4 v7, s[56:59], s22 offen offset:3072 lds
  s_cmp_lg_u32 s66, 0
  s_cbranch_scc1 sc_ci
  s_cmp_lg_u32 s16, 0
  s_cbranch_scc1 w0_2
  s_lshr_b32 s70, s3, 5
  s_and_b32 s71, s70, 4
  s_mul_i32 s71, s71, 12
  s_lshl_b32 s70, s70, 2
  s_add_u32 s70, s70, s71
  s_lshl_b32 s71, 1, s3
  v_mov_b32 v248, s71
  v_mov_b32 v249, 32
  s_mov_b64 exec, 1
  buffer_atomic_or v248, v249, s[12:15], s70 offen sc0
  buffer_load_dwordx2 v[250:251], v249, s[12:15], 0 offen offset:96 sc1
  s_mov_b64 exec, -1
w0_2:
sc_ci:
  v_and_b32 v26, 15, v25
  v_xor_b32 v27, v26, v24
  v_lshlrev_b32 v27, 4, v27
  v_bfe_u32 v28, v25, 2, 1
  v_lshlrev_b32 v28, 4, v28
  v_lshrrev_b32 v29, 3, v25
  v_lshl_add_u32 v28, v29, 2, v28
  v_and_b32 v29, 3, v25
  v_add_u32 v28, v28, v29
  v_lshl_add_u32 v28, v28, 9, v27
  v_lshrrev_b32 v29, 2, v26
  v_lshlrev_b32 v29, 15, v29
  v_bfe_u32 v30, v26, 1, 1
  v_lshl_add_u32 v29, v30, 11, v29
  v_lshrrev_b32 v30, 4, v25
  v_lshl_add_u32 v29, v30, 10, v29
  v_and_b32 v31, 1, v26
  v_lshl_add_u32 v29, v31, 9, v29
  v_add_u32 v29, v29, v27
  v_add_u32 v29, s25, v29
  v_xor_b32 v8, 0, v28
  v_xor_b32 v104, 0, v29
  v_xor_b32 v9, 32, v28
  v_xor_b32 v105, 32, v29
  v_xor_b32 v10, 64, v28
  v_xor_b32 v106, 64, v29
  v_xor_b32 v11, 96, v28
  v_xor_b32 v107, 96, v29
  v_xor_b32 v12, 128, v28
  v_xor_b32 v108, 128, v29
  v_xor_b32 v13, 160, v28
  v_xor_b32 v109, 160, v29
  v_xor_b32 v14, 192, v28
  v_xor_b32 v110, 192, v29
  v_xor_b32 v15, 224, v28
  v_xor_b32 v111, 224, v29
  s_mov_b32 s52, 1035512379
  s_waitcnt vmcnt(4)
  ds_read_b128 v[120:123], v104 offset:16384
  ds_read_b128 v[124:127], v105 offset:16384
  ds_read_b128 v[128:131], v106 offset:16384
  ds_read_b128 v[132:135], v107 offset:16384
  ds_read_b128 v[136:139], v108 offset:16384
  ds_read_b128 v[140:143], v109 offset:16384
  ds_read_b128 v[144:147], v110 offset:16384
  ds_read_b128 v[148:151], v111 offset:16384
  s_waitcnt lgkmcnt(4)
  ds_read_b128 v[152:155], v104 offset:16640
  ds_read_b128 v[156:159], v105 offset:16640
  ds_read_b128 v[160:163], v106 offset:16640
  ds_read_b128 v[164:167], v107 offset:16640
  ds_read_b128 v[168:171], v108 offset:16640
  ds_read_b128 v[172:175], v109 offset:16640
  ds_read_b128 v[176:179], v110 offset:16640
  ds_read_b128 v[180:183], v111 offset:16640
  s_waitcnt lgkmcnt(4)
  ds_read_b128 v[184:187], v104 offset:32768
  ds_read_b128 v[188:191], v105 offset:32768
  ds_read_b128 v[192:195], v106 offset:32768
  ds_read_b128 v[196:199], v107 offset:32768
  ds_read_b128 v[200:203], v108 offset:32768
  ds_read_b128 v[204:207], v109 offset:32768
  ds_read_b128 v[208:211], v110 offset:32768
  ds_read_b128 v[212:215], v111 offset:32768
  s_waitcnt lgkmcnt(4)
  ds_read_b128 v[216:219], v104 offset:33024
  ds_read_b128 v[220:223], v105 offset:33024
  ds_read_b128 v[224:227], v106 offset:33024
  ds_read_b128 v[228:231], v107 offset:33024
  ds_read_b128 v[232:235], v108 offset:33024
  ds_read_b128 v[236:239], v109 offset:33024
  ds_read_b128 v[240:243], v110 offset:33024
  ds_read_b128 v[244:247], v111 offset:33024
  s_waitcnt lgkmcnt(4)
  s_waitcnt lgkmcnt(0)
  s_add_u32 s22, s27, 262144
  s_add_u32 m0, s25, 16384
  s_nop 0
  buffer_load_dwordx4 v4, s[56:59], s22 offen offset:0 lds
  buffer_load_dwordx4 v5, s[56:59], s22 offen offset:1024 lds
  buffer_load_dwordx4 v6, s[56:59], s22 offen offset:2048 lds
  buffer_load_dwordx4 v7, s[56:59], s22 offen offset:3072 lds
  s_add_u32 s22, s27, 524288
  s_add_u32 m0, s25, 32768
  s_nop 0
  buffer_load_dwordx4 v4, s[56:59], s22 offen offset:0 lds
  buffer_load_dwordx4 v5, s[56:59], s22 offen offset:1024 lds
  buffer_load_dwordx4 v6, s[56:59], s22 offen offset:2048 lds
  buffer_load_dwordx4 v7, s[56:59], s22 offen offset:3072 lds
  s_add_u32 s22, s27, 786432
  s_add_u32 m0, s25, 49152
  s_nop 0
  buffer_load_dwordx4 v4, s[56:59], s22 offen offset:0 lds
  buffer_load_dwordx4 v5, s[56:59], s22 offen offset:1024 lds
  buffer_load_dwordx4 v6, s[56:59], s22 offen offset:2048 lds
  buffer_load_dwordx4 v7, s[56:59], s22 offen offset:3072 lds
  s_cmp_lg_u32 s66, 0
  s_cbranch_scc1 sc_cf
  s_cmp_lg_u32 s16, 0
  s_cbranch_scc1 w0_3
  s_waitcnt vmcnt(12)
  v_readfirstlane_b32 s70, v250
  s_cmp_lg_u32 s70, 0
  s_cbranch_scc1 sc_nz
  v_mov_b32 v249, 128
  v_mov_b32 v250, s88
  v_mov_b32 v251, s89
  v_mov_b32 v252, 0
  v_mov_b32 v253, 0
  s_mov_b64 exec, 1
  buffer_atomic_cmpswap_x2 v[250:253], v249, s[12:15], 0 offen sc0
  s_mov_b64 exec, -1
  s_waitcnt vmcnt(0)
  v_readfirstlane_b32 s70, v250
  s_cmp_lg_u32 s70, 0
  s_cbranch_scc1 sc_nz
  v_mov_b32 v250, s88
  v_mov_b32 v251, s89
sc_nz:
w0_3:
  v_mov_b32 v249, 160000
  s_add_u32 s101, s101, 1
  s_barrier
  s_mov_b64 exec, 1
  s_cmp_lg_u32 s16, 0
  s_cbranch_scc1 w0_4
  ds_write_b32 v249, v248 offset:0
  ds_write_b32 v249, v250 offset:4
  ds_write_b32 v249, v251 offset:8
  s_waitcnt lgkmcnt(0)
  v_mov_b32 v248, s101
  ds_write_b32 v249, v248 offset:16
  s_waitcnt lgkmcnt(0)
w0_4:
  s_mov_b64 exec, -1
  s_barrier
  ds_read_b32 v248, v249 offset:0
  ds_read_b32 v250, v249 offset:4
  ds_read_b32 v251, v249 offset:8
  ds_read_b32 v249, v249 offset:16
  s_waitcnt lgkmcnt(0)
  v_readfirstlane_b32 s70, v248
  v_readfirstlane_b32 s88, v250
  v_readfirstlane_b32 s89, v251
  v_cmp_ne_u32 vcc, s101, v249
  s_cbranch_vccnz ch_end
  s_mov_b32 s66, 1
  s_bitcmp1_b32 s70, s3
  s_cbranch_scc1 m_reclaim
sc_cf:
  s_cmp_lg_u32 s16, 0
  s_cbranch_scc1 w0_5
  s_cmp_eq_u32 s67, 0
  s_cselect_b32 s20, 1, 0x10001
  v_mov_b32 v248, s20
  v_mov_b32 v249, 0
  s_mov_b64 exec, 1
  buffer_atomic_add v248, v249, s[12:15], 0 offen
  s_mov_b64 exec, -1
w0_5:
  s_lshl_b32 s28, s17, 7
  s_add_u32 s28, s28, 88623104
  v_min_u32 v113, 96, v2
  s_mov_b32 s29, 88590336
  v_add_u32 v112, 1024, v2
  v_min_u32 v112, 1776, v112
  s_mul_i32 s32, s17, 401408
  s_mul_i32 s33, s16, 14336
  s_add_u32 s32, s32, s33
  s_add_u32 s33, s32, s33
  s_add_u32 s32, s32, 344064
  s_add_u32 s33, s33, 229376
  s_waitcnt vmcnt(8)
  s_barrier
  ds_read_b128 v[16:19], v8 offset:0
  ds_read_b128 v[20:23], v9 offset:0
  ds_read_b128 v[24:27], v10 offset:0
  ds_read_b128 v[28:31], v11 offset:0
  s_waitcnt lgkmcnt(3)
  v_mfma_f32_32x32x16_bf16 v[32:47], v[16:19], v[120:123], 0
  s_add_u32 s22, s27, 1048576
  s_add_u32 m0, s25, 65536
  s_nop 0
  buffer_load_dwordx4 v4, s[56:59], s22 offen offset:0 lds
  v_mfma_f32_32x32x16_bf16 v[48:63], v[16:19], v[184:187], 0
  ds_read_b128 v[16:19], v12 offset:0
  s_waitcnt lgkmcnt(3)
  v_mfma_f32_32x32x16_bf16 v[32:47], v[20:23], v[124:127], v[32:47]
  buffer_load_dwordx4 v5, s[56:59], s22 offen offset:1024 lds
  v_mfma_f32_32x32x16_bf16 v[48:63], v[20:23], v[188:191], v[48:63]
  ds_read_b128 v[20:23], v13 offset:0
  s_waitcnt lgkmcnt(3)
  v_mfma_f32_32x32x16_bf16 v[32:47], v[24:27], v[128:131], v[32:47]
  buffer_load_dwordx4 v6, s[56:59], s22 offen offset:2048 lds
  v_mfma_f32_32x32x16_bf16 v[48:63], v[24:27], v[192:195], v[48:63]
  ds_read_b128 v[24:27], v14 offset:0
  s_waitcnt lgkmcnt(3)
  v_mfma_f32_32x32x16_bf16 v[32:47], v[28:31], v[132:135], v[32:47]
  buffer_load_dwordx4 v7, s[56:59], s22 offen offset:3072 lds
  v_mfma_f32_32x32x16_bf16 v[48:63], v[28:31], v[196:199], v[48:63]
  ds_read_b128 v[28:31], v15 offset:0
  s_waitcnt lgkmcnt(3)
  v_mfma_f32_32x32x16_bf16 v[32:47], v[16:19], v[136:139], v[32:47]
  s_add_u32 s22, s27, 1310720
  s_add_u32 m0, s25, 81920
  s_nop 0
  buffer_load_dwordx4 v4, s[56:59], s22 offen offset:0 lds
  v_mfma_f32_32x32x16_bf16 v[48:63], v[16:19], v[200:203], v[48:63]
  ds_read_b128 v[16:19], v8 offset:256
  s_waitcnt lgkmcnt(3)
  v_mfma_f32_32x32x16_bf16 v[32:47], v[20:23], v[140:143], v[32:47]
  buffer_load_dwordx4 v5, s[56:59], s22 offen offset:1024 lds
  v_mfma_f32_32x32x16_bf16 v[48:63], v[20:23], v[204:207], v[48:63]
  ds_read_b128 v[20:23], v9 offset:256
  s_waitcnt lgkmcnt(3)
  v_mfma_f32_32x32x16_bf16 v[32:47], v[24:27], v[144:147], v[32:47]
  buffer_load_dwordx4 v6, s[56:59], s22 offen offset:2048 lds
  v_mfma_f32_32x32x16_bf16 v[48:63], v[24:27], v[208:211], v[48:63]
  ds_read_b128 v[24:27], v10 offset:256
  s_waitcnt lgkmcnt(3)
  v_mfma_f32_32x32x16_bf16 v[32:47], v[28:31], v[148:151], v[32:47]
  buffer_load_dwordx4 v7, s[56:59], s22 offen offset:3072 lds
  v_mfma_f32_32x32x16_bf16 v[48:63], v[28:31], v[212:215], v[48:63]
  ds_read_b128 v[28:31], v11 offset:256
  s_waitcnt lgkmcnt(3)
  v_mfma_f32_32x32x16_bf16 v[32:47], v[16:19], v[152:155], v[32:47]
  s_add_u32 s22, s27, 1572864
  s_add_u32 m0, s25, 98304
  s_nop 0
  buffer_load_dwordx4 v4, s[56:59], s22 offen offset:0 lds
  v_mfma_f32_32x32x16_bf16 v[48:63], v[16:19], v[216:219], v[48:63]
  ds_read_b128 v[16:19], v12 offset:256
  s_waitcnt lgkmcnt(3)
  v_mfma_f32_32x32x16_bf16 v[32:47], v[20:23], v[156:159], v[32:47]
  buffer_load_dwordx4 v5, s[56:59], s22 offen offset:1024 lds
  v_mfma_f32_32x32x16_bf16 v[48:63], v[20:23], v[220:223], v[48:63]
  ds_read_b128 v[20:23], v13 offset:256
  s_waitcnt lgkmcnt(3)
  v_mfma_f32_32x32x16_bf16 v[32:47], v[24:27], v[160:163], v[32:47]
  buffer_load_dwordx4 v6, s[56:59], s22 offen offset:2048 lds
  v_mfma_f32_32x32x16_bf16 v[48:63], v[24:27], v[224:227], v[48:63]
  ds_read_b128 v[24:27], v14 offset:256
  s_waitcnt lgkmcnt(3)
  v_mfma_f32_32x32x16_bf16 v[32:47], v[28:31], v[164:167], v[32:47]
  buffer_load_dwordx4 v7, s[56:59], s22 offen offset:3072 lds
  v_mfma_f32_32x32x16_bf16 v[48:63], v[28:31], v[228:231], v[48:63]
  ds_read_b128 v[28:31], v15 offset:256
  s_waitcnt lgkmcnt(3)
  v_mfma_f32_32x32x16_bf16 v[32:47], v[16:19], v[168:171], v[32:47]
  s_add_u32 s22, s27, 1835008
  s_add_u32 m0, s25, 114688
  s_nop 0
  buffer_load_dwordx4 v4, s[56:59], s22 offen offset:0 lds
  v_mfma_f32_32x32x16_bf16 v[48:63], v[16:19], v[232:235], v[48:63]
  ds_read_b128 v[16:19], v8 offset:16384
  s_waitcnt lgkmcnt(3)
  v_mfma_f32_32x32x16_bf16 v[32:47], v[20:23], v[172:175], v[32:47]
  buffer_load_dwordx4 v5, s[56:59], s22 offen offset:1024 lds
  v_mfma_f32_32x32x16_bf16 v[48:63], v[20:23], v[236:239], v[48:63]
  ds_read_b128 v[20:23], v9 offset:16384
  s_waitcnt lgkmcnt(3)
  v_mfma_f32_32x32x16_bf16 v[32:47], v[24:27], v[176:179], v[32:47]
  buffer_load_dwordx4 v6, s[56:59], s22 offen offset:2048 lds
  v_mfma_f32_32x32x16_bf16 v[48:63], v[24:27], v[240:243], v[48:63]
  ds_read_b128 v[24:27], v10 offset:16384
  s_waitcnt lgkmcnt(3)
  v_mfma_f32_32x32x16_bf16 v[32:47], v[28:31], v[180:183], v[32:47]
  buffer_load_dwordx4 v7, s[56:59], s22 offen offset:3072 lds
  v_mfma_f32_32x32x16_bf16 v[48:63], v[28:31], v[244:247], v[48:63]
  s_waitcnt vmcnt(16)
  s_barrier
  ds_read_b128 v[28:31], v11 offset:16384
  s_waitcnt lgkmcnt(3)
  v_mfma_f32_32x32x16_bf16 v[64:79], v[16:19], v[120:123], 0
  s_add_u32 s22, s27, 2097152
  s_add_u32 m0, s25, 131072
  s_nop 0
  buffer_load_dwordx4 v4, s[56:59], s22 offen offset:0 lds
  v_mfma_f32_32x32x16_bf16 v[80:95], v[16:19], v[184:187], 0
  ds_read_b128 v[16:19], v12 offset:16384
  s_waitcnt lgkmcnt(3)
  v_mfma_f32_32x32x16_bf16 v[64:79], v[20:23], v[124:127], v[64:79]
  buffer_load_dwordx4 v5, s[56:59], s22 offen offset:1024 lds
  v_mul_f32 v32, s52, v32
  v_mul_f32 v33, s52, v33
  v_cvt_pk_bf16_f32 v32, v32, v33
  v_mfma_f32_32x32x16_bf16 v[80:95], v[20:23], v[188:191], v[80:95]
  v_mul_f32 v34, s52, v34
  v_mul_f32 v35, s52, v35
  ds_read_b128 v[20:23], v13 offset:16384
  s_waitcnt lgkmcnt(3)
  v_mfma_f32_32x32x16_bf16 v[64:79], v[24:27], v[128:131], v[64:79]
  buffer_load_dwordx4 v6, s[56:59], s22 offen offset:2048 lds
  v_cvt_pk_bf16_f32 v33, v34, v35
  v_mul_f32 v36, s52, v36
  v_mul_f32 v37, s52, v37
  v_mfma_f32_32x32x16_bf16 v[80:95], v[24:27], v[192:195], v[80:95]
  v_cvt_pk_bf16_f32 v34, v36, v37
  v_mul_f32 v38, s52, v38
  ds_read_b128 v[24:27], v14 offset:16384
  s_waitcnt lgkmcnt(3)
  v_mfma_f32_32x32x16_bf16 v[64:79], v[28:31], v[132:135], v[64:79]
  buffer_load_dwordx4 v7, s[56:59], s22 offen offset:3072 lds
  v_mul_f32 v39, s52, v39
  v_cvt_pk_bf16_f32 v35, v38, v39
  v_mul_f32 v40, s52, v40
  v_mfma_f32_32x32x16_bf16 v[80:95], v[28:31], v[196:199], v[80:95]
  v_mul_f32 v41, s52, v41
  v_cvt_pk_bf16_f32 v40, v40, v41
  ds_read_b128 v[28:31], v15 offset:16384
  s_waitcnt lgkmcnt(3)
  v_mfma_f32_32x32x16_bf16 v[64:79], v[16:19], v[136:139], v[64:79]
  s_add_u32 s22, s27, 2359296
  s_add_u32 m0, s25, 0
  s_nop 0
  buffer_load_dwordx4 v4, s[56:59], s22 offen offset:0 lds
  v_mul_f32 v42, s52, v42
  v_mul_f32 v43, s52, v43
  v_cvt_pk_bf16_f32 v41, v42, v43
  v_mfma_f32_32x32x16_bf16 v[80:95], v[16:19], v[200:203], v[80:95]
  v_mul_f32 v44, s52, v44
  v_mul_f32 v45, s52, v45
  ds_read_b128 v[16:19], v8 offset:16640
  s_waitcnt lgkmcnt(3)
  v_mfma_f32_32x32x16_bf16 v[64:79], v[20:23], v[140:143], v[64:79]
  buffer_load_dwordx4 v5, s[56:59], s22 offen offset:1024 lds
  v_cvt_pk_bf16_f32 v42, v44, v45
  v_mul_f32 v46, s52, v46
  v_mul_f32 v47, s52, v47
  v_mfma_f32_32x32x16_bf16 v[80:95], v[20:23], v[204:207], v[80:95]
  v_cvt_pk_bf16_f32 v43, v46, v47
  v_permlane16_swap_b32 v32, v40
  ds_read_b128 v[20:23], v9 offset:16640
  s_waitcnt lgkmcnt(3)
  v_mfma_f32_32x32x16_bf16 v[64:79], v[24:27], v[144:147], v[64:79]
  buffer_load_dwordx4 v6, s[56:59], s22 offen offset:2048 lds
  v_permlane16_swap_b32 v33, v41
  v_permlane16_swap_b32 v34, v42
  v_permlane16_swap_b32 v35, v43
  v_mfma_f32_32x32x16_bf16 v[80:95], v[24:27], v[208:211], v[80:95]
  v_accvgpr_write_b32 a0, v32
  v_accvgpr_write_b32 a1, v33
  ds_read_b128 v[24:27], v10 offset:16640
  s_waitcnt lgkmcnt(3)
  v_mfma_f32_32x32x16_bf16 v[64:79], v[28:31], v[148:151], v[64:79]
  buffer_load_dwordx4 v7, s[56:59], s22 offen offset:3072 lds
  v_accvgpr_write_b32 a2, v34
  v_accvgpr_write_b32 a3, v35
  v_accvgpr_write_b32 a56, v40
  v_mfma_f32_32x32x16_bf16 v[80:95], v[28:31], v[212:215], v[80:95]
  v_accvgpr_write_b32 a57, v41
  v_accvgpr_write_b32 a58, v42
  ds_read_b128 v[28:31], v11 offset:16640
  s_waitcnt lgkmcnt(3)
  v_mfma_f32_32x32x16_bf16 v[64:79], v[16:19], v[152:155], v[64:79]
  v_accvgpr_write_b32 a59, v43
  v_mul_f32 v48, s52, v48
  v_mul_f32 v49, s52, v49
  v_mfma_f32_32x32x16_bf16 v[80:95], v[16:19], v[216:219], v[80:95]
  v_cvt_pk_bf16_f32 v48, v48, v49
  v_mul_f32 v50, s52, v50
  ds_read_b128 v[16:19], v12 offset:16640
  s_waitcnt lgkmcnt(3)
  v_mfma_f32_32x32x16_bf16 v[64:79], v[20:23], v[156:159], v[64:79]
  v_mul_f32 v51, s52, v51
  v_cvt_pk_bf16_f32 v49, v50, v51
  v_mul_f32 v52, s52, v52
  v_mfma_f32_32x32x16_bf16 v[80:95], v[20:23], v[220:223], v[80:95]
  v_mul_f32 v53, s52, v53
  v_cvt_pk_bf16_f32 v50, v52, v53
  ds_read_b128 v[20:23], v13 offset:16640
  s_waitcnt lgkmcnt(3)
  v_mfma_f32_32x32x16_bf16 v[64:79], v[24:27], v[160:163], v[64:79]
  v_mul_f32 v54, s52, v54
  v_mul_f32 v55, s52, v55
  v_cvt_pk_bf16_f32 v51, v54, v55
  v_mfma_f32_32x32x16_bf16 v[80:95], v[24:27], v[224:227], v[80:95]
  v_mul_f32 v56, s52, v56
  v_mul_f32 v57, s52, v57
  ds_read_b128 v[24:27], v14 offset:16640
  s_waitcnt lgkmcnt(3)
  v_mfma_f32_32x32x16_bf16 v[64:79], v[28:31], v[164:167], v[64:79]
  v_cvt_pk_bf16_f32 v56, v56, v57
  v_mul_f32 v58, s52, v58
  v_mul_f32 v59, s52, v59
  v_mfma_f32_32x32x16_bf16 v[80:95], v[28:31], v[228:231], v[80:95]
  v_cvt_pk_bf16_f32 v57, v58, v59
  v_mul_f32 v60, s52, v60
  ds_read_b128 v[28:31], v15 offset:16640
  s_waitcnt lgkmcnt(3)
  v_mfma_f32_32x32x16_bf16 v[64:79], v[16:19], v[168:171], v[64:79]
  v_mul_f32 v61, s52, v61
  v_cvt_pk_bf16_f32 v58, v60, v61
  v_mul_f32 v62, s52, v62
  v_mfma_f32_32x32x16_bf16 v[80:95], v[16:19], v[232:235], v[80:95]
  v_mul_f32 v63, s52, v63
  v_cvt_pk_bf16_f32 v59, v62, v63
  ds_read_b128 v[16:19], v8 offset:32768
  s_waitcnt lgkmcnt(3)
  v_mfma_f32_32x32x16_bf16 v[64:79], v[20:23], v[172:175], v[64:79]
  v_permlane16_swap_b32 v48, v56
  v_permlane16_swap_b32 v49, v57
  v_permlane16_swap_b32 v50, v58
  v_mfma_f32_32x32x16_bf16 v[80:95], v[20:23], v[236:239], v[80:95]
  v_permlane16_swap_b32 v51, v59
  v_accvgpr_write_b32 a112, v48
  ds_read_b128 v[20:23], v9 offset:32768
  s_waitcnt lgkmcnt(3)
  v_mfma_f32_32x32x16_bf16 v[64:79], v[24:27], v[176:179], v[64:79]
  v_accvgpr_write_b32 a113, v49
  v_accvgpr_write_b32 a114, v50
  v_accvgpr_write_b32 a115, v51
  v_mfma_f32_32x32x16_bf16 v[80:95], v[24:27], v[240:243], v[80:95]
  v_accvgpr_write_b32 a168, v56
  v_accvgpr_write_b32 a169, v57
  ds_read_b128 v[24:27], v10 offset:32768
  s_waitcnt lgkmcnt(3)
  v_mfma_f32_32x32x16_bf16 v[64:79], v[28:31], v[180:183], v[64:79]
  v_accvgpr_write_b32 a170, v58
  v_accvgpr_write_b32 a171, v59
  v_mfma_f32_32x32x16_bf16 v[80:95], v[28:31], v[244:247], v[80:95]
  ds_read_b128 v[28:31], v11 offset:32768
  s_waitcnt lgkmcnt(3)
  v_mfma_f32_32x32x16_bf16 v[32:47], v[16:19], v[120:123], 0
  v_mfma_f32_32x32x16_bf16 v[48:63], v[16:19], v[184:187], 0
  ds_read_b128 v[16:19], v12 offset:32768
  s_waitcnt lgkmcnt(3)
  v_mfma_f32_32x32x16_bf16 v[32:47], v[20:23], v[124:127], v[32:47]
  v_mul_f32 v64, s52, v64
  v_mul_f32 v65, s52, v65
  v_cvt_pk_bf16_f32 v64, v64, v65
  v_mfma_f32_32x32x16_bf16 v[48:63], v[20:23], v[188:191], v[48:63]
  v_mul_f32 v66, s52, v66
  v_mul_f32 v67, s52, v67
  ds_read_b128 v[20:23], v13 offset:32768
  s_waitcnt lgkmcnt(3)
  v_mfma_f32_32x32x16_bf16 v[32:47], v[24:27], v[128:131], v[32:47]
  v_cvt_pk_bf16_f32 v65, v66, v67
  v_mul_f32 v68, s52, v68
  v_mul_f32 v69, s52, v69
  v_mfma_f32_32x32x16_bf16 v[48:63], v[24:27], v[192:195], v[48:63]
  v_cvt_pk_bf16_f32 v66, v68, v69
  v_mul_f32 v70, s52, v70
  ds_read_b128 v[24:27], v14 offset:32768
  s_waitcnt lgkmcnt(3)
  v_mfma_f32_32x32x16_bf16 v[32:47], v[28:31], v[132:135], v[32:47]
  v_mul_f32 v71, s52, v71
  v_cvt_pk_bf16_f32 v67, v70, v71
  v_mul_f32 v72, s52, v72
  v_mfma_f32_32x32x16_bf16 v[48:63], v[28:31], v[196:199], v[48:63]
  v_mul_f32 v73, s52, v73
  v_cvt_pk_bf16_f32 v72, v72, v73
  ds_read_b128 v[28:31], v15 offset:32768
  s_waitcnt lgkmcnt(3)
  v_mfma_f32_32x32x16_bf16 v[32:47], v[16:19], v[136:139], v[32:47]
  v_mul_f32 v74, s52, v74
  v_mul_f32 v75, s52, v75
  v_cvt_pk_bf16_f32 v73, v74, v75
  v_mfma_f32_32x32x16_bf16 v[48:63], v[16:19], v[200:203], v[48:63]
  v_mul_f32 v76, s52, v76
  v_mul_f32 v77, s52, v77
  ds_read_b128 v[16:19], v8 offset:33024
  s_waitcnt lgkmcnt(3)
  v_mfma_f32_32x32x16_bf16 v[32:47], v[20:23], v[140:143], v[32:47]
  v_cvt_pk_bf16_f32 v74, v76, v77
  v_mul_f32 v78, s52, v78
  v_mul_f32 v79, s52, v79
  v_mfma_f32_32x32x16_bf16 v[48:63], v[20:23], v[204:207], v[48:63]
  v_cvt_pk_bf16_f32 v75, v78, v79
  v_permlane16_swap_b32 v64, v72
  ds_read_b128 v[20:23], v9 offset:33024
  s_waitcnt lgkmcnt(3)
  v_mfma_f32_32x32x16_bf16 v[32:47], v[24:27], v[144:147], v[32:47]
  v_permlane16_swap_b32 v65, v73
  v_permlane16_swap_b32 v66, v74
  v_permlane16_swap_b32 v67, v75
  v_mfma_f32_32x32x16_bf16 v[48:63], v[24:27], v[208:211], v[48:63]
  v_accvgpr_write_b32 a4, v64
  v_accvgpr_write_b32 a5, v65
  ds_read_b128 v[24:27], v10 offset:33024
  s_waitcnt lgkmcnt(3)
  v_mfma_f32_32x32x16_bf16 v[32:47], v[28:31], v[148:151], v[32:47]
  v_accvgpr_write_b32 a6, v66
  v_accvgpr_write_b32 a7, v67
  v_accvgpr_write_b32 a60, v72
  v_mfma_f32_32x32x16_bf16 v[48:63], v[28:31], v[212:215], v[48:63]
  v_accvgpr_write_b32 a61, v73
  v_accvgpr_write_b32 a62, v74
  ds_read_b128 v[28:31], v11 offset:33024
  s_waitcnt lgkmcnt(3)
  v_mfma_f32_32x32x16_bf16 v[32:47], v[16:19], v[152:155], v[32:47]
  v_accvgpr_write_b32 a63, v75
  v_mul_f32 v80, s52, v80
  v_mul_f32 v81, s52, v81
  v_mfma_f32_32x32x16_bf16 v[48:63], v[16:19], v[216:219], v[48:63]
  v_cvt_pk_bf16_f32 v80, v80, v81
  v_mul_f32 v82, s52, v82
  ds_read_b128 v[16:19], v12 offset:33024
  s_waitcnt lgkmcnt(3)
  v_mfma_f32_32x32x16_bf16 v[32:47], v[20:23], v[156:159], v[32:47]
  v_mul_f32 v83, s52, v83
  v_cvt_pk_bf16_f32 v81, v82, v83
  v_mul_f32 v84, s52, v84
  v_mfma_f32_32x32x16_bf16 v[48:63], v[20:23], v[220:223], v[48:63]
  v_mul_f32 v85, s52, v85
  v_cvt_pk_bf16_f32 v82, v84, v85
  ds_read_b128 v[20:23], v13 offset:33024
  s_waitcnt lgkmcnt(3)
  v_mfma_f32_32x32x16_bf16 v[32:47], v[24:27], v[160:163], v[32:47]
  v_mul_f32 v86, s52, v86
  v_mul_f32 v87, s52, v87
  v_cvt_pk_bf16_f32 v83, v86, v87
  v_mfma_f32_32x32x16_bf16 v[48:63], v[24:27], v[224:227], v[48:63]
  v_mul_f32 v88, s52, v88
  v_mul_f32 v89, s52, v89
  ds_read_b128 v[24:27], v14 offset:33024
  s_waitcnt lgkmcnt(3)
  v_mfma_f32_32x32x16_bf16 v[32:47], v[28:31], v[164:167], v[32:47]
  v_cvt_pk_bf16_f32 v88, v88, v89
  v_mul_f32 v90, s52, v90
  v_mul_f32 v91, s52, v91
  v_mfma_f32_32x32x16_bf16 v[48:63], v[28:31], v[228:231], v[48:63]
  v_cvt_pk_bf16_f32 v89, v90, v91
  v_mul_f32 v92, s52, v92
  ds_read_b128 v[28:31], v15 offset:33024
  s_waitcnt lgkmcnt(3)
  v_mfma_f32_32x32x16_bf16 v[32:47], v[16:19], v[168:171], v[32:47]
  v_mul_f32 v93, s52, v93
  v_cvt_pk_bf16_f32 v90, v92, v93
  v_mul_f32 v94, s52, v94
  v_mfma_f32_32x32x16_bf16 v[48:63], v[16:19], v[232:235], v[48:63]
  v_mul_f32 v95, s52, v95
  v_cvt_pk_bf16_f32 v91, v94, v95
  ds_read_b128 v[16:19], v8 offset:49152
  s_waitcnt lgkmcnt(3)
  v_mfma_f32_32x32x16_bf16 v[32:47], v[20:23], v[172:175], v[32:47]
  v_permlane16_swap_b32 v80, v88
  v_permlane16_swap_b32 v81, v89
  v_permlane16_swap_b32 v82, v90
  v_mfma_f32_32x32x16_bf16 v[48:63], v[20:23], v[236:239], v[48:63]
  v_permlane16_swap_b32 v83, v91
  v_accvgpr_write_b32 a116, v80
  ds_read_b128 v[20:23], v9 offset:49152
  s_waitcnt lgkmcnt(3)
  v_mfma_f32_32x32x16_bf16 v[32:47], v[24:27], v[176:179], v[32:47]
  v_accvgpr_write_b32 a117, v81
  v_accvgpr_write_b32 a118, v82
  v_accvgpr_write_b32 a119, v83
  v_mfma_f32_32x32x16_bf16 v[48:63], v[24:27], v[240:243], v[48:63]
  v_accvgpr_write_b32 a172, v88
  v_accvgpr_write_b32 a173, v89
  ds_read_b128 v[24:27], v10 offset:49152
  s_waitcnt lgkmcnt(3)
  v_mfma_f32_32x32x16_bf16 v[32:47], v[28:31], v[180:183], v[32:47]
  v_accvgpr_write_b32 a174, v90
  v_accvgpr_write_b32 a175, v91
  v_mfma_f32_32x32x16_bf16 v[48:63], v[28:31], v[244:247], v[48:63]
  s_waitcnt vmcnt(16)
  s_barrier
  ds_read_b128 v[28:31], v11 offset:49152
  s_waitcnt lgkmcnt(3)
  v_mfma_f32_32x32x16_bf16 v[64:79], v[16:19], v[120:123], 0
  s_add_u32 s22, s27, 2621440
  s_add_u32 m0, s25, 16384
  s_nop 0
  buffer_load_dwordx4 v4, s[56:59], s22 offen offset:0 lds
  v_mfma_f32_32x32x16_bf16 v[80:95], v[16:19], v[184:187], 0
  ds_read_b128 v[16:19], v12 offset:49152
  s_waitcnt lgkmcnt(3)
  v_mfma_f32_32x32x16_bf16 v[64:79], v[20:23], v[124:127], v[64:79]
  buffer_load_dwordx4 v5, s[56:59], s22 offen offset:1024 lds
  v_mul_f32 v32, s52, v32
  v_mul_f32 v33, s52, v33
  v_cvt_pk_bf16_f32 v32, v32, v33
  v_mfma_f32_32x32x16_bf16 v[80:95], v[20:23], v[188:191], v[80:95]
  v_mul_f32 v34, s52, v34
  v_mul_f32 v35, s52, v35
  ds_read_b128 v[20:23], v13 offset:49152
  s_waitcnt lgkmcnt(3)
  v_mfma_f32_32x32x16_bf16 v[64:79], v[24:27], v[128:131], v[64:79]
  buffer_load_dwordx4 v6, s[56:59], s22 offen offset:2048 lds
  v_cvt_pk_bf16_f32 v33, v34, v35
  v_mul_f32 v36, s52, v36
  v_mul_f32 v37, s52, v37
  v_mfma_f32_32x32x16_bf16 v[80:95], v[24:27], v[192:195], v[80:95]
  v_cvt_pk_bf16_f32 v34, v36, v37
  v_mul_f32 v38, s52, v38
  ds_read_b128 v[24:27], v14 offset:49152
  s_waitcnt lgkmcnt(3)
  v_mfma_f32_32x32x16_bf16 v[64:79], v[28:31], v[132:135], v[64:79]
  buffer_load_dwordx4 v7, s[56:59], s22 offen offset:3072 lds
  v_mul_f32 v39, s52, v39
  v_cvt_pk_bf16_f32 v35, v38, v39
  v_mul_f32 v40, s52, v40
  v_mfma_f32_32x32x16_bf16 v[80:95], v[28:31], v[196:199], v[80:95]
  v_mul_f32 v41, s52, v41
  v_cvt_pk_bf16_f32 v40, v40, v41
  ds_read_b128 v[28:31], v15 offset:49152
  s_waitcnt lgkmcnt(3)
  v_mfma_f32_32x32x16_bf16 v[64:79], v[16:19], v[136:139], v[64:79]
  s_add_u32 s22, s27, 2883584
  s_add_u32 m0, s25, 32768
  s_nop 0
  buffer_load_dwordx4 v4, s[56:59], s22 offen offset:0 lds
  v_mul_f32 v42, s52, v42
  v_mul_f32 v43, s52, v43
  v_cvt_pk_bf16_f32 v41, v42, v43
  v_mfma_f32_32x32x16_bf16 v[80:95], v[16:19], v[200:203], v[80:95]
  v_mul_f32 v44, s52, v44
  v_mul_f32 v45, s52, v45
  ds_read_b128 v[16:19], v8 offset:49408
  s_waitcnt lgkmcnt(3)
  v_mfma_f32_32x32x16_bf16 v[64:79], v[20:23], v[140:143], v[64:79]
  buffer_load_dwordx4 v5, s[56:59], s22 offen offset:1024 lds
  v_cvt_pk_bf16_f32 v42, v44, v45
  v_mul_f32 v46, s52, v46
  v_mul_f32 v47, s52, v47
  v_mfma_f32_32x32x16_bf16 v[80:95], v[20:23], v[204:207], v[80:95]
  v_cvt_pk_bf16_f32 v43, v46, v47
  v_permlane16_swap_b32 v32, v40
  ds_read_b128 v[20:23], v9 offset:49408
  s_waitcnt lgkmcnt(3)
  v_mfma_f32_32x32x16_bf16 v[64:79], v[24:27], v[144:147], v[64:79]
  buffer_load_dwordx4 v6, s[56:59], s22 offen offset:2048 lds
  v_permlane16_swap_b32 v33, v41
  v_permlane16_swap_b32 v34, v42
  v_permlane16_swap_b32 v35, v43
  v_mfma_f32_32x32x16_bf16 v[80:95], v[24:27], v[208:211], v[80:95]
  v_accvgpr_write_b32 a8, v32
  v_accvgpr_write_b32 a9, v33
  ds_read_b128 v[24:27], v10 offset:49408
  s_waitcnt lgkmcnt(3)
  v_mfma_f32_32x32x16_bf16 v[64:79], v[28:31], v[148:151], v[64:79]
  buffer_load_dwordx4 v7, s[56:59], s22 offen offset:3072 lds
  v_accvgpr_write_b32 a10, v34
  v_accvgpr_write_b32 a11, v35
  v_accvgpr_write_b32 a64, v40
  v_mfma_f32_32x32x16_bf16 v[80:95], v[28:31], v[212:215], v[80:95]
  v_accvgpr_write_b32 a65, v41
  v_accvgpr_write_b32 a66, v42
  ds_read_b128 v[28:31], v11 offset:49408
  s_waitcnt lgkmcnt(3)
  v_mfma_f32_32x32x16_bf16 v[64:79], v[16:19], v[152:155], v[64:79]
  v_accvgpr_write_b32 a67, v43
  v_mul_f32 v48, s52, v48
  v_mul_f32 v49, s52, v49
  v_mfma_f32_32x32x16_bf16 v[80:95], v[16:19], v[216:219], v[80:95]
  v_cvt_pk_bf16_f32 v48, v48, v49
  v_mul_f32 v50, s52, v50
  ds_read_b128 v[16:19], v12 offset:49408
  s_waitcnt lgkmcnt(3)
  v_mfma_f32_32x32x16_bf16 v[64:79], v[20:23], v[156:159], v[64:79]
  v_mul_f32 v51, s52, v51
  v_cvt_pk_bf16_f32 v49, v50, v51
  v_mul_f32 v52, s52, v52
  v_mfma_f32_32x32x16_bf16 v[80:95], v[20:23], v[220:223], v[80:95]
  v_mul_f32 v53, s52, v53
  v_cvt_pk_bf16_f32 v50, v52, v53
  ds_read_b128 v[20:23], v13 offset:49408
  s_waitcnt lgkmcnt(3)
  v_mfma_f32_32x32x16_bf16 v[64:79], v[24:27], v[160:163], v[64:79]
  v_mul_f32 v54, s52, v54
  v_mul_f32 v55, s52, v55
  v_cvt_pk_bf16_f32 v51, v54, v55
  v_mfma_f32_32x32x16_bf16 v[80:95], v[24:27], v[224:227], v[80:95]
  v_mul_f32 v56, s52, v56
  v_mul_f32 v57, s52, v57
  ds_read_b128 v[24:27], v14 offset:49408
  s_waitcnt lgkmcnt(3)
  v_mfma_f32_32x32x16_bf16 v[64:79], v[28:31], v[164:167], v[64:79]
  v_cvt_pk_bf16_f32 v56, v56, v57
  v_mul_f32 v58, s52, v58
  v_mul_f32 v59, s52, v59
  v_mfma_f32_32x32x16_bf16 v[80:95], v[28:31], v[228:231], v[80:95]
  v_cvt_pk_bf16_f32 v57, v58, v59
  v_mul_f32 v60, s52, v60
  ds_read_b128 v[28:31], v15 offset:49408
  s_waitcnt lgkmcnt(3)
  v_mfma_f32_32x32x16_bf16 v[64:79], v[16:19], v[168:171], v[64:79]
  v_mul_f32 v61, s52, v61
  v_cvt_pk_bf16_f32 v58, v60, v61
  v_mul_f32 v62, s52, v62
  v_mfma_f32_32x32x16_bf16 v[80:95], v[16:19], v[232:235], v[80:95]
  v_mul_f32 v63, s52, v63
  v_cvt_pk_bf16_f32 v59, v62, v63
  v_xor_b32 v8, 65536, v8
  ds_read_b128 v[16:19], v8 offset:0
  s_waitcnt lgkmcnt(3)
  v_mfma_f32_32x32x16_bf16 v[64:79], v[20:23], v[172:175], v[64:79]
  v_permlane16_swap_b32 v48, v56
  v_permlane16_swap_b32 v49, v57
  v_permlane16_swap_b32 v50, v58
  v_mfma_f32_32x32x16_bf16 v[80:95], v[20:23], v[236:239], v[80:95]
  v_permlane16_swap_b32 v51, v59
  v_accvgpr_write_b32 a120, v48
  v_xor_b32 v9, 65536, v9
  ds_read_b128 v[20:23], v9 offset:0
  s_waitcnt lgkmcnt(3)
  v_mfma_f32_32x32x16_bf16 v[64:79], v[24:27], v[176:179], v[64:79]
  v_accvgpr_write_b32 a121, v49
  v_accvgpr_write_b32 a122, v50
  v_accvgpr_write_b32 a123, v51
  v_mfma_f32_32x32x16_bf16 v[80:95], v[24:27], v[240:243], v[80:95]
  v_accvgpr_write_b32 a176, v56
  v_accvgpr_write_b32 a177, v57
  v_xor_b32 v10, 65536, v10
  ds_read_b128 v[24:27], v10 offset:0
  s_waitcnt lgkmcnt(3)
  v_mfma_f32_32x32x16_bf16 v[64:79], v[28:31], v[180:183], v[64:79]
  v_accvgpr_write_b32 a178, v58
  v_accvgpr_write_b32 a179, v59
  v_mfma_f32_32x32x16_bf16 v[80:95], v[28:31], v[244:247], v[80:95]
  v_xor_b32 v11, 65536, v11
  ds_read_b128 v[28:31], v11 offset:0
  s_waitcnt lgkmcnt(3)
  v_mfma_f32_32x32x16_bf16 v[32:47], v[16:19], v[120:123], 0
  v_mfma_f32_32x32x16_bf16 v[48:63], v[16:19], v[184:187], 0
  v_xor_b32 v12, 65536, v12
  ds_read_b128 v[16:19], v12 offset:0
  s_waitcnt lgkmcnt(3)
  v_mfma_f32_32x32x16_bf16 v[32:47], v[20:23], v[124:127], v[32:47]
  v_mul_f32 v64, s52, v64
  v_mul_f32 v65, s52, v65
  v_cvt_pk_bf16_f32 v64, v64, v65
  v_mfma_f32_32x32x16_bf16 v[48:63], v[20:23], v[188:191], v[48:63]
  v_mul_f32 v66, s52, v66
  v_mul_f32 v67, s52, v67
  v_xor_b32 v13, 65536, v13
  ds_read_b128 v[20:23], v13 offset:0
  s_waitcnt lgkmcnt(3)
  v_mfma_f32_32x32x16_bf16 v[32:47], v[24:27], v[128:131], v[32:47]
  v_cvt_pk_bf16_f32 v65, v66, v67
  v_mul_f32 v68, s52, v68
  v_mul_f32 v69, s52, v69
  v_mfma_f32_32x32x16_bf16 v[48:63], v[24:27], v[192:195], v[48:63]
  v_cvt_pk_bf16_f32 v66, v68, v69
  v_mul_f32 v70, s52, v70
  v_xor_b32 v14, 65536, v14
  ds_read_b128 v[24:27], v14 offset:0
  s_waitcnt lgkmcnt(3)
  v_mfma_f32_32x32x16_bf16 v[32:47], v[28:31], v[132:135], v[32:47]
  v_mul_f32 v71, s52, v71
  v_cvt_pk_bf16_f32 v67, v70, v71
  v_mul_f32 v72, s52, v72
  v_mfma_f32_32x32x16_bf16 v[48:63], v[28:31], v[196:199], v[48:63]
  v_mul_f32 v73, s52, v73
  v_cvt_pk_bf16_f32 v72, v72, v73
  v_xor_b32 v15, 65536, v15
  ds_read_b128 v[28:31], v15 offset:0
  s_waitcnt lgkmcnt(3)
  v_mfma_f32_32x32x16_bf16 v[32:47], v[16:19], v[136:139], v[32:47]
  v_mul_f32 v74, s52, v74
  v_mul_f32 v75, s52, v75
  v_cvt_pk_bf16_f32 v73, v74, v75
  v_mfma_f32_32x32x16_bf16 v[48:63], v[16:19], v[200:203], v[48:63]
  v_mul_f32 v76, s52, v76
  v_mul_f32 v77, s52, v77
  ds_read_b128 v[16:19], v8 offset:256
  s_waitcnt lgkmcnt(3)
  v_mfma_f32_32x32x16_bf16 v[32:47], v[20:23], v[140:143], v[32:47]
  v_cvt_pk_bf16_f32 v74, v76, v77
  v_mul_f32 v78, s52, v78
  v_mul_f32 v79, s52, v79
  v_mfma_f32_32x32x16_bf16 v[48:63], v[20:23], v[204:207], v[48:63]
  v_cvt_pk_bf16_f32 v75, v78, v79
  v_permlane16_swap_b32 v64, v72
  ds_read_b128 v[20:23], v9 offset:256
  s_waitcnt lgkmcnt(3)
  v_mfma_f32_32x32x16_bf16 v[32:47], v[24:27], v[144:147], v[32:47]
  v_permlane16_swap_b32 v65, v73
  v_permlane16_swap_b32 v66, v74
  v_permlane16_swap_b32 v67, v75
  v_mfma_f32_32x32x16_bf16 v[48:63], v[24:27], v[208:211], v[48:63]
  v_accvgpr_write_b32 a12, v64
  v_accvgpr_write_b32 a13, v65
  ds_read_b128 v[24:27], v10 offset:256
  s_waitcnt lgkmcnt(3)
  v_mfma_f32_32x32x16_bf16 v[32:47], v[28:31], v[148:151], v[32:47]
  v_accvgpr_write_b32 a14, v66
  v_accvgpr_write_b32 a15, v67
  v_accvgpr_write_b32 a68, v72
  v_mfma_f32_32x32x16_bf16 v[48:63], v[28:31], v[212:215], v[48:63]
  v_accvgpr_write_b32 a69, v73
  v_accvgpr_write_b32 a70, v74
  ds_read_b128 v[28:31], v11 offset:256
  s_waitcnt lgkmcnt(3)
  v_mfma_f32_32x32x16_bf16 v[32:47], v[16:19], v[152:155], v[32:47]
  v_accvgpr_write_b32 a71, v75
  v_mul_f32 v80, s52, v80
  v_mul_f32 v81, s52, v81
  v_mfma_f32_32x32x16_bf16 v[48:63], v[16:19], v[216:219], v[48:63]
  v_cvt_pk_bf16_f32 v80, v80, v81
  v_mul_f32 v82, s52, v82
  ds_read_b128 v[16:19], v12 offset:256
  s_waitcnt lgkmcnt(3)
  v_mfma_f32_32x32x16_bf16 v[32:47], v[20:23], v[156:159], v[32:47]
  v_mul_f32 v83, s52, v83
  v_cvt_pk_bf16_f32 v81, v82, v83
  v_mul_f32 v84, s52, v84
  v_mfma_f32_32x32x16_bf16 v[48:63], v[20:23], v[220:223], v[48:63]
  v_mul_f32 v85, s52, v85
  v_cvt_pk_bf16_f32 v82, v84, v85
  ds_read_b128 v[20:23], v13 offset:256
  s_waitcnt lgkmcnt(3)
  v_mfma_f32_32x32x16_bf16 v[32:47], v[24:27], v[160:163], v[32:47]
  v_mul_f32 v86, s52, v86
  v_mul_f32 v87, s52, v87
  v_cvt_pk_bf16_f32 v83, v86, v87
  v_mfma_f32_32x32x16_bf16 v[48:63], v[24:27], v[224:227], v[48:63]
  v_mul_f32 v88, s52, v88
  v_mul_f32 v89, s52, v89
  ds_read_b128 v[24:27], v14 offset:256
  s_waitcnt lgkmcnt(3)
  v_mfma_f32_32x32x16_bf16 v[32:47], v[28:31], v[164:167], v[32:47]
  v_cvt_pk_bf16_f32 v88, v88, v89
  v_mul_f32 v90, s52, v90
  v_mul_f32 v91, s52, v91
  v_mfma_f32_32x32x16_bf16 v[48:63], v[28:31], v[228:231], v[48:63]
  v_cvt_pk_bf16_f32 v89, v90, v91
  v_mul_f32 v92, s52, v92
  ds_read_b128 v[28:31], v15 offset:256
  s_waitcnt lgkmcnt(3)
  v_mfma_f32_32x32x16_bf16 v[32:47], v[16:19], v[168:171], v[32:47]
  v_mul_f32 v93, s52, v93
  v_cvt_pk_bf16_f32 v90, v92, v93
  v_mul_f32 v94, s52, v94
  v_mfma_f32_32x32x16_bf16 v[48:63], v[16:19], v[232:235], v[48:63]
  v_mul_f32 v95, s52, v95
  v_cvt_pk_bf16_f32 v91, v94, v95
  ds_read_b128 v[16:19], v8 offset:16384
  s_waitcnt lgkmcnt(3)
  v_mfma_f32_32x32x16_bf16 v[32:47], v[20:23], v[172:175], v[32:47]
  v_permlane16_swap_b32 v80, v88
  v_permlane16_swap_b32 v81, v89
  v_permlane16_swap_b32 v82, v90
  v_mfma_f32_32x32x16_bf16 v[48:63], v[20:23], v[236:239], v[48:63]
  v_permlane16_swap_b32 v83, v91
  v_accvgpr_write_b32 a124, v80
  ds_read_b128 v[20:23], v9 offset:16384
  s_waitcnt lgkmcnt(3)
  v_mfma_f32_32x32x16_bf16 v[32:47], v[24:27], v[176:179], v[32:47]
  v_accvgpr_write_b32 a125, v81
  v_accvgpr_write_b32 a126, v82
  v_accvgpr_write_b32 a127, v83
  v_mfma_f32_32x32x16_bf16 v[48:63], v[24:27], v[240:243], v[48:63]
  v_accvgpr_write_b32 a180, v88
  v_accvgpr_write_b32 a181, v89
  ds_read_b128 v[24:27], v10 offset:16384
  s_waitcnt lgkmcnt(3)
  v_mfma_f32_32x32x16_bf16 v[32:47], v[28:31], v[180:183], v[32:47]
  v_accvgpr_write_b32 a182, v90
  v_accvgpr_write_b32 a183, v91
  v_mfma_f32_32x32x16_bf16 v[48:63], v[28:31], v[244:247], v[48:63]
  s_waitcnt vmcnt(16)
  s_barrier
  ds_read_b128 v[28:31], v11 offset:16384
  s_waitcnt lgkmcnt(3)
  v_mfma_f32_32x32x16_bf16 v[64:79], v[16:19], v[120:123], 0
  s_add_u32 s22, s27, 3145728
  s_add_u32 m0, s25, 49152
  s_nop 0
  buffer_load_dwordx4 v4, s[56:59], s22 offen offset:0 lds
  v_mfma_f32_32x32x16_bf16 v[80:95], v[16:19], v[184:187], 0
  ds_read_b128 v[16:19], v12 offset:16384
  s_waitcnt lgkmcnt(3)
  v_mfma_f32_32x32x16_bf16 v[64:79], v[20:23], v[124:127], v[64:79]
  buffer_load_dwordx4 v5, s[56:59], s22 offen offset:1024 lds
  v_mul_f32 v32, s52, v32
  v_mul_f32 v33, s52, v33
  v_cvt_pk_bf16_f32 v32, v32, v33
  v_mfma_f32_32x32x16_bf16 v[80:95], v[20:23], v[188:191], v[80:95]
  v_mul_f32 v34, s52, v34
  v_mul_f32 v35, s52, v35
  ds_read_b128 v[20:23], v13 offset:16384
  s_waitcnt lgkmcnt(3)
  v_mfma_f32_32x32x16_bf16 v[64:79], v[24:27], v[128:131], v[64:79]
  buffer_load_dwordx4 v6, s[56:59], s22 offen offset:2048 lds
  v_cvt_pk_bf16_f32 v33, v34, v35
  v_mul_f32 v36, s52, v36
  v_mul_f32 v37, s52, v37
  v_mfma_f32_32x32x16_bf16 v[80:95], v[24:27], v[192:195], v[80:95]
  v_cvt_pk_bf16_f32 v34, v36, v37
  v_mul_f32 v38, s52, v38
  ds_read_b128 v[24:27], v14 offset:16384
  s_waitcnt lgkmcnt(3)
  v_mfma_f32_32x32x16_bf16 v[64:79], v[28:31], v[132:135], v[64:79]
  buffer_load_dwordx4 v7, s[56:59], s22 offen offset:3072 lds
  v_mul_f32 v39, s52, v39
  v_cvt_pk_bf16_f32 v35, v38, v39
  v_mul_f32 v40, s52, v40
  v_mfma_f32_32x32x16_bf16 v[80:95], v[28:31], v[196:199], v[80:95]
  v_mul_f32 v41, s52, v41
  v_cvt_pk_bf16_f32 v40, v40, v41
  ds_read_b128 v[28:31], v15 offset:16384
  s_waitcnt lgkmcnt(3)
  v_mfma_f32_32x32x16_bf16 v[64:79], v[16:19], v[136:139], v[64:79]
  s_add_u32 s22, s27, 3407872
  s_add_u32 m0, s25, 65536
  s_nop 0
  buffer_load_dwordx4 v4, s[56:59], s22 offen offset:0 lds
  v_mul_f32 v42, s52, v42
  v_mul_f32 v43, s52, v43
  v_cvt_pk_bf16_f32 v41, v42, v43
  v_mfma_f32_32x32x16_bf16 v[80:95], v[16:19], v[200:203], v[80:95]
  v_mul_f32 v44, s52, v44
  v_mul_f32 v45, s52, v45
  ds_read_b128 v[16:19], v8 offset:16640
  s_waitcnt lgkmcnt(3)
  v_mfma_f32_32x32x16_bf16 v[64:79], v[20:23], v[140:143], v[64:79]
  buffer_load_dwordx4 v5, s[56:59], s22 offen offset:1024 lds
  v_cvt_pk_bf16_f32 v42, v44, v45
  v_mul_f32 v46, s52, v46
  v_mul_f32 v47, s52, v47
  v_mfma_f32_32x32x16_bf16 v[80:95], v[20:23], v[204:207], v[80:95]
  v_cvt_pk_bf16_f32 v43, v46, v47
  v_permlane16_swap_b32 v32, v40
  ds_read_b128 v[20:23], v9 offset:16640
  s_waitcnt lgkmcnt(3)
  v_mfma_f32_32x32x16_bf16 v[64:79], v[24:27], v[144:147], v[64:79]
  buffer_load_dwordx4 v6, s[56:59], s22 offen offset:2048 lds
  v_permlane16_swap_b32 v33, v41
  v_permlane16_swap_b32 v34, v42
  v_permlane16_swap_b32 v35, v43
  v_mfma_f32_32x32x16_bf16 v[80:95], v[24:27], v[208:211], v[80:95]
  v_accvgpr_write_b32 a16, v32
  v_accvgpr_write_b32 a17, v33
  ds_read_b128 v[24:27], v10 offset:16640
  s_waitcnt lgkmcnt(3)
  v_mfma_f32_32x32x16_bf16 v[64:79], v[28:31], v[148:151], v[64:79]
  buffer_load_dwordx4 v7, s[56:59], s22 offen offset:3072 lds
  v_accvgpr_write_b32 a18, v34
  v_accvgpr_write_b32 a19, v35
  v_accvgpr_write_b32 a72, v40
  v_mfma_f32_32x32x16_bf16 v[80:95], v[28:31], v[212:215], v[80:95]
  v_accvgpr_write_b32 a73, v41
  v_accvgpr_write_b32 a74, v42
  ds_read_b128 v[28:31], v11 offset:16640
  s_waitcnt lgkmcnt(3)
  v_mfma_f32_32x32x16_bf16 v[64:79], v[16:19], v[152:155], v[64:79]
  v_accvgpr_write_b32 a75, v43
  v_mul_f32 v48, s52, v48
  v_mul_f32 v49, s52, v49
  v_mfma_f32_32x32x16_bf16 v[80:95], v[16:19], v[216:219], v[80:95]
  v_cvt_pk_bf16_f32 v48, v48, v49
  v_mul_f32 v50, s52, v50
  ds_read_b128 v[16:19], v12 offset:16640
  s_waitcnt lgkmcnt(3)
  v_mfma_f32_32x32x16_bf16 v[64:79], v[20:23], v[156:159], v[64:79]
  v_mul_f32 v51, s52, v51
  v_cvt_pk_bf16_f32 v49, v50, v51
  v_mul_f32 v52, s52, v52
  v_mfma_f32_32x32x16_bf16 v[80:95], v[20:23], v[220:223], v[80:95]
  v_mul_f32 v53, s52, v53
  v_cvt_pk_bf16_f32 v50, v52, v53
  ds_read_b128 v[20:23], v13 offset:16640
  s_waitcnt lgkmcnt(3)
  v_mfma_f32_32x32x16_bf16 v[64:79], v[24:27], v[160:163], v[64:79]
  v_mul_f32 v54, s52, v54
  v_mul_f32 v55, s52, v55
  v_cvt_pk_bf16_f32 v51, v54, v55
  v_mfma_f32_32x32x16_bf16 v[80:95], v[24:27], v[224:227], v[80:95]
  v_mul_f32 v56, s52, v56
  v_mul_f32 v57, s52, v57
  ds_read_b128 v[24:27], v14 offset:16640
  s_waitcnt lgkmcnt(3)
  v_mfma_f32_32x32x16_bf16 v[64:79], v[28:31], v[164:167], v[64:79]
  v_cvt_pk_bf16_f32 v56, v56, v57
  v_mul_f32 v58, s52, v58
  v_mul_f32 v59, s52, v59
  v_mfma_f32_32x32x16_bf16 v[80:95], v[28:31], v[228:231], v[80:95]
  v_cvt_pk_bf16_f32 v57, v58, v59
  v_mul_f32 v60, s52, v60
  ds_read_b128 v[28:31], v15 offset:16640
  s_waitcnt lgkmcnt(3)
  v_mfma_f32_32x32x16_bf16 v[64:79], v[16:19], v[168:171], v[64:79]
  v_mul_f32 v61, s52, v61
  v_cvt_pk_bf16_f32 v58, v60, v61
  v_mul_f32 v62, s52, v62
  v_mfma_f32_32x32x16_bf16 v[80:95], v[16:19], v[232:235], v[80:95]
  v_mul_f32 v63, s52, v63
  v_cvt_pk_bf16_f32 v59, v62, v63
  ds_read_b128 v[16:19], v8 offset:32768
  s_waitcnt lgkmcnt(3)
  v_mfma_f32_32x32x16_bf16 v[64:79], v[20:23], v[172:175], v[64:79]
  v_permlane16_swap_b32 v48, v56
  v_permlane16_swap_b32 v49, v57
  v_permlane16_swap_b32 v50, v58
  v_mfma_f32_32x32x16_bf16 v[80:95], v[20:23], v[236:239], v[80:95]
  v_permlane16_swap_b32 v51, v59
  v_accvgpr_write_b32 a128, v48
  ds_read_b128 v[20:23], v9 offset:32768
  s_waitcnt lgkmcnt(3)
  v_mfma_f32_32x32x16_bf16 v[64:79], v[24:27], v[176:179], v[64:79]
  v_accvgpr_write_b32 a129, v49
  v_accvgpr_write_b32 a130, v50
  v_accvgpr_write_b32 a131, v51
  v_mfma_f32_32x32x16_bf16 v[80:95], v[24:27], v[240:243], v[80:95]
  v_accvgpr_write_b32 a184, v56
  v_accvgpr_write_b32 a185, v57
  ds_read_b128 v[24:27], v10 offset:32768
  s_waitcnt lgkmcnt(3)
  v_mfma_f32_32x32x16_bf16 v[64:79], v[28:31], v[180:183], v[64:79]
  v_accvgpr_write_b32 a186, v58
  v_accvgpr_write_b32 a187, v59
  v_mfma_f32_32x32x16_bf16 v[80:95], v[28:31], v[244:247], v[80:95]
  ds_read_b128 v[28:31], v11 offset:32768
  s_waitcnt lgkmcnt(3)
  v_mfma_f32_32x32x16_bf16 v[32:47], v[16:19], v[120:123], 0
  v_mfma_f32_32x32x16_bf16 v[48:63], v[16:19], v[184:187], 0
  ds_read_b128 v[16:19], v12 offset:32768
  s_waitcnt lgkmcnt(3)
  v_mfma_f32_32x32x16_bf16 v[32:47], v[20:23], v[124:127], v[32:47]
  v_mul_f32 v64, s52, v64
  v_mul_f32 v65, s52, v65
  v_cvt_pk_bf16_f32 v64, v64, v65
  v_mfma_f32_32x32x16_bf16 v[48:63], v[20:23], v[188:191], v[48:63]
  v_mul_f32 v66, s52, v66
  v_mul_f32 v67, s52, v67
  ds_read_b128 v[20:23], v13 offset:32768
  s_waitcnt lgkmcnt(3)
  v_mfma_f32_32x32x16_bf16 v[32:47], v[24:27], v[128:131], v[32:47]
  v_cvt_pk_bf16_f32 v65, v66, v67
  v_mul_f32 v68, s52, v68
  v_mul_f32 v69, s52, v69
  v_mfma_f32_32x32x16_bf16 v[48:63], v[24:27], v[192:195], v[48:63]
  v_cvt_pk_bf16_f32 v66, v68, v69
  v_mul_f32 v70, s52, v70
  ds_read_b128 v[24:27], v14 offset:32768
  s_waitcnt lgkmcnt(3)
  v_mfma_f32_32x32x16_bf16 v[32:47], v[28:31], v[132:135], v[32:47]
  v_mul_f32 v71, s52, v71
  v_cvt_pk_bf16_f32 v67, v70, v71
  v_mul_f32 v72, s52, v72
  v_mfma_f32_32x32x16_bf16 v[48:63], v[28:31], v[196:199], v[48:63]
  v_mul_f32 v73, s52, v73
  v_cvt_pk_bf16_f32 v72, v72, v73
  ds_read_b128 v[28:31], v15 offset:32768
  s_waitcnt lgkmcnt(3)
  v_mfma_f32_32x32x16_bf16 v[32:47], v[16:19], v[136:139], v[32:47]
  v_mul_f32 v74, s52, v74
  v_mul_f32 v75, s52, v75
  v_cvt_pk_bf16_f32 v73, v74, v75
  v_mfma_f32_32x32x16_bf16 v[48:63], v[16:19], v[200:203], v[48:63]
  v_mul_f32 v76, s52, v76
  v_mul_f32 v77, s52, v77
  ds_read_b128 v[16:19], v8 offset:33024
  s_waitcnt lgkmcnt(3)
  v_mfma_f32_32x32x16_bf16 v[32:47], v[20:23], v[140:143], v[32:47]
  v_cvt_pk_bf16_f32 v74, v76, v77
  v_mul_f32 v78, s52, v78
  v_mul_f32 v79, s52, v79
  v_mfma_f32_32x32x16_bf16 v[48:63], v[20:23], v[204:207], v[48:63]
  v_cvt_pk_bf16_f32 v75, v78, v79
  v_permlane16_swap_b32 v64, v72
  ds_read_b128 v[20:23], v9 offset:33024
  s_waitcnt lgkmcnt(3)
  v_mfma_f32_32x32x16_bf16 v[32:47], v[24:27], v[144:147], v[32:47]
  v_permlane16_swap_b32 v65, v73
  v_permlane16_swap_b32 v66, v74
  v_permlane16_swap_b32 v67, v75
  v_mfma_f32_32x32x16_bf16 v[48:63], v[24:27], v[208:211], v[48:63]
  v_accvgpr_write_b32 a20, v64
  v_accvgpr_write_b32 a21, v65
  ds_read_b128 v[24:27], v10 offset:33024
  s_waitcnt lgkmcnt(3)
  v_mfma_f32_32x32x16_bf16 v[32:47], v[28:31], v[148:151], v[32:47]
  v_accvgpr_write_b32 a22, v66
  v_accvgpr_write_b32 a23, v67
  v_accvgpr_write_b32 a76, v72
  v_mfma_f32_32x32x16_bf16 v[48:63], v[28:31], v[212:215], v[48:63]
  v_accvgpr_write_b32 a77, v73
  v_accvgpr_write_b32 a78, v74
  ds_read_b128 v[28:31], v11 offset:33024
  s_waitcnt lgkmcnt(3)
  v_mfma_f32_32x32x16_bf16 v[32:47], v[16:19], v[152:155], v[32:47]
  v_accvgpr_write_b32 a79, v75
  v_mul_f32 v80, s52, v80
  v_mul_f32 v81, s52, v81
  v_mfma_f32_32x32x16_bf16 v[48:63], v[16:19], v[216:219], v[48:63]
  v_cvt_pk_bf16_f32 v80, v80, v81
  v_mul_f32 v82, s52, v82
  ds_read_b128 v[16:19], v12 offset:33024
  s_waitcnt lgkmcnt(3)
  v_mfma_f32_32x32x16_bf16 v[32:47], v[20:23], v[156:159], v[32:47]
  v_mul_f32 v83, s52, v83
  v_cvt_pk_bf16_f32 v81, v82, v83
  v_mul_f32 v84, s52, v84
  v_mfma_f32_32x32x16_bf16 v[48:63], v[20:23], v[220:223], v[48:63]
  v_mul_f32 v85, s52, v85
  v_cvt_pk_bf16_f32 v82, v84, v85
  ds_read_b128 v[20:23], v13 offset:33024
  s_waitcnt lgkmcnt(3)
  v_mfma_f32_32x32x16_bf16 v[32:47], v[24:27], v[160:163], v[32:47]
  v_mul_f32 v86, s52, v86
  v_mul_f32 v87, s52, v87
  v_cvt_pk_bf16_f32 v83, v86, v87
  v_mfma_f32_32x32x16_bf16 v[48:63], v[24:27], v[224:227], v[48:63]
  v_mul_f32 v88, s52, v88
  v_mul_f32 v89, s52, v89
  ds_read_b128 v[24:27], v14 offset:33024
  s_waitcnt lgkmcnt(3)
  v_mfma_f32_32x32x16_bf16 v[32:47], v[28:31], v[164:167], v[32:47]
  v_cvt_pk_bf16_f32 v88, v88, v89
  v_mul_f32 v90, s52, v90
  v_mul_f32 v91, s52, v91
  v_mfma_f32_32x32x16_bf16 v[48:63], v[28:31], v[228:231], v[48:63]
  v_cvt_pk_bf16_f32 v89, v90, v91
  v_mul_f32 v92, s52, v92
  ds_read_b128 v[28:31], v15 offset:33024
  s_waitcnt lgkmcnt(3)
  v_mfma_f32_32x32x16_bf16 v[32:47], v[16:19], v[168:171], v[32:47]
  v_mul_f32 v93, s52, v93
  v_cvt_pk_bf16_f32 v90, v92, v93
  v_mul_f32 v94, s52, v94
  v_mfma_f32_32x32x16_bf16 v[48:63], v[16:19], v[232:235], v[48:63]
  v_mul_f32 v95, s52, v95
  v_cvt_pk_bf16_f32 v91, v94, v95
  ds_read_b128 v[16:19], v8 offset:49152
  s_waitcnt lgkmcnt(3)
  v_mfma_f32_32x32x16_bf16 v[32:47], v[20:23], v[172:175], v[32:47]
  v_permlane16_swap_b32 v80, v88
  v_permlane16_swap_b32 v81, v89
  v_permlane16_swap_b32 v82, v90
  v_mfma_f32_32x32x16_bf16 v[48:63], v[20:23], v[236:239], v[48:63]
  v_permlane16_swap_b32 v83, v91
  v_accvgpr_write_b32 a132, v80
  ds_read_b128 v[20:23], v9 offset:49152
  s_waitcnt lgkmcnt(3)
  v_mfma_f32_32x32x16_bf16 v[32:47], v[24:27], v[176:179], v[32:47]
  v_accvgpr_write_b32 a133, v81
  v_accvgpr_write_b32 a134, v82
  v_accvgpr_write_b32 a135, v83
  v_mfma_f32_32x32x16_bf16 v[48:63], v[24:27], v[240:243], v[48:63]
  v_accvgpr_write_b32 a188, v88
  v_accvgpr_write_b32 a189, v89
  ds_read_b128 v[24:27], v10 offset:49152
  s_waitcnt lgkmcnt(3)
  v_mfma_f32_32x32x16_bf16 v[32:47], v[28:31], v[180:183], v[32:47]
  v_accvgpr_write_b32 a190, v90
  v_accvgpr_write_b32 a191, v91
  v_mfma_f32_32x32x16_bf16 v[48:63], v[28:31], v[244:247], v[48:63]
  s_waitcnt vmcnt(16)
  s_barrier
  ds_read_b128 v[28:31], v11 offset:49152
  s_waitcnt lgkmcnt(3)
  v_mfma_f32_32x32x16_bf16 v[64:79], v[16:19], v[120:123], 0
  v_mfma_f32_32x32x16_bf16 v[80:95], v[16:19], v[184:187], 0
  ds_read_b128 v[16:19], v12 offset:49152
  s_waitcnt lgkmcnt(3)
  v_mfma_f32_32x32x16_bf16 v[64:79], v[20:23], v[124:127], v[64:79]
  v_mul_f32 v32, s52, v32
  v_mul_f32 v33, s52, v33
  v_cvt_pk_bf16_f32 v32, v32, v33
  v_mfma_f32_32x32x16_bf16 v[80:95], v[20:23], v[188:191], v[80:95]
  v_mul_f32 v34, s52, v34
  v_mul_f32 v35, s52, v35
  ds_read_b128 v[20:23], v13 offset:49152
  s_waitcnt lgkmcnt(3)
  v_mfma_f32_32x32x16_bf16 v[64:79], v[24:27], v[128:131], v[64:79]
  v_cvt_pk_bf16_f32 v33, v34, v35
  v_mul_f32 v36, s52, v36
  v_mul_f32 v37, s52, v37
  v_mfma_f32_32x32x16_bf16 v[80:95], v[24:27], v[192:195], v[80:95]
  v_cvt_pk_bf16_f32 v34, v36, v37
  v_mul_f32 v38, s52, v38
  ds_read_b128 v[24:27], v14 offset:49152
  s_waitcnt lgkmcnt(3)
  v_mfma_f32_32x32x16_bf16 v[64:79], v[28:31], v[132:135], v[64:79]
  v_mul_f32 v39, s52, v39
  v_cvt_pk_bf16_f32 v35, v38, v39
  v_mul_f32 v40, s52, v40
  v_mfma_f32_32x32x16_bf16 v[80:95], v[28:31], v[196:199], v[80:95]
  v_mul_f32 v41, s52, v41
  v_cvt_pk_bf16_f32 v40, v40, v41
  ds_read_b128 v[28:31], v15 offset:49152
  s_waitcnt lgkmcnt(3)
  v_mfma_f32_32x32x16_bf16 v[64:79], v[16:19], v[136:139], v[64:79]
  v_mul_f32 v42, s52, v42
  v_mul_f32 v43, s52, v43
  v_cvt_pk_bf16_f32 v41, v42, v43
  v_mfma_f32_32x32x16_bf16 v[80:95], v[16:19], v[200:203], v[80:95]
  v_mul_f32 v44, s52, v44
  v_mul_f32 v45, s52, v45
  ds_read_b128 v[16:19], v8 offset:49408
  s_waitcnt lgkmcnt(3)
  v_mfma_f32_32x32x16_bf16 v[64:79], v[20:23], v[140:143], v[64:79]
  v_cvt_pk_bf16_f32 v42, v44, v45
  v_mul_f32 v46, s52, v46
  v_mul_f32 v47, s52, v47
  v_mfma_f32_32x32x16_bf16 v[80:95], v[20:23], v[204:207], v[80:95]
  v_cvt_pk_bf16_f32 v43, v46, v47
  v_permlane16_swap_b32 v32, v40
  ds_read_b128 v[20:23], v9 offset:49408
  s_waitcnt lgkmcnt(3)
  v_mfma_f32_32x32x16_bf16 v[64:79], v[24:27], v[144:147], v[64:79]
  v_permlane16_swap_b32 v33, v41
  v_permlane16_swap_b32 v34, v42
  v_permlane16_swap_b32 v35, v43
  v_mfma_f32_32x32x16_bf16 v[80:95], v[24:27], v[208:211], v[80:95]
  v_accvgpr_write_b32 a24, v32
  v_accvgpr_write_b32 a25, v33
  ds_read_b128 v[24:27], v10 offset:49408
  s_waitcnt lgkmcnt(3)
  v_mfma_f32_32x32x16_bf16 v[64:79], v[28:31], v[148:151], v[64:79]
  v_accvgpr_write_b32 a26, v34
  v_accvgpr_write_b32 a27, v35
  v_accvgpr_write_b32 a80, v40
  v_mfma_f32_32x32x16_bf16 v[80:95], v[28:31], v[212:215], v[80:95]
  v_accvgpr_write_b32 a81, v41
  v_accvgpr_write_b32 a82, v42
  ds_read_b128 v[28:31], v11 offset:49408
  s_waitcnt lgkmcnt(3)
  v_mfma_f32_32x32x16_bf16 v[64:79], v[16:19], v[152:155], v[64:79]
  v_accvgpr_write_b32 a83, v43
  v_mul_f32 v48, s52, v48
  v_mul_f32 v49, s52, v49
  v_mfma_f32_32x32x16_bf16 v[80:95], v[16:19], v[216:219], v[80:95]
  v_cvt_pk_bf16_f32 v48, v48, v49
  v_mul_f32 v50, s52, v50
  ds_read_b128 v[16:19], v12 offset:49408
  s_waitcnt lgkmcnt(3)
  v_mfma_f32_32x32x16_bf16 v[64:79], v[20:23], v[156:159], v[64:79]
  v_mul_f32 v51, s52, v51
  v_cvt_pk_bf16_f32 v49, v50, v51
  v_mul_f32 v52, s52, v52
  v_mfma_f32_32x32x16_bf16 v[80:95], v[20:23], v[220:223], v[80:95]
  v_mul_f32 v53, s52, v53
  v_cvt_pk_bf16_f32 v50, v52, v53
  ds_read_b128 v[20:23], v13 offset:49408
  s_waitcnt lgkmcnt(3)
  v_mfma_f32_32x32x16_bf16 v[64:79], v[24:27], v[160:163], v[64:79]
  v_mul_f32 v54, s52, v54
  v_mul_f32 v55, s52, v55
  v_cvt_pk_bf16_f32 v51, v54, v55
  v_mfma_f32_32x32x16_bf16 v[80:95], v[24:27], v[224:227], v[80:95]
  v_mul_f32 v56, s52, v56
  v_mul_f32 v57, s52, v57
  ds_read_b128 v[24:27], v14 offset:49408
  s_waitcnt lgkmcnt(3)
  v_mfma_f32_32x32x16_bf16 v[64:79], v[28:31], v[164:167], v[64:79]
  v_cvt_pk_bf16_f32 v56, v56, v57
  v_mul_f32 v58, s52, v58
  v_mul_f32 v59, s52, v59
  v_mfma_f32_32x32x16_bf16 v[80:95], v[28:31], v[228:231], v[80:95]
  v_cvt_pk_bf16_f32 v57, v58, v59
  v_mul_f32 v60, s52, v60
  ds_read_b128 v[28:31], v15 offset:49408
  s_waitcnt lgkmcnt(3)
  v_mfma_f32_32x32x16_bf16 v[64:79], v[16:19], v[168:171], v[64:79]
  v_mul_f32 v61, s52, v61
  v_cvt_pk_bf16_f32 v58, v60, v61
  v_mul_f32 v62, s52, v62
  v_mfma_f32_32x32x16_bf16 v[80:95], v[16:19], v[232:235], v[80:95]
  v_mul_f32 v63, s52, v63
  v_cvt_pk_bf16_f32 v59, v62, v63
  v_xor_b32 v8, 196608, v8
  ds_read_b128 v[16:19], v8 offset:0
  s_waitcnt lgkmcnt(3)
  v_mfma_f32_32x32x16_bf16 v[64:79], v[20:23], v[172:175], v[64:79]
  v_permlane16_swap_b32 v48, v56
  v_permlane16_swap_b32 v49, v57
  v_permlane16_swap_b32 v50, v58
  v_mfma_f32_32x32x16_bf16 v[80:95], v[20:23], v[236:239], v[80:95]
  v_permlane16_swap_b32 v51, v59
  v_accvgpr_write_b32 a136, v48
  v_xor_b32 v9, 196608, v9
  ds_read_b128 v[20:23], v9 offset:0
  s_waitcnt lgkmcnt(3)
  v_mfma_f32_32x32x16_bf16 v[64:79], v[24:27], v[176:179], v[64:79]
  v_accvgpr_write_b32 a137, v49
  v_accvgpr_write_b32 a138, v50
  v_accvgpr_write_b32 a139, v51
  v_mfma_f32_32x32x16_bf16 v[80:95], v[24:27], v[240:243], v[80:95]
  v_accvgpr_write_b32 a192, v56
  v_accvgpr_write_b32 a193, v57
  v_xor_b32 v10, 196608, v10
  ds_read_b128 v[24:27], v10 offset:0
  s_waitcnt lgkmcnt(3)
  v_mfma_f32_32x32x16_bf16 v[64:79], v[28:31], v[180:183], v[64:79]
  v_accvgpr_write_b32 a194, v58
  v_accvgpr_write_b32 a195, v59
  v_mfma_f32_32x32x16_bf16 v[80:95], v[28:31], v[244:247], v[80:95]
  v_xor_b32 v11, 196608, v11
  ds_read_b128 v[28:31], v11 offset:0
  s_waitcnt lgkmcnt(3)
  v_mfma_f32_32x32x16_bf16 v[32:47], v[16:19], v[120:123], 0
  v_mfma_f32_32x32x16_bf16 v[48:63], v[16:19], v[184:187], 0
  v_xor_b32 v12, 196608, v12
  ds_read_b128 v[16:19], v12 offset:0
  s_waitcnt lgkmcnt(3)
  v_mfma_f32_32x32x16_bf16 v[32:47], v[20:23], v[124:127], v[32:47]
  v_mul_f32 v64, s52, v64
  v_mul_f32 v65, s52, v65
  v_cvt_pk_bf16_f32 v64, v64, v65
  v_mfma_f32_32x32x16_bf16 v[48:63], v[20:23], v[188:191], v[48:63]
  v_mul_f32 v66, s52, v66
  v_mul_f32 v67, s52, v67
  v_xor_b32 v13, 196608, v13
  ds_read_b128 v[20:23], v13 offset:0
  s_waitcnt lgkmcnt(3)
  v_mfma_f32_32x32x16_bf16 v[32:47], v[24:27], v[128:131], v[32:47]
  v_cvt_pk_bf16_f32 v65, v66, v67
  v_mul_f32 v68, s52, v68
  v_mul_f32 v69, s52, v69
  v_mfma_f32_32x32x16_bf16 v[48:63], v[24:27], v[192:195], v[48:63]
  v_cvt_pk_bf16_f32 v66, v68, v69
  v_mul_f32 v70, s52, v70
  v_xor_b32 v14, 196608, v14
  ds_read_b128 v[24:27], v14 offset:0
  s_waitcnt lgkmcnt(3)
  v_mfma_f32_32x32x16_bf16 v[32:47], v[28:31], v[132:135], v[32:47]
  v_mul_f32 v71, s52, v71
  v_cvt_pk_bf16_f32 v67, v70, v71
  v_mul_f32 v72, s52, v72
  v_mfma_f32_32x32x16_bf16 v[48:63], v[28:31], v[196:199], v[48:63]
  v_mul_f32 v73, s52, v73
  v_cvt_pk_bf16_f32 v72, v72, v73
  v_xor_b32 v15, 196608, v15
  ds_read_b128 v[28:31], v15 offset:0
  s_waitcnt lgkmcnt(3)
  v_mfma_f32_32x32x16_bf16 v[32:47], v[16:19], v[136:139], v[32:47]
  v_mul_f32 v74, s52, v74
  v_mul_f32 v75, s52, v75
  v_cvt_pk_bf16_f32 v73, v74, v75
  v_mfma_f32_32x32x16_bf16 v[48:63], v[16:19], v[200:203], v[48:63]
  v_mul_f32 v76, s52, v76
  v_mul_f32 v77, s52, v77
  ds_read_b128 v[16:19], v8 offset:256
  s_waitcnt lgkmcnt(3)
  v_mfma_f32_32x32x16_bf16 v[32:47], v[20:23], v[140:143], v[32:47]
  v_cvt_pk_bf16_f32 v74, v76, v77
  v_mul_f32 v78, s52, v78
  v_mul_f32 v79, s52, v79
  v_mfma_f32_32x32x16_bf16 v[48:63], v[20:23], v[204:207], v[48:63]
  v_cvt_pk_bf16_f32 v75, v78, v79
  v_permlane16_swap_b32 v64, v72
  ds_read_b128 v[20:23], v9 offset:256
  s_waitcnt lgkmcnt(3)
  v_mfma_f32_32x32x16_bf16 v[32:47], v[24:27], v[144:147], v[32:47]
  v_permlane16_swap_b32 v65, v73
  v_permlane16_swap_b32 v66, v74
  v_permlane16_swap_b32 v67, v75
  v_mfma_f32_32x32x16_bf16 v[48:63], v[24:27], v[208:211], v[48:63]
  v_accvgpr_write_b32 a28, v64
  v_accvgpr_write_b32 a29, v65
  ds_read_b128 v[24:27], v10 offset:256
  s_waitcnt lgkmcnt(3)
  v_mfma_f32_32x32x16_bf16 v[32:47], v[28:31], v[148:151], v[32:47]
  v_accvgpr_write_b32 a30, v66
  v_accvgpr_write_b32 a31, v67
  v_accvgpr_write_b32 a84, v72
  v_mfma_f32_32x32x16_bf16 v[48:63], v[28:31], v[212:215], v[48:63]
  v_accvgpr_write_b32 a85, v73
  v_accvgpr_write_b32 a86, v74
  ds_read_b128 v[28:31], v11 offset:256
  s_waitcnt lgkmcnt(3)
  v_mfma_f32_32x32x16_bf16 v[32:47], v[16:19], v[152:155], v[32:47]
  v_accvgpr_write_b32 a87, v75
  v_mul_f32 v80, s52, v80
  v_mul_f32 v81, s52, v81
  v_mfma_f32_32x32x16_bf16 v[48:63], v[16:19], v[216:219], v[48:63]
  v_cvt_pk_bf16_f32 v80, v80, v81
  v_mul_f32 v82, s52, v82
  ds_read_b128 v[16:19], v12 offset:256
  s_waitcnt lgkmcnt(3)
  v_mfma_f32_32x32x16_bf16 v[32:47], v[20:23], v[156:159], v[32:47]
  v_mul_f32 v83, s52, v83
  v_cvt_pk_bf16_f32 v81, v82, v83
  v_mul_f32 v84, s52, v84
  v_mfma_f32_32x32x16_bf16 v[48:63], v[20:23], v[220:223], v[48:63]
  v_mul_f32 v85, s52, v85
  v_cvt_pk_bf16_f32 v82, v84, v85
  ds_read_b128 v[20:23], v13 offset:256
  s_waitcnt lgkmcnt(3)
  v_mfma_f32_32x32x16_bf16 v[32:47], v[24:27], v[160:163], v[32:47]
  v_mul_f32 v86, s52, v86
  v_mul_f32 v87, s52, v87
  v_cvt_pk_bf16_f32 v83, v86, v87
  v_mfma_f32_32x32x16_bf16 v[48:63], v[24:27], v[224:227], v[48:63]
  v_mul_f32 v88, s52, v88
  v_mul_f32 v89, s52, v89
  ds_read_b128 v[24:27], v14 offset:256
  s_waitcnt lgkmcnt(3)
  v_mfma_f32_32x32x16_bf16 v[32:47], v[28:31], v[164:167], v[32:47]
  v_cvt_pk_bf16_f32 v88, v88, v89
  v_mul_f32 v90, s52, v90
  v_mul_f32 v91, s52, v91
  v_mfma_f32_32x32x16_bf16 v[48:63], v[28:31], v[228:231], v[48:63]
  v_cvt_pk_bf16_f32 v89, v90, v91
  v_mul_f32 v92, s52, v92
  ds_read_b128 v[28:31], v15 offset:256
  s_waitcnt lgkmcnt(3)
  v_mfma_f32_32x32x16_bf16 v[32:47], v[16:19], v[168:171], v[32:47]
  v_mul_f32 v93, s52, v93
  v_cvt_pk_bf16_f32 v90, v92, v93
  v_mul_f32 v94, s52, v94
  v_mfma_f32_32x32x16_bf16 v[48:63], v[16:19], v[232:235], v[48:63]
  v_mul_f32 v95, s52, v95
  v_cvt_pk_bf16_f32 v91, v94, v95
  v_xor_b32 v8, 131072, v8
  ds_read_b128 v[16:19], v8 offset:0
  s_waitcnt lgkmcnt(3)
  v_mfma_f32_32x32x16_bf16 v[32:47], v[20:23], v[172:175], v[32:47]
  v_permlane16_swap_b32 v80, v88
  v_permlane16_swap_b32 v81, v89
  v_permlane16_swap_b32 v82, v90
  v_mfma_f32_32x32x16_bf16 v[48:63], v[20:23], v[236:239], v[48:63]
  v_permlane16_swap_b32 v83, v91
  v_accvgpr_write_b32 a140, v80
  v_xor_b32 v9, 131072, v9
  ds_read_b128 v[20:23], v9 offset:0
  s_waitcnt lgkmcnt(3)
  v_mfma_f32_32x32x16_bf16 v[32:47], v[24:27], v[176:179], v[32:47]
  v_accvgpr_write_b32 a141, v81
  v_accvgpr_write_b32 a142, v82
  v_accvgpr_write_b32 a143, v83
  v_mfma_f32_32x32x16_bf16 v[48:63], v[24:27], v[240:243], v[48:63]
  v_accvgpr_write_b32 a196, v88
  v_accvgpr_write_b32 a197, v89
  v_xor_b32 v10, 131072, v10
  ds_read_b128 v[24:27], v10 offset:0
  s_waitcnt lgkmcnt(3)
  v_mfma_f32_32x32x16_bf16 v[32:47], v[28:31], v[180:183], v[32:47]
  v_accvgpr_write_b32 a198, v90
  v_accvgpr_write_b32 a199, v91
  v_mfma_f32_32x32x16_bf16 v[48:63], v[28:31], v[244:247], v[48:63]
  s_waitcnt vmcnt(8)
  s_barrier
  v_xor_b32 v11, 131072, v11
  ds_read_b128 v[28:31], v11 offset:0
  s_waitcnt lgkmcnt(3)
  v_mfma_f32_32x32x16_bf16 v[64:79], v[16:19], v[120:123], 0
  v_mfma_f32_32x32x16_bf16 v[80:95], v[16:19], v[184:187], 0
  v_xor_b32 v12, 131072, v12
  ds_read_b128 v[16:19], v12 offset:0
  s_waitcnt lgkmcnt(3)
  v_mfma_f32_32x32x16_bf16 v[64:79], v[20:23], v[124:127], v[64:79]
  v_mul_f32 v32, s52, v32
  v_mul_f32 v33, s52, v33
  v_cvt_pk_bf16_f32 v32, v32, v33
  v_mfma_f32_32x32x16_bf16 v[80:95], v[20:23], v[188:191], v[80:95]
  v_mul_f32 v34, s52, v34
  v_mul_f32 v35, s52, v35
  v_xor_b32 v13, 131072, v13
  ds_read_b128 v[20:23], v13 offset:0
  s_waitcnt lgkmcnt(3)
  v_mfma_f32_32x32x16_bf16 v[64:79], v[24:27], v[128:131], v[64:79]
  v_cvt_pk_bf16_f32 v33, v34, v35
  v_mul_f32 v36, s52, v36
  v_mul_f32 v37, s52, v37
  v_mfma_f32_32x32x16_bf16 v[80:95], v[24:27], v[192:195], v[80:95]
  v_cvt_pk_bf16_f32 v34, v36, v37
  v_mul_f32 v38, s52, v38
  v_xor_b32 v14, 131072, v14
  ds_read_b128 v[24:27], v14 offset:0
  s_waitcnt lgkmcnt(3)
  v_mfma_f32_32x32x16_bf16 v[64:79], v[28:31], v[132:135], v[64:79]
  v_mul_f32 v39, s52, v39
  v_cvt_pk_bf16_f32 v35, v38, v39
  v_mul_f32 v40, s52, v40
  v_mfma_f32_32x32x16_bf16 v[80:95], v[28:31], v[196:199], v[80:95]
  v_mul_f32 v41, s52, v41
  v_cvt_pk_bf16_f32 v40, v40, v41
  v_xor_b32 v15, 131072, v15
  ds_read_b128 v[28:31], v15 offset:0
  s_waitcnt lgkmcnt(3)
  v_mfma_f32_32x32x16_bf16 v[64:79], v[16:19], v[136:139], v[64:79]
  v_mul_f32 v42, s52, v42
  v_mul_f32 v43, s52, v43
  v_cvt_pk_bf16_f32 v41, v42, v43
  v_mfma_f32_32x32x16_bf16 v[80:95], v[16:19], v[200:203], v[80:95]
  v_mul_f32 v44, s52, v44
  v_mul_f32 v45, s52, v45
  ds_read_b128 v[16:19], v8 offset:256
  s_waitcnt lgkmcnt(3)
  v_mfma_f32_32x32x16_bf16 v[64:79], v[20:23], v[140:143], v[64:79]
  v_cvt_pk_bf16_f32 v42, v44, v45
  v_mul_f32 v46, s52, v46
  v_mul_f32 v47, s52, v47
  v_mfma_f32_32x32x16_bf16 v[80:95], v[20:23], v[204:207], v[80:95]
  v_cvt_pk_bf16_f32 v43, v46, v47
  v_permlane16_swap_b32 v32, v40
  ds_read_b128 v[20:23], v9 offset:256
  s_waitcnt lgkmcnt(3)
  v_mfma_f32_32x32x16_bf16 v[64:79], v[24:27], v[144:147], v[64:79]
  v_permlane16_swap_b32 v33, v41
  v_permlane16_swap_b32 v34, v42
  v_permlane16_swap_b32 v35, v43
  v_mfma_f32_32x32x16_bf16 v[80:95], v[24:27], v[208:211], v[80:95]
  v_accvgpr_write_b32 a32, v32
  v_accvgpr_write_b32 a33, v33
  ds_read_b128 v[24:27], v10 offset:256
  s_waitcnt lgkmcnt(3)
  v_mfma_f32_32x32x16_bf16 v[64:79], v[28:31], v[148:151], v[64:79]
  v_accvgpr_write_b32 a34, v34
  v_accvgpr_write_b32 a35, v35
  v_accvgpr_write_b32 a88, v40
  v_mfma_f32_32x32x16_bf16 v[80:95], v[28:31], v[212:215], v[80:95]
  v_accvgpr_write_b32 a89, v41
  v_accvgpr_write_b32 a90, v42
  ds_read_b128 v[28:31], v11 offset:256
  s_waitcnt lgkmcnt(3)
  v_mfma_f32_32x32x16_bf16 v[64:79], v[16:19], v[152:155], v[64:79]
  v_accvgpr_write_b32 a91, v43
  v_mul_f32 v48, s52, v48
  v_mul_f32 v49, s52, v49
  v_mfma_f32_32x32x16_bf16 v[80:95], v[16:19], v[216:219], v[80:95]
  v_cvt_pk_bf16_f32 v48, v48, v49
  v_mul_f32 v50, s52, v50
  ds_read_b128 v[16:19], v12 offset:256
  s_waitcnt lgkmcnt(3)
  v_mfma_f32_32x32x16_bf16 v[64:79], v[20:23], v[156:159], v[64:79]
  v_mul_f32 v51, s52, v51
  v_cvt_pk_bf16_f32 v49, v50, v51
  v_mul_f32 v52, s52, v52
  v_mfma_f32_32x32x16_bf16 v[80:95], v[20:23], v[220:223], v[80:95]
  v_mul_f32 v53, s52, v53
  v_cvt_pk_bf16_f32 v50, v52, v53
  ds_read_b128 v[20:23], v13 offset:256
  s_waitcnt lgkmcnt(3)
  v_mfma_f32_32x32x16_bf16 v[64:79], v[24:27], v[160:163], v[64:79]
  v_mul_f32 v54, s52, v54
  v_mul_f32 v55, s52, v55
  v_cvt_pk_bf16_f32 v51, v54, v55
  v_mfma_f32_32x32x16_bf16 v[80:95], v[24:27], v[224:227], v[80:95]
  v_mul_f32 v56, s52, v56
  v_mul_f32 v57, s52, v57
  ds_read_b128 v[24:27], v14 offset:256
  s_waitcnt lgkmcnt(3)
  v_mfma_f32_32x32x16_bf16 v[64:79], v[28:31], v[164:167], v[64:79]
  v_cvt_pk_bf16_f32 v56, v56, v57
  v_mul_f32 v58, s52, v58
  v_mul_f32 v59, s52, v59
  v_mfma_f32_32x32x16_bf16 v[80:95], v[28:31], v[228:231], v[80:95]
  v_cvt_pk_bf16_f32 v57, v58, v59
  v_mul_f32 v60, s52, v60
  ds_read_b128 v[28:31], v15 offset:256
  s_waitcnt lgkmcnt(3)
  v_mfma_f32_32x32x16_bf16 v[64:79], v[16:19], v[168:171], v[64:79]
  v_mul_f32 v61, s52, v61
  v_cvt_pk_bf16_f32 v58, v60, v61
  v_mul_f32 v62, s52, v62
  v_mfma_f32_32x32x16_bf16 v[80:95], v[16:19], v[232:235], v[80:95]
  v_mul_f32 v63, s52, v63
  v_cvt_pk_bf16_f32 v59, v62, v63
  ds_read_b128 v[16:19], v8 offset:16384
  s_waitcnt lgkmcnt(3)
  v_mfma_f32_32x32x16_bf16 v[64:79], v[20:23], v[172:175], v[64:79]
  v_permlane16_swap_b32 v48, v56
  v_permlane16_swap_b32 v49, v57
  v_permlane16_swap_b32 v50, v58
  v_mfma_f32_32x32x16_bf16 v[80:95], v[20:23], v[236:239], v[80:95]
  v_permlane16_swap_b32 v51, v59
  v_accvgpr_write_b32 a144, v48
  ds_read_b128 v[20:23], v9 offset:16384
  s_waitcnt lgkmcnt(3)
  v_mfma_f32_32x32x16_bf16 v[64:79], v[24:27], v[176:179], v[64:79]
  v_accvgpr_write_b32 a145, v49
  v_accvgpr_write_b32 a146, v50
  v_accvgpr_write_b32 a147, v51
  v_mfma_f32_32x32x16_bf16 v[80:95], v[24:27], v[240:243], v[80:95]
  v_accvgpr_write_b32 a200, v56
  v_accvgpr_write_b32 a201, v57
  ds_read_b128 v[24:27], v10 offset:16384
  s_waitcnt lgkmcnt(3)
  v_mfma_f32_32x32x16_bf16 v[64:79], v[28:31], v[180:183], v[64:79]
  v_accvgpr_write_b32 a202, v58
  v_accvgpr_write_b32 a203, v59
  v_mfma_f32_32x32x16_bf16 v[80:95], v[28:31], v[244:247], v[80:95]
  ds_read_b128 v[28:31], v11 offset:16384
  s_waitcnt lgkmcnt(3)
  v_mfma_f32_32x32x16_bf16 v[32:47], v[16:19], v[120:123], 0
  v_mfma_f32_32x32x16_bf16 v[48:63], v[16:19], v[184:187], 0
  ds_read_b128 v[16:19], v12 offset:16384
  s_waitcnt lgkmcnt(3)
  v_mfma_f32_32x32x16_bf16 v[32:47], v[20:23], v[124:127], v[32:47]
  v_mul_f32 v64, s52, v64
  v_mul_f32 v65, s52, v65
  v_cvt_pk_bf16_f32 v64, v64, v65
  v_mfma_f32_32x32x16_bf16 v[48:63], v[20:23], v[188:191], v[48:63]
  v_mul_f32 v66, s52, v66
  v_mul_f32 v67, s52, v67
  ds_read_b128 v[20:23], v13 offset:16384
  s_waitcnt lgkmcnt(3)
  v_mfma_f32_32x32x16_bf16 v[32:47], v[24:27], v[128:131], v[32:47]
  v_cvt_pk_bf16_f32 v65, v66, v67
  v_mul_f32 v68, s52, v68
  v_mul_f32 v69, s52, v69
  v_mfma_f32_32x32x16_bf16 v[48:63], v[24:27], v[192:195], v[48:63]
  v_cvt_pk_bf16_f32 v66, v68, v69
  v_mul_f32 v70, s52, v70
  ds_read_b128 v[24:27], v14 offset:16384
  s_waitcnt lgkmcnt(3)
  v_mfma_f32_32x32x16_bf16 v[32:47], v[28:31], v[132:135], v[32:47]
  v_mul_f32 v71, s52, v71
  v_cvt_pk_bf16_f32 v67, v70, v71
  v_mul_f32 v72, s52, v72
  v_mfma_f32_32x32x16_bf16 v[48:63], v[28:31], v[196:199], v[48:63]
  v_mul_f32 v73, s52, v73
  v_cvt_pk_bf16_f32 v72, v72, v73
  ds_read_b128 v[28:31], v15 offset:16384
  s_waitcnt lgkmcnt(3)
  v_mfma_f32_32x32x16_bf16 v[32:47], v[16:19], v[136:139], v[32:47]
  buffer_load_dwordx4 v[100:103], v113, s[8:11], s28 offen sc1
  v_mul_f32 v74, s52, v74
  v_mul_f32 v75, s52, v75
  v_cvt_pk_bf16_f32 v73, v74, v75
  v_mfma_f32_32x32x16_bf16 v[48:63], v[16:19], v[200:203], v[48:63]
  v_mul_f32 v76, s52, v76
  v_mul_f32 v77, s52, v77
  ds_read_b128 v[16:19], v8 offset:16640
  s_waitcnt lgkmcnt(3)
  v_mfma_f32_32x32x16_bf16 v[32:47], v[20:23], v[140:143], v[32:47]
  v_cvt_pk_bf16_f32 v74, v76, v77
  v_mul_f32 v78, s52, v78
  v_mul_f32 v79, s52, v79
  v_mfma_f32_32x32x16_bf16 v[48:63], v[20:23], v[204:207], v[48:63]
  v_cvt_pk_bf16_f32 v75, v78, v79
  v_permlane16_swap_b32 v64, v72
  ds_read_b128 v[20:23], v9 offset:16640
  s_waitcnt lgkmcnt(3)
  v_mfma_f32_32x32x16_bf16 v[32:47], v[24:27], v[144:147], v[32:47]
  v_permlane16_swap_b32 v65, v73
  v_permlane16_swap_b32 v66, v74
  v_permlane16_swap_b32 v67, v75
  v_mfma_f32_32x32x16_bf16 v[48:63], v[24:27], v[208:211], v[48:63]
  v_accvgpr_write_b32 a36, v64
  v_accvgpr_write_b32 a37, v65
  ds_read_b128 v[24:27], v10 offset:16640
  s_waitcnt lgkmcnt(3)
  v_mfma_f32_32x32x16_bf16 v[32:47], v[28:31], v[148:151], v[32:47]
  v_accvgpr_write_b32 a38, v66
  v_accvgpr_write_b32 a39, v67
  v_accvgpr_write_b32 a92, v72
  v_mfma_f32_32x32x16_bf16 v[48:63], v[28:31], v[212:215], v[48:63]
  v_accvgpr_write_b32 a93, v73
  v_accvgpr_write_b32 a94, v74
  ds_read_b128 v[28:31], v11 offset:16640
  s_waitcnt lgkmcnt(3)
  v_mfma_f32_32x32x16_bf16 v[32:47], v[16:19], v[152:155], v[32:47]
  v_accvgpr_write_b32 a95, v75
  v_mul_f32 v80, s52, v80
  v_mul_f32 v81, s52, v81
  v_mfma_f32_32x32x16_bf16 v[48:63], v[16:19], v[216:219], v[48:63]
  v_cvt_pk_bf16_f32 v80, v80, v81
  v_mul_f32 v82, s52, v82
  ds_read_b128 v[16:19], v12 offset:16640
  s_waitcnt lgkmcnt(3)
  v_mfma_f32_32x32x16_bf16 v[32:47], v[20:23], v[156:159], v[32:47]
  v_mul_f32 v83, s52, v83
  v_cvt_pk_bf16_f32 v81, v82, v83
  v_mul_f32 v84, s52, v84
  v_mfma_f32_32x32x16_bf16 v[48:63], v[20:23], v[220:223], v[48:63]
  v_mul_f32 v85, s52, v85
  v_cvt_pk_bf16_f32 v82, v84, v85
  ds_read_b128 v[20:23], v13 offset:16640
  s_waitcnt lgkmcnt(3)
  v_mfma_f32_32x32x16_bf16 v[32:47], v[24:27], v[160:163], v[32:47]
  v_mul_f32 v86, s52, v86
  v_mul_f32 v87, s52, v87
  v_cvt_pk_bf16_f32 v83, v86, v87
  v_mfma_f32_32x32x16_bf16 v[48:63], v[24:27], v[224:227], v[48:63]
  v_mul_f32 v88, s52, v88
  v_mul_f32 v89, s52, v89
  ds_read_b128 v[24:27], v14 offset:16640
  s_waitcnt lgkmcnt(3)
  v_mfma_f32_32x32x16_bf16 v[32:47], v[28:31], v[164:167], v[32:47]
  v_cvt_pk_bf16_f32 v88, v88, v89
  v_mul_f32 v90, s52, v90
  v_mul_f32 v91, s52, v91
  v_mfma_f32_32x32x16_bf16 v[48:63], v[28:31], v[228:231], v[48:63]
  v_cvt_pk_bf16_f32 v89, v90, v91
  v_mul_f32 v92, s52, v92
  ds_read_b128 v[28:31], v15 offset:16640
  s_waitcnt lgkmcnt(3)
  v_mfma_f32_32x32x16_bf16 v[32:47], v[16:19], v[168:171], v[32:47]
  v_mul_f32 v93, s52, v93
  v_cvt_pk_bf16_f32 v90, v92, v93
  v_mul_f32 v94, s52, v94
  v_mfma_f32_32x32x16_bf16 v[48:63], v[16:19], v[232:235], v[48:63]
  v_mul_f32 v95, s52, v95
  v_cvt_pk_bf16_f32 v91, v94, v95
  ds_read_b128 v[16:19], v8 offset:32768
  s_waitcnt lgkmcnt(3)
  v_mfma_f32_32x32x16_bf16 v[32:47], v[20:23], v[172:175], v[32:47]
  v_permlane16_swap_b32 v80, v88
  v_permlane16_swap_b32 v81, v89
  v_permlane16_swap_b32 v82, v90
  v_mfma_f32_32x32x16_bf16 v[48:63], v[20:23], v[236:239], v[48:63]
  v_permlane16_swap_b32 v83, v91
  v_accvgpr_write_b32 a148, v80
  ds_read_b128 v[20:23], v9 offset:32768
  s_waitcnt lgkmcnt(3)
  v_mfma_f32_32x32x16_bf16 v[32:47], v[24:27], v[176:179], v[32:47]
  v_accvgpr_write_b32 a149, v81
  v_accvgpr_write_b32 a150, v82
  v_accvgpr_write_b32 a151, v83
  v_mfma_f32_32x32x16_bf16 v[48:63], v[24:27], v[240:243], v[48:63]
  v_accvgpr_write_b32 a204, v88
  v_accvgpr_write_b32 a205, v89
  ds_read_b128 v[24:27], v10 offset:32768
  s_waitcnt lgkmcnt(3)
  v_mfma_f32_32x32x16_bf16 v[32:47], v[28:31], v[180:183], v[32:47]
  v_accvgpr_write_b32 a206, v90
  v_accvgpr_write_b32 a207, v91
  v_mfma_f32_32x32x16_bf16 v[48:63], v[28:31], v[244:247], v[48:63]
  s_waitcnt vmcnt(1)
  s_barrier
  ds_read_b128 v[28:31], v11 offset:32768
  s_waitcnt lgkmcnt(3)
  v_mfma_f32_32x32x16_bf16 v[64:79], v[16:19], v[120:123], 0
  s_waitcnt vmcnt(0)
  v_cmp_ne_u64 vcc, s[88:89], v[100:101]
  v_cmp_ne_u64 s[54:55], s[88:89], v[102:103]
  s_add_u32 s48, s33, 14336
  v_mfma_f32_32x32x16_bf16 v[80:95], v[16:19], v[184:187], 0
  ds_read_b128 v[16:19], v12 offset:32768
  s_waitcnt lgkmcnt(3)
  v_mfma_f32_32x32x16_bf16 v[64:79], v[20:23], v[124:127], v[64:79]
  s_or_b64 vcc, vcc, s[54:55]
  s_cselect_b32 s48, 0x10000000, s48
  s_add_u32 s22, s48, 0
  s_add_u32 m0, s25, 0
  s_nop 0
  buffer_load_dwordx4 v2, s[8:11], s22 offen sc1 lds
  v_mul_f32 v32, s52, v32
  v_mul_f32 v33, s52, v33
  v_cvt_pk_bf16_f32 v32, v32, v33
  v_mfma_f32_32x32x16_bf16 v[80:95], v[20:23], v[188:191], v[80:95]
  v_mul_f32 v34, s52, v34
  v_mul_f32 v35, s52, v35
  ds_read_b128 v[20:23], v13 offset:32768
  s_waitcnt lgkmcnt(3)
  v_mfma_f32_32x32x16_bf16 v[64:79], v[24:27], v[128:131], v[64:79]
  s_add_u32 s22, s48, 1024
  s_add_u32 m0, s25, 1024
  s_nop 0
  buffer_load_dwordx4 v2, s[8:11], s22 offen sc1 lds
  v_cvt_pk_bf16_f32 v33, v34, v35
  v_mul_f32 v36, s52, v36
  v_mul_f32 v37, s52, v37
  v_mfma_f32_32x32x16_bf16 v[80:95], v[24:27], v[192:195], v[80:95]
  v_cvt_pk_bf16_f32 v34, v36, v37
  v_mul_f32 v38, s52, v38
  ds_read_b128 v[24:27], v14 offset:32768
  s_waitcnt lgkmcnt(3)
  v_mfma_f32_32x32x16_bf16 v[64:79], v[28:31], v[132:135], v[64:79]
  s_add_u32 s22, s48, 2048
  s_add_u32 m0, s25, 2048
  s_nop 0
  buffer_load_dwordx4 v2, s[8:11], s22 offen sc1 lds
  v_mul_f32 v39, s52, v39
  v_cvt_pk_bf16_f32 v35, v38, v39
  v_mul_f32 v40, s52, v40
  v_mfma_f32_32x32x16_bf16 v[80:95], v[28:31], v[196:199], v[80:95]
  v_mul_f32 v41, s52, v41
  v_cvt_pk_bf16_f32 v40, v40, v41
  ds_read_b128 v[28:31], v15 offset:32768
  s_waitcnt lgkmcnt(3)
  v_mfma_f32_32x32x16_bf16 v[64:79], v[16:19], v[136:139], v[64:79]
  s_add_u32 s22, s48, 3072
  s_add_u32 m0, s25, 3072
  s_nop 0
  buffer_load_dwordx4 v2, s[8:11], s22 offen sc1 lds
  v_mul_f32 v42, s52, v42
  v_mul_f32 v43, s52, v43
  v_cvt_pk_bf16_f32 v41, v42, v43
  v_mfma_f32_32x32x16_bf16 v[80:95], v[16:19], v[200:203], v[80:95]
  v_mul_f32 v44, s52, v44
  v_mul_f32 v45, s52, v45
  ds_read_b128 v[16:19], v8 offset:33024
  s_waitcnt lgkmcnt(3)
  v_mfma_f32_32x32x16_bf16 v[64:79], v[20:23], v[140:143], v[64:79]
  s_add_u32 s22, s48, 4096
  s_add_u32 m0, s25, 16384
  s_nop 0
  buffer_load_dwordx4 v2, s[8:11], s22 offen sc1 lds
  buffer_load_dwordx4 v[100:103], v113, s[8:11], s28 offen sc1
  v_cvt_pk_bf16_f32 v42, v44, v45
  v_mul_f32 v46, s52, v46
  v_mul_f32 v47, s52, v47
  v_mfma_f32_32x32x16_bf16 v[80:95], v[20:23], v[204:207], v[80:95]
  v_cvt_pk_bf16_f32 v43, v46, v47
  v_permlane16_swap_b32 v32, v40
  ds_read_b128 v[20:23], v9 offset:33024
  s_waitcnt lgkmcnt(3)
  v_mfma_f32_32x32x16_bf16 v[64:79], v[24:27], v[144:147], v[64:79]
  s_add_u32 s22, s48, 5120
  s_add_u32 m0, s25, 17408
  s_nop 0
  buffer_load_dwordx4 v2, s[8:11], s22 offen sc1 lds
  v_permlane16_swap_b32 v33, v41
  v_permlane16_swap_b32 v34, v42
  v_permlane16_swap_b32 v35, v43
  v_mfma_f32_32x32x16_bf16 v[80:95], v[24:27], v[208:211], v[80:95]
  v_accvgpr_write_b32 a40, v32
  v_accvgpr_write_b32 a41, v33
  ds_read_b128 v[24:27], v10 offset:33024
  s_waitcnt lgkmcnt(3)
  v_mfma_f32_32x32x16_bf16 v[64:79], v[28:31], v[148:151], v[64:79]
  s_add_u32 s22, s48, 6144
  s_add_u32 m0, s25, 18432
  s_nop 0
  buffer_load_dwordx4 v2, s[8:11], s22 offen sc1 lds
  v_accvgpr_write_b32 a42, v34
  v_accvgpr_write_b32 a43, v35
  v_accvgpr_write_b32 a96, v40
  v_mfma_f32_32x32x16_bf16 v[80:95], v[28:31], v[212:215], v[80:95]
  v_accvgpr_write_b32 a97, v41
  v_accvgpr_write_b32 a98, v42
  ds_read_b128 v[28:31], v11 offset:33024
  s_waitcnt lgkmcnt(3)
  v_mfma_f32_32x32x16_bf16 v[64:79], v[16:19], v[152:155], v[64:79]
  s_add_u32 s22, s48, 7168
  s_add_u32 m0, s25, 19456
  s_nop 0
  buffer_load_dwordx4 v2, s[8:11], s22 offen sc1 lds
  v_accvgpr_write_b32 a99, v43
  v_mul_f32 v48, s52, v48
  v_mul_f32 v49, s52, v49
  v_mfma_f32_32x32x16_bf16 v[80:95], v[16:19], v[216:219], v[80:95]
  v_cvt_pk_bf16_f32 v48, v48, v49
  v_mul_f32 v50, s52, v50
  ds_read_b128 v[16:19], v12 offset:33024
  s_waitcnt lgkmcnt(3)
  v_mfma_f32_32x32x16_bf16 v[64:79], v[20:23], v[156:159], v[64:79]
  s_add_u32 s22, s48, 8192
  s_add_u32 m0, s25, 81920
  s_nop 0
  buffer_load_dwordx4 v2, s[8:11], s22 offen sc1 lds
  v_mul_f32 v51, s52, v51
  v_cvt_pk_bf16_f32 v49, v50, v51
  v_mul_f32 v52, s52, v52
  v_mfma_f32_32x32x16_bf16 v[80:95], v[20:23], v[220:223], v[80:95]
  v_mul_f32 v53, s52, v53
  v_cvt_pk_bf16_f32 v50, v52, v53
  ds_read_b128 v[20:23], v13 offset:33024
  s_waitcnt lgkmcnt(3)
  v_mfma_f32_32x32x16_bf16 v[64:79], v[24:27], v[160:163], v[64:79]
  s_add_u32 s22, s48, 9216
  s_add_u32 m0, s25, 82944
  s_nop 0
  buffer_load_dwordx4 v2, s[8:11], s22 offen sc1 lds
  v_mul_f32 v54, s52, v54
  v_mul_f32 v55, s52, v55
  v_cvt_pk_bf16_f32 v51, v54, v55
  v_mfma_f32_32x32x16_bf16 v[80:95], v[24:27], v[224:227], v[80:95]
  v_mul_f32 v56, s52, v56
  v_mul_f32 v57, s52, v57
  ds_read_b128 v[24:27], v14 offset:33024
  s_waitcnt lgkmcnt(3)
  v_mfma_f32_32x32x16_bf16 v[64:79], v[28:31], v[164:167], v[64:79]
  s_add_u32 s22, s48, 10240
  s_add_u32 m0, s25, 83968
  s_nop 0
  buffer_load_dwordx4 v2, s[8:11], s22 offen sc1 lds
  v_cvt_pk_bf16_f32 v56, v56, v57
  v_mul_f32 v58, s52, v58
  v_mul_f32 v59, s52, v59
  v_mfma_f32_32x32x16_bf16 v[80:95], v[28:31], v[228:231], v[80:95]
  v_cvt_pk_bf16_f32 v57, v58, v59
  v_mul_f32 v60, s52, v60
  ds_read_b128 v[28:31], v15 offset:33024
  s_waitcnt lgkmcnt(3)
  v_mfma_f32_32x32x16_bf16 v[64:79], v[16:19], v[168:171], v[64:79]
  s_add_u32 s22, s48, 11264
  s_add_u32 m0, s25, 84992
  s_nop 0
  buffer_load_dwordx4 v2, s[8:11], s22 offen sc1 lds
  v_mul_f32 v61, s52, v61
  v_cvt_pk_bf16_f32 v58, v60, v61
  v_mul_f32 v62, s52, v62
  v_mfma_f32_32x32x16_bf16 v[80:95], v[16:19], v[232:235], v[80:95]
  v_mul_f32 v63, s52, v63
  v_cvt_pk_bf16_f32 v59, v62, v63
  ds_read_b128 v[16:19], v8 offset:49152
  s_waitcnt lgkmcnt(3)
  v_mfma_f32_32x32x16_bf16 v[64:79], v[20:23], v[172:175], v[64:79]
  s_add_u32 s22, s48, 12288
  s_add_u32 m0, s25, 98304
  s_nop 0
  buffer_load_dwordx4 v2, s[8:11], s22 offen sc1 lds
  v_permlane16_swap_b32 v48, v56
  v_permlane16_swap_b32 v49, v57
  v_permlane16_swap_b32 v50, v58
  v_mfma_f32_32x32x16_bf16 v[80:95], v[20:23], v[236:239], v[80:95]
  v_permlane16_swap_b32 v51, v59
  v_accvgpr_write_b32 a152, v48
  ds_read_b128 v[20:23], v9 offset:49152
  s_waitcnt lgkmcnt(3)
  v_mfma_f32_32x32x16_bf16 v[64:79], v[24:27], v[176:179], v[64:79]
  s_add_u32 s22, s48, 13312
  s_add_u32 m0, s25, 99328
  s_nop 0
  buffer_load_dwordx4 v2, s[8:11], s22 offen sc1 lds
  v_accvgpr_write_b32 a153, v49
  v_accvgpr_write_b32 a154, v50
  v_accvgpr_write_b32 a155, v51
  v_mfma_f32_32x32x16_bf16 v[80:95], v[24:27], v[240:243], v[80:95]
  v_accvgpr_write_b32 a208, v56
  v_accvgpr_write_b32 a209, v57
  ds_read_b128 v[24:27], v10 offset:49152
  s_waitcnt lgkmcnt(3)
  v_mfma_f32_32x32x16_bf16 v[64:79], v[28:31], v[180:183], v[64:79]
  v_accvgpr_write_b32 a210, v58
  v_accvgpr_write_b32 a211, v59
  v_mfma_f32_32x32x16_bf16 v[80:95], v[28:31], v[244:247], v[80:95]
  ds_read_b128 v[28:31], v11 offset:49152
  s_waitcnt lgkmcnt(3)
  v_mfma_f32_32x32x16_bf16 v[32:47], v[16:19], v[120:123], 0
  s_waitcnt vmcnt(9)
  v_cmp_ne_u64 vcc, s[88:89], v[100:101]
  v_cmp_ne_u64 s[54:55], s[88:89], v[102:103]
  s_add_u32 s49, s32, 0
  v_mfma_f32_32x32x16_bf16 v[48:63], v[16:19], v[184:187], 0
  ds_read_b128 v[16:19], v12 offset:49152
  s_waitcnt lgkmcnt(3)
  v_mfma_f32_32x32x16_bf16 v[32:47], v[20:23], v[124:127], v[32:47]
  s_or_b64 vcc, vcc, s[54:55]
  s_cselect_b32 s49, 0x10000000, s49
  s_add_u32 s22, s49, 0
  s_add_u32 m0, s25, 100352
  s_nop 0
  buffer_load_dwordx4 v2, s[8:11], s22 offen sc1 lds
  v_mul_f32 v64, s52, v64
  v_mul_f32 v65, s52, v65
  v_cvt_pk_bf16_f32 v64, v64, v65
  v_mfma_f32_32x32x16_bf16 v[48:63], v[20:23], v[188:191], v[48:63]
  v_mul_f32 v66, s52, v66
  v_mul_f32 v67, s52, v67
  ds_read_b128 v[20:23], v13 offset:49152
  s_waitcnt lgkmcnt(3)
  v_mfma_f32_32x32x16_bf16 v[32:47], v[24:27], v[128:131], v[32:47]
  s_add_u32 s22, s49, 1024
  s_add_u32 m0, s25, 101376
  s_nop 0
  buffer_load_dwordx4 v2, s[8:11], s22 offen sc1 lds
  v_cvt_pk_bf16_f32 v65, v66, v67
  v_mul_f32 v68, s52, v68
  v_mul_f32 v69, s52, v69
  v_mfma_f32_32x32x16_bf16 v[48:63], v[24:27], v[192:195], v[48:63]
  v_cvt_pk_bf16_f32 v66, v68, v69
  v_mul_f32 v70, s52, v70
  ds_read_b128 v[24:27], v14 offset:49152
  s_waitcnt lgkmcnt(3)
  v_mfma_f32_32x32x16_bf16 v[32:47], v[28:31], v[132:135], v[32:47]
  s_add_u32 s22, s49, 2048
  s_add_u32 m0, s25, 114688
  s_nop 0
  buffer_load_dwordx4 v2, s[8:11], s22 offen sc1 lds
  v_mul_f32 v71, s52, v71
  v_cvt_pk_bf16_f32 v67, v70, v71
  v_mul_f32 v72, s52, v72
  v_mfma_f32_32x32x16_bf16 v[48:63], v[28:31], v[196:199], v[48:63]
  v_mul_f32 v73, s52, v73
  v_cvt_pk_bf16_f32 v72, v72, v73
  ds_read_b128 v[28:31], v15 offset:49152
  s_waitcnt lgkmcnt(3)
  v_mfma_f32_32x32x16_bf16 v[32:47], v[16:19], v[136:139], v[32:47]
  s_add_u32 s22, s49, 3072
  s_add_u32 m0, s25, 115712
  s_nop 0
  buffer_load_dwordx4 v2, s[8:11], s22 offen sc1 lds
  v_mul_f32 v74, s52, v74
  v_mul_f32 v75, s52, v75
  v_cvt_pk_bf16_f32 v73, v74, v75
  v_mfma_f32_32x32x16_bf16 v[48:63], v[16:19], v[200:203], v[48:63]
  v_mul_f32 v76, s52, v76
  v_mul_f32 v77, s52, v77
  ds_read_b128 v[16:19], v8 offset:49408
  s_waitcnt lgkmcnt(3)
  v_mfma_f32_32x32x16_bf16 v[32:47], v[20:23], v[140:143], v[32:47]
  s_add_u32 s22, s49, 4096
  s_add_u32 m0, s25, 116736
  s_nop 0
  buffer_load_dwordx4 v2, s[8:11], s22 offen sc1 lds
  buffer_load_dwordx4 v[100:103], v113, s[8:11], s28 offen sc1
  v_cvt_pk_bf16_f32 v74, v76, v77
  v_mul_f32 v78, s52, v78
  v_mul_f32 v79, s52, v79
  v_mfma_f32_32x32x16_bf16 v[48:63], v[20:23], v[204:207], v[48:63]
  v_cvt_pk_bf16_f32 v75, v78, v79
  v_permlane16_swap_b32 v64, v72
  ds_read_b128 v[20:23], v9 offset:49408
  s_waitcnt lgkmcnt(3)
  v_mfma_f32_32x32x16_bf16 v[32:47], v[24:27], v[144:147], v[32:47]
  s_add_u32 s22, s49, 5120
  s_add_u32 m0, s25, 117760
  s_nop 0
  buffer_load_dwordx4 v2, s[8:11], s22 offen sc1 lds
  v_permlane16_swap_b32 v65, v73
  v_permlane16_swap_b32 v66, v74
  v_permlane16_swap_b32 v67, v75
  v_mfma_f32_32x32x16_bf16 v[48:63], v[24:27], v[208:211], v[48:63]
  v_accvgpr_write_b32 a44, v64
  v_accvgpr_write_b32 a45, v65
  ds_read_b128 v[24:27], v10 offset:49408
  s_waitcnt lgkmcnt(3)
  v_mfma_f32_32x32x16_bf16 v[32:47], v[28:31], v[148:151], v[32:47]
  s_add_u32 s22, s49, 6144
  s_add_u32 m0, s25, 131072
  s_nop 0
  buffer_load_dwordx4 v2, s[8:11], s22 offen sc1 lds
  v_accvgpr_write_b32 a46, v66
  v_accvgpr_write_b32 a47, v67
  v_accvgpr_write_b32 a100, v72
  v_mfma_f32_32x32x16_bf16 v[48:63], v[28:31], v[212:215], v[48:63]
  v_accvgpr_write_b32 a101, v73
  v_accvgpr_write_b32 a102, v74
  ds_read_b128 v[28:31], v11 offset:49408
  s_waitcnt lgkmcnt(3)
  v_mfma_f32_32x32x16_bf16 v[32:47], v[16:19], v[152:155], v[32:47]
  s_add_u32 s22, s49, 7168
  s_add_u32 m0, s25, 132096
  s_nop 0
  buffer_load_dwordx4 v2, s[8:11], s22 offen sc1 lds
  v_accvgpr_write_b32 a103, v75
  v_mul_f32 v80, s52, v80
  v_mul_f32 v81, s52, v81
  v_mfma_f32_32x32x16_bf16 v[48:63], v[16:19], v[216:219], v[48:63]
  v_cvt_pk_bf16_f32 v80, v80, v81
  v_mul_f32 v82, s52, v82
  ds_read_b128 v[16:19], v12 offset:49408
  s_waitcnt lgkmcnt(3)
  v_mfma_f32_32x32x16_bf16 v[32:47], v[20:23], v[156:159], v[32:47]
  s_add_u32 s22, s49, 8192
  s_add_u32 m0, s25, 133120
  s_nop 0
  buffer_load_dwordx4 v2, s[8:11], s22 offen sc1 lds
  v_mul_f32 v83, s52, v83
  v_cvt_pk_bf16_f32 v81, v82, v83
  v_mul_f32 v84, s52, v84
  v_mfma_f32_32x32x16_bf16 v[48:63], v[20:23], v[220:223], v[48:63]
  v_mul_f32 v85, s52, v85
  v_cvt_pk_bf16_f32 v82, v84, v85
  ds_read_b128 v[20:23], v13 offset:49408
  s_waitcnt lgkmcnt(3)
  v_mfma_f32_32x32x16_bf16 v[32:47], v[24:27], v[160:163], v[32:47]
  s_add_u32 s22, s49, 9216
  s_add_u32 m0, s25, 134144
  s_nop 0
  buffer_load_dwordx4 v2, s[8:11], s22 offen sc1 lds
  v_mul_f32 v86, s52, v86
  v_mul_f32 v87, s52, v87
  v_cvt_pk_bf16_f32 v83, v86, v87
  v_mfma_f32_32x32x16_bf16 v[48:63], v[24:27], v[224:227], v[48:63]
  v_mul_f32 v88, s52, v88
  v_mul_f32 v89, s52, v89
  ds_read_b128 v[24:27], v14 offset:49408
  s_waitcnt lgkmcnt(3)
  v_mfma_f32_32x32x16_bf16 v[32:47], v[28:31], v[164:167], v[32:47]
  s_add_u32 s22, s49, 10240
  s_add_u32 m0, s25, 147456
  s_nop 0
  buffer_load_dwordx4 v2, s[8:11], s22 offen sc1 lds
  v_cvt_pk_bf16_f32 v88, v88, v89
  v_mul_f32 v90, s52, v90
  v_mul_f32 v91, s52, v91
  v_mfma_f32_32x32x16_bf16 v[48:63], v[28:31], v[228:231], v[48:63]
  v_cvt_pk_bf16_f32 v89, v90, v91
  v_mul_f32 v92, s52, v92
  ds_read_b128 v[28:31], v15 offset:49408
  s_waitcnt lgkmcnt(3)
  v_mfma_f32_32x32x16_bf16 v[32:47], v[16:19], v[168:171], v[32:47]
  s_add_u32 s22, s49, 11264
  s_add_u32 m0, s25, 148480
  s_nop 0
  buffer_load_dwordx4 v2, s[8:11], s22 offen sc1 lds
  v_mul_f32 v93, s52, v93
  v_cvt_pk_bf16_f32 v90, v92, v93
  v_mul_f32 v94, s52, v94
  v_mfma_f32_32x32x16_bf16 v[48:63], v[16:19], v[232:235], v[48:63]
  v_mul_f32 v95, s52, v95
  v_cvt_pk_bf16_f32 v91, v94, v95
  v_xor_b32 v8, 65536, v8
  ds_read_b128 v[16:19], v8 offset:0
  s_waitcnt lgkmcnt(3)
  v_mfma_f32_32x32x16_bf16 v[32:47], v[20:23], v[172:175], v[32:47]
  s_add_u32 s22, s49, 12288
  s_add_u32 m0, s25, 149504
  s_nop 0
  buffer_load_dwordx4 v2, s[8:11], s22 offen sc1 lds
  v_permlane16_swap_b32 v80, v88
  v_permlane16_swap_b32 v81, v89
  v_permlane16_swap_b32 v82, v90
  v_mfma_f32_32x32x16_bf16 v[48:63], v[20:23], v[236:239], v[48:63]
  v_permlane16_swap_b32 v83, v91
  v_accvgpr_write_b32 a156, v80
  v_xor_b32 v9, 65536, v9
  ds_read_b128 v[20:23], v9 offset:0
  s_waitcnt lgkmcnt(3)
  v_mfma_f32_32x32x16_bf16 v[32:47], v[24:27], v[176:179], v[32:47]
  s_add_u32 s22, s49, 13312
  s_add_u32 m0, s25, 150528
  s_nop 0
  buffer_load_dwordx4 v2, s[8:11], s22 offen sc1 lds
  v_accvgpr_write_b32 a157, v81
  v_accvgpr_write_b32 a158, v82
  v_accvgpr_write_b32 a159, v83
  v_mfma_f32_32x32x16_bf16 v[48:63], v[24:27], v[240:243], v[48:63]
  v_accvgpr_write_b32 a212, v88
  v_accvgpr_write_b32 a213, v89
  v_xor_b32 v10, 65536, v10
  ds_read_b128 v[24:27], v10 offset:0
  s_waitcnt lgkmcnt(3)
  v_mfma_f32_32x32x16_bf16 v[32:47], v[28:31], v[180:183], v[32:47]
  v_accvgpr_write_b32 a214, v90
  v_accvgpr_write_b32 a215, v91
  v_mfma_f32_32x32x16_bf16 v[48:63], v[28:31], v[244:247], v[48:63]
  s_barrier
  v_xor_b32 v11, 65536, v11
  ds_read_b128 v[28:31], v11 offset:0
  s_waitcnt lgkmcnt(3)
  v_mfma_f32_32x32x16_bf16 v[64:79], v[16:19], v[120:123], 0
  s_waitcnt vmcnt(9)
  v_cmp_ne_u64 vcc, s[88:89], v[100:101]
  v_cmp_ne_u64 s[54:55], s[88:89], v[102:103]
  s_add_u32 s50, s33, 0
  v_mfma_f32_32x32x16_bf16 v[80:95], v[16:19], v[184:187], 0
  v_xor_b32 v12, 65536, v12
  ds_read_b128 v[16:19], v12 offset:0
  s_waitcnt lgkmcnt(3)
  v_mfma_f32_32x32x16_bf16 v[64:79], v[20:23], v[124:127], v[64:79]
  s_or_b64 vcc, vcc, s[54:55]
  s_cselect_b32 s50, 0x10000000, s50
  s_add_u32 s22, s50, 0
  buffer_load_dwordx4 a[224:227], v2, s[8:11], s22 offen sc1
  v_mul_f32 v32, s52, v32
  v_mul_f32 v33, s52, v33
  v_cvt_pk_bf16_f32 v32, v32, v33
  v_mfma_f32_32x32x16_bf16 v[80:95], v[20:23], v[188:191], v[80:95]
  v_mul_f32 v34, s52, v34
  v_mul_f32 v35, s52, v35
  v_xor_b32 v13, 65536, v13
  ds_read_b128 v[20:23], v13 offset:0
  s_waitcnt lgkmcnt(3)
  v_mfma_f32_32x32x16_bf16 v[64:79], v[24:27], v[128:131], v[64:79]
  s_add_u32 s22, s50, 1024
  buffer_load_dwordx4 a[228:231], v2, s[8:11], s22 offen sc1
  v_cvt_pk_bf16_f32 v33, v34, v35
  v_mul_f32 v36, s52, v36
  v_mul_f32 v37, s52, v37
  v_mfma_f32_32x32x16_bf16 v[80:95], v[24:27], v[192:195], v[80:95]
  v_cvt_pk_bf16_f32 v34, v36, v37
  v_mul_f32 v38, s52, v38
  v_xor_b32 v14, 65536, v14
  ds_read_b128 v[24:27], v14 offset:0
  s_waitcnt lgkmcnt(3)
  v_mfma_f32_32x32x16_bf16 v[64:79], v[28:31], v[132:135], v[64:79]
  s_add_u32 s22, s50, 2048
  buffer_load_dwordx4 a[232:235], v2, s[8:11], s22 offen sc1
  v_mul_f32 v39, s52, v39
  v_cvt_pk_bf16_f32 v35, v38, v39
  v_mul_f32 v40, s52, v40
  v_mfma_f32_32x32x16_bf16 v[80:95], v[28:31], v[196:199], v[80:95]
  v_mul_f32 v41, s52, v41
  v_cvt_pk_bf16_f32 v40, v40, v41
  v_xor_b32 v15, 65536, v15
  ds_read_b128 v[28:31], v15 offset:0
  s_waitcnt lgkmcnt(3)
  v_mfma_f32_32x32x16_bf16 v[64:79], v[16:19], v[136:139], v[64:79]
  s_add_u32 s22, s50, 3072
  buffer_load_dwordx4 a[236:239], v2, s[8:11], s22 offen sc1
  v_mul_f32 v42, s52, v42
  v_mul_f32 v43, s52, v43
  v_cvt_pk_bf16_f32 v41, v42, v43
  v_mfma_f32_32x32x16_bf16 v[80:95], v[16:19], v[200:203], v[80:95]
  v_mul_f32 v44, s52, v44
  v_mul_f32 v45, s52, v45
  ds_read_b128 v[16:19], v8 offset:256
  s_waitcnt lgkmcnt(3)
  v_mfma_f32_32x32x16_bf16 v[64:79], v[20:23], v[140:143], v[64:79]
  s_add_u32 s22, s50, 4096
  buffer_load_dwordx4 a[240:243], v2, s[8:11], s22 offen sc1
  v_cvt_pk_bf16_f32 v42, v44, v45
  v_mul_f32 v46, s52, v46
  v_mul_f32 v47, s52, v47
  v_mfma_f32_32x32x16_bf16 v[80:95], v[20:23], v[204:207], v[80:95]
  v_cvt_pk_bf16_f32 v43, v46, v47
  v_permlane16_swap_b32 v32, v40
  ds_read_b128 v[20:23], v9 offset:256
  s_waitcnt lgkmcnt(3)
  v_mfma_f32_32x32x16_bf16 v[64:79], v[24:27], v[144:147], v[64:79]
  s_add_u32 s22, s50, 5120
  buffer_load_dwordx4 a[244:247], v2, s[8:11], s22 offen sc1
  v_permlane16_swap_b32 v33, v41
  v_permlane16_swap_b32 v34, v42
  v_permlane16_swap_b32 v35, v43
  v_mfma_f32_32x32x16_bf16 v[80:95], v[24:27], v[208:211], v[80:95]
  v_accvgpr_write_b32 a48, v32
  v_accvgpr_write_b32 a49, v33
  ds_read_b128 v[24:27], v10 offset:256
  s_waitcnt lgkmcnt(3)
  v_mfma_f32_32x32x16_bf16 v[64:79], v[28:31], v[148:151], v[64:79]
  s_add_u32 s22, s50, 6144
  buffer_load_dwordx4 a[248:251], v2, s[8:11], s22 offen sc1
  v_accvgpr_write_b32 a50, v34
  v_accvgpr_write_b32 a51, v35
  v_accvgpr_write_b32 a104, v40
  v_mfma_f32_32x32x16_bf16 v[80:95], v[28:31], v[212:215], v[80:95]
  v_accvgpr_write_b32 a105, v41
  v_accvgpr_write_b32 a106, v42
  ds_read_b128 v[28:31], v11 offset:256
  s_waitcnt lgkmcnt(3)
  v_mfma_f32_32x32x16_bf16 v[64:79], v[16:19], v[152:155], v[64:79]
  s_add_u32 s22, s50, 7168
  buffer_load_dwordx4 a[252:255], v2, s[8:11], s22 offen sc1
  v_accvgpr_write_b32 a107, v43
  v_mul_f32 v48, s52, v48
  v_mul_f32 v49, s52, v49
  v_mfma_f32_32x32x16_bf16 v[80:95], v[16:19], v[216:219], v[80:95]
  v_cvt_pk_bf16_f32 v48, v48, v49
  v_mul_f32 v50, s52, v50
  ds_read_b128 v[16:19], v12 offset:256
  s_waitcnt lgkmcnt(3)
  v_mfma_f32_32x32x16_bf16 v[64:79], v[20:23], v[156:159], v[64:79]
  s_add_u32 s22, s50, 8192
  s_add_u32 m0, s25, 32768
  s_nop 0
  buffer_load_dwordx4 v2, s[8:11], s22 offen sc1 lds
  v_mul_f32 v51, s52, v51
  v_cvt_pk_bf16_f32 v49, v50, v51
  v_mul_f32 v52, s52, v52
  v_mfma_f32_32x32x16_bf16 v[80:95], v[20:23], v[220:223], v[80:95]
  v_mul_f32 v53, s52, v53
  v_cvt_pk_bf16_f32 v50, v52, v53
  ds_read_b128 v[20:23], v13 offset:256
  s_waitcnt lgkmcnt(3)
  v_mfma_f32_32x32x16_bf16 v[64:79], v[24:27], v[160:163], v[64:79]
  s_add_u32 s22, s50, 9216
  s_add_u32 m0, s25, 33792
  s_nop 0
  buffer_load_dwordx4 v2, s[8:11], s22 offen sc1 lds
  v_mul_f32 v54, s52, v54
  v_mul_f32 v55, s52, v55
  v_cvt_pk_bf16_f32 v51, v54, v55
  v_mfma_f32_32x32x16_bf16 v[80:95], v[24:27], v[224:227], v[80:95]
  v_mul_f32 v56, s52, v56
  v_mul_f32 v57, s52, v57
  ds_read_b128 v[24:27], v14 offset:256
  s_waitcnt lgkmcnt(3)
  v_mfma_f32_32x32x16_bf16 v[64:79], v[28:31], v[164:167], v[64:79]
  s_add_u32 s22, s50, 10240
  s_add_u32 m0, s25, 34816
  s_nop 0
  buffer_load_dwordx4 v2, s[8:11], s22 offen sc1 lds
  v_cvt_pk_bf16_f32 v56, v56, v57
  v_mul_f32 v58, s52, v58
  v_mul_f32 v59, s52, v59
  v_mfma_f32_32x32x16_bf16 v[80:95], v[28:31], v[228:231], v[80:95]
  v_cvt_pk_bf16_f32 v57, v58, v59
  v_mul_f32 v60, s52, v60
  ds_read_b128 v[28:31], v15 offset:256
  s_waitcnt lgkmcnt(3)
  v_mfma_f32_32x32x16_bf16 v[64:79], v[16:19], v[168:171], v[64:79]
  s_add_u32 s22, s50, 11264
  s_add_u32 m0, s25, 35840
  s_nop 0
  buffer_load_dwordx4 v2, s[8:11], s22 offen sc1 lds
  v_mul_f32 v61, s52, v61
  v_cvt_pk_bf16_f32 v58, v60, v61
  v_mul_f32 v62, s52, v62
  v_mfma_f32_32x32x16_bf16 v[80:95], v[16:19], v[232:235], v[80:95]
  v_mul_f32 v63, s52, v63
  v_cvt_pk_bf16_f32 v59, v62, v63
  s_waitcnt lgkmcnt(2)
  v_mfma_f32_32x32x16_bf16 v[64:79], v[20:23], v[172:175], v[64:79]
  s_add_u32 s22, s50, 12288
  s_add_u32 m0, s25, 49152
  s_nop 0
  buffer_load_dwordx4 v2, s[8:11], s22 offen sc1 lds
  v_permlane16_swap_b32 v48, v56
  v_permlane16_swap_b32 v49, v57
  v_permlane16_swap_b32 v50, v58
  v_mfma_f32_32x32x16_bf16 v[80:95], v[20:23], v[236:239], v[80:95]
  v_permlane16_swap_b32 v51, v59
  v_accvgpr_write_b32 a160, v48
  s_waitcnt lgkmcnt(1)
  v_mfma_f32_32x32x16_bf16 v[64:79], v[24:27], v[176:179], v[64:79]
  s_add_u32 s22, s50, 13312
  s_add_u32 m0, s25, 50176
  s_nop 0
  buffer_load_dwordx4 v2, s[8:11], s22 offen sc1 lds
  v_accvgpr_write_b32 a161, v49
  v_accvgpr_write_b32 a162, v50
  v_accvgpr_write_b32 a163, v51
  v_mfma_f32_32x32x16_bf16 v[80:95], v[24:27], v[240:243], v[80:95]
  v_accvgpr_write_b32 a216, v56
  v_accvgpr_write_b32 a217, v57
  s_waitcnt lgkmcnt(0)
  v_mfma_f32_32x32x16_bf16 v[64:79], v[28:31], v[180:183], v[64:79]
  buffer_load_dwordx4 v[100:103], v113, s[8:11], s28 offen sc1
  buffer_load_dwordx4 v[104:107], v2, s[8:11], s29 offen sc1
  buffer_load_dwordx4 v[108:111], v112, s[8:11], s29 offen sc1
  v_accvgpr_write_b32 a218, v58
  v_accvgpr_write_b32 a219, v59
  v_mfma_f32_32x32x16_bf16 v[80:95], v[28:31], v[244:247], v[80:95]
  s_nop 4
  v_mul_f32 v64, s52, v64
  v_mul_f32 v65, s52, v65
  v_cvt_pk_bf16_f32 v64, v64, v65
  v_mul_f32 v66, s52, v66
  v_mul_f32 v67, s52, v67
  v_cvt_pk_bf16_f32 v65, v66, v67
  v_mul_f32 v68, s52, v68
  v_mul_f32 v69, s52, v69
  v_cvt_pk_bf16_f32 v66, v68, v69
  v_mul_f32 v70, s52, v70
  v_mul_f32 v71, s52, v71
  v_cvt_pk_bf16_f32 v67, v70, v71
  v_mul_f32 v72, s52, v72
  v_mul_f32 v73, s52, v73
  v_cvt_pk_bf16_f32 v72, v72, v73
  v_mul_f32 v74, s52, v74
  v_mul_f32 v75, s52, v75
  v_cvt_pk_bf16_f32 v73, v74, v75
  v_mul_f32 v76, s52, v76
  v_mul_f32 v77, s52, v77
  v_cvt_pk_bf16_f32 v74, v76, v77
  v_mul_f32 v78, s52, v78
  v_mul_f32 v79, s52, v79
  v_cvt_pk_bf16_f32 v75, v78, v79
  v_permlane16_swap_b32 v64, v72
  v_permlane16_swap_b32 v65, v73
  v_permlane16_swap_b32 v66, v74
  v_permlane16_swap_b32 v67, v75
  v_accvgpr_write_b32 a52, v64
  v_accvgpr_write_b32 a53, v65
  v_accvgpr_write_b32 a54, v66
  v_accvgpr_write_b32 a55, v67
  v_accvgpr_write_b32 a108, v72
  v_accvgpr_write_b32 a109, v73
  v_accvgpr_write_b32 a110, v74
  v_accvgpr_write_b32 a111, v75
  v_mul_f32 v80, s52, v80
  v_mul_f32 v81, s52, v81
  v_cvt_pk_bf16_f32 v80, v80, v81
  v_mul_f32 v82, s52, v82
  v_mul_f32 v83, s52, v83
  v_cvt_pk_bf16_f32 v81, v82, v83
  v_mul_f32 v84, s52, v84
  v_mul_f32 v85, s52, v85
  v_cvt_pk_bf16_f32 v82, v84, v85
  v_mul_f32 v86, s52, v86
  v_mul_f32 v87, s52, v87
  v_cvt_pk_bf16_f32 v83, v86, v87
  v_mul_f32 v88, s52, v88
  v_mul_f32 v89, s52, v89
  v_cvt_pk_bf16_f32 v88, v88, v89
  v_mul_f32 v90, s52, v90
  v_mul_f32 v91, s52, v91
  v_cvt_pk_bf16_f32 v89, v90, v91
  v_mul_f32 v92, s52, v92
  v_mul_f32 v93, s52, v93
  v_cvt_pk_bf16_f32 v90, v92, v93
  v_mul_f32 v94, s52, v94
  v_mul_f32 v95, s52, v95
  v_cvt_pk_bf16_f32 v91, v94, v95
  v_permlane16_swap_b32 v80, v88
  v_permlane16_swap_b32 v81, v89
  v_permlane16_swap_b32 v82, v90
  v_permlane16_swap_b32 v83, v91
  v_accvgpr_write_b32 a164, v80
  v_accvgpr_write_b32 a165, v81
  v_accvgpr_write_b32 a166, v82
  v_accvgpr_write_b32 a167, v83
  v_accvgpr_write_b32 a220, v88
  v_accvgpr_write_b32 a221, v89
  v_accvgpr_write_b32 a222, v90
  v_accvgpr_write_b32 a223, v91
  s_mov_b32 s30, 0
  s_branch sc_aw_w
sc_aw:
  buffer_load_dwordx4 v[100:103], v113, s[8:11], s28 offen sc1
  buffer_load_dwordx4 v[104:107], v2, s[8:11], s29 offen sc1
  buffer_load_dwordx4 v[108:111], v112, s[8:11], s29 offen sc1
sc_aw_w:
  s_waitcnt vmcnt(0)
  v_cmp_ne_u64 vcc, s[88:89], v[100:101]
  s_cbranch_vccnz sc_aw_no
  v_cmp_ne_u64 vcc, s[88:89], v[102:103]
  s_cbranch_vccnz sc_aw_no
  v_cmp_ne_u64 vcc, s[88:89], v[104:105]
  s_cbranch_vccnz sc_aw_no
  v_cmp_ne_u64 vcc, s[88:89], v[106:107]
  s_cbranch_vccnz sc_aw_no
  v_cmp_ne_u64 vcc, s[88:89], v[108:109]
  s_cbranch_vccnz sc_aw_no
  v_cmp_ne_u64 vcc, s[88:89], v[110:111]
  s_cbranch_vccnz sc_aw_no
  s_branch sc_aw_ok
sc_aw_no:
  s_sleep 1
  s_add_u32 s30, s30, 1
  s_cmp_lt_u32 s30, 50000
  s_cbranch_scc1 sc_aw
  s_branch cA_abort
sc_aw_ok:
  v_add_u32 v4, s25, v2
  v_add_u32 v5, 0x10000, v4
  v_add_u32 v6, 0x20000, v4
  s_cmp_eq_u32 s48, 0x10000000
  s_cbranch_scc1 sc_d0
  ds_read_b128 v[144:147], v4 offset:0
  ds_read_b128 v[148:151], v4 offset:1024
  ds_read_b128 v[152:155], v4 offset:2048
  ds_read_b128 v[156:159], v4 offset:3072
  ds_read_b128 v[160:163], v4 offset:16384
  ds_read_b128 v[164:167], v4 offset:17408
  ds_read_b128 v[168:171], v4 offset:18432
  ds_read_b128 v[172:175], v4 offset:19456
  ds_read_b128 v[176:179], v5 offset:16384
  ds_read_b128 v[180:183], v5 offset:17408
  ds_read_b128 v[184:187], v5 offset:18432
  ds_read_b128 v[188:191], v5 offset:19456
  ds_read_b128 v[192:195], v5 offset:32768
  ds_read_b128 v[196:199], v5 offset:33792
  s_waitcnt lgkmcnt(0)
  s_branch sc_e0
sc_d0:
  s_add_u32 s22, s33, 12288
  buffer_load_dwordx4 v[144:147], v2, s[8:11], s22 offen offset:2048 sc1
  buffer_load_dwordx4 v[148:151], v2, s[8:11], s22 offen offset:3072 sc1
  s_add_u32 s22, s33, 16384
  buffer_load_dwordx4 v[152:155], v2, s[8:11], s22 offen offset:0 sc1
  buffer_load_dwordx4 v[156:159], v2, s[8:11], s22 offen offset:1024 sc1
  buffer_load_dwordx4 v[160:163], v2, s[8:11], s22 offen offset:2048 sc1
  buffer_load_dwordx4 v[164:167], v2, s[8:11], s22 offen offset:3072 sc1
  s_add_u32 s22, s33, 20480
  buffer_load_dwordx4 v[168:171], v2, s[8:11], s22 offen offset:0 sc1
  buffer_load_dwordx4 v[172:175], v2, s[8:11], s22 offen offset:1024 sc1
  buffer_load_dwordx4 v[176:179], v2, s[8:11], s22 offen offset:2048 sc1
  buffer_load_dwordx4 v[180:183], v2, s[8:11], s22 offen offset:3072 sc1
  s_add_u32 s22, s33, 24576
  buffer_load_dwordx4 v[184:187], v2, s[8:11], s22 offen offset:0 sc1
  buffer_load_dwordx4 v[188:191], v2, s[8:11], s22 offen offset:1024 sc1
  buffer_load_dwordx4 v[192:195], v2, s[8:11], s22 offen offset:2048 sc1
  buffer_load_dwordx4 v[196:199], v2, s[8:11], s22 offen offset:3072 sc1
sc_e0:
  s_cmp_eq_u32 s49, 0x10000000
  s_cbranch_scc1 sc_d1
  ds_read_b128 v[200:203], v5 offset:34816
  ds_read_b128 v[204:207], v5 offset:35840
  ds_read_b128 v[208:211], v5 offset:49152
  ds_read_b128 v[212:215], v5 offset:50176
  ds_read_b128 v[216:219], v5 offset:51200
  ds_read_b128 v[220:223], v5 offset:52224
  ds_read_b128 v[224:227], v6 offset:0
  ds_read_b128 v[228:231], v6 offset:1024
  ds_read_b128 v[232:235], v6 offset:2048
  ds_read_b128 v[236:239], v6 offset:3072
  ds_read_b128 v[240:243], v6 offset:16384
  ds_read_b128 v[244:247], v6 offset:17408
  ds_read_b128 v[248:251], v6 offset:18432
  ds_read_b128 v[252:255], v6 offset:19456
  s_waitcnt lgkmcnt(0)
  s_branch sc_e1
sc_d1:
  s_add_u32 s22, s32, 0
  buffer_load_dwordx4 v[200:203], v2, s[8:11], s22 offen offset:0 sc1
  buffer_load_dwordx4 v[204:207], v2, s[8:11], s22 offen offset:1024 sc1
  buffer_load_dwordx4 v[208:211], v2, s[8:11], s22 offen offset:2048 sc1
  buffer_load_dwordx4 v[212:215], v2, s[8:11], s22 offen offset:3072 sc1
  s_add_u32 s22, s32, 4096
  buffer_load_dwordx4 v[216:219], v2, s[8:11], s22 offen offset:0 sc1
  buffer_load_dwordx4 v[220:223], v2, s[8:11], s22 offen offset:1024 sc1
  buffer_load_dwordx4 v[224:227], v2, s[8:11], s22 offen offset:2048 sc1
  buffer_load_dwordx4 v[228:231], v2, s[8:11], s22 offen offset:3072 sc1
  s_add_u32 s22, s32, 8192
  buffer_load_dwordx4 v[232:235], v2, s[8:11], s22 offen offset:0 sc1
  buffer_load_dwordx4 v[236:239], v2, s[8:11], s22 offen offset:1024 sc1
  buffer_load_dwordx4 v[240:243], v2, s[8:11], s22 offen offset:2048 sc1
  buffer_load_dwordx4 v[244:247], v2, s[8:11], s22 offen offset:3072 sc1
  s_add_u32 s22, s32, 12288
  buffer_load_dwordx4 v[248:251], v2, s[8:11], s22 offen offset:0 sc1
  buffer_load_dwordx4 v[252:255], v2, s[8:11], s22 offen offset:1024 sc1
sc_e1:
  s_cmp_eq_u32 s50, 0x10000000
  s_cbranch_scc1 sc_d2
  ds_read_b128 v[120:123], v4 offset:32768
  ds_read_b128 v[124:127], v4 offset:33792
  ds_read_b128 v[128:131], v4 offset:34816
  ds_read_b128 v[132:135], v4 offset:35840
  ds_read_b128 v[136:139], v4 offset:49152
  ds_read_b128 v[140:143], v4 offset:50176
  s_waitcnt lgkmcnt(0)
  s_branch sc_e2
sc_d2:
  s_add_u32 s22, s33, 0
  buffer_load_dwordx4 a[224:227], v2, s[8:11], s22 offen offset:0 sc1
  buffer_load_dwordx4 a[228:231], v2, s[8:11], s22 offen offset:1024 sc1
  buffer_load_dwordx4 a[232:235], v2, s[8:11], s22 offen offset:2048 sc1
  buffer_load_dwordx4 a[236:239], v2, s[8:11], s22 offen offset:3072 sc1
  s_add_u32 s22, s33, 4096
  buffer_load_dwordx4 a[240:243], v2, s[8:11], s22 offen offset:0 sc1
  buffer_load_dwordx4 a[244:247], v2, s[8:11], s22 offen offset:1024 sc1
  buffer_load_dwordx4 a[248:251], v2, s[8:11], s22 offen offset:2048 sc1
  buffer_load_dwordx4 a[252:255], v2, s[8:11], s22 offen offset:3072 sc1
  s_add_u32 s22, s33, 8192
  buffer_load_dwordx4 v[120:123], v2, s[8:11], s22 offen offset:0 sc1
  buffer_load_dwordx4 v[124:127], v2, s[8:11], s22 offen offset:1024 sc1
  buffer_load_dwordx4 v[128:131], v2, s[8:11], s22 offen offset:2048 sc1
  buffer_load_dwordx4 v[132:135], v2, s[8:11], s22 offen offset:3072 sc1
  s_add_u32 s22, s33, 12288
  buffer_load_dwordx4 v[136:139], v2, s[8:11], s22 offen offset:0 sc1
  buffer_load_dwordx4 v[140:143], v2, s[8:11], s22 offen offset:1024 sc1
sc_e2:
  s_barrier
  s_branch m_role
m_val:
  s_cmp_lg_u32 s16, 0
  s_cbranch_scc1 w0_6
  v_mov_b32 v233, 128
  v_mov_b32 v234, s88
  v_mov_b32 v235, s89
  v_mov_b32 v236, 0
  v_mov_b32 v237, 0
  s_mov_b64 exec, 1
  buffer_atomic_cmpswap_x2 v[234:237], v233, s[12:15], 0 offen sc0
  s_mov_b64 exec, -1
w0_6:
  s_cmp_lg_u32 s66, 0
  s_cbranch_scc1 va_ci
  s_cmp_lg_u32 s16, 0
  s_cbranch_scc1 w0_7
  s_lshr_b32 s70, s3, 5
  s_and_b32 s71, s70, 4
  s_mul_i32 s71, s71, 12
  s_lshl_b32 s70, s70, 2
  s_add_u32 s70, s70, s71
  s_lshl_b32 s71, 1, s3
  v_mov_b32 v242, s71
  v_mov_b32 v243, 32
  s_mov_b64 exec, 1
  buffer_atomic_or v242, v243, s[12:15], s70 offen sc0
  buffer_load_dwordx2 v[244:245], v243, s[12:15], 0 offen offset:96 sc1
  s_mov_b64 exec, -1
w0_7:
va_ci:
  s_mov_b32 s56, s40
  s_and_b32 s57, s41, 0xffff
  s_mov_b32 s58, 3670016
  s_mov_b32 s59, 0x20000
  v_lshrrev_b32 v24, 5, v1
  v_and_b32 v25, 31, v1
  v_lshlrev_b32 v25, 4, v25
  v_lshl_add_u32 v24, v24, 13, v25
  s_mov_b32 s60, s42
  s_and_b32 s61, s43, 0xffff
  s_mov_b32 s62, 3670016
  s_mov_b32 s63, 0x20000
  s_lshl_b32 s22, s17, 9
  s_lshl_b32 s23, s16, 19
  s_add_u32 s23, s22, s23
  s_add_u32 s21, s23, 262144
  buffer_load_dwordx4 v[28:31], v24, s[60:63], s21 offen
  s_add_u32 s21, s23, 278528
  buffer_load_dwordx4 v[28:31], v24, s[60:63], s21 offen
  s_add_u32 s21, s23, 294912
  buffer_load_dwordx4 v[28:31], v24, s[60:63], s21 offen
  s_add_u32 s21, s23, 311296
  buffer_load_dwordx4 v[28:31], v24, s[60:63], s21 offen
  s_add_u32 s21, s23, 327680
  buffer_load_dwordx4 v[28:31], v24, s[60:63], s21 offen
  s_add_u32 s21, s23, 344064
  buffer_load_dwordx4 v[28:31], v24, s[60:63], s21 offen
  s_add_u32 s21, s23, 360448
  buffer_load_dwordx4 v[28:31], v24, s[60:63], s21 offen
  s_add_u32 s21, s23, 376832
  buffer_load_dwordx4 v[28:31], v24, s[60:63], s21 offen
  s_add_u32 s21, s23, 393216
  buffer_load_dwordx4 v[28:31], v24, s[60:63], s21 offen
  s_add_u32 s21, s23, 409600
  buffer_load_dwordx4 v[28:31], v24, s[60:63], s21 offen
  s_add_u32 s21, s23, 425984
  buffer_load_dwordx4 v[28:31], v24, s[60:63], s21 offen
  s_add_u32 s21, s23, 442368
  buffer_load_dwordx4 v[28:31], v24, s[60:63], s21 offen
  s_add_u32 s21, s23, 458752
  buffer_load_dwordx4 v[28:31], v24, s[60:63], s21 offen
  s_add_u32 s21, s23, 475136
  buffer_load_dwordx4 v[28:31], v24, s[60:63], s21 offen
  s_add_u32 s21, s23, 491520
  buffer_load_dwordx4 v[28:31], v24, s[60:63], s21 offen
  s_add_u32 s21, s23, 507904
  buffer_load_dwordx4 v[28:31], v24, s[60:63], s21 offen
  s_lshl_b32 s23, s16, 14
  s_add_u32 s22, s22, s23
  s_mov_b32 s30, 0
va_pf:
  buffer_load_dwordx4 v[28:31], v24, s[56:59], s22 offen
  s_waitcnt vmcnt(40)
  s_add_u32 s22, s22, 65536
  s_add_u32 s30, s30, 1
  s_cmp_lt_u32 s30, 28
  s_cbranch_scc1 va_pf
  s_cmp_lg_u32 s66, 0
  s_cbranch_scc1 va_cf
  s_cmp_lg_u32 s16, 0
  s_cbranch_scc1 w0_8
  s_waitcnt vmcnt(40)
  v_readfirstlane_b32 s70, v244
  s_cmp_lg_u32 s70, 0
  s_cbranch_scc1 va_nz
  v_mov_b32 v243, 128
  v_mov_b32 v244, s88
  v_mov_b32 v245, s89
  v_mov_b32 v246, 0
  v_mov_b32 v247, 0
  s_mov_b64 exec, 1
  buffer_atomic_cmpswap_x2 v[244:247], v243, s[12:15], 0 offen sc0
  s_mov_b64 exec, -1
  s_waitcnt vmcnt(0)
  v_readfirstlane_b32 s70, v244
  s_cmp_lg_u32 s70, 0
  s_cbranch_scc1 va_nz
  v_mov_b32 v244, s88
  v_mov_b32 v245, s89
va_nz:
w0_8:
  v_mov_b32 v243, 160000
  s_add_u32 s101, s101, 1
  s_barrier
  s_mov_b64 exec, 1
  s_cmp_lg_u32 s16, 0
  s_cbranch_scc1 w0_9
  ds_write_b32 v243, v242 offset:0
  ds_write_b32 v243, v244 offset:4
  ds_write_b32 v243, v245 offset:8
  s_waitcnt lgkmcnt(0)
  v_mov_b32 v242, s101
  ds_write_b32 v243, v242 offset:16
  s_waitcnt lgkmcnt(0)
w0_9:
  s_mov_b64 exec, -1
  s_barrier
  ds_read_b32 v242, v243 offset:0
  ds_read_b32 v244, v243 offset:4
  ds_read_b32 v245, v243 offset:8
  ds_read_b32 v243, v243 offset:16
  s_waitcnt lgkmcnt(0)
  v_readfirstlane_b32 s70, v242
  v_readfirstlane_b32 s88, v244
  v_readfirstlane_b32 s89, v245
  v_cmp_ne_u32 vcc, s101, v243
  s_cbranch_vccnz ch_end
  s_mov_b32 s66, 1
  s_bitcmp1_b32 s70, s3
  s_cbranch_scc1 m_reclaim
va_cf:
  s_cmp_lg_u32 s16, 0
  s_cbranch_scc1 w0_10
  s_cmp_eq_u32 s67, 0
  s_cselect_b32 s20, 1, 0x10001
  v_mov_b32 v242, s20
  v_mov_b32 v243, 0
  s_mov_b64 exec, 1
  buffer_atomic_add v242, v243, s[12:15], 0 offen
  s_mov_b64 exec, -1
w0_10:
m_role:
  s_mov_b32 s17, s3
  v_and_b32 v1, 63, v0
  v_lshlrev_b32 v2, 4, v1
  v_lshrrev_b32 v116, 4, v1
  v_and_b32 v117, 15, v1
  v_mov_b32 v3, 0x4444
  v_mov_b32 v118, 0xeeee
  v_cmp_lt_u32 vcc, 7, v117
  s_nop 1
  v_cndmask_b32 v3, v3, v118, vcc
  s_mov_b32 s19, 0
  s_mov_b32 s20, 75235328
  s_lshr_b32 s22, s17, 4
  s_lshl_b32 s22, s22, 2
  s_add_u32 s22, s22, s16
  s_and_b32 s17, s17, 15
  s_cmp_eq_u32 s22, 0
  s_cbranch_scc1 ch_init0
  s_cmp_eq_u32 s22, 1
  s_cbranch_scc1 ch_init1
  s_cmp_eq_u32 s22, 2
  s_cbranch_scc1 ch_init2
  s_cmp_eq_u32 s22, 3
  s_cbranch_scc1 ch_init3
  s_cmp_eq_u32 s22, 4
  s_cbranch_scc1 ch_init4
  s_cmp_eq_u32 s22, 5
  s_cbranch_scc1 ch_init5
  s_cmp_eq_u32 s22, 6
  s_cbranch_scc1 ch_init6
  s_cmp_eq_u32 s22, 7
  s_cbranch_scc1 ch_init7
  s_branch ch_end
ch_init0:
  s_mul_i32 s31, s17, 401408
  s_add_u32 s31, s31, 0
  s_mov_b32 s24, 71565312
  s_mov_b32 s25, 0
  s_add_u32 m0, s25, 0
  s_nop 0
  buffer_load_dwordx4 v2, s[8:11], s24 offen offset:0 sc1 lds
  buffer_load_dwordx4 v2, s[8:11], s24 offen offset:1024 sc1 lds
  buffer_load_dwordx4 v2, s[8:11], s24 offen offset:2048 sc1 lds
  buffer_load_dwordx4 v2, s[8:11], s24 offen offset:3072 sc1 lds
  s_add_u32 m0, s25, 4096
  s_add_u32 s22, s24, 4096
  buffer_load_dwordx4 v2, s[8:11], s22 offen offset:0 sc1 lds
  buffer_load_dwordx4 v2, s[8:11], s22 offen offset:1024 sc1 lds
  buffer_load_dwordx4 v2, s[8:11], s22 offen offset:2048 sc1 lds
  v_and_b32 v64, 7, v117
  v_and_b32 v65, 1, v116
  v_lshlrev_b32 v65, 2, v65
  v_sub_u32 v64, v64, v65
  v_lshrrev_b32 v65, 3, v117
  v_lshl_add_u32 v66, v65, 2, v64
  v_cmp_gt_u32 vcc, 4, v64
  v_mov_b32 v67, 99
  s_nop 0
  v_cndmask_b32 v66, v67, v66, vcc
  v_mov_b32 v68, 0x3f80
  v_mov_b32 v69, 0x3f800000
  v_mov_b32 v4, 0
  v_cmp_eq_u32 vcc, 0, v66
  s_nop 1
  v_cndmask_b32 v4, v4, v68, vcc
  v_cmp_eq_u32 vcc, 1, v66
  s_nop 1
  v_cndmask_b32 v4, v4, v69, vcc
  v_mov_b32 v5, 0
  v_cmp_eq_u32 vcc, 2, v66
  s_nop 1
  v_cndmask_b32 v5, v5, v68, vcc
  v_cmp_eq_u32 vcc, 3, v66
  s_nop 1
  v_cndmask_b32 v5, v5, v69, vcc
  v_mov_b32 v6, 0
  v_cmp_eq_u32 vcc, 4, v66
  s_nop 1
  v_cndmask_b32 v6, v6, v68, vcc
  v_cmp_eq_u32 vcc, 5, v66
  s_nop 1
  v_cndmask_b32 v6, v6, v69, vcc
  v_mov_b32 v7, 0
  v_cmp_eq_u32 vcc, 6, v66
  s_nop 1
  v_cndmask_b32 v7, v7, v68, vcc
  v_cmp_eq_u32 vcc, 7, v66
  s_nop 1
  v_cndmask_b32 v7, v7, v69, vcc
  v_lshrrev_b32 v64, 1, v116
  v_lshrrev_b32 v65, 3, v117
  v_cmp_eq_u32 s[26:27], v64, v65
  v_and_b32 v66, 1, v116
  v_add_u32 v64, 0, v64
  v_lshrrev_b32 v67, 1, v116
  v_lshlrev_b32 v67, 8, v67
  v_lshl_add_u32 v67, v66, 9, v67
  v_lshl_add_u32 v67, v117, 4, v67
  v_add_u32 v112, 57344, v67
  v_and_b32 v68, 7, v117
  v_lshlrev_b32 v67, 8, v64
  v_lshl_add_u32 v67, v68, 5, v67
  v_lshl_add_u32 v67, v66, 4, v67
  v_add_u32 v113, 65536, v67
  v_lshrrev_b32 v64, 5, v1
  v_and_b32 v65, 31, v1
  v_lshrrev_b32 v66, 3, v65
  v_and_b32 v67, 7, v65
  v_and_b32 v68, 3, v67
  v_lshl_add_u32 v68, v66, 2, v68
  v_lshrrev_b32 v69, 2, v67
  v_lshl_add_u32 v68, v69, 4, v68
  v_lshlrev_b32 v69, 11, v64
  v_lshl_add_u32 v69, v68, 4, v69
  v_add_u32 v114, 57344, v69
  v_add_u32 v70, 0, v64
  v_lshlrev_b32 v69, 9, v66
  v_lshl_add_u32 v69, v70, 5, v69
  v_lshl_add_u32 v69, v67, 2, v69
  v_add_u32 v115, 65536, v69
  v_lshlrev_b32 v69, 4, v68
  v_lshl_add_u32 v69, v64, 9, v69
  v_add_u32 v114, 57344, v69
  v_mul_u32_u24 v69, 144, v70
  v_lshl_add_u32 v69, v67, 4, v69
  v_add_u32 v115, 65536, v69
  v_and_b32 v71, 1, v116
  v_mul_u32_u24 v69, 2048, v71
  v_lshl_add_u32 v69, v64, 8, v69
  v_lshl_add_u32 v69, v117, 4, v69
  v_add_u32 v112, 57344, v69
  v_mul_u32_u24 v69, 144, v117
  v_lshl_add_u32 v69, v71, 6, v69
  v_lshl_add_u32 v69, v64, 5, v69
  v_add_u32 v113, 65536, v69
  v_and_b32 v71, 1, v1
  v_cmp_eq_u32 s[38:39], 0, v71
  v_cmp_gt_u32 vcc, 8, v65
  s_or_b64 s[28:29], s[38:39], vcc
  v_lshrrev_b32 v72, 1, v67
  v_lshlrev_b32 v72, 2, v72
  v_lshl_add_u32 v72, v70, 4, v72
  s_lshl_b32 s22, s17, 9
  s_add_u32 s22, s22, 9216
  v_lshl_add_u32 v73, v66, 7, v72
  v_add_u32 v73, s22, v73
  s_lshl_b32 s22, s17, 7
  s_add_u32 s22, s22, 7168
  v_add_u32 v74, s22, v72
  v_bfe_u32 v72, v65, 1, 1
  v_lshlrev_b32 v72, 7, v72
  v_lshl_add_u32 v72, v70, 4, v72
  v_bfe_u32 v73, v65, 2, 2
  v_lshl_add_u32 v72, v73, 2, v72
  v_lshrrev_b32 v73, 4, v65
  v_lshl_add_u32 v73, v73, 8, v72
  s_lshl_b32 s22, s17, 9
  s_add_u32 s22, s22, 9216
  v_add_u32 v73, s22, v73
  s_lshr_b32 s22, s17, 1
  s_lshl_b32 s22, s22, 8
  s_and_b32 s34, s17, 1
  s_lshl_b32 s34, s34, 3
  s_add_u32 s22, s22, s34
  s_add_u32 s22, s22, 7168
  v_add_u32 v74, s22, v72
  v_bfe_u32 v72, v65, 1, 1
  v_lshl_add_u32 v72, v64, 1, v72
  v_lshlrev_b32 v72, 4, v72
  v_bfe_u32 v73, v65, 2, 2
  v_lshl_add_u32 v72, v73, 2, v72
  v_lshrrev_b32 v73, 4, v65
  v_lshl_add_u32 v73, v73, 6, v72
  s_lshl_b32 s22, s17, 9
  s_add_u32 s22, s22, 9216
  v_add_u32 v73, s22, v73
  v_lshrrev_b32 v72, 1, v65
  v_lshlrev_b32 v72, 2, v72
  v_lshl_add_u32 v72, v64, 5, v72
  s_lshr_b32 s22, s17, 1
  s_lshl_b32 s22, s22, 8
  s_and_b32 s34, s17, 1
  s_lshl_b32 s34, s34, 4
  s_add_u32 s22, s22, s34
  s_add_u32 s22, s22, 7168
  v_add_u32 v74, s22, v72
  v_lshlrev_b32 v0, 2, v65
  s_and_b32 s22, s17, 31
  s_lshl_b32 s22, s22, 7
  s_add_u32 s22, s22, 21504
  v_add_u32 v0, s22, v0
  v_cndmask_b32 v1, v74, v73, s[38:39]
  s_lshl_b32 s36, s17, 2
  s_add_u32 s36, s36, 17408
  s_mov_b32 s37, 0x3e800000
  v_mov_b32 v64, 0
  v_mov_b32 v65, 0
  v_mov_b32 v66, 0
  v_mov_b32 v67, 0
  v_mov_b32 v68, 0
  v_mov_b32 v69, 0
  v_mov_b32 v70, 0
  v_mov_b32 v71, 0
  v_mov_b32 v72, 0
  v_mov_b32 v73, 0
  v_mov_b32 v74, 0
  v_mov_b32 v75, 0
  v_mov_b32 v76, 0
  v_mov_b32 v77, 0
  v_mov_b32 v78, 0
  v_mov_b32 v79, 0
  v_mov_b32 v80, 0
  v_mov_b32 v81, 0
  v_mov_b32 v82, 0
  v_mov_b32 v83, 0
  v_mov_b32 v84, 0
  v_mov_b32 v85, 0
  v_mov_b32 v86, 0
  v_mov_b32 v87, 0
  v_mov_b32 v88, 0
  v_mov_b32 v89, 0
  v_mov_b32 v90, 0
  v_mov_b32 v91, 0
  v_mov_b32 v92, 0
  v_mov_b32 v93, 0
  v_mov_b32 v94, 0
  v_mov_b32 v95, 0
  v_mov_b32 v96, 0
  v_mov_b32 v97, 0
  v_mov_b32 v98, 0
  v_mov_b32 v99, 0
  v_mov_b32 v100, 0
  v_mov_b32 v101, 0
  v_mov_b32 v102, 0
  v_mov_b32 v103, 0
  v_mov_b32 v104, 0
  v_mov_b32 v105, 0
  v_mov_b32 v106, 0
  v_mov_b32 v107, 0
  v_mov_b32 v108, 0
  v_mov_b32 v109, 0
  v_mov_b32 v110, 0
  v_mov_b32 v111, 0
  v_and_b32 v118, 1, v116
  v_cmp_eq_u32 vcc, 0, v118
  v_mov_b32 v118, 12288
  v_mov_b32 v119, 8192
  v_cndmask_b32 v118, v118, v119, vcc
  v_lshrrev_b32 v116, 1, v116
  v_lshl_add_u32 v118, v116, 9, v118
  v_lshl_add_u32 v117, v117, 4, v118
  s_mov_b32 s57, 28672
  s_mov_b32 s56, 0x42800000
  v_mov_b32 v116, v2
  s_mul_i32 s35, s17, 1835008
  s_add_u32 s35, s35, 42262528
  s_mov_b32 s30, 0
  v_mov_b32 v36, 0
ch_md0:
  buffer_load_dword v37, v36, s[12:15], 0 offen sc1
  s_waitcnt vmcnt(0)
  v_readfirstlane_b32 s22, v37
  s_and_b32 s31, s22, 0xffff
  s_cmp_ge_u32 s31, 32
  s_cbranch_scc1 ch_go0
  s_sleep 2
  s_add_u32 s30, s30, 1
  s_cmp_lt_u32 s30, 50000
  s_cbranch_scc1 ch_md0
  s_branch ch_end
ch_go0:
  s_mov_b32 s31, 0
  s_lshr_b32 s22, s22, 16
  s_cmp_lg_u32 s22, 0
  s_cbranch_scc1 cB_sc0_loop
  s_branch cA_sc0_loop
ch_init1:
  s_mul_i32 s31, s17, 401408
  s_add_u32 s31, s31, 0
  s_mov_b32 s24, 71572480
  s_mov_b32 s25, 0
  s_add_u32 m0, s25, 7168
  s_nop 0
  buffer_load_dwordx4 v2, s[8:11], s24 offen offset:0 sc1 lds
  buffer_load_dwordx4 v2, s[8:11], s24 offen offset:1024 sc1 lds
  buffer_load_dwordx4 v2, s[8:11], s24 offen offset:2048 sc1 lds
  buffer_load_dwordx4 v2, s[8:11], s24 offen offset:3072 sc1 lds
  s_add_u32 m0, s25, 11264
  s_add_u32 s22, s24, 4096
  buffer_load_dwordx4 v2, s[8:11], s22 offen offset:0 sc1 lds
  buffer_load_dwordx4 v2, s[8:11], s22 offen offset:1024 sc1 lds
  buffer_load_dwordx4 v2, s[8:11], s22 offen offset:2048 sc1 lds
  v_and_b32 v64, 7, v117
  v_and_b32 v65, 1, v116
  v_lshlrev_b32 v65, 2, v65
  v_sub_u32 v64, v64, v65
  v_lshrrev_b32 v65, 3, v117
  v_lshl_add_u32 v66, v65, 2, v64
  v_cmp_gt_u32 vcc, 4, v64
  v_mov_b32 v67, 99
  s_nop 0
  v_cndmask_b32 v66, v67, v66, vcc
  v_mov_b32 v68, 0x3f80
  v_mov_b32 v69, 0x3f800000
  v_mov_b32 v4, 0
  v_cmp_eq_u32 vcc, 0, v66
  s_nop 1
  v_cndmask_b32 v4, v4, v68, vcc
  v_cmp_eq_u32 vcc, 1, v66
  s_nop 1
  v_cndmask_b32 v4, v4, v69, vcc
  v_mov_b32 v5, 0
  v_cmp_eq_u32 vcc, 2, v66
  s_nop 1
  v_cndmask_b32 v5, v5, v68, vcc
  v_cmp_eq_u32 vcc, 3, v66
  s_nop 1
  v_cndmask_b32 v5, v5, v69, vcc
  v_mov_b32 v6, 0
  v_cmp_eq_u32 vcc, 4, v66
  s_nop 1
  v_cndmask_b32 v6, v6, v68, vcc
  v_cmp_eq_u32 vcc, 5, v66
  s_nop 1
  v_cndmask_b32 v6, v6, v69, vcc
  v_mov_b32 v7, 0
  v_cmp_eq_u32 vcc, 6, v66
  s_nop 1
  v_cndmask_b32 v7, v7, v68, vcc
  v_cmp_eq_u32 vcc, 7, v66
  s_nop 1
  v_cndmask_b32 v7, v7, v69, vcc
  v_lshrrev_b32 v64, 1, v116
  v_lshrrev_b32 v65, 3, v117
  v_cmp_eq_u32 s[26:27], v64, v65
  v_and_b32 v66, 1, v116
  v_add_u32 v64, 2, v64
  v_lshrrev_b32 v67, 1, v116
  v_lshlrev_b32 v67, 8, v67
  v_lshl_add_u32 v67, v66, 9, v67
  v_lshl_add_u32 v67, v117, 4, v67
  v_add_u32 v112, 58368, v67
  v_and_b32 v68, 7, v117
  v_lshlrev_b32 v67, 8, v64
  v_lshl_add_u32 v67, v68, 5, v67
  v_lshl_add_u32 v67, v66, 4, v67
  v_add_u32 v113, 65536, v67
  v_lshrrev_b32 v64, 5, v1
  v_and_b32 v65, 31, v1
  v_lshrrev_b32 v66, 3, v65
  v_and_b32 v67, 7, v65
  v_and_b32 v68, 3, v67
  v_lshl_add_u32 v68, v66, 2, v68
  v_lshrrev_b32 v69, 2, v67
  v_lshl_add_u32 v68, v69, 4, v68
  v_lshlrev_b32 v69, 11, v64
  v_lshl_add_u32 v69, v68, 4, v69
  v_add_u32 v114, 57352, v69
  v_add_u32 v70, 2, v64
  v_lshlrev_b32 v69, 9, v66
  v_lshl_add_u32 v69, v70, 5, v69
  v_lshl_add_u32 v69, v67, 2, v69
  v_add_u32 v115, 65536, v69
  v_lshlrev_b32 v69, 4, v68
  v_lshl_add_u32 v69, v64, 9, v69
  v_add_u32 v114, 58368, v69
  v_mul_u32_u24 v69, 144, v70
  v_lshl_add_u32 v69, v67, 4, v69
  v_add_u32 v115, 65536, v69
  v_and_b32 v71, 1, v116
  v_mul_u32_u24 v69, 2048, v71
  v_lshl_add_u32 v69, v64, 8, v69
  v_lshl_add_u32 v69, v117, 4, v69
  v_add_u32 v112, 57352, v69
  v_mul_u32_u24 v69, 144, v117
  v_lshl_add_u32 v69, v71, 6, v69
  v_lshl_add_u32 v69, v64, 5, v69
  v_add_u32 v113, 65540, v69
  v_and_b32 v71, 1, v1
  v_cmp_eq_u32 s[38:39], 0, v71
  v_cmp_gt_u32 vcc, 8, v65
  s_or_b64 s[28:29], s[38:39], vcc
  v_lshrrev_b32 v72, 1, v67
  v_lshlrev_b32 v72, 2, v72
  v_lshl_add_u32 v72, v70, 4, v72
  s_lshl_b32 s22, s17, 9
  s_add_u32 s22, s22, 9216
  v_lshl_add_u32 v73, v66, 7, v72
  v_add_u32 v73, s22, v73
  s_lshl_b32 s22, s17, 7
  s_add_u32 s22, s22, 7168
  v_add_u32 v74, s22, v72
  v_bfe_u32 v72, v65, 1, 1
  v_lshlrev_b32 v72, 7, v72
  v_lshl_add_u32 v72, v70, 4, v72
  v_bfe_u32 v73, v65, 2, 2
  v_lshl_add_u32 v72, v73, 2, v72
  v_lshrrev_b32 v73, 4, v65
  v_lshl_add_u32 v73, v73, 8, v72
  s_lshl_b32 s22, s17, 9
  s_add_u32 s22, s22, 9216
  v_add_u32 v73, s22, v73
  s_lshr_b32 s22, s17, 1
  s_lshl_b32 s22, s22, 8
  s_and_b32 s34, s17, 1
  s_lshl_b32 s34, s34, 3
  s_add_u32 s22, s22, s34
  s_add_u32 s22, s22, 7168
  v_add_u32 v74, s22, v72
  v_bfe_u32 v72, v65, 1, 1
  v_lshl_add_u32 v72, v64, 1, v72
  v_lshlrev_b32 v72, 4, v72
  v_bfe_u32 v73, v65, 2, 2
  v_lshl_add_u32 v72, v73, 2, v72
  v_lshrrev_b32 v73, 4, v65
  v_lshl_add_u32 v73, v73, 6, v72
  s_lshl_b32 s22, s17, 9
  s_add_u32 s22, s22, 9344
  v_add_u32 v73, s22, v73
  v_lshrrev_b32 v72, 1, v65
  v_lshlrev_b32 v72, 2, v72
  v_lshl_add_u32 v72, v64, 5, v72
  s_lshr_b32 s22, s17, 1
  s_lshl_b32 s22, s22, 8
  s_and_b32 s34, s17, 1
  s_lshl_b32 s34, s34, 4
  s_add_u32 s22, s22, s34
  s_add_u32 s22, s22, 7232
  v_add_u32 v74, s22, v72
  v_lshlrev_b32 v0, 2, v65
  s_and_b32 s22, s17, 31
  s_lshl_b32 s22, s22, 7
  s_add_u32 s22, s22, 21504
  v_add_u32 v0, s22, v0
  v_cndmask_b32 v1, v74, v73, s[38:39]
  s_lshl_b32 s36, s17, 2
  s_add_u32 s36, s36, 17408
  s_mov_b32 s37, 0x3e800000
  v_mov_b32 v64, 0
  v_mov_b32 v65, 0
  v_mov_b32 v66, 0
  v_mov_b32 v67, 0
  v_mov_b32 v68, 0
  v_mov_b32 v69, 0
  v_mov_b32 v70, 0
  v_mov_b32 v71, 0
  v_mov_b32 v72, 0
  v_mov_b32 v73, 0
  v_mov_b32 v74, 0
  v_mov_b32 v75, 0
  v_mov_b32 v76, 0
  v_mov_b32 v77, 0
  v_mov_b32 v78, 0
  v_mov_b32 v79, 0
  v_mov_b32 v80, 0
  v_mov_b32 v81, 0
  v_mov_b32 v82, 0
  v_mov_b32 v83, 0
  v_mov_b32 v84, 0
  v_mov_b32 v85, 0
  v_mov_b32 v86, 0
  v_mov_b32 v87, 0
  v_mov_b32 v88, 0
  v_mov_b32 v89, 0
  v_mov_b32 v90, 0
  v_mov_b32 v91, 0
  v_mov_b32 v92, 0
  v_mov_b32 v93, 0
  v_mov_b32 v94, 0
  v_mov_b32 v95, 0
  v_mov_b32 v96, 0
  v_mov_b32 v97, 0
  v_mov_b32 v98, 0
  v_mov_b32 v99, 0
  v_mov_b32 v100, 0
  v_mov_b32 v101, 0
  v_mov_b32 v102, 0
  v_mov_b32 v103, 0
  v_mov_b32 v104, 0
  v_mov_b32 v105, 0
  v_mov_b32 v106, 0
  v_mov_b32 v107, 0
  v_mov_b32 v108, 0
  v_mov_b32 v109, 0
  v_mov_b32 v110, 0
  v_mov_b32 v111, 0
  v_and_b32 v118, 1, v116
  v_cmp_eq_u32 vcc, 0, v118
  v_mov_b32 v118, 12288
  v_mov_b32 v119, 8448
  v_cndmask_b32 v118, v118, v119, vcc
  v_lshrrev_b32 v116, 1, v116
  v_lshl_add_u32 v118, v116, 9, v118
  v_lshl_add_u32 v117, v117, 4, v118
  s_mov_b32 s57, 28672
  s_mov_b32 s56, 0x42800000
  v_mov_b32 v116, v2
  v_lshrrev_b32 v0, 4, v2
  v_min_u32 v0, 12, v0
  s_mul_i32 s22, s17, 13
  v_add_u32 v0, s22, v0
  v_lshlrev_b32 v0, 7, v0
  v_add_u32 v0, 51200, v0
  s_mov_b32 s22, 75209728
  buffer_load_dword v119, v0, s[8:11], s22 offen sc1
  s_mov_b32 s22, 75184128
  buffer_load_dword v119, v0, s[8:11], s22 offen sc1
  s_mul_i32 s35, s17, 1835008
  s_add_u32 s35, s35, 42269696
  s_mov_b32 s30, 0
  v_mov_b32 v36, 0
ch_md1:
  buffer_load_dword v37, v36, s[12:15], 0 offen sc1
  s_waitcnt vmcnt(0)
  v_readfirstlane_b32 s22, v37
  s_and_b32 s31, s22, 0xffff
  s_cmp_ge_u32 s31, 32
  s_cbranch_scc1 ch_go1
  s_sleep 2
  s_add_u32 s30, s30, 1
  s_cmp_lt_u32 s30, 50000
  s_cbranch_scc1 ch_md1
  s_branch ch_end
ch_go1:
  s_mov_b32 s31, 0
  s_lshr_b32 s22, s22, 16
  s_cmp_lg_u32 s22, 0
  s_cbranch_scc1 cB_sc1_loop
  s_branch cA_sc1_loop
ch_init2:
  s_mul_i32 s31, s17, 401408
  s_add_u32 s31, s31, 0
  s_mov_b32 s24, 71579648
  s_mov_b32 s25, 0
  s_add_u32 m0, s25, 14336
  s_nop 0
  buffer_load_dwordx4 v2, s[8:11], s24 offen offset:0 sc1 lds
  buffer_load_dwordx4 v2, s[8:11], s24 offen offset:1024 sc1 lds
  buffer_load_dwordx4 v2, s[8:11], s24 offen offset:2048 sc1 lds
  buffer_load_dwordx4 v2, s[8:11], s24 offen offset:3072 sc1 lds
  s_add_u32 m0, s25, 18432
  s_add_u32 s22, s24, 4096
  buffer_load_dwordx4 v2, s[8:11], s22 offen offset:0 sc1 lds
  buffer_load_dwordx4 v2, s[8:11], s22 offen offset:1024 sc1 lds
  buffer_load_dwordx4 v2, s[8:11], s22 offen offset:2048 sc1 lds
  v_and_b32 v64, 7, v117
  v_and_b32 v65, 1, v116
  v_lshlrev_b32 v65, 2, v65
  v_sub_u32 v64, v64, v65
  v_lshrrev_b32 v65, 3, v117
  v_lshl_add_u32 v66, v65, 2, v64
  v_cmp_gt_u32 vcc, 4, v64
  v_mov_b32 v67, 99
  s_nop 0
  v_cndmask_b32 v66, v67, v66, vcc
  v_mov_b32 v68, 0x3f80
  v_mov_b32 v69, 0x3f800000
  v_mov_b32 v4, 0
  v_cmp_eq_u32 vcc, 0, v66
  s_nop 1
  v_cndmask_b32 v4, v4, v68, vcc
  v_cmp_eq_u32 vcc, 1, v66
  s_nop 1
  v_cndmask_b32 v4, v4, v69, vcc
  v_mov_b32 v5, 0
  v_cmp_eq_u32 vcc, 2, v66
  s_nop 1
  v_cndmask_b32 v5, v5, v68, vcc
  v_cmp_eq_u32 vcc, 3, v66
  s_nop 1
  v_cndmask_b32 v5, v5, v69, vcc
  v_mov_b32 v6, 0
  v_cmp_eq_u32 vcc, 4, v66
  s_nop 1
  v_cndmask_b32 v6, v6, v68, vcc
  v_cmp_eq_u32 vcc, 5, v66
  s_nop 1
  v_cndmask_b32 v6, v6, v69, vcc
  v_mov_b32 v7, 0
  v_cmp_eq_u32 vcc, 6, v66
  s_nop 1
  v_cndmask_b32 v7, v7, v68, vcc
  v_cmp_eq_u32 vcc, 7, v66
  s_nop 1
  v_cndmask_b32 v7, v7, v69, vcc
  v_lshrrev_b32 v64, 1, v116
  v_lshrrev_b32 v65, 3, v117
  v_cmp_eq_u32 s[26:27], v64, v65
  v_and_b32 v66, 1, v116
  v_add_u32 v64, 4, v64
  v_lshrrev_b32 v67, 1, v116
  v_lshlrev_b32 v67, 8, v67
  v_lshl_add_u32 v67, v66, 9, v67
  v_lshl_add_u32 v67, v117, 4, v67
  v_add_u32 v112, 59392, v67
  v_and_b32 v68, 7, v117
  v_lshlrev_b32 v67, 8, v64
  v_lshl_add_u32 v67, v68, 5, v67
  v_lshl_add_u32 v67, v66, 4, v67
  v_add_u32 v113, 65536, v67
  v_lshrrev_b32 v64, 5, v1
  v_and_b32 v65, 31, v1
  v_lshrrev_b32 v66, 3, v65
  v_and_b32 v67, 7, v65
  v_and_b32 v68, 3, v67
  v_lshl_add_u32 v68, v66, 2, v68
  v_lshrrev_b32 v69, 2, v67
  v_lshl_add_u32 v68, v69, 4, v68
  v_lshlrev_b32 v69, 11, v64
  v_lshl_add_u32 v69, v68, 4, v69
  v_add_u32 v114, 57856, v69
  v_add_u32 v70, 4, v64
  v_lshlrev_b32 v69, 9, v66
  v_lshl_add_u32 v69, v70, 5, v69
  v_lshl_add_u32 v69, v67, 2, v69
  v_add_u32 v115, 65536, v69
  v_lshlrev_b32 v69, 4, v68
  v_lshl_add_u32 v69, v64, 9, v69
  v_add_u32 v114, 59392, v69
  v_mul_u32_u24 v69, 144, v70
  v_lshl_add_u32 v69, v67, 4, v69
  v_add_u32 v115, 65536, v69
  v_and_b32 v71, 1, v116
  v_mul_u32_u24 v69, 2048, v71
  v_lshl_add_u32 v69, v64, 8, v69
  v_lshl_add_u32 v69, v117, 4, v69
  v_add_u32 v112, 57856, v69
  v_mul_u32_u24 v69, 144, v117
  v_lshl_add_u32 v69, v71, 6, v69
  v_lshl_add_u32 v69, v64, 5, v69
  v_add_u32 v113, 65544, v69
  v_and_b32 v71, 1, v1
  v_cmp_eq_u32 s[38:39], 0, v71
  v_cmp_gt_u32 vcc, 8, v65
  s_or_b64 s[28:29], s[38:39], vcc
  v_lshrrev_b32 v72, 1, v67
  v_lshlrev_b32 v72, 2, v72
  v_lshl_add_u32 v72, v70, 4, v72
  s_lshl_b32 s22, s17, 9
  s_add_u32 s22, s22, 9216
  v_lshl_add_u32 v73, v66, 7, v72
  v_add_u32 v73, s22, v73
  s_lshl_b32 s22, s17, 7
  s_add_u32 s22, s22, 7168
  v_add_u32 v74, s22, v72
  v_bfe_u32 v72, v65, 1, 1
  v_lshlrev_b32 v72, 7, v72
  v_lshl_add_u32 v72, v70, 4, v72
  v_bfe_u32 v73, v65, 2, 2
  v_lshl_add_u32 v72, v73, 2, v72
  v_lshrrev_b32 v73, 4, v65
  v_lshl_add_u32 v73, v73, 8, v72
  s_lshl_b32 s22, s17, 9
  s_add_u32 s22, s22, 9216
  v_add_u32 v73, s22, v73
  s_lshr_b32 s22, s17, 1
  s_lshl_b32 s22, s22, 8
  s_and_b32 s34, s17, 1
  s_lshl_b32 s34, s34, 3
  s_add_u32 s22, s22, s34
  s_add_u32 s22, s22, 7168
  v_add_u32 v74, s22, v72
  v_bfe_u32 v72, v65, 1, 1
  v_lshl_add_u32 v72, v64, 1, v72
  v_lshlrev_b32 v72, 4, v72
  v_bfe_u32 v73, v65, 2, 2
  v_lshl_add_u32 v72, v73, 2, v72
  v_lshrrev_b32 v73, 4, v65
  v_lshl_add_u32 v73, v73, 6, v72
  s_lshl_b32 s22, s17, 9
  s_add_u32 s22, s22, 9472
  v_add_u32 v73, s22, v73
  v_lshrrev_b32 v72, 1, v65
  v_lshlrev_b32 v72, 2, v72
  v_lshl_add_u32 v72, v64, 5, v72
  s_lshr_b32 s22, s17, 1
  s_lshl_b32 s22, s22, 8
  s_and_b32 s34, s17, 1
  s_lshl_b32 s34, s34, 4
  s_add_u32 s22, s22, s34
  s_add_u32 s22, s22, 7296
  v_add_u32 v74, s22, v72
  v_lshlrev_b32 v0, 2, v65
  s_and_b32 s22, s17, 31
  s_lshl_b32 s22, s22, 7
  s_add_u32 s22, s22, 21504
  v_add_u32 v0, s22, v0
  v_cndmask_b32 v1, v74, v73, s[38:39]
  s_lshl_b32 s36, s17, 2
  s_add_u32 s36, s36, 17408
  s_mov_b32 s37, 0x3e800000
  v_mov_b32 v64, 0
  v_mov_b32 v65, 0
  v_mov_b32 v66, 0
  v_mov_b32 v67, 0
  v_mov_b32 v68, 0
  v_mov_b32 v69, 0
  v_mov_b32 v70, 0
  v_mov_b32 v71, 0
  v_mov_b32 v72, 0
  v_mov_b32 v73, 0
  v_mov_b32 v74, 0
  v_mov_b32 v75, 0
  v_mov_b32 v76, 0
  v_mov_b32 v77, 0
  v_mov_b32 v78, 0
  v_mov_b32 v79, 0
  v_mov_b32 v80, 0
  v_mov_b32 v81, 0
  v_mov_b32 v82, 0
  v_mov_b32 v83, 0
  v_mov_b32 v84, 0
  v_mov_b32 v85, 0
  v_mov_b32 v86, 0
  v_mov_b32 v87, 0
  v_mov_b32 v88, 0
  v_mov_b32 v89, 0
  v_mov_b32 v90, 0
  v_mov_b32 v91, 0
  v_mov_b32 v92, 0
  v_mov_b32 v93, 0
  v_mov_b32 v94, 0
  v_mov_b32 v95, 0
  v_mov_b32 v96, 0
  v_mov_b32 v97, 0
  v_mov_b32 v98, 0
  v_mov_b32 v99, 0
  v_mov_b32 v100, 0
  v_mov_b32 v101, 0
  v_mov_b32 v102, 0
  v_mov_b32 v103, 0
  v_mov_b32 v104, 0
  v_mov_b32 v105, 0
  v_mov_b32 v106, 0
  v_mov_b32 v107, 0
  v_mov_b32 v108, 0
  v_mov_b32 v109, 0
  v_mov_b32 v110, 0
  v_mov_b32 v111, 0
  v_and_b32 v118, 1, v116
  v_cmp_eq_u32 vcc, 0, v118
  v_mov_b32 v118, 12544
  v_mov_b32 v119, 10240
  v_cndmask_b32 v118, v118, v119, vcc
  v_lshrrev_b32 v116, 1, v116
  v_lshl_add_u32 v118, v116, 9, v118
  v_lshl_add_u32 v117, v117, 4, v118
  s_mov_b32 s57, 28672
  s_mov_b32 s56, 0x42800000
  v_mov_b32 v116, v2
  v_lshrrev_b32 v0, 4, v2
  v_min_u32 v0, 13, v0
  s_mul_i32 s22, s17, 14
  v_add_u32 v0, s22, v0
  v_lshlrev_b32 v0, 7, v0
  v_add_u32 v0, 43008, v0
  s_mov_b32 s22, 71550976
  buffer_load_dword v119, v0, s[8:11], s22 offen sc1
  s_mov_b32 s22, 71522304
  buffer_load_dword v119, v0, s[8:11], s22 offen sc1
  s_mul_i32 s35, s17, 1835008
  s_add_u32 s35, s35, 42276864
  s_mov_b32 s30, 0
  v_mov_b32 v36, 0
ch_md2:
  buffer_load_dword v37, v36, s[12:15], 0 offen sc1
  s_waitcnt vmcnt(0)
  v_readfirstlane_b32 s22, v37
  s_and_b32 s31, s22, 0xffff
  s_cmp_ge_u32 s31, 32
  s_cbranch_scc1 ch_go2
  s_sleep 2
  s_add_u32 s30, s30, 1
  s_cmp_lt_u32 s30, 50000
  s_cbranch_scc1 ch_md2
  s_branch ch_end
ch_go2:
  s_mov_b32 s31, 0
  s_lshr_b32 s22, s22, 16
  s_cmp_lg_u32 s22, 0
  s_cbranch_scc1 cB_sc2_loop
  s_branch cA_sc2_loop
ch_init3:
  s_mul_i32 s31, s17, 401408
  s_add_u32 s31, s31, 0
  s_mov_b32 s24, 71586816
  s_mov_b32 s25, 0
  s_add_u32 m0, s25, 21504
  s_nop 0
  buffer_load_dwordx4 v2, s[8:11], s24 offen offset:0 sc1 lds
  buffer_load_dwordx4 v2, s[8:11], s24 offen offset:1024 sc1 lds
  buffer_load_dwordx4 v2, s[8:11], s24 offen offset:2048 sc1 lds
  buffer_load_dwordx4 v2, s[8:11], s24 offen offset:3072 sc1 lds
  s_add_u32 m0, s25, 25600
  s_add_u32 s22, s24, 4096
  buffer_load_dwordx4 v2, s[8:11], s22 offen offset:0 sc1 lds
  buffer_load_dwordx4 v2, s[8:11], s22 offen offset:1024 sc1 lds
  buffer_load_dwordx4 v2, s[8:11], s22 offen offset:2048 sc1 lds
  v_and_b32 v64, 7, v117
  v_and_b32 v65, 1, v116
  v_lshlrev_b32 v65, 2, v65
  v_sub_u32 v64, v64, v65
  v_lshrrev_b32 v65, 3, v117
  v_lshl_add_u32 v66, v65, 2, v64
  v_cmp_gt_u32 vcc, 4, v64
  v_mov_b32 v67, 99
  s_nop 0
  v_cndmask_b32 v66, v67, v66, vcc
  v_mov_b32 v68, 0x3f80
  v_mov_b32 v69, 0x3f800000
  v_mov_b32 v4, 0
  v_cmp_eq_u32 vcc, 0, v66
  s_nop 1
  v_cndmask_b32 v4, v4, v68, vcc
  v_cmp_eq_u32 vcc, 1, v66
  s_nop 1
  v_cndmask_b32 v4, v4, v69, vcc
  v_mov_b32 v5, 0
  v_cmp_eq_u32 vcc, 2, v66
  s_nop 1
  v_cndmask_b32 v5, v5, v68, vcc
  v_cmp_eq_u32 vcc, 3, v66
  s_nop 1
  v_cndmask_b32 v5, v5, v69, vcc
  v_mov_b32 v6, 0
  v_cmp_eq_u32 vcc, 4, v66
  s_nop 1
  v_cndmask_b32 v6, v6, v68, vcc
  v_cmp_eq_u32 vcc, 5, v66
  s_nop 1
  v_cndmask_b32 v6, v6, v69, vcc
  v_mov_b32 v7, 0
  v_cmp_eq_u32 vcc, 6, v66
  s_nop 1
  v_cndmask_b32 v7, v7, v68, vcc
  v_cmp_eq_u32 vcc, 7, v66
  s_nop 1
  v_cndmask_b32 v7, v7, v69, vcc
  v_lshrrev_b32 v64, 1, v116
  v_lshrrev_b32 v65, 3, v117
  v_cmp_eq_u32 s[26:27], v64, v65
  v_and_b32 v66, 1, v116
  v_add_u32 v64, 6, v64
  v_lshrrev_b32 v67, 1, v116
  v_lshlrev_b32 v67, 8, v67
  v_lshl_add_u32 v67, v66, 9, v67
  v_lshl_add_u32 v67, v117, 4, v67
  v_add_u32 v112, 60416, v67
  v_and_b32 v68, 7, v117
  v_lshlrev_b32 v67, 8, v64
  v_lshl_add_u32 v67, v68, 5, v67
  v_lshl_add_u32 v67, v66, 4, v67
  v_add_u32 v113, 65536, v67
  v_lshrrev_b32 v64, 5, v1
  v_and_b32 v65, 31, v1
  v_lshrrev_b32 v66, 3, v65
  v_and_b32 v67, 7, v65
  v_and_b32 v68, 3, v67
  v_lshl_add_u32 v68, v66, 2, v68
  v_lshrrev_b32 v69, 2, v67
  v_lshl_add_u32 v68, v69, 4, v68
  v_lshlrev_b32 v69, 11, v64
  v_lshl_add_u32 v69, v68, 4, v69
  v_add_u32 v114, 57864, v69
  v_add_u32 v70, 6, v64
  v_lshlrev_b32 v69, 9, v66
  v_lshl_add_u32 v69, v70, 5, v69
  v_lshl_add_u32 v69, v67, 2, v69
  v_add_u32 v115, 65536, v69
  v_lshlrev_b32 v69, 4, v68
  v_lshl_add_u32 v69, v64, 9, v69
  v_add_u32 v114, 60416, v69
  v_mul_u32_u24 v69, 144, v70
  v_lshl_add_u32 v69, v67, 4, v69
  v_add_u32 v115, 65536, v69
  v_and_b32 v71, 1, v116
  v_mul_u32_u24 v69, 2048, v71
  v_lshl_add_u32 v69, v64, 8, v69
  v_lshl_add_u32 v69, v117, 4, v69
  v_add_u32 v112, 57864, v69
  v_mul_u32_u24 v69, 144, v117
  v_lshl_add_u32 v69, v71, 6, v69
  v_lshl_add_u32 v69, v64, 5, v69
  v_add_u32 v113, 65548, v69
  v_and_b32 v71, 1, v1
  v_cmp_eq_u32 s[38:39], 0, v71
  v_cmp_gt_u32 vcc, 8, v65
  s_or_b64 s[28:29], s[38:39], vcc
  v_lshrrev_b32 v72, 1, v67
  v_lshlrev_b32 v72, 2, v72
  v_lshl_add_u32 v72, v70, 4, v72
  s_lshl_b32 s22, s17, 9
  s_add_u32 s22, s22, 9216
  v_lshl_add_u32 v73, v66, 7, v72
  v_add_u32 v73, s22, v73
  s_lshl_b32 s22, s17, 7
  s_add_u32 s22, s22, 7168
  v_add_u32 v74, s22, v72
  v_bfe_u32 v72, v65, 1, 1
  v_lshlrev_b32 v72, 7, v72
  v_lshl_add_u32 v72, v70, 4, v72
  v_bfe_u32 v73, v65, 2, 2
  v_lshl_add_u32 v72, v73, 2, v72
  v_lshrrev_b32 v73, 4, v65
  v_lshl_add_u32 v73, v73, 8, v72
  s_lshl_b32 s22, s17, 9
  s_add_u32 s22, s22, 9216
  v_add_u32 v73, s22, v73
  s_lshr_b32 s22, s17, 1
  s_lshl_b32 s22, s22, 8
  s_and_b32 s34, s17, 1
  s_lshl_b32 s34, s34, 3
  s_add_u32 s22, s22, s34
  s_add_u32 s22, s22, 7168
  v_add_u32 v74, s22, v72
  v_bfe_u32 v72, v65, 1, 1
  v_lshl_add_u32 v72, v64, 1, v72
  v_lshlrev_b32 v72, 4, v72
  v_bfe_u32 v73, v65, 2, 2
  v_lshl_add_u32 v72, v73, 2, v72
  v_lshrrev_b32 v73, 4, v65
  v_lshl_add_u32 v73, v73, 6, v72
  s_lshl_b32 s22, s17, 9
  s_add_u32 s22, s22, 9600
  v_add_u32 v73, s22, v73
  v_lshrrev_b32 v72, 1, v65
  v_lshlrev_b32 v72, 2, v72
  v_lshl_add_u32 v72, v64, 5, v72
  s_lshr_b32 s22, s17, 1
  s_lshl_b32 s22, s22, 8
  s_and_b32 s34, s17, 1
  s_lshl_b32 s34, s34, 4
  s_add_u32 s22, s22, s34
  s_add_u32 s22, s22, 7360
  v_add_u32 v74, s22, v72
  v_lshlrev_b32 v0, 2, v65
  s_and_b32 s22, s17, 31
  s_lshl_b32 s22, s22, 7
  s_add_u32 s22, s22, 21504
  v_add_u32 v0, s22, v0
  v_cndmask_b32 v1, v74, v73, s[38:39]
  s_lshl_b32 s36, s17, 2
  s_add_u32 s36, s36, 17408
  s_mov_b32 s37, 0x3e800000
  v_mov_b32 v64, 0
  v_mov_b32 v65, 0
  v_mov_b32 v66, 0
  v_mov_b32 v67, 0
  v_mov_b32 v68, 0
  v_mov_b32 v69, 0
  v_mov_b32 v70, 0
  v_mov_b32 v71, 0
  v_mov_b32 v72, 0
  v_mov_b32 v73, 0
  v_mov_b32 v74, 0
  v_mov_b32 v75, 0
  v_mov_b32 v76, 0
  v_mov_b32 v77, 0
  v_mov_b32 v78, 0
  v_mov_b32 v79, 0
  v_mov_b32 v80, 0
  v_mov_b32 v81, 0
  v_mov_b32 v82, 0
  v_mov_b32 v83, 0
  v_mov_b32 v84, 0
  v_mov_b32 v85, 0
  v_mov_b32 v86, 0
  v_mov_b32 v87, 0
  v_mov_b32 v88, 0
  v_mov_b32 v89, 0
  v_mov_b32 v90, 0
  v_mov_b32 v91, 0
  v_mov_b32 v92, 0
  v_mov_b32 v93, 0
  v_mov_b32 v94, 0
  v_mov_b32 v95, 0
  v_mov_b32 v96, 0
  v_mov_b32 v97, 0
  v_mov_b32 v98, 0
  v_mov_b32 v99, 0
  v_mov_b32 v100, 0
  v_mov_b32 v101, 0
  v_mov_b32 v102, 0
  v_mov_b32 v103, 0
  v_mov_b32 v104, 0
  v_mov_b32 v105, 0
  v_mov_b32 v106, 0
  v_mov_b32 v107, 0
  v_mov_b32 v108, 0
  v_mov_b32 v109, 0
  v_mov_b32 v110, 0
  v_mov_b32 v111, 0
  v_and_b32 v118, 1, v116
  v_cmp_eq_u32 vcc, 0, v118
  v_mov_b32 v118, 12544
  v_mov_b32 v119, 10496
  v_cndmask_b32 v118, v118, v119, vcc
  v_lshrrev_b32 v116, 1, v116
  v_lshl_add_u32 v118, v116, 9, v118
  v_lshl_add_u32 v117, v117, 4, v118
  s_mov_b32 s57, 28672
  s_mov_b32 s56, 0x42800000
  v_mov_b32 v116, v2
  s_mul_i32 s35, s17, 1835008
  s_add_u32 s35, s35, 42284032
  s_mov_b32 s30, 0
  v_mov_b32 v36, 0
ch_md3:
  buffer_load_dword v37, v36, s[12:15], 0 offen sc1
  s_waitcnt vmcnt(0)
  v_readfirstlane_b32 s22, v37
  s_and_b32 s31, s22, 0xffff
  s_cmp_ge_u32 s31, 32
  s_cbranch_scc1 ch_go3
  s_sleep 2
  s_add_u32 s30, s30, 1
  s_cmp_lt_u32 s30, 50000
  s_cbranch_scc1 ch_md3
  s_branch ch_end
ch_go3:
  s_mov_b32 s31, 0
  s_lshr_b32 s22, s22, 16
  s_cmp_lg_u32 s22, 0
  s_cbranch_scc1 cB_sc3_loop
  s_branch cA_sc3_loop
ch_init4:
  s_mul_i32 s31, s17, 401408
  s_add_u32 s31, s31, 6422528
  s_mul_i32 s22, s17, 28
  s_add_u32 s23, s22, 27
  s_lshr_b32 s22, s22, 6
  s_lshr_b32 s23, s23, 6
  s_sub_u32 s23, s23, s22
  s_lshl_b32 s23, s23, 8
  v_and_b32 v36, s23, v2
  v_med3_u32 v37, v117, 0, 3
  v_lshl_add_u32 v36, v37, 4, v36
  s_lshl_b32 s22, s22, 8
  s_add_u32 s22, s22, 88588288
  s_mov_b32 s30, 0
va_bw_11:
  buffer_load_dwordx4 v[40:43], v36, s[8:11], s22 offen sc1
  s_waitcnt vmcnt(0)
  v_cmp_ne_u64 vcc, s[88:89], v[40:41]
  s_cbranch_vccnz va_bw_11_no
  v_cmp_ne_u64 vcc, s[88:89], v[42:43]
  s_cbranch_vccnz va_bw_11_no
  s_branch va_bw_11_ok
va_bw_11_no:
  s_sleep 2
  s_add_u32 s30, s30, 1
  s_cmp_lt_u32 s30, 50000
  s_cbranch_scc1 va_bw_11
  s_branch cA_abort
va_bw_11_ok:
  s_add_u32 s22, s31, 0
  buffer_load_dwordx4 a[0:3], v2, s[8:11], s22 offen offset:0 sc1
  buffer_load_dwordx4 a[4:7], v2, s[8:11], s22 offen offset:1024 sc1
  buffer_load_dwordx4 a[8:11], v2, s[8:11], s22 offen offset:2048 sc1
  buffer_load_dwordx4 a[12:15], v2, s[8:11], s22 offen offset:3072 sc1
  s_add_u32 s22, s31, 4096
  buffer_load_dwordx4 a[16:19], v2, s[8:11], s22 offen offset:0 sc1
  buffer_load_dwordx4 a[20:23], v2, s[8:11], s22 offen offset:1024 sc1
  buffer_load_dwordx4 a[24:27], v2, s[8:11], s22 offen offset:2048 sc1
  buffer_load_dwordx4 a[28:31], v2, s[8:11], s22 offen offset:3072 sc1
  s_add_u32 s22, s31, 8192
  buffer_load_dwordx4 a[32:35], v2, s[8:11], s22 offen offset:0 sc1
  buffer_load_dwordx4 a[36:39], v2, s[8:11], s22 offen offset:1024 sc1
  buffer_load_dwordx4 a[40:43], v2, s[8:11], s22 offen offset:2048 sc1
  buffer_load_dwordx4 a[44:47], v2, s[8:11], s22 offen offset:3072 sc1
  s_add_u32 s22, s31, 12288
  buffer_load_dwordx4 a[48:51], v2, s[8:11], s22 offen offset:0 sc1
  buffer_load_dwordx4 a[52:55], v2, s[8:11], s22 offen offset:1024 sc1
  buffer_load_dwordx4 a[56:59], v2, s[8:11], s22 offen offset:2048 sc1
  buffer_load_dwordx4 a[60:63], v2, s[8:11], s22 offen offset:3072 sc1
  s_add_u32 s22, s31, 16384
  buffer_load_dwordx4 a[64:67], v2, s[8:11], s22 offen offset:0 sc1
  buffer_load_dwordx4 a[68:71], v2, s[8:11], s22 offen offset:1024 sc1
  buffer_load_dwordx4 a[72:75], v2, s[8:11], s22 offen offset:2048 sc1
  buffer_load_dwordx4 a[76:79], v2, s[8:11], s22 offen offset:3072 sc1
  s_add_u32 s22, s31, 20480
  buffer_load_dwordx4 a[80:83], v2, s[8:11], s22 offen offset:0 sc1
  buffer_load_dwordx4 a[84:87], v2, s[8:11], s22 offen offset:1024 sc1
  buffer_load_dwordx4 a[88:91], v2, s[8:11], s22 offen offset:2048 sc1
  buffer_load_dwordx4 a[92:95], v2, s[8:11], s22 offen offset:3072 sc1
  s_add_u32 s22, s31, 24576
  buffer_load_dwordx4 a[96:99], v2, s[8:11], s22 offen offset:0 sc1
  buffer_load_dwordx4 a[100:103], v2, s[8:11], s22 offen offset:1024 sc1
  buffer_load_dwordx4 a[104:107], v2, s[8:11], s22 offen offset:2048 sc1
  buffer_load_dwordx4 a[108:111], v2, s[8:11], s22 offen offset:3072 sc1
  s_add_u32 s22, s31, 28672
  buffer_load_dwordx4 a[112:115], v2, s[8:11], s22 offen offset:0 sc1
  buffer_load_dwordx4 a[116:119], v2, s[8:11], s22 offen offset:1024 sc1
  buffer_load_dwordx4 a[120:123], v2, s[8:11], s22 offen offset:2048 sc1
  buffer_load_dwordx4 a[124:127], v2, s[8:11], s22 offen offset:3072 sc1
  s_waitcnt vmcnt(24)
  s_add_u32 s22, s31, 32768
  buffer_load_dwordx4 a[128:131], v2, s[8:11], s22 offen offset:0 sc1
  buffer_load_dwordx4 a[132:135], v2, s[8:11], s22 offen offset:1024 sc1
  buffer_load_dwordx4 a[136:139], v2, s[8:11], s22 offen offset:2048 sc1
  buffer_load_dwordx4 a[140:143], v2, s[8:11], s22 offen offset:3072 sc1
  s_add_u32 s22, s31, 36864
  buffer_load_dwordx4 a[144:147], v2, s[8:11], s22 offen offset:0 sc1
  buffer_load_dwordx4 a[148:151], v2, s[8:11], s22 offen offset:1024 sc1
  buffer_load_dwordx4 a[152:155], v2, s[8:11], s22 offen offset:2048 sc1
  buffer_load_dwordx4 a[156:159], v2, s[8:11], s22 offen offset:3072 sc1
  s_add_u32 s22, s31, 40960
  buffer_load_dwordx4 a[160:163], v2, s[8:11], s22 offen offset:0 sc1
  buffer_load_dwordx4 a[164:167], v2, s[8:11], s22 offen offset:1024 sc1
  buffer_load_dwordx4 a[168:171], v2, s[8:11], s22 offen offset:2048 sc1
  buffer_load_dwordx4 a[172:175], v2, s[8:11], s22 offen offset:3072 sc1
  s_add_u32 s22, s31, 45056
  buffer_load_dwordx4 a[176:179], v2, s[8:11], s22 offen offset:0 sc1
  buffer_load_dwordx4 a[180:183], v2, s[8:11], s22 offen offset:1024 sc1
  buffer_load_dwordx4 a[184:187], v2, s[8:11], s22 offen offset:2048 sc1
  buffer_load_dwordx4 a[188:191], v2, s[8:11], s22 offen offset:3072 sc1
  s_add_u32 s22, s31, 49152
  buffer_load_dwordx4 a[192:195], v2, s[8:11], s22 offen offset:0 sc1
  buffer_load_dwordx4 a[196:199], v2, s[8:11], s22 offen offset:1024 sc1
  buffer_load_dwordx4 a[200:203], v2, s[8:11], s22 offen offset:2048 sc1
  buffer_load_dwordx4 a[204:207], v2, s[8:11], s22 offen offset:3072 sc1
  s_add_u32 s22, s31, 53248
  buffer_load_dwordx4 a[208:211], v2, s[8:11], s22 offen offset:0 sc1
  buffer_load_dwordx4 a[212:215], v2, s[8:11], s22 offen offset:1024 sc1
  buffer_load_dwordx4 a[216:219], v2, s[8:11], s22 offen offset:2048 sc1
  buffer_load_dwordx4 a[220:223], v2, s[8:11], s22 offen offset:3072 sc1
  s_add_u32 s22, s31, 57344
  buffer_load_dwordx4 a[224:227], v2, s[8:11], s22 offen offset:0 sc1
  buffer_load_dwordx4 a[228:231], v2, s[8:11], s22 offen offset:1024 sc1
  buffer_load_dwordx4 a[232:235], v2, s[8:11], s22 offen offset:2048 sc1
  buffer_load_dwordx4 a[236:239], v2, s[8:11], s22 offen offset:3072 sc1
  s_add_u32 s22, s31, 61440
  buffer_load_dwordx4 a[240:243], v2, s[8:11], s22 offen offset:0 sc1
  buffer_load_dwordx4 a[244:247], v2, s[8:11], s22 offen offset:1024 sc1
  buffer_load_dwordx4 a[248:251], v2, s[8:11], s22 offen offset:2048 sc1
  buffer_load_dwordx4 a[252:255], v2, s[8:11], s22 offen offset:3072 sc1
  s_waitcnt vmcnt(24)
  s_add_u32 s22, s31, 65536
  buffer_load_dwordx4 v[176:179], v2, s[8:11], s22 offen offset:0 sc1
  buffer_load_dwordx4 v[180:183], v2, s[8:11], s22 offen offset:1024 sc1
  buffer_load_dwordx4 v[184:187], v2, s[8:11], s22 offen offset:2048 sc1
  buffer_load_dwordx4 v[188:191], v2, s[8:11], s22 offen offset:3072 sc1
  s_add_u32 s22, s31, 69632
  buffer_load_dwordx4 v[192:195], v2, s[8:11], s22 offen offset:0 sc1
  buffer_load_dwordx4 v[196:199], v2, s[8:11], s22 offen offset:1024 sc1
  buffer_load_dwordx4 v[200:203], v2, s[8:11], s22 offen offset:2048 sc1
  buffer_load_dwordx4 v[204:207], v2, s[8:11], s22 offen offset:3072 sc1
  s_add_u32 s22, s31, 73728
  buffer_load_dwordx4 v[208:211], v2, s[8:11], s22 offen offset:0 sc1
  buffer_load_dwordx4 v[212:215], v2, s[8:11], s22 offen offset:1024 sc1
  buffer_load_dwordx4 v[216:219], v2, s[8:11], s22 offen offset:2048 sc1
  buffer_load_dwordx4 v[220:223], v2, s[8:11], s22 offen offset:3072 sc1
  s_add_u32 s22, s31, 77824
  buffer_load_dwordx4 v[224:227], v2, s[8:11], s22 offen offset:0 sc1
  buffer_load_dwordx4 v[228:231], v2, s[8:11], s22 offen offset:1024 sc1
  buffer_load_dwordx4 v[232:235], v2, s[8:11], s22 offen offset:2048 sc1
  buffer_load_dwordx4 v[236:239], v2, s[8:11], s22 offen offset:3072 sc1
  s_add_u32 s22, s31, 81920
  buffer_load_dwordx4 v[240:243], v2, s[8:11], s22 offen offset:0 sc1
  buffer_load_dwordx4 v[244:247], v2, s[8:11], s22 offen offset:1024 sc1
  buffer_load_dwordx4 v[248:251], v2, s[8:11], s22 offen offset:2048 sc1
  buffer_load_dwordx4 v[252:255], v2, s[8:11], s22 offen offset:3072 sc1
  s_mul_i32 s22, s17, 28
  s_add_u32 s23, s22, 27
  s_lshr_b32 s22, s22, 6
  s_lshr_b32 s23, s23, 6
  s_sub_u32 s23, s23, s22
  s_lshl_b32 s23, s23, 8
  v_and_b32 v36, s23, v2
  v_med3_u32 v37, v117, 10, 11
  v_lshl_add_u32 v36, v37, 4, v36
  s_lshl_b32 s22, s22, 8
  s_add_u32 s22, s22, 88588288
  s_mov_b32 s30, 0
va_bw_12:
  buffer_load_dwordx4 v[40:43], v36, s[8:11], s22 offen sc1
  s_waitcnt vmcnt(0)
  v_cmp_ne_u64 vcc, s[88:89], v[40:41]
  s_cbranch_vccnz va_bw_12_no
  v_cmp_ne_u64 vcc, s[88:89], v[42:43]
  s_cbranch_vccnz va_bw_12_no
  s_branch va_bw_12_ok
va_bw_12_no:
  s_sleep 2
  s_add_u32 s30, s30, 1
  s_cmp_lt_u32 s30, 50000
  s_cbranch_scc1 va_bw_12
  s_branch cA_abort
va_bw_12_ok:
  s_mov_b32 m0, 16384
  s_add_u32 s22, s31, 272384
  buffer_load_dwordx4 v2, s[8:11], s22 offen offset:0 sc1 lds
  buffer_load_dwordx4 v2, s[8:11], s22 offen offset:1024 sc1 lds
  buffer_load_dwordx4 v2, s[8:11], s22 offen offset:2048 sc1 lds
  buffer_load_dwordx4 v2, s[8:11], s22 offen offset:3072 sc1 lds
  s_mov_b32 m0, 20480
  s_add_u32 s22, s31, 276480
  buffer_load_dwordx4 v2, s[8:11], s22 offen offset:0 sc1 lds
  buffer_load_dwordx4 v2, s[8:11], s22 offen offset:1024 sc1 lds
  buffer_load_dwordx4 v2, s[8:11], s22 offen offset:2048 sc1 lds
  buffer_load_dwordx4 v2, s[8:11], s22 offen offset:3072 sc1 lds
  s_mov_b32 m0, 24576
  s_add_u32 s22, s31, 280576
  buffer_load_dwordx4 v2, s[8:11], s22 offen offset:0 sc1 lds
  buffer_load_dwordx4 v2, s[8:11], s22 offen offset:1024 sc1 lds
  buffer_load_dwordx4 v2, s[8:11], s22 offen offset:2048 sc1 lds
  buffer_load_dwordx4 v2, s[8:11], s22 offen offset:3072 sc1 lds
  s_mov_b32 m0, 28672
  s_add_u32 s22, s31, 284672
  buffer_load_dwordx4 v2, s[8:11], s22 offen offset:0 sc1 lds
  buffer_load_dwordx4 v2, s[8:11], s22 offen offset:1024 sc1 lds
  v_mov_b32 v72, v116
  v_mov_b32 v73, v117
  v_lshrrev_b32 v65, 1, v72
  v_and_b32 v66, 1, v72
  v_add_u32 v67, 0, v65
  v_lshl_add_u32 v67, v67, 4, v73
  v_mul_u32_u24 v68, 2341, v67
  v_lshrrev_b32 v68, 16, v68
  v_mul_u32_u24 v69, 28, v68
  v_sub_u32 v69, v67, v69
  v_lshrrev_b32 v70, 4, v69
  v_and_b32 v69, 15, v69
  v_and_b32 v71, 1, v69
  v_lshrrev_b32 v69, 1, v69
  v_lshl_add_u32 v69, v71, 3, v69
  v_lshlrev_b32 v71, 12, v70
  v_lshrrev_b32 v70, 1, v68
  v_lshl_add_u32 v71, v70, 9, v71
  v_and_b32 v70, 1, v68
  v_lshl_add_u32 v71, v70, 2, v71
  v_lshl_add_u32 v71, v69, 4, v71
  v_lshl_add_u32 v60, v66, 8, v71
  v_add_u32 v67, 2, v65
  v_lshl_add_u32 v67, v67, 4, v73
  v_mul_u32_u24 v68, 2341, v67
  v_lshrrev_b32 v68, 16, v68
  v_mul_u32_u24 v69, 28, v68
  v_sub_u32 v69, v67, v69
  v_lshrrev_b32 v70, 4, v69
  v_and_b32 v69, 15, v69
  v_and_b32 v71, 1, v69
  v_lshrrev_b32 v69, 1, v69
  v_lshl_add_u32 v69, v71, 3, v69
  v_lshlrev_b32 v71, 12, v70
  v_lshrrev_b32 v70, 1, v68
  v_lshl_add_u32 v71, v70, 9, v71
  v_and_b32 v70, 1, v68
  v_lshl_add_u32 v71, v70, 2, v71
  v_lshl_add_u32 v71, v69, 4, v71
  v_lshl_add_u32 v61, v66, 8, v71
  v_add_u32 v67, 4, v65
  v_lshl_add_u32 v67, v67, 4, v73
  v_mul_u32_u24 v68, 2341, v67
  v_lshrrev_b32 v68, 16, v68
  v_mul_u32_u24 v69, 28, v68
  v_sub_u32 v69, v67, v69
  v_lshrrev_b32 v70, 4, v69
  v_and_b32 v69, 15, v69
  v_and_b32 v71, 1, v69
  v_lshrrev_b32 v69, 1, v69
  v_lshl_add_u32 v69, v71, 3, v69
  v_lshlrev_b32 v71, 12, v70
  v_lshrrev_b32 v70, 1, v68
  v_lshl_add_u32 v71, v70, 9, v71
  v_and_b32 v70, 1, v68
  v_lshl_add_u32 v71, v70, 2, v71
  v_lshl_add_u32 v71, v69, 4, v71
  v_lshl_add_u32 v62, v66, 8, v71
  v_and_b32 v0, 31, v1
  v_lshlrev_b32 v0, 2, v0
  v_add_u32 v0, 21504, v0
  v_lshlrev_b32 v4, 2, v73
  s_and_b32 s22, s17, 15
  s_lshl_b32 s22, s22, 7
  s_add_u32 s22, s22, 17408
  v_add_u32 v4, s22, v4
  v_and_b32 v64, 7, v73
  v_lshlrev_b32 v5, 4, v64
  v_lshl_add_u32 v5, v72, 7, v5
  v_lshrrev_b32 v65, 3, v73
  v_lshl_add_u32 v5, v65, 9, v5
  s_lshl_b32 s22, s17, 3
  s_add_u32 s22, s22, 21504
  v_lshl_add_u32 v7, v2, 3, s22
  v_add_u32 v65, 0, v73
  v_min_u32 v65, 27, v65
  v_mad_u32_u24 v65, v72, 28, v65
  v_lshlrev_b32 v6, 4, v65
  s_lshr_b32 s22, s17, 1
  s_mul_i32 s22, s22, 7
  s_and_b32 s34, s17, 1
  s_lshl_b32 s35, s34, 2
  v_add_u32 v70, s35, v72
  v_mov_b32 v71, s34
  v_mov_b32 v69, 0
  v_cmp_eq_u32 vcc, 3, v72
  s_nop 1
  v_cndmask_b32 v70, v70, v72, vcc
  v_cndmask_b32 v69, v69, v71, vcc
  v_add_u32 v70, s22, v70
  v_lshrrev_b32 v68, 1, v70
  v_lshlrev_b32 v68, 8, v68
  v_lshl_add_u32 v68, v69, 7, v68
  v_and_b32 v69, 1, v70
  v_lshl_add_u32 v68, v69, 3, v68
  v_lshl_add_u32 v1, v64, 4, v68
  v_cmp_gt_u32 s[26:27], 8, v73
  v_lshrrev_b32 v65, 3, v73
  v_lshl_add_u32 v66, v64, 1, v65
  v_add_u32 v66, 0, v66
  v_min_u32 v66, 27, v66
  v_mad_u32_u24 v66, v72, 28, v66
  v_lshlrev_b32 v6, 4, v66
  s_mul_i32 s22, s17, 28
  s_add_u32 s22, s22, 0
  v_lshl_add_u32 v70, v64, 1, s22
  v_lshrrev_b32 v68, 4, v70
  v_lshlrev_b32 v68, 8, v68
  v_bfe_u32 v69, v70, 1, 1
  v_lshl_add_u32 v68, v69, 7, v68
  v_bfe_u32 v69, v70, 2, 2
  v_lshl_add_u32 v68, v69, 2, v68
  v_and_b32 v69, 1, v72
  v_lshl_add_u32 v65, v69, 2, v65
  v_lshrrev_b32 v69, 1, v72
  v_lshl_add_u32 v65, v69, 1, v65
  v_lshrrev_b32 v65, 3, v73
  v_lshl_add_u32 v65, v72, 1, v65
  v_lshrrev_b32 v5, 1, v72
  v_lshlrev_b32 v5, 9, v5
  v_lshrrev_b32 v69, 2, v73
  v_lshl_add_u32 v5, v69, 7, v5
  v_and_b32 v69, 1, v72
  v_lshl_add_u32 v5, v69, 6, v5
  v_and_b32 v69, 3, v73
  v_lshl_add_u32 v5, v69, 4, v5
  v_and_b32 v69, 1, v73
  v_mul_u32_u24 v69, 0xaaaa, v69
  v_add_u32 v0, 0x4444, v69
  v_lshl_add_u32 v1, v65, 4, v68
  v_cmp_gt_u32 s[26:27], 6, v64
  v_mov_b32 v156, 0
  v_mov_b32 v157, 0
  v_mov_b32 v158, 0
  v_mov_b32 v159, 0
  ds_write_b128 v2, v[156:159] offset:0
  ds_write_b128 v2, v[156:159] offset:1024
  ds_write_b128 v2, v[156:159] offset:2048
  ds_write_b128 v2, v[156:159] offset:3072
  s_mul_i32 s22, s17, 1835008
  s_add_u32 s25, s22, 42205184
  s_lshl_b32 s35, s17, 7
  s_add_u32 s35, s35, 88526848
  s_mov_b32 s38, 0
  v_mov_b32 v175, 0
  s_lshl_b32 s22, 0, 11
  s_add_u32 s22, s22, 88590336
  v_add_u32 v36, 1024, v2
  v_min_u32 v36, 1776, v36
  s_mov_b32 s30, 0
va_iw4:
  buffer_load_dwordx4 v[40:43], v2, s[8:11], s22 offen sc1
  buffer_load_dwordx4 v[44:47], v36, s[8:11], s22 offen sc1
  s_waitcnt vmcnt(0)
  v_cmp_ne_u64 vcc, s[88:89], v[40:41]
  s_cbranch_vccnz va_iw4_no
  v_cmp_ne_u64 vcc, s[88:89], v[42:43]
  s_cbranch_vccnz va_iw4_no
  v_cmp_ne_u64 vcc, s[88:89], v[44:45]
  s_cbranch_vccnz va_iw4_no
  v_cmp_ne_u64 vcc, s[88:89], v[46:47]
  s_cbranch_vccnz va_iw4_no
  s_branch va_iw4_ok
va_iw4_no:
  s_sleep 2
  s_add_u32 s30, s30, 1
  s_cmp_lt_u32 s30, 50000
  s_cbranch_scc1 va_iw4
  s_branch cA_abort
va_iw4_ok:
  s_mov_b32 s30, 0
  v_mov_b32 v36, 0
ch_md4:
  buffer_load_dword v37, v36, s[12:15], 0 offen sc1
  s_waitcnt vmcnt(0)
  v_readfirstlane_b32 s22, v37
  s_and_b32 s31, s22, 0xffff
  s_cmp_ge_u32 s31, 32
  s_cbranch_scc1 ch_go4
  s_sleep 2
  s_add_u32 s30, s30, 1
  s_cmp_lt_u32 s30, 50000
  s_cbranch_scc1 ch_md4
  s_branch ch_end
ch_go4:
  s_mov_b32 s31, 0
  v_mov_b32 v36, 0
  v_mov_b32 v37, 0
  v_mov_b32 v38, 0
  v_mov_b32 v39, 0
  v_mov_b32 v40, 0
  v_mov_b32 v41, 0
  v_mov_b32 v42, 0
  v_mov_b32 v43, 0
  v_mov_b32 v44, 0
  v_mov_b32 v45, 0
  v_mov_b32 v46, 0
  v_mov_b32 v47, 0
  v_mov_b32 v48, 0
  v_mov_b32 v49, 0
  v_mov_b32 v50, 0
  v_mov_b32 v51, 0
  v_mov_b32 v52, 0
  v_mov_b32 v53, 0
  v_mov_b32 v54, 0
  v_mov_b32 v55, 0
  v_mov_b32 v56, 0
  v_mov_b32 v57, 0
  v_mov_b32 v58, 0
  v_mov_b32 v59, 0
  s_lshr_b32 s22, s22, 16
  s_cmp_lg_u32 s22, 0
  s_cbranch_scc1 cB_va0_loop
  s_branch cA_va0_loop
ch_init5:
  s_mul_i32 s31, s17, 401408
  s_add_u32 s31, s31, 6422528
  s_mul_i32 s22, s17, 28
  s_add_u32 s23, s22, 27
  s_lshr_b32 s22, s22, 6
  s_lshr_b32 s23, s23, 6
  s_sub_u32 s23, s23, s22
  s_lshl_b32 s23, s23, 8
  v_and_b32 v36, s23, v2
  v_med3_u32 v37, v117, 3, 6
  v_lshl_add_u32 v36, v37, 4, v36
  s_lshl_b32 s22, s22, 8
  s_add_u32 s22, s22, 88588288
  s_mov_b32 s30, 0
va_bw_13:
  buffer_load_dwordx4 v[40:43], v36, s[8:11], s22 offen sc1
  s_waitcnt vmcnt(0)
  v_cmp_ne_u64 vcc, s[88:89], v[40:41]
  s_cbranch_vccnz va_bw_13_no
  v_cmp_ne_u64 vcc, s[88:89], v[42:43]
  s_cbranch_vccnz va_bw_13_no
  s_branch va_bw_13_ok
va_bw_13_no:
  s_sleep 2
  s_add_u32 s30, s30, 1
  s_cmp_lt_u32 s30, 50000
  s_cbranch_scc1 va_bw_13
  s_branch cA_abort
va_bw_13_ok:
  s_add_u32 s22, s31, 86016
  buffer_load_dwordx4 a[0:3], v2, s[8:11], s22 offen offset:0 sc1
  buffer_load_dwordx4 a[4:7], v2, s[8:11], s22 offen offset:1024 sc1
  buffer_load_dwordx4 a[8:11], v2, s[8:11], s22 offen offset:2048 sc1
  buffer_load_dwordx4 a[12:15], v2, s[8:11], s22 offen offset:3072 sc1
  s_add_u32 s22, s31, 90112
  buffer_load_dwordx4 a[16:19], v2, s[8:11], s22 offen offset:0 sc1
  buffer_load_dwordx4 a[20:23], v2, s[8:11], s22 offen offset:1024 sc1
  buffer_load_dwordx4 a[24:27], v2, s[8:11], s22 offen offset:2048 sc1
  buffer_load_dwordx4 a[28:31], v2, s[8:11], s22 offen offset:3072 sc1
  s_add_u32 s22, s31, 94208
  buffer_load_dwordx4 a[32:35], v2, s[8:11], s22 offen offset:0 sc1
  buffer_load_dwordx4 a[36:39], v2, s[8:11], s22 offen offset:1024 sc1
  buffer_load_dwordx4 a[40:43], v2, s[8:11], s22 offen offset:2048 sc1
  buffer_load_dwordx4 a[44:47], v2, s[8:11], s22 offen offset:3072 sc1
  s_add_u32 s22, s31, 98304
  buffer_load_dwordx4 a[48:51], v2, s[8:11], s22 offen offset:0 sc1
  buffer_load_dwordx4 a[52:55], v2, s[8:11], s22 offen offset:1024 sc1
  buffer_load_dwordx4 a[56:59], v2, s[8:11], s22 offen offset:2048 sc1
  buffer_load_dwordx4 a[60:63], v2, s[8:11], s22 offen offset:3072 sc1
  s_add_u32 s22, s31, 102400
  buffer_load_dwordx4 a[64:67], v2, s[8:11], s22 offen offset:0 sc1
  buffer_load_dwordx4 a[68:71], v2, s[8:11], s22 offen offset:1024 sc1
  buffer_load_dwordx4 a[72:75], v2, s[8:11], s22 offen offset:2048 sc1
  buffer_load_dwordx4 a[76:79], v2, s[8:11], s22 offen offset:3072 sc1
  s_add_u32 s22, s31, 106496
  buffer_load_dwordx4 a[80:83], v2, s[8:11], s22 offen offset:0 sc1
  buffer_load_dwordx4 a[84:87], v2, s[8:11], s22 offen offset:1024 sc1
  buffer_load_dwordx4 a[88:91], v2, s[8:11], s22 offen offset:2048 sc1
  buffer_load_dwordx4 a[92:95], v2, s[8:11], s22 offen offset:3072 sc1
  s_add_u32 s22, s31, 110592
  buffer_load_dwordx4 a[96:99], v2, s[8:11], s22 offen offset:0 sc1
  buffer_load_dwordx4 a[100:103], v2, s[8:11], s22 offen offset:1024 sc1
  buffer_load_dwordx4 a[104:107], v2, s[8:11], s22 offen offset:2048 sc1
  buffer_load_dwordx4 a[108:111], v2, s[8:11], s22 offen offset:3072 sc1
  s_add_u32 s22, s31, 114688
  buffer_load_dwordx4 a[112:115], v2, s[8:11], s22 offen offset:0 sc1
  buffer_load_dwordx4 a[116:119], v2, s[8:11], s22 offen offset:1024 sc1
  buffer_load_dwordx4 a[120:123], v2, s[8:11], s22 offen offset:2048 sc1
  buffer_load_dwordx4 a[124:127], v2, s[8:11], s22 offen offset:3072 sc1
  s_waitcnt vmcnt(24)
  s_add_u32 s22, s31, 118784
  buffer_load_dwordx4 a[128:131], v2, s[8:11], s22 offen offset:0 sc1
  buffer_load_dwordx4 a[132:135], v2, s[8:11], s22 offen offset:1024 sc1
  buffer_load_dwordx4 a[136:139], v2, s[8:11], s22 offen offset:2048 sc1
  buffer_load_dwordx4 a[140:143], v2, s[8:11], s22 offen offset:3072 sc1
  s_add_u32 s22, s31, 122880
  buffer_load_dwordx4 a[144:147], v2, s[8:11], s22 offen offset:0 sc1
  buffer_load_dwordx4 a[148:151], v2, s[8:11], s22 offen offset:1024 sc1
  buffer_load_dwordx4 a[152:155], v2, s[8:11], s22 offen offset:2048 sc1
  buffer_load_dwordx4 a[156:159], v2, s[8:11], s22 offen offset:3072 sc1
  s_add_u32 s22, s31, 126976
  buffer_load_dwordx4 a[160:163], v2, s[8:11], s22 offen offset:0 sc1
  buffer_load_dwordx4 a[164:167], v2, s[8:11], s22 offen offset:1024 sc1
  buffer_load_dwordx4 a[168:171], v2, s[8:11], s22 offen offset:2048 sc1
  buffer_load_dwordx4 a[172:175], v2, s[8:11], s22 offen offset:3072 sc1
  s_add_u32 s22, s31, 131072
  buffer_load_dwordx4 a[176:179], v2, s[8:11], s22 offen offset:0 sc1
  buffer_load_dwordx4 a[180:183], v2, s[8:11], s22 offen offset:1024 sc1
  buffer_load_dwordx4 a[184:187], v2, s[8:11], s22 offen offset:2048 sc1
  buffer_load_dwordx4 a[188:191], v2, s[8:11], s22 offen offset:3072 sc1
  s_add_u32 s22, s31, 135168
  buffer_load_dwordx4 a[192:195], v2, s[8:11], s22 offen offset:0 sc1
  buffer_load_dwordx4 a[196:199], v2, s[8:11], s22 offen offset:1024 sc1
  buffer_load_dwordx4 a[200:203], v2, s[8:11], s22 offen offset:2048 sc1
  buffer_load_dwordx4 a[204:207], v2, s[8:11], s22 offen offset:3072 sc1
  s_add_u32 s22, s31, 139264
  buffer_load_dwordx4 a[208:211], v2, s[8:11], s22 offen offset:0 sc1
  buffer_load_dwordx4 a[212:215], v2, s[8:11], s22 offen offset:1024 sc1
  buffer_load_dwordx4 a[216:219], v2, s[8:11], s22 offen offset:2048 sc1
  buffer_load_dwordx4 a[220:223], v2, s[8:11], s22 offen offset:3072 sc1
  s_add_u32 s22, s31, 143360
  buffer_load_dwordx4 a[224:227], v2, s[8:11], s22 offen offset:0 sc1
  buffer_load_dwordx4 a[228:231], v2, s[8:11], s22 offen offset:1024 sc1
  buffer_load_dwordx4 a[232:235], v2, s[8:11], s22 offen offset:2048 sc1
  buffer_load_dwordx4 a[236:239], v2, s[8:11], s22 offen offset:3072 sc1
  s_add_u32 s22, s31, 147456
  buffer_load_dwordx4 a[240:243], v2, s[8:11], s22 offen offset:0 sc1
  buffer_load_dwordx4 a[244:247], v2, s[8:11], s22 offen offset:1024 sc1
  buffer_load_dwordx4 a[248:251], v2, s[8:11], s22 offen offset:2048 sc1
  buffer_load_dwordx4 a[252:255], v2, s[8:11], s22 offen offset:3072 sc1
  s_waitcnt vmcnt(24)
  s_add_u32 s22, s31, 151552
  buffer_load_dwordx4 v[176:179], v2, s[8:11], s22 offen offset:0 sc1
  buffer_load_dwordx4 v[180:183], v2, s[8:11], s22 offen offset:1024 sc1
  buffer_load_dwordx4 v[184:187], v2, s[8:11], s22 offen offset:2048 sc1
  buffer_load_dwordx4 v[188:191], v2, s[8:11], s22 offen offset:3072 sc1
  s_add_u32 s22, s31, 155648
  buffer_load_dwordx4 v[192:195], v2, s[8:11], s22 offen offset:0 sc1
  buffer_load_dwordx4 v[196:199], v2, s[8:11], s22 offen offset:1024 sc1
  buffer_load_dwordx4 v[200:203], v2, s[8:11], s22 offen offset:2048 sc1
  buffer_load_dwordx4 v[204:207], v2, s[8:11], s22 offen offset:3072 sc1
  s_add_u32 s22, s31, 159744
  buffer_load_dwordx4 v[208:211], v2, s[8:11], s22 offen offset:0 sc1
  buffer_load_dwordx4 v[212:215], v2, s[8:11], s22 offen offset:1024 sc1
  buffer_load_dwordx4 v[216:219], v2, s[8:11], s22 offen offset:2048 sc1
  buffer_load_dwordx4 v[220:223], v2, s[8:11], s22 offen offset:3072 sc1
  s_add_u32 s22, s31, 163840
  buffer_load_dwordx4 v[224:227], v2, s[8:11], s22 offen offset:0 sc1
  buffer_load_dwordx4 v[228:231], v2, s[8:11], s22 offen offset:1024 sc1
  buffer_load_dwordx4 v[232:235], v2, s[8:11], s22 offen offset:2048 sc1
  buffer_load_dwordx4 v[236:239], v2, s[8:11], s22 offen offset:3072 sc1
  s_add_u32 s22, s31, 167936
  buffer_load_dwordx4 v[240:243], v2, s[8:11], s22 offen offset:0 sc1
  buffer_load_dwordx4 v[244:247], v2, s[8:11], s22 offen offset:1024 sc1
  buffer_load_dwordx4 v[248:251], v2, s[8:11], s22 offen offset:2048 sc1
  buffer_load_dwordx4 v[252:255], v2, s[8:11], s22 offen offset:3072 sc1
  s_mul_i32 s22, s17, 28
  s_add_u32 s23, s22, 27
  s_lshr_b32 s22, s22, 6
  s_lshr_b32 s23, s23, 6
  s_sub_u32 s23, s23, s22
  s_lshl_b32 s23, s23, 8
  v_and_b32 v36, s23, v2
  v_med3_u32 v37, v117, 15, 15
  v_lshl_add_u32 v36, v37, 4, v36
  s_lshl_b32 s22, s22, 8
  s_add_u32 s22, s22, 88588288
  s_mov_b32 s30, 0
va_bw_14:
  buffer_load_dwordx4 v[40:43], v36, s[8:11], s22 offen sc1
  s_waitcnt vmcnt(0)
  v_cmp_ne_u64 vcc, s[88:89], v[40:41]
  s_cbranch_vccnz va_bw_14_no
  v_cmp_ne_u64 vcc, s[88:89], v[42:43]
  s_cbranch_vccnz va_bw_14_no
  s_branch va_bw_14_ok
va_bw_14_no:
  s_sleep 2
  s_add_u32 s30, s30, 1
  s_cmp_lt_u32 s30, 50000
  s_cbranch_scc1 va_bw_14
  s_branch cA_abort
va_bw_14_ok:
  s_mov_b32 m0, 59392
  s_add_u32 s22, s31, 387072
  buffer_load_dwordx4 v2, s[8:11], s22 offen offset:0 sc1 lds
  buffer_load_dwordx4 v2, s[8:11], s22 offen offset:1024 sc1 lds
  buffer_load_dwordx4 v2, s[8:11], s22 offen offset:2048 sc1 lds
  buffer_load_dwordx4 v2, s[8:11], s22 offen offset:3072 sc1 lds
  s_mov_b32 m0, 63488
  s_add_u32 s22, s31, 391168
  buffer_load_dwordx4 v2, s[8:11], s22 offen offset:0 sc1 lds
  buffer_load_dwordx4 v2, s[8:11], s22 offen offset:1024 sc1 lds
  buffer_load_dwordx4 v2, s[8:11], s22 offen offset:2048 sc1 lds
  buffer_load_dwordx4 v2, s[8:11], s22 offen offset:3072 sc1 lds
  s_mov_b32 m0, 67584
  s_add_u32 s22, s31, 395264
  buffer_load_dwordx4 v2, s[8:11], s22 offen offset:0 sc1 lds
  buffer_load_dwordx4 v2, s[8:11], s22 offen offset:1024 sc1 lds
  buffer_load_dwordx4 v2, s[8:11], s22 offen offset:2048 sc1 lds
  buffer_load_dwordx4 v2, s[8:11], s22 offen offset:3072 sc1 lds
  s_mov_b32 m0, 71680
  s_add_u32 s22, s31, 399360
  buffer_load_dwordx4 v2, s[8:11], s22 offen offset:0 sc1 lds
  buffer_load_dwordx4 v2, s[8:11], s22 offen offset:1024 sc1 lds
  v_mov_b32 v72, v116
  v_mov_b32 v73, v117
  v_lshrrev_b32 v65, 1, v72
  v_and_b32 v66, 1, v72
  v_add_u32 v67, 6, v65
  v_lshl_add_u32 v67, v67, 4, v73
  v_mul_u32_u24 v68, 2341, v67
  v_lshrrev_b32 v68, 16, v68
  v_mul_u32_u24 v69, 28, v68
  v_sub_u32 v69, v67, v69
  v_lshrrev_b32 v70, 4, v69
  v_and_b32 v69, 15, v69
  v_and_b32 v71, 1, v69
  v_lshrrev_b32 v69, 1, v69
  v_lshl_add_u32 v69, v71, 3, v69
  v_lshlrev_b32 v71, 12, v70
  v_lshrrev_b32 v70, 1, v68
  v_lshl_add_u32 v71, v70, 9, v71
  v_and_b32 v70, 1, v68
  v_lshl_add_u32 v71, v70, 2, v71
  v_lshl_add_u32 v71, v69, 4, v71
  v_lshl_add_u32 v60, v66, 8, v71
  v_add_u32 v67, 8, v65
  v_lshl_add_u32 v67, v67, 4, v73
  v_mul_u32_u24 v68, 2341, v67
  v_lshrrev_b32 v68, 16, v68
  v_mul_u32_u24 v69, 28, v68
  v_sub_u32 v69, v67, v69
  v_lshrrev_b32 v70, 4, v69
  v_and_b32 v69, 15, v69
  v_and_b32 v71, 1, v69
  v_lshrrev_b32 v69, 1, v69
  v_lshl_add_u32 v69, v71, 3, v69
  v_lshlrev_b32 v71, 12, v70
  v_lshrrev_b32 v70, 1, v68
  v_lshl_add_u32 v71, v70, 9, v71
  v_and_b32 v70, 1, v68
  v_lshl_add_u32 v71, v70, 2, v71
  v_lshl_add_u32 v71, v69, 4, v71
  v_lshl_add_u32 v61, v66, 8, v71
  v_add_u32 v67, 10, v65
  v_lshl_add_u32 v67, v67, 4, v73
  v_mul_u32_u24 v68, 2341, v67
  v_lshrrev_b32 v68, 16, v68
  v_mul_u32_u24 v69, 28, v68
  v_sub_u32 v69, v67, v69
  v_lshrrev_b32 v70, 4, v69
  v_and_b32 v69, 15, v69
  v_and_b32 v71, 1, v69
  v_lshrrev_b32 v69, 1, v69
  v_lshl_add_u32 v69, v71, 3, v69
  v_lshlrev_b32 v71, 12, v70
  v_lshrrev_b32 v70, 1, v68
  v_lshl_add_u32 v71, v70, 9, v71
  v_and_b32 v70, 1, v68
  v_lshl_add_u32 v71, v70, 2, v71
  v_lshl_add_u32 v71, v69, 4, v71
  v_lshl_add_u32 v62, v66, 8, v71
  v_and_b32 v0, 31, v1
  v_lshlrev_b32 v0, 2, v0
  v_add_u32 v0, 21504, v0
  v_lshlrev_b32 v4, 2, v73
  s_and_b32 s22, s17, 15
  s_lshl_b32 s22, s22, 7
  s_add_u32 s22, s22, 17408
  v_add_u32 v4, s22, v4
  v_and_b32 v64, 7, v73
  v_lshlrev_b32 v5, 4, v64
  v_lshl_add_u32 v5, v72, 7, v5
  v_lshrrev_b32 v65, 3, v73
  v_lshl_add_u32 v5, v65, 9, v5
  s_lshl_b32 s22, s17, 3
  s_add_u32 s22, s22, 21508
  v_lshl_add_u32 v7, v2, 3, s22
  v_add_u32 v65, 16, v73
  v_min_u32 v65, 27, v65
  v_mad_u32_u24 v65, v72, 28, v65
  v_lshlrev_b32 v6, 4, v65
  s_lshr_b32 s22, s17, 1
  s_mul_i32 s22, s22, 7
  s_and_b32 s34, s17, 1
  s_lshl_b32 s35, s34, 2
  v_add_u32 v70, s35, v72
  v_mov_b32 v71, s34
  v_mov_b32 v69, 1
  v_cmp_eq_u32 vcc, 3, v72
  s_nop 1
  v_cndmask_b32 v70, v70, v72, vcc
  v_cndmask_b32 v69, v69, v71, vcc
  v_add_u32 v70, s22, v70
  v_lshrrev_b32 v68, 1, v70
  v_lshlrev_b32 v68, 8, v68
  v_lshl_add_u32 v68, v69, 7, v68
  v_and_b32 v69, 1, v70
  v_lshl_add_u32 v68, v69, 3, v68
  v_lshl_add_u32 v1, v64, 4, v68
  v_cmp_gt_u32 s[26:27], 8, v73
  v_cmp_gt_u32 vcc, 3, v72
  s_and_b64 s[26:27], s[26:27], vcc
  v_lshrrev_b32 v65, 3, v73
  v_lshl_add_u32 v66, v64, 1, v65
  v_add_u32 v66, 16, v66
  v_min_u32 v66, 27, v66
  v_mad_u32_u24 v66, v72, 28, v66
  v_lshlrev_b32 v6, 4, v66
  s_mul_i32 s22, s17, 28
  s_add_u32 s22, s22, 16
  v_lshl_add_u32 v70, v64, 1, s22
  v_lshrrev_b32 v68, 4, v70
  v_lshlrev_b32 v68, 8, v68
  v_bfe_u32 v69, v70, 1, 1
  v_lshl_add_u32 v68, v69, 7, v68
  v_bfe_u32 v69, v70, 2, 2
  v_lshl_add_u32 v68, v69, 2, v68
  v_and_b32 v69, 1, v72
  v_lshl_add_u32 v65, v69, 2, v65
  v_lshrrev_b32 v69, 1, v72
  v_lshl_add_u32 v65, v69, 1, v65
  v_lshrrev_b32 v65, 3, v73
  v_lshl_add_u32 v65, v72, 1, v65
  v_lshrrev_b32 v5, 1, v72
  v_lshlrev_b32 v5, 9, v5
  v_lshrrev_b32 v69, 2, v73
  v_lshl_add_u32 v5, v69, 7, v5
  v_and_b32 v69, 1, v72
  v_lshl_add_u32 v5, v69, 6, v5
  v_and_b32 v69, 3, v73
  v_lshl_add_u32 v5, v69, 4, v5
  v_and_b32 v69, 1, v73
  v_mul_u32_u24 v69, 0xaaaa, v69
  v_add_u32 v0, 0x4444, v69
  v_lshl_add_u32 v1, v65, 4, v68
  v_cmp_gt_u32 s[26:27], 6, v64
  v_mov_b32 v156, 0
  v_mov_b32 v157, 0
  v_mov_b32 v158, 0
  v_mov_b32 v159, 0
  ds_write_b128 v2, v[156:159] offset:4096
  ds_write_b128 v2, v[156:159] offset:5120
  ds_write_b128 v2, v[156:159] offset:6144
  ds_write_b128 v2, v[156:159] offset:7168
  s_mul_i32 s22, s17, 1835008
  s_add_u32 s25, s22, 42205184
  s_lshl_b32 s35, s17, 7
  s_add_u32 s35, s35, 88526848
  s_mov_b32 s38, 0
  v_mov_b32 v175, 0
  s_lshl_b32 s22, 0, 11
  s_add_u32 s22, s22, 88590336
  v_add_u32 v36, 1024, v2
  v_min_u32 v36, 1776, v36
  s_mov_b32 s30, 0
va_iw5:
  buffer_load_dwordx4 v[40:43], v2, s[8:11], s22 offen sc1
  buffer_load_dwordx4 v[44:47], v36, s[8:11], s22 offen sc1
  s_waitcnt vmcnt(0)
  v_cmp_ne_u64 vcc, s[88:89], v[40:41]
  s_cbranch_vccnz va_iw5_no
  v_cmp_ne_u64 vcc, s[88:89], v[42:43]
  s_cbranch_vccnz va_iw5_no
  v_cmp_ne_u64 vcc, s[88:89], v[44:45]
  s_cbranch_vccnz va_iw5_no
  v_cmp_ne_u64 vcc, s[88:89], v[46:47]
  s_cbranch_vccnz va_iw5_no
  s_branch va_iw5_ok
va_iw5_no:
  s_sleep 2
  s_add_u32 s30, s30, 1
  s_cmp_lt_u32 s30, 50000
  s_cbranch_scc1 va_iw5
  s_branch cA_abort
va_iw5_ok:
  s_mov_b32 s30, 0
  v_mov_b32 v36, 0
ch_md5:
  buffer_load_dword v37, v36, s[12:15], 0 offen sc1
  s_waitcnt vmcnt(0)
  v_readfirstlane_b32 s22, v37
  s_and_b32 s31, s22, 0xffff
  s_cmp_ge_u32 s31, 32
  s_cbranch_scc1 ch_go5
  s_sleep 2
  s_add_u32 s30, s30, 1
  s_cmp_lt_u32 s30, 50000
  s_cbranch_scc1 ch_md5
  s_branch ch_end
ch_go5:
  s_mov_b32 s31, 0
  v_mov_b32 v36, 0
  v_mov_b32 v37, 0
  v_mov_b32 v38, 0
  v_mov_b32 v39, 0
  v_mov_b32 v40, 0
  v_mov_b32 v41, 0
  v_mov_b32 v42, 0
  v_mov_b32 v43, 0
  v_mov_b32 v44, 0
  v_mov_b32 v45, 0
  v_mov_b32 v46, 0
  v_mov_b32 v47, 0
  v_mov_b32 v48, 0
  v_mov_b32 v49, 0
  v_mov_b32 v50, 0
  v_mov_b32 v51, 0
  v_mov_b32 v52, 0
  v_mov_b32 v53, 0
  v_mov_b32 v54, 0
  v_mov_b32 v55, 0
  v_mov_b32 v56, 0
  v_mov_b32 v57, 0
  v_mov_b32 v58, 0
  v_mov_b32 v59, 0
  s_lshr_b32 s22, s22, 16
  s_cmp_lg_u32 s22, 0
  s_cbranch_scc1 cB_va1_loop
  s_branch cA_va1_loop
ch_init6:
  s_mul_i32 s31, s17, 401408
  s_add_u32 s31, s31, 6422528
  s_mul_i32 s22, s17, 28
  s_add_u32 s23, s22, 27
  s_lshr_b32 s22, s22, 6
  s_lshr_b32 s23, s23, 6
  s_sub_u32 s23, s23, s22
  s_lshl_b32 s23, s23, 8
  v_and_b32 v36, s23, v2
  v_med3_u32 v37, v117, 6, 10
  v_lshl_add_u32 v36, v37, 4, v36
  s_lshl_b32 s22, s22, 8
  s_add_u32 s22, s22, 88588288
  s_mov_b32 s30, 0
va_bw_15:
  buffer_load_dwordx4 v[40:43], v36, s[8:11], s22 offen sc1
  s_waitcnt vmcnt(0)
  v_cmp_ne_u64 vcc, s[88:89], v[40:41]
  s_cbranch_vccnz va_bw_15_no
  v_cmp_ne_u64 vcc, s[88:89], v[42:43]
  s_cbranch_vccnz va_bw_15_no
  s_branch va_bw_15_ok
va_bw_15_no:
  s_sleep 2
  s_add_u32 s30, s30, 1
  s_cmp_lt_u32 s30, 50000
  s_cbranch_scc1 va_bw_15
  s_branch cA_abort
va_bw_15_ok:
  s_add_u32 s22, s31, 172032
  buffer_load_dwordx4 a[0:3], v2, s[8:11], s22 offen offset:0 sc1
  buffer_load_dwordx4 a[4:7], v2, s[8:11], s22 offen offset:1024 sc1
  buffer_load_dwordx4 a[8:11], v2, s[8:11], s22 offen offset:2048 sc1
  buffer_load_dwordx4 a[12:15], v2, s[8:11], s22 offen offset:3072 sc1
  s_add_u32 s22, s31, 176128
  buffer_load_dwordx4 a[16:19], v2, s[8:11], s22 offen offset:0 sc1
  buffer_load_dwordx4 a[20:23], v2, s[8:11], s22 offen offset:1024 sc1
  buffer_load_dwordx4 a[24:27], v2, s[8:11], s22 offen offset:2048 sc1
  buffer_load_dwordx4 a[28:31], v2, s[8:11], s22 offen offset:3072 sc1
  s_add_u32 s22, s31, 180224
  buffer_load_dwordx4 a[32:35], v2, s[8:11], s22 offen offset:0 sc1
  buffer_load_dwordx4 a[36:39], v2, s[8:11], s22 offen offset:1024 sc1
  buffer_load_dwordx4 a[40:43], v2, s[8:11], s22 offen offset:2048 sc1
  buffer_load_dwordx4 a[44:47], v2, s[8:11], s22 offen offset:3072 sc1
  s_add_u32 s22, s31, 184320
  buffer_load_dwordx4 a[48:51], v2, s[8:11], s22 offen offset:0 sc1
  buffer_load_dwordx4 a[52:55], v2, s[8:11], s22 offen offset:1024 sc1
  buffer_load_dwordx4 a[56:59], v2, s[8:11], s22 offen offset:2048 sc1
  buffer_load_dwordx4 a[60:63], v2, s[8:11], s22 offen offset:3072 sc1
  s_add_u32 s22, s31, 188416
  buffer_load_dwordx4 a[64:67], v2, s[8:11], s22 offen offset:0 sc1
  buffer_load_dwordx4 a[68:71], v2, s[8:11], s22 offen offset:1024 sc1
  buffer_load_dwordx4 a[72:75], v2, s[8:11], s22 offen offset:2048 sc1
  buffer_load_dwordx4 a[76:79], v2, s[8:11], s22 offen offset:3072 sc1
  s_add_u32 s22, s31, 192512
  buffer_load_dwordx4 a[80:83], v2, s[8:11], s22 offen offset:0 sc1
  buffer_load_dwordx4 a[84:87], v2, s[8:11], s22 offen offset:1024 sc1
  buffer_load_dwordx4 a[88:91], v2, s[8:11], s22 offen offset:2048 sc1
  buffer_load_dwordx4 a[92:95], v2, s[8:11], s22 offen offset:3072 sc1
  s_add_u32 s22, s31, 196608
  buffer_load_dwordx4 a[96:99], v2, s[8:11], s22 offen offset:0 sc1
  buffer_load_dwordx4 a[100:103], v2, s[8:11], s22 offen offset:1024 sc1
  buffer_load_dwordx4 a[104:107], v2, s[8:11], s22 offen offset:2048 sc1
  buffer_load_dwordx4 a[108:111], v2, s[8:11], s22 offen offset:3072 sc1
  s_add_u32 s22, s31, 200704
  buffer_load_dwordx4 a[112:115], v2, s[8:11], s22 offen offset:0 sc1
  buffer_load_dwordx4 a[116:119], v2, s[8:11], s22 offen offset:1024 sc1
  buffer_load_dwordx4 a[120:123], v2, s[8:11], s22 offen offset:2048 sc1
  buffer_load_dwordx4 a[124:127], v2, s[8:11], s22 offen offset:3072 sc1
  s_waitcnt vmcnt(24)
  s_add_u32 s22, s31, 204800
  buffer_load_dwordx4 a[128:131], v2, s[8:11], s22 offen offset:0 sc1
  buffer_load_dwordx4 a[132:135], v2, s[8:11], s22 offen offset:1024 sc1
  buffer_load_dwordx4 a[136:139], v2, s[8:11], s22 offen offset:2048 sc1
  buffer_load_dwordx4 a[140:143], v2, s[8:11], s22 offen offset:3072 sc1
  s_add_u32 s22, s31, 208896
  buffer_load_dwordx4 a[144:147], v2, s[8:11], s22 offen offset:0 sc1
  buffer_load_dwordx4 a[148:151], v2, s[8:11], s22 offen offset:1024 sc1
  buffer_load_dwordx4 a[152:155], v2, s[8:11], s22 offen offset:2048 sc1
  buffer_load_dwordx4 a[156:159], v2, s[8:11], s22 offen offset:3072 sc1
  s_add_u32 s22, s31, 212992
  buffer_load_dwordx4 a[160:163], v2, s[8:11], s22 offen offset:0 sc1
  buffer_load_dwordx4 a[164:167], v2, s[8:11], s22 offen offset:1024 sc1
  buffer_load_dwordx4 a[168:171], v2, s[8:11], s22 offen offset:2048 sc1
  buffer_load_dwordx4 a[172:175], v2, s[8:11], s22 offen offset:3072 sc1
  s_add_u32 s22, s31, 217088
  buffer_load_dwordx4 a[176:179], v2, s[8:11], s22 offen offset:0 sc1
  buffer_load_dwordx4 a[180:183], v2, s[8:11], s22 offen offset:1024 sc1
  buffer_load_dwordx4 a[184:187], v2, s[8:11], s22 offen offset:2048 sc1
  buffer_load_dwordx4 a[188:191], v2, s[8:11], s22 offen offset:3072 sc1
  s_add_u32 s22, s31, 221184
  buffer_load_dwordx4 a[192:195], v2, s[8:11], s22 offen offset:0 sc1
  buffer_load_dwordx4 a[196:199], v2, s[8:11], s22 offen offset:1024 sc1
  buffer_load_dwordx4 a[200:203], v2, s[8:11], s22 offen offset:2048 sc1
  buffer_load_dwordx4 a[204:207], v2, s[8:11], s22 offen offset:3072 sc1
  s_add_u32 s22, s31, 225280
  buffer_load_dwordx4 a[208:211], v2, s[8:11], s22 offen offset:0 sc1
  buffer_load_dwordx4 a[212:215], v2, s[8:11], s22 offen offset:1024 sc1
  buffer_load_dwordx4 a[216:219], v2, s[8:11], s22 offen offset:2048 sc1
  buffer_load_dwordx4 a[220:223], v2, s[8:11], s22 offen offset:3072 sc1
  s_add_u32 s22, s31, 229376
  buffer_load_dwordx4 a[224:227], v2, s[8:11], s22 offen offset:0 sc1
  buffer_load_dwordx4 a[228:231], v2, s[8:11], s22 offen offset:1024 sc1
  buffer_load_dwordx4 a[232:235], v2, s[8:11], s22 offen offset:2048 sc1
  buffer_load_dwordx4 a[236:239], v2, s[8:11], s22 offen offset:3072 sc1
  s_add_u32 s22, s31, 233472
  buffer_load_dwordx4 a[240:243], v2, s[8:11], s22 offen offset:0 sc1
  buffer_load_dwordx4 a[244:247], v2, s[8:11], s22 offen offset:1024 sc1
  buffer_load_dwordx4 a[248:251], v2, s[8:11], s22 offen offset:2048 sc1
  buffer_load_dwordx4 a[252:255], v2, s[8:11], s22 offen offset:3072 sc1
  s_waitcnt vmcnt(24)
  s_add_u32 s22, s31, 237568
  buffer_load_dwordx4 v[120:123], v2, s[8:11], s22 offen offset:0 sc1
  buffer_load_dwordx4 v[124:127], v2, s[8:11], s22 offen offset:1024 sc1
  buffer_load_dwordx4 v[128:131], v2, s[8:11], s22 offen offset:2048 sc1
  buffer_load_dwordx4 v[132:135], v2, s[8:11], s22 offen offset:3072 sc1
  s_add_u32 s22, s31, 241664
  buffer_load_dwordx4 v[136:139], v2, s[8:11], s22 offen offset:0 sc1
  buffer_load_dwordx4 v[140:143], v2, s[8:11], s22 offen offset:1024 sc1
  buffer_load_dwordx4 v[144:147], v2, s[8:11], s22 offen offset:2048 sc1
  buffer_load_dwordx4 v[148:151], v2, s[8:11], s22 offen offset:3072 sc1
  s_add_u32 s22, s31, 245760
  buffer_load_dwordx4 v[152:155], v2, s[8:11], s22 offen offset:0 sc1
  buffer_load_dwordx4 v[156:159], v2, s[8:11], s22 offen offset:1024 sc1
  buffer_load_dwordx4 v[160:163], v2, s[8:11], s22 offen offset:2048 sc1
  buffer_load_dwordx4 v[164:167], v2, s[8:11], s22 offen offset:3072 sc1
  s_add_u32 s22, s31, 249856
  buffer_load_dwordx4 v[168:171], v2, s[8:11], s22 offen offset:0 sc1
  buffer_load_dwordx4 v[172:175], v2, s[8:11], s22 offen offset:1024 sc1
  buffer_load_dwordx4 v[176:179], v2, s[8:11], s22 offen offset:2048 sc1
  buffer_load_dwordx4 v[180:183], v2, s[8:11], s22 offen offset:3072 sc1
  s_add_u32 s22, s31, 253952
  buffer_load_dwordx4 v[184:187], v2, s[8:11], s22 offen offset:0 sc1
  buffer_load_dwordx4 v[188:191], v2, s[8:11], s22 offen offset:1024 sc1
  buffer_load_dwordx4 v[192:195], v2, s[8:11], s22 offen offset:2048 sc1
  buffer_load_dwordx4 v[196:199], v2, s[8:11], s22 offen offset:3072 sc1
  s_add_u32 s22, s31, 258048
  buffer_load_dwordx4 v[200:203], v2, s[8:11], s22 offen offset:0 sc1
  buffer_load_dwordx4 v[204:207], v2, s[8:11], s22 offen offset:1024 sc1
  buffer_load_dwordx4 v[208:211], v2, s[8:11], s22 offen offset:2048 sc1
  buffer_load_dwordx4 v[212:215], v2, s[8:11], s22 offen offset:3072 sc1
  s_add_u32 s22, s31, 262144
  buffer_load_dwordx4 v[216:219], v2, s[8:11], s22 offen offset:0 sc1
  buffer_load_dwordx4 v[220:223], v2, s[8:11], s22 offen offset:1024 sc1
  buffer_load_dwordx4 v[224:227], v2, s[8:11], s22 offen offset:2048 sc1
  buffer_load_dwordx4 v[228:231], v2, s[8:11], s22 offen offset:3072 sc1
  s_add_u32 s22, s31, 266240
  buffer_load_dwordx4 v[232:235], v2, s[8:11], s22 offen offset:0 sc1
  buffer_load_dwordx4 v[236:239], v2, s[8:11], s22 offen offset:1024 sc1
  buffer_load_dwordx4 v[240:243], v2, s[8:11], s22 offen offset:2048 sc1
  buffer_load_dwordx4 v[244:247], v2, s[8:11], s22 offen offset:3072 sc1
  s_waitcnt vmcnt(24)
  s_add_u32 s22, s31, 270336
  buffer_load_dwordx4 v[248:251], v2, s[8:11], s22 offen offset:0 sc1
  buffer_load_dwordx4 v[252:255], v2, s[8:11], s22 offen offset:1024 sc1
  v_mov_b32 v72, v116
  v_mov_b32 v73, v117
  v_lshrrev_b32 v65, 1, v72
  v_and_b32 v66, 1, v72
  v_add_u32 v67, 12, v65
  v_lshl_add_u32 v67, v67, 4, v73
  v_mul_u32_u24 v68, 2341, v67
  v_lshrrev_b32 v68, 16, v68
  v_mul_u32_u24 v69, 28, v68
  v_sub_u32 v69, v67, v69
  v_lshrrev_b32 v70, 4, v69
  v_and_b32 v69, 15, v69
  v_and_b32 v71, 1, v69
  v_lshrrev_b32 v69, 1, v69
  v_lshl_add_u32 v69, v71, 3, v69
  v_lshlrev_b32 v71, 12, v70
  v_lshrrev_b32 v70, 1, v68
  v_lshl_add_u32 v71, v70, 9, v71
  v_and_b32 v70, 1, v68
  v_lshl_add_u32 v71, v70, 2, v71
  v_lshl_add_u32 v71, v69, 4, v71
  v_lshl_add_u32 v112, v66, 8, v71
  v_add_u32 v67, 14, v65
  v_lshl_add_u32 v67, v67, 4, v73
  v_mul_u32_u24 v68, 2341, v67
  v_lshrrev_b32 v68, 16, v68
  v_mul_u32_u24 v69, 28, v68
  v_sub_u32 v69, v67, v69
  v_lshrrev_b32 v70, 4, v69
  v_and_b32 v69, 15, v69
  v_and_b32 v71, 1, v69
  v_lshrrev_b32 v69, 1, v69
  v_lshl_add_u32 v69, v71, 3, v69
  v_lshlrev_b32 v71, 12, v70
  v_lshrrev_b32 v70, 1, v68
  v_lshl_add_u32 v71, v70, 9, v71
  v_and_b32 v70, 1, v68
  v_lshl_add_u32 v71, v70, 2, v71
  v_lshl_add_u32 v71, v69, 4, v71
  v_lshl_add_u32 v113, v66, 8, v71
  v_add_u32 v67, 16, v65
  v_lshl_add_u32 v67, v67, 4, v73
  v_mul_u32_u24 v68, 2341, v67
  v_lshrrev_b32 v68, 16, v68
  v_mul_u32_u24 v69, 28, v68
  v_sub_u32 v69, v67, v69
  v_lshrrev_b32 v70, 4, v69
  v_and_b32 v69, 15, v69
  v_and_b32 v71, 1, v69
  v_lshrrev_b32 v69, 1, v69
  v_lshl_add_u32 v69, v71, 3, v69
  v_lshlrev_b32 v71, 12, v70
  v_lshrrev_b32 v70, 1, v68
  v_lshl_add_u32 v71, v70, 9, v71
  v_and_b32 v70, 1, v68
  v_lshl_add_u32 v71, v70, 2, v71
  v_lshl_add_u32 v71, v69, 4, v71
  v_lshl_add_u32 v114, v66, 8, v71
  v_add_u32 v67, 18, v65
  v_lshl_add_u32 v67, v67, 4, v73
  v_mul_u32_u24 v68, 2341, v67
  v_lshrrev_b32 v68, 16, v68
  v_mul_u32_u24 v69, 28, v68
  v_sub_u32 v69, v67, v69
  v_lshrrev_b32 v70, 4, v69
  v_and_b32 v69, 15, v69
  v_and_b32 v71, 1, v69
  v_lshrrev_b32 v69, 1, v69
  v_lshl_add_u32 v69, v71, 3, v69
  v_lshlrev_b32 v71, 12, v70
  v_lshrrev_b32 v70, 1, v68
  v_lshl_add_u32 v71, v70, 9, v71
  v_and_b32 v70, 1, v68
  v_lshl_add_u32 v71, v70, 2, v71
  v_lshl_add_u32 v71, v69, 4, v71
  v_lshl_add_u32 v115, v66, 8, v71
  s_mul_i32 s24, s17, 532480
  s_add_u32 s24, s24, 76926976
  s_mul_i32 s34, s17, 640
  s_add_u32 s34, s34, 88569856
  s_mul_i32 s36, s17, 448
  v_add_u32 v0, s36, v2
  v_add_u32 v0, 8192, v0
  s_add_u32 s36, s36, 88068096
  v_cmp_gt_u32 s[26:27], 28, v1
  v_and_b32 v119, 31, v1
  v_lshlrev_b32 v119, 2, v119
  s_add_u32 s22, s17, 16
  s_and_b32 s22, s22, 31
  s_lshl_b32 s22, s22, 7
  s_add_u32 s22, s22, 21504
  v_add_u32 v119, s22, v119
  v_min_u32 v118, 12, v1
  s_mul_i32 s22, s17, 13
  v_add_u32 v118, s22, v118
  v_lshlrev_b32 v118, 7, v118
  v_add_u32 v118, 51200, v118
  s_mov_b32 s39, 71565312
  v_add_u32 v1, 16384, v2
  v_mov_b32 v117, 1
  s_mul_i32 s38, s17, 1104
  s_add_u32 s38, s38, 25600
  s_lshl_b32 s22, 0, 11
  s_add_u32 s22, s22, 88590336
  v_add_u32 v36, 1024, v2
  v_min_u32 v36, 1776, v36
  s_mov_b32 s30, 0
va_iw6:
  buffer_load_dwordx4 v[40:43], v2, s[8:11], s22 offen sc1
  buffer_load_dwordx4 v[44:47], v36, s[8:11], s22 offen sc1
  s_waitcnt vmcnt(0)
  v_cmp_ne_u64 vcc, s[88:89], v[40:41]
  s_cbranch_vccnz va_iw6_no
  v_cmp_ne_u64 vcc, s[88:89], v[42:43]
  s_cbranch_vccnz va_iw6_no
  v_cmp_ne_u64 vcc, s[88:89], v[44:45]
  s_cbranch_vccnz va_iw6_no
  v_cmp_ne_u64 vcc, s[88:89], v[46:47]
  s_cbranch_vccnz va_iw6_no
  s_branch va_iw6_ok
va_iw6_no:
  s_sleep 2
  s_add_u32 s30, s30, 1
  s_cmp_lt_u32 s30, 50000
  s_cbranch_scc1 va_iw6
  s_branch cA_abort
va_iw6_ok:
  s_mov_b32 s30, 0
  v_mov_b32 v36, 0
ch_md6:
  buffer_load_dword v37, v36, s[12:15], 0 offen sc1
  s_waitcnt vmcnt(0)
  v_readfirstlane_b32 s22, v37
  s_and_b32 s31, s22, 0xffff
  s_cmp_ge_u32 s31, 32
  s_cbranch_scc1 ch_go6
  s_sleep 2
  s_add_u32 s30, s30, 1
  s_cmp_lt_u32 s30, 50000
  s_cbranch_scc1 ch_md6
  s_branch ch_end
ch_go6:
  s_mov_b32 s31, 0
  s_lshr_b32 s22, s22, 16
  s_cmp_lg_u32 s22, 0
  s_cbranch_scc1 cB_va2_loop
  s_branch cA_va2_loop
ch_init7:
  s_mul_i32 s31, s17, 401408
  s_add_u32 s31, s31, 6422528
  s_mul_i32 s22, s17, 28
  s_add_u32 s23, s22, 27
  s_lshr_b32 s22, s22, 6
  s_lshr_b32 s23, s23, 6
  s_sub_u32 s23, s23, s22
  s_lshl_b32 s23, s23, 8
  v_and_b32 v36, s23, v2
  v_med3_u32 v37, v117, 11, 15
  v_lshl_add_u32 v36, v37, 4, v36
  s_lshl_b32 s22, s22, 8
  s_add_u32 s22, s22, 88588288
  s_mov_b32 s30, 0
va_bw_16:
  buffer_load_dwordx4 v[40:43], v36, s[8:11], s22 offen sc1
  s_waitcnt vmcnt(0)
  v_cmp_ne_u64 vcc, s[88:89], v[40:41]
  s_cbranch_vccnz va_bw_16_no
  v_cmp_ne_u64 vcc, s[88:89], v[42:43]
  s_cbranch_vccnz va_bw_16_no
  s_branch va_bw_16_ok
va_bw_16_no:
  s_sleep 2
  s_add_u32 s30, s30, 1
  s_cmp_lt_u32 s30, 50000
  s_cbranch_scc1 va_bw_16
  s_branch cA_abort
va_bw_16_ok:
  s_add_u32 s22, s31, 286720
  buffer_load_dwordx4 a[0:3], v2, s[8:11], s22 offen offset:0 sc1
  buffer_load_dwordx4 a[4:7], v2, s[8:11], s22 offen offset:1024 sc1
  buffer_load_dwordx4 a[8:11], v2, s[8:11], s22 offen offset:2048 sc1
  buffer_load_dwordx4 a[12:15], v2, s[8:11], s22 offen offset:3072 sc1
  s_add_u32 s22, s31, 290816
  buffer_load_dwordx4 a[16:19], v2, s[8:11], s22 offen offset:0 sc1
  buffer_load_dwordx4 a[20:23], v2, s[8:11], s22 offen offset:1024 sc1
  buffer_load_dwordx4 a[24:27], v2, s[8:11], s22 offen offset:2048 sc1
  buffer_load_dwordx4 a[28:31], v2, s[8:11], s22 offen offset:3072 sc1
  s_add_u32 s22, s31, 294912
  buffer_load_dwordx4 a[32:35], v2, s[8:11], s22 offen offset:0 sc1
  buffer_load_dwordx4 a[36:39], v2, s[8:11], s22 offen offset:1024 sc1
  buffer_load_dwordx4 a[40:43], v2, s[8:11], s22 offen offset:2048 sc1
  buffer_load_dwordx4 a[44:47], v2, s[8:11], s22 offen offset:3072 sc1
  s_add_u32 s22, s31, 299008
  buffer_load_dwordx4 a[48:51], v2, s[8:11], s22 offen offset:0 sc1
  buffer_load_dwordx4 a[52:55], v2, s[8:11], s22 offen offset:1024 sc1
  buffer_load_dwordx4 a[56:59], v2, s[8:11], s22 offen offset:2048 sc1
  buffer_load_dwordx4 a[60:63], v2, s[8:11], s22 offen offset:3072 sc1
  s_add_u32 s22, s31, 303104
  buffer_load_dwordx4 a[64:67], v2, s[8:11], s22 offen offset:0 sc1
  buffer_load_dwordx4 a[68:71], v2, s[8:11], s22 offen offset:1024 sc1
  buffer_load_dwordx4 a[72:75], v2, s[8:11], s22 offen offset:2048 sc1
  buffer_load_dwordx4 a[76:79], v2, s[8:11], s22 offen offset:3072 sc1
  s_add_u32 s22, s31, 307200
  buffer_load_dwordx4 a[80:83], v2, s[8:11], s22 offen offset:0 sc1
  buffer_load_dwordx4 a[84:87], v2, s[8:11], s22 offen offset:1024 sc1
  buffer_load_dwordx4 a[88:91], v2, s[8:11], s22 offen offset:2048 sc1
  buffer_load_dwordx4 a[92:95], v2, s[8:11], s22 offen offset:3072 sc1
  s_add_u32 s22, s31, 311296
  buffer_load_dwordx4 a[96:99], v2, s[8:11], s22 offen offset:0 sc1
  buffer_load_dwordx4 a[100:103], v2, s[8:11], s22 offen offset:1024 sc1
  buffer_load_dwordx4 a[104:107], v2, s[8:11], s22 offen offset:2048 sc1
  buffer_load_dwordx4 a[108:111], v2, s[8:11], s22 offen offset:3072 sc1
  s_add_u32 s22, s31, 315392
  buffer_load_dwordx4 a[112:115], v2, s[8:11], s22 offen offset:0 sc1
  buffer_load_dwordx4 a[116:119], v2, s[8:11], s22 offen offset:1024 sc1
  buffer_load_dwordx4 a[120:123], v2, s[8:11], s22 offen offset:2048 sc1
  buffer_load_dwordx4 a[124:127], v2, s[8:11], s22 offen offset:3072 sc1
  s_waitcnt vmcnt(24)
  s_add_u32 s22, s31, 319488
  buffer_load_dwordx4 a[128:131], v2, s[8:11], s22 offen offset:0 sc1
  buffer_load_dwordx4 a[132:135], v2, s[8:11], s22 offen offset:1024 sc1
  buffer_load_dwordx4 a[136:139], v2, s[8:11], s22 offen offset:2048 sc1
  buffer_load_dwordx4 a[140:143], v2, s[8:11], s22 offen offset:3072 sc1
  s_add_u32 s22, s31, 323584
  buffer_load_dwordx4 a[144:147], v2, s[8:11], s22 offen offset:0 sc1
  buffer_load_dwordx4 a[148:151], v2, s[8:11], s22 offen offset:1024 sc1
  buffer_load_dwordx4 a[152:155], v2, s[8:11], s22 offen offset:2048 sc1
  buffer_load_dwordx4 a[156:159], v2, s[8:11], s22 offen offset:3072 sc1
  s_add_u32 s22, s31, 327680
  buffer_load_dwordx4 a[160:163], v2, s[8:11], s22 offen offset:0 sc1
  buffer_load_dwordx4 a[164:167], v2, s[8:11], s22 offen offset:1024 sc1
  buffer_load_dwordx4 a[168:171], v2, s[8:11], s22 offen offset:2048 sc1
  buffer_load_dwordx4 a[172:175], v2, s[8:11], s22 offen offset:3072 sc1
  s_add_u32 s22, s31, 331776
  buffer_load_dwordx4 a[176:179], v2, s[8:11], s22 offen offset:0 sc1
  buffer_load_dwordx4 a[180:183], v2, s[8:11], s22 offen offset:1024 sc1
  buffer_load_dwordx4 a[184:187], v2, s[8:11], s22 offen offset:2048 sc1
  buffer_load_dwordx4 a[188:191], v2, s[8:11], s22 offen offset:3072 sc1
  s_add_u32 s22, s31, 335872
  buffer_load_dwordx4 a[192:195], v2, s[8:11], s22 offen offset:0 sc1
  buffer_load_dwordx4 a[196:199], v2, s[8:11], s22 offen offset:1024 sc1
  buffer_load_dwordx4 a[200:203], v2, s[8:11], s22 offen offset:2048 sc1
  buffer_load_dwordx4 a[204:207], v2, s[8:11], s22 offen offset:3072 sc1
  s_add_u32 s22, s31, 339968
  buffer_load_dwordx4 a[208:211], v2, s[8:11], s22 offen offset:0 sc1
  buffer_load_dwordx4 a[212:215], v2, s[8:11], s22 offen offset:1024 sc1
  buffer_load_dwordx4 a[216:219], v2, s[8:11], s22 offen offset:2048 sc1
  buffer_load_dwordx4 a[220:223], v2, s[8:11], s22 offen offset:3072 sc1
  s_add_u32 s22, s31, 344064
  buffer_load_dwordx4 a[224:227], v2, s[8:11], s22 offen offset:0 sc1
  buffer_load_dwordx4 a[228:231], v2, s[8:11], s22 offen offset:1024 sc1
  buffer_load_dwordx4 a[232:235], v2, s[8:11], s22 offen offset:2048 sc1
  buffer_load_dwordx4 a[236:239], v2, s[8:11], s22 offen offset:3072 sc1
  s_add_u32 s22, s31, 348160
  buffer_load_dwordx4 a[240:243], v2, s[8:11], s22 offen offset:0 sc1
  buffer_load_dwordx4 a[244:247], v2, s[8:11], s22 offen offset:1024 sc1
  buffer_load_dwordx4 a[248:251], v2, s[8:11], s22 offen offset:2048 sc1
  buffer_load_dwordx4 a[252:255], v2, s[8:11], s22 offen offset:3072 sc1
  s_waitcnt vmcnt(24)
  s_add_u32 s22, s31, 352256
  buffer_load_dwordx4 v[120:123], v2, s[8:11], s22 offen offset:0 sc1
  buffer_load_dwordx4 v[124:127], v2, s[8:11], s22 offen offset:1024 sc1
  buffer_load_dwordx4 v[128:131], v2, s[8:11], s22 offen offset:2048 sc1
  buffer_load_dwordx4 v[132:135], v2, s[8:11], s22 offen offset:3072 sc1
  s_add_u32 s22, s31, 356352
  buffer_load_dwordx4 v[136:139], v2, s[8:11], s22 offen offset:0 sc1
  buffer_load_dwordx4 v[140:143], v2, s[8:11], s22 offen offset:1024 sc1
  buffer_load_dwordx4 v[144:147], v2, s[8:11], s22 offen offset:2048 sc1
  buffer_load_dwordx4 v[148:151], v2, s[8:11], s22 offen offset:3072 sc1
  s_add_u32 s22, s31, 360448
  buffer_load_dwordx4 v[152:155], v2, s[8:11], s22 offen offset:0 sc1
  buffer_load_dwordx4 v[156:159], v2, s[8:11], s22 offen offset:1024 sc1
  buffer_load_dwordx4 v[160:163], v2, s[8:11], s22 offen offset:2048 sc1
  buffer_load_dwordx4 v[164:167], v2, s[8:11], s22 offen offset:3072 sc1
  s_add_u32 s22, s31, 364544
  buffer_load_dwordx4 v[168:171], v2, s[8:11], s22 offen offset:0 sc1
  buffer_load_dwordx4 v[172:175], v2, s[8:11], s22 offen offset:1024 sc1
  buffer_load_dwordx4 v[176:179], v2, s[8:11], s22 offen offset:2048 sc1
  buffer_load_dwordx4 v[180:183], v2, s[8:11], s22 offen offset:3072 sc1
  s_add_u32 s22, s31, 368640
  buffer_load_dwordx4 v[184:187], v2, s[8:11], s22 offen offset:0 sc1
  buffer_load_dwordx4 v[188:191], v2, s[8:11], s22 offen offset:1024 sc1
  buffer_load_dwordx4 v[192:195], v2, s[8:11], s22 offen offset:2048 sc1
  buffer_load_dwordx4 v[196:199], v2, s[8:11], s22 offen offset:3072 sc1
  s_add_u32 s22, s31, 372736
  buffer_load_dwordx4 v[200:203], v2, s[8:11], s22 offen offset:0 sc1
  buffer_load_dwordx4 v[204:207], v2, s[8:11], s22 offen offset:1024 sc1
  buffer_load_dwordx4 v[208:211], v2, s[8:11], s22 offen offset:2048 sc1
  buffer_load_dwordx4 v[212:215], v2, s[8:11], s22 offen offset:3072 sc1
  s_add_u32 s22, s31, 376832
  buffer_load_dwordx4 v[216:219], v2, s[8:11], s22 offen offset:0 sc1
  buffer_load_dwordx4 v[220:223], v2, s[8:11], s22 offen offset:1024 sc1
  buffer_load_dwordx4 v[224:227], v2, s[8:11], s22 offen offset:2048 sc1
  buffer_load_dwordx4 v[228:231], v2, s[8:11], s22 offen offset:3072 sc1
  s_add_u32 s22, s31, 380928
  buffer_load_dwordx4 v[232:235], v2, s[8:11], s22 offen offset:0 sc1
  buffer_load_dwordx4 v[236:239], v2, s[8:11], s22 offen offset:1024 sc1
  buffer_load_dwordx4 v[240:243], v2, s[8:11], s22 offen offset:2048 sc1
  buffer_load_dwordx4 v[244:247], v2, s[8:11], s22 offen offset:3072 sc1
  s_waitcnt vmcnt(24)
  s_add_u32 s22, s31, 385024
  buffer_load_dwordx4 v[248:251], v2, s[8:11], s22 offen offset:0 sc1
  buffer_load_dwordx4 v[252:255], v2, s[8:11], s22 offen offset:1024 sc1
  v_mov_b32 v72, v116
  v_mov_b32 v73, v117
  v_lshrrev_b32 v65, 1, v72
  v_and_b32 v66, 1, v72
  v_add_u32 v67, 20, v65
  v_lshl_add_u32 v67, v67, 4, v73
  v_mul_u32_u24 v68, 2341, v67
  v_lshrrev_b32 v68, 16, v68
  v_mul_u32_u24 v69, 28, v68
  v_sub_u32 v69, v67, v69
  v_lshrrev_b32 v70, 4, v69
  v_and_b32 v69, 15, v69
  v_and_b32 v71, 1, v69
  v_lshrrev_b32 v69, 1, v69
  v_lshl_add_u32 v69, v71, 3, v69
  v_lshlrev_b32 v71, 12, v70
  v_lshrrev_b32 v70, 1, v68
  v_lshl_add_u32 v71, v70, 9, v71
  v_and_b32 v70, 1, v68
  v_lshl_add_u32 v71, v70, 2, v71
  v_lshl_add_u32 v71, v69, 4, v71
  v_lshl_add_u32 v112, v66, 8, v71
  v_add_u32 v67, 22, v65
  v_lshl_add_u32 v67, v67, 4, v73
  v_mul_u32_u24 v68, 2341, v67
  v_lshrrev_b32 v68, 16, v68
  v_mul_u32_u24 v69, 28, v68
  v_sub_u32 v69, v67, v69
  v_lshrrev_b32 v70, 4, v69
  v_and_b32 v69, 15, v69
  v_and_b32 v71, 1, v69
  v_lshrrev_b32 v69, 1, v69
  v_lshl_add_u32 v69, v71, 3, v69
  v_lshlrev_b32 v71, 12, v70
  v_lshrrev_b32 v70, 1, v68
  v_lshl_add_u32 v71, v70, 9, v71
  v_and_b32 v70, 1, v68
  v_lshl_add_u32 v71, v70, 2, v71
  v_lshl_add_u32 v71, v69, 4, v71
  v_lshl_add_u32 v113, v66, 8, v71
  v_add_u32 v67, 24, v65
  v_lshl_add_u32 v67, v67, 4, v73
  v_mul_u32_u24 v68, 2341, v67
  v_lshrrev_b32 v68, 16, v68
  v_mul_u32_u24 v69, 28, v68
  v_sub_u32 v69, v67, v69
  v_lshrrev_b32 v70, 4, v69
  v_and_b32 v69, 15, v69
  v_and_b32 v71, 1, v69
  v_lshrrev_b32 v69, 1, v69
  v_lshl_add_u32 v69, v71, 3, v69
  v_lshlrev_b32 v71, 12, v70
  v_lshrrev_b32 v70, 1, v68
  v_lshl_add_u32 v71, v70, 9, v71
  v_and_b32 v70, 1, v68
  v_lshl_add_u32 v71, v70, 2, v71
  v_lshl_add_u32 v71, v69, 4, v71
  v_lshl_add_u32 v114, v66, 8, v71
  v_add_u32 v67, 26, v65
  v_lshl_add_u32 v67, v67, 4, v73
  v_mul_u32_u24 v68, 2341, v67
  v_lshrrev_b32 v68, 16, v68
  v_mul_u32_u24 v69, 28, v68
  v_sub_u32 v69, v67, v69
  v_lshrrev_b32 v70, 4, v69
  v_and_b32 v69, 15, v69
  v_and_b32 v71, 1, v69
  v_lshrrev_b32 v69, 1, v69
  v_lshl_add_u32 v69, v71, 3, v69
  v_lshlrev_b32 v71, 12, v70
  v_lshrrev_b32 v70, 1, v68
  v_lshl_add_u32 v71, v70, 9, v71
  v_and_b32 v70, 1, v68
  v_lshl_add_u32 v71, v70, 2, v71
  v_lshl_add_u32 v71, v69, 4, v71
  v_lshl_add_u32 v115, v66, 8, v71
  s_mul_i32 s24, s17, 532480
  s_add_u32 s24, s24, 76931072
  s_mul_i32 s34, s17, 640
  s_add_u32 s34, s34, 88569860
  s_mul_i32 s36, s17, 448
  v_add_u32 v0, s36, v2
  v_add_u32 v0, 8192, v0
  s_add_u32 s36, s36, 88068096
  v_cmp_gt_u32 s[26:27], 28, v1
  v_and_b32 v119, 31, v1
  v_lshlrev_b32 v119, 2, v119
  s_add_u32 s22, s17, 16
  s_and_b32 s22, s22, 31
  s_lshl_b32 s22, s22, 7
  s_add_u32 s22, s22, 21504
  v_add_u32 v119, s22, v119
  v_min_u32 v118, 13, v1
  s_mul_i32 s22, s17, 14
  v_add_u32 v118, s22, v118
  v_lshlrev_b32 v118, 7, v118
  v_add_u32 v118, 57344, v118
  s_mov_b32 s39, 71565312
  v_add_u32 v1, 59392, v2
  v_mov_b32 v117, 1
  s_mul_i32 s38, s17, 1104
  s_add_u32 s38, s38, 26624
  s_lshl_b32 s22, 0, 11
  s_add_u32 s22, s22, 88590336
  v_add_u32 v36, 1024, v2
  v_min_u32 v36, 1776, v36
  s_mov_b32 s30, 0
va_iw7:
  buffer_load_dwordx4 v[40:43], v2, s[8:11], s22 offen sc1
  buffer_load_dwordx4 v[44:47], v36, s[8:11], s22 offen sc1
  s_waitcnt vmcnt(0)
  v_cmp_ne_u64 vcc, s[88:89], v[40:41]
  s_cbranch_vccnz va_iw7_no
  v_cmp_ne_u64 vcc, s[88:89], v[42:43]
  s_cbranch_vccnz va_iw7_no
  v_cmp_ne_u64 vcc, s[88:89], v[44:45]
  s_cbranch_vccnz va_iw7_no
  v_cmp_ne_u64 vcc, s[88:89], v[46:47]
  s_cbranch_vccnz va_iw7_no
  s_branch va_iw7_ok
va_iw7_no:
  s_sleep 2
  s_add_u32 s30, s30, 1
  s_cmp_lt_u32 s30, 50000
  s_cbranch_scc1 va_iw7
  s_branch cA_abort
va_iw7_ok:
  s_mov_b32 s30, 0
  v_mov_b32 v36, 0
ch_md7:
  buffer_load_dword v37, v36, s[12:15], 0 offen sc1
  s_waitcnt vmcnt(0)
  v_readfirstlane_b32 s22, v37
  s_and_b32 s31, s22, 0xffff
  s_cmp_ge_u32 s31, 32
  s_cbranch_scc1 ch_go7
  s_sleep 2
  s_add_u32 s30, s30, 1
  s_cmp_lt_u32 s30, 50000
  s_cbranch_scc1 ch_md7
  s_branch ch_end
ch_go7:
  s_mov_b32 s31, 0
  s_lshr_b32 s22, s22, 16
  s_cmp_lg_u32 s22, 0
  s_cbranch_scc1 cB_va3_loop
  s_branch cA_va3_loop
.p2align 6

cA_sc0_loop:
  s_add_u32 s23, s20, 4096
  s_add_u32 s21, s20, 25600
  v_mov_b32 v48, 0
  v_mov_b32 v49, 0
  v_mov_b32 v50, 0
  v_mov_b32 v51, 0
  v_mov_b32 v52, 0
  v_mov_b32 v53, 0
  v_mov_b32 v54, 0
  v_mov_b32 v55, 0
  v_mov_b32 v56, 0
  v_mov_b32 v57, 0
  v_mov_b32 v58, 0
  v_mov_b32 v59, 0
  v_mov_b32 v60, 0
  v_mov_b32 v61, 0
  v_mov_b32 v62, 0
  v_mov_b32 v63, 0
  v_mov_b32 v88, 0
  v_mov_b32 v89, 0
  v_mov_b32 v90, 0
  v_mov_b32 v91, 0
  v_mov_b32 v92, 0
  v_mov_b32 v93, 0
  v_mov_b32 v94, 0
  v_mov_b32 v95, 0
  v_mov_b32 v66, 0
  v_mov_b32 v67, 0
  s_mov_b32 s30, 0
  s_mov_b32 s62, 0
  buffer_load_dword v68, v0, s[8:11], s20 offen sc1
  s_nop 7
  buffer_load_dword v69, v0, s[8:11], s20 offen sc1
  s_nop 7
  buffer_load_dword v70, v0, s[8:11], s20 offen sc1
  s_nop 7
  buffer_load_dword v71, v0, s[8:11], s20 offen sc1
  s_nop 7
  buffer_load_dword v72, v0, s[8:11], s20 offen sc1
cA_sc0_fp_l:
  s_waitcnt vmcnt(4)
  v_cmp_eq_u32 vcc, -1, v68
  s_cbranch_vccz cA_sc0_fp_d
  buffer_load_dword v68, v0, s[8:11], s20 offen sc1
  s_waitcnt vmcnt(4)
  v_cmp_eq_u32 vcc, -1, v69
  s_cbranch_vccz cA_sc0_fp_d
  buffer_load_dword v69, v0, s[8:11], s20 offen sc1
  s_waitcnt vmcnt(4)
  v_cmp_eq_u32 vcc, -1, v70
  s_cbranch_vccz cA_sc0_fp_d
  buffer_load_dword v70, v0, s[8:11], s20 offen sc1
  s_waitcnt vmcnt(4)
  v_cmp_eq_u32 vcc, -1, v71
  s_cbranch_vccz cA_sc0_fp_d
  buffer_load_dword v71, v0, s[8:11], s20 offen sc1
  s_waitcnt vmcnt(4)
  v_cmp_eq_u32 vcc, -1, v72
  s_cbranch_vccz cA_sc0_fp_d
  buffer_load_dword v72, v0, s[8:11], s20 offen sc1
  s_add_u32 s30, s30, 1
  s_cmp_lt_u32 s30, 400000
  s_cbranch_scc1 cA_sc0_fp_l
  s_branch cA_abort
cA_sc0_fp_d:
  buffer_load_dwordx4 v[8:11], v2, s[8:11], s20 offen offset:0
  s_barrier
  s_branch cA_sc0_ld1
cA_sc0_ld:
  buffer_load_dwordx4 v[8:11], v2, s[8:11], s20 offen offset:0
cA_sc0_ld1:
  v_mov_b32 v36, 0
  v_mov_b32 v37, 0
  v_mov_b32 v38, 0
  v_mov_b32 v39, 0
  buffer_load_dwordx4 v[12:15], v2, s[8:11], s20 offen offset:1024
  v_mov_b32 v40, 0
  v_mov_b32 v41, 0
  v_mov_b32 v42, 0
  v_mov_b32 v43, 0
  buffer_load_dwordx4 v[16:19], v2, s[8:11], s20 offen offset:2048
  v_mov_b32 v44, 0
  v_mov_b32 v45, 0
  v_mov_b32 v46, 0
  v_mov_b32 v47, 0
  ds_read_b128 v[96:99], v117 offset:0
  ds_read_b128 v[100:103], v117 offset:1024
  ds_read_b128 v[104:107], v117 offset:14336
  ds_read_b128 v[108:111], v117 offset:15360
  s_waitcnt vmcnt(2)
  v_smfmac_f32_16x16x64_bf16 v[36:39], v[8:11], a[0:7], v3
  v_smfmac_f32_16x16x64_bf16 v[40:43], v[8:11], a[56:63], v3
  buffer_load_dwordx4 v[20:23], v2, s[8:11], s20 offen offset:3072
  v_smfmac_f32_16x16x64_bf16 v[44:47], v[8:11], a[112:119], v3
  v_smfmac_f32_16x16x64_bf16 v[48:51], v[8:11], a[168:175], v3
  v_smfmac_f32_16x16x64_bf16 v[52:55], v[8:11], a[224:231], v3
  buffer_load_dwordx4 v[24:27], v2, s[8:11], s23 offen offset:0
  v_smfmac_f32_16x16x64_bf16 v[56:59], v[8:11], v[144:151], v3
  v_smfmac_f32_16x16x64_bf16 v[60:63], v[8:11], v[200:207], v3
  s_waitcnt vmcnt(3)
  v_smfmac_f32_16x16x64_bf16 v[36:39], v[12:15], a[8:15], v3
  v_smfmac_f32_16x16x64_bf16 v[40:43], v[12:15], a[64:71], v3
  buffer_load_dwordx4 v[28:31], v2, s[8:11], s23 offen offset:1024
  v_smfmac_f32_16x16x64_bf16 v[44:47], v[12:15], a[120:127], v3
  v_smfmac_f32_16x16x64_bf16 v[48:51], v[12:15], a[176:183], v3
  v_smfmac_f32_16x16x64_bf16 v[52:55], v[12:15], a[232:239], v3
  buffer_load_dwordx4 v[32:35], v2, s[8:11], s23 offen offset:2048
  v_smfmac_f32_16x16x64_bf16 v[56:59], v[12:15], v[152:159], v3
  v_smfmac_f32_16x16x64_bf16 v[60:63], v[12:15], v[208:215], v3
  s_waitcnt vmcnt(4)
  v_smfmac_f32_16x16x64_bf16 v[36:39], v[16:19], a[16:23], v3
  v_smfmac_f32_16x16x64_bf16 v[40:43], v[16:19], a[72:79], v3
  v_smfmac_f32_16x16x64_bf16 v[44:47], v[16:19], a[128:135], v3
  v_smfmac_f32_16x16x64_bf16 v[48:51], v[16:19], a[184:191], v3
  v_smfmac_f32_16x16x64_bf16 v[52:55], v[16:19], a[240:247], v3
  v_smfmac_f32_16x16x64_bf16 v[56:59], v[16:19], v[160:167], v3
  v_smfmac_f32_16x16x64_bf16 v[60:63], v[16:19], v[216:223], v3
  s_waitcnt vmcnt(3)
  v_smfmac_f32_16x16x64_bf16 v[36:39], v[20:23], a[24:31], v3
  v_smfmac_f32_16x16x64_bf16 v[40:43], v[20:23], a[80:87], v3
  v_smfmac_f32_16x16x64_bf16 v[44:47], v[20:23], a[136:143], v3
  v_smfmac_f32_16x16x64_bf16 v[48:51], v[20:23], a[192:199], v3
  v_smfmac_f32_16x16x64_bf16 v[52:55], v[20:23], a[248:255], v3
  v_smfmac_f32_16x16x64_bf16 v[56:59], v[20:23], v[168:175], v3
  v_smfmac_f32_16x16x64_bf16 v[60:63], v[20:23], v[224:231], v3
  s_waitcnt vmcnt(0)
cA_sc0_ph2:
  v_smfmac_f32_16x16x64_bf16 v[60:63], v[24:27], v[232:239], v3
  ds_read_b128 v[12:15], v116 offset:0
  ds_read_b128 v[16:19], v116 offset:1024
  v_smfmac_f32_16x16x64_bf16 v[60:63], v[28:31], v[240:247], v3
  v_smfmac_f32_16x16x64_bf16 v[60:63], v[32:35], v[248:255], v3
  v_mov_b32 v80, v24
  v_smfmac_f32_16x16x64_bf16 v[52:55], v[24:27], v[120:127], v3
  v_mov_b32 v81, v25
  v_smfmac_f32_16x16x64_bf16 v[52:55], v[28:31], v[128:135], v3
  v_mov_b32 v82, v32
  v_smfmac_f32_16x16x64_bf16 v[52:55], v[32:35], v[136:143], v3
  v_cvt_pk_bf16_f32 v64, v60, v61
  v_smfmac_f32_16x16x64_bf16 v[56:59], v[24:27], v[176:183], v3
  v_cvt_pk_bf16_f32 v65, v62, v63
  v_smfmac_f32_16x16x64_bf16 v[56:59], v[28:31], v[184:191], v3
  v_mov_b32 v83, v33
  v_mfma_f32_16x16x32_bf16 v[68:71], v[64:67], v[4:7], 0
  v_smfmac_f32_16x16x64_bf16 v[56:59], v[32:35], v[192:199], v3
  v_cvt_pk_bf16_f32 v64, v52, v53
  v_smfmac_f32_16x16x64_bf16 v[36:39], v[24:27], a[32:39], v3
  v_cvt_pk_bf16_f32 v65, v54, v55
  v_smfmac_f32_16x16x64_bf16 v[36:39], v[28:31], a[40:47], v3
  v_cvt_pk_bf16_f32 v78, v68, v69
  v_smfmac_f32_16x16x64_bf16 v[36:39], v[32:35], a[48:55], v3
  v_cvt_pk_bf16_f32 v79, v70, v71
  v_cvt_pk_bf16_f32 v66, v56, v57
  v_smfmac_f32_16x16x64_bf16 v[40:43], v[24:27], a[88:95], v3
  v_cvt_pk_bf16_f32 v67, v58, v59
  v_smfmac_f32_16x16x64_bf16 v[40:43], v[28:31], a[96:103], v3
  v_mfma_f32_16x16x32_bf16 v[72:75], v[64:67], v[4:7], 0
  ds_read_b128 v[52:55], v116 offset:14336
  ds_read_b128 v[56:59], v116 offset:15360
  v_smfmac_f32_16x16x64_bf16 v[40:43], v[32:35], a[104:111], v3
  v_cvt_pk_bf16_f32 v64, v36, v37
  v_smfmac_f32_16x16x64_bf16 v[44:47], v[24:27], a[144:151], v3
  v_cvt_pk_bf16_f32 v65, v38, v39
  v_smfmac_f32_16x16x64_bf16 v[44:47], v[28:31], a[152:159], v3
  v_cvt_pk_bf16_f32 v76, v72, v73
  v_smfmac_f32_16x16x64_bf16 v[44:47], v[32:35], a[160:167], v3
  v_cvt_pk_bf16_f32 v77, v74, v75
  v_cvt_pk_bf16_f32 v66, v40, v41
  v_smfmac_f32_16x16x64_bf16 v[48:51], v[24:27], a[200:207], v3
  v_cvt_pk_bf16_f32 v67, v42, v43
  v_smfmac_f32_16x16x64_bf16 v[48:51], v[28:31], a[208:215], v3
  v_mfma_f32_16x16x32_bf16 v[68:71], v[64:67], v[4:7], 0
  v_smfmac_f32_16x16x64_bf16 v[48:51], v[32:35], a[216:223], v3
  v_cvt_pk_bf16_f32 v64, v44, v45
  v_mfma_f32_16x16x32_bf16 v[84:87], v[80:83], v[76:79], 0
  v_cvt_pk_bf16_f32 v65, v46, v47
  s_waitcnt lgkmcnt(0)
  v_smfmac_f32_16x16x64_bf16 v[88:91], v[76:79], v[96:103], v3
  v_cvt_pk_bf16_f32 v60, v68, v69
  v_cvt_pk_bf16_f32 v61, v70, v71
  v_cvt_pk_bf16_f32 v66, v48, v49
  v_cvt_pk_bf16_f32 v67, v50, v51
  s_nop 1
  v_mfma_f32_16x16x32_bf16 v[72:75], v[64:67], v[4:7], 0
  v_smfmac_f32_16x16x64_bf16 v[92:95], v[76:79], v[104:111], v3
  s_nop 4
  v_cvt_pk_bf16_f32 v62, v72, v73
  v_cvt_pk_bf16_f32 v63, v74, v75
  s_nop 1
  v_mfma_f32_16x16x32_bf16 v[84:87], v[8:11], v[60:63], v[84:87]
  v_smfmac_f32_16x16x64_bf16 v[88:91], v[60:63], v[12:19], v3
  v_smfmac_f32_16x16x64_bf16 v[92:95], v[60:63], v[52:59], v3
  s_nop 1
  v_permlane32_swap_b32 v84, v86
  v_permlane32_swap_b32 v85, v87
  s_nop 0
  v_cmp_u_f32 vcc, v88, v89
  v_add_f32_dpp v84, v86, v84 row_ror:8 row_mask:0xf bank_mask:0xf
  v_add_f32_dpp v85, v87, v85 row_ror:8 row_mask:0xf bank_mask:0xf
  v_permlane32_swap_b32 v88, v92
  v_permlane32_swap_b32 v89, v93
  ds_write2_b32 v113, v84, v85 offset0:0 offset1:4
  v_permlane32_swap_b32 v90, v94
  v_permlane32_swap_b32 v91, v95
  v_add_f32 v88, v88, v92
  v_add_f32 v89, v89, v93
  v_add_f32 v90, v90, v94
  v_add_f32 v91, v91, v95
  ds_write2_b64 v112, v[88:89], v[90:91] offset0:0 offset1:128
  s_cbranch_vccnz cA_sc0_retry
cA_sc0_cont:
  s_waitcnt lgkmcnt(0)
  s_barrier
  ds_read_b128 v[36:39], v114
  ds_read_b128 v[44:47], v115
  s_waitcnt lgkmcnt(0)
  v_add_f32 v36, v36, v38
  v_add_f32 v37, v37, v39
  v_add_f32 v44, v44, v45
  v_add_f32 v46, v46, v47
  v_permlane32_swap_b32 v36, v37
  v_add_f32 v44, v44, v46
  v_add_f32 v36, v36, v37
  v_exp_f32 v49, v44
  v_exp_f32 v48, v36
  v_add_f32 v50, abs(v36), abs(v44)
  v_fma_f32 v39, v49, s37, v48
  v_cmp_ngt_f32 vcc, s56, v50
  v_cndmask_b32 v41, v48, v49, s[38:39]
  v_add_f32_dpp v39, v39, v39 quad_perm:[1,0,3,2] row_mask:0xf bank_mask:0xf
  v_cndmask_b32 v40, v49, v48, s[38:39]
  v_mov_b32_dpp v46, v41 quad_perm:[1,0,3,2] row_mask:0xf bank_mask:0xf
  v_add_f32_dpp v39, v39, v39 quad_perm:[2,3,0,1] row_mask:0xf bank_mask:0xf
  v_cndmask_b32 v42, v46, v40, s[38:39]
  v_cndmask_b32 v43, v40, v46, s[38:39]
  v_add_f32_dpp v39, v39, v39 row_half_mirror row_mask:0xf bank_mask:0xf
  s_cbranch_vccnz cA_sc0_slow
  s_nop 0
  v_add_f32_dpp v47, v39, v39 row_mirror row_mask:0xf bank_mask:0xf
  v_add_f32_dpp v39, v39, v39 row_mirror row_mask:0xf bank_mask:0xf
  s_nop 1
  v_permlane16_swap_b32 v39, v47
  v_add_f32 v39, v39, v47
  v_rcp_f32 v39, v39
  s_mov_b64 exec, s[28:29]
  v_mul_f32 v42, v42, v39
  v_mul_f32 v43, v43, v39
  v_cvt_pk_bf16_f32 v42, v42, v43
cA_sc0_pst:
  buffer_store_dword v42, v1, s[8:11], s20 offen
  s_mov_b64 exec, -1
  s_barrier
  s_add_u32 s24, s24, 28672
  s_add_u32 s35, s35, 28672
  s_xor_b32 s25, s25, 28672
  s_add_u32 m0, s25, 0
  s_nop 0
  buffer_load_dwordx4 v2, s[8:11], s24 offen offset:0 sc1 lds
  buffer_load_dwordx4 v2, s[8:11], s24 offen offset:1024 sc1 lds
  buffer_load_dwordx4 v2, s[8:11], s24 offen offset:2048 sc1 lds
  buffer_load_dwordx4 v2, s[8:11], s24 offen offset:3072 sc1 lds
  s_add_u32 m0, s25, 4096
  s_add_u32 s22, s24, 4096
  buffer_load_dwordx4 v2, s[8:11], s22 offen offset:0 sc1 lds
  buffer_load_dwordx4 v2, s[8:11], s22 offen offset:1024 sc1 lds
  buffer_load_dwordx4 v2, s[8:11], s22 offen offset:2048 sc1 lds
  v_xor_b32 v116, 28672, v116
  v_add_u32 v117, s57, v117
  s_sub_u32 s57, 0, s57
  s_add_u32 s19, s19, 1
  s_mov_b32 s20, s21
  s_cmp_lt_u32 s19, 63
  s_cbranch_scc1 cA_sc0_loop
  s_branch cA_done
cA_sc0_slow:
  v_max_f32 v50, v36, v44
  s_nop 1
  v_max_f32_dpp v50, v50, v50 quad_perm:[1,0,3,2] row_mask:0xf bank_mask:0xf
  s_nop 1
  v_max_f32_dpp v50, v50, v50 quad_perm:[2,3,0,1] row_mask:0xf bank_mask:0xf
  s_nop 1
  v_max_f32_dpp v50, v50, v50 row_half_mirror row_mask:0xf bank_mask:0xf
  s_nop 1
  v_max_f32_dpp v50, v50, v50 row_mirror row_mask:0xf bank_mask:0xf
  v_mov_b32 v47, v50
  s_nop 1
  v_permlane16_swap_b32 v50, v47
  v_max_f32 v50, v50, v47
  v_sub_f32 v48, v36, v50
  v_sub_f32 v49, v44, v50
  v_exp_f32 v48, v48
  v_exp_f32 v49, v49
  s_add_u32 s31, s31, 0x100
  v_fma_f32 v39, v49, s37, v48
  v_cndmask_b32 v41, v48, v49, s[38:39]
  s_nop 0
  v_add_f32_dpp v39, v39, v39 quad_perm:[1,0,3,2] row_mask:0xf bank_mask:0xf
  v_cndmask_b32 v40, v49, v48, s[38:39]
  v_mov_b32_dpp v46, v41 quad_perm:[1,0,3,2] row_mask:0xf bank_mask:0xf
  v_add_f32_dpp v39, v39, v39 quad_perm:[2,3,0,1] row_mask:0xf bank_mask:0xf
  v_cndmask_b32 v42, v46, v40, s[38:39]
  v_cndmask_b32 v43, v40, v46, s[38:39]
  v_add_f32_dpp v39, v39, v39 row_half_mirror row_mask:0xf bank_mask:0xf
  s_nop 1
  v_add_f32_dpp v47, v39, v39 row_mirror row_mask:0xf bank_mask:0xf
  v_add_f32_dpp v39, v39, v39 row_mirror row_mask:0xf bank_mask:0xf
  s_nop 1
  v_permlane16_swap_b32 v39, v47
  v_add_f32 v39, v39, v47
  v_rcp_f32 v39, v39
  s_mov_b64 exec, s[28:29]
  v_mul_f32 v42, v42, v39
  v_mul_f32 v43, v43, v39
  v_cvt_pk_bf16_f32 v42, v42, v43
  v_min_u32 v42, -2, v42
  s_branch cA_sc0_pst
cA_sc0_retry:
  s_cmp_lg_u32 s62, 0
  s_cbranch_scc1 cA_sc0_cont
  s_waitcnt vmcnt(0) lgkmcnt(0)
cA_sc0_rv:
  buffer_load_dwordx4 v[8:11], v2, s[8:11], s20 offen offset:0 sc1
  buffer_load_dwordx4 v[12:15], v2, s[8:11], s20 offen offset:1024 sc1
  buffer_load_dwordx4 v[16:19], v2, s[8:11], s20 offen offset:2048 sc1
  buffer_load_dwordx4 v[20:23], v2, s[8:11], s20 offen offset:3072 sc1
  buffer_load_dwordx4 v[24:27], v2, s[8:11], s23 offen offset:0 sc1
  buffer_load_dwordx4 v[28:31], v2, s[8:11], s23 offen offset:1024 sc1
  buffer_load_dwordx4 v[32:35], v2, s[8:11], s23 offen offset:2048 sc1
  s_waitcnt vmcnt(0)
  v_max3_u32 v118, v8, v9, v10
  v_max3_u32 v118, v118, v11, v12
  v_max3_u32 v118, v118, v13, v14
  v_max3_u32 v118, v118, v15, v16
  v_max3_u32 v118, v118, v17, v18
  v_max3_u32 v118, v118, v19, v20
  v_max3_u32 v118, v118, v21, v22
  v_max3_u32 v118, v118, v23, v24
  v_max3_u32 v118, v118, v25, v26
  v_max3_u32 v118, v118, v27, v28
  v_max3_u32 v118, v118, v29, v30
  v_max3_u32 v118, v118, v31, v32
  v_max3_u32 v118, v118, v33, v34
  v_max_u32 v118, v118, v35
  v_cmp_eq_u32 vcc, -1, v118
  s_cbranch_vccz cA_sc0_rk
  s_add_u32 s30, s30, 1
  s_cmp_lt_u32 s30, 400000
  s_cbranch_scc1 cA_sc0_rv
  s_branch cA_abort
cA_sc0_rk:
  s_mov_b32 s62, 1
  v_mov_b32 v36, 0
  v_mov_b32 v37, 0
  v_mov_b32 v38, 0
  v_mov_b32 v39, 0
  v_mov_b32 v40, 0
  v_mov_b32 v41, 0
  v_mov_b32 v42, 0
  v_mov_b32 v43, 0
  v_mov_b32 v44, 0
  v_mov_b32 v45, 0
  v_mov_b32 v46, 0
  v_mov_b32 v47, 0
  v_mov_b32 v48, 0
  v_mov_b32 v49, 0
  v_mov_b32 v50, 0
  v_mov_b32 v51, 0
  v_mov_b32 v52, 0
  v_mov_b32 v53, 0
  v_mov_b32 v54, 0
  v_mov_b32 v55, 0
  v_mov_b32 v56, 0
  v_mov_b32 v57, 0
  v_mov_b32 v58, 0
  v_mov_b32 v59, 0
  v_mov_b32 v60, 0
  v_mov_b32 v61, 0
  v_mov_b32 v62, 0
  v_mov_b32 v63, 0
  v_mov_b32 v88, 0
  v_mov_b32 v89, 0
  v_mov_b32 v90, 0
  v_mov_b32 v91, 0
  v_mov_b32 v92, 0
  v_mov_b32 v93, 0
  v_mov_b32 v94, 0
  v_mov_b32 v95, 0
  v_mov_b32 v66, 0
  v_mov_b32 v67, 0
  s_add_u32 s31, s31, 1
  ds_read_b128 v[96:99], v117 offset:0
  ds_read_b128 v[100:103], v117 offset:1024
  ds_read_b128 v[104:107], v117 offset:14336
  ds_read_b128 v[108:111], v117 offset:15360
  v_smfmac_f32_16x16x64_bf16 v[36:39], v[8:11], a[0:7], v3
  v_smfmac_f32_16x16x64_bf16 v[40:43], v[8:11], a[56:63], v3
  v_smfmac_f32_16x16x64_bf16 v[44:47], v[8:11], a[112:119], v3
  v_smfmac_f32_16x16x64_bf16 v[48:51], v[8:11], a[168:175], v3
  v_smfmac_f32_16x16x64_bf16 v[52:55], v[8:11], a[224:231], v3
  v_smfmac_f32_16x16x64_bf16 v[56:59], v[8:11], v[144:151], v3
  v_smfmac_f32_16x16x64_bf16 v[60:63], v[8:11], v[200:207], v3
  v_smfmac_f32_16x16x64_bf16 v[36:39], v[12:15], a[8:15], v3
  v_smfmac_f32_16x16x64_bf16 v[40:43], v[12:15], a[64:71], v3
  v_smfmac_f32_16x16x64_bf16 v[44:47], v[12:15], a[120:127], v3
  v_smfmac_f32_16x16x64_bf16 v[48:51], v[12:15], a[176:183], v3
  v_smfmac_f32_16x16x64_bf16 v[52:55], v[12:15], a[232:239], v3
  v_smfmac_f32_16x16x64_bf16 v[56:59], v[12:15], v[152:159], v3
  v_smfmac_f32_16x16x64_bf16 v[60:63], v[12:15], v[208:215], v3
  v_smfmac_f32_16x16x64_bf16 v[36:39], v[16:19], a[16:23], v3
  v_smfmac_f32_16x16x64_bf16 v[40:43], v[16:19], a[72:79], v3
  v_smfmac_f32_16x16x64_bf16 v[44:47], v[16:19], a[128:135], v3
  v_smfmac_f32_16x16x64_bf16 v[48:51], v[16:19], a[184:191], v3
  v_smfmac_f32_16x16x64_bf16 v[52:55], v[16:19], a[240:247], v3
  v_smfmac_f32_16x16x64_bf16 v[56:59], v[16:19], v[160:167], v3
  v_smfmac_f32_16x16x64_bf16 v[60:63], v[16:19], v[216:223], v3
  v_smfmac_f32_16x16x64_bf16 v[36:39], v[20:23], a[24:31], v3
  v_smfmac_f32_16x16x64_bf16 v[40:43], v[20:23], a[80:87], v3
  v_smfmac_f32_16x16x64_bf16 v[44:47], v[20:23], a[136:143], v3
  v_smfmac_f32_16x16x64_bf16 v[48:51], v[20:23], a[192:199], v3
  v_smfmac_f32_16x16x64_bf16 v[52:55], v[20:23], a[248:255], v3
  v_smfmac_f32_16x16x64_bf16 v[56:59], v[20:23], v[168:175], v3
  v_smfmac_f32_16x16x64_bf16 v[60:63], v[20:23], v[224:231], v3
  s_branch cA_sc0_ph2
.p2align 6

cA_sc1_loop:
  s_add_u32 s23, s20, 4096
  s_add_u32 s21, s20, 25600
  v_mov_b32 v48, 0
  v_mov_b32 v49, 0
  v_mov_b32 v50, 0
  v_mov_b32 v51, 0
  v_mov_b32 v52, 0
  v_mov_b32 v53, 0
  v_mov_b32 v54, 0
  v_mov_b32 v55, 0
  v_mov_b32 v56, 0
  v_mov_b32 v57, 0
  v_mov_b32 v58, 0
  v_mov_b32 v59, 0
  v_mov_b32 v60, 0
  v_mov_b32 v61, 0
  v_mov_b32 v62, 0
  v_mov_b32 v63, 0
  v_mov_b32 v88, 0
  v_mov_b32 v89, 0
  v_mov_b32 v90, 0
  v_mov_b32 v91, 0
  v_mov_b32 v92, 0
  v_mov_b32 v93, 0
  v_mov_b32 v94, 0
  v_mov_b32 v95, 0
  v_mov_b32 v64, 0
  v_mov_b32 v65, 0
  s_mov_b32 s30, 0
  s_mov_b32 s62, 0
  s_waitcnt vmcnt(0)
  s_barrier
cA_sc1_ld:
  buffer_load_dwordx4 v[8:11], v2, s[8:11], s20 offen offset:0
  v_mov_b32 v36, 0
  v_mov_b32 v37, 0
  v_mov_b32 v38, 0
  v_mov_b32 v39, 0
  buffer_load_dwordx4 v[12:15], v2, s[8:11], s20 offen offset:1024
  v_mov_b32 v40, 0
  v_mov_b32 v41, 0
  v_mov_b32 v42, 0
  v_mov_b32 v43, 0
  buffer_load_dwordx4 v[16:19], v2, s[8:11], s20 offen offset:2048
  v_mov_b32 v44, 0
  v_mov_b32 v45, 0
  v_mov_b32 v46, 0
  v_mov_b32 v47, 0
  ds_read_b128 v[96:99], v117 offset:0
  ds_read_b128 v[100:103], v117 offset:1024
  ds_read_b128 v[104:107], v117 offset:14336
  ds_read_b128 v[108:111], v117 offset:15360
  s_waitcnt vmcnt(2)
  v_smfmac_f32_16x16x64_bf16 v[36:39], v[8:11], a[0:7], v3
  v_smfmac_f32_16x16x64_bf16 v[40:43], v[8:11], a[56:63], v3
  buffer_load_dwordx4 v[20:23], v2, s[8:11], s20 offen offset:3072
  v_smfmac_f32_16x16x64_bf16 v[44:47], v[8:11], a[112:119], v3
  v_smfmac_f32_16x16x64_bf16 v[48:51], v[8:11], a[168:175], v3
  v_smfmac_f32_16x16x64_bf16 v[52:55], v[8:11], a[224:231], v3
  buffer_load_dwordx4 v[24:27], v2, s[8:11], s23 offen offset:0
  v_smfmac_f32_16x16x64_bf16 v[56:59], v[8:11], v[144:151], v3
  v_smfmac_f32_16x16x64_bf16 v[60:63], v[8:11], v[200:207], v3
  s_waitcnt vmcnt(3)
  v_smfmac_f32_16x16x64_bf16 v[36:39], v[12:15], a[8:15], v3
  v_smfmac_f32_16x16x64_bf16 v[40:43], v[12:15], a[64:71], v3
  buffer_load_dwordx4 v[28:31], v2, s[8:11], s23 offen offset:1024
  v_smfmac_f32_16x16x64_bf16 v[44:47], v[12:15], a[120:127], v3
  v_smfmac_f32_16x16x64_bf16 v[48:51], v[12:15], a[176:183], v3
  v_smfmac_f32_16x16x64_bf16 v[52:55], v[12:15], a[232:239], v3
  buffer_load_dwordx4 v[32:35], v2, s[8:11], s23 offen offset:2048
  v_smfmac_f32_16x16x64_bf16 v[56:59], v[12:15], v[152:159], v3
  v_smfmac_f32_16x16x64_bf16 v[60:63], v[12:15], v[208:215], v3
  s_waitcnt vmcnt(4)
  v_smfmac_f32_16x16x64_bf16 v[36:39], v[16:19], a[16:23], v3
  v_smfmac_f32_16x16x64_bf16 v[40:43], v[16:19], a[72:79], v3
  v_smfmac_f32_16x16x64_bf16 v[44:47], v[16:19], a[128:135], v3
  v_smfmac_f32_16x16x64_bf16 v[48:51], v[16:19], a[184:191], v3
  v_smfmac_f32_16x16x64_bf16 v[52:55], v[16:19], a[240:247], v3
  v_smfmac_f32_16x16x64_bf16 v[56:59], v[16:19], v[160:167], v3
  v_smfmac_f32_16x16x64_bf16 v[60:63], v[16:19], v[216:223], v3
  s_waitcnt vmcnt(3)
  v_smfmac_f32_16x16x64_bf16 v[36:39], v[20:23], a[24:31], v3
  v_smfmac_f32_16x16x64_bf16 v[40:43], v[20:23], a[80:87], v3
  v_smfmac_f32_16x16x64_bf16 v[44:47], v[20:23], a[136:143], v3
  v_smfmac_f32_16x16x64_bf16 v[48:51], v[20:23], a[192:199], v3
  v_smfmac_f32_16x16x64_bf16 v[52:55], v[20:23], a[248:255], v3
  v_smfmac_f32_16x16x64_bf16 v[56:59], v[20:23], v[168:175], v3
  v_smfmac_f32_16x16x64_bf16 v[60:63], v[20:23], v[224:231], v3
  s_waitcnt vmcnt(0)
cA_sc1_ph2:
  v_smfmac_f32_16x16x64_bf16 v[60:63], v[24:27], v[232:239], v3
  ds_read_b128 v[16:19], v116 offset:2048
  ds_read_b128 v[20:23], v116 offset:3072
  v_smfmac_f32_16x16x64_bf16 v[60:63], v[28:31], v[240:247], v3
  buffer_load_dword v119, v0, s[8:11], s20 offen sc1
  v_smfmac_f32_16x16x64_bf16 v[60:63], v[32:35], v[248:255], v3
  v_mov_b32 v80, v26
  v_smfmac_f32_16x16x64_bf16 v[52:55], v[24:27], v[120:127], v3
  v_mov_b32 v81, v27
  v_smfmac_f32_16x16x64_bf16 v[52:55], v[28:31], v[128:135], v3
  v_mov_b32 v82, v32
  v_smfmac_f32_16x16x64_bf16 v[52:55], v[32:35], v[136:143], v3
  v_cvt_pk_bf16_f32 v66, v60, v61
  v_smfmac_f32_16x16x64_bf16 v[56:59], v[24:27], v[176:183], v3
  v_cvt_pk_bf16_f32 v67, v62, v63
  v_smfmac_f32_16x16x64_bf16 v[56:59], v[28:31], v[184:191], v3
  v_mov_b32 v83, v33
  v_mfma_f32_16x16x32_bf16 v[68:71], v[64:67], v[4:7], 0
  v_smfmac_f32_16x16x64_bf16 v[56:59], v[32:35], v[192:199], v3
  v_cvt_pk_bf16_f32 v64, v52, v53
  v_smfmac_f32_16x16x64_bf16 v[36:39], v[24:27], a[32:39], v3
  v_cvt_pk_bf16_f32 v65, v54, v55
  v_smfmac_f32_16x16x64_bf16 v[36:39], v[28:31], a[40:47], v3
  v_cvt_pk_bf16_f32 v78, v68, v69
  v_smfmac_f32_16x16x64_bf16 v[36:39], v[32:35], a[48:55], v3
  v_cvt_pk_bf16_f32 v79, v70, v71
  v_cvt_pk_bf16_f32 v66, v56, v57
  v_smfmac_f32_16x16x64_bf16 v[40:43], v[24:27], a[88:95], v3
  v_cvt_pk_bf16_f32 v67, v58, v59
  v_smfmac_f32_16x16x64_bf16 v[40:43], v[28:31], a[96:103], v3
  v_mfma_f32_16x16x32_bf16 v[72:75], v[64:67], v[4:7], 0
  ds_read_b128 v[52:55], v116 offset:16384
  ds_read_b128 v[56:59], v116 offset:17408
  v_smfmac_f32_16x16x64_bf16 v[40:43], v[32:35], a[104:111], v3
  v_cvt_pk_bf16_f32 v64, v36, v37
  v_smfmac_f32_16x16x64_bf16 v[44:47], v[24:27], a[144:151], v3
  v_cvt_pk_bf16_f32 v65, v38, v39
  v_smfmac_f32_16x16x64_bf16 v[44:47], v[28:31], a[152:159], v3
  v_cvt_pk_bf16_f32 v76, v72, v73
  v_smfmac_f32_16x16x64_bf16 v[44:47], v[32:35], a[160:167], v3
  v_cvt_pk_bf16_f32 v77, v74, v75
  v_cvt_pk_bf16_f32 v66, v40, v41
  v_smfmac_f32_16x16x64_bf16 v[48:51], v[24:27], a[200:207], v3
  v_cvt_pk_bf16_f32 v67, v42, v43
  v_smfmac_f32_16x16x64_bf16 v[48:51], v[28:31], a[208:215], v3
  v_mfma_f32_16x16x32_bf16 v[68:71], v[64:67], v[4:7], 0
  v_smfmac_f32_16x16x64_bf16 v[48:51], v[32:35], a[216:223], v3
  v_cvt_pk_bf16_f32 v64, v44, v45
  v_mfma_f32_16x16x32_bf16 v[84:87], v[80:83], v[76:79], 0
  v_cvt_pk_bf16_f32 v65, v46, v47
  s_waitcnt lgkmcnt(0)
  v_smfmac_f32_16x16x64_bf16 v[88:91], v[76:79], v[96:103], v3
  v_cvt_pk_bf16_f32 v60, v68, v69
  v_cvt_pk_bf16_f32 v61, v70, v71
  v_cvt_pk_bf16_f32 v66, v48, v49
  v_cvt_pk_bf16_f32 v67, v50, v51
  s_nop 1
  v_mfma_f32_16x16x32_bf16 v[72:75], v[64:67], v[4:7], 0
  v_smfmac_f32_16x16x64_bf16 v[92:95], v[76:79], v[104:111], v3
  s_nop 4
  v_cvt_pk_bf16_f32 v62, v72, v73
  v_cvt_pk_bf16_f32 v63, v74, v75
  s_nop 1
  v_mfma_f32_16x16x32_bf16 v[84:87], v[12:15], v[60:63], v[84:87]
  v_smfmac_f32_16x16x64_bf16 v[88:91], v[60:63], v[16:23], v3
  v_smfmac_f32_16x16x64_bf16 v[92:95], v[60:63], v[52:59], v3
  s_nop 1
  v_permlane32_swap_b32 v84, v86
  v_permlane32_swap_b32 v85, v87
  s_nop 0
  v_cmp_u_f32 vcc, v88, v89
  v_add_f32_dpp v84, v86, v84 row_ror:8 row_mask:0xf bank_mask:0xf
  v_add_f32_dpp v85, v87, v85 row_ror:8 row_mask:0xf bank_mask:0xf
  v_permlane32_swap_b32 v88, v92
  v_permlane32_swap_b32 v89, v93
  ds_write2_b32 v113, v84, v85 offset0:0 offset1:4
  v_permlane32_swap_b32 v90, v94
  v_permlane32_swap_b32 v91, v95
  v_add_f32 v88, v88, v92
  v_add_f32 v89, v89, v93
  v_add_f32 v90, v90, v94
  v_add_f32 v91, v91, v95
  ds_write2_b64 v112, v[88:89], v[90:91] offset0:0 offset1:128
  s_cbranch_vccnz cA_sc1_retry
cA_sc1_cont:
  s_waitcnt lgkmcnt(0)
  s_barrier
  ds_read_b128 v[36:39], v114
  ds_read_b128 v[44:47], v115
  s_waitcnt lgkmcnt(0)
  v_add_f32 v36, v36, v38
  v_add_f32 v37, v37, v39
  v_add_f32 v44, v44, v45
  v_add_f32 v46, v46, v47
  v_permlane32_swap_b32 v36, v37
  v_add_f32 v44, v44, v46
  v_add_f32 v36, v36, v37
  v_exp_f32 v49, v44
  v_exp_f32 v48, v36
  v_add_f32 v50, abs(v36), abs(v44)
  v_fma_f32 v39, v49, s37, v48
  v_cmp_ngt_f32 vcc, s56, v50
  v_cndmask_b32 v41, v48, v49, s[38:39]
  v_add_f32_dpp v39, v39, v39 quad_perm:[1,0,3,2] row_mask:0xf bank_mask:0xf
  v_cndmask_b32 v40, v49, v48, s[38:39]
  v_mov_b32_dpp v46, v41 quad_perm:[1,0,3,2] row_mask:0xf bank_mask:0xf
  v_add_f32_dpp v39, v39, v39 quad_perm:[2,3,0,1] row_mask:0xf bank_mask:0xf
  v_cndmask_b32 v42, v46, v40, s[38:39]
  v_cndmask_b32 v43, v40, v46, s[38:39]
  v_add_f32_dpp v39, v39, v39 row_half_mirror row_mask:0xf bank_mask:0xf
  s_cbranch_vccnz cA_sc1_slow
  s_nop 0
  v_add_f32_dpp v47, v39, v39 row_mirror row_mask:0xf bank_mask:0xf
  v_add_f32_dpp v39, v39, v39 row_mirror row_mask:0xf bank_mask:0xf
  s_nop 1
  v_permlane16_swap_b32 v39, v47
  v_add_f32 v39, v39, v47
  v_rcp_f32 v39, v39
  s_mov_b64 exec, s[28:29]
  v_mul_f32 v42, v42, v39
  v_mul_f32 v43, v43, v39
  v_cvt_pk_bf16_f32 v42, v42, v43
cA_sc1_pst:
  buffer_store_dword v42, v1, s[8:11], s20 offen
  s_mov_b64 exec, -1
  s_barrier
  s_add_u32 s24, s24, 28672
  s_add_u32 s35, s35, 28672
  s_xor_b32 s25, s25, 28672
  s_add_u32 m0, s25, 7168
  s_nop 0
  buffer_load_dwordx4 v2, s[8:11], s24 offen offset:0 sc1 lds
  buffer_load_dwordx4 v2, s[8:11], s24 offen offset:1024 sc1 lds
  buffer_load_dwordx4 v2, s[8:11], s24 offen offset:2048 sc1 lds
  buffer_load_dwordx4 v2, s[8:11], s24 offen offset:3072 sc1 lds
  s_add_u32 m0, s25, 11264
  s_add_u32 s22, s24, 4096
  buffer_load_dwordx4 v2, s[8:11], s22 offen offset:0 sc1 lds
  buffer_load_dwordx4 v2, s[8:11], s22 offen offset:1024 sc1 lds
  buffer_load_dwordx4 v2, s[8:11], s22 offen offset:2048 sc1 lds
  v_xor_b32 v116, 28672, v116
  v_add_u32 v117, s57, v117
  s_sub_u32 s57, 0, s57
  s_add_u32 s19, s19, 1
  s_mov_b32 s20, s21
  s_cmp_lt_u32 s19, 63
  s_cbranch_scc1 cA_sc1_loop
  s_branch cA_done
cA_sc1_slow:
  v_max_f32 v50, v36, v44
  s_nop 1
  v_max_f32_dpp v50, v50, v50 quad_perm:[1,0,3,2] row_mask:0xf bank_mask:0xf
  s_nop 1
  v_max_f32_dpp v50, v50, v50 quad_perm:[2,3,0,1] row_mask:0xf bank_mask:0xf
  s_nop 1
  v_max_f32_dpp v50, v50, v50 row_half_mirror row_mask:0xf bank_mask:0xf
  s_nop 1
  v_max_f32_dpp v50, v50, v50 row_mirror row_mask:0xf bank_mask:0xf
  v_mov_b32 v47, v50
  s_nop 1
  v_permlane16_swap_b32 v50, v47
  v_max_f32 v50, v50, v47
  v_sub_f32 v48, v36, v50
  v_sub_f32 v49, v44, v50
  v_exp_f32 v48, v48
  v_exp_f32 v49, v49
  s_add_u32 s31, s31, 0x100
  v_fma_f32 v39, v49, s37, v48
  v_cndmask_b32 v41, v48, v49, s[38:39]
  s_nop 0
  v_add_f32_dpp v39, v39, v39 quad_perm:[1,0,3,2] row_mask:0xf bank_mask:0xf
  v_cndmask_b32 v40, v49, v48, s[38:39]
  v_mov_b32_dpp v46, v41 quad_perm:[1,0,3,2] row_mask:0xf bank_mask:0xf
  v_add_f32_dpp v39, v39, v39 quad_perm:[2,3,0,1] row_mask:0xf bank_mask:0xf
  v_cndmask_b32 v42, v46, v40, s[38:39]
  v_cndmask_b32 v43, v40, v46, s[38:39]
  v_add_f32_dpp v39, v39, v39 row_half_mirror row_mask:0xf bank_mask:0xf
  s_nop 1
  v_add_f32_dpp v47, v39, v39 row_mirror row_mask:0xf bank_mask:0xf
  v_add_f32_dpp v39, v39, v39 row_mirror row_mask:0xf bank_mask:0xf
  s_nop 1
  v_permlane16_swap_b32 v39, v47
  v_add_f32 v39, v39, v47
  v_rcp_f32 v39, v39
  s_mov_b64 exec, s[28:29]
  v_mul_f32 v42, v42, v39
  v_mul_f32 v43, v43, v39
  v_cvt_pk_bf16_f32 v42, v42, v43
  v_min_u32 v42, -2, v42
  s_branch cA_sc1_pst
cA_sc1_retry:
  s_cmp_lg_u32 s62, 0
  s_cbranch_scc1 cA_sc1_cont
  s_waitcnt vmcnt(0) lgkmcnt(0)
cA_sc1_rv:
  buffer_load_dwordx4 v[8:11], v2, s[8:11], s20 offen offset:0 sc1
  buffer_load_dwordx4 v[12:15], v2, s[8:11], s20 offen offset:1024 sc1
  buffer_load_dwordx4 v[16:19], v2, s[8:11], s20 offen offset:2048 sc1
  buffer_load_dwordx4 v[20:23], v2, s[8:11], s20 offen offset:3072 sc1
  buffer_load_dwordx4 v[24:27], v2, s[8:11], s23 offen offset:0 sc1
  buffer_load_dwordx4 v[28:31], v2, s[8:11], s23 offen offset:1024 sc1
  buffer_load_dwordx4 v[32:35], v2, s[8:11], s23 offen offset:2048 sc1
  s_waitcnt vmcnt(0)
  v_max3_u32 v118, v8, v9, v10
  v_max3_u32 v118, v118, v11, v12
  v_max3_u32 v118, v118, v13, v14
  v_max3_u32 v118, v118, v15, v16
  v_max3_u32 v118, v118, v17, v18
  v_max3_u32 v118, v118, v19, v20
  v_max3_u32 v118, v118, v21, v22
  v_max3_u32 v118, v118, v23, v24
  v_max3_u32 v118, v118, v25, v26
  v_max3_u32 v118, v118, v27, v28
  v_max3_u32 v118, v118, v29, v30
  v_max3_u32 v118, v118, v31, v32
  v_max3_u32 v118, v118, v33, v34
  v_max_u32 v118, v118, v35
  v_cmp_eq_u32 vcc, -1, v118
  s_cbranch_vccz cA_sc1_rk
  s_add_u32 s30, s30, 1
  s_cmp_lt_u32 s30, 400000
  s_cbranch_scc1 cA_sc1_rv
  s_branch cA_abort
cA_sc1_rk:
  s_mov_b32 s62, 1
  v_mov_b32 v36, 0
  v_mov_b32 v37, 0
  v_mov_b32 v38, 0
  v_mov_b32 v39, 0
  v_mov_b32 v40, 0
  v_mov_b32 v41, 0
  v_mov_b32 v42, 0
  v_mov_b32 v43, 0
  v_mov_b32 v44, 0
  v_mov_b32 v45, 0
  v_mov_b32 v46, 0
  v_mov_b32 v47, 0
  v_mov_b32 v48, 0
  v_mov_b32 v49, 0
  v_mov_b32 v50, 0
  v_mov_b32 v51, 0
  v_mov_b32 v52, 0
  v_mov_b32 v53, 0
  v_mov_b32 v54, 0
  v_mov_b32 v55, 0
  v_mov_b32 v56, 0
  v_mov_b32 v57, 0
  v_mov_b32 v58, 0
  v_mov_b32 v59, 0
  v_mov_b32 v60, 0
  v_mov_b32 v61, 0
  v_mov_b32 v62, 0
  v_mov_b32 v63, 0
  v_mov_b32 v88, 0
  v_mov_b32 v89, 0
  v_mov_b32 v90, 0
  v_mov_b32 v91, 0
  v_mov_b32 v92, 0
  v_mov_b32 v93, 0
  v_mov_b32 v94, 0
  v_mov_b32 v95, 0
  v_mov_b32 v64, 0
  v_mov_b32 v65, 0
  s_add_u32 s31, s31, 1
  ds_read_b128 v[96:99], v117 offset:0
  ds_read_b128 v[100:103], v117 offset:1024
  ds_read_b128 v[104:107], v117 offset:14336
  ds_read_b128 v[108:111], v117 offset:15360
  v_smfmac_f32_16x16x64_bf16 v[36:39], v[8:11], a[0:7], v3
  v_smfmac_f32_16x16x64_bf16 v[40:43], v[8:11], a[56:63], v3
  v_smfmac_f32_16x16x64_bf16 v[44:47], v[8:11], a[112:119], v3
  v_smfmac_f32_16x16x64_bf16 v[48:51], v[8:11], a[168:175], v3
  v_smfmac_f32_16x16x64_bf16 v[52:55], v[8:11], a[224:231], v3
  v_smfmac_f32_16x16x64_bf16 v[56:59], v[8:11], v[144:151], v3
  v_smfmac_f32_16x16x64_bf16 v[60:63], v[8:11], v[200:207], v3
  v_smfmac_f32_16x16x64_bf16 v[36:39], v[12:15], a[8:15], v3
  v_smfmac_f32_16x16x64_bf16 v[40:43], v[12:15], a[64:71], v3
  v_smfmac_f32_16x16x64_bf16 v[44:47], v[12:15], a[120:127], v3
  v_smfmac_f32_16x16x64_bf16 v[48:51], v[12:15], a[176:183], v3
  v_smfmac_f32_16x16x64_bf16 v[52:55], v[12:15], a[232:239], v3
  v_smfmac_f32_16x16x64_bf16 v[56:59], v[12:15], v[152:159], v3
  v_smfmac_f32_16x16x64_bf16 v[60:63], v[12:15], v[208:215], v3
  v_smfmac_f32_16x16x64_bf16 v[36:39], v[16:19], a[16:23], v3
  v_smfmac_f32_16x16x64_bf16 v[40:43], v[16:19], a[72:79], v3
  v_smfmac_f32_16x16x64_bf16 v[44:47], v[16:19], a[128:135], v3
  v_smfmac_f32_16x16x64_bf16 v[48:51], v[16:19], a[184:191], v3
  v_smfmac_f32_16x16x64_bf16 v[52:55], v[16:19], a[240:247], v3
  v_smfmac_f32_16x16x64_bf16 v[56:59], v[16:19], v[160:167], v3
  v_smfmac_f32_16x16x64_bf16 v[60:63], v[16:19], v[216:223], v3
  v_smfmac_f32_16x16x64_bf16 v[36:39], v[20:23], a[24:31], v3
  v_smfmac_f32_16x16x64_bf16 v[40:43], v[20:23], a[80:87], v3
  v_smfmac_f32_16x16x64_bf16 v[44:47], v[20:23], a[136:143], v3
  v_smfmac_f32_16x16x64_bf16 v[48:51], v[20:23], a[192:199], v3
  v_smfmac_f32_16x16x64_bf16 v[52:55], v[20:23], a[248:255], v3
  v_smfmac_f32_16x16x64_bf16 v[56:59], v[20:23], v[168:175], v3
  v_smfmac_f32_16x16x64_bf16 v[60:63], v[20:23], v[224:231], v3
  s_branch cA_sc1_ph2
.p2align 6

cA_sc2_loop:
  s_add_u32 s23, s20, 4096
  s_add_u32 s21, s20, 25600
  v_mov_b32 v48, 0
  v_mov_b32 v49, 0
  v_mov_b32 v50, 0
  v_mov_b32 v51, 0
  v_mov_b32 v52, 0
  v_mov_b32 v53, 0
  v_mov_b32 v54, 0
  v_mov_b32 v55, 0
  v_mov_b32 v56, 0
  v_mov_b32 v57, 0
  v_mov_b32 v58, 0
  v_mov_b32 v59, 0
  v_mov_b32 v60, 0
  v_mov_b32 v61, 0
  v_mov_b32 v62, 0
  v_mov_b32 v63, 0
  v_mov_b32 v88, 0
  v_mov_b32 v89, 0
  v_mov_b32 v90, 0
  v_mov_b32 v91, 0
  v_mov_b32 v92, 0
  v_mov_b32 v93, 0
  v_mov_b32 v94, 0
  v_mov_b32 v95, 0
  v_mov_b32 v66, 0
  v_mov_b32 v67, 0
  s_mov_b32 s30, 0
  s_mov_b32 s62, 0
  s_waitcnt vmcnt(0)
  s_barrier
cA_sc2_ld:
  buffer_load_dwordx4 v[8:11], v2, s[8:11], s20 offen offset:0
  v_mov_b32 v36, 0
  v_mov_b32 v37, 0
  v_mov_b32 v38, 0
  v_mov_b32 v39, 0
  buffer_load_dwordx4 v[12:15], v2, s[8:11], s20 offen offset:1024
  v_mov_b32 v40, 0
  v_mov_b32 v41, 0
  v_mov_b32 v42, 0
  v_mov_b32 v43, 0
  buffer_load_dwordx4 v[16:19], v2, s[8:11], s20 offen offset:2048
  v_mov_b32 v44, 0
  v_mov_b32 v45, 0
  v_mov_b32 v46, 0
  v_mov_b32 v47, 0
  ds_read_b128 v[96:99], v117 offset:0
  ds_read_b128 v[100:103], v117 offset:1024
  ds_read_b128 v[104:107], v117 offset:14336
  ds_read_b128 v[108:111], v117 offset:15360
  s_waitcnt vmcnt(2)
  v_smfmac_f32_16x16x64_bf16 v[36:39], v[8:11], a[0:7], v3
  v_smfmac_f32_16x16x64_bf16 v[40:43], v[8:11], a[56:63], v3
  buffer_load_dwordx4 v[20:23], v2, s[8:11], s20 offen offset:3072
  v_smfmac_f32_16x16x64_bf16 v[44:47], v[8:11], a[112:119], v3
  v_smfmac_f32_16x16x64_bf16 v[48:51], v[8:11], a[168:175], v3
  v_smfmac_f32_16x16x64_bf16 v[52:55], v[8:11], a[224:231], v3
  buffer_load_dwordx4 v[24:27], v2, s[8:11], s23 offen offset:0
  v_smfmac_f32_16x16x64_bf16 v[56:59], v[8:11], v[144:151], v3
  v_smfmac_f32_16x16x64_bf16 v[60:63], v[8:11], v[200:207], v3
  s_waitcnt vmcnt(3)
  v_smfmac_f32_16x16x64_bf16 v[36:39], v[12:15], a[8:15], v3
  v_smfmac_f32_16x16x64_bf16 v[40:43], v[12:15], a[64:71], v3
  buffer_load_dwordx4 v[28:31], v2, s[8:11], s23 offen offset:1024
  v_smfmac_f32_16x16x64_bf16 v[44:47], v[12:15], a[120:127], v3
  v_smfmac_f32_16x16x64_bf16 v[48:51], v[12:15], a[176:183], v3
  v_smfmac_f32_16x16x64_bf16 v[52:55], v[12:15], a[232:239], v3
  buffer_load_dwordx4 v[32:35], v2, s[8:11], s23 offen offset:2048
  v_smfmac_f32_16x16x64_bf16 v[56:59], v[12:15], v[152:159], v3
  v_smfmac_f32_16x16x64_bf16 v[60:63], v[12:15], v[208:215], v3
  s_waitcnt vmcnt(4)
  v_smfmac_f32_16x16x64_bf16 v[36:39], v[16:19], a[16:23], v3
  v_smfmac_f32_16x16x64_bf16 v[40:43], v[16:19], a[72:79], v3
  v_smfmac_f32_16x16x64_bf16 v[44:47], v[16:19], a[128:135], v3
  v_smfmac_f32_16x16x64_bf16 v[48:51], v[16:19], a[184:191], v3
  v_smfmac_f32_16x16x64_bf16 v[52:55], v[16:19], a[240:247], v3
  v_smfmac_f32_16x16x64_bf16 v[56:59], v[16:19], v[160:167], v3
  v_smfmac_f32_16x16x64_bf16 v[60:63], v[16:19], v[216:223], v3
  s_waitcnt vmcnt(3)
  v_smfmac_f32_16x16x64_bf16 v[36:39], v[20:23], a[24:31], v3
  v_smfmac_f32_16x16x64_bf16 v[40:43], v[20:23], a[80:87], v3
  v_smfmac_f32_16x16x64_bf16 v[44:47], v[20:23], a[136:143], v3
  v_smfmac_f32_16x16x64_bf16 v[48:51], v[20:23], a[192:199], v3
  v_smfmac_f32_16x16x64_bf16 v[52:55], v[20:23], a[248:255], v3
  v_smfmac_f32_16x16x64_bf16 v[56:59], v[20:23], v[168:175], v3
  v_smfmac_f32_16x16x64_bf16 v[60:63], v[20:23], v[224:231], v3
  s_waitcnt vmcnt(0)
cA_sc2_ph2:
  v_smfmac_f32_16x16x64_bf16 v[60:63], v[24:27], v[232:239], v3
  ds_read_b128 v[8:11], v116 offset:4096
  ds_read_b128 v[12:15], v116 offset:5120
  v_smfmac_f32_16x16x64_bf16 v[60:63], v[28:31], v[240:247], v3
  buffer_load_dword v119, v0, s[8:11], s24 offen sc1
  v_smfmac_f32_16x16x64_bf16 v[60:63], v[32:35], v[248:255], v3
  v_mov_b32 v80, v28
  v_smfmac_f32_16x16x64_bf16 v[52:55], v[24:27], v[120:127], v3
  v_mov_b32 v81, v29
  v_smfmac_f32_16x16x64_bf16 v[52:55], v[28:31], v[128:135], v3
  v_mov_b32 v82, v34
  v_smfmac_f32_16x16x64_bf16 v[52:55], v[32:35], v[136:143], v3
  v_cvt_pk_bf16_f32 v64, v60, v61
  v_smfmac_f32_16x16x64_bf16 v[56:59], v[24:27], v[176:183], v3
  v_cvt_pk_bf16_f32 v65, v62, v63
  v_smfmac_f32_16x16x64_bf16 v[56:59], v[28:31], v[184:191], v3
  v_mov_b32 v83, v35
  v_mfma_f32_16x16x32_bf16 v[68:71], v[64:67], v[4:7], 0
  v_smfmac_f32_16x16x64_bf16 v[56:59], v[32:35], v[192:199], v3
  v_cvt_pk_bf16_f32 v64, v52, v53
  v_smfmac_f32_16x16x64_bf16 v[36:39], v[24:27], a[32:39], v3
  v_cvt_pk_bf16_f32 v65, v54, v55
  v_smfmac_f32_16x16x64_bf16 v[36:39], v[28:31], a[40:47], v3
  v_cvt_pk_bf16_f32 v78, v68, v69
  v_smfmac_f32_16x16x64_bf16 v[36:39], v[32:35], a[48:55], v3
  v_cvt_pk_bf16_f32 v79, v70, v71
  v_cvt_pk_bf16_f32 v66, v56, v57
  v_smfmac_f32_16x16x64_bf16 v[40:43], v[24:27], a[88:95], v3
  v_cvt_pk_bf16_f32 v67, v58, v59
  v_smfmac_f32_16x16x64_bf16 v[40:43], v[28:31], a[96:103], v3
  v_mfma_f32_16x16x32_bf16 v[72:75], v[64:67], v[4:7], 0
  ds_read_b128 v[52:55], v116 offset:18432
  ds_read_b128 v[56:59], v116 offset:19456
  v_smfmac_f32_16x16x64_bf16 v[40:43], v[32:35], a[104:111], v3
  v_cvt_pk_bf16_f32 v64, v36, v37
  v_smfmac_f32_16x16x64_bf16 v[44:47], v[24:27], a[144:151], v3
  v_cvt_pk_bf16_f32 v65, v38, v39
  v_smfmac_f32_16x16x64_bf16 v[44:47], v[28:31], a[152:159], v3
  v_cvt_pk_bf16_f32 v76, v72, v73
  v_smfmac_f32_16x16x64_bf16 v[44:47], v[32:35], a[160:167], v3
  v_cvt_pk_bf16_f32 v77, v74, v75
  v_cvt_pk_bf16_f32 v66, v40, v41
  v_smfmac_f32_16x16x64_bf16 v[48:51], v[24:27], a[200:207], v3
  v_cvt_pk_bf16_f32 v67, v42, v43
  v_smfmac_f32_16x16x64_bf16 v[48:51], v[28:31], a[208:215], v3
  v_mfma_f32_16x16x32_bf16 v[68:71], v[64:67], v[4:7], 0
  v_smfmac_f32_16x16x64_bf16 v[48:51], v[32:35], a[216:223], v3
  v_cvt_pk_bf16_f32 v64, v44, v45
  v_mfma_f32_16x16x32_bf16 v[84:87], v[80:83], v[76:79], 0
  v_cvt_pk_bf16_f32 v65, v46, v47
  s_waitcnt lgkmcnt(0)
  v_smfmac_f32_16x16x64_bf16 v[88:91], v[76:79], v[96:103], v3
  v_cvt_pk_bf16_f32 v60, v68, v69
  v_cvt_pk_bf16_f32 v61, v70, v71
  v_cvt_pk_bf16_f32 v66, v48, v49
  v_cvt_pk_bf16_f32 v67, v50, v51
  s_nop 1
  v_mfma_f32_16x16x32_bf16 v[72:75], v[64:67], v[4:7], 0
  v_smfmac_f32_16x16x64_bf16 v[92:95], v[76:79], v[104:111], v3
  s_nop 4
  v_cvt_pk_bf16_f32 v62, v72, v73
  v_cvt_pk_bf16_f32 v63, v74, v75
  s_nop 1
  v_mfma_f32_16x16x32_bf16 v[84:87], v[16:19], v[60:63], v[84:87]
  v_smfmac_f32_16x16x64_bf16 v[88:91], v[60:63], v[8:15], v3
  v_smfmac_f32_16x16x64_bf16 v[92:95], v[60:63], v[52:59], v3
  s_nop 1
  v_permlane32_swap_b32 v84, v86
  v_permlane32_swap_b32 v85, v87
  s_nop 0
  v_cmp_u_f32 vcc, v88, v89
  v_add_f32_dpp v84, v86, v84 row_ror:8 row_mask:0xf bank_mask:0xf
  v_add_f32_dpp v85, v87, v85 row_ror:8 row_mask:0xf bank_mask:0xf
  v_permlane32_swap_b32 v88, v92
  v_permlane32_swap_b32 v89, v93
  ds_write2_b32 v113, v84, v85 offset0:0 offset1:4
  v_permlane32_swap_b32 v90, v94
  v_permlane32_swap_b32 v91, v95
  v_add_f32 v88, v88, v92
  v_add_f32 v89, v89, v93
  v_add_f32 v90, v90, v94
  v_add_f32 v91, v91, v95
  ds_write2_b64 v112, v[88:89], v[90:91] offset0:0 offset1:128
  s_cbranch_vccnz cA_sc2_retry
cA_sc2_cont:
  s_waitcnt lgkmcnt(0)
  s_barrier
  ds_read_b128 v[36:39], v114
  ds_read_b128 v[44:47], v115
  v_lshl_add_u32 v56, v2, 3, s36
  s_waitcnt lgkmcnt(0)
  v_add_f32 v36, v36, v38
  v_add_f32 v37, v37, v39
  v_add_f32 v44, v44, v45
  s_mov_b64 exec, 65535
  buffer_store_dword v2, v56, s[8:11], s20 offen
  s_mov_b64 exec, -1
  v_add_f32 v46, v46, v47
  v_permlane32_swap_b32 v36, v37
  v_add_f32 v44, v44, v46
  v_add_f32 v36, v36, v37
  v_exp_f32 v49, v44
  v_exp_f32 v48, v36
  v_add_f32 v50, abs(v36), abs(v44)
  v_fma_f32 v39, v49, s37, v48
  v_cmp_ngt_f32 vcc, s56, v50
  v_cndmask_b32 v41, v48, v49, s[38:39]
  v_add_f32_dpp v39, v39, v39 quad_perm:[1,0,3,2] row_mask:0xf bank_mask:0xf
  v_cndmask_b32 v40, v49, v48, s[38:39]
  v_mov_b32_dpp v46, v41 quad_perm:[1,0,3,2] row_mask:0xf bank_mask:0xf
  v_add_f32_dpp v39, v39, v39 quad_perm:[2,3,0,1] row_mask:0xf bank_mask:0xf
  v_cndmask_b32 v42, v46, v40, s[38:39]
  v_cndmask_b32 v43, v40, v46, s[38:39]
  v_add_f32_dpp v39, v39, v39 row_half_mirror row_mask:0xf bank_mask:0xf
  s_cbranch_vccnz cA_sc2_slow
  s_nop 0
  v_add_f32_dpp v47, v39, v39 row_mirror row_mask:0xf bank_mask:0xf
  v_add_f32_dpp v39, v39, v39 row_mirror row_mask:0xf bank_mask:0xf
  s_nop 1
  v_permlane16_swap_b32 v39, v47
  v_add_f32 v39, v39, v47
  v_rcp_f32 v39, v39
  s_mov_b64 exec, s[28:29]
  v_mul_f32 v42, v42, v39
  v_mul_f32 v43, v43, v39
  v_cvt_pk_bf16_f32 v42, v42, v43
cA_sc2_pst:
  buffer_store_dword v42, v1, s[8:11], s20 offen
  s_mov_b64 exec, -1
  s_barrier
  s_add_u32 s24, s24, 28672
  s_add_u32 s35, s35, 28672
  s_xor_b32 s25, s25, 28672
  s_add_u32 m0, s25, 14336
  s_nop 0
  buffer_load_dwordx4 v2, s[8:11], s24 offen offset:0 sc1 lds
  buffer_load_dwordx4 v2, s[8:11], s24 offen offset:1024 sc1 lds
  buffer_load_dwordx4 v2, s[8:11], s24 offen offset:2048 sc1 lds
  buffer_load_dwordx4 v2, s[8:11], s24 offen offset:3072 sc1 lds
  s_add_u32 m0, s25, 18432
  s_add_u32 s22, s24, 4096
  buffer_load_dwordx4 v2, s[8:11], s22 offen offset:0 sc1 lds
  buffer_load_dwordx4 v2, s[8:11], s22 offen offset:1024 sc1 lds
  buffer_load_dwordx4 v2, s[8:11], s22 offen offset:2048 sc1 lds
  v_xor_b32 v116, 28672, v116
  v_add_u32 v117, s57, v117
  s_sub_u32 s57, 0, s57
  s_add_u32 s19, s19, 1
  s_mov_b32 s20, s21
  s_cmp_lt_u32 s19, 63
  s_cbranch_scc1 cA_sc2_loop
  s_branch cA_done
cA_sc2_slow:
  v_max_f32 v50, v36, v44
  s_nop 1
  v_max_f32_dpp v50, v50, v50 quad_perm:[1,0,3,2] row_mask:0xf bank_mask:0xf
  s_nop 1
  v_max_f32_dpp v50, v50, v50 quad_perm:[2,3,0,1] row_mask:0xf bank_mask:0xf
  s_nop 1
  v_max_f32_dpp v50, v50, v50 row_half_mirror row_mask:0xf bank_mask:0xf
  s_nop 1
  v_max_f32_dpp v50, v50, v50 row_mirror row_mask:0xf bank_mask:0xf
  v_mov_b32 v47, v50
  s_nop 1
  v_permlane16_swap_b32 v50, v47
  v_max_f32 v50, v50, v47
  v_sub_f32 v48, v36, v50
  v_sub_f32 v49, v44, v50
  v_exp_f32 v48, v48
  v_exp_f32 v49, v49
  s_add_u32 s31, s31, 0x100
  v_fma_f32 v39, v49, s37, v48
  v_cndmask_b32 v41, v48, v49, s[38:39]
  s_nop 0
  v_add_f32_dpp v39, v39, v39 quad_perm:[1,0,3,2] row_mask:0xf bank_mask:0xf
  v_cndmask_b32 v40, v49, v48, s[38:39]
  v_mov_b32_dpp v46, v41 quad_perm:[1,0,3,2] row_mask:0xf bank_mask:0xf
  v_add_f32_dpp v39, v39, v39 quad_perm:[2,3,0,1] row_mask:0xf bank_mask:0xf
  v_cndmask_b32 v42, v46, v40, s[38:39]
  v_cndmask_b32 v43, v40, v46, s[38:39]
  v_add_f32_dpp v39, v39, v39 row_half_mirror row_mask:0xf bank_mask:0xf
  s_nop 1
  v_add_f32_dpp v47, v39, v39 row_mirror row_mask:0xf bank_mask:0xf
  v_add_f32_dpp v39, v39, v39 row_mirror row_mask:0xf bank_mask:0xf
  s_nop 1
  v_permlane16_swap_b32 v39, v47
  v_add_f32 v39, v39, v47
  v_rcp_f32 v39, v39
  s_mov_b64 exec, s[28:29]
  v_mul_f32 v42, v42, v39
  v_mul_f32 v43, v43, v39
  v_cvt_pk_bf16_f32 v42, v42, v43
  v_min_u32 v42, -2, v42
  s_branch cA_sc2_pst
cA_sc2_retry:
  s_cmp_lg_u32 s62, 0
  s_cbranch_scc1 cA_sc2_cont
  s_waitcnt vmcnt(0) lgkmcnt(0)
cA_sc2_rv:
  buffer_load_dwordx4 v[8:11], v2, s[8:11], s20 offen offset:0 sc1
  buffer_load_dwordx4 v[12:15], v2, s[8:11], s20 offen offset:1024 sc1
  buffer_load_dwordx4 v[16:19], v2, s[8:11], s20 offen offset:2048 sc1
  buffer_load_dwordx4 v[20:23], v2, s[8:11], s20 offen offset:3072 sc1
  buffer_load_dwordx4 v[24:27], v2, s[8:11], s23 offen offset:0 sc1
  buffer_load_dwordx4 v[28:31], v2, s[8:11], s23 offen offset:1024 sc1
  buffer_load_dwordx4 v[32:35], v2, s[8:11], s23 offen offset:2048 sc1
  s_waitcnt vmcnt(0)
  v_max3_u32 v118, v8, v9, v10
  v_max3_u32 v118, v118, v11, v12
  v_max3_u32 v118, v118, v13, v14
  v_max3_u32 v118, v118, v15, v16
  v_max3_u32 v118, v118, v17, v18
  v_max3_u32 v118, v118, v19, v20
  v_max3_u32 v118, v118, v21, v22
  v_max3_u32 v118, v118, v23, v24
  v_max3_u32 v118, v118, v25, v26
  v_max3_u32 v118, v118, v27, v28
  v_max3_u32 v118, v118, v29, v30
  v_max3_u32 v118, v118, v31, v32
  v_max3_u32 v118, v118, v33, v34
  v_max_u32 v118, v118, v35
  v_cmp_eq_u32 vcc, -1, v118
  s_cbranch_vccz cA_sc2_rk
  s_add_u32 s30, s30, 1
  s_cmp_lt_u32 s30, 400000
  s_cbranch_scc1 cA_sc2_rv
  s_branch cA_abort
cA_sc2_rk:
  s_mov_b32 s62, 1
  v_mov_b32 v36, 0
  v_mov_b32 v37, 0
  v_mov_b32 v38, 0
  v_mov_b32 v39, 0
  v_mov_b32 v40, 0
  v_mov_b32 v41, 0
  v_mov_b32 v42, 0
  v_mov_b32 v43, 0
  v_mov_b32 v44, 0
  v_mov_b32 v45, 0
  v_mov_b32 v46, 0
  v_mov_b32 v47, 0
  v_mov_b32 v48, 0
  v_mov_b32 v49, 0
  v_mov_b32 v50, 0
  v_mov_b32 v51, 0
  v_mov_b32 v52, 0
  v_mov_b32 v53, 0
  v_mov_b32 v54, 0
  v_mov_b32 v55, 0
  v_mov_b32 v56, 0
  v_mov_b32 v57, 0
  v_mov_b32 v58, 0
  v_mov_b32 v59, 0
  v_mov_b32 v60, 0
  v_mov_b32 v61, 0
  v_mov_b32 v62, 0
  v_mov_b32 v63, 0
  v_mov_b32 v88, 0
  v_mov_b32 v89, 0
  v_mov_b32 v90, 0
  v_mov_b32 v91, 0
  v_mov_b32 v92, 0
  v_mov_b32 v93, 0
  v_mov_b32 v94, 0
  v_mov_b32 v95, 0
  v_mov_b32 v66, 0
  v_mov_b32 v67, 0
  s_add_u32 s31, s31, 1
  ds_read_b128 v[96:99], v117 offset:0
  ds_read_b128 v[100:103], v117 offset:1024
  ds_read_b128 v[104:107], v117 offset:14336
  ds_read_b128 v[108:111], v117 offset:15360
  v_smfmac_f32_16x16x64_bf16 v[36:39], v[8:11], a[0:7], v3
  v_smfmac_f32_16x16x64_bf16 v[40:43], v[8:11], a[56:63], v3
  v_smfmac_f32_16x16x64_bf16 v[44:47], v[8:11], a[112:119], v3
  v_smfmac_f32_16x16x64_bf16 v[48:51], v[8:11], a[168:175], v3
  v_smfmac_f32_16x16x64_bf16 v[52:55], v[8:11], a[224:231], v3
  v_smfmac_f32_16x16x64_bf16 v[56:59], v[8:11], v[144:151], v3
  v_smfmac_f32_16x16x64_bf16 v[60:63], v[8:11], v[200:207], v3
  v_smfmac_f32_16x16x64_bf16 v[36:39], v[12:15], a[8:15], v3
  v_smfmac_f32_16x16x64_bf16 v[40:43], v[12:15], a[64:71], v3
  v_smfmac_f32_16x16x64_bf16 v[44:47], v[12:15], a[120:127], v3
  v_smfmac_f32_16x16x64_bf16 v[48:51], v[12:15], a[176:183], v3
  v_smfmac_f32_16x16x64_bf16 v[52:55], v[12:15], a[232:239], v3
  v_smfmac_f32_16x16x64_bf16 v[56:59], v[12:15], v[152:159], v3
  v_smfmac_f32_16x16x64_bf16 v[60:63], v[12:15], v[208:215], v3
  v_smfmac_f32_16x16x64_bf16 v[36:39], v[16:19], a[16:23], v3
  v_smfmac_f32_16x16x64_bf16 v[40:43], v[16:19], a[72:79], v3
  v_smfmac_f32_16x16x64_bf16 v[44:47], v[16:19], a[128:135], v3
  v_smfmac_f32_16x16x64_bf16 v[48:51], v[16:19], a[184:191], v3
  v_smfmac_f32_16x16x64_bf16 v[52:55], v[16:19], a[240:247], v3
  v_smfmac_f32_16x16x64_bf16 v[56:59], v[16:19], v[160:167], v3
  v_smfmac_f32_16x16x64_bf16 v[60:63], v[16:19], v[216:223], v3
  v_smfmac_f32_16x16x64_bf16 v[36:39], v[20:23], a[24:31], v3
  v_smfmac_f32_16x16x64_bf16 v[40:43], v[20:23], a[80:87], v3
  v_smfmac_f32_16x16x64_bf16 v[44:47], v[20:23], a[136:143], v3
  v_smfmac_f32_16x16x64_bf16 v[48:51], v[20:23], a[192:199], v3
  v_smfmac_f32_16x16x64_bf16 v[52:55], v[20:23], a[248:255], v3
  v_smfmac_f32_16x16x64_bf16 v[56:59], v[20:23], v[168:175], v3
  v_smfmac_f32_16x16x64_bf16 v[60:63], v[20:23], v[224:231], v3
  s_branch cA_sc2_ph2
.p2align 6

cA_sc3_loop:
  s_add_u32 s23, s20, 4096
  s_add_u32 s21, s20, 25600
  v_mov_b32 v48, 0
  v_mov_b32 v49, 0
  v_mov_b32 v50, 0
  v_mov_b32 v51, 0
  v_mov_b32 v52, 0
  v_mov_b32 v53, 0
  v_mov_b32 v54, 0
  v_mov_b32 v55, 0
  v_mov_b32 v56, 0
  v_mov_b32 v57, 0
  v_mov_b32 v58, 0
  v_mov_b32 v59, 0
  v_mov_b32 v60, 0
  v_mov_b32 v61, 0
  v_mov_b32 v62, 0
  v_mov_b32 v63, 0
  v_mov_b32 v88, 0
  v_mov_b32 v89, 0
  v_mov_b32 v90, 0
  v_mov_b32 v91, 0
  v_mov_b32 v92, 0
  v_mov_b32 v93, 0
  v_mov_b32 v94, 0
  v_mov_b32 v95, 0
  v_mov_b32 v64, 0
  v_mov_b32 v65, 0
  s_mov_b32 s30, 0
  s_mov_b32 s62, 0
  s_waitcnt vmcnt(0)
  s_barrier
cA_sc3_ld:
  buffer_load_dwordx4 v[8:11], v2, s[8:11], s20 offen offset:0
  v_mov_b32 v36, 0
  v_mov_b32 v37, 0
  v_mov_b32 v38, 0
  v_mov_b32 v39, 0
  buffer_load_dwordx4 v[12:15], v2, s[8:11], s20 offen offset:1024
  v_mov_b32 v40, 0
  v_mov_b32 v41, 0
  v_mov_b32 v42, 0
  v_mov_b32 v43, 0
  buffer_load_dwordx4 v[16:19], v2, s[8:11], s20 offen offset:2048
  v_mov_b32 v44, 0
  v_mov_b32 v45, 0
  v_mov_b32 v46, 0
  v_mov_b32 v47, 0
  ds_read_b128 v[96:99], v117 offset:0
  ds_read_b128 v[100:103], v117 offset:1024
  ds_read_b128 v[104:107], v117 offset:14336
  ds_read_b128 v[108:111], v117 offset:15360
  s_waitcnt vmcnt(2)
  v_smfmac_f32_16x16x64_bf16 v[36:39], v[8:11], a[0:7], v3
  v_smfmac_f32_16x16x64_bf16 v[40:43], v[8:11], a[56:63], v3
  buffer_load_dwordx4 v[20:23], v2, s[8:11], s20 offen offset:3072
  v_smfmac_f32_16x16x64_bf16 v[44:47], v[8:11], a[112:119], v3
  v_smfmac_f32_16x16x64_bf16 v[48:51], v[8:11], a[168:175], v3
  v_smfmac_f32_16x16x64_bf16 v[52:55], v[8:11], a[224:231], v3
  buffer_load_dwordx4 v[24:27], v2, s[8:11], s23 offen offset:0
  v_smfmac_f32_16x16x64_bf16 v[56:59], v[8:11], v[144:151], v3
  v_smfmac_f32_16x16x64_bf16 v[60:63], v[8:11], v[200:207], v3
  s_waitcnt vmcnt(3)
  v_smfmac_f32_16x16x64_bf16 v[36:39], v[12:15], a[8:15], v3
  v_smfmac_f32_16x16x64_bf16 v[40:43], v[12:15], a[64:71], v3
  buffer_load_dwordx4 v[28:31], v2, s[8:11], s23 offen offset:1024
  v_smfmac_f32_16x16x64_bf16 v[44:47], v[12:15], a[120:127], v3
  v_smfmac_f32_16x16x64_bf16 v[48:51], v[12:15], a[176:183], v3
  v_smfmac_f32_16x16x64_bf16 v[52:55], v[12:15], a[232:239], v3
  buffer_load_dwordx4 v[32:35], v2, s[8:11], s23 offen offset:2048
  v_smfmac_f32_16x16x64_bf16 v[56:59], v[12:15], v[152:159], v3
  v_smfmac_f32_16x16x64_bf16 v[60:63], v[12:15], v[208:215], v3
  s_waitcnt vmcnt(4)
  v_smfmac_f32_16x16x64_bf16 v[36:39], v[16:19], a[16:23], v3
  v_smfmac_f32_16x16x64_bf16 v[40:43], v[16:19], a[72:79], v3
  v_smfmac_f32_16x16x64_bf16 v[44:47], v[16:19], a[128:135], v3
  v_smfmac_f32_16x16x64_bf16 v[48:51], v[16:19], a[184:191], v3
  v_smfmac_f32_16x16x64_bf16 v[52:55], v[16:19], a[240:247], v3
  v_smfmac_f32_16x16x64_bf16 v[56:59], v[16:19], v[160:167], v3
  v_smfmac_f32_16x16x64_bf16 v[60:63], v[16:19], v[216:223], v3
  s_waitcnt vmcnt(3)
  v_smfmac_f32_16x16x64_bf16 v[36:39], v[20:23], a[24:31], v3
  v_smfmac_f32_16x16x64_bf16 v[40:43], v[20:23], a[80:87], v3
  v_smfmac_f32_16x16x64_bf16 v[44:47], v[20:23], a[136:143], v3
  v_smfmac_f32_16x16x64_bf16 v[48:51], v[20:23], a[192:199], v3
  v_smfmac_f32_16x16x64_bf16 v[52:55], v[20:23], a[248:255], v3
  v_smfmac_f32_16x16x64_bf16 v[56:59], v[20:23], v[168:175], v3
  v_smfmac_f32_16x16x64_bf16 v[60:63], v[20:23], v[224:231], v3
  s_waitcnt vmcnt(0)
cA_sc3_ph2:
  v_smfmac_f32_16x16x64_bf16 v[60:63], v[24:27], v[232:239], v3
  ds_read_b128 v[8:11], v116 offset:6144
  ds_read_b128 v[12:15], v116 offset:7168
  v_smfmac_f32_16x16x64_bf16 v[60:63], v[28:31], v[240:247], v3
  v_smfmac_f32_16x16x64_bf16 v[60:63], v[32:35], v[248:255], v3
  v_mov_b32 v80, v30
  v_smfmac_f32_16x16x64_bf16 v[52:55], v[24:27], v[120:127], v3
  v_mov_b32 v81, v31
  v_smfmac_f32_16x16x64_bf16 v[52:55], v[28:31], v[128:135], v3
  v_mov_b32 v82, v34
  v_smfmac_f32_16x16x64_bf16 v[52:55], v[32:35], v[136:143], v3
  v_cvt_pk_bf16_f32 v66, v60, v61
  v_smfmac_f32_16x16x64_bf16 v[56:59], v[24:27], v[176:183], v3
  v_cvt_pk_bf16_f32 v67, v62, v63
  v_smfmac_f32_16x16x64_bf16 v[56:59], v[28:31], v[184:191], v3
  v_mov_b32 v83, v35
  v_mfma_f32_16x16x32_bf16 v[68:71], v[64:67], v[4:7], 0
  v_smfmac_f32_16x16x64_bf16 v[56:59], v[32:35], v[192:199], v3
  v_cvt_pk_bf16_f32 v64, v52, v53
  v_smfmac_f32_16x16x64_bf16 v[36:39], v[24:27], a[32:39], v3
  v_cvt_pk_bf16_f32 v65, v54, v55
  v_smfmac_f32_16x16x64_bf16 v[36:39], v[28:31], a[40:47], v3
  v_cvt_pk_bf16_f32 v78, v68, v69
  v_smfmac_f32_16x16x64_bf16 v[36:39], v[32:35], a[48:55], v3
  v_cvt_pk_bf16_f32 v79, v70, v71
  v_cvt_pk_bf16_f32 v66, v56, v57
  v_smfmac_f32_16x16x64_bf16 v[40:43], v[24:27], a[88:95], v3
  v_cvt_pk_bf16_f32 v67, v58, v59
  v_smfmac_f32_16x16x64_bf16 v[40:43], v[28:31], a[96:103], v3
  v_mfma_f32_16x16x32_bf16 v[72:75], v[64:67], v[4:7], 0
  ds_read_b128 v[52:55], v116 offset:20480
  ds_read_b128 v[56:59], v116 offset:21504
  v_smfmac_f32_16x16x64_bf16 v[40:43], v[32:35], a[104:111], v3
  v_cvt_pk_bf16_f32 v64, v36, v37
  v_smfmac_f32_16x16x64_bf16 v[44:47], v[24:27], a[144:151], v3
  v_cvt_pk_bf16_f32 v65, v38, v39
  v_smfmac_f32_16x16x64_bf16 v[44:47], v[28:31], a[152:159], v3
  v_cvt_pk_bf16_f32 v76, v72, v73
  v_smfmac_f32_16x16x64_bf16 v[44:47], v[32:35], a[160:167], v3
  v_cvt_pk_bf16_f32 v77, v74, v75
  v_cvt_pk_bf16_f32 v66, v40, v41
  v_smfmac_f32_16x16x64_bf16 v[48:51], v[24:27], a[200:207], v3
  v_cvt_pk_bf16_f32 v67, v42, v43
  v_smfmac_f32_16x16x64_bf16 v[48:51], v[28:31], a[208:215], v3
  v_mfma_f32_16x16x32_bf16 v[68:71], v[64:67], v[4:7], 0
  v_smfmac_f32_16x16x64_bf16 v[48:51], v[32:35], a[216:223], v3
  v_cvt_pk_bf16_f32 v64, v44, v45
  v_mfma_f32_16x16x32_bf16 v[84:87], v[80:83], v[76:79], 0
  v_cvt_pk_bf16_f32 v65, v46, v47
  s_waitcnt lgkmcnt(0)
  v_smfmac_f32_16x16x64_bf16 v[88:91], v[76:79], v[96:103], v3
  v_cvt_pk_bf16_f32 v60, v68, v69
  v_cvt_pk_bf16_f32 v61, v70, v71
  v_cvt_pk_bf16_f32 v66, v48, v49
  v_cvt_pk_bf16_f32 v67, v50, v51
  s_nop 1
  v_mfma_f32_16x16x32_bf16 v[72:75], v[64:67], v[4:7], 0
  v_smfmac_f32_16x16x64_bf16 v[92:95], v[76:79], v[104:111], v3
  s_nop 4
  v_cvt_pk_bf16_f32 v62, v72, v73
  v_cvt_pk_bf16_f32 v63, v74, v75
  s_nop 1
  v_mfma_f32_16x16x32_bf16 v[84:87], v[20:23], v[60:63], v[84:87]
  v_smfmac_f32_16x16x64_bf16 v[88:91], v[60:63], v[8:15], v3
  v_smfmac_f32_16x16x64_bf16 v[92:95], v[60:63], v[52:59], v3
  s_nop 1
  v_permlane32_swap_b32 v84, v86
  v_permlane32_swap_b32 v85, v87
  s_nop 0
  v_cmp_u_f32 vcc, v88, v89
  v_add_f32_dpp v84, v86, v84 row_ror:8 row_mask:0xf bank_mask:0xf
  v_add_f32_dpp v85, v87, v85 row_ror:8 row_mask:0xf bank_mask:0xf
  v_permlane32_swap_b32 v88, v92
  v_permlane32_swap_b32 v89, v93
  ds_write2_b32 v113, v84, v85 offset0:0 offset1:4
  v_permlane32_swap_b32 v90, v94
  v_permlane32_swap_b32 v91, v95
  v_add_f32 v88, v88, v92
  v_add_f32 v89, v89, v93
  v_add_f32 v90, v90, v94
  v_add_f32 v91, v91, v95
  ds_write2_b64 v112, v[88:89], v[90:91] offset0:0 offset1:128
  s_cbranch_vccnz cA_sc3_retry
cA_sc3_cont:
  s_waitcnt lgkmcnt(0)
  s_barrier
  ds_read_b128 v[36:39], v114
  ds_read_b128 v[44:47], v115
  s_waitcnt lgkmcnt(0)
  v_add_f32 v36, v36, v38
  v_add_f32 v37, v37, v39
  v_add_f32 v44, v44, v45
  v_add_f32 v46, v46, v47
  v_permlane32_swap_b32 v36, v37
  v_add_f32 v44, v44, v46
  v_add_f32 v36, v36, v37
  v_exp_f32 v49, v44
  v_exp_f32 v48, v36
  v_add_f32 v50, abs(v36), abs(v44)
  v_fma_f32 v39, v49, s37, v48
  v_cmp_ngt_f32 vcc, s56, v50
  v_cndmask_b32 v41, v48, v49, s[38:39]
  v_add_f32_dpp v39, v39, v39 quad_perm:[1,0,3,2] row_mask:0xf bank_mask:0xf
  v_cndmask_b32 v40, v49, v48, s[38:39]
  v_mov_b32_dpp v46, v41 quad_perm:[1,0,3,2] row_mask:0xf bank_mask:0xf
  v_add_f32_dpp v39, v39, v39 quad_perm:[2,3,0,1] row_mask:0xf bank_mask:0xf
  v_cndmask_b32 v42, v46, v40, s[38:39]
  v_cndmask_b32 v43, v40, v46, s[38:39]
  v_add_f32_dpp v39, v39, v39 row_half_mirror row_mask:0xf bank_mask:0xf
  s_cbranch_vccnz cA_sc3_slow
  s_nop 0
  v_add_f32_dpp v47, v39, v39 row_mirror row_mask:0xf bank_mask:0xf
  v_add_f32_dpp v39, v39, v39 row_mirror row_mask:0xf bank_mask:0xf
  s_nop 1
  v_permlane16_swap_b32 v39, v47
  v_add_f32 v39, v39, v47
  v_rcp_f32 v39, v39
  s_mov_b64 exec, s[28:29]
  v_mul_f32 v42, v42, v39
  v_mul_f32 v43, v43, v39
  v_cvt_pk_bf16_f32 v42, v42, v43
cA_sc3_pst:
  buffer_store_dword v42, v1, s[8:11], s20 offen
  s_mov_b64 exec, -1
  s_barrier
  s_add_u32 s24, s24, 28672
  s_add_u32 s35, s35, 28672
  s_xor_b32 s25, s25, 28672
  s_add_u32 m0, s25, 21504
  s_nop 0
  buffer_load_dwordx4 v2, s[8:11], s24 offen offset:0 sc1 lds
  buffer_load_dwordx4 v2, s[8:11], s24 offen offset:1024 sc1 lds
  buffer_load_dwordx4 v2, s[8:11], s24 offen offset:2048 sc1 lds
  buffer_load_dwordx4 v2, s[8:11], s24 offen offset:3072 sc1 lds
  s_add_u32 m0, s25, 25600
  s_add_u32 s22, s24, 4096
  buffer_load_dwordx4 v2, s[8:11], s22 offen offset:0 sc1 lds
  buffer_load_dwordx4 v2, s[8:11], s22 offen offset:1024 sc1 lds
  buffer_load_dwordx4 v2, s[8:11], s22 offen offset:2048 sc1 lds
  v_xor_b32 v116, 28672, v116
  v_add_u32 v117, s57, v117
  s_sub_u32 s57, 0, s57
  s_add_u32 s19, s19, 1
  s_mov_b32 s20, s21
  s_cmp_lt_u32 s19, 63
  s_cbranch_scc1 cA_sc3_loop
  s_branch cA_done
cA_sc3_slow:
  v_max_f32 v50, v36, v44
  s_nop 1
  v_max_f32_dpp v50, v50, v50 quad_perm:[1,0,3,2] row_mask:0xf bank_mask:0xf
  s_nop 1
  v_max_f32_dpp v50, v50, v50 quad_perm:[2,3,0,1] row_mask:0xf bank_mask:0xf
  s_nop 1
  v_max_f32_dpp v50, v50, v50 row_half_mirror row_mask:0xf bank_mask:0xf
  s_nop 1
  v_max_f32_dpp v50, v50, v50 row_mirror row_mask:0xf bank_mask:0xf
  v_mov_b32 v47, v50
  s_nop 1
  v_permlane16_swap_b32 v50, v47
  v_max_f32 v50, v50, v47
  v_sub_f32 v48, v36, v50
  v_sub_f32 v49, v44, v50
  v_exp_f32 v48, v48
  v_exp_f32 v49, v49
  s_add_u32 s31, s31, 0x100
  v_fma_f32 v39, v49, s37, v48
  v_cndmask_b32 v41, v48, v49, s[38:39]
  s_nop 0
  v_add_f32_dpp v39, v39, v39 quad_perm:[1,0,3,2] row_mask:0xf bank_mask:0xf
  v_cndmask_b32 v40, v49, v48, s[38:39]
  v_mov_b32_dpp v46, v41 quad_perm:[1,0,3,2] row_mask:0xf bank_mask:0xf
  v_add_f32_dpp v39, v39, v39 quad_perm:[2,3,0,1] row_mask:0xf bank_mask:0xf
  v_cndmask_b32 v42, v46, v40, s[38:39]
  v_cndmask_b32 v43, v40, v46, s[38:39]
  v_add_f32_dpp v39, v39, v39 row_half_mirror row_mask:0xf bank_mask:0xf
  s_nop 1
  v_add_f32_dpp v47, v39, v39 row_mirror row_mask:0xf bank_mask:0xf
  v_add_f32_dpp v39, v39, v39 row_mirror row_mask:0xf bank_mask:0xf
  s_nop 1
  v_permlane16_swap_b32 v39, v47
  v_add_f32 v39, v39, v47
  v_rcp_f32 v39, v39
  s_mov_b64 exec, s[28:29]
  v_mul_f32 v42, v42, v39
  v_mul_f32 v43, v43, v39
  v_cvt_pk_bf16_f32 v42, v42, v43
  v_min_u32 v42, -2, v42
  s_branch cA_sc3_pst
cA_sc3_retry:
  s_cmp_lg_u32 s62, 0
  s_cbranch_scc1 cA_sc3_cont
  s_waitcnt vmcnt(0) lgkmcnt(0)
cA_sc3_rv:
  buffer_load_dwordx4 v[8:11], v2, s[8:11], s20 offen offset:0 sc1
  buffer_load_dwordx4 v[12:15], v2, s[8:11], s20 offen offset:1024 sc1
  buffer_load_dwordx4 v[16:19], v2, s[8:11], s20 offen offset:2048 sc1
  buffer_load_dwordx4 v[20:23], v2, s[8:11], s20 offen offset:3072 sc1
  buffer_load_dwordx4 v[24:27], v2, s[8:11], s23 offen offset:0 sc1
  buffer_load_dwordx4 v[28:31], v2, s[8:11], s23 offen offset:1024 sc1
  buffer_load_dwordx4 v[32:35], v2, s[8:11], s23 offen offset:2048 sc1
  s_waitcnt vmcnt(0)
  v_max3_u32 v118, v8, v9, v10
  v_max3_u32 v118, v118, v11, v12
  v_max3_u32 v118, v118, v13, v14
  v_max3_u32 v118, v118, v15, v16
  v_max3_u32 v118, v118, v17, v18
  v_max3_u32 v118, v118, v19, v20
  v_max3_u32 v118, v118, v21, v22
  v_max3_u32 v118, v118, v23, v24
  v_max3_u32 v118, v118, v25, v26
  v_max3_u32 v118, v118, v27, v28
  v_max3_u32 v118, v118, v29, v30
  v_max3_u32 v118, v118, v31, v32
  v_max3_u32 v118, v118, v33, v34
  v_max_u32 v118, v118, v35
  v_cmp_eq_u32 vcc, -1, v118
  s_cbranch_vccz cA_sc3_rk
  s_add_u32 s30, s30, 1
  s_cmp_lt_u32 s30, 400000
  s_cbranch_scc1 cA_sc3_rv
  s_branch cA_abort
cA_sc3_rk:
  s_mov_b32 s62, 1
  v_mov_b32 v36, 0
  v_mov_b32 v37, 0
  v_mov_b32 v38, 0
  v_mov_b32 v39, 0
  v_mov_b32 v40, 0
  v_mov_b32 v41, 0
  v_mov_b32 v42, 0
  v_mov_b32 v43, 0
  v_mov_b32 v44, 0
  v_mov_b32 v45, 0
  v_mov_b32 v46, 0
  v_mov_b32 v47, 0
  v_mov_b32 v48, 0
  v_mov_b32 v49, 0
  v_mov_b32 v50, 0
  v_mov_b32 v51, 0
  v_mov_b32 v52, 0
  v_mov_b32 v53, 0
  v_mov_b32 v54, 0
  v_mov_b32 v55, 0
  v_mov_b32 v56, 0
  v_mov_b32 v57, 0
  v_mov_b32 v58, 0
  v_mov_b32 v59, 0
  v_mov_b32 v60, 0
  v_mov_b32 v61, 0
  v_mov_b32 v62, 0
  v_mov_b32 v63, 0
  v_mov_b32 v88, 0
  v_mov_b32 v89, 0
  v_mov_b32 v90, 0
  v_mov_b32 v91, 0
  v_mov_b32 v92, 0
  v_mov_b32 v93, 0
  v_mov_b32 v94, 0
  v_mov_b32 v95, 0
  v_mov_b32 v64, 0
  v_mov_b32 v65, 0
  s_add_u32 s31, s31, 1
  ds_read_b128 v[96:99], v117 offset:0
  ds_read_b128 v[100:103], v117 offset:1024
  ds_read_b128 v[104:107], v117 offset:14336
  ds_read_b128 v[108:111], v117 offset:15360
  v_smfmac_f32_16x16x64_bf16 v[36:39], v[8:11], a[0:7], v3
  v_smfmac_f32_16x16x64_bf16 v[40:43], v[8:11], a[56:63], v3
  v_smfmac_f32_16x16x64_bf16 v[44:47], v[8:11], a[112:119], v3
  v_smfmac_f32_16x16x64_bf16 v[48:51], v[8:11], a[168:175], v3
  v_smfmac_f32_16x16x64_bf16 v[52:55], v[8:11], a[224:231], v3
  v_smfmac_f32_16x16x64_bf16 v[56:59], v[8:11], v[144:151], v3
  v_smfmac_f32_16x16x64_bf16 v[60:63], v[8:11], v[200:207], v3
  v_smfmac_f32_16x16x64_bf16 v[36:39], v[12:15], a[8:15], v3
  v_smfmac_f32_16x16x64_bf16 v[40:43], v[12:15], a[64:71], v3
  v_smfmac_f32_16x16x64_bf16 v[44:47], v[12:15], a[120:127], v3
  v_smfmac_f32_16x16x64_bf16 v[48:51], v[12:15], a[176:183], v3
  v_smfmac_f32_16x16x64_bf16 v[52:55], v[12:15], a[232:239], v3
  v_smfmac_f32_16x16x64_bf16 v[56:59], v[12:15], v[152:159], v3
  v_smfmac_f32_16x16x64_bf16 v[60:63], v[12:15], v[208:215], v3
  v_smfmac_f32_16x16x64_bf16 v[36:39], v[16:19], a[16:23], v3
  v_smfmac_f32_16x16x64_bf16 v[40:43], v[16:19], a[72:79], v3
  v_smfmac_f32_16x16x64_bf16 v[44:47], v[16:19], a[128:135], v3
  v_smfmac_f32_16x16x64_bf16 v[48:51], v[16:19], a[184:191], v3
  v_smfmac_f32_16x16x64_bf16 v[52:55], v[16:19], a[240:247], v3
  v_smfmac_f32_16x16x64_bf16 v[56:59], v[16:19], v[160:167], v3
  v_smfmac_f32_16x16x64_bf16 v[60:63], v[16:19], v[216:223], v3
  v_smfmac_f32_16x16x64_bf16 v[36:39], v[20:23], a[24:31], v3
  v_smfmac_f32_16x16x64_bf16 v[40:43], v[20:23], a[80:87], v3
  v_smfmac_f32_16x16x64_bf16 v[44:47], v[20:23], a[136:143], v3
  v_smfmac_f32_16x16x64_bf16 v[48:51], v[20:23], a[192:199], v3
  v_smfmac_f32_16x16x64_bf16 v[52:55], v[20:23], a[248:255], v3
  v_smfmac_f32_16x16x64_bf16 v[56:59], v[20:23], v[168:175], v3
  v_smfmac_f32_16x16x64_bf16 v[60:63], v[20:23], v[224:231], v3
  s_branch cA_sc3_ph2
.p2align 6

cA_va0_loop:
  s_add_u32 s23, s20, 4096
  s_add_u32 s21, s20, 25600
  s_mov_b32 s30, 0
  s_cmp_lg_u32 s19, s38
  s_cbranch_scc1 cA_va0_vok
  s_branch cA_va0_voc
cA_va0_vow:
  buffer_load_dword v175, off, s[8:11], s35 sc1
  s_waitcnt vmcnt(0)
cA_va0_voc:
  v_readfirstlane_b32 s22, v175
  s_cmp_eq_u32 s22, 56
  s_cbranch_scc1 cA_va0_vod
  s_sleep 1
  s_add_u32 s30, s30, 1
  s_cmp_lt_u32 s30, 400000
  s_cbranch_scc1 cA_va0_vow
  s_branch cA_abort
cA_va0_vod:
  s_add_u32 s35, s35, 2048
  s_add_u32 s38, s19, 8
  s_and_b32 s38, s38, -8
  s_cmp_eq_u32 s19, 0
  s_cselect_b32 s38, 4, s38
cA_va0_vok:
  s_cmp_eq_u32 s19, 63
  s_cbranch_scc1 cA_done
  s_barrier
  s_add_u32 s22, s25, 0
  buffer_load_dwordx4 v[80:83], v6, s[8:11], s22 offen offset:0 sc1
  buffer_load_dwordx4 v[84:87], v6, s[8:11], s22 offen offset:1792 sc1
  s_add_u32 s22, s25, 3584
  buffer_load_dwordx4 v[88:91], v6, s[8:11], s22 offen offset:0 sc1
  buffer_load_dwordx4 v[92:95], v6, s[8:11], s22 offen offset:1792 sc1
  s_add_u32 s22, s25, 7168
  buffer_load_dwordx4 v[96:99], v6, s[8:11], s22 offen offset:0 sc1
  buffer_load_dwordx4 v[100:103], v6, s[8:11], s22 offen offset:1792 sc1
  s_add_u32 s22, s25, 10752
  buffer_load_dwordx4 v[104:107], v6, s[8:11], s22 offen offset:0 sc1
  buffer_load_dwordx4 v[108:111], v6, s[8:11], s22 offen offset:1792 sc1
  s_add_u32 s22, s25, 14336
  buffer_load_dwordx4 v[112:115], v6, s[8:11], s22 offen offset:0 sc1
  buffer_load_dwordx4 v[116:119], v6, s[8:11], s22 offen offset:1792 sc1
  s_add_u32 s22, s25, 17920
  buffer_load_dwordx4 v[120:123], v6, s[8:11], s22 offen offset:0 sc1
  buffer_load_dwordx4 v[124:127], v6, s[8:11], s22 offen offset:1792 sc1
  s_add_u32 s22, s25, 21504
  buffer_load_dwordx4 v[128:131], v6, s[8:11], s22 offen offset:0 sc1
  buffer_load_dwordx4 v[132:135], v6, s[8:11], s22 offen offset:1792 sc1
  s_add_u32 s22, s25, 25088
  buffer_load_dwordx4 v[136:139], v6, s[8:11], s22 offen offset:0 sc1
  buffer_load_dwordx4 v[140:143], v6, s[8:11], s22 offen offset:1792 sc1
  buffer_load_dword v175, off, s[8:11], s35 sc1
  s_barrier
  ds_read_b128 v[8:11], v2 offset:8192
  ds_read_b128 v[12:15], v2 offset:9216
  ds_read_b128 v[16:19], v2 offset:10240
  ds_read_b128 v[20:23], v2 offset:11264
  ds_read_b128 v[24:27], v2 offset:12288
  ds_read_b128 v[28:31], v2 offset:13312
  ds_read_b128 v[32:35], v2 offset:14336
  s_waitcnt lgkmcnt(0)
  v_smfmac_f32_16x16x64_bf16 v[36:39], v[8:11], a[0:7], v3
  v_smfmac_f32_16x16x64_bf16 v[36:39], v[12:15], a[8:15], v3
  v_smfmac_f32_16x16x64_bf16 v[36:39], v[16:19], a[16:23], v3
  v_smfmac_f32_16x16x64_bf16 v[36:39], v[20:23], a[24:31], v3
  v_smfmac_f32_16x16x64_bf16 v[36:39], v[24:27], a[32:39], v3
  v_smfmac_f32_16x16x64_bf16 v[36:39], v[28:31], a[40:47], v3
  v_smfmac_f32_16x16x64_bf16 v[36:39], v[32:35], a[48:55], v3
  v_smfmac_f32_16x16x64_bf16 v[40:43], v[8:11], a[56:63], v3
  v_smfmac_f32_16x16x64_bf16 v[40:43], v[12:15], a[64:71], v3
  v_smfmac_f32_16x16x64_bf16 v[40:43], v[16:19], a[72:79], v3
  v_smfmac_f32_16x16x64_bf16 v[40:43], v[20:23], a[80:87], v3
  v_smfmac_f32_16x16x64_bf16 v[40:43], v[24:27], a[88:95], v3
  v_smfmac_f32_16x16x64_bf16 v[40:43], v[28:31], a[96:103], v3
  v_smfmac_f32_16x16x64_bf16 v[40:43], v[32:35], a[104:111], v3
  v_smfmac_f32_16x16x64_bf16 v[44:47], v[8:11], a[112:119], v3
  v_smfmac_f32_16x16x64_bf16 v[44:47], v[12:15], a[120:127], v3
  v_smfmac_f32_16x16x64_bf16 v[44:47], v[16:19], a[128:135], v3
  v_smfmac_f32_16x16x64_bf16 v[44:47], v[20:23], a[136:143], v3
  v_permlane32_swap_b32 v36, v40
  v_smfmac_f32_16x16x64_bf16 v[44:47], v[24:27], a[144:151], v3
  v_permlane32_swap_b32 v37, v41
  v_smfmac_f32_16x16x64_bf16 v[44:47], v[28:31], a[152:159], v3
  v_permlane32_swap_b32 v38, v42
  v_smfmac_f32_16x16x64_bf16 v[44:47], v[32:35], a[160:167], v3
  v_permlane32_swap_b32 v39, v43
  v_smfmac_f32_16x16x64_bf16 v[48:51], v[8:11], a[168:175], v3
  v_add_f32 v36, v36, v40
  v_smfmac_f32_16x16x64_bf16 v[48:51], v[12:15], a[176:183], v3
  v_add_f32 v37, v37, v41
  v_smfmac_f32_16x16x64_bf16 v[48:51], v[16:19], a[184:191], v3
  v_add_f32 v38, v38, v42
  v_smfmac_f32_16x16x64_bf16 v[48:51], v[20:23], a[192:199], v3
  v_add_f32 v39, v39, v43
  v_smfmac_f32_16x16x64_bf16 v[48:51], v[24:27], a[200:207], v3
  v_cvt_pk_bf16_f32 v40, v36, v37
  v_smfmac_f32_16x16x64_bf16 v[48:51], v[28:31], a[208:215], v3
  v_cvt_pk_bf16_f32 v41, v38, v39
  v_smfmac_f32_16x16x64_bf16 v[48:51], v[32:35], a[216:223], v3
  ds_write2_b32 v60, v40, v41 offset0:0 offset1:2
  v_smfmac_f32_16x16x64_bf16 v[52:55], v[8:11], a[224:231], v3
  v_smfmac_f32_16x16x64_bf16 v[52:55], v[12:15], a[232:239], v3
  v_smfmac_f32_16x16x64_bf16 v[52:55], v[16:19], a[240:247], v3
  v_smfmac_f32_16x16x64_bf16 v[52:55], v[20:23], a[248:255], v3
  v_permlane32_swap_b32 v44, v48
  v_smfmac_f32_16x16x64_bf16 v[52:55], v[24:27], v[176:183], v3
  v_permlane32_swap_b32 v45, v49
  v_smfmac_f32_16x16x64_bf16 v[52:55], v[28:31], v[184:191], v3
  v_permlane32_swap_b32 v46, v50
  v_smfmac_f32_16x16x64_bf16 v[52:55], v[32:35], v[192:199], v3
  v_permlane32_swap_b32 v47, v51
  v_smfmac_f32_16x16x64_bf16 v[56:59], v[8:11], v[200:207], v3
  v_add_f32 v44, v44, v48
  v_smfmac_f32_16x16x64_bf16 v[56:59], v[12:15], v[208:215], v3
  v_add_f32 v45, v45, v49
  v_smfmac_f32_16x16x64_bf16 v[56:59], v[16:19], v[216:223], v3
  v_add_f32 v46, v46, v50
  v_smfmac_f32_16x16x64_bf16 v[56:59], v[20:23], v[224:231], v3
  v_add_f32 v47, v47, v51
  v_smfmac_f32_16x16x64_bf16 v[56:59], v[24:27], v[232:239], v3
  v_cvt_pk_bf16_f32 v48, v44, v45
  v_smfmac_f32_16x16x64_bf16 v[56:59], v[28:31], v[240:247], v3
  v_cvt_pk_bf16_f32 v49, v46, v47
  v_smfmac_f32_16x16x64_bf16 v[56:59], v[32:35], v[248:255], v3
  ds_write2_b32 v61, v48, v49 offset0:0 offset1:2
  s_nop 6
  v_permlane32_swap_b32 v52, v56
  v_permlane32_swap_b32 v53, v57
  v_permlane32_swap_b32 v54, v58
  v_permlane32_swap_b32 v55, v59
  v_add_f32 v52, v52, v56
  v_add_f32 v53, v53, v57
  v_add_f32 v54, v54, v58
  v_add_f32 v55, v55, v59
  v_cvt_pk_bf16_f32 v56, v52, v53
  v_cvt_pk_bf16_f32 v57, v54, v55
  ds_write2_b32 v62, v56, v57 offset0:0 offset1:2
  s_cmp_eq_u32 s19, 63
  s_cbranch_scc1 cA_va0_last
  s_add_u32 s22, s20, 9216
  s_add_u32 s34, s20, 13312
  s_add_u32 s36, s20, 7168
  s_mov_b32 s37, 0
  v_mov_b32 v156, 0
  v_mov_b32 v157, 0
  v_mov_b32 v158, 0
  v_mov_b32 v159, 0
  buffer_load_dword v164, v4, s[8:11], s20 offen sc1
  s_nop 7
  buffer_load_dword v165, v4, s[8:11], s20 offen sc1
  s_nop 7
  buffer_load_dword v166, v4, s[8:11], s20 offen sc1
  s_nop 7
  buffer_load_dword v167, v4, s[8:11], s20 offen sc1
  s_nop 7
  buffer_load_dword v168, v4, s[8:11], s20 offen sc1
cA_va0_fw_l:
  s_waitcnt vmcnt(4)
  v_cmp_eq_u32 vcc, -1, v164
  s_cbranch_vccz cA_va0_fw_d
  buffer_load_dword v164, v4, s[8:11], s20 offen sc1
  s_waitcnt vmcnt(4)
  v_cmp_eq_u32 vcc, -1, v165
  s_cbranch_vccz cA_va0_fw_d
  buffer_load_dword v165, v4, s[8:11], s20 offen sc1
  s_waitcnt vmcnt(4)
  v_cmp_eq_u32 vcc, -1, v166
  s_cbranch_vccz cA_va0_fw_d
  buffer_load_dword v166, v4, s[8:11], s20 offen sc1
  s_waitcnt vmcnt(4)
  v_cmp_eq_u32 vcc, -1, v167
  s_cbranch_vccz cA_va0_fw_d
  buffer_load_dword v167, v4, s[8:11], s20 offen sc1
  s_waitcnt vmcnt(4)
  v_cmp_eq_u32 vcc, -1, v168
  s_cbranch_vccz cA_va0_fw_d
  buffer_load_dword v168, v4, s[8:11], s20 offen sc1
  s_add_u32 s30, s30, 1
  s_cmp_lt_u32 s30, 400000
  s_cbranch_scc1 cA_va0_fw_l
  s_branch cA_abort
cA_va0_fw_d:
  s_waitcnt lgkmcnt(0)
  buffer_load_dwordx4 v[8:11], v5, s[8:11], s22 offen offset:0
  v_mov_b32 v36, 0
  v_mov_b32 v37, 0
  v_mov_b32 v38, 0
  buffer_load_dwordx4 v[12:15], v5, s[8:11], s22 offen offset:1024
  v_mov_b32 v39, 0
  v_mov_b32 v40, 0
  v_mov_b32 v41, 0
  buffer_load_dwordx4 v[16:19], v5, s[8:11], s22 offen offset:2048
  v_mov_b32 v42, 0
  v_mov_b32 v43, 0
  v_mov_b32 v44, 0
  buffer_load_dwordx4 v[20:23], v5, s[8:11], s22 offen offset:3072
  v_mov_b32 v45, 0
  v_mov_b32 v46, 0
  v_mov_b32 v47, 0
  buffer_load_dwordx4 v[24:27], v5, s[8:11], s34 offen offset:0
  v_mov_b32 v48, 0
  v_mov_b32 v49, 0
  v_mov_b32 v50, 0
  buffer_load_dwordx4 v[28:31], v5, s[8:11], s34 offen offset:1024
  v_mov_b32 v51, 0
  v_mov_b32 v52, 0
  v_mov_b32 v53, 0
  buffer_load_dwordx4 v[32:35], v5, s[8:11], s34 offen offset:2048
  v_mov_b32 v54, 0
  v_mov_b32 v55, 0
  v_mov_b32 v56, 0
  buffer_load_dwordx4 v[144:147], v5, s[8:11], s34 offen offset:3072
  v_mov_b32 v57, 0
  v_mov_b32 v58, 0
  v_mov_b32 v59, 0
  buffer_load_dwordx4 v[148:151], v2, s[8:11], s36 offen offset:0
  buffer_load_dwordx4 v[152:155], v2, s[8:11], s36 offen offset:1024
  s_barrier
  ds_read_b128 v[64:67], v2 offset:0
  ds_read_b128 v[68:71], v2 offset:1024
  ds_read_b128 v[72:75], v2 offset:2048
  ds_read_b128 v[76:79], v2 offset:3072
  s_waitcnt vmcnt(9)
  v_smfmac_f32_16x16x64_bf16 v[156:159], v[8:11], v[80:87], v0
  s_waitcnt vmcnt(8)
  v_smfmac_f32_16x16x64_bf16 v[156:159], v[12:15], v[88:95], v0
  s_waitcnt vmcnt(7)
  v_smfmac_f32_16x16x64_bf16 v[156:159], v[16:19], v[96:103], v0
  s_waitcnt vmcnt(6)
  v_smfmac_f32_16x16x64_bf16 v[156:159], v[20:23], v[104:111], v0
  s_waitcnt vmcnt(5)
  v_smfmac_f32_16x16x64_bf16 v[156:159], v[24:27], v[112:119], v0
  s_mov_b32 exec_hi, 0
  buffer_store_dword v2, v7, s[8:11], s21 offen
  s_mov_b64 exec, -1
  s_waitcnt vmcnt(5)
  v_smfmac_f32_16x16x64_bf16 v[156:159], v[28:31], v[120:127], v0
  s_waitcnt vmcnt(4)
  v_smfmac_f32_16x16x64_bf16 v[156:159], v[32:35], v[128:135], v0
  s_waitcnt vmcnt(3)
  v_smfmac_f32_16x16x64_bf16 v[156:159], v[144:147], v[136:143], v0
  s_waitcnt vmcnt(2) lgkmcnt(0)
  v_smfmac_f32_16x16x64_bf16 v[156:159], v[148:151], v[64:71], v0
  s_waitcnt vmcnt(1)
  v_smfmac_f32_16x16x64_bf16 v[156:159], v[152:155], v[72:79], v0
cA_va0_ep:
  s_nop 7
  v_add_f32 v160, v156, v157
  v_add_f32 v161, v158, v159
  v_cmp_u_f32 vcc, v160, v161
  v_mov_b32_dpp v162, v160 row_ror:8 row_mask:0xf bank_mask:0xf
  v_mov_b32_dpp v160, v161 row_ror:8 row_mask:0xf bank_mask:0xc
  s_cbranch_vccnz cA_va0_rp
  v_mov_b32_dpp v161, v162 quad_perm:[0,1,2,3] row_mask:0xf bank_mask:0x3
  v_cvt_pk_bf16_f32 v160, v160, v161
cA_va0_pc:
  buffer_store_dword v160, v1, s[8:11], s21 offen
  s_cmp_lg_u32 s19, 62
  s_cbranch_scc1 cA_va0_nl
  s_mov_b32 s22, 88519680
  buffer_store_dword v160, v1, s[8:11], s22 offen sc1
  s_mov_b64 exec, -1
  s_branch cA_done
cA_va0_nl:
  s_mov_b64 exec, -1
  s_add_u32 s25, s25, 28672
  s_add_u32 s19, s19, 1
  s_mov_b32 s20, s21
  s_branch cA_va0_loop
cA_va0_last:
  s_waitcnt lgkmcnt(0)
  s_barrier
  s_branch cA_done
cA_va0_rp:
  s_cmp_eq_u32 s37, 0
  s_cbranch_scc1 cA_va0_rv
  v_mov_b32_dpp v161, v162 quad_perm:[0,1,2,3] row_mask:0xf bank_mask:0x3
  v_cvt_pk_bf16_f32 v160, v160, v161
  v_min_u32 v160, -2, v160
  s_branch cA_va0_pc
cA_va0_rv:
  buffer_load_dwordx4 v[8:11], v5, s[8:11], s22 offen offset:0 sc1
  buffer_load_dwordx4 v[12:15], v5, s[8:11], s22 offen offset:1024 sc1
  buffer_load_dwordx4 v[16:19], v5, s[8:11], s22 offen offset:2048 sc1
  buffer_load_dwordx4 v[20:23], v5, s[8:11], s22 offen offset:3072 sc1
  buffer_load_dwordx4 v[24:27], v5, s[8:11], s34 offen offset:0 sc1
  buffer_load_dwordx4 v[28:31], v5, s[8:11], s34 offen offset:1024 sc1
  buffer_load_dwordx4 v[32:35], v5, s[8:11], s34 offen offset:2048 sc1
  buffer_load_dwordx4 v[144:147], v5, s[8:11], s34 offen offset:3072 sc1
  buffer_load_dwordx4 v[148:151], v2, s[8:11], s36 offen offset:0 sc1
  buffer_load_dwordx4 v[152:155], v2, s[8:11], s36 offen offset:1024 sc1
  s_waitcnt vmcnt(0)
  v_max3_u32 v63, v8, v9, v10
  v_max3_u32 v63, v63, v11, v12
  v_max3_u32 v63, v63, v13, v14
  v_max3_u32 v63, v63, v15, v16
  v_max3_u32 v63, v63, v17, v18
  v_max3_u32 v63, v63, v19, v20
  v_max3_u32 v63, v63, v21, v22
  v_max3_u32 v63, v63, v23, v24
  v_max3_u32 v63, v63, v25, v26
  v_max3_u32 v63, v63, v27, v28
  v_max3_u32 v63, v63, v29, v30
  v_max3_u32 v63, v63, v31, v32
  v_max3_u32 v63, v63, v33, v34
  v_max3_u32 v63, v63, v35, v144
  v_max3_u32 v63, v63, v145, v146
  v_max3_u32 v63, v63, v147, v148
  v_max3_u32 v63, v63, v149, v150
  v_max3_u32 v63, v63, v151, v152
  v_max3_u32 v63, v63, v153, v154
  v_max_u32 v63, v63, v155
  v_cmp_eq_u32 vcc, -1, v63
  s_cbranch_vccz cA_va0_rk
  s_add_u32 s30, s30, 1
  s_cmp_lt_u32 s30, 400000
  s_cbranch_scc1 cA_va0_rv
  s_branch cA_abort
cA_va0_rk:
  s_mov_b32 s37, 1
  s_add_u32 s31, s31, 0x10000
  v_mov_b32 v156, 0
  v_mov_b32 v157, 0
  v_mov_b32 v158, 0
  v_mov_b32 v159, 0
  s_nop 1
  v_smfmac_f32_16x16x64_bf16 v[156:159], v[8:11], v[80:87], v0
  v_smfmac_f32_16x16x64_bf16 v[156:159], v[12:15], v[88:95], v0
  v_smfmac_f32_16x16x64_bf16 v[156:159], v[16:19], v[96:103], v0
  v_smfmac_f32_16x16x64_bf16 v[156:159], v[20:23], v[104:111], v0
  v_smfmac_f32_16x16x64_bf16 v[156:159], v[24:27], v[112:119], v0
  v_smfmac_f32_16x16x64_bf16 v[156:159], v[28:31], v[120:127], v0
  v_smfmac_f32_16x16x64_bf16 v[156:159], v[32:35], v[128:135], v0
  v_smfmac_f32_16x16x64_bf16 v[156:159], v[144:147], v[136:143], v0
  v_smfmac_f32_16x16x64_bf16 v[156:159], v[148:151], v[64:71], v0
  v_smfmac_f32_16x16x64_bf16 v[156:159], v[152:155], v[72:79], v0
  s_nop 7
  s_branch cA_va0_ep
.p2align 6

cA_va1_loop:
  s_add_u32 s23, s20, 4096
  s_add_u32 s21, s20, 25600
  s_mov_b32 s30, 0
  s_cmp_lg_u32 s19, s38
  s_cbranch_scc1 cA_va1_vok
  s_branch cA_va1_voc
cA_va1_vow:
  buffer_load_dword v175, off, s[8:11], s35 sc1
  s_waitcnt vmcnt(0)
cA_va1_voc:
  v_readfirstlane_b32 s22, v175
  s_cmp_eq_u32 s22, 56
  s_cbranch_scc1 cA_va1_vod
  s_sleep 1
  s_add_u32 s30, s30, 1
  s_cmp_lt_u32 s30, 400000
  s_cbranch_scc1 cA_va1_vow
  s_branch cA_abort
cA_va1_vod:
  s_add_u32 s35, s35, 2048
  s_add_u32 s38, s19, 8
  s_and_b32 s38, s38, -8
  s_cmp_eq_u32 s19, 0
  s_cselect_b32 s38, 4, s38
cA_va1_vok:
  s_cmp_eq_u32 s19, 63
  s_cbranch_scc1 cA_done
  s_barrier
  s_add_u32 s22, s25, 0
  buffer_load_dwordx4 v[80:83], v6, s[8:11], s22 offen offset:0 sc1
  buffer_load_dwordx4 v[84:87], v6, s[8:11], s22 offen offset:1792 sc1
  s_add_u32 s22, s25, 3584
  buffer_load_dwordx4 v[88:91], v6, s[8:11], s22 offen offset:0 sc1
  buffer_load_dwordx4 v[92:95], v6, s[8:11], s22 offen offset:1792 sc1
  s_add_u32 s22, s25, 7168
  buffer_load_dwordx4 v[96:99], v6, s[8:11], s22 offen offset:0 sc1
  buffer_load_dwordx4 v[100:103], v6, s[8:11], s22 offen offset:1792 sc1
  s_add_u32 s22, s25, 10752
  buffer_load_dwordx4 v[104:107], v6, s[8:11], s22 offen offset:0 sc1
  buffer_load_dwordx4 v[108:111], v6, s[8:11], s22 offen offset:1792 sc1
  s_add_u32 s22, s25, 14336
  buffer_load_dwordx4 v[112:115], v6, s[8:11], s22 offen offset:0 sc1
  buffer_load_dwordx4 v[116:119], v6, s[8:11], s22 offen offset:1792 sc1
  s_add_u32 s22, s25, 17920
  buffer_load_dwordx4 v[120:123], v6, s[8:11], s22 offen offset:0 sc1
  buffer_load_dwordx4 v[124:127], v6, s[8:11], s22 offen offset:1792 sc1
  s_add_u32 s22, s25, 21504
  buffer_load_dwordx4 v[128:131], v6, s[8:11], s22 offen offset:0 sc1
  buffer_load_dwordx4 v[132:135], v6, s[8:11], s22 offen offset:1792 sc1
  s_add_u32 s22, s25, 25088
  buffer_load_dwordx4 v[136:139], v6, s[8:11], s22 offen offset:0 sc1
  buffer_load_dwordx4 v[140:143], v6, s[8:11], s22 offen offset:1792 sc1
  buffer_load_dword v175, off, s[8:11], s35 sc1
  s_barrier
  ds_read_b128 v[8:11], v2 offset:8192
  ds_read_b128 v[12:15], v2 offset:9216
  ds_read_b128 v[16:19], v2 offset:10240
  ds_read_b128 v[20:23], v2 offset:11264
  ds_read_b128 v[24:27], v2 offset:12288
  ds_read_b128 v[28:31], v2 offset:13312
  ds_read_b128 v[32:35], v2 offset:14336
  s_waitcnt lgkmcnt(0)
  v_smfmac_f32_16x16x64_bf16 v[36:39], v[8:11], a[0:7], v3
  v_smfmac_f32_16x16x64_bf16 v[36:39], v[12:15], a[8:15], v3
  v_smfmac_f32_16x16x64_bf16 v[36:39], v[16:19], a[16:23], v3
  v_smfmac_f32_16x16x64_bf16 v[36:39], v[20:23], a[24:31], v3
  v_smfmac_f32_16x16x64_bf16 v[36:39], v[24:27], a[32:39], v3
  v_smfmac_f32_16x16x64_bf16 v[36:39], v[28:31], a[40:47], v3
  v_smfmac_f32_16x16x64_bf16 v[36:39], v[32:35], a[48:55], v3
  v_smfmac_f32_16x16x64_bf16 v[40:43], v[8:11], a[56:63], v3
  v_smfmac_f32_16x16x64_bf16 v[40:43], v[12:15], a[64:71], v3
  v_smfmac_f32_16x16x64_bf16 v[40:43], v[16:19], a[72:79], v3
  v_smfmac_f32_16x16x64_bf16 v[40:43], v[20:23], a[80:87], v3
  v_smfmac_f32_16x16x64_bf16 v[40:43], v[24:27], a[88:95], v3
  v_smfmac_f32_16x16x64_bf16 v[40:43], v[28:31], a[96:103], v3
  v_smfmac_f32_16x16x64_bf16 v[40:43], v[32:35], a[104:111], v3
  v_smfmac_f32_16x16x64_bf16 v[44:47], v[8:11], a[112:119], v3
  v_smfmac_f32_16x16x64_bf16 v[44:47], v[12:15], a[120:127], v3
  v_smfmac_f32_16x16x64_bf16 v[44:47], v[16:19], a[128:135], v3
  v_smfmac_f32_16x16x64_bf16 v[44:47], v[20:23], a[136:143], v3
  v_permlane32_swap_b32 v36, v40
  v_smfmac_f32_16x16x64_bf16 v[44:47], v[24:27], a[144:151], v3
  v_permlane32_swap_b32 v37, v41
  v_smfmac_f32_16x16x64_bf16 v[44:47], v[28:31], a[152:159], v3
  v_permlane32_swap_b32 v38, v42
  v_smfmac_f32_16x16x64_bf16 v[44:47], v[32:35], a[160:167], v3
  v_permlane32_swap_b32 v39, v43
  v_smfmac_f32_16x16x64_bf16 v[48:51], v[8:11], a[168:175], v3
  v_add_f32 v36, v36, v40
  v_smfmac_f32_16x16x64_bf16 v[48:51], v[12:15], a[176:183], v3
  v_add_f32 v37, v37, v41
  v_smfmac_f32_16x16x64_bf16 v[48:51], v[16:19], a[184:191], v3
  v_add_f32 v38, v38, v42
  v_smfmac_f32_16x16x64_bf16 v[48:51], v[20:23], a[192:199], v3
  v_add_f32 v39, v39, v43
  v_smfmac_f32_16x16x64_bf16 v[48:51], v[24:27], a[200:207], v3
  v_cvt_pk_bf16_f32 v40, v36, v37
  v_smfmac_f32_16x16x64_bf16 v[48:51], v[28:31], a[208:215], v3
  v_cvt_pk_bf16_f32 v41, v38, v39
  v_smfmac_f32_16x16x64_bf16 v[48:51], v[32:35], a[216:223], v3
  ds_write2_b32 v60, v40, v41 offset0:0 offset1:2
  v_smfmac_f32_16x16x64_bf16 v[52:55], v[8:11], a[224:231], v3
  v_smfmac_f32_16x16x64_bf16 v[52:55], v[12:15], a[232:239], v3
  v_smfmac_f32_16x16x64_bf16 v[52:55], v[16:19], a[240:247], v3
  v_smfmac_f32_16x16x64_bf16 v[52:55], v[20:23], a[248:255], v3
  v_permlane32_swap_b32 v44, v48
  v_smfmac_f32_16x16x64_bf16 v[52:55], v[24:27], v[176:183], v3
  v_permlane32_swap_b32 v45, v49
  v_smfmac_f32_16x16x64_bf16 v[52:55], v[28:31], v[184:191], v3
  v_permlane32_swap_b32 v46, v50
  v_smfmac_f32_16x16x64_bf16 v[52:55], v[32:35], v[192:199], v3
  v_permlane32_swap_b32 v47, v51
  v_smfmac_f32_16x16x64_bf16 v[56:59], v[8:11], v[200:207], v3
  v_add_f32 v44, v44, v48
  v_smfmac_f32_16x16x64_bf16 v[56:59], v[12:15], v[208:215], v3
  v_add_f32 v45, v45, v49
  v_smfmac_f32_16x16x64_bf16 v[56:59], v[16:19], v[216:223], v3
  v_add_f32 v46, v46, v50
  v_smfmac_f32_16x16x64_bf16 v[56:59], v[20:23], v[224:231], v3
  v_add_f32 v47, v47, v51
  v_smfmac_f32_16x16x64_bf16 v[56:59], v[24:27], v[232:239], v3
  v_cvt_pk_bf16_f32 v48, v44, v45
  v_smfmac_f32_16x16x64_bf16 v[56:59], v[28:31], v[240:247], v3
  v_cvt_pk_bf16_f32 v49, v46, v47
  v_smfmac_f32_16x16x64_bf16 v[56:59], v[32:35], v[248:255], v3
  ds_write2_b32 v61, v48, v49 offset0:0 offset1:2
  s_nop 6
  v_permlane32_swap_b32 v52, v56
  v_permlane32_swap_b32 v53, v57
  v_permlane32_swap_b32 v54, v58
  v_permlane32_swap_b32 v55, v59
  v_add_f32 v52, v52, v56
  v_add_f32 v53, v53, v57
  v_add_f32 v54, v54, v58
  v_add_f32 v55, v55, v59
  v_cvt_pk_bf16_f32 v56, v52, v53
  v_cvt_pk_bf16_f32 v57, v54, v55
  ds_write2_b32 v62, v56, v57 offset0:0 offset1:2
  s_cmp_eq_u32 s19, 63
  s_cbranch_scc1 cA_va1_last
  s_add_u32 s22, s20, 9216
  s_add_u32 s34, s20, 13312
  s_add_u32 s36, s20, 7168
  s_mov_b32 s37, 0
  v_mov_b32 v156, 0
  v_mov_b32 v157, 0
  v_mov_b32 v158, 0
  v_mov_b32 v159, 0
  buffer_load_dword v164, v4, s[8:11], s20 offen sc1
  s_nop 7
  buffer_load_dword v165, v4, s[8:11], s20 offen sc1
  s_nop 7
  buffer_load_dword v166, v4, s[8:11], s20 offen sc1
  s_nop 7
  buffer_load_dword v167, v4, s[8:11], s20 offen sc1
  s_nop 7
  buffer_load_dword v168, v4, s[8:11], s20 offen sc1
cA_va1_fw_l:
  s_waitcnt vmcnt(4)
  v_cmp_eq_u32 vcc, -1, v164
  s_cbranch_vccz cA_va1_fw_d
  buffer_load_dword v164, v4, s[8:11], s20 offen sc1
  s_waitcnt vmcnt(4)
  v_cmp_eq_u32 vcc, -1, v165
  s_cbranch_vccz cA_va1_fw_d
  buffer_load_dword v165, v4, s[8:11], s20 offen sc1
  s_waitcnt vmcnt(4)
  v_cmp_eq_u32 vcc, -1, v166
  s_cbranch_vccz cA_va1_fw_d
  buffer_load_dword v166, v4, s[8:11], s20 offen sc1
  s_waitcnt vmcnt(4)
  v_cmp_eq_u32 vcc, -1, v167
  s_cbranch_vccz cA_va1_fw_d
  buffer_load_dword v167, v4, s[8:11], s20 offen sc1
  s_waitcnt vmcnt(4)
  v_cmp_eq_u32 vcc, -1, v168
  s_cbranch_vccz cA_va1_fw_d
  buffer_load_dword v168, v4, s[8:11], s20 offen sc1
  s_add_u32 s30, s30, 1
  s_cmp_lt_u32 s30, 400000
  s_cbranch_scc1 cA_va1_fw_l
  s_branch cA_abort
cA_va1_fw_d:
  s_waitcnt lgkmcnt(0)
  buffer_load_dwordx4 v[8:11], v5, s[8:11], s22 offen offset:0
  v_mov_b32 v36, 0
  v_mov_b32 v37, 0
  v_mov_b32 v38, 0
  buffer_load_dwordx4 v[12:15], v5, s[8:11], s22 offen offset:1024
  v_mov_b32 v39, 0
  v_mov_b32 v40, 0
  v_mov_b32 v41, 0
  buffer_load_dwordx4 v[16:19], v5, s[8:11], s22 offen offset:2048
  v_mov_b32 v42, 0
  v_mov_b32 v43, 0
  v_mov_b32 v44, 0
  buffer_load_dwordx4 v[20:23], v5, s[8:11], s22 offen offset:3072
  v_mov_b32 v45, 0
  v_mov_b32 v46, 0
  v_mov_b32 v47, 0
  buffer_load_dwordx4 v[24:27], v5, s[8:11], s34 offen offset:0
  v_mov_b32 v48, 0
  v_mov_b32 v49, 0
  v_mov_b32 v50, 0
  buffer_load_dwordx4 v[28:31], v5, s[8:11], s34 offen offset:1024
  v_mov_b32 v51, 0
  v_mov_b32 v52, 0
  v_mov_b32 v53, 0
  buffer_load_dwordx4 v[32:35], v5, s[8:11], s34 offen offset:2048
  v_mov_b32 v54, 0
  v_mov_b32 v55, 0
  v_mov_b32 v56, 0
  buffer_load_dwordx4 v[144:147], v5, s[8:11], s34 offen offset:3072
  v_mov_b32 v57, 0
  v_mov_b32 v58, 0
  v_mov_b32 v59, 0
  buffer_load_dwordx4 v[148:151], v2, s[8:11], s36 offen offset:0
  buffer_load_dwordx4 v[152:155], v2, s[8:11], s36 offen offset:1024
  s_barrier
  ds_read_b128 v[64:67], v2 offset:4096
  ds_read_b128 v[68:71], v2 offset:5120
  ds_read_b128 v[72:75], v2 offset:6144
  ds_read_b128 v[76:79], v2 offset:7168
  s_waitcnt vmcnt(9)
  v_smfmac_f32_16x16x64_bf16 v[156:159], v[8:11], v[80:87], v0
  s_waitcnt vmcnt(8)
  v_smfmac_f32_16x16x64_bf16 v[156:159], v[12:15], v[88:95], v0
  s_waitcnt vmcnt(7)
  v_smfmac_f32_16x16x64_bf16 v[156:159], v[16:19], v[96:103], v0
  s_waitcnt vmcnt(6)
  v_smfmac_f32_16x16x64_bf16 v[156:159], v[20:23], v[104:111], v0
  s_waitcnt vmcnt(5)
  v_smfmac_f32_16x16x64_bf16 v[156:159], v[24:27], v[112:119], v0
  s_mov_b32 exec_hi, 0
  buffer_store_dword v2, v7, s[8:11], s21 offen
  s_mov_b64 exec, -1
  s_waitcnt vmcnt(5)
  v_smfmac_f32_16x16x64_bf16 v[156:159], v[28:31], v[120:127], v0
  s_waitcnt vmcnt(4)
  v_smfmac_f32_16x16x64_bf16 v[156:159], v[32:35], v[128:135], v0
  s_waitcnt vmcnt(3)
  v_smfmac_f32_16x16x64_bf16 v[156:159], v[144:147], v[136:143], v0
  s_waitcnt vmcnt(2) lgkmcnt(0)
  v_smfmac_f32_16x16x64_bf16 v[156:159], v[148:151], v[64:71], v0
  s_waitcnt vmcnt(1)
  v_smfmac_f32_16x16x64_bf16 v[156:159], v[152:155], v[72:79], v0
cA_va1_ep:
  s_nop 7
  v_add_f32 v160, v156, v157
  v_add_f32 v161, v158, v159
  v_cmp_u_f32 vcc, v160, v161
  v_mov_b32_dpp v162, v160 row_ror:8 row_mask:0xf bank_mask:0xf
  v_mov_b32_dpp v160, v161 row_ror:8 row_mask:0xf bank_mask:0xc
  s_cbranch_vccnz cA_va1_rp
  v_mov_b32_dpp v161, v162 quad_perm:[0,1,2,3] row_mask:0xf bank_mask:0x3
  v_cvt_pk_bf16_f32 v160, v160, v161
cA_va1_pc:
  s_mov_b64 exec, s[26:27]
  buffer_store_dword v160, v1, s[8:11], s21 offen
  s_cmp_lg_u32 s19, 62
  s_cbranch_scc1 cA_va1_nl
  s_mov_b32 s22, 88519680
  buffer_store_dword v160, v1, s[8:11], s22 offen sc1
  s_mov_b64 exec, -1
  s_branch cA_done
cA_va1_nl:
  s_mov_b64 exec, -1
  s_add_u32 s25, s25, 28672
  s_add_u32 s19, s19, 1
  s_mov_b32 s20, s21
  s_branch cA_va1_loop
cA_va1_last:
  s_waitcnt lgkmcnt(0)
  s_barrier
  s_branch cA_done
cA_va1_rp:
  s_cmp_eq_u32 s37, 0
  s_cbranch_scc1 cA_va1_rv
  v_mov_b32_dpp v161, v162 quad_perm:[0,1,2,3] row_mask:0xf bank_mask:0x3
  v_cvt_pk_bf16_f32 v160, v160, v161
  v_min_u32 v160, -2, v160
  s_branch cA_va1_pc
cA_va1_rv:
  buffer_load_dwordx4 v[8:11], v5, s[8:11], s22 offen offset:0 sc1
  buffer_load_dwordx4 v[12:15], v5, s[8:11], s22 offen offset:1024 sc1
  buffer_load_dwordx4 v[16:19], v5, s[8:11], s22 offen offset:2048 sc1
  buffer_load_dwordx4 v[20:23], v5, s[8:11], s22 offen offset:3072 sc1
  buffer_load_dwordx4 v[24:27], v5, s[8:11], s34 offen offset:0 sc1
  buffer_load_dwordx4 v[28:31], v5, s[8:11], s34 offen offset:1024 sc1
  buffer_load_dwordx4 v[32:35], v5, s[8:11], s34 offen offset:2048 sc1
  buffer_load_dwordx4 v[144:147], v5, s[8:11], s34 offen offset:3072 sc1
  buffer_load_dwordx4 v[148:151], v2, s[8:11], s36 offen offset:0 sc1
  buffer_load_dwordx4 v[152:155], v2, s[8:11], s36 offen offset:1024 sc1
  s_waitcnt vmcnt(0)
  v_max3_u32 v63, v8, v9, v10
  v_max3_u32 v63, v63, v11, v12
  v_max3_u32 v63, v63, v13, v14
  v_max3_u32 v63, v63, v15, v16
  v_max3_u32 v63, v63, v17, v18
  v_max3_u32 v63, v63, v19, v20
  v_max3_u32 v63, v63, v21, v22
  v_max3_u32 v63, v63, v23, v24
  v_max3_u32 v63, v63, v25, v26
  v_max3_u32 v63, v63, v27, v28
  v_max3_u32 v63, v63, v29, v30
  v_max3_u32 v63, v63, v31, v32
  v_max3_u32 v63, v63, v33, v34
  v_max3_u32 v63, v63, v35, v144
  v_max3_u32 v63, v63, v145, v146
  v_max3_u32 v63, v63, v147, v148
  v_max3_u32 v63, v63, v149, v150
  v_max3_u32 v63, v63, v151, v152
  v_max3_u32 v63, v63, v153, v154
  v_max_u32 v63, v63, v155
  v_cmp_eq_u32 vcc, -1, v63
  s_cbranch_vccz cA_va1_rk
  s_add_u32 s30, s30, 1
  s_cmp_lt_u32 s30, 400000
  s_cbranch_scc1 cA_va1_rv
  s_branch cA_abort
cA_va1_rk:
  s_mov_b32 s37, 1
  s_add_u32 s31, s31, 0x10000
  v_mov_b32 v156, 0
  v_mov_b32 v157, 0
  v_mov_b32 v158, 0
  v_mov_b32 v159, 0
  s_nop 1
  v_smfmac_f32_16x16x64_bf16 v[156:159], v[8:11], v[80:87], v0
  v_smfmac_f32_16x16x64_bf16 v[156:159], v[12:15], v[88:95], v0
  v_smfmac_f32_16x16x64_bf16 v[156:159], v[16:19], v[96:103], v0
  v_smfmac_f32_16x16x64_bf16 v[156:159], v[20:23], v[104:111], v0
  v_smfmac_f32_16x16x64_bf16 v[156:159], v[24:27], v[112:119], v0
  v_smfmac_f32_16x16x64_bf16 v[156:159], v[28:31], v[120:127], v0
  v_smfmac_f32_16x16x64_bf16 v[156:159], v[32:35], v[128:135], v0
  v_smfmac_f32_16x16x64_bf16 v[156:159], v[144:147], v[136:143], v0
  v_smfmac_f32_16x16x64_bf16 v[156:159], v[148:151], v[64:71], v0
  v_smfmac_f32_16x16x64_bf16 v[156:159], v[152:155], v[72:79], v0
  s_nop 7
  s_branch cA_va1_ep
.p2align 6

cA_va2_loop:
  s_add_u32 s23, s20, 4096
  s_add_u32 s21, s20, 25600
  v_mov_b32 v36, 0
  v_mov_b32 v37, 0
  v_mov_b32 v38, 0
  v_mov_b32 v39, 0
  v_mov_b32 v40, 0
  v_mov_b32 v41, 0
  v_mov_b32 v42, 0
  v_mov_b32 v43, 0
  v_mov_b32 v44, 0
  v_mov_b32 v45, 0
  v_mov_b32 v46, 0
  v_mov_b32 v47, 0
  v_mov_b32 v48, 0
  v_mov_b32 v49, 0
  v_mov_b32 v50, 0
  v_mov_b32 v51, 0
  v_mov_b32 v52, 0
  v_mov_b32 v53, 0
  v_mov_b32 v54, 0
  v_mov_b32 v55, 0
  v_mov_b32 v56, 0
  v_mov_b32 v57, 0
  v_mov_b32 v58, 0
  v_mov_b32 v59, 0
  v_mov_b32 v60, 0
  v_mov_b32 v61, 0
  v_mov_b32 v62, 0
  v_mov_b32 v63, 0
  v_mov_b32 v64, 0
  v_mov_b32 v65, 0
  v_mov_b32 v66, 0
  v_mov_b32 v67, 0
  s_mov_b32 s30, 0
  buffer_load_dword v76, v119, s[8:11], s20 offen sc1
  buffer_load_dword v77, v119, s[8:11], s20 offen sc1
  buffer_load_dword v78, v119, s[8:11], s20 offen sc1
cA_va2_fp_l:
  s_waitcnt vmcnt(2)
  v_cmp_eq_u32 vcc, -1, v76
  s_cbranch_vccz cA_va2_fp_d
  buffer_load_dword v76, v119, s[8:11], s20 offen sc1
  s_waitcnt vmcnt(2)
  v_cmp_eq_u32 vcc, -1, v77
  s_cbranch_vccz cA_va2_fp_d
  buffer_load_dword v77, v119, s[8:11], s20 offen sc1
  s_waitcnt vmcnt(2)
  v_cmp_eq_u32 vcc, -1, v78
  s_cbranch_vccz cA_va2_fp_d
  buffer_load_dword v78, v119, s[8:11], s20 offen sc1
  s_add_u32 s30, s30, 1
  s_cmp_lt_u32 s30, 400000
  s_cbranch_scc1 cA_va2_fp_l
  s_branch cA_abort
cA_va2_fp_d:
  buffer_load_dwordx4 v[8:11], v2, s[8:11], s20 offen offset:0 sc1
  buffer_load_dwordx4 v[12:15], v2, s[8:11], s20 offen offset:1024 sc1
  buffer_load_dwordx4 v[16:19], v2, s[8:11], s20 offen offset:2048 sc1
  buffer_load_dwordx4 v[20:23], v2, s[8:11], s20 offen offset:3072 sc1
  s_barrier
cA_va2_ld:
  s_waitcnt vmcnt(0)
  v_max3_u32 v84, v8, v9, v10
  v_max3_u32 v84, v84, v11, v12
  v_max3_u32 v84, v84, v13, v14
  v_max3_u32 v84, v84, v15, v16
  v_max3_u32 v84, v84, v17, v18
  v_max3_u32 v84, v84, v19, v20
  v_max3_u32 v84, v84, v21, v22
  v_max_u32 v84, v84, v23
  v_cmp_eq_u32 vcc, -1, v84
  ds_write_b128 v2, v[8:11] offset:8192
  ds_write_b128 v2, v[12:15] offset:9216
  ds_write_b128 v2, v[16:19] offset:10240
  ds_write_b128 v2, v[20:23] offset:11264
  s_cbranch_vccnz cA_va2_retry
  s_waitcnt lgkmcnt(0)
  s_barrier
  ds_read_b128 v[24:27], v2 offset:12288
  ds_read_b128 v[28:31], v2 offset:13312
  ds_read_b128 v[32:35], v2 offset:14336
  ds_read_b128 v[92:95], v0
  s_waitcnt lgkmcnt(0)
  s_mov_b64 exec, s[26:27]
  buffer_store_dwordx4 v[92:95], v2, s[8:11], s36 offen sc1
  s_mov_b64 exec, -1
  s_add_u32 s36, s36, 7168
  s_cmp_eq_u32 s19, 63
  s_cbranch_scc1 cA_done
  ds_read_b128 v[76:79], v1 offset:0
  ds_read_b128 v[80:83], v1 offset:1024
  ds_read_b128 v[84:87], v1 offset:2048
  ds_read_b128 v[88:91], v1 offset:3072
  ds_read_b128 v[92:95], v1 offset:4096
  ds_read_b128 v[96:99], v1 offset:5120
  v_smfmac_f32_16x16x64_bf16 v[60:63], v[8:11], v[200:207], v3
  v_smfmac_f32_16x16x64_bf16 v[60:63], v[12:15], v[208:215], v3
  s_waitcnt lgkmcnt(4)
  v_smfmac_f32_16x16x64_bf16 v[64:67], v[8:11], v[76:83], v3
  ds_read_b128 v[76:79], v1 offset:6144
  ds_read_b128 v[80:83], v1 offset:7168
  v_smfmac_f32_16x16x64_bf16 v[60:63], v[16:19], v[216:223], v3
  v_smfmac_f32_16x16x64_bf16 v[60:63], v[20:23], v[224:231], v3
  s_waitcnt lgkmcnt(4)
  v_smfmac_f32_16x16x64_bf16 v[64:67], v[12:15], v[84:91], v3
  ds_read_b128 v[84:87], v1 offset:8192
  ds_read_b128 v[88:91], v1 offset:9216
  v_smfmac_f32_16x16x64_bf16 v[60:63], v[24:27], v[232:239], v3
  v_smfmac_f32_16x16x64_bf16 v[60:63], v[28:31], v[240:247], v3
  s_waitcnt lgkmcnt(4)
  v_smfmac_f32_16x16x64_bf16 v[64:67], v[16:19], v[92:99], v3
  ds_read_b128 v[92:95], v1 offset:10240
  ds_read_b128 v[96:99], v1 offset:11264
  v_smfmac_f32_16x16x64_bf16 v[60:63], v[32:35], v[248:255], v3
  v_smfmac_f32_16x16x64_bf16 v[36:39], v[8:11], a[0:7], v3
  s_waitcnt lgkmcnt(4)
  v_smfmac_f32_16x16x64_bf16 v[64:67], v[20:23], v[76:83], v3
  ds_read_b128 v[76:79], v1 offset:12288
  ds_read_b128 v[80:83], v1 offset:13312
  v_smfmac_f32_16x16x64_bf16 v[36:39], v[12:15], a[8:15], v3
  v_smfmac_f32_16x16x64_bf16 v[36:39], v[16:19], a[16:23], v3
  s_waitcnt lgkmcnt(4)
  v_smfmac_f32_16x16x64_bf16 v[64:67], v[24:27], v[84:91], v3
  v_smfmac_f32_16x16x64_bf16 v[36:39], v[20:23], a[24:31], v3
  v_smfmac_f32_16x16x64_bf16 v[36:39], v[24:27], a[32:39], v3
  s_waitcnt lgkmcnt(2)
  v_smfmac_f32_16x16x64_bf16 v[64:67], v[28:31], v[92:99], v3
  v_smfmac_f32_16x16x64_bf16 v[36:39], v[28:31], a[40:47], v3
  v_smfmac_f32_16x16x64_bf16 v[36:39], v[32:35], a[48:55], v3
  s_waitcnt lgkmcnt(0)
  v_smfmac_f32_16x16x64_bf16 v[64:67], v[32:35], v[76:83], v3
  v_smfmac_f32_16x16x64_bf16 v[40:43], v[8:11], a[56:63], v3
  v_smfmac_f32_16x16x64_bf16 v[40:43], v[12:15], a[64:71], v3
  v_smfmac_f32_16x16x64_bf16 v[40:43], v[16:19], a[72:79], v3
  v_smfmac_f32_16x16x64_bf16 v[40:43], v[20:23], a[80:87], v3
  v_permlane32_swap_b32 v60, v64
  v_smfmac_f32_16x16x64_bf16 v[40:43], v[24:27], a[88:95], v3
  v_permlane32_swap_b32 v61, v65
  v_smfmac_f32_16x16x64_bf16 v[40:43], v[28:31], a[96:103], v3
  v_permlane32_swap_b32 v62, v66
  v_smfmac_f32_16x16x64_bf16 v[40:43], v[32:35], a[104:111], v3
  v_permlane32_swap_b32 v63, v67
  v_smfmac_f32_16x16x64_bf16 v[44:47], v[8:11], a[112:119], v3
  v_smfmac_f32_16x16x64_bf16 v[44:47], v[12:15], a[120:127], v3
  v_smfmac_f32_16x16x64_bf16 v[44:47], v[16:19], a[128:135], v3
  v_smfmac_f32_16x16x64_bf16 v[44:47], v[20:23], a[136:143], v3
  v_add_f32 v60, v60, v64
  v_add_f32 v61, v61, v65
  v_smfmac_f32_16x16x64_bf16 v[44:47], v[24:27], a[144:151], v3
  v_add_f32 v62, v62, v66
  v_add_f32 v63, v63, v67
  v_smfmac_f32_16x16x64_bf16 v[44:47], v[28:31], a[152:159], v3
  v_cvt_pk_bf16_f32 v64, v60, v61
  v_cvt_pk_bf16_f32 v65, v62, v63
  v_smfmac_f32_16x16x64_bf16 v[44:47], v[32:35], a[160:167], v3
  ds_write2_b32 v115, v64, v65 offset0:0 offset1:2
  v_smfmac_f32_16x16x64_bf16 v[48:51], v[8:11], a[168:175], v3
  v_permlane32_swap_b32 v36, v40
  v_smfmac_f32_16x16x64_bf16 v[48:51], v[12:15], a[176:183], v3
  v_permlane32_swap_b32 v37, v41
  v_smfmac_f32_16x16x64_bf16 v[48:51], v[16:19], a[184:191], v3
  v_permlane32_swap_b32 v38, v42
  v_smfmac_f32_16x16x64_bf16 v[48:51], v[20:23], a[192:199], v3
  v_permlane32_swap_b32 v39, v43
  v_smfmac_f32_16x16x64_bf16 v[48:51], v[24:27], a[200:207], v3
  v_add_f32 v36, v36, v40
  v_smfmac_f32_16x16x64_bf16 v[48:51], v[28:31], a[208:215], v3
  v_add_f32 v37, v37, v41
  v_smfmac_f32_16x16x64_bf16 v[48:51], v[32:35], a[216:223], v3
  v_add_f32 v38, v38, v42
  v_smfmac_f32_16x16x64_bf16 v[52:55], v[8:11], a[224:231], v3
  v_smfmac_f32_16x16x64_bf16 v[52:55], v[12:15], a[232:239], v3
  v_smfmac_f32_16x16x64_bf16 v[52:55], v[16:19], a[240:247], v3
  v_smfmac_f32_16x16x64_bf16 v[52:55], v[20:23], a[248:255], v3
  v_add_f32 v39, v39, v43
  v_cvt_pk_bf16_f32 v40, v36, v37
  v_smfmac_f32_16x16x64_bf16 v[52:55], v[24:27], v[120:127], v3
  v_cvt_pk_bf16_f32 v41, v38, v39
  v_smfmac_f32_16x16x64_bf16 v[52:55], v[28:31], v[128:135], v3
  ds_write2_b32 v112, v40, v41 offset0:0 offset1:2
  v_smfmac_f32_16x16x64_bf16 v[52:55], v[32:35], v[136:143], v3
  v_permlane32_swap_b32 v44, v48
  v_smfmac_f32_16x16x64_bf16 v[56:59], v[8:11], v[144:151], v3
  v_permlane32_swap_b32 v45, v49
  v_smfmac_f32_16x16x64_bf16 v[56:59], v[12:15], v[152:159], v3
  v_permlane32_swap_b32 v46, v50
  v_smfmac_f32_16x16x64_bf16 v[56:59], v[16:19], v[160:167], v3
  v_permlane32_swap_b32 v47, v51
  v_smfmac_f32_16x16x64_bf16 v[56:59], v[20:23], v[168:175], v3
  v_add_f32 v44, v44, v48
  v_smfmac_f32_16x16x64_bf16 v[56:59], v[24:27], v[176:183], v3
  v_add_f32 v45, v45, v49
  v_smfmac_f32_16x16x64_bf16 v[56:59], v[28:31], v[184:191], v3
  v_add_f32 v46, v46, v50
  v_smfmac_f32_16x16x64_bf16 v[56:59], v[32:35], v[192:199], v3
  v_add_f32 v47, v47, v51
  v_cvt_pk_bf16_f32 v48, v44, v45
  v_cvt_pk_bf16_f32 v49, v46, v47
  ds_write2_b32 v113, v48, v49 offset0:0 offset1:2
  s_nop 3
  v_permlane32_swap_b32 v52, v56
  v_permlane32_swap_b32 v53, v57
  v_permlane32_swap_b32 v54, v58
  v_permlane32_swap_b32 v55, v59
  v_add_f32 v52, v52, v56
  v_add_f32 v53, v53, v57
  v_add_f32 v54, v54, v58
  v_add_f32 v55, v55, v59
  v_cvt_pk_bf16_f32 v56, v52, v53
  v_cvt_pk_bf16_f32 v57, v54, v55
  ds_write2_b32 v114, v56, v57 offset0:0 offset1:2
  s_waitcnt lgkmcnt(0)
  s_barrier
  s_cmp_eq_u32 s19, 62
  s_cbranch_scc1 cA_done
  s_waitcnt vmcnt(0) lgkmcnt(0)
  s_add_u32 s19, s19, 1
  s_mov_b32 s20, s21
  s_branch cA_va2_loop
cA_va2_retry:
  s_waitcnt lgkmcnt(0)
  buffer_load_dwordx4 v[8:11], v2, s[8:11], s20 offen offset:0 sc1
  buffer_load_dwordx4 v[12:15], v2, s[8:11], s20 offen offset:1024 sc1
  buffer_load_dwordx4 v[16:19], v2, s[8:11], s20 offen offset:2048 sc1
  buffer_load_dwordx4 v[20:23], v2, s[8:11], s20 offen offset:3072 sc1
  s_add_u32 s31, s31, 1
  s_add_u32 s30, s30, 1
  s_cmp_lt_u32 s30, 400000
  s_cbranch_scc1 cA_va2_ld
  s_branch cA_abort
cA_va2_last:
  s_waitcnt lgkmcnt(0)
  buffer_store_dwordx4 v[100:103], v2, s[8:11], s24 offen offset:0 sc1
  buffer_store_dwordx4 v[104:107], v2, s[8:11], s24 offen offset:1024 sc1
  buffer_store_dwordx4 v[108:111], v2, s[8:11], s24 offen offset:2048 sc1
  buffer_store_dwordx4 v[4:7], v2, s[8:11], s24 offen offset:3072 sc1
  s_add_u32 s24, s24, 8192
  s_waitcnt vmcnt(0)
  s_mov_b64 exec, 1
  buffer_store_dword v117, v2, s[8:11], s34 offen sc1
  s_mov_b64 exec, -1
  s_add_u32 s34, s34, 8
  s_mov_b64 exec, 1
  buffer_store_dword v117, v2, s[8:11], s34 offen sc1
  s_mov_b64 exec, -1
  s_add_u32 s34, s34, 8
  s_branch cA_done
.p2align 6

cA_va3_loop:
  s_add_u32 s23, s20, 4096
  s_add_u32 s21, s20, 25600
  v_mov_b32 v36, 0
  v_mov_b32 v37, 0
  v_mov_b32 v38, 0
  v_mov_b32 v39, 0
  v_mov_b32 v40, 0
  v_mov_b32 v41, 0
  v_mov_b32 v42, 0
  v_mov_b32 v43, 0
  v_mov_b32 v44, 0
  v_mov_b32 v45, 0
  v_mov_b32 v46, 0
  v_mov_b32 v47, 0
  v_mov_b32 v48, 0
  v_mov_b32 v49, 0
  v_mov_b32 v50, 0
  v_mov_b32 v51, 0
  v_mov_b32 v52, 0
  v_mov_b32 v53, 0
  v_mov_b32 v54, 0
  v_mov_b32 v55, 0
  v_mov_b32 v56, 0
  v_mov_b32 v57, 0
  v_mov_b32 v58, 0
  v_mov_b32 v59, 0
  v_mov_b32 v60, 0
  v_mov_b32 v61, 0
  v_mov_b32 v62, 0
  v_mov_b32 v63, 0
  v_mov_b32 v64, 0
  v_mov_b32 v65, 0
  v_mov_b32 v66, 0
  v_mov_b32 v67, 0
  s_mov_b32 s30, 0
  buffer_load_dword v76, v119, s[8:11], s20 offen sc1
  buffer_load_dword v77, v119, s[8:11], s20 offen sc1
  buffer_load_dword v78, v119, s[8:11], s20 offen sc1
cA_va3_fp_l:
  s_waitcnt vmcnt(2)
  v_cmp_eq_u32 vcc, -1, v76
  s_cbranch_vccz cA_va3_fp_d
  buffer_load_dword v76, v119, s[8:11], s20 offen sc1
  s_waitcnt vmcnt(2)
  v_cmp_eq_u32 vcc, -1, v77
  s_cbranch_vccz cA_va3_fp_d
  buffer_load_dword v77, v119, s[8:11], s20 offen sc1
  s_waitcnt vmcnt(2)
  v_cmp_eq_u32 vcc, -1, v78
  s_cbranch_vccz cA_va3_fp_d
  buffer_load_dword v78, v119, s[8:11], s20 offen sc1
  s_add_u32 s30, s30, 1
  s_cmp_lt_u32 s30, 400000
  s_cbranch_scc1 cA_va3_fp_l
  s_branch cA_abort
cA_va3_fp_d:
  buffer_load_dwordx4 v[24:27], v2, s[8:11], s23 offen offset:0 sc1
  buffer_load_dwordx4 v[28:31], v2, s[8:11], s23 offen offset:1024 sc1
  buffer_load_dwordx4 v[32:35], v2, s[8:11], s23 offen offset:2048 sc1
  s_barrier
cA_va3_ld:
  s_waitcnt vmcnt(0)
  v_max3_u32 v84, v24, v25, v26
  v_max3_u32 v84, v84, v27, v28
  v_max3_u32 v84, v84, v29, v30
  v_max3_u32 v84, v84, v31, v32
  v_max3_u32 v84, v84, v33, v34
  v_max_u32 v84, v84, v35
  v_cmp_eq_u32 vcc, -1, v84
  ds_write_b128 v2, v[24:27] offset:12288
  ds_write_b128 v2, v[28:31] offset:13312
  ds_write_b128 v2, v[32:35] offset:14336
  s_cbranch_vccnz cA_va3_retry
  s_waitcnt lgkmcnt(0)
  s_barrier
  ds_read_b128 v[8:11], v2 offset:8192
  ds_read_b128 v[12:15], v2 offset:9216
  ds_read_b128 v[16:19], v2 offset:10240
  ds_read_b128 v[20:23], v2 offset:11264
  s_waitcnt lgkmcnt(0)
  s_cmp_eq_u32 s19, 63
  s_cbranch_scc1 cA_done
  ds_read_b128 v[76:79], v1 offset:0
  ds_read_b128 v[80:83], v1 offset:1024
  ds_read_b128 v[84:87], v1 offset:2048
  ds_read_b128 v[88:91], v1 offset:3072
  ds_read_b128 v[92:95], v1 offset:4096
  ds_read_b128 v[96:99], v1 offset:5120
  v_smfmac_f32_16x16x64_bf16 v[60:63], v[8:11], v[200:207], v3
  v_smfmac_f32_16x16x64_bf16 v[60:63], v[12:15], v[208:215], v3
  s_waitcnt lgkmcnt(4)
  v_smfmac_f32_16x16x64_bf16 v[64:67], v[8:11], v[76:83], v3
  ds_read_b128 v[76:79], v1 offset:6144
  ds_read_b128 v[80:83], v1 offset:7168
  v_smfmac_f32_16x16x64_bf16 v[60:63], v[16:19], v[216:223], v3
  v_smfmac_f32_16x16x64_bf16 v[60:63], v[20:23], v[224:231], v3
  s_waitcnt lgkmcnt(4)
  v_smfmac_f32_16x16x64_bf16 v[64:67], v[12:15], v[84:91], v3
  ds_read_b128 v[84:87], v1 offset:8192
  ds_read_b128 v[88:91], v1 offset:9216
  v_smfmac_f32_16x16x64_bf16 v[60:63], v[24:27], v[232:239], v3
  v_smfmac_f32_16x16x64_bf16 v[60:63], v[28:31], v[240:247], v3
  s_waitcnt lgkmcnt(4)
  v_smfmac_f32_16x16x64_bf16 v[64:67], v[16:19], v[92:99], v3
  ds_read_b128 v[92:95], v1 offset:10240
  ds_read_b128 v[96:99], v1 offset:11264
  v_smfmac_f32_16x16x64_bf16 v[60:63], v[32:35], v[248:255], v3
  v_smfmac_f32_16x16x64_bf16 v[36:39], v[8:11], a[0:7], v3
  s_waitcnt lgkmcnt(4)
  v_smfmac_f32_16x16x64_bf16 v[64:67], v[20:23], v[76:83], v3
  ds_read_b128 v[76:79], v1 offset:12288
  ds_read_b128 v[80:83], v1 offset:13312
  v_smfmac_f32_16x16x64_bf16 v[36:39], v[12:15], a[8:15], v3
  v_smfmac_f32_16x16x64_bf16 v[36:39], v[16:19], a[16:23], v3
  s_waitcnt lgkmcnt(4)
  v_smfmac_f32_16x16x64_bf16 v[64:67], v[24:27], v[84:91], v3
  v_smfmac_f32_16x16x64_bf16 v[36:39], v[20:23], a[24:31], v3
  v_smfmac_f32_16x16x64_bf16 v[36:39], v[24:27], a[32:39], v3
  s_waitcnt lgkmcnt(2)
  v_smfmac_f32_16x16x64_bf16 v[64:67], v[28:31], v[92:99], v3
  v_smfmac_f32_16x16x64_bf16 v[36:39], v[28:31], a[40:47], v3
  v_smfmac_f32_16x16x64_bf16 v[36:39], v[32:35], a[48:55], v3
  s_waitcnt lgkmcnt(0)
  v_smfmac_f32_16x16x64_bf16 v[64:67], v[32:35], v[76:83], v3
  v_smfmac_f32_16x16x64_bf16 v[40:43], v[8:11], a[56:63], v3
  v_smfmac_f32_16x16x64_bf16 v[40:43], v[12:15], a[64:71], v3
  v_smfmac_f32_16x16x64_bf16 v[40:43], v[16:19], a[72:79], v3
  v_smfmac_f32_16x16x64_bf16 v[40:43], v[20:23], a[80:87], v3
  v_permlane32_swap_b32 v60, v64
  v_smfmac_f32_16x16x64_bf16 v[40:43], v[24:27], a[88:95], v3
  v_permlane32_swap_b32 v61, v65
  v_smfmac_f32_16x16x64_bf16 v[40:43], v[28:31], a[96:103], v3
  v_permlane32_swap_b32 v62, v66
  v_smfmac_f32_16x16x64_bf16 v[40:43], v[32:35], a[104:111], v3
  v_permlane32_swap_b32 v63, v67
  v_smfmac_f32_16x16x64_bf16 v[44:47], v[8:11], a[112:119], v3
  v_smfmac_f32_16x16x64_bf16 v[44:47], v[12:15], a[120:127], v3
  v_smfmac_f32_16x16x64_bf16 v[44:47], v[16:19], a[128:135], v3
  v_smfmac_f32_16x16x64_bf16 v[44:47], v[20:23], a[136:143], v3
  v_add_f32 v60, v60, v64
  v_add_f32 v61, v61, v65
  v_smfmac_f32_16x16x64_bf16 v[44:47], v[24:27], a[144:151], v3
  v_add_f32 v62, v62, v66
  v_add_f32 v63, v63, v67
  v_smfmac_f32_16x16x64_bf16 v[44:47], v[28:31], a[152:159], v3
  v_cvt_pk_bf16_f32 v64, v60, v61
  v_cvt_pk_bf16_f32 v65, v62, v63
  v_smfmac_f32_16x16x64_bf16 v[44:47], v[32:35], a[160:167], v3
  ds_write2_b32 v115, v64, v65 offset0:0 offset1:2
  v_smfmac_f32_16x16x64_bf16 v[48:51], v[8:11], a[168:175], v3
  v_permlane32_swap_b32 v36, v40
  v_smfmac_f32_16x16x64_bf16 v[48:51], v[12:15], a[176:183], v3
  v_permlane32_swap_b32 v37, v41
  v_smfmac_f32_16x16x64_bf16 v[48:51], v[16:19], a[184:191], v3
  v_permlane32_swap_b32 v38, v42
  v_smfmac_f32_16x16x64_bf16 v[48:51], v[20:23], a[192:199], v3
  v_permlane32_swap_b32 v39, v43
  v_smfmac_f32_16x16x64_bf16 v[48:51], v[24:27], a[200:207], v3
  v_add_f32 v36, v36, v40
  v_smfmac_f32_16x16x64_bf16 v[48:51], v[28:31], a[208:215], v3
  v_add_f32 v37, v37, v41
  v_smfmac_f32_16x16x64_bf16 v[48:51], v[32:35], a[216:223], v3
  v_add_f32 v38, v38, v42
  v_smfmac_f32_16x16x64_bf16 v[52:55], v[8:11], a[224:231], v3
  v_smfmac_f32_16x16x64_bf16 v[52:55], v[12:15], a[232:239], v3
  v_smfmac_f32_16x16x64_bf16 v[52:55], v[16:19], a[240:247], v3
  v_smfmac_f32_16x16x64_bf16 v[52:55], v[20:23], a[248:255], v3
  v_add_f32 v39, v39, v43
  v_cvt_pk_bf16_f32 v40, v36, v37
  v_smfmac_f32_16x16x64_bf16 v[52:55], v[24:27], v[120:127], v3
  v_cvt_pk_bf16_f32 v41, v38, v39
  v_smfmac_f32_16x16x64_bf16 v[52:55], v[28:31], v[128:135], v3
  ds_write2_b32 v112, v40, v41 offset0:0 offset1:2
  v_smfmac_f32_16x16x64_bf16 v[52:55], v[32:35], v[136:143], v3
  v_permlane32_swap_b32 v44, v48
  v_smfmac_f32_16x16x64_bf16 v[56:59], v[8:11], v[144:151], v3
  v_permlane32_swap_b32 v45, v49
  v_smfmac_f32_16x16x64_bf16 v[56:59], v[12:15], v[152:159], v3
  v_permlane32_swap_b32 v46, v50
  v_smfmac_f32_16x16x64_bf16 v[56:59], v[16:19], v[160:167], v3
  v_permlane32_swap_b32 v47, v51
  v_smfmac_f32_16x16x64_bf16 v[56:59], v[20:23], v[168:175], v3
  v_add_f32 v44, v44, v48
  v_smfmac_f32_16x16x64_bf16 v[56:59], v[24:27], v[176:183], v3
  v_add_f32 v45, v45, v49
  v_smfmac_f32_16x16x64_bf16 v[56:59], v[28:31], v[184:191], v3
  v_add_f32 v46, v46, v50
  v_smfmac_f32_16x16x64_bf16 v[56:59], v[32:35], v[192:199], v3
  v_add_f32 v47, v47, v51
  v_cvt_pk_bf16_f32 v48, v44, v45
  v_cvt_pk_bf16_f32 v49, v46, v47
  ds_write2_b32 v113, v48, v49 offset0:0 offset1:2
  s_nop 3
  v_permlane32_swap_b32 v52, v56
  v_permlane32_swap_b32 v53, v57
  v_permlane32_swap_b32 v54, v58
  v_permlane32_swap_b32 v55, v59
  v_add_f32 v52, v52, v56
  v_add_f32 v53, v53, v57
  v_add_f32 v54, v54, v58
  v_add_f32 v55, v55, v59
  v_cvt_pk_bf16_f32 v56, v52, v53
  v_cvt_pk_bf16_f32 v57, v54, v55
  ds_write2_b32 v114, v56, v57 offset0:0 offset1:2
  s_waitcnt lgkmcnt(0)
  s_barrier
  s_cmp_eq_u32 s19, 62
  s_cbranch_scc1 cA_done
  s_waitcnt vmcnt(0) lgkmcnt(0)
  s_add_u32 s19, s19, 1
  s_mov_b32 s20, s21
  s_branch cA_va3_loop
cA_va3_retry:
  s_waitcnt lgkmcnt(0)
  buffer_load_dwordx4 v[24:27], v2, s[8:11], s23 offen offset:0 sc1
  buffer_load_dwordx4 v[28:31], v2, s[8:11], s23 offen offset:1024 sc1
  buffer_load_dwordx4 v[32:35], v2, s[8:11], s23 offen offset:2048 sc1
  s_add_u32 s31, s31, 1
  s_add_u32 s30, s30, 1
  s_cmp_lt_u32 s30, 400000
  s_cbranch_scc1 cA_va3_ld
  s_branch cA_abort
cA_va3_last:
  s_waitcnt lgkmcnt(0)
  buffer_store_dwordx4 v[100:103], v2, s[8:11], s24 offen offset:0 sc1
  buffer_store_dwordx4 v[104:107], v2, s[8:11], s24 offen offset:1024 sc1
  buffer_store_dwordx4 v[108:111], v2, s[8:11], s24 offen offset:2048 sc1
  buffer_store_dwordx4 v[4:7], v2, s[8:11], s24 offen offset:3072 sc1
  s_add_u32 s24, s24, 8192
  s_waitcnt vmcnt(0)
  s_mov_b64 exec, 1
  buffer_store_dword v117, v2, s[8:11], s34 offen sc1
  s_mov_b64 exec, -1
  s_add_u32 s34, s34, 8
  s_mov_b64 exec, 1
  buffer_store_dword v117, v2, s[8:11], s34 offen sc1
  s_mov_b64 exec, -1
  s_add_u32 s34, s34, 8
  s_branch cA_done
cA_abort:
  v_mov_b32 v4, 0xdead
  v_mov_b32 v5, 16
  buffer_store_dword v4, v5, s[12:15], 0 offen
  s_branch ch_end
cA_done:
  s_branch ch_end
.p2align 6

cB_sc0_loop:
  s_add_u32 s23, s20, 4096
  s_add_u32 s21, s20, 25600
  v_mov_b32 v48, 0
  v_mov_b32 v49, 0
  v_mov_b32 v50, 0
  v_mov_b32 v51, 0
  v_mov_b32 v52, 0
  v_mov_b32 v53, 0
  v_mov_b32 v54, 0
  v_mov_b32 v55, 0
  v_mov_b32 v56, 0
  v_mov_b32 v57, 0
  v_mov_b32 v58, 0
  v_mov_b32 v59, 0
  v_mov_b32 v60, 0
  v_mov_b32 v61, 0
  v_mov_b32 v62, 0
  v_mov_b32 v63, 0
  v_mov_b32 v88, 0
  v_mov_b32 v89, 0
  v_mov_b32 v90, 0
  v_mov_b32 v91, 0
  v_mov_b32 v92, 0
  v_mov_b32 v93, 0
  v_mov_b32 v94, 0
  v_mov_b32 v95, 0
  v_mov_b32 v66, 0
  v_mov_b32 v67, 0
  s_mov_b32 s30, 0
  s_mov_b32 s62, 0
  buffer_load_dword v68, v0, s[8:11], s20 offen sc1
  s_nop 7
  buffer_load_dword v69, v0, s[8:11], s20 offen sc1
  s_nop 7
  buffer_load_dword v70, v0, s[8:11], s20 offen sc1
  s_nop 7
  buffer_load_dword v71, v0, s[8:11], s20 offen sc1
  s_nop 7
  buffer_load_dword v72, v0, s[8:11], s20 offen sc1
cB_sc0_fp_l:
  s_waitcnt vmcnt(4)
  v_cmp_eq_u32 vcc, -1, v68
  s_cbranch_vccz cB_sc0_fp_d
  buffer_load_dword v68, v0, s[8:11], s20 offen sc1
  s_waitcnt vmcnt(4)
  v_cmp_eq_u32 vcc, -1, v69
  s_cbranch_vccz cB_sc0_fp_d
  buffer_load_dword v69, v0, s[8:11], s20 offen sc1
  s_waitcnt vmcnt(4)
  v_cmp_eq_u32 vcc, -1, v70
  s_cbranch_vccz cB_sc0_fp_d
  buffer_load_dword v70, v0, s[8:11], s20 offen sc1
  s_waitcnt vmcnt(4)
  v_cmp_eq_u32 vcc, -1, v71
  s_cbranch_vccz cB_sc0_fp_d
  buffer_load_dword v71, v0, s[8:11], s20 offen sc1
  s_waitcnt vmcnt(4)
  v_cmp_eq_u32 vcc, -1, v72
  s_cbranch_vccz cB_sc0_fp_d
  buffer_load_dword v72, v0, s[8:11], s20 offen sc1
  s_add_u32 s30, s30, 1
  s_cmp_lt_u32 s30, 400000
  s_cbranch_scc1 cB_sc0_fp_l
  s_branch cB_abort
cB_sc0_fp_d:
  buffer_load_dwordx4 v[8:11], v2, s[8:11], s20 offen offset:0 sc1
  s_barrier
  s_branch cB_sc0_ld1
cB_sc0_ld:
  buffer_load_dwordx4 v[8:11], v2, s[8:11], s20 offen offset:0 sc1
cB_sc0_ld1:
  v_mov_b32 v36, 0
  v_mov_b32 v37, 0
  v_mov_b32 v38, 0
  v_mov_b32 v39, 0
  buffer_load_dwordx4 v[12:15], v2, s[8:11], s20 offen offset:1024 sc1
  v_mov_b32 v40, 0
  v_mov_b32 v41, 0
  v_mov_b32 v42, 0
  v_mov_b32 v43, 0
  buffer_load_dwordx4 v[16:19], v2, s[8:11], s20 offen offset:2048 sc1
  v_mov_b32 v44, 0
  v_mov_b32 v45, 0
  v_mov_b32 v46, 0
  v_mov_b32 v47, 0
  ds_read_b128 v[96:99], v117 offset:0
  ds_read_b128 v[100:103], v117 offset:1024
  ds_read_b128 v[104:107], v117 offset:14336
  ds_read_b128 v[108:111], v117 offset:15360
  s_waitcnt vmcnt(2)
  v_smfmac_f32_16x16x64_bf16 v[36:39], v[8:11], a[0:7], v3
  v_smfmac_f32_16x16x64_bf16 v[40:43], v[8:11], a[56:63], v3
  buffer_load_dwordx4 v[20:23], v2, s[8:11], s20 offen offset:3072 sc1
  v_smfmac_f32_16x16x64_bf16 v[44:47], v[8:11], a[112:119], v3
  v_smfmac_f32_16x16x64_bf16 v[48:51], v[8:11], a[168:175], v3
  v_smfmac_f32_16x16x64_bf16 v[52:55], v[8:11], a[224:231], v3
  buffer_load_dwordx4 v[24:27], v2, s[8:11], s23 offen offset:0 sc1
  v_smfmac_f32_16x16x64_bf16 v[56:59], v[8:11], v[144:151], v3
  v_smfmac_f32_16x16x64_bf16 v[60:63], v[8:11], v[200:207], v3
  s_waitcnt vmcnt(3)
  v_smfmac_f32_16x16x64_bf16 v[36:39], v[12:15], a[8:15], v3
  v_smfmac_f32_16x16x64_bf16 v[40:43], v[12:15], a[64:71], v3
  buffer_load_dwordx4 v[28:31], v2, s[8:11], s23 offen offset:1024 sc1
  v_smfmac_f32_16x16x64_bf16 v[44:47], v[12:15], a[120:127], v3
  v_smfmac_f32_16x16x64_bf16 v[48:51], v[12:15], a[176:183], v3
  v_smfmac_f32_16x16x64_bf16 v[52:55], v[12:15], a[232:239], v3
  buffer_load_dwordx4 v[32:35], v2, s[8:11], s23 offen offset:2048 sc1
  v_smfmac_f32_16x16x64_bf16 v[56:59], v[12:15], v[152:159], v3
  v_smfmac_f32_16x16x64_bf16 v[60:63], v[12:15], v[208:215], v3
  s_waitcnt vmcnt(4)
  v_smfmac_f32_16x16x64_bf16 v[36:39], v[16:19], a[16:23], v3
  v_smfmac_f32_16x16x64_bf16 v[40:43], v[16:19], a[72:79], v3
  v_smfmac_f32_16x16x64_bf16 v[44:47], v[16:19], a[128:135], v3
  v_smfmac_f32_16x16x64_bf16 v[48:51], v[16:19], a[184:191], v3
  v_smfmac_f32_16x16x64_bf16 v[52:55], v[16:19], a[240:247], v3
  v_smfmac_f32_16x16x64_bf16 v[56:59], v[16:19], v[160:167], v3
  v_smfmac_f32_16x16x64_bf16 v[60:63], v[16:19], v[216:223], v3
  s_waitcnt vmcnt(3)
  v_smfmac_f32_16x16x64_bf16 v[36:39], v[20:23], a[24:31], v3
  v_smfmac_f32_16x16x64_bf16 v[40:43], v[20:23], a[80:87], v3
  v_smfmac_f32_16x16x64_bf16 v[44:47], v[20:23], a[136:143], v3
  v_smfmac_f32_16x16x64_bf16 v[48:51], v[20:23], a[192:199], v3
  v_smfmac_f32_16x16x64_bf16 v[52:55], v[20:23], a[248:255], v3
  v_smfmac_f32_16x16x64_bf16 v[56:59], v[20:23], v[168:175], v3
  v_smfmac_f32_16x16x64_bf16 v[60:63], v[20:23], v[224:231], v3
  s_waitcnt vmcnt(0)
cB_sc0_ph2:
  v_smfmac_f32_16x16x64_bf16 v[60:63], v[24:27], v[232:239], v3
  ds_read_b128 v[12:15], v116 offset:0
  ds_read_b128 v[16:19], v116 offset:1024
  v_smfmac_f32_16x16x64_bf16 v[60:63], v[28:31], v[240:247], v3
  v_smfmac_f32_16x16x64_bf16 v[60:63], v[32:35], v[248:255], v3
  v_mov_b32 v80, v24
  v_smfmac_f32_16x16x64_bf16 v[52:55], v[24:27], v[120:127], v3
  v_mov_b32 v81, v25
  v_smfmac_f32_16x16x64_bf16 v[52:55], v[28:31], v[128:135], v3
  v_mov_b32 v82, v32
  v_smfmac_f32_16x16x64_bf16 v[52:55], v[32:35], v[136:143], v3
  v_cvt_pk_bf16_f32 v64, v60, v61
  v_smfmac_f32_16x16x64_bf16 v[56:59], v[24:27], v[176:183], v3
  v_cvt_pk_bf16_f32 v65, v62, v63
  v_smfmac_f32_16x16x64_bf16 v[56:59], v[28:31], v[184:191], v3
  v_mov_b32 v83, v33
  v_mfma_f32_16x16x32_bf16 v[68:71], v[64:67], v[4:7], 0
  v_smfmac_f32_16x16x64_bf16 v[56:59], v[32:35], v[192:199], v3
  v_cvt_pk_bf16_f32 v64, v52, v53
  v_smfmac_f32_16x16x64_bf16 v[36:39], v[24:27], a[32:39], v3
  v_cvt_pk_bf16_f32 v65, v54, v55
  v_smfmac_f32_16x16x64_bf16 v[36:39], v[28:31], a[40:47], v3
  v_cvt_pk_bf16_f32 v78, v68, v69
  v_smfmac_f32_16x16x64_bf16 v[36:39], v[32:35], a[48:55], v3
  v_cvt_pk_bf16_f32 v79, v70, v71
  v_cvt_pk_bf16_f32 v66, v56, v57
  v_smfmac_f32_16x16x64_bf16 v[40:43], v[24:27], a[88:95], v3
  v_cvt_pk_bf16_f32 v67, v58, v59
  v_smfmac_f32_16x16x64_bf16 v[40:43], v[28:31], a[96:103], v3
  v_mfma_f32_16x16x32_bf16 v[72:75], v[64:67], v[4:7], 0
  ds_read_b128 v[52:55], v116 offset:14336
  ds_read_b128 v[56:59], v116 offset:15360
  v_smfmac_f32_16x16x64_bf16 v[40:43], v[32:35], a[104:111], v3
  v_cvt_pk_bf16_f32 v64, v36, v37
  v_smfmac_f32_16x16x64_bf16 v[44:47], v[24:27], a[144:151], v3
  v_cvt_pk_bf16_f32 v65, v38, v39
  v_smfmac_f32_16x16x64_bf16 v[44:47], v[28:31], a[152:159], v3
  v_cvt_pk_bf16_f32 v76, v72, v73
  v_smfmac_f32_16x16x64_bf16 v[44:47], v[32:35], a[160:167], v3
  v_cvt_pk_bf16_f32 v77, v74, v75
  v_cvt_pk_bf16_f32 v66, v40, v41
  v_smfmac_f32_16x16x64_bf16 v[48:51], v[24:27], a[200:207], v3
  v_cvt_pk_bf16_f32 v67, v42, v43
  v_smfmac_f32_16x16x64_bf16 v[48:51], v[28:31], a[208:215], v3
  v_mfma_f32_16x16x32_bf16 v[68:71], v[64:67], v[4:7], 0
  v_smfmac_f32_16x16x64_bf16 v[48:51], v[32:35], a[216:223], v3
  v_cvt_pk_bf16_f32 v64, v44, v45
  v_mfma_f32_16x16x32_bf16 v[84:87], v[80:83], v[76:79], 0
  v_cvt_pk_bf16_f32 v65, v46, v47
  s_waitcnt lgkmcnt(0)
  v_smfmac_f32_16x16x64_bf16 v[88:91], v[76:79], v[96:103], v3
  v_cvt_pk_bf16_f32 v60, v68, v69
  v_cvt_pk_bf16_f32 v61, v70, v71
  v_cvt_pk_bf16_f32 v66, v48, v49
  v_cvt_pk_bf16_f32 v67, v50, v51
  s_nop 1
  v_mfma_f32_16x16x32_bf16 v[72:75], v[64:67], v[4:7], 0
  v_smfmac_f32_16x16x64_bf16 v[92:95], v[76:79], v[104:111], v3
  s_nop 4
  v_cvt_pk_bf16_f32 v62, v72, v73
  v_cvt_pk_bf16_f32 v63, v74, v75
  s_nop 1
  v_mfma_f32_16x16x32_bf16 v[84:87], v[8:11], v[60:63], v[84:87]
  v_smfmac_f32_16x16x64_bf16 v[88:91], v[60:63], v[12:19], v3
  v_smfmac_f32_16x16x64_bf16 v[92:95], v[60:63], v[52:59], v3
  s_nop 1
  v_permlane32_swap_b32 v84, v86
  v_permlane32_swap_b32 v85, v87
  s_nop 0
  v_cmp_u_f32 vcc, v88, v89
  v_add_f32_dpp v84, v86, v84 row_ror:8 row_mask:0xf bank_mask:0xf
  v_add_f32_dpp v85, v87, v85 row_ror:8 row_mask:0xf bank_mask:0xf
  v_permlane32_swap_b32 v88, v92
  v_permlane32_swap_b32 v89, v93
  ds_write2_b32 v113, v84, v85 offset0:0 offset1:4
  v_permlane32_swap_b32 v90, v94
  v_permlane32_swap_b32 v91, v95
  v_add_f32 v88, v88, v92
  v_add_f32 v89, v89, v93
  v_add_f32 v90, v90, v94
  v_add_f32 v91, v91, v95
  ds_write2_b64 v112, v[88:89], v[90:91] offset0:0 offset1:128
  s_cbranch_vccnz cB_sc0_retry
cB_sc0_cont:
  s_waitcnt lgkmcnt(0)
  s_barrier
  ds_read_b128 v[36:39], v114
  ds_read_b128 v[44:47], v115
  s_waitcnt lgkmcnt(0)
  v_add_f32 v36, v36, v38
  v_add_f32 v37, v37, v39
  v_add_f32 v44, v44, v45
  v_add_f32 v46, v46, v47
  v_permlane32_swap_b32 v36, v37
  v_add_f32 v44, v44, v46
  v_add_f32 v36, v36, v37
  v_exp_f32 v49, v44
  v_exp_f32 v48, v36
  v_add_f32 v50, abs(v36), abs(v44)
  v_fma_f32 v39, v49, s37, v48
  v_cmp_ngt_f32 vcc, s56, v50
  v_cndmask_b32 v41, v48, v49, s[38:39]
  v_add_f32_dpp v39, v39, v39 quad_perm:[1,0,3,2] row_mask:0xf bank_mask:0xf
  v_cndmask_b32 v40, v49, v48, s[38:39]
  v_mov_b32_dpp v46, v41 quad_perm:[1,0,3,2] row_mask:0xf bank_mask:0xf
  v_add_f32_dpp v39, v39, v39 quad_perm:[2,3,0,1] row_mask:0xf bank_mask:0xf
  v_cndmask_b32 v42, v46, v40, s[38:39]
  v_cndmask_b32 v43, v40, v46, s[38:39]
  v_add_f32_dpp v39, v39, v39 row_half_mirror row_mask:0xf bank_mask:0xf
  s_cbranch_vccnz cB_sc0_slow
  s_nop 0
  v_add_f32_dpp v47, v39, v39 row_mirror row_mask:0xf bank_mask:0xf
  v_add_f32_dpp v39, v39, v39 row_mirror row_mask:0xf bank_mask:0xf
  s_nop 1
  v_permlane16_swap_b32 v39, v47
  v_add_f32 v39, v39, v47
  v_rcp_f32 v39, v39
  s_mov_b64 exec, s[28:29]
  v_mul_f32 v42, v42, v39
  v_mul_f32 v43, v43, v39
  v_cvt_pk_bf16_f32 v42, v42, v43
cB_sc0_pst:
  buffer_store_dword v42, v1, s[8:11], s20 offen sc1
  s_mov_b64 exec, -1
  s_barrier
  s_add_u32 s24, s24, 28672
  s_add_u32 s35, s35, 28672
  s_xor_b32 s25, s25, 28672
  s_add_u32 m0, s25, 0
  s_nop 0
  buffer_load_dwordx4 v2, s[8:11], s24 offen offset:0 sc1 lds
  buffer_load_dwordx4 v2, s[8:11], s24 offen offset:1024 sc1 lds
  buffer_load_dwordx4 v2, s[8:11], s24 offen offset:2048 sc1 lds
  buffer_load_dwordx4 v2, s[8:11], s24 offen offset:3072 sc1 lds
  s_add_u32 m0, s25, 4096
  s_add_u32 s22, s24, 4096
  buffer_load_dwordx4 v2, s[8:11], s22 offen offset:0 sc1 lds
  buffer_load_dwordx4 v2, s[8:11], s22 offen offset:1024 sc1 lds
  buffer_load_dwordx4 v2, s[8:11], s22 offen offset:2048 sc1 lds
  v_xor_b32 v116, 28672, v116
  v_add_u32 v117, s57, v117
  s_sub_u32 s57, 0, s57
  s_add_u32 s19, s19, 1
  s_mov_b32 s20, s21
  s_cmp_lt_u32 s19, 63
  s_cbranch_scc1 cB_sc0_loop
  s_branch cB_done
cB_sc0_slow:
  v_max_f32 v50, v36, v44
  s_nop 1
  v_max_f32_dpp v50, v50, v50 quad_perm:[1,0,3,2] row_mask:0xf bank_mask:0xf
  s_nop 1
  v_max_f32_dpp v50, v50, v50 quad_perm:[2,3,0,1] row_mask:0xf bank_mask:0xf
  s_nop 1
  v_max_f32_dpp v50, v50, v50 row_half_mirror row_mask:0xf bank_mask:0xf
  s_nop 1
  v_max_f32_dpp v50, v50, v50 row_mirror row_mask:0xf bank_mask:0xf
  v_mov_b32 v47, v50
  s_nop 1
  v_permlane16_swap_b32 v50, v47
  v_max_f32 v50, v50, v47
  v_sub_f32 v48, v36, v50
  v_sub_f32 v49, v44, v50
  v_exp_f32 v48, v48
  v_exp_f32 v49, v49
  s_add_u32 s31, s31, 0x100
  v_fma_f32 v39, v49, s37, v48
  v_cndmask_b32 v41, v48, v49, s[38:39]
  s_nop 0
  v_add_f32_dpp v39, v39, v39 quad_perm:[1,0,3,2] row_mask:0xf bank_mask:0xf
  v_cndmask_b32 v40, v49, v48, s[38:39]
  v_mov_b32_dpp v46, v41 quad_perm:[1,0,3,2] row_mask:0xf bank_mask:0xf
  v_add_f32_dpp v39, v39, v39 quad_perm:[2,3,0,1] row_mask:0xf bank_mask:0xf
  v_cndmask_b32 v42, v46, v40, s[38:39]
  v_cndmask_b32 v43, v40, v46, s[38:39]
  v_add_f32_dpp v39, v39, v39 row_half_mirror row_mask:0xf bank_mask:0xf
  s_nop 1
  v_add_f32_dpp v47, v39, v39 row_mirror row_mask:0xf bank_mask:0xf
  v_add_f32_dpp v39, v39, v39 row_mirror row_mask:0xf bank_mask:0xf
  s_nop 1
  v_permlane16_swap_b32 v39, v47
  v_add_f32 v39, v39, v47
  v_rcp_f32 v39, v39
  s_mov_b64 exec, s[28:29]
  v_mul_f32 v42, v42, v39
  v_mul_f32 v43, v43, v39
  v_cvt_pk_bf16_f32 v42, v42, v43
  v_min_u32 v42, -2, v42
  s_branch cB_sc0_pst
cB_sc0_retry:
  s_cmp_lg_u32 s62, 0
  s_cbranch_scc1 cB_sc0_cont
  s_waitcnt vmcnt(0) lgkmcnt(0)
cB_sc0_rv:
  buffer_load_dwordx4 v[8:11], v2, s[8:11], s20 offen offset:0 sc1
  buffer_load_dwordx4 v[12:15], v2, s[8:11], s20 offen offset:1024 sc1
  buffer_load_dwordx4 v[16:19], v2, s[8:11], s20 offen offset:2048 sc1
  buffer_load_dwordx4 v[20:23], v2, s[8:11], s20 offen offset:3072 sc1
  buffer_load_dwordx4 v[24:27], v2, s[8:11], s23 offen offset:0 sc1
  buffer_load_dwordx4 v[28:31], v2, s[8:11], s23 offen offset:1024 sc1
  buffer_load_dwordx4 v[32:35], v2, s[8:11], s23 offen offset:2048 sc1
  s_waitcnt vmcnt(0)
  v_max3_u32 v118, v8, v9, v10
  v_max3_u32 v118, v118, v11, v12
  v_max3_u32 v118, v118, v13, v14
  v_max3_u32 v118, v118, v15, v16
  v_max3_u32 v118, v118, v17, v18
  v_max3_u32 v118, v118, v19, v20
  v_max3_u32 v118, v118, v21, v22
  v_max3_u32 v118, v118, v23, v24
  v_max3_u32 v118, v118, v25, v26
  v_max3_u32 v118, v118, v27, v28
  v_max3_u32 v118, v118, v29, v30
  v_max3_u32 v118, v118, v31, v32
  v_max3_u32 v118, v118, v33, v34
  v_max_u32 v118, v118, v35
  v_cmp_eq_u32 vcc, -1, v118
  s_cbranch_vccz cB_sc0_rk
  s_add_u32 s30, s30, 1
  s_cmp_lt_u32 s30, 400000
  s_cbranch_scc1 cB_sc0_rv
  s_branch cB_abort
cB_sc0_rk:
  s_mov_b32 s62, 1
  v_mov_b32 v36, 0
  v_mov_b32 v37, 0
  v_mov_b32 v38, 0
  v_mov_b32 v39, 0
  v_mov_b32 v40, 0
  v_mov_b32 v41, 0
  v_mov_b32 v42, 0
  v_mov_b32 v43, 0
  v_mov_b32 v44, 0
  v_mov_b32 v45, 0
  v_mov_b32 v46, 0
  v_mov_b32 v47, 0
  v_mov_b32 v48, 0
  v_mov_b32 v49, 0
  v_mov_b32 v50, 0
  v_mov_b32 v51, 0
  v_mov_b32 v52, 0
  v_mov_b32 v53, 0
  v_mov_b32 v54, 0
  v_mov_b32 v55, 0
  v_mov_b32 v56, 0
  v_mov_b32 v57, 0
  v_mov_b32 v58, 0
  v_mov_b32 v59, 0
  v_mov_b32 v60, 0
  v_mov_b32 v61, 0
  v_mov_b32 v62, 0
  v_mov_b32 v63, 0
  v_mov_b32 v88, 0
  v_mov_b32 v89, 0
  v_mov_b32 v90, 0
  v_mov_b32 v91, 0
  v_mov_b32 v92, 0
  v_mov_b32 v93, 0
  v_mov_b32 v94, 0
  v_mov_b32 v95, 0
  v_mov_b32 v66, 0
  v_mov_b32 v67, 0
  s_add_u32 s31, s31, 1
  ds_read_b128 v[96:99], v117 offset:0
  ds_read_b128 v[100:103], v117 offset:1024
  ds_read_b128 v[104:107], v117 offset:14336
  ds_read_b128 v[108:111], v117 offset:15360
  v_smfmac_f32_16x16x64_bf16 v[36:39], v[8:11], a[0:7], v3
  v_smfmac_f32_16x16x64_bf16 v[40:43], v[8:11], a[56:63], v3
  v_smfmac_f32_16x16x64_bf16 v[44:47], v[8:11], a[112:119], v3
  v_smfmac_f32_16x16x64_bf16 v[48:51], v[8:11], a[168:175], v3
  v_smfmac_f32_16x16x64_bf16 v[52:55], v[8:11], a[224:231], v3
  v_smfmac_f32_16x16x64_bf16 v[56:59], v[8:11], v[144:151], v3
  v_smfmac_f32_16x16x64_bf16 v[60:63], v[8:11], v[200:207], v3
  v_smfmac_f32_16x16x64_bf16 v[36:39], v[12:15], a[8:15], v3
  v_smfmac_f32_16x16x64_bf16 v[40:43], v[12:15], a[64:71], v3
  v_smfmac_f32_16x16x64_bf16 v[44:47], v[12:15], a[120:127], v3
  v_smfmac_f32_16x16x64_bf16 v[48:51], v[12:15], a[176:183], v3
  v_smfmac_f32_16x16x64_bf16 v[52:55], v[12:15], a[232:239], v3
  v_smfmac_f32_16x16x64_bf16 v[56:59], v[12:15], v[152:159], v3
  v_smfmac_f32_16x16x64_bf16 v[60:63], v[12:15], v[208:215], v3
  v_smfmac_f32_16x16x64_bf16 v[36:39], v[16:19], a[16:23], v3
  v_smfmac_f32_16x16x64_bf16 v[40:43], v[16:19], a[72:79], v3
  v_smfmac_f32_16x16x64_bf16 v[44:47], v[16:19], a[128:135], v3
  v_smfmac_f32_16x16x64_bf16 v[48:51], v[16:19], a[184:191], v3
  v_smfmac_f32_16x16x64_bf16 v[52:55], v[16:19], a[240:247], v3
  v_smfmac_f32_16x16x64_bf16 v[56:59], v[16:19], v[160:167], v3
  v_smfmac_f32_16x16x64_bf16 v[60:63], v[16:19], v[216:223], v3
  v_smfmac_f32_16x16x64_bf16 v[36:39], v[20:23], a[24:31], v3
  v_smfmac_f32_16x16x64_bf16 v[40:43], v[20:23], a[80:87], v3
  v_smfmac_f32_16x16x64_bf16 v[44:47], v[20:23], a[136:143], v3
  v_smfmac_f32_16x16x64_bf16 v[48:51], v[20:23], a[192:199], v3
  v_smfmac_f32_16x16x64_bf16 v[52:55], v[20:23], a[248:255], v3
  v_smfmac_f32_16x16x64_bf16 v[56:59], v[20:23], v[168:175], v3
  v_smfmac_f32_16x16x64_bf16 v[60:63], v[20:23], v[224:231], v3
  s_branch cB_sc0_ph2
.p2align 6

cB_sc1_loop:
  s_add_u32 s23, s20, 4096
  s_add_u32 s21, s20, 25600
  v_mov_b32 v48, 0
  v_mov_b32 v49, 0
  v_mov_b32 v50, 0
  v_mov_b32 v51, 0
  v_mov_b32 v52, 0
  v_mov_b32 v53, 0
  v_mov_b32 v54, 0
  v_mov_b32 v55, 0
  v_mov_b32 v56, 0
  v_mov_b32 v57, 0
  v_mov_b32 v58, 0
  v_mov_b32 v59, 0
  v_mov_b32 v60, 0
  v_mov_b32 v61, 0
  v_mov_b32 v62, 0
  v_mov_b32 v63, 0
  v_mov_b32 v88, 0
  v_mov_b32 v89, 0
  v_mov_b32 v90, 0
  v_mov_b32 v91, 0
  v_mov_b32 v92, 0
  v_mov_b32 v93, 0
  v_mov_b32 v94, 0
  v_mov_b32 v95, 0
  v_mov_b32 v64, 0
  v_mov_b32 v65, 0
  s_mov_b32 s30, 0
  s_mov_b32 s62, 0
  s_waitcnt vmcnt(0)
  s_barrier
cB_sc1_ld:
  buffer_load_dwordx4 v[8:11], v2, s[8:11], s20 offen offset:0 sc1
  v_mov_b32 v36, 0
  v_mov_b32 v37, 0
  v_mov_b32 v38, 0
  v_mov_b32 v39, 0
  buffer_load_dwordx4 v[12:15], v2, s[8:11], s20 offen offset:1024 sc1
  v_mov_b32 v40, 0
  v_mov_b32 v41, 0
  v_mov_b32 v42, 0
  v_mov_b32 v43, 0
  buffer_load_dwordx4 v[16:19], v2, s[8:11], s20 offen offset:2048 sc1
  v_mov_b32 v44, 0
  v_mov_b32 v45, 0
  v_mov_b32 v46, 0
  v_mov_b32 v47, 0
  ds_read_b128 v[96:99], v117 offset:0
  ds_read_b128 v[100:103], v117 offset:1024
  ds_read_b128 v[104:107], v117 offset:14336
  ds_read_b128 v[108:111], v117 offset:15360
  s_waitcnt vmcnt(2)
  v_smfmac_f32_16x16x64_bf16 v[36:39], v[8:11], a[0:7], v3
  v_smfmac_f32_16x16x64_bf16 v[40:43], v[8:11], a[56:63], v3
  buffer_load_dwordx4 v[20:23], v2, s[8:11], s20 offen offset:3072 sc1
  v_smfmac_f32_16x16x64_bf16 v[44:47], v[8:11], a[112:119], v3
  v_smfmac_f32_16x16x64_bf16 v[48:51], v[8:11], a[168:175], v3
  v_smfmac_f32_16x16x64_bf16 v[52:55], v[8:11], a[224:231], v3
  buffer_load_dwordx4 v[24:27], v2, s[8:11], s23 offen offset:0 sc1
  v_smfmac_f32_16x16x64_bf16 v[56:59], v[8:11], v[144:151], v3
  v_smfmac_f32_16x16x64_bf16 v[60:63], v[8:11], v[200:207], v3
  s_waitcnt vmcnt(3)
  v_smfmac_f32_16x16x64_bf16 v[36:39], v[12:15], a[8:15], v3
  v_smfmac_f32_16x16x64_bf16 v[40:43], v[12:15], a[64:71], v3
  buffer_load_dwordx4 v[28:31], v2, s[8:11], s23 offen offset:1024 sc1
  v_smfmac_f32_16x16x64_bf16 v[44:47], v[12:15], a[120:127], v3
  v_smfmac_f32_16x16x64_bf16 v[48:51], v[12:15], a[176:183], v3
  v_smfmac_f32_16x16x64_bf16 v[52:55], v[12:15], a[232:239], v3
  buffer_load_dwordx4 v[32:35], v2, s[8:11], s23 offen offset:2048 sc1
  v_smfmac_f32_16x16x64_bf16 v[56:59], v[12:15], v[152:159], v3
  v_smfmac_f32_16x16x64_bf16 v[60:63], v[12:15], v[208:215], v3
  s_waitcnt vmcnt(4)
  v_smfmac_f32_16x16x64_bf16 v[36:39], v[16:19], a[16:23], v3
  v_smfmac_f32_16x16x64_bf16 v[40:43], v[16:19], a[72:79], v3
  v_smfmac_f32_16x16x64_bf16 v[44:47], v[16:19], a[128:135], v3
  v_smfmac_f32_16x16x64_bf16 v[48:51], v[16:19], a[184:191], v3
  v_smfmac_f32_16x16x64_bf16 v[52:55], v[16:19], a[240:247], v3
  v_smfmac_f32_16x16x64_bf16 v[56:59], v[16:19], v[160:167], v3
  v_smfmac_f32_16x16x64_bf16 v[60:63], v[16:19], v[216:223], v3
  s_waitcnt vmcnt(3)
  v_smfmac_f32_16x16x64_bf16 v[36:39], v[20:23], a[24:31], v3
  v_smfmac_f32_16x16x64_bf16 v[40:43], v[20:23], a[80:87], v3
  v_smfmac_f32_16x16x64_bf16 v[44:47], v[20:23], a[136:143], v3
  v_smfmac_f32_16x16x64_bf16 v[48:51], v[20:23], a[192:199], v3
  v_smfmac_f32_16x16x64_bf16 v[52:55], v[20:23], a[248:255], v3
  v_smfmac_f32_16x16x64_bf16 v[56:59], v[20:23], v[168:175], v3
  v_smfmac_f32_16x16x64_bf16 v[60:63], v[20:23], v[224:231], v3
  s_waitcnt vmcnt(0)
cB_sc1_ph2:
  v_smfmac_f32_16x16x64_bf16 v[60:63], v[24:27], v[232:239], v3
  ds_read_b128 v[16:19], v116 offset:2048
  ds_read_b128 v[20:23], v116 offset:3072
  v_smfmac_f32_16x16x64_bf16 v[60:63], v[28:31], v[240:247], v3
  buffer_load_dword v119, v0, s[8:11], s20 offen sc1
  v_smfmac_f32_16x16x64_bf16 v[60:63], v[32:35], v[248:255], v3
  v_mov_b32 v80, v26
  v_smfmac_f32_16x16x64_bf16 v[52:55], v[24:27], v[120:127], v3
  v_mov_b32 v81, v27
  v_smfmac_f32_16x16x64_bf16 v[52:55], v[28:31], v[128:135], v3
  v_mov_b32 v82, v32
  v_smfmac_f32_16x16x64_bf16 v[52:55], v[32:35], v[136:143], v3
  v_cvt_pk_bf16_f32 v66, v60, v61
  v_smfmac_f32_16x16x64_bf16 v[56:59], v[24:27], v[176:183], v3
  v_cvt_pk_bf16_f32 v67, v62, v63
  v_smfmac_f32_16x16x64_bf16 v[56:59], v[28:31], v[184:191], v3
  v_mov_b32 v83, v33
  v_mfma_f32_16x16x32_bf16 v[68:71], v[64:67], v[4:7], 0
  v_smfmac_f32_16x16x64_bf16 v[56:59], v[32:35], v[192:199], v3
  v_cvt_pk_bf16_f32 v64, v52, v53
  v_smfmac_f32_16x16x64_bf16 v[36:39], v[24:27], a[32:39], v3
  v_cvt_pk_bf16_f32 v65, v54, v55
  v_smfmac_f32_16x16x64_bf16 v[36:39], v[28:31], a[40:47], v3
  v_cvt_pk_bf16_f32 v78, v68, v69
  v_smfmac_f32_16x16x64_bf16 v[36:39], v[32:35], a[48:55], v3
  v_cvt_pk_bf16_f32 v79, v70, v71
  v_cvt_pk_bf16_f32 v66, v56, v57
  v_smfmac_f32_16x16x64_bf16 v[40:43], v[24:27], a[88:95], v3
  v_cvt_pk_bf16_f32 v67, v58, v59
  v_smfmac_f32_16x16x64_bf16 v[40:43], v[28:31], a[96:103], v3
  v_mfma_f32_16x16x32_bf16 v[72:75], v[64:67], v[4:7], 0
  ds_read_b128 v[52:55], v116 offset:16384
  ds_read_b128 v[56:59], v116 offset:17408
  v_smfmac_f32_16x16x64_bf16 v[40:43], v[32:35], a[104:111], v3
  v_cvt_pk_bf16_f32 v64, v36, v37
  v_smfmac_f32_16x16x64_bf16 v[44:47], v[24:27], a[144:151], v3
  v_cvt_pk_bf16_f32 v65, v38, v39
  v_smfmac_f32_16x16x64_bf16 v[44:47], v[28:31], a[152:159], v3
  v_cvt_pk_bf16_f32 v76, v72, v73
  v_smfmac_f32_16x16x64_bf16 v[44:47], v[32:35], a[160:167], v3
  v_cvt_pk_bf16_f32 v77, v74, v75
  v_cvt_pk_bf16_f32 v66, v40, v41
  v_smfmac_f32_16x16x64_bf16 v[48:51], v[24:27], a[200:207], v3
  v_cvt_pk_bf16_f32 v67, v42, v43
  v_smfmac_f32_16x16x64_bf16 v[48:51], v[28:31], a[208:215], v3
  v_mfma_f32_16x16x32_bf16 v[68:71], v[64:67], v[4:7], 0
  v_smfmac_f32_16x16x64_bf16 v[48:51], v[32:35], a[216:223], v3
  v_cvt_pk_bf16_f32 v64, v44, v45
  v_mfma_f32_16x16x32_bf16 v[84:87], v[80:83], v[76:79], 0
  v_cvt_pk_bf16_f32 v65, v46, v47
  s_waitcnt lgkmcnt(0)
  v_smfmac_f32_16x16x64_bf16 v[88:91], v[76:79], v[96:103], v3
  v_cvt_pk_bf16_f32 v60, v68, v69
  v_cvt_pk_bf16_f32 v61, v70, v71
  v_cvt_pk_bf16_f32 v66, v48, v49
  v_cvt_pk_bf16_f32 v67, v50, v51
  s_nop 1
  v_mfma_f32_16x16x32_bf16 v[72:75], v[64:67], v[4:7], 0
  v_smfmac_f32_16x16x64_bf16 v[92:95], v[76:79], v[104:111], v3
  s_nop 4
  v_cvt_pk_bf16_f32 v62, v72, v73
  v_cvt_pk_bf16_f32 v63, v74, v75
  s_nop 1
  v_mfma_f32_16x16x32_bf16 v[84:87], v[12:15], v[60:63], v[84:87]
  v_smfmac_f32_16x16x64_bf16 v[88:91], v[60:63], v[16:23], v3
  v_smfmac_f32_16x16x64_bf16 v[92:95], v[60:63], v[52:59], v3
  s_nop 1
  v_permlane32_swap_b32 v84, v86
  v_permlane32_swap_b32 v85, v87
  s_nop 0
  v_cmp_u_f32 vcc, v88, v89
  v_add_f32_dpp v84, v86, v84 row_ror:8 row_mask:0xf bank_mask:0xf
  v_add_f32_dpp v85, v87, v85 row_ror:8 row_mask:0xf bank_mask:0xf
  v_permlane32_swap_b32 v88, v92
  v_permlane32_swap_b32 v89, v93
  ds_write2_b32 v113, v84, v85 offset0:0 offset1:4
  v_permlane32_swap_b32 v90, v94
  v_permlane32_swap_b32 v91, v95
  v_add_f32 v88, v88, v92
  v_add_f32 v89, v89, v93
  v_add_f32 v90, v90, v94
  v_add_f32 v91, v91, v95
  ds_write2_b64 v112, v[88:89], v[90:91] offset0:0 offset1:128
  s_cbranch_vccnz cB_sc1_retry
cB_sc1_cont:
  s_waitcnt lgkmcnt(0)
  s_barrier
  ds_read_b128 v[36:39], v114
  ds_read_b128 v[44:47], v115
  s_waitcnt lgkmcnt(0)
  v_add_f32 v36, v36, v38
  v_add_f32 v37, v37, v39
  v_add_f32 v44, v44, v45
  v_add_f32 v46, v46, v47
  v_permlane32_swap_b32 v36, v37
  v_add_f32 v44, v44, v46
  v_add_f32 v36, v36, v37
  v_exp_f32 v49, v44
  v_exp_f32 v48, v36
  v_add_f32 v50, abs(v36), abs(v44)
  v_fma_f32 v39, v49, s37, v48
  v_cmp_ngt_f32 vcc, s56, v50
  v_cndmask_b32 v41, v48, v49, s[38:39]
  v_add_f32_dpp v39, v39, v39 quad_perm:[1,0,3,2] row_mask:0xf bank_mask:0xf
  v_cndmask_b32 v40, v49, v48, s[38:39]
  v_mov_b32_dpp v46, v41 quad_perm:[1,0,3,2] row_mask:0xf bank_mask:0xf
  v_add_f32_dpp v39, v39, v39 quad_perm:[2,3,0,1] row_mask:0xf bank_mask:0xf
  v_cndmask_b32 v42, v46, v40, s[38:39]
  v_cndmask_b32 v43, v40, v46, s[38:39]
  v_add_f32_dpp v39, v39, v39 row_half_mirror row_mask:0xf bank_mask:0xf
  s_cbranch_vccnz cB_sc1_slow
  s_nop 0
  v_add_f32_dpp v47, v39, v39 row_mirror row_mask:0xf bank_mask:0xf
  v_add_f32_dpp v39, v39, v39 row_mirror row_mask:0xf bank_mask:0xf
  s_nop 1
  v_permlane16_swap_b32 v39, v47
  v_add_f32 v39, v39, v47
  v_rcp_f32 v39, v39
  s_mov_b64 exec, s[28:29]
  v_mul_f32 v42, v42, v39
  v_mul_f32 v43, v43, v39
  v_cvt_pk_bf16_f32 v42, v42, v43
cB_sc1_pst:
  buffer_store_dword v42, v1, s[8:11], s20 offen sc1
  s_mov_b64 exec, -1
  s_barrier
  s_add_u32 s24, s24, 28672
  s_add_u32 s35, s35, 28672
  s_xor_b32 s25, s25, 28672
  s_add_u32 m0, s25, 7168
  s_nop 0
  buffer_load_dwordx4 v2, s[8:11], s24 offen offset:0 sc1 lds
  buffer_load_dwordx4 v2, s[8:11], s24 offen offset:1024 sc1 lds
  buffer_load_dwordx4 v2, s[8:11], s24 offen offset:2048 sc1 lds
  buffer_load_dwordx4 v2, s[8:11], s24 offen offset:3072 sc1 lds
  s_add_u32 m0, s25, 11264
  s_add_u32 s22, s24, 4096
  buffer_load_dwordx4 v2, s[8:11], s22 offen offset:0 sc1 lds
  buffer_load_dwordx4 v2, s[8:11], s22 offen offset:1024 sc1 lds
  buffer_load_dwordx4 v2, s[8:11], s22 offen offset:2048 sc1 lds
  v_xor_b32 v116, 28672, v116
  v_add_u32 v117, s57, v117
  s_sub_u32 s57, 0, s57
  s_add_u32 s19, s19, 1
  s_mov_b32 s20, s21
  s_cmp_lt_u32 s19, 63
  s_cbranch_scc1 cB_sc1_loop
  s_branch cB_done
cB_sc1_slow:
  v_max_f32 v50, v36, v44
  s_nop 1
  v_max_f32_dpp v50, v50, v50 quad_perm:[1,0,3,2] row_mask:0xf bank_mask:0xf
  s_nop 1
  v_max_f32_dpp v50, v50, v50 quad_perm:[2,3,0,1] row_mask:0xf bank_mask:0xf
  s_nop 1
  v_max_f32_dpp v50, v50, v50 row_half_mirror row_mask:0xf bank_mask:0xf
  s_nop 1
  v_max_f32_dpp v50, v50, v50 row_mirror row_mask:0xf bank_mask:0xf
  v_mov_b32 v47, v50
  s_nop 1
  v_permlane16_swap_b32 v50, v47
  v_max_f32 v50, v50, v47
  v_sub_f32 v48, v36, v50
  v_sub_f32 v49, v44, v50
  v_exp_f32 v48, v48
  v_exp_f32 v49, v49
  s_add_u32 s31, s31, 0x100
  v_fma_f32 v39, v49, s37, v48
  v_cndmask_b32 v41, v48, v49, s[38:39]
  s_nop 0
  v_add_f32_dpp v39, v39, v39 quad_perm:[1,0,3,2] row_mask:0xf bank_mask:0xf
  v_cndmask_b32 v40, v49, v48, s[38:39]
  v_mov_b32_dpp v46, v41 quad_perm:[1,0,3,2] row_mask:0xf bank_mask:0xf
  v_add_f32_dpp v39, v39, v39 quad_perm:[2,3,0,1] row_mask:0xf bank_mask:0xf
  v_cndmask_b32 v42, v46, v40, s[38:39]
  v_cndmask_b32 v43, v40, v46, s[38:39]
  v_add_f32_dpp v39, v39, v39 row_half_mirror row_mask:0xf bank_mask:0xf
  s_nop 1
  v_add_f32_dpp v47, v39, v39 row_mirror row_mask:0xf bank_mask:0xf
  v_add_f32_dpp v39, v39, v39 row_mirror row_mask:0xf bank_mask:0xf
  s_nop 1
  v_permlane16_swap_b32 v39, v47
  v_add_f32 v39, v39, v47
  v_rcp_f32 v39, v39
  s_mov_b64 exec, s[28:29]
  v_mul_f32 v42, v42, v39
  v_mul_f32 v43, v43, v39
  v_cvt_pk_bf16_f32 v42, v42, v43
  v_min_u32 v42, -2, v42
  s_branch cB_sc1_pst
cB_sc1_retry:
  s_cmp_lg_u32 s62, 0
  s_cbranch_scc1 cB_sc1_cont
  s_waitcnt vmcnt(0) lgkmcnt(0)
cB_sc1_rv:
  buffer_load_dwordx4 v[8:11], v2, s[8:11], s20 offen offset:0 sc1
  buffer_load_dwordx4 v[12:15], v2, s[8:11], s20 offen offset:1024 sc1
  buffer_load_dwordx4 v[16:19], v2, s[8:11], s20 offen offset:2048 sc1
  buffer_load_dwordx4 v[20:23], v2, s[8:11], s20 offen offset:3072 sc1
  buffer_load_dwordx4 v[24:27], v2, s[8:11], s23 offen offset:0 sc1
  buffer_load_dwordx4 v[28:31], v2, s[8:11], s23 offen offset:1024 sc1
  buffer_load_dwordx4 v[32:35], v2, s[8:11], s23 offen offset:2048 sc1
  s_waitcnt vmcnt(0)
  v_max3_u32 v118, v8, v9, v10
  v_max3_u32 v118, v118, v11, v12
  v_max3_u32 v118, v118, v13, v14
  v_max3_u32 v118, v118, v15, v16
  v_max3_u32 v118, v118, v17, v18
  v_max3_u32 v118, v118, v19, v20
  v_max3_u32 v118, v118, v21, v22
  v_max3_u32 v118, v118, v23, v24
  v_max3_u32 v118, v118, v25, v26
  v_max3_u32 v118, v118, v27, v28
  v_max3_u32 v118, v118, v29, v30
  v_max3_u32 v118, v118, v31, v32
  v_max3_u32 v118, v118, v33, v34
  v_max_u32 v118, v118, v35
  v_cmp_eq_u32 vcc, -1, v118
  s_cbranch_vccz cB_sc1_rk
  s_add_u32 s30, s30, 1
  s_cmp_lt_u32 s30, 400000
  s_cbranch_scc1 cB_sc1_rv
  s_branch cB_abort
cB_sc1_rk:
  s_mov_b32 s62, 1
  v_mov_b32 v36, 0
  v_mov_b32 v37, 0
  v_mov_b32 v38, 0
  v_mov_b32 v39, 0
  v_mov_b32 v40, 0
  v_mov_b32 v41, 0
  v_mov_b32 v42, 0
  v_mov_b32 v43, 0
  v_mov_b32 v44, 0
  v_mov_b32 v45, 0
  v_mov_b32 v46, 0
  v_mov_b32 v47, 0
  v_mov_b32 v48, 0
  v_mov_b32 v49, 0
  v_mov_b32 v50, 0
  v_mov_b32 v51, 0
  v_mov_b32 v52, 0
  v_mov_b32 v53, 0
  v_mov_b32 v54, 0
  v_mov_b32 v55, 0
  v_mov_b32 v56, 0
  v_mov_b32 v57, 0
  v_mov_b32 v58, 0
  v_mov_b32 v59, 0
  v_mov_b32 v60, 0
  v_mov_b32 v61, 0
  v_mov_b32 v62, 0
  v_mov_b32 v63, 0
  v_mov_b32 v88, 0
  v_mov_b32 v89, 0
  v_mov_b32 v90, 0
  v_mov_b32 v91, 0
  v_mov_b32 v92, 0
  v_mov_b32 v93, 0
  v_mov_b32 v94, 0
  v_mov_b32 v95, 0
  v_mov_b32 v64, 0
  v_mov_b32 v65, 0
  s_add_u32 s31, s31, 1
  ds_read_b128 v[96:99], v117 offset:0
  ds_read_b128 v[100:103], v117 offset:1024
  ds_read_b128 v[104:107], v117 offset:14336
  ds_read_b128 v[108:111], v117 offset:15360
  v_smfmac_f32_16x16x64_bf16 v[36:39], v[8:11], a[0:7], v3
  v_smfmac_f32_16x16x64_bf16 v[40:43], v[8:11], a[56:63], v3
  v_smfmac_f32_16x16x64_bf16 v[44:47], v[8:11], a[112:119], v3
  v_smfmac_f32_16x16x64_bf16 v[48:51], v[8:11], a[168:175], v3
  v_smfmac_f32_16x16x64_bf16 v[52:55], v[8:11], a[224:231], v3
  v_smfmac_f32_16x16x64_bf16 v[56:59], v[8:11], v[144:151], v3
  v_smfmac_f32_16x16x64_bf16 v[60:63], v[8:11], v[200:207], v3
  v_smfmac_f32_16x16x64_bf16 v[36:39], v[12:15], a[8:15], v3
  v_smfmac_f32_16x16x64_bf16 v[40:43], v[12:15], a[64:71], v3
  v_smfmac_f32_16x16x64_bf16 v[44:47], v[12:15], a[120:127], v3
  v_smfmac_f32_16x16x64_bf16 v[48:51], v[12:15], a[176:183], v3
  v_smfmac_f32_16x16x64_bf16 v[52:55], v[12:15], a[232:239], v3
  v_smfmac_f32_16x16x64_bf16 v[56:59], v[12:15], v[152:159], v3
  v_smfmac_f32_16x16x64_bf16 v[60:63], v[12:15], v[208:215], v3
  v_smfmac_f32_16x16x64_bf16 v[36:39], v[16:19], a[16:23], v3
  v_smfmac_f32_16x16x64_bf16 v[40:43], v[16:19], a[72:79], v3
  v_smfmac_f32_16x16x64_bf16 v[44:47], v[16:19], a[128:135], v3
  v_smfmac_f32_16x16x64_bf16 v[48:51], v[16:19], a[184:191], v3
  v_smfmac_f32_16x16x64_bf16 v[52:55], v[16:19], a[240:247], v3
  v_smfmac_f32_16x16x64_bf16 v[56:59], v[16:19], v[160:167], v3
  v_smfmac_f32_16x16x64_bf16 v[60:63], v[16:19], v[216:223], v3
  v_smfmac_f32_16x16x64_bf16 v[36:39], v[20:23], a[24:31], v3
  v_smfmac_f32_16x16x64_bf16 v[40:43], v[20:23], a[80:87], v3
  v_smfmac_f32_16x16x64_bf16 v[44:47], v[20:23], a[136:143], v3
  v_smfmac_f32_16x16x64_bf16 v[48:51], v[20:23], a[192:199], v3
  v_smfmac_f32_16x16x64_bf16 v[52:55], v[20:23], a[248:255], v3
  v_smfmac_f32_16x16x64_bf16 v[56:59], v[20:23], v[168:175], v3
  v_smfmac_f32_16x16x64_bf16 v[60:63], v[20:23], v[224:231], v3
  s_branch cB_sc1_ph2
.p2align 6

cB_sc2_loop:
  s_add_u32 s23, s20, 4096
  s_add_u32 s21, s20, 25600
  v_mov_b32 v48, 0
  v_mov_b32 v49, 0
  v_mov_b32 v50, 0
  v_mov_b32 v51, 0
  v_mov_b32 v52, 0
  v_mov_b32 v53, 0
  v_mov_b32 v54, 0
  v_mov_b32 v55, 0
  v_mov_b32 v56, 0
  v_mov_b32 v57, 0
  v_mov_b32 v58, 0
  v_mov_b32 v59, 0
  v_mov_b32 v60, 0
  v_mov_b32 v61, 0
  v_mov_b32 v62, 0
  v_mov_b32 v63, 0
  v_mov_b32 v88, 0
  v_mov_b32 v89, 0
  v_mov_b32 v90, 0
  v_mov_b32 v91, 0
  v_mov_b32 v92, 0
  v_mov_b32 v93, 0
  v_mov_b32 v94, 0
  v_mov_b32 v95, 0
  v_mov_b32 v66, 0
  v_mov_b32 v67, 0
  s_mov_b32 s30, 0
  s_mov_b32 s62, 0
  s_waitcnt vmcnt(0)
  s_barrier
cB_sc2_ld:
  buffer_load_dwordx4 v[8:11], v2, s[8:11], s20 offen offset:0 sc1
  v_mov_b32 v36, 0
  v_mov_b32 v37, 0
  v_mov_b32 v38, 0
  v_mov_b32 v39, 0
  buffer_load_dwordx4 v[12:15], v2, s[8:11], s20 offen offset:1024 sc1
  v_mov_b32 v40, 0
  v_mov_b32 v41, 0
  v_mov_b32 v42, 0
  v_mov_b32 v43, 0
  buffer_load_dwordx4 v[16:19], v2, s[8:11], s20 offen offset:2048 sc1
  v_mov_b32 v44, 0
  v_mov_b32 v45, 0
  v_mov_b32 v46, 0
  v_mov_b32 v47, 0
  ds_read_b128 v[96:99], v117 offset:0
  ds_read_b128 v[100:103], v117 offset:1024
  ds_read_b128 v[104:107], v117 offset:14336
  ds_read_b128 v[108:111], v117 offset:15360
  s_waitcnt vmcnt(2)
  v_smfmac_f32_16x16x64_bf16 v[36:39], v[8:11], a[0:7], v3
  v_smfmac_f32_16x16x64_bf16 v[40:43], v[8:11], a[56:63], v3
  buffer_load_dwordx4 v[20:23], v2, s[8:11], s20 offen offset:3072 sc1
  v_smfmac_f32_16x16x64_bf16 v[44:47], v[8:11], a[112:119], v3
  v_smfmac_f32_16x16x64_bf16 v[48:51], v[8:11], a[168:175], v3
  v_smfmac_f32_16x16x64_bf16 v[52:55], v[8:11], a[224:231], v3
  buffer_load_dwordx4 v[24:27], v2, s[8:11], s23 offen offset:0 sc1
  v_smfmac_f32_16x16x64_bf16 v[56:59], v[8:11], v[144:151], v3
  v_smfmac_f32_16x16x64_bf16 v[60:63], v[8:11], v[200:207], v3
  s_waitcnt vmcnt(3)
  v_smfmac_f32_16x16x64_bf16 v[36:39], v[12:15], a[8:15], v3
  v_smfmac_f32_16x16x64_bf16 v[40:43], v[12:15], a[64:71], v3
  buffer_load_dwordx4 v[28:31], v2, s[8:11], s23 offen offset:1024 sc1
  v_smfmac_f32_16x16x64_bf16 v[44:47], v[12:15], a[120:127], v3
  v_smfmac_f32_16x16x64_bf16 v[48:51], v[12:15], a[176:183], v3
  v_smfmac_f32_16x16x64_bf16 v[52:55], v[12:15], a[232:239], v3
  buffer_load_dwordx4 v[32:35], v2, s[8:11], s23 offen offset:2048 sc1
  v_smfmac_f32_16x16x64_bf16 v[56:59], v[12:15], v[152:159], v3
  v_smfmac_f32_16x16x64_bf16 v[60:63], v[12:15], v[208:215], v3
  s_waitcnt vmcnt(4)
  v_smfmac_f32_16x16x64_bf16 v[36:39], v[16:19], a[16:23], v3
  v_smfmac_f32_16x16x64_bf16 v[40:43], v[16:19], a[72:79], v3
  v_smfmac_f32_16x16x64_bf16 v[44:47], v[16:19], a[128:135], v3
  v_smfmac_f32_16x16x64_bf16 v[48:51], v[16:19], a[184:191], v3
  v_smfmac_f32_16x16x64_bf16 v[52:55], v[16:19], a[240:247], v3
  v_smfmac_f32_16x16x64_bf16 v[56:59], v[16:19], v[160:167], v3
  v_smfmac_f32_16x16x64_bf16 v[60:63], v[16:19], v[216:223], v3
  s_waitcnt vmcnt(3)
  v_smfmac_f32_16x16x64_bf16 v[36:39], v[20:23], a[24:31], v3
  v_smfmac_f32_16x16x64_bf16 v[40:43], v[20:23], a[80:87], v3
  v_smfmac_f32_16x16x64_bf16 v[44:47], v[20:23], a[136:143], v3
  v_smfmac_f32_16x16x64_bf16 v[48:51], v[20:23], a[192:199], v3
  v_smfmac_f32_16x16x64_bf16 v[52:55], v[20:23], a[248:255], v3
  v_smfmac_f32_16x16x64_bf16 v[56:59], v[20:23], v[168:175], v3
  v_smfmac_f32_16x16x64_bf16 v[60:63], v[20:23], v[224:231], v3
  s_waitcnt vmcnt(0)
cB_sc2_ph2:
  v_smfmac_f32_16x16x64_bf16 v[60:63], v[24:27], v[232:239], v3
  ds_read_b128 v[8:11], v116 offset:4096
  ds_read_b128 v[12:15], v116 offset:5120
  v_smfmac_f32_16x16x64_bf16 v[60:63], v[28:31], v[240:247], v3
  buffer_load_dword v119, v0, s[8:11], s24 offen sc1
  v_smfmac_f32_16x16x64_bf16 v[60:63], v[32:35], v[248:255], v3
  v_mov_b32 v80, v28
  v_smfmac_f32_16x16x64_bf16 v[52:55], v[24:27], v[120:127], v3
  v_mov_b32 v81, v29
  v_smfmac_f32_16x16x64_bf16 v[52:55], v[28:31], v[128:135], v3
  v_mov_b32 v82, v34
  v_smfmac_f32_16x16x64_bf16 v[52:55], v[32:35], v[136:143], v3
  v_cvt_pk_bf16_f32 v64, v60, v61
  v_smfmac_f32_16x16x64_bf16 v[56:59], v[24:27], v[176:183], v3
  v_cvt_pk_bf16_f32 v65, v62, v63
  v_smfmac_f32_16x16x64_bf16 v[56:59], v[28:31], v[184:191], v3
  v_mov_b32 v83, v35
  v_mfma_f32_16x16x32_bf16 v[68:71], v[64:67], v[4:7], 0
  v_smfmac_f32_16x16x64_bf16 v[56:59], v[32:35], v[192:199], v3
  v_cvt_pk_bf16_f32 v64, v52, v53
  v_smfmac_f32_16x16x64_bf16 v[36:39], v[24:27], a[32:39], v3
  v_cvt_pk_bf16_f32 v65, v54, v55
  v_smfmac_f32_16x16x64_bf16 v[36:39], v[28:31], a[40:47], v3
  v_cvt_pk_bf16_f32 v78, v68, v69
  v_smfmac_f32_16x16x64_bf16 v[36:39], v[32:35], a[48:55], v3
  v_cvt_pk_bf16_f32 v79, v70, v71
  v_cvt_pk_bf16_f32 v66, v56, v57
  v_smfmac_f32_16x16x64_bf16 v[40:43], v[24:27], a[88:95], v3
  v_cvt_pk_bf16_f32 v67, v58, v59
  v_smfmac_f32_16x16x64_bf16 v[40:43], v[28:31], a[96:103], v3
  v_mfma_f32_16x16x32_bf16 v[72:75], v[64:67], v[4:7], 0
  ds_read_b128 v[52:55], v116 offset:18432
  ds_read_b128 v[56:59], v116 offset:19456
  v_smfmac_f32_16x16x64_bf16 v[40:43], v[32:35], a[104:111], v3
  v_cvt_pk_bf16_f32 v64, v36, v37
  v_smfmac_f32_16x16x64_bf16 v[44:47], v[24:27], a[144:151], v3
  v_cvt_pk_bf16_f32 v65, v38, v39
  v_smfmac_f32_16x16x64_bf16 v[44:47], v[28:31], a[152:159], v3
  v_cvt_pk_bf16_f32 v76, v72, v73
  v_smfmac_f32_16x16x64_bf16 v[44:47], v[32:35], a[160:167], v3
  v_cvt_pk_bf16_f32 v77, v74, v75
  v_cvt_pk_bf16_f32 v66, v40, v41
  v_smfmac_f32_16x16x64_bf16 v[48:51], v[24:27], a[200:207], v3
  v_cvt_pk_bf16_f32 v67, v42, v43
  v_smfmac_f32_16x16x64_bf16 v[48:51], v[28:31], a[208:215], v3
  v_mfma_f32_16x16x32_bf16 v[68:71], v[64:67], v[4:7], 0
  v_smfmac_f32_16x16x64_bf16 v[48:51], v[32:35], a[216:223], v3
  v_cvt_pk_bf16_f32 v64, v44, v45
  v_mfma_f32_16x16x32_bf16 v[84:87], v[80:83], v[76:79], 0
  v_cvt_pk_bf16_f32 v65, v46, v47
  s_waitcnt lgkmcnt(0)
  v_smfmac_f32_16x16x64_bf16 v[88:91], v[76:79], v[96:103], v3
  v_cvt_pk_bf16_f32 v60, v68, v69
  v_cvt_pk_bf16_f32 v61, v70, v71
  v_cvt_pk_bf16_f32 v66, v48, v49
  v_cvt_pk_bf16_f32 v67, v50, v51
  s_nop 1
  v_mfma_f32_16x16x32_bf16 v[72:75], v[64:67], v[4:7], 0
  v_smfmac_f32_16x16x64_bf16 v[92:95], v[76:79], v[104:111], v3
  s_nop 4
  v_cvt_pk_bf16_f32 v62, v72, v73
  v_cvt_pk_bf16_f32 v63, v74, v75
  s_nop 1
  v_mfma_f32_16x16x32_bf16 v[84:87], v[16:19], v[60:63], v[84:87]
  v_smfmac_f32_16x16x64_bf16 v[88:91], v[60:63], v[8:15], v3
  v_smfmac_f32_16x16x64_bf16 v[92:95], v[60:63], v[52:59], v3
  s_nop 1
  v_permlane32_swap_b32 v84, v86
  v_permlane32_swap_b32 v85, v87
  s_nop 0
  v_cmp_u_f32 vcc, v88, v89
  v_add_f32_dpp v84, v86, v84 row_ror:8 row_mask:0xf bank_mask:0xf
  v_add_f32_dpp v85, v87, v85 row_ror:8 row_mask:0xf bank_mask:0xf
  v_permlane32_swap_b32 v88, v92
  v_permlane32_swap_b32 v89, v93
  ds_write2_b32 v113, v84, v85 offset0:0 offset1:4
  v_permlane32_swap_b32 v90, v94
  v_permlane32_swap_b32 v91, v95
  v_add_f32 v88, v88, v92
  v_add_f32 v89, v89, v93
  v_add_f32 v90, v90, v94
  v_add_f32 v91, v91, v95
  ds_write2_b64 v112, v[88:89], v[90:91] offset0:0 offset1:128
  s_cbranch_vccnz cB_sc2_retry
cB_sc2_cont:
  s_waitcnt lgkmcnt(0)
  s_barrier
  ds_read_b128 v[36:39], v114
  ds_read_b128 v[44:47], v115
  v_lshl_add_u32 v56, v2, 3, s36
  s_waitcnt lgkmcnt(0)
  v_add_f32 v36, v36, v38
  v_add_f32 v37, v37, v39
  v_add_f32 v44, v44, v45
  s_mov_b64 exec, 65535
  buffer_store_dword v2, v56, s[8:11], s20 offen sc1
  s_mov_b64 exec, -1
  v_add_f32 v46, v46, v47
  v_permlane32_swap_b32 v36, v37
  v_add_f32 v44, v44, v46
  v_add_f32 v36, v36, v37
  v_exp_f32 v49, v44
  v_exp_f32 v48, v36
  v_add_f32 v50, abs(v36), abs(v44)
  v_fma_f32 v39, v49, s37, v48
  v_cmp_ngt_f32 vcc, s56, v50
  v_cndmask_b32 v41, v48, v49, s[38:39]
  v_add_f32_dpp v39, v39, v39 quad_perm:[1,0,3,2] row_mask:0xf bank_mask:0xf
  v_cndmask_b32 v40, v49, v48, s[38:39]
  v_mov_b32_dpp v46, v41 quad_perm:[1,0,3,2] row_mask:0xf bank_mask:0xf
  v_add_f32_dpp v39, v39, v39 quad_perm:[2,3,0,1] row_mask:0xf bank_mask:0xf
  v_cndmask_b32 v42, v46, v40, s[38:39]
  v_cndmask_b32 v43, v40, v46, s[38:39]
  v_add_f32_dpp v39, v39, v39 row_half_mirror row_mask:0xf bank_mask:0xf
  s_cbranch_vccnz cB_sc2_slow
  s_nop 0
  v_add_f32_dpp v47, v39, v39 row_mirror row_mask:0xf bank_mask:0xf
  v_add_f32_dpp v39, v39, v39 row_mirror row_mask:0xf bank_mask:0xf
  s_nop 1
  v_permlane16_swap_b32 v39, v47
  v_add_f32 v39, v39, v47
  v_rcp_f32 v39, v39
  s_mov_b64 exec, s[28:29]
  v_mul_f32 v42, v42, v39
  v_mul_f32 v43, v43, v39
  v_cvt_pk_bf16_f32 v42, v42, v43
cB_sc2_pst:
  buffer_store_dword v42, v1, s[8:11], s20 offen sc1
  s_mov_b64 exec, -1
  s_barrier
  s_add_u32 s24, s24, 28672
  s_add_u32 s35, s35, 28672
  s_xor_b32 s25, s25, 28672
  s_add_u32 m0, s25, 14336
  s_nop 0
  buffer_load_dwordx4 v2, s[8:11], s24 offen offset:0 sc1 lds
  buffer_load_dwordx4 v2, s[8:11], s24 offen offset:1024 sc1 lds
  buffer_load_dwordx4 v2, s[8:11], s24 offen offset:2048 sc1 lds
  buffer_load_dwordx4 v2, s[8:11], s24 offen offset:3072 sc1 lds
  s_add_u32 m0, s25, 18432
  s_add_u32 s22, s24, 4096
  buffer_load_dwordx4 v2, s[8:11], s22 offen offset:0 sc1 lds
  buffer_load_dwordx4 v2, s[8:11], s22 offen offset:1024 sc1 lds
  buffer_load_dwordx4 v2, s[8:11], s22 offen offset:2048 sc1 lds
  v_xor_b32 v116, 28672, v116
  v_add_u32 v117, s57, v117
  s_sub_u32 s57, 0, s57
  s_add_u32 s19, s19, 1
  s_mov_b32 s20, s21
  s_cmp_lt_u32 s19, 63
  s_cbranch_scc1 cB_sc2_loop
  s_branch cB_done
cB_sc2_slow:
  v_max_f32 v50, v36, v44
  s_nop 1
  v_max_f32_dpp v50, v50, v50 quad_perm:[1,0,3,2] row_mask:0xf bank_mask:0xf
  s_nop 1
  v_max_f32_dpp v50, v50, v50 quad_perm:[2,3,0,1] row_mask:0xf bank_mask:0xf
  s_nop 1
  v_max_f32_dpp v50, v50, v50 row_half_mirror row_mask:0xf bank_mask:0xf
  s_nop 1
  v_max_f32_dpp v50, v50, v50 row_mirror row_mask:0xf bank_mask:0xf
  v_mov_b32 v47, v50
  s_nop 1
  v_permlane16_swap_b32 v50, v47
  v_max_f32 v50, v50, v47
  v_sub_f32 v48, v36, v50
  v_sub_f32 v49, v44, v50
  v_exp_f32 v48, v48
  v_exp_f32 v49, v49
  s_add_u32 s31, s31, 0x100
  v_fma_f32 v39, v49, s37, v48
  v_cndmask_b32 v41, v48, v49, s[38:39]
  s_nop 0
  v_add_f32_dpp v39, v39, v39 quad_perm:[1,0,3,2] row_mask:0xf bank_mask:0xf
  v_cndmask_b32 v40, v49, v48, s[38:39]
  v_mov_b32_dpp v46, v41 quad_perm:[1,0,3,2] row_mask:0xf bank_mask:0xf
  v_add_f32_dpp v39, v39, v39 quad_perm:[2,3,0,1] row_mask:0xf bank_mask:0xf
  v_cndmask_b32 v42, v46, v40, s[38:39]
  v_cndmask_b32 v43, v40, v46, s[38:39]
  v_add_f32_dpp v39, v39, v39 row_half_mirror row_mask:0xf bank_mask:0xf
  s_nop 1
  v_add_f32_dpp v47, v39, v39 row_mirror row_mask:0xf bank_mask:0xf
  v_add_f32_dpp v39, v39, v39 row_mirror row_mask:0xf bank_mask:0xf
  s_nop 1
  v_permlane16_swap_b32 v39, v47
  v_add_f32 v39, v39, v47
  v_rcp_f32 v39, v39
  s_mov_b64 exec, s[28:29]
  v_mul_f32 v42, v42, v39
  v_mul_f32 v43, v43, v39
  v_cvt_pk_bf16_f32 v42, v42, v43
  v_min_u32 v42, -2, v42
  s_branch cB_sc2_pst
cB_sc2_retry:
  s_cmp_lg_u32 s62, 0
  s_cbranch_scc1 cB_sc2_cont
  s_waitcnt vmcnt(0) lgkmcnt(0)
cB_sc2_rv:
  buffer_load_dwordx4 v[8:11], v2, s[8:11], s20 offen offset:0 sc1
  buffer_load_dwordx4 v[12:15], v2, s[8:11], s20 offen offset:1024 sc1
  buffer_load_dwordx4 v[16:19], v2, s[8:11], s20 offen offset:2048 sc1
  buffer_load_dwordx4 v[20:23], v2, s[8:11], s20 offen offset:3072 sc1
  buffer_load_dwordx4 v[24:27], v2, s[8:11], s23 offen offset:0 sc1
  buffer_load_dwordx4 v[28:31], v2, s[8:11], s23 offen offset:1024 sc1
  buffer_load_dwordx4 v[32:35], v2, s[8:11], s23 offen offset:2048 sc1
  s_waitcnt vmcnt(0)
  v_max3_u32 v118, v8, v9, v10
  v_max3_u32 v118, v118, v11, v12
  v_max3_u32 v118, v118, v13, v14
  v_max3_u32 v118, v118, v15, v16
  v_max3_u32 v118, v118, v17, v18
  v_max3_u32 v118, v118, v19, v20
  v_max3_u32 v118, v118, v21, v22
  v_max3_u32 v118, v118, v23, v24
  v_max3_u32 v118, v118, v25, v26
  v_max3_u32 v118, v118, v27, v28
  v_max3_u32 v118, v118, v29, v30
  v_max3_u32 v118, v118, v31, v32
  v_max3_u32 v118, v118, v33, v34
  v_max_u32 v118, v118, v35
  v_cmp_eq_u32 vcc, -1, v118
  s_cbranch_vccz cB_sc2_rk
  s_add_u32 s30, s30, 1
  s_cmp_lt_u32 s30, 400000
  s_cbranch_scc1 cB_sc2_rv
  s_branch cB_abort
cB_sc2_rk:
  s_mov_b32 s62, 1
  v_mov_b32 v36, 0
  v_mov_b32 v37, 0
  v_mov_b32 v38, 0
  v_mov_b32 v39, 0
  v_mov_b32 v40, 0
  v_mov_b32 v41, 0
  v_mov_b32 v42, 0
  v_mov_b32 v43, 0
  v_mov_b32 v44, 0
  v_mov_b32 v45, 0
  v_mov_b32 v46, 0
  v_mov_b32 v47, 0
  v_mov_b32 v48, 0
  v_mov_b32 v49, 0
  v_mov_b32 v50, 0
  v_mov_b32 v51, 0
  v_mov_b32 v52, 0
  v_mov_b32 v53, 0
  v_mov_b32 v54, 0
  v_mov_b32 v55, 0
  v_mov_b32 v56, 0
  v_mov_b32 v57, 0
  v_mov_b32 v58, 0
  v_mov_b32 v59, 0
  v_mov_b32 v60, 0
  v_mov_b32 v61, 0
  v_mov_b32 v62, 0
  v_mov_b32 v63, 0
  v_mov_b32 v88, 0
  v_mov_b32 v89, 0
  v_mov_b32 v90, 0
  v_mov_b32 v91, 0
  v_mov_b32 v92, 0
  v_mov_b32 v93, 0
  v_mov_b32 v94, 0
  v_mov_b32 v95, 0
  v_mov_b32 v66, 0
  v_mov_b32 v67, 0
  s_add_u32 s31, s31, 1
  ds_read_b128 v[96:99], v117 offset:0
  ds_read_b128 v[100:103], v117 offset:1024
  ds_read_b128 v[104:107], v117 offset:14336
  ds_read_b128 v[108:111], v117 offset:15360
  v_smfmac_f32_16x16x64_bf16 v[36:39], v[8:11], a[0:7], v3
  v_smfmac_f32_16x16x64_bf16 v[40:43], v[8:11], a[56:63], v3
  v_smfmac_f32_16x16x64_bf16 v[44:47], v[8:11], a[112:119], v3
  v_smfmac_f32_16x16x64_bf16 v[48:51], v[8:11], a[168:175], v3
  v_smfmac_f32_16x16x64_bf16 v[52:55], v[8:11], a[224:231], v3
  v_smfmac_f32_16x16x64_bf16 v[56:59], v[8:11], v[144:151], v3
  v_smfmac_f32_16x16x64_bf16 v[60:63], v[8:11], v[200:207], v3
  v_smfmac_f32_16x16x64_bf16 v[36:39], v[12:15], a[8:15], v3
  v_smfmac_f32_16x16x64_bf16 v[40:43], v[12:15], a[64:71], v3
  v_smfmac_f32_16x16x64_bf16 v[44:47], v[12:15], a[120:127], v3
  v_smfmac_f32_16x16x64_bf16 v[48:51], v[12:15], a[176:183], v3
  v_smfmac_f32_16x16x64_bf16 v[52:55], v[12:15], a[232:239], v3
  v_smfmac_f32_16x16x64_bf16 v[56:59], v[12:15], v[152:159], v3
  v_smfmac_f32_16x16x64_bf16 v[60:63], v[12:15], v[208:215], v3
  v_smfmac_f32_16x16x64_bf16 v[36:39], v[16:19], a[16:23], v3
  v_smfmac_f32_16x16x64_bf16 v[40:43], v[16:19], a[72:79], v3
  v_smfmac_f32_16x16x64_bf16 v[44:47], v[16:19], a[128:135], v3
  v_smfmac_f32_16x16x64_bf16 v[48:51], v[16:19], a[184:191], v3
  v_smfmac_f32_16x16x64_bf16 v[52:55], v[16:19], a[240:247], v3
  v_smfmac_f32_16x16x64_bf16 v[56:59], v[16:19], v[160:167], v3
  v_smfmac_f32_16x16x64_bf16 v[60:63], v[16:19], v[216:223], v3
  v_smfmac_f32_16x16x64_bf16 v[36:39], v[20:23], a[24:31], v3
  v_smfmac_f32_16x16x64_bf16 v[40:43], v[20:23], a[80:87], v3
  v_smfmac_f32_16x16x64_bf16 v[44:47], v[20:23], a[136:143], v3
  v_smfmac_f32_16x16x64_bf16 v[48:51], v[20:23], a[192:199], v3
  v_smfmac_f32_16x16x64_bf16 v[52:55], v[20:23], a[248:255], v3
  v_smfmac_f32_16x16x64_bf16 v[56:59], v[20:23], v[168:175], v3
  v_smfmac_f32_16x16x64_bf16 v[60:63], v[20:23], v[224:231], v3
  s_branch cB_sc2_ph2
.p2align 6

cB_sc3_loop:
  s_add_u32 s23, s20, 4096
  s_add_u32 s21, s20, 25600
  v_mov_b32 v48, 0
  v_mov_b32 v49, 0
  v_mov_b32 v50, 0
  v_mov_b32 v51, 0
  v_mov_b32 v52, 0
  v_mov_b32 v53, 0
  v_mov_b32 v54, 0
  v_mov_b32 v55, 0
  v_mov_b32 v56, 0
  v_mov_b32 v57, 0
  v_mov_b32 v58, 0
  v_mov_b32 v59, 0
  v_mov_b32 v60, 0
  v_mov_b32 v61, 0
  v_mov_b32 v62, 0
  v_mov_b32 v63, 0
  v_mov_b32 v88, 0
  v_mov_b32 v89, 0
  v_mov_b32 v90, 0
  v_mov_b32 v91, 0
  v_mov_b32 v92, 0
  v_mov_b32 v93, 0
  v_mov_b32 v94, 0
  v_mov_b32 v95, 0
  v_mov_b32 v64, 0
  v_mov_b32 v65, 0
  s_mov_b32 s30, 0
  s_mov_b32 s62, 0
  s_waitcnt vmcnt(0)
  s_barrier
cB_sc3_ld:
  buffer_load_dwordx4 v[8:11], v2, s[8:11], s20 offen offset:0 sc1
  v_mov_b32 v36, 0
  v_mov_b32 v37, 0
  v_mov_b32 v38, 0
  v_mov_b32 v39, 0
  buffer_load_dwordx4 v[12:15], v2, s[8:11], s20 offen offset:1024 sc1
  v_mov_b32 v40, 0
  v_mov_b32 v41, 0
  v_mov_b32 v42, 0
  v_mov_b32 v43, 0
  buffer_load_dwordx4 v[16:19], v2, s[8:11], s20 offen offset:2048 sc1
  v_mov_b32 v44, 0
  v_mov_b32 v45, 0
  v_mov_b32 v46, 0
  v_mov_b32 v47, 0
  ds_read_b128 v[96:99], v117 offset:0
  ds_read_b128 v[100:103], v117 offset:1024
  ds_read_b128 v[104:107], v117 offset:14336
  ds_read_b128 v[108:111], v117 offset:15360
  s_waitcnt vmcnt(2)
  v_smfmac_f32_16x16x64_bf16 v[36:39], v[8:11], a[0:7], v3
  v_smfmac_f32_16x16x64_bf16 v[40:43], v[8:11], a[56:63], v3
  buffer_load_dwordx4 v[20:23], v2, s[8:11], s20 offen offset:3072 sc1
  v_smfmac_f32_16x16x64_bf16 v[44:47], v[8:11], a[112:119], v3
  v_smfmac_f32_16x16x64_bf16 v[48:51], v[8:11], a[168:175], v3
  v_smfmac_f32_16x16x64_bf16 v[52:55], v[8:11], a[224:231], v3
  buffer_load_dwordx4 v[24:27], v2, s[8:11], s23 offen offset:0 sc1
  v_smfmac_f32_16x16x64_bf16 v[56:59], v[8:11], v[144:151], v3
  v_smfmac_f32_16x16x64_bf16 v[60:63], v[8:11], v[200:207], v3
  s_waitcnt vmcnt(3)
  v_smfmac_f32_16x16x64_bf16 v[36:39], v[12:15], a[8:15], v3
  v_smfmac_f32_16x16x64_bf16 v[40:43], v[12:15], a[64:71], v3
  buffer_load_dwordx4 v[28:31], v2, s[8:11], s23 offen offset:1024 sc1
  v_smfmac_f32_16x16x64_bf16 v[44:47], v[12:15], a[120:127], v3
  v_smfmac_f32_16x16x64_bf16 v[48:51], v[12:15], a[176:183], v3
  v_smfmac_f32_16x16x64_bf16 v[52:55], v[12:15], a[232:239], v3
  buffer_load_dwordx4 v[32:35], v2, s[8:11], s23 offen offset:2048 sc1
  v_smfmac_f32_16x16x64_bf16 v[56:59], v[12:15], v[152:159], v3
  v_smfmac_f32_16x16x64_bf16 v[60:63], v[12:15], v[208:215], v3
  s_waitcnt vmcnt(4)
  v_smfmac_f32_16x16x64_bf16 v[36:39], v[16:19], a[16:23], v3
  v_smfmac_f32_16x16x64_bf16 v[40:43], v[16:19], a[72:79], v3
  v_smfmac_f32_16x16x64_bf16 v[44:47], v[16:19], a[128:135], v3
  v_smfmac_f32_16x16x64_bf16 v[48:51], v[16:19], a[184:191], v3
  v_smfmac_f32_16x16x64_bf16 v[52:55], v[16:19], a[240:247], v3
  v_smfmac_f32_16x16x64_bf16 v[56:59], v[16:19], v[160:167], v3
  v_smfmac_f32_16x16x64_bf16 v[60:63], v[16:19], v[216:223], v3
  s_waitcnt vmcnt(3)
  v_smfmac_f32_16x16x64_bf16 v[36:39], v[20:23], a[24:31], v3
  v_smfmac_f32_16x16x64_bf16 v[40:43], v[20:23], a[80:87], v3
  v_smfmac_f32_16x16x64_bf16 v[44:47], v[20:23], a[136:143], v3
  v_smfmac_f32_16x16x64_bf16 v[48:51], v[20:23], a[192:199], v3
  v_smfmac_f32_16x16x64_bf16 v[52:55], v[20:23], a[248:255], v3
  v_smfmac_f32_16x16x64_bf16 v[56:59], v[20:23], v[168:175], v3
  v_smfmac_f32_16x16x64_bf16 v[60:63], v[20:23], v[224:231], v3
  s_waitcnt vmcnt(0)
cB_sc3_ph2:
  v_smfmac_f32_16x16x64_bf16 v[60:63], v[24:27], v[232:239], v3
  ds_read_b128 v[8:11], v116 offset:6144
  ds_read_b128 v[12:15], v116 offset:7168
  v_smfmac_f32_16x16x64_bf16 v[60:63], v[28:31], v[240:247], v3
  v_smfmac_f32_16x16x64_bf16 v[60:63], v[32:35], v[248:255], v3
  v_mov_b32 v80, v30
  v_smfmac_f32_16x16x64_bf16 v[52:55], v[24:27], v[120:127], v3
  v_mov_b32 v81, v31
  v_smfmac_f32_16x16x64_bf16 v[52:55], v[28:31], v[128:135], v3
  v_mov_b32 v82, v34
  v_smfmac_f32_16x16x64_bf16 v[52:55], v[32:35], v[136:143], v3
  v_cvt_pk_bf16_f32 v66, v60, v61
  v_smfmac_f32_16x16x64_bf16 v[56:59], v[24:27], v[176:183], v3
  v_cvt_pk_bf16_f32 v67, v62, v63
  v_smfmac_f32_16x16x64_bf16 v[56:59], v[28:31], v[184:191], v3
  v_mov_b32 v83, v35
  v_mfma_f32_16x16x32_bf16 v[68:71], v[64:67], v[4:7], 0
  v_smfmac_f32_16x16x64_bf16 v[56:59], v[32:35], v[192:199], v3
  v_cvt_pk_bf16_f32 v64, v52, v53
  v_smfmac_f32_16x16x64_bf16 v[36:39], v[24:27], a[32:39], v3
  v_cvt_pk_bf16_f32 v65, v54, v55
  v_smfmac_f32_16x16x64_bf16 v[36:39], v[28:31], a[40:47], v3
  v_cvt_pk_bf16_f32 v78, v68, v69
  v_smfmac_f32_16x16x64_bf16 v[36:39], v[32:35], a[48:55], v3
  v_cvt_pk_bf16_f32 v79, v70, v71
  v_cvt_pk_bf16_f32 v66, v56, v57
  v_smfmac_f32_16x16x64_bf16 v[40:43], v[24:27], a[88:95], v3
  v_cvt_pk_bf16_f32 v67, v58, v59
  v_smfmac_f32_16x16x64_bf16 v[40:43], v[28:31], a[96:103], v3
  v_mfma_f32_16x16x32_bf16 v[72:75], v[64:67], v[4:7], 0
  ds_read_b128 v[52:55], v116 offset:20480
  ds_read_b128 v[56:59], v116 offset:21504
  v_smfmac_f32_16x16x64_bf16 v[40:43], v[32:35], a[104:111], v3
  v_cvt_pk_bf16_f32 v64, v36, v37
  v_smfmac_f32_16x16x64_bf16 v[44:47], v[24:27], a[144:151], v3
  v_cvt_pk_bf16_f32 v65, v38, v39
  v_smfmac_f32_16x16x64_bf16 v[44:47], v[28:31], a[152:159], v3
  v_cvt_pk_bf16_f32 v76, v72, v73
  v_smfmac_f32_16x16x64_bf16 v[44:47], v[32:35], a[160:167], v3
  v_cvt_pk_bf16_f32 v77, v74, v75
  v_cvt_pk_bf16_f32 v66, v40, v41
  v_smfmac_f32_16x16x64_bf16 v[48:51], v[24:27], a[200:207], v3
  v_cvt_pk_bf16_f32 v67, v42, v43
  v_smfmac_f32_16x16x64_bf16 v[48:51], v[28:31], a[208:215], v3
  v_mfma_f32_16x16x32_bf16 v[68:71], v[64:67], v[4:7], 0
  v_smfmac_f32_16x16x64_bf16 v[48:51], v[32:35], a[216:223], v3
  v_cvt_pk_bf16_f32 v64, v44, v45
  v_mfma_f32_16x16x32_bf16 v[84:87], v[80:83], v[76:79], 0
  v_cvt_pk_bf16_f32 v65, v46, v47
  s_waitcnt lgkmcnt(0)
  v_smfmac_f32_16x16x64_bf16 v[88:91], v[76:79], v[96:103], v3
  v_cvt_pk_bf16_f32 v60, v68, v69
  v_cvt_pk_bf16_f32 v61, v70, v71
  v_cvt_pk_bf16_f32 v66, v48, v49
  v_cvt_pk_bf16_f32 v67, v50, v51
  s_nop 1
  v_mfma_f32_16x16x32_bf16 v[72:75], v[64:67], v[4:7], 0
  v_smfmac_f32_16x16x64_bf16 v[92:95], v[76:79], v[104:111], v3
  s_nop 4
  v_cvt_pk_bf16_f32 v62, v72, v73
  v_cvt_pk_bf16_f32 v63, v74, v75
  s_nop 1
  v_mfma_f32_16x16x32_bf16 v[84:87], v[20:23], v[60:63], v[84:87]
  v_smfmac_f32_16x16x64_bf16 v[88:91], v[60:63], v[8:15], v3
  v_smfmac_f32_16x16x64_bf16 v[92:95], v[60:63], v[52:59], v3
  s_nop 1
  v_permlane32_swap_b32 v84, v86
  v_permlane32_swap_b32 v85, v87
  s_nop 0
  v_cmp_u_f32 vcc, v88, v89
  v_add_f32_dpp v84, v86, v84 row_ror:8 row_mask:0xf bank_mask:0xf
  v_add_f32_dpp v85, v87, v85 row_ror:8 row_mask:0xf bank_mask:0xf
  v_permlane32_swap_b32 v88, v92
  v_permlane32_swap_b32 v89, v93
  ds_write2_b32 v113, v84, v85 offset0:0 offset1:4
  v_permlane32_swap_b32 v90, v94
  v_permlane32_swap_b32 v91, v95
  v_add_f32 v88, v88, v92
  v_add_f32 v89, v89, v93
  v_add_f32 v90, v90, v94
  v_add_f32 v91, v91, v95
  ds_write2_b64 v112, v[88:89], v[90:91] offset0:0 offset1:128
  s_cbranch_vccnz cB_sc3_retry
cB_sc3_cont:
  s_waitcnt lgkmcnt(0)
  s_barrier
  ds_read_b128 v[36:39], v114
  ds_read_b128 v[44:47], v115
  s_waitcnt lgkmcnt(0)
  v_add_f32 v36, v36, v38
  v_add_f32 v37, v37, v39
  v_add_f32 v44, v44, v45
  v_add_f32 v46, v46, v47
  v_permlane32_swap_b32 v36, v37
  v_add_f32 v44, v44, v46
  v_add_f32 v36, v36, v37
  v_exp_f32 v49, v44
  v_exp_f32 v48, v36
  v_add_f32 v50, abs(v36), abs(v44)
  v_fma_f32 v39, v49, s37, v48
  v_cmp_ngt_f32 vcc, s56, v50
  v_cndmask_b32 v41, v48, v49, s[38:39]
  v_add_f32_dpp v39, v39, v39 quad_perm:[1,0,3,2] row_mask:0xf bank_mask:0xf
  v_cndmask_b32 v40, v49, v48, s[38:39]
  v_mov_b32_dpp v46, v41 quad_perm:[1,0,3,2] row_mask:0xf bank_mask:0xf
  v_add_f32_dpp v39, v39, v39 quad_perm:[2,3,0,1] row_mask:0xf bank_mask:0xf
  v_cndmask_b32 v42, v46, v40, s[38:39]
  v_cndmask_b32 v43, v40, v46, s[38:39]
  v_add_f32_dpp v39, v39, v39 row_half_mirror row_mask:0xf bank_mask:0xf
  s_cbranch_vccnz cB_sc3_slow
  s_nop 0
  v_add_f32_dpp v47, v39, v39 row_mirror row_mask:0xf bank_mask:0xf
  v_add_f32_dpp v39, v39, v39 row_mirror row_mask:0xf bank_mask:0xf
  s_nop 1
  v_permlane16_swap_b32 v39, v47
  v_add_f32 v39, v39, v47
  v_rcp_f32 v39, v39
  s_mov_b64 exec, s[28:29]
  v_mul_f32 v42, v42, v39
  v_mul_f32 v43, v43, v39
  v_cvt_pk_bf16_f32 v42, v42, v43
cB_sc3_pst:
  buffer_store_dword v42, v1, s[8:11], s20 offen sc1
  s_mov_b64 exec, -1
  s_barrier
  s_add_u32 s24, s24, 28672
  s_add_u32 s35, s35, 28672
  s_xor_b32 s25, s25, 28672
  s_add_u32 m0, s25, 21504
  s_nop 0
  buffer_load_dwordx4 v2, s[8:11], s24 offen offset:0 sc1 lds
  buffer_load_dwordx4 v2, s[8:11], s24 offen offset:1024 sc1 lds
  buffer_load_dwordx4 v2, s[8:11], s24 offen offset:2048 sc1 lds
  buffer_load_dwordx4 v2, s[8:11], s24 offen offset:3072 sc1 lds
  s_add_u32 m0, s25, 25600
  s_add_u32 s22, s24, 4096
  buffer_load_dwordx4 v2, s[8:11], s22 offen offset:0 sc1 lds
  buffer_load_dwordx4 v2, s[8:11], s22 offen offset:1024 sc1 lds
  buffer_load_dwordx4 v2, s[8:11], s22 offen offset:2048 sc1 lds
  v_xor_b32 v116, 28672, v116
  v_add_u32 v117, s57, v117
  s_sub_u32 s57, 0, s57
  s_add_u32 s19, s19, 1
  s_mov_b32 s20, s21
  s_cmp_lt_u32 s19, 63
  s_cbranch_scc1 cB_sc3_loop
  s_branch cB_done
cB_sc3_slow:
  v_max_f32 v50, v36, v44
  s_nop 1
  v_max_f32_dpp v50, v50, v50 quad_perm:[1,0,3,2] row_mask:0xf bank_mask:0xf
  s_nop 1
  v_max_f32_dpp v50, v50, v50 quad_perm:[2,3,0,1] row_mask:0xf bank_mask:0xf
  s_nop 1
  v_max_f32_dpp v50, v50, v50 row_half_mirror row_mask:0xf bank_mask:0xf
  s_nop 1
  v_max_f32_dpp v50, v50, v50 row_mirror row_mask:0xf bank_mask:0xf
  v_mov_b32 v47, v50
  s_nop 1
  v_permlane16_swap_b32 v50, v47
  v_max_f32 v50, v50, v47
  v_sub_f32 v48, v36, v50
  v_sub_f32 v49, v44, v50
  v_exp_f32 v48, v48
  v_exp_f32 v49, v49
  s_add_u32 s31, s31, 0x100
  v_fma_f32 v39, v49, s37, v48
  v_cndmask_b32 v41, v48, v49, s[38:39]
  s_nop 0
  v_add_f32_dpp v39, v39, v39 quad_perm:[1,0,3,2] row_mask:0xf bank_mask:0xf
  v_cndmask_b32 v40, v49, v48, s[38:39]
  v_mov_b32_dpp v46, v41 quad_perm:[1,0,3,2] row_mask:0xf bank_mask:0xf
  v_add_f32_dpp v39, v39, v39 quad_perm:[2,3,0,1] row_mask:0xf bank_mask:0xf
  v_cndmask_b32 v42, v46, v40, s[38:39]
  v_cndmask_b32 v43, v40, v46, s[38:39]
  v_add_f32_dpp v39, v39, v39 row_half_mirror row_mask:0xf bank_mask:0xf
  s_nop 1
  v_add_f32_dpp v47, v39, v39 row_mirror row_mask:0xf bank_mask:0xf
  v_add_f32_dpp v39, v39, v39 row_mirror row_mask:0xf bank_mask:0xf
  s_nop 1
  v_permlane16_swap_b32 v39, v47
  v_add_f32 v39, v39, v47
  v_rcp_f32 v39, v39
  s_mov_b64 exec, s[28:29]
  v_mul_f32 v42, v42, v39
  v_mul_f32 v43, v43, v39
  v_cvt_pk_bf16_f32 v42, v42, v43
  v_min_u32 v42, -2, v42
  s_branch cB_sc3_pst
cB_sc3_retry:
  s_cmp_lg_u32 s62, 0
  s_cbranch_scc1 cB_sc3_cont
  s_waitcnt vmcnt(0) lgkmcnt(0)
cB_sc3_rv:
  buffer_load_dwordx4 v[8:11], v2, s[8:11], s20 offen offset:0 sc1
  buffer_load_dwordx4 v[12:15], v2, s[8:11], s20 offen offset:1024 sc1
  buffer_load_dwordx4 v[16:19], v2, s[8:11], s20 offen offset:2048 sc1
  buffer_load_dwordx4 v[20:23], v2, s[8:11], s20 offen offset:3072 sc1
  buffer_load_dwordx4 v[24:27], v2, s[8:11], s23 offen offset:0 sc1
  buffer_load_dwordx4 v[28:31], v2, s[8:11], s23 offen offset:1024 sc1
  buffer_load_dwordx4 v[32:35], v2, s[8:11], s23 offen offset:2048 sc1
  s_waitcnt vmcnt(0)
  v_max3_u32 v118, v8, v9, v10
  v_max3_u32 v118, v118, v11, v12
  v_max3_u32 v118, v118, v13, v14
  v_max3_u32 v118, v118, v15, v16
  v_max3_u32 v118, v118, v17, v18
  v_max3_u32 v118, v118, v19, v20
  v_max3_u32 v118, v118, v21, v22
  v_max3_u32 v118, v118, v23, v24
  v_max3_u32 v118, v118, v25, v26
  v_max3_u32 v118, v118, v27, v28
  v_max3_u32 v118, v118, v29, v30
  v_max3_u32 v118, v118, v31, v32
  v_max3_u32 v118, v118, v33, v34
  v_max_u32 v118, v118, v35
  v_cmp_eq_u32 vcc, -1, v118
  s_cbranch_vccz cB_sc3_rk
  s_add_u32 s30, s30, 1
  s_cmp_lt_u32 s30, 400000
  s_cbranch_scc1 cB_sc3_rv
  s_branch cB_abort
cB_sc3_rk:
  s_mov_b32 s62, 1
  v_mov_b32 v36, 0
  v_mov_b32 v37, 0
  v_mov_b32 v38, 0
  v_mov_b32 v39, 0
  v_mov_b32 v40, 0
  v_mov_b32 v41, 0
  v_mov_b32 v42, 0
  v_mov_b32 v43, 0
  v_mov_b32 v44, 0
  v_mov_b32 v45, 0
  v_mov_b32 v46, 0
  v_mov_b32 v47, 0
  v_mov_b32 v48, 0
  v_mov_b32 v49, 0
  v_mov_b32 v50, 0
  v_mov_b32 v51, 0
  v_mov_b32 v52, 0
  v_mov_b32 v53, 0
  v_mov_b32 v54, 0
  v_mov_b32 v55, 0
  v_mov_b32 v56, 0
  v_mov_b32 v57, 0
  v_mov_b32 v58, 0
  v_mov_b32 v59, 0
  v_mov_b32 v60, 0
  v_mov_b32 v61, 0
  v_mov_b32 v62, 0
  v_mov_b32 v63, 0
  v_mov_b32 v88, 0
  v_mov_b32 v89, 0
  v_mov_b32 v90, 0
  v_mov_b32 v91, 0
  v_mov_b32 v92, 0
  v_mov_b32 v93, 0
  v_mov_b32 v94, 0
  v_mov_b32 v95, 0
  v_mov_b32 v64, 0
  v_mov_b32 v65, 0
  s_add_u32 s31, s31, 1
  ds_read_b128 v[96:99], v117 offset:0
  ds_read_b128 v[100:103], v117 offset:1024
  ds_read_b128 v[104:107], v117 offset:14336
  ds_read_b128 v[108:111], v117 offset:15360
  v_smfmac_f32_16x16x64_bf16 v[36:39], v[8:11], a[0:7], v3
  v_smfmac_f32_16x16x64_bf16 v[40:43], v[8:11], a[56:63], v3
  v_smfmac_f32_16x16x64_bf16 v[44:47], v[8:11], a[112:119], v3
  v_smfmac_f32_16x16x64_bf16 v[48:51], v[8:11], a[168:175], v3
  v_smfmac_f32_16x16x64_bf16 v[52:55], v[8:11], a[224:231], v3
  v_smfmac_f32_16x16x64_bf16 v[56:59], v[8:11], v[144:151], v3
  v_smfmac_f32_16x16x64_bf16 v[60:63], v[8:11], v[200:207], v3
  v_smfmac_f32_16x16x64_bf16 v[36:39], v[12:15], a[8:15], v3
  v_smfmac_f32_16x16x64_bf16 v[40:43], v[12:15], a[64:71], v3
  v_smfmac_f32_16x16x64_bf16 v[44:47], v[12:15], a[120:127], v3
  v_smfmac_f32_16x16x64_bf16 v[48:51], v[12:15], a[176:183], v3
  v_smfmac_f32_16x16x64_bf16 v[52:55], v[12:15], a[232:239], v3
  v_smfmac_f32_16x16x64_bf16 v[56:59], v[12:15], v[152:159], v3
  v_smfmac_f32_16x16x64_bf16 v[60:63], v[12:15], v[208:215], v3
  v_smfmac_f32_16x16x64_bf16 v[36:39], v[16:19], a[16:23], v3
  v_smfmac_f32_16x16x64_bf16 v[40:43], v[16:19], a[72:79], v3
  v_smfmac_f32_16x16x64_bf16 v[44:47], v[16:19], a[128:135], v3
  v_smfmac_f32_16x16x64_bf16 v[48:51], v[16:19], a[184:191], v3
  v_smfmac_f32_16x16x64_bf16 v[52:55], v[16:19], a[240:247], v3
  v_smfmac_f32_16x16x64_bf16 v[56:59], v[16:19], v[160:167], v3
  v_smfmac_f32_16x16x64_bf16 v[60:63], v[16:19], v[216:223], v3
  v_smfmac_f32_16x16x64_bf16 v[36:39], v[20:23], a[24:31], v3
  v_smfmac_f32_16x16x64_bf16 v[40:43], v[20:23], a[80:87], v3
  v_smfmac_f32_16x16x64_bf16 v[44:47], v[20:23], a[136:143], v3
  v_smfmac_f32_16x16x64_bf16 v[48:51], v[20:23], a[192:199], v3
  v_smfmac_f32_16x16x64_bf16 v[52:55], v[20:23], a[248:255], v3
  v_smfmac_f32_16x16x64_bf16 v[56:59], v[20:23], v[168:175], v3
  v_smfmac_f32_16x16x64_bf16 v[60:63], v[20:23], v[224:231], v3
  s_branch cB_sc3_ph2
.p2align 6

cB_va0_loop:
  s_add_u32 s23, s20, 4096
  s_add_u32 s21, s20, 25600
  s_mov_b32 s30, 0
  s_cmp_lg_u32 s19, s38
  s_cbranch_scc1 cB_va0_vok
  s_branch cB_va0_voc
cB_va0_vow:
  buffer_load_dword v175, off, s[8:11], s35 sc1
  s_waitcnt vmcnt(0)
cB_va0_voc:
  v_readfirstlane_b32 s22, v175
  s_cmp_eq_u32 s22, 56
  s_cbranch_scc1 cB_va0_vod
  s_sleep 1
  s_add_u32 s30, s30, 1
  s_cmp_lt_u32 s30, 400000
  s_cbranch_scc1 cB_va0_vow
  s_branch cB_abort
cB_va0_vod:
  s_add_u32 s35, s35, 2048
  s_add_u32 s38, s19, 8
  s_and_b32 s38, s38, -8
  s_cmp_eq_u32 s19, 0
  s_cselect_b32 s38, 4, s38
cB_va0_vok:
  s_cmp_eq_u32 s19, 63
  s_cbranch_scc1 cB_done
  s_barrier
  s_add_u32 s22, s25, 0
  buffer_load_dwordx4 v[80:83], v6, s[8:11], s22 offen offset:0 sc1
  buffer_load_dwordx4 v[84:87], v6, s[8:11], s22 offen offset:1792 sc1
  s_add_u32 s22, s25, 3584
  buffer_load_dwordx4 v[88:91], v6, s[8:11], s22 offen offset:0 sc1
  buffer_load_dwordx4 v[92:95], v6, s[8:11], s22 offen offset:1792 sc1
  s_add_u32 s22, s25, 7168
  buffer_load_dwordx4 v[96:99], v6, s[8:11], s22 offen offset:0 sc1
  buffer_load_dwordx4 v[100:103], v6, s[8:11], s22 offen offset:1792 sc1
  s_add_u32 s22, s25, 10752
  buffer_load_dwordx4 v[104:107], v6, s[8:11], s22 offen offset:0 sc1
  buffer_load_dwordx4 v[108:111], v6, s[8:11], s22 offen offset:1792 sc1
  s_add_u32 s22, s25, 14336
  buffer_load_dwordx4 v[112:115], v6, s[8:11], s22 offen offset:0 sc1
  buffer_load_dwordx4 v[116:119], v6, s[8:11], s22 offen offset:1792 sc1
  s_add_u32 s22, s25, 17920
  buffer_load_dwordx4 v[120:123], v6, s[8:11], s22 offen offset:0 sc1
  buffer_load_dwordx4 v[124:127], v6, s[8:11], s22 offen offset:1792 sc1
  s_add_u32 s22, s25, 21504
  buffer_load_dwordx4 v[128:131], v6, s[8:11], s22 offen offset:0 sc1
  buffer_load_dwordx4 v[132:135], v6, s[8:11], s22 offen offset:1792 sc1
  s_add_u32 s22, s25, 25088
  buffer_load_dwordx4 v[136:139], v6, s[8:11], s22 offen offset:0 sc1
  buffer_load_dwordx4 v[140:143], v6, s[8:11], s22 offen offset:1792 sc1
  buffer_load_dword v175, off, s[8:11], s35 sc1
  s_barrier
  ds_read_b128 v[8:11], v2 offset:8192
  ds_read_b128 v[12:15], v2 offset:9216
  ds_read_b128 v[16:19], v2 offset:10240
  ds_read_b128 v[20:23], v2 offset:11264
  ds_read_b128 v[24:27], v2 offset:12288
  ds_read_b128 v[28:31], v2 offset:13312
  ds_read_b128 v[32:35], v2 offset:14336
  s_waitcnt lgkmcnt(0)
  v_smfmac_f32_16x16x64_bf16 v[36:39], v[8:11], a[0:7], v3
  v_smfmac_f32_16x16x64_bf16 v[36:39], v[12:15], a[8:15], v3
  v_smfmac_f32_16x16x64_bf16 v[36:39], v[16:19], a[16:23], v3
  v_smfmac_f32_16x16x64_bf16 v[36:39], v[20:23], a[24:31], v3
  v_smfmac_f32_16x16x64_bf16 v[36:39], v[24:27], a[32:39], v3
  v_smfmac_f32_16x16x64_bf16 v[36:39], v[28:31], a[40:47], v3
  v_smfmac_f32_16x16x64_bf16 v[36:39], v[32:35], a[48:55], v3
  v_smfmac_f32_16x16x64_bf16 v[40:43], v[8:11], a[56:63], v3
  v_smfmac_f32_16x16x64_bf16 v[40:43], v[12:15], a[64:71], v3
  v_smfmac_f32_16x16x64_bf16 v[40:43], v[16:19], a[72:79], v3
  v_smfmac_f32_16x16x64_bf16 v[40:43], v[20:23], a[80:87], v3
  v_smfmac_f32_16x16x64_bf16 v[40:43], v[24:27], a[88:95], v3
  v_smfmac_f32_16x16x64_bf16 v[40:43], v[28:31], a[96:103], v3
  v_smfmac_f32_16x16x64_bf16 v[40:43], v[32:35], a[104:111], v3
  v_smfmac_f32_16x16x64_bf16 v[44:47], v[8:11], a[112:119], v3
  v_smfmac_f32_16x16x64_bf16 v[44:47], v[12:15], a[120:127], v3
  v_smfmac_f32_16x16x64_bf16 v[44:47], v[16:19], a[128:135], v3
  v_smfmac_f32_16x16x64_bf16 v[44:47], v[20:23], a[136:143], v3
  v_permlane32_swap_b32 v36, v40
  v_smfmac_f32_16x16x64_bf16 v[44:47], v[24:27], a[144:151], v3
  v_permlane32_swap_b32 v37, v41
  v_smfmac_f32_16x16x64_bf16 v[44:47], v[28:31], a[152:159], v3
  v_permlane32_swap_b32 v38, v42
  v_smfmac_f32_16x16x64_bf16 v[44:47], v[32:35], a[160:167], v3
  v_permlane32_swap_b32 v39, v43
  v_smfmac_f32_16x16x64_bf16 v[48:51], v[8:11], a[168:175], v3
  v_add_f32 v36, v36, v40
  v_smfmac_f32_16x16x64_bf16 v[48:51], v[12:15], a[176:183], v3
  v_add_f32 v37, v37, v41
  v_smfmac_f32_16x16x64_bf16 v[48:51], v[16:19], a[184:191], v3
  v_add_f32 v38, v38, v42
  v_smfmac_f32_16x16x64_bf16 v[48:51], v[20:23], a[192:199], v3
  v_add_f32 v39, v39, v43
  v_smfmac_f32_16x16x64_bf16 v[48:51], v[24:27], a[200:207], v3
  v_cvt_pk_bf16_f32 v40, v36, v37
  v_smfmac_f32_16x16x64_bf16 v[48:51], v[28:31], a[208:215], v3
  v_cvt_pk_bf16_f32 v41, v38, v39
  v_smfmac_f32_16x16x64_bf16 v[48:51], v[32:35], a[216:223], v3
  ds_write2_b32 v60, v40, v41 offset0:0 offset1:2
  v_smfmac_f32_16x16x64_bf16 v[52:55], v[8:11], a[224:231], v3
  v_smfmac_f32_16x16x64_bf16 v[52:55], v[12:15], a[232:239], v3
  v_smfmac_f32_16x16x64_bf16 v[52:55], v[16:19], a[240:247], v3
  v_smfmac_f32_16x16x64_bf16 v[52:55], v[20:23], a[248:255], v3
  v_permlane32_swap_b32 v44, v48
  v_smfmac_f32_16x16x64_bf16 v[52:55], v[24:27], v[176:183], v3
  v_permlane32_swap_b32 v45, v49
  v_smfmac_f32_16x16x64_bf16 v[52:55], v[28:31], v[184:191], v3
  v_permlane32_swap_b32 v46, v50
  v_smfmac_f32_16x16x64_bf16 v[52:55], v[32:35], v[192:199], v3
  v_permlane32_swap_b32 v47, v51
  v_smfmac_f32_16x16x64_bf16 v[56:59], v[8:11], v[200:207], v3
  v_add_f32 v44, v44, v48
  v_smfmac_f32_16x16x64_bf16 v[56:59], v[12:15], v[208:215], v3
  v_add_f32 v45, v45, v49
  v_smfmac_f32_16x16x64_bf16 v[56:59], v[16:19], v[216:223], v3
  v_add_f32 v46, v46, v50
  v_smfmac_f32_16x16x64_bf16 v[56:59], v[20:23], v[224:231], v3
  v_add_f32 v47, v47, v51
  v_smfmac_f32_16x16x64_bf16 v[56:59], v[24:27], v[232:239], v3
  v_cvt_pk_bf16_f32 v48, v44, v45
  v_smfmac_f32_16x16x64_bf16 v[56:59], v[28:31], v[240:247], v3
  v_cvt_pk_bf16_f32 v49, v46, v47
  v_smfmac_f32_16x16x64_bf16 v[56:59], v[32:35], v[248:255], v3
  ds_write2_b32 v61, v48, v49 offset0:0 offset1:2
  s_nop 6
  v_permlane32_swap_b32 v52, v56
  v_permlane32_swap_b32 v53, v57
  v_permlane32_swap_b32 v54, v58
  v_permlane32_swap_b32 v55, v59
  v_add_f32 v52, v52, v56
  v_add_f32 v53, v53, v57
  v_add_f32 v54, v54, v58
  v_add_f32 v55, v55, v59
  v_cvt_pk_bf16_f32 v56, v52, v53
  v_cvt_pk_bf16_f32 v57, v54, v55
  ds_write2_b32 v62, v56, v57 offset0:0 offset1:2
  s_cmp_eq_u32 s19, 63
  s_cbranch_scc1 cB_va0_last
  s_add_u32 s22, s20, 9216
  s_add_u32 s34, s20, 13312
  s_add_u32 s36, s20, 7168
  s_mov_b32 s37, 0
  v_mov_b32 v156, 0
  v_mov_b32 v157, 0
  v_mov_b32 v158, 0
  v_mov_b32 v159, 0
  buffer_load_dword v164, v4, s[8:11], s20 offen sc1
  s_nop 7
  buffer_load_dword v165, v4, s[8:11], s20 offen sc1
  s_nop 7
  buffer_load_dword v166, v4, s[8:11], s20 offen sc1
  s_nop 7
  buffer_load_dword v167, v4, s[8:11], s20 offen sc1
  s_nop 7
  buffer_load_dword v168, v4, s[8:11], s20 offen sc1
cB_va0_fw_l:
  s_waitcnt vmcnt(4)
  v_cmp_eq_u32 vcc, -1, v164
  s_cbranch_vccz cB_va0_fw_d
  buffer_load_dword v164, v4, s[8:11], s20 offen sc1
  s_waitcnt vmcnt(4)
  v_cmp_eq_u32 vcc, -1, v165
  s_cbranch_vccz cB_va0_fw_d
  buffer_load_dword v165, v4, s[8:11], s20 offen sc1
  s_waitcnt vmcnt(4)
  v_cmp_eq_u32 vcc, -1, v166
  s_cbranch_vccz cB_va0_fw_d
  buffer_load_dword v166, v4, s[8:11], s20 offen sc1
  s_waitcnt vmcnt(4)
  v_cmp_eq_u32 vcc, -1, v167
  s_cbranch_vccz cB_va0_fw_d
  buffer_load_dword v167, v4, s[8:11], s20 offen sc1
  s_waitcnt vmcnt(4)
  v_cmp_eq_u32 vcc, -1, v168
  s_cbranch_vccz cB_va0_fw_d
  buffer_load_dword v168, v4, s[8:11], s20 offen sc1
  s_add_u32 s30, s30, 1
  s_cmp_lt_u32 s30, 400000
  s_cbranch_scc1 cB_va0_fw_l
  s_branch cB_abort
cB_va0_fw_d:
  s_waitcnt lgkmcnt(0)
  buffer_load_dwordx4 v[8:11], v5, s[8:11], s22 offen offset:0 sc1
  v_mov_b32 v36, 0
  v_mov_b32 v37, 0
  v_mov_b32 v38, 0
  buffer_load_dwordx4 v[12:15], v5, s[8:11], s22 offen offset:1024 sc1
  v_mov_b32 v39, 0
  v_mov_b32 v40, 0
  v_mov_b32 v41, 0
  buffer_load_dwordx4 v[16:19], v5, s[8:11], s22 offen offset:2048 sc1
  v_mov_b32 v42, 0
  v_mov_b32 v43, 0
  v_mov_b32 v44, 0
  buffer_load_dwordx4 v[20:23], v5, s[8:11], s22 offen offset:3072 sc1
  v_mov_b32 v45, 0
  v_mov_b32 v46, 0
  v_mov_b32 v47, 0
  buffer_load_dwordx4 v[24:27], v5, s[8:11], s34 offen offset:0 sc1
  v_mov_b32 v48, 0
  v_mov_b32 v49, 0
  v_mov_b32 v50, 0
  buffer_load_dwordx4 v[28:31], v5, s[8:11], s34 offen offset:1024 sc1
  v_mov_b32 v51, 0
  v_mov_b32 v52, 0
  v_mov_b32 v53, 0
  buffer_load_dwordx4 v[32:35], v5, s[8:11], s34 offen offset:2048 sc1
  v_mov_b32 v54, 0
  v_mov_b32 v55, 0
  v_mov_b32 v56, 0
  buffer_load_dwordx4 v[144:147], v5, s[8:11], s34 offen offset:3072 sc1
  v_mov_b32 v57, 0
  v_mov_b32 v58, 0
  v_mov_b32 v59, 0
  buffer_load_dwordx4 v[148:151], v2, s[8:11], s36 offen offset:0 sc1
  buffer_load_dwordx4 v[152:155], v2, s[8:11], s36 offen offset:1024 sc1
  s_barrier
  ds_read_b128 v[64:67], v2 offset:0
  ds_read_b128 v[68:71], v2 offset:1024
  ds_read_b128 v[72:75], v2 offset:2048
  ds_read_b128 v[76:79], v2 offset:3072
  s_waitcnt vmcnt(9)
  v_smfmac_f32_16x16x64_bf16 v[156:159], v[8:11], v[80:87], v0
  s_waitcnt vmcnt(8)
  v_smfmac_f32_16x16x64_bf16 v[156:159], v[12:15], v[88:95], v0
  s_waitcnt vmcnt(7)
  v_smfmac_f32_16x16x64_bf16 v[156:159], v[16:19], v[96:103], v0
  s_waitcnt vmcnt(6)
  v_smfmac_f32_16x16x64_bf16 v[156:159], v[20:23], v[104:111], v0
  s_waitcnt vmcnt(5)
  v_smfmac_f32_16x16x64_bf16 v[156:159], v[24:27], v[112:119], v0
  s_mov_b32 exec_hi, 0
  buffer_store_dword v2, v7, s[8:11], s21 offen sc1
  s_mov_b64 exec, -1
  s_waitcnt vmcnt(5)
  v_smfmac_f32_16x16x64_bf16 v[156:159], v[28:31], v[120:127], v0
  s_waitcnt vmcnt(4)
  v_smfmac_f32_16x16x64_bf16 v[156:159], v[32:35], v[128:135], v0
  s_waitcnt vmcnt(3)
  v_smfmac_f32_16x16x64_bf16 v[156:159], v[144:147], v[136:143], v0
  s_waitcnt vmcnt(2) lgkmcnt(0)
  v_smfmac_f32_16x16x64_bf16 v[156:159], v[148:151], v[64:71], v0
  s_waitcnt vmcnt(1)
  v_smfmac_f32_16x16x64_bf16 v[156:159], v[152:155], v[72:79], v0
cB_va0_ep:
  s_nop 7
  v_add_f32 v160, v156, v157
  v_add_f32 v161, v158, v159
  v_cmp_u_f32 vcc, v160, v161
  v_mov_b32_dpp v162, v160 row_ror:8 row_mask:0xf bank_mask:0xf
  v_mov_b32_dpp v160, v161 row_ror:8 row_mask:0xf bank_mask:0xc
  s_cbranch_vccnz cB_va0_rp
  v_mov_b32_dpp v161, v162 quad_perm:[0,1,2,3] row_mask:0xf bank_mask:0x3
  v_cvt_pk_bf16_f32 v160, v160, v161
cB_va0_pc:
  buffer_store_dword v160, v1, s[8:11], s21 offen sc1
  s_cmp_lg_u32 s19, 62
  s_cbranch_scc1 cB_va0_nl
  s_mov_b32 s22, 88519680
  buffer_store_dword v160, v1, s[8:11], s22 offen sc1
  s_mov_b64 exec, -1
  s_branch cB_done
cB_va0_nl:
  s_mov_b64 exec, -1
  s_add_u32 s25, s25, 28672
  s_add_u32 s19, s19, 1
  s_mov_b32 s20, s21
  s_branch cB_va0_loop
cB_va0_last:
  s_waitcnt lgkmcnt(0)
  s_barrier
  s_branch cB_done
cB_va0_rp:
  s_cmp_eq_u32 s37, 0
  s_cbranch_scc1 cB_va0_rv
  v_mov_b32_dpp v161, v162 quad_perm:[0,1,2,3] row_mask:0xf bank_mask:0x3
  v_cvt_pk_bf16_f32 v160, v160, v161
  v_min_u32 v160, -2, v160
  s_branch cB_va0_pc
cB_va0_rv:
  buffer_load_dwordx4 v[8:11], v5, s[8:11], s22 offen offset:0 sc1
  buffer_load_dwordx4 v[12:15], v5, s[8:11], s22 offen offset:1024 sc1
  buffer_load_dwordx4 v[16:19], v5, s[8:11], s22 offen offset:2048 sc1
  buffer_load_dwordx4 v[20:23], v5, s[8:11], s22 offen offset:3072 sc1
  buffer_load_dwordx4 v[24:27], v5, s[8:11], s34 offen offset:0 sc1
  buffer_load_dwordx4 v[28:31], v5, s[8:11], s34 offen offset:1024 sc1
  buffer_load_dwordx4 v[32:35], v5, s[8:11], s34 offen offset:2048 sc1
  buffer_load_dwordx4 v[144:147], v5, s[8:11], s34 offen offset:3072 sc1
  buffer_load_dwordx4 v[148:151], v2, s[8:11], s36 offen offset:0 sc1
  buffer_load_dwordx4 v[152:155], v2, s[8:11], s36 offen offset:1024 sc1
  s_waitcnt vmcnt(0)
  v_max3_u32 v63, v8, v9, v10
  v_max3_u32 v63, v63, v11, v12
  v_max3_u32 v63, v63, v13, v14
  v_max3_u32 v63, v63, v15, v16
  v_max3_u32 v63, v63, v17, v18
  v_max3_u32 v63, v63, v19, v20
  v_max3_u32 v63, v63, v21, v22
  v_max3_u32 v63, v63, v23, v24
  v_max3_u32 v63, v63, v25, v26
  v_max3_u32 v63, v63, v27, v28
  v_max3_u32 v63, v63, v29, v30
  v_max3_u32 v63, v63, v31, v32
  v_max3_u32 v63, v63, v33, v34
  v_max3_u32 v63, v63, v35, v144
  v_max3_u32 v63, v63, v145, v146
  v_max3_u32 v63, v63, v147, v148
  v_max3_u32 v63, v63, v149, v150
  v_max3_u32 v63, v63, v151, v152
  v_max3_u32 v63, v63, v153, v154
  v_max_u32 v63, v63, v155
  v_cmp_eq_u32 vcc, -1, v63
  s_cbranch_vccz cB_va0_rk
  s_add_u32 s30, s30, 1
  s_cmp_lt_u32 s30, 400000
  s_cbranch_scc1 cB_va0_rv
  s_branch cB_abort
cB_va0_rk:
  s_mov_b32 s37, 1
  s_add_u32 s31, s31, 0x10000
  v_mov_b32 v156, 0
  v_mov_b32 v157, 0
  v_mov_b32 v158, 0
  v_mov_b32 v159, 0
  s_nop 1
  v_smfmac_f32_16x16x64_bf16 v[156:159], v[8:11], v[80:87], v0
  v_smfmac_f32_16x16x64_bf16 v[156:159], v[12:15], v[88:95], v0
  v_smfmac_f32_16x16x64_bf16 v[156:159], v[16:19], v[96:103], v0
  v_smfmac_f32_16x16x64_bf16 v[156:159], v[20:23], v[104:111], v0
  v_smfmac_f32_16x16x64_bf16 v[156:159], v[24:27], v[112:119], v0
  v_smfmac_f32_16x16x64_bf16 v[156:159], v[28:31], v[120:127], v0
  v_smfmac_f32_16x16x64_bf16 v[156:159], v[32:35], v[128:135], v0
  v_smfmac_f32_16x16x64_bf16 v[156:159], v[144:147], v[136:143], v0
  v_smfmac_f32_16x16x64_bf16 v[156:159], v[148:151], v[64:71], v0
  v_smfmac_f32_16x16x64_bf16 v[156:159], v[152:155], v[72:79], v0
  s_nop 7
  s_branch cB_va0_ep
.p2align 6

cB_va1_loop:
  s_add_u32 s23, s20, 4096
  s_add_u32 s21, s20, 25600
  s_mov_b32 s30, 0
  s_cmp_lg_u32 s19, s38
  s_cbranch_scc1 cB_va1_vok
  s_branch cB_va1_voc
cB_va1_vow:
  buffer_load_dword v175, off, s[8:11], s35 sc1
  s_waitcnt vmcnt(0)
cB_va1_voc:
  v_readfirstlane_b32 s22, v175
  s_cmp_eq_u32 s22, 56
  s_cbranch_scc1 cB_va1_vod
  s_sleep 1
  s_add_u32 s30, s30, 1
  s_cmp_lt_u32 s30, 400000
  s_cbranch_scc1 cB_va1_vow
  s_branch cB_abort
cB_va1_vod:
  s_add_u32 s35, s35, 2048
  s_add_u32 s38, s19, 8
  s_and_b32 s38, s38, -8
  s_cmp_eq_u32 s19, 0
  s_cselect_b32 s38, 4, s38
cB_va1_vok:
  s_cmp_eq_u32 s19, 63
  s_cbranch_scc1 cB_done
  s_barrier
  s_add_u32 s22, s25, 0
  buffer_load_dwordx4 v[80:83], v6, s[8:11], s22 offen offset:0 sc1
  buffer_load_dwordx4 v[84:87], v6, s[8:11], s22 offen offset:1792 sc1
  s_add_u32 s22, s25, 3584
  buffer_load_dwordx4 v[88:91], v6, s[8:11], s22 offen offset:0 sc1
  buffer_load_dwordx4 v[92:95], v6, s[8:11], s22 offen offset:1792 sc1
  s_add_u32 s22, s25, 7168
  buffer_load_dwordx4 v[96:99], v6, s[8:11], s22 offen offset:0 sc1
  buffer_load_dwordx4 v[100:103], v6, s[8:11], s22 offen offset:1792 sc1
  s_add_u32 s22, s25, 10752
  buffer_load_dwordx4 v[104:107], v6, s[8:11], s22 offen offset:0 sc1
  buffer_load_dwordx4 v[108:111], v6, s[8:11], s22 offen offset:1792 sc1
  s_add_u32 s22, s25, 14336
  buffer_load_dwordx4 v[112:115], v6, s[8:11], s22 offen offset:0 sc1
  buffer_load_dwordx4 v[116:119], v6, s[8:11], s22 offen offset:1792 sc1
  s_add_u32 s22, s25, 17920
  buffer_load_dwordx4 v[120:123], v6, s[8:11], s22 offen offset:0 sc1
  buffer_load_dwordx4 v[124:127], v6, s[8:11], s22 offen offset:1792 sc1
  s_add_u32 s22, s25, 21504
  buffer_load_dwordx4 v[128:131], v6, s[8:11], s22 offen offset:0 sc1
  buffer_load_dwordx4 v[132:135], v6, s[8:11], s22 offen offset:1792 sc1
  s_add_u32 s22, s25, 25088
  buffer_load_dwordx4 v[136:139], v6, s[8:11], s22 offen offset:0 sc1
  buffer_load_dwordx4 v[140:143], v6, s[8:11], s22 offen offset:1792 sc1
  buffer_load_dword v175, off, s[8:11], s35 sc1
  s_barrier
  ds_read_b128 v[8:11], v2 offset:8192
  ds_read_b128 v[12:15], v2 offset:9216
  ds_read_b128 v[16:19], v2 offset:10240
  ds_read_b128 v[20:23], v2 offset:11264
  ds_read_b128 v[24:27], v2 offset:12288
  ds_read_b128 v[28:31], v2 offset:13312
  ds_read_b128 v[32:35], v2 offset:14336
  s_waitcnt lgkmcnt(0)
  v_smfmac_f32_16x16x64_bf16 v[36:39], v[8:11], a[0:7], v3
  v_smfmac_f32_16x16x64_bf16 v[36:39], v[12:15], a[8:15], v3
  v_smfmac_f32_16x16x64_bf16 v[36:39], v[16:19], a[16:23], v3
  v_smfmac_f32_16x16x64_bf16 v[36:39], v[20:23], a[24:31], v3
  v_smfmac_f32_16x16x64_bf16 v[36:39], v[24:27], a[32:39], v3
  v_smfmac_f32_16x16x64_bf16 v[36:39], v[28:31], a[40:47], v3
  v_smfmac_f32_16x16x64_bf16 v[36:39], v[32:35], a[48:55], v3
  v_smfmac_f32_16x16x64_bf16 v[40:43], v[8:11], a[56:63], v3
  v_smfmac_f32_16x16x64_bf16 v[40:43], v[12:15], a[64:71], v3
  v_smfmac_f32_16x16x64_bf16 v[40:43], v[16:19], a[72:79], v3
  v_smfmac_f32_16x16x64_bf16 v[40:43], v[20:23], a[80:87], v3
  v_smfmac_f32_16x16x64_bf16 v[40:43], v[24:27], a[88:95], v3
  v_smfmac_f32_16x16x64_bf16 v[40:43], v[28:31], a[96:103], v3
  v_smfmac_f32_16x16x64_bf16 v[40:43], v[32:35], a[104:111], v3
  v_smfmac_f32_16x16x64_bf16 v[44:47], v[8:11], a[112:119], v3
  v_smfmac_f32_16x16x64_bf16 v[44:47], v[12:15], a[120:127], v3
  v_smfmac_f32_16x16x64_bf16 v[44:47], v[16:19], a[128:135], v3
  v_smfmac_f32_16x16x64_bf16 v[44:47], v[20:23], a[136:143], v3
  v_permlane32_swap_b32 v36, v40
  v_smfmac_f32_16x16x64_bf16 v[44:47], v[24:27], a[144:151], v3
  v_permlane32_swap_b32 v37, v41
  v_smfmac_f32_16x16x64_bf16 v[44:47], v[28:31], a[152:159], v3
  v_permlane32_swap_b32 v38, v42
  v_smfmac_f32_16x16x64_bf16 v[44:47], v[32:35], a[160:167], v3
  v_permlane32_swap_b32 v39, v43
  v_smfmac_f32_16x16x64_bf16 v[48:51], v[8:11], a[168:175], v3
  v_add_f32 v36, v36, v40
  v_smfmac_f32_16x16x64_bf16 v[48:51], v[12:15], a[176:183], v3
  v_add_f32 v37, v37, v41
  v_smfmac_f32_16x16x64_bf16 v[48:51], v[16:19], a[184:191], v3
  v_add_f32 v38, v38, v42
  v_smfmac_f32_16x16x64_bf16 v[48:51], v[20:23], a[192:199], v3
  v_add_f32 v39, v39, v43
  v_smfmac_f32_16x16x64_bf16 v[48:51], v[24:27], a[200:207], v3
  v_cvt_pk_bf16_f32 v40, v36, v37
  v_smfmac_f32_16x16x64_bf16 v[48:51], v[28:31], a[208:215], v3
  v_cvt_pk_bf16_f32 v41, v38, v39
  v_smfmac_f32_16x16x64_bf16 v[48:51], v[32:35], a[216:223], v3
  ds_write2_b32 v60, v40, v41 offset0:0 offset1:2
  v_smfmac_f32_16x16x64_bf16 v[52:55], v[8:11], a[224:231], v3
  v_smfmac_f32_16x16x64_bf16 v[52:55], v[12:15], a[232:239], v3
  v_smfmac_f32_16x16x64_bf16 v[52:55], v[16:19], a[240:247], v3
  v_smfmac_f32_16x16x64_bf16 v[52:55], v[20:23], a[248:255], v3
  v_permlane32_swap_b32 v44, v48
  v_smfmac_f32_16x16x64_bf16 v[52:55], v[24:27], v[176:183], v3
  v_permlane32_swap_b32 v45, v49
  v_smfmac_f32_16x16x64_bf16 v[52:55], v[28:31], v[184:191], v3
  v_permlane32_swap_b32 v46, v50
  v_smfmac_f32_16x16x64_bf16 v[52:55], v[32:35], v[192:199], v3
  v_permlane32_swap_b32 v47, v51
  v_smfmac_f32_16x16x64_bf16 v[56:59], v[8:11], v[200:207], v3
  v_add_f32 v44, v44, v48
  v_smfmac_f32_16x16x64_bf16 v[56:59], v[12:15], v[208:215], v3
  v_add_f32 v45, v45, v49
  v_smfmac_f32_16x16x64_bf16 v[56:59], v[16:19], v[216:223], v3
  v_add_f32 v46, v46, v50
  v_smfmac_f32_16x16x64_bf16 v[56:59], v[20:23], v[224:231], v3
  v_add_f32 v47, v47, v51
  v_smfmac_f32_16x16x64_bf16 v[56:59], v[24:27], v[232:239], v3
  v_cvt_pk_bf16_f32 v48, v44, v45
  v_smfmac_f32_16x16x64_bf16 v[56:59], v[28:31], v[240:247], v3
  v_cvt_pk_bf16_f32 v49, v46, v47
  v_smfmac_f32_16x16x64_bf16 v[56:59], v[32:35], v[248:255], v3
  ds_write2_b32 v61, v48, v49 offset0:0 offset1:2
  s_nop 6
  v_permlane32_swap_b32 v52, v56
  v_permlane32_swap_b32 v53, v57
  v_permlane32_swap_b32 v54, v58
  v_permlane32_swap_b32 v55, v59
  v_add_f32 v52, v52, v56
  v_add_f32 v53, v53, v57
  v_add_f32 v54, v54, v58
  v_add_f32 v55, v55, v59
  v_cvt_pk_bf16_f32 v56, v52, v53
  v_cvt_pk_bf16_f32 v57, v54, v55
  ds_write2_b32 v62, v56, v57 offset0:0 offset1:2
  s_cmp_eq_u32 s19, 63
  s_cbranch_scc1 cB_va1_last
  s_add_u32 s22, s20, 9216
  s_add_u32 s34, s20, 13312
  s_add_u32 s36, s20, 7168
  s_mov_b32 s37, 0
  v_mov_b32 v156, 0
  v_mov_b32 v157, 0
  v_mov_b32 v158, 0
  v_mov_b32 v159, 0
  buffer_load_dword v164, v4, s[8:11], s20 offen sc1
  s_nop 7
  buffer_load_dword v165, v4, s[8:11], s20 offen sc1
  s_nop 7
  buffer_load_dword v166, v4, s[8:11], s20 offen sc1
  s_nop 7
  buffer_load_dword v167, v4, s[8:11], s20 offen sc1
  s_nop 7
  buffer_load_dword v168, v4, s[8:11], s20 offen sc1
cB_va1_fw_l:
  s_waitcnt vmcnt(4)
  v_cmp_eq_u32 vcc, -1, v164
  s_cbranch_vccz cB_va1_fw_d
  buffer_load_dword v164, v4, s[8:11], s20 offen sc1
  s_waitcnt vmcnt(4)
  v_cmp_eq_u32 vcc, -1, v165
  s_cbranch_vccz cB_va1_fw_d
  buffer_load_dword v165, v4, s[8:11], s20 offen sc1
  s_waitcnt vmcnt(4)
  v_cmp_eq_u32 vcc, -1, v166
  s_cbranch_vccz cB_va1_fw_d
  buffer_load_dword v166, v4, s[8:11], s20 offen sc1
  s_waitcnt vmcnt(4)
  v_cmp_eq_u32 vcc, -1, v167
  s_cbranch_vccz cB_va1_fw_d
  buffer_load_dword v167, v4, s[8:11], s20 offen sc1
  s_waitcnt vmcnt(4)
  v_cmp_eq_u32 vcc, -1, v168
  s_cbranch_vccz cB_va1_fw_d
  buffer_load_dword v168, v4, s[8:11], s20 offen sc1
  s_add_u32 s30, s30, 1
  s_cmp_lt_u32 s30, 400000
  s_cbranch_scc1 cB_va1_fw_l
  s_branch cB_abort
cB_va1_fw_d:
  s_waitcnt lgkmcnt(0)
  buffer_load_dwordx4 v[8:11], v5, s[8:11], s22 offen offset:0 sc1
  v_mov_b32 v36, 0
  v_mov_b32 v37, 0
  v_mov_b32 v38, 0
  buffer_load_dwordx4 v[12:15], v5, s[8:11], s22 offen offset:1024 sc1
  v_mov_b32 v39, 0
  v_mov_b32 v40, 0
  v_mov_b32 v41, 0
  buffer_load_dwordx4 v[16:19], v5, s[8:11], s22 offen offset:2048 sc1
  v_mov_b32 v42, 0
  v_mov_b32 v43, 0
  v_mov_b32 v44, 0
  buffer_load_dwordx4 v[20:23], v5, s[8:11], s22 offen offset:3072 sc1
  v_mov_b32 v45, 0
  v_mov_b32 v46, 0
  v_mov_b32 v47, 0
  buffer_load_dwordx4 v[24:27], v5, s[8:11], s34 offen offset:0 sc1
  v_mov_b32 v48, 0
  v_mov_b32 v49, 0
  v_mov_b32 v50, 0
  buffer_load_dwordx4 v[28:31], v5, s[8:11], s34 offen offset:1024 sc1
  v_mov_b32 v51, 0
  v_mov_b32 v52, 0
  v_mov_b32 v53, 0
  buffer_load_dwordx4 v[32:35], v5, s[8:11], s34 offen offset:2048 sc1
  v_mov_b32 v54, 0
  v_mov_b32 v55, 0
  v_mov_b32 v56, 0
  buffer_load_dwordx4 v[144:147], v5, s[8:11], s34 offen offset:3072 sc1
  v_mov_b32 v57, 0
  v_mov_b32 v58, 0
  v_mov_b32 v59, 0
  buffer_load_dwordx4 v[148:151], v2, s[8:11], s36 offen offset:0 sc1
  buffer_load_dwordx4 v[152:155], v2, s[8:11], s36 offen offset:1024 sc1
  s_barrier
  ds_read_b128 v[64:67], v2 offset:4096
  ds_read_b128 v[68:71], v2 offset:5120
  ds_read_b128 v[72:75], v2 offset:6144
  ds_read_b128 v[76:79], v2 offset:7168
  s_waitcnt vmcnt(9)
  v_smfmac_f32_16x16x64_bf16 v[156:159], v[8:11], v[80:87], v0
  s_waitcnt vmcnt(8)
  v_smfmac_f32_16x16x64_bf16 v[156:159], v[12:15], v[88:95], v0
  s_waitcnt vmcnt(7)
  v_smfmac_f32_16x16x64_bf16 v[156:159], v[16:19], v[96:103], v0
  s_waitcnt vmcnt(6)
  v_smfmac_f32_16x16x64_bf16 v[156:159], v[20:23], v[104:111], v0
  s_waitcnt vmcnt(5)
  v_smfmac_f32_16x16x64_bf16 v[156:159], v[24:27], v[112:119], v0
  s_mov_b32 exec_hi, 0
  buffer_store_dword v2, v7, s[8:11], s21 offen sc1
  s_mov_b64 exec, -1
  s_waitcnt vmcnt(5)
  v_smfmac_f32_16x16x64_bf16 v[156:159], v[28:31], v[120:127], v0
  s_waitcnt vmcnt(4)
  v_smfmac_f32_16x16x64_bf16 v[156:159], v[32:35], v[128:135], v0
  s_waitcnt vmcnt(3)
  v_smfmac_f32_16x16x64_bf16 v[156:159], v[144:147], v[136:143], v0
  s_waitcnt vmcnt(2) lgkmcnt(0)
  v_smfmac_f32_16x16x64_bf16 v[156:159], v[148:151], v[64:71], v0
  s_waitcnt vmcnt(1)
  v_smfmac_f32_16x16x64_bf16 v[156:159], v[152:155], v[72:79], v0
cB_va1_ep:
  s_nop 7
  v_add_f32 v160, v156, v157
  v_add_f32 v161, v158, v159
  v_cmp_u_f32 vcc, v160, v161
  v_mov_b32_dpp v162, v160 row_ror:8 row_mask:0xf bank_mask:0xf
  v_mov_b32_dpp v160, v161 row_ror:8 row_mask:0xf bank_mask:0xc
  s_cbranch_vccnz cB_va1_rp
  v_mov_b32_dpp v161, v162 quad_perm:[0,1,2,3] row_mask:0xf bank_mask:0x3
  v_cvt_pk_bf16_f32 v160, v160, v161
cB_va1_pc:
  s_mov_b64 exec, s[26:27]
  buffer_store_dword v160, v1, s[8:11], s21 offen sc1
  s_cmp_lg_u32 s19, 62
  s_cbranch_scc1 cB_va1_nl
  s_mov_b32 s22, 88519680
  buffer_store_dword v160, v1, s[8:11], s22 offen sc1
  s_mov_b64 exec, -1
  s_branch cB_done
cB_va1_nl:
  s_mov_b64 exec, -1
  s_add_u32 s25, s25, 28672
  s_add_u32 s19, s19, 1
  s_mov_b32 s20, s21
  s_branch cB_va1_loop
cB_va1_last:
  s_waitcnt lgkmcnt(0)
  s_barrier
  s_branch cB_done
cB_va1_rp:
  s_cmp_eq_u32 s37, 0
  s_cbranch_scc1 cB_va1_rv
  v_mov_b32_dpp v161, v162 quad_perm:[0,1,2,3] row_mask:0xf bank_mask:0x3
  v_cvt_pk_bf16_f32 v160, v160, v161
  v_min_u32 v160, -2, v160
  s_branch cB_va1_pc
cB_va1_rv:
  buffer_load_dwordx4 v[8:11], v5, s[8:11], s22 offen offset:0 sc1
  buffer_load_dwordx4 v[12:15], v5, s[8:11], s22 offen offset:1024 sc1
  buffer_load_dwordx4 v[16:19], v5, s[8:11], s22 offen offset:2048 sc1
  buffer_load_dwordx4 v[20:23], v5, s[8:11], s22 offen offset:3072 sc1
  buffer_load_dwordx4 v[24:27], v5, s[8:11], s34 offen offset:0 sc1
  buffer_load_dwordx4 v[28:31], v5, s[8:11], s34 offen offset:1024 sc1
  buffer_load_dwordx4 v[32:35], v5, s[8:11], s34 offen offset:2048 sc1
  buffer_load_dwordx4 v[144:147], v5, s[8:11], s34 offen offset:3072 sc1
  buffer_load_dwordx4 v[148:151], v2, s[8:11], s36 offen offset:0 sc1
  buffer_load_dwordx4 v[152:155], v2, s[8:11], s36 offen offset:1024 sc1
  s_waitcnt vmcnt(0)
  v_max3_u32 v63, v8, v9, v10
  v_max3_u32 v63, v63, v11, v12
  v_max3_u32 v63, v63, v13, v14
  v_max3_u32 v63, v63, v15, v16
  v_max3_u32 v63, v63, v17, v18
  v_max3_u32 v63, v63, v19, v20
  v_max3_u32 v63, v63, v21, v22
  v_max3_u32 v63, v63, v23, v24
  v_max3_u32 v63, v63, v25, v26
  v_max3_u32 v63, v63, v27, v28
  v_max3_u32 v63, v63, v29, v30
  v_max3_u32 v63, v63, v31, v32
  v_max3_u32 v63, v63, v33, v34
  v_max3_u32 v63, v63, v35, v144
  v_max3_u32 v63, v63, v145, v146
  v_max3_u32 v63, v63, v147, v148
  v_max3_u32 v63, v63, v149, v150
  v_max3_u32 v63, v63, v151, v152
  v_max3_u32 v63, v63, v153, v154
  v_max_u32 v63, v63, v155
  v_cmp_eq_u32 vcc, -1, v63
  s_cbranch_vccz cB_va1_rk
  s_add_u32 s30, s30, 1
  s_cmp_lt_u32 s30, 400000
  s_cbranch_scc1 cB_va1_rv
  s_branch cB_abort
cB_va1_rk:
  s_mov_b32 s37, 1
  s_add_u32 s31, s31, 0x10000
  v_mov_b32 v156, 0
  v_mov_b32 v157, 0
  v_mov_b32 v158, 0
  v_mov_b32 v159, 0
  s_nop 1
  v_smfmac_f32_16x16x64_bf16 v[156:159], v[8:11], v[80:87], v0
  v_smfmac_f32_16x16x64_bf16 v[156:159], v[12:15], v[88:95], v0
  v_smfmac_f32_16x16x64_bf16 v[156:159], v[16:19], v[96:103], v0
  v_smfmac_f32_16x16x64_bf16 v[156:159], v[20:23], v[104:111], v0
  v_smfmac_f32_16x16x64_bf16 v[156:159], v[24:27], v[112:119], v0
  v_smfmac_f32_16x16x64_bf16 v[156:159], v[28:31], v[120:127], v0
  v_smfmac_f32_16x16x64_bf16 v[156:159], v[32:35], v[128:135], v0
  v_smfmac_f32_16x16x64_bf16 v[156:159], v[144:147], v[136:143], v0
  v_smfmac_f32_16x16x64_bf16 v[156:159], v[148:151], v[64:71], v0
  v_smfmac_f32_16x16x64_bf16 v[156:159], v[152:155], v[72:79], v0
  s_nop 7
  s_branch cB_va1_ep
.p2align 6

cB_va2_loop:
  s_add_u32 s23, s20, 4096
  s_add_u32 s21, s20, 25600
  v_mov_b32 v36, 0
  v_mov_b32 v37, 0
  v_mov_b32 v38, 0
  v_mov_b32 v39, 0
  v_mov_b32 v40, 0
  v_mov_b32 v41, 0
  v_mov_b32 v42, 0
  v_mov_b32 v43, 0
  v_mov_b32 v44, 0
  v_mov_b32 v45, 0
  v_mov_b32 v46, 0
  v_mov_b32 v47, 0
  v_mov_b32 v48, 0
  v_mov_b32 v49, 0
  v_mov_b32 v50, 0
  v_mov_b32 v51, 0
  v_mov_b32 v52, 0
  v_mov_b32 v53, 0
  v_mov_b32 v54, 0
  v_mov_b32 v55, 0
  v_mov_b32 v56, 0
  v_mov_b32 v57, 0
  v_mov_b32 v58, 0
  v_mov_b32 v59, 0
  v_mov_b32 v60, 0
  v_mov_b32 v61, 0
  v_mov_b32 v62, 0
  v_mov_b32 v63, 0
  v_mov_b32 v64, 0
  v_mov_b32 v65, 0
  v_mov_b32 v66, 0
  v_mov_b32 v67, 0
  s_mov_b32 s30, 0
  buffer_load_dword v76, v119, s[8:11], s20 offen sc1
  buffer_load_dword v77, v119, s[8:11], s20 offen sc1
  buffer_load_dword v78, v119, s[8:11], s20 offen sc1
cB_va2_fp_l:
  s_waitcnt vmcnt(2)
  v_cmp_eq_u32 vcc, -1, v76
  s_cbranch_vccz cB_va2_fp_d
  buffer_load_dword v76, v119, s[8:11], s20 offen sc1
  s_waitcnt vmcnt(2)
  v_cmp_eq_u32 vcc, -1, v77
  s_cbranch_vccz cB_va2_fp_d
  buffer_load_dword v77, v119, s[8:11], s20 offen sc1
  s_waitcnt vmcnt(2)
  v_cmp_eq_u32 vcc, -1, v78
  s_cbranch_vccz cB_va2_fp_d
  buffer_load_dword v78, v119, s[8:11], s20 offen sc1
  s_add_u32 s30, s30, 1
  s_cmp_lt_u32 s30, 400000
  s_cbranch_scc1 cB_va2_fp_l
  s_branch cB_abort
cB_va2_fp_d:
  buffer_load_dwordx4 v[8:11], v2, s[8:11], s20 offen offset:0 sc1
  buffer_load_dwordx4 v[12:15], v2, s[8:11], s20 offen offset:1024 sc1
  buffer_load_dwordx4 v[16:19], v2, s[8:11], s20 offen offset:2048 sc1
  buffer_load_dwordx4 v[20:23], v2, s[8:11], s20 offen offset:3072 sc1
  s_barrier
cB_va2_ld:
  s_waitcnt vmcnt(0)
  v_max3_u32 v84, v8, v9, v10
  v_max3_u32 v84, v84, v11, v12
  v_max3_u32 v84, v84, v13, v14
  v_max3_u32 v84, v84, v15, v16
  v_max3_u32 v84, v84, v17, v18
  v_max3_u32 v84, v84, v19, v20
  v_max3_u32 v84, v84, v21, v22
  v_max_u32 v84, v84, v23
  v_cmp_eq_u32 vcc, -1, v84
  ds_write_b128 v2, v[8:11] offset:8192
  ds_write_b128 v2, v[12:15] offset:9216
  ds_write_b128 v2, v[16:19] offset:10240
  ds_write_b128 v2, v[20:23] offset:11264
  s_cbranch_vccnz cB_va2_retry
  s_waitcnt lgkmcnt(0)
  s_barrier
  ds_read_b128 v[24:27], v2 offset:12288
  ds_read_b128 v[28:31], v2 offset:13312
  ds_read_b128 v[32:35], v2 offset:14336
  ds_read_b128 v[92:95], v0
  s_waitcnt lgkmcnt(0)
  s_mov_b64 exec, s[26:27]
  buffer_store_dwordx4 v[92:95], v2, s[8:11], s36 offen sc1
  s_mov_b64 exec, -1
  s_add_u32 s36, s36, 7168
  s_cmp_eq_u32 s19, 63
  s_cbranch_scc1 cB_done
  ds_read_b128 v[76:79], v1 offset:0
  ds_read_b128 v[80:83], v1 offset:1024
  ds_read_b128 v[84:87], v1 offset:2048
  ds_read_b128 v[88:91], v1 offset:3072
  ds_read_b128 v[92:95], v1 offset:4096
  ds_read_b128 v[96:99], v1 offset:5120
  v_smfmac_f32_16x16x64_bf16 v[60:63], v[8:11], v[200:207], v3
  v_smfmac_f32_16x16x64_bf16 v[60:63], v[12:15], v[208:215], v3
  s_waitcnt lgkmcnt(4)
  v_smfmac_f32_16x16x64_bf16 v[64:67], v[8:11], v[76:83], v3
  ds_read_b128 v[76:79], v1 offset:6144
  ds_read_b128 v[80:83], v1 offset:7168
  v_smfmac_f32_16x16x64_bf16 v[60:63], v[16:19], v[216:223], v3
  v_smfmac_f32_16x16x64_bf16 v[60:63], v[20:23], v[224:231], v3
  s_waitcnt lgkmcnt(4)
  v_smfmac_f32_16x16x64_bf16 v[64:67], v[12:15], v[84:91], v3
  ds_read_b128 v[84:87], v1 offset:8192
  ds_read_b128 v[88:91], v1 offset:9216
  v_smfmac_f32_16x16x64_bf16 v[60:63], v[24:27], v[232:239], v3
  v_smfmac_f32_16x16x64_bf16 v[60:63], v[28:31], v[240:247], v3
  s_waitcnt lgkmcnt(4)
  v_smfmac_f32_16x16x64_bf16 v[64:67], v[16:19], v[92:99], v3
  ds_read_b128 v[92:95], v1 offset:10240
  ds_read_b128 v[96:99], v1 offset:11264
  v_smfmac_f32_16x16x64_bf16 v[60:63], v[32:35], v[248:255], v3
  v_smfmac_f32_16x16x64_bf16 v[36:39], v[8:11], a[0:7], v3
  s_waitcnt lgkmcnt(4)
  v_smfmac_f32_16x16x64_bf16 v[64:67], v[20:23], v[76:83], v3
  ds_read_b128 v[76:79], v1 offset:12288
  ds_read_b128 v[80:83], v1 offset:13312
  v_smfmac_f32_16x16x64_bf16 v[36:39], v[12:15], a[8:15], v3
  v_smfmac_f32_16x16x64_bf16 v[36:39], v[16:19], a[16:23], v3
  s_waitcnt lgkmcnt(4)
  v_smfmac_f32_16x16x64_bf16 v[64:67], v[24:27], v[84:91], v3
  v_smfmac_f32_16x16x64_bf16 v[36:39], v[20:23], a[24:31], v3
  v_smfmac_f32_16x16x64_bf16 v[36:39], v[24:27], a[32:39], v3
  s_waitcnt lgkmcnt(2)
  v_smfmac_f32_16x16x64_bf16 v[64:67], v[28:31], v[92:99], v3
  v_smfmac_f32_16x16x64_bf16 v[36:39], v[28:31], a[40:47], v3
  v_smfmac_f32_16x16x64_bf16 v[36:39], v[32:35], a[48:55], v3
  s_waitcnt lgkmcnt(0)
  v_smfmac_f32_16x16x64_bf16 v[64:67], v[32:35], v[76:83], v3
  v_smfmac_f32_16x16x64_bf16 v[40:43], v[8:11], a[56:63], v3
  v_smfmac_f32_16x16x64_bf16 v[40:43], v[12:15], a[64:71], v3
  v_smfmac_f32_16x16x64_bf16 v[40:43], v[16:19], a[72:79], v3
  v_smfmac_f32_16x16x64_bf16 v[40:43], v[20:23], a[80:87], v3
  v_permlane32_swap_b32 v60, v64
  v_smfmac_f32_16x16x64_bf16 v[40:43], v[24:27], a[88:95], v3
  v_permlane32_swap_b32 v61, v65
  v_smfmac_f32_16x16x64_bf16 v[40:43], v[28:31], a[96:103], v3
  v_permlane32_swap_b32 v62, v66
  v_smfmac_f32_16x16x64_bf16 v[40:43], v[32:35], a[104:111], v3
  v_permlane32_swap_b32 v63, v67
  v_smfmac_f32_16x16x64_bf16 v[44:47], v[8:11], a[112:119], v3
  v_smfmac_f32_16x16x64_bf16 v[44:47], v[12:15], a[120:127], v3
  v_smfmac_f32_16x16x64_bf16 v[44:47], v[16:19], a[128:135], v3
  v_smfmac_f32_16x16x64_bf16 v[44:47], v[20:23], a[136:143], v3
  v_add_f32 v60, v60, v64
  v_add_f32 v61, v61, v65
  v_smfmac_f32_16x16x64_bf16 v[44:47], v[24:27], a[144:151], v3
  v_add_f32 v62, v62, v66
  v_add_f32 v63, v63, v67
  v_smfmac_f32_16x16x64_bf16 v[44:47], v[28:31], a[152:159], v3
  v_cvt_pk_bf16_f32 v64, v60, v61
  v_cvt_pk_bf16_f32 v65, v62, v63
  v_smfmac_f32_16x16x64_bf16 v[44:47], v[32:35], a[160:167], v3
  ds_write2_b32 v115, v64, v65 offset0:0 offset1:2
  v_smfmac_f32_16x16x64_bf16 v[48:51], v[8:11], a[168:175], v3
  v_permlane32_swap_b32 v36, v40
  v_smfmac_f32_16x16x64_bf16 v[48:51], v[12:15], a[176:183], v3
  v_permlane32_swap_b32 v37, v41
  v_smfmac_f32_16x16x64_bf16 v[48:51], v[16:19], a[184:191], v3
  v_permlane32_swap_b32 v38, v42
  v_smfmac_f32_16x16x64_bf16 v[48:51], v[20:23], a[192:199], v3
  v_permlane32_swap_b32 v39, v43
  v_smfmac_f32_16x16x64_bf16 v[48:51], v[24:27], a[200:207], v3
  v_add_f32 v36, v36, v40
  v_smfmac_f32_16x16x64_bf16 v[48:51], v[28:31], a[208:215], v3
  v_add_f32 v37, v37, v41
  v_smfmac_f32_16x16x64_bf16 v[48:51], v[32:35], a[216:223], v3
  v_add_f32 v38, v38, v42
  v_smfmac_f32_16x16x64_bf16 v[52:55], v[8:11], a[224:231], v3
  v_smfmac_f32_16x16x64_bf16 v[52:55], v[12:15], a[232:239], v3
  v_smfmac_f32_16x16x64_bf16 v[52:55], v[16:19], a[240:247], v3
  v_smfmac_f32_16x16x64_bf16 v[52:55], v[20:23], a[248:255], v3
  v_add_f32 v39, v39, v43
  v_cvt_pk_bf16_f32 v40, v36, v37
  v_smfmac_f32_16x16x64_bf16 v[52:55], v[24:27], v[120:127], v3
  v_cvt_pk_bf16_f32 v41, v38, v39
  v_smfmac_f32_16x16x64_bf16 v[52:55], v[28:31], v[128:135], v3
  ds_write2_b32 v112, v40, v41 offset0:0 offset1:2
  v_smfmac_f32_16x16x64_bf16 v[52:55], v[32:35], v[136:143], v3
  v_permlane32_swap_b32 v44, v48
  v_smfmac_f32_16x16x64_bf16 v[56:59], v[8:11], v[144:151], v3
  v_permlane32_swap_b32 v45, v49
  v_smfmac_f32_16x16x64_bf16 v[56:59], v[12:15], v[152:159], v3
  v_permlane32_swap_b32 v46, v50
  v_smfmac_f32_16x16x64_bf16 v[56:59], v[16:19], v[160:167], v3
  v_permlane32_swap_b32 v47, v51
  v_smfmac_f32_16x16x64_bf16 v[56:59], v[20:23], v[168:175], v3
  v_add_f32 v44, v44, v48
  v_smfmac_f32_16x16x64_bf16 v[56:59], v[24:27], v[176:183], v3
  v_add_f32 v45, v45, v49
  v_smfmac_f32_16x16x64_bf16 v[56:59], v[28:31], v[184:191], v3
  v_add_f32 v46, v46, v50
  v_smfmac_f32_16x16x64_bf16 v[56:59], v[32:35], v[192:199], v3
  v_add_f32 v47, v47, v51
  v_cvt_pk_bf16_f32 v48, v44, v45
  v_cvt_pk_bf16_f32 v49, v46, v47
  ds_write2_b32 v113, v48, v49 offset0:0 offset1:2
  s_nop 3
  v_permlane32_swap_b32 v52, v56
  v_permlane32_swap_b32 v53, v57
  v_permlane32_swap_b32 v54, v58
  v_permlane32_swap_b32 v55, v59
  v_add_f32 v52, v52, v56
  v_add_f32 v53, v53, v57
  v_add_f32 v54, v54, v58
  v_add_f32 v55, v55, v59
  v_cvt_pk_bf16_f32 v56, v52, v53
  v_cvt_pk_bf16_f32 v57, v54, v55
  ds_write2_b32 v114, v56, v57 offset0:0 offset1:2
  s_waitcnt lgkmcnt(0)
  s_barrier
  s_cmp_eq_u32 s19, 62
  s_cbranch_scc1 cB_done
  s_waitcnt vmcnt(0) lgkmcnt(0)
  s_add_u32 s19, s19, 1
  s_mov_b32 s20, s21
  s_branch cB_va2_loop
cB_va2_retry:
  s_waitcnt lgkmcnt(0)
  buffer_load_dwordx4 v[8:11], v2, s[8:11], s20 offen offset:0 sc1
  buffer_load_dwordx4 v[12:15], v2, s[8:11], s20 offen offset:1024 sc1
  buffer_load_dwordx4 v[16:19], v2, s[8:11], s20 offen offset:2048 sc1
  buffer_load_dwordx4 v[20:23], v2, s[8:11], s20 offen offset:3072 sc1
  s_add_u32 s31, s31, 1
  s_add_u32 s30, s30, 1
  s_cmp_lt_u32 s30, 400000
  s_cbranch_scc1 cB_va2_ld
  s_branch cB_abort
cB_va2_last:
  s_waitcnt lgkmcnt(0)
  buffer_store_dwordx4 v[100:103], v2, s[8:11], s24 offen offset:0 sc1
  buffer_store_dwordx4 v[104:107], v2, s[8:11], s24 offen offset:1024 sc1
  buffer_store_dwordx4 v[108:111], v2, s[8:11], s24 offen offset:2048 sc1
  buffer_store_dwordx4 v[4:7], v2, s[8:11], s24 offen offset:3072 sc1
  s_add_u32 s24, s24, 8192
  s_waitcnt vmcnt(0)
  s_mov_b64 exec, 1
  buffer_store_dword v117, v2, s[8:11], s34 offen sc1
  s_mov_b64 exec, -1
  s_add_u32 s34, s34, 8
  s_mov_b64 exec, 1
  buffer_store_dword v117, v2, s[8:11], s34 offen sc1
  s_mov_b64 exec, -1
  s_add_u32 s34, s34, 8
  s_branch cB_done
.p2align 6

cB_va3_loop:
  s_add_u32 s23, s20, 4096
  s_add_u32 s21, s20, 25600
  v_mov_b32 v36, 0
  v_mov_b32 v37, 0
  v_mov_b32 v38, 0
  v_mov_b32 v39, 0
  v_mov_b32 v40, 0
  v_mov_b32 v41, 0
  v_mov_b32 v42, 0
  v_mov_b32 v43, 0
  v_mov_b32 v44, 0
  v_mov_b32 v45, 0
  v_mov_b32 v46, 0
  v_mov_b32 v47, 0
  v_mov_b32 v48, 0
  v_mov_b32 v49, 0
  v_mov_b32 v50, 0
  v_mov_b32 v51, 0
  v_mov_b32 v52, 0
  v_mov_b32 v53, 0
  v_mov_b32 v54, 0
  v_mov_b32 v55, 0
  v_mov_b32 v56, 0
  v_mov_b32 v57, 0
  v_mov_b32 v58, 0
  v_mov_b32 v59, 0
  v_mov_b32 v60, 0
  v_mov_b32 v61, 0
  v_mov_b32 v62, 0
  v_mov_b32 v63, 0
  v_mov_b32 v64, 0
  v_mov_b32 v65, 0
  v_mov_b32 v66, 0
  v_mov_b32 v67, 0
  s_mov_b32 s30, 0
  buffer_load_dword v76, v119, s[8:11], s20 offen sc1
  buffer_load_dword v77, v119, s[8:11], s20 offen sc1
  buffer_load_dword v78, v119, s[8:11], s20 offen sc1
cB_va3_fp_l:
  s_waitcnt vmcnt(2)
  v_cmp_eq_u32 vcc, -1, v76
  s_cbranch_vccz cB_va3_fp_d
  buffer_load_dword v76, v119, s[8:11], s20 offen sc1
  s_waitcnt vmcnt(2)
  v_cmp_eq_u32 vcc, -1, v77
  s_cbranch_vccz cB_va3_fp_d
  buffer_load_dword v77, v119, s[8:11], s20 offen sc1
  s_waitcnt vmcnt(2)
  v_cmp_eq_u32 vcc, -1, v78
  s_cbranch_vccz cB_va3_fp_d
  buffer_load_dword v78, v119, s[8:11], s20 offen sc1
  s_add_u32 s30, s30, 1
  s_cmp_lt_u32 s30, 400000
  s_cbranch_scc1 cB_va3_fp_l
  s_branch cB_abort
cB_va3_fp_d:
  buffer_load_dwordx4 v[24:27], v2, s[8:11], s23 offen offset:0 sc1
  buffer_load_dwordx4 v[28:31], v2, s[8:11], s23 offen offset:1024 sc1
  buffer_load_dwordx4 v[32:35], v2, s[8:11], s23 offen offset:2048 sc1
  s_barrier
cB_va3_ld:
  s_waitcnt vmcnt(0)
  v_max3_u32 v84, v24, v25, v26
  v_max3_u32 v84, v84, v27, v28
  v_max3_u32 v84, v84, v29, v30
  v_max3_u32 v84, v84, v31, v32
  v_max3_u32 v84, v84, v33, v34
  v_max_u32 v84, v84, v35
  v_cmp_eq_u32 vcc, -1, v84
  ds_write_b128 v2, v[24:27] offset:12288
  ds_write_b128 v2, v[28:31] offset:13312
  ds_write_b128 v2, v[32:35] offset:14336
  s_cbranch_vccnz cB_va3_retry
  s_waitcnt lgkmcnt(0)
  s_barrier
  ds_read_b128 v[8:11], v2 offset:8192
  ds_read_b128 v[12:15], v2 offset:9216
  ds_read_b128 v[16:19], v2 offset:10240
  ds_read_b128 v[20:23], v2 offset:11264
  s_waitcnt lgkmcnt(0)
  s_cmp_eq_u32 s19, 63
  s_cbranch_scc1 cB_done
  ds_read_b128 v[76:79], v1 offset:0
  ds_read_b128 v[80:83], v1 offset:1024
  ds_read_b128 v[84:87], v1 offset:2048
  ds_read_b128 v[88:91], v1 offset:3072
  ds_read_b128 v[92:95], v1 offset:4096
  ds_read_b128 v[96:99], v1 offset:5120
  v_smfmac_f32_16x16x64_bf16 v[60:63], v[8:11], v[200:207], v3
  v_smfmac_f32_16x16x64_bf16 v[60:63], v[12:15], v[208:215], v3
  s_waitcnt lgkmcnt(4)
  v_smfmac_f32_16x16x64_bf16 v[64:67], v[8:11], v[76:83], v3
  ds_read_b128 v[76:79], v1 offset:6144
  ds_read_b128 v[80:83], v1 offset:7168
  v_smfmac_f32_16x16x64_bf16 v[60:63], v[16:19], v[216:223], v3
  v_smfmac_f32_16x16x64_bf16 v[60:63], v[20:23], v[224:231], v3
  s_waitcnt lgkmcnt(4)
  v_smfmac_f32_16x16x64_bf16 v[64:67], v[12:15], v[84:91], v3
  ds_read_b128 v[84:87], v1 offset:8192
  ds_read_b128 v[88:91], v1 offset:9216
  v_smfmac_f32_16x16x64_bf16 v[60:63], v[24:27], v[232:239], v3
  v_smfmac_f32_16x16x64_bf16 v[60:63], v[28:31], v[240:247], v3
  s_waitcnt lgkmcnt(4)
  v_smfmac_f32_16x16x64_bf16 v[64:67], v[16:19], v[92:99], v3
  ds_read_b128 v[92:95], v1 offset:10240
  ds_read_b128 v[96:99], v1 offset:11264
  v_smfmac_f32_16x16x64_bf16 v[60:63], v[32:35], v[248:255], v3
  v_smfmac_f32_16x16x64_bf16 v[36:39], v[8:11], a[0:7], v3
  s_waitcnt lgkmcnt(4)
  v_smfmac_f32_16x16x64_bf16 v[64:67], v[20:23], v[76:83], v3
  ds_read_b128 v[76:79], v1 offset:12288
  ds_read_b128 v[80:83], v1 offset:13312
  v_smfmac_f32_16x16x64_bf16 v[36:39], v[12:15], a[8:15], v3
  v_smfmac_f32_16x16x64_bf16 v[36:39], v[16:19], a[16:23], v3
  s_waitcnt lgkmcnt(4)
  v_smfmac_f32_16x16x64_bf16 v[64:67], v[24:27], v[84:91], v3
  v_smfmac_f32_16x16x64_bf16 v[36:39], v[20:23], a[24:31], v3
  v_smfmac_f32_16x16x64_bf16 v[36:39], v[24:27], a[32:39], v3
  s_waitcnt lgkmcnt(2)
  v_smfmac_f32_16x16x64_bf16 v[64:67], v[28:31], v[92:99], v3
  v_smfmac_f32_16x16x64_bf16 v[36:39], v[28:31], a[40:47], v3
  v_smfmac_f32_16x16x64_bf16 v[36:39], v[32:35], a[48:55], v3
  s_waitcnt lgkmcnt(0)
  v_smfmac_f32_16x16x64_bf16 v[64:67], v[32:35], v[76:83], v3
  v_smfmac_f32_16x16x64_bf16 v[40:43], v[8:11], a[56:63], v3
  v_smfmac_f32_16x16x64_bf16 v[40:43], v[12:15], a[64:71], v3
  v_smfmac_f32_16x16x64_bf16 v[40:43], v[16:19], a[72:79], v3
  v_smfmac_f32_16x16x64_bf16 v[40:43], v[20:23], a[80:87], v3
  v_permlane32_swap_b32 v60, v64
  v_smfmac_f32_16x16x64_bf16 v[40:43], v[24:27], a[88:95], v3
  v_permlane32_swap_b32 v61, v65
  v_smfmac_f32_16x16x64_bf16 v[40:43], v[28:31], a[96:103], v3
  v_permlane32_swap_b32 v62, v66
  v_smfmac_f32_16x16x64_bf16 v[40:43], v[32:35], a[104:111], v3
  v_permlane32_swap_b32 v63, v67
  v_smfmac_f32_16x16x64_bf16 v[44:47], v[8:11], a[112:119], v3
  v_smfmac_f32_16x16x64_bf16 v[44:47], v[12:15], a[120:127], v3
  v_smfmac_f32_16x16x64_bf16 v[44:47], v[16:19], a[128:135], v3
  v_smfmac_f32_16x16x64_bf16 v[44:47], v[20:23], a[136:143], v3
  v_add_f32 v60, v60, v64
  v_add_f32 v61, v61, v65
  v_smfmac_f32_16x16x64_bf16 v[44:47], v[24:27], a[144:151], v3
  v_add_f32 v62, v62, v66
  v_add_f32 v63, v63, v67
  v_smfmac_f32_16x16x64_bf16 v[44:47], v[28:31], a[152:159], v3
  v_cvt_pk_bf16_f32 v64, v60, v61
  v_cvt_pk_bf16_f32 v65, v62, v63
  v_smfmac_f32_16x16x64_bf16 v[44:47], v[32:35], a[160:167], v3
  ds_write2_b32 v115, v64, v65 offset0:0 offset1:2
  v_smfmac_f32_16x16x64_bf16 v[48:51], v[8:11], a[168:175], v3
  v_permlane32_swap_b32 v36, v40
  v_smfmac_f32_16x16x64_bf16 v[48:51], v[12:15], a[176:183], v3
  v_permlane32_swap_b32 v37, v41
  v_smfmac_f32_16x16x64_bf16 v[48:51], v[16:19], a[184:191], v3
  v_permlane32_swap_b32 v38, v42
  v_smfmac_f32_16x16x64_bf16 v[48:51], v[20:23], a[192:199], v3
  v_permlane32_swap_b32 v39, v43
  v_smfmac_f32_16x16x64_bf16 v[48:51], v[24:27], a[200:207], v3
  v_add_f32 v36, v36, v40
  v_smfmac_f32_16x16x64_bf16 v[48:51], v[28:31], a[208:215], v3
  v_add_f32 v37, v37, v41
  v_smfmac_f32_16x16x64_bf16 v[48:51], v[32:35], a[216:223], v3
  v_add_f32 v38, v38, v42
  v_smfmac_f32_16x16x64_bf16 v[52:55], v[8:11], a[224:231], v3
  v_smfmac_f32_16x16x64_bf16 v[52:55], v[12:15], a[232:239], v3
  v_smfmac_f32_16x16x64_bf16 v[52:55], v[16:19], a[240:247], v3
  v_smfmac_f32_16x16x64_bf16 v[52:55], v[20:23], a[248:255], v3
  v_add_f32 v39, v39, v43
  v_cvt_pk_bf16_f32 v40, v36, v37
  v_smfmac_f32_16x16x64_bf16 v[52:55], v[24:27], v[120:127], v3
  v_cvt_pk_bf16_f32 v41, v38, v39
  v_smfmac_f32_16x16x64_bf16 v[52:55], v[28:31], v[128:135], v3
  ds_write2_b32 v112, v40, v41 offset0:0 offset1:2
  v_smfmac_f32_16x16x64_bf16 v[52:55], v[32:35], v[136:143], v3
  v_permlane32_swap_b32 v44, v48
  v_smfmac_f32_16x16x64_bf16 v[56:59], v[8:11], v[144:151], v3
  v_permlane32_swap_b32 v45, v49
  v_smfmac_f32_16x16x64_bf16 v[56:59], v[12:15], v[152:159], v3
  v_permlane32_swap_b32 v46, v50
  v_smfmac_f32_16x16x64_bf16 v[56:59], v[16:19], v[160:167], v3
  v_permlane32_swap_b32 v47, v51
  v_smfmac_f32_16x16x64_bf16 v[56:59], v[20:23], v[168:175], v3
  v_add_f32 v44, v44, v48
  v_smfmac_f32_16x16x64_bf16 v[56:59], v[24:27], v[176:183], v3
  v_add_f32 v45, v45, v49
  v_smfmac_f32_16x16x64_bf16 v[56:59], v[28:31], v[184:191], v3
  v_add_f32 v46, v46, v50
  v_smfmac_f32_16x16x64_bf16 v[56:59], v[32:35], v[192:199], v3
  v_add_f32 v47, v47, v51
  v_cvt_pk_bf16_f32 v48, v44, v45
  v_cvt_pk_bf16_f32 v49, v46, v47
  ds_write2_b32 v113, v48, v49 offset0:0 offset1:2
  s_nop 3
  v_permlane32_swap_b32 v52, v56
  v_permlane32_swap_b32 v53, v57
  v_permlane32_swap_b32 v54, v58
  v_permlane32_swap_b32 v55, v59
  v_add_f32 v52, v52, v56
  v_add_f32 v53, v53, v57
  v_add_f32 v54, v54, v58
  v_add_f32 v55, v55, v59
  v_cvt_pk_bf16_f32 v56, v52, v53
  v_cvt_pk_bf16_f32 v57, v54, v55
  ds_write2_b32 v114, v56, v57 offset0:0 offset1:2
  s_waitcnt lgkmcnt(0)
  s_barrier
  s_cmp_eq_u32 s19, 62
  s_cbranch_scc1 cB_done
  s_waitcnt vmcnt(0) lgkmcnt(0)
  s_add_u32 s19, s19, 1
  s_mov_b32 s20, s21
  s_branch cB_va3_loop
cB_va3_retry:
  s_waitcnt lgkmcnt(0)
  buffer_load_dwordx4 v[24:27], v2, s[8:11], s23 offen offset:0 sc1
  buffer_load_dwordx4 v[28:31], v2, s[8:11], s23 offen offset:1024 sc1
  buffer_load_dwordx4 v[32:35], v2, s[8:11], s23 offen offset:2048 sc1
  s_add_u32 s31, s31, 1
  s_add_u32 s30, s30, 1
  s_cmp_lt_u32 s30, 400000
  s_cbranch_scc1 cB_va3_ld
  s_branch cB_abort
cB_va3_last:
  s_waitcnt lgkmcnt(0)
  buffer_store_dwordx4 v[100:103], v2, s[8:11], s24 offen offset:0 sc1
  buffer_store_dwordx4 v[104:107], v2, s[8:11], s24 offen offset:1024 sc1
  buffer_store_dwordx4 v[108:111], v2, s[8:11], s24 offen offset:2048 sc1
  buffer_store_dwordx4 v[4:7], v2, s[8:11], s24 offen offset:3072 sc1
  s_add_u32 s24, s24, 8192
  s_waitcnt vmcnt(0)
  s_mov_b64 exec, 1
  buffer_store_dword v117, v2, s[8:11], s34 offen sc1
  s_mov_b64 exec, -1
  s_add_u32 s34, s34, 8
  s_mov_b64 exec, 1
  buffer_store_dword v117, v2, s[8:11], s34 offen sc1
  s_mov_b64 exec, -1
  s_add_u32 s34, s34, 8
  s_branch cB_done
cB_abort:
  v_mov_b32 v4, 0xdead
  v_mov_b32 v5, 16
  buffer_store_dword v4, v5, s[12:15], 0 offen
  s_branch ch_end
cB_done:
  s_branch ch_end
m_reclaim:
  s_waitcnt vmcnt(0)
  s_lshr_b32 s20, s3, 5
  s_cmp_lg_u32 s16, 0
  s_cbranch_scc1 w0_17
  s_mov_b32 s21, 0
  s_mov_b64 exec, 1
rc_l:
  s_cmp_lg_u32 s70, -1
  s_cbranch_scc1 rc_t
  s_add_u32 s20, s20, 1
  s_cmp_lt_u32 s20, 8
  s_cselect_b32 s20, s20, 0
  s_mov_b32 s70, 0
  s_mov_b32 s3, -1
  s_add_u32 s21, s21, 1
  s_cmp_ge_u32 s21, 9
  s_cbranch_scc1 rc_d
rc_t:
  s_ff0_i32_b32 s22, s70
  s_lshl_b32 s23, 1, s22
  s_and_b32 s71, s20, 4
  s_mul_i32 s71, s71, 12
  s_lshl_b32 s3, s20, 2
  s_add_u32 s3, s3, s71
  v_mov_b32 v242, s23
  v_mov_b32 v243, 32
  buffer_atomic_or v242, v243, s[12:15], s3 offen sc0
  s_waitcnt vmcnt(0)
  v_readfirstlane_b32 s70, v242
  s_lshl_b32 s3, s20, 5
  s_add_u32 s3, s3, s22
  s_bitcmp1_b32 s70, s22
  s_cbranch_scc1 rc_l
rc_d:
  s_mov_b64 exec, -1
  v_mov_b32 v242, s3
w0_17:
  v_mov_b32 v250, 160000
  s_add_u32 s101, s101, 1
  s_barrier
  s_mov_b64 exec, 1
  s_cmp_lg_u32 s16, 0
  s_cbranch_scc1 w0_18
  ds_write_b32 v250, v242 offset:0
  s_waitcnt lgkmcnt(0)
  v_mov_b32 v242, s101
  ds_write_b32 v250, v242 offset:16
  s_waitcnt lgkmcnt(0)
w0_18:
  s_mov_b64 exec, -1
  s_barrier
  ds_read_b32 v242, v250 offset:0
  ds_read_b32 v250, v250 offset:16
  s_waitcnt lgkmcnt(0)
  v_readfirstlane_b32 s3, v242
  v_cmp_ne_u32 vcc, s101, v250
  s_cbranch_vccnz ch_end
  s_cmp_lg_u32 s3, -1
  s_cbranch_scc1 m_start
  v_mov_b32 v250, 0
  s_branch wk_ask
m_bjob:
  v_and_b32 v1, 63, v0
  v_lshlrev_b32 v2, 4, v1
  v_lshrrev_b32 v3, 4, v1
  v_and_b32 v4, 15, v1
  s_sub_u32 s18, s3, 32
  s_mul_i32 s17, s18, 4682
  s_lshr_b32 s17, s17, 16
  s_mul_i32 s20, s17, 14
  s_sub_u32 s19, s18, s20
  s_cmp_ge_u32 s19, 7
  s_cselect_b32 s31, 7, 0
  s_sub_u32 s19, s19, s31
  s_mov_b32 s60, s44
  s_and_b32 s61, s45, 0xffff
  s_mov_b32 s62, 3670016
  s_mov_b32 s63, 0x20000
  s_mov_b32 s56, s46
  s_and_b32 s57, s47, 0xffff
  s_mov_b32 s58, 3670016
  s_mov_b32 s59, 0x20000
  s_lshl_b32 s30, s16, 13
  s_mul_i32 s27, s17, 229376
  s_lshl_b32 s29, s19, 7
  s_add_u32 s27, s27, s29
  v_lshrrev_b32 v7, 3, v1
  v_and_b32 v8, 7, v1
  s_lshl_b32 s29, s16, 6
  v_add_u32 v7, s29, v7
  v_mul_u32_u24 v7, 896, v7
  v_lshl_add_u32 v7, v8, 4, v7
  s_add_u32 m0, s30, 0
  s_add_u32 s22, s27, 0
  buffer_load_dwordx4 v7, s[56:59], s22 offen offset:0 lds
  s_add_u32 s22, s27, 6144
  buffer_load_dwordx4 v7, s[56:59], s22 offen offset:1024 lds
  s_add_u32 s22, s27, 12288
  buffer_load_dwordx4 v7, s[56:59], s22 offen offset:2048 lds
  s_add_u32 s22, s27, 18432
  buffer_load_dwordx4 v7, s[56:59], s22 offen offset:3072 lds
  s_add_u32 m0, s30, 4096
  s_add_u32 s22, s27, 28672
  buffer_load_dwordx4 v7, s[56:59], s22 offen offset:0 lds
  s_add_u32 s22, s27, 34816
  buffer_load_dwordx4 v7, s[56:59], s22 offen offset:1024 lds
  s_add_u32 s22, s27, 40960
  buffer_load_dwordx4 v7, s[56:59], s22 offen offset:2048 lds
  s_add_u32 s22, s27, 47104
  buffer_load_dwordx4 v7, s[56:59], s22 offen offset:3072 lds
  v_lshrrev_b32 v5, 5, v1
  v_and_b32 v6, 31, v1
  s_lshl_b32 s25, s16, 15
  s_add_u32 s25, s25, 32768
  s_lshl_b32 s26, s17, 9
  s_add_u32 s28, s19, s16
  s_cmp_ge_u32 s28, 7
  s_cselect_b32 s20, 7, 0
  s_sub_u32 s28, s28, s20
  s_add_u32 s28, s28, s31
  s_add_u32 s29, s19, s16
  s_add_u32 s29, s29, 4
  s_cmp_ge_u32 s29, 7
  s_cselect_b32 s20, 7, 0
  s_sub_u32 s29, s29, s20
  s_add_u32 s29, s29, s31
  s_lshl_b32 s32, s28, 18
  s_add_u32 s32, s32, s26
  s_lshl_b32 s33, s29, 18
  s_add_u32 s33, s33, s26
  v_xor_b32 v8, v6, v5
  v_lshlrev_b32 v8, 4, v8
  v_lshl_add_u32 v8, v5, 13, v8
  v_xor_b32 v12, 0, v8
  v_xor_b32 v13, 32, v8
  v_add_u32 v13, 15360, v13
  v_xor_b32 v14, 0, v8
  v_add_u32 v14, 30720, v14
  v_xor_b32 v15, 32, v8
  v_add_u32 v15, 46080, v15
  s_add_u32 s20, s16, 0
  s_and_b32 s20, s20, 3
  s_mul_i32 s21, s20, 65600
  s_lshl_b32 s20, s20, 12
  s_add_u32 s48, s20, s25
  s_mov_b32 m0, s48
  v_xor_b32 v16, s21, v12
  buffer_load_dwordx4 v16, s[60:63], s32 offen offset:0 lds
  v_xor_b32 v17, s21, v13
  buffer_load_dwordx4 v17, s[60:63], s32 offen offset:1024 lds
  v_xor_b32 v18, s21, v14
  buffer_load_dwordx4 v18, s[60:63], s32 offen offset:2048 lds
  v_xor_b32 v19, s21, v15
  buffer_load_dwordx4 v19, s[60:63], s32 offen offset:3072 lds
  s_add_u32 s20, s16, 1
  s_and_b32 s20, s20, 3
  s_mul_i32 s21, s20, 65600
  s_lshl_b32 s20, s20, 12
  s_add_u32 s49, s20, s25
  s_mov_b32 m0, s49
  v_xor_b32 v20, s21, v12
  buffer_load_dwordx4 v20, s[60:63], s32 offen offset:0 lds
  v_xor_b32 v21, s21, v13
  buffer_load_dwordx4 v21, s[60:63], s32 offen offset:1024 lds
  v_xor_b32 v22, s21, v14
  buffer_load_dwordx4 v22, s[60:63], s32 offen offset:2048 lds
  v_xor_b32 v23, s21, v15
  buffer_load_dwordx4 v23, s[60:63], s32 offen offset:3072 lds
  s_add_u32 s20, s16, 2
  s_and_b32 s20, s20, 3
  s_mul_i32 s21, s20, 65600
  s_lshl_b32 s20, s20, 12
  s_add_u32 s50, s20, s25
  s_mov_b32 m0, s50
  v_xor_b32 v24, s21, v12
  buffer_load_dwordx4 v24, s[60:63], s32 offen offset:0 lds
  v_xor_b32 v25, s21, v13
  buffer_load_dwordx4 v25, s[60:63], s32 offen offset:1024 lds
  v_xor_b32 v26, s21, v14
  buffer_load_dwordx4 v26, s[60:63], s32 offen offset:2048 lds
  v_xor_b32 v27, s21, v15
  buffer_load_dwordx4 v27, s[60:63], s32 offen offset:3072 lds
  s_add_u32 s20, s16, 3
  s_and_b32 s20, s20, 3
  s_mul_i32 s21, s20, 65600
  s_lshl_b32 s20, s20, 12
  s_add_u32 s51, s20, s25
  s_mov_b32 m0, s51
  v_xor_b32 v28, s21, v12
  buffer_load_dwordx4 v28, s[60:63], s32 offen offset:0 lds
  v_xor_b32 v29, s21, v13
  buffer_load_dwordx4 v29, s[60:63], s32 offen offset:1024 lds
  v_xor_b32 v30, s21, v14
  buffer_load_dwordx4 v30, s[60:63], s32 offen offset:2048 lds
  v_xor_b32 v31, s21, v15
  buffer_load_dwordx4 v31, s[60:63], s32 offen offset:3072 lds
  s_cmp_eq_u32 s16, 3
  s_cbranch_scc1 bj_np1
  s_add_u32 m0, s48, 16384
  s_nop 0
  buffer_load_dwordx4 v16, s[60:63], s33 offen offset:0 lds
  buffer_load_dwordx4 v17, s[60:63], s33 offen offset:1024 lds
  buffer_load_dwordx4 v18, s[60:63], s33 offen offset:2048 lds
  buffer_load_dwordx4 v19, s[60:63], s33 offen offset:3072 lds
  s_add_u32 m0, s49, 16384
  s_nop 0
  buffer_load_dwordx4 v20, s[60:63], s33 offen offset:0 lds
  buffer_load_dwordx4 v21, s[60:63], s33 offen offset:1024 lds
  buffer_load_dwordx4 v22, s[60:63], s33 offen offset:2048 lds
  buffer_load_dwordx4 v23, s[60:63], s33 offen offset:3072 lds
  s_add_u32 m0, s50, 16384
  s_nop 0
  buffer_load_dwordx4 v24, s[60:63], s33 offen offset:0 lds
  buffer_load_dwordx4 v25, s[60:63], s33 offen offset:1024 lds
  buffer_load_dwordx4 v26, s[60:63], s33 offen offset:2048 lds
  buffer_load_dwordx4 v27, s[60:63], s33 offen offset:3072 lds
  s_add_u32 m0, s51, 16384
  s_nop 0
  buffer_load_dwordx4 v28, s[60:63], s33 offen offset:0 lds
  buffer_load_dwordx4 v29, s[60:63], s33 offen offset:1024 lds
  buffer_load_dwordx4 v30, s[60:63], s33 offen offset:2048 lds
  buffer_load_dwordx4 v31, s[60:63], s33 offen offset:3072 lds
bj_np1:
  s_mov_b32 s52, s36
  s_and_b32 s53, s37, 0xffff
  s_mov_b32 s54, 1835008
  s_mov_b32 s55, 0x20000
  s_lshl_b32 s20, s18, 8
  v_add_u32 v95, s20, v0
  s_mov_b32 s21, 9586981
  v_mul_hi_u32 v6, v95, s21
  v_mul_u32_u24 v7, 448, v6
  v_sub_u32 v7, v95, v7
  v_lshrrev_b32 v8, 4, v7
  v_and_b32 v7, 15, v7
  v_lshl_add_u32 v9, v6, 4, v7
  v_mul_u32_u24 v9, 896, v9
  v_lshl_add_u32 v9, v8, 5, v9
  buffer_load_dwordx4 v[84:87], v9, s[52:55], 0 offen
  buffer_load_dwordx4 v[88:91], v9, s[52:55], 0 offen offset:16
  v_mul_u32_u24 v6, 14336, v6
  v_lshl_add_u32 v6, v7, 4, v6
  v_lshl_add_u32 v92, v8, 9, v6
  v_lshrrev_b32 v7, 2, v8
  v_lshl_add_u32 v6, v7, 11, v6
  v_and_b32 v7, 3, v8
  v_lshl_add_u32 v93, v7, 8, v6
  s_mov_b32 s72, s38
  s_and_b32 s73, s39, 0xffff
  s_mov_b32 s74, 7168
  s_mov_b32 s75, 0x20000
  v_min_u32 v6, 223, v0
  v_lshrrev_b32 v7, 3, v6
  v_and_b32 v6, 7, v6
  v_mul_u32_u24 v9, 896, v6
  v_lshl_add_u32 v9, v7, 5, v9
  buffer_load_dwordx4 v[36:39], v9, s[72:75], 0 offen
  buffer_load_dwordx4 v[40:43], v9, s[72:75], 0 offen offset:16
  v_lshlrev_b32 v7, 8, v7
  v_lshl_add_u32 v94, v6, 4, v7
  s_cmp_lt_u32 s16, 2
  s_cselect_b32 s20, s40, s42
  s_cselect_b32 s21, s41, s43
  s_mov_b32 s72, s20
  s_and_b32 s73, s21, 0xffff
  s_mov_b32 s74, 3670016
  s_mov_b32 s75, 0x20000
  s_add_u32 s20, s19, s31
  s_lshl_b32 s21, s20, 5
  s_lshl_b32 s22, s16, 4
  s_add_u32 s21, s21, s22
  s_mul_i32 s20, s20, 14
  s_add_u32 s20, s20, 250
  s_cmp_lt_u32 s16, 2
  s_cselect_b32 s20, s21, s20
  s_lshl_b32 s20, s20, 13
  s_add_u32 s20, s20, s26
  v_lshlrev_b32 v6, 13, v4
  v_lshl_add_u32 v6, v3, 7, v6
  buffer_load_dword v51, v6, s[72:75], s20 offen
  s_cmp_lg_u32 s66, 0
  s_cbranch_scc1 bj_ci
  s_cmp_lg_u32 s16, 0
  s_cbranch_scc1 w0_19
  s_lshr_b32 s70, s3, 5
  s_and_b32 s71, s70, 4
  s_mul_i32 s71, s71, 12
  s_lshl_b32 s70, s70, 2
  s_add_u32 s70, s70, s71
  s_lshl_b32 s71, 1, s3
  v_mov_b32 v44, s71
  v_mov_b32 v45, 32
  s_mov_b64 exec, 1
  buffer_atomic_or v44, v45, s[12:15], s70 offen sc0
  buffer_load_dwordx2 v[46:47], v45, s[12:15], 0 offen offset:96 sc1
  s_mov_b64 exec, -1
w0_19:
bj_ci:
  s_lshl_b32 s30, s19, 6
  s_add_u32 s30, s30, 0
  v_add_u32 v8, s30, v4
  v_mul_u32_u24 v10, 2341, v8
  v_lshrrev_b32 v10, 16, v10
  v_mul_u32_u24 v11, 28, v10
  v_sub_u32 v32, v8, v11
  s_mul_i32 s30, s17, 28
  v_add_u32 v32, s30, v32
  v_lshrrev_b32 v33, 4, v32
  v_and_b32 v32, 15, v32
  s_mov_b32 s30, 401408
  v_mul_lo_u32 v10, v10, s30
  v_mul_u32_u24 v33, 14336, v33
  v_add_u32 v10, v10, v33
  v_lshl_add_u32 v10, v3, 8, v10
  v_lshl_add_u32 v10, v32, 4, v10
  v_add_u32 v12, 6422528, v10
  s_lshl_b32 s30, s19, 6
  s_add_u32 s30, s30, 16
  v_add_u32 v8, s30, v4
  v_mul_u32_u24 v10, 2341, v8
  v_lshrrev_b32 v10, 16, v10
  v_mul_u32_u24 v11, 28, v10
  v_sub_u32 v32, v8, v11
  s_mul_i32 s30, s17, 28
  v_add_u32 v32, s30, v32
  v_lshrrev_b32 v33, 4, v32
  v_and_b32 v32, 15, v32
  s_mov_b32 s30, 401408
  v_mul_lo_u32 v10, v10, s30
  v_mul_u32_u24 v33, 14336, v33
  v_add_u32 v10, v10, v33
  v_lshl_add_u32 v10, v3, 8, v10
  v_lshl_add_u32 v10, v32, 4, v10
  v_add_u32 v13, 6422528, v10
  s_lshl_b32 s30, s19, 6
  s_add_u32 s30, s30, 32
  v_add_u32 v8, s30, v4
  v_mul_u32_u24 v10, 2341, v8
  v_lshrrev_b32 v10, 16, v10
  v_mul_u32_u24 v11, 28, v10
  v_sub_u32 v32, v8, v11
  s_mul_i32 s30, s17, 28
  v_add_u32 v32, s30, v32
  v_lshrrev_b32 v33, 4, v32
  v_and_b32 v32, 15, v32
  s_mov_b32 s30, 401408
  v_mul_lo_u32 v10, v10, s30
  v_mul_u32_u24 v33, 14336, v33
  v_add_u32 v10, v10, v33
  v_lshl_add_u32 v10, v3, 8, v10
  v_lshl_add_u32 v10, v32, 4, v10
  v_add_u32 v14, 6422528, v10
  s_lshl_b32 s30, s19, 6
  s_add_u32 s30, s30, 48
  v_add_u32 v8, s30, v4
  v_mul_u32_u24 v10, 2341, v8
  v_lshrrev_b32 v10, 16, v10
  v_mul_u32_u24 v11, 28, v10
  v_sub_u32 v32, v8, v11
  s_mul_i32 s30, s17, 28
  v_add_u32 v32, s30, v32
  v_lshrrev_b32 v33, 4, v32
  v_and_b32 v32, 15, v32
  s_mov_b32 s30, 401408
  v_mul_lo_u32 v10, v10, s30
  v_mul_u32_u24 v33, 14336, v33
  v_add_u32 v10, v10, v33
  v_lshl_add_u32 v10, v3, 8, v10
  v_lshl_add_u32 v10, v32, 4, v10
  v_add_u32 v15, 6422528, v10
  v_lshrrev_b32 v7, 2, v4
  v_lshlrev_b32 v7, 3, v7
  v_and_b32 v8, 3, v4
  v_add_u32 v7, v7, v8
  v_xor_b32 v10, v3, v4
  v_lshlrev_b32 v10, 4, v10
  v_lshl_add_u32 v10, v7, 9, v10
  v_add_u32 v10, s25, v10
  v_xor_b32 v32, 0, v10
  v_xor_b32 v33, 64, v10
  v_xor_b32 v34, 128, v10
  v_xor_b32 v35, 192, v10
  v_lshrrev_b32 v7, 2, v4
  v_lshl_add_u32 v7, v3, 3, v7
  v_lshlrev_b32 v7, 7, v7
  v_and_b32 v8, 3, v4
  v_lshl_add_u32 v7, v8, 3, v7
  s_waitcnt vmcnt(37)
  s_cmp_lg_u32 s16, 3
  s_cbranch_scc1 w3_20
  s_waitcnt vmcnt(21)
w3_20:
  s_barrier
  ds_read_b64_tr_b16 v[128:129], v7 offset:0
  ds_read_b64_tr_b16 v[130:131], v7 offset:512
  ds_read_b64_tr_b16 v[132:133], v7 offset:4096
  ds_read_b64_tr_b16 v[134:135], v7 offset:4608
  ds_read_b64_tr_b16 v[136:137], v7 offset:8192
  ds_read_b64_tr_b16 v[138:139], v7 offset:8704
  ds_read_b64_tr_b16 v[140:141], v7 offset:12288
  ds_read_b64_tr_b16 v[142:143], v7 offset:12800
  s_waitcnt lgkmcnt(6)
  ds_read_b64_tr_b16 v[144:145], v7 offset:16384
  ds_read_b64_tr_b16 v[146:147], v7 offset:16896
  ds_read_b64_tr_b16 v[148:149], v7 offset:20480
  ds_read_b64_tr_b16 v[150:151], v7 offset:20992
  ds_read_b64_tr_b16 v[152:153], v7 offset:24576
  ds_read_b64_tr_b16 v[154:155], v7 offset:25088
  ds_read_b64_tr_b16 v[156:157], v7 offset:28672
  ds_read_b64_tr_b16 v[158:159], v7 offset:29184
  s_waitcnt lgkmcnt(6)
  ds_read_b64_tr_b16 v[160:161], v7 offset:32
  ds_read_b64_tr_b16 v[162:163], v7 offset:544
  ds_read_b64_tr_b16 v[164:165], v7 offset:4128
  ds_read_b64_tr_b16 v[166:167], v7 offset:4640
  ds_read_b64_tr_b16 v[168:169], v7 offset:8224
  ds_read_b64_tr_b16 v[170:171], v7 offset:8736
  ds_read_b64_tr_b16 v[172:173], v7 offset:12320
  ds_read_b64_tr_b16 v[174:175], v7 offset:12832
  s_waitcnt lgkmcnt(6)
  ds_read_b64_tr_b16 v[176:177], v7 offset:16416
  ds_read_b64_tr_b16 v[178:179], v7 offset:16928
  ds_read_b64_tr_b16 v[180:181], v7 offset:20512
  ds_read_b64_tr_b16 v[182:183], v7 offset:21024
  ds_read_b64_tr_b16 v[184:185], v7 offset:24608
  ds_read_b64_tr_b16 v[186:187], v7 offset:25120
  ds_read_b64_tr_b16 v[188:189], v7 offset:28704
  ds_read_b64_tr_b16 v[190:191], v7 offset:29216
  s_waitcnt lgkmcnt(6)
  ds_read_b64_tr_b16 v[192:193], v7 offset:64
  ds_read_b64_tr_b16 v[194:195], v7 offset:576
  ds_read_b64_tr_b16 v[196:197], v7 offset:4160
  ds_read_b64_tr_b16 v[198:199], v7 offset:4672
  ds_read_b64_tr_b16 v[200:201], v7 offset:8256
  ds_read_b64_tr_b16 v[202:203], v7 offset:8768
  ds_read_b64_tr_b16 v[204:205], v7 offset:12352
  ds_read_b64_tr_b16 v[206:207], v7 offset:12864
  s_waitcnt lgkmcnt(6)
  ds_read_b64_tr_b16 v[208:209], v7 offset:16448
  ds_read_b64_tr_b16 v[210:211], v7 offset:16960
  ds_read_b64_tr_b16 v[212:213], v7 offset:20544
  ds_read_b64_tr_b16 v[214:215], v7 offset:21056
  ds_read_b64_tr_b16 v[216:217], v7 offset:24640
  ds_read_b64_tr_b16 v[218:219], v7 offset:25152
  ds_read_b64_tr_b16 v[220:221], v7 offset:28736
  ds_read_b64_tr_b16 v[222:223], v7 offset:29248
  s_waitcnt lgkmcnt(6)
  ds_read_b64_tr_b16 v[224:225], v7 offset:96
  ds_read_b64_tr_b16 v[226:227], v7 offset:608
  ds_read_b64_tr_b16 v[228:229], v7 offset:4192
  ds_read_b64_tr_b16 v[230:231], v7 offset:4704
  ds_read_b64_tr_b16 v[232:233], v7 offset:8288
  ds_read_b64_tr_b16 v[234:235], v7 offset:8800
  ds_read_b64_tr_b16 v[236:237], v7 offset:12384
  ds_read_b64_tr_b16 v[238:239], v7 offset:12896
  s_waitcnt lgkmcnt(6)
  ds_read_b64_tr_b16 v[240:241], v7 offset:16480
  ds_read_b64_tr_b16 v[242:243], v7 offset:16992
  ds_read_b64_tr_b16 v[244:245], v7 offset:20576
  ds_read_b64_tr_b16 v[246:247], v7 offset:21088
  ds_read_b64_tr_b16 v[248:249], v7 offset:24672
  ds_read_b64_tr_b16 v[250:251], v7 offset:25184
  ds_read_b64_tr_b16 v[252:253], v7 offset:28768
  ds_read_b64_tr_b16 v[254:255], v7 offset:29280
  s_waitcnt lgkmcnt(6)
  s_waitcnt vmcnt(21) lgkmcnt(0)
  s_cmp_lg_u32 s16, 3
  s_cbranch_scc1 w3_21
  s_waitcnt vmcnt(5)
w3_21:
  ds_read_b128 v[52:55], v32 offset:0
  ds_read_b128 v[56:59], v33 offset:0
  ds_read_b128 v[60:63], v34 offset:0
  ds_read_b128 v[64:67], v35 offset:0
  s_waitcnt lgkmcnt(3)
  v_mfma_f32_16x16x32_bf16 v[96:99], v[52:55], v[128:131], 0
  v_mfma_f32_16x16x32_bf16 v[100:103], v[52:55], v[160:163], 0
  v_mfma_f32_16x16x32_bf16 v[104:107], v[52:55], v[192:195], 0
  v_mfma_f32_16x16x32_bf16 v[108:111], v[52:55], v[224:227], 0
  ds_read_b128 v[52:55], v32 offset:256
  s_waitcnt lgkmcnt(3)
  v_mfma_f32_16x16x32_bf16 v[96:99], v[56:59], v[132:135], v[96:99]
  v_mfma_f32_16x16x32_bf16 v[100:103], v[56:59], v[164:167], v[100:103]
  v_mfma_f32_16x16x32_bf16 v[104:107], v[56:59], v[196:199], v[104:107]
  v_mfma_f32_16x16x32_bf16 v[108:111], v[56:59], v[228:231], v[108:111]
  ds_read_b128 v[56:59], v33 offset:256
  s_waitcnt lgkmcnt(3)
  v_mfma_f32_16x16x32_bf16 v[96:99], v[60:63], v[136:139], v[96:99]
  v_mfma_f32_16x16x32_bf16 v[100:103], v[60:63], v[168:171], v[100:103]
  v_mfma_f32_16x16x32_bf16 v[104:107], v[60:63], v[200:203], v[104:107]
  v_mfma_f32_16x16x32_bf16 v[108:111], v[60:63], v[232:235], v[108:111]
  ds_read_b128 v[60:63], v34 offset:256
  s_waitcnt lgkmcnt(3)
  v_mfma_f32_16x16x32_bf16 v[96:99], v[64:67], v[140:143], v[96:99]
  v_mfma_f32_16x16x32_bf16 v[100:103], v[64:67], v[172:175], v[100:103]
  v_mfma_f32_16x16x32_bf16 v[104:107], v[64:67], v[204:207], v[104:107]
  v_mfma_f32_16x16x32_bf16 v[108:111], v[64:67], v[236:239], v[108:111]
  ds_read_b128 v[64:67], v35 offset:256
  s_waitcnt lgkmcnt(3)
  v_mfma_f32_16x16x32_bf16 v[96:99], v[52:55], v[144:147], v[96:99]
  v_mfma_f32_16x16x32_bf16 v[100:103], v[52:55], v[176:179], v[100:103]
  v_mfma_f32_16x16x32_bf16 v[104:107], v[52:55], v[208:211], v[104:107]
  v_mfma_f32_16x16x32_bf16 v[108:111], v[52:55], v[240:243], v[108:111]
  ds_read_b128 v[52:55], v32 offset:2048
  s_waitcnt lgkmcnt(3)
  v_mfma_f32_16x16x32_bf16 v[96:99], v[56:59], v[148:151], v[96:99]
  v_mfma_f32_16x16x32_bf16 v[100:103], v[56:59], v[180:183], v[100:103]
  v_mfma_f32_16x16x32_bf16 v[104:107], v[56:59], v[212:215], v[104:107]
  v_mfma_f32_16x16x32_bf16 v[108:111], v[56:59], v[244:247], v[108:111]
  ds_read_b128 v[56:59], v33 offset:2048
  s_waitcnt lgkmcnt(3)
  v_mfma_f32_16x16x32_bf16 v[96:99], v[60:63], v[152:155], v[96:99]
  v_mfma_f32_16x16x32_bf16 v[100:103], v[60:63], v[184:187], v[100:103]
  v_mfma_f32_16x16x32_bf16 v[104:107], v[60:63], v[216:219], v[104:107]
  v_mfma_f32_16x16x32_bf16 v[108:111], v[60:63], v[248:251], v[108:111]
  ds_read_b128 v[60:63], v34 offset:2048
  s_waitcnt lgkmcnt(3)
  v_mfma_f32_16x16x32_bf16 v[96:99], v[64:67], v[156:159], v[96:99]
  v_mfma_f32_16x16x32_bf16 v[100:103], v[64:67], v[188:191], v[100:103]
  v_mfma_f32_16x16x32_bf16 v[104:107], v[64:67], v[220:223], v[104:107]
  v_mfma_f32_16x16x32_bf16 v[108:111], v[64:67], v[252:255], v[108:111]
  ds_read_b128 v[64:67], v35 offset:2048
  s_waitcnt lgkmcnt(3)
  v_mfma_f32_16x16x32_bf16 v[112:115], v[52:55], v[128:131], 0
  v_mfma_f32_16x16x32_bf16 v[116:119], v[52:55], v[160:163], 0
  v_mfma_f32_16x16x32_bf16 v[120:123], v[52:55], v[192:195], 0
  v_mfma_f32_16x16x32_bf16 v[124:127], v[52:55], v[224:227], 0
  ds_read_b128 v[52:55], v32 offset:2304
  s_waitcnt lgkmcnt(3)
  v_mfma_f32_16x16x32_bf16 v[112:115], v[56:59], v[132:135], v[112:115]
  v_mfma_f32_16x16x32_bf16 v[116:119], v[56:59], v[164:167], v[116:119]
  v_mfma_f32_16x16x32_bf16 v[120:123], v[56:59], v[196:199], v[120:123]
  v_mfma_f32_16x16x32_bf16 v[124:127], v[56:59], v[228:231], v[124:127]
  ds_read_b128 v[56:59], v33 offset:2304
  s_waitcnt lgkmcnt(3)
  v_mfma_f32_16x16x32_bf16 v[112:115], v[60:63], v[136:139], v[112:115]
  v_mfma_f32_16x16x32_bf16 v[116:119], v[60:63], v[168:171], v[116:119]
  v_mfma_f32_16x16x32_bf16 v[120:123], v[60:63], v[200:203], v[120:123]
  v_mfma_f32_16x16x32_bf16 v[124:127], v[60:63], v[232:235], v[124:127]
  ds_read_b128 v[60:63], v34 offset:2304
  s_waitcnt lgkmcnt(3)
  v_mfma_f32_16x16x32_bf16 v[112:115], v[64:67], v[140:143], v[112:115]
  v_mfma_f32_16x16x32_bf16 v[116:119], v[64:67], v[172:175], v[116:119]
  v_mfma_f32_16x16x32_bf16 v[120:123], v[64:67], v[204:207], v[120:123]
  v_mfma_f32_16x16x32_bf16 v[124:127], v[64:67], v[236:239], v[124:127]
  ds_read_b128 v[64:67], v35 offset:2304
  s_waitcnt lgkmcnt(3)
  v_mfma_f32_16x16x32_bf16 v[112:115], v[52:55], v[144:147], v[112:115]
  v_mfma_f32_16x16x32_bf16 v[116:119], v[52:55], v[176:179], v[116:119]
  v_mfma_f32_16x16x32_bf16 v[120:123], v[52:55], v[208:211], v[120:123]
  v_mfma_f32_16x16x32_bf16 v[124:127], v[52:55], v[240:243], v[124:127]
  s_waitcnt lgkmcnt(2)
  v_mfma_f32_16x16x32_bf16 v[112:115], v[56:59], v[148:151], v[112:115]
  v_mfma_f32_16x16x32_bf16 v[116:119], v[56:59], v[180:183], v[116:119]
  v_mfma_f32_16x16x32_bf16 v[120:123], v[56:59], v[212:215], v[120:123]
  v_mfma_f32_16x16x32_bf16 v[124:127], v[56:59], v[244:247], v[124:127]
  s_waitcnt lgkmcnt(1)
  v_mfma_f32_16x16x32_bf16 v[112:115], v[60:63], v[152:155], v[112:115]
  v_mfma_f32_16x16x32_bf16 v[116:119], v[60:63], v[184:187], v[116:119]
  v_mfma_f32_16x16x32_bf16 v[120:123], v[60:63], v[216:219], v[120:123]
  v_mfma_f32_16x16x32_bf16 v[124:127], v[60:63], v[248:251], v[124:127]
  s_waitcnt lgkmcnt(0)
  v_mfma_f32_16x16x32_bf16 v[112:115], v[64:67], v[156:159], v[112:115]
  v_mfma_f32_16x16x32_bf16 v[116:119], v[64:67], v[188:191], v[116:119]
  v_mfma_f32_16x16x32_bf16 v[120:123], v[64:67], v[220:223], v[120:123]
  v_mfma_f32_16x16x32_bf16 v[124:127], v[64:67], v[252:255], v[124:127]
  s_cmp_lg_u32 s66, 0
  s_cbranch_scc1 bj_cf
  s_cmp_lg_u32 s16, 0
  s_cbranch_scc1 w0_22
  s_waitcnt vmcnt(0)
  v_readfirstlane_b32 s70, v46
  s_cmp_lg_u32 s70, 0
  s_cbranch_scc1 bj_nz
  v_mov_b32 v45, 128
  v_mov_b32 v46, s88
  v_mov_b32 v47, s89
  v_mov_b32 v48, 0
  v_mov_b32 v49, 0
  s_mov_b64 exec, 1
  buffer_atomic_cmpswap_x2 v[46:49], v45, s[12:15], 0 offen sc0
  s_mov_b64 exec, -1
  s_waitcnt vmcnt(0)
  v_readfirstlane_b32 s70, v46
  s_cmp_lg_u32 s70, 0
  s_cbranch_scc1 bj_nz
  v_mov_b32 v46, s88
  v_mov_b32 v47, s89
bj_nz:
w0_22:
  v_mov_b32 v45, 160000
  s_add_u32 s101, s101, 1
  s_barrier
  s_mov_b64 exec, 1
  s_cmp_lg_u32 s16, 0
  s_cbranch_scc1 w0_23
  ds_write_b32 v45, v44 offset:0
  ds_write_b32 v45, v46 offset:4
  ds_write_b32 v45, v47 offset:8
  s_waitcnt lgkmcnt(0)
  v_mov_b32 v44, s101
  ds_write_b32 v45, v44 offset:16
  s_waitcnt lgkmcnt(0)
w0_23:
  s_mov_b64 exec, -1
  s_barrier
  ds_read_b32 v44, v45 offset:0
  ds_read_b32 v46, v45 offset:4
  ds_read_b32 v47, v45 offset:8
  ds_read_b32 v45, v45 offset:16
  s_waitcnt lgkmcnt(0)
  v_readfirstlane_b32 s70, v44
  v_readfirstlane_b32 s88, v46
  v_readfirstlane_b32 s89, v47
  v_cmp_ne_u32 vcc, s101, v45
  s_cbranch_vccnz ch_end
  s_mov_b32 s66, 1
  s_bitcmp1_b32 s70, s3
  s_cbranch_scc1 m_reclaim
bj_cf:
  s_lshl_b32 s30, s28, 10
  v_cvt_pk_bf16_f32 v68, v96, v97
  v_cvt_pk_bf16_f32 v69, v98, v99
  v_cvt_pk_bf16_f32 v70, v112, v113
  v_cvt_pk_bf16_f32 v71, v114, v115
  buffer_store_dwordx4 v[68:71], v12, s[8:11], s30 offen sc1
  v_cvt_pk_bf16_f32 v72, v100, v101
  v_cvt_pk_bf16_f32 v73, v102, v103
  v_cvt_pk_bf16_f32 v74, v116, v117
  v_cvt_pk_bf16_f32 v75, v118, v119
  buffer_store_dwordx4 v[72:75], v13, s[8:11], s30 offen sc1
  v_cvt_pk_bf16_f32 v76, v104, v105
  v_cvt_pk_bf16_f32 v77, v106, v107
  v_cvt_pk_bf16_f32 v78, v120, v121
  v_cvt_pk_bf16_f32 v79, v122, v123
  buffer_store_dwordx4 v[76:79], v14, s[8:11], s30 offen sc1
  v_cvt_pk_bf16_f32 v80, v108, v109
  v_cvt_pk_bf16_f32 v81, v110, v111
  v_cvt_pk_bf16_f32 v82, v124, v125
  v_cvt_pk_bf16_f32 v83, v126, v127
  buffer_store_dwordx4 v[80:83], v15, s[8:11], s30 offen sc1
  s_cmp_eq_u32 s16, 3
  s_cbranch_scc1 bj_w3
  s_waitcnt vmcnt(9)
  ds_read_b128 v[52:55], v32 offset:16384
  ds_read_b128 v[56:59], v33 offset:16384
  ds_read_b128 v[60:63], v34 offset:16384
  ds_read_b128 v[64:67], v35 offset:16384
  s_waitcnt lgkmcnt(3)
  v_mfma_f32_16x16x32_bf16 v[96:99], v[52:55], v[128:131], 0
  v_mfma_f32_16x16x32_bf16 v[100:103], v[52:55], v[160:163], 0
  v_mfma_f32_16x16x32_bf16 v[104:107], v[52:55], v[192:195], 0
  v_mfma_f32_16x16x32_bf16 v[108:111], v[52:55], v[224:227], 0
  ds_read_b128 v[52:55], v32 offset:16640
  s_waitcnt lgkmcnt(3)
  v_mfma_f32_16x16x32_bf16 v[96:99], v[56:59], v[132:135], v[96:99]
  v_mfma_f32_16x16x32_bf16 v[100:103], v[56:59], v[164:167], v[100:103]
  v_mfma_f32_16x16x32_bf16 v[104:107], v[56:59], v[196:199], v[104:107]
  v_mfma_f32_16x16x32_bf16 v[108:111], v[56:59], v[228:231], v[108:111]
  ds_read_b128 v[56:59], v33 offset:16640
  s_waitcnt lgkmcnt(3)
  v_mfma_f32_16x16x32_bf16 v[96:99], v[60:63], v[136:139], v[96:99]
  v_mfma_f32_16x16x32_bf16 v[100:103], v[60:63], v[168:171], v[100:103]
  v_mfma_f32_16x16x32_bf16 v[104:107], v[60:63], v[200:203], v[104:107]
  v_mfma_f32_16x16x32_bf16 v[108:111], v[60:63], v[232:235], v[108:111]
  ds_read_b128 v[60:63], v34 offset:16640
  s_waitcnt lgkmcnt(3)
  v_mfma_f32_16x16x32_bf16 v[96:99], v[64:67], v[140:143], v[96:99]
  v_mfma_f32_16x16x32_bf16 v[100:103], v[64:67], v[172:175], v[100:103]
  v_mfma_f32_16x16x32_bf16 v[104:107], v[64:67], v[204:207], v[104:107]
  v_mfma_f32_16x16x32_bf16 v[108:111], v[64:67], v[236:239], v[108:111]
  ds_read_b128 v[64:67], v35 offset:16640
  s_waitcnt lgkmcnt(3)
  v_mfma_f32_16x16x32_bf16 v[96:99], v[52:55], v[144:147], v[96:99]
  v_mfma_f32_16x16x32_bf16 v[100:103], v[52:55], v[176:179], v[100:103]
  v_mfma_f32_16x16x32_bf16 v[104:107], v[52:55], v[208:211], v[104:107]
  v_mfma_f32_16x16x32_bf16 v[108:111], v[52:55], v[240:243], v[108:111]
  ds_read_b128 v[52:55], v32 offset:18432
  s_waitcnt lgkmcnt(3)
  v_mfma_f32_16x16x32_bf16 v[96:99], v[56:59], v[148:151], v[96:99]
  v_mfma_f32_16x16x32_bf16 v[100:103], v[56:59], v[180:183], v[100:103]
  v_mfma_f32_16x16x32_bf16 v[104:107], v[56:59], v[212:215], v[104:107]
  v_mfma_f32_16x16x32_bf16 v[108:111], v[56:59], v[244:247], v[108:111]
  ds_read_b128 v[56:59], v33 offset:18432
  s_waitcnt lgkmcnt(3)
  v_mfma_f32_16x16x32_bf16 v[96:99], v[60:63], v[152:155], v[96:99]
  v_mfma_f32_16x16x32_bf16 v[100:103], v[60:63], v[184:187], v[100:103]
  v_mfma_f32_16x16x32_bf16 v[104:107], v[60:63], v[216:219], v[104:107]
  v_mfma_f32_16x16x32_bf16 v[108:111], v[60:63], v[248:251], v[108:111]
  ds_read_b128 v[60:63], v34 offset:18432
  s_waitcnt lgkmcnt(3)
  v_mfma_f32_16x16x32_bf16 v[96:99], v[64:67], v[156:159], v[96:99]
  v_mfma_f32_16x16x32_bf16 v[100:103], v[64:67], v[188:191], v[100:103]
  v_mfma_f32_16x16x32_bf16 v[104:107], v[64:67], v[220:223], v[104:107]
  v_mfma_f32_16x16x32_bf16 v[108:111], v[64:67], v[252:255], v[108:111]
  ds_read_b128 v[64:67], v35 offset:18432
  s_waitcnt lgkmcnt(3)
  v_mfma_f32_16x16x32_bf16 v[112:115], v[52:55], v[128:131], 0
  v_mfma_f32_16x16x32_bf16 v[116:119], v[52:55], v[160:163], 0
  v_mfma_f32_16x16x32_bf16 v[120:123], v[52:55], v[192:195], 0
  v_mfma_f32_16x16x32_bf16 v[124:127], v[52:55], v[224:227], 0
  ds_read_b128 v[52:55], v32 offset:18688
  s_waitcnt lgkmcnt(3)
  v_mfma_f32_16x16x32_bf16 v[112:115], v[56:59], v[132:135], v[112:115]
  v_mfma_f32_16x16x32_bf16 v[116:119], v[56:59], v[164:167], v[116:119]
  v_mfma_f32_16x16x32_bf16 v[120:123], v[56:59], v[196:199], v[120:123]
  v_mfma_f32_16x16x32_bf16 v[124:127], v[56:59], v[228:231], v[124:127]
  ds_read_b128 v[56:59], v33 offset:18688
  s_waitcnt lgkmcnt(3)
  v_mfma_f32_16x16x32_bf16 v[112:115], v[60:63], v[136:139], v[112:115]
  v_mfma_f32_16x16x32_bf16 v[116:119], v[60:63], v[168:171], v[116:119]
  v_mfma_f32_16x16x32_bf16 v[120:123], v[60:63], v[200:203], v[120:123]
  v_mfma_f32_16x16x32_bf16 v[124:127], v[60:63], v[232:235], v[124:127]
  ds_read_b128 v[60:63], v34 offset:18688
  s_waitcnt lgkmcnt(3)
  v_mfma_f32_16x16x32_bf16 v[112:115], v[64:67], v[140:143], v[112:115]
  v_mfma_f32_16x16x32_bf16 v[116:119], v[64:67], v[172:175], v[116:119]
  v_mfma_f32_16x16x32_bf16 v[120:123], v[64:67], v[204:207], v[120:123]
  v_mfma_f32_16x16x32_bf16 v[124:127], v[64:67], v[236:239], v[124:127]
  ds_read_b128 v[64:67], v35 offset:18688
  s_waitcnt lgkmcnt(3)
  v_mfma_f32_16x16x32_bf16 v[112:115], v[52:55], v[144:147], v[112:115]
  v_mfma_f32_16x16x32_bf16 v[116:119], v[52:55], v[176:179], v[116:119]
  v_mfma_f32_16x16x32_bf16 v[120:123], v[52:55], v[208:211], v[120:123]
  v_mfma_f32_16x16x32_bf16 v[124:127], v[52:55], v[240:243], v[124:127]
  s_waitcnt lgkmcnt(2)
  v_mfma_f32_16x16x32_bf16 v[112:115], v[56:59], v[148:151], v[112:115]
  v_mfma_f32_16x16x32_bf16 v[116:119], v[56:59], v[180:183], v[116:119]
  v_mfma_f32_16x16x32_bf16 v[120:123], v[56:59], v[212:215], v[120:123]
  v_mfma_f32_16x16x32_bf16 v[124:127], v[56:59], v[244:247], v[124:127]
  s_waitcnt lgkmcnt(1)
  v_mfma_f32_16x16x32_bf16 v[112:115], v[60:63], v[152:155], v[112:115]
  v_mfma_f32_16x16x32_bf16 v[116:119], v[60:63], v[184:187], v[116:119]
  v_mfma_f32_16x16x32_bf16 v[120:123], v[60:63], v[216:219], v[120:123]
  v_mfma_f32_16x16x32_bf16 v[124:127], v[60:63], v[248:251], v[124:127]
  s_waitcnt lgkmcnt(0)
  v_mfma_f32_16x16x32_bf16 v[112:115], v[64:67], v[156:159], v[112:115]
  v_mfma_f32_16x16x32_bf16 v[116:119], v[64:67], v[188:191], v[116:119]
  v_mfma_f32_16x16x32_bf16 v[120:123], v[64:67], v[220:223], v[120:123]
  v_mfma_f32_16x16x32_bf16 v[124:127], v[64:67], v[252:255], v[124:127]
  s_lshl_b32 s30, s29, 10
  v_cvt_pk_bf16_f32 v68, v96, v97
  v_cvt_pk_bf16_f32 v69, v98, v99
  v_cvt_pk_bf16_f32 v70, v112, v113
  v_cvt_pk_bf16_f32 v71, v114, v115
  buffer_store_dwordx4 v[68:71], v12, s[8:11], s30 offen sc1
  v_cvt_pk_bf16_f32 v72, v100, v101
  v_cvt_pk_bf16_f32 v73, v102, v103
  v_cvt_pk_bf16_f32 v74, v116, v117
  v_cvt_pk_bf16_f32 v75, v118, v119
  buffer_store_dwordx4 v[72:75], v13, s[8:11], s30 offen sc1
  v_cvt_pk_bf16_f32 v76, v104, v105
  v_cvt_pk_bf16_f32 v77, v106, v107
  v_cvt_pk_bf16_f32 v78, v120, v121
  v_cvt_pk_bf16_f32 v79, v122, v123
  buffer_store_dwordx4 v[76:79], v14, s[8:11], s30 offen sc1
  v_cvt_pk_bf16_f32 v80, v108, v109
  v_cvt_pk_bf16_f32 v81, v110, v111
  v_cvt_pk_bf16_f32 v82, v124, v125
  v_cvt_pk_bf16_f32 v83, v126, v127
  buffer_store_dwordx4 v[80:83], v15, s[8:11], s30 offen sc1
bj_w3:
  s_lshl_b32 s77, s19, 8
  s_lshl_b32 s21, s17, 4
  s_add_u32 s77, s77, s21
  s_cmp_lg_u32 s31, 0
  s_cselect_b32 s21, 8, 0
  s_add_u32 s77, s77, s21
  s_add_u32 s77, s77, 88588288
  s_add_u32 s78, s77, 2048
  s_waitcnt vmcnt(4)
  v_mov_b32 v96, v84
  v_mov_b32 v100, v85
  v_min_u32 v104, -2, v36
  v_min_u32 v108, -2, v37
  v_mov_b32 v97, v86
  v_mov_b32 v101, v87
  v_min_u32 v105, -2, v38
  v_min_u32 v109, -2, v39
  v_mov_b32 v98, v88
  v_mov_b32 v102, v89
  v_min_u32 v106, -2, v40
  v_min_u32 v110, -2, v41
  v_mov_b32 v99, v90
  v_mov_b32 v103, v91
  v_min_u32 v107, -2, v42
  v_min_u32 v111, -2, v43
  s_mov_b32 s20, 71565312
  s_mov_b32 s21, 73400320
  buffer_store_dwordx4 v[84:87], v92, s[8:11], s20 offen sc1
  buffer_store_dwordx4 v[88:91], v92, s[8:11], s20 offen offset:256 sc1
  buffer_store_dwordx4 v[96:99], v93, s[8:11], s21 offen sc1
  buffer_store_dwordx4 v[100:103], v93, s[8:11], s21 offen offset:1024 sc1
  s_cmp_lg_u32 s18, 0
  s_cbranch_scc1 bk_nm
  s_mov_b32 s20, 75235328
  s_mov_b32 s21, 88068096
  buffer_store_dwordx4 v[104:107], v94, s[8:11], s20 offen sc1
  buffer_store_dwordx4 v[108:111], v94, s[8:11], s20 offen offset:128 sc1
  buffer_store_dwordx4 v[104:107], v94, s[8:11], s21 offen sc1
  buffer_store_dwordx4 v[108:111], v94, s[8:11], s21 offen offset:128 sc1
bk_nm:
  s_mov_b32 s23, 75235328
  v_add_u32 v6, 448, v95
  v_subrev_u32 v7, 1344, v6
  v_mov_b32 v52, -1
  v_mov_b32 v9, 0
  v_cmp_gt_u32 vcc, 256, v7
  s_nop 1
  v_cndmask_b32 v52, v52, v9, vcc
  v_mov_b32 v53, v52
  v_mov_b32 v54, v52
  v_mov_b32 v55, v52
  v_lshlrev_b32 v8, 4, v6
  v_mov_b32 v9, 0x10000000
  v_cmp_lt_u32 vcc, 105599, v6
  s_nop 1
  v_cndmask_b32 v8, v8, v9, vcc
  buffer_store_dwordx4 v[52:55], v8, s[8:11], s23 offen sc1
  v_add_u32 v6, 57792, v95
  v_subrev_u32 v7, 1344, v6
  v_mov_b32 v56, -1
  v_mov_b32 v9, 0
  v_cmp_gt_u32 vcc, 256, v7
  s_nop 1
  v_cndmask_b32 v56, v56, v9, vcc
  v_mov_b32 v57, v56
  v_mov_b32 v58, v56
  v_mov_b32 v59, v56
  v_lshlrev_b32 v8, 4, v6
  v_mov_b32 v9, 0x10000000
  v_cmp_lt_u32 vcc, 105599, v6
  s_nop 1
  v_cndmask_b32 v8, v8, v9, vcc
  buffer_store_dwordx4 v[56:59], v8, s[8:11], s23 offen sc1
  s_mov_b32 s23, 87945216
  v_add_u32 v6, 448, v95
  v_cmp_gt_u32 vcc, 7680, v95
  s_nop 1
  v_cndmask_b32 v6, v6, v95, vcc
  v_subrev_u32 v7, 36352, v6
  v_mov_b32 v60, -1
  v_mov_b32 v9, 0
  v_cmp_gt_u32 vcc, 1048576, v7
  s_nop 1
  v_cndmask_b32 v60, v60, v9, vcc
  v_mov_b32 v61, v60
  v_mov_b32 v62, v60
  v_mov_b32 v63, v60
  v_lshlrev_b32 v8, 4, v6
  v_mov_b32 v9, 0x10000000
  v_cmp_lt_u32 vcc, 40191, v6
  s_nop 1
  v_cndmask_b32 v8, v8, v9, vcc
  buffer_store_dwordx4 v[60:63], v8, s[8:11], s23 offen sc1
  s_barrier
  s_mov_b32 s56, s40
  s_and_b32 s57, s41, 0xffff
  s_mov_b32 s58, 3670016
  s_mov_b32 s59, 0x20000
  s_mov_b32 s60, s42
  s_and_b32 s61, s43, 0xffff
  s_mov_b32 s62, 3670016
  s_mov_b32 s63, 0x20000
  s_add_u32 s28, s31, s19
  v_lshrrev_b32 v5, 5, v1
  v_and_b32 v6, 31, v1
  v_xor_b32 v6, v6, v5
  v_lshlrev_b32 v6, 4, v6
  v_lshl_add_u32 v6, v5, 13, v6
  s_lshl_b32 s20, s16, 6
  v_xor_b32 v7, s20, v6
  s_lshl_b32 s22, s28, 18
  s_lshl_b32 s21, s16, 16
  s_add_u32 s22, s22, s21
  s_add_u32 s22, s22, s26
  s_lshl_b32 m0, s16, 12
  v_xor_b32 v8, 0, v7
  buffer_load_dwordx4 v8, s[56:59], s22 offen offset:0 lds
  v_xor_b32 v8, 32, v7
  v_add_u32 v8, 15360, v8
  buffer_load_dwordx4 v8, s[56:59], s22 offen offset:1024 lds
  v_xor_b32 v8, 0, v7
  v_add_u32 v8, 30720, v8
  buffer_load_dwordx4 v8, s[56:59], s22 offen offset:2048 lds
  v_xor_b32 v8, 32, v7
  v_add_u32 v8, 46080, v8
  buffer_load_dwordx4 v8, s[56:59], s22 offen offset:3072 lds
  v_xor_b32 v16, 0, v6
  v_xor_b32 v17, 32, v6
  v_add_u32 v17, 31744, v17
  v_xor_b32 v18, 64, v6
  v_add_u32 v18, 129024, v18
  v_xor_b32 v19, 96, v6
  v_add_u32 v19, 160768, v19
  v_xor_b32 v20, 128, v6
  v_add_u32 v20, 262144, v20
  v_xor_b32 v21, 160, v6
  v_add_u32 v21, 293888, v21
  v_xor_b32 v22, 192, v6
  v_add_u32 v22, 391168, v22
  v_xor_b32 v23, 224, v6
  v_add_u32 v23, 422912, v23
  s_lshr_b32 s20, s16, 1
  s_lshl_b32 s20, s20, 16
  s_and_b32 s21, s16, 1
  s_lshl_b32 s21, s21, 14
  s_add_u32 s20, s20, s21
  s_add_u32 s29, s20, s26
  s_mul_i32 s25, s16, 24576
  s_add_u32 s25, s25, 16384
  s_add_u32 s22, s29, 2097152
  s_add_u32 m0, s25, 0
  s_nop 0
  buffer_load_dwordx4 v16, s[60:63], s22 offen offset:0 lds
  buffer_load_dwordx4 v17, s[60:63], s22 offen offset:1024 lds
  buffer_load_dwordx4 v18, s[60:63], s22 offen offset:2048 lds
  buffer_load_dwordx4 v19, s[60:63], s22 offen offset:3072 lds
  s_add_u32 m0, s25, 4096
  s_nop 0
  buffer_load_dwordx4 v20, s[60:63], s22 offen offset:0 lds
  buffer_load_dwordx4 v21, s[60:63], s22 offen offset:1024 lds
  buffer_load_dwordx4 v22, s[60:63], s22 offen offset:2048 lds
  buffer_load_dwordx4 v23, s[60:63], s22 offen offset:3072 lds
  s_waitcnt vmcnt(12)
  s_barrier
  s_cmp_lg_u32 s16, 0
  s_cbranch_scc1 pub_24
  v_mul_u32_u24 v46, 2048, v1
  v_mov_b32 v44, s88
  v_mov_b32 v45, s89
  s_mov_b64 exec, 1
  buffer_store_dwordx2 v[44:45], v46, s[8:11], s77 offen sc1
  s_mov_b64 exec, -1
pub_24:
  s_cmp_lg_u32 s16, 0
  s_cbranch_scc1 w0_25
  v_mul_u32_u24 v50, 2048, v1
  v_mov_b32 v48, s88
  v_mov_b32 v49, s89
  s_mov_b64 exec, 511
  buffer_store_dwordx2 v[48:49], v50, s[8:11], s78 offen sc1
  s_mov_b64 exec, -1
w0_25:
  s_add_u32 s22, s29, 2621440
  s_add_u32 m0, s25, 8192
  s_nop 0
  buffer_load_dwordx4 v16, s[60:63], s22 offen offset:0 lds
  buffer_load_dwordx4 v17, s[60:63], s22 offen offset:1024 lds
  buffer_load_dwordx4 v18, s[60:63], s22 offen offset:2048 lds
  buffer_load_dwordx4 v19, s[60:63], s22 offen offset:3072 lds
  s_add_u32 m0, s25, 12288
  s_nop 0
  buffer_load_dwordx4 v20, s[60:63], s22 offen offset:0 lds
  buffer_load_dwordx4 v21, s[60:63], s22 offen offset:1024 lds
  buffer_load_dwordx4 v22, s[60:63], s22 offen offset:2048 lds
  buffer_load_dwordx4 v23, s[60:63], s22 offen offset:3072 lds
  s_add_u32 s22, s29, 3145728
  s_add_u32 m0, s25, 16384
  s_nop 0
  buffer_load_dwordx4 v16, s[60:63], s22 offen offset:0 lds
  buffer_load_dwordx4 v17, s[60:63], s22 offen offset:1024 lds
  buffer_load_dwordx4 v18, s[60:63], s22 offen offset:2048 lds
  buffer_load_dwordx4 v19, s[60:63], s22 offen offset:3072 lds
  s_add_u32 m0, s25, 20480
  s_nop 0
  buffer_load_dwordx4 v20, s[60:63], s22 offen offset:0 lds
  buffer_load_dwordx4 v21, s[60:63], s22 offen offset:1024 lds
  buffer_load_dwordx4 v22, s[60:63], s22 offen offset:2048 lds
  buffer_load_dwordx4 v23, s[60:63], s22 offen offset:3072 lds
  v_mov_b32 v250, s68
  s_or_b32 s20, s69, s16
  s_cbranch_scc1 bj_ht
  s_cmp_lg_u32 s16, 0
  s_cbranch_scc1 w0_26
  v_mov_b32 v250, 1
  v_mov_b32 v251, 192
  s_mov_b64 exec, 1
  buffer_atomic_add v250, v251, s[12:15], 0 offen sc0
  s_mov_b64 exec, -1
w0_26:
  s_branch bj_h2
bj_ht:
  buffer_load_dword v251, off, s[8:11], s77
bj_h2:
  v_lshrrev_b32 v7, 2, v4
  v_lshlrev_b32 v7, 3, v7
  v_and_b32 v8, 3, v4
  v_add_u32 v7, v7, v8
  v_xor_b32 v10, v3, v4
  v_lshlrev_b32 v10, 4, v10
  v_lshl_add_u32 v11, v4, 9, v10
  v_add_u32 v11, s25, v11
  v_lshl_add_u32 v10, v7, 9, v10
  v_xor_b32 v32, 0, v10
  v_xor_b32 v36, 0, v11
  v_xor_b32 v33, 64, v10
  v_xor_b32 v37, 64, v11
  v_xor_b32 v34, 128, v10
  v_xor_b32 v38, 128, v11
  v_xor_b32 v35, 192, v10
  v_xor_b32 v39, 192, v11
  s_mul_i32 s30, s17, 401408
  s_mul_i32 s20, s16, 14336
  s_add_u32 s30, s30, s20
  s_lshl_b32 s20, s28, 10
  s_add_u32 s30, s30, s20
  s_mov_b32 s24, 1035512379
  s_lshl_b32 s20, s17, 7
  s_lshl_b32 s28, s28, 3
  s_add_u32 s28, s28, s20
  s_add_u32 s28, s28, 88623104
  s_waitcnt vmcnt(1)
  s_barrier
  ds_read_b128 v[128:131], v32 offset:0
  ds_read_b128 v[132:135], v32 offset:2048
  ds_read_b128 v[136:139], v36 offset:0
  ds_read_b128 v[140:143], v36 offset:8192
  ds_read_b128 v[144:147], v36 offset:16384
  ds_read_b128 v[148:151], v33 offset:0
  ds_read_b128 v[152:155], v33 offset:2048
  ds_read_b128 v[156:159], v37 offset:0
  ds_read_b128 v[160:163], v37 offset:8192
  ds_read_b128 v[164:167], v37 offset:16384
  ds_read_b128 v[168:171], v34 offset:0
  ds_read_b128 v[172:175], v34 offset:2048
  ds_read_b128 v[176:179], v38 offset:0
  ds_read_b128 v[180:183], v38 offset:8192
  ds_read_b128 v[184:187], v38 offset:16384
  s_waitcnt lgkmcnt(10)
  v_mfma_f32_16x16x32_bf16 v[96:99], v[128:131], v[136:139], 0
  v_mfma_f32_16x16x32_bf16 v[100:103], v[132:135], v[136:139], 0
  v_mfma_f32_16x16x32_bf16 v[104:107], v[128:131], v[140:143], 0
  v_mfma_f32_16x16x32_bf16 v[108:111], v[132:135], v[140:143], 0
  v_mfma_f32_16x16x32_bf16 v[112:115], v[128:131], v[144:147], 0
  v_mfma_f32_16x16x32_bf16 v[116:119], v[132:135], v[144:147], 0
  ds_read_b128 v[128:131], v35 offset:0
  ds_read_b128 v[132:135], v35 offset:2048
  ds_read_b128 v[136:139], v39 offset:0
  ds_read_b128 v[140:143], v39 offset:8192
  ds_read_b128 v[144:147], v39 offset:16384
  s_waitcnt lgkmcnt(10)
  v_mfma_f32_16x16x32_bf16 v[96:99], v[148:151], v[156:159], v[96:99]
  v_mfma_f32_16x16x32_bf16 v[100:103], v[152:155], v[156:159], v[100:103]
  v_mfma_f32_16x16x32_bf16 v[104:107], v[148:151], v[160:163], v[104:107]
  v_mfma_f32_16x16x32_bf16 v[108:111], v[152:155], v[160:163], v[108:111]
  v_mfma_f32_16x16x32_bf16 v[112:115], v[148:151], v[164:167], v[112:115]
  v_mfma_f32_16x16x32_bf16 v[116:119], v[152:155], v[164:167], v[116:119]
  ds_read_b128 v[148:151], v32 offset:256
  ds_read_b128 v[152:155], v32 offset:2304
  ds_read_b128 v[156:159], v36 offset:256
  ds_read_b128 v[160:163], v36 offset:8448
  ds_read_b128 v[164:167], v36 offset:16640
  s_waitcnt lgkmcnt(10)
  v_mfma_f32_16x16x32_bf16 v[96:99], v[168:171], v[176:179], v[96:99]
  v_mfma_f32_16x16x32_bf16 v[100:103], v[172:175], v[176:179], v[100:103]
  v_mfma_f32_16x16x32_bf16 v[104:107], v[168:171], v[180:183], v[104:107]
  v_mfma_f32_16x16x32_bf16 v[108:111], v[172:175], v[180:183], v[108:111]
  v_mfma_f32_16x16x32_bf16 v[112:115], v[168:171], v[184:187], v[112:115]
  v_mfma_f32_16x16x32_bf16 v[116:119], v[172:175], v[184:187], v[116:119]
  ds_read_b128 v[168:171], v33 offset:256
  ds_read_b128 v[172:175], v33 offset:2304
  ds_read_b128 v[176:179], v37 offset:256
  ds_read_b128 v[180:183], v37 offset:8448
  ds_read_b128 v[184:187], v37 offset:16640
  s_waitcnt lgkmcnt(10)
  v_mfma_f32_16x16x32_bf16 v[96:99], v[128:131], v[136:139], v[96:99]
  v_mfma_f32_16x16x32_bf16 v[100:103], v[132:135], v[136:139], v[100:103]
  v_mfma_f32_16x16x32_bf16 v[104:107], v[128:131], v[140:143], v[104:107]
  v_mfma_f32_16x16x32_bf16 v[108:111], v[132:135], v[140:143], v[108:111]
  v_mfma_f32_16x16x32_bf16 v[112:115], v[128:131], v[144:147], v[112:115]
  v_mfma_f32_16x16x32_bf16 v[116:119], v[132:135], v[144:147], v[116:119]
  ds_read_b128 v[128:131], v34 offset:256
  ds_read_b128 v[132:135], v34 offset:2304
  ds_read_b128 v[136:139], v38 offset:256
  ds_read_b128 v[140:143], v38 offset:8448
  ds_read_b128 v[144:147], v38 offset:16640
  s_waitcnt lgkmcnt(10)
  v_mfma_f32_16x16x32_bf16 v[96:99], v[148:151], v[156:159], v[96:99]
  v_mfma_f32_16x16x32_bf16 v[100:103], v[152:155], v[156:159], v[100:103]
  v_mfma_f32_16x16x32_bf16 v[104:107], v[148:151], v[160:163], v[104:107]
  v_mfma_f32_16x16x32_bf16 v[108:111], v[152:155], v[160:163], v[108:111]
  v_mfma_f32_16x16x32_bf16 v[112:115], v[148:151], v[164:167], v[112:115]
  v_mfma_f32_16x16x32_bf16 v[116:119], v[152:155], v[164:167], v[116:119]
  ds_read_b128 v[148:151], v35 offset:256
  ds_read_b128 v[152:155], v35 offset:2304
  ds_read_b128 v[156:159], v39 offset:256
  ds_read_b128 v[160:163], v39 offset:8448
  ds_read_b128 v[164:167], v39 offset:16640
  s_waitcnt lgkmcnt(10)
  v_mfma_f32_16x16x32_bf16 v[96:99], v[168:171], v[176:179], v[96:99]
  v_mfma_f32_16x16x32_bf16 v[100:103], v[172:175], v[176:179], v[100:103]
  v_mfma_f32_16x16x32_bf16 v[104:107], v[168:171], v[180:183], v[104:107]
  v_mfma_f32_16x16x32_bf16 v[108:111], v[172:175], v[180:183], v[108:111]
  v_mfma_f32_16x16x32_bf16 v[112:115], v[168:171], v[184:187], v[112:115]
  v_mfma_f32_16x16x32_bf16 v[116:119], v[172:175], v[184:187], v[116:119]
  s_waitcnt lgkmcnt(5)
  v_mfma_f32_16x16x32_bf16 v[96:99], v[128:131], v[136:139], v[96:99]
  v_mfma_f32_16x16x32_bf16 v[100:103], v[132:135], v[136:139], v[100:103]
  v_mfma_f32_16x16x32_bf16 v[104:107], v[128:131], v[140:143], v[104:107]
  v_mfma_f32_16x16x32_bf16 v[108:111], v[132:135], v[140:143], v[108:111]
  v_mfma_f32_16x16x32_bf16 v[112:115], v[128:131], v[144:147], v[112:115]
  v_mfma_f32_16x16x32_bf16 v[116:119], v[132:135], v[144:147], v[116:119]
  s_waitcnt lgkmcnt(0)
  v_mfma_f32_16x16x32_bf16 v[96:99], v[148:151], v[156:159], v[96:99]
  v_mfma_f32_16x16x32_bf16 v[100:103], v[152:155], v[156:159], v[100:103]
  v_mfma_f32_16x16x32_bf16 v[104:107], v[148:151], v[160:163], v[104:107]
  v_mfma_f32_16x16x32_bf16 v[108:111], v[152:155], v[160:163], v[108:111]
  v_mfma_f32_16x16x32_bf16 v[112:115], v[148:151], v[164:167], v[112:115]
  v_mfma_f32_16x16x32_bf16 v[116:119], v[152:155], v[164:167], v[116:119]
  v_mul_f32 v96, s24, v96
  v_mul_f32 v97, s24, v97
  v_mul_f32 v98, s24, v98
  v_mul_f32 v99, s24, v99
  v_mul_f32 v100, s24, v100
  v_mul_f32 v101, s24, v101
  v_mul_f32 v102, s24, v102
  v_mul_f32 v103, s24, v103
  v_cvt_pk_bf16_f32 v68, v96, v97
  v_cvt_pk_bf16_f32 v69, v98, v99
  v_cvt_pk_bf16_f32 v70, v100, v101
  v_cvt_pk_bf16_f32 v71, v102, v103
  s_add_u32 s20, s30, 229376
  buffer_store_dwordx4 v[68:71], v2, s[8:11], s20 offen sc1
  v_mul_f32 v104, s24, v104
  v_mul_f32 v105, s24, v105
  v_mul_f32 v106, s24, v106
  v_mul_f32 v107, s24, v107
  v_mul_f32 v108, s24, v108
  v_mul_f32 v109, s24, v109
  v_mul_f32 v110, s24, v110
  v_mul_f32 v111, s24, v111
  v_cvt_pk_bf16_f32 v72, v104, v105
  v_cvt_pk_bf16_f32 v73, v106, v107
  v_cvt_pk_bf16_f32 v74, v108, v109
  v_cvt_pk_bf16_f32 v75, v110, v111
  s_add_u32 s20, s30, 286720
  buffer_store_dwordx4 v[72:75], v2, s[8:11], s20 offen sc1
  v_mul_f32 v112, s24, v112
  v_mul_f32 v113, s24, v113
  v_mul_f32 v114, s24, v114
  v_mul_f32 v115, s24, v115
  v_mul_f32 v116, s24, v116
  v_mul_f32 v117, s24, v117
  v_mul_f32 v118, s24, v118
  v_mul_f32 v119, s24, v119
  v_cvt_pk_bf16_f32 v76, v112, v113
  v_cvt_pk_bf16_f32 v77, v114, v115
  v_cvt_pk_bf16_f32 v78, v116, v117
  v_cvt_pk_bf16_f32 v79, v118, v119
  s_add_u32 s20, s30, 344064
  buffer_store_dwordx4 v[76:79], v2, s[8:11], s20 offen sc1
  s_waitcnt vmcnt(0)
  s_barrier
  s_cmp_lg_u32 s16, 0
  s_cbranch_scc1 pub_27
  v_mul_u32_u24 v26, 2048, v1
  v_mov_b32 v24, s88
  v_mov_b32 v25, s89
  s_mov_b64 exec, 1
  buffer_store_dwordx2 v[24:25], v26, s[8:11], s28 offen sc1
  s_mov_b64 exec, -1
pub_27:
  v_mov_b32 v6, 160000
  s_add_u32 s101, s101, 1
  s_barrier
  s_mov_b64 exec, 1
  s_cmp_lg_u32 s16, 0
  s_cbranch_scc1 w0_28
  ds_write_b32 v6, v250 offset:0
  s_waitcnt lgkmcnt(0)
  v_mov_b32 v250, s101
  ds_write_b32 v6, v250 offset:16
  s_waitcnt lgkmcnt(0)
w0_28:
  s_mov_b64 exec, -1
  s_barrier
  ds_read_b32 v250, v6 offset:0
  ds_read_b32 v6, v6 offset:16
  s_waitcnt lgkmcnt(0)
  v_readfirstlane_b32 s3, v250
  v_cmp_ne_u32 vcc, s101, v6
  s_cbranch_vccnz ch_end
  s_branch wk_have
wk_loop:
  s_waitcnt vmcnt(0) lgkmcnt(0)
  s_cmp_eq_u32 s96, 1
  s_cbranch_scc1 wk_ask
  s_mov_b32 s96, 1
  s_cmp_lg_u32 s16, 0
  s_cbranch_scc1 w0_29
  s_mov_b32 s30, 0
  v_mov_b32 v243, 32
sf_l:
  buffer_load_dword v242, v243, s[12:15], 0 offen sc1
  s_waitcnt vmcnt(0)
  v_readfirstlane_b32 s70, v242
  s_cmp_eq_u32 s70, -1
  s_cbranch_scc1 sf_d
  s_sleep 16
  s_add_u32 s30, s30, 1
  s_cmp_lt_u32 s30, 64
  s_cbranch_scc1 sf_l
  s_mov_b32 s20, 0
  s_mov_b32 s21, 0
  s_mov_b64 exec, 1
sf_c_l:
  s_cmp_lg_u32 s70, -1
  s_cbranch_scc1 sf_c_t
  s_add_u32 s20, s20, 1
  s_cmp_lt_u32 s20, 8
  s_cselect_b32 s20, s20, 0
  s_mov_b32 s70, 0
  s_mov_b32 s3, -1
  s_add_u32 s21, s21, 1
  s_cmp_ge_u32 s21, 1
  s_cbranch_scc1 sf_c_d
sf_c_t:
  s_ff0_i32_b32 s22, s70
  s_lshl_b32 s23, 1, s22
  s_and_b32 s71, s20, 4
  s_mul_i32 s71, s71, 12
  s_lshl_b32 s3, s20, 2
  s_add_u32 s3, s3, s71
  v_mov_b32 v242, s23
  v_mov_b32 v243, 32
  buffer_atomic_or v242, v243, s[12:15], s3 offen sc0
  s_waitcnt vmcnt(0)
  v_readfirstlane_b32 s70, v242
  s_lshl_b32 s3, s20, 5
  s_add_u32 s3, s3, s22
  s_bitcmp1_b32 s70, s22
  s_cbranch_scc1 sf_c_l
sf_c_d:
  s_mov_b64 exec, -1
  v_mov_b32 v242, s3
sf_d:
w0_29:
  v_mov_b32 v243, 160000
  s_add_u32 s101, s101, 1
  s_barrier
  s_mov_b64 exec, 1
  s_cmp_lg_u32 s16, 0
  s_cbranch_scc1 w0_30
  ds_write_b32 v243, v242 offset:0
  s_waitcnt lgkmcnt(0)
  v_mov_b32 v242, s101
  ds_write_b32 v243, v242 offset:16
  s_waitcnt lgkmcnt(0)
w0_30:
  s_mov_b64 exec, -1
  s_barrier
  ds_read_b32 v242, v243 offset:0
  ds_read_b32 v243, v243 offset:16
  s_waitcnt lgkmcnt(0)
  v_readfirstlane_b32 s3, v242
  v_cmp_ne_u32 vcc, s101, v243
  s_cbranch_vccnz ch_end
  s_cmp_eq_u32 s3, -1
  s_cbranch_scc1 wk_ask
  s_load_dwordx8 s[36:43], s[0:1], 56
  s_load_dwordx4 s[44:47], s[0:1], 88
  s_getreg_b32 s67, hwreg(HW_REG_XCC_ID)
  s_and_b32 s67, s67, 7
  s_mov_b32 s66, 1
  s_waitcnt lgkmcnt(0)
  s_branch m_start
wk_ask:
  v_readfirstlane_b32 s22, v250
  s_cmp_ge_u32 s22, 1376
  s_cbranch_scc1 wk_next
  s_cmp_lg_u32 s16, 0
  s_cbranch_scc1 w0_31
  v_mov_b32 v250, 1
  v_mov_b32 v251, 192
  s_mov_b64 exec, 1
  buffer_atomic_add v250, v251, s[12:15], 0 offen sc0
  s_mov_b64 exec, -1
w0_31:
wk_next:
  s_waitcnt vmcnt(0)
  v_mov_b32 v6, 160000
  s_add_u32 s101, s101, 1
  s_barrier
  s_mov_b64 exec, 1
  s_cmp_lg_u32 s16, 0
  s_cbranch_scc1 w0_32
  ds_write_b32 v6, v250 offset:0
  s_waitcnt lgkmcnt(0)
  v_mov_b32 v250, s101
  ds_write_b32 v6, v250 offset:16
  s_waitcnt lgkmcnt(0)
w0_32:
  s_mov_b64 exec, -1
  s_barrier
  ds_read_b32 v250, v6 offset:0
  ds_read_b32 v6, v6 offset:16
  s_waitcnt lgkmcnt(0)
  v_readfirstlane_b32 s3, v250
  v_cmp_ne_u32 vcc, s101, v6
  s_cbranch_vccnz ch_end
wk_have:
  s_cmp_ge_u32 s3, 1376
  s_cbranch_scc1 ch_end
  v_mov_b32 v250, 0
  v_mov_b32 v251, 192
  v_and_b32 v1, 63, v0
  v_lshlrev_b32 v2, 4, v1
  v_lshrrev_b32 v3, 4, v1
  v_and_b32 v4, 15, v1
  s_cmp_lg_u32 s97, 0
  s_cbranch_scc1 wk_go
  s_mov_b32 s68, s3
  s_mov_b32 s69, 1
  s_cmp_lg_u32 s16, 0
  s_cbranch_scc1 w0_33
  s_add_u32 s20, s67, 1
  s_lshl_b32 s22, s20, 11
  s_add_u32 s22, s22, 88590336
  v_add_u32 v24, 1024, v2
  v_min_u32 v24, 1776, v24
  s_mov_b32 s30, 0
wk_af:
  buffer_load_dwordx4 v[28:31], v2, s[8:11], s22 offen sc1
  buffer_load_dwordx4 v[32:35], v24, s[8:11], s22 offen sc1
  s_waitcnt vmcnt(0)
  v_cmp_ne_u64 vcc, s[88:89], v[28:29]
  s_cbranch_vccnz wk_af_no
  v_cmp_ne_u64 vcc, s[88:89], v[30:31]
  s_cbranch_vccnz wk_af_no
  v_cmp_ne_u64 vcc, s[88:89], v[32:33]
  s_cbranch_vccnz wk_af_no
  v_cmp_ne_u64 vcc, s[88:89], v[34:35]
  s_cbranch_vccnz wk_af_no
  s_branch wk_af_ok
wk_af_no:
  s_sleep 4
  s_add_u32 s30, s30, 1
  s_and_b32 s20, s30, 63
  s_cbranch_scc1 wk_ns
  s_mov_b32 s20, 1
  s_mov_b32 s70, 0
  s_mov_b32 s21, 0
  s_mov_b64 exec, 1
wk_st_l:
  s_cmp_lg_u32 s70, -1
  s_cbranch_scc1 wk_st_t
  s_add_u32 s20, s20, 1
  s_cmp_lt_u32 s20, 8
  s_cselect_b32 s20, s20, 1
  s_mov_b32 s70, 0
  s_mov_b32 s3, -1
  s_add_u32 s21, s21, 1
  s_cmp_ge_u32 s21, 7
  s_cbranch_scc1 wk_st_d
wk_st_t:
  s_ff0_i32_b32 s22, s70
  s_lshl_b32 s23, 1, s22
  s_and_b32 s71, s20, 4
  s_mul_i32 s71, s71, 12
  s_lshl_b32 s3, s20, 2
  s_add_u32 s3, s3, s71
  v_mov_b32 v242, s23
  v_mov_b32 v243, 32
  buffer_atomic_or v242, v243, s[12:15], s3 offen sc0
  s_waitcnt vmcnt(0)
  v_readfirstlane_b32 s70, v242
  s_lshl_b32 s3, s20, 5
  s_add_u32 s3, s3, s22
  s_bitcmp1_b32 s70, s22
  s_cbranch_scc1 wk_st_l
wk_st_d:
  s_mov_b64 exec, -1
  v_mov_b32 v242, s3
  s_cmp_lg_u32 s3, -1
  s_cbranch_scc1 wk_pd
  s_add_u32 s20, s67, 1
  s_lshl_b32 s22, s20, 11
  s_add_u32 s22, s22, 88590336
wk_ns:
  s_cmp_lt_u32 s30, 50000
  s_cbranch_scc1 wk_af
  s_branch cA_abort
wk_af_ok:
  v_mov_b32 v242, -1
wk_pd:
w0_33:
  v_mov_b32 v243, 160000
  s_add_u32 s101, s101, 1
  s_barrier
  s_mov_b64 exec, 1
  s_cmp_lg_u32 s16, 0
  s_cbranch_scc1 w0_34
  ds_write_b32 v243, v242 offset:0
  s_waitcnt lgkmcnt(0)
  v_mov_b32 v242, s101
  ds_write_b32 v243, v242 offset:16
  s_waitcnt lgkmcnt(0)
w0_34:
  s_mov_b64 exec, -1
  s_barrier
  ds_read_b32 v242, v243 offset:0
  ds_read_b32 v243, v243 offset:16
  s_waitcnt lgkmcnt(0)
  v_readfirstlane_b32 s3, v242
  v_cmp_ne_u32 vcc, s101, v243
  s_cbranch_vccnz ch_end
  s_cmp_lg_u32 s3, -1
  s_cbranch_scc1 m_bjob
  s_mov_b32 s3, s68
  s_mov_b32 s97, 1
wk_go:
  s_cmp_ge_u32 s3, 864
  s_cbranch_scc1 wk_tok
  s_cmp_ge_u32 s3, 752
  s_cbranch_scc1 wk_s4d
  s_cmp_ge_u32 s3, 624
  s_cbranch_scc1 wk_f
  s_cmp_ge_u32 s3, 560
  s_cbranch_scc1 wk_vf
  s_cmp_ge_u32 s3, 496
  s_cbranch_scc1 wk_vh
  s_cmp_ge_u32 s3, 368
  s_cbranch_scc1 wk_a
  s_cmp_ge_u32 s3, 336
  s_cbranch_scc1 wk_srv
  s_cmp_ge_u32 s3, 224
  s_cbranch_scc1 wk_v7
  s_sub_u32 s20, s3, 0
  s_cmp_ge_u32 s20, 112
  s_cselect_b32 s18, 1, 0
  s_cselect_b32 s21, 112, 0
  s_sub_u32 s20, s20, s21
  s_and_b32 s17, s20, 15
  s_add_u32 s17, s17, 16
  s_lshr_b32 s34, s20, 4
  s_lshl_b32 s34, s34, 1
  s_add_u32 s35, s34, 2
  s_cmp_eq_u32 s18, 0
  s_cbranch_scc1 wf_nw
  s_and_b32 s20, s3, 3
  s_lshl_b32 s20, s20, 3
  s_add_u32 s20, s20, 8
  s_cmp_eq_u32 s16, 0
  s_cselect_b32 s20, 0, s20
  s_cmp_ge_u32 s16, 2
  s_cselect_b32 s20, 112, s20
  s_load_dwordx2 s[72:73], s[0:1], s20
  s_lshr_b32 s21, s3, 2
  s_lshl_b32 s21, s21, 12
  s_mov_b32 s74, 229376
  s_lshl_b32 s22, s3, 13
  s_cmp_eq_u32 s16, 0
  s_cselect_b32 s21, s22, s21
  s_cselect_b32 s74, 1835008, s74
  s_lshl_b32 s22, s3, 1
  s_add_u32 s22, s22, s16
  s_sub_u32 s22, s22, 2
  s_lshl_b32 s22, s22, 13
  s_cmp_ge_u32 s16, 2
  s_cselect_b32 s21, s22, s21
  s_cselect_b32 s74, 3670016, s74
  v_lshlrev_b32 v6, 3, v2
  s_cmp_eq_u32 s16, 1
  s_cselect_b32 exec_hi, 0, -1
  s_waitcnt lgkmcnt(0)
  s_and_b32 s73, s73, 0xffff
  s_mov_b32 s75, 0x20000
  buffer_load_dword v7, v6, s[72:75], s21 offen
  s_mov_b64 exec, -1
  s_sub_u32 s3, s3, 112
  s_and_b32 s20, s3, 3
  s_lshl_b32 s20, s20, 3
  s_add_u32 s20, s20, 8
  s_cmp_eq_u32 s16, 0
  s_cselect_b32 s20, 0, s20
  s_cmp_ge_u32 s16, 2
  s_cselect_b32 s20, 112, s20
  s_load_dwordx2 s[72:73], s[0:1], s20
  s_lshr_b32 s21, s3, 2
  s_lshl_b32 s21, s21, 12
  s_mov_b32 s74, 229376
  s_lshl_b32 s22, s3, 13
  s_cmp_eq_u32 s16, 0
  s_cselect_b32 s21, s22, s21
  s_cselect_b32 s74, 1835008, s74
  s_lshl_b32 s22, s3, 1
  s_add_u32 s22, s22, s16
  s_sub_u32 s22, s22, 2
  s_lshl_b32 s22, s22, 13
  s_cmp_ge_u32 s16, 2
  s_cselect_b32 s21, s22, s21
  s_cselect_b32 s74, 3670016, s74
  v_lshlrev_b32 v6, 3, v2
  s_cmp_eq_u32 s16, 1
  s_cselect_b32 exec_hi, 0, -1
  s_waitcnt lgkmcnt(0)
  s_and_b32 s73, s73, 0xffff
  s_mov_b32 s75, 0x20000
  buffer_load_dword v7, v6, s[72:75], s21 offen
  s_mov_b64 exec, -1
wf_nw:
  s_lshl_b32 s20, s18, 3
  s_lshl_b32 s21, s16, 1
  s_add_u32 s20, s20, s21
  s_mul_i32 s21, s20, 14336
  s_add_u32 s21, s21, 71565312
  s_add_u32 s22, s21, 0
  buffer_load_dwordx4 a[0:3], v2, s[8:11], s22 offen offset:0 sc1
  buffer_load_dwordx4 a[4:7], v2, s[8:11], s22 offen offset:1024 sc1
  buffer_load_dwordx4 a[8:11], v2, s[8:11], s22 offen offset:2048 sc1
  buffer_load_dwordx4 a[12:15], v2, s[8:11], s22 offen offset:3072 sc1
  s_add_u32 s22, s21, 4096
  buffer_load_dwordx4 a[16:19], v2, s[8:11], s22 offen offset:0 sc1
  buffer_load_dwordx4 a[20:23], v2, s[8:11], s22 offen offset:1024 sc1
  buffer_load_dwordx4 a[24:27], v2, s[8:11], s22 offen offset:2048 sc1
  buffer_load_dwordx4 a[28:31], v2, s[8:11], s22 offen offset:3072 sc1
  s_add_u32 s22, s21, 8192
  buffer_load_dwordx4 a[32:35], v2, s[8:11], s22 offen offset:0 sc1
  buffer_load_dwordx4 a[36:39], v2, s[8:11], s22 offen offset:1024 sc1
  buffer_load_dwordx4 a[40:43], v2, s[8:11], s22 offen offset:2048 sc1
  buffer_load_dwordx4 a[44:47], v2, s[8:11], s22 offen offset:3072 sc1
  s_add_u32 s22, s21, 12288
  buffer_load_dwordx4 a[48:51], v2, s[8:11], s22 offen offset:0 sc1
  buffer_load_dwordx4 a[52:55], v2, s[8:11], s22 offen offset:1024 sc1
  buffer_load_dwordx4 a[56:59], v2, s[8:11], s22 offen offset:2048 sc1
  buffer_load_dwordx4 a[60:63], v2, s[8:11], s22 offen offset:3072 sc1
  s_add_u32 s22, s21, 16384
  buffer_load_dwordx4 a[64:67], v2, s[8:11], s22 offen offset:0 sc1
  buffer_load_dwordx4 a[68:71], v2, s[8:11], s22 offen offset:1024 sc1
  buffer_load_dwordx4 a[72:75], v2, s[8:11], s22 offen offset:2048 sc1
  buffer_load_dwordx4 a[76:79], v2, s[8:11], s22 offen offset:3072 sc1
  s_add_u32 s22, s21, 20480
  buffer_load_dwordx4 a[80:83], v2, s[8:11], s22 offen offset:0 sc1
  buffer_load_dwordx4 a[84:87], v2, s[8:11], s22 offen offset:1024 sc1
  buffer_load_dwordx4 a[88:91], v2, s[8:11], s22 offen offset:2048 sc1
  buffer_load_dwordx4 a[92:95], v2, s[8:11], s22 offen offset:3072 sc1
  s_add_u32 s22, s21, 24576
  buffer_load_dwordx4 a[96:99], v2, s[8:11], s22 offen offset:0 sc1
  buffer_load_dwordx4 a[100:103], v2, s[8:11], s22 offen offset:1024 sc1
  buffer_load_dwordx4 a[104:107], v2, s[8:11], s22 offen offset:2048 sc1
  buffer_load_dwordx4 a[108:111], v2, s[8:11], s22 offen offset:3072 sc1
  s_waitcnt vmcnt(40)
  s_mul_i32 s23, s17, 401408
  s_and_b32 s22, s16, 1
  s_mul_i32 s22, s22, 7168
  s_add_u32 s23, s23, s22
  s_add_u32 s23, s23, 0
  s_lshr_b32 s22, s16, 1
  s_mul_i32 s22, s22, 14336
  s_add_u32 s23, s23, s22
  s_mul_i32 s27, s16, 7168
  s_lshr_b32 s28, s20, 1
wf_vo:
  s_sub_u32 s29, s17, 16
  s_lshl_b32 s29, s29, 6
  s_add_u32 s29, s29, s28
  s_mul_i32 s29, s29, 28672
  s_add_u32 s29, s29, 42205184
  v_mul_u32_u24 v6, 28, v3
  s_mov_b32 s31, 0
  s_lshl_b32 s24, s34, 1
  s_mul_i32 s24, s24, 14336
  s_add_u32 s24, s24, s23
  s_cmp_lt_u32 s34, s35
  s_cselect_b32 s24, s24, 0x10000000
  s_add_u32 m0, s31, s27
  s_nop 0
  buffer_load_dwordx4 v2, s[8:11], s24 offen offset:0 sc1 lds
  buffer_load_dwordx4 v2, s[8:11], s24 offen offset:1024 sc1 lds
  buffer_load_dwordx4 v2, s[8:11], s24 offen offset:2048 sc1 lds
  buffer_load_dwordx4 v2, s[8:11], s24 offen offset:3072 sc1 lds
  s_add_u32 m0, m0, 4096
  s_add_u32 s24, s24, 4096
  buffer_load_dwordx4 v2, s[8:11], s24 offen offset:0 sc1 lds
  buffer_load_dwordx4 v2, s[8:11], s24 offen offset:1024 sc1 lds
  buffer_load_dwordx4 v2, s[8:11], s24 offen offset:2048 sc1 lds
  s_add_u32 s30, s34, 1
  s_mov_b32 s31, 28672
  s_lshl_b32 s24, s30, 1
  s_mul_i32 s24, s24, 14336
  s_add_u32 s24, s24, s23
  s_cmp_lt_u32 s30, s35
  s_cselect_b32 s24, s24, 0x10000000
  s_add_u32 m0, s31, s27
  s_nop 0
  buffer_load_dwordx4 v2, s[8:11], s24 offen offset:0 sc1 lds
  buffer_load_dwordx4 v2, s[8:11], s24 offen offset:1024 sc1 lds
  buffer_load_dwordx4 v2, s[8:11], s24 offen offset:2048 sc1 lds
  buffer_load_dwordx4 v2, s[8:11], s24 offen offset:3072 sc1 lds
  s_add_u32 m0, m0, 4096
  s_add_u32 s24, s24, 4096
  buffer_load_dwordx4 v2, s[8:11], s24 offen offset:0 sc1 lds
  buffer_load_dwordx4 v2, s[8:11], s24 offen offset:1024 sc1 lds
  buffer_load_dwordx4 v2, s[8:11], s24 offen offset:2048 sc1 lds
  s_mov_b32 s19, s34
  s_mov_b32 s32, 0
  s_mov_b32 s33, 57344
  s_waitcnt vmcnt(7)
  s_branch wf_vo_in
wf_vo_loop:
  s_waitcnt vmcnt(9)
wf_vo_in:
  s_barrier
  s_add_u32 s30, s19, 2
  s_lshl_b32 s24, s30, 1
  s_mul_i32 s24, s24, 14336
  s_add_u32 s24, s24, s23
  s_cmp_lt_u32 s30, s35
  s_cselect_b32 s24, s24, 0x10000000
  s_add_u32 m0, s33, s27
  s_nop 0
  buffer_load_dwordx4 v2, s[8:11], s24 offen offset:0 sc1 lds
  buffer_load_dwordx4 v2, s[8:11], s24 offen offset:1024 sc1 lds
  buffer_load_dwordx4 v2, s[8:11], s24 offen offset:2048 sc1 lds
  buffer_load_dwordx4 v2, s[8:11], s24 offen offset:3072 sc1 lds
  s_add_u32 m0, m0, 4096
  s_add_u32 s24, s24, 4096
  buffer_load_dwordx4 v2, s[8:11], s24 offen offset:0 sc1 lds
  buffer_load_dwordx4 v2, s[8:11], s24 offen offset:1024 sc1 lds
  buffer_load_dwordx4 v2, s[8:11], s24 offen offset:2048 sc1 lds
  v_add_u32 v5, s32, v2
  ds_read_b128 v[8:11], v5 offset:0
  ds_read_b128 v[12:15], v5 offset:14336
  ds_read_b128 v[16:19], v5 offset:1024
  ds_read_b128 v[20:23], v5 offset:15360
  ds_read_b128 v[24:27], v5 offset:2048
  ds_read_b128 v[28:31], v5 offset:16384
  ds_read_b128 v[32:35], v5 offset:3072
  s_waitcnt lgkmcnt(6)
  v_mfma_f32_16x16x32_bf16 v[40:43], a[0:3], v[8:11], 0
  v_mfma_f32_16x16x32_bf16 v[44:47], a[56:59], v[8:11], 0
  ds_read_b128 v[36:39], v5 offset:17408
  s_waitcnt lgkmcnt(6)
  v_mfma_f32_16x16x32_bf16 v[56:59], a[0:3], v[12:15], 0
  v_mfma_f32_16x16x32_bf16 v[60:63], a[56:59], v[12:15], 0
  ds_read_b128 v[8:11], v5 offset:4096
  s_waitcnt lgkmcnt(6)
  v_mfma_f32_16x16x32_bf16 v[40:43], a[4:7], v[16:19], v[40:43]
  v_mfma_f32_16x16x32_bf16 v[44:47], a[60:63], v[16:19], v[44:47]
  ds_read_b128 v[12:15], v5 offset:18432
  s_waitcnt lgkmcnt(6)
  v_mfma_f32_16x16x32_bf16 v[56:59], a[4:7], v[20:23], v[56:59]
  v_mfma_f32_16x16x32_bf16 v[60:63], a[60:63], v[20:23], v[60:63]
  ds_read_b128 v[16:19], v5 offset:5120
  s_waitcnt lgkmcnt(6)
  v_mfma_f32_16x16x32_bf16 v[40:43], a[8:11], v[24:27], v[40:43]
  v_mfma_f32_16x16x32_bf16 v[44:47], a[64:67], v[24:27], v[44:47]
  ds_read_b128 v[20:23], v5 offset:19456
  s_waitcnt lgkmcnt(6)
  v_mfma_f32_16x16x32_bf16 v[56:59], a[8:11], v[28:31], v[56:59]
  v_mfma_f32_16x16x32_bf16 v[60:63], a[64:67], v[28:31], v[60:63]
  ds_read_b128 v[24:27], v5 offset:6144
  s_waitcnt lgkmcnt(6)
  v_mfma_f32_16x16x32_bf16 v[40:43], a[12:15], v[32:35], v[40:43]
  v_mfma_f32_16x16x32_bf16 v[44:47], a[68:71], v[32:35], v[44:47]
  ds_read_b128 v[28:31], v5 offset:20480
  s_waitcnt lgkmcnt(6)
  v_mfma_f32_16x16x32_bf16 v[56:59], a[12:15], v[36:39], v[56:59]
  v_mfma_f32_16x16x32_bf16 v[60:63], a[68:71], v[36:39], v[60:63]
  ds_read_b128 v[32:35], v5 offset:7168
  s_waitcnt lgkmcnt(6)
  v_mfma_f32_16x16x32_bf16 v[40:43], a[16:19], v[8:11], v[40:43]
  v_mfma_f32_16x16x32_bf16 v[44:47], a[72:75], v[8:11], v[44:47]
  ds_read_b128 v[36:39], v5 offset:21504
  s_waitcnt lgkmcnt(6)
  v_mfma_f32_16x16x32_bf16 v[56:59], a[16:19], v[12:15], v[56:59]
  v_mfma_f32_16x16x32_bf16 v[60:63], a[72:75], v[12:15], v[60:63]
  ds_read_b128 v[8:11], v5 offset:8192
  s_waitcnt lgkmcnt(6)
  v_mfma_f32_16x16x32_bf16 v[40:43], a[20:23], v[16:19], v[40:43]
  v_mfma_f32_16x16x32_bf16 v[44:47], a[76:79], v[16:19], v[44:47]
  ds_read_b128 v[12:15], v5 offset:22528
  s_waitcnt lgkmcnt(6)
  v_mfma_f32_16x16x32_bf16 v[56:59], a[20:23], v[20:23], v[56:59]
  v_mfma_f32_16x16x32_bf16 v[60:63], a[76:79], v[20:23], v[60:63]
  ds_read_b128 v[16:19], v5 offset:9216
  s_waitcnt lgkmcnt(6)
  v_mfma_f32_16x16x32_bf16 v[40:43], a[24:27], v[24:27], v[40:43]
  v_mfma_f32_16x16x32_bf16 v[44:47], a[80:83], v[24:27], v[44:47]
  ds_read_b128 v[20:23], v5 offset:23552
  s_waitcnt lgkmcnt(6)
  v_mfma_f32_16x16x32_bf16 v[56:59], a[24:27], v[28:31], v[56:59]
  v_mfma_f32_16x16x32_bf16 v[60:63], a[80:83], v[28:31], v[60:63]
  ds_read_b128 v[24:27], v5 offset:10240
  s_waitcnt lgkmcnt(6)
  v_mfma_f32_16x16x32_bf16 v[40:43], a[28:31], v[32:35], v[40:43]
  v_mfma_f32_16x16x32_bf16 v[44:47], a[84:87], v[32:35], v[44:47]
  ds_read_b128 v[28:31], v5 offset:24576
  s_waitcnt lgkmcnt(6)
  v_mfma_f32_16x16x32_bf16 v[56:59], a[28:31], v[36:39], v[56:59]
  v_mfma_f32_16x16x32_bf16 v[60:63], a[84:87], v[36:39], v[60:63]
  ds_read_b128 v[32:35], v5 offset:11264
  s_waitcnt lgkmcnt(6)
  v_mfma_f32_16x16x32_bf16 v[40:43], a[32:35], v[8:11], v[40:43]
  v_mfma_f32_16x16x32_bf16 v[44:47], a[88:91], v[8:11], v[44:47]
  ds_read_b128 v[36:39], v5 offset:25600
  s_waitcnt lgkmcnt(6)
  v_mfma_f32_16x16x32_bf16 v[56:59], a[32:35], v[12:15], v[56:59]
  v_mfma_f32_16x16x32_bf16 v[60:63], a[88:91], v[12:15], v[60:63]
  ds_read_b128 v[8:11], v5 offset:12288
  s_waitcnt lgkmcnt(6)
  v_mfma_f32_16x16x32_bf16 v[40:43], a[36:39], v[16:19], v[40:43]
  v_mfma_f32_16x16x32_bf16 v[44:47], a[92:95], v[16:19], v[44:47]
  ds_read_b128 v[12:15], v5 offset:26624
  s_waitcnt lgkmcnt(6)
  v_mfma_f32_16x16x32_bf16 v[56:59], a[36:39], v[20:23], v[56:59]
  v_mfma_f32_16x16x32_bf16 v[60:63], a[92:95], v[20:23], v[60:63]
  ds_read_b128 v[16:19], v5 offset:13312
  s_waitcnt lgkmcnt(6)
  v_mfma_f32_16x16x32_bf16 v[40:43], a[40:43], v[24:27], v[40:43]
  v_mfma_f32_16x16x32_bf16 v[44:47], a[96:99], v[24:27], v[44:47]
  ds_read_b128 v[20:23], v5 offset:27648
  s_waitcnt lgkmcnt(6)
  v_mfma_f32_16x16x32_bf16 v[56:59], a[40:43], v[28:31], v[56:59]
  v_mfma_f32_16x16x32_bf16 v[60:63], a[96:99], v[28:31], v[60:63]
  s_waitcnt lgkmcnt(5)
  v_mfma_f32_16x16x32_bf16 v[40:43], a[44:47], v[32:35], v[40:43]
  v_mfma_f32_16x16x32_bf16 v[44:47], a[100:103], v[32:35], v[44:47]
  s_waitcnt lgkmcnt(4)
  v_mfma_f32_16x16x32_bf16 v[56:59], a[44:47], v[36:39], v[56:59]
  v_mfma_f32_16x16x32_bf16 v[60:63], a[100:103], v[36:39], v[60:63]
  s_waitcnt lgkmcnt(3)
  v_mfma_f32_16x16x32_bf16 v[40:43], a[48:51], v[8:11], v[40:43]
  v_mfma_f32_16x16x32_bf16 v[44:47], a[104:107], v[8:11], v[44:47]
  s_waitcnt lgkmcnt(2)
  v_mfma_f32_16x16x32_bf16 v[56:59], a[48:51], v[12:15], v[56:59]
  v_mfma_f32_16x16x32_bf16 v[60:63], a[104:107], v[12:15], v[60:63]
  s_waitcnt lgkmcnt(1)
  v_mfma_f32_16x16x32_bf16 v[40:43], a[52:55], v[16:19], v[40:43]
  v_mfma_f32_16x16x32_bf16 v[44:47], a[108:111], v[16:19], v[44:47]
  s_waitcnt lgkmcnt(0)
  v_mfma_f32_16x16x32_bf16 v[56:59], a[52:55], v[20:23], v[56:59]
  v_mfma_f32_16x16x32_bf16 v[60:63], a[108:111], v[20:23], v[60:63]
  s_add_u32 s25, s29, 28672
  s_lshl_b32 s24, s19, 5
  s_add_u32 s24, s24, 0
  v_add_u32 v88, s24, v4
  v_mul_u32_u24 v89, 2341, v88
  v_lshrrev_b32 v89, 16, v89
  v_mul_u32_u24 v89, 84, v89
  v_add3_u32 v88, v88, v89, v6
  v_lshlrev_b32 v90, 4, v88
  v_cvt_pk_bf16_f32 v72, v40, v41
  v_cvt_pk_bf16_f32 v73, v42, v43
  v_cvt_pk_bf16_f32 v74, v44, v45
  v_cvt_pk_bf16_f32 v75, v46, v47
  buffer_store_dwordx4 v[72:75], v90, s[8:11], s29 offen sc1
  s_lshl_b32 s24, s19, 5
  s_add_u32 s24, s24, 16
  v_add_u32 v88, s24, v4
  v_mul_u32_u24 v89, 2341, v88
  v_lshrrev_b32 v89, 16, v89
  v_mul_u32_u24 v89, 84, v89
  v_add3_u32 v88, v88, v89, v6
  v_lshlrev_b32 v91, 4, v88
  v_cvt_pk_bf16_f32 v80, v56, v57
  v_cvt_pk_bf16_f32 v81, v58, v59
  v_cvt_pk_bf16_f32 v82, v60, v61
  v_cvt_pk_bf16_f32 v83, v62, v63
  buffer_store_dwordx4 v[80:83], v91, s[8:11], s29 offen sc1
  s_mov_b32 s33, s32
  s_add_u32 s32, s32, 28672
  s_cmp_eq_u32 s32, 86016
  s_cselect_b32 s32, 0, s32
  s_add_u32 s19, s19, 1
  s_cmp_lt_u32 s19, s35
  s_cbranch_scc1 wf_vo_loop
  s_branch wf_done
wf_done:
  s_lshr_b32 s20, s18, 1
  s_lshl_b32 s20, s20, 4
  s_and_b32 s21, s17, 15
  s_add_u32 s20, s20, s21
  s_lshl_b32 s20, s20, 7
  s_cmp_lt_u32 s17, 16
  s_cselect_b32 s21, 16384, 0
  s_add_u32 s20, s20, s21
  s_add_u32 s20, s20, 88528896
  s_sub_u32 s21, s35, s34
  s_lshr_b32 s21, s21, 1
  v_mov_b32 v5, s21
  v_mov_b32 v6, 0
  s_waitcnt vmcnt(0)
  s_mov_b64 exec, 1
  s_cmp_lg_u32 s18, 0
  s_cbranch_scc1 wf_h1
  v_mov_b32 v7, 2
  s_sub_u32 s21, s20, 2048
  buffer_atomic_add v7, v6, s[8:11], s21 offen
wf_h1:
  buffer_atomic_add v5, v6, s[8:11], s20 offen
  s_mov_b64 exec, -1
  s_branch wk_loop
wk_v7:
  s_sub_u32 s20, s3, 224
  s_mov_b32 s18, 1
  s_and_b32 s17, s20, 15
  s_add_u32 s17, s17, 16
  s_lshr_b32 s34, s20, 4
  s_lshl_b32 s34, s34, 1
  s_add_u32 s35, s34, 2
  s_branch wk_gemm
wk_vh:
  s_sub_u32 s20, s3, 496
  s_and_b32 s17, s20, 15
  s_add_u32 s17, s17, 16
  s_lshr_b32 s18, s20, 5
  s_add_u32 s18, s18, 2
  s_bitcmp1_b32 s20, 4
  s_cselect_b32 s34, 7, 0
  s_add_u32 s35, s34, 7
  s_branch wk_gemm
wk_vf:
  s_sub_u32 s20, s3, 560
  s_and_b32 s17, s20, 15
  s_add_u32 s17, s17, 16
  s_lshr_b32 s18, s20, 4
  s_add_u32 s18, s18, 4
  s_mov_b32 s34, 0
  s_mov_b32 s35, 14
  s_branch wk_gemm
wk_f:
  s_sub_u32 s20, s3, 624
  s_and_b32 s17, s20, 15
  s_lshr_b32 s18, s20, 4
  s_mov_b32 s34, 0
  s_mov_b32 s35, 14
  s_lshl_b32 s22, s17, 7
  s_add_u32 s22, s22, 88621056
  s_add_u32 s23, s22, 2048
  v_min_u32 v24, 48, v2
  v_min_u32 v25, 96, v2
  s_mov_b32 s30, 0
wk_aw:
  buffer_load_dwordx4 v[28:31], v24, s[8:11], s22 offen sc1
  buffer_load_dwordx4 v[32:35], v25, s[8:11], s23 offen sc1
  s_waitcnt vmcnt(0)
  v_cmp_ne_u64 vcc, s[88:89], v[28:29]
  s_cbranch_vccnz wk_aw_no
  v_cmp_ne_u64 vcc, s[88:89], v[30:31]
  s_cbranch_vccnz wk_aw_no
  v_cmp_ne_u64 vcc, s[88:89], v[32:33]
  s_cbranch_vccnz wk_aw_no
  v_cmp_ne_u64 vcc, s[88:89], v[34:35]
  s_cbranch_vccnz wk_aw_no
  s_branch wk_aw_ok
wk_aw_no:
  s_sleep 6
  s_add_u32 s30, s30, 1
  s_cmp_lt_u32 s30, 50000
  s_cbranch_scc1 wk_aw
  s_branch cA_abort
wk_aw_ok:
wk_gemm:
  s_lshl_b32 s20, s18, 4
  s_lshl_b32 s21, s16, 2
  s_add_u32 s20, s20, s21
  s_mul_i32 s21, s20, 14336
  s_add_u32 s21, s21, 71565312
  s_add_u32 s22, s21, 0
  buffer_load_dwordx4 a[0:3], v2, s[8:11], s22 offen offset:0 sc1
  buffer_load_dwordx4 a[4:7], v2, s[8:11], s22 offen offset:1024 sc1
  buffer_load_dwordx4 a[8:11], v2, s[8:11], s22 offen offset:2048 sc1
  buffer_load_dwordx4 a[12:15], v2, s[8:11], s22 offen offset:3072 sc1
  s_add_u32 s22, s21, 4096
  buffer_load_dwordx4 a[16:19], v2, s[8:11], s22 offen offset:0 sc1
  buffer_load_dwordx4 a[20:23], v2, s[8:11], s22 offen offset:1024 sc1
  buffer_load_dwordx4 a[24:27], v2, s[8:11], s22 offen offset:2048 sc1
  buffer_load_dwordx4 a[28:31], v2, s[8:11], s22 offen offset:3072 sc1
  s_add_u32 s22, s21, 8192
  buffer_load_dwordx4 a[32:35], v2, s[8:11], s22 offen offset:0 sc1
  buffer_load_dwordx4 a[36:39], v2, s[8:11], s22 offen offset:1024 sc1
  buffer_load_dwordx4 a[40:43], v2, s[8:11], s22 offen offset:2048 sc1
  buffer_load_dwordx4 a[44:47], v2, s[8:11], s22 offen offset:3072 sc1
  s_add_u32 s22, s21, 12288
  buffer_load_dwordx4 a[48:51], v2, s[8:11], s22 offen offset:0 sc1
  buffer_load_dwordx4 a[52:55], v2, s[8:11], s22 offen offset:1024 sc1
  buffer_load_dwordx4 a[56:59], v2, s[8:11], s22 offen offset:2048 sc1
  buffer_load_dwordx4 a[60:63], v2, s[8:11], s22 offen offset:3072 sc1
  s_add_u32 s22, s21, 16384
  buffer_load_dwordx4 a[64:67], v2, s[8:11], s22 offen offset:0 sc1
  buffer_load_dwordx4 a[68:71], v2, s[8:11], s22 offen offset:1024 sc1
  buffer_load_dwordx4 a[72:75], v2, s[8:11], s22 offen offset:2048 sc1
  buffer_load_dwordx4 a[76:79], v2, s[8:11], s22 offen offset:3072 sc1
  s_add_u32 s22, s21, 20480
  buffer_load_dwordx4 a[80:83], v2, s[8:11], s22 offen offset:0 sc1
  buffer_load_dwordx4 a[84:87], v2, s[8:11], s22 offen offset:1024 sc1
  buffer_load_dwordx4 a[88:91], v2, s[8:11], s22 offen offset:2048 sc1
  buffer_load_dwordx4 a[92:95], v2, s[8:11], s22 offen offset:3072 sc1
  s_add_u32 s22, s21, 24576
  buffer_load_dwordx4 a[96:99], v2, s[8:11], s22 offen offset:0 sc1
  buffer_load_dwordx4 a[100:103], v2, s[8:11], s22 offen offset:1024 sc1
  buffer_load_dwordx4 a[104:107], v2, s[8:11], s22 offen offset:2048 sc1
  buffer_load_dwordx4 a[108:111], v2, s[8:11], s22 offen offset:3072 sc1
  s_add_u32 s22, s21, 28672
  buffer_load_dwordx4 a[112:115], v2, s[8:11], s22 offen offset:0 sc1
  buffer_load_dwordx4 a[116:119], v2, s[8:11], s22 offen offset:1024 sc1
  buffer_load_dwordx4 a[120:123], v2, s[8:11], s22 offen offset:2048 sc1
  buffer_load_dwordx4 a[124:127], v2, s[8:11], s22 offen offset:3072 sc1
  s_add_u32 s22, s21, 32768
  buffer_load_dwordx4 a[128:131], v2, s[8:11], s22 offen offset:0 sc1
  buffer_load_dwordx4 a[132:135], v2, s[8:11], s22 offen offset:1024 sc1
  buffer_load_dwordx4 a[136:139], v2, s[8:11], s22 offen offset:2048 sc1
  buffer_load_dwordx4 a[140:143], v2, s[8:11], s22 offen offset:3072 sc1
  s_add_u32 s22, s21, 36864
  buffer_load_dwordx4 a[144:147], v2, s[8:11], s22 offen offset:0 sc1
  buffer_load_dwordx4 a[148:151], v2, s[8:11], s22 offen offset:1024 sc1
  buffer_load_dwordx4 a[152:155], v2, s[8:11], s22 offen offset:2048 sc1
  buffer_load_dwordx4 a[156:159], v2, s[8:11], s22 offen offset:3072 sc1
  s_add_u32 s22, s21, 40960
  buffer_load_dwordx4 a[160:163], v2, s[8:11], s22 offen offset:0 sc1
  buffer_load_dwordx4 a[164:167], v2, s[8:11], s22 offen offset:1024 sc1
  buffer_load_dwordx4 a[168:171], v2, s[8:11], s22 offen offset:2048 sc1
  buffer_load_dwordx4 a[172:175], v2, s[8:11], s22 offen offset:3072 sc1
  s_add_u32 s22, s21, 45056
  buffer_load_dwordx4 a[176:179], v2, s[8:11], s22 offen offset:0 sc1
  buffer_load_dwordx4 a[180:183], v2, s[8:11], s22 offen offset:1024 sc1
  buffer_load_dwordx4 a[184:187], v2, s[8:11], s22 offen offset:2048 sc1
  buffer_load_dwordx4 a[188:191], v2, s[8:11], s22 offen offset:3072 sc1
  s_add_u32 s22, s21, 49152
  buffer_load_dwordx4 a[192:195], v2, s[8:11], s22 offen offset:0 sc1
  buffer_load_dwordx4 a[196:199], v2, s[8:11], s22 offen offset:1024 sc1
  buffer_load_dwordx4 a[200:203], v2, s[8:11], s22 offen offset:2048 sc1
  buffer_load_dwordx4 a[204:207], v2, s[8:11], s22 offen offset:3072 sc1
  s_add_u32 s22, s21, 53248
  buffer_load_dwordx4 a[208:211], v2, s[8:11], s22 offen offset:0 sc1
  buffer_load_dwordx4 a[212:215], v2, s[8:11], s22 offen offset:1024 sc1
  buffer_load_dwordx4 a[216:219], v2, s[8:11], s22 offen offset:2048 sc1
  buffer_load_dwordx4 a[220:223], v2, s[8:11], s22 offen offset:3072 sc1
  s_waitcnt vmcnt(40)
  s_mul_i32 s23, s17, 401408
  s_and_b32 s22, s16, 1
  s_mul_i32 s22, s22, 7168
  s_add_u32 s23, s23, s22
  s_add_u32 s23, s23, 0
  s_lshr_b32 s22, s16, 1
  s_mul_i32 s22, s22, 14336
  s_add_u32 s23, s23, s22
  s_mul_i32 s27, s16, 7168
  s_lshr_b32 s28, s20, 1
  s_cmp_lt_u32 s17, 16
  s_cbranch_scc0 wg_vo
  s_add_u32 s23, s23, s22
  s_lshl_b32 s29, s28, 4
  s_add_u32 s29, s29, s17
  s_mul_i32 s29, s29, 28672
  s_add_u32 s29, s29, 12845056
  s_mov_b32 s31, 0
  s_lshr_b32 s24, s34, 1
  s_lshl_b32 s24, s24, 2
  s_and_b32 s25, s34, 1
  s_add_u32 s24, s24, s25
  s_mul_i32 s24, s24, 14336
  s_add_u32 s24, s24, s23
  s_cmp_lt_u32 s34, s35
  s_cselect_b32 s24, s24, 0x10000000
  s_add_u32 m0, s31, s27
  s_nop 0
  buffer_load_dwordx4 v2, s[8:11], s24 offen offset:0 sc1 lds
  buffer_load_dwordx4 v2, s[8:11], s24 offen offset:1024 sc1 lds
  buffer_load_dwordx4 v2, s[8:11], s24 offen offset:2048 sc1 lds
  buffer_load_dwordx4 v2, s[8:11], s24 offen offset:3072 sc1 lds
  s_add_u32 m0, m0, 4096
  s_add_u32 s24, s24, 4096
  buffer_load_dwordx4 v2, s[8:11], s24 offen offset:0 sc1 lds
  buffer_load_dwordx4 v2, s[8:11], s24 offen offset:1024 sc1 lds
  buffer_load_dwordx4 v2, s[8:11], s24 offen offset:2048 sc1 lds
  s_add_u32 s30, s34, 1
  s_mov_b32 s31, 28672
  s_lshr_b32 s24, s30, 1
  s_lshl_b32 s24, s24, 2
  s_and_b32 s25, s30, 1
  s_add_u32 s24, s24, s25
  s_mul_i32 s24, s24, 14336
  s_add_u32 s24, s24, s23
  s_cmp_lt_u32 s30, s35
  s_cselect_b32 s24, s24, 0x10000000
  s_add_u32 m0, s31, s27
  s_nop 0
  buffer_load_dwordx4 v2, s[8:11], s24 offen offset:0 sc1 lds
  buffer_load_dwordx4 v2, s[8:11], s24 offen offset:1024 sc1 lds
  buffer_load_dwordx4 v2, s[8:11], s24 offen offset:2048 sc1 lds
  buffer_load_dwordx4 v2, s[8:11], s24 offen offset:3072 sc1 lds
  s_add_u32 m0, m0, 4096
  s_add_u32 s24, s24, 4096
  buffer_load_dwordx4 v2, s[8:11], s24 offen offset:0 sc1 lds
  buffer_load_dwordx4 v2, s[8:11], s24 offen offset:1024 sc1 lds
  buffer_load_dwordx4 v2, s[8:11], s24 offen offset:2048 sc1 lds
  s_mov_b32 s19, s34
  s_mov_b32 s32, 0
  s_mov_b32 s33, 57344
  s_waitcnt vmcnt(7)
  s_branch wg_f_in
wg_f_loop:
  s_waitcnt vmcnt(11)
wg_f_in:
  s_barrier
  s_add_u32 s30, s19, 2
  s_lshr_b32 s24, s30, 1
  s_lshl_b32 s24, s24, 2
  s_and_b32 s25, s30, 1
  s_add_u32 s24, s24, s25
  s_mul_i32 s24, s24, 14336
  s_add_u32 s24, s24, s23
  s_cmp_lt_u32 s30, s35
  s_cselect_b32 s24, s24, 0x10000000
  s_add_u32 m0, s33, s27
  s_nop 0
  buffer_load_dwordx4 v2, s[8:11], s24 offen offset:0 sc1 lds
  buffer_load_dwordx4 v2, s[8:11], s24 offen offset:1024 sc1 lds
  buffer_load_dwordx4 v2, s[8:11], s24 offen offset:2048 sc1 lds
  buffer_load_dwordx4 v2, s[8:11], s24 offen offset:3072 sc1 lds
  s_add_u32 m0, m0, 4096
  s_add_u32 s24, s24, 4096
  buffer_load_dwordx4 v2, s[8:11], s24 offen offset:0 sc1 lds
  buffer_load_dwordx4 v2, s[8:11], s24 offen offset:1024 sc1 lds
  buffer_load_dwordx4 v2, s[8:11], s24 offen offset:2048 sc1 lds
  v_add_u32 v5, s32, v2
  ds_read_b128 v[8:11], v5 offset:0
  ds_read_b128 v[12:15], v5 offset:14336
  ds_read_b128 v[16:19], v5 offset:1024
  ds_read_b128 v[20:23], v5 offset:15360
  ds_read_b128 v[24:27], v5 offset:2048
  ds_read_b128 v[28:31], v5 offset:16384
  ds_read_b128 v[32:35], v5 offset:3072
  s_waitcnt lgkmcnt(6)
  v_mfma_f32_16x16x32_bf16 v[40:43], v[8:11], a[0:3], 0
  v_mfma_f32_16x16x32_bf16 v[44:47], v[8:11], a[56:59], 0
  v_mfma_f32_16x16x32_bf16 v[48:51], v[8:11], a[112:115], 0
  v_mfma_f32_16x16x32_bf16 v[52:55], v[8:11], a[168:171], 0
  ds_read_b128 v[36:39], v5 offset:17408
  s_waitcnt lgkmcnt(6)
  v_mfma_f32_16x16x32_bf16 v[56:59], v[12:15], a[0:3], 0
  v_mfma_f32_16x16x32_bf16 v[60:63], v[12:15], a[56:59], 0
  v_mfma_f32_16x16x32_bf16 v[64:67], v[12:15], a[112:115], 0
  v_mfma_f32_16x16x32_bf16 v[68:71], v[12:15], a[168:171], 0
  ds_read_b128 v[8:11], v5 offset:4096
  s_waitcnt lgkmcnt(6)
  v_mfma_f32_16x16x32_bf16 v[40:43], v[16:19], a[4:7], v[40:43]
  v_mfma_f32_16x16x32_bf16 v[44:47], v[16:19], a[60:63], v[44:47]
  v_mfma_f32_16x16x32_bf16 v[48:51], v[16:19], a[116:119], v[48:51]
  v_mfma_f32_16x16x32_bf16 v[52:55], v[16:19], a[172:175], v[52:55]
  ds_read_b128 v[12:15], v5 offset:18432
  s_waitcnt lgkmcnt(6)
  v_mfma_f32_16x16x32_bf16 v[56:59], v[20:23], a[4:7], v[56:59]
  v_mfma_f32_16x16x32_bf16 v[60:63], v[20:23], a[60:63], v[60:63]
  v_mfma_f32_16x16x32_bf16 v[64:67], v[20:23], a[116:119], v[64:67]
  v_mfma_f32_16x16x32_bf16 v[68:71], v[20:23], a[172:175], v[68:71]
  ds_read_b128 v[16:19], v5 offset:5120
  s_waitcnt lgkmcnt(6)
  v_mfma_f32_16x16x32_bf16 v[40:43], v[24:27], a[8:11], v[40:43]
  v_mfma_f32_16x16x32_bf16 v[44:47], v[24:27], a[64:67], v[44:47]
  v_mfma_f32_16x16x32_bf16 v[48:51], v[24:27], a[120:123], v[48:51]
  v_mfma_f32_16x16x32_bf16 v[52:55], v[24:27], a[176:179], v[52:55]
  ds_read_b128 v[20:23], v5 offset:19456
  s_waitcnt lgkmcnt(6)
  v_mfma_f32_16x16x32_bf16 v[56:59], v[28:31], a[8:11], v[56:59]
  v_mfma_f32_16x16x32_bf16 v[60:63], v[28:31], a[64:67], v[60:63]
  v_mfma_f32_16x16x32_bf16 v[64:67], v[28:31], a[120:123], v[64:67]
  v_mfma_f32_16x16x32_bf16 v[68:71], v[28:31], a[176:179], v[68:71]
  ds_read_b128 v[24:27], v5 offset:6144
  s_waitcnt lgkmcnt(6)
  v_mfma_f32_16x16x32_bf16 v[40:43], v[32:35], a[12:15], v[40:43]
  v_mfma_f32_16x16x32_bf16 v[44:47], v[32:35], a[68:71], v[44:47]
  v_mfma_f32_16x16x32_bf16 v[48:51], v[32:35], a[124:127], v[48:51]
  v_mfma_f32_16x16x32_bf16 v[52:55], v[32:35], a[180:183], v[52:55]
  ds_read_b128 v[28:31], v5 offset:20480
  s_waitcnt lgkmcnt(6)
  v_mfma_f32_16x16x32_bf16 v[56:59], v[36:39], a[12:15], v[56:59]
  v_mfma_f32_16x16x32_bf16 v[60:63], v[36:39], a[68:71], v[60:63]
  v_mfma_f32_16x16x32_bf16 v[64:67], v[36:39], a[124:127], v[64:67]
  v_mfma_f32_16x16x32_bf16 v[68:71], v[36:39], a[180:183], v[68:71]
  ds_read_b128 v[32:35], v5 offset:7168
  s_waitcnt lgkmcnt(6)
  v_mfma_f32_16x16x32_bf16 v[40:43], v[8:11], a[16:19], v[40:43]
  v_mfma_f32_16x16x32_bf16 v[44:47], v[8:11], a[72:75], v[44:47]
  v_mfma_f32_16x16x32_bf16 v[48:51], v[8:11], a[128:131], v[48:51]
  v_mfma_f32_16x16x32_bf16 v[52:55], v[8:11], a[184:187], v[52:55]
  ds_read_b128 v[36:39], v5 offset:21504
  s_waitcnt lgkmcnt(6)
  v_mfma_f32_16x16x32_bf16 v[56:59], v[12:15], a[16:19], v[56:59]
  v_mfma_f32_16x16x32_bf16 v[60:63], v[12:15], a[72:75], v[60:63]
  v_mfma_f32_16x16x32_bf16 v[64:67], v[12:15], a[128:131], v[64:67]
  v_mfma_f32_16x16x32_bf16 v[68:71], v[12:15], a[184:187], v[68:71]
  ds_read_b128 v[8:11], v5 offset:8192
  s_waitcnt lgkmcnt(6)
  v_mfma_f32_16x16x32_bf16 v[40:43], v[16:19], a[20:23], v[40:43]
  v_mfma_f32_16x16x32_bf16 v[44:47], v[16:19], a[76:79], v[44:47]
  v_mfma_f32_16x16x32_bf16 v[48:51], v[16:19], a[132:135], v[48:51]
  v_mfma_f32_16x16x32_bf16 v[52:55], v[16:19], a[188:191], v[52:55]
  ds_read_b128 v[12:15], v5 offset:22528
  s_waitcnt lgkmcnt(6)
  v_mfma_f32_16x16x32_bf16 v[56:59], v[20:23], a[20:23], v[56:59]
  v_mfma_f32_16x16x32_bf16 v[60:63], v[20:23], a[76:79], v[60:63]
  v_mfma_f32_16x16x32_bf16 v[64:67], v[20:23], a[132:135], v[64:67]
  v_mfma_f32_16x16x32_bf16 v[68:71], v[20:23], a[188:191], v[68:71]
  ds_read_b128 v[16:19], v5 offset:9216
  s_waitcnt lgkmcnt(6)
  v_mfma_f32_16x16x32_bf16 v[40:43], v[24:27], a[24:27], v[40:43]
  v_mfma_f32_16x16x32_bf16 v[44:47], v[24:27], a[80:83], v[44:47]
  v_mfma_f32_16x16x32_bf16 v[48:51], v[24:27], a[136:139], v[48:51]
  v_mfma_f32_16x16x32_bf16 v[52:55], v[24:27], a[192:195], v[52:55]
  ds_read_b128 v[20:23], v5 offset:23552
  s_waitcnt lgkmcnt(6)
  v_mfma_f32_16x16x32_bf16 v[56:59], v[28:31], a[24:27], v[56:59]
  v_mfma_f32_16x16x32_bf16 v[60:63], v[28:31], a[80:83], v[60:63]
  v_mfma_f32_16x16x32_bf16 v[64:67], v[28:31], a[136:139], v[64:67]
  v_mfma_f32_16x16x32_bf16 v[68:71], v[28:31], a[192:195], v[68:71]
  ds_read_b128 v[24:27], v5 offset:10240
  s_waitcnt lgkmcnt(6)
  v_mfma_f32_16x16x32_bf16 v[40:43], v[32:35], a[28:31], v[40:43]
  v_mfma_f32_16x16x32_bf16 v[44:47], v[32:35], a[84:87], v[44:47]
  v_mfma_f32_16x16x32_bf16 v[48:51], v[32:35], a[140:143], v[48:51]
  v_mfma_f32_16x16x32_bf16 v[52:55], v[32:35], a[196:199], v[52:55]
  ds_read_b128 v[28:31], v5 offset:24576
  s_waitcnt lgkmcnt(6)
  v_mfma_f32_16x16x32_bf16 v[56:59], v[36:39], a[28:31], v[56:59]
  v_mfma_f32_16x16x32_bf16 v[60:63], v[36:39], a[84:87], v[60:63]
  v_mfma_f32_16x16x32_bf16 v[64:67], v[36:39], a[140:143], v[64:67]
  v_mfma_f32_16x16x32_bf16 v[68:71], v[36:39], a[196:199], v[68:71]
  ds_read_b128 v[32:35], v5 offset:11264
  s_waitcnt lgkmcnt(6)
  v_mfma_f32_16x16x32_bf16 v[40:43], v[8:11], a[32:35], v[40:43]
  v_mfma_f32_16x16x32_bf16 v[44:47], v[8:11], a[88:91], v[44:47]
  v_mfma_f32_16x16x32_bf16 v[48:51], v[8:11], a[144:147], v[48:51]
  v_mfma_f32_16x16x32_bf16 v[52:55], v[8:11], a[200:203], v[52:55]
  ds_read_b128 v[36:39], v5 offset:25600
  s_waitcnt lgkmcnt(6)
  v_mfma_f32_16x16x32_bf16 v[56:59], v[12:15], a[32:35], v[56:59]
  v_mfma_f32_16x16x32_bf16 v[60:63], v[12:15], a[88:91], v[60:63]
  v_mfma_f32_16x16x32_bf16 v[64:67], v[12:15], a[144:147], v[64:67]
  v_mfma_f32_16x16x32_bf16 v[68:71], v[12:15], a[200:203], v[68:71]
  ds_read_b128 v[8:11], v5 offset:12288
  s_waitcnt lgkmcnt(6)
  v_mfma_f32_16x16x32_bf16 v[40:43], v[16:19], a[36:39], v[40:43]
  v_mfma_f32_16x16x32_bf16 v[44:47], v[16:19], a[92:95], v[44:47]
  v_mfma_f32_16x16x32_bf16 v[48:51], v[16:19], a[148:151], v[48:51]
  v_mfma_f32_16x16x32_bf16 v[52:55], v[16:19], a[204:207], v[52:55]
  ds_read_b128 v[12:15], v5 offset:26624
  s_waitcnt lgkmcnt(6)
  v_mfma_f32_16x16x32_bf16 v[56:59], v[20:23], a[36:39], v[56:59]
  v_mfma_f32_16x16x32_bf16 v[60:63], v[20:23], a[92:95], v[60:63]
  v_mfma_f32_16x16x32_bf16 v[64:67], v[20:23], a[148:151], v[64:67]
  v_mfma_f32_16x16x32_bf16 v[68:71], v[20:23], a[204:207], v[68:71]
  ds_read_b128 v[16:19], v5 offset:13312
  s_waitcnt lgkmcnt(6)
  v_mfma_f32_16x16x32_bf16 v[40:43], v[24:27], a[40:43], v[40:43]
  v_mfma_f32_16x16x32_bf16 v[44:47], v[24:27], a[96:99], v[44:47]
  v_mfma_f32_16x16x32_bf16 v[48:51], v[24:27], a[152:155], v[48:51]
  v_mfma_f32_16x16x32_bf16 v[52:55], v[24:27], a[208:211], v[52:55]
  ds_read_b128 v[20:23], v5 offset:27648
  s_waitcnt lgkmcnt(6)
  v_mfma_f32_16x16x32_bf16 v[56:59], v[28:31], a[40:43], v[56:59]
  v_mfma_f32_16x16x32_bf16 v[60:63], v[28:31], a[96:99], v[60:63]
  v_mfma_f32_16x16x32_bf16 v[64:67], v[28:31], a[152:155], v[64:67]
  v_mfma_f32_16x16x32_bf16 v[68:71], v[28:31], a[208:211], v[68:71]
  s_waitcnt lgkmcnt(5)
  v_mfma_f32_16x16x32_bf16 v[40:43], v[32:35], a[44:47], v[40:43]
  v_mfma_f32_16x16x32_bf16 v[44:47], v[32:35], a[100:103], v[44:47]
  v_mfma_f32_16x16x32_bf16 v[48:51], v[32:35], a[156:159], v[48:51]
  v_mfma_f32_16x16x32_bf16 v[52:55], v[32:35], a[212:215], v[52:55]
  s_waitcnt lgkmcnt(4)
  v_mfma_f32_16x16x32_bf16 v[56:59], v[36:39], a[44:47], v[56:59]
  v_mfma_f32_16x16x32_bf16 v[60:63], v[36:39], a[100:103], v[60:63]
  v_mfma_f32_16x16x32_bf16 v[64:67], v[36:39], a[156:159], v[64:67]
  v_mfma_f32_16x16x32_bf16 v[68:71], v[36:39], a[212:215], v[68:71]
  s_waitcnt lgkmcnt(3)
  v_mfma_f32_16x16x32_bf16 v[40:43], v[8:11], a[48:51], v[40:43]
  v_mfma_f32_16x16x32_bf16 v[44:47], v[8:11], a[104:107], v[44:47]
  v_mfma_f32_16x16x32_bf16 v[48:51], v[8:11], a[160:163], v[48:51]
  v_mfma_f32_16x16x32_bf16 v[52:55], v[8:11], a[216:219], v[52:55]
  s_waitcnt lgkmcnt(2)
  v_mfma_f32_16x16x32_bf16 v[56:59], v[12:15], a[48:51], v[56:59]
  v_mfma_f32_16x16x32_bf16 v[60:63], v[12:15], a[104:107], v[60:63]
  v_mfma_f32_16x16x32_bf16 v[64:67], v[12:15], a[160:163], v[64:67]
  v_mfma_f32_16x16x32_bf16 v[68:71], v[12:15], a[216:219], v[68:71]
  s_waitcnt lgkmcnt(1)
  v_mfma_f32_16x16x32_bf16 v[40:43], v[16:19], a[52:55], v[40:43]
  v_mfma_f32_16x16x32_bf16 v[44:47], v[16:19], a[108:111], v[44:47]
  v_mfma_f32_16x16x32_bf16 v[48:51], v[16:19], a[164:167], v[48:51]
  v_mfma_f32_16x16x32_bf16 v[52:55], v[16:19], a[220:223], v[52:55]
  s_waitcnt lgkmcnt(0)
  v_mfma_f32_16x16x32_bf16 v[56:59], v[20:23], a[52:55], v[56:59]
  v_mfma_f32_16x16x32_bf16 v[60:63], v[20:23], a[108:111], v[60:63]
  v_mfma_f32_16x16x32_bf16 v[64:67], v[20:23], a[164:167], v[64:67]
  v_mfma_f32_16x16x32_bf16 v[68:71], v[20:23], a[220:223], v[68:71]
  s_lshl_b32 s24, s19, 10
  s_add_u32 s24, s24, s29
  v_cvt_pk_bf16_f32 v72, v40, v41
  v_cvt_pk_bf16_f32 v73, v42, v43
  v_cvt_pk_bf16_f32 v74, v56, v57
  v_cvt_pk_bf16_f32 v75, v58, v59
  s_add_u32 s25, s24, 0
  buffer_store_dwordx4 v[72:75], v2, s[8:11], s25 offen sc1
  v_cvt_pk_bf16_f32 v76, v44, v45
  v_cvt_pk_bf16_f32 v77, v46, v47
  v_cvt_pk_bf16_f32 v78, v60, v61
  v_cvt_pk_bf16_f32 v79, v62, v63
  s_add_u32 s25, s24, 14336
  buffer_store_dwordx4 v[76:79], v2, s[8:11], s25 offen sc1
  v_cvt_pk_bf16_f32 v80, v48, v49
  v_cvt_pk_bf16_f32 v81, v50, v51
  v_cvt_pk_bf16_f32 v82, v64, v65
  v_cvt_pk_bf16_f32 v83, v66, v67
  s_add_u32 s25, s24, 458752
  buffer_store_dwordx4 v[80:83], v2, s[8:11], s25 offen sc1
  v_cvt_pk_bf16_f32 v84, v52, v53
  v_cvt_pk_bf16_f32 v85, v54, v55
  v_cvt_pk_bf16_f32 v86, v68, v69
  v_cvt_pk_bf16_f32 v87, v70, v71
  s_add_u32 s25, s24, 473088
  buffer_store_dwordx4 v[84:87], v2, s[8:11], s25 offen sc1
  s_mov_b32 s33, s32
  s_add_u32 s32, s32, 28672
  s_cmp_eq_u32 s32, 86016
  s_cselect_b32 s32, 0, s32
  s_add_u32 s19, s19, 1
  s_cmp_lt_u32 s19, s35
  s_cbranch_scc1 wg_f_loop
  s_branch wg_done
wg_vo:
  s_sub_u32 s29, s17, 16
  s_lshl_b32 s29, s29, 6
  s_add_u32 s29, s29, s28
  s_mul_i32 s29, s29, 28672
  s_add_u32 s29, s29, 42205184
  v_mul_u32_u24 v6, 28, v3
  s_mov_b32 s31, 0
  s_lshl_b32 s24, s34, 1
  s_mul_i32 s24, s24, 14336
  s_add_u32 s24, s24, s23
  s_cmp_lt_u32 s34, s35
  s_cselect_b32 s24, s24, 0x10000000
  s_add_u32 m0, s31, s27
  s_nop 0
  buffer_load_dwordx4 v2, s[8:11], s24 offen offset:0 sc1 lds
  buffer_load_dwordx4 v2, s[8:11], s24 offen offset:1024 sc1 lds
  buffer_load_dwordx4 v2, s[8:11], s24 offen offset:2048 sc1 lds
  buffer_load_dwordx4 v2, s[8:11], s24 offen offset:3072 sc1 lds
  s_add_u32 m0, m0, 4096
  s_add_u32 s24, s24, 4096
  buffer_load_dwordx4 v2, s[8:11], s24 offen offset:0 sc1 lds
  buffer_load_dwordx4 v2, s[8:11], s24 offen offset:1024 sc1 lds
  buffer_load_dwordx4 v2, s[8:11], s24 offen offset:2048 sc1 lds
  s_add_u32 s30, s34, 1
  s_mov_b32 s31, 28672
  s_lshl_b32 s24, s30, 1
  s_mul_i32 s24, s24, 14336
  s_add_u32 s24, s24, s23
  s_cmp_lt_u32 s30, s35
  s_cselect_b32 s24, s24, 0x10000000
  s_add_u32 m0, s31, s27
  s_nop 0
  buffer_load_dwordx4 v2, s[8:11], s24 offen offset:0 sc1 lds
  buffer_load_dwordx4 v2, s[8:11], s24 offen offset:1024 sc1 lds
  buffer_load_dwordx4 v2, s[8:11], s24 offen offset:2048 sc1 lds
  buffer_load_dwordx4 v2, s[8:11], s24 offen offset:3072 sc1 lds
  s_add_u32 m0, m0, 4096
  s_add_u32 s24, s24, 4096
  buffer_load_dwordx4 v2, s[8:11], s24 offen offset:0 sc1 lds
  buffer_load_dwordx4 v2, s[8:11], s24 offen offset:1024 sc1 lds
  buffer_load_dwordx4 v2, s[8:11], s24 offen offset:2048 sc1 lds
  s_mov_b32 s19, s34
  s_mov_b32 s32, 0
  s_mov_b32 s33, 57344
  s_waitcnt vmcnt(7)
  s_branch wg_vo_in
wg_vo_loop:
  s_waitcnt vmcnt(11)
wg_vo_in:
  s_barrier
  s_add_u32 s30, s19, 2
  s_lshl_b32 s24, s30, 1
  s_mul_i32 s24, s24, 14336
  s_add_u32 s24, s24, s23
  s_cmp_lt_u32 s30, s35
  s_cselect_b32 s24, s24, 0x10000000
  s_add_u32 m0, s33, s27
  s_nop 0
  buffer_load_dwordx4 v2, s[8:11], s24 offen offset:0 sc1 lds
  buffer_load_dwordx4 v2, s[8:11], s24 offen offset:1024 sc1 lds
  buffer_load_dwordx4 v2, s[8:11], s24 offen offset:2048 sc1 lds
  buffer_load_dwordx4 v2, s[8:11], s24 offen offset:3072 sc1 lds
  s_add_u32 m0, m0, 4096
  s_add_u32 s24, s24, 4096
  buffer_load_dwordx4 v2, s[8:11], s24 offen offset:0 sc1 lds
  buffer_load_dwordx4 v2, s[8:11], s24 offen offset:1024 sc1 lds
  buffer_load_dwordx4 v2, s[8:11], s24 offen offset:2048 sc1 lds
  v_add_u32 v5, s32, v2
  ds_read_b128 v[8:11], v5 offset:0
  ds_read_b128 v[12:15], v5 offset:14336
  ds_read_b128 v[16:19], v5 offset:1024
  ds_read_b128 v[20:23], v5 offset:15360
  ds_read_b128 v[24:27], v5 offset:2048
  ds_read_b128 v[28:31], v5 offset:16384
  ds_read_b128 v[32:35], v5 offset:3072
  s_waitcnt lgkmcnt(6)
  v_mfma_f32_16x16x32_bf16 v[40:43], a[0:3], v[8:11], 0
  v_mfma_f32_16x16x32_bf16 v[44:47], a[56:59], v[8:11], 0
  v_mfma_f32_16x16x32_bf16 v[48:51], a[112:115], v[8:11], 0
  v_mfma_f32_16x16x32_bf16 v[52:55], a[168:171], v[8:11], 0
  ds_read_b128 v[36:39], v5 offset:17408
  s_waitcnt lgkmcnt(6)
  v_mfma_f32_16x16x32_bf16 v[56:59], a[0:3], v[12:15], 0
  v_mfma_f32_16x16x32_bf16 v[60:63], a[56:59], v[12:15], 0
  v_mfma_f32_16x16x32_bf16 v[64:67], a[112:115], v[12:15], 0
  v_mfma_f32_16x16x32_bf16 v[68:71], a[168:171], v[12:15], 0
  ds_read_b128 v[8:11], v5 offset:4096
  s_waitcnt lgkmcnt(6)
  v_mfma_f32_16x16x32_bf16 v[40:43], a[4:7], v[16:19], v[40:43]
  v_mfma_f32_16x16x32_bf16 v[44:47], a[60:63], v[16:19], v[44:47]
  v_mfma_f32_16x16x32_bf16 v[48:51], a[116:119], v[16:19], v[48:51]
  v_mfma_f32_16x16x32_bf16 v[52:55], a[172:175], v[16:19], v[52:55]
  ds_read_b128 v[12:15], v5 offset:18432
  s_waitcnt lgkmcnt(6)
  v_mfma_f32_16x16x32_bf16 v[56:59], a[4:7], v[20:23], v[56:59]
  v_mfma_f32_16x16x32_bf16 v[60:63], a[60:63], v[20:23], v[60:63]
  v_mfma_f32_16x16x32_bf16 v[64:67], a[116:119], v[20:23], v[64:67]
  v_mfma_f32_16x16x32_bf16 v[68:71], a[172:175], v[20:23], v[68:71]
  ds_read_b128 v[16:19], v5 offset:5120
  s_waitcnt lgkmcnt(6)
  v_mfma_f32_16x16x32_bf16 v[40:43], a[8:11], v[24:27], v[40:43]
  v_mfma_f32_16x16x32_bf16 v[44:47], a[64:67], v[24:27], v[44:47]
  v_mfma_f32_16x16x32_bf16 v[48:51], a[120:123], v[24:27], v[48:51]
  v_mfma_f32_16x16x32_bf16 v[52:55], a[176:179], v[24:27], v[52:55]
  ds_read_b128 v[20:23], v5 offset:19456
  s_waitcnt lgkmcnt(6)
  v_mfma_f32_16x16x32_bf16 v[56:59], a[8:11], v[28:31], v[56:59]
  v_mfma_f32_16x16x32_bf16 v[60:63], a[64:67], v[28:31], v[60:63]
  v_mfma_f32_16x16x32_bf16 v[64:67], a[120:123], v[28:31], v[64:67]
  v_mfma_f32_16x16x32_bf16 v[68:71], a[176:179], v[28:31], v[68:71]
  ds_read_b128 v[24:27], v5 offset:6144
  s_waitcnt lgkmcnt(6)
  v_mfma_f32_16x16x32_bf16 v[40:43], a[12:15], v[32:35], v[40:43]
  v_mfma_f32_16x16x32_bf16 v[44:47], a[68:71], v[32:35], v[44:47]
  v_mfma_f32_16x16x32_bf16 v[48:51], a[124:127], v[32:35], v[48:51]
  v_mfma_f32_16x16x32_bf16 v[52:55], a[180:183], v[32:35], v[52:55]
  ds_read_b128 v[28:31], v5 offset:20480
  s_waitcnt lgkmcnt(6)
  v_mfma_f32_16x16x32_bf16 v[56:59], a[12:15], v[36:39], v[56:59]
  v_mfma_f32_16x16x32_bf16 v[60:63], a[68:71], v[36:39], v[60:63]
  v_mfma_f32_16x16x32_bf16 v[64:67], a[124:127], v[36:39], v[64:67]
  v_mfma_f32_16x16x32_bf16 v[68:71], a[180:183], v[36:39], v[68:71]
  ds_read_b128 v[32:35], v5 offset:7168
  s_waitcnt lgkmcnt(6)
  v_mfma_f32_16x16x32_bf16 v[40:43], a[16:19], v[8:11], v[40:43]
  v_mfma_f32_16x16x32_bf16 v[44:47], a[72:75], v[8:11], v[44:47]
  v_mfma_f32_16x16x32_bf16 v[48:51], a[128:131], v[8:11], v[48:51]
  v_mfma_f32_16x16x32_bf16 v[52:55], a[184:187], v[8:11], v[52:55]
  ds_read_b128 v[36:39], v5 offset:21504
  s_waitcnt lgkmcnt(6)
  v_mfma_f32_16x16x32_bf16 v[56:59], a[16:19], v[12:15], v[56:59]
  v_mfma_f32_16x16x32_bf16 v[60:63], a[72:75], v[12:15], v[60:63]
  v_mfma_f32_16x16x32_bf16 v[64:67], a[128:131], v[12:15], v[64:67]
  v_mfma_f32_16x16x32_bf16 v[68:71], a[184:187], v[12:15], v[68:71]
  ds_read_b128 v[8:11], v5 offset:8192
  s_waitcnt lgkmcnt(6)
  v_mfma_f32_16x16x32_bf16 v[40:43], a[20:23], v[16:19], v[40:43]
  v_mfma_f32_16x16x32_bf16 v[44:47], a[76:79], v[16:19], v[44:47]
  v_mfma_f32_16x16x32_bf16 v[48:51], a[132:135], v[16:19], v[48:51]
  v_mfma_f32_16x16x32_bf16 v[52:55], a[188:191], v[16:19], v[52:55]
  ds_read_b128 v[12:15], v5 offset:22528
  s_waitcnt lgkmcnt(6)
  v_mfma_f32_16x16x32_bf16 v[56:59], a[20:23], v[20:23], v[56:59]
  v_mfma_f32_16x16x32_bf16 v[60:63], a[76:79], v[20:23], v[60:63]
  v_mfma_f32_16x16x32_bf16 v[64:67], a[132:135], v[20:23], v[64:67]
  v_mfma_f32_16x16x32_bf16 v[68:71], a[188:191], v[20:23], v[68:71]
  ds_read_b128 v[16:19], v5 offset:9216
  s_waitcnt lgkmcnt(6)
  v_mfma_f32_16x16x32_bf16 v[40:43], a[24:27], v[24:27], v[40:43]
  v_mfma_f32_16x16x32_bf16 v[44:47], a[80:83], v[24:27], v[44:47]
  v_mfma_f32_16x16x32_bf16 v[48:51], a[136:139], v[24:27], v[48:51]
  v_mfma_f32_16x16x32_bf16 v[52:55], a[192:195], v[24:27], v[52:55]
  ds_read_b128 v[20:23], v5 offset:23552
  s_waitcnt lgkmcnt(6)
  v_mfma_f32_16x16x32_bf16 v[56:59], a[24:27], v[28:31], v[56:59]
  v_mfma_f32_16x16x32_bf16 v[60:63], a[80:83], v[28:31], v[60:63]
  v_mfma_f32_16x16x32_bf16 v[64:67], a[136:139], v[28:31], v[64:67]
  v_mfma_f32_16x16x32_bf16 v[68:71], a[192:195], v[28:31], v[68:71]
  ds_read_b128 v[24:27], v5 offset:10240
  s_waitcnt lgkmcnt(6)
  v_mfma_f32_16x16x32_bf16 v[40:43], a[28:31], v[32:35], v[40:43]
  v_mfma_f32_16x16x32_bf16 v[44:47], a[84:87], v[32:35], v[44:47]
  v_mfma_f32_16x16x32_bf16 v[48:51], a[140:143], v[32:35], v[48:51]
  v_mfma_f32_16x16x32_bf16 v[52:55], a[196:199], v[32:35], v[52:55]
  ds_read_b128 v[28:31], v5 offset:24576
  s_waitcnt lgkmcnt(6)
  v_mfma_f32_16x16x32_bf16 v[56:59], a[28:31], v[36:39], v[56:59]
  v_mfma_f32_16x16x32_bf16 v[60:63], a[84:87], v[36:39], v[60:63]
  v_mfma_f32_16x16x32_bf16 v[64:67], a[140:143], v[36:39], v[64:67]
  v_mfma_f32_16x16x32_bf16 v[68:71], a[196:199], v[36:39], v[68:71]
  ds_read_b128 v[32:35], v5 offset:11264
  s_waitcnt lgkmcnt(6)
  v_mfma_f32_16x16x32_bf16 v[40:43], a[32:35], v[8:11], v[40:43]
  v_mfma_f32_16x16x32_bf16 v[44:47], a[88:91], v[8:11], v[44:47]
  v_mfma_f32_16x16x32_bf16 v[48:51], a[144:147], v[8:11], v[48:51]
  v_mfma_f32_16x16x32_bf16 v[52:55], a[200:203], v[8:11], v[52:55]
  ds_read_b128 v[36:39], v5 offset:25600
  s_waitcnt lgkmcnt(6)
  v_mfma_f32_16x16x32_bf16 v[56:59], a[32:35], v[12:15], v[56:59]
  v_mfma_f32_16x16x32_bf16 v[60:63], a[88:91], v[12:15], v[60:63]
  v_mfma_f32_16x16x32_bf16 v[64:67], a[144:147], v[12:15], v[64:67]
  v_mfma_f32_16x16x32_bf16 v[68:71], a[200:203], v[12:15], v[68:71]
  ds_read_b128 v[8:11], v5 offset:12288
  s_waitcnt lgkmcnt(6)
  v_mfma_f32_16x16x32_bf16 v[40:43], a[36:39], v[16:19], v[40:43]
  v_mfma_f32_16x16x32_bf16 v[44:47], a[92:95], v[16:19], v[44:47]
  v_mfma_f32_16x16x32_bf16 v[48:51], a[148:151], v[16:19], v[48:51]
  v_mfma_f32_16x16x32_bf16 v[52:55], a[204:207], v[16:19], v[52:55]
  ds_read_b128 v[12:15], v5 offset:26624
  s_waitcnt lgkmcnt(6)
  v_mfma_f32_16x16x32_bf16 v[56:59], a[36:39], v[20:23], v[56:59]
  v_mfma_f32_16x16x32_bf16 v[60:63], a[92:95], v[20:23], v[60:63]
  v_mfma_f32_16x16x32_bf16 v[64:67], a[148:151], v[20:23], v[64:67]
  v_mfma_f32_16x16x32_bf16 v[68:71], a[204:207], v[20:23], v[68:71]
  ds_read_b128 v[16:19], v5 offset:13312
  s_waitcnt lgkmcnt(6)
  v_mfma_f32_16x16x32_bf16 v[40:43], a[40:43], v[24:27], v[40:43]
  v_mfma_f32_16x16x32_bf16 v[44:47], a[96:99], v[24:27], v[44:47]
  v_mfma_f32_16x16x32_bf16 v[48:51], a[152:155], v[24:27], v[48:51]
  v_mfma_f32_16x16x32_bf16 v[52:55], a[208:211], v[24:27], v[52:55]
  ds_read_b128 v[20:23], v5 offset:27648
  s_waitcnt lgkmcnt(6)
  v_mfma_f32_16x16x32_bf16 v[56:59], a[40:43], v[28:31], v[56:59]
  v_mfma_f32_16x16x32_bf16 v[60:63], a[96:99], v[28:31], v[60:63]
  v_mfma_f32_16x16x32_bf16 v[64:67], a[152:155], v[28:31], v[64:67]
  v_mfma_f32_16x16x32_bf16 v[68:71], a[208:211], v[28:31], v[68:71]
  s_waitcnt lgkmcnt(5)
  v_mfma_f32_16x16x32_bf16 v[40:43], a[44:47], v[32:35], v[40:43]
  v_mfma_f32_16x16x32_bf16 v[44:47], a[100:103], v[32:35], v[44:47]
  v_mfma_f32_16x16x32_bf16 v[48:51], a[156:159], v[32:35], v[48:51]
  v_mfma_f32_16x16x32_bf16 v[52:55], a[212:215], v[32:35], v[52:55]
  s_waitcnt lgkmcnt(4)
  v_mfma_f32_16x16x32_bf16 v[56:59], a[44:47], v[36:39], v[56:59]
  v_mfma_f32_16x16x32_bf16 v[60:63], a[100:103], v[36:39], v[60:63]
  v_mfma_f32_16x16x32_bf16 v[64:67], a[156:159], v[36:39], v[64:67]
  v_mfma_f32_16x16x32_bf16 v[68:71], a[212:215], v[36:39], v[68:71]
  s_waitcnt lgkmcnt(3)
  v_mfma_f32_16x16x32_bf16 v[40:43], a[48:51], v[8:11], v[40:43]
  v_mfma_f32_16x16x32_bf16 v[44:47], a[104:107], v[8:11], v[44:47]
  v_mfma_f32_16x16x32_bf16 v[48:51], a[160:163], v[8:11], v[48:51]
  v_mfma_f32_16x16x32_bf16 v[52:55], a[216:219], v[8:11], v[52:55]
  s_waitcnt lgkmcnt(2)
  v_mfma_f32_16x16x32_bf16 v[56:59], a[48:51], v[12:15], v[56:59]
  v_mfma_f32_16x16x32_bf16 v[60:63], a[104:107], v[12:15], v[60:63]
  v_mfma_f32_16x16x32_bf16 v[64:67], a[160:163], v[12:15], v[64:67]
  v_mfma_f32_16x16x32_bf16 v[68:71], a[216:219], v[12:15], v[68:71]
  s_waitcnt lgkmcnt(1)
  v_mfma_f32_16x16x32_bf16 v[40:43], a[52:55], v[16:19], v[40:43]
  v_mfma_f32_16x16x32_bf16 v[44:47], a[108:111], v[16:19], v[44:47]
  v_mfma_f32_16x16x32_bf16 v[48:51], a[164:167], v[16:19], v[48:51]
  v_mfma_f32_16x16x32_bf16 v[52:55], a[220:223], v[16:19], v[52:55]
  s_waitcnt lgkmcnt(0)
  v_mfma_f32_16x16x32_bf16 v[56:59], a[52:55], v[20:23], v[56:59]
  v_mfma_f32_16x16x32_bf16 v[60:63], a[108:111], v[20:23], v[60:63]
  v_mfma_f32_16x16x32_bf16 v[64:67], a[164:167], v[20:23], v[64:67]
  v_mfma_f32_16x16x32_bf16 v[68:71], a[220:223], v[20:23], v[68:71]
  s_add_u32 s25, s29, 28672
  s_lshl_b32 s24, s19, 5
  s_add_u32 s24, s24, 0
  v_add_u32 v88, s24, v4
  v_mul_u32_u24 v89, 2341, v88
  v_lshrrev_b32 v89, 16, v89
  v_mul_u32_u24 v89, 84, v89
  v_add3_u32 v88, v88, v89, v6
  v_lshlrev_b32 v90, 4, v88
  v_cvt_pk_bf16_f32 v72, v40, v41
  v_cvt_pk_bf16_f32 v73, v42, v43
  v_cvt_pk_bf16_f32 v74, v44, v45
  v_cvt_pk_bf16_f32 v75, v46, v47
  buffer_store_dwordx4 v[72:75], v90, s[8:11], s29 offen sc1
  v_cvt_pk_bf16_f32 v76, v48, v49
  v_cvt_pk_bf16_f32 v77, v50, v51
  v_cvt_pk_bf16_f32 v78, v52, v53
  v_cvt_pk_bf16_f32 v79, v54, v55
  buffer_store_dwordx4 v[76:79], v90, s[8:11], s25 offen sc1
  s_lshl_b32 s24, s19, 5
  s_add_u32 s24, s24, 16
  v_add_u32 v88, s24, v4
  v_mul_u32_u24 v89, 2341, v88
  v_lshrrev_b32 v89, 16, v89
  v_mul_u32_u24 v89, 84, v89
  v_add3_u32 v88, v88, v89, v6
  v_lshlrev_b32 v91, 4, v88
  v_cvt_pk_bf16_f32 v80, v56, v57
  v_cvt_pk_bf16_f32 v81, v58, v59
  v_cvt_pk_bf16_f32 v82, v60, v61
  v_cvt_pk_bf16_f32 v83, v62, v63
  buffer_store_dwordx4 v[80:83], v91, s[8:11], s29 offen sc1
  v_cvt_pk_bf16_f32 v84, v64, v65
  v_cvt_pk_bf16_f32 v85, v66, v67
  v_cvt_pk_bf16_f32 v86, v68, v69
  v_cvt_pk_bf16_f32 v87, v70, v71
  buffer_store_dwordx4 v[84:87], v91, s[8:11], s25 offen sc1
  s_mov_b32 s33, s32
  s_add_u32 s32, s32, 28672
  s_cmp_eq_u32 s32, 86016
  s_cselect_b32 s32, 0, s32
  s_add_u32 s19, s19, 1
  s_cmp_lt_u32 s19, s35
  s_cbranch_scc1 wg_vo_loop
  s_branch wg_done
wg_done:
  s_lshl_b32 s20, s18, 4
  s_and_b32 s21, s17, 15
  s_add_u32 s20, s20, s21
  s_lshl_b32 s20, s20, 7
  s_cmp_lt_u32 s17, 16
  s_cselect_b32 s21, 16384, 0
  s_add_u32 s20, s20, s21
  s_add_u32 s20, s20, 88528896
  s_sub_u32 s21, s35, s34
  v_mov_b32 v5, s21
  v_mov_b32 v6, 0
  s_waitcnt vmcnt(0)
  s_mov_b64 exec, 1
  buffer_atomic_add v5, v6, s[8:11], s20 offen
  s_mov_b64 exec, -1
  s_branch wk_loop
wk_a:
  s_load_dwordx8 s[36:43], s[0:1], 56
  s_load_dwordx4 s[44:47], s[0:1], 88
  s_sub_u32 s3, s3, 368
  s_and_b32 s17, s3, 15
  s_lshr_b32 s19, s3, 5
  s_bitcmp1_b32 s3, 4
  s_cselect_b32 s31, 7, 0
  s_waitcnt lgkmcnt(0)
  s_mov_b32 s60, s40
  s_and_b32 s61, s41, 0xffff
  s_mov_b32 s62, 3670016
  s_mov_b32 s63, 0x20000
  s_mov_b32 s56, s42
  s_and_b32 s57, s43, 0xffff
  s_mov_b32 s58, 3670016
  s_mov_b32 s59, 0x20000
  s_lshl_b32 s30, s16, 13
  s_lshl_b32 s27, s19, 19
  s_lshl_b32 s29, s16, 17
  s_add_u32 s27, s27, s29
  s_lshl_b32 s29, s17, 9
  s_add_u32 s27, s27, s29
  v_lshrrev_b32 v5, 5, v1
  v_and_b32 v6, 31, v1
  v_xor_b32 v6, v6, v5
  v_lshlrev_b32 v6, 4, v6
  v_lshl_add_u32 v6, v5, 13, v6
  s_add_u32 m0, s30, 0
  s_add_u32 s22, s27, 0
  v_xor_b32 v7, 0, v6
  buffer_load_dwordx4 v7, s[56:59], s22 offen offset:0 lds
  s_add_u32 s22, s27, 15360
  v_xor_b32 v7, 32, v6
  buffer_load_dwordx4 v7, s[56:59], s22 offen offset:1024 lds
  s_add_u32 s22, s27, 30720
  v_xor_b32 v7, 64, v6
  buffer_load_dwordx4 v7, s[56:59], s22 offen offset:2048 lds
  s_add_u32 s22, s27, 46080
  v_xor_b32 v7, 96, v6
  buffer_load_dwordx4 v7, s[56:59], s22 offen offset:3072 lds
  s_add_u32 m0, s30, 4096
  s_add_u32 s22, s27, 65536
  v_xor_b32 v7, 128, v6
  buffer_load_dwordx4 v7, s[56:59], s22 offen offset:0 lds
  s_add_u32 s22, s27, 80896
  v_xor_b32 v7, 160, v6
  buffer_load_dwordx4 v7, s[56:59], s22 offen offset:1024 lds
  s_add_u32 s22, s27, 96256
  v_xor_b32 v7, 192, v6
  buffer_load_dwordx4 v7, s[56:59], s22 offen offset:2048 lds
  s_add_u32 s22, s27, 111616
  v_xor_b32 v7, 224, v6
  buffer_load_dwordx4 v7, s[56:59], s22 offen offset:3072 lds
  v_lshrrev_b32 v5, 5, v1
  v_and_b32 v6, 31, v1
  s_lshl_b32 s25, s16, 15
  s_add_u32 s25, s25, 32768
  s_lshl_b32 s26, s17, 9
  s_add_u32 s28, s19, s16
  s_cmp_ge_u32 s28, 7
  s_cselect_b32 s20, 7, 0
  s_sub_u32 s28, s28, s20
  s_add_u32 s28, s28, s31
  s_add_u32 s29, s19, s16
  s_add_u32 s29, s29, 4
  s_cmp_ge_u32 s29, 7
  s_cselect_b32 s20, 7, 0
  s_sub_u32 s29, s29, s20
  s_add_u32 s29, s29, s31
  s_lshl_b32 s32, s28, 18
  s_add_u32 s32, s32, s26
  s_lshl_b32 s33, s29, 18
  s_add_u32 s33, s33, s26
  v_xor_b32 v8, v6, v5
  v_lshlrev_b32 v8, 4, v8
  v_lshl_add_u32 v8, v5, 13, v8
  v_xor_b32 v12, 0, v8
  v_xor_b32 v13, 32, v8
  v_add_u32 v13, 15360, v13
  v_xor_b32 v14, 0, v8
  v_add_u32 v14, 30720, v14
  v_xor_b32 v15, 32, v8
  v_add_u32 v15, 46080, v15
  s_add_u32 s20, s16, 0
  s_and_b32 s20, s20, 3
  s_mul_i32 s21, s20, 65600
  s_lshl_b32 s20, s20, 12
  s_add_u32 s48, s20, s25
  s_mov_b32 m0, s48
  v_xor_b32 v16, s21, v12
  buffer_load_dwordx4 v16, s[60:63], s32 offen offset:0 lds
  v_xor_b32 v17, s21, v13
  buffer_load_dwordx4 v17, s[60:63], s32 offen offset:1024 lds
  v_xor_b32 v18, s21, v14
  buffer_load_dwordx4 v18, s[60:63], s32 offen offset:2048 lds
  v_xor_b32 v19, s21, v15
  buffer_load_dwordx4 v19, s[60:63], s32 offen offset:3072 lds
  s_add_u32 s20, s16, 1
  s_and_b32 s20, s20, 3
  s_mul_i32 s21, s20, 65600
  s_lshl_b32 s20, s20, 12
  s_add_u32 s49, s20, s25
  s_mov_b32 m0, s49
  v_xor_b32 v20, s21, v12
  buffer_load_dwordx4 v20, s[60:63], s32 offen offset:0 lds
  v_xor_b32 v21, s21, v13
  buffer_load_dwordx4 v21, s[60:63], s32 offen offset:1024 lds
  v_xor_b32 v22, s21, v14
  buffer_load_dwordx4 v22, s[60:63], s32 offen offset:2048 lds
  v_xor_b32 v23, s21, v15
  buffer_load_dwordx4 v23, s[60:63], s32 offen offset:3072 lds
  s_add_u32 s20, s16, 2
  s_and_b32 s20, s20, 3
  s_mul_i32 s21, s20, 65600
  s_lshl_b32 s20, s20, 12
  s_add_u32 s50, s20, s25
  s_mov_b32 m0, s50
  v_xor_b32 v24, s21, v12
  buffer_load_dwordx4 v24, s[60:63], s32 offen offset:0 lds
  v_xor_b32 v25, s21, v13
  buffer_load_dwordx4 v25, s[60:63], s32 offen offset:1024 lds
  v_xor_b32 v26, s21, v14
  buffer_load_dwordx4 v26, s[60:63], s32 offen offset:2048 lds
  v_xor_b32 v27, s21, v15
  buffer_load_dwordx4 v27, s[60:63], s32 offen offset:3072 lds
  s_add_u32 s20, s16, 3
  s_and_b32 s20, s20, 3
  s_mul_i32 s21, s20, 65600
  s_lshl_b32 s20, s20, 12
  s_add_u32 s51, s20, s25
  s_mov_b32 m0, s51
  v_xor_b32 v28, s21, v12
  buffer_load_dwordx4 v28, s[60:63], s32 offen offset:0 lds
  v_xor_b32 v29, s21, v13
  buffer_load_dwordx4 v29, s[60:63], s32 offen offset:1024 lds
  v_xor_b32 v30, s21, v14
  buffer_load_dwordx4 v30, s[60:63], s32 offen offset:2048 lds
  v_xor_b32 v31, s21, v15
  buffer_load_dwordx4 v31, s[60:63], s32 offen offset:3072 lds
  s_cmp_eq_u32 s16, 3
  s_cbranch_scc1 aj_np1
  s_add_u32 m0, s48, 16384
  s_nop 0
  buffer_load_dwordx4 v16, s[60:63], s33 offen offset:0 lds
  buffer_load_dwordx4 v17, s[60:63], s33 offen offset:1024 lds
  buffer_load_dwordx4 v18, s[60:63], s33 offen offset:2048 lds
  buffer_load_dwordx4 v19, s[60:63], s33 offen offset:3072 lds
  s_add_u32 m0, s49, 16384
  s_nop 0
  buffer_load_dwordx4 v20, s[60:63], s33 offen offset:0 lds
  buffer_load_dwordx4 v21, s[60:63], s33 offen offset:1024 lds
  buffer_load_dwordx4 v22, s[60:63], s33 offen offset:2048 lds
  buffer_load_dwordx4 v23, s[60:63], s33 offen offset:3072 lds
  s_add_u32 m0, s50, 16384
  s_nop 0
  buffer_load_dwordx4 v24, s[60:63], s33 offen offset:0 lds
  buffer_load_dwordx4 v25, s[60:63], s33 offen offset:1024 lds
  buffer_load_dwordx4 v26, s[60:63], s33 offen offset:2048 lds
  buffer_load_dwordx4 v27, s[60:63], s33 offen offset:3072 lds
  s_add_u32 m0, s51, 16384
  s_nop 0
  buffer_load_dwordx4 v28, s[60:63], s33 offen offset:0 lds
  buffer_load_dwordx4 v29, s[60:63], s33 offen offset:1024 lds
  buffer_load_dwordx4 v30, s[60:63], s33 offen offset:2048 lds
  buffer_load_dwordx4 v31, s[60:63], s33 offen offset:3072 lds
aj_np1:
  s_mul_i32 s30, s17, 401408
  s_mul_i32 s20, s19, 57344
  s_add_u32 s30, s30, s20
  v_add_u32 v12, s30, v2
  v_add_u32 v13, 14336, v12
  v_add_u32 v14, 28672, v12
  v_add_u32 v15, 43008, v12
  v_lshrrev_b32 v7, 2, v4
  v_lshlrev_b32 v7, 3, v7
  v_and_b32 v8, 3, v4
  v_add_u32 v7, v7, v8
  v_xor_b32 v10, v3, v4
  v_lshlrev_b32 v10, 4, v10
  v_lshl_add_u32 v10, v7, 9, v10
  v_add_u32 v10, s25, v10
  v_xor_b32 v32, 0, v10
  v_xor_b32 v33, 64, v10
  v_xor_b32 v34, 128, v10
  v_xor_b32 v35, 192, v10
  v_and_b32 v8, 2, v4
  v_lshlrev_b32 v8, 1, v8
  v_and_b32 v9, 1, v4
  v_add_u32 v8, v8, v9
  v_lshrrev_b32 v7, 2, v4
  v_lshl_add_u32 v7, v7, 4, v8
  v_xor_b32 v8, v8, v3
  v_lshlrev_b32 v8, 4, v8
  v_lshl_add_u32 v7, v7, 9, v8
  s_mov_b32 s24, 1035512379
  s_waitcnt vmcnt(32)
  s_cmp_lg_u32 s16, 3
  s_cbranch_scc1 w3_35
  s_waitcnt vmcnt(16)
w3_35:
  s_barrier
  v_xor_b32 v8, 0, v7
  ds_read_b128 v[128:131], v8 offset:0
  v_xor_b32 v9, 64, v7
  ds_read_b128 v[132:135], v9 offset:0
  v_xor_b32 v10, 128, v7
  ds_read_b128 v[136:139], v10 offset:0
  v_xor_b32 v11, 192, v7
  ds_read_b128 v[140:143], v11 offset:0
  ds_read_b128 v[144:147], v8 offset:256
  ds_read_b128 v[148:151], v9 offset:256
  ds_read_b128 v[152:155], v10 offset:256
  ds_read_b128 v[156:159], v11 offset:256
  s_waitcnt lgkmcnt(4)
  v_xor_b32 v8, 32, v7
  ds_read_b128 v[160:163], v8 offset:1024
  v_xor_b32 v9, 96, v7
  ds_read_b128 v[164:167], v9 offset:1024
  v_xor_b32 v10, 160, v7
  ds_read_b128 v[168:171], v10 offset:1024
  v_xor_b32 v11, 224, v7
  ds_read_b128 v[172:175], v11 offset:1024
  ds_read_b128 v[176:179], v8 offset:1280
  ds_read_b128 v[180:183], v9 offset:1280
  ds_read_b128 v[184:187], v10 offset:1280
  ds_read_b128 v[188:191], v11 offset:1280
  s_waitcnt lgkmcnt(4)
  v_xor_b32 v8, 128, v7
  ds_read_b128 v[192:195], v8 offset:4096
  v_xor_b32 v9, 192, v7
  ds_read_b128 v[196:199], v9 offset:4096
  v_xor_b32 v10, 0, v7
  ds_read_b128 v[200:203], v10 offset:4096
  v_xor_b32 v11, 64, v7
  ds_read_b128 v[204:207], v11 offset:4096
  ds_read_b128 v[208:211], v8 offset:4352
  ds_read_b128 v[212:215], v9 offset:4352
  ds_read_b128 v[216:219], v10 offset:4352
  ds_read_b128 v[220:223], v11 offset:4352
  s_waitcnt lgkmcnt(4)
  v_xor_b32 v8, 160, v7
  ds_read_b128 v[224:227], v8 offset:5120
  v_xor_b32 v9, 224, v7
  ds_read_b128 v[228:231], v9 offset:5120
  v_xor_b32 v10, 32, v7
  ds_read_b128 v[232:235], v10 offset:5120
  v_xor_b32 v11, 96, v7
  ds_read_b128 v[236:239], v11 offset:5120
  ds_read_b128 v[240:243], v8 offset:5376
  ds_read_b128 v[244:247], v9 offset:5376
  ds_read_b128 v[248:251], v10 offset:5376
  ds_read_b128 v[252:255], v11 offset:5376
  s_waitcnt lgkmcnt(4)
  s_waitcnt vmcnt(16) lgkmcnt(0)
  s_cmp_lg_u32 s16, 3
  s_cbranch_scc1 w3_36
  s_waitcnt vmcnt(0)
w3_36:
  ds_read_b128 v[52:55], v32 offset:0
  ds_read_b128 v[56:59], v33 offset:0
  ds_read_b128 v[60:63], v34 offset:0
  ds_read_b128 v[64:67], v35 offset:0
  s_waitcnt lgkmcnt(3)
  v_mfma_f32_16x16x32_bf16 v[96:99], v[52:55], v[128:131], 0
  v_mfma_f32_16x16x32_bf16 v[100:103], v[52:55], v[160:163], 0
  v_mfma_f32_16x16x32_bf16 v[104:107], v[52:55], v[192:195], 0
  v_mfma_f32_16x16x32_bf16 v[108:111], v[52:55], v[224:227], 0
  ds_read_b128 v[52:55], v32 offset:256
  s_waitcnt lgkmcnt(3)
  v_mfma_f32_16x16x32_bf16 v[96:99], v[56:59], v[132:135], v[96:99]
  v_mfma_f32_16x16x32_bf16 v[100:103], v[56:59], v[164:167], v[100:103]
  v_mfma_f32_16x16x32_bf16 v[104:107], v[56:59], v[196:199], v[104:107]
  v_mfma_f32_16x16x32_bf16 v[108:111], v[56:59], v[228:231], v[108:111]
  ds_read_b128 v[56:59], v33 offset:256
  s_waitcnt lgkmcnt(3)
  v_mfma_f32_16x16x32_bf16 v[96:99], v[60:63], v[136:139], v[96:99]
  v_mfma_f32_16x16x32_bf16 v[100:103], v[60:63], v[168:171], v[100:103]
  v_mfma_f32_16x16x32_bf16 v[104:107], v[60:63], v[200:203], v[104:107]
  v_mfma_f32_16x16x32_bf16 v[108:111], v[60:63], v[232:235], v[108:111]
  ds_read_b128 v[60:63], v34 offset:256
  s_waitcnt lgkmcnt(3)
  v_mfma_f32_16x16x32_bf16 v[96:99], v[64:67], v[140:143], v[96:99]
  v_mfma_f32_16x16x32_bf16 v[100:103], v[64:67], v[172:175], v[100:103]
  v_mfma_f32_16x16x32_bf16 v[104:107], v[64:67], v[204:207], v[104:107]
  v_mfma_f32_16x16x32_bf16 v[108:111], v[64:67], v[236:239], v[108:111]
  ds_read_b128 v[64:67], v35 offset:256
  s_waitcnt lgkmcnt(3)
  v_mfma_f32_16x16x32_bf16 v[96:99], v[52:55], v[144:147], v[96:99]
  v_mfma_f32_16x16x32_bf16 v[100:103], v[52:55], v[176:179], v[100:103]
  v_mfma_f32_16x16x32_bf16 v[104:107], v[52:55], v[208:211], v[104:107]
  v_mfma_f32_16x16x32_bf16 v[108:111], v[52:55], v[240:243], v[108:111]
  ds_read_b128 v[52:55], v32 offset:2048
  s_waitcnt lgkmcnt(3)
  v_mfma_f32_16x16x32_bf16 v[96:99], v[56:59], v[148:151], v[96:99]
  v_mfma_f32_16x16x32_bf16 v[100:103], v[56:59], v[180:183], v[100:103]
  v_mfma_f32_16x16x32_bf16 v[104:107], v[56:59], v[212:215], v[104:107]
  v_mfma_f32_16x16x32_bf16 v[108:111], v[56:59], v[244:247], v[108:111]
  ds_read_b128 v[56:59], v33 offset:2048
  s_waitcnt lgkmcnt(3)
  v_mfma_f32_16x16x32_bf16 v[96:99], v[60:63], v[152:155], v[96:99]
  v_mfma_f32_16x16x32_bf16 v[100:103], v[60:63], v[184:187], v[100:103]
  v_mfma_f32_16x16x32_bf16 v[104:107], v[60:63], v[216:219], v[104:107]
  v_mfma_f32_16x16x32_bf16 v[108:111], v[60:63], v[248:251], v[108:111]
  ds_read_b128 v[60:63], v34 offset:2048
  s_waitcnt lgkmcnt(3)
  v_mfma_f32_16x16x32_bf16 v[96:99], v[64:67], v[156:159], v[96:99]
  v_mfma_f32_16x16x32_bf16 v[100:103], v[64:67], v[188:191], v[100:103]
  v_mfma_f32_16x16x32_bf16 v[104:107], v[64:67], v[220:223], v[104:107]
  v_mfma_f32_16x16x32_bf16 v[108:111], v[64:67], v[252:255], v[108:111]
  ds_read_b128 v[64:67], v35 offset:2048
  s_waitcnt lgkmcnt(3)
  v_mfma_f32_16x16x32_bf16 v[112:115], v[52:55], v[128:131], 0
  v_mfma_f32_16x16x32_bf16 v[116:119], v[52:55], v[160:163], 0
  v_mfma_f32_16x16x32_bf16 v[120:123], v[52:55], v[192:195], 0
  v_mfma_f32_16x16x32_bf16 v[124:127], v[52:55], v[224:227], 0
  ds_read_b128 v[52:55], v32 offset:2304
  s_waitcnt lgkmcnt(3)
  v_mfma_f32_16x16x32_bf16 v[112:115], v[56:59], v[132:135], v[112:115]
  v_mfma_f32_16x16x32_bf16 v[116:119], v[56:59], v[164:167], v[116:119]
  v_mfma_f32_16x16x32_bf16 v[120:123], v[56:59], v[196:199], v[120:123]
  v_mfma_f32_16x16x32_bf16 v[124:127], v[56:59], v[228:231], v[124:127]
  ds_read_b128 v[56:59], v33 offset:2304
  s_waitcnt lgkmcnt(3)
  v_mfma_f32_16x16x32_bf16 v[112:115], v[60:63], v[136:139], v[112:115]
  v_mfma_f32_16x16x32_bf16 v[116:119], v[60:63], v[168:171], v[116:119]
  v_mfma_f32_16x16x32_bf16 v[120:123], v[60:63], v[200:203], v[120:123]
  v_mfma_f32_16x16x32_bf16 v[124:127], v[60:63], v[232:235], v[124:127]
  ds_read_b128 v[60:63], v34 offset:2304
  s_waitcnt lgkmcnt(3)
  v_mfma_f32_16x16x32_bf16 v[112:115], v[64:67], v[140:143], v[112:115]
  v_mfma_f32_16x16x32_bf16 v[116:119], v[64:67], v[172:175], v[116:119]
  v_mfma_f32_16x16x32_bf16 v[120:123], v[64:67], v[204:207], v[120:123]
  v_mfma_f32_16x16x32_bf16 v[124:127], v[64:67], v[236:239], v[124:127]
  ds_read_b128 v[64:67], v35 offset:2304
  s_waitcnt lgkmcnt(3)
  v_mfma_f32_16x16x32_bf16 v[112:115], v[52:55], v[144:147], v[112:115]
  v_mfma_f32_16x16x32_bf16 v[116:119], v[52:55], v[176:179], v[116:119]
  v_mfma_f32_16x16x32_bf16 v[120:123], v[52:55], v[208:211], v[120:123]
  v_mfma_f32_16x16x32_bf16 v[124:127], v[52:55], v[240:243], v[124:127]
  s_waitcnt lgkmcnt(2)
  v_mfma_f32_16x16x32_bf16 v[112:115], v[56:59], v[148:151], v[112:115]
  v_mfma_f32_16x16x32_bf16 v[116:119], v[56:59], v[180:183], v[116:119]
  v_mfma_f32_16x16x32_bf16 v[120:123], v[56:59], v[212:215], v[120:123]
  v_mfma_f32_16x16x32_bf16 v[124:127], v[56:59], v[244:247], v[124:127]
  s_waitcnt lgkmcnt(1)
  v_mfma_f32_16x16x32_bf16 v[112:115], v[60:63], v[152:155], v[112:115]
  v_mfma_f32_16x16x32_bf16 v[116:119], v[60:63], v[184:187], v[116:119]
  v_mfma_f32_16x16x32_bf16 v[120:123], v[60:63], v[216:219], v[120:123]
  v_mfma_f32_16x16x32_bf16 v[124:127], v[60:63], v[248:251], v[124:127]
  s_waitcnt lgkmcnt(0)
  v_mfma_f32_16x16x32_bf16 v[112:115], v[64:67], v[156:159], v[112:115]
  v_mfma_f32_16x16x32_bf16 v[116:119], v[64:67], v[188:191], v[116:119]
  v_mfma_f32_16x16x32_bf16 v[120:123], v[64:67], v[220:223], v[120:123]
  v_mfma_f32_16x16x32_bf16 v[124:127], v[64:67], v[252:255], v[124:127]
  s_lshl_b32 s30, s28, 10
  v_mul_f32 v96, s24, v96
  v_mul_f32 v97, s24, v97
  v_mul_f32 v98, s24, v98
  v_mul_f32 v99, s24, v99
  v_cvt_pk_bf16_f32 v68, v96, v97
  v_cvt_pk_bf16_f32 v69, v98, v99
  v_mul_f32 v112, s24, v112
  v_mul_f32 v113, s24, v113
  v_mul_f32 v114, s24, v114
  v_mul_f32 v115, s24, v115
  v_cvt_pk_bf16_f32 v70, v112, v113
  v_cvt_pk_bf16_f32 v71, v114, v115
  buffer_store_dwordx4 v[68:71], v12, s[8:11], s30 offen sc1
  v_mul_f32 v100, s24, v100
  v_mul_f32 v101, s24, v101
  v_mul_f32 v102, s24, v102
  v_mul_f32 v103, s24, v103
  v_cvt_pk_bf16_f32 v72, v100, v101
  v_cvt_pk_bf16_f32 v73, v102, v103
  v_mul_f32 v116, s24, v116
  v_mul_f32 v117, s24, v117
  v_mul_f32 v118, s24, v118
  v_mul_f32 v119, s24, v119
  v_cvt_pk_bf16_f32 v74, v116, v117
  v_cvt_pk_bf16_f32 v75, v118, v119
  buffer_store_dwordx4 v[72:75], v13, s[8:11], s30 offen sc1
  v_mul_f32 v104, s24, v104
  v_mul_f32 v105, s24, v105
  v_mul_f32 v106, s24, v106
  v_mul_f32 v107, s24, v107
  v_cvt_pk_bf16_f32 v76, v104, v105
  v_cvt_pk_bf16_f32 v77, v106, v107
  v_mul_f32 v120, s24, v120
  v_mul_f32 v121, s24, v121
  v_mul_f32 v122, s24, v122
  v_mul_f32 v123, s24, v123
  v_cvt_pk_bf16_f32 v78, v120, v121
  v_cvt_pk_bf16_f32 v79, v122, v123
  buffer_store_dwordx4 v[76:79], v14, s[8:11], s30 offen sc1
  v_mul_f32 v108, s24, v108
  v_mul_f32 v109, s24, v109
  v_mul_f32 v110, s24, v110
  v_mul_f32 v111, s24, v111
  v_cvt_pk_bf16_f32 v80, v108, v109
  v_cvt_pk_bf16_f32 v81, v110, v111
  v_mul_f32 v124, s24, v124
  v_mul_f32 v125, s24, v125
  v_mul_f32 v126, s24, v126
  v_mul_f32 v127, s24, v127
  v_cvt_pk_bf16_f32 v82, v124, v125
  v_cvt_pk_bf16_f32 v83, v126, v127
  buffer_store_dwordx4 v[80:83], v15, s[8:11], s30 offen sc1
  s_cmp_eq_u32 s16, 3
  s_cbranch_scc1 aj_w3
  s_waitcnt vmcnt(4)
  ds_read_b128 v[52:55], v32 offset:16384
  ds_read_b128 v[56:59], v33 offset:16384
  ds_read_b128 v[60:63], v34 offset:16384
  ds_read_b128 v[64:67], v35 offset:16384
  s_waitcnt lgkmcnt(3)
  v_mfma_f32_16x16x32_bf16 v[96:99], v[52:55], v[128:131], 0
  v_mfma_f32_16x16x32_bf16 v[100:103], v[52:55], v[160:163], 0
  v_mfma_f32_16x16x32_bf16 v[104:107], v[52:55], v[192:195], 0
  v_mfma_f32_16x16x32_bf16 v[108:111], v[52:55], v[224:227], 0
  ds_read_b128 v[52:55], v32 offset:16640
  s_waitcnt lgkmcnt(3)
  v_mfma_f32_16x16x32_bf16 v[96:99], v[56:59], v[132:135], v[96:99]
  v_mfma_f32_16x16x32_bf16 v[100:103], v[56:59], v[164:167], v[100:103]
  v_mfma_f32_16x16x32_bf16 v[104:107], v[56:59], v[196:199], v[104:107]
  v_mfma_f32_16x16x32_bf16 v[108:111], v[56:59], v[228:231], v[108:111]
  ds_read_b128 v[56:59], v33 offset:16640
  s_waitcnt lgkmcnt(3)
  v_mfma_f32_16x16x32_bf16 v[96:99], v[60:63], v[136:139], v[96:99]
  v_mfma_f32_16x16x32_bf16 v[100:103], v[60:63], v[168:171], v[100:103]
  v_mfma_f32_16x16x32_bf16 v[104:107], v[60:63], v[200:203], v[104:107]
  v_mfma_f32_16x16x32_bf16 v[108:111], v[60:63], v[232:235], v[108:111]
  ds_read_b128 v[60:63], v34 offset:16640
  s_waitcnt lgkmcnt(3)
  v_mfma_f32_16x16x32_bf16 v[96:99], v[64:67], v[140:143], v[96:99]
  v_mfma_f32_16x16x32_bf16 v[100:103], v[64:67], v[172:175], v[100:103]
  v_mfma_f32_16x16x32_bf16 v[104:107], v[64:67], v[204:207], v[104:107]
  v_mfma_f32_16x16x32_bf16 v[108:111], v[64:67], v[236:239], v[108:111]
  ds_read_b128 v[64:67], v35 offset:16640
  s_waitcnt lgkmcnt(3)
  v_mfma_f32_16x16x32_bf16 v[96:99], v[52:55], v[144:147], v[96:99]
  v_mfma_f32_16x16x32_bf16 v[100:103], v[52:55], v[176:179], v[100:103]
  v_mfma_f32_16x16x32_bf16 v[104:107], v[52:55], v[208:211], v[104:107]
  v_mfma_f32_16x16x32_bf16 v[108:111], v[52:55], v[240:243], v[108:111]
  ds_read_b128 v[52:55], v32 offset:18432
  s_waitcnt lgkmcnt(3)
  v_mfma_f32_16x16x32_bf16 v[96:99], v[56:59], v[148:151], v[96:99]
  v_mfma_f32_16x16x32_bf16 v[100:103], v[56:59], v[180:183], v[100:103]
  v_mfma_f32_16x16x32_bf16 v[104:107], v[56:59], v[212:215], v[104:107]
  v_mfma_f32_16x16x32_bf16 v[108:111], v[56:59], v[244:247], v[108:111]
  ds_read_b128 v[56:59], v33 offset:18432
  s_waitcnt lgkmcnt(3)
  v_mfma_f32_16x16x32_bf16 v[96:99], v[60:63], v[152:155], v[96:99]
  v_mfma_f32_16x16x32_bf16 v[100:103], v[60:63], v[184:187], v[100:103]
  v_mfma_f32_16x16x32_bf16 v[104:107], v[60:63], v[216:219], v[104:107]
  v_mfma_f32_16x16x32_bf16 v[108:111], v[60:63], v[248:251], v[108:111]
  ds_read_b128 v[60:63], v34 offset:18432
  s_waitcnt lgkmcnt(3)
  v_mfma_f32_16x16x32_bf16 v[96:99], v[64:67], v[156:159], v[96:99]
  v_mfma_f32_16x16x32_bf16 v[100:103], v[64:67], v[188:191], v[100:103]
  v_mfma_f32_16x16x32_bf16 v[104:107], v[64:67], v[220:223], v[104:107]
  v_mfma_f32_16x16x32_bf16 v[108:111], v[64:67], v[252:255], v[108:111]
  ds_read_b128 v[64:67], v35 offset:18432
  s_waitcnt lgkmcnt(3)
  v_mfma_f32_16x16x32_bf16 v[112:115], v[52:55], v[128:131], 0
  v_mfma_f32_16x16x32_bf16 v[116:119], v[52:55], v[160:163], 0
  v_mfma_f32_16x16x32_bf16 v[120:123], v[52:55], v[192:195], 0
  v_mfma_f32_16x16x32_bf16 v[124:127], v[52:55], v[224:227], 0
  ds_read_b128 v[52:55], v32 offset:18688
  s_waitcnt lgkmcnt(3)
  v_mfma_f32_16x16x32_bf16 v[112:115], v[56:59], v[132:135], v[112:115]
  v_mfma_f32_16x16x32_bf16 v[116:119], v[56:59], v[164:167], v[116:119]
  v_mfma_f32_16x16x32_bf16 v[120:123], v[56:59], v[196:199], v[120:123]
  v_mfma_f32_16x16x32_bf16 v[124:127], v[56:59], v[228:231], v[124:127]
  ds_read_b128 v[56:59], v33 offset:18688
  s_waitcnt lgkmcnt(3)
  v_mfma_f32_16x16x32_bf16 v[112:115], v[60:63], v[136:139], v[112:115]
  v_mfma_f32_16x16x32_bf16 v[116:119], v[60:63], v[168:171], v[116:119]
  v_mfma_f32_16x16x32_bf16 v[120:123], v[60:63], v[200:203], v[120:123]
  v_mfma_f32_16x16x32_bf16 v[124:127], v[60:63], v[232:235], v[124:127]
  ds_read_b128 v[60:63], v34 offset:18688
  s_waitcnt lgkmcnt(3)
  v_mfma_f32_16x16x32_bf16 v[112:115], v[64:67], v[140:143], v[112:115]
  v_mfma_f32_16x16x32_bf16 v[116:119], v[64:67], v[172:175], v[116:119]
  v_mfma_f32_16x16x32_bf16 v[120:123], v[64:67], v[204:207], v[120:123]
  v_mfma_f32_16x16x32_bf16 v[124:127], v[64:67], v[236:239], v[124:127]
  ds_read_b128 v[64:67], v35 offset:18688
  s_waitcnt lgkmcnt(3)
  v_mfma_f32_16x16x32_bf16 v[112:115], v[52:55], v[144:147], v[112:115]
  v_mfma_f32_16x16x32_bf16 v[116:119], v[52:55], v[176:179], v[116:119]
  v_mfma_f32_16x16x32_bf16 v[120:123], v[52:55], v[208:211], v[120:123]
  v_mfma_f32_16x16x32_bf16 v[124:127], v[52:55], v[240:243], v[124:127]
  s_waitcnt lgkmcnt(2)
  v_mfma_f32_16x16x32_bf16 v[112:115], v[56:59], v[148:151], v[112:115]
  v_mfma_f32_16x16x32_bf16 v[116:119], v[56:59], v[180:183], v[116:119]
  v_mfma_f32_16x16x32_bf16 v[120:123], v[56:59], v[212:215], v[120:123]
  v_mfma_f32_16x16x32_bf16 v[124:127], v[56:59], v[244:247], v[124:127]
  s_waitcnt lgkmcnt(1)
  v_mfma_f32_16x16x32_bf16 v[112:115], v[60:63], v[152:155], v[112:115]
  v_mfma_f32_16x16x32_bf16 v[116:119], v[60:63], v[184:187], v[116:119]
  v_mfma_f32_16x16x32_bf16 v[120:123], v[60:63], v[216:219], v[120:123]
  v_mfma_f32_16x16x32_bf16 v[124:127], v[60:63], v[248:251], v[124:127]
  s_waitcnt lgkmcnt(0)
  v_mfma_f32_16x16x32_bf16 v[112:115], v[64:67], v[156:159], v[112:115]
  v_mfma_f32_16x16x32_bf16 v[116:119], v[64:67], v[188:191], v[116:119]
  v_mfma_f32_16x16x32_bf16 v[120:123], v[64:67], v[220:223], v[120:123]
  v_mfma_f32_16x16x32_bf16 v[124:127], v[64:67], v[252:255], v[124:127]
  s_lshl_b32 s30, s29, 10
  v_mul_f32 v96, s24, v96
  v_mul_f32 v97, s24, v97
  v_mul_f32 v98, s24, v98
  v_mul_f32 v99, s24, v99
  v_cvt_pk_bf16_f32 v68, v96, v97
  v_cvt_pk_bf16_f32 v69, v98, v99
  v_mul_f32 v112, s24, v112
  v_mul_f32 v113, s24, v113
  v_mul_f32 v114, s24, v114
  v_mul_f32 v115, s24, v115
  v_cvt_pk_bf16_f32 v70, v112, v113
  v_cvt_pk_bf16_f32 v71, v114, v115
  buffer_store_dwordx4 v[68:71], v12, s[8:11], s30 offen sc1
  v_mul_f32 v100, s24, v100
  v_mul_f32 v101, s24, v101
  v_mul_f32 v102, s24, v102
  v_mul_f32 v103, s24, v103
  v_cvt_pk_bf16_f32 v72, v100, v101
  v_cvt_pk_bf16_f32 v73, v102, v103
  v_mul_f32 v116, s24, v116
  v_mul_f32 v117, s24, v117
  v_mul_f32 v118, s24, v118
  v_mul_f32 v119, s24, v119
  v_cvt_pk_bf16_f32 v74, v116, v117
  v_cvt_pk_bf16_f32 v75, v118, v119
  buffer_store_dwordx4 v[72:75], v13, s[8:11], s30 offen sc1
  v_mul_f32 v104, s24, v104
  v_mul_f32 v105, s24, v105
  v_mul_f32 v106, s24, v106
  v_mul_f32 v107, s24, v107
  v_cvt_pk_bf16_f32 v76, v104, v105
  v_cvt_pk_bf16_f32 v77, v106, v107
  v_mul_f32 v120, s24, v120
  v_mul_f32 v121, s24, v121
  v_mul_f32 v122, s24, v122
  v_mul_f32 v123, s24, v123
  v_cvt_pk_bf16_f32 v78, v120, v121
  v_cvt_pk_bf16_f32 v79, v122, v123
  buffer_store_dwordx4 v[76:79], v14, s[8:11], s30 offen sc1
  v_mul_f32 v108, s24, v108
  v_mul_f32 v109, s24, v109
  v_mul_f32 v110, s24, v110
  v_mul_f32 v111, s24, v111
  v_cvt_pk_bf16_f32 v80, v108, v109
  v_cvt_pk_bf16_f32 v81, v110, v111
  v_mul_f32 v124, s24, v124
  v_mul_f32 v125, s24, v125
  v_mul_f32 v126, s24, v126
  v_mul_f32 v127, s24, v127
  v_cvt_pk_bf16_f32 v82, v124, v125
  v_cvt_pk_bf16_f32 v83, v126, v127
  buffer_store_dwordx4 v[80:83], v15, s[8:11], s30 offen sc1
aj_w3:
  s_lshl_b32 s28, s17, 7
  s_lshl_b32 s21, s19, 4
  s_add_u32 s28, s28, s21
  s_cmp_lg_u32 s31, 0
  s_cselect_b32 s21, 8, 0
  s_add_u32 s28, s28, s21
  s_add_u32 s28, s28, 88621056
  s_waitcnt vmcnt(0)
  s_barrier
  s_cmp_lg_u32 s16, 0
  s_cbranch_scc1 pub_37
  v_mul_u32_u24 v26, 2048, v1
  v_mov_b32 v24, s88
  v_mov_b32 v25, s89
  s_mov_b64 exec, 1
  buffer_store_dwordx2 v[24:25], v26, s[8:11], s28 offen sc1
  s_mov_b64 exec, -1
pub_37:
  v_mov_b32 v250, 0
  s_branch wk_loop
wk_srv:
  s_sub_u32 s3, s3, 336
  s_and_b32 s18, s3, 15
  s_lshr_b32 s19, s3, 4
  s_and_b32 s19, s19, 1
  s_mul_i32 s20, s18, 401408
  s_mul_i32 s21, s16, 100352
  s_add_u32 s20, s20, s21
  s_add_u32 s20, s20, 6422528
  s_add_u32 s22, s20, 0
  buffer_load_dwordx4 a[0:3], v2, s[8:11], s22 offen offset:0 sc1
  buffer_load_dwordx4 a[4:7], v2, s[8:11], s22 offen offset:1024 sc1
  buffer_load_dwordx4 a[8:11], v2, s[8:11], s22 offen offset:2048 sc1
  buffer_load_dwordx4 a[12:15], v2, s[8:11], s22 offen offset:3072 sc1
  s_add_u32 s22, s20, 4096
  buffer_load_dwordx4 a[16:19], v2, s[8:11], s22 offen offset:0 sc1
  buffer_load_dwordx4 a[20:23], v2, s[8:11], s22 offen offset:1024 sc1
  buffer_load_dwordx4 a[24:27], v2, s[8:11], s22 offen offset:2048 sc1
  buffer_load_dwordx4 a[28:31], v2, s[8:11], s22 offen offset:3072 sc1
  s_add_u32 s22, s20, 8192
  buffer_load_dwordx4 a[32:35], v2, s[8:11], s22 offen offset:0 sc1
  buffer_load_dwordx4 a[36:39], v2, s[8:11], s22 offen offset:1024 sc1
  buffer_load_dwordx4 a[40:43], v2, s[8:11], s22 offen offset:2048 sc1
  buffer_load_dwordx4 a[44:47], v2, s[8:11], s22 offen offset:3072 sc1
  s_add_u32 s22, s20, 12288
  buffer_load_dwordx4 a[48:51], v2, s[8:11], s22 offen offset:0 sc1
  buffer_load_dwordx4 a[52:55], v2, s[8:11], s22 offen offset:1024 sc1
  buffer_load_dwordx4 a[56:59], v2, s[8:11], s22 offen offset:2048 sc1
  buffer_load_dwordx4 a[60:63], v2, s[8:11], s22 offen offset:3072 sc1
  s_add_u32 s22, s20, 16384
  buffer_load_dwordx4 a[64:67], v2, s[8:11], s22 offen offset:0 sc1
  buffer_load_dwordx4 a[68:71], v2, s[8:11], s22 offen offset:1024 sc1
  buffer_load_dwordx4 a[72:75], v2, s[8:11], s22 offen offset:2048 sc1
  buffer_load_dwordx4 a[76:79], v2, s[8:11], s22 offen offset:3072 sc1
  s_add_u32 s22, s20, 20480
  buffer_load_dwordx4 a[80:83], v2, s[8:11], s22 offen offset:0 sc1
  buffer_load_dwordx4 a[84:87], v2, s[8:11], s22 offen offset:1024 sc1
  buffer_load_dwordx4 a[88:91], v2, s[8:11], s22 offen offset:2048 sc1
  buffer_load_dwordx4 a[92:95], v2, s[8:11], s22 offen offset:3072 sc1
  s_add_u32 s22, s20, 24576
  buffer_load_dwordx4 a[96:99], v2, s[8:11], s22 offen offset:0 sc1
  buffer_load_dwordx4 a[100:103], v2, s[8:11], s22 offen offset:1024 sc1
  buffer_load_dwordx4 a[104:107], v2, s[8:11], s22 offen offset:2048 sc1
  buffer_load_dwordx4 a[108:111], v2, s[8:11], s22 offen offset:3072 sc1
  s_add_u32 s22, s20, 28672
  buffer_load_dwordx4 a[112:115], v2, s[8:11], s22 offen offset:0 sc1
  buffer_load_dwordx4 a[116:119], v2, s[8:11], s22 offen offset:1024 sc1
  buffer_load_dwordx4 a[120:123], v2, s[8:11], s22 offen offset:2048 sc1
  buffer_load_dwordx4 a[124:127], v2, s[8:11], s22 offen offset:3072 sc1
  s_waitcnt vmcnt(24)
  s_add_u32 s22, s20, 32768
  buffer_load_dwordx4 a[128:131], v2, s[8:11], s22 offen offset:0 sc1
  buffer_load_dwordx4 a[132:135], v2, s[8:11], s22 offen offset:1024 sc1
  buffer_load_dwordx4 a[136:139], v2, s[8:11], s22 offen offset:2048 sc1
  buffer_load_dwordx4 a[140:143], v2, s[8:11], s22 offen offset:3072 sc1
  s_add_u32 s22, s20, 36864
  buffer_load_dwordx4 a[144:147], v2, s[8:11], s22 offen offset:0 sc1
  buffer_load_dwordx4 a[148:151], v2, s[8:11], s22 offen offset:1024 sc1
  buffer_load_dwordx4 a[152:155], v2, s[8:11], s22 offen offset:2048 sc1
  buffer_load_dwordx4 a[156:159], v2, s[8:11], s22 offen offset:3072 sc1
  s_add_u32 s22, s20, 40960
  buffer_load_dwordx4 a[160:163], v2, s[8:11], s22 offen offset:0 sc1
  buffer_load_dwordx4 a[164:167], v2, s[8:11], s22 offen offset:1024 sc1
  buffer_load_dwordx4 a[168:171], v2, s[8:11], s22 offen offset:2048 sc1
  buffer_load_dwordx4 a[172:175], v2, s[8:11], s22 offen offset:3072 sc1
  s_add_u32 s22, s20, 45056
  buffer_load_dwordx4 a[176:179], v2, s[8:11], s22 offen offset:0 sc1
  buffer_load_dwordx4 a[180:183], v2, s[8:11], s22 offen offset:1024 sc1
  buffer_load_dwordx4 a[184:187], v2, s[8:11], s22 offen offset:2048 sc1
  buffer_load_dwordx4 a[188:191], v2, s[8:11], s22 offen offset:3072 sc1
  s_add_u32 s22, s20, 49152
  buffer_load_dwordx4 a[192:195], v2, s[8:11], s22 offen offset:0 sc1
  buffer_load_dwordx4 a[196:199], v2, s[8:11], s22 offen offset:1024 sc1
  buffer_load_dwordx4 a[200:203], v2, s[8:11], s22 offen offset:2048 sc1
  buffer_load_dwordx4 a[204:207], v2, s[8:11], s22 offen offset:3072 sc1
  s_add_u32 s22, s20, 53248
  buffer_load_dwordx4 a[208:211], v2, s[8:11], s22 offen offset:0 sc1
  buffer_load_dwordx4 a[212:215], v2, s[8:11], s22 offen offset:1024 sc1
  buffer_load_dwordx4 a[216:219], v2, s[8:11], s22 offen offset:2048 sc1
  buffer_load_dwordx4 a[220:223], v2, s[8:11], s22 offen offset:3072 sc1
  s_add_u32 s22, s20, 57344
  buffer_load_dwordx4 a[224:227], v2, s[8:11], s22 offen offset:0 sc1
  buffer_load_dwordx4 a[228:231], v2, s[8:11], s22 offen offset:1024 sc1
  buffer_load_dwordx4 a[232:235], v2, s[8:11], s22 offen offset:2048 sc1
  buffer_load_dwordx4 a[236:239], v2, s[8:11], s22 offen offset:3072 sc1
  s_add_u32 s22, s20, 61440
  buffer_load_dwordx4 a[240:243], v2, s[8:11], s22 offen offset:0 sc1
  buffer_load_dwordx4 a[244:247], v2, s[8:11], s22 offen offset:1024 sc1
  buffer_load_dwordx4 a[248:251], v2, s[8:11], s22 offen offset:2048 sc1
  buffer_load_dwordx4 a[252:255], v2, s[8:11], s22 offen offset:3072 sc1
  s_waitcnt vmcnt(24)
  s_add_u32 s22, s20, 65536
  buffer_load_dwordx4 v[120:123], v2, s[8:11], s22 offen offset:0 sc1
  buffer_load_dwordx4 v[124:127], v2, s[8:11], s22 offen offset:1024 sc1
  buffer_load_dwordx4 v[128:131], v2, s[8:11], s22 offen offset:2048 sc1
  buffer_load_dwordx4 v[132:135], v2, s[8:11], s22 offen offset:3072 sc1
  s_add_u32 s22, s20, 69632
  buffer_load_dwordx4 v[136:139], v2, s[8:11], s22 offen offset:0 sc1
  buffer_load_dwordx4 v[140:143], v2, s[8:11], s22 offen offset:1024 sc1
  buffer_load_dwordx4 v[144:147], v2, s[8:11], s22 offen offset:2048 sc1
  buffer_load_dwordx4 v[148:151], v2, s[8:11], s22 offen offset:3072 sc1
  s_add_u32 s22, s20, 73728
  buffer_load_dwordx4 v[152:155], v2, s[8:11], s22 offen offset:0 sc1
  buffer_load_dwordx4 v[156:159], v2, s[8:11], s22 offen offset:1024 sc1
  buffer_load_dwordx4 v[160:163], v2, s[8:11], s22 offen offset:2048 sc1
  buffer_load_dwordx4 v[164:167], v2, s[8:11], s22 offen offset:3072 sc1
  s_add_u32 s22, s20, 77824
  buffer_load_dwordx4 v[168:171], v2, s[8:11], s22 offen offset:0 sc1
  buffer_load_dwordx4 v[172:175], v2, s[8:11], s22 offen offset:1024 sc1
  buffer_load_dwordx4 v[176:179], v2, s[8:11], s22 offen offset:2048 sc1
  buffer_load_dwordx4 v[180:183], v2, s[8:11], s22 offen offset:3072 sc1
  s_add_u32 s22, s20, 81920
  buffer_load_dwordx4 v[184:187], v2, s[8:11], s22 offen offset:0 sc1
  buffer_load_dwordx4 v[188:191], v2, s[8:11], s22 offen offset:1024 sc1
  buffer_load_dwordx4 v[192:195], v2, s[8:11], s22 offen offset:2048 sc1
  buffer_load_dwordx4 v[196:199], v2, s[8:11], s22 offen offset:3072 sc1
  s_add_u32 s22, s20, 86016
  buffer_load_dwordx4 v[200:203], v2, s[8:11], s22 offen offset:0 sc1
  buffer_load_dwordx4 v[204:207], v2, s[8:11], s22 offen offset:1024 sc1
  buffer_load_dwordx4 v[208:211], v2, s[8:11], s22 offen offset:2048 sc1
  buffer_load_dwordx4 v[212:215], v2, s[8:11], s22 offen offset:3072 sc1
  s_add_u32 s22, s20, 90112
  buffer_load_dwordx4 v[216:219], v2, s[8:11], s22 offen offset:0 sc1
  buffer_load_dwordx4 v[220:223], v2, s[8:11], s22 offen offset:1024 sc1
  buffer_load_dwordx4 v[224:227], v2, s[8:11], s22 offen offset:2048 sc1
  buffer_load_dwordx4 v[228:231], v2, s[8:11], s22 offen offset:3072 sc1
  s_add_u32 s22, s20, 94208
  buffer_load_dwordx4 v[232:235], v2, s[8:11], s22 offen offset:0 sc1
  buffer_load_dwordx4 v[236:239], v2, s[8:11], s22 offen offset:1024 sc1
  buffer_load_dwordx4 v[240:243], v2, s[8:11], s22 offen offset:2048 sc1
  buffer_load_dwordx4 v[244:247], v2, s[8:11], s22 offen offset:3072 sc1
  s_waitcnt vmcnt(24)
  s_add_u32 s22, s20, 98304
  buffer_load_dwordx4 v[248:251], v2, s[8:11], s22 offen offset:0 sc1
  buffer_load_dwordx4 v[252:255], v2, s[8:11], s22 offen offset:1024 sc1
  v_mov_b32 v5, 0x4444
  v_mov_b32 v6, 0xeeee
  v_cmp_lt_u32 vcc, 7, v4
  s_nop 1
  v_cndmask_b32 v5, v5, v6, vcc
  s_lshl_b32 s23, s16, 11
  v_lshrrev_b32 v80, 1, v3
  v_and_b32 v81, 1, v3
  v_add_u32 v82, 0, v80
  v_lshl_add_u32 v82, v82, 4, v4
  v_mul_u32_u24 v83, 2341, v82
  v_lshrrev_b32 v83, 16, v83
  v_mul_u32_u24 v84, 28, v83
  v_sub_u32 v84, v82, v84
  v_lshrrev_b32 v85, 4, v84
  v_and_b32 v84, 15, v84
  v_lshlrev_b32 v86, 10, v85
  v_lshl_add_u32 v86, v83, 8, v86
  v_lshl_add_u32 v86, v84, 4, v86
  v_lshl_add_u32 v86, v81, 3, v86
  v_add_u32 v72, s23, v86
  v_add_u32 v82, 2, v80
  v_lshl_add_u32 v82, v82, 4, v4
  v_mul_u32_u24 v83, 2341, v82
  v_lshrrev_b32 v83, 16, v83
  v_mul_u32_u24 v84, 28, v83
  v_sub_u32 v84, v82, v84
  v_lshrrev_b32 v85, 4, v84
  v_and_b32 v84, 15, v84
  v_lshlrev_b32 v86, 10, v85
  v_lshl_add_u32 v86, v83, 8, v86
  v_lshl_add_u32 v86, v84, 4, v86
  v_lshl_add_u32 v86, v81, 3, v86
  v_add_u32 v73, s23, v86
  v_add_u32 v82, 4, v80
  v_lshl_add_u32 v82, v82, 4, v4
  v_mul_u32_u24 v83, 2341, v82
  v_lshrrev_b32 v83, 16, v83
  v_mul_u32_u24 v84, 28, v83
  v_sub_u32 v84, v82, v84
  v_lshrrev_b32 v85, 4, v84
  v_and_b32 v84, 15, v84
  v_lshlrev_b32 v86, 10, v85
  v_lshl_add_u32 v86, v83, 8, v86
  v_lshl_add_u32 v86, v84, 4, v86
  v_lshl_add_u32 v86, v81, 3, v86
  v_add_u32 v74, s23, v86
  v_mov_b32 v82, 6
  v_lshl_add_u32 v82, v82, 4, v4
  v_mul_u32_u24 v83, 2341, v82
  v_lshrrev_b32 v83, 16, v83
  v_mul_u32_u24 v84, 28, v83
  v_sub_u32 v84, v82, v84
  v_lshrrev_b32 v85, 4, v84
  v_and_b32 v84, 15, v84
  v_lshlrev_b32 v86, 10, v85
  v_lshl_add_u32 v86, v83, 8, v86
  v_lshl_add_u32 v86, v84, 4, v86
  v_lshl_add_u32 v86, v81, 3, v86
  v_add_u32 v75, s23, v86
  v_add_u32 v76, s23, v2
  s_mul_i32 s27, s18, 448
  v_mov_b32 v77, s27
  v_mov_b32 v78, 1
  s_mov_b32 s17, s19
  s_mul_i32 s24, s19, 7168
  s_add_u32 s24, s24, 88068096
  s_mul_i32 s25, s18, 65
  s_add_u32 s25, s25, s19
  s_lshl_b32 s25, s25, 13
  s_add_u32 s25, s25, s23
  s_add_u32 s25, s25, 76935168
  s_lshl_b32 s26, s18, 6
  s_add_u32 s26, s26, s19
  s_lshl_b32 s26, s26, 4
  s_lshl_b32 s27, s16, 2
  s_add_u32 s26, s26, s27
  s_add_u32 s26, s26, 88569856
ws_loop:
  v_mov_b32 v36, 0
  v_mov_b32 v37, 0
  v_mov_b32 v38, 0
  v_mov_b32 v39, 0
  v_mov_b32 v40, 0
  v_mov_b32 v41, 0
  v_mov_b32 v42, 0
  v_mov_b32 v43, 0
  v_mov_b32 v44, 0
  v_mov_b32 v45, 0
  v_mov_b32 v46, 0
  v_mov_b32 v47, 0
  v_mov_b32 v48, 0
  v_mov_b32 v49, 0
  v_mov_b32 v50, 0
  v_mov_b32 v51, 0
  v_mov_b32 v52, 0
  v_mov_b32 v53, 0
  v_mov_b32 v54, 0
  v_mov_b32 v55, 0
  v_mov_b32 v56, 0
  v_mov_b32 v57, 0
  v_mov_b32 v58, 0
  v_mov_b32 v59, 0
  v_mov_b32 v60, 0
  v_mov_b32 v61, 0
  v_mov_b32 v62, 0
  v_mov_b32 v63, 0
  s_mov_b32 s30, 0
ws_pm:
  s_cmp_ge_u32 s17, 61
  s_cbranch_scc1 mp_38a
  v_mov_b32 v79, 0
  s_mov_b64 exec, 1
  buffer_atomic_or v79, v77, s[8:11], s24 offen sc0
  s_mov_b64 exec, -1
  s_branch mp_38b
mp_38a:
  buffer_load_dword v79, v77, s[8:11], s24 offen sc1
mp_38b:
  s_waitcnt vmcnt(0)
  v_cmp_eq_u32 vcc, -1, v79
  s_cbranch_vccnz ws_pr
ws_fl:
  s_add_u32 s22, s24, 4096
  buffer_load_dwordx4 v[8:11], v2, s[8:11], s24 offen offset:0 sc1
  buffer_load_dwordx4 v[12:15], v2, s[8:11], s24 offen offset:1024 sc1
  buffer_load_dwordx4 v[16:19], v2, s[8:11], s24 offen offset:2048 sc1
  buffer_load_dwordx4 v[20:23], v2, s[8:11], s24 offen offset:3072 sc1
  buffer_load_dwordx4 v[24:27], v2, s[8:11], s22 offen offset:0 sc1
  buffer_load_dwordx4 v[28:31], v2, s[8:11], s22 offen offset:1024 sc1
  buffer_load_dwordx4 v[32:35], v2, s[8:11], s22 offen offset:2048 sc1
  s_waitcnt vmcnt(0)
  v_max_u32 v79, v8, v9
  v_max3_u32 v79, v79, v10, v11
  v_max3_u32 v79, v79, v12, v13
  v_max3_u32 v79, v79, v14, v15
  v_max3_u32 v79, v79, v16, v17
  v_max3_u32 v79, v79, v18, v19
  v_max3_u32 v79, v79, v20, v21
  v_max3_u32 v79, v79, v22, v23
  v_max3_u32 v79, v79, v24, v25
  v_max3_u32 v79, v79, v26, v27
  v_max3_u32 v79, v79, v28, v29
  v_max3_u32 v79, v79, v30, v31
  v_max3_u32 v79, v79, v32, v33
  v_max3_u32 v79, v79, v34, v35
  v_cmp_eq_u32 vcc, -1, v79
  s_cbranch_vccz ws_pk
ws_pr:
  s_sleep 1
  s_cmp_ge_u32 s17, 61
  s_cbranch_scc1 ws_sh
  s_sleep 6
ws_sh:
  s_add_u32 s30, s30, 1
  s_cmp_lt_u32 s30, 30000
  s_cbranch_scc1 ws_pm
  s_branch cA_abort
ws_pk:
  v_smfmac_f32_16x16x64_bf16 v[36:39], v[8:11], a[0:7], v5
  v_smfmac_f32_16x16x64_bf16 v[36:39], v[12:15], a[8:15], v5
  v_smfmac_f32_16x16x64_bf16 v[36:39], v[16:19], a[16:23], v5
  v_smfmac_f32_16x16x64_bf16 v[36:39], v[20:23], a[24:31], v5
  v_smfmac_f32_16x16x64_bf16 v[36:39], v[24:27], a[32:39], v5
  v_smfmac_f32_16x16x64_bf16 v[36:39], v[28:31], a[40:47], v5
  v_smfmac_f32_16x16x64_bf16 v[36:39], v[32:35], a[48:55], v5
  v_smfmac_f32_16x16x64_bf16 v[40:43], v[8:11], a[56:63], v5
  v_smfmac_f32_16x16x64_bf16 v[40:43], v[12:15], a[64:71], v5
  v_smfmac_f32_16x16x64_bf16 v[40:43], v[16:19], a[72:79], v5
  v_smfmac_f32_16x16x64_bf16 v[40:43], v[20:23], a[80:87], v5
  v_smfmac_f32_16x16x64_bf16 v[40:43], v[24:27], a[88:95], v5
  v_smfmac_f32_16x16x64_bf16 v[40:43], v[28:31], a[96:103], v5
  v_smfmac_f32_16x16x64_bf16 v[40:43], v[32:35], a[104:111], v5
  v_smfmac_f32_16x16x64_bf16 v[44:47], v[8:11], a[112:119], v5
  v_smfmac_f32_16x16x64_bf16 v[44:47], v[12:15], a[120:127], v5
  v_smfmac_f32_16x16x64_bf16 v[44:47], v[16:19], a[128:135], v5
  v_smfmac_f32_16x16x64_bf16 v[44:47], v[20:23], a[136:143], v5
  v_smfmac_f32_16x16x64_bf16 v[44:47], v[24:27], a[144:151], v5
  v_smfmac_f32_16x16x64_bf16 v[44:47], v[28:31], a[152:159], v5
  v_smfmac_f32_16x16x64_bf16 v[44:47], v[32:35], a[160:167], v5
  v_smfmac_f32_16x16x64_bf16 v[48:51], v[8:11], a[168:175], v5
  v_smfmac_f32_16x16x64_bf16 v[48:51], v[12:15], a[176:183], v5
  v_smfmac_f32_16x16x64_bf16 v[48:51], v[16:19], a[184:191], v5
  v_smfmac_f32_16x16x64_bf16 v[48:51], v[20:23], a[192:199], v5
  v_smfmac_f32_16x16x64_bf16 v[48:51], v[24:27], a[200:207], v5
  v_smfmac_f32_16x16x64_bf16 v[48:51], v[28:31], a[208:215], v5
  v_smfmac_f32_16x16x64_bf16 v[48:51], v[32:35], a[216:223], v5
  v_smfmac_f32_16x16x64_bf16 v[52:55], v[8:11], a[224:231], v5
  v_smfmac_f32_16x16x64_bf16 v[52:55], v[12:15], a[232:239], v5
  v_smfmac_f32_16x16x64_bf16 v[52:55], v[16:19], a[240:247], v5
  v_smfmac_f32_16x16x64_bf16 v[52:55], v[20:23], a[248:255], v5
  v_smfmac_f32_16x16x64_bf16 v[52:55], v[24:27], v[120:127], v5
  v_smfmac_f32_16x16x64_bf16 v[52:55], v[28:31], v[128:135], v5
  v_smfmac_f32_16x16x64_bf16 v[52:55], v[32:35], v[136:143], v5
  v_smfmac_f32_16x16x64_bf16 v[56:59], v[8:11], v[144:151], v5
  v_smfmac_f32_16x16x64_bf16 v[56:59], v[12:15], v[152:159], v5
  v_smfmac_f32_16x16x64_bf16 v[56:59], v[16:19], v[160:167], v5
  v_smfmac_f32_16x16x64_bf16 v[56:59], v[20:23], v[168:175], v5
  v_smfmac_f32_16x16x64_bf16 v[56:59], v[24:27], v[176:183], v5
  v_smfmac_f32_16x16x64_bf16 v[56:59], v[28:31], v[184:191], v5
  v_smfmac_f32_16x16x64_bf16 v[56:59], v[32:35], v[192:199], v5
  v_smfmac_f32_16x16x64_bf16 v[60:63], v[8:11], v[200:207], v5
  v_smfmac_f32_16x16x64_bf16 v[60:63], v[12:15], v[208:215], v5
  v_smfmac_f32_16x16x64_bf16 v[60:63], v[16:19], v[216:223], v5
  v_smfmac_f32_16x16x64_bf16 v[60:63], v[20:23], v[224:231], v5
  v_smfmac_f32_16x16x64_bf16 v[60:63], v[24:27], v[232:239], v5
  v_smfmac_f32_16x16x64_bf16 v[60:63], v[28:31], v[240:247], v5
  v_smfmac_f32_16x16x64_bf16 v[60:63], v[32:35], v[248:255], v5
  v_permlane32_swap_b32 v36, v40
  v_permlane32_swap_b32 v37, v41
  v_permlane32_swap_b32 v38, v42
  v_permlane32_swap_b32 v39, v43
  v_add_f32 v36, v36, v40
  v_add_f32 v37, v37, v41
  v_add_f32 v38, v38, v42
  v_add_f32 v39, v39, v43
  v_cvt_pk_bf16_f32 v40, v36, v37
  v_cvt_pk_bf16_f32 v41, v38, v39
  ds_write_b64 v72, v[40:41]
  v_permlane32_swap_b32 v44, v48
  v_permlane32_swap_b32 v45, v49
  v_permlane32_swap_b32 v46, v50
  v_permlane32_swap_b32 v47, v51
  v_add_f32 v44, v44, v48
  v_add_f32 v45, v45, v49
  v_add_f32 v46, v46, v50
  v_add_f32 v47, v47, v51
  v_cvt_pk_bf16_f32 v48, v44, v45
  v_cvt_pk_bf16_f32 v49, v46, v47
  ds_write_b64 v73, v[48:49]
  v_permlane32_swap_b32 v52, v56
  v_permlane32_swap_b32 v53, v57
  v_permlane32_swap_b32 v54, v58
  v_permlane32_swap_b32 v55, v59
  v_add_f32 v52, v52, v56
  v_add_f32 v53, v53, v57
  v_add_f32 v54, v54, v58
  v_add_f32 v55, v55, v59
  v_cvt_pk_bf16_f32 v56, v52, v53
  v_cvt_pk_bf16_f32 v57, v54, v55
  ds_write_b64 v74, v[56:57]
  v_mov_b32 v64, v60
  v_mov_b32 v65, v61
  v_mov_b32 v66, v62
  v_mov_b32 v67, v63
  v_permlane32_swap_b32 v60, v64
  v_permlane32_swap_b32 v61, v65
  v_permlane32_swap_b32 v62, v66
  v_permlane32_swap_b32 v63, v67
  v_add_f32 v60, v60, v64
  v_add_f32 v61, v61, v65
  v_add_f32 v62, v62, v66
  v_add_f32 v63, v63, v67
  v_cvt_pk_bf16_f32 v64, v60, v61
  v_cvt_pk_bf16_f32 v65, v62, v63
  ds_write_b64 v75, v[64:65]
  s_waitcnt lgkmcnt(0)
  ds_read_b128 v[64:67], v76
  ds_read_b128 v[68:71], v76 offset:1024
  s_waitcnt lgkmcnt(0)
  buffer_store_dwordx4 v[64:67], v2, s[8:11], s25 offen sc1
  buffer_store_dwordx4 v[68:71], v2, s[8:11], s25 offen offset:1024 sc1
  s_waitcnt vmcnt(0)
  s_mov_b64 exec, 1
  buffer_store_dword v78, v2, s[8:11], s26 offen sc1
  s_mov_b64 exec, -1
  s_add_u32 s24, s24, 14336
  s_add_u32 s25, s25, 16384
  s_add_u32 s26, s26, 32
  s_add_u32 s17, s17, 2
  s_cmp_lt_u32 s17, 64
  s_cbranch_scc1 ws_loop
  v_mov_b32 v250, 0
  s_branch wk_loop
wk_s4d:
  s_cmp_lg_u32 s16, 0
  s_cbranch_scc1 w0_39
  s_getreg_b32 s20, hwreg(HW_REG_XCC_ID)
  s_sub_u32 s20, s20, 1
  s_and_b32 s20, s20, 7
  s_mov_b64 exec, 1
s4_l:
  s_cmp_ge_u32 s20, 7
  s_cselect_b32 s20, 0, s20
  s_lshl_b32 s21, s20, 7
  s_add_u32 s21, s21, 88586240
  v_mov_b32 v242, 1
  buffer_atomic_add v242, off, s[8:11], s21 sc0
  s_waitcnt vmcnt(0)
  v_readfirstlane_b32 s21, v242
  s_lshl_b32 s22, s20, 4
  s_add_u32 s20, s20, 1
  s_cmp_ge_u32 s21, 16
  s_cbranch_scc1 s4_l
  v_add_u32 v242, s22, v242
  s_mov_b64 exec, -1
w0_39:
  v_mov_b32 v243, 160000
  s_add_u32 s101, s101, 1
  s_barrier
  s_mov_b64 exec, 1
  s_cmp_lg_u32 s16, 0
  s_cbranch_scc1 w0_40
  ds_write_b32 v243, v242 offset:0
  s_waitcnt lgkmcnt(0)
  v_mov_b32 v242, s101
  ds_write_b32 v243, v242 offset:16
  s_waitcnt lgkmcnt(0)
w0_40:
  s_mov_b64 exec, -1
  s_barrier
  ds_read_b32 v242, v243 offset:0
  ds_read_b32 v243, v243 offset:16
  s_waitcnt lgkmcnt(0)
  v_readfirstlane_b32 s3, v242
  v_cmp_ne_u32 vcc, s101, v243
  s_cbranch_vccnz ch_end
  s_load_dwordx8 s[40:47], s[0:1], 0
  s_load_dwordx4 s[48:51], s[0:1], 32
  s_load_dwordx2 s[52:53], s[0:1], 48
  s_load_dwordx2 s[54:55], s[0:1], 112
  v_lshrrev_b32 v1, 6, v0
  s_nop 0
  v_readfirstlane_b32 s16, v1
  v_and_b32 v1, 63, v0
  v_lshrrev_b32 v3, 4, v1
  v_and_b32 v4, 15, v1
  s_mul_i32 s17, s16, 24576
  s_waitcnt lgkmcnt(0)
  s_mov_b32 s60, s40
  s_and_b32 s61, s41, 0xffff
  s_mov_b32 s62, 1835008
  s_mov_b32 s63, 0x20000
  s_mov_b32 s64, s42
  s_and_b32 s65, s43, 0xffff
  s_mov_b32 s66, 229376
  s_mov_b32 s67, 0x20000
  s_mov_b32 s68, s44
  s_and_b32 s69, s45, 0xffff
  s_mov_b32 s70, 229376
  s_mov_b32 s71, 0x20000
  s_mov_b32 s72, s46
  s_and_b32 s73, s47, 0xffff
  s_mov_b32 s74, 229376
  s_mov_b32 s75, 0x20000
  s_mov_b32 s76, s48
  s_and_b32 s77, s49, 0xffff
  s_mov_b32 s78, 229376
  s_mov_b32 s79, 0x20000
  s_mov_b32 s80, s50
  s_and_b32 s81, s51, 0xffff
  s_mov_b32 s82, 896
  s_mov_b32 s83, 0x20000
  s_mov_b32 s84, s52
  s_and_b32 s85, s53, 0xffff
  s_mov_b32 s86, 896
  s_mov_b32 s87, 0x20000
  s_mov_b32 s92, s54
  s_and_b32 s93, s55, 0xffff
  s_mov_b32 s94, 3670016
  s_mov_b32 s95, 0x20000
  v_lshlrev_b32 v5, 5, v1
  v_sub_u32 v5, 2047, v5
  s_add_u32 s18, s17, 13056
  v_subrev_u32 v6, 0, v5
  v_max_i32 v7, 0, v6
  v_cvt_f32_u32 v7, v7
  v_cvt_pk_bf16_f32 v8, v7, v7
  v_and_b32 v7, 0xffff0000, v8
  v_lshrrev_b32 v8, 23, v7
  v_subrev_u32 v8, 134, v8
  v_max_i32 v8, 0, v8
  v_cvt_u32_f32 v7, v7
  v_lshrrev_b32 v7, v8, v7
  v_lshl_add_u32 v7, v8, 8, v7
  v_lshl_add_u32 v200, v7, 2, s18
  v_subrev_u32 v6, 1, v5
  v_max_i32 v7, 0, v6
  v_cvt_f32_u32 v7, v7
  v_cvt_pk_bf16_f32 v8, v7, v7
  v_and_b32 v7, 0xffff0000, v8
  v_lshrrev_b32 v8, 23, v7
  v_subrev_u32 v8, 134, v8
  v_max_i32 v8, 0, v8
  v_cvt_u32_f32 v7, v7
  v_lshrrev_b32 v7, v8, v7
  v_lshl_add_u32 v7, v8, 8, v7
  v_lshl_add_u32 v201, v7, 2, s18
  v_subrev_u32 v6, 2, v5
  v_max_i32 v7, 0, v6
  v_cvt_f32_u32 v7, v7
  v_cvt_pk_bf16_f32 v8, v7, v7
  v_and_b32 v7, 0xffff0000, v8
  v_lshrrev_b32 v8, 23, v7
  v_subrev_u32 v8, 134, v8
  v_max_i32 v8, 0, v8
  v_cvt_u32_f32 v7, v7
  v_lshrrev_b32 v7, v8, v7
  v_lshl_add_u32 v7, v8, 8, v7
  v_lshl_add_u32 v202, v7, 2, s18
  v_subrev_u32 v6, 3, v5
  v_max_i32 v7, 0, v6
  v_cvt_f32_u32 v7, v7
  v_cvt_pk_bf16_f32 v8, v7, v7
  v_and_b32 v7, 0xffff0000, v8
  v_lshrrev_b32 v8, 23, v7
  v_subrev_u32 v8, 134, v8
  v_max_i32 v8, 0, v8
  v_cvt_u32_f32 v7, v7
  v_lshrrev_b32 v7, v8, v7
  v_lshl_add_u32 v7, v8, 8, v7
  v_lshl_add_u32 v203, v7, 2, s18
  v_subrev_u32 v6, 4, v5
  v_max_i32 v7, 0, v6
  v_cvt_f32_u32 v7, v7
  v_cvt_pk_bf16_f32 v8, v7, v7
  v_and_b32 v7, 0xffff0000, v8
  v_lshrrev_b32 v8, 23, v7
  v_subrev_u32 v8, 134, v8
  v_max_i32 v8, 0, v8
  v_cvt_u32_f32 v7, v7
  v_lshrrev_b32 v7, v8, v7
  v_lshl_add_u32 v7, v8, 8, v7
  v_lshl_add_u32 v204, v7, 2, s18
  v_subrev_u32 v6, 5, v5
  v_max_i32 v7, 0, v6
  v_cvt_f32_u32 v7, v7
  v_cvt_pk_bf16_f32 v8, v7, v7
  v_and_b32 v7, 0xffff0000, v8
  v_lshrrev_b32 v8, 23, v7
  v_subrev_u32 v8, 134, v8
  v_max_i32 v8, 0, v8
  v_cvt_u32_f32 v7, v7
  v_lshrrev_b32 v7, v8, v7
  v_lshl_add_u32 v7, v8, 8, v7
  v_lshl_add_u32 v205, v7, 2, s18
  v_subrev_u32 v6, 6, v5
  v_max_i32 v7, 0, v6
  v_cvt_f32_u32 v7, v7
  v_cvt_pk_bf16_f32 v8, v7, v7
  v_and_b32 v7, 0xffff0000, v8
  v_lshrrev_b32 v8, 23, v7
  v_subrev_u32 v8, 134, v8
  v_max_i32 v8, 0, v8
  v_cvt_u32_f32 v7, v7
  v_lshrrev_b32 v7, v8, v7
  v_lshl_add_u32 v7, v8, 8, v7
  v_lshl_add_u32 v206, v7, 2, s18
  v_subrev_u32 v6, 7, v5
  v_max_i32 v7, 0, v6
  v_cvt_f32_u32 v7, v7
  v_cvt_pk_bf16_f32 v8, v7, v7
  v_and_b32 v7, 0xffff0000, v8
  v_lshrrev_b32 v8, 23, v7
  v_subrev_u32 v8, 134, v8
  v_max_i32 v8, 0, v8
  v_cvt_u32_f32 v7, v7
  v_lshrrev_b32 v7, v8, v7
  v_lshl_add_u32 v7, v8, 8, v7
  v_lshl_add_u32 v207, v7, 2, s18
  v_subrev_u32 v6, 8, v5
  v_max_i32 v7, 0, v6
  v_cvt_f32_u32 v7, v7
  v_cvt_pk_bf16_f32 v8, v7, v7
  v_and_b32 v7, 0xffff0000, v8
  v_lshrrev_b32 v8, 23, v7
  v_subrev_u32 v8, 134, v8
  v_max_i32 v8, 0, v8
  v_cvt_u32_f32 v7, v7
  v_lshrrev_b32 v7, v8, v7
  v_lshl_add_u32 v7, v8, 8, v7
  v_lshl_add_u32 v208, v7, 2, s18
  v_subrev_u32 v6, 9, v5
  v_max_i32 v7, 0, v6
  v_cvt_f32_u32 v7, v7
  v_cvt_pk_bf16_f32 v8, v7, v7
  v_and_b32 v7, 0xffff0000, v8
  v_lshrrev_b32 v8, 23, v7
  v_subrev_u32 v8, 134, v8
  v_max_i32 v8, 0, v8
  v_cvt_u32_f32 v7, v7
  v_lshrrev_b32 v7, v8, v7
  v_lshl_add_u32 v7, v8, 8, v7
  v_lshl_add_u32 v209, v7, 2, s18
  v_subrev_u32 v6, 10, v5
  v_max_i32 v7, 0, v6
  v_cvt_f32_u32 v7, v7
  v_cvt_pk_bf16_f32 v8, v7, v7
  v_and_b32 v7, 0xffff0000, v8
  v_lshrrev_b32 v8, 23, v7
  v_subrev_u32 v8, 134, v8
  v_max_i32 v8, 0, v8
  v_cvt_u32_f32 v7, v7
  v_lshrrev_b32 v7, v8, v7
  v_lshl_add_u32 v7, v8, 8, v7
  v_lshl_add_u32 v210, v7, 2, s18
  v_subrev_u32 v6, 11, v5
  v_max_i32 v7, 0, v6
  v_cvt_f32_u32 v7, v7
  v_cvt_pk_bf16_f32 v8, v7, v7
  v_and_b32 v7, 0xffff0000, v8
  v_lshrrev_b32 v8, 23, v7
  v_subrev_u32 v8, 134, v8
  v_max_i32 v8, 0, v8
  v_cvt_u32_f32 v7, v7
  v_lshrrev_b32 v7, v8, v7
  v_lshl_add_u32 v7, v8, 8, v7
  v_lshl_add_u32 v211, v7, 2, s18
  v_subrev_u32 v6, 12, v5
  v_max_i32 v7, 0, v6
  v_cvt_f32_u32 v7, v7
  v_cvt_pk_bf16_f32 v8, v7, v7
  v_and_b32 v7, 0xffff0000, v8
  v_lshrrev_b32 v8, 23, v7
  v_subrev_u32 v8, 134, v8
  v_max_i32 v8, 0, v8
  v_cvt_u32_f32 v7, v7
  v_lshrrev_b32 v7, v8, v7
  v_lshl_add_u32 v7, v8, 8, v7
  v_lshl_add_u32 v212, v7, 2, s18
  v_subrev_u32 v6, 13, v5
  v_max_i32 v7, 0, v6
  v_cvt_f32_u32 v7, v7
  v_cvt_pk_bf16_f32 v8, v7, v7
  v_and_b32 v7, 0xffff0000, v8
  v_lshrrev_b32 v8, 23, v7
  v_subrev_u32 v8, 134, v8
  v_max_i32 v8, 0, v8
  v_cvt_u32_f32 v7, v7
  v_lshrrev_b32 v7, v8, v7
  v_lshl_add_u32 v7, v8, 8, v7
  v_lshl_add_u32 v213, v7, 2, s18
  v_subrev_u32 v6, 14, v5
  v_max_i32 v7, 0, v6
  v_cvt_f32_u32 v7, v7
  v_cvt_pk_bf16_f32 v8, v7, v7
  v_and_b32 v7, 0xffff0000, v8
  v_lshrrev_b32 v8, 23, v7
  v_subrev_u32 v8, 134, v8
  v_max_i32 v8, 0, v8
  v_cvt_u32_f32 v7, v7
  v_lshrrev_b32 v7, v8, v7
  v_lshl_add_u32 v7, v8, 8, v7
  v_lshl_add_u32 v214, v7, 2, s18
  v_subrev_u32 v6, 15, v5
  v_max_i32 v7, 0, v6
  v_cvt_f32_u32 v7, v7
  v_cvt_pk_bf16_f32 v8, v7, v7
  v_and_b32 v7, 0xffff0000, v8
  v_lshrrev_b32 v8, 23, v7
  v_subrev_u32 v8, 134, v8
  v_max_i32 v8, 0, v8
  v_cvt_u32_f32 v7, v7
  v_lshrrev_b32 v7, v8, v7
  v_lshl_add_u32 v7, v8, 8, v7
  v_lshl_add_u32 v215, v7, 2, s18
  v_subrev_u32 v6, 16, v5
  v_max_i32 v7, 0, v6
  v_cvt_f32_u32 v7, v7
  v_cvt_pk_bf16_f32 v8, v7, v7
  v_and_b32 v7, 0xffff0000, v8
  v_lshrrev_b32 v8, 23, v7
  v_subrev_u32 v8, 134, v8
  v_max_i32 v8, 0, v8
  v_cvt_u32_f32 v7, v7
  v_lshrrev_b32 v7, v8, v7
  v_lshl_add_u32 v7, v8, 8, v7
  v_lshl_add_u32 v216, v7, 2, s18
  v_subrev_u32 v6, 17, v5
  v_max_i32 v7, 0, v6
  v_cvt_f32_u32 v7, v7
  v_cvt_pk_bf16_f32 v8, v7, v7
  v_and_b32 v7, 0xffff0000, v8
  v_lshrrev_b32 v8, 23, v7
  v_subrev_u32 v8, 134, v8
  v_max_i32 v8, 0, v8
  v_cvt_u32_f32 v7, v7
  v_lshrrev_b32 v7, v8, v7
  v_lshl_add_u32 v7, v8, 8, v7
  v_lshl_add_u32 v217, v7, 2, s18
  v_subrev_u32 v6, 18, v5
  v_max_i32 v7, 0, v6
  v_cvt_f32_u32 v7, v7
  v_cvt_pk_bf16_f32 v8, v7, v7
  v_and_b32 v7, 0xffff0000, v8
  v_lshrrev_b32 v8, 23, v7
  v_subrev_u32 v8, 134, v8
  v_max_i32 v8, 0, v8
  v_cvt_u32_f32 v7, v7
  v_lshrrev_b32 v7, v8, v7
  v_lshl_add_u32 v7, v8, 8, v7
  v_lshl_add_u32 v218, v7, 2, s18
  v_subrev_u32 v6, 19, v5
  v_max_i32 v7, 0, v6
  v_cvt_f32_u32 v7, v7
  v_cvt_pk_bf16_f32 v8, v7, v7
  v_and_b32 v7, 0xffff0000, v8
  v_lshrrev_b32 v8, 23, v7
  v_subrev_u32 v8, 134, v8
  v_max_i32 v8, 0, v8
  v_cvt_u32_f32 v7, v7
  v_lshrrev_b32 v7, v8, v7
  v_lshl_add_u32 v7, v8, 8, v7
  v_lshl_add_u32 v219, v7, 2, s18
  v_subrev_u32 v6, 20, v5
  v_max_i32 v7, 0, v6
  v_cvt_f32_u32 v7, v7
  v_cvt_pk_bf16_f32 v8, v7, v7
  v_and_b32 v7, 0xffff0000, v8
  v_lshrrev_b32 v8, 23, v7
  v_subrev_u32 v8, 134, v8
  v_max_i32 v8, 0, v8
  v_cvt_u32_f32 v7, v7
  v_lshrrev_b32 v7, v8, v7
  v_lshl_add_u32 v7, v8, 8, v7
  v_lshl_add_u32 v220, v7, 2, s18
  v_subrev_u32 v6, 21, v5
  v_max_i32 v7, 0, v6
  v_cvt_f32_u32 v7, v7
  v_cvt_pk_bf16_f32 v8, v7, v7
  v_and_b32 v7, 0xffff0000, v8
  v_lshrrev_b32 v8, 23, v7
  v_subrev_u32 v8, 134, v8
  v_max_i32 v8, 0, v8
  v_cvt_u32_f32 v7, v7
  v_lshrrev_b32 v7, v8, v7
  v_lshl_add_u32 v7, v8, 8, v7
  v_lshl_add_u32 v221, v7, 2, s18
  v_subrev_u32 v6, 22, v5
  v_max_i32 v7, 0, v6
  v_cvt_f32_u32 v7, v7
  v_cvt_pk_bf16_f32 v8, v7, v7
  v_and_b32 v7, 0xffff0000, v8
  v_lshrrev_b32 v8, 23, v7
  v_subrev_u32 v8, 134, v8
  v_max_i32 v8, 0, v8
  v_cvt_u32_f32 v7, v7
  v_lshrrev_b32 v7, v8, v7
  v_lshl_add_u32 v7, v8, 8, v7
  v_lshl_add_u32 v222, v7, 2, s18
  v_subrev_u32 v6, 23, v5
  v_max_i32 v7, 0, v6
  v_cvt_f32_u32 v7, v7
  v_cvt_pk_bf16_f32 v8, v7, v7
  v_and_b32 v7, 0xffff0000, v8
  v_lshrrev_b32 v8, 23, v7
  v_subrev_u32 v8, 134, v8
  v_max_i32 v8, 0, v8
  v_cvt_u32_f32 v7, v7
  v_lshrrev_b32 v7, v8, v7
  v_lshl_add_u32 v7, v8, 8, v7
  v_lshl_add_u32 v223, v7, 2, s18
  v_subrev_u32 v6, 24, v5
  v_max_i32 v7, 0, v6
  v_cvt_f32_u32 v7, v7
  v_cvt_pk_bf16_f32 v8, v7, v7
  v_and_b32 v7, 0xffff0000, v8
  v_lshrrev_b32 v8, 23, v7
  v_subrev_u32 v8, 134, v8
  v_max_i32 v8, 0, v8
  v_cvt_u32_f32 v7, v7
  v_lshrrev_b32 v7, v8, v7
  v_lshl_add_u32 v7, v8, 8, v7
  v_lshl_add_u32 v224, v7, 2, s18
  v_subrev_u32 v6, 25, v5
  v_max_i32 v7, 0, v6
  v_cvt_f32_u32 v7, v7
  v_cvt_pk_bf16_f32 v8, v7, v7
  v_and_b32 v7, 0xffff0000, v8
  v_lshrrev_b32 v8, 23, v7
  v_subrev_u32 v8, 134, v8
  v_max_i32 v8, 0, v8
  v_cvt_u32_f32 v7, v7
  v_lshrrev_b32 v7, v8, v7
  v_lshl_add_u32 v7, v8, 8, v7
  v_lshl_add_u32 v225, v7, 2, s18
  v_subrev_u32 v6, 26, v5
  v_max_i32 v7, 0, v6
  v_cvt_f32_u32 v7, v7
  v_cvt_pk_bf16_f32 v8, v7, v7
  v_and_b32 v7, 0xffff0000, v8
  v_lshrrev_b32 v8, 23, v7
  v_subrev_u32 v8, 134, v8
  v_max_i32 v8, 0, v8
  v_cvt_u32_f32 v7, v7
  v_lshrrev_b32 v7, v8, v7
  v_lshl_add_u32 v7, v8, 8, v7
  v_lshl_add_u32 v226, v7, 2, s18
  v_subrev_u32 v6, 27, v5
  v_max_i32 v7, 0, v6
  v_cvt_f32_u32 v7, v7
  v_cvt_pk_bf16_f32 v8, v7, v7
  v_and_b32 v7, 0xffff0000, v8
  v_lshrrev_b32 v8, 23, v7
  v_subrev_u32 v8, 134, v8
  v_max_i32 v8, 0, v8
  v_cvt_u32_f32 v7, v7
  v_lshrrev_b32 v7, v8, v7
  v_lshl_add_u32 v7, v8, 8, v7
  v_lshl_add_u32 v227, v7, 2, s18
  v_subrev_u32 v6, 28, v5
  v_max_i32 v7, 0, v6
  v_cvt_f32_u32 v7, v7
  v_cvt_pk_bf16_f32 v8, v7, v7
  v_and_b32 v7, 0xffff0000, v8
  v_lshrrev_b32 v8, 23, v7
  v_subrev_u32 v8, 134, v8
  v_max_i32 v8, 0, v8
  v_cvt_u32_f32 v7, v7
  v_lshrrev_b32 v7, v8, v7
  v_lshl_add_u32 v7, v8, 8, v7
  v_lshl_add_u32 v228, v7, 2, s18
  v_subrev_u32 v6, 29, v5
  v_max_i32 v7, 0, v6
  v_cvt_f32_u32 v7, v7
  v_cvt_pk_bf16_f32 v8, v7, v7
  v_and_b32 v7, 0xffff0000, v8
  v_lshrrev_b32 v8, 23, v7
  v_subrev_u32 v8, 134, v8
  v_max_i32 v8, 0, v8
  v_cvt_u32_f32 v7, v7
  v_lshrrev_b32 v7, v8, v7
  v_lshl_add_u32 v7, v8, 8, v7
  v_lshl_add_u32 v229, v7, 2, s18
  v_subrev_u32 v6, 30, v5
  v_max_i32 v7, 0, v6
  v_cvt_f32_u32 v7, v7
  v_cvt_pk_bf16_f32 v8, v7, v7
  v_and_b32 v7, 0xffff0000, v8
  v_lshrrev_b32 v8, 23, v7
  v_subrev_u32 v8, 134, v8
  v_max_i32 v8, 0, v8
  v_cvt_u32_f32 v7, v7
  v_lshrrev_b32 v7, v8, v7
  v_lshl_add_u32 v7, v8, 8, v7
  v_lshl_add_u32 v230, v7, 2, s18
  v_subrev_u32 v6, 31, v5
  v_max_i32 v7, 0, v6
  v_cvt_f32_u32 v7, v7
  v_cvt_pk_bf16_f32 v8, v7, v7
  v_and_b32 v7, 0xffff0000, v8
  v_lshrrev_b32 v8, 23, v7
  v_subrev_u32 v8, 134, v8
  v_max_i32 v8, 0, v8
  v_cvt_u32_f32 v7, v7
  v_lshrrev_b32 v7, v8, v7
  v_lshl_add_u32 v7, v8, 8, v7
  v_lshl_add_u32 v231, v7, 2, s18
  v_subrev_u32 v6, 32, v5
  v_max_i32 v7, 0, v6
  v_cvt_f32_u32 v7, v7
  v_cvt_pk_bf16_f32 v8, v7, v7
  v_and_b32 v7, 0xffff0000, v8
  v_lshrrev_b32 v8, 23, v7
  v_subrev_u32 v8, 134, v8
  v_max_i32 v8, 0, v8
  v_cvt_u32_f32 v7, v7
  v_lshrrev_b32 v7, v8, v7
  v_lshl_add_u32 v7, v8, 8, v7
  v_mov_b32 v8, 1280
  v_cmp_gt_i32 vcc, 0, v6
  s_nop 1
  v_cndmask_b32 v7, v7, v8, vcc
  v_lshl_add_u32 v232, v7, 2, s18
  v_mov_b32 v8, 0
  v_mov_b32 v9, 0
  v_lshlrev_b32 v5, 3, v1
  v_add_u32 v5, s17, v5
  ds_write_b64 v5, v[8:9]
  v_and_b32 v6, 15, v1
  v_lshlrev_b32 v6, 3, v6
  v_add_u32 v6, s17, v6
  ds_write_b64 v6, v[8:9] offset:8704
  ds_write_b64 v6, v[8:9] offset:12928
  v_mov_b32 v6, s17
  ds_write_b64 v6, v[8:9] offset:18176
  s_lshl_b32 s19, s3, 2
  s_add_u32 s20, s19, s16
  s_lshl_b32 s21, s3, 3
  v_mul_u32_u24 v5, 3584, v0
  v_mul_u32_u24 v141, 1792, v0
  s_lshl_b32 s22, s20, 9
  v_lshlrev_b32 v6, 3, v1
  buffer_load_dwordx2 v[24:25], v6, s[64:67], s22 offen
  buffer_load_dwordx2 v[26:27], v6, s[68:71], s22 offen
  buffer_load_dwordx2 v[28:29], v6, s[72:75], s22 offen
  buffer_load_dwordx2 v[30:31], v6, s[76:79], s22 offen
  s_lshl_b32 s22, s20, 1
  v_mov_b32 v7, 0
  buffer_load_ushort v32, v7, s[80:83], s22 offen
  buffer_load_ushort v33, v7, s[84:87], s22 offen
  s_mov_b32 s24, 0x05040100
  s_mov_b32 s25, 0x07060302
  s_barrier
  s_waitcnt vmcnt(0)
  s_mov_b32 s26, 1069066811
  s_mov_b32 s27, 1042479491
  v_lshlrev_b32 v32, 16, v32
  v_lshlrev_b32 v33, 16, v33
  v_mul_f32 v32, s26, v32
  v_exp_f32 v32, v32
  s_nop 0
  v_cvt_pk_bf16_f32 v34, v32, v32
  v_and_b32 v32, 0xffff0000, v34
  v_lshlrev_b32 v37, 6, v1
  v_add_u32 v37, s17, v37
  v_lshlrev_b32 v40, 16, v24
  v_lshlrev_b32 v41, 16, v26
  v_lshlrev_b32 v42, 16, v28
  v_lshlrev_b32 v43, 16, v30
  v_mul_f32 v40, s26, v40
  v_exp_f32 v40, v40
  s_nop 0
  v_cvt_pk_bf16_f32 v34, v40, v40
  v_and_b32 v40, 0xffff0000, v34
  v_mul_f32 v40, v40, v32
  v_mul_f32 v40, s26, v40
  v_sub_f32 v40, 0, v40
  v_mul_f32 v41, v41, v32
  v_mul_f32 v41, s27, v41
  v_mul_f32 v42, v42, v32
  v_mul_f32 v43, v43, v32
  v_add_f32 v42, v42, v42
  v_add_f32 v43, v43, v43
  ds_write_b128 v37, v[40:43] offset:18240
  v_and_b32 v40, 0xffff0000, v24
  v_and_b32 v41, 0xffff0000, v26
  v_and_b32 v42, 0xffff0000, v28
  v_and_b32 v43, 0xffff0000, v30
  v_mul_f32 v40, s26, v40
  v_exp_f32 v40, v40
  s_nop 0
  v_cvt_pk_bf16_f32 v34, v40, v40
  v_and_b32 v40, 0xffff0000, v34
  v_mul_f32 v40, v40, v32
  v_mul_f32 v40, s26, v40
  v_sub_f32 v40, 0, v40
  v_mul_f32 v41, v41, v32
  v_mul_f32 v41, s27, v41
  v_mul_f32 v42, v42, v32
  v_mul_f32 v43, v43, v32
  v_add_f32 v42, v42, v42
  v_add_f32 v43, v43, v43
  ds_write_b128 v37, v[40:43] offset:18256
  v_lshlrev_b32 v40, 16, v25
  v_lshlrev_b32 v41, 16, v27
  v_lshlrev_b32 v42, 16, v29
  v_lshlrev_b32 v43, 16, v31
  v_mul_f32 v40, s26, v40
  v_exp_f32 v40, v40
  s_nop 0
  v_cvt_pk_bf16_f32 v34, v40, v40
  v_and_b32 v40, 0xffff0000, v34
  v_mul_f32 v40, v40, v32
  v_mul_f32 v40, s26, v40
  v_sub_f32 v40, 0, v40
  v_mul_f32 v41, v41, v32
  v_mul_f32 v41, s27, v41
  v_mul_f32 v42, v42, v32
  v_mul_f32 v43, v43, v32
  v_add_f32 v42, v42, v42
  v_add_f32 v43, v43, v43
  ds_write_b128 v37, v[40:43] offset:18272
  v_and_b32 v40, 0xffff0000, v25
  v_and_b32 v41, 0xffff0000, v27
  v_and_b32 v42, 0xffff0000, v29
  v_and_b32 v43, 0xffff0000, v31
  v_mul_f32 v40, s26, v40
  v_exp_f32 v40, v40
  s_nop 0
  v_cvt_pk_bf16_f32 v34, v40, v40
  v_and_b32 v40, 0xffff0000, v34
  v_mul_f32 v40, v40, v32
  v_mul_f32 v40, s26, v40
  v_sub_f32 v40, 0, v40
  v_mul_f32 v41, v41, v32
  v_mul_f32 v41, s27, v41
  v_mul_f32 v42, v42, v32
  v_mul_f32 v43, v43, v32
  v_add_f32 v42, v42, v42
  v_add_f32 v43, v43, v43
  ds_write_b128 v37, v[40:43] offset:18288
  v_cvt_f32_u32 v44, v4
  v_lshlrev_b32 v45, 4, v4
  v_cvt_f32_u32 v45, v45
  v_lshlrev_b32 v46, 4, v3
  v_add_u32 v46, s17, v46
  v_mov_b32 v48, 0
  v_mov_b32 v49, 0
  v_mov_b32 v50, 0
  v_mov_b32 v51, 0
  v_mov_b32 v52, 0
  v_mov_b32 v53, 0
  v_mov_b32 v54, 0
  v_mov_b32 v55, 0
  v_mov_b32 v56, 0
  v_mov_b32 v57, 0
  v_mov_b32 v58, 0
  v_mov_b32 v59, 0
  v_mov_b32 v60, 0
  v_mov_b32 v61, 0
  v_mov_b32 v62, 0
  v_mov_b32 v63, 0
  v_mov_b32 v64, 0
  v_mov_b32 v65, 0
  v_mov_b32 v66, 0
  v_mov_b32 v67, 0
  s_waitcnt lgkmcnt(0)
  ds_read_b128 v[68:71], v46 offset:18240
  s_add_u32 s22, s21, 0
  buffer_load_dwordx2 v[8:9], v5, s[60:63], s22 offen offset:0
  s_mov_b32 s28, 0
  s_call_b64 s[30:31], wk_kl
  s_mov_b32 s28, 0
  s_call_b64 s[30:31], wk_kl
  s_add_u32 s22, s21, 0
  buffer_load_dwordx2 v[10:11], v5, s[60:63], s22 offen offset:896
  s_mov_b32 s28, 0
  s_call_b64 s[30:31], wk_kl
  s_mov_b32 s28, 0
  s_call_b64 s[30:31], wk_kl
  s_add_u32 s22, s21, 0
  buffer_load_dwordx2 v[12:13], v5, s[60:63], s22 offen offset:1792
  s_mov_b32 s28, 0
  s_call_b64 s[30:31], wk_kl
  s_mov_b32 s28, 0
  s_call_b64 s[30:31], wk_kl
  s_add_u32 s22, s21, 0
  buffer_load_dwordx2 v[14:15], v5, s[60:63], s22 offen offset:2688
  s_mov_b32 s28, 0
  s_call_b64 s[30:31], wk_kl
  s_mov_b32 s28, 0
  s_call_b64 s[30:31], wk_kl
  s_add_u32 s22, s21, 917504
  buffer_load_dwordx2 v[16:17], v5, s[60:63], s22 offen offset:0
  s_mov_b32 s28, 0
  s_call_b64 s[30:31], wk_kl
  s_mov_b32 s28, 0
  s_call_b64 s[30:31], wk_kl
  s_add_u32 s22, s21, 917504
  buffer_load_dwordx2 v[18:19], v5, s[60:63], s22 offen offset:896
  s_mov_b32 s28, 0
  s_call_b64 s[30:31], wk_kl
  s_mov_b32 s28, 0
  s_call_b64 s[30:31], wk_kl
  s_add_u32 s22, s21, 917504
  buffer_load_dwordx2 v[20:21], v5, s[60:63], s22 offen offset:1792
  s_mov_b32 s28, 0
  s_call_b64 s[30:31], wk_kl
  s_mov_b32 s28, 0
  s_call_b64 s[30:31], wk_kl
  s_add_u32 s22, s21, 917504
  buffer_load_dwordx2 v[22:23], v5, s[60:63], s22 offen offset:2688
  s_mov_b32 s28, 0
  s_call_b64 s[30:31], wk_kl
  s_mov_b32 s28, 0
  s_call_b64 s[30:31], wk_kl
  s_branch wk_kd
wk_kl:
  s_waitcnt lgkmcnt(0)
  v_mov_b32 v72, v68
  v_mov_b32 v73, v69
  v_mov_b32 v74, v70
  v_mov_b32 v75, v71
  v_add_u32 v46, 64, v46
  ds_read_b128 v[68:71], v46 offset:18240
  v_mul_f32 v80, v72, v45
  v_mul_f32 v81, v73, v45
  v_exp_f32 v80, v80
  v_fract_f32 v81, v81
  v_cos_f32 v76, v81
  v_sin_f32 v77, v81
  v_mul_f32 v76, v76, v80
  v_mul_f32 v77, v77, v80
  v_mul_f32 v80, v72, v44
  v_mul_f32 v81, v73, v44
  v_exp_f32 v80, v80
  v_fract_f32 v81, v81
  v_cos_f32 v78, v81
  v_sin_f32 v79, v81
  v_mul_f32 v78, v78, v80
  v_mul_f32 v79, v79, v80
  v_mul_f32 v82, v74, v76
  v_mul_f32 v83, v74, v77
  v_fma_f32 v82, -v75, v77, v82
  v_fma_f32 v83, -v75, v76, -v83
  v_mul_f32 v86, v76, v76
  v_mul_f32 v87, v76, v77
  v_fma_f32 v86, -v77, v77, v86
  v_add_f32 v87, v87, v87
  v_mfma_f32_16x16x4_f32 v[48:51], v82, v78, v[48:51]
  v_mul_f32 v88, v78, v78
  v_mul_f32 v89, v78, v79
  v_fma_f32 v88, -v79, v79, v88
  v_add_f32 v89, v89, v89
  v_mfma_f32_16x16x4_f32 v[48:51], v83, v79, v[48:51]
  v_mul_f32 v84, v74, v86
  v_mul_f32 v85, v74, v87
  v_fma_f32 v84, -v75, v87, v84
  v_fma_f32 v85, -v75, v86, -v85
  v_mul_f32 v76, v86, v86
  v_mul_f32 v77, v86, v87
  v_fma_f32 v76, -v87, v87, v76
  v_add_f32 v77, v77, v77
  v_mfma_f32_16x16x4_f32 v[52:55], v84, v88, v[52:55]
  v_mul_f32 v78, v88, v88
  v_mul_f32 v79, v88, v89
  v_fma_f32 v78, -v89, v89, v78
  v_add_f32 v79, v79, v79
  v_mfma_f32_16x16x4_f32 v[52:55], v85, v89, v[52:55]
  v_mul_f32 v82, v74, v76
  v_mul_f32 v83, v74, v77
  v_fma_f32 v82, -v75, v77, v82
  v_fma_f32 v83, -v75, v76, -v83
  v_mul_f32 v86, v76, v76
  v_mul_f32 v87, v76, v77
  v_fma_f32 v86, -v77, v77, v86
  v_add_f32 v87, v87, v87
  v_mfma_f32_16x16x4_f32 v[56:59], v82, v78, v[56:59]
  v_mul_f32 v88, v78, v78
  v_mul_f32 v89, v78, v79
  v_fma_f32 v88, -v79, v79, v88
  v_add_f32 v89, v89, v89
  v_mfma_f32_16x16x4_f32 v[56:59], v83, v79, v[56:59]
  v_mul_f32 v84, v74, v86
  v_mul_f32 v85, v74, v87
  v_fma_f32 v84, -v75, v87, v84
  v_fma_f32 v85, -v75, v86, -v85
  v_mul_f32 v76, v86, v86
  v_mul_f32 v77, v86, v87
  v_fma_f32 v76, -v87, v87, v76
  v_add_f32 v77, v77, v77
  v_mfma_f32_16x16x4_f32 v[60:63], v84, v88, v[60:63]
  v_mfma_f32_16x16x4_f32 v[60:63], v85, v89, v[60:63]
  v_mul_f32 v82, v74, v76
  v_fma_f32 v82, -v75, v77, v82
  s_nop 1
  v_mfma_f32_16x16x4_f32 v[64:67], v82, v88, v[64:67]
  s_add_u32 s28, s28, 1
  s_cmp_lt_u32 s28, 4
  s_cbranch_scc1 wk_kl
  s_setpc_b64 s[30:31]
wk_kd:
  s_nop 15
  s_nop 3
  s_waitcnt vmcnt(0)
  v_lshlrev_b32 v6, 3, v0
  v_perm_b32 v34, v10, v8, s24
  v_perm_b32 v35, v14, v12, s24
  v_add_u32 v36, 512, v6
  ds_write_b64 v36, v[34:35]
  v_perm_b32 v34, v10, v8, s25
  v_perm_b32 v35, v14, v12, s25
  v_add_u32 v36, 25088, v6
  ds_write_b64 v36, v[34:35]
  v_perm_b32 v34, v11, v9, s24
  v_perm_b32 v35, v15, v13, s24
  v_add_u32 v36, 49664, v6
  ds_write_b64 v36, v[34:35]
  v_perm_b32 v34, v11, v9, s25
  v_perm_b32 v35, v15, v13, s25
  v_add_u32 v36, 74240, v6
  ds_write_b64 v36, v[34:35]
  v_perm_b32 v34, v18, v16, s24
  v_perm_b32 v35, v22, v20, s24
  v_add_u32 v36, 2560, v6
  ds_write_b64 v36, v[34:35]
  v_perm_b32 v34, v18, v16, s25
  v_perm_b32 v35, v22, v20, s25
  v_add_u32 v36, 27136, v6
  ds_write_b64 v36, v[34:35]
  v_perm_b32 v34, v19, v17, s24
  v_perm_b32 v35, v23, v21, s24
  v_add_u32 v36, 51712, v6
  ds_write_b64 v36, v[34:35]
  v_perm_b32 v34, v19, v17, s25
  v_perm_b32 v35, v23, v21, s25
  v_add_u32 v36, 76288, v6
  ds_write_b64 v36, v[34:35]
  v_lshlrev_b32 v46, 8, v3
  v_lshl_add_u32 v46, v4, 2, v46
  v_add_u32 v46, s17, v46
  ds_write_b32 v46, v48 offset:13056
  ds_write_b32 v46, v49 offset:13120
  ds_write_b32 v46, v50 offset:13184
  ds_write_b32 v46, v51 offset:13248
  s_waitcnt lgkmcnt(8)
  ds_write_b32 v46, v52 offset:14080
  ds_write_b32 v46, v53 offset:14144
  ds_write_b32 v46, v54 offset:14208
  ds_write_b32 v46, v55 offset:14272
  s_waitcnt lgkmcnt(8)
  ds_write_b32 v46, v56 offset:15104
  ds_write_b32 v46, v57 offset:15168
  ds_write_b32 v46, v58 offset:15232
  ds_write_b32 v46, v59 offset:15296
  s_waitcnt lgkmcnt(8)
  ds_write_b32 v46, v60 offset:16128
  ds_write_b32 v46, v61 offset:16192
  ds_write_b32 v46, v62 offset:16256
  ds_write_b32 v46, v63 offset:16320
  s_waitcnt lgkmcnt(8)
  ds_write_b32 v46, v64 offset:17152
  ds_write_b32 v46, v65 offset:17216
  ds_write_b32 v46, v66 offset:17280
  ds_write_b32 v46, v67 offset:17344
  s_waitcnt lgkmcnt(8)
  s_waitcnt lgkmcnt(0)
  ds_read_b32 v48, v200
  ds_read_b32 v49, v201
  ds_read_b32 v50, v202
  ds_read_b32 v51, v203
  ds_read_b32 v52, v204
  ds_read_b32 v53, v205
  ds_read_b32 v54, v206
  ds_read_b32 v55, v207
  s_waitcnt lgkmcnt(4)
  ds_read_b32 v56, v208
  ds_read_b32 v57, v209
  ds_read_b32 v58, v210
  ds_read_b32 v59, v211
  ds_read_b32 v60, v212
  ds_read_b32 v61, v213
  ds_read_b32 v62, v214
  ds_read_b32 v63, v215
  s_waitcnt lgkmcnt(4)
  ds_read_b32 v64, v216
  ds_read_b32 v65, v217
  ds_read_b32 v66, v218
  ds_read_b32 v67, v219
  ds_read_b32 v68, v220
  ds_read_b32 v69, v221
  ds_read_b32 v70, v222
  ds_read_b32 v71, v223
  s_waitcnt lgkmcnt(4)
  ds_read_b32 v72, v224
  ds_read_b32 v73, v225
  ds_read_b32 v74, v226
  ds_read_b32 v75, v227
  ds_read_b32 v76, v228
  ds_read_b32 v77, v229
  ds_read_b32 v78, v230
  ds_read_b32 v79, v231
  s_waitcnt lgkmcnt(4)
  ds_read_b32 v80, v232
  s_waitcnt lgkmcnt(0)
  v_lshlrev_b32 v46, 6, v1
  v_add_u32 v46, s17, v46
  v_cvt_pk_bf16_f32 v84, v48, v49
  v_cvt_pk_bf16_f32 v88, v49, v50
  v_cvt_pk_bf16_f32 v85, v50, v51
  v_cvt_pk_bf16_f32 v89, v51, v52
  v_cvt_pk_bf16_f32 v86, v52, v53
  v_cvt_pk_bf16_f32 v90, v53, v54
  v_cvt_pk_bf16_f32 v87, v54, v55
  v_cvt_pk_bf16_f32 v91, v55, v56
  ds_write_b128 v46, v[84:87] offset:4608
  ds_write_b128 v46, v[88:91] offset:8832
  s_waitcnt lgkmcnt(0)
  v_cvt_pk_bf16_f32 v84, v56, v57
  v_cvt_pk_bf16_f32 v88, v57, v58
  v_cvt_pk_bf16_f32 v85, v58, v59
  v_cvt_pk_bf16_f32 v89, v59, v60
  v_cvt_pk_bf16_f32 v86, v60, v61
  v_cvt_pk_bf16_f32 v90, v61, v62
  v_cvt_pk_bf16_f32 v87, v62, v63
  v_cvt_pk_bf16_f32 v91, v63, v64
  ds_write_b128 v46, v[84:87] offset:4624
  ds_write_b128 v46, v[88:91] offset:8848
  s_waitcnt lgkmcnt(0)
  v_cvt_pk_bf16_f32 v84, v64, v65
  v_cvt_pk_bf16_f32 v88, v65, v66
  v_cvt_pk_bf16_f32 v85, v66, v67
  v_cvt_pk_bf16_f32 v89, v67, v68
  v_cvt_pk_bf16_f32 v86, v68, v69
  v_cvt_pk_bf16_f32 v90, v69, v70
  v_cvt_pk_bf16_f32 v87, v70, v71
  v_cvt_pk_bf16_f32 v91, v71, v72
  ds_write_b128 v46, v[84:87] offset:4640
  ds_write_b128 v46, v[88:91] offset:8864
  s_waitcnt lgkmcnt(0)
  v_cvt_pk_bf16_f32 v84, v72, v73
  v_cvt_pk_bf16_f32 v88, v73, v74
  v_cvt_pk_bf16_f32 v85, v74, v75
  v_cvt_pk_bf16_f32 v89, v75, v76
  v_cvt_pk_bf16_f32 v86, v76, v77
  v_cvt_pk_bf16_f32 v90, v77, v78
  v_cvt_pk_bf16_f32 v87, v78, v79
  v_cvt_pk_bf16_f32 v91, v79, v80
  ds_write_b128 v46, v[84:87] offset:4656
  ds_write_b128 v46, v[88:91] offset:8880
  s_waitcnt lgkmcnt(0)
  s_barrier
  v_lshrrev_b32 v47, 1, v3
  v_sub_u32 v46, v4, v47
  v_add_u32 v46, 1, v46
  v_lshlrev_b32 v46, 5, v46
  v_and_b32 v48, 1, v3
  v_lshl_add_u32 v46, v48, 4, v46
  v_add_u32 v46, s17, v46
  ds_read_b128 a[0:3], v46 offset:32
  ds_read_b128 a[4:7], v46 offset:96
  ds_read_b128 a[8:11], v46 offset:160
  ds_read_b128 a[12:15], v46 offset:224
  ds_read_b128 a[16:19], v46 offset:288
  ds_read_b128 a[20:23], v46 offset:352
  ds_read_b128 a[24:27], v46 offset:416
  ds_read_b128 a[28:31], v46 offset:480
  s_waitcnt lgkmcnt(4)
  ds_read_b128 a[32:35], v46 offset:544
  ds_read_b128 a[36:39], v46 offset:608
  ds_read_b128 a[40:43], v46 offset:672
  ds_read_b128 a[44:47], v46 offset:736
  ds_read_b128 a[48:51], v46 offset:800
  ds_read_b128 a[52:55], v46 offset:864
  ds_read_b128 a[56:59], v46 offset:928
  ds_read_b128 a[60:63], v46 offset:992
  s_waitcnt lgkmcnt(4)
  ds_read_b128 a[64:67], v46 offset:1056
  ds_read_b128 a[68:71], v46 offset:1120
  ds_read_b128 a[72:75], v46 offset:1184
  ds_read_b128 a[76:79], v46 offset:1248
  ds_read_b128 a[80:83], v46 offset:1312
  ds_read_b128 a[84:87], v46 offset:1376
  ds_read_b128 a[88:91], v46 offset:1440
  ds_read_b128 a[92:95], v46 offset:1504
  s_waitcnt lgkmcnt(4)
  ds_read_b128 a[96:99], v46 offset:1568
  ds_read_b128 a[100:103], v46 offset:1632
  ds_read_b128 a[104:107], v46 offset:1696
  ds_read_b128 a[108:111], v46 offset:1760
  ds_read_b128 a[112:115], v46 offset:1824
  ds_read_b128 a[116:119], v46 offset:1888
  ds_read_b128 a[120:123], v46 offset:1952
  ds_read_b128 a[124:127], v46 offset:2016
  s_waitcnt lgkmcnt(4)
  ds_read_b128 a[128:131], v46 offset:2080
  ds_read_b128 a[132:135], v46 offset:2144
  ds_read_b128 a[136:139], v46 offset:2208
  ds_read_b128 a[140:143], v46 offset:2272
  ds_read_b128 a[144:147], v46 offset:2336
  ds_read_b128 a[148:151], v46 offset:2400
  ds_read_b128 a[152:155], v46 offset:2464
  ds_read_b128 a[156:159], v46 offset:2528
  s_waitcnt lgkmcnt(4)
  ds_read_b128 a[160:163], v46 offset:2592
  ds_read_b128 a[164:167], v46 offset:2656
  ds_read_b128 a[168:171], v46 offset:2720
  ds_read_b128 a[172:175], v46 offset:2784
  ds_read_b128 a[176:179], v46 offset:2848
  ds_read_b128 a[180:183], v46 offset:2912
  ds_read_b128 a[184:187], v46 offset:2976
  ds_read_b128 a[188:191], v46 offset:3040
  s_waitcnt lgkmcnt(4)
  ds_read_b128 a[192:195], v46 offset:3104
  ds_read_b128 a[196:199], v46 offset:3168
  ds_read_b128 a[200:203], v46 offset:3232
  ds_read_b128 a[204:207], v46 offset:3296
  ds_read_b128 a[208:211], v46 offset:3360
  ds_read_b128 a[212:215], v46 offset:3424
  ds_read_b128 a[216:219], v46 offset:3488
  ds_read_b128 a[220:223], v46 offset:3552
  s_waitcnt lgkmcnt(4)
  ds_read_b128 a[224:227], v46 offset:3616
  ds_read_b128 a[228:231], v46 offset:3680
  ds_read_b128 a[232:235], v46 offset:3744
  ds_read_b128 a[236:239], v46 offset:3808
  ds_read_b128 a[240:243], v46 offset:3872
  ds_read_b128 a[244:247], v46 offset:3936
  ds_read_b128 a[248:251], v46 offset:4000
  ds_read_b128 a[252:255], v46 offset:4064
  s_waitcnt lgkmcnt(4)
  v_lshlrev_b32 v49, 4, v47
  v_add_u32 v49, v49, v4
  v_sub_u32 v49, 2047, v49
  v_lshl_add_u32 v49, v48, 3, v49
  v_and_b32 v50, 1, v49
  v_lshrrev_b32 v49, 1, v49
  v_lshlrev_b32 v49, 2, v49
  v_mul_u32_u24 v50, 4224, v50
  v_add3_u32 v49, v49, v50, s17
  v_add_u32 v49, 4608, v49
  v_subrev_u32 v52, 896, v49
  v_subrev_u32 v53, 1856, v49
  v_subrev_u32 v54, 2816, v49
  v_subrev_u32 v55, 3776, v49
  v_subrev_u32 v56, 4736, v49
  s_waitcnt lgkmcnt(0)
  ds_read2_b32 v[92:93], v52 offset0:224 offset1:225
  ds_read2_b32 v[94:95], v52 offset0:226 offset1:227
  ds_read2_b32 v[96:97], v52 offset0:208 offset1:209
  ds_read2_b32 v[98:99], v52 offset0:210 offset1:211
  ds_read2_b32 v[100:101], v52 offset0:192 offset1:193
  ds_read2_b32 v[102:103], v52 offset0:194 offset1:195
  ds_read2_b32 v[104:105], v52 offset0:176 offset1:177
  ds_read2_b32 v[106:107], v52 offset0:178 offset1:179
  s_waitcnt lgkmcnt(6)
  v_mfma_f32_16x16x32_bf16 v[60:63], v[92:95], a[28:31], 0
  v_mfma_f32_16x16x32_bf16 v[64:67], v[92:95], a[60:63], 0
  v_mfma_f32_16x16x32_bf16 v[68:71], v[92:95], a[92:95], 0
  v_mfma_f32_16x16x32_bf16 v[72:75], v[92:95], a[124:127], 0
  v_mfma_f32_16x16x32_bf16 v[76:79], v[92:95], a[156:159], 0
  v_mfma_f32_16x16x32_bf16 v[80:83], v[92:95], a[188:191], 0
  v_mfma_f32_16x16x32_bf16 v[84:87], v[92:95], a[220:223], 0
  v_mfma_f32_16x16x32_bf16 v[88:91], v[92:95], a[252:255], 0
  ds_read2_b32 v[92:93], v52 offset0:160 offset1:161
  ds_read2_b32 v[94:95], v52 offset0:162 offset1:163
  s_waitcnt lgkmcnt(6)
  v_mfma_f32_16x16x32_bf16 v[60:63], v[96:99], a[24:27], v[60:63]
  v_mfma_f32_16x16x32_bf16 v[64:67], v[96:99], a[56:59], v[64:67]
  v_mfma_f32_16x16x32_bf16 v[68:71], v[96:99], a[88:91], v[68:71]
  v_mfma_f32_16x16x32_bf16 v[72:75], v[96:99], a[120:123], v[72:75]
  v_mfma_f32_16x16x32_bf16 v[76:79], v[96:99], a[152:155], v[76:79]
  v_mfma_f32_16x16x32_bf16 v[80:83], v[96:99], a[184:187], v[80:83]
  v_mfma_f32_16x16x32_bf16 v[84:87], v[96:99], a[216:219], v[84:87]
  v_mfma_f32_16x16x32_bf16 v[88:91], v[96:99], a[248:251], v[88:91]
  ds_read2_b32 v[96:97], v52 offset0:144 offset1:145
  ds_read2_b32 v[98:99], v52 offset0:146 offset1:147
  s_waitcnt lgkmcnt(6)
  v_mfma_f32_16x16x32_bf16 v[60:63], v[100:103], a[20:23], v[60:63]
  v_mfma_f32_16x16x32_bf16 v[64:67], v[100:103], a[52:55], v[64:67]
  v_mfma_f32_16x16x32_bf16 v[68:71], v[100:103], a[84:87], v[68:71]
  v_mfma_f32_16x16x32_bf16 v[72:75], v[100:103], a[116:119], v[72:75]
  v_mfma_f32_16x16x32_bf16 v[76:79], v[100:103], a[148:151], v[76:79]
  v_mfma_f32_16x16x32_bf16 v[80:83], v[100:103], a[180:183], v[80:83]
  v_mfma_f32_16x16x32_bf16 v[84:87], v[100:103], a[212:215], v[84:87]
  v_mfma_f32_16x16x32_bf16 v[88:91], v[100:103], a[244:247], v[88:91]
  ds_read2_b32 v[100:101], v52 offset0:128 offset1:129
  ds_read2_b32 v[102:103], v52 offset0:130 offset1:131
  s_waitcnt lgkmcnt(6)
  v_mfma_f32_16x16x32_bf16 v[60:63], v[104:107], a[16:19], v[60:63]
  v_mfma_f32_16x16x32_bf16 v[64:67], v[104:107], a[48:51], v[64:67]
  v_mfma_f32_16x16x32_bf16 v[68:71], v[104:107], a[80:83], v[68:71]
  v_mfma_f32_16x16x32_bf16 v[72:75], v[104:107], a[112:115], v[72:75]
  v_mfma_f32_16x16x32_bf16 v[76:79], v[104:107], a[144:147], v[76:79]
  v_mfma_f32_16x16x32_bf16 v[80:83], v[104:107], a[176:179], v[80:83]
  v_mfma_f32_16x16x32_bf16 v[84:87], v[104:107], a[208:211], v[84:87]
  v_mfma_f32_16x16x32_bf16 v[88:91], v[104:107], a[240:243], v[88:91]
  ds_read2_b32 v[104:105], v52 offset0:112 offset1:113
  ds_read2_b32 v[106:107], v52 offset0:114 offset1:115
  s_waitcnt lgkmcnt(6)
  v_mfma_f32_16x16x32_bf16 v[60:63], v[92:95], a[12:15], v[60:63]
  v_mfma_f32_16x16x32_bf16 v[64:67], v[92:95], a[44:47], v[64:67]
  v_mfma_f32_16x16x32_bf16 v[68:71], v[92:95], a[76:79], v[68:71]
  v_mfma_f32_16x16x32_bf16 v[72:75], v[92:95], a[108:111], v[72:75]
  v_mfma_f32_16x16x32_bf16 v[76:79], v[92:95], a[140:143], v[76:79]
  v_mfma_f32_16x16x32_bf16 v[80:83], v[92:95], a[172:175], v[80:83]
  v_mfma_f32_16x16x32_bf16 v[84:87], v[92:95], a[204:207], v[84:87]
  v_mfma_f32_16x16x32_bf16 v[88:91], v[92:95], a[236:239], v[88:91]
  ds_read2_b32 v[92:93], v52 offset0:96 offset1:97
  ds_read2_b32 v[94:95], v52 offset0:98 offset1:99
  s_waitcnt lgkmcnt(6)
  v_mfma_f32_16x16x32_bf16 v[60:63], v[96:99], a[8:11], v[60:63]
  v_mfma_f32_16x16x32_bf16 v[64:67], v[96:99], a[40:43], v[64:67]
  v_mfma_f32_16x16x32_bf16 v[68:71], v[96:99], a[72:75], v[68:71]
  v_mfma_f32_16x16x32_bf16 v[72:75], v[96:99], a[104:107], v[72:75]
  v_mfma_f32_16x16x32_bf16 v[76:79], v[96:99], a[136:139], v[76:79]
  v_mfma_f32_16x16x32_bf16 v[80:83], v[96:99], a[168:171], v[80:83]
  v_mfma_f32_16x16x32_bf16 v[84:87], v[96:99], a[200:203], v[84:87]
  v_mfma_f32_16x16x32_bf16 v[88:91], v[96:99], a[232:235], v[88:91]
  ds_read2_b32 v[96:97], v52 offset0:80 offset1:81
  ds_read2_b32 v[98:99], v52 offset0:82 offset1:83
  s_waitcnt lgkmcnt(6)
  v_mfma_f32_16x16x32_bf16 v[60:63], v[100:103], a[4:7], v[60:63]
  v_mfma_f32_16x16x32_bf16 v[64:67], v[100:103], a[36:39], v[64:67]
  v_mfma_f32_16x16x32_bf16 v[68:71], v[100:103], a[68:71], v[68:71]
  v_mfma_f32_16x16x32_bf16 v[72:75], v[100:103], a[100:103], v[72:75]
  v_mfma_f32_16x16x32_bf16 v[76:79], v[100:103], a[132:135], v[76:79]
  v_mfma_f32_16x16x32_bf16 v[80:83], v[100:103], a[164:167], v[80:83]
  v_mfma_f32_16x16x32_bf16 v[84:87], v[100:103], a[196:199], v[84:87]
  v_mfma_f32_16x16x32_bf16 v[88:91], v[100:103], a[228:231], v[88:91]
  ds_read2_b32 v[100:101], v52 offset0:64 offset1:65
  ds_read2_b32 v[102:103], v52 offset0:66 offset1:67
  s_waitcnt lgkmcnt(6)
  v_mfma_f32_16x16x32_bf16 v[60:63], v[104:107], a[0:3], v[60:63]
  v_mfma_f32_16x16x32_bf16 v[64:67], v[104:107], a[32:35], v[64:67]
  v_mfma_f32_16x16x32_bf16 v[68:71], v[104:107], a[64:67], v[68:71]
  v_mfma_f32_16x16x32_bf16 v[72:75], v[104:107], a[96:99], v[72:75]
  v_mfma_f32_16x16x32_bf16 v[76:79], v[104:107], a[128:131], v[76:79]
  v_mfma_f32_16x16x32_bf16 v[80:83], v[104:107], a[160:163], v[80:83]
  v_mfma_f32_16x16x32_bf16 v[84:87], v[104:107], a[192:195], v[84:87]
  v_mfma_f32_16x16x32_bf16 v[88:91], v[104:107], a[224:227], v[88:91]
  ds_read2_b32 v[104:105], v52 offset0:48 offset1:49
  ds_read2_b32 v[106:107], v52 offset0:50 offset1:51
  s_waitcnt lgkmcnt(6)
  v_mfma_f32_16x16x32_bf16 v[64:67], v[92:95], a[28:31], v[64:67]
  v_mfma_f32_16x16x32_bf16 v[68:71], v[92:95], a[60:63], v[68:71]
  v_mfma_f32_16x16x32_bf16 v[72:75], v[92:95], a[92:95], v[72:75]
  v_mfma_f32_16x16x32_bf16 v[76:79], v[92:95], a[124:127], v[76:79]
  v_mfma_f32_16x16x32_bf16 v[80:83], v[92:95], a[156:159], v[80:83]
  v_mfma_f32_16x16x32_bf16 v[84:87], v[92:95], a[188:191], v[84:87]
  v_mfma_f32_16x16x32_bf16 v[88:91], v[92:95], a[220:223], v[88:91]
  ds_read2_b32 v[92:93], v52 offset0:32 offset1:33
  ds_read2_b32 v[94:95], v52 offset0:34 offset1:35
  s_waitcnt lgkmcnt(6)
  v_mfma_f32_16x16x32_bf16 v[64:67], v[96:99], a[24:27], v[64:67]
  v_mfma_f32_16x16x32_bf16 v[68:71], v[96:99], a[56:59], v[68:71]
  v_mfma_f32_16x16x32_bf16 v[72:75], v[96:99], a[88:91], v[72:75]
  v_mfma_f32_16x16x32_bf16 v[76:79], v[96:99], a[120:123], v[76:79]
  v_mfma_f32_16x16x32_bf16 v[80:83], v[96:99], a[152:155], v[80:83]
  v_mfma_f32_16x16x32_bf16 v[84:87], v[96:99], a[184:187], v[84:87]
  v_mfma_f32_16x16x32_bf16 v[88:91], v[96:99], a[216:219], v[88:91]
  ds_read2_b32 v[96:97], v52 offset0:16 offset1:17
  ds_read2_b32 v[98:99], v52 offset0:18 offset1:19
  s_waitcnt lgkmcnt(6)
  v_mfma_f32_16x16x32_bf16 v[64:67], v[100:103], a[20:23], v[64:67]
  v_mfma_f32_16x16x32_bf16 v[68:71], v[100:103], a[52:55], v[68:71]
  v_mfma_f32_16x16x32_bf16 v[72:75], v[100:103], a[84:87], v[72:75]
  v_mfma_f32_16x16x32_bf16 v[76:79], v[100:103], a[116:119], v[76:79]
  v_mfma_f32_16x16x32_bf16 v[80:83], v[100:103], a[148:151], v[80:83]
  v_mfma_f32_16x16x32_bf16 v[84:87], v[100:103], a[180:183], v[84:87]
  v_mfma_f32_16x16x32_bf16 v[88:91], v[100:103], a[212:215], v[88:91]
  ds_read2_b32 v[100:101], v52 offset0:0 offset1:1
  ds_read2_b32 v[102:103], v52 offset0:2 offset1:3
  s_waitcnt lgkmcnt(6)
  v_mfma_f32_16x16x32_bf16 v[64:67], v[104:107], a[16:19], v[64:67]
  v_mfma_f32_16x16x32_bf16 v[68:71], v[104:107], a[48:51], v[68:71]
  v_mfma_f32_16x16x32_bf16 v[72:75], v[104:107], a[80:83], v[72:75]
  v_mfma_f32_16x16x32_bf16 v[76:79], v[104:107], a[112:115], v[76:79]
  v_mfma_f32_16x16x32_bf16 v[80:83], v[104:107], a[144:147], v[80:83]
  v_mfma_f32_16x16x32_bf16 v[84:87], v[104:107], a[176:179], v[84:87]
  v_mfma_f32_16x16x32_bf16 v[88:91], v[104:107], a[208:211], v[88:91]
  ds_read2_b32 v[104:105], v53 offset0:224 offset1:225
  ds_read2_b32 v[106:107], v53 offset0:226 offset1:227
  s_waitcnt lgkmcnt(6)
  v_mfma_f32_16x16x32_bf16 v[64:67], v[92:95], a[12:15], v[64:67]
  v_mfma_f32_16x16x32_bf16 v[68:71], v[92:95], a[44:47], v[68:71]
  v_mfma_f32_16x16x32_bf16 v[72:75], v[92:95], a[76:79], v[72:75]
  v_mfma_f32_16x16x32_bf16 v[76:79], v[92:95], a[108:111], v[76:79]
  v_mfma_f32_16x16x32_bf16 v[80:83], v[92:95], a[140:143], v[80:83]
  v_mfma_f32_16x16x32_bf16 v[84:87], v[92:95], a[172:175], v[84:87]
  v_mfma_f32_16x16x32_bf16 v[88:91], v[92:95], a[204:207], v[88:91]
  ds_read2_b32 v[92:93], v53 offset0:208 offset1:209
  ds_read2_b32 v[94:95], v53 offset0:210 offset1:211
  s_waitcnt lgkmcnt(6)
  v_mfma_f32_16x16x32_bf16 v[64:67], v[96:99], a[8:11], v[64:67]
  v_mfma_f32_16x16x32_bf16 v[68:71], v[96:99], a[40:43], v[68:71]
  v_mfma_f32_16x16x32_bf16 v[72:75], v[96:99], a[72:75], v[72:75]
  v_mfma_f32_16x16x32_bf16 v[76:79], v[96:99], a[104:107], v[76:79]
  v_mfma_f32_16x16x32_bf16 v[80:83], v[96:99], a[136:139], v[80:83]
  v_mfma_f32_16x16x32_bf16 v[84:87], v[96:99], a[168:171], v[84:87]
  v_mfma_f32_16x16x32_bf16 v[88:91], v[96:99], a[200:203], v[88:91]
  ds_read2_b32 v[96:97], v53 offset0:192 offset1:193
  ds_read2_b32 v[98:99], v53 offset0:194 offset1:195
  s_waitcnt lgkmcnt(6)
  v_mfma_f32_16x16x32_bf16 v[64:67], v[100:103], a[4:7], v[64:67]
  v_mfma_f32_16x16x32_bf16 v[68:71], v[100:103], a[36:39], v[68:71]
  v_mfma_f32_16x16x32_bf16 v[72:75], v[100:103], a[68:71], v[72:75]
  v_mfma_f32_16x16x32_bf16 v[76:79], v[100:103], a[100:103], v[76:79]
  v_mfma_f32_16x16x32_bf16 v[80:83], v[100:103], a[132:135], v[80:83]
  v_mfma_f32_16x16x32_bf16 v[84:87], v[100:103], a[164:167], v[84:87]
  v_mfma_f32_16x16x32_bf16 v[88:91], v[100:103], a[196:199], v[88:91]
  ds_read2_b32 v[100:101], v53 offset0:176 offset1:177
  ds_read2_b32 v[102:103], v53 offset0:178 offset1:179
  s_waitcnt lgkmcnt(6)
  v_mfma_f32_16x16x32_bf16 v[64:67], v[104:107], a[0:3], v[64:67]
  v_mfma_f32_16x16x32_bf16 v[68:71], v[104:107], a[32:35], v[68:71]
  v_mfma_f32_16x16x32_bf16 v[72:75], v[104:107], a[64:67], v[72:75]
  v_mfma_f32_16x16x32_bf16 v[76:79], v[104:107], a[96:99], v[76:79]
  v_mfma_f32_16x16x32_bf16 v[80:83], v[104:107], a[128:131], v[80:83]
  v_mfma_f32_16x16x32_bf16 v[84:87], v[104:107], a[160:163], v[84:87]
  v_mfma_f32_16x16x32_bf16 v[88:91], v[104:107], a[192:195], v[88:91]
  ds_read2_b32 v[104:105], v53 offset0:160 offset1:161
  ds_read2_b32 v[106:107], v53 offset0:162 offset1:163
  s_waitcnt lgkmcnt(6)
  v_mfma_f32_16x16x32_bf16 v[68:71], v[92:95], a[28:31], v[68:71]
  v_mfma_f32_16x16x32_bf16 v[72:75], v[92:95], a[60:63], v[72:75]
  v_mfma_f32_16x16x32_bf16 v[76:79], v[92:95], a[92:95], v[76:79]
  v_mfma_f32_16x16x32_bf16 v[80:83], v[92:95], a[124:127], v[80:83]
  v_mfma_f32_16x16x32_bf16 v[84:87], v[92:95], a[156:159], v[84:87]
  v_mfma_f32_16x16x32_bf16 v[88:91], v[92:95], a[188:191], v[88:91]
  ds_read2_b32 v[92:93], v53 offset0:144 offset1:145
  ds_read2_b32 v[94:95], v53 offset0:146 offset1:147
  s_waitcnt lgkmcnt(6)
  v_mfma_f32_16x16x32_bf16 v[68:71], v[96:99], a[24:27], v[68:71]
  v_mfma_f32_16x16x32_bf16 v[72:75], v[96:99], a[56:59], v[72:75]
  v_mfma_f32_16x16x32_bf16 v[76:79], v[96:99], a[88:91], v[76:79]
  v_mfma_f32_16x16x32_bf16 v[80:83], v[96:99], a[120:123], v[80:83]
  v_mfma_f32_16x16x32_bf16 v[84:87], v[96:99], a[152:155], v[84:87]
  v_mfma_f32_16x16x32_bf16 v[88:91], v[96:99], a[184:187], v[88:91]
  ds_read2_b32 v[96:97], v53 offset0:128 offset1:129
  ds_read2_b32 v[98:99], v53 offset0:130 offset1:131
  s_waitcnt lgkmcnt(6)
  v_mfma_f32_16x16x32_bf16 v[68:71], v[100:103], a[20:23], v[68:71]
  v_mfma_f32_16x16x32_bf16 v[72:75], v[100:103], a[52:55], v[72:75]
  v_mfma_f32_16x16x32_bf16 v[76:79], v[100:103], a[84:87], v[76:79]
  v_mfma_f32_16x16x32_bf16 v[80:83], v[100:103], a[116:119], v[80:83]
  v_mfma_f32_16x16x32_bf16 v[84:87], v[100:103], a[148:151], v[84:87]
  v_mfma_f32_16x16x32_bf16 v[88:91], v[100:103], a[180:183], v[88:91]
  ds_read2_b32 v[100:101], v53 offset0:112 offset1:113
  ds_read2_b32 v[102:103], v53 offset0:114 offset1:115
  s_waitcnt lgkmcnt(6)
  v_mfma_f32_16x16x32_bf16 v[68:71], v[104:107], a[16:19], v[68:71]
  v_mfma_f32_16x16x32_bf16 v[72:75], v[104:107], a[48:51], v[72:75]
  v_mfma_f32_16x16x32_bf16 v[76:79], v[104:107], a[80:83], v[76:79]
  v_mfma_f32_16x16x32_bf16 v[80:83], v[104:107], a[112:115], v[80:83]
  v_mfma_f32_16x16x32_bf16 v[84:87], v[104:107], a[144:147], v[84:87]
  v_mfma_f32_16x16x32_bf16 v[88:91], v[104:107], a[176:179], v[88:91]
  ds_read2_b32 v[104:105], v53 offset0:96 offset1:97
  ds_read2_b32 v[106:107], v53 offset0:98 offset1:99
  s_waitcnt lgkmcnt(6)
  v_mfma_f32_16x16x32_bf16 v[68:71], v[92:95], a[12:15], v[68:71]
  v_mfma_f32_16x16x32_bf16 v[72:75], v[92:95], a[44:47], v[72:75]
  v_mfma_f32_16x16x32_bf16 v[76:79], v[92:95], a[76:79], v[76:79]
  v_mfma_f32_16x16x32_bf16 v[80:83], v[92:95], a[108:111], v[80:83]
  v_mfma_f32_16x16x32_bf16 v[84:87], v[92:95], a[140:143], v[84:87]
  v_mfma_f32_16x16x32_bf16 v[88:91], v[92:95], a[172:175], v[88:91]
  ds_read2_b32 v[92:93], v53 offset0:80 offset1:81
  ds_read2_b32 v[94:95], v53 offset0:82 offset1:83
  s_waitcnt lgkmcnt(6)
  v_mfma_f32_16x16x32_bf16 v[68:71], v[96:99], a[8:11], v[68:71]
  v_mfma_f32_16x16x32_bf16 v[72:75], v[96:99], a[40:43], v[72:75]
  v_mfma_f32_16x16x32_bf16 v[76:79], v[96:99], a[72:75], v[76:79]
  v_mfma_f32_16x16x32_bf16 v[80:83], v[96:99], a[104:107], v[80:83]
  v_mfma_f32_16x16x32_bf16 v[84:87], v[96:99], a[136:139], v[84:87]
  v_mfma_f32_16x16x32_bf16 v[88:91], v[96:99], a[168:171], v[88:91]
  ds_read2_b32 v[96:97], v53 offset0:64 offset1:65
  ds_read2_b32 v[98:99], v53 offset0:66 offset1:67
  s_waitcnt lgkmcnt(6)
  v_mfma_f32_16x16x32_bf16 v[68:71], v[100:103], a[4:7], v[68:71]
  v_mfma_f32_16x16x32_bf16 v[72:75], v[100:103], a[36:39], v[72:75]
  v_mfma_f32_16x16x32_bf16 v[76:79], v[100:103], a[68:71], v[76:79]
  v_mfma_f32_16x16x32_bf16 v[80:83], v[100:103], a[100:103], v[80:83]
  v_mfma_f32_16x16x32_bf16 v[84:87], v[100:103], a[132:135], v[84:87]
  v_mfma_f32_16x16x32_bf16 v[88:91], v[100:103], a[164:167], v[88:91]
  ds_read2_b32 v[100:101], v53 offset0:48 offset1:49
  ds_read2_b32 v[102:103], v53 offset0:50 offset1:51
  s_waitcnt lgkmcnt(6)
  v_mfma_f32_16x16x32_bf16 v[68:71], v[104:107], a[0:3], v[68:71]
  v_mfma_f32_16x16x32_bf16 v[72:75], v[104:107], a[32:35], v[72:75]
  v_mfma_f32_16x16x32_bf16 v[76:79], v[104:107], a[64:67], v[76:79]
  v_mfma_f32_16x16x32_bf16 v[80:83], v[104:107], a[96:99], v[80:83]
  v_mfma_f32_16x16x32_bf16 v[84:87], v[104:107], a[128:131], v[84:87]
  v_mfma_f32_16x16x32_bf16 v[88:91], v[104:107], a[160:163], v[88:91]
  ds_read2_b32 v[104:105], v53 offset0:32 offset1:33
  ds_read2_b32 v[106:107], v53 offset0:34 offset1:35
  s_waitcnt lgkmcnt(6)
  v_mfma_f32_16x16x32_bf16 v[72:75], v[92:95], a[28:31], v[72:75]
  v_mfma_f32_16x16x32_bf16 v[76:79], v[92:95], a[60:63], v[76:79]
  v_mfma_f32_16x16x32_bf16 v[80:83], v[92:95], a[92:95], v[80:83]
  v_mfma_f32_16x16x32_bf16 v[84:87], v[92:95], a[124:127], v[84:87]
  v_mfma_f32_16x16x32_bf16 v[88:91], v[92:95], a[156:159], v[88:91]
  ds_read2_b32 v[92:93], v53 offset0:16 offset1:17
  ds_read2_b32 v[94:95], v53 offset0:18 offset1:19
  s_waitcnt lgkmcnt(6)
  v_mfma_f32_16x16x32_bf16 v[72:75], v[96:99], a[24:27], v[72:75]
  v_mfma_f32_16x16x32_bf16 v[76:79], v[96:99], a[56:59], v[76:79]
  v_mfma_f32_16x16x32_bf16 v[80:83], v[96:99], a[88:91], v[80:83]
  v_mfma_f32_16x16x32_bf16 v[84:87], v[96:99], a[120:123], v[84:87]
  v_mfma_f32_16x16x32_bf16 v[88:91], v[96:99], a[152:155], v[88:91]
  ds_read2_b32 v[96:97], v53 offset0:0 offset1:1
  ds_read2_b32 v[98:99], v53 offset0:2 offset1:3
  s_waitcnt lgkmcnt(6)
  v_mfma_f32_16x16x32_bf16 v[72:75], v[100:103], a[20:23], v[72:75]
  v_mfma_f32_16x16x32_bf16 v[76:79], v[100:103], a[52:55], v[76:79]
  v_mfma_f32_16x16x32_bf16 v[80:83], v[100:103], a[84:87], v[80:83]
  v_mfma_f32_16x16x32_bf16 v[84:87], v[100:103], a[116:119], v[84:87]
  v_mfma_f32_16x16x32_bf16 v[88:91], v[100:103], a[148:151], v[88:91]
  ds_read2_b32 v[100:101], v54 offset0:224 offset1:225
  ds_read2_b32 v[102:103], v54 offset0:226 offset1:227
  s_waitcnt lgkmcnt(6)
  v_mfma_f32_16x16x32_bf16 v[72:75], v[104:107], a[16:19], v[72:75]
  v_mfma_f32_16x16x32_bf16 v[76:79], v[104:107], a[48:51], v[76:79]
  v_mfma_f32_16x16x32_bf16 v[80:83], v[104:107], a[80:83], v[80:83]
  v_mfma_f32_16x16x32_bf16 v[84:87], v[104:107], a[112:115], v[84:87]
  v_mfma_f32_16x16x32_bf16 v[88:91], v[104:107], a[144:147], v[88:91]
  ds_read2_b32 v[104:105], v54 offset0:208 offset1:209
  ds_read2_b32 v[106:107], v54 offset0:210 offset1:211
  s_waitcnt lgkmcnt(6)
  v_mfma_f32_16x16x32_bf16 v[72:75], v[92:95], a[12:15], v[72:75]
  v_mfma_f32_16x16x32_bf16 v[76:79], v[92:95], a[44:47], v[76:79]
  v_mfma_f32_16x16x32_bf16 v[80:83], v[92:95], a[76:79], v[80:83]
  v_mfma_f32_16x16x32_bf16 v[84:87], v[92:95], a[108:111], v[84:87]
  v_mfma_f32_16x16x32_bf16 v[88:91], v[92:95], a[140:143], v[88:91]
  ds_read2_b32 v[92:93], v54 offset0:192 offset1:193
  ds_read2_b32 v[94:95], v54 offset0:194 offset1:195
  s_waitcnt lgkmcnt(6)
  v_mfma_f32_16x16x32_bf16 v[72:75], v[96:99], a[8:11], v[72:75]
  v_mfma_f32_16x16x32_bf16 v[76:79], v[96:99], a[40:43], v[76:79]
  v_mfma_f32_16x16x32_bf16 v[80:83], v[96:99], a[72:75], v[80:83]
  v_mfma_f32_16x16x32_bf16 v[84:87], v[96:99], a[104:107], v[84:87]
  v_mfma_f32_16x16x32_bf16 v[88:91], v[96:99], a[136:139], v[88:91]
  ds_read2_b32 v[96:97], v54 offset0:176 offset1:177
  ds_read2_b32 v[98:99], v54 offset0:178 offset1:179
  s_waitcnt lgkmcnt(6)
  v_mfma_f32_16x16x32_bf16 v[72:75], v[100:103], a[4:7], v[72:75]
  v_mfma_f32_16x16x32_bf16 v[76:79], v[100:103], a[36:39], v[76:79]
  v_mfma_f32_16x16x32_bf16 v[80:83], v[100:103], a[68:71], v[80:83]
  v_mfma_f32_16x16x32_bf16 v[84:87], v[100:103], a[100:103], v[84:87]
  v_mfma_f32_16x16x32_bf16 v[88:91], v[100:103], a[132:135], v[88:91]
  ds_read2_b32 v[100:101], v54 offset0:160 offset1:161
  ds_read2_b32 v[102:103], v54 offset0:162 offset1:163
  s_waitcnt lgkmcnt(6)
  v_mfma_f32_16x16x32_bf16 v[72:75], v[104:107], a[0:3], v[72:75]
  v_mfma_f32_16x16x32_bf16 v[76:79], v[104:107], a[32:35], v[76:79]
  v_mfma_f32_16x16x32_bf16 v[80:83], v[104:107], a[64:67], v[80:83]
  v_mfma_f32_16x16x32_bf16 v[84:87], v[104:107], a[96:99], v[84:87]
  v_mfma_f32_16x16x32_bf16 v[88:91], v[104:107], a[128:131], v[88:91]
  ds_read2_b32 v[104:105], v54 offset0:144 offset1:145
  ds_read2_b32 v[106:107], v54 offset0:146 offset1:147
  s_waitcnt lgkmcnt(6)
  v_mfma_f32_16x16x32_bf16 v[76:79], v[92:95], a[28:31], v[76:79]
  v_mfma_f32_16x16x32_bf16 v[80:83], v[92:95], a[60:63], v[80:83]
  v_mfma_f32_16x16x32_bf16 v[84:87], v[92:95], a[92:95], v[84:87]
  v_mfma_f32_16x16x32_bf16 v[88:91], v[92:95], a[124:127], v[88:91]
  ds_read2_b32 v[92:93], v54 offset0:128 offset1:129
  ds_read2_b32 v[94:95], v54 offset0:130 offset1:131
  s_waitcnt lgkmcnt(6)
  v_mfma_f32_16x16x32_bf16 v[76:79], v[96:99], a[24:27], v[76:79]
  v_mfma_f32_16x16x32_bf16 v[80:83], v[96:99], a[56:59], v[80:83]
  v_mfma_f32_16x16x32_bf16 v[84:87], v[96:99], a[88:91], v[84:87]
  v_mfma_f32_16x16x32_bf16 v[88:91], v[96:99], a[120:123], v[88:91]
  ds_read2_b32 v[96:97], v54 offset0:112 offset1:113
  ds_read2_b32 v[98:99], v54 offset0:114 offset1:115
  s_waitcnt lgkmcnt(6)
  v_mfma_f32_16x16x32_bf16 v[76:79], v[100:103], a[20:23], v[76:79]
  v_mfma_f32_16x16x32_bf16 v[80:83], v[100:103], a[52:55], v[80:83]
  v_mfma_f32_16x16x32_bf16 v[84:87], v[100:103], a[84:87], v[84:87]
  v_mfma_f32_16x16x32_bf16 v[88:91], v[100:103], a[116:119], v[88:91]
  ds_read2_b32 v[100:101], v54 offset0:96 offset1:97
  ds_read2_b32 v[102:103], v54 offset0:98 offset1:99
  s_waitcnt lgkmcnt(6)
  v_mfma_f32_16x16x32_bf16 v[76:79], v[104:107], a[16:19], v[76:79]
  v_mfma_f32_16x16x32_bf16 v[80:83], v[104:107], a[48:51], v[80:83]
  v_mfma_f32_16x16x32_bf16 v[84:87], v[104:107], a[80:83], v[84:87]
  v_mfma_f32_16x16x32_bf16 v[88:91], v[104:107], a[112:115], v[88:91]
  ds_read2_b32 v[104:105], v54 offset0:80 offset1:81
  ds_read2_b32 v[106:107], v54 offset0:82 offset1:83
  s_waitcnt lgkmcnt(6)
  v_mfma_f32_16x16x32_bf16 v[76:79], v[92:95], a[12:15], v[76:79]
  v_mfma_f32_16x16x32_bf16 v[80:83], v[92:95], a[44:47], v[80:83]
  v_mfma_f32_16x16x32_bf16 v[84:87], v[92:95], a[76:79], v[84:87]
  v_mfma_f32_16x16x32_bf16 v[88:91], v[92:95], a[108:111], v[88:91]
  ds_read2_b32 v[92:93], v54 offset0:64 offset1:65
  ds_read2_b32 v[94:95], v54 offset0:66 offset1:67
  s_waitcnt lgkmcnt(6)
  v_mfma_f32_16x16x32_bf16 v[76:79], v[96:99], a[8:11], v[76:79]
  v_mfma_f32_16x16x32_bf16 v[80:83], v[96:99], a[40:43], v[80:83]
  v_mfma_f32_16x16x32_bf16 v[84:87], v[96:99], a[72:75], v[84:87]
  v_mfma_f32_16x16x32_bf16 v[88:91], v[96:99], a[104:107], v[88:91]
  ds_read2_b32 v[96:97], v54 offset0:48 offset1:49
  ds_read2_b32 v[98:99], v54 offset0:50 offset1:51
  s_waitcnt lgkmcnt(6)
  v_mfma_f32_16x16x32_bf16 v[76:79], v[100:103], a[4:7], v[76:79]
  v_mfma_f32_16x16x32_bf16 v[80:83], v[100:103], a[36:39], v[80:83]
  v_mfma_f32_16x16x32_bf16 v[84:87], v[100:103], a[68:71], v[84:87]
  v_mfma_f32_16x16x32_bf16 v[88:91], v[100:103], a[100:103], v[88:91]
  ds_read2_b32 v[100:101], v54 offset0:32 offset1:33
  ds_read2_b32 v[102:103], v54 offset0:34 offset1:35
  s_waitcnt lgkmcnt(6)
  v_mfma_f32_16x16x32_bf16 v[76:79], v[104:107], a[0:3], v[76:79]
  v_mfma_f32_16x16x32_bf16 v[80:83], v[104:107], a[32:35], v[80:83]
  v_mfma_f32_16x16x32_bf16 v[84:87], v[104:107], a[64:67], v[84:87]
  v_mfma_f32_16x16x32_bf16 v[88:91], v[104:107], a[96:99], v[88:91]
  ds_read2_b32 v[104:105], v54 offset0:16 offset1:17
  ds_read2_b32 v[106:107], v54 offset0:18 offset1:19
  s_waitcnt lgkmcnt(6)
  v_mfma_f32_16x16x32_bf16 v[80:83], v[92:95], a[28:31], v[80:83]
  v_mfma_f32_16x16x32_bf16 v[84:87], v[92:95], a[60:63], v[84:87]
  v_mfma_f32_16x16x32_bf16 v[88:91], v[92:95], a[92:95], v[88:91]
  ds_read2_b32 v[92:93], v54 offset0:0 offset1:1
  ds_read2_b32 v[94:95], v54 offset0:2 offset1:3
  s_waitcnt lgkmcnt(6)
  v_mfma_f32_16x16x32_bf16 v[80:83], v[96:99], a[24:27], v[80:83]
  v_mfma_f32_16x16x32_bf16 v[84:87], v[96:99], a[56:59], v[84:87]
  v_mfma_f32_16x16x32_bf16 v[88:91], v[96:99], a[88:91], v[88:91]
  ds_read2_b32 v[96:97], v55 offset0:224 offset1:225
  ds_read2_b32 v[98:99], v55 offset0:226 offset1:227
  s_waitcnt lgkmcnt(6)
  v_mfma_f32_16x16x32_bf16 v[80:83], v[100:103], a[20:23], v[80:83]
  v_mfma_f32_16x16x32_bf16 v[84:87], v[100:103], a[52:55], v[84:87]
  v_mfma_f32_16x16x32_bf16 v[88:91], v[100:103], a[84:87], v[88:91]
  ds_read2_b32 v[100:101], v55 offset0:208 offset1:209
  ds_read2_b32 v[102:103], v55 offset0:210 offset1:211
  s_waitcnt lgkmcnt(6)
  v_mfma_f32_16x16x32_bf16 v[80:83], v[104:107], a[16:19], v[80:83]
  v_mfma_f32_16x16x32_bf16 v[84:87], v[104:107], a[48:51], v[84:87]
  v_mfma_f32_16x16x32_bf16 v[88:91], v[104:107], a[80:83], v[88:91]
  ds_read2_b32 v[104:105], v55 offset0:192 offset1:193
  ds_read2_b32 v[106:107], v55 offset0:194 offset1:195
  s_waitcnt lgkmcnt(6)
  v_mfma_f32_16x16x32_bf16 v[80:83], v[92:95], a[12:15], v[80:83]
  v_mfma_f32_16x16x32_bf16 v[84:87], v[92:95], a[44:47], v[84:87]
  v_mfma_f32_16x16x32_bf16 v[88:91], v[92:95], a[76:79], v[88:91]
  ds_read2_b32 v[92:93], v55 offset0:176 offset1:177
  ds_read2_b32 v[94:95], v55 offset0:178 offset1:179
  s_waitcnt lgkmcnt(6)
  v_mfma_f32_16x16x32_bf16 v[80:83], v[96:99], a[8:11], v[80:83]
  v_mfma_f32_16x16x32_bf16 v[84:87], v[96:99], a[40:43], v[84:87]
  v_mfma_f32_16x16x32_bf16 v[88:91], v[96:99], a[72:75], v[88:91]
  ds_read2_b32 v[96:97], v55 offset0:160 offset1:161
  ds_read2_b32 v[98:99], v55 offset0:162 offset1:163
  s_waitcnt lgkmcnt(6)
  v_mfma_f32_16x16x32_bf16 v[80:83], v[100:103], a[4:7], v[80:83]
  v_mfma_f32_16x16x32_bf16 v[84:87], v[100:103], a[36:39], v[84:87]
  v_mfma_f32_16x16x32_bf16 v[88:91], v[100:103], a[68:71], v[88:91]
  ds_read2_b32 v[100:101], v55 offset0:144 offset1:145
  ds_read2_b32 v[102:103], v55 offset0:146 offset1:147
  s_waitcnt lgkmcnt(6)
  v_mfma_f32_16x16x32_bf16 v[80:83], v[104:107], a[0:3], v[80:83]
  v_mfma_f32_16x16x32_bf16 v[84:87], v[104:107], a[32:35], v[84:87]
  v_mfma_f32_16x16x32_bf16 v[88:91], v[104:107], a[64:67], v[88:91]
  ds_read2_b32 v[104:105], v55 offset0:128 offset1:129
  ds_read2_b32 v[106:107], v55 offset0:130 offset1:131
  s_waitcnt lgkmcnt(6)
  v_mfma_f32_16x16x32_bf16 v[84:87], v[92:95], a[28:31], v[84:87]
  v_mfma_f32_16x16x32_bf16 v[88:91], v[92:95], a[60:63], v[88:91]
  ds_read2_b32 v[92:93], v55 offset0:112 offset1:113
  ds_read2_b32 v[94:95], v55 offset0:114 offset1:115
  s_waitcnt lgkmcnt(6)
  v_mfma_f32_16x16x32_bf16 v[84:87], v[96:99], a[24:27], v[84:87]
  v_mfma_f32_16x16x32_bf16 v[88:91], v[96:99], a[56:59], v[88:91]
  ds_read2_b32 v[96:97], v55 offset0:96 offset1:97
  ds_read2_b32 v[98:99], v55 offset0:98 offset1:99
  s_waitcnt lgkmcnt(6)
  v_mfma_f32_16x16x32_bf16 v[84:87], v[100:103], a[20:23], v[84:87]
  v_mfma_f32_16x16x32_bf16 v[88:91], v[100:103], a[52:55], v[88:91]
  ds_read2_b32 v[100:101], v55 offset0:80 offset1:81
  ds_read2_b32 v[102:103], v55 offset0:82 offset1:83
  s_waitcnt lgkmcnt(6)
  v_mfma_f32_16x16x32_bf16 v[84:87], v[104:107], a[16:19], v[84:87]
  v_mfma_f32_16x16x32_bf16 v[88:91], v[104:107], a[48:51], v[88:91]
  ds_read2_b32 v[104:105], v55 offset0:64 offset1:65
  ds_read2_b32 v[106:107], v55 offset0:66 offset1:67
  s_waitcnt lgkmcnt(6)
  v_mfma_f32_16x16x32_bf16 v[84:87], v[92:95], a[12:15], v[84:87]
  v_mfma_f32_16x16x32_bf16 v[88:91], v[92:95], a[44:47], v[88:91]
  ds_read2_b32 v[92:93], v55 offset0:48 offset1:49
  ds_read2_b32 v[94:95], v55 offset0:50 offset1:51
  s_waitcnt lgkmcnt(6)
  v_mfma_f32_16x16x32_bf16 v[84:87], v[96:99], a[8:11], v[84:87]
  v_mfma_f32_16x16x32_bf16 v[88:91], v[96:99], a[40:43], v[88:91]
  ds_read2_b32 v[96:97], v55 offset0:32 offset1:33
  ds_read2_b32 v[98:99], v55 offset0:34 offset1:35
  s_waitcnt lgkmcnt(6)
  v_mfma_f32_16x16x32_bf16 v[84:87], v[100:103], a[4:7], v[84:87]
  v_mfma_f32_16x16x32_bf16 v[88:91], v[100:103], a[36:39], v[88:91]
  ds_read2_b32 v[100:101], v55 offset0:16 offset1:17
  ds_read2_b32 v[102:103], v55 offset0:18 offset1:19
  s_waitcnt lgkmcnt(6)
  v_mfma_f32_16x16x32_bf16 v[84:87], v[104:107], a[0:3], v[84:87]
  v_mfma_f32_16x16x32_bf16 v[88:91], v[104:107], a[32:35], v[88:91]
  ds_read2_b32 v[104:105], v55 offset0:0 offset1:1
  ds_read2_b32 v[106:107], v55 offset0:2 offset1:3
  s_waitcnt lgkmcnt(6)
  v_mfma_f32_16x16x32_bf16 v[88:91], v[92:95], a[28:31], v[88:91]
  ds_read2_b32 v[92:93], v56 offset0:224 offset1:225
  ds_read2_b32 v[94:95], v56 offset0:226 offset1:227
  s_waitcnt lgkmcnt(6)
  v_mfma_f32_16x16x32_bf16 v[88:91], v[96:99], a[24:27], v[88:91]
  ds_read2_b32 v[96:97], v56 offset0:208 offset1:209
  ds_read2_b32 v[98:99], v56 offset0:210 offset1:211
  s_waitcnt lgkmcnt(6)
  v_mfma_f32_16x16x32_bf16 v[88:91], v[100:103], a[20:23], v[88:91]
  ds_read2_b32 v[100:101], v56 offset0:192 offset1:193
  ds_read2_b32 v[102:103], v56 offset0:194 offset1:195
  s_waitcnt lgkmcnt(6)
  v_mfma_f32_16x16x32_bf16 v[88:91], v[104:107], a[16:19], v[88:91]
  ds_read2_b32 v[104:105], v56 offset0:176 offset1:177
  ds_read2_b32 v[106:107], v56 offset0:178 offset1:179
  s_waitcnt lgkmcnt(6)
  v_mfma_f32_16x16x32_bf16 v[88:91], v[92:95], a[12:15], v[88:91]
  s_waitcnt lgkmcnt(4)
  v_mfma_f32_16x16x32_bf16 v[88:91], v[96:99], a[8:11], v[88:91]
  s_waitcnt lgkmcnt(2)
  v_mfma_f32_16x16x32_bf16 v[88:91], v[100:103], a[4:7], v[88:91]
  s_waitcnt lgkmcnt(0)
  v_mfma_f32_16x16x32_bf16 v[88:91], v[104:107], a[0:3], v[88:91]
  v_lshlrev_b32 v46, 5, v4
  v_lshl_add_u32 v46, v3, 3, v46
  v_add_u32 v46, s17, v46
  ds_read_b64 v[108:109], v46 offset:512
  ds_read_b64 v[110:111], v46 offset:1024
  ds_read_b64 v[112:113], v46 offset:1536
  ds_read_b64 v[114:115], v46 offset:2048
  ds_read_b64 v[116:117], v46 offset:2560
  ds_read_b64 v[118:119], v46 offset:3072
  ds_read_b64 v[120:121], v46 offset:3584
  ds_read_b64 v[122:123], v46 offset:4096
  s_waitcnt lgkmcnt(0)
  v_lshlrev_b32 v124, 16, v108
  v_and_b32 v125, 0xffff0000, v108
  v_lshlrev_b32 v126, 16, v109
  v_and_b32 v127, 0xffff0000, v109
  v_mul_f32 v124, v124, v33
  v_mul_f32 v125, v125, v33
  v_mul_f32 v126, v126, v33
  v_mul_f32 v127, v127, v33
  v_cvt_pk_bf16_f32 v128, v124, v125
  v_cvt_pk_bf16_f32 v129, v126, v127
  v_cvt_pk_bf16_f32 v130, v60, v61
  v_cvt_pk_bf16_f32 v131, v62, v63
  v_lshlrev_b32 v124, 16, v128
  v_and_b32 v125, 0xffff0000, v128
  v_lshlrev_b32 v132, 16, v130
  v_and_b32 v133, 0xffff0000, v130
  v_lshlrev_b32 v126, 16, v129
  v_and_b32 v127, 0xffff0000, v129
  v_lshlrev_b32 v134, 16, v131
  v_and_b32 v135, 0xffff0000, v131
  v_add_f32 v124, v124, v132
  v_add_f32 v125, v125, v133
  v_add_f32 v126, v126, v134
  v_add_f32 v127, v127, v135
  v_cvt_pk_bf16_f32 v108, v124, v125
  v_cvt_pk_bf16_f32 v109, v126, v127
  ds_write_b64 v46, v[108:109] offset:512
  v_lshlrev_b32 v124, 16, v110
  v_and_b32 v125, 0xffff0000, v110
  v_lshlrev_b32 v126, 16, v111
  v_and_b32 v127, 0xffff0000, v111
  v_mul_f32 v124, v124, v33
  v_mul_f32 v125, v125, v33
  v_mul_f32 v126, v126, v33
  v_mul_f32 v127, v127, v33
  v_cvt_pk_bf16_f32 v128, v124, v125
  v_cvt_pk_bf16_f32 v129, v126, v127
  v_cvt_pk_bf16_f32 v130, v64, v65
  v_cvt_pk_bf16_f32 v131, v66, v67
  v_lshlrev_b32 v124, 16, v128
  v_and_b32 v125, 0xffff0000, v128
  v_lshlrev_b32 v132, 16, v130
  v_and_b32 v133, 0xffff0000, v130
  v_lshlrev_b32 v126, 16, v129
  v_and_b32 v127, 0xffff0000, v129
  v_lshlrev_b32 v134, 16, v131
  v_and_b32 v135, 0xffff0000, v131
  v_add_f32 v124, v124, v132
  v_add_f32 v125, v125, v133
  v_add_f32 v126, v126, v134
  v_add_f32 v127, v127, v135
  v_cvt_pk_bf16_f32 v110, v124, v125
  v_cvt_pk_bf16_f32 v111, v126, v127
  ds_write_b64 v46, v[110:111] offset:1024
  v_lshlrev_b32 v124, 16, v112
  v_and_b32 v125, 0xffff0000, v112
  v_lshlrev_b32 v126, 16, v113
  v_and_b32 v127, 0xffff0000, v113
  v_mul_f32 v124, v124, v33
  v_mul_f32 v125, v125, v33
  v_mul_f32 v126, v126, v33
  v_mul_f32 v127, v127, v33
  v_cvt_pk_bf16_f32 v128, v124, v125
  v_cvt_pk_bf16_f32 v129, v126, v127
  v_cvt_pk_bf16_f32 v130, v68, v69
  v_cvt_pk_bf16_f32 v131, v70, v71
  v_lshlrev_b32 v124, 16, v128
  v_and_b32 v125, 0xffff0000, v128
  v_lshlrev_b32 v132, 16, v130
  v_and_b32 v133, 0xffff0000, v130
  v_lshlrev_b32 v126, 16, v129
  v_and_b32 v127, 0xffff0000, v129
  v_lshlrev_b32 v134, 16, v131
  v_and_b32 v135, 0xffff0000, v131
  v_add_f32 v124, v124, v132
  v_add_f32 v125, v125, v133
  v_add_f32 v126, v126, v134
  v_add_f32 v127, v127, v135
  v_cvt_pk_bf16_f32 v112, v124, v125
  v_cvt_pk_bf16_f32 v113, v126, v127
  ds_write_b64 v46, v[112:113] offset:1536
  v_lshlrev_b32 v124, 16, v114
  v_and_b32 v125, 0xffff0000, v114
  v_lshlrev_b32 v126, 16, v115
  v_and_b32 v127, 0xffff0000, v115
  v_mul_f32 v124, v124, v33
  v_mul_f32 v125, v125, v33
  v_mul_f32 v126, v126, v33
  v_mul_f32 v127, v127, v33
  v_cvt_pk_bf16_f32 v128, v124, v125
  v_cvt_pk_bf16_f32 v129, v126, v127
  v_cvt_pk_bf16_f32 v130, v72, v73
  v_cvt_pk_bf16_f32 v131, v74, v75
  v_lshlrev_b32 v124, 16, v128
  v_and_b32 v125, 0xffff0000, v128
  v_lshlrev_b32 v132, 16, v130
  v_and_b32 v133, 0xffff0000, v130
  v_lshlrev_b32 v126, 16, v129
  v_and_b32 v127, 0xffff0000, v129
  v_lshlrev_b32 v134, 16, v131
  v_and_b32 v135, 0xffff0000, v131
  v_add_f32 v124, v124, v132
  v_add_f32 v125, v125, v133
  v_add_f32 v126, v126, v134
  v_add_f32 v127, v127, v135
  v_cvt_pk_bf16_f32 v114, v124, v125
  v_cvt_pk_bf16_f32 v115, v126, v127
  ds_write_b64 v46, v[114:115] offset:2048
  v_lshlrev_b32 v124, 16, v116
  v_and_b32 v125, 0xffff0000, v116
  v_lshlrev_b32 v126, 16, v117
  v_and_b32 v127, 0xffff0000, v117
  v_mul_f32 v124, v124, v33
  v_mul_f32 v125, v125, v33
  v_mul_f32 v126, v126, v33
  v_mul_f32 v127, v127, v33
  v_cvt_pk_bf16_f32 v128, v124, v125
  v_cvt_pk_bf16_f32 v129, v126, v127
  v_cvt_pk_bf16_f32 v130, v76, v77
  v_cvt_pk_bf16_f32 v131, v78, v79
  v_lshlrev_b32 v124, 16, v128
  v_and_b32 v125, 0xffff0000, v128
  v_lshlrev_b32 v132, 16, v130
  v_and_b32 v133, 0xffff0000, v130
  v_lshlrev_b32 v126, 16, v129
  v_and_b32 v127, 0xffff0000, v129
  v_lshlrev_b32 v134, 16, v131
  v_and_b32 v135, 0xffff0000, v131
  v_add_f32 v124, v124, v132
  v_add_f32 v125, v125, v133
  v_add_f32 v126, v126, v134
  v_add_f32 v127, v127, v135
  v_cvt_pk_bf16_f32 v116, v124, v125
  v_cvt_pk_bf16_f32 v117, v126, v127
  ds_write_b64 v46, v[116:117] offset:2560
  v_lshlrev_b32 v124, 16, v118
  v_and_b32 v125, 0xffff0000, v118
  v_lshlrev_b32 v126, 16, v119
  v_and_b32 v127, 0xffff0000, v119
  v_mul_f32 v124, v124, v33
  v_mul_f32 v125, v125, v33
  v_mul_f32 v126, v126, v33
  v_mul_f32 v127, v127, v33
  v_cvt_pk_bf16_f32 v128, v124, v125
  v_cvt_pk_bf16_f32 v129, v126, v127
  v_cvt_pk_bf16_f32 v130, v80, v81
  v_cvt_pk_bf16_f32 v131, v82, v83
  v_lshlrev_b32 v124, 16, v128
  v_and_b32 v125, 0xffff0000, v128
  v_lshlrev_b32 v132, 16, v130
  v_and_b32 v133, 0xffff0000, v130
  v_lshlrev_b32 v126, 16, v129
  v_and_b32 v127, 0xffff0000, v129
  v_lshlrev_b32 v134, 16, v131
  v_and_b32 v135, 0xffff0000, v131
  v_add_f32 v124, v124, v132
  v_add_f32 v125, v125, v133
  v_add_f32 v126, v126, v134
  v_add_f32 v127, v127, v135
  v_cvt_pk_bf16_f32 v118, v124, v125
  v_cvt_pk_bf16_f32 v119, v126, v127
  ds_write_b64 v46, v[118:119] offset:3072
  v_lshlrev_b32 v124, 16, v120
  v_and_b32 v125, 0xffff0000, v120
  v_lshlrev_b32 v126, 16, v121
  v_and_b32 v127, 0xffff0000, v121
  v_mul_f32 v124, v124, v33
  v_mul_f32 v125, v125, v33
  v_mul_f32 v126, v126, v33
  v_mul_f32 v127, v127, v33
  v_cvt_pk_bf16_f32 v128, v124, v125
  v_cvt_pk_bf16_f32 v129, v126, v127
  v_cvt_pk_bf16_f32 v130, v84, v85
  v_cvt_pk_bf16_f32 v131, v86, v87
  v_lshlrev_b32 v124, 16, v128
  v_and_b32 v125, 0xffff0000, v128
  v_lshlrev_b32 v132, 16, v130
  v_and_b32 v133, 0xffff0000, v130
  v_lshlrev_b32 v126, 16, v129
  v_and_b32 v127, 0xffff0000, v129
  v_lshlrev_b32 v134, 16, v131
  v_and_b32 v135, 0xffff0000, v131
  v_add_f32 v124, v124, v132
  v_add_f32 v125, v125, v133
  v_add_f32 v126, v126, v134
  v_add_f32 v127, v127, v135
  v_cvt_pk_bf16_f32 v120, v124, v125
  v_cvt_pk_bf16_f32 v121, v126, v127
  ds_write_b64 v46, v[120:121] offset:3584
  v_lshlrev_b32 v124, 16, v122
  v_and_b32 v125, 0xffff0000, v122
  v_lshlrev_b32 v126, 16, v123
  v_and_b32 v127, 0xffff0000, v123
  v_mul_f32 v124, v124, v33
  v_mul_f32 v125, v125, v33
  v_mul_f32 v126, v126, v33
  v_mul_f32 v127, v127, v33
  v_cvt_pk_bf16_f32 v128, v124, v125
  v_cvt_pk_bf16_f32 v129, v126, v127
  v_cvt_pk_bf16_f32 v130, v88, v89
  v_cvt_pk_bf16_f32 v131, v90, v91
  v_lshlrev_b32 v124, 16, v128
  v_and_b32 v125, 0xffff0000, v128
  v_lshlrev_b32 v132, 16, v130
  v_and_b32 v133, 0xffff0000, v130
  v_lshlrev_b32 v126, 16, v129
  v_and_b32 v127, 0xffff0000, v129
  v_lshlrev_b32 v134, 16, v131
  v_and_b32 v135, 0xffff0000, v131
  v_add_f32 v124, v124, v132
  v_add_f32 v125, v125, v133
  v_add_f32 v126, v126, v134
  v_add_f32 v127, v127, v135
  v_cvt_pk_bf16_f32 v122, v124, v125
  v_cvt_pk_bf16_f32 v123, v126, v127
  ds_write_b64 v46, v[122:123] offset:4096
  s_waitcnt lgkmcnt(0)
  s_barrier
  v_lshlrev_b32 v6, 3, v0
  v_mul_u32_u24 v5, 7168, v0
  v_add_u32 v36, 512, v6
  ds_read_b64 v[8:9], v36
  v_add_u32 v36, 25088, v6
  ds_read_b64 v[10:11], v36
  v_add_u32 v36, 49664, v6
  ds_read_b64 v[12:13], v36
  v_add_u32 v36, 74240, v6
  ds_read_b64 v[14:15], v36
  s_waitcnt lgkmcnt(0)
  s_add_u32 s22, s21, 0
  s_add_u32 s23, s22, 3584
  v_perm_b32 v16, v10, v8, s24
  v_perm_b32 v17, v14, v12, s24
  buffer_store_dwordx2 v[16:17], v5, s[92:95], s22 offen offset:0
  v_perm_b32 v18, v10, v8, s25
  v_perm_b32 v19, v14, v12, s25
  buffer_store_dwordx2 v[18:19], v5, s[92:95], s22 offen offset:1792
  v_perm_b32 v20, v11, v9, s24
  v_perm_b32 v21, v15, v13, s24
  buffer_store_dwordx2 v[20:21], v5, s[92:95], s23 offen offset:0
  v_perm_b32 v22, v11, v9, s25
  v_perm_b32 v23, v15, v13, s25
  buffer_store_dwordx2 v[22:23], v5, s[92:95], s23 offen offset:1792
  v_add_u32 v36, 2560, v6
  ds_read_b64 v[8:9], v36
  v_add_u32 v36, 27136, v6
  ds_read_b64 v[10:11], v36
  v_add_u32 v36, 51712, v6
  ds_read_b64 v[12:13], v36
  v_add_u32 v36, 76288, v6
  ds_read_b64 v[14:15], v36
  s_waitcnt lgkmcnt(0)
  s_add_u32 s22, s21, 1835008
  s_add_u32 s23, s22, 3584
  v_perm_b32 v24, v10, v8, s24
  v_perm_b32 v25, v14, v12, s24
  buffer_store_dwordx2 v[24:25], v5, s[92:95], s22 offen offset:0
  v_perm_b32 v26, v10, v8, s25
  v_perm_b32 v27, v14, v12, s25
  buffer_store_dwordx2 v[26:27], v5, s[92:95], s22 offen offset:1792
  v_perm_b32 v28, v11, v9, s24
  v_perm_b32 v29, v15, v13, s24
  buffer_store_dwordx2 v[28:29], v5, s[92:95], s23 offen offset:0
  v_perm_b32 v30, v11, v9, s25
  v_perm_b32 v31, v15, v13, s25
  buffer_store_dwordx2 v[30:31], v5, s[92:95], s23 offen offset:1792
  s_branch wk_loop
wk_tok:
  s_sub_u32 s3, s3, 864
  s_and_b32 s18, s3, 3
  s_lshr_b32 s17, s3, 2
  s_cmp_lt_u32 s17, 8
  s_cbranch_scc1 wk_tokp
  s_sub_u32 s17, s17, 64
  s_cmp_ge_i32 s17, 56
  s_cbranch_scc1 wk_toko
  s_add_u32 s20, s17, 56
  s_lshr_b32 s17, s20, 1
  s_bitcmp0_b32 s20, 0
  s_cbranch_scc1 wk_toko
  s_add_u32 s17, s17, 8
wk_tokp:
  s_lshl_b32 s20, s18, 2
  s_add_u32 s20, s20, s16
  s_lshl_b32 s21, s17, 4
  s_add_u32 s21, s21, s20
  s_mul_i32 s21, s21, 28672
  s_add_u32 s21, s21, 12845056
  s_mul_i32 s23, s17, 28672
  s_add_u32 s23, s23, 73400320
  s_mul_i32 s24, s17, 7168
  s_add_u32 s24, s24, 88068096
  s_lshr_b32 s25, s17, 3
  s_lshl_b32 s25, s25, 4
  s_add_u32 s25, s25, s20
  s_lshl_b32 s25, s25, 7
  s_add_u32 s25, s25, 88545280
  v_mov_b32 v60, 0
  s_mov_b32 s30, 0
wp_wf:
  buffer_load_dword v61, v60, s[8:11], s25 offen sc1
  s_waitcnt vmcnt(0)
  v_cmp_ne_u32 vcc, 56, v61
  s_cbranch_vccz wp_wf_ok
  s_sleep 1
  s_cmp_ge_u32 s17, 61
  s_cbranch_scc1 wp_wf_bo
  s_sleep 4
  s_cmp_ge_u32 s17, 56
  s_cbranch_scc1 wp_wf_bo
  s_sleep 40
wp_wf_bo:
  s_add_u32 s30, s30, 1
  s_cmp_lt_u32 s30, 30000
  s_cbranch_scc1 wp_wf
  s_branch wp_abort
wp_wf_ok:
  s_add_u32 s22, s21, 0
  buffer_load_dwordx4 a[0:3], v2, s[8:11], s22 offen offset:0 sc1
  buffer_load_dwordx4 a[4:7], v2, s[8:11], s22 offen offset:1024 sc1
  buffer_load_dwordx4 a[8:11], v2, s[8:11], s22 offen offset:2048 sc1
  buffer_load_dwordx4 a[12:15], v2, s[8:11], s22 offen offset:3072 sc1
  s_add_u32 s22, s21, 4096
  buffer_load_dwordx4 a[16:19], v2, s[8:11], s22 offen offset:0 sc1
  buffer_load_dwordx4 a[20:23], v2, s[8:11], s22 offen offset:1024 sc1
  buffer_load_dwordx4 a[24:27], v2, s[8:11], s22 offen offset:2048 sc1
  buffer_load_dwordx4 a[28:31], v2, s[8:11], s22 offen offset:3072 sc1
  s_add_u32 s22, s21, 8192
  buffer_load_dwordx4 a[32:35], v2, s[8:11], s22 offen offset:0 sc1
  buffer_load_dwordx4 a[36:39], v2, s[8:11], s22 offen offset:1024 sc1
  buffer_load_dwordx4 a[40:43], v2, s[8:11], s22 offen offset:2048 sc1
  buffer_load_dwordx4 a[44:47], v2, s[8:11], s22 offen offset:3072 sc1
  s_add_u32 s22, s21, 12288
  buffer_load_dwordx4 a[48:51], v2, s[8:11], s22 offen offset:0 sc1
  buffer_load_dwordx4 a[52:55], v2, s[8:11], s22 offen offset:1024 sc1
  buffer_load_dwordx4 a[56:59], v2, s[8:11], s22 offen offset:2048 sc1
  buffer_load_dwordx4 a[60:63], v2, s[8:11], s22 offen offset:3072 sc1
  s_add_u32 s22, s21, 16384
  buffer_load_dwordx4 a[64:67], v2, s[8:11], s22 offen offset:0 sc1
  buffer_load_dwordx4 a[68:71], v2, s[8:11], s22 offen offset:1024 sc1
  buffer_load_dwordx4 a[72:75], v2, s[8:11], s22 offen offset:2048 sc1
  buffer_load_dwordx4 a[76:79], v2, s[8:11], s22 offen offset:3072 sc1
  s_add_u32 s22, s21, 20480
  buffer_load_dwordx4 a[80:83], v2, s[8:11], s22 offen offset:0 sc1
  buffer_load_dwordx4 a[84:87], v2, s[8:11], s22 offen offset:1024 sc1
  buffer_load_dwordx4 a[88:91], v2, s[8:11], s22 offen offset:2048 sc1
  buffer_load_dwordx4 a[92:95], v2, s[8:11], s22 offen offset:3072 sc1
  s_add_u32 s22, s21, 24576
  buffer_load_dwordx4 a[96:99], v2, s[8:11], s22 offen offset:0 sc1
  buffer_load_dwordx4 a[100:103], v2, s[8:11], s22 offen offset:1024 sc1
  buffer_load_dwordx4 a[104:107], v2, s[8:11], s22 offen offset:2048 sc1
  buffer_load_dwordx4 a[108:111], v2, s[8:11], s22 offen offset:3072 sc1
  s_add_u32 s22, s23, 0
  buffer_load_dwordx4 a[112:115], v2, s[8:11], s22 offen offset:0 sc1
  buffer_load_dwordx4 a[116:119], v2, s[8:11], s22 offen offset:1024 sc1
  buffer_load_dwordx4 a[120:123], v2, s[8:11], s22 offen offset:2048 sc1
  buffer_load_dwordx4 a[124:127], v2, s[8:11], s22 offen offset:3072 sc1
  s_add_u32 s22, s23, 4096
  buffer_load_dwordx4 a[128:131], v2, s[8:11], s22 offen offset:0 sc1
  buffer_load_dwordx4 a[132:135], v2, s[8:11], s22 offen offset:1024 sc1
  buffer_load_dwordx4 a[136:139], v2, s[8:11], s22 offen offset:2048 sc1
  buffer_load_dwordx4 a[140:143], v2, s[8:11], s22 offen offset:3072 sc1
  s_add_u32 s22, s23, 8192
  buffer_load_dwordx4 a[144:147], v2, s[8:11], s22 offen offset:0 sc1
  buffer_load_dwordx4 a[148:151], v2, s[8:11], s22 offen offset:1024 sc1
  buffer_load_dwordx4 a[152:155], v2, s[8:11], s22 offen offset:2048 sc1
  buffer_load_dwordx4 a[156:159], v2, s[8:11], s22 offen offset:3072 sc1
  s_add_u32 s22, s23, 12288
  buffer_load_dwordx4 a[160:163], v2, s[8:11], s22 offen offset:0 sc1
  buffer_load_dwordx4 a[164:167], v2, s[8:11], s22 offen offset:1024 sc1
  buffer_load_dwordx4 a[168:171], v2, s[8:11], s22 offen offset:2048 sc1
  buffer_load_dwordx4 a[172:175], v2, s[8:11], s22 offen offset:3072 sc1
  s_add_u32 s22, s23, 16384
  buffer_load_dwordx4 a[176:179], v2, s[8:11], s22 offen offset:0 sc1
  buffer_load_dwordx4 a[180:183], v2, s[8:11], s22 offen offset:1024 sc1
  buffer_load_dwordx4 a[184:187], v2, s[8:11], s22 offen offset:2048 sc1
  buffer_load_dwordx4 a[188:191], v2, s[8:11], s22 offen offset:3072 sc1
  s_add_u32 s22, s23, 20480
  buffer_load_dwordx4 a[192:195], v2, s[8:11], s22 offen offset:0 sc1
  buffer_load_dwordx4 a[196:199], v2, s[8:11], s22 offen offset:1024 sc1
  buffer_load_dwordx4 a[200:203], v2, s[8:11], s22 offen offset:2048 sc1
  buffer_load_dwordx4 a[204:207], v2, s[8:11], s22 offen offset:3072 sc1
  s_add_u32 s22, s23, 24576
  buffer_load_dwordx4 a[208:211], v2, s[8:11], s22 offen offset:0 sc1
  buffer_load_dwordx4 a[212:215], v2, s[8:11], s22 offen offset:1024 sc1
  buffer_load_dwordx4 a[216:219], v2, s[8:11], s22 offen offset:2048 sc1
  buffer_load_dwordx4 a[220:223], v2, s[8:11], s22 offen offset:3072 sc1
  v_lshl_add_u32 v5, v3, 2, 0
  v_cmp_le_u32 s[40:41], v5, v4
  v_lshl_add_u32 v5, v3, 2, 1
  v_cmp_le_u32 s[42:43], v5, v4
  v_lshl_add_u32 v5, v3, 2, 2
  v_cmp_le_u32 s[44:45], v5, v4
  v_lshl_add_u32 v5, v3, 2, 3
  v_cmp_le_u32 s[46:47], v5, v4
  v_cmp_gt_u32 s[48:49], 2, v3
  v_mov_b32 v6, 0xff800000
  s_waitcnt vmcnt(0)
  v_mfma_f32_16x16x32_bf16 v[8:11], a[112:115], a[0:3], 0
  v_mfma_f32_16x16x32_bf16 v[12:15], a[112:115], a[56:59], 0
  v_mfma_f32_16x16x32_bf16 v[16:19], a[168:171], a[56:59], 0
  v_mfma_f32_16x16x32_bf16 v[8:11], a[116:119], a[4:7], v[8:11]
  v_mfma_f32_16x16x32_bf16 v[12:15], a[116:119], a[60:63], v[12:15]
  v_mfma_f32_16x16x32_bf16 v[16:19], a[172:175], a[60:63], v[16:19]
  v_mfma_f32_16x16x32_bf16 v[8:11], a[120:123], a[8:11], v[8:11]
  v_mfma_f32_16x16x32_bf16 v[12:15], a[120:123], a[64:67], v[12:15]
  v_mfma_f32_16x16x32_bf16 v[16:19], a[176:179], a[64:67], v[16:19]
  v_mfma_f32_16x16x32_bf16 v[8:11], a[124:127], a[12:15], v[8:11]
  v_mfma_f32_16x16x32_bf16 v[12:15], a[124:127], a[68:71], v[12:15]
  v_mfma_f32_16x16x32_bf16 v[16:19], a[180:183], a[68:71], v[16:19]
  v_mfma_f32_16x16x32_bf16 v[8:11], a[128:131], a[16:19], v[8:11]
  v_mfma_f32_16x16x32_bf16 v[12:15], a[128:131], a[72:75], v[12:15]
  v_mfma_f32_16x16x32_bf16 v[16:19], a[184:187], a[72:75], v[16:19]
  v_mfma_f32_16x16x32_bf16 v[8:11], a[132:135], a[20:23], v[8:11]
  v_mfma_f32_16x16x32_bf16 v[12:15], a[132:135], a[76:79], v[12:15]
  v_mfma_f32_16x16x32_bf16 v[16:19], a[188:191], a[76:79], v[16:19]
  v_mfma_f32_16x16x32_bf16 v[8:11], a[136:139], a[24:27], v[8:11]
  v_mfma_f32_16x16x32_bf16 v[12:15], a[136:139], a[80:83], v[12:15]
  v_mfma_f32_16x16x32_bf16 v[16:19], a[192:195], a[80:83], v[16:19]
  v_mfma_f32_16x16x32_bf16 v[8:11], a[140:143], a[28:31], v[8:11]
  v_mfma_f32_16x16x32_bf16 v[12:15], a[140:143], a[84:87], v[12:15]
  v_mfma_f32_16x16x32_bf16 v[16:19], a[196:199], a[84:87], v[16:19]
  v_mfma_f32_16x16x32_bf16 v[8:11], a[144:147], a[32:35], v[8:11]
  v_mfma_f32_16x16x32_bf16 v[12:15], a[144:147], a[88:91], v[12:15]
  v_mfma_f32_16x16x32_bf16 v[16:19], a[200:203], a[88:91], v[16:19]
  v_mfma_f32_16x16x32_bf16 v[8:11], a[148:151], a[36:39], v[8:11]
  v_mfma_f32_16x16x32_bf16 v[12:15], a[148:151], a[92:95], v[12:15]
  v_mfma_f32_16x16x32_bf16 v[16:19], a[204:207], a[92:95], v[16:19]
  v_mfma_f32_16x16x32_bf16 v[8:11], a[152:155], a[40:43], v[8:11]
  v_mfma_f32_16x16x32_bf16 v[12:15], a[152:155], a[96:99], v[12:15]
  v_mfma_f32_16x16x32_bf16 v[16:19], a[208:211], a[96:99], v[16:19]
  v_mfma_f32_16x16x32_bf16 v[8:11], a[156:159], a[44:47], v[8:11]
  v_mfma_f32_16x16x32_bf16 v[12:15], a[156:159], a[100:103], v[12:15]
  v_mfma_f32_16x16x32_bf16 v[16:19], a[212:215], a[100:103], v[16:19]
  v_mfma_f32_16x16x32_bf16 v[8:11], a[160:163], a[48:51], v[8:11]
  v_mfma_f32_16x16x32_bf16 v[12:15], a[160:163], a[104:107], v[12:15]
  v_mfma_f32_16x16x32_bf16 v[16:19], a[216:219], a[104:107], v[16:19]
  v_mfma_f32_16x16x32_bf16 v[8:11], a[164:167], a[52:55], v[8:11]
  v_mfma_f32_16x16x32_bf16 v[12:15], a[164:167], a[108:111], v[12:15]
  v_mfma_f32_16x16x32_bf16 v[16:19], a[220:223], a[108:111], v[16:19]
  s_mul_i32 s22, s20, 448
  v_mov_b32 v62, s22
  s_mov_b32 s30, 0
wp_pm:
  s_cmp_ge_u32 s17, 64
  s_cbranch_scc1 wp_pf
  s_cmp_ge_u32 s17, 61
  s_cbranch_scc1 mp_41a
  v_mov_b32 v61, 0
  s_mov_b64 exec, 1
  buffer_atomic_or v61, v62, s[8:11], s24 offen sc0
  s_mov_b64 exec, -1
  s_branch mp_41b
mp_41a:
  buffer_load_dword v61, v62, s[8:11], s24 offen sc1
mp_41b:
  s_waitcnt vmcnt(0)
  v_cmp_eq_u32 vcc, -1, v61
  s_cbranch_vccnz wp_pr
wp_pf:
  s_add_u32 s22, s24, 4096
  buffer_load_dwordx4 v[64:67], v2, s[8:11], s24 offen offset:0 sc1
  buffer_load_dwordx4 v[68:71], v2, s[8:11], s24 offen offset:1024 sc1
  buffer_load_dwordx4 v[72:75], v2, s[8:11], s24 offen offset:2048 sc1
  buffer_load_dwordx4 v[76:79], v2, s[8:11], s24 offen offset:3072 sc1
  buffer_load_dwordx4 v[80:83], v2, s[8:11], s22 offen offset:0 sc1
  buffer_load_dwordx4 v[84:87], v2, s[8:11], s22 offen offset:1024 sc1
  buffer_load_dwordx4 v[88:91], v2, s[8:11], s22 offen offset:2048 sc1
  s_waitcnt vmcnt(0)
  v_max_u32 v61, v64, v65
  v_max3_u32 v61, v61, v66, v67
  v_max3_u32 v61, v61, v68, v69
  v_max3_u32 v61, v61, v70, v71
  v_max3_u32 v61, v61, v72, v73
  v_max3_u32 v61, v61, v74, v75
  v_max3_u32 v61, v61, v76, v77
  v_max3_u32 v61, v61, v78, v79
  v_max3_u32 v61, v61, v80, v81
  v_max3_u32 v61, v61, v82, v83
  v_max3_u32 v61, v61, v84, v85
  v_max3_u32 v61, v61, v86, v87
  v_max3_u32 v61, v61, v88, v89
  v_max3_u32 v61, v61, v90, v91
  v_cmp_eq_u32 vcc, -1, v61
  s_cbranch_vccz wp_pk
wp_pr:
  s_sleep 1
  s_cmp_ge_u32 s17, 61
  s_cbranch_scc1 wp_pm_bo
  s_sleep 4
  s_cmp_ge_u32 s17, 56
  s_cbranch_scc1 wp_pm_bo
  s_sleep 40
wp_pm_bo:
  s_add_u32 s30, s30, 1
  s_cmp_lt_u32 s30, 30000
  s_cbranch_scc1 wp_pm
  s_branch wp_abort
wp_pk:
  buffer_load_dword v250, v251, s[12:15], 0 offen sc1
  v_mfma_f32_16x16x32_bf16 v[20:23], v[64:67], a[0:3], 0
  v_mfma_f32_16x16x32_bf16 v[24:27], v[64:67], a[4:7], 0
  v_mfma_f32_16x16x32_bf16 v[28:31], v[64:67], a[56:59], 0
  v_mfma_f32_16x16x32_bf16 v[32:35], v[64:67], a[60:63], 0
  v_mfma_f32_16x16x32_bf16 v[20:23], v[68:71], a[8:11], v[20:23]
  v_mfma_f32_16x16x32_bf16 v[24:27], v[68:71], a[12:15], v[24:27]
  v_mfma_f32_16x16x32_bf16 v[28:31], v[68:71], a[64:67], v[28:31]
  v_mfma_f32_16x16x32_bf16 v[32:35], v[68:71], a[68:71], v[32:35]
  v_mfma_f32_16x16x32_bf16 v[20:23], v[72:75], a[16:19], v[20:23]
  v_mfma_f32_16x16x32_bf16 v[24:27], v[72:75], a[20:23], v[24:27]
  v_mfma_f32_16x16x32_bf16 v[28:31], v[72:75], a[72:75], v[28:31]
  v_mfma_f32_16x16x32_bf16 v[32:35], v[72:75], a[76:79], v[32:35]
  v_mfma_f32_16x16x32_bf16 v[20:23], v[76:79], a[24:27], v[20:23]
  v_mfma_f32_16x16x32_bf16 v[24:27], v[76:79], a[28:31], v[24:27]
  v_mfma_f32_16x16x32_bf16 v[28:31], v[76:79], a[80:83], v[28:31]
  v_mfma_f32_16x16x32_bf16 v[32:35], v[76:79], a[84:87], v[32:35]
  v_mfma_f32_16x16x32_bf16 v[20:23], v[80:83], a[32:35], v[20:23]
  v_mfma_f32_16x16x32_bf16 v[24:27], v[80:83], a[36:39], v[24:27]
  v_mfma_f32_16x16x32_bf16 v[28:31], v[80:83], a[88:91], v[28:31]
  v_mfma_f32_16x16x32_bf16 v[32:35], v[80:83], a[92:95], v[32:35]
  v_mfma_f32_16x16x32_bf16 v[20:23], v[84:87], a[40:43], v[20:23]
  v_mfma_f32_16x16x32_bf16 v[24:27], v[84:87], a[44:47], v[24:27]
  v_mfma_f32_16x16x32_bf16 v[28:31], v[84:87], a[96:99], v[28:31]
  v_mfma_f32_16x16x32_bf16 v[32:35], v[84:87], a[100:103], v[32:35]
  v_mfma_f32_16x16x32_bf16 v[20:23], v[88:91], a[48:51], v[20:23]
  v_mfma_f32_16x16x32_bf16 v[24:27], v[88:91], a[52:55], v[24:27]
  v_mfma_f32_16x16x32_bf16 v[28:31], v[88:91], a[104:107], v[28:31]
  v_mfma_f32_16x16x32_bf16 v[32:35], v[88:91], a[108:111], v[32:35]
  s_lshl_b32 s25, s17, 1
  s_mul_i32 s25, s25, 20480
  s_add_u32 s25, s25, 85446656
  s_lshl_b32 s26, s20, 10
  s_add_u32 s26, s26, s25
  s_lshl_b32 s27, s18, 10
  s_add_u32 s27, s27, s25
  s_lshr_b32 s28, s16, 1
  s_lshl_b32 s28, s28, 3
  s_add_u32 s27, s27, s28
  s_add_u32 s27, s27, 16384
  s_and_b32 s28, s16, 1
  s_cmp_eq_u32 s28, 0
  s_cselect_b32 s50, -1, 0
  s_cselect_b32 s51, 0, -1
  v_cndmask_b32 v8, v6, v8, s[40:41]
  v_cndmask_b32 v9, v6, v9, s[42:43]
  v_cndmask_b32 v10, v6, v10, s[44:45]
  v_cndmask_b32 v11, v6, v11, s[46:47]
  v_cndmask_b32 v20, v24, v20, s[48:49]
  v_cndmask_b32 v21, v25, v21, s[48:49]
  v_cndmask_b32 v22, v26, v22, s[48:49]
  v_cndmask_b32 v23, v27, v23, s[48:49]
  v_mov_b32 v24, v20
  v_mov_b32 v25, v21
  v_mov_b32 v26, v22
  v_mov_b32 v27, v23
  v_permlane32_swap_b32 v20, v24
  v_permlane32_swap_b32 v21, v25
  v_permlane32_swap_b32 v22, v26
  v_permlane32_swap_b32 v23, v27
  v_add_f32 v20, v20, v24
  v_add_f32 v21, v21, v25
  v_add_f32 v22, v22, v26
  v_add_f32 v23, v23, v27
  v_max3_f32 v40, v8, v9, v10
  v_max3_f32 v40, v40, v11, v20
  v_max3_f32 v40, v40, v21, v22
  v_max_f32 v40, v40, v23
  v_mov_b32 v41, v40
  s_nop 1
  v_permlane16_swap_b32 v40, v41
  v_max_f32 v40, v40, v41
  v_mov_b32 v41, v40
  s_nop 1
  v_permlane32_swap_b32 v40, v41
  v_max_f32 v40, v40, v41
  v_sub_f32 v8, v8, v40
  v_sub_f32 v9, v9, v40
  v_sub_f32 v10, v10, v40
  v_sub_f32 v11, v11, v40
  v_sub_f32 v20, v20, v40
  v_sub_f32 v21, v21, v40
  v_sub_f32 v22, v22, v40
  v_sub_f32 v23, v23, v40
  v_exp_f32 v8, v8
  v_exp_f32 v9, v9
  v_exp_f32 v10, v10
  v_exp_f32 v11, v11
  v_exp_f32 v20, v20
  v_exp_f32 v21, v21
  v_exp_f32 v22, v22
  v_exp_f32 v23, v23
  v_add_f32 v42, v20, v21
  v_add_f32 v43, v22, v23
  v_add_f32 v42, v42, v43
  v_mul_f32 v42, 0.5, v42
  v_add_f32 v42, v42, v8
  v_add_f32 v42, v42, v9
  v_add_f32 v42, v42, v10
  v_add_f32 v42, v42, v11
  v_mov_b32 v41, v42
  s_nop 1
  v_permlane16_swap_b32 v42, v41
  v_add_f32 v42, v42, v41
  v_mov_b32 v41, v42
  s_nop 1
  v_permlane32_swap_b32 v42, v41
  v_add_f32 v42, v42, v41
  v_rcp_f32 v42, v42
  s_nop 0
  v_mul_f32 v8, v8, v42
  v_mul_f32 v9, v9, v42
  v_mul_f32 v10, v10, v42
  v_mul_f32 v11, v11, v42
  v_mul_f32 v20, v20, v42
  v_mul_f32 v21, v21, v42
  v_mul_f32 v22, v22, v42
  v_mul_f32 v23, v23, v42
  v_cvt_pk_bf16_f32 v44, v8, v9
  v_cvt_pk_bf16_f32 v45, v10, v11
  v_mov_b32 v46, 0
  v_mov_b32 v47, 0
  v_cvt_pk_bf16_f32 v48, v20, v21
  v_cvt_pk_bf16_f32 v49, v22, v23
  v_min_u32 v44, -2, v44
  v_min_u32 v45, -2, v45
  v_min_u32 v46, -2, v46
  v_min_u32 v47, -2, v47
  v_min_u32 v48, -2, v48
  v_min_u32 v49, -2, v49
  buffer_store_dwordx4 v[44:47], v2, s[8:11], s26 offen sc1
  s_mov_b64 exec, s[50:51]
  buffer_store_dwordx2 v[48:49], v2, s[8:11], s27 offen sc1
  s_mov_b64 exec, -1
  s_add_u32 s26, s26, 20480
  s_add_u32 s27, s27, 20480
  v_cndmask_b32 v16, v6, v16, s[40:41]
  v_cndmask_b32 v17, v6, v17, s[42:43]
  v_cndmask_b32 v18, v6, v18, s[44:45]
  v_cndmask_b32 v19, v6, v19, s[46:47]
  v_cndmask_b32 v28, v32, v28, s[48:49]
  v_cndmask_b32 v29, v33, v29, s[48:49]
  v_cndmask_b32 v30, v34, v30, s[48:49]
  v_cndmask_b32 v31, v35, v31, s[48:49]
  v_mov_b32 v32, v28
  v_mov_b32 v33, v29
  v_mov_b32 v34, v30
  v_mov_b32 v35, v31
  v_permlane32_swap_b32 v28, v32
  v_permlane32_swap_b32 v29, v33
  v_permlane32_swap_b32 v30, v34
  v_permlane32_swap_b32 v31, v35
  v_add_f32 v28, v28, v32
  v_add_f32 v29, v29, v33
  v_add_f32 v30, v30, v34
  v_add_f32 v31, v31, v35
  v_max3_f32 v40, v12, v13, v14
  v_max3_f32 v40, v40, v15, v16
  v_max3_f32 v40, v40, v17, v18
  v_max3_f32 v40, v40, v19, v28
  v_max3_f32 v40, v40, v29, v30
  v_max_f32 v40, v40, v31
  v_mov_b32 v41, v40
  s_nop 1
  v_permlane16_swap_b32 v40, v41
  v_max_f32 v40, v40, v41
  v_mov_b32 v41, v40
  s_nop 1
  v_permlane32_swap_b32 v40, v41
  v_max_f32 v40, v40, v41
  v_sub_f32 v12, v12, v40
  v_sub_f32 v13, v13, v40
  v_sub_f32 v14, v14, v40
  v_sub_f32 v15, v15, v40
  v_sub_f32 v16, v16, v40
  v_sub_f32 v17, v17, v40
  v_sub_f32 v18, v18, v40
  v_sub_f32 v19, v19, v40
  v_sub_f32 v28, v28, v40
  v_sub_f32 v29, v29, v40
  v_sub_f32 v30, v30, v40
  v_sub_f32 v31, v31, v40
  v_exp_f32 v12, v12
  v_exp_f32 v13, v13
  v_exp_f32 v14, v14
  v_exp_f32 v15, v15
  v_exp_f32 v16, v16
  v_exp_f32 v17, v17
  v_exp_f32 v18, v18
  v_exp_f32 v19, v19
  v_exp_f32 v28, v28
  v_exp_f32 v29, v29
  v_exp_f32 v30, v30
  v_exp_f32 v31, v31
  v_add_f32 v42, v28, v29
  v_add_f32 v43, v30, v31
  v_add_f32 v42, v42, v43
  v_mul_f32 v42, 0.5, v42
  v_add_f32 v42, v42, v12
  v_add_f32 v42, v42, v13
  v_add_f32 v42, v42, v14
  v_add_f32 v42, v42, v15
  v_add_f32 v42, v42, v16
  v_add_f32 v42, v42, v17
  v_add_f32 v42, v42, v18
  v_add_f32 v42, v42, v19
  v_mov_b32 v41, v42
  s_nop 1
  v_permlane16_swap_b32 v42, v41
  v_add_f32 v42, v42, v41
  v_mov_b32 v41, v42
  s_nop 1
  v_permlane32_swap_b32 v42, v41
  v_add_f32 v42, v42, v41
  v_rcp_f32 v42, v42
  s_nop 0
  v_mul_f32 v12, v12, v42
  v_mul_f32 v13, v13, v42
  v_mul_f32 v14, v14, v42
  v_mul_f32 v15, v15, v42
  v_mul_f32 v16, v16, v42
  v_mul_f32 v17, v17, v42
  v_mul_f32 v18, v18, v42
  v_mul_f32 v19, v19, v42
  v_mul_f32 v28, v28, v42
  v_mul_f32 v29, v29, v42
  v_mul_f32 v30, v30, v42
  v_mul_f32 v31, v31, v42
  v_cvt_pk_bf16_f32 v52, v12, v13
  v_cvt_pk_bf16_f32 v53, v14, v15
  v_cvt_pk_bf16_f32 v54, v16, v17
  v_cvt_pk_bf16_f32 v55, v18, v19
  v_cvt_pk_bf16_f32 v56, v28, v29
  v_cvt_pk_bf16_f32 v57, v30, v31
  v_min_u32 v52, -2, v52
  v_min_u32 v53, -2, v53
  v_min_u32 v54, -2, v54
  v_min_u32 v55, -2, v55
  v_min_u32 v56, -2, v56
  v_min_u32 v57, -2, v57
  buffer_store_dwordx4 v[52:55], v2, s[8:11], s26 offen sc1
  s_mov_b64 exec, s[50:51]
  buffer_store_dwordx2 v[56:57], v2, s[8:11], s27 offen sc1
  s_mov_b64 exec, -1
  s_lshl_b32 s25, s17, 7
  s_add_u32 s25, s25, 88561664
  v_mov_b32 v5, 1
  v_mov_b32 v6, 0
  s_waitcnt vmcnt(0)
  s_mov_b64 exec, 1
  buffer_atomic_add v5, v6, s[8:11], s25 offen
  s_mov_b64 exec, -1
  s_branch wk_loop
wk_toko:
  s_lshl_b32 s20, s18, 2
  s_add_u32 s20, s20, s16
  s_mul_i32 s24, s20, 65
  s_add_u32 s24, s24, s17
  s_lshl_b32 s24, s24, 13
  s_add_u32 s24, s24, 76935168
  s_lshl_b32 s21, s20, 6
  s_add_u32 s21, s21, s17
  s_mul_i32 s21, s21, 28672
  s_add_u32 s21, s21, 42205184
  s_lshl_b32 s25, s17, 1
  s_mul_i32 s25, s25, 20480
  s_add_u32 s25, s25, 85446656
  v_lshrrev_b32 v8, 5, v1
  v_and_b32 v9, 31, v1
  v_min_u32 v5, 27, v9
  v_mad_u32_u24 v5, v8, 28, v5
  v_lshlrev_b32 v5, 4, v5
  v_lshrrev_b32 v10, 4, v9
  v_lshlrev_b32 v7, 10, v10
  v_lshl_add_u32 v7, v4, 4, v7
  v_lshl_add_u32 v7, v8, 3, v7
  v_mul_u32_u24 v6, 20480, v10
  v_lshl_add_u32 v6, v8, 8, v6
  v_lshl_add_u32 v6, v4, 4, v6
  s_lshr_b32 s26, s17, 3
  s_lshl_b32 s26, s26, 4
  s_add_u32 s26, s26, s20
  s_lshl_b32 s26, s26, 7
  s_add_u32 s26, s26, 88528896
  v_mov_b32 v60, 0
  s_mov_b32 s30, 0
wo_wv:
  buffer_load_dword v61, v60, s[8:11], s26 offen sc1
  s_waitcnt vmcnt(0)
  v_cmp_ne_u32 vcc, 56, v61
  s_cbranch_vccz wo_wv_ok
  s_sleep 1
  s_cmp_ge_u32 s17, 61
  s_cbranch_scc1 wo_wv_bo
  s_sleep 4
  s_cmp_ge_u32 s17, 56
  s_cbranch_scc1 wo_wv_bo
  s_sleep 40
wo_wv_bo:
  s_add_u32 s30, s30, 1
  s_cmp_lt_u32 s30, 30000
  s_cbranch_scc1 wo_wv
  s_branch wo_abort
wo_wv_ok:
  s_add_u32 s22, s21, 0
  buffer_load_dwordx4 a[0:3], v5, s[8:11], s22 offen offset:0 sc1
  buffer_load_dwordx4 a[4:7], v5, s[8:11], s22 offen offset:896 sc1
  buffer_load_dwordx4 a[8:11], v5, s[8:11], s22 offen offset:1792 sc1
  buffer_load_dwordx4 a[12:15], v5, s[8:11], s22 offen offset:2688 sc1
  s_add_u32 s22, s21, 3584
  buffer_load_dwordx4 a[16:19], v5, s[8:11], s22 offen offset:0 sc1
  buffer_load_dwordx4 a[20:23], v5, s[8:11], s22 offen offset:896 sc1
  buffer_load_dwordx4 a[24:27], v5, s[8:11], s22 offen offset:1792 sc1
  buffer_load_dwordx4 a[28:31], v5, s[8:11], s22 offen offset:2688 sc1
  s_add_u32 s22, s21, 7168
  buffer_load_dwordx4 a[32:35], v5, s[8:11], s22 offen offset:0 sc1
  buffer_load_dwordx4 a[36:39], v5, s[8:11], s22 offen offset:896 sc1
  buffer_load_dwordx4 a[40:43], v5, s[8:11], s22 offen offset:1792 sc1
  buffer_load_dwordx4 a[44:47], v5, s[8:11], s22 offen offset:2688 sc1
  s_add_u32 s22, s21, 10752
  buffer_load_dwordx4 a[48:51], v5, s[8:11], s22 offen offset:0 sc1
  buffer_load_dwordx4 a[52:55], v5, s[8:11], s22 offen offset:896 sc1
  buffer_load_dwordx4 a[56:59], v5, s[8:11], s22 offen offset:1792 sc1
  buffer_load_dwordx4 a[60:63], v5, s[8:11], s22 offen offset:2688 sc1
  s_add_u32 s22, s21, 14336
  buffer_load_dwordx4 a[64:67], v5, s[8:11], s22 offen offset:0 sc1
  buffer_load_dwordx4 a[68:71], v5, s[8:11], s22 offen offset:896 sc1
  buffer_load_dwordx4 a[72:75], v5, s[8:11], s22 offen offset:1792 sc1
  buffer_load_dwordx4 a[76:79], v5, s[8:11], s22 offen offset:2688 sc1
  s_add_u32 s22, s21, 17920
  buffer_load_dwordx4 a[80:83], v5, s[8:11], s22 offen offset:0 sc1
  buffer_load_dwordx4 a[84:87], v5, s[8:11], s22 offen offset:896 sc1
  buffer_load_dwordx4 a[88:91], v5, s[8:11], s22 offen offset:1792 sc1
  buffer_load_dwordx4 a[92:95], v5, s[8:11], s22 offen offset:2688 sc1
  s_add_u32 s22, s21, 21504
  buffer_load_dwordx4 a[96:99], v5, s[8:11], s22 offen offset:0 sc1
  buffer_load_dwordx4 a[100:103], v5, s[8:11], s22 offen offset:896 sc1
  buffer_load_dwordx4 a[104:107], v5, s[8:11], s22 offen offset:1792 sc1
  buffer_load_dwordx4 a[108:111], v5, s[8:11], s22 offen offset:2688 sc1
  s_add_u32 s22, s21, 25088
  buffer_load_dwordx4 a[112:115], v5, s[8:11], s22 offen offset:0 sc1
  buffer_load_dwordx4 a[116:119], v5, s[8:11], s22 offen offset:896 sc1
  buffer_load_dwordx4 a[120:123], v5, s[8:11], s22 offen offset:1792 sc1
  buffer_load_dwordx4 a[124:127], v5, s[8:11], s22 offen offset:2688 sc1
  s_cmp_ge_u32 s17, 61
  s_cbranch_scc1 wo_lm
  s_lshl_b32 s26, s17, 7
  s_add_u32 s26, s26, 88561664
  v_mov_b32 v60, 0
  s_mov_b32 s30, 0
wo_wp:
  buffer_load_dword v61, v60, s[8:11], s26 offen sc1
  s_waitcnt vmcnt(0)
  v_cmp_ne_u32 vcc, 16, v61
  s_cbranch_vccz wo_wp_ok
  s_sleep 2
  s_cmp_ge_u32 s17, 61
  s_cbranch_scc1 wo_wp_bo
  s_sleep 4
  s_cmp_ge_u32 s17, 56
  s_cbranch_scc1 wo_wp_bo
  s_sleep 40
wo_wp_bo:
  s_add_u32 s30, s30, 1
  s_cmp_lt_u32 s30, 30000
  s_cbranch_scc1 wo_wp
  s_branch wo_abort
wo_wp_ok:
  s_branch wo_lp
wo_lm:
  s_mul_i32 s26, s17, 7168
  s_add_u32 s26, s26, 88068096
  v_mov_b32 v60, 0
  s_mov_b32 s30, 0
wo_wm:
  buffer_load_dword v61, v60, s[8:11], s26 offen sc1
  s_waitcnt vmcnt(0)
  v_cmp_eq_u32 vcc, -1, v61
  s_cbranch_vccz wo_wm_ok
  s_sleep 2
  s_cmp_ge_u32 s17, 61
  s_cbranch_scc1 wo_wm_bo
  s_sleep 4
  s_cmp_ge_u32 s17, 56
  s_cbranch_scc1 wo_wm_bo
  s_sleep 40
wo_wm_bo:
  s_add_u32 s30, s30, 1
  s_cmp_lt_u32 s30, 30000
  s_cbranch_scc1 wo_wm
  s_branch wo_abort
wo_wm_ok:
wo_lp:
  s_mul_i32 s26, s16, 10240
  s_add_u32 s27, s25, s26
  v_add_u32 v11, s26, v2
  s_lshl_b32 s26, s20, 6
  s_add_u32 s26, s26, s17
  s_lshl_b32 s26, s26, 4
  s_add_u32 s26, s26, 88569856
  v_lshlrev_b32 v60, 2, v3
  s_mov_b32 s30, 0
wo_pl:
  s_add_u32 s22, s27, 0
  buffer_load_dwordx4 v[128:131], v2, s[8:11], s22 offen offset:0 sc1
  buffer_load_dwordx4 v[132:135], v2, s[8:11], s22 offen offset:1024 sc1
  buffer_load_dwordx4 v[136:139], v2, s[8:11], s22 offen offset:2048 sc1
  buffer_load_dwordx4 v[140:143], v2, s[8:11], s22 offen offset:3072 sc1
  s_add_u32 s22, s27, 4096
  buffer_load_dwordx4 v[144:147], v2, s[8:11], s22 offen offset:0 sc1
  buffer_load_dwordx4 v[148:151], v2, s[8:11], s22 offen offset:1024 sc1
  buffer_load_dwordx4 v[152:155], v2, s[8:11], s22 offen offset:2048 sc1
  buffer_load_dwordx4 v[156:159], v2, s[8:11], s22 offen offset:3072 sc1
  s_add_u32 s22, s27, 8192
  buffer_load_dwordx4 v[160:163], v2, s[8:11], s22 offen offset:0 sc1
  buffer_load_dwordx4 v[164:167], v2, s[8:11], s22 offen offset:1024 sc1
  buffer_load_dword v61, v60, s[8:11], s26 offen sc1
  s_waitcnt vmcnt(1)
  v_max_u32 v62, v128, v129
  v_max3_u32 v62, v62, v130, v131
  v_max3_u32 v62, v62, v132, v133
  v_max3_u32 v62, v62, v134, v135
  v_max3_u32 v62, v62, v136, v137
  v_max3_u32 v62, v62, v138, v139
  v_max3_u32 v62, v62, v140, v141
  v_max3_u32 v62, v62, v142, v143
  v_max3_u32 v62, v62, v144, v145
  v_max3_u32 v62, v62, v146, v147
  v_max3_u32 v62, v62, v148, v149
  v_max3_u32 v62, v62, v150, v151
  v_max3_u32 v62, v62, v152, v153
  v_max3_u32 v62, v62, v154, v155
  v_max3_u32 v62, v62, v156, v157
  v_max3_u32 v62, v62, v158, v159
  v_max3_u32 v62, v62, v160, v161
  v_max3_u32 v62, v62, v162, v163
  v_max3_u32 v62, v62, v164, v165
  v_max3_u32 v62, v62, v166, v167
  v_cmp_eq_u32 vcc, -1, v62
  s_cbranch_vccz wo_pk
  s_add_u32 s30, s30, 1
  s_cmp_lt_u32 s30, 30000
  s_cbranch_scc1 wo_pl
  s_branch wo_abort
wo_pk:
  ds_write_b128 v11, v[128:131] offset:0
  ds_write_b128 v11, v[132:135] offset:1024
  ds_write_b128 v11, v[136:139] offset:2048
  ds_write_b128 v11, v[140:143] offset:3072
  ds_write_b128 v11, v[144:147] offset:4096
  ds_write_b128 v11, v[148:151] offset:5120
  ds_write_b128 v11, v[152:155] offset:6144
  ds_write_b128 v11, v[156:159] offset:7168
  ds_write_b128 v11, v[160:163] offset:8192
  ds_write_b128 v11, v[164:167] offset:9216
  s_waitcnt vmcnt(0)
  v_cmp_ne_u32 vcc, 1, v61
  s_mov_b32 s28, 0
  s_cbranch_vccnz wo_nt
  s_add_u32 s22, s24, 0
  buffer_load_dwordx2 v[28:29], v7, s[8:11], s22 offen offset:0 sc1
  buffer_load_dwordx2 v[30:31], v7, s[8:11], s22 offen offset:512 sc1
  buffer_load_dwordx2 v[32:33], v7, s[8:11], s22 offen offset:256 sc1
  buffer_load_dwordx2 v[34:35], v7, s[8:11], s22 offen offset:768 sc1
  buffer_load_dwordx2 v[36:37], v7, s[8:11], s22 offen offset:2048 sc1
  buffer_load_dwordx2 v[38:39], v7, s[8:11], s22 offen offset:2560 sc1
  buffer_load_dwordx2 v[40:41], v7, s[8:11], s22 offen offset:2304 sc1
  buffer_load_dwordx2 v[42:43], v7, s[8:11], s22 offen offset:2816 sc1
  s_add_u32 s22, s24, 4096
  buffer_load_dwordx2 v[44:45], v7, s[8:11], s22 offen offset:0 sc1
  buffer_load_dwordx2 v[46:47], v7, s[8:11], s22 offen offset:512 sc1
  buffer_load_dwordx2 v[48:49], v7, s[8:11], s22 offen offset:256 sc1
  buffer_load_dwordx2 v[50:51], v7, s[8:11], s22 offen offset:768 sc1
  buffer_load_dwordx2 v[52:53], v7, s[8:11], s22 offen offset:2048 sc1
  buffer_load_dwordx2 v[54:55], v7, s[8:11], s22 offen offset:2560 sc1
  buffer_load_dwordx2 v[56:57], v7, s[8:11], s22 offen offset:2304 sc1
  buffer_load_dwordx2 v[58:59], v7, s[8:11], s22 offen offset:2816 sc1
  s_mov_b32 s28, 1
wo_nt:
  buffer_load_dword v250, v251, s[12:15], 0 offen sc1
  s_waitcnt lgkmcnt(0)
  s_barrier
  buffer_load_dword v61, v60, s[8:11], s26 offen sc1
  ds_read_b128 v[64:67], v6 offset:0
  ds_read_b128 v[68:71], v6 offset:512
  ds_read_b128 v[72:75], v6 offset:1024
  ds_read_b128 v[76:79], v6 offset:1536
  ds_read_b128 v[80:83], v6 offset:2048
  ds_read_b128 v[84:87], v6 offset:2560
  ds_read_b128 v[88:91], v6 offset:3072
  s_waitcnt lgkmcnt(6)
  v_mfma_f32_32x32x16_bf16 v[12:27], a[0:3], v[64:67], 0
  ds_read_b128 v[92:95], v6 offset:3584
  s_waitcnt lgkmcnt(6)
  v_mfma_f32_32x32x16_bf16 v[12:27], a[4:7], v[68:71], v[12:27]
  ds_read_b128 v[64:67], v6 offset:4096
  s_waitcnt lgkmcnt(6)
  v_mfma_f32_32x32x16_bf16 v[12:27], a[8:11], v[72:75], v[12:27]
  ds_read_b128 v[68:71], v6 offset:4608
  s_waitcnt lgkmcnt(6)
  v_mfma_f32_32x32x16_bf16 v[12:27], a[12:15], v[76:79], v[12:27]
  ds_read_b128 v[72:75], v6 offset:5120
  s_waitcnt lgkmcnt(6)
  v_mfma_f32_32x32x16_bf16 v[12:27], a[16:19], v[80:83], v[12:27]
  ds_read_b128 v[76:79], v6 offset:5632
  s_waitcnt lgkmcnt(6)
  v_mfma_f32_32x32x16_bf16 v[12:27], a[20:23], v[84:87], v[12:27]
  ds_read_b128 v[80:83], v6 offset:6144
  s_waitcnt lgkmcnt(6)
  v_mfma_f32_32x32x16_bf16 v[12:27], a[24:27], v[88:91], v[12:27]
  ds_read_b128 v[84:87], v6 offset:6656
  s_waitcnt lgkmcnt(6)
  v_mfma_f32_32x32x16_bf16 v[12:27], a[28:31], v[92:95], v[12:27]
  ds_read_b128 v[88:91], v6 offset:7168
  s_waitcnt lgkmcnt(6)
  v_mfma_f32_32x32x16_bf16 v[12:27], a[32:35], v[64:67], v[12:27]
  ds_read_b128 v[92:95], v6 offset:7680
  s_waitcnt lgkmcnt(6)
  v_mfma_f32_32x32x16_bf16 v[12:27], a[36:39], v[68:71], v[12:27]
  ds_read_b128 v[64:67], v6 offset:8192
  s_waitcnt lgkmcnt(6)
  v_mfma_f32_32x32x16_bf16 v[12:27], a[40:43], v[72:75], v[12:27]
  ds_read_b128 v[68:71], v6 offset:8704
  s_waitcnt lgkmcnt(6)
  v_mfma_f32_32x32x16_bf16 v[12:27], a[44:47], v[76:79], v[12:27]
  ds_read_b128 v[72:75], v6 offset:9216
  s_waitcnt lgkmcnt(6)
  v_mfma_f32_32x32x16_bf16 v[12:27], a[48:51], v[80:83], v[12:27]
  ds_read_b128 v[76:79], v6 offset:9728
  s_waitcnt lgkmcnt(6)
  v_mfma_f32_32x32x16_bf16 v[12:27], a[52:55], v[84:87], v[12:27]
  ds_read_b128 v[80:83], v6 offset:10240
  s_waitcnt lgkmcnt(6)
  v_mfma_f32_32x32x16_bf16 v[12:27], a[56:59], v[88:91], v[12:27]
  ds_read_b128 v[84:87], v6 offset:10752
  s_waitcnt lgkmcnt(6)
  v_mfma_f32_32x32x16_bf16 v[12:27], a[60:63], v[92:95], v[12:27]
  ds_read_b128 v[88:91], v6 offset:11264
  s_waitcnt lgkmcnt(6)
  v_mfma_f32_32x32x16_bf16 v[12:27], a[64:67], v[64:67], v[12:27]
  ds_read_b128 v[92:95], v6 offset:11776
  s_waitcnt lgkmcnt(6)
  v_mfma_f32_32x32x16_bf16 v[12:27], a[68:71], v[68:71], v[12:27]
  ds_read_b128 v[64:67], v6 offset:12288
  s_waitcnt lgkmcnt(6)
  v_mfma_f32_32x32x16_bf16 v[12:27], a[72:75], v[72:75], v[12:27]
  ds_read_b128 v[68:71], v6 offset:12800
  s_waitcnt lgkmcnt(6)
  v_mfma_f32_32x32x16_bf16 v[12:27], a[76:79], v[76:79], v[12:27]
  s_cmp_lg_u32 s28, 0
  s_cbranch_scc1 wo_h2
  s_waitcnt vmcnt(0)
  v_cmp_ne_u32 vcc, 1, v61
  s_cbranch_vccnz wo_h2
  s_add_u32 s22, s24, 0
  buffer_load_dwordx2 v[28:29], v7, s[8:11], s22 offen offset:0 sc1
  buffer_load_dwordx2 v[30:31], v7, s[8:11], s22 offen offset:512 sc1
  buffer_load_dwordx2 v[32:33], v7, s[8:11], s22 offen offset:256 sc1
  buffer_load_dwordx2 v[34:35], v7, s[8:11], s22 offen offset:768 sc1
  buffer_load_dwordx2 v[36:37], v7, s[8:11], s22 offen offset:2048 sc1
  buffer_load_dwordx2 v[38:39], v7, s[8:11], s22 offen offset:2560 sc1
  buffer_load_dwordx2 v[40:41], v7, s[8:11], s22 offen offset:2304 sc1
  buffer_load_dwordx2 v[42:43], v7, s[8:11], s22 offen offset:2816 sc1
  s_add_u32 s22, s24, 4096
  buffer_load_dwordx2 v[44:45], v7, s[8:11], s22 offen offset:0 sc1
  buffer_load_dwordx2 v[46:47], v7, s[8:11], s22 offen offset:512 sc1
  buffer_load_dwordx2 v[48:49], v7, s[8:11], s22 offen offset:256 sc1
  buffer_load_dwordx2 v[50:51], v7, s[8:11], s22 offen offset:768 sc1
  buffer_load_dwordx2 v[52:53], v7, s[8:11], s22 offen offset:2048 sc1
  buffer_load_dwordx2 v[54:55], v7, s[8:11], s22 offen offset:2560 sc1
  buffer_load_dwordx2 v[56:57], v7, s[8:11], s22 offen offset:2304 sc1
  buffer_load_dwordx2 v[58:59], v7, s[8:11], s22 offen offset:2816 sc1
  s_mov_b32 s28, 1
wo_h2:
  ds_read_b128 v[72:75], v6 offset:13312
  s_waitcnt lgkmcnt(6)
  v_mfma_f32_32x32x16_bf16 v[12:27], a[80:83], v[80:83], v[12:27]
  ds_read_b128 v[76:79], v6 offset:13824
  s_waitcnt lgkmcnt(6)
  v_mfma_f32_32x32x16_bf16 v[12:27], a[84:87], v[84:87], v[12:27]
  ds_read_b128 v[80:83], v6 offset:14336
  s_waitcnt lgkmcnt(6)
  v_mfma_f32_32x32x16_bf16 v[12:27], a[88:91], v[88:91], v[12:27]
  ds_read_b128 v[84:87], v6 offset:14848
  s_waitcnt lgkmcnt(6)
  v_mfma_f32_32x32x16_bf16 v[12:27], a[92:95], v[92:95], v[12:27]
  ds_read_b128 v[88:91], v6 offset:15360
  s_waitcnt lgkmcnt(6)
  v_mfma_f32_32x32x16_bf16 v[12:27], a[96:99], v[64:67], v[12:27]
  ds_read_b128 v[92:95], v6 offset:15872
  s_waitcnt lgkmcnt(6)
  v_mfma_f32_32x32x16_bf16 v[12:27], a[100:103], v[68:71], v[12:27]
  ds_read_b128 v[64:67], v6 offset:16384
  s_waitcnt lgkmcnt(6)
  v_mfma_f32_32x32x16_bf16 v[12:27], a[104:107], v[72:75], v[12:27]
  ds_read_b128 v[68:71], v6 offset:16896
  s_waitcnt lgkmcnt(6)
  v_mfma_f32_32x32x16_bf16 v[12:27], a[108:111], v[76:79], v[12:27]
  ds_read_b128 v[72:75], v6 offset:17408
  s_waitcnt lgkmcnt(6)
  v_mfma_f32_32x32x16_bf16 v[12:27], a[112:115], v[80:83], v[12:27]
  ds_read_b128 v[76:79], v6 offset:17920
  s_waitcnt lgkmcnt(6)
  v_mfma_f32_32x32x16_bf16 v[12:27], a[116:119], v[84:87], v[12:27]
  ds_read_b128 v[80:83], v6 offset:18432
  s_waitcnt lgkmcnt(6)
  v_mfma_f32_32x32x16_bf16 v[12:27], a[120:123], v[88:91], v[12:27]
  ds_read_b128 v[84:87], v6 offset:18944
  s_waitcnt lgkmcnt(6)
  v_mfma_f32_32x32x16_bf16 v[12:27], a[124:127], v[92:95], v[12:27]
  s_cmp_lg_u32 s28, 0
  s_cbranch_scc1 wo_ht
  v_lshlrev_b32 v60, 2, v3
  s_mov_b32 s30, 0
wo_wt:
  buffer_load_dword v61, v60, s[8:11], s26 offen sc1
  s_waitcnt vmcnt(0)
  v_cmp_ne_u32 vcc, 1, v61
  s_cbranch_vccz wo_wt_ok
  s_sleep 1
  s_cmp_ge_u32 s17, 61
  s_cbranch_scc1 wo_wt_bo
  s_sleep 4
  s_cmp_ge_u32 s17, 56
  s_cbranch_scc1 wo_wt_bo
  s_sleep 40
wo_wt_bo:
  s_add_u32 s30, s30, 1
  s_cmp_lt_u32 s30, 30000
  s_cbranch_scc1 wo_wt
  s_branch wo_abort
wo_wt_ok:
  s_add_u32 s22, s24, 0
  buffer_load_dwordx2 v[28:29], v7, s[8:11], s22 offen offset:0 sc1
  buffer_load_dwordx2 v[30:31], v7, s[8:11], s22 offen offset:512 sc1
  buffer_load_dwordx2 v[32:33], v7, s[8:11], s22 offen offset:256 sc1
  buffer_load_dwordx2 v[34:35], v7, s[8:11], s22 offen offset:768 sc1
  buffer_load_dwordx2 v[36:37], v7, s[8:11], s22 offen offset:2048 sc1
  buffer_load_dwordx2 v[38:39], v7, s[8:11], s22 offen offset:2560 sc1
  buffer_load_dwordx2 v[40:41], v7, s[8:11], s22 offen offset:2304 sc1
  buffer_load_dwordx2 v[42:43], v7, s[8:11], s22 offen offset:2816 sc1
  s_add_u32 s22, s24, 4096
  buffer_load_dwordx2 v[44:45], v7, s[8:11], s22 offen offset:0 sc1
  buffer_load_dwordx2 v[46:47], v7, s[8:11], s22 offen offset:512 sc1
  buffer_load_dwordx2 v[48:49], v7, s[8:11], s22 offen offset:256 sc1
  buffer_load_dwordx2 v[50:51], v7, s[8:11], s22 offen offset:768 sc1
  buffer_load_dwordx2 v[52:53], v7, s[8:11], s22 offen offset:2048 sc1
  buffer_load_dwordx2 v[54:55], v7, s[8:11], s22 offen offset:2560 sc1
  buffer_load_dwordx2 v[56:57], v7, s[8:11], s22 offen offset:2304 sc1
  buffer_load_dwordx2 v[58:59], v7, s[8:11], s22 offen offset:2816 sc1
wo_ht:
  ds_read_b128 v[88:91], v6 offset:19456
  s_waitcnt lgkmcnt(6) vmcnt(0)
  v_mfma_f32_32x32x16_bf16 v[12:27], v[28:31], v[64:67], v[12:27]
  ds_read_b128 v[92:95], v6 offset:19968
  s_waitcnt lgkmcnt(6)
  v_mfma_f32_32x32x16_bf16 v[12:27], v[32:35], v[68:71], v[12:27]
  s_waitcnt lgkmcnt(5)
  v_mfma_f32_32x32x16_bf16 v[12:27], v[36:39], v[72:75], v[12:27]
  s_waitcnt lgkmcnt(4)
  v_mfma_f32_32x32x16_bf16 v[12:27], v[40:43], v[76:79], v[12:27]
  s_waitcnt lgkmcnt(3)
  v_mfma_f32_32x32x16_bf16 v[12:27], v[44:47], v[80:83], v[12:27]
  s_waitcnt lgkmcnt(2)
  v_mfma_f32_32x32x16_bf16 v[12:27], v[48:51], v[84:87], v[12:27]
  s_waitcnt lgkmcnt(1)
  v_mfma_f32_32x32x16_bf16 v[12:27], v[52:55], v[88:91], v[12:27]
  s_waitcnt lgkmcnt(0)
  v_mfma_f32_32x32x16_bf16 v[12:27], v[56:59], v[92:95], v[12:27]
  v_mul_u32_u24 v9, 240, v9
  s_movk_i32 s23, 240
  v_lshl_add_u32 v8, v8, 3, v9
  s_mul_i32 s22, s16, 56
  v_add_u32 v8, s22, v8
  v_min_u32 v11, 223, v0
  v_mul_u32_u24 v9, 4682, v11
  v_lshrrev_b32 v9, 16, v9
  v_mul_u32_u24 v10, 14, v9
  v_sub_u32 v10, v11, v10
  v_lshlrev_b32 v10, 4, v10
  v_mad_u32_u24 v11, v9, s23, v10
  v_mul_u32_u24 v9, 1792, v9
  v_add_u32 v10, v9, v10
  s_mul_i32 s26, s17, 57344
  s_mul_i32 s22, s18, 224
  s_add_u32 s26, s26, s22
  s_add_u32 s26, s26, 896
  s_add_u32 s27, s26, 28672
  v_cvt_pk_bf16_f32 v96, v12, v13
  v_cvt_pk_bf16_f32 v97, v14, v15
  ds_write_b64 v8, v[96:97] offset:49152
  v_cvt_pk_bf16_f32 v98, v16, v17
  v_cvt_pk_bf16_f32 v99, v18, v19
  ds_write_b64 v8, v[98:99] offset:49168
  v_cvt_pk_bf16_f32 v100, v20, v21
  v_cvt_pk_bf16_f32 v101, v22, v23
  ds_write_b64 v8, v[100:101] offset:49184
  v_cvt_pk_bf16_f32 v102, v24, v25
  v_cvt_pk_bf16_f32 v103, v26, v27
  s_mov_b32 exec_hi, 0
  ds_write_b64 v8, v[102:103] offset:49200
  s_mov_b64 exec, -1
  s_waitcnt lgkmcnt(0)
  s_barrier
  ds_read_b128 v[104:107], v11 offset:49152
  ds_read_b128 v[108:111], v11 offset:52992
  s_cmp_lg_u32 s16, 3
  s_cselect_b32 exec_hi, -1, 0
  s_waitcnt lgkmcnt(1)
  buffer_store_dwordx4 v[104:107], v10, s[92:95], s26 offen
  s_waitcnt lgkmcnt(0)
  buffer_store_dwordx4 v[108:111], v10, s[92:95], s27 offen
  s_mov_b64 exec, -1
  v_readfirstlane_b32 s22, v250
  s_cmp_ge_u32 s22, 1376
  s_cbranch_scc1 ch_end
  s_branch wk_loop
wp_abort:
wo_abort:
  s_branch cA_abort
ch_end:
  s_endpgm

.section .rodata,"a"
.p2align 6
.amdhsa_kernel main_kernel
  .amdhsa_next_free_vgpr 512
  .amdhsa_next_free_sgpr 102
  .amdhsa_accum_offset 256
  .amdhsa_group_segment_fixed_size 0
  .amdhsa_kernarg_size 136
  .amdhsa_user_sgpr_count 2
  .amdhsa_user_sgpr_kernarg_segment_ptr 1
  .amdhsa_system_sgpr_workgroup_id_x 1
.end_amdhsa_kernel
```

```asm
; @launch kernel=main_kernel grid=(256,1,1) block=(256,1,1) lds=163840
.amdgcn_target "amdgcn-amd-amdhsa--gfx950"
.text
.globl main_kernel
.p2align 8
.type main_kernel,@function
main_kernel:
  s_cmp_ge_u32 s2, 256
  s_cbranch_scc1 ch_end
  s_load_dwordx4 s[4:7], s[0:1], 120
  s_load_dwordx2 s[92:93], s[0:1], 112
  s_load_dwordx8 s[36:43], s[0:1], 56
  s_load_dwordx4 s[44:47], s[0:1], 88
  s_memrealtime s[88:89]
  s_getpc_b64 s[98:99]
pf_main_kernel_1:
  s_sub_u32 s98, s98, pf_main_kernel_1-main_kernel
  s_subb_u32 s99, s99, 0
  s_lshr_b32 s20, s2, 3
  v_lshl_add_u32 v60, v0, 5, s20
  v_lshlrev_b32 v60, 7, v60
  v_min_u32 v60, ch_end-main_kernel-4, v60
  v_cmp_gt_u32 vcc, 32, v0
  s_and_saveexec_b64 s[22:23], vcc
  s_cbranch_execz pf_main_kernel_1_n
  global_load_dword v62, v60, s[98:99]
pf_main_kernel_1_n:
  s_mov_b64 exec, -1
  s_getreg_b32 s67, hwreg(HW_REG_XCC_ID)
  s_and_b32 s67, s67, 7
  v_lshrrev_b32 v1, 6, v0
  s_nop 0
  v_readfirstlane_b32 s16, v1
  s_mov_b32 s66, 0
  s_mov_b32 s68, 0
  s_mov_b32 s69, 0
  s_mov_b32 s96, 0
  s_mov_b32 s97, 0
  s_mov_b32 s101, 0x5eed0000
  s_sub_u32 s20, s67, 0
  s_lshr_b32 s21, s2, 3
  s_and_b32 s20, s20, 7
  s_lshl_b32 s3, s20, 5
  s_add_u32 s3, s3, s21
  s_waitcnt lgkmcnt(0)
  s_mov_b32 s8, s6
  s_and_b32 s9, s7, 0xffff
  s_mov_b32 s10, 0x10000000
  s_mov_b32 s11, 0x20000
  s_mov_b32 s12, s4
  s_and_b32 s13, s5, 0xffff
  s_mov_b32 s14, 256
  s_mov_b32 s15, 0x20000
  s_or_b32 s88, s88, 1
  s_and_b32 s93, s93, 0xffff
  s_mov_b32 s94, 3670016
  s_mov_b32 s95, 0x20000
m_start:
  s_cmp_ge_u32 s3, 32
  s_cbranch_scc1 m_bjob
  v_and_b32 v1, 63, v0
  v_lshlrev_b32 v2, 4, v1
  v_lshrrev_b32 v116, 4, v1
  v_and_b32 v117, 15, v1
  v_mov_b32 v3, 0x4444
  v_mov_b32 v118, 0xeeee
  v_cmp_lt_u32 vcc, 7, v117
  s_nop 1
  v_cndmask_b32 v3, v3, v118, vcc
  s_and_b32 s17, s3, 15
  s_cmp_ge_u32 s3, 16
  s_cbranch_scc1 m_val
  s_mov_b32 s60, s42
  s_and_b32 s61, s43, 0xffff
  s_mov_b32 s62, 3670016
  s_mov_b32 s63, 0x20000
  v_lshrrev_b32 v24, 5, v1
  v_and_b32 v25, 31, v1
  s_lshl_b32 s26, s17, 9
  s_lshl_b32 s25, s16, 12
  v_xor_b32 v26, v25, v24
  v_lshlrev_b32 v26, 4, v26
  v_lshl_add_u32 v26, v24, 13, v26
  v_xor_b32 v100, 0, v26
  v_xor_b32 v101, 0, v26
  v_add_u32 v101, 15360, v101
  v_xor_b32 v102, 32, v26
  v_add_u32 v102, 30720, v102
  v_xor_b32 v103, 32, v26
  v_add_u32 v103, 46080, v103
  s_lshl_b32 s23, s16, 19
  s_add_u32 s23, s23, s26
  s_add_u32 m0, s25, 16384
  s_nop 0
  buffer_load_dwordx4 v100, s[60:63], s23 offen offset:0 lds
  buffer_load_dwordx4 v101, s[60:63], s23 offen offset:1024 lds
  buffer_load_dwordx4 v102, s[60:63], s23 offen offset:2048 lds
  buffer_load_dwordx4 v103, s[60:63], s23 offen offset:3072 lds
  s_add_u32 m0, s25, 32768
  s_add_u32 s23, s23, 65536
  buffer_load_dwordx4 v100, s[60:63], s23 offen offset:0 lds
  buffer_load_dwordx4 v101, s[60:63], s23 offen offset:1024 lds
  buffer_load_dwordx4 v102, s[60:63], s23 offen offset:2048 lds
  buffer_load_dwordx4 v103, s[60:63], s23 offen offset:3072 lds
  v_xor_b32 v100, 64, v100
  v_xor_b32 v101, 64, v101
  v_xor_b32 v102, 64, v102
  v_xor_b32 v103, 64, v103
  s_add_u32 m0, s25, 49152
  s_add_u32 s23, s23, 65536
  buffer_load_dwordx4 v100, s[60:63], s23 offen offset:0 lds
  buffer_load_dwordx4 v101, s[60:63], s23 offen offset:1024 lds
  buffer_load_dwordx4 v102, s[60:63], s23 offen offset:2048 lds
  buffer_load_dwordx4 v103, s[60:63], s23 offen offset:3072 lds
  s_add_u32 m0, s25, 65536
  s_add_u32 s23, s23, 65536
  buffer_load_dwordx4 v100, s[60:63], s23 offen offset:0 lds
  buffer_load_dwordx4 v101, s[60:63], s23 offen offset:1024 lds
  buffer_load_dwordx4 v102, s[60:63], s23 offen offset:2048 lds
  buffer_load_dwordx4 v103, s[60:63], s23 offen offset:3072 lds
  v_xor_b32 v100, 192, v100
  v_xor_b32 v101, 192, v101
  v_xor_b32 v102, 192, v102
  v_xor_b32 v103, 192, v103
  s_add_u32 m0, s25, 81920
  s_add_u32 s23, s23, 65536
  buffer_load_dwordx4 v100, s[60:63], s23 offen offset:0 lds
  buffer_load_dwordx4 v101, s[60:63], s23 offen offset:1024 lds
  buffer_load_dwordx4 v102, s[60:63], s23 offen offset:2048 lds
  buffer_load_dwordx4 v103, s[60:63], s23 offen offset:3072 lds
  s_add_u32 m0, s25, 98304
  s_add_u32 s23, s23, 65536
  buffer_load_dwordx4 v100, s[60:63], s23 offen offset:0 lds
  buffer_load_dwordx4 v101, s[60:63], s23 offen offset:1024 lds
  buffer_load_dwordx4 v102, s[60:63], s23 offen offset:2048 lds
  buffer_load_dwordx4 v103, s[60:63], s23 offen offset:3072 lds
  v_xor_b32 v100, 64, v100
  v_xor_b32 v101, 64, v101
  v_xor_b32 v102, 64, v102
  v_xor_b32 v103, 64, v103
  s_add_u32 m0, s25, 114688
  s_add_u32 s23, s23, 65536
  buffer_load_dwordx4 v100, s[60:63], s23 offen offset:0 lds
  buffer_load_dwordx4 v101, s[60:63], s23 offen offset:1024 lds
  buffer_load_dwordx4 v102, s[60:63], s23 offen offset:2048 lds
  buffer_load_dwordx4 v103, s[60:63], s23 offen offset:3072 lds
  s_add_u32 m0, s25, 131072
  s_add_u32 s23, s23, 65536
  buffer_load_dwordx4 v100, s[60:63], s23 offen offset:0 lds
  buffer_load_dwordx4 v101, s[60:63], s23 offen offset:1024 lds
  buffer_load_dwordx4 v102, s[60:63], s23 offen offset:2048 lds
  buffer_load_dwordx4 v103, s[60:63], s23 offen offset:3072 lds
  s_mov_b32 s56, s40
  s_and_b32 s57, s41, 0xffff
  s_mov_b32 s58, 3670016
  s_mov_b32 s59, 0x20000
  s_lshl_b32 s21, s16, 16
  s_add_u32 s27, s26, s21
  s_lshr_b32 s20, s16, 1
  s_lshl_b32 s20, s20, 6
  v_xor_b32 v26, s20, v26
  v_xor_b32 v4, 0, v26
  v_xor_b32 v5, 32, v26
  v_add_u32 v5, 15360, v5
  v_xor_b32 v6, 128, v26
  v_add_u32 v6, 30720, v6
  v_xor_b32 v7, 160, v26
  v_add_u32 v7, 46080, v7
  s_add_u32 s22, s27, 0
  s_add_u32 m0, s25, 0
  s_nop 0
  buffer_load_dwordx4 v4, s[56:59], s22 offen offset:0 lds
  buffer_load_dwordx4 v5, s[56:59], s22 offen offset:1024 lds
  buffer_load_dwordx4 v6, s[56:59], s22 offen offset:2048 lds
  buffer_load_dwordx4 v7, s[56:59], s22 offen offset:3072 lds
  s_cmp_lg_u32 s66, 0
  s_cbranch_scc1 sc_ci
  s_cmp_lg_u32 s16, 0
  s_cbranch_scc1 w0_2
  s_lshr_b32 s70, s3, 5
  s_and_b32 s71, s70, 4
  s_mul_i32 s71, s71, 12
  s_lshl_b32 s70, s70, 2
  s_add_u32 s70, s70, s71
  s_lshl_b32 s71, 1, s3
  v_mov_b32 v248, s71
  v_mov_b32 v249, 32
  s_mov_b64 exec, 1
  buffer_atomic_or v248, v249, s[12:15], s70 offen sc0
  buffer_load_dwordx2 v[250:251], v249, s[12:15], 0 offen offset:96 sc1
  s_mov_b64 exec, -1
w0_2:
sc_ci:
  v_and_b32 v26, 15, v25
  v_xor_b32 v27, v26, v24
  v_lshlrev_b32 v27, 4, v27
  v_bfe_u32 v28, v25, 2, 1
  v_lshlrev_b32 v28, 4, v28
  v_lshrrev_b32 v29, 3, v25
  v_lshl_add_u32 v28, v29, 2, v28
  v_and_b32 v29, 3, v25
  v_add_u32 v28, v28, v29
  v_lshl_add_u32 v28, v28, 9, v27
  v_lshrrev_b32 v29, 2, v26
  v_lshlrev_b32 v29, 15, v29
  v_bfe_u32 v30, v26, 1, 1
  v_lshl_add_u32 v29, v30, 11, v29
  v_lshrrev_b32 v30, 4, v25
  v_lshl_add_u32 v29, v30, 10, v29
  v_and_b32 v31, 1, v26
  v_lshl_add_u32 v29, v31, 9, v29
  v_add_u32 v29, v29, v27
  v_add_u32 v29, s25, v29
  v_xor_b32 v8, 0, v28
  v_xor_b32 v104, 0, v29
  v_xor_b32 v9, 32, v28
  v_xor_b32 v105, 32, v29
  v_xor_b32 v10, 64, v28
  v_xor_b32 v106, 64, v29
  v_xor_b32 v11, 96, v28
  v_xor_b32 v107, 96, v29
  v_xor_b32 v12, 128, v28
  v_xor_b32 v108, 128, v29
  v_xor_b32 v13, 160, v28
  v_xor_b32 v109, 160, v29
  v_xor_b32 v14, 192, v28
  v_xor_b32 v110, 192, v29
  v_xor_b32 v15, 224, v28
  v_xor_b32 v111, 224, v29
  s_mov_b32 s52, 1035512379
  s_waitcnt vmcnt(4)
  ds_read_b128 v[120:123], v104 offset:16384
  ds_read_b128 v[124:127], v105 offset:16384
  ds_read_b128 v[128:131], v106 offset:16384
  ds_read_b128 v[132:135], v107 offset:16384
  ds_read_b128 v[136:139], v108 offset:16384
  ds_read_b128 v[140:143], v109 offset:16384
  ds_read_b128 v[144:147], v110 offset:16384
  ds_read_b128 v[148:151], v111 offset:16384
  s_waitcnt lgkmcnt(4)
  ds_read_b128 v[152:155], v104 offset:16640
  ds_read_b128 v[156:159], v105 offset:16640
  ds_read_b128 v[160:163], v106 offset:16640
  ds_read_b128 v[164:167], v107 offset:16640
  ds_read_b128 v[168:171], v108 offset:16640
  ds_read_b128 v[172:175], v109 offset:16640
  ds_read_b128 v[176:179], v110 offset:16640
  ds_read_b128 v[180:183], v111 offset:16640
  s_waitcnt lgkmcnt(4)
  ds_read_b128 v[184:187], v104 offset:32768
  ds_read_b128 v[188:191], v105 offset:32768
  ds_read_b128 v[192:195], v106 offset:32768
  ds_read_b128 v[196:199], v107 offset:32768
  ds_read_b128 v[200:203], v108 offset:32768
  ds_read_b128 v[204:207], v109 offset:32768
  ds_read_b128 v[208:211], v110 offset:32768
  ds_read_b128 v[212:215], v111 offset:32768
  s_waitcnt lgkmcnt(4)
  ds_read_b128 v[216:219], v104 offset:33024
  ds_read_b128 v[220:223], v105 offset:33024
  ds_read_b128 v[224:227], v106 offset:33024
  ds_read_b128 v[228:231], v107 offset:33024
  ds_read_b128 v[232:235], v108 offset:33024
  ds_read_b128 v[236:239], v109 offset:33024
  ds_read_b128 v[240:243], v110 offset:33024
  ds_read_b128 v[244:247], v111 offset:33024
  s_waitcnt lgkmcnt(4)
  s_waitcnt lgkmcnt(0)
  s_add_u32 s22, s27, 262144
  s_add_u32 m0, s25, 16384
  s_nop 0
  buffer_load_dwordx4 v4, s[56:59], s22 offen offset:0 lds
  buffer_load_dwordx4 v5, s[56:59], s22 offen offset:1024 lds
  buffer_load_dwordx4 v6, s[56:59], s22 offen offset:2048 lds
  buffer_load_dwordx4 v7, s[56:59], s22 offen offset:3072 lds
  s_add_u32 s22, s27, 524288
  s_add_u32 m0, s25, 32768
  s_nop 0
  buffer_load_dwordx4 v4, s[56:59], s22 offen offset:0 lds
  buffer_load_dwordx4 v5, s[56:59], s22 offen offset:1024 lds
  buffer_load_dwordx4 v6, s[56:59], s22 offen offset:2048 lds
  buffer_load_dwordx4 v7, s[56:59], s22 offen offset:3072 lds
  s_add_u32 s22, s27, 786432
  s_add_u32 m0, s25, 49152
  s_nop 0
  buffer_load_dwordx4 v4, s[56:59], s22 offen offset:0 lds
  buffer_load_dwordx4 v5, s[56:59], s22 offen offset:1024 lds
  buffer_load_dwordx4 v6, s[56:59], s22 offen offset:2048 lds
  buffer_load_dwordx4 v7, s[56:59], s22 offen offset:3072 lds
  s_cmp_lg_u32 s66, 0
  s_cbranch_scc1 sc_cf
  s_cmp_lg_u32 s16, 0
  s_cbranch_scc1 w0_3
  s_waitcnt vmcnt(12)
  v_readfirstlane_b32 s70, v250
  s_cmp_lg_u32 s70, 0
  s_cbranch_scc1 sc_nz
  v_mov_b32 v249, 128
  v_mov_b32 v250, s88
  v_mov_b32 v251, s89
  v_mov_b32 v252, 0
  v_mov_b32 v253, 0
  s_mov_b64 exec, 1
  buffer_atomic_cmpswap_x2 v[250:253], v249, s[12:15], 0 offen sc0
  s_mov_b64 exec, -1
  s_waitcnt vmcnt(0)
  v_readfirstlane_b32 s70, v250
  s_cmp_lg_u32 s70, 0
  s_cbranch_scc1 sc_nz
  v_mov_b32 v250, s88
  v_mov_b32 v251, s89
sc_nz:
w0_3:
  v_mov_b32 v249, 160000
  s_add_u32 s101, s101, 1
  s_barrier
  s_mov_b64 exec, 1
  s_cmp_lg_u32 s16, 0
  s_cbranch_scc1 w0_4
  ds_write_b32 v249, v248 offset:0
  ds_write_b32 v249, v250 offset:4
  ds_write_b32 v249, v251 offset:8
  s_waitcnt lgkmcnt(0)
  v_mov_b32 v248, s101
  ds_write_b32 v249, v248 offset:16
  s_waitcnt lgkmcnt(0)
w0_4:
  s_mov_b64 exec, -1
  s_barrier
  ds_read_b32 v248, v249 offset:0
  ds_read_b32 v250, v249 offset:4
  ds_read_b32 v251, v249 offset:8
  ds_read_b32 v249, v249 offset:16
  s_waitcnt lgkmcnt(0)
  v_readfirstlane_b32 s70, v248
  v_readfirstlane_b32 s88, v250
  v_readfirstlane_b32 s89, v251
  v_cmp_ne_u32 vcc, s101, v249
  s_cbranch_vccnz ch_end
  s_mov_b32 s66, 1
  s_bitcmp1_b32 s70, s3
  s_cbranch_scc1 m_reclaim
sc_cf:
  s_cmp_lg_u32 s16, 0
  s_cbranch_scc1 w0_5
  s_cmp_eq_u32 s67, 0
  s_cselect_b32 s20, 1, 0x10001
  v_mov_b32 v248, s20
  v_mov_b32 v249, 0
  s_mov_b64 exec, 1
  buffer_atomic_add v248, v249, s[12:15], 0 offen
  s_mov_b64 exec, -1
w0_5:
  s_lshl_b32 s28, s17, 7
  s_add_u32 s28, s28, 88623104
  v_min_u32 v113, 96, v2
  s_mov_b32 s29, 88590336
  v_add_u32 v112, 1024, v2
  v_min_u32 v112, 1776, v112
  s_mul_i32 s32, s17, 401408
  s_mul_i32 s33, s16, 14336
  s_add_u32 s32, s32, s33
  s_add_u32 s33, s32, s33
  s_add_u32 s32, s32, 344064
  s_add_u32 s33, s33, 229376
  s_waitcnt vmcnt(8)
  s_barrier
  ds_read_b128 v[16:19], v8 offset:0
  ds_read_b128 v[20:23], v9 offset:0
  ds_read_b128 v[24:27], v10 offset:0
  ds_read_b128 v[28:31], v11 offset:0
  s_waitcnt lgkmcnt(3)
  v_mfma_f32_32x32x16_bf16 v[32:47], v[16:19], v[120:123], 0
  s_add_u32 s22, s27, 1048576
  s_add_u32 m0, s25, 65536
  s_nop 0
  buffer_load_dwordx4 v4, s[56:59], s22 offen offset:0 lds
  v_mfma_f32_32x32x16_bf16 v[48:63], v[16:19], v[184:187], 0
  ds_read_b128 v[16:19], v12 offset:0
  s_waitcnt lgkmcnt(3)
  v_mfma_f32_32x32x16_bf16 v[32:47], v[20:23], v[124:127], v[32:47]
  buffer_load_dwordx4 v5, s[56:59], s22 offen offset:1024 lds
  v_mfma_f32_32x32x16_bf16 v[48:63], v[20:23], v[188:191], v[48:63]
  ds_read_b128 v[20:23], v13 offset:0
  s_waitcnt lgkmcnt(3)
  v_mfma_f32_32x32x16_bf16 v[32:47], v[24:27], v[128:131], v[32:47]
  buffer_load_dwordx4 v6, s[56:59], s22 offen offset:2048 lds
  v_mfma_f32_32x32x16_bf16 v[48:63], v[24:27], v[192:195], v[48:63]
  ds_read_b128 v[24:27], v14 offset:0
  s_waitcnt lgkmcnt(3)
  v_mfma_f32_32x32x16_bf16 v[32:47], v[28:31], v[132:135], v[32:47]
  buffer_load_dwordx4 v7, s[56:59], s22 offen offset:3072 lds
  v_mfma_f32_32x32x16_bf16 v[48:63], v[28:31], v[196:199], v[48:63]
  ds_read_b128 v[28:31], v15 offset:0
  s_waitcnt lgkmcnt(3)
  v_mfma_f32_32x32x16_bf16 v[32:47], v[16:19], v[136:139], v[32:47]
  s_add_u32 s22, s27, 1310720
  s_add_u32 m0, s25, 81920
  s_nop 0
  buffer_load_dwordx4 v4, s[56:59], s22 offen offset:0 lds
  v_mfma_f32_32x32x16_bf16 v[48:63], v[16:19], v[200:203], v[48:63]
  ds_read_b128 v[16:19], v8 offset:256
  s_waitcnt lgkmcnt(3)
  v_mfma_f32_32x32x16_bf16 v[32:47], v[20:23], v[140:143], v[32:47]
  buffer_load_dwordx4 v5, s[56:59], s22 offen offset:1024 lds
  v_mfma_f32_32x32x16_bf16 v[48:63], v[20:23], v[204:207], v[48:63]
  ds_read_b128 v[20:23], v9 offset:256
  s_waitcnt lgkmcnt(3)
  v_mfma_f32_32x32x16_bf16 v[32:47], v[24:27], v[144:147], v[32:47]
  buffer_load_dwordx4 v6, s[56:59], s22 offen offset:2048 lds
  v_mfma_f32_32x32x16_bf16 v[48:63], v[24:27], v[208:211], v[48:63]
  ds_read_b128 v[24:27], v10 offset:256
  s_waitcnt lgkmcnt(3)
  v_mfma_f32_32x32x16_bf16 v[32:47], v[28:31], v[148:151], v[32:47]
  buffer_load_dwordx4 v7, s[56:59], s22 offen offset:3072 lds
  v_mfma_f32_32x32x16_bf16 v[48:63], v[28:31], v[212:215], v[48:63]
  ds_read_b128 v[28:31], v11 offset:256
  s_waitcnt lgkmcnt(3)
  v_mfma_f32_32x32x16_bf16 v[32:47], v[16:19], v[152:155], v[32:47]
  s_add_u32 s22, s27, 1572864
  s_add_u32 m0, s25, 98304
  s_nop 0
  buffer_load_dwordx4 v4, s[56:59], s22 offen offset:0 lds
  v_mfma_f32_32x32x16_bf16 v[48:63], v[16:19], v[216:219], v[48:63]
  ds_read_b128 v[16:19], v12 offset:256
  s_waitcnt lgkmcnt(3)
  v_mfma_f32_32x32x16_bf16 v[32:47], v[20:23], v[156:159], v[32:47]
  buffer_load_dwordx4 v5, s[56:59], s22 offen offset:1024 lds
  v_mfma_f32_32x32x16_bf16 v[48:63], v[20:23], v[220:223], v[48:63]
  ds_read_b128 v[20:23], v13 offset:256
  s_waitcnt lgkmcnt(3)
  v_mfma_f32_32x32x16_bf16 v[32:47], v[24:27], v[160:163], v[32:47]
  buffer_load_dwordx4 v6, s[56:59], s22 offen offset:2048 lds
  v_mfma_f32_32x32x16_bf16 v[48:63], v[24:27], v[224:227], v[48:63]
  ds_read_b128 v[24:27], v14 offset:256
  s_waitcnt lgkmcnt(3)
  v_mfma_f32_32x32x16_bf16 v[32:47], v[28:31], v[164:167], v[32:47]
  buffer_load_dwordx4 v7, s[56:59], s22 offen offset:3072 lds
  v_mfma_f32_32x32x16_bf16 v[48:63], v[28:31], v[228:231], v[48:63]
  ds_read_b128 v[28:31], v15 offset:256
  s_waitcnt lgkmcnt(3)
  v_mfma_f32_32x32x16_bf16 v[32:47], v[16:19], v[168:171], v[32:47]
  s_add_u32 s22, s27, 1835008
  s_add_u32 m0, s25, 114688
  s_nop 0
  buffer_load_dwordx4 v4, s[56:59], s22 offen offset:0 lds
  v_mfma_f32_32x32x16_bf16 v[48:63], v[16:19], v[232:235], v[48:63]
  ds_read_b128 v[16:19], v8 offset:16384
  s_waitcnt lgkmcnt(3)
  v_mfma_f32_32x32x16_bf16 v[32:47], v[20:23], v[172:175], v[32:47]
  buffer_load_dwordx4 v5, s[56:59], s22 offen offset:1024 lds
  v_mfma_f32_32x32x16_bf16 v[48:63], v[20:23], v[236:239], v[48:63]
  ds_read_b128 v[20:23], v9 offset:16384
  s_waitcnt lgkmcnt(3)
  v_mfma_f32_32x32x16_bf16 v[32:47], v[24:27], v[176:179], v[32:47]
  buffer_load_dwordx4 v6, s[56:59], s22 offen offset:2048 lds
  v_mfma_f32_32x32x16_bf16 v[48:63], v[24:27], v[240:243], v[48:63]
  ds_read_b128 v[24:27], v10 offset:16384
  s_waitcnt lgkmcnt(3)
  v_mfma_f32_32x32x16_bf16 v[32:47], v[28:31], v[180:183], v[32:47]
  buffer_load_dwordx4 v7, s[56:59], s22 offen offset:3072 lds
  v_mfma_f32_32x32x16_bf16 v[48:63], v[28:31], v[244:247], v[48:63]
  s_waitcnt vmcnt(16)
  s_barrier
  ds_read_b128 v[28:31], v11 offset:16384
  s_waitcnt lgkmcnt(3)
  v_mfma_f32_32x32x16_bf16 v[64:79], v[16:19], v[120:123], 0
  s_add_u32 s22, s27, 2097152
  s_add_u32 m0, s25, 131072
  s_nop 0
  buffer_load_dwordx4 v4, s[56:59], s22 offen offset:0 lds
  v_mfma_f32_32x32x16_bf16 v[80:95], v[16:19], v[184:187], 0
  ds_read_b128 v[16:19], v12 offset:16384
  s_waitcnt lgkmcnt(3)
  v_mfma_f32_32x32x16_bf16 v[64:79], v[20:23], v[124:127], v[64:79]
  buffer_load_dwordx4 v5, s[56:59], s22 offen offset:1024 lds
  v_mul_f32 v32, s52, v32
  v_mul_f32 v33, s52, v33
  v_cvt_pk_bf16_f32 v32, v32, v33
  v_mfma_f32_32x32x16_bf16 v[80:95], v[20:23], v[188:191], v[80:95]
  v_mul_f32 v34, s52, v34
  v_mul_f32 v35, s52, v35
  ds_read_b128 v[20:23], v13 offset:16384
  s_waitcnt lgkmcnt(3)
  v_mfma_f32_32x32x16_bf16 v[64:79], v[24:27], v[128:131], v[64:79]
  buffer_load_dwordx4 v6, s[56:59], s22 offen offset:2048 lds
  v_cvt_pk_bf16_f32 v33, v34, v35
  v_mul_f32 v36, s52, v36
  v_mul_f32 v37, s52, v37
  v_mfma_f32_32x32x16_bf16 v[80:95], v[24:27], v[192:195], v[80:95]
  v_cvt_pk_bf16_f32 v34, v36, v37
  v_mul_f32 v38, s52, v38
  ds_read_b128 v[24:27], v14 offset:16384
  s_waitcnt lgkmcnt(3)
  v_mfma_f32_32x32x16_bf16 v[64:79], v[28:31], v[132:135], v[64:79]
  buffer_load_dwordx4 v7, s[56:59], s22 offen offset:3072 lds
  v_mul_f32 v39, s52, v39
  v_cvt_pk_bf16_f32 v35, v38, v39
  v_mul_f32 v40, s52, v40
  v_mfma_f32_32x32x16_bf16 v[80:95], v[28:31], v[196:199], v[80:95]
  v_mul_f32 v41, s52, v41
  v_cvt_pk_bf16_f32 v40, v40, v41
  ds_read_b128 v[28:31], v15 offset:16384
  s_waitcnt lgkmcnt(3)
  v_mfma_f32_32x32x16_bf16 v[64:79], v[16:19], v[136:139], v[64:79]
  s_add_u32 s22, s27, 2359296
  s_add_u32 m0, s25, 0
  s_nop 0
  buffer_load_dwordx4 v4, s[56:59], s22 offen offset:0 lds
  v_mul_f32 v42, s52, v42
  v_mul_f32 v43, s52, v43
  v_cvt_pk_bf16_f32 v41, v42, v43
  v_mfma_f32_32x32x16_bf16 v[80:95], v[16:19], v[200:203], v[80:95]
  v_mul_f32 v44, s52, v44
  v_mul_f32 v45, s52, v45
  ds_read_b128 v[16:19], v8 offset:16640
  s_waitcnt lgkmcnt(3)
  v_mfma_f32_32x32x16_bf16 v[64:79], v[20:23], v[140:143], v[64:79]
  buffer_load_dwordx4 v5, s[56:59], s22 offen offset:1024 lds
  v_cvt_pk_bf16_f32 v42, v44, v45
  v_mul_f32 v46, s52, v46
  v_mul_f32 v47, s52, v47
  v_mfma_f32_32x32x16_bf16 v[80:95], v[20:23], v[204:207], v[80:95]
  v_cvt_pk_bf16_f32 v43, v46, v47
  v_permlane16_swap_b32 v32, v40
  ds_read_b128 v[20:23], v9 offset:16640
  s_waitcnt lgkmcnt(3)
  v_mfma_f32_32x32x16_bf16 v[64:79], v[24:27], v[144:147], v[64:79]
  buffer_load_dwordx4 v6, s[56:59], s22 offen offset:2048 lds
  v_permlane16_swap_b32 v33, v41
  v_permlane16_swap_b32 v34, v42
  v_permlane16_swap_b32 v35, v43
  v_mfma_f32_32x32x16_bf16 v[80:95], v[24:27], v[208:211], v[80:95]
  v_accvgpr_write_b32 a0, v32
  v_accvgpr_write_b32 a1, v33
  ds_read_b128 v[24:27], v10 offset:16640
  s_waitcnt lgkmcnt(3)
  v_mfma_f32_32x32x16_bf16 v[64:79], v[28:31], v[148:151], v[64:79]
  buffer_load_dwordx4 v7, s[56:59], s22 offen offset:3072 lds
  v_accvgpr_write_b32 a2, v34
  v_accvgpr_write_b32 a3, v35
  v_accvgpr_write_b32 a56, v40
  v_mfma_f32_32x32x16_bf16 v[80:95], v[28:31], v[212:215], v[80:95]
  v_accvgpr_write_b32 a57, v41
  v_accvgpr_write_b32 a58, v42
  ds_read_b128 v[28:31], v11 offset:16640
  s_waitcnt lgkmcnt(3)
  v_mfma_f32_32x32x16_bf16 v[64:79], v[16:19], v[152:155], v[64:79]
  v_accvgpr_write_b32 a59, v43
  v_mul_f32 v48, s52, v48
  v_mul_f32 v49, s52, v49
  v_mfma_f32_32x32x16_bf16 v[80:95], v[16:19], v[216:219], v[80:95]
  v_cvt_pk_bf16_f32 v48, v48, v49
  v_mul_f32 v50, s52, v50
  ds_read_b128 v[16:19], v12 offset:16640
  s_waitcnt lgkmcnt(3)
  v_mfma_f32_32x32x16_bf16 v[64:79], v[20:23], v[156:159], v[64:79]
  v_mul_f32 v51, s52, v51
  v_cvt_pk_bf16_f32 v49, v50, v51
  v_mul_f32 v52, s52, v52
  v_mfma_f32_32x32x16_bf16 v[80:95], v[20:23], v[220:223], v[80:95]
  v_mul_f32 v53, s52, v53
  v_cvt_pk_bf16_f32 v50, v52, v53
  ds_read_b128 v[20:23], v13 offset:16640
  s_waitcnt lgkmcnt(3)
  v_mfma_f32_32x32x16_bf16 v[64:79], v[24:27], v[160:163], v[64:79]
  v_mul_f32 v54, s52, v54
  v_mul_f32 v55, s52, v55
  v_cvt_pk_bf16_f32 v51, v54, v55
  v_mfma_f32_32x32x16_bf16 v[80:95], v[24:27], v[224:227], v[80:95]
  v_mul_f32 v56, s52, v56
  v_mul_f32 v57, s52, v57
  ds_read_b128 v[24:27], v14 offset:16640
  s_waitcnt lgkmcnt(3)
  v_mfma_f32_32x32x16_bf16 v[64:79], v[28:31], v[164:167], v[64:79]
  v_cvt_pk_bf16_f32 v56, v56, v57
  v_mul_f32 v58, s52, v58
  v_mul_f32 v59, s52, v59
  v_mfma_f32_32x32x16_bf16 v[80:95], v[28:31], v[228:231], v[80:95]
  v_cvt_pk_bf16_f32 v57, v58, v59
  v_mul_f32 v60, s52, v60
  ds_read_b128 v[28:31], v15 offset:16640
  s_waitcnt lgkmcnt(3)
  v_mfma_f32_32x32x16_bf16 v[64:79], v[16:19], v[168:171], v[64:79]
  v_mul_f32 v61, s52, v61
  v_cvt_pk_bf16_f32 v58, v60, v61
  v_mul_f32 v62, s52, v62
  v_mfma_f32_32x32x16_bf16 v[80:95], v[16:19], v[232:235], v[80:95]
  v_mul_f32 v63, s52, v63
  v_cvt_pk_bf16_f32 v59, v62, v63
  ds_read_b128 v[16:19], v8 offset:32768
  s_waitcnt lgkmcnt(3)
  v_mfma_f32_32x32x16_bf16 v[64:79], v[20:23], v[172:175], v[64:79]
  v_permlane16_swap_b32 v48, v56
  v_permlane16_swap_b32 v49, v57
  v_permlane16_swap_b32 v50, v58
  v_mfma_f32_32x32x16_bf16 v[80:95], v[20:23], v[236:239], v[80:95]
  v_permlane16_swap_b32 v51, v59
  v_accvgpr_write_b32 a112, v48
  ds_read_b128 v[20:23], v9 offset:32768
  s_waitcnt lgkmcnt(3)
  v_mfma_f32_32x32x16_bf16 v[64:79], v[24:27], v[176:179], v[64:79]
  v_accvgpr_write_b32 a113, v49
  v_accvgpr_write_b32 a114, v50
  v_accvgpr_write_b32 a115, v51
  v_mfma_f32_32x32x16_bf16 v[80:95], v[24:27], v[240:243], v[80:95]
  v_accvgpr_write_b32 a168, v56
  v_accvgpr_write_b32 a169, v57
  ds_read_b128 v[24:27], v10 offset:32768
  s_waitcnt lgkmcnt(3)
  v_mfma_f32_32x32x16_bf16 v[64:79], v[28:31], v[180:183], v[64:79]
  v_accvgpr_write_b32 a170, v58
  v_accvgpr_write_b32 a171, v59
  v_mfma_f32_32x32x16_bf16 v[80:95], v[28:31], v[244:247], v[80:95]
  ds_read_b128 v[28:31], v11 offset:32768
  s_waitcnt lgkmcnt(3)
  v_mfma_f32_32x32x16_bf16 v[32:47], v[16:19], v[120:123], 0
  v_mfma_f32_32x32x16_bf16 v[48:63], v[16:19], v[184:187], 0
  ds_read_b128 v[16:19], v12 offset:32768
  s_waitcnt lgkmcnt(3)
  v_mfma_f32_32x32x16_bf16 v[32:47], v[20:23], v[124:127], v[32:47]
  v_mul_f32 v64, s52, v64
  v_mul_f32 v65, s52, v65
  v_cvt_pk_bf16_f32 v64, v64, v65
  v_mfma_f32_32x32x16_bf16 v[48:63], v[20:23], v[188:191], v[48:63]
  v_mul_f32 v66, s52, v66
  v_mul_f32 v67, s52, v67
  ds_read_b128 v[20:23], v13 offset:32768
  s_waitcnt lgkmcnt(3)
  v_mfma_f32_32x32x16_bf16 v[32:47], v[24:27], v[128:131], v[32:47]
  v_cvt_pk_bf16_f32 v65, v66, v67
  v_mul_f32 v68, s52, v68
  v_mul_f32 v69, s52, v69
  v_mfma_f32_32x32x16_bf16 v[48:63], v[24:27], v[192:195], v[48:63]
  v_cvt_pk_bf16_f32 v66, v68, v69
  v_mul_f32 v70, s52, v70
  ds_read_b128 v[24:27], v14 offset:32768
  s_waitcnt lgkmcnt(3)
  v_mfma_f32_32x32x16_bf16 v[32:47], v[28:31], v[132:135], v[32:47]
  v_mul_f32 v71, s52, v71
  v_cvt_pk_bf16_f32 v67, v70, v71
  v_mul_f32 v72, s52, v72
  v_mfma_f32_32x32x16_bf16 v[48:63], v[28:31], v[196:199], v[48:63]
  v_mul_f32 v73, s52, v73
  v_cvt_pk_bf16_f32 v72, v72, v73
  ds_read_b128 v[28:31], v15 offset:32768
  s_waitcnt lgkmcnt(3)
  v_mfma_f32_32x32x16_bf16 v[32:47], v[16:19], v[136:139], v[32:47]
  v_mul_f32 v74, s52, v74
  v_mul_f32 v75, s52, v75
  v_cvt_pk_bf16_f32 v73, v74, v75
  v_mfma_f32_32x32x16_bf16 v[48:63], v[16:19], v[200:203], v[48:63]
  v_mul_f32 v76, s52, v76
  v_mul_f32 v77, s52, v77
  ds_read_b128 v[16:19], v8 offset:33024
  s_waitcnt lgkmcnt(3)
  v_mfma_f32_32x32x16_bf16 v[32:47], v[20:23], v[140:143], v[32:47]
  v_cvt_pk_bf16_f32 v74, v76, v77
  v_mul_f32 v78, s52, v78
  v_mul_f32 v79, s52, v79
  v_mfma_f32_32x32x16_bf16 v[48:63], v[20:23], v[204:207], v[48:63]
  v_cvt_pk_bf16_f32 v75, v78, v79
  v_permlane16_swap_b32 v64, v72
  ds_read_b128 v[20:23], v9 offset:33024
  s_waitcnt lgkmcnt(3)
  v_mfma_f32_32x32x16_bf16 v[32:47], v[24:27], v[144:147], v[32:47]
  v_permlane16_swap_b32 v65, v73
  v_permlane16_swap_b32 v66, v74
  v_permlane16_swap_b32 v67, v75
  v_mfma_f32_32x32x16_bf16 v[48:63], v[24:27], v[208:211], v[48:63]
  v_accvgpr_write_b32 a4, v64
  v_accvgpr_write_b32 a5, v65
  ds_read_b128 v[24:27], v10 offset:33024
  s_waitcnt lgkmcnt(3)
  v_mfma_f32_32x32x16_bf16 v[32:47], v[28:31], v[148:151], v[32:47]
  v_accvgpr_write_b32 a6, v66
  v_accvgpr_write_b32 a7, v67
  v_accvgpr_write_b32 a60, v72
  v_mfma_f32_32x32x16_bf16 v[48:63], v[28:31], v[212:215], v[48:63]
  v_accvgpr_write_b32 a61, v73
  v_accvgpr_write_b32 a62, v74
  ds_read_b128 v[28:31], v11 offset:33024
  s_waitcnt lgkmcnt(3)
  v_mfma_f32_32x32x16_bf16 v[32:47], v[16:19], v[152:155], v[32:47]
  v_accvgpr_write_b32 a63, v75
  v_mul_f32 v80, s52, v80
  v_mul_f32 v81, s52, v81
  v_mfma_f32_32x32x16_bf16 v[48:63], v[16:19], v[216:219], v[48:63]
  v_cvt_pk_bf16_f32 v80, v80, v81
  v_mul_f32 v82, s52, v82
  ds_read_b128 v[16:19], v12 offset:33024
  s_waitcnt lgkmcnt(3)
  v_mfma_f32_32x32x16_bf16 v[32:47], v[20:23], v[156:159], v[32:47]
  v_mul_f32 v83, s52, v83
  v_cvt_pk_bf16_f32 v81, v82, v83
  v_mul_f32 v84, s52, v84
  v_mfma_f32_32x32x16_bf16 v[48:63], v[20:23], v[220:223], v[48:63]
  v_mul_f32 v85, s52, v85
  v_cvt_pk_bf16_f32 v82, v84, v85
  ds_read_b128 v[20:23], v13 offset:33024
  s_waitcnt lgkmcnt(3)
  v_mfma_f32_32x32x16_bf16 v[32:47], v[24:27], v[160:163], v[32:47]
  v_mul_f32 v86, s52, v86
  v_mul_f32 v87, s52, v87
  v_cvt_pk_bf16_f32 v83, v86, v87
  v_mfma_f32_32x32x16_bf16 v[48:63], v[24:27], v[224:227], v[48:63]
  v_mul_f32 v88, s52, v88
  v_mul_f32 v89, s52, v89
  ds_read_b128 v[24:27], v14 offset:33024
  s_waitcnt lgkmcnt(3)
  v_mfma_f32_32x32x16_bf16 v[32:47], v[28:31], v[164:167], v[32:47]
  v_cvt_pk_bf16_f32 v88, v88, v89
  v_mul_f32 v90, s52, v90
  v_mul_f32 v91, s52, v91
  v_mfma_f32_32x32x16_bf16 v[48:63], v[28:31], v[228:231], v[48:63]
  v_cvt_pk_bf16_f32 v89, v90, v91
  v_mul_f32 v92, s52, v92
  ds_read_b128 v[28:31], v15 offset:33024
  s_waitcnt lgkmcnt(3)
  v_mfma_f32_32x32x16_bf16 v[32:47], v[16:19], v[168:171], v[32:47]
  v_mul_f32 v93, s52, v93
  v_cvt_pk_bf16_f32 v90, v92, v93
  v_mul_f32 v94, s52, v94
  v_mfma_f32_32x32x16_bf16 v[48:63], v[16:19], v[232:235], v[48:63]
  v_mul_f32 v95, s52, v95
  v_cvt_pk_bf16_f32 v91, v94, v95
  ds_read_b128 v[16:19], v8 offset:49152
  s_waitcnt lgkmcnt(3)
  v_mfma_f32_32x32x16_bf16 v[32:47], v[20:23], v[172:175], v[32:47]
  v_permlane16_swap_b32 v80, v88
  v_permlane16_swap_b32 v81, v89
  v_permlane16_swap_b32 v82, v90
  v_mfma_f32_32x32x16_bf16 v[48:63], v[20:23], v[236:239], v[48:63]
  v_permlane16_swap_b32 v83, v91
  v_accvgpr_write_b32 a116, v80
  ds_read_b128 v[20:23], v9 offset:49152
  s_waitcnt lgkmcnt(3)
  v_mfma_f32_32x32x16_bf16 v[32:47], v[24:27], v[176:179], v[32:47]
  v_accvgpr_write_b32 a117, v81
  v_accvgpr_write_b32 a118, v82
  v_accvgpr_write_b32 a119, v83
  v_mfma_f32_32x32x16_bf16 v[48:63], v[24:27], v[240:243], v[48:63]
  v_accvgpr_write_b32 a172, v88
  v_accvgpr_write_b32 a173, v89
  ds_read_b128 v[24:27], v10 offset:49152
  s_waitcnt lgkmcnt(3)
  v_mfma_f32_32x32x16_bf16 v[32:47], v[28:31], v[180:183], v[32:47]
  v_accvgpr_write_b32 a174, v90
  v_accvgpr_write_b32 a175, v91
  v_mfma_f32_32x32x16_bf16 v[48:63], v[28:31], v[244:247], v[48:63]
  s_waitcnt vmcnt(16)
  s_barrier
  ds_read_b128 v[28:31], v11 offset:49152
  s_waitcnt lgkmcnt(3)
  v_mfma_f32_32x32x16_bf16 v[64:79], v[16:19], v[120:123], 0
  s_add_u32 s22, s27, 2621440
  s_add_u32 m0, s25, 16384
  s_nop 0
  buffer_load_dwordx4 v4, s[56:59], s22 offen offset:0 lds
  v_mfma_f32_32x32x16_bf16 v[80:95], v[16:19], v[184:187], 0
  ds_read_b128 v[16:19], v12 offset:49152
  s_waitcnt lgkmcnt(3)
  v_mfma_f32_32x32x16_bf16 v[64:79], v[20:23], v[124:127], v[64:79]
  buffer_load_dwordx4 v5, s[56:59], s22 offen offset:1024 lds
  v_mul_f32 v32, s52, v32
  v_mul_f32 v33, s52, v33
  v_cvt_pk_bf16_f32 v32, v32, v33
  v_mfma_f32_32x32x16_bf16 v[80:95], v[20:23], v[188:191], v[80:95]
  v_mul_f32 v34, s52, v34
  v_mul_f32 v35, s52, v35
  ds_read_b128 v[20:23], v13 offset:49152
  s_waitcnt lgkmcnt(3)
  v_mfma_f32_32x32x16_bf16 v[64:79], v[24:27], v[128:131], v[64:79]
  buffer_load_dwordx4 v6, s[56:59], s22 offen offset:2048 lds
  v_cvt_pk_bf16_f32 v33, v34, v35
  v_mul_f32 v36, s52, v36
  v_mul_f32 v37, s52, v37
  v_mfma_f32_32x32x16_bf16 v[80:95], v[24:27], v[192:195], v[80:95]
  v_cvt_pk_bf16_f32 v34, v36, v37
  v_mul_f32 v38, s52, v38
  ds_read_b128 v[24:27], v14 offset:49152
  s_waitcnt lgkmcnt(3)
  v_mfma_f32_32x32x16_bf16 v[64:79], v[28:31], v[132:135], v[64:79]
  buffer_load_dwordx4 v7, s[56:59], s22 offen offset:3072 lds
  v_mul_f32 v39, s52, v39
  v_cvt_pk_bf16_f32 v35, v38, v39
  v_mul_f32 v40, s52, v40
  v_mfma_f32_32x32x16_bf16 v[80:95], v[28:31], v[196:199], v[80:95]
  v_mul_f32 v41, s52, v41
  v_cvt_pk_bf16_f32 v40, v40, v41
  ds_read_b128 v[28:31], v15 offset:49152
  s_waitcnt lgkmcnt(3)
  v_mfma_f32_32x32x16_bf16 v[64:79], v[16:19], v[136:139], v[64:79]
  s_add_u32 s22, s27, 2883584
  s_add_u32 m0, s25, 32768
  s_nop 0
  buffer_load_dwordx4 v4, s[56:59], s22 offen offset:0 lds
  v_mul_f32 v42, s52, v42
  v_mul_f32 v43, s52, v43
  v_cvt_pk_bf16_f32 v41, v42, v43
  v_mfma_f32_32x32x16_bf16 v[80:95], v[16:19], v[200:203], v[80:95]
  v_mul_f32 v44, s52, v44
  v_mul_f32 v45, s52, v45
  ds_read_b128 v[16:19], v8 offset:49408
  s_waitcnt lgkmcnt(3)
  v_mfma_f32_32x32x16_bf16 v[64:79], v[20:23], v[140:143], v[64:79]
  buffer_load_dwordx4 v5, s[56:59], s22 offen offset:1024 lds
  v_cvt_pk_bf16_f32 v42, v44, v45
  v_mul_f32 v46, s52, v46
  v_mul_f32 v47, s52, v47
  v_mfma_f32_32x32x16_bf16 v[80:95], v[20:23], v[204:207], v[80:95]
  v_cvt_pk_bf16_f32 v43, v46, v47
  v_permlane16_swap_b32 v32, v40
  ds_read_b128 v[20:23], v9 offset:49408
  s_waitcnt lgkmcnt(3)
  v_mfma_f32_32x32x16_bf16 v[64:79], v[24:27], v[144:147], v[64:79]
  buffer_load_dwordx4 v6, s[56:59], s22 offen offset:2048 lds
  v_permlane16_swap_b32 v33, v41
  v_permlane16_swap_b32 v34, v42
  v_permlane16_swap_b32 v35, v43
  v_mfma_f32_32x32x16_bf16 v[80:95], v[24:27], v[208:211], v[80:95]
  v_accvgpr_write_b32 a8, v32
  v_accvgpr_write_b32 a9, v33
  ds_read_b128 v[24:27], v10 offset:49408
  s_waitcnt lgkmcnt(3)
  v_mfma_f32_32x32x16_bf16 v[64:79], v[28:31], v[148:151], v[64:79]
  buffer_load_dwordx4 v7, s[56:59], s22 offen offset:3072 lds
  v_accvgpr_write_b32 a10, v34
  v_accvgpr_write_b32 a11, v35
  v_accvgpr_write_b32 a64, v40
  v_mfma_f32_32x32x16_bf16 v[80:95], v[28:31], v[212:215], v[80:95]
  v_accvgpr_write_b32 a65, v41
  v_accvgpr_write_b32 a66, v42
  ds_read_b128 v[28:31], v11 offset:49408
  s_waitcnt lgkmcnt(3)
  v_mfma_f32_32x32x16_bf16 v[64:79], v[16:19], v[152:155], v[64:79]
  v_accvgpr_write_b32 a67, v43
  v_mul_f32 v48, s52, v48
  v_mul_f32 v49, s52, v49
  v_mfma_f32_32x32x16_bf16 v[80:95], v[16:19], v[216:219], v[80:95]
  v_cvt_pk_bf16_f32 v48, v48, v49
  v_mul_f32 v50, s52, v50
  ds_read_b128 v[16:19], v12 offset:49408
  s_waitcnt lgkmcnt(3)
  v_mfma_f32_32x32x16_bf16 v[64:79], v[20:23], v[156:159], v[64:79]
  v_mul_f32 v51, s52, v51
  v_cvt_pk_bf16_f32 v49, v50, v51
  v_mul_f32 v52, s52, v52
  v_mfma_f32_32x32x16_bf16 v[80:95], v[20:23], v[220:223], v[80:95]
  v_mul_f32 v53, s52, v53
  v_cvt_pk_bf16_f32 v50, v52, v53
  ds_read_b128 v[20:23], v13 offset:49408
  s_waitcnt lgkmcnt(3)
  v_mfma_f32_32x32x16_bf16 v[64:79], v[24:27], v[160:163], v[64:79]
  v_mul_f32 v54, s52, v54
  v_mul_f32 v55, s52, v55
  v_cvt_pk_bf16_f32 v51, v54, v55
  v_mfma_f32_32x32x16_bf16 v[80:95], v[24:27], v[224:227], v[80:95]
  v_mul_f32 v56, s52, v56
  v_mul_f32 v57, s52, v57
  ds_read_b128 v[24:27], v14 offset:49408
  s_waitcnt lgkmcnt(3)
  v_mfma_f32_32x32x16_bf16 v[64:79], v[28:31], v[164:167], v[64:79]
  v_cvt_pk_bf16_f32 v56, v56, v57
  v_mul_f32 v58, s52, v58
  v_mul_f32 v59, s52, v59
  v_mfma_f32_32x32x16_bf16 v[80:95], v[28:31], v[228:231], v[80:95]
  v_cvt_pk_bf16_f32 v57, v58, v59
  v_mul_f32 v60, s52, v60
  ds_read_b128 v[28:31], v15 offset:49408
  s_waitcnt lgkmcnt(3)
  v_mfma_f32_32x32x16_bf16 v[64:79], v[16:19], v[168:171], v[64:79]
  v_mul_f32 v61, s52, v61
  v_cvt_pk_bf16_f32 v58, v60, v61
  v_mul_f32 v62, s52, v62
  v_mfma_f32_32x32x16_bf16 v[80:95], v[16:19], v[232:235], v[80:95]
  v_mul_f32 v63, s52, v63
  v_cvt_pk_bf16_f32 v59, v62, v63
  v_xor_b32 v8, 65536, v8
  ds_read_b128 v[16:19], v8 offset:0
  s_waitcnt lgkmcnt(3)
  v_mfma_f32_32x32x16_bf16 v[64:79], v[20:23], v[172:175], v[64:79]
  v_permlane16_swap_b32 v48, v56
  v_permlane16_swap_b32 v49, v57
  v_permlane16_swap_b32 v50, v58
  v_mfma_f32_32x32x16_bf16 v[80:95], v[20:23], v[236:239], v[80:95]
  v_permlane16_swap_b32 v51, v59
  v_accvgpr_write_b32 a120, v48
  v_xor_b32 v9, 65536, v9
  ds_read_b128 v[20:23], v9 offset:0
  s_waitcnt lgkmcnt(3)
  v_mfma_f32_32x32x16_bf16 v[64:79], v[24:27], v[176:179], v[64:79]
  v_accvgpr_write_b32 a121, v49
  v_accvgpr_write_b32 a122, v50
  v_accvgpr_write_b32 a123, v51
  v_mfma_f32_32x32x16_bf16 v[80:95], v[24:27], v[240:243], v[80:95]
  v_accvgpr_write_b32 a176, v56
  v_accvgpr_write_b32 a177, v57
  v_xor_b32 v10, 65536, v10
  ds_read_b128 v[24:27], v10 offset:0
  s_waitcnt lgkmcnt(3)
  v_mfma_f32_32x32x16_bf16 v[64:79], v[28:31], v[180:183], v[64:79]
  v_accvgpr_write_b32 a178, v58
  v_accvgpr_write_b32 a179, v59
  v_mfma_f32_32x32x16_bf16 v[80:95], v[28:31], v[244:247], v[80:95]
  v_xor_b32 v11, 65536, v11
  ds_read_b128 v[28:31], v11 offset:0
  s_waitcnt lgkmcnt(3)
  v_mfma_f32_32x32x16_bf16 v[32:47], v[16:19], v[120:123], 0
  v_mfma_f32_32x32x16_bf16 v[48:63], v[16:19], v[184:187], 0
  v_xor_b32 v12, 65536, v12
  ds_read_b128 v[16:19], v12 offset:0
  s_waitcnt lgkmcnt(3)
  v_mfma_f32_32x32x16_bf16 v[32:47], v[20:23], v[124:127], v[32:47]
  v_mul_f32 v64, s52, v64
  v_mul_f32 v65, s52, v65
  v_cvt_pk_bf16_f32 v64, v64, v65
  v_mfma_f32_32x32x16_bf16 v[48:63], v[20:23], v[188:191], v[48:63]
  v_mul_f32 v66, s52, v66
  v_mul_f32 v67, s52, v67
  v_xor_b32 v13, 65536, v13
  ds_read_b128 v[20:23], v13 offset:0
  s_waitcnt lgkmcnt(3)
  v_mfma_f32_32x32x16_bf16 v[32:47], v[24:27], v[128:131], v[32:47]
  v_cvt_pk_bf16_f32 v65, v66, v67
  v_mul_f32 v68, s52, v68
  v_mul_f32 v69, s52, v69
  v_mfma_f32_32x32x16_bf16 v[48:63], v[24:27], v[192:195], v[48:63]
  v_cvt_pk_bf16_f32 v66, v68, v69
  v_mul_f32 v70, s52, v70
  v_xor_b32 v14, 65536, v14
  ds_read_b128 v[24:27], v14 offset:0
  s_waitcnt lgkmcnt(3)
  v_mfma_f32_32x32x16_bf16 v[32:47], v[28:31], v[132:135], v[32:47]
  v_mul_f32 v71, s52, v71
  v_cvt_pk_bf16_f32 v67, v70, v71
  v_mul_f32 v72, s52, v72
  v_mfma_f32_32x32x16_bf16 v[48:63], v[28:31], v[196:199], v[48:63]
  v_mul_f32 v73, s52, v73
  v_cvt_pk_bf16_f32 v72, v72, v73
  v_xor_b32 v15, 65536, v15
  ds_read_b128 v[28:31], v15 offset:0
  s_waitcnt lgkmcnt(3)
  v_mfma_f32_32x32x16_bf16 v[32:47], v[16:19], v[136:139], v[32:47]
  v_mul_f32 v74, s52, v74
  v_mul_f32 v75, s52, v75
  v_cvt_pk_bf16_f32 v73, v74, v75
  v_mfma_f32_32x32x16_bf16 v[48:63], v[16:19], v[200:203], v[48:63]
  v_mul_f32 v76, s52, v76
  v_mul_f32 v77, s52, v77
  ds_read_b128 v[16:19], v8 offset:256
  s_waitcnt lgkmcnt(3)
  v_mfma_f32_32x32x16_bf16 v[32:47], v[20:23], v[140:143], v[32:47]
  v_cvt_pk_bf16_f32 v74, v76, v77
  v_mul_f32 v78, s52, v78
  v_mul_f32 v79, s52, v79
  v_mfma_f32_32x32x16_bf16 v[48:63], v[20:23], v[204:207], v[48:63]
  v_cvt_pk_bf16_f32 v75, v78, v79
  v_permlane16_swap_b32 v64, v72
  ds_read_b128 v[20:23], v9 offset:256
  s_waitcnt lgkmcnt(3)
  v_mfma_f32_32x32x16_bf16 v[32:47], v[24:27], v[144:147], v[32:47]
  v_permlane16_swap_b32 v65, v73
  v_permlane16_swap_b32 v66, v74
  v_permlane16_swap_b32 v67, v75
  v_mfma_f32_32x32x16_bf16 v[48:63], v[24:27], v[208:211], v[48:63]
  v_accvgpr_write_b32 a12, v64
  v_accvgpr_write_b32 a13, v65
  ds_read_b128 v[24:27], v10 offset:256
  s_waitcnt lgkmcnt(3)
  v_mfma_f32_32x32x16_bf16 v[32:47], v[28:31], v[148:151], v[32:47]
  v_accvgpr_write_b32 a14, v66
  v_accvgpr_write_b32 a15, v67
  v_accvgpr_write_b32 a68, v72
  v_mfma_f32_32x32x16_bf16 v[48:63], v[28:31], v[212:215], v[48:63]
  v_accvgpr_write_b32 a69, v73
  v_accvgpr_write_b32 a70, v74
  ds_read_b128 v[28:31], v11 offset:256
  s_waitcnt lgkmcnt(3)
  v_mfma_f32_32x32x16_bf16 v[32:47], v[16:19], v[152:155], v[32:47]
  v_accvgpr_write_b32 a71, v75
  v_mul_f32 v80, s52, v80
  v_mul_f32 v81, s52, v81
  v_mfma_f32_32x32x16_bf16 v[48:63], v[16:19], v[216:219], v[48:63]
  v_cvt_pk_bf16_f32 v80, v80, v81
  v_mul_f32 v82, s52, v82
  ds_read_b128 v[16:19], v12 offset:256
  s_waitcnt lgkmcnt(3)
  v_mfma_f32_32x32x16_bf16 v[32:47], v[20:23], v[156:159], v[32:47]
  v_mul_f32 v83, s52, v83
  v_cvt_pk_bf16_f32 v81, v82, v83
  v_mul_f32 v84, s52, v84
  v_mfma_f32_32x32x16_bf16 v[48:63], v[20:23], v[220:223], v[48:63]
  v_mul_f32 v85, s52, v85
  v_cvt_pk_bf16_f32 v82, v84, v85
  ds_read_b128 v[20:23], v13 offset:256
  s_waitcnt lgkmcnt(3)
  v_mfma_f32_32x32x16_bf16 v[32:47], v[24:27], v[160:163], v[32:47]
  v_mul_f32 v86, s52, v86
  v_mul_f32 v87, s52, v87
  v_cvt_pk_bf16_f32 v83, v86, v87
  v_mfma_f32_32x32x16_bf16 v[48:63], v[24:27], v[224:227], v[48:63]
  v_mul_f32 v88, s52, v88
  v_mul_f32 v89, s52, v89
  ds_read_b128 v[24:27], v14 offset:256
  s_waitcnt lgkmcnt(3)
  v_mfma_f32_32x32x16_bf16 v[32:47], v[28:31], v[164:167], v[32:47]
  v_cvt_pk_bf16_f32 v88, v88, v89
  v_mul_f32 v90, s52, v90
  v_mul_f32 v91, s52, v91
  v_mfma_f32_32x32x16_bf16 v[48:63], v[28:31], v[228:231], v[48:63]
  v_cvt_pk_bf16_f32 v89, v90, v91
  v_mul_f32 v92, s52, v92
  ds_read_b128 v[28:31], v15 offset:256
  s_waitcnt lgkmcnt(3)
  v_mfma_f32_32x32x16_bf16 v[32:47], v[16:19], v[168:171], v[32:47]
  v_mul_f32 v93, s52, v93
  v_cvt_pk_bf16_f32 v90, v92, v93
  v_mul_f32 v94, s52, v94
  v_mfma_f32_32x32x16_bf16 v[48:63], v[16:19], v[232:235], v[48:63]
  v_mul_f32 v95, s52, v95
  v_cvt_pk_bf16_f32 v91, v94, v95
  ds_read_b128 v[16:19], v8 offset:16384
  s_waitcnt lgkmcnt(3)
  v_mfma_f32_32x32x16_bf16 v[32:47], v[20:23], v[172:175], v[32:47]
  v_permlane16_swap_b32 v80, v88
  v_permlane16_swap_b32 v81, v89
  v_permlane16_swap_b32 v82, v90
  v_mfma_f32_32x32x16_bf16 v[48:63], v[20:23], v[236:239], v[48:63]
  v_permlane16_swap_b32 v83, v91
  v_accvgpr_write_b32 a124, v80
  ds_read_b128 v[20:23], v9 offset:16384
  s_waitcnt lgkmcnt(3)
  v_mfma_f32_32x32x16_bf16 v[32:47], v[24:27], v[176:179], v[32:47]
  v_accvgpr_write_b32 a125, v81
  v_accvgpr_write_b32 a126, v82
  v_accvgpr_write_b32 a127, v83
  v_mfma_f32_32x32x16_bf16 v[48:63], v[24:27], v[240:243], v[48:63]
  v_accvgpr_write_b32 a180, v88
  v_accvgpr_write_b32 a181, v89
  ds_read_b128 v[24:27], v10 offset:16384
  s_waitcnt lgkmcnt(3)
  v_mfma_f32_32x32x16_bf16 v[32:47], v[28:31], v[180:183], v[32:47]
  v_accvgpr_write_b32 a182, v90
  v_accvgpr_write_b32 a183, v91
  v_mfma_f32_32x32x16_bf16 v[48:63], v[28:31], v[244:247], v[48:63]
  s_waitcnt vmcnt(16)
  s_barrier
  ds_read_b128 v[28:31], v11 offset:16384
  s_waitcnt lgkmcnt(3)
  v_mfma_f32_32x32x16_bf16 v[64:79], v[16:19], v[120:123], 0
  s_add_u32 s22, s27, 3145728
  s_add_u32 m0, s25, 49152
  s_nop 0
  buffer_load_dwordx4 v4, s[56:59], s22 offen offset:0 lds
  v_mfma_f32_32x32x16_bf16 v[80:95], v[16:19], v[184:187], 0
  ds_read_b128 v[16:19], v12 offset:16384
  s_waitcnt lgkmcnt(3)
  v_mfma_f32_32x32x16_bf16 v[64:79], v[20:23], v[124:127], v[64:79]
  buffer_load_dwordx4 v5, s[56:59], s22 offen offset:1024 lds
  v_mul_f32 v32, s52, v32
  v_mul_f32 v33, s52, v33
  v_cvt_pk_bf16_f32 v32, v32, v33
  v_mfma_f32_32x32x16_bf16 v[80:95], v[20:23], v[188:191], v[80:95]
  v_mul_f32 v34, s52, v34
  v_mul_f32 v35, s52, v35
  ds_read_b128 v[20:23], v13 offset:16384
  s_waitcnt lgkmcnt(3)
  v_mfma_f32_32x32x16_bf16 v[64:79], v[24:27], v[128:131], v[64:79]
  buffer_load_dwordx4 v6, s[56:59], s22 offen offset:2048 lds
  v_cvt_pk_bf16_f32 v33, v34, v35
  v_mul_f32 v36, s52, v36
  v_mul_f32 v37, s52, v37
  v_mfma_f32_32x32x16_bf16 v[80:95], v[24:27], v[192:195], v[80:95]
  v_cvt_pk_bf16_f32 v34, v36, v37
  v_mul_f32 v38, s52, v38
  ds_read_b128 v[24:27], v14 offset:16384
  s_waitcnt lgkmcnt(3)
  v_mfma_f32_32x32x16_bf16 v[64:79], v[28:31], v[132:135], v[64:79]
  buffer_load_dwordx4 v7, s[56:59], s22 offen offset:3072 lds
  v_mul_f32 v39, s52, v39
  v_cvt_pk_bf16_f32 v35, v38, v39
  v_mul_f32 v40, s52, v40
  v_mfma_f32_32x32x16_bf16 v[80:95], v[28:31], v[196:199], v[80:95]
  v_mul_f32 v41, s52, v41
  v_cvt_pk_bf16_f32 v40, v40, v41
  ds_read_b128 v[28:31], v15 offset:16384
  s_waitcnt lgkmcnt(3)
  v_mfma_f32_32x32x16_bf16 v[64:79], v[16:19], v[136:139], v[64:79]
  s_add_u32 s22, s27, 3407872
  s_add_u32 m0, s25, 65536
  s_nop 0
  buffer_load_dwordx4 v4, s[56:59], s22 offen offset:0 lds
  v_mul_f32 v42, s52, v42
  v_mul_f32 v43, s52, v43
  v_cvt_pk_bf16_f32 v41, v42, v43
  v_mfma_f32_32x32x16_bf16 v[80:95], v[16:19], v[200:203], v[80:95]
  v_mul_f32 v44, s52, v44
  v_mul_f32 v45, s52, v45
  ds_read_b128 v[16:19], v8 offset:16640
  s_waitcnt lgkmcnt(3)
  v_mfma_f32_32x32x16_bf16 v[64:79], v[20:23], v[140:143], v[64:79]
  buffer_load_dwordx4 v5, s[56:59], s22 offen offset:1024 lds
  v_cvt_pk_bf16_f32 v42, v44, v45
  v_mul_f32 v46, s52, v46
  v_mul_f32 v47, s52, v47
  v_mfma_f32_32x32x16_bf16 v[80:95], v[20:23], v[204:207], v[80:95]
  v_cvt_pk_bf16_f32 v43, v46, v47
  v_permlane16_swap_b32 v32, v40
  ds_read_b128 v[20:23], v9 offset:16640
  s_waitcnt lgkmcnt(3)
  v_mfma_f32_32x32x16_bf16 v[64:79], v[24:27], v[144:147], v[64:79]
  buffer_load_dwordx4 v6, s[56:59], s22 offen offset:2048 lds
  v_permlane16_swap_b32 v33, v41
  v_permlane16_swap_b32 v34, v42
  v_permlane16_swap_b32 v35, v43
  v_mfma_f32_32x32x16_bf16 v[80:95], v[24:27], v[208:211], v[80:95]
  v_accvgpr_write_b32 a16, v32
  v_accvgpr_write_b32 a17, v33
  ds_read_b128 v[24:27], v10 offset:16640
  s_waitcnt lgkmcnt(3)
  v_mfma_f32_32x32x16_bf16 v[64:79], v[28:31], v[148:151], v[64:79]
  buffer_load_dwordx4 v7, s[56:59], s22 offen offset:3072 lds
  v_accvgpr_write_b32 a18, v34
  v_accvgpr_write_b32 a19, v35
  v_accvgpr_write_b32 a72, v40
  v_mfma_f32_32x32x16_bf16 v[80:95], v[28:31], v[212:215], v[80:95]
  v_accvgpr_write_b32 a73, v41
  v_accvgpr_write_b32 a74, v42
  ds_read_b128 v[28:31], v11 offset:16640
  s_waitcnt lgkmcnt(3)
  v_mfma_f32_32x32x16_bf16 v[64:79], v[16:19], v[152:155], v[64:79]
  v_accvgpr_write_b32 a75, v43
  v_mul_f32 v48, s52, v48
  v_mul_f32 v49, s52, v49
  v_mfma_f32_32x32x16_bf16 v[80:95], v[16:19], v[216:219], v[80:95]
  v_cvt_pk_bf16_f32 v48, v48, v49
  v_mul_f32 v50, s52, v50
  ds_read_b128 v[16:19], v12 offset:16640
  s_waitcnt lgkmcnt(3)
  v_mfma_f32_32x32x16_bf16 v[64:79], v[20:23], v[156:159], v[64:79]
  v_mul_f32 v51, s52, v51
  v_cvt_pk_bf16_f32 v49, v50, v51
  v_mul_f32 v52, s52, v52
  v_mfma_f32_32x32x16_bf16 v[80:95], v[20:23], v[220:223], v[80:95]
  v_mul_f32 v53, s52, v53
  v_cvt_pk_bf16_f32 v50, v52, v53
  ds_read_b128 v[20:23], v13 offset:16640
  s_waitcnt lgkmcnt(3)
  v_mfma_f32_32x32x16_bf16 v[64:79], v[24:27], v[160:163], v[64:79]
  v_mul_f32 v54, s52, v54
  v_mul_f32 v55, s52, v55
  v_cvt_pk_bf16_f32 v51, v54, v55
  v_mfma_f32_32x32x16_bf16 v[80:95], v[24:27], v[224:227], v[80:95]
  v_mul_f32 v56, s52, v56
  v_mul_f32 v57, s52, v57
  ds_read_b128 v[24:27], v14 offset:16640
  s_waitcnt lgkmcnt(3)
  v_mfma_f32_32x32x16_bf16 v[64:79], v[28:31], v[164:167], v[64:79]
  v_cvt_pk_bf16_f32 v56, v56, v57
  v_mul_f32 v58, s52, v58
  v_mul_f32 v59, s52, v59
  v_mfma_f32_32x32x16_bf16 v[80:95], v[28:31], v[228:231], v[80:95]
  v_cvt_pk_bf16_f32 v57, v58, v59
  v_mul_f32 v60, s52, v60
  ds_read_b128 v[28:31], v15 offset:16640
  s_waitcnt lgkmcnt(3)
  v_mfma_f32_32x32x16_bf16 v[64:79], v[16:19], v[168:171], v[64:79]
  v_mul_f32 v61, s52, v61
  v_cvt_pk_bf16_f32 v58, v60, v61
  v_mul_f32 v62, s52, v62
  v_mfma_f32_32x32x16_bf16 v[80:95], v[16:19], v[232:235], v[80:95]
  v_mul_f32 v63, s52, v63
  v_cvt_pk_bf16_f32 v59, v62, v63
  ds_read_b128 v[16:19], v8 offset:32768
  s_waitcnt lgkmcnt(3)
  v_mfma_f32_32x32x16_bf16 v[64:79], v[20:23], v[172:175], v[64:79]
  v_permlane16_swap_b32 v48, v56
  v_permlane16_swap_b32 v49, v57
  v_permlane16_swap_b32 v50, v58
  v_mfma_f32_32x32x16_bf16 v[80:95], v[20:23], v[236:239], v[80:95]
  v_permlane16_swap_b32 v51, v59
  v_accvgpr_write_b32 a128, v48
  ds_read_b128 v[20:23], v9 offset:32768
  s_waitcnt lgkmcnt(3)
  v_mfma_f32_32x32x16_bf16 v[64:79], v[24:27], v[176:179], v[64:79]
  v_accvgpr_write_b32 a129, v49
  v_accvgpr_write_b32 a130, v50
  v_accvgpr_write_b32 a131, v51
  v_mfma_f32_32x32x16_bf16 v[80:95], v[24:27], v[240:243], v[80:95]
  v_accvgpr_write_b32 a184, v56
  v_accvgpr_write_b32 a185, v57
  ds_read_b128 v[24:27], v10 offset:32768
  s_waitcnt lgkmcnt(3)
  v_mfma_f32_32x32x16_bf16 v[64:79], v[28:31], v[180:183], v[64:79]
  v_accvgpr_write_b32 a186, v58
  v_accvgpr_write_b32 a187, v59
  v_mfma_f32_32x32x16_bf16 v[80:95], v[28:31], v[244:247], v[80:95]
  ds_read_b128 v[28:31], v11 offset:32768
  s_waitcnt lgkmcnt(3)
  v_mfma_f32_32x32x16_bf16 v[32:47], v[16:19], v[120:123], 0
  v_mfma_f32_32x32x16_bf16 v[48:63], v[16:19], v[184:187], 0
  ds_read_b128 v[16:19], v12 offset:32768
  s_waitcnt lgkmcnt(3)
  v_mfma_f32_32x32x16_bf16 v[32:47], v[20:23], v[124:127], v[32:47]
  v_mul_f32 v64, s52, v64
  v_mul_f32 v65, s52, v65
  v_cvt_pk_bf16_f32 v64, v64, v65
  v_mfma_f32_32x32x16_bf16 v[48:63], v[20:23], v[188:191], v[48:63]
  v_mul_f32 v66, s52, v66
  v_mul_f32 v67, s52, v67
  ds_read_b128 v[20:23], v13 offset:32768
  s_waitcnt lgkmcnt(3)
  v_mfma_f32_32x32x16_bf16 v[32:47], v[24:27], v[128:131], v[32:47]
  v_cvt_pk_bf16_f32 v65, v66, v67
  v_mul_f32 v68, s52, v68
  v_mul_f32 v69, s52, v69
  v_mfma_f32_32x32x16_bf16 v[48:63], v[24:27], v[192:195], v[48:63]
  v_cvt_pk_bf16_f32 v66, v68, v69
  v_mul_f32 v70, s52, v70
  ds_read_b128 v[24:27], v14 offset:32768
  s_waitcnt lgkmcnt(3)
  v_mfma_f32_32x32x16_bf16 v[32:47], v[28:31], v[132:135], v[32:47]
  v_mul_f32 v71, s52, v71
  v_cvt_pk_bf16_f32 v67, v70, v71
  v_mul_f32 v72, s52, v72
  v_mfma_f32_32x32x16_bf16 v[48:63], v[28:31], v[196:199], v[48:63]
  v_mul_f32 v73, s52, v73
  v_cvt_pk_bf16_f32 v72, v72, v73
  ds_read_b128 v[28:31], v15 offset:32768
  s_waitcnt lgkmcnt(3)
  v_mfma_f32_32x32x16_bf16 v[32:47], v[16:19], v[136:139], v[32:47]
  v_mul_f32 v74, s52, v74
  v_mul_f32 v75, s52, v75
  v_cvt_pk_bf16_f32 v73, v74, v75
  v_mfma_f32_32x32x16_bf16 v[48:63], v[16:19], v[200:203], v[48:63]
  v_mul_f32 v76, s52, v76
  v_mul_f32 v77, s52, v77
  ds_read_b128 v[16:19], v8 offset:33024
  s_waitcnt lgkmcnt(3)
  v_mfma_f32_32x32x16_bf16 v[32:47], v[20:23], v[140:143], v[32:47]
  v_cvt_pk_bf16_f32 v74, v76, v77
  v_mul_f32 v78, s52, v78
  v_mul_f32 v79, s52, v79
  v_mfma_f32_32x32x16_bf16 v[48:63], v[20:23], v[204:207], v[48:63]
  v_cvt_pk_bf16_f32 v75, v78, v79
  v_permlane16_swap_b32 v64, v72
  ds_read_b128 v[20:23], v9 offset:33024
  s_waitcnt lgkmcnt(3)
  v_mfma_f32_32x32x16_bf16 v[32:47], v[24:27], v[144:147], v[32:47]
  v_permlane16_swap_b32 v65, v73
  v_permlane16_swap_b32 v66, v74
  v_permlane16_swap_b32 v67, v75
  v_mfma_f32_32x32x16_bf16 v[48:63], v[24:27], v[208:211], v[48:63]
  v_accvgpr_write_b32 a20, v64
  v_accvgpr_write_b32 a21, v65
  ds_read_b128 v[24:27], v10 offset:33024
  s_waitcnt lgkmcnt(3)
  v_mfma_f32_32x32x16_bf16 v[32:47], v[28:31], v[148:151], v[32:47]
  v_accvgpr_write_b32 a22, v66
  v_accvgpr_write_b32 a23, v67
  v_accvgpr_write_b32 a76, v72
  v_mfma_f32_32x32x16_bf16 v[48:63], v[28:31], v[212:215], v[48:63]
  v_accvgpr_write_b32 a77, v73
  v_accvgpr_write_b32 a78, v74
  ds_read_b128 v[28:31], v11 offset:33024
  s_waitcnt lgkmcnt(3)
  v_mfma_f32_32x32x16_bf16 v[32:47], v[16:19], v[152:155], v[32:47]
  v_accvgpr_write_b32 a79, v75
  v_mul_f32 v80, s52, v80
  v_mul_f32 v81, s52, v81
  v_mfma_f32_32x32x16_bf16 v[48:63], v[16:19], v[216:219], v[48:63]
  v_cvt_pk_bf16_f32 v80, v80, v81
  v_mul_f32 v82, s52, v82
  ds_read_b128 v[16:19], v12 offset:33024
  s_waitcnt lgkmcnt(3)
  v_mfma_f32_32x32x16_bf16 v[32:47], v[20:23], v[156:159], v[32:47]
  v_mul_f32 v83, s52, v83
  v_cvt_pk_bf16_f32 v81, v82, v83
  v_mul_f32 v84, s52, v84
  v_mfma_f32_32x32x16_bf16 v[48:63], v[20:23], v[220:223], v[48:63]
  v_mul_f32 v85, s52, v85
  v_cvt_pk_bf16_f32 v82, v84, v85
  ds_read_b128 v[20:23], v13 offset:33024
  s_waitcnt lgkmcnt(3)
  v_mfma_f32_32x32x16_bf16 v[32:47], v[24:27], v[160:163], v[32:47]
  v_mul_f32 v86, s52, v86
  v_mul_f32 v87, s52, v87
  v_cvt_pk_bf16_f32 v83, v86, v87
  v_mfma_f32_32x32x16_bf16 v[48:63], v[24:27], v[224:227], v[48:63]
  v_mul_f32 v88, s52, v88
  v_mul_f32 v89, s52, v89
  ds_read_b128 v[24:27], v14 offset:33024
  s_waitcnt lgkmcnt(3)
  v_mfma_f32_32x32x16_bf16 v[32:47], v[28:31], v[164:167], v[32:47]
  v_cvt_pk_bf16_f32 v88, v88, v89
  v_mul_f32 v90, s52, v90
  v_mul_f32 v91, s52, v91
  v_mfma_f32_32x32x16_bf16 v[48:63], v[28:31], v[228:231], v[48:63]
  v_cvt_pk_bf16_f32 v89, v90, v91
  v_mul_f32 v92, s52, v92
  ds_read_b128 v[28:31], v15 offset:33024
  s_waitcnt lgkmcnt(3)
  v_mfma_f32_32x32x16_bf16 v[32:47], v[16:19], v[168:171], v[32:47]
  v_mul_f32 v93, s52, v93
  v_cvt_pk_bf16_f32 v90, v92, v93
  v_mul_f32 v94, s52, v94
  v_mfma_f32_32x32x16_bf16 v[48:63], v[16:19], v[232:235], v[48:63]
  v_mul_f32 v95, s52, v95
  v_cvt_pk_bf16_f32 v91, v94, v95
  ds_read_b128 v[16:19], v8 offset:49152
  s_waitcnt lgkmcnt(3)
  v_mfma_f32_32x32x16_bf16 v[32:47], v[20:23], v[172:175], v[32:47]
  v_permlane16_swap_b32 v80, v88
  v_permlane16_swap_b32 v81, v89
  v_permlane16_swap_b32 v82, v90
  v_mfma_f32_32x32x16_bf16 v[48:63], v[20:23], v[236:239], v[48:63]
  v_permlane16_swap_b32 v83, v91
  v_accvgpr_write_b32 a132, v80
  ds_read_b128 v[20:23], v9 offset:49152
  s_waitcnt lgkmcnt(3)
  v_mfma_f32_32x32x16_bf16 v[32:47], v[24:27], v[176:179], v[32:47]
  v_accvgpr_write_b32 a133, v81
  v_accvgpr_write_b32 a134, v82
  v_accvgpr_write_b32 a135, v83
  v_mfma_f32_32x32x16_bf16 v[48:63], v[24:27], v[240:243], v[48:63]
  v_accvgpr_write_b32 a188, v88
  v_accvgpr_write_b32 a189, v89
  ds_read_b128 v[24:27], v10 offset:49152
  s_waitcnt lgkmcnt(3)
  v_mfma_f32_32x32x16_bf16 v[32:47], v[28:31], v[180:183], v[32:47]
  v_accvgpr_write_b32 a190, v90
  v_accvgpr_write_b32 a191, v91
  v_mfma_f32_32x32x16_bf16 v[48:63], v[28:31], v[244:247], v[48:63]
  s_waitcnt vmcnt(16)
  s_barrier
  ds_read_b128 v[28:31], v11 offset:49152
  s_waitcnt lgkmcnt(3)
  v_mfma_f32_32x32x16_bf16 v[64:79], v[16:19], v[120:123], 0
  v_mfma_f32_32x32x16_bf16 v[80:95], v[16:19], v[184:187], 0
  ds_read_b128 v[16:19], v12 offset:49152
  s_waitcnt lgkmcnt(3)
  v_mfma_f32_32x32x16_bf16 v[64:79], v[20:23], v[124:127], v[64:79]
  v_mul_f32 v32, s52, v32
  v_mul_f32 v33, s52, v33
  v_cvt_pk_bf16_f32 v32, v32, v33
  v_mfma_f32_32x32x16_bf16 v[80:95], v[20:23], v[188:191], v[80:95]
  v_mul_f32 v34, s52, v34
  v_mul_f32 v35, s52, v35
  ds_read_b128 v[20:23], v13 offset:49152
  s_waitcnt lgkmcnt(3)
  v_mfma_f32_32x32x16_bf16 v[64:79], v[24:27], v[128:131], v[64:79]
  v_cvt_pk_bf16_f32 v33, v34, v35
  v_mul_f32 v36, s52, v36
  v_mul_f32 v37, s52, v37
  v_mfma_f32_32x32x16_bf16 v[80:95], v[24:27], v[192:195], v[80:95]
  v_cvt_pk_bf16_f32 v34, v36, v37
  v_mul_f32 v38, s52, v38
  ds_read_b128 v[24:27], v14 offset:49152
  s_waitcnt lgkmcnt(3)
  v_mfma_f32_32x32x16_bf16 v[64:79], v[28:31], v[132:135], v[64:79]
  v_mul_f32 v39, s52, v39
  v_cvt_pk_bf16_f32 v35, v38, v39
  v_mul_f32 v40, s52, v40
  v_mfma_f32_32x32x16_bf16 v[80:95], v[28:31], v[196:199], v[80:95]
  v_mul_f32 v41, s52, v41
  v_cvt_pk_bf16_f32 v40, v40, v41
  ds_read_b128 v[28:31], v15 offset:49152
  s_waitcnt lgkmcnt(3)
  v_mfma_f32_32x32x16_bf16 v[64:79], v[16:19], v[136:139], v[64:79]
  v_mul_f32 v42, s52, v42
  v_mul_f32 v43, s52, v43
  v_cvt_pk_bf16_f32 v41, v42, v43
  v_mfma_f32_32x32x16_bf16 v[80:95], v[16:19], v[200:203], v[80:95]
  v_mul_f32 v44, s52, v44
  v_mul_f32 v45, s52, v45
  ds_read_b128 v[16:19], v8 offset:49408
  s_waitcnt lgkmcnt(3)
  v_mfma_f32_32x32x16_bf16 v[64:79], v[20:23], v[140:143], v[64:79]
  v_cvt_pk_bf16_f32 v42, v44, v45
  v_mul_f32 v46, s52, v46
  v_mul_f32 v47, s52, v47
  v_mfma_f32_32x32x16_bf16 v[80:95], v[20:23], v[204:207], v[80:95]
  v_cvt_pk_bf16_f32 v43, v46, v47
  v_permlane16_swap_b32 v32, v40
  ds_read_b128 v[20:23], v9 offset:49408
  s_waitcnt lgkmcnt(3)
  v_mfma_f32_32x32x16_bf16 v[64:79], v[24:27], v[144:147], v[64:79]
  v_permlane16_swap_b32 v33, v41
  v_permlane16_swap_b32 v34, v42
  v_permlane16_swap_b32 v35, v43
  v_mfma_f32_32x32x16_bf16 v[80:95], v[24:27], v[208:211], v[80:95]
  v_accvgpr_write_b32 a24, v32
  v_accvgpr_write_b32 a25, v33
  ds_read_b128 v[24:27], v10 offset:49408
  s_waitcnt lgkmcnt(3)
  v_mfma_f32_32x32x16_bf16 v[64:79], v[28:31], v[148:151], v[64:79]
  v_accvgpr_write_b32 a26, v34
  v_accvgpr_write_b32 a27, v35
  v_accvgpr_write_b32 a80, v40
  v_mfma_f32_32x32x16_bf16 v[80:95], v[28:31], v[212:215], v[80:95]
  v_accvgpr_write_b32 a81, v41
  v_accvgpr_write_b32 a82, v42
  ds_read_b128 v[28:31], v11 offset:49408
  s_waitcnt lgkmcnt(3)
  v_mfma_f32_32x32x16_bf16 v[64:79], v[16:19], v[152:155], v[64:79]
  v_accvgpr_write_b32 a83, v43
  v_mul_f32 v48, s52, v48
  v_mul_f32 v49, s52, v49
  v_mfma_f32_32x32x16_bf16 v[80:95], v[16:19], v[216:219], v[80:95]
  v_cvt_pk_bf16_f32 v48, v48, v49
  v_mul_f32 v50, s52, v50
  ds_read_b128 v[16:19], v12 offset:49408
  s_waitcnt lgkmcnt(3)
  v_mfma_f32_32x32x16_bf16 v[64:79], v[20:23], v[156:159], v[64:79]
  v_mul_f32 v51, s52, v51
  v_cvt_pk_bf16_f32 v49, v50, v51
  v_mul_f32 v52, s52, v52
  v_mfma_f32_32x32x16_bf16 v[80:95], v[20:23], v[220:223], v[80:95]
  v_mul_f32 v53, s52, v53
  v_cvt_pk_bf16_f32 v50, v52, v53
  ds_read_b128 v[20:23], v13 offset:49408
  s_waitcnt lgkmcnt(3)
  v_mfma_f32_32x32x16_bf16 v[64:79], v[24:27], v[160:163], v[64:79]
  v_mul_f32 v54, s52, v54
  v_mul_f32 v55, s52, v55
  v_cvt_pk_bf16_f32 v51, v54, v55
  v_mfma_f32_32x32x16_bf16 v[80:95], v[24:27], v[224:227], v[80:95]
  v_mul_f32 v56, s52, v56
  v_mul_f32 v57, s52, v57
  ds_read_b128 v[24:27], v14 offset:49408
  s_waitcnt lgkmcnt(3)
  v_mfma_f32_32x32x16_bf16 v[64:79], v[28:31], v[164:167], v[64:79]
  v_cvt_pk_bf16_f32 v56, v56, v57
  v_mul_f32 v58, s52, v58
  v_mul_f32 v59, s52, v59
  v_mfma_f32_32x32x16_bf16 v[80:95], v[28:31], v[228:231], v[80:95]
  v_cvt_pk_bf16_f32 v57, v58, v59
  v_mul_f32 v60, s52, v60
  ds_read_b128 v[28:31], v15 offset:49408
  s_waitcnt lgkmcnt(3)
  v_mfma_f32_32x32x16_bf16 v[64:79], v[16:19], v[168:171], v[64:79]
  v_mul_f32 v61, s52, v61
  v_cvt_pk_bf16_f32 v58, v60, v61
  v_mul_f32 v62, s52, v62
  v_mfma_f32_32x32x16_bf16 v[80:95], v[16:19], v[232:235], v[80:95]
  v_mul_f32 v63, s52, v63
  v_cvt_pk_bf16_f32 v59, v62, v63
  v_xor_b32 v8, 196608, v8
  ds_read_b128 v[16:19], v8 offset:0
  s_waitcnt lgkmcnt(3)
  v_mfma_f32_32x32x16_bf16 v[64:79], v[20:23], v[172:175], v[64:79]
  v_permlane16_swap_b32 v48, v56
  v_permlane16_swap_b32 v49, v57
  v_permlane16_swap_b32 v50, v58
  v_mfma_f32_32x32x16_bf16 v[80:95], v[20:23], v[236:239], v[80:95]
  v_permlane16_swap_b32 v51, v59
  v_accvgpr_write_b32 a136, v48
  v_xor_b32 v9, 196608, v9
  ds_read_b128 v[20:23], v9 offset:0
  s_waitcnt lgkmcnt(3)
  v_mfma_f32_32x32x16_bf16 v[64:79], v[24:27], v[176:179], v[64:79]
  v_accvgpr_write_b32 a137, v49
  v_accvgpr_write_b32 a138, v50
  v_accvgpr_write_b32 a139, v51
  v_mfma_f32_32x32x16_bf16 v[80:95], v[24:27], v[240:243], v[80:95]
  v_accvgpr_write_b32 a192, v56
  v_accvgpr_write_b32 a193, v57
  v_xor_b32 v10, 196608, v10
  ds_read_b128 v[24:27], v10 offset:0
  s_waitcnt lgkmcnt(3)
  v_mfma_f32_32x32x16_bf16 v[64:79], v[28:31], v[180:183], v[64:79]
  v_accvgpr_write_b32 a194, v58
  v_accvgpr_write_b32 a195, v59
  v_mfma_f32_32x32x16_bf16 v[80:95], v[28:31], v[244:247], v[80:95]
  v_xor_b32 v11, 196608, v11
  ds_read_b128 v[28:31], v11 offset:0
  s_waitcnt lgkmcnt(3)
  v_mfma_f32_32x32x16_bf16 v[32:47], v[16:19], v[120:123], 0
  v_mfma_f32_32x32x16_bf16 v[48:63], v[16:19], v[184:187], 0
  v_xor_b32 v12, 196608, v12
  ds_read_b128 v[16:19], v12 offset:0
  s_waitcnt lgkmcnt(3)
  v_mfma_f32_32x32x16_bf16 v[32:47], v[20:23], v[124:127], v[32:47]
  v_mul_f32 v64, s52, v64
  v_mul_f32 v65, s52, v65
  v_cvt_pk_bf16_f32 v64, v64, v65
  v_mfma_f32_32x32x16_bf16 v[48:63], v[20:23], v[188:191], v[48:63]
  v_mul_f32 v66, s52, v66
  v_mul_f32 v67, s52, v67
  v_xor_b32 v13, 196608, v13
  ds_read_b128 v[20:23], v13 offset:0
  s_waitcnt lgkmcnt(3)
  v_mfma_f32_32x32x16_bf16 v[32:47], v[24:27], v[128:131], v[32:47]
  v_cvt_pk_bf16_f32 v65, v66, v67
  v_mul_f32 v68, s52, v68
  v_mul_f32 v69, s52, v69
  v_mfma_f32_32x32x16_bf16 v[48:63], v[24:27], v[192:195], v[48:63]
  v_cvt_pk_bf16_f32 v66, v68, v69
  v_mul_f32 v70, s52, v70
  v_xor_b32 v14, 196608, v14
  ds_read_b128 v[24:27], v14 offset:0
  s_waitcnt lgkmcnt(3)
  v_mfma_f32_32x32x16_bf16 v[32:47], v[28:31], v[132:135], v[32:47]
  v_mul_f32 v71, s52, v71
  v_cvt_pk_bf16_f32 v67, v70, v71
  v_mul_f32 v72, s52, v72
  v_mfma_f32_32x32x16_bf16 v[48:63], v[28:31], v[196:199], v[48:63]
  v_mul_f32 v73, s52, v73
  v_cvt_pk_bf16_f32 v72, v72, v73
  v_xor_b32 v15, 196608, v15
  ds_read_b128 v[28:31], v15 offset:0
  s_waitcnt lgkmcnt(3)
  v_mfma_f32_32x32x16_bf16 v[32:47], v[16:19], v[136:139], v[32:47]
  v_mul_f32 v74, s52, v74
  v_mul_f32 v75, s52, v75
  v_cvt_pk_bf16_f32 v73, v74, v75
  v_mfma_f32_32x32x16_bf16 v[48:63], v[16:19], v[200:203], v[48:63]
  v_mul_f32 v76, s52, v76
  v_mul_f32 v77, s52, v77
  ds_read_b128 v[16:19], v8 offset:256
  s_waitcnt lgkmcnt(3)
  v_mfma_f32_32x32x16_bf16 v[32:47], v[20:23], v[140:143], v[32:47]
  v_cvt_pk_bf16_f32 v74, v76, v77
  v_mul_f32 v78, s52, v78
  v_mul_f32 v79, s52, v79
  v_mfma_f32_32x32x16_bf16 v[48:63], v[20:23], v[204:207], v[48:63]
  v_cvt_pk_bf16_f32 v75, v78, v79
  v_permlane16_swap_b32 v64, v72
  ds_read_b128 v[20:23], v9 offset:256
  s_waitcnt lgkmcnt(3)
  v_mfma_f32_32x32x16_bf16 v[32:47], v[24:27], v[144:147], v[32:47]
  v_permlane16_swap_b32 v65, v73
  v_permlane16_swap_b32 v66, v74
  v_permlane16_swap_b32 v67, v75
  v_mfma_f32_32x32x16_bf16 v[48:63], v[24:27], v[208:211], v[48:63]
  v_accvgpr_write_b32 a28, v64
  v_accvgpr_write_b32 a29, v65
  ds_read_b128 v[24:27], v10 offset:256
  s_waitcnt lgkmcnt(3)
  v_mfma_f32_32x32x16_bf16 v[32:47], v[28:31], v[148:151], v[32:47]
  v_accvgpr_write_b32 a30, v66
  v_accvgpr_write_b32 a31, v67
  v_accvgpr_write_b32 a84, v72
  v_mfma_f32_32x32x16_bf16 v[48:63], v[28:31], v[212:215], v[48:63]
  v_accvgpr_write_b32 a85, v73
  v_accvgpr_write_b32 a86, v74
  ds_read_b128 v[28:31], v11 offset:256
  s_waitcnt lgkmcnt(3)
  v_mfma_f32_32x32x16_bf16 v[32:47], v[16:19], v[152:155], v[32:47]
  v_accvgpr_write_b32 a87, v75
  v_mul_f32 v80, s52, v80
  v_mul_f32 v81, s52, v81
  v_mfma_f32_32x32x16_bf16 v[48:63], v[16:19], v[216:219], v[48:63]
  v_cvt_pk_bf16_f32 v80, v80, v81
  v_mul_f32 v82, s52, v82
  ds_read_b128 v[16:19], v12 offset:256
  s_waitcnt lgkmcnt(3)
  v_mfma_f32_32x32x16_bf16 v[32:47], v[20:23], v[156:159], v[32:47]
  v_mul_f32 v83, s52, v83
  v_cvt_pk_bf16_f32 v81, v82, v83
  v_mul_f32 v84, s52, v84
  v_mfma_f32_32x32x16_bf16 v[48:63], v[20:23], v[220:223], v[48:63]
  v_mul_f32 v85, s52, v85
  v_cvt_pk_bf16_f32 v82, v84, v85
  ds_read_b128 v[20:23], v13 offset:256
  s_waitcnt lgkmcnt(3)
  v_mfma_f32_32x32x16_bf16 v[32:47], v[24:27], v[160:163], v[32:47]
  v_mul_f32 v86, s52, v86
  v_mul_f32 v87, s52, v87
  v_cvt_pk_bf16_f32 v83, v86, v87
  v_mfma_f32_32x32x16_bf16 v[48:63], v[24:27], v[224:227], v[48:63]
  v_mul_f32 v88, s52, v88
  v_mul_f32 v89, s52, v89
  ds_read_b128 v[24:27], v14 offset:256
  s_waitcnt lgkmcnt(3)
  v_mfma_f32_32x32x16_bf16 v[32:47], v[28:31], v[164:167], v[32:47]
  v_cvt_pk_bf16_f32 v88, v88, v89
  v_mul_f32 v90, s52, v90
  v_mul_f32 v91, s52, v91
  v_mfma_f32_32x32x16_bf16 v[48:63], v[28:31], v[228:231], v[48:63]
  v_cvt_pk_bf16_f32 v89, v90, v91
  v_mul_f32 v92, s52, v92
  ds_read_b128 v[28:31], v15 offset:256
  s_waitcnt lgkmcnt(3)
  v_mfma_f32_32x32x16_bf16 v[32:47], v[16:19], v[168:171], v[32:47]
  v_mul_f32 v93, s52, v93
  v_cvt_pk_bf16_f32 v90, v92, v93
  v_mul_f32 v94, s52, v94
  v_mfma_f32_32x32x16_bf16 v[48:63], v[16:19], v[232:235], v[48:63]
  v_mul_f32 v95, s52, v95
  v_cvt_pk_bf16_f32 v91, v94, v95
  v_xor_b32 v8, 131072, v8
  ds_read_b128 v[16:19], v8 offset:0
  s_waitcnt lgkmcnt(3)
  v_mfma_f32_32x32x16_bf16 v[32:47], v[20:23], v[172:175], v[32:47]
  v_permlane16_swap_b32 v80, v88
  v_permlane16_swap_b32 v81, v89
  v_permlane16_swap_b32 v82, v90
  v_mfma_f32_32x32x16_bf16 v[48:63], v[20:23], v[236:239], v[48:63]
  v_permlane16_swap_b32 v83, v91
  v_accvgpr_write_b32 a140, v80
  v_xor_b32 v9, 131072, v9
  ds_read_b128 v[20:23], v9 offset:0
  s_waitcnt lgkmcnt(3)
  v_mfma_f32_32x32x16_bf16 v[32:47], v[24:27], v[176:179], v[32:47]
  v_accvgpr_write_b32 a141, v81
  v_accvgpr_write_b32 a142, v82
  v_accvgpr_write_b32 a143, v83
  v_mfma_f32_32x32x16_bf16 v[48:63], v[24:27], v[240:243], v[48:63]
  v_accvgpr_write_b32 a196, v88
  v_accvgpr_write_b32 a197, v89
  v_xor_b32 v10, 131072, v10
  ds_read_b128 v[24:27], v10 offset:0
  s_waitcnt lgkmcnt(3)
  v_mfma_f32_32x32x16_bf16 v[32:47], v[28:31], v[180:183], v[32:47]
  v_accvgpr_write_b32 a198, v90
  v_accvgpr_write_b32 a199, v91
  v_mfma_f32_32x32x16_bf16 v[48:63], v[28:31], v[244:247], v[48:63]
  s_waitcnt vmcnt(8)
  s_barrier
  v_xor_b32 v11, 131072, v11
  ds_read_b128 v[28:31], v11 offset:0
  s_waitcnt lgkmcnt(3)
  v_mfma_f32_32x32x16_bf16 v[64:79], v[16:19], v[120:123], 0
  v_mfma_f32_32x32x16_bf16 v[80:95], v[16:19], v[184:187], 0
  v_xor_b32 v12, 131072, v12
  ds_read_b128 v[16:19], v12 offset:0
  s_waitcnt lgkmcnt(3)
  v_mfma_f32_32x32x16_bf16 v[64:79], v[20:23], v[124:127], v[64:79]
  v_mul_f32 v32, s52, v32
  v_mul_f32 v33, s52, v33
  v_cvt_pk_bf16_f32 v32, v32, v33
  v_mfma_f32_32x32x16_bf16 v[80:95], v[20:23], v[188:191], v[80:95]
  v_mul_f32 v34, s52, v34
  v_mul_f32 v35, s52, v35
  v_xor_b32 v13, 131072, v13
  ds_read_b128 v[20:23], v13 offset:0
  s_waitcnt lgkmcnt(3)
  v_mfma_f32_32x32x16_bf16 v[64:79], v[24:27], v[128:131], v[64:79]
  v_cvt_pk_bf16_f32 v33, v34, v35
  v_mul_f32 v36, s52, v36
  v_mul_f32 v37, s52, v37
  v_mfma_f32_32x32x16_bf16 v[80:95], v[24:27], v[192:195], v[80:95]
  v_cvt_pk_bf16_f32 v34, v36, v37
  v_mul_f32 v38, s52, v38
  v_xor_b32 v14, 131072, v14
  ds_read_b128 v[24:27], v14 offset:0
  s_waitcnt lgkmcnt(3)
  v_mfma_f32_32x32x16_bf16 v[64:79], v[28:31], v[132:135], v[64:79]
  v_mul_f32 v39, s52, v39
  v_cvt_pk_bf16_f32 v35, v38, v39
  v_mul_f32 v40, s52, v40
  v_mfma_f32_32x32x16_bf16 v[80:95], v[28:31], v[196:199], v[80:95]
  v_mul_f32 v41, s52, v41
  v_cvt_pk_bf16_f32 v40, v40, v41
  v_xor_b32 v15, 131072, v15
  ds_read_b128 v[28:31], v15 offset:0
  s_waitcnt lgkmcnt(3)
  v_mfma_f32_32x32x16_bf16 v[64:79], v[16:19], v[136:139], v[64:79]
  v_mul_f32 v42, s52, v42
  v_mul_f32 v43, s52, v43
  v_cvt_pk_bf16_f32 v41, v42, v43
  v_mfma_f32_32x32x16_bf16 v[80:95], v[16:19], v[200:203], v[80:95]
  v_mul_f32 v44, s52, v44
  v_mul_f32 v45, s52, v45
  ds_read_b128 v[16:19], v8 offset:256
  s_waitcnt lgkmcnt(3)
  v_mfma_f32_32x32x16_bf16 v[64:79], v[20:23], v[140:143], v[64:79]
  v_cvt_pk_bf16_f32 v42, v44, v45
  v_mul_f32 v46, s52, v46
  v_mul_f32 v47, s52, v47
  v_mfma_f32_32x32x16_bf16 v[80:95], v[20:23], v[204:207], v[80:95]
  v_cvt_pk_bf16_f32 v43, v46, v47
  v_permlane16_swap_b32 v32, v40
  ds_read_b128 v[20:23], v9 offset:256
  s_waitcnt lgkmcnt(3)
  v_mfma_f32_32x32x16_bf16 v[64:79], v[24:27], v[144:147], v[64:79]
  v_permlane16_swap_b32 v33, v41
  v_permlane16_swap_b32 v34, v42
  v_permlane16_swap_b32 v35, v43
  v_mfma_f32_32x32x16_bf16 v[80:95], v[24:27], v[208:211], v[80:95]
  v_accvgpr_write_b32 a32, v32
  v_accvgpr_write_b32 a33, v33
  ds_read_b128 v[24:27], v10 offset:256
  s_waitcnt lgkmcnt(3)
  v_mfma_f32_32x32x16_bf16 v[64:79], v[28:31], v[148:151], v[64:79]
  v_accvgpr_write_b32 a34, v34
  v_accvgpr_write_b32 a35, v35
  v_accvgpr_write_b32 a88, v40
  v_mfma_f32_32x32x16_bf16 v[80:95], v[28:31], v[212:215], v[80:95]
  v_accvgpr_write_b32 a89, v41
  v_accvgpr_write_b32 a90, v42
  ds_read_b128 v[28:31], v11 offset:256
  s_waitcnt lgkmcnt(3)
  v_mfma_f32_32x32x16_bf16 v[64:79], v[16:19], v[152:155], v[64:79]
  v_accvgpr_write_b32 a91, v43
  v_mul_f32 v48, s52, v48
  v_mul_f32 v49, s52, v49
  v_mfma_f32_32x32x16_bf16 v[80:95], v[16:19], v[216:219], v[80:95]
  v_cvt_pk_bf16_f32 v48, v48, v49
  v_mul_f32 v50, s52, v50
  ds_read_b128 v[16:19], v12 offset:256
  s_waitcnt lgkmcnt(3)
  v_mfma_f32_32x32x16_bf16 v[64:79], v[20:23], v[156:159], v[64:79]
  v_mul_f32 v51, s52, v51
  v_cvt_pk_bf16_f32 v49, v50, v51
  v_mul_f32 v52, s52, v52
  v_mfma_f32_32x32x16_bf16 v[80:95], v[20:23], v[220:223], v[80:95]
  v_mul_f32 v53, s52, v53
  v_cvt_pk_bf16_f32 v50, v52, v53
  ds_read_b128 v[20:23], v13 offset:256
  s_waitcnt lgkmcnt(3)
  v_mfma_f32_32x32x16_bf16 v[64:79], v[24:27], v[160:163], v[64:79]
  v_mul_f32 v54, s52, v54
  v_mul_f32 v55, s52, v55
  v_cvt_pk_bf16_f32 v51, v54, v55
  v_mfma_f32_32x32x16_bf16 v[80:95], v[24:27], v[224:227], v[80:95]
  v_mul_f32 v56, s52, v56
  v_mul_f32 v57, s52, v57
  ds_read_b128 v[24:27], v14 offset:256
  s_waitcnt lgkmcnt(3)
  v_mfma_f32_32x32x16_bf16 v[64:79], v[28:31], v[164:167], v[64:79]
  v_cvt_pk_bf16_f32 v56, v56, v57
  v_mul_f32 v58, s52, v58
  v_mul_f32 v59, s52, v59
  v_mfma_f32_32x32x16_bf16 v[80:95], v[28:31], v[228:231], v[80:95]
  v_cvt_pk_bf16_f32 v57, v58, v59
  v_mul_f32 v60, s52, v60
  ds_read_b128 v[28:31], v15 offset:256
  s_waitcnt lgkmcnt(3)
  v_mfma_f32_32x32x16_bf16 v[64:79], v[16:19], v[168:171], v[64:79]
  v_mul_f32 v61, s52, v61
  v_cvt_pk_bf16_f32 v58, v60, v61
  v_mul_f32 v62, s52, v62
  v_mfma_f32_32x32x16_bf16 v[80:95], v[16:19], v[232:235], v[80:95]
  v_mul_f32 v63, s52, v63
  v_cvt_pk_bf16_f32 v59, v62, v63
  ds_read_b128 v[16:19], v8 offset:16384
  s_waitcnt lgkmcnt(3)
  v_mfma_f32_32x32x16_bf16 v[64:79], v[20:23], v[172:175], v[64:79]
  v_permlane16_swap_b32 v48, v56
  v_permlane16_swap_b32 v49, v57
  v_permlane16_swap_b32 v50, v58
  v_mfma_f32_32x32x16_bf16 v[80:95], v[20:23], v[236:239], v[80:95]
  v_permlane16_swap_b32 v51, v59
  v_accvgpr_write_b32 a144, v48
  ds_read_b128 v[20:23], v9 offset:16384
  s_waitcnt lgkmcnt(3)
  v_mfma_f32_32x32x16_bf16 v[64:79], v[24:27], v[176:179], v[64:79]
  v_accvgpr_write_b32 a145, v49
  v_accvgpr_write_b32 a146, v50
  v_accvgpr_write_b32 a147, v51
  v_mfma_f32_32x32x16_bf16 v[80:95], v[24:27], v[240:243], v[80:95]
  v_accvgpr_write_b32 a200, v56
  v_accvgpr_write_b32 a201, v57
  ds_read_b128 v[24:27], v10 offset:16384
  s_waitcnt lgkmcnt(3)
  v_mfma_f32_32x32x16_bf16 v[64:79], v[28:31], v[180:183], v[64:79]
  v_accvgpr_write_b32 a202, v58
  v_accvgpr_write_b32 a203, v59
  v_mfma_f32_32x32x16_bf16 v[80:95], v[28:31], v[244:247], v[80:95]
  ds_read_b128 v[28:31], v11 offset:16384
  s_waitcnt lgkmcnt(3)
  v_mfma_f32_32x32x16_bf16 v[32:47], v[16:19], v[120:123], 0
  v_mfma_f32_32x32x16_bf16 v[48:63], v[16:19], v[184:187], 0
  ds_read_b128 v[16:19], v12 offset:16384
  s_waitcnt lgkmcnt(3)
  v_mfma_f32_32x32x16_bf16 v[32:47], v[20:23], v[124:127], v[32:47]
  v_mul_f32 v64, s52, v64
  v_mul_f32 v65, s52, v65
  v_cvt_pk_bf16_f32 v64, v64, v65
  v_mfma_f32_32x32x16_bf16 v[48:63], v[20:23], v[188:191], v[48:63]
  v_mul_f32 v66, s52, v66
  v_mul_f32 v67, s52, v67
  ds_read_b128 v[20:23], v13 offset:16384
  s_waitcnt lgkmcnt(3)
  v_mfma_f32_32x32x16_bf16 v[32:47], v[24:27], v[128:131], v[32:47]
  v_cvt_pk_bf16_f32 v65, v66, v67
  v_mul_f32 v68, s52, v68
  v_mul_f32 v69, s52, v69
  v_mfma_f32_32x32x16_bf16 v[48:63], v[24:27], v[192:195], v[48:63]
  v_cvt_pk_bf16_f32 v66, v68, v69
  v_mul_f32 v70, s52, v70
  ds_read_b128 v[24:27], v14 offset:16384
  s_waitcnt lgkmcnt(3)
  v_mfma_f32_32x32x16_bf16 v[32:47], v[28:31], v[132:135], v[32:47]
  v_mul_f32 v71, s52, v71
  v_cvt_pk_bf16_f32 v67, v70, v71
  v_mul_f32 v72, s52, v72
  v_mfma_f32_32x32x16_bf16 v[48:63], v[28:31], v[196:199], v[48:63]
  v_mul_f32 v73, s52, v73
  v_cvt_pk_bf16_f32 v72, v72, v73
  ds_read_b128 v[28:31], v15 offset:16384
  s_waitcnt lgkmcnt(3)
  v_mfma_f32_32x32x16_bf16 v[32:47], v[16:19], v[136:139], v[32:47]
  buffer_load_dwordx4 v[100:103], v113, s[8:11], s28 offen sc1
  v_mul_f32 v74, s52, v74
  v_mul_f32 v75, s52, v75
  v_cvt_pk_bf16_f32 v73, v74, v75
  v_mfma_f32_32x32x16_bf16 v[48:63], v[16:19], v[200:203], v[48:63]
  v_mul_f32 v76, s52, v76
  v_mul_f32 v77, s52, v77
  ds_read_b128 v[16:19], v8 offset:16640
  s_waitcnt lgkmcnt(3)
  v_mfma_f32_32x32x16_bf16 v[32:47], v[20:23], v[140:143], v[32:47]
  v_cvt_pk_bf16_f32 v74, v76, v77
  v_mul_f32 v78, s52, v78
  v_mul_f32 v79, s52, v79
  v_mfma_f32_32x32x16_bf16 v[48:63], v[20:23], v[204:207], v[48:63]
  v_cvt_pk_bf16_f32 v75, v78, v79
  v_permlane16_swap_b32 v64, v72
  ds_read_b128 v[20:23], v9 offset:16640
  s_waitcnt lgkmcnt(3)
  v_mfma_f32_32x32x16_bf16 v[32:47], v[24:27], v[144:147], v[32:47]
  v_permlane16_swap_b32 v65, v73
  v_permlane16_swap_b32 v66, v74
  v_permlane16_swap_b32 v67, v75
  v_mfma_f32_32x32x16_bf16 v[48:63], v[24:27], v[208:211], v[48:63]
  v_accvgpr_write_b32 a36, v64
  v_accvgpr_write_b32 a37, v65
  ds_read_b128 v[24:27], v10 offset:16640
  s_waitcnt lgkmcnt(3)
  v_mfma_f32_32x32x16_bf16 v[32:47], v[28:31], v[148:151], v[32:47]
  v_accvgpr_write_b32 a38, v66
  v_accvgpr_write_b32 a39, v67
  v_accvgpr_write_b32 a92, v72
  v_mfma_f32_32x32x16_bf16 v[48:63], v[28:31], v[212:215], v[48:63]
  v_accvgpr_write_b32 a93, v73
  v_accvgpr_write_b32 a94, v74
  ds_read_b128 v[28:31], v11 offset:16640
  s_waitcnt lgkmcnt(3)
  v_mfma_f32_32x32x16_bf16 v[32:47], v[16:19], v[152:155], v[32:47]
  v_accvgpr_write_b32 a95, v75
  v_mul_f32 v80, s52, v80
  v_mul_f32 v81, s52, v81
  v_mfma_f32_32x32x16_bf16 v[48:63], v[16:19], v[216:219], v[48:63]
  v_cvt_pk_bf16_f32 v80, v80, v81
  v_mul_f32 v82, s52, v82
  ds_read_b128 v[16:19], v12 offset:16640
  s_waitcnt lgkmcnt(3)
  v_mfma_f32_32x32x16_bf16 v[32:47], v[20:23], v[156:159], v[32:47]
  v_mul_f32 v83, s52, v83
  v_cvt_pk_bf16_f32 v81, v82, v83
  v_mul_f32 v84, s52, v84
  v_mfma_f32_32x32x16_bf16 v[48:63], v[20:23], v[220:223], v[48:63]
  v_mul_f32 v85, s52, v85
  v_cvt_pk_bf16_f32 v82, v84, v85
  ds_read_b128 v[20:23], v13 offset:16640
  s_waitcnt lgkmcnt(3)
  v_mfma_f32_32x32x16_bf16 v[32:47], v[24:27], v[160:163], v[32:47]
  v_mul_f32 v86, s52, v86
  v_mul_f32 v87, s52, v87
  v_cvt_pk_bf16_f32 v83, v86, v87
  v_mfma_f32_32x32x16_bf16 v[48:63], v[24:27], v[224:227], v[48:63]
  v_mul_f32 v88, s52, v88
  v_mul_f32 v89, s52, v89
  ds_read_b128 v[24:27], v14 offset:16640
  s_waitcnt lgkmcnt(3)
  v_mfma_f32_32x32x16_bf16 v[32:47], v[28:31], v[164:167], v[32:47]
  v_cvt_pk_bf16_f32 v88, v88, v89
  v_mul_f32 v90, s52, v90
  v_mul_f32 v91, s52, v91
  v_mfma_f32_32x32x16_bf16 v[48:63], v[28:31], v[228:231], v[48:63]
  v_cvt_pk_bf16_f32 v89, v90, v91
  v_mul_f32 v92, s52, v92
  ds_read_b128 v[28:31], v15 offset:16640
  s_waitcnt lgkmcnt(3)
  v_mfma_f32_32x32x16_bf16 v[32:47], v[16:19], v[168:171], v[32:47]
  v_mul_f32 v93, s52, v93
  v_cvt_pk_bf16_f32 v90, v92, v93
  v_mul_f32 v94, s52, v94
  v_mfma_f32_32x32x16_bf16 v[48:63], v[16:19], v[232:235], v[48:63]
  v_mul_f32 v95, s52, v95
  v_cvt_pk_bf16_f32 v91, v94, v95
  ds_read_b128 v[16:19], v8 offset:32768
  s_waitcnt lgkmcnt(3)
  v_mfma_f32_32x32x16_bf16 v[32:47], v[20:23], v[172:175], v[32:47]
  v_permlane16_swap_b32 v80, v88
  v_permlane16_swap_b32 v81, v89
  v_permlane16_swap_b32 v82, v90
  v_mfma_f32_32x32x16_bf16 v[48:63], v[20:23], v[236:239], v[48:63]
  v_permlane16_swap_b32 v83, v91
  v_accvgpr_write_b32 a148, v80
  ds_read_b128 v[20:23], v9 offset:32768
  s_waitcnt lgkmcnt(3)
  v_mfma_f32_32x32x16_bf16 v[32:47], v[24:27], v[176:179], v[32:47]
  v_accvgpr_write_b32 a149, v81
  v_accvgpr_write_b32 a150, v82
  v_accvgpr_write_b32 a151, v83
  v_mfma_f32_32x32x16_bf16 v[48:63], v[24:27], v[240:243], v[48:63]
  v_accvgpr_write_b32 a204, v88
  v_accvgpr_write_b32 a205, v89
  ds_read_b128 v[24:27], v10 offset:32768
  s_waitcnt lgkmcnt(3)
  v_mfma_f32_32x32x16_bf16 v[32:47], v[28:31], v[180:183], v[32:47]
  v_accvgpr_write_b32 a206, v90
  v_accvgpr_write_b32 a207, v91
  v_mfma_f32_32x32x16_bf16 v[48:63], v[28:31], v[244:247], v[48:63]
  s_waitcnt vmcnt(1)
  s_barrier
  ds_read_b128 v[28:31], v11 offset:32768
  s_waitcnt lgkmcnt(3)
  v_mfma_f32_32x32x16_bf16 v[64:79], v[16:19], v[120:123], 0
  s_waitcnt vmcnt(0)
  v_cmp_ne_u64 vcc, s[88:89], v[100:101]
  v_cmp_ne_u64 s[54:55], s[88:89], v[102:103]
  s_add_u32 s48, s33, 14336
  v_mfma_f32_32x32x16_bf16 v[80:95], v[16:19], v[184:187], 0
  ds_read_b128 v[16:19], v12 offset:32768
  s_waitcnt lgkmcnt(3)
  v_mfma_f32_32x32x16_bf16 v[64:79], v[20:23], v[124:127], v[64:79]
  s_or_b64 vcc, vcc, s[54:55]
  s_cselect_b32 s48, 0x10000000, s48
  s_add_u32 s22, s48, 0
  s_add_u32 m0, s25, 0
  s_nop 0
  buffer_load_dwordx4 v2, s[8:11], s22 offen sc1 lds
  v_mul_f32 v32, s52, v32
  v_mul_f32 v33, s52, v33
  v_cvt_pk_bf16_f32 v32, v32, v33
  v_mfma_f32_32x32x16_bf16 v[80:95], v[20:23], v[188:191], v[80:95]
  v_mul_f32 v34, s52, v34
  v_mul_f32 v35, s52, v35
  ds_read_b128 v[20:23], v13 offset:32768
  s_waitcnt lgkmcnt(3)
  v_mfma_f32_32x32x16_bf16 v[64:79], v[24:27], v[128:131], v[64:79]
  s_add_u32 s22, s48, 1024
  s_add_u32 m0, s25, 1024
  s_nop 0
  buffer_load_dwordx4 v2, s[8:11], s22 offen sc1 lds
  v_cvt_pk_bf16_f32 v33, v34, v35
  v_mul_f32 v36, s52, v36
  v_mul_f32 v37, s52, v37
  v_mfma_f32_32x32x16_bf16 v[80:95], v[24:27], v[192:195], v[80:95]
  v_cvt_pk_bf16_f32 v34, v36, v37
  v_mul_f32 v38, s52, v38
  ds_read_b128 v[24:27], v14 offset:32768
  s_waitcnt lgkmcnt(3)
  v_mfma_f32_32x32x16_bf16 v[64:79], v[28:31], v[132:135], v[64:79]
  s_add_u32 s22, s48, 2048
  s_add_u32 m0, s25, 2048
  s_nop 0
  buffer_load_dwordx4 v2, s[8:11], s22 offen sc1 lds
  v_mul_f32 v39, s52, v39
  v_cvt_pk_bf16_f32 v35, v38, v39
  v_mul_f32 v40, s52, v40
  v_mfma_f32_32x32x16_bf16 v[80:95], v[28:31], v[196:199], v[80:95]
  v_mul_f32 v41, s52, v41
  v_cvt_pk_bf16_f32 v40, v40, v41
  ds_read_b128 v[28:31], v15 offset:32768
  s_waitcnt lgkmcnt(3)
  v_mfma_f32_32x32x16_bf16 v[64:79], v[16:19], v[136:139], v[64:79]
  s_add_u32 s22, s48, 3072
  s_add_u32 m0, s25, 3072
  s_nop 0
  buffer_load_dwordx4 v2, s[8:11], s22 offen sc1 lds
  v_mul_f32 v42, s52, v42
  v_mul_f32 v43, s52, v43
  v_cvt_pk_bf16_f32 v41, v42, v43
  v_mfma_f32_32x32x16_bf16 v[80:95], v[16:19], v[200:203], v[80:95]
  v_mul_f32 v44, s52, v44
  v_mul_f32 v45, s52, v45
  ds_read_b128 v[16:19], v8 offset:33024
  s_waitcnt lgkmcnt(3)
  v_mfma_f32_32x32x16_bf16 v[64:79], v[20:23], v[140:143], v[64:79]
  s_add_u32 s22, s48, 4096
  s_add_u32 m0, s25, 16384
  s_nop 0
  buffer_load_dwordx4 v2, s[8:11], s22 offen sc1 lds
  buffer_load_dwordx4 v[100:103], v113, s[8:11], s28 offen sc1
  v_cvt_pk_bf16_f32 v42, v44, v45
  v_mul_f32 v46, s52, v46
  v_mul_f32 v47, s52, v47
  v_mfma_f32_32x32x16_bf16 v[80:95], v[20:23], v[204:207], v[80:95]
  v_cvt_pk_bf16_f32 v43, v46, v47
  v_permlane16_swap_b32 v32, v40
  ds_read_b128 v[20:23], v9 offset:33024
  s_waitcnt lgkmcnt(3)
  v_mfma_f32_32x32x16_bf16 v[64:79], v[24:27], v[144:147], v[64:79]
  s_add_u32 s22, s48, 5120
  s_add_u32 m0, s25, 17408
  s_nop 0
  buffer_load_dwordx4 v2, s[8:11], s22 offen sc1 lds
  v_permlane16_swap_b32 v33, v41
  v_permlane16_swap_b32 v34, v42
  v_permlane16_swap_b32 v35, v43
  v_mfma_f32_32x32x16_bf16 v[80:95], v[24:27], v[208:211], v[80:95]
  v_accvgpr_write_b32 a40, v32
  v_accvgpr_write_b32 a41, v33
  ds_read_b128 v[24:27], v10 offset:33024
  s_waitcnt lgkmcnt(3)
  v_mfma_f32_32x32x16_bf16 v[64:79], v[28:31], v[148:151], v[64:79]
  s_add_u32 s22, s48, 6144
  s_add_u32 m0, s25, 18432
  s_nop 0
  buffer_load_dwordx4 v2, s[8:11], s22 offen sc1 lds
  v_accvgpr_write_b32 a42, v34
  v_accvgpr_write_b32 a43, v35
  v_accvgpr_write_b32 a96, v40
  v_mfma_f32_32x32x16_bf16 v[80:95], v[28:31], v[212:215], v[80:95]
  v_accvgpr_write_b32 a97, v41
  v_accvgpr_write_b32 a98, v42
  ds_read_b128 v[28:31], v11 offset:33024
  s_waitcnt lgkmcnt(3)
  v_mfma_f32_32x32x16_bf16 v[64:79], v[16:19], v[152:155], v[64:79]
  s_add_u32 s22, s48, 7168
  s_add_u32 m0, s25, 19456
  s_nop 0
  buffer_load_dwordx4 v2, s[8:11], s22 offen sc1 lds
  v_accvgpr_write_b32 a99, v43
  v_mul_f32 v48, s52, v48
  v_mul_f32 v49, s52, v49
  v_mfma_f32_32x32x16_bf16 v[80:95], v[16:19], v[216:219], v[80:95]
  v_cvt_pk_bf16_f32 v48, v48, v49
  v_mul_f32 v50, s52, v50
  ds_read_b128 v[16:19], v12 offset:33024
  s_waitcnt lgkmcnt(3)
  v_mfma_f32_32x32x16_bf16 v[64:79], v[20:23], v[156:159], v[64:79]
  s_add_u32 s22, s48, 8192
  s_add_u32 m0, s25, 81920
  s_nop 0
  buffer_load_dwordx4 v2, s[8:11], s22 offen sc1 lds
  v_mul_f32 v51, s52, v51
  v_cvt_pk_bf16_f32 v49, v50, v51
  v_mul_f32 v52, s52, v52
  v_mfma_f32_32x32x16_bf16 v[80:95], v[20:23], v[220:223], v[80:95]
  v_mul_f32 v53, s52, v53
  v_cvt_pk_bf16_f32 v50, v52, v53
  ds_read_b128 v[20:23], v13 offset:33024
  s_waitcnt lgkmcnt(3)
  v_mfma_f32_32x32x16_bf16 v[64:79], v[24:27], v[160:163], v[64:79]
  s_add_u32 s22, s48, 9216
  s_add_u32 m0, s25, 82944
  s_nop 0
  buffer_load_dwordx4 v2, s[8:11], s22 offen sc1 lds
  v_mul_f32 v54, s52, v54
  v_mul_f32 v55, s52, v55
  v_cvt_pk_bf16_f32 v51, v54, v55
  v_mfma_f32_32x32x16_bf16 v[80:95], v[24:27], v[224:227], v[80:95]
  v_mul_f32 v56, s52, v56
  v_mul_f32 v57, s52, v57
  ds_read_b128 v[24:27], v14 offset:33024
  s_waitcnt lgkmcnt(3)
  v_mfma_f32_32x32x16_bf16 v[64:79], v[28:31], v[164:167], v[64:79]
  s_add_u32 s22, s48, 10240
  s_add_u32 m0, s25, 83968
  s_nop 0
  buffer_load_dwordx4 v2, s[8:11], s22 offen sc1 lds
  v_cvt_pk_bf16_f32 v56, v56, v57
  v_mul_f32 v58, s52, v58
  v_mul_f32 v59, s52, v59
  v_mfma_f32_32x32x16_bf16 v[80:95], v[28:31], v[228:231], v[80:95]
  v_cvt_pk_bf16_f32 v57, v58, v59
  v_mul_f32 v60, s52, v60
  ds_read_b128 v[28:31], v15 offset:33024
  s_waitcnt lgkmcnt(3)
  v_mfma_f32_32x32x16_bf16 v[64:79], v[16:19], v[168:171], v[64:79]
  s_add_u32 s22, s48, 11264
  s_add_u32 m0, s25, 84992
  s_nop 0
  buffer_load_dwordx4 v2, s[8:11], s22 offen sc1 lds
  v_mul_f32 v61, s52, v61
  v_cvt_pk_bf16_f32 v58, v60, v61
  v_mul_f32 v62, s52, v62
  v_mfma_f32_32x32x16_bf16 v[80:95], v[16:19], v[232:235], v[80:95]
  v_mul_f32 v63, s52, v63
  v_cvt_pk_bf16_f32 v59, v62, v63
  ds_read_b128 v[16:19], v8 offset:49152
  s_waitcnt lgkmcnt(3)
  v_mfma_f32_32x32x16_bf16 v[64:79], v[20:23], v[172:175], v[64:79]
  s_add_u32 s22, s48, 12288
  s_add_u32 m0, s25, 98304
  s_nop 0
  buffer_load_dwordx4 v2, s[8:11], s22 offen sc1 lds
  v_permlane16_swap_b32 v48, v56
  v_permlane16_swap_b32 v49, v57
  v_permlane16_swap_b32 v50, v58
  v_mfma_f32_32x32x16_bf16 v[80:95], v[20:23], v[236:239], v[80:95]
  v_permlane16_swap_b32 v51, v59
  v_accvgpr_write_b32 a152, v48
  ds_read_b128 v[20:23], v9 offset:49152
  s_waitcnt lgkmcnt(3)
  v_mfma_f32_32x32x16_bf16 v[64:79], v[24:27], v[176:179], v[64:79]
  s_add_u32 s22, s48, 13312
  s_add_u32 m0, s25, 99328
  s_nop 0
  buffer_load_dwordx4 v2, s[8:11], s22 offen sc1 lds
  v_accvgpr_write_b32 a153, v49
  v_accvgpr_write_b32 a154, v50
  v_accvgpr_write_b32 a155, v51
  v_mfma_f32_32x32x16_bf16 v[80:95], v[24:27], v[240:243], v[80:95]
  v_accvgpr_write_b32 a208, v56
  v_accvgpr_write_b32 a209, v57
  ds_read_b128 v[24:27], v10 offset:49152
  s_waitcnt lgkmcnt(3)
  v_mfma_f32_32x32x16_bf16 v[64:79], v[28:31], v[180:183], v[64:79]
  v_accvgpr_write_b32 a210, v58
  v_accvgpr_write_b32 a211, v59
  v_mfma_f32_32x32x16_bf16 v[80:95], v[28:31], v[244:247], v[80:95]
  ds_read_b128 v[28:31], v11 offset:49152
  s_waitcnt lgkmcnt(3)
  v_mfma_f32_32x32x16_bf16 v[32:47], v[16:19], v[120:123], 0
  s_waitcnt vmcnt(9)
  v_cmp_ne_u64 vcc, s[88:89], v[100:101]
  v_cmp_ne_u64 s[54:55], s[88:89], v[102:103]
  s_add_u32 s49, s32, 0
  v_mfma_f32_32x32x16_bf16 v[48:63], v[16:19], v[184:187], 0
  ds_read_b128 v[16:19], v12 offset:49152
  s_waitcnt lgkmcnt(3)
  v_mfma_f32_32x32x16_bf16 v[32:47], v[20:23], v[124:127], v[32:47]
  s_or_b64 vcc, vcc, s[54:55]
  s_cselect_b32 s49, 0x10000000, s49
  s_add_u32 s22, s49, 0
  s_add_u32 m0, s25, 100352
  s_nop 0
  buffer_load_dwordx4 v2, s[8:11], s22 offen sc1 lds
  v_mul_f32 v64, s52, v64
  v_mul_f32 v65, s52, v65
  v_cvt_pk_bf16_f32 v64, v64, v65
  v_mfma_f32_32x32x16_bf16 v[48:63], v[20:23], v[188:191], v[48:63]
  v_mul_f32 v66, s52, v66
  v_mul_f32 v67, s52, v67
  ds_read_b128 v[20:23], v13 offset:49152
  s_waitcnt lgkmcnt(3)
  v_mfma_f32_32x32x16_bf16 v[32:47], v[24:27], v[128:131], v[32:47]
  s_add_u32 s22, s49, 1024
  s_add_u32 m0, s25, 101376
  s_nop 0
  buffer_load_dwordx4 v2, s[8:11], s22 offen sc1 lds
  v_cvt_pk_bf16_f32 v65, v66, v67
  v_mul_f32 v68, s52, v68
  v_mul_f32 v69, s52, v69
  v_mfma_f32_32x32x16_bf16 v[48:63], v[24:27], v[192:195], v[48:63]
  v_cvt_pk_bf16_f32 v66, v68, v69
  v_mul_f32 v70, s52, v70
  ds_read_b128 v[24:27], v14 offset:49152
  s_waitcnt lgkmcnt(3)
  v_mfma_f32_32x32x16_bf16 v[32:47], v[28:31], v[132:135], v[32:47]
  s_add_u32 s22, s49, 2048
  s_add_u32 m0, s25, 114688
  s_nop 0
  buffer_load_dwordx4 v2, s[8:11], s22 offen sc1 lds
  v_mul_f32 v71, s52, v71
  v_cvt_pk_bf16_f32 v67, v70, v71
  v_mul_f32 v72, s52, v72
  v_mfma_f32_32x32x16_bf16 v[48:63], v[28:31], v[196:199], v[48:63]
  v_mul_f32 v73, s52, v73
  v_cvt_pk_bf16_f32 v72, v72, v73
  ds_read_b128 v[28:31], v15 offset:49152
  s_waitcnt lgkmcnt(3)
  v_mfma_f32_32x32x16_bf16 v[32:47], v[16:19], v[136:139], v[32:47]
  s_add_u32 s22, s49, 3072
  s_add_u32 m0, s25, 115712
  s_nop 0
  buffer_load_dwordx4 v2, s[8:11], s22 offen sc1 lds
  v_mul_f32 v74, s52, v74
  v_mul_f32 v75, s52, v75
  v_cvt_pk_bf16_f32 v73, v74, v75
  v_mfma_f32_32x32x16_bf16 v[48:63], v[16:19], v[200:203], v[48:63]
  v_mul_f32 v76, s52, v76
  v_mul_f32 v77, s52, v77
  ds_read_b128 v[16:19], v8 offset:49408
  s_waitcnt lgkmcnt(3)
  v_mfma_f32_32x32x16_bf16 v[32:47], v[20:23], v[140:143], v[32:47]
  s_add_u32 s22, s49, 4096
  s_add_u32 m0, s25, 116736
  s_nop 0
  buffer_load_dwordx4 v2, s[8:11], s22 offen sc1 lds
  buffer_load_dwordx4 v[100:103], v113, s[8:11], s28 offen sc1
  v_cvt_pk_bf16_f32 v74, v76, v77
  v_mul_f32 v78, s52, v78
  v_mul_f32 v79, s52, v79
  v_mfma_f32_32x32x16_bf16 v[48:63], v[20:23], v[204:207], v[48:63]
  v_cvt_pk_bf16_f32 v75, v78, v79
  v_permlane16_swap_b32 v64, v72
  ds_read_b128 v[20:23], v9 offset:49408
  s_waitcnt lgkmcnt(3)
  v_mfma_f32_32x32x16_bf16 v[32:47], v[24:27], v[144:147], v[32:47]
  s_add_u32 s22, s49, 5120
  s_add_u32 m0, s25, 117760
  s_nop 0
  buffer_load_dwordx4 v2, s[8:11], s22 offen sc1 lds
  v_permlane16_swap_b32 v65, v73
  v_permlane16_swap_b32 v66, v74
  v_permlane16_swap_b32 v67, v75
  v_mfma_f32_32x32x16_bf16 v[48:63], v[24:27], v[208:211], v[48:63]
  v_accvgpr_write_b32 a44, v64
  v_accvgpr_write_b32 a45, v65
  ds_read_b128 v[24:27], v10 offset:49408
  s_waitcnt lgkmcnt(3)
  v_mfma_f32_32x32x16_bf16 v[32:47], v[28:31], v[148:151], v[32:47]
  s_add_u32 s22, s49, 6144
  s_add_u32 m0, s25, 131072
  s_nop 0
  buffer_load_dwordx4 v2, s[8:11], s22 offen sc1 lds
  v_accvgpr_write_b32 a46, v66
  v_accvgpr_write_b32 a47, v67
  v_accvgpr_write_b32 a100, v72
  v_mfma_f32_32x32x16_bf16 v[48:63], v[28:31], v[212:215], v[48:63]
  v_accvgpr_write_b32 a101, v73
  v_accvgpr_write_b32 a102, v74
  ds_read_b128 v[28:31], v11 offset:49408
  s_waitcnt lgkmcnt(3)
  v_mfma_f32_32x32x16_bf16 v[32:47], v[16:19], v[152:155], v[32:47]
  s_add_u32 s22, s49, 7168
  s_add_u32 m0, s25, 132096
  s_nop 0
  buffer_load_dwordx4 v2, s[8:11], s22 offen sc1 lds
  v_accvgpr_write_b32 a103, v75
  v_mul_f32 v80, s52, v80
  v_mul_f32 v81, s52, v81
  v_mfma_f32_32x32x16_bf16 v[48:63], v[16:19], v[216:219], v[48:63]
  v_cvt_pk_bf16_f32 v80, v80, v81
  v_mul_f32 v82, s52, v82
  ds_read_b128 v[16:19], v12 offset:49408
  s_waitcnt lgkmcnt(3)
  v_mfma_f32_32x32x16_bf16 v[32:47], v[20:23], v[156:159], v[32:47]
  s_add_u32 s22, s49, 8192
  s_add_u32 m0, s25, 133120
  s_nop 0
  buffer_load_dwordx4 v2, s[8:11], s22 offen sc1 lds
  v_mul_f32 v83, s52, v83
  v_cvt_pk_bf16_f32 v81, v82, v83
  v_mul_f32 v84, s52, v84
  v_mfma_f32_32x32x16_bf16 v[48:63], v[20:23], v[220:223], v[48:63]
  v_mul_f32 v85, s52, v85
  v_cvt_pk_bf16_f32 v82, v84, v85
  ds_read_b128 v[20:23], v13 offset:49408
  s_waitcnt lgkmcnt(3)
  v_mfma_f32_32x32x16_bf16 v[32:47], v[24:27], v[160:163], v[32:47]
  s_add_u32 s22, s49, 9216
  s_add_u32 m0, s25, 134144
  s_nop 0
  buffer_load_dwordx4 v2, s[8:11], s22 offen sc1 lds
  v_mul_f32 v86, s52, v86
  v_mul_f32 v87, s52, v87
  v_cvt_pk_bf16_f32 v83, v86, v87
  v_mfma_f32_32x32x16_bf16 v[48:63], v[24:27], v[224:227], v[48:63]
  v_mul_f32 v88, s52, v88
  v_mul_f32 v89, s52, v89
  ds_read_b128 v[24:27], v14 offset:49408
  s_waitcnt lgkmcnt(3)
  v_mfma_f32_32x32x16_bf16 v[32:47], v[28:31], v[164:167], v[32:47]
  s_add_u32 s22, s49, 10240
  s_add_u32 m0, s25, 147456
  s_nop 0
  buffer_load_dwordx4 v2, s[8:11], s22 offen sc1 lds
  v_cvt_pk_bf16_f32 v88, v88, v89
  v_mul_f32 v90, s52, v90
  v_mul_f32 v91, s52, v91
  v_mfma_f32_32x32x16_bf16 v[48:63], v[28:31], v[228:231], v[48:63]
  v_cvt_pk_bf16_f32 v89, v90, v91
  v_mul_f32 v92, s52, v92
  ds_read_b128 v[28:31], v15 offset:49408
  s_waitcnt lgkmcnt(3)
  v_mfma_f32_32x32x16_bf16 v[32:47], v[16:19], v[168:171], v[32:47]
  s_add_u32 s22, s49, 11264
  s_add_u32 m0, s25, 148480
  s_nop 0
  buffer_load_dwordx4 v2, s[8:11], s22 offen sc1 lds
  v_mul_f32 v93, s52, v93
  v_cvt_pk_bf16_f32 v90, v92, v93
  v_mul_f32 v94, s52, v94
  v_mfma_f32_32x32x16_bf16 v[48:63], v[16:19], v[232:235], v[48:63]
  v_mul_f32 v95, s52, v95
  v_cvt_pk_bf16_f32 v91, v94, v95
  v_xor_b32 v8, 65536, v8
  ds_read_b128 v[16:19], v8 offset:0
  s_waitcnt lgkmcnt(3)
  v_mfma_f32_32x32x16_bf16 v[32:47], v[20:23], v[172:175], v[32:47]
  s_add_u32 s22, s49, 12288
  s_add_u32 m0, s25, 149504
  s_nop 0
  buffer_load_dwordx4 v2, s[8:11], s22 offen sc1 lds
  v_permlane16_swap_b32 v80, v88
  v_permlane16_swap_b32 v81, v89
  v_permlane16_swap_b32 v82, v90
  v_mfma_f32_32x32x16_bf16 v[48:63], v[20:23], v[236:239], v[48:63]
  v_permlane16_swap_b32 v83, v91
  v_accvgpr_write_b32 a156, v80
  v_xor_b32 v9, 65536, v9
  ds_read_b128 v[20:23], v9 offset:0
  s_waitcnt lgkmcnt(3)
  v_mfma_f32_32x32x16_bf16 v[32:47], v[24:27], v[176:179], v[32:47]
  s_add_u32 s22, s49, 13312
  s_add_u32 m0, s25, 150528
  s_nop 0
  buffer_load_dwordx4 v2, s[8:11], s22 offen sc1 lds
  v_accvgpr_write_b32 a157, v81
  v_accvgpr_write_b32 a158, v82
  v_accvgpr_write_b32 a159, v83
  v_mfma_f32_32x32x16_bf16 v[48:63], v[24:27], v[240:243], v[48:63]
  v_accvgpr_write_b32 a212, v88
  v_accvgpr_write_b32 a213, v89
  v_xor_b32 v10, 65536, v10
  ds_read_b128 v[24:27], v10 offset:0
  s_waitcnt lgkmcnt(3)
  v_mfma_f32_32x32x16_bf16 v[32:47], v[28:31], v[180:183], v[32:47]
  v_accvgpr_write_b32 a214, v90
  v_accvgpr_write_b32 a215, v91
  v_mfma_f32_32x32x16_bf16 v[48:63], v[28:31], v[244:247], v[48:63]
  s_barrier
  v_xor_b32 v11, 65536, v11
  ds_read_b128 v[28:31], v11 offset:0
  s_waitcnt lgkmcnt(3)
  v_mfma_f32_32x32x16_bf16 v[64:79], v[16:19], v[120:123], 0
  s_waitcnt vmcnt(9)
  v_cmp_ne_u64 vcc, s[88:89], v[100:101]
  v_cmp_ne_u64 s[54:55], s[88:89], v[102:103]
  s_add_u32 s50, s33, 0
  v_mfma_f32_32x32x16_bf16 v[80:95], v[16:19], v[184:187], 0
  v_xor_b32 v12, 65536, v12
  ds_read_b128 v[16:19], v12 offset:0
  s_waitcnt lgkmcnt(3)
  v_mfma_f32_32x32x16_bf16 v[64:79], v[20:23], v[124:127], v[64:79]
  s_or_b64 vcc, vcc, s[54:55]
  s_cselect_b32 s50, 0x10000000, s50
  s_add_u32 s22, s50, 0
  buffer_load_dwordx4 a[224:227], v2, s[8:11], s22 offen sc1
  v_mul_f32 v32, s52, v32
  v_mul_f32 v33, s52, v33
  v_cvt_pk_bf16_f32 v32, v32, v33
  v_mfma_f32_32x32x16_bf16 v[80:95], v[20:23], v[188:191], v[80:95]
  v_mul_f32 v34, s52, v34
  v_mul_f32 v35, s52, v35
  v_xor_b32 v13, 65536, v13
  ds_read_b128 v[20:23], v13 offset:0
  s_waitcnt lgkmcnt(3)
  v_mfma_f32_32x32x16_bf16 v[64:79], v[24:27], v[128:131], v[64:79]
  s_add_u32 s22, s50, 1024
  buffer_load_dwordx4 a[228:231], v2, s[8:11], s22 offen sc1
  v_cvt_pk_bf16_f32 v33, v34, v35
  v_mul_f32 v36, s52, v36
  v_mul_f32 v37, s52, v37
  v_mfma_f32_32x32x16_bf16 v[80:95], v[24:27], v[192:195], v[80:95]
  v_cvt_pk_bf16_f32 v34, v36, v37
  v_mul_f32 v38, s52, v38
  v_xor_b32 v14, 65536, v14
  ds_read_b128 v[24:27], v14 offset:0
  s_waitcnt lgkmcnt(3)
  v_mfma_f32_32x32x16_bf16 v[64:79], v[28:31], v[132:135], v[64:79]
  s_add_u32 s22, s50, 2048
  buffer_load_dwordx4 a[232:235], v2, s[8:11], s22 offen sc1
  v_mul_f32 v39, s52, v39
  v_cvt_pk_bf16_f32 v35, v38, v39
  v_mul_f32 v40, s52, v40
  v_mfma_f32_32x32x16_bf16 v[80:95], v[28:31], v[196:199], v[80:95]
  v_mul_f32 v41, s52, v41
  v_cvt_pk_bf16_f32 v40, v40, v41
  v_xor_b32 v15, 65536, v15
  ds_read_b128 v[28:31], v15 offset:0
  s_waitcnt lgkmcnt(3)
  v_mfma_f32_32x32x16_bf16 v[64:79], v[16:19], v[136:139], v[64:79]
  s_add_u32 s22, s50, 3072
  buffer_load_dwordx4 a[236:239], v2, s[8:11], s22 offen sc1
  v_mul_f32 v42, s52, v42
  v_mul_f32 v43, s52, v43
  v_cvt_pk_bf16_f32 v41, v42, v43
  v_mfma_f32_32x32x16_bf16 v[80:95], v[16:19], v[200:203], v[80:95]
  v_mul_f32 v44, s52, v44
  v_mul_f32 v45, s52, v45
  ds_read_b128 v[16:19], v8 offset:256
  s_waitcnt lgkmcnt(3)
  v_mfma_f32_32x32x16_bf16 v[64:79], v[20:23], v[140:143], v[64:79]
  s_add_u32 s22, s50, 4096
  buffer_load_dwordx4 a[240:243], v2, s[8:11], s22 offen sc1
  v_cvt_pk_bf16_f32 v42, v44, v45
  v_mul_f32 v46, s52, v46
  v_mul_f32 v47, s52, v47
  v_mfma_f32_32x32x16_bf16 v[80:95], v[20:23], v[204:207], v[80:95]
  v_cvt_pk_bf16_f32 v43, v46, v47
  v_permlane16_swap_b32 v32, v40
  ds_read_b128 v[20:23], v9 offset:256
  s_waitcnt lgkmcnt(3)
  v_mfma_f32_32x32x16_bf16 v[64:79], v[24:27], v[144:147], v[64:79]
  s_add_u32 s22, s50, 5120
  buffer_load_dwordx4 a[244:247], v2, s[8:11], s22 offen sc1
  v_permlane16_swap_b32 v33, v41
  v_permlane16_swap_b32 v34, v42
  v_permlane16_swap_b32 v35, v43
  v_mfma_f32_32x32x16_bf16 v[80:95], v[24:27], v[208:211], v[80:95]
  v_accvgpr_write_b32 a48, v32
  v_accvgpr_write_b32 a49, v33
  ds_read_b128 v[24:27], v10 offset:256
  s_waitcnt lgkmcnt(3)
  v_mfma_f32_32x32x16_bf16 v[64:79], v[28:31], v[148:151], v[64:79]
  s_add_u32 s22, s50, 6144
  buffer_load_dwordx4 a[248:251], v2, s[8:11], s22 offen sc1
  v_accvgpr_write_b32 a50, v34
  v_accvgpr_write_b32 a51, v35
  v_accvgpr_write_b32 a104, v40
  v_mfma_f32_32x32x16_bf16 v[80:95], v[28:31], v[212:215], v[80:95]
  v_accvgpr_write_b32 a105, v41
  v_accvgpr_write_b32 a106, v42
  ds_read_b128 v[28:31], v11 offset:256
  s_waitcnt lgkmcnt(3)
  v_mfma_f32_32x32x16_bf16 v[64:79], v[16:19], v[152:155], v[64:79]
  s_add_u32 s22, s50, 7168
  buffer_load_dwordx4 a[252:255], v2, s[8:11], s22 offen sc1
  v_accvgpr_write_b32 a107, v43
  v_mul_f32 v48, s52, v48
  v_mul_f32 v49, s52, v49
  v_mfma_f32_32x32x16_bf16 v[80:95], v[16:19], v[216:219], v[80:95]
  v_cvt_pk_bf16_f32 v48, v48, v49
  v_mul_f32 v50, s52, v50
  ds_read_b128 v[16:19], v12 offset:256
  s_waitcnt lgkmcnt(3)
  v_mfma_f32_32x32x16_bf16 v[64:79], v[20:23], v[156:159], v[64:79]
  s_add_u32 s22, s50, 8192
  s_add_u32 m0, s25, 32768
  s_nop 0
  buffer_load_dwordx4 v2, s[8:11], s22 offen sc1 lds
  v_mul_f32 v51, s52, v51
  v_cvt_pk_bf16_f32 v49, v50, v51
  v_mul_f32 v52, s52, v52
  v_mfma_f32_32x32x16_bf16 v[80:95], v[20:23], v[220:223], v[80:95]
  v_mul_f32 v53, s52, v53
  v_cvt_pk_bf16_f32 v50, v52, v53
  ds_read_b128 v[20:23], v13 offset:256
  s_waitcnt lgkmcnt(3)
  v_mfma_f32_32x32x16_bf16 v[64:79], v[24:27], v[160:163], v[64:79]
  s_add_u32 s22, s50, 9216
  s_add_u32 m0, s25, 33792
  s_nop 0
  buffer_load_dwordx4 v2, s[8:11], s22 offen sc1 lds
  v_mul_f32 v54, s52, v54
  v_mul_f32 v55, s52, v55
  v_cvt_pk_bf16_f32 v51, v54, v55
  v_mfma_f32_32x32x16_bf16 v[80:95], v[24:27], v[224:227], v[80:95]
  v_mul_f32 v56, s52, v56
  v_mul_f32 v57, s52, v57
  ds_read_b128 v[24:27], v14 offset:256
  s_waitcnt lgkmcnt(3)
  v_mfma_f32_32x32x16_bf16 v[64:79], v[28:31], v[164:167], v[64:79]
  s_add_u32 s22, s50, 10240
  s_add_u32 m0, s25, 34816
  s_nop 0
  buffer_load_dwordx4 v2, s[8:11], s22 offen sc1 lds
  v_cvt_pk_bf16_f32 v56, v56, v57
  v_mul_f32 v58, s52, v58
  v_mul_f32 v59, s52, v59
  v_mfma_f32_32x32x16_bf16 v[80:95], v[28:31], v[228:231], v[80:95]
  v_cvt_pk_bf16_f32 v57, v58, v59
  v_mul_f32 v60, s52, v60
  ds_read_b128 v[28:31], v15 offset:256
  s_waitcnt lgkmcnt(3)
  v_mfma_f32_32x32x16_bf16 v[64:79], v[16:19], v[168:171], v[64:79]
  s_add_u32 s22, s50, 11264
  s_add_u32 m0, s25, 35840
  s_nop 0
  buffer_load_dwordx4 v2, s[8:11], s22 offen sc1 lds
  v_mul_f32 v61, s52, v61
  v_cvt_pk_bf16_f32 v58, v60, v61
  v_mul_f32 v62, s52, v62
  v_mfma_f32_32x32x16_bf16 v[80:95], v[16:19], v[232:235], v[80:95]
  v_mul_f32 v63, s52, v63
  v_cvt_pk_bf16_f32 v59, v62, v63
  s_waitcnt lgkmcnt(2)
  v_mfma_f32_32x32x16_bf16 v[64:79], v[20:23], v[172:175], v[64:79]
  s_add_u32 s22, s50, 12288
  s_add_u32 m0, s25, 49152
  s_nop 0
  buffer_load_dwordx4 v2, s[8:11], s22 offen sc1 lds
  v_permlane16_swap_b32 v48, v56
  v_permlane16_swap_b32 v49, v57
  v_permlane16_swap_b32 v50, v58
  v_mfma_f32_32x32x16_bf16 v[80:95], v[20:23], v[236:239], v[80:95]
  v_permlane16_swap_b32 v51, v59
  v_accvgpr_write_b32 a160, v48
  s_waitcnt lgkmcnt(1)
  v_mfma_f32_32x32x16_bf16 v[64:79], v[24:27], v[176:179], v[64:79]
  s_add_u32 s22, s50, 13312
  s_add_u32 m0, s25, 50176
  s_nop 0
  buffer_load_dwordx4 v2, s[8:11], s22 offen sc1 lds
  v_accvgpr_write_b32 a161, v49
  v_accvgpr_write_b32 a162, v50
  v_accvgpr_write_b32 a163, v51
  v_mfma_f32_32x32x16_bf16 v[80:95], v[24:27], v[240:243], v[80:95]
  v_accvgpr_write_b32 a216, v56
  v_accvgpr_write_b32 a217, v57
  s_waitcnt lgkmcnt(0)
  v_mfma_f32_32x32x16_bf16 v[64:79], v[28:31], v[180:183], v[64:79]
  buffer_load_dwordx4 v[100:103], v113, s[8:11], s28 offen sc1
  buffer_load_dwordx4 v[104:107], v2, s[8:11], s29 offen sc1
  buffer_load_dwordx4 v[108:111], v112, s[8:11], s29 offen sc1
  v_accvgpr_write_b32 a218, v58
  v_accvgpr_write_b32 a219, v59
  v_mfma_f32_32x32x16_bf16 v[80:95], v[28:31], v[244:247], v[80:95]
  s_nop 4
  v_mul_f32 v64, s52, v64
  v_mul_f32 v65, s52, v65
  v_cvt_pk_bf16_f32 v64, v64, v65
  v_mul_f32 v66, s52, v66
  v_mul_f32 v67, s52, v67
  v_cvt_pk_bf16_f32 v65, v66, v67
  v_mul_f32 v68, s52, v68
  v_mul_f32 v69, s52, v69
  v_cvt_pk_bf16_f32 v66, v68, v69
  v_mul_f32 v70, s52, v70
  v_mul_f32 v71, s52, v71
  v_cvt_pk_bf16_f32 v67, v70, v71
  v_mul_f32 v72, s52, v72
  v_mul_f32 v73, s52, v73
  v_cvt_pk_bf16_f32 v72, v72, v73
  v_mul_f32 v74, s52, v74
  v_mul_f32 v75, s52, v75
  v_cvt_pk_bf16_f32 v73, v74, v75
  v_mul_f32 v76, s52, v76
  v_mul_f32 v77, s52, v77
  v_cvt_pk_bf16_f32 v74, v76, v77
  v_mul_f32 v78, s52, v78
  v_mul_f32 v79, s52, v79
  v_cvt_pk_bf16_f32 v75, v78, v79
  v_permlane16_swap_b32 v64, v72
  v_permlane16_swap_b32 v65, v73
  v_permlane16_swap_b32 v66, v74
  v_permlane16_swap_b32 v67, v75
  v_accvgpr_write_b32 a52, v64
  v_accvgpr_write_b32 a53, v65
  v_accvgpr_write_b32 a54, v66
  v_accvgpr_write_b32 a55, v67
  v_accvgpr_write_b32 a108, v72
  v_accvgpr_write_b32 a109, v73
  v_accvgpr_write_b32 a110, v74
  v_accvgpr_write_b32 a111, v75
  v_mul_f32 v80, s52, v80
  v_mul_f32 v81, s52, v81
  v_cvt_pk_bf16_f32 v80, v80, v81
  v_mul_f32 v82, s52, v82
  v_mul_f32 v83, s52, v83
  v_cvt_pk_bf16_f32 v81, v82, v83
  v_mul_f32 v84, s52, v84
  v_mul_f32 v85, s52, v85
  v_cvt_pk_bf16_f32 v82, v84, v85
  v_mul_f32 v86, s52, v86
  v_mul_f32 v87, s52, v87
  v_cvt_pk_bf16_f32 v83, v86, v87
  v_mul_f32 v88, s52, v88
  v_mul_f32 v89, s52, v89
  v_cvt_pk_bf16_f32 v88, v88, v89
  v_mul_f32 v90, s52, v90
  v_mul_f32 v91, s52, v91
  v_cvt_pk_bf16_f32 v89, v90, v91
  v_mul_f32 v92, s52, v92
  v_mul_f32 v93, s52, v93
  v_cvt_pk_bf16_f32 v90, v92, v93
  v_mul_f32 v94, s52, v94
  v_mul_f32 v95, s52, v95
  v_cvt_pk_bf16_f32 v91, v94, v95
  v_permlane16_swap_b32 v80, v88
  v_permlane16_swap_b32 v81, v89
  v_permlane16_swap_b32 v82, v90
  v_permlane16_swap_b32 v83, v91
  v_accvgpr_write_b32 a164, v80
  v_accvgpr_write_b32 a165, v81
  v_accvgpr_write_b32 a166, v82
  v_accvgpr_write_b32 a167, v83
  v_accvgpr_write_b32 a220, v88
  v_accvgpr_write_b32 a221, v89
  v_accvgpr_write_b32 a222, v90
  v_accvgpr_write_b32 a223, v91
  s_mov_b32 s30, 0
  s_branch sc_aw_w
sc_aw:
  buffer_load_dwordx4 v[100:103], v113, s[8:11], s28 offen sc1
  buffer_load_dwordx4 v[104:107], v2, s[8:11], s29 offen sc1
  buffer_load_dwordx4 v[108:111], v112, s[8:11], s29 offen sc1
sc_aw_w:
  s_waitcnt vmcnt(0)
  v_cmp_ne_u64 vcc, s[88:89], v[100:101]
  s_cbranch_vccnz sc_aw_no
  v_cmp_ne_u64 vcc, s[88:89], v[102:103]
  s_cbranch_vccnz sc_aw_no
  v_cmp_ne_u64 vcc, s[88:89], v[104:105]
  s_cbranch_vccnz sc_aw_no
  v_cmp_ne_u64 vcc, s[88:89], v[106:107]
  s_cbranch_vccnz sc_aw_no
  v_cmp_ne_u64 vcc, s[88:89], v[108:109]
  s_cbranch_vccnz sc_aw_no
  v_cmp_ne_u64 vcc, s[88:89], v[110:111]
  s_cbranch_vccnz sc_aw_no
  s_branch sc_aw_ok
sc_aw_no:
  s_sleep 1
  s_add_u32 s30, s30, 1
  s_cmp_lt_u32 s30, 50000
  s_cbranch_scc1 sc_aw
  s_branch cA_abort
sc_aw_ok:
  v_add_u32 v4, s25, v2
  v_add_u32 v5, 0x10000, v4
  v_add_u32 v6, 0x20000, v4
  s_cmp_eq_u32 s48, 0x10000000
  s_cbranch_scc1 sc_d0
  ds_read_b128 v[144:147], v4 offset:0
  ds_read_b128 v[148:151], v4 offset:1024
  ds_read_b128 v[152:155], v4 offset:2048
  ds_read_b128 v[156:159], v4 offset:3072
  ds_read_b128 v[160:163], v4 offset:16384
  ds_read_b128 v[164:167], v4 offset:17408
  ds_read_b128 v[168:171], v4 offset:18432
  ds_read_b128 v[172:175], v4 offset:19456
  ds_read_b128 v[176:179], v5 offset:16384
  ds_read_b128 v[180:183], v5 offset:17408
  ds_read_b128 v[184:187], v5 offset:18432
  ds_read_b128 v[188:191], v5 offset:19456
  ds_read_b128 v[192:195], v5 offset:32768
  ds_read_b128 v[196:199], v5 offset:33792
  s_waitcnt lgkmcnt(0)
  s_branch sc_e0
sc_d0:
  s_add_u32 s22, s33, 12288
  buffer_load_dwordx4 v[144:147], v2, s[8:11], s22 offen offset:2048 sc1
  buffer_load_dwordx4 v[148:151], v2, s[8:11], s22 offen offset:3072 sc1
  s_add_u32 s22, s33, 16384
  buffer_load_dwordx4 v[152:155], v2, s[8:11], s22 offen offset:0 sc1
  buffer_load_dwordx4 v[156:159], v2, s[8:11], s22 offen offset:1024 sc1
  buffer_load_dwordx4 v[160:163], v2, s[8:11], s22 offen offset:2048 sc1
  buffer_load_dwordx4 v[164:167], v2, s[8:11], s22 offen offset:3072 sc1
  s_add_u32 s22, s33, 20480
  buffer_load_dwordx4 v[168:171], v2, s[8:11], s22 offen offset:0 sc1
  buffer_load_dwordx4 v[172:175], v2, s[8:11], s22 offen offset:1024 sc1
  buffer_load_dwordx4 v[176:179], v2, s[8:11], s22 offen offset:2048 sc1
  buffer_load_dwordx4 v[180:183], v2, s[8:11], s22 offen offset:3072 sc1
  s_add_u32 s22, s33, 24576
  buffer_load_dwordx4 v[184:187], v2, s[8:11], s22 offen offset:0 sc1
  buffer_load_dwordx4 v[188:191], v2, s[8:11], s22 offen offset:1024 sc1
  buffer_load_dwordx4 v[192:195], v2, s[8:11], s22 offen offset:2048 sc1
  buffer_load_dwordx4 v[196:199], v2, s[8:11], s22 offen offset:3072 sc1
sc_e0:
  s_cmp_eq_u32 s49, 0x10000000
  s_cbranch_scc1 sc_d1
  ds_read_b128 v[200:203], v5 offset:34816
  ds_read_b128 v[204:207], v5 offset:35840
  ds_read_b128 v[208:211], v5 offset:49152
  ds_read_b128 v[212:215], v5 offset:50176
  ds_read_b128 v[216:219], v5 offset:51200
  ds_read_b128 v[220:223], v5 offset:52224
  ds_read_b128 v[224:227], v6 offset:0
  ds_read_b128 v[228:231], v6 offset:1024
  ds_read_b128 v[232:235], v6 offset:2048
  ds_read_b128 v[236:239], v6 offset:3072
  ds_read_b128 v[240:243], v6 offset:16384
  ds_read_b128 v[244:247], v6 offset:17408
  ds_read_b128 v[248:251], v6 offset:18432
  ds_read_b128 v[252:255], v6 offset:19456
  s_waitcnt lgkmcnt(0)
  s_branch sc_e1
sc_d1:
  s_add_u32 s22, s32, 0
  buffer_load_dwordx4 v[200:203], v2, s[8:11], s22 offen offset:0 sc1
  buffer_load_dwordx4 v[204:207], v2, s[8:11], s22 offen offset:1024 sc1
  buffer_load_dwordx4 v[208:211], v2, s[8:11], s22 offen offset:2048 sc1
  buffer_load_dwordx4 v[212:215], v2, s[8:11], s22 offen offset:3072 sc1
  s_add_u32 s22, s32, 4096
  buffer_load_dwordx4 v[216:219], v2, s[8:11], s22 offen offset:0 sc1
  buffer_load_dwordx4 v[220:223], v2, s[8:11], s22 offen offset:1024 sc1
  buffer_load_dwordx4 v[224:227], v2, s[8:11], s22 offen offset:2048 sc1
  buffer_load_dwordx4 v[228:231], v2, s[8:11], s22 offen offset:3072 sc1
  s_add_u32 s22, s32, 8192
  buffer_load_dwordx4 v[232:235], v2, s[8:11], s22 offen offset:0 sc1
  buffer_load_dwordx4 v[236:239], v2, s[8:11], s22 offen offset:1024 sc1
  buffer_load_dwordx4 v[240:243], v2, s[8:11], s22 offen offset:2048 sc1
  buffer_load_dwordx4 v[244:247], v2, s[8:11], s22 offen offset:3072 sc1
  s_add_u32 s22, s32, 12288
  buffer_load_dwordx4 v[248:251], v2, s[8:11], s22 offen offset:0 sc1
  buffer_load_dwordx4 v[252:255], v2, s[8:11], s22 offen offset:1024 sc1
sc_e1:
  s_cmp_eq_u32 s50, 0x10000000
  s_cbranch_scc1 sc_d2
  ds_read_b128 v[120:123], v4 offset:32768
  ds_read_b128 v[124:127], v4 offset:33792
  ds_read_b128 v[128:131], v4 offset:34816
  ds_read_b128 v[132:135], v4 offset:35840
  ds_read_b128 v[136:139], v4 offset:49152
  ds_read_b128 v[140:143], v4 offset:50176
  s_waitcnt lgkmcnt(0)
  s_branch sc_e2
sc_d2:
  s_add_u32 s22, s33, 0
  buffer_load_dwordx4 a[224:227], v2, s[8:11], s22 offen offset:0 sc1
  buffer_load_dwordx4 a[228:231], v2, s[8:11], s22 offen offset:1024 sc1
  buffer_load_dwordx4 a[232:235], v2, s[8:11], s22 offen offset:2048 sc1
  buffer_load_dwordx4 a[236:239], v2, s[8:11], s22 offen offset:3072 sc1
  s_add_u32 s22, s33, 4096
  buffer_load_dwordx4 a[240:243], v2, s[8:11], s22 offen offset:0 sc1
  buffer_load_dwordx4 a[244:247], v2, s[8:11], s22 offen offset:1024 sc1
  buffer_load_dwordx4 a[248:251], v2, s[8:11], s22 offen offset:2048 sc1
  buffer_load_dwordx4 a[252:255], v2, s[8:11], s22 offen offset:3072 sc1
  s_add_u32 s22, s33, 8192
  buffer_load_dwordx4 v[120:123], v2, s[8:11], s22 offen offset:0 sc1
  buffer_load_dwordx4 v[124:127], v2, s[8:11], s22 offen offset:1024 sc1
  buffer_load_dwordx4 v[128:131], v2, s[8:11], s22 offen offset:2048 sc1
  buffer_load_dwordx4 v[132:135], v2, s[8:11], s22 offen offset:3072 sc1
  s_add_u32 s22, s33, 12288
  buffer_load_dwordx4 v[136:139], v2, s[8:11], s22 offen offset:0 sc1
  buffer_load_dwordx4 v[140:143], v2, s[8:11], s22 offen offset:1024 sc1
sc_e2:
  s_barrier
  s_branch m_role
m_val:
  s_cmp_lg_u32 s16, 0
  s_cbranch_scc1 w0_6
  v_mov_b32 v233, 128
  v_mov_b32 v234, s88
  v_mov_b32 v235, s89
  v_mov_b32 v236, 0
  v_mov_b32 v237, 0
  s_mov_b64 exec, 1
  buffer_atomic_cmpswap_x2 v[234:237], v233, s[12:15], 0 offen sc0
  s_mov_b64 exec, -1
w0_6:
  s_cmp_lg_u32 s66, 0
  s_cbranch_scc1 va_ci
  s_cmp_lg_u32 s16, 0
  s_cbranch_scc1 w0_7
  s_lshr_b32 s70, s3, 5
  s_and_b32 s71, s70, 4
  s_mul_i32 s71, s71, 12
  s_lshl_b32 s70, s70, 2
  s_add_u32 s70, s70, s71
  s_lshl_b32 s71, 1, s3
  v_mov_b32 v242, s71
  v_mov_b32 v243, 32
  s_mov_b64 exec, 1
  buffer_atomic_or v242, v243, s[12:15], s70 offen sc0
  buffer_load_dwordx2 v[244:245], v243, s[12:15], 0 offen offset:96 sc1
  s_mov_b64 exec, -1
w0_7:
va_ci:
  s_mov_b32 s56, s40
  s_and_b32 s57, s41, 0xffff
  s_mov_b32 s58, 3670016
  s_mov_b32 s59, 0x20000
  v_lshrrev_b32 v24, 5, v1
  v_and_b32 v25, 31, v1
  v_lshlrev_b32 v25, 4, v25
  v_lshl_add_u32 v24, v24, 13, v25
  s_mov_b32 s60, s42
  s_and_b32 s61, s43, 0xffff
  s_mov_b32 s62, 3670016
  s_mov_b32 s63, 0x20000
  s_lshl_b32 s22, s17, 9
  s_lshl_b32 s23, s16, 19
  s_add_u32 s23, s22, s23
  s_add_u32 s21, s23, 262144
  buffer_load_dwordx4 v[28:31], v24, s[60:63], s21 offen
  s_add_u32 s21, s23, 278528
  buffer_load_dwordx4 v[28:31], v24, s[60:63], s21 offen
  s_add_u32 s21, s23, 294912
  buffer_load_dwordx4 v[28:31], v24, s[60:63], s21 offen
  s_add_u32 s21, s23, 311296
  buffer_load_dwordx4 v[28:31], v24, s[60:63], s21 offen
  s_add_u32 s21, s23, 327680
  buffer_load_dwordx4 v[28:31], v24, s[60:63], s21 offen
  s_add_u32 s21, s23, 344064
  buffer_load_dwordx4 v[28:31], v24, s[60:63], s21 offen
  s_add_u32 s21, s23, 360448
  buffer_load_dwordx4 v[28:31], v24, s[60:63], s21 offen
  s_add_u32 s21, s23, 376832
  buffer_load_dwordx4 v[28:31], v24, s[60:63], s21 offen
  s_add_u32 s21, s23, 393216
  buffer_load_dwordx4 v[28:31], v24, s[60:63], s21 offen
  s_add_u32 s21, s23, 409600
  buffer_load_dwordx4 v[28:31], v24, s[60:63], s21 offen
  s_add_u32 s21, s23, 425984
  buffer_load_dwordx4 v[28:31], v24, s[60:63], s21 offen
  s_add_u32 s21, s23, 442368
  buffer_load_dwordx4 v[28:31], v24, s[60:63], s21 offen
  s_add_u32 s21, s23, 458752
  buffer_load_dwordx4 v[28:31], v24, s[60:63], s21 offen
  s_add_u32 s21, s23, 475136
  buffer_load_dwordx4 v[28:31], v24, s[60:63], s21 offen
  s_add_u32 s21, s23, 491520
  buffer_load_dwordx4 v[28:31], v24, s[60:63], s21 offen
  s_add_u32 s21, s23, 507904
  buffer_load_dwordx4 v[28:31], v24, s[60:63], s21 offen
  s_lshl_b32 s23, s16, 14
  s_add_u32 s22, s22, s23
  s_mov_b32 s30, 0
va_pf:
  buffer_load_dwordx4 v[28:31], v24, s[56:59], s22 offen
  s_waitcnt vmcnt(40)
  s_add_u32 s22, s22, 65536
  s_add_u32 s30, s30, 1
  s_cmp_lt_u32 s30, 56
  s_cbranch_scc1 va_pf
  s_cmp_lg_u32 s66, 0
  s_cbranch_scc1 va_cf
  s_cmp_lg_u32 s16, 0
  s_cbranch_scc1 w0_8
  s_waitcnt vmcnt(40)
  v_readfirstlane_b32 s70, v244
  s_cmp_lg_u32 s70, 0
  s_cbranch_scc1 va_nz
  v_mov_b32 v243, 128
  v_mov_b32 v244, s88
  v_mov_b32 v245, s89
  v_mov_b32 v246, 0
  v_mov_b32 v247, 0
  s_mov_b64 exec, 1
  buffer_atomic_cmpswap_x2 v[244:247], v243, s[12:15], 0 offen sc0
  s_mov_b64 exec, -1
  s_waitcnt vmcnt(0)
  v_readfirstlane_b32 s70, v244
  s_cmp_lg_u32 s70, 0
  s_cbranch_scc1 va_nz
  v_mov_b32 v244, s88
  v_mov_b32 v245, s89
va_nz:
w0_8:
  v_mov_b32 v243, 160000
  s_add_u32 s101, s101, 1
  s_barrier
  s_mov_b64 exec, 1
  s_cmp_lg_u32 s16, 0
  s_cbranch_scc1 w0_9
  ds_write_b32 v243, v242 offset:0
  ds_write_b32 v243, v244 offset:4
  ds_write_b32 v243, v245 offset:8
  s_waitcnt lgkmcnt(0)
  v_mov_b32 v242, s101
  ds_write_b32 v243, v242 offset:16
  s_waitcnt lgkmcnt(0)
w0_9:
  s_mov_b64 exec, -1
  s_barrier
  ds_read_b32 v242, v243 offset:0
  ds_read_b32 v244, v243 offset:4
  ds_read_b32 v245, v243 offset:8
  ds_read_b32 v243, v243 offset:16
  s_waitcnt lgkmcnt(0)
  v_readfirstlane_b32 s70, v242
  v_readfirstlane_b32 s88, v244
  v_readfirstlane_b32 s89, v245
  v_cmp_ne_u32 vcc, s101, v243
  s_cbranch_vccnz ch_end
  s_mov_b32 s66, 1
  s_bitcmp1_b32 s70, s3
  s_cbranch_scc1 m_reclaim
va_cf:
  s_cmp_lg_u32 s16, 0
  s_cbranch_scc1 w0_10
  s_cmp_eq_u32 s67, 0
  s_cselect_b32 s20, 1, 0x10001
  v_mov_b32 v242, s20
  v_mov_b32 v243, 0
  s_mov_b64 exec, 1
  buffer_atomic_add v242, v243, s[12:15], 0 offen
  s_mov_b64 exec, -1
w0_10:
m_role:
  s_mov_b32 s17, s3
  v_and_b32 v1, 63, v0
  v_lshlrev_b32 v2, 4, v1
  v_lshrrev_b32 v116, 4, v1
  v_and_b32 v117, 15, v1
  v_mov_b32 v3, 0x4444
  v_mov_b32 v118, 0xeeee
  v_cmp_lt_u32 vcc, 7, v117
  s_nop 1
  v_cndmask_b32 v3, v3, v118, vcc
  s_mov_b32 s19, 0
  s_mov_b32 s20, 75235328
  s_lshr_b32 s22, s17, 4
  s_lshl_b32 s22, s22, 2
  s_add_u32 s22, s22, s16
  s_and_b32 s17, s17, 15
  s_cmp_eq_u32 s22, 0
  s_cbranch_scc1 ch_init0
  s_cmp_eq_u32 s22, 1
  s_cbranch_scc1 ch_init1
  s_cmp_eq_u32 s22, 2
  s_cbranch_scc1 ch_init2
  s_cmp_eq_u32 s22, 3
  s_cbranch_scc1 ch_init3
  s_cmp_eq_u32 s22, 4
  s_cbranch_scc1 ch_init4
  s_cmp_eq_u32 s22, 5
  s_cbranch_scc1 ch_init5
  s_cmp_eq_u32 s22, 6
  s_cbranch_scc1 ch_init6
  s_cmp_eq_u32 s22, 7
  s_cbranch_scc1 ch_init7
  s_branch ch_end
ch_init0:
  s_mul_i32 s31, s17, 401408
  s_add_u32 s31, s31, 0
  s_mov_b32 s24, 71565312
  s_mov_b32 s25, 0
  s_add_u32 m0, s25, 0
  s_nop 0
  buffer_load_dwordx4 v2, s[8:11], s24 offen offset:0 sc1 lds
  buffer_load_dwordx4 v2, s[8:11], s24 offen offset:1024 sc1 lds
  buffer_load_dwordx4 v2, s[8:11], s24 offen offset:2048 sc1 lds
  buffer_load_dwordx4 v2, s[8:11], s24 offen offset:3072 sc1 lds
  s_add_u32 m0, s25, 4096
  s_add_u32 s22, s24, 4096
  buffer_load_dwordx4 v2, s[8:11], s22 offen offset:0 sc1 lds
  buffer_load_dwordx4 v2, s[8:11], s22 offen offset:1024 sc1 lds
  buffer_load_dwordx4 v2, s[8:11], s22 offen offset:2048 sc1 lds
  v_and_b32 v64, 7, v117
  v_and_b32 v65, 1, v116
  v_lshlrev_b32 v65, 2, v65
  v_sub_u32 v64, v64, v65
  v_lshrrev_b32 v65, 3, v117
  v_lshl_add_u32 v66, v65, 2, v64
  v_cmp_gt_u32 vcc, 4, v64
  v_mov_b32 v67, 99
  s_nop 0
  v_cndmask_b32 v66, v67, v66, vcc
  v_mov_b32 v68, 0x3f80
  v_mov_b32 v69, 0x3f800000
  v_mov_b32 v4, 0
  v_cmp_eq_u32 vcc, 0, v66
  s_nop 1
  v_cndmask_b32 v4, v4, v68, vcc
  v_cmp_eq_u32 vcc, 1, v66
  s_nop 1
  v_cndmask_b32 v4, v4, v69, vcc
  v_mov_b32 v5, 0
  v_cmp_eq_u32 vcc, 2, v66
  s_nop 1
  v_cndmask_b32 v5, v5, v68, vcc
  v_cmp_eq_u32 vcc, 3, v66
  s_nop 1
  v_cndmask_b32 v5, v5, v69, vcc
  v_mov_b32 v6, 0
  v_cmp_eq_u32 vcc, 4, v66
  s_nop 1
  v_cndmask_b32 v6, v6, v68, vcc
  v_cmp_eq_u32 vcc, 5, v66
  s_nop 1
  v_cndmask_b32 v6, v6, v69, vcc
  v_mov_b32 v7, 0
  v_cmp_eq_u32 vcc, 6, v66
  s_nop 1
  v_cndmask_b32 v7, v7, v68, vcc
  v_cmp_eq_u32 vcc, 7, v66
  s_nop 1
  v_cndmask_b32 v7, v7, v69, vcc
  v_lshrrev_b32 v64, 1, v116
  v_lshrrev_b32 v65, 3, v117
  v_cmp_eq_u32 s[26:27], v64, v65
  v_and_b32 v66, 1, v116
  v_add_u32 v64, 0, v64
  v_lshrrev_b32 v67, 1, v116
  v_lshlrev_b32 v67, 8, v67
  v_lshl_add_u32 v67, v66, 9, v67
  v_lshl_add_u32 v67, v117, 4, v67
  v_add_u32 v112, 57344, v67
  v_and_b32 v68, 7, v117
  v_lshlrev_b32 v67, 8, v64
  v_lshl_add_u32 v67, v68, 5, v67
  v_lshl_add_u32 v67, v66, 4, v67
  v_add_u32 v113, 65536, v67
  v_lshrrev_b32 v64, 5, v1
  v_and_b32 v65, 31, v1
  v_lshrrev_b32 v66, 3, v65
  v_and_b32 v67, 7, v65
  v_and_b32 v68, 3, v67
  v_lshl_add_u32 v68, v66, 2, v68
  v_lshrrev_b32 v69, 2, v67
  v_lshl_add_u32 v68, v69, 4, v68
  v_lshlrev_b32 v69, 11, v64
  v_lshl_add_u32 v69, v68, 4, v69
  v_add_u32 v114, 57344, v69
  v_add_u32 v70, 0, v64
  v_lshlrev_b32 v69, 9, v66
  v_lshl_add_u32 v69, v70, 5, v69
  v_lshl_add_u32 v69, v67, 2, v69
  v_add_u32 v115, 65536, v69
  v_lshlrev_b32 v69, 4, v68
  v_lshl_add_u32 v69, v64, 9, v69
  v_add_u32 v114, 57344, v69
  v_mul_u32_u24 v69, 144, v70
  v_lshl_add_u32 v69, v67, 4, v69
  v_add_u32 v115, 65536, v69
  v_and_b32 v71, 1, v116
  v_mul_u32_u24 v69, 2048, v71
  v_lshl_add_u32 v69, v64, 8, v69
  v_lshl_add_u32 v69, v117, 4, v69
  v_add_u32 v112, 57344, v69
  v_mul_u32_u24 v69, 144, v117
  v_lshl_add_u32 v69, v71, 6, v69
  v_lshl_add_u32 v69, v64, 5, v69
  v_add_u32 v113, 65536, v69
  v_and_b32 v71, 1, v1
  v_cmp_eq_u32 s[38:39], 0, v71
  v_cmp_gt_u32 vcc, 8, v65
  s_or_b64 s[28:29], s[38:39], vcc
  v_lshrrev_b32 v72, 1, v67
  v_lshlrev_b32 v72, 2, v72
  v_lshl_add_u32 v72, v70, 4, v72
  s_lshl_b32 s22, s17, 9
  s_add_u32 s22, s22, 9216
  v_lshl_add_u32 v73, v66, 7, v72
  v_add_u32 v73, s22, v73
  s_lshl_b32 s22, s17, 7
  s_add_u32 s22, s22, 7168
  v_add_u32 v74, s22, v72
  v_bfe_u32 v72, v65, 1, 1
  v_lshlrev_b32 v72, 7, v72
  v_lshl_add_u32 v72, v70, 4, v72
  v_bfe_u32 v73, v65, 2, 2
  v_lshl_add_u32 v72, v73, 2, v72
  v_lshrrev_b32 v73, 4, v65
  v_lshl_add_u32 v73, v73, 8, v72
  s_lshl_b32 s22, s17, 9
  s_add_u32 s22, s22, 9216
  v_add_u32 v73, s22, v73
  s_lshr_b32 s22, s17, 1
  s_lshl_b32 s22, s22, 8
  s_and_b32 s34, s17, 1
  s_lshl_b32 s34, s34, 3
  s_add_u32 s22, s22, s34
  s_add_u32 s22, s22, 7168
  v_add_u32 v74, s22, v72
  v_bfe_u32 v72, v65, 1, 1
  v_lshl_add_u32 v72, v64, 1, v72
  v_lshlrev_b32 v72, 4, v72
  v_bfe_u32 v73, v65, 2, 2
  v_lshl_add_u32 v72, v73, 2, v72
  v_lshrrev_b32 v73, 4, v65
  v_lshl_add_u32 v73, v73, 6, v72
  s_lshl_b32 s22, s17, 9
  s_add_u32 s22, s22, 9216
  v_add_u32 v73, s22, v73
  v_lshrrev_b32 v72, 1, v65
  v_lshlrev_b32 v72, 2, v72
  v_lshl_add_u32 v72, v64, 5, v72
  s_lshr_b32 s22, s17, 1
  s_lshl_b32 s22, s22, 8
  s_and_b32 s34, s17, 1
  s_lshl_b32 s34, s34, 4
  s_add_u32 s22, s22, s34
  s_add_u32 s22, s22, 7168
  v_add_u32 v74, s22, v72
  v_lshlrev_b32 v0, 2, v65
  s_and_b32 s22, s17, 31
  s_lshl_b32 s22, s22, 7
  s_add_u32 s22, s22, 21504
  v_add_u32 v0, s22, v0
  v_cndmask_b32 v1, v74, v73, s[38:39]
  s_lshl_b32 s36, s17, 2
  s_add_u32 s36, s36, 17408
  s_mov_b32 s37, 0x3e800000
  v_mov_b32 v64, 0
  v_mov_b32 v65, 0
  v_mov_b32 v66, 0
  v_mov_b32 v67, 0
  v_mov_b32 v68, 0
  v_mov_b32 v69, 0
  v_mov_b32 v70, 0
  v_mov_b32 v71, 0
  v_mov_b32 v72, 0
  v_mov_b32 v73, 0
  v_mov_b32 v74, 0
  v_mov_b32 v75, 0
  v_mov_b32 v76, 0
  v_mov_b32 v77, 0
  v_mov_b32 v78, 0
  v_mov_b32 v79, 0
  v_mov_b32 v80, 0
  v_mov_b32 v81, 0
  v_mov_b32 v82, 0
  v_mov_b32 v83, 0
  v_mov_b32 v84, 0
  v_mov_b32 v85, 0
  v_mov_b32 v86, 0
  v_mov_b32 v87, 0
  v_mov_b32 v88, 0
  v_mov_b32 v89, 0
  v_mov_b32 v90, 0
  v_mov_b32 v91, 0
  v_mov_b32 v92, 0
  v_mov_b32 v93, 0
  v_mov_b32 v94, 0
  v_mov_b32 v95, 0
  v_mov_b32 v96, 0
  v_mov_b32 v97, 0
  v_mov_b32 v98, 0
  v_mov_b32 v99, 0
  v_mov_b32 v100, 0
  v_mov_b32 v101, 0
  v_mov_b32 v102, 0
  v_mov_b32 v103, 0
  v_mov_b32 v104, 0
  v_mov_b32 v105, 0
  v_mov_b32 v106, 0
  v_mov_b32 v107, 0
  v_mov_b32 v108, 0
  v_mov_b32 v109, 0
  v_mov_b32 v110, 0
  v_mov_b32 v111, 0
  v_and_b32 v118, 1, v116
  v_cmp_eq_u32 vcc, 0, v118
  v_mov_b32 v118, 12288
  v_mov_b32 v119, 8192
  v_cndmask_b32 v118, v118, v119, vcc
  v_lshrrev_b32 v116, 1, v116
  v_lshl_add_u32 v118, v116, 9, v118
  v_lshl_add_u32 v117, v117, 4, v118
  s_mov_b32 s57, 28672
  s_mov_b32 s56, 0x42800000
  v_mov_b32 v116, v2
  s_mul_i32 s35, s17, 1835008
  s_add_u32 s35, s35, 42262528
  s_mov_b32 s30, 0
  v_mov_b32 v36, 0
ch_md0:
  buffer_load_dword v37, v36, s[12:15], 0 offen sc1
  s_waitcnt vmcnt(0)
  v_readfirstlane_b32 s22, v37
  s_and_b32 s31, s22, 0xffff
  s_cmp_ge_u32 s31, 32
  s_cbranch_scc1 ch_go0
  s_sleep 2
  s_add_u32 s30, s30, 1
  s_cmp_lt_u32 s30, 50000
  s_cbranch_scc1 ch_md0
  s_branch ch_end
ch_go0:
  s_mov_b32 s31, 0
  s_lshr_b32 s22, s22, 16
  s_cmp_lg_u32 s22, 0
  s_cbranch_scc1 cB_sc0_loop
  s_branch cA_sc0_loop
ch_init1:
  s_mul_i32 s31, s17, 401408
  s_add_u32 s31, s31, 0
  s_mov_b32 s24, 71572480
  s_mov_b32 s25, 0
  s_add_u32 m0, s25, 7168
  s_nop 0
  buffer_load_dwordx4 v2, s[8:11], s24 offen offset:0 sc1 lds
  buffer_load_dwordx4 v2, s[8:11], s24 offen offset:1024 sc1 lds
  buffer_load_dwordx4 v2, s[8:11], s24 offen offset:2048 sc1 lds
  buffer_load_dwordx4 v2, s[8:11], s24 offen offset:3072 sc1 lds
  s_add_u32 m0, s25, 11264
  s_add_u32 s22, s24, 4096
  buffer_load_dwordx4 v2, s[8:11], s22 offen offset:0 sc1 lds
  buffer_load_dwordx4 v2, s[8:11], s22 offen offset:1024 sc1 lds
  buffer_load_dwordx4 v2, s[8:11], s22 offen offset:2048 sc1 lds
  v_and_b32 v64, 7, v117
  v_and_b32 v65, 1, v116
  v_lshlrev_b32 v65, 2, v65
  v_sub_u32 v64, v64, v65
  v_lshrrev_b32 v65, 3, v117
  v_lshl_add_u32 v66, v65, 2, v64
  v_cmp_gt_u32 vcc, 4, v64
  v_mov_b32 v67, 99
  s_nop 0
  v_cndmask_b32 v66, v67, v66, vcc
  v_mov_b32 v68, 0x3f80
  v_mov_b32 v69, 0x3f800000
  v_mov_b32 v4, 0
  v_cmp_eq_u32 vcc, 0, v66
  s_nop 1
  v_cndmask_b32 v4, v4, v68, vcc
  v_cmp_eq_u32 vcc, 1, v66
  s_nop 1
  v_cndmask_b32 v4, v4, v69, vcc
  v_mov_b32 v5, 0
  v_cmp_eq_u32 vcc, 2, v66
  s_nop 1
  v_cndmask_b32 v5, v5, v68, vcc
  v_cmp_eq_u32 vcc, 3, v66
  s_nop 1
  v_cndmask_b32 v5, v5, v69, vcc
  v_mov_b32 v6, 0
  v_cmp_eq_u32 vcc, 4, v66
  s_nop 1
  v_cndmask_b32 v6, v6, v68, vcc
  v_cmp_eq_u32 vcc, 5, v66
  s_nop 1
  v_cndmask_b32 v6, v6, v69, vcc
  v_mov_b32 v7, 0
  v_cmp_eq_u32 vcc, 6, v66
  s_nop 1
  v_cndmask_b32 v7, v7, v68, vcc
  v_cmp_eq_u32 vcc, 7, v66
  s_nop 1
  v_cndmask_b32 v7, v7, v69, vcc
  v_lshrrev_b32 v64, 1, v116
  v_lshrrev_b32 v65, 3, v117
  v_cmp_eq_u32 s[26:27], v64, v65
  v_and_b32 v66, 1, v116
  v_add_u32 v64, 2, v64
  v_lshrrev_b32 v67, 1, v116
  v_lshlrev_b32 v67, 8, v67
  v_lshl_add_u32 v67, v66, 9, v67
  v_lshl_add_u32 v67, v117, 4, v67
  v_add_u32 v112, 58368, v67
  v_and_b32 v68, 7, v117
  v_lshlrev_b32 v67, 8, v64
  v_lshl_add_u32 v67, v68, 5, v67
  v_lshl_add_u32 v67, v66, 4, v67
  v_add_u32 v113, 65536, v67
  v_lshrrev_b32 v64, 5, v1
  v_and_b32 v65, 31, v1
  v_lshrrev_b32 v66, 3, v65
  v_and_b32 v67, 7, v65
  v_and_b32 v68, 3, v67
  v_lshl_add_u32 v68, v66, 2, v68
  v_lshrrev_b32 v69, 2, v67
  v_lshl_add_u32 v68, v69, 4, v68
  v_lshlrev_b32 v69, 11, v64
  v_lshl_add_u32 v69, v68, 4, v69
  v_add_u32 v114, 57352, v69
  v_add_u32 v70, 2, v64
  v_lshlrev_b32 v69, 9, v66
  v_lshl_add_u32 v69, v70, 5, v69
  v_lshl_add_u32 v69, v67, 2, v69
  v_add_u32 v115, 65536, v69
  v_lshlrev_b32 v69, 4, v68
  v_lshl_add_u32 v69, v64, 9, v69
  v_add_u32 v114, 58368, v69
  v_mul_u32_u24 v69, 144, v70
  v_lshl_add_u32 v69, v67, 4, v69
  v_add_u32 v115, 65536, v69
  v_and_b32 v71, 1, v116
  v_mul_u32_u24 v69, 2048, v71
  v_lshl_add_u32 v69, v64, 8, v69
  v_lshl_add_u32 v69, v117, 4, v69
  v_add_u32 v112, 57352, v69
  v_mul_u32_u24 v69, 144, v117
  v_lshl_add_u32 v69, v71, 6, v69
  v_lshl_add_u32 v69, v64, 5, v69
  v_add_u32 v113, 65540, v69
  v_and_b32 v71, 1, v1
  v_cmp_eq_u32 s[38:39], 0, v71
  v_cmp_gt_u32 vcc, 8, v65
  s_or_b64 s[28:29], s[38:39], vcc
  v_lshrrev_b32 v72, 1, v67
  v_lshlrev_b32 v72, 2, v72
  v_lshl_add_u32 v72, v70, 4, v72
  s_lshl_b32 s22, s17, 9
  s_add_u32 s22, s22, 9216
  v_lshl_add_u32 v73, v66, 7, v72
  v_add_u32 v73, s22, v73
  s_lshl_b32 s22, s17, 7
  s_add_u32 s22, s22, 7168
  v_add_u32 v74, s22, v72
  v_bfe_u32 v72, v65, 1, 1
  v_lshlrev_b32 v72, 7, v72
  v_lshl_add_u32 v72, v70, 4, v72
  v_bfe_u32 v73, v65, 2, 2
  v_lshl_add_u32 v72, v73, 2, v72
  v_lshrrev_b32 v73, 4, v65
  v_lshl_add_u32 v73, v73, 8, v72
  s_lshl_b32 s22, s17, 9
  s_add_u32 s22, s22, 9216
  v_add_u32 v73, s22, v73
  s_lshr_b32 s22, s17, 1
  s_lshl_b32 s22, s22, 8
  s_and_b32 s34, s17, 1
  s_lshl_b32 s34, s34, 3
  s_add_u32 s22, s22, s34
  s_add_u32 s22, s22, 7168
  v_add_u32 v74, s22, v72
  v_bfe_u32 v72, v65, 1, 1
  v_lshl_add_u32 v72, v64, 1, v72
  v_lshlrev_b32 v72, 4, v72
  v_bfe_u32 v73, v65, 2, 2
  v_lshl_add_u32 v72, v73, 2, v72
  v_lshrrev_b32 v73, 4, v65
  v_lshl_add_u32 v73, v73, 6, v72
  s_lshl_b32 s22, s17, 9
  s_add_u32 s22, s22, 9344
  v_add_u32 v73, s22, v73
  v_lshrrev_b32 v72, 1, v65
  v_lshlrev_b32 v72, 2, v72
  v_lshl_add_u32 v72, v64, 5, v72
  s_lshr_b32 s22, s17, 1
  s_lshl_b32 s22, s22, 8
  s_and_b32 s34, s17, 1
  s_lshl_b32 s34, s34, 4
  s_add_u32 s22, s22, s34
  s_add_u32 s22, s22, 7232
  v_add_u32 v74, s22, v72
  v_lshlrev_b32 v0, 2, v65
  s_and_b32 s22, s17, 31
  s_lshl_b32 s22, s22, 7
  s_add_u32 s22, s22, 21504
  v_add_u32 v0, s22, v0
  v_cndmask_b32 v1, v74, v73, s[38:39]
  s_lshl_b32 s36, s17, 2
  s_add_u32 s36, s36, 17408
  s_mov_b32 s37, 0x3e800000
  v_mov_b32 v64, 0
  v_mov_b32 v65, 0
  v_mov_b32 v66, 0
  v_mov_b32 v67, 0
  v_mov_b32 v68, 0
  v_mov_b32 v69, 0
  v_mov_b32 v70, 0
  v_mov_b32 v71, 0
  v_mov_b32 v72, 0
  v_mov_b32 v73, 0
  v_mov_b32 v74, 0
  v_mov_b32 v75, 0
  v_mov_b32 v76, 0
  v_mov_b32 v77, 0
  v_mov_b32 v78, 0
  v_mov_b32 v79, 0
  v_mov_b32 v80, 0
  v_mov_b32 v81, 0
  v_mov_b32 v82, 0
  v_mov_b32 v83, 0
  v_mov_b32 v84, 0
  v_mov_b32 v85, 0
  v_mov_b32 v86, 0
  v_mov_b32 v87, 0
  v_mov_b32 v88, 0
  v_mov_b32 v89, 0
  v_mov_b32 v90, 0
  v_mov_b32 v91, 0
  v_mov_b32 v92, 0
  v_mov_b32 v93, 0
  v_mov_b32 v94, 0
  v_mov_b32 v95, 0
  v_mov_b32 v96, 0
  v_mov_b32 v97, 0
  v_mov_b32 v98, 0
  v_mov_b32 v99, 0
  v_mov_b32 v100, 0
  v_mov_b32 v101, 0
  v_mov_b32 v102, 0
  v_mov_b32 v103, 0
  v_mov_b32 v104, 0
  v_mov_b32 v105, 0
  v_mov_b32 v106, 0
  v_mov_b32 v107, 0
  v_mov_b32 v108, 0
  v_mov_b32 v109, 0
  v_mov_b32 v110, 0
  v_mov_b32 v111, 0
  v_and_b32 v118, 1, v116
  v_cmp_eq_u32 vcc, 0, v118
  v_mov_b32 v118, 12288
  v_mov_b32 v119, 8448
  v_cndmask_b32 v118, v118, v119, vcc
  v_lshrrev_b32 v116, 1, v116
  v_lshl_add_u32 v118, v116, 9, v118
  v_lshl_add_u32 v117, v117, 4, v118
  s_mov_b32 s57, 28672
  s_mov_b32 s56, 0x42800000
  v_mov_b32 v116, v2
  v_lshrrev_b32 v0, 4, v2
  v_min_u32 v0, 12, v0
  s_mul_i32 s22, s17, 13
  v_add_u32 v0, s22, v0
  v_lshlrev_b32 v0, 7, v0
  v_add_u32 v0, 51200, v0
  s_mov_b32 s22, 75209728
  buffer_load_dword v119, v0, s[8:11], s22 offen sc1
  s_mov_b32 s22, 75184128
  buffer_load_dword v119, v0, s[8:11], s22 offen sc1
  s_mul_i32 s35, s17, 1835008
  s_add_u32 s35, s35, 42269696
  s_mov_b32 s30, 0
  v_mov_b32 v36, 0
ch_md1:
  buffer_load_dword v37, v36, s[12:15], 0 offen sc1
  s_waitcnt vmcnt(0)
  v_readfirstlane_b32 s22, v37
  s_and_b32 s31, s22, 0xffff
  s_cmp_ge_u32 s31, 32
  s_cbranch_scc1 ch_go1
  s_sleep 2
  s_add_u32 s30, s30, 1
  s_cmp_lt_u32 s30, 50000
  s_cbranch_scc1 ch_md1
  s_branch ch_end
ch_go1:
  s_mov_b32 s31, 0
  s_lshr_b32 s22, s22, 16
  s_cmp_lg_u32 s22, 0
  s_cbranch_scc1 cB_sc1_loop
  s_branch cA_sc1_loop
ch_init2:
  s_mul_i32 s31, s17, 401408
  s_add_u32 s31, s31, 0
  s_mov_b32 s24, 71579648
  s_mov_b32 s25, 0
  s_add_u32 m0, s25, 14336
  s_nop 0
  buffer_load_dwordx4 v2, s[8:11], s24 offen offset:0 sc1 lds
  buffer_load_dwordx4 v2, s[8:11], s24 offen offset:1024 sc1 lds
  buffer_load_dwordx4 v2, s[8:11], s24 offen offset:2048 sc1 lds
  buffer_load_dwordx4 v2, s[8:11], s24 offen offset:3072 sc1 lds
  s_add_u32 m0, s25, 18432
  s_add_u32 s22, s24, 4096
  buffer_load_dwordx4 v2, s[8:11], s22 offen offset:0 sc1 lds
  buffer_load_dwordx4 v2, s[8:11], s22 offen offset:1024 sc1 lds
  buffer_load_dwordx4 v2, s[8:11], s22 offen offset:2048 sc1 lds
  v_and_b32 v64, 7, v117
  v_and_b32 v65, 1, v116
  v_lshlrev_b32 v65, 2, v65
  v_sub_u32 v64, v64, v65
  v_lshrrev_b32 v65, 3, v117
  v_lshl_add_u32 v66, v65, 2, v64
  v_cmp_gt_u32 vcc, 4, v64
  v_mov_b32 v67, 99
  s_nop 0
  v_cndmask_b32 v66, v67, v66, vcc
  v_mov_b32 v68, 0x3f80
  v_mov_b32 v69, 0x3f800000
  v_mov_b32 v4, 0
  v_cmp_eq_u32 vcc, 0, v66
  s_nop 1
  v_cndmask_b32 v4, v4, v68, vcc
  v_cmp_eq_u32 vcc, 1, v66
  s_nop 1
  v_cndmask_b32 v4, v4, v69, vcc
  v_mov_b32 v5, 0
  v_cmp_eq_u32 vcc, 2, v66
  s_nop 1
  v_cndmask_b32 v5, v5, v68, vcc
  v_cmp_eq_u32 vcc, 3, v66
  s_nop 1
  v_cndmask_b32 v5, v5, v69, vcc
  v_mov_b32 v6, 0
  v_cmp_eq_u32 vcc, 4, v66
  s_nop 1
  v_cndmask_b32 v6, v6, v68, vcc
  v_cmp_eq_u32 vcc, 5, v66
  s_nop 1
  v_cndmask_b32 v6, v6, v69, vcc
  v_mov_b32 v7, 0
  v_cmp_eq_u32 vcc, 6, v66
  s_nop 1
  v_cndmask_b32 v7, v7, v68, vcc
  v_cmp_eq_u32 vcc, 7, v66
  s_nop 1
  v_cndmask_b32 v7, v7, v69, vcc
  v_lshrrev_b32 v64, 1, v116
  v_lshrrev_b32 v65, 3, v117
  v_cmp_eq_u32 s[26:27], v64, v65
  v_and_b32 v66, 1, v116
  v_add_u32 v64, 4, v64
  v_lshrrev_b32 v67, 1, v116
  v_lshlrev_b32 v67, 8, v67
  v_lshl_add_u32 v67, v66, 9, v67
  v_lshl_add_u32 v67, v117, 4, v67
  v_add_u32 v112, 59392, v67
  v_and_b32 v68, 7, v117
  v_lshlrev_b32 v67, 8, v64
  v_lshl_add_u32 v67, v68, 5, v67
  v_lshl_add_u32 v67, v66, 4, v67
  v_add_u32 v113, 65536, v67
  v_lshrrev_b32 v64, 5, v1
  v_and_b32 v65, 31, v1
  v_lshrrev_b32 v66, 3, v65
  v_and_b32 v67, 7, v65
  v_and_b32 v68, 3, v67
  v_lshl_add_u32 v68, v66, 2, v68
  v_lshrrev_b32 v69, 2, v67
  v_lshl_add_u32 v68, v69, 4, v68
  v_lshlrev_b32 v69, 11, v64
  v_lshl_add_u32 v69, v68, 4, v69
  v_add_u32 v114, 57856, v69
  v_add_u32 v70, 4, v64
  v_lshlrev_b32 v69, 9, v66
  v_lshl_add_u32 v69, v70, 5, v69
  v_lshl_add_u32 v69, v67, 2, v69
  v_add_u32 v115, 65536, v69
  v_lshlrev_b32 v69, 4, v68
  v_lshl_add_u32 v69, v64, 9, v69
  v_add_u32 v114, 59392, v69
  v_mul_u32_u24 v69, 144, v70
  v_lshl_add_u32 v69, v67, 4, v69
  v_add_u32 v115, 65536, v69
  v_and_b32 v71, 1, v116
  v_mul_u32_u24 v69, 2048, v71
  v_lshl_add_u32 v69, v64, 8, v69
  v_lshl_add_u32 v69, v117, 4, v69
  v_add_u32 v112, 57856, v69
  v_mul_u32_u24 v69, 144, v117
  v_lshl_add_u32 v69, v71, 6, v69
  v_lshl_add_u32 v69, v64, 5, v69
  v_add_u32 v113, 65544, v69
  v_and_b32 v71, 1, v1
  v_cmp_eq_u32 s[38:39], 0, v71
  v_cmp_gt_u32 vcc, 8, v65
  s_or_b64 s[28:29], s[38:39], vcc
  v_lshrrev_b32 v72, 1, v67
  v_lshlrev_b32 v72, 2, v72
  v_lshl_add_u32 v72, v70, 4, v72
  s_lshl_b32 s22, s17, 9
  s_add_u32 s22, s22, 9216
  v_lshl_add_u32 v73, v66, 7, v72
  v_add_u32 v73, s22, v73
  s_lshl_b32 s22, s17, 7
  s_add_u32 s22, s22, 7168
  v_add_u32 v74, s22, v72
  v_bfe_u32 v72, v65, 1, 1
  v_lshlrev_b32 v72, 7, v72
  v_lshl_add_u32 v72, v70, 4, v72
  v_bfe_u32 v73, v65, 2, 2
  v_lshl_add_u32 v72, v73, 2, v72
  v_lshrrev_b32 v73, 4, v65
  v_lshl_add_u32 v73, v73, 8, v72
  s_lshl_b32 s22, s17, 9
  s_add_u32 s22, s22, 9216
  v_add_u32 v73, s22, v73
  s_lshr_b32 s22, s17, 1
  s_lshl_b32 s22, s22, 8
  s_and_b32 s34, s17, 1
  s_lshl_b32 s34, s34, 3
  s_add_u32 s22, s22, s34
  s_add_u32 s22, s22, 7168
  v_add_u32 v74, s22, v72
  v_bfe_u32 v72, v65, 1, 1
  v_lshl_add_u32 v72, v64, 1, v72
  v_lshlrev_b32 v72, 4, v72
  v_bfe_u32 v73, v65, 2, 2
  v_lshl_add_u32 v72, v73, 2, v72
  v_lshrrev_b32 v73, 4, v65
  v_lshl_add_u32 v73, v73, 6, v72
  s_lshl_b32 s22, s17, 9
  s_add_u32 s22, s22, 9472
  v_add_u32 v73, s22, v73
  v_lshrrev_b32 v72, 1, v65
  v_lshlrev_b32 v72, 2, v72
  v_lshl_add_u32 v72, v64, 5, v72
  s_lshr_b32 s22, s17, 1
  s_lshl_b32 s22, s22, 8
  s_and_b32 s34, s17, 1
  s_lshl_b32 s34, s34, 4
  s_add_u32 s22, s22, s34
  s_add_u32 s22, s22, 7296
  v_add_u32 v74, s22, v72
  v_lshlrev_b32 v0, 2, v65
  s_and_b32 s22, s17, 31
  s_lshl_b32 s22, s22, 7
  s_add_u32 s22, s22, 21504
  v_add_u32 v0, s22, v0
  v_cndmask_b32 v1, v74, v73, s[38:39]
  s_lshl_b32 s36, s17, 2
  s_add_u32 s36, s36, 17408
  s_mov_b32 s37, 0x3e800000
  v_mov_b32 v64, 0
  v_mov_b32 v65, 0
  v_mov_b32 v66, 0
  v_mov_b32 v67, 0
  v_mov_b32 v68, 0
  v_mov_b32 v69, 0
  v_mov_b32 v70, 0
  v_mov_b32 v71, 0
  v_mov_b32 v72, 0
  v_mov_b32 v73, 0
  v_mov_b32 v74, 0
  v_mov_b32 v75, 0
  v_mov_b32 v76, 0
  v_mov_b32 v77, 0
  v_mov_b32 v78, 0
  v_mov_b32 v79, 0
  v_mov_b32 v80, 0
  v_mov_b32 v81, 0
  v_mov_b32 v82, 0
  v_mov_b32 v83, 0
  v_mov_b32 v84, 0
  v_mov_b32 v85, 0
  v_mov_b32 v86, 0
  v_mov_b32 v87, 0
  v_mov_b32 v88, 0
  v_mov_b32 v89, 0
  v_mov_b32 v90, 0
  v_mov_b32 v91, 0
  v_mov_b32 v92, 0
  v_mov_b32 v93, 0
  v_mov_b32 v94, 0
  v_mov_b32 v95, 0
  v_mov_b32 v96, 0
  v_mov_b32 v97, 0
  v_mov_b32 v98, 0
  v_mov_b32 v99, 0
  v_mov_b32 v100, 0
  v_mov_b32 v101, 0
  v_mov_b32 v102, 0
  v_mov_b32 v103, 0
  v_mov_b32 v104, 0
  v_mov_b32 v105, 0
  v_mov_b32 v106, 0
  v_mov_b32 v107, 0
  v_mov_b32 v108, 0
  v_mov_b32 v109, 0
  v_mov_b32 v110, 0
  v_mov_b32 v111, 0
  v_and_b32 v118, 1, v116
  v_cmp_eq_u32 vcc, 0, v118
  v_mov_b32 v118, 12544
  v_mov_b32 v119, 10240
  v_cndmask_b32 v118, v118, v119, vcc
  v_lshrrev_b32 v116, 1, v116
  v_lshl_add_u32 v118, v116, 9, v118
  v_lshl_add_u32 v117, v117, 4, v118
  s_mov_b32 s57, 28672
  s_mov_b32 s56, 0x42800000
  v_mov_b32 v116, v2
  v_lshrrev_b32 v0, 4, v2
  v_min_u32 v0, 13, v0
  s_mul_i32 s22, s17, 14
  v_add_u32 v0, s22, v0
  v_lshlrev_b32 v0, 7, v0
  v_add_u32 v0, 43008, v0
  s_mov_b32 s22, 71550976
  buffer_load_dword v119, v0, s[8:11], s22 offen sc1
  s_mov_b32 s22, 71522304
  buffer_load_dword v119, v0, s[8:11], s22 offen sc1
  s_mul_i32 s35, s17, 1835008
  s_add_u32 s35, s35, 42276864
  s_mov_b32 s30, 0
  v_mov_b32 v36, 0
ch_md2:
  buffer_load_dword v37, v36, s[12:15], 0 offen sc1
  s_waitcnt vmcnt(0)
  v_readfirstlane_b32 s22, v37
  s_and_b32 s31, s22, 0xffff
  s_cmp_ge_u32 s31, 32
  s_cbranch_scc1 ch_go2
  s_sleep 2
  s_add_u32 s30, s30, 1
  s_cmp_lt_u32 s30, 50000
  s_cbranch_scc1 ch_md2
  s_branch ch_end
ch_go2:
  s_mov_b32 s31, 0
  s_lshr_b32 s22, s22, 16
  s_cmp_lg_u32 s22, 0
  s_cbranch_scc1 cB_sc2_loop
  s_branch cA_sc2_loop
ch_init3:
  s_mul_i32 s31, s17, 401408
  s_add_u32 s31, s31, 0
  s_mov_b32 s24, 71586816
  s_mov_b32 s25, 0
  s_add_u32 m0, s25, 21504
  s_nop 0
  buffer_load_dwordx4 v2, s[8:11], s24 offen offset:0 sc1 lds
  buffer_load_dwordx4 v2, s[8:11], s24 offen offset:1024 sc1 lds
  buffer_load_dwordx4 v2, s[8:11], s24 offen offset:2048 sc1 lds
  buffer_load_dwordx4 v2, s[8:11], s24 offen offset:3072 sc1 lds
  s_add_u32 m0, s25, 25600
  s_add_u32 s22, s24, 4096
  buffer_load_dwordx4 v2, s[8:11], s22 offen offset:0 sc1 lds
  buffer_load_dwordx4 v2, s[8:11], s22 offen offset:1024 sc1 lds
  buffer_load_dwordx4 v2, s[8:11], s22 offen offset:2048 sc1 lds
  v_and_b32 v64, 7, v117
  v_and_b32 v65, 1, v116
  v_lshlrev_b32 v65, 2, v65
  v_sub_u32 v64, v64, v65
  v_lshrrev_b32 v65, 3, v117
  v_lshl_add_u32 v66, v65, 2, v64
  v_cmp_gt_u32 vcc, 4, v64
  v_mov_b32 v67, 99
  s_nop 0
  v_cndmask_b32 v66, v67, v66, vcc
  v_mov_b32 v68, 0x3f80
  v_mov_b32 v69, 0x3f800000
  v_mov_b32 v4, 0
  v_cmp_eq_u32 vcc, 0, v66
  s_nop 1
  v_cndmask_b32 v4, v4, v68, vcc
  v_cmp_eq_u32 vcc, 1, v66
  s_nop 1
  v_cndmask_b32 v4, v4, v69, vcc
  v_mov_b32 v5, 0
  v_cmp_eq_u32 vcc, 2, v66
  s_nop 1
  v_cndmask_b32 v5, v5, v68, vcc
  v_cmp_eq_u32 vcc, 3, v66
  s_nop 1
  v_cndmask_b32 v5, v5, v69, vcc
  v_mov_b32 v6, 0
  v_cmp_eq_u32 vcc, 4, v66
  s_nop 1
  v_cndmask_b32 v6, v6, v68, vcc
  v_cmp_eq_u32 vcc, 5, v66
  s_nop 1
  v_cndmask_b32 v6, v6, v69, vcc
  v_mov_b32 v7, 0
  v_cmp_eq_u32 vcc, 6, v66
  s_nop 1
  v_cndmask_b32 v7, v7, v68, vcc
  v_cmp_eq_u32 vcc, 7, v66
  s_nop 1
  v_cndmask_b32 v7, v7, v69, vcc
  v_lshrrev_b32 v64, 1, v116
  v_lshrrev_b32 v65, 3, v117
  v_cmp_eq_u32 s[26:27], v64, v65
  v_and_b32 v66, 1, v116
  v_add_u32 v64, 6, v64
  v_lshrrev_b32 v67, 1, v116
  v_lshlrev_b32 v67, 8, v67
  v_lshl_add_u32 v67, v66, 9, v67
  v_lshl_add_u32 v67, v117, 4, v67
  v_add_u32 v112, 60416, v67
  v_and_b32 v68, 7, v117
  v_lshlrev_b32 v67, 8, v64
  v_lshl_add_u32 v67, v68, 5, v67
  v_lshl_add_u32 v67, v66, 4, v67
  v_add_u32 v113, 65536, v67
  v_lshrrev_b32 v64, 5, v1
  v_and_b32 v65, 31, v1
  v_lshrrev_b32 v66, 3, v65
  v_and_b32 v67, 7, v65
  v_and_b32 v68, 3, v67
  v_lshl_add_u32 v68, v66, 2, v68
  v_lshrrev_b32 v69, 2, v67
  v_lshl_add_u32 v68, v69, 4, v68
  v_lshlrev_b32 v69, 11, v64
  v_lshl_add_u32 v69, v68, 4, v69
  v_add_u32 v114, 57864, v69
  v_add_u32 v70, 6, v64
  v_lshlrev_b32 v69, 9, v66
  v_lshl_add_u32 v69, v70, 5, v69
  v_lshl_add_u32 v69, v67, 2, v69
  v_add_u32 v115, 65536, v69
  v_lshlrev_b32 v69, 4, v68
  v_lshl_add_u32 v69, v64, 9, v69
  v_add_u32 v114, 60416, v69
  v_mul_u32_u24 v69, 144, v70
  v_lshl_add_u32 v69, v67, 4, v69
  v_add_u32 v115, 65536, v69
  v_and_b32 v71, 1, v116
  v_mul_u32_u24 v69, 2048, v71
  v_lshl_add_u32 v69, v64, 8, v69
  v_lshl_add_u32 v69, v117, 4, v69
  v_add_u32 v112, 57864, v69
  v_mul_u32_u24 v69, 144, v117
  v_lshl_add_u32 v69, v71, 6, v69
  v_lshl_add_u32 v69, v64, 5, v69
  v_add_u32 v113, 65548, v69
  v_and_b32 v71, 1, v1
  v_cmp_eq_u32 s[38:39], 0, v71
  v_cmp_gt_u32 vcc, 8, v65
  s_or_b64 s[28:29], s[38:39], vcc
  v_lshrrev_b32 v72, 1, v67
  v_lshlrev_b32 v72, 2, v72
  v_lshl_add_u32 v72, v70, 4, v72
  s_lshl_b32 s22, s17, 9
  s_add_u32 s22, s22, 9216
  v_lshl_add_u32 v73, v66, 7, v72
  v_add_u32 v73, s22, v73
  s_lshl_b32 s22, s17, 7
  s_add_u32 s22, s22, 7168
  v_add_u32 v74, s22, v72
  v_bfe_u32 v72, v65, 1, 1
  v_lshlrev_b32 v72, 7, v72
  v_lshl_add_u32 v72, v70, 4, v72
  v_bfe_u32 v73, v65, 2, 2
  v_lshl_add_u32 v72, v73, 2, v72
  v_lshrrev_b32 v73, 4, v65
  v_lshl_add_u32 v73, v73, 8, v72
  s_lshl_b32 s22, s17, 9
  s_add_u32 s22, s22, 9216
  v_add_u32 v73, s22, v73
  s_lshr_b32 s22, s17, 1
  s_lshl_b32 s22, s22, 8
  s_and_b32 s34, s17, 1
  s_lshl_b32 s34, s34, 3
  s_add_u32 s22, s22, s34
  s_add_u32 s22, s22, 7168
  v_add_u32 v74, s22, v72
  v_bfe_u32 v72, v65, 1, 1
  v_lshl_add_u32 v72, v64, 1, v72
  v_lshlrev_b32 v72, 4, v72
  v_bfe_u32 v73, v65, 2, 2
  v_lshl_add_u32 v72, v73, 2, v72
  v_lshrrev_b32 v73, 4, v65
  v_lshl_add_u32 v73, v73, 6, v72
  s_lshl_b32 s22, s17, 9
  s_add_u32 s22, s22, 9600
  v_add_u32 v73, s22, v73
  v_lshrrev_b32 v72, 1, v65
  v_lshlrev_b32 v72, 2, v72
  v_lshl_add_u32 v72, v64, 5, v72
  s_lshr_b32 s22, s17, 1
  s_lshl_b32 s22, s22, 8
  s_and_b32 s34, s17, 1
  s_lshl_b32 s34, s34, 4
  s_add_u32 s22, s22, s34
  s_add_u32 s22, s22, 7360
  v_add_u32 v74, s22, v72
  v_lshlrev_b32 v0, 2, v65
  s_and_b32 s22, s17, 31
  s_lshl_b32 s22, s22, 7
  s_add_u32 s22, s22, 21504
  v_add_u32 v0, s22, v0
  v_cndmask_b32 v1, v74, v73, s[38:39]
  s_lshl_b32 s36, s17, 2
  s_add_u32 s36, s36, 17408
  s_mov_b32 s37, 0x3e800000
  v_mov_b32 v64, 0
  v_mov_b32 v65, 0
  v_mov_b32 v66, 0
  v_mov_b32 v67, 0
  v_mov_b32 v68, 0
  v_mov_b32 v69, 0
  v_mov_b32 v70, 0
  v_mov_b32 v71, 0
  v_mov_b32 v72, 0
  v_mov_b32 v73, 0
  v_mov_b32 v74, 0
  v_mov_b32 v75, 0
  v_mov_b32 v76, 0
  v_mov_b32 v77, 0
  v_mov_b32 v78, 0
  v_mov_b32 v79, 0
  v_mov_b32 v80, 0
  v_mov_b32 v81, 0
  v_mov_b32 v82, 0
  v_mov_b32 v83, 0
  v_mov_b32 v84, 0
  v_mov_b32 v85, 0
  v_mov_b32 v86, 0
  v_mov_b32 v87, 0
  v_mov_b32 v88, 0
  v_mov_b32 v89, 0
  v_mov_b32 v90, 0
  v_mov_b32 v91, 0
  v_mov_b32 v92, 0
  v_mov_b32 v93, 0
  v_mov_b32 v94, 0
  v_mov_b32 v95, 0
  v_mov_b32 v96, 0
  v_mov_b32 v97, 0
  v_mov_b32 v98, 0
  v_mov_b32 v99, 0
  v_mov_b32 v100, 0
  v_mov_b32 v101, 0
  v_mov_b32 v102, 0
  v_mov_b32 v103, 0
  v_mov_b32 v104, 0
  v_mov_b32 v105, 0
  v_mov_b32 v106, 0
  v_mov_b32 v107, 0
  v_mov_b32 v108, 0
  v_mov_b32 v109, 0
  v_mov_b32 v110, 0
  v_mov_b32 v111, 0
  v_and_b32 v118, 1, v116
  v_cmp_eq_u32 vcc, 0, v118
  v_mov_b32 v118, 12544
  v_mov_b32 v119, 10496
  v_cndmask_b32 v118, v118, v119, vcc
  v_lshrrev_b32 v116, 1, v116
  v_lshl_add_u32 v118, v116, 9, v118
  v_lshl_add_u32 v117, v117, 4, v118
  s_mov_b32 s57, 28672
  s_mov_b32 s56, 0x42800000
  v_mov_b32 v116, v2
  s_mul_i32 s35, s17, 1835008
  s_add_u32 s35, s35, 42284032
  s_mov_b32 s30, 0
  v_mov_b32 v36, 0
ch_md3:
  buffer_load_dword v37, v36, s[12:15], 0 offen sc1
  s_waitcnt vmcnt(0)
  v_readfirstlane_b32 s22, v37
  s_and_b32 s31, s22, 0xffff
  s_cmp_ge_u32 s31, 32
  s_cbranch_scc1 ch_go3
  s_sleep 2
  s_add_u32 s30, s30, 1
  s_cmp_lt_u32 s30, 50000
  s_cbranch_scc1 ch_md3
  s_branch ch_end
ch_go3:
  s_mov_b32 s31, 0
  s_lshr_b32 s22, s22, 16
  s_cmp_lg_u32 s22, 0
  s_cbranch_scc1 cB_sc3_loop
  s_branch cA_sc3_loop
ch_init4:
  s_mul_i32 s31, s17, 401408
  s_add_u32 s31, s31, 6422528
  s_mul_i32 s22, s17, 28
  s_add_u32 s23, s22, 27
  s_lshr_b32 s22, s22, 6
  s_lshr_b32 s23, s23, 6
  s_sub_u32 s23, s23, s22
  s_lshl_b32 s23, s23, 8
  v_and_b32 v36, s23, v2
  v_med3_u32 v37, v117, 0, 3
  v_lshl_add_u32 v36, v37, 4, v36
  s_lshl_b32 s22, s22, 8
  s_add_u32 s22, s22, 88588288
  s_mov_b32 s30, 0
va_bw_11:
  buffer_load_dwordx4 v[40:43], v36, s[8:11], s22 offen sc1
  s_waitcnt vmcnt(0)
  v_cmp_ne_u64 vcc, s[88:89], v[40:41]
  s_cbranch_vccnz va_bw_11_no
  v_cmp_ne_u64 vcc, s[88:89], v[42:43]
  s_cbranch_vccnz va_bw_11_no
  s_branch va_bw_11_ok
va_bw_11_no:
  s_sleep 2
  s_add_u32 s30, s30, 1
  s_cmp_lt_u32 s30, 50000
  s_cbranch_scc1 va_bw_11
  s_branch cA_abort
va_bw_11_ok:
  s_add_u32 s22, s31, 0
  buffer_load_dwordx4 a[0:3], v2, s[8:11], s22 offen offset:0 sc1
  buffer_load_dwordx4 a[4:7], v2, s[8:11], s22 offen offset:1024 sc1
  buffer_load_dwordx4 a[8:11], v2, s[8:11], s22 offen offset:2048 sc1
  buffer_load_dwordx4 a[12:15], v2, s[8:11], s22 offen offset:3072 sc1
  s_add_u32 s22, s31, 4096
  buffer_load_dwordx4 a[16:19], v2, s[8:11], s22 offen offset:0 sc1
  buffer_load_dwordx4 a[20:23], v2, s[8:11], s22 offen offset:1024 sc1
  buffer_load_dwordx4 a[24:27], v2, s[8:11], s22 offen offset:2048 sc1
  buffer_load_dwordx4 a[28:31], v2, s[8:11], s22 offen offset:3072 sc1
  s_add_u32 s22, s31, 8192
  buffer_load_dwordx4 a[32:35], v2, s[8:11], s22 offen offset:0 sc1
  buffer_load_dwordx4 a[36:39], v2, s[8:11], s22 offen offset:1024 sc1
  buffer_load_dwordx4 a[40:43], v2, s[8:11], s22 offen offset:2048 sc1
  buffer_load_dwordx4 a[44:47], v2, s[8:11], s22 offen offset:3072 sc1
  s_add_u32 s22, s31, 12288
  buffer_load_dwordx4 a[48:51], v2, s[8:11], s22 offen offset:0 sc1
  buffer_load_dwordx4 a[52:55], v2, s[8:11], s22 offen offset:1024 sc1
  buffer_load_dwordx4 a[56:59], v2, s[8:11], s22 offen offset:2048 sc1
  buffer_load_dwordx4 a[60:63], v2, s[8:11], s22 offen offset:3072 sc1
  s_add_u32 s22, s31, 16384
  buffer_load_dwordx4 a[64:67], v2, s[8:11], s22 offen offset:0 sc1
  buffer_load_dwordx4 a[68:71], v2, s[8:11], s22 offen offset:1024 sc1
  buffer_load_dwordx4 a[72:75], v2, s[8:11], s22 offen offset:2048 sc1
  buffer_load_dwordx4 a[76:79], v2, s[8:11], s22 offen offset:3072 sc1
  s_add_u32 s22, s31, 20480
  buffer_load_dwordx4 a[80:83], v2, s[8:11], s22 offen offset:0 sc1
  buffer_load_dwordx4 a[84:87], v2, s[8:11], s22 offen offset:1024 sc1
  buffer_load_dwordx4 a[88:91], v2, s[8:11], s22 offen offset:2048 sc1
  buffer_load_dwordx4 a[92:95], v2, s[8:11], s22 offen offset:3072 sc1
  s_add_u32 s22, s31, 24576
  buffer_load_dwordx4 a[96:99], v2, s[8:11], s22 offen offset:0 sc1
  buffer_load_dwordx4 a[100:103], v2, s[8:11], s22 offen offset:1024 sc1
  buffer_load_dwordx4 a[104:107], v2, s[8:11], s22 offen offset:2048 sc1
  buffer_load_dwordx4 a[108:111], v2, s[8:11], s22 offen offset:3072 sc1
  s_add_u32 s22, s31, 28672
  buffer_load_dwordx4 a[112:115], v2, s[8:11], s22 offen offset:0 sc1
  buffer_load_dwordx4 a[116:119], v2, s[8:11], s22 offen offset:1024 sc1
  buffer_load_dwordx4 a[120:123], v2, s[8:11], s22 offen offset:2048 sc1
  buffer_load_dwordx4 a[124:127], v2, s[8:11], s22 offen offset:3072 sc1
  s_waitcnt vmcnt(24)
  s_add_u32 s22, s31, 32768
  buffer_load_dwordx4 a[128:131], v2, s[8:11], s22 offen offset:0 sc1
  buffer_load_dwordx4 a[132:135], v2, s[8:11], s22 offen offset:1024 sc1
  buffer_load_dwordx4 a[136:139], v2, s[8:11], s22 offen offset:2048 sc1
  buffer_load_dwordx4 a[140:143], v2, s[8:11], s22 offen offset:3072 sc1
  s_add_u32 s22, s31, 36864
  buffer_load_dwordx4 a[144:147], v2, s[8:11], s22 offen offset:0 sc1
  buffer_load_dwordx4 a[148:151], v2, s[8:11], s22 offen offset:1024 sc1
  buffer_load_dwordx4 a[152:155], v2, s[8:11], s22 offen offset:2048 sc1
  buffer_load_dwordx4 a[156:159], v2, s[8:11], s22 offen offset:3072 sc1
  s_add_u32 s22, s31, 40960
  buffer_load_dwordx4 a[160:163], v2, s[8:11], s22 offen offset:0 sc1
  buffer_load_dwordx4 a[164:167], v2, s[8:11], s22 offen offset:1024 sc1
  buffer_load_dwordx4 a[168:171], v2, s[8:11], s22 offen offset:2048 sc1
  buffer_load_dwordx4 a[172:175], v2, s[8:11], s22 offen offset:3072 sc1
  s_add_u32 s22, s31, 45056
  buffer_load_dwordx4 a[176:179], v2, s[8:11], s22 offen offset:0 sc1
  buffer_load_dwordx4 a[180:183], v2, s[8:11], s22 offen offset:1024 sc1
  buffer_load_dwordx4 a[184:187], v2, s[8:11], s22 offen offset:2048 sc1
  buffer_load_dwordx4 a[188:191], v2, s[8:11], s22 offen offset:3072 sc1
  s_add_u32 s22, s31, 49152
  buffer_load_dwordx4 a[192:195], v2, s[8:11], s22 offen offset:0 sc1
  buffer_load_dwordx4 a[196:199], v2, s[8:11], s22 offen offset:1024 sc1
  buffer_load_dwordx4 a[200:203], v2, s[8:11], s22 offen offset:2048 sc1
  buffer_load_dwordx4 a[204:207], v2, s[8:11], s22 offen offset:3072 sc1
  s_add_u32 s22, s31, 53248
  buffer_load_dwordx4 a[208:211], v2, s[8:11], s22 offen offset:0 sc1
  buffer_load_dwordx4 a[212:215], v2, s[8:11], s22 offen offset:1024 sc1
  buffer_load_dwordx4 a[216:219], v2, s[8:11], s22 offen offset:2048 sc1
  buffer_load_dwordx4 a[220:223], v2, s[8:11], s22 offen offset:3072 sc1
  s_add_u32 s22, s31, 57344
  buffer_load_dwordx4 a[224:227], v2, s[8:11], s22 offen offset:0 sc1
  buffer_load_dwordx4 a[228:231], v2, s[8:11], s22 offen offset:1024 sc1
  buffer_load_dwordx4 a[232:235], v2, s[8:11], s22 offen offset:2048 sc1
  buffer_load_dwordx4 a[236:239], v2, s[8:11], s22 offen offset:3072 sc1
  s_add_u32 s22, s31, 61440
  buffer_load_dwordx4 a[240:243], v2, s[8:11], s22 offen offset:0 sc1
  buffer_load_dwordx4 a[244:247], v2, s[8:11], s22 offen offset:1024 sc1
  buffer_load_dwordx4 a[248:251], v2, s[8:11], s22 offen offset:2048 sc1
  buffer_load_dwordx4 a[252:255], v2, s[8:11], s22 offen offset:3072 sc1
  s_waitcnt vmcnt(24)
  s_add_u32 s22, s31, 65536
  buffer_load_dwordx4 v[176:179], v2, s[8:11], s22 offen offset:0 sc1
  buffer_load_dwordx4 v[180:183], v2, s[8:11], s22 offen offset:1024 sc1
  buffer_load_dwordx4 v[184:187], v2, s[8:11], s22 offen offset:2048 sc1
  buffer_load_dwordx4 v[188:191], v2, s[8:11], s22 offen offset:3072 sc1
  s_add_u32 s22, s31, 69632
  buffer_load_dwordx4 v[192:195], v2, s[8:11], s22 offen offset:0 sc1
  buffer_load_dwordx4 v[196:199], v2, s[8:11], s22 offen offset:1024 sc1
  buffer_load_dwordx4 v[200:203], v2, s[8:11], s22 offen offset:2048 sc1
  buffer_load_dwordx4 v[204:207], v2, s[8:11], s22 offen offset:3072 sc1
  s_add_u32 s22, s31, 73728
  buffer_load_dwordx4 v[208:211], v2, s[8:11], s22 offen offset:0 sc1
  buffer_load_dwordx4 v[212:215], v2, s[8:11], s22 offen offset:1024 sc1
  buffer_load_dwordx4 v[216:219], v2, s[8:11], s22 offen offset:2048 sc1
  buffer_load_dwordx4 v[220:223], v2, s[8:11], s22 offen offset:3072 sc1
  s_add_u32 s22, s31, 77824
  buffer_load_dwordx4 v[224:227], v2, s[8:11], s22 offen offset:0 sc1
  buffer_load_dwordx4 v[228:231], v2, s[8:11], s22 offen offset:1024 sc1
  buffer_load_dwordx4 v[232:235], v2, s[8:11], s22 offen offset:2048 sc1
  buffer_load_dwordx4 v[236:239], v2, s[8:11], s22 offen offset:3072 sc1
  s_add_u32 s22, s31, 81920
  buffer_load_dwordx4 v[240:243], v2, s[8:11], s22 offen offset:0 sc1
  buffer_load_dwordx4 v[244:247], v2, s[8:11], s22 offen offset:1024 sc1
  buffer_load_dwordx4 v[248:251], v2, s[8:11], s22 offen offset:2048 sc1
  buffer_load_dwordx4 v[252:255], v2, s[8:11], s22 offen offset:3072 sc1
  s_mul_i32 s22, s17, 28
  s_add_u32 s23, s22, 27
  s_lshr_b32 s22, s22, 6
  s_lshr_b32 s23, s23, 6
  s_sub_u32 s23, s23, s22
  s_lshl_b32 s23, s23, 8
  v_and_b32 v36, s23, v2
  v_med3_u32 v37, v117, 10, 11
  v_lshl_add_u32 v36, v37, 4, v36
  s_lshl_b32 s22, s22, 8
  s_add_u32 s22, s22, 88588288
  s_mov_b32 s30, 0
va_bw_12:
  buffer_load_dwordx4 v[40:43], v36, s[8:11], s22 offen sc1
  s_waitcnt vmcnt(0)
  v_cmp_ne_u64 vcc, s[88:89], v[40:41]
  s_cbranch_vccnz va_bw_12_no
  v_cmp_ne_u64 vcc, s[88:89], v[42:43]
  s_cbranch_vccnz va_bw_12_no
  s_branch va_bw_12_ok
va_bw_12_no:
  s_sleep 2
  s_add_u32 s30, s30, 1
  s_cmp_lt_u32 s30, 50000
  s_cbranch_scc1 va_bw_12
  s_branch cA_abort
va_bw_12_ok:
  s_mov_b32 m0, 16384
  s_add_u32 s22, s31, 272384
  buffer_load_dwordx4 v2, s[8:11], s22 offen offset:0 sc1 lds
  buffer_load_dwordx4 v2, s[8:11], s22 offen offset:1024 sc1 lds
  buffer_load_dwordx4 v2, s[8:11], s22 offen offset:2048 sc1 lds
  buffer_load_dwordx4 v2, s[8:11], s22 offen offset:3072 sc1 lds
  s_mov_b32 m0, 20480
  s_add_u32 s22, s31, 276480
  buffer_load_dwordx4 v2, s[8:11], s22 offen offset:0 sc1 lds
  buffer_load_dwordx4 v2, s[8:11], s22 offen offset:1024 sc1 lds
  buffer_load_dwordx4 v2, s[8:11], s22 offen offset:2048 sc1 lds
  buffer_load_dwordx4 v2, s[8:11], s22 offen offset:3072 sc1 lds
  s_mov_b32 m0, 24576
  s_add_u32 s22, s31, 280576
  buffer_load_dwordx4 v2, s[8:11], s22 offen offset:0 sc1 lds
  buffer_load_dwordx4 v2, s[8:11], s22 offen offset:1024 sc1 lds
  buffer_load_dwordx4 v2, s[8:11], s22 offen offset:2048 sc1 lds
  buffer_load_dwordx4 v2, s[8:11], s22 offen offset:3072 sc1 lds
  s_mov_b32 m0, 28672
  s_add_u32 s22, s31, 284672
  buffer_load_dwordx4 v2, s[8:11], s22 offen offset:0 sc1 lds
  buffer_load_dwordx4 v2, s[8:11], s22 offen offset:1024 sc1 lds
  v_mov_b32 v72, v116
  v_mov_b32 v73, v117
  v_lshrrev_b32 v65, 1, v72
  v_and_b32 v66, 1, v72
  v_add_u32 v67, 0, v65
  v_lshl_add_u32 v67, v67, 4, v73
  v_mul_u32_u24 v68, 2341, v67
  v_lshrrev_b32 v68, 16, v68
  v_mul_u32_u24 v69, 28, v68
  v_sub_u32 v69, v67, v69
  v_lshrrev_b32 v70, 4, v69
  v_and_b32 v69, 15, v69
  v_and_b32 v71, 1, v69
  v_lshrrev_b32 v69, 1, v69
  v_lshl_add_u32 v69, v71, 3, v69
  v_lshlrev_b32 v71, 12, v70
  v_lshrrev_b32 v70, 1, v68
  v_lshl_add_u32 v71, v70, 9, v71
  v_and_b32 v70, 1, v68
  v_lshl_add_u32 v71, v70, 2, v71
  v_lshl_add_u32 v71, v69, 4, v71
  v_lshl_add_u32 v60, v66, 8, v71
  v_add_u32 v67, 2, v65
  v_lshl_add_u32 v67, v67, 4, v73
  v_mul_u32_u24 v68, 2341, v67
  v_lshrrev_b32 v68, 16, v68
  v_mul_u32_u24 v69, 28, v68
  v_sub_u32 v69, v67, v69
  v_lshrrev_b32 v70, 4, v69
  v_and_b32 v69, 15, v69
  v_and_b32 v71, 1, v69
  v_lshrrev_b32 v69, 1, v69
  v_lshl_add_u32 v69, v71, 3, v69
  v_lshlrev_b32 v71, 12, v70
  v_lshrrev_b32 v70, 1, v68
  v_lshl_add_u32 v71, v70, 9, v71
  v_and_b32 v70, 1, v68
  v_lshl_add_u32 v71, v70, 2, v71
  v_lshl_add_u32 v71, v69, 4, v71
  v_lshl_add_u32 v61, v66, 8, v71
  v_add_u32 v67, 4, v65
  v_lshl_add_u32 v67, v67, 4, v73
  v_mul_u32_u24 v68, 2341, v67
  v_lshrrev_b32 v68, 16, v68
  v_mul_u32_u24 v69, 28, v68
  v_sub_u32 v69, v67, v69
  v_lshrrev_b32 v70, 4, v69
  v_and_b32 v69, 15, v69
  v_and_b32 v71, 1, v69
  v_lshrrev_b32 v69, 1, v69
  v_lshl_add_u32 v69, v71, 3, v69
  v_lshlrev_b32 v71, 12, v70
  v_lshrrev_b32 v70, 1, v68
  v_lshl_add_u32 v71, v70, 9, v71
  v_and_b32 v70, 1, v68
  v_lshl_add_u32 v71, v70, 2, v71
  v_lshl_add_u32 v71, v69, 4, v71
  v_lshl_add_u32 v62, v66, 8, v71
  v_and_b32 v0, 31, v1
  v_lshlrev_b32 v0, 2, v0
  v_add_u32 v0, 21504, v0
  v_lshlrev_b32 v4, 2, v73
  s_and_b32 s22, s17, 15
  s_lshl_b32 s22, s22, 7
  s_add_u32 s22, s22, 17408
  v_add_u32 v4, s22, v4
  v_and_b32 v64, 7, v73
  v_lshlrev_b32 v5, 4, v64
  v_lshl_add_u32 v5, v72, 7, v5
  v_lshrrev_b32 v65, 3, v73
  v_lshl_add_u32 v5, v65, 9, v5
  s_lshl_b32 s22, s17, 3
  s_add_u32 s22, s22, 21504
  v_lshl_add_u32 v7, v2, 3, s22
  v_add_u32 v65, 0, v73
  v_min_u32 v65, 27, v65
  v_mad_u32_u24 v65, v72, 28, v65
  v_lshlrev_b32 v6, 4, v65
  s_lshr_b32 s22, s17, 1
  s_mul_i32 s22, s22, 7
  s_and_b32 s34, s17, 1
  s_lshl_b32 s35, s34, 2
  v_add_u32 v70, s35, v72
  v_mov_b32 v71, s34
  v_mov_b32 v69, 0
  v_cmp_eq_u32 vcc, 3, v72
  s_nop 1
  v_cndmask_b32 v70, v70, v72, vcc
  v_cndmask_b32 v69, v69, v71, vcc
  v_add_u32 v70, s22, v70
  v_lshrrev_b32 v68, 1, v70
  v_lshlrev_b32 v68, 8, v68
  v_lshl_add_u32 v68, v69, 7, v68
  v_and_b32 v69, 1, v70
  v_lshl_add_u32 v68, v69, 3, v68
  v_lshl_add_u32 v1, v64, 4, v68
  v_cmp_gt_u32 s[26:27], 8, v73
  v_lshrrev_b32 v65, 3, v73
  v_lshl_add_u32 v66, v64, 1, v65
  v_add_u32 v66, 0, v66
  v_min_u32 v66, 27, v66
  v_mad_u32_u24 v66, v72, 28, v66
  v_lshlrev_b32 v6, 4, v66
  s_mul_i32 s22, s17, 28
  s_add_u32 s22, s22, 0
  v_lshl_add_u32 v70, v64, 1, s22
  v_lshrrev_b32 v68, 4, v70
  v_lshlrev_b32 v68, 8, v68
  v_bfe_u32 v69, v70, 1, 1
  v_lshl_add_u32 v68, v69, 7, v68
  v_bfe_u32 v69, v70, 2, 2
  v_lshl_add_u32 v68, v69, 2, v68
  v_and_b32 v69, 1, v72
  v_lshl_add_u32 v65, v69, 2, v65
  v_lshrrev_b32 v69, 1, v72
  v_lshl_add_u32 v65, v69, 1, v65
  v_lshrrev_b32 v65, 3, v73
  v_lshl_add_u32 v65, v72, 1, v65
  v_lshrrev_b32 v5, 1, v72
  v_lshlrev_b32 v5, 9, v5
  v_lshrrev_b32 v69, 2, v73
  v_lshl_add_u32 v5, v69, 7, v5
  v_and_b32 v69, 1, v72
  v_lshl_add_u32 v5, v69, 6, v5
  v_and_b32 v69, 3, v73
  v_lshl_add_u32 v5, v69, 4, v5
  v_and_b32 v69, 1, v73
  v_mul_u32_u24 v69, 0xaaaa, v69
  v_add_u32 v0, 0x4444, v69
  v_lshl_add_u32 v1, v65, 4, v68
  v_cmp_gt_u32 s[26:27], 6, v64
  v_mov_b32 v156, 0
  v_mov_b32 v157, 0
  v_mov_b32 v158, 0
  v_mov_b32 v159, 0
  ds_write_b128 v2, v[156:159] offset:0
  ds_write_b128 v2, v[156:159] offset:1024
  ds_write_b128 v2, v[156:159] offset:2048
  ds_write_b128 v2, v[156:159] offset:3072
  s_mul_i32 s22, s17, 1835008
  s_add_u32 s25, s22, 42205184
  s_lshl_b32 s35, s17, 7
  s_add_u32 s35, s35, 88526848
  s_mov_b32 s38, 0
  v_mov_b32 v63, 0
  s_lshl_b32 s22, 0, 11
  s_add_u32 s22, s22, 88590336
  v_add_u32 v36, 1024, v2
  v_min_u32 v36, 1776, v36
  s_mov_b32 s30, 0
va_iw4:
  buffer_load_dwordx4 v[40:43], v2, s[8:11], s22 offen sc1
  buffer_load_dwordx4 v[44:47], v36, s[8:11], s22 offen sc1
  s_waitcnt vmcnt(0)
  v_cmp_ne_u64 vcc, s[88:89], v[40:41]
  s_cbranch_vccnz va_iw4_no
  v_cmp_ne_u64 vcc, s[88:89], v[42:43]
  s_cbranch_vccnz va_iw4_no
  v_cmp_ne_u64 vcc, s[88:89], v[44:45]
  s_cbranch_vccnz va_iw4_no
  v_cmp_ne_u64 vcc, s[88:89], v[46:47]
  s_cbranch_vccnz va_iw4_no
  s_branch va_iw4_ok
va_iw4_no:
  s_sleep 2
  s_add_u32 s30, s30, 1
  s_cmp_lt_u32 s30, 50000
  s_cbranch_scc1 va_iw4
  s_branch cA_abort
va_iw4_ok:
  s_mov_b32 s30, 0
  v_mov_b32 v36, 0
ch_md4:
  buffer_load_dword v37, v36, s[12:15], 0 offen sc1
  s_waitcnt vmcnt(0)
  v_readfirstlane_b32 s22, v37
  s_and_b32 s31, s22, 0xffff
  s_cmp_ge_u32 s31, 32
  s_cbranch_scc1 ch_go4
  s_sleep 2
  s_add_u32 s30, s30, 1
  s_cmp_lt_u32 s30, 50000
  s_cbranch_scc1 ch_md4
  s_branch ch_end
ch_go4:
  s_mov_b32 s31, 0
  v_mov_b32 v36, 0
  v_mov_b32 v37, 0
  v_mov_b32 v38, 0
  v_mov_b32 v39, 0
  v_mov_b32 v40, 0
  v_mov_b32 v41, 0
  v_mov_b32 v42, 0
  v_mov_b32 v43, 0
  v_mov_b32 v44, 0
  v_mov_b32 v45, 0
  v_mov_b32 v46, 0
  v_mov_b32 v47, 0
  v_mov_b32 v48, 0
  v_mov_b32 v49, 0
  v_mov_b32 v50, 0
  v_mov_b32 v51, 0
  v_mov_b32 v52, 0
  v_mov_b32 v53, 0
  v_mov_b32 v54, 0
  v_mov_b32 v55, 0
  v_mov_b32 v56, 0
  v_mov_b32 v57, 0
  v_mov_b32 v58, 0
  v_mov_b32 v59, 0
  s_lshr_b32 s22, s22, 16
  s_cmp_lg_u32 s22, 0
  s_cbranch_scc1 cB_va0_loop
  s_branch cA_va0_loop
ch_init5:
  s_mul_i32 s31, s17, 401408
  s_add_u32 s31, s31, 6422528
  s_mul_i32 s22, s17, 28
  s_add_u32 s23, s22, 27
  s_lshr_b32 s22, s22, 6
  s_lshr_b32 s23, s23, 6
  s_sub_u32 s23, s23, s22
  s_lshl_b32 s23, s23, 8
  v_and_b32 v36, s23, v2
  v_med3_u32 v37, v117, 3, 6
  v_lshl_add_u32 v36, v37, 4, v36
  s_lshl_b32 s22, s22, 8
  s_add_u32 s22, s22, 88588288
  s_mov_b32 s30, 0
va_bw_13:
  buffer_load_dwordx4 v[40:43], v36, s[8:11], s22 offen sc1
  s_waitcnt vmcnt(0)
  v_cmp_ne_u64 vcc, s[88:89], v[40:41]
  s_cbranch_vccnz va_bw_13_no
  v_cmp_ne_u64 vcc, s[88:89], v[42:43]
  s_cbranch_vccnz va_bw_13_no
  s_branch va_bw_13_ok
va_bw_13_no:
  s_sleep 2
  s_add_u32 s30, s30, 1
  s_cmp_lt_u32 s30, 50000
  s_cbranch_scc1 va_bw_13
  s_branch cA_abort
va_bw_13_ok:
  s_add_u32 s22, s31, 86016
  buffer_load_dwordx4 a[0:3], v2, s[8:11], s22 offen offset:0 sc1
  buffer_load_dwordx4 a[4:7], v2, s[8:11], s22 offen offset:1024 sc1
  buffer_load_dwordx4 a[8:11], v2, s[8:11], s22 offen offset:2048 sc1
  buffer_load_dwordx4 a[12:15], v2, s[8:11], s22 offen offset:3072 sc1
  s_add_u32 s22, s31, 90112
  buffer_load_dwordx4 a[16:19], v2, s[8:11], s22 offen offset:0 sc1
  buffer_load_dwordx4 a[20:23], v2, s[8:11], s22 offen offset:1024 sc1
  buffer_load_dwordx4 a[24:27], v2, s[8:11], s22 offen offset:2048 sc1
  buffer_load_dwordx4 a[28:31], v2, s[8:11], s22 offen offset:3072 sc1
  s_add_u32 s22, s31, 94208
  buffer_load_dwordx4 a[32:35], v2, s[8:11], s22 offen offset:0 sc1
  buffer_load_dwordx4 a[36:39], v2, s[8:11], s22 offen offset:1024 sc1
  buffer_load_dwordx4 a[40:43], v2, s[8:11], s22 offen offset:2048 sc1
  buffer_load_dwordx4 a[44:47], v2, s[8:11], s22 offen offset:3072 sc1
  s_add_u32 s22, s31, 98304
  buffer_load_dwordx4 a[48:51], v2, s[8:11], s22 offen offset:0 sc1
  buffer_load_dwordx4 a[52:55], v2, s[8:11], s22 offen offset:1024 sc1
  buffer_load_dwordx4 a[56:59], v2, s[8:11], s22 offen offset:2048 sc1
  buffer_load_dwordx4 a[60:63], v2, s[8:11], s22 offen offset:3072 sc1
  s_add_u32 s22, s31, 102400
  buffer_load_dwordx4 a[64:67], v2, s[8:11], s22 offen offset:0 sc1
  buffer_load_dwordx4 a[68:71], v2, s[8:11], s22 offen offset:1024 sc1
  buffer_load_dwordx4 a[72:75], v2, s[8:11], s22 offen offset:2048 sc1
  buffer_load_dwordx4 a[76:79], v2, s[8:11], s22 offen offset:3072 sc1
  s_add_u32 s22, s31, 106496
  buffer_load_dwordx4 a[80:83], v2, s[8:11], s22 offen offset:0 sc1
  buffer_load_dwordx4 a[84:87], v2, s[8:11], s22 offen offset:1024 sc1
  buffer_load_dwordx4 a[88:91], v2, s[8:11], s22 offen offset:2048 sc1
  buffer_load_dwordx4 a[92:95], v2, s[8:11], s22 offen offset:3072 sc1
  s_add_u32 s22, s31, 110592
  buffer_load_dwordx4 a[96:99], v2, s[8:11], s22 offen offset:0 sc1
  buffer_load_dwordx4 a[100:103], v2, s[8:11], s22 offen offset:1024 sc1
  buffer_load_dwordx4 a[104:107], v2, s[8:11], s22 offen offset:2048 sc1
  buffer_load_dwordx4 a[108:111], v2, s[8:11], s22 offen offset:3072 sc1
  s_add_u32 s22, s31, 114688
  buffer_load_dwordx4 a[112:115], v2, s[8:11], s22 offen offset:0 sc1
  buffer_load_dwordx4 a[116:119], v2, s[8:11], s22 offen offset:1024 sc1
  buffer_load_dwordx4 a[120:123], v2, s[8:11], s22 offen offset:2048 sc1
  buffer_load_dwordx4 a[124:127], v2, s[8:11], s22 offen offset:3072 sc1
  s_waitcnt vmcnt(24)
  s_add_u32 s22, s31, 118784
  buffer_load_dwordx4 a[128:131], v2, s[8:11], s22 offen offset:0 sc1
  buffer_load_dwordx4 a[132:135], v2, s[8:11], s22 offen offset:1024 sc1
  buffer_load_dwordx4 a[136:139], v2, s[8:11], s22 offen offset:2048 sc1
  buffer_load_dwordx4 a[140:143], v2, s[8:11], s22 offen offset:3072 sc1
  s_add_u32 s22, s31, 122880
  buffer_load_dwordx4 a[144:147], v2, s[8:11], s22 offen offset:0 sc1
  buffer_load_dwordx4 a[148:151], v2, s[8:11], s22 offen offset:1024 sc1
  buffer_load_dwordx4 a[152:155], v2, s[8:11], s22 offen offset:2048 sc1
  buffer_load_dwordx4 a[156:159], v2, s[8:11], s22 offen offset:3072 sc1
  s_add_u32 s22, s31, 126976
  buffer_load_dwordx4 a[160:163], v2, s[8:11], s22 offen offset:0 sc1
  buffer_load_dwordx4 a[164:167], v2, s[8:11], s22 offen offset:1024 sc1
  buffer_load_dwordx4 a[168:171], v2, s[8:11], s22 offen offset:2048 sc1
  buffer_load_dwordx4 a[172:175], v2, s[8:11], s22 offen offset:3072 sc1
  s_add_u32 s22, s31, 131072
  buffer_load_dwordx4 a[176:179], v2, s[8:11], s22 offen offset:0 sc1
  buffer_load_dwordx4 a[180:183], v2, s[8:11], s22 offen offset:1024 sc1
  buffer_load_dwordx4 a[184:187], v2, s[8:11], s22 offen offset:2048 sc1
  buffer_load_dwordx4 a[188:191], v2, s[8:11], s22 offen offset:3072 sc1
  s_add_u32 s22, s31, 135168
  buffer_load_dwordx4 a[192:195], v2, s[8:11], s22 offen offset:0 sc1
  buffer_load_dwordx4 a[196:199], v2, s[8:11], s22 offen offset:1024 sc1
  buffer_load_dwordx4 a[200:203], v2, s[8:11], s22 offen offset:2048 sc1
  buffer_load_dwordx4 a[204:207], v2, s[8:11], s22 offen offset:3072 sc1
  s_add_u32 s22, s31, 139264
  buffer_load_dwordx4 a[208:211], v2, s[8:11], s22 offen offset:0 sc1
  buffer_load_dwordx4 a[212:215], v2, s[8:11], s22 offen offset:1024 sc1
  buffer_load_dwordx4 a[216:219], v2, s[8:11], s22 offen offset:2048 sc1
  buffer_load_dwordx4 a[220:223], v2, s[8:11], s22 offen offset:3072 sc1
  s_add_u32 s22, s31, 143360
  buffer_load_dwordx4 a[224:227], v2, s[8:11], s22 offen offset:0 sc1
  buffer_load_dwordx4 a[228:231], v2, s[8:11], s22 offen offset:1024 sc1
  buffer_load_dwordx4 a[232:235], v2, s[8:11], s22 offen offset:2048 sc1
  buffer_load_dwordx4 a[236:239], v2, s[8:11], s22 offen offset:3072 sc1
  s_add_u32 s22, s31, 147456
  buffer_load_dwordx4 a[240:243], v2, s[8:11], s22 offen offset:0 sc1
  buffer_load_dwordx4 a[244:247], v2, s[8:11], s22 offen offset:1024 sc1
  buffer_load_dwordx4 a[248:251], v2, s[8:11], s22 offen offset:2048 sc1
  buffer_load_dwordx4 a[252:255], v2, s[8:11], s22 offen offset:3072 sc1
  s_waitcnt vmcnt(24)
  s_add_u32 s22, s31, 151552
  buffer_load_dwordx4 v[176:179], v2, s[8:11], s22 offen offset:0 sc1
  buffer_load_dwordx4 v[180:183], v2, s[8:11], s22 offen offset:1024 sc1
  buffer_load_dwordx4 v[184:187], v2, s[8:11], s22 offen offset:2048 sc1
  buffer_load_dwordx4 v[188:191], v2, s[8:11], s22 offen offset:3072 sc1
  s_add_u32 s22, s31, 155648
  buffer_load_dwordx4 v[192:195], v2, s[8:11], s22 offen offset:0 sc1
  buffer_load_dwordx4 v[196:199], v2, s[8:11], s22 offen offset:1024 sc1
  buffer_load_dwordx4 v[200:203], v2, s[8:11], s22 offen offset:2048 sc1
  buffer_load_dwordx4 v[204:207], v2, s[8:11], s22 offen offset:3072 sc1
  s_add_u32 s22, s31, 159744
  buffer_load_dwordx4 v[208:211], v2, s[8:11], s22 offen offset:0 sc1
  buffer_load_dwordx4 v[212:215], v2, s[8:11], s22 offen offset:1024 sc1
  buffer_load_dwordx4 v[216:219], v2, s[8:11], s22 offen offset:2048 sc1
  buffer_load_dwordx4 v[220:223], v2, s[8:11], s22 offen offset:3072 sc1
  s_add_u32 s22, s31, 163840
  buffer_load_dwordx4 v[224:227], v2, s[8:11], s22 offen offset:0 sc1
  buffer_load_dwordx4 v[228:231], v2, s[8:11], s22 offen offset:1024 sc1
  buffer_load_dwordx4 v[232:235], v2, s[8:11], s22 offen offset:2048 sc1
  buffer_load_dwordx4 v[236:239], v2, s[8:11], s22 offen offset:3072 sc1
  s_add_u32 s22, s31, 167936
  buffer_load_dwordx4 v[240:243], v2, s[8:11], s22 offen offset:0 sc1
  buffer_load_dwordx4 v[244:247], v2, s[8:11], s22 offen offset:1024 sc1
  buffer_load_dwordx4 v[248:251], v2, s[8:11], s22 offen offset:2048 sc1
  buffer_load_dwordx4 v[252:255], v2, s[8:11], s22 offen offset:3072 sc1
  s_mul_i32 s22, s17, 28
  s_add_u32 s23, s22, 27
  s_lshr_b32 s22, s22, 6
  s_lshr_b32 s23, s23, 6
  s_sub_u32 s23, s23, s22
  s_lshl_b32 s23, s23, 8
  v_and_b32 v36, s23, v2
  v_med3_u32 v37, v117, 15, 15
  v_lshl_add_u32 v36, v37, 4, v36
  s_lshl_b32 s22, s22, 8
  s_add_u32 s22, s22, 88588288
  s_mov_b32 s30, 0
va_bw_14:
  buffer_load_dwordx4 v[40:43], v36, s[8:11], s22 offen sc1
  s_waitcnt vmcnt(0)
  v_cmp_ne_u64 vcc, s[88:89], v[40:41]
  s_cbranch_vccnz va_bw_14_no
  v_cmp_ne_u64 vcc, s[88:89], v[42:43]
  s_cbranch_vccnz va_bw_14_no
  s_branch va_bw_14_ok
va_bw_14_no:
  s_sleep 2
  s_add_u32 s30, s30, 1
  s_cmp_lt_u32 s30, 50000
  s_cbranch_scc1 va_bw_14
  s_branch cA_abort
va_bw_14_ok:
  s_mov_b32 m0, 59392
  s_add_u32 s22, s31, 387072
  buffer_load_dwordx4 v2, s[8:11], s22 offen offset:0 sc1 lds
  buffer_load_dwordx4 v2, s[8:11], s22 offen offset:1024 sc1 lds
  buffer_load_dwordx4 v2, s[8:11], s22 offen offset:2048 sc1 lds
  buffer_load_dwordx4 v2, s[8:11], s22 offen offset:3072 sc1 lds
  s_mov_b32 m0, 63488
  s_add_u32 s22, s31, 391168
  buffer_load_dwordx4 v2, s[8:11], s22 offen offset:0 sc1 lds
  buffer_load_dwordx4 v2, s[8:11], s22 offen offset:1024 sc1 lds
  buffer_load_dwordx4 v2, s[8:11], s22 offen offset:2048 sc1 lds
  buffer_load_dwordx4 v2, s[8:11], s22 offen offset:3072 sc1 lds
  s_mov_b32 m0, 67584
  s_add_u32 s22, s31, 395264
  buffer_load_dwordx4 v2, s[8:11], s22 offen offset:0 sc1 lds
  buffer_load_dwordx4 v2, s[8:11], s22 offen offset:1024 sc1 lds
  buffer_load_dwordx4 v2, s[8:11], s22 offen offset:2048 sc1 lds
  buffer_load_dwordx4 v2, s[8:11], s22 offen offset:3072 sc1 lds
  s_mov_b32 m0, 71680
  s_add_u32 s22, s31, 399360
  buffer_load_dwordx4 v2, s[8:11], s22 offen offset:0 sc1 lds
  buffer_load_dwordx4 v2, s[8:11], s22 offen offset:1024 sc1 lds
  v_mov_b32 v72, v116
  v_mov_b32 v73, v117
  v_lshrrev_b32 v65, 1, v72
  v_and_b32 v66, 1, v72
  v_add_u32 v67, 6, v65
  v_lshl_add_u32 v67, v67, 4, v73
  v_mul_u32_u24 v68, 2341, v67
  v_lshrrev_b32 v68, 16, v68
  v_mul_u32_u24 v69, 28, v68
  v_sub_u32 v69, v67, v69
  v_lshrrev_b32 v70, 4, v69
  v_and_b32 v69, 15, v69
  v_and_b32 v71, 1, v69
  v_lshrrev_b32 v69, 1, v69
  v_lshl_add_u32 v69, v71, 3, v69
  v_lshlrev_b32 v71, 12, v70
  v_lshrrev_b32 v70, 1, v68
  v_lshl_add_u32 v71, v70, 9, v71
  v_and_b32 v70, 1, v68
  v_lshl_add_u32 v71, v70, 2, v71
  v_lshl_add_u32 v71, v69, 4, v71
  v_lshl_add_u32 v60, v66, 8, v71
  v_add_u32 v67, 8, v65
  v_lshl_add_u32 v67, v67, 4, v73
  v_mul_u32_u24 v68, 2341, v67
  v_lshrrev_b32 v68, 16, v68
  v_mul_u32_u24 v69, 28, v68
  v_sub_u32 v69, v67, v69
  v_lshrrev_b32 v70, 4, v69
  v_and_b32 v69, 15, v69
  v_and_b32 v71, 1, v69
  v_lshrrev_b32 v69, 1, v69
  v_lshl_add_u32 v69, v71, 3, v69
  v_lshlrev_b32 v71, 12, v70
  v_lshrrev_b32 v70, 1, v68
  v_lshl_add_u32 v71, v70, 9, v71
  v_and_b32 v70, 1, v68
  v_lshl_add_u32 v71, v70, 2, v71
  v_lshl_add_u32 v71, v69, 4, v71
  v_lshl_add_u32 v61, v66, 8, v71
  v_add_u32 v67, 10, v65
  v_lshl_add_u32 v67, v67, 4, v73
  v_mul_u32_u24 v68, 2341, v67
  v_lshrrev_b32 v68, 16, v68
  v_mul_u32_u24 v69, 28, v68
  v_sub_u32 v69, v67, v69
  v_lshrrev_b32 v70, 4, v69
  v_and_b32 v69, 15, v69
  v_and_b32 v71, 1, v69
  v_lshrrev_b32 v69, 1, v69
  v_lshl_add_u32 v69, v71, 3, v69
  v_lshlrev_b32 v71, 12, v70
  v_lshrrev_b32 v70, 1, v68
  v_lshl_add_u32 v71, v70, 9, v71
  v_and_b32 v70, 1, v68
  v_lshl_add_u32 v71, v70, 2, v71
  v_lshl_add_u32 v71, v69, 4, v71
  v_lshl_add_u32 v62, v66, 8, v71
  v_and_b32 v0, 31, v1
  v_lshlrev_b32 v0, 2, v0
  v_add_u32 v0, 21504, v0
  v_lshlrev_b32 v4, 2, v73
  s_and_b32 s22, s17, 15
  s_lshl_b32 s22, s22, 7
  s_add_u32 s22, s22, 17408
  v_add_u32 v4, s22, v4
  v_and_b32 v64, 7, v73
  v_lshlrev_b32 v5, 4, v64
  v_lshl_add_u32 v5, v72, 7, v5
  v_lshrrev_b32 v65, 3, v73
  v_lshl_add_u32 v5, v65, 9, v5
  s_lshl_b32 s22, s17, 3
  s_add_u32 s22, s22, 21508
  v_lshl_add_u32 v7, v2, 3, s22
  v_add_u32 v65, 16, v73
  v_min_u32 v65, 27, v65
  v_mad_u32_u24 v65, v72, 28, v65
  v_lshlrev_b32 v6, 4, v65
  s_lshr_b32 s22, s17, 1
  s_mul_i32 s22, s22, 7
  s_and_b32 s34, s17, 1
  s_lshl_b32 s35, s34, 2
  v_add_u32 v70, s35, v72
  v_mov_b32 v71, s34
  v_mov_b32 v69, 1
  v_cmp_eq_u32 vcc, 3, v72
  s_nop 1
  v_cndmask_b32 v70, v70, v72, vcc
  v_cndmask_b32 v69, v69, v71, vcc
  v_add_u32 v70, s22, v70
  v_lshrrev_b32 v68, 1, v70
  v_lshlrev_b32 v68, 8, v68
  v_lshl_add_u32 v68, v69, 7, v68
  v_and_b32 v69, 1, v70
  v_lshl_add_u32 v68, v69, 3, v68
  v_lshl_add_u32 v1, v64, 4, v68
  v_cmp_gt_u32 s[26:27], 8, v73
  v_cmp_gt_u32 vcc, 3, v72
  s_and_b64 s[26:27], s[26:27], vcc
  v_lshrrev_b32 v65, 3, v73
  v_lshl_add_u32 v66, v64, 1, v65
  v_add_u32 v66, 16, v66
  v_min_u32 v66, 27, v66
  v_mad_u32_u24 v66, v72, 28, v66
  v_lshlrev_b32 v6, 4, v66
  s_mul_i32 s22, s17, 28
  s_add_u32 s22, s22, 16
  v_lshl_add_u32 v70, v64, 1, s22
  v_lshrrev_b32 v68, 4, v70
  v_lshlrev_b32 v68, 8, v68
  v_bfe_u32 v69, v70, 1, 1
  v_lshl_add_u32 v68, v69, 7, v68
  v_bfe_u32 v69, v70, 2, 2
  v_lshl_add_u32 v68, v69, 2, v68
  v_and_b32 v69, 1, v72
  v_lshl_add_u32 v65, v69, 2, v65
  v_lshrrev_b32 v69, 1, v72
  v_lshl_add_u32 v65, v69, 1, v65
  v_lshrrev_b32 v65, 3, v73
  v_lshl_add_u32 v65, v72, 1, v65
  v_lshrrev_b32 v5, 1, v72
  v_lshlrev_b32 v5, 9, v5
  v_lshrrev_b32 v69, 2, v73
  v_lshl_add_u32 v5, v69, 7, v5
  v_and_b32 v69, 1, v72
  v_lshl_add_u32 v5, v69, 6, v5
  v_and_b32 v69, 3, v73
  v_lshl_add_u32 v5, v69, 4, v5
  v_and_b32 v69, 1, v73
  v_mul_u32_u24 v69, 0xaaaa, v69
  v_add_u32 v0, 0x4444, v69
  v_lshl_add_u32 v1, v65, 4, v68
  v_cmp_gt_u32 s[26:27], 6, v64
  v_mov_b32 v156, 0
  v_mov_b32 v157, 0
  v_mov_b32 v158, 0
  v_mov_b32 v159, 0
  ds_write_b128 v2, v[156:159] offset:4096
  ds_write_b128 v2, v[156:159] offset:5120
  ds_write_b128 v2, v[156:159] offset:6144
  ds_write_b128 v2, v[156:159] offset:7168
  s_mul_i32 s22, s17, 1835008
  s_add_u32 s25, s22, 42205184
  s_lshl_b32 s35, s17, 7
  s_add_u32 s35, s35, 88526848
  s_mov_b32 s38, 0
  v_mov_b32 v63, 0
  s_lshl_b32 s22, 0, 11
  s_add_u32 s22, s22, 88590336
  v_add_u32 v36, 1024, v2
  v_min_u32 v36, 1776, v36
  s_mov_b32 s30, 0
va_iw5:
  buffer_load_dwordx4 v[40:43], v2, s[8:11], s22 offen sc1
  buffer_load_dwordx4 v[44:47], v36, s[8:11], s22 offen sc1
  s_waitcnt vmcnt(0)
  v_cmp_ne_u64 vcc, s[88:89], v[40:41]
  s_cbranch_vccnz va_iw5_no
  v_cmp_ne_u64 vcc, s[88:89], v[42:43]
  s_cbranch_vccnz va_iw5_no
  v_cmp_ne_u64 vcc, s[88:89], v[44:45]
  s_cbranch_vccnz va_iw5_no
  v_cmp_ne_u64 vcc, s[88:89], v[46:47]
  s_cbranch_vccnz va_iw5_no
  s_branch va_iw5_ok
va_iw5_no:
  s_sleep 2
  s_add_u32 s30, s30, 1
  s_cmp_lt_u32 s30, 50000
  s_cbranch_scc1 va_iw5
  s_branch cA_abort
va_iw5_ok:
  s_mov_b32 s30, 0
  v_mov_b32 v36, 0
ch_md5:
  buffer_load_dword v37, v36, s[12:15], 0 offen sc1
  s_waitcnt vmcnt(0)
  v_readfirstlane_b32 s22, v37
  s_and_b32 s31, s22, 0xffff
  s_cmp_ge_u32 s31, 32
  s_cbranch_scc1 ch_go5
  s_sleep 2
  s_add_u32 s30, s30, 1
  s_cmp_lt_u32 s30, 50000
  s_cbranch_scc1 ch_md5
  s_branch ch_end
ch_go5:
  s_mov_b32 s31, 0
  v_mov_b32 v36, 0
  v_mov_b32 v37, 0
  v_mov_b32 v38, 0
  v_mov_b32 v39, 0
  v_mov_b32 v40, 0
  v_mov_b32 v41, 0
  v_mov_b32 v42, 0
  v_mov_b32 v43, 0
  v_mov_b32 v44, 0
  v_mov_b32 v45, 0
  v_mov_b32 v46, 0
  v_mov_b32 v47, 0
  v_mov_b32 v48, 0
  v_mov_b32 v49, 0
  v_mov_b32 v50, 0
  v_mov_b32 v51, 0
  v_mov_b32 v52, 0
  v_mov_b32 v53, 0
  v_mov_b32 v54, 0
  v_mov_b32 v55, 0
  v_mov_b32 v56, 0
  v_mov_b32 v57, 0
  v_mov_b32 v58, 0
  v_mov_b32 v59, 0
  s_lshr_b32 s22, s22, 16
  s_cmp_lg_u32 s22, 0
  s_cbranch_scc1 cB_va1_loop
  s_branch cA_va1_loop
ch_init6:
  s_mul_i32 s31, s17, 401408
  s_add_u32 s31, s31, 6422528
  s_mul_i32 s22, s17, 28
  s_add_u32 s23, s22, 27
  s_lshr_b32 s22, s22, 6
  s_lshr_b32 s23, s23, 6
  s_sub_u32 s23, s23, s22
  s_lshl_b32 s23, s23, 8
  v_and_b32 v36, s23, v2
  v_med3_u32 v37, v117, 6, 10
  v_lshl_add_u32 v36, v37, 4, v36
  s_lshl_b32 s22, s22, 8
  s_add_u32 s22, s22, 88588288
  s_mov_b32 s30, 0
va_bw_15:
  buffer_load_dwordx4 v[40:43], v36, s[8:11], s22 offen sc1
  s_waitcnt vmcnt(0)
  v_cmp_ne_u64 vcc, s[88:89], v[40:41]
  s_cbranch_vccnz va_bw_15_no
  v_cmp_ne_u64 vcc, s[88:89], v[42:43]
  s_cbranch_vccnz va_bw_15_no
  s_branch va_bw_15_ok
va_bw_15_no:
  s_sleep 2
  s_add_u32 s30, s30, 1
  s_cmp_lt_u32 s30, 50000
  s_cbranch_scc1 va_bw_15
  s_branch cA_abort
va_bw_15_ok:
  s_add_u32 s22, s31, 172032
  buffer_load_dwordx4 a[0:3], v2, s[8:11], s22 offen offset:0 sc1
  buffer_load_dwordx4 a[4:7], v2, s[8:11], s22 offen offset:1024 sc1
  buffer_load_dwordx4 a[8:11], v2, s[8:11], s22 offen offset:2048 sc1
  buffer_load_dwordx4 a[12:15], v2, s[8:11], s22 offen offset:3072 sc1
  s_add_u32 s22, s31, 176128
  buffer_load_dwordx4 a[16:19], v2, s[8:11], s22 offen offset:0 sc1
  buffer_load_dwordx4 a[20:23], v2, s[8:11], s22 offen offset:1024 sc1
  buffer_load_dwordx4 a[24:27], v2, s[8:11], s22 offen offset:2048 sc1
  buffer_load_dwordx4 a[28:31], v2, s[8:11], s22 offen offset:3072 sc1
  s_add_u32 s22, s31, 180224
  buffer_load_dwordx4 a[32:35], v2, s[8:11], s22 offen offset:0 sc1
  buffer_load_dwordx4 a[36:39], v2, s[8:11], s22 offen offset:1024 sc1
  buffer_load_dwordx4 a[40:43], v2, s[8:11], s22 offen offset:2048 sc1
  buffer_load_dwordx4 a[44:47], v2, s[8:11], s22 offen offset:3072 sc1
  s_add_u32 s22, s31, 184320
  buffer_load_dwordx4 a[48:51], v2, s[8:11], s22 offen offset:0 sc1
  buffer_load_dwordx4 a[52:55], v2, s[8:11], s22 offen offset:1024 sc1
  buffer_load_dwordx4 a[56:59], v2, s[8:11], s22 offen offset:2048 sc1
  buffer_load_dwordx4 a[60:63], v2, s[8:11], s22 offen offset:3072 sc1
  s_add_u32 s22, s31, 188416
  buffer_load_dwordx4 a[64:67], v2, s[8:11], s22 offen offset:0 sc1
  buffer_load_dwordx4 a[68:71], v2, s[8:11], s22 offen offset:1024 sc1
  buffer_load_dwordx4 a[72:75], v2, s[8:11], s22 offen offset:2048 sc1
  buffer_load_dwordx4 a[76:79], v2, s[8:11], s22 offen offset:3072 sc1
  s_add_u32 s22, s31, 192512
  buffer_load_dwordx4 a[80:83], v2, s[8:11], s22 offen offset:0 sc1
  buffer_load_dwordx4 a[84:87], v2, s[8:11], s22 offen offset:1024 sc1
  buffer_load_dwordx4 a[88:91], v2, s[8:11], s22 offen offset:2048 sc1
  buffer_load_dwordx4 a[92:95], v2, s[8:11], s22 offen offset:3072 sc1
  s_add_u32 s22, s31, 196608
  buffer_load_dwordx4 a[96:99], v2, s[8:11], s22 offen offset:0 sc1
  buffer_load_dwordx4 a[100:103], v2, s[8:11], s22 offen offset:1024 sc1
  buffer_load_dwordx4 a[104:107], v2, s[8:11], s22 offen offset:2048 sc1
  buffer_load_dwordx4 a[108:111], v2, s[8:11], s22 offen offset:3072 sc1
  s_add_u32 s22, s31, 200704
  buffer_load_dwordx4 a[112:115], v2, s[8:11], s22 offen offset:0 sc1
  buffer_load_dwordx4 a[116:119], v2, s[8:11], s22 offen offset:1024 sc1
  buffer_load_dwordx4 a[120:123], v2, s[8:11], s22 offen offset:2048 sc1
  buffer_load_dwordx4 a[124:127], v2, s[8:11], s22 offen offset:3072 sc1
  s_waitcnt vmcnt(24)
  s_add_u32 s22, s31, 204800
  buffer_load_dwordx4 a[128:131], v2, s[8:11], s22 offen offset:0 sc1
  buffer_load_dwordx4 a[132:135], v2, s[8:11], s22 offen offset:1024 sc1
  buffer_load_dwordx4 a[136:139], v2, s[8:11], s22 offen offset:2048 sc1
  buffer_load_dwordx4 a[140:143], v2, s[8:11], s22 offen offset:3072 sc1
  s_add_u32 s22, s31, 208896
  buffer_load_dwordx4 a[144:147], v2, s[8:11], s22 offen offset:0 sc1
  buffer_load_dwordx4 a[148:151], v2, s[8:11], s22 offen offset:1024 sc1
  buffer_load_dwordx4 a[152:155], v2, s[8:11], s22 offen offset:2048 sc1
  buffer_load_dwordx4 a[156:159], v2, s[8:11], s22 offen offset:3072 sc1
  s_add_u32 s22, s31, 212992
  buffer_load_dwordx4 a[160:163], v2, s[8:11], s22 offen offset:0 sc1
  buffer_load_dwordx4 a[164:167], v2, s[8:11], s22 offen offset:1024 sc1
  buffer_load_dwordx4 a[168:171], v2, s[8:11], s22 offen offset:2048 sc1
  buffer_load_dwordx4 a[172:175], v2, s[8:11], s22 offen offset:3072 sc1
  s_add_u32 s22, s31, 217088
  buffer_load_dwordx4 a[176:179], v2, s[8:11], s22 offen offset:0 sc1
  buffer_load_dwordx4 a[180:183], v2, s[8:11], s22 offen offset:1024 sc1
  buffer_load_dwordx4 a[184:187], v2, s[8:11], s22 offen offset:2048 sc1
  buffer_load_dwordx4 a[188:191], v2, s[8:11], s22 offen offset:3072 sc1
  s_add_u32 s22, s31, 221184
  buffer_load_dwordx4 a[192:195], v2, s[8:11], s22 offen offset:0 sc1
  buffer_load_dwordx4 a[196:199], v2, s[8:11], s22 offen offset:1024 sc1
  buffer_load_dwordx4 a[200:203], v2, s[8:11], s22 offen offset:2048 sc1
  buffer_load_dwordx4 a[204:207], v2, s[8:11], s22 offen offset:3072 sc1
  s_add_u32 s22, s31, 225280
  buffer_load_dwordx4 a[208:211], v2, s[8:11], s22 offen offset:0 sc1
  buffer_load_dwordx4 a[212:215], v2, s[8:11], s22 offen offset:1024 sc1
  buffer_load_dwordx4 a[216:219], v2, s[8:11], s22 offen offset:2048 sc1
  buffer_load_dwordx4 a[220:223], v2, s[8:11], s22 offen offset:3072 sc1
  s_add_u32 s22, s31, 229376
  buffer_load_dwordx4 a[224:227], v2, s[8:11], s22 offen offset:0 sc1
  buffer_load_dwordx4 a[228:231], v2, s[8:11], s22 offen offset:1024 sc1
  buffer_load_dwordx4 a[232:235], v2, s[8:11], s22 offen offset:2048 sc1
  buffer_load_dwordx4 a[236:239], v2, s[8:11], s22 offen offset:3072 sc1
  s_add_u32 s22, s31, 233472
  buffer_load_dwordx4 a[240:243], v2, s[8:11], s22 offen offset:0 sc1
  buffer_load_dwordx4 a[244:247], v2, s[8:11], s22 offen offset:1024 sc1
  buffer_load_dwordx4 a[248:251], v2, s[8:11], s22 offen offset:2048 sc1
  buffer_load_dwordx4 a[252:255], v2, s[8:11], s22 offen offset:3072 sc1
  s_waitcnt vmcnt(24)
  s_add_u32 s22, s31, 237568
  buffer_load_dwordx4 v[120:123], v2, s[8:11], s22 offen offset:0 sc1
  buffer_load_dwordx4 v[124:127], v2, s[8:11], s22 offen offset:1024 sc1
  buffer_load_dwordx4 v[128:131], v2, s[8:11], s22 offen offset:2048 sc1
  buffer_load_dwordx4 v[132:135], v2, s[8:11], s22 offen offset:3072 sc1
  s_add_u32 s22, s31, 241664
  buffer_load_dwordx4 v[136:139], v2, s[8:11], s22 offen offset:0 sc1
  buffer_load_dwordx4 v[140:143], v2, s[8:11], s22 offen offset:1024 sc1
  buffer_load_dwordx4 v[144:147], v2, s[8:11], s22 offen offset:2048 sc1
  buffer_load_dwordx4 v[148:151], v2, s[8:11], s22 offen offset:3072 sc1
  s_add_u32 s22, s31, 245760
  buffer_load_dwordx4 v[152:155], v2, s[8:11], s22 offen offset:0 sc1
  buffer_load_dwordx4 v[156:159], v2, s[8:11], s22 offen offset:1024 sc1
  buffer_load_dwordx4 v[160:163], v2, s[8:11], s22 offen offset:2048 sc1
  buffer_load_dwordx4 v[164:167], v2, s[8:11], s22 offen offset:3072 sc1
  s_add_u32 s22, s31, 249856
  buffer_load_dwordx4 v[168:171], v2, s[8:11], s22 offen offset:0 sc1
  buffer_load_dwordx4 v[172:175], v2, s[8:11], s22 offen offset:1024 sc1
  buffer_load_dwordx4 v[176:179], v2, s[8:11], s22 offen offset:2048 sc1
  buffer_load_dwordx4 v[180:183], v2, s[8:11], s22 offen offset:3072 sc1
  s_add_u32 s22, s31, 253952
  buffer_load_dwordx4 v[184:187], v2, s[8:11], s22 offen offset:0 sc1
  buffer_load_dwordx4 v[188:191], v2, s[8:11], s22 offen offset:1024 sc1
  buffer_load_dwordx4 v[192:195], v2, s[8:11], s22 offen offset:2048 sc1
  buffer_load_dwordx4 v[196:199], v2, s[8:11], s22 offen offset:3072 sc1
  s_add_u32 s22, s31, 258048
  buffer_load_dwordx4 v[200:203], v2, s[8:11], s22 offen offset:0 sc1
  buffer_load_dwordx4 v[204:207], v2, s[8:11], s22 offen offset:1024 sc1
  buffer_load_dwordx4 v[208:211], v2, s[8:11], s22 offen offset:2048 sc1
  buffer_load_dwordx4 v[212:215], v2, s[8:11], s22 offen offset:3072 sc1
  s_add_u32 s22, s31, 262144
  buffer_load_dwordx4 v[216:219], v2, s[8:11], s22 offen offset:0 sc1
  buffer_load_dwordx4 v[220:223], v2, s[8:11], s22 offen offset:1024 sc1
  buffer_load_dwordx4 v[224:227], v2, s[8:11], s22 offen offset:2048 sc1
  buffer_load_dwordx4 v[228:231], v2, s[8:11], s22 offen offset:3072 sc1
  s_add_u32 s22, s31, 266240
  buffer_load_dwordx4 v[232:235], v2, s[8:11], s22 offen offset:0 sc1
  buffer_load_dwordx4 v[236:239], v2, s[8:11], s22 offen offset:1024 sc1
  buffer_load_dwordx4 v[240:243], v2, s[8:11], s22 offen offset:2048 sc1
  buffer_load_dwordx4 v[244:247], v2, s[8:11], s22 offen offset:3072 sc1
  s_waitcnt vmcnt(24)
  s_add_u32 s22, s31, 270336
  buffer_load_dwordx4 v[248:251], v2, s[8:11], s22 offen offset:0 sc1
  buffer_load_dwordx4 v[252:255], v2, s[8:11], s22 offen offset:1024 sc1
  v_mov_b32 v72, v116
  v_mov_b32 v73, v117
  v_lshrrev_b32 v65, 1, v72
  v_and_b32 v66, 1, v72
  v_add_u32 v67, 12, v65
  v_lshl_add_u32 v67, v67, 4, v73
  v_mul_u32_u24 v68, 2341, v67
  v_lshrrev_b32 v68, 16, v68
  v_mul_u32_u24 v69, 28, v68
  v_sub_u32 v69, v67, v69
  v_lshrrev_b32 v70, 4, v69
  v_and_b32 v69, 15, v69
  v_and_b32 v71, 1, v69
  v_lshrrev_b32 v69, 1, v69
  v_lshl_add_u32 v69, v71, 3, v69
  v_lshlrev_b32 v71, 12, v70
  v_lshrrev_b32 v70, 1, v68
  v_lshl_add_u32 v71, v70, 9, v71
  v_and_b32 v70, 1, v68
  v_lshl_add_u32 v71, v70, 2, v71
  v_lshl_add_u32 v71, v69, 4, v71
  v_lshl_add_u32 v112, v66, 8, v71
  v_add_u32 v67, 14, v65
  v_lshl_add_u32 v67, v67, 4, v73
  v_mul_u32_u24 v68, 2341, v67
  v_lshrrev_b32 v68, 16, v68
  v_mul_u32_u24 v69, 28, v68
  v_sub_u32 v69, v67, v69
  v_lshrrev_b32 v70, 4, v69
  v_and_b32 v69, 15, v69
  v_and_b32 v71, 1, v69
  v_lshrrev_b32 v69, 1, v69
  v_lshl_add_u32 v69, v71, 3, v69
  v_lshlrev_b32 v71, 12, v70
  v_lshrrev_b32 v70, 1, v68
  v_lshl_add_u32 v71, v70, 9, v71
  v_and_b32 v70, 1, v68
  v_lshl_add_u32 v71, v70, 2, v71
  v_lshl_add_u32 v71, v69, 4, v71
  v_lshl_add_u32 v113, v66, 8, v71
  v_add_u32 v67, 16, v65
  v_lshl_add_u32 v67, v67, 4, v73
  v_mul_u32_u24 v68, 2341, v67
  v_lshrrev_b32 v68, 16, v68
  v_mul_u32_u24 v69, 28, v68
  v_sub_u32 v69, v67, v69
  v_lshrrev_b32 v70, 4, v69
  v_and_b32 v69, 15, v69
  v_and_b32 v71, 1, v69
  v_lshrrev_b32 v69, 1, v69
  v_lshl_add_u32 v69, v71, 3, v69
  v_lshlrev_b32 v71, 12, v70
  v_lshrrev_b32 v70, 1, v68
  v_lshl_add_u32 v71, v70, 9, v71
  v_and_b32 v70, 1, v68
  v_lshl_add_u32 v71, v70, 2, v71
  v_lshl_add_u32 v71, v69, 4, v71
  v_lshl_add_u32 v114, v66, 8, v71
  v_add_u32 v67, 18, v65
  v_lshl_add_u32 v67, v67, 4, v73
  v_mul_u32_u24 v68, 2341, v67
  v_lshrrev_b32 v68, 16, v68
  v_mul_u32_u24 v69, 28, v68
  v_sub_u32 v69, v67, v69
  v_lshrrev_b32 v70, 4, v69
  v_and_b32 v69, 15, v69
  v_and_b32 v71, 1, v69
  v_lshrrev_b32 v69, 1, v69
  v_lshl_add_u32 v69, v71, 3, v69
  v_lshlrev_b32 v71, 12, v70
  v_lshrrev_b32 v70, 1, v68
  v_lshl_add_u32 v71, v70, 9, v71
  v_and_b32 v70, 1, v68
  v_lshl_add_u32 v71, v70, 2, v71
  v_lshl_add_u32 v71, v69, 4, v71
  v_lshl_add_u32 v115, v66, 8, v71
  s_mul_i32 s24, s17, 532480
  s_add_u32 s24, s24, 76926976
  s_mul_i32 s34, s17, 640
  s_add_u32 s34, s34, 88569856
  s_mul_i32 s36, s17, 448
  v_add_u32 v0, s36, v2
  v_add_u32 v0, 8192, v0
  s_add_u32 s36, s36, 88068096
  v_cmp_gt_u32 s[26:27], 28, v1
  v_and_b32 v119, 31, v1
  v_lshlrev_b32 v119, 2, v119
  s_add_u32 s22, s17, 16
  s_and_b32 s22, s22, 31
  s_lshl_b32 s22, s22, 7
  s_add_u32 s22, s22, 21504
  v_add_u32 v119, s22, v119
  v_min_u32 v118, 12, v1
  s_mul_i32 s22, s17, 13
  v_add_u32 v118, s22, v118
  v_lshlrev_b32 v118, 7, v118
  v_add_u32 v118, 51200, v118
  s_mov_b32 s39, 71565312
  v_add_u32 v1, 16384, v2
  v_mov_b32 v117, 1
  s_mul_i32 s38, s17, 1104
  s_add_u32 s38, s38, 25600
  s_lshl_b32 s22, 0, 11
  s_add_u32 s22, s22, 88590336
  v_add_u32 v36, 1024, v2
  v_min_u32 v36, 1776, v36
  s_mov_b32 s30, 0
va_iw6:
  buffer_load_dwordx4 v[40:43], v2, s[8:11], s22 offen sc1
  buffer_load_dwordx4 v[44:47], v36, s[8:11], s22 offen sc1
  s_waitcnt vmcnt(0)
  v_cmp_ne_u64 vcc, s[88:89], v[40:41]
  s_cbranch_vccnz va_iw6_no
  v_cmp_ne_u64 vcc, s[88:89], v[42:43]
  s_cbranch_vccnz va_iw6_no
  v_cmp_ne_u64 vcc, s[88:89], v[44:45]
  s_cbranch_vccnz va_iw6_no
  v_cmp_ne_u64 vcc, s[88:89], v[46:47]
  s_cbranch_vccnz va_iw6_no
  s_branch va_iw6_ok
va_iw6_no:
  s_sleep 2
  s_add_u32 s30, s30, 1
  s_cmp_lt_u32 s30, 50000
  s_cbranch_scc1 va_iw6
  s_branch cA_abort
va_iw6_ok:
  s_mov_b32 s30, 0
  v_mov_b32 v36, 0
ch_md6:
  buffer_load_dword v37, v36, s[12:15], 0 offen sc1
  s_waitcnt vmcnt(0)
  v_readfirstlane_b32 s22, v37
  s_and_b32 s31, s22, 0xffff
  s_cmp_ge_u32 s31, 32
  s_cbranch_scc1 ch_go6
  s_sleep 2
  s_add_u32 s30, s30, 1
  s_cmp_lt_u32 s30, 50000
  s_cbranch_scc1 ch_md6
  s_branch ch_end
ch_go6:
  s_mov_b32 s31, 0
  s_lshr_b32 s22, s22, 16
  s_cmp_lg_u32 s22, 0
  s_cbranch_scc1 cB_va2_loop
  s_branch cA_va2_loop
ch_init7:
  s_mul_i32 s31, s17, 401408
  s_add_u32 s31, s31, 6422528
  s_mul_i32 s22, s17, 28
  s_add_u32 s23, s22, 27
  s_lshr_b32 s22, s22, 6
  s_lshr_b32 s23, s23, 6
  s_sub_u32 s23, s23, s22
  s_lshl_b32 s23, s23, 8
  v_and_b32 v36, s23, v2
  v_med3_u32 v37, v117, 11, 15
  v_lshl_add_u32 v36, v37, 4, v36
  s_lshl_b32 s22, s22, 8
  s_add_u32 s22, s22, 88588288
  s_mov_b32 s30, 0
va_bw_16:
  buffer_load_dwordx4 v[40:43], v36, s[8:11], s22 offen sc1
  s_waitcnt vmcnt(0)
  v_cmp_ne_u64 vcc, s[88:89], v[40:41]
  s_cbranch_vccnz va_bw_16_no
  v_cmp_ne_u64 vcc, s[88:89], v[42:43]
  s_cbranch_vccnz va_bw_16_no
  s_branch va_bw_16_ok
va_bw_16_no:
  s_sleep 2
  s_add_u32 s30, s30, 1
  s_cmp_lt_u32 s30, 50000
  s_cbranch_scc1 va_bw_16
  s_branch cA_abort
va_bw_16_ok:
  s_add_u32 s22, s31, 286720
  buffer_load_dwordx4 a[0:3], v2, s[8:11], s22 offen offset:0 sc1
  buffer_load_dwordx4 a[4:7], v2, s[8:11], s22 offen offset:1024 sc1
  buffer_load_dwordx4 a[8:11], v2, s[8:11], s22 offen offset:2048 sc1
  buffer_load_dwordx4 a[12:15], v2, s[8:11], s22 offen offset:3072 sc1
  s_add_u32 s22, s31, 290816
  buffer_load_dwordx4 a[16:19], v2, s[8:11], s22 offen offset:0 sc1
  buffer_load_dwordx4 a[20:23], v2, s[8:11], s22 offen offset:1024 sc1
  buffer_load_dwordx4 a[24:27], v2, s[8:11], s22 offen offset:2048 sc1
  buffer_load_dwordx4 a[28:31], v2, s[8:11], s22 offen offset:3072 sc1
  s_add_u32 s22, s31, 294912
  buffer_load_dwordx4 a[32:35], v2, s[8:11], s22 offen offset:0 sc1
  buffer_load_dwordx4 a[36:39], v2, s[8:11], s22 offen offset:1024 sc1
  buffer_load_dwordx4 a[40:43], v2, s[8:11], s22 offen offset:2048 sc1
  buffer_load_dwordx4 a[44:47], v2, s[8:11], s22 offen offset:3072 sc1
  s_add_u32 s22, s31, 299008
  buffer_load_dwordx4 a[48:51], v2, s[8:11], s22 offen offset:0 sc1
  buffer_load_dwordx4 a[52:55], v2, s[8:11], s22 offen offset:1024 sc1
  buffer_load_dwordx4 a[56:59], v2, s[8:11], s22 offen offset:2048 sc1
  buffer_load_dwordx4 a[60:63], v2, s[8:11], s22 offen offset:3072 sc1
  s_add_u32 s22, s31, 303104
  buffer_load_dwordx4 a[64:67], v2, s[8:11], s22 offen offset:0 sc1
  buffer_load_dwordx4 a[68:71], v2, s[8:11], s22 offen offset:1024 sc1
  buffer_load_dwordx4 a[72:75], v2, s[8:11], s22 offen offset:2048 sc1
  buffer_load_dwordx4 a[76:79], v2, s[8:11], s22 offen offset:3072 sc1
  s_add_u32 s22, s31, 307200
  buffer_load_dwordx4 a[80:83], v2, s[8:11], s22 offen offset:0 sc1
  buffer_load_dwordx4 a[84:87], v2, s[8:11], s22 offen offset:1024 sc1
  buffer_load_dwordx4 a[88:91], v2, s[8:11], s22 offen offset:2048 sc1
  buffer_load_dwordx4 a[92:95], v2, s[8:11], s22 offen offset:3072 sc1
  s_add_u32 s22, s31, 311296
  buffer_load_dwordx4 a[96:99], v2, s[8:11], s22 offen offset:0 sc1
  buffer_load_dwordx4 a[100:103], v2, s[8:11], s22 offen offset:1024 sc1
  buffer_load_dwordx4 a[104:107], v2, s[8:11], s22 offen offset:2048 sc1
  buffer_load_dwordx4 a[108:111], v2, s[8:11], s22 offen offset:3072 sc1
  s_add_u32 s22, s31, 315392
  buffer_load_dwordx4 a[112:115], v2, s[8:11], s22 offen offset:0 sc1
  buffer_load_dwordx4 a[116:119], v2, s[8:11], s22 offen offset:1024 sc1
  buffer_load_dwordx4 a[120:123], v2, s[8:11], s22 offen offset:2048 sc1
  buffer_load_dwordx4 a[124:127], v2, s[8:11], s22 offen offset:3072 sc1
  s_waitcnt vmcnt(24)
  s_add_u32 s22, s31, 319488
  buffer_load_dwordx4 a[128:131], v2, s[8:11], s22 offen offset:0 sc1
  buffer_load_dwordx4 a[132:135], v2, s[8:11], s22 offen offset:1024 sc1
  buffer_load_dwordx4 a[136:139], v2, s[8:11], s22 offen offset:2048 sc1
  buffer_load_dwordx4 a[140:143], v2, s[8:11], s22 offen offset:3072 sc1
  s_add_u32 s22, s31, 323584
  buffer_load_dwordx4 a[144:147], v2, s[8:11], s22 offen offset:0 sc1
  buffer_load_dwordx4 a[148:151], v2, s[8:11], s22 offen offset:1024 sc1
  buffer_load_dwordx4 a[152:155], v2, s[8:11], s22 offen offset:2048 sc1
  buffer_load_dwordx4 a[156:159], v2, s[8:11], s22 offen offset:3072 sc1
  s_add_u32 s22, s31, 327680
  buffer_load_dwordx4 a[160:163], v2, s[8:11], s22 offen offset:0 sc1
  buffer_load_dwordx4 a[164:167], v2, s[8:11], s22 offen offset:1024 sc1
  buffer_load_dwordx4 a[168:171], v2, s[8:11], s22 offen offset:2048 sc1
  buffer_load_dwordx4 a[172:175], v2, s[8:11], s22 offen offset:3072 sc1
  s_add_u32 s22, s31, 331776
  buffer_load_dwordx4 a[176:179], v2, s[8:11], s22 offen offset:0 sc1
  buffer_load_dwordx4 a[180:183], v2, s[8:11], s22 offen offset:1024 sc1
  buffer_load_dwordx4 a[184:187], v2, s[8:11], s22 offen offset:2048 sc1
  buffer_load_dwordx4 a[188:191], v2, s[8:11], s22 offen offset:3072 sc1
  s_add_u32 s22, s31, 335872
  buffer_load_dwordx4 a[192:195], v2, s[8:11], s22 offen offset:0 sc1
  buffer_load_dwordx4 a[196:199], v2, s[8:11], s22 offen offset:1024 sc1
  buffer_load_dwordx4 a[200:203], v2, s[8:11], s22 offen offset:2048 sc1
  buffer_load_dwordx4 a[204:207], v2, s[8:11], s22 offen offset:3072 sc1
  s_add_u32 s22, s31, 339968
  buffer_load_dwordx4 a[208:211], v2, s[8:11], s22 offen offset:0 sc1
  buffer_load_dwordx4 a[212:215], v2, s[8:11], s22 offen offset:1024 sc1
  buffer_load_dwordx4 a[216:219], v2, s[8:11], s22 offen offset:2048 sc1
  buffer_load_dwordx4 a[220:223], v2, s[8:11], s22 offen offset:3072 sc1
  s_add_u32 s22, s31, 344064
  buffer_load_dwordx4 a[224:227], v2, s[8:11], s22 offen offset:0 sc1
  buffer_load_dwordx4 a[228:231], v2, s[8:11], s22 offen offset:1024 sc1
  buffer_load_dwordx4 a[232:235], v2, s[8:11], s22 offen offset:2048 sc1
  buffer_load_dwordx4 a[236:239], v2, s[8:11], s22 offen offset:3072 sc1
  s_add_u32 s22, s31, 348160
  buffer_load_dwordx4 a[240:243], v2, s[8:11], s22 offen offset:0 sc1
  buffer_load_dwordx4 a[244:247], v2, s[8:11], s22 offen offset:1024 sc1
  buffer_load_dwordx4 a[248:251], v2, s[8:11], s22 offen offset:2048 sc1
  buffer_load_dwordx4 a[252:255], v2, s[8:11], s22 offen offset:3072 sc1
  s_waitcnt vmcnt(24)
  s_add_u32 s22, s31, 352256
  buffer_load_dwordx4 v[120:123], v2, s[8:11], s22 offen offset:0 sc1
  buffer_load_dwordx4 v[124:127], v2, s[8:11], s22 offen offset:1024 sc1
  buffer_load_dwordx4 v[128:131], v2, s[8:11], s22 offen offset:2048 sc1
  buffer_load_dwordx4 v[132:135], v2, s[8:11], s22 offen offset:3072 sc1
  s_add_u32 s22, s31, 356352
  buffer_load_dwordx4 v[136:139], v2, s[8:11], s22 offen offset:0 sc1
  buffer_load_dwordx4 v[140:143], v2, s[8:11], s22 offen offset:1024 sc1
  buffer_load_dwordx4 v[144:147], v2, s[8:11], s22 offen offset:2048 sc1
  buffer_load_dwordx4 v[148:151], v2, s[8:11], s22 offen offset:3072 sc1
  s_add_u32 s22, s31, 360448
  buffer_load_dwordx4 v[152:155], v2, s[8:11], s22 offen offset:0 sc1
  buffer_load_dwordx4 v[156:159], v2, s[8:11], s22 offen offset:1024 sc1
  buffer_load_dwordx4 v[160:163], v2, s[8:11], s22 offen offset:2048 sc1
  buffer_load_dwordx4 v[164:167], v2, s[8:11], s22 offen offset:3072 sc1
  s_add_u32 s22, s31, 364544
  buffer_load_dwordx4 v[168:171], v2, s[8:11], s22 offen offset:0 sc1
  buffer_load_dwordx4 v[172:175], v2, s[8:11], s22 offen offset:1024 sc1
  buffer_load_dwordx4 v[176:179], v2, s[8:11], s22 offen offset:2048 sc1
  buffer_load_dwordx4 v[180:183], v2, s[8:11], s22 offen offset:3072 sc1
  s_add_u32 s22, s31, 368640
  buffer_load_dwordx4 v[184:187], v2, s[8:11], s22 offen offset:0 sc1
  buffer_load_dwordx4 v[188:191], v2, s[8:11], s22 offen offset:1024 sc1
  buffer_load_dwordx4 v[192:195], v2, s[8:11], s22 offen offset:2048 sc1
  buffer_load_dwordx4 v[196:199], v2, s[8:11], s22 offen offset:3072 sc1
  s_add_u32 s22, s31, 372736
  buffer_load_dwordx4 v[200:203], v2, s[8:11], s22 offen offset:0 sc1
  buffer_load_dwordx4 v[204:207], v2, s[8:11], s22 offen offset:1024 sc1
  buffer_load_dwordx4 v[208:211], v2, s[8:11], s22 offen offset:2048 sc1
  buffer_load_dwordx4 v[212:215], v2, s[8:11], s22 offen offset:3072 sc1
  s_add_u32 s22, s31, 376832
  buffer_load_dwordx4 v[216:219], v2, s[8:11], s22 offen offset:0 sc1
  buffer_load_dwordx4 v[220:223], v2, s[8:11], s22 offen offset:1024 sc1
  buffer_load_dwordx4 v[224:227], v2, s[8:11], s22 offen offset:2048 sc1
  buffer_load_dwordx4 v[228:231], v2, s[8:11], s22 offen offset:3072 sc1
  s_add_u32 s22, s31, 380928
  buffer_load_dwordx4 v[232:235], v2, s[8:11], s22 offen offset:0 sc1
  buffer_load_dwordx4 v[236:239], v2, s[8:11], s22 offen offset:1024 sc1
  buffer_load_dwordx4 v[240:243], v2, s[8:11], s22 offen offset:2048 sc1
  buffer_load_dwordx4 v[244:247], v2, s[8:11], s22 offen offset:3072 sc1
  s_waitcnt vmcnt(24)
  s_add_u32 s22, s31, 385024
  buffer_load_dwordx4 v[248:251], v2, s[8:11], s22 offen offset:0 sc1
  buffer_load_dwordx4 v[252:255], v2, s[8:11], s22 offen offset:1024 sc1
  v_mov_b32 v72, v116
  v_mov_b32 v73, v117
  v_lshrrev_b32 v65, 1, v72
  v_and_b32 v66, 1, v72
  v_add_u32 v67, 20, v65
  v_lshl_add_u32 v67, v67, 4, v73
  v_mul_u32_u24 v68, 2341, v67
  v_lshrrev_b32 v68, 16, v68
  v_mul_u32_u24 v69, 28, v68
  v_sub_u32 v69, v67, v69
  v_lshrrev_b32 v70, 4, v69
  v_and_b32 v69, 15, v69
  v_and_b32 v71, 1, v69
  v_lshrrev_b32 v69, 1, v69
  v_lshl_add_u32 v69, v71, 3, v69
  v_lshlrev_b32 v71, 12, v70
  v_lshrrev_b32 v70, 1, v68
  v_lshl_add_u32 v71, v70, 9, v71
  v_and_b32 v70, 1, v68
  v_lshl_add_u32 v71, v70, 2, v71
  v_lshl_add_u32 v71, v69, 4, v71
  v_lshl_add_u32 v112, v66, 8, v71
  v_add_u32 v67, 22, v65
  v_lshl_add_u32 v67, v67, 4, v73
  v_mul_u32_u24 v68, 2341, v67
  v_lshrrev_b32 v68, 16, v68
  v_mul_u32_u24 v69, 28, v68
  v_sub_u32 v69, v67, v69
  v_lshrrev_b32 v70, 4, v69
  v_and_b32 v69, 15, v69
  v_and_b32 v71, 1, v69
  v_lshrrev_b32 v69, 1, v69
  v_lshl_add_u32 v69, v71, 3, v69
  v_lshlrev_b32 v71, 12, v70
  v_lshrrev_b32 v70, 1, v68
  v_lshl_add_u32 v71, v70, 9, v71
  v_and_b32 v70, 1, v68
  v_lshl_add_u32 v71, v70, 2, v71
  v_lshl_add_u32 v71, v69, 4, v71
  v_lshl_add_u32 v113, v66, 8, v71
  v_add_u32 v67, 24, v65
  v_lshl_add_u32 v67, v67, 4, v73
  v_mul_u32_u24 v68, 2341, v67
  v_lshrrev_b32 v68, 16, v68
  v_mul_u32_u24 v69, 28, v68
  v_sub_u32 v69, v67, v69
  v_lshrrev_b32 v70, 4, v69
  v_and_b32 v69, 15, v69
  v_and_b32 v71, 1, v69
  v_lshrrev_b32 v69, 1, v69
  v_lshl_add_u32 v69, v71, 3, v69
  v_lshlrev_b32 v71, 12, v70
  v_lshrrev_b32 v70, 1, v68
  v_lshl_add_u32 v71, v70, 9, v71
  v_and_b32 v70, 1, v68
  v_lshl_add_u32 v71, v70, 2, v71
  v_lshl_add_u32 v71, v69, 4, v71
  v_lshl_add_u32 v114, v66, 8, v71
  v_add_u32 v67, 26, v65
  v_lshl_add_u32 v67, v67, 4, v73
  v_mul_u32_u24 v68, 2341, v67
  v_lshrrev_b32 v68, 16, v68
  v_mul_u32_u24 v69, 28, v68
  v_sub_u32 v69, v67, v69
  v_lshrrev_b32 v70, 4, v69
  v_and_b32 v69, 15, v69
  v_and_b32 v71, 1, v69
  v_lshrrev_b32 v69, 1, v69
  v_lshl_add_u32 v69, v71, 3, v69
  v_lshlrev_b32 v71, 12, v70
  v_lshrrev_b32 v70, 1, v68
  v_lshl_add_u32 v71, v70, 9, v71
  v_and_b32 v70, 1, v68
  v_lshl_add_u32 v71, v70, 2, v71
  v_lshl_add_u32 v71, v69, 4, v71
  v_lshl_add_u32 v115, v66, 8, v71
  s_mul_i32 s24, s17, 532480
  s_add_u32 s24, s24, 76931072
  s_mul_i32 s34, s17, 640
  s_add_u32 s34, s34, 88569860
  s_mul_i32 s36, s17, 448
  v_add_u32 v0, s36, v2
  v_add_u32 v0, 8192, v0
  s_add_u32 s36, s36, 88068096
  v_cmp_gt_u32 s[26:27], 28, v1
  v_and_b32 v119, 31, v1
  v_lshlrev_b32 v119, 2, v119
  s_add_u32 s22, s17, 16
  s_and_b32 s22, s22, 31
  s_lshl_b32 s22, s22, 7
  s_add_u32 s22, s22, 21504
  v_add_u32 v119, s22, v119
  v_min_u32 v118, 13, v1
  s_mul_i32 s22, s17, 14
  v_add_u32 v118, s22, v118
  v_lshlrev_b32 v118, 7, v118
  v_add_u32 v118, 57344, v118
  s_mov_b32 s39, 71565312
  v_add_u32 v1, 59392, v2
  v_mov_b32 v117, 1
  s_mul_i32 s38, s17, 1104
  s_add_u32 s38, s38, 26624
  s_lshl_b32 s22, 0, 11
  s_add_u32 s22, s22, 88590336
  v_add_u32 v36, 1024, v2
  v_min_u32 v36, 1776, v36
  s_mov_b32 s30, 0
va_iw7:
  buffer_load_dwordx4 v[40:43], v2, s[8:11], s22 offen sc1
  buffer_load_dwordx4 v[44:47], v36, s[8:11], s22 offen sc1
  s_waitcnt vmcnt(0)
  v_cmp_ne_u64 vcc, s[88:89], v[40:41]
  s_cbranch_vccnz va_iw7_no
  v_cmp_ne_u64 vcc, s[88:89], v[42:43]
  s_cbranch_vccnz va_iw7_no
  v_cmp_ne_u64 vcc, s[88:89], v[44:45]
  s_cbranch_vccnz va_iw7_no
  v_cmp_ne_u64 vcc, s[88:89], v[46:47]
  s_cbranch_vccnz va_iw7_no
  s_branch va_iw7_ok
va_iw7_no:
  s_sleep 2
  s_add_u32 s30, s30, 1
  s_cmp_lt_u32 s30, 50000
  s_cbranch_scc1 va_iw7
  s_branch cA_abort
va_iw7_ok:
  s_mov_b32 s30, 0
  v_mov_b32 v36, 0
ch_md7:
  buffer_load_dword v37, v36, s[12:15], 0 offen sc1
  s_waitcnt vmcnt(0)
  v_readfirstlane_b32 s22, v37
  s_and_b32 s31, s22, 0xffff
  s_cmp_ge_u32 s31, 32
  s_cbranch_scc1 ch_go7
  s_sleep 2
  s_add_u32 s30, s30, 1
  s_cmp_lt_u32 s30, 50000
  s_cbranch_scc1 ch_md7
  s_branch ch_end
ch_go7:
  s_mov_b32 s31, 0
  s_lshr_b32 s22, s22, 16
  s_cmp_lg_u32 s22, 0
  s_cbranch_scc1 cB_va3_loop
  s_branch cA_va3_loop
.p2align 6

cA_sc0_loop:
  s_add_u32 s23, s20, 4096
  s_add_u32 s21, s20, 25600
  v_mov_b32 v48, 0
  v_mov_b32 v49, 0
  v_mov_b32 v50, 0
  v_mov_b32 v51, 0
  v_mov_b32 v52, 0
  v_mov_b32 v53, 0
  v_mov_b32 v54, 0
  v_mov_b32 v55, 0
  v_mov_b32 v56, 0
  v_mov_b32 v57, 0
  v_mov_b32 v58, 0
  v_mov_b32 v59, 0
  v_mov_b32 v60, 0
  v_mov_b32 v61, 0
  v_mov_b32 v62, 0
  v_mov_b32 v63, 0
  v_mov_b32 v88, 0
  v_mov_b32 v89, 0
  v_mov_b32 v90, 0
  v_mov_b32 v91, 0
  v_mov_b32 v92, 0
  v_mov_b32 v93, 0
  v_mov_b32 v94, 0
  v_mov_b32 v95, 0
  v_mov_b32 v66, 0
  v_mov_b32 v67, 0
  s_mov_b32 s30, 0
  s_mov_b32 s62, 0
  buffer_load_dword v68, v0, s[8:11], s20 offen sc1
  s_nop 7
  buffer_load_dword v69, v0, s[8:11], s20 offen sc1
  s_nop 7
  buffer_load_dword v70, v0, s[8:11], s20 offen sc1
  s_nop 7
  buffer_load_dword v71, v0, s[8:11], s20 offen sc1
  s_nop 7
  buffer_load_dword v72, v0, s[8:11], s20 offen sc1
cA_sc0_fp_l:
  s_waitcnt vmcnt(4)
  v_cmp_eq_u32 vcc, -1, v68
  s_cbranch_vccz cA_sc0_fp_d
  buffer_load_dword v68, v0, s[8:11], s20 offen sc1
  s_waitcnt vmcnt(4)
  v_cmp_eq_u32 vcc, -1, v69
  s_cbranch_vccz cA_sc0_fp_d
  buffer_load_dword v69, v0, s[8:11], s20 offen sc1
  s_waitcnt vmcnt(4)
  v_cmp_eq_u32 vcc, -1, v70
  s_cbranch_vccz cA_sc0_fp_d
  buffer_load_dword v70, v0, s[8:11], s20 offen sc1
  s_waitcnt vmcnt(4)
  v_cmp_eq_u32 vcc, -1, v71
  s_cbranch_vccz cA_sc0_fp_d
  buffer_load_dword v71, v0, s[8:11], s20 offen sc1
  s_waitcnt vmcnt(4)
  v_cmp_eq_u32 vcc, -1, v72
  s_cbranch_vccz cA_sc0_fp_d
  buffer_load_dword v72, v0, s[8:11], s20 offen sc1
  s_add_u32 s30, s30, 1
  s_cmp_lt_u32 s30, 400000
  s_cbranch_scc1 cA_sc0_fp_l
  s_branch cA_abort
cA_sc0_fp_d:
  buffer_load_dwordx4 v[8:11], v2, s[8:11], s20 offen offset:0
  s_barrier
  s_branch cA_sc0_ld1
cA_sc0_ld:
  buffer_load_dwordx4 v[8:11], v2, s[8:11], s20 offen offset:0
cA_sc0_ld1:
  v_mov_b32 v36, 0
  v_mov_b32 v37, 0
  v_mov_b32 v38, 0
  v_mov_b32 v39, 0
  buffer_load_dwordx4 v[12:15], v2, s[8:11], s20 offen offset:1024
  v_mov_b32 v40, 0
  v_mov_b32 v41, 0
  v_mov_b32 v42, 0
  v_mov_b32 v43, 0
  buffer_load_dwordx4 v[16:19], v2, s[8:11], s20 offen offset:2048
  v_mov_b32 v44, 0
  v_mov_b32 v45, 0
  v_mov_b32 v46, 0
  v_mov_b32 v47, 0
  ds_read_b128 v[96:99], v117 offset:0
  ds_read_b128 v[100:103], v117 offset:1024
  ds_read_b128 v[104:107], v117 offset:14336
  ds_read_b128 v[108:111], v117 offset:15360
  s_waitcnt vmcnt(2)
  v_smfmac_f32_16x16x64_bf16 v[36:39], v[8:11], a[0:7], v3
  v_smfmac_f32_16x16x64_bf16 v[40:43], v[8:11], a[56:63], v3
  buffer_load_dwordx4 v[20:23], v2, s[8:11], s20 offen offset:3072
  v_smfmac_f32_16x16x64_bf16 v[44:47], v[8:11], a[112:119], v3
  v_smfmac_f32_16x16x64_bf16 v[48:51], v[8:11], a[168:175], v3
  v_smfmac_f32_16x16x64_bf16 v[52:55], v[8:11], a[224:231], v3
  buffer_load_dwordx4 v[24:27], v2, s[8:11], s23 offen offset:0
  v_smfmac_f32_16x16x64_bf16 v[56:59], v[8:11], v[144:151], v3
  v_smfmac_f32_16x16x64_bf16 v[60:63], v[8:11], v[200:207], v3
  s_waitcnt vmcnt(3)
  v_smfmac_f32_16x16x64_bf16 v[36:39], v[12:15], a[8:15], v3
  v_smfmac_f32_16x16x64_bf16 v[40:43], v[12:15], a[64:71], v3
  buffer_load_dwordx4 v[28:31], v2, s[8:11], s23 offen offset:1024
  v_smfmac_f32_16x16x64_bf16 v[44:47], v[12:15], a[120:127], v3
  v_smfmac_f32_16x16x64_bf16 v[48:51], v[12:15], a[176:183], v3
  v_smfmac_f32_16x16x64_bf16 v[52:55], v[12:15], a[232:239], v3
  buffer_load_dwordx4 v[32:35], v2, s[8:11], s23 offen offset:2048
  v_smfmac_f32_16x16x64_bf16 v[56:59], v[12:15], v[152:159], v3
  v_smfmac_f32_16x16x64_bf16 v[60:63], v[12:15], v[208:215], v3
  s_waitcnt vmcnt(4)
  v_smfmac_f32_16x16x64_bf16 v[36:39], v[16:19], a[16:23], v3
  v_smfmac_f32_16x16x64_bf16 v[40:43], v[16:19], a[72:79], v3
  v_smfmac_f32_16x16x64_bf16 v[44:47], v[16:19], a[128:135], v3
  v_smfmac_f32_16x16x64_bf16 v[48:51], v[16:19], a[184:191], v3
  v_smfmac_f32_16x16x64_bf16 v[52:55], v[16:19], a[240:247], v3
  v_smfmac_f32_16x16x64_bf16 v[56:59], v[16:19], v[160:167], v3
  v_smfmac_f32_16x16x64_bf16 v[60:63], v[16:19], v[216:223], v3
  s_waitcnt vmcnt(3)
  v_smfmac_f32_16x16x64_bf16 v[36:39], v[20:23], a[24:31], v3
  v_smfmac_f32_16x16x64_bf16 v[40:43], v[20:23], a[80:87], v3
  v_smfmac_f32_16x16x64_bf16 v[44:47], v[20:23], a[136:143], v3
  v_smfmac_f32_16x16x64_bf16 v[48:51], v[20:23], a[192:199], v3
  v_smfmac_f32_16x16x64_bf16 v[52:55], v[20:23], a[248:255], v3
  v_smfmac_f32_16x16x64_bf16 v[56:59], v[20:23], v[168:175], v3
  v_smfmac_f32_16x16x64_bf16 v[60:63], v[20:23], v[224:231], v3
  s_waitcnt vmcnt(0)
cA_sc0_ph2:
  v_smfmac_f32_16x16x64_bf16 v[60:63], v[24:27], v[232:239], v3
  ds_read_b128 v[12:15], v116 offset:0
  ds_read_b128 v[16:19], v116 offset:1024
  v_smfmac_f32_16x16x64_bf16 v[60:63], v[28:31], v[240:247], v3
  v_smfmac_f32_16x16x64_bf16 v[60:63], v[32:35], v[248:255], v3
  v_mov_b32 v80, v24
  v_smfmac_f32_16x16x64_bf16 v[52:55], v[24:27], v[120:127], v3
  v_mov_b32 v81, v25
  v_smfmac_f32_16x16x64_bf16 v[52:55], v[28:31], v[128:135], v3
  v_mov_b32 v82, v32
  v_smfmac_f32_16x16x64_bf16 v[52:55], v[32:35], v[136:143], v3
  v_cvt_pk_bf16_f32 v64, v60, v61
  v_smfmac_f32_16x16x64_bf16 v[56:59], v[24:27], v[176:183], v3
  v_cvt_pk_bf16_f32 v65, v62, v63
  v_smfmac_f32_16x16x64_bf16 v[56:59], v[28:31], v[184:191], v3
  v_mov_b32 v83, v33
  v_mfma_f32_16x16x32_bf16 v[68:71], v[64:67], v[4:7], 0
  v_smfmac_f32_16x16x64_bf16 v[56:59], v[32:35], v[192:199], v3
  v_cvt_pk_bf16_f32 v64, v52, v53
  v_smfmac_f32_16x16x64_bf16 v[36:39], v[24:27], a[32:39], v3
  v_cvt_pk_bf16_f32 v65, v54, v55
  v_smfmac_f32_16x16x64_bf16 v[36:39], v[28:31], a[40:47], v3
  v_cvt_pk_bf16_f32 v78, v68, v69
  v_smfmac_f32_16x16x64_bf16 v[36:39], v[32:35], a[48:55], v3
  v_cvt_pk_bf16_f32 v79, v70, v71
  v_cvt_pk_bf16_f32 v66, v56, v57
  v_smfmac_f32_16x16x64_bf16 v[40:43], v[24:27], a[88:95], v3
  v_cvt_pk_bf16_f32 v67, v58, v59
  v_smfmac_f32_16x16x64_bf16 v[40:43], v[28:31], a[96:103], v3
  v_mfma_f32_16x16x32_bf16 v[72:75], v[64:67], v[4:7], 0
  ds_read_b128 v[52:55], v116 offset:14336
  ds_read_b128 v[56:59], v116 offset:15360
  v_smfmac_f32_16x16x64_bf16 v[40:43], v[32:35], a[104:111], v3
  v_cvt_pk_bf16_f32 v64, v36, v37
  v_smfmac_f32_16x16x64_bf16 v[44:47], v[24:27], a[144:151], v3
  v_cvt_pk_bf16_f32 v65, v38, v39
  v_smfmac_f32_16x16x64_bf16 v[44:47], v[28:31], a[152:159], v3
  v_cvt_pk_bf16_f32 v76, v72, v73
  v_smfmac_f32_16x16x64_bf16 v[44:47], v[32:35], a[160:167], v3
  v_cvt_pk_bf16_f32 v77, v74, v75
  v_cvt_pk_bf16_f32 v66, v40, v41
  v_smfmac_f32_16x16x64_bf16 v[48:51], v[24:27], a[200:207], v3
  v_cvt_pk_bf16_f32 v67, v42, v43
  v_smfmac_f32_16x16x64_bf16 v[48:51], v[28:31], a[208:215], v3
  v_mfma_f32_16x16x32_bf16 v[68:71], v[64:67], v[4:7], 0
  v_smfmac_f32_16x16x64_bf16 v[48:51], v[32:35], a[216:223], v3
  v_cvt_pk_bf16_f32 v64, v44, v45
  v_mfma_f32_16x16x32_bf16 v[84:87], v[80:83], v[76:79], 0
  v_cvt_pk_bf16_f32 v65, v46, v47
  s_waitcnt lgkmcnt(0)
  v_smfmac_f32_16x16x64_bf16 v[88:91], v[76:79], v[96:103], v3
  v_cvt_pk_bf16_f32 v60, v68, v69
  v_cvt_pk_bf16_f32 v61, v70, v71
  v_cvt_pk_bf16_f32 v66, v48, v49
  v_cvt_pk_bf16_f32 v67, v50, v51
  s_nop 1
  v_mfma_f32_16x16x32_bf16 v[72:75], v[64:67], v[4:7], 0
  v_smfmac_f32_16x16x64_bf16 v[92:95], v[76:79], v[104:111], v3
  s_nop 4
  v_cvt_pk_bf16_f32 v62, v72, v73
  v_cvt_pk_bf16_f32 v63, v74, v75
  s_nop 1
  v_mfma_f32_16x16x32_bf16 v[84:87], v[8:11], v[60:63], v[84:87]
  v_smfmac_f32_16x16x64_bf16 v[88:91], v[60:63], v[12:19], v3
  v_smfmac_f32_16x16x64_bf16 v[92:95], v[60:63], v[52:59], v3
  s_nop 1
  v_permlane32_swap_b32 v84, v86
  v_permlane32_swap_b32 v85, v87
  s_nop 0
  v_cmp_u_f32 vcc, v88, v89
  v_add_f32_dpp v84, v86, v84 row_ror:8 row_mask:0xf bank_mask:0xf
  v_add_f32_dpp v85, v87, v85 row_ror:8 row_mask:0xf bank_mask:0xf
  v_permlane32_swap_b32 v88, v92
  v_permlane32_swap_b32 v89, v93
  ds_write2_b32 v113, v84, v85 offset0:0 offset1:4
  v_permlane32_swap_b32 v90, v94
  v_permlane32_swap_b32 v91, v95
  v_add_f32 v88, v88, v92
  v_add_f32 v89, v89, v93
  v_add_f32 v90, v90, v94
  v_add_f32 v91, v91, v95
  ds_write2_b64 v112, v[88:89], v[90:91] offset0:0 offset1:128
  s_cbranch_vccnz cA_sc0_retry
cA_sc0_cont:
  s_waitcnt lgkmcnt(0)
  s_barrier
  ds_read_b128 v[36:39], v114
  ds_read_b128 v[44:47], v115
  s_waitcnt lgkmcnt(0)
  v_add_f32 v36, v36, v38
  v_add_f32 v37, v37, v39
  v_add_f32 v44, v44, v45
  v_add_f32 v46, v46, v47
  v_permlane32_swap_b32 v36, v37
  v_add_f32 v44, v44, v46
  v_add_f32 v36, v36, v37
  v_exp_f32 v49, v44
  v_exp_f32 v48, v36
  v_add_f32 v50, abs(v36), abs(v44)
  v_fma_f32 v39, v49, s37, v48
  v_cmp_ngt_f32 vcc, s56, v50
  v_cndmask_b32 v41, v48, v49, s[38:39]
  v_add_f32_dpp v39, v39, v39 quad_perm:[1,0,3,2] row_mask:0xf bank_mask:0xf
  v_cndmask_b32 v40, v49, v48, s[38:39]
  v_mov_b32_dpp v46, v41 quad_perm:[1,0,3,2] row_mask:0xf bank_mask:0xf
  v_add_f32_dpp v39, v39, v39 quad_perm:[2,3,0,1] row_mask:0xf bank_mask:0xf
  v_cndmask_b32 v42, v46, v40, s[38:39]
  v_cndmask_b32 v43, v40, v46, s[38:39]
  v_add_f32_dpp v39, v39, v39 row_half_mirror row_mask:0xf bank_mask:0xf
  s_cbranch_vccnz cA_sc0_slow
  s_nop 0
  v_add_f32_dpp v47, v39, v39 row_mirror row_mask:0xf bank_mask:0xf
  v_add_f32_dpp v39, v39, v39 row_mirror row_mask:0xf bank_mask:0xf
  s_nop 1
  v_permlane16_swap_b32 v39, v47
  v_add_f32 v39, v39, v47
  v_rcp_f32 v39, v39
  s_mov_b64 exec, s[28:29]
  v_mul_f32 v42, v42, v39
  v_mul_f32 v43, v43, v39
  v_cvt_pk_bf16_f32 v42, v42, v43
cA_sc0_pst:
  buffer_store_dword v42, v1, s[8:11], s20 offen
  s_mov_b64 exec, -1
  s_barrier
  s_add_u32 s24, s24, 28672
  s_add_u32 s35, s35, 28672
  s_xor_b32 s25, s25, 28672
  s_add_u32 m0, s25, 0
  s_nop 0
  buffer_load_dwordx4 v2, s[8:11], s24 offen offset:0 sc1 lds
  buffer_load_dwordx4 v2, s[8:11], s24 offen offset:1024 sc1 lds
  buffer_load_dwordx4 v2, s[8:11], s24 offen offset:2048 sc1 lds
  buffer_load_dwordx4 v2, s[8:11], s24 offen offset:3072 sc1 lds
  s_add_u32 m0, s25, 4096
  s_add_u32 s22, s24, 4096
  buffer_load_dwordx4 v2, s[8:11], s22 offen offset:0 sc1 lds
  buffer_load_dwordx4 v2, s[8:11], s22 offen offset:1024 sc1 lds
  buffer_load_dwordx4 v2, s[8:11], s22 offen offset:2048 sc1 lds
  v_xor_b32 v116, 28672, v116
  v_add_u32 v117, s57, v117
  s_sub_u32 s57, 0, s57
  s_add_u32 s19, s19, 1
  s_mov_b32 s20, s21
  s_cmp_lt_u32 s19, 63
  s_cbranch_scc1 cA_sc0_loop
  s_branch cA_done
cA_sc0_slow:
  v_max_f32 v50, v36, v44
  s_nop 1
  v_max_f32_dpp v50, v50, v50 quad_perm:[1,0,3,2] row_mask:0xf bank_mask:0xf
  s_nop 1
  v_max_f32_dpp v50, v50, v50 quad_perm:[2,3,0,1] row_mask:0xf bank_mask:0xf
  s_nop 1
  v_max_f32_dpp v50, v50, v50 row_half_mirror row_mask:0xf bank_mask:0xf
  s_nop 1
  v_max_f32_dpp v50, v50, v50 row_mirror row_mask:0xf bank_mask:0xf
  v_mov_b32 v47, v50
  s_nop 1
  v_permlane16_swap_b32 v50, v47
  v_max_f32 v50, v50, v47
  v_sub_f32 v48, v36, v50
  v_sub_f32 v49, v44, v50
  v_exp_f32 v48, v48
  v_exp_f32 v49, v49
  s_add_u32 s31, s31, 0x100
  v_fma_f32 v39, v49, s37, v48
  v_cndmask_b32 v41, v48, v49, s[38:39]
  s_nop 0
  v_add_f32_dpp v39, v39, v39 quad_perm:[1,0,3,2] row_mask:0xf bank_mask:0xf
  v_cndmask_b32 v40, v49, v48, s[38:39]
  v_mov_b32_dpp v46, v41 quad_perm:[1,0,3,2] row_mask:0xf bank_mask:0xf
  v_add_f32_dpp v39, v39, v39 quad_perm:[2,3,0,1] row_mask:0xf bank_mask:0xf
  v_cndmask_b32 v42, v46, v40, s[38:39]
  v_cndmask_b32 v43, v40, v46, s[38:39]
  v_add_f32_dpp v39, v39, v39 row_half_mirror row_mask:0xf bank_mask:0xf
  s_nop 1
  v_add_f32_dpp v47, v39, v39 row_mirror row_mask:0xf bank_mask:0xf
  v_add_f32_dpp v39, v39, v39 row_mirror row_mask:0xf bank_mask:0xf
  s_nop 1
  v_permlane16_swap_b32 v39, v47
  v_add_f32 v39, v39, v47
  v_rcp_f32 v39, v39
  s_mov_b64 exec, s[28:29]
  v_mul_f32 v42, v42, v39
  v_mul_f32 v43, v43, v39
  v_cvt_pk_bf16_f32 v42, v42, v43
  v_min_u32 v42, -2, v42
  s_branch cA_sc0_pst
cA_sc0_retry:
  s_cmp_lg_u32 s62, 0
  s_cbranch_scc1 cA_sc0_cont
  s_waitcnt vmcnt(0) lgkmcnt(0)
cA_sc0_rv:
  buffer_load_dwordx4 v[8:11], v2, s[8:11], s20 offen offset:0 sc1
  buffer_load_dwordx4 v[12:15], v2, s[8:11], s20 offen offset:1024 sc1
  buffer_load_dwordx4 v[16:19], v2, s[8:11], s20 offen offset:2048 sc1
  buffer_load_dwordx4 v[20:23], v2, s[8:11], s20 offen offset:3072 sc1
  buffer_load_dwordx4 v[24:27], v2, s[8:11], s23 offen offset:0 sc1
  buffer_load_dwordx4 v[28:31], v2, s[8:11], s23 offen offset:1024 sc1
  buffer_load_dwordx4 v[32:35], v2, s[8:11], s23 offen offset:2048 sc1
  s_waitcnt vmcnt(0)
  v_max3_u32 v118, v8, v9, v10
  v_max3_u32 v118, v118, v11, v12
  v_max3_u32 v118, v118, v13, v14
  v_max3_u32 v118, v118, v15, v16
  v_max3_u32 v118, v118, v17, v18
  v_max3_u32 v118, v118, v19, v20
  v_max3_u32 v118, v118, v21, v22
  v_max3_u32 v118, v118, v23, v24
  v_max3_u32 v118, v118, v25, v26
  v_max3_u32 v118, v118, v27, v28
  v_max3_u32 v118, v118, v29, v30
  v_max3_u32 v118, v118, v31, v32
  v_max3_u32 v118, v118, v33, v34
  v_max_u32 v118, v118, v35
  v_cmp_eq_u32 vcc, -1, v118
  s_cbranch_vccz cA_sc0_rk
  s_add_u32 s30, s30, 1
  s_cmp_lt_u32 s30, 400000
  s_cbranch_scc1 cA_sc0_rv
  s_branch cA_abort
cA_sc0_rk:
  s_mov_b32 s62, 1
  v_mov_b32 v36, 0
  v_mov_b32 v37, 0
  v_mov_b32 v38, 0
  v_mov_b32 v39, 0
  v_mov_b32 v40, 0
  v_mov_b32 v41, 0
  v_mov_b32 v42, 0
  v_mov_b32 v43, 0
  v_mov_b32 v44, 0
  v_mov_b32 v45, 0
  v_mov_b32 v46, 0
  v_mov_b32 v47, 0
  v_mov_b32 v48, 0
  v_mov_b32 v49, 0
  v_mov_b32 v50, 0
  v_mov_b32 v51, 0
  v_mov_b32 v52, 0
  v_mov_b32 v53, 0
  v_mov_b32 v54, 0
  v_mov_b32 v55, 0
  v_mov_b32 v56, 0
  v_mov_b32 v57, 0
  v_mov_b32 v58, 0
  v_mov_b32 v59, 0
  v_mov_b32 v60, 0
  v_mov_b32 v61, 0
  v_mov_b32 v62, 0
  v_mov_b32 v63, 0
  v_mov_b32 v88, 0
  v_mov_b32 v89, 0
  v_mov_b32 v90, 0
  v_mov_b32 v91, 0
  v_mov_b32 v92, 0
  v_mov_b32 v93, 0
  v_mov_b32 v94, 0
  v_mov_b32 v95, 0
  v_mov_b32 v66, 0
  v_mov_b32 v67, 0
  s_add_u32 s31, s31, 1
  ds_read_b128 v[96:99], v117 offset:0
  ds_read_b128 v[100:103], v117 offset:1024
  ds_read_b128 v[104:107], v117 offset:14336
  ds_read_b128 v[108:111], v117 offset:15360
  v_smfmac_f32_16x16x64_bf16 v[36:39], v[8:11], a[0:7], v3
  v_smfmac_f32_16x16x64_bf16 v[40:43], v[8:11], a[56:63], v3
  v_smfmac_f32_16x16x64_bf16 v[44:47], v[8:11], a[112:119], v3
  v_smfmac_f32_16x16x64_bf16 v[48:51], v[8:11], a[168:175], v3
  v_smfmac_f32_16x16x64_bf16 v[52:55], v[8:11], a[224:231], v3
  v_smfmac_f32_16x16x64_bf16 v[56:59], v[8:11], v[144:151], v3
  v_smfmac_f32_16x16x64_bf16 v[60:63], v[8:11], v[200:207], v3
  v_smfmac_f32_16x16x64_bf16 v[36:39], v[12:15], a[8:15], v3
  v_smfmac_f32_16x16x64_bf16 v[40:43], v[12:15], a[64:71], v3
  v_smfmac_f32_16x16x64_bf16 v[44:47], v[12:15], a[120:127], v3
  v_smfmac_f32_16x16x64_bf16 v[48:51], v[12:15], a[176:183], v3
  v_smfmac_f32_16x16x64_bf16 v[52:55], v[12:15], a[232:239], v3
  v_smfmac_f32_16x16x64_bf16 v[56:59], v[12:15], v[152:159], v3
  v_smfmac_f32_16x16x64_bf16 v[60:63], v[12:15], v[208:215], v3
  v_smfmac_f32_16x16x64_bf16 v[36:39], v[16:19], a[16:23], v3
  v_smfmac_f32_16x16x64_bf16 v[40:43], v[16:19], a[72:79], v3
  v_smfmac_f32_16x16x64_bf16 v[44:47], v[16:19], a[128:135], v3
  v_smfmac_f32_16x16x64_bf16 v[48:51], v[16:19], a[184:191], v3
  v_smfmac_f32_16x16x64_bf16 v[52:55], v[16:19], a[240:247], v3
  v_smfmac_f32_16x16x64_bf16 v[56:59], v[16:19], v[160:167], v3
  v_smfmac_f32_16x16x64_bf16 v[60:63], v[16:19], v[216:223], v3
  v_smfmac_f32_16x16x64_bf16 v[36:39], v[20:23], a[24:31], v3
  v_smfmac_f32_16x16x64_bf16 v[40:43], v[20:23], a[80:87], v3
  v_smfmac_f32_16x16x64_bf16 v[44:47], v[20:23], a[136:143], v3
  v_smfmac_f32_16x16x64_bf16 v[48:51], v[20:23], a[192:199], v3
  v_smfmac_f32_16x16x64_bf16 v[52:55], v[20:23], a[248:255], v3
  v_smfmac_f32_16x16x64_bf16 v[56:59], v[20:23], v[168:175], v3
  v_smfmac_f32_16x16x64_bf16 v[60:63], v[20:23], v[224:231], v3
  s_branch cA_sc0_ph2
.p2align 6

cA_sc1_loop:
  s_add_u32 s23, s20, 4096
  s_add_u32 s21, s20, 25600
  v_mov_b32 v48, 0
  v_mov_b32 v49, 0
  v_mov_b32 v50, 0
  v_mov_b32 v51, 0
  v_mov_b32 v52, 0
  v_mov_b32 v53, 0
  v_mov_b32 v54, 0
  v_mov_b32 v55, 0
  v_mov_b32 v56, 0
  v_mov_b32 v57, 0
  v_mov_b32 v58, 0
  v_mov_b32 v59, 0
  v_mov_b32 v60, 0
  v_mov_b32 v61, 0
  v_mov_b32 v62, 0
  v_mov_b32 v63, 0
  v_mov_b32 v88, 0
  v_mov_b32 v89, 0
  v_mov_b32 v90, 0
  v_mov_b32 v91, 0
  v_mov_b32 v92, 0
  v_mov_b32 v93, 0
  v_mov_b32 v94, 0
  v_mov_b32 v95, 0
  v_mov_b32 v64, 0
  v_mov_b32 v65, 0
  s_mov_b32 s30, 0
  s_mov_b32 s62, 0
  s_waitcnt vmcnt(0)
  s_barrier
cA_sc1_ld:
  buffer_load_dwordx4 v[8:11], v2, s[8:11], s20 offen offset:0
  v_mov_b32 v36, 0
  v_mov_b32 v37, 0
  v_mov_b32 v38, 0
  v_mov_b32 v39, 0
  buffer_load_dwordx4 v[12:15], v2, s[8:11], s20 offen offset:1024
  v_mov_b32 v40, 0
  v_mov_b32 v41, 0
  v_mov_b32 v42, 0
  v_mov_b32 v43, 0
  buffer_load_dwordx4 v[16:19], v2, s[8:11], s20 offen offset:2048
  v_mov_b32 v44, 0
  v_mov_b32 v45, 0
  v_mov_b32 v46, 0
  v_mov_b32 v47, 0
  ds_read_b128 v[96:99], v117 offset:0
  ds_read_b128 v[100:103], v117 offset:1024
  ds_read_b128 v[104:107], v117 offset:14336
  ds_read_b128 v[108:111], v117 offset:15360
  s_waitcnt vmcnt(2)
  v_smfmac_f32_16x16x64_bf16 v[36:39], v[8:11], a[0:7], v3
  v_smfmac_f32_16x16x64_bf16 v[40:43], v[8:11], a[56:63], v3
  buffer_load_dwordx4 v[20:23], v2, s[8:11], s20 offen offset:3072
  v_smfmac_f32_16x16x64_bf16 v[44:47], v[8:11], a[112:119], v3
  v_smfmac_f32_16x16x64_bf16 v[48:51], v[8:11], a[168:175], v3
  v_smfmac_f32_16x16x64_bf16 v[52:55], v[8:11], a[224:231], v3
  buffer_load_dwordx4 v[24:27], v2, s[8:11], s23 offen offset:0
  v_smfmac_f32_16x16x64_bf16 v[56:59], v[8:11], v[144:151], v3
  v_smfmac_f32_16x16x64_bf16 v[60:63], v[8:11], v[200:207], v3
  s_waitcnt vmcnt(3)
  v_smfmac_f32_16x16x64_bf16 v[36:39], v[12:15], a[8:15], v3
  v_smfmac_f32_16x16x64_bf16 v[40:43], v[12:15], a[64:71], v3
  buffer_load_dwordx4 v[28:31], v2, s[8:11], s23 offen offset:1024
  v_smfmac_f32_16x16x64_bf16 v[44:47], v[12:15], a[120:127], v3
  v_smfmac_f32_16x16x64_bf16 v[48:51], v[12:15], a[176:183], v3
  v_smfmac_f32_16x16x64_bf16 v[52:55], v[12:15], a[232:239], v3
  buffer_load_dwordx4 v[32:35], v2, s[8:11], s23 offen offset:2048
  v_smfmac_f32_16x16x64_bf16 v[56:59], v[12:15], v[152:159], v3
  v_smfmac_f32_16x16x64_bf16 v[60:63], v[12:15], v[208:215], v3
  s_waitcnt vmcnt(4)
  v_smfmac_f32_16x16x64_bf16 v[36:39], v[16:19], a[16:23], v3
  v_smfmac_f32_16x16x64_bf16 v[40:43], v[16:19], a[72:79], v3
  v_smfmac_f32_16x16x64_bf16 v[44:47], v[16:19], a[128:135], v3
  v_smfmac_f32_16x16x64_bf16 v[48:51], v[16:19], a[184:191], v3
  v_smfmac_f32_16x16x64_bf16 v[52:55], v[16:19], a[240:247], v3
  v_smfmac_f32_16x16x64_bf16 v[56:59], v[16:19], v[160:167], v3
  v_smfmac_f32_16x16x64_bf16 v[60:63], v[16:19], v[216:223], v3
  s_waitcnt vmcnt(3)
  v_smfmac_f32_16x16x64_bf16 v[36:39], v[20:23], a[24:31], v3
  v_smfmac_f32_16x16x64_bf16 v[40:43], v[20:23], a[80:87], v3
  v_smfmac_f32_16x16x64_bf16 v[44:47], v[20:23], a[136:143], v3
  v_smfmac_f32_16x16x64_bf16 v[48:51], v[20:23], a[192:199], v3
  v_smfmac_f32_16x16x64_bf16 v[52:55], v[20:23], a[248:255], v3
  v_smfmac_f32_16x16x64_bf16 v[56:59], v[20:23], v[168:175], v3
  v_smfmac_f32_16x16x64_bf16 v[60:63], v[20:23], v[224:231], v3
  s_waitcnt vmcnt(0)
cA_sc1_ph2:
  v_smfmac_f32_16x16x64_bf16 v[60:63], v[24:27], v[232:239], v3
  ds_read_b128 v[16:19], v116 offset:2048
  ds_read_b128 v[20:23], v116 offset:3072
  v_smfmac_f32_16x16x64_bf16 v[60:63], v[28:31], v[240:247], v3
  buffer_load_dword v119, v0, s[8:11], s20 offen sc1
  v_smfmac_f32_16x16x64_bf16 v[60:63], v[32:35], v[248:255], v3
  v_mov_b32 v80, v26
  v_smfmac_f32_16x16x64_bf16 v[52:55], v[24:27], v[120:127], v3
  v_mov_b32 v81, v27
  v_smfmac_f32_16x16x64_bf16 v[52:55], v[28:31], v[128:135], v3
  v_mov_b32 v82, v32
  v_smfmac_f32_16x16x64_bf16 v[52:55], v[32:35], v[136:143], v3
  v_cvt_pk_bf16_f32 v66, v60, v61
  v_smfmac_f32_16x16x64_bf16 v[56:59], v[24:27], v[176:183], v3
  v_cvt_pk_bf16_f32 v67, v62, v63
  v_smfmac_f32_16x16x64_bf16 v[56:59], v[28:31], v[184:191], v3
  v_mov_b32 v83, v33
  v_mfma_f32_16x16x32_bf16 v[68:71], v[64:67], v[4:7], 0
  v_smfmac_f32_16x16x64_bf16 v[56:59], v[32:35], v[192:199], v3
  v_cvt_pk_bf16_f32 v64, v52, v53
  v_smfmac_f32_16x16x64_bf16 v[36:39], v[24:27], a[32:39], v3
  v_cvt_pk_bf16_f32 v65, v54, v55
  v_smfmac_f32_16x16x64_bf16 v[36:39], v[28:31], a[40:47], v3
  v_cvt_pk_bf16_f32 v78, v68, v69
  v_smfmac_f32_16x16x64_bf16 v[36:39], v[32:35], a[48:55], v3
  v_cvt_pk_bf16_f32 v79, v70, v71
  v_cvt_pk_bf16_f32 v66, v56, v57
  v_smfmac_f32_16x16x64_bf16 v[40:43], v[24:27], a[88:95], v3
  v_cvt_pk_bf16_f32 v67, v58, v59
  v_smfmac_f32_16x16x64_bf16 v[40:43], v[28:31], a[96:103], v3
  v_mfma_f32_16x16x32_bf16 v[72:75], v[64:67], v[4:7], 0
  ds_read_b128 v[52:55], v116 offset:16384
  ds_read_b128 v[56:59], v116 offset:17408
  v_smfmac_f32_16x16x64_bf16 v[40:43], v[32:35], a[104:111], v3
  v_cvt_pk_bf16_f32 v64, v36, v37
  v_smfmac_f32_16x16x64_bf16 v[44:47], v[24:27], a[144:151], v3
  v_cvt_pk_bf16_f32 v65, v38, v39
  v_smfmac_f32_16x16x64_bf16 v[44:47], v[28:31], a[152:159], v3
  v_cvt_pk_bf16_f32 v76, v72, v73
  v_smfmac_f32_16x16x64_bf16 v[44:47], v[32:35], a[160:167], v3
  v_cvt_pk_bf16_f32 v77, v74, v75
  v_cvt_pk_bf16_f32 v66, v40, v41
  v_smfmac_f32_16x16x64_bf16 v[48:51], v[24:27], a[200:207], v3
  v_cvt_pk_bf16_f32 v67, v42, v43
  v_smfmac_f32_16x16x64_bf16 v[48:51], v[28:31], a[208:215], v3
  v_mfma_f32_16x16x32_bf16 v[68:71], v[64:67], v[4:7], 0
  v_smfmac_f32_16x16x64_bf16 v[48:51], v[32:35], a[216:223], v3
  v_cvt_pk_bf16_f32 v64, v44, v45
  v_mfma_f32_16x16x32_bf16 v[84:87], v[80:83], v[76:79], 0
  v_cvt_pk_bf16_f32 v65, v46, v47
  s_waitcnt lgkmcnt(0)
  v_smfmac_f32_16x16x64_bf16 v[88:91], v[76:79], v[96:103], v3
  v_cvt_pk_bf16_f32 v60, v68, v69
  v_cvt_pk_bf16_f32 v61, v70, v71
  v_cvt_pk_bf16_f32 v66, v48, v49
  v_cvt_pk_bf16_f32 v67, v50, v51
  s_nop 1
  v_mfma_f32_16x16x32_bf16 v[72:75], v[64:67], v[4:7], 0
  v_smfmac_f32_16x16x64_bf16 v[92:95], v[76:79], v[104:111], v3
  s_nop 4
  v_cvt_pk_bf16_f32 v62, v72, v73
  v_cvt_pk_bf16_f32 v63, v74, v75
  s_nop 1
  v_mfma_f32_16x16x32_bf16 v[84:87], v[12:15], v[60:63], v[84:87]
  v_smfmac_f32_16x16x64_bf16 v[88:91], v[60:63], v[16:23], v3
  v_smfmac_f32_16x16x64_bf16 v[92:95], v[60:63], v[52:59], v3
  s_nop 1
  v_permlane32_swap_b32 v84, v86
  v_permlane32_swap_b32 v85, v87
  s_nop 0
  v_cmp_u_f32 vcc, v88, v89
  v_add_f32_dpp v84, v86, v84 row_ror:8 row_mask:0xf bank_mask:0xf
  v_add_f32_dpp v85, v87, v85 row_ror:8 row_mask:0xf bank_mask:0xf
  v_permlane32_swap_b32 v88, v92
  v_permlane32_swap_b32 v89, v93
  ds_write2_b32 v113, v84, v85 offset0:0 offset1:4
  v_permlane32_swap_b32 v90, v94
  v_permlane32_swap_b32 v91, v95
  v_add_f32 v88, v88, v92
  v_add_f32 v89, v89, v93
  v_add_f32 v90, v90, v94
  v_add_f32 v91, v91, v95
  ds_write2_b64 v112, v[88:89], v[90:91] offset0:0 offset1:128
  s_cbranch_vccnz cA_sc1_retry
cA_sc1_cont:
  s_waitcnt lgkmcnt(0)
  s_barrier
  ds_read_b128 v[36:39], v114
  ds_read_b128 v[44:47], v115
  s_waitcnt lgkmcnt(0)
  v_add_f32 v36, v36, v38
  v_add_f32 v37, v37, v39
  v_add_f32 v44, v44, v45
  v_add_f32 v46, v46, v47
  v_permlane32_swap_b32 v36, v37
  v_add_f32 v44, v44, v46
  v_add_f32 v36, v36, v37
  v_exp_f32 v49, v44
  v_exp_f32 v48, v36
  v_add_f32 v50, abs(v36), abs(v44)
  v_fma_f32 v39, v49, s37, v48
  v_cmp_ngt_f32 vcc, s56, v50
  v_cndmask_b32 v41, v48, v49, s[38:39]
  v_add_f32_dpp v39, v39, v39 quad_perm:[1,0,3,2] row_mask:0xf bank_mask:0xf
  v_cndmask_b32 v40, v49, v48, s[38:39]
  v_mov_b32_dpp v46, v41 quad_perm:[1,0,3,2] row_mask:0xf bank_mask:0xf
  v_add_f32_dpp v39, v39, v39 quad_perm:[2,3,0,1] row_mask:0xf bank_mask:0xf
  v_cndmask_b32 v42, v46, v40, s[38:39]
  v_cndmask_b32 v43, v40, v46, s[38:39]
  v_add_f32_dpp v39, v39, v39 row_half_mirror row_mask:0xf bank_mask:0xf
  s_cbranch_vccnz cA_sc1_slow
  s_nop 0
  v_add_f32_dpp v47, v39, v39 row_mirror row_mask:0xf bank_mask:0xf
  v_add_f32_dpp v39, v39, v39 row_mirror row_mask:0xf bank_mask:0xf
  s_nop 1
  v_permlane16_swap_b32 v39, v47
  v_add_f32 v39, v39, v47
  v_rcp_f32 v39, v39
  s_mov_b64 exec, s[28:29]
  v_mul_f32 v42, v42, v39
  v_mul_f32 v43, v43, v39
  v_cvt_pk_bf16_f32 v42, v42, v43
cA_sc1_pst:
  buffer_store_dword v42, v1, s[8:11], s20 offen
  s_mov_b64 exec, -1
  s_barrier
  s_add_u32 s24, s24, 28672
  s_add_u32 s35, s35, 28672
  s_xor_b32 s25, s25, 28672
  s_add_u32 m0, s25, 7168
  s_nop 0
  buffer_load_dwordx4 v2, s[8:11], s24 offen offset:0 sc1 lds
  buffer_load_dwordx4 v2, s[8:11], s24 offen offset:1024 sc1 lds
  buffer_load_dwordx4 v2, s[8:11], s24 offen offset:2048 sc1 lds
  buffer_load_dwordx4 v2, s[8:11], s24 offen offset:3072 sc1 lds
  s_add_u32 m0, s25, 11264
  s_add_u32 s22, s24, 4096
  buffer_load_dwordx4 v2, s[8:11], s22 offen offset:0 sc1 lds
  buffer_load_dwordx4 v2, s[8:11], s22 offen offset:1024 sc1 lds
  buffer_load_dwordx4 v2, s[8:11], s22 offen offset:2048 sc1 lds
  v_xor_b32 v116, 28672, v116
  v_add_u32 v117, s57, v117
  s_sub_u32 s57, 0, s57
  s_add_u32 s19, s19, 1
  s_mov_b32 s20, s21
  s_cmp_lt_u32 s19, 63
  s_cbranch_scc1 cA_sc1_loop
  s_branch cA_done
cA_sc1_slow:
  v_max_f32 v50, v36, v44
  s_nop 1
  v_max_f32_dpp v50, v50, v50 quad_perm:[1,0,3,2] row_mask:0xf bank_mask:0xf
  s_nop 1
  v_max_f32_dpp v50, v50, v50 quad_perm:[2,3,0,1] row_mask:0xf bank_mask:0xf
  s_nop 1
  v_max_f32_dpp v50, v50, v50 row_half_mirror row_mask:0xf bank_mask:0xf
  s_nop 1
  v_max_f32_dpp v50, v50, v50 row_mirror row_mask:0xf bank_mask:0xf
  v_mov_b32 v47, v50
  s_nop 1
  v_permlane16_swap_b32 v50, v47
  v_max_f32 v50, v50, v47
  v_sub_f32 v48, v36, v50
  v_sub_f32 v49, v44, v50
  v_exp_f32 v48, v48
  v_exp_f32 v49, v49
  s_add_u32 s31, s31, 0x100
  v_fma_f32 v39, v49, s37, v48
  v_cndmask_b32 v41, v48, v49, s[38:39]
  s_nop 0
  v_add_f32_dpp v39, v39, v39 quad_perm:[1,0,3,2] row_mask:0xf bank_mask:0xf
  v_cndmask_b32 v40, v49, v48, s[38:39]
  v_mov_b32_dpp v46, v41 quad_perm:[1,0,3,2] row_mask:0xf bank_mask:0xf
  v_add_f32_dpp v39, v39, v39 quad_perm:[2,3,0,1] row_mask:0xf bank_mask:0xf
  v_cndmask_b32 v42, v46, v40, s[38:39]
  v_cndmask_b32 v43, v40, v46, s[38:39]
  v_add_f32_dpp v39, v39, v39 row_half_mirror row_mask:0xf bank_mask:0xf
  s_nop 1
  v_add_f32_dpp v47, v39, v39 row_mirror row_mask:0xf bank_mask:0xf
  v_add_f32_dpp v39, v39, v39 row_mirror row_mask:0xf bank_mask:0xf
  s_nop 1
  v_permlane16_swap_b32 v39, v47
  v_add_f32 v39, v39, v47
  v_rcp_f32 v39, v39
  s_mov_b64 exec, s[28:29]
  v_mul_f32 v42, v42, v39
  v_mul_f32 v43, v43, v39
  v_cvt_pk_bf16_f32 v42, v42, v43
  v_min_u32 v42, -2, v42
  s_branch cA_sc1_pst
cA_sc1_retry:
  s_cmp_lg_u32 s62, 0
  s_cbranch_scc1 cA_sc1_cont
  s_waitcnt vmcnt(0) lgkmcnt(0)
cA_sc1_rv:
  buffer_load_dwordx4 v[8:11], v2, s[8:11], s20 offen offset:0 sc1
  buffer_load_dwordx4 v[12:15], v2, s[8:11], s20 offen offset:1024 sc1
  buffer_load_dwordx4 v[16:19], v2, s[8:11], s20 offen offset:2048 sc1
  buffer_load_dwordx4 v[20:23], v2, s[8:11], s20 offen offset:3072 sc1
  buffer_load_dwordx4 v[24:27], v2, s[8:11], s23 offen offset:0 sc1
  buffer_load_dwordx4 v[28:31], v2, s[8:11], s23 offen offset:1024 sc1
  buffer_load_dwordx4 v[32:35], v2, s[8:11], s23 offen offset:2048 sc1
  s_waitcnt vmcnt(0)
  v_max3_u32 v118, v8, v9, v10
  v_max3_u32 v118, v118, v11, v12
  v_max3_u32 v118, v118, v13, v14
  v_max3_u32 v118, v118, v15, v16
  v_max3_u32 v118, v118, v17, v18
  v_max3_u32 v118, v118, v19, v20
  v_max3_u32 v118, v118, v21, v22
  v_max3_u32 v118, v118, v23, v24
  v_max3_u32 v118, v118, v25, v26
  v_max3_u32 v118, v118, v27, v28
  v_max3_u32 v118, v118, v29, v30
  v_max3_u32 v118, v118, v31, v32
  v_max3_u32 v118, v118, v33, v34
  v_max_u32 v118, v118, v35
  v_cmp_eq_u32 vcc, -1, v118
  s_cbranch_vccz cA_sc1_rk
  s_add_u32 s30, s30, 1
  s_cmp_lt_u32 s30, 400000
  s_cbranch_scc1 cA_sc1_rv
  s_branch cA_abort
cA_sc1_rk:
  s_mov_b32 s62, 1
  v_mov_b32 v36, 0
  v_mov_b32 v37, 0
  v_mov_b32 v38, 0
  v_mov_b32 v39, 0
  v_mov_b32 v40, 0
  v_mov_b32 v41, 0
  v_mov_b32 v42, 0
  v_mov_b32 v43, 0
  v_mov_b32 v44, 0
  v_mov_b32 v45, 0
  v_mov_b32 v46, 0
  v_mov_b32 v47, 0
  v_mov_b32 v48, 0
  v_mov_b32 v49, 0
  v_mov_b32 v50, 0
  v_mov_b32 v51, 0
  v_mov_b32 v52, 0
  v_mov_b32 v53, 0
  v_mov_b32 v54, 0
  v_mov_b32 v55, 0
  v_mov_b32 v56, 0
  v_mov_b32 v57, 0
  v_mov_b32 v58, 0
  v_mov_b32 v59, 0
  v_mov_b32 v60, 0
  v_mov_b32 v61, 0
  v_mov_b32 v62, 0
  v_mov_b32 v63, 0
  v_mov_b32 v88, 0
  v_mov_b32 v89, 0
  v_mov_b32 v90, 0
  v_mov_b32 v91, 0
  v_mov_b32 v92, 0
  v_mov_b32 v93, 0
  v_mov_b32 v94, 0
  v_mov_b32 v95, 0
  v_mov_b32 v64, 0
  v_mov_b32 v65, 0
  s_add_u32 s31, s31, 1
  ds_read_b128 v[96:99], v117 offset:0
  ds_read_b128 v[100:103], v117 offset:1024
  ds_read_b128 v[104:107], v117 offset:14336
  ds_read_b128 v[108:111], v117 offset:15360
  v_smfmac_f32_16x16x64_bf16 v[36:39], v[8:11], a[0:7], v3
  v_smfmac_f32_16x16x64_bf16 v[40:43], v[8:11], a[56:63], v3
  v_smfmac_f32_16x16x64_bf16 v[44:47], v[8:11], a[112:119], v3
  v_smfmac_f32_16x16x64_bf16 v[48:51], v[8:11], a[168:175], v3
  v_smfmac_f32_16x16x64_bf16 v[52:55], v[8:11], a[224:231], v3
  v_smfmac_f32_16x16x64_bf16 v[56:59], v[8:11], v[144:151], v3
  v_smfmac_f32_16x16x64_bf16 v[60:63], v[8:11], v[200:207], v3
  v_smfmac_f32_16x16x64_bf16 v[36:39], v[12:15], a[8:15], v3
  v_smfmac_f32_16x16x64_bf16 v[40:43], v[12:15], a[64:71], v3
  v_smfmac_f32_16x16x64_bf16 v[44:47], v[12:15], a[120:127], v3
  v_smfmac_f32_16x16x64_bf16 v[48:51], v[12:15], a[176:183], v3
  v_smfmac_f32_16x16x64_bf16 v[52:55], v[12:15], a[232:239], v3
  v_smfmac_f32_16x16x64_bf16 v[56:59], v[12:15], v[152:159], v3
  v_smfmac_f32_16x16x64_bf16 v[60:63], v[12:15], v[208:215], v3
  v_smfmac_f32_16x16x64_bf16 v[36:39], v[16:19], a[16:23], v3
  v_smfmac_f32_16x16x64_bf16 v[40:43], v[16:19], a[72:79], v3
  v_smfmac_f32_16x16x64_bf16 v[44:47], v[16:19], a[128:135], v3
  v_smfmac_f32_16x16x64_bf16 v[48:51], v[16:19], a[184:191], v3
  v_smfmac_f32_16x16x64_bf16 v[52:55], v[16:19], a[240:247], v3
  v_smfmac_f32_16x16x64_bf16 v[56:59], v[16:19], v[160:167], v3
  v_smfmac_f32_16x16x64_bf16 v[60:63], v[16:19], v[216:223], v3
  v_smfmac_f32_16x16x64_bf16 v[36:39], v[20:23], a[24:31], v3
  v_smfmac_f32_16x16x64_bf16 v[40:43], v[20:23], a[80:87], v3
  v_smfmac_f32_16x16x64_bf16 v[44:47], v[20:23], a[136:143], v3
  v_smfmac_f32_16x16x64_bf16 v[48:51], v[20:23], a[192:199], v3
  v_smfmac_f32_16x16x64_bf16 v[52:55], v[20:23], a[248:255], v3
  v_smfmac_f32_16x16x64_bf16 v[56:59], v[20:23], v[168:175], v3
  v_smfmac_f32_16x16x64_bf16 v[60:63], v[20:23], v[224:231], v3
  s_branch cA_sc1_ph2
.p2align 6

cA_sc2_loop:
  s_add_u32 s23, s20, 4096
  s_add_u32 s21, s20, 25600
  v_mov_b32 v48, 0
  v_mov_b32 v49, 0
  v_mov_b32 v50, 0
  v_mov_b32 v51, 0
  v_mov_b32 v52, 0
  v_mov_b32 v53, 0
  v_mov_b32 v54, 0
  v_mov_b32 v55, 0
  v_mov_b32 v56, 0
  v_mov_b32 v57, 0
  v_mov_b32 v58, 0
  v_mov_b32 v59, 0
  v_mov_b32 v60, 0
  v_mov_b32 v61, 0
  v_mov_b32 v62, 0
  v_mov_b32 v63, 0
  v_mov_b32 v88, 0
  v_mov_b32 v89, 0
  v_mov_b32 v90, 0
  v_mov_b32 v91, 0
  v_mov_b32 v92, 0
  v_mov_b32 v93, 0
  v_mov_b32 v94, 0
  v_mov_b32 v95, 0
  v_mov_b32 v66, 0
  v_mov_b32 v67, 0
  s_mov_b32 s30, 0
  s_mov_b32 s62, 0
  s_waitcnt vmcnt(0)
  s_barrier
cA_sc2_ld:
  buffer_load_dwordx4 v[8:11], v2, s[8:11], s20 offen offset:0
  v_mov_b32 v36, 0
  v_mov_b32 v37, 0
  v_mov_b32 v38, 0
  v_mov_b32 v39, 0
  buffer_load_dwordx4 v[12:15], v2, s[8:11], s20 offen offset:1024
  v_mov_b32 v40, 0
  v_mov_b32 v41, 0
  v_mov_b32 v42, 0
  v_mov_b32 v43, 0
  buffer_load_dwordx4 v[16:19], v2, s[8:11], s20 offen offset:2048
  v_mov_b32 v44, 0
  v_mov_b32 v45, 0
  v_mov_b32 v46, 0
  v_mov_b32 v47, 0
  ds_read_b128 v[96:99], v117 offset:0
  ds_read_b128 v[100:103], v117 offset:1024
  ds_read_b128 v[104:107], v117 offset:14336
  ds_read_b128 v[108:111], v117 offset:15360
  s_waitcnt vmcnt(2)
  v_smfmac_f32_16x16x64_bf16 v[36:39], v[8:11], a[0:7], v3
  v_smfmac_f32_16x16x64_bf16 v[40:43], v[8:11], a[56:63], v3
  buffer_load_dwordx4 v[20:23], v2, s[8:11], s20 offen offset:3072
  v_smfmac_f32_16x16x64_bf16 v[44:47], v[8:11], a[112:119], v3
  v_smfmac_f32_16x16x64_bf16 v[48:51], v[8:11], a[168:175], v3
  v_smfmac_f32_16x16x64_bf16 v[52:55], v[8:11], a[224:231], v3
  buffer_load_dwordx4 v[24:27], v2, s[8:11], s23 offen offset:0
  v_smfmac_f32_16x16x64_bf16 v[56:59], v[8:11], v[144:151], v3
  v_smfmac_f32_16x16x64_bf16 v[60:63], v[8:11], v[200:207], v3
  s_waitcnt vmcnt(3)
  v_smfmac_f32_16x16x64_bf16 v[36:39], v[12:15], a[8:15], v3
  v_smfmac_f32_16x16x64_bf16 v[40:43], v[12:15], a[64:71], v3
  buffer_load_dwordx4 v[28:31], v2, s[8:11], s23 offen offset:1024
  v_smfmac_f32_16x16x64_bf16 v[44:47], v[12:15], a[120:127], v3
  v_smfmac_f32_16x16x64_bf16 v[48:51], v[12:15], a[176:183], v3
  v_smfmac_f32_16x16x64_bf16 v[52:55], v[12:15], a[232:239], v3
  buffer_load_dwordx4 v[32:35], v2, s[8:11], s23 offen offset:2048
  v_smfmac_f32_16x16x64_bf16 v[56:59], v[12:15], v[152:159], v3
  v_smfmac_f32_16x16x64_bf16 v[60:63], v[12:15], v[208:215], v3
  s_waitcnt vmcnt(4)
  v_smfmac_f32_16x16x64_bf16 v[36:39], v[16:19], a[16:23], v3
  v_smfmac_f32_16x16x64_bf16 v[40:43], v[16:19], a[72:79], v3
  v_smfmac_f32_16x16x64_bf16 v[44:47], v[16:19], a[128:135], v3
  v_smfmac_f32_16x16x64_bf16 v[48:51], v[16:19], a[184:191], v3
  v_smfmac_f32_16x16x64_bf16 v[52:55], v[16:19], a[240:247], v3
  v_smfmac_f32_16x16x64_bf16 v[56:59], v[16:19], v[160:167], v3
  v_smfmac_f32_16x16x64_bf16 v[60:63], v[16:19], v[216:223], v3
  s_waitcnt vmcnt(3)
  v_smfmac_f32_16x16x64_bf16 v[36:39], v[20:23], a[24:31], v3
  v_smfmac_f32_16x16x64_bf16 v[40:43], v[20:23], a[80:87], v3
  v_smfmac_f32_16x16x64_bf16 v[44:47], v[20:23], a[136:143], v3
  v_smfmac_f32_16x16x64_bf16 v[48:51], v[20:23], a[192:199], v3
  v_smfmac_f32_16x16x64_bf16 v[52:55], v[20:23], a[248:255], v3
  v_smfmac_f32_16x16x64_bf16 v[56:59], v[20:23], v[168:175], v3
  v_smfmac_f32_16x16x64_bf16 v[60:63], v[20:23], v[224:231], v3
  s_waitcnt vmcnt(0)
cA_sc2_ph2:
  v_smfmac_f32_16x16x64_bf16 v[60:63], v[24:27], v[232:239], v3
  ds_read_b128 v[8:11], v116 offset:4096
  ds_read_b128 v[12:15], v116 offset:5120
  v_smfmac_f32_16x16x64_bf16 v[60:63], v[28:31], v[240:247], v3
  buffer_load_dword v119, v0, s[8:11], s24 offen sc1
  v_smfmac_f32_16x16x64_bf16 v[60:63], v[32:35], v[248:255], v3
  v_mov_b32 v80, v28
  v_smfmac_f32_16x16x64_bf16 v[52:55], v[24:27], v[120:127], v3
  v_mov_b32 v81, v29
  v_smfmac_f32_16x16x64_bf16 v[52:55], v[28:31], v[128:135], v3
  v_mov_b32 v82, v34
  v_smfmac_f32_16x16x64_bf16 v[52:55], v[32:35], v[136:143], v3
  v_cvt_pk_bf16_f32 v64, v60, v61
  v_smfmac_f32_16x16x64_bf16 v[56:59], v[24:27], v[176:183], v3
  v_cvt_pk_bf16_f32 v65, v62, v63
  v_smfmac_f32_16x16x64_bf16 v[56:59], v[28:31], v[184:191], v3
  v_mov_b32 v83, v35
  v_mfma_f32_16x16x32_bf16 v[68:71], v[64:67], v[4:7], 0
  v_smfmac_f32_16x16x64_bf16 v[56:59], v[32:35], v[192:199], v3
  v_cvt_pk_bf16_f32 v64, v52, v53
  v_smfmac_f32_16x16x64_bf16 v[36:39], v[24:27], a[32:39], v3
  v_cvt_pk_bf16_f32 v65, v54, v55
  v_smfmac_f32_16x16x64_bf16 v[36:39], v[28:31], a[40:47], v3
  v_cvt_pk_bf16_f32 v78, v68, v69
  v_smfmac_f32_16x16x64_bf16 v[36:39], v[32:35], a[48:55], v3
  v_cvt_pk_bf16_f32 v79, v70, v71
  v_cvt_pk_bf16_f32 v66, v56, v57
  v_smfmac_f32_16x16x64_bf16 v[40:43], v[24:27], a[88:95], v3
  v_cvt_pk_bf16_f32 v67, v58, v59
  v_smfmac_f32_16x16x64_bf16 v[40:43], v[28:31], a[96:103], v3
  v_mfma_f32_16x16x32_bf16 v[72:75], v[64:67], v[4:7], 0
  ds_read_b128 v[52:55], v116 offset:18432
  ds_read_b128 v[56:59], v116 offset:19456
  v_smfmac_f32_16x16x64_bf16 v[40:43], v[32:35], a[104:111], v3
  v_cvt_pk_bf16_f32 v64, v36, v37
  v_smfmac_f32_16x16x64_bf16 v[44:47], v[24:27], a[144:151], v3
  v_cvt_pk_bf16_f32 v65, v38, v39
  v_smfmac_f32_16x16x64_bf16 v[44:47], v[28:31], a[152:159], v3
  v_cvt_pk_bf16_f32 v76, v72, v73
  v_smfmac_f32_16x16x64_bf16 v[44:47], v[32:35], a[160:167], v3
  v_cvt_pk_bf16_f32 v77, v74, v75
  v_cvt_pk_bf16_f32 v66, v40, v41
  v_smfmac_f32_16x16x64_bf16 v[48:51], v[24:27], a[200:207], v3
  v_cvt_pk_bf16_f32 v67, v42, v43
  v_smfmac_f32_16x16x64_bf16 v[48:51], v[28:31], a[208:215], v3
  v_mfma_f32_16x16x32_bf16 v[68:71], v[64:67], v[4:7], 0
  v_smfmac_f32_16x16x64_bf16 v[48:51], v[32:35], a[216:223], v3
  v_cvt_pk_bf16_f32 v64, v44, v45
  v_mfma_f32_16x16x32_bf16 v[84:87], v[80:83], v[76:79], 0
  v_cvt_pk_bf16_f32 v65, v46, v47
  s_waitcnt lgkmcnt(0)
  v_smfmac_f32_16x16x64_bf16 v[88:91], v[76:79], v[96:103], v3
  v_cvt_pk_bf16_f32 v60, v68, v69
  v_cvt_pk_bf16_f32 v61, v70, v71
  v_cvt_pk_bf16_f32 v66, v48, v49
  v_cvt_pk_bf16_f32 v67, v50, v51
  s_nop 1
  v_mfma_f32_16x16x32_bf16 v[72:75], v[64:67], v[4:7], 0
  v_smfmac_f32_16x16x64_bf16 v[92:95], v[76:79], v[104:111], v3
  s_nop 4
  v_cvt_pk_bf16_f32 v62, v72, v73
  v_cvt_pk_bf16_f32 v63, v74, v75
  s_nop 1
  v_mfma_f32_16x16x32_bf16 v[84:87], v[16:19], v[60:63], v[84:87]
  v_smfmac_f32_16x16x64_bf16 v[88:91], v[60:63], v[8:15], v3
  v_smfmac_f32_16x16x64_bf16 v[92:95], v[60:63], v[52:59], v3
  s_nop 1
  v_permlane32_swap_b32 v84, v86
  v_permlane32_swap_b32 v85, v87
  s_nop 0
  v_cmp_u_f32 vcc, v88, v89
  v_add_f32_dpp v84, v86, v84 row_ror:8 row_mask:0xf bank_mask:0xf
  v_add_f32_dpp v85, v87, v85 row_ror:8 row_mask:0xf bank_mask:0xf
  v_permlane32_swap_b32 v88, v92
  v_permlane32_swap_b32 v89, v93
  ds_write2_b32 v113, v84, v85 offset0:0 offset1:4
  v_permlane32_swap_b32 v90, v94
  v_permlane32_swap_b32 v91, v95
  v_add_f32 v88, v88, v92
  v_add_f32 v89, v89, v93
  v_add_f32 v90, v90, v94
  v_add_f32 v91, v91, v95
  ds_write2_b64 v112, v[88:89], v[90:91] offset0:0 offset1:128
  s_cbranch_vccnz cA_sc2_retry
cA_sc2_cont:
  s_waitcnt lgkmcnt(0)
  s_barrier
  ds_read_b128 v[36:39], v114
  ds_read_b128 v[44:47], v115
  v_lshl_add_u32 v56, v2, 3, s36
  s_waitcnt lgkmcnt(0)
  v_add_f32 v36, v36, v38
  v_add_f32 v37, v37, v39
  v_add_f32 v44, v44, v45
  s_mov_b64 exec, 65535
  buffer_store_dword v2, v56, s[8:11], s20 offen
  s_mov_b64 exec, -1
  v_add_f32 v46, v46, v47
  v_permlane32_swap_b32 v36, v37
  v_add_f32 v44, v44, v46
  v_add_f32 v36, v36, v37
  v_exp_f32 v49, v44
  v_exp_f32 v48, v36
  v_add_f32 v50, abs(v36), abs(v44)
  v_fma_f32 v39, v49, s37, v48
  v_cmp_ngt_f32 vcc, s56, v50
  v_cndmask_b32 v41, v48, v49, s[38:39]
  v_add_f32_dpp v39, v39, v39 quad_perm:[1,0,3,2] row_mask:0xf bank_mask:0xf
  v_cndmask_b32 v40, v49, v48, s[38:39]
  v_mov_b32_dpp v46, v41 quad_perm:[1,0,3,2] row_mask:0xf bank_mask:0xf
  v_add_f32_dpp v39, v39, v39 quad_perm:[2,3,0,1] row_mask:0xf bank_mask:0xf
  v_cndmask_b32 v42, v46, v40, s[38:39]
  v_cndmask_b32 v43, v40, v46, s[38:39]
  v_add_f32_dpp v39, v39, v39 row_half_mirror row_mask:0xf bank_mask:0xf
  s_cbranch_vccnz cA_sc2_slow
  s_nop 0
  v_add_f32_dpp v47, v39, v39 row_mirror row_mask:0xf bank_mask:0xf
  v_add_f32_dpp v39, v39, v39 row_mirror row_mask:0xf bank_mask:0xf
  s_nop 1
  v_permlane16_swap_b32 v39, v47
  v_add_f32 v39, v39, v47
  v_rcp_f32 v39, v39
  s_mov_b64 exec, s[28:29]
  v_mul_f32 v42, v42, v39
  v_mul_f32 v43, v43, v39
  v_cvt_pk_bf16_f32 v42, v42, v43
cA_sc2_pst:
  buffer_store_dword v42, v1, s[8:11], s20 offen
  s_mov_b64 exec, -1
  s_barrier
  s_add_u32 s24, s24, 28672
  s_add_u32 s35, s35, 28672
  s_xor_b32 s25, s25, 28672
  s_add_u32 m0, s25, 14336
  s_nop 0
  buffer_load_dwordx4 v2, s[8:11], s24 offen offset:0 sc1 lds
  buffer_load_dwordx4 v2, s[8:11], s24 offen offset:1024 sc1 lds
  buffer_load_dwordx4 v2, s[8:11], s24 offen offset:2048 sc1 lds
  buffer_load_dwordx4 v2, s[8:11], s24 offen offset:3072 sc1 lds
  s_add_u32 m0, s25, 18432
  s_add_u32 s22, s24, 4096
  buffer_load_dwordx4 v2, s[8:11], s22 offen offset:0 sc1 lds
  buffer_load_dwordx4 v2, s[8:11], s22 offen offset:1024 sc1 lds
  buffer_load_dwordx4 v2, s[8:11], s22 offen offset:2048 sc1 lds
  v_xor_b32 v116, 28672, v116
  v_add_u32 v117, s57, v117
  s_sub_u32 s57, 0, s57
  s_add_u32 s19, s19, 1
  s_mov_b32 s20, s21
  s_cmp_lt_u32 s19, 63
  s_cbranch_scc1 cA_sc2_loop
  s_branch cA_done
cA_sc2_slow:
  v_max_f32 v50, v36, v44
  s_nop 1
  v_max_f32_dpp v50, v50, v50 quad_perm:[1,0,3,2] row_mask:0xf bank_mask:0xf
  s_nop 1
  v_max_f32_dpp v50, v50, v50 quad_perm:[2,3,0,1] row_mask:0xf bank_mask:0xf
  s_nop 1
  v_max_f32_dpp v50, v50, v50 row_half_mirror row_mask:0xf bank_mask:0xf
  s_nop 1
  v_max_f32_dpp v50, v50, v50 row_mirror row_mask:0xf bank_mask:0xf
  v_mov_b32 v47, v50
  s_nop 1
  v_permlane16_swap_b32 v50, v47
  v_max_f32 v50, v50, v47
  v_sub_f32 v48, v36, v50
  v_sub_f32 v49, v44, v50
  v_exp_f32 v48, v48
  v_exp_f32 v49, v49
  s_add_u32 s31, s31, 0x100
  v_fma_f32 v39, v49, s37, v48
  v_cndmask_b32 v41, v48, v49, s[38:39]
  s_nop 0
  v_add_f32_dpp v39, v39, v39 quad_perm:[1,0,3,2] row_mask:0xf bank_mask:0xf
  v_cndmask_b32 v40, v49, v48, s[38:39]
  v_mov_b32_dpp v46, v41 quad_perm:[1,0,3,2] row_mask:0xf bank_mask:0xf
  v_add_f32_dpp v39, v39, v39 quad_perm:[2,3,0,1] row_mask:0xf bank_mask:0xf
  v_cndmask_b32 v42, v46, v40, s[38:39]
  v_cndmask_b32 v43, v40, v46, s[38:39]
  v_add_f32_dpp v39, v39, v39 row_half_mirror row_mask:0xf bank_mask:0xf
  s_nop 1
  v_add_f32_dpp v47, v39, v39 row_mirror row_mask:0xf bank_mask:0xf
  v_add_f32_dpp v39, v39, v39 row_mirror row_mask:0xf bank_mask:0xf
  s_nop 1
  v_permlane16_swap_b32 v39, v47
  v_add_f32 v39, v39, v47
  v_rcp_f32 v39, v39
  s_mov_b64 exec, s[28:29]
  v_mul_f32 v42, v42, v39
  v_mul_f32 v43, v43, v39
  v_cvt_pk_bf16_f32 v42, v42, v43
  v_min_u32 v42, -2, v42
  s_branch cA_sc2_pst
cA_sc2_retry:
  s_cmp_lg_u32 s62, 0
  s_cbranch_scc1 cA_sc2_cont
  s_waitcnt vmcnt(0) lgkmcnt(0)
cA_sc2_rv:
  buffer_load_dwordx4 v[8:11], v2, s[8:11], s20 offen offset:0 sc1
  buffer_load_dwordx4 v[12:15], v2, s[8:11], s20 offen offset:1024 sc1
  buffer_load_dwordx4 v[16:19], v2, s[8:11], s20 offen offset:2048 sc1
  buffer_load_dwordx4 v[20:23], v2, s[8:11], s20 offen offset:3072 sc1
  buffer_load_dwordx4 v[24:27], v2, s[8:11], s23 offen offset:0 sc1
  buffer_load_dwordx4 v[28:31], v2, s[8:11], s23 offen offset:1024 sc1
  buffer_load_dwordx4 v[32:35], v2, s[8:11], s23 offen offset:2048 sc1
  s_waitcnt vmcnt(0)
  v_max3_u32 v118, v8, v9, v10
  v_max3_u32 v118, v118, v11, v12
  v_max3_u32 v118, v118, v13, v14
  v_max3_u32 v118, v118, v15, v16
  v_max3_u32 v118, v118, v17, v18
  v_max3_u32 v118, v118, v19, v20
  v_max3_u32 v118, v118, v21, v22
  v_max3_u32 v118, v118, v23, v24
  v_max3_u32 v118, v118, v25, v26
  v_max3_u32 v118, v118, v27, v28
  v_max3_u32 v118, v118, v29, v30
  v_max3_u32 v118, v118, v31, v32
  v_max3_u32 v118, v118, v33, v34
  v_max_u32 v118, v118, v35
  v_cmp_eq_u32 vcc, -1, v118
  s_cbranch_vccz cA_sc2_rk
  s_add_u32 s30, s30, 1
  s_cmp_lt_u32 s30, 400000
  s_cbranch_scc1 cA_sc2_rv
  s_branch cA_abort
cA_sc2_rk:
  s_mov_b32 s62, 1
  v_mov_b32 v36, 0
  v_mov_b32 v37, 0
  v_mov_b32 v38, 0
  v_mov_b32 v39, 0
  v_mov_b32 v40, 0
  v_mov_b32 v41, 0
  v_mov_b32 v42, 0
  v_mov_b32 v43, 0
  v_mov_b32 v44, 0
  v_mov_b32 v45, 0
  v_mov_b32 v46, 0
  v_mov_b32 v47, 0
  v_mov_b32 v48, 0
  v_mov_b32 v49, 0
  v_mov_b32 v50, 0
  v_mov_b32 v51, 0
  v_mov_b32 v52, 0
  v_mov_b32 v53, 0
  v_mov_b32 v54, 0
  v_mov_b32 v55, 0
  v_mov_b32 v56, 0
  v_mov_b32 v57, 0
  v_mov_b32 v58, 0
  v_mov_b32 v59, 0
  v_mov_b32 v60, 0
  v_mov_b32 v61, 0
  v_mov_b32 v62, 0
  v_mov_b32 v63, 0
  v_mov_b32 v88, 0
  v_mov_b32 v89, 0
  v_mov_b32 v90, 0
  v_mov_b32 v91, 0
  v_mov_b32 v92, 0
  v_mov_b32 v93, 0
  v_mov_b32 v94, 0
  v_mov_b32 v95, 0
  v_mov_b32 v66, 0
  v_mov_b32 v67, 0
  s_add_u32 s31, s31, 1
  ds_read_b128 v[96:99], v117 offset:0
  ds_read_b128 v[100:103], v117 offset:1024
  ds_read_b128 v[104:107], v117 offset:14336
  ds_read_b128 v[108:111], v117 offset:15360
  v_smfmac_f32_16x16x64_bf16 v[36:39], v[8:11], a[0:7], v3
  v_smfmac_f32_16x16x64_bf16 v[40:43], v[8:11], a[56:63], v3
  v_smfmac_f32_16x16x64_bf16 v[44:47], v[8:11], a[112:119], v3
  v_smfmac_f32_16x16x64_bf16 v[48:51], v[8:11], a[168:175], v3
  v_smfmac_f32_16x16x64_bf16 v[52:55], v[8:11], a[224:231], v3
  v_smfmac_f32_16x16x64_bf16 v[56:59], v[8:11], v[144:151], v3
  v_smfmac_f32_16x16x64_bf16 v[60:63], v[8:11], v[200:207], v3
  v_smfmac_f32_16x16x64_bf16 v[36:39], v[12:15], a[8:15], v3
  v_smfmac_f32_16x16x64_bf16 v[40:43], v[12:15], a[64:71], v3
  v_smfmac_f32_16x16x64_bf16 v[44:47], v[12:15], a[120:127], v3
  v_smfmac_f32_16x16x64_bf16 v[48:51], v[12:15], a[176:183], v3
  v_smfmac_f32_16x16x64_bf16 v[52:55], v[12:15], a[232:239], v3
  v_smfmac_f32_16x16x64_bf16 v[56:59], v[12:15], v[152:159], v3
  v_smfmac_f32_16x16x64_bf16 v[60:63], v[12:15], v[208:215], v3
  v_smfmac_f32_16x16x64_bf16 v[36:39], v[16:19], a[16:23], v3
  v_smfmac_f32_16x16x64_bf16 v[40:43], v[16:19], a[72:79], v3
  v_smfmac_f32_16x16x64_bf16 v[44:47], v[16:19], a[128:135], v3
  v_smfmac_f32_16x16x64_bf16 v[48:51], v[16:19], a[184:191], v3
  v_smfmac_f32_16x16x64_bf16 v[52:55], v[16:19], a[240:247], v3
  v_smfmac_f32_16x16x64_bf16 v[56:59], v[16:19], v[160:167], v3
  v_smfmac_f32_16x16x64_bf16 v[60:63], v[16:19], v[216:223], v3
  v_smfmac_f32_16x16x64_bf16 v[36:39], v[20:23], a[24:31], v3
  v_smfmac_f32_16x16x64_bf16 v[40:43], v[20:23], a[80:87], v3
  v_smfmac_f32_16x16x64_bf16 v[44:47], v[20:23], a[136:143], v3
  v_smfmac_f32_16x16x64_bf16 v[48:51], v[20:23], a[192:199], v3
  v_smfmac_f32_16x16x64_bf16 v[52:55], v[20:23], a[248:255], v3
  v_smfmac_f32_16x16x64_bf16 v[56:59], v[20:23], v[168:175], v3
  v_smfmac_f32_16x16x64_bf16 v[60:63], v[20:23], v[224:231], v3
  s_branch cA_sc2_ph2
.p2align 6

cA_sc3_loop:
  s_add_u32 s23, s20, 4096
  s_add_u32 s21, s20, 25600
  v_mov_b32 v48, 0
  v_mov_b32 v49, 0
  v_mov_b32 v50, 0
  v_mov_b32 v51, 0
  v_mov_b32 v52, 0
  v_mov_b32 v53, 0
  v_mov_b32 v54, 0
  v_mov_b32 v55, 0
  v_mov_b32 v56, 0
  v_mov_b32 v57, 0
  v_mov_b32 v58, 0
  v_mov_b32 v59, 0
  v_mov_b32 v60, 0
  v_mov_b32 v61, 0
  v_mov_b32 v62, 0
  v_mov_b32 v63, 0
  v_mov_b32 v88, 0
  v_mov_b32 v89, 0
  v_mov_b32 v90, 0
  v_mov_b32 v91, 0
  v_mov_b32 v92, 0
  v_mov_b32 v93, 0
  v_mov_b32 v94, 0
  v_mov_b32 v95, 0
  v_mov_b32 v64, 0
  v_mov_b32 v65, 0
  s_mov_b32 s30, 0
  s_mov_b32 s62, 0
  s_waitcnt vmcnt(0)
  s_barrier
cA_sc3_ld:
  buffer_load_dwordx4 v[8:11], v2, s[8:11], s20 offen offset:0
  v_mov_b32 v36, 0
  v_mov_b32 v37, 0
  v_mov_b32 v38, 0
  v_mov_b32 v39, 0
  buffer_load_dwordx4 v[12:15], v2, s[8:11], s20 offen offset:1024
  v_mov_b32 v40, 0
  v_mov_b32 v41, 0
  v_mov_b32 v42, 0
  v_mov_b32 v43, 0
  buffer_load_dwordx4 v[16:19], v2, s[8:11], s20 offen offset:2048
  v_mov_b32 v44, 0
  v_mov_b32 v45, 0
  v_mov_b32 v46, 0
  v_mov_b32 v47, 0
  ds_read_b128 v[96:99], v117 offset:0
  ds_read_b128 v[100:103], v117 offset:1024
  ds_read_b128 v[104:107], v117 offset:14336
  ds_read_b128 v[108:111], v117 offset:15360
  s_waitcnt vmcnt(2)
  v_smfmac_f32_16x16x64_bf16 v[36:39], v[8:11], a[0:7], v3
  v_smfmac_f32_16x16x64_bf16 v[40:43], v[8:11], a[56:63], v3
  buffer_load_dwordx4 v[20:23], v2, s[8:11], s20 offen offset:3072
  v_smfmac_f32_16x16x64_bf16 v[44:47], v[8:11], a[112:119], v3
  v_smfmac_f32_16x16x64_bf16 v[48:51], v[8:11], a[168:175], v3
  v_smfmac_f32_16x16x64_bf16 v[52:55], v[8:11], a[224:231], v3
  buffer_load_dwordx4 v[24:27], v2, s[8:11], s23 offen offset:0
  v_smfmac_f32_16x16x64_bf16 v[56:59], v[8:11], v[144:151], v3
  v_smfmac_f32_16x16x64_bf16 v[60:63], v[8:11], v[200:207], v3
  s_waitcnt vmcnt(3)
  v_smfmac_f32_16x16x64_bf16 v[36:39], v[12:15], a[8:15], v3
  v_smfmac_f32_16x16x64_bf16 v[40:43], v[12:15], a[64:71], v3
  buffer_load_dwordx4 v[28:31], v2, s[8:11], s23 offen offset:1024
  v_smfmac_f32_16x16x64_bf16 v[44:47], v[12:15], a[120:127], v3
  v_smfmac_f32_16x16x64_bf16 v[48:51], v[12:15], a[176:183], v3
  v_smfmac_f32_16x16x64_bf16 v[52:55], v[12:15], a[232:239], v3
  buffer_load_dwordx4 v[32:35], v2, s[8:11], s23 offen offset:2048
  v_smfmac_f32_16x16x64_bf16 v[56:59], v[12:15], v[152:159], v3
  v_smfmac_f32_16x16x64_bf16 v[60:63], v[12:15], v[208:215], v3
  s_waitcnt vmcnt(4)
  v_smfmac_f32_16x16x64_bf16 v[36:39], v[16:19], a[16:23], v3
  v_smfmac_f32_16x16x64_bf16 v[40:43], v[16:19], a[72:79], v3
  v_smfmac_f32_16x16x64_bf16 v[44:47], v[16:19], a[128:135], v3
  v_smfmac_f32_16x16x64_bf16 v[48:51], v[16:19], a[184:191], v3
  v_smfmac_f32_16x16x64_bf16 v[52:55], v[16:19], a[240:247], v3
  v_smfmac_f32_16x16x64_bf16 v[56:59], v[16:19], v[160:167], v3
  v_smfmac_f32_16x16x64_bf16 v[60:63], v[16:19], v[216:223], v3
  s_waitcnt vmcnt(3)
  v_smfmac_f32_16x16x64_bf16 v[36:39], v[20:23], a[24:31], v3
  v_smfmac_f32_16x16x64_bf16 v[40:43], v[20:23], a[80:87], v3
  v_smfmac_f32_16x16x64_bf16 v[44:47], v[20:23], a[136:143], v3
  v_smfmac_f32_16x16x64_bf16 v[48:51], v[20:23], a[192:199], v3
  v_smfmac_f32_16x16x64_bf16 v[52:55], v[20:23], a[248:255], v3
  v_smfmac_f32_16x16x64_bf16 v[56:59], v[20:23], v[168:175], v3
  v_smfmac_f32_16x16x64_bf16 v[60:63], v[20:23], v[224:231], v3
  s_waitcnt vmcnt(0)
cA_sc3_ph2:
  v_smfmac_f32_16x16x64_bf16 v[60:63], v[24:27], v[232:239], v3
  ds_read_b128 v[8:11], v116 offset:6144
  ds_read_b128 v[12:15], v116 offset:7168
  v_smfmac_f32_16x16x64_bf16 v[60:63], v[28:31], v[240:247], v3
  v_smfmac_f32_16x16x64_bf16 v[60:63], v[32:35], v[248:255], v3
  v_mov_b32 v80, v30
  v_smfmac_f32_16x16x64_bf16 v[52:55], v[24:27], v[120:127], v3
  v_mov_b32 v81, v31
  v_smfmac_f32_16x16x64_bf16 v[52:55], v[28:31], v[128:135], v3
  v_mov_b32 v82, v34
  v_smfmac_f32_16x16x64_bf16 v[52:55], v[32:35], v[136:143], v3
  v_cvt_pk_bf16_f32 v66, v60, v61
  v_smfmac_f32_16x16x64_bf16 v[56:59], v[24:27], v[176:183], v3
  v_cvt_pk_bf16_f32 v67, v62, v63
  v_smfmac_f32_16x16x64_bf16 v[56:59], v[28:31], v[184:191], v3
  v_mov_b32 v83, v35
  v_mfma_f32_16x16x32_bf16 v[68:71], v[64:67], v[4:7], 0
  v_smfmac_f32_16x16x64_bf16 v[56:59], v[32:35], v[192:199], v3
  v_cvt_pk_bf16_f32 v64, v52, v53
  v_smfmac_f32_16x16x64_bf16 v[36:39], v[24:27], a[32:39], v3
  v_cvt_pk_bf16_f32 v65, v54, v55
  v_smfmac_f32_16x16x64_bf16 v[36:39], v[28:31], a[40:47], v3
  v_cvt_pk_bf16_f32 v78, v68, v69
  v_smfmac_f32_16x16x64_bf16 v[36:39], v[32:35], a[48:55], v3
  v_cvt_pk_bf16_f32 v79, v70, v71
  v_cvt_pk_bf16_f32 v66, v56, v57
  v_smfmac_f32_16x16x64_bf16 v[40:43], v[24:27], a[88:95], v3
  v_cvt_pk_bf16_f32 v67, v58, v59
  v_smfmac_f32_16x16x64_bf16 v[40:43], v[28:31], a[96:103], v3
  v_mfma_f32_16x16x32_bf16 v[72:75], v[64:67], v[4:7], 0
  ds_read_b128 v[52:55], v116 offset:20480
  ds_read_b128 v[56:59], v116 offset:21504
  v_smfmac_f32_16x16x64_bf16 v[40:43], v[32:35], a[104:111], v3
  v_cvt_pk_bf16_f32 v64, v36, v37
  v_smfmac_f32_16x16x64_bf16 v[44:47], v[24:27], a[144:151], v3
  v_cvt_pk_bf16_f32 v65, v38, v39
  v_smfmac_f32_16x16x64_bf16 v[44:47], v[28:31], a[152:159], v3
  v_cvt_pk_bf16_f32 v76, v72, v73
  v_smfmac_f32_16x16x64_bf16 v[44:47], v[32:35], a[160:167], v3
  v_cvt_pk_bf16_f32 v77, v74, v75
  v_cvt_pk_bf16_f32 v66, v40, v41
  v_smfmac_f32_16x16x64_bf16 v[48:51], v[24:27], a[200:207], v3
  v_cvt_pk_bf16_f32 v67, v42, v43
  v_smfmac_f32_16x16x64_bf16 v[48:51], v[28:31], a[208:215], v3
  v_mfma_f32_16x16x32_bf16 v[68:71], v[64:67], v[4:7], 0
  v_smfmac_f32_16x16x64_bf16 v[48:51], v[32:35], a[216:223], v3
  v_cvt_pk_bf16_f32 v64, v44, v45
  v_mfma_f32_16x16x32_bf16 v[84:87], v[80:83], v[76:79], 0
  v_cvt_pk_bf16_f32 v65, v46, v47
  s_waitcnt lgkmcnt(0)
  v_smfmac_f32_16x16x64_bf16 v[88:91], v[76:79], v[96:103], v3
  v_cvt_pk_bf16_f32 v60, v68, v69
  v_cvt_pk_bf16_f32 v61, v70, v71
  v_cvt_pk_bf16_f32 v66, v48, v49
  v_cvt_pk_bf16_f32 v67, v50, v51
  s_nop 1
  v_mfma_f32_16x16x32_bf16 v[72:75], v[64:67], v[4:7], 0
  v_smfmac_f32_16x16x64_bf16 v[92:95], v[76:79], v[104:111], v3
  s_nop 4
  v_cvt_pk_bf16_f32 v62, v72, v73
  v_cvt_pk_bf16_f32 v63, v74, v75
  s_nop 1
  v_mfma_f32_16x16x32_bf16 v[84:87], v[20:23], v[60:63], v[84:87]
  v_smfmac_f32_16x16x64_bf16 v[88:91], v[60:63], v[8:15], v3
  v_smfmac_f32_16x16x64_bf16 v[92:95], v[60:63], v[52:59], v3
  s_nop 1
  v_permlane32_swap_b32 v84, v86
  v_permlane32_swap_b32 v85, v87
  s_nop 0
  v_cmp_u_f32 vcc, v88, v89
  v_add_f32_dpp v84, v86, v84 row_ror:8 row_mask:0xf bank_mask:0xf
  v_add_f32_dpp v85, v87, v85 row_ror:8 row_mask:0xf bank_mask:0xf
  v_permlane32_swap_b32 v88, v92
  v_permlane32_swap_b32 v89, v93
  ds_write2_b32 v113, v84, v85 offset0:0 offset1:4
  v_permlane32_swap_b32 v90, v94
  v_permlane32_swap_b32 v91, v95
  v_add_f32 v88, v88, v92
  v_add_f32 v89, v89, v93
  v_add_f32 v90, v90, v94
  v_add_f32 v91, v91, v95
  ds_write2_b64 v112, v[88:89], v[90:91] offset0:0 offset1:128
  s_cbranch_vccnz cA_sc3_retry
cA_sc3_cont:
  s_waitcnt lgkmcnt(0)
  s_barrier
  ds_read_b128 v[36:39], v114
  ds_read_b128 v[44:47], v115
  s_waitcnt lgkmcnt(0)
  v_add_f32 v36, v36, v38
  v_add_f32 v37, v37, v39
  v_add_f32 v44, v44, v45
  v_add_f32 v46, v46, v47
  v_permlane32_swap_b32 v36, v37
  v_add_f32 v44, v44, v46
  v_add_f32 v36, v36, v37
  v_exp_f32 v49, v44
  v_exp_f32 v48, v36
  v_add_f32 v50, abs(v36), abs(v44)
  v_fma_f32 v39, v49, s37, v48
  v_cmp_ngt_f32 vcc, s56, v50
  v_cndmask_b32 v41, v48, v49, s[38:39]
  v_add_f32_dpp v39, v39, v39 quad_perm:[1,0,3,2] row_mask:0xf bank_mask:0xf
  v_cndmask_b32 v40, v49, v48, s[38:39]
  v_mov_b32_dpp v46, v41 quad_perm:[1,0,3,2] row_mask:0xf bank_mask:0xf
  v_add_f32_dpp v39, v39, v39 quad_perm:[2,3,0,1] row_mask:0xf bank_mask:0xf
  v_cndmask_b32 v42, v46, v40, s[38:39]
  v_cndmask_b32 v43, v40, v46, s[38:39]
  v_add_f32_dpp v39, v39, v39 row_half_mirror row_mask:0xf bank_mask:0xf
  s_cbranch_vccnz cA_sc3_slow
  s_nop 0
  v_add_f32_dpp v47, v39, v39 row_mirror row_mask:0xf bank_mask:0xf
  v_add_f32_dpp v39, v39, v39 row_mirror row_mask:0xf bank_mask:0xf
  s_nop 1
  v_permlane16_swap_b32 v39, v47
  v_add_f32 v39, v39, v47
  v_rcp_f32 v39, v39
  s_mov_b64 exec, s[28:29]
  v_mul_f32 v42, v42, v39
  v_mul_f32 v43, v43, v39
  v_cvt_pk_bf16_f32 v42, v42, v43
cA_sc3_pst:
  buffer_store_dword v42, v1, s[8:11], s20 offen
  s_mov_b64 exec, -1
  s_barrier
  s_add_u32 s24, s24, 28672
  s_add_u32 s35, s35, 28672
  s_xor_b32 s25, s25, 28672
  s_add_u32 m0, s25, 21504
  s_nop 0
  buffer_load_dwordx4 v2, s[8:11], s24 offen offset:0 sc1 lds
  buffer_load_dwordx4 v2, s[8:11], s24 offen offset:1024 sc1 lds
  buffer_load_dwordx4 v2, s[8:11], s24 offen offset:2048 sc1 lds
  buffer_load_dwordx4 v2, s[8:11], s24 offen offset:3072 sc1 lds
  s_add_u32 m0, s25, 25600
  s_add_u32 s22, s24, 4096
  buffer_load_dwordx4 v2, s[8:11], s22 offen offset:0 sc1 lds
  buffer_load_dwordx4 v2, s[8:11], s22 offen offset:1024 sc1 lds
  buffer_load_dwordx4 v2, s[8:11], s22 offen offset:2048 sc1 lds
  v_xor_b32 v116, 28672, v116
  v_add_u32 v117, s57, v117
  s_sub_u32 s57, 0, s57
  s_add_u32 s19, s19, 1
  s_mov_b32 s20, s21
  s_cmp_lt_u32 s19, 63
  s_cbranch_scc1 cA_sc3_loop
  s_branch cA_done
cA_sc3_slow:
  v_max_f32 v50, v36, v44
  s_nop 1
  v_max_f32_dpp v50, v50, v50 quad_perm:[1,0,3,2] row_mask:0xf bank_mask:0xf
  s_nop 1
  v_max_f32_dpp v50, v50, v50 quad_perm:[2,3,0,1] row_mask:0xf bank_mask:0xf
  s_nop 1
  v_max_f32_dpp v50, v50, v50 row_half_mirror row_mask:0xf bank_mask:0xf
  s_nop 1
  v_max_f32_dpp v50, v50, v50 row_mirror row_mask:0xf bank_mask:0xf
  v_mov_b32 v47, v50
  s_nop 1
  v_permlane16_swap_b32 v50, v47
  v_max_f32 v50, v50, v47
  v_sub_f32 v48, v36, v50
  v_sub_f32 v49, v44, v50
  v_exp_f32 v48, v48
  v_exp_f32 v49, v49
  s_add_u32 s31, s31, 0x100
  v_fma_f32 v39, v49, s37, v48
  v_cndmask_b32 v41, v48, v49, s[38:39]
  s_nop 0
  v_add_f32_dpp v39, v39, v39 quad_perm:[1,0,3,2] row_mask:0xf bank_mask:0xf
  v_cndmask_b32 v40, v49, v48, s[38:39]
  v_mov_b32_dpp v46, v41 quad_perm:[1,0,3,2] row_mask:0xf bank_mask:0xf
  v_add_f32_dpp v39, v39, v39 quad_perm:[2,3,0,1] row_mask:0xf bank_mask:0xf
  v_cndmask_b32 v42, v46, v40, s[38:39]
  v_cndmask_b32 v43, v40, v46, s[38:39]
  v_add_f32_dpp v39, v39, v39 row_half_mirror row_mask:0xf bank_mask:0xf
  s_nop 1
  v_add_f32_dpp v47, v39, v39 row_mirror row_mask:0xf bank_mask:0xf
  v_add_f32_dpp v39, v39, v39 row_mirror row_mask:0xf bank_mask:0xf
  s_nop 1
  v_permlane16_swap_b32 v39, v47
  v_add_f32 v39, v39, v47
  v_rcp_f32 v39, v39
  s_mov_b64 exec, s[28:29]
  v_mul_f32 v42, v42, v39
  v_mul_f32 v43, v43, v39
  v_cvt_pk_bf16_f32 v42, v42, v43
  v_min_u32 v42, -2, v42
  s_branch cA_sc3_pst
cA_sc3_retry:
  s_cmp_lg_u32 s62, 0
  s_cbranch_scc1 cA_sc3_cont
  s_waitcnt vmcnt(0) lgkmcnt(0)
cA_sc3_rv:
  buffer_load_dwordx4 v[8:11], v2, s[8:11], s20 offen offset:0 sc1
  buffer_load_dwordx4 v[12:15], v2, s[8:11], s20 offen offset:1024 sc1
  buffer_load_dwordx4 v[16:19], v2, s[8:11], s20 offen offset:2048 sc1
  buffer_load_dwordx4 v[20:23], v2, s[8:11], s20 offen offset:3072 sc1
  buffer_load_dwordx4 v[24:27], v2, s[8:11], s23 offen offset:0 sc1
  buffer_load_dwordx4 v[28:31], v2, s[8:11], s23 offen offset:1024 sc1
  buffer_load_dwordx4 v[32:35], v2, s[8:11], s23 offen offset:2048 sc1
  s_waitcnt vmcnt(0)
  v_max3_u32 v118, v8, v9, v10
  v_max3_u32 v118, v118, v11, v12
  v_max3_u32 v118, v118, v13, v14
  v_max3_u32 v118, v118, v15, v16
  v_max3_u32 v118, v118, v17, v18
  v_max3_u32 v118, v118, v19, v20
  v_max3_u32 v118, v118, v21, v22
  v_max3_u32 v118, v118, v23, v24
  v_max3_u32 v118, v118, v25, v26
  v_max3_u32 v118, v118, v27, v28
  v_max3_u32 v118, v118, v29, v30
  v_max3_u32 v118, v118, v31, v32
  v_max3_u32 v118, v118, v33, v34
  v_max_u32 v118, v118, v35
  v_cmp_eq_u32 vcc, -1, v118
  s_cbranch_vccz cA_sc3_rk
  s_add_u32 s30, s30, 1
  s_cmp_lt_u32 s30, 400000
  s_cbranch_scc1 cA_sc3_rv
  s_branch cA_abort
cA_sc3_rk:
  s_mov_b32 s62, 1
  v_mov_b32 v36, 0
  v_mov_b32 v37, 0
  v_mov_b32 v38, 0
  v_mov_b32 v39, 0
  v_mov_b32 v40, 0
  v_mov_b32 v41, 0
  v_mov_b32 v42, 0
  v_mov_b32 v43, 0
  v_mov_b32 v44, 0
  v_mov_b32 v45, 0
  v_mov_b32 v46, 0
  v_mov_b32 v47, 0
  v_mov_b32 v48, 0
  v_mov_b32 v49, 0
  v_mov_b32 v50, 0
  v_mov_b32 v51, 0
  v_mov_b32 v52, 0
  v_mov_b32 v53, 0
  v_mov_b32 v54, 0
  v_mov_b32 v55, 0
  v_mov_b32 v56, 0
  v_mov_b32 v57, 0
  v_mov_b32 v58, 0
  v_mov_b32 v59, 0
  v_mov_b32 v60, 0
  v_mov_b32 v61, 0
  v_mov_b32 v62, 0
  v_mov_b32 v63, 0
  v_mov_b32 v88, 0
  v_mov_b32 v89, 0
  v_mov_b32 v90, 0
  v_mov_b32 v91, 0
  v_mov_b32 v92, 0
  v_mov_b32 v93, 0
  v_mov_b32 v94, 0
  v_mov_b32 v95, 0
  v_mov_b32 v64, 0
  v_mov_b32 v65, 0
  s_add_u32 s31, s31, 1
  ds_read_b128 v[96:99], v117 offset:0
  ds_read_b128 v[100:103], v117 offset:1024
  ds_read_b128 v[104:107], v117 offset:14336
  ds_read_b128 v[108:111], v117 offset:15360
  v_smfmac_f32_16x16x64_bf16 v[36:39], v[8:11], a[0:7], v3
  v_smfmac_f32_16x16x64_bf16 v[40:43], v[8:11], a[56:63], v3
  v_smfmac_f32_16x16x64_bf16 v[44:47], v[8:11], a[112:119], v3
  v_smfmac_f32_16x16x64_bf16 v[48:51], v[8:11], a[168:175], v3
  v_smfmac_f32_16x16x64_bf16 v[52:55], v[8:11], a[224:231], v3
  v_smfmac_f32_16x16x64_bf16 v[56:59], v[8:11], v[144:151], v3
  v_smfmac_f32_16x16x64_bf16 v[60:63], v[8:11], v[200:207], v3
  v_smfmac_f32_16x16x64_bf16 v[36:39], v[12:15], a[8:15], v3
  v_smfmac_f32_16x16x64_bf16 v[40:43], v[12:15], a[64:71], v3
  v_smfmac_f32_16x16x64_bf16 v[44:47], v[12:15], a[120:127], v3
  v_smfmac_f32_16x16x64_bf16 v[48:51], v[12:15], a[176:183], v3
  v_smfmac_f32_16x16x64_bf16 v[52:55], v[12:15], a[232:239], v3
  v_smfmac_f32_16x16x64_bf16 v[56:59], v[12:15], v[152:159], v3
  v_smfmac_f32_16x16x64_bf16 v[60:63], v[12:15], v[208:215], v3
  v_smfmac_f32_16x16x64_bf16 v[36:39], v[16:19], a[16:23], v3
  v_smfmac_f32_16x16x64_bf16 v[40:43], v[16:19], a[72:79], v3
  v_smfmac_f32_16x16x64_bf16 v[44:47], v[16:19], a[128:135], v3
  v_smfmac_f32_16x16x64_bf16 v[48:51], v[16:19], a[184:191], v3
  v_smfmac_f32_16x16x64_bf16 v[52:55], v[16:19], a[240:247], v3
  v_smfmac_f32_16x16x64_bf16 v[56:59], v[16:19], v[160:167], v3
  v_smfmac_f32_16x16x64_bf16 v[60:63], v[16:19], v[216:223], v3
  v_smfmac_f32_16x16x64_bf16 v[36:39], v[20:23], a[24:31], v3
  v_smfmac_f32_16x16x64_bf16 v[40:43], v[20:23], a[80:87], v3
  v_smfmac_f32_16x16x64_bf16 v[44:47], v[20:23], a[136:143], v3
  v_smfmac_f32_16x16x64_bf16 v[48:51], v[20:23], a[192:199], v3
  v_smfmac_f32_16x16x64_bf16 v[52:55], v[20:23], a[248:255], v3
  v_smfmac_f32_16x16x64_bf16 v[56:59], v[20:23], v[168:175], v3
  v_smfmac_f32_16x16x64_bf16 v[60:63], v[20:23], v[224:231], v3
  s_branch cA_sc3_ph2
.p2align 6

cA_va0_loop:
  s_add_u32 s23, s20, 4096
  s_add_u32 s21, s20, 25600
  s_mov_b32 s30, 0
  s_cmp_lg_u32 s19, s38
  s_cbranch_scc1 cA_va0_vok
  s_branch cA_va0_voc
cA_va0_vow:
  s_nop 0
  buffer_load_dword v63, off, s[8:11], s35 sc1
  s_waitcnt vmcnt(0)
cA_va0_voc:
  v_readfirstlane_b32 s22, v63
  s_cmp_eq_u32 s22, 56
  s_cbranch_scc1 cA_va0_vod
  s_sleep 1
  s_add_u32 s30, s30, 1
  s_cmp_lt_u32 s30, 400000
  s_cbranch_scc1 cA_va0_vow
  s_branch cA_abort
cA_va0_vod:
  s_add_u32 s35, s35, 2048
  s_add_u32 s38, s19, 8
  s_and_b32 s38, s38, -8
  s_cmp_eq_u32 s19, 0
  s_cselect_b32 s38, 4, s38
cA_va0_vok:
  s_cmp_eq_u32 s19, 63
  s_cbranch_scc1 cA_done
  s_barrier
  s_add_u32 s22, s25, 0
  buffer_load_dwordx4 v[80:83], v6, s[8:11], s22 offen offset:0 sc1
  buffer_load_dwordx4 v[84:87], v6, s[8:11], s22 offen offset:1792 sc1
  s_add_u32 s22, s25, 3584
  buffer_load_dwordx4 v[88:91], v6, s[8:11], s22 offen offset:0 sc1
  buffer_load_dwordx4 v[92:95], v6, s[8:11], s22 offen offset:1792 sc1
  s_add_u32 s22, s25, 7168
  buffer_load_dwordx4 v[96:99], v6, s[8:11], s22 offen offset:0 sc1
  buffer_load_dwordx4 v[100:103], v6, s[8:11], s22 offen offset:1792 sc1
  s_add_u32 s22, s25, 10752
  buffer_load_dwordx4 v[104:107], v6, s[8:11], s22 offen offset:0 sc1
  buffer_load_dwordx4 v[108:111], v6, s[8:11], s22 offen offset:1792 sc1
  s_add_u32 s22, s25, 14336
  buffer_load_dwordx4 v[112:115], v6, s[8:11], s22 offen offset:0 sc1
  buffer_load_dwordx4 v[116:119], v6, s[8:11], s22 offen offset:1792 sc1
  s_add_u32 s22, s25, 17920
  buffer_load_dwordx4 v[120:123], v6, s[8:11], s22 offen offset:0 sc1
  buffer_load_dwordx4 v[124:127], v6, s[8:11], s22 offen offset:1792 sc1
  s_add_u32 s22, s25, 21504
  buffer_load_dwordx4 v[128:131], v6, s[8:11], s22 offen offset:0 sc1
  buffer_load_dwordx4 v[132:135], v6, s[8:11], s22 offen offset:1792 sc1
  s_add_u32 s22, s25, 25088
  buffer_load_dwordx4 v[136:139], v6, s[8:11], s22 offen offset:0 sc1
  buffer_load_dwordx4 v[140:143], v6, s[8:11], s22 offen offset:1792 sc1
  buffer_load_dword v63, off, s[8:11], s35 sc1
  s_barrier
  ds_read_b128 v[8:11], v2 offset:8192
  ds_read_b128 v[12:15], v2 offset:9216
  ds_read_b128 v[16:19], v2 offset:10240
  ds_read_b128 v[20:23], v2 offset:11264
  ds_read_b128 v[24:27], v2 offset:12288
  ds_read_b128 v[28:31], v2 offset:13312
  ds_read_b128 v[32:35], v2 offset:14336
  s_waitcnt lgkmcnt(0)
  v_smfmac_f32_16x16x64_bf16 v[36:39], v[8:11], a[0:7], v3
  v_smfmac_f32_16x16x64_bf16 v[36:39], v[12:15], a[8:15], v3
  v_smfmac_f32_16x16x64_bf16 v[36:39], v[16:19], a[16:23], v3
  v_smfmac_f32_16x16x64_bf16 v[36:39], v[20:23], a[24:31], v3
  v_smfmac_f32_16x16x64_bf16 v[36:39], v[24:27], a[32:39], v3
  v_smfmac_f32_16x16x64_bf16 v[36:39], v[28:31], a[40:47], v3
  v_smfmac_f32_16x16x64_bf16 v[36:39], v[32:35], a[48:55], v3
  v_smfmac_f32_16x16x64_bf16 v[40:43], v[8:11], a[56:63], v3
  v_smfmac_f32_16x16x64_bf16 v[40:43], v[12:15], a[64:71], v3
  v_smfmac_f32_16x16x64_bf16 v[40:43], v[16:19], a[72:79], v3
  v_smfmac_f32_16x16x64_bf16 v[40:43], v[20:23], a[80:87], v3
  v_smfmac_f32_16x16x64_bf16 v[40:43], v[24:27], a[88:95], v3
  v_smfmac_f32_16x16x64_bf16 v[40:43], v[28:31], a[96:103], v3
  v_smfmac_f32_16x16x64_bf16 v[40:43], v[32:35], a[104:111], v3
  v_smfmac_f32_16x16x64_bf16 v[44:47], v[8:11], a[112:119], v3
  v_smfmac_f32_16x16x64_bf16 v[44:47], v[12:15], a[120:127], v3
  v_smfmac_f32_16x16x64_bf16 v[44:47], v[16:19], a[128:135], v3
  v_smfmac_f32_16x16x64_bf16 v[44:47], v[20:23], a[136:143], v3
  v_permlane32_swap_b32 v36, v40
  v_smfmac_f32_16x16x64_bf16 v[44:47], v[24:27], a[144:151], v3
  v_permlane32_swap_b32 v37, v41
  v_smfmac_f32_16x16x64_bf16 v[44:47], v[28:31], a[152:159], v3
  v_permlane32_swap_b32 v38, v42
  v_smfmac_f32_16x16x64_bf16 v[44:47], v[32:35], a[160:167], v3
  v_permlane32_swap_b32 v39, v43
  v_smfmac_f32_16x16x64_bf16 v[48:51], v[8:11], a[168:175], v3
  v_add_f32 v36, v36, v40
  v_smfmac_f32_16x16x64_bf16 v[48:51], v[12:15], a[176:183], v3
  v_add_f32 v37, v37, v41
  v_smfmac_f32_16x16x64_bf16 v[48:51], v[16:19], a[184:191], v3
  v_add_f32 v38, v38, v42
  v_smfmac_f32_16x16x64_bf16 v[48:51], v[20:23], a[192:199], v3
  v_add_f32 v39, v39, v43
  v_smfmac_f32_16x16x64_bf16 v[48:51], v[24:27], a[200:207], v3
  v_cvt_pk_bf16_f32 v40, v36, v37
  v_smfmac_f32_16x16x64_bf16 v[48:51], v[28:31], a[208:215], v3
  v_cvt_pk_bf16_f32 v41, v38, v39
  v_smfmac_f32_16x16x64_bf16 v[48:51], v[32:35], a[216:223], v3
  ds_write2_b32 v60, v40, v41 offset0:0 offset1:2
  v_smfmac_f32_16x16x64_bf16 v[52:55], v[8:11], a[224:231], v3
  v_smfmac_f32_16x16x64_bf16 v[52:55], v[12:15], a[232:239], v3
  v_smfmac_f32_16x16x64_bf16 v[52:55], v[16:19], a[240:247], v3
  v_smfmac_f32_16x16x64_bf16 v[52:55], v[20:23], a[248:255], v3
  v_permlane32_swap_b32 v44, v48
  v_smfmac_f32_16x16x64_bf16 v[52:55], v[24:27], v[176:183], v3
  v_permlane32_swap_b32 v45, v49
  v_smfmac_f32_16x16x64_bf16 v[52:55], v[28:31], v[184:191], v3
  v_permlane32_swap_b32 v46, v50
  v_smfmac_f32_16x16x64_bf16 v[52:55], v[32:35], v[192:199], v3
  v_permlane32_swap_b32 v47, v51
  v_smfmac_f32_16x16x64_bf16 v[56:59], v[8:11], v[200:207], v3
  v_add_f32 v44, v44, v48
  v_smfmac_f32_16x16x64_bf16 v[56:59], v[12:15], v[208:215], v3
  v_add_f32 v45, v45, v49
  v_smfmac_f32_16x16x64_bf16 v[56:59], v[16:19], v[216:223], v3
  v_add_f32 v46, v46, v50
  v_smfmac_f32_16x16x64_bf16 v[56:59], v[20:23], v[224:231], v3
  v_add_f32 v47, v47, v51
  v_smfmac_f32_16x16x64_bf16 v[56:59], v[24:27], v[232:239], v3
  v_cvt_pk_bf16_f32 v48, v44, v45
  v_smfmac_f32_16x16x64_bf16 v[56:59], v[28:31], v[240:247], v3
  v_cvt_pk_bf16_f32 v49, v46, v47
  v_smfmac_f32_16x16x64_bf16 v[56:59], v[32:35], v[248:255], v3
  ds_write2_b32 v61, v48, v49 offset0:0 offset1:2
  s_nop 6
  v_permlane32_swap_b32 v52, v56
  v_permlane32_swap_b32 v53, v57
  v_permlane32_swap_b32 v54, v58
  v_permlane32_swap_b32 v55, v59
  v_add_f32 v52, v52, v56
  v_add_f32 v53, v53, v57
  v_add_f32 v54, v54, v58
  v_add_f32 v55, v55, v59
  v_cvt_pk_bf16_f32 v56, v52, v53
  v_cvt_pk_bf16_f32 v57, v54, v55
  ds_write2_b32 v62, v56, v57 offset0:0 offset1:2
  s_cmp_eq_u32 s19, 63
  s_cbranch_scc1 cA_va0_last
  s_add_u32 s22, s20, 9216
  s_add_u32 s34, s20, 13312
  s_add_u32 s36, s20, 7168
  s_mov_b32 s37, 0
  v_mov_b32 v156, 0
  v_mov_b32 v157, 0
  v_mov_b32 v158, 0
  v_mov_b32 v159, 0
  buffer_load_dword v164, v4, s[8:11], s20 offen sc1
  s_nop 7
  buffer_load_dword v165, v4, s[8:11], s20 offen sc1
  s_nop 7
  buffer_load_dword v166, v4, s[8:11], s20 offen sc1
  s_nop 7
  buffer_load_dword v167, v4, s[8:11], s20 offen sc1
  s_nop 7
  buffer_load_dword v168, v4, s[8:11], s20 offen sc1
cA_va0_fw_l:
  s_waitcnt vmcnt(4)
  v_cmp_eq_u32 vcc, -1, v164
  s_cbranch_vccz cA_va0_fw_d
  buffer_load_dword v164, v4, s[8:11], s20 offen sc1
  s_waitcnt vmcnt(4)
  v_cmp_eq_u32 vcc, -1, v165
  s_cbranch_vccz cA_va0_fw_d
  buffer_load_dword v165, v4, s[8:11], s20 offen sc1
  s_waitcnt vmcnt(4)
  v_cmp_eq_u32 vcc, -1, v166
  s_cbranch_vccz cA_va0_fw_d
  buffer_load_dword v166, v4, s[8:11], s20 offen sc1
  s_waitcnt vmcnt(4)
  v_cmp_eq_u32 vcc, -1, v167
  s_cbranch_vccz cA_va0_fw_d
  buffer_load_dword v167, v4, s[8:11], s20 offen sc1
  s_waitcnt vmcnt(4)
  v_cmp_eq_u32 vcc, -1, v168
  s_cbranch_vccz cA_va0_fw_d
  buffer_load_dword v168, v4, s[8:11], s20 offen sc1
  s_add_u32 s30, s30, 1
  s_cmp_lt_u32 s30, 400000
  s_cbranch_scc1 cA_va0_fw_l
  s_branch cA_abort
cA_va0_fw_d:
  s_waitcnt lgkmcnt(0)
  buffer_load_dwordx4 v[8:11], v5, s[8:11], s22 offen offset:0
  v_mov_b32 v36, 0
  v_mov_b32 v37, 0
  v_mov_b32 v38, 0
  buffer_load_dwordx4 v[12:15], v5, s[8:11], s22 offen offset:1024
  v_mov_b32 v39, 0
  v_mov_b32 v40, 0
  v_mov_b32 v41, 0
  buffer_load_dwordx4 v[16:19], v5, s[8:11], s22 offen offset:2048
  v_mov_b32 v42, 0
  v_mov_b32 v43, 0
  v_mov_b32 v44, 0
  buffer_load_dwordx4 v[20:23], v5, s[8:11], s22 offen offset:3072
  v_mov_b32 v45, 0
  v_mov_b32 v46, 0
  v_mov_b32 v47, 0
  buffer_load_dwordx4 v[24:27], v5, s[8:11], s34 offen offset:0
  v_mov_b32 v48, 0
  v_mov_b32 v49, 0
  v_mov_b32 v50, 0
  buffer_load_dwordx4 v[28:31], v5, s[8:11], s34 offen offset:1024
  v_mov_b32 v51, 0
  v_mov_b32 v52, 0
  v_mov_b32 v53, 0
  buffer_load_dwordx4 v[32:35], v5, s[8:11], s34 offen offset:2048
  v_mov_b32 v54, 0
  v_mov_b32 v55, 0
  v_mov_b32 v56, 0
  buffer_load_dwordx4 v[144:147], v5, s[8:11], s34 offen offset:3072
  v_mov_b32 v57, 0
  v_mov_b32 v58, 0
  v_mov_b32 v59, 0
  buffer_load_dwordx4 v[148:151], v2, s[8:11], s36 offen offset:0
  buffer_load_dwordx4 v[152:155], v2, s[8:11], s36 offen offset:1024
  s_barrier
  ds_read_b128 v[64:67], v2 offset:0
  ds_read_b128 v[68:71], v2 offset:1024
  ds_read_b128 v[72:75], v2 offset:2048
  ds_read_b128 v[76:79], v2 offset:3072
  s_waitcnt vmcnt(9)
  v_smfmac_f32_16x16x64_bf16 v[156:159], v[8:11], v[80:87], v0
  s_waitcnt vmcnt(8)
  v_smfmac_f32_16x16x64_bf16 v[156:159], v[12:15], v[88:95], v0
  s_waitcnt vmcnt(7)
  v_smfmac_f32_16x16x64_bf16 v[156:159], v[16:19], v[96:103], v0
  s_waitcnt vmcnt(6)
  v_smfmac_f32_16x16x64_bf16 v[156:159], v[20:23], v[104:111], v0
  s_waitcnt vmcnt(5)
  v_smfmac_f32_16x16x64_bf16 v[156:159], v[24:27], v[112:119], v0
  s_mov_b32 exec_hi, 0
  buffer_store_dword v2, v7, s[8:11], s21 offen
  s_mov_b64 exec, -1
  s_waitcnt vmcnt(5)
  v_smfmac_f32_16x16x64_bf16 v[156:159], v[28:31], v[120:127], v0
  s_waitcnt vmcnt(4)
  v_smfmac_f32_16x16x64_bf16 v[156:159], v[32:35], v[128:135], v0
  s_waitcnt vmcnt(3)
  v_smfmac_f32_16x16x64_bf16 v[156:159], v[144:147], v[136:143], v0
  s_waitcnt vmcnt(2) lgkmcnt(0)
  v_smfmac_f32_16x16x64_bf16 v[156:159], v[148:151], v[64:71], v0
  s_waitcnt vmcnt(1)
  v_smfmac_f32_16x16x64_bf16 v[156:159], v[152:155], v[72:79], v0
cA_va0_ep:
  s_nop 7
  v_add_f32 v160, v156, v157
  v_add_f32 v161, v158, v159
  v_cmp_u_f32 vcc, v160, v161
  v_mov_b32_dpp v162, v160 row_ror:8 row_mask:0xf bank_mask:0xf
  v_mov_b32_dpp v160, v161 row_ror:8 row_mask:0xf bank_mask:0xc
  s_cbranch_vccnz cA_va0_rp
  v_mov_b32_dpp v161, v162 quad_perm:[0,1,2,3] row_mask:0xf bank_mask:0x3
  v_cvt_pk_bf16_f32 v160, v160, v161
cA_va0_pc:
  buffer_store_dword v160, v1, s[8:11], s21 offen
  s_cmp_lg_u32 s19, 62
  s_cbranch_scc1 cA_va0_nl
  s_mov_b32 s22, 88519680
  buffer_store_dword v160, v1, s[8:11], s22 offen sc1
  s_mov_b64 exec, -1
  s_branch cA_done
cA_va0_nl:
  s_mov_b64 exec, -1
  s_add_u32 s25, s25, 28672
  s_add_u32 s19, s19, 1
  s_mov_b32 s20, s21
  s_branch cA_va0_loop
cA_va0_last:
  s_waitcnt lgkmcnt(0)
  s_barrier
  s_branch cA_done
cA_va0_rp:
  s_cmp_eq_u32 s37, 0
  s_cbranch_scc1 cA_va0_rv
  v_mov_b32_dpp v161, v162 quad_perm:[0,1,2,3] row_mask:0xf bank_mask:0x3
  v_cvt_pk_bf16_f32 v160, v160, v161
  v_min_u32 v160, -2, v160
  s_branch cA_va0_pc
cA_va0_rv:
  buffer_load_dwordx4 v[8:11], v5, s[8:11], s22 offen offset:0 sc1
  buffer_load_dwordx4 v[12:15], v5, s[8:11], s22 offen offset:1024 sc1
  buffer_load_dwordx4 v[16:19], v5, s[8:11], s22 offen offset:2048 sc1
  buffer_load_dwordx4 v[20:23], v5, s[8:11], s22 offen offset:3072 sc1
  buffer_load_dwordx4 v[24:27], v5, s[8:11], s34 offen offset:0 sc1
  buffer_load_dwordx4 v[28:31], v5, s[8:11], s34 offen offset:1024 sc1
  buffer_load_dwordx4 v[32:35], v5, s[8:11], s34 offen offset:2048 sc1
  buffer_load_dwordx4 v[144:147], v5, s[8:11], s34 offen offset:3072 sc1
  buffer_load_dwordx4 v[148:151], v2, s[8:11], s36 offen offset:0 sc1
  buffer_load_dwordx4 v[152:155], v2, s[8:11], s36 offen offset:1024 sc1
  s_waitcnt vmcnt(0)
  v_max3_u32 v175, v8, v9, v10
  v_max3_u32 v175, v175, v11, v12
  v_max3_u32 v175, v175, v13, v14
  v_max3_u32 v175, v175, v15, v16
  v_max3_u32 v175, v175, v17, v18
  v_max3_u32 v175, v175, v19, v20
  v_max3_u32 v175, v175, v21, v22
  v_max3_u32 v175, v175, v23, v24
  v_max3_u32 v175, v175, v25, v26
  v_max3_u32 v175, v175, v27, v28
  v_max3_u32 v175, v175, v29, v30
  v_max3_u32 v175, v175, v31, v32
  v_max3_u32 v175, v175, v33, v34
  v_max3_u32 v175, v175, v35, v144
  v_max3_u32 v175, v175, v145, v146
  v_max3_u32 v175, v175, v147, v148
  v_max3_u32 v175, v175, v149, v150
  v_max3_u32 v175, v175, v151, v152
  v_max3_u32 v175, v175, v153, v154
  v_max_u32 v175, v175, v155
  v_cmp_eq_u32 vcc, -1, v175
  s_cbranch_vccz cA_va0_rk
  s_add_u32 s30, s30, 1
  s_cmp_lt_u32 s30, 400000
  s_cbranch_scc1 cA_va0_rv
  s_branch cA_abort
cA_va0_rk:
  s_mov_b32 s37, 1
  s_add_u32 s31, s31, 0x10000
  v_mov_b32 v156, 0
  v_mov_b32 v157, 0
  v_mov_b32 v158, 0
  v_mov_b32 v159, 0
  s_nop 1
  v_smfmac_f32_16x16x64_bf16 v[156:159], v[8:11], v[80:87], v0
  v_smfmac_f32_16x16x64_bf16 v[156:159], v[12:15], v[88:95], v0
  v_smfmac_f32_16x16x64_bf16 v[156:159], v[16:19], v[96:103], v0
  v_smfmac_f32_16x16x64_bf16 v[156:159], v[20:23], v[104:111], v0
  v_smfmac_f32_16x16x64_bf16 v[156:159], v[24:27], v[112:119], v0
  v_smfmac_f32_16x16x64_bf16 v[156:159], v[28:31], v[120:127], v0
  v_smfmac_f32_16x16x64_bf16 v[156:159], v[32:35], v[128:135], v0
  v_smfmac_f32_16x16x64_bf16 v[156:159], v[144:147], v[136:143], v0
  v_smfmac_f32_16x16x64_bf16 v[156:159], v[148:151], v[64:71], v0
  v_smfmac_f32_16x16x64_bf16 v[156:159], v[152:155], v[72:79], v0
  s_nop 7
  s_branch cA_va0_ep
.p2align 6

cA_va1_loop:
  s_add_u32 s23, s20, 4096
  s_add_u32 s21, s20, 25600
  s_mov_b32 s30, 0
  s_cmp_lg_u32 s19, s38
  s_cbranch_scc1 cA_va1_vok
  s_branch cA_va1_voc
cA_va1_vow:
  buffer_load_dword v63, off, s[8:11], s35 sc1
  s_waitcnt vmcnt(0)
cA_va1_voc:
  v_readfirstlane_b32 s22, v63
  s_cmp_eq_u32 s22, 56
  s_cbranch_scc1 cA_va1_vod
  s_sleep 1
  s_add_u32 s30, s30, 1
  s_cmp_lt_u32 s30, 400000
  s_cbranch_scc1 cA_va1_vow
  s_branch cA_abort
cA_va1_vod:
  s_add_u32 s35, s35, 2048
  s_add_u32 s38, s19, 8
  s_and_b32 s38, s38, -8
  s_cmp_eq_u32 s19, 0
  s_cselect_b32 s38, 4, s38
cA_va1_vok:
  s_cmp_eq_u32 s19, 63
  s_cbranch_scc1 cA_done
  s_barrier
  s_add_u32 s22, s25, 0
  buffer_load_dwordx4 v[80:83], v6, s[8:11], s22 offen offset:0 sc1
  buffer_load_dwordx4 v[84:87], v6, s[8:11], s22 offen offset:1792 sc1
  s_add_u32 s22, s25, 3584
  buffer_load_dwordx4 v[88:91], v6, s[8:11], s22 offen offset:0 sc1
  buffer_load_dwordx4 v[92:95], v6, s[8:11], s22 offen offset:1792 sc1
  s_add_u32 s22, s25, 7168
  buffer_load_dwordx4 v[96:99], v6, s[8:11], s22 offen offset:0 sc1
  buffer_load_dwordx4 v[100:103], v6, s[8:11], s22 offen offset:1792 sc1
  s_add_u32 s22, s25, 10752
  buffer_load_dwordx4 v[104:107], v6, s[8:11], s22 offen offset:0 sc1
  buffer_load_dwordx4 v[108:111], v6, s[8:11], s22 offen offset:1792 sc1
  s_add_u32 s22, s25, 14336
  buffer_load_dwordx4 v[112:115], v6, s[8:11], s22 offen offset:0 sc1
  buffer_load_dwordx4 v[116:119], v6, s[8:11], s22 offen offset:1792 sc1
  s_add_u32 s22, s25, 17920
  buffer_load_dwordx4 v[120:123], v6, s[8:11], s22 offen offset:0 sc1
  buffer_load_dwordx4 v[124:127], v6, s[8:11], s22 offen offset:1792 sc1
  s_add_u32 s22, s25, 21504
  buffer_load_dwordx4 v[128:131], v6, s[8:11], s22 offen offset:0 sc1
  buffer_load_dwordx4 v[132:135], v6, s[8:11], s22 offen offset:1792 sc1
  s_add_u32 s22, s25, 25088
  buffer_load_dwordx4 v[136:139], v6, s[8:11], s22 offen offset:0 sc1
  buffer_load_dwordx4 v[140:143], v6, s[8:11], s22 offen offset:1792 sc1
  buffer_load_dword v63, off, s[8:11], s35 sc1
  s_barrier
  ds_read_b128 v[8:11], v2 offset:8192
  ds_read_b128 v[12:15], v2 offset:9216
  ds_read_b128 v[16:19], v2 offset:10240
  ds_read_b128 v[20:23], v2 offset:11264
  ds_read_b128 v[24:27], v2 offset:12288
  ds_read_b128 v[28:31], v2 offset:13312
  ds_read_b128 v[32:35], v2 offset:14336
  s_waitcnt lgkmcnt(0)
  v_smfmac_f32_16x16x64_bf16 v[36:39], v[8:11], a[0:7], v3
  v_smfmac_f32_16x16x64_bf16 v[36:39], v[12:15], a[8:15], v3
  v_smfmac_f32_16x16x64_bf16 v[36:39], v[16:19], a[16:23], v3
  v_smfmac_f32_16x16x64_bf16 v[36:39], v[20:23], a[24:31], v3
  v_smfmac_f32_16x16x64_bf16 v[36:39], v[24:27], a[32:39], v3
  v_smfmac_f32_16x16x64_bf16 v[36:39], v[28:31], a[40:47], v3
  v_smfmac_f32_16x16x64_bf16 v[36:39], v[32:35], a[48:55], v3
  v_smfmac_f32_16x16x64_bf16 v[40:43], v[8:11], a[56:63], v3
  v_smfmac_f32_16x16x64_bf16 v[40:43], v[12:15], a[64:71], v3
  v_smfmac_f32_16x16x64_bf16 v[40:43], v[16:19], a[72:79], v3
  v_smfmac_f32_16x16x64_bf16 v[40:43], v[20:23], a[80:87], v3
  v_smfmac_f32_16x16x64_bf16 v[40:43], v[24:27], a[88:95], v3
  v_smfmac_f32_16x16x64_bf16 v[40:43], v[28:31], a[96:103], v3
  v_smfmac_f32_16x16x64_bf16 v[40:43], v[32:35], a[104:111], v3
  v_smfmac_f32_16x16x64_bf16 v[44:47], v[8:11], a[112:119], v3
  v_smfmac_f32_16x16x64_bf16 v[44:47], v[12:15], a[120:127], v3
  v_smfmac_f32_16x16x64_bf16 v[44:47], v[16:19], a[128:135], v3
  v_smfmac_f32_16x16x64_bf16 v[44:47], v[20:23], a[136:143], v3
  v_permlane32_swap_b32 v36, v40
  v_smfmac_f32_16x16x64_bf16 v[44:47], v[24:27], a[144:151], v3
  v_permlane32_swap_b32 v37, v41
  v_smfmac_f32_16x16x64_bf16 v[44:47], v[28:31], a[152:159], v3
  v_permlane32_swap_b32 v38, v42
  v_smfmac_f32_16x16x64_bf16 v[44:47], v[32:35], a[160:167], v3
  v_permlane32_swap_b32 v39, v43
  v_smfmac_f32_16x16x64_bf16 v[48:51], v[8:11], a[168:175], v3
  v_add_f32 v36, v36, v40
  v_smfmac_f32_16x16x64_bf16 v[48:51], v[12:15], a[176:183], v3
  v_add_f32 v37, v37, v41
  v_smfmac_f32_16x16x64_bf16 v[48:51], v[16:19], a[184:191], v3
  v_add_f32 v38, v38, v42
  v_smfmac_f32_16x16x64_bf16 v[48:51], v[20:23], a[192:199], v3
  v_add_f32 v39, v39, v43
  v_smfmac_f32_16x16x64_bf16 v[48:51], v[24:27], a[200:207], v3
  v_cvt_pk_bf16_f32 v40, v36, v37
  v_smfmac_f32_16x16x64_bf16 v[48:51], v[28:31], a[208:215], v3
  v_cvt_pk_bf16_f32 v41, v38, v39
  v_smfmac_f32_16x16x64_bf16 v[48:51], v[32:35], a[216:223], v3
  ds_write2_b32 v60, v40, v41 offset0:0 offset1:2
  v_smfmac_f32_16x16x64_bf16 v[52:55], v[8:11], a[224:231], v3
  v_smfmac_f32_16x16x64_bf16 v[52:55], v[12:15], a[232:239], v3
  v_smfmac_f32_16x16x64_bf16 v[52:55], v[16:19], a[240:247], v3
  v_smfmac_f32_16x16x64_bf16 v[52:55], v[20:23], a[248:255], v3
  v_permlane32_swap_b32 v44, v48
  v_smfmac_f32_16x16x64_bf16 v[52:55], v[24:27], v[176:183], v3
  v_permlane32_swap_b32 v45, v49
  v_smfmac_f32_16x16x64_bf16 v[52:55], v[28:31], v[184:191], v3
  v_permlane32_swap_b32 v46, v50
  v_smfmac_f32_16x16x64_bf16 v[52:55], v[32:35], v[192:199], v3
  v_permlane32_swap_b32 v47, v51
  v_smfmac_f32_16x16x64_bf16 v[56:59], v[8:11], v[200:207], v3
  v_add_f32 v44, v44, v48
  v_smfmac_f32_16x16x64_bf16 v[56:59], v[12:15], v[208:215], v3
  v_add_f32 v45, v45, v49
  v_smfmac_f32_16x16x64_bf16 v[56:59], v[16:19], v[216:223], v3
  v_add_f32 v46, v46, v50
  v_smfmac_f32_16x16x64_bf16 v[56:59], v[20:23], v[224:231], v3
  v_add_f32 v47, v47, v51
  v_smfmac_f32_16x16x64_bf16 v[56:59], v[24:27], v[232:239], v3
  v_cvt_pk_bf16_f32 v48, v44, v45
  v_smfmac_f32_16x16x64_bf16 v[56:59], v[28:31], v[240:247], v3
  v_cvt_pk_bf16_f32 v49, v46, v47
  v_smfmac_f32_16x16x64_bf16 v[56:59], v[32:35], v[248:255], v3
  ds_write2_b32 v61, v48, v49 offset0:0 offset1:2
  s_nop 6
  v_permlane32_swap_b32 v52, v56
  v_permlane32_swap_b32 v53, v57
  v_permlane32_swap_b32 v54, v58
  v_permlane32_swap_b32 v55, v59
  v_add_f32 v52, v52, v56
  v_add_f32 v53, v53, v57
  v_add_f32 v54, v54, v58
  v_add_f32 v55, v55, v59
  v_cvt_pk_bf16_f32 v56, v52, v53
  v_cvt_pk_bf16_f32 v57, v54, v55
  ds_write2_b32 v62, v56, v57 offset0:0 offset1:2
  s_cmp_eq_u32 s19, 63
  s_cbranch_scc1 cA_va1_last
  s_add_u32 s22, s20, 9216
  s_add_u32 s34, s20, 13312
  s_add_u32 s36, s20, 7168
  s_mov_b32 s37, 0
  v_mov_b32 v156, 0
  v_mov_b32 v157, 0
  v_mov_b32 v158, 0
  v_mov_b32 v159, 0
  buffer_load_dword v164, v4, s[8:11], s20 offen sc1
  s_nop 7
  buffer_load_dword v165, v4, s[8:11], s20 offen sc1
  s_nop 7
  buffer_load_dword v166, v4, s[8:11], s20 offen sc1
  s_nop 7
  buffer_load_dword v167, v4, s[8:11], s20 offen sc1
  s_nop 7
  buffer_load_dword v168, v4, s[8:11], s20 offen sc1
cA_va1_fw_l:
  s_waitcnt vmcnt(4)
  v_cmp_eq_u32 vcc, -1, v164
  s_cbranch_vccz cA_va1_fw_d
  buffer_load_dword v164, v4, s[8:11], s20 offen sc1
  s_waitcnt vmcnt(4)
  v_cmp_eq_u32 vcc, -1, v165
  s_cbranch_vccz cA_va1_fw_d
  buffer_load_dword v165, v4, s[8:11], s20 offen sc1
  s_waitcnt vmcnt(4)
  v_cmp_eq_u32 vcc, -1, v166
  s_cbranch_vccz cA_va1_fw_d
  buffer_load_dword v166, v4, s[8:11], s20 offen sc1
  s_waitcnt vmcnt(4)
  v_cmp_eq_u32 vcc, -1, v167
  s_cbranch_vccz cA_va1_fw_d
  buffer_load_dword v167, v4, s[8:11], s20 offen sc1
  s_waitcnt vmcnt(4)
  v_cmp_eq_u32 vcc, -1, v168
  s_cbranch_vccz cA_va1_fw_d
  buffer_load_dword v168, v4, s[8:11], s20 offen sc1
  s_add_u32 s30, s30, 1
  s_cmp_lt_u32 s30, 400000
  s_cbranch_scc1 cA_va1_fw_l
  s_branch cA_abort
cA_va1_fw_d:
  s_waitcnt lgkmcnt(0)
  buffer_load_dwordx4 v[8:11], v5, s[8:11], s22 offen offset:0
  v_mov_b32 v36, 0
  v_mov_b32 v37, 0
  v_mov_b32 v38, 0
  buffer_load_dwordx4 v[12:15], v5, s[8:11], s22 offen offset:1024
  v_mov_b32 v39, 0
  v_mov_b32 v40, 0
  v_mov_b32 v41, 0
  buffer_load_dwordx4 v[16:19], v5, s[8:11], s22 offen offset:2048
  v_mov_b32 v42, 0
  v_mov_b32 v43, 0
  v_mov_b32 v44, 0
  buffer_load_dwordx4 v[20:23], v5, s[8:11], s22 offen offset:3072
  v_mov_b32 v45, 0
  v_mov_b32 v46, 0
  v_mov_b32 v47, 0
  buffer_load_dwordx4 v[24:27], v5, s[8:11], s34 offen offset:0
  v_mov_b32 v48, 0
  v_mov_b32 v49, 0
  v_mov_b32 v50, 0
  buffer_load_dwordx4 v[28:31], v5, s[8:11], s34 offen offset:1024
  v_mov_b32 v51, 0
  v_mov_b32 v52, 0
  v_mov_b32 v53, 0
  buffer_load_dwordx4 v[32:35], v5, s[8:11], s34 offen offset:2048
  v_mov_b32 v54, 0
  v_mov_b32 v55, 0
  v_mov_b32 v56, 0
  buffer_load_dwordx4 v[144:147], v5, s[8:11], s34 offen offset:3072
  v_mov_b32 v57, 0
  v_mov_b32 v58, 0
  v_mov_b32 v59, 0
  buffer_load_dwordx4 v[148:151], v2, s[8:11], s36 offen offset:0
  buffer_load_dwordx4 v[152:155], v2, s[8:11], s36 offen offset:1024
  s_barrier
  ds_read_b128 v[64:67], v2 offset:4096
  ds_read_b128 v[68:71], v2 offset:5120
  ds_read_b128 v[72:75], v2 offset:6144
  ds_read_b128 v[76:79], v2 offset:7168
  s_waitcnt vmcnt(9)
  v_smfmac_f32_16x16x64_bf16 v[156:159], v[8:11], v[80:87], v0
  s_waitcnt vmcnt(8)
  v_smfmac_f32_16x16x64_bf16 v[156:159], v[12:15], v[88:95], v0
  s_waitcnt vmcnt(7)
  v_smfmac_f32_16x16x64_bf16 v[156:159], v[16:19], v[96:103], v0
  s_waitcnt vmcnt(6)
  v_smfmac_f32_16x16x64_bf16 v[156:159], v[20:23], v[104:111], v0
  s_waitcnt vmcnt(5)
  v_smfmac_f32_16x16x64_bf16 v[156:159], v[24:27], v[112:119], v0
  s_mov_b32 exec_hi, 0
  buffer_store_dword v2, v7, s[8:11], s21 offen
  s_mov_b64 exec, -1
  s_waitcnt vmcnt(5)
  v_smfmac_f32_16x16x64_bf16 v[156:159], v[28:31], v[120:127], v0
  s_waitcnt vmcnt(4)
  v_smfmac_f32_16x16x64_bf16 v[156:159], v[32:35], v[128:135], v0
  s_waitcnt vmcnt(3)
  v_smfmac_f32_16x16x64_bf16 v[156:159], v[144:147], v[136:143], v0
  s_waitcnt vmcnt(2) lgkmcnt(0)
  v_smfmac_f32_16x16x64_bf16 v[156:159], v[148:151], v[64:71], v0
  s_waitcnt vmcnt(1)
  v_smfmac_f32_16x16x64_bf16 v[156:159], v[152:155], v[72:79], v0
cA_va1_ep:
  s_nop 7
  v_add_f32 v160, v156, v157
  v_add_f32 v161, v158, v159
  v_cmp_u_f32 vcc, v160, v161
  v_mov_b32_dpp v162, v160 row_ror:8 row_mask:0xf bank_mask:0xf
  v_mov_b32_dpp v160, v161 row_ror:8 row_mask:0xf bank_mask:0xc
  s_cbranch_vccnz cA_va1_rp
  v_mov_b32_dpp v161, v162 quad_perm:[0,1,2,3] row_mask:0xf bank_mask:0x3
  v_cvt_pk_bf16_f32 v160, v160, v161
cA_va1_pc:
  s_mov_b64 exec, s[26:27]
  buffer_store_dword v160, v1, s[8:11], s21 offen
  s_cmp_lg_u32 s19, 62
  s_cbranch_scc1 cA_va1_nl
  s_mov_b32 s22, 88519680
  buffer_store_dword v160, v1, s[8:11], s22 offen sc1
  s_mov_b64 exec, -1
  s_branch cA_done
cA_va1_nl:
  s_mov_b64 exec, -1
  s_add_u32 s25, s25, 28672
  s_add_u32 s19, s19, 1
  s_mov_b32 s20, s21
  s_branch cA_va1_loop
cA_va1_last:
  s_waitcnt lgkmcnt(0)
  s_barrier
  s_branch cA_done
cA_va1_rp:
  s_cmp_eq_u32 s37, 0
  s_cbranch_scc1 cA_va1_rv
  v_mov_b32_dpp v161, v162 quad_perm:[0,1,2,3] row_mask:0xf bank_mask:0x3
  v_cvt_pk_bf16_f32 v160, v160, v161
  v_min_u32 v160, -2, v160
  s_branch cA_va1_pc
cA_va1_rv:
  buffer_load_dwordx4 v[8:11], v5, s[8:11], s22 offen offset:0 sc1
  buffer_load_dwordx4 v[12:15], v5, s[8:11], s22 offen offset:1024 sc1
  buffer_load_dwordx4 v[16:19], v5, s[8:11], s22 offen offset:2048 sc1
  buffer_load_dwordx4 v[20:23], v5, s[8:11], s22 offen offset:3072 sc1
  buffer_load_dwordx4 v[24:27], v5, s[8:11], s34 offen offset:0 sc1
  buffer_load_dwordx4 v[28:31], v5, s[8:11], s34 offen offset:1024 sc1
  buffer_load_dwordx4 v[32:35], v5, s[8:11], s34 offen offset:2048 sc1
  buffer_load_dwordx4 v[144:147], v5, s[8:11], s34 offen offset:3072 sc1
  buffer_load_dwordx4 v[148:151], v2, s[8:11], s36 offen offset:0 sc1
  buffer_load_dwordx4 v[152:155], v2, s[8:11], s36 offen offset:1024 sc1
  s_waitcnt vmcnt(0)
  v_max3_u32 v175, v8, v9, v10
  v_max3_u32 v175, v175, v11, v12
  v_max3_u32 v175, v175, v13, v14
  v_max3_u32 v175, v175, v15, v16
  v_max3_u32 v175, v175, v17, v18
  v_max3_u32 v175, v175, v19, v20
  v_max3_u32 v175, v175, v21, v22
  v_max3_u32 v175, v175, v23, v24
  v_max3_u32 v175, v175, v25, v26
  v_max3_u32 v175, v175, v27, v28
  v_max3_u32 v175, v175, v29, v30
  v_max3_u32 v175, v175, v31, v32
  v_max3_u32 v175, v175, v33, v34
  v_max3_u32 v175, v175, v35, v144
  v_max3_u32 v175, v175, v145, v146
  v_max3_u32 v175, v175, v147, v148
  v_max3_u32 v175, v175, v149, v150
  v_max3_u32 v175, v175, v151, v152
  v_max3_u32 v175, v175, v153, v154
  v_max_u32 v175, v175, v155
  v_cmp_eq_u32 vcc, -1, v175
  s_cbranch_vccz cA_va1_rk
  s_add_u32 s30, s30, 1
  s_cmp_lt_u32 s30, 400000
  s_cbranch_scc1 cA_va1_rv
  s_branch cA_abort
cA_va1_rk:
  s_mov_b32 s37, 1
  s_add_u32 s31, s31, 0x10000
  v_mov_b32 v156, 0
  v_mov_b32 v157, 0
  v_mov_b32 v158, 0
  v_mov_b32 v159, 0
  s_nop 1
  v_smfmac_f32_16x16x64_bf16 v[156:159], v[8:11], v[80:87], v0
  v_smfmac_f32_16x16x64_bf16 v[156:159], v[12:15], v[88:95], v0
  v_smfmac_f32_16x16x64_bf16 v[156:159], v[16:19], v[96:103], v0
  v_smfmac_f32_16x16x64_bf16 v[156:159], v[20:23], v[104:111], v0
  v_smfmac_f32_16x16x64_bf16 v[156:159], v[24:27], v[112:119], v0
  v_smfmac_f32_16x16x64_bf16 v[156:159], v[28:31], v[120:127], v0
  v_smfmac_f32_16x16x64_bf16 v[156:159], v[32:35], v[128:135], v0
  v_smfmac_f32_16x16x64_bf16 v[156:159], v[144:147], v[136:143], v0
  v_smfmac_f32_16x16x64_bf16 v[156:159], v[148:151], v[64:71], v0
  v_smfmac_f32_16x16x64_bf16 v[156:159], v[152:155], v[72:79], v0
  s_nop 7
  s_branch cA_va1_ep
.p2align 6

cA_va2_loop:
  s_add_u32 s23, s20, 4096
  s_add_u32 s21, s20, 25600
  v_mov_b32 v36, 0
  v_mov_b32 v37, 0
  v_mov_b32 v38, 0
  v_mov_b32 v39, 0
  v_mov_b32 v40, 0
  v_mov_b32 v41, 0
  v_mov_b32 v42, 0
  v_mov_b32 v43, 0
  v_mov_b32 v44, 0
  v_mov_b32 v45, 0
  v_mov_b32 v46, 0
  v_mov_b32 v47, 0
  v_mov_b32 v48, 0
  v_mov_b32 v49, 0
  v_mov_b32 v50, 0
  v_mov_b32 v51, 0
  v_mov_b32 v52, 0
  v_mov_b32 v53, 0
  v_mov_b32 v54, 0
  v_mov_b32 v55, 0
  v_mov_b32 v56, 0
  v_mov_b32 v57, 0
  v_mov_b32 v58, 0
  v_mov_b32 v59, 0
  v_mov_b32 v60, 0
  v_mov_b32 v61, 0
  v_mov_b32 v62, 0
  v_mov_b32 v63, 0
  v_mov_b32 v64, 0
  v_mov_b32 v65, 0
  v_mov_b32 v66, 0
  v_mov_b32 v67, 0
  s_mov_b32 s30, 0
  buffer_load_dword v76, v119, s[8:11], s20 offen sc1
  buffer_load_dword v77, v119, s[8:11], s20 offen sc1
  buffer_load_dword v78, v119, s[8:11], s20 offen sc1
cA_va2_fp_l:
  s_waitcnt vmcnt(2)
  v_cmp_eq_u32 vcc, -1, v76
  s_cbranch_vccz cA_va2_fp_d
  buffer_load_dword v76, v119, s[8:11], s20 offen sc1
  s_waitcnt vmcnt(2)
  v_cmp_eq_u32 vcc, -1, v77
  s_cbranch_vccz cA_va2_fp_d
  buffer_load_dword v77, v119, s[8:11], s20 offen sc1
  s_waitcnt vmcnt(2)
  v_cmp_eq_u32 vcc, -1, v78
  s_cbranch_vccz cA_va2_fp_d
  buffer_load_dword v78, v119, s[8:11], s20 offen sc1
  s_add_u32 s30, s30, 1
  s_cmp_lt_u32 s30, 400000
  s_cbranch_scc1 cA_va2_fp_l
  s_branch cA_abort
cA_va2_fp_d:
  buffer_load_dwordx4 v[8:11], v2, s[8:11], s20 offen offset:0 sc1
  buffer_load_dwordx4 v[12:15], v2, s[8:11], s20 offen offset:1024 sc1
  buffer_load_dwordx4 v[16:19], v2, s[8:11], s20 offen offset:2048 sc1
  buffer_load_dwordx4 v[20:23], v2, s[8:11], s20 offen offset:3072 sc1
  s_barrier
cA_va2_ld:
  s_waitcnt vmcnt(0)
  v_max3_u32 v84, v8, v9, v10
  v_max3_u32 v84, v84, v11, v12
  v_max3_u32 v84, v84, v13, v14
  v_max3_u32 v84, v84, v15, v16
  v_max3_u32 v84, v84, v17, v18
  v_max3_u32 v84, v84, v19, v20
  v_max3_u32 v84, v84, v21, v22
  v_max_u32 v84, v84, v23
  v_cmp_eq_u32 vcc, -1, v84
  ds_write_b128 v2, v[8:11] offset:8192
  ds_write_b128 v2, v[12:15] offset:9216
  ds_write_b128 v2, v[16:19] offset:10240
  ds_write_b128 v2, v[20:23] offset:11264
  s_cbranch_vccnz cA_va2_retry
  s_waitcnt lgkmcnt(0)
  s_barrier
  ds_read_b128 v[24:27], v2 offset:12288
  ds_read_b128 v[28:31], v2 offset:13312
  ds_read_b128 v[32:35], v2 offset:14336
  ds_read_b128 v[92:95], v0
  s_waitcnt lgkmcnt(0)
  s_mov_b64 exec, s[26:27]
  buffer_store_dwordx4 v[92:95], v2, s[8:11], s36 offen sc1
  s_mov_b64 exec, -1
  s_add_u32 s36, s36, 7168
  s_cmp_eq_u32 s19, 63
  s_cbranch_scc1 cA_done
  ds_read_b128 v[76:79], v1 offset:0
  ds_read_b128 v[80:83], v1 offset:1024
  ds_read_b128 v[84:87], v1 offset:2048
  ds_read_b128 v[88:91], v1 offset:3072
  ds_read_b128 v[92:95], v1 offset:4096
  ds_read_b128 v[96:99], v1 offset:5120
  v_smfmac_f32_16x16x64_bf16 v[60:63], v[8:11], v[200:207], v3
  v_smfmac_f32_16x16x64_bf16 v[60:63], v[12:15], v[208:215], v3
  s_waitcnt lgkmcnt(4)
  v_smfmac_f32_16x16x64_bf16 v[64:67], v[8:11], v[76:83], v3
  ds_read_b128 v[76:79], v1 offset:6144
  ds_read_b128 v[80:83], v1 offset:7168
  v_smfmac_f32_16x16x64_bf16 v[60:63], v[16:19], v[216:223], v3
  v_smfmac_f32_16x16x64_bf16 v[60:63], v[20:23], v[224:231], v3
  s_waitcnt lgkmcnt(4)
  v_smfmac_f32_16x16x64_bf16 v[64:67], v[12:15], v[84:91], v3
  ds_read_b128 v[84:87], v1 offset:8192
  ds_read_b128 v[88:91], v1 offset:9216
  v_smfmac_f32_16x16x64_bf16 v[60:63], v[24:27], v[232:239], v3
  v_smfmac_f32_16x16x64_bf16 v[60:63], v[28:31], v[240:247], v3
  s_waitcnt lgkmcnt(4)
  v_smfmac_f32_16x16x64_bf16 v[64:67], v[16:19], v[92:99], v3
  ds_read_b128 v[92:95], v1 offset:10240
  ds_read_b128 v[96:99], v1 offset:11264
  v_smfmac_f32_16x16x64_bf16 v[60:63], v[32:35], v[248:255], v3
  v_smfmac_f32_16x16x64_bf16 v[36:39], v[8:11], a[0:7], v3
  s_waitcnt lgkmcnt(4)
  v_smfmac_f32_16x16x64_bf16 v[64:67], v[20:23], v[76:83], v3
  ds_read_b128 v[76:79], v1 offset:12288
  ds_read_b128 v[80:83], v1 offset:13312
  v_smfmac_f32_16x16x64_bf16 v[36:39], v[12:15], a[8:15], v3
  v_smfmac_f32_16x16x64_bf16 v[36:39], v[16:19], a[16:23], v3
  s_waitcnt lgkmcnt(4)
  v_smfmac_f32_16x16x64_bf16 v[64:67], v[24:27], v[84:91], v3
  v_smfmac_f32_16x16x64_bf16 v[36:39], v[20:23], a[24:31], v3
  v_smfmac_f32_16x16x64_bf16 v[36:39], v[24:27], a[32:39], v3
  s_waitcnt lgkmcnt(2)
  v_smfmac_f32_16x16x64_bf16 v[64:67], v[28:31], v[92:99], v3
  v_smfmac_f32_16x16x64_bf16 v[36:39], v[28:31], a[40:47], v3
  v_smfmac_f32_16x16x64_bf16 v[36:39], v[32:35], a[48:55], v3
  s_waitcnt lgkmcnt(0)
  v_smfmac_f32_16x16x64_bf16 v[64:67], v[32:35], v[76:83], v3
  v_smfmac_f32_16x16x64_bf16 v[40:43], v[8:11], a[56:63], v3
  v_smfmac_f32_16x16x64_bf16 v[40:43], v[12:15], a[64:71], v3
  v_smfmac_f32_16x16x64_bf16 v[40:43], v[16:19], a[72:79], v3
  v_smfmac_f32_16x16x64_bf16 v[40:43], v[20:23], a[80:87], v3
  v_permlane32_swap_b32 v60, v64
  v_smfmac_f32_16x16x64_bf16 v[40:43], v[24:27], a[88:95], v3
  v_permlane32_swap_b32 v61, v65
  v_smfmac_f32_16x16x64_bf16 v[40:43], v[28:31], a[96:103], v3
  v_permlane32_swap_b32 v62, v66
  v_smfmac_f32_16x16x64_bf16 v[40:43], v[32:35], a[104:111], v3
  v_permlane32_swap_b32 v63, v67
  v_smfmac_f32_16x16x64_bf16 v[44:47], v[8:11], a[112:119], v3
  v_smfmac_f32_16x16x64_bf16 v[44:47], v[12:15], a[120:127], v3
  v_smfmac_f32_16x16x64_bf16 v[44:47], v[16:19], a[128:135], v3
  v_smfmac_f32_16x16x64_bf16 v[44:47], v[20:23], a[136:143], v3
  v_add_f32 v60, v60, v64
  v_add_f32 v61, v61, v65
  v_smfmac_f32_16x16x64_bf16 v[44:47], v[24:27], a[144:151], v3
  v_add_f32 v62, v62, v66
  v_add_f32 v63, v63, v67
  v_smfmac_f32_16x16x64_bf16 v[44:47], v[28:31], a[152:159], v3
  v_cvt_pk_bf16_f32 v64, v60, v61
  v_cvt_pk_bf16_f32 v65, v62, v63
  v_smfmac_f32_16x16x64_bf16 v[44:47], v[32:35], a[160:167], v3
  ds_write2_b32 v115, v64, v65 offset0:0 offset1:2
  v_smfmac_f32_16x16x64_bf16 v[48:51], v[8:11], a[168:175], v3
  v_permlane32_swap_b32 v36, v40
  v_smfmac_f32_16x16x64_bf16 v[48:51], v[12:15], a[176:183], v3
  v_permlane32_swap_b32 v37, v41
  v_smfmac_f32_16x16x64_bf16 v[48:51], v[16:19], a[184:191], v3
  v_permlane32_swap_b32 v38, v42
  v_smfmac_f32_16x16x64_bf16 v[48:51], v[20:23], a[192:199], v3
  v_permlane32_swap_b32 v39, v43
  v_smfmac_f32_16x16x64_bf16 v[48:51], v[24:27], a[200:207], v3
  v_add_f32 v36, v36, v40
  v_smfmac_f32_16x16x64_bf16 v[48:51], v[28:31], a[208:215], v3
  v_add_f32 v37, v37, v41
  v_smfmac_f32_16x16x64_bf16 v[48:51], v[32:35], a[216:223], v3
  v_add_f32 v38, v38, v42
  v_smfmac_f32_16x16x64_bf16 v[52:55], v[8:11], a[224:231], v3
  v_smfmac_f32_16x16x64_bf16 v[52:55], v[12:15], a[232:239], v3
  v_smfmac_f32_16x16x64_bf16 v[52:55], v[16:19], a[240:247], v3
  v_smfmac_f32_16x16x64_bf16 v[52:55], v[20:23], a[248:255], v3
  v_add_f32 v39, v39, v43
  v_cvt_pk_bf16_f32 v40, v36, v37
  v_smfmac_f32_16x16x64_bf16 v[52:55], v[24:27], v[120:127], v3
  v_cvt_pk_bf16_f32 v41, v38, v39
  v_smfmac_f32_16x16x64_bf16 v[52:55], v[28:31], v[128:135], v3
  ds_write2_b32 v112, v40, v41 offset0:0 offset1:2
  v_smfmac_f32_16x16x64_bf16 v[52:55], v[32:35], v[136:143], v3
  v_permlane32_swap_b32 v44, v48
  v_smfmac_f32_16x16x64_bf16 v[56:59], v[8:11], v[144:151], v3
  v_permlane32_swap_b32 v45, v49
  v_smfmac_f32_16x16x64_bf16 v[56:59], v[12:15], v[152:159], v3
  v_permlane32_swap_b32 v46, v50
  v_smfmac_f32_16x16x64_bf16 v[56:59], v[16:19], v[160:167], v3
  v_permlane32_swap_b32 v47, v51
  v_smfmac_f32_16x16x64_bf16 v[56:59], v[20:23], v[168:175], v3
  v_add_f32 v44, v44, v48
  v_smfmac_f32_16x16x64_bf16 v[56:59], v[24:27], v[176:183], v3
  v_add_f32 v45, v45, v49
  v_smfmac_f32_16x16x64_bf16 v[56:59], v[28:31], v[184:191], v3
  v_add_f32 v46, v46, v50
  v_smfmac_f32_16x16x64_bf16 v[56:59], v[32:35], v[192:199], v3
  v_add_f32 v47, v47, v51
  v_cvt_pk_bf16_f32 v48, v44, v45
  v_cvt_pk_bf16_f32 v49, v46, v47
  ds_write2_b32 v113, v48, v49 offset0:0 offset1:2
  s_nop 3
  v_permlane32_swap_b32 v52, v56
  v_permlane32_swap_b32 v53, v57
  v_permlane32_swap_b32 v54, v58
  v_permlane32_swap_b32 v55, v59
  v_add_f32 v52, v52, v56
  v_add_f32 v53, v53, v57
  v_add_f32 v54, v54, v58
  v_add_f32 v55, v55, v59
  v_cvt_pk_bf16_f32 v56, v52, v53
  v_cvt_pk_bf16_f32 v57, v54, v55
  ds_write2_b32 v114, v56, v57 offset0:0 offset1:2
  s_waitcnt lgkmcnt(0)
  s_barrier
  s_cmp_eq_u32 s19, 62
  s_cbranch_scc1 cA_done
  s_waitcnt vmcnt(0) lgkmcnt(0)
  s_add_u32 s19, s19, 1
  s_mov_b32 s20, s21
  s_branch cA_va2_loop
cA_va2_retry:
  s_waitcnt lgkmcnt(0)
  buffer_load_dwordx4 v[8:11], v2, s[8:11], s20 offen offset:0 sc1
  buffer_load_dwordx4 v[12:15], v2, s[8:11], s20 offen offset:1024 sc1
  buffer_load_dwordx4 v[16:19], v2, s[8:11], s20 offen offset:2048 sc1
  buffer_load_dwordx4 v[20:23], v2, s[8:11], s20 offen offset:3072 sc1
  s_add_u32 s31, s31, 1
  s_add_u32 s30, s30, 1
  s_cmp_lt_u32 s30, 400000
  s_cbranch_scc1 cA_va2_ld
  s_branch cA_abort
cA_va2_last:
  s_waitcnt lgkmcnt(0)
  buffer_store_dwordx4 v[100:103], v2, s[8:11], s24 offen offset:0 sc1
  buffer_store_dwordx4 v[104:107], v2, s[8:11], s24 offen offset:1024 sc1
  buffer_store_dwordx4 v[108:111], v2, s[8:11], s24 offen offset:2048 sc1
  buffer_store_dwordx4 v[4:7], v2, s[8:11], s24 offen offset:3072 sc1
  s_add_u32 s24, s24, 8192
  s_waitcnt vmcnt(0)
  s_mov_b64 exec, 1
  buffer_store_dword v117, v2, s[8:11], s34 offen sc1
  s_mov_b64 exec, -1
  s_add_u32 s34, s34, 8
  s_mov_b64 exec, 1
  buffer_store_dword v117, v2, s[8:11], s34 offen sc1
  s_mov_b64 exec, -1
  s_add_u32 s34, s34, 8
  s_branch cA_done
.p2align 6

cA_va3_loop:
  s_add_u32 s23, s20, 4096
  s_add_u32 s21, s20, 25600
  v_mov_b32 v36, 0
  v_mov_b32 v37, 0
  v_mov_b32 v38, 0
  v_mov_b32 v39, 0
  v_mov_b32 v40, 0
  v_mov_b32 v41, 0
  v_mov_b32 v42, 0
  v_mov_b32 v43, 0
  v_mov_b32 v44, 0
  v_mov_b32 v45, 0
  v_mov_b32 v46, 0
  v_mov_b32 v47, 0
  v_mov_b32 v48, 0
  v_mov_b32 v49, 0
  v_mov_b32 v50, 0
  v_mov_b32 v51, 0
  v_mov_b32 v52, 0
  v_mov_b32 v53, 0
  v_mov_b32 v54, 0
  v_mov_b32 v55, 0
  v_mov_b32 v56, 0
  v_mov_b32 v57, 0
  v_mov_b32 v58, 0
  v_mov_b32 v59, 0
  v_mov_b32 v60, 0
  v_mov_b32 v61, 0
  v_mov_b32 v62, 0
  v_mov_b32 v63, 0
  v_mov_b32 v64, 0
  v_mov_b32 v65, 0
  v_mov_b32 v66, 0
  v_mov_b32 v67, 0
  s_mov_b32 s30, 0
  buffer_load_dword v76, v119, s[8:11], s20 offen sc1
  buffer_load_dword v77, v119, s[8:11], s20 offen sc1
  buffer_load_dword v78, v119, s[8:11], s20 offen sc1
cA_va3_fp_l:
  s_waitcnt vmcnt(2)
  v_cmp_eq_u32 vcc, -1, v76
  s_cbranch_vccz cA_va3_fp_d
  buffer_load_dword v76, v119, s[8:11], s20 offen sc1
  s_waitcnt vmcnt(2)
  v_cmp_eq_u32 vcc, -1, v77
  s_cbranch_vccz cA_va3_fp_d
  buffer_load_dword v77, v119, s[8:11], s20 offen sc1
  s_waitcnt vmcnt(2)
  v_cmp_eq_u32 vcc, -1, v78
  s_cbranch_vccz cA_va3_fp_d
  buffer_load_dword v78, v119, s[8:11], s20 offen sc1
  s_add_u32 s30, s30, 1
  s_cmp_lt_u32 s30, 400000
  s_cbranch_scc1 cA_va3_fp_l
  s_branch cA_abort
cA_va3_fp_d:
  buffer_load_dwordx4 v[24:27], v2, s[8:11], s23 offen offset:0 sc1
  buffer_load_dwordx4 v[28:31], v2, s[8:11], s23 offen offset:1024 sc1
  buffer_load_dwordx4 v[32:35], v2, s[8:11], s23 offen offset:2048 sc1
  s_barrier
cA_va3_ld:
  s_waitcnt vmcnt(0)
  v_max3_u32 v84, v24, v25, v26
  v_max3_u32 v84, v84, v27, v28
  v_max3_u32 v84, v84, v29, v30
  v_max3_u32 v84, v84, v31, v32
  v_max3_u32 v84, v84, v33, v34
  v_max_u32 v84, v84, v35
  v_cmp_eq_u32 vcc, -1, v84
  ds_write_b128 v2, v[24:27] offset:12288
  ds_write_b128 v2, v[28:31] offset:13312
  ds_write_b128 v2, v[32:35] offset:14336
  s_cbranch_vccnz cA_va3_retry
  s_waitcnt lgkmcnt(0)
  s_barrier
  ds_read_b128 v[8:11], v2 offset:8192
  ds_read_b128 v[12:15], v2 offset:9216
  ds_read_b128 v[16:19], v2 offset:10240
  ds_read_b128 v[20:23], v2 offset:11264
  s_waitcnt lgkmcnt(0)
  s_cmp_eq_u32 s19, 63
  s_cbranch_scc1 cA_done
  ds_read_b128 v[76:79], v1 offset:0
  ds_read_b128 v[80:83], v1 offset:1024
  ds_read_b128 v[84:87], v1 offset:2048
  ds_read_b128 v[88:91], v1 offset:3072
  ds_read_b128 v[92:95], v1 offset:4096
  ds_read_b128 v[96:99], v1 offset:5120
  v_smfmac_f32_16x16x64_bf16 v[60:63], v[8:11], v[200:207], v3
  v_smfmac_f32_16x16x64_bf16 v[60:63], v[12:15], v[208:215], v3
  s_waitcnt lgkmcnt(4)
  v_smfmac_f32_16x16x64_bf16 v[64:67], v[8:11], v[76:83], v3
  ds_read_b128 v[76:79], v1 offset:6144
  ds_read_b128 v[80:83], v1 offset:7168
  v_smfmac_f32_16x16x64_bf16 v[60:63], v[16:19], v[216:223], v3
  v_smfmac_f32_16x16x64_bf16 v[60:63], v[20:23], v[224:231], v3
  s_waitcnt lgkmcnt(4)
  v_smfmac_f32_16x16x64_bf16 v[64:67], v[12:15], v[84:91], v3
  ds_read_b128 v[84:87], v1 offset:8192
  ds_read_b128 v[88:91], v1 offset:9216
  v_smfmac_f32_16x16x64_bf16 v[60:63], v[24:27], v[232:239], v3
  v_smfmac_f32_16x16x64_bf16 v[60:63], v[28:31], v[240:247], v3
  s_waitcnt lgkmcnt(4)
  v_smfmac_f32_16x16x64_bf16 v[64:67], v[16:19], v[92:99], v3
  ds_read_b128 v[92:95], v1 offset:10240
  ds_read_b128 v[96:99], v1 offset:11264
  v_smfmac_f32_16x16x64_bf16 v[60:63], v[32:35], v[248:255], v3
  v_smfmac_f32_16x16x64_bf16 v[36:39], v[8:11], a[0:7], v3
  s_waitcnt lgkmcnt(4)
  v_smfmac_f32_16x16x64_bf16 v[64:67], v[20:23], v[76:83], v3
  ds_read_b128 v[76:79], v1 offset:12288
  ds_read_b128 v[80:83], v1 offset:13312
  v_smfmac_f32_16x16x64_bf16 v[36:39], v[12:15], a[8:15], v3
  v_smfmac_f32_16x16x64_bf16 v[36:39], v[16:19], a[16:23], v3
  s_waitcnt lgkmcnt(4)
  v_smfmac_f32_16x16x64_bf16 v[64:67], v[24:27], v[84:91], v3
  v_smfmac_f32_16x16x64_bf16 v[36:39], v[20:23], a[24:31], v3
  v_smfmac_f32_16x16x64_bf16 v[36:39], v[24:27], a[32:39], v3
  s_waitcnt lgkmcnt(2)
  v_smfmac_f32_16x16x64_bf16 v[64:67], v[28:31], v[92:99], v3
  v_smfmac_f32_16x16x64_bf16 v[36:39], v[28:31], a[40:47], v3
  v_smfmac_f32_16x16x64_bf16 v[36:39], v[32:35], a[48:55], v3
  s_waitcnt lgkmcnt(0)
  v_smfmac_f32_16x16x64_bf16 v[64:67], v[32:35], v[76:83], v3
  v_smfmac_f32_16x16x64_bf16 v[40:43], v[8:11], a[56:63], v3
  v_smfmac_f32_16x16x64_bf16 v[40:43], v[12:15], a[64:71], v3
  v_smfmac_f32_16x16x64_bf16 v[40:43], v[16:19], a[72:79], v3
  v_smfmac_f32_16x16x64_bf16 v[40:43], v[20:23], a[80:87], v3
  v_permlane32_swap_b32 v60, v64
  v_smfmac_f32_16x16x64_bf16 v[40:43], v[24:27], a[88:95], v3
  v_permlane32_swap_b32 v61, v65
  v_smfmac_f32_16x16x64_bf16 v[40:43], v[28:31], a[96:103], v3
  v_permlane32_swap_b32 v62, v66
  v_smfmac_f32_16x16x64_bf16 v[40:43], v[32:35], a[104:111], v3
  v_permlane32_swap_b32 v63, v67
  v_smfmac_f32_16x16x64_bf16 v[44:47], v[8:11], a[112:119], v3
  v_smfmac_f32_16x16x64_bf16 v[44:47], v[12:15], a[120:127], v3
  v_smfmac_f32_16x16x64_bf16 v[44:47], v[16:19], a[128:135], v3
  v_smfmac_f32_16x16x64_bf16 v[44:47], v[20:23], a[136:143], v3
  v_add_f32 v60, v60, v64
  v_add_f32 v61, v61, v65
  v_smfmac_f32_16x16x64_bf16 v[44:47], v[24:27], a[144:151], v3
  v_add_f32 v62, v62, v66
  v_add_f32 v63, v63, v67
  v_smfmac_f32_16x16x64_bf16 v[44:47], v[28:31], a[152:159], v3
  v_cvt_pk_bf16_f32 v64, v60, v61
  v_cvt_pk_bf16_f32 v65, v62, v63
  v_smfmac_f32_16x16x64_bf16 v[44:47], v[32:35], a[160:167], v3
  ds_write2_b32 v115, v64, v65 offset0:0 offset1:2
  v_smfmac_f32_16x16x64_bf16 v[48:51], v[8:11], a[168:175], v3
  v_permlane32_swap_b32 v36, v40
  v_smfmac_f32_16x16x64_bf16 v[48:51], v[12:15], a[176:183], v3
  v_permlane32_swap_b32 v37, v41
  v_smfmac_f32_16x16x64_bf16 v[48:51], v[16:19], a[184:191], v3
  v_permlane32_swap_b32 v38, v42
  v_smfmac_f32_16x16x64_bf16 v[48:51], v[20:23], a[192:199], v3
  v_permlane32_swap_b32 v39, v43
  v_smfmac_f32_16x16x64_bf16 v[48:51], v[24:27], a[200:207], v3
  v_add_f32 v36, v36, v40
  v_smfmac_f32_16x16x64_bf16 v[48:51], v[28:31], a[208:215], v3
  v_add_f32 v37, v37, v41
  v_smfmac_f32_16x16x64_bf16 v[48:51], v[32:35], a[216:223], v3
  v_add_f32 v38, v38, v42
  v_smfmac_f32_16x16x64_bf16 v[52:55], v[8:11], a[224:231], v3
  v_smfmac_f32_16x16x64_bf16 v[52:55], v[12:15], a[232:239], v3
  v_smfmac_f32_16x16x64_bf16 v[52:55], v[16:19], a[240:247], v3
  v_smfmac_f32_16x16x64_bf16 v[52:55], v[20:23], a[248:255], v3
  v_add_f32 v39, v39, v43
  v_cvt_pk_bf16_f32 v40, v36, v37
  v_smfmac_f32_16x16x64_bf16 v[52:55], v[24:27], v[120:127], v3
  v_cvt_pk_bf16_f32 v41, v38, v39
  v_smfmac_f32_16x16x64_bf16 v[52:55], v[28:31], v[128:135], v3
  ds_write2_b32 v112, v40, v41 offset0:0 offset1:2
  v_smfmac_f32_16x16x64_bf16 v[52:55], v[32:35], v[136:143], v3
  v_permlane32_swap_b32 v44, v48
  v_smfmac_f32_16x16x64_bf16 v[56:59], v[8:11], v[144:151], v3
  v_permlane32_swap_b32 v45, v49
  v_smfmac_f32_16x16x64_bf16 v[56:59], v[12:15], v[152:159], v3
  v_permlane32_swap_b32 v46, v50
  v_smfmac_f32_16x16x64_bf16 v[56:59], v[16:19], v[160:167], v3
  v_permlane32_swap_b32 v47, v51
  v_smfmac_f32_16x16x64_bf16 v[56:59], v[20:23], v[168:175], v3
  v_add_f32 v44, v44, v48
  v_smfmac_f32_16x16x64_bf16 v[56:59], v[24:27], v[176:183], v3
  v_add_f32 v45, v45, v49
  v_smfmac_f32_16x16x64_bf16 v[56:59], v[28:31], v[184:191], v3
  v_add_f32 v46, v46, v50
  v_smfmac_f32_16x16x64_bf16 v[56:59], v[32:35], v[192:199], v3
  v_add_f32 v47, v47, v51
  v_cvt_pk_bf16_f32 v48, v44, v45
  v_cvt_pk_bf16_f32 v49, v46, v47
  ds_write2_b32 v113, v48, v49 offset0:0 offset1:2
  s_nop 3
  v_permlane32_swap_b32 v52, v56
  v_permlane32_swap_b32 v53, v57
  v_permlane32_swap_b32 v54, v58
  v_permlane32_swap_b32 v55, v59
  v_add_f32 v52, v52, v56
  v_add_f32 v53, v53, v57
  v_add_f32 v54, v54, v58
  v_add_f32 v55, v55, v59
  v_cvt_pk_bf16_f32 v56, v52, v53
  v_cvt_pk_bf16_f32 v57, v54, v55
  ds_write2_b32 v114, v56, v57 offset0:0 offset1:2
  s_waitcnt lgkmcnt(0)
  s_barrier
  s_cmp_eq_u32 s19, 62
  s_cbranch_scc1 cA_done
  s_waitcnt vmcnt(0) lgkmcnt(0)
  s_add_u32 s19, s19, 1
  s_mov_b32 s20, s21
  s_branch cA_va3_loop
cA_va3_retry:
  s_waitcnt lgkmcnt(0)
  buffer_load_dwordx4 v[24:27], v2, s[8:11], s23 offen offset:0 sc1
  buffer_load_dwordx4 v[28:31], v2, s[8:11], s23 offen offset:1024 sc1
  buffer_load_dwordx4 v[32:35], v2, s[8:11], s23 offen offset:2048 sc1
  s_add_u32 s31, s31, 1
  s_add_u32 s30, s30, 1
  s_cmp_lt_u32 s30, 400000
  s_cbranch_scc1 cA_va3_ld
  s_branch cA_abort
cA_va3_last:
  s_waitcnt lgkmcnt(0)
  buffer_store_dwordx4 v[100:103], v2, s[8:11], s24 offen offset:0 sc1
  buffer_store_dwordx4 v[104:107], v2, s[8:11], s24 offen offset:1024 sc1
  buffer_store_dwordx4 v[108:111], v2, s[8:11], s24 offen offset:2048 sc1
  buffer_store_dwordx4 v[4:7], v2, s[8:11], s24 offen offset:3072 sc1
  s_add_u32 s24, s24, 8192
  s_waitcnt vmcnt(0)
  s_mov_b64 exec, 1
  buffer_store_dword v117, v2, s[8:11], s34 offen sc1
  s_mov_b64 exec, -1
  s_add_u32 s34, s34, 8
  s_mov_b64 exec, 1
  buffer_store_dword v117, v2, s[8:11], s34 offen sc1
  s_mov_b64 exec, -1
  s_add_u32 s34, s34, 8
  s_branch cA_done
cA_abort:
  v_mov_b32 v4, 0xdead
  v_mov_b32 v5, 16
  buffer_store_dword v4, v5, s[12:15], 0 offen
  s_branch ch_end
cA_done:
  s_branch ch_end
.p2align 6

cB_sc0_loop:
  s_add_u32 s23, s20, 4096
  s_add_u32 s21, s20, 25600
  v_mov_b32 v48, 0
  v_mov_b32 v49, 0
  v_mov_b32 v50, 0
  v_mov_b32 v51, 0
  v_mov_b32 v52, 0
  v_mov_b32 v53, 0
  v_mov_b32 v54, 0
  v_mov_b32 v55, 0
  v_mov_b32 v56, 0
  v_mov_b32 v57, 0
  v_mov_b32 v58, 0
  v_mov_b32 v59, 0
  v_mov_b32 v60, 0
  v_mov_b32 v61, 0
  v_mov_b32 v62, 0
  v_mov_b32 v63, 0
  v_mov_b32 v88, 0
  v_mov_b32 v89, 0
  v_mov_b32 v90, 0
  v_mov_b32 v91, 0
  v_mov_b32 v92, 0
  v_mov_b32 v93, 0
  v_mov_b32 v94, 0
  v_mov_b32 v95, 0
  v_mov_b32 v66, 0
  v_mov_b32 v67, 0
  s_mov_b32 s30, 0
  s_mov_b32 s62, 0
  buffer_load_dword v68, v0, s[8:11], s20 offen sc1
  s_nop 7
  buffer_load_dword v69, v0, s[8:11], s20 offen sc1
  s_nop 7
  buffer_load_dword v70, v0, s[8:11], s20 offen sc1
  s_nop 7
  buffer_load_dword v71, v0, s[8:11], s20 offen sc1
  s_nop 7
  buffer_load_dword v72, v0, s[8:11], s20 offen sc1
cB_sc0_fp_l:
  s_waitcnt vmcnt(4)
  v_cmp_eq_u32 vcc, -1, v68
  s_cbranch_vccz cB_sc0_fp_d
  buffer_load_dword v68, v0, s[8:11], s20 offen sc1
  s_waitcnt vmcnt(4)
  v_cmp_eq_u32 vcc, -1, v69
  s_cbranch_vccz cB_sc0_fp_d
  buffer_load_dword v69, v0, s[8:11], s20 offen sc1
  s_waitcnt vmcnt(4)
  v_cmp_eq_u32 vcc, -1, v70
  s_cbranch_vccz cB_sc0_fp_d
  buffer_load_dword v70, v0, s[8:11], s20 offen sc1
  s_waitcnt vmcnt(4)
  v_cmp_eq_u32 vcc, -1, v71
  s_cbranch_vccz cB_sc0_fp_d
  buffer_load_dword v71, v0, s[8:11], s20 offen sc1
  s_waitcnt vmcnt(4)
  v_cmp_eq_u32 vcc, -1, v72
  s_cbranch_vccz cB_sc0_fp_d
  buffer_load_dword v72, v0, s[8:11], s20 offen sc1
  s_add_u32 s30, s30, 1
  s_cmp_lt_u32 s30, 400000
  s_cbranch_scc1 cB_sc0_fp_l
  s_branch cB_abort
cB_sc0_fp_d:
  buffer_load_dwordx4 v[8:11], v2, s[8:11], s20 offen offset:0 sc1
  s_barrier
  s_branch cB_sc0_ld1
cB_sc0_ld:
  buffer_load_dwordx4 v[8:11], v2, s[8:11], s20 offen offset:0 sc1
cB_sc0_ld1:
  v_mov_b32 v36, 0
  v_mov_b32 v37, 0
  v_mov_b32 v38, 0
  v_mov_b32 v39, 0
  buffer_load_dwordx4 v[12:15], v2, s[8:11], s20 offen offset:1024 sc1
  v_mov_b32 v40, 0
  v_mov_b32 v41, 0
  v_mov_b32 v42, 0
  v_mov_b32 v43, 0
  buffer_load_dwordx4 v[16:19], v2, s[8:11], s20 offen offset:2048 sc1
  v_mov_b32 v44, 0
  v_mov_b32 v45, 0
  v_mov_b32 v46, 0
  v_mov_b32 v47, 0
  ds_read_b128 v[96:99], v117 offset:0
  ds_read_b128 v[100:103], v117 offset:1024
  ds_read_b128 v[104:107], v117 offset:14336
  ds_read_b128 v[108:111], v117 offset:15360
  s_waitcnt vmcnt(2)
  v_smfmac_f32_16x16x64_bf16 v[36:39], v[8:11], a[0:7], v3
  v_smfmac_f32_16x16x64_bf16 v[40:43], v[8:11], a[56:63], v3
  buffer_load_dwordx4 v[20:23], v2, s[8:11], s20 offen offset:3072 sc1
  v_smfmac_f32_16x16x64_bf16 v[44:47], v[8:11], a[112:119], v3
  v_smfmac_f32_16x16x64_bf16 v[48:51], v[8:11], a[168:175], v3
  v_smfmac_f32_16x16x64_bf16 v[52:55], v[8:11], a[224:231], v3
  buffer_load_dwordx4 v[24:27], v2, s[8:11], s23 offen offset:0 sc1
  v_smfmac_f32_16x16x64_bf16 v[56:59], v[8:11], v[144:151], v3
  v_smfmac_f32_16x16x64_bf16 v[60:63], v[8:11], v[200:207], v3
  s_waitcnt vmcnt(3)
  v_smfmac_f32_16x16x64_bf16 v[36:39], v[12:15], a[8:15], v3
  v_smfmac_f32_16x16x64_bf16 v[40:43], v[12:15], a[64:71], v3
  buffer_load_dwordx4 v[28:31], v2, s[8:11], s23 offen offset:1024 sc1
  v_smfmac_f32_16x16x64_bf16 v[44:47], v[12:15], a[120:127], v3
  v_smfmac_f32_16x16x64_bf16 v[48:51], v[12:15], a[176:183], v3
  v_smfmac_f32_16x16x64_bf16 v[52:55], v[12:15], a[232:239], v3
  buffer_load_dwordx4 v[32:35], v2, s[8:11], s23 offen offset:2048 sc1
  v_smfmac_f32_16x16x64_bf16 v[56:59], v[12:15], v[152:159], v3
  v_smfmac_f32_16x16x64_bf16 v[60:63], v[12:15], v[208:215], v3
  s_waitcnt vmcnt(4)
  v_smfmac_f32_16x16x64_bf16 v[36:39], v[16:19], a[16:23], v3
  v_smfmac_f32_16x16x64_bf16 v[40:43], v[16:19], a[72:79], v3
  v_smfmac_f32_16x16x64_bf16 v[44:47], v[16:19], a[128:135], v3
  v_smfmac_f32_16x16x64_bf16 v[48:51], v[16:19], a[184:191], v3
  v_smfmac_f32_16x16x64_bf16 v[52:55], v[16:19], a[240:247], v3
  v_smfmac_f32_16x16x64_bf16 v[56:59], v[16:19], v[160:167], v3
  v_smfmac_f32_16x16x64_bf16 v[60:63], v[16:19], v[216:223], v3
  s_waitcnt vmcnt(3)
  v_smfmac_f32_16x16x64_bf16 v[36:39], v[20:23], a[24:31], v3
  v_smfmac_f32_16x16x64_bf16 v[40:43], v[20:23], a[80:87], v3
  v_smfmac_f32_16x16x64_bf16 v[44:47], v[20:23], a[136:143], v3
  v_smfmac_f32_16x16x64_bf16 v[48:51], v[20:23], a[192:199], v3
  v_smfmac_f32_16x16x64_bf16 v[52:55], v[20:23], a[248:255], v3
  v_smfmac_f32_16x16x64_bf16 v[56:59], v[20:23], v[168:175], v3
  v_smfmac_f32_16x16x64_bf16 v[60:63], v[20:23], v[224:231], v3
  s_waitcnt vmcnt(0)
cB_sc0_ph2:
  v_smfmac_f32_16x16x64_bf16 v[60:63], v[24:27], v[232:239], v3
  ds_read_b128 v[12:15], v116 offset:0
  ds_read_b128 v[16:19], v116 offset:1024
  v_smfmac_f32_16x16x64_bf16 v[60:63], v[28:31], v[240:247], v3
  v_smfmac_f32_16x16x64_bf16 v[60:63], v[32:35], v[248:255], v3
  v_mov_b32 v80, v24
  v_smfmac_f32_16x16x64_bf16 v[52:55], v[24:27], v[120:127], v3
  v_mov_b32 v81, v25
  v_smfmac_f32_16x16x64_bf16 v[52:55], v[28:31], v[128:135], v3
  v_mov_b32 v82, v32
  v_smfmac_f32_16x16x64_bf16 v[52:55], v[32:35], v[136:143], v3
  v_cvt_pk_bf16_f32 v64, v60, v61
  v_smfmac_f32_16x16x64_bf16 v[56:59], v[24:27], v[176:183], v3
  v_cvt_pk_bf16_f32 v65, v62, v63
  v_smfmac_f32_16x16x64_bf16 v[56:59], v[28:31], v[184:191], v3
  v_mov_b32 v83, v33
  v_mfma_f32_16x16x32_bf16 v[68:71], v[64:67], v[4:7], 0
  v_smfmac_f32_16x16x64_bf16 v[56:59], v[32:35], v[192:199], v3
  v_cvt_pk_bf16_f32 v64, v52, v53
  v_smfmac_f32_16x16x64_bf16 v[36:39], v[24:27], a[32:39], v3
  v_cvt_pk_bf16_f32 v65, v54, v55
  v_smfmac_f32_16x16x64_bf16 v[36:39], v[28:31], a[40:47], v3
  v_cvt_pk_bf16_f32 v78, v68, v69
  v_smfmac_f32_16x16x64_bf16 v[36:39], v[32:35], a[48:55], v3
  v_cvt_pk_bf16_f32 v79, v70, v71
  v_cvt_pk_bf16_f32 v66, v56, v57
  v_smfmac_f32_16x16x64_bf16 v[40:43], v[24:27], a[88:95], v3
  v_cvt_pk_bf16_f32 v67, v58, v59
  v_smfmac_f32_16x16x64_bf16 v[40:43], v[28:31], a[96:103], v3
  v_mfma_f32_16x16x32_bf16 v[72:75], v[64:67], v[4:7], 0
  ds_read_b128 v[52:55], v116 offset:14336
  ds_read_b128 v[56:59], v116 offset:15360
  v_smfmac_f32_16x16x64_bf16 v[40:43], v[32:35], a[104:111], v3
  v_cvt_pk_bf16_f32 v64, v36, v37
  v_smfmac_f32_16x16x64_bf16 v[44:47], v[24:27], a[144:151], v3
  v_cvt_pk_bf16_f32 v65, v38, v39
  v_smfmac_f32_16x16x64_bf16 v[44:47], v[28:31], a[152:159], v3
  v_cvt_pk_bf16_f32 v76, v72, v73
  v_smfmac_f32_16x16x64_bf16 v[44:47], v[32:35], a[160:167], v3
  v_cvt_pk_bf16_f32 v77, v74, v75
  v_cvt_pk_bf16_f32 v66, v40, v41
  v_smfmac_f32_16x16x64_bf16 v[48:51], v[24:27], a[200:207], v3
  v_cvt_pk_bf16_f32 v67, v42, v43
  v_smfmac_f32_16x16x64_bf16 v[48:51], v[28:31], a[208:215], v3
  v_mfma_f32_16x16x32_bf16 v[68:71], v[64:67], v[4:7], 0
  v_smfmac_f32_16x16x64_bf16 v[48:51], v[32:35], a[216:223], v3
  v_cvt_pk_bf16_f32 v64, v44, v45
  v_mfma_f32_16x16x32_bf16 v[84:87], v[80:83], v[76:79], 0
  v_cvt_pk_bf16_f32 v65, v46, v47
  s_waitcnt lgkmcnt(0)
  v_smfmac_f32_16x16x64_bf16 v[88:91], v[76:79], v[96:103], v3
  v_cvt_pk_bf16_f32 v60, v68, v69
  v_cvt_pk_bf16_f32 v61, v70, v71
  v_cvt_pk_bf16_f32 v66, v48, v49
  v_cvt_pk_bf16_f32 v67, v50, v51
  s_nop 1
  v_mfma_f32_16x16x32_bf16 v[72:75], v[64:67], v[4:7], 0
  v_smfmac_f32_16x16x64_bf16 v[92:95], v[76:79], v[104:111], v3
  s_nop 4
  v_cvt_pk_bf16_f32 v62, v72, v73
  v_cvt_pk_bf16_f32 v63, v74, v75
  s_nop 1
  v_mfma_f32_16x16x32_bf16 v[84:87], v[8:11], v[60:63], v[84:87]
  v_smfmac_f32_16x16x64_bf16 v[88:91], v[60:63], v[12:19], v3
  v_smfmac_f32_16x16x64_bf16 v[92:95], v[60:63], v[52:59], v3
  s_nop 1
  v_permlane32_swap_b32 v84, v86
  v_permlane32_swap_b32 v85, v87
  s_nop 0
  v_cmp_u_f32 vcc, v88, v89
  v_add_f32_dpp v84, v86, v84 row_ror:8 row_mask:0xf bank_mask:0xf
  v_add_f32_dpp v85, v87, v85 row_ror:8 row_mask:0xf bank_mask:0xf
  v_permlane32_swap_b32 v88, v92
  v_permlane32_swap_b32 v89, v93
  ds_write2_b32 v113, v84, v85 offset0:0 offset1:4
  v_permlane32_swap_b32 v90, v94
  v_permlane32_swap_b32 v91, v95
  v_add_f32 v88, v88, v92
  v_add_f32 v89, v89, v93
  v_add_f32 v90, v90, v94
  v_add_f32 v91, v91, v95
  ds_write2_b64 v112, v[88:89], v[90:91] offset0:0 offset1:128
  s_cbranch_vccnz cB_sc0_retry
cB_sc0_cont:
  s_waitcnt lgkmcnt(0)
  s_barrier
  ds_read_b128 v[36:39], v114
  ds_read_b128 v[44:47], v115
  s_waitcnt lgkmcnt(0)
  v_add_f32 v36, v36, v38
  v_add_f32 v37, v37, v39
  v_add_f32 v44, v44, v45
  v_add_f32 v46, v46, v47
  v_permlane32_swap_b32 v36, v37
  v_add_f32 v44, v44, v46
  v_add_f32 v36, v36, v37
  v_exp_f32 v49, v44
  v_exp_f32 v48, v36
  v_add_f32 v50, abs(v36), abs(v44)
  v_fma_f32 v39, v49, s37, v48
  v_cmp_ngt_f32 vcc, s56, v50
  v_cndmask_b32 v41, v48, v49, s[38:39]
  v_add_f32_dpp v39, v39, v39 quad_perm:[1,0,3,2] row_mask:0xf bank_mask:0xf
  v_cndmask_b32 v40, v49, v48, s[38:39]
  v_mov_b32_dpp v46, v41 quad_perm:[1,0,3,2] row_mask:0xf bank_mask:0xf
  v_add_f32_dpp v39, v39, v39 quad_perm:[2,3,0,1] row_mask:0xf bank_mask:0xf
  v_cndmask_b32 v42, v46, v40, s[38:39]
  v_cndmask_b32 v43, v40, v46, s[38:39]
  v_add_f32_dpp v39, v39, v39 row_half_mirror row_mask:0xf bank_mask:0xf
  s_cbranch_vccnz cB_sc0_slow
  s_nop 0
  v_add_f32_dpp v47, v39, v39 row_mirror row_mask:0xf bank_mask:0xf
  v_add_f32_dpp v39, v39, v39 row_mirror row_mask:0xf bank_mask:0xf
  s_nop 1
  v_permlane16_swap_b32 v39, v47
  v_add_f32 v39, v39, v47
  v_rcp_f32 v39, v39
  s_mov_b64 exec, s[28:29]
  v_mul_f32 v42, v42, v39
  v_mul_f32 v43, v43, v39
  v_cvt_pk_bf16_f32 v42, v42, v43
cB_sc0_pst:
  buffer_store_dword v42, v1, s[8:11], s20 offen sc1
  s_mov_b64 exec, -1
  s_barrier
  s_add_u32 s24, s24, 28672
  s_add_u32 s35, s35, 28672
  s_xor_b32 s25, s25, 28672
  s_add_u32 m0, s25, 0
  s_nop 0
  buffer_load_dwordx4 v2, s[8:11], s24 offen offset:0 sc1 lds
  buffer_load_dwordx4 v2, s[8:11], s24 offen offset:1024 sc1 lds
  buffer_load_dwordx4 v2, s[8:11], s24 offen offset:2048 sc1 lds
  buffer_load_dwordx4 v2, s[8:11], s24 offen offset:3072 sc1 lds
  s_add_u32 m0, s25, 4096
  s_add_u32 s22, s24, 4096
  buffer_load_dwordx4 v2, s[8:11], s22 offen offset:0 sc1 lds
  buffer_load_dwordx4 v2, s[8:11], s22 offen offset:1024 sc1 lds
  buffer_load_dwordx4 v2, s[8:11], s22 offen offset:2048 sc1 lds
  v_xor_b32 v116, 28672, v116
  v_add_u32 v117, s57, v117
  s_sub_u32 s57, 0, s57
  s_add_u32 s19, s19, 1
  s_mov_b32 s20, s21
  s_cmp_lt_u32 s19, 63
  s_cbranch_scc1 cB_sc0_loop
  s_branch cB_done
cB_sc0_slow:
  v_max_f32 v50, v36, v44
  s_nop 1
  v_max_f32_dpp v50, v50, v50 quad_perm:[1,0,3,2] row_mask:0xf bank_mask:0xf
  s_nop 1
  v_max_f32_dpp v50, v50, v50 quad_perm:[2,3,0,1] row_mask:0xf bank_mask:0xf
  s_nop 1
  v_max_f32_dpp v50, v50, v50 row_half_mirror row_mask:0xf bank_mask:0xf
  s_nop 1
  v_max_f32_dpp v50, v50, v50 row_mirror row_mask:0xf bank_mask:0xf
  v_mov_b32 v47, v50
  s_nop 1
  v_permlane16_swap_b32 v50, v47
  v_max_f32 v50, v50, v47
  v_sub_f32 v48, v36, v50
  v_sub_f32 v49, v44, v50
  v_exp_f32 v48, v48
  v_exp_f32 v49, v49
  s_add_u32 s31, s31, 0x100
  v_fma_f32 v39, v49, s37, v48
  v_cndmask_b32 v41, v48, v49, s[38:39]
  s_nop 0
  v_add_f32_dpp v39, v39, v39 quad_perm:[1,0,3,2] row_mask:0xf bank_mask:0xf
  v_cndmask_b32 v40, v49, v48, s[38:39]
  v_mov_b32_dpp v46, v41 quad_perm:[1,0,3,2] row_mask:0xf bank_mask:0xf
  v_add_f32_dpp v39, v39, v39 quad_perm:[2,3,0,1] row_mask:0xf bank_mask:0xf
  v_cndmask_b32 v42, v46, v40, s[38:39]
  v_cndmask_b32 v43, v40, v46, s[38:39]
  v_add_f32_dpp v39, v39, v39 row_half_mirror row_mask:0xf bank_mask:0xf
  s_nop 1
  v_add_f32_dpp v47, v39, v39 row_mirror row_mask:0xf bank_mask:0xf
  v_add_f32_dpp v39, v39, v39 row_mirror row_mask:0xf bank_mask:0xf
  s_nop 1
  v_permlane16_swap_b32 v39, v47
  v_add_f32 v39, v39, v47
  v_rcp_f32 v39, v39
  s_mov_b64 exec, s[28:29]
  v_mul_f32 v42, v42, v39
  v_mul_f32 v43, v43, v39
  v_cvt_pk_bf16_f32 v42, v42, v43
  v_min_u32 v42, -2, v42
  s_branch cB_sc0_pst
cB_sc0_retry:
  s_cmp_lg_u32 s62, 0
  s_cbranch_scc1 cB_sc0_cont
  s_waitcnt vmcnt(0) lgkmcnt(0)
cB_sc0_rv:
  buffer_load_dwordx4 v[8:11], v2, s[8:11], s20 offen offset:0 sc1
  buffer_load_dwordx4 v[12:15], v2, s[8:11], s20 offen offset:1024 sc1
  buffer_load_dwordx4 v[16:19], v2, s[8:11], s20 offen offset:2048 sc1
  buffer_load_dwordx4 v[20:23], v2, s[8:11], s20 offen offset:3072 sc1
  buffer_load_dwordx4 v[24:27], v2, s[8:11], s23 offen offset:0 sc1
  buffer_load_dwordx4 v[28:31], v2, s[8:11], s23 offen offset:1024 sc1
  buffer_load_dwordx4 v[32:35], v2, s[8:11], s23 offen offset:2048 sc1
  s_waitcnt vmcnt(0)
  v_max3_u32 v118, v8, v9, v10
  v_max3_u32 v118, v118, v11, v12
  v_max3_u32 v118, v118, v13, v14
  v_max3_u32 v118, v118, v15, v16
  v_max3_u32 v118, v118, v17, v18
  v_max3_u32 v118, v118, v19, v20
  v_max3_u32 v118, v118, v21, v22
  v_max3_u32 v118, v118, v23, v24
  v_max3_u32 v118, v118, v25, v26
  v_max3_u32 v118, v118, v27, v28
  v_max3_u32 v118, v118, v29, v30
  v_max3_u32 v118, v118, v31, v32
  v_max3_u32 v118, v118, v33, v34
  v_max_u32 v118, v118, v35
  v_cmp_eq_u32 vcc, -1, v118
  s_cbranch_vccz cB_sc0_rk
  s_add_u32 s30, s30, 1
  s_cmp_lt_u32 s30, 400000
  s_cbranch_scc1 cB_sc0_rv
  s_branch cB_abort
cB_sc0_rk:
  s_mov_b32 s62, 1
  v_mov_b32 v36, 0
  v_mov_b32 v37, 0
  v_mov_b32 v38, 0
  v_mov_b32 v39, 0
  v_mov_b32 v40, 0
  v_mov_b32 v41, 0
  v_mov_b32 v42, 0
  v_mov_b32 v43, 0
  v_mov_b32 v44, 0
  v_mov_b32 v45, 0
  v_mov_b32 v46, 0
  v_mov_b32 v47, 0
  v_mov_b32 v48, 0
  v_mov_b32 v49, 0
  v_mov_b32 v50, 0
  v_mov_b32 v51, 0
  v_mov_b32 v52, 0
  v_mov_b32 v53, 0
  v_mov_b32 v54, 0
  v_mov_b32 v55, 0
  v_mov_b32 v56, 0
  v_mov_b32 v57, 0
  v_mov_b32 v58, 0
  v_mov_b32 v59, 0
  v_mov_b32 v60, 0
  v_mov_b32 v61, 0
  v_mov_b32 v62, 0
  v_mov_b32 v63, 0
  v_mov_b32 v88, 0
  v_mov_b32 v89, 0
  v_mov_b32 v90, 0
  v_mov_b32 v91, 0
  v_mov_b32 v92, 0
  v_mov_b32 v93, 0
  v_mov_b32 v94, 0
  v_mov_b32 v95, 0
  v_mov_b32 v66, 0
  v_mov_b32 v67, 0
  s_add_u32 s31, s31, 1
  ds_read_b128 v[96:99], v117 offset:0
  ds_read_b128 v[100:103], v117 offset:1024
  ds_read_b128 v[104:107], v117 offset:14336
  ds_read_b128 v[108:111], v117 offset:15360
  v_smfmac_f32_16x16x64_bf16 v[36:39], v[8:11], a[0:7], v3
  v_smfmac_f32_16x16x64_bf16 v[40:43], v[8:11], a[56:63], v3
  v_smfmac_f32_16x16x64_bf16 v[44:47], v[8:11], a[112:119], v3
  v_smfmac_f32_16x16x64_bf16 v[48:51], v[8:11], a[168:175], v3
  v_smfmac_f32_16x16x64_bf16 v[52:55], v[8:11], a[224:231], v3
  v_smfmac_f32_16x16x64_bf16 v[56:59], v[8:11], v[144:151], v3
  v_smfmac_f32_16x16x64_bf16 v[60:63], v[8:11], v[200:207], v3
  v_smfmac_f32_16x16x64_bf16 v[36:39], v[12:15], a[8:15], v3
  v_smfmac_f32_16x16x64_bf16 v[40:43], v[12:15], a[64:71], v3
  v_smfmac_f32_16x16x64_bf16 v[44:47], v[12:15], a[120:127], v3
  v_smfmac_f32_16x16x64_bf16 v[48:51], v[12:15], a[176:183], v3
  v_smfmac_f32_16x16x64_bf16 v[52:55], v[12:15], a[232:239], v3
  v_smfmac_f32_16x16x64_bf16 v[56:59], v[12:15], v[152:159], v3
  v_smfmac_f32_16x16x64_bf16 v[60:63], v[12:15], v[208:215], v3
  v_smfmac_f32_16x16x64_bf16 v[36:39], v[16:19], a[16:23], v3
  v_smfmac_f32_16x16x64_bf16 v[40:43], v[16:19], a[72:79], v3
  v_smfmac_f32_16x16x64_bf16 v[44:47], v[16:19], a[128:135], v3
  v_smfmac_f32_16x16x64_bf16 v[48:51], v[16:19], a[184:191], v3
  v_smfmac_f32_16x16x64_bf16 v[52:55], v[16:19], a[240:247], v3
  v_smfmac_f32_16x16x64_bf16 v[56:59], v[16:19], v[160:167], v3
  v_smfmac_f32_16x16x64_bf16 v[60:63], v[16:19], v[216:223], v3
  v_smfmac_f32_16x16x64_bf16 v[36:39], v[20:23], a[24:31], v3
  v_smfmac_f32_16x16x64_bf16 v[40:43], v[20:23], a[80:87], v3
  v_smfmac_f32_16x16x64_bf16 v[44:47], v[20:23], a[136:143], v3
  v_smfmac_f32_16x16x64_bf16 v[48:51], v[20:23], a[192:199], v3
  v_smfmac_f32_16x16x64_bf16 v[52:55], v[20:23], a[248:255], v3
  v_smfmac_f32_16x16x64_bf16 v[56:59], v[20:23], v[168:175], v3
  v_smfmac_f32_16x16x64_bf16 v[60:63], v[20:23], v[224:231], v3
  s_branch cB_sc0_ph2
.p2align 6

cB_sc1_loop:
  s_add_u32 s23, s20, 4096
  s_add_u32 s21, s20, 25600
  v_mov_b32 v48, 0
  v_mov_b32 v49, 0
  v_mov_b32 v50, 0
  v_mov_b32 v51, 0
  v_mov_b32 v52, 0
  v_mov_b32 v53, 0
  v_mov_b32 v54, 0
  v_mov_b32 v55, 0
  v_mov_b32 v56, 0
  v_mov_b32 v57, 0
  v_mov_b32 v58, 0
  v_mov_b32 v59, 0
  v_mov_b32 v60, 0
  v_mov_b32 v61, 0
  v_mov_b32 v62, 0
  v_mov_b32 v63, 0
  v_mov_b32 v88, 0
  v_mov_b32 v89, 0
  v_mov_b32 v90, 0
  v_mov_b32 v91, 0
  v_mov_b32 v92, 0
  v_mov_b32 v93, 0
  v_mov_b32 v94, 0
  v_mov_b32 v95, 0
  v_mov_b32 v64, 0
  v_mov_b32 v65, 0
  s_mov_b32 s30, 0
  s_mov_b32 s62, 0
  s_waitcnt vmcnt(0)
  s_barrier
cB_sc1_ld:
  buffer_load_dwordx4 v[8:11], v2, s[8:11], s20 offen offset:0 sc1
  v_mov_b32 v36, 0
  v_mov_b32 v37, 0
  v_mov_b32 v38, 0
  v_mov_b32 v39, 0
  buffer_load_dwordx4 v[12:15], v2, s[8:11], s20 offen offset:1024 sc1
  v_mov_b32 v40, 0
  v_mov_b32 v41, 0
  v_mov_b32 v42, 0
  v_mov_b32 v43, 0
  buffer_load_dwordx4 v[16:19], v2, s[8:11], s20 offen offset:2048 sc1
  v_mov_b32 v44, 0
  v_mov_b32 v45, 0
  v_mov_b32 v46, 0
  v_mov_b32 v47, 0
  ds_read_b128 v[96:99], v117 offset:0
  ds_read_b128 v[100:103], v117 offset:1024
  ds_read_b128 v[104:107], v117 offset:14336
  ds_read_b128 v[108:111], v117 offset:15360
  s_waitcnt vmcnt(2)
  v_smfmac_f32_16x16x64_bf16 v[36:39], v[8:11], a[0:7], v3
  v_smfmac_f32_16x16x64_bf16 v[40:43], v[8:11], a[56:63], v3
  buffer_load_dwordx4 v[20:23], v2, s[8:11], s20 offen offset:3072 sc1
  v_smfmac_f32_16x16x64_bf16 v[44:47], v[8:11], a[112:119], v3
  v_smfmac_f32_16x16x64_bf16 v[48:51], v[8:11], a[168:175], v3
  v_smfmac_f32_16x16x64_bf16 v[52:55], v[8:11], a[224:231], v3
  buffer_load_dwordx4 v[24:27], v2, s[8:11], s23 offen offset:0 sc1
  v_smfmac_f32_16x16x64_bf16 v[56:59], v[8:11], v[144:151], v3
  v_smfmac_f32_16x16x64_bf16 v[60:63], v[8:11], v[200:207], v3
  s_waitcnt vmcnt(3)
  v_smfmac_f32_16x16x64_bf16 v[36:39], v[12:15], a[8:15], v3
  v_smfmac_f32_16x16x64_bf16 v[40:43], v[12:15], a[64:71], v3
  buffer_load_dwordx4 v[28:31], v2, s[8:11], s23 offen offset:1024 sc1
  v_smfmac_f32_16x16x64_bf16 v[44:47], v[12:15], a[120:127], v3
  v_smfmac_f32_16x16x64_bf16 v[48:51], v[12:15], a[176:183], v3
  v_smfmac_f32_16x16x64_bf16 v[52:55], v[12:15], a[232:239], v3
  buffer_load_dwordx4 v[32:35], v2, s[8:11], s23 offen offset:2048 sc1
  v_smfmac_f32_16x16x64_bf16 v[56:59], v[12:15], v[152:159], v3
  v_smfmac_f32_16x16x64_bf16 v[60:63], v[12:15], v[208:215], v3
  s_waitcnt vmcnt(4)
  v_smfmac_f32_16x16x64_bf16 v[36:39], v[16:19], a[16:23], v3
  v_smfmac_f32_16x16x64_bf16 v[40:43], v[16:19], a[72:79], v3
  v_smfmac_f32_16x16x64_bf16 v[44:47], v[16:19], a[128:135], v3
  v_smfmac_f32_16x16x64_bf16 v[48:51], v[16:19], a[184:191], v3
  v_smfmac_f32_16x16x64_bf16 v[52:55], v[16:19], a[240:247], v3
  v_smfmac_f32_16x16x64_bf16 v[56:59], v[16:19], v[160:167], v3
  v_smfmac_f32_16x16x64_bf16 v[60:63], v[16:19], v[216:223], v3
  s_waitcnt vmcnt(3)
  v_smfmac_f32_16x16x64_bf16 v[36:39], v[20:23], a[24:31], v3
  v_smfmac_f32_16x16x64_bf16 v[40:43], v[20:23], a[80:87], v3
  v_smfmac_f32_16x16x64_bf16 v[44:47], v[20:23], a[136:143], v3
  v_smfmac_f32_16x16x64_bf16 v[48:51], v[20:23], a[192:199], v3
  v_smfmac_f32_16x16x64_bf16 v[52:55], v[20:23], a[248:255], v3
  v_smfmac_f32_16x16x64_bf16 v[56:59], v[20:23], v[168:175], v3
  v_smfmac_f32_16x16x64_bf16 v[60:63], v[20:23], v[224:231], v3
  s_waitcnt vmcnt(0)
cB_sc1_ph2:
  v_smfmac_f32_16x16x64_bf16 v[60:63], v[24:27], v[232:239], v3
  ds_read_b128 v[16:19], v116 offset:2048
  ds_read_b128 v[20:23], v116 offset:3072
  v_smfmac_f32_16x16x64_bf16 v[60:63], v[28:31], v[240:247], v3
  buffer_load_dword v119, v0, s[8:11], s20 offen sc1
  v_smfmac_f32_16x16x64_bf16 v[60:63], v[32:35], v[248:255], v3
  v_mov_b32 v80, v26
  v_smfmac_f32_16x16x64_bf16 v[52:55], v[24:27], v[120:127], v3
  v_mov_b32 v81, v27
  v_smfmac_f32_16x16x64_bf16 v[52:55], v[28:31], v[128:135], v3
  v_mov_b32 v82, v32
  v_smfmac_f32_16x16x64_bf16 v[52:55], v[32:35], v[136:143], v3
  v_cvt_pk_bf16_f32 v66, v60, v61
  v_smfmac_f32_16x16x64_bf16 v[56:59], v[24:27], v[176:183], v3
  v_cvt_pk_bf16_f32 v67, v62, v63
  v_smfmac_f32_16x16x64_bf16 v[56:59], v[28:31], v[184:191], v3
  v_mov_b32 v83, v33
  v_mfma_f32_16x16x32_bf16 v[68:71], v[64:67], v[4:7], 0
  v_smfmac_f32_16x16x64_bf16 v[56:59], v[32:35], v[192:199], v3
  v_cvt_pk_bf16_f32 v64, v52, v53
  v_smfmac_f32_16x16x64_bf16 v[36:39], v[24:27], a[32:39], v3
  v_cvt_pk_bf16_f32 v65, v54, v55
  v_smfmac_f32_16x16x64_bf16 v[36:39], v[28:31], a[40:47], v3
  v_cvt_pk_bf16_f32 v78, v68, v69
  v_smfmac_f32_16x16x64_bf16 v[36:39], v[32:35], a[48:55], v3
  v_cvt_pk_bf16_f32 v79, v70, v71
  v_cvt_pk_bf16_f32 v66, v56, v57
  v_smfmac_f32_16x16x64_bf16 v[40:43], v[24:27], a[88:95], v3
  v_cvt_pk_bf16_f32 v67, v58, v59
  v_smfmac_f32_16x16x64_bf16 v[40:43], v[28:31], a[96:103], v3
  v_mfma_f32_16x16x32_bf16 v[72:75], v[64:67], v[4:7], 0
  ds_read_b128 v[52:55], v116 offset:16384
  ds_read_b128 v[56:59], v116 offset:17408
  v_smfmac_f32_16x16x64_bf16 v[40:43], v[32:35], a[104:111], v3
  v_cvt_pk_bf16_f32 v64, v36, v37
  v_smfmac_f32_16x16x64_bf16 v[44:47], v[24:27], a[144:151], v3
  v_cvt_pk_bf16_f32 v65, v38, v39
  v_smfmac_f32_16x16x64_bf16 v[44:47], v[28:31], a[152:159], v3
  v_cvt_pk_bf16_f32 v76, v72, v73
  v_smfmac_f32_16x16x64_bf16 v[44:47], v[32:35], a[160:167], v3
  v_cvt_pk_bf16_f32 v77, v74, v75
  v_cvt_pk_bf16_f32 v66, v40, v41
  v_smfmac_f32_16x16x64_bf16 v[48:51], v[24:27], a[200:207], v3
  v_cvt_pk_bf16_f32 v67, v42, v43
  v_smfmac_f32_16x16x64_bf16 v[48:51], v[28:31], a[208:215], v3
  v_mfma_f32_16x16x32_bf16 v[68:71], v[64:67], v[4:7], 0
  v_smfmac_f32_16x16x64_bf16 v[48:51], v[32:35], a[216:223], v3
  v_cvt_pk_bf16_f32 v64, v44, v45
  v_mfma_f32_16x16x32_bf16 v[84:87], v[80:83], v[76:79], 0
  v_cvt_pk_bf16_f32 v65, v46, v47
  s_waitcnt lgkmcnt(0)
  v_smfmac_f32_16x16x64_bf16 v[88:91], v[76:79], v[96:103], v3
  v_cvt_pk_bf16_f32 v60, v68, v69
  v_cvt_pk_bf16_f32 v61, v70, v71
  v_cvt_pk_bf16_f32 v66, v48, v49
  v_cvt_pk_bf16_f32 v67, v50, v51
  s_nop 1
  v_mfma_f32_16x16x32_bf16 v[72:75], v[64:67], v[4:7], 0
  v_smfmac_f32_16x16x64_bf16 v[92:95], v[76:79], v[104:111], v3
  s_nop 4
  v_cvt_pk_bf16_f32 v62, v72, v73
  v_cvt_pk_bf16_f32 v63, v74, v75
  s_nop 1
  v_mfma_f32_16x16x32_bf16 v[84:87], v[12:15], v[60:63], v[84:87]
  v_smfmac_f32_16x16x64_bf16 v[88:91], v[60:63], v[16:23], v3
  v_smfmac_f32_16x16x64_bf16 v[92:95], v[60:63], v[52:59], v3
  s_nop 1
  v_permlane32_swap_b32 v84, v86
  v_permlane32_swap_b32 v85, v87
  s_nop 0
  v_cmp_u_f32 vcc, v88, v89
  v_add_f32_dpp v84, v86, v84 row_ror:8 row_mask:0xf bank_mask:0xf
  v_add_f32_dpp v85, v87, v85 row_ror:8 row_mask:0xf bank_mask:0xf
  v_permlane32_swap_b32 v88, v92
  v_permlane32_swap_b32 v89, v93
  ds_write2_b32 v113, v84, v85 offset0:0 offset1:4
  v_permlane32_swap_b32 v90, v94
  v_permlane32_swap_b32 v91, v95
  v_add_f32 v88, v88, v92
  v_add_f32 v89, v89, v93
  v_add_f32 v90, v90, v94
  v_add_f32 v91, v91, v95
  ds_write2_b64 v112, v[88:89], v[90:91] offset0:0 offset1:128
  s_cbranch_vccnz cB_sc1_retry
cB_sc1_cont:
  s_waitcnt lgkmcnt(0)
  s_barrier
  ds_read_b128 v[36:39], v114
  ds_read_b128 v[44:47], v115
  s_waitcnt lgkmcnt(0)
  v_add_f32 v36, v36, v38
  v_add_f32 v37, v37, v39
  v_add_f32 v44, v44, v45
  v_add_f32 v46, v46, v47
  v_permlane32_swap_b32 v36, v37
  v_add_f32 v44, v44, v46
  v_add_f32 v36, v36, v37
  v_exp_f32 v49, v44
  v_exp_f32 v48, v36
  v_add_f32 v50, abs(v36), abs(v44)
  v_fma_f32 v39, v49, s37, v48
  v_cmp_ngt_f32 vcc, s56, v50
  v_cndmask_b32 v41, v48, v49, s[38:39]
  v_add_f32_dpp v39, v39, v39 quad_perm:[1,0,3,2] row_mask:0xf bank_mask:0xf
  v_cndmask_b32 v40, v49, v48, s[38:39]
  v_mov_b32_dpp v46, v41 quad_perm:[1,0,3,2] row_mask:0xf bank_mask:0xf
  v_add_f32_dpp v39, v39, v39 quad_perm:[2,3,0,1] row_mask:0xf bank_mask:0xf
  v_cndmask_b32 v42, v46, v40, s[38:39]
  v_cndmask_b32 v43, v40, v46, s[38:39]
  v_add_f32_dpp v39, v39, v39 row_half_mirror row_mask:0xf bank_mask:0xf
  s_cbranch_vccnz cB_sc1_slow
  s_nop 0
  v_add_f32_dpp v47, v39, v39 row_mirror row_mask:0xf bank_mask:0xf
  v_add_f32_dpp v39, v39, v39 row_mirror row_mask:0xf bank_mask:0xf
  s_nop 1
  v_permlane16_swap_b32 v39, v47
  v_add_f32 v39, v39, v47
  v_rcp_f32 v39, v39
  s_mov_b64 exec, s[28:29]
  v_mul_f32 v42, v42, v39
  v_mul_f32 v43, v43, v39
  v_cvt_pk_bf16_f32 v42, v42, v43
cB_sc1_pst:
  buffer_store_dword v42, v1, s[8:11], s20 offen sc1
  s_mov_b64 exec, -1
  s_barrier
  s_add_u32 s24, s24, 28672
  s_add_u32 s35, s35, 28672
  s_xor_b32 s25, s25, 28672
  s_add_u32 m0, s25, 7168
  s_nop 0
  buffer_load_dwordx4 v2, s[8:11], s24 offen offset:0 sc1 lds
  buffer_load_dwordx4 v2, s[8:11], s24 offen offset:1024 sc1 lds
  buffer_load_dwordx4 v2, s[8:11], s24 offen offset:2048 sc1 lds
  buffer_load_dwordx4 v2, s[8:11], s24 offen offset:3072 sc1 lds
  s_add_u32 m0, s25, 11264
  s_add_u32 s22, s24, 4096
  buffer_load_dwordx4 v2, s[8:11], s22 offen offset:0 sc1 lds
  buffer_load_dwordx4 v2, s[8:11], s22 offen offset:1024 sc1 lds
  buffer_load_dwordx4 v2, s[8:11], s22 offen offset:2048 sc1 lds
  v_xor_b32 v116, 28672, v116
  v_add_u32 v117, s57, v117
  s_sub_u32 s57, 0, s57
  s_add_u32 s19, s19, 1
  s_mov_b32 s20, s21
  s_cmp_lt_u32 s19, 63
  s_cbranch_scc1 cB_sc1_loop
  s_branch cB_done
cB_sc1_slow:
  v_max_f32 v50, v36, v44
  s_nop 1
  v_max_f32_dpp v50, v50, v50 quad_perm:[1,0,3,2] row_mask:0xf bank_mask:0xf
  s_nop 1
  v_max_f32_dpp v50, v50, v50 quad_perm:[2,3,0,1] row_mask:0xf bank_mask:0xf
  s_nop 1
  v_max_f32_dpp v50, v50, v50 row_half_mirror row_mask:0xf bank_mask:0xf
  s_nop 1
  v_max_f32_dpp v50, v50, v50 row_mirror row_mask:0xf bank_mask:0xf
  v_mov_b32 v47, v50
  s_nop 1
  v_permlane16_swap_b32 v50, v47
  v_max_f32 v50, v50, v47
  v_sub_f32 v48, v36, v50
  v_sub_f32 v49, v44, v50
  v_exp_f32 v48, v48
  v_exp_f32 v49, v49
  s_add_u32 s31, s31, 0x100
  v_fma_f32 v39, v49, s37, v48
  v_cndmask_b32 v41, v48, v49, s[38:39]
  s_nop 0
  v_add_f32_dpp v39, v39, v39 quad_perm:[1,0,3,2] row_mask:0xf bank_mask:0xf
  v_cndmask_b32 v40, v49, v48, s[38:39]
  v_mov_b32_dpp v46, v41 quad_perm:[1,0,3,2] row_mask:0xf bank_mask:0xf
  v_add_f32_dpp v39, v39, v39 quad_perm:[2,3,0,1] row_mask:0xf bank_mask:0xf
  v_cndmask_b32 v42, v46, v40, s[38:39]
  v_cndmask_b32 v43, v40, v46, s[38:39]
  v_add_f32_dpp v39, v39, v39 row_half_mirror row_mask:0xf bank_mask:0xf
  s_nop 1
  v_add_f32_dpp v47, v39, v39 row_mirror row_mask:0xf bank_mask:0xf
  v_add_f32_dpp v39, v39, v39 row_mirror row_mask:0xf bank_mask:0xf
  s_nop 1
  v_permlane16_swap_b32 v39, v47
  v_add_f32 v39, v39, v47
  v_rcp_f32 v39, v39
  s_mov_b64 exec, s[28:29]
  v_mul_f32 v42, v42, v39
  v_mul_f32 v43, v43, v39
  v_cvt_pk_bf16_f32 v42, v42, v43
  v_min_u32 v42, -2, v42
  s_branch cB_sc1_pst
cB_sc1_retry:
  s_cmp_lg_u32 s62, 0
  s_cbranch_scc1 cB_sc1_cont
  s_waitcnt vmcnt(0) lgkmcnt(0)
cB_sc1_rv:
  buffer_load_dwordx4 v[8:11], v2, s[8:11], s20 offen offset:0 sc1
  buffer_load_dwordx4 v[12:15], v2, s[8:11], s20 offen offset:1024 sc1
  buffer_load_dwordx4 v[16:19], v2, s[8:11], s20 offen offset:2048 sc1
  buffer_load_dwordx4 v[20:23], v2, s[8:11], s20 offen offset:3072 sc1
  buffer_load_dwordx4 v[24:27], v2, s[8:11], s23 offen offset:0 sc1
  buffer_load_dwordx4 v[28:31], v2, s[8:11], s23 offen offset:1024 sc1
  buffer_load_dwordx4 v[32:35], v2, s[8:11], s23 offen offset:2048 sc1
  s_waitcnt vmcnt(0)
  v_max3_u32 v118, v8, v9, v10
  v_max3_u32 v118, v118, v11, v12
  v_max3_u32 v118, v118, v13, v14
  v_max3_u32 v118, v118, v15, v16
  v_max3_u32 v118, v118, v17, v18
  v_max3_u32 v118, v118, v19, v20
  v_max3_u32 v118, v118, v21, v22
  v_max3_u32 v118, v118, v23, v24
  v_max3_u32 v118, v118, v25, v26
  v_max3_u32 v118, v118, v27, v28
  v_max3_u32 v118, v118, v29, v30
  v_max3_u32 v118, v118, v31, v32
  v_max3_u32 v118, v118, v33, v34
  v_max_u32 v118, v118, v35
  v_cmp_eq_u32 vcc, -1, v118
  s_cbranch_vccz cB_sc1_rk
  s_add_u32 s30, s30, 1
  s_cmp_lt_u32 s30, 400000
  s_cbranch_scc1 cB_sc1_rv
  s_branch cB_abort
cB_sc1_rk:
  s_mov_b32 s62, 1
  v_mov_b32 v36, 0
  v_mov_b32 v37, 0
  v_mov_b32 v38, 0
  v_mov_b32 v39, 0
  v_mov_b32 v40, 0
  v_mov_b32 v41, 0
  v_mov_b32 v42, 0
  v_mov_b32 v43, 0
  v_mov_b32 v44, 0
  v_mov_b32 v45, 0
  v_mov_b32 v46, 0
  v_mov_b32 v47, 0
  v_mov_b32 v48, 0
  v_mov_b32 v49, 0
  v_mov_b32 v50, 0
  v_mov_b32 v51, 0
  v_mov_b32 v52, 0
  v_mov_b32 v53, 0
  v_mov_b32 v54, 0
  v_mov_b32 v55, 0
  v_mov_b32 v56, 0
  v_mov_b32 v57, 0
  v_mov_b32 v58, 0
  v_mov_b32 v59, 0
  v_mov_b32 v60, 0
  v_mov_b32 v61, 0
  v_mov_b32 v62, 0
  v_mov_b32 v63, 0
  v_mov_b32 v88, 0
  v_mov_b32 v89, 0
  v_mov_b32 v90, 0
  v_mov_b32 v91, 0
  v_mov_b32 v92, 0
  v_mov_b32 v93, 0
  v_mov_b32 v94, 0
  v_mov_b32 v95, 0
  v_mov_b32 v64, 0
  v_mov_b32 v65, 0
  s_add_u32 s31, s31, 1
  ds_read_b128 v[96:99], v117 offset:0
  ds_read_b128 v[100:103], v117 offset:1024
  ds_read_b128 v[104:107], v117 offset:14336
  ds_read_b128 v[108:111], v117 offset:15360
  v_smfmac_f32_16x16x64_bf16 v[36:39], v[8:11], a[0:7], v3
  v_smfmac_f32_16x16x64_bf16 v[40:43], v[8:11], a[56:63], v3
  v_smfmac_f32_16x16x64_bf16 v[44:47], v[8:11], a[112:119], v3
  v_smfmac_f32_16x16x64_bf16 v[48:51], v[8:11], a[168:175], v3
  v_smfmac_f32_16x16x64_bf16 v[52:55], v[8:11], a[224:231], v3
  v_smfmac_f32_16x16x64_bf16 v[56:59], v[8:11], v[144:151], v3
  v_smfmac_f32_16x16x64_bf16 v[60:63], v[8:11], v[200:207], v3
  v_smfmac_f32_16x16x64_bf16 v[36:39], v[12:15], a[8:15], v3
  v_smfmac_f32_16x16x64_bf16 v[40:43], v[12:15], a[64:71], v3
  v_smfmac_f32_16x16x64_bf16 v[44:47], v[12:15], a[120:127], v3
  v_smfmac_f32_16x16x64_bf16 v[48:51], v[12:15], a[176:183], v3
  v_smfmac_f32_16x16x64_bf16 v[52:55], v[12:15], a[232:239], v3
  v_smfmac_f32_16x16x64_bf16 v[56:59], v[12:15], v[152:159], v3
  v_smfmac_f32_16x16x64_bf16 v[60:63], v[12:15], v[208:215], v3
  v_smfmac_f32_16x16x64_bf16 v[36:39], v[16:19], a[16:23], v3
  v_smfmac_f32_16x16x64_bf16 v[40:43], v[16:19], a[72:79], v3
  v_smfmac_f32_16x16x64_bf16 v[44:47], v[16:19], a[128:135], v3
  v_smfmac_f32_16x16x64_bf16 v[48:51], v[16:19], a[184:191], v3
  v_smfmac_f32_16x16x64_bf16 v[52:55], v[16:19], a[240:247], v3
  v_smfmac_f32_16x16x64_bf16 v[56:59], v[16:19], v[160:167], v3
  v_smfmac_f32_16x16x64_bf16 v[60:63], v[16:19], v[216:223], v3
  v_smfmac_f32_16x16x64_bf16 v[36:39], v[20:23], a[24:31], v3
  v_smfmac_f32_16x16x64_bf16 v[40:43], v[20:23], a[80:87], v3
  v_smfmac_f32_16x16x64_bf16 v[44:47], v[20:23], a[136:143], v3
  v_smfmac_f32_16x16x64_bf16 v[48:51], v[20:23], a[192:199], v3
  v_smfmac_f32_16x16x64_bf16 v[52:55], v[20:23], a[248:255], v3
  v_smfmac_f32_16x16x64_bf16 v[56:59], v[20:23], v[168:175], v3
  v_smfmac_f32_16x16x64_bf16 v[60:63], v[20:23], v[224:231], v3
  s_branch cB_sc1_ph2
.p2align 6

cB_sc2_loop:
  s_add_u32 s23, s20, 4096
  s_add_u32 s21, s20, 25600
  v_mov_b32 v48, 0
  v_mov_b32 v49, 0
  v_mov_b32 v50, 0
  v_mov_b32 v51, 0
  v_mov_b32 v52, 0
  v_mov_b32 v53, 0
  v_mov_b32 v54, 0
  v_mov_b32 v55, 0
  v_mov_b32 v56, 0
  v_mov_b32 v57, 0
  v_mov_b32 v58, 0
  v_mov_b32 v59, 0
  v_mov_b32 v60, 0
  v_mov_b32 v61, 0
  v_mov_b32 v62, 0
  v_mov_b32 v63, 0
  v_mov_b32 v88, 0
  v_mov_b32 v89, 0
  v_mov_b32 v90, 0
  v_mov_b32 v91, 0
  v_mov_b32 v92, 0
  v_mov_b32 v93, 0
  v_mov_b32 v94, 0
  v_mov_b32 v95, 0
  v_mov_b32 v66, 0
  v_mov_b32 v67, 0
  s_mov_b32 s30, 0
  s_mov_b32 s62, 0
  s_waitcnt vmcnt(0)
  s_barrier
cB_sc2_ld:
  buffer_load_dwordx4 v[8:11], v2, s[8:11], s20 offen offset:0 sc1
  v_mov_b32 v36, 0
  v_mov_b32 v37, 0
  v_mov_b32 v38, 0
  v_mov_b32 v39, 0
  buffer_load_dwordx4 v[12:15], v2, s[8:11], s20 offen offset:1024 sc1
  v_mov_b32 v40, 0
  v_mov_b32 v41, 0
  v_mov_b32 v42, 0
  v_mov_b32 v43, 0
  buffer_load_dwordx4 v[16:19], v2, s[8:11], s20 offen offset:2048 sc1
  v_mov_b32 v44, 0
  v_mov_b32 v45, 0
  v_mov_b32 v46, 0
  v_mov_b32 v47, 0
  ds_read_b128 v[96:99], v117 offset:0
  ds_read_b128 v[100:103], v117 offset:1024
  ds_read_b128 v[104:107], v117 offset:14336
  ds_read_b128 v[108:111], v117 offset:15360
  s_waitcnt vmcnt(2)
  v_smfmac_f32_16x16x64_bf16 v[36:39], v[8:11], a[0:7], v3
  v_smfmac_f32_16x16x64_bf16 v[40:43], v[8:11], a[56:63], v3
  buffer_load_dwordx4 v[20:23], v2, s[8:11], s20 offen offset:3072 sc1
  v_smfmac_f32_16x16x64_bf16 v[44:47], v[8:11], a[112:119], v3
  v_smfmac_f32_16x16x64_bf16 v[48:51], v[8:11], a[168:175], v3
  v_smfmac_f32_16x16x64_bf16 v[52:55], v[8:11], a[224:231], v3
  buffer_load_dwordx4 v[24:27], v2, s[8:11], s23 offen offset:0 sc1
  v_smfmac_f32_16x16x64_bf16 v[56:59], v[8:11], v[144:151], v3
  v_smfmac_f32_16x16x64_bf16 v[60:63], v[8:11], v[200:207], v3
  s_waitcnt vmcnt(3)
  v_smfmac_f32_16x16x64_bf16 v[36:39], v[12:15], a[8:15], v3
  v_smfmac_f32_16x16x64_bf16 v[40:43], v[12:15], a[64:71], v3
  buffer_load_dwordx4 v[28:31], v2, s[8:11], s23 offen offset:1024 sc1
  v_smfmac_f32_16x16x64_bf16 v[44:47], v[12:15], a[120:127], v3
  v_smfmac_f32_16x16x64_bf16 v[48:51], v[12:15], a[176:183], v3
  v_smfmac_f32_16x16x64_bf16 v[52:55], v[12:15], a[232:239], v3
  buffer_load_dwordx4 v[32:35], v2, s[8:11], s23 offen offset:2048 sc1
  v_smfmac_f32_16x16x64_bf16 v[56:59], v[12:15], v[152:159], v3
  v_smfmac_f32_16x16x64_bf16 v[60:63], v[12:15], v[208:215], v3
  s_waitcnt vmcnt(4)
  v_smfmac_f32_16x16x64_bf16 v[36:39], v[16:19], a[16:23], v3
  v_smfmac_f32_16x16x64_bf16 v[40:43], v[16:19], a[72:79], v3
  v_smfmac_f32_16x16x64_bf16 v[44:47], v[16:19], a[128:135], v3
  v_smfmac_f32_16x16x64_bf16 v[48:51], v[16:19], a[184:191], v3
  v_smfmac_f32_16x16x64_bf16 v[52:55], v[16:19], a[240:247], v3
  v_smfmac_f32_16x16x64_bf16 v[56:59], v[16:19], v[160:167], v3
  v_smfmac_f32_16x16x64_bf16 v[60:63], v[16:19], v[216:223], v3
  s_waitcnt vmcnt(3)
  v_smfmac_f32_16x16x64_bf16 v[36:39], v[20:23], a[24:31], v3
  v_smfmac_f32_16x16x64_bf16 v[40:43], v[20:23], a[80:87], v3
  v_smfmac_f32_16x16x64_bf16 v[44:47], v[20:23], a[136:143], v3
  v_smfmac_f32_16x16x64_bf16 v[48:51], v[20:23], a[192:199], v3
  v_smfmac_f32_16x16x64_bf16 v[52:55], v[20:23], a[248:255], v3
  v_smfmac_f32_16x16x64_bf16 v[56:59], v[20:23], v[168:175], v3
  v_smfmac_f32_16x16x64_bf16 v[60:63], v[20:23], v[224:231], v3
  s_waitcnt vmcnt(0)
cB_sc2_ph2:
  v_smfmac_f32_16x16x64_bf16 v[60:63], v[24:27], v[232:239], v3
  ds_read_b128 v[8:11], v116 offset:4096
  ds_read_b128 v[12:15], v116 offset:5120
  v_smfmac_f32_16x16x64_bf16 v[60:63], v[28:31], v[240:247], v3
  buffer_load_dword v119, v0, s[8:11], s24 offen sc1
  v_smfmac_f32_16x16x64_bf16 v[60:63], v[32:35], v[248:255], v3
  v_mov_b32 v80, v28
  v_smfmac_f32_16x16x64_bf16 v[52:55], v[24:27], v[120:127], v3
  v_mov_b32 v81, v29
  v_smfmac_f32_16x16x64_bf16 v[52:55], v[28:31], v[128:135], v3
  v_mov_b32 v82, v34
  v_smfmac_f32_16x16x64_bf16 v[52:55], v[32:35], v[136:143], v3
  v_cvt_pk_bf16_f32 v64, v60, v61
  v_smfmac_f32_16x16x64_bf16 v[56:59], v[24:27], v[176:183], v3
  v_cvt_pk_bf16_f32 v65, v62, v63
  v_smfmac_f32_16x16x64_bf16 v[56:59], v[28:31], v[184:191], v3
  v_mov_b32 v83, v35
  v_mfma_f32_16x16x32_bf16 v[68:71], v[64:67], v[4:7], 0
  v_smfmac_f32_16x16x64_bf16 v[56:59], v[32:35], v[192:199], v3
  v_cvt_pk_bf16_f32 v64, v52, v53
  v_smfmac_f32_16x16x64_bf16 v[36:39], v[24:27], a[32:39], v3
  v_cvt_pk_bf16_f32 v65, v54, v55
  v_smfmac_f32_16x16x64_bf16 v[36:39], v[28:31], a[40:47], v3
  v_cvt_pk_bf16_f32 v78, v68, v69
  v_smfmac_f32_16x16x64_bf16 v[36:39], v[32:35], a[48:55], v3
  v_cvt_pk_bf16_f32 v79, v70, v71
  v_cvt_pk_bf16_f32 v66, v56, v57
  v_smfmac_f32_16x16x64_bf16 v[40:43], v[24:27], a[88:95], v3
  v_cvt_pk_bf16_f32 v67, v58, v59
  v_smfmac_f32_16x16x64_bf16 v[40:43], v[28:31], a[96:103], v3
  v_mfma_f32_16x16x32_bf16 v[72:75], v[64:67], v[4:7], 0
  ds_read_b128 v[52:55], v116 offset:18432
  ds_read_b128 v[56:59], v116 offset:19456
  v_smfmac_f32_16x16x64_bf16 v[40:43], v[32:35], a[104:111], v3
  v_cvt_pk_bf16_f32 v64, v36, v37
  v_smfmac_f32_16x16x64_bf16 v[44:47], v[24:27], a[144:151], v3
  v_cvt_pk_bf16_f32 v65, v38, v39
  v_smfmac_f32_16x16x64_bf16 v[44:47], v[28:31], a[152:159], v3
  v_cvt_pk_bf16_f32 v76, v72, v73
  v_smfmac_f32_16x16x64_bf16 v[44:47], v[32:35], a[160:167], v3
  v_cvt_pk_bf16_f32 v77, v74, v75
  v_cvt_pk_bf16_f32 v66, v40, v41
  v_smfmac_f32_16x16x64_bf16 v[48:51], v[24:27], a[200:207], v3
  v_cvt_pk_bf16_f32 v67, v42, v43
  v_smfmac_f32_16x16x64_bf16 v[48:51], v[28:31], a[208:215], v3
  v_mfma_f32_16x16x32_bf16 v[68:71], v[64:67], v[4:7], 0
  v_smfmac_f32_16x16x64_bf16 v[48:51], v[32:35], a[216:223], v3
  v_cvt_pk_bf16_f32 v64, v44, v45
  v_mfma_f32_16x16x32_bf16 v[84:87], v[80:83], v[76:79], 0
  v_cvt_pk_bf16_f32 v65, v46, v47
  s_waitcnt lgkmcnt(0)
  v_smfmac_f32_16x16x64_bf16 v[88:91], v[76:79], v[96:103], v3
  v_cvt_pk_bf16_f32 v60, v68, v69
  v_cvt_pk_bf16_f32 v61, v70, v71
  v_cvt_pk_bf16_f32 v66, v48, v49
  v_cvt_pk_bf16_f32 v67, v50, v51
  s_nop 1
  v_mfma_f32_16x16x32_bf16 v[72:75], v[64:67], v[4:7], 0
  v_smfmac_f32_16x16x64_bf16 v[92:95], v[76:79], v[104:111], v3
  s_nop 4
  v_cvt_pk_bf16_f32 v62, v72, v73
  v_cvt_pk_bf16_f32 v63, v74, v75
  s_nop 1
  v_mfma_f32_16x16x32_bf16 v[84:87], v[16:19], v[60:63], v[84:87]
  v_smfmac_f32_16x16x64_bf16 v[88:91], v[60:63], v[8:15], v3
  v_smfmac_f32_16x16x64_bf16 v[92:95], v[60:63], v[52:59], v3
  s_nop 1
  v_permlane32_swap_b32 v84, v86
  v_permlane32_swap_b32 v85, v87
  s_nop 0
  v_cmp_u_f32 vcc, v88, v89
  v_add_f32_dpp v84, v86, v84 row_ror:8 row_mask:0xf bank_mask:0xf
  v_add_f32_dpp v85, v87, v85 row_ror:8 row_mask:0xf bank_mask:0xf
  v_permlane32_swap_b32 v88, v92
  v_permlane32_swap_b32 v89, v93
  ds_write2_b32 v113, v84, v85 offset0:0 offset1:4
  v_permlane32_swap_b32 v90, v94
  v_permlane32_swap_b32 v91, v95
  v_add_f32 v88, v88, v92
  v_add_f32 v89, v89, v93
  v_add_f32 v90, v90, v94
  v_add_f32 v91, v91, v95
  ds_write2_b64 v112, v[88:89], v[90:91] offset0:0 offset1:128
  s_cbranch_vccnz cB_sc2_retry
cB_sc2_cont:
  s_waitcnt lgkmcnt(0)
  s_barrier
  ds_read_b128 v[36:39], v114
  ds_read_b128 v[44:47], v115
  v_lshl_add_u32 v56, v2, 3, s36
  s_waitcnt lgkmcnt(0)
  v_add_f32 v36, v36, v38
  v_add_f32 v37, v37, v39
  v_add_f32 v44, v44, v45
  s_mov_b64 exec, 65535
  buffer_store_dword v2, v56, s[8:11], s20 offen sc1
  s_mov_b64 exec, -1
  v_add_f32 v46, v46, v47
  v_permlane32_swap_b32 v36, v37
  v_add_f32 v44, v44, v46
  v_add_f32 v36, v36, v37
  v_exp_f32 v49, v44
  v_exp_f32 v48, v36
  v_add_f32 v50, abs(v36), abs(v44)
  v_fma_f32 v39, v49, s37, v48
  v_cmp_ngt_f32 vcc, s56, v50
  v_cndmask_b32 v41, v48, v49, s[38:39]
  v_add_f32_dpp v39, v39, v39 quad_perm:[1,0,3,2] row_mask:0xf bank_mask:0xf
  v_cndmask_b32 v40, v49, v48, s[38:39]
  v_mov_b32_dpp v46, v41 quad_perm:[1,0,3,2] row_mask:0xf bank_mask:0xf
  v_add_f32_dpp v39, v39, v39 quad_perm:[2,3,0,1] row_mask:0xf bank_mask:0xf
  v_cndmask_b32 v42, v46, v40, s[38:39]
  v_cndmask_b32 v43, v40, v46, s[38:39]
  v_add_f32_dpp v39, v39, v39 row_half_mirror row_mask:0xf bank_mask:0xf
  s_cbranch_vccnz cB_sc2_slow
  s_nop 0
  v_add_f32_dpp v47, v39, v39 row_mirror row_mask:0xf bank_mask:0xf
  v_add_f32_dpp v39, v39, v39 row_mirror row_mask:0xf bank_mask:0xf
  s_nop 1
  v_permlane16_swap_b32 v39, v47
  v_add_f32 v39, v39, v47
  v_rcp_f32 v39, v39
  s_mov_b64 exec, s[28:29]
  v_mul_f32 v42, v42, v39
  v_mul_f32 v43, v43, v39
  v_cvt_pk_bf16_f32 v42, v42, v43
cB_sc2_pst:
  buffer_store_dword v42, v1, s[8:11], s20 offen sc1
  s_mov_b64 exec, -1
  s_barrier
  s_add_u32 s24, s24, 28672
  s_add_u32 s35, s35, 28672
  s_xor_b32 s25, s25, 28672
  s_add_u32 m0, s25, 14336
  s_nop 0
  buffer_load_dwordx4 v2, s[8:11], s24 offen offset:0 sc1 lds
  buffer_load_dwordx4 v2, s[8:11], s24 offen offset:1024 sc1 lds
  buffer_load_dwordx4 v2, s[8:11], s24 offen offset:2048 sc1 lds
  buffer_load_dwordx4 v2, s[8:11], s24 offen offset:3072 sc1 lds
  s_add_u32 m0, s25, 18432
  s_add_u32 s22, s24, 4096
  buffer_load_dwordx4 v2, s[8:11], s22 offen offset:0 sc1 lds
  buffer_load_dwordx4 v2, s[8:11], s22 offen offset:1024 sc1 lds
  buffer_load_dwordx4 v2, s[8:11], s22 offen offset:2048 sc1 lds
  v_xor_b32 v116, 28672, v116
  v_add_u32 v117, s57, v117
  s_sub_u32 s57, 0, s57
  s_add_u32 s19, s19, 1
  s_mov_b32 s20, s21
  s_cmp_lt_u32 s19, 63
  s_cbranch_scc1 cB_sc2_loop
  s_branch cB_done
cB_sc2_slow:
  v_max_f32 v50, v36, v44
  s_nop 1
  v_max_f32_dpp v50, v50, v50 quad_perm:[1,0,3,2] row_mask:0xf bank_mask:0xf
  s_nop 1
  v_max_f32_dpp v50, v50, v50 quad_perm:[2,3,0,1] row_mask:0xf bank_mask:0xf
  s_nop 1
  v_max_f32_dpp v50, v50, v50 row_half_mirror row_mask:0xf bank_mask:0xf
  s_nop 1
  v_max_f32_dpp v50, v50, v50 row_mirror row_mask:0xf bank_mask:0xf
  v_mov_b32 v47, v50
  s_nop 1
  v_permlane16_swap_b32 v50, v47
  v_max_f32 v50, v50, v47
  v_sub_f32 v48, v36, v50
  v_sub_f32 v49, v44, v50
  v_exp_f32 v48, v48
  v_exp_f32 v49, v49
  s_add_u32 s31, s31, 0x100
  v_fma_f32 v39, v49, s37, v48
  v_cndmask_b32 v41, v48, v49, s[38:39]
  s_nop 0
  v_add_f32_dpp v39, v39, v39 quad_perm:[1,0,3,2] row_mask:0xf bank_mask:0xf
  v_cndmask_b32 v40, v49, v48, s[38:39]
  v_mov_b32_dpp v46, v41 quad_perm:[1,0,3,2] row_mask:0xf bank_mask:0xf
  v_add_f32_dpp v39, v39, v39 quad_perm:[2,3,0,1] row_mask:0xf bank_mask:0xf
  v_cndmask_b32 v42, v46, v40, s[38:39]
  v_cndmask_b32 v43, v40, v46, s[38:39]
  v_add_f32_dpp v39, v39, v39 row_half_mirror row_mask:0xf bank_mask:0xf
  s_nop 1
  v_add_f32_dpp v47, v39, v39 row_mirror row_mask:0xf bank_mask:0xf
  v_add_f32_dpp v39, v39, v39 row_mirror row_mask:0xf bank_mask:0xf
  s_nop 1
  v_permlane16_swap_b32 v39, v47
  v_add_f32 v39, v39, v47
  v_rcp_f32 v39, v39
  s_mov_b64 exec, s[28:29]
  v_mul_f32 v42, v42, v39
  v_mul_f32 v43, v43, v39
  v_cvt_pk_bf16_f32 v42, v42, v43
  v_min_u32 v42, -2, v42
  s_branch cB_sc2_pst
cB_sc2_retry:
  s_cmp_lg_u32 s62, 0
  s_cbranch_scc1 cB_sc2_cont
  s_waitcnt vmcnt(0) lgkmcnt(0)
cB_sc2_rv:
  buffer_load_dwordx4 v[8:11], v2, s[8:11], s20 offen offset:0 sc1
  buffer_load_dwordx4 v[12:15], v2, s[8:11], s20 offen offset:1024 sc1
  buffer_load_dwordx4 v[16:19], v2, s[8:11], s20 offen offset:2048 sc1
  buffer_load_dwordx4 v[20:23], v2, s[8:11], s20 offen offset:3072 sc1
  buffer_load_dwordx4 v[24:27], v2, s[8:11], s23 offen offset:0 sc1
  buffer_load_dwordx4 v[28:31], v2, s[8:11], s23 offen offset:1024 sc1
  buffer_load_dwordx4 v[32:35], v2, s[8:11], s23 offen offset:2048 sc1
  s_waitcnt vmcnt(0)
  v_max3_u32 v118, v8, v9, v10
  v_max3_u32 v118, v118, v11, v12
  v_max3_u32 v118, v118, v13, v14
  v_max3_u32 v118, v118, v15, v16
  v_max3_u32 v118, v118, v17, v18
  v_max3_u32 v118, v118, v19, v20
  v_max3_u32 v118, v118, v21, v22
  v_max3_u32 v118, v118, v23, v24
  v_max3_u32 v118, v118, v25, v26
  v_max3_u32 v118, v118, v27, v28
  v_max3_u32 v118, v118, v29, v30
  v_max3_u32 v118, v118, v31, v32
  v_max3_u32 v118, v118, v33, v34
  v_max_u32 v118, v118, v35
  v_cmp_eq_u32 vcc, -1, v118
  s_cbranch_vccz cB_sc2_rk
  s_add_u32 s30, s30, 1
  s_cmp_lt_u32 s30, 400000
  s_cbranch_scc1 cB_sc2_rv
  s_branch cB_abort
cB_sc2_rk:
  s_mov_b32 s62, 1
  v_mov_b32 v36, 0
  v_mov_b32 v37, 0
  v_mov_b32 v38, 0
  v_mov_b32 v39, 0
  v_mov_b32 v40, 0
  v_mov_b32 v41, 0
  v_mov_b32 v42, 0
  v_mov_b32 v43, 0
  v_mov_b32 v44, 0
  v_mov_b32 v45, 0
  v_mov_b32 v46, 0
  v_mov_b32 v47, 0
  v_mov_b32 v48, 0
  v_mov_b32 v49, 0
  v_mov_b32 v50, 0
  v_mov_b32 v51, 0
  v_mov_b32 v52, 0
  v_mov_b32 v53, 0
  v_mov_b32 v54, 0
  v_mov_b32 v55, 0
  v_mov_b32 v56, 0
  v_mov_b32 v57, 0
  v_mov_b32 v58, 0
  v_mov_b32 v59, 0
  v_mov_b32 v60, 0
  v_mov_b32 v61, 0
  v_mov_b32 v62, 0
  v_mov_b32 v63, 0
  v_mov_b32 v88, 0
  v_mov_b32 v89, 0
  v_mov_b32 v90, 0
  v_mov_b32 v91, 0
  v_mov_b32 v92, 0
  v_mov_b32 v93, 0
  v_mov_b32 v94, 0
  v_mov_b32 v95, 0
  v_mov_b32 v66, 0
  v_mov_b32 v67, 0
  s_add_u32 s31, s31, 1
  ds_read_b128 v[96:99], v117 offset:0
  ds_read_b128 v[100:103], v117 offset:1024
  ds_read_b128 v[104:107], v117 offset:14336
  ds_read_b128 v[108:111], v117 offset:15360
  v_smfmac_f32_16x16x64_bf16 v[36:39], v[8:11], a[0:7], v3
  v_smfmac_f32_16x16x64_bf16 v[40:43], v[8:11], a[56:63], v3
  v_smfmac_f32_16x16x64_bf16 v[44:47], v[8:11], a[112:119], v3
  v_smfmac_f32_16x16x64_bf16 v[48:51], v[8:11], a[168:175], v3
  v_smfmac_f32_16x16x64_bf16 v[52:55], v[8:11], a[224:231], v3
  v_smfmac_f32_16x16x64_bf16 v[56:59], v[8:11], v[144:151], v3
  v_smfmac_f32_16x16x64_bf16 v[60:63], v[8:11], v[200:207], v3
  v_smfmac_f32_16x16x64_bf16 v[36:39], v[12:15], a[8:15], v3
  v_smfmac_f32_16x16x64_bf16 v[40:43], v[12:15], a[64:71], v3
  v_smfmac_f32_16x16x64_bf16 v[44:47], v[12:15], a[120:127], v3
  v_smfmac_f32_16x16x64_bf16 v[48:51], v[12:15], a[176:183], v3
  v_smfmac_f32_16x16x64_bf16 v[52:55], v[12:15], a[232:239], v3
  v_smfmac_f32_16x16x64_bf16 v[56:59], v[12:15], v[152:159], v3
  v_smfmac_f32_16x16x64_bf16 v[60:63], v[12:15], v[208:215], v3
  v_smfmac_f32_16x16x64_bf16 v[36:39], v[16:19], a[16:23], v3
  v_smfmac_f32_16x16x64_bf16 v[40:43], v[16:19], a[72:79], v3
  v_smfmac_f32_16x16x64_bf16 v[44:47], v[16:19], a[128:135], v3
  v_smfmac_f32_16x16x64_bf16 v[48:51], v[16:19], a[184:191], v3
  v_smfmac_f32_16x16x64_bf16 v[52:55], v[16:19], a[240:247], v3
  v_smfmac_f32_16x16x64_bf16 v[56:59], v[16:19], v[160:167], v3
  v_smfmac_f32_16x16x64_bf16 v[60:63], v[16:19], v[216:223], v3
  v_smfmac_f32_16x16x64_bf16 v[36:39], v[20:23], a[24:31], v3
  v_smfmac_f32_16x16x64_bf16 v[40:43], v[20:23], a[80:87], v3
  v_smfmac_f32_16x16x64_bf16 v[44:47], v[20:23], a[136:143], v3
  v_smfmac_f32_16x16x64_bf16 v[48:51], v[20:23], a[192:199], v3
  v_smfmac_f32_16x16x64_bf16 v[52:55], v[20:23], a[248:255], v3
  v_smfmac_f32_16x16x64_bf16 v[56:59], v[20:23], v[168:175], v3
  v_smfmac_f32_16x16x64_bf16 v[60:63], v[20:23], v[224:231], v3
  s_branch cB_sc2_ph2
.p2align 6

cB_sc3_loop:
  s_add_u32 s23, s20, 4096
  s_add_u32 s21, s20, 25600
  v_mov_b32 v48, 0
  v_mov_b32 v49, 0
  v_mov_b32 v50, 0
  v_mov_b32 v51, 0
  v_mov_b32 v52, 0
  v_mov_b32 v53, 0
  v_mov_b32 v54, 0
  v_mov_b32 v55, 0
  v_mov_b32 v56, 0
  v_mov_b32 v57, 0
  v_mov_b32 v58, 0
  v_mov_b32 v59, 0
  v_mov_b32 v60, 0
  v_mov_b32 v61, 0
  v_mov_b32 v62, 0
  v_mov_b32 v63, 0
  v_mov_b32 v88, 0
  v_mov_b32 v89, 0
  v_mov_b32 v90, 0
  v_mov_b32 v91, 0
  v_mov_b32 v92, 0
  v_mov_b32 v93, 0
  v_mov_b32 v94, 0
  v_mov_b32 v95, 0
  v_mov_b32 v64, 0
  v_mov_b32 v65, 0
  s_mov_b32 s30, 0
  s_mov_b32 s62, 0
  s_waitcnt vmcnt(0)
  s_barrier
cB_sc3_ld:
  buffer_load_dwordx4 v[8:11], v2, s[8:11], s20 offen offset:0 sc1
  v_mov_b32 v36, 0
  v_mov_b32 v37, 0
  v_mov_b32 v38, 0
  v_mov_b32 v39, 0
  buffer_load_dwordx4 v[12:15], v2, s[8:11], s20 offen offset:1024 sc1
  v_mov_b32 v40, 0
  v_mov_b32 v41, 0
  v_mov_b32 v42, 0
  v_mov_b32 v43, 0
  buffer_load_dwordx4 v[16:19], v2, s[8:11], s20 offen offset:2048 sc1
  v_mov_b32 v44, 0
  v_mov_b32 v45, 0
  v_mov_b32 v46, 0
  v_mov_b32 v47, 0
  ds_read_b128 v[96:99], v117 offset:0
  ds_read_b128 v[100:103], v117 offset:1024
  ds_read_b128 v[104:107], v117 offset:14336
  ds_read_b128 v[108:111], v117 offset:15360
  s_waitcnt vmcnt(2)
  v_smfmac_f32_16x16x64_bf16 v[36:39], v[8:11], a[0:7], v3
  v_smfmac_f32_16x16x64_bf16 v[40:43], v[8:11], a[56:63], v3
  buffer_load_dwordx4 v[20:23], v2, s[8:11], s20 offen offset:3072 sc1
  v_smfmac_f32_16x16x64_bf16 v[44:47], v[8:11], a[112:119], v3
  v_smfmac_f32_16x16x64_bf16 v[48:51], v[8:11], a[168:175], v3
  v_smfmac_f32_16x16x64_bf16 v[52:55], v[8:11], a[224:231], v3
  buffer_load_dwordx4 v[24:27], v2, s[8:11], s23 offen offset:0 sc1
  v_smfmac_f32_16x16x64_bf16 v[56:59], v[8:11], v[144:151], v3
  v_smfmac_f32_16x16x64_bf16 v[60:63], v[8:11], v[200:207], v3
  s_waitcnt vmcnt(3)
  v_smfmac_f32_16x16x64_bf16 v[36:39], v[12:15], a[8:15], v3
  v_smfmac_f32_16x16x64_bf16 v[40:43], v[12:15], a[64:71], v3
  buffer_load_dwordx4 v[28:31], v2, s[8:11], s23 offen offset:1024 sc1
  v_smfmac_f32_16x16x64_bf16 v[44:47], v[12:15], a[120:127], v3
  v_smfmac_f32_16x16x64_bf16 v[48:51], v[12:15], a[176:183], v3
  v_smfmac_f32_16x16x64_bf16 v[52:55], v[12:15], a[232:239], v3
  buffer_load_dwordx4 v[32:35], v2, s[8:11], s23 offen offset:2048 sc1
  v_smfmac_f32_16x16x64_bf16 v[56:59], v[12:15], v[152:159], v3
  v_smfmac_f32_16x16x64_bf16 v[60:63], v[12:15], v[208:215], v3
  s_waitcnt vmcnt(4)
  v_smfmac_f32_16x16x64_bf16 v[36:39], v[16:19], a[16:23], v3
  v_smfmac_f32_16x16x64_bf16 v[40:43], v[16:19], a[72:79], v3
  v_smfmac_f32_16x16x64_bf16 v[44:47], v[16:19], a[128:135], v3
  v_smfmac_f32_16x16x64_bf16 v[48:51], v[16:19], a[184:191], v3
  v_smfmac_f32_16x16x64_bf16 v[52:55], v[16:19], a[240:247], v3
  v_smfmac_f32_16x16x64_bf16 v[56:59], v[16:19], v[160:167], v3
  v_smfmac_f32_16x16x64_bf16 v[60:63], v[16:19], v[216:223], v3
  s_waitcnt vmcnt(3)
  v_smfmac_f32_16x16x64_bf16 v[36:39], v[20:23], a[24:31], v3
  v_smfmac_f32_16x16x64_bf16 v[40:43], v[20:23], a[80:87], v3
  v_smfmac_f32_16x16x64_bf16 v[44:47], v[20:23], a[136:143], v3
  v_smfmac_f32_16x16x64_bf16 v[48:51], v[20:23], a[192:199], v3
  v_smfmac_f32_16x16x64_bf16 v[52:55], v[20:23], a[248:255], v3
  v_smfmac_f32_16x16x64_bf16 v[56:59], v[20:23], v[168:175], v3
  v_smfmac_f32_16x16x64_bf16 v[60:63], v[20:23], v[224:231], v3
  s_waitcnt vmcnt(0)
cB_sc3_ph2:
  v_smfmac_f32_16x16x64_bf16 v[60:63], v[24:27], v[232:239], v3
  ds_read_b128 v[8:11], v116 offset:6144
  ds_read_b128 v[12:15], v116 offset:7168
  v_smfmac_f32_16x16x64_bf16 v[60:63], v[28:31], v[240:247], v3
  v_smfmac_f32_16x16x64_bf16 v[60:63], v[32:35], v[248:255], v3
  v_mov_b32 v80, v30
  v_smfmac_f32_16x16x64_bf16 v[52:55], v[24:27], v[120:127], v3
  v_mov_b32 v81, v31
  v_smfmac_f32_16x16x64_bf16 v[52:55], v[28:31], v[128:135], v3
  v_mov_b32 v82, v34
  v_smfmac_f32_16x16x64_bf16 v[52:55], v[32:35], v[136:143], v3
  v_cvt_pk_bf16_f32 v66, v60, v61
  v_smfmac_f32_16x16x64_bf16 v[56:59], v[24:27], v[176:183], v3
  v_cvt_pk_bf16_f32 v67, v62, v63
  v_smfmac_f32_16x16x64_bf16 v[56:59], v[28:31], v[184:191], v3
  v_mov_b32 v83, v35
  v_mfma_f32_16x16x32_bf16 v[68:71], v[64:67], v[4:7], 0
  v_smfmac_f32_16x16x64_bf16 v[56:59], v[32:35], v[192:199], v3
  v_cvt_pk_bf16_f32 v64, v52, v53
  v_smfmac_f32_16x16x64_bf16 v[36:39], v[24:27], a[32:39], v3
  v_cvt_pk_bf16_f32 v65, v54, v55
  v_smfmac_f32_16x16x64_bf16 v[36:39], v[28:31], a[40:47], v3
  v_cvt_pk_bf16_f32 v78, v68, v69
  v_smfmac_f32_16x16x64_bf16 v[36:39], v[32:35], a[48:55], v3
  v_cvt_pk_bf16_f32 v79, v70, v71
  v_cvt_pk_bf16_f32 v66, v56, v57
  v_smfmac_f32_16x16x64_bf16 v[40:43], v[24:27], a[88:95], v3
  v_cvt_pk_bf16_f32 v67, v58, v59
  v_smfmac_f32_16x16x64_bf16 v[40:43], v[28:31], a[96:103], v3
  v_mfma_f32_16x16x32_bf16 v[72:75], v[64:67], v[4:7], 0
  ds_read_b128 v[52:55], v116 offset:20480
  ds_read_b128 v[56:59], v116 offset:21504
  v_smfmac_f32_16x16x64_bf16 v[40:43], v[32:35], a[104:111], v3
  v_cvt_pk_bf16_f32 v64, v36, v37
  v_smfmac_f32_16x16x64_bf16 v[44:47], v[24:27], a[144:151], v3
  v_cvt_pk_bf16_f32 v65, v38, v39
  v_smfmac_f32_16x16x64_bf16 v[44:47], v[28:31], a[152:159], v3
  v_cvt_pk_bf16_f32 v76, v72, v73
  v_smfmac_f32_16x16x64_bf16 v[44:47], v[32:35], a[160:167], v3
  v_cvt_pk_bf16_f32 v77, v74, v75
  v_cvt_pk_bf16_f32 v66, v40, v41
  v_smfmac_f32_16x16x64_bf16 v[48:51], v[24:27], a[200:207], v3
  v_cvt_pk_bf16_f32 v67, v42, v43
  v_smfmac_f32_16x16x64_bf16 v[48:51], v[28:31], a[208:215], v3
  v_mfma_f32_16x16x32_bf16 v[68:71], v[64:67], v[4:7], 0
  v_smfmac_f32_16x16x64_bf16 v[48:51], v[32:35], a[216:223], v3
  v_cvt_pk_bf16_f32 v64, v44, v45
  v_mfma_f32_16x16x32_bf16 v[84:87], v[80:83], v[76:79], 0
  v_cvt_pk_bf16_f32 v65, v46, v47
  s_waitcnt lgkmcnt(0)
  v_smfmac_f32_16x16x64_bf16 v[88:91], v[76:79], v[96:103], v3
  v_cvt_pk_bf16_f32 v60, v68, v69
  v_cvt_pk_bf16_f32 v61, v70, v71
  v_cvt_pk_bf16_f32 v66, v48, v49
  v_cvt_pk_bf16_f32 v67, v50, v51
  s_nop 1
  v_mfma_f32_16x16x32_bf16 v[72:75], v[64:67], v[4:7], 0
  v_smfmac_f32_16x16x64_bf16 v[92:95], v[76:79], v[104:111], v3
  s_nop 4
  v_cvt_pk_bf16_f32 v62, v72, v73
  v_cvt_pk_bf16_f32 v63, v74, v75
  s_nop 1
  v_mfma_f32_16x16x32_bf16 v[84:87], v[20:23], v[60:63], v[84:87]
  v_smfmac_f32_16x16x64_bf16 v[88:91], v[60:63], v[8:15], v3
  v_smfmac_f32_16x16x64_bf16 v[92:95], v[60:63], v[52:59], v3
  s_nop 1
  v_permlane32_swap_b32 v84, v86
  v_permlane32_swap_b32 v85, v87
  s_nop 0
  v_cmp_u_f32 vcc, v88, v89
  v_add_f32_dpp v84, v86, v84 row_ror:8 row_mask:0xf bank_mask:0xf
  v_add_f32_dpp v85, v87, v85 row_ror:8 row_mask:0xf bank_mask:0xf
  v_permlane32_swap_b32 v88, v92
  v_permlane32_swap_b32 v89, v93
  ds_write2_b32 v113, v84, v85 offset0:0 offset1:4
  v_permlane32_swap_b32 v90, v94
  v_permlane32_swap_b32 v91, v95
  v_add_f32 v88, v88, v92
  v_add_f32 v89, v89, v93
  v_add_f32 v90, v90, v94
  v_add_f32 v91, v91, v95
  ds_write2_b64 v112, v[88:89], v[90:91] offset0:0 offset1:128
  s_cbranch_vccnz cB_sc3_retry
cB_sc3_cont:
  s_waitcnt lgkmcnt(0)
  s_barrier
  ds_read_b128 v[36:39], v114
  ds_read_b128 v[44:47], v115
  s_waitcnt lgkmcnt(0)
  v_add_f32 v36, v36, v38
  v_add_f32 v37, v37, v39
  v_add_f32 v44, v44, v45
  v_add_f32 v46, v46, v47
  v_permlane32_swap_b32 v36, v37
  v_add_f32 v44, v44, v46
  v_add_f32 v36, v36, v37
  v_exp_f32 v49, v44
  v_exp_f32 v48, v36
  v_add_f32 v50, abs(v36), abs(v44)
  v_fma_f32 v39, v49, s37, v48
  v_cmp_ngt_f32 vcc, s56, v50
  v_cndmask_b32 v41, v48, v49, s[38:39]
  v_add_f32_dpp v39, v39, v39 quad_perm:[1,0,3,2] row_mask:0xf bank_mask:0xf
  v_cndmask_b32 v40, v49, v48, s[38:39]
  v_mov_b32_dpp v46, v41 quad_perm:[1,0,3,2] row_mask:0xf bank_mask:0xf
  v_add_f32_dpp v39, v39, v39 quad_perm:[2,3,0,1] row_mask:0xf bank_mask:0xf
  v_cndmask_b32 v42, v46, v40, s[38:39]
  v_cndmask_b32 v43, v40, v46, s[38:39]
  v_add_f32_dpp v39, v39, v39 row_half_mirror row_mask:0xf bank_mask:0xf
  s_cbranch_vccnz cB_sc3_slow
  s_nop 0
  v_add_f32_dpp v47, v39, v39 row_mirror row_mask:0xf bank_mask:0xf
  v_add_f32_dpp v39, v39, v39 row_mirror row_mask:0xf bank_mask:0xf
  s_nop 1
  v_permlane16_swap_b32 v39, v47
  v_add_f32 v39, v39, v47
  v_rcp_f32 v39, v39
  s_mov_b64 exec, s[28:29]
  v_mul_f32 v42, v42, v39
  v_mul_f32 v43, v43, v39
  v_cvt_pk_bf16_f32 v42, v42, v43
cB_sc3_pst:
  buffer_store_dword v42, v1, s[8:11], s20 offen sc1
  s_mov_b64 exec, -1
  s_barrier
  s_add_u32 s24, s24, 28672
  s_add_u32 s35, s35, 28672
  s_xor_b32 s25, s25, 28672
  s_add_u32 m0, s25, 21504
  s_nop 0
  buffer_load_dwordx4 v2, s[8:11], s24 offen offset:0 sc1 lds
  buffer_load_dwordx4 v2, s[8:11], s24 offen offset:1024 sc1 lds
  buffer_load_dwordx4 v2, s[8:11], s24 offen offset:2048 sc1 lds
  buffer_load_dwordx4 v2, s[8:11], s24 offen offset:3072 sc1 lds
  s_add_u32 m0, s25, 25600
  s_add_u32 s22, s24, 4096
  buffer_load_dwordx4 v2, s[8:11], s22 offen offset:0 sc1 lds
  buffer_load_dwordx4 v2, s[8:11], s22 offen offset:1024 sc1 lds
  buffer_load_dwordx4 v2, s[8:11], s22 offen offset:2048 sc1 lds
  v_xor_b32 v116, 28672, v116
  v_add_u32 v117, s57, v117
  s_sub_u32 s57, 0, s57
  s_add_u32 s19, s19, 1
  s_mov_b32 s20, s21
  s_cmp_lt_u32 s19, 63
  s_cbranch_scc1 cB_sc3_loop
  s_branch cB_done
cB_sc3_slow:
  v_max_f32 v50, v36, v44
  s_nop 1
  v_max_f32_dpp v50, v50, v50 quad_perm:[1,0,3,2] row_mask:0xf bank_mask:0xf
  s_nop 1
  v_max_f32_dpp v50, v50, v50 quad_perm:[2,3,0,1] row_mask:0xf bank_mask:0xf
  s_nop 1
  v_max_f32_dpp v50, v50, v50 row_half_mirror row_mask:0xf bank_mask:0xf
  s_nop 1
  v_max_f32_dpp v50, v50, v50 row_mirror row_mask:0xf bank_mask:0xf
  v_mov_b32 v47, v50
  s_nop 1
  v_permlane16_swap_b32 v50, v47
  v_max_f32 v50, v50, v47
  v_sub_f32 v48, v36, v50
  v_sub_f32 v49, v44, v50
  v_exp_f32 v48, v48
  v_exp_f32 v49, v49
  s_add_u32 s31, s31, 0x100
  v_fma_f32 v39, v49, s37, v48
  v_cndmask_b32 v41, v48, v49, s[38:39]
  s_nop 0
  v_add_f32_dpp v39, v39, v39 quad_perm:[1,0,3,2] row_mask:0xf bank_mask:0xf
  v_cndmask_b32 v40, v49, v48, s[38:39]
  v_mov_b32_dpp v46, v41 quad_perm:[1,0,3,2] row_mask:0xf bank_mask:0xf
  v_add_f32_dpp v39, v39, v39 quad_perm:[2,3,0,1] row_mask:0xf bank_mask:0xf
  v_cndmask_b32 v42, v46, v40, s[38:39]
  v_cndmask_b32 v43, v40, v46, s[38:39]
  v_add_f32_dpp v39, v39, v39 row_half_mirror row_mask:0xf bank_mask:0xf
  s_nop 1
  v_add_f32_dpp v47, v39, v39 row_mirror row_mask:0xf bank_mask:0xf
  v_add_f32_dpp v39, v39, v39 row_mirror row_mask:0xf bank_mask:0xf
  s_nop 1
  v_permlane16_swap_b32 v39, v47
  v_add_f32 v39, v39, v47
  v_rcp_f32 v39, v39
  s_mov_b64 exec, s[28:29]
  v_mul_f32 v42, v42, v39
  v_mul_f32 v43, v43, v39
  v_cvt_pk_bf16_f32 v42, v42, v43
  v_min_u32 v42, -2, v42
  s_branch cB_sc3_pst
cB_sc3_retry:
  s_cmp_lg_u32 s62, 0
  s_cbranch_scc1 cB_sc3_cont
  s_waitcnt vmcnt(0) lgkmcnt(0)
cB_sc3_rv:
  buffer_load_dwordx4 v[8:11], v2, s[8:11], s20 offen offset:0 sc1
  buffer_load_dwordx4 v[12:15], v2, s[8:11], s20 offen offset:1024 sc1
  buffer_load_dwordx4 v[16:19], v2, s[8:11], s20 offen offset:2048 sc1
  buffer_load_dwordx4 v[20:23], v2, s[8:11], s20 offen offset:3072 sc1
  buffer_load_dwordx4 v[24:27], v2, s[8:11], s23 offen offset:0 sc1
  buffer_load_dwordx4 v[28:31], v2, s[8:11], s23 offen offset:1024 sc1
  buffer_load_dwordx4 v[32:35], v2, s[8:11], s23 offen offset:2048 sc1
  s_waitcnt vmcnt(0)
  v_max3_u32 v118, v8, v9, v10
  v_max3_u32 v118, v118, v11, v12
  v_max3_u32 v118, v118, v13, v14
  v_max3_u32 v118, v118, v15, v16
  v_max3_u32 v118, v118, v17, v18
  v_max3_u32 v118, v118, v19, v20
  v_max3_u32 v118, v118, v21, v22
  v_max3_u32 v118, v118, v23, v24
  v_max3_u32 v118, v118, v25, v26
  v_max3_u32 v118, v118, v27, v28
  v_max3_u32 v118, v118, v29, v30
  v_max3_u32 v118, v118, v31, v32
  v_max3_u32 v118, v118, v33, v34
  v_max_u32 v118, v118, v35
  v_cmp_eq_u32 vcc, -1, v118
  s_cbranch_vccz cB_sc3_rk
  s_add_u32 s30, s30, 1
  s_cmp_lt_u32 s30, 400000
  s_cbranch_scc1 cB_sc3_rv
  s_branch cB_abort
cB_sc3_rk:
  s_mov_b32 s62, 1
  v_mov_b32 v36, 0
  v_mov_b32 v37, 0
  v_mov_b32 v38, 0
  v_mov_b32 v39, 0
  v_mov_b32 v40, 0
  v_mov_b32 v41, 0
  v_mov_b32 v42, 0
  v_mov_b32 v43, 0
  v_mov_b32 v44, 0
  v_mov_b32 v45, 0
  v_mov_b32 v46, 0
  v_mov_b32 v47, 0
  v_mov_b32 v48, 0
  v_mov_b32 v49, 0
  v_mov_b32 v50, 0
  v_mov_b32 v51, 0
  v_mov_b32 v52, 0
  v_mov_b32 v53, 0
  v_mov_b32 v54, 0
  v_mov_b32 v55, 0
  v_mov_b32 v56, 0
  v_mov_b32 v57, 0
  v_mov_b32 v58, 0
  v_mov_b32 v59, 0
  v_mov_b32 v60, 0
  v_mov_b32 v61, 0
  v_mov_b32 v62, 0
  v_mov_b32 v63, 0
  v_mov_b32 v88, 0
  v_mov_b32 v89, 0
  v_mov_b32 v90, 0
  v_mov_b32 v91, 0
  v_mov_b32 v92, 0
  v_mov_b32 v93, 0
  v_mov_b32 v94, 0
  v_mov_b32 v95, 0
  v_mov_b32 v64, 0
  v_mov_b32 v65, 0
  s_add_u32 s31, s31, 1
  ds_read_b128 v[96:99], v117 offset:0
  ds_read_b128 v[100:103], v117 offset:1024
  ds_read_b128 v[104:107], v117 offset:14336
  ds_read_b128 v[108:111], v117 offset:15360
  v_smfmac_f32_16x16x64_bf16 v[36:39], v[8:11], a[0:7], v3
  v_smfmac_f32_16x16x64_bf16 v[40:43], v[8:11], a[56:63], v3
  v_smfmac_f32_16x16x64_bf16 v[44:47], v[8:11], a[112:119], v3
  v_smfmac_f32_16x16x64_bf16 v[48:51], v[8:11], a[168:175], v3
  v_smfmac_f32_16x16x64_bf16 v[52:55], v[8:11], a[224:231], v3
  v_smfmac_f32_16x16x64_bf16 v[56:59], v[8:11], v[144:151], v3
  v_smfmac_f32_16x16x64_bf16 v[60:63], v[8:11], v[200:207], v3
  v_smfmac_f32_16x16x64_bf16 v[36:39], v[12:15], a[8:15], v3
  v_smfmac_f32_16x16x64_bf16 v[40:43], v[12:15], a[64:71], v3
  v_smfmac_f32_16x16x64_bf16 v[44:47], v[12:15], a[120:127], v3
  v_smfmac_f32_16x16x64_bf16 v[48:51], v[12:15], a[176:183], v3
  v_smfmac_f32_16x16x64_bf16 v[52:55], v[12:15], a[232:239], v3
  v_smfmac_f32_16x16x64_bf16 v[56:59], v[12:15], v[152:159], v3
  v_smfmac_f32_16x16x64_bf16 v[60:63], v[12:15], v[208:215], v3
  v_smfmac_f32_16x16x64_bf16 v[36:39], v[16:19], a[16:23], v3
  v_smfmac_f32_16x16x64_bf16 v[40:43], v[16:19], a[72:79], v3
  v_smfmac_f32_16x16x64_bf16 v[44:47], v[16:19], a[128:135], v3
  v_smfmac_f32_16x16x64_bf16 v[48:51], v[16:19], a[184:191], v3
  v_smfmac_f32_16x16x64_bf16 v[52:55], v[16:19], a[240:247], v3
  v_smfmac_f32_16x16x64_bf16 v[56:59], v[16:19], v[160:167], v3
  v_smfmac_f32_16x16x64_bf16 v[60:63], v[16:19], v[216:223], v3
  v_smfmac_f32_16x16x64_bf16 v[36:39], v[20:23], a[24:31], v3
  v_smfmac_f32_16x16x64_bf16 v[40:43], v[20:23], a[80:87], v3
  v_smfmac_f32_16x16x64_bf16 v[44:47], v[20:23], a[136:143], v3
  v_smfmac_f32_16x16x64_bf16 v[48:51], v[20:23], a[192:199], v3
  v_smfmac_f32_16x16x64_bf16 v[52:55], v[20:23], a[248:255], v3
  v_smfmac_f32_16x16x64_bf16 v[56:59], v[20:23], v[168:175], v3
  v_smfmac_f32_16x16x64_bf16 v[60:63], v[20:23], v[224:231], v3
  s_branch cB_sc3_ph2
.p2align 6

cB_va0_loop:
  s_add_u32 s23, s20, 4096
  s_add_u32 s21, s20, 25600
  s_mov_b32 s30, 0
  s_cmp_lg_u32 s19, s38
  s_cbranch_scc1 cB_va0_vok
  s_branch cB_va0_voc
cB_va0_vow:
  s_nop 0
  buffer_load_dword v63, off, s[8:11], s35 sc1
  s_waitcnt vmcnt(0)
cB_va0_voc:
  v_readfirstlane_b32 s22, v63
  s_cmp_eq_u32 s22, 56
  s_cbranch_scc1 cB_va0_vod
  s_sleep 1
  s_add_u32 s30, s30, 1
  s_cmp_lt_u32 s30, 400000
  s_cbranch_scc1 cB_va0_vow
  s_branch cB_abort
cB_va0_vod:
  s_add_u32 s35, s35, 2048
  s_add_u32 s38, s19, 8
  s_and_b32 s38, s38, -8
  s_cmp_eq_u32 s19, 0
  s_cselect_b32 s38, 4, s38
cB_va0_vok:
  s_cmp_eq_u32 s19, 63
  s_cbranch_scc1 cB_done
  s_barrier
  s_add_u32 s22, s25, 0
  buffer_load_dwordx4 v[80:83], v6, s[8:11], s22 offen offset:0 sc1
  buffer_load_dwordx4 v[84:87], v6, s[8:11], s22 offen offset:1792 sc1
  s_add_u32 s22, s25, 3584
  buffer_load_dwordx4 v[88:91], v6, s[8:11], s22 offen offset:0 sc1
  buffer_load_dwordx4 v[92:95], v6, s[8:11], s22 offen offset:1792 sc1
  s_add_u32 s22, s25, 7168
  buffer_load_dwordx4 v[96:99], v6, s[8:11], s22 offen offset:0 sc1
  buffer_load_dwordx4 v[100:103], v6, s[8:11], s22 offen offset:1792 sc1
  s_add_u32 s22, s25, 10752
  buffer_load_dwordx4 v[104:107], v6, s[8:11], s22 offen offset:0 sc1
  buffer_load_dwordx4 v[108:111], v6, s[8:11], s22 offen offset:1792 sc1
  s_add_u32 s22, s25, 14336
  buffer_load_dwordx4 v[112:115], v6, s[8:11], s22 offen offset:0 sc1
  buffer_load_dwordx4 v[116:119], v6, s[8:11], s22 offen offset:1792 sc1
  s_add_u32 s22, s25, 17920
  buffer_load_dwordx4 v[120:123], v6, s[8:11], s22 offen offset:0 sc1
  buffer_load_dwordx4 v[124:127], v6, s[8:11], s22 offen offset:1792 sc1
  s_add_u32 s22, s25, 21504
  buffer_load_dwordx4 v[128:131], v6, s[8:11], s22 offen offset:0 sc1
  buffer_load_dwordx4 v[132:135], v6, s[8:11], s22 offen offset:1792 sc1
  s_add_u32 s22, s25, 25088
  buffer_load_dwordx4 v[136:139], v6, s[8:11], s22 offen offset:0 sc1
  buffer_load_dwordx4 v[140:143], v6, s[8:11], s22 offen offset:1792 sc1
  buffer_load_dword v63, off, s[8:11], s35 sc1
  s_barrier
  ds_read_b128 v[8:11], v2 offset:8192
  ds_read_b128 v[12:15], v2 offset:9216
  ds_read_b128 v[16:19], v2 offset:10240
  ds_read_b128 v[20:23], v2 offset:11264
  ds_read_b128 v[24:27], v2 offset:12288
  ds_read_b128 v[28:31], v2 offset:13312
  ds_read_b128 v[32:35], v2 offset:14336
  s_waitcnt lgkmcnt(0)
  v_smfmac_f32_16x16x64_bf16 v[36:39], v[8:11], a[0:7], v3
  v_smfmac_f32_16x16x64_bf16 v[36:39], v[12:15], a[8:15], v3
  v_smfmac_f32_16x16x64_bf16 v[36:39], v[16:19], a[16:23], v3
  v_smfmac_f32_16x16x64_bf16 v[36:39], v[20:23], a[24:31], v3
  v_smfmac_f32_16x16x64_bf16 v[36:39], v[24:27], a[32:39], v3
  v_smfmac_f32_16x16x64_bf16 v[36:39], v[28:31], a[40:47], v3
  v_smfmac_f32_16x16x64_bf16 v[36:39], v[32:35], a[48:55], v3
  v_smfmac_f32_16x16x64_bf16 v[40:43], v[8:11], a[56:63], v3
  v_smfmac_f32_16x16x64_bf16 v[40:43], v[12:15], a[64:71], v3
  v_smfmac_f32_16x16x64_bf16 v[40:43], v[16:19], a[72:79], v3
  v_smfmac_f32_16x16x64_bf16 v[40:43], v[20:23], a[80:87], v3
  v_smfmac_f32_16x16x64_bf16 v[40:43], v[24:27], a[88:95], v3
  v_smfmac_f32_16x16x64_bf16 v[40:43], v[28:31], a[96:103], v3
  v_smfmac_f32_16x16x64_bf16 v[40:43], v[32:35], a[104:111], v3
  v_smfmac_f32_16x16x64_bf16 v[44:47], v[8:11], a[112:119], v3
  v_smfmac_f32_16x16x64_bf16 v[44:47], v[12:15], a[120:127], v3
  v_smfmac_f32_16x16x64_bf16 v[44:47], v[16:19], a[128:135], v3
  v_smfmac_f32_16x16x64_bf16 v[44:47], v[20:23], a[136:143], v3
  v_permlane32_swap_b32 v36, v40
  v_smfmac_f32_16x16x64_bf16 v[44:47], v[24:27], a[144:151], v3
  v_permlane32_swap_b32 v37, v41
  v_smfmac_f32_16x16x64_bf16 v[44:47], v[28:31], a[152:159], v3
  v_permlane32_swap_b32 v38, v42
  v_smfmac_f32_16x16x64_bf16 v[44:47], v[32:35], a[160:167], v3
  v_permlane32_swap_b32 v39, v43
  v_smfmac_f32_16x16x64_bf16 v[48:51], v[8:11], a[168:175], v3
  v_add_f32 v36, v36, v40
  v_smfmac_f32_16x16x64_bf16 v[48:51], v[12:15], a[176:183], v3
  v_add_f32 v37, v37, v41
  v_smfmac_f32_16x16x64_bf16 v[48:51], v[16:19], a[184:191], v3
  v_add_f32 v38, v38, v42
  v_smfmac_f32_16x16x64_bf16 v[48:51], v[20:23], a[192:199], v3
  v_add_f32 v39, v39, v43
  v_smfmac_f32_16x16x64_bf16 v[48:51], v[24:27], a[200:207], v3
  v_cvt_pk_bf16_f32 v40, v36, v37
  v_smfmac_f32_16x16x64_bf16 v[48:51], v[28:31], a[208:215], v3
  v_cvt_pk_bf16_f32 v41, v38, v39
  v_smfmac_f32_16x16x64_bf16 v[48:51], v[32:35], a[216:223], v3
  ds_write2_b32 v60, v40, v41 offset0:0 offset1:2
  v_smfmac_f32_16x16x64_bf16 v[52:55], v[8:11], a[224:231], v3
  v_smfmac_f32_16x16x64_bf16 v[52:55], v[12:15], a[232:239], v3
  v_smfmac_f32_16x16x64_bf16 v[52:55], v[16:19], a[240:247], v3
  v_smfmac_f32_16x16x64_bf16 v[52:55], v[20:23], a[248:255], v3
  v_permlane32_swap_b32 v44, v48
  v_smfmac_f32_16x16x64_bf16 v[52:55], v[24:27], v[176:183], v3
  v_permlane32_swap_b32 v45, v49
  v_smfmac_f32_16x16x64_bf16 v[52:55], v[28:31], v[184:191], v3
  v_permlane32_swap_b32 v46, v50
  v_smfmac_f32_16x16x64_bf16 v[52:55], v[32:35], v[192:199], v3
  v_permlane32_swap_b32 v47, v51
  v_smfmac_f32_16x16x64_bf16 v[56:59], v[8:11], v[200:207], v3
  v_add_f32 v44, v44, v48
  v_smfmac_f32_16x16x64_bf16 v[56:59], v[12:15], v[208:215], v3
  v_add_f32 v45, v45, v49
  v_smfmac_f32_16x16x64_bf16 v[56:59], v[16:19], v[216:223], v3
  v_add_f32 v46, v46, v50
  v_smfmac_f32_16x16x64_bf16 v[56:59], v[20:23], v[224:231], v3
  v_add_f32 v47, v47, v51
  v_smfmac_f32_16x16x64_bf16 v[56:59], v[24:27], v[232:239], v3
  v_cvt_pk_bf16_f32 v48, v44, v45
  v_smfmac_f32_16x16x64_bf16 v[56:59], v[28:31], v[240:247], v3
  v_cvt_pk_bf16_f32 v49, v46, v47
  v_smfmac_f32_16x16x64_bf16 v[56:59], v[32:35], v[248:255], v3
  ds_write2_b32 v61, v48, v49 offset0:0 offset1:2
  s_nop 6
  v_permlane32_swap_b32 v52, v56
  v_permlane32_swap_b32 v53, v57
  v_permlane32_swap_b32 v54, v58
  v_permlane32_swap_b32 v55, v59
  v_add_f32 v52, v52, v56
  v_add_f32 v53, v53, v57
  v_add_f32 v54, v54, v58
  v_add_f32 v55, v55, v59
  v_cvt_pk_bf16_f32 v56, v52, v53
  v_cvt_pk_bf16_f32 v57, v54, v55
  ds_write2_b32 v62, v56, v57 offset0:0 offset1:2
  s_cmp_eq_u32 s19, 63
  s_cbranch_scc1 cB_va0_last
  s_add_u32 s22, s20, 9216
  s_add_u32 s34, s20, 13312
  s_add_u32 s36, s20, 7168
  s_mov_b32 s37, 0
  v_mov_b32 v156, 0
  v_mov_b32 v157, 0
  v_mov_b32 v158, 0
  v_mov_b32 v159, 0
  buffer_load_dword v164, v4, s[8:11], s20 offen sc1
  s_nop 7
  buffer_load_dword v165, v4, s[8:11], s20 offen sc1
  s_nop 7
  buffer_load_dword v166, v4, s[8:11], s20 offen sc1
  s_nop 7
  buffer_load_dword v167, v4, s[8:11], s20 offen sc1
  s_nop 7
  buffer_load_dword v168, v4, s[8:11], s20 offen sc1
cB_va0_fw_l:
  s_waitcnt vmcnt(4)
  v_cmp_eq_u32 vcc, -1, v164
  s_cbranch_vccz cB_va0_fw_d
  buffer_load_dword v164, v4, s[8:11], s20 offen sc1
  s_waitcnt vmcnt(4)
  v_cmp_eq_u32 vcc, -1, v165
  s_cbranch_vccz cB_va0_fw_d
  buffer_load_dword v165, v4, s[8:11], s20 offen sc1
  s_waitcnt vmcnt(4)
  v_cmp_eq_u32 vcc, -1, v166
  s_cbranch_vccz cB_va0_fw_d
  buffer_load_dword v166, v4, s[8:11], s20 offen sc1
  s_waitcnt vmcnt(4)
  v_cmp_eq_u32 vcc, -1, v167
  s_cbranch_vccz cB_va0_fw_d
  buffer_load_dword v167, v4, s[8:11], s20 offen sc1
  s_waitcnt vmcnt(4)
  v_cmp_eq_u32 vcc, -1, v168
  s_cbranch_vccz cB_va0_fw_d
  buffer_load_dword v168, v4, s[8:11], s20 offen sc1
  s_add_u32 s30, s30, 1
  s_cmp_lt_u32 s30, 400000
  s_cbranch_scc1 cB_va0_fw_l
  s_branch cB_abort
cB_va0_fw_d:
  s_waitcnt lgkmcnt(0)
  buffer_load_dwordx4 v[8:11], v5, s[8:11], s22 offen offset:0 sc1
  v_mov_b32 v36, 0
  v_mov_b32 v37, 0
  v_mov_b32 v38, 0
  buffer_load_dwordx4 v[12:15], v5, s[8:11], s22 offen offset:1024 sc1
  v_mov_b32 v39, 0
  v_mov_b32 v40, 0
  v_mov_b32 v41, 0
  buffer_load_dwordx4 v[16:19], v5, s[8:11], s22 offen offset:2048 sc1
  v_mov_b32 v42, 0
  v_mov_b32 v43, 0
  v_mov_b32 v44, 0
  buffer_load_dwordx4 v[20:23], v5, s[8:11], s22 offen offset:3072 sc1
  v_mov_b32 v45, 0
  v_mov_b32 v46, 0
  v_mov_b32 v47, 0
  buffer_load_dwordx4 v[24:27], v5, s[8:11], s34 offen offset:0 sc1
  v_mov_b32 v48, 0
  v_mov_b32 v49, 0
  v_mov_b32 v50, 0
  buffer_load_dwordx4 v[28:31], v5, s[8:11], s34 offen offset:1024 sc1
  v_mov_b32 v51, 0
  v_mov_b32 v52, 0
  v_mov_b32 v53, 0
  buffer_load_dwordx4 v[32:35], v5, s[8:11], s34 offen offset:2048 sc1
  v_mov_b32 v54, 0
  v_mov_b32 v55, 0
  v_mov_b32 v56, 0
  buffer_load_dwordx4 v[144:147], v5, s[8:11], s34 offen offset:3072 sc1
  v_mov_b32 v57, 0
  v_mov_b32 v58, 0
  v_mov_b32 v59, 0
  buffer_load_dwordx4 v[148:151], v2, s[8:11], s36 offen offset:0 sc1
  buffer_load_dwordx4 v[152:155], v2, s[8:11], s36 offen offset:1024 sc1
  s_barrier
  ds_read_b128 v[64:67], v2 offset:0
  ds_read_b128 v[68:71], v2 offset:1024
  ds_read_b128 v[72:75], v2 offset:2048
  ds_read_b128 v[76:79], v2 offset:3072
  s_waitcnt vmcnt(9)
  v_smfmac_f32_16x16x64_bf16 v[156:159], v[8:11], v[80:87], v0
  s_waitcnt vmcnt(8)
  v_smfmac_f32_16x16x64_bf16 v[156:159], v[12:15], v[88:95], v0
  s_waitcnt vmcnt(7)
  v_smfmac_f32_16x16x64_bf16 v[156:159], v[16:19], v[96:103], v0
  s_waitcnt vmcnt(6)
  v_smfmac_f32_16x16x64_bf16 v[156:159], v[20:23], v[104:111], v0
  s_waitcnt vmcnt(5)
  v_smfmac_f32_16x16x64_bf16 v[156:159], v[24:27], v[112:119], v0
  s_mov_b32 exec_hi, 0
  buffer_store_dword v2, v7, s[8:11], s21 offen sc1
  s_mov_b64 exec, -1
  s_waitcnt vmcnt(5)
  v_smfmac_f32_16x16x64_bf16 v[156:159], v[28:31], v[120:127], v0
  s_waitcnt vmcnt(4)
  v_smfmac_f32_16x16x64_bf16 v[156:159], v[32:35], v[128:135], v0
  s_waitcnt vmcnt(3)
  v_smfmac_f32_16x16x64_bf16 v[156:159], v[144:147], v[136:143], v0
  s_waitcnt vmcnt(2) lgkmcnt(0)
  v_smfmac_f32_16x16x64_bf16 v[156:159], v[148:151], v[64:71], v0
  s_waitcnt vmcnt(1)
  v_smfmac_f32_16x16x64_bf16 v[156:159], v[152:155], v[72:79], v0
cB_va0_ep:
  s_nop 7
  v_add_f32 v160, v156, v157
  v_add_f32 v161, v158, v159
  v_cmp_u_f32 vcc, v160, v161
  v_mov_b32_dpp v162, v160 row_ror:8 row_mask:0xf bank_mask:0xf
  v_mov_b32_dpp v160, v161 row_ror:8 row_mask:0xf bank_mask:0xc
  s_cbranch_vccnz cB_va0_rp
  v_mov_b32_dpp v161, v162 quad_perm:[0,1,2,3] row_mask:0xf bank_mask:0x3
  v_cvt_pk_bf16_f32 v160, v160, v161
cB_va0_pc:
  buffer_store_dword v160, v1, s[8:11], s21 offen sc1
  s_cmp_lg_u32 s19, 62
  s_cbranch_scc1 cB_va0_nl
  s_mov_b32 s22, 88519680
  buffer_store_dword v160, v1, s[8:11], s22 offen sc1
  s_mov_b64 exec, -1
  s_branch cB_done
cB_va0_nl:
  s_mov_b64 exec, -1
  s_add_u32 s25, s25, 28672
  s_add_u32 s19, s19, 1
  s_mov_b32 s20, s21
  s_branch cB_va0_loop
cB_va0_last:
  s_waitcnt lgkmcnt(0)
  s_barrier
  s_branch cB_done
cB_va0_rp:
  s_cmp_eq_u32 s37, 0
  s_cbranch_scc1 cB_va0_rv
  v_mov_b32_dpp v161, v162 quad_perm:[0,1,2,3] row_mask:0xf bank_mask:0x3
  v_cvt_pk_bf16_f32 v160, v160, v161
  v_min_u32 v160, -2, v160
  s_branch cB_va0_pc
cB_va0_rv:
  buffer_load_dwordx4 v[8:11], v5, s[8:11], s22 offen offset:0 sc1
  buffer_load_dwordx4 v[12:15], v5, s[8:11], s22 offen offset:1024 sc1
  buffer_load_dwordx4 v[16:19], v5, s[8:11], s22 offen offset:2048 sc1
  buffer_load_dwordx4 v[20:23], v5, s[8:11], s22 offen offset:3072 sc1
  buffer_load_dwordx4 v[24:27], v5, s[8:11], s34 offen offset:0 sc1
  buffer_load_dwordx4 v[28:31], v5, s[8:11], s34 offen offset:1024 sc1
  buffer_load_dwordx4 v[32:35], v5, s[8:11], s34 offen offset:2048 sc1
  buffer_load_dwordx4 v[144:147], v5, s[8:11], s34 offen offset:3072 sc1
  buffer_load_dwordx4 v[148:151], v2, s[8:11], s36 offen offset:0 sc1
  buffer_load_dwordx4 v[152:155], v2, s[8:11], s36 offen offset:1024 sc1
  s_waitcnt vmcnt(0)
  v_max3_u32 v175, v8, v9, v10
  v_max3_u32 v175, v175, v11, v12
  v_max3_u32 v175, v175, v13, v14
  v_max3_u32 v175, v175, v15, v16
  v_max3_u32 v175, v175, v17, v18
  v_max3_u32 v175, v175, v19, v20
  v_max3_u32 v175, v175, v21, v22
  v_max3_u32 v175, v175, v23, v24
  v_max3_u32 v175, v175, v25, v26
  v_max3_u32 v175, v175, v27, v28
  v_max3_u32 v175, v175, v29, v30
  v_max3_u32 v175, v175, v31, v32
  v_max3_u32 v175, v175, v33, v34
  v_max3_u32 v175, v175, v35, v144
  v_max3_u32 v175, v175, v145, v146
  v_max3_u32 v175, v175, v147, v148
  v_max3_u32 v175, v175, v149, v150
  v_max3_u32 v175, v175, v151, v152
  v_max3_u32 v175, v175, v153, v154
  v_max_u32 v175, v175, v155
  v_cmp_eq_u32 vcc, -1, v175
  s_cbranch_vccz cB_va0_rk
  s_add_u32 s30, s30, 1
  s_cmp_lt_u32 s30, 400000
  s_cbranch_scc1 cB_va0_rv
  s_branch cB_abort
cB_va0_rk:
  s_mov_b32 s37, 1
  s_add_u32 s31, s31, 0x10000
  v_mov_b32 v156, 0
  v_mov_b32 v157, 0
  v_mov_b32 v158, 0
  v_mov_b32 v159, 0
  s_nop 1
  v_smfmac_f32_16x16x64_bf16 v[156:159], v[8:11], v[80:87], v0
  v_smfmac_f32_16x16x64_bf16 v[156:159], v[12:15], v[88:95], v0
  v_smfmac_f32_16x16x64_bf16 v[156:159], v[16:19], v[96:103], v0
  v_smfmac_f32_16x16x64_bf16 v[156:159], v[20:23], v[104:111], v0
  v_smfmac_f32_16x16x64_bf16 v[156:159], v[24:27], v[112:119], v0
  v_smfmac_f32_16x16x64_bf16 v[156:159], v[28:31], v[120:127], v0
  v_smfmac_f32_16x16x64_bf16 v[156:159], v[32:35], v[128:135], v0
  v_smfmac_f32_16x16x64_bf16 v[156:159], v[144:147], v[136:143], v0
  v_smfmac_f32_16x16x64_bf16 v[156:159], v[148:151], v[64:71], v0
  v_smfmac_f32_16x16x64_bf16 v[156:159], v[152:155], v[72:79], v0
  s_nop 7
  s_branch cB_va0_ep
.p2align 6

cB_va1_loop:
  s_add_u32 s23, s20, 4096
  s_add_u32 s21, s20, 25600
  s_mov_b32 s30, 0
  s_cmp_lg_u32 s19, s38
  s_cbranch_scc1 cB_va1_vok
  s_branch cB_va1_voc
cB_va1_vow:
  buffer_load_dword v63, off, s[8:11], s35 sc1
  s_waitcnt vmcnt(0)
cB_va1_voc:
  v_readfirstlane_b32 s22, v63
  s_cmp_eq_u32 s22, 56
  s_cbranch_scc1 cB_va1_vod
  s_sleep 1
  s_add_u32 s30, s30, 1
  s_cmp_lt_u32 s30, 400000
  s_cbranch_scc1 cB_va1_vow
  s_branch cB_abort
cB_va1_vod:
  s_add_u32 s35, s35, 2048
  s_add_u32 s38, s19, 8
  s_and_b32 s38, s38, -8
  s_cmp_eq_u32 s19, 0
  s_cselect_b32 s38, 4, s38
cB_va1_vok:
  s_cmp_eq_u32 s19, 63
  s_cbranch_scc1 cB_done
  s_barrier
  s_add_u32 s22, s25, 0
  buffer_load_dwordx4 v[80:83], v6, s[8:11], s22 offen offset:0 sc1
  buffer_load_dwordx4 v[84:87], v6, s[8:11], s22 offen offset:1792 sc1
  s_add_u32 s22, s25, 3584
  buffer_load_dwordx4 v[88:91], v6, s[8:11], s22 offen offset:0 sc1
  buffer_load_dwordx4 v[92:95], v6, s[8:11], s22 offen offset:1792 sc1
  s_add_u32 s22, s25, 7168
  buffer_load_dwordx4 v[96:99], v6, s[8:11], s22 offen offset:0 sc1
  buffer_load_dwordx4 v[100:103], v6, s[8:11], s22 offen offset:1792 sc1
  s_add_u32 s22, s25, 10752
  buffer_load_dwordx4 v[104:107], v6, s[8:11], s22 offen offset:0 sc1
  buffer_load_dwordx4 v[108:111], v6, s[8:11], s22 offen offset:1792 sc1
  s_add_u32 s22, s25, 14336
  buffer_load_dwordx4 v[112:115], v6, s[8:11], s22 offen offset:0 sc1
  buffer_load_dwordx4 v[116:119], v6, s[8:11], s22 offen offset:1792 sc1
  s_add_u32 s22, s25, 17920
  buffer_load_dwordx4 v[120:123], v6, s[8:11], s22 offen offset:0 sc1
  buffer_load_dwordx4 v[124:127], v6, s[8:11], s22 offen offset:1792 sc1
  s_add_u32 s22, s25, 21504
  buffer_load_dwordx4 v[128:131], v6, s[8:11], s22 offen offset:0 sc1
  buffer_load_dwordx4 v[132:135], v6, s[8:11], s22 offen offset:1792 sc1
  s_add_u32 s22, s25, 25088
  buffer_load_dwordx4 v[136:139], v6, s[8:11], s22 offen offset:0 sc1
  buffer_load_dwordx4 v[140:143], v6, s[8:11], s22 offen offset:1792 sc1
  buffer_load_dword v63, off, s[8:11], s35 sc1
  s_barrier
  ds_read_b128 v[8:11], v2 offset:8192
  ds_read_b128 v[12:15], v2 offset:9216
  ds_read_b128 v[16:19], v2 offset:10240
  ds_read_b128 v[20:23], v2 offset:11264
  ds_read_b128 v[24:27], v2 offset:12288
  ds_read_b128 v[28:31], v2 offset:13312
  ds_read_b128 v[32:35], v2 offset:14336
  s_waitcnt lgkmcnt(0)
  v_smfmac_f32_16x16x64_bf16 v[36:39], v[8:11], a[0:7], v3
  v_smfmac_f32_16x16x64_bf16 v[36:39], v[12:15], a[8:15], v3
  v_smfmac_f32_16x16x64_bf16 v[36:39], v[16:19], a[16:23], v3
  v_smfmac_f32_16x16x64_bf16 v[36:39], v[20:23], a[24:31], v3
  v_smfmac_f32_16x16x64_bf16 v[36:39], v[24:27], a[32:39], v3
  v_smfmac_f32_16x16x64_bf16 v[36:39], v[28:31], a[40:47], v3
  v_smfmac_f32_16x16x64_bf16 v[36:39], v[32:35], a[48:55], v3
  v_smfmac_f32_16x16x64_bf16 v[40:43], v[8:11], a[56:63], v3
  v_smfmac_f32_16x16x64_bf16 v[40:43], v[12:15], a[64:71], v3
  v_smfmac_f32_16x16x64_bf16 v[40:43], v[16:19], a[72:79], v3
  v_smfmac_f32_16x16x64_bf16 v[40:43], v[20:23], a[80:87], v3
  v_smfmac_f32_16x16x64_bf16 v[40:43], v[24:27], a[88:95], v3
  v_smfmac_f32_16x16x64_bf16 v[40:43], v[28:31], a[96:103], v3
  v_smfmac_f32_16x16x64_bf16 v[40:43], v[32:35], a[104:111], v3
  v_smfmac_f32_16x16x64_bf16 v[44:47], v[8:11], a[112:119], v3
  v_smfmac_f32_16x16x64_bf16 v[44:47], v[12:15], a[120:127], v3
  v_smfmac_f32_16x16x64_bf16 v[44:47], v[16:19], a[128:135], v3
  v_smfmac_f32_16x16x64_bf16 v[44:47], v[20:23], a[136:143], v3
  v_permlane32_swap_b32 v36, v40
  v_smfmac_f32_16x16x64_bf16 v[44:47], v[24:27], a[144:151], v3
  v_permlane32_swap_b32 v37, v41
  v_smfmac_f32_16x16x64_bf16 v[44:47], v[28:31], a[152:159], v3
  v_permlane32_swap_b32 v38, v42
  v_smfmac_f32_16x16x64_bf16 v[44:47], v[32:35], a[160:167], v3
  v_permlane32_swap_b32 v39, v43
  v_smfmac_f32_16x16x64_bf16 v[48:51], v[8:11], a[168:175], v3
  v_add_f32 v36, v36, v40
  v_smfmac_f32_16x16x64_bf16 v[48:51], v[12:15], a[176:183], v3
  v_add_f32 v37, v37, v41
  v_smfmac_f32_16x16x64_bf16 v[48:51], v[16:19], a[184:191], v3
  v_add_f32 v38, v38, v42
  v_smfmac_f32_16x16x64_bf16 v[48:51], v[20:23], a[192:199], v3
  v_add_f32 v39, v39, v43
  v_smfmac_f32_16x16x64_bf16 v[48:51], v[24:27], a[200:207], v3
  v_cvt_pk_bf16_f32 v40, v36, v37
  v_smfmac_f32_16x16x64_bf16 v[48:51], v[28:31], a[208:215], v3
  v_cvt_pk_bf16_f32 v41, v38, v39
  v_smfmac_f32_16x16x64_bf16 v[48:51], v[32:35], a[216:223], v3
  ds_write2_b32 v60, v40, v41 offset0:0 offset1:2
  v_smfmac_f32_16x16x64_bf16 v[52:55], v[8:11], a[224:231], v3
  v_smfmac_f32_16x16x64_bf16 v[52:55], v[12:15], a[232:239], v3
  v_smfmac_f32_16x16x64_bf16 v[52:55], v[16:19], a[240:247], v3
  v_smfmac_f32_16x16x64_bf16 v[52:55], v[20:23], a[248:255], v3
  v_permlane32_swap_b32 v44, v48
  v_smfmac_f32_16x16x64_bf16 v[52:55], v[24:27], v[176:183], v3
  v_permlane32_swap_b32 v45, v49
  v_smfmac_f32_16x16x64_bf16 v[52:55], v[28:31], v[184:191], v3
  v_permlane32_swap_b32 v46, v50
  v_smfmac_f32_16x16x64_bf16 v[52:55], v[32:35], v[192:199], v3
  v_permlane32_swap_b32 v47, v51
  v_smfmac_f32_16x16x64_bf16 v[56:59], v[8:11], v[200:207], v3
  v_add_f32 v44, v44, v48
  v_smfmac_f32_16x16x64_bf16 v[56:59], v[12:15], v[208:215], v3
  v_add_f32 v45, v45, v49
  v_smfmac_f32_16x16x64_bf16 v[56:59], v[16:19], v[216:223], v3
  v_add_f32 v46, v46, v50
  v_smfmac_f32_16x16x64_bf16 v[56:59], v[20:23], v[224:231], v3
  v_add_f32 v47, v47, v51
  v_smfmac_f32_16x16x64_bf16 v[56:59], v[24:27], v[232:239], v3
  v_cvt_pk_bf16_f32 v48, v44, v45
  v_smfmac_f32_16x16x64_bf16 v[56:59], v[28:31], v[240:247], v3
  v_cvt_pk_bf16_f32 v49, v46, v47
  v_smfmac_f32_16x16x64_bf16 v[56:59], v[32:35], v[248:255], v3
  ds_write2_b32 v61, v48, v49 offset0:0 offset1:2
  s_nop 6
  v_permlane32_swap_b32 v52, v56
  v_permlane32_swap_b32 v53, v57
  v_permlane32_swap_b32 v54, v58
  v_permlane32_swap_b32 v55, v59
  v_add_f32 v52, v52, v56
  v_add_f32 v53, v53, v57
  v_add_f32 v54, v54, v58
  v_add_f32 v55, v55, v59
  v_cvt_pk_bf16_f32 v56, v52, v53
  v_cvt_pk_bf16_f32 v57, v54, v55
  ds_write2_b32 v62, v56, v57 offset0:0 offset1:2
  s_cmp_eq_u32 s19, 63
  s_cbranch_scc1 cB_va1_last
  s_add_u32 s22, s20, 9216
  s_add_u32 s34, s20, 13312
  s_add_u32 s36, s20, 7168
  s_mov_b32 s37, 0
  v_mov_b32 v156, 0
  v_mov_b32 v157, 0
  v_mov_b32 v158, 0
  v_mov_b32 v159, 0
  buffer_load_dword v164, v4, s[8:11], s20 offen sc1
  s_nop 7
  buffer_load_dword v165, v4, s[8:11], s20 offen sc1
  s_nop 7
  buffer_load_dword v166, v4, s[8:11], s20 offen sc1
  s_nop 7
  buffer_load_dword v167, v4, s[8:11], s20 offen sc1
  s_nop 7
  buffer_load_dword v168, v4, s[8:11], s20 offen sc1
cB_va1_fw_l:
  s_waitcnt vmcnt(4)
  v_cmp_eq_u32 vcc, -1, v164
  s_cbranch_vccz cB_va1_fw_d
  buffer_load_dword v164, v4, s[8:11], s20 offen sc1
  s_waitcnt vmcnt(4)
  v_cmp_eq_u32 vcc, -1, v165
  s_cbranch_vccz cB_va1_fw_d
  buffer_load_dword v165, v4, s[8:11], s20 offen sc1
  s_waitcnt vmcnt(4)
  v_cmp_eq_u32 vcc, -1, v166
  s_cbranch_vccz cB_va1_fw_d
  buffer_load_dword v166, v4, s[8:11], s20 offen sc1
  s_waitcnt vmcnt(4)
  v_cmp_eq_u32 vcc, -1, v167
  s_cbranch_vccz cB_va1_fw_d
  buffer_load_dword v167, v4, s[8:11], s20 offen sc1
  s_waitcnt vmcnt(4)
  v_cmp_eq_u32 vcc, -1, v168
  s_cbranch_vccz cB_va1_fw_d
  buffer_load_dword v168, v4, s[8:11], s20 offen sc1
  s_add_u32 s30, s30, 1
  s_cmp_lt_u32 s30, 400000
  s_cbranch_scc1 cB_va1_fw_l
  s_branch cB_abort
cB_va1_fw_d:
  s_waitcnt lgkmcnt(0)
  buffer_load_dwordx4 v[8:11], v5, s[8:11], s22 offen offset:0 sc1
  v_mov_b32 v36, 0
  v_mov_b32 v37, 0
  v_mov_b32 v38, 0
  buffer_load_dwordx4 v[12:15], v5, s[8:11], s22 offen offset:1024 sc1
  v_mov_b32 v39, 0
  v_mov_b32 v40, 0
  v_mov_b32 v41, 0
  buffer_load_dwordx4 v[16:19], v5, s[8:11], s22 offen offset:2048 sc1
  v_mov_b32 v42, 0
  v_mov_b32 v43, 0
  v_mov_b32 v44, 0
  buffer_load_dwordx4 v[20:23], v5, s[8:11], s22 offen offset:3072 sc1
  v_mov_b32 v45, 0
  v_mov_b32 v46, 0
  v_mov_b32 v47, 0
  buffer_load_dwordx4 v[24:27], v5, s[8:11], s34 offen offset:0 sc1
  v_mov_b32 v48, 0
  v_mov_b32 v49, 0
  v_mov_b32 v50, 0
  buffer_load_dwordx4 v[28:31], v5, s[8:11], s34 offen offset:1024 sc1
  v_mov_b32 v51, 0
  v_mov_b32 v52, 0
  v_mov_b32 v53, 0
  buffer_load_dwordx4 v[32:35], v5, s[8:11], s34 offen offset:2048 sc1
  v_mov_b32 v54, 0
  v_mov_b32 v55, 0
  v_mov_b32 v56, 0
  buffer_load_dwordx4 v[144:147], v5, s[8:11], s34 offen offset:3072 sc1
  v_mov_b32 v57, 0
  v_mov_b32 v58, 0
  v_mov_b32 v59, 0
  buffer_load_dwordx4 v[148:151], v2, s[8:11], s36 offen offset:0 sc1
  buffer_load_dwordx4 v[152:155], v2, s[8:11], s36 offen offset:1024 sc1
  s_barrier
  ds_read_b128 v[64:67], v2 offset:4096
  ds_read_b128 v[68:71], v2 offset:5120
  ds_read_b128 v[72:75], v2 offset:6144
  ds_read_b128 v[76:79], v2 offset:7168
  s_waitcnt vmcnt(9)
  v_smfmac_f32_16x16x64_bf16 v[156:159], v[8:11], v[80:87], v0
  s_waitcnt vmcnt(8)
  v_smfmac_f32_16x16x64_bf16 v[156:159], v[12:15], v[88:95], v0
  s_waitcnt vmcnt(7)
  v_smfmac_f32_16x16x64_bf16 v[156:159], v[16:19], v[96:103], v0
  s_waitcnt vmcnt(6)
  v_smfmac_f32_16x16x64_bf16 v[156:159], v[20:23], v[104:111], v0
  s_waitcnt vmcnt(5)
  v_smfmac_f32_16x16x64_bf16 v[156:159], v[24:27], v[112:119], v0
  s_mov_b32 exec_hi, 0
  buffer_store_dword v2, v7, s[8:11], s21 offen sc1
  s_mov_b64 exec, -1
  s_waitcnt vmcnt(5)
  v_smfmac_f32_16x16x64_bf16 v[156:159], v[28:31], v[120:127], v0
  s_waitcnt vmcnt(4)
  v_smfmac_f32_16x16x64_bf16 v[156:159], v[32:35], v[128:135], v0
  s_waitcnt vmcnt(3)
  v_smfmac_f32_16x16x64_bf16 v[156:159], v[144:147], v[136:143], v0
  s_waitcnt vmcnt(2) lgkmcnt(0)
  v_smfmac_f32_16x16x64_bf16 v[156:159], v[148:151], v[64:71], v0
  s_waitcnt vmcnt(1)
  v_smfmac_f32_16x16x64_bf16 v[156:159], v[152:155], v[72:79], v0
cB_va1_ep:
  s_nop 7
  v_add_f32 v160, v156, v157
  v_add_f32 v161, v158, v159
  v_cmp_u_f32 vcc, v160, v161
  v_mov_b32_dpp v162, v160 row_ror:8 row_mask:0xf bank_mask:0xf
  v_mov_b32_dpp v160, v161 row_ror:8 row_mask:0xf bank_mask:0xc
  s_cbranch_vccnz cB_va1_rp
  v_mov_b32_dpp v161, v162 quad_perm:[0,1,2,3] row_mask:0xf bank_mask:0x3
  v_cvt_pk_bf16_f32 v160, v160, v161
cB_va1_pc:
  s_mov_b64 exec, s[26:27]
  buffer_store_dword v160, v1, s[8:11], s21 offen sc1
  s_cmp_lg_u32 s19, 62
  s_cbranch_scc1 cB_va1_nl
  s_mov_b32 s22, 88519680
  buffer_store_dword v160, v1, s[8:11], s22 offen sc1
  s_mov_b64 exec, -1
  s_branch cB_done
cB_va1_nl:
  s_mov_b64 exec, -1
  s_add_u32 s25, s25, 28672
  s_add_u32 s19, s19, 1
  s_mov_b32 s20, s21
  s_branch cB_va1_loop
cB_va1_last:
  s_waitcnt lgkmcnt(0)
  s_barrier
  s_branch cB_done
cB_va1_rp:
  s_cmp_eq_u32 s37, 0
  s_cbranch_scc1 cB_va1_rv
  v_mov_b32_dpp v161, v162 quad_perm:[0,1,2,3] row_mask:0xf bank_mask:0x3
  v_cvt_pk_bf16_f32 v160, v160, v161
  v_min_u32 v160, -2, v160
  s_branch cB_va1_pc
cB_va1_rv:
  buffer_load_dwordx4 v[8:11], v5, s[8:11], s22 offen offset:0 sc1
  buffer_load_dwordx4 v[12:15], v5, s[8:11], s22 offen offset:1024 sc1
  buffer_load_dwordx4 v[16:19], v5, s[8:11], s22 offen offset:2048 sc1
  buffer_load_dwordx4 v[20:23], v5, s[8:11], s22 offen offset:3072 sc1
  buffer_load_dwordx4 v[24:27], v5, s[8:11], s34 offen offset:0 sc1
  buffer_load_dwordx4 v[28:31], v5, s[8:11], s34 offen offset:1024 sc1
  buffer_load_dwordx4 v[32:35], v5, s[8:11], s34 offen offset:2048 sc1
  buffer_load_dwordx4 v[144:147], v5, s[8:11], s34 offen offset:3072 sc1
  buffer_load_dwordx4 v[148:151], v2, s[8:11], s36 offen offset:0 sc1
  buffer_load_dwordx4 v[152:155], v2, s[8:11], s36 offen offset:1024 sc1
  s_waitcnt vmcnt(0)
  v_max3_u32 v175, v8, v9, v10
  v_max3_u32 v175, v175, v11, v12
  v_max3_u32 v175, v175, v13, v14
  v_max3_u32 v175, v175, v15, v16
  v_max3_u32 v175, v175, v17, v18
  v_max3_u32 v175, v175, v19, v20
  v_max3_u32 v175, v175, v21, v22
  v_max3_u32 v175, v175, v23, v24
  v_max3_u32 v175, v175, v25, v26
  v_max3_u32 v175, v175, v27, v28
  v_max3_u32 v175, v175, v29, v30
  v_max3_u32 v175, v175, v31, v32
  v_max3_u32 v175, v175, v33, v34
  v_max3_u32 v175, v175, v35, v144
  v_max3_u32 v175, v175, v145, v146
  v_max3_u32 v175, v175, v147, v148
  v_max3_u32 v175, v175, v149, v150
  v_max3_u32 v175, v175, v151, v152
  v_max3_u32 v175, v175, v153, v154
  v_max_u32 v175, v175, v155
  v_cmp_eq_u32 vcc, -1, v175
  s_cbranch_vccz cB_va1_rk
  s_add_u32 s30, s30, 1
  s_cmp_lt_u32 s30, 400000
  s_cbranch_scc1 cB_va1_rv
  s_branch cB_abort
cB_va1_rk:
  s_mov_b32 s37, 1
  s_add_u32 s31, s31, 0x10000
  v_mov_b32 v156, 0
  v_mov_b32 v157, 0
  v_mov_b32 v158, 0
  v_mov_b32 v159, 0
  s_nop 1
  v_smfmac_f32_16x16x64_bf16 v[156:159], v[8:11], v[80:87], v0
  v_smfmac_f32_16x16x64_bf16 v[156:159], v[12:15], v[88:95], v0
  v_smfmac_f32_16x16x64_bf16 v[156:159], v[16:19], v[96:103], v0
  v_smfmac_f32_16x16x64_bf16 v[156:159], v[20:23], v[104:111], v0
  v_smfmac_f32_16x16x64_bf16 v[156:159], v[24:27], v[112:119], v0
  v_smfmac_f32_16x16x64_bf16 v[156:159], v[28:31], v[120:127], v0
  v_smfmac_f32_16x16x64_bf16 v[156:159], v[32:35], v[128:135], v0
  v_smfmac_f32_16x16x64_bf16 v[156:159], v[144:147], v[136:143], v0
  v_smfmac_f32_16x16x64_bf16 v[156:159], v[148:151], v[64:71], v0
  v_smfmac_f32_16x16x64_bf16 v[156:159], v[152:155], v[72:79], v0
  s_nop 7
  s_branch cB_va1_ep
.p2align 6

cB_va2_loop:
  s_add_u32 s23, s20, 4096
  s_add_u32 s21, s20, 25600
  v_mov_b32 v36, 0
  v_mov_b32 v37, 0
  v_mov_b32 v38, 0
  v_mov_b32 v39, 0
  v_mov_b32 v40, 0
  v_mov_b32 v41, 0
  v_mov_b32 v42, 0
  v_mov_b32 v43, 0
  v_mov_b32 v44, 0
  v_mov_b32 v45, 0
  v_mov_b32 v46, 0
  v_mov_b32 v47, 0
  v_mov_b32 v48, 0
  v_mov_b32 v49, 0
  v_mov_b32 v50, 0
  v_mov_b32 v51, 0
  v_mov_b32 v52, 0
  v_mov_b32 v53, 0
  v_mov_b32 v54, 0
  v_mov_b32 v55, 0
  v_mov_b32 v56, 0
  v_mov_b32 v57, 0
  v_mov_b32 v58, 0
  v_mov_b32 v59, 0
  v_mov_b32 v60, 0
  v_mov_b32 v61, 0
  v_mov_b32 v62, 0
  v_mov_b32 v63, 0
  v_mov_b32 v64, 0
  v_mov_b32 v65, 0
  v_mov_b32 v66, 0
  v_mov_b32 v67, 0
  s_mov_b32 s30, 0
  buffer_load_dword v76, v119, s[8:11], s20 offen sc1
  buffer_load_dword v77, v119, s[8:11], s20 offen sc1
  buffer_load_dword v78, v119, s[8:11], s20 offen sc1
cB_va2_fp_l:
  s_waitcnt vmcnt(2)
  v_cmp_eq_u32 vcc, -1, v76
  s_cbranch_vccz cB_va2_fp_d
  buffer_load_dword v76, v119, s[8:11], s20 offen sc1
  s_waitcnt vmcnt(2)
  v_cmp_eq_u32 vcc, -1, v77
  s_cbranch_vccz cB_va2_fp_d
  buffer_load_dword v77, v119, s[8:11], s20 offen sc1
  s_waitcnt vmcnt(2)
  v_cmp_eq_u32 vcc, -1, v78
  s_cbranch_vccz cB_va2_fp_d
  buffer_load_dword v78, v119, s[8:11], s20 offen sc1
  s_add_u32 s30, s30, 1
  s_cmp_lt_u32 s30, 400000
  s_cbranch_scc1 cB_va2_fp_l
  s_branch cB_abort
cB_va2_fp_d:
  buffer_load_dwordx4 v[8:11], v2, s[8:11], s20 offen offset:0 sc1
  buffer_load_dwordx4 v[12:15], v2, s[8:11], s20 offen offset:1024 sc1
  buffer_load_dwordx4 v[16:19], v2, s[8:11], s20 offen offset:2048 sc1
  buffer_load_dwordx4 v[20:23], v2, s[8:11], s20 offen offset:3072 sc1
  s_barrier
cB_va2_ld:
  s_waitcnt vmcnt(0)
  v_max3_u32 v84, v8, v9, v10
  v_max3_u32 v84, v84, v11, v12
  v_max3_u32 v84, v84, v13, v14
  v_max3_u32 v84, v84, v15, v16
  v_max3_u32 v84, v84, v17, v18
  v_max3_u32 v84, v84, v19, v20
  v_max3_u32 v84, v84, v21, v22
  v_max_u32 v84, v84, v23
  v_cmp_eq_u32 vcc, -1, v84
  ds_write_b128 v2, v[8:11] offset:8192
  ds_write_b128 v2, v[12:15] offset:9216
  ds_write_b128 v2, v[16:19] offset:10240
  ds_write_b128 v2, v[20:23] offset:11264
  s_cbranch_vccnz cB_va2_retry
  s_waitcnt lgkmcnt(0)
  s_barrier
  ds_read_b128 v[24:27], v2 offset:12288
  ds_read_b128 v[28:31], v2 offset:13312
  ds_read_b128 v[32:35], v2 offset:14336
  ds_read_b128 v[92:95], v0
  s_waitcnt lgkmcnt(0)
  s_mov_b64 exec, s[26:27]
  buffer_store_dwordx4 v[92:95], v2, s[8:11], s36 offen sc1
  s_mov_b64 exec, -1
  s_add_u32 s36, s36, 7168
  s_cmp_eq_u32 s19, 63
  s_cbranch_scc1 cB_done
  ds_read_b128 v[76:79], v1 offset:0
  ds_read_b128 v[80:83], v1 offset:1024
  ds_read_b128 v[84:87], v1 offset:2048
  ds_read_b128 v[88:91], v1 offset:3072
  ds_read_b128 v[92:95], v1 offset:4096
  ds_read_b128 v[96:99], v1 offset:5120
  v_smfmac_f32_16x16x64_bf16 v[60:63], v[8:11], v[200:207], v3
  v_smfmac_f32_16x16x64_bf16 v[60:63], v[12:15], v[208:215], v3
  s_waitcnt lgkmcnt(4)
  v_smfmac_f32_16x16x64_bf16 v[64:67], v[8:11], v[76:83], v3
  ds_read_b128 v[76:79], v1 offset:6144
  ds_read_b128 v[80:83], v1 offset:7168
  v_smfmac_f32_16x16x64_bf16 v[60:63], v[16:19], v[216:223], v3
  v_smfmac_f32_16x16x64_bf16 v[60:63], v[20:23], v[224:231], v3
  s_waitcnt lgkmcnt(4)
  v_smfmac_f32_16x16x64_bf16 v[64:67], v[12:15], v[84:91], v3
  ds_read_b128 v[84:87], v1 offset:8192
  ds_read_b128 v[88:91], v1 offset:9216
  v_smfmac_f32_16x16x64_bf16 v[60:63], v[24:27], v[232:239], v3
  v_smfmac_f32_16x16x64_bf16 v[60:63], v[28:31], v[240:247], v3
  s_waitcnt lgkmcnt(4)
  v_smfmac_f32_16x16x64_bf16 v[64:67], v[16:19], v[92:99], v3
  ds_read_b128 v[92:95], v1 offset:10240
  ds_read_b128 v[96:99], v1 offset:11264
  v_smfmac_f32_16x16x64_bf16 v[60:63], v[32:35], v[248:255], v3
  v_smfmac_f32_16x16x64_bf16 v[36:39], v[8:11], a[0:7], v3
  s_waitcnt lgkmcnt(4)
  v_smfmac_f32_16x16x64_bf16 v[64:67], v[20:23], v[76:83], v3
  ds_read_b128 v[76:79], v1 offset:12288
  ds_read_b128 v[80:83], v1 offset:13312
  v_smfmac_f32_16x16x64_bf16 v[36:39], v[12:15], a[8:15], v3
  v_smfmac_f32_16x16x64_bf16 v[36:39], v[16:19], a[16:23], v3
  s_waitcnt lgkmcnt(4)
  v_smfmac_f32_16x16x64_bf16 v[64:67], v[24:27], v[84:91], v3
  v_smfmac_f32_16x16x64_bf16 v[36:39], v[20:23], a[24:31], v3
  v_smfmac_f32_16x16x64_bf16 v[36:39], v[24:27], a[32:39], v3
  s_waitcnt lgkmcnt(2)
  v_smfmac_f32_16x16x64_bf16 v[64:67], v[28:31], v[92:99], v3
  v_smfmac_f32_16x16x64_bf16 v[36:39], v[28:31], a[40:47], v3
  v_smfmac_f32_16x16x64_bf16 v[36:39], v[32:35], a[48:55], v3
  s_waitcnt lgkmcnt(0)
  v_smfmac_f32_16x16x64_bf16 v[64:67], v[32:35], v[76:83], v3
  v_smfmac_f32_16x16x64_bf16 v[40:43], v[8:11], a[56:63], v3
  v_smfmac_f32_16x16x64_bf16 v[40:43], v[12:15], a[64:71], v3
  v_smfmac_f32_16x16x64_bf16 v[40:43], v[16:19], a[72:79], v3
  v_smfmac_f32_16x16x64_bf16 v[40:43], v[20:23], a[80:87], v3
  v_permlane32_swap_b32 v60, v64
  v_smfmac_f32_16x16x64_bf16 v[40:43], v[24:27], a[88:95], v3
  v_permlane32_swap_b32 v61, v65
  v_smfmac_f32_16x16x64_bf16 v[40:43], v[28:31], a[96:103], v3
  v_permlane32_swap_b32 v62, v66
  v_smfmac_f32_16x16x64_bf16 v[40:43], v[32:35], a[104:111], v3
  v_permlane32_swap_b32 v63, v67
  v_smfmac_f32_16x16x64_bf16 v[44:47], v[8:11], a[112:119], v3
  v_smfmac_f32_16x16x64_bf16 v[44:47], v[12:15], a[120:127], v3
  v_smfmac_f32_16x16x64_bf16 v[44:47], v[16:19], a[128:135], v3
  v_smfmac_f32_16x16x64_bf16 v[44:47], v[20:23], a[136:143], v3
  v_add_f32 v60, v60, v64
  v_add_f32 v61, v61, v65
  v_smfmac_f32_16x16x64_bf16 v[44:47], v[24:27], a[144:151], v3
  v_add_f32 v62, v62, v66
  v_add_f32 v63, v63, v67
  v_smfmac_f32_16x16x64_bf16 v[44:47], v[28:31], a[152:159], v3
  v_cvt_pk_bf16_f32 v64, v60, v61
  v_cvt_pk_bf16_f32 v65, v62, v63
  v_smfmac_f32_16x16x64_bf16 v[44:47], v[32:35], a[160:167], v3
  ds_write2_b32 v115, v64, v65 offset0:0 offset1:2
  v_smfmac_f32_16x16x64_bf16 v[48:51], v[8:11], a[168:175], v3
  v_permlane32_swap_b32 v36, v40
  v_smfmac_f32_16x16x64_bf16 v[48:51], v[12:15], a[176:183], v3
  v_permlane32_swap_b32 v37, v41
  v_smfmac_f32_16x16x64_bf16 v[48:51], v[16:19], a[184:191], v3
  v_permlane32_swap_b32 v38, v42
  v_smfmac_f32_16x16x64_bf16 v[48:51], v[20:23], a[192:199], v3
  v_permlane32_swap_b32 v39, v43
  v_smfmac_f32_16x16x64_bf16 v[48:51], v[24:27], a[200:207], v3
  v_add_f32 v36, v36, v40
  v_smfmac_f32_16x16x64_bf16 v[48:51], v[28:31], a[208:215], v3
  v_add_f32 v37, v37, v41
  v_smfmac_f32_16x16x64_bf16 v[48:51], v[32:35], a[216:223], v3
  v_add_f32 v38, v38, v42
  v_smfmac_f32_16x16x64_bf16 v[52:55], v[8:11], a[224:231], v3
  v_smfmac_f32_16x16x64_bf16 v[52:55], v[12:15], a[232:239], v3
  v_smfmac_f32_16x16x64_bf16 v[52:55], v[16:19], a[240:247], v3
  v_smfmac_f32_16x16x64_bf16 v[52:55], v[20:23], a[248:255], v3
  v_add_f32 v39, v39, v43
  v_cvt_pk_bf16_f32 v40, v36, v37
  v_smfmac_f32_16x16x64_bf16 v[52:55], v[24:27], v[120:127], v3
  v_cvt_pk_bf16_f32 v41, v38, v39
  v_smfmac_f32_16x16x64_bf16 v[52:55], v[28:31], v[128:135], v3
  ds_write2_b32 v112, v40, v41 offset0:0 offset1:2
  v_smfmac_f32_16x16x64_bf16 v[52:55], v[32:35], v[136:143], v3
  v_permlane32_swap_b32 v44, v48
  v_smfmac_f32_16x16x64_bf16 v[56:59], v[8:11], v[144:151], v3
  v_permlane32_swap_b32 v45, v49
  v_smfmac_f32_16x16x64_bf16 v[56:59], v[12:15], v[152:159], v3
  v_permlane32_swap_b32 v46, v50
  v_smfmac_f32_16x16x64_bf16 v[56:59], v[16:19], v[160:167], v3
  v_permlane32_swap_b32 v47, v51
  v_smfmac_f32_16x16x64_bf16 v[56:59], v[20:23], v[168:175], v3
  v_add_f32 v44, v44, v48
  v_smfmac_f32_16x16x64_bf16 v[56:59], v[24:27], v[176:183], v3
  v_add_f32 v45, v45, v49
  v_smfmac_f32_16x16x64_bf16 v[56:59], v[28:31], v[184:191], v3
  v_add_f32 v46, v46, v50
  v_smfmac_f32_16x16x64_bf16 v[56:59], v[32:35], v[192:199], v3
  v_add_f32 v47, v47, v51
  v_cvt_pk_bf16_f32 v48, v44, v45
  v_cvt_pk_bf16_f32 v49, v46, v47
  ds_write2_b32 v113, v48, v49 offset0:0 offset1:2
  s_nop 3
  v_permlane32_swap_b32 v52, v56
  v_permlane32_swap_b32 v53, v57
  v_permlane32_swap_b32 v54, v58
  v_permlane32_swap_b32 v55, v59
  v_add_f32 v52, v52, v56
  v_add_f32 v53, v53, v57
  v_add_f32 v54, v54, v58
  v_add_f32 v55, v55, v59
  v_cvt_pk_bf16_f32 v56, v52, v53
  v_cvt_pk_bf16_f32 v57, v54, v55
  ds_write2_b32 v114, v56, v57 offset0:0 offset1:2
  s_waitcnt lgkmcnt(0)
  s_barrier
  s_cmp_eq_u32 s19, 62
  s_cbranch_scc1 cB_done
  s_waitcnt vmcnt(0) lgkmcnt(0)
  s_add_u32 s19, s19, 1
  s_mov_b32 s20, s21
  s_branch cB_va2_loop
cB_va2_retry:
  s_waitcnt lgkmcnt(0)
  buffer_load_dwordx4 v[8:11], v2, s[8:11], s20 offen offset:0 sc1
  buffer_load_dwordx4 v[12:15], v2, s[8:11], s20 offen offset:1024 sc1
  buffer_load_dwordx4 v[16:19], v2, s[8:11], s20 offen offset:2048 sc1
  buffer_load_dwordx4 v[20:23], v2, s[8:11], s20 offen offset:3072 sc1
  s_add_u32 s31, s31, 1
  s_add_u32 s30, s30, 1
  s_cmp_lt_u32 s30, 400000
  s_cbranch_scc1 cB_va2_ld
  s_branch cB_abort
cB_va2_last:
  s_waitcnt lgkmcnt(0)
  buffer_store_dwordx4 v[100:103], v2, s[8:11], s24 offen offset:0 sc1
  buffer_store_dwordx4 v[104:107], v2, s[8:11], s24 offen offset:1024 sc1
  buffer_store_dwordx4 v[108:111], v2, s[8:11], s24 offen offset:2048 sc1
  buffer_store_dwordx4 v[4:7], v2, s[8:11], s24 offen offset:3072 sc1
  s_add_u32 s24, s24, 8192
  s_waitcnt vmcnt(0)
  s_mov_b64 exec, 1
  buffer_store_dword v117, v2, s[8:11], s34 offen sc1
  s_mov_b64 exec, -1
  s_add_u32 s34, s34, 8
  s_mov_b64 exec, 1
  buffer_store_dword v117, v2, s[8:11], s34 offen sc1
  s_mov_b64 exec, -1
  s_add_u32 s34, s34, 8
  s_branch cB_done
.p2align 6

cB_va3_loop:
  s_add_u32 s23, s20, 4096
  s_add_u32 s21, s20, 25600
  v_mov_b32 v36, 0
  v_mov_b32 v37, 0
  v_mov_b32 v38, 0
  v_mov_b32 v39, 0
  v_mov_b32 v40, 0
  v_mov_b32 v41, 0
  v_mov_b32 v42, 0
  v_mov_b32 v43, 0
  v_mov_b32 v44, 0
  v_mov_b32 v45, 0
  v_mov_b32 v46, 0
  v_mov_b32 v47, 0
  v_mov_b32 v48, 0
  v_mov_b32 v49, 0
  v_mov_b32 v50, 0
  v_mov_b32 v51, 0
  v_mov_b32 v52, 0
  v_mov_b32 v53, 0
  v_mov_b32 v54, 0
  v_mov_b32 v55, 0
  v_mov_b32 v56, 0
  v_mov_b32 v57, 0
  v_mov_b32 v58, 0
  v_mov_b32 v59, 0
  v_mov_b32 v60, 0
  v_mov_b32 v61, 0
  v_mov_b32 v62, 0
  v_mov_b32 v63, 0
  v_mov_b32 v64, 0
  v_mov_b32 v65, 0
  v_mov_b32 v66, 0
  v_mov_b32 v67, 0
  s_mov_b32 s30, 0
  buffer_load_dword v76, v119, s[8:11], s20 offen sc1
  buffer_load_dword v77, v119, s[8:11], s20 offen sc1
  buffer_load_dword v78, v119, s[8:11], s20 offen sc1
cB_va3_fp_l:
  s_waitcnt vmcnt(2)
  v_cmp_eq_u32 vcc, -1, v76
  s_cbranch_vccz cB_va3_fp_d
  buffer_load_dword v76, v119, s[8:11], s20 offen sc1
  s_waitcnt vmcnt(2)
  v_cmp_eq_u32 vcc, -1, v77
  s_cbranch_vccz cB_va3_fp_d
  buffer_load_dword v77, v119, s[8:11], s20 offen sc1
  s_waitcnt vmcnt(2)
  v_cmp_eq_u32 vcc, -1, v78
  s_cbranch_vccz cB_va3_fp_d
  buffer_load_dword v78, v119, s[8:11], s20 offen sc1
  s_add_u32 s30, s30, 1
  s_cmp_lt_u32 s30, 400000
  s_cbranch_scc1 cB_va3_fp_l
  s_branch cB_abort
cB_va3_fp_d:
  buffer_load_dwordx4 v[24:27], v2, s[8:11], s23 offen offset:0 sc1
  buffer_load_dwordx4 v[28:31], v2, s[8:11], s23 offen offset:1024 sc1
  buffer_load_dwordx4 v[32:35], v2, s[8:11], s23 offen offset:2048 sc1
  s_barrier
cB_va3_ld:
  s_waitcnt vmcnt(0)
  v_max3_u32 v84, v24, v25, v26
  v_max3_u32 v84, v84, v27, v28
  v_max3_u32 v84, v84, v29, v30
  v_max3_u32 v84, v84, v31, v32
  v_max3_u32 v84, v84, v33, v34
  v_max_u32 v84, v84, v35
  v_cmp_eq_u32 vcc, -1, v84
  ds_write_b128 v2, v[24:27] offset:12288
  ds_write_b128 v2, v[28:31] offset:13312
  ds_write_b128 v2, v[32:35] offset:14336
  s_cbranch_vccnz cB_va3_retry
  s_waitcnt lgkmcnt(0)
  s_barrier
  ds_read_b128 v[8:11], v2 offset:8192
  ds_read_b128 v[12:15], v2 offset:9216
  ds_read_b128 v[16:19], v2 offset:10240
  ds_read_b128 v[20:23], v2 offset:11264
  s_waitcnt lgkmcnt(0)
  s_cmp_eq_u32 s19, 63
  s_cbranch_scc1 cB_done
  ds_read_b128 v[76:79], v1 offset:0
  ds_read_b128 v[80:83], v1 offset:1024
  ds_read_b128 v[84:87], v1 offset:2048
  ds_read_b128 v[88:91], v1 offset:3072
  ds_read_b128 v[92:95], v1 offset:4096
  ds_read_b128 v[96:99], v1 offset:5120
  v_smfmac_f32_16x16x64_bf16 v[60:63], v[8:11], v[200:207], v3
  v_smfmac_f32_16x16x64_bf16 v[60:63], v[12:15], v[208:215], v3
  s_waitcnt lgkmcnt(4)
  v_smfmac_f32_16x16x64_bf16 v[64:67], v[8:11], v[76:83], v3
  ds_read_b128 v[76:79], v1 offset:6144
  ds_read_b128 v[80:83], v1 offset:7168
  v_smfmac_f32_16x16x64_bf16 v[60:63], v[16:19], v[216:223], v3
  v_smfmac_f32_16x16x64_bf16 v[60:63], v[20:23], v[224:231], v3
  s_waitcnt lgkmcnt(4)
  v_smfmac_f32_16x16x64_bf16 v[64:67], v[12:15], v[84:91], v3
  ds_read_b128 v[84:87], v1 offset:8192
  ds_read_b128 v[88:91], v1 offset:9216
  v_smfmac_f32_16x16x64_bf16 v[60:63], v[24:27], v[232:239], v3
  v_smfmac_f32_16x16x64_bf16 v[60:63], v[28:31], v[240:247], v3
  s_waitcnt lgkmcnt(4)
  v_smfmac_f32_16x16x64_bf16 v[64:67], v[16:19], v[92:99], v3
  ds_read_b128 v[92:95], v1 offset:10240
  ds_read_b128 v[96:99], v1 offset:11264
  v_smfmac_f32_16x16x64_bf16 v[60:63], v[32:35], v[248:255], v3
  v_smfmac_f32_16x16x64_bf16 v[36:39], v[8:11], a[0:7], v3
  s_waitcnt lgkmcnt(4)
  v_smfmac_f32_16x16x64_bf16 v[64:67], v[20:23], v[76:83], v3
  ds_read_b128 v[76:79], v1 offset:12288
  ds_read_b128 v[80:83], v1 offset:13312
  v_smfmac_f32_16x16x64_bf16 v[36:39], v[12:15], a[8:15], v3
  v_smfmac_f32_16x16x64_bf16 v[36:39], v[16:19], a[16:23], v3
  s_waitcnt lgkmcnt(4)
  v_smfmac_f32_16x16x64_bf16 v[64:67], v[24:27], v[84:91], v3
  v_smfmac_f32_16x16x64_bf16 v[36:39], v[20:23], a[24:31], v3
  v_smfmac_f32_16x16x64_bf16 v[36:39], v[24:27], a[32:39], v3
  s_waitcnt lgkmcnt(2)
  v_smfmac_f32_16x16x64_bf16 v[64:67], v[28:31], v[92:99], v3
  v_smfmac_f32_16x16x64_bf16 v[36:39], v[28:31], a[40:47], v3
  v_smfmac_f32_16x16x64_bf16 v[36:39], v[32:35], a[48:55], v3
  s_waitcnt lgkmcnt(0)
  v_smfmac_f32_16x16x64_bf16 v[64:67], v[32:35], v[76:83], v3
  v_smfmac_f32_16x16x64_bf16 v[40:43], v[8:11], a[56:63], v3
  v_smfmac_f32_16x16x64_bf16 v[40:43], v[12:15], a[64:71], v3
  v_smfmac_f32_16x16x64_bf16 v[40:43], v[16:19], a[72:79], v3
  v_smfmac_f32_16x16x64_bf16 v[40:43], v[20:23], a[80:87], v3
  v_permlane32_swap_b32 v60, v64
  v_smfmac_f32_16x16x64_bf16 v[40:43], v[24:27], a[88:95], v3
  v_permlane32_swap_b32 v61, v65
  v_smfmac_f32_16x16x64_bf16 v[40:43], v[28:31], a[96:103], v3
  v_permlane32_swap_b32 v62, v66
  v_smfmac_f32_16x16x64_bf16 v[40:43], v[32:35], a[104:111], v3
  v_permlane32_swap_b32 v63, v67
  v_smfmac_f32_16x16x64_bf16 v[44:47], v[8:11], a[112:119], v3
  v_smfmac_f32_16x16x64_bf16 v[44:47], v[12:15], a[120:127], v3
  v_smfmac_f32_16x16x64_bf16 v[44:47], v[16:19], a[128:135], v3
  v_smfmac_f32_16x16x64_bf16 v[44:47], v[20:23], a[136:143], v3
  v_add_f32 v60, v60, v64
  v_add_f32 v61, v61, v65
  v_smfmac_f32_16x16x64_bf16 v[44:47], v[24:27], a[144:151], v3
  v_add_f32 v62, v62, v66
  v_add_f32 v63, v63, v67
  v_smfmac_f32_16x16x64_bf16 v[44:47], v[28:31], a[152:159], v3
  v_cvt_pk_bf16_f32 v64, v60, v61
  v_cvt_pk_bf16_f32 v65, v62, v63
  v_smfmac_f32_16x16x64_bf16 v[44:47], v[32:35], a[160:167], v3
  ds_write2_b32 v115, v64, v65 offset0:0 offset1:2
  v_smfmac_f32_16x16x64_bf16 v[48:51], v[8:11], a[168:175], v3
  v_permlane32_swap_b32 v36, v40
  v_smfmac_f32_16x16x64_bf16 v[48:51], v[12:15], a[176:183], v3
  v_permlane32_swap_b32 v37, v41
  v_smfmac_f32_16x16x64_bf16 v[48:51], v[16:19], a[184:191], v3
  v_permlane32_swap_b32 v38, v42
  v_smfmac_f32_16x16x64_bf16 v[48:51], v[20:23], a[192:199], v3
  v_permlane32_swap_b32 v39, v43
  v_smfmac_f32_16x16x64_bf16 v[48:51], v[24:27], a[200:207], v3
  v_add_f32 v36, v36, v40
  v_smfmac_f32_16x16x64_bf16 v[48:51], v[28:31], a[208:215], v3
  v_add_f32 v37, v37, v41
  v_smfmac_f32_16x16x64_bf16 v[48:51], v[32:35], a[216:223], v3
  v_add_f32 v38, v38, v42
  v_smfmac_f32_16x16x64_bf16 v[52:55], v[8:11], a[224:231], v3
  v_smfmac_f32_16x16x64_bf16 v[52:55], v[12:15], a[232:239], v3
  v_smfmac_f32_16x16x64_bf16 v[52:55], v[16:19], a[240:247], v3
  v_smfmac_f32_16x16x64_bf16 v[52:55], v[20:23], a[248:255], v3
  v_add_f32 v39, v39, v43
  v_cvt_pk_bf16_f32 v40, v36, v37
  v_smfmac_f32_16x16x64_bf16 v[52:55], v[24:27], v[120:127], v3
  v_cvt_pk_bf16_f32 v41, v38, v39
  v_smfmac_f32_16x16x64_bf16 v[52:55], v[28:31], v[128:135], v3
  ds_write2_b32 v112, v40, v41 offset0:0 offset1:2
  v_smfmac_f32_16x16x64_bf16 v[52:55], v[32:35], v[136:143], v3
  v_permlane32_swap_b32 v44, v48
  v_smfmac_f32_16x16x64_bf16 v[56:59], v[8:11], v[144:151], v3
  v_permlane32_swap_b32 v45, v49
  v_smfmac_f32_16x16x64_bf16 v[56:59], v[12:15], v[152:159], v3
  v_permlane32_swap_b32 v46, v50
  v_smfmac_f32_16x16x64_bf16 v[56:59], v[16:19], v[160:167], v3
  v_permlane32_swap_b32 v47, v51
  v_smfmac_f32_16x16x64_bf16 v[56:59], v[20:23], v[168:175], v3
  v_add_f32 v44, v44, v48
  v_smfmac_f32_16x16x64_bf16 v[56:59], v[24:27], v[176:183], v3
  v_add_f32 v45, v45, v49
  v_smfmac_f32_16x16x64_bf16 v[56:59], v[28:31], v[184:191], v3
  v_add_f32 v46, v46, v50
  v_smfmac_f32_16x16x64_bf16 v[56:59], v[32:35], v[192:199], v3
  v_add_f32 v47, v47, v51
  v_cvt_pk_bf16_f32 v48, v44, v45
  v_cvt_pk_bf16_f32 v49, v46, v47
  ds_write2_b32 v113, v48, v49 offset0:0 offset1:2
  s_nop 3
  v_permlane32_swap_b32 v52, v56
  v_permlane32_swap_b32 v53, v57
  v_permlane32_swap_b32 v54, v58
  v_permlane32_swap_b32 v55, v59
  v_add_f32 v52, v52, v56
  v_add_f32 v53, v53, v57
  v_add_f32 v54, v54, v58
  v_add_f32 v55, v55, v59
  v_cvt_pk_bf16_f32 v56, v52, v53
  v_cvt_pk_bf16_f32 v57, v54, v55
  ds_write2_b32 v114, v56, v57 offset0:0 offset1:2
  s_waitcnt lgkmcnt(0)
  s_barrier
  s_cmp_eq_u32 s19, 62
  s_cbranch_scc1 cB_done
  s_waitcnt vmcnt(0) lgkmcnt(0)
  s_add_u32 s19, s19, 1
  s_mov_b32 s20, s21
  s_branch cB_va3_loop
cB_va3_retry:
  s_waitcnt lgkmcnt(0)
  buffer_load_dwordx4 v[24:27], v2, s[8:11], s23 offen offset:0 sc1
  buffer_load_dwordx4 v[28:31], v2, s[8:11], s23 offen offset:1024 sc1
  buffer_load_dwordx4 v[32:35], v2, s[8:11], s23 offen offset:2048 sc1
  s_add_u32 s31, s31, 1
  s_add_u32 s30, s30, 1
  s_cmp_lt_u32 s30, 400000
  s_cbranch_scc1 cB_va3_ld
  s_branch cB_abort
cB_va3_last:
  s_waitcnt lgkmcnt(0)
  buffer_store_dwordx4 v[100:103], v2, s[8:11], s24 offen offset:0 sc1
  buffer_store_dwordx4 v[104:107], v2, s[8:11], s24 offen offset:1024 sc1
  buffer_store_dwordx4 v[108:111], v2, s[8:11], s24 offen offset:2048 sc1
  buffer_store_dwordx4 v[4:7], v2, s[8:11], s24 offen offset:3072 sc1
  s_add_u32 s24, s24, 8192
  s_waitcnt vmcnt(0)
  s_mov_b64 exec, 1
  buffer_store_dword v117, v2, s[8:11], s34 offen sc1
  s_mov_b64 exec, -1
  s_add_u32 s34, s34, 8
  s_mov_b64 exec, 1
  buffer_store_dword v117, v2, s[8:11], s34 offen sc1
  s_mov_b64 exec, -1
  s_add_u32 s34, s34, 8
  s_branch cB_done
cB_abort:
  v_mov_b32 v4, 0xdead
  v_mov_b32 v5, 16
  buffer_store_dword v4, v5, s[12:15], 0 offen
  s_branch ch_end
cB_done:
  s_branch ch_end
m_reclaim:
  s_waitcnt vmcnt(0)
  s_lshr_b32 s20, s3, 5
  s_cmp_lg_u32 s16, 0
  s_cbranch_scc1 w0_17
  s_mov_b32 s21, 0
  s_mov_b64 exec, 1
rc_l:
  s_cmp_lg_u32 s70, -1
  s_cbranch_scc1 rc_t
  s_add_u32 s20, s20, 1
  s_cmp_lt_u32 s20, 8
  s_cselect_b32 s20, s20, 0
  s_mov_b32 s70, 0
  s_mov_b32 s3, -1
  s_add_u32 s21, s21, 1
  s_cmp_ge_u32 s21, 9
  s_cbranch_scc1 rc_d
rc_t:
  s_ff0_i32_b32 s22, s70
  s_lshl_b32 s23, 1, s22
  s_and_b32 s71, s20, 4
  s_mul_i32 s71, s71, 12
  s_lshl_b32 s3, s20, 2
  s_add_u32 s3, s3, s71
  v_mov_b32 v242, s23
  v_mov_b32 v243, 32
  buffer_atomic_or v242, v243, s[12:15], s3 offen sc0
  s_waitcnt vmcnt(0)
  v_readfirstlane_b32 s70, v242
  s_lshl_b32 s3, s20, 5
  s_add_u32 s3, s3, s22
  s_bitcmp1_b32 s70, s22
  s_cbranch_scc1 rc_l
rc_d:
  s_mov_b64 exec, -1
  v_mov_b32 v242, s3
w0_17:
  v_mov_b32 v250, 160000
  s_add_u32 s101, s101, 1
  s_barrier
  s_mov_b64 exec, 1
  s_cmp_lg_u32 s16, 0
  s_cbranch_scc1 w0_18
  ds_write_b32 v250, v242 offset:0
  s_waitcnt lgkmcnt(0)
  v_mov_b32 v242, s101
  ds_write_b32 v250, v242 offset:16
  s_waitcnt lgkmcnt(0)
w0_18:
  s_mov_b64 exec, -1
  s_barrier
  ds_read_b32 v242, v250 offset:0
  ds_read_b32 v250, v250 offset:16
  s_waitcnt lgkmcnt(0)
  v_readfirstlane_b32 s3, v242
  v_cmp_ne_u32 vcc, s101, v250
  s_cbranch_vccnz ch_end
  s_cmp_lg_u32 s3, -1
  s_cbranch_scc1 m_start
  v_mov_b32 v250, 0
  s_branch wk_ask
m_bjob:
  v_and_b32 v1, 63, v0
  v_lshlrev_b32 v2, 4, v1
  v_lshrrev_b32 v3, 4, v1
  v_and_b32 v4, 15, v1
  s_sub_u32 s18, s3, 32
  s_mul_i32 s17, s18, 4682
  s_lshr_b32 s17, s17, 16
  s_mul_i32 s20, s17, 14
  s_sub_u32 s19, s18, s20
  s_cmp_ge_u32 s19, 7
  s_cselect_b32 s31, 7, 0
  s_sub_u32 s19, s19, s31
  s_mov_b32 s60, s44
  s_and_b32 s61, s45, 0xffff
  s_mov_b32 s62, 3670016
  s_mov_b32 s63, 0x20000
  s_mov_b32 s56, s46
  s_and_b32 s57, s47, 0xffff
  s_mov_b32 s58, 3670016
  s_mov_b32 s59, 0x20000
  s_lshl_b32 s30, s16, 13
  s_mul_i32 s27, s17, 229376
  s_lshl_b32 s29, s19, 7
  s_add_u32 s27, s27, s29
  v_lshrrev_b32 v7, 3, v1
  v_and_b32 v8, 7, v1
  v_and_b32 v9, 2, v7
  v_xor_b32 v8, v8, v9
  s_lshl_b32 s29, s16, 6
  v_add_u32 v7, s29, v7
  v_mul_u32_u24 v7, 896, v7
  v_lshl_add_u32 v7, v8, 4, v7
  v_xor_b32 v8, 64, v7
  s_add_u32 m0, s30, 0
  s_add_u32 s22, s27, 0
  buffer_load_dwordx4 v7, s[56:59], s22 offen offset:0 lds
  s_add_u32 s22, s27, 6144
  buffer_load_dwordx4 v8, s[56:59], s22 offen offset:1024 lds
  s_add_u32 s22, s27, 12288
  buffer_load_dwordx4 v7, s[56:59], s22 offen offset:2048 lds
  s_add_u32 s22, s27, 18432
  buffer_load_dwordx4 v8, s[56:59], s22 offen offset:3072 lds
  s_add_u32 m0, s30, 4096
  s_add_u32 s22, s27, 28672
  buffer_load_dwordx4 v7, s[56:59], s22 offen offset:0 lds
  s_add_u32 s22, s27, 34816
  buffer_load_dwordx4 v8, s[56:59], s22 offen offset:1024 lds
  s_add_u32 s22, s27, 40960
  buffer_load_dwordx4 v7, s[56:59], s22 offen offset:2048 lds
  s_add_u32 s22, s27, 47104
  buffer_load_dwordx4 v8, s[56:59], s22 offen offset:3072 lds
  v_lshrrev_b32 v5, 5, v1
  v_and_b32 v6, 31, v1
  s_lshl_b32 s25, s16, 15
  s_add_u32 s25, s25, 32768
  s_lshl_b32 s26, s17, 9
  s_add_u32 s28, s19, s16
  s_cmp_ge_u32 s28, 7
  s_cselect_b32 s20, 7, 0
  s_sub_u32 s28, s28, s20
  s_add_u32 s28, s28, s31
  s_add_u32 s29, s19, s16
  s_add_u32 s29, s29, 4
  s_cmp_ge_u32 s29, 7
  s_cselect_b32 s20, 7, 0
  s_sub_u32 s29, s29, s20
  s_add_u32 s29, s29, s31
  s_lshl_b32 s32, s28, 18
  s_add_u32 s32, s32, s26
  s_lshl_b32 s33, s29, 18
  s_add_u32 s33, s33, s26
  v_xor_b32 v8, v6, v5
  v_lshlrev_b32 v8, 4, v8
  v_lshl_add_u32 v8, v5, 13, v8
  v_xor_b32 v12, 0, v8
  v_xor_b32 v13, 32, v8
  v_add_u32 v13, 15360, v13
  v_xor_b32 v14, 0, v8
  v_add_u32 v14, 30720, v14
  v_xor_b32 v15, 32, v8
  v_add_u32 v15, 46080, v15
  s_add_u32 s20, s16, 0
  s_and_b32 s20, s20, 3
  s_mul_i32 s21, s20, 65600
  s_lshl_b32 s20, s20, 12
  s_add_u32 s48, s20, s25
  s_mov_b32 m0, s48
  v_xor_b32 v16, s21, v12
  buffer_load_dwordx4 v16, s[60:63], s32 offen offset:0 lds
  v_xor_b32 v17, s21, v13
  buffer_load_dwordx4 v17, s[60:63], s32 offen offset:1024 lds
  v_xor_b32 v18, s21, v14
  buffer_load_dwordx4 v18, s[60:63], s32 offen offset:2048 lds
  v_xor_b32 v19, s21, v15
  buffer_load_dwordx4 v19, s[60:63], s32 offen offset:3072 lds
  s_add_u32 s20, s16, 1
  s_and_b32 s20, s20, 3
  s_mul_i32 s21, s20, 65600
  s_lshl_b32 s20, s20, 12
  s_add_u32 s49, s20, s25
  s_mov_b32 m0, s49
  v_xor_b32 v20, s21, v12
  buffer_load_dwordx4 v20, s[60:63], s32 offen offset:0 lds
  v_xor_b32 v21, s21, v13
  buffer_load_dwordx4 v21, s[60:63], s32 offen offset:1024 lds
  v_xor_b32 v22, s21, v14
  buffer_load_dwordx4 v22, s[60:63], s32 offen offset:2048 lds
  v_xor_b32 v23, s21, v15
  buffer_load_dwordx4 v23, s[60:63], s32 offen offset:3072 lds
  s_add_u32 s20, s16, 2
  s_and_b32 s20, s20, 3
  s_mul_i32 s21, s20, 65600
  s_lshl_b32 s20, s20, 12
  s_add_u32 s50, s20, s25
  s_mov_b32 m0, s50
  v_xor_b32 v24, s21, v12
  buffer_load_dwordx4 v24, s[60:63], s32 offen offset:0 lds
  v_xor_b32 v25, s21, v13
  buffer_load_dwordx4 v25, s[60:63], s32 offen offset:1024 lds
  v_xor_b32 v26, s21, v14
  buffer_load_dwordx4 v26, s[60:63], s32 offen offset:2048 lds
  v_xor_b32 v27, s21, v15
  buffer_load_dwordx4 v27, s[60:63], s32 offen offset:3072 lds
  s_add_u32 s20, s16, 3
  s_and_b32 s20, s20, 3
  s_mul_i32 s21, s20, 65600
  s_lshl_b32 s20, s20, 12
  s_add_u32 s51, s20, s25
  s_mov_b32 m0, s51
  v_xor_b32 v28, s21, v12
  buffer_load_dwordx4 v28, s[60:63], s32 offen offset:0 lds
  v_xor_b32 v29, s21, v13
  buffer_load_dwordx4 v29, s[60:63], s32 offen offset:1024 lds
  v_xor_b32 v30, s21, v14
  buffer_load_dwordx4 v30, s[60:63], s32 offen offset:2048 lds
  v_xor_b32 v31, s21, v15
  buffer_load_dwordx4 v31, s[60:63], s32 offen offset:3072 lds
  s_cmp_lg_u32 s66, 0
  s_cbranch_scc1 bj_ci
  s_cmp_lg_u32 s16, 0
  s_cbranch_scc1 w0_19
  s_lshr_b32 s70, s3, 5
  s_and_b32 s71, s70, 4
  s_mul_i32 s71, s71, 12
  s_lshl_b32 s70, s70, 2
  s_add_u32 s70, s70, s71
  s_lshl_b32 s71, 1, s3
  v_mov_b32 v44, s71
  v_mov_b32 v45, 32
  s_mov_b64 exec, 1
  buffer_atomic_or v44, v45, s[12:15], s70 offen sc0
  buffer_load_dwordx2 v[46:47], v45, s[12:15], 0 offen offset:96 sc1
  s_mov_b64 exec, -1
w0_19:
bj_ci:
  s_lshl_b32 s30, s19, 6
  s_add_u32 s30, s30, 0
  v_add_u32 v8, s30, v4
  v_mul_u32_u24 v10, 2341, v8
  v_lshrrev_b32 v10, 16, v10
  v_mul_u32_u24 v11, 28, v10
  v_sub_u32 v32, v8, v11
  s_mul_i32 s30, s17, 28
  v_add_u32 v32, s30, v32
  v_lshrrev_b32 v33, 4, v32
  v_and_b32 v32, 15, v32
  s_mov_b32 s30, 401408
  v_mul_lo_u32 v10, v10, s30
  v_mul_u32_u24 v33, 14336, v33
  v_add_u32 v10, v10, v33
  v_lshl_add_u32 v10, v3, 8, v10
  v_lshl_add_u32 v10, v32, 4, v10
  v_add_u32 v12, 6422528, v10
  s_lshl_b32 s30, s19, 6
  s_add_u32 s30, s30, 16
  v_add_u32 v8, s30, v4
  v_mul_u32_u24 v10, 2341, v8
  v_lshrrev_b32 v10, 16, v10
  v_mul_u32_u24 v11, 28, v10
  v_sub_u32 v32, v8, v11
  s_mul_i32 s30, s17, 28
  v_add_u32 v32, s30, v32
  v_lshrrev_b32 v33, 4, v32
  v_and_b32 v32, 15, v32
  s_mov_b32 s30, 401408
  v_mul_lo_u32 v10, v10, s30
  v_mul_u32_u24 v33, 14336, v33
  v_add_u32 v10, v10, v33
  v_lshl_add_u32 v10, v3, 8, v10
  v_lshl_add_u32 v10, v32, 4, v10
  v_add_u32 v13, 6422528, v10
  s_lshl_b32 s30, s19, 6
  s_add_u32 s30, s30, 32
  v_add_u32 v8, s30, v4
  v_mul_u32_u24 v10, 2341, v8
  v_lshrrev_b32 v10, 16, v10
  v_mul_u32_u24 v11, 28, v10
  v_sub_u32 v32, v8, v11
  s_mul_i32 s30, s17, 28
  v_add_u32 v32, s30, v32
  v_lshrrev_b32 v33, 4, v32
  v_and_b32 v32, 15, v32
  s_mov_b32 s30, 401408
  v_mul_lo_u32 v10, v10, s30
  v_mul_u32_u24 v33, 14336, v33
  v_add_u32 v10, v10, v33
  v_lshl_add_u32 v10, v3, 8, v10
  v_lshl_add_u32 v10, v32, 4, v10
  v_add_u32 v14, 6422528, v10
  s_lshl_b32 s30, s19, 6
  s_add_u32 s30, s30, 48
  v_add_u32 v8, s30, v4
  v_mul_u32_u24 v10, 2341, v8
  v_lshrrev_b32 v10, 16, v10
  v_mul_u32_u24 v11, 28, v10
  v_sub_u32 v32, v8, v11
  s_mul_i32 s30, s17, 28
  v_add_u32 v32, s30, v32
  v_lshrrev_b32 v33, 4, v32
  v_and_b32 v32, 15, v32
  s_mov_b32 s30, 401408
  v_mul_lo_u32 v10, v10, s30
  v_mul_u32_u24 v33, 14336, v33
  v_add_u32 v10, v10, v33
  v_lshl_add_u32 v10, v3, 8, v10
  v_lshl_add_u32 v10, v32, 4, v10
  v_add_u32 v15, 6422528, v10
  v_lshrrev_b32 v7, 2, v4
  v_lshlrev_b32 v7, 3, v7
  v_and_b32 v8, 3, v4
  v_add_u32 v7, v7, v8
  v_xor_b32 v10, v3, v4
  v_lshlrev_b32 v10, 4, v10
  v_lshl_add_u32 v10, v7, 9, v10
  v_add_u32 v10, s25, v10
  v_xor_b32 v32, 0, v10
  v_xor_b32 v33, 64, v10
  v_xor_b32 v34, 128, v10
  v_xor_b32 v35, 192, v10
  v_lshrrev_b32 v7, 2, v4
  v_lshl_add_u32 v7, v3, 3, v7
  v_lshlrev_b32 v7, 7, v7
  v_and_b32 v8, 3, v4
  v_lshl_add_u32 v7, v8, 3, v7
  v_lshrrev_b32 v8, 3, v4
  v_lshl_add_u32 v7, v8, 5, v7
  v_and_b32 v8, 1, v3
  v_lshl_add_u32 v7, v8, 6, v7
  s_waitcnt vmcnt(16)
  s_barrier
  s_cmp_eq_u32 s16, 3
  s_cbranch_scc1 bj_np0
  s_add_u32 m0, s48, 16384
  s_nop 0
  buffer_load_dwordx4 v16, s[60:63], s33 offen offset:0 lds
  buffer_load_dwordx4 v17, s[60:63], s33 offen offset:1024 lds
  buffer_load_dwordx4 v18, s[60:63], s33 offen offset:2048 lds
  buffer_load_dwordx4 v19, s[60:63], s33 offen offset:3072 lds
bj_np0:
  v_xor_b32 v9, 0, v7
  ds_read_b64_tr_b16 v[128:129], v9 offset:0
  ds_read_b64_tr_b16 v[130:131], v9 offset:512
  ds_read_b64_tr_b16 v[132:133], v9 offset:4096
  ds_read_b64_tr_b16 v[134:135], v9 offset:4608
  ds_read_b64_tr_b16 v[136:137], v9 offset:8192
  ds_read_b64_tr_b16 v[138:139], v9 offset:8704
  ds_read_b64_tr_b16 v[140:141], v9 offset:12288
  ds_read_b64_tr_b16 v[142:143], v9 offset:12800
  s_waitcnt lgkmcnt(6)
  ds_read_b64_tr_b16 v[144:145], v9 offset:16384
  ds_read_b64_tr_b16 v[146:147], v9 offset:16896
  ds_read_b64_tr_b16 v[148:149], v9 offset:20480
  ds_read_b64_tr_b16 v[150:151], v9 offset:20992
  ds_read_b64_tr_b16 v[152:153], v9 offset:24576
  ds_read_b64_tr_b16 v[154:155], v9 offset:25088
  ds_read_b64_tr_b16 v[156:157], v9 offset:28672
  ds_read_b64_tr_b16 v[158:159], v9 offset:29184
  s_waitcnt lgkmcnt(6)
  s_cmp_eq_u32 s16, 3
  s_cbranch_scc1 bj_np1
  s_add_u32 m0, s49, 16384
  s_nop 0
  buffer_load_dwordx4 v20, s[60:63], s33 offen offset:0 lds
  buffer_load_dwordx4 v21, s[60:63], s33 offen offset:1024 lds
  buffer_load_dwordx4 v22, s[60:63], s33 offen offset:2048 lds
  buffer_load_dwordx4 v23, s[60:63], s33 offen offset:3072 lds
bj_np1:
  v_xor_b32 v9, 32, v7
  ds_read_b64_tr_b16 v[160:161], v9 offset:0
  ds_read_b64_tr_b16 v[162:163], v9 offset:512
  ds_read_b64_tr_b16 v[164:165], v9 offset:4096
  ds_read_b64_tr_b16 v[166:167], v9 offset:4608
  ds_read_b64_tr_b16 v[168:169], v9 offset:8192
  ds_read_b64_tr_b16 v[170:171], v9 offset:8704
  ds_read_b64_tr_b16 v[172:173], v9 offset:12288
  ds_read_b64_tr_b16 v[174:175], v9 offset:12800
  s_waitcnt lgkmcnt(6)
  ds_read_b64_tr_b16 v[176:177], v9 offset:16384
  ds_read_b64_tr_b16 v[178:179], v9 offset:16896
  ds_read_b64_tr_b16 v[180:181], v9 offset:20480
  ds_read_b64_tr_b16 v[182:183], v9 offset:20992
  ds_read_b64_tr_b16 v[184:185], v9 offset:24576
  ds_read_b64_tr_b16 v[186:187], v9 offset:25088
  ds_read_b64_tr_b16 v[188:189], v9 offset:28672
  ds_read_b64_tr_b16 v[190:191], v9 offset:29184
  s_waitcnt lgkmcnt(6)
  s_cmp_eq_u32 s16, 3
  s_cbranch_scc1 bj_np2
  s_add_u32 m0, s50, 16384
  s_nop 0
  buffer_load_dwordx4 v24, s[60:63], s33 offen offset:0 lds
  buffer_load_dwordx4 v25, s[60:63], s33 offen offset:1024 lds
  buffer_load_dwordx4 v26, s[60:63], s33 offen offset:2048 lds
  buffer_load_dwordx4 v27, s[60:63], s33 offen offset:3072 lds
bj_np2:
  v_xor_b32 v9, 64, v7
  ds_read_b64_tr_b16 v[192:193], v9 offset:0
  ds_read_b64_tr_b16 v[194:195], v9 offset:512
  ds_read_b64_tr_b16 v[196:197], v9 offset:4096
  ds_read_b64_tr_b16 v[198:199], v9 offset:4608
  ds_read_b64_tr_b16 v[200:201], v9 offset:8192
  ds_read_b64_tr_b16 v[202:203], v9 offset:8704
  ds_read_b64_tr_b16 v[204:205], v9 offset:12288
  ds_read_b64_tr_b16 v[206:207], v9 offset:12800
  s_waitcnt lgkmcnt(6)
  ds_read_b64_tr_b16 v[208:209], v9 offset:16384
  ds_read_b64_tr_b16 v[210:211], v9 offset:16896
  ds_read_b64_tr_b16 v[212:213], v9 offset:20480
  ds_read_b64_tr_b16 v[214:215], v9 offset:20992
  ds_read_b64_tr_b16 v[216:217], v9 offset:24576
  ds_read_b64_tr_b16 v[218:219], v9 offset:25088
  ds_read_b64_tr_b16 v[220:221], v9 offset:28672
  ds_read_b64_tr_b16 v[222:223], v9 offset:29184
  s_waitcnt lgkmcnt(6)
  s_cmp_eq_u32 s16, 3
  s_cbranch_scc1 bj_np3
  s_add_u32 m0, s51, 16384
  s_nop 0
  buffer_load_dwordx4 v28, s[60:63], s33 offen offset:0 lds
  buffer_load_dwordx4 v29, s[60:63], s33 offen offset:1024 lds
  buffer_load_dwordx4 v30, s[60:63], s33 offen offset:2048 lds
  buffer_load_dwordx4 v31, s[60:63], s33 offen offset:3072 lds
bj_np3:
  v_xor_b32 v9, 96, v7
  ds_read_b64_tr_b16 v[224:225], v9 offset:0
  ds_read_b64_tr_b16 v[226:227], v9 offset:512
  ds_read_b64_tr_b16 v[228:229], v9 offset:4096
  ds_read_b64_tr_b16 v[230:231], v9 offset:4608
  ds_read_b64_tr_b16 v[232:233], v9 offset:8192
  ds_read_b64_tr_b16 v[234:235], v9 offset:8704
  ds_read_b64_tr_b16 v[236:237], v9 offset:12288
  ds_read_b64_tr_b16 v[238:239], v9 offset:12800
  s_waitcnt lgkmcnt(6)
  ds_read_b64_tr_b16 v[240:241], v9 offset:16384
  ds_read_b64_tr_b16 v[242:243], v9 offset:16896
  ds_read_b64_tr_b16 v[244:245], v9 offset:20480
  ds_read_b64_tr_b16 v[246:247], v9 offset:20992
  ds_read_b64_tr_b16 v[248:249], v9 offset:24576
  ds_read_b64_tr_b16 v[250:251], v9 offset:25088
  ds_read_b64_tr_b16 v[252:253], v9 offset:28672
  ds_read_b64_tr_b16 v[254:255], v9 offset:29184
  s_waitcnt lgkmcnt(6)
  s_mov_b32 s52, s36
  s_and_b32 s53, s37, 0xffff
  s_mov_b32 s54, 1835008
  s_mov_b32 s55, 0x20000
  s_lshl_b32 s20, s18, 8
  v_add_u32 v95, s20, v0
  s_mov_b32 s21, 9586981
  v_mul_hi_u32 v6, v95, s21
  v_mul_u32_u24 v7, 448, v6
  v_sub_u32 v7, v95, v7
  v_lshrrev_b32 v8, 4, v7
  v_and_b32 v7, 15, v7
  v_lshl_add_u32 v9, v6, 4, v7
  v_mul_u32_u24 v9, 896, v9
  v_lshl_add_u32 v9, v8, 5, v9
  buffer_load_dwordx4 v[84:87], v9, s[52:55], 0 offen
  buffer_load_dwordx4 v[88:91], v9, s[52:55], 0 offen offset:16
  v_mul_u32_u24 v6, 14336, v6
  v_lshl_add_u32 v6, v7, 4, v6
  v_lshl_add_u32 v92, v8, 9, v6
  v_lshrrev_b32 v7, 2, v8
  v_lshl_add_u32 v6, v7, 11, v6
  v_and_b32 v7, 3, v8
  v_lshl_add_u32 v93, v7, 8, v6
  s_mov_b32 s72, s38
  s_and_b32 s73, s39, 0xffff
  s_mov_b32 s74, 7168
  s_mov_b32 s75, 0x20000
  v_min_u32 v6, 223, v0
  v_lshrrev_b32 v7, 3, v6
  v_and_b32 v6, 7, v6
  v_mul_u32_u24 v9, 896, v6
  v_lshl_add_u32 v9, v7, 5, v9
  buffer_load_dwordx4 v[36:39], v9, s[72:75], 0 offen
  buffer_load_dwordx4 v[40:43], v9, s[72:75], 0 offen offset:16
  v_lshlrev_b32 v7, 8, v7
  v_lshl_add_u32 v94, v6, 4, v7
  s_lshl_b32 s26, s17, 9
  s_waitcnt vmcnt(20) lgkmcnt(0)
  s_cmp_lg_u32 s16, 3
  s_cbranch_scc1 w3_20
  s_waitcnt vmcnt(4)
w3_20:
  ds_read_b128 v[52:55], v32 offset:0
  ds_read_b128 v[56:59], v33 offset:0
  ds_read_b128 v[60:63], v34 offset:0
  ds_read_b128 v[64:67], v35 offset:0
  s_waitcnt lgkmcnt(3)
  v_mfma_f32_16x16x32_bf16 v[96:99], v[52:55], v[128:131], 0
  v_mfma_f32_16x16x32_bf16 v[100:103], v[52:55], v[160:163], 0
  v_mfma_f32_16x16x32_bf16 v[104:107], v[52:55], v[192:195], 0
  v_mfma_f32_16x16x32_bf16 v[108:111], v[52:55], v[224:227], 0
  ds_read_b128 v[52:55], v32 offset:256
  s_waitcnt lgkmcnt(3)
  v_mfma_f32_16x16x32_bf16 v[96:99], v[56:59], v[132:135], v[96:99]
  v_mfma_f32_16x16x32_bf16 v[100:103], v[56:59], v[164:167], v[100:103]
  v_mfma_f32_16x16x32_bf16 v[104:107], v[56:59], v[196:199], v[104:107]
  v_mfma_f32_16x16x32_bf16 v[108:111], v[56:59], v[228:231], v[108:111]
  ds_read_b128 v[56:59], v33 offset:256
  s_waitcnt lgkmcnt(3)
  v_mfma_f32_16x16x32_bf16 v[96:99], v[60:63], v[136:139], v[96:99]
  v_mfma_f32_16x16x32_bf16 v[100:103], v[60:63], v[168:171], v[100:103]
  v_mfma_f32_16x16x32_bf16 v[104:107], v[60:63], v[200:203], v[104:107]
  v_mfma_f32_16x16x32_bf16 v[108:111], v[60:63], v[232:235], v[108:111]
  ds_read_b128 v[60:63], v34 offset:256
  s_waitcnt lgkmcnt(3)
  v_mfma_f32_16x16x32_bf16 v[96:99], v[64:67], v[140:143], v[96:99]
  v_mfma_f32_16x16x32_bf16 v[100:103], v[64:67], v[172:175], v[100:103]
  v_mfma_f32_16x16x32_bf16 v[104:107], v[64:67], v[204:207], v[104:107]
  v_mfma_f32_16x16x32_bf16 v[108:111], v[64:67], v[236:239], v[108:111]
  ds_read_b128 v[64:67], v35 offset:256
  s_waitcnt lgkmcnt(3)
  v_mfma_f32_16x16x32_bf16 v[96:99], v[52:55], v[144:147], v[96:99]
  v_mfma_f32_16x16x32_bf16 v[100:103], v[52:55], v[176:179], v[100:103]
  v_mfma_f32_16x16x32_bf16 v[104:107], v[52:55], v[208:211], v[104:107]
  v_mfma_f32_16x16x32_bf16 v[108:111], v[52:55], v[240:243], v[108:111]
  ds_read_b128 v[52:55], v32 offset:2048
  s_waitcnt lgkmcnt(3)
  v_mfma_f32_16x16x32_bf16 v[96:99], v[56:59], v[148:151], v[96:99]
  v_mfma_f32_16x16x32_bf16 v[100:103], v[56:59], v[180:183], v[100:103]
  v_mfma_f32_16x16x32_bf16 v[104:107], v[56:59], v[212:215], v[104:107]
  v_mfma_f32_16x16x32_bf16 v[108:111], v[56:59], v[244:247], v[108:111]
  ds_read_b128 v[56:59], v33 offset:2048
  s_waitcnt lgkmcnt(3)
  v_mfma_f32_16x16x32_bf16 v[96:99], v[60:63], v[152:155], v[96:99]
  v_mfma_f32_16x16x32_bf16 v[100:103], v[60:63], v[184:187], v[100:103]
  v_mfma_f32_16x16x32_bf16 v[104:107], v[60:63], v[216:219], v[104:107]
  v_mfma_f32_16x16x32_bf16 v[108:111], v[60:63], v[248:251], v[108:111]
  ds_read_b128 v[60:63], v34 offset:2048
  s_waitcnt lgkmcnt(3)
  v_mfma_f32_16x16x32_bf16 v[96:99], v[64:67], v[156:159], v[96:99]
  v_mfma_f32_16x16x32_bf16 v[100:103], v[64:67], v[188:191], v[100:103]
  v_mfma_f32_16x16x32_bf16 v[104:107], v[64:67], v[220:223], v[104:107]
  v_mfma_f32_16x16x32_bf16 v[108:111], v[64:67], v[252:255], v[108:111]
  ds_read_b128 v[64:67], v35 offset:2048
  s_waitcnt lgkmcnt(3)
  v_mfma_f32_16x16x32_bf16 v[112:115], v[52:55], v[128:131], 0
  v_mfma_f32_16x16x32_bf16 v[116:119], v[52:55], v[160:163], 0
  v_mfma_f32_16x16x32_bf16 v[120:123], v[52:55], v[192:195], 0
  v_mfma_f32_16x16x32_bf16 v[124:127], v[52:55], v[224:227], 0
  ds_read_b128 v[52:55], v32 offset:2304
  s_waitcnt lgkmcnt(3)
  v_mfma_f32_16x16x32_bf16 v[112:115], v[56:59], v[132:135], v[112:115]
  v_mfma_f32_16x16x32_bf16 v[116:119], v[56:59], v[164:167], v[116:119]
  v_mfma_f32_16x16x32_bf16 v[120:123], v[56:59], v[196:199], v[120:123]
  v_mfma_f32_16x16x32_bf16 v[124:127], v[56:59], v[228:231], v[124:127]
  ds_read_b128 v[56:59], v33 offset:2304
  s_waitcnt lgkmcnt(3)
  v_mfma_f32_16x16x32_bf16 v[112:115], v[60:63], v[136:139], v[112:115]
  v_mfma_f32_16x16x32_bf16 v[116:119], v[60:63], v[168:171], v[116:119]
  v_mfma_f32_16x16x32_bf16 v[120:123], v[60:63], v[200:203], v[120:123]
  v_mfma_f32_16x16x32_bf16 v[124:127], v[60:63], v[232:235], v[124:127]
  ds_read_b128 v[60:63], v34 offset:2304
  s_waitcnt lgkmcnt(3)
  v_mfma_f32_16x16x32_bf16 v[112:115], v[64:67], v[140:143], v[112:115]
  v_mfma_f32_16x16x32_bf16 v[116:119], v[64:67], v[172:175], v[116:119]
  v_mfma_f32_16x16x32_bf16 v[120:123], v[64:67], v[204:207], v[120:123]
  v_mfma_f32_16x16x32_bf16 v[124:127], v[64:67], v[236:239], v[124:127]
  ds_read_b128 v[64:67], v35 offset:2304
  s_waitcnt lgkmcnt(3)
  v_mfma_f32_16x16x32_bf16 v[112:115], v[52:55], v[144:147], v[112:115]
  v_mfma_f32_16x16x32_bf16 v[116:119], v[52:55], v[176:179], v[116:119]
  v_mfma_f32_16x16x32_bf16 v[120:123], v[52:55], v[208:211], v[120:123]
  v_mfma_f32_16x16x32_bf16 v[124:127], v[52:55], v[240:243], v[124:127]
  s_waitcnt lgkmcnt(2)
  v_mfma_f32_16x16x32_bf16 v[112:115], v[56:59], v[148:151], v[112:115]
  v_mfma_f32_16x16x32_bf16 v[116:119], v[56:59], v[180:183], v[116:119]
  v_mfma_f32_16x16x32_bf16 v[120:123], v[56:59], v[212:215], v[120:123]
  v_mfma_f32_16x16x32_bf16 v[124:127], v[56:59], v[244:247], v[124:127]
  s_waitcnt lgkmcnt(1)
  v_mfma_f32_16x16x32_bf16 v[112:115], v[60:63], v[152:155], v[112:115]
  v_mfma_f32_16x16x32_bf16 v[116:119], v[60:63], v[184:187], v[116:119]
  v_mfma_f32_16x16x32_bf16 v[120:123], v[60:63], v[216:219], v[120:123]
  v_mfma_f32_16x16x32_bf16 v[124:127], v[60:63], v[248:251], v[124:127]
  s_waitcnt lgkmcnt(0)
  v_mfma_f32_16x16x32_bf16 v[112:115], v[64:67], v[156:159], v[112:115]
  v_mfma_f32_16x16x32_bf16 v[116:119], v[64:67], v[188:191], v[116:119]
  v_mfma_f32_16x16x32_bf16 v[120:123], v[64:67], v[220:223], v[120:123]
  v_mfma_f32_16x16x32_bf16 v[124:127], v[64:67], v[252:255], v[124:127]
  s_lshl_b32 s30, s28, 10
  v_cvt_pk_bf16_f32 v68, v96, v97
  v_cvt_pk_bf16_f32 v69, v98, v99
  v_cvt_pk_bf16_f32 v70, v112, v113
  v_cvt_pk_bf16_f32 v71, v114, v115
  buffer_store_dwordx4 v[68:71], v12, s[8:11], s30 offen sc1
  v_cvt_pk_bf16_f32 v72, v100, v101
  v_cvt_pk_bf16_f32 v73, v102, v103
  v_cvt_pk_bf16_f32 v74, v116, v117
  v_cvt_pk_bf16_f32 v75, v118, v119
  buffer_store_dwordx4 v[72:75], v13, s[8:11], s30 offen sc1
  v_cvt_pk_bf16_f32 v76, v104, v105
  v_cvt_pk_bf16_f32 v77, v106, v107
  v_cvt_pk_bf16_f32 v78, v120, v121
  v_cvt_pk_bf16_f32 v79, v122, v123
  buffer_store_dwordx4 v[76:79], v14, s[8:11], s30 offen sc1
  v_cvt_pk_bf16_f32 v80, v108, v109
  v_cvt_pk_bf16_f32 v81, v110, v111
  v_cvt_pk_bf16_f32 v82, v124, v125
  v_cvt_pk_bf16_f32 v83, v126, v127
  buffer_store_dwordx4 v[80:83], v15, s[8:11], s30 offen sc1
  s_cmp_eq_u32 s16, 3
  s_cbranch_scc1 bj_w3
  s_waitcnt vmcnt(8)
  ds_read_b128 v[52:55], v32 offset:16384
  ds_read_b128 v[56:59], v33 offset:16384
  ds_read_b128 v[60:63], v34 offset:16384
  ds_read_b128 v[64:67], v35 offset:16384
  s_waitcnt lgkmcnt(3)
  v_mfma_f32_16x16x32_bf16 v[96:99], v[52:55], v[128:131], 0
  v_mfma_f32_16x16x32_bf16 v[100:103], v[52:55], v[160:163], 0
  v_mfma_f32_16x16x32_bf16 v[104:107], v[52:55], v[192:195], 0
  v_mfma_f32_16x16x32_bf16 v[108:111], v[52:55], v[224:227], 0
  ds_read_b128 v[52:55], v32 offset:16640
  s_waitcnt lgkmcnt(3)
  v_mfma_f32_16x16x32_bf16 v[96:99], v[56:59], v[132:135], v[96:99]
  v_mfma_f32_16x16x32_bf16 v[100:103], v[56:59], v[164:167], v[100:103]
  v_mfma_f32_16x16x32_bf16 v[104:107], v[56:59], v[196:199], v[104:107]
  v_mfma_f32_16x16x32_bf16 v[108:111], v[56:59], v[228:231], v[108:111]
  ds_read_b128 v[56:59], v33 offset:16640
  s_waitcnt lgkmcnt(3)
  v_mfma_f32_16x16x32_bf16 v[96:99], v[60:63], v[136:139], v[96:99]
  v_mfma_f32_16x16x32_bf16 v[100:103], v[60:63], v[168:171], v[100:103]
  v_mfma_f32_16x16x32_bf16 v[104:107], v[60:63], v[200:203], v[104:107]
  v_mfma_f32_16x16x32_bf16 v[108:111], v[60:63], v[232:235], v[108:111]
  ds_read_b128 v[60:63], v34 offset:16640
  s_waitcnt lgkmcnt(3)
  v_mfma_f32_16x16x32_bf16 v[96:99], v[64:67], v[140:143], v[96:99]
  v_mfma_f32_16x16x32_bf16 v[100:103], v[64:67], v[172:175], v[100:103]
  v_mfma_f32_16x16x32_bf16 v[104:107], v[64:67], v[204:207], v[104:107]
  v_mfma_f32_16x16x32_bf16 v[108:111], v[64:67], v[236:239], v[108:111]
  ds_read_b128 v[64:67], v35 offset:16640
  s_waitcnt lgkmcnt(3)
  v_mfma_f32_16x16x32_bf16 v[96:99], v[52:55], v[144:147], v[96:99]
  v_mfma_f32_16x16x32_bf16 v[100:103], v[52:55], v[176:179], v[100:103]
  v_mfma_f32_16x16x32_bf16 v[104:107], v[52:55], v[208:211], v[104:107]
  v_mfma_f32_16x16x32_bf16 v[108:111], v[52:55], v[240:243], v[108:111]
  ds_read_b128 v[52:55], v32 offset:18432
  s_waitcnt lgkmcnt(3)
  v_mfma_f32_16x16x32_bf16 v[96:99], v[56:59], v[148:151], v[96:99]
  v_mfma_f32_16x16x32_bf16 v[100:103], v[56:59], v[180:183], v[100:103]
  v_mfma_f32_16x16x32_bf16 v[104:107], v[56:59], v[212:215], v[104:107]
  v_mfma_f32_16x16x32_bf16 v[108:111], v[56:59], v[244:247], v[108:111]
  ds_read_b128 v[56:59], v33 offset:18432
  s_waitcnt lgkmcnt(3)
  v_mfma_f32_16x16x32_bf16 v[96:99], v[60:63], v[152:155], v[96:99]
  v_mfma_f32_16x16x32_bf16 v[100:103], v[60:63], v[184:187], v[100:103]
  v_mfma_f32_16x16x32_bf16 v[104:107], v[60:63], v[216:219], v[104:107]
  v_mfma_f32_16x16x32_bf16 v[108:111], v[60:63], v[248:251], v[108:111]
  ds_read_b128 v[60:63], v34 offset:18432
  s_waitcnt lgkmcnt(3)
  v_mfma_f32_16x16x32_bf16 v[96:99], v[64:67], v[156:159], v[96:99]
  v_mfma_f32_16x16x32_bf16 v[100:103], v[64:67], v[188:191], v[100:103]
  v_mfma_f32_16x16x32_bf16 v[104:107], v[64:67], v[220:223], v[104:107]
  v_mfma_f32_16x16x32_bf16 v[108:111], v[64:67], v[252:255], v[108:111]
  ds_read_b128 v[64:67], v35 offset:18432
  s_waitcnt lgkmcnt(3)
  v_mfma_f32_16x16x32_bf16 v[112:115], v[52:55], v[128:131], 0
  v_mfma_f32_16x16x32_bf16 v[116:119], v[52:55], v[160:163], 0
  v_mfma_f32_16x16x32_bf16 v[120:123], v[52:55], v[192:195], 0
  v_mfma_f32_16x16x32_bf16 v[124:127], v[52:55], v[224:227], 0
  ds_read_b128 v[52:55], v32 offset:18688
  s_waitcnt lgkmcnt(3)
  v_mfma_f32_16x16x32_bf16 v[112:115], v[56:59], v[132:135], v[112:115]
  v_mfma_f32_16x16x32_bf16 v[116:119], v[56:59], v[164:167], v[116:119]
  v_mfma_f32_16x16x32_bf16 v[120:123], v[56:59], v[196:199], v[120:123]
  v_mfma_f32_16x16x32_bf16 v[124:127], v[56:59], v[228:231], v[124:127]
  ds_read_b128 v[56:59], v33 offset:18688
  s_waitcnt lgkmcnt(3)
  v_mfma_f32_16x16x32_bf16 v[112:115], v[60:63], v[136:139], v[112:115]
  v_mfma_f32_16x16x32_bf16 v[116:119], v[60:63], v[168:171], v[116:119]
  v_mfma_f32_16x16x32_bf16 v[120:123], v[60:63], v[200:203], v[120:123]
  v_mfma_f32_16x16x32_bf16 v[124:127], v[60:63], v[232:235], v[124:127]
  ds_read_b128 v[60:63], v34 offset:18688
  s_waitcnt lgkmcnt(3)
  v_mfma_f32_16x16x32_bf16 v[112:115], v[64:67], v[140:143], v[112:115]
  v_mfma_f32_16x16x32_bf16 v[116:119], v[64:67], v[172:175], v[116:119]
  v_mfma_f32_16x16x32_bf16 v[120:123], v[64:67], v[204:207], v[120:123]
  v_mfma_f32_16x16x32_bf16 v[124:127], v[64:67], v[236:239], v[124:127]
  ds_read_b128 v[64:67], v35 offset:18688
  s_waitcnt lgkmcnt(3)
  v_mfma_f32_16x16x32_bf16 v[112:115], v[52:55], v[144:147], v[112:115]
  v_mfma_f32_16x16x32_bf16 v[116:119], v[52:55], v[176:179], v[116:119]
  v_mfma_f32_16x16x32_bf16 v[120:123], v[52:55], v[208:211], v[120:123]
  v_mfma_f32_16x16x32_bf16 v[124:127], v[52:55], v[240:243], v[124:127]
  s_waitcnt lgkmcnt(2)
  v_mfma_f32_16x16x32_bf16 v[112:115], v[56:59], v[148:151], v[112:115]
  v_mfma_f32_16x16x32_bf16 v[116:119], v[56:59], v[180:183], v[116:119]
  v_mfma_f32_16x16x32_bf16 v[120:123], v[56:59], v[212:215], v[120:123]
  v_mfma_f32_16x16x32_bf16 v[124:127], v[56:59], v[244:247], v[124:127]
  s_waitcnt lgkmcnt(1)
  v_mfma_f32_16x16x32_bf16 v[112:115], v[60:63], v[152:155], v[112:115]
  v_mfma_f32_16x16x32_bf16 v[116:119], v[60:63], v[184:187], v[116:119]
  v_mfma_f32_16x16x32_bf16 v[120:123], v[60:63], v[216:219], v[120:123]
  v_mfma_f32_16x16x32_bf16 v[124:127], v[60:63], v[248:251], v[124:127]
  s_waitcnt lgkmcnt(0)
  v_mfma_f32_16x16x32_bf16 v[112:115], v[64:67], v[156:159], v[112:115]
  v_mfma_f32_16x16x32_bf16 v[116:119], v[64:67], v[188:191], v[116:119]
  v_mfma_f32_16x16x32_bf16 v[120:123], v[64:67], v[220:223], v[120:123]
  v_mfma_f32_16x16x32_bf16 v[124:127], v[64:67], v[252:255], v[124:127]
  s_lshl_b32 s30, s29, 10
  v_cvt_pk_bf16_f32 v68, v96, v97
  v_cvt_pk_bf16_f32 v69, v98, v99
  v_cvt_pk_bf16_f32 v70, v112, v113
  v_cvt_pk_bf16_f32 v71, v114, v115
  buffer_store_dwordx4 v[68:71], v12, s[8:11], s30 offen sc1
  v_cvt_pk_bf16_f32 v72, v100, v101
  v_cvt_pk_bf16_f32 v73, v102, v103
  v_cvt_pk_bf16_f32 v74, v116, v117
  v_cvt_pk_bf16_f32 v75, v118, v119
  buffer_store_dwordx4 v[72:75], v13, s[8:11], s30 offen sc1
  v_cvt_pk_bf16_f32 v76, v104, v105
  v_cvt_pk_bf16_f32 v77, v106, v107
  v_cvt_pk_bf16_f32 v78, v120, v121
  v_cvt_pk_bf16_f32 v79, v122, v123
  buffer_store_dwordx4 v[76:79], v14, s[8:11], s30 offen sc1
  v_cvt_pk_bf16_f32 v80, v108, v109
  v_cvt_pk_bf16_f32 v81, v110, v111
  v_cvt_pk_bf16_f32 v82, v124, v125
  v_cvt_pk_bf16_f32 v83, v126, v127
  buffer_store_dwordx4 v[80:83], v15, s[8:11], s30 offen sc1
bj_w3:
  s_lshl_b32 s77, s19, 8
  s_lshl_b32 s21, s17, 4
  s_add_u32 s77, s77, s21
  s_cmp_lg_u32 s31, 0
  s_cselect_b32 s21, 8, 0
  s_add_u32 s77, s77, s21
  s_add_u32 s77, s77, 88588288
  s_add_u32 s78, s77, 2048
  s_cmp_lg_u32 s66, 0
  s_cbranch_scc1 bj_cf
  s_cmp_lg_u32 s16, 0
  s_cbranch_scc1 w0_21
  s_waitcnt vmcnt(8)
  v_readfirstlane_b32 s70, v46
  s_cmp_lg_u32 s70, 0
  s_cbranch_scc1 bj_nz
  v_mov_b32 v45, 128
  v_mov_b32 v46, s88
  v_mov_b32 v47, s89
  v_mov_b32 v48, 0
  v_mov_b32 v49, 0
  s_mov_b64 exec, 1
  buffer_atomic_cmpswap_x2 v[46:49], v45, s[12:15], 0 offen sc0
  s_mov_b64 exec, -1
  s_waitcnt vmcnt(0)
  v_readfirstlane_b32 s70, v46
  s_cmp_lg_u32 s70, 0
  s_cbranch_scc1 bj_nz
  v_mov_b32 v46, s88
  v_mov_b32 v47, s89
bj_nz:
w0_21:
  v_mov_b32 v45, 160000
  s_add_u32 s101, s101, 1
  s_barrier
  s_mov_b64 exec, 1
  s_cmp_lg_u32 s16, 0
  s_cbranch_scc1 w0_22
  ds_write_b32 v45, v44 offset:0
  ds_write_b32 v45, v46 offset:4
  ds_write_b32 v45, v47 offset:8
  s_waitcnt lgkmcnt(0)
  v_mov_b32 v44, s101
  ds_write_b32 v45, v44 offset:16
  s_waitcnt lgkmcnt(0)
w0_22:
  s_mov_b64 exec, -1
  s_barrier
  ds_read_b32 v44, v45 offset:0
  ds_read_b32 v46, v45 offset:4
  ds_read_b32 v47, v45 offset:8
  ds_read_b32 v45, v45 offset:16
  s_waitcnt lgkmcnt(0)
  v_readfirstlane_b32 s70, v44
  v_readfirstlane_b32 s88, v46
  v_readfirstlane_b32 s89, v47
  v_cmp_ne_u32 vcc, s101, v45
  s_cbranch_vccnz ch_end
  s_mov_b32 s66, 1
  s_bitcmp1_b32 s70, s3
  s_cbranch_scc1 m_reclaim
bj_cf:
  s_barrier
  s_mov_b32 s56, s40
  s_and_b32 s57, s41, 0xffff
  s_mov_b32 s58, 3670016
  s_mov_b32 s59, 0x20000
  s_mov_b32 s60, s42
  s_and_b32 s61, s43, 0xffff
  s_mov_b32 s62, 3670016
  s_mov_b32 s63, 0x20000
  s_add_u32 s28, s31, s19
  v_lshrrev_b32 v5, 5, v1
  v_and_b32 v6, 31, v1
  v_xor_b32 v6, v6, v5
  v_lshlrev_b32 v6, 4, v6
  v_lshl_add_u32 v6, v5, 13, v6
  s_lshl_b32 s20, s16, 6
  v_xor_b32 v7, s20, v6
  s_lshl_b32 s22, s28, 18
  s_lshl_b32 s21, s16, 16
  s_add_u32 s22, s22, s21
  s_add_u32 s22, s22, s26
  s_lshl_b32 m0, s16, 12
  v_xor_b32 v8, 0, v7
  buffer_load_dwordx4 v8, s[56:59], s22 offen offset:0 lds
  v_xor_b32 v8, 32, v7
  v_add_u32 v8, 15360, v8
  buffer_load_dwordx4 v8, s[56:59], s22 offen offset:1024 lds
  v_xor_b32 v8, 0, v7
  v_add_u32 v8, 30720, v8
  buffer_load_dwordx4 v8, s[56:59], s22 offen offset:2048 lds
  v_xor_b32 v8, 32, v7
  v_add_u32 v8, 46080, v8
  buffer_load_dwordx4 v8, s[56:59], s22 offen offset:3072 lds
  v_xor_b32 v16, 0, v6
  v_xor_b32 v17, 32, v6
  v_add_u32 v17, 31744, v17
  v_xor_b32 v18, 64, v6
  v_add_u32 v18, 129024, v18
  v_xor_b32 v19, 96, v6
  v_add_u32 v19, 160768, v19
  v_xor_b32 v20, 128, v6
  v_add_u32 v20, 262144, v20
  v_xor_b32 v21, 160, v6
  v_add_u32 v21, 293888, v21
  v_xor_b32 v22, 192, v6
  v_add_u32 v22, 391168, v22
  v_xor_b32 v23, 224, v6
  v_add_u32 v23, 422912, v23
  s_lshr_b32 s20, s16, 1
  s_lshl_b32 s20, s20, 16
  s_and_b32 s21, s16, 1
  s_lshl_b32 s21, s21, 14
  s_add_u32 s20, s20, s21
  s_add_u32 s29, s20, s26
  s_mul_i32 s25, s16, 24576
  s_add_u32 s25, s25, 16384
  s_add_u32 s22, s29, 2097152
  s_add_u32 m0, s25, 0
  s_nop 0
  buffer_load_dwordx4 v16, s[60:63], s22 offen offset:0 lds
  buffer_load_dwordx4 v17, s[60:63], s22 offen offset:1024 lds
  buffer_load_dwordx4 v18, s[60:63], s22 offen offset:2048 lds
  buffer_load_dwordx4 v19, s[60:63], s22 offen offset:3072 lds
  s_add_u32 m0, s25, 4096
  s_nop 0
  buffer_load_dwordx4 v20, s[60:63], s22 offen offset:0 lds
  buffer_load_dwordx4 v21, s[60:63], s22 offen offset:1024 lds
  buffer_load_dwordx4 v22, s[60:63], s22 offen offset:2048 lds
  buffer_load_dwordx4 v23, s[60:63], s22 offen offset:3072 lds
  s_waitcnt vmcnt(12)
  s_barrier
  s_cmp_lg_u32 s16, 0
  s_cbranch_scc1 pub_23
  v_mul_u32_u24 v50, 2048, v1
  v_mov_b32 v48, s88
  v_mov_b32 v49, s89
  s_mov_b64 exec, 1
  buffer_store_dwordx2 v[48:49], v50, s[8:11], s77 offen sc1
  s_mov_b64 exec, -1
pub_23:
  s_cmp_ge_u32 s18, 70
  s_cbranch_scc1 bk_nm
  s_mov_b32 s20, 71565312
  buffer_store_dwordx4 v[84:87], v92, s[8:11], s20 offen sc1
  buffer_store_dwordx4 v[88:91], v92, s[8:11], s20 offen offset:256 sc1
  s_cmp_lg_u32 s18, 0
  s_cbranch_scc1 bk_nm
  v_min_u32 v104, -2, v36
  v_min_u32 v108, -2, v37
  v_min_u32 v105, -2, v38
  v_min_u32 v109, -2, v39
  v_min_u32 v106, -2, v40
  v_min_u32 v110, -2, v41
  v_min_u32 v107, -2, v42
  v_min_u32 v111, -2, v43
  s_mov_b32 s20, 75235328
  s_mov_b32 s21, 88068096
  buffer_store_dwordx4 v[104:107], v94, s[8:11], s20 offen sc1
  buffer_store_dwordx4 v[108:111], v94, s[8:11], s20 offen offset:128 sc1
  buffer_store_dwordx4 v[104:107], v94, s[8:11], s21 offen sc1
  buffer_store_dwordx4 v[108:111], v94, s[8:11], s21 offen offset:128 sc1
bk_nm:
  s_mov_b32 s23, 75235328
  v_add_u32 v6, 448, v95
  v_subrev_u32 v7, 1344, v6
  v_mov_b32 v52, -1
  v_mov_b32 v9, 0
  v_cmp_gt_u32 vcc, 256, v7
  s_nop 1
  v_cndmask_b32 v52, v52, v9, vcc
  v_mov_b32 v53, v52
  v_mov_b32 v54, v52
  v_mov_b32 v55, v52
  v_lshlrev_b32 v8, 4, v6
  v_mov_b32 v9, 0x10000000
  v_cmp_lt_u32 vcc, 31999, v6
  s_nop 1
  v_cndmask_b32 v8, v8, v9, vcc
  buffer_store_dwordx4 v[52:55], v8, s[8:11], s23 offen sc1
  s_mov_b32 s23, 87945216
  v_add_u32 v6, 448, v95
  v_cmp_gt_u32 vcc, 7680, v95
  s_nop 1
  v_cndmask_b32 v6, v6, v95, vcc
  v_subrev_u32 v7, 36352, v6
  v_mov_b32 v56, -1
  v_mov_b32 v9, 0
  v_cmp_gt_u32 vcc, 1048576, v7
  s_nop 1
  v_cndmask_b32 v56, v56, v9, vcc
  v_mov_b32 v57, v56
  v_mov_b32 v58, v56
  v_mov_b32 v59, v56
  v_lshlrev_b32 v8, 4, v6
  v_mov_b32 v9, 0x10000000
  v_cmp_lt_u32 vcc, 40191, v6
  s_nop 1
  v_cndmask_b32 v8, v8, v9, vcc
  buffer_store_dwordx4 v[56:59], v8, s[8:11], s23 offen sc1
  s_add_u32 s22, s29, 2621440
  s_add_u32 m0, s25, 8192
  s_nop 0
  buffer_load_dwordx4 v16, s[60:63], s22 offen offset:0 lds
  buffer_load_dwordx4 v17, s[60:63], s22 offen offset:1024 lds
  buffer_load_dwordx4 v18, s[60:63], s22 offen offset:2048 lds
  buffer_load_dwordx4 v19, s[60:63], s22 offen offset:3072 lds
  s_add_u32 m0, s25, 12288
  s_nop 0
  buffer_load_dwordx4 v20, s[60:63], s22 offen offset:0 lds
  buffer_load_dwordx4 v21, s[60:63], s22 offen offset:1024 lds
  buffer_load_dwordx4 v22, s[60:63], s22 offen offset:2048 lds
  buffer_load_dwordx4 v23, s[60:63], s22 offen offset:3072 lds
  s_add_u32 s22, s29, 3145728
  s_add_u32 m0, s25, 16384
  s_nop 0
  buffer_load_dwordx4 v16, s[60:63], s22 offen offset:0 lds
  buffer_load_dwordx4 v17, s[60:63], s22 offen offset:1024 lds
  buffer_load_dwordx4 v18, s[60:63], s22 offen offset:2048 lds
  buffer_load_dwordx4 v19, s[60:63], s22 offen offset:3072 lds
  s_add_u32 m0, s25, 20480
  s_nop 0
  buffer_load_dwordx4 v20, s[60:63], s22 offen offset:0 lds
  buffer_load_dwordx4 v21, s[60:63], s22 offen offset:1024 lds
  buffer_load_dwordx4 v22, s[60:63], s22 offen offset:2048 lds
  buffer_load_dwordx4 v23, s[60:63], s22 offen offset:3072 lds
  v_mov_b32 v250, s68
  s_or_b32 s20, s69, s16
  s_cbranch_scc1 bj_ht
  s_cmp_lg_u32 s16, 0
  s_cbranch_scc1 w0_24
  v_mov_b32 v250, 1
  v_mov_b32 v251, 192
  s_mov_b64 exec, 1
  buffer_atomic_add v250, v251, s[12:15], 0 offen sc0
  s_mov_b64 exec, -1
w0_24:
  s_branch bj_h2
bj_ht:
  buffer_load_dword v251, off, s[8:11], s77
bj_h2:
  v_lshrrev_b32 v7, 2, v4
  v_lshlrev_b32 v7, 3, v7
  v_and_b32 v8, 3, v4
  v_add_u32 v7, v7, v8
  v_xor_b32 v10, v3, v4
  v_lshlrev_b32 v10, 4, v10
  v_lshl_add_u32 v11, v4, 9, v10
  v_add_u32 v11, s25, v11
  v_lshl_add_u32 v10, v7, 9, v10
  v_xor_b32 v32, 0, v10
  v_xor_b32 v36, 0, v11
  v_xor_b32 v33, 64, v10
  v_xor_b32 v37, 64, v11
  v_xor_b32 v34, 128, v10
  v_xor_b32 v38, 128, v11
  v_xor_b32 v35, 192, v10
  v_xor_b32 v39, 192, v11
  s_mul_i32 s30, s17, 401408
  s_mul_i32 s20, s16, 14336
  s_add_u32 s30, s30, s20
  s_lshl_b32 s20, s28, 10
  s_add_u32 s30, s30, s20
  s_mov_b32 s24, 1035512379
  s_lshl_b32 s20, s17, 7
  s_lshl_b32 s28, s28, 3
  s_add_u32 s28, s28, s20
  s_add_u32 s28, s28, 88623104
  s_waitcnt vmcnt(1)
  s_barrier
  s_cmp_lg_u32 s16, 0
  s_cbranch_scc1 w0_25
  v_mul_u32_u24 v50, 2048, v1
  v_mov_b32 v48, s88
  v_mov_b32 v49, s89
  s_mov_b64 exec, 511
  buffer_store_dwordx2 v[48:49], v50, s[8:11], s78 offen sc1
  s_mov_b64 exec, -1
w0_25:
  ds_read_b128 v[128:131], v32 offset:0
  ds_read_b128 v[132:135], v32 offset:2048
  ds_read_b128 v[136:139], v36 offset:0
  ds_read_b128 v[140:143], v36 offset:8192
  ds_read_b128 v[144:147], v36 offset:16384
  ds_read_b128 v[148:151], v33 offset:0
  ds_read_b128 v[152:155], v33 offset:2048
  ds_read_b128 v[156:159], v37 offset:0
  ds_read_b128 v[160:163], v37 offset:8192
  ds_read_b128 v[164:167], v37 offset:16384
  ds_read_b128 v[168:171], v34 offset:0
  ds_read_b128 v[172:175], v34 offset:2048
  ds_read_b128 v[176:179], v38 offset:0
  ds_read_b128 v[180:183], v38 offset:8192
  ds_read_b128 v[184:187], v38 offset:16384
  s_waitcnt lgkmcnt(10)
  v_mfma_f32_16x16x32_bf16 v[96:99], v[128:131], v[136:139], 0
  v_mfma_f32_16x16x32_bf16 v[100:103], v[132:135], v[136:139], 0
  v_mfma_f32_16x16x32_bf16 v[104:107], v[128:131], v[140:143], 0
  v_mfma_f32_16x16x32_bf16 v[108:111], v[132:135], v[140:143], 0
  v_mfma_f32_16x16x32_bf16 v[112:115], v[128:131], v[144:147], 0
  v_mfma_f32_16x16x32_bf16 v[116:119], v[132:135], v[144:147], 0
  ds_read_b128 v[128:131], v35 offset:0
  ds_read_b128 v[132:135], v35 offset:2048
  ds_read_b128 v[136:139], v39 offset:0
  ds_read_b128 v[140:143], v39 offset:8192
  ds_read_b128 v[144:147], v39 offset:16384
  s_waitcnt lgkmcnt(10)
  v_mfma_f32_16x16x32_bf16 v[96:99], v[148:151], v[156:159], v[96:99]
  v_mfma_f32_16x16x32_bf16 v[100:103], v[152:155], v[156:159], v[100:103]
  v_mfma_f32_16x16x32_bf16 v[104:107], v[148:151], v[160:163], v[104:107]
  v_mfma_f32_16x16x32_bf16 v[108:111], v[152:155], v[160:163], v[108:111]
  v_mfma_f32_16x16x32_bf16 v[112:115], v[148:151], v[164:167], v[112:115]
  v_mfma_f32_16x16x32_bf16 v[116:119], v[152:155], v[164:167], v[116:119]
  ds_read_b128 v[148:151], v32 offset:256
  ds_read_b128 v[152:155], v32 offset:2304
  ds_read_b128 v[156:159], v36 offset:256
  ds_read_b128 v[160:163], v36 offset:8448
  ds_read_b128 v[164:167], v36 offset:16640
  s_waitcnt lgkmcnt(10)
  v_mfma_f32_16x16x32_bf16 v[96:99], v[168:171], v[176:179], v[96:99]
  v_mfma_f32_16x16x32_bf16 v[100:103], v[172:175], v[176:179], v[100:103]
  v_mfma_f32_16x16x32_bf16 v[104:107], v[168:171], v[180:183], v[104:107]
  v_mfma_f32_16x16x32_bf16 v[108:111], v[172:175], v[180:183], v[108:111]
  v_mfma_f32_16x16x32_bf16 v[112:115], v[168:171], v[184:187], v[112:115]
  v_mfma_f32_16x16x32_bf16 v[116:119], v[172:175], v[184:187], v[116:119]
  ds_read_b128 v[168:171], v33 offset:256
  ds_read_b128 v[172:175], v33 offset:2304
  ds_read_b128 v[176:179], v37 offset:256
  ds_read_b128 v[180:183], v37 offset:8448
  ds_read_b128 v[184:187], v37 offset:16640
  s_waitcnt lgkmcnt(10)
  v_mfma_f32_16x16x32_bf16 v[96:99], v[128:131], v[136:139], v[96:99]
  v_mfma_f32_16x16x32_bf16 v[100:103], v[132:135], v[136:139], v[100:103]
  v_mfma_f32_16x16x32_bf16 v[104:107], v[128:131], v[140:143], v[104:107]
  v_mfma_f32_16x16x32_bf16 v[108:111], v[132:135], v[140:143], v[108:111]
  v_mfma_f32_16x16x32_bf16 v[112:115], v[128:131], v[144:147], v[112:115]
  v_mfma_f32_16x16x32_bf16 v[116:119], v[132:135], v[144:147], v[116:119]
  ds_read_b128 v[128:131], v34 offset:256
  ds_read_b128 v[132:135], v34 offset:2304
  ds_read_b128 v[136:139], v38 offset:256
  ds_read_b128 v[140:143], v38 offset:8448
  ds_read_b128 v[144:147], v38 offset:16640
  s_waitcnt lgkmcnt(10)
  v_mfma_f32_16x16x32_bf16 v[96:99], v[148:151], v[156:159], v[96:99]
  v_mfma_f32_16x16x32_bf16 v[100:103], v[152:155], v[156:159], v[100:103]
  v_mfma_f32_16x16x32_bf16 v[104:107], v[148:151], v[160:163], v[104:107]
  v_mfma_f32_16x16x32_bf16 v[108:111], v[152:155], v[160:163], v[108:111]
  v_mfma_f32_16x16x32_bf16 v[112:115], v[148:151], v[164:167], v[112:115]
  v_mfma_f32_16x16x32_bf16 v[116:119], v[152:155], v[164:167], v[116:119]
  ds_read_b128 v[148:151], v35 offset:256
  ds_read_b128 v[152:155], v35 offset:2304
  ds_read_b128 v[156:159], v39 offset:256
  ds_read_b128 v[160:163], v39 offset:8448
  ds_read_b128 v[164:167], v39 offset:16640
  s_waitcnt lgkmcnt(10)
  v_mfma_f32_16x16x32_bf16 v[96:99], v[168:171], v[176:179], v[96:99]
  v_mfma_f32_16x16x32_bf16 v[100:103], v[172:175], v[176:179], v[100:103]
  v_mfma_f32_16x16x32_bf16 v[104:107], v[168:171], v[180:183], v[104:107]
  v_mfma_f32_16x16x32_bf16 v[108:111], v[172:175], v[180:183], v[108:111]
  v_mfma_f32_16x16x32_bf16 v[112:115], v[168:171], v[184:187], v[112:115]
  v_mfma_f32_16x16x32_bf16 v[116:119], v[172:175], v[184:187], v[116:119]
  s_waitcnt lgkmcnt(5)
  v_mfma_f32_16x16x32_bf16 v[96:99], v[128:131], v[136:139], v[96:99]
  v_mfma_f32_16x16x32_bf16 v[100:103], v[132:135], v[136:139], v[100:103]
  v_mfma_f32_16x16x32_bf16 v[104:107], v[128:131], v[140:143], v[104:107]
  v_mfma_f32_16x16x32_bf16 v[108:111], v[132:135], v[140:143], v[108:111]
  v_mfma_f32_16x16x32_bf16 v[112:115], v[128:131], v[144:147], v[112:115]
  v_mfma_f32_16x16x32_bf16 v[116:119], v[132:135], v[144:147], v[116:119]
  s_waitcnt lgkmcnt(0)
  v_mfma_f32_16x16x32_bf16 v[96:99], v[148:151], v[156:159], v[96:99]
  v_mfma_f32_16x16x32_bf16 v[100:103], v[152:155], v[156:159], v[100:103]
  v_mfma_f32_16x16x32_bf16 v[104:107], v[148:151], v[160:163], v[104:107]
  v_mfma_f32_16x16x32_bf16 v[108:111], v[152:155], v[160:163], v[108:111]
  v_mfma_f32_16x16x32_bf16 v[112:115], v[148:151], v[164:167], v[112:115]
  v_mfma_f32_16x16x32_bf16 v[116:119], v[152:155], v[164:167], v[116:119]
  v_mul_f32 v96, s24, v96
  v_mul_f32 v97, s24, v97
  v_mul_f32 v98, s24, v98
  v_mul_f32 v99, s24, v99
  v_mul_f32 v100, s24, v100
  v_mul_f32 v101, s24, v101
  v_mul_f32 v102, s24, v102
  v_mul_f32 v103, s24, v103
  v_cvt_pk_bf16_f32 v68, v96, v97
  v_cvt_pk_bf16_f32 v69, v98, v99
  v_cvt_pk_bf16_f32 v70, v100, v101
  v_cvt_pk_bf16_f32 v71, v102, v103
  s_add_u32 s20, s30, 229376
  buffer_store_dwordx4 v[68:71], v2, s[8:11], s20 offen sc1
  v_mul_f32 v104, s24, v104
  v_mul_f32 v105, s24, v105
  v_mul_f32 v106, s24, v106
  v_mul_f32 v107, s24, v107
  v_mul_f32 v108, s24, v108
  v_mul_f32 v109, s24, v109
  v_mul_f32 v110, s24, v110
  v_mul_f32 v111, s24, v111
  v_cvt_pk_bf16_f32 v72, v104, v105
  v_cvt_pk_bf16_f32 v73, v106, v107
  v_cvt_pk_bf16_f32 v74, v108, v109
  v_cvt_pk_bf16_f32 v75, v110, v111
  s_add_u32 s20, s30, 286720
  buffer_store_dwordx4 v[72:75], v2, s[8:11], s20 offen sc1
  v_mul_f32 v112, s24, v112
  v_mul_f32 v113, s24, v113
  v_mul_f32 v114, s24, v114
  v_mul_f32 v115, s24, v115
  v_mul_f32 v116, s24, v116
  v_mul_f32 v117, s24, v117
  v_mul_f32 v118, s24, v118
  v_mul_f32 v119, s24, v119
  v_cvt_pk_bf16_f32 v76, v112, v113
  v_cvt_pk_bf16_f32 v77, v114, v115
  v_cvt_pk_bf16_f32 v78, v116, v117
  v_cvt_pk_bf16_f32 v79, v118, v119
  s_add_u32 s20, s30, 344064
  buffer_store_dwordx4 v[76:79], v2, s[8:11], s20 offen sc1
  s_waitcnt vmcnt(0)
  s_barrier
  s_cmp_lg_u32 s16, 0
  s_cbranch_scc1 pub_26
  v_mul_u32_u24 v26, 2048, v1
  v_mov_b32 v24, s88
  v_mov_b32 v25, s89
  s_mov_b64 exec, 1
  buffer_store_dwordx2 v[24:25], v26, s[8:11], s28 offen sc1
  s_mov_b64 exec, -1
pub_26:
  v_mov_b32 v6, 160000
  s_add_u32 s101, s101, 1
  s_barrier
  s_mov_b64 exec, 1
  s_cmp_lg_u32 s16, 0
  s_cbranch_scc1 w0_27
  ds_write_b32 v6, v250 offset:0
  s_waitcnt lgkmcnt(0)
  v_mov_b32 v250, s101
  ds_write_b32 v6, v250 offset:16
  s_waitcnt lgkmcnt(0)
w0_27:
  s_mov_b64 exec, -1
  s_barrier
  ds_read_b32 v250, v6 offset:0
  ds_read_b32 v6, v6 offset:16
  s_waitcnt lgkmcnt(0)
  v_readfirstlane_b32 s3, v250
  v_cmp_ne_u32 vcc, s101, v6
  s_cbranch_vccnz ch_end
  s_branch wk_have
wk_loop:
  s_waitcnt vmcnt(0) lgkmcnt(0)
  s_cmp_eq_u32 s96, 1
  s_cbranch_scc1 wk_ask
  s_mov_b32 s96, 1
  s_cmp_lg_u32 s16, 0
  s_cbranch_scc1 w0_28
  s_mov_b32 s30, 0
  v_mov_b32 v243, 32
sf_l:
  buffer_load_dword v242, v243, s[12:15], 0 offen sc1
  s_waitcnt vmcnt(0)
  v_readfirstlane_b32 s70, v242
  s_cmp_eq_u32 s70, -1
  s_cbranch_scc1 sf_d
  s_sleep 16
  s_add_u32 s30, s30, 1
  s_cmp_lt_u32 s30, 64
  s_cbranch_scc1 sf_l
  s_mov_b32 s20, 0
  s_mov_b32 s21, 0
  s_mov_b64 exec, 1
sf_c_l:
  s_cmp_lg_u32 s70, -1
  s_cbranch_scc1 sf_c_t
  s_add_u32 s20, s20, 1
  s_cmp_lt_u32 s20, 8
  s_cselect_b32 s20, s20, 0
  s_mov_b32 s70, 0
  s_mov_b32 s3, -1
  s_add_u32 s21, s21, 1
  s_cmp_ge_u32 s21, 1
  s_cbranch_scc1 sf_c_d
sf_c_t:
  s_ff0_i32_b32 s22, s70
  s_lshl_b32 s23, 1, s22
  s_and_b32 s71, s20, 4
  s_mul_i32 s71, s71, 12
  s_lshl_b32 s3, s20, 2
  s_add_u32 s3, s3, s71
  v_mov_b32 v242, s23
  v_mov_b32 v243, 32
  buffer_atomic_or v242, v243, s[12:15], s3 offen sc0
  s_waitcnt vmcnt(0)
  v_readfirstlane_b32 s70, v242
  s_lshl_b32 s3, s20, 5
  s_add_u32 s3, s3, s22
  s_bitcmp1_b32 s70, s22
  s_cbranch_scc1 sf_c_l
sf_c_d:
  s_mov_b64 exec, -1
  v_mov_b32 v242, s3
sf_d:
w0_28:
  v_mov_b32 v243, 160000
  s_add_u32 s101, s101, 1
  s_barrier
  s_mov_b64 exec, 1
  s_cmp_lg_u32 s16, 0
  s_cbranch_scc1 w0_29
  ds_write_b32 v243, v242 offset:0
  s_waitcnt lgkmcnt(0)
  v_mov_b32 v242, s101
  ds_write_b32 v243, v242 offset:16
  s_waitcnt lgkmcnt(0)
w0_29:
  s_mov_b64 exec, -1
  s_barrier
  ds_read_b32 v242, v243 offset:0
  ds_read_b32 v243, v243 offset:16
  s_waitcnt lgkmcnt(0)
  v_readfirstlane_b32 s3, v242
  v_cmp_ne_u32 vcc, s101, v243
  s_cbranch_vccnz ch_end
  s_cmp_eq_u32 s3, -1
  s_cbranch_scc1 wk_ask
  s_load_dwordx8 s[36:43], s[0:1], 56
  s_load_dwordx4 s[44:47], s[0:1], 88
  s_getreg_b32 s67, hwreg(HW_REG_XCC_ID)
  s_and_b32 s67, s67, 7
  s_mov_b32 s66, 1
  s_waitcnt lgkmcnt(0)
  s_branch m_start
wk_ask:
  v_readfirstlane_b32 s22, v250
  s_cmp_ge_u32 s22, 1376
  s_cbranch_scc1 wk_next
  s_cmp_lg_u32 s16, 0
  s_cbranch_scc1 w0_30
  v_mov_b32 v250, 1
  v_mov_b32 v251, 192
  s_mov_b64 exec, 1
  buffer_atomic_add v250, v251, s[12:15], 0 offen sc0
  s_mov_b64 exec, -1
w0_30:
wk_next:
  s_waitcnt vmcnt(0)
  v_mov_b32 v6, 160000
  s_add_u32 s101, s101, 1
  s_barrier
  s_mov_b64 exec, 1
  s_cmp_lg_u32 s16, 0
  s_cbranch_scc1 w0_31
  ds_write_b32 v6, v250 offset:0
  s_waitcnt lgkmcnt(0)
  v_mov_b32 v250, s101
  ds_write_b32 v6, v250 offset:16
  s_waitcnt lgkmcnt(0)
w0_31:
  s_mov_b64 exec, -1
  s_barrier
  ds_read_b32 v250, v6 offset:0
  ds_read_b32 v6, v6 offset:16
  s_waitcnt lgkmcnt(0)
  v_readfirstlane_b32 s3, v250
  v_cmp_ne_u32 vcc, s101, v6
  s_cbranch_vccnz ch_end
wk_have:
  s_cmp_ge_u32 s3, 1376
  s_cbranch_scc1 ch_end
  v_mov_b32 v250, 0
  v_mov_b32 v251, 192
  v_and_b32 v1, 63, v0
  v_lshlrev_b32 v2, 4, v1
  v_lshrrev_b32 v3, 4, v1
  v_and_b32 v4, 15, v1
  s_cmp_lg_u32 s97, 0
  s_cbranch_scc1 wk_go
  s_mov_b32 s68, s3
  s_mov_b32 s69, 1
  s_cmp_lg_u32 s16, 0
  s_cbranch_scc1 w0_32
  s_add_u32 s20, s67, 1
  s_lshl_b32 s22, s20, 11
  s_add_u32 s22, s22, 88590336
  v_add_u32 v24, 1024, v2
  v_min_u32 v24, 1776, v24
  s_mov_b32 s30, 0
wk_af:
  buffer_load_dwordx4 v[28:31], v2, s[8:11], s22 offen sc1
  buffer_load_dwordx4 v[32:35], v24, s[8:11], s22 offen sc1
  s_waitcnt vmcnt(0)
  v_cmp_ne_u64 vcc, s[88:89], v[28:29]
  s_cbranch_vccnz wk_af_no
  v_cmp_ne_u64 vcc, s[88:89], v[30:31]
  s_cbranch_vccnz wk_af_no
  v_cmp_ne_u64 vcc, s[88:89], v[32:33]
  s_cbranch_vccnz wk_af_no
  v_cmp_ne_u64 vcc, s[88:89], v[34:35]
  s_cbranch_vccnz wk_af_no
  s_branch wk_af_ok
wk_af_no:
  s_sleep 4
  s_add_u32 s30, s30, 1
  s_and_b32 s20, s30, 63
  s_cbranch_scc1 wk_ns
  s_mov_b32 s20, 1
  s_mov_b32 s70, 0
  s_mov_b32 s21, 0
  s_mov_b64 exec, 1
wk_st_l:
  s_cmp_lg_u32 s70, -1
  s_cbranch_scc1 wk_st_t
  s_add_u32 s20, s20, 1
  s_cmp_lt_u32 s20, 8
  s_cselect_b32 s20, s20, 1
  s_mov_b32 s70, 0
  s_mov_b32 s3, -1
  s_add_u32 s21, s21, 1
  s_cmp_ge_u32 s21, 7
  s_cbranch_scc1 wk_st_d
wk_st_t:
  s_ff0_i32_b32 s22, s70
  s_lshl_b32 s23, 1, s22
  s_and_b32 s71, s20, 4
  s_mul_i32 s71, s71, 12
  s_lshl_b32 s3, s20, 2
  s_add_u32 s3, s3, s71
  v_mov_b32 v242, s23
  v_mov_b32 v243, 32
  buffer_atomic_or v242, v243, s[12:15], s3 offen sc0
  s_waitcnt vmcnt(0)
  v_readfirstlane_b32 s70, v242
  s_lshl_b32 s3, s20, 5
  s_add_u32 s3, s3, s22
  s_bitcmp1_b32 s70, s22
  s_cbranch_scc1 wk_st_l
wk_st_d:
  s_mov_b64 exec, -1
  v_mov_b32 v242, s3
  s_cmp_lg_u32 s3, -1
  s_cbranch_scc1 wk_pd
  s_add_u32 s20, s67, 1
  s_lshl_b32 s22, s20, 11
  s_add_u32 s22, s22, 88590336
wk_ns:
  s_cmp_lt_u32 s30, 50000
  s_cbranch_scc1 wk_af
  s_branch cA_abort
wk_af_ok:
  v_mov_b32 v242, -1
wk_pd:
w0_32:
  v_mov_b32 v243, 160000
  s_add_u32 s101, s101, 1
  s_barrier
  s_mov_b64 exec, 1
  s_cmp_lg_u32 s16, 0
  s_cbranch_scc1 w0_33
  ds_write_b32 v243, v242 offset:0
  s_waitcnt lgkmcnt(0)
  v_mov_b32 v242, s101
  ds_write_b32 v243, v242 offset:16
  s_waitcnt lgkmcnt(0)
w0_33:
  s_mov_b64 exec, -1
  s_barrier
  ds_read_b32 v242, v243 offset:0
  ds_read_b32 v243, v243 offset:16
  s_waitcnt lgkmcnt(0)
  v_readfirstlane_b32 s3, v242
  v_cmp_ne_u32 vcc, s101, v243
  s_cbranch_vccnz ch_end
  s_cmp_lg_u32 s3, -1
  s_cbranch_scc1 m_bjob
  s_mov_b32 s3, s68
  s_mov_b32 s97, 1
wk_go:
  s_cmp_lt_u32 s3, 368
  s_cbranch_scc1 wk_g2
  s_sub_u32 s20, s3, 432
  s_cmp_lt_u32 s20, 128
  s_cbranch_scc1 wk_g2
  s_cmp_eq_u32 s97, 2
  s_cbranch_scc1 wk_g2
  s_getreg_b32 s20, hwreg(HW_REG_XCC_ID)
  s_and_b32 s20, s20, 7
  s_cmp_lg_u32 s16, 0
  s_cbranch_scc1 w0_34
  s_lshl_b32 s22, s20, 11
  s_add_u32 s22, s22, 88625152
  v_add_u32 v24, 1024, v2
  v_min_u32 v24, 1776, v24
  s_mov_b32 s30, 0
wk_i2:
  buffer_load_dwordx4 v[28:31], v2, s[8:11], s22 offen sc1
  buffer_load_dwordx4 v[32:35], v24, s[8:11], s22 offen sc1
  s_waitcnt vmcnt(0)
  v_cmp_ne_u64 vcc, s[88:89], v[28:29]
  s_cbranch_vccnz wk_i2_no
  v_cmp_ne_u64 vcc, s[88:89], v[30:31]
  s_cbranch_vccnz wk_i2_no
  v_cmp_ne_u64 vcc, s[88:89], v[32:33]
  s_cbranch_vccnz wk_i2_no
  v_cmp_ne_u64 vcc, s[88:89], v[34:35]
  s_cbranch_vccnz wk_i2_no
  s_branch wk_i2_ok
wk_i2_no:
  s_sleep 4
  s_add_u32 s30, s30, 1
  s_cmp_lt_u32 s30, 50000
  s_cbranch_scc1 wk_i2
  s_branch cA_abort
wk_i2_ok:
w0_34:
  v_mov_b32 v242, 0
  v_mov_b32 v243, 160000
  s_add_u32 s101, s101, 1
  s_barrier
  s_mov_b64 exec, 1
  s_cmp_lg_u32 s16, 0
  s_cbranch_scc1 w0_35
  ds_write_b32 v243, v242 offset:0
  s_waitcnt lgkmcnt(0)
  v_mov_b32 v242, s101
  ds_write_b32 v243, v242 offset:16
  s_waitcnt lgkmcnt(0)
w0_35:
  s_mov_b64 exec, -1
  s_barrier
  ds_read_b32 v242, v243 offset:0
  ds_read_b32 v243, v243 offset:16
  s_waitcnt lgkmcnt(0)
  v_readfirstlane_b32 s20, v242
  v_cmp_ne_u32 vcc, s101, v243
  s_cbranch_vccnz ch_end
  s_mov_b32 s97, 2
wk_g2:
  s_cmp_ge_u32 s3, 864
  s_cbranch_scc1 wk_tok
  s_cmp_ge_u32 s3, 752
  s_cbranch_scc1 wk_s4d
  s_cmp_ge_u32 s3, 624
  s_cbranch_scc1 wk_f
  s_cmp_ge_u32 s3, 560
  s_cbranch_scc1 wk_vf
  s_cmp_ge_u32 s3, 432
  s_cbranch_scc1 wk_a
  s_cmp_ge_u32 s3, 368
  s_cbranch_scc1 wk_vh
  s_cmp_ge_u32 s3, 256
  s_cbranch_scc1 wk_v7
  s_cmp_ge_u32 s3, 224
  s_cbranch_scc1 wk_srv
  s_sub_u32 s20, s3, 0
  s_cmp_ge_u32 s20, 112
  s_cselect_b32 s18, 1, 0
  s_cselect_b32 s21, 112, 0
  s_sub_u32 s20, s20, s21
  s_and_b32 s17, s20, 15
  s_add_u32 s17, s17, 16
  s_lshr_b32 s34, s20, 4
  s_lshl_b32 s34, s34, 1
  s_add_u32 s35, s34, 2
  s_cmp_eq_u32 s18, 0
  s_cbranch_scc1 wf_nw
  s_and_b32 s20, s3, 3
  s_lshl_b32 s20, s20, 3
  s_add_u32 s20, s20, 8
  s_cmp_eq_u32 s16, 0
  s_cselect_b32 s20, 0, s20
  s_cmp_ge_u32 s16, 2
  s_cselect_b32 s20, 112, s20
  s_load_dwordx2 s[72:73], s[0:1], s20
  s_lshr_b32 s21, s3, 2
  s_lshl_b32 s21, s21, 12
  s_mov_b32 s74, 229376
  s_lshl_b32 s22, s3, 13
  s_cmp_eq_u32 s16, 0
  s_cselect_b32 s21, s22, s21
  s_cselect_b32 s74, 1835008, s74
  s_lshl_b32 s22, s3, 1
  s_add_u32 s22, s22, s16
  s_sub_u32 s22, s22, 2
  s_lshl_b32 s22, s22, 13
  s_cmp_ge_u32 s16, 2
  s_cselect_b32 s21, s22, s21
  s_cselect_b32 s74, 3670016, s74
  v_lshlrev_b32 v6, 3, v2
  s_cmp_eq_u32 s16, 1
  s_cselect_b32 exec_hi, 0, -1
  s_waitcnt lgkmcnt(0)
  s_and_b32 s73, s73, 0xffff
  s_mov_b32 s75, 0x20000
  buffer_load_dword v7, v6, s[72:75], s21 offen
  s_mov_b64 exec, -1
  s_sub_u32 s3, s3, 112
  s_and_b32 s20, s3, 3
  s_lshl_b32 s20, s20, 3
  s_add_u32 s20, s20, 8
  s_cmp_eq_u32 s16, 0
  s_cselect_b32 s20, 0, s20
  s_cmp_ge_u32 s16, 2
  s_cselect_b32 s20, 112, s20
  s_load_dwordx2 s[72:73], s[0:1], s20
  s_lshr_b32 s21, s3, 2
  s_lshl_b32 s21, s21, 12
  s_mov_b32 s74, 229376
  s_lshl_b32 s22, s3, 13
  s_cmp_eq_u32 s16, 0
  s_cselect_b32 s21, s22, s21
  s_cselect_b32 s74, 1835008, s74
  s_lshl_b32 s22, s3, 1
  s_add_u32 s22, s22, s16
  s_sub_u32 s22, s22, 2
  s_lshl_b32 s22, s22, 13
  s_cmp_ge_u32 s16, 2
  s_cselect_b32 s21, s22, s21
  s_cselect_b32 s74, 3670016, s74
  v_lshlrev_b32 v6, 3, v2
  s_cmp_eq_u32 s16, 1
  s_cselect_b32 exec_hi, 0, -1
  s_waitcnt lgkmcnt(0)
  s_and_b32 s73, s73, 0xffff
  s_mov_b32 s75, 0x20000
  buffer_load_dword v7, v6, s[72:75], s21 offen
  s_mov_b64 exec, -1
  s_add_u32 s3, s3, 112
wf_nw:
  s_lshl_b32 s20, s18, 3
  s_lshl_b32 s21, s16, 1
  s_add_u32 s20, s20, s21
  s_mul_i32 s21, s20, 14336
  s_add_u32 s21, s21, 71565312
  s_add_u32 s22, s21, 0
  buffer_load_dwordx4 a[0:3], v2, s[8:11], s22 offen offset:0 sc1
  buffer_load_dwordx4 a[4:7], v2, s[8:11], s22 offen offset:1024 sc1
  buffer_load_dwordx4 a[8:11], v2, s[8:11], s22 offen offset:2048 sc1
  buffer_load_dwordx4 a[12:15], v2, s[8:11], s22 offen offset:3072 sc1
  s_add_u32 s22, s21, 4096
  buffer_load_dwordx4 a[16:19], v2, s[8:11], s22 offen offset:0 sc1
  buffer_load_dwordx4 a[20:23], v2, s[8:11], s22 offen offset:1024 sc1
  buffer_load_dwordx4 a[24:27], v2, s[8:11], s22 offen offset:2048 sc1
  buffer_load_dwordx4 a[28:31], v2, s[8:11], s22 offen offset:3072 sc1
  s_add_u32 s22, s21, 8192
  buffer_load_dwordx4 a[32:35], v2, s[8:11], s22 offen offset:0 sc1
  buffer_load_dwordx4 a[36:39], v2, s[8:11], s22 offen offset:1024 sc1
  buffer_load_dwordx4 a[40:43], v2, s[8:11], s22 offen offset:2048 sc1
  buffer_load_dwordx4 a[44:47], v2, s[8:11], s22 offen offset:3072 sc1
  s_add_u32 s22, s21, 12288
  buffer_load_dwordx4 a[48:51], v2, s[8:11], s22 offen offset:0 sc1
  buffer_load_dwordx4 a[52:55], v2, s[8:11], s22 offen offset:1024 sc1
  buffer_load_dwordx4 a[56:59], v2, s[8:11], s22 offen offset:2048 sc1
  buffer_load_dwordx4 a[60:63], v2, s[8:11], s22 offen offset:3072 sc1
  s_add_u32 s22, s21, 16384
  buffer_load_dwordx4 a[64:67], v2, s[8:11], s22 offen offset:0 sc1
  buffer_load_dwordx4 a[68:71], v2, s[8:11], s22 offen offset:1024 sc1
  buffer_load_dwordx4 a[72:75], v2, s[8:11], s22 offen offset:2048 sc1
  buffer_load_dwordx4 a[76:79], v2, s[8:11], s22 offen offset:3072 sc1
  s_add_u32 s22, s21, 20480
  buffer_load_dwordx4 a[80:83], v2, s[8:11], s22 offen offset:0 sc1
  buffer_load_dwordx4 a[84:87], v2, s[8:11], s22 offen offset:1024 sc1
  buffer_load_dwordx4 a[88:91], v2, s[8:11], s22 offen offset:2048 sc1
  buffer_load_dwordx4 a[92:95], v2, s[8:11], s22 offen offset:3072 sc1
  s_add_u32 s22, s21, 24576
  buffer_load_dwordx4 a[96:99], v2, s[8:11], s22 offen offset:0 sc1
  buffer_load_dwordx4 a[100:103], v2, s[8:11], s22 offen offset:1024 sc1
  buffer_load_dwordx4 a[104:107], v2, s[8:11], s22 offen offset:2048 sc1
  buffer_load_dwordx4 a[108:111], v2, s[8:11], s22 offen offset:3072 sc1
  s_waitcnt vmcnt(40)
  s_mul_i32 s23, s17, 401408
  s_and_b32 s22, s16, 1
  s_mul_i32 s22, s22, 7168
  s_add_u32 s23, s23, s22
  s_add_u32 s23, s23, 0
  s_lshr_b32 s22, s16, 1
  s_mul_i32 s22, s22, 14336
  s_add_u32 s23, s23, s22
  s_mul_i32 s27, s16, 7168
  s_lshr_b32 s28, s20, 1
wf_vo:
  s_sub_u32 s29, s17, 16
  s_lshl_b32 s29, s29, 6
  s_add_u32 s29, s29, s28
  s_mul_i32 s29, s29, 28672
  s_add_u32 s29, s29, 42205184
  v_mul_u32_u24 v6, 28, v3
  s_mov_b32 s31, 0
  s_lshl_b32 s24, s34, 1
  s_mul_i32 s24, s24, 14336
  s_add_u32 s24, s24, s23
  s_cmp_lt_u32 s34, s35
  s_cselect_b32 s24, s24, 0x10000000
  s_add_u32 m0, s31, s27
  s_nop 0
  buffer_load_dwordx4 v2, s[8:11], s24 offen offset:0 sc1 lds
  buffer_load_dwordx4 v2, s[8:11], s24 offen offset:1024 sc1 lds
  buffer_load_dwordx4 v2, s[8:11], s24 offen offset:2048 sc1 lds
  buffer_load_dwordx4 v2, s[8:11], s24 offen offset:3072 sc1 lds
  s_add_u32 m0, m0, 4096
  s_add_u32 s24, s24, 4096
  buffer_load_dwordx4 v2, s[8:11], s24 offen offset:0 sc1 lds
  buffer_load_dwordx4 v2, s[8:11], s24 offen offset:1024 sc1 lds
  buffer_load_dwordx4 v2, s[8:11], s24 offen offset:2048 sc1 lds
  s_add_u32 s30, s34, 1
  s_mov_b32 s31, 28672
  s_lshl_b32 s24, s30, 1
  s_mul_i32 s24, s24, 14336
  s_add_u32 s24, s24, s23
  s_cmp_lt_u32 s30, s35
  s_cselect_b32 s24, s24, 0x10000000
  s_add_u32 m0, s31, s27
  s_nop 0
  buffer_load_dwordx4 v2, s[8:11], s24 offen offset:0 sc1 lds
  buffer_load_dwordx4 v2, s[8:11], s24 offen offset:1024 sc1 lds
  buffer_load_dwordx4 v2, s[8:11], s24 offen offset:2048 sc1 lds
  buffer_load_dwordx4 v2, s[8:11], s24 offen offset:3072 sc1 lds
  s_add_u32 m0, m0, 4096
  s_add_u32 s24, s24, 4096
  buffer_load_dwordx4 v2, s[8:11], s24 offen offset:0 sc1 lds
  buffer_load_dwordx4 v2, s[8:11], s24 offen offset:1024 sc1 lds
  buffer_load_dwordx4 v2, s[8:11], s24 offen offset:2048 sc1 lds
  s_mov_b32 s19, s34
  s_mov_b32 s32, 0
  s_mov_b32 s33, 57344
  s_waitcnt vmcnt(7)
  s_branch wf_vo_in
wf_vo_loop:
  s_waitcnt vmcnt(9)
wf_vo_in:
  s_barrier
  s_add_u32 s30, s19, 2
  s_lshl_b32 s24, s30, 1
  s_mul_i32 s24, s24, 14336
  s_add_u32 s24, s24, s23
  s_cmp_lt_u32 s30, s35
  s_cselect_b32 s24, s24, 0x10000000
  s_add_u32 m0, s33, s27
  s_nop 0
  buffer_load_dwordx4 v2, s[8:11], s24 offen offset:0 sc1 lds
  buffer_load_dwordx4 v2, s[8:11], s24 offen offset:1024 sc1 lds
  buffer_load_dwordx4 v2, s[8:11], s24 offen offset:2048 sc1 lds
  buffer_load_dwordx4 v2, s[8:11], s24 offen offset:3072 sc1 lds
  s_add_u32 m0, m0, 4096
  s_add_u32 s24, s24, 4096
  buffer_load_dwordx4 v2, s[8:11], s24 offen offset:0 sc1 lds
  buffer_load_dwordx4 v2, s[8:11], s24 offen offset:1024 sc1 lds
  buffer_load_dwordx4 v2, s[8:11], s24 offen offset:2048 sc1 lds
  v_add_u32 v5, s32, v2
  ds_read_b128 v[8:11], v5 offset:0
  ds_read_b128 v[12:15], v5 offset:14336
  ds_read_b128 v[16:19], v5 offset:1024
  ds_read_b128 v[20:23], v5 offset:15360
  ds_read_b128 v[24:27], v5 offset:2048
  ds_read_b128 v[28:31], v5 offset:16384
  ds_read_b128 v[32:35], v5 offset:3072
  s_waitcnt lgkmcnt(6)
  v_mfma_f32_16x16x32_bf16 v[40:43], a[0:3], v[8:11], 0
  v_mfma_f32_16x16x32_bf16 v[44:47], a[56:59], v[8:11], 0
  ds_read_b128 v[36:39], v5 offset:17408
  s_waitcnt lgkmcnt(6)
  v_mfma_f32_16x16x32_bf16 v[56:59], a[0:3], v[12:15], 0
  v_mfma_f32_16x16x32_bf16 v[60:63], a[56:59], v[12:15], 0
  ds_read_b128 v[8:11], v5 offset:4096
  s_waitcnt lgkmcnt(6)
  v_mfma_f32_16x16x32_bf16 v[40:43], a[4:7], v[16:19], v[40:43]
  v_mfma_f32_16x16x32_bf16 v[44:47], a[60:63], v[16:19], v[44:47]
  ds_read_b128 v[12:15], v5 offset:18432
  s_waitcnt lgkmcnt(6)
  v_mfma_f32_16x16x32_bf16 v[56:59], a[4:7], v[20:23], v[56:59]
  v_mfma_f32_16x16x32_bf16 v[60:63], a[60:63], v[20:23], v[60:63]
  ds_read_b128 v[16:19], v5 offset:5120
  s_waitcnt lgkmcnt(6)
  v_mfma_f32_16x16x32_bf16 v[40:43], a[8:11], v[24:27], v[40:43]
  v_mfma_f32_16x16x32_bf16 v[44:47], a[64:67], v[24:27], v[44:47]
  ds_read_b128 v[20:23], v5 offset:19456
  s_waitcnt lgkmcnt(6)
  v_mfma_f32_16x16x32_bf16 v[56:59], a[8:11], v[28:31], v[56:59]
  v_mfma_f32_16x16x32_bf16 v[60:63], a[64:67], v[28:31], v[60:63]
  ds_read_b128 v[24:27], v5 offset:6144
  s_waitcnt lgkmcnt(6)
  v_mfma_f32_16x16x32_bf16 v[40:43], a[12:15], v[32:35], v[40:43]
  v_mfma_f32_16x16x32_bf16 v[44:47], a[68:71], v[32:35], v[44:47]
  ds_read_b128 v[28:31], v5 offset:20480
  s_waitcnt lgkmcnt(6)
  v_mfma_f32_16x16x32_bf16 v[56:59], a[12:15], v[36:39], v[56:59]
  v_mfma_f32_16x16x32_bf16 v[60:63], a[68:71], v[36:39], v[60:63]
  ds_read_b128 v[32:35], v5 offset:7168
  s_waitcnt lgkmcnt(6)
  v_mfma_f32_16x16x32_bf16 v[40:43], a[16:19], v[8:11], v[40:43]
  v_mfma_f32_16x16x32_bf16 v[44:47], a[72:75], v[8:11], v[44:47]
  ds_read_b128 v[36:39], v5 offset:21504
  s_waitcnt lgkmcnt(6)
  v_mfma_f32_16x16x32_bf16 v[56:59], a[16:19], v[12:15], v[56:59]
  v_mfma_f32_16x16x32_bf16 v[60:63], a[72:75], v[12:15], v[60:63]
  ds_read_b128 v[8:11], v5 offset:8192
  s_waitcnt lgkmcnt(6)
  v_mfma_f32_16x16x32_bf16 v[40:43], a[20:23], v[16:19], v[40:43]
  v_mfma_f32_16x16x32_bf16 v[44:47], a[76:79], v[16:19], v[44:47]
  ds_read_b128 v[12:15], v5 offset:22528
  s_waitcnt lgkmcnt(6)
  v_mfma_f32_16x16x32_bf16 v[56:59], a[20:23], v[20:23], v[56:59]
  v_mfma_f32_16x16x32_bf16 v[60:63], a[76:79], v[20:23], v[60:63]
  ds_read_b128 v[16:19], v5 offset:9216
  s_waitcnt lgkmcnt(6)
  v_mfma_f32_16x16x32_bf16 v[40:43], a[24:27], v[24:27], v[40:43]
  v_mfma_f32_16x16x32_bf16 v[44:47], a[80:83], v[24:27], v[44:47]
  ds_read_b128 v[20:23], v5 offset:23552
  s_waitcnt lgkmcnt(6)
  v_mfma_f32_16x16x32_bf16 v[56:59], a[24:27], v[28:31], v[56:59]
  v_mfma_f32_16x16x32_bf16 v[60:63], a[80:83], v[28:31], v[60:63]
  ds_read_b128 v[24:27], v5 offset:10240
  s_waitcnt lgkmcnt(6)
  v_mfma_f32_16x16x32_bf16 v[40:43], a[28:31], v[32:35], v[40:43]
  v_mfma_f32_16x16x32_bf16 v[44:47], a[84:87], v[32:35], v[44:47]
  ds_read_b128 v[28:31], v5 offset:24576
  s_waitcnt lgkmcnt(6)
  v_mfma_f32_16x16x32_bf16 v[56:59], a[28:31], v[36:39], v[56:59]
  v_mfma_f32_16x16x32_bf16 v[60:63], a[84:87], v[36:39], v[60:63]
  ds_read_b128 v[32:35], v5 offset:11264
  s_waitcnt lgkmcnt(6)
  v_mfma_f32_16x16x32_bf16 v[40:43], a[32:35], v[8:11], v[40:43]
  v_mfma_f32_16x16x32_bf16 v[44:47], a[88:91], v[8:11], v[44:47]
  ds_read_b128 v[36:39], v5 offset:25600
  s_waitcnt lgkmcnt(6)
  v_mfma_f32_16x16x32_bf16 v[56:59], a[32:35], v[12:15], v[56:59]
  v_mfma_f32_16x16x32_bf16 v[60:63], a[88:91], v[12:15], v[60:63]
  ds_read_b128 v[8:11], v5 offset:12288
  s_waitcnt lgkmcnt(6)
  v_mfma_f32_16x16x32_bf16 v[40:43], a[36:39], v[16:19], v[40:43]
  v_mfma_f32_16x16x32_bf16 v[44:47], a[92:95], v[16:19], v[44:47]
  ds_read_b128 v[12:15], v5 offset:26624
  s_waitcnt lgkmcnt(6)
  v_mfma_f32_16x16x32_bf16 v[56:59], a[36:39], v[20:23], v[56:59]
  v_mfma_f32_16x16x32_bf16 v[60:63], a[92:95], v[20:23], v[60:63]
  ds_read_b128 v[16:19], v5 offset:13312
  s_waitcnt lgkmcnt(6)
  v_mfma_f32_16x16x32_bf16 v[40:43], a[40:43], v[24:27], v[40:43]
  v_mfma_f32_16x16x32_bf16 v[44:47], a[96:99], v[24:27], v[44:47]
  ds_read_b128 v[20:23], v5 offset:27648
  s_waitcnt lgkmcnt(6)
  v_mfma_f32_16x16x32_bf16 v[56:59], a[40:43], v[28:31], v[56:59]
  v_mfma_f32_16x16x32_bf16 v[60:63], a[96:99], v[28:31], v[60:63]
  s_waitcnt lgkmcnt(5)
  v_mfma_f32_16x16x32_bf16 v[40:43], a[44:47], v[32:35], v[40:43]
  v_mfma_f32_16x16x32_bf16 v[44:47], a[100:103], v[32:35], v[44:47]
  s_waitcnt lgkmcnt(4)
  v_mfma_f32_16x16x32_bf16 v[56:59], a[44:47], v[36:39], v[56:59]
  v_mfma_f32_16x16x32_bf16 v[60:63], a[100:103], v[36:39], v[60:63]
  s_waitcnt lgkmcnt(3)
  v_mfma_f32_16x16x32_bf16 v[40:43], a[48:51], v[8:11], v[40:43]
  v_mfma_f32_16x16x32_bf16 v[44:47], a[104:107], v[8:11], v[44:47]
  s_waitcnt lgkmcnt(2)
  v_mfma_f32_16x16x32_bf16 v[56:59], a[48:51], v[12:15], v[56:59]
  v_mfma_f32_16x16x32_bf16 v[60:63], a[104:107], v[12:15], v[60:63]
  s_waitcnt lgkmcnt(1)
  v_mfma_f32_16x16x32_bf16 v[40:43], a[52:55], v[16:19], v[40:43]
  v_mfma_f32_16x16x32_bf16 v[44:47], a[108:111], v[16:19], v[44:47]
  s_waitcnt lgkmcnt(0)
  v_mfma_f32_16x16x32_bf16 v[56:59], a[52:55], v[20:23], v[56:59]
  v_mfma_f32_16x16x32_bf16 v[60:63], a[108:111], v[20:23], v[60:63]
  s_add_u32 s25, s29, 28672
  s_lshl_b32 s24, s19, 5
  s_add_u32 s24, s24, 0
  v_add_u32 v88, s24, v4
  v_mul_u32_u24 v89, 2341, v88
  v_lshrrev_b32 v89, 16, v89
  v_mul_u32_u24 v89, 84, v89
  v_add3_u32 v88, v88, v89, v6
  v_lshlrev_b32 v90, 4, v88
  v_cvt_pk_bf16_f32 v72, v40, v41
  v_cvt_pk_bf16_f32 v73, v42, v43
  v_cvt_pk_bf16_f32 v74, v44, v45
  v_cvt_pk_bf16_f32 v75, v46, v47
  buffer_store_dwordx4 v[72:75], v90, s[8:11], s29 offen sc1
  s_lshl_b32 s24, s19, 5
  s_add_u32 s24, s24, 16
  v_add_u32 v88, s24, v4
  v_mul_u32_u24 v89, 2341, v88
  v_lshrrev_b32 v89, 16, v89
  v_mul_u32_u24 v89, 84, v89
  v_add3_u32 v88, v88, v89, v6
  v_lshlrev_b32 v91, 4, v88
  v_cvt_pk_bf16_f32 v80, v56, v57
  v_cvt_pk_bf16_f32 v81, v58, v59
  v_cvt_pk_bf16_f32 v82, v60, v61
  v_cvt_pk_bf16_f32 v83, v62, v63
  buffer_store_dwordx4 v[80:83], v91, s[8:11], s29 offen sc1
  s_mov_b32 s33, s32
  s_add_u32 s32, s32, 28672
  s_cmp_eq_u32 s32, 86016
  s_cselect_b32 s32, 0, s32
  s_add_u32 s19, s19, 1
  s_cmp_lt_u32 s19, s35
  s_cbranch_scc1 wf_vo_loop
  s_branch wf_done
wf_done:
  s_lshr_b32 s20, s18, 1
  s_lshl_b32 s20, s20, 4
  s_and_b32 s21, s17, 15
  s_add_u32 s20, s20, s21
  s_lshl_b32 s20, s20, 7
  s_cmp_lt_u32 s17, 16
  s_cselect_b32 s21, 16384, 0
  s_add_u32 s20, s20, s21
  s_add_u32 s20, s20, 88528896
  s_sub_u32 s21, s35, s34
  s_lshr_b32 s21, s21, 1
  v_mov_b32 v5, s21
  v_mov_b32 v6, 0
  s_waitcnt vmcnt(0)
  s_mov_b64 exec, 1
  s_cmp_lg_u32 s18, 0
  s_cbranch_scc1 wf_h1
  v_mov_b32 v7, 2
  s_sub_u32 s21, s20, 2048
  buffer_atomic_add v7, v6, s[8:11], s21 offen
wf_h1:
  buffer_atomic_add v5, v6, s[8:11], s20 offen
  s_mov_b64 exec, -1
  s_load_dwordx8 s[36:43], s[0:1], 56
  s_load_dwordx4 s[44:47], s[0:1], 88
  s_waitcnt lgkmcnt(0)
  s_mov_b32 s52, s36
  s_and_b32 s53, s37, 0xffff
  s_mov_b32 s54, 1835008
  s_mov_b32 s55, 0x20000
  s_lshl_b32 s20, s3, 8
  v_add_u32 v95, s20, v0
  s_mov_b32 s21, 9586981
  v_mul_hi_u32 v6, v95, s21
  v_mul_u32_u24 v7, 448, v6
  v_sub_u32 v7, v95, v7
  v_lshrrev_b32 v8, 4, v7
  v_and_b32 v7, 15, v7
  v_lshl_add_u32 v9, v6, 4, v7
  v_mul_u32_u24 v9, 896, v9
  v_lshl_add_u32 v9, v8, 5, v9
  buffer_load_dwordx4 v[84:87], v9, s[52:55], 0 offen
  buffer_load_dwordx4 v[88:91], v9, s[52:55], 0 offen offset:16
  v_mul_u32_u24 v6, 14336, v6
  v_lshl_add_u32 v6, v7, 4, v6
  v_lshl_add_u32 v92, v8, 9, v6
  v_lshrrev_b32 v7, 2, v8
  v_lshl_add_u32 v6, v7, 11, v6
  v_and_b32 v7, 3, v8
  v_lshl_add_u32 v93, v7, 8, v6
  v_mov_b32 v52, -1
  v_mov_b32 v53, -1
  v_mov_b32 v54, -1
  v_mov_b32 v55, -1
  s_mov_b32 s23, 75747328
  v_lshlrev_b32 v8, 4, v95
  buffer_store_dwordx4 v[52:55], v8, s[8:11], s23 offen sc1
  v_add_u32 v8, 917504, v8
  v_mov_b32 v9, 0x10000000
  v_cmp_lt_u32 vcc, 16255, v95
  s_nop 1
  v_cndmask_b32 v8, v8, v9, vcc
  buffer_store_dwordx4 v[52:55], v8, s[8:11], s23 offen sc1
  s_waitcnt vmcnt(1)
  v_mov_b32 v96, v84
  v_mov_b32 v100, v85
  v_mov_b32 v97, v86
  v_mov_b32 v101, v87
  v_mov_b32 v98, v88
  v_mov_b32 v102, v89
  v_mov_b32 v99, v90
  v_mov_b32 v103, v91
  s_mov_b32 s20, 71565312
  s_mov_b32 s21, 73400320
  buffer_store_dwordx4 v[96:99], v93, s[8:11], s21 offen sc1
  buffer_store_dwordx4 v[100:103], v93, s[8:11], s21 offen offset:1024 sc1
  s_cmp_lt_u32 s3, 70
  s_cbranch_scc1 i2_nx
  buffer_store_dwordx4 v[84:87], v92, s[8:11], s20 offen sc1
  buffer_store_dwordx4 v[88:91], v92, s[8:11], s20 offen offset:256 sc1
i2_nx:
  s_lshl_b32 s20, s3, 3
  s_add_u32 s20, s20, 88625152
  s_waitcnt vmcnt(0)
  s_barrier
  s_cmp_lg_u32 s16, 0
  s_cbranch_scc1 pub_36
  v_mul_u32_u24 v26, 2048, v1
  v_mov_b32 v24, s88
  v_mov_b32 v25, s89
  s_mov_b64 exec, 255
  buffer_store_dwordx2 v[24:25], v26, s[8:11], s20 offen sc1
  s_mov_b64 exec, -1
pub_36:
  s_branch wk_loop
wk_v7:
  s_sub_u32 s20, s3, 256
  s_mov_b32 s18, 1
  s_and_b32 s17, s20, 15
  s_add_u32 s17, s17, 16
  s_lshr_b32 s34, s20, 4
  s_lshl_b32 s34, s34, 1
  s_add_u32 s35, s34, 2
  s_branch wk_gemm
wk_vh:
  s_sub_u32 s20, s3, 368
  s_and_b32 s17, s20, 15
  s_add_u32 s17, s17, 16
  s_lshr_b32 s18, s20, 5
  s_add_u32 s18, s18, 2
  s_bitcmp1_b32 s20, 4
  s_cselect_b32 s34, 7, 0
  s_add_u32 s35, s34, 7
  s_branch wk_gemm
wk_vf:
  s_sub_u32 s20, s3, 560
  s_and_b32 s17, s20, 15
  s_add_u32 s17, s17, 16
  s_lshr_b32 s18, s20, 4
  s_add_u32 s18, s18, 4
  s_mov_b32 s34, 0
  s_mov_b32 s35, 14
  s_branch wk_gemm
wk_f:
  s_sub_u32 s20, s3, 624
  s_and_b32 s17, s20, 15
  s_lshr_b32 s18, s20, 4
  s_mov_b32 s34, 0
  s_mov_b32 s35, 14
  s_lshl_b32 s22, s17, 7
  s_add_u32 s22, s22, 88621056
  s_add_u32 s23, s22, 2048
  v_min_u32 v24, 48, v2
  v_min_u32 v25, 96, v2
  s_mov_b32 s30, 0
wk_aw:
  buffer_load_dwordx4 v[28:31], v24, s[8:11], s22 offen sc1
  buffer_load_dwordx4 v[32:35], v25, s[8:11], s23 offen sc1
  s_waitcnt vmcnt(0)
  v_cmp_ne_u64 vcc, s[88:89], v[28:29]
  s_cbranch_vccnz wk_aw_no
  v_cmp_ne_u64 vcc, s[88:89], v[30:31]
  s_cbranch_vccnz wk_aw_no
  v_cmp_ne_u64 vcc, s[88:89], v[32:33]
  s_cbranch_vccnz wk_aw_no
  v_cmp_ne_u64 vcc, s[88:89], v[34:35]
  s_cbranch_vccnz wk_aw_no
  s_branch wk_aw_ok
wk_aw_no:
  s_sleep 6
  s_add_u32 s30, s30, 1
  s_cmp_lt_u32 s30, 50000
  s_cbranch_scc1 wk_aw
  s_branch cA_abort
wk_aw_ok:
wk_gemm:
  s_lshl_b32 s20, s18, 4
  s_lshl_b32 s21, s16, 2
  s_add_u32 s20, s20, s21
  s_mul_i32 s21, s20, 14336
  s_add_u32 s21, s21, 71565312
  s_add_u32 s22, s21, 0
  buffer_load_dwordx4 a[0:3], v2, s[8:11], s22 offen offset:0 sc1
  buffer_load_dwordx4 a[4:7], v2, s[8:11], s22 offen offset:1024 sc1
  buffer_load_dwordx4 a[8:11], v2, s[8:11], s22 offen offset:2048 sc1
  buffer_load_dwordx4 a[12:15], v2, s[8:11], s22 offen offset:3072 sc1
  s_add_u32 s22, s21, 4096
  buffer_load_dwordx4 a[16:19], v2, s[8:11], s22 offen offset:0 sc1
  buffer_load_dwordx4 a[20:23], v2, s[8:11], s22 offen offset:1024 sc1
  buffer_load_dwordx4 a[24:27], v2, s[8:11], s22 offen offset:2048 sc1
  buffer_load_dwordx4 a[28:31], v2, s[8:11], s22 offen offset:3072 sc1
  s_add_u32 s22, s21, 8192
  buffer_load_dwordx4 a[32:35], v2, s[8:11], s22 offen offset:0 sc1
  buffer_load_dwordx4 a[36:39], v2, s[8:11], s22 offen offset:1024 sc1
  buffer_load_dwordx4 a[40:43], v2, s[8:11], s22 offen offset:2048 sc1
  buffer_load_dwordx4 a[44:47], v2, s[8:11], s22 offen offset:3072 sc1
  s_add_u32 s22, s21, 12288
  buffer_load_dwordx4 a[48:51], v2, s[8:11], s22 offen offset:0 sc1
  buffer_load_dwordx4 a[52:55], v2, s[8:11], s22 offen offset:1024 sc1
  buffer_load_dwordx4 a[56:59], v2, s[8:11], s22 offen offset:2048 sc1
  buffer_load_dwordx4 a[60:63], v2, s[8:11], s22 offen offset:3072 sc1
  s_add_u32 s22, s21, 16384
  buffer_load_dwordx4 a[64:67], v2, s[8:11], s22 offen offset:0 sc1
  buffer_load_dwordx4 a[68:71], v2, s[8:11], s22 offen offset:1024 sc1
  buffer_load_dwordx4 a[72:75], v2, s[8:11], s22 offen offset:2048 sc1
  buffer_load_dwordx4 a[76:79], v2, s[8:11], s22 offen offset:3072 sc1
  s_add_u32 s22, s21, 20480
  buffer_load_dwordx4 a[80:83], v2, s[8:11], s22 offen offset:0 sc1
  buffer_load_dwordx4 a[84:87], v2, s[8:11], s22 offen offset:1024 sc1
  buffer_load_dwordx4 a[88:91], v2, s[8:11], s22 offen offset:2048 sc1
  buffer_load_dwordx4 a[92:95], v2, s[8:11], s22 offen offset:3072 sc1
  s_add_u32 s22, s21, 24576
  buffer_load_dwordx4 a[96:99], v2, s[8:11], s22 offen offset:0 sc1
  buffer_load_dwordx4 a[100:103], v2, s[8:11], s22 offen offset:1024 sc1
  buffer_load_dwordx4 a[104:107], v2, s[8:11], s22 offen offset:2048 sc1
  buffer_load_dwordx4 a[108:111], v2, s[8:11], s22 offen offset:3072 sc1
  s_add_u32 s22, s21, 28672
  buffer_load_dwordx4 a[112:115], v2, s[8:11], s22 offen offset:0 sc1
  buffer_load_dwordx4 a[116:119], v2, s[8:11], s22 offen offset:1024 sc1
  buffer_load_dwordx4 a[120:123], v2, s[8:11], s22 offen offset:2048 sc1
  buffer_load_dwordx4 a[124:127], v2, s[8:11], s22 offen offset:3072 sc1
  s_add_u32 s22, s21, 32768
  buffer_load_dwordx4 a[128:131], v2, s[8:11], s22 offen offset:0 sc1
  buffer_load_dwordx4 a[132:135], v2, s[8:11], s22 offen offset:1024 sc1
  buffer_load_dwordx4 a[136:139], v2, s[8:11], s22 offen offset:2048 sc1
  buffer_load_dwordx4 a[140:143], v2, s[8:11], s22 offen offset:3072 sc1
  s_add_u32 s22, s21, 36864
  buffer_load_dwordx4 a[144:147], v2, s[8:11], s22 offen offset:0 sc1
  buffer_load_dwordx4 a[148:151], v2, s[8:11], s22 offen offset:1024 sc1
  buffer_load_dwordx4 a[152:155], v2, s[8:11], s22 offen offset:2048 sc1
  buffer_load_dwordx4 a[156:159], v2, s[8:11], s22 offen offset:3072 sc1
  s_add_u32 s22, s21, 40960
  buffer_load_dwordx4 a[160:163], v2, s[8:11], s22 offen offset:0 sc1
  buffer_load_dwordx4 a[164:167], v2, s[8:11], s22 offen offset:1024 sc1
  buffer_load_dwordx4 a[168:171], v2, s[8:11], s22 offen offset:2048 sc1
  buffer_load_dwordx4 a[172:175], v2, s[8:11], s22 offen offset:3072 sc1
  s_add_u32 s22, s21, 45056
  buffer_load_dwordx4 a[176:179], v2, s[8:11], s22 offen offset:0 sc1
  buffer_load_dwordx4 a[180:183], v2, s[8:11], s22 offen offset:1024 sc1
  buffer_load_dwordx4 a[184:187], v2, s[8:11], s22 offen offset:2048 sc1
  buffer_load_dwordx4 a[188:191], v2, s[8:11], s22 offen offset:3072 sc1
  s_add_u32 s22, s21, 49152
  buffer_load_dwordx4 a[192:195], v2, s[8:11], s22 offen offset:0 sc1
  buffer_load_dwordx4 a[196:199], v2, s[8:11], s22 offen offset:1024 sc1
  buffer_load_dwordx4 a[200:203], v2, s[8:11], s22 offen offset:2048 sc1
  buffer_load_dwordx4 a[204:207], v2, s[8:11], s22 offen offset:3072 sc1
  s_add_u32 s22, s21, 53248
  buffer_load_dwordx4 a[208:211], v2, s[8:11], s22 offen offset:0 sc1
  buffer_load_dwordx4 a[212:215], v2, s[8:11], s22 offen offset:1024 sc1
  buffer_load_dwordx4 a[216:219], v2, s[8:11], s22 offen offset:2048 sc1
  buffer_load_dwordx4 a[220:223], v2, s[8:11], s22 offen offset:3072 sc1
  s_waitcnt vmcnt(40)
  s_mul_i32 s23, s17, 401408
  s_and_b32 s22, s16, 1
  s_mul_i32 s22, s22, 7168
  s_add_u32 s23, s23, s22
  s_add_u32 s23, s23, 0
  s_lshr_b32 s22, s16, 1
  s_mul_i32 s22, s22, 14336
  s_add_u32 s23, s23, s22
  s_mul_i32 s27, s16, 7168
  s_lshr_b32 s28, s20, 1
  s_cmp_lt_u32 s17, 16
  s_cbranch_scc0 wg_vo
  s_add_u32 s23, s23, s22
  s_lshl_b32 s29, s28, 4
  s_add_u32 s29, s29, s17
  s_mul_i32 s29, s29, 28672
  s_add_u32 s29, s29, 12845056
  s_mov_b32 s31, 0
  s_lshr_b32 s24, s34, 1
  s_lshl_b32 s24, s24, 2
  s_and_b32 s25, s34, 1
  s_add_u32 s24, s24, s25
  s_mul_i32 s24, s24, 14336
  s_add_u32 s24, s24, s23
  s_cmp_lt_u32 s34, s35
  s_cselect_b32 s24, s24, 0x10000000
  s_add_u32 m0, s31, s27
  s_nop 0
  buffer_load_dwordx4 v2, s[8:11], s24 offen offset:0 sc1 lds
  buffer_load_dwordx4 v2, s[8:11], s24 offen offset:1024 sc1 lds
  buffer_load_dwordx4 v2, s[8:11], s24 offen offset:2048 sc1 lds
  buffer_load_dwordx4 v2, s[8:11], s24 offen offset:3072 sc1 lds
  s_add_u32 m0, m0, 4096
  s_add_u32 s24, s24, 4096
  buffer_load_dwordx4 v2, s[8:11], s24 offen offset:0 sc1 lds
  buffer_load_dwordx4 v2, s[8:11], s24 offen offset:1024 sc1 lds
  buffer_load_dwordx4 v2, s[8:11], s24 offen offset:2048 sc1 lds
  s_add_u32 s30, s34, 1
  s_mov_b32 s31, 28672
  s_lshr_b32 s24, s30, 1
  s_lshl_b32 s24, s24, 2
  s_and_b32 s25, s30, 1
  s_add_u32 s24, s24, s25
  s_mul_i32 s24, s24, 14336
  s_add_u32 s24, s24, s23
  s_cmp_lt_u32 s30, s35
  s_cselect_b32 s24, s24, 0x10000000
  s_add_u32 m0, s31, s27
  s_nop 0
  buffer_load_dwordx4 v2, s[8:11], s24 offen offset:0 sc1 lds
  buffer_load_dwordx4 v2, s[8:11], s24 offen offset:1024 sc1 lds
  buffer_load_dwordx4 v2, s[8:11], s24 offen offset:2048 sc1 lds
  buffer_load_dwordx4 v2, s[8:11], s24 offen offset:3072 sc1 lds
  s_add_u32 m0, m0, 4096
  s_add_u32 s24, s24, 4096
  buffer_load_dwordx4 v2, s[8:11], s24 offen offset:0 sc1 lds
  buffer_load_dwordx4 v2, s[8:11], s24 offen offset:1024 sc1 lds
  buffer_load_dwordx4 v2, s[8:11], s24 offen offset:2048 sc1 lds
  s_mov_b32 s19, s34
  s_mov_b32 s32, 0
  s_mov_b32 s33, 57344
  s_waitcnt vmcnt(7)
  s_branch wg_f_in
wg_f_loop:
  s_waitcnt vmcnt(11)
wg_f_in:
  s_barrier
  s_add_u32 s30, s19, 2
  s_lshr_b32 s24, s30, 1
  s_lshl_b32 s24, s24, 2
  s_and_b32 s25, s30, 1
  s_add_u32 s24, s24, s25
  s_mul_i32 s24, s24, 14336
  s_add_u32 s24, s24, s23
  s_cmp_lt_u32 s30, s35
  s_cselect_b32 s24, s24, 0x10000000
  s_add_u32 m0, s33, s27
  s_nop 0
  buffer_load_dwordx4 v2, s[8:11], s24 offen offset:0 sc1 lds
  buffer_load_dwordx4 v2, s[8:11], s24 offen offset:1024 sc1 lds
  buffer_load_dwordx4 v2, s[8:11], s24 offen offset:2048 sc1 lds
  buffer_load_dwordx4 v2, s[8:11], s24 offen offset:3072 sc1 lds
  s_add_u32 m0, m0, 4096
  s_add_u32 s24, s24, 4096
  buffer_load_dwordx4 v2, s[8:11], s24 offen offset:0 sc1 lds
  buffer_load_dwordx4 v2, s[8:11], s24 offen offset:1024 sc1 lds
  buffer_load_dwordx4 v2, s[8:11], s24 offen offset:2048 sc1 lds
  v_add_u32 v5, s32, v2
  ds_read_b128 v[8:11], v5 offset:0
  ds_read_b128 v[12:15], v5 offset:14336
  ds_read_b128 v[16:19], v5 offset:1024
  ds_read_b128 v[20:23], v5 offset:15360
  ds_read_b128 v[24:27], v5 offset:2048
  ds_read_b128 v[28:31], v5 offset:16384
  ds_read_b128 v[32:35], v5 offset:3072
  s_waitcnt lgkmcnt(6)
  v_mfma_f32_16x16x32_bf16 v[40:43], v[8:11], a[0:3], 0
  v_mfma_f32_16x16x32_bf16 v[44:47], v[8:11], a[56:59], 0
  v_mfma_f32_16x16x32_bf16 v[48:51], v[8:11], a[112:115], 0
  v_mfma_f32_16x16x32_bf16 v[52:55], v[8:11], a[168:171], 0
  ds_read_b128 v[36:39], v5 offset:17408
  s_waitcnt lgkmcnt(6)
  v_mfma_f32_16x16x32_bf16 v[56:59], v[12:15], a[0:3], 0
  v_mfma_f32_16x16x32_bf16 v[60:63], v[12:15], a[56:59], 0
  v_mfma_f32_16x16x32_bf16 v[64:67], v[12:15], a[112:115], 0
  v_mfma_f32_16x16x32_bf16 v[68:71], v[12:15], a[168:171], 0
  ds_read_b128 v[8:11], v5 offset:4096
  s_waitcnt lgkmcnt(6)
  v_mfma_f32_16x16x32_bf16 v[40:43], v[16:19], a[4:7], v[40:43]
  v_mfma_f32_16x16x32_bf16 v[44:47], v[16:19], a[60:63], v[44:47]
  v_mfma_f32_16x16x32_bf16 v[48:51], v[16:19], a[116:119], v[48:51]
  v_mfma_f32_16x16x32_bf16 v[52:55], v[16:19], a[172:175], v[52:55]
  ds_read_b128 v[12:15], v5 offset:18432
  s_waitcnt lgkmcnt(6)
  v_mfma_f32_16x16x32_bf16 v[56:59], v[20:23], a[4:7], v[56:59]
  v_mfma_f32_16x16x32_bf16 v[60:63], v[20:23], a[60:63], v[60:63]
  v_mfma_f32_16x16x32_bf16 v[64:67], v[20:23], a[116:119], v[64:67]
  v_mfma_f32_16x16x32_bf16 v[68:71], v[20:23], a[172:175], v[68:71]
  ds_read_b128 v[16:19], v5 offset:5120
  s_waitcnt lgkmcnt(6)
  v_mfma_f32_16x16x32_bf16 v[40:43], v[24:27], a[8:11], v[40:43]
  v_mfma_f32_16x16x32_bf16 v[44:47], v[24:27], a[64:67], v[44:47]
  v_mfma_f32_16x16x32_bf16 v[48:51], v[24:27], a[120:123], v[48:51]
  v_mfma_f32_16x16x32_bf16 v[52:55], v[24:27], a[176:179], v[52:55]
  ds_read_b128 v[20:23], v5 offset:19456
  s_waitcnt lgkmcnt(6)
  v_mfma_f32_16x16x32_bf16 v[56:59], v[28:31], a[8:11], v[56:59]
  v_mfma_f32_16x16x32_bf16 v[60:63], v[28:31], a[64:67], v[60:63]
  v_mfma_f32_16x16x32_bf16 v[64:67], v[28:31], a[120:123], v[64:67]
  v_mfma_f32_16x16x32_bf16 v[68:71], v[28:31], a[176:179], v[68:71]
  ds_read_b128 v[24:27], v5 offset:6144
  s_waitcnt lgkmcnt(6)
  v_mfma_f32_16x16x32_bf16 v[40:43], v[32:35], a[12:15], v[40:43]
  v_mfma_f32_16x16x32_bf16 v[44:47], v[32:35], a[68:71], v[44:47]
  v_mfma_f32_16x16x32_bf16 v[48:51], v[32:35], a[124:127], v[48:51]
  v_mfma_f32_16x16x32_bf16 v[52:55], v[32:35], a[180:183], v[52:55]
  ds_read_b128 v[28:31], v5 offset:20480
  s_waitcnt lgkmcnt(6)
  v_mfma_f32_16x16x32_bf16 v[56:59], v[36:39], a[12:15], v[56:59]
  v_mfma_f32_16x16x32_bf16 v[60:63], v[36:39], a[68:71], v[60:63]
  v_mfma_f32_16x16x32_bf16 v[64:67], v[36:39], a[124:127], v[64:67]
  v_mfma_f32_16x16x32_bf16 v[68:71], v[36:39], a[180:183], v[68:71]
  ds_read_b128 v[32:35], v5 offset:7168
  s_waitcnt lgkmcnt(6)
  v_mfma_f32_16x16x32_bf16 v[40:43], v[8:11], a[16:19], v[40:43]
  v_mfma_f32_16x16x32_bf16 v[44:47], v[8:11], a[72:75], v[44:47]
  v_mfma_f32_16x16x32_bf16 v[48:51], v[8:11], a[128:131], v[48:51]
  v_mfma_f32_16x16x32_bf16 v[52:55], v[8:11], a[184:187], v[52:55]
  ds_read_b128 v[36:39], v5 offset:21504
  s_waitcnt lgkmcnt(6)
  v_mfma_f32_16x16x32_bf16 v[56:59], v[12:15], a[16:19], v[56:59]
  v_mfma_f32_16x16x32_bf16 v[60:63], v[12:15], a[72:75], v[60:63]
  v_mfma_f32_16x16x32_bf16 v[64:67], v[12:15], a[128:131], v[64:67]
  v_mfma_f32_16x16x32_bf16 v[68:71], v[12:15], a[184:187], v[68:71]
  ds_read_b128 v[8:11], v5 offset:8192
  s_waitcnt lgkmcnt(6)
  v_mfma_f32_16x16x32_bf16 v[40:43], v[16:19], a[20:23], v[40:43]
  v_mfma_f32_16x16x32_bf16 v[44:47], v[16:19], a[76:79], v[44:47]
  v_mfma_f32_16x16x32_bf16 v[48:51], v[16:19], a[132:135], v[48:51]
  v_mfma_f32_16x16x32_bf16 v[52:55], v[16:19], a[188:191], v[52:55]
  ds_read_b128 v[12:15], v5 offset:22528
  s_waitcnt lgkmcnt(6)
  v_mfma_f32_16x16x32_bf16 v[56:59], v[20:23], a[20:23], v[56:59]
  v_mfma_f32_16x16x32_bf16 v[60:63], v[20:23], a[76:79], v[60:63]
  v_mfma_f32_16x16x32_bf16 v[64:67], v[20:23], a[132:135], v[64:67]
  v_mfma_f32_16x16x32_bf16 v[68:71], v[20:23], a[188:191], v[68:71]
  ds_read_b128 v[16:19], v5 offset:9216
  s_waitcnt lgkmcnt(6)
  v_mfma_f32_16x16x32_bf16 v[40:43], v[24:27], a[24:27], v[40:43]
  v_mfma_f32_16x16x32_bf16 v[44:47], v[24:27], a[80:83], v[44:47]
  v_mfma_f32_16x16x32_bf16 v[48:51], v[24:27], a[136:139], v[48:51]
  v_mfma_f32_16x16x32_bf16 v[52:55], v[24:27], a[192:195], v[52:55]
  ds_read_b128 v[20:23], v5 offset:23552
  s_waitcnt lgkmcnt(6)
  v_mfma_f32_16x16x32_bf16 v[56:59], v[28:31], a[24:27], v[56:59]
  v_mfma_f32_16x16x32_bf16 v[60:63], v[28:31], a[80:83], v[60:63]
  v_mfma_f32_16x16x32_bf16 v[64:67], v[28:31], a[136:139], v[64:67]
  v_mfma_f32_16x16x32_bf16 v[68:71], v[28:31], a[192:195], v[68:71]
  ds_read_b128 v[24:27], v5 offset:10240
  s_waitcnt lgkmcnt(6)
  v_mfma_f32_16x16x32_bf16 v[40:43], v[32:35], a[28:31], v[40:43]
  v_mfma_f32_16x16x32_bf16 v[44:47], v[32:35], a[84:87], v[44:47]
  v_mfma_f32_16x16x32_bf16 v[48:51], v[32:35], a[140:143], v[48:51]
  v_mfma_f32_16x16x32_bf16 v[52:55], v[32:35], a[196:199], v[52:55]
  ds_read_b128 v[28:31], v5 offset:24576
  s_waitcnt lgkmcnt(6)
  v_mfma_f32_16x16x32_bf16 v[56:59], v[36:39], a[28:31], v[56:59]
  v_mfma_f32_16x16x32_bf16 v[60:63], v[36:39], a[84:87], v[60:63]
  v_mfma_f32_16x16x32_bf16 v[64:67], v[36:39], a[140:143], v[64:67]
  v_mfma_f32_16x16x32_bf16 v[68:71], v[36:39], a[196:199], v[68:71]
  ds_read_b128 v[32:35], v5 offset:11264
  s_waitcnt lgkmcnt(6)
  v_mfma_f32_16x16x32_bf16 v[40:43], v[8:11], a[32:35], v[40:43]
  v_mfma_f32_16x16x32_bf16 v[44:47], v[8:11], a[88:91], v[44:47]
  v_mfma_f32_16x16x32_bf16 v[48:51], v[8:11], a[144:147], v[48:51]
  v_mfma_f32_16x16x32_bf16 v[52:55], v[8:11], a[200:203], v[52:55]
  ds_read_b128 v[36:39], v5 offset:25600
  s_waitcnt lgkmcnt(6)
  v_mfma_f32_16x16x32_bf16 v[56:59], v[12:15], a[32:35], v[56:59]
  v_mfma_f32_16x16x32_bf16 v[60:63], v[12:15], a[88:91], v[60:63]
  v_mfma_f32_16x16x32_bf16 v[64:67], v[12:15], a[144:147], v[64:67]
  v_mfma_f32_16x16x32_bf16 v[68:71], v[12:15], a[200:203], v[68:71]
  ds_read_b128 v[8:11], v5 offset:12288
  s_waitcnt lgkmcnt(6)
  v_mfma_f32_16x16x32_bf16 v[40:43], v[16:19], a[36:39], v[40:43]
  v_mfma_f32_16x16x32_bf16 v[44:47], v[16:19], a[92:95], v[44:47]
  v_mfma_f32_16x16x32_bf16 v[48:51], v[16:19], a[148:151], v[48:51]
  v_mfma_f32_16x16x32_bf16 v[52:55], v[16:19], a[204:207], v[52:55]
  ds_read_b128 v[12:15], v5 offset:26624
  s_waitcnt lgkmcnt(6)
  v_mfma_f32_16x16x32_bf16 v[56:59], v[20:23], a[36:39], v[56:59]
  v_mfma_f32_16x16x32_bf16 v[60:63], v[20:23], a[92:95], v[60:63]
  v_mfma_f32_16x16x32_bf16 v[64:67], v[20:23], a[148:151], v[64:67]
  v_mfma_f32_16x16x32_bf16 v[68:71], v[20:23], a[204:207], v[68:71]
  ds_read_b128 v[16:19], v5 offset:13312
  s_waitcnt lgkmcnt(6)
  v_mfma_f32_16x16x32_bf16 v[40:43], v[24:27], a[40:43], v[40:43]
  v_mfma_f32_16x16x32_bf16 v[44:47], v[24:27], a[96:99], v[44:47]
  v_mfma_f32_16x16x32_bf16 v[48:51], v[24:27], a[152:155], v[48:51]
  v_mfma_f32_16x16x32_bf16 v[52:55], v[24:27], a[208:211], v[52:55]
  ds_read_b128 v[20:23], v5 offset:27648
  s_waitcnt lgkmcnt(6)
  v_mfma_f32_16x16x32_bf16 v[56:59], v[28:31], a[40:43], v[56:59]
  v_mfma_f32_16x16x32_bf16 v[60:63], v[28:31], a[96:99], v[60:63]
  v_mfma_f32_16x16x32_bf16 v[64:67], v[28:31], a[152:155], v[64:67]
  v_mfma_f32_16x16x32_bf16 v[68:71], v[28:31], a[208:211], v[68:71]
  s_waitcnt lgkmcnt(5)
  v_mfma_f32_16x16x32_bf16 v[40:43], v[32:35], a[44:47], v[40:43]
  v_mfma_f32_16x16x32_bf16 v[44:47], v[32:35], a[100:103], v[44:47]
  v_mfma_f32_16x16x32_bf16 v[48:51], v[32:35], a[156:159], v[48:51]
  v_mfma_f32_16x16x32_bf16 v[52:55], v[32:35], a[212:215], v[52:55]
  s_waitcnt lgkmcnt(4)
  v_mfma_f32_16x16x32_bf16 v[56:59], v[36:39], a[44:47], v[56:59]
  v_mfma_f32_16x16x32_bf16 v[60:63], v[36:39], a[100:103], v[60:63]
  v_mfma_f32_16x16x32_bf16 v[64:67], v[36:39], a[156:159], v[64:67]
  v_mfma_f32_16x16x32_bf16 v[68:71], v[36:39], a[212:215], v[68:71]
  s_waitcnt lgkmcnt(3)
  v_mfma_f32_16x16x32_bf16 v[40:43], v[8:11], a[48:51], v[40:43]
  v_mfma_f32_16x16x32_bf16 v[44:47], v[8:11], a[104:107], v[44:47]
  v_mfma_f32_16x16x32_bf16 v[48:51], v[8:11], a[160:163], v[48:51]
  v_mfma_f32_16x16x32_bf16 v[52:55], v[8:11], a[216:219], v[52:55]
  s_waitcnt lgkmcnt(2)
  v_mfma_f32_16x16x32_bf16 v[56:59], v[12:15], a[48:51], v[56:59]
  v_mfma_f32_16x16x32_bf16 v[60:63], v[12:15], a[104:107], v[60:63]
  v_mfma_f32_16x16x32_bf16 v[64:67], v[12:15], a[160:163], v[64:67]
  v_mfma_f32_16x16x32_bf16 v[68:71], v[12:15], a[216:219], v[68:71]
  s_waitcnt lgkmcnt(1)
  v_mfma_f32_16x16x32_bf16 v[40:43], v[16:19], a[52:55], v[40:43]
  v_mfma_f32_16x16x32_bf16 v[44:47], v[16:19], a[108:111], v[44:47]
  v_mfma_f32_16x16x32_bf16 v[48:51], v[16:19], a[164:167], v[48:51]
  v_mfma_f32_16x16x32_bf16 v[52:55], v[16:19], a[220:223], v[52:55]
  s_waitcnt lgkmcnt(0)
  v_mfma_f32_16x16x32_bf16 v[56:59], v[20:23], a[52:55], v[56:59]
  v_mfma_f32_16x16x32_bf16 v[60:63], v[20:23], a[108:111], v[60:63]
  v_mfma_f32_16x16x32_bf16 v[64:67], v[20:23], a[164:167], v[64:67]
  v_mfma_f32_16x16x32_bf16 v[68:71], v[20:23], a[220:223], v[68:71]
  s_lshl_b32 s24, s19, 10
  s_add_u32 s24, s24, s29
  v_cvt_pk_bf16_f32 v72, v40, v41
  v_cvt_pk_bf16_f32 v73, v42, v43
  v_cvt_pk_bf16_f32 v74, v56, v57
  v_cvt_pk_bf16_f32 v75, v58, v59
  s_add_u32 s25, s24, 0
  buffer_store_dwordx4 v[72:75], v2, s[8:11], s25 offen sc1
  v_cvt_pk_bf16_f32 v76, v44, v45
  v_cvt_pk_bf16_f32 v77, v46, v47
  v_cvt_pk_bf16_f32 v78, v60, v61
  v_cvt_pk_bf16_f32 v79, v62, v63
  s_add_u32 s25, s24, 14336
  buffer_store_dwordx4 v[76:79], v2, s[8:11], s25 offen sc1
  v_cvt_pk_bf16_f32 v80, v48, v49
  v_cvt_pk_bf16_f32 v81, v50, v51
  v_cvt_pk_bf16_f32 v82, v64, v65
  v_cvt_pk_bf16_f32 v83, v66, v67
  s_add_u32 s25, s24, 458752
  buffer_store_dwordx4 v[80:83], v2, s[8:11], s25 offen sc1
  v_cvt_pk_bf16_f32 v84, v52, v53
  v_cvt_pk_bf16_f32 v85, v54, v55
  v_cvt_pk_bf16_f32 v86, v68, v69
  v_cvt_pk_bf16_f32 v87, v70, v71
  s_add_u32 s25, s24, 473088
  buffer_store_dwordx4 v[84:87], v2, s[8:11], s25 offen sc1
  s_mov_b32 s33, s32
  s_add_u32 s32, s32, 28672
  s_cmp_eq_u32 s32, 86016
  s_cselect_b32 s32, 0, s32
  s_add_u32 s19, s19, 1
  s_cmp_lt_u32 s19, s35
  s_cbranch_scc1 wg_f_loop
  s_branch wg_done
wg_vo:
  s_sub_u32 s29, s17, 16
  s_lshl_b32 s29, s29, 6
  s_add_u32 s29, s29, s28
  s_mul_i32 s29, s29, 28672
  s_add_u32 s29, s29, 42205184
  v_mul_u32_u24 v6, 28, v3
  s_mov_b32 s31, 0
  s_lshl_b32 s24, s34, 1
  s_mul_i32 s24, s24, 14336
  s_add_u32 s24, s24, s23
  s_cmp_lt_u32 s34, s35
  s_cselect_b32 s24, s24, 0x10000000
  s_add_u32 m0, s31, s27
  s_nop 0
  buffer_load_dwordx4 v2, s[8:11], s24 offen offset:0 sc1 lds
  buffer_load_dwordx4 v2, s[8:11], s24 offen offset:1024 sc1 lds
  buffer_load_dwordx4 v2, s[8:11], s24 offen offset:2048 sc1 lds
  buffer_load_dwordx4 v2, s[8:11], s24 offen offset:3072 sc1 lds
  s_add_u32 m0, m0, 4096
  s_add_u32 s24, s24, 4096
  buffer_load_dwordx4 v2, s[8:11], s24 offen offset:0 sc1 lds
  buffer_load_dwordx4 v2, s[8:11], s24 offen offset:1024 sc1 lds
  buffer_load_dwordx4 v2, s[8:11], s24 offen offset:2048 sc1 lds
  s_add_u32 s30, s34, 1
  s_mov_b32 s31, 28672
  s_lshl_b32 s24, s30, 1
  s_mul_i32 s24, s24, 14336
  s_add_u32 s24, s24, s23
  s_cmp_lt_u32 s30, s35
  s_cselect_b32 s24, s24, 0x10000000
  s_add_u32 m0, s31, s27
  s_nop 0
  buffer_load_dwordx4 v2, s[8:11], s24 offen offset:0 sc1 lds
  buffer_load_dwordx4 v2, s[8:11], s24 offen offset:1024 sc1 lds
  buffer_load_dwordx4 v2, s[8:11], s24 offen offset:2048 sc1 lds
  buffer_load_dwordx4 v2, s[8:11], s24 offen offset:3072 sc1 lds
  s_add_u32 m0, m0, 4096
  s_add_u32 s24, s24, 4096
  buffer_load_dwordx4 v2, s[8:11], s24 offen offset:0 sc1 lds
  buffer_load_dwordx4 v2, s[8:11], s24 offen offset:1024 sc1 lds
  buffer_load_dwordx4 v2, s[8:11], s24 offen offset:2048 sc1 lds
  s_mov_b32 s19, s34
  s_mov_b32 s32, 0
  s_mov_b32 s33, 57344
  s_waitcnt vmcnt(7)
  s_branch wg_vo_in
wg_vo_loop:
  s_waitcnt vmcnt(11)
wg_vo_in:
  s_barrier
  s_add_u32 s30, s19, 2
  s_lshl_b32 s24, s30, 1
  s_mul_i32 s24, s24, 14336
  s_add_u32 s24, s24, s23
  s_cmp_lt_u32 s30, s35
  s_cselect_b32 s24, s24, 0x10000000
  s_add_u32 m0, s33, s27
  s_nop 0
  buffer_load_dwordx4 v2, s[8:11], s24 offen offset:0 sc1 lds
  buffer_load_dwordx4 v2, s[8:11], s24 offen offset:1024 sc1 lds
  buffer_load_dwordx4 v2, s[8:11], s24 offen offset:2048 sc1 lds
  buffer_load_dwordx4 v2, s[8:11], s24 offen offset:3072 sc1 lds
  s_add_u32 m0, m0, 4096
  s_add_u32 s24, s24, 4096
  buffer_load_dwordx4 v2, s[8:11], s24 offen offset:0 sc1 lds
  buffer_load_dwordx4 v2, s[8:11], s24 offen offset:1024 sc1 lds
  buffer_load_dwordx4 v2, s[8:11], s24 offen offset:2048 sc1 lds
  v_add_u32 v5, s32, v2
  ds_read_b128 v[8:11], v5 offset:0
  ds_read_b128 v[12:15], v5 offset:14336
  ds_read_b128 v[16:19], v5 offset:1024
  ds_read_b128 v[20:23], v5 offset:15360
  ds_read_b128 v[24:27], v5 offset:2048
  ds_read_b128 v[28:31], v5 offset:16384
  ds_read_b128 v[32:35], v5 offset:3072
  s_waitcnt lgkmcnt(6)
  v_mfma_f32_16x16x32_bf16 v[40:43], a[0:3], v[8:11], 0
  v_mfma_f32_16x16x32_bf16 v[44:47], a[56:59], v[8:11], 0
  v_mfma_f32_16x16x32_bf16 v[48:51], a[112:115], v[8:11], 0
  v_mfma_f32_16x16x32_bf16 v[52:55], a[168:171], v[8:11], 0
  ds_read_b128 v[36:39], v5 offset:17408
  s_waitcnt lgkmcnt(6)
  v_mfma_f32_16x16x32_bf16 v[56:59], a[0:3], v[12:15], 0
  v_mfma_f32_16x16x32_bf16 v[60:63], a[56:59], v[12:15], 0
  v_mfma_f32_16x16x32_bf16 v[64:67], a[112:115], v[12:15], 0
  v_mfma_f32_16x16x32_bf16 v[68:71], a[168:171], v[12:15], 0
  ds_read_b128 v[8:11], v5 offset:4096
  s_waitcnt lgkmcnt(6)
  v_mfma_f32_16x16x32_bf16 v[40:43], a[4:7], v[16:19], v[40:43]
  v_mfma_f32_16x16x32_bf16 v[44:47], a[60:63], v[16:19], v[44:47]
  v_mfma_f32_16x16x32_bf16 v[48:51], a[116:119], v[16:19], v[48:51]
  v_mfma_f32_16x16x32_bf16 v[52:55], a[172:175], v[16:19], v[52:55]
  ds_read_b128 v[12:15], v5 offset:18432
  s_waitcnt lgkmcnt(6)
  v_mfma_f32_16x16x32_bf16 v[56:59], a[4:7], v[20:23], v[56:59]
  v_mfma_f32_16x16x32_bf16 v[60:63], a[60:63], v[20:23], v[60:63]
  v_mfma_f32_16x16x32_bf16 v[64:67], a[116:119], v[20:23], v[64:67]
  v_mfma_f32_16x16x32_bf16 v[68:71], a[172:175], v[20:23], v[68:71]
  ds_read_b128 v[16:19], v5 offset:5120
  s_waitcnt lgkmcnt(6)
  v_mfma_f32_16x16x32_bf16 v[40:43], a[8:11], v[24:27], v[40:43]
  v_mfma_f32_16x16x32_bf16 v[44:47], a[64:67], v[24:27], v[44:47]
  v_mfma_f32_16x16x32_bf16 v[48:51], a[120:123], v[24:27], v[48:51]
  v_mfma_f32_16x16x32_bf16 v[52:55], a[176:179], v[24:27], v[52:55]
  ds_read_b128 v[20:23], v5 offset:19456
  s_waitcnt lgkmcnt(6)
  v_mfma_f32_16x16x32_bf16 v[56:59], a[8:11], v[28:31], v[56:59]
  v_mfma_f32_16x16x32_bf16 v[60:63], a[64:67], v[28:31], v[60:63]
  v_mfma_f32_16x16x32_bf16 v[64:67], a[120:123], v[28:31], v[64:67]
  v_mfma_f32_16x16x32_bf16 v[68:71], a[176:179], v[28:31], v[68:71]
  ds_read_b128 v[24:27], v5 offset:6144
  s_waitcnt lgkmcnt(6)
  v_mfma_f32_16x16x32_bf16 v[40:43], a[12:15], v[32:35], v[40:43]
  v_mfma_f32_16x16x32_bf16 v[44:47], a[68:71], v[32:35], v[44:47]
  v_mfma_f32_16x16x32_bf16 v[48:51], a[124:127], v[32:35], v[48:51]
  v_mfma_f32_16x16x32_bf16 v[52:55], a[180:183], v[32:35], v[52:55]
  ds_read_b128 v[28:31], v5 offset:20480
  s_waitcnt lgkmcnt(6)
  v_mfma_f32_16x16x32_bf16 v[56:59], a[12:15], v[36:39], v[56:59]
  v_mfma_f32_16x16x32_bf16 v[60:63], a[68:71], v[36:39], v[60:63]
  v_mfma_f32_16x16x32_bf16 v[64:67], a[124:127], v[36:39], v[64:67]
  v_mfma_f32_16x16x32_bf16 v[68:71], a[180:183], v[36:39], v[68:71]
  ds_read_b128 v[32:35], v5 offset:7168
  s_waitcnt lgkmcnt(6)
  v_mfma_f32_16x16x32_bf16 v[40:43], a[16:19], v[8:11], v[40:43]
  v_mfma_f32_16x16x32_bf16 v[44:47], a[72:75], v[8:11], v[44:47]
  v_mfma_f32_16x16x32_bf16 v[48:51], a[128:131], v[8:11], v[48:51]
  v_mfma_f32_16x16x32_bf16 v[52:55], a[184:187], v[8:11], v[52:55]
  ds_read_b128 v[36:39], v5 offset:21504
  s_waitcnt lgkmcnt(6)
  v_mfma_f32_16x16x32_bf16 v[56:59], a[16:19], v[12:15], v[56:59]
  v_mfma_f32_16x16x32_bf16 v[60:63], a[72:75], v[12:15], v[60:63]
  v_mfma_f32_16x16x32_bf16 v[64:67], a[128:131], v[12:15], v[64:67]
  v_mfma_f32_16x16x32_bf16 v[68:71], a[184:187], v[12:15], v[68:71]
  ds_read_b128 v[8:11], v5 offset:8192
  s_waitcnt lgkmcnt(6)
  v_mfma_f32_16x16x32_bf16 v[40:43], a[20:23], v[16:19], v[40:43]
  v_mfma_f32_16x16x32_bf16 v[44:47], a[76:79], v[16:19], v[44:47]
  v_mfma_f32_16x16x32_bf16 v[48:51], a[132:135], v[16:19], v[48:51]
  v_mfma_f32_16x16x32_bf16 v[52:55], a[188:191], v[16:19], v[52:55]
  ds_read_b128 v[12:15], v5 offset:22528
  s_waitcnt lgkmcnt(6)
  v_mfma_f32_16x16x32_bf16 v[56:59], a[20:23], v[20:23], v[56:59]
  v_mfma_f32_16x16x32_bf16 v[60:63], a[76:79], v[20:23], v[60:63]
  v_mfma_f32_16x16x32_bf16 v[64:67], a[132:135], v[20:23], v[64:67]
  v_mfma_f32_16x16x32_bf16 v[68:71], a[188:191], v[20:23], v[68:71]
  ds_read_b128 v[16:19], v5 offset:9216
  s_waitcnt lgkmcnt(6)
  v_mfma_f32_16x16x32_bf16 v[40:43], a[24:27], v[24:27], v[40:43]
  v_mfma_f32_16x16x32_bf16 v[44:47], a[80:83], v[24:27], v[44:47]
  v_mfma_f32_16x16x32_bf16 v[48:51], a[136:139], v[24:27], v[48:51]
  v_mfma_f32_16x16x32_bf16 v[52:55], a[192:195], v[24:27], v[52:55]
  ds_read_b128 v[20:23], v5 offset:23552
  s_waitcnt lgkmcnt(6)
  v_mfma_f32_16x16x32_bf16 v[56:59], a[24:27], v[28:31], v[56:59]
  v_mfma_f32_16x16x32_bf16 v[60:63], a[80:83], v[28:31], v[60:63]
  v_mfma_f32_16x16x32_bf16 v[64:67], a[136:139], v[28:31], v[64:67]
  v_mfma_f32_16x16x32_bf16 v[68:71], a[192:195], v[28:31], v[68:71]
  ds_read_b128 v[24:27], v5 offset:10240
  s_waitcnt lgkmcnt(6)
  v_mfma_f32_16x16x32_bf16 v[40:43], a[28:31], v[32:35], v[40:43]
  v_mfma_f32_16x16x32_bf16 v[44:47], a[84:87], v[32:35], v[44:47]
  v_mfma_f32_16x16x32_bf16 v[48:51], a[140:143], v[32:35], v[48:51]
  v_mfma_f32_16x16x32_bf16 v[52:55], a[196:199], v[32:35], v[52:55]
  ds_read_b128 v[28:31], v5 offset:24576
  s_waitcnt lgkmcnt(6)
  v_mfma_f32_16x16x32_bf16 v[56:59], a[28:31], v[36:39], v[56:59]
  v_mfma_f32_16x16x32_bf16 v[60:63], a[84:87], v[36:39], v[60:63]
  v_mfma_f32_16x16x32_bf16 v[64:67], a[140:143], v[36:39], v[64:67]
  v_mfma_f32_16x16x32_bf16 v[68:71], a[196:199], v[36:39], v[68:71]
  ds_read_b128 v[32:35], v5 offset:11264
  s_waitcnt lgkmcnt(6)
  v_mfma_f32_16x16x32_bf16 v[40:43], a[32:35], v[8:11], v[40:43]
  v_mfma_f32_16x16x32_bf16 v[44:47], a[88:91], v[8:11], v[44:47]
  v_mfma_f32_16x16x32_bf16 v[48:51], a[144:147], v[8:11], v[48:51]
  v_mfma_f32_16x16x32_bf16 v[52:55], a[200:203], v[8:11], v[52:55]
  ds_read_b128 v[36:39], v5 offset:25600
  s_waitcnt lgkmcnt(6)
  v_mfma_f32_16x16x32_bf16 v[56:59], a[32:35], v[12:15], v[56:59]
  v_mfma_f32_16x16x32_bf16 v[60:63], a[88:91], v[12:15], v[60:63]
  v_mfma_f32_16x16x32_bf16 v[64:67], a[144:147], v[12:15], v[64:67]
  v_mfma_f32_16x16x32_bf16 v[68:71], a[200:203], v[12:15], v[68:71]
  ds_read_b128 v[8:11], v5 offset:12288
  s_waitcnt lgkmcnt(6)
  v_mfma_f32_16x16x32_bf16 v[40:43], a[36:39], v[16:19], v[40:43]
  v_mfma_f32_16x16x32_bf16 v[44:47], a[92:95], v[16:19], v[44:47]
  v_mfma_f32_16x16x32_bf16 v[48:51], a[148:151], v[16:19], v[48:51]
  v_mfma_f32_16x16x32_bf16 v[52:55], a[204:207], v[16:19], v[52:55]
  ds_read_b128 v[12:15], v5 offset:26624
  s_waitcnt lgkmcnt(6)
  v_mfma_f32_16x16x32_bf16 v[56:59], a[36:39], v[20:23], v[56:59]
  v_mfma_f32_16x16x32_bf16 v[60:63], a[92:95], v[20:23], v[60:63]
  v_mfma_f32_16x16x32_bf16 v[64:67], a[148:151], v[20:23], v[64:67]
  v_mfma_f32_16x16x32_bf16 v[68:71], a[204:207], v[20:23], v[68:71]
  ds_read_b128 v[16:19], v5 offset:13312
  s_waitcnt lgkmcnt(6)
  v_mfma_f32_16x16x32_bf16 v[40:43], a[40:43], v[24:27], v[40:43]
  v_mfma_f32_16x16x32_bf16 v[44:47], a[96:99], v[24:27], v[44:47]
  v_mfma_f32_16x16x32_bf16 v[48:51], a[152:155], v[24:27], v[48:51]
  v_mfma_f32_16x16x32_bf16 v[52:55], a[208:211], v[24:27], v[52:55]
  ds_read_b128 v[20:23], v5 offset:27648
  s_waitcnt lgkmcnt(6)
  v_mfma_f32_16x16x32_bf16 v[56:59], a[40:43], v[28:31], v[56:59]
  v_mfma_f32_16x16x32_bf16 v[60:63], a[96:99], v[28:31], v[60:63]
  v_mfma_f32_16x16x32_bf16 v[64:67], a[152:155], v[28:31], v[64:67]
  v_mfma_f32_16x16x32_bf16 v[68:71], a[208:211], v[28:31], v[68:71]
  s_waitcnt lgkmcnt(5)
  v_mfma_f32_16x16x32_bf16 v[40:43], a[44:47], v[32:35], v[40:43]
  v_mfma_f32_16x16x32_bf16 v[44:47], a[100:103], v[32:35], v[44:47]
  v_mfma_f32_16x16x32_bf16 v[48:51], a[156:159], v[32:35], v[48:51]
  v_mfma_f32_16x16x32_bf16 v[52:55], a[212:215], v[32:35], v[52:55]
  s_waitcnt lgkmcnt(4)
  v_mfma_f32_16x16x32_bf16 v[56:59], a[44:47], v[36:39], v[56:59]
  v_mfma_f32_16x16x32_bf16 v[60:63], a[100:103], v[36:39], v[60:63]
  v_mfma_f32_16x16x32_bf16 v[64:67], a[156:159], v[36:39], v[64:67]
  v_mfma_f32_16x16x32_bf16 v[68:71], a[212:215], v[36:39], v[68:71]
  s_waitcnt lgkmcnt(3)
  v_mfma_f32_16x16x32_bf16 v[40:43], a[48:51], v[8:11], v[40:43]
  v_mfma_f32_16x16x32_bf16 v[44:47], a[104:107], v[8:11], v[44:47]
  v_mfma_f32_16x16x32_bf16 v[48:51], a[160:163], v[8:11], v[48:51]
  v_mfma_f32_16x16x32_bf16 v[52:55], a[216:219], v[8:11], v[52:55]
  s_waitcnt lgkmcnt(2)
  v_mfma_f32_16x16x32_bf16 v[56:59], a[48:51], v[12:15], v[56:59]
  v_mfma_f32_16x16x32_bf16 v[60:63], a[104:107], v[12:15], v[60:63]
  v_mfma_f32_16x16x32_bf16 v[64:67], a[160:163], v[12:15], v[64:67]
  v_mfma_f32_16x16x32_bf16 v[68:71], a[216:219], v[12:15], v[68:71]
  s_waitcnt lgkmcnt(1)
  v_mfma_f32_16x16x32_bf16 v[40:43], a[52:55], v[16:19], v[40:43]
  v_mfma_f32_16x16x32_bf16 v[44:47], a[108:111], v[16:19], v[44:47]
  v_mfma_f32_16x16x32_bf16 v[48:51], a[164:167], v[16:19], v[48:51]
  v_mfma_f32_16x16x32_bf16 v[52:55], a[220:223], v[16:19], v[52:55]
  s_waitcnt lgkmcnt(0)
  v_mfma_f32_16x16x32_bf16 v[56:59], a[52:55], v[20:23], v[56:59]
  v_mfma_f32_16x16x32_bf16 v[60:63], a[108:111], v[20:23], v[60:63]
  v_mfma_f32_16x16x32_bf16 v[64:67], a[164:167], v[20:23], v[64:67]
  v_mfma_f32_16x16x32_bf16 v[68:71], a[220:223], v[20:23], v[68:71]
  s_add_u32 s25, s29, 28672
  s_lshl_b32 s24, s19, 5
  s_add_u32 s24, s24, 0
  v_add_u32 v88, s24, v4
  v_mul_u32_u24 v89, 2341, v88
  v_lshrrev_b32 v89, 16, v89
  v_mul_u32_u24 v89, 84, v89
  v_add3_u32 v88, v88, v89, v6
  v_lshlrev_b32 v90, 4, v88
  v_cvt_pk_bf16_f32 v72, v40, v41
  v_cvt_pk_bf16_f32 v73, v42, v43
  v_cvt_pk_bf16_f32 v74, v44, v45
  v_cvt_pk_bf16_f32 v75, v46, v47
  buffer_store_dwordx4 v[72:75], v90, s[8:11], s29 offen sc1
  v_cvt_pk_bf16_f32 v76, v48, v49
  v_cvt_pk_bf16_f32 v77, v50, v51
  v_cvt_pk_bf16_f32 v78, v52, v53
  v_cvt_pk_bf16_f32 v79, v54, v55
  buffer_store_dwordx4 v[76:79], v90, s[8:11], s25 offen sc1
  s_lshl_b32 s24, s19, 5
  s_add_u32 s24, s24, 16
  v_add_u32 v88, s24, v4
  v_mul_u32_u24 v89, 2341, v88
  v_lshrrev_b32 v89, 16, v89
  v_mul_u32_u24 v89, 84, v89
  v_add3_u32 v88, v88, v89, v6
  v_lshlrev_b32 v91, 4, v88
  v_cvt_pk_bf16_f32 v80, v56, v57
  v_cvt_pk_bf16_f32 v81, v58, v59
  v_cvt_pk_bf16_f32 v82, v60, v61
  v_cvt_pk_bf16_f32 v83, v62, v63
  buffer_store_dwordx4 v[80:83], v91, s[8:11], s29 offen sc1
  v_cvt_pk_bf16_f32 v84, v64, v65
  v_cvt_pk_bf16_f32 v85, v66, v67
  v_cvt_pk_bf16_f32 v86, v68, v69
  v_cvt_pk_bf16_f32 v87, v70, v71
  buffer_store_dwordx4 v[84:87], v91, s[8:11], s25 offen sc1
  s_mov_b32 s33, s32
  s_add_u32 s32, s32, 28672
  s_cmp_eq_u32 s32, 86016
  s_cselect_b32 s32, 0, s32
  s_add_u32 s19, s19, 1
  s_cmp_lt_u32 s19, s35
  s_cbranch_scc1 wg_vo_loop
  s_branch wg_done
wg_done:
  s_lshl_b32 s20, s18, 4
  s_and_b32 s21, s17, 15
  s_add_u32 s20, s20, s21
  s_lshl_b32 s20, s20, 7
  s_cmp_lt_u32 s17, 16
  s_cselect_b32 s21, 16384, 0
  s_add_u32 s20, s20, s21
  s_add_u32 s20, s20, 88528896
  s_sub_u32 s21, s35, s34
  v_mov_b32 v5, s21
  v_mov_b32 v6, 0
  s_waitcnt vmcnt(0)
  s_mov_b64 exec, 1
  buffer_atomic_add v5, v6, s[8:11], s20 offen
  s_mov_b64 exec, -1
  s_branch wk_loop
wk_a:
  s_load_dwordx8 s[36:43], s[0:1], 56
  s_load_dwordx4 s[44:47], s[0:1], 88
  s_sub_u32 s3, s3, 432
  s_and_b32 s17, s3, 15
  s_lshr_b32 s19, s3, 5
  s_bitcmp1_b32 s3, 4
  s_cselect_b32 s31, 7, 0
  s_waitcnt lgkmcnt(0)
  s_mov_b32 s60, s40
  s_and_b32 s61, s41, 0xffff
  s_mov_b32 s62, 3670016
  s_mov_b32 s63, 0x20000
  s_mov_b32 s56, s42
  s_and_b32 s57, s43, 0xffff
  s_mov_b32 s58, 3670016
  s_mov_b32 s59, 0x20000
  s_lshl_b32 s30, s16, 13
  s_lshl_b32 s27, s19, 19
  s_lshl_b32 s29, s16, 17
  s_add_u32 s27, s27, s29
  s_lshl_b32 s29, s17, 9
  s_add_u32 s27, s27, s29
  v_lshrrev_b32 v5, 5, v1
  v_and_b32 v6, 31, v1
  v_xor_b32 v6, v6, v5
  v_lshlrev_b32 v6, 4, v6
  v_lshl_add_u32 v6, v5, 13, v6
  s_add_u32 m0, s30, 0
  s_add_u32 s22, s27, 0
  v_xor_b32 v7, 0, v6
  buffer_load_dwordx4 v7, s[56:59], s22 offen offset:0 lds
  s_add_u32 s22, s27, 15360
  v_xor_b32 v7, 32, v6
  buffer_load_dwordx4 v7, s[56:59], s22 offen offset:1024 lds
  s_add_u32 s22, s27, 30720
  v_xor_b32 v7, 64, v6
  buffer_load_dwordx4 v7, s[56:59], s22 offen offset:2048 lds
  s_add_u32 s22, s27, 46080
  v_xor_b32 v7, 96, v6
  buffer_load_dwordx4 v7, s[56:59], s22 offen offset:3072 lds
  s_add_u32 m0, s30, 4096
  s_add_u32 s22, s27, 65536
  v_xor_b32 v7, 128, v6
  buffer_load_dwordx4 v7, s[56:59], s22 offen offset:0 lds
  s_add_u32 s22, s27, 80896
  v_xor_b32 v7, 160, v6
  buffer_load_dwordx4 v7, s[56:59], s22 offen offset:1024 lds
  s_add_u32 s22, s27, 96256
  v_xor_b32 v7, 192, v6
  buffer_load_dwordx4 v7, s[56:59], s22 offen offset:2048 lds
  s_add_u32 s22, s27, 111616
  v_xor_b32 v7, 224, v6
  buffer_load_dwordx4 v7, s[56:59], s22 offen offset:3072 lds
  v_lshrrev_b32 v5, 5, v1
  v_and_b32 v6, 31, v1
  s_lshl_b32 s25, s16, 15
  s_add_u32 s25, s25, 32768
  s_lshl_b32 s26, s17, 9
  s_add_u32 s28, s19, s16
  s_cmp_ge_u32 s28, 7
  s_cselect_b32 s20, 7, 0
  s_sub_u32 s28, s28, s20
  s_add_u32 s28, s28, s31
  s_add_u32 s29, s19, s16
  s_add_u32 s29, s29, 4
  s_cmp_ge_u32 s29, 7
  s_cselect_b32 s20, 7, 0
  s_sub_u32 s29, s29, s20
  s_add_u32 s29, s29, s31
  s_lshl_b32 s32, s28, 18
  s_add_u32 s32, s32, s26
  s_lshl_b32 s33, s29, 18
  s_add_u32 s33, s33, s26
  v_xor_b32 v8, v6, v5
  v_lshlrev_b32 v8, 4, v8
  v_lshl_add_u32 v8, v5, 13, v8
  v_xor_b32 v12, 0, v8
  v_xor_b32 v13, 32, v8
  v_add_u32 v13, 15360, v13
  v_xor_b32 v14, 0, v8
  v_add_u32 v14, 30720, v14
  v_xor_b32 v15, 32, v8
  v_add_u32 v15, 46080, v15
  s_add_u32 s20, s16, 0
  s_and_b32 s20, s20, 3
  s_mul_i32 s21, s20, 65600
  s_lshl_b32 s20, s20, 12
  s_add_u32 s48, s20, s25
  s_mov_b32 m0, s48
  v_xor_b32 v16, s21, v12
  buffer_load_dwordx4 v16, s[60:63], s32 offen offset:0 lds
  v_xor_b32 v17, s21, v13
  buffer_load_dwordx4 v17, s[60:63], s32 offen offset:1024 lds
  v_xor_b32 v18, s21, v14
  buffer_load_dwordx4 v18, s[60:63], s32 offen offset:2048 lds
  v_xor_b32 v19, s21, v15
  buffer_load_dwordx4 v19, s[60:63], s32 offen offset:3072 lds
  s_add_u32 s20, s16, 1
  s_and_b32 s20, s20, 3
  s_mul_i32 s21, s20, 65600
  s_lshl_b32 s20, s20, 12
  s_add_u32 s49, s20, s25
  s_mov_b32 m0, s49
  v_xor_b32 v20, s21, v12
  buffer_load_dwordx4 v20, s[60:63], s32 offen offset:0 lds
  v_xor_b32 v21, s21, v13
  buffer_load_dwordx4 v21, s[60:63], s32 offen offset:1024 lds
  v_xor_b32 v22, s21, v14
  buffer_load_dwordx4 v22, s[60:63], s32 offen offset:2048 lds
  v_xor_b32 v23, s21, v15
  buffer_load_dwordx4 v23, s[60:63], s32 offen offset:3072 lds
  s_add_u32 s20, s16, 2
  s_and_b32 s20, s20, 3
  s_mul_i32 s21, s20, 65600
  s_lshl_b32 s20, s20, 12
  s_add_u32 s50, s20, s25
  s_mov_b32 m0, s50
  v_xor_b32 v24, s21, v12
  buffer_load_dwordx4 v24, s[60:63], s32 offen offset:0 lds
  v_xor_b32 v25, s21, v13
  buffer_load_dwordx4 v25, s[60:63], s32 offen offset:1024 lds
  v_xor_b32 v26, s21, v14
  buffer_load_dwordx4 v26, s[60:63], s32 offen offset:2048 lds
  v_xor_b32 v27, s21, v15
  buffer_load_dwordx4 v27, s[60:63], s32 offen offset:3072 lds
  s_add_u32 s20, s16, 3
  s_and_b32 s20, s20, 3
  s_mul_i32 s21, s20, 65600
  s_lshl_b32 s20, s20, 12
  s_add_u32 s51, s20, s25
  s_mov_b32 m0, s51
  v_xor_b32 v28, s21, v12
  buffer_load_dwordx4 v28, s[60:63], s32 offen offset:0 lds
  v_xor_b32 v29, s21, v13
  buffer_load_dwordx4 v29, s[60:63], s32 offen offset:1024 lds
  v_xor_b32 v30, s21, v14
  buffer_load_dwordx4 v30, s[60:63], s32 offen offset:2048 lds
  v_xor_b32 v31, s21, v15
  buffer_load_dwordx4 v31, s[60:63], s32 offen offset:3072 lds
  s_mul_i32 s30, s17, 401408
  s_mul_i32 s20, s19, 57344
  s_add_u32 s30, s30, s20
  v_add_u32 v12, s30, v2
  v_add_u32 v13, 14336, v12
  v_add_u32 v14, 28672, v12
  v_add_u32 v15, 43008, v12
  v_lshrrev_b32 v7, 2, v4
  v_lshlrev_b32 v7, 3, v7
  v_and_b32 v8, 3, v4
  v_add_u32 v7, v7, v8
  v_xor_b32 v10, v3, v4
  v_lshlrev_b32 v10, 4, v10
  v_lshl_add_u32 v10, v7, 9, v10
  v_add_u32 v10, s25, v10
  v_xor_b32 v32, 0, v10
  v_xor_b32 v33, 64, v10
  v_xor_b32 v34, 128, v10
  v_xor_b32 v35, 192, v10
  v_and_b32 v8, 2, v4
  v_lshlrev_b32 v8, 1, v8
  v_and_b32 v9, 1, v4
  v_add_u32 v8, v8, v9
  v_lshrrev_b32 v7, 2, v4
  v_lshl_add_u32 v7, v7, 4, v8
  v_xor_b32 v8, v8, v3
  v_lshlrev_b32 v8, 4, v8
  v_lshl_add_u32 v7, v7, 9, v8
  s_mov_b32 s24, 1035512379
  s_waitcnt vmcnt(16)
  s_barrier
  s_cmp_eq_u32 s16, 3
  s_cbranch_scc1 aj_np0
  s_add_u32 m0, s48, 16384
  s_nop 0
  buffer_load_dwordx4 v16, s[60:63], s33 offen offset:0 lds
  buffer_load_dwordx4 v17, s[60:63], s33 offen offset:1024 lds
  buffer_load_dwordx4 v18, s[60:63], s33 offen offset:2048 lds
  buffer_load_dwordx4 v19, s[60:63], s33 offen offset:3072 lds
aj_np0:
  v_xor_b32 v8, 0, v7
  ds_read_b128 v[128:131], v8 offset:0
  v_xor_b32 v9, 64, v7
  ds_read_b128 v[132:135], v9 offset:0
  v_xor_b32 v10, 128, v7
  ds_read_b128 v[136:139], v10 offset:0
  v_xor_b32 v11, 192, v7
  ds_read_b128 v[140:143], v11 offset:0
  ds_read_b128 v[144:147], v8 offset:256
  ds_read_b128 v[148:151], v9 offset:256
  ds_read_b128 v[152:155], v10 offset:256
  ds_read_b128 v[156:159], v11 offset:256
  s_waitcnt lgkmcnt(4)
  s_cmp_eq_u32 s16, 3
  s_cbranch_scc1 aj_np1
  s_add_u32 m0, s49, 16384
  s_nop 0
  buffer_load_dwordx4 v20, s[60:63], s33 offen offset:0 lds
  buffer_load_dwordx4 v21, s[60:63], s33 offen offset:1024 lds
  buffer_load_dwordx4 v22, s[60:63], s33 offen offset:2048 lds
  buffer_load_dwordx4 v23, s[60:63], s33 offen offset:3072 lds
aj_np1:
  v_xor_b32 v8, 32, v7
  ds_read_b128 v[160:163], v8 offset:1024
  v_xor_b32 v9, 96, v7
  ds_read_b128 v[164:167], v9 offset:1024
  v_xor_b32 v10, 160, v7
  ds_read_b128 v[168:171], v10 offset:1024
  v_xor_b32 v11, 224, v7
  ds_read_b128 v[172:175], v11 offset:1024
  ds_read_b128 v[176:179], v8 offset:1280
  ds_read_b128 v[180:183], v9 offset:1280
  ds_read_b128 v[184:187], v10 offset:1280
  ds_read_b128 v[188:191], v11 offset:1280
  s_waitcnt lgkmcnt(4)
  s_cmp_eq_u32 s16, 3
  s_cbranch_scc1 aj_np2
  s_add_u32 m0, s50, 16384
  s_nop 0
  buffer_load_dwordx4 v24, s[60:63], s33 offen offset:0 lds
  buffer_load_dwordx4 v25, s[60:63], s33 offen offset:1024 lds
  buffer_load_dwordx4 v26, s[60:63], s33 offen offset:2048 lds
  buffer_load_dwordx4 v27, s[60:63], s33 offen offset:3072 lds
aj_np2:
  v_xor_b32 v8, 128, v7
  ds_read_b128 v[192:195], v8 offset:4096
  v_xor_b32 v9, 192, v7
  ds_read_b128 v[196:199], v9 offset:4096
  v_xor_b32 v10, 0, v7
  ds_read_b128 v[200:203], v10 offset:4096
  v_xor_b32 v11, 64, v7
  ds_read_b128 v[204:207], v11 offset:4096
  ds_read_b128 v[208:211], v8 offset:4352
  ds_read_b128 v[212:215], v9 offset:4352
  ds_read_b128 v[216:219], v10 offset:4352
  ds_read_b128 v[220:223], v11 offset:4352
  s_waitcnt lgkmcnt(4)
  s_cmp_eq_u32 s16, 3
  s_cbranch_scc1 aj_np3
  s_add_u32 m0, s51, 16384
  s_nop 0
  buffer_load_dwordx4 v28, s[60:63], s33 offen offset:0 lds
  buffer_load_dwordx4 v29, s[60:63], s33 offen offset:1024 lds
  buffer_load_dwordx4 v30, s[60:63], s33 offen offset:2048 lds
  buffer_load_dwordx4 v31, s[60:63], s33 offen offset:3072 lds
aj_np3:
  v_xor_b32 v8, 160, v7
  ds_read_b128 v[224:227], v8 offset:5120
  v_xor_b32 v9, 224, v7
  ds_read_b128 v[228:231], v9 offset:5120
  v_xor_b32 v10, 32, v7
  ds_read_b128 v[232:235], v10 offset:5120
  v_xor_b32 v11, 96, v7
  ds_read_b128 v[236:239], v11 offset:5120
  ds_read_b128 v[240:243], v8 offset:5376
  ds_read_b128 v[244:247], v9 offset:5376
  ds_read_b128 v[248:251], v10 offset:5376
  ds_read_b128 v[252:255], v11 offset:5376
  s_waitcnt lgkmcnt(4)
  s_waitcnt vmcnt(16) lgkmcnt(0)
  s_cmp_lg_u32 s16, 3
  s_cbranch_scc1 w3_37
  s_waitcnt vmcnt(0)
w3_37:
  ds_read_b128 v[52:55], v32 offset:0
  ds_read_b128 v[56:59], v33 offset:0
  ds_read_b128 v[60:63], v34 offset:0
  ds_read_b128 v[64:67], v35 offset:0
  s_waitcnt lgkmcnt(3)
  v_mfma_f32_16x16x32_bf16 v[96:99], v[52:55], v[128:131], 0
  v_mfma_f32_16x16x32_bf16 v[100:103], v[52:55], v[160:163], 0
  v_mfma_f32_16x16x32_bf16 v[104:107], v[52:55], v[192:195], 0
  v_mfma_f32_16x16x32_bf16 v[108:111], v[52:55], v[224:227], 0
  ds_read_b128 v[52:55], v32 offset:256
  s_waitcnt lgkmcnt(3)
  v_mfma_f32_16x16x32_bf16 v[96:99], v[56:59], v[132:135], v[96:99]
  v_mfma_f32_16x16x32_bf16 v[100:103], v[56:59], v[164:167], v[100:103]
  v_mfma_f32_16x16x32_bf16 v[104:107], v[56:59], v[196:199], v[104:107]
  v_mfma_f32_16x16x32_bf16 v[108:111], v[56:59], v[228:231], v[108:111]
  ds_read_b128 v[56:59], v33 offset:256
  s_waitcnt lgkmcnt(3)
  v_mfma_f32_16x16x32_bf16 v[96:99], v[60:63], v[136:139], v[96:99]
  v_mfma_f32_16x16x32_bf16 v[100:103], v[60:63], v[168:171], v[100:103]
  v_mfma_f32_16x16x32_bf16 v[104:107], v[60:63], v[200:203], v[104:107]
  v_mfma_f32_16x16x32_bf16 v[108:111], v[60:63], v[232:235], v[108:111]
  ds_read_b128 v[60:63], v34 offset:256
  s_waitcnt lgkmcnt(3)
  v_mfma_f32_16x16x32_bf16 v[96:99], v[64:67], v[140:143], v[96:99]
  v_mfma_f32_16x16x32_bf16 v[100:103], v[64:67], v[172:175], v[100:103]
  v_mfma_f32_16x16x32_bf16 v[104:107], v[64:67], v[204:207], v[104:107]
  v_mfma_f32_16x16x32_bf16 v[108:111], v[64:67], v[236:239], v[108:111]
  ds_read_b128 v[64:67], v35 offset:256
  s_waitcnt lgkmcnt(3)
  v_mfma_f32_16x16x32_bf16 v[96:99], v[52:55], v[144:147], v[96:99]
  v_mfma_f32_16x16x32_bf16 v[100:103], v[52:55], v[176:179], v[100:103]
  v_mfma_f32_16x16x32_bf16 v[104:107], v[52:55], v[208:211], v[104:107]
  v_mfma_f32_16x16x32_bf16 v[108:111], v[52:55], v[240:243], v[108:111]
  ds_read_b128 v[52:55], v32 offset:2048
  s_waitcnt lgkmcnt(3)
  v_mfma_f32_16x16x32_bf16 v[96:99], v[56:59], v[148:151], v[96:99]
  v_mfma_f32_16x16x32_bf16 v[100:103], v[56:59], v[180:183], v[100:103]
  v_mfma_f32_16x16x32_bf16 v[104:107], v[56:59], v[212:215], v[104:107]
  v_mfma_f32_16x16x32_bf16 v[108:111], v[56:59], v[244:247], v[108:111]
  ds_read_b128 v[56:59], v33 offset:2048
  s_waitcnt lgkmcnt(3)
  v_mfma_f32_16x16x32_bf16 v[96:99], v[60:63], v[152:155], v[96:99]
  v_mfma_f32_16x16x32_bf16 v[100:103], v[60:63], v[184:187], v[100:103]
  v_mfma_f32_16x16x32_bf16 v[104:107], v[60:63], v[216:219], v[104:107]
  v_mfma_f32_16x16x32_bf16 v[108:111], v[60:63], v[248:251], v[108:111]
  ds_read_b128 v[60:63], v34 offset:2048
  s_waitcnt lgkmcnt(3)
  v_mfma_f32_16x16x32_bf16 v[96:99], v[64:67], v[156:159], v[96:99]
  v_mfma_f32_16x16x32_bf16 v[100:103], v[64:67], v[188:191], v[100:103]
  v_mfma_f32_16x16x32_bf16 v[104:107], v[64:67], v[220:223], v[104:107]
  v_mfma_f32_16x16x32_bf16 v[108:111], v[64:67], v[252:255], v[108:111]
  ds_read_b128 v[64:67], v35 offset:2048
  s_waitcnt lgkmcnt(3)
  v_mfma_f32_16x16x32_bf16 v[112:115], v[52:55], v[128:131], 0
  v_mfma_f32_16x16x32_bf16 v[116:119], v[52:55], v[160:163], 0
  v_mfma_f32_16x16x32_bf16 v[120:123], v[52:55], v[192:195], 0
  v_mfma_f32_16x16x32_bf16 v[124:127], v[52:55], v[224:227], 0
  ds_read_b128 v[52:55], v32 offset:2304
  s_waitcnt lgkmcnt(3)
  v_mfma_f32_16x16x32_bf16 v[112:115], v[56:59], v[132:135], v[112:115]
  v_mfma_f32_16x16x32_bf16 v[116:119], v[56:59], v[164:167], v[116:119]
  v_mfma_f32_16x16x32_bf16 v[120:123], v[56:59], v[196:199], v[120:123]
  v_mfma_f32_16x16x32_bf16 v[124:127], v[56:59], v[228:231], v[124:127]
  ds_read_b128 v[56:59], v33 offset:2304
  s_waitcnt lgkmcnt(3)
  v_mfma_f32_16x16x32_bf16 v[112:115], v[60:63], v[136:139], v[112:115]
  v_mfma_f32_16x16x32_bf16 v[116:119], v[60:63], v[168:171], v[116:119]
  v_mfma_f32_16x16x32_bf16 v[120:123], v[60:63], v[200:203], v[120:123]
  v_mfma_f32_16x16x32_bf16 v[124:127], v[60:63], v[232:235], v[124:127]
  ds_read_b128 v[60:63], v34 offset:2304
  s_waitcnt lgkmcnt(3)
  v_mfma_f32_16x16x32_bf16 v[112:115], v[64:67], v[140:143], v[112:115]
  v_mfma_f32_16x16x32_bf16 v[116:119], v[64:67], v[172:175], v[116:119]
  v_mfma_f32_16x16x32_bf16 v[120:123], v[64:67], v[204:207], v[120:123]
  v_mfma_f32_16x16x32_bf16 v[124:127], v[64:67], v[236:239], v[124:127]
  ds_read_b128 v[64:67], v35 offset:2304
  s_waitcnt lgkmcnt(3)
  v_mfma_f32_16x16x32_bf16 v[112:115], v[52:55], v[144:147], v[112:115]
  v_mfma_f32_16x16x32_bf16 v[116:119], v[52:55], v[176:179], v[116:119]
  v_mfma_f32_16x16x32_bf16 v[120:123], v[52:55], v[208:211], v[120:123]
  v_mfma_f32_16x16x32_bf16 v[124:127], v[52:55], v[240:243], v[124:127]
  s_waitcnt lgkmcnt(2)
  v_mfma_f32_16x16x32_bf16 v[112:115], v[56:59], v[148:151], v[112:115]
  v_mfma_f32_16x16x32_bf16 v[116:119], v[56:59], v[180:183], v[116:119]
  v_mfma_f32_16x16x32_bf16 v[120:123], v[56:59], v[212:215], v[120:123]
  v_mfma_f32_16x16x32_bf16 v[124:127], v[56:59], v[244:247], v[124:127]
  s_waitcnt lgkmcnt(1)
  v_mfma_f32_16x16x32_bf16 v[112:115], v[60:63], v[152:155], v[112:115]
  v_mfma_f32_16x16x32_bf16 v[116:119], v[60:63], v[184:187], v[116:119]
  v_mfma_f32_16x16x32_bf16 v[120:123], v[60:63], v[216:219], v[120:123]
  v_mfma_f32_16x16x32_bf16 v[124:127], v[60:63], v[248:251], v[124:127]
  s_waitcnt lgkmcnt(0)
  v_mfma_f32_16x16x32_bf16 v[112:115], v[64:67], v[156:159], v[112:115]
  v_mfma_f32_16x16x32_bf16 v[116:119], v[64:67], v[188:191], v[116:119]
  v_mfma_f32_16x16x32_bf16 v[120:123], v[64:67], v[220:223], v[120:123]
  v_mfma_f32_16x16x32_bf16 v[124:127], v[64:67], v[252:255], v[124:127]
  s_lshl_b32 s30, s28, 10
  v_mul_f32 v96, s24, v96
  v_mul_f32 v97, s24, v97
  v_mul_f32 v98, s24, v98
  v_mul_f32 v99, s24, v99
  v_cvt_pk_bf16_f32 v68, v96, v97
  v_cvt_pk_bf16_f32 v69, v98, v99
  v_mul_f32 v112, s24, v112
  v_mul_f32 v113, s24, v113
  v_mul_f32 v114, s24, v114
  v_mul_f32 v115, s24, v115
  v_cvt_pk_bf16_f32 v70, v112, v113
  v_cvt_pk_bf16_f32 v71, v114, v115
  buffer_store_dwordx4 v[68:71], v12, s[8:11], s30 offen sc1
  v_mul_f32 v100, s24, v100
  v_mul_f32 v101, s24, v101
  v_mul_f32 v102, s24, v102
  v_mul_f32 v103, s24, v103
  v_cvt_pk_bf16_f32 v72, v100, v101
  v_cvt_pk_bf16_f32 v73, v102, v103
  v_mul_f32 v116, s24, v116
  v_mul_f32 v117, s24, v117
  v_mul_f32 v118, s24, v118
  v_mul_f32 v119, s24, v119
  v_cvt_pk_bf16_f32 v74, v116, v117
  v_cvt_pk_bf16_f32 v75, v118, v119
  buffer_store_dwordx4 v[72:75], v13, s[8:11], s30 offen sc1
  v_mul_f32 v104, s24, v104
  v_mul_f32 v105, s24, v105
  v_mul_f32 v106, s24, v106
  v_mul_f32 v107, s24, v107
  v_cvt_pk_bf16_f32 v76, v104, v105
  v_cvt_pk_bf16_f32 v77, v106, v107
  v_mul_f32 v120, s24, v120
  v_mul_f32 v121, s24, v121
  v_mul_f32 v122, s24, v122
  v_mul_f32 v123, s24, v123
  v_cvt_pk_bf16_f32 v78, v120, v121
  v_cvt_pk_bf16_f32 v79, v122, v123
  buffer_store_dwordx4 v[76:79], v14, s[8:11], s30 offen sc1
  v_mul_f32 v108, s24, v108
  v_mul_f32 v109, s24, v109
  v_mul_f32 v110, s24, v110
  v_mul_f32 v111, s24, v111
  v_cvt_pk_bf16_f32 v80, v108, v109
  v_cvt_pk_bf16_f32 v81, v110, v111
  v_mul_f32 v124, s24, v124
  v_mul_f32 v125, s24, v125
  v_mul_f32 v126, s24, v126
  v_mul_f32 v127, s24, v127
  v_cvt_pk_bf16_f32 v82, v124, v125
  v_cvt_pk_bf16_f32 v83, v126, v127
  buffer_store_dwordx4 v[80:83], v15, s[8:11], s30 offen sc1
  s_cmp_eq_u32 s16, 3
  s_cbranch_scc1 aj_w3
  s_waitcnt vmcnt(4)
  ds_read_b128 v[52:55], v32 offset:16384
  ds_read_b128 v[56:59], v33 offset:16384
  ds_read_b128 v[60:63], v34 offset:16384
  ds_read_b128 v[64:67], v35 offset:16384
  s_waitcnt lgkmcnt(3)
  v_mfma_f32_16x16x32_bf16 v[96:99], v[52:55], v[128:131], 0
  v_mfma_f32_16x16x32_bf16 v[100:103], v[52:55], v[160:163], 0
  v_mfma_f32_16x16x32_bf16 v[104:107], v[52:55], v[192:195], 0
  v_mfma_f32_16x16x32_bf16 v[108:111], v[52:55], v[224:227], 0
  ds_read_b128 v[52:55], v32 offset:16640
  s_waitcnt lgkmcnt(3)
  v_mfma_f32_16x16x32_bf16 v[96:99], v[56:59], v[132:135], v[96:99]
  v_mfma_f32_16x16x32_bf16 v[100:103], v[56:59], v[164:167], v[100:103]
  v_mfma_f32_16x16x32_bf16 v[104:107], v[56:59], v[196:199], v[104:107]
  v_mfma_f32_16x16x32_bf16 v[108:111], v[56:59], v[228:231], v[108:111]
  ds_read_b128 v[56:59], v33 offset:16640
  s_waitcnt lgkmcnt(3)
  v_mfma_f32_16x16x32_bf16 v[96:99], v[60:63], v[136:139], v[96:99]
  v_mfma_f32_16x16x32_bf16 v[100:103], v[60:63], v[168:171], v[100:103]
  v_mfma_f32_16x16x32_bf16 v[104:107], v[60:63], v[200:203], v[104:107]
  v_mfma_f32_16x16x32_bf16 v[108:111], v[60:63], v[232:235], v[108:111]
  ds_read_b128 v[60:63], v34 offset:16640
  s_waitcnt lgkmcnt(3)
  v_mfma_f32_16x16x32_bf16 v[96:99], v[64:67], v[140:143], v[96:99]
  v_mfma_f32_16x16x32_bf16 v[100:103], v[64:67], v[172:175], v[100:103]
  v_mfma_f32_16x16x32_bf16 v[104:107], v[64:67], v[204:207], v[104:107]
  v_mfma_f32_16x16x32_bf16 v[108:111], v[64:67], v[236:239], v[108:111]
  ds_read_b128 v[64:67], v35 offset:16640
  s_waitcnt lgkmcnt(3)
  v_mfma_f32_16x16x32_bf16 v[96:99], v[52:55], v[144:147], v[96:99]
  v_mfma_f32_16x16x32_bf16 v[100:103], v[52:55], v[176:179], v[100:103]
  v_mfma_f32_16x16x32_bf16 v[104:107], v[52:55], v[208:211], v[104:107]
  v_mfma_f32_16x16x32_bf16 v[108:111], v[52:55], v[240:243], v[108:111]
  ds_read_b128 v[52:55], v32 offset:18432
  s_waitcnt lgkmcnt(3)
  v_mfma_f32_16x16x32_bf16 v[96:99], v[56:59], v[148:151], v[96:99]
  v_mfma_f32_16x16x32_bf16 v[100:103], v[56:59], v[180:183], v[100:103]
  v_mfma_f32_16x16x32_bf16 v[104:107], v[56:59], v[212:215], v[104:107]
  v_mfma_f32_16x16x32_bf16 v[108:111], v[56:59], v[244:247], v[108:111]
  ds_read_b128 v[56:59], v33 offset:18432
  s_waitcnt lgkmcnt(3)
  v_mfma_f32_16x16x32_bf16 v[96:99], v[60:63], v[152:155], v[96:99]
  v_mfma_f32_16x16x32_bf16 v[100:103], v[60:63], v[184:187], v[100:103]
  v_mfma_f32_16x16x32_bf16 v[104:107], v[60:63], v[216:219], v[104:107]
  v_mfma_f32_16x16x32_bf16 v[108:111], v[60:63], v[248:251], v[108:111]
  ds_read_b128 v[60:63], v34 offset:18432
  s_waitcnt lgkmcnt(3)
  v_mfma_f32_16x16x32_bf16 v[96:99], v[64:67], v[156:159], v[96:99]
  v_mfma_f32_16x16x32_bf16 v[100:103], v[64:67], v[188:191], v[100:103]
  v_mfma_f32_16x16x32_bf16 v[104:107], v[64:67], v[220:223], v[104:107]
  v_mfma_f32_16x16x32_bf16 v[108:111], v[64:67], v[252:255], v[108:111]
  ds_read_b128 v[64:67], v35 offset:18432
  s_waitcnt lgkmcnt(3)
  v_mfma_f32_16x16x32_bf16 v[112:115], v[52:55], v[128:131], 0
  v_mfma_f32_16x16x32_bf16 v[116:119], v[52:55], v[160:163], 0
  v_mfma_f32_16x16x32_bf16 v[120:123], v[52:55], v[192:195], 0
  v_mfma_f32_16x16x32_bf16 v[124:127], v[52:55], v[224:227], 0
  ds_read_b128 v[52:55], v32 offset:18688
  s_waitcnt lgkmcnt(3)
  v_mfma_f32_16x16x32_bf16 v[112:115], v[56:59], v[132:135], v[112:115]
  v_mfma_f32_16x16x32_bf16 v[116:119], v[56:59], v[164:167], v[116:119]
  v_mfma_f32_16x16x32_bf16 v[120:123], v[56:59], v[196:199], v[120:123]
  v_mfma_f32_16x16x32_bf16 v[124:127], v[56:59], v[228:231], v[124:127]
  ds_read_b128 v[56:59], v33 offset:18688
  s_waitcnt lgkmcnt(3)
  v_mfma_f32_16x16x32_bf16 v[112:115], v[60:63], v[136:139], v[112:115]
  v_mfma_f32_16x16x32_bf16 v[116:119], v[60:63], v[168:171], v[116:119]
  v_mfma_f32_16x16x32_bf16 v[120:123], v[60:63], v[200:203], v[120:123]
  v_mfma_f32_16x16x32_bf16 v[124:127], v[60:63], v[232:235], v[124:127]
  ds_read_b128 v[60:63], v34 offset:18688
  s_waitcnt lgkmcnt(3)
  v_mfma_f32_16x16x32_bf16 v[112:115], v[64:67], v[140:143], v[112:115]
  v_mfma_f32_16x16x32_bf16 v[116:119], v[64:67], v[172:175], v[116:119]
  v_mfma_f32_16x16x32_bf16 v[120:123], v[64:67], v[204:207], v[120:123]
  v_mfma_f32_16x16x32_bf16 v[124:127], v[64:67], v[236:239], v[124:127]
  ds_read_b128 v[64:67], v35 offset:18688
  s_waitcnt lgkmcnt(3)
  v_mfma_f32_16x16x32_bf16 v[112:115], v[52:55], v[144:147], v[112:115]
  v_mfma_f32_16x16x32_bf16 v[116:119], v[52:55], v[176:179], v[116:119]
  v_mfma_f32_16x16x32_bf16 v[120:123], v[52:55], v[208:211], v[120:123]
  v_mfma_f32_16x16x32_bf16 v[124:127], v[52:55], v[240:243], v[124:127]
  s_waitcnt lgkmcnt(2)
  v_mfma_f32_16x16x32_bf16 v[112:115], v[56:59], v[148:151], v[112:115]
  v_mfma_f32_16x16x32_bf16 v[116:119], v[56:59], v[180:183], v[116:119]
  v_mfma_f32_16x16x32_bf16 v[120:123], v[56:59], v[212:215], v[120:123]
  v_mfma_f32_16x16x32_bf16 v[124:127], v[56:59], v[244:247], v[124:127]
  s_waitcnt lgkmcnt(1)
  v_mfma_f32_16x16x32_bf16 v[112:115], v[60:63], v[152:155], v[112:115]
  v_mfma_f32_16x16x32_bf16 v[116:119], v[60:63], v[184:187], v[116:119]
  v_mfma_f32_16x16x32_bf16 v[120:123], v[60:63], v[216:219], v[120:123]
  v_mfma_f32_16x16x32_bf16 v[124:127], v[60:63], v[248:251], v[124:127]
  s_waitcnt lgkmcnt(0)
  v_mfma_f32_16x16x32_bf16 v[112:115], v[64:67], v[156:159], v[112:115]
  v_mfma_f32_16x16x32_bf16 v[116:119], v[64:67], v[188:191], v[116:119]
  v_mfma_f32_16x16x32_bf16 v[120:123], v[64:67], v[220:223], v[120:123]
  v_mfma_f32_16x16x32_bf16 v[124:127], v[64:67], v[252:255], v[124:127]
  s_lshl_b32 s30, s29, 10
  v_mul_f32 v96, s24, v96
  v_mul_f32 v97, s24, v97
  v_mul_f32 v98, s24, v98
  v_mul_f32 v99, s24, v99
  v_cvt_pk_bf16_f32 v68, v96, v97
  v_cvt_pk_bf16_f32 v69, v98, v99
  v_mul_f32 v112, s24, v112
  v_mul_f32 v113, s24, v113
  v_mul_f32 v114, s24, v114
  v_mul_f32 v115, s24, v115
  v_cvt_pk_bf16_f32 v70, v112, v113
  v_cvt_pk_bf16_f32 v71, v114, v115
  buffer_store_dwordx4 v[68:71], v12, s[8:11], s30 offen sc1
  v_mul_f32 v100, s24, v100
  v_mul_f32 v101, s24, v101
  v_mul_f32 v102, s24, v102
  v_mul_f32 v103, s24, v103
  v_cvt_pk_bf16_f32 v72, v100, v101
  v_cvt_pk_bf16_f32 v73, v102, v103
  v_mul_f32 v116, s24, v116
  v_mul_f32 v117, s24, v117
  v_mul_f32 v118, s24, v118
  v_mul_f32 v119, s24, v119
  v_cvt_pk_bf16_f32 v74, v116, v117
  v_cvt_pk_bf16_f32 v75, v118, v119
  buffer_store_dwordx4 v[72:75], v13, s[8:11], s30 offen sc1
  v_mul_f32 v104, s24, v104
  v_mul_f32 v105, s24, v105
  v_mul_f32 v106, s24, v106
  v_mul_f32 v107, s24, v107
  v_cvt_pk_bf16_f32 v76, v104, v105
  v_cvt_pk_bf16_f32 v77, v106, v107
  v_mul_f32 v120, s24, v120
  v_mul_f32 v121, s24, v121
  v_mul_f32 v122, s24, v122
  v_mul_f32 v123, s24, v123
  v_cvt_pk_bf16_f32 v78, v120, v121
  v_cvt_pk_bf16_f32 v79, v122, v123
  buffer_store_dwordx4 v[76:79], v14, s[8:11], s30 offen sc1
  v_mul_f32 v108, s24, v108
  v_mul_f32 v109, s24, v109
  v_mul_f32 v110, s24, v110
  v_mul_f32 v111, s24, v111
  v_cvt_pk_bf16_f32 v80, v108, v109
  v_cvt_pk_bf16_f32 v81, v110, v111
  v_mul_f32 v124, s24, v124
  v_mul_f32 v125, s24, v125
  v_mul_f32 v126, s24, v126
  v_mul_f32 v127, s24, v127
  v_cvt_pk_bf16_f32 v82, v124, v125
  v_cvt_pk_bf16_f32 v83, v126, v127
  buffer_store_dwordx4 v[80:83], v15, s[8:11], s30 offen sc1
aj_w3:
  s_lshl_b32 s28, s17, 7
  s_lshl_b32 s21, s19, 4
  s_add_u32 s28, s28, s21
  s_cmp_lg_u32 s31, 0
  s_cselect_b32 s21, 8, 0
  s_add_u32 s28, s28, s21
  s_add_u32 s28, s28, 88621056
  s_waitcnt vmcnt(0)
  s_barrier
  s_cmp_lg_u32 s16, 0
  s_cbranch_scc1 pub_38
  v_mul_u32_u24 v26, 2048, v1
  v_mov_b32 v24, s88
  v_mov_b32 v25, s89
  s_mov_b64 exec, 1
  buffer_store_dwordx2 v[24:25], v26, s[8:11], s28 offen sc1
  s_mov_b64 exec, -1
pub_38:
  v_mov_b32 v250, 0
  s_branch wk_loop
wk_srv:
  s_sub_u32 s3, s3, 224
  s_and_b32 s18, s3, 15
  s_lshr_b32 s19, s3, 4
  s_and_b32 s19, s19, 1
  s_mul_i32 s20, s18, 401408
  s_mul_i32 s21, s16, 100352
  s_add_u32 s20, s20, s21
  s_add_u32 s20, s20, 6422528
  s_add_u32 s22, s20, 0
  buffer_load_dwordx4 a[0:3], v2, s[8:11], s22 offen offset:0 sc1
  buffer_load_dwordx4 a[4:7], v2, s[8:11], s22 offen offset:1024 sc1
  buffer_load_dwordx4 a[8:11], v2, s[8:11], s22 offen offset:2048 sc1
  buffer_load_dwordx4 a[12:15], v2, s[8:11], s22 offen offset:3072 sc1
  s_add_u32 s22, s20, 4096
  buffer_load_dwordx4 a[16:19], v2, s[8:11], s22 offen offset:0 sc1
  buffer_load_dwordx4 a[20:23], v2, s[8:11], s22 offen offset:1024 sc1
  buffer_load_dwordx4 a[24:27], v2, s[8:11], s22 offen offset:2048 sc1
  buffer_load_dwordx4 a[28:31], v2, s[8:11], s22 offen offset:3072 sc1
  s_add_u32 s22, s20, 8192
  buffer_load_dwordx4 a[32:35], v2, s[8:11], s22 offen offset:0 sc1
  buffer_load_dwordx4 a[36:39], v2, s[8:11], s22 offen offset:1024 sc1
  buffer_load_dwordx4 a[40:43], v2, s[8:11], s22 offen offset:2048 sc1
  buffer_load_dwordx4 a[44:47], v2, s[8:11], s22 offen offset:3072 sc1
  s_add_u32 s22, s20, 12288
  buffer_load_dwordx4 a[48:51], v2, s[8:11], s22 offen offset:0 sc1
  buffer_load_dwordx4 a[52:55], v2, s[8:11], s22 offen offset:1024 sc1
  buffer_load_dwordx4 a[56:59], v2, s[8:11], s22 offen offset:2048 sc1
  buffer_load_dwordx4 a[60:63], v2, s[8:11], s22 offen offset:3072 sc1
  s_add_u32 s22, s20, 16384
  buffer_load_dwordx4 a[64:67], v2, s[8:11], s22 offen offset:0 sc1
  buffer_load_dwordx4 a[68:71], v2, s[8:11], s22 offen offset:1024 sc1
  buffer_load_dwordx4 a[72:75], v2, s[8:11], s22 offen offset:2048 sc1
  buffer_load_dwordx4 a[76:79], v2, s[8:11], s22 offen offset:3072 sc1
  s_add_u32 s22, s20, 20480
  buffer_load_dwordx4 a[80:83], v2, s[8:11], s22 offen offset:0 sc1
  buffer_load_dwordx4 a[84:87], v2, s[8:11], s22 offen offset:1024 sc1
  buffer_load_dwordx4 a[88:91], v2, s[8:11], s22 offen offset:2048 sc1
  buffer_load_dwordx4 a[92:95], v2, s[8:11], s22 offen offset:3072 sc1
  s_add_u32 s22, s20, 24576
  buffer_load_dwordx4 a[96:99], v2, s[8:11], s22 offen offset:0 sc1
  buffer_load_dwordx4 a[100:103], v2, s[8:11], s22 offen offset:1024 sc1
  buffer_load_dwordx4 a[104:107], v2, s[8:11], s22 offen offset:2048 sc1
  buffer_load_dwordx4 a[108:111], v2, s[8:11], s22 offen offset:3072 sc1
  s_add_u32 s22, s20, 28672
  buffer_load_dwordx4 a[112:115], v2, s[8:11], s22 offen offset:0 sc1
  buffer_load_dwordx4 a[116:119], v2, s[8:11], s22 offen offset:1024 sc1
  buffer_load_dwordx4 a[120:123], v2, s[8:11], s22 offen offset:2048 sc1
  buffer_load_dwordx4 a[124:127], v2, s[8:11], s22 offen offset:3072 sc1
  s_waitcnt vmcnt(24)
  s_add_u32 s22, s20, 32768
  buffer_load_dwordx4 a[128:131], v2, s[8:11], s22 offen offset:0 sc1
  buffer_load_dwordx4 a[132:135], v2, s[8:11], s22 offen offset:1024 sc1
  buffer_load_dwordx4 a[136:139], v2, s[8:11], s22 offen offset:2048 sc1
  buffer_load_dwordx4 a[140:143], v2, s[8:11], s22 offen offset:3072 sc1
  s_add_u32 s22, s20, 36864
  buffer_load_dwordx4 a[144:147], v2, s[8:11], s22 offen offset:0 sc1
  buffer_load_dwordx4 a[148:151], v2, s[8:11], s22 offen offset:1024 sc1
  buffer_load_dwordx4 a[152:155], v2, s[8:11], s22 offen offset:2048 sc1
  buffer_load_dwordx4 a[156:159], v2, s[8:11], s22 offen offset:3072 sc1
  s_add_u32 s22, s20, 40960
  buffer_load_dwordx4 a[160:163], v2, s[8:11], s22 offen offset:0 sc1
  buffer_load_dwordx4 a[164:167], v2, s[8:11], s22 offen offset:1024 sc1
  buffer_load_dwordx4 a[168:171], v2, s[8:11], s22 offen offset:2048 sc1
  buffer_load_dwordx4 a[172:175], v2, s[8:11], s22 offen offset:3072 sc1
  s_add_u32 s22, s20, 45056
  buffer_load_dwordx4 a[176:179], v2, s[8:11], s22 offen offset:0 sc1
  buffer_load_dwordx4 a[180:183], v2, s[8:11], s22 offen offset:1024 sc1
  buffer_load_dwordx4 a[184:187], v2, s[8:11], s22 offen offset:2048 sc1
  buffer_load_dwordx4 a[188:191], v2, s[8:11], s22 offen offset:3072 sc1
  s_add_u32 s22, s20, 49152
  buffer_load_dwordx4 a[192:195], v2, s[8:11], s22 offen offset:0 sc1
  buffer_load_dwordx4 a[196:199], v2, s[8:11], s22 offen offset:1024 sc1
  buffer_load_dwordx4 a[200:203], v2, s[8:11], s22 offen offset:2048 sc1
  buffer_load_dwordx4 a[204:207], v2, s[8:11], s22 offen offset:3072 sc1
  s_add_u32 s22, s20, 53248
  buffer_load_dwordx4 a[208:211], v2, s[8:11], s22 offen offset:0 sc1
  buffer_load_dwordx4 a[212:215], v2, s[8:11], s22 offen offset:1024 sc1
  buffer_load_dwordx4 a[216:219], v2, s[8:11], s22 offen offset:2048 sc1
  buffer_load_dwordx4 a[220:223], v2, s[8:11], s22 offen offset:3072 sc1
  s_add_u32 s22, s20, 57344
  buffer_load_dwordx4 a[224:227], v2, s[8:11], s22 offen offset:0 sc1
  buffer_load_dwordx4 a[228:231], v2, s[8:11], s22 offen offset:1024 sc1
  buffer_load_dwordx4 a[232:235], v2, s[8:11], s22 offen offset:2048 sc1
  buffer_load_dwordx4 a[236:239], v2, s[8:11], s22 offen offset:3072 sc1
  s_add_u32 s22, s20, 61440
  buffer_load_dwordx4 a[240:243], v2, s[8:11], s22 offen offset:0 sc1
  buffer_load_dwordx4 a[244:247], v2, s[8:11], s22 offen offset:1024 sc1
  buffer_load_dwordx4 a[248:251], v2, s[8:11], s22 offen offset:2048 sc1
  buffer_load_dwordx4 a[252:255], v2, s[8:11], s22 offen offset:3072 sc1
  s_waitcnt vmcnt(24)
  s_add_u32 s22, s20, 65536
  buffer_load_dwordx4 v[120:123], v2, s[8:11], s22 offen offset:0 sc1
  buffer_load_dwordx4 v[124:127], v2, s[8:11], s22 offen offset:1024 sc1
  buffer_load_dwordx4 v[128:131], v2, s[8:11], s22 offen offset:2048 sc1
  buffer_load_dwordx4 v[132:135], v2, s[8:11], s22 offen offset:3072 sc1
  s_add_u32 s22, s20, 69632
  buffer_load_dwordx4 v[136:139], v2, s[8:11], s22 offen offset:0 sc1
  buffer_load_dwordx4 v[140:143], v2, s[8:11], s22 offen offset:1024 sc1
  buffer_load_dwordx4 v[144:147], v2, s[8:11], s22 offen offset:2048 sc1
  buffer_load_dwordx4 v[148:151], v2, s[8:11], s22 offen offset:3072 sc1
  s_add_u32 s22, s20, 73728
  buffer_load_dwordx4 v[152:155], v2, s[8:11], s22 offen offset:0 sc1
  buffer_load_dwordx4 v[156:159], v2, s[8:11], s22 offen offset:1024 sc1
  buffer_load_dwordx4 v[160:163], v2, s[8:11], s22 offen offset:2048 sc1
  buffer_load_dwordx4 v[164:167], v2, s[8:11], s22 offen offset:3072 sc1
  s_add_u32 s22, s20, 77824
  buffer_load_dwordx4 v[168:171], v2, s[8:11], s22 offen offset:0 sc1
  buffer_load_dwordx4 v[172:175], v2, s[8:11], s22 offen offset:1024 sc1
  buffer_load_dwordx4 v[176:179], v2, s[8:11], s22 offen offset:2048 sc1
  buffer_load_dwordx4 v[180:183], v2, s[8:11], s22 offen offset:3072 sc1
  s_add_u32 s22, s20, 81920
  buffer_load_dwordx4 v[184:187], v2, s[8:11], s22 offen offset:0 sc1
  buffer_load_dwordx4 v[188:191], v2, s[8:11], s22 offen offset:1024 sc1
  buffer_load_dwordx4 v[192:195], v2, s[8:11], s22 offen offset:2048 sc1
  buffer_load_dwordx4 v[196:199], v2, s[8:11], s22 offen offset:3072 sc1
  s_add_u32 s22, s20, 86016
  buffer_load_dwordx4 v[200:203], v2, s[8:11], s22 offen offset:0 sc1
  buffer_load_dwordx4 v[204:207], v2, s[8:11], s22 offen offset:1024 sc1
  buffer_load_dwordx4 v[208:211], v2, s[8:11], s22 offen offset:2048 sc1
  buffer_load_dwordx4 v[212:215], v2, s[8:11], s22 offen offset:3072 sc1
  s_add_u32 s22, s20, 90112
  buffer_load_dwordx4 v[216:219], v2, s[8:11], s22 offen offset:0 sc1
  buffer_load_dwordx4 v[220:223], v2, s[8:11], s22 offen offset:1024 sc1
  buffer_load_dwordx4 v[224:227], v2, s[8:11], s22 offen offset:2048 sc1
  buffer_load_dwordx4 v[228:231], v2, s[8:11], s22 offen offset:3072 sc1
  s_add_u32 s22, s20, 94208
  buffer_load_dwordx4 v[232:235], v2, s[8:11], s22 offen offset:0 sc1
  buffer_load_dwordx4 v[236:239], v2, s[8:11], s22 offen offset:1024 sc1
  buffer_load_dwordx4 v[240:243], v2, s[8:11], s22 offen offset:2048 sc1
  buffer_load_dwordx4 v[244:247], v2, s[8:11], s22 offen offset:3072 sc1
  s_waitcnt vmcnt(24)
  s_add_u32 s22, s20, 98304
  buffer_load_dwordx4 v[248:251], v2, s[8:11], s22 offen offset:0 sc1
  buffer_load_dwordx4 v[252:255], v2, s[8:11], s22 offen offset:1024 sc1
  v_mov_b32 v5, 0x4444
  v_mov_b32 v6, 0xeeee
  v_cmp_lt_u32 vcc, 7, v4
  s_nop 1
  v_cndmask_b32 v5, v5, v6, vcc
  s_lshl_b32 s23, s16, 11
  v_lshrrev_b32 v80, 1, v3
  v_and_b32 v81, 1, v3
  v_add_u32 v82, 0, v80
  v_lshl_add_u32 v82, v82, 4, v4
  v_mul_u32_u24 v83, 2341, v82
  v_lshrrev_b32 v83, 16, v83
  v_mul_u32_u24 v84, 28, v83
  v_sub_u32 v84, v82, v84
  v_lshrrev_b32 v85, 4, v84
  v_and_b32 v84, 15, v84
  v_lshlrev_b32 v86, 10, v85
  v_lshl_add_u32 v86, v83, 8, v86
  v_lshl_add_u32 v86, v84, 4, v86
  v_lshl_add_u32 v86, v81, 3, v86
  v_add_u32 v72, s23, v86
  v_add_u32 v82, 2, v80
  v_lshl_add_u32 v82, v82, 4, v4
  v_mul_u32_u24 v83, 2341, v82
  v_lshrrev_b32 v83, 16, v83
  v_mul_u32_u24 v84, 28, v83
  v_sub_u32 v84, v82, v84
  v_lshrrev_b32 v85, 4, v84
  v_and_b32 v84, 15, v84
  v_lshlrev_b32 v86, 10, v85
  v_lshl_add_u32 v86, v83, 8, v86
  v_lshl_add_u32 v86, v84, 4, v86
  v_lshl_add_u32 v86, v81, 3, v86
  v_add_u32 v73, s23, v86
  v_add_u32 v82, 4, v80
  v_lshl_add_u32 v82, v82, 4, v4
  v_mul_u32_u24 v83, 2341, v82
  v_lshrrev_b32 v83, 16, v83
  v_mul_u32_u24 v84, 28, v83
  v_sub_u32 v84, v82, v84
  v_lshrrev_b32 v85, 4, v84
  v_and_b32 v84, 15, v84
  v_lshlrev_b32 v86, 10, v85
  v_lshl_add_u32 v86, v83, 8, v86
  v_lshl_add_u32 v86, v84, 4, v86
  v_lshl_add_u32 v86, v81, 3, v86
  v_add_u32 v74, s23, v86
  v_mov_b32 v82, 6
  v_lshl_add_u32 v82, v82, 4, v4
  v_mul_u32_u24 v83, 2341, v82
  v_lshrrev_b32 v83, 16, v83
  v_mul_u32_u24 v84, 28, v83
  v_sub_u32 v84, v82, v84
  v_lshrrev_b32 v85, 4, v84
  v_and_b32 v84, 15, v84
  v_lshlrev_b32 v86, 10, v85
  v_lshl_add_u32 v86, v83, 8, v86
  v_lshl_add_u32 v86, v84, 4, v86
  v_lshl_add_u32 v86, v81, 3, v86
  v_add_u32 v75, s23, v86
  v_add_u32 v76, s23, v2
  s_mul_i32 s27, s18, 448
  v_mov_b32 v77, s27
  v_mov_b32 v78, 1
  s_mov_b32 s17, s19
  s_mul_i32 s24, s19, 7168
  s_add_u32 s24, s24, 88068096
  s_mul_i32 s25, s18, 65
  s_add_u32 s25, s25, s19
  s_lshl_b32 s25, s25, 13
  s_add_u32 s25, s25, s23
  s_add_u32 s25, s25, 76935168
  s_lshl_b32 s26, s18, 6
  s_add_u32 s26, s26, s19
  s_lshl_b32 s26, s26, 4
  s_lshl_b32 s27, s16, 2
  s_add_u32 s26, s26, s27
  s_add_u32 s26, s26, 88569856
  v_mov_b32 v87, -1
ws_loop:
  v_mov_b32 v36, 0
  v_mov_b32 v37, 0
  v_mov_b32 v38, 0
  v_mov_b32 v39, 0
  v_mov_b32 v40, 0
  v_mov_b32 v41, 0
  v_mov_b32 v42, 0
  v_mov_b32 v43, 0
  v_mov_b32 v44, 0
  v_mov_b32 v45, 0
  v_mov_b32 v46, 0
  v_mov_b32 v47, 0
  v_mov_b32 v48, 0
  v_mov_b32 v49, 0
  v_mov_b32 v50, 0
  v_mov_b32 v51, 0
  v_mov_b32 v52, 0
  v_mov_b32 v53, 0
  v_mov_b32 v54, 0
  v_mov_b32 v55, 0
  v_mov_b32 v56, 0
  v_mov_b32 v57, 0
  v_mov_b32 v58, 0
  v_mov_b32 v59, 0
  v_mov_b32 v60, 0
  v_mov_b32 v61, 0
  v_mov_b32 v62, 0
  v_mov_b32 v63, 0
  s_mov_b32 s30, 0
  v_cmp_eq_u32 vcc, -1, v87
  s_cbranch_vccz ws_fl
ws_pm:
  s_cmp_ge_u32 s17, 61
  s_cbranch_scc1 mp_39a
  v_mov_b32 v79, 0
  s_mov_b64 exec, 1
  buffer_atomic_or v79, v77, s[8:11], s24 offen sc0
  s_mov_b64 exec, -1
  s_branch mp_39b
mp_39a:
  buffer_load_dword v79, v77, s[8:11], s24 offen sc1
mp_39b:
  s_waitcnt vmcnt(0)
  v_cmp_eq_u32 vcc, -1, v79
  s_cbranch_vccnz ws_pr
ws_fl:
  s_add_u32 s22, s24, 4096
  buffer_load_dwordx4 v[8:11], v2, s[8:11], s24 offen offset:0 sc1
  buffer_load_dwordx4 v[12:15], v2, s[8:11], s24 offen offset:1024 sc1
  buffer_load_dwordx4 v[16:19], v2, s[8:11], s24 offen offset:2048 sc1
  buffer_load_dwordx4 v[20:23], v2, s[8:11], s24 offen offset:3072 sc1
  buffer_load_dwordx4 v[24:27], v2, s[8:11], s22 offen offset:0 sc1
  buffer_load_dwordx4 v[28:31], v2, s[8:11], s22 offen offset:1024 sc1
  buffer_load_dwordx4 v[32:35], v2, s[8:11], s22 offen offset:2048 sc1
  s_waitcnt vmcnt(0)
  v_max_u32 v79, v8, v9
  v_max3_u32 v79, v79, v10, v11
  v_max3_u32 v79, v79, v12, v13
  v_max3_u32 v79, v79, v14, v15
  v_max3_u32 v79, v79, v16, v17
  v_max3_u32 v79, v79, v18, v19
  v_max3_u32 v79, v79, v20, v21
  v_max3_u32 v79, v79, v22, v23
  v_max3_u32 v79, v79, v24, v25
  v_max3_u32 v79, v79, v26, v27
  v_max3_u32 v79, v79, v28, v29
  v_max3_u32 v79, v79, v30, v31
  v_max3_u32 v79, v79, v32, v33
  v_max3_u32 v79, v79, v34, v35
  v_cmp_eq_u32 vcc, -1, v79
  s_cbranch_vccz ws_pk
ws_pr:
  s_sleep 1
  s_cmp_ge_u32 s17, 61
  s_cbranch_scc1 ws_sh
  s_sleep 6
ws_sh:
  s_add_u32 s30, s30, 1
  s_cmp_lt_u32 s30, 30000
  s_cbranch_scc1 ws_pm
  s_branch cA_abort
ws_pk:
  s_cmp_ge_u32 s17, 62
  s_cbranch_scc1 ws_na
  s_add_u32 s22, s24, 14336
  s_cmp_ge_u32 s17, 61
  s_cbranch_scc1 mp_40a
  v_mov_b32 v87, 0
  s_mov_b64 exec, 1
  buffer_atomic_or v87, v77, s[8:11], s22 offen sc0
  s_mov_b64 exec, -1
  s_branch mp_40b
mp_40a:
  buffer_load_dword v87, v77, s[8:11], s22 offen sc1
mp_40b:
ws_na:
  v_smfmac_f32_16x16x64_bf16 v[36:39], v[8:11], a[0:7], v5
  v_smfmac_f32_16x16x64_bf16 v[36:39], v[12:15], a[8:15], v5
  v_smfmac_f32_16x16x64_bf16 v[36:39], v[16:19], a[16:23], v5
  v_smfmac_f32_16x16x64_bf16 v[36:39], v[20:23], a[24:31], v5
  v_smfmac_f32_16x16x64_bf16 v[36:39], v[24:27], a[32:39], v5
  v_smfmac_f32_16x16x64_bf16 v[36:39], v[28:31], a[40:47], v5
  v_smfmac_f32_16x16x64_bf16 v[36:39], v[32:35], a[48:55], v5
  v_smfmac_f32_16x16x64_bf16 v[40:43], v[8:11], a[56:63], v5
  v_smfmac_f32_16x16x64_bf16 v[40:43], v[12:15], a[64:71], v5
  v_smfmac_f32_16x16x64_bf16 v[40:43], v[16:19], a[72:79], v5
  v_smfmac_f32_16x16x64_bf16 v[40:43], v[20:23], a[80:87], v5
  v_smfmac_f32_16x16x64_bf16 v[40:43], v[24:27], a[88:95], v5
  v_smfmac_f32_16x16x64_bf16 v[40:43], v[28:31], a[96:103], v5
  v_smfmac_f32_16x16x64_bf16 v[40:43], v[32:35], a[104:111], v5
  v_smfmac_f32_16x16x64_bf16 v[44:47], v[8:11], a[112:119], v5
  v_smfmac_f32_16x16x64_bf16 v[44:47], v[12:15], a[120:127], v5
  v_smfmac_f32_16x16x64_bf16 v[44:47], v[16:19], a[128:135], v5
  v_smfmac_f32_16x16x64_bf16 v[44:47], v[20:23], a[136:143], v5
  v_smfmac_f32_16x16x64_bf16 v[44:47], v[24:27], a[144:151], v5
  v_smfmac_f32_16x16x64_bf16 v[44:47], v[28:31], a[152:159], v5
  v_smfmac_f32_16x16x64_bf16 v[44:47], v[32:35], a[160:167], v5
  v_smfmac_f32_16x16x64_bf16 v[48:51], v[8:11], a[168:175], v5
  v_smfmac_f32_16x16x64_bf16 v[48:51], v[12:15], a[176:183], v5
  v_smfmac_f32_16x16x64_bf16 v[48:51], v[16:19], a[184:191], v5
  v_smfmac_f32_16x16x64_bf16 v[48:51], v[20:23], a[192:199], v5
  v_smfmac_f32_16x16x64_bf16 v[48:51], v[24:27], a[200:207], v5
  v_smfmac_f32_16x16x64_bf16 v[48:51], v[28:31], a[208:215], v5
  v_smfmac_f32_16x16x64_bf16 v[48:51], v[32:35], a[216:223], v5
  v_smfmac_f32_16x16x64_bf16 v[52:55], v[8:11], a[224:231], v5
  v_smfmac_f32_16x16x64_bf16 v[52:55], v[12:15], a[232:239], v5
  v_smfmac_f32_16x16x64_bf16 v[52:55], v[16:19], a[240:247], v5
  v_smfmac_f32_16x16x64_bf16 v[52:55], v[20:23], a[248:255], v5
  v_smfmac_f32_16x16x64_bf16 v[52:55], v[24:27], v[120:127], v5
  v_smfmac_f32_16x16x64_bf16 v[52:55], v[28:31], v[128:135], v5
  v_smfmac_f32_16x16x64_bf16 v[52:55], v[32:35], v[136:143], v5
  v_smfmac_f32_16x16x64_bf16 v[56:59], v[8:11], v[144:151], v5
  v_smfmac_f32_16x16x64_bf16 v[56:59], v[12:15], v[152:159], v5
  v_smfmac_f32_16x16x64_bf16 v[56:59], v[16:19], v[160:167], v5
  v_smfmac_f32_16x16x64_bf16 v[56:59], v[20:23], v[168:175], v5
  v_smfmac_f32_16x16x64_bf16 v[56:59], v[24:27], v[176:183], v5
  v_smfmac_f32_16x16x64_bf16 v[56:59], v[28:31], v[184:191], v5
  v_smfmac_f32_16x16x64_bf16 v[56:59], v[32:35], v[192:199], v5
  v_smfmac_f32_16x16x64_bf16 v[60:63], v[8:11], v[200:207], v5
  v_smfmac_f32_16x16x64_bf16 v[60:63], v[12:15], v[208:215], v5
  v_smfmac_f32_16x16x64_bf16 v[60:63], v[16:19], v[216:223], v5
  v_smfmac_f32_16x16x64_bf16 v[60:63], v[20:23], v[224:231], v5
  v_smfmac_f32_16x16x64_bf16 v[60:63], v[24:27], v[232:239], v5
  v_smfmac_f32_16x16x64_bf16 v[60:63], v[28:31], v[240:247], v5
  v_smfmac_f32_16x16x64_bf16 v[60:63], v[32:35], v[248:255], v5
  v_permlane32_swap_b32 v36, v40
  v_permlane32_swap_b32 v37, v41
  v_permlane32_swap_b32 v38, v42
  v_permlane32_swap_b32 v39, v43
  v_add_f32 v36, v36, v40
  v_add_f32 v37, v37, v41
  v_add_f32 v38, v38, v42
  v_add_f32 v39, v39, v43
  v_cvt_pk_bf16_f32 v40, v36, v37
  v_cvt_pk_bf16_f32 v41, v38, v39
  ds_write_b64 v72, v[40:41]
  v_permlane32_swap_b32 v44, v48
  v_permlane32_swap_b32 v45, v49
  v_permlane32_swap_b32 v46, v50
  v_permlane32_swap_b32 v47, v51
  v_add_f32 v44, v44, v48
  v_add_f32 v45, v45, v49
  v_add_f32 v46, v46, v50
  v_add_f32 v47, v47, v51
  v_cvt_pk_bf16_f32 v48, v44, v45
  v_cvt_pk_bf16_f32 v49, v46, v47
  ds_write_b64 v73, v[48:49]
  v_permlane32_swap_b32 v52, v56
  v_permlane32_swap_b32 v53, v57
  v_permlane32_swap_b32 v54, v58
  v_permlane32_swap_b32 v55, v59
  v_add_f32 v52, v52, v56
  v_add_f32 v53, v53, v57
  v_add_f32 v54, v54, v58
  v_add_f32 v55, v55, v59
  v_cvt_pk_bf16_f32 v56, v52, v53
  v_cvt_pk_bf16_f32 v57, v54, v55
  ds_write_b64 v74, v[56:57]
  v_mov_b32 v64, v60
  v_mov_b32 v65, v61
  v_mov_b32 v66, v62
  v_mov_b32 v67, v63
  v_permlane32_swap_b32 v60, v64
  v_permlane32_swap_b32 v61, v65
  v_permlane32_swap_b32 v62, v66
  v_permlane32_swap_b32 v63, v67
  v_add_f32 v60, v60, v64
  v_add_f32 v61, v61, v65
  v_add_f32 v62, v62, v66
  v_add_f32 v63, v63, v67
  v_cvt_pk_bf16_f32 v64, v60, v61
  v_cvt_pk_bf16_f32 v65, v62, v63
  ds_write_b64 v75, v[64:65]
  s_waitcnt lgkmcnt(0)
  ds_read_b128 v[64:67], v76
  ds_read_b128 v[68:71], v76 offset:1024
  s_waitcnt lgkmcnt(0)
  buffer_store_dwordx4 v[64:67], v2, s[8:11], s25 offen sc1
  buffer_store_dwordx4 v[68:71], v2, s[8:11], s25 offen offset:1024 sc1
  s_waitcnt vmcnt(0)
  s_mov_b64 exec, 1
  buffer_store_dword v78, v2, s[8:11], s26 offen sc1
  s_mov_b64 exec, -1
  s_add_u32 s24, s24, 14336
  s_add_u32 s25, s25, 16384
  s_add_u32 s26, s26, 32
  s_add_u32 s17, s17, 2
  s_cmp_lt_u32 s17, 64
  s_cbranch_scc1 ws_loop
  v_mov_b32 v250, 0
  s_branch wk_loop
wk_s4d:
  s_cmp_lg_u32 s16, 0
  s_cbranch_scc1 w0_41
  s_getreg_b32 s20, hwreg(HW_REG_XCC_ID)
  s_sub_u32 s20, s20, 1
  s_and_b32 s20, s20, 7
  s_mov_b64 exec, 1
s4_l:
  s_cmp_ge_u32 s20, 7
  s_cselect_b32 s20, 0, s20
  s_lshl_b32 s21, s20, 7
  s_add_u32 s21, s21, 88586240
  v_mov_b32 v242, 1
  buffer_atomic_add v242, off, s[8:11], s21 sc0
  s_waitcnt vmcnt(0)
  v_readfirstlane_b32 s21, v242
  s_lshl_b32 s22, s20, 4
  s_add_u32 s20, s20, 1
  s_cmp_ge_u32 s21, 16
  s_cbranch_scc1 s4_l
  v_add_u32 v242, s22, v242
  s_mov_b64 exec, -1
w0_41:
  v_mov_b32 v243, 160000
  s_add_u32 s101, s101, 1
  s_barrier
  s_mov_b64 exec, 1
  s_cmp_lg_u32 s16, 0
  s_cbranch_scc1 w0_42
  ds_write_b32 v243, v242 offset:0
  s_waitcnt lgkmcnt(0)
  v_mov_b32 v242, s101
  ds_write_b32 v243, v242 offset:16
  s_waitcnt lgkmcnt(0)
w0_42:
  s_mov_b64 exec, -1
  s_barrier
  ds_read_b32 v242, v243 offset:0
  ds_read_b32 v243, v243 offset:16
  s_waitcnt lgkmcnt(0)
  v_readfirstlane_b32 s3, v242
  v_cmp_ne_u32 vcc, s101, v243
  s_cbranch_vccnz ch_end
  s_load_dwordx8 s[40:47], s[0:1], 0
  s_load_dwordx4 s[48:51], s[0:1], 32
  s_load_dwordx2 s[52:53], s[0:1], 48
  s_load_dwordx2 s[54:55], s[0:1], 112
  v_lshrrev_b32 v1, 6, v0
  s_nop 0
  v_readfirstlane_b32 s16, v1
  v_and_b32 v1, 63, v0
  v_lshrrev_b32 v3, 4, v1
  v_and_b32 v4, 15, v1
  s_mul_i32 s17, s16, 24576
  s_waitcnt lgkmcnt(0)
  s_mov_b32 s60, s40
  s_and_b32 s61, s41, 0xffff
  s_mov_b32 s62, 1835008
  s_mov_b32 s63, 0x20000
  s_mov_b32 s64, s42
  s_and_b32 s65, s43, 0xffff
  s_mov_b32 s66, 229376
  s_mov_b32 s67, 0x20000
  s_mov_b32 s68, s44
  s_and_b32 s69, s45, 0xffff
  s_mov_b32 s70, 229376
  s_mov_b32 s71, 0x20000
  s_mov_b32 s72, s46
  s_and_b32 s73, s47, 0xffff
  s_mov_b32 s74, 229376
  s_mov_b32 s75, 0x20000
  s_mov_b32 s76, s48
  s_and_b32 s77, s49, 0xffff
  s_mov_b32 s78, 229376
  s_mov_b32 s79, 0x20000
  s_mov_b32 s80, s50
  s_and_b32 s81, s51, 0xffff
  s_mov_b32 s82, 896
  s_mov_b32 s83, 0x20000
  s_mov_b32 s84, s52
  s_and_b32 s85, s53, 0xffff
  s_mov_b32 s86, 896
  s_mov_b32 s87, 0x20000
  s_mov_b32 s92, s54
  s_and_b32 s93, s55, 0xffff
  s_mov_b32 s94, 3670016
  s_mov_b32 s95, 0x20000
  v_lshlrev_b32 v5, 5, v1
  v_sub_u32 v5, 2047, v5
  s_add_u32 s18, s17, 13056
  v_subrev_u32 v6, 0, v5
  v_max_i32 v7, 0, v6
  v_cvt_f32_u32 v7, v7
  v_cvt_pk_bf16_f32 v8, v7, v7
  v_and_b32 v7, 0xffff0000, v8
  v_lshrrev_b32 v8, 23, v7
  v_subrev_u32 v8, 134, v8
  v_max_i32 v8, 0, v8
  v_cvt_u32_f32 v7, v7
  v_lshrrev_b32 v7, v8, v7
  v_lshl_add_u32 v7, v8, 8, v7
  v_lshl_add_u32 v200, v7, 2, s18
  v_subrev_u32 v6, 1, v5
  v_max_i32 v7, 0, v6
  v_cvt_f32_u32 v7, v7
  v_cvt_pk_bf16_f32 v8, v7, v7
  v_and_b32 v7, 0xffff0000, v8
  v_lshrrev_b32 v8, 23, v7
  v_subrev_u32 v8, 134, v8
  v_max_i32 v8, 0, v8
  v_cvt_u32_f32 v7, v7
  v_lshrrev_b32 v7, v8, v7
  v_lshl_add_u32 v7, v8, 8, v7
  v_lshl_add_u32 v201, v7, 2, s18
  v_subrev_u32 v6, 2, v5
  v_max_i32 v7, 0, v6
  v_cvt_f32_u32 v7, v7
  v_cvt_pk_bf16_f32 v8, v7, v7
  v_and_b32 v7, 0xffff0000, v8
  v_lshrrev_b32 v8, 23, v7
  v_subrev_u32 v8, 134, v8
  v_max_i32 v8, 0, v8
  v_cvt_u32_f32 v7, v7
  v_lshrrev_b32 v7, v8, v7
  v_lshl_add_u32 v7, v8, 8, v7
  v_lshl_add_u32 v202, v7, 2, s18
  v_subrev_u32 v6, 3, v5
  v_max_i32 v7, 0, v6
  v_cvt_f32_u32 v7, v7
  v_cvt_pk_bf16_f32 v8, v7, v7
  v_and_b32 v7, 0xffff0000, v8
  v_lshrrev_b32 v8, 23, v7
  v_subrev_u32 v8, 134, v8
  v_max_i32 v8, 0, v8
  v_cvt_u32_f32 v7, v7
  v_lshrrev_b32 v7, v8, v7
  v_lshl_add_u32 v7, v8, 8, v7
  v_lshl_add_u32 v203, v7, 2, s18
  v_subrev_u32 v6, 4, v5
  v_max_i32 v7, 0, v6
  v_cvt_f32_u32 v7, v7
  v_cvt_pk_bf16_f32 v8, v7, v7
  v_and_b32 v7, 0xffff0000, v8
  v_lshrrev_b32 v8, 23, v7
  v_subrev_u32 v8, 134, v8
  v_max_i32 v8, 0, v8
  v_cvt_u32_f32 v7, v7
  v_lshrrev_b32 v7, v8, v7
  v_lshl_add_u32 v7, v8, 8, v7
  v_lshl_add_u32 v204, v7, 2, s18
  v_subrev_u32 v6, 5, v5
  v_max_i32 v7, 0, v6
  v_cvt_f32_u32 v7, v7
  v_cvt_pk_bf16_f32 v8, v7, v7
  v_and_b32 v7, 0xffff0000, v8
  v_lshrrev_b32 v8, 23, v7
  v_subrev_u32 v8, 134, v8
  v_max_i32 v8, 0, v8
  v_cvt_u32_f32 v7, v7
  v_lshrrev_b32 v7, v8, v7
  v_lshl_add_u32 v7, v8, 8, v7
  v_lshl_add_u32 v205, v7, 2, s18
  v_subrev_u32 v6, 6, v5
  v_max_i32 v7, 0, v6
  v_cvt_f32_u32 v7, v7
  v_cvt_pk_bf16_f32 v8, v7, v7
  v_and_b32 v7, 0xffff0000, v8
  v_lshrrev_b32 v8, 23, v7
  v_subrev_u32 v8, 134, v8
  v_max_i32 v8, 0, v8
  v_cvt_u32_f32 v7, v7
  v_lshrrev_b32 v7, v8, v7
  v_lshl_add_u32 v7, v8, 8, v7
  v_lshl_add_u32 v206, v7, 2, s18
  v_subrev_u32 v6, 7, v5
  v_max_i32 v7, 0, v6
  v_cvt_f32_u32 v7, v7
  v_cvt_pk_bf16_f32 v8, v7, v7
  v_and_b32 v7, 0xffff0000, v8
  v_lshrrev_b32 v8, 23, v7
  v_subrev_u32 v8, 134, v8
  v_max_i32 v8, 0, v8
  v_cvt_u32_f32 v7, v7
  v_lshrrev_b32 v7, v8, v7
  v_lshl_add_u32 v7, v8, 8, v7
  v_lshl_add_u32 v207, v7, 2, s18
  v_subrev_u32 v6, 8, v5
  v_max_i32 v7, 0, v6
  v_cvt_f32_u32 v7, v7
  v_cvt_pk_bf16_f32 v8, v7, v7
  v_and_b32 v7, 0xffff0000, v8
  v_lshrrev_b32 v8, 23, v7
  v_subrev_u32 v8, 134, v8
  v_max_i32 v8, 0, v8
  v_cvt_u32_f32 v7, v7
  v_lshrrev_b32 v7, v8, v7
  v_lshl_add_u32 v7, v8, 8, v7
  v_lshl_add_u32 v208, v7, 2, s18
  v_subrev_u32 v6, 9, v5
  v_max_i32 v7, 0, v6
  v_cvt_f32_u32 v7, v7
  v_cvt_pk_bf16_f32 v8, v7, v7
  v_and_b32 v7, 0xffff0000, v8
  v_lshrrev_b32 v8, 23, v7
  v_subrev_u32 v8, 134, v8
  v_max_i32 v8, 0, v8
  v_cvt_u32_f32 v7, v7
  v_lshrrev_b32 v7, v8, v7
  v_lshl_add_u32 v7, v8, 8, v7
  v_lshl_add_u32 v209, v7, 2, s18
  v_subrev_u32 v6, 10, v5
  v_max_i32 v7, 0, v6
  v_cvt_f32_u32 v7, v7
  v_cvt_pk_bf16_f32 v8, v7, v7
  v_and_b32 v7, 0xffff0000, v8
  v_lshrrev_b32 v8, 23, v7
  v_subrev_u32 v8, 134, v8
  v_max_i32 v8, 0, v8
  v_cvt_u32_f32 v7, v7
  v_lshrrev_b32 v7, v8, v7
  v_lshl_add_u32 v7, v8, 8, v7
  v_lshl_add_u32 v210, v7, 2, s18
  v_subrev_u32 v6, 11, v5
  v_max_i32 v7, 0, v6
  v_cvt_f32_u32 v7, v7
  v_cvt_pk_bf16_f32 v8, v7, v7
  v_and_b32 v7, 0xffff0000, v8
  v_lshrrev_b32 v8, 23, v7
  v_subrev_u32 v8, 134, v8
  v_max_i32 v8, 0, v8
  v_cvt_u32_f32 v7, v7
  v_lshrrev_b32 v7, v8, v7
  v_lshl_add_u32 v7, v8, 8, v7
  v_lshl_add_u32 v211, v7, 2, s18
  v_subrev_u32 v6, 12, v5
  v_max_i32 v7, 0, v6
  v_cvt_f32_u32 v7, v7
  v_cvt_pk_bf16_f32 v8, v7, v7
  v_and_b32 v7, 0xffff0000, v8
  v_lshrrev_b32 v8, 23, v7
  v_subrev_u32 v8, 134, v8
  v_max_i32 v8, 0, v8
  v_cvt_u32_f32 v7, v7
  v_lshrrev_b32 v7, v8, v7
  v_lshl_add_u32 v7, v8, 8, v7
  v_lshl_add_u32 v212, v7, 2, s18
  v_subrev_u32 v6, 13, v5
  v_max_i32 v7, 0, v6
  v_cvt_f32_u32 v7, v7
  v_cvt_pk_bf16_f32 v8, v7, v7
  v_and_b32 v7, 0xffff0000, v8
  v_lshrrev_b32 v8, 23, v7
  v_subrev_u32 v8, 134, v8
  v_max_i32 v8, 0, v8
  v_cvt_u32_f32 v7, v7
  v_lshrrev_b32 v7, v8, v7
  v_lshl_add_u32 v7, v8, 8, v7
  v_lshl_add_u32 v213, v7, 2, s18
  v_subrev_u32 v6, 14, v5
  v_max_i32 v7, 0, v6
  v_cvt_f32_u32 v7, v7
  v_cvt_pk_bf16_f32 v8, v7, v7
  v_and_b32 v7, 0xffff0000, v8
  v_lshrrev_b32 v8, 23, v7
  v_subrev_u32 v8, 134, v8
  v_max_i32 v8, 0, v8
  v_cvt_u32_f32 v7, v7
  v_lshrrev_b32 v7, v8, v7
  v_lshl_add_u32 v7, v8, 8, v7
  v_lshl_add_u32 v214, v7, 2, s18
  v_subrev_u32 v6, 15, v5
  v_max_i32 v7, 0, v6
  v_cvt_f32_u32 v7, v7
  v_cvt_pk_bf16_f32 v8, v7, v7
  v_and_b32 v7, 0xffff0000, v8
  v_lshrrev_b32 v8, 23, v7
  v_subrev_u32 v8, 134, v8
  v_max_i32 v8, 0, v8
  v_cvt_u32_f32 v7, v7
  v_lshrrev_b32 v7, v8, v7
  v_lshl_add_u32 v7, v8, 8, v7
  v_lshl_add_u32 v215, v7, 2, s18
  v_subrev_u32 v6, 16, v5
  v_max_i32 v7, 0, v6
  v_cvt_f32_u32 v7, v7
  v_cvt_pk_bf16_f32 v8, v7, v7
  v_and_b32 v7, 0xffff0000, v8
  v_lshrrev_b32 v8, 23, v7
  v_subrev_u32 v8, 134, v8
  v_max_i32 v8, 0, v8
  v_cvt_u32_f32 v7, v7
  v_lshrrev_b32 v7, v8, v7
  v_lshl_add_u32 v7, v8, 8, v7
  v_lshl_add_u32 v216, v7, 2, s18
  v_subrev_u32 v6, 17, v5
  v_max_i32 v7, 0, v6
  v_cvt_f32_u32 v7, v7
  v_cvt_pk_bf16_f32 v8, v7, v7
  v_and_b32 v7, 0xffff0000, v8
  v_lshrrev_b32 v8, 23, v7
  v_subrev_u32 v8, 134, v8
  v_max_i32 v8, 0, v8
  v_cvt_u32_f32 v7, v7
  v_lshrrev_b32 v7, v8, v7
  v_lshl_add_u32 v7, v8, 8, v7
  v_lshl_add_u32 v217, v7, 2, s18
  v_subrev_u32 v6, 18, v5
  v_max_i32 v7, 0, v6
  v_cvt_f32_u32 v7, v7
  v_cvt_pk_bf16_f32 v8, v7, v7
  v_and_b32 v7, 0xffff0000, v8
  v_lshrrev_b32 v8, 23, v7
  v_subrev_u32 v8, 134, v8
  v_max_i32 v8, 0, v8
  v_cvt_u32_f32 v7, v7
  v_lshrrev_b32 v7, v8, v7
  v_lshl_add_u32 v7, v8, 8, v7
  v_lshl_add_u32 v218, v7, 2, s18
  v_subrev_u32 v6, 19, v5
  v_max_i32 v7, 0, v6
  v_cvt_f32_u32 v7, v7
  v_cvt_pk_bf16_f32 v8, v7, v7
  v_and_b32 v7, 0xffff0000, v8
  v_lshrrev_b32 v8, 23, v7
  v_subrev_u32 v8, 134, v8
  v_max_i32 v8, 0, v8
  v_cvt_u32_f32 v7, v7
  v_lshrrev_b32 v7, v8, v7
  v_lshl_add_u32 v7, v8, 8, v7
  v_lshl_add_u32 v219, v7, 2, s18
  v_subrev_u32 v6, 20, v5
  v_max_i32 v7, 0, v6
  v_cvt_f32_u32 v7, v7
  v_cvt_pk_bf16_f32 v8, v7, v7
  v_and_b32 v7, 0xffff0000, v8
  v_lshrrev_b32 v8, 23, v7
  v_subrev_u32 v8, 134, v8
  v_max_i32 v8, 0, v8
  v_cvt_u32_f32 v7, v7
  v_lshrrev_b32 v7, v8, v7
  v_lshl_add_u32 v7, v8, 8, v7
  v_lshl_add_u32 v220, v7, 2, s18
  v_subrev_u32 v6, 21, v5
  v_max_i32 v7, 0, v6
  v_cvt_f32_u32 v7, v7
  v_cvt_pk_bf16_f32 v8, v7, v7
  v_and_b32 v7, 0xffff0000, v8
  v_lshrrev_b32 v8, 23, v7
  v_subrev_u32 v8, 134, v8
  v_max_i32 v8, 0, v8
  v_cvt_u32_f32 v7, v7
  v_lshrrev_b32 v7, v8, v7
  v_lshl_add_u32 v7, v8, 8, v7
  v_lshl_add_u32 v221, v7, 2, s18
  v_subrev_u32 v6, 22, v5
  v_max_i32 v7, 0, v6
  v_cvt_f32_u32 v7, v7
  v_cvt_pk_bf16_f32 v8, v7, v7
  v_and_b32 v7, 0xffff0000, v8
  v_lshrrev_b32 v8, 23, v7
  v_subrev_u32 v8, 134, v8
  v_max_i32 v8, 0, v8
  v_cvt_u32_f32 v7, v7
  v_lshrrev_b32 v7, v8, v7
  v_lshl_add_u32 v7, v8, 8, v7
  v_lshl_add_u32 v222, v7, 2, s18
  v_subrev_u32 v6, 23, v5
  v_max_i32 v7, 0, v6
  v_cvt_f32_u32 v7, v7
  v_cvt_pk_bf16_f32 v8, v7, v7
  v_and_b32 v7, 0xffff0000, v8
  v_lshrrev_b32 v8, 23, v7
  v_subrev_u32 v8, 134, v8
  v_max_i32 v8, 0, v8
  v_cvt_u32_f32 v7, v7
  v_lshrrev_b32 v7, v8, v7
  v_lshl_add_u32 v7, v8, 8, v7
  v_lshl_add_u32 v223, v7, 2, s18
  v_subrev_u32 v6, 24, v5
  v_max_i32 v7, 0, v6
  v_cvt_f32_u32 v7, v7
  v_cvt_pk_bf16_f32 v8, v7, v7
  v_and_b32 v7, 0xffff0000, v8
  v_lshrrev_b32 v8, 23, v7
  v_subrev_u32 v8, 134, v8
  v_max_i32 v8, 0, v8
  v_cvt_u32_f32 v7, v7
  v_lshrrev_b32 v7, v8, v7
  v_lshl_add_u32 v7, v8, 8, v7
  v_lshl_add_u32 v224, v7, 2, s18
  v_subrev_u32 v6, 25, v5
  v_max_i32 v7, 0, v6
  v_cvt_f32_u32 v7, v7
  v_cvt_pk_bf16_f32 v8, v7, v7
  v_and_b32 v7, 0xffff0000, v8
  v_lshrrev_b32 v8, 23, v7
  v_subrev_u32 v8, 134, v8
  v_max_i32 v8, 0, v8
  v_cvt_u32_f32 v7, v7
  v_lshrrev_b32 v7, v8, v7
  v_lshl_add_u32 v7, v8, 8, v7
  v_lshl_add_u32 v225, v7, 2, s18
  v_subrev_u32 v6, 26, v5
  v_max_i32 v7, 0, v6
  v_cvt_f32_u32 v7, v7
  v_cvt_pk_bf16_f32 v8, v7, v7
  v_and_b32 v7, 0xffff0000, v8
  v_lshrrev_b32 v8, 23, v7
  v_subrev_u32 v8, 134, v8
  v_max_i32 v8, 0, v8
  v_cvt_u32_f32 v7, v7
  v_lshrrev_b32 v7, v8, v7
  v_lshl_add_u32 v7, v8, 8, v7
  v_lshl_add_u32 v226, v7, 2, s18
  v_subrev_u32 v6, 27, v5
  v_max_i32 v7, 0, v6
  v_cvt_f32_u32 v7, v7
  v_cvt_pk_bf16_f32 v8, v7, v7
  v_and_b32 v7, 0xffff0000, v8
  v_lshrrev_b32 v8, 23, v7
  v_subrev_u32 v8, 134, v8
  v_max_i32 v8, 0, v8
  v_cvt_u32_f32 v7, v7
  v_lshrrev_b32 v7, v8, v7
  v_lshl_add_u32 v7, v8, 8, v7
  v_lshl_add_u32 v227, v7, 2, s18
  v_subrev_u32 v6, 28, v5
  v_max_i32 v7, 0, v6
  v_cvt_f32_u32 v7, v7
  v_cvt_pk_bf16_f32 v8, v7, v7
  v_and_b32 v7, 0xffff0000, v8
  v_lshrrev_b32 v8, 23, v7
  v_subrev_u32 v8, 134, v8
  v_max_i32 v8, 0, v8
  v_cvt_u32_f32 v7, v7
  v_lshrrev_b32 v7, v8, v7
  v_lshl_add_u32 v7, v8, 8, v7
  v_lshl_add_u32 v228, v7, 2, s18
  v_subrev_u32 v6, 29, v5
  v_max_i32 v7, 0, v6
  v_cvt_f32_u32 v7, v7
  v_cvt_pk_bf16_f32 v8, v7, v7
  v_and_b32 v7, 0xffff0000, v8
  v_lshrrev_b32 v8, 23, v7
  v_subrev_u32 v8, 134, v8
  v_max_i32 v8, 0, v8
  v_cvt_u32_f32 v7, v7
  v_lshrrev_b32 v7, v8, v7
  v_lshl_add_u32 v7, v8, 8, v7
  v_lshl_add_u32 v229, v7, 2, s18
  v_subrev_u32 v6, 30, v5
  v_max_i32 v7, 0, v6
  v_cvt_f32_u32 v7, v7
  v_cvt_pk_bf16_f32 v8, v7, v7
  v_and_b32 v7, 0xffff0000, v8
  v_lshrrev_b32 v8, 23, v7
  v_subrev_u32 v8, 134, v8
  v_max_i32 v8, 0, v8
  v_cvt_u32_f32 v7, v7
  v_lshrrev_b32 v7, v8, v7
  v_lshl_add_u32 v7, v8, 8, v7
  v_lshl_add_u32 v230, v7, 2, s18
  v_subrev_u32 v6, 31, v5
  v_max_i32 v7, 0, v6
  v_cvt_f32_u32 v7, v7
  v_cvt_pk_bf16_f32 v8, v7, v7
  v_and_b32 v7, 0xffff0000, v8
  v_lshrrev_b32 v8, 23, v7
  v_subrev_u32 v8, 134, v8
  v_max_i32 v8, 0, v8
  v_cvt_u32_f32 v7, v7
  v_lshrrev_b32 v7, v8, v7
  v_lshl_add_u32 v7, v8, 8, v7
  v_lshl_add_u32 v231, v7, 2, s18
  v_subrev_u32 v6, 32, v5
  v_max_i32 v7, 0, v6
  v_cvt_f32_u32 v7, v7
  v_cvt_pk_bf16_f32 v8, v7, v7
  v_and_b32 v7, 0xffff0000, v8
  v_lshrrev_b32 v8, 23, v7
  v_subrev_u32 v8, 134, v8
  v_max_i32 v8, 0, v8
  v_cvt_u32_f32 v7, v7
  v_lshrrev_b32 v7, v8, v7
  v_lshl_add_u32 v7, v8, 8, v7
  v_mov_b32 v8, 1280
  v_cmp_gt_i32 vcc, 0, v6
  s_nop 1
  v_cndmask_b32 v7, v7, v8, vcc
  v_lshl_add_u32 v232, v7, 2, s18
  v_mov_b32 v8, 0
  v_mov_b32 v9, 0
  v_lshlrev_b32 v5, 3, v1
  v_add_u32 v5, s17, v5
  ds_write_b64 v5, v[8:9]
  v_and_b32 v6, 15, v1
  v_lshlrev_b32 v6, 3, v6
  v_add_u32 v6, s17, v6
  ds_write_b64 v6, v[8:9] offset:8704
  ds_write_b64 v6, v[8:9] offset:12928
  v_mov_b32 v6, s17
  ds_write_b64 v6, v[8:9] offset:18176
  s_lshl_b32 s19, s3, 2
  s_add_u32 s20, s19, s16
  s_lshl_b32 s21, s3, 3
  v_mul_u32_u24 v5, 3584, v0
  v_mul_u32_u24 v141, 1792, v0
  s_lshl_b32 s22, s20, 9
  v_lshlrev_b32 v6, 3, v1
  buffer_load_dwordx2 v[24:25], v6, s[64:67], s22 offen
  buffer_load_dwordx2 v[26:27], v6, s[68:71], s22 offen
  buffer_load_dwordx2 v[28:29], v6, s[72:75], s22 offen
  buffer_load_dwordx2 v[30:31], v6, s[76:79], s22 offen
  s_lshl_b32 s22, s20, 1
  v_mov_b32 v7, 0
  buffer_load_ushort v32, v7, s[80:83], s22 offen
  buffer_load_ushort v33, v7, s[84:87], s22 offen
  s_mov_b32 s24, 0x05040100
  s_mov_b32 s25, 0x07060302
  s_barrier
  s_waitcnt vmcnt(0)
  s_mov_b32 s26, 1069066811
  s_mov_b32 s27, 1042479491
  v_lshlrev_b32 v32, 16, v32
  v_lshlrev_b32 v33, 16, v33
  v_mul_f32 v32, s26, v32
  v_exp_f32 v32, v32
  s_nop 0
  v_cvt_pk_bf16_f32 v34, v32, v32
  v_and_b32 v32, 0xffff0000, v34
  v_lshlrev_b32 v37, 6, v1
  v_add_u32 v37, s17, v37
  v_lshlrev_b32 v40, 16, v24
  v_lshlrev_b32 v41, 16, v26
  v_lshlrev_b32 v42, 16, v28
  v_lshlrev_b32 v43, 16, v30
  v_mul_f32 v40, s26, v40
  v_exp_f32 v40, v40
  s_nop 0
  v_cvt_pk_bf16_f32 v34, v40, v40
  v_and_b32 v40, 0xffff0000, v34
  v_mul_f32 v40, v40, v32
  v_mul_f32 v40, s26, v40
  v_sub_f32 v40, 0, v40
  v_mul_f32 v41, v41, v32
  v_mul_f32 v41, s27, v41
  v_mul_f32 v42, v42, v32
  v_mul_f32 v43, v43, v32
  v_add_f32 v42, v42, v42
  v_add_f32 v43, v43, v43
  ds_write_b128 v37, v[40:43] offset:18240
  v_and_b32 v40, 0xffff0000, v24
  v_and_b32 v41, 0xffff0000, v26
  v_and_b32 v42, 0xffff0000, v28
  v_and_b32 v43, 0xffff0000, v30
  v_mul_f32 v40, s26, v40
  v_exp_f32 v40, v40
  s_nop 0
  v_cvt_pk_bf16_f32 v34, v40, v40
  v_and_b32 v40, 0xffff0000, v34
  v_mul_f32 v40, v40, v32
  v_mul_f32 v40, s26, v40
  v_sub_f32 v40, 0, v40
  v_mul_f32 v41, v41, v32
  v_mul_f32 v41, s27, v41
  v_mul_f32 v42, v42, v32
  v_mul_f32 v43, v43, v32
  v_add_f32 v42, v42, v42
  v_add_f32 v43, v43, v43
  ds_write_b128 v37, v[40:43] offset:18256
  v_lshlrev_b32 v40, 16, v25
  v_lshlrev_b32 v41, 16, v27
  v_lshlrev_b32 v42, 16, v29
  v_lshlrev_b32 v43, 16, v31
  v_mul_f32 v40, s26, v40
  v_exp_f32 v40, v40
  s_nop 0
  v_cvt_pk_bf16_f32 v34, v40, v40
  v_and_b32 v40, 0xffff0000, v34
  v_mul_f32 v40, v40, v32
  v_mul_f32 v40, s26, v40
  v_sub_f32 v40, 0, v40
  v_mul_f32 v41, v41, v32
  v_mul_f32 v41, s27, v41
  v_mul_f32 v42, v42, v32
  v_mul_f32 v43, v43, v32
  v_add_f32 v42, v42, v42
  v_add_f32 v43, v43, v43
  ds_write_b128 v37, v[40:43] offset:18272
  v_and_b32 v40, 0xffff0000, v25
  v_and_b32 v41, 0xffff0000, v27
  v_and_b32 v42, 0xffff0000, v29
  v_and_b32 v43, 0xffff0000, v31
  v_mul_f32 v40, s26, v40
  v_exp_f32 v40, v40
  s_nop 0
  v_cvt_pk_bf16_f32 v34, v40, v40
  v_and_b32 v40, 0xffff0000, v34
  v_mul_f32 v40, v40, v32
  v_mul_f32 v40, s26, v40
  v_sub_f32 v40, 0, v40
  v_mul_f32 v41, v41, v32
  v_mul_f32 v41, s27, v41
  v_mul_f32 v42, v42, v32
  v_mul_f32 v43, v43, v32
  v_add_f32 v42, v42, v42
  v_add_f32 v43, v43, v43
  ds_write_b128 v37, v[40:43] offset:18288
  v_cvt_f32_u32 v44, v4
  v_lshlrev_b32 v45, 4, v4
  v_cvt_f32_u32 v45, v45
  v_lshlrev_b32 v46, 4, v3
  v_add_u32 v46, s17, v46
  v_mov_b32 v48, 0
  v_mov_b32 v49, 0
  v_mov_b32 v50, 0
  v_mov_b32 v51, 0
  v_mov_b32 v52, 0
  v_mov_b32 v53, 0
  v_mov_b32 v54, 0
  v_mov_b32 v55, 0
  v_mov_b32 v56, 0
  v_mov_b32 v57, 0
  v_mov_b32 v58, 0
  v_mov_b32 v59, 0
  v_mov_b32 v60, 0
  v_mov_b32 v61, 0
  v_mov_b32 v62, 0
  v_mov_b32 v63, 0
  v_mov_b32 v64, 0
  v_mov_b32 v65, 0
  v_mov_b32 v66, 0
  v_mov_b32 v67, 0
  s_waitcnt lgkmcnt(0)
  ds_read_b128 v[68:71], v46 offset:18240
  s_add_u32 s22, s21, 0
  buffer_load_dwordx2 v[8:9], v5, s[60:63], s22 offen offset:0
  s_mov_b32 s28, 0
  s_call_b64 s[30:31], wk_kl
  s_mov_b32 s28, 0
  s_call_b64 s[30:31], wk_kl
  s_add_u32 s22, s21, 0
  buffer_load_dwordx2 v[10:11], v5, s[60:63], s22 offen offset:896
  s_mov_b32 s28, 0
  s_call_b64 s[30:31], wk_kl
  s_mov_b32 s28, 0
  s_call_b64 s[30:31], wk_kl
  s_add_u32 s22, s21, 0
  buffer_load_dwordx2 v[12:13], v5, s[60:63], s22 offen offset:1792
  s_mov_b32 s28, 0
  s_call_b64 s[30:31], wk_kl
  s_mov_b32 s28, 0
  s_call_b64 s[30:31], wk_kl
  s_add_u32 s22, s21, 0
  buffer_load_dwordx2 v[14:15], v5, s[60:63], s22 offen offset:2688
  s_mov_b32 s28, 0
  s_call_b64 s[30:31], wk_kl
  s_mov_b32 s28, 0
  s_call_b64 s[30:31], wk_kl
  s_add_u32 s22, s21, 917504
  buffer_load_dwordx2 v[16:17], v5, s[60:63], s22 offen offset:0
  s_mov_b32 s28, 0
  s_call_b64 s[30:31], wk_kl
  s_mov_b32 s28, 0
  s_call_b64 s[30:31], wk_kl
  s_add_u32 s22, s21, 917504
  buffer_load_dwordx2 v[18:19], v5, s[60:63], s22 offen offset:896
  s_mov_b32 s28, 0
  s_call_b64 s[30:31], wk_kl
  s_mov_b32 s28, 0
  s_call_b64 s[30:31], wk_kl
  s_add_u32 s22, s21, 917504
  buffer_load_dwordx2 v[20:21], v5, s[60:63], s22 offen offset:1792
  s_mov_b32 s28, 0
  s_call_b64 s[30:31], wk_kl
  s_mov_b32 s28, 0
  s_call_b64 s[30:31], wk_kl
  s_add_u32 s22, s21, 917504
  buffer_load_dwordx2 v[22:23], v5, s[60:63], s22 offen offset:2688
  s_mov_b32 s28, 0
  s_call_b64 s[30:31], wk_kl
  s_mov_b32 s28, 0
  s_call_b64 s[30:31], wk_kl
  s_branch wk_kd
wk_kl:
  s_waitcnt lgkmcnt(0)
  v_mov_b32 v72, v68
  v_mov_b32 v73, v69
  v_mov_b32 v74, v70
  v_mov_b32 v75, v71
  v_add_u32 v46, 64, v46
  ds_read_b128 v[68:71], v46 offset:18240
  v_mul_f32 v80, v72, v45
  v_mul_f32 v81, v73, v45
  v_exp_f32 v80, v80
  v_fract_f32 v81, v81
  v_cos_f32 v76, v81
  v_sin_f32 v77, v81
  v_mul_f32 v76, v76, v80
  v_mul_f32 v77, v77, v80
  v_mul_f32 v80, v72, v44
  v_mul_f32 v81, v73, v44
  v_exp_f32 v80, v80
  v_fract_f32 v81, v81
  v_cos_f32 v78, v81
  v_sin_f32 v79, v81
  v_mul_f32 v78, v78, v80
  v_mul_f32 v79, v79, v80
  v_mul_f32 v82, v74, v76
  v_mul_f32 v83, v74, v77
  v_fma_f32 v82, -v75, v77, v82
  v_fma_f32 v83, -v75, v76, -v83
  v_mul_f32 v86, v76, v76
  v_mul_f32 v87, v76, v77
  v_fma_f32 v86, -v77, v77, v86
  v_add_f32 v87, v87, v87
  v_mfma_f32_16x16x4_f32 v[48:51], v82, v78, v[48:51]
  v_mul_f32 v88, v78, v78
  v_mul_f32 v89, v78, v79
  v_fma_f32 v88, -v79, v79, v88
  v_add_f32 v89, v89, v89
  v_mfma_f32_16x16x4_f32 v[48:51], v83, v79, v[48:51]
  v_mul_f32 v84, v74, v86
  v_mul_f32 v85, v74, v87
  v_fma_f32 v84, -v75, v87, v84
  v_fma_f32 v85, -v75, v86, -v85
  v_mul_f32 v76, v86, v86
  v_mul_f32 v77, v86, v87
  v_fma_f32 v76, -v87, v87, v76
  v_add_f32 v77, v77, v77
  v_mfma_f32_16x16x4_f32 v[52:55], v84, v88, v[52:55]
  v_mul_f32 v78, v88, v88
  v_mul_f32 v79, v88, v89
  v_fma_f32 v78, -v89, v89, v78
  v_add_f32 v79, v79, v79
  v_mfma_f32_16x16x4_f32 v[52:55], v85, v89, v[52:55]
  v_mul_f32 v82, v74, v76
  v_mul_f32 v83, v74, v77
  v_fma_f32 v82, -v75, v77, v82
  v_fma_f32 v83, -v75, v76, -v83
  v_mul_f32 v86, v76, v76
  v_mul_f32 v87, v76, v77
  v_fma_f32 v86, -v77, v77, v86
  v_add_f32 v87, v87, v87
  v_mfma_f32_16x16x4_f32 v[56:59], v82, v78, v[56:59]
  v_mul_f32 v88, v78, v78
  v_mul_f32 v89, v78, v79
  v_fma_f32 v88, -v79, v79, v88
  v_add_f32 v89, v89, v89
  v_mfma_f32_16x16x4_f32 v[56:59], v83, v79, v[56:59]
  v_mul_f32 v84, v74, v86
  v_mul_f32 v85, v74, v87
  v_fma_f32 v84, -v75, v87, v84
  v_fma_f32 v85, -v75, v86, -v85
  v_mul_f32 v76, v86, v86
  v_mul_f32 v77, v86, v87
  v_fma_f32 v76, -v87, v87, v76
  v_add_f32 v77, v77, v77
  v_mfma_f32_16x16x4_f32 v[60:63], v84, v88, v[60:63]
  v_mfma_f32_16x16x4_f32 v[60:63], v85, v89, v[60:63]
  v_mul_f32 v82, v74, v76
  v_fma_f32 v82, -v75, v77, v82
  s_nop 1
  v_mfma_f32_16x16x4_f32 v[64:67], v82, v88, v[64:67]
  s_add_u32 s28, s28, 1
  s_cmp_lt_u32 s28, 4
  s_cbranch_scc1 wk_kl
  s_setpc_b64 s[30:31]
wk_kd:
  s_nop 15
  s_nop 3
  s_waitcnt vmcnt(0)
  v_lshlrev_b32 v6, 3, v0
  v_perm_b32 v34, v10, v8, s24
  v_perm_b32 v35, v14, v12, s24
  v_add_u32 v36, 512, v6
  ds_write_b64 v36, v[34:35]
  v_perm_b32 v34, v10, v8, s25
  v_perm_b32 v35, v14, v12, s25
  v_add_u32 v36, 25088, v6
  ds_write_b64 v36, v[34:35]
  v_perm_b32 v34, v11, v9, s24
  v_perm_b32 v35, v15, v13, s24
  v_add_u32 v36, 49664, v6
  ds_write_b64 v36, v[34:35]
  v_perm_b32 v34, v11, v9, s25
  v_perm_b32 v35, v15, v13, s25
  v_add_u32 v36, 74240, v6
  ds_write_b64 v36, v[34:35]
  v_perm_b32 v34, v18, v16, s24
  v_perm_b32 v35, v22, v20, s24
  v_add_u32 v36, 2560, v6
  ds_write_b64 v36, v[34:35]
  v_perm_b32 v34, v18, v16, s25
  v_perm_b32 v35, v22, v20, s25
  v_add_u32 v36, 27136, v6
  ds_write_b64 v36, v[34:35]
  v_perm_b32 v34, v19, v17, s24
  v_perm_b32 v35, v23, v21, s24
  v_add_u32 v36, 51712, v6
  ds_write_b64 v36, v[34:35]
  v_perm_b32 v34, v19, v17, s25
  v_perm_b32 v35, v23, v21, s25
  v_add_u32 v36, 76288, v6
  ds_write_b64 v36, v[34:35]
  v_lshlrev_b32 v46, 8, v3
  v_lshl_add_u32 v46, v4, 2, v46
  v_add_u32 v46, s17, v46
  ds_write_b32 v46, v48 offset:13056
  ds_write_b32 v46, v49 offset:13120
  ds_write_b32 v46, v50 offset:13184
  ds_write_b32 v46, v51 offset:13248
  s_waitcnt lgkmcnt(8)
  ds_write_b32 v46, v52 offset:14080
  ds_write_b32 v46, v53 offset:14144
  ds_write_b32 v46, v54 offset:14208
  ds_write_b32 v46, v55 offset:14272
  s_waitcnt lgkmcnt(8)
  ds_write_b32 v46, v56 offset:15104
  ds_write_b32 v46, v57 offset:15168
  ds_write_b32 v46, v58 offset:15232
  ds_write_b32 v46, v59 offset:15296
  s_waitcnt lgkmcnt(8)
  ds_write_b32 v46, v60 offset:16128
  ds_write_b32 v46, v61 offset:16192
  ds_write_b32 v46, v62 offset:16256
  ds_write_b32 v46, v63 offset:16320
  s_waitcnt lgkmcnt(8)
  ds_write_b32 v46, v64 offset:17152
  ds_write_b32 v46, v65 offset:17216
  ds_write_b32 v46, v66 offset:17280
  ds_write_b32 v46, v67 offset:17344
  s_waitcnt lgkmcnt(8)
  s_waitcnt lgkmcnt(0)
  ds_read_b32 v48, v200
  ds_read_b32 v49, v201
  ds_read_b32 v50, v202
  ds_read_b32 v51, v203
  ds_read_b32 v52, v204
  ds_read_b32 v53, v205
  ds_read_b32 v54, v206
  ds_read_b32 v55, v207
  s_waitcnt lgkmcnt(4)
  ds_read_b32 v56, v208
  ds_read_b32 v57, v209
  ds_read_b32 v58, v210
  ds_read_b32 v59, v211
  ds_read_b32 v60, v212
  ds_read_b32 v61, v213
  ds_read_b32 v62, v214
  ds_read_b32 v63, v215
  s_waitcnt lgkmcnt(4)
  ds_read_b32 v64, v216
  ds_read_b32 v65, v217
  ds_read_b32 v66, v218
  ds_read_b32 v67, v219
  ds_read_b32 v68, v220
  ds_read_b32 v69, v221
  ds_read_b32 v70, v222
  ds_read_b32 v71, v223
  s_waitcnt lgkmcnt(4)
  ds_read_b32 v72, v224
  ds_read_b32 v73, v225
  ds_read_b32 v74, v226
  ds_read_b32 v75, v227
  ds_read_b32 v76, v228
  ds_read_b32 v77, v229
  ds_read_b32 v78, v230
  ds_read_b32 v79, v231
  s_waitcnt lgkmcnt(4)
  ds_read_b32 v80, v232
  s_waitcnt lgkmcnt(0)
  v_lshlrev_b32 v46, 6, v1
  v_add_u32 v46, s17, v46
  v_cvt_pk_bf16_f32 v84, v48, v49
  v_cvt_pk_bf16_f32 v88, v49, v50
  v_cvt_pk_bf16_f32 v85, v50, v51
  v_cvt_pk_bf16_f32 v89, v51, v52
  v_cvt_pk_bf16_f32 v86, v52, v53
  v_cvt_pk_bf16_f32 v90, v53, v54
  v_cvt_pk_bf16_f32 v87, v54, v55
  v_cvt_pk_bf16_f32 v91, v55, v56
  ds_write_b128 v46, v[84:87] offset:4608
  ds_write_b128 v46, v[88:91] offset:8832
  s_waitcnt lgkmcnt(0)
  v_cvt_pk_bf16_f32 v84, v56, v57
  v_cvt_pk_bf16_f32 v88, v57, v58
  v_cvt_pk_bf16_f32 v85, v58, v59
  v_cvt_pk_bf16_f32 v89, v59, v60
  v_cvt_pk_bf16_f32 v86, v60, v61
  v_cvt_pk_bf16_f32 v90, v61, v62
  v_cvt_pk_bf16_f32 v87, v62, v63
  v_cvt_pk_bf16_f32 v91, v63, v64
  ds_write_b128 v46, v[84:87] offset:4624
  ds_write_b128 v46, v[88:91] offset:8848
  s_waitcnt lgkmcnt(0)
  v_cvt_pk_bf16_f32 v84, v64, v65
  v_cvt_pk_bf16_f32 v88, v65, v66
  v_cvt_pk_bf16_f32 v85, v66, v67
  v_cvt_pk_bf16_f32 v89, v67, v68
  v_cvt_pk_bf16_f32 v86, v68, v69
  v_cvt_pk_bf16_f32 v90, v69, v70
  v_cvt_pk_bf16_f32 v87, v70, v71
  v_cvt_pk_bf16_f32 v91, v71, v72
  ds_write_b128 v46, v[84:87] offset:4640
  ds_write_b128 v46, v[88:91] offset:8864
  s_waitcnt lgkmcnt(0)
  v_cvt_pk_bf16_f32 v84, v72, v73
  v_cvt_pk_bf16_f32 v88, v73, v74
  v_cvt_pk_bf16_f32 v85, v74, v75
  v_cvt_pk_bf16_f32 v89, v75, v76
  v_cvt_pk_bf16_f32 v86, v76, v77
  v_cvt_pk_bf16_f32 v90, v77, v78
  v_cvt_pk_bf16_f32 v87, v78, v79
  v_cvt_pk_bf16_f32 v91, v79, v80
  ds_write_b128 v46, v[84:87] offset:4656
  ds_write_b128 v46, v[88:91] offset:8880
  s_waitcnt lgkmcnt(0)
  s_barrier
  v_lshrrev_b32 v47, 1, v3
  v_sub_u32 v46, v4, v47
  v_add_u32 v46, 1, v46
  v_lshlrev_b32 v46, 5, v46
  v_and_b32 v48, 1, v3
  v_lshl_add_u32 v46, v48, 4, v46
  v_add_u32 v46, s17, v46
  ds_read_b128 a[0:3], v46 offset:32
  ds_read_b128 a[4:7], v46 offset:96
  ds_read_b128 a[8:11], v46 offset:160
  ds_read_b128 a[12:15], v46 offset:224
  ds_read_b128 a[16:19], v46 offset:288
  ds_read_b128 a[20:23], v46 offset:352
  ds_read_b128 a[24:27], v46 offset:416
  ds_read_b128 a[28:31], v46 offset:480
  s_waitcnt lgkmcnt(4)
  ds_read_b128 a[32:35], v46 offset:544
  ds_read_b128 a[36:39], v46 offset:608
  ds_read_b128 a[40:43], v46 offset:672
  ds_read_b128 a[44:47], v46 offset:736
  ds_read_b128 a[48:51], v46 offset:800
  ds_read_b128 a[52:55], v46 offset:864
  ds_read_b128 a[56:59], v46 offset:928
  ds_read_b128 a[60:63], v46 offset:992
  s_waitcnt lgkmcnt(4)
  ds_read_b128 a[64:67], v46 offset:1056
  ds_read_b128 a[68:71], v46 offset:1120
  ds_read_b128 a[72:75], v46 offset:1184
  ds_read_b128 a[76:79], v46 offset:1248
  ds_read_b128 a[80:83], v46 offset:1312
  ds_read_b128 a[84:87], v46 offset:1376
  ds_read_b128 a[88:91], v46 offset:1440
  ds_read_b128 a[92:95], v46 offset:1504
  s_waitcnt lgkmcnt(4)
  ds_read_b128 a[96:99], v46 offset:1568
  ds_read_b128 a[100:103], v46 offset:1632
  ds_read_b128 a[104:107], v46 offset:1696
  ds_read_b128 a[108:111], v46 offset:1760
  ds_read_b128 a[112:115], v46 offset:1824
  ds_read_b128 a[116:119], v46 offset:1888
  ds_read_b128 a[120:123], v46 offset:1952
  ds_read_b128 a[124:127], v46 offset:2016
  s_waitcnt lgkmcnt(4)
  ds_read_b128 a[128:131], v46 offset:2080
  ds_read_b128 a[132:135], v46 offset:2144
  ds_read_b128 a[136:139], v46 offset:2208
  ds_read_b128 a[140:143], v46 offset:2272
  ds_read_b128 a[144:147], v46 offset:2336
  ds_read_b128 a[148:151], v46 offset:2400
  ds_read_b128 a[152:155], v46 offset:2464
  ds_read_b128 a[156:159], v46 offset:2528
  s_waitcnt lgkmcnt(4)
  ds_read_b128 a[160:163], v46 offset:2592
  ds_read_b128 a[164:167], v46 offset:2656
  ds_read_b128 a[168:171], v46 offset:2720
  ds_read_b128 a[172:175], v46 offset:2784
  ds_read_b128 a[176:179], v46 offset:2848
  ds_read_b128 a[180:183], v46 offset:2912
  ds_read_b128 a[184:187], v46 offset:2976
  ds_read_b128 a[188:191], v46 offset:3040
  s_waitcnt lgkmcnt(4)
  ds_read_b128 a[192:195], v46 offset:3104
  ds_read_b128 a[196:199], v46 offset:3168
  ds_read_b128 a[200:203], v46 offset:3232
  ds_read_b128 a[204:207], v46 offset:3296
  ds_read_b128 a[208:211], v46 offset:3360
  ds_read_b128 a[212:215], v46 offset:3424
  ds_read_b128 a[216:219], v46 offset:3488
  ds_read_b128 a[220:223], v46 offset:3552
  s_waitcnt lgkmcnt(4)
  ds_read_b128 a[224:227], v46 offset:3616
  ds_read_b128 a[228:231], v46 offset:3680
  ds_read_b128 a[232:235], v46 offset:3744
  ds_read_b128 a[236:239], v46 offset:3808
  ds_read_b128 a[240:243], v46 offset:3872
  ds_read_b128 a[244:247], v46 offset:3936
  ds_read_b128 a[248:251], v46 offset:4000
  ds_read_b128 a[252:255], v46 offset:4064
  s_waitcnt lgkmcnt(4)
  v_lshlrev_b32 v49, 4, v47
  v_add_u32 v49, v49, v4
  v_sub_u32 v49, 2047, v49
  v_lshl_add_u32 v49, v48, 3, v49
  v_and_b32 v50, 1, v49
  v_lshrrev_b32 v49, 1, v49
  v_lshlrev_b32 v49, 2, v49
  v_mul_u32_u24 v50, 4224, v50
  v_add3_u32 v49, v49, v50, s17
  v_add_u32 v49, 4608, v49
  v_subrev_u32 v52, 896, v49
  v_subrev_u32 v53, 1856, v49
  v_subrev_u32 v54, 2816, v49
  v_subrev_u32 v55, 3776, v49
  v_subrev_u32 v56, 4736, v49
  s_waitcnt lgkmcnt(0)
  ds_read2_b32 v[92:93], v52 offset0:224 offset1:225
  ds_read2_b32 v[94:95], v52 offset0:226 offset1:227
  ds_read2_b32 v[96:97], v52 offset0:208 offset1:209
  ds_read2_b32 v[98:99], v52 offset0:210 offset1:211
  ds_read2_b32 v[100:101], v52 offset0:192 offset1:193
  ds_read2_b32 v[102:103], v52 offset0:194 offset1:195
  ds_read2_b32 v[104:105], v52 offset0:176 offset1:177
  ds_read2_b32 v[106:107], v52 offset0:178 offset1:179
  s_waitcnt lgkmcnt(6)
  v_mfma_f32_16x16x32_bf16 v[60:63], v[92:95], a[28:31], 0
  v_mfma_f32_16x16x32_bf16 v[64:67], v[92:95], a[60:63], 0
  v_mfma_f32_16x16x32_bf16 v[68:71], v[92:95], a[92:95], 0
  v_mfma_f32_16x16x32_bf16 v[72:75], v[92:95], a[124:127], 0
  v_mfma_f32_16x16x32_bf16 v[76:79], v[92:95], a[156:159], 0
  v_mfma_f32_16x16x32_bf16 v[80:83], v[92:95], a[188:191], 0
  v_mfma_f32_16x16x32_bf16 v[84:87], v[92:95], a[220:223], 0
  v_mfma_f32_16x16x32_bf16 v[88:91], v[92:95], a[252:255], 0
  ds_read2_b32 v[92:93], v52 offset0:160 offset1:161
  ds_read2_b32 v[94:95], v52 offset0:162 offset1:163
  s_waitcnt lgkmcnt(6)
  v_mfma_f32_16x16x32_bf16 v[60:63], v[96:99], a[24:27], v[60:63]
  v_mfma_f32_16x16x32_bf16 v[64:67], v[96:99], a[56:59], v[64:67]
  v_mfma_f32_16x16x32_bf16 v[68:71], v[96:99], a[88:91], v[68:71]
  v_mfma_f32_16x16x32_bf16 v[72:75], v[96:99], a[120:123], v[72:75]
  v_mfma_f32_16x16x32_bf16 v[76:79], v[96:99], a[152:155], v[76:79]
  v_mfma_f32_16x16x32_bf16 v[80:83], v[96:99], a[184:187], v[80:83]
  v_mfma_f32_16x16x32_bf16 v[84:87], v[96:99], a[216:219], v[84:87]
  v_mfma_f32_16x16x32_bf16 v[88:91], v[96:99], a[248:251], v[88:91]
  ds_read2_b32 v[96:97], v52 offset0:144 offset1:145
  ds_read2_b32 v[98:99], v52 offset0:146 offset1:147
  s_waitcnt lgkmcnt(6)
  v_mfma_f32_16x16x32_bf16 v[60:63], v[100:103], a[20:23], v[60:63]
  v_mfma_f32_16x16x32_bf16 v[64:67], v[100:103], a[52:55], v[64:67]
  v_mfma_f32_16x16x32_bf16 v[68:71], v[100:103], a[84:87], v[68:71]
  v_mfma_f32_16x16x32_bf16 v[72:75], v[100:103], a[116:119], v[72:75]
  v_mfma_f32_16x16x32_bf16 v[76:79], v[100:103], a[148:151], v[76:79]
  v_mfma_f32_16x16x32_bf16 v[80:83], v[100:103], a[180:183], v[80:83]
  v_mfma_f32_16x16x32_bf16 v[84:87], v[100:103], a[212:215], v[84:87]
  v_mfma_f32_16x16x32_bf16 v[88:91], v[100:103], a[244:247], v[88:91]
  ds_read2_b32 v[100:101], v52 offset0:128 offset1:129
  ds_read2_b32 v[102:103], v52 offset0:130 offset1:131
  s_waitcnt lgkmcnt(6)
  v_mfma_f32_16x16x32_bf16 v[60:63], v[104:107], a[16:19], v[60:63]
  v_mfma_f32_16x16x32_bf16 v[64:67], v[104:107], a[48:51], v[64:67]
  v_mfma_f32_16x16x32_bf16 v[68:71], v[104:107], a[80:83], v[68:71]
  v_mfma_f32_16x16x32_bf16 v[72:75], v[104:107], a[112:115], v[72:75]
  v_mfma_f32_16x16x32_bf16 v[76:79], v[104:107], a[144:147], v[76:79]
  v_mfma_f32_16x16x32_bf16 v[80:83], v[104:107], a[176:179], v[80:83]
  v_mfma_f32_16x16x32_bf16 v[84:87], v[104:107], a[208:211], v[84:87]
  v_mfma_f32_16x16x32_bf16 v[88:91], v[104:107], a[240:243], v[88:91]
  ds_read2_b32 v[104:105], v52 offset0:112 offset1:113
  ds_read2_b32 v[106:107], v52 offset0:114 offset1:115
  s_waitcnt lgkmcnt(6)
  v_mfma_f32_16x16x32_bf16 v[60:63], v[92:95], a[12:15], v[60:63]
  v_mfma_f32_16x16x32_bf16 v[64:67], v[92:95], a[44:47], v[64:67]
  v_mfma_f32_16x16x32_bf16 v[68:71], v[92:95], a[76:79], v[68:71]
  v_mfma_f32_16x16x32_bf16 v[72:75], v[92:95], a[108:111], v[72:75]
  v_mfma_f32_16x16x32_bf16 v[76:79], v[92:95], a[140:143], v[76:79]
  v_mfma_f32_16x16x32_bf16 v[80:83], v[92:95], a[172:175], v[80:83]
  v_mfma_f32_16x16x32_bf16 v[84:87], v[92:95], a[204:207], v[84:87]
  v_mfma_f32_16x16x32_bf16 v[88:91], v[92:95], a[236:239], v[88:91]
  ds_read2_b32 v[92:93], v52 offset0:96 offset1:97
  ds_read2_b32 v[94:95], v52 offset0:98 offset1:99
  s_waitcnt lgkmcnt(6)
  v_mfma_f32_16x16x32_bf16 v[60:63], v[96:99], a[8:11], v[60:63]
  v_mfma_f32_16x16x32_bf16 v[64:67], v[96:99], a[40:43], v[64:67]
  v_mfma_f32_16x16x32_bf16 v[68:71], v[96:99], a[72:75], v[68:71]
  v_mfma_f32_16x16x32_bf16 v[72:75], v[96:99], a[104:107], v[72:75]
  v_mfma_f32_16x16x32_bf16 v[76:79], v[96:99], a[136:139], v[76:79]
  v_mfma_f32_16x16x32_bf16 v[80:83], v[96:99], a[168:171], v[80:83]
  v_mfma_f32_16x16x32_bf16 v[84:87], v[96:99], a[200:203], v[84:87]
  v_mfma_f32_16x16x32_bf16 v[88:91], v[96:99], a[232:235], v[88:91]
  ds_read2_b32 v[96:97], v52 offset0:80 offset1:81
  ds_read2_b32 v[98:99], v52 offset0:82 offset1:83
  s_waitcnt lgkmcnt(6)
  v_mfma_f32_16x16x32_bf16 v[60:63], v[100:103], a[4:7], v[60:63]
  v_mfma_f32_16x16x32_bf16 v[64:67], v[100:103], a[36:39], v[64:67]
  v_mfma_f32_16x16x32_bf16 v[68:71], v[100:103], a[68:71], v[68:71]
  v_mfma_f32_16x16x32_bf16 v[72:75], v[100:103], a[100:103], v[72:75]
  v_mfma_f32_16x16x32_bf16 v[76:79], v[100:103], a[132:135], v[76:79]
  v_mfma_f32_16x16x32_bf16 v[80:83], v[100:103], a[164:167], v[80:83]
  v_mfma_f32_16x16x32_bf16 v[84:87], v[100:103], a[196:199], v[84:87]
  v_mfma_f32_16x16x32_bf16 v[88:91], v[100:103], a[228:231], v[88:91]
  ds_read2_b32 v[100:101], v52 offset0:64 offset1:65
  ds_read2_b32 v[102:103], v52 offset0:66 offset1:67
  s_waitcnt lgkmcnt(6)
  v_mfma_f32_16x16x32_bf16 v[60:63], v[104:107], a[0:3], v[60:63]
  v_mfma_f32_16x16x32_bf16 v[64:67], v[104:107], a[32:35], v[64:67]
  v_mfma_f32_16x16x32_bf16 v[68:71], v[104:107], a[64:67], v[68:71]
  v_mfma_f32_16x16x32_bf16 v[72:75], v[104:107], a[96:99], v[72:75]
  v_mfma_f32_16x16x32_bf16 v[76:79], v[104:107], a[128:131], v[76:79]
  v_mfma_f32_16x16x32_bf16 v[80:83], v[104:107], a[160:163], v[80:83]
  v_mfma_f32_16x16x32_bf16 v[84:87], v[104:107], a[192:195], v[84:87]
  v_mfma_f32_16x16x32_bf16 v[88:91], v[104:107], a[224:227], v[88:91]
  ds_read2_b32 v[104:105], v52 offset0:48 offset1:49
  ds_read2_b32 v[106:107], v52 offset0:50 offset1:51
  s_waitcnt lgkmcnt(6)
  v_mfma_f32_16x16x32_bf16 v[64:67], v[92:95], a[28:31], v[64:67]
  v_mfma_f32_16x16x32_bf16 v[68:71], v[92:95], a[60:63], v[68:71]
  v_mfma_f32_16x16x32_bf16 v[72:75], v[92:95], a[92:95], v[72:75]
  v_mfma_f32_16x16x32_bf16 v[76:79], v[92:95], a[124:127], v[76:79]
  v_mfma_f32_16x16x32_bf16 v[80:83], v[92:95], a[156:159], v[80:83]
  v_mfma_f32_16x16x32_bf16 v[84:87], v[92:95], a[188:191], v[84:87]
  v_mfma_f32_16x16x32_bf16 v[88:91], v[92:95], a[220:223], v[88:91]
  ds_read2_b32 v[92:93], v52 offset0:32 offset1:33
  ds_read2_b32 v[94:95], v52 offset0:34 offset1:35
  s_waitcnt lgkmcnt(6)
  v_mfma_f32_16x16x32_bf16 v[64:67], v[96:99], a[24:27], v[64:67]
  v_mfma_f32_16x16x32_bf16 v[68:71], v[96:99], a[56:59], v[68:71]
  v_mfma_f32_16x16x32_bf16 v[72:75], v[96:99], a[88:91], v[72:75]
  v_mfma_f32_16x16x32_bf16 v[76:79], v[96:99], a[120:123], v[76:79]
  v_mfma_f32_16x16x32_bf16 v[80:83], v[96:99], a[152:155], v[80:83]
  v_mfma_f32_16x16x32_bf16 v[84:87], v[96:99], a[184:187], v[84:87]
  v_mfma_f32_16x16x32_bf16 v[88:91], v[96:99], a[216:219], v[88:91]
  ds_read2_b32 v[96:97], v52 offset0:16 offset1:17
  ds_read2_b32 v[98:99], v52 offset0:18 offset1:19
  s_waitcnt lgkmcnt(6)
  v_mfma_f32_16x16x32_bf16 v[64:67], v[100:103], a[20:23], v[64:67]
  v_mfma_f32_16x16x32_bf16 v[68:71], v[100:103], a[52:55], v[68:71]
  v_mfma_f32_16x16x32_bf16 v[72:75], v[100:103], a[84:87], v[72:75]
  v_mfma_f32_16x16x32_bf16 v[76:79], v[100:103], a[116:119], v[76:79]
  v_mfma_f32_16x16x32_bf16 v[80:83], v[100:103], a[148:151], v[80:83]
  v_mfma_f32_16x16x32_bf16 v[84:87], v[100:103], a[180:183], v[84:87]
  v_mfma_f32_16x16x32_bf16 v[88:91], v[100:103], a[212:215], v[88:91]
  ds_read2_b32 v[100:101], v52 offset0:0 offset1:1
  ds_read2_b32 v[102:103], v52 offset0:2 offset1:3
  s_waitcnt lgkmcnt(6)
  v_mfma_f32_16x16x32_bf16 v[64:67], v[104:107], a[16:19], v[64:67]
  v_mfma_f32_16x16x32_bf16 v[68:71], v[104:107], a[48:51], v[68:71]
  v_mfma_f32_16x16x32_bf16 v[72:75], v[104:107], a[80:83], v[72:75]
  v_mfma_f32_16x16x32_bf16 v[76:79], v[104:107], a[112:115], v[76:79]
  v_mfma_f32_16x16x32_bf16 v[80:83], v[104:107], a[144:147], v[80:83]
  v_mfma_f32_16x16x32_bf16 v[84:87], v[104:107], a[176:179], v[84:87]
  v_mfma_f32_16x16x32_bf16 v[88:91], v[104:107], a[208:211], v[88:91]
  ds_read2_b32 v[104:105], v53 offset0:224 offset1:225
  ds_read2_b32 v[106:107], v53 offset0:226 offset1:227
  s_waitcnt lgkmcnt(6)
  v_mfma_f32_16x16x32_bf16 v[64:67], v[92:95], a[12:15], v[64:67]
  v_mfma_f32_16x16x32_bf16 v[68:71], v[92:95], a[44:47], v[68:71]
  v_mfma_f32_16x16x32_bf16 v[72:75], v[92:95], a[76:79], v[72:75]
  v_mfma_f32_16x16x32_bf16 v[76:79], v[92:95], a[108:111], v[76:79]
  v_mfma_f32_16x16x32_bf16 v[80:83], v[92:95], a[140:143], v[80:83]
  v_mfma_f32_16x16x32_bf16 v[84:87], v[92:95], a[172:175], v[84:87]
  v_mfma_f32_16x16x32_bf16 v[88:91], v[92:95], a[204:207], v[88:91]
  ds_read2_b32 v[92:93], v53 offset0:208 offset1:209
  ds_read2_b32 v[94:95], v53 offset0:210 offset1:211
  s_waitcnt lgkmcnt(6)
  v_mfma_f32_16x16x32_bf16 v[64:67], v[96:99], a[8:11], v[64:67]
  v_mfma_f32_16x16x32_bf16 v[68:71], v[96:99], a[40:43], v[68:71]
  v_mfma_f32_16x16x32_bf16 v[72:75], v[96:99], a[72:75], v[72:75]
  v_mfma_f32_16x16x32_bf16 v[76:79], v[96:99], a[104:107], v[76:79]
  v_mfma_f32_16x16x32_bf16 v[80:83], v[96:99], a[136:139], v[80:83]
  v_mfma_f32_16x16x32_bf16 v[84:87], v[96:99], a[168:171], v[84:87]
  v_mfma_f32_16x16x32_bf16 v[88:91], v[96:99], a[200:203], v[88:91]
  ds_read2_b32 v[96:97], v53 offset0:192 offset1:193
  ds_read2_b32 v[98:99], v53 offset0:194 offset1:195
  s_waitcnt lgkmcnt(6)
  v_mfma_f32_16x16x32_bf16 v[64:67], v[100:103], a[4:7], v[64:67]
  v_mfma_f32_16x16x32_bf16 v[68:71], v[100:103], a[36:39], v[68:71]
  v_mfma_f32_16x16x32_bf16 v[72:75], v[100:103], a[68:71], v[72:75]
  v_mfma_f32_16x16x32_bf16 v[76:79], v[100:103], a[100:103], v[76:79]
  v_mfma_f32_16x16x32_bf16 v[80:83], v[100:103], a[132:135], v[80:83]
  v_mfma_f32_16x16x32_bf16 v[84:87], v[100:103], a[164:167], v[84:87]
  v_mfma_f32_16x16x32_bf16 v[88:91], v[100:103], a[196:199], v[88:91]
  ds_read2_b32 v[100:101], v53 offset0:176 offset1:177
  ds_read2_b32 v[102:103], v53 offset0:178 offset1:179
  s_waitcnt lgkmcnt(6)
  v_mfma_f32_16x16x32_bf16 v[64:67], v[104:107], a[0:3], v[64:67]
  v_mfma_f32_16x16x32_bf16 v[68:71], v[104:107], a[32:35], v[68:71]
  v_mfma_f32_16x16x32_bf16 v[72:75], v[104:107], a[64:67], v[72:75]
  v_mfma_f32_16x16x32_bf16 v[76:79], v[104:107], a[96:99], v[76:79]
  v_mfma_f32_16x16x32_bf16 v[80:83], v[104:107], a[128:131], v[80:83]
  v_mfma_f32_16x16x32_bf16 v[84:87], v[104:107], a[160:163], v[84:87]
  v_mfma_f32_16x16x32_bf16 v[88:91], v[104:107], a[192:195], v[88:91]
  ds_read2_b32 v[104:105], v53 offset0:160 offset1:161
  ds_read2_b32 v[106:107], v53 offset0:162 offset1:163
  s_waitcnt lgkmcnt(6)
  v_mfma_f32_16x16x32_bf16 v[68:71], v[92:95], a[28:31], v[68:71]
  v_mfma_f32_16x16x32_bf16 v[72:75], v[92:95], a[60:63], v[72:75]
  v_mfma_f32_16x16x32_bf16 v[76:79], v[92:95], a[92:95], v[76:79]
  v_mfma_f32_16x16x32_bf16 v[80:83], v[92:95], a[124:127], v[80:83]
  v_mfma_f32_16x16x32_bf16 v[84:87], v[92:95], a[156:159], v[84:87]
  v_mfma_f32_16x16x32_bf16 v[88:91], v[92:95], a[188:191], v[88:91]
  ds_read2_b32 v[92:93], v53 offset0:144 offset1:145
  ds_read2_b32 v[94:95], v53 offset0:146 offset1:147
  s_waitcnt lgkmcnt(6)
  v_mfma_f32_16x16x32_bf16 v[68:71], v[96:99], a[24:27], v[68:71]
  v_mfma_f32_16x16x32_bf16 v[72:75], v[96:99], a[56:59], v[72:75]
  v_mfma_f32_16x16x32_bf16 v[76:79], v[96:99], a[88:91], v[76:79]
  v_mfma_f32_16x16x32_bf16 v[80:83], v[96:99], a[120:123], v[80:83]
  v_mfma_f32_16x16x32_bf16 v[84:87], v[96:99], a[152:155], v[84:87]
  v_mfma_f32_16x16x32_bf16 v[88:91], v[96:99], a[184:187], v[88:91]
  ds_read2_b32 v[96:97], v53 offset0:128 offset1:129
  ds_read2_b32 v[98:99], v53 offset0:130 offset1:131
  s_waitcnt lgkmcnt(6)
  v_mfma_f32_16x16x32_bf16 v[68:71], v[100:103], a[20:23], v[68:71]
  v_mfma_f32_16x16x32_bf16 v[72:75], v[100:103], a[52:55], v[72:75]
  v_mfma_f32_16x16x32_bf16 v[76:79], v[100:103], a[84:87], v[76:79]
  v_mfma_f32_16x16x32_bf16 v[80:83], v[100:103], a[116:119], v[80:83]
  v_mfma_f32_16x16x32_bf16 v[84:87], v[100:103], a[148:151], v[84:87]
  v_mfma_f32_16x16x32_bf16 v[88:91], v[100:103], a[180:183], v[88:91]
  ds_read2_b32 v[100:101], v53 offset0:112 offset1:113
  ds_read2_b32 v[102:103], v53 offset0:114 offset1:115
  s_waitcnt lgkmcnt(6)
  v_mfma_f32_16x16x32_bf16 v[68:71], v[104:107], a[16:19], v[68:71]
  v_mfma_f32_16x16x32_bf16 v[72:75], v[104:107], a[48:51], v[72:75]
  v_mfma_f32_16x16x32_bf16 v[76:79], v[104:107], a[80:83], v[76:79]
  v_mfma_f32_16x16x32_bf16 v[80:83], v[104:107], a[112:115], v[80:83]
  v_mfma_f32_16x16x32_bf16 v[84:87], v[104:107], a[144:147], v[84:87]
  v_mfma_f32_16x16x32_bf16 v[88:91], v[104:107], a[176:179], v[88:91]
  ds_read2_b32 v[104:105], v53 offset0:96 offset1:97
  ds_read2_b32 v[106:107], v53 offset0:98 offset1:99
  s_waitcnt lgkmcnt(6)
  v_mfma_f32_16x16x32_bf16 v[68:71], v[92:95], a[12:15], v[68:71]
  v_mfma_f32_16x16x32_bf16 v[72:75], v[92:95], a[44:47], v[72:75]
  v_mfma_f32_16x16x32_bf16 v[76:79], v[92:95], a[76:79], v[76:79]
  v_mfma_f32_16x16x32_bf16 v[80:83], v[92:95], a[108:111], v[80:83]
  v_mfma_f32_16x16x32_bf16 v[84:87], v[92:95], a[140:143], v[84:87]
  v_mfma_f32_16x16x32_bf16 v[88:91], v[92:95], a[172:175], v[88:91]
  ds_read2_b32 v[92:93], v53 offset0:80 offset1:81
  ds_read2_b32 v[94:95], v53 offset0:82 offset1:83
  s_waitcnt lgkmcnt(6)
  v_mfma_f32_16x16x32_bf16 v[68:71], v[96:99], a[8:11], v[68:71]
  v_mfma_f32_16x16x32_bf16 v[72:75], v[96:99], a[40:43], v[72:75]
  v_mfma_f32_16x16x32_bf16 v[76:79], v[96:99], a[72:75], v[76:79]
  v_mfma_f32_16x16x32_bf16 v[80:83], v[96:99], a[104:107], v[80:83]
  v_mfma_f32_16x16x32_bf16 v[84:87], v[96:99], a[136:139], v[84:87]
  v_mfma_f32_16x16x32_bf16 v[88:91], v[96:99], a[168:171], v[88:91]
  ds_read2_b32 v[96:97], v53 offset0:64 offset1:65
  ds_read2_b32 v[98:99], v53 offset0:66 offset1:67
  s_waitcnt lgkmcnt(6)
  v_mfma_f32_16x16x32_bf16 v[68:71], v[100:103], a[4:7], v[68:71]
  v_mfma_f32_16x16x32_bf16 v[72:75], v[100:103], a[36:39], v[72:75]
  v_mfma_f32_16x16x32_bf16 v[76:79], v[100:103], a[68:71], v[76:79]
  v_mfma_f32_16x16x32_bf16 v[80:83], v[100:103], a[100:103], v[80:83]
  v_mfma_f32_16x16x32_bf16 v[84:87], v[100:103], a[132:135], v[84:87]
  v_mfma_f32_16x16x32_bf16 v[88:91], v[100:103], a[164:167], v[88:91]
  ds_read2_b32 v[100:101], v53 offset0:48 offset1:49
  ds_read2_b32 v[102:103], v53 offset0:50 offset1:51
  s_waitcnt lgkmcnt(6)
  v_mfma_f32_16x16x32_bf16 v[68:71], v[104:107], a[0:3], v[68:71]
  v_mfma_f32_16x16x32_bf16 v[72:75], v[104:107], a[32:35], v[72:75]
  v_mfma_f32_16x16x32_bf16 v[76:79], v[104:107], a[64:67], v[76:79]
  v_mfma_f32_16x16x32_bf16 v[80:83], v[104:107], a[96:99], v[80:83]
  v_mfma_f32_16x16x32_bf16 v[84:87], v[104:107], a[128:131], v[84:87]
  v_mfma_f32_16x16x32_bf16 v[88:91], v[104:107], a[160:163], v[88:91]
  ds_read2_b32 v[104:105], v53 offset0:32 offset1:33
  ds_read2_b32 v[106:107], v53 offset0:34 offset1:35
  s_waitcnt lgkmcnt(6)
  v_mfma_f32_16x16x32_bf16 v[72:75], v[92:95], a[28:31], v[72:75]
  v_mfma_f32_16x16x32_bf16 v[76:79], v[92:95], a[60:63], v[76:79]
  v_mfma_f32_16x16x32_bf16 v[80:83], v[92:95], a[92:95], v[80:83]
  v_mfma_f32_16x16x32_bf16 v[84:87], v[92:95], a[124:127], v[84:87]
  v_mfma_f32_16x16x32_bf16 v[88:91], v[92:95], a[156:159], v[88:91]
  ds_read2_b32 v[92:93], v53 offset0:16 offset1:17
  ds_read2_b32 v[94:95], v53 offset0:18 offset1:19
  s_waitcnt lgkmcnt(6)
  v_mfma_f32_16x16x32_bf16 v[72:75], v[96:99], a[24:27], v[72:75]
  v_mfma_f32_16x16x32_bf16 v[76:79], v[96:99], a[56:59], v[76:79]
  v_mfma_f32_16x16x32_bf16 v[80:83], v[96:99], a[88:91], v[80:83]
  v_mfma_f32_16x16x32_bf16 v[84:87], v[96:99], a[120:123], v[84:87]
  v_mfma_f32_16x16x32_bf16 v[88:91], v[96:99], a[152:155], v[88:91]
  ds_read2_b32 v[96:97], v53 offset0:0 offset1:1
  ds_read2_b32 v[98:99], v53 offset0:2 offset1:3
  s_waitcnt lgkmcnt(6)
  v_mfma_f32_16x16x32_bf16 v[72:75], v[100:103], a[20:23], v[72:75]
  v_mfma_f32_16x16x32_bf16 v[76:79], v[100:103], a[52:55], v[76:79]
  v_mfma_f32_16x16x32_bf16 v[80:83], v[100:103], a[84:87], v[80:83]
  v_mfma_f32_16x16x32_bf16 v[84:87], v[100:103], a[116:119], v[84:87]
  v_mfma_f32_16x16x32_bf16 v[88:91], v[100:103], a[148:151], v[88:91]
  ds_read2_b32 v[100:101], v54 offset0:224 offset1:225
  ds_read2_b32 v[102:103], v54 offset0:226 offset1:227
  s_waitcnt lgkmcnt(6)
  v_mfma_f32_16x16x32_bf16 v[72:75], v[104:107], a[16:19], v[72:75]
  v_mfma_f32_16x16x32_bf16 v[76:79], v[104:107], a[48:51], v[76:79]
  v_mfma_f32_16x16x32_bf16 v[80:83], v[104:107], a[80:83], v[80:83]
  v_mfma_f32_16x16x32_bf16 v[84:87], v[104:107], a[112:115], v[84:87]
  v_mfma_f32_16x16x32_bf16 v[88:91], v[104:107], a[144:147], v[88:91]
  ds_read2_b32 v[104:105], v54 offset0:208 offset1:209
  ds_read2_b32 v[106:107], v54 offset0:210 offset1:211
  s_waitcnt lgkmcnt(6)
  v_mfma_f32_16x16x32_bf16 v[72:75], v[92:95], a[12:15], v[72:75]
  v_mfma_f32_16x16x32_bf16 v[76:79], v[92:95], a[44:47], v[76:79]
  v_mfma_f32_16x16x32_bf16 v[80:83], v[92:95], a[76:79], v[80:83]
  v_mfma_f32_16x16x32_bf16 v[84:87], v[92:95], a[108:111], v[84:87]
  v_mfma_f32_16x16x32_bf16 v[88:91], v[92:95], a[140:143], v[88:91]
  ds_read2_b32 v[92:93], v54 offset0:192 offset1:193
  ds_read2_b32 v[94:95], v54 offset0:194 offset1:195
  s_waitcnt lgkmcnt(6)
  v_mfma_f32_16x16x32_bf16 v[72:75], v[96:99], a[8:11], v[72:75]
  v_mfma_f32_16x16x32_bf16 v[76:79], v[96:99], a[40:43], v[76:79]
  v_mfma_f32_16x16x32_bf16 v[80:83], v[96:99], a[72:75], v[80:83]
  v_mfma_f32_16x16x32_bf16 v[84:87], v[96:99], a[104:107], v[84:87]
  v_mfma_f32_16x16x32_bf16 v[88:91], v[96:99], a[136:139], v[88:91]
  ds_read2_b32 v[96:97], v54 offset0:176 offset1:177
  ds_read2_b32 v[98:99], v54 offset0:178 offset1:179
  s_waitcnt lgkmcnt(6)
  v_mfma_f32_16x16x32_bf16 v[72:75], v[100:103], a[4:7], v[72:75]
  v_mfma_f32_16x16x32_bf16 v[76:79], v[100:103], a[36:39], v[76:79]
  v_mfma_f32_16x16x32_bf16 v[80:83], v[100:103], a[68:71], v[80:83]
  v_mfma_f32_16x16x32_bf16 v[84:87], v[100:103], a[100:103], v[84:87]
  v_mfma_f32_16x16x32_bf16 v[88:91], v[100:103], a[132:135], v[88:91]
  ds_read2_b32 v[100:101], v54 offset0:160 offset1:161
  ds_read2_b32 v[102:103], v54 offset0:162 offset1:163
  s_waitcnt lgkmcnt(6)
  v_mfma_f32_16x16x32_bf16 v[72:75], v[104:107], a[0:3], v[72:75]
  v_mfma_f32_16x16x32_bf16 v[76:79], v[104:107], a[32:35], v[76:79]
  v_mfma_f32_16x16x32_bf16 v[80:83], v[104:107], a[64:67], v[80:83]
  v_mfma_f32_16x16x32_bf16 v[84:87], v[104:107], a[96:99], v[84:87]
  v_mfma_f32_16x16x32_bf16 v[88:91], v[104:107], a[128:131], v[88:91]
  ds_read2_b32 v[104:105], v54 offset0:144 offset1:145
  ds_read2_b32 v[106:107], v54 offset0:146 offset1:147
  s_waitcnt lgkmcnt(6)
  v_mfma_f32_16x16x32_bf16 v[76:79], v[92:95], a[28:31], v[76:79]
  v_mfma_f32_16x16x32_bf16 v[80:83], v[92:95], a[60:63], v[80:83]
  v_mfma_f32_16x16x32_bf16 v[84:87], v[92:95], a[92:95], v[84:87]
  v_mfma_f32_16x16x32_bf16 v[88:91], v[92:95], a[124:127], v[88:91]
  ds_read2_b32 v[92:93], v54 offset0:128 offset1:129
  ds_read2_b32 v[94:95], v54 offset0:130 offset1:131
  s_waitcnt lgkmcnt(6)
  v_mfma_f32_16x16x32_bf16 v[76:79], v[96:99], a[24:27], v[76:79]
  v_mfma_f32_16x16x32_bf16 v[80:83], v[96:99], a[56:59], v[80:83]
  v_mfma_f32_16x16x32_bf16 v[84:87], v[96:99], a[88:91], v[84:87]
  v_mfma_f32_16x16x32_bf16 v[88:91], v[96:99], a[120:123], v[88:91]
  ds_read2_b32 v[96:97], v54 offset0:112 offset1:113
  ds_read2_b32 v[98:99], v54 offset0:114 offset1:115
  s_waitcnt lgkmcnt(6)
  v_mfma_f32_16x16x32_bf16 v[76:79], v[100:103], a[20:23], v[76:79]
  v_mfma_f32_16x16x32_bf16 v[80:83], v[100:103], a[52:55], v[80:83]
  v_mfma_f32_16x16x32_bf16 v[84:87], v[100:103], a[84:87], v[84:87]
  v_mfma_f32_16x16x32_bf16 v[88:91], v[100:103], a[116:119], v[88:91]
  ds_read2_b32 v[100:101], v54 offset0:96 offset1:97
  ds_read2_b32 v[102:103], v54 offset0:98 offset1:99
  s_waitcnt lgkmcnt(6)
  v_mfma_f32_16x16x32_bf16 v[76:79], v[104:107], a[16:19], v[76:79]
  v_mfma_f32_16x16x32_bf16 v[80:83], v[104:107], a[48:51], v[80:83]
  v_mfma_f32_16x16x32_bf16 v[84:87], v[104:107], a[80:83], v[84:87]
  v_mfma_f32_16x16x32_bf16 v[88:91], v[104:107], a[112:115], v[88:91]
  ds_read2_b32 v[104:105], v54 offset0:80 offset1:81
  ds_read2_b32 v[106:107], v54 offset0:82 offset1:83
  s_waitcnt lgkmcnt(6)
  v_mfma_f32_16x16x32_bf16 v[76:79], v[92:95], a[12:15], v[76:79]
  v_mfma_f32_16x16x32_bf16 v[80:83], v[92:95], a[44:47], v[80:83]
  v_mfma_f32_16x16x32_bf16 v[84:87], v[92:95], a[76:79], v[84:87]
  v_mfma_f32_16x16x32_bf16 v[88:91], v[92:95], a[108:111], v[88:91]
  ds_read2_b32 v[92:93], v54 offset0:64 offset1:65
  ds_read2_b32 v[94:95], v54 offset0:66 offset1:67
  s_waitcnt lgkmcnt(6)
  v_mfma_f32_16x16x32_bf16 v[76:79], v[96:99], a[8:11], v[76:79]
  v_mfma_f32_16x16x32_bf16 v[80:83], v[96:99], a[40:43], v[80:83]
  v_mfma_f32_16x16x32_bf16 v[84:87], v[96:99], a[72:75], v[84:87]
  v_mfma_f32_16x16x32_bf16 v[88:91], v[96:99], a[104:107], v[88:91]
  ds_read2_b32 v[96:97], v54 offset0:48 offset1:49
  ds_read2_b32 v[98:99], v54 offset0:50 offset1:51
  s_waitcnt lgkmcnt(6)
  v_mfma_f32_16x16x32_bf16 v[76:79], v[100:103], a[4:7], v[76:79]
  v_mfma_f32_16x16x32_bf16 v[80:83], v[100:103], a[36:39], v[80:83]
  v_mfma_f32_16x16x32_bf16 v[84:87], v[100:103], a[68:71], v[84:87]
  v_mfma_f32_16x16x32_bf16 v[88:91], v[100:103], a[100:103], v[88:91]
  ds_read2_b32 v[100:101], v54 offset0:32 offset1:33
  ds_read2_b32 v[102:103], v54 offset0:34 offset1:35
  s_waitcnt lgkmcnt(6)
  v_mfma_f32_16x16x32_bf16 v[76:79], v[104:107], a[0:3], v[76:79]
  v_mfma_f32_16x16x32_bf16 v[80:83], v[104:107], a[32:35], v[80:83]
  v_mfma_f32_16x16x32_bf16 v[84:87], v[104:107], a[64:67], v[84:87]
  v_mfma_f32_16x16x32_bf16 v[88:91], v[104:107], a[96:99], v[88:91]
  ds_read2_b32 v[104:105], v54 offset0:16 offset1:17
  ds_read2_b32 v[106:107], v54 offset0:18 offset1:19
  s_waitcnt lgkmcnt(6)
  v_mfma_f32_16x16x32_bf16 v[80:83], v[92:95], a[28:31], v[80:83]
  v_mfma_f32_16x16x32_bf16 v[84:87], v[92:95], a[60:63], v[84:87]
  v_mfma_f32_16x16x32_bf16 v[88:91], v[92:95], a[92:95], v[88:91]
  ds_read2_b32 v[92:93], v54 offset0:0 offset1:1
  ds_read2_b32 v[94:95], v54 offset0:2 offset1:3
  s_waitcnt lgkmcnt(6)
  v_mfma_f32_16x16x32_bf16 v[80:83], v[96:99], a[24:27], v[80:83]
  v_mfma_f32_16x16x32_bf16 v[84:87], v[96:99], a[56:59], v[84:87]
  v_mfma_f32_16x16x32_bf16 v[88:91], v[96:99], a[88:91], v[88:91]
  ds_read2_b32 v[96:97], v55 offset0:224 offset1:225
  ds_read2_b32 v[98:99], v55 offset0:226 offset1:227
  s_waitcnt lgkmcnt(6)
  v_mfma_f32_16x16x32_bf16 v[80:83], v[100:103], a[20:23], v[80:83]
  v_mfma_f32_16x16x32_bf16 v[84:87], v[100:103], a[52:55], v[84:87]
  v_mfma_f32_16x16x32_bf16 v[88:91], v[100:103], a[84:87], v[88:91]
  ds_read2_b32 v[100:101], v55 offset0:208 offset1:209
  ds_read2_b32 v[102:103], v55 offset0:210 offset1:211
  s_waitcnt lgkmcnt(6)
  v_mfma_f32_16x16x32_bf16 v[80:83], v[104:107], a[16:19], v[80:83]
  v_mfma_f32_16x16x32_bf16 v[84:87], v[104:107], a[48:51], v[84:87]
  v_mfma_f32_16x16x32_bf16 v[88:91], v[104:107], a[80:83], v[88:91]
  ds_read2_b32 v[104:105], v55 offset0:192 offset1:193
  ds_read2_b32 v[106:107], v55 offset0:194 offset1:195
  s_waitcnt lgkmcnt(6)
  v_mfma_f32_16x16x32_bf16 v[80:83], v[92:95], a[12:15], v[80:83]
  v_mfma_f32_16x16x32_bf16 v[84:87], v[92:95], a[44:47], v[84:87]
  v_mfma_f32_16x16x32_bf16 v[88:91], v[92:95], a[76:79], v[88:91]
  ds_read2_b32 v[92:93], v55 offset0:176 offset1:177
  ds_read2_b32 v[94:95], v55 offset0:178 offset1:179
  s_waitcnt lgkmcnt(6)
  v_mfma_f32_16x16x32_bf16 v[80:83], v[96:99], a[8:11], v[80:83]
  v_mfma_f32_16x16x32_bf16 v[84:87], v[96:99], a[40:43], v[84:87]
  v_mfma_f32_16x16x32_bf16 v[88:91], v[96:99], a[72:75], v[88:91]
  ds_read2_b32 v[96:97], v55 offset0:160 offset1:161
  ds_read2_b32 v[98:99], v55 offset0:162 offset1:163
  s_waitcnt lgkmcnt(6)
  v_mfma_f32_16x16x32_bf16 v[80:83], v[100:103], a[4:7], v[80:83]
  v_mfma_f32_16x16x32_bf16 v[84:87], v[100:103], a[36:39], v[84:87]
  v_mfma_f32_16x16x32_bf16 v[88:91], v[100:103], a[68:71], v[88:91]
  ds_read2_b32 v[100:101], v55 offset0:144 offset1:145
  ds_read2_b32 v[102:103], v55 offset0:146 offset1:147
  s_waitcnt lgkmcnt(6)
  v_mfma_f32_16x16x32_bf16 v[80:83], v[104:107], a[0:3], v[80:83]
  v_mfma_f32_16x16x32_bf16 v[84:87], v[104:107], a[32:35], v[84:87]
  v_mfma_f32_16x16x32_bf16 v[88:91], v[104:107], a[64:67], v[88:91]
  ds_read2_b32 v[104:105], v55 offset0:128 offset1:129
  ds_read2_b32 v[106:107], v55 offset0:130 offset1:131
  s_waitcnt lgkmcnt(6)
  v_mfma_f32_16x16x32_bf16 v[84:87], v[92:95], a[28:31], v[84:87]
  v_mfma_f32_16x16x32_bf16 v[88:91], v[92:95], a[60:63], v[88:91]
  ds_read2_b32 v[92:93], v55 offset0:112 offset1:113
  ds_read2_b32 v[94:95], v55 offset0:114 offset1:115
  s_waitcnt lgkmcnt(6)
  v_mfma_f32_16x16x32_bf16 v[84:87], v[96:99], a[24:27], v[84:87]
  v_mfma_f32_16x16x32_bf16 v[88:91], v[96:99], a[56:59], v[88:91]
  ds_read2_b32 v[96:97], v55 offset0:96 offset1:97
  ds_read2_b32 v[98:99], v55 offset0:98 offset1:99
  s_waitcnt lgkmcnt(6)
  v_mfma_f32_16x16x32_bf16 v[84:87], v[100:103], a[20:23], v[84:87]
  v_mfma_f32_16x16x32_bf16 v[88:91], v[100:103], a[52:55], v[88:91]
  ds_read2_b32 v[100:101], v55 offset0:80 offset1:81
  ds_read2_b32 v[102:103], v55 offset0:82 offset1:83
  s_waitcnt lgkmcnt(6)
  v_mfma_f32_16x16x32_bf16 v[84:87], v[104:107], a[16:19], v[84:87]
  v_mfma_f32_16x16x32_bf16 v[88:91], v[104:107], a[48:51], v[88:91]
  ds_read2_b32 v[104:105], v55 offset0:64 offset1:65
  ds_read2_b32 v[106:107], v55 offset0:66 offset1:67
  s_waitcnt lgkmcnt(6)
  v_mfma_f32_16x16x32_bf16 v[84:87], v[92:95], a[12:15], v[84:87]
  v_mfma_f32_16x16x32_bf16 v[88:91], v[92:95], a[44:47], v[88:91]
  ds_read2_b32 v[92:93], v55 offset0:48 offset1:49
  ds_read2_b32 v[94:95], v55 offset0:50 offset1:51
  s_waitcnt lgkmcnt(6)
  v_mfma_f32_16x16x32_bf16 v[84:87], v[96:99], a[8:11], v[84:87]
  v_mfma_f32_16x16x32_bf16 v[88:91], v[96:99], a[40:43], v[88:91]
  ds_read2_b32 v[96:97], v55 offset0:32 offset1:33
  ds_read2_b32 v[98:99], v55 offset0:34 offset1:35
  s_waitcnt lgkmcnt(6)
  v_mfma_f32_16x16x32_bf16 v[84:87], v[100:103], a[4:7], v[84:87]
  v_mfma_f32_16x16x32_bf16 v[88:91], v[100:103], a[36:39], v[88:91]
  ds_read2_b32 v[100:101], v55 offset0:16 offset1:17
  ds_read2_b32 v[102:103], v55 offset0:18 offset1:19
  s_waitcnt lgkmcnt(6)
  v_mfma_f32_16x16x32_bf16 v[84:87], v[104:107], a[0:3], v[84:87]
  v_mfma_f32_16x16x32_bf16 v[88:91], v[104:107], a[32:35], v[88:91]
  ds_read2_b32 v[104:105], v55 offset0:0 offset1:1
  ds_read2_b32 v[106:107], v55 offset0:2 offset1:3
  s_waitcnt lgkmcnt(6)
  v_mfma_f32_16x16x32_bf16 v[88:91], v[92:95], a[28:31], v[88:91]
  ds_read2_b32 v[92:93], v56 offset0:224 offset1:225
  ds_read2_b32 v[94:95], v56 offset0:226 offset1:227
  s_waitcnt lgkmcnt(6)
  v_mfma_f32_16x16x32_bf16 v[88:91], v[96:99], a[24:27], v[88:91]
  ds_read2_b32 v[96:97], v56 offset0:208 offset1:209
  ds_read2_b32 v[98:99], v56 offset0:210 offset1:211
  s_waitcnt lgkmcnt(6)
  v_mfma_f32_16x16x32_bf16 v[88:91], v[100:103], a[20:23], v[88:91]
  ds_read2_b32 v[100:101], v56 offset0:192 offset1:193
  ds_read2_b32 v[102:103], v56 offset0:194 offset1:195
  s_waitcnt lgkmcnt(6)
  v_mfma_f32_16x16x32_bf16 v[88:91], v[104:107], a[16:19], v[88:91]
  ds_read2_b32 v[104:105], v56 offset0:176 offset1:177
  ds_read2_b32 v[106:107], v56 offset0:178 offset1:179
  s_waitcnt lgkmcnt(6)
  v_mfma_f32_16x16x32_bf16 v[88:91], v[92:95], a[12:15], v[88:91]
  s_waitcnt lgkmcnt(4)
  v_mfma_f32_16x16x32_bf16 v[88:91], v[96:99], a[8:11], v[88:91]
  s_waitcnt lgkmcnt(2)
  v_mfma_f32_16x16x32_bf16 v[88:91], v[100:103], a[4:7], v[88:91]
  s_waitcnt lgkmcnt(0)
  v_mfma_f32_16x16x32_bf16 v[88:91], v[104:107], a[0:3], v[88:91]
  v_lshlrev_b32 v46, 5, v4
  v_lshl_add_u32 v46, v3, 3, v46
  v_add_u32 v46, s17, v46
  ds_read_b64 v[108:109], v46 offset:512
  ds_read_b64 v[110:111], v46 offset:1024
  ds_read_b64 v[112:113], v46 offset:1536
  ds_read_b64 v[114:115], v46 offset:2048
  ds_read_b64 v[116:117], v46 offset:2560
  ds_read_b64 v[118:119], v46 offset:3072
  ds_read_b64 v[120:121], v46 offset:3584
  ds_read_b64 v[122:123], v46 offset:4096
  s_waitcnt lgkmcnt(0)
  v_lshlrev_b32 v124, 16, v108
  v_and_b32 v125, 0xffff0000, v108
  v_lshlrev_b32 v126, 16, v109
  v_and_b32 v127, 0xffff0000, v109
  v_mul_f32 v124, v124, v33
  v_mul_f32 v125, v125, v33
  v_mul_f32 v126, v126, v33
  v_mul_f32 v127, v127, v33
  v_cvt_pk_bf16_f32 v128, v124, v125
  v_cvt_pk_bf16_f32 v129, v126, v127
  v_cvt_pk_bf16_f32 v130, v60, v61
  v_cvt_pk_bf16_f32 v131, v62, v63
  v_lshlrev_b32 v124, 16, v128
  v_and_b32 v125, 0xffff0000, v128
  v_lshlrev_b32 v132, 16, v130
  v_and_b32 v133, 0xffff0000, v130
  v_lshlrev_b32 v126, 16, v129
  v_and_b32 v127, 0xffff0000, v129
  v_lshlrev_b32 v134, 16, v131
  v_and_b32 v135, 0xffff0000, v131
  v_add_f32 v124, v124, v132
  v_add_f32 v125, v125, v133
  v_add_f32 v126, v126, v134
  v_add_f32 v127, v127, v135
  v_cvt_pk_bf16_f32 v108, v124, v125
  v_cvt_pk_bf16_f32 v109, v126, v127
  ds_write_b64 v46, v[108:109] offset:512
  v_lshlrev_b32 v124, 16, v110
  v_and_b32 v125, 0xffff0000, v110
  v_lshlrev_b32 v126, 16, v111
  v_and_b32 v127, 0xffff0000, v111
  v_mul_f32 v124, v124, v33
  v_mul_f32 v125, v125, v33
  v_mul_f32 v126, v126, v33
  v_mul_f32 v127, v127, v33
  v_cvt_pk_bf16_f32 v128, v124, v125
  v_cvt_pk_bf16_f32 v129, v126, v127
  v_cvt_pk_bf16_f32 v130, v64, v65
  v_cvt_pk_bf16_f32 v131, v66, v67
  v_lshlrev_b32 v124, 16, v128
  v_and_b32 v125, 0xffff0000, v128
  v_lshlrev_b32 v132, 16, v130
  v_and_b32 v133, 0xffff0000, v130
  v_lshlrev_b32 v126, 16, v129
  v_and_b32 v127, 0xffff0000, v129
  v_lshlrev_b32 v134, 16, v131
  v_and_b32 v135, 0xffff0000, v131
  v_add_f32 v124, v124, v132
  v_add_f32 v125, v125, v133
  v_add_f32 v126, v126, v134
  v_add_f32 v127, v127, v135
  v_cvt_pk_bf16_f32 v110, v124, v125
  v_cvt_pk_bf16_f32 v111, v126, v127
  ds_write_b64 v46, v[110:111] offset:1024
  v_lshlrev_b32 v124, 16, v112
  v_and_b32 v125, 0xffff0000, v112
  v_lshlrev_b32 v126, 16, v113
  v_and_b32 v127, 0xffff0000, v113
  v_mul_f32 v124, v124, v33
  v_mul_f32 v125, v125, v33
  v_mul_f32 v126, v126, v33
  v_mul_f32 v127, v127, v33
  v_cvt_pk_bf16_f32 v128, v124, v125
  v_cvt_pk_bf16_f32 v129, v126, v127
  v_cvt_pk_bf16_f32 v130, v68, v69
  v_cvt_pk_bf16_f32 v131, v70, v71
  v_lshlrev_b32 v124, 16, v128
  v_and_b32 v125, 0xffff0000, v128
  v_lshlrev_b32 v132, 16, v130
  v_and_b32 v133, 0xffff0000, v130
  v_lshlrev_b32 v126, 16, v129
  v_and_b32 v127, 0xffff0000, v129
  v_lshlrev_b32 v134, 16, v131
  v_and_b32 v135, 0xffff0000, v131
  v_add_f32 v124, v124, v132
  v_add_f32 v125, v125, v133
  v_add_f32 v126, v126, v134
  v_add_f32 v127, v127, v135
  v_cvt_pk_bf16_f32 v112, v124, v125
  v_cvt_pk_bf16_f32 v113, v126, v127
  ds_write_b64 v46, v[112:113] offset:1536
  v_lshlrev_b32 v124, 16, v114
  v_and_b32 v125, 0xffff0000, v114
  v_lshlrev_b32 v126, 16, v115
  v_and_b32 v127, 0xffff0000, v115
  v_mul_f32 v124, v124, v33
  v_mul_f32 v125, v125, v33
  v_mul_f32 v126, v126, v33
  v_mul_f32 v127, v127, v33
  v_cvt_pk_bf16_f32 v128, v124, v125
  v_cvt_pk_bf16_f32 v129, v126, v127
  v_cvt_pk_bf16_f32 v130, v72, v73
  v_cvt_pk_bf16_f32 v131, v74, v75
  v_lshlrev_b32 v124, 16, v128
  v_and_b32 v125, 0xffff0000, v128
  v_lshlrev_b32 v132, 16, v130
  v_and_b32 v133, 0xffff0000, v130
  v_lshlrev_b32 v126, 16, v129
  v_and_b32 v127, 0xffff0000, v129
  v_lshlrev_b32 v134, 16, v131
  v_and_b32 v135, 0xffff0000, v131
  v_add_f32 v124, v124, v132
  v_add_f32 v125, v125, v133
  v_add_f32 v126, v126, v134
  v_add_f32 v127, v127, v135
  v_cvt_pk_bf16_f32 v114, v124, v125
  v_cvt_pk_bf16_f32 v115, v126, v127
  ds_write_b64 v46, v[114:115] offset:2048
  v_lshlrev_b32 v124, 16, v116
  v_and_b32 v125, 0xffff0000, v116
  v_lshlrev_b32 v126, 16, v117
  v_and_b32 v127, 0xffff0000, v117
  v_mul_f32 v124, v124, v33
  v_mul_f32 v125, v125, v33
  v_mul_f32 v126, v126, v33
  v_mul_f32 v127, v127, v33
  v_cvt_pk_bf16_f32 v128, v124, v125
  v_cvt_pk_bf16_f32 v129, v126, v127
  v_cvt_pk_bf16_f32 v130, v76, v77
  v_cvt_pk_bf16_f32 v131, v78, v79
  v_lshlrev_b32 v124, 16, v128
  v_and_b32 v125, 0xffff0000, v128
  v_lshlrev_b32 v132, 16, v130
  v_and_b32 v133, 0xffff0000, v130
  v_lshlrev_b32 v126, 16, v129
  v_and_b32 v127, 0xffff0000, v129
  v_lshlrev_b32 v134, 16, v131
  v_and_b32 v135, 0xffff0000, v131
  v_add_f32 v124, v124, v132
  v_add_f32 v125, v125, v133
  v_add_f32 v126, v126, v134
  v_add_f32 v127, v127, v135
  v_cvt_pk_bf16_f32 v116, v124, v125
  v_cvt_pk_bf16_f32 v117, v126, v127
  ds_write_b64 v46, v[116:117] offset:2560
  v_lshlrev_b32 v124, 16, v118
  v_and_b32 v125, 0xffff0000, v118
  v_lshlrev_b32 v126, 16, v119
  v_and_b32 v127, 0xffff0000, v119
  v_mul_f32 v124, v124, v33
  v_mul_f32 v125, v125, v33
  v_mul_f32 v126, v126, v33
  v_mul_f32 v127, v127, v33
  v_cvt_pk_bf16_f32 v128, v124, v125
  v_cvt_pk_bf16_f32 v129, v126, v127
  v_cvt_pk_bf16_f32 v130, v80, v81
  v_cvt_pk_bf16_f32 v131, v82, v83
  v_lshlrev_b32 v124, 16, v128
  v_and_b32 v125, 0xffff0000, v128
  v_lshlrev_b32 v132, 16, v130
  v_and_b32 v133, 0xffff0000, v130
  v_lshlrev_b32 v126, 16, v129
  v_and_b32 v127, 0xffff0000, v129
  v_lshlrev_b32 v134, 16, v131
  v_and_b32 v135, 0xffff0000, v131
  v_add_f32 v124, v124, v132
  v_add_f32 v125, v125, v133
  v_add_f32 v126, v126, v134
  v_add_f32 v127, v127, v135
  v_cvt_pk_bf16_f32 v118, v124, v125
  v_cvt_pk_bf16_f32 v119, v126, v127
  ds_write_b64 v46, v[118:119] offset:3072
  v_lshlrev_b32 v124, 16, v120
  v_and_b32 v125, 0xffff0000, v120
  v_lshlrev_b32 v126, 16, v121
  v_and_b32 v127, 0xffff0000, v121
  v_mul_f32 v124, v124, v33
  v_mul_f32 v125, v125, v33
  v_mul_f32 v126, v126, v33
  v_mul_f32 v127, v127, v33
  v_cvt_pk_bf16_f32 v128, v124, v125
  v_cvt_pk_bf16_f32 v129, v126, v127
  v_cvt_pk_bf16_f32 v130, v84, v85
  v_cvt_pk_bf16_f32 v131, v86, v87
  v_lshlrev_b32 v124, 16, v128
  v_and_b32 v125, 0xffff0000, v128
  v_lshlrev_b32 v132, 16, v130
  v_and_b32 v133, 0xffff0000, v130
  v_lshlrev_b32 v126, 16, v129
  v_and_b32 v127, 0xffff0000, v129
  v_lshlrev_b32 v134, 16, v131
  v_and_b32 v135, 0xffff0000, v131
  v_add_f32 v124, v124, v132
  v_add_f32 v125, v125, v133
  v_add_f32 v126, v126, v134
  v_add_f32 v127, v127, v135
  v_cvt_pk_bf16_f32 v120, v124, v125
  v_cvt_pk_bf16_f32 v121, v126, v127
  ds_write_b64 v46, v[120:121] offset:3584
  v_lshlrev_b32 v124, 16, v122
  v_and_b32 v125, 0xffff0000, v122
  v_lshlrev_b32 v126, 16, v123
  v_and_b32 v127, 0xffff0000, v123
  v_mul_f32 v124, v124, v33
  v_mul_f32 v125, v125, v33
  v_mul_f32 v126, v126, v33
  v_mul_f32 v127, v127, v33
  v_cvt_pk_bf16_f32 v128, v124, v125
  v_cvt_pk_bf16_f32 v129, v126, v127
  v_cvt_pk_bf16_f32 v130, v88, v89
  v_cvt_pk_bf16_f32 v131, v90, v91
  v_lshlrev_b32 v124, 16, v128
  v_and_b32 v125, 0xffff0000, v128
  v_lshlrev_b32 v132, 16, v130
  v_and_b32 v133, 0xffff0000, v130
  v_lshlrev_b32 v126, 16, v129
  v_and_b32 v127, 0xffff0000, v129
  v_lshlrev_b32 v134, 16, v131
  v_and_b32 v135, 0xffff0000, v131
  v_add_f32 v124, v124, v132
  v_add_f32 v125, v125, v133
  v_add_f32 v126, v126, v134
  v_add_f32 v127, v127, v135
  v_cvt_pk_bf16_f32 v122, v124, v125
  v_cvt_pk_bf16_f32 v123, v126, v127
  ds_write_b64 v46, v[122:123] offset:4096
  s_waitcnt lgkmcnt(0)
  s_barrier
  v_lshlrev_b32 v6, 3, v0
  v_mul_u32_u24 v5, 7168, v0
  v_add_u32 v36, 512, v6
  ds_read_b64 v[8:9], v36
  v_add_u32 v36, 25088, v6
  ds_read_b64 v[10:11], v36
  v_add_u32 v36, 49664, v6
  ds_read_b64 v[12:13], v36
  v_add_u32 v36, 74240, v6
  ds_read_b64 v[14:15], v36
  s_waitcnt lgkmcnt(0)
  s_add_u32 s22, s21, 0
  s_add_u32 s23, s22, 3584
  v_perm_b32 v16, v10, v8, s24
  v_perm_b32 v17, v14, v12, s24
  buffer_store_dwordx2 v[16:17], v5, s[92:95], s22 offen offset:0
  v_perm_b32 v18, v10, v8, s25
  v_perm_b32 v19, v14, v12, s25
  buffer_store_dwordx2 v[18:19], v5, s[92:95], s22 offen offset:1792
  v_perm_b32 v20, v11, v9, s24
  v_perm_b32 v21, v15, v13, s24
  buffer_store_dwordx2 v[20:21], v5, s[92:95], s23 offen offset:0
  v_perm_b32 v22, v11, v9, s25
  v_perm_b32 v23, v15, v13, s25
  buffer_store_dwordx2 v[22:23], v5, s[92:95], s23 offen offset:1792
  v_add_u32 v36, 2560, v6
  ds_read_b64 v[8:9], v36
  v_add_u32 v36, 27136, v6
  ds_read_b64 v[10:11], v36
  v_add_u32 v36, 51712, v6
  ds_read_b64 v[12:13], v36
  v_add_u32 v36, 76288, v6
  ds_read_b64 v[14:15], v36
  s_waitcnt lgkmcnt(0)
  s_add_u32 s22, s21, 1835008
  s_add_u32 s23, s22, 3584
  v_perm_b32 v24, v10, v8, s24
  v_perm_b32 v25, v14, v12, s24
  buffer_store_dwordx2 v[24:25], v5, s[92:95], s22 offen offset:0
  v_perm_b32 v26, v10, v8, s25
  v_perm_b32 v27, v14, v12, s25
  buffer_store_dwordx2 v[26:27], v5, s[92:95], s22 offen offset:1792
  v_perm_b32 v28, v11, v9, s24
  v_perm_b32 v29, v15, v13, s24
  buffer_store_dwordx2 v[28:29], v5, s[92:95], s23 offen offset:0
  v_perm_b32 v30, v11, v9, s25
  v_perm_b32 v31, v15, v13, s25
  buffer_store_dwordx2 v[30:31], v5, s[92:95], s23 offen offset:1792
  s_branch wk_loop
wk_tok:
  s_sub_u32 s3, s3, 864
  s_and_b32 s18, s3, 3
  s_lshr_b32 s17, s3, 2
  s_cmp_lt_u32 s17, 8
  s_cbranch_scc1 wk_tokp
  s_sub_u32 s17, s17, 64
  s_cmp_ge_i32 s17, 56
  s_cbranch_scc1 wk_toko
  s_add_u32 s20, s17, 56
  s_lshr_b32 s17, s20, 1
  s_bitcmp0_b32 s20, 0
  s_cbranch_scc1 wk_toko
  s_add_u32 s17, s17, 8
wk_tokp:
  s_lshl_b32 s20, s18, 2
  s_add_u32 s20, s20, s16
  s_lshl_b32 s21, s17, 4
  s_add_u32 s21, s21, s20
  s_mul_i32 s21, s21, 28672
  s_add_u32 s21, s21, 12845056
  s_mul_i32 s23, s17, 28672
  s_add_u32 s23, s23, 73400320
  s_mul_i32 s24, s17, 7168
  s_add_u32 s24, s24, 88068096
  s_lshr_b32 s25, s17, 3
  s_lshl_b32 s25, s25, 4
  s_add_u32 s25, s25, s20
  s_lshl_b32 s25, s25, 7
  s_add_u32 s25, s25, 88545280
  v_mov_b32 v60, 0
  s_mov_b32 s30, 0
wp_wf:
  buffer_load_dword v61, v60, s[8:11], s25 offen sc1
  s_waitcnt vmcnt(0)
  v_cmp_ne_u32 vcc, 56, v61
  s_cbranch_vccz wp_wf_ok
  s_sleep 1
  s_cmp_ge_u32 s17, 61
  s_cbranch_scc1 wp_wf_bo
  s_sleep 4
  s_cmp_ge_u32 s17, 56
  s_cbranch_scc1 wp_wf_bo
  s_sleep 40
wp_wf_bo:
  s_add_u32 s30, s30, 1
  s_cmp_lt_u32 s30, 30000
  s_cbranch_scc1 wp_wf
  s_branch wp_abort
wp_wf_ok:
  s_add_u32 s22, s21, 0
  buffer_load_dwordx4 a[0:3], v2, s[8:11], s22 offen offset:0 sc1
  buffer_load_dwordx4 a[4:7], v2, s[8:11], s22 offen offset:1024 sc1
  buffer_load_dwordx4 a[8:11], v2, s[8:11], s22 offen offset:2048 sc1
  buffer_load_dwordx4 a[12:15], v2, s[8:11], s22 offen offset:3072 sc1
  s_add_u32 s22, s21, 4096
  buffer_load_dwordx4 a[16:19], v2, s[8:11], s22 offen offset:0 sc1
  buffer_load_dwordx4 a[20:23], v2, s[8:11], s22 offen offset:1024 sc1
  buffer_load_dwordx4 a[24:27], v2, s[8:11], s22 offen offset:2048 sc1
  buffer_load_dwordx4 a[28:31], v2, s[8:11], s22 offen offset:3072 sc1
  s_add_u32 s22, s21, 8192
  buffer_load_dwordx4 a[32:35], v2, s[8:11], s22 offen offset:0 sc1
  buffer_load_dwordx4 a[36:39], v2, s[8:11], s22 offen offset:1024 sc1
  buffer_load_dwordx4 a[40:43], v2, s[8:11], s22 offen offset:2048 sc1
  buffer_load_dwordx4 a[44:47], v2, s[8:11], s22 offen offset:3072 sc1
  s_add_u32 s22, s21, 12288
  buffer_load_dwordx4 a[48:51], v2, s[8:11], s22 offen offset:0 sc1
  buffer_load_dwordx4 a[52:55], v2, s[8:11], s22 offen offset:1024 sc1
  buffer_load_dwordx4 a[56:59], v2, s[8:11], s22 offen offset:2048 sc1
  buffer_load_dwordx4 a[60:63], v2, s[8:11], s22 offen offset:3072 sc1
  s_add_u32 s22, s21, 16384
  buffer_load_dwordx4 a[64:67], v2, s[8:11], s22 offen offset:0 sc1
  buffer_load_dwordx4 a[68:71], v2, s[8:11], s22 offen offset:1024 sc1
  buffer_load_dwordx4 a[72:75], v2, s[8:11], s22 offen offset:2048 sc1
  buffer_load_dwordx4 a[76:79], v2, s[8:11], s22 offen offset:3072 sc1
  s_add_u32 s22, s21, 20480
  buffer_load_dwordx4 a[80:83], v2, s[8:11], s22 offen offset:0 sc1
  buffer_load_dwordx4 a[84:87], v2, s[8:11], s22 offen offset:1024 sc1
  buffer_load_dwordx4 a[88:91], v2, s[8:11], s22 offen offset:2048 sc1
  buffer_load_dwordx4 a[92:95], v2, s[8:11], s22 offen offset:3072 sc1
  s_add_u32 s22, s21, 24576
  buffer_load_dwordx4 a[96:99], v2, s[8:11], s22 offen offset:0 sc1
  buffer_load_dwordx4 a[100:103], v2, s[8:11], s22 offen offset:1024 sc1
  buffer_load_dwordx4 a[104:107], v2, s[8:11], s22 offen offset:2048 sc1
  buffer_load_dwordx4 a[108:111], v2, s[8:11], s22 offen offset:3072 sc1
  s_add_u32 s22, s23, 0
  buffer_load_dwordx4 a[112:115], v2, s[8:11], s22 offen offset:0 sc1
  buffer_load_dwordx4 a[116:119], v2, s[8:11], s22 offen offset:1024 sc1
  buffer_load_dwordx4 a[120:123], v2, s[8:11], s22 offen offset:2048 sc1
  buffer_load_dwordx4 a[124:127], v2, s[8:11], s22 offen offset:3072 sc1
  s_add_u32 s22, s23, 4096
  buffer_load_dwordx4 a[128:131], v2, s[8:11], s22 offen offset:0 sc1
  buffer_load_dwordx4 a[132:135], v2, s[8:11], s22 offen offset:1024 sc1
  buffer_load_dwordx4 a[136:139], v2, s[8:11], s22 offen offset:2048 sc1
  buffer_load_dwordx4 a[140:143], v2, s[8:11], s22 offen offset:3072 sc1
  s_add_u32 s22, s23, 8192
  buffer_load_dwordx4 a[144:147], v2, s[8:11], s22 offen offset:0 sc1
  buffer_load_dwordx4 a[148:151], v2, s[8:11], s22 offen offset:1024 sc1
  buffer_load_dwordx4 a[152:155], v2, s[8:11], s22 offen offset:2048 sc1
  buffer_load_dwordx4 a[156:159], v2, s[8:11], s22 offen offset:3072 sc1
  s_add_u32 s22, s23, 12288
  buffer_load_dwordx4 a[160:163], v2, s[8:11], s22 offen offset:0 sc1
  buffer_load_dwordx4 a[164:167], v2, s[8:11], s22 offen offset:1024 sc1
  buffer_load_dwordx4 a[168:171], v2, s[8:11], s22 offen offset:2048 sc1
  buffer_load_dwordx4 a[172:175], v2, s[8:11], s22 offen offset:3072 sc1
  s_add_u32 s22, s23, 16384
  buffer_load_dwordx4 a[176:179], v2, s[8:11], s22 offen offset:0 sc1
  buffer_load_dwordx4 a[180:183], v2, s[8:11], s22 offen offset:1024 sc1
  buffer_load_dwordx4 a[184:187], v2, s[8:11], s22 offen offset:2048 sc1
  buffer_load_dwordx4 a[188:191], v2, s[8:11], s22 offen offset:3072 sc1
  s_add_u32 s22, s23, 20480
  buffer_load_dwordx4 a[192:195], v2, s[8:11], s22 offen offset:0 sc1
  buffer_load_dwordx4 a[196:199], v2, s[8:11], s22 offen offset:1024 sc1
  buffer_load_dwordx4 a[200:203], v2, s[8:11], s22 offen offset:2048 sc1
  buffer_load_dwordx4 a[204:207], v2, s[8:11], s22 offen offset:3072 sc1
  s_add_u32 s22, s23, 24576
  buffer_load_dwordx4 a[208:211], v2, s[8:11], s22 offen offset:0 sc1
  buffer_load_dwordx4 a[212:215], v2, s[8:11], s22 offen offset:1024 sc1
  buffer_load_dwordx4 a[216:219], v2, s[8:11], s22 offen offset:2048 sc1
  buffer_load_dwordx4 a[220:223], v2, s[8:11], s22 offen offset:3072 sc1
  v_lshl_add_u32 v5, v3, 2, 0
  v_cmp_le_u32 s[40:41], v5, v4
  v_lshl_add_u32 v5, v3, 2, 1
  v_cmp_le_u32 s[42:43], v5, v4
  v_lshl_add_u32 v5, v3, 2, 2
  v_cmp_le_u32 s[44:45], v5, v4
  v_lshl_add_u32 v5, v3, 2, 3
  v_cmp_le_u32 s[46:47], v5, v4
  v_cmp_gt_u32 s[48:49], 2, v3
  v_mov_b32 v6, 0xff800000
  s_waitcnt vmcnt(0)
  v_mfma_f32_16x16x32_bf16 v[8:11], a[112:115], a[0:3], 0
  v_mfma_f32_16x16x32_bf16 v[12:15], a[112:115], a[56:59], 0
  v_mfma_f32_16x16x32_bf16 v[16:19], a[168:171], a[56:59], 0
  v_mfma_f32_16x16x32_bf16 v[8:11], a[116:119], a[4:7], v[8:11]
  v_mfma_f32_16x16x32_bf16 v[12:15], a[116:119], a[60:63], v[12:15]
  v_mfma_f32_16x16x32_bf16 v[16:19], a[172:175], a[60:63], v[16:19]
  v_mfma_f32_16x16x32_bf16 v[8:11], a[120:123], a[8:11], v[8:11]
  v_mfma_f32_16x16x32_bf16 v[12:15], a[120:123], a[64:67], v[12:15]
  v_mfma_f32_16x16x32_bf16 v[16:19], a[176:179], a[64:67], v[16:19]
  v_mfma_f32_16x16x32_bf16 v[8:11], a[124:127], a[12:15], v[8:11]
  v_mfma_f32_16x16x32_bf16 v[12:15], a[124:127], a[68:71], v[12:15]
  v_mfma_f32_16x16x32_bf16 v[16:19], a[180:183], a[68:71], v[16:19]
  v_mfma_f32_16x16x32_bf16 v[8:11], a[128:131], a[16:19], v[8:11]
  v_mfma_f32_16x16x32_bf16 v[12:15], a[128:131], a[72:75], v[12:15]
  v_mfma_f32_16x16x32_bf16 v[16:19], a[184:187], a[72:75], v[16:19]
  v_mfma_f32_16x16x32_bf16 v[8:11], a[132:135], a[20:23], v[8:11]
  v_mfma_f32_16x16x32_bf16 v[12:15], a[132:135], a[76:79], v[12:15]
  v_mfma_f32_16x16x32_bf16 v[16:19], a[188:191], a[76:79], v[16:19]
  v_mfma_f32_16x16x32_bf16 v[8:11], a[136:139], a[24:27], v[8:11]
  v_mfma_f32_16x16x32_bf16 v[12:15], a[136:139], a[80:83], v[12:15]
  v_mfma_f32_16x16x32_bf16 v[16:19], a[192:195], a[80:83], v[16:19]
  v_mfma_f32_16x16x32_bf16 v[8:11], a[140:143], a[28:31], v[8:11]
  v_mfma_f32_16x16x32_bf16 v[12:15], a[140:143], a[84:87], v[12:15]
  v_mfma_f32_16x16x32_bf16 v[16:19], a[196:199], a[84:87], v[16:19]
  v_mfma_f32_16x16x32_bf16 v[8:11], a[144:147], a[32:35], v[8:11]
  v_mfma_f32_16x16x32_bf16 v[12:15], a[144:147], a[88:91], v[12:15]
  v_mfma_f32_16x16x32_bf16 v[16:19], a[200:203], a[88:91], v[16:19]
  v_mfma_f32_16x16x32_bf16 v[8:11], a[148:151], a[36:39], v[8:11]
  v_mfma_f32_16x16x32_bf16 v[12:15], a[148:151], a[92:95], v[12:15]
  v_mfma_f32_16x16x32_bf16 v[16:19], a[204:207], a[92:95], v[16:19]
  v_mfma_f32_16x16x32_bf16 v[8:11], a[152:155], a[40:43], v[8:11]
  v_mfma_f32_16x16x32_bf16 v[12:15], a[152:155], a[96:99], v[12:15]
  v_mfma_f32_16x16x32_bf16 v[16:19], a[208:211], a[96:99], v[16:19]
  v_mfma_f32_16x16x32_bf16 v[8:11], a[156:159], a[44:47], v[8:11]
  v_mfma_f32_16x16x32_bf16 v[12:15], a[156:159], a[100:103], v[12:15]
  v_mfma_f32_16x16x32_bf16 v[16:19], a[212:215], a[100:103], v[16:19]
  v_mfma_f32_16x16x32_bf16 v[8:11], a[160:163], a[48:51], v[8:11]
  v_mfma_f32_16x16x32_bf16 v[12:15], a[160:163], a[104:107], v[12:15]
  v_mfma_f32_16x16x32_bf16 v[16:19], a[216:219], a[104:107], v[16:19]
  v_mfma_f32_16x16x32_bf16 v[8:11], a[164:167], a[52:55], v[8:11]
  v_mfma_f32_16x16x32_bf16 v[12:15], a[164:167], a[108:111], v[12:15]
  v_mfma_f32_16x16x32_bf16 v[16:19], a[220:223], a[108:111], v[16:19]
  s_mul_i32 s22, s20, 448
  v_mov_b32 v62, s22
  s_mov_b32 s30, 0
wp_pm:
  s_cmp_ge_u32 s17, 64
  s_cbranch_scc1 wp_pf
  s_cmp_ge_u32 s17, 61
  s_cbranch_scc1 mp_43a
  v_mov_b32 v61, 0
  s_mov_b64 exec, 1
  buffer_atomic_or v61, v62, s[8:11], s24 offen sc0
  s_mov_b64 exec, -1
  s_branch mp_43b
mp_43a:
  buffer_load_dword v61, v62, s[8:11], s24 offen sc1
mp_43b:
  s_waitcnt vmcnt(0)
  v_cmp_eq_u32 vcc, -1, v61
  s_cbranch_vccnz wp_pr
wp_pf:
  s_add_u32 s22, s24, 4096
  buffer_load_dwordx4 v[64:67], v2, s[8:11], s24 offen offset:0 sc1
  buffer_load_dwordx4 v[68:71], v2, s[8:11], s24 offen offset:1024 sc1
  buffer_load_dwordx4 v[72:75], v2, s[8:11], s24 offen offset:2048 sc1
  buffer_load_dwordx4 v[76:79], v2, s[8:11], s24 offen offset:3072 sc1
  buffer_load_dwordx4 v[80:83], v2, s[8:11], s22 offen offset:0 sc1
  buffer_load_dwordx4 v[84:87], v2, s[8:11], s22 offen offset:1024 sc1
  buffer_load_dwordx4 v[88:91], v2, s[8:11], s22 offen offset:2048 sc1
  s_waitcnt vmcnt(0)
  v_max_u32 v61, v64, v65
  v_max3_u32 v61, v61, v66, v67
  v_max3_u32 v61, v61, v68, v69
  v_max3_u32 v61, v61, v70, v71
  v_max3_u32 v61, v61, v72, v73
  v_max3_u32 v61, v61, v74, v75
  v_max3_u32 v61, v61, v76, v77
  v_max3_u32 v61, v61, v78, v79
  v_max3_u32 v61, v61, v80, v81
  v_max3_u32 v61, v61, v82, v83
  v_max3_u32 v61, v61, v84, v85
  v_max3_u32 v61, v61, v86, v87
  v_max3_u32 v61, v61, v88, v89
  v_max3_u32 v61, v61, v90, v91
  v_cmp_eq_u32 vcc, -1, v61
  s_cbranch_vccz wp_pk
wp_pr:
  s_sleep 1
  s_cmp_ge_u32 s17, 61
  s_cbranch_scc1 wp_pm_bo
  s_sleep 4
  s_cmp_ge_u32 s17, 56
  s_cbranch_scc1 wp_pm_bo
  s_sleep 40
wp_pm_bo:
  s_add_u32 s30, s30, 1
  s_cmp_lt_u32 s30, 30000
  s_cbranch_scc1 wp_pm
  s_branch wp_abort
wp_pk:
  buffer_load_dword v250, v251, s[12:15], 0 offen sc1
  v_mfma_f32_16x16x32_bf16 v[20:23], v[64:67], a[0:3], 0
  v_mfma_f32_16x16x32_bf16 v[24:27], v[64:67], a[4:7], 0
  v_mfma_f32_16x16x32_bf16 v[28:31], v[64:67], a[56:59], 0
  v_mfma_f32_16x16x32_bf16 v[32:35], v[64:67], a[60:63], 0
  v_mfma_f32_16x16x32_bf16 v[20:23], v[68:71], a[8:11], v[20:23]
  v_mfma_f32_16x16x32_bf16 v[24:27], v[68:71], a[12:15], v[24:27]
  v_mfma_f32_16x16x32_bf16 v[28:31], v[68:71], a[64:67], v[28:31]
  v_mfma_f32_16x16x32_bf16 v[32:35], v[68:71], a[68:71], v[32:35]
  v_mfma_f32_16x16x32_bf16 v[20:23], v[72:75], a[16:19], v[20:23]
  v_mfma_f32_16x16x32_bf16 v[24:27], v[72:75], a[20:23], v[24:27]
  v_mfma_f32_16x16x32_bf16 v[28:31], v[72:75], a[72:75], v[28:31]
  v_mfma_f32_16x16x32_bf16 v[32:35], v[72:75], a[76:79], v[32:35]
  v_mfma_f32_16x16x32_bf16 v[20:23], v[76:79], a[24:27], v[20:23]
  v_mfma_f32_16x16x32_bf16 v[24:27], v[76:79], a[28:31], v[24:27]
  v_mfma_f32_16x16x32_bf16 v[28:31], v[76:79], a[80:83], v[28:31]
  v_mfma_f32_16x16x32_bf16 v[32:35], v[76:79], a[84:87], v[32:35]
  v_mfma_f32_16x16x32_bf16 v[20:23], v[80:83], a[32:35], v[20:23]
  v_mfma_f32_16x16x32_bf16 v[24:27], v[80:83], a[36:39], v[24:27]
  v_mfma_f32_16x16x32_bf16 v[28:31], v[80:83], a[88:91], v[28:31]
  v_mfma_f32_16x16x32_bf16 v[32:35], v[80:83], a[92:95], v[32:35]
  v_mfma_f32_16x16x32_bf16 v[20:23], v[84:87], a[40:43], v[20:23]
  v_mfma_f32_16x16x32_bf16 v[24:27], v[84:87], a[44:47], v[24:27]
  v_mfma_f32_16x16x32_bf16 v[28:31], v[84:87], a[96:99], v[28:31]
  v_mfma_f32_16x16x32_bf16 v[32:35], v[84:87], a[100:103], v[32:35]
  v_mfma_f32_16x16x32_bf16 v[20:23], v[88:91], a[48:51], v[20:23]
  v_mfma_f32_16x16x32_bf16 v[24:27], v[88:91], a[52:55], v[24:27]
  v_mfma_f32_16x16x32_bf16 v[28:31], v[88:91], a[104:107], v[28:31]
  v_mfma_f32_16x16x32_bf16 v[32:35], v[88:91], a[108:111], v[32:35]
  s_lshl_b32 s25, s17, 1
  s_mul_i32 s25, s25, 20480
  s_add_u32 s25, s25, 85446656
  s_lshl_b32 s26, s20, 10
  s_add_u32 s26, s26, s25
  s_lshl_b32 s27, s18, 10
  s_add_u32 s27, s27, s25
  s_lshr_b32 s28, s16, 1
  s_lshl_b32 s28, s28, 3
  s_add_u32 s27, s27, s28
  s_add_u32 s27, s27, 16384
  s_and_b32 s28, s16, 1
  s_cmp_eq_u32 s28, 0
  s_cselect_b32 s50, -1, 0
  s_cselect_b32 s51, 0, -1
  v_cndmask_b32 v8, v6, v8, s[40:41]
  v_cndmask_b32 v9, v6, v9, s[42:43]
  v_cndmask_b32 v10, v6, v10, s[44:45]
  v_cndmask_b32 v11, v6, v11, s[46:47]
  v_cndmask_b32 v20, v24, v20, s[48:49]
  v_cndmask_b32 v21, v25, v21, s[48:49]
  v_cndmask_b32 v22, v26, v22, s[48:49]
  v_cndmask_b32 v23, v27, v23, s[48:49]
  v_mov_b32 v24, v20
  v_mov_b32 v25, v21
  v_mov_b32 v26, v22
  v_mov_b32 v27, v23
  v_permlane32_swap_b32 v20, v24
  v_permlane32_swap_b32 v21, v25
  v_permlane32_swap_b32 v22, v26
  v_permlane32_swap_b32 v23, v27
  v_add_f32 v20, v20, v24
  v_add_f32 v21, v21, v25
  v_add_f32 v22, v22, v26
  v_add_f32 v23, v23, v27
  v_max3_f32 v40, v8, v9, v10
  v_max3_f32 v40, v40, v11, v20
  v_max3_f32 v40, v40, v21, v22
  v_max_f32 v40, v40, v23
  v_mov_b32 v41, v40
  s_nop 1
  v_permlane16_swap_b32 v40, v41
  v_max_f32 v40, v40, v41
  v_mov_b32 v41, v40
  s_nop 1
  v_permlane32_swap_b32 v40, v41
  v_max_f32 v40, v40, v41
  v_sub_f32 v8, v8, v40
  v_sub_f32 v9, v9, v40
  v_sub_f32 v10, v10, v40
  v_sub_f32 v11, v11, v40
  v_sub_f32 v20, v20, v40
  v_sub_f32 v21, v21, v40
  v_sub_f32 v22, v22, v40
  v_sub_f32 v23, v23, v40
  v_exp_f32 v8, v8
  v_exp_f32 v9, v9
  v_exp_f32 v10, v10
  v_exp_f32 v11, v11
  v_exp_f32 v20, v20
  v_exp_f32 v21, v21
  v_exp_f32 v22, v22
  v_exp_f32 v23, v23
  v_add_f32 v42, v20, v21
  v_add_f32 v43, v22, v23
  v_add_f32 v42, v42, v43
  v_mul_f32 v42, 0.5, v42
  v_add_f32 v42, v42, v8
  v_add_f32 v42, v42, v9
  v_add_f32 v42, v42, v10
  v_add_f32 v42, v42, v11
  v_mov_b32 v41, v42
  s_nop 1
  v_permlane16_swap_b32 v42, v41
  v_add_f32 v42, v42, v41
  v_mov_b32 v41, v42
  s_nop 1
  v_permlane32_swap_b32 v42, v41
  v_add_f32 v42, v42, v41
  v_rcp_f32 v42, v42
  s_nop 0
  v_mul_f32 v8, v8, v42
  v_mul_f32 v9, v9, v42
  v_mul_f32 v10, v10, v42
  v_mul_f32 v11, v11, v42
  v_mul_f32 v20, v20, v42
  v_mul_f32 v21, v21, v42
  v_mul_f32 v22, v22, v42
  v_mul_f32 v23, v23, v42
  v_cvt_pk_bf16_f32 v44, v8, v9
  v_cvt_pk_bf16_f32 v45, v10, v11
  v_mov_b32 v46, 0
  v_mov_b32 v47, 0
  v_cvt_pk_bf16_f32 v48, v20, v21
  v_cvt_pk_bf16_f32 v49, v22, v23
  v_min_u32 v44, -2, v44
  v_min_u32 v45, -2, v45
  v_min_u32 v46, -2, v46
  v_min_u32 v47, -2, v47
  v_min_u32 v48, -2, v48
  v_min_u32 v49, -2, v49
  buffer_store_dwordx4 v[44:47], v2, s[8:11], s26 offen sc1
  s_mov_b64 exec, s[50:51]
  buffer_store_dwordx2 v[48:49], v2, s[8:11], s27 offen sc1
  s_mov_b64 exec, -1
  s_add_u32 s26, s26, 20480
  s_add_u32 s27, s27, 20480
  v_cndmask_b32 v16, v6, v16, s[40:41]
  v_cndmask_b32 v17, v6, v17, s[42:43]
  v_cndmask_b32 v18, v6, v18, s[44:45]
  v_cndmask_b32 v19, v6, v19, s[46:47]
  v_cndmask_b32 v28, v32, v28, s[48:49]
  v_cndmask_b32 v29, v33, v29, s[48:49]
  v_cndmask_b32 v30, v34, v30, s[48:49]
  v_cndmask_b32 v31, v35, v31, s[48:49]
  v_mov_b32 v32, v28
  v_mov_b32 v33, v29
  v_mov_b32 v34, v30
  v_mov_b32 v35, v31
  v_permlane32_swap_b32 v28, v32
  v_permlane32_swap_b32 v29, v33
  v_permlane32_swap_b32 v30, v34
  v_permlane32_swap_b32 v31, v35
  v_add_f32 v28, v28, v32
  v_add_f32 v29, v29, v33
  v_add_f32 v30, v30, v34
  v_add_f32 v31, v31, v35
  v_max3_f32 v40, v12, v13, v14
  v_max3_f32 v40, v40, v15, v16
  v_max3_f32 v40, v40, v17, v18
  v_max3_f32 v40, v40, v19, v28
  v_max3_f32 v40, v40, v29, v30
  v_max_f32 v40, v40, v31
  v_mov_b32 v41, v40
  s_nop 1
  v_permlane16_swap_b32 v40, v41
  v_max_f32 v40, v40, v41
  v_mov_b32 v41, v40
  s_nop 1
  v_permlane32_swap_b32 v40, v41
  v_max_f32 v40, v40, v41
  v_sub_f32 v12, v12, v40
  v_sub_f32 v13, v13, v40
  v_sub_f32 v14, v14, v40
  v_sub_f32 v15, v15, v40
  v_sub_f32 v16, v16, v40
  v_sub_f32 v17, v17, v40
  v_sub_f32 v18, v18, v40
  v_sub_f32 v19, v19, v40
  v_sub_f32 v28, v28, v40
  v_sub_f32 v29, v29, v40
  v_sub_f32 v30, v30, v40
  v_sub_f32 v31, v31, v40
  v_exp_f32 v12, v12
  v_exp_f32 v13, v13
  v_exp_f32 v14, v14
  v_exp_f32 v15, v15
  v_exp_f32 v16, v16
  v_exp_f32 v17, v17
  v_exp_f32 v18, v18
  v_exp_f32 v19, v19
  v_exp_f32 v28, v28
  v_exp_f32 v29, v29
  v_exp_f32 v30, v30
  v_exp_f32 v31, v31
  v_add_f32 v42, v28, v29
  v_add_f32 v43, v30, v31
  v_add_f32 v42, v42, v43
  v_mul_f32 v42, 0.5, v42
  v_add_f32 v42, v42, v12
  v_add_f32 v42, v42, v13
  v_add_f32 v42, v42, v14
  v_add_f32 v42, v42, v15
  v_add_f32 v42, v42, v16
  v_add_f32 v42, v42, v17
  v_add_f32 v42, v42, v18
  v_add_f32 v42, v42, v19
  v_mov_b32 v41, v42
  s_nop 1
  v_permlane16_swap_b32 v42, v41
  v_add_f32 v42, v42, v41
  v_mov_b32 v41, v42
  s_nop 1
  v_permlane32_swap_b32 v42, v41
  v_add_f32 v42, v42, v41
  v_rcp_f32 v42, v42
  s_nop 0
  v_mul_f32 v12, v12, v42
  v_mul_f32 v13, v13, v42
  v_mul_f32 v14, v14, v42
  v_mul_f32 v15, v15, v42
  v_mul_f32 v16, v16, v42
  v_mul_f32 v17, v17, v42
  v_mul_f32 v18, v18, v42
  v_mul_f32 v19, v19, v42
  v_mul_f32 v28, v28, v42
  v_mul_f32 v29, v29, v42
  v_mul_f32 v30, v30, v42
  v_mul_f32 v31, v31, v42
  v_cvt_pk_bf16_f32 v52, v12, v13
  v_cvt_pk_bf16_f32 v53, v14, v15
  v_cvt_pk_bf16_f32 v54, v16, v17
  v_cvt_pk_bf16_f32 v55, v18, v19
  v_cvt_pk_bf16_f32 v56, v28, v29
  v_cvt_pk_bf16_f32 v57, v30, v31
  v_min_u32 v52, -2, v52
  v_min_u32 v53, -2, v53
  v_min_u32 v54, -2, v54
  v_min_u32 v55, -2, v55
  v_min_u32 v56, -2, v56
  v_min_u32 v57, -2, v57
  buffer_store_dwordx4 v[52:55], v2, s[8:11], s26 offen sc1
  s_mov_b64 exec, s[50:51]
  buffer_store_dwordx2 v[56:57], v2, s[8:11], s27 offen sc1
  s_mov_b64 exec, -1
  s_lshl_b32 s25, s17, 7
  s_add_u32 s25, s25, 88561664
  v_mov_b32 v5, 1
  v_mov_b32 v6, 0
  s_waitcnt vmcnt(0)
  s_mov_b64 exec, 1
  buffer_atomic_add v5, v6, s[8:11], s25 offen
  s_mov_b64 exec, -1
  s_branch wk_loop
wk_toko:
  s_lshl_b32 s20, s18, 2
  s_add_u32 s20, s20, s16
  s_mul_i32 s24, s20, 65
  s_add_u32 s24, s24, s17
  s_lshl_b32 s24, s24, 13
  s_add_u32 s24, s24, 76935168
  s_lshl_b32 s21, s20, 6
  s_add_u32 s21, s21, s17
  s_mul_i32 s21, s21, 28672
  s_add_u32 s21, s21, 42205184
  s_lshl_b32 s25, s17, 1
  s_mul_i32 s25, s25, 20480
  s_add_u32 s25, s25, 85446656
  v_lshrrev_b32 v8, 5, v1
  v_and_b32 v9, 31, v1
  v_min_u32 v5, 27, v9
  v_mad_u32_u24 v5, v8, 28, v5
  v_lshlrev_b32 v5, 4, v5
  v_lshrrev_b32 v10, 4, v9
  v_lshlrev_b32 v7, 10, v10
  v_lshl_add_u32 v7, v4, 4, v7
  v_lshl_add_u32 v7, v8, 3, v7
  v_mul_u32_u24 v6, 20480, v10
  v_lshl_add_u32 v6, v8, 8, v6
  v_lshl_add_u32 v6, v4, 4, v6
  s_lshr_b32 s26, s17, 3
  s_lshl_b32 s26, s26, 4
  s_add_u32 s26, s26, s20
  s_lshl_b32 s26, s26, 7
  s_add_u32 s26, s26, 88528896
  v_mov_b32 v60, 0
  s_mov_b32 s30, 0
wo_wv:
  buffer_load_dword v61, v60, s[8:11], s26 offen sc1
  s_waitcnt vmcnt(0)
  v_cmp_ne_u32 vcc, 56, v61
  s_cbranch_vccz wo_wv_ok
  s_sleep 1
  s_cmp_ge_u32 s17, 61
  s_cbranch_scc1 wo_wv_bo
  s_sleep 4
  s_cmp_ge_u32 s17, 56
  s_cbranch_scc1 wo_wv_bo
  s_sleep 40
wo_wv_bo:
  s_add_u32 s30, s30, 1
  s_cmp_lt_u32 s30, 30000
  s_cbranch_scc1 wo_wv
  s_branch wo_abort
wo_wv_ok:
  s_add_u32 s22, s21, 0
  buffer_load_dwordx4 a[0:3], v5, s[8:11], s22 offen offset:0 sc1
  buffer_load_dwordx4 a[4:7], v5, s[8:11], s22 offen offset:896 sc1
  buffer_load_dwordx4 a[8:11], v5, s[8:11], s22 offen offset:1792 sc1
  buffer_load_dwordx4 a[12:15], v5, s[8:11], s22 offen offset:2688 sc1
  s_add_u32 s22, s21, 3584
  buffer_load_dwordx4 a[16:19], v5, s[8:11], s22 offen offset:0 sc1
  buffer_load_dwordx4 a[20:23], v5, s[8:11], s22 offen offset:896 sc1
  buffer_load_dwordx4 a[24:27], v5, s[8:11], s22 offen offset:1792 sc1
  buffer_load_dwordx4 a[28:31], v5, s[8:11], s22 offen offset:2688 sc1
  s_add_u32 s22, s21, 7168
  buffer_load_dwordx4 a[32:35], v5, s[8:11], s22 offen offset:0 sc1
  buffer_load_dwordx4 a[36:39], v5, s[8:11], s22 offen offset:896 sc1
  buffer_load_dwordx4 a[40:43], v5, s[8:11], s22 offen offset:1792 sc1
  buffer_load_dwordx4 a[44:47], v5, s[8:11], s22 offen offset:2688 sc1
  s_add_u32 s22, s21, 10752
  buffer_load_dwordx4 a[48:51], v5, s[8:11], s22 offen offset:0 sc1
  buffer_load_dwordx4 a[52:55], v5, s[8:11], s22 offen offset:896 sc1
  buffer_load_dwordx4 a[56:59], v5, s[8:11], s22 offen offset:1792 sc1
  buffer_load_dwordx4 a[60:63], v5, s[8:11], s22 offen offset:2688 sc1
  s_add_u32 s22, s21, 14336
  buffer_load_dwordx4 a[64:67], v5, s[8:11], s22 offen offset:0 sc1
  buffer_load_dwordx4 a[68:71], v5, s[8:11], s22 offen offset:896 sc1
  buffer_load_dwordx4 a[72:75], v5, s[8:11], s22 offen offset:1792 sc1
  buffer_load_dwordx4 a[76:79], v5, s[8:11], s22 offen offset:2688 sc1
  s_add_u32 s22, s21, 17920
  buffer_load_dwordx4 a[80:83], v5, s[8:11], s22 offen offset:0 sc1
  buffer_load_dwordx4 a[84:87], v5, s[8:11], s22 offen offset:896 sc1
  buffer_load_dwordx4 a[88:91], v5, s[8:11], s22 offen offset:1792 sc1
  buffer_load_dwordx4 a[92:95], v5, s[8:11], s22 offen offset:2688 sc1
  s_add_u32 s22, s21, 21504
  buffer_load_dwordx4 a[96:99], v5, s[8:11], s22 offen offset:0 sc1
  buffer_load_dwordx4 a[100:103], v5, s[8:11], s22 offen offset:896 sc1
  buffer_load_dwordx4 a[104:107], v5, s[8:11], s22 offen offset:1792 sc1
  buffer_load_dwordx4 a[108:111], v5, s[8:11], s22 offen offset:2688 sc1
  s_add_u32 s22, s21, 25088
  buffer_load_dwordx4 a[112:115], v5, s[8:11], s22 offen offset:0 sc1
  buffer_load_dwordx4 a[116:119], v5, s[8:11], s22 offen offset:896 sc1
  buffer_load_dwordx4 a[120:123], v5, s[8:11], s22 offen offset:1792 sc1
  buffer_load_dwordx4 a[124:127], v5, s[8:11], s22 offen offset:2688 sc1
  s_cmp_ge_u32 s17, 61
  s_cbranch_scc1 wo_lm
  s_lshl_b32 s26, s17, 7
  s_add_u32 s26, s26, 88561664
  v_mov_b32 v60, 0
  s_mov_b32 s30, 0
wo_wp:
  buffer_load_dword v61, v60, s[8:11], s26 offen sc1
  s_waitcnt vmcnt(0)
  v_cmp_ne_u32 vcc, 16, v61
  s_cbranch_vccz wo_wp_ok
  s_sleep 2
  s_cmp_ge_u32 s17, 61
  s_cbranch_scc1 wo_wp_bo
  s_sleep 4
  s_cmp_ge_u32 s17, 56
  s_cbranch_scc1 wo_wp_bo
  s_sleep 40
wo_wp_bo:
  s_add_u32 s30, s30, 1
  s_cmp_lt_u32 s30, 30000
  s_cbranch_scc1 wo_wp
  s_branch wo_abort
wo_wp_ok:
  s_branch wo_lp
wo_lm:
  s_mul_i32 s26, s17, 7168
  s_add_u32 s26, s26, 88068096
  v_mov_b32 v60, 0
  s_mov_b32 s30, 0
wo_wm:
  buffer_load_dword v61, v60, s[8:11], s26 offen sc1
  s_waitcnt vmcnt(0)
  v_cmp_eq_u32 vcc, -1, v61
  s_cbranch_vccz wo_wm_ok
  s_sleep 2
  s_cmp_ge_u32 s17, 61
  s_cbranch_scc1 wo_wm_bo
  s_sleep 4
  s_cmp_ge_u32 s17, 56
  s_cbranch_scc1 wo_wm_bo
  s_sleep 40
wo_wm_bo:
  s_add_u32 s30, s30, 1
  s_cmp_lt_u32 s30, 30000
  s_cbranch_scc1 wo_wm
  s_branch wo_abort
wo_wm_ok:
wo_lp:
  s_mul_i32 s26, s16, 10240
  s_add_u32 s27, s25, s26
  v_add_u32 v11, s26, v2
  s_lshl_b32 s26, s20, 6
  s_add_u32 s26, s26, s17
  s_lshl_b32 s26, s26, 4
  s_add_u32 s26, s26, 88569856
  v_lshlrev_b32 v60, 2, v3
  s_mov_b32 s30, 0
wo_pl:
  s_add_u32 s22, s27, 0
  buffer_load_dwordx4 v[128:131], v2, s[8:11], s22 offen offset:0 sc1
  buffer_load_dwordx4 v[132:135], v2, s[8:11], s22 offen offset:1024 sc1
  buffer_load_dwordx4 v[136:139], v2, s[8:11], s22 offen offset:2048 sc1
  buffer_load_dwordx4 v[140:143], v2, s[8:11], s22 offen offset:3072 sc1
  s_add_u32 s22, s27, 4096
  buffer_load_dwordx4 v[144:147], v2, s[8:11], s22 offen offset:0 sc1
  buffer_load_dwordx4 v[148:151], v2, s[8:11], s22 offen offset:1024 sc1
  buffer_load_dwordx4 v[152:155], v2, s[8:11], s22 offen offset:2048 sc1
  buffer_load_dwordx4 v[156:159], v2, s[8:11], s22 offen offset:3072 sc1
  s_add_u32 s22, s27, 8192
  buffer_load_dwordx4 v[160:163], v2, s[8:11], s22 offen offset:0 sc1
  buffer_load_dwordx4 v[164:167], v2, s[8:11], s22 offen offset:1024 sc1
  buffer_load_dword v61, v60, s[8:11], s26 offen sc1
  s_waitcnt vmcnt(1)
  v_max_u32 v62, v128, v129
  v_max3_u32 v62, v62, v130, v131
  v_max3_u32 v62, v62, v132, v133
  v_max3_u32 v62, v62, v134, v135
  v_max3_u32 v62, v62, v136, v137
  v_max3_u32 v62, v62, v138, v139
  v_max3_u32 v62, v62, v140, v141
  v_max3_u32 v62, v62, v142, v143
  v_max3_u32 v62, v62, v144, v145
  v_max3_u32 v62, v62, v146, v147
  v_max3_u32 v62, v62, v148, v149
  v_max3_u32 v62, v62, v150, v151
  v_max3_u32 v62, v62, v152, v153
  v_max3_u32 v62, v62, v154, v155
  v_max3_u32 v62, v62, v156, v157
  v_max3_u32 v62, v62, v158, v159
  v_max3_u32 v62, v62, v160, v161
  v_max3_u32 v62, v62, v162, v163
  v_max3_u32 v62, v62, v164, v165
  v_max3_u32 v62, v62, v166, v167
  v_cmp_eq_u32 vcc, -1, v62
  s_cbranch_vccz wo_pk
  s_add_u32 s30, s30, 1
  s_cmp_lt_u32 s30, 30000
  s_cbranch_scc1 wo_pl
  s_branch wo_abort
wo_pk:
  ds_write_b128 v11, v[128:131] offset:0
  ds_write_b128 v11, v[132:135] offset:1024
  ds_write_b128 v11, v[136:139] offset:2048
  ds_write_b128 v11, v[140:143] offset:3072
  ds_write_b128 v11, v[144:147] offset:4096
  ds_write_b128 v11, v[148:151] offset:5120
  ds_write_b128 v11, v[152:155] offset:6144
  ds_write_b128 v11, v[156:159] offset:7168
  ds_write_b128 v11, v[160:163] offset:8192
  ds_write_b128 v11, v[164:167] offset:9216
  s_waitcnt vmcnt(0)
  v_cmp_ne_u32 vcc, 1, v61
  s_mov_b32 s28, 0
  s_cbranch_vccnz wo_nt
  s_add_u32 s22, s24, 0
  buffer_load_dwordx2 v[28:29], v7, s[8:11], s22 offen offset:0 sc1
  buffer_load_dwordx2 v[30:31], v7, s[8:11], s22 offen offset:512 sc1
  buffer_load_dwordx2 v[32:33], v7, s[8:11], s22 offen offset:256 sc1
  buffer_load_dwordx2 v[34:35], v7, s[8:11], s22 offen offset:768 sc1
  buffer_load_dwordx2 v[36:37], v7, s[8:11], s22 offen offset:2048 sc1
  buffer_load_dwordx2 v[38:39], v7, s[8:11], s22 offen offset:2560 sc1
  buffer_load_dwordx2 v[40:41], v7, s[8:11], s22 offen offset:2304 sc1
  buffer_load_dwordx2 v[42:43], v7, s[8:11], s22 offen offset:2816 sc1
  s_add_u32 s22, s24, 4096
  buffer_load_dwordx2 v[44:45], v7, s[8:11], s22 offen offset:0 sc1
  buffer_load_dwordx2 v[46:47], v7, s[8:11], s22 offen offset:512 sc1
  buffer_load_dwordx2 v[48:49], v7, s[8:11], s22 offen offset:256 sc1
  buffer_load_dwordx2 v[50:51], v7, s[8:11], s22 offen offset:768 sc1
  buffer_load_dwordx2 v[52:53], v7, s[8:11], s22 offen offset:2048 sc1
  buffer_load_dwordx2 v[54:55], v7, s[8:11], s22 offen offset:2560 sc1
  buffer_load_dwordx2 v[56:57], v7, s[8:11], s22 offen offset:2304 sc1
  buffer_load_dwordx2 v[58:59], v7, s[8:11], s22 offen offset:2816 sc1
  s_mov_b32 s28, 1
wo_nt:
  buffer_load_dword v250, v251, s[12:15], 0 offen sc1
  s_waitcnt lgkmcnt(0)
  s_barrier
  buffer_load_dword v61, v60, s[8:11], s26 offen sc1
  ds_read_b128 v[64:67], v6 offset:0
  ds_read_b128 v[68:71], v6 offset:512
  ds_read_b128 v[72:75], v6 offset:1024
  ds_read_b128 v[76:79], v6 offset:1536
  ds_read_b128 v[80:83], v6 offset:2048
  ds_read_b128 v[84:87], v6 offset:2560
  ds_read_b128 v[88:91], v6 offset:3072
  s_waitcnt lgkmcnt(6)
  v_mfma_f32_32x32x16_bf16 v[12:27], a[0:3], v[64:67], 0
  ds_read_b128 v[92:95], v6 offset:3584
  s_waitcnt lgkmcnt(6)
  v_mfma_f32_32x32x16_bf16 v[12:27], a[4:7], v[68:71], v[12:27]
  ds_read_b128 v[64:67], v6 offset:4096
  s_waitcnt lgkmcnt(6)
  v_mfma_f32_32x32x16_bf16 v[12:27], a[8:11], v[72:75], v[12:27]
  ds_read_b128 v[68:71], v6 offset:4608
  s_waitcnt lgkmcnt(6)
  v_mfma_f32_32x32x16_bf16 v[12:27], a[12:15], v[76:79], v[12:27]
  ds_read_b128 v[72:75], v6 offset:5120
  s_waitcnt lgkmcnt(6)
  v_mfma_f32_32x32x16_bf16 v[12:27], a[16:19], v[80:83], v[12:27]
  ds_read_b128 v[76:79], v6 offset:5632
  s_waitcnt lgkmcnt(6)
  v_mfma_f32_32x32x16_bf16 v[12:27], a[20:23], v[84:87], v[12:27]
  ds_read_b128 v[80:83], v6 offset:6144
  s_waitcnt lgkmcnt(6)
  v_mfma_f32_32x32x16_bf16 v[12:27], a[24:27], v[88:91], v[12:27]
  ds_read_b128 v[84:87], v6 offset:6656
  s_waitcnt lgkmcnt(6)
  v_mfma_f32_32x32x16_bf16 v[12:27], a[28:31], v[92:95], v[12:27]
  ds_read_b128 v[88:91], v6 offset:7168
  s_waitcnt lgkmcnt(6)
  v_mfma_f32_32x32x16_bf16 v[12:27], a[32:35], v[64:67], v[12:27]
  ds_read_b128 v[92:95], v6 offset:7680
  s_waitcnt lgkmcnt(6)
  v_mfma_f32_32x32x16_bf16 v[12:27], a[36:39], v[68:71], v[12:27]
  ds_read_b128 v[64:67], v6 offset:8192
  s_waitcnt lgkmcnt(6)
  v_mfma_f32_32x32x16_bf16 v[12:27], a[40:43], v[72:75], v[12:27]
  ds_read_b128 v[68:71], v6 offset:8704
  s_waitcnt lgkmcnt(6)
  v_mfma_f32_32x32x16_bf16 v[12:27], a[44:47], v[76:79], v[12:27]
  ds_read_b128 v[72:75], v6 offset:9216
  s_waitcnt lgkmcnt(6)
  v_mfma_f32_32x32x16_bf16 v[12:27], a[48:51], v[80:83], v[12:27]
  ds_read_b128 v[76:79], v6 offset:9728
  s_waitcnt lgkmcnt(6)
  v_mfma_f32_32x32x16_bf16 v[12:27], a[52:55], v[84:87], v[12:27]
  ds_read_b128 v[80:83], v6 offset:10240
  s_waitcnt lgkmcnt(6)
  v_mfma_f32_32x32x16_bf16 v[12:27], a[56:59], v[88:91], v[12:27]
  ds_read_b128 v[84:87], v6 offset:10752
  s_waitcnt lgkmcnt(6)
  v_mfma_f32_32x32x16_bf16 v[12:27], a[60:63], v[92:95], v[12:27]
  ds_read_b128 v[88:91], v6 offset:11264
  s_waitcnt lgkmcnt(6)
  v_mfma_f32_32x32x16_bf16 v[12:27], a[64:67], v[64:67], v[12:27]
  ds_read_b128 v[92:95], v6 offset:11776
  s_waitcnt lgkmcnt(6)
  v_mfma_f32_32x32x16_bf16 v[12:27], a[68:71], v[68:71], v[12:27]
  ds_read_b128 v[64:67], v6 offset:12288
  s_waitcnt lgkmcnt(6)
  v_mfma_f32_32x32x16_bf16 v[12:27], a[72:75], v[72:75], v[12:27]
  ds_read_b128 v[68:71], v6 offset:12800
  s_waitcnt lgkmcnt(6)
  v_mfma_f32_32x32x16_bf16 v[12:27], a[76:79], v[76:79], v[12:27]
  s_cmp_lg_u32 s28, 0
  s_cbranch_scc1 wo_h2
  s_waitcnt vmcnt(0)
  v_cmp_ne_u32 vcc, 1, v61
  s_cbranch_vccnz wo_h2
  s_add_u32 s22, s24, 0
  buffer_load_dwordx2 v[28:29], v7, s[8:11], s22 offen offset:0 sc1
  buffer_load_dwordx2 v[30:31], v7, s[8:11], s22 offen offset:512 sc1
  buffer_load_dwordx2 v[32:33], v7, s[8:11], s22 offen offset:256 sc1
  buffer_load_dwordx2 v[34:35], v7, s[8:11], s22 offen offset:768 sc1
  buffer_load_dwordx2 v[36:37], v7, s[8:11], s22 offen offset:2048 sc1
  buffer_load_dwordx2 v[38:39], v7, s[8:11], s22 offen offset:2560 sc1
  buffer_load_dwordx2 v[40:41], v7, s[8:11], s22 offen offset:2304 sc1
  buffer_load_dwordx2 v[42:43], v7, s[8:11], s22 offen offset:2816 sc1
  s_add_u32 s22, s24, 4096
  buffer_load_dwordx2 v[44:45], v7, s[8:11], s22 offen offset:0 sc1
  buffer_load_dwordx2 v[46:47], v7, s[8:11], s22 offen offset:512 sc1
  buffer_load_dwordx2 v[48:49], v7, s[8:11], s22 offen offset:256 sc1
  buffer_load_dwordx2 v[50:51], v7, s[8:11], s22 offen offset:768 sc1
  buffer_load_dwordx2 v[52:53], v7, s[8:11], s22 offen offset:2048 sc1
  buffer_load_dwordx2 v[54:55], v7, s[8:11], s22 offen offset:2560 sc1
  buffer_load_dwordx2 v[56:57], v7, s[8:11], s22 offen offset:2304 sc1
  buffer_load_dwordx2 v[58:59], v7, s[8:11], s22 offen offset:2816 sc1
  s_mov_b32 s28, 1
wo_h2:
  ds_read_b128 v[72:75], v6 offset:13312
  s_waitcnt lgkmcnt(6)
  v_mfma_f32_32x32x16_bf16 v[12:27], a[80:83], v[80:83], v[12:27]
  ds_read_b128 v[76:79], v6 offset:13824
  s_waitcnt lgkmcnt(6)
  v_mfma_f32_32x32x16_bf16 v[12:27], a[84:87], v[84:87], v[12:27]
  ds_read_b128 v[80:83], v6 offset:14336
  s_waitcnt lgkmcnt(6)
  v_mfma_f32_32x32x16_bf16 v[12:27], a[88:91], v[88:91], v[12:27]
  ds_read_b128 v[84:87], v6 offset:14848
  s_waitcnt lgkmcnt(6)
  v_mfma_f32_32x32x16_bf16 v[12:27], a[92:95], v[92:95], v[12:27]
  ds_read_b128 v[88:91], v6 offset:15360
  s_waitcnt lgkmcnt(6)
  v_mfma_f32_32x32x16_bf16 v[12:27], a[96:99], v[64:67], v[12:27]
  ds_read_b128 v[92:95], v6 offset:15872
  s_waitcnt lgkmcnt(6)
  v_mfma_f32_32x32x16_bf16 v[12:27], a[100:103], v[68:71], v[12:27]
  ds_read_b128 v[64:67], v6 offset:16384
  s_waitcnt lgkmcnt(6)
  v_mfma_f32_32x32x16_bf16 v[12:27], a[104:107], v[72:75], v[12:27]
  ds_read_b128 v[68:71], v6 offset:16896
  s_waitcnt lgkmcnt(6)
  v_mfma_f32_32x32x16_bf16 v[12:27], a[108:111], v[76:79], v[12:27]
  ds_read_b128 v[72:75], v6 offset:17408
  s_waitcnt lgkmcnt(6)
  v_mfma_f32_32x32x16_bf16 v[12:27], a[112:115], v[80:83], v[12:27]
  ds_read_b128 v[76:79], v6 offset:17920
  s_waitcnt lgkmcnt(6)
  v_mfma_f32_32x32x16_bf16 v[12:27], a[116:119], v[84:87], v[12:27]
  ds_read_b128 v[80:83], v6 offset:18432
  s_waitcnt lgkmcnt(6)
  v_mfma_f32_32x32x16_bf16 v[12:27], a[120:123], v[88:91], v[12:27]
  ds_read_b128 v[84:87], v6 offset:18944
  s_waitcnt lgkmcnt(6)
  v_mfma_f32_32x32x16_bf16 v[12:27], a[124:127], v[92:95], v[12:27]
  s_cmp_lg_u32 s28, 0
  s_cbranch_scc1 wo_ht
  v_lshlrev_b32 v60, 2, v3
  s_mov_b32 s30, 0
wo_wt:
  buffer_load_dword v61, v60, s[8:11], s26 offen sc1
  s_waitcnt vmcnt(0)
  v_cmp_ne_u32 vcc, 1, v61
  s_cbranch_vccz wo_wt_ok
  s_sleep 1
  s_cmp_ge_u32 s17, 61
  s_cbranch_scc1 wo_wt_bo
  s_sleep 4
  s_cmp_ge_u32 s17, 56
  s_cbranch_scc1 wo_wt_bo
  s_sleep 40
wo_wt_bo:
  s_add_u32 s30, s30, 1
  s_cmp_lt_u32 s30, 30000
  s_cbranch_scc1 wo_wt
  s_branch wo_abort
wo_wt_ok:
  s_add_u32 s22, s24, 0
  buffer_load_dwordx2 v[28:29], v7, s[8:11], s22 offen offset:0 sc1
  buffer_load_dwordx2 v[30:31], v7, s[8:11], s22 offen offset:512 sc1
  buffer_load_dwordx2 v[32:33], v7, s[8:11], s22 offen offset:256 sc1
  buffer_load_dwordx2 v[34:35], v7, s[8:11], s22 offen offset:768 sc1
  buffer_load_dwordx2 v[36:37], v7, s[8:11], s22 offen offset:2048 sc1
  buffer_load_dwordx2 v[38:39], v7, s[8:11], s22 offen offset:2560 sc1
  buffer_load_dwordx2 v[40:41], v7, s[8:11], s22 offen offset:2304 sc1
  buffer_load_dwordx2 v[42:43], v7, s[8:11], s22 offen offset:2816 sc1
  s_add_u32 s22, s24, 4096
  buffer_load_dwordx2 v[44:45], v7, s[8:11], s22 offen offset:0 sc1
  buffer_load_dwordx2 v[46:47], v7, s[8:11], s22 offen offset:512 sc1
  buffer_load_dwordx2 v[48:49], v7, s[8:11], s22 offen offset:256 sc1
  buffer_load_dwordx2 v[50:51], v7, s[8:11], s22 offen offset:768 sc1
  buffer_load_dwordx2 v[52:53], v7, s[8:11], s22 offen offset:2048 sc1
  buffer_load_dwordx2 v[54:55], v7, s[8:11], s22 offen offset:2560 sc1
  buffer_load_dwordx2 v[56:57], v7, s[8:11], s22 offen offset:2304 sc1
  buffer_load_dwordx2 v[58:59], v7, s[8:11], s22 offen offset:2816 sc1
wo_ht:
  ds_read_b128 v[88:91], v6 offset:19456
  s_waitcnt lgkmcnt(6) vmcnt(0)
  v_mfma_f32_32x32x16_bf16 v[12:27], v[28:31], v[64:67], v[12:27]
  ds_read_b128 v[92:95], v6 offset:19968
  s_waitcnt lgkmcnt(6)
  v_mfma_f32_32x32x16_bf16 v[12:27], v[32:35], v[68:71], v[12:27]
  s_waitcnt lgkmcnt(5)
  v_mfma_f32_32x32x16_bf16 v[12:27], v[36:39], v[72:75], v[12:27]
  s_waitcnt lgkmcnt(4)
  v_mfma_f32_32x32x16_bf16 v[12:27], v[40:43], v[76:79], v[12:27]
  s_waitcnt lgkmcnt(3)
  v_mfma_f32_32x32x16_bf16 v[12:27], v[44:47], v[80:83], v[12:27]
  s_waitcnt lgkmcnt(2)
  v_mfma_f32_32x32x16_bf16 v[12:27], v[48:51], v[84:87], v[12:27]
  s_waitcnt lgkmcnt(1)
  v_mfma_f32_32x32x16_bf16 v[12:27], v[52:55], v[88:91], v[12:27]
  s_waitcnt lgkmcnt(0)
  v_mfma_f32_32x32x16_bf16 v[12:27], v[56:59], v[92:95], v[12:27]
  v_mul_u32_u24 v9, 240, v9
  s_movk_i32 s23, 240
  v_lshl_add_u32 v8, v8, 3, v9
  s_mul_i32 s22, s16, 56
  v_add_u32 v8, s22, v8
  v_min_u32 v11, 223, v0
  v_mul_u32_u24 v9, 4682, v11
  v_lshrrev_b32 v9, 16, v9
  v_mul_u32_u24 v10, 14, v9
  v_sub_u32 v10, v11, v10
  v_lshlrev_b32 v10, 4, v10
  v_mad_u32_u24 v11, v9, s23, v10
  v_mul_u32_u24 v9, 1792, v9
  v_add_u32 v10, v9, v10
  s_mul_i32 s26, s17, 57344
  s_mul_i32 s22, s18, 224
  s_add_u32 s26, s26, s22
  s_add_u32 s26, s26, 896
  s_add_u32 s27, s26, 28672
  v_cvt_pk_bf16_f32 v96, v12, v13
  v_cvt_pk_bf16_f32 v97, v14, v15
  ds_write_b64 v8, v[96:97] offset:49152
  v_cvt_pk_bf16_f32 v98, v16, v17
  v_cvt_pk_bf16_f32 v99, v18, v19
  ds_write_b64 v8, v[98:99] offset:49168
  v_cvt_pk_bf16_f32 v100, v20, v21
  v_cvt_pk_bf16_f32 v101, v22, v23
  ds_write_b64 v8, v[100:101] offset:49184
  v_cvt_pk_bf16_f32 v102, v24, v25
  v_cvt_pk_bf16_f32 v103, v26, v27
  s_mov_b32 exec_hi, 0
  ds_write_b64 v8, v[102:103] offset:49200
  s_mov_b64 exec, -1
  s_waitcnt lgkmcnt(0)
  s_barrier
  ds_read_b128 v[104:107], v11 offset:49152
  ds_read_b128 v[108:111], v11 offset:52992
  s_cmp_lg_u32 s16, 3
  s_cselect_b32 exec_hi, -1, 0
  s_waitcnt lgkmcnt(1)
  buffer_store_dwordx4 v[104:107], v10, s[92:95], s26 offen
  s_waitcnt lgkmcnt(0)
  buffer_store_dwordx4 v[108:111], v10, s[92:95], s27 offen
  s_mov_b64 exec, -1
  v_readfirstlane_b32 s22, v250
  s_cmp_ge_u32 s22, 1376
  s_cbranch_scc1 ch_end
  s_branch wk_loop
wp_abort:
wo_abort:
  s_branch cA_abort
ch_end:
  s_endpgm

.section .rodata,"a"
.p2align 6
.amdhsa_kernel main_kernel
  .amdhsa_next_free_vgpr 512
  .amdhsa_next_free_sgpr 102
  .amdhsa_accum_offset 256
  .amdhsa_group_segment_fixed_size 0
  .amdhsa_kernarg_size 136
  .amdhsa_user_sgpr_count 2
  .amdhsa_user_sgpr_kernarg_segment_ptr 1
  .amdhsa_system_sgpr_workgroup_id_x 1
.end_amdhsa_kernel
```

```asm
; @launch kernel=main_kernel grid=(256,1,1) block=(256,1,1) lds=163840
.amdgcn_target "amdgcn-amd-amdhsa--gfx950"
.text
.globl main_kernel
.p2align 8
.type main_kernel,@function
main_kernel:
  s_cmp_ge_u32 s2, 256
  s_cbranch_scc1 ch_end
  s_load_dwordx4 s[4:7], s[0:1], 120
  s_load_dwordx2 s[92:93], s[0:1], 112
  s_load_dwordx8 s[36:43], s[0:1], 56
  s_load_dwordx4 s[44:47], s[0:1], 88
  s_memrealtime s[88:89]
  s_getpc_b64 s[98:99]
pf_main_kernel_1:
  s_sub_u32 s98, s98, pf_main_kernel_1-main_kernel
  s_subb_u32 s99, s99, 0
  s_lshr_b32 s20, s2, 3
  v_lshl_add_u32 v60, v0, 5, s20
  v_lshlrev_b32 v60, 7, v60
  v_min_u32 v60, ch_end-main_kernel-4, v60
  v_cmp_gt_u32 vcc, 32, v0
  s_and_saveexec_b64 s[22:23], vcc
  s_cbranch_execz pf_main_kernel_1_n
  global_load_dword v62, v60, s[98:99]
pf_main_kernel_1_n:
  s_mov_b64 exec, -1
  s_getreg_b32 s67, hwreg(HW_REG_XCC_ID)
  s_and_b32 s67, s67, 7
  v_lshrrev_b32 v1, 6, v0
  s_nop 0
  v_readfirstlane_b32 s16, v1
  s_mov_b32 s66, 0
  s_mov_b32 s68, 0
  s_mov_b32 s69, 0
  s_mov_b32 s96, 0
  s_mov_b32 s97, 0
  s_mov_b32 s101, 0x5eed0000
  s_sub_u32 s20, s67, 0
  s_lshr_b32 s21, s2, 3
  s_and_b32 s20, s20, 7
  s_lshl_b32 s3, s20, 5
  s_add_u32 s3, s3, s21
  s_waitcnt lgkmcnt(0)
  s_mov_b32 s8, s6
  s_and_b32 s9, s7, 0xffff
  s_mov_b32 s10, 0x10000000
  s_mov_b32 s11, 0x20000
  s_mov_b32 s12, s4
  s_and_b32 s13, s5, 0xffff
  s_mov_b32 s14, 256
  s_mov_b32 s15, 0x20000
  s_or_b32 s88, s88, 1
  s_and_b32 s93, s93, 0xffff
  s_mov_b32 s94, 3670016
  s_mov_b32 s95, 0x20000
m_start:
  s_cmp_ge_u32 s3, 32
  s_cbranch_scc1 m_bjob
  v_and_b32 v1, 63, v0
  v_lshlrev_b32 v2, 4, v1
  v_lshrrev_b32 v116, 4, v1
  v_and_b32 v117, 15, v1
  v_mov_b32 v3, 0x4444
  v_mov_b32 v118, 0xeeee
  v_cmp_lt_u32 vcc, 7, v117
  s_nop 1
  v_cndmask_b32 v3, v3, v118, vcc
  s_and_b32 s17, s3, 15
  s_cmp_ge_u32 s3, 16
  s_cbranch_scc1 m_val
  s_mov_b32 s60, s42
  s_and_b32 s61, s43, 0xffff
  s_mov_b32 s62, 3670016
  s_mov_b32 s63, 0x20000
  v_lshrrev_b32 v24, 5, v1
  v_and_b32 v25, 31, v1
  s_lshl_b32 s26, s17, 9
  s_lshl_b32 s25, s16, 12
  v_xor_b32 v26, v25, v24
  v_lshlrev_b32 v26, 4, v26
  v_lshl_add_u32 v26, v24, 13, v26
  v_xor_b32 v100, 0, v26
  v_xor_b32 v101, 0, v26
  v_add_u32 v101, 15360, v101
  v_xor_b32 v102, 32, v26
  v_add_u32 v102, 30720, v102
  v_xor_b32 v103, 32, v26
  v_add_u32 v103, 46080, v103
  s_lshl_b32 s23, s16, 19
  s_add_u32 s23, s23, s26
  s_add_u32 m0, s25, 16384
  s_nop 0
  buffer_load_dwordx4 v100, s[60:63], s23 offen offset:0 lds
  buffer_load_dwordx4 v101, s[60:63], s23 offen offset:1024 lds
  buffer_load_dwordx4 v102, s[60:63], s23 offen offset:2048 lds
  buffer_load_dwordx4 v103, s[60:63], s23 offen offset:3072 lds
  s_add_u32 m0, s25, 32768
  s_add_u32 s23, s23, 65536
  buffer_load_dwordx4 v100, s[60:63], s23 offen offset:0 lds
  buffer_load_dwordx4 v101, s[60:63], s23 offen offset:1024 lds
  buffer_load_dwordx4 v102, s[60:63], s23 offen offset:2048 lds
  buffer_load_dwordx4 v103, s[60:63], s23 offen offset:3072 lds
  v_xor_b32 v100, 64, v100
  v_xor_b32 v101, 64, v101
  v_xor_b32 v102, 64, v102
  v_xor_b32 v103, 64, v103
  s_add_u32 m0, s25, 49152
  s_add_u32 s23, s23, 65536
  buffer_load_dwordx4 v100, s[60:63], s23 offen offset:0 lds
  buffer_load_dwordx4 v101, s[60:63], s23 offen offset:1024 lds
  buffer_load_dwordx4 v102, s[60:63], s23 offen offset:2048 lds
  buffer_load_dwordx4 v103, s[60:63], s23 offen offset:3072 lds
  s_add_u32 m0, s25, 65536
  s_add_u32 s23, s23, 65536
  buffer_load_dwordx4 v100, s[60:63], s23 offen offset:0 lds
  buffer_load_dwordx4 v101, s[60:63], s23 offen offset:1024 lds
  buffer_load_dwordx4 v102, s[60:63], s23 offen offset:2048 lds
  buffer_load_dwordx4 v103, s[60:63], s23 offen offset:3072 lds
  v_xor_b32 v100, 192, v100
  v_xor_b32 v101, 192, v101
  v_xor_b32 v102, 192, v102
  v_xor_b32 v103, 192, v103
  s_add_u32 m0, s25, 81920
  s_add_u32 s23, s23, 65536
  buffer_load_dwordx4 v100, s[60:63], s23 offen offset:0 lds
  buffer_load_dwordx4 v101, s[60:63], s23 offen offset:1024 lds
  buffer_load_dwordx4 v102, s[60:63], s23 offen offset:2048 lds
  buffer_load_dwordx4 v103, s[60:63], s23 offen offset:3072 lds
  s_add_u32 m0, s25, 98304
  s_add_u32 s23, s23, 65536
  buffer_load_dwordx4 v100, s[60:63], s23 offen offset:0 lds
  buffer_load_dwordx4 v101, s[60:63], s23 offen offset:1024 lds
  buffer_load_dwordx4 v102, s[60:63], s23 offen offset:2048 lds
  buffer_load_dwordx4 v103, s[60:63], s23 offen offset:3072 lds
  v_xor_b32 v100, 64, v100
  v_xor_b32 v101, 64, v101
  v_xor_b32 v102, 64, v102
  v_xor_b32 v103, 64, v103
  s_add_u32 m0, s25, 114688
  s_add_u32 s23, s23, 65536
  buffer_load_dwordx4 v100, s[60:63], s23 offen offset:0 lds
  buffer_load_dwordx4 v101, s[60:63], s23 offen offset:1024 lds
  buffer_load_dwordx4 v102, s[60:63], s23 offen offset:2048 lds
  buffer_load_dwordx4 v103, s[60:63], s23 offen offset:3072 lds
  s_add_u32 m0, s25, 131072
  s_add_u32 s23, s23, 65536
  buffer_load_dwordx4 v100, s[60:63], s23 offen offset:0 lds
  buffer_load_dwordx4 v101, s[60:63], s23 offen offset:1024 lds
  buffer_load_dwordx4 v102, s[60:63], s23 offen offset:2048 lds
  buffer_load_dwordx4 v103, s[60:63], s23 offen offset:3072 lds
  s_mov_b32 s56, s40
  s_and_b32 s57, s41, 0xffff
  s_mov_b32 s58, 3670016
  s_mov_b32 s59, 0x20000
  s_lshl_b32 s21, s16, 16
  s_add_u32 s27, s26, s21
  s_lshr_b32 s20, s16, 1
  s_lshl_b32 s20, s20, 6
  v_xor_b32 v26, s20, v26
  v_xor_b32 v4, 0, v26
  v_xor_b32 v5, 32, v26
  v_add_u32 v5, 15360, v5
  v_xor_b32 v6, 128, v26
  v_add_u32 v6, 30720, v6
  v_xor_b32 v7, 160, v26
  v_add_u32 v7, 46080, v7
  s_add_u32 s22, s27, 0
  s_add_u32 m0, s25, 0
  s_nop 0
  buffer_load_dwordx4 v4, s[56:59], s22 offen offset:0 lds
  buffer_load_dwordx4 v5, s[56:59], s22 offen offset:1024 lds
  buffer_load_dwordx4 v6, s[56:59], s22 offen offset:2048 lds
  buffer_load_dwordx4 v7, s[56:59], s22 offen offset:3072 lds
  s_cmp_lg_u32 s66, 0
  s_cbranch_scc1 sc_ci
  s_cmp_lg_u32 s16, 0
  s_cbranch_scc1 w0_2
  s_lshr_b32 s70, s3, 5
  s_and_b32 s71, s70, 4
  s_mul_i32 s71, s71, 12
  s_lshl_b32 s70, s70, 2
  s_add_u32 s70, s70, s71
  s_lshl_b32 s71, 1, s3
  v_mov_b32 v248, s71
  v_mov_b32 v249, 32
  s_mov_b64 exec, 1
  buffer_atomic_or v248, v249, s[12:15], s70 offen sc0
  buffer_load_dwordx2 v[250:251], v249, s[12:15], 0 offen offset:96 sc1
  s_mov_b64 exec, -1
w0_2:
sc_ci:
  v_and_b32 v26, 15, v25
  v_xor_b32 v27, v26, v24
  v_lshlrev_b32 v27, 4, v27
  v_bfe_u32 v28, v25, 2, 1
  v_lshlrev_b32 v28, 4, v28
  v_lshrrev_b32 v29, 3, v25
  v_lshl_add_u32 v28, v29, 2, v28
  v_and_b32 v29, 3, v25
  v_add_u32 v28, v28, v29
  v_lshl_add_u32 v28, v28, 9, v27
  v_lshrrev_b32 v29, 2, v26
  v_lshlrev_b32 v29, 15, v29
  v_bfe_u32 v30, v26, 1, 1
  v_lshl_add_u32 v29, v30, 11, v29
  v_lshrrev_b32 v30, 4, v25
  v_lshl_add_u32 v29, v30, 10, v29
  v_and_b32 v31, 1, v26
  v_lshl_add_u32 v29, v31, 9, v29
  v_add_u32 v29, v29, v27
  v_add_u32 v29, s25, v29
  v_xor_b32 v8, 0, v28
  v_xor_b32 v104, 0, v29
  v_xor_b32 v9, 32, v28
  v_xor_b32 v105, 32, v29
  v_xor_b32 v10, 64, v28
  v_xor_b32 v106, 64, v29
  v_xor_b32 v11, 96, v28
  v_xor_b32 v107, 96, v29
  v_xor_b32 v12, 128, v28
  v_xor_b32 v108, 128, v29
  v_xor_b32 v13, 160, v28
  v_xor_b32 v109, 160, v29
  v_xor_b32 v14, 192, v28
  v_xor_b32 v110, 192, v29
  v_xor_b32 v15, 224, v28
  v_xor_b32 v111, 224, v29
  s_mov_b32 s52, 1035512379
  s_waitcnt vmcnt(4)
  ds_read_b128 v[120:123], v104 offset:16384
  ds_read_b128 v[124:127], v105 offset:16384
  ds_read_b128 v[128:131], v106 offset:16384
  ds_read_b128 v[132:135], v107 offset:16384
  ds_read_b128 v[136:139], v108 offset:16384
  ds_read_b128 v[140:143], v109 offset:16384
  ds_read_b128 v[144:147], v110 offset:16384
  ds_read_b128 v[148:151], v111 offset:16384
  s_waitcnt lgkmcnt(4)
  ds_read_b128 v[152:155], v104 offset:16640
  ds_read_b128 v[156:159], v105 offset:16640
  ds_read_b128 v[160:163], v106 offset:16640
  ds_read_b128 v[164:167], v107 offset:16640
  ds_read_b128 v[168:171], v108 offset:16640
  ds_read_b128 v[172:175], v109 offset:16640
  ds_read_b128 v[176:179], v110 offset:16640
  ds_read_b128 v[180:183], v111 offset:16640
  s_waitcnt lgkmcnt(4)
  ds_read_b128 v[184:187], v104 offset:32768
  ds_read_b128 v[188:191], v105 offset:32768
  ds_read_b128 v[192:195], v106 offset:32768
  ds_read_b128 v[196:199], v107 offset:32768
  ds_read_b128 v[200:203], v108 offset:32768
  ds_read_b128 v[204:207], v109 offset:32768
  ds_read_b128 v[208:211], v110 offset:32768
  ds_read_b128 v[212:215], v111 offset:32768
  s_waitcnt lgkmcnt(4)
  ds_read_b128 v[216:219], v104 offset:33024
  ds_read_b128 v[220:223], v105 offset:33024
  ds_read_b128 v[224:227], v106 offset:33024
  ds_read_b128 v[228:231], v107 offset:33024
  ds_read_b128 v[232:235], v108 offset:33024
  ds_read_b128 v[236:239], v109 offset:33024
  ds_read_b128 v[240:243], v110 offset:33024
  ds_read_b128 v[244:247], v111 offset:33024
  s_waitcnt lgkmcnt(4)
  s_waitcnt lgkmcnt(0)
  s_add_u32 s22, s27, 262144
  s_add_u32 m0, s25, 16384
  s_nop 0
  buffer_load_dwordx4 v4, s[56:59], s22 offen offset:0 lds
  buffer_load_dwordx4 v5, s[56:59], s22 offen offset:1024 lds
  buffer_load_dwordx4 v6, s[56:59], s22 offen offset:2048 lds
  buffer_load_dwordx4 v7, s[56:59], s22 offen offset:3072 lds
  s_add_u32 s22, s27, 524288
  s_add_u32 m0, s25, 32768
  s_nop 0
  buffer_load_dwordx4 v4, s[56:59], s22 offen offset:0 lds
  buffer_load_dwordx4 v5, s[56:59], s22 offen offset:1024 lds
  buffer_load_dwordx4 v6, s[56:59], s22 offen offset:2048 lds
  buffer_load_dwordx4 v7, s[56:59], s22 offen offset:3072 lds
  s_add_u32 s22, s27, 786432
  s_add_u32 m0, s25, 49152
  s_nop 0
  buffer_load_dwordx4 v4, s[56:59], s22 offen offset:0 lds
  buffer_load_dwordx4 v5, s[56:59], s22 offen offset:1024 lds
  buffer_load_dwordx4 v6, s[56:59], s22 offen offset:2048 lds
  buffer_load_dwordx4 v7, s[56:59], s22 offen offset:3072 lds
  s_cmp_lg_u32 s66, 0
  s_cbranch_scc1 sc_cf
  s_cmp_lg_u32 s16, 0
  s_cbranch_scc1 w0_3
  s_waitcnt vmcnt(12)
  v_readfirstlane_b32 s70, v250
  s_cmp_lg_u32 s70, 0
  s_cbranch_scc1 sc_nz
  v_mov_b32 v249, 128
  v_mov_b32 v250, s88
  v_mov_b32 v251, s89
  v_mov_b32 v252, 0
  v_mov_b32 v253, 0
  s_mov_b64 exec, 1
  buffer_atomic_cmpswap_x2 v[250:253], v249, s[12:15], 0 offen sc0
  s_mov_b64 exec, -1
  s_waitcnt vmcnt(0)
  v_readfirstlane_b32 s70, v250
  s_cmp_lg_u32 s70, 0
  s_cbranch_scc1 sc_nz
  v_mov_b32 v250, s88
  v_mov_b32 v251, s89
sc_nz:
w0_3:
  v_mov_b32 v249, 160000
  s_add_u32 s101, s101, 1
  s_barrier
  s_mov_b64 exec, 1
  s_cmp_lg_u32 s16, 0
  s_cbranch_scc1 w0_4
  ds_write_b32 v249, v248 offset:0
  ds_write_b32 v249, v250 offset:4
  ds_write_b32 v249, v251 offset:8
  s_waitcnt lgkmcnt(0)
  v_mov_b32 v248, s101
  ds_write_b32 v249, v248 offset:16
  s_waitcnt lgkmcnt(0)
w0_4:
  s_mov_b64 exec, -1
  s_barrier
  ds_read_b32 v248, v249 offset:0
  ds_read_b32 v250, v249 offset:4
  ds_read_b32 v251, v249 offset:8
  ds_read_b32 v249, v249 offset:16
  s_waitcnt lgkmcnt(0)
  v_readfirstlane_b32 s70, v248
  v_readfirstlane_b32 s88, v250
  v_readfirstlane_b32 s89, v251
  v_cmp_ne_u32 vcc, s101, v249
  s_cbranch_vccnz ch_end
  s_mov_b32 s66, 1
  s_bitcmp1_b32 s70, s3
  s_cbranch_scc1 m_reclaim
sc_cf:
  s_cmp_lg_u32 s16, 0
  s_cbranch_scc1 w0_5
  s_cmp_eq_u32 s67, 0
  s_cselect_b32 s20, 1, 0x10001
  v_mov_b32 v248, s20
  v_mov_b32 v249, 0
  s_mov_b64 exec, 1
  buffer_atomic_add v248, v249, s[12:15], 0 offen
  s_mov_b64 exec, -1
w0_5:
  s_lshl_b32 s28, s17, 7
  s_add_u32 s28, s28, 88623104
  v_min_u32 v113, 96, v2
  s_mov_b32 s29, 88590336
  v_add_u32 v112, 1024, v2
  v_min_u32 v112, 1776, v112
  s_mul_i32 s32, s17, 401408
  s_mul_i32 s33, s16, 14336
  s_add_u32 s32, s32, s33
  s_add_u32 s33, s32, s33
  s_add_u32 s32, s32, 344064
  s_add_u32 s33, s33, 229376
  s_waitcnt vmcnt(8)
  s_barrier
  ds_read_b128 v[16:19], v8 offset:0
  ds_read_b128 v[20:23], v9 offset:0
  ds_read_b128 v[24:27], v10 offset:0
  ds_read_b128 v[28:31], v11 offset:0
  s_waitcnt lgkmcnt(3)
  v_mfma_f32_32x32x16_bf16 v[32:47], v[16:19], v[120:123], 0
  s_add_u32 s22, s27, 1048576
  s_add_u32 m0, s25, 65536
  s_nop 0
  buffer_load_dwordx4 v4, s[56:59], s22 offen offset:0 lds
  v_mfma_f32_32x32x16_bf16 v[48:63], v[16:19], v[184:187], 0
  ds_read_b128 v[16:19], v12 offset:0
  s_waitcnt lgkmcnt(3)
  v_mfma_f32_32x32x16_bf16 v[32:47], v[20:23], v[124:127], v[32:47]
  buffer_load_dwordx4 v5, s[56:59], s22 offen offset:1024 lds
  v_mfma_f32_32x32x16_bf16 v[48:63], v[20:23], v[188:191], v[48:63]
  ds_read_b128 v[20:23], v13 offset:0
  s_waitcnt lgkmcnt(3)
  v_mfma_f32_32x32x16_bf16 v[32:47], v[24:27], v[128:131], v[32:47]
  buffer_load_dwordx4 v6, s[56:59], s22 offen offset:2048 lds
  v_mfma_f32_32x32x16_bf16 v[48:63], v[24:27], v[192:195], v[48:63]
  ds_read_b128 v[24:27], v14 offset:0
  s_waitcnt lgkmcnt(3)
  v_mfma_f32_32x32x16_bf16 v[32:47], v[28:31], v[132:135], v[32:47]
  buffer_load_dwordx4 v7, s[56:59], s22 offen offset:3072 lds
  v_mfma_f32_32x32x16_bf16 v[48:63], v[28:31], v[196:199], v[48:63]
  ds_read_b128 v[28:31], v15 offset:0
  s_waitcnt lgkmcnt(3)
  v_mfma_f32_32x32x16_bf16 v[32:47], v[16:19], v[136:139], v[32:47]
  s_add_u32 s22, s27, 1310720
  s_add_u32 m0, s25, 81920
  s_nop 0
  buffer_load_dwordx4 v4, s[56:59], s22 offen offset:0 lds
  v_mfma_f32_32x32x16_bf16 v[48:63], v[16:19], v[200:203], v[48:63]
  ds_read_b128 v[16:19], v8 offset:256
  s_waitcnt lgkmcnt(3)
  v_mfma_f32_32x32x16_bf16 v[32:47], v[20:23], v[140:143], v[32:47]
  buffer_load_dwordx4 v5, s[56:59], s22 offen offset:1024 lds
  v_mfma_f32_32x32x16_bf16 v[48:63], v[20:23], v[204:207], v[48:63]
  ds_read_b128 v[20:23], v9 offset:256
  s_waitcnt lgkmcnt(3)
  v_mfma_f32_32x32x16_bf16 v[32:47], v[24:27], v[144:147], v[32:47]
  buffer_load_dwordx4 v6, s[56:59], s22 offen offset:2048 lds
  v_mfma_f32_32x32x16_bf16 v[48:63], v[24:27], v[208:211], v[48:63]
  ds_read_b128 v[24:27], v10 offset:256
  s_waitcnt lgkmcnt(3)
  v_mfma_f32_32x32x16_bf16 v[32:47], v[28:31], v[148:151], v[32:47]
  buffer_load_dwordx4 v7, s[56:59], s22 offen offset:3072 lds
  v_mfma_f32_32x32x16_bf16 v[48:63], v[28:31], v[212:215], v[48:63]
  ds_read_b128 v[28:31], v11 offset:256
  s_waitcnt lgkmcnt(3)
  v_mfma_f32_32x32x16_bf16 v[32:47], v[16:19], v[152:155], v[32:47]
  s_add_u32 s22, s27, 1572864
  s_add_u32 m0, s25, 98304
  s_nop 0
  buffer_load_dwordx4 v4, s[56:59], s22 offen offset:0 lds
  v_mfma_f32_32x32x16_bf16 v[48:63], v[16:19], v[216:219], v[48:63]
  ds_read_b128 v[16:19], v12 offset:256
  s_waitcnt lgkmcnt(3)
  v_mfma_f32_32x32x16_bf16 v[32:47], v[20:23], v[156:159], v[32:47]
  buffer_load_dwordx4 v5, s[56:59], s22 offen offset:1024 lds
  v_mfma_f32_32x32x16_bf16 v[48:63], v[20:23], v[220:223], v[48:63]
  ds_read_b128 v[20:23], v13 offset:256
  s_waitcnt lgkmcnt(3)
  v_mfma_f32_32x32x16_bf16 v[32:47], v[24:27], v[160:163], v[32:47]
  buffer_load_dwordx4 v6, s[56:59], s22 offen offset:2048 lds
  v_mfma_f32_32x32x16_bf16 v[48:63], v[24:27], v[224:227], v[48:63]
  ds_read_b128 v[24:27], v14 offset:256
  s_waitcnt lgkmcnt(3)
  v_mfma_f32_32x32x16_bf16 v[32:47], v[28:31], v[164:167], v[32:47]
  buffer_load_dwordx4 v7, s[56:59], s22 offen offset:3072 lds
  v_mfma_f32_32x32x16_bf16 v[48:63], v[28:31], v[228:231], v[48:63]
  ds_read_b128 v[28:31], v15 offset:256
  s_waitcnt lgkmcnt(3)
  v_mfma_f32_32x32x16_bf16 v[32:47], v[16:19], v[168:171], v[32:47]
  s_add_u32 s22, s27, 1835008
  s_add_u32 m0, s25, 114688
  s_nop 0
  buffer_load_dwordx4 v4, s[56:59], s22 offen offset:0 lds
  v_mfma_f32_32x32x16_bf16 v[48:63], v[16:19], v[232:235], v[48:63]
  ds_read_b128 v[16:19], v8 offset:16384
  s_waitcnt lgkmcnt(3)
  v_mfma_f32_32x32x16_bf16 v[32:47], v[20:23], v[172:175], v[32:47]
  buffer_load_dwordx4 v5, s[56:59], s22 offen offset:1024 lds
  v_mfma_f32_32x32x16_bf16 v[48:63], v[20:23], v[236:239], v[48:63]
  ds_read_b128 v[20:23], v9 offset:16384
  s_waitcnt lgkmcnt(3)
  v_mfma_f32_32x32x16_bf16 v[32:47], v[24:27], v[176:179], v[32:47]
  buffer_load_dwordx4 v6, s[56:59], s22 offen offset:2048 lds
  v_mfma_f32_32x32x16_bf16 v[48:63], v[24:27], v[240:243], v[48:63]
  ds_read_b128 v[24:27], v10 offset:16384
  s_waitcnt lgkmcnt(3)
  v_mfma_f32_32x32x16_bf16 v[32:47], v[28:31], v[180:183], v[32:47]
  buffer_load_dwordx4 v7, s[56:59], s22 offen offset:3072 lds
  v_mfma_f32_32x32x16_bf16 v[48:63], v[28:31], v[244:247], v[48:63]
  s_waitcnt vmcnt(16)
  s_barrier
  ds_read_b128 v[28:31], v11 offset:16384
  s_waitcnt lgkmcnt(3)
  v_mfma_f32_32x32x16_bf16 v[64:79], v[16:19], v[120:123], 0
  s_add_u32 s22, s27, 2097152
  s_add_u32 m0, s25, 131072
  s_nop 0
  buffer_load_dwordx4 v4, s[56:59], s22 offen offset:0 lds
  v_mfma_f32_32x32x16_bf16 v[80:95], v[16:19], v[184:187], 0
  ds_read_b128 v[16:19], v12 offset:16384
  s_waitcnt lgkmcnt(3)
  v_mfma_f32_32x32x16_bf16 v[64:79], v[20:23], v[124:127], v[64:79]
  buffer_load_dwordx4 v5, s[56:59], s22 offen offset:1024 lds
  v_mul_f32 v32, s52, v32
  v_mul_f32 v33, s52, v33
  v_cvt_pk_bf16_f32 v32, v32, v33
  v_mfma_f32_32x32x16_bf16 v[80:95], v[20:23], v[188:191], v[80:95]
  v_mul_f32 v34, s52, v34
  v_mul_f32 v35, s52, v35
  ds_read_b128 v[20:23], v13 offset:16384
  s_waitcnt lgkmcnt(3)
  v_mfma_f32_32x32x16_bf16 v[64:79], v[24:27], v[128:131], v[64:79]
  buffer_load_dwordx4 v6, s[56:59], s22 offen offset:2048 lds
  v_cvt_pk_bf16_f32 v33, v34, v35
  v_mul_f32 v36, s52, v36
  v_mul_f32 v37, s52, v37
  v_mfma_f32_32x32x16_bf16 v[80:95], v[24:27], v[192:195], v[80:95]
  v_cvt_pk_bf16_f32 v34, v36, v37
  v_mul_f32 v38, s52, v38
  ds_read_b128 v[24:27], v14 offset:16384
  s_waitcnt lgkmcnt(3)
  v_mfma_f32_32x32x16_bf16 v[64:79], v[28:31], v[132:135], v[64:79]
  buffer_load_dwordx4 v7, s[56:59], s22 offen offset:3072 lds
  v_mul_f32 v39, s52, v39
  v_cvt_pk_bf16_f32 v35, v38, v39
  v_mul_f32 v40, s52, v40
  v_mfma_f32_32x32x16_bf16 v[80:95], v[28:31], v[196:199], v[80:95]
  v_mul_f32 v41, s52, v41
  v_cvt_pk_bf16_f32 v40, v40, v41
  ds_read_b128 v[28:31], v15 offset:16384
  s_waitcnt lgkmcnt(3)
  v_mfma_f32_32x32x16_bf16 v[64:79], v[16:19], v[136:139], v[64:79]
  s_add_u32 s22, s27, 2359296
  s_add_u32 m0, s25, 0
  s_nop 0
  buffer_load_dwordx4 v4, s[56:59], s22 offen offset:0 lds
  v_mul_f32 v42, s52, v42
  v_mul_f32 v43, s52, v43
  v_cvt_pk_bf16_f32 v41, v42, v43
  v_mfma_f32_32x32x16_bf16 v[80:95], v[16:19], v[200:203], v[80:95]
  v_mul_f32 v44, s52, v44
  v_mul_f32 v45, s52, v45
  ds_read_b128 v[16:19], v8 offset:16640
  s_waitcnt lgkmcnt(3)
  v_mfma_f32_32x32x16_bf16 v[64:79], v[20:23], v[140:143], v[64:79]
  buffer_load_dwordx4 v5, s[56:59], s22 offen offset:1024 lds
  v_cvt_pk_bf16_f32 v42, v44, v45
  v_mul_f32 v46, s52, v46
  v_mul_f32 v47, s52, v47
  v_mfma_f32_32x32x16_bf16 v[80:95], v[20:23], v[204:207], v[80:95]
  v_cvt_pk_bf16_f32 v43, v46, v47
  v_permlane16_swap_b32 v32, v40
  ds_read_b128 v[20:23], v9 offset:16640
  s_waitcnt lgkmcnt(3)
  v_mfma_f32_32x32x16_bf16 v[64:79], v[24:27], v[144:147], v[64:79]
  buffer_load_dwordx4 v6, s[56:59], s22 offen offset:2048 lds
  v_permlane16_swap_b32 v33, v41
  v_permlane16_swap_b32 v34, v42
  v_permlane16_swap_b32 v35, v43
  v_mfma_f32_32x32x16_bf16 v[80:95], v[24:27], v[208:211], v[80:95]
  v_accvgpr_write_b32 a0, v32
  v_accvgpr_write_b32 a1, v33
  ds_read_b128 v[24:27], v10 offset:16640
  s_waitcnt lgkmcnt(3)
  v_mfma_f32_32x32x16_bf16 v[64:79], v[28:31], v[148:151], v[64:79]
  buffer_load_dwordx4 v7, s[56:59], s22 offen offset:3072 lds
  v_accvgpr_write_b32 a2, v34
  v_accvgpr_write_b32 a3, v35
  v_accvgpr_write_b32 a56, v40
  v_mfma_f32_32x32x16_bf16 v[80:95], v[28:31], v[212:215], v[80:95]
  v_accvgpr_write_b32 a57, v41
  v_accvgpr_write_b32 a58, v42
  ds_read_b128 v[28:31], v11 offset:16640
  s_waitcnt lgkmcnt(3)
  v_mfma_f32_32x32x16_bf16 v[64:79], v[16:19], v[152:155], v[64:79]
  v_accvgpr_write_b32 a59, v43
  v_mul_f32 v48, s52, v48
  v_mul_f32 v49, s52, v49
  v_mfma_f32_32x32x16_bf16 v[80:95], v[16:19], v[216:219], v[80:95]
  v_cvt_pk_bf16_f32 v48, v48, v49
  v_mul_f32 v50, s52, v50
  ds_read_b128 v[16:19], v12 offset:16640
  s_waitcnt lgkmcnt(3)
  v_mfma_f32_32x32x16_bf16 v[64:79], v[20:23], v[156:159], v[64:79]
  v_mul_f32 v51, s52, v51
  v_cvt_pk_bf16_f32 v49, v50, v51
  v_mul_f32 v52, s52, v52
  v_mfma_f32_32x32x16_bf16 v[80:95], v[20:23], v[220:223], v[80:95]
  v_mul_f32 v53, s52, v53
  v_cvt_pk_bf16_f32 v50, v52, v53
  ds_read_b128 v[20:23], v13 offset:16640
  s_waitcnt lgkmcnt(3)
  v_mfma_f32_32x32x16_bf16 v[64:79], v[24:27], v[160:163], v[64:79]
  v_mul_f32 v54, s52, v54
  v_mul_f32 v55, s52, v55
  v_cvt_pk_bf16_f32 v51, v54, v55
  v_mfma_f32_32x32x16_bf16 v[80:95], v[24:27], v[224:227], v[80:95]
  v_mul_f32 v56, s52, v56
  v_mul_f32 v57, s52, v57
  ds_read_b128 v[24:27], v14 offset:16640
  s_waitcnt lgkmcnt(3)
  v_mfma_f32_32x32x16_bf16 v[64:79], v[28:31], v[164:167], v[64:79]
  v_cvt_pk_bf16_f32 v56, v56, v57
  v_mul_f32 v58, s52, v58
  v_mul_f32 v59, s52, v59
  v_mfma_f32_32x32x16_bf16 v[80:95], v[28:31], v[228:231], v[80:95]
  v_cvt_pk_bf16_f32 v57, v58, v59
  v_mul_f32 v60, s52, v60
  ds_read_b128 v[28:31], v15 offset:16640
  s_waitcnt lgkmcnt(3)
  v_mfma_f32_32x32x16_bf16 v[64:79], v[16:19], v[168:171], v[64:79]
  v_mul_f32 v61, s52, v61
  v_cvt_pk_bf16_f32 v58, v60, v61
  v_mul_f32 v62, s52, v62
  v_mfma_f32_32x32x16_bf16 v[80:95], v[16:19], v[232:235], v[80:95]
  v_mul_f32 v63, s52, v63
  v_cvt_pk_bf16_f32 v59, v62, v63
  ds_read_b128 v[16:19], v8 offset:32768
  s_waitcnt lgkmcnt(3)
  v_mfma_f32_32x32x16_bf16 v[64:79], v[20:23], v[172:175], v[64:79]
  v_permlane16_swap_b32 v48, v56
  v_permlane16_swap_b32 v49, v57
  v_permlane16_swap_b32 v50, v58
  v_mfma_f32_32x32x16_bf16 v[80:95], v[20:23], v[236:239], v[80:95]
  v_permlane16_swap_b32 v51, v59
  v_accvgpr_write_b32 a112, v48
  ds_read_b128 v[20:23], v9 offset:32768
  s_waitcnt lgkmcnt(3)
  v_mfma_f32_32x32x16_bf16 v[64:79], v[24:27], v[176:179], v[64:79]
  v_accvgpr_write_b32 a113, v49
  v_accvgpr_write_b32 a114, v50
  v_accvgpr_write_b32 a115, v51
  v_mfma_f32_32x32x16_bf16 v[80:95], v[24:27], v[240:243], v[80:95]
  v_accvgpr_write_b32 a168, v56
  v_accvgpr_write_b32 a169, v57
  ds_read_b128 v[24:27], v10 offset:32768
  s_waitcnt lgkmcnt(3)
  v_mfma_f32_32x32x16_bf16 v[64:79], v[28:31], v[180:183], v[64:79]
  v_accvgpr_write_b32 a170, v58
  v_accvgpr_write_b32 a171, v59
  v_mfma_f32_32x32x16_bf16 v[80:95], v[28:31], v[244:247], v[80:95]
  ds_read_b128 v[28:31], v11 offset:32768
  s_waitcnt lgkmcnt(3)
  v_mfma_f32_32x32x16_bf16 v[32:47], v[16:19], v[120:123], 0
  v_mfma_f32_32x32x16_bf16 v[48:63], v[16:19], v[184:187], 0
  ds_read_b128 v[16:19], v12 offset:32768
  s_waitcnt lgkmcnt(3)
  v_mfma_f32_32x32x16_bf16 v[32:47], v[20:23], v[124:127], v[32:47]
  v_mul_f32 v64, s52, v64
  v_mul_f32 v65, s52, v65
  v_cvt_pk_bf16_f32 v64, v64, v65
  v_mfma_f32_32x32x16_bf16 v[48:63], v[20:23], v[188:191], v[48:63]
  v_mul_f32 v66, s52, v66
  v_mul_f32 v67, s52, v67
  ds_read_b128 v[20:23], v13 offset:32768
  s_waitcnt lgkmcnt(3)
  v_mfma_f32_32x32x16_bf16 v[32:47], v[24:27], v[128:131], v[32:47]
  v_cvt_pk_bf16_f32 v65, v66, v67
  v_mul_f32 v68, s52, v68
  v_mul_f32 v69, s52, v69
  v_mfma_f32_32x32x16_bf16 v[48:63], v[24:27], v[192:195], v[48:63]
  v_cvt_pk_bf16_f32 v66, v68, v69
  v_mul_f32 v70, s52, v70
  ds_read_b128 v[24:27], v14 offset:32768
  s_waitcnt lgkmcnt(3)
  v_mfma_f32_32x32x16_bf16 v[32:47], v[28:31], v[132:135], v[32:47]
  v_mul_f32 v71, s52, v71
  v_cvt_pk_bf16_f32 v67, v70, v71
  v_mul_f32 v72, s52, v72
  v_mfma_f32_32x32x16_bf16 v[48:63], v[28:31], v[196:199], v[48:63]
  v_mul_f32 v73, s52, v73
  v_cvt_pk_bf16_f32 v72, v72, v73
  ds_read_b128 v[28:31], v15 offset:32768
  s_waitcnt lgkmcnt(3)
  v_mfma_f32_32x32x16_bf16 v[32:47], v[16:19], v[136:139], v[32:47]
  v_mul_f32 v74, s52, v74
  v_mul_f32 v75, s52, v75
  v_cvt_pk_bf16_f32 v73, v74, v75
  v_mfma_f32_32x32x16_bf16 v[48:63], v[16:19], v[200:203], v[48:63]
  v_mul_f32 v76, s52, v76
  v_mul_f32 v77, s52, v77
  ds_read_b128 v[16:19], v8 offset:33024
  s_waitcnt lgkmcnt(3)
  v_mfma_f32_32x32x16_bf16 v[32:47], v[20:23], v[140:143], v[32:47]
  v_cvt_pk_bf16_f32 v74, v76, v77
  v_mul_f32 v78, s52, v78
  v_mul_f32 v79, s52, v79
  v_mfma_f32_32x32x16_bf16 v[48:63], v[20:23], v[204:207], v[48:63]
  v_cvt_pk_bf16_f32 v75, v78, v79
  v_permlane16_swap_b32 v64, v72
  ds_read_b128 v[20:23], v9 offset:33024
  s_waitcnt lgkmcnt(3)
  v_mfma_f32_32x32x16_bf16 v[32:47], v[24:27], v[144:147], v[32:47]
  v_permlane16_swap_b32 v65, v73
  v_permlane16_swap_b32 v66, v74
  v_permlane16_swap_b32 v67, v75
  v_mfma_f32_32x32x16_bf16 v[48:63], v[24:27], v[208:211], v[48:63]
  v_accvgpr_write_b32 a4, v64
  v_accvgpr_write_b32 a5, v65
  ds_read_b128 v[24:27], v10 offset:33024
  s_waitcnt lgkmcnt(3)
  v_mfma_f32_32x32x16_bf16 v[32:47], v[28:31], v[148:151], v[32:47]
  v_accvgpr_write_b32 a6, v66
  v_accvgpr_write_b32 a7, v67
  v_accvgpr_write_b32 a60, v72
  v_mfma_f32_32x32x16_bf16 v[48:63], v[28:31], v[212:215], v[48:63]
  v_accvgpr_write_b32 a61, v73
  v_accvgpr_write_b32 a62, v74
  ds_read_b128 v[28:31], v11 offset:33024
  s_waitcnt lgkmcnt(3)
  v_mfma_f32_32x32x16_bf16 v[32:47], v[16:19], v[152:155], v[32:47]
  v_accvgpr_write_b32 a63, v75
  v_mul_f32 v80, s52, v80
  v_mul_f32 v81, s52, v81
  v_mfma_f32_32x32x16_bf16 v[48:63], v[16:19], v[216:219], v[48:63]
  v_cvt_pk_bf16_f32 v80, v80, v81
  v_mul_f32 v82, s52, v82
  ds_read_b128 v[16:19], v12 offset:33024
  s_waitcnt lgkmcnt(3)
  v_mfma_f32_32x32x16_bf16 v[32:47], v[20:23], v[156:159], v[32:47]
  v_mul_f32 v83, s52, v83
  v_cvt_pk_bf16_f32 v81, v82, v83
  v_mul_f32 v84, s52, v84
  v_mfma_f32_32x32x16_bf16 v[48:63], v[20:23], v[220:223], v[48:63]
  v_mul_f32 v85, s52, v85
  v_cvt_pk_bf16_f32 v82, v84, v85
  ds_read_b128 v[20:23], v13 offset:33024
  s_waitcnt lgkmcnt(3)
  v_mfma_f32_32x32x16_bf16 v[32:47], v[24:27], v[160:163], v[32:47]
  v_mul_f32 v86, s52, v86
  v_mul_f32 v87, s52, v87
  v_cvt_pk_bf16_f32 v83, v86, v87
  v_mfma_f32_32x32x16_bf16 v[48:63], v[24:27], v[224:227], v[48:63]
  v_mul_f32 v88, s52, v88
  v_mul_f32 v89, s52, v89
  ds_read_b128 v[24:27], v14 offset:33024
  s_waitcnt lgkmcnt(3)
  v_mfma_f32_32x32x16_bf16 v[32:47], v[28:31], v[164:167], v[32:47]
  v_cvt_pk_bf16_f32 v88, v88, v89
  v_mul_f32 v90, s52, v90
  v_mul_f32 v91, s52, v91
  v_mfma_f32_32x32x16_bf16 v[48:63], v[28:31], v[228:231], v[48:63]
  v_cvt_pk_bf16_f32 v89, v90, v91
  v_mul_f32 v92, s52, v92
  ds_read_b128 v[28:31], v15 offset:33024
  s_waitcnt lgkmcnt(3)
  v_mfma_f32_32x32x16_bf16 v[32:47], v[16:19], v[168:171], v[32:47]
  v_mul_f32 v93, s52, v93
  v_cvt_pk_bf16_f32 v90, v92, v93
  v_mul_f32 v94, s52, v94
  v_mfma_f32_32x32x16_bf16 v[48:63], v[16:19], v[232:235], v[48:63]
  v_mul_f32 v95, s52, v95
  v_cvt_pk_bf16_f32 v91, v94, v95
  ds_read_b128 v[16:19], v8 offset:49152
  s_waitcnt lgkmcnt(3)
  v_mfma_f32_32x32x16_bf16 v[32:47], v[20:23], v[172:175], v[32:47]
  v_permlane16_swap_b32 v80, v88
  v_permlane16_swap_b32 v81, v89
  v_permlane16_swap_b32 v82, v90
  v_mfma_f32_32x32x16_bf16 v[48:63], v[20:23], v[236:239], v[48:63]
  v_permlane16_swap_b32 v83, v91
  v_accvgpr_write_b32 a116, v80
  ds_read_b128 v[20:23], v9 offset:49152
  s_waitcnt lgkmcnt(3)
  v_mfma_f32_32x32x16_bf16 v[32:47], v[24:27], v[176:179], v[32:47]
  v_accvgpr_write_b32 a117, v81
  v_accvgpr_write_b32 a118, v82
  v_accvgpr_write_b32 a119, v83
  v_mfma_f32_32x32x16_bf16 v[48:63], v[24:27], v[240:243], v[48:63]
  v_accvgpr_write_b32 a172, v88
  v_accvgpr_write_b32 a173, v89
  ds_read_b128 v[24:27], v10 offset:49152
  s_waitcnt lgkmcnt(3)
  v_mfma_f32_32x32x16_bf16 v[32:47], v[28:31], v[180:183], v[32:47]
  v_accvgpr_write_b32 a174, v90
  v_accvgpr_write_b32 a175, v91
  v_mfma_f32_32x32x16_bf16 v[48:63], v[28:31], v[244:247], v[48:63]
  s_waitcnt vmcnt(16)
  s_barrier
  ds_read_b128 v[28:31], v11 offset:49152
  s_waitcnt lgkmcnt(3)
  v_mfma_f32_32x32x16_bf16 v[64:79], v[16:19], v[120:123], 0
  s_add_u32 s22, s27, 2621440
  s_add_u32 m0, s25, 16384
  s_nop 0
  buffer_load_dwordx4 v4, s[56:59], s22 offen offset:0 lds
  v_mfma_f32_32x32x16_bf16 v[80:95], v[16:19], v[184:187], 0
  ds_read_b128 v[16:19], v12 offset:49152
  s_waitcnt lgkmcnt(3)
  v_mfma_f32_32x32x16_bf16 v[64:79], v[20:23], v[124:127], v[64:79]
  buffer_load_dwordx4 v5, s[56:59], s22 offen offset:1024 lds
  v_mul_f32 v32, s52, v32
  v_mul_f32 v33, s52, v33
  v_cvt_pk_bf16_f32 v32, v32, v33
  v_mfma_f32_32x32x16_bf16 v[80:95], v[20:23], v[188:191], v[80:95]
  v_mul_f32 v34, s52, v34
  v_mul_f32 v35, s52, v35
  ds_read_b128 v[20:23], v13 offset:49152
  s_waitcnt lgkmcnt(3)
  v_mfma_f32_32x32x16_bf16 v[64:79], v[24:27], v[128:131], v[64:79]
  buffer_load_dwordx4 v6, s[56:59], s22 offen offset:2048 lds
  v_cvt_pk_bf16_f32 v33, v34, v35
  v_mul_f32 v36, s52, v36
  v_mul_f32 v37, s52, v37
  v_mfma_f32_32x32x16_bf16 v[80:95], v[24:27], v[192:195], v[80:95]
  v_cvt_pk_bf16_f32 v34, v36, v37
  v_mul_f32 v38, s52, v38
  ds_read_b128 v[24:27], v14 offset:49152
  s_waitcnt lgkmcnt(3)
  v_mfma_f32_32x32x16_bf16 v[64:79], v[28:31], v[132:135], v[64:79]
  buffer_load_dwordx4 v7, s[56:59], s22 offen offset:3072 lds
  v_mul_f32 v39, s52, v39
  v_cvt_pk_bf16_f32 v35, v38, v39
  v_mul_f32 v40, s52, v40
  v_mfma_f32_32x32x16_bf16 v[80:95], v[28:31], v[196:199], v[80:95]
  v_mul_f32 v41, s52, v41
  v_cvt_pk_bf16_f32 v40, v40, v41
  ds_read_b128 v[28:31], v15 offset:49152
  s_waitcnt lgkmcnt(3)
  v_mfma_f32_32x32x16_bf16 v[64:79], v[16:19], v[136:139], v[64:79]
  s_add_u32 s22, s27, 2883584
  s_add_u32 m0, s25, 32768
  s_nop 0
  buffer_load_dwordx4 v4, s[56:59], s22 offen offset:0 lds
  v_mul_f32 v42, s52, v42
  v_mul_f32 v43, s52, v43
  v_cvt_pk_bf16_f32 v41, v42, v43
  v_mfma_f32_32x32x16_bf16 v[80:95], v[16:19], v[200:203], v[80:95]
  v_mul_f32 v44, s52, v44
  v_mul_f32 v45, s52, v45
  ds_read_b128 v[16:19], v8 offset:49408
  s_waitcnt lgkmcnt(3)
  v_mfma_f32_32x32x16_bf16 v[64:79], v[20:23], v[140:143], v[64:79]
  buffer_load_dwordx4 v5, s[56:59], s22 offen offset:1024 lds
  v_cvt_pk_bf16_f32 v42, v44, v45
  v_mul_f32 v46, s52, v46
  v_mul_f32 v47, s52, v47
  v_mfma_f32_32x32x16_bf16 v[80:95], v[20:23], v[204:207], v[80:95]
  v_cvt_pk_bf16_f32 v43, v46, v47
  v_permlane16_swap_b32 v32, v40
  ds_read_b128 v[20:23], v9 offset:49408
  s_waitcnt lgkmcnt(3)
  v_mfma_f32_32x32x16_bf16 v[64:79], v[24:27], v[144:147], v[64:79]
  buffer_load_dwordx4 v6, s[56:59], s22 offen offset:2048 lds
  v_permlane16_swap_b32 v33, v41
  v_permlane16_swap_b32 v34, v42
  v_permlane16_swap_b32 v35, v43
  v_mfma_f32_32x32x16_bf16 v[80:95], v[24:27], v[208:211], v[80:95]
  v_accvgpr_write_b32 a8, v32
  v_accvgpr_write_b32 a9, v33
  ds_read_b128 v[24:27], v10 offset:49408
  s_waitcnt lgkmcnt(3)
  v_mfma_f32_32x32x16_bf16 v[64:79], v[28:31], v[148:151], v[64:79]
  buffer_load_dwordx4 v7, s[56:59], s22 offen offset:3072 lds
  v_accvgpr_write_b32 a10, v34
  v_accvgpr_write_b32 a11, v35
  v_accvgpr_write_b32 a64, v40
  v_mfma_f32_32x32x16_bf16 v[80:95], v[28:31], v[212:215], v[80:95]
  v_accvgpr_write_b32 a65, v41
  v_accvgpr_write_b32 a66, v42
  ds_read_b128 v[28:31], v11 offset:49408
  s_waitcnt lgkmcnt(3)
  v_mfma_f32_32x32x16_bf16 v[64:79], v[16:19], v[152:155], v[64:79]
  v_accvgpr_write_b32 a67, v43
  v_mul_f32 v48, s52, v48
  v_mul_f32 v49, s52, v49
  v_mfma_f32_32x32x16_bf16 v[80:95], v[16:19], v[216:219], v[80:95]
  v_cvt_pk_bf16_f32 v48, v48, v49
  v_mul_f32 v50, s52, v50
  ds_read_b128 v[16:19], v12 offset:49408
  s_waitcnt lgkmcnt(3)
  v_mfma_f32_32x32x16_bf16 v[64:79], v[20:23], v[156:159], v[64:79]
  v_mul_f32 v51, s52, v51
  v_cvt_pk_bf16_f32 v49, v50, v51
  v_mul_f32 v52, s52, v52
  v_mfma_f32_32x32x16_bf16 v[80:95], v[20:23], v[220:223], v[80:95]
  v_mul_f32 v53, s52, v53
  v_cvt_pk_bf16_f32 v50, v52, v53
  ds_read_b128 v[20:23], v13 offset:49408
  s_waitcnt lgkmcnt(3)
  v_mfma_f32_32x32x16_bf16 v[64:79], v[24:27], v[160:163], v[64:79]
  v_mul_f32 v54, s52, v54
  v_mul_f32 v55, s52, v55
  v_cvt_pk_bf16_f32 v51, v54, v55
  v_mfma_f32_32x32x16_bf16 v[80:95], v[24:27], v[224:227], v[80:95]
  v_mul_f32 v56, s52, v56
  v_mul_f32 v57, s52, v57
  ds_read_b128 v[24:27], v14 offset:49408
  s_waitcnt lgkmcnt(3)
  v_mfma_f32_32x32x16_bf16 v[64:79], v[28:31], v[164:167], v[64:79]
  v_cvt_pk_bf16_f32 v56, v56, v57
  v_mul_f32 v58, s52, v58
  v_mul_f32 v59, s52, v59
  v_mfma_f32_32x32x16_bf16 v[80:95], v[28:31], v[228:231], v[80:95]
  v_cvt_pk_bf16_f32 v57, v58, v59
  v_mul_f32 v60, s52, v60
  ds_read_b128 v[28:31], v15 offset:49408
  s_waitcnt lgkmcnt(3)
  v_mfma_f32_32x32x16_bf16 v[64:79], v[16:19], v[168:171], v[64:79]
  v_mul_f32 v61, s52, v61
  v_cvt_pk_bf16_f32 v58, v60, v61
  v_mul_f32 v62, s52, v62
  v_mfma_f32_32x32x16_bf16 v[80:95], v[16:19], v[232:235], v[80:95]
  v_mul_f32 v63, s52, v63
  v_cvt_pk_bf16_f32 v59, v62, v63
  v_xor_b32 v8, 65536, v8
  ds_read_b128 v[16:19], v8 offset:0
  s_waitcnt lgkmcnt(3)
  v_mfma_f32_32x32x16_bf16 v[64:79], v[20:23], v[172:175], v[64:79]
  v_permlane16_swap_b32 v48, v56
  v_permlane16_swap_b32 v49, v57
  v_permlane16_swap_b32 v50, v58
  v_mfma_f32_32x32x16_bf16 v[80:95], v[20:23], v[236:239], v[80:95]
  v_permlane16_swap_b32 v51, v59
  v_accvgpr_write_b32 a120, v48
  v_xor_b32 v9, 65536, v9
  ds_read_b128 v[20:23], v9 offset:0
  s_waitcnt lgkmcnt(3)
  v_mfma_f32_32x32x16_bf16 v[64:79], v[24:27], v[176:179], v[64:79]
  v_accvgpr_write_b32 a121, v49
  v_accvgpr_write_b32 a122, v50
  v_accvgpr_write_b32 a123, v51
  v_mfma_f32_32x32x16_bf16 v[80:95], v[24:27], v[240:243], v[80:95]
  v_accvgpr_write_b32 a176, v56
  v_accvgpr_write_b32 a177, v57
  v_xor_b32 v10, 65536, v10
  ds_read_b128 v[24:27], v10 offset:0
  s_waitcnt lgkmcnt(3)
  v_mfma_f32_32x32x16_bf16 v[64:79], v[28:31], v[180:183], v[64:79]
  v_accvgpr_write_b32 a178, v58
  v_accvgpr_write_b32 a179, v59
  v_mfma_f32_32x32x16_bf16 v[80:95], v[28:31], v[244:247], v[80:95]
  v_xor_b32 v11, 65536, v11
  ds_read_b128 v[28:31], v11 offset:0
  s_waitcnt lgkmcnt(3)
  v_mfma_f32_32x32x16_bf16 v[32:47], v[16:19], v[120:123], 0
  v_mfma_f32_32x32x16_bf16 v[48:63], v[16:19], v[184:187], 0
  v_xor_b32 v12, 65536, v12
  ds_read_b128 v[16:19], v12 offset:0
  s_waitcnt lgkmcnt(3)
  v_mfma_f32_32x32x16_bf16 v[32:47], v[20:23], v[124:127], v[32:47]
  v_mul_f32 v64, s52, v64
  v_mul_f32 v65, s52, v65
  v_cvt_pk_bf16_f32 v64, v64, v65
  v_mfma_f32_32x32x16_bf16 v[48:63], v[20:23], v[188:191], v[48:63]
  v_mul_f32 v66, s52, v66
  v_mul_f32 v67, s52, v67
  v_xor_b32 v13, 65536, v13
  ds_read_b128 v[20:23], v13 offset:0
  s_waitcnt lgkmcnt(3)
  v_mfma_f32_32x32x16_bf16 v[32:47], v[24:27], v[128:131], v[32:47]
  v_cvt_pk_bf16_f32 v65, v66, v67
  v_mul_f32 v68, s52, v68
  v_mul_f32 v69, s52, v69
  v_mfma_f32_32x32x16_bf16 v[48:63], v[24:27], v[192:195], v[48:63]
  v_cvt_pk_bf16_f32 v66, v68, v69
  v_mul_f32 v70, s52, v70
  v_xor_b32 v14, 65536, v14
  ds_read_b128 v[24:27], v14 offset:0
  s_waitcnt lgkmcnt(3)
  v_mfma_f32_32x32x16_bf16 v[32:47], v[28:31], v[132:135], v[32:47]
  v_mul_f32 v71, s52, v71
  v_cvt_pk_bf16_f32 v67, v70, v71
  v_mul_f32 v72, s52, v72
  v_mfma_f32_32x32x16_bf16 v[48:63], v[28:31], v[196:199], v[48:63]
  v_mul_f32 v73, s52, v73
  v_cvt_pk_bf16_f32 v72, v72, v73
  v_xor_b32 v15, 65536, v15
  ds_read_b128 v[28:31], v15 offset:0
  s_waitcnt lgkmcnt(3)
  v_mfma_f32_32x32x16_bf16 v[32:47], v[16:19], v[136:139], v[32:47]
  v_mul_f32 v74, s52, v74
  v_mul_f32 v75, s52, v75
  v_cvt_pk_bf16_f32 v73, v74, v75
  v_mfma_f32_32x32x16_bf16 v[48:63], v[16:19], v[200:203], v[48:63]
  v_mul_f32 v76, s52, v76
  v_mul_f32 v77, s52, v77
  ds_read_b128 v[16:19], v8 offset:256
  s_waitcnt lgkmcnt(3)
  v_mfma_f32_32x32x16_bf16 v[32:47], v[20:23], v[140:143], v[32:47]
  v_cvt_pk_bf16_f32 v74, v76, v77
  v_mul_f32 v78, s52, v78
  v_mul_f32 v79, s52, v79
  v_mfma_f32_32x32x16_bf16 v[48:63], v[20:23], v[204:207], v[48:63]
  v_cvt_pk_bf16_f32 v75, v78, v79
  v_permlane16_swap_b32 v64, v72
  ds_read_b128 v[20:23], v9 offset:256
  s_waitcnt lgkmcnt(3)
  v_mfma_f32_32x32x16_bf16 v[32:47], v[24:27], v[144:147], v[32:47]
  v_permlane16_swap_b32 v65, v73
  v_permlane16_swap_b32 v66, v74
  v_permlane16_swap_b32 v67, v75
  v_mfma_f32_32x32x16_bf16 v[48:63], v[24:27], v[208:211], v[48:63]
  v_accvgpr_write_b32 a12, v64
  v_accvgpr_write_b32 a13, v65
  ds_read_b128 v[24:27], v10 offset:256
  s_waitcnt lgkmcnt(3)
  v_mfma_f32_32x32x16_bf16 v[32:47], v[28:31], v[148:151], v[32:47]
  v_accvgpr_write_b32 a14, v66
  v_accvgpr_write_b32 a15, v67
  v_accvgpr_write_b32 a68, v72
  v_mfma_f32_32x32x16_bf16 v[48:63], v[28:31], v[212:215], v[48:63]
  v_accvgpr_write_b32 a69, v73
  v_accvgpr_write_b32 a70, v74
  ds_read_b128 v[28:31], v11 offset:256
  s_waitcnt lgkmcnt(3)
  v_mfma_f32_32x32x16_bf16 v[32:47], v[16:19], v[152:155], v[32:47]
  v_accvgpr_write_b32 a71, v75
  v_mul_f32 v80, s52, v80
  v_mul_f32 v81, s52, v81
  v_mfma_f32_32x32x16_bf16 v[48:63], v[16:19], v[216:219], v[48:63]
  v_cvt_pk_bf16_f32 v80, v80, v81
  v_mul_f32 v82, s52, v82
  ds_read_b128 v[16:19], v12 offset:256
  s_waitcnt lgkmcnt(3)
  v_mfma_f32_32x32x16_bf16 v[32:47], v[20:23], v[156:159], v[32:47]
  v_mul_f32 v83, s52, v83
  v_cvt_pk_bf16_f32 v81, v82, v83
  v_mul_f32 v84, s52, v84
  v_mfma_f32_32x32x16_bf16 v[48:63], v[20:23], v[220:223], v[48:63]
  v_mul_f32 v85, s52, v85
  v_cvt_pk_bf16_f32 v82, v84, v85
  ds_read_b128 v[20:23], v13 offset:256
  s_waitcnt lgkmcnt(3)
  v_mfma_f32_32x32x16_bf16 v[32:47], v[24:27], v[160:163], v[32:47]
  v_mul_f32 v86, s52, v86
  v_mul_f32 v87, s52, v87
  v_cvt_pk_bf16_f32 v83, v86, v87
  v_mfma_f32_32x32x16_bf16 v[48:63], v[24:27], v[224:227], v[48:63]
  v_mul_f32 v88, s52, v88
  v_mul_f32 v89, s52, v89
  ds_read_b128 v[24:27], v14 offset:256
  s_waitcnt lgkmcnt(3)
  v_mfma_f32_32x32x16_bf16 v[32:47], v[28:31], v[164:167], v[32:47]
  v_cvt_pk_bf16_f32 v88, v88, v89
  v_mul_f32 v90, s52, v90
  v_mul_f32 v91, s52, v91
  v_mfma_f32_32x32x16_bf16 v[48:63], v[28:31], v[228:231], v[48:63]
  v_cvt_pk_bf16_f32 v89, v90, v91
  v_mul_f32 v92, s52, v92
  ds_read_b128 v[28:31], v15 offset:256
  s_waitcnt lgkmcnt(3)
  v_mfma_f32_32x32x16_bf16 v[32:47], v[16:19], v[168:171], v[32:47]
  v_mul_f32 v93, s52, v93
  v_cvt_pk_bf16_f32 v90, v92, v93
  v_mul_f32 v94, s52, v94
  v_mfma_f32_32x32x16_bf16 v[48:63], v[16:19], v[232:235], v[48:63]
  v_mul_f32 v95, s52, v95
  v_cvt_pk_bf16_f32 v91, v94, v95
  ds_read_b128 v[16:19], v8 offset:16384
  s_waitcnt lgkmcnt(3)
  v_mfma_f32_32x32x16_bf16 v[32:47], v[20:23], v[172:175], v[32:47]
  v_permlane16_swap_b32 v80, v88
  v_permlane16_swap_b32 v81, v89
  v_permlane16_swap_b32 v82, v90
  v_mfma_f32_32x32x16_bf16 v[48:63], v[20:23], v[236:239], v[48:63]
  v_permlane16_swap_b32 v83, v91
  v_accvgpr_write_b32 a124, v80
  ds_read_b128 v[20:23], v9 offset:16384
  s_waitcnt lgkmcnt(3)
  v_mfma_f32_32x32x16_bf16 v[32:47], v[24:27], v[176:179], v[32:47]
  v_accvgpr_write_b32 a125, v81
  v_accvgpr_write_b32 a126, v82
  v_accvgpr_write_b32 a127, v83
  v_mfma_f32_32x32x16_bf16 v[48:63], v[24:27], v[240:243], v[48:63]
  v_accvgpr_write_b32 a180, v88
  v_accvgpr_write_b32 a181, v89
  ds_read_b128 v[24:27], v10 offset:16384
  s_waitcnt lgkmcnt(3)
  v_mfma_f32_32x32x16_bf16 v[32:47], v[28:31], v[180:183], v[32:47]
  v_accvgpr_write_b32 a182, v90
  v_accvgpr_write_b32 a183, v91
  v_mfma_f32_32x32x16_bf16 v[48:63], v[28:31], v[244:247], v[48:63]
  s_waitcnt vmcnt(16)
  s_barrier
  ds_read_b128 v[28:31], v11 offset:16384
  s_waitcnt lgkmcnt(3)
  v_mfma_f32_32x32x16_bf16 v[64:79], v[16:19], v[120:123], 0
  s_add_u32 s22, s27, 3145728
  s_add_u32 m0, s25, 49152
  s_nop 0
  buffer_load_dwordx4 v4, s[56:59], s22 offen offset:0 lds
  v_mfma_f32_32x32x16_bf16 v[80:95], v[16:19], v[184:187], 0
  ds_read_b128 v[16:19], v12 offset:16384
  s_waitcnt lgkmcnt(3)
  v_mfma_f32_32x32x16_bf16 v[64:79], v[20:23], v[124:127], v[64:79]
  buffer_load_dwordx4 v5, s[56:59], s22 offen offset:1024 lds
  v_mul_f32 v32, s52, v32
  v_mul_f32 v33, s52, v33
  v_cvt_pk_bf16_f32 v32, v32, v33
  v_mfma_f32_32x32x16_bf16 v[80:95], v[20:23], v[188:191], v[80:95]
  v_mul_f32 v34, s52, v34
  v_mul_f32 v35, s52, v35
  ds_read_b128 v[20:23], v13 offset:16384
  s_waitcnt lgkmcnt(3)
  v_mfma_f32_32x32x16_bf16 v[64:79], v[24:27], v[128:131], v[64:79]
  buffer_load_dwordx4 v6, s[56:59], s22 offen offset:2048 lds
  v_cvt_pk_bf16_f32 v33, v34, v35
  v_mul_f32 v36, s52, v36
  v_mul_f32 v37, s52, v37
  v_mfma_f32_32x32x16_bf16 v[80:95], v[24:27], v[192:195], v[80:95]
  v_cvt_pk_bf16_f32 v34, v36, v37
  v_mul_f32 v38, s52, v38
  ds_read_b128 v[24:27], v14 offset:16384
  s_waitcnt lgkmcnt(3)
  v_mfma_f32_32x32x16_bf16 v[64:79], v[28:31], v[132:135], v[64:79]
  buffer_load_dwordx4 v7, s[56:59], s22 offen offset:3072 lds
  v_mul_f32 v39, s52, v39
  v_cvt_pk_bf16_f32 v35, v38, v39
  v_mul_f32 v40, s52, v40
  v_mfma_f32_32x32x16_bf16 v[80:95], v[28:31], v[196:199], v[80:95]
  v_mul_f32 v41, s52, v41
  v_cvt_pk_bf16_f32 v40, v40, v41
  ds_read_b128 v[28:31], v15 offset:16384
  s_waitcnt lgkmcnt(3)
  v_mfma_f32_32x32x16_bf16 v[64:79], v[16:19], v[136:139], v[64:79]
  s_add_u32 s22, s27, 3407872
  s_add_u32 m0, s25, 65536
  s_nop 0
  buffer_load_dwordx4 v4, s[56:59], s22 offen offset:0 lds
  v_mul_f32 v42, s52, v42
  v_mul_f32 v43, s52, v43
  v_cvt_pk_bf16_f32 v41, v42, v43
  v_mfma_f32_32x32x16_bf16 v[80:95], v[16:19], v[200:203], v[80:95]
  v_mul_f32 v44, s52, v44
  v_mul_f32 v45, s52, v45
  ds_read_b128 v[16:19], v8 offset:16640
  s_waitcnt lgkmcnt(3)
  v_mfma_f32_32x32x16_bf16 v[64:79], v[20:23], v[140:143], v[64:79]
  buffer_load_dwordx4 v5, s[56:59], s22 offen offset:1024 lds
  v_cvt_pk_bf16_f32 v42, v44, v45
  v_mul_f32 v46, s52, v46
  v_mul_f32 v47, s52, v47
  v_mfma_f32_32x32x16_bf16 v[80:95], v[20:23], v[204:207], v[80:95]
  v_cvt_pk_bf16_f32 v43, v46, v47
  v_permlane16_swap_b32 v32, v40
  ds_read_b128 v[20:23], v9 offset:16640
  s_waitcnt lgkmcnt(3)
  v_mfma_f32_32x32x16_bf16 v[64:79], v[24:27], v[144:147], v[64:79]
  buffer_load_dwordx4 v6, s[56:59], s22 offen offset:2048 lds
  v_permlane16_swap_b32 v33, v41
  v_permlane16_swap_b32 v34, v42
  v_permlane16_swap_b32 v35, v43
  v_mfma_f32_32x32x16_bf16 v[80:95], v[24:27], v[208:211], v[80:95]
  v_accvgpr_write_b32 a16, v32
  v_accvgpr_write_b32 a17, v33
  ds_read_b128 v[24:27], v10 offset:16640
  s_waitcnt lgkmcnt(3)
  v_mfma_f32_32x32x16_bf16 v[64:79], v[28:31], v[148:151], v[64:79]
  buffer_load_dwordx4 v7, s[56:59], s22 offen offset:3072 lds
  v_accvgpr_write_b32 a18, v34
  v_accvgpr_write_b32 a19, v35
  v_accvgpr_write_b32 a72, v40
  v_mfma_f32_32x32x16_bf16 v[80:95], v[28:31], v[212:215], v[80:95]
  v_accvgpr_write_b32 a73, v41
  v_accvgpr_write_b32 a74, v42
  ds_read_b128 v[28:31], v11 offset:16640
  s_waitcnt lgkmcnt(3)
  v_mfma_f32_32x32x16_bf16 v[64:79], v[16:19], v[152:155], v[64:79]
  v_accvgpr_write_b32 a75, v43
  v_mul_f32 v48, s52, v48
  v_mul_f32 v49, s52, v49
  v_mfma_f32_32x32x16_bf16 v[80:95], v[16:19], v[216:219], v[80:95]
  v_cvt_pk_bf16_f32 v48, v48, v49
  v_mul_f32 v50, s52, v50
  ds_read_b128 v[16:19], v12 offset:16640
  s_waitcnt lgkmcnt(3)
  v_mfma_f32_32x32x16_bf16 v[64:79], v[20:23], v[156:159], v[64:79]
  v_mul_f32 v51, s52, v51
  v_cvt_pk_bf16_f32 v49, v50, v51
  v_mul_f32 v52, s52, v52
  v_mfma_f32_32x32x16_bf16 v[80:95], v[20:23], v[220:223], v[80:95]
  v_mul_f32 v53, s52, v53
  v_cvt_pk_bf16_f32 v50, v52, v53
  ds_read_b128 v[20:23], v13 offset:16640
  s_waitcnt lgkmcnt(3)
  v_mfma_f32_32x32x16_bf16 v[64:79], v[24:27], v[160:163], v[64:79]
  v_mul_f32 v54, s52, v54
  v_mul_f32 v55, s52, v55
  v_cvt_pk_bf16_f32 v51, v54, v55
  v_mfma_f32_32x32x16_bf16 v[80:95], v[24:27], v[224:227], v[80:95]
  v_mul_f32 v56, s52, v56
  v_mul_f32 v57, s52, v57
  ds_read_b128 v[24:27], v14 offset:16640
  s_waitcnt lgkmcnt(3)
  v_mfma_f32_32x32x16_bf16 v[64:79], v[28:31], v[164:167], v[64:79]
  v_cvt_pk_bf16_f32 v56, v56, v57
  v_mul_f32 v58, s52, v58
  v_mul_f32 v59, s52, v59
  v_mfma_f32_32x32x16_bf16 v[80:95], v[28:31], v[228:231], v[80:95]
  v_cvt_pk_bf16_f32 v57, v58, v59
  v_mul_f32 v60, s52, v60
  ds_read_b128 v[28:31], v15 offset:16640
  s_waitcnt lgkmcnt(3)
  v_mfma_f32_32x32x16_bf16 v[64:79], v[16:19], v[168:171], v[64:79]
  v_mul_f32 v61, s52, v61
  v_cvt_pk_bf16_f32 v58, v60, v61
  v_mul_f32 v62, s52, v62
  v_mfma_f32_32x32x16_bf16 v[80:95], v[16:19], v[232:235], v[80:95]
  v_mul_f32 v63, s52, v63
  v_cvt_pk_bf16_f32 v59, v62, v63
  ds_read_b128 v[16:19], v8 offset:32768
  s_waitcnt lgkmcnt(3)
  v_mfma_f32_32x32x16_bf16 v[64:79], v[20:23], v[172:175], v[64:79]
  v_permlane16_swap_b32 v48, v56
  v_permlane16_swap_b32 v49, v57
  v_permlane16_swap_b32 v50, v58
  v_mfma_f32_32x32x16_bf16 v[80:95], v[20:23], v[236:239], v[80:95]
  v_permlane16_swap_b32 v51, v59
  v_accvgpr_write_b32 a128, v48
  ds_read_b128 v[20:23], v9 offset:32768
  s_waitcnt lgkmcnt(3)
  v_mfma_f32_32x32x16_bf16 v[64:79], v[24:27], v[176:179], v[64:79]
  v_accvgpr_write_b32 a129, v49
  v_accvgpr_write_b32 a130, v50
  v_accvgpr_write_b32 a131, v51
  v_mfma_f32_32x32x16_bf16 v[80:95], v[24:27], v[240:243], v[80:95]
  v_accvgpr_write_b32 a184, v56
  v_accvgpr_write_b32 a185, v57
  ds_read_b128 v[24:27], v10 offset:32768
  s_waitcnt lgkmcnt(3)
  v_mfma_f32_32x32x16_bf16 v[64:79], v[28:31], v[180:183], v[64:79]
  v_accvgpr_write_b32 a186, v58
  v_accvgpr_write_b32 a187, v59
  v_mfma_f32_32x32x16_bf16 v[80:95], v[28:31], v[244:247], v[80:95]
  ds_read_b128 v[28:31], v11 offset:32768
  s_waitcnt lgkmcnt(3)
  v_mfma_f32_32x32x16_bf16 v[32:47], v[16:19], v[120:123], 0
  v_mfma_f32_32x32x16_bf16 v[48:63], v[16:19], v[184:187], 0
  ds_read_b128 v[16:19], v12 offset:32768
  s_waitcnt lgkmcnt(3)
  v_mfma_f32_32x32x16_bf16 v[32:47], v[20:23], v[124:127], v[32:47]
  v_mul_f32 v64, s52, v64
  v_mul_f32 v65, s52, v65
  v_cvt_pk_bf16_f32 v64, v64, v65
  v_mfma_f32_32x32x16_bf16 v[48:63], v[20:23], v[188:191], v[48:63]
  v_mul_f32 v66, s52, v66
  v_mul_f32 v67, s52, v67
  ds_read_b128 v[20:23], v13 offset:32768
  s_waitcnt lgkmcnt(3)
  v_mfma_f32_32x32x16_bf16 v[32:47], v[24:27], v[128:131], v[32:47]
  v_cvt_pk_bf16_f32 v65, v66, v67
  v_mul_f32 v68, s52, v68
  v_mul_f32 v69, s52, v69
  v_mfma_f32_32x32x16_bf16 v[48:63], v[24:27], v[192:195], v[48:63]
  v_cvt_pk_bf16_f32 v66, v68, v69
  v_mul_f32 v70, s52, v70
  ds_read_b128 v[24:27], v14 offset:32768
  s_waitcnt lgkmcnt(3)
  v_mfma_f32_32x32x16_bf16 v[32:47], v[28:31], v[132:135], v[32:47]
  v_mul_f32 v71, s52, v71
  v_cvt_pk_bf16_f32 v67, v70, v71
  v_mul_f32 v72, s52, v72
  v_mfma_f32_32x32x16_bf16 v[48:63], v[28:31], v[196:199], v[48:63]
  v_mul_f32 v73, s52, v73
  v_cvt_pk_bf16_f32 v72, v72, v73
  ds_read_b128 v[28:31], v15 offset:32768
  s_waitcnt lgkmcnt(3)
  v_mfma_f32_32x32x16_bf16 v[32:47], v[16:19], v[136:139], v[32:47]
  v_mul_f32 v74, s52, v74
  v_mul_f32 v75, s52, v75
  v_cvt_pk_bf16_f32 v73, v74, v75
  v_mfma_f32_32x32x16_bf16 v[48:63], v[16:19], v[200:203], v[48:63]
  v_mul_f32 v76, s52, v76
  v_mul_f32 v77, s52, v77
  ds_read_b128 v[16:19], v8 offset:33024
  s_waitcnt lgkmcnt(3)
  v_mfma_f32_32x32x16_bf16 v[32:47], v[20:23], v[140:143], v[32:47]
  v_cvt_pk_bf16_f32 v74, v76, v77
  v_mul_f32 v78, s52, v78
  v_mul_f32 v79, s52, v79
  v_mfma_f32_32x32x16_bf16 v[48:63], v[20:23], v[204:207], v[48:63]
  v_cvt_pk_bf16_f32 v75, v78, v79
  v_permlane16_swap_b32 v64, v72
  ds_read_b128 v[20:23], v9 offset:33024
  s_waitcnt lgkmcnt(3)
  v_mfma_f32_32x32x16_bf16 v[32:47], v[24:27], v[144:147], v[32:47]
  v_permlane16_swap_b32 v65, v73
  v_permlane16_swap_b32 v66, v74
  v_permlane16_swap_b32 v67, v75
  v_mfma_f32_32x32x16_bf16 v[48:63], v[24:27], v[208:211], v[48:63]
  v_accvgpr_write_b32 a20, v64
  v_accvgpr_write_b32 a21, v65
  ds_read_b128 v[24:27], v10 offset:33024
  s_waitcnt lgkmcnt(3)
  v_mfma_f32_32x32x16_bf16 v[32:47], v[28:31], v[148:151], v[32:47]
  v_accvgpr_write_b32 a22, v66
  v_accvgpr_write_b32 a23, v67
  v_accvgpr_write_b32 a76, v72
  v_mfma_f32_32x32x16_bf16 v[48:63], v[28:31], v[212:215], v[48:63]
  v_accvgpr_write_b32 a77, v73
  v_accvgpr_write_b32 a78, v74
  ds_read_b128 v[28:31], v11 offset:33024
  s_waitcnt lgkmcnt(3)
  v_mfma_f32_32x32x16_bf16 v[32:47], v[16:19], v[152:155], v[32:47]
  v_accvgpr_write_b32 a79, v75
  v_mul_f32 v80, s52, v80
  v_mul_f32 v81, s52, v81
  v_mfma_f32_32x32x16_bf16 v[48:63], v[16:19], v[216:219], v[48:63]
  v_cvt_pk_bf16_f32 v80, v80, v81
  v_mul_f32 v82, s52, v82
  ds_read_b128 v[16:19], v12 offset:33024
  s_waitcnt lgkmcnt(3)
  v_mfma_f32_32x32x16_bf16 v[32:47], v[20:23], v[156:159], v[32:47]
  v_mul_f32 v83, s52, v83
  v_cvt_pk_bf16_f32 v81, v82, v83
  v_mul_f32 v84, s52, v84
  v_mfma_f32_32x32x16_bf16 v[48:63], v[20:23], v[220:223], v[48:63]
  v_mul_f32 v85, s52, v85
  v_cvt_pk_bf16_f32 v82, v84, v85
  ds_read_b128 v[20:23], v13 offset:33024
  s_waitcnt lgkmcnt(3)
  v_mfma_f32_32x32x16_bf16 v[32:47], v[24:27], v[160:163], v[32:47]
  v_mul_f32 v86, s52, v86
  v_mul_f32 v87, s52, v87
  v_cvt_pk_bf16_f32 v83, v86, v87
  v_mfma_f32_32x32x16_bf16 v[48:63], v[24:27], v[224:227], v[48:63]
  v_mul_f32 v88, s52, v88
  v_mul_f32 v89, s52, v89
  ds_read_b128 v[24:27], v14 offset:33024
  s_waitcnt lgkmcnt(3)
  v_mfma_f32_32x32x16_bf16 v[32:47], v[28:31], v[164:167], v[32:47]
  v_cvt_pk_bf16_f32 v88, v88, v89
  v_mul_f32 v90, s52, v90
  v_mul_f32 v91, s52, v91
  v_mfma_f32_32x32x16_bf16 v[48:63], v[28:31], v[228:231], v[48:63]
  v_cvt_pk_bf16_f32 v89, v90, v91
  v_mul_f32 v92, s52, v92
  ds_read_b128 v[28:31], v15 offset:33024
  s_waitcnt lgkmcnt(3)
  v_mfma_f32_32x32x16_bf16 v[32:47], v[16:19], v[168:171], v[32:47]
  v_mul_f32 v93, s52, v93
  v_cvt_pk_bf16_f32 v90, v92, v93
  v_mul_f32 v94, s52, v94
  v_mfma_f32_32x32x16_bf16 v[48:63], v[16:19], v[232:235], v[48:63]
  v_mul_f32 v95, s52, v95
  v_cvt_pk_bf16_f32 v91, v94, v95
  ds_read_b128 v[16:19], v8 offset:49152
  s_waitcnt lgkmcnt(3)
  v_mfma_f32_32x32x16_bf16 v[32:47], v[20:23], v[172:175], v[32:47]
  v_permlane16_swap_b32 v80, v88
  v_permlane16_swap_b32 v81, v89
  v_permlane16_swap_b32 v82, v90
  v_mfma_f32_32x32x16_bf16 v[48:63], v[20:23], v[236:239], v[48:63]
  v_permlane16_swap_b32 v83, v91
  v_accvgpr_write_b32 a132, v80
  ds_read_b128 v[20:23], v9 offset:49152
  s_waitcnt lgkmcnt(3)
  v_mfma_f32_32x32x16_bf16 v[32:47], v[24:27], v[176:179], v[32:47]
  v_accvgpr_write_b32 a133, v81
  v_accvgpr_write_b32 a134, v82
  v_accvgpr_write_b32 a135, v83
  v_mfma_f32_32x32x16_bf16 v[48:63], v[24:27], v[240:243], v[48:63]
  v_accvgpr_write_b32 a188, v88
  v_accvgpr_write_b32 a189, v89
  ds_read_b128 v[24:27], v10 offset:49152
  s_waitcnt lgkmcnt(3)
  v_mfma_f32_32x32x16_bf16 v[32:47], v[28:31], v[180:183], v[32:47]
  v_accvgpr_write_b32 a190, v90
  v_accvgpr_write_b32 a191, v91
  v_mfma_f32_32x32x16_bf16 v[48:63], v[28:31], v[244:247], v[48:63]
  s_waitcnt vmcnt(16)
  s_barrier
  ds_read_b128 v[28:31], v11 offset:49152
  s_waitcnt lgkmcnt(3)
  v_mfma_f32_32x32x16_bf16 v[64:79], v[16:19], v[120:123], 0
  v_mfma_f32_32x32x16_bf16 v[80:95], v[16:19], v[184:187], 0
  ds_read_b128 v[16:19], v12 offset:49152
  s_waitcnt lgkmcnt(3)
  v_mfma_f32_32x32x16_bf16 v[64:79], v[20:23], v[124:127], v[64:79]
  v_mul_f32 v32, s52, v32
  v_mul_f32 v33, s52, v33
  v_cvt_pk_bf16_f32 v32, v32, v33
  v_mfma_f32_32x32x16_bf16 v[80:95], v[20:23], v[188:191], v[80:95]
  v_mul_f32 v34, s52, v34
  v_mul_f32 v35, s52, v35
  ds_read_b128 v[20:23], v13 offset:49152
  s_waitcnt lgkmcnt(3)
  v_mfma_f32_32x32x16_bf16 v[64:79], v[24:27], v[128:131], v[64:79]
  v_cvt_pk_bf16_f32 v33, v34, v35
  v_mul_f32 v36, s52, v36
  v_mul_f32 v37, s52, v37
  v_mfma_f32_32x32x16_bf16 v[80:95], v[24:27], v[192:195], v[80:95]
  v_cvt_pk_bf16_f32 v34, v36, v37
  v_mul_f32 v38, s52, v38
  ds_read_b128 v[24:27], v14 offset:49152
  s_waitcnt lgkmcnt(3)
  v_mfma_f32_32x32x16_bf16 v[64:79], v[28:31], v[132:135], v[64:79]
  v_mul_f32 v39, s52, v39
  v_cvt_pk_bf16_f32 v35, v38, v39
  v_mul_f32 v40, s52, v40
  v_mfma_f32_32x32x16_bf16 v[80:95], v[28:31], v[196:199], v[80:95]
  v_mul_f32 v41, s52, v41
  v_cvt_pk_bf16_f32 v40, v40, v41
  ds_read_b128 v[28:31], v15 offset:49152
  s_waitcnt lgkmcnt(3)
  v_mfma_f32_32x32x16_bf16 v[64:79], v[16:19], v[136:139], v[64:79]
  v_mul_f32 v42, s52, v42
  v_mul_f32 v43, s52, v43
  v_cvt_pk_bf16_f32 v41, v42, v43
  v_mfma_f32_32x32x16_bf16 v[80:95], v[16:19], v[200:203], v[80:95]
  v_mul_f32 v44, s52, v44
  v_mul_f32 v45, s52, v45
  ds_read_b128 v[16:19], v8 offset:49408
  s_waitcnt lgkmcnt(3)
  v_mfma_f32_32x32x16_bf16 v[64:79], v[20:23], v[140:143], v[64:79]
  v_cvt_pk_bf16_f32 v42, v44, v45
  v_mul_f32 v46, s52, v46
  v_mul_f32 v47, s52, v47
  v_mfma_f32_32x32x16_bf16 v[80:95], v[20:23], v[204:207], v[80:95]
  v_cvt_pk_bf16_f32 v43, v46, v47
  v_permlane16_swap_b32 v32, v40
  ds_read_b128 v[20:23], v9 offset:49408
  s_waitcnt lgkmcnt(3)
  v_mfma_f32_32x32x16_bf16 v[64:79], v[24:27], v[144:147], v[64:79]
  v_permlane16_swap_b32 v33, v41
  v_permlane16_swap_b32 v34, v42
  v_permlane16_swap_b32 v35, v43
  v_mfma_f32_32x32x16_bf16 v[80:95], v[24:27], v[208:211], v[80:95]
  v_accvgpr_write_b32 a24, v32
  v_accvgpr_write_b32 a25, v33
  ds_read_b128 v[24:27], v10 offset:49408
  s_waitcnt lgkmcnt(3)
  v_mfma_f32_32x32x16_bf16 v[64:79], v[28:31], v[148:151], v[64:79]
  v_accvgpr_write_b32 a26, v34
  v_accvgpr_write_b32 a27, v35
  v_accvgpr_write_b32 a80, v40
  v_mfma_f32_32x32x16_bf16 v[80:95], v[28:31], v[212:215], v[80:95]
  v_accvgpr_write_b32 a81, v41
  v_accvgpr_write_b32 a82, v42
  ds_read_b128 v[28:31], v11 offset:49408
  s_waitcnt lgkmcnt(3)
  v_mfma_f32_32x32x16_bf16 v[64:79], v[16:19], v[152:155], v[64:79]
  v_accvgpr_write_b32 a83, v43
  v_mul_f32 v48, s52, v48
  v_mul_f32 v49, s52, v49
  v_mfma_f32_32x32x16_bf16 v[80:95], v[16:19], v[216:219], v[80:95]
  v_cvt_pk_bf16_f32 v48, v48, v49
  v_mul_f32 v50, s52, v50
  ds_read_b128 v[16:19], v12 offset:49408
  s_waitcnt lgkmcnt(3)
  v_mfma_f32_32x32x16_bf16 v[64:79], v[20:23], v[156:159], v[64:79]
  v_mul_f32 v51, s52, v51
  v_cvt_pk_bf16_f32 v49, v50, v51
  v_mul_f32 v52, s52, v52
  v_mfma_f32_32x32x16_bf16 v[80:95], v[20:23], v[220:223], v[80:95]
  v_mul_f32 v53, s52, v53
  v_cvt_pk_bf16_f32 v50, v52, v53
  ds_read_b128 v[20:23], v13 offset:49408
  s_waitcnt lgkmcnt(3)
  v_mfma_f32_32x32x16_bf16 v[64:79], v[24:27], v[160:163], v[64:79]
  v_mul_f32 v54, s52, v54
  v_mul_f32 v55, s52, v55
  v_cvt_pk_bf16_f32 v51, v54, v55
  v_mfma_f32_32x32x16_bf16 v[80:95], v[24:27], v[224:227], v[80:95]
  v_mul_f32 v56, s52, v56
  v_mul_f32 v57, s52, v57
  ds_read_b128 v[24:27], v14 offset:49408
  s_waitcnt lgkmcnt(3)
  v_mfma_f32_32x32x16_bf16 v[64:79], v[28:31], v[164:167], v[64:79]
  v_cvt_pk_bf16_f32 v56, v56, v57
  v_mul_f32 v58, s52, v58
  v_mul_f32 v59, s52, v59
  v_mfma_f32_32x32x16_bf16 v[80:95], v[28:31], v[228:231], v[80:95]
  v_cvt_pk_bf16_f32 v57, v58, v59
  v_mul_f32 v60, s52, v60
  ds_read_b128 v[28:31], v15 offset:49408
  s_waitcnt lgkmcnt(3)
  v_mfma_f32_32x32x16_bf16 v[64:79], v[16:19], v[168:171], v[64:79]
  v_mul_f32 v61, s52, v61
  v_cvt_pk_bf16_f32 v58, v60, v61
  v_mul_f32 v62, s52, v62
  v_mfma_f32_32x32x16_bf16 v[80:95], v[16:19], v[232:235], v[80:95]
  v_mul_f32 v63, s52, v63
  v_cvt_pk_bf16_f32 v59, v62, v63
  v_xor_b32 v8, 196608, v8
  ds_read_b128 v[16:19], v8 offset:0
  s_waitcnt lgkmcnt(3)
  v_mfma_f32_32x32x16_bf16 v[64:79], v[20:23], v[172:175], v[64:79]
  v_permlane16_swap_b32 v48, v56
  v_permlane16_swap_b32 v49, v57
  v_permlane16_swap_b32 v50, v58
  v_mfma_f32_32x32x16_bf16 v[80:95], v[20:23], v[236:239], v[80:95]
  v_permlane16_swap_b32 v51, v59
  v_accvgpr_write_b32 a136, v48
  v_xor_b32 v9, 196608, v9
  ds_read_b128 v[20:23], v9 offset:0
  s_waitcnt lgkmcnt(3)
  v_mfma_f32_32x32x16_bf16 v[64:79], v[24:27], v[176:179], v[64:79]
  v_accvgpr_write_b32 a137, v49
  v_accvgpr_write_b32 a138, v50
  v_accvgpr_write_b32 a139, v51
  v_mfma_f32_32x32x16_bf16 v[80:95], v[24:27], v[240:243], v[80:95]
  v_accvgpr_write_b32 a192, v56
  v_accvgpr_write_b32 a193, v57
  v_xor_b32 v10, 196608, v10
  ds_read_b128 v[24:27], v10 offset:0
  s_waitcnt lgkmcnt(3)
  v_mfma_f32_32x32x16_bf16 v[64:79], v[28:31], v[180:183], v[64:79]
  v_accvgpr_write_b32 a194, v58
  v_accvgpr_write_b32 a195, v59
  v_mfma_f32_32x32x16_bf16 v[80:95], v[28:31], v[244:247], v[80:95]
  v_xor_b32 v11, 196608, v11
  ds_read_b128 v[28:31], v11 offset:0
  s_waitcnt lgkmcnt(3)
  v_mfma_f32_32x32x16_bf16 v[32:47], v[16:19], v[120:123], 0
  v_mfma_f32_32x32x16_bf16 v[48:63], v[16:19], v[184:187], 0
  v_xor_b32 v12, 196608, v12
  ds_read_b128 v[16:19], v12 offset:0
  s_waitcnt lgkmcnt(3)
  v_mfma_f32_32x32x16_bf16 v[32:47], v[20:23], v[124:127], v[32:47]
  v_mul_f32 v64, s52, v64
  v_mul_f32 v65, s52, v65
  v_cvt_pk_bf16_f32 v64, v64, v65
  v_mfma_f32_32x32x16_bf16 v[48:63], v[20:23], v[188:191], v[48:63]
  v_mul_f32 v66, s52, v66
  v_mul_f32 v67, s52, v67
  v_xor_b32 v13, 196608, v13
  ds_read_b128 v[20:23], v13 offset:0
  s_waitcnt lgkmcnt(3)
  v_mfma_f32_32x32x16_bf16 v[32:47], v[24:27], v[128:131], v[32:47]
  v_cvt_pk_bf16_f32 v65, v66, v67
  v_mul_f32 v68, s52, v68
  v_mul_f32 v69, s52, v69
  v_mfma_f32_32x32x16_bf16 v[48:63], v[24:27], v[192:195], v[48:63]
  v_cvt_pk_bf16_f32 v66, v68, v69
  v_mul_f32 v70, s52, v70
  v_xor_b32 v14, 196608, v14
  ds_read_b128 v[24:27], v14 offset:0
  s_waitcnt lgkmcnt(3)
  v_mfma_f32_32x32x16_bf16 v[32:47], v[28:31], v[132:135], v[32:47]
  v_mul_f32 v71, s52, v71
  v_cvt_pk_bf16_f32 v67, v70, v71
  v_mul_f32 v72, s52, v72
  v_mfma_f32_32x32x16_bf16 v[48:63], v[28:31], v[196:199], v[48:63]
  v_mul_f32 v73, s52, v73
  v_cvt_pk_bf16_f32 v72, v72, v73
  v_xor_b32 v15, 196608, v15
  ds_read_b128 v[28:31], v15 offset:0
  s_waitcnt lgkmcnt(3)
  v_mfma_f32_32x32x16_bf16 v[32:47], v[16:19], v[136:139], v[32:47]
  v_mul_f32 v74, s52, v74
  v_mul_f32 v75, s52, v75
  v_cvt_pk_bf16_f32 v73, v74, v75
  v_mfma_f32_32x32x16_bf16 v[48:63], v[16:19], v[200:203], v[48:63]
  v_mul_f32 v76, s52, v76
  v_mul_f32 v77, s52, v77
  ds_read_b128 v[16:19], v8 offset:256
  s_waitcnt lgkmcnt(3)
  v_mfma_f32_32x32x16_bf16 v[32:47], v[20:23], v[140:143], v[32:47]
  v_cvt_pk_bf16_f32 v74, v76, v77
  v_mul_f32 v78, s52, v78
  v_mul_f32 v79, s52, v79
  v_mfma_f32_32x32x16_bf16 v[48:63], v[20:23], v[204:207], v[48:63]
  v_cvt_pk_bf16_f32 v75, v78, v79
  v_permlane16_swap_b32 v64, v72
  ds_read_b128 v[20:23], v9 offset:256
  s_waitcnt lgkmcnt(3)
  v_mfma_f32_32x32x16_bf16 v[32:47], v[24:27], v[144:147], v[32:47]
  v_permlane16_swap_b32 v65, v73
  v_permlane16_swap_b32 v66, v74
  v_permlane16_swap_b32 v67, v75
  v_mfma_f32_32x32x16_bf16 v[48:63], v[24:27], v[208:211], v[48:63]
  v_accvgpr_write_b32 a28, v64
  v_accvgpr_write_b32 a29, v65
  ds_read_b128 v[24:27], v10 offset:256
  s_waitcnt lgkmcnt(3)
  v_mfma_f32_32x32x16_bf16 v[32:47], v[28:31], v[148:151], v[32:47]
  v_accvgpr_write_b32 a30, v66
  v_accvgpr_write_b32 a31, v67
  v_accvgpr_write_b32 a84, v72
  v_mfma_f32_32x32x16_bf16 v[48:63], v[28:31], v[212:215], v[48:63]
  v_accvgpr_write_b32 a85, v73
  v_accvgpr_write_b32 a86, v74
  ds_read_b128 v[28:31], v11 offset:256
  s_waitcnt lgkmcnt(3)
  v_mfma_f32_32x32x16_bf16 v[32:47], v[16:19], v[152:155], v[32:47]
  v_accvgpr_write_b32 a87, v75
  v_mul_f32 v80, s52, v80
  v_mul_f32 v81, s52, v81
  v_mfma_f32_32x32x16_bf16 v[48:63], v[16:19], v[216:219], v[48:63]
  v_cvt_pk_bf16_f32 v80, v80, v81
  v_mul_f32 v82, s52, v82
  ds_read_b128 v[16:19], v12 offset:256
  s_waitcnt lgkmcnt(3)
  v_mfma_f32_32x32x16_bf16 v[32:47], v[20:23], v[156:159], v[32:47]
  v_mul_f32 v83, s52, v83
  v_cvt_pk_bf16_f32 v81, v82, v83
  v_mul_f32 v84, s52, v84
  v_mfma_f32_32x32x16_bf16 v[48:63], v[20:23], v[220:223], v[48:63]
  v_mul_f32 v85, s52, v85
  v_cvt_pk_bf16_f32 v82, v84, v85
  ds_read_b128 v[20:23], v13 offset:256
  s_waitcnt lgkmcnt(3)
  v_mfma_f32_32x32x16_bf16 v[32:47], v[24:27], v[160:163], v[32:47]
  v_mul_f32 v86, s52, v86
  v_mul_f32 v87, s52, v87
  v_cvt_pk_bf16_f32 v83, v86, v87
  v_mfma_f32_32x32x16_bf16 v[48:63], v[24:27], v[224:227], v[48:63]
  v_mul_f32 v88, s52, v88
  v_mul_f32 v89, s52, v89
  ds_read_b128 v[24:27], v14 offset:256
  s_waitcnt lgkmcnt(3)
  v_mfma_f32_32x32x16_bf16 v[32:47], v[28:31], v[164:167], v[32:47]
  v_cvt_pk_bf16_f32 v88, v88, v89
  v_mul_f32 v90, s52, v90
  v_mul_f32 v91, s52, v91
  v_mfma_f32_32x32x16_bf16 v[48:63], v[28:31], v[228:231], v[48:63]
  v_cvt_pk_bf16_f32 v89, v90, v91
  v_mul_f32 v92, s52, v92
  ds_read_b128 v[28:31], v15 offset:256
  s_waitcnt lgkmcnt(3)
  v_mfma_f32_32x32x16_bf16 v[32:47], v[16:19], v[168:171], v[32:47]
  v_mul_f32 v93, s52, v93
  v_cvt_pk_bf16_f32 v90, v92, v93
  v_mul_f32 v94, s52, v94
  v_mfma_f32_32x32x16_bf16 v[48:63], v[16:19], v[232:235], v[48:63]
  v_mul_f32 v95, s52, v95
  v_cvt_pk_bf16_f32 v91, v94, v95
  v_xor_b32 v8, 131072, v8
  ds_read_b128 v[16:19], v8 offset:0
  s_waitcnt lgkmcnt(3)
  v_mfma_f32_32x32x16_bf16 v[32:47], v[20:23], v[172:175], v[32:47]
  v_permlane16_swap_b32 v80, v88
  v_permlane16_swap_b32 v81, v89
  v_permlane16_swap_b32 v82, v90
  v_mfma_f32_32x32x16_bf16 v[48:63], v[20:23], v[236:239], v[48:63]
  v_permlane16_swap_b32 v83, v91
  v_accvgpr_write_b32 a140, v80
  v_xor_b32 v9, 131072, v9
  ds_read_b128 v[20:23], v9 offset:0
  s_waitcnt lgkmcnt(3)
  v_mfma_f32_32x32x16_bf16 v[32:47], v[24:27], v[176:179], v[32:47]
  v_accvgpr_write_b32 a141, v81
  v_accvgpr_write_b32 a142, v82
  v_accvgpr_write_b32 a143, v83
  v_mfma_f32_32x32x16_bf16 v[48:63], v[24:27], v[240:243], v[48:63]
  v_accvgpr_write_b32 a196, v88
  v_accvgpr_write_b32 a197, v89
  v_xor_b32 v10, 131072, v10
  ds_read_b128 v[24:27], v10 offset:0
  s_waitcnt lgkmcnt(3)
  v_mfma_f32_32x32x16_bf16 v[32:47], v[28:31], v[180:183], v[32:47]
  v_accvgpr_write_b32 a198, v90
  v_accvgpr_write_b32 a199, v91
  v_mfma_f32_32x32x16_bf16 v[48:63], v[28:31], v[244:247], v[48:63]
  s_waitcnt vmcnt(8)
  s_barrier
  v_xor_b32 v11, 131072, v11
  ds_read_b128 v[28:31], v11 offset:0
  s_waitcnt lgkmcnt(3)
  v_mfma_f32_32x32x16_bf16 v[64:79], v[16:19], v[120:123], 0
  v_mfma_f32_32x32x16_bf16 v[80:95], v[16:19], v[184:187], 0
  v_xor_b32 v12, 131072, v12
  ds_read_b128 v[16:19], v12 offset:0
  s_waitcnt lgkmcnt(3)
  v_mfma_f32_32x32x16_bf16 v[64:79], v[20:23], v[124:127], v[64:79]
  v_mul_f32 v32, s52, v32
  v_mul_f32 v33, s52, v33
  v_cvt_pk_bf16_f32 v32, v32, v33
  v_mfma_f32_32x32x16_bf16 v[80:95], v[20:23], v[188:191], v[80:95]
  v_mul_f32 v34, s52, v34
  v_mul_f32 v35, s52, v35
  v_xor_b32 v13, 131072, v13
  ds_read_b128 v[20:23], v13 offset:0
  s_waitcnt lgkmcnt(3)
  v_mfma_f32_32x32x16_bf16 v[64:79], v[24:27], v[128:131], v[64:79]
  v_cvt_pk_bf16_f32 v33, v34, v35
  v_mul_f32 v36, s52, v36
  v_mul_f32 v37, s52, v37
  v_mfma_f32_32x32x16_bf16 v[80:95], v[24:27], v[192:195], v[80:95]
  v_cvt_pk_bf16_f32 v34, v36, v37
  v_mul_f32 v38, s52, v38
  v_xor_b32 v14, 131072, v14
  ds_read_b128 v[24:27], v14 offset:0
  s_waitcnt lgkmcnt(3)
  v_mfma_f32_32x32x16_bf16 v[64:79], v[28:31], v[132:135], v[64:79]
  v_mul_f32 v39, s52, v39
  v_cvt_pk_bf16_f32 v35, v38, v39
  v_mul_f32 v40, s52, v40
  v_mfma_f32_32x32x16_bf16 v[80:95], v[28:31], v[196:199], v[80:95]
  v_mul_f32 v41, s52, v41
  v_cvt_pk_bf16_f32 v40, v40, v41
  v_xor_b32 v15, 131072, v15
  ds_read_b128 v[28:31], v15 offset:0
  s_waitcnt lgkmcnt(3)
  v_mfma_f32_32x32x16_bf16 v[64:79], v[16:19], v[136:139], v[64:79]
  v_mul_f32 v42, s52, v42
  v_mul_f32 v43, s52, v43
  v_cvt_pk_bf16_f32 v41, v42, v43
  v_mfma_f32_32x32x16_bf16 v[80:95], v[16:19], v[200:203], v[80:95]
  v_mul_f32 v44, s52, v44
  v_mul_f32 v45, s52, v45
  ds_read_b128 v[16:19], v8 offset:256
  s_waitcnt lgkmcnt(3)
  v_mfma_f32_32x32x16_bf16 v[64:79], v[20:23], v[140:143], v[64:79]
  v_cvt_pk_bf16_f32 v42, v44, v45
  v_mul_f32 v46, s52, v46
  v_mul_f32 v47, s52, v47
  v_mfma_f32_32x32x16_bf16 v[80:95], v[20:23], v[204:207], v[80:95]
  v_cvt_pk_bf16_f32 v43, v46, v47
  v_permlane16_swap_b32 v32, v40
  ds_read_b128 v[20:23], v9 offset:256
  s_waitcnt lgkmcnt(3)
  v_mfma_f32_32x32x16_bf16 v[64:79], v[24:27], v[144:147], v[64:79]
  v_permlane16_swap_b32 v33, v41
  v_permlane16_swap_b32 v34, v42
  v_permlane16_swap_b32 v35, v43
  v_mfma_f32_32x32x16_bf16 v[80:95], v[24:27], v[208:211], v[80:95]
  v_accvgpr_write_b32 a32, v32
  v_accvgpr_write_b32 a33, v33
  ds_read_b128 v[24:27], v10 offset:256
  s_waitcnt lgkmcnt(3)
  v_mfma_f32_32x32x16_bf16 v[64:79], v[28:31], v[148:151], v[64:79]
  v_accvgpr_write_b32 a34, v34
  v_accvgpr_write_b32 a35, v35
  v_accvgpr_write_b32 a88, v40
  v_mfma_f32_32x32x16_bf16 v[80:95], v[28:31], v[212:215], v[80:95]
  v_accvgpr_write_b32 a89, v41
  v_accvgpr_write_b32 a90, v42
  ds_read_b128 v[28:31], v11 offset:256
  s_waitcnt lgkmcnt(3)
  v_mfma_f32_32x32x16_bf16 v[64:79], v[16:19], v[152:155], v[64:79]
  v_accvgpr_write_b32 a91, v43
  v_mul_f32 v48, s52, v48
  v_mul_f32 v49, s52, v49
  v_mfma_f32_32x32x16_bf16 v[80:95], v[16:19], v[216:219], v[80:95]
  v_cvt_pk_bf16_f32 v48, v48, v49
  v_mul_f32 v50, s52, v50
  ds_read_b128 v[16:19], v12 offset:256
  s_waitcnt lgkmcnt(3)
  v_mfma_f32_32x32x16_bf16 v[64:79], v[20:23], v[156:159], v[64:79]
  v_mul_f32 v51, s52, v51
  v_cvt_pk_bf16_f32 v49, v50, v51
  v_mul_f32 v52, s52, v52
  v_mfma_f32_32x32x16_bf16 v[80:95], v[20:23], v[220:223], v[80:95]
  v_mul_f32 v53, s52, v53
  v_cvt_pk_bf16_f32 v50, v52, v53
  ds_read_b128 v[20:23], v13 offset:256
  s_waitcnt lgkmcnt(3)
  v_mfma_f32_32x32x16_bf16 v[64:79], v[24:27], v[160:163], v[64:79]
  v_mul_f32 v54, s52, v54
  v_mul_f32 v55, s52, v55
  v_cvt_pk_bf16_f32 v51, v54, v55
  v_mfma_f32_32x32x16_bf16 v[80:95], v[24:27], v[224:227], v[80:95]
  v_mul_f32 v56, s52, v56
  v_mul_f32 v57, s52, v57
  ds_read_b128 v[24:27], v14 offset:256
  s_waitcnt lgkmcnt(3)
  v_mfma_f32_32x32x16_bf16 v[64:79], v[28:31], v[164:167], v[64:79]
  v_cvt_pk_bf16_f32 v56, v56, v57
  v_mul_f32 v58, s52, v58
  v_mul_f32 v59, s52, v59
  v_mfma_f32_32x32x16_bf16 v[80:95], v[28:31], v[228:231], v[80:95]
  v_cvt_pk_bf16_f32 v57, v58, v59
  v_mul_f32 v60, s52, v60
  ds_read_b128 v[28:31], v15 offset:256
  s_waitcnt lgkmcnt(3)
  v_mfma_f32_32x32x16_bf16 v[64:79], v[16:19], v[168:171], v[64:79]
  v_mul_f32 v61, s52, v61
  v_cvt_pk_bf16_f32 v58, v60, v61
  v_mul_f32 v62, s52, v62
  v_mfma_f32_32x32x16_bf16 v[80:95], v[16:19], v[232:235], v[80:95]
  v_mul_f32 v63, s52, v63
  v_cvt_pk_bf16_f32 v59, v62, v63
  ds_read_b128 v[16:19], v8 offset:16384
  s_waitcnt lgkmcnt(3)
  v_mfma_f32_32x32x16_bf16 v[64:79], v[20:23], v[172:175], v[64:79]
  v_permlane16_swap_b32 v48, v56
  v_permlane16_swap_b32 v49, v57
  v_permlane16_swap_b32 v50, v58
  v_mfma_f32_32x32x16_bf16 v[80:95], v[20:23], v[236:239], v[80:95]
  v_permlane16_swap_b32 v51, v59
  v_accvgpr_write_b32 a144, v48
  ds_read_b128 v[20:23], v9 offset:16384
  s_waitcnt lgkmcnt(3)
  v_mfma_f32_32x32x16_bf16 v[64:79], v[24:27], v[176:179], v[64:79]
  v_accvgpr_write_b32 a145, v49
  v_accvgpr_write_b32 a146, v50
  v_accvgpr_write_b32 a147, v51
  v_mfma_f32_32x32x16_bf16 v[80:95], v[24:27], v[240:243], v[80:95]
  v_accvgpr_write_b32 a200, v56
  v_accvgpr_write_b32 a201, v57
  ds_read_b128 v[24:27], v10 offset:16384
  s_waitcnt lgkmcnt(3)
  v_mfma_f32_32x32x16_bf16 v[64:79], v[28:31], v[180:183], v[64:79]
  v_accvgpr_write_b32 a202, v58
  v_accvgpr_write_b32 a203, v59
  v_mfma_f32_32x32x16_bf16 v[80:95], v[28:31], v[244:247], v[80:95]
  ds_read_b128 v[28:31], v11 offset:16384
  s_waitcnt lgkmcnt(3)
  v_mfma_f32_32x32x16_bf16 v[32:47], v[16:19], v[120:123], 0
  v_mfma_f32_32x32x16_bf16 v[48:63], v[16:19], v[184:187], 0
  ds_read_b128 v[16:19], v12 offset:16384
  s_waitcnt lgkmcnt(3)
  v_mfma_f32_32x32x16_bf16 v[32:47], v[20:23], v[124:127], v[32:47]
  v_mul_f32 v64, s52, v64
  v_mul_f32 v65, s52, v65
  v_cvt_pk_bf16_f32 v64, v64, v65
  v_mfma_f32_32x32x16_bf16 v[48:63], v[20:23], v[188:191], v[48:63]
  v_mul_f32 v66, s52, v66
  v_mul_f32 v67, s52, v67
  ds_read_b128 v[20:23], v13 offset:16384
  s_waitcnt lgkmcnt(3)
  v_mfma_f32_32x32x16_bf16 v[32:47], v[24:27], v[128:131], v[32:47]
  v_cvt_pk_bf16_f32 v65, v66, v67
  v_mul_f32 v68, s52, v68
  v_mul_f32 v69, s52, v69
  v_mfma_f32_32x32x16_bf16 v[48:63], v[24:27], v[192:195], v[48:63]
  v_cvt_pk_bf16_f32 v66, v68, v69
  v_mul_f32 v70, s52, v70
  ds_read_b128 v[24:27], v14 offset:16384
  s_waitcnt lgkmcnt(3)
  v_mfma_f32_32x32x16_bf16 v[32:47], v[28:31], v[132:135], v[32:47]
  v_mul_f32 v71, s52, v71
  v_cvt_pk_bf16_f32 v67, v70, v71
  v_mul_f32 v72, s52, v72
  v_mfma_f32_32x32x16_bf16 v[48:63], v[28:31], v[196:199], v[48:63]
  v_mul_f32 v73, s52, v73
  v_cvt_pk_bf16_f32 v72, v72, v73
  ds_read_b128 v[28:31], v15 offset:16384
  s_waitcnt lgkmcnt(3)
  v_mfma_f32_32x32x16_bf16 v[32:47], v[16:19], v[136:139], v[32:47]
  buffer_load_dwordx4 v[100:103], v113, s[8:11], s28 offen sc1
  v_mul_f32 v74, s52, v74
  v_mul_f32 v75, s52, v75
  v_cvt_pk_bf16_f32 v73, v74, v75
  v_mfma_f32_32x32x16_bf16 v[48:63], v[16:19], v[200:203], v[48:63]
  v_mul_f32 v76, s52, v76
  v_mul_f32 v77, s52, v77
  ds_read_b128 v[16:19], v8 offset:16640
  s_waitcnt lgkmcnt(3)
  v_mfma_f32_32x32x16_bf16 v[32:47], v[20:23], v[140:143], v[32:47]
  v_cvt_pk_bf16_f32 v74, v76, v77
  v_mul_f32 v78, s52, v78
  v_mul_f32 v79, s52, v79
  v_mfma_f32_32x32x16_bf16 v[48:63], v[20:23], v[204:207], v[48:63]
  v_cvt_pk_bf16_f32 v75, v78, v79
  v_permlane16_swap_b32 v64, v72
  ds_read_b128 v[20:23], v9 offset:16640
  s_waitcnt lgkmcnt(3)
  v_mfma_f32_32x32x16_bf16 v[32:47], v[24:27], v[144:147], v[32:47]
  v_permlane16_swap_b32 v65, v73
  v_permlane16_swap_b32 v66, v74
  v_permlane16_swap_b32 v67, v75
  v_mfma_f32_32x32x16_bf16 v[48:63], v[24:27], v[208:211], v[48:63]
  v_accvgpr_write_b32 a36, v64
  v_accvgpr_write_b32 a37, v65
  ds_read_b128 v[24:27], v10 offset:16640
  s_waitcnt lgkmcnt(3)
  v_mfma_f32_32x32x16_bf16 v[32:47], v[28:31], v[148:151], v[32:47]
  v_accvgpr_write_b32 a38, v66
  v_accvgpr_write_b32 a39, v67
  v_accvgpr_write_b32 a92, v72
  v_mfma_f32_32x32x16_bf16 v[48:63], v[28:31], v[212:215], v[48:63]
  v_accvgpr_write_b32 a93, v73
  v_accvgpr_write_b32 a94, v74
  ds_read_b128 v[28:31], v11 offset:16640
  s_waitcnt lgkmcnt(3)
  v_mfma_f32_32x32x16_bf16 v[32:47], v[16:19], v[152:155], v[32:47]
  v_accvgpr_write_b32 a95, v75
  v_mul_f32 v80, s52, v80
  v_mul_f32 v81, s52, v81
  v_mfma_f32_32x32x16_bf16 v[48:63], v[16:19], v[216:219], v[48:63]
  v_cvt_pk_bf16_f32 v80, v80, v81
  v_mul_f32 v82, s52, v82
  ds_read_b128 v[16:19], v12 offset:16640
  s_waitcnt lgkmcnt(3)
  v_mfma_f32_32x32x16_bf16 v[32:47], v[20:23], v[156:159], v[32:47]
  v_mul_f32 v83, s52, v83
  v_cvt_pk_bf16_f32 v81, v82, v83
  v_mul_f32 v84, s52, v84
  v_mfma_f32_32x32x16_bf16 v[48:63], v[20:23], v[220:223], v[48:63]
  v_mul_f32 v85, s52, v85
  v_cvt_pk_bf16_f32 v82, v84, v85
  ds_read_b128 v[20:23], v13 offset:16640
  s_waitcnt lgkmcnt(3)
  v_mfma_f32_32x32x16_bf16 v[32:47], v[24:27], v[160:163], v[32:47]
  v_mul_f32 v86, s52, v86
  v_mul_f32 v87, s52, v87
  v_cvt_pk_bf16_f32 v83, v86, v87
  v_mfma_f32_32x32x16_bf16 v[48:63], v[24:27], v[224:227], v[48:63]
  v_mul_f32 v88, s52, v88
  v_mul_f32 v89, s52, v89
  ds_read_b128 v[24:27], v14 offset:16640
  s_waitcnt lgkmcnt(3)
  v_mfma_f32_32x32x16_bf16 v[32:47], v[28:31], v[164:167], v[32:47]
  v_cvt_pk_bf16_f32 v88, v88, v89
  v_mul_f32 v90, s52, v90
  v_mul_f32 v91, s52, v91
  v_mfma_f32_32x32x16_bf16 v[48:63], v[28:31], v[228:231], v[48:63]
  v_cvt_pk_bf16_f32 v89, v90, v91
  v_mul_f32 v92, s52, v92
  ds_read_b128 v[28:31], v15 offset:16640
  s_waitcnt lgkmcnt(3)
  v_mfma_f32_32x32x16_bf16 v[32:47], v[16:19], v[168:171], v[32:47]
  v_mul_f32 v93, s52, v93
  v_cvt_pk_bf16_f32 v90, v92, v93
  v_mul_f32 v94, s52, v94
  v_mfma_f32_32x32x16_bf16 v[48:63], v[16:19], v[232:235], v[48:63]
  v_mul_f32 v95, s52, v95
  v_cvt_pk_bf16_f32 v91, v94, v95
  ds_read_b128 v[16:19], v8 offset:32768
  s_waitcnt lgkmcnt(3)
  v_mfma_f32_32x32x16_bf16 v[32:47], v[20:23], v[172:175], v[32:47]
  v_permlane16_swap_b32 v80, v88
  v_permlane16_swap_b32 v81, v89
  v_permlane16_swap_b32 v82, v90
  v_mfma_f32_32x32x16_bf16 v[48:63], v[20:23], v[236:239], v[48:63]
  v_permlane16_swap_b32 v83, v91
  v_accvgpr_write_b32 a148, v80
  ds_read_b128 v[20:23], v9 offset:32768
  s_waitcnt lgkmcnt(3)
  v_mfma_f32_32x32x16_bf16 v[32:47], v[24:27], v[176:179], v[32:47]
  v_accvgpr_write_b32 a149, v81
  v_accvgpr_write_b32 a150, v82
  v_accvgpr_write_b32 a151, v83
  v_mfma_f32_32x32x16_bf16 v[48:63], v[24:27], v[240:243], v[48:63]
  v_accvgpr_write_b32 a204, v88
  v_accvgpr_write_b32 a205, v89
  ds_read_b128 v[24:27], v10 offset:32768
  s_waitcnt lgkmcnt(3)
  v_mfma_f32_32x32x16_bf16 v[32:47], v[28:31], v[180:183], v[32:47]
  v_accvgpr_write_b32 a206, v90
  v_accvgpr_write_b32 a207, v91
  v_mfma_f32_32x32x16_bf16 v[48:63], v[28:31], v[244:247], v[48:63]
  s_waitcnt vmcnt(1)
  s_barrier
  ds_read_b128 v[28:31], v11 offset:32768
  s_waitcnt lgkmcnt(3)
  v_mfma_f32_32x32x16_bf16 v[64:79], v[16:19], v[120:123], 0
  s_waitcnt vmcnt(0)
  v_cmp_ne_u64 vcc, s[88:89], v[100:101]
  v_cmp_ne_u64 s[54:55], s[88:89], v[102:103]
  s_add_u32 s48, s33, 14336
  v_mfma_f32_32x32x16_bf16 v[80:95], v[16:19], v[184:187], 0
  ds_read_b128 v[16:19], v12 offset:32768
  s_waitcnt lgkmcnt(3)
  v_mfma_f32_32x32x16_bf16 v[64:79], v[20:23], v[124:127], v[64:79]
  s_or_b64 vcc, vcc, s[54:55]
  s_cselect_b32 s48, 0x10000000, s48
  s_add_u32 s22, s48, 0
  s_add_u32 m0, s25, 0
  s_nop 0
  buffer_load_dwordx4 v2, s[8:11], s22 offen sc1 lds
  v_mul_f32 v32, s52, v32
  v_mul_f32 v33, s52, v33
  v_cvt_pk_bf16_f32 v32, v32, v33
  v_mfma_f32_32x32x16_bf16 v[80:95], v[20:23], v[188:191], v[80:95]
  v_mul_f32 v34, s52, v34
  v_mul_f32 v35, s52, v35
  ds_read_b128 v[20:23], v13 offset:32768
  s_waitcnt lgkmcnt(3)
  v_mfma_f32_32x32x16_bf16 v[64:79], v[24:27], v[128:131], v[64:79]
  s_add_u32 s22, s48, 1024
  s_add_u32 m0, s25, 1024
  s_nop 0
  buffer_load_dwordx4 v2, s[8:11], s22 offen sc1 lds
  v_cvt_pk_bf16_f32 v33, v34, v35
  v_mul_f32 v36, s52, v36
  v_mul_f32 v37, s52, v37
  v_mfma_f32_32x32x16_bf16 v[80:95], v[24:27], v[192:195], v[80:95]
  v_cvt_pk_bf16_f32 v34, v36, v37
  v_mul_f32 v38, s52, v38
  ds_read_b128 v[24:27], v14 offset:32768
  s_waitcnt lgkmcnt(3)
  v_mfma_f32_32x32x16_bf16 v[64:79], v[28:31], v[132:135], v[64:79]
  s_add_u32 s22, s48, 2048
  s_add_u32 m0, s25, 2048
  s_nop 0
  buffer_load_dwordx4 v2, s[8:11], s22 offen sc1 lds
  v_mul_f32 v39, s52, v39
  v_cvt_pk_bf16_f32 v35, v38, v39
  v_mul_f32 v40, s52, v40
  v_mfma_f32_32x32x16_bf16 v[80:95], v[28:31], v[196:199], v[80:95]
  v_mul_f32 v41, s52, v41
  v_cvt_pk_bf16_f32 v40, v40, v41
  ds_read_b128 v[28:31], v15 offset:32768
  s_waitcnt lgkmcnt(3)
  v_mfma_f32_32x32x16_bf16 v[64:79], v[16:19], v[136:139], v[64:79]
  s_add_u32 s22, s48, 3072
  s_add_u32 m0, s25, 3072
  s_nop 0
  buffer_load_dwordx4 v2, s[8:11], s22 offen sc1 lds
  v_mul_f32 v42, s52, v42
  v_mul_f32 v43, s52, v43
  v_cvt_pk_bf16_f32 v41, v42, v43
  v_mfma_f32_32x32x16_bf16 v[80:95], v[16:19], v[200:203], v[80:95]
  v_mul_f32 v44, s52, v44
  v_mul_f32 v45, s52, v45
  ds_read_b128 v[16:19], v8 offset:33024
  s_waitcnt lgkmcnt(3)
  v_mfma_f32_32x32x16_bf16 v[64:79], v[20:23], v[140:143], v[64:79]
  s_add_u32 s22, s48, 4096
  s_add_u32 m0, s25, 16384
  s_nop 0
  buffer_load_dwordx4 v2, s[8:11], s22 offen sc1 lds
  buffer_load_dwordx4 v[100:103], v113, s[8:11], s28 offen sc1
  v_cvt_pk_bf16_f32 v42, v44, v45
  v_mul_f32 v46, s52, v46
  v_mul_f32 v47, s52, v47
  v_mfma_f32_32x32x16_bf16 v[80:95], v[20:23], v[204:207], v[80:95]
  v_cvt_pk_bf16_f32 v43, v46, v47
  v_permlane16_swap_b32 v32, v40
  ds_read_b128 v[20:23], v9 offset:33024
  s_waitcnt lgkmcnt(3)
  v_mfma_f32_32x32x16_bf16 v[64:79], v[24:27], v[144:147], v[64:79]
  s_add_u32 s22, s48, 5120
  s_add_u32 m0, s25, 17408
  s_nop 0
  buffer_load_dwordx4 v2, s[8:11], s22 offen sc1 lds
  v_permlane16_swap_b32 v33, v41
  v_permlane16_swap_b32 v34, v42
  v_permlane16_swap_b32 v35, v43
  v_mfma_f32_32x32x16_bf16 v[80:95], v[24:27], v[208:211], v[80:95]
  v_accvgpr_write_b32 a40, v32
  v_accvgpr_write_b32 a41, v33
  ds_read_b128 v[24:27], v10 offset:33024
  s_waitcnt lgkmcnt(3)
  v_mfma_f32_32x32x16_bf16 v[64:79], v[28:31], v[148:151], v[64:79]
  s_add_u32 s22, s48, 6144
  s_add_u32 m0, s25, 18432
  s_nop 0
  buffer_load_dwordx4 v2, s[8:11], s22 offen sc1 lds
  v_accvgpr_write_b32 a42, v34
  v_accvgpr_write_b32 a43, v35
  v_accvgpr_write_b32 a96, v40
  v_mfma_f32_32x32x16_bf16 v[80:95], v[28:31], v[212:215], v[80:95]
  v_accvgpr_write_b32 a97, v41
  v_accvgpr_write_b32 a98, v42
  ds_read_b128 v[28:31], v11 offset:33024
  s_waitcnt lgkmcnt(3)
  v_mfma_f32_32x32x16_bf16 v[64:79], v[16:19], v[152:155], v[64:79]
  s_add_u32 s22, s48, 7168
  s_add_u32 m0, s25, 19456
  s_nop 0
  buffer_load_dwordx4 v2, s[8:11], s22 offen sc1 lds
  v_accvgpr_write_b32 a99, v43
  v_mul_f32 v48, s52, v48
  v_mul_f32 v49, s52, v49
  v_mfma_f32_32x32x16_bf16 v[80:95], v[16:19], v[216:219], v[80:95]
  v_cvt_pk_bf16_f32 v48, v48, v49
  v_mul_f32 v50, s52, v50
  ds_read_b128 v[16:19], v12 offset:33024
  s_waitcnt lgkmcnt(3)
  v_mfma_f32_32x32x16_bf16 v[64:79], v[20:23], v[156:159], v[64:79]
  s_add_u32 s22, s48, 8192
  s_add_u32 m0, s25, 81920
  s_nop 0
  buffer_load_dwordx4 v2, s[8:11], s22 offen sc1 lds
  v_mul_f32 v51, s52, v51
  v_cvt_pk_bf16_f32 v49, v50, v51
  v_mul_f32 v52, s52, v52
  v_mfma_f32_32x32x16_bf16 v[80:95], v[20:23], v[220:223], v[80:95]
  v_mul_f32 v53, s52, v53
  v_cvt_pk_bf16_f32 v50, v52, v53
  ds_read_b128 v[20:23], v13 offset:33024
  s_waitcnt lgkmcnt(3)
  v_mfma_f32_32x32x16_bf16 v[64:79], v[24:27], v[160:163], v[64:79]
  s_add_u32 s22, s48, 9216
  s_add_u32 m0, s25, 82944
  s_nop 0
  buffer_load_dwordx4 v2, s[8:11], s22 offen sc1 lds
  v_mul_f32 v54, s52, v54
  v_mul_f32 v55, s52, v55
  v_cvt_pk_bf16_f32 v51, v54, v55
  v_mfma_f32_32x32x16_bf16 v[80:95], v[24:27], v[224:227], v[80:95]
  v_mul_f32 v56, s52, v56
  v_mul_f32 v57, s52, v57
  ds_read_b128 v[24:27], v14 offset:33024
  s_waitcnt lgkmcnt(3)
  v_mfma_f32_32x32x16_bf16 v[64:79], v[28:31], v[164:167], v[64:79]
  s_add_u32 s22, s48, 10240
  s_add_u32 m0, s25, 83968
  s_nop 0
  buffer_load_dwordx4 v2, s[8:11], s22 offen sc1 lds
  v_cvt_pk_bf16_f32 v56, v56, v57
  v_mul_f32 v58, s52, v58
  v_mul_f32 v59, s52, v59
  v_mfma_f32_32x32x16_bf16 v[80:95], v[28:31], v[228:231], v[80:95]
  v_cvt_pk_bf16_f32 v57, v58, v59
  v_mul_f32 v60, s52, v60
  ds_read_b128 v[28:31], v15 offset:33024
  s_waitcnt lgkmcnt(3)
  v_mfma_f32_32x32x16_bf16 v[64:79], v[16:19], v[168:171], v[64:79]
  s_add_u32 s22, s48, 11264
  s_add_u32 m0, s25, 84992
  s_nop 0
  buffer_load_dwordx4 v2, s[8:11], s22 offen sc1 lds
  v_mul_f32 v61, s52, v61
  v_cvt_pk_bf16_f32 v58, v60, v61
  v_mul_f32 v62, s52, v62
  v_mfma_f32_32x32x16_bf16 v[80:95], v[16:19], v[232:235], v[80:95]
  v_mul_f32 v63, s52, v63
  v_cvt_pk_bf16_f32 v59, v62, v63
  ds_read_b128 v[16:19], v8 offset:49152
  s_waitcnt lgkmcnt(3)
  v_mfma_f32_32x32x16_bf16 v[64:79], v[20:23], v[172:175], v[64:79]
  s_add_u32 s22, s48, 12288
  s_add_u32 m0, s25, 98304
  s_nop 0
  buffer_load_dwordx4 v2, s[8:11], s22 offen sc1 lds
  v_permlane16_swap_b32 v48, v56
  v_permlane16_swap_b32 v49, v57
  v_permlane16_swap_b32 v50, v58
  v_mfma_f32_32x32x16_bf16 v[80:95], v[20:23], v[236:239], v[80:95]
  v_permlane16_swap_b32 v51, v59
  v_accvgpr_write_b32 a152, v48
  ds_read_b128 v[20:23], v9 offset:49152
  s_waitcnt lgkmcnt(3)
  v_mfma_f32_32x32x16_bf16 v[64:79], v[24:27], v[176:179], v[64:79]
  s_add_u32 s22, s48, 13312
  s_add_u32 m0, s25, 99328
  s_nop 0
  buffer_load_dwordx4 v2, s[8:11], s22 offen sc1 lds
  v_accvgpr_write_b32 a153, v49
  v_accvgpr_write_b32 a154, v50
  v_accvgpr_write_b32 a155, v51
  v_mfma_f32_32x32x16_bf16 v[80:95], v[24:27], v[240:243], v[80:95]
  v_accvgpr_write_b32 a208, v56
  v_accvgpr_write_b32 a209, v57
  ds_read_b128 v[24:27], v10 offset:49152
  s_waitcnt lgkmcnt(3)
  v_mfma_f32_32x32x16_bf16 v[64:79], v[28:31], v[180:183], v[64:79]
  v_accvgpr_write_b32 a210, v58
  v_accvgpr_write_b32 a211, v59
  v_mfma_f32_32x32x16_bf16 v[80:95], v[28:31], v[244:247], v[80:95]
  ds_read_b128 v[28:31], v11 offset:49152
  s_waitcnt lgkmcnt(3)
  v_mfma_f32_32x32x16_bf16 v[32:47], v[16:19], v[120:123], 0
  s_waitcnt vmcnt(9)
  v_cmp_ne_u64 vcc, s[88:89], v[100:101]
  v_cmp_ne_u64 s[54:55], s[88:89], v[102:103]
  s_add_u32 s49, s32, 0
  v_mfma_f32_32x32x16_bf16 v[48:63], v[16:19], v[184:187], 0
  ds_read_b128 v[16:19], v12 offset:49152
  s_waitcnt lgkmcnt(3)
  v_mfma_f32_32x32x16_bf16 v[32:47], v[20:23], v[124:127], v[32:47]
  s_or_b64 vcc, vcc, s[54:55]
  s_cselect_b32 s49, 0x10000000, s49
  s_add_u32 s22, s49, 0
  s_add_u32 m0, s25, 100352
  s_nop 0
  buffer_load_dwordx4 v2, s[8:11], s22 offen sc1 lds
  v_mul_f32 v64, s52, v64
  v_mul_f32 v65, s52, v65
  v_cvt_pk_bf16_f32 v64, v64, v65
  v_mfma_f32_32x32x16_bf16 v[48:63], v[20:23], v[188:191], v[48:63]
  v_mul_f32 v66, s52, v66
  v_mul_f32 v67, s52, v67
  ds_read_b128 v[20:23], v13 offset:49152
  s_waitcnt lgkmcnt(3)
  v_mfma_f32_32x32x16_bf16 v[32:47], v[24:27], v[128:131], v[32:47]
  s_add_u32 s22, s49, 1024
  s_add_u32 m0, s25, 101376
  s_nop 0
  buffer_load_dwordx4 v2, s[8:11], s22 offen sc1 lds
  v_cvt_pk_bf16_f32 v65, v66, v67
  v_mul_f32 v68, s52, v68
  v_mul_f32 v69, s52, v69
  v_mfma_f32_32x32x16_bf16 v[48:63], v[24:27], v[192:195], v[48:63]
  v_cvt_pk_bf16_f32 v66, v68, v69
  v_mul_f32 v70, s52, v70
  ds_read_b128 v[24:27], v14 offset:49152
  s_waitcnt lgkmcnt(3)
  v_mfma_f32_32x32x16_bf16 v[32:47], v[28:31], v[132:135], v[32:47]
  s_add_u32 s22, s49, 2048
  s_add_u32 m0, s25, 114688
  s_nop 0
  buffer_load_dwordx4 v2, s[8:11], s22 offen sc1 lds
  v_mul_f32 v71, s52, v71
  v_cvt_pk_bf16_f32 v67, v70, v71
  v_mul_f32 v72, s52, v72
  v_mfma_f32_32x32x16_bf16 v[48:63], v[28:31], v[196:199], v[48:63]
  v_mul_f32 v73, s52, v73
  v_cvt_pk_bf16_f32 v72, v72, v73
  ds_read_b128 v[28:31], v15 offset:49152
  s_waitcnt lgkmcnt(3)
  v_mfma_f32_32x32x16_bf16 v[32:47], v[16:19], v[136:139], v[32:47]
  s_add_u32 s22, s49, 3072
  s_add_u32 m0, s25, 115712
  s_nop 0
  buffer_load_dwordx4 v2, s[8:11], s22 offen sc1 lds
  v_mul_f32 v74, s52, v74
  v_mul_f32 v75, s52, v75
  v_cvt_pk_bf16_f32 v73, v74, v75
  v_mfma_f32_32x32x16_bf16 v[48:63], v[16:19], v[200:203], v[48:63]
  v_mul_f32 v76, s52, v76
  v_mul_f32 v77, s52, v77
  ds_read_b128 v[16:19], v8 offset:49408
  s_waitcnt lgkmcnt(3)
  v_mfma_f32_32x32x16_bf16 v[32:47], v[20:23], v[140:143], v[32:47]
  s_add_u32 s22, s49, 4096
  s_add_u32 m0, s25, 116736
  s_nop 0
  buffer_load_dwordx4 v2, s[8:11], s22 offen sc1 lds
  buffer_load_dwordx4 v[100:103], v113, s[8:11], s28 offen sc1
  v_cvt_pk_bf16_f32 v74, v76, v77
  v_mul_f32 v78, s52, v78
  v_mul_f32 v79, s52, v79
  v_mfma_f32_32x32x16_bf16 v[48:63], v[20:23], v[204:207], v[48:63]
  v_cvt_pk_bf16_f32 v75, v78, v79
  v_permlane16_swap_b32 v64, v72
  ds_read_b128 v[20:23], v9 offset:49408
  s_waitcnt lgkmcnt(3)
  v_mfma_f32_32x32x16_bf16 v[32:47], v[24:27], v[144:147], v[32:47]
  s_add_u32 s22, s49, 5120
  s_add_u32 m0, s25, 117760
  s_nop 0
  buffer_load_dwordx4 v2, s[8:11], s22 offen sc1 lds
  v_permlane16_swap_b32 v65, v73
  v_permlane16_swap_b32 v66, v74
  v_permlane16_swap_b32 v67, v75
  v_mfma_f32_32x32x16_bf16 v[48:63], v[24:27], v[208:211], v[48:63]
  v_accvgpr_write_b32 a44, v64
  v_accvgpr_write_b32 a45, v65
  ds_read_b128 v[24:27], v10 offset:49408
  s_waitcnt lgkmcnt(3)
  v_mfma_f32_32x32x16_bf16 v[32:47], v[28:31], v[148:151], v[32:47]
  s_add_u32 s22, s49, 6144
  s_add_u32 m0, s25, 131072
  s_nop 0
  buffer_load_dwordx4 v2, s[8:11], s22 offen sc1 lds
  v_accvgpr_write_b32 a46, v66
  v_accvgpr_write_b32 a47, v67
  v_accvgpr_write_b32 a100, v72
  v_mfma_f32_32x32x16_bf16 v[48:63], v[28:31], v[212:215], v[48:63]
  v_accvgpr_write_b32 a101, v73
  v_accvgpr_write_b32 a102, v74
  ds_read_b128 v[28:31], v11 offset:49408
  s_waitcnt lgkmcnt(3)
  v_mfma_f32_32x32x16_bf16 v[32:47], v[16:19], v[152:155], v[32:47]
  s_add_u32 s22, s49, 7168
  s_add_u32 m0, s25, 132096
  s_nop 0
  buffer_load_dwordx4 v2, s[8:11], s22 offen sc1 lds
  v_accvgpr_write_b32 a103, v75
  v_mul_f32 v80, s52, v80
  v_mul_f32 v81, s52, v81
  v_mfma_f32_32x32x16_bf16 v[48:63], v[16:19], v[216:219], v[48:63]
  v_cvt_pk_bf16_f32 v80, v80, v81
  v_mul_f32 v82, s52, v82
  ds_read_b128 v[16:19], v12 offset:49408
  s_waitcnt lgkmcnt(3)
  v_mfma_f32_32x32x16_bf16 v[32:47], v[20:23], v[156:159], v[32:47]
  s_add_u32 s22, s49, 8192
  s_add_u32 m0, s25, 133120
  s_nop 0
  buffer_load_dwordx4 v2, s[8:11], s22 offen sc1 lds
  v_mul_f32 v83, s52, v83
  v_cvt_pk_bf16_f32 v81, v82, v83
  v_mul_f32 v84, s52, v84
  v_mfma_f32_32x32x16_bf16 v[48:63], v[20:23], v[220:223], v[48:63]
  v_mul_f32 v85, s52, v85
  v_cvt_pk_bf16_f32 v82, v84, v85
  ds_read_b128 v[20:23], v13 offset:49408
  s_waitcnt lgkmcnt(3)
  v_mfma_f32_32x32x16_bf16 v[32:47], v[24:27], v[160:163], v[32:47]
  s_add_u32 s22, s49, 9216
  s_add_u32 m0, s25, 134144
  s_nop 0
  buffer_load_dwordx4 v2, s[8:11], s22 offen sc1 lds
  v_mul_f32 v86, s52, v86
  v_mul_f32 v87, s52, v87
  v_cvt_pk_bf16_f32 v83, v86, v87
  v_mfma_f32_32x32x16_bf16 v[48:63], v[24:27], v[224:227], v[48:63]
  v_mul_f32 v88, s52, v88
  v_mul_f32 v89, s52, v89
  ds_read_b128 v[24:27], v14 offset:49408
  s_waitcnt lgkmcnt(3)
  v_mfma_f32_32x32x16_bf16 v[32:47], v[28:31], v[164:167], v[32:47]
  s_add_u32 s22, s49, 10240
  s_add_u32 m0, s25, 147456
  s_nop 0
  buffer_load_dwordx4 v2, s[8:11], s22 offen sc1 lds
  v_cvt_pk_bf16_f32 v88, v88, v89
  v_mul_f32 v90, s52, v90
  v_mul_f32 v91, s52, v91
  v_mfma_f32_32x32x16_bf16 v[48:63], v[28:31], v[228:231], v[48:63]
  v_cvt_pk_bf16_f32 v89, v90, v91
  v_mul_f32 v92, s52, v92
  ds_read_b128 v[28:31], v15 offset:49408
  s_waitcnt lgkmcnt(3)
  v_mfma_f32_32x32x16_bf16 v[32:47], v[16:19], v[168:171], v[32:47]
  s_add_u32 s22, s49, 11264
  s_add_u32 m0, s25, 148480
  s_nop 0
  buffer_load_dwordx4 v2, s[8:11], s22 offen sc1 lds
  v_mul_f32 v93, s52, v93
  v_cvt_pk_bf16_f32 v90, v92, v93
  v_mul_f32 v94, s52, v94
  v_mfma_f32_32x32x16_bf16 v[48:63], v[16:19], v[232:235], v[48:63]
  v_mul_f32 v95, s52, v95
  v_cvt_pk_bf16_f32 v91, v94, v95
  v_xor_b32 v8, 65536, v8
  ds_read_b128 v[16:19], v8 offset:0
  s_waitcnt lgkmcnt(3)
  v_mfma_f32_32x32x16_bf16 v[32:47], v[20:23], v[172:175], v[32:47]
  s_add_u32 s22, s49, 12288
  s_add_u32 m0, s25, 149504
  s_nop 0
  buffer_load_dwordx4 v2, s[8:11], s22 offen sc1 lds
  v_permlane16_swap_b32 v80, v88
  v_permlane16_swap_b32 v81, v89
  v_permlane16_swap_b32 v82, v90
  v_mfma_f32_32x32x16_bf16 v[48:63], v[20:23], v[236:239], v[48:63]
  v_permlane16_swap_b32 v83, v91
  v_accvgpr_write_b32 a156, v80
  v_xor_b32 v9, 65536, v9
  ds_read_b128 v[20:23], v9 offset:0
  s_waitcnt lgkmcnt(3)
  v_mfma_f32_32x32x16_bf16 v[32:47], v[24:27], v[176:179], v[32:47]
  s_add_u32 s22, s49, 13312
  s_add_u32 m0, s25, 150528
  s_nop 0
  buffer_load_dwordx4 v2, s[8:11], s22 offen sc1 lds
  v_accvgpr_write_b32 a157, v81
  v_accvgpr_write_b32 a158, v82
  v_accvgpr_write_b32 a159, v83
  v_mfma_f32_32x32x16_bf16 v[48:63], v[24:27], v[240:243], v[48:63]
  v_accvgpr_write_b32 a212, v88
  v_accvgpr_write_b32 a213, v89
  v_xor_b32 v10, 65536, v10
  ds_read_b128 v[24:27], v10 offset:0
  s_waitcnt lgkmcnt(3)
  v_mfma_f32_32x32x16_bf16 v[32:47], v[28:31], v[180:183], v[32:47]
  v_accvgpr_write_b32 a214, v90
  v_accvgpr_write_b32 a215, v91
  v_mfma_f32_32x32x16_bf16 v[48:63], v[28:31], v[244:247], v[48:63]
  s_barrier
  v_xor_b32 v11, 65536, v11
  ds_read_b128 v[28:31], v11 offset:0
  s_waitcnt lgkmcnt(3)
  v_mfma_f32_32x32x16_bf16 v[64:79], v[16:19], v[120:123], 0
  s_waitcnt vmcnt(9)
  v_cmp_ne_u64 vcc, s[88:89], v[100:101]
  v_cmp_ne_u64 s[54:55], s[88:89], v[102:103]
  s_add_u32 s50, s33, 0
  v_mfma_f32_32x32x16_bf16 v[80:95], v[16:19], v[184:187], 0
  v_xor_b32 v12, 65536, v12
  ds_read_b128 v[16:19], v12 offset:0
  s_waitcnt lgkmcnt(3)
  v_mfma_f32_32x32x16_bf16 v[64:79], v[20:23], v[124:127], v[64:79]
  s_or_b64 vcc, vcc, s[54:55]
  s_cselect_b32 s50, 0x10000000, s50
  s_add_u32 s22, s50, 0
  buffer_load_dwordx4 a[224:227], v2, s[8:11], s22 offen sc1
  v_mul_f32 v32, s52, v32
  v_mul_f32 v33, s52, v33
  v_cvt_pk_bf16_f32 v32, v32, v33
  v_mfma_f32_32x32x16_bf16 v[80:95], v[20:23], v[188:191], v[80:95]
  v_mul_f32 v34, s52, v34
  v_mul_f32 v35, s52, v35
  v_xor_b32 v13, 65536, v13
  ds_read_b128 v[20:23], v13 offset:0
  s_waitcnt lgkmcnt(3)
  v_mfma_f32_32x32x16_bf16 v[64:79], v[24:27], v[128:131], v[64:79]
  s_add_u32 s22, s50, 1024
  buffer_load_dwordx4 a[228:231], v2, s[8:11], s22 offen sc1
  v_cvt_pk_bf16_f32 v33, v34, v35
  v_mul_f32 v36, s52, v36
  v_mul_f32 v37, s52, v37
  v_mfma_f32_32x32x16_bf16 v[80:95], v[24:27], v[192:195], v[80:95]
  v_cvt_pk_bf16_f32 v34, v36, v37
  v_mul_f32 v38, s52, v38
  v_xor_b32 v14, 65536, v14
  ds_read_b128 v[24:27], v14 offset:0
  s_waitcnt lgkmcnt(3)
  v_mfma_f32_32x32x16_bf16 v[64:79], v[28:31], v[132:135], v[64:79]
  s_add_u32 s22, s50, 2048
  buffer_load_dwordx4 a[232:235], v2, s[8:11], s22 offen sc1
  v_mul_f32 v39, s52, v39
  v_cvt_pk_bf16_f32 v35, v38, v39
  v_mul_f32 v40, s52, v40
  v_mfma_f32_32x32x16_bf16 v[80:95], v[28:31], v[196:199], v[80:95]
  v_mul_f32 v41, s52, v41
  v_cvt_pk_bf16_f32 v40, v40, v41
  v_xor_b32 v15, 65536, v15
  ds_read_b128 v[28:31], v15 offset:0
  s_waitcnt lgkmcnt(3)
  v_mfma_f32_32x32x16_bf16 v[64:79], v[16:19], v[136:139], v[64:79]
  s_add_u32 s22, s50, 3072
  buffer_load_dwordx4 a[236:239], v2, s[8:11], s22 offen sc1
  v_mul_f32 v42, s52, v42
  v_mul_f32 v43, s52, v43
  v_cvt_pk_bf16_f32 v41, v42, v43
  v_mfma_f32_32x32x16_bf16 v[80:95], v[16:19], v[200:203], v[80:95]
  v_mul_f32 v44, s52, v44
  v_mul_f32 v45, s52, v45
  ds_read_b128 v[16:19], v8 offset:256
  s_waitcnt lgkmcnt(3)
  v_mfma_f32_32x32x16_bf16 v[64:79], v[20:23], v[140:143], v[64:79]
  s_add_u32 s22, s50, 4096
  buffer_load_dwordx4 a[240:243], v2, s[8:11], s22 offen sc1
  v_cvt_pk_bf16_f32 v42, v44, v45
  v_mul_f32 v46, s52, v46
  v_mul_f32 v47, s52, v47
  v_mfma_f32_32x32x16_bf16 v[80:95], v[20:23], v[204:207], v[80:95]
  v_cvt_pk_bf16_f32 v43, v46, v47
  v_permlane16_swap_b32 v32, v40
  ds_read_b128 v[20:23], v9 offset:256
  s_waitcnt lgkmcnt(3)
  v_mfma_f32_32x32x16_bf16 v[64:79], v[24:27], v[144:147], v[64:79]
  s_add_u32 s22, s50, 5120
  buffer_load_dwordx4 a[244:247], v2, s[8:11], s22 offen sc1
  v_permlane16_swap_b32 v33, v41
  v_permlane16_swap_b32 v34, v42
  v_permlane16_swap_b32 v35, v43
  v_mfma_f32_32x32x16_bf16 v[80:95], v[24:27], v[208:211], v[80:95]
  v_accvgpr_write_b32 a48, v32
  v_accvgpr_write_b32 a49, v33
  ds_read_b128 v[24:27], v10 offset:256
  s_waitcnt lgkmcnt(3)
  v_mfma_f32_32x32x16_bf16 v[64:79], v[28:31], v[148:151], v[64:79]
  s_add_u32 s22, s50, 6144
  buffer_load_dwordx4 a[248:251], v2, s[8:11], s22 offen sc1
  v_accvgpr_write_b32 a50, v34
  v_accvgpr_write_b32 a51, v35
  v_accvgpr_write_b32 a104, v40
  v_mfma_f32_32x32x16_bf16 v[80:95], v[28:31], v[212:215], v[80:95]
  v_accvgpr_write_b32 a105, v41
  v_accvgpr_write_b32 a106, v42
  ds_read_b128 v[28:31], v11 offset:256
  s_waitcnt lgkmcnt(3)
  v_mfma_f32_32x32x16_bf16 v[64:79], v[16:19], v[152:155], v[64:79]
  s_add_u32 s22, s50, 7168
  buffer_load_dwordx4 a[252:255], v2, s[8:11], s22 offen sc1
  v_accvgpr_write_b32 a107, v43
  v_mul_f32 v48, s52, v48
  v_mul_f32 v49, s52, v49
  v_mfma_f32_32x32x16_bf16 v[80:95], v[16:19], v[216:219], v[80:95]
  v_cvt_pk_bf16_f32 v48, v48, v49
  v_mul_f32 v50, s52, v50
  ds_read_b128 v[16:19], v12 offset:256
  s_waitcnt lgkmcnt(3)
  v_mfma_f32_32x32x16_bf16 v[64:79], v[20:23], v[156:159], v[64:79]
  s_add_u32 s22, s50, 8192
  s_add_u32 m0, s25, 32768
  s_nop 0
  buffer_load_dwordx4 v2, s[8:11], s22 offen sc1 lds
  v_mul_f32 v51, s52, v51
  v_cvt_pk_bf16_f32 v49, v50, v51
  v_mul_f32 v52, s52, v52
  v_mfma_f32_32x32x16_bf16 v[80:95], v[20:23], v[220:223], v[80:95]
  v_mul_f32 v53, s52, v53
  v_cvt_pk_bf16_f32 v50, v52, v53
  ds_read_b128 v[20:23], v13 offset:256
  s_waitcnt lgkmcnt(3)
  v_mfma_f32_32x32x16_bf16 v[64:79], v[24:27], v[160:163], v[64:79]
  s_add_u32 s22, s50, 9216
  s_add_u32 m0, s25, 33792
  s_nop 0
  buffer_load_dwordx4 v2, s[8:11], s22 offen sc1 lds
  v_mul_f32 v54, s52, v54
  v_mul_f32 v55, s52, v55
  v_cvt_pk_bf16_f32 v51, v54, v55
  v_mfma_f32_32x32x16_bf16 v[80:95], v[24:27], v[224:227], v[80:95]
  v_mul_f32 v56, s52, v56
  v_mul_f32 v57, s52, v57
  ds_read_b128 v[24:27], v14 offset:256
  s_waitcnt lgkmcnt(3)
  v_mfma_f32_32x32x16_bf16 v[64:79], v[28:31], v[164:167], v[64:79]
  s_add_u32 s22, s50, 10240
  s_add_u32 m0, s25, 34816
  s_nop 0
  buffer_load_dwordx4 v2, s[8:11], s22 offen sc1 lds
  v_cvt_pk_bf16_f32 v56, v56, v57
  v_mul_f32 v58, s52, v58
  v_mul_f32 v59, s52, v59
  v_mfma_f32_32x32x16_bf16 v[80:95], v[28:31], v[228:231], v[80:95]
  v_cvt_pk_bf16_f32 v57, v58, v59
  v_mul_f32 v60, s52, v60
  ds_read_b128 v[28:31], v15 offset:256
  s_waitcnt lgkmcnt(3)
  v_mfma_f32_32x32x16_bf16 v[64:79], v[16:19], v[168:171], v[64:79]
  s_add_u32 s22, s50, 11264
  s_add_u32 m0, s25, 35840
  s_nop 0
  buffer_load_dwordx4 v2, s[8:11], s22 offen sc1 lds
  v_mul_f32 v61, s52, v61
  v_cvt_pk_bf16_f32 v58, v60, v61
  v_mul_f32 v62, s52, v62
  v_mfma_f32_32x32x16_bf16 v[80:95], v[16:19], v[232:235], v[80:95]
  v_mul_f32 v63, s52, v63
  v_cvt_pk_bf16_f32 v59, v62, v63
  s_waitcnt lgkmcnt(2)
  v_mfma_f32_32x32x16_bf16 v[64:79], v[20:23], v[172:175], v[64:79]
  s_add_u32 s22, s50, 12288
  s_add_u32 m0, s25, 49152
  s_nop 0
  buffer_load_dwordx4 v2, s[8:11], s22 offen sc1 lds
  v_permlane16_swap_b32 v48, v56
  v_permlane16_swap_b32 v49, v57
  v_permlane16_swap_b32 v50, v58
  v_mfma_f32_32x32x16_bf16 v[80:95], v[20:23], v[236:239], v[80:95]
  v_permlane16_swap_b32 v51, v59
  v_accvgpr_write_b32 a160, v48
  s_waitcnt lgkmcnt(1)
  v_mfma_f32_32x32x16_bf16 v[64:79], v[24:27], v[176:179], v[64:79]
  s_add_u32 s22, s50, 13312
  s_add_u32 m0, s25, 50176
  s_nop 0
  buffer_load_dwordx4 v2, s[8:11], s22 offen sc1 lds
  v_accvgpr_write_b32 a161, v49
  v_accvgpr_write_b32 a162, v50
  v_accvgpr_write_b32 a163, v51
  v_mfma_f32_32x32x16_bf16 v[80:95], v[24:27], v[240:243], v[80:95]
  v_accvgpr_write_b32 a216, v56
  v_accvgpr_write_b32 a217, v57
  s_waitcnt lgkmcnt(0)
  v_mfma_f32_32x32x16_bf16 v[64:79], v[28:31], v[180:183], v[64:79]
  buffer_load_dwordx4 v[100:103], v113, s[8:11], s28 offen sc1
  buffer_load_dwordx4 v[104:107], v2, s[8:11], s29 offen sc1
  buffer_load_dwordx4 v[108:111], v112, s[8:11], s29 offen sc1
  v_accvgpr_write_b32 a218, v58
  v_accvgpr_write_b32 a219, v59
  v_mfma_f32_32x32x16_bf16 v[80:95], v[28:31], v[244:247], v[80:95]
  s_nop 4
  v_mul_f32 v64, s52, v64
  v_mul_f32 v65, s52, v65
  v_cvt_pk_bf16_f32 v64, v64, v65
  v_mul_f32 v66, s52, v66
  v_mul_f32 v67, s52, v67
  v_cvt_pk_bf16_f32 v65, v66, v67
  v_mul_f32 v68, s52, v68
  v_mul_f32 v69, s52, v69
  v_cvt_pk_bf16_f32 v66, v68, v69
  v_mul_f32 v70, s52, v70
  v_mul_f32 v71, s52, v71
  v_cvt_pk_bf16_f32 v67, v70, v71
  v_mul_f32 v72, s52, v72
  v_mul_f32 v73, s52, v73
  v_cvt_pk_bf16_f32 v72, v72, v73
  v_mul_f32 v74, s52, v74
  v_mul_f32 v75, s52, v75
  v_cvt_pk_bf16_f32 v73, v74, v75
  v_mul_f32 v76, s52, v76
  v_mul_f32 v77, s52, v77
  v_cvt_pk_bf16_f32 v74, v76, v77
  v_mul_f32 v78, s52, v78
  v_mul_f32 v79, s52, v79
  v_cvt_pk_bf16_f32 v75, v78, v79
  v_permlane16_swap_b32 v64, v72
  v_permlane16_swap_b32 v65, v73
  v_permlane16_swap_b32 v66, v74
  v_permlane16_swap_b32 v67, v75
  v_accvgpr_write_b32 a52, v64
  v_accvgpr_write_b32 a53, v65
  v_accvgpr_write_b32 a54, v66
  v_accvgpr_write_b32 a55, v67
  v_accvgpr_write_b32 a108, v72
  v_accvgpr_write_b32 a109, v73
  v_accvgpr_write_b32 a110, v74
  v_accvgpr_write_b32 a111, v75
  v_mul_f32 v80, s52, v80
  v_mul_f32 v81, s52, v81
  v_cvt_pk_bf16_f32 v80, v80, v81
  v_mul_f32 v82, s52, v82
  v_mul_f32 v83, s52, v83
  v_cvt_pk_bf16_f32 v81, v82, v83
  v_mul_f32 v84, s52, v84
  v_mul_f32 v85, s52, v85
  v_cvt_pk_bf16_f32 v82, v84, v85
  v_mul_f32 v86, s52, v86
  v_mul_f32 v87, s52, v87
  v_cvt_pk_bf16_f32 v83, v86, v87
  v_mul_f32 v88, s52, v88
  v_mul_f32 v89, s52, v89
  v_cvt_pk_bf16_f32 v88, v88, v89
  v_mul_f32 v90, s52, v90
  v_mul_f32 v91, s52, v91
  v_cvt_pk_bf16_f32 v89, v90, v91
  v_mul_f32 v92, s52, v92
  v_mul_f32 v93, s52, v93
  v_cvt_pk_bf16_f32 v90, v92, v93
  v_mul_f32 v94, s52, v94
  v_mul_f32 v95, s52, v95
  v_cvt_pk_bf16_f32 v91, v94, v95
  v_permlane16_swap_b32 v80, v88
  v_permlane16_swap_b32 v81, v89
  v_permlane16_swap_b32 v82, v90
  v_permlane16_swap_b32 v83, v91
  v_accvgpr_write_b32 a164, v80
  v_accvgpr_write_b32 a165, v81
  v_accvgpr_write_b32 a166, v82
  v_accvgpr_write_b32 a167, v83
  v_accvgpr_write_b32 a220, v88
  v_accvgpr_write_b32 a221, v89
  v_accvgpr_write_b32 a222, v90
  v_accvgpr_write_b32 a223, v91
  s_mov_b32 s30, 0
  s_branch sc_aw_w
sc_aw:
  buffer_load_dwordx4 v[100:103], v113, s[8:11], s28 offen sc1
  buffer_load_dwordx4 v[104:107], v2, s[8:11], s29 offen sc1
  buffer_load_dwordx4 v[108:111], v112, s[8:11], s29 offen sc1
sc_aw_w:
  s_waitcnt vmcnt(0)
  v_cmp_ne_u64 vcc, s[88:89], v[100:101]
  s_cbranch_vccnz sc_aw_no
  v_cmp_ne_u64 vcc, s[88:89], v[102:103]
  s_cbranch_vccnz sc_aw_no
  v_cmp_ne_u64 vcc, s[88:89], v[104:105]
  s_cbranch_vccnz sc_aw_no
  v_cmp_ne_u64 vcc, s[88:89], v[106:107]
  s_cbranch_vccnz sc_aw_no
  v_cmp_ne_u64 vcc, s[88:89], v[108:109]
  s_cbranch_vccnz sc_aw_no
  v_cmp_ne_u64 vcc, s[88:89], v[110:111]
  s_cbranch_vccnz sc_aw_no
  s_branch sc_aw_ok
sc_aw_no:
  s_sleep 1
  s_add_u32 s30, s30, 1
  s_cmp_lt_u32 s30, 50000
  s_cbranch_scc1 sc_aw
  s_branch cA_abort
sc_aw_ok:
  v_add_u32 v4, s25, v2
  v_add_u32 v5, 0x10000, v4
  v_add_u32 v6, 0x20000, v4
  s_cmp_eq_u32 s48, 0x10000000
  s_cbranch_scc1 sc_d0
  ds_read_b128 v[144:147], v4 offset:0
  ds_read_b128 v[148:151], v4 offset:1024
  ds_read_b128 v[152:155], v4 offset:2048
  ds_read_b128 v[156:159], v4 offset:3072
  ds_read_b128 v[160:163], v4 offset:16384
  ds_read_b128 v[164:167], v4 offset:17408
  ds_read_b128 v[168:171], v4 offset:18432
  ds_read_b128 v[172:175], v4 offset:19456
  ds_read_b128 v[176:179], v5 offset:16384
  ds_read_b128 v[180:183], v5 offset:17408
  ds_read_b128 v[184:187], v5 offset:18432
  ds_read_b128 v[188:191], v5 offset:19456
  ds_read_b128 v[192:195], v5 offset:32768
  ds_read_b128 v[196:199], v5 offset:33792
  s_waitcnt lgkmcnt(0)
  s_branch sc_e0
sc_d0:
  s_add_u32 s22, s33, 12288
  buffer_load_dwordx4 v[144:147], v2, s[8:11], s22 offen offset:2048 sc1
  buffer_load_dwordx4 v[148:151], v2, s[8:11], s22 offen offset:3072 sc1
  s_add_u32 s22, s33, 16384
  buffer_load_dwordx4 v[152:155], v2, s[8:11], s22 offen offset:0 sc1
  buffer_load_dwordx4 v[156:159], v2, s[8:11], s22 offen offset:1024 sc1
  buffer_load_dwordx4 v[160:163], v2, s[8:11], s22 offen offset:2048 sc1
  buffer_load_dwordx4 v[164:167], v2, s[8:11], s22 offen offset:3072 sc1
  s_add_u32 s22, s33, 20480
  buffer_load_dwordx4 v[168:171], v2, s[8:11], s22 offen offset:0 sc1
  buffer_load_dwordx4 v[172:175], v2, s[8:11], s22 offen offset:1024 sc1
  buffer_load_dwordx4 v[176:179], v2, s[8:11], s22 offen offset:2048 sc1
  buffer_load_dwordx4 v[180:183], v2, s[8:11], s22 offen offset:3072 sc1
  s_add_u32 s22, s33, 24576
  buffer_load_dwordx4 v[184:187], v2, s[8:11], s22 offen offset:0 sc1
  buffer_load_dwordx4 v[188:191], v2, s[8:11], s22 offen offset:1024 sc1
  buffer_load_dwordx4 v[192:195], v2, s[8:11], s22 offen offset:2048 sc1
  buffer_load_dwordx4 v[196:199], v2, s[8:11], s22 offen offset:3072 sc1
sc_e0:
  s_cmp_eq_u32 s49, 0x10000000
  s_cbranch_scc1 sc_d1
  ds_read_b128 v[200:203], v5 offset:34816
  ds_read_b128 v[204:207], v5 offset:35840
  ds_read_b128 v[208:211], v5 offset:49152
  ds_read_b128 v[212:215], v5 offset:50176
  ds_read_b128 v[216:219], v5 offset:51200
  ds_read_b128 v[220:223], v5 offset:52224
  ds_read_b128 v[224:227], v6 offset:0
  ds_read_b128 v[228:231], v6 offset:1024
  ds_read_b128 v[232:235], v6 offset:2048
  ds_read_b128 v[236:239], v6 offset:3072
  ds_read_b128 v[240:243], v6 offset:16384
  ds_read_b128 v[244:247], v6 offset:17408
  ds_read_b128 v[248:251], v6 offset:18432
  ds_read_b128 v[252:255], v6 offset:19456
  s_waitcnt lgkmcnt(0)
  s_branch sc_e1
sc_d1:
  s_add_u32 s22, s32, 0
  buffer_load_dwordx4 v[200:203], v2, s[8:11], s22 offen offset:0 sc1
  buffer_load_dwordx4 v[204:207], v2, s[8:11], s22 offen offset:1024 sc1
  buffer_load_dwordx4 v[208:211], v2, s[8:11], s22 offen offset:2048 sc1
  buffer_load_dwordx4 v[212:215], v2, s[8:11], s22 offen offset:3072 sc1
  s_add_u32 s22, s32, 4096
  buffer_load_dwordx4 v[216:219], v2, s[8:11], s22 offen offset:0 sc1
  buffer_load_dwordx4 v[220:223], v2, s[8:11], s22 offen offset:1024 sc1
  buffer_load_dwordx4 v[224:227], v2, s[8:11], s22 offen offset:2048 sc1
  buffer_load_dwordx4 v[228:231], v2, s[8:11], s22 offen offset:3072 sc1
  s_add_u32 s22, s32, 8192
  buffer_load_dwordx4 v[232:235], v2, s[8:11], s22 offen offset:0 sc1
  buffer_load_dwordx4 v[236:239], v2, s[8:11], s22 offen offset:1024 sc1
  buffer_load_dwordx4 v[240:243], v2, s[8:11], s22 offen offset:2048 sc1
  buffer_load_dwordx4 v[244:247], v2, s[8:11], s22 offen offset:3072 sc1
  s_add_u32 s22, s32, 12288
  buffer_load_dwordx4 v[248:251], v2, s[8:11], s22 offen offset:0 sc1
  buffer_load_dwordx4 v[252:255], v2, s[8:11], s22 offen offset:1024 sc1
sc_e1:
  s_cmp_eq_u32 s50, 0x10000000
  s_cbranch_scc1 sc_d2
  ds_read_b128 v[120:123], v4 offset:32768
  ds_read_b128 v[124:127], v4 offset:33792
  ds_read_b128 v[128:131], v4 offset:34816
  ds_read_b128 v[132:135], v4 offset:35840
  ds_read_b128 v[136:139], v4 offset:49152
  ds_read_b128 v[140:143], v4 offset:50176
  s_waitcnt lgkmcnt(0)
  s_branch sc_e2
sc_d2:
  s_add_u32 s22, s33, 0
  buffer_load_dwordx4 a[224:227], v2, s[8:11], s22 offen offset:0 sc1
  buffer_load_dwordx4 a[228:231], v2, s[8:11], s22 offen offset:1024 sc1
  buffer_load_dwordx4 a[232:235], v2, s[8:11], s22 offen offset:2048 sc1
  buffer_load_dwordx4 a[236:239], v2, s[8:11], s22 offen offset:3072 sc1
  s_add_u32 s22, s33, 4096
  buffer_load_dwordx4 a[240:243], v2, s[8:11], s22 offen offset:0 sc1
  buffer_load_dwordx4 a[244:247], v2, s[8:11], s22 offen offset:1024 sc1
  buffer_load_dwordx4 a[248:251], v2, s[8:11], s22 offen offset:2048 sc1
  buffer_load_dwordx4 a[252:255], v2, s[8:11], s22 offen offset:3072 sc1
  s_add_u32 s22, s33, 8192
  buffer_load_dwordx4 v[120:123], v2, s[8:11], s22 offen offset:0 sc1
  buffer_load_dwordx4 v[124:127], v2, s[8:11], s22 offen offset:1024 sc1
  buffer_load_dwordx4 v[128:131], v2, s[8:11], s22 offen offset:2048 sc1
  buffer_load_dwordx4 v[132:135], v2, s[8:11], s22 offen offset:3072 sc1
  s_add_u32 s22, s33, 12288
  buffer_load_dwordx4 v[136:139], v2, s[8:11], s22 offen offset:0 sc1
  buffer_load_dwordx4 v[140:143], v2, s[8:11], s22 offen offset:1024 sc1
sc_e2:
  s_barrier
  s_branch m_role
m_val:
  s_cmp_lg_u32 s16, 0
  s_cbranch_scc1 w0_6
  v_mov_b32 v233, 128
  v_mov_b32 v234, s88
  v_mov_b32 v235, s89
  v_mov_b32 v236, 0
  v_mov_b32 v237, 0
  s_mov_b64 exec, 1
  buffer_atomic_cmpswap_x2 v[234:237], v233, s[12:15], 0 offen sc0
  s_mov_b64 exec, -1
w0_6:
  s_cmp_lg_u32 s66, 0
  s_cbranch_scc1 va_ci
  s_cmp_lg_u32 s16, 0
  s_cbranch_scc1 w0_7
  s_lshr_b32 s70, s3, 5
  s_and_b32 s71, s70, 4
  s_mul_i32 s71, s71, 12
  s_lshl_b32 s70, s70, 2
  s_add_u32 s70, s70, s71
  s_lshl_b32 s71, 1, s3
  v_mov_b32 v242, s71
  v_mov_b32 v243, 32
  s_mov_b64 exec, 1
  buffer_atomic_or v242, v243, s[12:15], s70 offen sc0
  buffer_load_dwordx2 v[244:245], v243, s[12:15], 0 offen offset:96 sc1
  s_mov_b64 exec, -1
w0_7:
va_ci:
  s_mov_b32 s56, s40
  s_and_b32 s57, s41, 0xffff
  s_mov_b32 s58, 3670016
  s_mov_b32 s59, 0x20000
  v_lshrrev_b32 v24, 5, v1
  v_and_b32 v25, 31, v1
  v_lshlrev_b32 v25, 4, v25
  v_lshl_add_u32 v24, v24, 13, v25
  s_mov_b32 s60, s42
  s_and_b32 s61, s43, 0xffff
  s_mov_b32 s62, 3670016
  s_mov_b32 s63, 0x20000
  s_lshl_b32 s22, s17, 9
  s_lshl_b32 s23, s16, 19
  s_add_u32 s23, s22, s23
  s_add_u32 s21, s23, 262144
  buffer_load_dwordx4 v[28:31], v24, s[60:63], s21 offen
  s_add_u32 s21, s23, 278528
  buffer_load_dwordx4 v[28:31], v24, s[60:63], s21 offen
  s_add_u32 s21, s23, 294912
  buffer_load_dwordx4 v[28:31], v24, s[60:63], s21 offen
  s_add_u32 s21, s23, 311296
  buffer_load_dwordx4 v[28:31], v24, s[60:63], s21 offen
  s_add_u32 s21, s23, 327680
  buffer_load_dwordx4 v[28:31], v24, s[60:63], s21 offen
  s_add_u32 s21, s23, 344064
  buffer_load_dwordx4 v[28:31], v24, s[60:63], s21 offen
  s_add_u32 s21, s23, 360448
  buffer_load_dwordx4 v[28:31], v24, s[60:63], s21 offen
  s_add_u32 s21, s23, 376832
  buffer_load_dwordx4 v[28:31], v24, s[60:63], s21 offen
  s_add_u32 s21, s23, 393216
  buffer_load_dwordx4 v[28:31], v24, s[60:63], s21 offen
  s_add_u32 s21, s23, 409600
  buffer_load_dwordx4 v[28:31], v24, s[60:63], s21 offen
  s_add_u32 s21, s23, 425984
  buffer_load_dwordx4 v[28:31], v24, s[60:63], s21 offen
  s_add_u32 s21, s23, 442368
  buffer_load_dwordx4 v[28:31], v24, s[60:63], s21 offen
  s_add_u32 s21, s23, 458752
  buffer_load_dwordx4 v[28:31], v24, s[60:63], s21 offen
  s_add_u32 s21, s23, 475136
  buffer_load_dwordx4 v[28:31], v24, s[60:63], s21 offen
  s_add_u32 s21, s23, 491520
  buffer_load_dwordx4 v[28:31], v24, s[60:63], s21 offen
  s_add_u32 s21, s23, 507904
  buffer_load_dwordx4 v[28:31], v24, s[60:63], s21 offen
  s_lshl_b32 s23, s16, 14
  s_add_u32 s22, s22, s23
  s_mov_b32 s30, 0
va_pf:
  buffer_load_dwordx4 v[28:31], v24, s[56:59], s22 offen
  s_waitcnt vmcnt(40)
  s_add_u32 s22, s22, 65536
  s_add_u32 s30, s30, 1
  s_cmp_lt_u32 s30, 56
  s_cbranch_scc1 va_pf
  s_cmp_lg_u32 s66, 0
  s_cbranch_scc1 va_cf
  s_cmp_lg_u32 s16, 0
  s_cbranch_scc1 w0_8
  s_waitcnt vmcnt(40)
  v_readfirstlane_b32 s70, v244
  s_cmp_lg_u32 s70, 0
  s_cbranch_scc1 va_nz
  v_mov_b32 v243, 128
  v_mov_b32 v244, s88
  v_mov_b32 v245, s89
  v_mov_b32 v246, 0
  v_mov_b32 v247, 0
  s_mov_b64 exec, 1
  buffer_atomic_cmpswap_x2 v[244:247], v243, s[12:15], 0 offen sc0
  s_mov_b64 exec, -1
  s_waitcnt vmcnt(0)
  v_readfirstlane_b32 s70, v244
  s_cmp_lg_u32 s70, 0
  s_cbranch_scc1 va_nz
  v_mov_b32 v244, s88
  v_mov_b32 v245, s89
va_nz:
w0_8:
  v_mov_b32 v243, 160000
  s_add_u32 s101, s101, 1
  s_barrier
  s_mov_b64 exec, 1
  s_cmp_lg_u32 s16, 0
  s_cbranch_scc1 w0_9
  ds_write_b32 v243, v242 offset:0
  ds_write_b32 v243, v244 offset:4
  ds_write_b32 v243, v245 offset:8
  s_waitcnt lgkmcnt(0)
  v_mov_b32 v242, s101
  ds_write_b32 v243, v242 offset:16
  s_waitcnt lgkmcnt(0)
w0_9:
  s_mov_b64 exec, -1
  s_barrier
  ds_read_b32 v242, v243 offset:0
  ds_read_b32 v244, v243 offset:4
  ds_read_b32 v245, v243 offset:8
  ds_read_b32 v243, v243 offset:16
  s_waitcnt lgkmcnt(0)
  v_readfirstlane_b32 s70, v242
  v_readfirstlane_b32 s88, v244
  v_readfirstlane_b32 s89, v245
  v_cmp_ne_u32 vcc, s101, v243
  s_cbranch_vccnz ch_end
  s_mov_b32 s66, 1
  s_bitcmp1_b32 s70, s3
  s_cbranch_scc1 m_reclaim
va_cf:
  s_cmp_lg_u32 s16, 0
  s_cbranch_scc1 w0_10
  s_cmp_eq_u32 s67, 0
  s_cselect_b32 s20, 1, 0x10001
  v_mov_b32 v242, s20
  v_mov_b32 v243, 0
  s_mov_b64 exec, 1
  buffer_atomic_add v242, v243, s[12:15], 0 offen
  s_mov_b64 exec, -1
w0_10:
m_role:
  s_mov_b32 s17, s3
  v_and_b32 v1, 63, v0
  v_lshlrev_b32 v2, 4, v1
  v_lshrrev_b32 v116, 4, v1
  v_and_b32 v117, 15, v1
  v_mov_b32 v3, 0x4444
  v_mov_b32 v118, 0xeeee
  v_cmp_lt_u32 vcc, 7, v117
  s_nop 1
  v_cndmask_b32 v3, v3, v118, vcc
  s_mov_b32 s19, 0
  s_mov_b32 s20, 75235328
  s_lshr_b32 s22, s17, 4
  s_lshl_b32 s22, s22, 2
  s_add_u32 s22, s22, s16
  s_and_b32 s17, s17, 15
  s_cmp_eq_u32 s22, 0
  s_cbranch_scc1 ch_init0
  s_cmp_eq_u32 s22, 1
  s_cbranch_scc1 ch_init1
  s_cmp_eq_u32 s22, 2
  s_cbranch_scc1 ch_init2
  s_cmp_eq_u32 s22, 3
  s_cbranch_scc1 ch_init3
  s_cmp_eq_u32 s22, 4
  s_cbranch_scc1 ch_init4
  s_cmp_eq_u32 s22, 5
  s_cbranch_scc1 ch_init5
  s_cmp_eq_u32 s22, 6
  s_cbranch_scc1 ch_init6
  s_cmp_eq_u32 s22, 7
  s_cbranch_scc1 ch_init7
  s_branch ch_end
ch_init0:
  s_mul_i32 s31, s17, 401408
  s_add_u32 s31, s31, 0
  s_mov_b32 s24, 71565312
  s_mov_b32 s25, 0
  s_add_u32 m0, s25, 0
  s_nop 0
  buffer_load_dwordx4 v2, s[8:11], s24 offen offset:0 sc1 lds
  buffer_load_dwordx4 v2, s[8:11], s24 offen offset:1024 sc1 lds
  buffer_load_dwordx4 v2, s[8:11], s24 offen offset:2048 sc1 lds
  buffer_load_dwordx4 v2, s[8:11], s24 offen offset:3072 sc1 lds
  s_add_u32 m0, s25, 4096
  s_add_u32 s22, s24, 4096
  buffer_load_dwordx4 v2, s[8:11], s22 offen offset:0 sc1 lds
  buffer_load_dwordx4 v2, s[8:11], s22 offen offset:1024 sc1 lds
  buffer_load_dwordx4 v2, s[8:11], s22 offen offset:2048 sc1 lds
  v_and_b32 v64, 7, v117
  v_and_b32 v65, 1, v116
  v_lshlrev_b32 v65, 2, v65
  v_sub_u32 v64, v64, v65
  v_lshrrev_b32 v65, 3, v117
  v_lshl_add_u32 v66, v65, 2, v64
  v_cmp_gt_u32 vcc, 4, v64
  v_mov_b32 v67, 99
  s_nop 0
  v_cndmask_b32 v66, v67, v66, vcc
  v_mov_b32 v68, 0x3f80
  v_mov_b32 v69, 0x3f800000
  v_mov_b32 v4, 0
  v_cmp_eq_u32 vcc, 0, v66
  s_nop 1
  v_cndmask_b32 v4, v4, v68, vcc
  v_cmp_eq_u32 vcc, 1, v66
  s_nop 1
  v_cndmask_b32 v4, v4, v69, vcc
  v_mov_b32 v5, 0
  v_cmp_eq_u32 vcc, 2, v66
  s_nop 1
  v_cndmask_b32 v5, v5, v68, vcc
  v_cmp_eq_u32 vcc, 3, v66
  s_nop 1
  v_cndmask_b32 v5, v5, v69, vcc
  v_mov_b32 v6, 0
  v_cmp_eq_u32 vcc, 4, v66
  s_nop 1
  v_cndmask_b32 v6, v6, v68, vcc
  v_cmp_eq_u32 vcc, 5, v66
  s_nop 1
  v_cndmask_b32 v6, v6, v69, vcc
  v_mov_b32 v7, 0
  v_cmp_eq_u32 vcc, 6, v66
  s_nop 1
  v_cndmask_b32 v7, v7, v68, vcc
  v_cmp_eq_u32 vcc, 7, v66
  s_nop 1
  v_cndmask_b32 v7, v7, v69, vcc
  v_lshrrev_b32 v64, 1, v116
  v_lshrrev_b32 v65, 3, v117
  v_cmp_eq_u32 s[26:27], v64, v65
  v_and_b32 v66, 1, v116
  v_add_u32 v64, 0, v64
  v_lshrrev_b32 v67, 1, v116
  v_lshlrev_b32 v67, 8, v67
  v_lshl_add_u32 v67, v66, 9, v67
  v_lshl_add_u32 v67, v117, 4, v67
  v_add_u32 v112, 57344, v67
  v_and_b32 v68, 7, v117
  v_lshlrev_b32 v67, 8, v64
  v_lshl_add_u32 v67, v68, 5, v67
  v_lshl_add_u32 v67, v66, 4, v67
  v_add_u32 v113, 65536, v67
  v_lshrrev_b32 v64, 5, v1
  v_and_b32 v65, 31, v1
  v_lshrrev_b32 v66, 3, v65
  v_and_b32 v67, 7, v65
  v_and_b32 v68, 3, v67
  v_lshl_add_u32 v68, v66, 2, v68
  v_lshrrev_b32 v69, 2, v67
  v_lshl_add_u32 v68, v69, 4, v68
  v_lshlrev_b32 v69, 11, v64
  v_lshl_add_u32 v69, v68, 4, v69
  v_add_u32 v114, 57344, v69
  v_add_u32 v70, 0, v64
  v_lshlrev_b32 v69, 9, v66
  v_lshl_add_u32 v69, v70, 5, v69
  v_lshl_add_u32 v69, v67, 2, v69
  v_add_u32 v115, 65536, v69
  v_lshlrev_b32 v69, 4, v68
  v_lshl_add_u32 v69, v64, 9, v69
  v_add_u32 v114, 57344, v69
  v_mul_u32_u24 v69, 144, v70
  v_lshl_add_u32 v69, v67, 4, v69
  v_add_u32 v115, 65536, v69
  v_and_b32 v71, 1, v116
  v_mul_u32_u24 v69, 2048, v71
  v_lshl_add_u32 v69, v64, 8, v69
  v_lshl_add_u32 v69, v117, 4, v69
  v_add_u32 v112, 57344, v69
  v_mul_u32_u24 v69, 144, v117
  v_lshl_add_u32 v69, v71, 6, v69
  v_lshl_add_u32 v69, v64, 5, v69
  v_add_u32 v113, 65536, v69
  v_and_b32 v71, 1, v1
  v_cmp_eq_u32 s[38:39], 0, v71
  v_cmp_gt_u32 vcc, 8, v65
  s_or_b64 s[28:29], s[38:39], vcc
  v_lshrrev_b32 v72, 1, v67
  v_lshlrev_b32 v72, 2, v72
  v_lshl_add_u32 v72, v70, 4, v72
  s_lshl_b32 s22, s17, 9
  s_add_u32 s22, s22, 9216
  v_lshl_add_u32 v73, v66, 7, v72
  v_add_u32 v73, s22, v73
  s_lshl_b32 s22, s17, 7
  s_add_u32 s22, s22, 7168
  v_add_u32 v74, s22, v72
  v_bfe_u32 v72, v65, 1, 1
  v_lshlrev_b32 v72, 7, v72
  v_lshl_add_u32 v72, v70, 4, v72
  v_bfe_u32 v73, v65, 2, 2
  v_lshl_add_u32 v72, v73, 2, v72
  v_lshrrev_b32 v73, 4, v65
  v_lshl_add_u32 v73, v73, 8, v72
  s_lshl_b32 s22, s17, 9
  s_add_u32 s22, s22, 9216
  v_add_u32 v73, s22, v73
  s_lshr_b32 s22, s17, 1
  s_lshl_b32 s22, s22, 8
  s_and_b32 s34, s17, 1
  s_lshl_b32 s34, s34, 3
  s_add_u32 s22, s22, s34
  s_add_u32 s22, s22, 7168
  v_add_u32 v74, s22, v72
  v_bfe_u32 v72, v65, 1, 1
  v_lshl_add_u32 v72, v64, 1, v72
  v_lshlrev_b32 v72, 4, v72
  v_bfe_u32 v73, v65, 2, 2
  v_lshl_add_u32 v72, v73, 2, v72
  v_lshrrev_b32 v73, 4, v65
  v_lshl_add_u32 v73, v73, 6, v72
  s_lshl_b32 s22, s17, 9
  s_add_u32 s22, s22, 9216
  v_add_u32 v73, s22, v73
  v_lshrrev_b32 v72, 1, v65
  v_lshlrev_b32 v72, 2, v72
  v_lshl_add_u32 v72, v64, 5, v72
  s_lshr_b32 s22, s17, 1
  s_lshl_b32 s22, s22, 8
  s_and_b32 s34, s17, 1
  s_lshl_b32 s34, s34, 4
  s_add_u32 s22, s22, s34
  s_add_u32 s22, s22, 7168
  v_add_u32 v74, s22, v72
  v_lshlrev_b32 v0, 2, v65
  s_and_b32 s22, s17, 31
  s_lshl_b32 s22, s22, 7
  s_add_u32 s22, s22, 21504
  v_add_u32 v0, s22, v0
  v_cndmask_b32 v1, v74, v73, s[38:39]
  s_lshl_b32 s36, s17, 2
  s_add_u32 s36, s36, 17408
  s_mov_b32 s37, 0x3e800000
  v_mov_b32 v64, 0
  v_mov_b32 v65, 0
  v_mov_b32 v66, 0
  v_mov_b32 v67, 0
  v_mov_b32 v68, 0
  v_mov_b32 v69, 0
  v_mov_b32 v70, 0
  v_mov_b32 v71, 0
  v_mov_b32 v72, 0
  v_mov_b32 v73, 0
  v_mov_b32 v74, 0
  v_mov_b32 v75, 0
  v_mov_b32 v76, 0
  v_mov_b32 v77, 0
  v_mov_b32 v78, 0
  v_mov_b32 v79, 0
  v_mov_b32 v80, 0
  v_mov_b32 v81, 0
  v_mov_b32 v82, 0
  v_mov_b32 v83, 0
  v_mov_b32 v84, 0
  v_mov_b32 v85, 0
  v_mov_b32 v86, 0
  v_mov_b32 v87, 0
  v_mov_b32 v88, 0
  v_mov_b32 v89, 0
  v_mov_b32 v90, 0
  v_mov_b32 v91, 0
  v_mov_b32 v92, 0
  v_mov_b32 v93, 0
  v_mov_b32 v94, 0
  v_mov_b32 v95, 0
  v_mov_b32 v96, 0
  v_mov_b32 v97, 0
  v_mov_b32 v98, 0
  v_mov_b32 v99, 0
  v_mov_b32 v100, 0
  v_mov_b32 v101, 0
  v_mov_b32 v102, 0
  v_mov_b32 v103, 0
  v_mov_b32 v104, 0
  v_mov_b32 v105, 0
  v_mov_b32 v106, 0
  v_mov_b32 v107, 0
  v_mov_b32 v108, 0
  v_mov_b32 v109, 0
  v_mov_b32 v110, 0
  v_mov_b32 v111, 0
  v_and_b32 v118, 1, v116
  v_cmp_eq_u32 vcc, 0, v118
  v_mov_b32 v118, 12288
  v_mov_b32 v119, 8192
  v_cndmask_b32 v118, v118, v119, vcc
  v_lshrrev_b32 v116, 1, v116
  v_lshl_add_u32 v118, v116, 9, v118
  v_lshl_add_u32 v117, v117, 4, v118
  s_mov_b32 s57, 28672
  s_mov_b32 s56, 0x42800000
  v_mov_b32 v116, v2
  s_mul_i32 s35, s17, 1835008
  s_add_u32 s35, s35, 42262528
  s_mov_b32 s30, 0
  v_mov_b32 v36, 0
ch_md0:
  buffer_load_dword v37, v36, s[12:15], 0 offen sc1
  s_waitcnt vmcnt(0)
  v_readfirstlane_b32 s22, v37
  s_and_b32 s31, s22, 0xffff
  s_cmp_ge_u32 s31, 32
  s_cbranch_scc1 ch_go0
  s_sleep 2
  s_add_u32 s30, s30, 1
  s_cmp_lt_u32 s30, 50000
  s_cbranch_scc1 ch_md0
  s_branch ch_end
ch_go0:
  s_mov_b32 s31, 0
  s_lshr_b32 s22, s22, 16
  s_cmp_lg_u32 s22, 0
  s_cbranch_scc1 cB_sc0_loop
  s_branch cA_sc0_loop
ch_init1:
  s_mul_i32 s31, s17, 401408
  s_add_u32 s31, s31, 0
  s_mov_b32 s24, 71572480
  s_mov_b32 s25, 0
  s_add_u32 m0, s25, 7168
  s_nop 0
  buffer_load_dwordx4 v2, s[8:11], s24 offen offset:0 sc1 lds
  buffer_load_dwordx4 v2, s[8:11], s24 offen offset:1024 sc1 lds
  buffer_load_dwordx4 v2, s[8:11], s24 offen offset:2048 sc1 lds
  buffer_load_dwordx4 v2, s[8:11], s24 offen offset:3072 sc1 lds
  s_add_u32 m0, s25, 11264
  s_add_u32 s22, s24, 4096
  buffer_load_dwordx4 v2, s[8:11], s22 offen offset:0 sc1 lds
  buffer_load_dwordx4 v2, s[8:11], s22 offen offset:1024 sc1 lds
  buffer_load_dwordx4 v2, s[8:11], s22 offen offset:2048 sc1 lds
  v_and_b32 v64, 7, v117
  v_and_b32 v65, 1, v116
  v_lshlrev_b32 v65, 2, v65
  v_sub_u32 v64, v64, v65
  v_lshrrev_b32 v65, 3, v117
  v_lshl_add_u32 v66, v65, 2, v64
  v_cmp_gt_u32 vcc, 4, v64
  v_mov_b32 v67, 99
  s_nop 0
  v_cndmask_b32 v66, v67, v66, vcc
  v_mov_b32 v68, 0x3f80
  v_mov_b32 v69, 0x3f800000
  v_mov_b32 v4, 0
  v_cmp_eq_u32 vcc, 0, v66
  s_nop 1
  v_cndmask_b32 v4, v4, v68, vcc
  v_cmp_eq_u32 vcc, 1, v66
  s_nop 1
  v_cndmask_b32 v4, v4, v69, vcc
  v_mov_b32 v5, 0
  v_cmp_eq_u32 vcc, 2, v66
  s_nop 1
  v_cndmask_b32 v5, v5, v68, vcc
  v_cmp_eq_u32 vcc, 3, v66
  s_nop 1
  v_cndmask_b32 v5, v5, v69, vcc
  v_mov_b32 v6, 0
  v_cmp_eq_u32 vcc, 4, v66
  s_nop 1
  v_cndmask_b32 v6, v6, v68, vcc
  v_cmp_eq_u32 vcc, 5, v66
  s_nop 1
  v_cndmask_b32 v6, v6, v69, vcc
  v_mov_b32 v7, 0
  v_cmp_eq_u32 vcc, 6, v66
  s_nop 1
  v_cndmask_b32 v7, v7, v68, vcc
  v_cmp_eq_u32 vcc, 7, v66
  s_nop 1
  v_cndmask_b32 v7, v7, v69, vcc
  v_lshrrev_b32 v64, 1, v116
  v_lshrrev_b32 v65, 3, v117
  v_cmp_eq_u32 s[26:27], v64, v65
  v_and_b32 v66, 1, v116
  v_add_u32 v64, 2, v64
  v_lshrrev_b32 v67, 1, v116
  v_lshlrev_b32 v67, 8, v67
  v_lshl_add_u32 v67, v66, 9, v67
  v_lshl_add_u32 v67, v117, 4, v67
  v_add_u32 v112, 58368, v67
  v_and_b32 v68, 7, v117
  v_lshlrev_b32 v67, 8, v64
  v_lshl_add_u32 v67, v68, 5, v67
  v_lshl_add_u32 v67, v66, 4, v67
  v_add_u32 v113, 65536, v67
  v_lshrrev_b32 v64, 5, v1
  v_and_b32 v65, 31, v1
  v_lshrrev_b32 v66, 3, v65
  v_and_b32 v67, 7, v65
  v_and_b32 v68, 3, v67
  v_lshl_add_u32 v68, v66, 2, v68
  v_lshrrev_b32 v69, 2, v67
  v_lshl_add_u32 v68, v69, 4, v68
  v_lshlrev_b32 v69, 11, v64
  v_lshl_add_u32 v69, v68, 4, v69
  v_add_u32 v114, 57352, v69
  v_add_u32 v70, 2, v64
  v_lshlrev_b32 v69, 9, v66
  v_lshl_add_u32 v69, v70, 5, v69
  v_lshl_add_u32 v69, v67, 2, v69
  v_add_u32 v115, 65536, v69
  v_lshlrev_b32 v69, 4, v68
  v_lshl_add_u32 v69, v64, 9, v69
  v_add_u32 v114, 58368, v69
  v_mul_u32_u24 v69, 144, v70
  v_lshl_add_u32 v69, v67, 4, v69
  v_add_u32 v115, 65536, v69
  v_and_b32 v71, 1, v116
  v_mul_u32_u24 v69, 2048, v71
  v_lshl_add_u32 v69, v64, 8, v69
  v_lshl_add_u32 v69, v117, 4, v69
  v_add_u32 v112, 57352, v69
  v_mul_u32_u24 v69, 144, v117
  v_lshl_add_u32 v69, v71, 6, v69
  v_lshl_add_u32 v69, v64, 5, v69
  v_add_u32 v113, 65540, v69
  v_and_b32 v71, 1, v1
  v_cmp_eq_u32 s[38:39], 0, v71
  v_cmp_gt_u32 vcc, 8, v65
  s_or_b64 s[28:29], s[38:39], vcc
  v_lshrrev_b32 v72, 1, v67
  v_lshlrev_b32 v72, 2, v72
  v_lshl_add_u32 v72, v70, 4, v72
  s_lshl_b32 s22, s17, 9
  s_add_u32 s22, s22, 9216
  v_lshl_add_u32 v73, v66, 7, v72
  v_add_u32 v73, s22, v73
  s_lshl_b32 s22, s17, 7
  s_add_u32 s22, s22, 7168
  v_add_u32 v74, s22, v72
  v_bfe_u32 v72, v65, 1, 1
  v_lshlrev_b32 v72, 7, v72
  v_lshl_add_u32 v72, v70, 4, v72
  v_bfe_u32 v73, v65, 2, 2
  v_lshl_add_u32 v72, v73, 2, v72
  v_lshrrev_b32 v73, 4, v65
  v_lshl_add_u32 v73, v73, 8, v72
  s_lshl_b32 s22, s17, 9
  s_add_u32 s22, s22, 9216
  v_add_u32 v73, s22, v73
  s_lshr_b32 s22, s17, 1
  s_lshl_b32 s22, s22, 8
  s_and_b32 s34, s17, 1
  s_lshl_b32 s34, s34, 3
  s_add_u32 s22, s22, s34
  s_add_u32 s22, s22, 7168
  v_add_u32 v74, s22, v72
  v_bfe_u32 v72, v65, 1, 1
  v_lshl_add_u32 v72, v64, 1, v72
  v_lshlrev_b32 v72, 4, v72
  v_bfe_u32 v73, v65, 2, 2
  v_lshl_add_u32 v72, v73, 2, v72
  v_lshrrev_b32 v73, 4, v65
  v_lshl_add_u32 v73, v73, 6, v72
  s_lshl_b32 s22, s17, 9
  s_add_u32 s22, s22, 9344
  v_add_u32 v73, s22, v73
  v_lshrrev_b32 v72, 1, v65
  v_lshlrev_b32 v72, 2, v72
  v_lshl_add_u32 v72, v64, 5, v72
  s_lshr_b32 s22, s17, 1
  s_lshl_b32 s22, s22, 8
  s_and_b32 s34, s17, 1
  s_lshl_b32 s34, s34, 4
  s_add_u32 s22, s22, s34
  s_add_u32 s22, s22, 7232
  v_add_u32 v74, s22, v72
  v_lshlrev_b32 v0, 2, v65
  s_and_b32 s22, s17, 31
  s_lshl_b32 s22, s22, 7
  s_add_u32 s22, s22, 21504
  v_add_u32 v0, s22, v0
  v_cndmask_b32 v1, v74, v73, s[38:39]
  s_lshl_b32 s36, s17, 2
  s_add_u32 s36, s36, 17408
  s_mov_b32 s37, 0x3e800000
  v_mov_b32 v64, 0
  v_mov_b32 v65, 0
  v_mov_b32 v66, 0
  v_mov_b32 v67, 0
  v_mov_b32 v68, 0
  v_mov_b32 v69, 0
  v_mov_b32 v70, 0
  v_mov_b32 v71, 0
  v_mov_b32 v72, 0
  v_mov_b32 v73, 0
  v_mov_b32 v74, 0
  v_mov_b32 v75, 0
  v_mov_b32 v76, 0
  v_mov_b32 v77, 0
  v_mov_b32 v78, 0
  v_mov_b32 v79, 0
  v_mov_b32 v80, 0
  v_mov_b32 v81, 0
  v_mov_b32 v82, 0
  v_mov_b32 v83, 0
  v_mov_b32 v84, 0
  v_mov_b32 v85, 0
  v_mov_b32 v86, 0
  v_mov_b32 v87, 0
  v_mov_b32 v88, 0
  v_mov_b32 v89, 0
  v_mov_b32 v90, 0
  v_mov_b32 v91, 0
  v_mov_b32 v92, 0
  v_mov_b32 v93, 0
  v_mov_b32 v94, 0
  v_mov_b32 v95, 0
  v_mov_b32 v96, 0
  v_mov_b32 v97, 0
  v_mov_b32 v98, 0
  v_mov_b32 v99, 0
  v_mov_b32 v100, 0
  v_mov_b32 v101, 0
  v_mov_b32 v102, 0
  v_mov_b32 v103, 0
  v_mov_b32 v104, 0
  v_mov_b32 v105, 0
  v_mov_b32 v106, 0
  v_mov_b32 v107, 0
  v_mov_b32 v108, 0
  v_mov_b32 v109, 0
  v_mov_b32 v110, 0
  v_mov_b32 v111, 0
  v_and_b32 v118, 1, v116
  v_cmp_eq_u32 vcc, 0, v118
  v_mov_b32 v118, 12288
  v_mov_b32 v119, 8448
  v_cndmask_b32 v118, v118, v119, vcc
  v_lshrrev_b32 v116, 1, v116
  v_lshl_add_u32 v118, v116, 9, v118
  v_lshl_add_u32 v117, v117, 4, v118
  s_mov_b32 s57, 28672
  s_mov_b32 s56, 0x42800000
  v_mov_b32 v116, v2
  v_lshrrev_b32 v0, 4, v2
  v_min_u32 v0, 12, v0
  s_mul_i32 s22, s17, 13
  v_add_u32 v0, s22, v0
  v_lshlrev_b32 v0, 7, v0
  v_add_u32 v0, 51200, v0
  s_mov_b32 s22, 75209728
  buffer_load_dword v119, v0, s[8:11], s22 offen sc1
  s_mov_b32 s22, 75184128
  buffer_load_dword v119, v0, s[8:11], s22 offen sc1
  s_mul_i32 s35, s17, 1835008
  s_add_u32 s35, s35, 42269696
  s_mov_b32 s30, 0
  v_mov_b32 v36, 0
ch_md1:
  buffer_load_dword v37, v36, s[12:15], 0 offen sc1
  s_waitcnt vmcnt(0)
  v_readfirstlane_b32 s22, v37
  s_and_b32 s31, s22, 0xffff
  s_cmp_ge_u32 s31, 32
  s_cbranch_scc1 ch_go1
  s_sleep 2
  s_add_u32 s30, s30, 1
  s_cmp_lt_u32 s30, 50000
  s_cbranch_scc1 ch_md1
  s_branch ch_end
ch_go1:
  s_mov_b32 s31, 0
  s_lshr_b32 s22, s22, 16
  s_cmp_lg_u32 s22, 0
  s_cbranch_scc1 cB_sc1_loop
  s_branch cA_sc1_loop
ch_init2:
  s_mul_i32 s31, s17, 401408
  s_add_u32 s31, s31, 0
  s_mov_b32 s24, 71579648
  s_mov_b32 s25, 0
  s_add_u32 m0, s25, 14336
  s_nop 0
  buffer_load_dwordx4 v2, s[8:11], s24 offen offset:0 sc1 lds
  buffer_load_dwordx4 v2, s[8:11], s24 offen offset:1024 sc1 lds
  buffer_load_dwordx4 v2, s[8:11], s24 offen offset:2048 sc1 lds
  buffer_load_dwordx4 v2, s[8:11], s24 offen offset:3072 sc1 lds
  s_add_u32 m0, s25, 18432
  s_add_u32 s22, s24, 4096
  buffer_load_dwordx4 v2, s[8:11], s22 offen offset:0 sc1 lds
  buffer_load_dwordx4 v2, s[8:11], s22 offen offset:1024 sc1 lds
  buffer_load_dwordx4 v2, s[8:11], s22 offen offset:2048 sc1 lds
  v_and_b32 v64, 7, v117
  v_and_b32 v65, 1, v116
  v_lshlrev_b32 v65, 2, v65
  v_sub_u32 v64, v64, v65
  v_lshrrev_b32 v65, 3, v117
  v_lshl_add_u32 v66, v65, 2, v64
  v_cmp_gt_u32 vcc, 4, v64
  v_mov_b32 v67, 99
  s_nop 0
  v_cndmask_b32 v66, v67, v66, vcc
  v_mov_b32 v68, 0x3f80
  v_mov_b32 v69, 0x3f800000
  v_mov_b32 v4, 0
  v_cmp_eq_u32 vcc, 0, v66
  s_nop 1
  v_cndmask_b32 v4, v4, v68, vcc
  v_cmp_eq_u32 vcc, 1, v66
  s_nop 1
  v_cndmask_b32 v4, v4, v69, vcc
  v_mov_b32 v5, 0
  v_cmp_eq_u32 vcc, 2, v66
  s_nop 1
  v_cndmask_b32 v5, v5, v68, vcc
  v_cmp_eq_u32 vcc, 3, v66
  s_nop 1
  v_cndmask_b32 v5, v5, v69, vcc
  v_mov_b32 v6, 0
  v_cmp_eq_u32 vcc, 4, v66
  s_nop 1
  v_cndmask_b32 v6, v6, v68, vcc
  v_cmp_eq_u32 vcc, 5, v66
  s_nop 1
  v_cndmask_b32 v6, v6, v69, vcc
  v_mov_b32 v7, 0
  v_cmp_eq_u32 vcc, 6, v66
  s_nop 1
  v_cndmask_b32 v7, v7, v68, vcc
  v_cmp_eq_u32 vcc, 7, v66
  s_nop 1
  v_cndmask_b32 v7, v7, v69, vcc
  v_lshrrev_b32 v64, 1, v116
  v_lshrrev_b32 v65, 3, v117
  v_cmp_eq_u32 s[26:27], v64, v65
  v_and_b32 v66, 1, v116
  v_add_u32 v64, 4, v64
  v_lshrrev_b32 v67, 1, v116
  v_lshlrev_b32 v67, 8, v67
  v_lshl_add_u32 v67, v66, 9, v67
  v_lshl_add_u32 v67, v117, 4, v67
  v_add_u32 v112, 59392, v67
  v_and_b32 v68, 7, v117
  v_lshlrev_b32 v67, 8, v64
  v_lshl_add_u32 v67, v68, 5, v67
  v_lshl_add_u32 v67, v66, 4, v67
  v_add_u32 v113, 65536, v67
  v_lshrrev_b32 v64, 5, v1
  v_and_b32 v65, 31, v1
  v_lshrrev_b32 v66, 3, v65
  v_and_b32 v67, 7, v65
  v_and_b32 v68, 3, v67
  v_lshl_add_u32 v68, v66, 2, v68
  v_lshrrev_b32 v69, 2, v67
  v_lshl_add_u32 v68, v69, 4, v68
  v_lshlrev_b32 v69, 11, v64
  v_lshl_add_u32 v69, v68, 4, v69
  v_add_u32 v114, 57856, v69
  v_add_u32 v70, 4, v64
  v_lshlrev_b32 v69, 9, v66
  v_lshl_add_u32 v69, v70, 5, v69
  v_lshl_add_u32 v69, v67, 2, v69
  v_add_u32 v115, 65536, v69
  v_lshlrev_b32 v69, 4, v68
  v_lshl_add_u32 v69, v64, 9, v69
  v_add_u32 v114, 59392, v69
  v_mul_u32_u24 v69, 144, v70
  v_lshl_add_u32 v69, v67, 4, v69
  v_add_u32 v115, 65536, v69
  v_and_b32 v71, 1, v116
  v_mul_u32_u24 v69, 2048, v71
  v_lshl_add_u32 v69, v64, 8, v69
  v_lshl_add_u32 v69, v117, 4, v69
  v_add_u32 v112, 57856, v69
  v_mul_u32_u24 v69, 144, v117
  v_lshl_add_u32 v69, v71, 6, v69
  v_lshl_add_u32 v69, v64, 5, v69
  v_add_u32 v113, 65544, v69
  v_and_b32 v71, 1, v1
  v_cmp_eq_u32 s[38:39], 0, v71
  v_cmp_gt_u32 vcc, 8, v65
  s_or_b64 s[28:29], s[38:39], vcc
  v_lshrrev_b32 v72, 1, v67
  v_lshlrev_b32 v72, 2, v72
  v_lshl_add_u32 v72, v70, 4, v72
  s_lshl_b32 s22, s17, 9
  s_add_u32 s22, s22, 9216
  v_lshl_add_u32 v73, v66, 7, v72
  v_add_u32 v73, s22, v73
  s_lshl_b32 s22, s17, 7
  s_add_u32 s22, s22, 7168
  v_add_u32 v74, s22, v72
  v_bfe_u32 v72, v65, 1, 1
  v_lshlrev_b32 v72, 7, v72
  v_lshl_add_u32 v72, v70, 4, v72
  v_bfe_u32 v73, v65, 2, 2
  v_lshl_add_u32 v72, v73, 2, v72
  v_lshrrev_b32 v73, 4, v65
  v_lshl_add_u32 v73, v73, 8, v72
  s_lshl_b32 s22, s17, 9
  s_add_u32 s22, s22, 9216
  v_add_u32 v73, s22, v73
  s_lshr_b32 s22, s17, 1
  s_lshl_b32 s22, s22, 8
  s_and_b32 s34, s17, 1
  s_lshl_b32 s34, s34, 3
  s_add_u32 s22, s22, s34
  s_add_u32 s22, s22, 7168
  v_add_u32 v74, s22, v72
  v_bfe_u32 v72, v65, 1, 1
  v_lshl_add_u32 v72, v64, 1, v72
  v_lshlrev_b32 v72, 4, v72
  v_bfe_u32 v73, v65, 2, 2
  v_lshl_add_u32 v72, v73, 2, v72
  v_lshrrev_b32 v73, 4, v65
  v_lshl_add_u32 v73, v73, 6, v72
  s_lshl_b32 s22, s17, 9
  s_add_u32 s22, s22, 9472
  v_add_u32 v73, s22, v73
  v_lshrrev_b32 v72, 1, v65
  v_lshlrev_b32 v72, 2, v72
  v_lshl_add_u32 v72, v64, 5, v72
  s_lshr_b32 s22, s17, 1
  s_lshl_b32 s22, s22, 8
  s_and_b32 s34, s17, 1
  s_lshl_b32 s34, s34, 4
  s_add_u32 s22, s22, s34
  s_add_u32 s22, s22, 7296
  v_add_u32 v74, s22, v72
  v_lshlrev_b32 v0, 2, v65
  s_and_b32 s22, s17, 31
  s_lshl_b32 s22, s22, 7
  s_add_u32 s22, s22, 21504
  v_add_u32 v0, s22, v0
  v_cndmask_b32 v1, v74, v73, s[38:39]
  s_lshl_b32 s36, s17, 2
  s_add_u32 s36, s36, 17408
  s_mov_b32 s37, 0x3e800000
  v_mov_b32 v64, 0
  v_mov_b32 v65, 0
  v_mov_b32 v66, 0
  v_mov_b32 v67, 0
  v_mov_b32 v68, 0
  v_mov_b32 v69, 0
  v_mov_b32 v70, 0
  v_mov_b32 v71, 0
  v_mov_b32 v72, 0
  v_mov_b32 v73, 0
  v_mov_b32 v74, 0
  v_mov_b32 v75, 0
  v_mov_b32 v76, 0
  v_mov_b32 v77, 0
  v_mov_b32 v78, 0
  v_mov_b32 v79, 0
  v_mov_b32 v80, 0
  v_mov_b32 v81, 0
  v_mov_b32 v82, 0
  v_mov_b32 v83, 0
  v_mov_b32 v84, 0
  v_mov_b32 v85, 0
  v_mov_b32 v86, 0
  v_mov_b32 v87, 0
  v_mov_b32 v88, 0
  v_mov_b32 v89, 0
  v_mov_b32 v90, 0
  v_mov_b32 v91, 0
  v_mov_b32 v92, 0
  v_mov_b32 v93, 0
  v_mov_b32 v94, 0
  v_mov_b32 v95, 0
  v_mov_b32 v96, 0
  v_mov_b32 v97, 0
  v_mov_b32 v98, 0
  v_mov_b32 v99, 0
  v_mov_b32 v100, 0
  v_mov_b32 v101, 0
  v_mov_b32 v102, 0
  v_mov_b32 v103, 0
  v_mov_b32 v104, 0
  v_mov_b32 v105, 0
  v_mov_b32 v106, 0
  v_mov_b32 v107, 0
  v_mov_b32 v108, 0
  v_mov_b32 v109, 0
  v_mov_b32 v110, 0
  v_mov_b32 v111, 0
  v_and_b32 v118, 1, v116
  v_cmp_eq_u32 vcc, 0, v118
  v_mov_b32 v118, 12544
  v_mov_b32 v119, 10240
  v_cndmask_b32 v118, v118, v119, vcc
  v_lshrrev_b32 v116, 1, v116
  v_lshl_add_u32 v118, v116, 9, v118
  v_lshl_add_u32 v117, v117, 4, v118
  s_mov_b32 s57, 28672
  s_mov_b32 s56, 0x42800000
  v_mov_b32 v116, v2
  v_lshrrev_b32 v0, 4, v2
  v_min_u32 v0, 13, v0
  s_mul_i32 s22, s17, 14
  v_add_u32 v0, s22, v0
  v_lshlrev_b32 v0, 7, v0
  v_add_u32 v0, 43008, v0
  s_mov_b32 s22, 71550976
  buffer_load_dword v119, v0, s[8:11], s22 offen sc1
  s_mov_b32 s22, 71522304
  buffer_load_dword v119, v0, s[8:11], s22 offen sc1
  s_mul_i32 s35, s17, 1835008
  s_add_u32 s35, s35, 42276864
  s_mov_b32 s30, 0
  v_mov_b32 v36, 0
ch_md2:
  buffer_load_dword v37, v36, s[12:15], 0 offen sc1
  s_waitcnt vmcnt(0)
  v_readfirstlane_b32 s22, v37
  s_and_b32 s31, s22, 0xffff
  s_cmp_ge_u32 s31, 32
  s_cbranch_scc1 ch_go2
  s_sleep 2
  s_add_u32 s30, s30, 1
  s_cmp_lt_u32 s30, 50000
  s_cbranch_scc1 ch_md2
  s_branch ch_end
ch_go2:
  s_mov_b32 s31, 0
  s_lshr_b32 s22, s22, 16
  s_cmp_lg_u32 s22, 0
  s_cbranch_scc1 cB_sc2_loop
  s_branch cA_sc2_loop
ch_init3:
  s_mul_i32 s31, s17, 401408
  s_add_u32 s31, s31, 0
  s_mov_b32 s24, 71586816
  s_mov_b32 s25, 0
  s_add_u32 m0, s25, 21504
  s_nop 0
  buffer_load_dwordx4 v2, s[8:11], s24 offen offset:0 sc1 lds
  buffer_load_dwordx4 v2, s[8:11], s24 offen offset:1024 sc1 lds
  buffer_load_dwordx4 v2, s[8:11], s24 offen offset:2048 sc1 lds
  buffer_load_dwordx4 v2, s[8:11], s24 offen offset:3072 sc1 lds
  s_add_u32 m0, s25, 25600
  s_add_u32 s22, s24, 4096
  buffer_load_dwordx4 v2, s[8:11], s22 offen offset:0 sc1 lds
  buffer_load_dwordx4 v2, s[8:11], s22 offen offset:1024 sc1 lds
  buffer_load_dwordx4 v2, s[8:11], s22 offen offset:2048 sc1 lds
  v_and_b32 v64, 7, v117
  v_and_b32 v65, 1, v116
  v_lshlrev_b32 v65, 2, v65
  v_sub_u32 v64, v64, v65
  v_lshrrev_b32 v65, 3, v117
  v_lshl_add_u32 v66, v65, 2, v64
  v_cmp_gt_u32 vcc, 4, v64
  v_mov_b32 v67, 99
  s_nop 0
  v_cndmask_b32 v66, v67, v66, vcc
  v_mov_b32 v68, 0x3f80
  v_mov_b32 v69, 0x3f800000
  v_mov_b32 v4, 0
  v_cmp_eq_u32 vcc, 0, v66
  s_nop 1
  v_cndmask_b32 v4, v4, v68, vcc
  v_cmp_eq_u32 vcc, 1, v66
  s_nop 1
  v_cndmask_b32 v4, v4, v69, vcc
  v_mov_b32 v5, 0
  v_cmp_eq_u32 vcc, 2, v66
  s_nop 1
  v_cndmask_b32 v5, v5, v68, vcc
  v_cmp_eq_u32 vcc, 3, v66
  s_nop 1
  v_cndmask_b32 v5, v5, v69, vcc
  v_mov_b32 v6, 0
  v_cmp_eq_u32 vcc, 4, v66
  s_nop 1
  v_cndmask_b32 v6, v6, v68, vcc
  v_cmp_eq_u32 vcc, 5, v66
  s_nop 1
  v_cndmask_b32 v6, v6, v69, vcc
  v_mov_b32 v7, 0
  v_cmp_eq_u32 vcc, 6, v66
  s_nop 1
  v_cndmask_b32 v7, v7, v68, vcc
  v_cmp_eq_u32 vcc, 7, v66
  s_nop 1
  v_cndmask_b32 v7, v7, v69, vcc
  v_lshrrev_b32 v64, 1, v116
  v_lshrrev_b32 v65, 3, v117
  v_cmp_eq_u32 s[26:27], v64, v65
  v_and_b32 v66, 1, v116
  v_add_u32 v64, 6, v64
  v_lshrrev_b32 v67, 1, v116
  v_lshlrev_b32 v67, 8, v67
  v_lshl_add_u32 v67, v66, 9, v67
  v_lshl_add_u32 v67, v117, 4, v67
  v_add_u32 v112, 60416, v67
  v_and_b32 v68, 7, v117
  v_lshlrev_b32 v67, 8, v64
  v_lshl_add_u32 v67, v68, 5, v67
  v_lshl_add_u32 v67, v66, 4, v67
  v_add_u32 v113, 65536, v67
  v_lshrrev_b32 v64, 5, v1
  v_and_b32 v65, 31, v1
  v_lshrrev_b32 v66, 3, v65
  v_and_b32 v67, 7, v65
  v_and_b32 v68, 3, v67
  v_lshl_add_u32 v68, v66, 2, v68
  v_lshrrev_b32 v69, 2, v67
  v_lshl_add_u32 v68, v69, 4, v68
  v_lshlrev_b32 v69, 11, v64
  v_lshl_add_u32 v69, v68, 4, v69
  v_add_u32 v114, 57864, v69
  v_add_u32 v70, 6, v64
  v_lshlrev_b32 v69, 9, v66
  v_lshl_add_u32 v69, v70, 5, v69
  v_lshl_add_u32 v69, v67, 2, v69
  v_add_u32 v115, 65536, v69
  v_lshlrev_b32 v69, 4, v68
  v_lshl_add_u32 v69, v64, 9, v69
  v_add_u32 v114, 60416, v69
  v_mul_u32_u24 v69, 144, v70
  v_lshl_add_u32 v69, v67, 4, v69
  v_add_u32 v115, 65536, v69
  v_and_b32 v71, 1, v116
  v_mul_u32_u24 v69, 2048, v71
  v_lshl_add_u32 v69, v64, 8, v69
  v_lshl_add_u32 v69, v117, 4, v69
  v_add_u32 v112, 57864, v69
  v_mul_u32_u24 v69, 144, v117
  v_lshl_add_u32 v69, v71, 6, v69
  v_lshl_add_u32 v69, v64, 5, v69
  v_add_u32 v113, 65548, v69
  v_and_b32 v71, 1, v1
  v_cmp_eq_u32 s[38:39], 0, v71
  v_cmp_gt_u32 vcc, 8, v65
  s_or_b64 s[28:29], s[38:39], vcc
  v_lshrrev_b32 v72, 1, v67
  v_lshlrev_b32 v72, 2, v72
  v_lshl_add_u32 v72, v70, 4, v72
  s_lshl_b32 s22, s17, 9
  s_add_u32 s22, s22, 9216
  v_lshl_add_u32 v73, v66, 7, v72
  v_add_u32 v73, s22, v73
  s_lshl_b32 s22, s17, 7
  s_add_u32 s22, s22, 7168
  v_add_u32 v74, s22, v72
  v_bfe_u32 v72, v65, 1, 1
  v_lshlrev_b32 v72, 7, v72
  v_lshl_add_u32 v72, v70, 4, v72
  v_bfe_u32 v73, v65, 2, 2
  v_lshl_add_u32 v72, v73, 2, v72
  v_lshrrev_b32 v73, 4, v65
  v_lshl_add_u32 v73, v73, 8, v72
  s_lshl_b32 s22, s17, 9
  s_add_u32 s22, s22, 9216
  v_add_u32 v73, s22, v73
  s_lshr_b32 s22, s17, 1
  s_lshl_b32 s22, s22, 8
  s_and_b32 s34, s17, 1
  s_lshl_b32 s34, s34, 3
  s_add_u32 s22, s22, s34
  s_add_u32 s22, s22, 7168
  v_add_u32 v74, s22, v72
  v_bfe_u32 v72, v65, 1, 1
  v_lshl_add_u32 v72, v64, 1, v72
  v_lshlrev_b32 v72, 4, v72
  v_bfe_u32 v73, v65, 2, 2
  v_lshl_add_u32 v72, v73, 2, v72
  v_lshrrev_b32 v73, 4, v65
  v_lshl_add_u32 v73, v73, 6, v72
  s_lshl_b32 s22, s17, 9
  s_add_u32 s22, s22, 9600
  v_add_u32 v73, s22, v73
  v_lshrrev_b32 v72, 1, v65
  v_lshlrev_b32 v72, 2, v72
  v_lshl_add_u32 v72, v64, 5, v72
  s_lshr_b32 s22, s17, 1
  s_lshl_b32 s22, s22, 8
  s_and_b32 s34, s17, 1
  s_lshl_b32 s34, s34, 4
  s_add_u32 s22, s22, s34
  s_add_u32 s22, s22, 7360
  v_add_u32 v74, s22, v72
  v_lshlrev_b32 v0, 2, v65
  s_and_b32 s22, s17, 31
  s_lshl_b32 s22, s22, 7
  s_add_u32 s22, s22, 21504
  v_add_u32 v0, s22, v0
  v_cndmask_b32 v1, v74, v73, s[38:39]
  s_lshl_b32 s36, s17, 2
  s_add_u32 s36, s36, 17408
  s_mov_b32 s37, 0x3e800000
  v_mov_b32 v64, 0
  v_mov_b32 v65, 0
  v_mov_b32 v66, 0
  v_mov_b32 v67, 0
  v_mov_b32 v68, 0
  v_mov_b32 v69, 0
  v_mov_b32 v70, 0
  v_mov_b32 v71, 0
  v_mov_b32 v72, 0
  v_mov_b32 v73, 0
  v_mov_b32 v74, 0
  v_mov_b32 v75, 0
  v_mov_b32 v76, 0
  v_mov_b32 v77, 0
  v_mov_b32 v78, 0
  v_mov_b32 v79, 0
  v_mov_b32 v80, 0
  v_mov_b32 v81, 0
  v_mov_b32 v82, 0
  v_mov_b32 v83, 0
  v_mov_b32 v84, 0
  v_mov_b32 v85, 0
  v_mov_b32 v86, 0
  v_mov_b32 v87, 0
  v_mov_b32 v88, 0
  v_mov_b32 v89, 0
  v_mov_b32 v90, 0
  v_mov_b32 v91, 0
  v_mov_b32 v92, 0
  v_mov_b32 v93, 0
  v_mov_b32 v94, 0
  v_mov_b32 v95, 0
  v_mov_b32 v96, 0
  v_mov_b32 v97, 0
  v_mov_b32 v98, 0
  v_mov_b32 v99, 0
  v_mov_b32 v100, 0
  v_mov_b32 v101, 0
  v_mov_b32 v102, 0
  v_mov_b32 v103, 0
  v_mov_b32 v104, 0
  v_mov_b32 v105, 0
  v_mov_b32 v106, 0
  v_mov_b32 v107, 0
  v_mov_b32 v108, 0
  v_mov_b32 v109, 0
  v_mov_b32 v110, 0
  v_mov_b32 v111, 0
  v_and_b32 v118, 1, v116
  v_cmp_eq_u32 vcc, 0, v118
  v_mov_b32 v118, 12544
  v_mov_b32 v119, 10496
  v_cndmask_b32 v118, v118, v119, vcc
  v_lshrrev_b32 v116, 1, v116
  v_lshl_add_u32 v118, v116, 9, v118
  v_lshl_add_u32 v117, v117, 4, v118
  s_mov_b32 s57, 28672
  s_mov_b32 s56, 0x42800000
  v_mov_b32 v116, v2
  s_mul_i32 s35, s17, 1835008
  s_add_u32 s35, s35, 42284032
  s_mov_b32 s30, 0
  v_mov_b32 v36, 0
ch_md3:
  buffer_load_dword v37, v36, s[12:15], 0 offen sc1
  s_waitcnt vmcnt(0)
  v_readfirstlane_b32 s22, v37
  s_and_b32 s31, s22, 0xffff
  s_cmp_ge_u32 s31, 32
  s_cbranch_scc1 ch_go3
  s_sleep 2
  s_add_u32 s30, s30, 1
  s_cmp_lt_u32 s30, 50000
  s_cbranch_scc1 ch_md3
  s_branch ch_end
ch_go3:
  s_mov_b32 s31, 0
  s_lshr_b32 s22, s22, 16
  s_cmp_lg_u32 s22, 0
  s_cbranch_scc1 cB_sc3_loop
  s_branch cA_sc3_loop
ch_init4:
  s_mul_i32 s31, s17, 401408
  s_add_u32 s31, s31, 6422528
  s_mul_i32 s22, s17, 28
  s_add_u32 s23, s22, 27
  s_lshr_b32 s22, s22, 6
  s_lshr_b32 s23, s23, 6
  s_sub_u32 s23, s23, s22
  s_lshl_b32 s23, s23, 8
  v_and_b32 v36, s23, v2
  v_med3_u32 v37, v117, 0, 3
  v_lshl_add_u32 v36, v37, 4, v36
  s_lshl_b32 s22, s22, 8
  s_add_u32 s22, s22, 88588288
  s_mov_b32 s30, 0
va_bw_11:
  buffer_load_dwordx4 v[40:43], v36, s[8:11], s22 offen sc1
  s_waitcnt vmcnt(0)
  v_cmp_ne_u64 vcc, s[88:89], v[40:41]
  s_cbranch_vccnz va_bw_11_no
  v_cmp_ne_u64 vcc, s[88:89], v[42:43]
  s_cbranch_vccnz va_bw_11_no
  s_branch va_bw_11_ok
va_bw_11_no:
  s_sleep 2
  s_add_u32 s30, s30, 1
  s_cmp_lt_u32 s30, 50000
  s_cbranch_scc1 va_bw_11
  s_branch cA_abort
va_bw_11_ok:
  s_add_u32 s22, s31, 0
  buffer_load_dwordx4 a[0:3], v2, s[8:11], s22 offen offset:0 sc1
  buffer_load_dwordx4 a[4:7], v2, s[8:11], s22 offen offset:1024 sc1
  buffer_load_dwordx4 a[8:11], v2, s[8:11], s22 offen offset:2048 sc1
  buffer_load_dwordx4 a[12:15], v2, s[8:11], s22 offen offset:3072 sc1
  s_add_u32 s22, s31, 4096
  buffer_load_dwordx4 a[16:19], v2, s[8:11], s22 offen offset:0 sc1
  buffer_load_dwordx4 a[20:23], v2, s[8:11], s22 offen offset:1024 sc1
  buffer_load_dwordx4 a[24:27], v2, s[8:11], s22 offen offset:2048 sc1
  buffer_load_dwordx4 a[28:31], v2, s[8:11], s22 offen offset:3072 sc1
  s_add_u32 s22, s31, 8192
  buffer_load_dwordx4 a[32:35], v2, s[8:11], s22 offen offset:0 sc1
  buffer_load_dwordx4 a[36:39], v2, s[8:11], s22 offen offset:1024 sc1
  buffer_load_dwordx4 a[40:43], v2, s[8:11], s22 offen offset:2048 sc1
  buffer_load_dwordx4 a[44:47], v2, s[8:11], s22 offen offset:3072 sc1
  s_add_u32 s22, s31, 12288
  buffer_load_dwordx4 a[48:51], v2, s[8:11], s22 offen offset:0 sc1
  buffer_load_dwordx4 a[52:55], v2, s[8:11], s22 offen offset:1024 sc1
  buffer_load_dwordx4 a[56:59], v2, s[8:11], s22 offen offset:2048 sc1
  buffer_load_dwordx4 a[60:63], v2, s[8:11], s22 offen offset:3072 sc1
  s_add_u32 s22, s31, 16384
  buffer_load_dwordx4 a[64:67], v2, s[8:11], s22 offen offset:0 sc1
  buffer_load_dwordx4 a[68:71], v2, s[8:11], s22 offen offset:1024 sc1
  buffer_load_dwordx4 a[72:75], v2, s[8:11], s22 offen offset:2048 sc1
  buffer_load_dwordx4 a[76:79], v2, s[8:11], s22 offen offset:3072 sc1
  s_add_u32 s22, s31, 20480
  buffer_load_dwordx4 a[80:83], v2, s[8:11], s22 offen offset:0 sc1
  buffer_load_dwordx4 a[84:87], v2, s[8:11], s22 offen offset:1024 sc1
  buffer_load_dwordx4 a[88:91], v2, s[8:11], s22 offen offset:2048 sc1
  buffer_load_dwordx4 a[92:95], v2, s[8:11], s22 offen offset:3072 sc1
  s_add_u32 s22, s31, 24576
  buffer_load_dwordx4 a[96:99], v2, s[8:11], s22 offen offset:0 sc1
  buffer_load_dwordx4 a[100:103], v2, s[8:11], s22 offen offset:1024 sc1
  buffer_load_dwordx4 a[104:107], v2, s[8:11], s22 offen offset:2048 sc1
  buffer_load_dwordx4 a[108:111], v2, s[8:11], s22 offen offset:3072 sc1
  s_add_u32 s22, s31, 28672
  buffer_load_dwordx4 a[112:115], v2, s[8:11], s22 offen offset:0 sc1
  buffer_load_dwordx4 a[116:119], v2, s[8:11], s22 offen offset:1024 sc1
  buffer_load_dwordx4 a[120:123], v2, s[8:11], s22 offen offset:2048 sc1
  buffer_load_dwordx4 a[124:127], v2, s[8:11], s22 offen offset:3072 sc1
  s_waitcnt vmcnt(24)
  s_add_u32 s22, s31, 32768
  buffer_load_dwordx4 a[128:131], v2, s[8:11], s22 offen offset:0 sc1
  buffer_load_dwordx4 a[132:135], v2, s[8:11], s22 offen offset:1024 sc1
  buffer_load_dwordx4 a[136:139], v2, s[8:11], s22 offen offset:2048 sc1
  buffer_load_dwordx4 a[140:143], v2, s[8:11], s22 offen offset:3072 sc1
  s_add_u32 s22, s31, 36864
  buffer_load_dwordx4 a[144:147], v2, s[8:11], s22 offen offset:0 sc1
  buffer_load_dwordx4 a[148:151], v2, s[8:11], s22 offen offset:1024 sc1
  buffer_load_dwordx4 a[152:155], v2, s[8:11], s22 offen offset:2048 sc1
  buffer_load_dwordx4 a[156:159], v2, s[8:11], s22 offen offset:3072 sc1
  s_add_u32 s22, s31, 40960
  buffer_load_dwordx4 a[160:163], v2, s[8:11], s22 offen offset:0 sc1
  buffer_load_dwordx4 a[164:167], v2, s[8:11], s22 offen offset:1024 sc1
  buffer_load_dwordx4 a[168:171], v2, s[8:11], s22 offen offset:2048 sc1
  buffer_load_dwordx4 a[172:175], v2, s[8:11], s22 offen offset:3072 sc1
  s_add_u32 s22, s31, 45056
  buffer_load_dwordx4 a[176:179], v2, s[8:11], s22 offen offset:0 sc1
  buffer_load_dwordx4 a[180:183], v2, s[8:11], s22 offen offset:1024 sc1
  buffer_load_dwordx4 a[184:187], v2, s[8:11], s22 offen offset:2048 sc1
  buffer_load_dwordx4 a[188:191], v2, s[8:11], s22 offen offset:3072 sc1
  s_add_u32 s22, s31, 49152
  buffer_load_dwordx4 a[192:195], v2, s[8:11], s22 offen offset:0 sc1
  buffer_load_dwordx4 a[196:199], v2, s[8:11], s22 offen offset:1024 sc1
  buffer_load_dwordx4 a[200:203], v2, s[8:11], s22 offen offset:2048 sc1
  buffer_load_dwordx4 a[204:207], v2, s[8:11], s22 offen offset:3072 sc1
  s_add_u32 s22, s31, 53248
  buffer_load_dwordx4 a[208:211], v2, s[8:11], s22 offen offset:0 sc1
  buffer_load_dwordx4 a[212:215], v2, s[8:11], s22 offen offset:1024 sc1
  buffer_load_dwordx4 a[216:219], v2, s[8:11], s22 offen offset:2048 sc1
  buffer_load_dwordx4 a[220:223], v2, s[8:11], s22 offen offset:3072 sc1
  s_add_u32 s22, s31, 57344
  buffer_load_dwordx4 a[224:227], v2, s[8:11], s22 offen offset:0 sc1
  buffer_load_dwordx4 a[228:231], v2, s[8:11], s22 offen offset:1024 sc1
  buffer_load_dwordx4 a[232:235], v2, s[8:11], s22 offen offset:2048 sc1
  buffer_load_dwordx4 a[236:239], v2, s[8:11], s22 offen offset:3072 sc1
  s_add_u32 s22, s31, 61440
  buffer_load_dwordx4 a[240:243], v2, s[8:11], s22 offen offset:0 sc1
  buffer_load_dwordx4 a[244:247], v2, s[8:11], s22 offen offset:1024 sc1
  buffer_load_dwordx4 a[248:251], v2, s[8:11], s22 offen offset:2048 sc1
  buffer_load_dwordx4 a[252:255], v2, s[8:11], s22 offen offset:3072 sc1
  s_waitcnt vmcnt(24)
  s_add_u32 s22, s31, 65536
  buffer_load_dwordx4 v[176:179], v2, s[8:11], s22 offen offset:0 sc1
  buffer_load_dwordx4 v[180:183], v2, s[8:11], s22 offen offset:1024 sc1
  buffer_load_dwordx4 v[184:187], v2, s[8:11], s22 offen offset:2048 sc1
  buffer_load_dwordx4 v[188:191], v2, s[8:11], s22 offen offset:3072 sc1
  s_add_u32 s22, s31, 69632
  buffer_load_dwordx4 v[192:195], v2, s[8:11], s22 offen offset:0 sc1
  buffer_load_dwordx4 v[196:199], v2, s[8:11], s22 offen offset:1024 sc1
  buffer_load_dwordx4 v[200:203], v2, s[8:11], s22 offen offset:2048 sc1
  buffer_load_dwordx4 v[204:207], v2, s[8:11], s22 offen offset:3072 sc1
  s_add_u32 s22, s31, 73728
  buffer_load_dwordx4 v[208:211], v2, s[8:11], s22 offen offset:0 sc1
  buffer_load_dwordx4 v[212:215], v2, s[8:11], s22 offen offset:1024 sc1
  buffer_load_dwordx4 v[216:219], v2, s[8:11], s22 offen offset:2048 sc1
  buffer_load_dwordx4 v[220:223], v2, s[8:11], s22 offen offset:3072 sc1
  s_add_u32 s22, s31, 77824
  buffer_load_dwordx4 v[224:227], v2, s[8:11], s22 offen offset:0 sc1
  buffer_load_dwordx4 v[228:231], v2, s[8:11], s22 offen offset:1024 sc1
  buffer_load_dwordx4 v[232:235], v2, s[8:11], s22 offen offset:2048 sc1
  buffer_load_dwordx4 v[236:239], v2, s[8:11], s22 offen offset:3072 sc1
  s_add_u32 s22, s31, 81920
  buffer_load_dwordx4 v[240:243], v2, s[8:11], s22 offen offset:0 sc1
  buffer_load_dwordx4 v[244:247], v2, s[8:11], s22 offen offset:1024 sc1
  buffer_load_dwordx4 v[248:251], v2, s[8:11], s22 offen offset:2048 sc1
  buffer_load_dwordx4 v[252:255], v2, s[8:11], s22 offen offset:3072 sc1
  s_mul_i32 s22, s17, 28
  s_add_u32 s23, s22, 27
  s_lshr_b32 s22, s22, 6
  s_lshr_b32 s23, s23, 6
  s_sub_u32 s23, s23, s22
  s_lshl_b32 s23, s23, 8
  v_and_b32 v36, s23, v2
  v_med3_u32 v37, v117, 10, 11
  v_lshl_add_u32 v36, v37, 4, v36
  s_lshl_b32 s22, s22, 8
  s_add_u32 s22, s22, 88588288
  s_mov_b32 s30, 0
va_bw_12:
  buffer_load_dwordx4 v[40:43], v36, s[8:11], s22 offen sc1
  s_waitcnt vmcnt(0)
  v_cmp_ne_u64 vcc, s[88:89], v[40:41]
  s_cbranch_vccnz va_bw_12_no
  v_cmp_ne_u64 vcc, s[88:89], v[42:43]
  s_cbranch_vccnz va_bw_12_no
  s_branch va_bw_12_ok
va_bw_12_no:
  s_sleep 2
  s_add_u32 s30, s30, 1
  s_cmp_lt_u32 s30, 50000
  s_cbranch_scc1 va_bw_12
  s_branch cA_abort
va_bw_12_ok:
  s_mov_b32 m0, 16384
  s_add_u32 s22, s31, 272384
  buffer_load_dwordx4 v2, s[8:11], s22 offen offset:0 sc1 lds
  buffer_load_dwordx4 v2, s[8:11], s22 offen offset:1024 sc1 lds
  buffer_load_dwordx4 v2, s[8:11], s22 offen offset:2048 sc1 lds
  buffer_load_dwordx4 v2, s[8:11], s22 offen offset:3072 sc1 lds
  s_mov_b32 m0, 20480
  s_add_u32 s22, s31, 276480
  buffer_load_dwordx4 v2, s[8:11], s22 offen offset:0 sc1 lds
  buffer_load_dwordx4 v2, s[8:11], s22 offen offset:1024 sc1 lds
  buffer_load_dwordx4 v2, s[8:11], s22 offen offset:2048 sc1 lds
  buffer_load_dwordx4 v2, s[8:11], s22 offen offset:3072 sc1 lds
  s_mov_b32 m0, 24576
  s_add_u32 s22, s31, 280576
  buffer_load_dwordx4 v2, s[8:11], s22 offen offset:0 sc1 lds
  buffer_load_dwordx4 v2, s[8:11], s22 offen offset:1024 sc1 lds
  buffer_load_dwordx4 v2, s[8:11], s22 offen offset:2048 sc1 lds
  buffer_load_dwordx4 v2, s[8:11], s22 offen offset:3072 sc1 lds
  s_mov_b32 m0, 28672
  s_add_u32 s22, s31, 284672
  buffer_load_dwordx4 v2, s[8:11], s22 offen offset:0 sc1 lds
  buffer_load_dwordx4 v2, s[8:11], s22 offen offset:1024 sc1 lds
  v_mov_b32 v72, v116
  v_mov_b32 v73, v117
  v_lshrrev_b32 v65, 1, v72
  v_and_b32 v66, 1, v72
  v_add_u32 v67, 0, v65
  v_lshl_add_u32 v67, v67, 4, v73
  v_mul_u32_u24 v68, 2341, v67
  v_lshrrev_b32 v68, 16, v68
  v_mul_u32_u24 v69, 28, v68
  v_sub_u32 v69, v67, v69
  v_lshrrev_b32 v70, 4, v69
  v_and_b32 v69, 15, v69
  v_and_b32 v71, 1, v69
  v_lshrrev_b32 v69, 1, v69
  v_lshl_add_u32 v69, v71, 3, v69
  v_lshlrev_b32 v71, 12, v70
  v_lshrrev_b32 v70, 1, v68
  v_lshl_add_u32 v71, v70, 9, v71
  v_and_b32 v70, 1, v68
  v_lshl_add_u32 v71, v70, 2, v71
  v_lshl_add_u32 v71, v69, 4, v71
  v_lshl_add_u32 v60, v66, 8, v71
  v_add_u32 v67, 2, v65
  v_lshl_add_u32 v67, v67, 4, v73
  v_mul_u32_u24 v68, 2341, v67
  v_lshrrev_b32 v68, 16, v68
  v_mul_u32_u24 v69, 28, v68
  v_sub_u32 v69, v67, v69
  v_lshrrev_b32 v70, 4, v69
  v_and_b32 v69, 15, v69
  v_and_b32 v71, 1, v69
  v_lshrrev_b32 v69, 1, v69
  v_lshl_add_u32 v69, v71, 3, v69
  v_lshlrev_b32 v71, 12, v70
  v_lshrrev_b32 v70, 1, v68
  v_lshl_add_u32 v71, v70, 9, v71
  v_and_b32 v70, 1, v68
  v_lshl_add_u32 v71, v70, 2, v71
  v_lshl_add_u32 v71, v69, 4, v71
  v_lshl_add_u32 v61, v66, 8, v71
  v_add_u32 v67, 4, v65
  v_lshl_add_u32 v67, v67, 4, v73
  v_mul_u32_u24 v68, 2341, v67
  v_lshrrev_b32 v68, 16, v68
  v_mul_u32_u24 v69, 28, v68
  v_sub_u32 v69, v67, v69
  v_lshrrev_b32 v70, 4, v69
  v_and_b32 v69, 15, v69
  v_and_b32 v71, 1, v69
  v_lshrrev_b32 v69, 1, v69
  v_lshl_add_u32 v69, v71, 3, v69
  v_lshlrev_b32 v71, 12, v70
  v_lshrrev_b32 v70, 1, v68
  v_lshl_add_u32 v71, v70, 9, v71
  v_and_b32 v70, 1, v68
  v_lshl_add_u32 v71, v70, 2, v71
  v_lshl_add_u32 v71, v69, 4, v71
  v_lshl_add_u32 v62, v66, 8, v71
  v_and_b32 v0, 31, v1
  v_lshlrev_b32 v0, 2, v0
  v_add_u32 v0, 21504, v0
  v_lshlrev_b32 v4, 2, v73
  s_and_b32 s22, s17, 15
  s_lshl_b32 s22, s22, 7
  s_add_u32 s22, s22, 17408
  v_add_u32 v4, s22, v4
  v_and_b32 v64, 7, v73
  v_lshlrev_b32 v5, 4, v64
  v_lshl_add_u32 v5, v72, 7, v5
  v_lshrrev_b32 v65, 3, v73
  v_lshl_add_u32 v5, v65, 9, v5
  s_lshl_b32 s22, s17, 3
  s_add_u32 s22, s22, 21504
  v_lshl_add_u32 v7, v2, 3, s22
  v_add_u32 v65, 0, v73
  v_min_u32 v65, 27, v65
  v_mad_u32_u24 v65, v72, 28, v65
  v_lshlrev_b32 v6, 4, v65
  s_lshr_b32 s22, s17, 1
  s_mul_i32 s22, s22, 7
  s_and_b32 s34, s17, 1
  s_lshl_b32 s35, s34, 2
  v_add_u32 v70, s35, v72
  v_mov_b32 v71, s34
  v_mov_b32 v69, 0
  v_cmp_eq_u32 vcc, 3, v72
  s_nop 1
  v_cndmask_b32 v70, v70, v72, vcc
  v_cndmask_b32 v69, v69, v71, vcc
  v_add_u32 v70, s22, v70
  v_lshrrev_b32 v68, 1, v70
  v_lshlrev_b32 v68, 8, v68
  v_lshl_add_u32 v68, v69, 7, v68
  v_and_b32 v69, 1, v70
  v_lshl_add_u32 v68, v69, 3, v68
  v_lshl_add_u32 v1, v64, 4, v68
  v_cmp_gt_u32 s[26:27], 8, v73
  v_lshrrev_b32 v65, 3, v73
  v_lshl_add_u32 v66, v64, 1, v65
  v_add_u32 v66, 0, v66
  v_min_u32 v66, 27, v66
  v_mad_u32_u24 v66, v72, 28, v66
  v_lshlrev_b32 v6, 4, v66
  s_mul_i32 s22, s17, 28
  s_add_u32 s22, s22, 0
  v_lshl_add_u32 v70, v64, 1, s22
  v_lshrrev_b32 v68, 4, v70
  v_lshlrev_b32 v68, 8, v68
  v_bfe_u32 v69, v70, 1, 1
  v_lshl_add_u32 v68, v69, 7, v68
  v_bfe_u32 v69, v70, 2, 2
  v_lshl_add_u32 v68, v69, 2, v68
  v_and_b32 v69, 1, v72
  v_lshl_add_u32 v65, v69, 2, v65
  v_lshrrev_b32 v69, 1, v72
  v_lshl_add_u32 v65, v69, 1, v65
  v_lshrrev_b32 v65, 3, v73
  v_lshl_add_u32 v65, v72, 1, v65
  v_lshrrev_b32 v5, 1, v72
  v_lshlrev_b32 v5, 9, v5
  v_lshrrev_b32 v69, 2, v73
  v_lshl_add_u32 v5, v69, 7, v5
  v_and_b32 v69, 1, v72
  v_lshl_add_u32 v5, v69, 6, v5
  v_and_b32 v69, 3, v73
  v_lshl_add_u32 v5, v69, 4, v5
  v_and_b32 v69, 1, v73
  v_mul_u32_u24 v69, 0xaaaa, v69
  v_add_u32 v0, 0x4444, v69
  v_lshl_add_u32 v1, v65, 4, v68
  v_cmp_gt_u32 s[26:27], 6, v64
  v_mov_b32 v156, 0
  v_mov_b32 v157, 0
  v_mov_b32 v158, 0
  v_mov_b32 v159, 0
  ds_write_b128 v2, v[156:159] offset:0
  ds_write_b128 v2, v[156:159] offset:1024
  ds_write_b128 v2, v[156:159] offset:2048
  ds_write_b128 v2, v[156:159] offset:3072
  s_mul_i32 s22, s17, 1835008
  s_add_u32 s25, s22, 42205184
  s_lshl_b32 s35, s17, 7
  s_add_u32 s35, s35, 88526848
  s_mov_b32 s38, 0
  v_mov_b32 v63, 0
  s_lshl_b32 s22, 0, 11
  s_add_u32 s22, s22, 88590336
  v_add_u32 v36, 1024, v2
  v_min_u32 v36, 1776, v36
  s_mov_b32 s30, 0
va_iw4:
  buffer_load_dwordx4 v[40:43], v2, s[8:11], s22 offen sc1
  buffer_load_dwordx4 v[44:47], v36, s[8:11], s22 offen sc1
  s_waitcnt vmcnt(0)
  v_cmp_ne_u64 vcc, s[88:89], v[40:41]
  s_cbranch_vccnz va_iw4_no
  v_cmp_ne_u64 vcc, s[88:89], v[42:43]
  s_cbranch_vccnz va_iw4_no
  v_cmp_ne_u64 vcc, s[88:89], v[44:45]
  s_cbranch_vccnz va_iw4_no
  v_cmp_ne_u64 vcc, s[88:89], v[46:47]
  s_cbranch_vccnz va_iw4_no
  s_branch va_iw4_ok
va_iw4_no:
  s_sleep 2
  s_add_u32 s30, s30, 1
  s_cmp_lt_u32 s30, 50000
  s_cbranch_scc1 va_iw4
  s_branch cA_abort
va_iw4_ok:
  s_mov_b32 s30, 0
  v_mov_b32 v36, 0
ch_md4:
  buffer_load_dword v37, v36, s[12:15], 0 offen sc1
  s_waitcnt vmcnt(0)
  v_readfirstlane_b32 s22, v37
  s_and_b32 s31, s22, 0xffff
  s_cmp_ge_u32 s31, 32
  s_cbranch_scc1 ch_go4
  s_sleep 2
  s_add_u32 s30, s30, 1
  s_cmp_lt_u32 s30, 50000
  s_cbranch_scc1 ch_md4
  s_branch ch_end
ch_go4:
  s_mov_b32 s31, 0
  v_mov_b32 v36, 0
  v_mov_b32 v37, 0
  v_mov_b32 v38, 0
  v_mov_b32 v39, 0
  v_mov_b32 v40, 0
  v_mov_b32 v41, 0
  v_mov_b32 v42, 0
  v_mov_b32 v43, 0
  v_mov_b32 v44, 0
  v_mov_b32 v45, 0
  v_mov_b32 v46, 0
  v_mov_b32 v47, 0
  v_mov_b32 v48, 0
  v_mov_b32 v49, 0
  v_mov_b32 v50, 0
  v_mov_b32 v51, 0
  v_mov_b32 v52, 0
  v_mov_b32 v53, 0
  v_mov_b32 v54, 0
  v_mov_b32 v55, 0
  v_mov_b32 v56, 0
  v_mov_b32 v57, 0
  v_mov_b32 v58, 0
  v_mov_b32 v59, 0
  s_lshr_b32 s22, s22, 16
  s_cmp_lg_u32 s22, 0
  s_cbranch_scc1 cB_va0_loop
  s_branch cA_va0_loop
ch_init5:
  s_mul_i32 s31, s17, 401408
  s_add_u32 s31, s31, 6422528
  s_mul_i32 s22, s17, 28
  s_add_u32 s23, s22, 27
  s_lshr_b32 s22, s22, 6
  s_lshr_b32 s23, s23, 6
  s_sub_u32 s23, s23, s22
  s_lshl_b32 s23, s23, 8
  v_and_b32 v36, s23, v2
  v_med3_u32 v37, v117, 3, 6
  v_lshl_add_u32 v36, v37, 4, v36
  s_lshl_b32 s22, s22, 8
  s_add_u32 s22, s22, 88588288
  s_mov_b32 s30, 0
va_bw_13:
  buffer_load_dwordx4 v[40:43], v36, s[8:11], s22 offen sc1
  s_waitcnt vmcnt(0)
  v_cmp_ne_u64 vcc, s[88:89], v[40:41]
  s_cbranch_vccnz va_bw_13_no
  v_cmp_ne_u64 vcc, s[88:89], v[42:43]
  s_cbranch_vccnz va_bw_13_no
  s_branch va_bw_13_ok
va_bw_13_no:
  s_sleep 2
  s_add_u32 s30, s30, 1
  s_cmp_lt_u32 s30, 50000
  s_cbranch_scc1 va_bw_13
  s_branch cA_abort
va_bw_13_ok:
  s_add_u32 s22, s31, 86016
  buffer_load_dwordx4 a[0:3], v2, s[8:11], s22 offen offset:0 sc1
  buffer_load_dwordx4 a[4:7], v2, s[8:11], s22 offen offset:1024 sc1
  buffer_load_dwordx4 a[8:11], v2, s[8:11], s22 offen offset:2048 sc1
  buffer_load_dwordx4 a[12:15], v2, s[8:11], s22 offen offset:3072 sc1
  s_add_u32 s22, s31, 90112
  buffer_load_dwordx4 a[16:19], v2, s[8:11], s22 offen offset:0 sc1
  buffer_load_dwordx4 a[20:23], v2, s[8:11], s22 offen offset:1024 sc1
  buffer_load_dwordx4 a[24:27], v2, s[8:11], s22 offen offset:2048 sc1
  buffer_load_dwordx4 a[28:31], v2, s[8:11], s22 offen offset:3072 sc1
  s_add_u32 s22, s31, 94208
  buffer_load_dwordx4 a[32:35], v2, s[8:11], s22 offen offset:0 sc1
  buffer_load_dwordx4 a[36:39], v2, s[8:11], s22 offen offset:1024 sc1
  buffer_load_dwordx4 a[40:43], v2, s[8:11], s22 offen offset:2048 sc1
  buffer_load_dwordx4 a[44:47], v2, s[8:11], s22 offen offset:3072 sc1
  s_add_u32 s22, s31, 98304
  buffer_load_dwordx4 a[48:51], v2, s[8:11], s22 offen offset:0 sc1
  buffer_load_dwordx4 a[52:55], v2, s[8:11], s22 offen offset:1024 sc1
  buffer_load_dwordx4 a[56:59], v2, s[8:11], s22 offen offset:2048 sc1
  buffer_load_dwordx4 a[60:63], v2, s[8:11], s22 offen offset:3072 sc1
  s_add_u32 s22, s31, 102400
  buffer_load_dwordx4 a[64:67], v2, s[8:11], s22 offen offset:0 sc1
  buffer_load_dwordx4 a[68:71], v2, s[8:11], s22 offen offset:1024 sc1
  buffer_load_dwordx4 a[72:75], v2, s[8:11], s22 offen offset:2048 sc1
  buffer_load_dwordx4 a[76:79], v2, s[8:11], s22 offen offset:3072 sc1
  s_add_u32 s22, s31, 106496
  buffer_load_dwordx4 a[80:83], v2, s[8:11], s22 offen offset:0 sc1
  buffer_load_dwordx4 a[84:87], v2, s[8:11], s22 offen offset:1024 sc1
  buffer_load_dwordx4 a[88:91], v2, s[8:11], s22 offen offset:2048 sc1
  buffer_load_dwordx4 a[92:95], v2, s[8:11], s22 offen offset:3072 sc1
  s_add_u32 s22, s31, 110592
  buffer_load_dwordx4 a[96:99], v2, s[8:11], s22 offen offset:0 sc1
  buffer_load_dwordx4 a[100:103], v2, s[8:11], s22 offen offset:1024 sc1
  buffer_load_dwordx4 a[104:107], v2, s[8:11], s22 offen offset:2048 sc1
  buffer_load_dwordx4 a[108:111], v2, s[8:11], s22 offen offset:3072 sc1
  s_add_u32 s22, s31, 114688
  buffer_load_dwordx4 a[112:115], v2, s[8:11], s22 offen offset:0 sc1
  buffer_load_dwordx4 a[116:119], v2, s[8:11], s22 offen offset:1024 sc1
  buffer_load_dwordx4 a[120:123], v2, s[8:11], s22 offen offset:2048 sc1
  buffer_load_dwordx4 a[124:127], v2, s[8:11], s22 offen offset:3072 sc1
  s_waitcnt vmcnt(24)
  s_add_u32 s22, s31, 118784
  buffer_load_dwordx4 a[128:131], v2, s[8:11], s22 offen offset:0 sc1
  buffer_load_dwordx4 a[132:135], v2, s[8:11], s22 offen offset:1024 sc1
  buffer_load_dwordx4 a[136:139], v2, s[8:11], s22 offen offset:2048 sc1
  buffer_load_dwordx4 a[140:143], v2, s[8:11], s22 offen offset:3072 sc1
  s_add_u32 s22, s31, 122880
  buffer_load_dwordx4 a[144:147], v2, s[8:11], s22 offen offset:0 sc1
  buffer_load_dwordx4 a[148:151], v2, s[8:11], s22 offen offset:1024 sc1
  buffer_load_dwordx4 a[152:155], v2, s[8:11], s22 offen offset:2048 sc1
  buffer_load_dwordx4 a[156:159], v2, s[8:11], s22 offen offset:3072 sc1
  s_add_u32 s22, s31, 126976
  buffer_load_dwordx4 a[160:163], v2, s[8:11], s22 offen offset:0 sc1
  buffer_load_dwordx4 a[164:167], v2, s[8:11], s22 offen offset:1024 sc1
  buffer_load_dwordx4 a[168:171], v2, s[8:11], s22 offen offset:2048 sc1
  buffer_load_dwordx4 a[172:175], v2, s[8:11], s22 offen offset:3072 sc1
  s_add_u32 s22, s31, 131072
  buffer_load_dwordx4 a[176:179], v2, s[8:11], s22 offen offset:0 sc1
  buffer_load_dwordx4 a[180:183], v2, s[8:11], s22 offen offset:1024 sc1
  buffer_load_dwordx4 a[184:187], v2, s[8:11], s22 offen offset:2048 sc1
  buffer_load_dwordx4 a[188:191], v2, s[8:11], s22 offen offset:3072 sc1
  s_add_u32 s22, s31, 135168
  buffer_load_dwordx4 a[192:195], v2, s[8:11], s22 offen offset:0 sc1
  buffer_load_dwordx4 a[196:199], v2, s[8:11], s22 offen offset:1024 sc1
  buffer_load_dwordx4 a[200:203], v2, s[8:11], s22 offen offset:2048 sc1
  buffer_load_dwordx4 a[204:207], v2, s[8:11], s22 offen offset:3072 sc1
  s_add_u32 s22, s31, 139264
  buffer_load_dwordx4 a[208:211], v2, s[8:11], s22 offen offset:0 sc1
  buffer_load_dwordx4 a[212:215], v2, s[8:11], s22 offen offset:1024 sc1
  buffer_load_dwordx4 a[216:219], v2, s[8:11], s22 offen offset:2048 sc1
  buffer_load_dwordx4 a[220:223], v2, s[8:11], s22 offen offset:3072 sc1
  s_add_u32 s22, s31, 143360
  buffer_load_dwordx4 a[224:227], v2, s[8:11], s22 offen offset:0 sc1
  buffer_load_dwordx4 a[228:231], v2, s[8:11], s22 offen offset:1024 sc1
  buffer_load_dwordx4 a[232:235], v2, s[8:11], s22 offen offset:2048 sc1
  buffer_load_dwordx4 a[236:239], v2, s[8:11], s22 offen offset:3072 sc1
  s_add_u32 s22, s31, 147456
  buffer_load_dwordx4 a[240:243], v2, s[8:11], s22 offen offset:0 sc1
  buffer_load_dwordx4 a[244:247], v2, s[8:11], s22 offen offset:1024 sc1
  buffer_load_dwordx4 a[248:251], v2, s[8:11], s22 offen offset:2048 sc1
  buffer_load_dwordx4 a[252:255], v2, s[8:11], s22 offen offset:3072 sc1
  s_waitcnt vmcnt(24)
  s_add_u32 s22, s31, 151552
  buffer_load_dwordx4 v[176:179], v2, s[8:11], s22 offen offset:0 sc1
  buffer_load_dwordx4 v[180:183], v2, s[8:11], s22 offen offset:1024 sc1
  buffer_load_dwordx4 v[184:187], v2, s[8:11], s22 offen offset:2048 sc1
  buffer_load_dwordx4 v[188:191], v2, s[8:11], s22 offen offset:3072 sc1
  s_add_u32 s22, s31, 155648
  buffer_load_dwordx4 v[192:195], v2, s[8:11], s22 offen offset:0 sc1
  buffer_load_dwordx4 v[196:199], v2, s[8:11], s22 offen offset:1024 sc1
  buffer_load_dwordx4 v[200:203], v2, s[8:11], s22 offen offset:2048 sc1
  buffer_load_dwordx4 v[204:207], v2, s[8:11], s22 offen offset:3072 sc1
  s_add_u32 s22, s31, 159744
  buffer_load_dwordx4 v[208:211], v2, s[8:11], s22 offen offset:0 sc1
  buffer_load_dwordx4 v[212:215], v2, s[8:11], s22 offen offset:1024 sc1
  buffer_load_dwordx4 v[216:219], v2, s[8:11], s22 offen offset:2048 sc1
  buffer_load_dwordx4 v[220:223], v2, s[8:11], s22 offen offset:3072 sc1
  s_add_u32 s22, s31, 163840
  buffer_load_dwordx4 v[224:227], v2, s[8:11], s22 offen offset:0 sc1
  buffer_load_dwordx4 v[228:231], v2, s[8:11], s22 offen offset:1024 sc1
  buffer_load_dwordx4 v[232:235], v2, s[8:11], s22 offen offset:2048 sc1
  buffer_load_dwordx4 v[236:239], v2, s[8:11], s22 offen offset:3072 sc1
  s_add_u32 s22, s31, 167936
  buffer_load_dwordx4 v[240:243], v2, s[8:11], s22 offen offset:0 sc1
  buffer_load_dwordx4 v[244:247], v2, s[8:11], s22 offen offset:1024 sc1
  buffer_load_dwordx4 v[248:251], v2, s[8:11], s22 offen offset:2048 sc1
  buffer_load_dwordx4 v[252:255], v2, s[8:11], s22 offen offset:3072 sc1
  s_mul_i32 s22, s17, 28
  s_add_u32 s23, s22, 27
  s_lshr_b32 s22, s22, 6
  s_lshr_b32 s23, s23, 6
  s_sub_u32 s23, s23, s22
  s_lshl_b32 s23, s23, 8
  v_and_b32 v36, s23, v2
  v_med3_u32 v37, v117, 15, 15
  v_lshl_add_u32 v36, v37, 4, v36
  s_lshl_b32 s22, s22, 8
  s_add_u32 s22, s22, 88588288
  s_mov_b32 s30, 0
va_bw_14:
  buffer_load_dwordx4 v[40:43], v36, s[8:11], s22 offen sc1
  s_waitcnt vmcnt(0)
  v_cmp_ne_u64 vcc, s[88:89], v[40:41]
  s_cbranch_vccnz va_bw_14_no
  v_cmp_ne_u64 vcc, s[88:89], v[42:43]
  s_cbranch_vccnz va_bw_14_no
  s_branch va_bw_14_ok
va_bw_14_no:
  s_sleep 2
  s_add_u32 s30, s30, 1
  s_cmp_lt_u32 s30, 50000
  s_cbranch_scc1 va_bw_14
  s_branch cA_abort
va_bw_14_ok:
  s_mov_b32 m0, 59392
  s_add_u32 s22, s31, 387072
  buffer_load_dwordx4 v2, s[8:11], s22 offen offset:0 sc1 lds
  buffer_load_dwordx4 v2, s[8:11], s22 offen offset:1024 sc1 lds
  buffer_load_dwordx4 v2, s[8:11], s22 offen offset:2048 sc1 lds
  buffer_load_dwordx4 v2, s[8:11], s22 offen offset:3072 sc1 lds
  s_mov_b32 m0, 63488
  s_add_u32 s22, s31, 391168
  buffer_load_dwordx4 v2, s[8:11], s22 offen offset:0 sc1 lds
  buffer_load_dwordx4 v2, s[8:11], s22 offen offset:1024 sc1 lds
  buffer_load_dwordx4 v2, s[8:11], s22 offen offset:2048 sc1 lds
  buffer_load_dwordx4 v2, s[8:11], s22 offen offset:3072 sc1 lds
  s_mov_b32 m0, 67584
  s_add_u32 s22, s31, 395264
  buffer_load_dwordx4 v2, s[8:11], s22 offen offset:0 sc1 lds
  buffer_load_dwordx4 v2, s[8:11], s22 offen offset:1024 sc1 lds
  buffer_load_dwordx4 v2, s[8:11], s22 offen offset:2048 sc1 lds
  buffer_load_dwordx4 v2, s[8:11], s22 offen offset:3072 sc1 lds
  s_mov_b32 m0, 71680
  s_add_u32 s22, s31, 399360
  buffer_load_dwordx4 v2, s[8:11], s22 offen offset:0 sc1 lds
  buffer_load_dwordx4 v2, s[8:11], s22 offen offset:1024 sc1 lds
  v_mov_b32 v72, v116
  v_mov_b32 v73, v117
  v_lshrrev_b32 v65, 1, v72
  v_and_b32 v66, 1, v72
  v_add_u32 v67, 6, v65
  v_lshl_add_u32 v67, v67, 4, v73
  v_mul_u32_u24 v68, 2341, v67
  v_lshrrev_b32 v68, 16, v68
  v_mul_u32_u24 v69, 28, v68
  v_sub_u32 v69, v67, v69
  v_lshrrev_b32 v70, 4, v69
  v_and_b32 v69, 15, v69
  v_and_b32 v71, 1, v69
  v_lshrrev_b32 v69, 1, v69
  v_lshl_add_u32 v69, v71, 3, v69
  v_lshlrev_b32 v71, 12, v70
  v_lshrrev_b32 v70, 1, v68
  v_lshl_add_u32 v71, v70, 9, v71
  v_and_b32 v70, 1, v68
  v_lshl_add_u32 v71, v70, 2, v71
  v_lshl_add_u32 v71, v69, 4, v71
  v_lshl_add_u32 v60, v66, 8, v71
  v_add_u32 v67, 8, v65
  v_lshl_add_u32 v67, v67, 4, v73
  v_mul_u32_u24 v68, 2341, v67
  v_lshrrev_b32 v68, 16, v68
  v_mul_u32_u24 v69, 28, v68
  v_sub_u32 v69, v67, v69
  v_lshrrev_b32 v70, 4, v69
  v_and_b32 v69, 15, v69
  v_and_b32 v71, 1, v69
  v_lshrrev_b32 v69, 1, v69
  v_lshl_add_u32 v69, v71, 3, v69
  v_lshlrev_b32 v71, 12, v70
  v_lshrrev_b32 v70, 1, v68
  v_lshl_add_u32 v71, v70, 9, v71
  v_and_b32 v70, 1, v68
  v_lshl_add_u32 v71, v70, 2, v71
  v_lshl_add_u32 v71, v69, 4, v71
  v_lshl_add_u32 v61, v66, 8, v71
  v_add_u32 v67, 10, v65
  v_lshl_add_u32 v67, v67, 4, v73
  v_mul_u32_u24 v68, 2341, v67
  v_lshrrev_b32 v68, 16, v68
  v_mul_u32_u24 v69, 28, v68
  v_sub_u32 v69, v67, v69
  v_lshrrev_b32 v70, 4, v69
  v_and_b32 v69, 15, v69
  v_and_b32 v71, 1, v69
  v_lshrrev_b32 v69, 1, v69
  v_lshl_add_u32 v69, v71, 3, v69
  v_lshlrev_b32 v71, 12, v70
  v_lshrrev_b32 v70, 1, v68
  v_lshl_add_u32 v71, v70, 9, v71
  v_and_b32 v70, 1, v68
  v_lshl_add_u32 v71, v70, 2, v71
  v_lshl_add_u32 v71, v69, 4, v71
  v_lshl_add_u32 v62, v66, 8, v71
  v_and_b32 v0, 31, v1
  v_lshlrev_b32 v0, 2, v0
  v_add_u32 v0, 21504, v0
  v_lshlrev_b32 v4, 2, v73
  s_and_b32 s22, s17, 15
  s_lshl_b32 s22, s22, 7
  s_add_u32 s22, s22, 17408
  v_add_u32 v4, s22, v4
  v_and_b32 v64, 7, v73
  v_lshlrev_b32 v5, 4, v64
  v_lshl_add_u32 v5, v72, 7, v5
  v_lshrrev_b32 v65, 3, v73
  v_lshl_add_u32 v5, v65, 9, v5
  s_lshl_b32 s22, s17, 3
  s_add_u32 s22, s22, 21508
  v_lshl_add_u32 v7, v2, 3, s22
  v_add_u32 v65, 16, v73
  v_min_u32 v65, 27, v65
  v_mad_u32_u24 v65, v72, 28, v65
  v_lshlrev_b32 v6, 4, v65
  s_lshr_b32 s22, s17, 1
  s_mul_i32 s22, s22, 7
  s_and_b32 s34, s17, 1
  s_lshl_b32 s35, s34, 2
  v_add_u32 v70, s35, v72
  v_mov_b32 v71, s34
  v_mov_b32 v69, 1
  v_cmp_eq_u32 vcc, 3, v72
  s_nop 1
  v_cndmask_b32 v70, v70, v72, vcc
  v_cndmask_b32 v69, v69, v71, vcc
  v_add_u32 v70, s22, v70
  v_lshrrev_b32 v68, 1, v70
  v_lshlrev_b32 v68, 8, v68
  v_lshl_add_u32 v68, v69, 7, v68
  v_and_b32 v69, 1, v70
  v_lshl_add_u32 v68, v69, 3, v68
  v_lshl_add_u32 v1, v64, 4, v68
  v_cmp_gt_u32 s[26:27], 8, v73
  v_cmp_gt_u32 vcc, 3, v72
  s_and_b64 s[26:27], s[26:27], vcc
  v_lshrrev_b32 v65, 3, v73
  v_lshl_add_u32 v66, v64, 1, v65
  v_add_u32 v66, 16, v66
  v_min_u32 v66, 27, v66
  v_mad_u32_u24 v66, v72, 28, v66
  v_lshlrev_b32 v6, 4, v66
  s_mul_i32 s22, s17, 28
  s_add_u32 s22, s22, 16
  v_lshl_add_u32 v70, v64, 1, s22
  v_lshrrev_b32 v68, 4, v70
  v_lshlrev_b32 v68, 8, v68
  v_bfe_u32 v69, v70, 1, 1
  v_lshl_add_u32 v68, v69, 7, v68
  v_bfe_u32 v69, v70, 2, 2
  v_lshl_add_u32 v68, v69, 2, v68
  v_and_b32 v69, 1, v72
  v_lshl_add_u32 v65, v69, 2, v65
  v_lshrrev_b32 v69, 1, v72
  v_lshl_add_u32 v65, v69, 1, v65
  v_lshrrev_b32 v65, 3, v73
  v_lshl_add_u32 v65, v72, 1, v65
  v_lshrrev_b32 v5, 1, v72
  v_lshlrev_b32 v5, 9, v5
  v_lshrrev_b32 v69, 2, v73
  v_lshl_add_u32 v5, v69, 7, v5
  v_and_b32 v69, 1, v72
  v_lshl_add_u32 v5, v69, 6, v5
  v_and_b32 v69, 3, v73
  v_lshl_add_u32 v5, v69, 4, v5
  v_and_b32 v69, 1, v73
  v_mul_u32_u24 v69, 0xaaaa, v69
  v_add_u32 v0, 0x4444, v69
  v_lshl_add_u32 v1, v65, 4, v68
  v_cmp_gt_u32 s[26:27], 6, v64
  v_mov_b32 v156, 0
  v_mov_b32 v157, 0
  v_mov_b32 v158, 0
  v_mov_b32 v159, 0
  ds_write_b128 v2, v[156:159] offset:4096
  ds_write_b128 v2, v[156:159] offset:5120
  ds_write_b128 v2, v[156:159] offset:6144
  ds_write_b128 v2, v[156:159] offset:7168
  s_mul_i32 s22, s17, 1835008
  s_add_u32 s25, s22, 42205184
  s_lshl_b32 s35, s17, 7
  s_add_u32 s35, s35, 88526848
  s_mov_b32 s38, 0
  v_mov_b32 v63, 0
  s_lshl_b32 s22, 0, 11
  s_add_u32 s22, s22, 88590336
  v_add_u32 v36, 1024, v2
  v_min_u32 v36, 1776, v36
  s_mov_b32 s30, 0
va_iw5:
  buffer_load_dwordx4 v[40:43], v2, s[8:11], s22 offen sc1
  buffer_load_dwordx4 v[44:47], v36, s[8:11], s22 offen sc1
  s_waitcnt vmcnt(0)
  v_cmp_ne_u64 vcc, s[88:89], v[40:41]
  s_cbranch_vccnz va_iw5_no
  v_cmp_ne_u64 vcc, s[88:89], v[42:43]
  s_cbranch_vccnz va_iw5_no
  v_cmp_ne_u64 vcc, s[88:89], v[44:45]
  s_cbranch_vccnz va_iw5_no
  v_cmp_ne_u64 vcc, s[88:89], v[46:47]
  s_cbranch_vccnz va_iw5_no
  s_branch va_iw5_ok
va_iw5_no:
  s_sleep 2
  s_add_u32 s30, s30, 1
  s_cmp_lt_u32 s30, 50000
  s_cbranch_scc1 va_iw5
  s_branch cA_abort
va_iw5_ok:
  s_mov_b32 s30, 0
  v_mov_b32 v36, 0
ch_md5:
  buffer_load_dword v37, v36, s[12:15], 0 offen sc1
  s_waitcnt vmcnt(0)
  v_readfirstlane_b32 s22, v37
  s_and_b32 s31, s22, 0xffff
  s_cmp_ge_u32 s31, 32
  s_cbranch_scc1 ch_go5
  s_sleep 2
  s_add_u32 s30, s30, 1
  s_cmp_lt_u32 s30, 50000
  s_cbranch_scc1 ch_md5
  s_branch ch_end
ch_go5:
  s_mov_b32 s31, 0
  v_mov_b32 v36, 0
  v_mov_b32 v37, 0
  v_mov_b32 v38, 0
  v_mov_b32 v39, 0
  v_mov_b32 v40, 0
  v_mov_b32 v41, 0
  v_mov_b32 v42, 0
  v_mov_b32 v43, 0
  v_mov_b32 v44, 0
  v_mov_b32 v45, 0
  v_mov_b32 v46, 0
  v_mov_b32 v47, 0
  v_mov_b32 v48, 0
  v_mov_b32 v49, 0
  v_mov_b32 v50, 0
  v_mov_b32 v51, 0
  v_mov_b32 v52, 0
  v_mov_b32 v53, 0
  v_mov_b32 v54, 0
  v_mov_b32 v55, 0
  v_mov_b32 v56, 0
  v_mov_b32 v57, 0
  v_mov_b32 v58, 0
  v_mov_b32 v59, 0
  s_lshr_b32 s22, s22, 16
  s_cmp_lg_u32 s22, 0
  s_cbranch_scc1 cB_va1_loop
  s_branch cA_va1_loop
ch_init6:
  s_mul_i32 s31, s17, 401408
  s_add_u32 s31, s31, 6422528
  s_mul_i32 s22, s17, 28
  s_add_u32 s23, s22, 27
  s_lshr_b32 s22, s22, 6
  s_lshr_b32 s23, s23, 6
  s_sub_u32 s23, s23, s22
  s_lshl_b32 s23, s23, 8
  v_and_b32 v36, s23, v2
  v_med3_u32 v37, v117, 6, 10
  v_lshl_add_u32 v36, v37, 4, v36
  s_lshl_b32 s22, s22, 8
  s_add_u32 s22, s22, 88588288
  s_mov_b32 s30, 0
va_bw_15:
  buffer_load_dwordx4 v[40:43], v36, s[8:11], s22 offen sc1
  s_waitcnt vmcnt(0)
  v_cmp_ne_u64 vcc, s[88:89], v[40:41]
  s_cbranch_vccnz va_bw_15_no
  v_cmp_ne_u64 vcc, s[88:89], v[42:43]
  s_cbranch_vccnz va_bw_15_no
  s_branch va_bw_15_ok
va_bw_15_no:
  s_sleep 2
  s_add_u32 s30, s30, 1
  s_cmp_lt_u32 s30, 50000
  s_cbranch_scc1 va_bw_15
  s_branch cA_abort
va_bw_15_ok:
  s_add_u32 s22, s31, 172032
  buffer_load_dwordx4 a[0:3], v2, s[8:11], s22 offen offset:0 sc1
  buffer_load_dwordx4 a[4:7], v2, s[8:11], s22 offen offset:1024 sc1
  buffer_load_dwordx4 a[8:11], v2, s[8:11], s22 offen offset:2048 sc1
  buffer_load_dwordx4 a[12:15], v2, s[8:11], s22 offen offset:3072 sc1
  s_add_u32 s22, s31, 176128
  buffer_load_dwordx4 a[16:19], v2, s[8:11], s22 offen offset:0 sc1
  buffer_load_dwordx4 a[20:23], v2, s[8:11], s22 offen offset:1024 sc1
  buffer_load_dwordx4 a[24:27], v2, s[8:11], s22 offen offset:2048 sc1
  buffer_load_dwordx4 a[28:31], v2, s[8:11], s22 offen offset:3072 sc1
  s_add_u32 s22, s31, 180224
  buffer_load_dwordx4 a[32:35], v2, s[8:11], s22 offen offset:0 sc1
  buffer_load_dwordx4 a[36:39], v2, s[8:11], s22 offen offset:1024 sc1
  buffer_load_dwordx4 a[40:43], v2, s[8:11], s22 offen offset:2048 sc1
  buffer_load_dwordx4 a[44:47], v2, s[8:11], s22 offen offset:3072 sc1
  s_add_u32 s22, s31, 184320
  buffer_load_dwordx4 a[48:51], v2, s[8:11], s22 offen offset:0 sc1
  buffer_load_dwordx4 a[52:55], v2, s[8:11], s22 offen offset:1024 sc1
  buffer_load_dwordx4 a[56:59], v2, s[8:11], s22 offen offset:2048 sc1
  buffer_load_dwordx4 a[60:63], v2, s[8:11], s22 offen offset:3072 sc1
  s_add_u32 s22, s31, 188416
  buffer_load_dwordx4 a[64:67], v2, s[8:11], s22 offen offset:0 sc1
  buffer_load_dwordx4 a[68:71], v2, s[8:11], s22 offen offset:1024 sc1
  buffer_load_dwordx4 a[72:75], v2, s[8:11], s22 offen offset:2048 sc1
  buffer_load_dwordx4 a[76:79], v2, s[8:11], s22 offen offset:3072 sc1
  s_add_u32 s22, s31, 192512
  buffer_load_dwordx4 a[80:83], v2, s[8:11], s22 offen offset:0 sc1
  buffer_load_dwordx4 a[84:87], v2, s[8:11], s22 offen offset:1024 sc1
  buffer_load_dwordx4 a[88:91], v2, s[8:11], s22 offen offset:2048 sc1
  buffer_load_dwordx4 a[92:95], v2, s[8:11], s22 offen offset:3072 sc1
  s_add_u32 s22, s31, 196608
  buffer_load_dwordx4 a[96:99], v2, s[8:11], s22 offen offset:0 sc1
  buffer_load_dwordx4 a[100:103], v2, s[8:11], s22 offen offset:1024 sc1
  buffer_load_dwordx4 a[104:107], v2, s[8:11], s22 offen offset:2048 sc1
  buffer_load_dwordx4 a[108:111], v2, s[8:11], s22 offen offset:3072 sc1
  s_add_u32 s22, s31, 200704
  buffer_load_dwordx4 a[112:115], v2, s[8:11], s22 offen offset:0 sc1
  buffer_load_dwordx4 a[116:119], v2, s[8:11], s22 offen offset:1024 sc1
  buffer_load_dwordx4 a[120:123], v2, s[8:11], s22 offen offset:2048 sc1
  buffer_load_dwordx4 a[124:127], v2, s[8:11], s22 offen offset:3072 sc1
  s_waitcnt vmcnt(24)
  s_add_u32 s22, s31, 204800
  buffer_load_dwordx4 a[128:131], v2, s[8:11], s22 offen offset:0 sc1
  buffer_load_dwordx4 a[132:135], v2, s[8:11], s22 offen offset:1024 sc1
  buffer_load_dwordx4 a[136:139], v2, s[8:11], s22 offen offset:2048 sc1
  buffer_load_dwordx4 a[140:143], v2, s[8:11], s22 offen offset:3072 sc1
  s_add_u32 s22, s31, 208896
  buffer_load_dwordx4 a[144:147], v2, s[8:11], s22 offen offset:0 sc1
  buffer_load_dwordx4 a[148:151], v2, s[8:11], s22 offen offset:1024 sc1
  buffer_load_dwordx4 a[152:155], v2, s[8:11], s22 offen offset:2048 sc1
  buffer_load_dwordx4 a[156:159], v2, s[8:11], s22 offen offset:3072 sc1
  s_add_u32 s22, s31, 212992
  buffer_load_dwordx4 a[160:163], v2, s[8:11], s22 offen offset:0 sc1
  buffer_load_dwordx4 a[164:167], v2, s[8:11], s22 offen offset:1024 sc1
  buffer_load_dwordx4 a[168:171], v2, s[8:11], s22 offen offset:2048 sc1
  buffer_load_dwordx4 a[172:175], v2, s[8:11], s22 offen offset:3072 sc1
  s_add_u32 s22, s31, 217088
  buffer_load_dwordx4 a[176:179], v2, s[8:11], s22 offen offset:0 sc1
  buffer_load_dwordx4 a[180:183], v2, s[8:11], s22 offen offset:1024 sc1
  buffer_load_dwordx4 a[184:187], v2, s[8:11], s22 offen offset:2048 sc1
  buffer_load_dwordx4 a[188:191], v2, s[8:11], s22 offen offset:3072 sc1
  s_add_u32 s22, s31, 221184
  buffer_load_dwordx4 a[192:195], v2, s[8:11], s22 offen offset:0 sc1
  buffer_load_dwordx4 a[196:199], v2, s[8:11], s22 offen offset:1024 sc1
  buffer_load_dwordx4 a[200:203], v2, s[8:11], s22 offen offset:2048 sc1
  buffer_load_dwordx4 a[204:207], v2, s[8:11], s22 offen offset:3072 sc1
  s_add_u32 s22, s31, 225280
  buffer_load_dwordx4 a[208:211], v2, s[8:11], s22 offen offset:0 sc1
  buffer_load_dwordx4 a[212:215], v2, s[8:11], s22 offen offset:1024 sc1
  buffer_load_dwordx4 a[216:219], v2, s[8:11], s22 offen offset:2048 sc1
  buffer_load_dwordx4 a[220:223], v2, s[8:11], s22 offen offset:3072 sc1
  s_add_u32 s22, s31, 229376
  buffer_load_dwordx4 a[224:227], v2, s[8:11], s22 offen offset:0 sc1
  buffer_load_dwordx4 a[228:231], v2, s[8:11], s22 offen offset:1024 sc1
  buffer_load_dwordx4 a[232:235], v2, s[8:11], s22 offen offset:2048 sc1
  buffer_load_dwordx4 a[236:239], v2, s[8:11], s22 offen offset:3072 sc1
  s_add_u32 s22, s31, 233472
  buffer_load_dwordx4 a[240:243], v2, s[8:11], s22 offen offset:0 sc1
  buffer_load_dwordx4 a[244:247], v2, s[8:11], s22 offen offset:1024 sc1
  buffer_load_dwordx4 a[248:251], v2, s[8:11], s22 offen offset:2048 sc1
  buffer_load_dwordx4 a[252:255], v2, s[8:11], s22 offen offset:3072 sc1
  s_waitcnt vmcnt(24)
  s_add_u32 s22, s31, 237568
  buffer_load_dwordx4 v[120:123], v2, s[8:11], s22 offen offset:0 sc1
  buffer_load_dwordx4 v[124:127], v2, s[8:11], s22 offen offset:1024 sc1
  buffer_load_dwordx4 v[128:131], v2, s[8:11], s22 offen offset:2048 sc1
  buffer_load_dwordx4 v[132:135], v2, s[8:11], s22 offen offset:3072 sc1
  s_add_u32 s22, s31, 241664
  buffer_load_dwordx4 v[136:139], v2, s[8:11], s22 offen offset:0 sc1
  buffer_load_dwordx4 v[140:143], v2, s[8:11], s22 offen offset:1024 sc1
  buffer_load_dwordx4 v[144:147], v2, s[8:11], s22 offen offset:2048 sc1
  buffer_load_dwordx4 v[148:151], v2, s[8:11], s22 offen offset:3072 sc1
  s_add_u32 s22, s31, 245760
  buffer_load_dwordx4 v[152:155], v2, s[8:11], s22 offen offset:0 sc1
  buffer_load_dwordx4 v[156:159], v2, s[8:11], s22 offen offset:1024 sc1
  buffer_load_dwordx4 v[160:163], v2, s[8:11], s22 offen offset:2048 sc1
  buffer_load_dwordx4 v[164:167], v2, s[8:11], s22 offen offset:3072 sc1
  s_add_u32 s22, s31, 249856
  buffer_load_dwordx4 v[168:171], v2, s[8:11], s22 offen offset:0 sc1
  buffer_load_dwordx4 v[172:175], v2, s[8:11], s22 offen offset:1024 sc1
  buffer_load_dwordx4 v[176:179], v2, s[8:11], s22 offen offset:2048 sc1
  buffer_load_dwordx4 v[180:183], v2, s[8:11], s22 offen offset:3072 sc1
  s_add_u32 s22, s31, 253952
  buffer_load_dwordx4 v[184:187], v2, s[8:11], s22 offen offset:0 sc1
  buffer_load_dwordx4 v[188:191], v2, s[8:11], s22 offen offset:1024 sc1
  buffer_load_dwordx4 v[192:195], v2, s[8:11], s22 offen offset:2048 sc1
  buffer_load_dwordx4 v[196:199], v2, s[8:11], s22 offen offset:3072 sc1
  s_add_u32 s22, s31, 258048
  buffer_load_dwordx4 v[200:203], v2, s[8:11], s22 offen offset:0 sc1
  buffer_load_dwordx4 v[204:207], v2, s[8:11], s22 offen offset:1024 sc1
  buffer_load_dwordx4 v[208:211], v2, s[8:11], s22 offen offset:2048 sc1
  buffer_load_dwordx4 v[212:215], v2, s[8:11], s22 offen offset:3072 sc1
  s_add_u32 s22, s31, 262144
  buffer_load_dwordx4 v[216:219], v2, s[8:11], s22 offen offset:0 sc1
  buffer_load_dwordx4 v[220:223], v2, s[8:11], s22 offen offset:1024 sc1
  buffer_load_dwordx4 v[224:227], v2, s[8:11], s22 offen offset:2048 sc1
  buffer_load_dwordx4 v[228:231], v2, s[8:11], s22 offen offset:3072 sc1
  s_add_u32 s22, s31, 266240
  buffer_load_dwordx4 v[232:235], v2, s[8:11], s22 offen offset:0 sc1
  buffer_load_dwordx4 v[236:239], v2, s[8:11], s22 offen offset:1024 sc1
  buffer_load_dwordx4 v[240:243], v2, s[8:11], s22 offen offset:2048 sc1
  buffer_load_dwordx4 v[244:247], v2, s[8:11], s22 offen offset:3072 sc1
  s_waitcnt vmcnt(24)
  s_add_u32 s22, s31, 270336
  buffer_load_dwordx4 v[248:251], v2, s[8:11], s22 offen offset:0 sc1
  buffer_load_dwordx4 v[252:255], v2, s[8:11], s22 offen offset:1024 sc1
  v_mov_b32 v72, v116
  v_mov_b32 v73, v117
  v_lshrrev_b32 v65, 1, v72
  v_and_b32 v66, 1, v72
  v_add_u32 v67, 12, v65
  v_lshl_add_u32 v67, v67, 4, v73
  v_mul_u32_u24 v68, 2341, v67
  v_lshrrev_b32 v68, 16, v68
  v_mul_u32_u24 v69, 28, v68
  v_sub_u32 v69, v67, v69
  v_lshrrev_b32 v70, 4, v69
  v_and_b32 v69, 15, v69
  v_and_b32 v71, 1, v69
  v_lshrrev_b32 v69, 1, v69
  v_lshl_add_u32 v69, v71, 3, v69
  v_lshlrev_b32 v71, 12, v70
  v_lshrrev_b32 v70, 1, v68
  v_lshl_add_u32 v71, v70, 9, v71
  v_and_b32 v70, 1, v68
  v_lshl_add_u32 v71, v70, 2, v71
  v_lshl_add_u32 v71, v69, 4, v71
  v_lshl_add_u32 v112, v66, 8, v71
  v_add_u32 v67, 14, v65
  v_lshl_add_u32 v67, v67, 4, v73
  v_mul_u32_u24 v68, 2341, v67
  v_lshrrev_b32 v68, 16, v68
  v_mul_u32_u24 v69, 28, v68
  v_sub_u32 v69, v67, v69
  v_lshrrev_b32 v70, 4, v69
  v_and_b32 v69, 15, v69
  v_and_b32 v71, 1, v69
  v_lshrrev_b32 v69, 1, v69
  v_lshl_add_u32 v69, v71, 3, v69
  v_lshlrev_b32 v71, 12, v70
  v_lshrrev_b32 v70, 1, v68
  v_lshl_add_u32 v71, v70, 9, v71
  v_and_b32 v70, 1, v68
  v_lshl_add_u32 v71, v70, 2, v71
  v_lshl_add_u32 v71, v69, 4, v71
  v_lshl_add_u32 v113, v66, 8, v71
  v_add_u32 v67, 16, v65
  v_lshl_add_u32 v67, v67, 4, v73
  v_mul_u32_u24 v68, 2341, v67
  v_lshrrev_b32 v68, 16, v68
  v_mul_u32_u24 v69, 28, v68
  v_sub_u32 v69, v67, v69
  v_lshrrev_b32 v70, 4, v69
  v_and_b32 v69, 15, v69
  v_and_b32 v71, 1, v69
  v_lshrrev_b32 v69, 1, v69
  v_lshl_add_u32 v69, v71, 3, v69
  v_lshlrev_b32 v71, 12, v70
  v_lshrrev_b32 v70, 1, v68
  v_lshl_add_u32 v71, v70, 9, v71
  v_and_b32 v70, 1, v68
  v_lshl_add_u32 v71, v70, 2, v71
  v_lshl_add_u32 v71, v69, 4, v71
  v_lshl_add_u32 v114, v66, 8, v71
  v_add_u32 v67, 18, v65
  v_lshl_add_u32 v67, v67, 4, v73
  v_mul_u32_u24 v68, 2341, v67
  v_lshrrev_b32 v68, 16, v68
  v_mul_u32_u24 v69, 28, v68
  v_sub_u32 v69, v67, v69
  v_lshrrev_b32 v70, 4, v69
  v_and_b32 v69, 15, v69
  v_and_b32 v71, 1, v69
  v_lshrrev_b32 v69, 1, v69
  v_lshl_add_u32 v69, v71, 3, v69
  v_lshlrev_b32 v71, 12, v70
  v_lshrrev_b32 v70, 1, v68
  v_lshl_add_u32 v71, v70, 9, v71
  v_and_b32 v70, 1, v68
  v_lshl_add_u32 v71, v70, 2, v71
  v_lshl_add_u32 v71, v69, 4, v71
  v_lshl_add_u32 v115, v66, 8, v71
  s_mul_i32 s24, s17, 532480
  s_add_u32 s24, s24, 76926976
  s_mul_i32 s34, s17, 640
  s_add_u32 s34, s34, 88569856
  s_mul_i32 s36, s17, 448
  v_add_u32 v0, s36, v2
  v_add_u32 v0, 8192, v0
  s_add_u32 s36, s36, 88068096
  v_cmp_gt_u32 s[26:27], 28, v1
  v_and_b32 v119, 31, v1
  v_lshlrev_b32 v119, 2, v119
  s_add_u32 s22, s17, 16
  s_and_b32 s22, s22, 31
  s_lshl_b32 s22, s22, 7
  s_add_u32 s22, s22, 21504
  v_add_u32 v119, s22, v119
  v_min_u32 v118, 12, v1
  s_mul_i32 s22, s17, 13
  v_add_u32 v118, s22, v118
  v_lshlrev_b32 v118, 7, v118
  v_add_u32 v118, 51200, v118
  s_mov_b32 s39, 71565312
  v_add_u32 v1, 16384, v2
  v_mov_b32 v117, 1
  s_mul_i32 s38, s17, 1104
  s_add_u32 s38, s38, 25600
  s_lshl_b32 s22, 0, 11
  s_add_u32 s22, s22, 88590336
  v_add_u32 v36, 1024, v2
  v_min_u32 v36, 1776, v36
  s_mov_b32 s30, 0
va_iw6:
  buffer_load_dwordx4 v[40:43], v2, s[8:11], s22 offen sc1
  buffer_load_dwordx4 v[44:47], v36, s[8:11], s22 offen sc1
  s_waitcnt vmcnt(0)
  v_cmp_ne_u64 vcc, s[88:89], v[40:41]
  s_cbranch_vccnz va_iw6_no
  v_cmp_ne_u64 vcc, s[88:89], v[42:43]
  s_cbranch_vccnz va_iw6_no
  v_cmp_ne_u64 vcc, s[88:89], v[44:45]
  s_cbranch_vccnz va_iw6_no
  v_cmp_ne_u64 vcc, s[88:89], v[46:47]
  s_cbranch_vccnz va_iw6_no
  s_branch va_iw6_ok
va_iw6_no:
  s_sleep 2
  s_add_u32 s30, s30, 1
  s_cmp_lt_u32 s30, 50000
  s_cbranch_scc1 va_iw6
  s_branch cA_abort
va_iw6_ok:
  s_mov_b32 s30, 0
  v_mov_b32 v36, 0
ch_md6:
  buffer_load_dword v37, v36, s[12:15], 0 offen sc1
  s_waitcnt vmcnt(0)
  v_readfirstlane_b32 s22, v37
  s_and_b32 s31, s22, 0xffff
  s_cmp_ge_u32 s31, 32
  s_cbranch_scc1 ch_go6
  s_sleep 2
  s_add_u32 s30, s30, 1
  s_cmp_lt_u32 s30, 50000
  s_cbranch_scc1 ch_md6
  s_branch ch_end
ch_go6:
  s_mov_b32 s31, 0
  s_lshr_b32 s22, s22, 16
  s_cmp_lg_u32 s22, 0
  s_cbranch_scc1 cB_va2_loop
  s_branch cA_va2_loop
ch_init7:
  s_mul_i32 s31, s17, 401408
  s_add_u32 s31, s31, 6422528
  s_mul_i32 s22, s17, 28
  s_add_u32 s23, s22, 27
  s_lshr_b32 s22, s22, 6
  s_lshr_b32 s23, s23, 6
  s_sub_u32 s23, s23, s22
  s_lshl_b32 s23, s23, 8
  v_and_b32 v36, s23, v2
  v_med3_u32 v37, v117, 11, 15
  v_lshl_add_u32 v36, v37, 4, v36
  s_lshl_b32 s22, s22, 8
  s_add_u32 s22, s22, 88588288
  s_mov_b32 s30, 0
va_bw_16:
  buffer_load_dwordx4 v[40:43], v36, s[8:11], s22 offen sc1
  s_waitcnt vmcnt(0)
  v_cmp_ne_u64 vcc, s[88:89], v[40:41]
  s_cbranch_vccnz va_bw_16_no
  v_cmp_ne_u64 vcc, s[88:89], v[42:43]
  s_cbranch_vccnz va_bw_16_no
  s_branch va_bw_16_ok
va_bw_16_no:
  s_sleep 2
  s_add_u32 s30, s30, 1
  s_cmp_lt_u32 s30, 50000
  s_cbranch_scc1 va_bw_16
  s_branch cA_abort
va_bw_16_ok:
  s_add_u32 s22, s31, 286720
  buffer_load_dwordx4 a[0:3], v2, s[8:11], s22 offen offset:0 sc1
  buffer_load_dwordx4 a[4:7], v2, s[8:11], s22 offen offset:1024 sc1
  buffer_load_dwordx4 a[8:11], v2, s[8:11], s22 offen offset:2048 sc1
  buffer_load_dwordx4 a[12:15], v2, s[8:11], s22 offen offset:3072 sc1
  s_add_u32 s22, s31, 290816
  buffer_load_dwordx4 a[16:19], v2, s[8:11], s22 offen offset:0 sc1
  buffer_load_dwordx4 a[20:23], v2, s[8:11], s22 offen offset:1024 sc1
  buffer_load_dwordx4 a[24:27], v2, s[8:11], s22 offen offset:2048 sc1
  buffer_load_dwordx4 a[28:31], v2, s[8:11], s22 offen offset:3072 sc1
  s_add_u32 s22, s31, 294912
  buffer_load_dwordx4 a[32:35], v2, s[8:11], s22 offen offset:0 sc1
  buffer_load_dwordx4 a[36:39], v2, s[8:11], s22 offen offset:1024 sc1
  buffer_load_dwordx4 a[40:43], v2, s[8:11], s22 offen offset:2048 sc1
  buffer_load_dwordx4 a[44:47], v2, s[8:11], s22 offen offset:3072 sc1
  s_add_u32 s22, s31, 299008
  buffer_load_dwordx4 a[48:51], v2, s[8:11], s22 offen offset:0 sc1
  buffer_load_dwordx4 a[52:55], v2, s[8:11], s22 offen offset:1024 sc1
  buffer_load_dwordx4 a[56:59], v2, s[8:11], s22 offen offset:2048 sc1
  buffer_load_dwordx4 a[60:63], v2, s[8:11], s22 offen offset:3072 sc1
  s_add_u32 s22, s31, 303104
  buffer_load_dwordx4 a[64:67], v2, s[8:11], s22 offen offset:0 sc1
  buffer_load_dwordx4 a[68:71], v2, s[8:11], s22 offen offset:1024 sc1
  buffer_load_dwordx4 a[72:75], v2, s[8:11], s22 offen offset:2048 sc1
  buffer_load_dwordx4 a[76:79], v2, s[8:11], s22 offen offset:3072 sc1
  s_add_u32 s22, s31, 307200
  buffer_load_dwordx4 a[80:83], v2, s[8:11], s22 offen offset:0 sc1
  buffer_load_dwordx4 a[84:87], v2, s[8:11], s22 offen offset:1024 sc1
  buffer_load_dwordx4 a[88:91], v2, s[8:11], s22 offen offset:2048 sc1
  buffer_load_dwordx4 a[92:95], v2, s[8:11], s22 offen offset:3072 sc1
  s_add_u32 s22, s31, 311296
  buffer_load_dwordx4 a[96:99], v2, s[8:11], s22 offen offset:0 sc1
  buffer_load_dwordx4 a[100:103], v2, s[8:11], s22 offen offset:1024 sc1
  buffer_load_dwordx4 a[104:107], v2, s[8:11], s22 offen offset:2048 sc1
  buffer_load_dwordx4 a[108:111], v2, s[8:11], s22 offen offset:3072 sc1
  s_add_u32 s22, s31, 315392
  buffer_load_dwordx4 a[112:115], v2, s[8:11], s22 offen offset:0 sc1
  buffer_load_dwordx4 a[116:119], v2, s[8:11], s22 offen offset:1024 sc1
  buffer_load_dwordx4 a[120:123], v2, s[8:11], s22 offen offset:2048 sc1
  buffer_load_dwordx4 a[124:127], v2, s[8:11], s22 offen offset:3072 sc1
  s_waitcnt vmcnt(24)
  s_add_u32 s22, s31, 319488
  buffer_load_dwordx4 a[128:131], v2, s[8:11], s22 offen offset:0 sc1
  buffer_load_dwordx4 a[132:135], v2, s[8:11], s22 offen offset:1024 sc1
  buffer_load_dwordx4 a[136:139], v2, s[8:11], s22 offen offset:2048 sc1
  buffer_load_dwordx4 a[140:143], v2, s[8:11], s22 offen offset:3072 sc1
  s_add_u32 s22, s31, 323584
  buffer_load_dwordx4 a[144:147], v2, s[8:11], s22 offen offset:0 sc1
  buffer_load_dwordx4 a[148:151], v2, s[8:11], s22 offen offset:1024 sc1
  buffer_load_dwordx4 a[152:155], v2, s[8:11], s22 offen offset:2048 sc1
  buffer_load_dwordx4 a[156:159], v2, s[8:11], s22 offen offset:3072 sc1
  s_add_u32 s22, s31, 327680
  buffer_load_dwordx4 a[160:163], v2, s[8:11], s22 offen offset:0 sc1
  buffer_load_dwordx4 a[164:167], v2, s[8:11], s22 offen offset:1024 sc1
  buffer_load_dwordx4 a[168:171], v2, s[8:11], s22 offen offset:2048 sc1
  buffer_load_dwordx4 a[172:175], v2, s[8:11], s22 offen offset:3072 sc1
  s_add_u32 s22, s31, 331776
  buffer_load_dwordx4 a[176:179], v2, s[8:11], s22 offen offset:0 sc1
  buffer_load_dwordx4 a[180:183], v2, s[8:11], s22 offen offset:1024 sc1
  buffer_load_dwordx4 a[184:187], v2, s[8:11], s22 offen offset:2048 sc1
  buffer_load_dwordx4 a[188:191], v2, s[8:11], s22 offen offset:3072 sc1
  s_add_u32 s22, s31, 335872
  buffer_load_dwordx4 a[192:195], v2, s[8:11], s22 offen offset:0 sc1
  buffer_load_dwordx4 a[196:199], v2, s[8:11], s22 offen offset:1024 sc1
  buffer_load_dwordx4 a[200:203], v2, s[8:11], s22 offen offset:2048 sc1
  buffer_load_dwordx4 a[204:207], v2, s[8:11], s22 offen offset:3072 sc1
  s_add_u32 s22, s31, 339968
  buffer_load_dwordx4 a[208:211], v2, s[8:11], s22 offen offset:0 sc1
  buffer_load_dwordx4 a[212:215], v2, s[8:11], s22 offen offset:1024 sc1
  buffer_load_dwordx4 a[216:219], v2, s[8:11], s22 offen offset:2048 sc1
  buffer_load_dwordx4 a[220:223], v2, s[8:11], s22 offen offset:3072 sc1
  s_add_u32 s22, s31, 344064
  buffer_load_dwordx4 a[224:227], v2, s[8:11], s22 offen offset:0 sc1
  buffer_load_dwordx4 a[228:231], v2, s[8:11], s22 offen offset:1024 sc1
  buffer_load_dwordx4 a[232:235], v2, s[8:11], s22 offen offset:2048 sc1
  buffer_load_dwordx4 a[236:239], v2, s[8:11], s22 offen offset:3072 sc1
  s_add_u32 s22, s31, 348160
  buffer_load_dwordx4 a[240:243], v2, s[8:11], s22 offen offset:0 sc1
  buffer_load_dwordx4 a[244:247], v2, s[8:11], s22 offen offset:1024 sc1
  buffer_load_dwordx4 a[248:251], v2, s[8:11], s22 offen offset:2048 sc1
  buffer_load_dwordx4 a[252:255], v2, s[8:11], s22 offen offset:3072 sc1
  s_waitcnt vmcnt(24)
  s_add_u32 s22, s31, 352256
  buffer_load_dwordx4 v[120:123], v2, s[8:11], s22 offen offset:0 sc1
  buffer_load_dwordx4 v[124:127], v2, s[8:11], s22 offen offset:1024 sc1
  buffer_load_dwordx4 v[128:131], v2, s[8:11], s22 offen offset:2048 sc1
  buffer_load_dwordx4 v[132:135], v2, s[8:11], s22 offen offset:3072 sc1
  s_add_u32 s22, s31, 356352
  buffer_load_dwordx4 v[136:139], v2, s[8:11], s22 offen offset:0 sc1
  buffer_load_dwordx4 v[140:143], v2, s[8:11], s22 offen offset:1024 sc1
  buffer_load_dwordx4 v[144:147], v2, s[8:11], s22 offen offset:2048 sc1
  buffer_load_dwordx4 v[148:151], v2, s[8:11], s22 offen offset:3072 sc1
  s_add_u32 s22, s31, 360448
  buffer_load_dwordx4 v[152:155], v2, s[8:11], s22 offen offset:0 sc1
  buffer_load_dwordx4 v[156:159], v2, s[8:11], s22 offen offset:1024 sc1
  buffer_load_dwordx4 v[160:163], v2, s[8:11], s22 offen offset:2048 sc1
  buffer_load_dwordx4 v[164:167], v2, s[8:11], s22 offen offset:3072 sc1
  s_add_u32 s22, s31, 364544
  buffer_load_dwordx4 v[168:171], v2, s[8:11], s22 offen offset:0 sc1
  buffer_load_dwordx4 v[172:175], v2, s[8:11], s22 offen offset:1024 sc1
  buffer_load_dwordx4 v[176:179], v2, s[8:11], s22 offen offset:2048 sc1
  buffer_load_dwordx4 v[180:183], v2, s[8:11], s22 offen offset:3072 sc1
  s_add_u32 s22, s31, 368640
  buffer_load_dwordx4 v[184:187], v2, s[8:11], s22 offen offset:0 sc1
  buffer_load_dwordx4 v[188:191], v2, s[8:11], s22 offen offset:1024 sc1
  buffer_load_dwordx4 v[192:195], v2, s[8:11], s22 offen offset:2048 sc1
  buffer_load_dwordx4 v[196:199], v2, s[8:11], s22 offen offset:3072 sc1
  s_add_u32 s22, s31, 372736
  buffer_load_dwordx4 v[200:203], v2, s[8:11], s22 offen offset:0 sc1
  buffer_load_dwordx4 v[204:207], v2, s[8:11], s22 offen offset:1024 sc1
  buffer_load_dwordx4 v[208:211], v2, s[8:11], s22 offen offset:2048 sc1
  buffer_load_dwordx4 v[212:215], v2, s[8:11], s22 offen offset:3072 sc1
  s_add_u32 s22, s31, 376832
  buffer_load_dwordx4 v[216:219], v2, s[8:11], s22 offen offset:0 sc1
  buffer_load_dwordx4 v[220:223], v2, s[8:11], s22 offen offset:1024 sc1
  buffer_load_dwordx4 v[224:227], v2, s[8:11], s22 offen offset:2048 sc1
  buffer_load_dwordx4 v[228:231], v2, s[8:11], s22 offen offset:3072 sc1
  s_add_u32 s22, s31, 380928
  buffer_load_dwordx4 v[232:235], v2, s[8:11], s22 offen offset:0 sc1
  buffer_load_dwordx4 v[236:239], v2, s[8:11], s22 offen offset:1024 sc1
  buffer_load_dwordx4 v[240:243], v2, s[8:11], s22 offen offset:2048 sc1
  buffer_load_dwordx4 v[244:247], v2, s[8:11], s22 offen offset:3072 sc1
  s_waitcnt vmcnt(24)
  s_add_u32 s22, s31, 385024
  buffer_load_dwordx4 v[248:251], v2, s[8:11], s22 offen offset:0 sc1
  buffer_load_dwordx4 v[252:255], v2, s[8:11], s22 offen offset:1024 sc1
  v_mov_b32 v72, v116
  v_mov_b32 v73, v117
  v_lshrrev_b32 v65, 1, v72
  v_and_b32 v66, 1, v72
  v_add_u32 v67, 20, v65
  v_lshl_add_u32 v67, v67, 4, v73
  v_mul_u32_u24 v68, 2341, v67
  v_lshrrev_b32 v68, 16, v68
  v_mul_u32_u24 v69, 28, v68
  v_sub_u32 v69, v67, v69
  v_lshrrev_b32 v70, 4, v69
  v_and_b32 v69, 15, v69
  v_and_b32 v71, 1, v69
  v_lshrrev_b32 v69, 1, v69
  v_lshl_add_u32 v69, v71, 3, v69
  v_lshlrev_b32 v71, 12, v70
  v_lshrrev_b32 v70, 1, v68
  v_lshl_add_u32 v71, v70, 9, v71
  v_and_b32 v70, 1, v68
  v_lshl_add_u32 v71, v70, 2, v71
  v_lshl_add_u32 v71, v69, 4, v71
  v_lshl_add_u32 v112, v66, 8, v71
  v_add_u32 v67, 22, v65
  v_lshl_add_u32 v67, v67, 4, v73
  v_mul_u32_u24 v68, 2341, v67
  v_lshrrev_b32 v68, 16, v68
  v_mul_u32_u24 v69, 28, v68
  v_sub_u32 v69, v67, v69
  v_lshrrev_b32 v70, 4, v69
  v_and_b32 v69, 15, v69
  v_and_b32 v71, 1, v69
  v_lshrrev_b32 v69, 1, v69
  v_lshl_add_u32 v69, v71, 3, v69
  v_lshlrev_b32 v71, 12, v70
  v_lshrrev_b32 v70, 1, v68
  v_lshl_add_u32 v71, v70, 9, v71
  v_and_b32 v70, 1, v68
  v_lshl_add_u32 v71, v70, 2, v71
  v_lshl_add_u32 v71, v69, 4, v71
  v_lshl_add_u32 v113, v66, 8, v71
  v_add_u32 v67, 24, v65
  v_lshl_add_u32 v67, v67, 4, v73
  v_mul_u32_u24 v68, 2341, v67
  v_lshrrev_b32 v68, 16, v68
  v_mul_u32_u24 v69, 28, v68
  v_sub_u32 v69, v67, v69
  v_lshrrev_b32 v70, 4, v69
  v_and_b32 v69, 15, v69
  v_and_b32 v71, 1, v69
  v_lshrrev_b32 v69, 1, v69
  v_lshl_add_u32 v69, v71, 3, v69
  v_lshlrev_b32 v71, 12, v70
  v_lshrrev_b32 v70, 1, v68
  v_lshl_add_u32 v71, v70, 9, v71
  v_and_b32 v70, 1, v68
  v_lshl_add_u32 v71, v70, 2, v71
  v_lshl_add_u32 v71, v69, 4, v71
  v_lshl_add_u32 v114, v66, 8, v71
  v_add_u32 v67, 26, v65
  v_lshl_add_u32 v67, v67, 4, v73
  v_mul_u32_u24 v68, 2341, v67
  v_lshrrev_b32 v68, 16, v68
  v_mul_u32_u24 v69, 28, v68
  v_sub_u32 v69, v67, v69
  v_lshrrev_b32 v70, 4, v69
  v_and_b32 v69, 15, v69
  v_and_b32 v71, 1, v69
  v_lshrrev_b32 v69, 1, v69
  v_lshl_add_u32 v69, v71, 3, v69
  v_lshlrev_b32 v71, 12, v70
  v_lshrrev_b32 v70, 1, v68
  v_lshl_add_u32 v71, v70, 9, v71
  v_and_b32 v70, 1, v68
  v_lshl_add_u32 v71, v70, 2, v71
  v_lshl_add_u32 v71, v69, 4, v71
  v_lshl_add_u32 v115, v66, 8, v71
  s_mul_i32 s24, s17, 532480
  s_add_u32 s24, s24, 76931072
  s_mul_i32 s34, s17, 640
  s_add_u32 s34, s34, 88569860
  s_mul_i32 s36, s17, 448
  v_add_u32 v0, s36, v2
  v_add_u32 v0, 8192, v0
  s_add_u32 s36, s36, 88068096
  v_cmp_gt_u32 s[26:27], 28, v1
  v_and_b32 v119, 31, v1
  v_lshlrev_b32 v119, 2, v119
  s_add_u32 s22, s17, 16
  s_and_b32 s22, s22, 31
  s_lshl_b32 s22, s22, 7
  s_add_u32 s22, s22, 21504
  v_add_u32 v119, s22, v119
  v_min_u32 v118, 13, v1
  s_mul_i32 s22, s17, 14
  v_add_u32 v118, s22, v118
  v_lshlrev_b32 v118, 7, v118
  v_add_u32 v118, 57344, v118
  s_mov_b32 s39, 71565312
  v_add_u32 v1, 59392, v2
  v_mov_b32 v117, 1
  s_mul_i32 s38, s17, 1104
  s_add_u32 s38, s38, 26624
  s_lshl_b32 s22, 0, 11
  s_add_u32 s22, s22, 88590336
  v_add_u32 v36, 1024, v2
  v_min_u32 v36, 1776, v36
  s_mov_b32 s30, 0
va_iw7:
  buffer_load_dwordx4 v[40:43], v2, s[8:11], s22 offen sc1
  buffer_load_dwordx4 v[44:47], v36, s[8:11], s22 offen sc1
  s_waitcnt vmcnt(0)
  v_cmp_ne_u64 vcc, s[88:89], v[40:41]
  s_cbranch_vccnz va_iw7_no
  v_cmp_ne_u64 vcc, s[88:89], v[42:43]
  s_cbranch_vccnz va_iw7_no
  v_cmp_ne_u64 vcc, s[88:89], v[44:45]
  s_cbranch_vccnz va_iw7_no
  v_cmp_ne_u64 vcc, s[88:89], v[46:47]
  s_cbranch_vccnz va_iw7_no
  s_branch va_iw7_ok
va_iw7_no:
  s_sleep 2
  s_add_u32 s30, s30, 1
  s_cmp_lt_u32 s30, 50000
  s_cbranch_scc1 va_iw7
  s_branch cA_abort
va_iw7_ok:
  s_mov_b32 s30, 0
  v_mov_b32 v36, 0
ch_md7:
  buffer_load_dword v37, v36, s[12:15], 0 offen sc1
  s_waitcnt vmcnt(0)
  v_readfirstlane_b32 s22, v37
  s_and_b32 s31, s22, 0xffff
  s_cmp_ge_u32 s31, 32
  s_cbranch_scc1 ch_go7
  s_sleep 2
  s_add_u32 s30, s30, 1
  s_cmp_lt_u32 s30, 50000
  s_cbranch_scc1 ch_md7
  s_branch ch_end
ch_go7:
  s_mov_b32 s31, 0
  s_lshr_b32 s22, s22, 16
  s_cmp_lg_u32 s22, 0
  s_cbranch_scc1 cB_va3_loop
  s_branch cA_va3_loop
.p2align 6

cA_sc0_loop:
  s_add_u32 s23, s20, 4096
  s_add_u32 s21, s20, 25600
  v_mov_b32 v48, 0
  v_mov_b32 v49, 0
  v_mov_b32 v50, 0
  v_mov_b32 v51, 0
  v_mov_b32 v52, 0
  v_mov_b32 v53, 0
  v_mov_b32 v54, 0
  v_mov_b32 v55, 0
  v_mov_b32 v56, 0
  v_mov_b32 v57, 0
  v_mov_b32 v58, 0
  v_mov_b32 v59, 0
  v_mov_b32 v60, 0
  v_mov_b32 v61, 0
  v_mov_b32 v62, 0
  v_mov_b32 v63, 0
  v_mov_b32 v88, 0
  v_mov_b32 v89, 0
  v_mov_b32 v90, 0
  v_mov_b32 v91, 0
  v_mov_b32 v92, 0
  v_mov_b32 v93, 0
  v_mov_b32 v94, 0
  v_mov_b32 v95, 0
  v_mov_b32 v66, 0
  v_mov_b32 v67, 0
  s_mov_b32 s30, 0
  s_mov_b32 s62, 0
  buffer_load_dword v68, v0, s[8:11], s20 offen sc1
  s_nop 7
  buffer_load_dword v69, v0, s[8:11], s20 offen sc1
  s_nop 7
  buffer_load_dword v70, v0, s[8:11], s20 offen sc1
  s_nop 7
  buffer_load_dword v71, v0, s[8:11], s20 offen sc1
  s_nop 7
  buffer_load_dword v72, v0, s[8:11], s20 offen sc1
cA_sc0_fp_l:
  s_waitcnt vmcnt(4)
  v_cmp_eq_u32 vcc, -1, v68
  s_cbranch_vccz cA_sc0_fp_d
  buffer_load_dword v68, v0, s[8:11], s20 offen sc1
  s_waitcnt vmcnt(4)
  v_cmp_eq_u32 vcc, -1, v69
  s_cbranch_vccz cA_sc0_fp_d
  buffer_load_dword v69, v0, s[8:11], s20 offen sc1
  s_waitcnt vmcnt(4)
  v_cmp_eq_u32 vcc, -1, v70
  s_cbranch_vccz cA_sc0_fp_d
  buffer_load_dword v70, v0, s[8:11], s20 offen sc1
  s_waitcnt vmcnt(4)
  v_cmp_eq_u32 vcc, -1, v71
  s_cbranch_vccz cA_sc0_fp_d
  buffer_load_dword v71, v0, s[8:11], s20 offen sc1
  s_waitcnt vmcnt(4)
  v_cmp_eq_u32 vcc, -1, v72
  s_cbranch_vccz cA_sc0_fp_d
  buffer_load_dword v72, v0, s[8:11], s20 offen sc1
  s_add_u32 s30, s30, 1
  s_cmp_lt_u32 s30, 400000
  s_cbranch_scc1 cA_sc0_fp_l
  s_branch cA_abort
cA_sc0_fp_d:
  buffer_load_dwordx4 v[8:11], v2, s[8:11], s20 offen offset:0
  s_barrier
  s_branch cA_sc0_ld1
cA_sc0_ld:
  buffer_load_dwordx4 v[8:11], v2, s[8:11], s20 offen offset:0
cA_sc0_ld1:
  v_mov_b32 v36, 0
  v_mov_b32 v37, 0
  v_mov_b32 v38, 0
  v_mov_b32 v39, 0
  buffer_load_dwordx4 v[12:15], v2, s[8:11], s20 offen offset:1024
  v_mov_b32 v40, 0
  v_mov_b32 v41, 0
  v_mov_b32 v42, 0
  v_mov_b32 v43, 0
  buffer_load_dwordx4 v[16:19], v2, s[8:11], s20 offen offset:2048
  v_mov_b32 v44, 0
  v_mov_b32 v45, 0
  v_mov_b32 v46, 0
  v_mov_b32 v47, 0
  ds_read_b128 v[96:99], v117 offset:0
  ds_read_b128 v[100:103], v117 offset:1024
  ds_read_b128 v[104:107], v117 offset:14336
  ds_read_b128 v[108:111], v117 offset:15360
  s_waitcnt vmcnt(2)
  v_smfmac_f32_16x16x64_bf16 v[36:39], v[8:11], a[0:7], v3
  v_smfmac_f32_16x16x64_bf16 v[40:43], v[8:11], a[56:63], v3
  buffer_load_dwordx4 v[20:23], v2, s[8:11], s20 offen offset:3072
  v_smfmac_f32_16x16x64_bf16 v[44:47], v[8:11], a[112:119], v3
  v_smfmac_f32_16x16x64_bf16 v[48:51], v[8:11], a[168:175], v3
  v_smfmac_f32_16x16x64_bf16 v[52:55], v[8:11], a[224:231], v3
  buffer_load_dwordx4 v[24:27], v2, s[8:11], s23 offen offset:0
  v_smfmac_f32_16x16x64_bf16 v[56:59], v[8:11], v[144:151], v3
  v_smfmac_f32_16x16x64_bf16 v[60:63], v[8:11], v[200:207], v3
  s_waitcnt vmcnt(3)
  v_smfmac_f32_16x16x64_bf16 v[36:39], v[12:15], a[8:15], v3
  v_smfmac_f32_16x16x64_bf16 v[40:43], v[12:15], a[64:71], v3
  buffer_load_dwordx4 v[28:31], v2, s[8:11], s23 offen offset:1024
  v_smfmac_f32_16x16x64_bf16 v[44:47], v[12:15], a[120:127], v3
  v_smfmac_f32_16x16x64_bf16 v[48:51], v[12:15], a[176:183], v3
  v_smfmac_f32_16x16x64_bf16 v[52:55], v[12:15], a[232:239], v3
  buffer_load_dwordx4 v[32:35], v2, s[8:11], s23 offen offset:2048
  v_smfmac_f32_16x16x64_bf16 v[56:59], v[12:15], v[152:159], v3
  v_smfmac_f32_16x16x64_bf16 v[60:63], v[12:15], v[208:215], v3
  s_waitcnt vmcnt(4)
  v_smfmac_f32_16x16x64_bf16 v[36:39], v[16:19], a[16:23], v3
  v_smfmac_f32_16x16x64_bf16 v[40:43], v[16:19], a[72:79], v3
  v_smfmac_f32_16x16x64_bf16 v[44:47], v[16:19], a[128:135], v3
  v_smfmac_f32_16x16x64_bf16 v[48:51], v[16:19], a[184:191], v3
  v_smfmac_f32_16x16x64_bf16 v[52:55], v[16:19], a[240:247], v3
  v_smfmac_f32_16x16x64_bf16 v[56:59], v[16:19], v[160:167], v3
  v_smfmac_f32_16x16x64_bf16 v[60:63], v[16:19], v[216:223], v3
  s_waitcnt vmcnt(3)
  v_smfmac_f32_16x16x64_bf16 v[36:39], v[20:23], a[24:31], v3
  v_smfmac_f32_16x16x64_bf16 v[40:43], v[20:23], a[80:87], v3
  v_smfmac_f32_16x16x64_bf16 v[44:47], v[20:23], a[136:143], v3
  v_smfmac_f32_16x16x64_bf16 v[48:51], v[20:23], a[192:199], v3
  v_smfmac_f32_16x16x64_bf16 v[52:55], v[20:23], a[248:255], v3
  v_smfmac_f32_16x16x64_bf16 v[56:59], v[20:23], v[168:175], v3
  v_smfmac_f32_16x16x64_bf16 v[60:63], v[20:23], v[224:231], v3
  s_waitcnt vmcnt(0)
cA_sc0_ph2:
  v_smfmac_f32_16x16x64_bf16 v[60:63], v[24:27], v[232:239], v3
  ds_read_b128 v[12:15], v116 offset:0
  ds_read_b128 v[16:19], v116 offset:1024
  v_smfmac_f32_16x16x64_bf16 v[60:63], v[28:31], v[240:247], v3
  v_smfmac_f32_16x16x64_bf16 v[60:63], v[32:35], v[248:255], v3
  v_mov_b32 v80, v24
  v_smfmac_f32_16x16x64_bf16 v[52:55], v[24:27], v[120:127], v3
  v_mov_b32 v81, v25
  v_smfmac_f32_16x16x64_bf16 v[52:55], v[28:31], v[128:135], v3
  v_mov_b32 v82, v32
  v_smfmac_f32_16x16x64_bf16 v[52:55], v[32:35], v[136:143], v3
  v_cvt_pk_bf16_f32 v64, v60, v61
  v_smfmac_f32_16x16x64_bf16 v[56:59], v[24:27], v[176:183], v3
  v_cvt_pk_bf16_f32 v65, v62, v63
  v_smfmac_f32_16x16x64_bf16 v[56:59], v[28:31], v[184:191], v3
  v_mov_b32 v83, v33
  v_mfma_f32_16x16x32_bf16 v[68:71], v[64:67], v[4:7], 0
  v_smfmac_f32_16x16x64_bf16 v[56:59], v[32:35], v[192:199], v3
  v_cvt_pk_bf16_f32 v64, v52, v53
  v_smfmac_f32_16x16x64_bf16 v[36:39], v[24:27], a[32:39], v3
  v_cvt_pk_bf16_f32 v65, v54, v55
  v_smfmac_f32_16x16x64_bf16 v[36:39], v[28:31], a[40:47], v3
  v_cvt_pk_bf16_f32 v78, v68, v69
  v_smfmac_f32_16x16x64_bf16 v[36:39], v[32:35], a[48:55], v3
  v_cvt_pk_bf16_f32 v79, v70, v71
  v_cvt_pk_bf16_f32 v66, v56, v57
  v_smfmac_f32_16x16x64_bf16 v[40:43], v[24:27], a[88:95], v3
  v_cvt_pk_bf16_f32 v67, v58, v59
  v_smfmac_f32_16x16x64_bf16 v[40:43], v[28:31], a[96:103], v3
  v_mfma_f32_16x16x32_bf16 v[72:75], v[64:67], v[4:7], 0
  ds_read_b128 v[52:55], v116 offset:14336
  ds_read_b128 v[56:59], v116 offset:15360
  v_smfmac_f32_16x16x64_bf16 v[40:43], v[32:35], a[104:111], v3
  v_cvt_pk_bf16_f32 v64, v36, v37
  v_smfmac_f32_16x16x64_bf16 v[44:47], v[24:27], a[144:151], v3
  v_cvt_pk_bf16_f32 v65, v38, v39
  v_smfmac_f32_16x16x64_bf16 v[44:47], v[28:31], a[152:159], v3
  v_cvt_pk_bf16_f32 v76, v72, v73
  v_smfmac_f32_16x16x64_bf16 v[44:47], v[32:35], a[160:167], v3
  v_cvt_pk_bf16_f32 v77, v74, v75
  v_cvt_pk_bf16_f32 v66, v40, v41
  v_smfmac_f32_16x16x64_bf16 v[48:51], v[24:27], a[200:207], v3
  v_cvt_pk_bf16_f32 v67, v42, v43
  v_smfmac_f32_16x16x64_bf16 v[48:51], v[28:31], a[208:215], v3
  v_mfma_f32_16x16x32_bf16 v[68:71], v[64:67], v[4:7], 0
  v_smfmac_f32_16x16x64_bf16 v[48:51], v[32:35], a[216:223], v3
  v_cvt_pk_bf16_f32 v64, v44, v45
  v_mfma_f32_16x16x32_bf16 v[84:87], v[80:83], v[76:79], 0
  v_cvt_pk_bf16_f32 v65, v46, v47
  s_waitcnt lgkmcnt(0)
  v_smfmac_f32_16x16x64_bf16 v[88:91], v[76:79], v[96:103], v3
  v_cvt_pk_bf16_f32 v60, v68, v69
  v_cvt_pk_bf16_f32 v61, v70, v71
  v_cvt_pk_bf16_f32 v66, v48, v49
  v_cvt_pk_bf16_f32 v67, v50, v51
  s_nop 1
  v_mfma_f32_16x16x32_bf16 v[72:75], v[64:67], v[4:7], 0
  v_smfmac_f32_16x16x64_bf16 v[92:95], v[76:79], v[104:111], v3
  s_nop 4
  v_cvt_pk_bf16_f32 v62, v72, v73
  v_cvt_pk_bf16_f32 v63, v74, v75
  s_nop 1
  v_mfma_f32_16x16x32_bf16 v[84:87], v[8:11], v[60:63], v[84:87]
  v_smfmac_f32_16x16x64_bf16 v[88:91], v[60:63], v[12:19], v3
  v_smfmac_f32_16x16x64_bf16 v[92:95], v[60:63], v[52:59], v3
  s_nop 1
  v_permlane32_swap_b32 v84, v86
  v_permlane32_swap_b32 v85, v87
  s_nop 0
  v_cmp_u_f32 vcc, v88, v89
  v_add_f32_dpp v84, v86, v84 row_ror:8 row_mask:0xf bank_mask:0xf
  v_add_f32_dpp v85, v87, v85 row_ror:8 row_mask:0xf bank_mask:0xf
  v_permlane32_swap_b32 v88, v92
  v_permlane32_swap_b32 v89, v93
  ds_write2_b32 v113, v84, v85 offset0:0 offset1:4
  v_permlane32_swap_b32 v90, v94
  v_permlane32_swap_b32 v91, v95
  v_add_f32 v88, v88, v92
  v_add_f32 v89, v89, v93
  v_add_f32 v90, v90, v94
  v_add_f32 v91, v91, v95
  ds_write2_b64 v112, v[88:89], v[90:91] offset0:0 offset1:128
  s_cbranch_vccnz cA_sc0_retry
cA_sc0_cont:
  s_waitcnt lgkmcnt(0)
  s_barrier
  ds_read_b128 v[36:39], v114
  ds_read_b128 v[44:47], v115
  s_waitcnt lgkmcnt(0)
  v_add_f32 v36, v36, v38
  v_add_f32 v37, v37, v39
  v_add_f32 v44, v44, v45
  v_add_f32 v46, v46, v47
  v_permlane32_swap_b32 v36, v37
  v_add_f32 v44, v44, v46
  v_add_f32 v36, v36, v37
  v_exp_f32 v49, v44
  v_exp_f32 v48, v36
  v_add_f32 v50, abs(v36), abs(v44)
  v_fma_f32 v39, v49, s37, v48
  v_cmp_ngt_f32 vcc, s56, v50
  v_cndmask_b32 v41, v48, v49, s[38:39]
  v_add_f32_dpp v39, v39, v39 quad_perm:[1,0,3,2] row_mask:0xf bank_mask:0xf
  v_cndmask_b32 v40, v49, v48, s[38:39]
  v_mov_b32_dpp v46, v41 quad_perm:[1,0,3,2] row_mask:0xf bank_mask:0xf
  v_add_f32_dpp v39, v39, v39 quad_perm:[2,3,0,1] row_mask:0xf bank_mask:0xf
  v_cndmask_b32 v42, v46, v40, s[38:39]
  v_cndmask_b32 v43, v40, v46, s[38:39]
  v_add_f32_dpp v39, v39, v39 row_half_mirror row_mask:0xf bank_mask:0xf
  s_cbranch_vccnz cA_sc0_slow
  s_nop 0
  v_add_f32_dpp v47, v39, v39 row_mirror row_mask:0xf bank_mask:0xf
  v_add_f32_dpp v39, v39, v39 row_mirror row_mask:0xf bank_mask:0xf
  s_nop 1
  v_permlane16_swap_b32 v39, v47
  v_add_f32 v39, v39, v47
  v_rcp_f32 v39, v39
  s_mov_b64 exec, s[28:29]
  v_mul_f32 v42, v42, v39
  v_mul_f32 v43, v43, v39
  v_cvt_pk_bf16_f32 v42, v42, v43
cA_sc0_pst:
  buffer_store_dword v42, v1, s[8:11], s20 offen
  s_mov_b64 exec, -1
  s_barrier
  s_add_u32 s24, s24, 28672
  s_add_u32 s35, s35, 28672
  s_xor_b32 s25, s25, 28672
  s_add_u32 m0, s25, 0
  s_nop 0
  buffer_load_dwordx4 v2, s[8:11], s24 offen offset:0 sc1 lds
  buffer_load_dwordx4 v2, s[8:11], s24 offen offset:1024 sc1 lds
  buffer_load_dwordx4 v2, s[8:11], s24 offen offset:2048 sc1 lds
  buffer_load_dwordx4 v2, s[8:11], s24 offen offset:3072 sc1 lds
  s_add_u32 m0, s25, 4096
  s_add_u32 s22, s24, 4096
  buffer_load_dwordx4 v2, s[8:11], s22 offen offset:0 sc1 lds
  buffer_load_dwordx4 v2, s[8:11], s22 offen offset:1024 sc1 lds
  buffer_load_dwordx4 v2, s[8:11], s22 offen offset:2048 sc1 lds
  v_xor_b32 v116, 28672, v116
  v_add_u32 v117, s57, v117
  s_sub_u32 s57, 0, s57
  s_add_u32 s19, s19, 1
  s_mov_b32 s20, s21
  s_cmp_lt_u32 s19, 63
  s_cbranch_scc1 cA_sc0_loop
  s_branch cA_done
cA_sc0_slow:
  v_max_f32 v50, v36, v44
  s_nop 1
  v_max_f32_dpp v50, v50, v50 quad_perm:[1,0,3,2] row_mask:0xf bank_mask:0xf
  s_nop 1
  v_max_f32_dpp v50, v50, v50 quad_perm:[2,3,0,1] row_mask:0xf bank_mask:0xf
  s_nop 1
  v_max_f32_dpp v50, v50, v50 row_half_mirror row_mask:0xf bank_mask:0xf
  s_nop 1
  v_max_f32_dpp v50, v50, v50 row_mirror row_mask:0xf bank_mask:0xf
  v_mov_b32 v47, v50
  s_nop 1
  v_permlane16_swap_b32 v50, v47
  v_max_f32 v50, v50, v47
  v_sub_f32 v48, v36, v50
  v_sub_f32 v49, v44, v50
  v_exp_f32 v48, v48
  v_exp_f32 v49, v49
  s_add_u32 s31, s31, 0x100
  v_fma_f32 v39, v49, s37, v48
  v_cndmask_b32 v41, v48, v49, s[38:39]
  s_nop 0
  v_add_f32_dpp v39, v39, v39 quad_perm:[1,0,3,2] row_mask:0xf bank_mask:0xf
  v_cndmask_b32 v40, v49, v48, s[38:39]
  v_mov_b32_dpp v46, v41 quad_perm:[1,0,3,2] row_mask:0xf bank_mask:0xf
  v_add_f32_dpp v39, v39, v39 quad_perm:[2,3,0,1] row_mask:0xf bank_mask:0xf
  v_cndmask_b32 v42, v46, v40, s[38:39]
  v_cndmask_b32 v43, v40, v46, s[38:39]
  v_add_f32_dpp v39, v39, v39 row_half_mirror row_mask:0xf bank_mask:0xf
  s_nop 1
  v_add_f32_dpp v47, v39, v39 row_mirror row_mask:0xf bank_mask:0xf
  v_add_f32_dpp v39, v39, v39 row_mirror row_mask:0xf bank_mask:0xf
  s_nop 1
  v_permlane16_swap_b32 v39, v47
  v_add_f32 v39, v39, v47
  v_rcp_f32 v39, v39
  s_mov_b64 exec, s[28:29]
  v_mul_f32 v42, v42, v39
  v_mul_f32 v43, v43, v39
  v_cvt_pk_bf16_f32 v42, v42, v43
  v_min_u32 v42, -2, v42
  s_branch cA_sc0_pst
cA_sc0_retry:
  s_cmp_lg_u32 s62, 0
  s_cbranch_scc1 cA_sc0_cont
  s_waitcnt vmcnt(0) lgkmcnt(0)
cA_sc0_rv:
  buffer_load_dwordx4 v[8:11], v2, s[8:11], s20 offen offset:0 sc1
  buffer_load_dwordx4 v[12:15], v2, s[8:11], s20 offen offset:1024 sc1
  buffer_load_dwordx4 v[16:19], v2, s[8:11], s20 offen offset:2048 sc1
  buffer_load_dwordx4 v[20:23], v2, s[8:11], s20 offen offset:3072 sc1
  buffer_load_dwordx4 v[24:27], v2, s[8:11], s23 offen offset:0 sc1
  buffer_load_dwordx4 v[28:31], v2, s[8:11], s23 offen offset:1024 sc1
  buffer_load_dwordx4 v[32:35], v2, s[8:11], s23 offen offset:2048 sc1
  s_waitcnt vmcnt(0)
  v_max3_u32 v118, v8, v9, v10
  v_max3_u32 v118, v118, v11, v12
  v_max3_u32 v118, v118, v13, v14
  v_max3_u32 v118, v118, v15, v16
  v_max3_u32 v118, v118, v17, v18
  v_max3_u32 v118, v118, v19, v20
  v_max3_u32 v118, v118, v21, v22
  v_max3_u32 v118, v118, v23, v24
  v_max3_u32 v118, v118, v25, v26
  v_max3_u32 v118, v118, v27, v28
  v_max3_u32 v118, v118, v29, v30
  v_max3_u32 v118, v118, v31, v32
  v_max3_u32 v118, v118, v33, v34
  v_max_u32 v118, v118, v35
  v_cmp_eq_u32 vcc, -1, v118
  s_cbranch_vccz cA_sc0_rk
  s_add_u32 s30, s30, 1
  s_cmp_lt_u32 s30, 400000
  s_cbranch_scc1 cA_sc0_rv
  s_branch cA_abort
cA_sc0_rk:
  s_mov_b32 s62, 1
  v_mov_b32 v36, 0
  v_mov_b32 v37, 0
  v_mov_b32 v38, 0
  v_mov_b32 v39, 0
  v_mov_b32 v40, 0
  v_mov_b32 v41, 0
  v_mov_b32 v42, 0
  v_mov_b32 v43, 0
  v_mov_b32 v44, 0
  v_mov_b32 v45, 0
  v_mov_b32 v46, 0
  v_mov_b32 v47, 0
  v_mov_b32 v48, 0
  v_mov_b32 v49, 0
  v_mov_b32 v50, 0
  v_mov_b32 v51, 0
  v_mov_b32 v52, 0
  v_mov_b32 v53, 0
  v_mov_b32 v54, 0
  v_mov_b32 v55, 0
  v_mov_b32 v56, 0
  v_mov_b32 v57, 0
  v_mov_b32 v58, 0
  v_mov_b32 v59, 0
  v_mov_b32 v60, 0
  v_mov_b32 v61, 0
  v_mov_b32 v62, 0
  v_mov_b32 v63, 0
  v_mov_b32 v88, 0
  v_mov_b32 v89, 0
  v_mov_b32 v90, 0
  v_mov_b32 v91, 0
  v_mov_b32 v92, 0
  v_mov_b32 v93, 0
  v_mov_b32 v94, 0
  v_mov_b32 v95, 0
  v_mov_b32 v66, 0
  v_mov_b32 v67, 0
  s_add_u32 s31, s31, 1
  ds_read_b128 v[96:99], v117 offset:0
  ds_read_b128 v[100:103], v117 offset:1024
  ds_read_b128 v[104:107], v117 offset:14336
  ds_read_b128 v[108:111], v117 offset:15360
  v_smfmac_f32_16x16x64_bf16 v[36:39], v[8:11], a[0:7], v3
  v_smfmac_f32_16x16x64_bf16 v[40:43], v[8:11], a[56:63], v3
  v_smfmac_f32_16x16x64_bf16 v[44:47], v[8:11], a[112:119], v3
  v_smfmac_f32_16x16x64_bf16 v[48:51], v[8:11], a[168:175], v3
  v_smfmac_f32_16x16x64_bf16 v[52:55], v[8:11], a[224:231], v3
  v_smfmac_f32_16x16x64_bf16 v[56:59], v[8:11], v[144:151], v3
  v_smfmac_f32_16x16x64_bf16 v[60:63], v[8:11], v[200:207], v3
  v_smfmac_f32_16x16x64_bf16 v[36:39], v[12:15], a[8:15], v3
  v_smfmac_f32_16x16x64_bf16 v[40:43], v[12:15], a[64:71], v3
  v_smfmac_f32_16x16x64_bf16 v[44:47], v[12:15], a[120:127], v3
  v_smfmac_f32_16x16x64_bf16 v[48:51], v[12:15], a[176:183], v3
  v_smfmac_f32_16x16x64_bf16 v[52:55], v[12:15], a[232:239], v3
  v_smfmac_f32_16x16x64_bf16 v[56:59], v[12:15], v[152:159], v3
  v_smfmac_f32_16x16x64_bf16 v[60:63], v[12:15], v[208:215], v3
  v_smfmac_f32_16x16x64_bf16 v[36:39], v[16:19], a[16:23], v3
  v_smfmac_f32_16x16x64_bf16 v[40:43], v[16:19], a[72:79], v3
  v_smfmac_f32_16x16x64_bf16 v[44:47], v[16:19], a[128:135], v3
  v_smfmac_f32_16x16x64_bf16 v[48:51], v[16:19], a[184:191], v3
  v_smfmac_f32_16x16x64_bf16 v[52:55], v[16:19], a[240:247], v3
  v_smfmac_f32_16x16x64_bf16 v[56:59], v[16:19], v[160:167], v3
  v_smfmac_f32_16x16x64_bf16 v[60:63], v[16:19], v[216:223], v3
  v_smfmac_f32_16x16x64_bf16 v[36:39], v[20:23], a[24:31], v3
  v_smfmac_f32_16x16x64_bf16 v[40:43], v[20:23], a[80:87], v3
  v_smfmac_f32_16x16x64_bf16 v[44:47], v[20:23], a[136:143], v3
  v_smfmac_f32_16x16x64_bf16 v[48:51], v[20:23], a[192:199], v3
  v_smfmac_f32_16x16x64_bf16 v[52:55], v[20:23], a[248:255], v3
  v_smfmac_f32_16x16x64_bf16 v[56:59], v[20:23], v[168:175], v3
  v_smfmac_f32_16x16x64_bf16 v[60:63], v[20:23], v[224:231], v3
  s_branch cA_sc0_ph2
.p2align 6

cA_sc1_loop:
  s_add_u32 s23, s20, 4096
  s_add_u32 s21, s20, 25600
  v_mov_b32 v48, 0
  v_mov_b32 v49, 0
  v_mov_b32 v50, 0
  v_mov_b32 v51, 0
  v_mov_b32 v52, 0
  v_mov_b32 v53, 0
  v_mov_b32 v54, 0
  v_mov_b32 v55, 0
  v_mov_b32 v56, 0
  v_mov_b32 v57, 0
  v_mov_b32 v58, 0
  v_mov_b32 v59, 0
  v_mov_b32 v60, 0
  v_mov_b32 v61, 0
  v_mov_b32 v62, 0
  v_mov_b32 v63, 0
  v_mov_b32 v88, 0
  v_mov_b32 v89, 0
  v_mov_b32 v90, 0
  v_mov_b32 v91, 0
  v_mov_b32 v92, 0
  v_mov_b32 v93, 0
  v_mov_b32 v94, 0
  v_mov_b32 v95, 0
  v_mov_b32 v64, 0
  v_mov_b32 v65, 0
  s_mov_b32 s30, 0
  s_mov_b32 s62, 0
  s_waitcnt vmcnt(0)
  s_barrier
cA_sc1_ld:
  buffer_load_dwordx4 v[8:11], v2, s[8:11], s20 offen offset:0
  v_mov_b32 v36, 0
  v_mov_b32 v37, 0
  v_mov_b32 v38, 0
  v_mov_b32 v39, 0
  buffer_load_dwordx4 v[12:15], v2, s[8:11], s20 offen offset:1024
  v_mov_b32 v40, 0
  v_mov_b32 v41, 0
  v_mov_b32 v42, 0
  v_mov_b32 v43, 0
  buffer_load_dwordx4 v[16:19], v2, s[8:11], s20 offen offset:2048
  v_mov_b32 v44, 0
  v_mov_b32 v45, 0
  v_mov_b32 v46, 0
  v_mov_b32 v47, 0
  ds_read_b128 v[96:99], v117 offset:0
  ds_read_b128 v[100:103], v117 offset:1024
  ds_read_b128 v[104:107], v117 offset:14336
  ds_read_b128 v[108:111], v117 offset:15360
  s_waitcnt vmcnt(2)
  v_smfmac_f32_16x16x64_bf16 v[36:39], v[8:11], a[0:7], v3
  v_smfmac_f32_16x16x64_bf16 v[40:43], v[8:11], a[56:63], v3
  buffer_load_dwordx4 v[20:23], v2, s[8:11], s20 offen offset:3072
  v_smfmac_f32_16x16x64_bf16 v[44:47], v[8:11], a[112:119], v3
  v_smfmac_f32_16x16x64_bf16 v[48:51], v[8:11], a[168:175], v3
  v_smfmac_f32_16x16x64_bf16 v[52:55], v[8:11], a[224:231], v3
  buffer_load_dwordx4 v[24:27], v2, s[8:11], s23 offen offset:0
  v_smfmac_f32_16x16x64_bf16 v[56:59], v[8:11], v[144:151], v3
  v_smfmac_f32_16x16x64_bf16 v[60:63], v[8:11], v[200:207], v3
  s_waitcnt vmcnt(3)
  v_smfmac_f32_16x16x64_bf16 v[36:39], v[12:15], a[8:15], v3
  v_smfmac_f32_16x16x64_bf16 v[40:43], v[12:15], a[64:71], v3
  buffer_load_dwordx4 v[28:31], v2, s[8:11], s23 offen offset:1024
  v_smfmac_f32_16x16x64_bf16 v[44:47], v[12:15], a[120:127], v3
  v_smfmac_f32_16x16x64_bf16 v[48:51], v[12:15], a[176:183], v3
  v_smfmac_f32_16x16x64_bf16 v[52:55], v[12:15], a[232:239], v3
  buffer_load_dwordx4 v[32:35], v2, s[8:11], s23 offen offset:2048
  v_smfmac_f32_16x16x64_bf16 v[56:59], v[12:15], v[152:159], v3
  v_smfmac_f32_16x16x64_bf16 v[60:63], v[12:15], v[208:215], v3
  s_waitcnt vmcnt(4)
  v_smfmac_f32_16x16x64_bf16 v[36:39], v[16:19], a[16:23], v3
  v_smfmac_f32_16x16x64_bf16 v[40:43], v[16:19], a[72:79], v3
  v_smfmac_f32_16x16x64_bf16 v[44:47], v[16:19], a[128:135], v3
  v_smfmac_f32_16x16x64_bf16 v[48:51], v[16:19], a[184:191], v3
  v_smfmac_f32_16x16x64_bf16 v[52:55], v[16:19], a[240:247], v3
  v_smfmac_f32_16x16x64_bf16 v[56:59], v[16:19], v[160:167], v3
  v_smfmac_f32_16x16x64_bf16 v[60:63], v[16:19], v[216:223], v3
  s_waitcnt vmcnt(3)
  v_smfmac_f32_16x16x64_bf16 v[36:39], v[20:23], a[24:31], v3
  v_smfmac_f32_16x16x64_bf16 v[40:43], v[20:23], a[80:87], v3
  v_smfmac_f32_16x16x64_bf16 v[44:47], v[20:23], a[136:143], v3
  v_smfmac_f32_16x16x64_bf16 v[48:51], v[20:23], a[192:199], v3
  v_smfmac_f32_16x16x64_bf16 v[52:55], v[20:23], a[248:255], v3
  v_smfmac_f32_16x16x64_bf16 v[56:59], v[20:23], v[168:175], v3
  v_smfmac_f32_16x16x64_bf16 v[60:63], v[20:23], v[224:231], v3
  s_waitcnt vmcnt(0)
cA_sc1_ph2:
  v_smfmac_f32_16x16x64_bf16 v[60:63], v[24:27], v[232:239], v3
  ds_read_b128 v[16:19], v116 offset:2048
  ds_read_b128 v[20:23], v116 offset:3072
  v_smfmac_f32_16x16x64_bf16 v[60:63], v[28:31], v[240:247], v3
  buffer_load_dword v119, v0, s[8:11], s20 offen sc1
  v_smfmac_f32_16x16x64_bf16 v[60:63], v[32:35], v[248:255], v3
  v_mov_b32 v80, v26
  v_smfmac_f32_16x16x64_bf16 v[52:55], v[24:27], v[120:127], v3
  v_mov_b32 v81, v27
  v_smfmac_f32_16x16x64_bf16 v[52:55], v[28:31], v[128:135], v3
  v_mov_b32 v82, v32
  v_smfmac_f32_16x16x64_bf16 v[52:55], v[32:35], v[136:143], v3
  v_cvt_pk_bf16_f32 v66, v60, v61
  v_smfmac_f32_16x16x64_bf16 v[56:59], v[24:27], v[176:183], v3
  v_cvt_pk_bf16_f32 v67, v62, v63
  v_smfmac_f32_16x16x64_bf16 v[56:59], v[28:31], v[184:191], v3
  v_mov_b32 v83, v33
  v_mfma_f32_16x16x32_bf16 v[68:71], v[64:67], v[4:7], 0
  v_smfmac_f32_16x16x64_bf16 v[56:59], v[32:35], v[192:199], v3
  v_cvt_pk_bf16_f32 v64, v52, v53
  v_smfmac_f32_16x16x64_bf16 v[36:39], v[24:27], a[32:39], v3
  v_cvt_pk_bf16_f32 v65, v54, v55
  v_smfmac_f32_16x16x64_bf16 v[36:39], v[28:31], a[40:47], v3
  v_cvt_pk_bf16_f32 v78, v68, v69
  v_smfmac_f32_16x16x64_bf16 v[36:39], v[32:35], a[48:55], v3
  v_cvt_pk_bf16_f32 v79, v70, v71
  v_cvt_pk_bf16_f32 v66, v56, v57
  v_smfmac_f32_16x16x64_bf16 v[40:43], v[24:27], a[88:95], v3
  v_cvt_pk_bf16_f32 v67, v58, v59
  v_smfmac_f32_16x16x64_bf16 v[40:43], v[28:31], a[96:103], v3
  v_mfma_f32_16x16x32_bf16 v[72:75], v[64:67], v[4:7], 0
  ds_read_b128 v[52:55], v116 offset:16384
  ds_read_b128 v[56:59], v116 offset:17408
  v_smfmac_f32_16x16x64_bf16 v[40:43], v[32:35], a[104:111], v3
  v_cvt_pk_bf16_f32 v64, v36, v37
  v_smfmac_f32_16x16x64_bf16 v[44:47], v[24:27], a[144:151], v3
  v_cvt_pk_bf16_f32 v65, v38, v39
  v_smfmac_f32_16x16x64_bf16 v[44:47], v[28:31], a[152:159], v3
  v_cvt_pk_bf16_f32 v76, v72, v73
  v_smfmac_f32_16x16x64_bf16 v[44:47], v[32:35], a[160:167], v3
  v_cvt_pk_bf16_f32 v77, v74, v75
  v_cvt_pk_bf16_f32 v66, v40, v41
  v_smfmac_f32_16x16x64_bf16 v[48:51], v[24:27], a[200:207], v3
  v_cvt_pk_bf16_f32 v67, v42, v43
  v_smfmac_f32_16x16x64_bf16 v[48:51], v[28:31], a[208:215], v3
  v_mfma_f32_16x16x32_bf16 v[68:71], v[64:67], v[4:7], 0
  v_smfmac_f32_16x16x64_bf16 v[48:51], v[32:35], a[216:223], v3
  v_cvt_pk_bf16_f32 v64, v44, v45
  v_mfma_f32_16x16x32_bf16 v[84:87], v[80:83], v[76:79], 0
  v_cvt_pk_bf16_f32 v65, v46, v47
  s_waitcnt lgkmcnt(0)
  v_smfmac_f32_16x16x64_bf16 v[88:91], v[76:79], v[96:103], v3
  v_cvt_pk_bf16_f32 v60, v68, v69
  v_cvt_pk_bf16_f32 v61, v70, v71
  v_cvt_pk_bf16_f32 v66, v48, v49
  v_cvt_pk_bf16_f32 v67, v50, v51
  s_nop 1
  v_mfma_f32_16x16x32_bf16 v[72:75], v[64:67], v[4:7], 0
  v_smfmac_f32_16x16x64_bf16 v[92:95], v[76:79], v[104:111], v3
  s_nop 4
  v_cvt_pk_bf16_f32 v62, v72, v73
  v_cvt_pk_bf16_f32 v63, v74, v75
  s_nop 1
  v_mfma_f32_16x16x32_bf16 v[84:87], v[12:15], v[60:63], v[84:87]
  v_smfmac_f32_16x16x64_bf16 v[88:91], v[60:63], v[16:23], v3
  v_smfmac_f32_16x16x64_bf16 v[92:95], v[60:63], v[52:59], v3
  s_nop 1
  v_permlane32_swap_b32 v84, v86
  v_permlane32_swap_b32 v85, v87
  s_nop 0
  v_cmp_u_f32 vcc, v88, v89
  v_add_f32_dpp v84, v86, v84 row_ror:8 row_mask:0xf bank_mask:0xf
  v_add_f32_dpp v85, v87, v85 row_ror:8 row_mask:0xf bank_mask:0xf
  v_permlane32_swap_b32 v88, v92
  v_permlane32_swap_b32 v89, v93
  ds_write2_b32 v113, v84, v85 offset0:0 offset1:4
  v_permlane32_swap_b32 v90, v94
  v_permlane32_swap_b32 v91, v95
  v_add_f32 v88, v88, v92
  v_add_f32 v89, v89, v93
  v_add_f32 v90, v90, v94
  v_add_f32 v91, v91, v95
  ds_write2_b64 v112, v[88:89], v[90:91] offset0:0 offset1:128
  s_cbranch_vccnz cA_sc1_retry
cA_sc1_cont:
  s_waitcnt lgkmcnt(0)
  s_barrier
  ds_read_b128 v[36:39], v114
  ds_read_b128 v[44:47], v115
  s_waitcnt lgkmcnt(0)
  v_add_f32 v36, v36, v38
  v_add_f32 v37, v37, v39
  v_add_f32 v44, v44, v45
  v_add_f32 v46, v46, v47
  v_permlane32_swap_b32 v36, v37
  v_add_f32 v44, v44, v46
  v_add_f32 v36, v36, v37
  v_exp_f32 v49, v44
  v_exp_f32 v48, v36
  v_add_f32 v50, abs(v36), abs(v44)
  v_fma_f32 v39, v49, s37, v48
  v_cmp_ngt_f32 vcc, s56, v50
  v_cndmask_b32 v41, v48, v49, s[38:39]
  v_add_f32_dpp v39, v39, v39 quad_perm:[1,0,3,2] row_mask:0xf bank_mask:0xf
  v_cndmask_b32 v40, v49, v48, s[38:39]
  v_mov_b32_dpp v46, v41 quad_perm:[1,0,3,2] row_mask:0xf bank_mask:0xf
  v_add_f32_dpp v39, v39, v39 quad_perm:[2,3,0,1] row_mask:0xf bank_mask:0xf
  v_cndmask_b32 v42, v46, v40, s[38:39]
  v_cndmask_b32 v43, v40, v46, s[38:39]
  v_add_f32_dpp v39, v39, v39 row_half_mirror row_mask:0xf bank_mask:0xf
  s_cbranch_vccnz cA_sc1_slow
  s_nop 0
  v_add_f32_dpp v47, v39, v39 row_mirror row_mask:0xf bank_mask:0xf
  v_add_f32_dpp v39, v39, v39 row_mirror row_mask:0xf bank_mask:0xf
  s_nop 1
  v_permlane16_swap_b32 v39, v47
  v_add_f32 v39, v39, v47
  v_rcp_f32 v39, v39
  s_mov_b64 exec, s[28:29]
  v_mul_f32 v42, v42, v39
  v_mul_f32 v43, v43, v39
  v_cvt_pk_bf16_f32 v42, v42, v43
cA_sc1_pst:
  buffer_store_dword v42, v1, s[8:11], s20 offen
  s_mov_b64 exec, -1
  s_barrier
  s_add_u32 s24, s24, 28672
  s_add_u32 s35, s35, 28672
  s_xor_b32 s25, s25, 28672
  s_add_u32 m0, s25, 7168
  s_nop 0
  buffer_load_dwordx4 v2, s[8:11], s24 offen offset:0 sc1 lds
  buffer_load_dwordx4 v2, s[8:11], s24 offen offset:1024 sc1 lds
  buffer_load_dwordx4 v2, s[8:11], s24 offen offset:2048 sc1 lds
  buffer_load_dwordx4 v2, s[8:11], s24 offen offset:3072 sc1 lds
  s_add_u32 m0, s25, 11264
  s_add_u32 s22, s24, 4096
  buffer_load_dwordx4 v2, s[8:11], s22 offen offset:0 sc1 lds
  buffer_load_dwordx4 v2, s[8:11], s22 offen offset:1024 sc1 lds
  buffer_load_dwordx4 v2, s[8:11], s22 offen offset:2048 sc1 lds
  v_xor_b32 v116, 28672, v116
  v_add_u32 v117, s57, v117
  s_sub_u32 s57, 0, s57
  s_add_u32 s19, s19, 1
  s_mov_b32 s20, s21
  s_cmp_lt_u32 s19, 63
  s_cbranch_scc1 cA_sc1_loop
  s_branch cA_done
cA_sc1_slow:
  v_max_f32 v50, v36, v44
  s_nop 1
  v_max_f32_dpp v50, v50, v50 quad_perm:[1,0,3,2] row_mask:0xf bank_mask:0xf
  s_nop 1
  v_max_f32_dpp v50, v50, v50 quad_perm:[2,3,0,1] row_mask:0xf bank_mask:0xf
  s_nop 1
  v_max_f32_dpp v50, v50, v50 row_half_mirror row_mask:0xf bank_mask:0xf
  s_nop 1
  v_max_f32_dpp v50, v50, v50 row_mirror row_mask:0xf bank_mask:0xf
  v_mov_b32 v47, v50
  s_nop 1
  v_permlane16_swap_b32 v50, v47
  v_max_f32 v50, v50, v47
  v_sub_f32 v48, v36, v50
  v_sub_f32 v49, v44, v50
  v_exp_f32 v48, v48
  v_exp_f32 v49, v49
  s_add_u32 s31, s31, 0x100
  v_fma_f32 v39, v49, s37, v48
  v_cndmask_b32 v41, v48, v49, s[38:39]
  s_nop 0
  v_add_f32_dpp v39, v39, v39 quad_perm:[1,0,3,2] row_mask:0xf bank_mask:0xf
  v_cndmask_b32 v40, v49, v48, s[38:39]
  v_mov_b32_dpp v46, v41 quad_perm:[1,0,3,2] row_mask:0xf bank_mask:0xf
  v_add_f32_dpp v39, v39, v39 quad_perm:[2,3,0,1] row_mask:0xf bank_mask:0xf
  v_cndmask_b32 v42, v46, v40, s[38:39]
  v_cndmask_b32 v43, v40, v46, s[38:39]
  v_add_f32_dpp v39, v39, v39 row_half_mirror row_mask:0xf bank_mask:0xf
  s_nop 1
  v_add_f32_dpp v47, v39, v39 row_mirror row_mask:0xf bank_mask:0xf
  v_add_f32_dpp v39, v39, v39 row_mirror row_mask:0xf bank_mask:0xf
  s_nop 1
  v_permlane16_swap_b32 v39, v47
  v_add_f32 v39, v39, v47
  v_rcp_f32 v39, v39
  s_mov_b64 exec, s[28:29]
  v_mul_f32 v42, v42, v39
  v_mul_f32 v43, v43, v39
  v_cvt_pk_bf16_f32 v42, v42, v43
  v_min_u32 v42, -2, v42
  s_branch cA_sc1_pst
cA_sc1_retry:
  s_cmp_lg_u32 s62, 0
  s_cbranch_scc1 cA_sc1_cont
  s_waitcnt vmcnt(0) lgkmcnt(0)
cA_sc1_rv:
  buffer_load_dwordx4 v[8:11], v2, s[8:11], s20 offen offset:0 sc1
  buffer_load_dwordx4 v[12:15], v2, s[8:11], s20 offen offset:1024 sc1
  buffer_load_dwordx4 v[16:19], v2, s[8:11], s20 offen offset:2048 sc1
  buffer_load_dwordx4 v[20:23], v2, s[8:11], s20 offen offset:3072 sc1
  buffer_load_dwordx4 v[24:27], v2, s[8:11], s23 offen offset:0 sc1
  buffer_load_dwordx4 v[28:31], v2, s[8:11], s23 offen offset:1024 sc1
  buffer_load_dwordx4 v[32:35], v2, s[8:11], s23 offen offset:2048 sc1
  s_waitcnt vmcnt(0)
  v_max3_u32 v118, v8, v9, v10
  v_max3_u32 v118, v118, v11, v12
  v_max3_u32 v118, v118, v13, v14
  v_max3_u32 v118, v118, v15, v16
  v_max3_u32 v118, v118, v17, v18
  v_max3_u32 v118, v118, v19, v20
  v_max3_u32 v118, v118, v21, v22
  v_max3_u32 v118, v118, v23, v24
  v_max3_u32 v118, v118, v25, v26
  v_max3_u32 v118, v118, v27, v28
  v_max3_u32 v118, v118, v29, v30
  v_max3_u32 v118, v118, v31, v32
  v_max3_u32 v118, v118, v33, v34
  v_max_u32 v118, v118, v35
  v_cmp_eq_u32 vcc, -1, v118
  s_cbranch_vccz cA_sc1_rk
  s_add_u32 s30, s30, 1
  s_cmp_lt_u32 s30, 400000
  s_cbranch_scc1 cA_sc1_rv
  s_branch cA_abort
cA_sc1_rk:
  s_mov_b32 s62, 1
  v_mov_b32 v36, 0
  v_mov_b32 v37, 0
  v_mov_b32 v38, 0
  v_mov_b32 v39, 0
  v_mov_b32 v40, 0
  v_mov_b32 v41, 0
  v_mov_b32 v42, 0
  v_mov_b32 v43, 0
  v_mov_b32 v44, 0
  v_mov_b32 v45, 0
  v_mov_b32 v46, 0
  v_mov_b32 v47, 0
  v_mov_b32 v48, 0
  v_mov_b32 v49, 0
  v_mov_b32 v50, 0
  v_mov_b32 v51, 0
  v_mov_b32 v52, 0
  v_mov_b32 v53, 0
  v_mov_b32 v54, 0
  v_mov_b32 v55, 0
  v_mov_b32 v56, 0
  v_mov_b32 v57, 0
  v_mov_b32 v58, 0
  v_mov_b32 v59, 0
  v_mov_b32 v60, 0
  v_mov_b32 v61, 0
  v_mov_b32 v62, 0
  v_mov_b32 v63, 0
  v_mov_b32 v88, 0
  v_mov_b32 v89, 0
  v_mov_b32 v90, 0
  v_mov_b32 v91, 0
  v_mov_b32 v92, 0
  v_mov_b32 v93, 0
  v_mov_b32 v94, 0
  v_mov_b32 v95, 0
  v_mov_b32 v64, 0
  v_mov_b32 v65, 0
  s_add_u32 s31, s31, 1
  ds_read_b128 v[96:99], v117 offset:0
  ds_read_b128 v[100:103], v117 offset:1024
  ds_read_b128 v[104:107], v117 offset:14336
  ds_read_b128 v[108:111], v117 offset:15360
  v_smfmac_f32_16x16x64_bf16 v[36:39], v[8:11], a[0:7], v3
  v_smfmac_f32_16x16x64_bf16 v[40:43], v[8:11], a[56:63], v3
  v_smfmac_f32_16x16x64_bf16 v[44:47], v[8:11], a[112:119], v3
  v_smfmac_f32_16x16x64_bf16 v[48:51], v[8:11], a[168:175], v3
  v_smfmac_f32_16x16x64_bf16 v[52:55], v[8:11], a[224:231], v3
  v_smfmac_f32_16x16x64_bf16 v[56:59], v[8:11], v[144:151], v3
  v_smfmac_f32_16x16x64_bf16 v[60:63], v[8:11], v[200:207], v3
  v_smfmac_f32_16x16x64_bf16 v[36:39], v[12:15], a[8:15], v3
  v_smfmac_f32_16x16x64_bf16 v[40:43], v[12:15], a[64:71], v3
  v_smfmac_f32_16x16x64_bf16 v[44:47], v[12:15], a[120:127], v3
  v_smfmac_f32_16x16x64_bf16 v[48:51], v[12:15], a[176:183], v3
  v_smfmac_f32_16x16x64_bf16 v[52:55], v[12:15], a[232:239], v3
  v_smfmac_f32_16x16x64_bf16 v[56:59], v[12:15], v[152:159], v3
  v_smfmac_f32_16x16x64_bf16 v[60:63], v[12:15], v[208:215], v3
  v_smfmac_f32_16x16x64_bf16 v[36:39], v[16:19], a[16:23], v3
  v_smfmac_f32_16x16x64_bf16 v[40:43], v[16:19], a[72:79], v3
  v_smfmac_f32_16x16x64_bf16 v[44:47], v[16:19], a[128:135], v3
  v_smfmac_f32_16x16x64_bf16 v[48:51], v[16:19], a[184:191], v3
  v_smfmac_f32_16x16x64_bf16 v[52:55], v[16:19], a[240:247], v3
  v_smfmac_f32_16x16x64_bf16 v[56:59], v[16:19], v[160:167], v3
  v_smfmac_f32_16x16x64_bf16 v[60:63], v[16:19], v[216:223], v3
  v_smfmac_f32_16x16x64_bf16 v[36:39], v[20:23], a[24:31], v3
  v_smfmac_f32_16x16x64_bf16 v[40:43], v[20:23], a[80:87], v3
  v_smfmac_f32_16x16x64_bf16 v[44:47], v[20:23], a[136:143], v3
  v_smfmac_f32_16x16x64_bf16 v[48:51], v[20:23], a[192:199], v3
  v_smfmac_f32_16x16x64_bf16 v[52:55], v[20:23], a[248:255], v3
  v_smfmac_f32_16x16x64_bf16 v[56:59], v[20:23], v[168:175], v3
  v_smfmac_f32_16x16x64_bf16 v[60:63], v[20:23], v[224:231], v3
  s_branch cA_sc1_ph2
.p2align 6

cA_sc2_loop:
  s_add_u32 s23, s20, 4096
  s_add_u32 s21, s20, 25600
  v_mov_b32 v48, 0
  v_mov_b32 v49, 0
  v_mov_b32 v50, 0
  v_mov_b32 v51, 0
  v_mov_b32 v52, 0
  v_mov_b32 v53, 0
  v_mov_b32 v54, 0
  v_mov_b32 v55, 0
  v_mov_b32 v56, 0
  v_mov_b32 v57, 0
  v_mov_b32 v58, 0
  v_mov_b32 v59, 0
  v_mov_b32 v60, 0
  v_mov_b32 v61, 0
  v_mov_b32 v62, 0
  v_mov_b32 v63, 0
  v_mov_b32 v88, 0
  v_mov_b32 v89, 0
  v_mov_b32 v90, 0
  v_mov_b32 v91, 0
  v_mov_b32 v92, 0
  v_mov_b32 v93, 0
  v_mov_b32 v94, 0
  v_mov_b32 v95, 0
  v_mov_b32 v66, 0
  v_mov_b32 v67, 0
  s_mov_b32 s30, 0
  s_mov_b32 s62, 0
  s_waitcnt vmcnt(0)
  s_barrier
cA_sc2_ld:
  buffer_load_dwordx4 v[8:11], v2, s[8:11], s20 offen offset:0
  v_mov_b32 v36, 0
  v_mov_b32 v37, 0
  v_mov_b32 v38, 0
  v_mov_b32 v39, 0
  buffer_load_dwordx4 v[12:15], v2, s[8:11], s20 offen offset:1024
  v_mov_b32 v40, 0
  v_mov_b32 v41, 0
  v_mov_b32 v42, 0
  v_mov_b32 v43, 0
  buffer_load_dwordx4 v[16:19], v2, s[8:11], s20 offen offset:2048
  v_mov_b32 v44, 0
  v_mov_b32 v45, 0
  v_mov_b32 v46, 0
  v_mov_b32 v47, 0
  ds_read_b128 v[96:99], v117 offset:0
  ds_read_b128 v[100:103], v117 offset:1024
  ds_read_b128 v[104:107], v117 offset:14336
  ds_read_b128 v[108:111], v117 offset:15360
  s_waitcnt vmcnt(2)
  v_smfmac_f32_16x16x64_bf16 v[36:39], v[8:11], a[0:7], v3
  v_smfmac_f32_16x16x64_bf16 v[40:43], v[8:11], a[56:63], v3
  buffer_load_dwordx4 v[20:23], v2, s[8:11], s20 offen offset:3072
  v_smfmac_f32_16x16x64_bf16 v[44:47], v[8:11], a[112:119], v3
  v_smfmac_f32_16x16x64_bf16 v[48:51], v[8:11], a[168:175], v3
  v_smfmac_f32_16x16x64_bf16 v[52:55], v[8:11], a[224:231], v3
  buffer_load_dwordx4 v[24:27], v2, s[8:11], s23 offen offset:0
  v_smfmac_f32_16x16x64_bf16 v[56:59], v[8:11], v[144:151], v3
  v_smfmac_f32_16x16x64_bf16 v[60:63], v[8:11], v[200:207], v3
  s_waitcnt vmcnt(3)
  v_smfmac_f32_16x16x64_bf16 v[36:39], v[12:15], a[8:15], v3
  v_smfmac_f32_16x16x64_bf16 v[40:43], v[12:15], a[64:71], v3
  buffer_load_dwordx4 v[28:31], v2, s[8:11], s23 offen offset:1024
  v_smfmac_f32_16x16x64_bf16 v[44:47], v[12:15], a[120:127], v3
  v_smfmac_f32_16x16x64_bf16 v[48:51], v[12:15], a[176:183], v3
  v_smfmac_f32_16x16x64_bf16 v[52:55], v[12:15], a[232:239], v3
  buffer_load_dwordx4 v[32:35], v2, s[8:11], s23 offen offset:2048
  v_smfmac_f32_16x16x64_bf16 v[56:59], v[12:15], v[152:159], v3
  v_smfmac_f32_16x16x64_bf16 v[60:63], v[12:15], v[208:215], v3
  s_waitcnt vmcnt(4)
  v_smfmac_f32_16x16x64_bf16 v[36:39], v[16:19], a[16:23], v3
  v_smfmac_f32_16x16x64_bf16 v[40:43], v[16:19], a[72:79], v3
  v_smfmac_f32_16x16x64_bf16 v[44:47], v[16:19], a[128:135], v3
  v_smfmac_f32_16x16x64_bf16 v[48:51], v[16:19], a[184:191], v3
  v_smfmac_f32_16x16x64_bf16 v[52:55], v[16:19], a[240:247], v3
  v_smfmac_f32_16x16x64_bf16 v[56:59], v[16:19], v[160:167], v3
  v_smfmac_f32_16x16x64_bf16 v[60:63], v[16:19], v[216:223], v3
  s_waitcnt vmcnt(3)
  v_smfmac_f32_16x16x64_bf16 v[36:39], v[20:23], a[24:31], v3
  v_smfmac_f32_16x16x64_bf16 v[40:43], v[20:23], a[80:87], v3
  v_smfmac_f32_16x16x64_bf16 v[44:47], v[20:23], a[136:143], v3
  v_smfmac_f32_16x16x64_bf16 v[48:51], v[20:23], a[192:199], v3
  v_smfmac_f32_16x16x64_bf16 v[52:55], v[20:23], a[248:255], v3
  v_smfmac_f32_16x16x64_bf16 v[56:59], v[20:23], v[168:175], v3
  v_smfmac_f32_16x16x64_bf16 v[60:63], v[20:23], v[224:231], v3
  s_waitcnt vmcnt(0)
cA_sc2_ph2:
  v_smfmac_f32_16x16x64_bf16 v[60:63], v[24:27], v[232:239], v3
  ds_read_b128 v[8:11], v116 offset:4096
  ds_read_b128 v[12:15], v116 offset:5120
  v_smfmac_f32_16x16x64_bf16 v[60:63], v[28:31], v[240:247], v3
  buffer_load_dword v119, v0, s[8:11], s24 offen sc1
  v_smfmac_f32_16x16x64_bf16 v[60:63], v[32:35], v[248:255], v3
  v_mov_b32 v80, v28
  v_smfmac_f32_16x16x64_bf16 v[52:55], v[24:27], v[120:127], v3
  v_mov_b32 v81, v29
  v_smfmac_f32_16x16x64_bf16 v[52:55], v[28:31], v[128:135], v3
  v_mov_b32 v82, v34
  v_smfmac_f32_16x16x64_bf16 v[52:55], v[32:35], v[136:143], v3
  v_cvt_pk_bf16_f32 v64, v60, v61
  v_smfmac_f32_16x16x64_bf16 v[56:59], v[24:27], v[176:183], v3
  v_cvt_pk_bf16_f32 v65, v62, v63
  v_smfmac_f32_16x16x64_bf16 v[56:59], v[28:31], v[184:191], v3
  v_mov_b32 v83, v35
  v_mfma_f32_16x16x32_bf16 v[68:71], v[64:67], v[4:7], 0
  v_smfmac_f32_16x16x64_bf16 v[56:59], v[32:35], v[192:199], v3
  v_cvt_pk_bf16_f32 v64, v52, v53
  v_smfmac_f32_16x16x64_bf16 v[36:39], v[24:27], a[32:39], v3
  v_cvt_pk_bf16_f32 v65, v54, v55
  v_smfmac_f32_16x16x64_bf16 v[36:39], v[28:31], a[40:47], v3
  v_cvt_pk_bf16_f32 v78, v68, v69
  v_smfmac_f32_16x16x64_bf16 v[36:39], v[32:35], a[48:55], v3
  v_cvt_pk_bf16_f32 v79, v70, v71
  v_cvt_pk_bf16_f32 v66, v56, v57
  v_smfmac_f32_16x16x64_bf16 v[40:43], v[24:27], a[88:95], v3
  v_cvt_pk_bf16_f32 v67, v58, v59
  v_smfmac_f32_16x16x64_bf16 v[40:43], v[28:31], a[96:103], v3
  v_mfma_f32_16x16x32_bf16 v[72:75], v[64:67], v[4:7], 0
  ds_read_b128 v[52:55], v116 offset:18432
  ds_read_b128 v[56:59], v116 offset:19456
  v_smfmac_f32_16x16x64_bf16 v[40:43], v[32:35], a[104:111], v3
  v_cvt_pk_bf16_f32 v64, v36, v37
  v_smfmac_f32_16x16x64_bf16 v[44:47], v[24:27], a[144:151], v3
  v_cvt_pk_bf16_f32 v65, v38, v39
  v_smfmac_f32_16x16x64_bf16 v[44:47], v[28:31], a[152:159], v3
  v_cvt_pk_bf16_f32 v76, v72, v73
  v_smfmac_f32_16x16x64_bf16 v[44:47], v[32:35], a[160:167], v3
  v_cvt_pk_bf16_f32 v77, v74, v75
  v_cvt_pk_bf16_f32 v66, v40, v41
  v_smfmac_f32_16x16x64_bf16 v[48:51], v[24:27], a[200:207], v3
  v_cvt_pk_bf16_f32 v67, v42, v43
  v_smfmac_f32_16x16x64_bf16 v[48:51], v[28:31], a[208:215], v3
  v_mfma_f32_16x16x32_bf16 v[68:71], v[64:67], v[4:7], 0
  v_smfmac_f32_16x16x64_bf16 v[48:51], v[32:35], a[216:223], v3
  v_cvt_pk_bf16_f32 v64, v44, v45
  v_mfma_f32_16x16x32_bf16 v[84:87], v[80:83], v[76:79], 0
  v_cvt_pk_bf16_f32 v65, v46, v47
  s_waitcnt lgkmcnt(0)
  v_smfmac_f32_16x16x64_bf16 v[88:91], v[76:79], v[96:103], v3
  v_cvt_pk_bf16_f32 v60, v68, v69
  v_cvt_pk_bf16_f32 v61, v70, v71
  v_cvt_pk_bf16_f32 v66, v48, v49
  v_cvt_pk_bf16_f32 v67, v50, v51
  s_nop 1
  v_mfma_f32_16x16x32_bf16 v[72:75], v[64:67], v[4:7], 0
  v_smfmac_f32_16x16x64_bf16 v[92:95], v[76:79], v[104:111], v3
  s_nop 4
  v_cvt_pk_bf16_f32 v62, v72, v73
  v_cvt_pk_bf16_f32 v63, v74, v75
  s_nop 1
  v_mfma_f32_16x16x32_bf16 v[84:87], v[16:19], v[60:63], v[84:87]
  v_smfmac_f32_16x16x64_bf16 v[88:91], v[60:63], v[8:15], v3
  v_smfmac_f32_16x16x64_bf16 v[92:95], v[60:63], v[52:59], v3
  s_nop 1
  v_permlane32_swap_b32 v84, v86
  v_permlane32_swap_b32 v85, v87
  s_nop 0
  v_cmp_u_f32 vcc, v88, v89
  v_add_f32_dpp v84, v86, v84 row_ror:8 row_mask:0xf bank_mask:0xf
  v_add_f32_dpp v85, v87, v85 row_ror:8 row_mask:0xf bank_mask:0xf
  v_permlane32_swap_b32 v88, v92
  v_permlane32_swap_b32 v89, v93
  ds_write2_b32 v113, v84, v85 offset0:0 offset1:4
  v_permlane32_swap_b32 v90, v94
  v_permlane32_swap_b32 v91, v95
  v_add_f32 v88, v88, v92
  v_add_f32 v89, v89, v93
  v_add_f32 v90, v90, v94
  v_add_f32 v91, v91, v95
  ds_write2_b64 v112, v[88:89], v[90:91] offset0:0 offset1:128
  s_cbranch_vccnz cA_sc2_retry
cA_sc2_cont:
  s_waitcnt lgkmcnt(0)
  s_barrier
  ds_read_b128 v[36:39], v114
  ds_read_b128 v[44:47], v115
  v_lshl_add_u32 v56, v2, 3, s36
  s_waitcnt lgkmcnt(0)
  v_add_f32 v36, v36, v38
  v_add_f32 v37, v37, v39
  v_add_f32 v44, v44, v45
  s_mov_b64 exec, 65535
  buffer_store_dword v2, v56, s[8:11], s20 offen
  s_mov_b64 exec, -1
  v_add_f32 v46, v46, v47
  v_permlane32_swap_b32 v36, v37
  v_add_f32 v44, v44, v46
  v_add_f32 v36, v36, v37
  v_exp_f32 v49, v44
  v_exp_f32 v48, v36
  v_add_f32 v50, abs(v36), abs(v44)
  v_fma_f32 v39, v49, s37, v48
  v_cmp_ngt_f32 vcc, s56, v50
  v_cndmask_b32 v41, v48, v49, s[38:39]
  v_add_f32_dpp v39, v39, v39 quad_perm:[1,0,3,2] row_mask:0xf bank_mask:0xf
  v_cndmask_b32 v40, v49, v48, s[38:39]
  v_mov_b32_dpp v46, v41 quad_perm:[1,0,3,2] row_mask:0xf bank_mask:0xf
  v_add_f32_dpp v39, v39, v39 quad_perm:[2,3,0,1] row_mask:0xf bank_mask:0xf
  v_cndmask_b32 v42, v46, v40, s[38:39]
  v_cndmask_b32 v43, v40, v46, s[38:39]
  v_add_f32_dpp v39, v39, v39 row_half_mirror row_mask:0xf bank_mask:0xf
  s_cbranch_vccnz cA_sc2_slow
  s_nop 0
  v_add_f32_dpp v47, v39, v39 row_mirror row_mask:0xf bank_mask:0xf
  v_add_f32_dpp v39, v39, v39 row_mirror row_mask:0xf bank_mask:0xf
  s_nop 1
  v_permlane16_swap_b32 v39, v47
  v_add_f32 v39, v39, v47
  v_rcp_f32 v39, v39
  s_mov_b64 exec, s[28:29]
  v_mul_f32 v42, v42, v39
  v_mul_f32 v43, v43, v39
  v_cvt_pk_bf16_f32 v42, v42, v43
cA_sc2_pst:
  buffer_store_dword v42, v1, s[8:11], s20 offen
  s_mov_b64 exec, -1
  s_barrier
  s_add_u32 s24, s24, 28672
  s_add_u32 s35, s35, 28672
  s_xor_b32 s25, s25, 28672
  s_add_u32 m0, s25, 14336
  s_nop 0
  buffer_load_dwordx4 v2, s[8:11], s24 offen offset:0 sc1 lds
  buffer_load_dwordx4 v2, s[8:11], s24 offen offset:1024 sc1 lds
  buffer_load_dwordx4 v2, s[8:11], s24 offen offset:2048 sc1 lds
  buffer_load_dwordx4 v2, s[8:11], s24 offen offset:3072 sc1 lds
  s_add_u32 m0, s25, 18432
  s_add_u32 s22, s24, 4096
  buffer_load_dwordx4 v2, s[8:11], s22 offen offset:0 sc1 lds
  buffer_load_dwordx4 v2, s[8:11], s22 offen offset:1024 sc1 lds
  buffer_load_dwordx4 v2, s[8:11], s22 offen offset:2048 sc1 lds
  v_xor_b32 v116, 28672, v116
  v_add_u32 v117, s57, v117
  s_sub_u32 s57, 0, s57
  s_add_u32 s19, s19, 1
  s_mov_b32 s20, s21
  s_cmp_lt_u32 s19, 63
  s_cbranch_scc1 cA_sc2_loop
  s_branch cA_done
cA_sc2_slow:
  v_max_f32 v50, v36, v44
  s_nop 1
  v_max_f32_dpp v50, v50, v50 quad_perm:[1,0,3,2] row_mask:0xf bank_mask:0xf
  s_nop 1
  v_max_f32_dpp v50, v50, v50 quad_perm:[2,3,0,1] row_mask:0xf bank_mask:0xf
  s_nop 1
  v_max_f32_dpp v50, v50, v50 row_half_mirror row_mask:0xf bank_mask:0xf
  s_nop 1
  v_max_f32_dpp v50, v50, v50 row_mirror row_mask:0xf bank_mask:0xf
  v_mov_b32 v47, v50
  s_nop 1
  v_permlane16_swap_b32 v50, v47
  v_max_f32 v50, v50, v47
  v_sub_f32 v48, v36, v50
  v_sub_f32 v49, v44, v50
  v_exp_f32 v48, v48
  v_exp_f32 v49, v49
  s_add_u32 s31, s31, 0x100
  v_fma_f32 v39, v49, s37, v48
  v_cndmask_b32 v41, v48, v49, s[38:39]
  s_nop 0
  v_add_f32_dpp v39, v39, v39 quad_perm:[1,0,3,2] row_mask:0xf bank_mask:0xf
  v_cndmask_b32 v40, v49, v48, s[38:39]
  v_mov_b32_dpp v46, v41 quad_perm:[1,0,3,2] row_mask:0xf bank_mask:0xf
  v_add_f32_dpp v39, v39, v39 quad_perm:[2,3,0,1] row_mask:0xf bank_mask:0xf
  v_cndmask_b32 v42, v46, v40, s[38:39]
  v_cndmask_b32 v43, v40, v46, s[38:39]
  v_add_f32_dpp v39, v39, v39 row_half_mirror row_mask:0xf bank_mask:0xf
  s_nop 1
  v_add_f32_dpp v47, v39, v39 row_mirror row_mask:0xf bank_mask:0xf
  v_add_f32_dpp v39, v39, v39 row_mirror row_mask:0xf bank_mask:0xf
  s_nop 1
  v_permlane16_swap_b32 v39, v47
  v_add_f32 v39, v39, v47
  v_rcp_f32 v39, v39
  s_mov_b64 exec, s[28:29]
  v_mul_f32 v42, v42, v39
  v_mul_f32 v43, v43, v39
  v_cvt_pk_bf16_f32 v42, v42, v43
  v_min_u32 v42, -2, v42
  s_branch cA_sc2_pst
cA_sc2_retry:
  s_cmp_lg_u32 s62, 0
  s_cbranch_scc1 cA_sc2_cont
  s_waitcnt vmcnt(0) lgkmcnt(0)
cA_sc2_rv:
  buffer_load_dwordx4 v[8:11], v2, s[8:11], s20 offen offset:0 sc1
  buffer_load_dwordx4 v[12:15], v2, s[8:11], s20 offen offset:1024 sc1
  buffer_load_dwordx4 v[16:19], v2, s[8:11], s20 offen offset:2048 sc1
  buffer_load_dwordx4 v[20:23], v2, s[8:11], s20 offen offset:3072 sc1
  buffer_load_dwordx4 v[24:27], v2, s[8:11], s23 offen offset:0 sc1
  buffer_load_dwordx4 v[28:31], v2, s[8:11], s23 offen offset:1024 sc1
  buffer_load_dwordx4 v[32:35], v2, s[8:11], s23 offen offset:2048 sc1
  s_waitcnt vmcnt(0)
  v_max3_u32 v118, v8, v9, v10
  v_max3_u32 v118, v118, v11, v12
  v_max3_u32 v118, v118, v13, v14
  v_max3_u32 v118, v118, v15, v16
  v_max3_u32 v118, v118, v17, v18
  v_max3_u32 v118, v118, v19, v20
  v_max3_u32 v118, v118, v21, v22
  v_max3_u32 v118, v118, v23, v24
  v_max3_u32 v118, v118, v25, v26
  v_max3_u32 v118, v118, v27, v28
  v_max3_u32 v118, v118, v29, v30
  v_max3_u32 v118, v118, v31, v32
  v_max3_u32 v118, v118, v33, v34
  v_max_u32 v118, v118, v35
  v_cmp_eq_u32 vcc, -1, v118
  s_cbranch_vccz cA_sc2_rk
  s_add_u32 s30, s30, 1
  s_cmp_lt_u32 s30, 400000
  s_cbranch_scc1 cA_sc2_rv
  s_branch cA_abort
cA_sc2_rk:
  s_mov_b32 s62, 1
  v_mov_b32 v36, 0
  v_mov_b32 v37, 0
  v_mov_b32 v38, 0
  v_mov_b32 v39, 0
  v_mov_b32 v40, 0
  v_mov_b32 v41, 0
  v_mov_b32 v42, 0
  v_mov_b32 v43, 0
  v_mov_b32 v44, 0
  v_mov_b32 v45, 0
  v_mov_b32 v46, 0
  v_mov_b32 v47, 0
  v_mov_b32 v48, 0
  v_mov_b32 v49, 0
  v_mov_b32 v50, 0
  v_mov_b32 v51, 0
  v_mov_b32 v52, 0
  v_mov_b32 v53, 0
  v_mov_b32 v54, 0
  v_mov_b32 v55, 0
  v_mov_b32 v56, 0
  v_mov_b32 v57, 0
  v_mov_b32 v58, 0
  v_mov_b32 v59, 0
  v_mov_b32 v60, 0
  v_mov_b32 v61, 0
  v_mov_b32 v62, 0
  v_mov_b32 v63, 0
  v_mov_b32 v88, 0
  v_mov_b32 v89, 0
  v_mov_b32 v90, 0
  v_mov_b32 v91, 0
  v_mov_b32 v92, 0
  v_mov_b32 v93, 0
  v_mov_b32 v94, 0
  v_mov_b32 v95, 0
  v_mov_b32 v66, 0
  v_mov_b32 v67, 0
  s_add_u32 s31, s31, 1
  ds_read_b128 v[96:99], v117 offset:0
  ds_read_b128 v[100:103], v117 offset:1024
  ds_read_b128 v[104:107], v117 offset:14336
  ds_read_b128 v[108:111], v117 offset:15360
  v_smfmac_f32_16x16x64_bf16 v[36:39], v[8:11], a[0:7], v3
  v_smfmac_f32_16x16x64_bf16 v[40:43], v[8:11], a[56:63], v3
  v_smfmac_f32_16x16x64_bf16 v[44:47], v[8:11], a[112:119], v3
  v_smfmac_f32_16x16x64_bf16 v[48:51], v[8:11], a[168:175], v3
  v_smfmac_f32_16x16x64_bf16 v[52:55], v[8:11], a[224:231], v3
  v_smfmac_f32_16x16x64_bf16 v[56:59], v[8:11], v[144:151], v3
  v_smfmac_f32_16x16x64_bf16 v[60:63], v[8:11], v[200:207], v3
  v_smfmac_f32_16x16x64_bf16 v[36:39], v[12:15], a[8:15], v3
  v_smfmac_f32_16x16x64_bf16 v[40:43], v[12:15], a[64:71], v3
  v_smfmac_f32_16x16x64_bf16 v[44:47], v[12:15], a[120:127], v3
  v_smfmac_f32_16x16x64_bf16 v[48:51], v[12:15], a[176:183], v3
  v_smfmac_f32_16x16x64_bf16 v[52:55], v[12:15], a[232:239], v3
  v_smfmac_f32_16x16x64_bf16 v[56:59], v[12:15], v[152:159], v3
  v_smfmac_f32_16x16x64_bf16 v[60:63], v[12:15], v[208:215], v3
  v_smfmac_f32_16x16x64_bf16 v[36:39], v[16:19], a[16:23], v3
  v_smfmac_f32_16x16x64_bf16 v[40:43], v[16:19], a[72:79], v3
  v_smfmac_f32_16x16x64_bf16 v[44:47], v[16:19], a[128:135], v3
  v_smfmac_f32_16x16x64_bf16 v[48:51], v[16:19], a[184:191], v3
  v_smfmac_f32_16x16x64_bf16 v[52:55], v[16:19], a[240:247], v3
  v_smfmac_f32_16x16x64_bf16 v[56:59], v[16:19], v[160:167], v3
  v_smfmac_f32_16x16x64_bf16 v[60:63], v[16:19], v[216:223], v3
  v_smfmac_f32_16x16x64_bf16 v[36:39], v[20:23], a[24:31], v3
  v_smfmac_f32_16x16x64_bf16 v[40:43], v[20:23], a[80:87], v3
  v_smfmac_f32_16x16x64_bf16 v[44:47], v[20:23], a[136:143], v3
  v_smfmac_f32_16x16x64_bf16 v[48:51], v[20:23], a[192:199], v3
  v_smfmac_f32_16x16x64_bf16 v[52:55], v[20:23], a[248:255], v3
  v_smfmac_f32_16x16x64_bf16 v[56:59], v[20:23], v[168:175], v3
  v_smfmac_f32_16x16x64_bf16 v[60:63], v[20:23], v[224:231], v3
  s_branch cA_sc2_ph2
.p2align 6

cA_sc3_loop:
  s_add_u32 s23, s20, 4096
  s_add_u32 s21, s20, 25600
  v_mov_b32 v48, 0
  v_mov_b32 v49, 0
  v_mov_b32 v50, 0
  v_mov_b32 v51, 0
  v_mov_b32 v52, 0
  v_mov_b32 v53, 0
  v_mov_b32 v54, 0
  v_mov_b32 v55, 0
  v_mov_b32 v56, 0
  v_mov_b32 v57, 0
  v_mov_b32 v58, 0
  v_mov_b32 v59, 0
  v_mov_b32 v60, 0
  v_mov_b32 v61, 0
  v_mov_b32 v62, 0
  v_mov_b32 v63, 0
  v_mov_b32 v88, 0
  v_mov_b32 v89, 0
  v_mov_b32 v90, 0
  v_mov_b32 v91, 0
  v_mov_b32 v92, 0
  v_mov_b32 v93, 0
  v_mov_b32 v94, 0
  v_mov_b32 v95, 0
  v_mov_b32 v64, 0
  v_mov_b32 v65, 0
  s_mov_b32 s30, 0
  s_mov_b32 s62, 0
  s_waitcnt vmcnt(0)
  s_barrier
cA_sc3_ld:
  buffer_load_dwordx4 v[8:11], v2, s[8:11], s20 offen offset:0
  v_mov_b32 v36, 0
  v_mov_b32 v37, 0
  v_mov_b32 v38, 0
  v_mov_b32 v39, 0
  buffer_load_dwordx4 v[12:15], v2, s[8:11], s20 offen offset:1024
  v_mov_b32 v40, 0
  v_mov_b32 v41, 0
  v_mov_b32 v42, 0
  v_mov_b32 v43, 0
  buffer_load_dwordx4 v[16:19], v2, s[8:11], s20 offen offset:2048
  v_mov_b32 v44, 0
  v_mov_b32 v45, 0
  v_mov_b32 v46, 0
  v_mov_b32 v47, 0
  ds_read_b128 v[96:99], v117 offset:0
  ds_read_b128 v[100:103], v117 offset:1024
  ds_read_b128 v[104:107], v117 offset:14336
  ds_read_b128 v[108:111], v117 offset:15360
  s_waitcnt vmcnt(2)
  v_smfmac_f32_16x16x64_bf16 v[36:39], v[8:11], a[0:7], v3
  v_smfmac_f32_16x16x64_bf16 v[40:43], v[8:11], a[56:63], v3
  buffer_load_dwordx4 v[20:23], v2, s[8:11], s20 offen offset:3072
  v_smfmac_f32_16x16x64_bf16 v[44:47], v[8:11], a[112:119], v3
  v_smfmac_f32_16x16x64_bf16 v[48:51], v[8:11], a[168:175], v3
  v_smfmac_f32_16x16x64_bf16 v[52:55], v[8:11], a[224:231], v3
  buffer_load_dwordx4 v[24:27], v2, s[8:11], s23 offen offset:0
  v_smfmac_f32_16x16x64_bf16 v[56:59], v[8:11], v[144:151], v3
  v_smfmac_f32_16x16x64_bf16 v[60:63], v[8:11], v[200:207], v3
  s_waitcnt vmcnt(3)
  v_smfmac_f32_16x16x64_bf16 v[36:39], v[12:15], a[8:15], v3
  v_smfmac_f32_16x16x64_bf16 v[40:43], v[12:15], a[64:71], v3
  buffer_load_dwordx4 v[28:31], v2, s[8:11], s23 offen offset:1024
  v_smfmac_f32_16x16x64_bf16 v[44:47], v[12:15], a[120:127], v3
  v_smfmac_f32_16x16x64_bf16 v[48:51], v[12:15], a[176:183], v3
  v_smfmac_f32_16x16x64_bf16 v[52:55], v[12:15], a[232:239], v3
  buffer_load_dwordx4 v[32:35], v2, s[8:11], s23 offen offset:2048
  v_smfmac_f32_16x16x64_bf16 v[56:59], v[12:15], v[152:159], v3
  v_smfmac_f32_16x16x64_bf16 v[60:63], v[12:15], v[208:215], v3
  s_waitcnt vmcnt(4)
  v_smfmac_f32_16x16x64_bf16 v[36:39], v[16:19], a[16:23], v3
  v_smfmac_f32_16x16x64_bf16 v[40:43], v[16:19], a[72:79], v3
  v_smfmac_f32_16x16x64_bf16 v[44:47], v[16:19], a[128:135], v3
  v_smfmac_f32_16x16x64_bf16 v[48:51], v[16:19], a[184:191], v3
  v_smfmac_f32_16x16x64_bf16 v[52:55], v[16:19], a[240:247], v3
  v_smfmac_f32_16x16x64_bf16 v[56:59], v[16:19], v[160:167], v3
  v_smfmac_f32_16x16x64_bf16 v[60:63], v[16:19], v[216:223], v3
  s_waitcnt vmcnt(3)
  v_smfmac_f32_16x16x64_bf16 v[36:39], v[20:23], a[24:31], v3
  v_smfmac_f32_16x16x64_bf16 v[40:43], v[20:23], a[80:87], v3
  v_smfmac_f32_16x16x64_bf16 v[44:47], v[20:23], a[136:143], v3
  v_smfmac_f32_16x16x64_bf16 v[48:51], v[20:23], a[192:199], v3
  v_smfmac_f32_16x16x64_bf16 v[52:55], v[20:23], a[248:255], v3
  v_smfmac_f32_16x16x64_bf16 v[56:59], v[20:23], v[168:175], v3
  v_smfmac_f32_16x16x64_bf16 v[60:63], v[20:23], v[224:231], v3
  s_waitcnt vmcnt(0)
cA_sc3_ph2:
  v_smfmac_f32_16x16x64_bf16 v[60:63], v[24:27], v[232:239], v3
  ds_read_b128 v[8:11], v116 offset:6144
  ds_read_b128 v[12:15], v116 offset:7168
  v_smfmac_f32_16x16x64_bf16 v[60:63], v[28:31], v[240:247], v3
  v_smfmac_f32_16x16x64_bf16 v[60:63], v[32:35], v[248:255], v3
  v_mov_b32 v80, v30
  v_smfmac_f32_16x16x64_bf16 v[52:55], v[24:27], v[120:127], v3
  v_mov_b32 v81, v31
  v_smfmac_f32_16x16x64_bf16 v[52:55], v[28:31], v[128:135], v3
  v_mov_b32 v82, v34
  v_smfmac_f32_16x16x64_bf16 v[52:55], v[32:35], v[136:143], v3
  v_cvt_pk_bf16_f32 v66, v60, v61
  v_smfmac_f32_16x16x64_bf16 v[56:59], v[24:27], v[176:183], v3
  v_cvt_pk_bf16_f32 v67, v62, v63
  v_smfmac_f32_16x16x64_bf16 v[56:59], v[28:31], v[184:191], v3
  v_mov_b32 v83, v35
  v_mfma_f32_16x16x32_bf16 v[68:71], v[64:67], v[4:7], 0
  v_smfmac_f32_16x16x64_bf16 v[56:59], v[32:35], v[192:199], v3
  v_cvt_pk_bf16_f32 v64, v52, v53
  v_smfmac_f32_16x16x64_bf16 v[36:39], v[24:27], a[32:39], v3
  v_cvt_pk_bf16_f32 v65, v54, v55
  v_smfmac_f32_16x16x64_bf16 v[36:39], v[28:31], a[40:47], v3
  v_cvt_pk_bf16_f32 v78, v68, v69
  v_smfmac_f32_16x16x64_bf16 v[36:39], v[32:35], a[48:55], v3
  v_cvt_pk_bf16_f32 v79, v70, v71
  v_cvt_pk_bf16_f32 v66, v56, v57
  v_smfmac_f32_16x16x64_bf16 v[40:43], v[24:27], a[88:95], v3
  v_cvt_pk_bf16_f32 v67, v58, v59
  v_smfmac_f32_16x16x64_bf16 v[40:43], v[28:31], a[96:103], v3
  v_mfma_f32_16x16x32_bf16 v[72:75], v[64:67], v[4:7], 0
  ds_read_b128 v[52:55], v116 offset:20480
  ds_read_b128 v[56:59], v116 offset:21504
  v_smfmac_f32_16x16x64_bf16 v[40:43], v[32:35], a[104:111], v3
  v_cvt_pk_bf16_f32 v64, v36, v37
  v_smfmac_f32_16x16x64_bf16 v[44:47], v[24:27], a[144:151], v3
  v_cvt_pk_bf16_f32 v65, v38, v39
  v_smfmac_f32_16x16x64_bf16 v[44:47], v[28:31], a[152:159], v3
  v_cvt_pk_bf16_f32 v76, v72, v73
  v_smfmac_f32_16x16x64_bf16 v[44:47], v[32:35], a[160:167], v3
  v_cvt_pk_bf16_f32 v77, v74, v75
  v_cvt_pk_bf16_f32 v66, v40, v41
  v_smfmac_f32_16x16x64_bf16 v[48:51], v[24:27], a[200:207], v3
  v_cvt_pk_bf16_f32 v67, v42, v43
  v_smfmac_f32_16x16x64_bf16 v[48:51], v[28:31], a[208:215], v3
  v_mfma_f32_16x16x32_bf16 v[68:71], v[64:67], v[4:7], 0
  v_smfmac_f32_16x16x64_bf16 v[48:51], v[32:35], a[216:223], v3
  v_cvt_pk_bf16_f32 v64, v44, v45
  v_mfma_f32_16x16x32_bf16 v[84:87], v[80:83], v[76:79], 0
  v_cvt_pk_bf16_f32 v65, v46, v47
  s_waitcnt lgkmcnt(0)
  v_smfmac_f32_16x16x64_bf16 v[88:91], v[76:79], v[96:103], v3
  v_cvt_pk_bf16_f32 v60, v68, v69
  v_cvt_pk_bf16_f32 v61, v70, v71
  v_cvt_pk_bf16_f32 v66, v48, v49
  v_cvt_pk_bf16_f32 v67, v50, v51
  s_nop 1
  v_mfma_f32_16x16x32_bf16 v[72:75], v[64:67], v[4:7], 0
  v_smfmac_f32_16x16x64_bf16 v[92:95], v[76:79], v[104:111], v3
  s_nop 4
  v_cvt_pk_bf16_f32 v62, v72, v73
  v_cvt_pk_bf16_f32 v63, v74, v75
  s_nop 1
  v_mfma_f32_16x16x32_bf16 v[84:87], v[20:23], v[60:63], v[84:87]
  v_smfmac_f32_16x16x64_bf16 v[88:91], v[60:63], v[8:15], v3
  v_smfmac_f32_16x16x64_bf16 v[92:95], v[60:63], v[52:59], v3
  s_nop 1
  v_permlane32_swap_b32 v84, v86
  v_permlane32_swap_b32 v85, v87
  s_nop 0
  v_cmp_u_f32 vcc, v88, v89
  v_add_f32_dpp v84, v86, v84 row_ror:8 row_mask:0xf bank_mask:0xf
  v_add_f32_dpp v85, v87, v85 row_ror:8 row_mask:0xf bank_mask:0xf
  v_permlane32_swap_b32 v88, v92
  v_permlane32_swap_b32 v89, v93
  ds_write2_b32 v113, v84, v85 offset0:0 offset1:4
  v_permlane32_swap_b32 v90, v94
  v_permlane32_swap_b32 v91, v95
  v_add_f32 v88, v88, v92
  v_add_f32 v89, v89, v93
  v_add_f32 v90, v90, v94
  v_add_f32 v91, v91, v95
  ds_write2_b64 v112, v[88:89], v[90:91] offset0:0 offset1:128
  s_cbranch_vccnz cA_sc3_retry
cA_sc3_cont:
  s_waitcnt lgkmcnt(0)
  s_barrier
  ds_read_b128 v[36:39], v114
  ds_read_b128 v[44:47], v115
  s_waitcnt lgkmcnt(0)
  v_add_f32 v36, v36, v38
  v_add_f32 v37, v37, v39
  v_add_f32 v44, v44, v45
  v_add_f32 v46, v46, v47
  v_permlane32_swap_b32 v36, v37
  v_add_f32 v44, v44, v46
  v_add_f32 v36, v36, v37
  v_exp_f32 v49, v44
  v_exp_f32 v48, v36
  v_add_f32 v50, abs(v36), abs(v44)
  v_fma_f32 v39, v49, s37, v48
  v_cmp_ngt_f32 vcc, s56, v50
  v_cndmask_b32 v41, v48, v49, s[38:39]
  v_add_f32_dpp v39, v39, v39 quad_perm:[1,0,3,2] row_mask:0xf bank_mask:0xf
  v_cndmask_b32 v40, v49, v48, s[38:39]
  v_mov_b32_dpp v46, v41 quad_perm:[1,0,3,2] row_mask:0xf bank_mask:0xf
  v_add_f32_dpp v39, v39, v39 quad_perm:[2,3,0,1] row_mask:0xf bank_mask:0xf
  v_cndmask_b32 v42, v46, v40, s[38:39]
  v_cndmask_b32 v43, v40, v46, s[38:39]
  v_add_f32_dpp v39, v39, v39 row_half_mirror row_mask:0xf bank_mask:0xf
  s_cbranch_vccnz cA_sc3_slow
  s_nop 0
  v_add_f32_dpp v47, v39, v39 row_mirror row_mask:0xf bank_mask:0xf
  v_add_f32_dpp v39, v39, v39 row_mirror row_mask:0xf bank_mask:0xf
  s_nop 1
  v_permlane16_swap_b32 v39, v47
  v_add_f32 v39, v39, v47
  v_rcp_f32 v39, v39
  s_mov_b64 exec, s[28:29]
  v_mul_f32 v42, v42, v39
  v_mul_f32 v43, v43, v39
  v_cvt_pk_bf16_f32 v42, v42, v43
cA_sc3_pst:
  buffer_store_dword v42, v1, s[8:11], s20 offen
  s_mov_b64 exec, -1
  s_barrier
  s_add_u32 s24, s24, 28672
  s_add_u32 s35, s35, 28672
  s_xor_b32 s25, s25, 28672
  s_add_u32 m0, s25, 21504
  s_nop 0
  buffer_load_dwordx4 v2, s[8:11], s24 offen offset:0 sc1 lds
  buffer_load_dwordx4 v2, s[8:11], s24 offen offset:1024 sc1 lds
  buffer_load_dwordx4 v2, s[8:11], s24 offen offset:2048 sc1 lds
  buffer_load_dwordx4 v2, s[8:11], s24 offen offset:3072 sc1 lds
  s_add_u32 m0, s25, 25600
  s_add_u32 s22, s24, 4096
  buffer_load_dwordx4 v2, s[8:11], s22 offen offset:0 sc1 lds
  buffer_load_dwordx4 v2, s[8:11], s22 offen offset:1024 sc1 lds
  buffer_load_dwordx4 v2, s[8:11], s22 offen offset:2048 sc1 lds
  v_xor_b32 v116, 28672, v116
  v_add_u32 v117, s57, v117
  s_sub_u32 s57, 0, s57
  s_add_u32 s19, s19, 1
  s_mov_b32 s20, s21
  s_cmp_lt_u32 s19, 63
  s_cbranch_scc1 cA_sc3_loop
  s_branch cA_done
cA_sc3_slow:
  v_max_f32 v50, v36, v44
  s_nop 1
  v_max_f32_dpp v50, v50, v50 quad_perm:[1,0,3,2] row_mask:0xf bank_mask:0xf
  s_nop 1
  v_max_f32_dpp v50, v50, v50 quad_perm:[2,3,0,1] row_mask:0xf bank_mask:0xf
  s_nop 1
  v_max_f32_dpp v50, v50, v50 row_half_mirror row_mask:0xf bank_mask:0xf
  s_nop 1
  v_max_f32_dpp v50, v50, v50 row_mirror row_mask:0xf bank_mask:0xf
  v_mov_b32 v47, v50
  s_nop 1
  v_permlane16_swap_b32 v50, v47
  v_max_f32 v50, v50, v47
  v_sub_f32 v48, v36, v50
  v_sub_f32 v49, v44, v50
  v_exp_f32 v48, v48
  v_exp_f32 v49, v49
  s_add_u32 s31, s31, 0x100
  v_fma_f32 v39, v49, s37, v48
  v_cndmask_b32 v41, v48, v49, s[38:39]
  s_nop 0
  v_add_f32_dpp v39, v39, v39 quad_perm:[1,0,3,2] row_mask:0xf bank_mask:0xf
  v_cndmask_b32 v40, v49, v48, s[38:39]
  v_mov_b32_dpp v46, v41 quad_perm:[1,0,3,2] row_mask:0xf bank_mask:0xf
  v_add_f32_dpp v39, v39, v39 quad_perm:[2,3,0,1] row_mask:0xf bank_mask:0xf
  v_cndmask_b32 v42, v46, v40, s[38:39]
  v_cndmask_b32 v43, v40, v46, s[38:39]
  v_add_f32_dpp v39, v39, v39 row_half_mirror row_mask:0xf bank_mask:0xf
  s_nop 1
  v_add_f32_dpp v47, v39, v39 row_mirror row_mask:0xf bank_mask:0xf
  v_add_f32_dpp v39, v39, v39 row_mirror row_mask:0xf bank_mask:0xf
  s_nop 1
  v_permlane16_swap_b32 v39, v47
  v_add_f32 v39, v39, v47
  v_rcp_f32 v39, v39
  s_mov_b64 exec, s[28:29]
  v_mul_f32 v42, v42, v39
  v_mul_f32 v43, v43, v39
  v_cvt_pk_bf16_f32 v42, v42, v43
  v_min_u32 v42, -2, v42
  s_branch cA_sc3_pst
cA_sc3_retry:
  s_cmp_lg_u32 s62, 0
  s_cbranch_scc1 cA_sc3_cont
  s_waitcnt vmcnt(0) lgkmcnt(0)
cA_sc3_rv:
  buffer_load_dwordx4 v[8:11], v2, s[8:11], s20 offen offset:0 sc1
  buffer_load_dwordx4 v[12:15], v2, s[8:11], s20 offen offset:1024 sc1
  buffer_load_dwordx4 v[16:19], v2, s[8:11], s20 offen offset:2048 sc1
  buffer_load_dwordx4 v[20:23], v2, s[8:11], s20 offen offset:3072 sc1
  buffer_load_dwordx4 v[24:27], v2, s[8:11], s23 offen offset:0 sc1
  buffer_load_dwordx4 v[28:31], v2, s[8:11], s23 offen offset:1024 sc1
  buffer_load_dwordx4 v[32:35], v2, s[8:11], s23 offen offset:2048 sc1
  s_waitcnt vmcnt(0)
  v_max3_u32 v118, v8, v9, v10
  v_max3_u32 v118, v118, v11, v12
  v_max3_u32 v118, v118, v13, v14
  v_max3_u32 v118, v118, v15, v16
  v_max3_u32 v118, v118, v17, v18
  v_max3_u32 v118, v118, v19, v20
  v_max3_u32 v118, v118, v21, v22
  v_max3_u32 v118, v118, v23, v24
  v_max3_u32 v118, v118, v25, v26
  v_max3_u32 v118, v118, v27, v28
  v_max3_u32 v118, v118, v29, v30
  v_max3_u32 v118, v118, v31, v32
  v_max3_u32 v118, v118, v33, v34
  v_max_u32 v118, v118, v35
  v_cmp_eq_u32 vcc, -1, v118
  s_cbranch_vccz cA_sc3_rk
  s_add_u32 s30, s30, 1
  s_cmp_lt_u32 s30, 400000
  s_cbranch_scc1 cA_sc3_rv
  s_branch cA_abort
cA_sc3_rk:
  s_mov_b32 s62, 1
  v_mov_b32 v36, 0
  v_mov_b32 v37, 0
  v_mov_b32 v38, 0
  v_mov_b32 v39, 0
  v_mov_b32 v40, 0
  v_mov_b32 v41, 0
  v_mov_b32 v42, 0
  v_mov_b32 v43, 0
  v_mov_b32 v44, 0
  v_mov_b32 v45, 0
  v_mov_b32 v46, 0
  v_mov_b32 v47, 0
  v_mov_b32 v48, 0
  v_mov_b32 v49, 0
  v_mov_b32 v50, 0
  v_mov_b32 v51, 0
  v_mov_b32 v52, 0
  v_mov_b32 v53, 0
  v_mov_b32 v54, 0
  v_mov_b32 v55, 0
  v_mov_b32 v56, 0
  v_mov_b32 v57, 0
  v_mov_b32 v58, 0
  v_mov_b32 v59, 0
  v_mov_b32 v60, 0
  v_mov_b32 v61, 0
  v_mov_b32 v62, 0
  v_mov_b32 v63, 0
  v_mov_b32 v88, 0
  v_mov_b32 v89, 0
  v_mov_b32 v90, 0
  v_mov_b32 v91, 0
  v_mov_b32 v92, 0
  v_mov_b32 v93, 0
  v_mov_b32 v94, 0
  v_mov_b32 v95, 0
  v_mov_b32 v64, 0
  v_mov_b32 v65, 0
  s_add_u32 s31, s31, 1
  ds_read_b128 v[96:99], v117 offset:0
  ds_read_b128 v[100:103], v117 offset:1024
  ds_read_b128 v[104:107], v117 offset:14336
  ds_read_b128 v[108:111], v117 offset:15360
  v_smfmac_f32_16x16x64_bf16 v[36:39], v[8:11], a[0:7], v3
  v_smfmac_f32_16x16x64_bf16 v[40:43], v[8:11], a[56:63], v3
  v_smfmac_f32_16x16x64_bf16 v[44:47], v[8:11], a[112:119], v3
  v_smfmac_f32_16x16x64_bf16 v[48:51], v[8:11], a[168:175], v3
  v_smfmac_f32_16x16x64_bf16 v[52:55], v[8:11], a[224:231], v3
  v_smfmac_f32_16x16x64_bf16 v[56:59], v[8:11], v[144:151], v3
  v_smfmac_f32_16x16x64_bf16 v[60:63], v[8:11], v[200:207], v3
  v_smfmac_f32_16x16x64_bf16 v[36:39], v[12:15], a[8:15], v3
  v_smfmac_f32_16x16x64_bf16 v[40:43], v[12:15], a[64:71], v3
  v_smfmac_f32_16x16x64_bf16 v[44:47], v[12:15], a[120:127], v3
  v_smfmac_f32_16x16x64_bf16 v[48:51], v[12:15], a[176:183], v3
  v_smfmac_f32_16x16x64_bf16 v[52:55], v[12:15], a[232:239], v3
  v_smfmac_f32_16x16x64_bf16 v[56:59], v[12:15], v[152:159], v3
  v_smfmac_f32_16x16x64_bf16 v[60:63], v[12:15], v[208:215], v3
  v_smfmac_f32_16x16x64_bf16 v[36:39], v[16:19], a[16:23], v3
  v_smfmac_f32_16x16x64_bf16 v[40:43], v[16:19], a[72:79], v3
  v_smfmac_f32_16x16x64_bf16 v[44:47], v[16:19], a[128:135], v3
  v_smfmac_f32_16x16x64_bf16 v[48:51], v[16:19], a[184:191], v3
  v_smfmac_f32_16x16x64_bf16 v[52:55], v[16:19], a[240:247], v3
  v_smfmac_f32_16x16x64_bf16 v[56:59], v[16:19], v[160:167], v3
  v_smfmac_f32_16x16x64_bf16 v[60:63], v[16:19], v[216:223], v3
  v_smfmac_f32_16x16x64_bf16 v[36:39], v[20:23], a[24:31], v3
  v_smfmac_f32_16x16x64_bf16 v[40:43], v[20:23], a[80:87], v3
  v_smfmac_f32_16x16x64_bf16 v[44:47], v[20:23], a[136:143], v3
  v_smfmac_f32_16x16x64_bf16 v[48:51], v[20:23], a[192:199], v3
  v_smfmac_f32_16x16x64_bf16 v[52:55], v[20:23], a[248:255], v3
  v_smfmac_f32_16x16x64_bf16 v[56:59], v[20:23], v[168:175], v3
  v_smfmac_f32_16x16x64_bf16 v[60:63], v[20:23], v[224:231], v3
  s_branch cA_sc3_ph2
.p2align 6

cA_va0_loop:
  s_add_u32 s23, s20, 4096
  s_add_u32 s21, s20, 25600
  s_mov_b32 s30, 0
  s_cmp_lg_u32 s19, s38
  s_cbranch_scc1 cA_va0_vok
  s_branch cA_va0_voc
cA_va0_vow:
  s_nop 0
  buffer_load_dword v63, off, s[8:11], s35 sc1
  s_waitcnt vmcnt(0)
cA_va0_voc:
  v_readfirstlane_b32 s22, v63
  s_cmp_eq_u32 s22, 56
  s_cbranch_scc1 cA_va0_vod
  s_sleep 1
  s_add_u32 s30, s30, 1
  s_cmp_lt_u32 s30, 400000
  s_cbranch_scc1 cA_va0_vow
  s_branch cA_abort
cA_va0_vod:
  s_add_u32 s35, s35, 2048
  s_add_u32 s38, s19, 8
  s_and_b32 s38, s38, -8
  s_cmp_eq_u32 s19, 0
  s_cselect_b32 s38, 4, s38
cA_va0_vok:
  s_cmp_eq_u32 s19, 63
  s_cbranch_scc1 cA_done
  s_barrier
  s_add_u32 s22, s25, 0
  buffer_load_dwordx4 v[80:83], v6, s[8:11], s22 offen offset:0 sc1
  buffer_load_dwordx4 v[84:87], v6, s[8:11], s22 offen offset:1792 sc1
  s_add_u32 s22, s25, 3584
  buffer_load_dwordx4 v[88:91], v6, s[8:11], s22 offen offset:0 sc1
  buffer_load_dwordx4 v[92:95], v6, s[8:11], s22 offen offset:1792 sc1
  s_add_u32 s22, s25, 7168
  buffer_load_dwordx4 v[96:99], v6, s[8:11], s22 offen offset:0 sc1
  buffer_load_dwordx4 v[100:103], v6, s[8:11], s22 offen offset:1792 sc1
  s_add_u32 s22, s25, 10752
  buffer_load_dwordx4 v[104:107], v6, s[8:11], s22 offen offset:0 sc1
  buffer_load_dwordx4 v[108:111], v6, s[8:11], s22 offen offset:1792 sc1
  s_add_u32 s22, s25, 14336
  buffer_load_dwordx4 v[112:115], v6, s[8:11], s22 offen offset:0 sc1
  buffer_load_dwordx4 v[116:119], v6, s[8:11], s22 offen offset:1792 sc1
  s_add_u32 s22, s25, 17920
  buffer_load_dwordx4 v[120:123], v6, s[8:11], s22 offen offset:0 sc1
  buffer_load_dwordx4 v[124:127], v6, s[8:11], s22 offen offset:1792 sc1
  s_add_u32 s22, s25, 21504
  buffer_load_dwordx4 v[128:131], v6, s[8:11], s22 offen offset:0 sc1
  buffer_load_dwordx4 v[132:135], v6, s[8:11], s22 offen offset:1792 sc1
  s_add_u32 s22, s25, 25088
  buffer_load_dwordx4 v[136:139], v6, s[8:11], s22 offen offset:0 sc1
  buffer_load_dwordx4 v[140:143], v6, s[8:11], s22 offen offset:1792 sc1
  s_add_u32 s22, s19, 1
  s_cmp_lg_u32 s22, s38
  s_cbranch_scc1 cA_va0_nk
  buffer_load_dword v63, off, s[8:11], s35 sc1
cA_va0_nk:
  s_barrier
  ds_read_b128 v[8:11], v2 offset:8192
  ds_read_b128 v[12:15], v2 offset:9216
  ds_read_b128 v[16:19], v2 offset:10240
  ds_read_b128 v[20:23], v2 offset:11264
  ds_read_b128 v[24:27], v2 offset:12288
  ds_read_b128 v[28:31], v2 offset:13312
  ds_read_b128 v[32:35], v2 offset:14336
  s_waitcnt lgkmcnt(0)
  v_smfmac_f32_16x16x64_bf16 v[36:39], v[8:11], a[0:7], v3
  v_smfmac_f32_16x16x64_bf16 v[36:39], v[12:15], a[8:15], v3
  v_smfmac_f32_16x16x64_bf16 v[36:39], v[16:19], a[16:23], v3
  v_smfmac_f32_16x16x64_bf16 v[36:39], v[20:23], a[24:31], v3
  v_smfmac_f32_16x16x64_bf16 v[36:39], v[24:27], a[32:39], v3
  v_smfmac_f32_16x16x64_bf16 v[36:39], v[28:31], a[40:47], v3
  v_smfmac_f32_16x16x64_bf16 v[36:39], v[32:35], a[48:55], v3
  v_smfmac_f32_16x16x64_bf16 v[40:43], v[8:11], a[56:63], v3
  v_smfmac_f32_16x16x64_bf16 v[40:43], v[12:15], a[64:71], v3
  v_smfmac_f32_16x16x64_bf16 v[40:43], v[16:19], a[72:79], v3
  v_smfmac_f32_16x16x64_bf16 v[40:43], v[20:23], a[80:87], v3
  v_smfmac_f32_16x16x64_bf16 v[40:43], v[24:27], a[88:95], v3
  v_smfmac_f32_16x16x64_bf16 v[40:43], v[28:31], a[96:103], v3
  v_smfmac_f32_16x16x64_bf16 v[40:43], v[32:35], a[104:111], v3
  v_smfmac_f32_16x16x64_bf16 v[44:47], v[8:11], a[112:119], v3
  v_smfmac_f32_16x16x64_bf16 v[44:47], v[12:15], a[120:127], v3
  v_smfmac_f32_16x16x64_bf16 v[44:47], v[16:19], a[128:135], v3
  v_smfmac_f32_16x16x64_bf16 v[44:47], v[20:23], a[136:143], v3
  v_permlane32_swap_b32 v36, v40
  v_smfmac_f32_16x16x64_bf16 v[44:47], v[24:27], a[144:151], v3
  v_permlane32_swap_b32 v37, v41
  v_smfmac_f32_16x16x64_bf16 v[44:47], v[28:31], a[152:159], v3
  v_permlane32_swap_b32 v38, v42
  v_smfmac_f32_16x16x64_bf16 v[44:47], v[32:35], a[160:167], v3
  v_permlane32_swap_b32 v39, v43
  v_smfmac_f32_16x16x64_bf16 v[48:51], v[8:11], a[168:175], v3
  v_add_f32 v36, v36, v40
  v_smfmac_f32_16x16x64_bf16 v[48:51], v[12:15], a[176:183], v3
  v_add_f32 v37, v37, v41
  v_smfmac_f32_16x16x64_bf16 v[48:51], v[16:19], a[184:191], v3
  v_add_f32 v38, v38, v42
  v_smfmac_f32_16x16x64_bf16 v[48:51], v[20:23], a[192:199], v3
  v_add_f32 v39, v39, v43
  v_smfmac_f32_16x16x64_bf16 v[48:51], v[24:27], a[200:207], v3
  v_cvt_pk_bf16_f32 v40, v36, v37
  v_smfmac_f32_16x16x64_bf16 v[48:51], v[28:31], a[208:215], v3
  v_cvt_pk_bf16_f32 v41, v38, v39
  v_smfmac_f32_16x16x64_bf16 v[48:51], v[32:35], a[216:223], v3
  ds_write2_b32 v60, v40, v41 offset0:0 offset1:2
  v_smfmac_f32_16x16x64_bf16 v[52:55], v[8:11], a[224:231], v3
  v_smfmac_f32_16x16x64_bf16 v[52:55], v[12:15], a[232:239], v3
  v_smfmac_f32_16x16x64_bf16 v[52:55], v[16:19], a[240:247], v3
  v_smfmac_f32_16x16x64_bf16 v[52:55], v[20:23], a[248:255], v3
  v_permlane32_swap_b32 v44, v48
  v_smfmac_f32_16x16x64_bf16 v[52:55], v[24:27], v[176:183], v3
  v_permlane32_swap_b32 v45, v49
  v_smfmac_f32_16x16x64_bf16 v[52:55], v[28:31], v[184:191], v3
  v_permlane32_swap_b32 v46, v50
  v_smfmac_f32_16x16x64_bf16 v[52:55], v[32:35], v[192:199], v3
  v_permlane32_swap_b32 v47, v51
  v_smfmac_f32_16x16x64_bf16 v[56:59], v[8:11], v[200:207], v3
  v_add_f32 v44, v44, v48
  v_smfmac_f32_16x16x64_bf16 v[56:59], v[12:15], v[208:215], v3
  v_add_f32 v45, v45, v49
  v_smfmac_f32_16x16x64_bf16 v[56:59], v[16:19], v[216:223], v3
  v_add_f32 v46, v46, v50
  v_smfmac_f32_16x16x64_bf16 v[56:59], v[20:23], v[224:231], v3
  v_add_f32 v47, v47, v51
  v_smfmac_f32_16x16x64_bf16 v[56:59], v[24:27], v[232:239], v3
  v_cvt_pk_bf16_f32 v48, v44, v45
  v_smfmac_f32_16x16x64_bf16 v[56:59], v[28:31], v[240:247], v3
  v_cvt_pk_bf16_f32 v49, v46, v47
  v_smfmac_f32_16x16x64_bf16 v[56:59], v[32:35], v[248:255], v3
  ds_write2_b32 v61, v48, v49 offset0:0 offset1:2
  s_nop 6
  v_permlane32_swap_b32 v52, v56
  v_permlane32_swap_b32 v53, v57
  v_permlane32_swap_b32 v54, v58
  v_permlane32_swap_b32 v55, v59
  v_add_f32 v52, v52, v56
  v_add_f32 v53, v53, v57
  v_add_f32 v54, v54, v58
  v_add_f32 v55, v55, v59
  v_cvt_pk_bf16_f32 v56, v52, v53
  v_cvt_pk_bf16_f32 v57, v54, v55
  ds_write2_b32 v62, v56, v57 offset0:0 offset1:2
  s_cmp_eq_u32 s19, 63
  s_cbranch_scc1 cA_va0_last
  s_add_u32 s22, s20, 9216
  s_add_u32 s34, s20, 13312
  s_add_u32 s36, s20, 7168
  s_mov_b32 s37, 0
  v_mov_b32 v156, 0
  v_mov_b32 v157, 0
  v_mov_b32 v158, 0
  v_mov_b32 v159, 0
  buffer_load_dword v164, v4, s[8:11], s20 offen sc1
  s_nop 7
  buffer_load_dword v165, v4, s[8:11], s20 offen sc1
  s_nop 7
  buffer_load_dword v166, v4, s[8:11], s20 offen sc1
  s_nop 7
  buffer_load_dword v167, v4, s[8:11], s20 offen sc1
  s_nop 7
  buffer_load_dword v168, v4, s[8:11], s20 offen sc1
cA_va0_fw_l:
  s_waitcnt vmcnt(4)
  v_cmp_eq_u32 vcc, -1, v164
  s_cbranch_vccz cA_va0_fw_d
  buffer_load_dword v164, v4, s[8:11], s20 offen sc1
  s_waitcnt vmcnt(4)
  v_cmp_eq_u32 vcc, -1, v165
  s_cbranch_vccz cA_va0_fw_d
  buffer_load_dword v165, v4, s[8:11], s20 offen sc1
  s_waitcnt vmcnt(4)
  v_cmp_eq_u32 vcc, -1, v166
  s_cbranch_vccz cA_va0_fw_d
  buffer_load_dword v166, v4, s[8:11], s20 offen sc1
  s_waitcnt vmcnt(4)
  v_cmp_eq_u32 vcc, -1, v167
  s_cbranch_vccz cA_va0_fw_d
  buffer_load_dword v167, v4, s[8:11], s20 offen sc1
  s_waitcnt vmcnt(4)
  v_cmp_eq_u32 vcc, -1, v168
  s_cbranch_vccz cA_va0_fw_d
  buffer_load_dword v168, v4, s[8:11], s20 offen sc1
  s_add_u32 s30, s30, 1
  s_cmp_lt_u32 s30, 400000
  s_cbranch_scc1 cA_va0_fw_l
  s_branch cA_abort
cA_va0_fw_d:
  s_waitcnt lgkmcnt(0)
  buffer_load_dwordx4 v[8:11], v5, s[8:11], s22 offen offset:0
  v_mov_b32 v36, 0
  v_mov_b32 v37, 0
  v_mov_b32 v38, 0
  buffer_load_dwordx4 v[12:15], v5, s[8:11], s22 offen offset:1024
  v_mov_b32 v39, 0
  v_mov_b32 v40, 0
  v_mov_b32 v41, 0
  buffer_load_dwordx4 v[16:19], v5, s[8:11], s22 offen offset:2048
  v_mov_b32 v42, 0
  v_mov_b32 v43, 0
  v_mov_b32 v44, 0
  buffer_load_dwordx4 v[20:23], v5, s[8:11], s22 offen offset:3072
  v_mov_b32 v45, 0
  v_mov_b32 v46, 0
  v_mov_b32 v47, 0
  buffer_load_dwordx4 v[24:27], v5, s[8:11], s34 offen offset:0
  v_mov_b32 v48, 0
  v_mov_b32 v49, 0
  v_mov_b32 v50, 0
  buffer_load_dwordx4 v[28:31], v5, s[8:11], s34 offen offset:1024
  v_mov_b32 v51, 0
  v_mov_b32 v52, 0
  v_mov_b32 v53, 0
  buffer_load_dwordx4 v[32:35], v5, s[8:11], s34 offen offset:2048
  v_mov_b32 v54, 0
  v_mov_b32 v55, 0
  v_mov_b32 v56, 0
  buffer_load_dwordx4 v[144:147], v5, s[8:11], s34 offen offset:3072
  v_mov_b32 v57, 0
  v_mov_b32 v58, 0
  v_mov_b32 v59, 0
  buffer_load_dwordx4 v[148:151], v2, s[8:11], s36 offen offset:0
  buffer_load_dwordx4 v[152:155], v2, s[8:11], s36 offen offset:1024
  s_barrier
  ds_read_b128 v[64:67], v2 offset:0
  ds_read_b128 v[68:71], v2 offset:1024
  ds_read_b128 v[72:75], v2 offset:2048
  ds_read_b128 v[76:79], v2 offset:3072
  s_waitcnt vmcnt(9)
  v_smfmac_f32_16x16x64_bf16 v[156:159], v[8:11], v[80:87], v0
  s_waitcnt vmcnt(8)
  v_smfmac_f32_16x16x64_bf16 v[156:159], v[12:15], v[88:95], v0
  s_waitcnt vmcnt(7)
  v_smfmac_f32_16x16x64_bf16 v[156:159], v[16:19], v[96:103], v0
  s_waitcnt vmcnt(6)
  v_smfmac_f32_16x16x64_bf16 v[156:159], v[20:23], v[104:111], v0
  s_waitcnt vmcnt(5)
  v_smfmac_f32_16x16x64_bf16 v[156:159], v[24:27], v[112:119], v0
  s_mov_b32 exec_hi, 0
  buffer_store_dword v2, v7, s[8:11], s21 offen
  s_mov_b64 exec, -1
  s_waitcnt vmcnt(5)
  v_smfmac_f32_16x16x64_bf16 v[156:159], v[28:31], v[120:127], v0
  s_waitcnt vmcnt(4)
  v_smfmac_f32_16x16x64_bf16 v[156:159], v[32:35], v[128:135], v0
  s_waitcnt vmcnt(3)
  v_smfmac_f32_16x16x64_bf16 v[156:159], v[144:147], v[136:143], v0
  s_waitcnt vmcnt(2) lgkmcnt(0)
  v_smfmac_f32_16x16x64_bf16 v[156:159], v[148:151], v[64:71], v0
  s_waitcnt vmcnt(1)
  v_smfmac_f32_16x16x64_bf16 v[156:159], v[152:155], v[72:79], v0
cA_va0_ep:
  s_nop 7
  v_add_f32 v160, v156, v157
  v_add_f32 v161, v158, v159
  v_cmp_u_f32 vcc, v160, v161
  v_mov_b32_dpp v162, v160 row_ror:8 row_mask:0xf bank_mask:0xf
  v_mov_b32_dpp v160, v161 row_ror:8 row_mask:0xf bank_mask:0xc
  s_cbranch_vccnz cA_va0_rp
  v_mov_b32_dpp v161, v162 quad_perm:[0,1,2,3] row_mask:0xf bank_mask:0x3
  v_cvt_pk_bf16_f32 v160, v160, v161
cA_va0_pc:
  buffer_store_dword v160, v1, s[8:11], s21 offen
  s_cmp_lg_u32 s19, 62
  s_cbranch_scc1 cA_va0_nl
  s_mov_b32 s22, 88519680
  buffer_store_dword v160, v1, s[8:11], s22 offen sc1
  s_mov_b64 exec, -1
  s_branch cA_done
cA_va0_nl:
  s_mov_b64 exec, -1
  s_add_u32 s25, s25, 28672
  s_add_u32 s19, s19, 1
  s_mov_b32 s20, s21
  s_branch cA_va0_loop
cA_va0_last:
  s_waitcnt lgkmcnt(0)
  s_barrier
  s_branch cA_done
cA_va0_rp:
  s_cmp_eq_u32 s37, 0
  s_cbranch_scc1 cA_va0_rv
  v_mov_b32_dpp v161, v162 quad_perm:[0,1,2,3] row_mask:0xf bank_mask:0x3
  v_cvt_pk_bf16_f32 v160, v160, v161
  v_min_u32 v160, -2, v160
  s_branch cA_va0_pc
cA_va0_rv:
  buffer_load_dwordx4 v[8:11], v5, s[8:11], s22 offen offset:0 sc1
  buffer_load_dwordx4 v[12:15], v5, s[8:11], s22 offen offset:1024 sc1
  buffer_load_dwordx4 v[16:19], v5, s[8:11], s22 offen offset:2048 sc1
  buffer_load_dwordx4 v[20:23], v5, s[8:11], s22 offen offset:3072 sc1
  buffer_load_dwordx4 v[24:27], v5, s[8:11], s34 offen offset:0 sc1
  buffer_load_dwordx4 v[28:31], v5, s[8:11], s34 offen offset:1024 sc1
  buffer_load_dwordx4 v[32:35], v5, s[8:11], s34 offen offset:2048 sc1
  buffer_load_dwordx4 v[144:147], v5, s[8:11], s34 offen offset:3072 sc1
  buffer_load_dwordx4 v[148:151], v2, s[8:11], s36 offen offset:0 sc1
  buffer_load_dwordx4 v[152:155], v2, s[8:11], s36 offen offset:1024 sc1
  s_waitcnt vmcnt(0)
  v_max3_u32 v175, v8, v9, v10
  v_max3_u32 v175, v175, v11, v12
  v_max3_u32 v175, v175, v13, v14
  v_max3_u32 v175, v175, v15, v16
  v_max3_u32 v175, v175, v17, v18
  v_max3_u32 v175, v175, v19, v20
  v_max3_u32 v175, v175, v21, v22
  v_max3_u32 v175, v175, v23, v24
  v_max3_u32 v175, v175, v25, v26
  v_max3_u32 v175, v175, v27, v28
  v_max3_u32 v175, v175, v29, v30
  v_max3_u32 v175, v175, v31, v32
  v_max3_u32 v175, v175, v33, v34
  v_max3_u32 v175, v175, v35, v144
  v_max3_u32 v175, v175, v145, v146
  v_max3_u32 v175, v175, v147, v148
  v_max3_u32 v175, v175, v149, v150
  v_max3_u32 v175, v175, v151, v152
  v_max3_u32 v175, v175, v153, v154
  v_max_u32 v175, v175, v155
  v_cmp_eq_u32 vcc, -1, v175
  s_cbranch_vccz cA_va0_rk
  s_add_u32 s30, s30, 1
  s_cmp_lt_u32 s30, 400000
  s_cbranch_scc1 cA_va0_rv
  s_branch cA_abort
cA_va0_rk:
  s_mov_b32 s37, 1
  s_add_u32 s31, s31, 0x10000
  v_mov_b32 v156, 0
  v_mov_b32 v157, 0
  v_mov_b32 v158, 0
  v_mov_b32 v159, 0
  s_nop 1
  v_smfmac_f32_16x16x64_bf16 v[156:159], v[8:11], v[80:87], v0
  v_smfmac_f32_16x16x64_bf16 v[156:159], v[12:15], v[88:95], v0
  v_smfmac_f32_16x16x64_bf16 v[156:159], v[16:19], v[96:103], v0
  v_smfmac_f32_16x16x64_bf16 v[156:159], v[20:23], v[104:111], v0
  v_smfmac_f32_16x16x64_bf16 v[156:159], v[24:27], v[112:119], v0
  v_smfmac_f32_16x16x64_bf16 v[156:159], v[28:31], v[120:127], v0
  v_smfmac_f32_16x16x64_bf16 v[156:159], v[32:35], v[128:135], v0
  v_smfmac_f32_16x16x64_bf16 v[156:159], v[144:147], v[136:143], v0
  v_smfmac_f32_16x16x64_bf16 v[156:159], v[148:151], v[64:71], v0
  v_smfmac_f32_16x16x64_bf16 v[156:159], v[152:155], v[72:79], v0
  s_nop 7
  s_branch cA_va0_ep
.p2align 6

cA_va1_loop:
  s_add_u32 s23, s20, 4096
  s_add_u32 s21, s20, 25600
  s_mov_b32 s30, 0
  s_cmp_lg_u32 s19, s38
  s_cbranch_scc1 cA_va1_vok
  s_branch cA_va1_voc
cA_va1_vow:
  buffer_load_dword v63, off, s[8:11], s35 sc1
  s_waitcnt vmcnt(0)
cA_va1_voc:
  v_readfirstlane_b32 s22, v63
  s_cmp_eq_u32 s22, 56
  s_cbranch_scc1 cA_va1_vod
  s_sleep 1
  s_add_u32 s30, s30, 1
  s_cmp_lt_u32 s30, 400000
  s_cbranch_scc1 cA_va1_vow
  s_branch cA_abort
cA_va1_vod:
  s_add_u32 s35, s35, 2048
  s_add_u32 s38, s19, 8
  s_and_b32 s38, s38, -8
  s_cmp_eq_u32 s19, 0
  s_cselect_b32 s38, 4, s38
cA_va1_vok:
  s_cmp_eq_u32 s19, 63
  s_cbranch_scc1 cA_done
  s_barrier
  s_add_u32 s22, s25, 0
  buffer_load_dwordx4 v[80:83], v6, s[8:11], s22 offen offset:0 sc1
  buffer_load_dwordx4 v[84:87], v6, s[8:11], s22 offen offset:1792 sc1
  s_add_u32 s22, s25, 3584
  buffer_load_dwordx4 v[88:91], v6, s[8:11], s22 offen offset:0 sc1
  buffer_load_dwordx4 v[92:95], v6, s[8:11], s22 offen offset:1792 sc1
  s_add_u32 s22, s25, 7168
  buffer_load_dwordx4 v[96:99], v6, s[8:11], s22 offen offset:0 sc1
  buffer_load_dwordx4 v[100:103], v6, s[8:11], s22 offen offset:1792 sc1
  s_add_u32 s22, s25, 10752
  buffer_load_dwordx4 v[104:107], v6, s[8:11], s22 offen offset:0 sc1
  buffer_load_dwordx4 v[108:111], v6, s[8:11], s22 offen offset:1792 sc1
  s_add_u32 s22, s25, 14336
  buffer_load_dwordx4 v[112:115], v6, s[8:11], s22 offen offset:0 sc1
  buffer_load_dwordx4 v[116:119], v6, s[8:11], s22 offen offset:1792 sc1
  s_add_u32 s22, s25, 17920
  buffer_load_dwordx4 v[120:123], v6, s[8:11], s22 offen offset:0 sc1
  buffer_load_dwordx4 v[124:127], v6, s[8:11], s22 offen offset:1792 sc1
  s_add_u32 s22, s25, 21504
  buffer_load_dwordx4 v[128:131], v6, s[8:11], s22 offen offset:0 sc1
  buffer_load_dwordx4 v[132:135], v6, s[8:11], s22 offen offset:1792 sc1
  s_add_u32 s22, s25, 25088
  buffer_load_dwordx4 v[136:139], v6, s[8:11], s22 offen offset:0 sc1
  buffer_load_dwordx4 v[140:143], v6, s[8:11], s22 offen offset:1792 sc1
  s_add_u32 s22, s19, 1
  s_cmp_lg_u32 s22, s38
  s_cbranch_scc1 cA_va1_nk
  buffer_load_dword v63, off, s[8:11], s35 sc1
cA_va1_nk:
  s_barrier
  ds_read_b128 v[8:11], v2 offset:8192
  ds_read_b128 v[12:15], v2 offset:9216
  ds_read_b128 v[16:19], v2 offset:10240
  ds_read_b128 v[20:23], v2 offset:11264
  ds_read_b128 v[24:27], v2 offset:12288
  ds_read_b128 v[28:31], v2 offset:13312
  ds_read_b128 v[32:35], v2 offset:14336
  s_waitcnt lgkmcnt(0)
  v_smfmac_f32_16x16x64_bf16 v[36:39], v[8:11], a[0:7], v3
  v_smfmac_f32_16x16x64_bf16 v[36:39], v[12:15], a[8:15], v3
  v_smfmac_f32_16x16x64_bf16 v[36:39], v[16:19], a[16:23], v3
  v_smfmac_f32_16x16x64_bf16 v[36:39], v[20:23], a[24:31], v3
  v_smfmac_f32_16x16x64_bf16 v[36:39], v[24:27], a[32:39], v3
  v_smfmac_f32_16x16x64_bf16 v[36:39], v[28:31], a[40:47], v3
  v_smfmac_f32_16x16x64_bf16 v[36:39], v[32:35], a[48:55], v3
  v_smfmac_f32_16x16x64_bf16 v[40:43], v[8:11], a[56:63], v3
  v_smfmac_f32_16x16x64_bf16 v[40:43], v[12:15], a[64:71], v3
  v_smfmac_f32_16x16x64_bf16 v[40:43], v[16:19], a[72:79], v3
  v_smfmac_f32_16x16x64_bf16 v[40:43], v[20:23], a[80:87], v3
  v_smfmac_f32_16x16x64_bf16 v[40:43], v[24:27], a[88:95], v3
  v_smfmac_f32_16x16x64_bf16 v[40:43], v[28:31], a[96:103], v3
  v_smfmac_f32_16x16x64_bf16 v[40:43], v[32:35], a[104:111], v3
  v_smfmac_f32_16x16x64_bf16 v[44:47], v[8:11], a[112:119], v3
  v_smfmac_f32_16x16x64_bf16 v[44:47], v[12:15], a[120:127], v3
  v_smfmac_f32_16x16x64_bf16 v[44:47], v[16:19], a[128:135], v3
  v_smfmac_f32_16x16x64_bf16 v[44:47], v[20:23], a[136:143], v3
  v_permlane32_swap_b32 v36, v40
  v_smfmac_f32_16x16x64_bf16 v[44:47], v[24:27], a[144:151], v3
  v_permlane32_swap_b32 v37, v41
  v_smfmac_f32_16x16x64_bf16 v[44:47], v[28:31], a[152:159], v3
  v_permlane32_swap_b32 v38, v42
  v_smfmac_f32_16x16x64_bf16 v[44:47], v[32:35], a[160:167], v3
  v_permlane32_swap_b32 v39, v43
  v_smfmac_f32_16x16x64_bf16 v[48:51], v[8:11], a[168:175], v3
  v_add_f32 v36, v36, v40
  v_smfmac_f32_16x16x64_bf16 v[48:51], v[12:15], a[176:183], v3
  v_add_f32 v37, v37, v41
  v_smfmac_f32_16x16x64_bf16 v[48:51], v[16:19], a[184:191], v3
  v_add_f32 v38, v38, v42
  v_smfmac_f32_16x16x64_bf16 v[48:51], v[20:23], a[192:199], v3
  v_add_f32 v39, v39, v43
  v_smfmac_f32_16x16x64_bf16 v[48:51], v[24:27], a[200:207], v3
  v_cvt_pk_bf16_f32 v40, v36, v37
  v_smfmac_f32_16x16x64_bf16 v[48:51], v[28:31], a[208:215], v3
  v_cvt_pk_bf16_f32 v41, v38, v39
  v_smfmac_f32_16x16x64_bf16 v[48:51], v[32:35], a[216:223], v3
  ds_write2_b32 v60, v40, v41 offset0:0 offset1:2
  v_smfmac_f32_16x16x64_bf16 v[52:55], v[8:11], a[224:231], v3
  v_smfmac_f32_16x16x64_bf16 v[52:55], v[12:15], a[232:239], v3
  v_smfmac_f32_16x16x64_bf16 v[52:55], v[16:19], a[240:247], v3
  v_smfmac_f32_16x16x64_bf16 v[52:55], v[20:23], a[248:255], v3
  v_permlane32_swap_b32 v44, v48
  v_smfmac_f32_16x16x64_bf16 v[52:55], v[24:27], v[176:183], v3
  v_permlane32_swap_b32 v45, v49
  v_smfmac_f32_16x16x64_bf16 v[52:55], v[28:31], v[184:191], v3
  v_permlane32_swap_b32 v46, v50
  v_smfmac_f32_16x16x64_bf16 v[52:55], v[32:35], v[192:199], v3
  v_permlane32_swap_b32 v47, v51
  v_smfmac_f32_16x16x64_bf16 v[56:59], v[8:11], v[200:207], v3
  v_add_f32 v44, v44, v48
  v_smfmac_f32_16x16x64_bf16 v[56:59], v[12:15], v[208:215], v3
  v_add_f32 v45, v45, v49
  v_smfmac_f32_16x16x64_bf16 v[56:59], v[16:19], v[216:223], v3
  v_add_f32 v46, v46, v50
  v_smfmac_f32_16x16x64_bf16 v[56:59], v[20:23], v[224:231], v3
  v_add_f32 v47, v47, v51
  v_smfmac_f32_16x16x64_bf16 v[56:59], v[24:27], v[232:239], v3
  v_cvt_pk_bf16_f32 v48, v44, v45
  v_smfmac_f32_16x16x64_bf16 v[56:59], v[28:31], v[240:247], v3
  v_cvt_pk_bf16_f32 v49, v46, v47
  v_smfmac_f32_16x16x64_bf16 v[56:59], v[32:35], v[248:255], v3
  ds_write2_b32 v61, v48, v49 offset0:0 offset1:2
  s_nop 6
  v_permlane32_swap_b32 v52, v56
  v_permlane32_swap_b32 v53, v57
  v_permlane32_swap_b32 v54, v58
  v_permlane32_swap_b32 v55, v59
  v_add_f32 v52, v52, v56
  v_add_f32 v53, v53, v57
  v_add_f32 v54, v54, v58
  v_add_f32 v55, v55, v59
  v_cvt_pk_bf16_f32 v56, v52, v53
  v_cvt_pk_bf16_f32 v57, v54, v55
  ds_write2_b32 v62, v56, v57 offset0:0 offset1:2
  s_cmp_eq_u32 s19, 63
  s_cbranch_scc1 cA_va1_last
  s_add_u32 s22, s20, 9216
  s_add_u32 s34, s20, 13312
  s_add_u32 s36, s20, 7168
  s_mov_b32 s37, 0
  v_mov_b32 v156, 0
  v_mov_b32 v157, 0
  v_mov_b32 v158, 0
  v_mov_b32 v159, 0
  buffer_load_dword v164, v4, s[8:11], s20 offen sc1
  s_nop 7
  buffer_load_dword v165, v4, s[8:11], s20 offen sc1
  s_nop 7
  buffer_load_dword v166, v4, s[8:11], s20 offen sc1
  s_nop 7
  buffer_load_dword v167, v4, s[8:11], s20 offen sc1
  s_nop 7
  buffer_load_dword v168, v4, s[8:11], s20 offen sc1
cA_va1_fw_l:
  s_waitcnt vmcnt(4)
  v_cmp_eq_u32 vcc, -1, v164
  s_cbranch_vccz cA_va1_fw_d
  buffer_load_dword v164, v4, s[8:11], s20 offen sc1
  s_waitcnt vmcnt(4)
  v_cmp_eq_u32 vcc, -1, v165
  s_cbranch_vccz cA_va1_fw_d
  buffer_load_dword v165, v4, s[8:11], s20 offen sc1
  s_waitcnt vmcnt(4)
  v_cmp_eq_u32 vcc, -1, v166
  s_cbranch_vccz cA_va1_fw_d
  buffer_load_dword v166, v4, s[8:11], s20 offen sc1
  s_waitcnt vmcnt(4)
  v_cmp_eq_u32 vcc, -1, v167
  s_cbranch_vccz cA_va1_fw_d
  buffer_load_dword v167, v4, s[8:11], s20 offen sc1
  s_waitcnt vmcnt(4)
  v_cmp_eq_u32 vcc, -1, v168
  s_cbranch_vccz cA_va1_fw_d
  buffer_load_dword v168, v4, s[8:11], s20 offen sc1
  s_add_u32 s30, s30, 1
  s_cmp_lt_u32 s30, 400000
  s_cbranch_scc1 cA_va1_fw_l
  s_branch cA_abort
cA_va1_fw_d:
  s_waitcnt lgkmcnt(0)
  buffer_load_dwordx4 v[8:11], v5, s[8:11], s22 offen offset:0
  v_mov_b32 v36, 0
  v_mov_b32 v37, 0
  v_mov_b32 v38, 0
  buffer_load_dwordx4 v[12:15], v5, s[8:11], s22 offen offset:1024
  v_mov_b32 v39, 0
  v_mov_b32 v40, 0
  v_mov_b32 v41, 0
  buffer_load_dwordx4 v[16:19], v5, s[8:11], s22 offen offset:2048
  v_mov_b32 v42, 0
  v_mov_b32 v43, 0
  v_mov_b32 v44, 0
  buffer_load_dwordx4 v[20:23], v5, s[8:11], s22 offen offset:3072
  v_mov_b32 v45, 0
  v_mov_b32 v46, 0
  v_mov_b32 v47, 0
  buffer_load_dwordx4 v[24:27], v5, s[8:11], s34 offen offset:0
  v_mov_b32 v48, 0
  v_mov_b32 v49, 0
  v_mov_b32 v50, 0
  buffer_load_dwordx4 v[28:31], v5, s[8:11], s34 offen offset:1024
  v_mov_b32 v51, 0
  v_mov_b32 v52, 0
  v_mov_b32 v53, 0
  buffer_load_dwordx4 v[32:35], v5, s[8:11], s34 offen offset:2048
  v_mov_b32 v54, 0
  v_mov_b32 v55, 0
  v_mov_b32 v56, 0
  buffer_load_dwordx4 v[144:147], v5, s[8:11], s34 offen offset:3072
  v_mov_b32 v57, 0
  v_mov_b32 v58, 0
  v_mov_b32 v59, 0
  buffer_load_dwordx4 v[148:151], v2, s[8:11], s36 offen offset:0
  buffer_load_dwordx4 v[152:155], v2, s[8:11], s36 offen offset:1024
  s_barrier
  ds_read_b128 v[64:67], v2 offset:4096
  ds_read_b128 v[68:71], v2 offset:5120
  ds_read_b128 v[72:75], v2 offset:6144
  ds_read_b128 v[76:79], v2 offset:7168
  s_waitcnt vmcnt(9)
  v_smfmac_f32_16x16x64_bf16 v[156:159], v[8:11], v[80:87], v0
  s_waitcnt vmcnt(8)
  v_smfmac_f32_16x16x64_bf16 v[156:159], v[12:15], v[88:95], v0
  s_waitcnt vmcnt(7)
  v_smfmac_f32_16x16x64_bf16 v[156:159], v[16:19], v[96:103], v0
  s_waitcnt vmcnt(6)
  v_smfmac_f32_16x16x64_bf16 v[156:159], v[20:23], v[104:111], v0
  s_waitcnt vmcnt(5)
  v_smfmac_f32_16x16x64_bf16 v[156:159], v[24:27], v[112:119], v0
  s_mov_b32 exec_hi, 0
  buffer_store_dword v2, v7, s[8:11], s21 offen
  s_mov_b64 exec, -1
  s_waitcnt vmcnt(5)
  v_smfmac_f32_16x16x64_bf16 v[156:159], v[28:31], v[120:127], v0
  s_waitcnt vmcnt(4)
  v_smfmac_f32_16x16x64_bf16 v[156:159], v[32:35], v[128:135], v0
  s_waitcnt vmcnt(3)
  v_smfmac_f32_16x16x64_bf16 v[156:159], v[144:147], v[136:143], v0
  s_waitcnt vmcnt(2) lgkmcnt(0)
  v_smfmac_f32_16x16x64_bf16 v[156:159], v[148:151], v[64:71], v0
  s_waitcnt vmcnt(1)
  v_smfmac_f32_16x16x64_bf16 v[156:159], v[152:155], v[72:79], v0
cA_va1_ep:
  s_nop 7
  v_add_f32 v160, v156, v157
  v_add_f32 v161, v158, v159
  v_cmp_u_f32 vcc, v160, v161
  v_mov_b32_dpp v162, v160 row_ror:8 row_mask:0xf bank_mask:0xf
  v_mov_b32_dpp v160, v161 row_ror:8 row_mask:0xf bank_mask:0xc
  s_cbranch_vccnz cA_va1_rp
  v_mov_b32_dpp v161, v162 quad_perm:[0,1,2,3] row_mask:0xf bank_mask:0x3
  v_cvt_pk_bf16_f32 v160, v160, v161
cA_va1_pc:
  s_mov_b64 exec, s[26:27]
  buffer_store_dword v160, v1, s[8:11], s21 offen
  s_cmp_lg_u32 s19, 62
  s_cbranch_scc1 cA_va1_nl
  s_mov_b32 s22, 88519680
  buffer_store_dword v160, v1, s[8:11], s22 offen sc1
  s_mov_b64 exec, -1
  s_branch cA_done
cA_va1_nl:
  s_mov_b64 exec, -1
  s_add_u32 s25, s25, 28672
  s_add_u32 s19, s19, 1
  s_mov_b32 s20, s21
  s_branch cA_va1_loop
cA_va1_last:
  s_waitcnt lgkmcnt(0)
  s_barrier
  s_branch cA_done
cA_va1_rp:
  s_cmp_eq_u32 s37, 0
  s_cbranch_scc1 cA_va1_rv
  v_mov_b32_dpp v161, v162 quad_perm:[0,1,2,3] row_mask:0xf bank_mask:0x3
  v_cvt_pk_bf16_f32 v160, v160, v161
  v_min_u32 v160, -2, v160
  s_branch cA_va1_pc
cA_va1_rv:
  buffer_load_dwordx4 v[8:11], v5, s[8:11], s22 offen offset:0 sc1
  buffer_load_dwordx4 v[12:15], v5, s[8:11], s22 offen offset:1024 sc1
  buffer_load_dwordx4 v[16:19], v5, s[8:11], s22 offen offset:2048 sc1
  buffer_load_dwordx4 v[20:23], v5, s[8:11], s22 offen offset:3072 sc1
  buffer_load_dwordx4 v[24:27], v5, s[8:11], s34 offen offset:0 sc1
  buffer_load_dwordx4 v[28:31], v5, s[8:11], s34 offen offset:1024 sc1
  buffer_load_dwordx4 v[32:35], v5, s[8:11], s34 offen offset:2048 sc1
  buffer_load_dwordx4 v[144:147], v5, s[8:11], s34 offen offset:3072 sc1
  buffer_load_dwordx4 v[148:151], v2, s[8:11], s36 offen offset:0 sc1
  buffer_load_dwordx4 v[152:155], v2, s[8:11], s36 offen offset:1024 sc1
  s_waitcnt vmcnt(0)
  v_max3_u32 v175, v8, v9, v10
  v_max3_u32 v175, v175, v11, v12
  v_max3_u32 v175, v175, v13, v14
  v_max3_u32 v175, v175, v15, v16
  v_max3_u32 v175, v175, v17, v18
  v_max3_u32 v175, v175, v19, v20
  v_max3_u32 v175, v175, v21, v22
  v_max3_u32 v175, v175, v23, v24
  v_max3_u32 v175, v175, v25, v26
  v_max3_u32 v175, v175, v27, v28
  v_max3_u32 v175, v175, v29, v30
  v_max3_u32 v175, v175, v31, v32
  v_max3_u32 v175, v175, v33, v34
  v_max3_u32 v175, v175, v35, v144
  v_max3_u32 v175, v175, v145, v146
  v_max3_u32 v175, v175, v147, v148
  v_max3_u32 v175, v175, v149, v150
  v_max3_u32 v175, v175, v151, v152
  v_max3_u32 v175, v175, v153, v154
  v_max_u32 v175, v175, v155
  v_cmp_eq_u32 vcc, -1, v175
  s_cbranch_vccz cA_va1_rk
  s_add_u32 s30, s30, 1
  s_cmp_lt_u32 s30, 400000
  s_cbranch_scc1 cA_va1_rv
  s_branch cA_abort
cA_va1_rk:
  s_mov_b32 s37, 1
  s_add_u32 s31, s31, 0x10000
  v_mov_b32 v156, 0
  v_mov_b32 v157, 0
  v_mov_b32 v158, 0
  v_mov_b32 v159, 0
  s_nop 1
  v_smfmac_f32_16x16x64_bf16 v[156:159], v[8:11], v[80:87], v0
  v_smfmac_f32_16x16x64_bf16 v[156:159], v[12:15], v[88:95], v0
  v_smfmac_f32_16x16x64_bf16 v[156:159], v[16:19], v[96:103], v0
  v_smfmac_f32_16x16x64_bf16 v[156:159], v[20:23], v[104:111], v0
  v_smfmac_f32_16x16x64_bf16 v[156:159], v[24:27], v[112:119], v0
  v_smfmac_f32_16x16x64_bf16 v[156:159], v[28:31], v[120:127], v0
  v_smfmac_f32_16x16x64_bf16 v[156:159], v[32:35], v[128:135], v0
  v_smfmac_f32_16x16x64_bf16 v[156:159], v[144:147], v[136:143], v0
  v_smfmac_f32_16x16x64_bf16 v[156:159], v[148:151], v[64:71], v0
  v_smfmac_f32_16x16x64_bf16 v[156:159], v[152:155], v[72:79], v0
  s_nop 7
  s_branch cA_va1_ep
.p2align 6

cA_va2_loop:
  s_add_u32 s23, s20, 4096
  s_add_u32 s21, s20, 25600
  v_mov_b32 v36, 0
  v_mov_b32 v37, 0
  v_mov_b32 v38, 0
  v_mov_b32 v39, 0
  v_mov_b32 v40, 0
  v_mov_b32 v41, 0
  v_mov_b32 v42, 0
  v_mov_b32 v43, 0
  v_mov_b32 v44, 0
  v_mov_b32 v45, 0
  v_mov_b32 v46, 0
  v_mov_b32 v47, 0
  v_mov_b32 v48, 0
  v_mov_b32 v49, 0
  v_mov_b32 v50, 0
  v_mov_b32 v51, 0
  v_mov_b32 v52, 0
  v_mov_b32 v53, 0
  v_mov_b32 v54, 0
  v_mov_b32 v55, 0
  v_mov_b32 v56, 0
  v_mov_b32 v57, 0
  v_mov_b32 v58, 0
  v_mov_b32 v59, 0
  v_mov_b32 v60, 0
  v_mov_b32 v61, 0
  v_mov_b32 v62, 0
  v_mov_b32 v63, 0
  v_mov_b32 v64, 0
  v_mov_b32 v65, 0
  v_mov_b32 v66, 0
  v_mov_b32 v67, 0
  s_mov_b32 s30, 0
  buffer_load_dword v76, v119, s[8:11], s20 offen sc1
  buffer_load_dword v77, v119, s[8:11], s20 offen sc1
  buffer_load_dword v78, v119, s[8:11], s20 offen sc1
cA_va2_fp_l:
  s_waitcnt vmcnt(2)
  v_cmp_eq_u32 vcc, -1, v76
  s_cbranch_vccz cA_va2_fp_d
  buffer_load_dword v76, v119, s[8:11], s20 offen sc1
  s_waitcnt vmcnt(2)
  v_cmp_eq_u32 vcc, -1, v77
  s_cbranch_vccz cA_va2_fp_d
  buffer_load_dword v77, v119, s[8:11], s20 offen sc1
  s_waitcnt vmcnt(2)
  v_cmp_eq_u32 vcc, -1, v78
  s_cbranch_vccz cA_va2_fp_d
  buffer_load_dword v78, v119, s[8:11], s20 offen sc1
  s_add_u32 s30, s30, 1
  s_cmp_lt_u32 s30, 400000
  s_cbranch_scc1 cA_va2_fp_l
  s_branch cA_abort
cA_va2_fp_d:
  buffer_load_dwordx4 v[8:11], v2, s[8:11], s20 offen offset:0 sc1
  buffer_load_dwordx4 v[12:15], v2, s[8:11], s20 offen offset:1024 sc1
  buffer_load_dwordx4 v[16:19], v2, s[8:11], s20 offen offset:2048 sc1
  buffer_load_dwordx4 v[20:23], v2, s[8:11], s20 offen offset:3072 sc1
  s_barrier
cA_va2_ld:
  s_waitcnt vmcnt(0)
  v_max3_u32 v84, v8, v9, v10
  v_max3_u32 v84, v84, v11, v12
  v_max3_u32 v84, v84, v13, v14
  v_max3_u32 v84, v84, v15, v16
  v_max3_u32 v84, v84, v17, v18
  v_max3_u32 v84, v84, v19, v20
  v_max3_u32 v84, v84, v21, v22
  v_max_u32 v84, v84, v23
  v_cmp_eq_u32 vcc, -1, v84
  ds_write_b128 v2, v[8:11] offset:8192
  ds_write_b128 v2, v[12:15] offset:9216
  ds_write_b128 v2, v[16:19] offset:10240
  ds_write_b128 v2, v[20:23] offset:11264
  s_cbranch_vccnz cA_va2_retry
  s_waitcnt lgkmcnt(0)
  s_barrier
  ds_read_b128 v[24:27], v2 offset:12288
  ds_read_b128 v[28:31], v2 offset:13312
  ds_read_b128 v[32:35], v2 offset:14336
  ds_read_b128 v[92:95], v0
  s_waitcnt lgkmcnt(0)
  s_mov_b64 exec, s[26:27]
  buffer_store_dwordx4 v[92:95], v2, s[8:11], s36 offen sc1
  s_mov_b64 exec, -1
  s_add_u32 s36, s36, 7168
  s_cmp_eq_u32 s19, 63
  s_cbranch_scc1 cA_done
  ds_read_b128 v[76:79], v1 offset:0
  ds_read_b128 v[80:83], v1 offset:1024
  ds_read_b128 v[84:87], v1 offset:2048
  ds_read_b128 v[88:91], v1 offset:3072
  ds_read_b128 v[92:95], v1 offset:4096
  ds_read_b128 v[96:99], v1 offset:5120
  v_smfmac_f32_16x16x64_bf16 v[60:63], v[8:11], v[200:207], v3
  v_smfmac_f32_16x16x64_bf16 v[60:63], v[12:15], v[208:215], v3
  s_waitcnt lgkmcnt(4)
  v_smfmac_f32_16x16x64_bf16 v[64:67], v[8:11], v[76:83], v3
  ds_read_b128 v[76:79], v1 offset:6144
  ds_read_b128 v[80:83], v1 offset:7168
  v_smfmac_f32_16x16x64_bf16 v[60:63], v[16:19], v[216:223], v3
  v_smfmac_f32_16x16x64_bf16 v[60:63], v[20:23], v[224:231], v3
  s_waitcnt lgkmcnt(4)
  v_smfmac_f32_16x16x64_bf16 v[64:67], v[12:15], v[84:91], v3
  ds_read_b128 v[84:87], v1 offset:8192
  ds_read_b128 v[88:91], v1 offset:9216
  v_smfmac_f32_16x16x64_bf16 v[60:63], v[24:27], v[232:239], v3
  v_smfmac_f32_16x16x64_bf16 v[60:63], v[28:31], v[240:247], v3
  s_waitcnt lgkmcnt(4)
  v_smfmac_f32_16x16x64_bf16 v[64:67], v[16:19], v[92:99], v3
  ds_read_b128 v[92:95], v1 offset:10240
  ds_read_b128 v[96:99], v1 offset:11264
  v_smfmac_f32_16x16x64_bf16 v[60:63], v[32:35], v[248:255], v3
  v_smfmac_f32_16x16x64_bf16 v[36:39], v[8:11], a[0:7], v3
  s_waitcnt lgkmcnt(4)
  v_smfmac_f32_16x16x64_bf16 v[64:67], v[20:23], v[76:83], v3
  ds_read_b128 v[76:79], v1 offset:12288
  ds_read_b128 v[80:83], v1 offset:13312
  v_smfmac_f32_16x16x64_bf16 v[36:39], v[12:15], a[8:15], v3
  v_smfmac_f32_16x16x64_bf16 v[36:39], v[16:19], a[16:23], v3
  s_waitcnt lgkmcnt(4)
  v_smfmac_f32_16x16x64_bf16 v[64:67], v[24:27], v[84:91], v3
  v_smfmac_f32_16x16x64_bf16 v[36:39], v[20:23], a[24:31], v3
  v_smfmac_f32_16x16x64_bf16 v[36:39], v[24:27], a[32:39], v3
  s_waitcnt lgkmcnt(2)
  v_smfmac_f32_16x16x64_bf16 v[64:67], v[28:31], v[92:99], v3
  v_smfmac_f32_16x16x64_bf16 v[36:39], v[28:31], a[40:47], v3
  v_smfmac_f32_16x16x64_bf16 v[36:39], v[32:35], a[48:55], v3
  s_waitcnt lgkmcnt(0)
  v_smfmac_f32_16x16x64_bf16 v[64:67], v[32:35], v[76:83], v3
  v_smfmac_f32_16x16x64_bf16 v[40:43], v[8:11], a[56:63], v3
  v_smfmac_f32_16x16x64_bf16 v[40:43], v[12:15], a[64:71], v3
  v_smfmac_f32_16x16x64_bf16 v[40:43], v[16:19], a[72:79], v3
  v_smfmac_f32_16x16x64_bf16 v[40:43], v[20:23], a[80:87], v3
  v_permlane32_swap_b32 v60, v64
  v_smfmac_f32_16x16x64_bf16 v[40:43], v[24:27], a[88:95], v3
  v_permlane32_swap_b32 v61, v65
  v_smfmac_f32_16x16x64_bf16 v[40:43], v[28:31], a[96:103], v3
  v_permlane32_swap_b32 v62, v66
  v_smfmac_f32_16x16x64_bf16 v[40:43], v[32:35], a[104:111], v3
  v_permlane32_swap_b32 v63, v67
  v_smfmac_f32_16x16x64_bf16 v[44:47], v[8:11], a[112:119], v3
  v_smfmac_f32_16x16x64_bf16 v[44:47], v[12:15], a[120:127], v3
  v_smfmac_f32_16x16x64_bf16 v[44:47], v[16:19], a[128:135], v3
  v_smfmac_f32_16x16x64_bf16 v[44:47], v[20:23], a[136:143], v3
  v_add_f32 v60, v60, v64
  v_add_f32 v61, v61, v65
  v_smfmac_f32_16x16x64_bf16 v[44:47], v[24:27], a[144:151], v3
  v_add_f32 v62, v62, v66
  v_add_f32 v63, v63, v67
  v_smfmac_f32_16x16x64_bf16 v[44:47], v[28:31], a[152:159], v3
  v_cvt_pk_bf16_f32 v64, v60, v61
  v_cvt_pk_bf16_f32 v65, v62, v63
  v_smfmac_f32_16x16x64_bf16 v[44:47], v[32:35], a[160:167], v3
  ds_write2_b32 v115, v64, v65 offset0:0 offset1:2
  v_smfmac_f32_16x16x64_bf16 v[48:51], v[8:11], a[168:175], v3
  v_permlane32_swap_b32 v36, v40
  v_smfmac_f32_16x16x64_bf16 v[48:51], v[12:15], a[176:183], v3
  v_permlane32_swap_b32 v37, v41
  v_smfmac_f32_16x16x64_bf16 v[48:51], v[16:19], a[184:191], v3
  v_permlane32_swap_b32 v38, v42
  v_smfmac_f32_16x16x64_bf16 v[48:51], v[20:23], a[192:199], v3
  v_permlane32_swap_b32 v39, v43
  v_smfmac_f32_16x16x64_bf16 v[48:51], v[24:27], a[200:207], v3
  v_add_f32 v36, v36, v40
  v_smfmac_f32_16x16x64_bf16 v[48:51], v[28:31], a[208:215], v3
  v_add_f32 v37, v37, v41
  v_smfmac_f32_16x16x64_bf16 v[48:51], v[32:35], a[216:223], v3
  v_add_f32 v38, v38, v42
  v_smfmac_f32_16x16x64_bf16 v[52:55], v[8:11], a[224:231], v3
  v_smfmac_f32_16x16x64_bf16 v[52:55], v[12:15], a[232:239], v3
  v_smfmac_f32_16x16x64_bf16 v[52:55], v[16:19], a[240:247], v3
  v_smfmac_f32_16x16x64_bf16 v[52:55], v[20:23], a[248:255], v3
  v_add_f32 v39, v39, v43
  v_cvt_pk_bf16_f32 v40, v36, v37
  v_smfmac_f32_16x16x64_bf16 v[52:55], v[24:27], v[120:127], v3
  v_cvt_pk_bf16_f32 v41, v38, v39
  v_smfmac_f32_16x16x64_bf16 v[52:55], v[28:31], v[128:135], v3
  ds_write2_b32 v112, v40, v41 offset0:0 offset1:2
  v_smfmac_f32_16x16x64_bf16 v[52:55], v[32:35], v[136:143], v3
  v_permlane32_swap_b32 v44, v48
  v_smfmac_f32_16x16x64_bf16 v[56:59], v[8:11], v[144:151], v3
  v_permlane32_swap_b32 v45, v49
  v_smfmac_f32_16x16x64_bf16 v[56:59], v[12:15], v[152:159], v3
  v_permlane32_swap_b32 v46, v50
  v_smfmac_f32_16x16x64_bf16 v[56:59], v[16:19], v[160:167], v3
  v_permlane32_swap_b32 v47, v51
  v_smfmac_f32_16x16x64_bf16 v[56:59], v[20:23], v[168:175], v3
  v_add_f32 v44, v44, v48
  v_smfmac_f32_16x16x64_bf16 v[56:59], v[24:27], v[176:183], v3
  v_add_f32 v45, v45, v49
  v_smfmac_f32_16x16x64_bf16 v[56:59], v[28:31], v[184:191], v3
  v_add_f32 v46, v46, v50
  v_smfmac_f32_16x16x64_bf16 v[56:59], v[32:35], v[192:199], v3
  v_add_f32 v47, v47, v51
  v_cvt_pk_bf16_f32 v48, v44, v45
  v_cvt_pk_bf16_f32 v49, v46, v47
  ds_write2_b32 v113, v48, v49 offset0:0 offset1:2
  s_nop 3
  v_permlane32_swap_b32 v52, v56
  v_permlane32_swap_b32 v53, v57
  v_permlane32_swap_b32 v54, v58
  v_permlane32_swap_b32 v55, v59
  v_add_f32 v52, v52, v56
  v_add_f32 v53, v53, v57
  v_add_f32 v54, v54, v58
  v_add_f32 v55, v55, v59
  v_cvt_pk_bf16_f32 v56, v52, v53
  v_cvt_pk_bf16_f32 v57, v54, v55
  ds_write2_b32 v114, v56, v57 offset0:0 offset1:2
  s_waitcnt lgkmcnt(0)
  s_barrier
  s_cmp_eq_u32 s19, 62
  s_cbranch_scc1 cA_done
  s_waitcnt vmcnt(0) lgkmcnt(0)
  s_add_u32 s19, s19, 1
  s_mov_b32 s20, s21
  s_branch cA_va2_loop
cA_va2_retry:
  s_waitcnt lgkmcnt(0)
  buffer_load_dwordx4 v[8:11], v2, s[8:11], s20 offen offset:0 sc1
  buffer_load_dwordx4 v[12:15], v2, s[8:11], s20 offen offset:1024 sc1
  buffer_load_dwordx4 v[16:19], v2, s[8:11], s20 offen offset:2048 sc1
  buffer_load_dwordx4 v[20:23], v2, s[8:11], s20 offen offset:3072 sc1
  s_add_u32 s31, s31, 1
  s_add_u32 s30, s30, 1
  s_cmp_lt_u32 s30, 400000
  s_cbranch_scc1 cA_va2_ld
  s_branch cA_abort
cA_va2_last:
  s_waitcnt lgkmcnt(0)
  buffer_store_dwordx4 v[100:103], v2, s[8:11], s24 offen offset:0 sc1
  buffer_store_dwordx4 v[104:107], v2, s[8:11], s24 offen offset:1024 sc1
  buffer_store_dwordx4 v[108:111], v2, s[8:11], s24 offen offset:2048 sc1
  buffer_store_dwordx4 v[4:7], v2, s[8:11], s24 offen offset:3072 sc1
  s_add_u32 s24, s24, 8192
  s_waitcnt vmcnt(0)
  s_mov_b64 exec, 1
  buffer_store_dword v117, v2, s[8:11], s34 offen sc1
  s_mov_b64 exec, -1
  s_add_u32 s34, s34, 8
  s_mov_b64 exec, 1
  buffer_store_dword v117, v2, s[8:11], s34 offen sc1
  s_mov_b64 exec, -1
  s_add_u32 s34, s34, 8
  s_branch cA_done
.p2align 6

cA_va3_loop:
  s_add_u32 s23, s20, 4096
  s_add_u32 s21, s20, 25600
  v_mov_b32 v36, 0
  v_mov_b32 v37, 0
  v_mov_b32 v38, 0
  v_mov_b32 v39, 0
  v_mov_b32 v40, 0
  v_mov_b32 v41, 0
  v_mov_b32 v42, 0
  v_mov_b32 v43, 0
  v_mov_b32 v44, 0
  v_mov_b32 v45, 0
  v_mov_b32 v46, 0
  v_mov_b32 v47, 0
  v_mov_b32 v48, 0
  v_mov_b32 v49, 0
  v_mov_b32 v50, 0
  v_mov_b32 v51, 0
  v_mov_b32 v52, 0
  v_mov_b32 v53, 0
  v_mov_b32 v54, 0
  v_mov_b32 v55, 0
  v_mov_b32 v56, 0
  v_mov_b32 v57, 0
  v_mov_b32 v58, 0
  v_mov_b32 v59, 0
  v_mov_b32 v60, 0
  v_mov_b32 v61, 0
  v_mov_b32 v62, 0
  v_mov_b32 v63, 0
  v_mov_b32 v64, 0
  v_mov_b32 v65, 0
  v_mov_b32 v66, 0
  v_mov_b32 v67, 0
  s_mov_b32 s30, 0
  buffer_load_dword v76, v119, s[8:11], s20 offen sc1
  buffer_load_dword v77, v119, s[8:11], s20 offen sc1
  buffer_load_dword v78, v119, s[8:11], s20 offen sc1
cA_va3_fp_l:
  s_waitcnt vmcnt(2)
  v_cmp_eq_u32 vcc, -1, v76
  s_cbranch_vccz cA_va3_fp_d
  buffer_load_dword v76, v119, s[8:11], s20 offen sc1
  s_waitcnt vmcnt(2)
  v_cmp_eq_u32 vcc, -1, v77
  s_cbranch_vccz cA_va3_fp_d
  buffer_load_dword v77, v119, s[8:11], s20 offen sc1
  s_waitcnt vmcnt(2)
  v_cmp_eq_u32 vcc, -1, v78
  s_cbranch_vccz cA_va3_fp_d
  buffer_load_dword v78, v119, s[8:11], s20 offen sc1
  s_add_u32 s30, s30, 1
  s_cmp_lt_u32 s30, 400000
  s_cbranch_scc1 cA_va3_fp_l
  s_branch cA_abort
cA_va3_fp_d:
  buffer_load_dwordx4 v[24:27], v2, s[8:11], s23 offen offset:0 sc1
  buffer_load_dwordx4 v[28:31], v2, s[8:11], s23 offen offset:1024 sc1
  buffer_load_dwordx4 v[32:35], v2, s[8:11], s23 offen offset:2048 sc1
  s_barrier
cA_va3_ld:
  s_waitcnt vmcnt(0)
  v_max3_u32 v84, v24, v25, v26
  v_max3_u32 v84, v84, v27, v28
  v_max3_u32 v84, v84, v29, v30
  v_max3_u32 v84, v84, v31, v32
  v_max3_u32 v84, v84, v33, v34
  v_max_u32 v84, v84, v35
  v_cmp_eq_u32 vcc, -1, v84
  ds_write_b128 v2, v[24:27] offset:12288
  ds_write_b128 v2, v[28:31] offset:13312
  ds_write_b128 v2, v[32:35] offset:14336
  s_cbranch_vccnz cA_va3_retry
  s_waitcnt lgkmcnt(0)
  s_barrier
  ds_read_b128 v[8:11], v2 offset:8192
  ds_read_b128 v[12:15], v2 offset:9216
  ds_read_b128 v[16:19], v2 offset:10240
  ds_read_b128 v[20:23], v2 offset:11264
  s_waitcnt lgkmcnt(0)
  s_cmp_eq_u32 s19, 63
  s_cbranch_scc1 cA_done
  ds_read_b128 v[76:79], v1 offset:0
  ds_read_b128 v[80:83], v1 offset:1024
  ds_read_b128 v[84:87], v1 offset:2048
  ds_read_b128 v[88:91], v1 offset:3072
  ds_read_b128 v[92:95], v1 offset:4096
  ds_read_b128 v[96:99], v1 offset:5120
  v_smfmac_f32_16x16x64_bf16 v[60:63], v[8:11], v[200:207], v3
  v_smfmac_f32_16x16x64_bf16 v[60:63], v[12:15], v[208:215], v3
  s_waitcnt lgkmcnt(4)
  v_smfmac_f32_16x16x64_bf16 v[64:67], v[8:11], v[76:83], v3
  ds_read_b128 v[76:79], v1 offset:6144
  ds_read_b128 v[80:83], v1 offset:7168
  v_smfmac_f32_16x16x64_bf16 v[60:63], v[16:19], v[216:223], v3
  v_smfmac_f32_16x16x64_bf16 v[60:63], v[20:23], v[224:231], v3
  s_waitcnt lgkmcnt(4)
  v_smfmac_f32_16x16x64_bf16 v[64:67], v[12:15], v[84:91], v3
  ds_read_b128 v[84:87], v1 offset:8192
  ds_read_b128 v[88:91], v1 offset:9216
  v_smfmac_f32_16x16x64_bf16 v[60:63], v[24:27], v[232:239], v3
  v_smfmac_f32_16x16x64_bf16 v[60:63], v[28:31], v[240:247], v3
  s_waitcnt lgkmcnt(4)
  v_smfmac_f32_16x16x64_bf16 v[64:67], v[16:19], v[92:99], v3
  ds_read_b128 v[92:95], v1 offset:10240
  ds_read_b128 v[96:99], v1 offset:11264
  v_smfmac_f32_16x16x64_bf16 v[60:63], v[32:35], v[248:255], v3
  v_smfmac_f32_16x16x64_bf16 v[36:39], v[8:11], a[0:7], v3
  s_waitcnt lgkmcnt(4)
  v_smfmac_f32_16x16x64_bf16 v[64:67], v[20:23], v[76:83], v3
  ds_read_b128 v[76:79], v1 offset:12288
  ds_read_b128 v[80:83], v1 offset:13312
  v_smfmac_f32_16x16x64_bf16 v[36:39], v[12:15], a[8:15], v3
  v_smfmac_f32_16x16x64_bf16 v[36:39], v[16:19], a[16:23], v3
  s_waitcnt lgkmcnt(4)
  v_smfmac_f32_16x16x64_bf16 v[64:67], v[24:27], v[84:91], v3
  v_smfmac_f32_16x16x64_bf16 v[36:39], v[20:23], a[24:31], v3
  v_smfmac_f32_16x16x64_bf16 v[36:39], v[24:27], a[32:39], v3
  s_waitcnt lgkmcnt(2)
  v_smfmac_f32_16x16x64_bf16 v[64:67], v[28:31], v[92:99], v3
  v_smfmac_f32_16x16x64_bf16 v[36:39], v[28:31], a[40:47], v3
  v_smfmac_f32_16x16x64_bf16 v[36:39], v[32:35], a[48:55], v3
  s_waitcnt lgkmcnt(0)
  v_smfmac_f32_16x16x64_bf16 v[64:67], v[32:35], v[76:83], v3
  v_smfmac_f32_16x16x64_bf16 v[40:43], v[8:11], a[56:63], v3
  v_smfmac_f32_16x16x64_bf16 v[40:43], v[12:15], a[64:71], v3
  v_smfmac_f32_16x16x64_bf16 v[40:43], v[16:19], a[72:79], v3
  v_smfmac_f32_16x16x64_bf16 v[40:43], v[20:23], a[80:87], v3
  v_permlane32_swap_b32 v60, v64
  v_smfmac_f32_16x16x64_bf16 v[40:43], v[24:27], a[88:95], v3
  v_permlane32_swap_b32 v61, v65
  v_smfmac_f32_16x16x64_bf16 v[40:43], v[28:31], a[96:103], v3
  v_permlane32_swap_b32 v62, v66
  v_smfmac_f32_16x16x64_bf16 v[40:43], v[32:35], a[104:111], v3
  v_permlane32_swap_b32 v63, v67
  v_smfmac_f32_16x16x64_bf16 v[44:47], v[8:11], a[112:119], v3
  v_smfmac_f32_16x16x64_bf16 v[44:47], v[12:15], a[120:127], v3
  v_smfmac_f32_16x16x64_bf16 v[44:47], v[16:19], a[128:135], v3
  v_smfmac_f32_16x16x64_bf16 v[44:47], v[20:23], a[136:143], v3
  v_add_f32 v60, v60, v64
  v_add_f32 v61, v61, v65
  v_smfmac_f32_16x16x64_bf16 v[44:47], v[24:27], a[144:151], v3
  v_add_f32 v62, v62, v66
  v_add_f32 v63, v63, v67
  v_smfmac_f32_16x16x64_bf16 v[44:47], v[28:31], a[152:159], v3
  v_cvt_pk_bf16_f32 v64, v60, v61
  v_cvt_pk_bf16_f32 v65, v62, v63
  v_smfmac_f32_16x16x64_bf16 v[44:47], v[32:35], a[160:167], v3
  ds_write2_b32 v115, v64, v65 offset0:0 offset1:2
  v_smfmac_f32_16x16x64_bf16 v[48:51], v[8:11], a[168:175], v3
  v_permlane32_swap_b32 v36, v40
  v_smfmac_f32_16x16x64_bf16 v[48:51], v[12:15], a[176:183], v3
  v_permlane32_swap_b32 v37, v41
  v_smfmac_f32_16x16x64_bf16 v[48:51], v[16:19], a[184:191], v3
  v_permlane32_swap_b32 v38, v42
  v_smfmac_f32_16x16x64_bf16 v[48:51], v[20:23], a[192:199], v3
  v_permlane32_swap_b32 v39, v43
  v_smfmac_f32_16x16x64_bf16 v[48:51], v[24:27], a[200:207], v3
  v_add_f32 v36, v36, v40
  v_smfmac_f32_16x16x64_bf16 v[48:51], v[28:31], a[208:215], v3
  v_add_f32 v37, v37, v41
  v_smfmac_f32_16x16x64_bf16 v[48:51], v[32:35], a[216:223], v3
  v_add_f32 v38, v38, v42
  v_smfmac_f32_16x16x64_bf16 v[52:55], v[8:11], a[224:231], v3
  v_smfmac_f32_16x16x64_bf16 v[52:55], v[12:15], a[232:239], v3
  v_smfmac_f32_16x16x64_bf16 v[52:55], v[16:19], a[240:247], v3
  v_smfmac_f32_16x16x64_bf16 v[52:55], v[20:23], a[248:255], v3
  v_add_f32 v39, v39, v43
  v_cvt_pk_bf16_f32 v40, v36, v37
  v_smfmac_f32_16x16x64_bf16 v[52:55], v[24:27], v[120:127], v3
  v_cvt_pk_bf16_f32 v41, v38, v39
  v_smfmac_f32_16x16x64_bf16 v[52:55], v[28:31], v[128:135], v3
  ds_write2_b32 v112, v40, v41 offset0:0 offset1:2
  v_smfmac_f32_16x16x64_bf16 v[52:55], v[32:35], v[136:143], v3
  v_permlane32_swap_b32 v44, v48
  v_smfmac_f32_16x16x64_bf16 v[56:59], v[8:11], v[144:151], v3
  v_permlane32_swap_b32 v45, v49
  v_smfmac_f32_16x16x64_bf16 v[56:59], v[12:15], v[152:159], v3
  v_permlane32_swap_b32 v46, v50
  v_smfmac_f32_16x16x64_bf16 v[56:59], v[16:19], v[160:167], v3
  v_permlane32_swap_b32 v47, v51
  v_smfmac_f32_16x16x64_bf16 v[56:59], v[20:23], v[168:175], v3
  v_add_f32 v44, v44, v48
  v_smfmac_f32_16x16x64_bf16 v[56:59], v[24:27], v[176:183], v3
  v_add_f32 v45, v45, v49
  v_smfmac_f32_16x16x64_bf16 v[56:59], v[28:31], v[184:191], v3
  v_add_f32 v46, v46, v50
  v_smfmac_f32_16x16x64_bf16 v[56:59], v[32:35], v[192:199], v3
  v_add_f32 v47, v47, v51
  v_cvt_pk_bf16_f32 v48, v44, v45
  v_cvt_pk_bf16_f32 v49, v46, v47
  ds_write2_b32 v113, v48, v49 offset0:0 offset1:2
  s_nop 3
  v_permlane32_swap_b32 v52, v56
  v_permlane32_swap_b32 v53, v57
  v_permlane32_swap_b32 v54, v58
  v_permlane32_swap_b32 v55, v59
  v_add_f32 v52, v52, v56
  v_add_f32 v53, v53, v57
  v_add_f32 v54, v54, v58
  v_add_f32 v55, v55, v59
  v_cvt_pk_bf16_f32 v56, v52, v53
  v_cvt_pk_bf16_f32 v57, v54, v55
  ds_write2_b32 v114, v56, v57 offset0:0 offset1:2
  s_waitcnt lgkmcnt(0)
  s_barrier
  s_cmp_eq_u32 s19, 62
  s_cbranch_scc1 cA_done
  s_waitcnt vmcnt(0) lgkmcnt(0)
  s_add_u32 s19, s19, 1
  s_mov_b32 s20, s21
  s_branch cA_va3_loop
cA_va3_retry:
  s_waitcnt lgkmcnt(0)
  buffer_load_dwordx4 v[24:27], v2, s[8:11], s23 offen offset:0 sc1
  buffer_load_dwordx4 v[28:31], v2, s[8:11], s23 offen offset:1024 sc1
  buffer_load_dwordx4 v[32:35], v2, s[8:11], s23 offen offset:2048 sc1
  s_add_u32 s31, s31, 1
  s_add_u32 s30, s30, 1
  s_cmp_lt_u32 s30, 400000
  s_cbranch_scc1 cA_va3_ld
  s_branch cA_abort
cA_va3_last:
  s_waitcnt lgkmcnt(0)
  buffer_store_dwordx4 v[100:103], v2, s[8:11], s24 offen offset:0 sc1
  buffer_store_dwordx4 v[104:107], v2, s[8:11], s24 offen offset:1024 sc1
  buffer_store_dwordx4 v[108:111], v2, s[8:11], s24 offen offset:2048 sc1
  buffer_store_dwordx4 v[4:7], v2, s[8:11], s24 offen offset:3072 sc1
  s_add_u32 s24, s24, 8192
  s_waitcnt vmcnt(0)
  s_mov_b64 exec, 1
  buffer_store_dword v117, v2, s[8:11], s34 offen sc1
  s_mov_b64 exec, -1
  s_add_u32 s34, s34, 8
  s_mov_b64 exec, 1
  buffer_store_dword v117, v2, s[8:11], s34 offen sc1
  s_mov_b64 exec, -1
  s_add_u32 s34, s34, 8
  s_branch cA_done
cA_abort:
  v_mov_b32 v4, 0xdead
  v_mov_b32 v5, 16
  buffer_store_dword v4, v5, s[12:15], 0 offen
  s_branch ch_end
cA_done:
  s_branch ch_end
.p2align 6

cB_sc0_loop:
  s_add_u32 s23, s20, 4096
  s_add_u32 s21, s20, 25600
  v_mov_b32 v48, 0
  v_mov_b32 v49, 0
  v_mov_b32 v50, 0
  v_mov_b32 v51, 0
  v_mov_b32 v52, 0
  v_mov_b32 v53, 0
  v_mov_b32 v54, 0
  v_mov_b32 v55, 0
  v_mov_b32 v56, 0
  v_mov_b32 v57, 0
  v_mov_b32 v58, 0
  v_mov_b32 v59, 0
  v_mov_b32 v60, 0
  v_mov_b32 v61, 0
  v_mov_b32 v62, 0
  v_mov_b32 v63, 0
  v_mov_b32 v88, 0
  v_mov_b32 v89, 0
  v_mov_b32 v90, 0
  v_mov_b32 v91, 0
  v_mov_b32 v92, 0
  v_mov_b32 v93, 0
  v_mov_b32 v94, 0
  v_mov_b32 v95, 0
  v_mov_b32 v66, 0
  v_mov_b32 v67, 0
  s_mov_b32 s30, 0
  s_mov_b32 s62, 0
  buffer_load_dword v68, v0, s[8:11], s20 offen sc1
  s_nop 7
  buffer_load_dword v69, v0, s[8:11], s20 offen sc1
  s_nop 7
  buffer_load_dword v70, v0, s[8:11], s20 offen sc1
  s_nop 7
  buffer_load_dword v71, v0, s[8:11], s20 offen sc1
  s_nop 7
  buffer_load_dword v72, v0, s[8:11], s20 offen sc1
cB_sc0_fp_l:
  s_waitcnt vmcnt(4)
  v_cmp_eq_u32 vcc, -1, v68
  s_cbranch_vccz cB_sc0_fp_d
  buffer_load_dword v68, v0, s[8:11], s20 offen sc1
  s_waitcnt vmcnt(4)
  v_cmp_eq_u32 vcc, -1, v69
  s_cbranch_vccz cB_sc0_fp_d
  buffer_load_dword v69, v0, s[8:11], s20 offen sc1
  s_waitcnt vmcnt(4)
  v_cmp_eq_u32 vcc, -1, v70
  s_cbranch_vccz cB_sc0_fp_d
  buffer_load_dword v70, v0, s[8:11], s20 offen sc1
  s_waitcnt vmcnt(4)
  v_cmp_eq_u32 vcc, -1, v71
  s_cbranch_vccz cB_sc0_fp_d
  buffer_load_dword v71, v0, s[8:11], s20 offen sc1
  s_waitcnt vmcnt(4)
  v_cmp_eq_u32 vcc, -1, v72
  s_cbranch_vccz cB_sc0_fp_d
  buffer_load_dword v72, v0, s[8:11], s20 offen sc1
  s_add_u32 s30, s30, 1
  s_cmp_lt_u32 s30, 400000
  s_cbranch_scc1 cB_sc0_fp_l
  s_branch cB_abort
cB_sc0_fp_d:
  buffer_load_dwordx4 v[8:11], v2, s[8:11], s20 offen offset:0 sc1
  s_barrier
  s_branch cB_sc0_ld1
cB_sc0_ld:
  buffer_load_dwordx4 v[8:11], v2, s[8:11], s20 offen offset:0 sc1
cB_sc0_ld1:
  v_mov_b32 v36, 0
  v_mov_b32 v37, 0
  v_mov_b32 v38, 0
  v_mov_b32 v39, 0
  buffer_load_dwordx4 v[12:15], v2, s[8:11], s20 offen offset:1024 sc1
  v_mov_b32 v40, 0
  v_mov_b32 v41, 0
  v_mov_b32 v42, 0
  v_mov_b32 v43, 0
  buffer_load_dwordx4 v[16:19], v2, s[8:11], s20 offen offset:2048 sc1
  v_mov_b32 v44, 0
  v_mov_b32 v45, 0
  v_mov_b32 v46, 0
  v_mov_b32 v47, 0
  ds_read_b128 v[96:99], v117 offset:0
  ds_read_b128 v[100:103], v117 offset:1024
  ds_read_b128 v[104:107], v117 offset:14336
  ds_read_b128 v[108:111], v117 offset:15360
  s_waitcnt vmcnt(2)
  v_smfmac_f32_16x16x64_bf16 v[36:39], v[8:11], a[0:7], v3
  v_smfmac_f32_16x16x64_bf16 v[40:43], v[8:11], a[56:63], v3
  buffer_load_dwordx4 v[20:23], v2, s[8:11], s20 offen offset:3072 sc1
  v_smfmac_f32_16x16x64_bf16 v[44:47], v[8:11], a[112:119], v3
  v_smfmac_f32_16x16x64_bf16 v[48:51], v[8:11], a[168:175], v3
  v_smfmac_f32_16x16x64_bf16 v[52:55], v[8:11], a[224:231], v3
  buffer_load_dwordx4 v[24:27], v2, s[8:11], s23 offen offset:0 sc1
  v_smfmac_f32_16x16x64_bf16 v[56:59], v[8:11], v[144:151], v3
  v_smfmac_f32_16x16x64_bf16 v[60:63], v[8:11], v[200:207], v3
  s_waitcnt vmcnt(3)
  v_smfmac_f32_16x16x64_bf16 v[36:39], v[12:15], a[8:15], v3
  v_smfmac_f32_16x16x64_bf16 v[40:43], v[12:15], a[64:71], v3
  buffer_load_dwordx4 v[28:31], v2, s[8:11], s23 offen offset:1024 sc1
  v_smfmac_f32_16x16x64_bf16 v[44:47], v[12:15], a[120:127], v3
  v_smfmac_f32_16x16x64_bf16 v[48:51], v[12:15], a[176:183], v3
  v_smfmac_f32_16x16x64_bf16 v[52:55], v[12:15], a[232:239], v3
  buffer_load_dwordx4 v[32:35], v2, s[8:11], s23 offen offset:2048 sc1
  v_smfmac_f32_16x16x64_bf16 v[56:59], v[12:15], v[152:159], v3
  v_smfmac_f32_16x16x64_bf16 v[60:63], v[12:15], v[208:215], v3
  s_waitcnt vmcnt(4)
  v_smfmac_f32_16x16x64_bf16 v[36:39], v[16:19], a[16:23], v3
  v_smfmac_f32_16x16x64_bf16 v[40:43], v[16:19], a[72:79], v3
  v_smfmac_f32_16x16x64_bf16 v[44:47], v[16:19], a[128:135], v3
  v_smfmac_f32_16x16x64_bf16 v[48:51], v[16:19], a[184:191], v3
  v_smfmac_f32_16x16x64_bf16 v[52:55], v[16:19], a[240:247], v3
  v_smfmac_f32_16x16x64_bf16 v[56:59], v[16:19], v[160:167], v3
  v_smfmac_f32_16x16x64_bf16 v[60:63], v[16:19], v[216:223], v3
  s_waitcnt vmcnt(3)
  v_smfmac_f32_16x16x64_bf16 v[36:39], v[20:23], a[24:31], v3
  v_smfmac_f32_16x16x64_bf16 v[40:43], v[20:23], a[80:87], v3
  v_smfmac_f32_16x16x64_bf16 v[44:47], v[20:23], a[136:143], v3
  v_smfmac_f32_16x16x64_bf16 v[48:51], v[20:23], a[192:199], v3
  v_smfmac_f32_16x16x64_bf16 v[52:55], v[20:23], a[248:255], v3
  v_smfmac_f32_16x16x64_bf16 v[56:59], v[20:23], v[168:175], v3
  v_smfmac_f32_16x16x64_bf16 v[60:63], v[20:23], v[224:231], v3
  s_waitcnt vmcnt(0)
cB_sc0_ph2:
  v_smfmac_f32_16x16x64_bf16 v[60:63], v[24:27], v[232:239], v3
  ds_read_b128 v[12:15], v116 offset:0
  ds_read_b128 v[16:19], v116 offset:1024
  v_smfmac_f32_16x16x64_bf16 v[60:63], v[28:31], v[240:247], v3
  v_smfmac_f32_16x16x64_bf16 v[60:63], v[32:35], v[248:255], v3
  v_mov_b32 v80, v24
  v_smfmac_f32_16x16x64_bf16 v[52:55], v[24:27], v[120:127], v3
  v_mov_b32 v81, v25
  v_smfmac_f32_16x16x64_bf16 v[52:55], v[28:31], v[128:135], v3
  v_mov_b32 v82, v32
  v_smfmac_f32_16x16x64_bf16 v[52:55], v[32:35], v[136:143], v3
  v_cvt_pk_bf16_f32 v64, v60, v61
  v_smfmac_f32_16x16x64_bf16 v[56:59], v[24:27], v[176:183], v3
  v_cvt_pk_bf16_f32 v65, v62, v63
  v_smfmac_f32_16x16x64_bf16 v[56:59], v[28:31], v[184:191], v3
  v_mov_b32 v83, v33
  v_mfma_f32_16x16x32_bf16 v[68:71], v[64:67], v[4:7], 0
  v_smfmac_f32_16x16x64_bf16 v[56:59], v[32:35], v[192:199], v3
  v_cvt_pk_bf16_f32 v64, v52, v53
  v_smfmac_f32_16x16x64_bf16 v[36:39], v[24:27], a[32:39], v3
  v_cvt_pk_bf16_f32 v65, v54, v55
  v_smfmac_f32_16x16x64_bf16 v[36:39], v[28:31], a[40:47], v3
  v_cvt_pk_bf16_f32 v78, v68, v69
  v_smfmac_f32_16x16x64_bf16 v[36:39], v[32:35], a[48:55], v3
  v_cvt_pk_bf16_f32 v79, v70, v71
  v_cvt_pk_bf16_f32 v66, v56, v57
  v_smfmac_f32_16x16x64_bf16 v[40:43], v[24:27], a[88:95], v3
  v_cvt_pk_bf16_f32 v67, v58, v59
  v_smfmac_f32_16x16x64_bf16 v[40:43], v[28:31], a[96:103], v3
  v_mfma_f32_16x16x32_bf16 v[72:75], v[64:67], v[4:7], 0
  ds_read_b128 v[52:55], v116 offset:14336
  ds_read_b128 v[56:59], v116 offset:15360
  v_smfmac_f32_16x16x64_bf16 v[40:43], v[32:35], a[104:111], v3
  v_cvt_pk_bf16_f32 v64, v36, v37
  v_smfmac_f32_16x16x64_bf16 v[44:47], v[24:27], a[144:151], v3
  v_cvt_pk_bf16_f32 v65, v38, v39
  v_smfmac_f32_16x16x64_bf16 v[44:47], v[28:31], a[152:159], v3
  v_cvt_pk_bf16_f32 v76, v72, v73
  v_smfmac_f32_16x16x64_bf16 v[44:47], v[32:35], a[160:167], v3
  v_cvt_pk_bf16_f32 v77, v74, v75
  v_cvt_pk_bf16_f32 v66, v40, v41
  v_smfmac_f32_16x16x64_bf16 v[48:51], v[24:27], a[200:207], v3
  v_cvt_pk_bf16_f32 v67, v42, v43
  v_smfmac_f32_16x16x64_bf16 v[48:51], v[28:31], a[208:215], v3
  v_mfma_f32_16x16x32_bf16 v[68:71], v[64:67], v[4:7], 0
  v_smfmac_f32_16x16x64_bf16 v[48:51], v[32:35], a[216:223], v3
  v_cvt_pk_bf16_f32 v64, v44, v45
  v_mfma_f32_16x16x32_bf16 v[84:87], v[80:83], v[76:79], 0
  v_cvt_pk_bf16_f32 v65, v46, v47
  s_waitcnt lgkmcnt(0)
  v_smfmac_f32_16x16x64_bf16 v[88:91], v[76:79], v[96:103], v3
  v_cvt_pk_bf16_f32 v60, v68, v69
  v_cvt_pk_bf16_f32 v61, v70, v71
  v_cvt_pk_bf16_f32 v66, v48, v49
  v_cvt_pk_bf16_f32 v67, v50, v51
  s_nop 1
  v_mfma_f32_16x16x32_bf16 v[72:75], v[64:67], v[4:7], 0
  v_smfmac_f32_16x16x64_bf16 v[92:95], v[76:79], v[104:111], v3
  s_nop 4
  v_cvt_pk_bf16_f32 v62, v72, v73
  v_cvt_pk_bf16_f32 v63, v74, v75
  s_nop 1
  v_mfma_f32_16x16x32_bf16 v[84:87], v[8:11], v[60:63], v[84:87]
  v_smfmac_f32_16x16x64_bf16 v[88:91], v[60:63], v[12:19], v3
  v_smfmac_f32_16x16x64_bf16 v[92:95], v[60:63], v[52:59], v3
  s_nop 1
  v_permlane32_swap_b32 v84, v86
  v_permlane32_swap_b32 v85, v87
  s_nop 0
  v_cmp_u_f32 vcc, v88, v89
  v_add_f32_dpp v84, v86, v84 row_ror:8 row_mask:0xf bank_mask:0xf
  v_add_f32_dpp v85, v87, v85 row_ror:8 row_mask:0xf bank_mask:0xf
  v_permlane32_swap_b32 v88, v92
  v_permlane32_swap_b32 v89, v93
  ds_write2_b32 v113, v84, v85 offset0:0 offset1:4
  v_permlane32_swap_b32 v90, v94
  v_permlane32_swap_b32 v91, v95
  v_add_f32 v88, v88, v92
  v_add_f32 v89, v89, v93
  v_add_f32 v90, v90, v94
  v_add_f32 v91, v91, v95
  ds_write2_b64 v112, v[88:89], v[90:91] offset0:0 offset1:128
  s_cbranch_vccnz cB_sc0_retry
cB_sc0_cont:
  s_waitcnt lgkmcnt(0)
  s_barrier
  ds_read_b128 v[36:39], v114
  ds_read_b128 v[44:47], v115
  s_waitcnt lgkmcnt(0)
  v_add_f32 v36, v36, v38
  v_add_f32 v37, v37, v39
  v_add_f32 v44, v44, v45
  v_add_f32 v46, v46, v47
  v_permlane32_swap_b32 v36, v37
  v_add_f32 v44, v44, v46
  v_add_f32 v36, v36, v37
  v_exp_f32 v49, v44
  v_exp_f32 v48, v36
  v_add_f32 v50, abs(v36), abs(v44)
  v_fma_f32 v39, v49, s37, v48
  v_cmp_ngt_f32 vcc, s56, v50
  v_cndmask_b32 v41, v48, v49, s[38:39]
  v_add_f32_dpp v39, v39, v39 quad_perm:[1,0,3,2] row_mask:0xf bank_mask:0xf
  v_cndmask_b32 v40, v49, v48, s[38:39]
  v_mov_b32_dpp v46, v41 quad_perm:[1,0,3,2] row_mask:0xf bank_mask:0xf
  v_add_f32_dpp v39, v39, v39 quad_perm:[2,3,0,1] row_mask:0xf bank_mask:0xf
  v_cndmask_b32 v42, v46, v40, s[38:39]
  v_cndmask_b32 v43, v40, v46, s[38:39]
  v_add_f32_dpp v39, v39, v39 row_half_mirror row_mask:0xf bank_mask:0xf
  s_cbranch_vccnz cB_sc0_slow
  s_nop 0
  v_add_f32_dpp v47, v39, v39 row_mirror row_mask:0xf bank_mask:0xf
  v_add_f32_dpp v39, v39, v39 row_mirror row_mask:0xf bank_mask:0xf
  s_nop 1
  v_permlane16_swap_b32 v39, v47
  v_add_f32 v39, v39, v47
  v_rcp_f32 v39, v39
  s_mov_b64 exec, s[28:29]
  v_mul_f32 v42, v42, v39
  v_mul_f32 v43, v43, v39
  v_cvt_pk_bf16_f32 v42, v42, v43
cB_sc0_pst:
  buffer_store_dword v42, v1, s[8:11], s20 offen sc1
  s_mov_b64 exec, -1
  s_barrier
  s_add_u32 s24, s24, 28672
  s_add_u32 s35, s35, 28672
  s_xor_b32 s25, s25, 28672
  s_add_u32 m0, s25, 0
  s_nop 0
  buffer_load_dwordx4 v2, s[8:11], s24 offen offset:0 sc1 lds
  buffer_load_dwordx4 v2, s[8:11], s24 offen offset:1024 sc1 lds
  buffer_load_dwordx4 v2, s[8:11], s24 offen offset:2048 sc1 lds
  buffer_load_dwordx4 v2, s[8:11], s24 offen offset:3072 sc1 lds
  s_add_u32 m0, s25, 4096
  s_add_u32 s22, s24, 4096
  buffer_load_dwordx4 v2, s[8:11], s22 offen offset:0 sc1 lds
  buffer_load_dwordx4 v2, s[8:11], s22 offen offset:1024 sc1 lds
  buffer_load_dwordx4 v2, s[8:11], s22 offen offset:2048 sc1 lds
  v_xor_b32 v116, 28672, v116
  v_add_u32 v117, s57, v117
  s_sub_u32 s57, 0, s57
  s_add_u32 s19, s19, 1
  s_mov_b32 s20, s21
  s_cmp_lt_u32 s19, 63
  s_cbranch_scc1 cB_sc0_loop
  s_branch cB_done
cB_sc0_slow:
  v_max_f32 v50, v36, v44
  s_nop 1
  v_max_f32_dpp v50, v50, v50 quad_perm:[1,0,3,2] row_mask:0xf bank_mask:0xf
  s_nop 1
  v_max_f32_dpp v50, v50, v50 quad_perm:[2,3,0,1] row_mask:0xf bank_mask:0xf
  s_nop 1
  v_max_f32_dpp v50, v50, v50 row_half_mirror row_mask:0xf bank_mask:0xf
  s_nop 1
  v_max_f32_dpp v50, v50, v50 row_mirror row_mask:0xf bank_mask:0xf
  v_mov_b32 v47, v50
  s_nop 1
  v_permlane16_swap_b32 v50, v47
  v_max_f32 v50, v50, v47
  v_sub_f32 v48, v36, v50
  v_sub_f32 v49, v44, v50
  v_exp_f32 v48, v48
  v_exp_f32 v49, v49
  s_add_u32 s31, s31, 0x100
  v_fma_f32 v39, v49, s37, v48
  v_cndmask_b32 v41, v48, v49, s[38:39]
  s_nop 0
  v_add_f32_dpp v39, v39, v39 quad_perm:[1,0,3,2] row_mask:0xf bank_mask:0xf
  v_cndmask_b32 v40, v49, v48, s[38:39]
  v_mov_b32_dpp v46, v41 quad_perm:[1,0,3,2] row_mask:0xf bank_mask:0xf
  v_add_f32_dpp v39, v39, v39 quad_perm:[2,3,0,1] row_mask:0xf bank_mask:0xf
  v_cndmask_b32 v42, v46, v40, s[38:39]
  v_cndmask_b32 v43, v40, v46, s[38:39]
  v_add_f32_dpp v39, v39, v39 row_half_mirror row_mask:0xf bank_mask:0xf
  s_nop 1
  v_add_f32_dpp v47, v39, v39 row_mirror row_mask:0xf bank_mask:0xf
  v_add_f32_dpp v39, v39, v39 row_mirror row_mask:0xf bank_mask:0xf
  s_nop 1
  v_permlane16_swap_b32 v39, v47
  v_add_f32 v39, v39, v47
  v_rcp_f32 v39, v39
  s_mov_b64 exec, s[28:29]
  v_mul_f32 v42, v42, v39
  v_mul_f32 v43, v43, v39
  v_cvt_pk_bf16_f32 v42, v42, v43
  v_min_u32 v42, -2, v42
  s_branch cB_sc0_pst
cB_sc0_retry:
  s_cmp_lg_u32 s62, 0
  s_cbranch_scc1 cB_sc0_cont
  s_waitcnt vmcnt(0) lgkmcnt(0)
cB_sc0_rv:
  buffer_load_dwordx4 v[8:11], v2, s[8:11], s20 offen offset:0 sc1
  buffer_load_dwordx4 v[12:15], v2, s[8:11], s20 offen offset:1024 sc1
  buffer_load_dwordx4 v[16:19], v2, s[8:11], s20 offen offset:2048 sc1
  buffer_load_dwordx4 v[20:23], v2, s[8:11], s20 offen offset:3072 sc1
  buffer_load_dwordx4 v[24:27], v2, s[8:11], s23 offen offset:0 sc1
  buffer_load_dwordx4 v[28:31], v2, s[8:11], s23 offen offset:1024 sc1
  buffer_load_dwordx4 v[32:35], v2, s[8:11], s23 offen offset:2048 sc1
  s_waitcnt vmcnt(0)
  v_max3_u32 v118, v8, v9, v10
  v_max3_u32 v118, v118, v11, v12
  v_max3_u32 v118, v118, v13, v14
  v_max3_u32 v118, v118, v15, v16
  v_max3_u32 v118, v118, v17, v18
  v_max3_u32 v118, v118, v19, v20
  v_max3_u32 v118, v118, v21, v22
  v_max3_u32 v118, v118, v23, v24
  v_max3_u32 v118, v118, v25, v26
  v_max3_u32 v118, v118, v27, v28
  v_max3_u32 v118, v118, v29, v30
  v_max3_u32 v118, v118, v31, v32
  v_max3_u32 v118, v118, v33, v34
  v_max_u32 v118, v118, v35
  v_cmp_eq_u32 vcc, -1, v118
  s_cbranch_vccz cB_sc0_rk
  s_add_u32 s30, s30, 1
  s_cmp_lt_u32 s30, 400000
  s_cbranch_scc1 cB_sc0_rv
  s_branch cB_abort
cB_sc0_rk:
  s_mov_b32 s62, 1
  v_mov_b32 v36, 0
  v_mov_b32 v37, 0
  v_mov_b32 v38, 0
  v_mov_b32 v39, 0
  v_mov_b32 v40, 0
  v_mov_b32 v41, 0
  v_mov_b32 v42, 0
  v_mov_b32 v43, 0
  v_mov_b32 v44, 0
  v_mov_b32 v45, 0
  v_mov_b32 v46, 0
  v_mov_b32 v47, 0
  v_mov_b32 v48, 0
  v_mov_b32 v49, 0
  v_mov_b32 v50, 0
  v_mov_b32 v51, 0
  v_mov_b32 v52, 0
  v_mov_b32 v53, 0
  v_mov_b32 v54, 0
  v_mov_b32 v55, 0
  v_mov_b32 v56, 0
  v_mov_b32 v57, 0
  v_mov_b32 v58, 0
  v_mov_b32 v59, 0
  v_mov_b32 v60, 0
  v_mov_b32 v61, 0
  v_mov_b32 v62, 0
  v_mov_b32 v63, 0
  v_mov_b32 v88, 0
  v_mov_b32 v89, 0
  v_mov_b32 v90, 0
  v_mov_b32 v91, 0
  v_mov_b32 v92, 0
  v_mov_b32 v93, 0
  v_mov_b32 v94, 0
  v_mov_b32 v95, 0
  v_mov_b32 v66, 0
  v_mov_b32 v67, 0
  s_add_u32 s31, s31, 1
  ds_read_b128 v[96:99], v117 offset:0
  ds_read_b128 v[100:103], v117 offset:1024
  ds_read_b128 v[104:107], v117 offset:14336
  ds_read_b128 v[108:111], v117 offset:15360
  v_smfmac_f32_16x16x64_bf16 v[36:39], v[8:11], a[0:7], v3
  v_smfmac_f32_16x16x64_bf16 v[40:43], v[8:11], a[56:63], v3
  v_smfmac_f32_16x16x64_bf16 v[44:47], v[8:11], a[112:119], v3
  v_smfmac_f32_16x16x64_bf16 v[48:51], v[8:11], a[168:175], v3
  v_smfmac_f32_16x16x64_bf16 v[52:55], v[8:11], a[224:231], v3
  v_smfmac_f32_16x16x64_bf16 v[56:59], v[8:11], v[144:151], v3
  v_smfmac_f32_16x16x64_bf16 v[60:63], v[8:11], v[200:207], v3
  v_smfmac_f32_16x16x64_bf16 v[36:39], v[12:15], a[8:15], v3
  v_smfmac_f32_16x16x64_bf16 v[40:43], v[12:15], a[64:71], v3
  v_smfmac_f32_16x16x64_bf16 v[44:47], v[12:15], a[120:127], v3
  v_smfmac_f32_16x16x64_bf16 v[48:51], v[12:15], a[176:183], v3
  v_smfmac_f32_16x16x64_bf16 v[52:55], v[12:15], a[232:239], v3
  v_smfmac_f32_16x16x64_bf16 v[56:59], v[12:15], v[152:159], v3
  v_smfmac_f32_16x16x64_bf16 v[60:63], v[12:15], v[208:215], v3
  v_smfmac_f32_16x16x64_bf16 v[36:39], v[16:19], a[16:23], v3
  v_smfmac_f32_16x16x64_bf16 v[40:43], v[16:19], a[72:79], v3
  v_smfmac_f32_16x16x64_bf16 v[44:47], v[16:19], a[128:135], v3
  v_smfmac_f32_16x16x64_bf16 v[48:51], v[16:19], a[184:191], v3
  v_smfmac_f32_16x16x64_bf16 v[52:55], v[16:19], a[240:247], v3
  v_smfmac_f32_16x16x64_bf16 v[56:59], v[16:19], v[160:167], v3
  v_smfmac_f32_16x16x64_bf16 v[60:63], v[16:19], v[216:223], v3
  v_smfmac_f32_16x16x64_bf16 v[36:39], v[20:23], a[24:31], v3
  v_smfmac_f32_16x16x64_bf16 v[40:43], v[20:23], a[80:87], v3
  v_smfmac_f32_16x16x64_bf16 v[44:47], v[20:23], a[136:143], v3
  v_smfmac_f32_16x16x64_bf16 v[48:51], v[20:23], a[192:199], v3
  v_smfmac_f32_16x16x64_bf16 v[52:55], v[20:23], a[248:255], v3
  v_smfmac_f32_16x16x64_bf16 v[56:59], v[20:23], v[168:175], v3
  v_smfmac_f32_16x16x64_bf16 v[60:63], v[20:23], v[224:231], v3
  s_branch cB_sc0_ph2
.p2align 6

cB_sc1_loop:
  s_add_u32 s23, s20, 4096
  s_add_u32 s21, s20, 25600
  v_mov_b32 v48, 0
  v_mov_b32 v49, 0
  v_mov_b32 v50, 0
  v_mov_b32 v51, 0
  v_mov_b32 v52, 0
  v_mov_b32 v53, 0
  v_mov_b32 v54, 0
  v_mov_b32 v55, 0
  v_mov_b32 v56, 0
  v_mov_b32 v57, 0
  v_mov_b32 v58, 0
  v_mov_b32 v59, 0
  v_mov_b32 v60, 0
  v_mov_b32 v61, 0
  v_mov_b32 v62, 0
  v_mov_b32 v63, 0
  v_mov_b32 v88, 0
  v_mov_b32 v89, 0
  v_mov_b32 v90, 0
  v_mov_b32 v91, 0
  v_mov_b32 v92, 0
  v_mov_b32 v93, 0
  v_mov_b32 v94, 0
  v_mov_b32 v95, 0
  v_mov_b32 v64, 0
  v_mov_b32 v65, 0
  s_mov_b32 s30, 0
  s_mov_b32 s62, 0
  s_waitcnt vmcnt(0)
  s_barrier
cB_sc1_ld:
  buffer_load_dwordx4 v[8:11], v2, s[8:11], s20 offen offset:0 sc1
  v_mov_b32 v36, 0
  v_mov_b32 v37, 0
  v_mov_b32 v38, 0
  v_mov_b32 v39, 0
  buffer_load_dwordx4 v[12:15], v2, s[8:11], s20 offen offset:1024 sc1
  v_mov_b32 v40, 0
  v_mov_b32 v41, 0
  v_mov_b32 v42, 0
  v_mov_b32 v43, 0
  buffer_load_dwordx4 v[16:19], v2, s[8:11], s20 offen offset:2048 sc1
  v_mov_b32 v44, 0
  v_mov_b32 v45, 0
  v_mov_b32 v46, 0
  v_mov_b32 v47, 0
  ds_read_b128 v[96:99], v117 offset:0
  ds_read_b128 v[100:103], v117 offset:1024
  ds_read_b128 v[104:107], v117 offset:14336
  ds_read_b128 v[108:111], v117 offset:15360
  s_waitcnt vmcnt(2)
  v_smfmac_f32_16x16x64_bf16 v[36:39], v[8:11], a[0:7], v3
  v_smfmac_f32_16x16x64_bf16 v[40:43], v[8:11], a[56:63], v3
  buffer_load_dwordx4 v[20:23], v2, s[8:11], s20 offen offset:3072 sc1
  v_smfmac_f32_16x16x64_bf16 v[44:47], v[8:11], a[112:119], v3
  v_smfmac_f32_16x16x64_bf16 v[48:51], v[8:11], a[168:175], v3
  v_smfmac_f32_16x16x64_bf16 v[52:55], v[8:11], a[224:231], v3
  buffer_load_dwordx4 v[24:27], v2, s[8:11], s23 offen offset:0 sc1
  v_smfmac_f32_16x16x64_bf16 v[56:59], v[8:11], v[144:151], v3
  v_smfmac_f32_16x16x64_bf16 v[60:63], v[8:11], v[200:207], v3
  s_waitcnt vmcnt(3)
  v_smfmac_f32_16x16x64_bf16 v[36:39], v[12:15], a[8:15], v3
  v_smfmac_f32_16x16x64_bf16 v[40:43], v[12:15], a[64:71], v3
  buffer_load_dwordx4 v[28:31], v2, s[8:11], s23 offen offset:1024 sc1
  v_smfmac_f32_16x16x64_bf16 v[44:47], v[12:15], a[120:127], v3
  v_smfmac_f32_16x16x64_bf16 v[48:51], v[12:15], a[176:183], v3
  v_smfmac_f32_16x16x64_bf16 v[52:55], v[12:15], a[232:239], v3
  buffer_load_dwordx4 v[32:35], v2, s[8:11], s23 offen offset:2048 sc1
  v_smfmac_f32_16x16x64_bf16 v[56:59], v[12:15], v[152:159], v3
  v_smfmac_f32_16x16x64_bf16 v[60:63], v[12:15], v[208:215], v3
  s_waitcnt vmcnt(4)
  v_smfmac_f32_16x16x64_bf16 v[36:39], v[16:19], a[16:23], v3
  v_smfmac_f32_16x16x64_bf16 v[40:43], v[16:19], a[72:79], v3
  v_smfmac_f32_16x16x64_bf16 v[44:47], v[16:19], a[128:135], v3
  v_smfmac_f32_16x16x64_bf16 v[48:51], v[16:19], a[184:191], v3
  v_smfmac_f32_16x16x64_bf16 v[52:55], v[16:19], a[240:247], v3
  v_smfmac_f32_16x16x64_bf16 v[56:59], v[16:19], v[160:167], v3
  v_smfmac_f32_16x16x64_bf16 v[60:63], v[16:19], v[216:223], v3
  s_waitcnt vmcnt(3)
  v_smfmac_f32_16x16x64_bf16 v[36:39], v[20:23], a[24:31], v3
  v_smfmac_f32_16x16x64_bf16 v[40:43], v[20:23], a[80:87], v3
  v_smfmac_f32_16x16x64_bf16 v[44:47], v[20:23], a[136:143], v3
  v_smfmac_f32_16x16x64_bf16 v[48:51], v[20:23], a[192:199], v3
  v_smfmac_f32_16x16x64_bf16 v[52:55], v[20:23], a[248:255], v3
  v_smfmac_f32_16x16x64_bf16 v[56:59], v[20:23], v[168:175], v3
  v_smfmac_f32_16x16x64_bf16 v[60:63], v[20:23], v[224:231], v3
  s_waitcnt vmcnt(0)
cB_sc1_ph2:
  v_smfmac_f32_16x16x64_bf16 v[60:63], v[24:27], v[232:239], v3
  ds_read_b128 v[16:19], v116 offset:2048
  ds_read_b128 v[20:23], v116 offset:3072
  v_smfmac_f32_16x16x64_bf16 v[60:63], v[28:31], v[240:247], v3
  buffer_load_dword v119, v0, s[8:11], s20 offen sc1
  v_smfmac_f32_16x16x64_bf16 v[60:63], v[32:35], v[248:255], v3
  v_mov_b32 v80, v26
  v_smfmac_f32_16x16x64_bf16 v[52:55], v[24:27], v[120:127], v3
  v_mov_b32 v81, v27
  v_smfmac_f32_16x16x64_bf16 v[52:55], v[28:31], v[128:135], v3
  v_mov_b32 v82, v32
  v_smfmac_f32_16x16x64_bf16 v[52:55], v[32:35], v[136:143], v3
  v_cvt_pk_bf16_f32 v66, v60, v61
  v_smfmac_f32_16x16x64_bf16 v[56:59], v[24:27], v[176:183], v3
  v_cvt_pk_bf16_f32 v67, v62, v63
  v_smfmac_f32_16x16x64_bf16 v[56:59], v[28:31], v[184:191], v3
  v_mov_b32 v83, v33
  v_mfma_f32_16x16x32_bf16 v[68:71], v[64:67], v[4:7], 0
  v_smfmac_f32_16x16x64_bf16 v[56:59], v[32:35], v[192:199], v3
  v_cvt_pk_bf16_f32 v64, v52, v53
  v_smfmac_f32_16x16x64_bf16 v[36:39], v[24:27], a[32:39], v3
  v_cvt_pk_bf16_f32 v65, v54, v55
  v_smfmac_f32_16x16x64_bf16 v[36:39], v[28:31], a[40:47], v3
  v_cvt_pk_bf16_f32 v78, v68, v69
  v_smfmac_f32_16x16x64_bf16 v[36:39], v[32:35], a[48:55], v3
  v_cvt_pk_bf16_f32 v79, v70, v71
  v_cvt_pk_bf16_f32 v66, v56, v57
  v_smfmac_f32_16x16x64_bf16 v[40:43], v[24:27], a[88:95], v3
  v_cvt_pk_bf16_f32 v67, v58, v59
  v_smfmac_f32_16x16x64_bf16 v[40:43], v[28:31], a[96:103], v3
  v_mfma_f32_16x16x32_bf16 v[72:75], v[64:67], v[4:7], 0
  ds_read_b128 v[52:55], v116 offset:16384
  ds_read_b128 v[56:59], v116 offset:17408
  v_smfmac_f32_16x16x64_bf16 v[40:43], v[32:35], a[104:111], v3
  v_cvt_pk_bf16_f32 v64, v36, v37
  v_smfmac_f32_16x16x64_bf16 v[44:47], v[24:27], a[144:151], v3
  v_cvt_pk_bf16_f32 v65, v38, v39
  v_smfmac_f32_16x16x64_bf16 v[44:47], v[28:31], a[152:159], v3
  v_cvt_pk_bf16_f32 v76, v72, v73
  v_smfmac_f32_16x16x64_bf16 v[44:47], v[32:35], a[160:167], v3
  v_cvt_pk_bf16_f32 v77, v74, v75
  v_cvt_pk_bf16_f32 v66, v40, v41
  v_smfmac_f32_16x16x64_bf16 v[48:51], v[24:27], a[200:207], v3
  v_cvt_pk_bf16_f32 v67, v42, v43
  v_smfmac_f32_16x16x64_bf16 v[48:51], v[28:31], a[208:215], v3
  v_mfma_f32_16x16x32_bf16 v[68:71], v[64:67], v[4:7], 0
  v_smfmac_f32_16x16x64_bf16 v[48:51], v[32:35], a[216:223], v3
  v_cvt_pk_bf16_f32 v64, v44, v45
  v_mfma_f32_16x16x32_bf16 v[84:87], v[80:83], v[76:79], 0
  v_cvt_pk_bf16_f32 v65, v46, v47
  s_waitcnt lgkmcnt(0)
  v_smfmac_f32_16x16x64_bf16 v[88:91], v[76:79], v[96:103], v3
  v_cvt_pk_bf16_f32 v60, v68, v69
  v_cvt_pk_bf16_f32 v61, v70, v71
  v_cvt_pk_bf16_f32 v66, v48, v49
  v_cvt_pk_bf16_f32 v67, v50, v51
  s_nop 1
  v_mfma_f32_16x16x32_bf16 v[72:75], v[64:67], v[4:7], 0
  v_smfmac_f32_16x16x64_bf16 v[92:95], v[76:79], v[104:111], v3
  s_nop 4
  v_cvt_pk_bf16_f32 v62, v72, v73
  v_cvt_pk_bf16_f32 v63, v74, v75
  s_nop 1
  v_mfma_f32_16x16x32_bf16 v[84:87], v[12:15], v[60:63], v[84:87]
  v_smfmac_f32_16x16x64_bf16 v[88:91], v[60:63], v[16:23], v3
  v_smfmac_f32_16x16x64_bf16 v[92:95], v[60:63], v[52:59], v3
  s_nop 1
  v_permlane32_swap_b32 v84, v86
  v_permlane32_swap_b32 v85, v87
  s_nop 0
  v_cmp_u_f32 vcc, v88, v89
  v_add_f32_dpp v84, v86, v84 row_ror:8 row_mask:0xf bank_mask:0xf
  v_add_f32_dpp v85, v87, v85 row_ror:8 row_mask:0xf bank_mask:0xf
  v_permlane32_swap_b32 v88, v92
  v_permlane32_swap_b32 v89, v93
  ds_write2_b32 v113, v84, v85 offset0:0 offset1:4
  v_permlane32_swap_b32 v90, v94
  v_permlane32_swap_b32 v91, v95
  v_add_f32 v88, v88, v92
  v_add_f32 v89, v89, v93
  v_add_f32 v90, v90, v94
  v_add_f32 v91, v91, v95
  ds_write2_b64 v112, v[88:89], v[90:91] offset0:0 offset1:128
  s_cbranch_vccnz cB_sc1_retry
cB_sc1_cont:
  s_waitcnt lgkmcnt(0)
  s_barrier
  ds_read_b128 v[36:39], v114
  ds_read_b128 v[44:47], v115
  s_waitcnt lgkmcnt(0)
  v_add_f32 v36, v36, v38
  v_add_f32 v37, v37, v39
  v_add_f32 v44, v44, v45
  v_add_f32 v46, v46, v47
  v_permlane32_swap_b32 v36, v37
  v_add_f32 v44, v44, v46
  v_add_f32 v36, v36, v37
  v_exp_f32 v49, v44
  v_exp_f32 v48, v36
  v_add_f32 v50, abs(v36), abs(v44)
  v_fma_f32 v39, v49, s37, v48
  v_cmp_ngt_f32 vcc, s56, v50
  v_cndmask_b32 v41, v48, v49, s[38:39]
  v_add_f32_dpp v39, v39, v39 quad_perm:[1,0,3,2] row_mask:0xf bank_mask:0xf
  v_cndmask_b32 v40, v49, v48, s[38:39]
  v_mov_b32_dpp v46, v41 quad_perm:[1,0,3,2] row_mask:0xf bank_mask:0xf
  v_add_f32_dpp v39, v39, v39 quad_perm:[2,3,0,1] row_mask:0xf bank_mask:0xf
  v_cndmask_b32 v42, v46, v40, s[38:39]
  v_cndmask_b32 v43, v40, v46, s[38:39]
  v_add_f32_dpp v39, v39, v39 row_half_mirror row_mask:0xf bank_mask:0xf
  s_cbranch_vccnz cB_sc1_slow
  s_nop 0
  v_add_f32_dpp v47, v39, v39 row_mirror row_mask:0xf bank_mask:0xf
  v_add_f32_dpp v39, v39, v39 row_mirror row_mask:0xf bank_mask:0xf
  s_nop 1
  v_permlane16_swap_b32 v39, v47
  v_add_f32 v39, v39, v47
  v_rcp_f32 v39, v39
  s_mov_b64 exec, s[28:29]
  v_mul_f32 v42, v42, v39
  v_mul_f32 v43, v43, v39
  v_cvt_pk_bf16_f32 v42, v42, v43
cB_sc1_pst:
  buffer_store_dword v42, v1, s[8:11], s20 offen sc1
  s_mov_b64 exec, -1
  s_barrier
  s_add_u32 s24, s24, 28672
  s_add_u32 s35, s35, 28672
  s_xor_b32 s25, s25, 28672
  s_add_u32 m0, s25, 7168
  s_nop 0
  buffer_load_dwordx4 v2, s[8:11], s24 offen offset:0 sc1 lds
  buffer_load_dwordx4 v2, s[8:11], s24 offen offset:1024 sc1 lds
  buffer_load_dwordx4 v2, s[8:11], s24 offen offset:2048 sc1 lds
  buffer_load_dwordx4 v2, s[8:11], s24 offen offset:3072 sc1 lds
  s_add_u32 m0, s25, 11264
  s_add_u32 s22, s24, 4096
  buffer_load_dwordx4 v2, s[8:11], s22 offen offset:0 sc1 lds
  buffer_load_dwordx4 v2, s[8:11], s22 offen offset:1024 sc1 lds
  buffer_load_dwordx4 v2, s[8:11], s22 offen offset:2048 sc1 lds
  v_xor_b32 v116, 28672, v116
  v_add_u32 v117, s57, v117
  s_sub_u32 s57, 0, s57
  s_add_u32 s19, s19, 1
  s_mov_b32 s20, s21
  s_cmp_lt_u32 s19, 63
  s_cbranch_scc1 cB_sc1_loop
  s_branch cB_done
cB_sc1_slow:
  v_max_f32 v50, v36, v44
  s_nop 1
  v_max_f32_dpp v50, v50, v50 quad_perm:[1,0,3,2] row_mask:0xf bank_mask:0xf
  s_nop 1
  v_max_f32_dpp v50, v50, v50 quad_perm:[2,3,0,1] row_mask:0xf bank_mask:0xf
  s_nop 1
  v_max_f32_dpp v50, v50, v50 row_half_mirror row_mask:0xf bank_mask:0xf
  s_nop 1
  v_max_f32_dpp v50, v50, v50 row_mirror row_mask:0xf bank_mask:0xf
  v_mov_b32 v47, v50
  s_nop 1
  v_permlane16_swap_b32 v50, v47
  v_max_f32 v50, v50, v47
  v_sub_f32 v48, v36, v50
  v_sub_f32 v49, v44, v50
  v_exp_f32 v48, v48
  v_exp_f32 v49, v49
  s_add_u32 s31, s31, 0x100
  v_fma_f32 v39, v49, s37, v48
  v_cndmask_b32 v41, v48, v49, s[38:39]
  s_nop 0
  v_add_f32_dpp v39, v39, v39 quad_perm:[1,0,3,2] row_mask:0xf bank_mask:0xf
  v_cndmask_b32 v40, v49, v48, s[38:39]
  v_mov_b32_dpp v46, v41 quad_perm:[1,0,3,2] row_mask:0xf bank_mask:0xf
  v_add_f32_dpp v39, v39, v39 quad_perm:[2,3,0,1] row_mask:0xf bank_mask:0xf
  v_cndmask_b32 v42, v46, v40, s[38:39]
  v_cndmask_b32 v43, v40, v46, s[38:39]
  v_add_f32_dpp v39, v39, v39 row_half_mirror row_mask:0xf bank_mask:0xf
  s_nop 1
  v_add_f32_dpp v47, v39, v39 row_mirror row_mask:0xf bank_mask:0xf
  v_add_f32_dpp v39, v39, v39 row_mirror row_mask:0xf bank_mask:0xf
  s_nop 1
  v_permlane16_swap_b32 v39, v47
  v_add_f32 v39, v39, v47
  v_rcp_f32 v39, v39
  s_mov_b64 exec, s[28:29]
  v_mul_f32 v42, v42, v39
  v_mul_f32 v43, v43, v39
  v_cvt_pk_bf16_f32 v42, v42, v43
  v_min_u32 v42, -2, v42
  s_branch cB_sc1_pst
cB_sc1_retry:
  s_cmp_lg_u32 s62, 0
  s_cbranch_scc1 cB_sc1_cont
  s_waitcnt vmcnt(0) lgkmcnt(0)
cB_sc1_rv:
  buffer_load_dwordx4 v[8:11], v2, s[8:11], s20 offen offset:0 sc1
  buffer_load_dwordx4 v[12:15], v2, s[8:11], s20 offen offset:1024 sc1
  buffer_load_dwordx4 v[16:19], v2, s[8:11], s20 offen offset:2048 sc1
  buffer_load_dwordx4 v[20:23], v2, s[8:11], s20 offen offset:3072 sc1
  buffer_load_dwordx4 v[24:27], v2, s[8:11], s23 offen offset:0 sc1
  buffer_load_dwordx4 v[28:31], v2, s[8:11], s23 offen offset:1024 sc1
  buffer_load_dwordx4 v[32:35], v2, s[8:11], s23 offen offset:2048 sc1
  s_waitcnt vmcnt(0)
  v_max3_u32 v118, v8, v9, v10
  v_max3_u32 v118, v118, v11, v12
  v_max3_u32 v118, v118, v13, v14
  v_max3_u32 v118, v118, v15, v16
  v_max3_u32 v118, v118, v17, v18
  v_max3_u32 v118, v118, v19, v20
  v_max3_u32 v118, v118, v21, v22
  v_max3_u32 v118, v118, v23, v24
  v_max3_u32 v118, v118, v25, v26
  v_max3_u32 v118, v118, v27, v28
  v_max3_u32 v118, v118, v29, v30
  v_max3_u32 v118, v118, v31, v32
  v_max3_u32 v118, v118, v33, v34
  v_max_u32 v118, v118, v35
  v_cmp_eq_u32 vcc, -1, v118
  s_cbranch_vccz cB_sc1_rk
  s_add_u32 s30, s30, 1
  s_cmp_lt_u32 s30, 400000
  s_cbranch_scc1 cB_sc1_rv
  s_branch cB_abort
cB_sc1_rk:
  s_mov_b32 s62, 1
  v_mov_b32 v36, 0
  v_mov_b32 v37, 0
  v_mov_b32 v38, 0
  v_mov_b32 v39, 0
  v_mov_b32 v40, 0
  v_mov_b32 v41, 0
  v_mov_b32 v42, 0
  v_mov_b32 v43, 0
  v_mov_b32 v44, 0
  v_mov_b32 v45, 0
  v_mov_b32 v46, 0
  v_mov_b32 v47, 0
  v_mov_b32 v48, 0
  v_mov_b32 v49, 0
  v_mov_b32 v50, 0
  v_mov_b32 v51, 0
  v_mov_b32 v52, 0
  v_mov_b32 v53, 0
  v_mov_b32 v54, 0
  v_mov_b32 v55, 0
  v_mov_b32 v56, 0
  v_mov_b32 v57, 0
  v_mov_b32 v58, 0
  v_mov_b32 v59, 0
  v_mov_b32 v60, 0
  v_mov_b32 v61, 0
  v_mov_b32 v62, 0
  v_mov_b32 v63, 0
  v_mov_b32 v88, 0
  v_mov_b32 v89, 0
  v_mov_b32 v90, 0
  v_mov_b32 v91, 0
  v_mov_b32 v92, 0
  v_mov_b32 v93, 0
  v_mov_b32 v94, 0
  v_mov_b32 v95, 0
  v_mov_b32 v64, 0
  v_mov_b32 v65, 0
  s_add_u32 s31, s31, 1
  ds_read_b128 v[96:99], v117 offset:0
  ds_read_b128 v[100:103], v117 offset:1024
  ds_read_b128 v[104:107], v117 offset:14336
  ds_read_b128 v[108:111], v117 offset:15360
  v_smfmac_f32_16x16x64_bf16 v[36:39], v[8:11], a[0:7], v3
  v_smfmac_f32_16x16x64_bf16 v[40:43], v[8:11], a[56:63], v3
  v_smfmac_f32_16x16x64_bf16 v[44:47], v[8:11], a[112:119], v3
  v_smfmac_f32_16x16x64_bf16 v[48:51], v[8:11], a[168:175], v3
  v_smfmac_f32_16x16x64_bf16 v[52:55], v[8:11], a[224:231], v3
  v_smfmac_f32_16x16x64_bf16 v[56:59], v[8:11], v[144:151], v3
  v_smfmac_f32_16x16x64_bf16 v[60:63], v[8:11], v[200:207], v3
  v_smfmac_f32_16x16x64_bf16 v[36:39], v[12:15], a[8:15], v3
  v_smfmac_f32_16x16x64_bf16 v[40:43], v[12:15], a[64:71], v3
  v_smfmac_f32_16x16x64_bf16 v[44:47], v[12:15], a[120:127], v3
  v_smfmac_f32_16x16x64_bf16 v[48:51], v[12:15], a[176:183], v3
  v_smfmac_f32_16x16x64_bf16 v[52:55], v[12:15], a[232:239], v3
  v_smfmac_f32_16x16x64_bf16 v[56:59], v[12:15], v[152:159], v3
  v_smfmac_f32_16x16x64_bf16 v[60:63], v[12:15], v[208:215], v3
  v_smfmac_f32_16x16x64_bf16 v[36:39], v[16:19], a[16:23], v3
  v_smfmac_f32_16x16x64_bf16 v[40:43], v[16:19], a[72:79], v3
  v_smfmac_f32_16x16x64_bf16 v[44:47], v[16:19], a[128:135], v3
  v_smfmac_f32_16x16x64_bf16 v[48:51], v[16:19], a[184:191], v3
  v_smfmac_f32_16x16x64_bf16 v[52:55], v[16:19], a[240:247], v3
  v_smfmac_f32_16x16x64_bf16 v[56:59], v[16:19], v[160:167], v3
  v_smfmac_f32_16x16x64_bf16 v[60:63], v[16:19], v[216:223], v3
  v_smfmac_f32_16x16x64_bf16 v[36:39], v[20:23], a[24:31], v3
  v_smfmac_f32_16x16x64_bf16 v[40:43], v[20:23], a[80:87], v3
  v_smfmac_f32_16x16x64_bf16 v[44:47], v[20:23], a[136:143], v3
  v_smfmac_f32_16x16x64_bf16 v[48:51], v[20:23], a[192:199], v3
  v_smfmac_f32_16x16x64_bf16 v[52:55], v[20:23], a[248:255], v3
  v_smfmac_f32_16x16x64_bf16 v[56:59], v[20:23], v[168:175], v3
  v_smfmac_f32_16x16x64_bf16 v[60:63], v[20:23], v[224:231], v3
  s_branch cB_sc1_ph2
.p2align 6

cB_sc2_loop:
  s_add_u32 s23, s20, 4096
  s_add_u32 s21, s20, 25600
  v_mov_b32 v48, 0
  v_mov_b32 v49, 0
  v_mov_b32 v50, 0
  v_mov_b32 v51, 0
  v_mov_b32 v52, 0
  v_mov_b32 v53, 0
  v_mov_b32 v54, 0
  v_mov_b32 v55, 0
  v_mov_b32 v56, 0
  v_mov_b32 v57, 0
  v_mov_b32 v58, 0
  v_mov_b32 v59, 0
  v_mov_b32 v60, 0
  v_mov_b32 v61, 0
  v_mov_b32 v62, 0
  v_mov_b32 v63, 0
  v_mov_b32 v88, 0
  v_mov_b32 v89, 0
  v_mov_b32 v90, 0
  v_mov_b32 v91, 0
  v_mov_b32 v92, 0
  v_mov_b32 v93, 0
  v_mov_b32 v94, 0
  v_mov_b32 v95, 0
  v_mov_b32 v66, 0
  v_mov_b32 v67, 0
  s_mov_b32 s30, 0
  s_mov_b32 s62, 0
  s_waitcnt vmcnt(0)
  s_barrier
cB_sc2_ld:
  buffer_load_dwordx4 v[8:11], v2, s[8:11], s20 offen offset:0 sc1
  v_mov_b32 v36, 0
  v_mov_b32 v37, 0
  v_mov_b32 v38, 0
  v_mov_b32 v39, 0
  buffer_load_dwordx4 v[12:15], v2, s[8:11], s20 offen offset:1024 sc1
  v_mov_b32 v40, 0
  v_mov_b32 v41, 0
  v_mov_b32 v42, 0
  v_mov_b32 v43, 0
  buffer_load_dwordx4 v[16:19], v2, s[8:11], s20 offen offset:2048 sc1
  v_mov_b32 v44, 0
  v_mov_b32 v45, 0
  v_mov_b32 v46, 0
  v_mov_b32 v47, 0
  ds_read_b128 v[96:99], v117 offset:0
  ds_read_b128 v[100:103], v117 offset:1024
  ds_read_b128 v[104:107], v117 offset:14336
  ds_read_b128 v[108:111], v117 offset:15360
  s_waitcnt vmcnt(2)
  v_smfmac_f32_16x16x64_bf16 v[36:39], v[8:11], a[0:7], v3
  v_smfmac_f32_16x16x64_bf16 v[40:43], v[8:11], a[56:63], v3
  buffer_load_dwordx4 v[20:23], v2, s[8:11], s20 offen offset:3072 sc1
  v_smfmac_f32_16x16x64_bf16 v[44:47], v[8:11], a[112:119], v3
  v_smfmac_f32_16x16x64_bf16 v[48:51], v[8:11], a[168:175], v3
  v_smfmac_f32_16x16x64_bf16 v[52:55], v[8:11], a[224:231], v3
  buffer_load_dwordx4 v[24:27], v2, s[8:11], s23 offen offset:0 sc1
  v_smfmac_f32_16x16x64_bf16 v[56:59], v[8:11], v[144:151], v3
  v_smfmac_f32_16x16x64_bf16 v[60:63], v[8:11], v[200:207], v3
  s_waitcnt vmcnt(3)
  v_smfmac_f32_16x16x64_bf16 v[36:39], v[12:15], a[8:15], v3
  v_smfmac_f32_16x16x64_bf16 v[40:43], v[12:15], a[64:71], v3
  buffer_load_dwordx4 v[28:31], v2, s[8:11], s23 offen offset:1024 sc1
  v_smfmac_f32_16x16x64_bf16 v[44:47], v[12:15], a[120:127], v3
  v_smfmac_f32_16x16x64_bf16 v[48:51], v[12:15], a[176:183], v3
  v_smfmac_f32_16x16x64_bf16 v[52:55], v[12:15], a[232:239], v3
  buffer_load_dwordx4 v[32:35], v2, s[8:11], s23 offen offset:2048 sc1
  v_smfmac_f32_16x16x64_bf16 v[56:59], v[12:15], v[152:159], v3
  v_smfmac_f32_16x16x64_bf16 v[60:63], v[12:15], v[208:215], v3
  s_waitcnt vmcnt(4)
  v_smfmac_f32_16x16x64_bf16 v[36:39], v[16:19], a[16:23], v3
  v_smfmac_f32_16x16x64_bf16 v[40:43], v[16:19], a[72:79], v3
  v_smfmac_f32_16x16x64_bf16 v[44:47], v[16:19], a[128:135], v3
  v_smfmac_f32_16x16x64_bf16 v[48:51], v[16:19], a[184:191], v3
  v_smfmac_f32_16x16x64_bf16 v[52:55], v[16:19], a[240:247], v3
  v_smfmac_f32_16x16x64_bf16 v[56:59], v[16:19], v[160:167], v3
  v_smfmac_f32_16x16x64_bf16 v[60:63], v[16:19], v[216:223], v3
  s_waitcnt vmcnt(3)
  v_smfmac_f32_16x16x64_bf16 v[36:39], v[20:23], a[24:31], v3
  v_smfmac_f32_16x16x64_bf16 v[40:43], v[20:23], a[80:87], v3
  v_smfmac_f32_16x16x64_bf16 v[44:47], v[20:23], a[136:143], v3
  v_smfmac_f32_16x16x64_bf16 v[48:51], v[20:23], a[192:199], v3
  v_smfmac_f32_16x16x64_bf16 v[52:55], v[20:23], a[248:255], v3
  v_smfmac_f32_16x16x64_bf16 v[56:59], v[20:23], v[168:175], v3
  v_smfmac_f32_16x16x64_bf16 v[60:63], v[20:23], v[224:231], v3
  s_waitcnt vmcnt(0)
cB_sc2_ph2:
  v_smfmac_f32_16x16x64_bf16 v[60:63], v[24:27], v[232:239], v3
  ds_read_b128 v[8:11], v116 offset:4096
  ds_read_b128 v[12:15], v116 offset:5120
  v_smfmac_f32_16x16x64_bf16 v[60:63], v[28:31], v[240:247], v3
  buffer_load_dword v119, v0, s[8:11], s24 offen sc1
  v_smfmac_f32_16x16x64_bf16 v[60:63], v[32:35], v[248:255], v3
  v_mov_b32 v80, v28
  v_smfmac_f32_16x16x64_bf16 v[52:55], v[24:27], v[120:127], v3
  v_mov_b32 v81, v29
  v_smfmac_f32_16x16x64_bf16 v[52:55], v[28:31], v[128:135], v3
  v_mov_b32 v82, v34
  v_smfmac_f32_16x16x64_bf16 v[52:55], v[32:35], v[136:143], v3
  v_cvt_pk_bf16_f32 v64, v60, v61
  v_smfmac_f32_16x16x64_bf16 v[56:59], v[24:27], v[176:183], v3
  v_cvt_pk_bf16_f32 v65, v62, v63
  v_smfmac_f32_16x16x64_bf16 v[56:59], v[28:31], v[184:191], v3
  v_mov_b32 v83, v35
  v_mfma_f32_16x16x32_bf16 v[68:71], v[64:67], v[4:7], 0
  v_smfmac_f32_16x16x64_bf16 v[56:59], v[32:35], v[192:199], v3
  v_cvt_pk_bf16_f32 v64, v52, v53
  v_smfmac_f32_16x16x64_bf16 v[36:39], v[24:27], a[32:39], v3
  v_cvt_pk_bf16_f32 v65, v54, v55
  v_smfmac_f32_16x16x64_bf16 v[36:39], v[28:31], a[40:47], v3
  v_cvt_pk_bf16_f32 v78, v68, v69
  v_smfmac_f32_16x16x64_bf16 v[36:39], v[32:35], a[48:55], v3
  v_cvt_pk_bf16_f32 v79, v70, v71
  v_cvt_pk_bf16_f32 v66, v56, v57
  v_smfmac_f32_16x16x64_bf16 v[40:43], v[24:27], a[88:95], v3
  v_cvt_pk_bf16_f32 v67, v58, v59
  v_smfmac_f32_16x16x64_bf16 v[40:43], v[28:31], a[96:103], v3
  v_mfma_f32_16x16x32_bf16 v[72:75], v[64:67], v[4:7], 0
  ds_read_b128 v[52:55], v116 offset:18432
  ds_read_b128 v[56:59], v116 offset:19456
  v_smfmac_f32_16x16x64_bf16 v[40:43], v[32:35], a[104:111], v3
  v_cvt_pk_bf16_f32 v64, v36, v37
  v_smfmac_f32_16x16x64_bf16 v[44:47], v[24:27], a[144:151], v3
  v_cvt_pk_bf16_f32 v65, v38, v39
  v_smfmac_f32_16x16x64_bf16 v[44:47], v[28:31], a[152:159], v3
  v_cvt_pk_bf16_f32 v76, v72, v73
  v_smfmac_f32_16x16x64_bf16 v[44:47], v[32:35], a[160:167], v3
  v_cvt_pk_bf16_f32 v77, v74, v75
  v_cvt_pk_bf16_f32 v66, v40, v41
  v_smfmac_f32_16x16x64_bf16 v[48:51], v[24:27], a[200:207], v3
  v_cvt_pk_bf16_f32 v67, v42, v43
  v_smfmac_f32_16x16x64_bf16 v[48:51], v[28:31], a[208:215], v3
  v_mfma_f32_16x16x32_bf16 v[68:71], v[64:67], v[4:7], 0
  v_smfmac_f32_16x16x64_bf16 v[48:51], v[32:35], a[216:223], v3
  v_cvt_pk_bf16_f32 v64, v44, v45
  v_mfma_f32_16x16x32_bf16 v[84:87], v[80:83], v[76:79], 0
  v_cvt_pk_bf16_f32 v65, v46, v47
  s_waitcnt lgkmcnt(0)
  v_smfmac_f32_16x16x64_bf16 v[88:91], v[76:79], v[96:103], v3
  v_cvt_pk_bf16_f32 v60, v68, v69
  v_cvt_pk_bf16_f32 v61, v70, v71
  v_cvt_pk_bf16_f32 v66, v48, v49
  v_cvt_pk_bf16_f32 v67, v50, v51
  s_nop 1
  v_mfma_f32_16x16x32_bf16 v[72:75], v[64:67], v[4:7], 0
  v_smfmac_f32_16x16x64_bf16 v[92:95], v[76:79], v[104:111], v3
  s_nop 4
  v_cvt_pk_bf16_f32 v62, v72, v73
  v_cvt_pk_bf16_f32 v63, v74, v75
  s_nop 1
  v_mfma_f32_16x16x32_bf16 v[84:87], v[16:19], v[60:63], v[84:87]
  v_smfmac_f32_16x16x64_bf16 v[88:91], v[60:63], v[8:15], v3
  v_smfmac_f32_16x16x64_bf16 v[92:95], v[60:63], v[52:59], v3
  s_nop 1
  v_permlane32_swap_b32 v84, v86
  v_permlane32_swap_b32 v85, v87
  s_nop 0
  v_cmp_u_f32 vcc, v88, v89
  v_add_f32_dpp v84, v86, v84 row_ror:8 row_mask:0xf bank_mask:0xf
  v_add_f32_dpp v85, v87, v85 row_ror:8 row_mask:0xf bank_mask:0xf
  v_permlane32_swap_b32 v88, v92
  v_permlane32_swap_b32 v89, v93
  ds_write2_b32 v113, v84, v85 offset0:0 offset1:4
  v_permlane32_swap_b32 v90, v94
  v_permlane32_swap_b32 v91, v95
  v_add_f32 v88, v88, v92
  v_add_f32 v89, v89, v93
  v_add_f32 v90, v90, v94
  v_add_f32 v91, v91, v95
  ds_write2_b64 v112, v[88:89], v[90:91] offset0:0 offset1:128
  s_cbranch_vccnz cB_sc2_retry
cB_sc2_cont:
  s_waitcnt lgkmcnt(0)
  s_barrier
  ds_read_b128 v[36:39], v114
  ds_read_b128 v[44:47], v115
  v_lshl_add_u32 v56, v2, 3, s36
  s_waitcnt lgkmcnt(0)
  v_add_f32 v36, v36, v38
  v_add_f32 v37, v37, v39
  v_add_f32 v44, v44, v45
  s_mov_b64 exec, 65535
  buffer_store_dword v2, v56, s[8:11], s20 offen sc1
  s_mov_b64 exec, -1
  v_add_f32 v46, v46, v47
  v_permlane32_swap_b32 v36, v37
  v_add_f32 v44, v44, v46
  v_add_f32 v36, v36, v37
  v_exp_f32 v49, v44
  v_exp_f32 v48, v36
  v_add_f32 v50, abs(v36), abs(v44)
  v_fma_f32 v39, v49, s37, v48
  v_cmp_ngt_f32 vcc, s56, v50
  v_cndmask_b32 v41, v48, v49, s[38:39]
  v_add_f32_dpp v39, v39, v39 quad_perm:[1,0,3,2] row_mask:0xf bank_mask:0xf
  v_cndmask_b32 v40, v49, v48, s[38:39]
  v_mov_b32_dpp v46, v41 quad_perm:[1,0,3,2] row_mask:0xf bank_mask:0xf
  v_add_f32_dpp v39, v39, v39 quad_perm:[2,3,0,1] row_mask:0xf bank_mask:0xf
  v_cndmask_b32 v42, v46, v40, s[38:39]
  v_cndmask_b32 v43, v40, v46, s[38:39]
  v_add_f32_dpp v39, v39, v39 row_half_mirror row_mask:0xf bank_mask:0xf
  s_cbranch_vccnz cB_sc2_slow
  s_nop 0
  v_add_f32_dpp v47, v39, v39 row_mirror row_mask:0xf bank_mask:0xf
  v_add_f32_dpp v39, v39, v39 row_mirror row_mask:0xf bank_mask:0xf
  s_nop 1
  v_permlane16_swap_b32 v39, v47
  v_add_f32 v39, v39, v47
  v_rcp_f32 v39, v39
  s_mov_b64 exec, s[28:29]
  v_mul_f32 v42, v42, v39
  v_mul_f32 v43, v43, v39
  v_cvt_pk_bf16_f32 v42, v42, v43
cB_sc2_pst:
  buffer_store_dword v42, v1, s[8:11], s20 offen sc1
  s_mov_b64 exec, -1
  s_barrier
  s_add_u32 s24, s24, 28672
  s_add_u32 s35, s35, 28672
  s_xor_b32 s25, s25, 28672
  s_add_u32 m0, s25, 14336
  s_nop 0
  buffer_load_dwordx4 v2, s[8:11], s24 offen offset:0 sc1 lds
  buffer_load_dwordx4 v2, s[8:11], s24 offen offset:1024 sc1 lds
  buffer_load_dwordx4 v2, s[8:11], s24 offen offset:2048 sc1 lds
  buffer_load_dwordx4 v2, s[8:11], s24 offen offset:3072 sc1 lds
  s_add_u32 m0, s25, 18432
  s_add_u32 s22, s24, 4096
  buffer_load_dwordx4 v2, s[8:11], s22 offen offset:0 sc1 lds
  buffer_load_dwordx4 v2, s[8:11], s22 offen offset:1024 sc1 lds
  buffer_load_dwordx4 v2, s[8:11], s22 offen offset:2048 sc1 lds
  v_xor_b32 v116, 28672, v116
  v_add_u32 v117, s57, v117
  s_sub_u32 s57, 0, s57
  s_add_u32 s19, s19, 1
  s_mov_b32 s20, s21
  s_cmp_lt_u32 s19, 63
  s_cbranch_scc1 cB_sc2_loop
  s_branch cB_done
cB_sc2_slow:
  v_max_f32 v50, v36, v44
  s_nop 1
  v_max_f32_dpp v50, v50, v50 quad_perm:[1,0,3,2] row_mask:0xf bank_mask:0xf
  s_nop 1
  v_max_f32_dpp v50, v50, v50 quad_perm:[2,3,0,1] row_mask:0xf bank_mask:0xf
  s_nop 1
  v_max_f32_dpp v50, v50, v50 row_half_mirror row_mask:0xf bank_mask:0xf
  s_nop 1
  v_max_f32_dpp v50, v50, v50 row_mirror row_mask:0xf bank_mask:0xf
  v_mov_b32 v47, v50
  s_nop 1
  v_permlane16_swap_b32 v50, v47
  v_max_f32 v50, v50, v47
  v_sub_f32 v48, v36, v50
  v_sub_f32 v49, v44, v50
  v_exp_f32 v48, v48
  v_exp_f32 v49, v49
  s_add_u32 s31, s31, 0x100
  v_fma_f32 v39, v49, s37, v48
  v_cndmask_b32 v41, v48, v49, s[38:39]
  s_nop 0
  v_add_f32_dpp v39, v39, v39 quad_perm:[1,0,3,2] row_mask:0xf bank_mask:0xf
  v_cndmask_b32 v40, v49, v48, s[38:39]
  v_mov_b32_dpp v46, v41 quad_perm:[1,0,3,2] row_mask:0xf bank_mask:0xf
  v_add_f32_dpp v39, v39, v39 quad_perm:[2,3,0,1] row_mask:0xf bank_mask:0xf
  v_cndmask_b32 v42, v46, v40, s[38:39]
  v_cndmask_b32 v43, v40, v46, s[38:39]
  v_add_f32_dpp v39, v39, v39 row_half_mirror row_mask:0xf bank_mask:0xf
  s_nop 1
  v_add_f32_dpp v47, v39, v39 row_mirror row_mask:0xf bank_mask:0xf
  v_add_f32_dpp v39, v39, v39 row_mirror row_mask:0xf bank_mask:0xf
  s_nop 1
  v_permlane16_swap_b32 v39, v47
  v_add_f32 v39, v39, v47
  v_rcp_f32 v39, v39
  s_mov_b64 exec, s[28:29]
  v_mul_f32 v42, v42, v39
  v_mul_f32 v43, v43, v39
  v_cvt_pk_bf16_f32 v42, v42, v43
  v_min_u32 v42, -2, v42
  s_branch cB_sc2_pst
cB_sc2_retry:
  s_cmp_lg_u32 s62, 0
  s_cbranch_scc1 cB_sc2_cont
  s_waitcnt vmcnt(0) lgkmcnt(0)
cB_sc2_rv:
  buffer_load_dwordx4 v[8:11], v2, s[8:11], s20 offen offset:0 sc1
  buffer_load_dwordx4 v[12:15], v2, s[8:11], s20 offen offset:1024 sc1
  buffer_load_dwordx4 v[16:19], v2, s[8:11], s20 offen offset:2048 sc1
  buffer_load_dwordx4 v[20:23], v2, s[8:11], s20 offen offset:3072 sc1
  buffer_load_dwordx4 v[24:27], v2, s[8:11], s23 offen offset:0 sc1
  buffer_load_dwordx4 v[28:31], v2, s[8:11], s23 offen offset:1024 sc1
  buffer_load_dwordx4 v[32:35], v2, s[8:11], s23 offen offset:2048 sc1
  s_waitcnt vmcnt(0)
  v_max3_u32 v118, v8, v9, v10
  v_max3_u32 v118, v118, v11, v12
  v_max3_u32 v118, v118, v13, v14
  v_max3_u32 v118, v118, v15, v16
  v_max3_u32 v118, v118, v17, v18
  v_max3_u32 v118, v118, v19, v20
  v_max3_u32 v118, v118, v21, v22
  v_max3_u32 v118, v118, v23, v24
  v_max3_u32 v118, v118, v25, v26
  v_max3_u32 v118, v118, v27, v28
  v_max3_u32 v118, v118, v29, v30
  v_max3_u32 v118, v118, v31, v32
  v_max3_u32 v118, v118, v33, v34
  v_max_u32 v118, v118, v35
  v_cmp_eq_u32 vcc, -1, v118
  s_cbranch_vccz cB_sc2_rk
  s_add_u32 s30, s30, 1
  s_cmp_lt_u32 s30, 400000
  s_cbranch_scc1 cB_sc2_rv
  s_branch cB_abort
cB_sc2_rk:
  s_mov_b32 s62, 1
  v_mov_b32 v36, 0
  v_mov_b32 v37, 0
  v_mov_b32 v38, 0
  v_mov_b32 v39, 0
  v_mov_b32 v40, 0
  v_mov_b32 v41, 0
  v_mov_b32 v42, 0
  v_mov_b32 v43, 0
  v_mov_b32 v44, 0
  v_mov_b32 v45, 0
  v_mov_b32 v46, 0
  v_mov_b32 v47, 0
  v_mov_b32 v48, 0
  v_mov_b32 v49, 0
  v_mov_b32 v50, 0
  v_mov_b32 v51, 0
  v_mov_b32 v52, 0
  v_mov_b32 v53, 0
  v_mov_b32 v54, 0
  v_mov_b32 v55, 0
  v_mov_b32 v56, 0
  v_mov_b32 v57, 0
  v_mov_b32 v58, 0
  v_mov_b32 v59, 0
  v_mov_b32 v60, 0
  v_mov_b32 v61, 0
  v_mov_b32 v62, 0
  v_mov_b32 v63, 0
  v_mov_b32 v88, 0
  v_mov_b32 v89, 0
  v_mov_b32 v90, 0
  v_mov_b32 v91, 0
  v_mov_b32 v92, 0
  v_mov_b32 v93, 0
  v_mov_b32 v94, 0
  v_mov_b32 v95, 0
  v_mov_b32 v66, 0
  v_mov_b32 v67, 0
  s_add_u32 s31, s31, 1
  ds_read_b128 v[96:99], v117 offset:0
  ds_read_b128 v[100:103], v117 offset:1024
  ds_read_b128 v[104:107], v117 offset:14336
  ds_read_b128 v[108:111], v117 offset:15360
  v_smfmac_f32_16x16x64_bf16 v[36:39], v[8:11], a[0:7], v3
  v_smfmac_f32_16x16x64_bf16 v[40:43], v[8:11], a[56:63], v3
  v_smfmac_f32_16x16x64_bf16 v[44:47], v[8:11], a[112:119], v3
  v_smfmac_f32_16x16x64_bf16 v[48:51], v[8:11], a[168:175], v3
  v_smfmac_f32_16x16x64_bf16 v[52:55], v[8:11], a[224:231], v3
  v_smfmac_f32_16x16x64_bf16 v[56:59], v[8:11], v[144:151], v3
  v_smfmac_f32_16x16x64_bf16 v[60:63], v[8:11], v[200:207], v3
  v_smfmac_f32_16x16x64_bf16 v[36:39], v[12:15], a[8:15], v3
  v_smfmac_f32_16x16x64_bf16 v[40:43], v[12:15], a[64:71], v3
  v_smfmac_f32_16x16x64_bf16 v[44:47], v[12:15], a[120:127], v3
  v_smfmac_f32_16x16x64_bf16 v[48:51], v[12:15], a[176:183], v3
  v_smfmac_f32_16x16x64_bf16 v[52:55], v[12:15], a[232:239], v3
  v_smfmac_f32_16x16x64_bf16 v[56:59], v[12:15], v[152:159], v3
  v_smfmac_f32_16x16x64_bf16 v[60:63], v[12:15], v[208:215], v3
  v_smfmac_f32_16x16x64_bf16 v[36:39], v[16:19], a[16:23], v3
  v_smfmac_f32_16x16x64_bf16 v[40:43], v[16:19], a[72:79], v3
  v_smfmac_f32_16x16x64_bf16 v[44:47], v[16:19], a[128:135], v3
  v_smfmac_f32_16x16x64_bf16 v[48:51], v[16:19], a[184:191], v3
  v_smfmac_f32_16x16x64_bf16 v[52:55], v[16:19], a[240:247], v3
  v_smfmac_f32_16x16x64_bf16 v[56:59], v[16:19], v[160:167], v3
  v_smfmac_f32_16x16x64_bf16 v[60:63], v[16:19], v[216:223], v3
  v_smfmac_f32_16x16x64_bf16 v[36:39], v[20:23], a[24:31], v3
  v_smfmac_f32_16x16x64_bf16 v[40:43], v[20:23], a[80:87], v3
  v_smfmac_f32_16x16x64_bf16 v[44:47], v[20:23], a[136:143], v3
  v_smfmac_f32_16x16x64_bf16 v[48:51], v[20:23], a[192:199], v3
  v_smfmac_f32_16x16x64_bf16 v[52:55], v[20:23], a[248:255], v3
  v_smfmac_f32_16x16x64_bf16 v[56:59], v[20:23], v[168:175], v3
  v_smfmac_f32_16x16x64_bf16 v[60:63], v[20:23], v[224:231], v3
  s_branch cB_sc2_ph2
.p2align 6

cB_sc3_loop:
  s_add_u32 s23, s20, 4096
  s_add_u32 s21, s20, 25600
  v_mov_b32 v48, 0
  v_mov_b32 v49, 0
  v_mov_b32 v50, 0
  v_mov_b32 v51, 0
  v_mov_b32 v52, 0
  v_mov_b32 v53, 0
  v_mov_b32 v54, 0
  v_mov_b32 v55, 0
  v_mov_b32 v56, 0
  v_mov_b32 v57, 0
  v_mov_b32 v58, 0
  v_mov_b32 v59, 0
  v_mov_b32 v60, 0
  v_mov_b32 v61, 0
  v_mov_b32 v62, 0
  v_mov_b32 v63, 0
  v_mov_b32 v88, 0
  v_mov_b32 v89, 0
  v_mov_b32 v90, 0
  v_mov_b32 v91, 0
  v_mov_b32 v92, 0
  v_mov_b32 v93, 0
  v_mov_b32 v94, 0
  v_mov_b32 v95, 0
  v_mov_b32 v64, 0
  v_mov_b32 v65, 0
  s_mov_b32 s30, 0
  s_mov_b32 s62, 0
  s_waitcnt vmcnt(0)
  s_barrier
cB_sc3_ld:
  buffer_load_dwordx4 v[8:11], v2, s[8:11], s20 offen offset:0 sc1
  v_mov_b32 v36, 0
  v_mov_b32 v37, 0
  v_mov_b32 v38, 0
  v_mov_b32 v39, 0
  buffer_load_dwordx4 v[12:15], v2, s[8:11], s20 offen offset:1024 sc1
  v_mov_b32 v40, 0
  v_mov_b32 v41, 0
  v_mov_b32 v42, 0
  v_mov_b32 v43, 0
  buffer_load_dwordx4 v[16:19], v2, s[8:11], s20 offen offset:2048 sc1
  v_mov_b32 v44, 0
  v_mov_b32 v45, 0
  v_mov_b32 v46, 0
  v_mov_b32 v47, 0
  ds_read_b128 v[96:99], v117 offset:0
  ds_read_b128 v[100:103], v117 offset:1024
  ds_read_b128 v[104:107], v117 offset:14336
  ds_read_b128 v[108:111], v117 offset:15360
  s_waitcnt vmcnt(2)
  v_smfmac_f32_16x16x64_bf16 v[36:39], v[8:11], a[0:7], v3
  v_smfmac_f32_16x16x64_bf16 v[40:43], v[8:11], a[56:63], v3
  buffer_load_dwordx4 v[20:23], v2, s[8:11], s20 offen offset:3072 sc1
  v_smfmac_f32_16x16x64_bf16 v[44:47], v[8:11], a[112:119], v3
  v_smfmac_f32_16x16x64_bf16 v[48:51], v[8:11], a[168:175], v3
  v_smfmac_f32_16x16x64_bf16 v[52:55], v[8:11], a[224:231], v3
  buffer_load_dwordx4 v[24:27], v2, s[8:11], s23 offen offset:0 sc1
  v_smfmac_f32_16x16x64_bf16 v[56:59], v[8:11], v[144:151], v3
  v_smfmac_f32_16x16x64_bf16 v[60:63], v[8:11], v[200:207], v3
  s_waitcnt vmcnt(3)
  v_smfmac_f32_16x16x64_bf16 v[36:39], v[12:15], a[8:15], v3
  v_smfmac_f32_16x16x64_bf16 v[40:43], v[12:15], a[64:71], v3
  buffer_load_dwordx4 v[28:31], v2, s[8:11], s23 offen offset:1024 sc1
  v_smfmac_f32_16x16x64_bf16 v[44:47], v[12:15], a[120:127], v3
  v_smfmac_f32_16x16x64_bf16 v[48:51], v[12:15], a[176:183], v3
  v_smfmac_f32_16x16x64_bf16 v[52:55], v[12:15], a[232:239], v3
  buffer_load_dwordx4 v[32:35], v2, s[8:11], s23 offen offset:2048 sc1
  v_smfmac_f32_16x16x64_bf16 v[56:59], v[12:15], v[152:159], v3
  v_smfmac_f32_16x16x64_bf16 v[60:63], v[12:15], v[208:215], v3
  s_waitcnt vmcnt(4)
  v_smfmac_f32_16x16x64_bf16 v[36:39], v[16:19], a[16:23], v3
  v_smfmac_f32_16x16x64_bf16 v[40:43], v[16:19], a[72:79], v3
  v_smfmac_f32_16x16x64_bf16 v[44:47], v[16:19], a[128:135], v3
  v_smfmac_f32_16x16x64_bf16 v[48:51], v[16:19], a[184:191], v3
  v_smfmac_f32_16x16x64_bf16 v[52:55], v[16:19], a[240:247], v3
  v_smfmac_f32_16x16x64_bf16 v[56:59], v[16:19], v[160:167], v3
  v_smfmac_f32_16x16x64_bf16 v[60:63], v[16:19], v[216:223], v3
  s_waitcnt vmcnt(3)
  v_smfmac_f32_16x16x64_bf16 v[36:39], v[20:23], a[24:31], v3
  v_smfmac_f32_16x16x64_bf16 v[40:43], v[20:23], a[80:87], v3
  v_smfmac_f32_16x16x64_bf16 v[44:47], v[20:23], a[136:143], v3
  v_smfmac_f32_16x16x64_bf16 v[48:51], v[20:23], a[192:199], v3
  v_smfmac_f32_16x16x64_bf16 v[52:55], v[20:23], a[248:255], v3
  v_smfmac_f32_16x16x64_bf16 v[56:59], v[20:23], v[168:175], v3
  v_smfmac_f32_16x16x64_bf16 v[60:63], v[20:23], v[224:231], v3
  s_waitcnt vmcnt(0)
cB_sc3_ph2:
  v_smfmac_f32_16x16x64_bf16 v[60:63], v[24:27], v[232:239], v3
  ds_read_b128 v[8:11], v116 offset:6144
  ds_read_b128 v[12:15], v116 offset:7168
  v_smfmac_f32_16x16x64_bf16 v[60:63], v[28:31], v[240:247], v3
  v_smfmac_f32_16x16x64_bf16 v[60:63], v[32:35], v[248:255], v3
  v_mov_b32 v80, v30
  v_smfmac_f32_16x16x64_bf16 v[52:55], v[24:27], v[120:127], v3
  v_mov_b32 v81, v31
  v_smfmac_f32_16x16x64_bf16 v[52:55], v[28:31], v[128:135], v3
  v_mov_b32 v82, v34
  v_smfmac_f32_16x16x64_bf16 v[52:55], v[32:35], v[136:143], v3
  v_cvt_pk_bf16_f32 v66, v60, v61
  v_smfmac_f32_16x16x64_bf16 v[56:59], v[24:27], v[176:183], v3
  v_cvt_pk_bf16_f32 v67, v62, v63
  v_smfmac_f32_16x16x64_bf16 v[56:59], v[28:31], v[184:191], v3
  v_mov_b32 v83, v35
  v_mfma_f32_16x16x32_bf16 v[68:71], v[64:67], v[4:7], 0
  v_smfmac_f32_16x16x64_bf16 v[56:59], v[32:35], v[192:199], v3
  v_cvt_pk_bf16_f32 v64, v52, v53
  v_smfmac_f32_16x16x64_bf16 v[36:39], v[24:27], a[32:39], v3
  v_cvt_pk_bf16_f32 v65, v54, v55
  v_smfmac_f32_16x16x64_bf16 v[36:39], v[28:31], a[40:47], v3
  v_cvt_pk_bf16_f32 v78, v68, v69
  v_smfmac_f32_16x16x64_bf16 v[36:39], v[32:35], a[48:55], v3
  v_cvt_pk_bf16_f32 v79, v70, v71
  v_cvt_pk_bf16_f32 v66, v56, v57
  v_smfmac_f32_16x16x64_bf16 v[40:43], v[24:27], a[88:95], v3
  v_cvt_pk_bf16_f32 v67, v58, v59
  v_smfmac_f32_16x16x64_bf16 v[40:43], v[28:31], a[96:103], v3
  v_mfma_f32_16x16x32_bf16 v[72:75], v[64:67], v[4:7], 0
  ds_read_b128 v[52:55], v116 offset:20480
  ds_read_b128 v[56:59], v116 offset:21504
  v_smfmac_f32_16x16x64_bf16 v[40:43], v[32:35], a[104:111], v3
  v_cvt_pk_bf16_f32 v64, v36, v37
  v_smfmac_f32_16x16x64_bf16 v[44:47], v[24:27], a[144:151], v3
  v_cvt_pk_bf16_f32 v65, v38, v39
  v_smfmac_f32_16x16x64_bf16 v[44:47], v[28:31], a[152:159], v3
  v_cvt_pk_bf16_f32 v76, v72, v73
  v_smfmac_f32_16x16x64_bf16 v[44:47], v[32:35], a[160:167], v3
  v_cvt_pk_bf16_f32 v77, v74, v75
  v_cvt_pk_bf16_f32 v66, v40, v41
  v_smfmac_f32_16x16x64_bf16 v[48:51], v[24:27], a[200:207], v3
  v_cvt_pk_bf16_f32 v67, v42, v43
  v_smfmac_f32_16x16x64_bf16 v[48:51], v[28:31], a[208:215], v3
  v_mfma_f32_16x16x32_bf16 v[68:71], v[64:67], v[4:7], 0
  v_smfmac_f32_16x16x64_bf16 v[48:51], v[32:35], a[216:223], v3
  v_cvt_pk_bf16_f32 v64, v44, v45
  v_mfma_f32_16x16x32_bf16 v[84:87], v[80:83], v[76:79], 0
  v_cvt_pk_bf16_f32 v65, v46, v47
  s_waitcnt lgkmcnt(0)
  v_smfmac_f32_16x16x64_bf16 v[88:91], v[76:79], v[96:103], v3
  v_cvt_pk_bf16_f32 v60, v68, v69
  v_cvt_pk_bf16_f32 v61, v70, v71
  v_cvt_pk_bf16_f32 v66, v48, v49
  v_cvt_pk_bf16_f32 v67, v50, v51
  s_nop 1
  v_mfma_f32_16x16x32_bf16 v[72:75], v[64:67], v[4:7], 0
  v_smfmac_f32_16x16x64_bf16 v[92:95], v[76:79], v[104:111], v3
  s_nop 4
  v_cvt_pk_bf16_f32 v62, v72, v73
  v_cvt_pk_bf16_f32 v63, v74, v75
  s_nop 1
  v_mfma_f32_16x16x32_bf16 v[84:87], v[20:23], v[60:63], v[84:87]
  v_smfmac_f32_16x16x64_bf16 v[88:91], v[60:63], v[8:15], v3
  v_smfmac_f32_16x16x64_bf16 v[92:95], v[60:63], v[52:59], v3
  s_nop 1
  v_permlane32_swap_b32 v84, v86
  v_permlane32_swap_b32 v85, v87
  s_nop 0
  v_cmp_u_f32 vcc, v88, v89
  v_add_f32_dpp v84, v86, v84 row_ror:8 row_mask:0xf bank_mask:0xf
  v_add_f32_dpp v85, v87, v85 row_ror:8 row_mask:0xf bank_mask:0xf
  v_permlane32_swap_b32 v88, v92
  v_permlane32_swap_b32 v89, v93
  ds_write2_b32 v113, v84, v85 offset0:0 offset1:4
  v_permlane32_swap_b32 v90, v94
  v_permlane32_swap_b32 v91, v95
  v_add_f32 v88, v88, v92
  v_add_f32 v89, v89, v93
  v_add_f32 v90, v90, v94
  v_add_f32 v91, v91, v95
  ds_write2_b64 v112, v[88:89], v[90:91] offset0:0 offset1:128
  s_cbranch_vccnz cB_sc3_retry
cB_sc3_cont:
  s_waitcnt lgkmcnt(0)
  s_barrier
  ds_read_b128 v[36:39], v114
  ds_read_b128 v[44:47], v115
  s_waitcnt lgkmcnt(0)
  v_add_f32 v36, v36, v38
  v_add_f32 v37, v37, v39
  v_add_f32 v44, v44, v45
  v_add_f32 v46, v46, v47
  v_permlane32_swap_b32 v36, v37
  v_add_f32 v44, v44, v46
  v_add_f32 v36, v36, v37
  v_exp_f32 v49, v44
  v_exp_f32 v48, v36
  v_add_f32 v50, abs(v36), abs(v44)
  v_fma_f32 v39, v49, s37, v48
  v_cmp_ngt_f32 vcc, s56, v50
  v_cndmask_b32 v41, v48, v49, s[38:39]
  v_add_f32_dpp v39, v39, v39 quad_perm:[1,0,3,2] row_mask:0xf bank_mask:0xf
  v_cndmask_b32 v40, v49, v48, s[38:39]
  v_mov_b32_dpp v46, v41 quad_perm:[1,0,3,2] row_mask:0xf bank_mask:0xf
  v_add_f32_dpp v39, v39, v39 quad_perm:[2,3,0,1] row_mask:0xf bank_mask:0xf
  v_cndmask_b32 v42, v46, v40, s[38:39]
  v_cndmask_b32 v43, v40, v46, s[38:39]
  v_add_f32_dpp v39, v39, v39 row_half_mirror row_mask:0xf bank_mask:0xf
  s_cbranch_vccnz cB_sc3_slow
  s_nop 0
  v_add_f32_dpp v47, v39, v39 row_mirror row_mask:0xf bank_mask:0xf
  v_add_f32_dpp v39, v39, v39 row_mirror row_mask:0xf bank_mask:0xf
  s_nop 1
  v_permlane16_swap_b32 v39, v47
  v_add_f32 v39, v39, v47
  v_rcp_f32 v39, v39
  s_mov_b64 exec, s[28:29]
  v_mul_f32 v42, v42, v39
  v_mul_f32 v43, v43, v39
  v_cvt_pk_bf16_f32 v42, v42, v43
cB_sc3_pst:
  buffer_store_dword v42, v1, s[8:11], s20 offen sc1
  s_mov_b64 exec, -1
  s_barrier
  s_add_u32 s24, s24, 28672
  s_add_u32 s35, s35, 28672
  s_xor_b32 s25, s25, 28672
  s_add_u32 m0, s25, 21504
  s_nop 0
  buffer_load_dwordx4 v2, s[8:11], s24 offen offset:0 sc1 lds
  buffer_load_dwordx4 v2, s[8:11], s24 offen offset:1024 sc1 lds
  buffer_load_dwordx4 v2, s[8:11], s24 offen offset:2048 sc1 lds
  buffer_load_dwordx4 v2, s[8:11], s24 offen offset:3072 sc1 lds
  s_add_u32 m0, s25, 25600
  s_add_u32 s22, s24, 4096
  buffer_load_dwordx4 v2, s[8:11], s22 offen offset:0 sc1 lds
  buffer_load_dwordx4 v2, s[8:11], s22 offen offset:1024 sc1 lds
  buffer_load_dwordx4 v2, s[8:11], s22 offen offset:2048 sc1 lds
  v_xor_b32 v116, 28672, v116
  v_add_u32 v117, s57, v117
  s_sub_u32 s57, 0, s57
  s_add_u32 s19, s19, 1
  s_mov_b32 s20, s21
  s_cmp_lt_u32 s19, 63
  s_cbranch_scc1 cB_sc3_loop
  s_branch cB_done
cB_sc3_slow:
  v_max_f32 v50, v36, v44
  s_nop 1
  v_max_f32_dpp v50, v50, v50 quad_perm:[1,0,3,2] row_mask:0xf bank_mask:0xf
  s_nop 1
  v_max_f32_dpp v50, v50, v50 quad_perm:[2,3,0,1] row_mask:0xf bank_mask:0xf
  s_nop 1
  v_max_f32_dpp v50, v50, v50 row_half_mirror row_mask:0xf bank_mask:0xf
  s_nop 1
  v_max_f32_dpp v50, v50, v50 row_mirror row_mask:0xf bank_mask:0xf
  v_mov_b32 v47, v50
  s_nop 1
  v_permlane16_swap_b32 v50, v47
  v_max_f32 v50, v50, v47
  v_sub_f32 v48, v36, v50
  v_sub_f32 v49, v44, v50
  v_exp_f32 v48, v48
  v_exp_f32 v49, v49
  s_add_u32 s31, s31, 0x100
  v_fma_f32 v39, v49, s37, v48
  v_cndmask_b32 v41, v48, v49, s[38:39]
  s_nop 0
  v_add_f32_dpp v39, v39, v39 quad_perm:[1,0,3,2] row_mask:0xf bank_mask:0xf
  v_cndmask_b32 v40, v49, v48, s[38:39]
  v_mov_b32_dpp v46, v41 quad_perm:[1,0,3,2] row_mask:0xf bank_mask:0xf
  v_add_f32_dpp v39, v39, v39 quad_perm:[2,3,0,1] row_mask:0xf bank_mask:0xf
  v_cndmask_b32 v42, v46, v40, s[38:39]
  v_cndmask_b32 v43, v40, v46, s[38:39]
  v_add_f32_dpp v39, v39, v39 row_half_mirror row_mask:0xf bank_mask:0xf
  s_nop 1
  v_add_f32_dpp v47, v39, v39 row_mirror row_mask:0xf bank_mask:0xf
  v_add_f32_dpp v39, v39, v39 row_mirror row_mask:0xf bank_mask:0xf
  s_nop 1
  v_permlane16_swap_b32 v39, v47
  v_add_f32 v39, v39, v47
  v_rcp_f32 v39, v39
  s_mov_b64 exec, s[28:29]
  v_mul_f32 v42, v42, v39
  v_mul_f32 v43, v43, v39
  v_cvt_pk_bf16_f32 v42, v42, v43
  v_min_u32 v42, -2, v42
  s_branch cB_sc3_pst
cB_sc3_retry:
  s_cmp_lg_u32 s62, 0
  s_cbranch_scc1 cB_sc3_cont
  s_waitcnt vmcnt(0) lgkmcnt(0)
cB_sc3_rv:
  buffer_load_dwordx4 v[8:11], v2, s[8:11], s20 offen offset:0 sc1
  buffer_load_dwordx4 v[12:15], v2, s[8:11], s20 offen offset:1024 sc1
  buffer_load_dwordx4 v[16:19], v2, s[8:11], s20 offen offset:2048 sc1
  buffer_load_dwordx4 v[20:23], v2, s[8:11], s20 offen offset:3072 sc1
  buffer_load_dwordx4 v[24:27], v2, s[8:11], s23 offen offset:0 sc1
  buffer_load_dwordx4 v[28:31], v2, s[8:11], s23 offen offset:1024 sc1
  buffer_load_dwordx4 v[32:35], v2, s[8:11], s23 offen offset:2048 sc1
  s_waitcnt vmcnt(0)
  v_max3_u32 v118, v8, v9, v10
  v_max3_u32 v118, v118, v11, v12
  v_max3_u32 v118, v118, v13, v14
  v_max3_u32 v118, v118, v15, v16
  v_max3_u32 v118, v118, v17, v18
  v_max3_u32 v118, v118, v19, v20
  v_max3_u32 v118, v118, v21, v22
  v_max3_u32 v118, v118, v23, v24
  v_max3_u32 v118, v118, v25, v26
  v_max3_u32 v118, v118, v27, v28
  v_max3_u32 v118, v118, v29, v30
  v_max3_u32 v118, v118, v31, v32
  v_max3_u32 v118, v118, v33, v34
  v_max_u32 v118, v118, v35
  v_cmp_eq_u32 vcc, -1, v118
  s_cbranch_vccz cB_sc3_rk
  s_add_u32 s30, s30, 1
  s_cmp_lt_u32 s30, 400000
  s_cbranch_scc1 cB_sc3_rv
  s_branch cB_abort
cB_sc3_rk:
  s_mov_b32 s62, 1
  v_mov_b32 v36, 0
  v_mov_b32 v37, 0
  v_mov_b32 v38, 0
  v_mov_b32 v39, 0
  v_mov_b32 v40, 0
  v_mov_b32 v41, 0
  v_mov_b32 v42, 0
  v_mov_b32 v43, 0
  v_mov_b32 v44, 0
  v_mov_b32 v45, 0
  v_mov_b32 v46, 0
  v_mov_b32 v47, 0
  v_mov_b32 v48, 0
  v_mov_b32 v49, 0
  v_mov_b32 v50, 0
  v_mov_b32 v51, 0
  v_mov_b32 v52, 0
  v_mov_b32 v53, 0
  v_mov_b32 v54, 0
  v_mov_b32 v55, 0
  v_mov_b32 v56, 0
  v_mov_b32 v57, 0
  v_mov_b32 v58, 0
  v_mov_b32 v59, 0
  v_mov_b32 v60, 0
  v_mov_b32 v61, 0
  v_mov_b32 v62, 0
  v_mov_b32 v63, 0
  v_mov_b32 v88, 0
  v_mov_b32 v89, 0
  v_mov_b32 v90, 0
  v_mov_b32 v91, 0
  v_mov_b32 v92, 0
  v_mov_b32 v93, 0
  v_mov_b32 v94, 0
  v_mov_b32 v95, 0
  v_mov_b32 v64, 0
  v_mov_b32 v65, 0
  s_add_u32 s31, s31, 1
  ds_read_b128 v[96:99], v117 offset:0
  ds_read_b128 v[100:103], v117 offset:1024
  ds_read_b128 v[104:107], v117 offset:14336
  ds_read_b128 v[108:111], v117 offset:15360
  v_smfmac_f32_16x16x64_bf16 v[36:39], v[8:11], a[0:7], v3
  v_smfmac_f32_16x16x64_bf16 v[40:43], v[8:11], a[56:63], v3
  v_smfmac_f32_16x16x64_bf16 v[44:47], v[8:11], a[112:119], v3
  v_smfmac_f32_16x16x64_bf16 v[48:51], v[8:11], a[168:175], v3
  v_smfmac_f32_16x16x64_bf16 v[52:55], v[8:11], a[224:231], v3
  v_smfmac_f32_16x16x64_bf16 v[56:59], v[8:11], v[144:151], v3
  v_smfmac_f32_16x16x64_bf16 v[60:63], v[8:11], v[200:207], v3
  v_smfmac_f32_16x16x64_bf16 v[36:39], v[12:15], a[8:15], v3
  v_smfmac_f32_16x16x64_bf16 v[40:43], v[12:15], a[64:71], v3
  v_smfmac_f32_16x16x64_bf16 v[44:47], v[12:15], a[120:127], v3
  v_smfmac_f32_16x16x64_bf16 v[48:51], v[12:15], a[176:183], v3
  v_smfmac_f32_16x16x64_bf16 v[52:55], v[12:15], a[232:239], v3
  v_smfmac_f32_16x16x64_bf16 v[56:59], v[12:15], v[152:159], v3
  v_smfmac_f32_16x16x64_bf16 v[60:63], v[12:15], v[208:215], v3
  v_smfmac_f32_16x16x64_bf16 v[36:39], v[16:19], a[16:23], v3
  v_smfmac_f32_16x16x64_bf16 v[40:43], v[16:19], a[72:79], v3
  v_smfmac_f32_16x16x64_bf16 v[44:47], v[16:19], a[128:135], v3
  v_smfmac_f32_16x16x64_bf16 v[48:51], v[16:19], a[184:191], v3
  v_smfmac_f32_16x16x64_bf16 v[52:55], v[16:19], a[240:247], v3
  v_smfmac_f32_16x16x64_bf16 v[56:59], v[16:19], v[160:167], v3
  v_smfmac_f32_16x16x64_bf16 v[60:63], v[16:19], v[216:223], v3
  v_smfmac_f32_16x16x64_bf16 v[36:39], v[20:23], a[24:31], v3
  v_smfmac_f32_16x16x64_bf16 v[40:43], v[20:23], a[80:87], v3
  v_smfmac_f32_16x16x64_bf16 v[44:47], v[20:23], a[136:143], v3
  v_smfmac_f32_16x16x64_bf16 v[48:51], v[20:23], a[192:199], v3
  v_smfmac_f32_16x16x64_bf16 v[52:55], v[20:23], a[248:255], v3
  v_smfmac_f32_16x16x64_bf16 v[56:59], v[20:23], v[168:175], v3
  v_smfmac_f32_16x16x64_bf16 v[60:63], v[20:23], v[224:231], v3
  s_branch cB_sc3_ph2
.p2align 6

cB_va0_loop:
  s_add_u32 s23, s20, 4096
  s_add_u32 s21, s20, 25600
  s_mov_b32 s30, 0
  s_cmp_lg_u32 s19, s38
  s_cbranch_scc1 cB_va0_vok
  s_branch cB_va0_voc
cB_va0_vow:
  s_nop 0
  buffer_load_dword v63, off, s[8:11], s35 sc1
  s_waitcnt vmcnt(0)
cB_va0_voc:
  v_readfirstlane_b32 s22, v63
  s_cmp_eq_u32 s22, 56
  s_cbranch_scc1 cB_va0_vod
  s_sleep 1
  s_add_u32 s30, s30, 1
  s_cmp_lt_u32 s30, 400000
  s_cbranch_scc1 cB_va0_vow
  s_branch cB_abort
cB_va0_vod:
  s_add_u32 s35, s35, 2048
  s_add_u32 s38, s19, 8
  s_and_b32 s38, s38, -8
  s_cmp_eq_u32 s19, 0
  s_cselect_b32 s38, 4, s38
cB_va0_vok:
  s_cmp_eq_u32 s19, 63
  s_cbranch_scc1 cB_done
  s_barrier
  s_add_u32 s22, s25, 0
  buffer_load_dwordx4 v[80:83], v6, s[8:11], s22 offen offset:0 sc1
  buffer_load_dwordx4 v[84:87], v6, s[8:11], s22 offen offset:1792 sc1
  s_add_u32 s22, s25, 3584
  buffer_load_dwordx4 v[88:91], v6, s[8:11], s22 offen offset:0 sc1
  buffer_load_dwordx4 v[92:95], v6, s[8:11], s22 offen offset:1792 sc1
  s_add_u32 s22, s25, 7168
  buffer_load_dwordx4 v[96:99], v6, s[8:11], s22 offen offset:0 sc1
  buffer_load_dwordx4 v[100:103], v6, s[8:11], s22 offen offset:1792 sc1
  s_add_u32 s22, s25, 10752
  buffer_load_dwordx4 v[104:107], v6, s[8:11], s22 offen offset:0 sc1
  buffer_load_dwordx4 v[108:111], v6, s[8:11], s22 offen offset:1792 sc1
  s_add_u32 s22, s25, 14336
  buffer_load_dwordx4 v[112:115], v6, s[8:11], s22 offen offset:0 sc1
  buffer_load_dwordx4 v[116:119], v6, s[8:11], s22 offen offset:1792 sc1
  s_add_u32 s22, s25, 17920
  buffer_load_dwordx4 v[120:123], v6, s[8:11], s22 offen offset:0 sc1
  buffer_load_dwordx4 v[124:127], v6, s[8:11], s22 offen offset:1792 sc1
  s_add_u32 s22, s25, 21504
  buffer_load_dwordx4 v[128:131], v6, s[8:11], s22 offen offset:0 sc1
  buffer_load_dwordx4 v[132:135], v6, s[8:11], s22 offen offset:1792 sc1
  s_add_u32 s22, s25, 25088
  buffer_load_dwordx4 v[136:139], v6, s[8:11], s22 offen offset:0 sc1
  buffer_load_dwordx4 v[140:143], v6, s[8:11], s22 offen offset:1792 sc1
  s_add_u32 s22, s19, 1
  s_cmp_lg_u32 s22, s38
  s_cbranch_scc1 cB_va0_nk
  buffer_load_dword v63, off, s[8:11], s35 sc1
cB_va0_nk:
  s_barrier
  ds_read_b128 v[8:11], v2 offset:8192
  ds_read_b128 v[12:15], v2 offset:9216
  ds_read_b128 v[16:19], v2 offset:10240
  ds_read_b128 v[20:23], v2 offset:11264
  ds_read_b128 v[24:27], v2 offset:12288
  ds_read_b128 v[28:31], v2 offset:13312
  ds_read_b128 v[32:35], v2 offset:14336
  s_waitcnt lgkmcnt(0)
  v_smfmac_f32_16x16x64_bf16 v[36:39], v[8:11], a[0:7], v3
  v_smfmac_f32_16x16x64_bf16 v[36:39], v[12:15], a[8:15], v3
  v_smfmac_f32_16x16x64_bf16 v[36:39], v[16:19], a[16:23], v3
  v_smfmac_f32_16x16x64_bf16 v[36:39], v[20:23], a[24:31], v3
  v_smfmac_f32_16x16x64_bf16 v[36:39], v[24:27], a[32:39], v3
  v_smfmac_f32_16x16x64_bf16 v[36:39], v[28:31], a[40:47], v3
  v_smfmac_f32_16x16x64_bf16 v[36:39], v[32:35], a[48:55], v3
  v_smfmac_f32_16x16x64_bf16 v[40:43], v[8:11], a[56:63], v3
  v_smfmac_f32_16x16x64_bf16 v[40:43], v[12:15], a[64:71], v3
  v_smfmac_f32_16x16x64_bf16 v[40:43], v[16:19], a[72:79], v3
  v_smfmac_f32_16x16x64_bf16 v[40:43], v[20:23], a[80:87], v3
  v_smfmac_f32_16x16x64_bf16 v[40:43], v[24:27], a[88:95], v3
  v_smfmac_f32_16x16x64_bf16 v[40:43], v[28:31], a[96:103], v3
  v_smfmac_f32_16x16x64_bf16 v[40:43], v[32:35], a[104:111], v3
  v_smfmac_f32_16x16x64_bf16 v[44:47], v[8:11], a[112:119], v3
  v_smfmac_f32_16x16x64_bf16 v[44:47], v[12:15], a[120:127], v3
  v_smfmac_f32_16x16x64_bf16 v[44:47], v[16:19], a[128:135], v3
  v_smfmac_f32_16x16x64_bf16 v[44:47], v[20:23], a[136:143], v3
  v_permlane32_swap_b32 v36, v40
  v_smfmac_f32_16x16x64_bf16 v[44:47], v[24:27], a[144:151], v3
  v_permlane32_swap_b32 v37, v41
  v_smfmac_f32_16x16x64_bf16 v[44:47], v[28:31], a[152:159], v3
  v_permlane32_swap_b32 v38, v42
  v_smfmac_f32_16x16x64_bf16 v[44:47], v[32:35], a[160:167], v3
  v_permlane32_swap_b32 v39, v43
  v_smfmac_f32_16x16x64_bf16 v[48:51], v[8:11], a[168:175], v3
  v_add_f32 v36, v36, v40
  v_smfmac_f32_16x16x64_bf16 v[48:51], v[12:15], a[176:183], v3
  v_add_f32 v37, v37, v41
  v_smfmac_f32_16x16x64_bf16 v[48:51], v[16:19], a[184:191], v3
  v_add_f32 v38, v38, v42
  v_smfmac_f32_16x16x64_bf16 v[48:51], v[20:23], a[192:199], v3
  v_add_f32 v39, v39, v43
  v_smfmac_f32_16x16x64_bf16 v[48:51], v[24:27], a[200:207], v3
  v_cvt_pk_bf16_f32 v40, v36, v37
  v_smfmac_f32_16x16x64_bf16 v[48:51], v[28:31], a[208:215], v3
  v_cvt_pk_bf16_f32 v41, v38, v39
  v_smfmac_f32_16x16x64_bf16 v[48:51], v[32:35], a[216:223], v3
  ds_write2_b32 v60, v40, v41 offset0:0 offset1:2
  v_smfmac_f32_16x16x64_bf16 v[52:55], v[8:11], a[224:231], v3
  v_smfmac_f32_16x16x64_bf16 v[52:55], v[12:15], a[232:239], v3
  v_smfmac_f32_16x16x64_bf16 v[52:55], v[16:19], a[240:247], v3
  v_smfmac_f32_16x16x64_bf16 v[52:55], v[20:23], a[248:255], v3
  v_permlane32_swap_b32 v44, v48
  v_smfmac_f32_16x16x64_bf16 v[52:55], v[24:27], v[176:183], v3
  v_permlane32_swap_b32 v45, v49
  v_smfmac_f32_16x16x64_bf16 v[52:55], v[28:31], v[184:191], v3
  v_permlane32_swap_b32 v46, v50
  v_smfmac_f32_16x16x64_bf16 v[52:55], v[32:35], v[192:199], v3
  v_permlane32_swap_b32 v47, v51
  v_smfmac_f32_16x16x64_bf16 v[56:59], v[8:11], v[200:207], v3
  v_add_f32 v44, v44, v48
  v_smfmac_f32_16x16x64_bf16 v[56:59], v[12:15], v[208:215], v3
  v_add_f32 v45, v45, v49
  v_smfmac_f32_16x16x64_bf16 v[56:59], v[16:19], v[216:223], v3
  v_add_f32 v46, v46, v50
  v_smfmac_f32_16x16x64_bf16 v[56:59], v[20:23], v[224:231], v3
  v_add_f32 v47, v47, v51
  v_smfmac_f32_16x16x64_bf16 v[56:59], v[24:27], v[232:239], v3
  v_cvt_pk_bf16_f32 v48, v44, v45
  v_smfmac_f32_16x16x64_bf16 v[56:59], v[28:31], v[240:247], v3
  v_cvt_pk_bf16_f32 v49, v46, v47
  v_smfmac_f32_16x16x64_bf16 v[56:59], v[32:35], v[248:255], v3
  ds_write2_b32 v61, v48, v49 offset0:0 offset1:2
  s_nop 6
  v_permlane32_swap_b32 v52, v56
  v_permlane32_swap_b32 v53, v57
  v_permlane32_swap_b32 v54, v58
  v_permlane32_swap_b32 v55, v59
  v_add_f32 v52, v52, v56
  v_add_f32 v53, v53, v57
  v_add_f32 v54, v54, v58
  v_add_f32 v55, v55, v59
  v_cvt_pk_bf16_f32 v56, v52, v53
  v_cvt_pk_bf16_f32 v57, v54, v55
  ds_write2_b32 v62, v56, v57 offset0:0 offset1:2
  s_cmp_eq_u32 s19, 63
  s_cbranch_scc1 cB_va0_last
  s_add_u32 s22, s20, 9216
  s_add_u32 s34, s20, 13312
  s_add_u32 s36, s20, 7168
  s_mov_b32 s37, 0
  v_mov_b32 v156, 0
  v_mov_b32 v157, 0
  v_mov_b32 v158, 0
  v_mov_b32 v159, 0
  buffer_load_dword v164, v4, s[8:11], s20 offen sc1
  s_nop 7
  buffer_load_dword v165, v4, s[8:11], s20 offen sc1
  s_nop 7
  buffer_load_dword v166, v4, s[8:11], s20 offen sc1
  s_nop 7
  buffer_load_dword v167, v4, s[8:11], s20 offen sc1
  s_nop 7
  buffer_load_dword v168, v4, s[8:11], s20 offen sc1
cB_va0_fw_l:
  s_waitcnt vmcnt(4)
  v_cmp_eq_u32 vcc, -1, v164
  s_cbranch_vccz cB_va0_fw_d
  buffer_load_dword v164, v4, s[8:11], s20 offen sc1
  s_waitcnt vmcnt(4)
  v_cmp_eq_u32 vcc, -1, v165
  s_cbranch_vccz cB_va0_fw_d
  buffer_load_dword v165, v4, s[8:11], s20 offen sc1
  s_waitcnt vmcnt(4)
  v_cmp_eq_u32 vcc, -1, v166
  s_cbranch_vccz cB_va0_fw_d
  buffer_load_dword v166, v4, s[8:11], s20 offen sc1
  s_waitcnt vmcnt(4)
  v_cmp_eq_u32 vcc, -1, v167
  s_cbranch_vccz cB_va0_fw_d
  buffer_load_dword v167, v4, s[8:11], s20 offen sc1
  s_waitcnt vmcnt(4)
  v_cmp_eq_u32 vcc, -1, v168
  s_cbranch_vccz cB_va0_fw_d
  buffer_load_dword v168, v4, s[8:11], s20 offen sc1
  s_add_u32 s30, s30, 1
  s_cmp_lt_u32 s30, 400000
  s_cbranch_scc1 cB_va0_fw_l
  s_branch cB_abort
cB_va0_fw_d:
  s_waitcnt lgkmcnt(0)
  buffer_load_dwordx4 v[8:11], v5, s[8:11], s22 offen offset:0 sc1
  v_mov_b32 v36, 0
  v_mov_b32 v37, 0
  v_mov_b32 v38, 0
  buffer_load_dwordx4 v[12:15], v5, s[8:11], s22 offen offset:1024 sc1
  v_mov_b32 v39, 0
  v_mov_b32 v40, 0
  v_mov_b32 v41, 0
  buffer_load_dwordx4 v[16:19], v5, s[8:11], s22 offen offset:2048 sc1
  v_mov_b32 v42, 0
  v_mov_b32 v43, 0
  v_mov_b32 v44, 0
  buffer_load_dwordx4 v[20:23], v5, s[8:11], s22 offen offset:3072 sc1
  v_mov_b32 v45, 0
  v_mov_b32 v46, 0
  v_mov_b32 v47, 0
  buffer_load_dwordx4 v[24:27], v5, s[8:11], s34 offen offset:0 sc1
  v_mov_b32 v48, 0
  v_mov_b32 v49, 0
  v_mov_b32 v50, 0
  buffer_load_dwordx4 v[28:31], v5, s[8:11], s34 offen offset:1024 sc1
  v_mov_b32 v51, 0
  v_mov_b32 v52, 0
  v_mov_b32 v53, 0
  buffer_load_dwordx4 v[32:35], v5, s[8:11], s34 offen offset:2048 sc1
  v_mov_b32 v54, 0
  v_mov_b32 v55, 0
  v_mov_b32 v56, 0
  buffer_load_dwordx4 v[144:147], v5, s[8:11], s34 offen offset:3072 sc1
  v_mov_b32 v57, 0
  v_mov_b32 v58, 0
  v_mov_b32 v59, 0
  buffer_load_dwordx4 v[148:151], v2, s[8:11], s36 offen offset:0 sc1
  buffer_load_dwordx4 v[152:155], v2, s[8:11], s36 offen offset:1024 sc1
  s_barrier
  ds_read_b128 v[64:67], v2 offset:0
  ds_read_b128 v[68:71], v2 offset:1024
  ds_read_b128 v[72:75], v2 offset:2048
  ds_read_b128 v[76:79], v2 offset:3072
  s_waitcnt vmcnt(9)
  v_smfmac_f32_16x16x64_bf16 v[156:159], v[8:11], v[80:87], v0
  s_waitcnt vmcnt(8)
  v_smfmac_f32_16x16x64_bf16 v[156:159], v[12:15], v[88:95], v0
  s_waitcnt vmcnt(7)
  v_smfmac_f32_16x16x64_bf16 v[156:159], v[16:19], v[96:103], v0
  s_waitcnt vmcnt(6)
  v_smfmac_f32_16x16x64_bf16 v[156:159], v[20:23], v[104:111], v0
  s_waitcnt vmcnt(5)
  v_smfmac_f32_16x16x64_bf16 v[156:159], v[24:27], v[112:119], v0
  s_mov_b32 exec_hi, 0
  buffer_store_dword v2, v7, s[8:11], s21 offen sc1
  s_mov_b64 exec, -1
  s_waitcnt vmcnt(5)
  v_smfmac_f32_16x16x64_bf16 v[156:159], v[28:31], v[120:127], v0
  s_waitcnt vmcnt(4)
  v_smfmac_f32_16x16x64_bf16 v[156:159], v[32:35], v[128:135], v0
  s_waitcnt vmcnt(3)
  v_smfmac_f32_16x16x64_bf16 v[156:159], v[144:147], v[136:143], v0
  s_waitcnt vmcnt(2) lgkmcnt(0)
  v_smfmac_f32_16x16x64_bf16 v[156:159], v[148:151], v[64:71], v0
  s_waitcnt vmcnt(1)
  v_smfmac_f32_16x16x64_bf16 v[156:159], v[152:155], v[72:79], v0
cB_va0_ep:
  s_nop 7
  v_add_f32 v160, v156, v157
  v_add_f32 v161, v158, v159
  v_cmp_u_f32 vcc, v160, v161
  v_mov_b32_dpp v162, v160 row_ror:8 row_mask:0xf bank_mask:0xf
  v_mov_b32_dpp v160, v161 row_ror:8 row_mask:0xf bank_mask:0xc
  s_cbranch_vccnz cB_va0_rp
  v_mov_b32_dpp v161, v162 quad_perm:[0,1,2,3] row_mask:0xf bank_mask:0x3
  v_cvt_pk_bf16_f32 v160, v160, v161
cB_va0_pc:
  buffer_store_dword v160, v1, s[8:11], s21 offen sc1
  s_cmp_lg_u32 s19, 62
  s_cbranch_scc1 cB_va0_nl
  s_mov_b32 s22, 88519680
  buffer_store_dword v160, v1, s[8:11], s22 offen sc1
  s_mov_b64 exec, -1
  s_branch cB_done
cB_va0_nl:
  s_mov_b64 exec, -1
  s_add_u32 s25, s25, 28672
  s_add_u32 s19, s19, 1
  s_mov_b32 s20, s21
  s_branch cB_va0_loop
cB_va0_last:
  s_waitcnt lgkmcnt(0)
  s_barrier
  s_branch cB_done
cB_va0_rp:
  s_cmp_eq_u32 s37, 0
  s_cbranch_scc1 cB_va0_rv
  v_mov_b32_dpp v161, v162 quad_perm:[0,1,2,3] row_mask:0xf bank_mask:0x3
  v_cvt_pk_bf16_f32 v160, v160, v161
  v_min_u32 v160, -2, v160
  s_branch cB_va0_pc
cB_va0_rv:
  buffer_load_dwordx4 v[8:11], v5, s[8:11], s22 offen offset:0 sc1
  buffer_load_dwordx4 v[12:15], v5, s[8:11], s22 offen offset:1024 sc1
  buffer_load_dwordx4 v[16:19], v5, s[8:11], s22 offen offset:2048 sc1
  buffer_load_dwordx4 v[20:23], v5, s[8:11], s22 offen offset:3072 sc1
  buffer_load_dwordx4 v[24:27], v5, s[8:11], s34 offen offset:0 sc1
  buffer_load_dwordx4 v[28:31], v5, s[8:11], s34 offen offset:1024 sc1
  buffer_load_dwordx4 v[32:35], v5, s[8:11], s34 offen offset:2048 sc1
  buffer_load_dwordx4 v[144:147], v5, s[8:11], s34 offen offset:3072 sc1
  buffer_load_dwordx4 v[148:151], v2, s[8:11], s36 offen offset:0 sc1
  buffer_load_dwordx4 v[152:155], v2, s[8:11], s36 offen offset:1024 sc1
  s_waitcnt vmcnt(0)
  v_max3_u32 v175, v8, v9, v10
  v_max3_u32 v175, v175, v11, v12
  v_max3_u32 v175, v175, v13, v14
  v_max3_u32 v175, v175, v15, v16
  v_max3_u32 v175, v175, v17, v18
  v_max3_u32 v175, v175, v19, v20
  v_max3_u32 v175, v175, v21, v22
  v_max3_u32 v175, v175, v23, v24
  v_max3_u32 v175, v175, v25, v26
  v_max3_u32 v175, v175, v27, v28
  v_max3_u32 v175, v175, v29, v30
  v_max3_u32 v175, v175, v31, v32
  v_max3_u32 v175, v175, v33, v34
  v_max3_u32 v175, v175, v35, v144
  v_max3_u32 v175, v175, v145, v146
  v_max3_u32 v175, v175, v147, v148
  v_max3_u32 v175, v175, v149, v150
  v_max3_u32 v175, v175, v151, v152
  v_max3_u32 v175, v175, v153, v154
  v_max_u32 v175, v175, v155
  v_cmp_eq_u32 vcc, -1, v175
  s_cbranch_vccz cB_va0_rk
  s_add_u32 s30, s30, 1
  s_cmp_lt_u32 s30, 400000
  s_cbranch_scc1 cB_va0_rv
  s_branch cB_abort
cB_va0_rk:
  s_mov_b32 s37, 1
  s_add_u32 s31, s31, 0x10000
  v_mov_b32 v156, 0
  v_mov_b32 v157, 0
  v_mov_b32 v158, 0
  v_mov_b32 v159, 0
  s_nop 1
  v_smfmac_f32_16x16x64_bf16 v[156:159], v[8:11], v[80:87], v0
  v_smfmac_f32_16x16x64_bf16 v[156:159], v[12:15], v[88:95], v0
  v_smfmac_f32_16x16x64_bf16 v[156:159], v[16:19], v[96:103], v0
  v_smfmac_f32_16x16x64_bf16 v[156:159], v[20:23], v[104:111], v0
  v_smfmac_f32_16x16x64_bf16 v[156:159], v[24:27], v[112:119], v0
  v_smfmac_f32_16x16x64_bf16 v[156:159], v[28:31], v[120:127], v0
  v_smfmac_f32_16x16x64_bf16 v[156:159], v[32:35], v[128:135], v0
  v_smfmac_f32_16x16x64_bf16 v[156:159], v[144:147], v[136:143], v0
  v_smfmac_f32_16x16x64_bf16 v[156:159], v[148:151], v[64:71], v0
  v_smfmac_f32_16x16x64_bf16 v[156:159], v[152:155], v[72:79], v0
  s_nop 7
  s_branch cB_va0_ep
.p2align 6

cB_va1_loop:
  s_add_u32 s23, s20, 4096
  s_add_u32 s21, s20, 25600
  s_mov_b32 s30, 0
  s_cmp_lg_u32 s19, s38
  s_cbranch_scc1 cB_va1_vok
  s_branch cB_va1_voc
cB_va1_vow:
  buffer_load_dword v63, off, s[8:11], s35 sc1
  s_waitcnt vmcnt(0)
cB_va1_voc:
  v_readfirstlane_b32 s22, v63
  s_cmp_eq_u32 s22, 56
  s_cbranch_scc1 cB_va1_vod
  s_sleep 1
  s_add_u32 s30, s30, 1
  s_cmp_lt_u32 s30, 400000
  s_cbranch_scc1 cB_va1_vow
  s_branch cB_abort
cB_va1_vod:
  s_add_u32 s35, s35, 2048
  s_add_u32 s38, s19, 8
  s_and_b32 s38, s38, -8
  s_cmp_eq_u32 s19, 0
  s_cselect_b32 s38, 4, s38
cB_va1_vok:
  s_cmp_eq_u32 s19, 63
  s_cbranch_scc1 cB_done
  s_barrier
  s_add_u32 s22, s25, 0
  buffer_load_dwordx4 v[80:83], v6, s[8:11], s22 offen offset:0 sc1
  buffer_load_dwordx4 v[84:87], v6, s[8:11], s22 offen offset:1792 sc1
  s_add_u32 s22, s25, 3584
  buffer_load_dwordx4 v[88:91], v6, s[8:11], s22 offen offset:0 sc1
  buffer_load_dwordx4 v[92:95], v6, s[8:11], s22 offen offset:1792 sc1
  s_add_u32 s22, s25, 7168
  buffer_load_dwordx4 v[96:99], v6, s[8:11], s22 offen offset:0 sc1
  buffer_load_dwordx4 v[100:103], v6, s[8:11], s22 offen offset:1792 sc1
  s_add_u32 s22, s25, 10752
  buffer_load_dwordx4 v[104:107], v6, s[8:11], s22 offen offset:0 sc1
  buffer_load_dwordx4 v[108:111], v6, s[8:11], s22 offen offset:1792 sc1
  s_add_u32 s22, s25, 14336
  buffer_load_dwordx4 v[112:115], v6, s[8:11], s22 offen offset:0 sc1
  buffer_load_dwordx4 v[116:119], v6, s[8:11], s22 offen offset:1792 sc1
  s_add_u32 s22, s25, 17920
  buffer_load_dwordx4 v[120:123], v6, s[8:11], s22 offen offset:0 sc1
  buffer_load_dwordx4 v[124:127], v6, s[8:11], s22 offen offset:1792 sc1
  s_add_u32 s22, s25, 21504
  buffer_load_dwordx4 v[128:131], v6, s[8:11], s22 offen offset:0 sc1
  buffer_load_dwordx4 v[132:135], v6, s[8:11], s22 offen offset:1792 sc1
  s_add_u32 s22, s25, 25088
  buffer_load_dwordx4 v[136:139], v6, s[8:11], s22 offen offset:0 sc1
  buffer_load_dwordx4 v[140:143], v6, s[8:11], s22 offen offset:1792 sc1
  s_add_u32 s22, s19, 1
  s_cmp_lg_u32 s22, s38
  s_cbranch_scc1 cB_va1_nk
  buffer_load_dword v63, off, s[8:11], s35 sc1
cB_va1_nk:
  s_barrier
  ds_read_b128 v[8:11], v2 offset:8192
  ds_read_b128 v[12:15], v2 offset:9216
  ds_read_b128 v[16:19], v2 offset:10240
  ds_read_b128 v[20:23], v2 offset:11264
  ds_read_b128 v[24:27], v2 offset:12288
  ds_read_b128 v[28:31], v2 offset:13312
  ds_read_b128 v[32:35], v2 offset:14336
  s_waitcnt lgkmcnt(0)
  v_smfmac_f32_16x16x64_bf16 v[36:39], v[8:11], a[0:7], v3
  v_smfmac_f32_16x16x64_bf16 v[36:39], v[12:15], a[8:15], v3
  v_smfmac_f32_16x16x64_bf16 v[36:39], v[16:19], a[16:23], v3
  v_smfmac_f32_16x16x64_bf16 v[36:39], v[20:23], a[24:31], v3
  v_smfmac_f32_16x16x64_bf16 v[36:39], v[24:27], a[32:39], v3
  v_smfmac_f32_16x16x64_bf16 v[36:39], v[28:31], a[40:47], v3
  v_smfmac_f32_16x16x64_bf16 v[36:39], v[32:35], a[48:55], v3
  v_smfmac_f32_16x16x64_bf16 v[40:43], v[8:11], a[56:63], v3
  v_smfmac_f32_16x16x64_bf16 v[40:43], v[12:15], a[64:71], v3
  v_smfmac_f32_16x16x64_bf16 v[40:43], v[16:19], a[72:79], v3
  v_smfmac_f32_16x16x64_bf16 v[40:43], v[20:23], a[80:87], v3
  v_smfmac_f32_16x16x64_bf16 v[40:43], v[24:27], a[88:95], v3
  v_smfmac_f32_16x16x64_bf16 v[40:43], v[28:31], a[96:103], v3
  v_smfmac_f32_16x16x64_bf16 v[40:43], v[32:35], a[104:111], v3
  v_smfmac_f32_16x16x64_bf16 v[44:47], v[8:11], a[112:119], v3
  v_smfmac_f32_16x16x64_bf16 v[44:47], v[12:15], a[120:127], v3
  v_smfmac_f32_16x16x64_bf16 v[44:47], v[16:19], a[128:135], v3
  v_smfmac_f32_16x16x64_bf16 v[44:47], v[20:23], a[136:143], v3
  v_permlane32_swap_b32 v36, v40
  v_smfmac_f32_16x16x64_bf16 v[44:47], v[24:27], a[144:151], v3
  v_permlane32_swap_b32 v37, v41
  v_smfmac_f32_16x16x64_bf16 v[44:47], v[28:31], a[152:159], v3
  v_permlane32_swap_b32 v38, v42
  v_smfmac_f32_16x16x64_bf16 v[44:47], v[32:35], a[160:167], v3
  v_permlane32_swap_b32 v39, v43
  v_smfmac_f32_16x16x64_bf16 v[48:51], v[8:11], a[168:175], v3
  v_add_f32 v36, v36, v40
  v_smfmac_f32_16x16x64_bf16 v[48:51], v[12:15], a[176:183], v3
  v_add_f32 v37, v37, v41
  v_smfmac_f32_16x16x64_bf16 v[48:51], v[16:19], a[184:191], v3
  v_add_f32 v38, v38, v42
  v_smfmac_f32_16x16x64_bf16 v[48:51], v[20:23], a[192:199], v3
  v_add_f32 v39, v39, v43
  v_smfmac_f32_16x16x64_bf16 v[48:51], v[24:27], a[200:207], v3
  v_cvt_pk_bf16_f32 v40, v36, v37
  v_smfmac_f32_16x16x64_bf16 v[48:51], v[28:31], a[208:215], v3
  v_cvt_pk_bf16_f32 v41, v38, v39
  v_smfmac_f32_16x16x64_bf16 v[48:51], v[32:35], a[216:223], v3
  ds_write2_b32 v60, v40, v41 offset0:0 offset1:2
  v_smfmac_f32_16x16x64_bf16 v[52:55], v[8:11], a[224:231], v3
  v_smfmac_f32_16x16x64_bf16 v[52:55], v[12:15], a[232:239], v3
  v_smfmac_f32_16x16x64_bf16 v[52:55], v[16:19], a[240:247], v3
  v_smfmac_f32_16x16x64_bf16 v[52:55], v[20:23], a[248:255], v3
  v_permlane32_swap_b32 v44, v48
  v_smfmac_f32_16x16x64_bf16 v[52:55], v[24:27], v[176:183], v3
  v_permlane32_swap_b32 v45, v49
  v_smfmac_f32_16x16x64_bf16 v[52:55], v[28:31], v[184:191], v3
  v_permlane32_swap_b32 v46, v50
  v_smfmac_f32_16x16x64_bf16 v[52:55], v[32:35], v[192:199], v3
  v_permlane32_swap_b32 v47, v51
  v_smfmac_f32_16x16x64_bf16 v[56:59], v[8:11], v[200:207], v3
  v_add_f32 v44, v44, v48
  v_smfmac_f32_16x16x64_bf16 v[56:59], v[12:15], v[208:215], v3
  v_add_f32 v45, v45, v49
  v_smfmac_f32_16x16x64_bf16 v[56:59], v[16:19], v[216:223], v3
  v_add_f32 v46, v46, v50
  v_smfmac_f32_16x16x64_bf16 v[56:59], v[20:23], v[224:231], v3
  v_add_f32 v47, v47, v51
  v_smfmac_f32_16x16x64_bf16 v[56:59], v[24:27], v[232:239], v3
  v_cvt_pk_bf16_f32 v48, v44, v45
  v_smfmac_f32_16x16x64_bf16 v[56:59], v[28:31], v[240:247], v3
  v_cvt_pk_bf16_f32 v49, v46, v47
  v_smfmac_f32_16x16x64_bf16 v[56:59], v[32:35], v[248:255], v3
  ds_write2_b32 v61, v48, v49 offset0:0 offset1:2
  s_nop 6
  v_permlane32_swap_b32 v52, v56
  v_permlane32_swap_b32 v53, v57
  v_permlane32_swap_b32 v54, v58
  v_permlane32_swap_b32 v55, v59
  v_add_f32 v52, v52, v56
  v_add_f32 v53, v53, v57
  v_add_f32 v54, v54, v58
  v_add_f32 v55, v55, v59
  v_cvt_pk_bf16_f32 v56, v52, v53
  v_cvt_pk_bf16_f32 v57, v54, v55
  ds_write2_b32 v62, v56, v57 offset0:0 offset1:2
  s_cmp_eq_u32 s19, 63
  s_cbranch_scc1 cB_va1_last
  s_add_u32 s22, s20, 9216
  s_add_u32 s34, s20, 13312
  s_add_u32 s36, s20, 7168
  s_mov_b32 s37, 0
  v_mov_b32 v156, 0
  v_mov_b32 v157, 0
  v_mov_b32 v158, 0
  v_mov_b32 v159, 0
  buffer_load_dword v164, v4, s[8:11], s20 offen sc1
  s_nop 7
  buffer_load_dword v165, v4, s[8:11], s20 offen sc1
  s_nop 7
  buffer_load_dword v166, v4, s[8:11], s20 offen sc1
  s_nop 7
  buffer_load_dword v167, v4, s[8:11], s20 offen sc1
  s_nop 7
  buffer_load_dword v168, v4, s[8:11], s20 offen sc1
cB_va1_fw_l:
  s_waitcnt vmcnt(4)
  v_cmp_eq_u32 vcc, -1, v164
  s_cbranch_vccz cB_va1_fw_d
  buffer_load_dword v164, v4, s[8:11], s20 offen sc1
  s_waitcnt vmcnt(4)
  v_cmp_eq_u32 vcc, -1, v165
  s_cbranch_vccz cB_va1_fw_d
  buffer_load_dword v165, v4, s[8:11], s20 offen sc1
  s_waitcnt vmcnt(4)
  v_cmp_eq_u32 vcc, -1, v166
  s_cbranch_vccz cB_va1_fw_d
  buffer_load_dword v166, v4, s[8:11], s20 offen sc1
  s_waitcnt vmcnt(4)
  v_cmp_eq_u32 vcc, -1, v167
  s_cbranch_vccz cB_va1_fw_d
  buffer_load_dword v167, v4, s[8:11], s20 offen sc1
  s_waitcnt vmcnt(4)
  v_cmp_eq_u32 vcc, -1, v168
  s_cbranch_vccz cB_va1_fw_d
  buffer_load_dword v168, v4, s[8:11], s20 offen sc1
  s_add_u32 s30, s30, 1
  s_cmp_lt_u32 s30, 400000
  s_cbranch_scc1 cB_va1_fw_l
  s_branch cB_abort
cB_va1_fw_d:
  s_waitcnt lgkmcnt(0)
  buffer_load_dwordx4 v[8:11], v5, s[8:11], s22 offen offset:0 sc1
  v_mov_b32 v36, 0
  v_mov_b32 v37, 0
  v_mov_b32 v38, 0
  buffer_load_dwordx4 v[12:15], v5, s[8:11], s22 offen offset:1024 sc1
  v_mov_b32 v39, 0
  v_mov_b32 v40, 0
  v_mov_b32 v41, 0
  buffer_load_dwordx4 v[16:19], v5, s[8:11], s22 offen offset:2048 sc1
  v_mov_b32 v42, 0
  v_mov_b32 v43, 0
  v_mov_b32 v44, 0
  buffer_load_dwordx4 v[20:23], v5, s[8:11], s22 offen offset:3072 sc1
  v_mov_b32 v45, 0
  v_mov_b32 v46, 0
  v_mov_b32 v47, 0
  buffer_load_dwordx4 v[24:27], v5, s[8:11], s34 offen offset:0 sc1
  v_mov_b32 v48, 0
  v_mov_b32 v49, 0
  v_mov_b32 v50, 0
  buffer_load_dwordx4 v[28:31], v5, s[8:11], s34 offen offset:1024 sc1
  v_mov_b32 v51, 0
  v_mov_b32 v52, 0
  v_mov_b32 v53, 0
  buffer_load_dwordx4 v[32:35], v5, s[8:11], s34 offen offset:2048 sc1
  v_mov_b32 v54, 0
  v_mov_b32 v55, 0
  v_mov_b32 v56, 0
  buffer_load_dwordx4 v[144:147], v5, s[8:11], s34 offen offset:3072 sc1
  v_mov_b32 v57, 0
  v_mov_b32 v58, 0
  v_mov_b32 v59, 0
  buffer_load_dwordx4 v[148:151], v2, s[8:11], s36 offen offset:0 sc1
  buffer_load_dwordx4 v[152:155], v2, s[8:11], s36 offen offset:1024 sc1
  s_barrier
  ds_read_b128 v[64:67], v2 offset:4096
  ds_read_b128 v[68:71], v2 offset:5120
  ds_read_b128 v[72:75], v2 offset:6144
  ds_read_b128 v[76:79], v2 offset:7168
  s_waitcnt vmcnt(9)
  v_smfmac_f32_16x16x64_bf16 v[156:159], v[8:11], v[80:87], v0
  s_waitcnt vmcnt(8)
  v_smfmac_f32_16x16x64_bf16 v[156:159], v[12:15], v[88:95], v0
  s_waitcnt vmcnt(7)
  v_smfmac_f32_16x16x64_bf16 v[156:159], v[16:19], v[96:103], v0
  s_waitcnt vmcnt(6)
  v_smfmac_f32_16x16x64_bf16 v[156:159], v[20:23], v[104:111], v0
  s_waitcnt vmcnt(5)
  v_smfmac_f32_16x16x64_bf16 v[156:159], v[24:27], v[112:119], v0
  s_mov_b32 exec_hi, 0
  buffer_store_dword v2, v7, s[8:11], s21 offen sc1
  s_mov_b64 exec, -1
  s_waitcnt vmcnt(5)
  v_smfmac_f32_16x16x64_bf16 v[156:159], v[28:31], v[120:127], v0
  s_waitcnt vmcnt(4)
  v_smfmac_f32_16x16x64_bf16 v[156:159], v[32:35], v[128:135], v0
  s_waitcnt vmcnt(3)
  v_smfmac_f32_16x16x64_bf16 v[156:159], v[144:147], v[136:143], v0
  s_waitcnt vmcnt(2) lgkmcnt(0)
  v_smfmac_f32_16x16x64_bf16 v[156:159], v[148:151], v[64:71], v0
  s_waitcnt vmcnt(1)
  v_smfmac_f32_16x16x64_bf16 v[156:159], v[152:155], v[72:79], v0
cB_va1_ep:
  s_nop 7
  v_add_f32 v160, v156, v157
  v_add_f32 v161, v158, v159
  v_cmp_u_f32 vcc, v160, v161
  v_mov_b32_dpp v162, v160 row_ror:8 row_mask:0xf bank_mask:0xf
  v_mov_b32_dpp v160, v161 row_ror:8 row_mask:0xf bank_mask:0xc
  s_cbranch_vccnz cB_va1_rp
  v_mov_b32_dpp v161, v162 quad_perm:[0,1,2,3] row_mask:0xf bank_mask:0x3
  v_cvt_pk_bf16_f32 v160, v160, v161
cB_va1_pc:
  s_mov_b64 exec, s[26:27]
  buffer_store_dword v160, v1, s[8:11], s21 offen sc1
  s_cmp_lg_u32 s19, 62
  s_cbranch_scc1 cB_va1_nl
  s_mov_b32 s22, 88519680
  buffer_store_dword v160, v1, s[8:11], s22 offen sc1
  s_mov_b64 exec, -1
  s_branch cB_done
cB_va1_nl:
  s_mov_b64 exec, -1
  s_add_u32 s25, s25, 28672
  s_add_u32 s19, s19, 1
  s_mov_b32 s20, s21
  s_branch cB_va1_loop
cB_va1_last:
  s_waitcnt lgkmcnt(0)
  s_barrier
  s_branch cB_done
cB_va1_rp:
  s_cmp_eq_u32 s37, 0
  s_cbranch_scc1 cB_va1_rv
  v_mov_b32_dpp v161, v162 quad_perm:[0,1,2,3] row_mask:0xf bank_mask:0x3
  v_cvt_pk_bf16_f32 v160, v160, v161
  v_min_u32 v160, -2, v160
  s_branch cB_va1_pc
cB_va1_rv:
  buffer_load_dwordx4 v[8:11], v5, s[8:11], s22 offen offset:0 sc1
  buffer_load_dwordx4 v[12:15], v5, s[8:11], s22 offen offset:1024 sc1
  buffer_load_dwordx4 v[16:19], v5, s[8:11], s22 offen offset:2048 sc1
  buffer_load_dwordx4 v[20:23], v5, s[8:11], s22 offen offset:3072 sc1
  buffer_load_dwordx4 v[24:27], v5, s[8:11], s34 offen offset:0 sc1
  buffer_load_dwordx4 v[28:31], v5, s[8:11], s34 offen offset:1024 sc1
  buffer_load_dwordx4 v[32:35], v5, s[8:11], s34 offen offset:2048 sc1
  buffer_load_dwordx4 v[144:147], v5, s[8:11], s34 offen offset:3072 sc1
  buffer_load_dwordx4 v[148:151], v2, s[8:11], s36 offen offset:0 sc1
  buffer_load_dwordx4 v[152:155], v2, s[8:11], s36 offen offset:1024 sc1
  s_waitcnt vmcnt(0)
  v_max3_u32 v175, v8, v9, v10
  v_max3_u32 v175, v175, v11, v12
  v_max3_u32 v175, v175, v13, v14
  v_max3_u32 v175, v175, v15, v16
  v_max3_u32 v175, v175, v17, v18
  v_max3_u32 v175, v175, v19, v20
  v_max3_u32 v175, v175, v21, v22
  v_max3_u32 v175, v175, v23, v24
  v_max3_u32 v175, v175, v25, v26
  v_max3_u32 v175, v175, v27, v28
  v_max3_u32 v175, v175, v29, v30
  v_max3_u32 v175, v175, v31, v32
  v_max3_u32 v175, v175, v33, v34
  v_max3_u32 v175, v175, v35, v144
  v_max3_u32 v175, v175, v145, v146
  v_max3_u32 v175, v175, v147, v148
  v_max3_u32 v175, v175, v149, v150
  v_max3_u32 v175, v175, v151, v152
  v_max3_u32 v175, v175, v153, v154
  v_max_u32 v175, v175, v155
  v_cmp_eq_u32 vcc, -1, v175
  s_cbranch_vccz cB_va1_rk
  s_add_u32 s30, s30, 1
  s_cmp_lt_u32 s30, 400000
  s_cbranch_scc1 cB_va1_rv
  s_branch cB_abort
cB_va1_rk:
  s_mov_b32 s37, 1
  s_add_u32 s31, s31, 0x10000
  v_mov_b32 v156, 0
  v_mov_b32 v157, 0
  v_mov_b32 v158, 0
  v_mov_b32 v159, 0
  s_nop 1
  v_smfmac_f32_16x16x64_bf16 v[156:159], v[8:11], v[80:87], v0
  v_smfmac_f32_16x16x64_bf16 v[156:159], v[12:15], v[88:95], v0
  v_smfmac_f32_16x16x64_bf16 v[156:159], v[16:19], v[96:103], v0
  v_smfmac_f32_16x16x64_bf16 v[156:159], v[20:23], v[104:111], v0
  v_smfmac_f32_16x16x64_bf16 v[156:159], v[24:27], v[112:119], v0
  v_smfmac_f32_16x16x64_bf16 v[156:159], v[28:31], v[120:127], v0
  v_smfmac_f32_16x16x64_bf16 v[156:159], v[32:35], v[128:135], v0
  v_smfmac_f32_16x16x64_bf16 v[156:159], v[144:147], v[136:143], v0
  v_smfmac_f32_16x16x64_bf16 v[156:159], v[148:151], v[64:71], v0
  v_smfmac_f32_16x16x64_bf16 v[156:159], v[152:155], v[72:79], v0
  s_nop 7
  s_branch cB_va1_ep
.p2align 6

cB_va2_loop:
  s_add_u32 s23, s20, 4096
  s_add_u32 s21, s20, 25600
  v_mov_b32 v36, 0
  v_mov_b32 v37, 0
  v_mov_b32 v38, 0
  v_mov_b32 v39, 0
  v_mov_b32 v40, 0
  v_mov_b32 v41, 0
  v_mov_b32 v42, 0
  v_mov_b32 v43, 0
  v_mov_b32 v44, 0
  v_mov_b32 v45, 0
  v_mov_b32 v46, 0
  v_mov_b32 v47, 0
  v_mov_b32 v48, 0
  v_mov_b32 v49, 0
  v_mov_b32 v50, 0
  v_mov_b32 v51, 0
  v_mov_b32 v52, 0
  v_mov_b32 v53, 0
  v_mov_b32 v54, 0
  v_mov_b32 v55, 0
  v_mov_b32 v56, 0
  v_mov_b32 v57, 0
  v_mov_b32 v58, 0
  v_mov_b32 v59, 0
  v_mov_b32 v60, 0
  v_mov_b32 v61, 0
  v_mov_b32 v62, 0
  v_mov_b32 v63, 0
  v_mov_b32 v64, 0
  v_mov_b32 v65, 0
  v_mov_b32 v66, 0
  v_mov_b32 v67, 0
  s_mov_b32 s30, 0
  buffer_load_dword v76, v119, s[8:11], s20 offen sc1
  buffer_load_dword v77, v119, s[8:11], s20 offen sc1
  buffer_load_dword v78, v119, s[8:11], s20 offen sc1
cB_va2_fp_l:
  s_waitcnt vmcnt(2)
  v_cmp_eq_u32 vcc, -1, v76
  s_cbranch_vccz cB_va2_fp_d
  buffer_load_dword v76, v119, s[8:11], s20 offen sc1
  s_waitcnt vmcnt(2)
  v_cmp_eq_u32 vcc, -1, v77
  s_cbranch_vccz cB_va2_fp_d
  buffer_load_dword v77, v119, s[8:11], s20 offen sc1
  s_waitcnt vmcnt(2)
  v_cmp_eq_u32 vcc, -1, v78
  s_cbranch_vccz cB_va2_fp_d
  buffer_load_dword v78, v119, s[8:11], s20 offen sc1
  s_add_u32 s30, s30, 1
  s_cmp_lt_u32 s30, 400000
  s_cbranch_scc1 cB_va2_fp_l
  s_branch cB_abort
cB_va2_fp_d:
  buffer_load_dwordx4 v[8:11], v2, s[8:11], s20 offen offset:0 sc1
  buffer_load_dwordx4 v[12:15], v2, s[8:11], s20 offen offset:1024 sc1
  buffer_load_dwordx4 v[16:19], v2, s[8:11], s20 offen offset:2048 sc1
  buffer_load_dwordx4 v[20:23], v2, s[8:11], s20 offen offset:3072 sc1
  s_barrier
cB_va2_ld:
  s_waitcnt vmcnt(0)
  v_max3_u32 v84, v8, v9, v10
  v_max3_u32 v84, v84, v11, v12
  v_max3_u32 v84, v84, v13, v14
  v_max3_u32 v84, v84, v15, v16
  v_max3_u32 v84, v84, v17, v18
  v_max3_u32 v84, v84, v19, v20
  v_max3_u32 v84, v84, v21, v22
  v_max_u32 v84, v84, v23
  v_cmp_eq_u32 vcc, -1, v84
  ds_write_b128 v2, v[8:11] offset:8192
  ds_write_b128 v2, v[12:15] offset:9216
  ds_write_b128 v2, v[16:19] offset:10240
  ds_write_b128 v2, v[20:23] offset:11264
  s_cbranch_vccnz cB_va2_retry
  s_waitcnt lgkmcnt(0)
  s_barrier
  ds_read_b128 v[24:27], v2 offset:12288
  ds_read_b128 v[28:31], v2 offset:13312
  ds_read_b128 v[32:35], v2 offset:14336
  ds_read_b128 v[92:95], v0
  s_waitcnt lgkmcnt(0)
  s_mov_b64 exec, s[26:27]
  buffer_store_dwordx4 v[92:95], v2, s[8:11], s36 offen sc1
  s_mov_b64 exec, -1
  s_add_u32 s36, s36, 7168
  s_cmp_eq_u32 s19, 63
  s_cbranch_scc1 cB_done
  ds_read_b128 v[76:79], v1 offset:0
  ds_read_b128 v[80:83], v1 offset:1024
  ds_read_b128 v[84:87], v1 offset:2048
  ds_read_b128 v[88:91], v1 offset:3072
  ds_read_b128 v[92:95], v1 offset:4096
  ds_read_b128 v[96:99], v1 offset:5120
  v_smfmac_f32_16x16x64_bf16 v[60:63], v[8:11], v[200:207], v3
  v_smfmac_f32_16x16x64_bf16 v[60:63], v[12:15], v[208:215], v3
  s_waitcnt lgkmcnt(4)
  v_smfmac_f32_16x16x64_bf16 v[64:67], v[8:11], v[76:83], v3
  ds_read_b128 v[76:79], v1 offset:6144
  ds_read_b128 v[80:83], v1 offset:7168
  v_smfmac_f32_16x16x64_bf16 v[60:63], v[16:19], v[216:223], v3
  v_smfmac_f32_16x16x64_bf16 v[60:63], v[20:23], v[224:231], v3
  s_waitcnt lgkmcnt(4)
  v_smfmac_f32_16x16x64_bf16 v[64:67], v[12:15], v[84:91], v3
  ds_read_b128 v[84:87], v1 offset:8192
  ds_read_b128 v[88:91], v1 offset:9216
  v_smfmac_f32_16x16x64_bf16 v[60:63], v[24:27], v[232:239], v3
  v_smfmac_f32_16x16x64_bf16 v[60:63], v[28:31], v[240:247], v3
  s_waitcnt lgkmcnt(4)
  v_smfmac_f32_16x16x64_bf16 v[64:67], v[16:19], v[92:99], v3
  ds_read_b128 v[92:95], v1 offset:10240
  ds_read_b128 v[96:99], v1 offset:11264
  v_smfmac_f32_16x16x64_bf16 v[60:63], v[32:35], v[248:255], v3
  v_smfmac_f32_16x16x64_bf16 v[36:39], v[8:11], a[0:7], v3
  s_waitcnt lgkmcnt(4)
  v_smfmac_f32_16x16x64_bf16 v[64:67], v[20:23], v[76:83], v3
  ds_read_b128 v[76:79], v1 offset:12288
  ds_read_b128 v[80:83], v1 offset:13312
  v_smfmac_f32_16x16x64_bf16 v[36:39], v[12:15], a[8:15], v3
  v_smfmac_f32_16x16x64_bf16 v[36:39], v[16:19], a[16:23], v3
  s_waitcnt lgkmcnt(4)
  v_smfmac_f32_16x16x64_bf16 v[64:67], v[24:27], v[84:91], v3
  v_smfmac_f32_16x16x64_bf16 v[36:39], v[20:23], a[24:31], v3
  v_smfmac_f32_16x16x64_bf16 v[36:39], v[24:27], a[32:39], v3
  s_waitcnt lgkmcnt(2)
  v_smfmac_f32_16x16x64_bf16 v[64:67], v[28:31], v[92:99], v3
  v_smfmac_f32_16x16x64_bf16 v[36:39], v[28:31], a[40:47], v3
  v_smfmac_f32_16x16x64_bf16 v[36:39], v[32:35], a[48:55], v3
  s_waitcnt lgkmcnt(0)
  v_smfmac_f32_16x16x64_bf16 v[64:67], v[32:35], v[76:83], v3
  v_smfmac_f32_16x16x64_bf16 v[40:43], v[8:11], a[56:63], v3
  v_smfmac_f32_16x16x64_bf16 v[40:43], v[12:15], a[64:71], v3
  v_smfmac_f32_16x16x64_bf16 v[40:43], v[16:19], a[72:79], v3
  v_smfmac_f32_16x16x64_bf16 v[40:43], v[20:23], a[80:87], v3
  v_permlane32_swap_b32 v60, v64
  v_smfmac_f32_16x16x64_bf16 v[40:43], v[24:27], a[88:95], v3
  v_permlane32_swap_b32 v61, v65
  v_smfmac_f32_16x16x64_bf16 v[40:43], v[28:31], a[96:103], v3
  v_permlane32_swap_b32 v62, v66
  v_smfmac_f32_16x16x64_bf16 v[40:43], v[32:35], a[104:111], v3
  v_permlane32_swap_b32 v63, v67
  v_smfmac_f32_16x16x64_bf16 v[44:47], v[8:11], a[112:119], v3
  v_smfmac_f32_16x16x64_bf16 v[44:47], v[12:15], a[120:127], v3
  v_smfmac_f32_16x16x64_bf16 v[44:47], v[16:19], a[128:135], v3
  v_smfmac_f32_16x16x64_bf16 v[44:47], v[20:23], a[136:143], v3
  v_add_f32 v60, v60, v64
  v_add_f32 v61, v61, v65
  v_smfmac_f32_16x16x64_bf16 v[44:47], v[24:27], a[144:151], v3
  v_add_f32 v62, v62, v66
  v_add_f32 v63, v63, v67
  v_smfmac_f32_16x16x64_bf16 v[44:47], v[28:31], a[152:159], v3
  v_cvt_pk_bf16_f32 v64, v60, v61
  v_cvt_pk_bf16_f32 v65, v62, v63
  v_smfmac_f32_16x16x64_bf16 v[44:47], v[32:35], a[160:167], v3
  ds_write2_b32 v115, v64, v65 offset0:0 offset1:2
  v_smfmac_f32_16x16x64_bf16 v[48:51], v[8:11], a[168:175], v3
  v_permlane32_swap_b32 v36, v40
  v_smfmac_f32_16x16x64_bf16 v[48:51], v[12:15], a[176:183], v3
  v_permlane32_swap_b32 v37, v41
  v_smfmac_f32_16x16x64_bf16 v[48:51], v[16:19], a[184:191], v3
  v_permlane32_swap_b32 v38, v42
  v_smfmac_f32_16x16x64_bf16 v[48:51], v[20:23], a[192:199], v3
  v_permlane32_swap_b32 v39, v43
  v_smfmac_f32_16x16x64_bf16 v[48:51], v[24:27], a[200:207], v3
  v_add_f32 v36, v36, v40
  v_smfmac_f32_16x16x64_bf16 v[48:51], v[28:31], a[208:215], v3
  v_add_f32 v37, v37, v41
  v_smfmac_f32_16x16x64_bf16 v[48:51], v[32:35], a[216:223], v3
  v_add_f32 v38, v38, v42
  v_smfmac_f32_16x16x64_bf16 v[52:55], v[8:11], a[224:231], v3
  v_smfmac_f32_16x16x64_bf16 v[52:55], v[12:15], a[232:239], v3
  v_smfmac_f32_16x16x64_bf16 v[52:55], v[16:19], a[240:247], v3
  v_smfmac_f32_16x16x64_bf16 v[52:55], v[20:23], a[248:255], v3
  v_add_f32 v39, v39, v43
  v_cvt_pk_bf16_f32 v40, v36, v37
  v_smfmac_f32_16x16x64_bf16 v[52:55], v[24:27], v[120:127], v3
  v_cvt_pk_bf16_f32 v41, v38, v39
  v_smfmac_f32_16x16x64_bf16 v[52:55], v[28:31], v[128:135], v3
  ds_write2_b32 v112, v40, v41 offset0:0 offset1:2
  v_smfmac_f32_16x16x64_bf16 v[52:55], v[32:35], v[136:143], v3
  v_permlane32_swap_b32 v44, v48
  v_smfmac_f32_16x16x64_bf16 v[56:59], v[8:11], v[144:151], v3
  v_permlane32_swap_b32 v45, v49
  v_smfmac_f32_16x16x64_bf16 v[56:59], v[12:15], v[152:159], v3
  v_permlane32_swap_b32 v46, v50
  v_smfmac_f32_16x16x64_bf16 v[56:59], v[16:19], v[160:167], v3
  v_permlane32_swap_b32 v47, v51
  v_smfmac_f32_16x16x64_bf16 v[56:59], v[20:23], v[168:175], v3
  v_add_f32 v44, v44, v48
  v_smfmac_f32_16x16x64_bf16 v[56:59], v[24:27], v[176:183], v3
  v_add_f32 v45, v45, v49
  v_smfmac_f32_16x16x64_bf16 v[56:59], v[28:31], v[184:191], v3
  v_add_f32 v46, v46, v50
  v_smfmac_f32_16x16x64_bf16 v[56:59], v[32:35], v[192:199], v3
  v_add_f32 v47, v47, v51
  v_cvt_pk_bf16_f32 v48, v44, v45
  v_cvt_pk_bf16_f32 v49, v46, v47
  ds_write2_b32 v113, v48, v49 offset0:0 offset1:2
  s_nop 3
  v_permlane32_swap_b32 v52, v56
  v_permlane32_swap_b32 v53, v57
  v_permlane32_swap_b32 v54, v58
  v_permlane32_swap_b32 v55, v59
  v_add_f32 v52, v52, v56
  v_add_f32 v53, v53, v57
  v_add_f32 v54, v54, v58
  v_add_f32 v55, v55, v59
  v_cvt_pk_bf16_f32 v56, v52, v53
  v_cvt_pk_bf16_f32 v57, v54, v55
  ds_write2_b32 v114, v56, v57 offset0:0 offset1:2
  s_waitcnt lgkmcnt(0)
  s_barrier
  s_cmp_eq_u32 s19, 62
  s_cbranch_scc1 cB_done
  s_waitcnt vmcnt(0) lgkmcnt(0)
  s_add_u32 s19, s19, 1
  s_mov_b32 s20, s21
  s_branch cB_va2_loop
cB_va2_retry:
  s_waitcnt lgkmcnt(0)
  buffer_load_dwordx4 v[8:11], v2, s[8:11], s20 offen offset:0 sc1
  buffer_load_dwordx4 v[12:15], v2, s[8:11], s20 offen offset:1024 sc1
  buffer_load_dwordx4 v[16:19], v2, s[8:11], s20 offen offset:2048 sc1
  buffer_load_dwordx4 v[20:23], v2, s[8:11], s20 offen offset:3072 sc1
  s_add_u32 s31, s31, 1
  s_add_u32 s30, s30, 1
  s_cmp_lt_u32 s30, 400000
  s_cbranch_scc1 cB_va2_ld
  s_branch cB_abort
cB_va2_last:
  s_waitcnt lgkmcnt(0)
  buffer_store_dwordx4 v[100:103], v2, s[8:11], s24 offen offset:0 sc1
  buffer_store_dwordx4 v[104:107], v2, s[8:11], s24 offen offset:1024 sc1
  buffer_store_dwordx4 v[108:111], v2, s[8:11], s24 offen offset:2048 sc1
  buffer_store_dwordx4 v[4:7], v2, s[8:11], s24 offen offset:3072 sc1
  s_add_u32 s24, s24, 8192
  s_waitcnt vmcnt(0)
  s_mov_b64 exec, 1
  buffer_store_dword v117, v2, s[8:11], s34 offen sc1
  s_mov_b64 exec, -1
  s_add_u32 s34, s34, 8
  s_mov_b64 exec, 1
  buffer_store_dword v117, v2, s[8:11], s34 offen sc1
  s_mov_b64 exec, -1
  s_add_u32 s34, s34, 8
  s_branch cB_done
.p2align 6

cB_va3_loop:
  s_add_u32 s23, s20, 4096
  s_add_u32 s21, s20, 25600
  v_mov_b32 v36, 0
  v_mov_b32 v37, 0
  v_mov_b32 v38, 0
  v_mov_b32 v39, 0
  v_mov_b32 v40, 0
  v_mov_b32 v41, 0
  v_mov_b32 v42, 0
  v_mov_b32 v43, 0
  v_mov_b32 v44, 0
  v_mov_b32 v45, 0
  v_mov_b32 v46, 0
  v_mov_b32 v47, 0
  v_mov_b32 v48, 0
  v_mov_b32 v49, 0
  v_mov_b32 v50, 0
  v_mov_b32 v51, 0
  v_mov_b32 v52, 0
  v_mov_b32 v53, 0
  v_mov_b32 v54, 0
  v_mov_b32 v55, 0
  v_mov_b32 v56, 0
  v_mov_b32 v57, 0
  v_mov_b32 v58, 0
  v_mov_b32 v59, 0
  v_mov_b32 v60, 0
  v_mov_b32 v61, 0
  v_mov_b32 v62, 0
  v_mov_b32 v63, 0
  v_mov_b32 v64, 0
  v_mov_b32 v65, 0
  v_mov_b32 v66, 0
  v_mov_b32 v67, 0
  s_mov_b32 s30, 0
  buffer_load_dword v76, v119, s[8:11], s20 offen sc1
  buffer_load_dword v77, v119, s[8:11], s20 offen sc1
  buffer_load_dword v78, v119, s[8:11], s20 offen sc1
cB_va3_fp_l:
  s_waitcnt vmcnt(2)
  v_cmp_eq_u32 vcc, -1, v76
  s_cbranch_vccz cB_va3_fp_d
  buffer_load_dword v76, v119, s[8:11], s20 offen sc1
  s_waitcnt vmcnt(2)
  v_cmp_eq_u32 vcc, -1, v77
  s_cbranch_vccz cB_va3_fp_d
  buffer_load_dword v77, v119, s[8:11], s20 offen sc1
  s_waitcnt vmcnt(2)
  v_cmp_eq_u32 vcc, -1, v78
  s_cbranch_vccz cB_va3_fp_d
  buffer_load_dword v78, v119, s[8:11], s20 offen sc1
  s_add_u32 s30, s30, 1
  s_cmp_lt_u32 s30, 400000
  s_cbranch_scc1 cB_va3_fp_l
  s_branch cB_abort
cB_va3_fp_d:
  buffer_load_dwordx4 v[24:27], v2, s[8:11], s23 offen offset:0 sc1
  buffer_load_dwordx4 v[28:31], v2, s[8:11], s23 offen offset:1024 sc1
  buffer_load_dwordx4 v[32:35], v2, s[8:11], s23 offen offset:2048 sc1
  s_barrier
cB_va3_ld:
  s_waitcnt vmcnt(0)
  v_max3_u32 v84, v24, v25, v26
  v_max3_u32 v84, v84, v27, v28
  v_max3_u32 v84, v84, v29, v30
  v_max3_u32 v84, v84, v31, v32
  v_max3_u32 v84, v84, v33, v34
  v_max_u32 v84, v84, v35
  v_cmp_eq_u32 vcc, -1, v84
  ds_write_b128 v2, v[24:27] offset:12288
  ds_write_b128 v2, v[28:31] offset:13312
  ds_write_b128 v2, v[32:35] offset:14336
  s_cbranch_vccnz cB_va3_retry
  s_waitcnt lgkmcnt(0)
  s_barrier
  ds_read_b128 v[8:11], v2 offset:8192
  ds_read_b128 v[12:15], v2 offset:9216
  ds_read_b128 v[16:19], v2 offset:10240
  ds_read_b128 v[20:23], v2 offset:11264
  s_waitcnt lgkmcnt(0)
  s_cmp_eq_u32 s19, 63
  s_cbranch_scc1 cB_done
  ds_read_b128 v[76:79], v1 offset:0
  ds_read_b128 v[80:83], v1 offset:1024
  ds_read_b128 v[84:87], v1 offset:2048
  ds_read_b128 v[88:91], v1 offset:3072
  ds_read_b128 v[92:95], v1 offset:4096
  ds_read_b128 v[96:99], v1 offset:5120
  v_smfmac_f32_16x16x64_bf16 v[60:63], v[8:11], v[200:207], v3
  v_smfmac_f32_16x16x64_bf16 v[60:63], v[12:15], v[208:215], v3
  s_waitcnt lgkmcnt(4)
  v_smfmac_f32_16x16x64_bf16 v[64:67], v[8:11], v[76:83], v3
  ds_read_b128 v[76:79], v1 offset:6144
  ds_read_b128 v[80:83], v1 offset:7168
  v_smfmac_f32_16x16x64_bf16 v[60:63], v[16:19], v[216:223], v3
  v_smfmac_f32_16x16x64_bf16 v[60:63], v[20:23], v[224:231], v3
  s_waitcnt lgkmcnt(4)
  v_smfmac_f32_16x16x64_bf16 v[64:67], v[12:15], v[84:91], v3
  ds_read_b128 v[84:87], v1 offset:8192
  ds_read_b128 v[88:91], v1 offset:9216
  v_smfmac_f32_16x16x64_bf16 v[60:63], v[24:27], v[232:239], v3
  v_smfmac_f32_16x16x64_bf16 v[60:63], v[28:31], v[240:247], v3
  s_waitcnt lgkmcnt(4)
  v_smfmac_f32_16x16x64_bf16 v[64:67], v[16:19], v[92:99], v3
  ds_read_b128 v[92:95], v1 offset:10240
  ds_read_b128 v[96:99], v1 offset:11264
  v_smfmac_f32_16x16x64_bf16 v[60:63], v[32:35], v[248:255], v3
  v_smfmac_f32_16x16x64_bf16 v[36:39], v[8:11], a[0:7], v3
  s_waitcnt lgkmcnt(4)
  v_smfmac_f32_16x16x64_bf16 v[64:67], v[20:23], v[76:83], v3
  ds_read_b128 v[76:79], v1 offset:12288
  ds_read_b128 v[80:83], v1 offset:13312
  v_smfmac_f32_16x16x64_bf16 v[36:39], v[12:15], a[8:15], v3
  v_smfmac_f32_16x16x64_bf16 v[36:39], v[16:19], a[16:23], v3
  s_waitcnt lgkmcnt(4)
  v_smfmac_f32_16x16x64_bf16 v[64:67], v[24:27], v[84:91], v3
  v_smfmac_f32_16x16x64_bf16 v[36:39], v[20:23], a[24:31], v3
  v_smfmac_f32_16x16x64_bf16 v[36:39], v[24:27], a[32:39], v3
  s_waitcnt lgkmcnt(2)
  v_smfmac_f32_16x16x64_bf16 v[64:67], v[28:31], v[92:99], v3
  v_smfmac_f32_16x16x64_bf16 v[36:39], v[28:31], a[40:47], v3
  v_smfmac_f32_16x16x64_bf16 v[36:39], v[32:35], a[48:55], v3
  s_waitcnt lgkmcnt(0)
  v_smfmac_f32_16x16x64_bf16 v[64:67], v[32:35], v[76:83], v3
  v_smfmac_f32_16x16x64_bf16 v[40:43], v[8:11], a[56:63], v3
  v_smfmac_f32_16x16x64_bf16 v[40:43], v[12:15], a[64:71], v3
  v_smfmac_f32_16x16x64_bf16 v[40:43], v[16:19], a[72:79], v3
  v_smfmac_f32_16x16x64_bf16 v[40:43], v[20:23], a[80:87], v3
  v_permlane32_swap_b32 v60, v64
  v_smfmac_f32_16x16x64_bf16 v[40:43], v[24:27], a[88:95], v3
  v_permlane32_swap_b32 v61, v65
  v_smfmac_f32_16x16x64_bf16 v[40:43], v[28:31], a[96:103], v3
  v_permlane32_swap_b32 v62, v66
  v_smfmac_f32_16x16x64_bf16 v[40:43], v[32:35], a[104:111], v3
  v_permlane32_swap_b32 v63, v67
  v_smfmac_f32_16x16x64_bf16 v[44:47], v[8:11], a[112:119], v3
  v_smfmac_f32_16x16x64_bf16 v[44:47], v[12:15], a[120:127], v3
  v_smfmac_f32_16x16x64_bf16 v[44:47], v[16:19], a[128:135], v3
  v_smfmac_f32_16x16x64_bf16 v[44:47], v[20:23], a[136:143], v3
  v_add_f32 v60, v60, v64
  v_add_f32 v61, v61, v65
  v_smfmac_f32_16x16x64_bf16 v[44:47], v[24:27], a[144:151], v3
  v_add_f32 v62, v62, v66
  v_add_f32 v63, v63, v67
  v_smfmac_f32_16x16x64_bf16 v[44:47], v[28:31], a[152:159], v3
  v_cvt_pk_bf16_f32 v64, v60, v61
  v_cvt_pk_bf16_f32 v65, v62, v63
  v_smfmac_f32_16x16x64_bf16 v[44:47], v[32:35], a[160:167], v3
  ds_write2_b32 v115, v64, v65 offset0:0 offset1:2
  v_smfmac_f32_16x16x64_bf16 v[48:51], v[8:11], a[168:175], v3
  v_permlane32_swap_b32 v36, v40
  v_smfmac_f32_16x16x64_bf16 v[48:51], v[12:15], a[176:183], v3
  v_permlane32_swap_b32 v37, v41
  v_smfmac_f32_16x16x64_bf16 v[48:51], v[16:19], a[184:191], v3
  v_permlane32_swap_b32 v38, v42
  v_smfmac_f32_16x16x64_bf16 v[48:51], v[20:23], a[192:199], v3
  v_permlane32_swap_b32 v39, v43
  v_smfmac_f32_16x16x64_bf16 v[48:51], v[24:27], a[200:207], v3
  v_add_f32 v36, v36, v40
  v_smfmac_f32_16x16x64_bf16 v[48:51], v[28:31], a[208:215], v3
  v_add_f32 v37, v37, v41
  v_smfmac_f32_16x16x64_bf16 v[48:51], v[32:35], a[216:223], v3
  v_add_f32 v38, v38, v42
  v_smfmac_f32_16x16x64_bf16 v[52:55], v[8:11], a[224:231], v3
  v_smfmac_f32_16x16x64_bf16 v[52:55], v[12:15], a[232:239], v3
  v_smfmac_f32_16x16x64_bf16 v[52:55], v[16:19], a[240:247], v3
  v_smfmac_f32_16x16x64_bf16 v[52:55], v[20:23], a[248:255], v3
  v_add_f32 v39, v39, v43
  v_cvt_pk_bf16_f32 v40, v36, v37
  v_smfmac_f32_16x16x64_bf16 v[52:55], v[24:27], v[120:127], v3
  v_cvt_pk_bf16_f32 v41, v38, v39
  v_smfmac_f32_16x16x64_bf16 v[52:55], v[28:31], v[128:135], v3
  ds_write2_b32 v112, v40, v41 offset0:0 offset1:2
  v_smfmac_f32_16x16x64_bf16 v[52:55], v[32:35], v[136:143], v3
  v_permlane32_swap_b32 v44, v48
  v_smfmac_f32_16x16x64_bf16 v[56:59], v[8:11], v[144:151], v3
  v_permlane32_swap_b32 v45, v49
  v_smfmac_f32_16x16x64_bf16 v[56:59], v[12:15], v[152:159], v3
  v_permlane32_swap_b32 v46, v50
  v_smfmac_f32_16x16x64_bf16 v[56:59], v[16:19], v[160:167], v3
  v_permlane32_swap_b32 v47, v51
  v_smfmac_f32_16x16x64_bf16 v[56:59], v[20:23], v[168:175], v3
  v_add_f32 v44, v44, v48
  v_smfmac_f32_16x16x64_bf16 v[56:59], v[24:27], v[176:183], v3
  v_add_f32 v45, v45, v49
  v_smfmac_f32_16x16x64_bf16 v[56:59], v[28:31], v[184:191], v3
  v_add_f32 v46, v46, v50
  v_smfmac_f32_16x16x64_bf16 v[56:59], v[32:35], v[192:199], v3
  v_add_f32 v47, v47, v51
  v_cvt_pk_bf16_f32 v48, v44, v45
  v_cvt_pk_bf16_f32 v49, v46, v47
  ds_write2_b32 v113, v48, v49 offset0:0 offset1:2
  s_nop 3
  v_permlane32_swap_b32 v52, v56
  v_permlane32_swap_b32 v53, v57
  v_permlane32_swap_b32 v54, v58
  v_permlane32_swap_b32 v55, v59
  v_add_f32 v52, v52, v56
  v_add_f32 v53, v53, v57
  v_add_f32 v54, v54, v58
  v_add_f32 v55, v55, v59
  v_cvt_pk_bf16_f32 v56, v52, v53
  v_cvt_pk_bf16_f32 v57, v54, v55
  ds_write2_b32 v114, v56, v57 offset0:0 offset1:2
  s_waitcnt lgkmcnt(0)
  s_barrier
  s_cmp_eq_u32 s19, 62
  s_cbranch_scc1 cB_done
  s_waitcnt vmcnt(0) lgkmcnt(0)
  s_add_u32 s19, s19, 1
  s_mov_b32 s20, s21
  s_branch cB_va3_loop
cB_va3_retry:
  s_waitcnt lgkmcnt(0)
  buffer_load_dwordx4 v[24:27], v2, s[8:11], s23 offen offset:0 sc1
  buffer_load_dwordx4 v[28:31], v2, s[8:11], s23 offen offset:1024 sc1
  buffer_load_dwordx4 v[32:35], v2, s[8:11], s23 offen offset:2048 sc1
  s_add_u32 s31, s31, 1
  s_add_u32 s30, s30, 1
  s_cmp_lt_u32 s30, 400000
  s_cbranch_scc1 cB_va3_ld
  s_branch cB_abort
cB_va3_last:
  s_waitcnt lgkmcnt(0)
  buffer_store_dwordx4 v[100:103], v2, s[8:11], s24 offen offset:0 sc1
  buffer_store_dwordx4 v[104:107], v2, s[8:11], s24 offen offset:1024 sc1
  buffer_store_dwordx4 v[108:111], v2, s[8:11], s24 offen offset:2048 sc1
  buffer_store_dwordx4 v[4:7], v2, s[8:11], s24 offen offset:3072 sc1
  s_add_u32 s24, s24, 8192
  s_waitcnt vmcnt(0)
  s_mov_b64 exec, 1
  buffer_store_dword v117, v2, s[8:11], s34 offen sc1
  s_mov_b64 exec, -1
  s_add_u32 s34, s34, 8
  s_mov_b64 exec, 1
  buffer_store_dword v117, v2, s[8:11], s34 offen sc1
  s_mov_b64 exec, -1
  s_add_u32 s34, s34, 8
  s_branch cB_done
cB_abort:
  v_mov_b32 v4, 0xdead
  v_mov_b32 v5, 16
  buffer_store_dword v4, v5, s[12:15], 0 offen
  s_branch ch_end
cB_done:
  s_branch ch_end
m_reclaim:
  s_waitcnt vmcnt(0)
  s_lshr_b32 s20, s3, 5
  s_cmp_lg_u32 s16, 0
  s_cbranch_scc1 w0_17
  s_mov_b32 s21, 0
  s_mov_b64 exec, 1
rc_l:
  s_cmp_lg_u32 s70, -1
  s_cbranch_scc1 rc_t
  s_add_u32 s20, s20, 1
  s_cmp_lt_u32 s20, 8
  s_cselect_b32 s20, s20, 0
  s_mov_b32 s70, 0
  s_mov_b32 s3, -1
  s_add_u32 s21, s21, 1
  s_cmp_ge_u32 s21, 9
  s_cbranch_scc1 rc_d
rc_t:
  s_ff0_i32_b32 s22, s70
  s_lshl_b32 s23, 1, s22
  s_and_b32 s71, s20, 4
  s_mul_i32 s71, s71, 12
  s_lshl_b32 s3, s20, 2
  s_add_u32 s3, s3, s71
  v_mov_b32 v242, s23
  v_mov_b32 v243, 32
  buffer_atomic_or v242, v243, s[12:15], s3 offen sc0
  s_waitcnt vmcnt(0)
  v_readfirstlane_b32 s70, v242
  s_lshl_b32 s3, s20, 5
  s_add_u32 s3, s3, s22
  s_bitcmp1_b32 s70, s22
  s_cbranch_scc1 rc_l
rc_d:
  s_mov_b64 exec, -1
  v_mov_b32 v242, s3
w0_17:
  v_mov_b32 v250, 160000
  s_add_u32 s101, s101, 1
  s_barrier
  s_mov_b64 exec, 1
  s_cmp_lg_u32 s16, 0
  s_cbranch_scc1 w0_18
  ds_write_b32 v250, v242 offset:0
  s_waitcnt lgkmcnt(0)
  v_mov_b32 v242, s101
  ds_write_b32 v250, v242 offset:16
  s_waitcnt lgkmcnt(0)
w0_18:
  s_mov_b64 exec, -1
  s_barrier
  ds_read_b32 v242, v250 offset:0
  ds_read_b32 v250, v250 offset:16
  s_waitcnt lgkmcnt(0)
  v_readfirstlane_b32 s3, v242
  v_cmp_ne_u32 vcc, s101, v250
  s_cbranch_vccnz ch_end
  s_cmp_lg_u32 s3, -1
  s_cbranch_scc1 m_start
  v_mov_b32 v250, 0
  s_branch wk_ask
m_bjob:
  v_and_b32 v1, 63, v0
  v_lshlrev_b32 v2, 4, v1
  v_lshrrev_b32 v3, 4, v1
  v_and_b32 v4, 15, v1
  s_sub_u32 s18, s3, 32
  s_mul_i32 s17, s18, 4682
  s_lshr_b32 s17, s17, 16
  s_mul_i32 s20, s17, 14
  s_sub_u32 s19, s18, s20
  s_cmp_ge_u32 s19, 7
  s_cselect_b32 s31, 7, 0
  s_sub_u32 s19, s19, s31
  s_mov_b32 s60, s44
  s_and_b32 s61, s45, 0xffff
  s_mov_b32 s62, 3670016
  s_mov_b32 s63, 0x20000
  s_mov_b32 s56, s46
  s_and_b32 s57, s47, 0xffff
  s_mov_b32 s58, 3670016
  s_mov_b32 s59, 0x20000
  s_lshl_b32 s30, s16, 13
  s_mul_i32 s27, s17, 229376
  s_lshl_b32 s29, s19, 7
  s_add_u32 s27, s27, s29
  v_lshrrev_b32 v7, 3, v1
  v_and_b32 v8, 7, v1
  v_and_b32 v9, 2, v7
  v_xor_b32 v8, v8, v9
  s_lshl_b32 s29, s16, 6
  v_add_u32 v7, s29, v7
  v_mul_u32_u24 v7, 896, v7
  v_lshl_add_u32 v7, v8, 4, v7
  v_xor_b32 v8, 64, v7
  s_add_u32 m0, s30, 0
  s_add_u32 s22, s27, 0
  buffer_load_dwordx4 v7, s[56:59], s22 offen offset:0 lds
  s_add_u32 s22, s27, 6144
  buffer_load_dwordx4 v8, s[56:59], s22 offen offset:1024 lds
  s_add_u32 s22, s27, 12288
  buffer_load_dwordx4 v7, s[56:59], s22 offen offset:2048 lds
  s_add_u32 s22, s27, 18432
  buffer_load_dwordx4 v8, s[56:59], s22 offen offset:3072 lds
  s_add_u32 m0, s30, 4096
  s_add_u32 s22, s27, 28672
  buffer_load_dwordx4 v7, s[56:59], s22 offen offset:0 lds
  s_add_u32 s22, s27, 34816
  buffer_load_dwordx4 v8, s[56:59], s22 offen offset:1024 lds
  s_add_u32 s22, s27, 40960
  buffer_load_dwordx4 v7, s[56:59], s22 offen offset:2048 lds
  s_add_u32 s22, s27, 47104
  buffer_load_dwordx4 v8, s[56:59], s22 offen offset:3072 lds
  v_lshrrev_b32 v5, 5, v1
  v_and_b32 v6, 31, v1
  s_lshl_b32 s25, s16, 15
  s_add_u32 s25, s25, 32768
  s_lshl_b32 s26, s17, 9
  s_add_u32 s28, s19, s16
  s_cmp_ge_u32 s28, 7
  s_cselect_b32 s20, 7, 0
  s_sub_u32 s28, s28, s20
  s_add_u32 s28, s28, s31
  s_add_u32 s29, s19, s16
  s_add_u32 s29, s29, 4
  s_cmp_ge_u32 s29, 7
  s_cselect_b32 s20, 7, 0
  s_sub_u32 s29, s29, s20
  s_add_u32 s29, s29, s31
  s_lshl_b32 s32, s28, 18
  s_add_u32 s32, s32, s26
  s_lshl_b32 s33, s29, 18
  s_add_u32 s33, s33, s26
  v_xor_b32 v8, v6, v5
  v_lshlrev_b32 v8, 4, v8
  v_lshl_add_u32 v8, v5, 13, v8
  v_xor_b32 v12, 0, v8
  v_xor_b32 v13, 32, v8
  v_add_u32 v13, 15360, v13
  v_xor_b32 v14, 0, v8
  v_add_u32 v14, 30720, v14
  v_xor_b32 v15, 32, v8
  v_add_u32 v15, 46080, v15
  s_add_u32 s20, s16, 0
  s_and_b32 s20, s20, 3
  s_mul_i32 s21, s20, 65600
  s_lshl_b32 s20, s20, 12
  s_add_u32 s48, s20, s25
  s_mov_b32 m0, s48
  v_xor_b32 v16, s21, v12
  buffer_load_dwordx4 v16, s[60:63], s32 offen offset:0 lds
  v_xor_b32 v17, s21, v13
  buffer_load_dwordx4 v17, s[60:63], s32 offen offset:1024 lds
  v_xor_b32 v18, s21, v14
  buffer_load_dwordx4 v18, s[60:63], s32 offen offset:2048 lds
  v_xor_b32 v19, s21, v15
  buffer_load_dwordx4 v19, s[60:63], s32 offen offset:3072 lds
  s_add_u32 s20, s16, 1
  s_and_b32 s20, s20, 3
  s_mul_i32 s21, s20, 65600
  s_lshl_b32 s20, s20, 12
  s_add_u32 s49, s20, s25
  s_mov_b32 m0, s49
  v_xor_b32 v20, s21, v12
  buffer_load_dwordx4 v20, s[60:63], s32 offen offset:0 lds
  v_xor_b32 v21, s21, v13
  buffer_load_dwordx4 v21, s[60:63], s32 offen offset:1024 lds
  v_xor_b32 v22, s21, v14
  buffer_load_dwordx4 v22, s[60:63], s32 offen offset:2048 lds
  v_xor_b32 v23, s21, v15
  buffer_load_dwordx4 v23, s[60:63], s32 offen offset:3072 lds
  s_add_u32 s20, s16, 2
  s_and_b32 s20, s20, 3
  s_mul_i32 s21, s20, 65600
  s_lshl_b32 s20, s20, 12
  s_add_u32 s50, s20, s25
  s_mov_b32 m0, s50
  v_xor_b32 v24, s21, v12
  buffer_load_dwordx4 v24, s[60:63], s32 offen offset:0 lds
  v_xor_b32 v25, s21, v13
  buffer_load_dwordx4 v25, s[60:63], s32 offen offset:1024 lds
  v_xor_b32 v26, s21, v14
  buffer_load_dwordx4 v26, s[60:63], s32 offen offset:2048 lds
  v_xor_b32 v27, s21, v15
  buffer_load_dwordx4 v27, s[60:63], s32 offen offset:3072 lds
  s_add_u32 s20, s16, 3
  s_and_b32 s20, s20, 3
  s_mul_i32 s21, s20, 65600
  s_lshl_b32 s20, s20, 12
  s_add_u32 s51, s20, s25
  s_mov_b32 m0, s51
  v_xor_b32 v28, s21, v12
  buffer_load_dwordx4 v28, s[60:63], s32 offen offset:0 lds
  v_xor_b32 v29, s21, v13
  buffer_load_dwordx4 v29, s[60:63], s32 offen offset:1024 lds
  v_xor_b32 v30, s21, v14
  buffer_load_dwordx4 v30, s[60:63], s32 offen offset:2048 lds
  v_xor_b32 v31, s21, v15
  buffer_load_dwordx4 v31, s[60:63], s32 offen offset:3072 lds
  s_cmp_lg_u32 s66, 0
  s_cbranch_scc1 bj_ci
  s_cmp_lg_u32 s16, 0
  s_cbranch_scc1 w0_19
  s_lshr_b32 s70, s3, 5
  s_and_b32 s71, s70, 4
  s_mul_i32 s71, s71, 12
  s_lshl_b32 s70, s70, 2
  s_add_u32 s70, s70, s71
  s_lshl_b32 s71, 1, s3
  v_mov_b32 v44, s71
  v_mov_b32 v45, 32
  s_mov_b64 exec, 1
  buffer_atomic_or v44, v45, s[12:15], s70 offen sc0
  buffer_load_dwordx2 v[46:47], v45, s[12:15], 0 offen offset:96 sc1
  s_mov_b64 exec, -1
w0_19:
bj_ci:
  s_lshl_b32 s30, s19, 6
  s_add_u32 s30, s30, 0
  v_add_u32 v8, s30, v4
  v_mul_u32_u24 v10, 2341, v8
  v_lshrrev_b32 v10, 16, v10
  v_mul_u32_u24 v11, 28, v10
  v_sub_u32 v32, v8, v11
  s_mul_i32 s30, s17, 28
  v_add_u32 v32, s30, v32
  v_lshrrev_b32 v33, 4, v32
  v_and_b32 v32, 15, v32
  s_mov_b32 s30, 401408
  v_mul_lo_u32 v10, v10, s30
  v_mul_u32_u24 v33, 14336, v33
  v_add_u32 v10, v10, v33
  v_lshl_add_u32 v10, v3, 8, v10
  v_lshl_add_u32 v10, v32, 4, v10
  v_add_u32 v12, 6422528, v10
  s_lshl_b32 s30, s19, 6
  s_add_u32 s30, s30, 16
  v_add_u32 v8, s30, v4
  v_mul_u32_u24 v10, 2341, v8
  v_lshrrev_b32 v10, 16, v10
  v_mul_u32_u24 v11, 28, v10
  v_sub_u32 v32, v8, v11
  s_mul_i32 s30, s17, 28
  v_add_u32 v32, s30, v32
  v_lshrrev_b32 v33, 4, v32
  v_and_b32 v32, 15, v32
  s_mov_b32 s30, 401408
  v_mul_lo_u32 v10, v10, s30
  v_mul_u32_u24 v33, 14336, v33
  v_add_u32 v10, v10, v33
  v_lshl_add_u32 v10, v3, 8, v10
  v_lshl_add_u32 v10, v32, 4, v10
  v_add_u32 v13, 6422528, v10
  s_lshl_b32 s30, s19, 6
  s_add_u32 s30, s30, 32
  v_add_u32 v8, s30, v4
  v_mul_u32_u24 v10, 2341, v8
  v_lshrrev_b32 v10, 16, v10
  v_mul_u32_u24 v11, 28, v10
  v_sub_u32 v32, v8, v11
  s_mul_i32 s30, s17, 28
  v_add_u32 v32, s30, v32
  v_lshrrev_b32 v33, 4, v32
  v_and_b32 v32, 15, v32
  s_mov_b32 s30, 401408
  v_mul_lo_u32 v10, v10, s30
  v_mul_u32_u24 v33, 14336, v33
  v_add_u32 v10, v10, v33
  v_lshl_add_u32 v10, v3, 8, v10
  v_lshl_add_u32 v10, v32, 4, v10
  v_add_u32 v14, 6422528, v10
  s_lshl_b32 s30, s19, 6
  s_add_u32 s30, s30, 48
  v_add_u32 v8, s30, v4
  v_mul_u32_u24 v10, 2341, v8
  v_lshrrev_b32 v10, 16, v10
  v_mul_u32_u24 v11, 28, v10
  v_sub_u32 v32, v8, v11
  s_mul_i32 s30, s17, 28
  v_add_u32 v32, s30, v32
  v_lshrrev_b32 v33, 4, v32
  v_and_b32 v32, 15, v32
  s_mov_b32 s30, 401408
  v_mul_lo_u32 v10, v10, s30
  v_mul_u32_u24 v33, 14336, v33
  v_add_u32 v10, v10, v33
  v_lshl_add_u32 v10, v3, 8, v10
  v_lshl_add_u32 v10, v32, 4, v10
  v_add_u32 v15, 6422528, v10
  v_lshrrev_b32 v7, 2, v4
  v_lshlrev_b32 v7, 3, v7
  v_and_b32 v8, 3, v4
  v_add_u32 v7, v7, v8
  v_xor_b32 v10, v3, v4
  v_lshlrev_b32 v10, 4, v10
  v_lshl_add_u32 v10, v7, 9, v10
  v_add_u32 v10, s25, v10
  v_xor_b32 v32, 0, v10
  v_xor_b32 v33, 64, v10
  v_xor_b32 v34, 128, v10
  v_xor_b32 v35, 192, v10
  v_lshrrev_b32 v7, 2, v4
  v_lshl_add_u32 v7, v3, 3, v7
  v_lshlrev_b32 v7, 7, v7
  v_and_b32 v8, 3, v4
  v_lshl_add_u32 v7, v8, 3, v7
  v_lshrrev_b32 v8, 3, v4
  v_lshl_add_u32 v7, v8, 5, v7
  v_and_b32 v8, 1, v3
  v_lshl_add_u32 v7, v8, 6, v7
  s_waitcnt vmcnt(16)
  s_barrier
  s_cmp_eq_u32 s16, 3
  s_cbranch_scc1 bj_np0
  s_add_u32 m0, s48, 16384
  s_nop 0
  buffer_load_dwordx4 v16, s[60:63], s33 offen offset:0 lds
  buffer_load_dwordx4 v17, s[60:63], s33 offen offset:1024 lds
  buffer_load_dwordx4 v18, s[60:63], s33 offen offset:2048 lds
  buffer_load_dwordx4 v19, s[60:63], s33 offen offset:3072 lds
bj_np0:
  v_xor_b32 v9, 0, v7
  ds_read_b64_tr_b16 v[128:129], v9 offset:0
  ds_read_b64_tr_b16 v[130:131], v9 offset:512
  ds_read_b64_tr_b16 v[132:133], v9 offset:4096
  ds_read_b64_tr_b16 v[134:135], v9 offset:4608
  ds_read_b64_tr_b16 v[136:137], v9 offset:8192
  ds_read_b64_tr_b16 v[138:139], v9 offset:8704
  ds_read_b64_tr_b16 v[140:141], v9 offset:12288
  ds_read_b64_tr_b16 v[142:143], v9 offset:12800
  s_waitcnt lgkmcnt(6)
  ds_read_b64_tr_b16 v[144:145], v9 offset:16384
  ds_read_b64_tr_b16 v[146:147], v9 offset:16896
  ds_read_b64_tr_b16 v[148:149], v9 offset:20480
  ds_read_b64_tr_b16 v[150:151], v9 offset:20992
  ds_read_b64_tr_b16 v[152:153], v9 offset:24576
  ds_read_b64_tr_b16 v[154:155], v9 offset:25088
  ds_read_b64_tr_b16 v[156:157], v9 offset:28672
  ds_read_b64_tr_b16 v[158:159], v9 offset:29184
  s_waitcnt lgkmcnt(6)
  s_cmp_eq_u32 s16, 3
  s_cbranch_scc1 bj_np1
  s_add_u32 m0, s49, 16384
  s_nop 0
  buffer_load_dwordx4 v20, s[60:63], s33 offen offset:0 lds
  buffer_load_dwordx4 v21, s[60:63], s33 offen offset:1024 lds
  buffer_load_dwordx4 v22, s[60:63], s33 offen offset:2048 lds
  buffer_load_dwordx4 v23, s[60:63], s33 offen offset:3072 lds
bj_np1:
  v_xor_b32 v9, 32, v7
  ds_read_b64_tr_b16 v[160:161], v9 offset:0
  ds_read_b64_tr_b16 v[162:163], v9 offset:512
  ds_read_b64_tr_b16 v[164:165], v9 offset:4096
  ds_read_b64_tr_b16 v[166:167], v9 offset:4608
  ds_read_b64_tr_b16 v[168:169], v9 offset:8192
  ds_read_b64_tr_b16 v[170:171], v9 offset:8704
  ds_read_b64_tr_b16 v[172:173], v9 offset:12288
  ds_read_b64_tr_b16 v[174:175], v9 offset:12800
  s_waitcnt lgkmcnt(6)
  ds_read_b64_tr_b16 v[176:177], v9 offset:16384
  ds_read_b64_tr_b16 v[178:179], v9 offset:16896
  ds_read_b64_tr_b16 v[180:181], v9 offset:20480
  ds_read_b64_tr_b16 v[182:183], v9 offset:20992
  ds_read_b64_tr_b16 v[184:185], v9 offset:24576
  ds_read_b64_tr_b16 v[186:187], v9 offset:25088
  ds_read_b64_tr_b16 v[188:189], v9 offset:28672
  ds_read_b64_tr_b16 v[190:191], v9 offset:29184
  s_waitcnt lgkmcnt(6)
  s_cmp_eq_u32 s16, 3
  s_cbranch_scc1 bj_np2
  s_add_u32 m0, s50, 16384
  s_nop 0
  buffer_load_dwordx4 v24, s[60:63], s33 offen offset:0 lds
  buffer_load_dwordx4 v25, s[60:63], s33 offen offset:1024 lds
  buffer_load_dwordx4 v26, s[60:63], s33 offen offset:2048 lds
  buffer_load_dwordx4 v27, s[60:63], s33 offen offset:3072 lds
bj_np2:
  v_xor_b32 v9, 64, v7
  ds_read_b64_tr_b16 v[192:193], v9 offset:0
  ds_read_b64_tr_b16 v[194:195], v9 offset:512
  ds_read_b64_tr_b16 v[196:197], v9 offset:4096
  ds_read_b64_tr_b16 v[198:199], v9 offset:4608
  ds_read_b64_tr_b16 v[200:201], v9 offset:8192
  ds_read_b64_tr_b16 v[202:203], v9 offset:8704
  ds_read_b64_tr_b16 v[204:205], v9 offset:12288
  ds_read_b64_tr_b16 v[206:207], v9 offset:12800
  s_waitcnt lgkmcnt(6)
  ds_read_b64_tr_b16 v[208:209], v9 offset:16384
  ds_read_b64_tr_b16 v[210:211], v9 offset:16896
  ds_read_b64_tr_b16 v[212:213], v9 offset:20480
  ds_read_b64_tr_b16 v[214:215], v9 offset:20992
  ds_read_b64_tr_b16 v[216:217], v9 offset:24576
  ds_read_b64_tr_b16 v[218:219], v9 offset:25088
  ds_read_b64_tr_b16 v[220:221], v9 offset:28672
  ds_read_b64_tr_b16 v[222:223], v9 offset:29184
  s_waitcnt lgkmcnt(6)
  s_cmp_eq_u32 s16, 3
  s_cbranch_scc1 bj_np3
  s_add_u32 m0, s51, 16384
  s_nop 0
  buffer_load_dwordx4 v28, s[60:63], s33 offen offset:0 lds
  buffer_load_dwordx4 v29, s[60:63], s33 offen offset:1024 lds
  buffer_load_dwordx4 v30, s[60:63], s33 offen offset:2048 lds
  buffer_load_dwordx4 v31, s[60:63], s33 offen offset:3072 lds
bj_np3:
  v_xor_b32 v9, 96, v7
  ds_read_b64_tr_b16 v[224:225], v9 offset:0
  ds_read_b64_tr_b16 v[226:227], v9 offset:512
  ds_read_b64_tr_b16 v[228:229], v9 offset:4096
  ds_read_b64_tr_b16 v[230:231], v9 offset:4608
  ds_read_b64_tr_b16 v[232:233], v9 offset:8192
  ds_read_b64_tr_b16 v[234:235], v9 offset:8704
  ds_read_b64_tr_b16 v[236:237], v9 offset:12288
  ds_read_b64_tr_b16 v[238:239], v9 offset:12800
  s_waitcnt lgkmcnt(6)
  ds_read_b64_tr_b16 v[240:241], v9 offset:16384
  ds_read_b64_tr_b16 v[242:243], v9 offset:16896
  ds_read_b64_tr_b16 v[244:245], v9 offset:20480
  ds_read_b64_tr_b16 v[246:247], v9 offset:20992
  ds_read_b64_tr_b16 v[248:249], v9 offset:24576
  ds_read_b64_tr_b16 v[250:251], v9 offset:25088
  ds_read_b64_tr_b16 v[252:253], v9 offset:28672
  ds_read_b64_tr_b16 v[254:255], v9 offset:29184
  s_waitcnt lgkmcnt(6)
  s_mov_b32 s52, s36
  s_and_b32 s53, s37, 0xffff
  s_mov_b32 s54, 1835008
  s_mov_b32 s55, 0x20000
  s_lshl_b32 s20, s18, 8
  v_add_u32 v95, s20, v0
  s_mov_b32 s21, 9586981
  v_mul_hi_u32 v6, v95, s21
  v_mul_u32_u24 v7, 448, v6
  v_sub_u32 v7, v95, v7
  v_lshrrev_b32 v8, 4, v7
  v_and_b32 v7, 15, v7
  v_lshl_add_u32 v9, v6, 4, v7
  v_mul_u32_u24 v9, 896, v9
  v_lshl_add_u32 v9, v8, 5, v9
  buffer_load_dwordx4 v[84:87], v9, s[52:55], 0 offen
  buffer_load_dwordx4 v[88:91], v9, s[52:55], 0 offen offset:16
  v_mul_u32_u24 v6, 14336, v6
  v_lshl_add_u32 v6, v7, 4, v6
  v_lshl_add_u32 v92, v8, 9, v6
  v_lshrrev_b32 v7, 2, v8
  v_lshl_add_u32 v6, v7, 11, v6
  v_and_b32 v7, 3, v8
  v_lshl_add_u32 v93, v7, 8, v6
  s_mov_b32 s72, s38
  s_and_b32 s73, s39, 0xffff
  s_mov_b32 s74, 7168
  s_mov_b32 s75, 0x20000
  v_min_u32 v6, 223, v0
  v_lshrrev_b32 v7, 3, v6
  v_and_b32 v6, 7, v6
  v_mul_u32_u24 v9, 896, v6
  v_lshl_add_u32 v9, v7, 5, v9
  buffer_load_dwordx4 v[36:39], v9, s[72:75], 0 offen
  buffer_load_dwordx4 v[40:43], v9, s[72:75], 0 offen offset:16
  v_lshlrev_b32 v7, 8, v7
  v_lshl_add_u32 v94, v6, 4, v7
  s_lshl_b32 s26, s17, 9
  s_waitcnt vmcnt(20) lgkmcnt(0)
  s_cmp_lg_u32 s16, 3
  s_cbranch_scc1 w3_20
  s_waitcnt vmcnt(4)
w3_20:
  ds_read_b128 v[52:55], v32 offset:0
  ds_read_b128 v[56:59], v33 offset:0
  ds_read_b128 v[60:63], v34 offset:0
  ds_read_b128 v[64:67], v35 offset:0
  s_waitcnt lgkmcnt(3)
  v_mfma_f32_16x16x32_bf16 v[96:99], v[52:55], v[128:131], 0
  v_mfma_f32_16x16x32_bf16 v[100:103], v[52:55], v[160:163], 0
  v_mfma_f32_16x16x32_bf16 v[104:107], v[52:55], v[192:195], 0
  v_mfma_f32_16x16x32_bf16 v[108:111], v[52:55], v[224:227], 0
  ds_read_b128 v[52:55], v32 offset:256
  s_waitcnt lgkmcnt(3)
  v_mfma_f32_16x16x32_bf16 v[96:99], v[56:59], v[132:135], v[96:99]
  v_mfma_f32_16x16x32_bf16 v[100:103], v[56:59], v[164:167], v[100:103]
  v_mfma_f32_16x16x32_bf16 v[104:107], v[56:59], v[196:199], v[104:107]
  v_mfma_f32_16x16x32_bf16 v[108:111], v[56:59], v[228:231], v[108:111]
  ds_read_b128 v[56:59], v33 offset:256
  s_waitcnt lgkmcnt(3)
  v_mfma_f32_16x16x32_bf16 v[96:99], v[60:63], v[136:139], v[96:99]
  v_mfma_f32_16x16x32_bf16 v[100:103], v[60:63], v[168:171], v[100:103]
  v_mfma_f32_16x16x32_bf16 v[104:107], v[60:63], v[200:203], v[104:107]
  v_mfma_f32_16x16x32_bf16 v[108:111], v[60:63], v[232:235], v[108:111]
  ds_read_b128 v[60:63], v34 offset:256
  s_waitcnt lgkmcnt(3)
  v_mfma_f32_16x16x32_bf16 v[96:99], v[64:67], v[140:143], v[96:99]
  v_mfma_f32_16x16x32_bf16 v[100:103], v[64:67], v[172:175], v[100:103]
  v_mfma_f32_16x16x32_bf16 v[104:107], v[64:67], v[204:207], v[104:107]
  v_mfma_f32_16x16x32_bf16 v[108:111], v[64:67], v[236:239], v[108:111]
  ds_read_b128 v[64:67], v35 offset:256
  s_waitcnt lgkmcnt(3)
  v_mfma_f32_16x16x32_bf16 v[96:99], v[52:55], v[144:147], v[96:99]
  v_mfma_f32_16x16x32_bf16 v[100:103], v[52:55], v[176:179], v[100:103]
  v_mfma_f32_16x16x32_bf16 v[104:107], v[52:55], v[208:211], v[104:107]
  v_mfma_f32_16x16x32_bf16 v[108:111], v[52:55], v[240:243], v[108:111]
  ds_read_b128 v[52:55], v32 offset:2048
  s_waitcnt lgkmcnt(3)
  v_mfma_f32_16x16x32_bf16 v[96:99], v[56:59], v[148:151], v[96:99]
  v_mfma_f32_16x16x32_bf16 v[100:103], v[56:59], v[180:183], v[100:103]
  v_mfma_f32_16x16x32_bf16 v[104:107], v[56:59], v[212:215], v[104:107]
  v_mfma_f32_16x16x32_bf16 v[108:111], v[56:59], v[244:247], v[108:111]
  ds_read_b128 v[56:59], v33 offset:2048
  s_waitcnt lgkmcnt(3)
  v_mfma_f32_16x16x32_bf16 v[96:99], v[60:63], v[152:155], v[96:99]
  v_mfma_f32_16x16x32_bf16 v[100:103], v[60:63], v[184:187], v[100:103]
  v_mfma_f32_16x16x32_bf16 v[104:107], v[60:63], v[216:219], v[104:107]
  v_mfma_f32_16x16x32_bf16 v[108:111], v[60:63], v[248:251], v[108:111]
  ds_read_b128 v[60:63], v34 offset:2048
  s_waitcnt lgkmcnt(3)
  v_mfma_f32_16x16x32_bf16 v[96:99], v[64:67], v[156:159], v[96:99]
  v_mfma_f32_16x16x32_bf16 v[100:103], v[64:67], v[188:191], v[100:103]
  v_mfma_f32_16x16x32_bf16 v[104:107], v[64:67], v[220:223], v[104:107]
  v_mfma_f32_16x16x32_bf16 v[108:111], v[64:67], v[252:255], v[108:111]
  ds_read_b128 v[64:67], v35 offset:2048
  s_waitcnt lgkmcnt(3)
  v_mfma_f32_16x16x32_bf16 v[112:115], v[52:55], v[128:131], 0
  v_mfma_f32_16x16x32_bf16 v[116:119], v[52:55], v[160:163], 0
  v_mfma_f32_16x16x32_bf16 v[120:123], v[52:55], v[192:195], 0
  v_mfma_f32_16x16x32_bf16 v[124:127], v[52:55], v[224:227], 0
  ds_read_b128 v[52:55], v32 offset:2304
  s_waitcnt lgkmcnt(3)
  v_mfma_f32_16x16x32_bf16 v[112:115], v[56:59], v[132:135], v[112:115]
  v_mfma_f32_16x16x32_bf16 v[116:119], v[56:59], v[164:167], v[116:119]
  v_mfma_f32_16x16x32_bf16 v[120:123], v[56:59], v[196:199], v[120:123]
  v_mfma_f32_16x16x32_bf16 v[124:127], v[56:59], v[228:231], v[124:127]
  ds_read_b128 v[56:59], v33 offset:2304
  s_waitcnt lgkmcnt(3)
  v_mfma_f32_16x16x32_bf16 v[112:115], v[60:63], v[136:139], v[112:115]
  v_mfma_f32_16x16x32_bf16 v[116:119], v[60:63], v[168:171], v[116:119]
  v_mfma_f32_16x16x32_bf16 v[120:123], v[60:63], v[200:203], v[120:123]
  v_mfma_f32_16x16x32_bf16 v[124:127], v[60:63], v[232:235], v[124:127]
  ds_read_b128 v[60:63], v34 offset:2304
  s_waitcnt lgkmcnt(3)
  v_mfma_f32_16x16x32_bf16 v[112:115], v[64:67], v[140:143], v[112:115]
  v_mfma_f32_16x16x32_bf16 v[116:119], v[64:67], v[172:175], v[116:119]
  v_mfma_f32_16x16x32_bf16 v[120:123], v[64:67], v[204:207], v[120:123]
  v_mfma_f32_16x16x32_bf16 v[124:127], v[64:67], v[236:239], v[124:127]
  ds_read_b128 v[64:67], v35 offset:2304
  s_waitcnt lgkmcnt(3)
  v_mfma_f32_16x16x32_bf16 v[112:115], v[52:55], v[144:147], v[112:115]
  v_mfma_f32_16x16x32_bf16 v[116:119], v[52:55], v[176:179], v[116:119]
  v_mfma_f32_16x16x32_bf16 v[120:123], v[52:55], v[208:211], v[120:123]
  v_mfma_f32_16x16x32_bf16 v[124:127], v[52:55], v[240:243], v[124:127]
  s_waitcnt lgkmcnt(2)
  v_mfma_f32_16x16x32_bf16 v[112:115], v[56:59], v[148:151], v[112:115]
  v_mfma_f32_16x16x32_bf16 v[116:119], v[56:59], v[180:183], v[116:119]
  v_mfma_f32_16x16x32_bf16 v[120:123], v[56:59], v[212:215], v[120:123]
  v_mfma_f32_16x16x32_bf16 v[124:127], v[56:59], v[244:247], v[124:127]
  s_waitcnt lgkmcnt(1)
  v_mfma_f32_16x16x32_bf16 v[112:115], v[60:63], v[152:155], v[112:115]
  v_mfma_f32_16x16x32_bf16 v[116:119], v[60:63], v[184:187], v[116:119]
  v_mfma_f32_16x16x32_bf16 v[120:123], v[60:63], v[216:219], v[120:123]
  v_mfma_f32_16x16x32_bf16 v[124:127], v[60:63], v[248:251], v[124:127]
  s_waitcnt lgkmcnt(0)
  v_mfma_f32_16x16x32_bf16 v[112:115], v[64:67], v[156:159], v[112:115]
  v_mfma_f32_16x16x32_bf16 v[116:119], v[64:67], v[188:191], v[116:119]
  v_mfma_f32_16x16x32_bf16 v[120:123], v[64:67], v[220:223], v[120:123]
  v_mfma_f32_16x16x32_bf16 v[124:127], v[64:67], v[252:255], v[124:127]
  s_lshl_b32 s30, s28, 10
  v_cvt_pk_bf16_f32 v68, v96, v97
  v_cvt_pk_bf16_f32 v69, v98, v99
  v_cvt_pk_bf16_f32 v70, v112, v113
  v_cvt_pk_bf16_f32 v71, v114, v115
  buffer_store_dwordx4 v[68:71], v12, s[8:11], s30 offen sc1
  v_cvt_pk_bf16_f32 v72, v100, v101
  v_cvt_pk_bf16_f32 v73, v102, v103
  v_cvt_pk_bf16_f32 v74, v116, v117
  v_cvt_pk_bf16_f32 v75, v118, v119
  buffer_store_dwordx4 v[72:75], v13, s[8:11], s30 offen sc1
  v_cvt_pk_bf16_f32 v76, v104, v105
  v_cvt_pk_bf16_f32 v77, v106, v107
  v_cvt_pk_bf16_f32 v78, v120, v121
  v_cvt_pk_bf16_f32 v79, v122, v123
  buffer_store_dwordx4 v[76:79], v14, s[8:11], s30 offen sc1
  v_cvt_pk_bf16_f32 v80, v108, v109
  v_cvt_pk_bf16_f32 v81, v110, v111
  v_cvt_pk_bf16_f32 v82, v124, v125
  v_cvt_pk_bf16_f32 v83, v126, v127
  buffer_store_dwordx4 v[80:83], v15, s[8:11], s30 offen sc1
  s_cmp_eq_u32 s16, 3
  s_cbranch_scc1 bj_w3
  s_waitcnt vmcnt(8)
  ds_read_b128 v[52:55], v32 offset:16384
  ds_read_b128 v[56:59], v33 offset:16384
  ds_read_b128 v[60:63], v34 offset:16384
  ds_read_b128 v[64:67], v35 offset:16384
  s_waitcnt lgkmcnt(3)
  v_mfma_f32_16x16x32_bf16 v[96:99], v[52:55], v[128:131], 0
  v_mfma_f32_16x16x32_bf16 v[100:103], v[52:55], v[160:163], 0
  v_mfma_f32_16x16x32_bf16 v[104:107], v[52:55], v[192:195], 0
  v_mfma_f32_16x16x32_bf16 v[108:111], v[52:55], v[224:227], 0
  ds_read_b128 v[52:55], v32 offset:16640
  s_waitcnt lgkmcnt(3)
  v_mfma_f32_16x16x32_bf16 v[96:99], v[56:59], v[132:135], v[96:99]
  v_mfma_f32_16x16x32_bf16 v[100:103], v[56:59], v[164:167], v[100:103]
  v_mfma_f32_16x16x32_bf16 v[104:107], v[56:59], v[196:199], v[104:107]
  v_mfma_f32_16x16x32_bf16 v[108:111], v[56:59], v[228:231], v[108:111]
  ds_read_b128 v[56:59], v33 offset:16640
  s_waitcnt lgkmcnt(3)
  v_mfma_f32_16x16x32_bf16 v[96:99], v[60:63], v[136:139], v[96:99]
  v_mfma_f32_16x16x32_bf16 v[100:103], v[60:63], v[168:171], v[100:103]
  v_mfma_f32_16x16x32_bf16 v[104:107], v[60:63], v[200:203], v[104:107]
  v_mfma_f32_16x16x32_bf16 v[108:111], v[60:63], v[232:235], v[108:111]
  ds_read_b128 v[60:63], v34 offset:16640
  s_waitcnt lgkmcnt(3)
  v_mfma_f32_16x16x32_bf16 v[96:99], v[64:67], v[140:143], v[96:99]
  v_mfma_f32_16x16x32_bf16 v[100:103], v[64:67], v[172:175], v[100:103]
  v_mfma_f32_16x16x32_bf16 v[104:107], v[64:67], v[204:207], v[104:107]
  v_mfma_f32_16x16x32_bf16 v[108:111], v[64:67], v[236:239], v[108:111]
  ds_read_b128 v[64:67], v35 offset:16640
  s_waitcnt lgkmcnt(3)
  v_mfma_f32_16x16x32_bf16 v[96:99], v[52:55], v[144:147], v[96:99]
  v_mfma_f32_16x16x32_bf16 v[100:103], v[52:55], v[176:179], v[100:103]
  v_mfma_f32_16x16x32_bf16 v[104:107], v[52:55], v[208:211], v[104:107]
  v_mfma_f32_16x16x32_bf16 v[108:111], v[52:55], v[240:243], v[108:111]
  ds_read_b128 v[52:55], v32 offset:18432
  s_waitcnt lgkmcnt(3)
  v_mfma_f32_16x16x32_bf16 v[96:99], v[56:59], v[148:151], v[96:99]
  v_mfma_f32_16x16x32_bf16 v[100:103], v[56:59], v[180:183], v[100:103]
  v_mfma_f32_16x16x32_bf16 v[104:107], v[56:59], v[212:215], v[104:107]
  v_mfma_f32_16x16x32_bf16 v[108:111], v[56:59], v[244:247], v[108:111]
  ds_read_b128 v[56:59], v33 offset:18432
  s_waitcnt lgkmcnt(3)
  v_mfma_f32_16x16x32_bf16 v[96:99], v[60:63], v[152:155], v[96:99]
  v_mfma_f32_16x16x32_bf16 v[100:103], v[60:63], v[184:187], v[100:103]
  v_mfma_f32_16x16x32_bf16 v[104:107], v[60:63], v[216:219], v[104:107]
  v_mfma_f32_16x16x32_bf16 v[108:111], v[60:63], v[248:251], v[108:111]
  ds_read_b128 v[60:63], v34 offset:18432
  s_waitcnt lgkmcnt(3)
  v_mfma_f32_16x16x32_bf16 v[96:99], v[64:67], v[156:159], v[96:99]
  v_mfma_f32_16x16x32_bf16 v[100:103], v[64:67], v[188:191], v[100:103]
  v_mfma_f32_16x16x32_bf16 v[104:107], v[64:67], v[220:223], v[104:107]
  v_mfma_f32_16x16x32_bf16 v[108:111], v[64:67], v[252:255], v[108:111]
  ds_read_b128 v[64:67], v35 offset:18432
  s_waitcnt lgkmcnt(3)
  v_mfma_f32_16x16x32_bf16 v[112:115], v[52:55], v[128:131], 0
  v_mfma_f32_16x16x32_bf16 v[116:119], v[52:55], v[160:163], 0
  v_mfma_f32_16x16x32_bf16 v[120:123], v[52:55], v[192:195], 0
  v_mfma_f32_16x16x32_bf16 v[124:127], v[52:55], v[224:227], 0
  ds_read_b128 v[52:55], v32 offset:18688
  s_waitcnt lgkmcnt(3)
  v_mfma_f32_16x16x32_bf16 v[112:115], v[56:59], v[132:135], v[112:115]
  v_mfma_f32_16x16x32_bf16 v[116:119], v[56:59], v[164:167], v[116:119]
  v_mfma_f32_16x16x32_bf16 v[120:123], v[56:59], v[196:199], v[120:123]
  v_mfma_f32_16x16x32_bf16 v[124:127], v[56:59], v[228:231], v[124:127]
  ds_read_b128 v[56:59], v33 offset:18688
  s_waitcnt lgkmcnt(3)
  v_mfma_f32_16x16x32_bf16 v[112:115], v[60:63], v[136:139], v[112:115]
  v_mfma_f32_16x16x32_bf16 v[116:119], v[60:63], v[168:171], v[116:119]
  v_mfma_f32_16x16x32_bf16 v[120:123], v[60:63], v[200:203], v[120:123]
  v_mfma_f32_16x16x32_bf16 v[124:127], v[60:63], v[232:235], v[124:127]
  ds_read_b128 v[60:63], v34 offset:18688
  s_waitcnt lgkmcnt(3)
  v_mfma_f32_16x16x32_bf16 v[112:115], v[64:67], v[140:143], v[112:115]
  v_mfma_f32_16x16x32_bf16 v[116:119], v[64:67], v[172:175], v[116:119]
  v_mfma_f32_16x16x32_bf16 v[120:123], v[64:67], v[204:207], v[120:123]
  v_mfma_f32_16x16x32_bf16 v[124:127], v[64:67], v[236:239], v[124:127]
  ds_read_b128 v[64:67], v35 offset:18688
  s_waitcnt lgkmcnt(3)
  v_mfma_f32_16x16x32_bf16 v[112:115], v[52:55], v[144:147], v[112:115]
  v_mfma_f32_16x16x32_bf16 v[116:119], v[52:55], v[176:179], v[116:119]
  v_mfma_f32_16x16x32_bf16 v[120:123], v[52:55], v[208:211], v[120:123]
  v_mfma_f32_16x16x32_bf16 v[124:127], v[52:55], v[240:243], v[124:127]
  s_waitcnt lgkmcnt(2)
  v_mfma_f32_16x16x32_bf16 v[112:115], v[56:59], v[148:151], v[112:115]
  v_mfma_f32_16x16x32_bf16 v[116:119], v[56:59], v[180:183], v[116:119]
  v_mfma_f32_16x16x32_bf16 v[120:123], v[56:59], v[212:215], v[120:123]
  v_mfma_f32_16x16x32_bf16 v[124:127], v[56:59], v[244:247], v[124:127]
  s_waitcnt lgkmcnt(1)
  v_mfma_f32_16x16x32_bf16 v[112:115], v[60:63], v[152:155], v[112:115]
  v_mfma_f32_16x16x32_bf16 v[116:119], v[60:63], v[184:187], v[116:119]
  v_mfma_f32_16x16x32_bf16 v[120:123], v[60:63], v[216:219], v[120:123]
  v_mfma_f32_16x16x32_bf16 v[124:127], v[60:63], v[248:251], v[124:127]
  s_waitcnt lgkmcnt(0)
  v_mfma_f32_16x16x32_bf16 v[112:115], v[64:67], v[156:159], v[112:115]
  v_mfma_f32_16x16x32_bf16 v[116:119], v[64:67], v[188:191], v[116:119]
  v_mfma_f32_16x16x32_bf16 v[120:123], v[64:67], v[220:223], v[120:123]
  v_mfma_f32_16x16x32_bf16 v[124:127], v[64:67], v[252:255], v[124:127]
  s_lshl_b32 s30, s29, 10
  v_cvt_pk_bf16_f32 v68, v96, v97
  v_cvt_pk_bf16_f32 v69, v98, v99
  v_cvt_pk_bf16_f32 v70, v112, v113
  v_cvt_pk_bf16_f32 v71, v114, v115
  buffer_store_dwordx4 v[68:71], v12, s[8:11], s30 offen sc1
  v_cvt_pk_bf16_f32 v72, v100, v101
  v_cvt_pk_bf16_f32 v73, v102, v103
  v_cvt_pk_bf16_f32 v74, v116, v117
  v_cvt_pk_bf16_f32 v75, v118, v119
  buffer_store_dwordx4 v[72:75], v13, s[8:11], s30 offen sc1
  v_cvt_pk_bf16_f32 v76, v104, v105
  v_cvt_pk_bf16_f32 v77, v106, v107
  v_cvt_pk_bf16_f32 v78, v120, v121
  v_cvt_pk_bf16_f32 v79, v122, v123
  buffer_store_dwordx4 v[76:79], v14, s[8:11], s30 offen sc1
  v_cvt_pk_bf16_f32 v80, v108, v109
  v_cvt_pk_bf16_f32 v81, v110, v111
  v_cvt_pk_bf16_f32 v82, v124, v125
  v_cvt_pk_bf16_f32 v83, v126, v127
  buffer_store_dwordx4 v[80:83], v15, s[8:11], s30 offen sc1
bj_w3:
  s_lshl_b32 s77, s19, 8
  s_lshl_b32 s21, s17, 4
  s_add_u32 s77, s77, s21
  s_cmp_lg_u32 s31, 0
  s_cselect_b32 s21, 8, 0
  s_add_u32 s77, s77, s21
  s_add_u32 s77, s77, 88588288
  s_add_u32 s78, s77, 2048
  s_cmp_lg_u32 s66, 0
  s_cbranch_scc1 bj_cf
  s_cmp_lg_u32 s16, 0
  s_cbranch_scc1 w0_21
  s_waitcnt vmcnt(8)
  v_readfirstlane_b32 s70, v46
  s_cmp_lg_u32 s70, 0
  s_cbranch_scc1 bj_nz
  v_mov_b32 v45, 128
  v_mov_b32 v46, s88
  v_mov_b32 v47, s89
  v_mov_b32 v48, 0
  v_mov_b32 v49, 0
  s_mov_b64 exec, 1
  buffer_atomic_cmpswap_x2 v[46:49], v45, s[12:15], 0 offen sc0
  s_mov_b64 exec, -1
  s_waitcnt vmcnt(0)
  v_readfirstlane_b32 s70, v46
  s_cmp_lg_u32 s70, 0
  s_cbranch_scc1 bj_nz
  v_mov_b32 v46, s88
  v_mov_b32 v47, s89
bj_nz:
w0_21:
  v_mov_b32 v45, 160000
  s_add_u32 s101, s101, 1
  s_barrier
  s_mov_b64 exec, 1
  s_cmp_lg_u32 s16, 0
  s_cbranch_scc1 w0_22
  ds_write_b32 v45, v44 offset:0
  ds_write_b32 v45, v46 offset:4
  ds_write_b32 v45, v47 offset:8
  s_waitcnt lgkmcnt(0)
  v_mov_b32 v44, s101
  ds_write_b32 v45, v44 offset:16
  s_waitcnt lgkmcnt(0)
w0_22:
  s_mov_b64 exec, -1
  s_barrier
  ds_read_b32 v44, v45 offset:0
  ds_read_b32 v46, v45 offset:4
  ds_read_b32 v47, v45 offset:8
  ds_read_b32 v45, v45 offset:16
  s_waitcnt lgkmcnt(0)
  v_readfirstlane_b32 s70, v44
  v_readfirstlane_b32 s88, v46
  v_readfirstlane_b32 s89, v47
  v_cmp_ne_u32 vcc, s101, v45
  s_cbranch_vccnz ch_end
  s_mov_b32 s66, 1
  s_bitcmp1_b32 s70, s3
  s_cbranch_scc1 m_reclaim
bj_cf:
  s_barrier
  s_mov_b32 s56, s40
  s_and_b32 s57, s41, 0xffff
  s_mov_b32 s58, 3670016
  s_mov_b32 s59, 0x20000
  s_mov_b32 s60, s42
  s_and_b32 s61, s43, 0xffff
  s_mov_b32 s62, 3670016
  s_mov_b32 s63, 0x20000
  s_add_u32 s28, s31, s19
  v_lshrrev_b32 v5, 5, v1
  v_and_b32 v6, 31, v1
  v_xor_b32 v6, v6, v5
  v_lshlrev_b32 v6, 4, v6
  v_lshl_add_u32 v6, v5, 13, v6
  s_lshl_b32 s20, s16, 6
  v_xor_b32 v7, s20, v6
  s_lshl_b32 s22, s28, 18
  s_lshl_b32 s21, s16, 16
  s_add_u32 s22, s22, s21
  s_add_u32 s22, s22, s26
  s_lshl_b32 m0, s16, 12
  v_xor_b32 v8, 0, v7
  buffer_load_dwordx4 v8, s[56:59], s22 offen offset:0 lds
  v_xor_b32 v8, 32, v7
  v_add_u32 v8, 15360, v8
  buffer_load_dwordx4 v8, s[56:59], s22 offen offset:1024 lds
  v_xor_b32 v8, 0, v7
  v_add_u32 v8, 30720, v8
  buffer_load_dwordx4 v8, s[56:59], s22 offen offset:2048 lds
  v_xor_b32 v8, 32, v7
  v_add_u32 v8, 46080, v8
  buffer_load_dwordx4 v8, s[56:59], s22 offen offset:3072 lds
  v_xor_b32 v16, 0, v6
  v_xor_b32 v17, 32, v6
  v_add_u32 v17, 31744, v17
  v_xor_b32 v18, 64, v6
  v_add_u32 v18, 129024, v18
  v_xor_b32 v19, 96, v6
  v_add_u32 v19, 160768, v19
  v_xor_b32 v20, 128, v6
  v_add_u32 v20, 262144, v20
  v_xor_b32 v21, 160, v6
  v_add_u32 v21, 293888, v21
  v_xor_b32 v22, 192, v6
  v_add_u32 v22, 391168, v22
  v_xor_b32 v23, 224, v6
  v_add_u32 v23, 422912, v23
  s_lshr_b32 s20, s16, 1
  s_lshl_b32 s20, s20, 16
  s_and_b32 s21, s16, 1
  s_lshl_b32 s21, s21, 14
  s_add_u32 s20, s20, s21
  s_add_u32 s29, s20, s26
  s_mul_i32 s25, s16, 24576
  s_add_u32 s25, s25, 16384
  s_add_u32 s22, s29, 2097152
  s_add_u32 m0, s25, 0
  s_nop 0
  buffer_load_dwordx4 v16, s[60:63], s22 offen offset:0 lds
  buffer_load_dwordx4 v17, s[60:63], s22 offen offset:1024 lds
  buffer_load_dwordx4 v18, s[60:63], s22 offen offset:2048 lds
  buffer_load_dwordx4 v19, s[60:63], s22 offen offset:3072 lds
  s_add_u32 m0, s25, 4096
  s_nop 0
  buffer_load_dwordx4 v20, s[60:63], s22 offen offset:0 lds
  buffer_load_dwordx4 v21, s[60:63], s22 offen offset:1024 lds
  buffer_load_dwordx4 v22, s[60:63], s22 offen offset:2048 lds
  buffer_load_dwordx4 v23, s[60:63], s22 offen offset:3072 lds
  s_waitcnt vmcnt(12)
  s_barrier
  s_cmp_lg_u32 s16, 0
  s_cbranch_scc1 pub_23
  v_mul_u32_u24 v50, 2048, v1
  v_mov_b32 v48, s88
  v_mov_b32 v49, s89
  s_mov_b64 exec, 1
  buffer_store_dwordx2 v[48:49], v50, s[8:11], s77 offen sc1
  s_mov_b64 exec, -1
pub_23:
  s_cmp_ge_u32 s18, 70
  s_cbranch_scc1 bk_nm
  s_mov_b32 s20, 71565312
  buffer_store_dwordx4 v[84:87], v92, s[8:11], s20 offen sc1
  buffer_store_dwordx4 v[88:91], v92, s[8:11], s20 offen offset:256 sc1
  s_cmp_lg_u32 s18, 0
  s_cbranch_scc1 bk_nm
  v_min_u32 v104, -2, v36
  v_min_u32 v108, -2, v37
  v_min_u32 v105, -2, v38
  v_min_u32 v109, -2, v39
  v_min_u32 v106, -2, v40
  v_min_u32 v110, -2, v41
  v_min_u32 v107, -2, v42
  v_min_u32 v111, -2, v43
  s_mov_b32 s20, 75235328
  s_mov_b32 s21, 88068096
  buffer_store_dwordx4 v[104:107], v94, s[8:11], s20 offen sc1
  buffer_store_dwordx4 v[108:111], v94, s[8:11], s20 offen offset:128 sc1
  buffer_store_dwordx4 v[104:107], v94, s[8:11], s21 offen sc1
  buffer_store_dwordx4 v[108:111], v94, s[8:11], s21 offen offset:128 sc1
bk_nm:
  s_mov_b32 s23, 75235328
  v_add_u32 v6, 448, v95
  v_subrev_u32 v7, 1344, v6
  v_mov_b32 v52, -1
  v_mov_b32 v9, 0
  v_cmp_gt_u32 vcc, 256, v7
  s_nop 1
  v_cndmask_b32 v52, v52, v9, vcc
  v_mov_b32 v53, v52
  v_mov_b32 v54, v52
  v_mov_b32 v55, v52
  v_lshlrev_b32 v8, 4, v6
  v_mov_b32 v9, 0x10000000
  v_cmp_lt_u32 vcc, 31999, v6
  s_nop 1
  v_cndmask_b32 v8, v8, v9, vcc
  buffer_store_dwordx4 v[52:55], v8, s[8:11], s23 offen sc1
  s_mov_b32 s23, 87945216
  v_add_u32 v6, 448, v95
  v_cmp_gt_u32 vcc, 7680, v95
  s_nop 1
  v_cndmask_b32 v6, v6, v95, vcc
  v_subrev_u32 v7, 36352, v6
  v_mov_b32 v56, -1
  v_mov_b32 v9, 0
  v_cmp_gt_u32 vcc, 1048576, v7
  s_nop 1
  v_cndmask_b32 v56, v56, v9, vcc
  v_mov_b32 v57, v56
  v_mov_b32 v58, v56
  v_mov_b32 v59, v56
  v_lshlrev_b32 v8, 4, v6
  v_mov_b32 v9, 0x10000000
  v_cmp_lt_u32 vcc, 40191, v6
  s_nop 1
  v_cndmask_b32 v8, v8, v9, vcc
  buffer_store_dwordx4 v[56:59], v8, s[8:11], s23 offen sc1
  s_add_u32 s22, s29, 2621440
  s_add_u32 m0, s25, 8192
  s_nop 0
  buffer_load_dwordx4 v16, s[60:63], s22 offen offset:0 lds
  buffer_load_dwordx4 v17, s[60:63], s22 offen offset:1024 lds
  buffer_load_dwordx4 v18, s[60:63], s22 offen offset:2048 lds
  buffer_load_dwordx4 v19, s[60:63], s22 offen offset:3072 lds
  s_add_u32 m0, s25, 12288
  s_nop 0
  buffer_load_dwordx4 v20, s[60:63], s22 offen offset:0 lds
  buffer_load_dwordx4 v21, s[60:63], s22 offen offset:1024 lds
  buffer_load_dwordx4 v22, s[60:63], s22 offen offset:2048 lds
  buffer_load_dwordx4 v23, s[60:63], s22 offen offset:3072 lds
  s_add_u32 s22, s29, 3145728
  s_add_u32 m0, s25, 16384
  s_nop 0
  buffer_load_dwordx4 v16, s[60:63], s22 offen offset:0 lds
  buffer_load_dwordx4 v17, s[60:63], s22 offen offset:1024 lds
  buffer_load_dwordx4 v18, s[60:63], s22 offen offset:2048 lds
  buffer_load_dwordx4 v19, s[60:63], s22 offen offset:3072 lds
  s_add_u32 m0, s25, 20480
  s_nop 0
  buffer_load_dwordx4 v20, s[60:63], s22 offen offset:0 lds
  buffer_load_dwordx4 v21, s[60:63], s22 offen offset:1024 lds
  buffer_load_dwordx4 v22, s[60:63], s22 offen offset:2048 lds
  buffer_load_dwordx4 v23, s[60:63], s22 offen offset:3072 lds
  v_mov_b32 v250, s68
  s_or_b32 s20, s69, s16
  s_cbranch_scc1 bj_ht
  s_cmp_lg_u32 s16, 0
  s_cbranch_scc1 w0_24
  v_mov_b32 v250, 1
  v_mov_b32 v251, 192
  s_mov_b64 exec, 1
  buffer_atomic_add v250, v251, s[12:15], 0 offen sc0
  s_mov_b64 exec, -1
w0_24:
  s_branch bj_h2
bj_ht:
  buffer_load_dword v251, off, s[8:11], s77
bj_h2:
  v_lshrrev_b32 v7, 2, v4
  v_lshlrev_b32 v7, 3, v7
  v_and_b32 v8, 3, v4
  v_add_u32 v7, v7, v8
  v_xor_b32 v10, v3, v4
  v_lshlrev_b32 v10, 4, v10
  v_lshl_add_u32 v11, v4, 9, v10
  v_add_u32 v11, s25, v11
  v_lshl_add_u32 v10, v7, 9, v10
  v_xor_b32 v32, 0, v10
  v_xor_b32 v36, 0, v11
  v_xor_b32 v33, 64, v10
  v_xor_b32 v37, 64, v11
  v_xor_b32 v34, 128, v10
  v_xor_b32 v38, 128, v11
  v_xor_b32 v35, 192, v10
  v_xor_b32 v39, 192, v11
  s_mul_i32 s30, s17, 401408
  s_mul_i32 s20, s16, 14336
  s_add_u32 s30, s30, s20
  s_lshl_b32 s20, s28, 10
  s_add_u32 s30, s30, s20
  s_mov_b32 s24, 1035512379
  s_lshl_b32 s20, s17, 7
  s_lshl_b32 s28, s28, 3
  s_add_u32 s28, s28, s20
  s_add_u32 s28, s28, 88623104
  s_waitcnt vmcnt(1)
  s_barrier
  s_cmp_lg_u32 s16, 0
  s_cbranch_scc1 w0_25
  v_mul_u32_u24 v50, 2048, v1
  v_mov_b32 v48, s88
  v_mov_b32 v49, s89
  s_mov_b64 exec, 511
  buffer_store_dwordx2 v[48:49], v50, s[8:11], s78 offen sc1
  s_mov_b64 exec, -1
w0_25:
  ds_read_b128 v[128:131], v32 offset:0
  ds_read_b128 v[132:135], v32 offset:2048
  ds_read_b128 v[136:139], v36 offset:0
  ds_read_b128 v[140:143], v36 offset:8192
  ds_read_b128 v[144:147], v36 offset:16384
  ds_read_b128 v[148:151], v33 offset:0
  ds_read_b128 v[152:155], v33 offset:2048
  ds_read_b128 v[156:159], v37 offset:0
  ds_read_b128 v[160:163], v37 offset:8192
  ds_read_b128 v[164:167], v37 offset:16384
  ds_read_b128 v[168:171], v34 offset:0
  ds_read_b128 v[172:175], v34 offset:2048
  ds_read_b128 v[176:179], v38 offset:0
  ds_read_b128 v[180:183], v38 offset:8192
  ds_read_b128 v[184:187], v38 offset:16384
  s_waitcnt lgkmcnt(10)
  v_mfma_f32_16x16x32_bf16 v[96:99], v[128:131], v[136:139], 0
  v_mfma_f32_16x16x32_bf16 v[100:103], v[132:135], v[136:139], 0
  v_mfma_f32_16x16x32_bf16 v[104:107], v[128:131], v[140:143], 0
  v_mfma_f32_16x16x32_bf16 v[108:111], v[132:135], v[140:143], 0
  v_mfma_f32_16x16x32_bf16 v[112:115], v[128:131], v[144:147], 0
  v_mfma_f32_16x16x32_bf16 v[116:119], v[132:135], v[144:147], 0
  ds_read_b128 v[128:131], v35 offset:0
  ds_read_b128 v[132:135], v35 offset:2048
  ds_read_b128 v[136:139], v39 offset:0
  ds_read_b128 v[140:143], v39 offset:8192
  ds_read_b128 v[144:147], v39 offset:16384
  s_waitcnt lgkmcnt(10)
  v_mfma_f32_16x16x32_bf16 v[96:99], v[148:151], v[156:159], v[96:99]
  v_mfma_f32_16x16x32_bf16 v[100:103], v[152:155], v[156:159], v[100:103]
  v_mfma_f32_16x16x32_bf16 v[104:107], v[148:151], v[160:163], v[104:107]
  v_mfma_f32_16x16x32_bf16 v[108:111], v[152:155], v[160:163], v[108:111]
  v_mfma_f32_16x16x32_bf16 v[112:115], v[148:151], v[164:167], v[112:115]
  v_mfma_f32_16x16x32_bf16 v[116:119], v[152:155], v[164:167], v[116:119]
  ds_read_b128 v[148:151], v32 offset:256
  ds_read_b128 v[152:155], v32 offset:2304
  ds_read_b128 v[156:159], v36 offset:256
  ds_read_b128 v[160:163], v36 offset:8448
  ds_read_b128 v[164:167], v36 offset:16640
  s_waitcnt lgkmcnt(10)
  v_mfma_f32_16x16x32_bf16 v[96:99], v[168:171], v[176:179], v[96:99]
  v_mfma_f32_16x16x32_bf16 v[100:103], v[172:175], v[176:179], v[100:103]
  v_mfma_f32_16x16x32_bf16 v[104:107], v[168:171], v[180:183], v[104:107]
  v_mfma_f32_16x16x32_bf16 v[108:111], v[172:175], v[180:183], v[108:111]
  v_mfma_f32_16x16x32_bf16 v[112:115], v[168:171], v[184:187], v[112:115]
  v_mfma_f32_16x16x32_bf16 v[116:119], v[172:175], v[184:187], v[116:119]
  ds_read_b128 v[168:171], v33 offset:256
  ds_read_b128 v[172:175], v33 offset:2304
  ds_read_b128 v[176:179], v37 offset:256
  ds_read_b128 v[180:183], v37 offset:8448
  ds_read_b128 v[184:187], v37 offset:16640
  s_waitcnt lgkmcnt(10)
  v_mfma_f32_16x16x32_bf16 v[96:99], v[128:131], v[136:139], v[96:99]
  v_mfma_f32_16x16x32_bf16 v[100:103], v[132:135], v[136:139], v[100:103]
  v_mfma_f32_16x16x32_bf16 v[104:107], v[128:131], v[140:143], v[104:107]
  v_mfma_f32_16x16x32_bf16 v[108:111], v[132:135], v[140:143], v[108:111]
  v_mfma_f32_16x16x32_bf16 v[112:115], v[128:131], v[144:147], v[112:115]
  v_mfma_f32_16x16x32_bf16 v[116:119], v[132:135], v[144:147], v[116:119]
  ds_read_b128 v[128:131], v34 offset:256
  ds_read_b128 v[132:135], v34 offset:2304
  ds_read_b128 v[136:139], v38 offset:256
  ds_read_b128 v[140:143], v38 offset:8448
  ds_read_b128 v[144:147], v38 offset:16640
  s_waitcnt lgkmcnt(10)
  v_mfma_f32_16x16x32_bf16 v[96:99], v[148:151], v[156:159], v[96:99]
  v_mfma_f32_16x16x32_bf16 v[100:103], v[152:155], v[156:159], v[100:103]
  v_mfma_f32_16x16x32_bf16 v[104:107], v[148:151], v[160:163], v[104:107]
  v_mfma_f32_16x16x32_bf16 v[108:111], v[152:155], v[160:163], v[108:111]
  v_mfma_f32_16x16x32_bf16 v[112:115], v[148:151], v[164:167], v[112:115]
  v_mfma_f32_16x16x32_bf16 v[116:119], v[152:155], v[164:167], v[116:119]
  ds_read_b128 v[148:151], v35 offset:256
  ds_read_b128 v[152:155], v35 offset:2304
  ds_read_b128 v[156:159], v39 offset:256
  ds_read_b128 v[160:163], v39 offset:8448
  ds_read_b128 v[164:167], v39 offset:16640
  s_waitcnt lgkmcnt(10)
  v_mfma_f32_16x16x32_bf16 v[96:99], v[168:171], v[176:179], v[96:99]
  v_mfma_f32_16x16x32_bf16 v[100:103], v[172:175], v[176:179], v[100:103]
  v_mfma_f32_16x16x32_bf16 v[104:107], v[168:171], v[180:183], v[104:107]
  v_mfma_f32_16x16x32_bf16 v[108:111], v[172:175], v[180:183], v[108:111]
  v_mfma_f32_16x16x32_bf16 v[112:115], v[168:171], v[184:187], v[112:115]
  v_mfma_f32_16x16x32_bf16 v[116:119], v[172:175], v[184:187], v[116:119]
  s_waitcnt lgkmcnt(5)
  v_mfma_f32_16x16x32_bf16 v[96:99], v[128:131], v[136:139], v[96:99]
  v_mfma_f32_16x16x32_bf16 v[100:103], v[132:135], v[136:139], v[100:103]
  v_mfma_f32_16x16x32_bf16 v[104:107], v[128:131], v[140:143], v[104:107]
  v_mfma_f32_16x16x32_bf16 v[108:111], v[132:135], v[140:143], v[108:111]
  v_mfma_f32_16x16x32_bf16 v[112:115], v[128:131], v[144:147], v[112:115]
  v_mfma_f32_16x16x32_bf16 v[116:119], v[132:135], v[144:147], v[116:119]
  s_waitcnt lgkmcnt(0)
  v_mfma_f32_16x16x32_bf16 v[96:99], v[148:151], v[156:159], v[96:99]
  v_mfma_f32_16x16x32_bf16 v[100:103], v[152:155], v[156:159], v[100:103]
  v_mfma_f32_16x16x32_bf16 v[104:107], v[148:151], v[160:163], v[104:107]
  v_mfma_f32_16x16x32_bf16 v[108:111], v[152:155], v[160:163], v[108:111]
  v_mfma_f32_16x16x32_bf16 v[112:115], v[148:151], v[164:167], v[112:115]
  v_mfma_f32_16x16x32_bf16 v[116:119], v[152:155], v[164:167], v[116:119]
  v_mul_f32 v96, s24, v96
  v_mul_f32 v97, s24, v97
  v_mul_f32 v98, s24, v98
  v_mul_f32 v99, s24, v99
  v_mul_f32 v100, s24, v100
  v_mul_f32 v101, s24, v101
  v_mul_f32 v102, s24, v102
  v_mul_f32 v103, s24, v103
  v_cvt_pk_bf16_f32 v68, v96, v97
  v_cvt_pk_bf16_f32 v69, v98, v99
  v_cvt_pk_bf16_f32 v70, v100, v101
  v_cvt_pk_bf16_f32 v71, v102, v103
  s_add_u32 s20, s30, 229376
  buffer_store_dwordx4 v[68:71], v2, s[8:11], s20 offen sc1
  v_mul_f32 v104, s24, v104
  v_mul_f32 v105, s24, v105
  v_mul_f32 v106, s24, v106
  v_mul_f32 v107, s24, v107
  v_mul_f32 v108, s24, v108
  v_mul_f32 v109, s24, v109
  v_mul_f32 v110, s24, v110
  v_mul_f32 v111, s24, v111
  v_cvt_pk_bf16_f32 v72, v104, v105
  v_cvt_pk_bf16_f32 v73, v106, v107
  v_cvt_pk_bf16_f32 v74, v108, v109
  v_cvt_pk_bf16_f32 v75, v110, v111
  s_add_u32 s20, s30, 286720
  buffer_store_dwordx4 v[72:75], v2, s[8:11], s20 offen sc1
  v_mul_f32 v112, s24, v112
  v_mul_f32 v113, s24, v113
  v_mul_f32 v114, s24, v114
  v_mul_f32 v115, s24, v115
  v_mul_f32 v116, s24, v116
  v_mul_f32 v117, s24, v117
  v_mul_f32 v118, s24, v118
  v_mul_f32 v119, s24, v119
  v_cvt_pk_bf16_f32 v76, v112, v113
  v_cvt_pk_bf16_f32 v77, v114, v115
  v_cvt_pk_bf16_f32 v78, v116, v117
  v_cvt_pk_bf16_f32 v79, v118, v119
  s_add_u32 s20, s30, 344064
  buffer_store_dwordx4 v[76:79], v2, s[8:11], s20 offen sc1
  s_waitcnt vmcnt(0)
  s_barrier
  s_cmp_lg_u32 s16, 0
  s_cbranch_scc1 pub_26
  v_mul_u32_u24 v26, 2048, v1
  v_mov_b32 v24, s88
  v_mov_b32 v25, s89
  s_mov_b64 exec, 1
  buffer_store_dwordx2 v[24:25], v26, s[8:11], s28 offen sc1
  s_mov_b64 exec, -1
pub_26:
  v_mov_b32 v6, 160000
  s_add_u32 s101, s101, 1
  s_barrier
  s_mov_b64 exec, 1
  s_cmp_lg_u32 s16, 0
  s_cbranch_scc1 w0_27
  ds_write_b32 v6, v250 offset:0
  s_waitcnt lgkmcnt(0)
  v_mov_b32 v250, s101
  ds_write_b32 v6, v250 offset:16
  s_waitcnt lgkmcnt(0)
w0_27:
  s_mov_b64 exec, -1
  s_barrier
  ds_read_b32 v250, v6 offset:0
  ds_read_b32 v6, v6 offset:16
  s_waitcnt lgkmcnt(0)
  v_readfirstlane_b32 s3, v250
  v_cmp_ne_u32 vcc, s101, v6
  s_cbranch_vccnz ch_end
  s_branch wk_have
wk_loop:
  s_waitcnt vmcnt(0) lgkmcnt(0)
  s_cmp_eq_u32 s96, 1
  s_cbranch_scc1 wk_ask
  s_mov_b32 s96, 1
  s_cmp_lg_u32 s16, 0
  s_cbranch_scc1 w0_28
  s_mov_b32 s30, 0
  v_mov_b32 v243, 32
sf_l:
  buffer_load_dword v242, v243, s[12:15], 0 offen sc1
  s_waitcnt vmcnt(0)
  v_readfirstlane_b32 s70, v242
  s_cmp_eq_u32 s70, -1
  s_cbranch_scc1 sf_d
  s_sleep 16
  s_add_u32 s30, s30, 1
  s_cmp_lt_u32 s30, 64
  s_cbranch_scc1 sf_l
  s_mov_b32 s20, 0
  s_mov_b32 s21, 0
  s_mov_b64 exec, 1
sf_c_l:
  s_cmp_lg_u32 s70, -1
  s_cbranch_scc1 sf_c_t
  s_add_u32 s20, s20, 1
  s_cmp_lt_u32 s20, 8
  s_cselect_b32 s20, s20, 0
  s_mov_b32 s70, 0
  s_mov_b32 s3, -1
  s_add_u32 s21, s21, 1
  s_cmp_ge_u32 s21, 1
  s_cbranch_scc1 sf_c_d
sf_c_t:
  s_ff0_i32_b32 s22, s70
  s_lshl_b32 s23, 1, s22
  s_and_b32 s71, s20, 4
  s_mul_i32 s71, s71, 12
  s_lshl_b32 s3, s20, 2
  s_add_u32 s3, s3, s71
  v_mov_b32 v242, s23
  v_mov_b32 v243, 32
  buffer_atomic_or v242, v243, s[12:15], s3 offen sc0
  s_waitcnt vmcnt(0)
  v_readfirstlane_b32 s70, v242
  s_lshl_b32 s3, s20, 5
  s_add_u32 s3, s3, s22
  s_bitcmp1_b32 s70, s22
  s_cbranch_scc1 sf_c_l
sf_c_d:
  s_mov_b64 exec, -1
  v_mov_b32 v242, s3
sf_d:
w0_28:
  v_mov_b32 v243, 160000
  s_add_u32 s101, s101, 1
  s_barrier
  s_mov_b64 exec, 1
  s_cmp_lg_u32 s16, 0
  s_cbranch_scc1 w0_29
  ds_write_b32 v243, v242 offset:0
  s_waitcnt lgkmcnt(0)
  v_mov_b32 v242, s101
  ds_write_b32 v243, v242 offset:16
  s_waitcnt lgkmcnt(0)
w0_29:
  s_mov_b64 exec, -1
  s_barrier
  ds_read_b32 v242, v243 offset:0
  ds_read_b32 v243, v243 offset:16
  s_waitcnt lgkmcnt(0)
  v_readfirstlane_b32 s3, v242
  v_cmp_ne_u32 vcc, s101, v243
  s_cbranch_vccnz ch_end
  s_cmp_eq_u32 s3, -1
  s_cbranch_scc1 wk_ask
  s_load_dwordx8 s[36:43], s[0:1], 56
  s_load_dwordx4 s[44:47], s[0:1], 88
  s_getreg_b32 s67, hwreg(HW_REG_XCC_ID)
  s_and_b32 s67, s67, 7
  s_mov_b32 s66, 1
  s_waitcnt lgkmcnt(0)
  s_branch m_start
wk_ask:
  v_readfirstlane_b32 s22, v250
  s_cmp_ge_u32 s22, 1376
  s_cbranch_scc1 wk_next
  s_cmp_lg_u32 s16, 0
  s_cbranch_scc1 w0_30
  v_mov_b32 v250, 1
  v_mov_b32 v251, 192
  s_mov_b64 exec, 1
  buffer_atomic_add v250, v251, s[12:15], 0 offen sc0
  s_mov_b64 exec, -1
w0_30:
wk_next:
  s_waitcnt vmcnt(0)
  v_mov_b32 v6, 160000
  s_add_u32 s101, s101, 1
  s_barrier
  s_mov_b64 exec, 1
  s_cmp_lg_u32 s16, 0
  s_cbranch_scc1 w0_31
  ds_write_b32 v6, v250 offset:0
  s_waitcnt lgkmcnt(0)
  v_mov_b32 v250, s101
  ds_write_b32 v6, v250 offset:16
  s_waitcnt lgkmcnt(0)
w0_31:
  s_mov_b64 exec, -1
  s_barrier
  ds_read_b32 v250, v6 offset:0
  ds_read_b32 v6, v6 offset:16
  s_waitcnt lgkmcnt(0)
  v_readfirstlane_b32 s3, v250
  v_cmp_ne_u32 vcc, s101, v6
  s_cbranch_vccnz ch_end
wk_have:
  s_cmp_ge_u32 s3, 1376
  s_cbranch_scc1 ch_end
  v_mov_b32 v250, 0
  v_mov_b32 v251, 192
  v_and_b32 v1, 63, v0
  v_lshlrev_b32 v2, 4, v1
  v_lshrrev_b32 v3, 4, v1
  v_and_b32 v4, 15, v1
  s_cmp_lg_u32 s97, 0
  s_cbranch_scc1 wk_go
  s_mov_b32 s68, s3
  s_mov_b32 s69, 1
  s_cmp_lg_u32 s16, 0
  s_cbranch_scc1 w0_32
  s_add_u32 s20, s67, 1
  s_lshl_b32 s22, s20, 11
  s_add_u32 s22, s22, 88590336
  v_add_u32 v24, 1024, v2
  v_min_u32 v24, 1776, v24
  s_mov_b32 s30, 0
wk_af:
  buffer_load_dwordx4 v[28:31], v2, s[8:11], s22 offen sc1
  buffer_load_dwordx4 v[32:35], v24, s[8:11], s22 offen sc1
  s_waitcnt vmcnt(0)
  v_cmp_ne_u64 vcc, s[88:89], v[28:29]
  s_cbranch_vccnz wk_af_no
  v_cmp_ne_u64 vcc, s[88:89], v[30:31]
  s_cbranch_vccnz wk_af_no
  v_cmp_ne_u64 vcc, s[88:89], v[32:33]
  s_cbranch_vccnz wk_af_no
  v_cmp_ne_u64 vcc, s[88:89], v[34:35]
  s_cbranch_vccnz wk_af_no
  s_branch wk_af_ok
wk_af_no:
  s_sleep 4
  s_add_u32 s30, s30, 1
  s_and_b32 s20, s30, 63
  s_cbranch_scc1 wk_ns
  s_mov_b32 s20, 1
  s_mov_b32 s70, 0
  s_mov_b32 s21, 0
  s_mov_b64 exec, 1
wk_st_l:
  s_cmp_lg_u32 s70, -1
  s_cbranch_scc1 wk_st_t
  s_add_u32 s20, s20, 1
  s_cmp_lt_u32 s20, 8
  s_cselect_b32 s20, s20, 1
  s_mov_b32 s70, 0
  s_mov_b32 s3, -1
  s_add_u32 s21, s21, 1
  s_cmp_ge_u32 s21, 7
  s_cbranch_scc1 wk_st_d
wk_st_t:
  s_ff0_i32_b32 s22, s70
  s_lshl_b32 s23, 1, s22
  s_and_b32 s71, s20, 4
  s_mul_i32 s71, s71, 12
  s_lshl_b32 s3, s20, 2
  s_add_u32 s3, s3, s71
  v_mov_b32 v242, s23
  v_mov_b32 v243, 32
  buffer_atomic_or v242, v243, s[12:15], s3 offen sc0
  s_waitcnt vmcnt(0)
  v_readfirstlane_b32 s70, v242
  s_lshl_b32 s3, s20, 5
  s_add_u32 s3, s3, s22
  s_bitcmp1_b32 s70, s22
  s_cbranch_scc1 wk_st_l
wk_st_d:
  s_mov_b64 exec, -1
  v_mov_b32 v242, s3
  s_cmp_lg_u32 s3, -1
  s_cbranch_scc1 wk_pd
  s_add_u32 s20, s67, 1
  s_lshl_b32 s22, s20, 11
  s_add_u32 s22, s22, 88590336
wk_ns:
  s_cmp_lt_u32 s30, 50000
  s_cbranch_scc1 wk_af
  s_branch cA_abort
wk_af_ok:
  v_mov_b32 v242, -1
wk_pd:
w0_32:
  v_mov_b32 v243, 160000
  s_add_u32 s101, s101, 1
  s_barrier
  s_mov_b64 exec, 1
  s_cmp_lg_u32 s16, 0
  s_cbranch_scc1 w0_33
  ds_write_b32 v243, v242 offset:0
  s_waitcnt lgkmcnt(0)
  v_mov_b32 v242, s101
  ds_write_b32 v243, v242 offset:16
  s_waitcnt lgkmcnt(0)
w0_33:
  s_mov_b64 exec, -1
  s_barrier
  ds_read_b32 v242, v243 offset:0
  ds_read_b32 v243, v243 offset:16
  s_waitcnt lgkmcnt(0)
  v_readfirstlane_b32 s3, v242
  v_cmp_ne_u32 vcc, s101, v243
  s_cbranch_vccnz ch_end
  s_cmp_lg_u32 s3, -1
  s_cbranch_scc1 m_bjob
  s_mov_b32 s3, s68
  s_mov_b32 s97, 1
wk_go:
  s_cmp_lt_u32 s3, 368
  s_cbranch_scc1 wk_g2
  s_sub_u32 s20, s3, 432
  s_cmp_lt_u32 s20, 128
  s_cbranch_scc1 wk_g2
  s_cmp_eq_u32 s97, 2
  s_cbranch_scc1 wk_g2
  s_getreg_b32 s20, hwreg(HW_REG_XCC_ID)
  s_and_b32 s20, s20, 7
  s_cmp_lg_u32 s16, 0
  s_cbranch_scc1 w0_34
  s_lshl_b32 s22, s20, 11
  s_add_u32 s22, s22, 88625152
  v_add_u32 v24, 1024, v2
  v_min_u32 v24, 1776, v24
  s_mov_b32 s30, 0
wk_i2:
  buffer_load_dwordx4 v[28:31], v2, s[8:11], s22 offen sc1
  buffer_load_dwordx4 v[32:35], v24, s[8:11], s22 offen sc1
  s_waitcnt vmcnt(0)
  v_cmp_ne_u64 vcc, s[88:89], v[28:29]
  s_cbranch_vccnz wk_i2_no
  v_cmp_ne_u64 vcc, s[88:89], v[30:31]
  s_cbranch_vccnz wk_i2_no
  v_cmp_ne_u64 vcc, s[88:89], v[32:33]
  s_cbranch_vccnz wk_i2_no
  v_cmp_ne_u64 vcc, s[88:89], v[34:35]
  s_cbranch_vccnz wk_i2_no
  s_branch wk_i2_ok
wk_i2_no:
  s_sleep 4
  s_add_u32 s30, s30, 1
  s_cmp_lt_u32 s30, 50000
  s_cbranch_scc1 wk_i2
  s_branch cA_abort
wk_i2_ok:
w0_34:
  v_mov_b32 v242, 0
  v_mov_b32 v243, 160000
  s_add_u32 s101, s101, 1
  s_barrier
  s_mov_b64 exec, 1
  s_cmp_lg_u32 s16, 0
  s_cbranch_scc1 w0_35
  ds_write_b32 v243, v242 offset:0
  s_waitcnt lgkmcnt(0)
  v_mov_b32 v242, s101
  ds_write_b32 v243, v242 offset:16
  s_waitcnt lgkmcnt(0)
w0_35:
  s_mov_b64 exec, -1
  s_barrier
  ds_read_b32 v242, v243 offset:0
  ds_read_b32 v243, v243 offset:16
  s_waitcnt lgkmcnt(0)
  v_readfirstlane_b32 s20, v242
  v_cmp_ne_u32 vcc, s101, v243
  s_cbranch_vccnz ch_end
  s_mov_b32 s97, 2
wk_g2:
  s_cmp_ge_u32 s3, 864
  s_cbranch_scc1 wk_tok
  s_cmp_ge_u32 s3, 752
  s_cbranch_scc1 wk_s4d
  s_cmp_ge_u32 s3, 624
  s_cbranch_scc1 wk_f
  s_cmp_ge_u32 s3, 560
  s_cbranch_scc1 wk_vf
  s_cmp_ge_u32 s3, 432
  s_cbranch_scc1 wk_a
  s_cmp_ge_u32 s3, 368
  s_cbranch_scc1 wk_vh
  s_cmp_ge_u32 s3, 256
  s_cbranch_scc1 wk_v7
  s_cmp_ge_u32 s3, 224
  s_cbranch_scc1 wk_srv
  s_sub_u32 s20, s3, 0
  s_cmp_ge_u32 s20, 112
  s_cselect_b32 s18, 1, 0
  s_cselect_b32 s21, 112, 0
  s_sub_u32 s20, s20, s21
  s_and_b32 s17, s20, 15
  s_add_u32 s17, s17, 16
  s_lshr_b32 s34, s20, 4
  s_lshl_b32 s34, s34, 1
  s_add_u32 s35, s34, 2
  s_cmp_eq_u32 s18, 0
  s_cbranch_scc1 wf_nw
  s_and_b32 s20, s3, 3
  s_lshl_b32 s20, s20, 3
  s_add_u32 s20, s20, 8
  s_cmp_eq_u32 s16, 0
  s_cselect_b32 s20, 0, s20
  s_cmp_ge_u32 s16, 2
  s_cselect_b32 s20, 112, s20
  s_load_dwordx2 s[72:73], s[0:1], s20
  s_lshr_b32 s21, s3, 2
  s_lshl_b32 s21, s21, 12
  s_mov_b32 s74, 229376
  s_lshl_b32 s22, s3, 13
  s_cmp_eq_u32 s16, 0
  s_cselect_b32 s21, s22, s21
  s_cselect_b32 s74, 1835008, s74
  s_lshl_b32 s22, s3, 1
  s_add_u32 s22, s22, s16
  s_sub_u32 s22, s22, 2
  s_lshl_b32 s22, s22, 13
  s_cmp_ge_u32 s16, 2
  s_cselect_b32 s21, s22, s21
  s_cselect_b32 s74, 3670016, s74
  v_lshlrev_b32 v6, 3, v2
  s_cmp_eq_u32 s16, 1
  s_cselect_b32 exec_hi, 0, -1
  s_waitcnt lgkmcnt(0)
  s_and_b32 s73, s73, 0xffff
  s_mov_b32 s75, 0x20000
  buffer_load_dword v7, v6, s[72:75], s21 offen
  s_mov_b64 exec, -1
  s_sub_u32 s3, s3, 112
  s_and_b32 s20, s3, 3
  s_lshl_b32 s20, s20, 3
  s_add_u32 s20, s20, 8
  s_cmp_eq_u32 s16, 0
  s_cselect_b32 s20, 0, s20
  s_cmp_ge_u32 s16, 2
  s_cselect_b32 s20, 112, s20
  s_load_dwordx2 s[72:73], s[0:1], s20
  s_lshr_b32 s21, s3, 2
  s_lshl_b32 s21, s21, 12
  s_mov_b32 s74, 229376
  s_lshl_b32 s22, s3, 13
  s_cmp_eq_u32 s16, 0
  s_cselect_b32 s21, s22, s21
  s_cselect_b32 s74, 1835008, s74
  s_lshl_b32 s22, s3, 1
  s_add_u32 s22, s22, s16
  s_sub_u32 s22, s22, 2
  s_lshl_b32 s22, s22, 13
  s_cmp_ge_u32 s16, 2
  s_cselect_b32 s21, s22, s21
  s_cselect_b32 s74, 3670016, s74
  v_lshlrev_b32 v6, 3, v2
  s_cmp_eq_u32 s16, 1
  s_cselect_b32 exec_hi, 0, -1
  s_waitcnt lgkmcnt(0)
  s_and_b32 s73, s73, 0xffff
  s_mov_b32 s75, 0x20000
  buffer_load_dword v7, v6, s[72:75], s21 offen
  s_mov_b64 exec, -1
  s_add_u32 s3, s3, 112
wf_nw:
  s_lshl_b32 s20, s18, 3
  s_lshl_b32 s21, s16, 1
  s_add_u32 s20, s20, s21
  s_mul_i32 s21, s20, 14336
  s_add_u32 s21, s21, 71565312
  s_add_u32 s22, s21, 0
  buffer_load_dwordx4 a[0:3], v2, s[8:11], s22 offen offset:0 sc1
  buffer_load_dwordx4 a[4:7], v2, s[8:11], s22 offen offset:1024 sc1
  buffer_load_dwordx4 a[8:11], v2, s[8:11], s22 offen offset:2048 sc1
  buffer_load_dwordx4 a[12:15], v2, s[8:11], s22 offen offset:3072 sc1
  s_add_u32 s22, s21, 4096
  buffer_load_dwordx4 a[16:19], v2, s[8:11], s22 offen offset:0 sc1
  buffer_load_dwordx4 a[20:23], v2, s[8:11], s22 offen offset:1024 sc1
  buffer_load_dwordx4 a[24:27], v2, s[8:11], s22 offen offset:2048 sc1
  buffer_load_dwordx4 a[28:31], v2, s[8:11], s22 offen offset:3072 sc1
  s_add_u32 s22, s21, 8192
  buffer_load_dwordx4 a[32:35], v2, s[8:11], s22 offen offset:0 sc1
  buffer_load_dwordx4 a[36:39], v2, s[8:11], s22 offen offset:1024 sc1
  buffer_load_dwordx4 a[40:43], v2, s[8:11], s22 offen offset:2048 sc1
  buffer_load_dwordx4 a[44:47], v2, s[8:11], s22 offen offset:3072 sc1
  s_add_u32 s22, s21, 12288
  buffer_load_dwordx4 a[48:51], v2, s[8:11], s22 offen offset:0 sc1
  buffer_load_dwordx4 a[52:55], v2, s[8:11], s22 offen offset:1024 sc1
  buffer_load_dwordx4 a[56:59], v2, s[8:11], s22 offen offset:2048 sc1
  buffer_load_dwordx4 a[60:63], v2, s[8:11], s22 offen offset:3072 sc1
  s_add_u32 s22, s21, 16384
  buffer_load_dwordx4 a[64:67], v2, s[8:11], s22 offen offset:0 sc1
  buffer_load_dwordx4 a[68:71], v2, s[8:11], s22 offen offset:1024 sc1
  buffer_load_dwordx4 a[72:75], v2, s[8:11], s22 offen offset:2048 sc1
  buffer_load_dwordx4 a[76:79], v2, s[8:11], s22 offen offset:3072 sc1
  s_add_u32 s22, s21, 20480
  buffer_load_dwordx4 a[80:83], v2, s[8:11], s22 offen offset:0 sc1
  buffer_load_dwordx4 a[84:87], v2, s[8:11], s22 offen offset:1024 sc1
  buffer_load_dwordx4 a[88:91], v2, s[8:11], s22 offen offset:2048 sc1
  buffer_load_dwordx4 a[92:95], v2, s[8:11], s22 offen offset:3072 sc1
  s_add_u32 s22, s21, 24576
  buffer_load_dwordx4 a[96:99], v2, s[8:11], s22 offen offset:0 sc1
  buffer_load_dwordx4 a[100:103], v2, s[8:11], s22 offen offset:1024 sc1
  buffer_load_dwordx4 a[104:107], v2, s[8:11], s22 offen offset:2048 sc1
  buffer_load_dwordx4 a[108:111], v2, s[8:11], s22 offen offset:3072 sc1
  s_waitcnt vmcnt(40)
  s_mul_i32 s23, s17, 401408
  s_and_b32 s22, s16, 1
  s_mul_i32 s22, s22, 7168
  s_add_u32 s23, s23, s22
  s_add_u32 s23, s23, 0
  s_lshr_b32 s22, s16, 1
  s_mul_i32 s22, s22, 14336
  s_add_u32 s23, s23, s22
  s_mul_i32 s27, s16, 7168
  s_lshr_b32 s28, s20, 1
wf_vo:
  s_sub_u32 s29, s17, 16
  s_lshl_b32 s29, s29, 6
  s_add_u32 s29, s29, s28
  s_mul_i32 s29, s29, 28672
  s_add_u32 s29, s29, 42205184
  v_mul_u32_u24 v6, 28, v3
  s_mov_b32 s31, 0
  s_lshl_b32 s24, s34, 1
  s_mul_i32 s24, s24, 14336
  s_add_u32 s24, s24, s23
  s_cmp_lt_u32 s34, s35
  s_cselect_b32 s24, s24, 0x10000000
  s_add_u32 m0, s31, s27
  s_nop 0
  buffer_load_dwordx4 v2, s[8:11], s24 offen offset:0 sc1 lds
  buffer_load_dwordx4 v2, s[8:11], s24 offen offset:1024 sc1 lds
  buffer_load_dwordx4 v2, s[8:11], s24 offen offset:2048 sc1 lds
  buffer_load_dwordx4 v2, s[8:11], s24 offen offset:3072 sc1 lds
  s_add_u32 m0, m0, 4096
  s_add_u32 s24, s24, 4096
  buffer_load_dwordx4 v2, s[8:11], s24 offen offset:0 sc1 lds
  buffer_load_dwordx4 v2, s[8:11], s24 offen offset:1024 sc1 lds
  buffer_load_dwordx4 v2, s[8:11], s24 offen offset:2048 sc1 lds
  s_add_u32 s30, s34, 1
  s_mov_b32 s31, 28672
  s_lshl_b32 s24, s30, 1
  s_mul_i32 s24, s24, 14336
  s_add_u32 s24, s24, s23
  s_cmp_lt_u32 s30, s35
  s_cselect_b32 s24, s24, 0x10000000
  s_add_u32 m0, s31, s27
  s_nop 0
  buffer_load_dwordx4 v2, s[8:11], s24 offen offset:0 sc1 lds
  buffer_load_dwordx4 v2, s[8:11], s24 offen offset:1024 sc1 lds
  buffer_load_dwordx4 v2, s[8:11], s24 offen offset:2048 sc1 lds
  buffer_load_dwordx4 v2, s[8:11], s24 offen offset:3072 sc1 lds
  s_add_u32 m0, m0, 4096
  s_add_u32 s24, s24, 4096
  buffer_load_dwordx4 v2, s[8:11], s24 offen offset:0 sc1 lds
  buffer_load_dwordx4 v2, s[8:11], s24 offen offset:1024 sc1 lds
  buffer_load_dwordx4 v2, s[8:11], s24 offen offset:2048 sc1 lds
  s_mov_b32 s19, s34
  s_mov_b32 s32, 0
  s_mov_b32 s33, 57344
  s_waitcnt vmcnt(7)
  s_branch wf_vo_in
wf_vo_loop:
  s_waitcnt vmcnt(9)
wf_vo_in:
  s_barrier
  s_add_u32 s30, s19, 2
  s_lshl_b32 s24, s30, 1
  s_mul_i32 s24, s24, 14336
  s_add_u32 s24, s24, s23
  s_cmp_lt_u32 s30, s35
  s_cselect_b32 s24, s24, 0x10000000
  s_add_u32 m0, s33, s27
  s_nop 0
  buffer_load_dwordx4 v2, s[8:11], s24 offen offset:0 sc1 lds
  buffer_load_dwordx4 v2, s[8:11], s24 offen offset:1024 sc1 lds
  buffer_load_dwordx4 v2, s[8:11], s24 offen offset:2048 sc1 lds
  buffer_load_dwordx4 v2, s[8:11], s24 offen offset:3072 sc1 lds
  s_add_u32 m0, m0, 4096
  s_add_u32 s24, s24, 4096
  buffer_load_dwordx4 v2, s[8:11], s24 offen offset:0 sc1 lds
  buffer_load_dwordx4 v2, s[8:11], s24 offen offset:1024 sc1 lds
  buffer_load_dwordx4 v2, s[8:11], s24 offen offset:2048 sc1 lds
  v_add_u32 v5, s32, v2
  ds_read_b128 v[8:11], v5 offset:0
  ds_read_b128 v[12:15], v5 offset:14336
  ds_read_b128 v[16:19], v5 offset:1024
  ds_read_b128 v[20:23], v5 offset:15360
  ds_read_b128 v[24:27], v5 offset:2048
  ds_read_b128 v[28:31], v5 offset:16384
  ds_read_b128 v[32:35], v5 offset:3072
  s_waitcnt lgkmcnt(6)
  v_mfma_f32_16x16x32_bf16 v[40:43], a[0:3], v[8:11], 0
  v_mfma_f32_16x16x32_bf16 v[44:47], a[56:59], v[8:11], 0
  ds_read_b128 v[36:39], v5 offset:17408
  s_waitcnt lgkmcnt(6)
  v_mfma_f32_16x16x32_bf16 v[56:59], a[0:3], v[12:15], 0
  v_mfma_f32_16x16x32_bf16 v[60:63], a[56:59], v[12:15], 0
  ds_read_b128 v[8:11], v5 offset:4096
  s_waitcnt lgkmcnt(6)
  v_mfma_f32_16x16x32_bf16 v[40:43], a[4:7], v[16:19], v[40:43]
  v_mfma_f32_16x16x32_bf16 v[44:47], a[60:63], v[16:19], v[44:47]
  ds_read_b128 v[12:15], v5 offset:18432
  s_waitcnt lgkmcnt(6)
  v_mfma_f32_16x16x32_bf16 v[56:59], a[4:7], v[20:23], v[56:59]
  v_mfma_f32_16x16x32_bf16 v[60:63], a[60:63], v[20:23], v[60:63]
  ds_read_b128 v[16:19], v5 offset:5120
  s_waitcnt lgkmcnt(6)
  v_mfma_f32_16x16x32_bf16 v[40:43], a[8:11], v[24:27], v[40:43]
  v_mfma_f32_16x16x32_bf16 v[44:47], a[64:67], v[24:27], v[44:47]
  ds_read_b128 v[20:23], v5 offset:19456
  s_waitcnt lgkmcnt(6)
  v_mfma_f32_16x16x32_bf16 v[56:59], a[8:11], v[28:31], v[56:59]
  v_mfma_f32_16x16x32_bf16 v[60:63], a[64:67], v[28:31], v[60:63]
  ds_read_b128 v[24:27], v5 offset:6144
  s_waitcnt lgkmcnt(6)
  v_mfma_f32_16x16x32_bf16 v[40:43], a[12:15], v[32:35], v[40:43]
  v_mfma_f32_16x16x32_bf16 v[44:47], a[68:71], v[32:35], v[44:47]
  ds_read_b128 v[28:31], v5 offset:20480
  s_waitcnt lgkmcnt(6)
  v_mfma_f32_16x16x32_bf16 v[56:59], a[12:15], v[36:39], v[56:59]
  v_mfma_f32_16x16x32_bf16 v[60:63], a[68:71], v[36:39], v[60:63]
  ds_read_b128 v[32:35], v5 offset:7168
  s_waitcnt lgkmcnt(6)
  v_mfma_f32_16x16x32_bf16 v[40:43], a[16:19], v[8:11], v[40:43]
  v_mfma_f32_16x16x32_bf16 v[44:47], a[72:75], v[8:11], v[44:47]
  ds_read_b128 v[36:39], v5 offset:21504
  s_waitcnt lgkmcnt(6)
  v_mfma_f32_16x16x32_bf16 v[56:59], a[16:19], v[12:15], v[56:59]
  v_mfma_f32_16x16x32_bf16 v[60:63], a[72:75], v[12:15], v[60:63]
  ds_read_b128 v[8:11], v5 offset:8192
  s_waitcnt lgkmcnt(6)
  v_mfma_f32_16x16x32_bf16 v[40:43], a[20:23], v[16:19], v[40:43]
  v_mfma_f32_16x16x32_bf16 v[44:47], a[76:79], v[16:19], v[44:47]
  ds_read_b128 v[12:15], v5 offset:22528
  s_waitcnt lgkmcnt(6)
  v_mfma_f32_16x16x32_bf16 v[56:59], a[20:23], v[20:23], v[56:59]
  v_mfma_f32_16x16x32_bf16 v[60:63], a[76:79], v[20:23], v[60:63]
  ds_read_b128 v[16:19], v5 offset:9216
  s_waitcnt lgkmcnt(6)
  v_mfma_f32_16x16x32_bf16 v[40:43], a[24:27], v[24:27], v[40:43]
  v_mfma_f32_16x16x32_bf16 v[44:47], a[80:83], v[24:27], v[44:47]
  ds_read_b128 v[20:23], v5 offset:23552
  s_waitcnt lgkmcnt(6)
  v_mfma_f32_16x16x32_bf16 v[56:59], a[24:27], v[28:31], v[56:59]
  v_mfma_f32_16x16x32_bf16 v[60:63], a[80:83], v[28:31], v[60:63]
  ds_read_b128 v[24:27], v5 offset:10240
  s_waitcnt lgkmcnt(6)
  v_mfma_f32_16x16x32_bf16 v[40:43], a[28:31], v[32:35], v[40:43]
  v_mfma_f32_16x16x32_bf16 v[44:47], a[84:87], v[32:35], v[44:47]
  ds_read_b128 v[28:31], v5 offset:24576
  s_waitcnt lgkmcnt(6)
  v_mfma_f32_16x16x32_bf16 v[56:59], a[28:31], v[36:39], v[56:59]
  v_mfma_f32_16x16x32_bf16 v[60:63], a[84:87], v[36:39], v[60:63]
  ds_read_b128 v[32:35], v5 offset:11264
  s_waitcnt lgkmcnt(6)
  v_mfma_f32_16x16x32_bf16 v[40:43], a[32:35], v[8:11], v[40:43]
  v_mfma_f32_16x16x32_bf16 v[44:47], a[88:91], v[8:11], v[44:47]
  ds_read_b128 v[36:39], v5 offset:25600
  s_waitcnt lgkmcnt(6)
  v_mfma_f32_16x16x32_bf16 v[56:59], a[32:35], v[12:15], v[56:59]
  v_mfma_f32_16x16x32_bf16 v[60:63], a[88:91], v[12:15], v[60:63]
  ds_read_b128 v[8:11], v5 offset:12288
  s_waitcnt lgkmcnt(6)
  v_mfma_f32_16x16x32_bf16 v[40:43], a[36:39], v[16:19], v[40:43]
  v_mfma_f32_16x16x32_bf16 v[44:47], a[92:95], v[16:19], v[44:47]
  ds_read_b128 v[12:15], v5 offset:26624
  s_waitcnt lgkmcnt(6)
  v_mfma_f32_16x16x32_bf16 v[56:59], a[36:39], v[20:23], v[56:59]
  v_mfma_f32_16x16x32_bf16 v[60:63], a[92:95], v[20:23], v[60:63]
  ds_read_b128 v[16:19], v5 offset:13312
  s_waitcnt lgkmcnt(6)
  v_mfma_f32_16x16x32_bf16 v[40:43], a[40:43], v[24:27], v[40:43]
  v_mfma_f32_16x16x32_bf16 v[44:47], a[96:99], v[24:27], v[44:47]
  ds_read_b128 v[20:23], v5 offset:27648
  s_waitcnt lgkmcnt(6)
  v_mfma_f32_16x16x32_bf16 v[56:59], a[40:43], v[28:31], v[56:59]
  v_mfma_f32_16x16x32_bf16 v[60:63], a[96:99], v[28:31], v[60:63]
  s_waitcnt lgkmcnt(5)
  v_mfma_f32_16x16x32_bf16 v[40:43], a[44:47], v[32:35], v[40:43]
  v_mfma_f32_16x16x32_bf16 v[44:47], a[100:103], v[32:35], v[44:47]
  s_waitcnt lgkmcnt(4)
  v_mfma_f32_16x16x32_bf16 v[56:59], a[44:47], v[36:39], v[56:59]
  v_mfma_f32_16x16x32_bf16 v[60:63], a[100:103], v[36:39], v[60:63]
  s_waitcnt lgkmcnt(3)
  v_mfma_f32_16x16x32_bf16 v[40:43], a[48:51], v[8:11], v[40:43]
  v_mfma_f32_16x16x32_bf16 v[44:47], a[104:107], v[8:11], v[44:47]
  s_waitcnt lgkmcnt(2)
  v_mfma_f32_16x16x32_bf16 v[56:59], a[48:51], v[12:15], v[56:59]
  v_mfma_f32_16x16x32_bf16 v[60:63], a[104:107], v[12:15], v[60:63]
  s_waitcnt lgkmcnt(1)
  v_mfma_f32_16x16x32_bf16 v[40:43], a[52:55], v[16:19], v[40:43]
  v_mfma_f32_16x16x32_bf16 v[44:47], a[108:111], v[16:19], v[44:47]
  s_waitcnt lgkmcnt(0)
  v_mfma_f32_16x16x32_bf16 v[56:59], a[52:55], v[20:23], v[56:59]
  v_mfma_f32_16x16x32_bf16 v[60:63], a[108:111], v[20:23], v[60:63]
  s_add_u32 s25, s29, 28672
  s_lshl_b32 s24, s19, 5
  s_add_u32 s24, s24, 0
  v_add_u32 v88, s24, v4
  v_mul_u32_u24 v89, 2341, v88
  v_lshrrev_b32 v89, 16, v89
  v_mul_u32_u24 v89, 84, v89
  v_add3_u32 v88, v88, v89, v6
  v_lshlrev_b32 v90, 4, v88
  v_cvt_pk_bf16_f32 v72, v40, v41
  v_cvt_pk_bf16_f32 v73, v42, v43
  v_cvt_pk_bf16_f32 v74, v44, v45
  v_cvt_pk_bf16_f32 v75, v46, v47
  buffer_store_dwordx4 v[72:75], v90, s[8:11], s29 offen sc1
  s_lshl_b32 s24, s19, 5
  s_add_u32 s24, s24, 16
  v_add_u32 v88, s24, v4
  v_mul_u32_u24 v89, 2341, v88
  v_lshrrev_b32 v89, 16, v89
  v_mul_u32_u24 v89, 84, v89
  v_add3_u32 v88, v88, v89, v6
  v_lshlrev_b32 v91, 4, v88
  v_cvt_pk_bf16_f32 v80, v56, v57
  v_cvt_pk_bf16_f32 v81, v58, v59
  v_cvt_pk_bf16_f32 v82, v60, v61
  v_cvt_pk_bf16_f32 v83, v62, v63
  buffer_store_dwordx4 v[80:83], v91, s[8:11], s29 offen sc1
  s_mov_b32 s33, s32
  s_add_u32 s32, s32, 28672
  s_cmp_eq_u32 s32, 86016
  s_cselect_b32 s32, 0, s32
  s_add_u32 s19, s19, 1
  s_cmp_lt_u32 s19, s35
  s_cbranch_scc1 wf_vo_loop
  s_branch wf_done
wf_done:
  s_lshr_b32 s20, s18, 1
  s_lshl_b32 s20, s20, 4
  s_and_b32 s21, s17, 15
  s_add_u32 s20, s20, s21
  s_lshl_b32 s20, s20, 7
  s_cmp_lt_u32 s17, 16
  s_cselect_b32 s21, 16384, 0
  s_add_u32 s20, s20, s21
  s_add_u32 s20, s20, 88528896
  s_sub_u32 s21, s35, s34
  s_lshr_b32 s21, s21, 1
  v_mov_b32 v5, s21
  v_mov_b32 v6, 0
  s_waitcnt vmcnt(0)
  s_mov_b64 exec, 1
  s_cmp_lg_u32 s18, 0
  s_cbranch_scc1 wf_h1
  v_mov_b32 v7, 2
  s_sub_u32 s21, s20, 2048
  buffer_atomic_add v7, v6, s[8:11], s21 offen
wf_h1:
  buffer_atomic_add v5, v6, s[8:11], s20 offen
  s_mov_b64 exec, -1
  s_load_dwordx8 s[36:43], s[0:1], 56
  s_load_dwordx4 s[44:47], s[0:1], 88
  s_waitcnt lgkmcnt(0)
  s_mov_b32 s52, s36
  s_and_b32 s53, s37, 0xffff
  s_mov_b32 s54, 1835008
  s_mov_b32 s55, 0x20000
  s_lshl_b32 s20, s3, 8
  v_add_u32 v95, s20, v0
  s_mov_b32 s21, 9586981
  v_mul_hi_u32 v6, v95, s21
  v_mul_u32_u24 v7, 448, v6
  v_sub_u32 v7, v95, v7
  v_lshrrev_b32 v8, 4, v7
  v_and_b32 v7, 15, v7
  v_lshl_add_u32 v9, v6, 4, v7
  v_mul_u32_u24 v9, 896, v9
  v_lshl_add_u32 v9, v8, 5, v9
  buffer_load_dwordx4 v[84:87], v9, s[52:55], 0 offen
  buffer_load_dwordx4 v[88:91], v9, s[52:55], 0 offen offset:16
  v_mul_u32_u24 v6, 14336, v6
  v_lshl_add_u32 v6, v7, 4, v6
  v_lshl_add_u32 v92, v8, 9, v6
  v_lshrrev_b32 v7, 2, v8
  v_lshl_add_u32 v6, v7, 11, v6
  v_and_b32 v7, 3, v8
  v_lshl_add_u32 v93, v7, 8, v6
  v_mov_b32 v52, -1
  v_mov_b32 v53, -1
  v_mov_b32 v54, -1
  v_mov_b32 v55, -1
  s_mov_b32 s23, 75747328
  v_lshlrev_b32 v8, 4, v95
  buffer_store_dwordx4 v[52:55], v8, s[8:11], s23 offen sc1
  v_add_u32 v8, 917504, v8
  v_mov_b32 v9, 0x10000000
  v_cmp_lt_u32 vcc, 16255, v95
  s_nop 1
  v_cndmask_b32 v8, v8, v9, vcc
  buffer_store_dwordx4 v[52:55], v8, s[8:11], s23 offen sc1
  s_waitcnt vmcnt(1)
  v_mov_b32 v96, v84
  v_mov_b32 v100, v85
  v_mov_b32 v97, v86
  v_mov_b32 v101, v87
  v_mov_b32 v98, v88
  v_mov_b32 v102, v89
  v_mov_b32 v99, v90
  v_mov_b32 v103, v91
  s_mov_b32 s20, 71565312
  s_mov_b32 s21, 73400320
  buffer_store_dwordx4 v[96:99], v93, s[8:11], s21 offen sc1
  buffer_store_dwordx4 v[100:103], v93, s[8:11], s21 offen offset:1024 sc1
  s_cmp_lt_u32 s3, 70
  s_cbranch_scc1 i2_nx
  buffer_store_dwordx4 v[84:87], v92, s[8:11], s20 offen sc1
  buffer_store_dwordx4 v[88:91], v92, s[8:11], s20 offen offset:256 sc1
i2_nx:
  s_lshl_b32 s20, s3, 3
  s_add_u32 s20, s20, 88625152
  s_waitcnt vmcnt(0)
  s_barrier
  s_cmp_lg_u32 s16, 0
  s_cbranch_scc1 pub_36
  v_mul_u32_u24 v26, 2048, v1
  v_mov_b32 v24, s88
  v_mov_b32 v25, s89
  s_mov_b64 exec, 255
  buffer_store_dwordx2 v[24:25], v26, s[8:11], s20 offen sc1
  s_mov_b64 exec, -1
pub_36:
  s_branch wk_loop
wk_v7:
  s_sub_u32 s20, s3, 256
  s_mov_b32 s18, 1
  s_and_b32 s17, s20, 15
  s_add_u32 s17, s17, 16
  s_lshr_b32 s34, s20, 4
  s_lshl_b32 s34, s34, 1
  s_add_u32 s35, s34, 2
  s_branch wk_gemm
wk_vh:
  s_sub_u32 s20, s3, 368
  s_and_b32 s17, s20, 15
  s_add_u32 s17, s17, 16
  s_lshr_b32 s18, s20, 5
  s_add_u32 s18, s18, 2
  s_bitcmp1_b32 s20, 4
  s_cselect_b32 s34, 7, 0
  s_add_u32 s35, s34, 7
  s_branch wk_gemm
wk_vf:
  s_sub_u32 s20, s3, 560
  s_and_b32 s17, s20, 15
  s_add_u32 s17, s17, 16
  s_lshr_b32 s18, s20, 4
  s_add_u32 s18, s18, 4
  s_mov_b32 s34, 0
  s_mov_b32 s35, 14
  s_branch wk_gemm
wk_f:
  s_sub_u32 s20, s3, 624
  s_and_b32 s17, s20, 15
  s_lshr_b32 s18, s20, 4
  s_mov_b32 s34, 0
  s_mov_b32 s35, 14
  s_lshl_b32 s22, s17, 7
  s_add_u32 s22, s22, 88621056
  s_add_u32 s23, s22, 2048
  v_min_u32 v24, 48, v2
  v_min_u32 v25, 96, v2
  s_mov_b32 s30, 0
wk_aw:
  buffer_load_dwordx4 v[28:31], v24, s[8:11], s22 offen sc1
  buffer_load_dwordx4 v[32:35], v25, s[8:11], s23 offen sc1
  s_waitcnt vmcnt(0)
  v_cmp_ne_u64 vcc, s[88:89], v[28:29]
  s_cbranch_vccnz wk_aw_no
  v_cmp_ne_u64 vcc, s[88:89], v[30:31]
  s_cbranch_vccnz wk_aw_no
  v_cmp_ne_u64 vcc, s[88:89], v[32:33]
  s_cbranch_vccnz wk_aw_no
  v_cmp_ne_u64 vcc, s[88:89], v[34:35]
  s_cbranch_vccnz wk_aw_no
  s_branch wk_aw_ok
wk_aw_no:
  s_sleep 6
  s_add_u32 s30, s30, 1
  s_cmp_lt_u32 s30, 50000
  s_cbranch_scc1 wk_aw
  s_branch cA_abort
wk_aw_ok:
wk_gemm:
  s_lshl_b32 s20, s18, 4
  s_lshl_b32 s21, s16, 2
  s_add_u32 s20, s20, s21
  s_mul_i32 s21, s20, 14336
  s_add_u32 s21, s21, 71565312
  s_add_u32 s22, s21, 0
  buffer_load_dwordx4 a[0:3], v2, s[8:11], s22 offen offset:0 sc1
  buffer_load_dwordx4 a[4:7], v2, s[8:11], s22 offen offset:1024 sc1
  buffer_load_dwordx4 a[8:11], v2, s[8:11], s22 offen offset:2048 sc1
  buffer_load_dwordx4 a[12:15], v2, s[8:11], s22 offen offset:3072 sc1
  s_add_u32 s22, s21, 4096
  buffer_load_dwordx4 a[16:19], v2, s[8:11], s22 offen offset:0 sc1
  buffer_load_dwordx4 a[20:23], v2, s[8:11], s22 offen offset:1024 sc1
  buffer_load_dwordx4 a[24:27], v2, s[8:11], s22 offen offset:2048 sc1
  buffer_load_dwordx4 a[28:31], v2, s[8:11], s22 offen offset:3072 sc1
  s_add_u32 s22, s21, 8192
  buffer_load_dwordx4 a[32:35], v2, s[8:11], s22 offen offset:0 sc1
  buffer_load_dwordx4 a[36:39], v2, s[8:11], s22 offen offset:1024 sc1
  buffer_load_dwordx4 a[40:43], v2, s[8:11], s22 offen offset:2048 sc1
  buffer_load_dwordx4 a[44:47], v2, s[8:11], s22 offen offset:3072 sc1
  s_add_u32 s22, s21, 12288
  buffer_load_dwordx4 a[48:51], v2, s[8:11], s22 offen offset:0 sc1
  buffer_load_dwordx4 a[52:55], v2, s[8:11], s22 offen offset:1024 sc1
  buffer_load_dwordx4 a[56:59], v2, s[8:11], s22 offen offset:2048 sc1
  buffer_load_dwordx4 a[60:63], v2, s[8:11], s22 offen offset:3072 sc1
  s_add_u32 s22, s21, 16384
  buffer_load_dwordx4 a[64:67], v2, s[8:11], s22 offen offset:0 sc1
  buffer_load_dwordx4 a[68:71], v2, s[8:11], s22 offen offset:1024 sc1
  buffer_load_dwordx4 a[72:75], v2, s[8:11], s22 offen offset:2048 sc1
  buffer_load_dwordx4 a[76:79], v2, s[8:11], s22 offen offset:3072 sc1
  s_add_u32 s22, s21, 20480
  buffer_load_dwordx4 a[80:83], v2, s[8:11], s22 offen offset:0 sc1
  buffer_load_dwordx4 a[84:87], v2, s[8:11], s22 offen offset:1024 sc1
  buffer_load_dwordx4 a[88:91], v2, s[8:11], s22 offen offset:2048 sc1
  buffer_load_dwordx4 a[92:95], v2, s[8:11], s22 offen offset:3072 sc1
  s_add_u32 s22, s21, 24576
  buffer_load_dwordx4 a[96:99], v2, s[8:11], s22 offen offset:0 sc1
  buffer_load_dwordx4 a[100:103], v2, s[8:11], s22 offen offset:1024 sc1
  buffer_load_dwordx4 a[104:107], v2, s[8:11], s22 offen offset:2048 sc1
  buffer_load_dwordx4 a[108:111], v2, s[8:11], s22 offen offset:3072 sc1
  s_add_u32 s22, s21, 28672
  buffer_load_dwordx4 a[112:115], v2, s[8:11], s22 offen offset:0 sc1
  buffer_load_dwordx4 a[116:119], v2, s[8:11], s22 offen offset:1024 sc1
  buffer_load_dwordx4 a[120:123], v2, s[8:11], s22 offen offset:2048 sc1
  buffer_load_dwordx4 a[124:127], v2, s[8:11], s22 offen offset:3072 sc1
  s_add_u32 s22, s21, 32768
  buffer_load_dwordx4 a[128:131], v2, s[8:11], s22 offen offset:0 sc1
  buffer_load_dwordx4 a[132:135], v2, s[8:11], s22 offen offset:1024 sc1
  buffer_load_dwordx4 a[136:139], v2, s[8:11], s22 offen offset:2048 sc1
  buffer_load_dwordx4 a[140:143], v2, s[8:11], s22 offen offset:3072 sc1
  s_add_u32 s22, s21, 36864
  buffer_load_dwordx4 a[144:147], v2, s[8:11], s22 offen offset:0 sc1
  buffer_load_dwordx4 a[148:151], v2, s[8:11], s22 offen offset:1024 sc1
  buffer_load_dwordx4 a[152:155], v2, s[8:11], s22 offen offset:2048 sc1
  buffer_load_dwordx4 a[156:159], v2, s[8:11], s22 offen offset:3072 sc1
  s_add_u32 s22, s21, 40960
  buffer_load_dwordx4 a[160:163], v2, s[8:11], s22 offen offset:0 sc1
  buffer_load_dwordx4 a[164:167], v2, s[8:11], s22 offen offset:1024 sc1
  buffer_load_dwordx4 a[168:171], v2, s[8:11], s22 offen offset:2048 sc1
  buffer_load_dwordx4 a[172:175], v2, s[8:11], s22 offen offset:3072 sc1
  s_add_u32 s22, s21, 45056
  buffer_load_dwordx4 a[176:179], v2, s[8:11], s22 offen offset:0 sc1
  buffer_load_dwordx4 a[180:183], v2, s[8:11], s22 offen offset:1024 sc1
  buffer_load_dwordx4 a[184:187], v2, s[8:11], s22 offen offset:2048 sc1
  buffer_load_dwordx4 a[188:191], v2, s[8:11], s22 offen offset:3072 sc1
  s_add_u32 s22, s21, 49152
  buffer_load_dwordx4 a[192:195], v2, s[8:11], s22 offen offset:0 sc1
  buffer_load_dwordx4 a[196:199], v2, s[8:11], s22 offen offset:1024 sc1
  buffer_load_dwordx4 a[200:203], v2, s[8:11], s22 offen offset:2048 sc1
  buffer_load_dwordx4 a[204:207], v2, s[8:11], s22 offen offset:3072 sc1
  s_add_u32 s22, s21, 53248
  buffer_load_dwordx4 a[208:211], v2, s[8:11], s22 offen offset:0 sc1
  buffer_load_dwordx4 a[212:215], v2, s[8:11], s22 offen offset:1024 sc1
  buffer_load_dwordx4 a[216:219], v2, s[8:11], s22 offen offset:2048 sc1
  buffer_load_dwordx4 a[220:223], v2, s[8:11], s22 offen offset:3072 sc1
  s_waitcnt vmcnt(40)
  s_mul_i32 s23, s17, 401408
  s_and_b32 s22, s16, 1
  s_mul_i32 s22, s22, 7168
  s_add_u32 s23, s23, s22
  s_add_u32 s23, s23, 0
  s_lshr_b32 s22, s16, 1
  s_mul_i32 s22, s22, 14336
  s_add_u32 s23, s23, s22
  s_mul_i32 s27, s16, 7168
  s_lshr_b32 s28, s20, 1
  s_cmp_lt_u32 s17, 16
  s_cbranch_scc0 wg_vo
  s_add_u32 s23, s23, s22
  s_lshl_b32 s29, s28, 4
  s_add_u32 s29, s29, s17
  s_mul_i32 s29, s29, 28672
  s_add_u32 s29, s29, 12845056
  s_mov_b32 s31, 0
  s_lshr_b32 s24, s34, 1
  s_lshl_b32 s24, s24, 2
  s_and_b32 s25, s34, 1
  s_add_u32 s24, s24, s25
  s_mul_i32 s24, s24, 14336
  s_add_u32 s24, s24, s23
  s_cmp_lt_u32 s34, s35
  s_cselect_b32 s24, s24, 0x10000000
  s_add_u32 m0, s31, s27
  s_nop 0
  buffer_load_dwordx4 v2, s[8:11], s24 offen offset:0 sc1 lds
  buffer_load_dwordx4 v2, s[8:11], s24 offen offset:1024 sc1 lds
  buffer_load_dwordx4 v2, s[8:11], s24 offen offset:2048 sc1 lds
  buffer_load_dwordx4 v2, s[8:11], s24 offen offset:3072 sc1 lds
  s_add_u32 m0, m0, 4096
  s_add_u32 s24, s24, 4096
  buffer_load_dwordx4 v2, s[8:11], s24 offen offset:0 sc1 lds
  buffer_load_dwordx4 v2, s[8:11], s24 offen offset:1024 sc1 lds
  buffer_load_dwordx4 v2, s[8:11], s24 offen offset:2048 sc1 lds
  s_add_u32 s30, s34, 1
  s_mov_b32 s31, 28672
  s_lshr_b32 s24, s30, 1
  s_lshl_b32 s24, s24, 2
  s_and_b32 s25, s30, 1
  s_add_u32 s24, s24, s25
  s_mul_i32 s24, s24, 14336
  s_add_u32 s24, s24, s23
  s_cmp_lt_u32 s30, s35
  s_cselect_b32 s24, s24, 0x10000000
  s_add_u32 m0, s31, s27
  s_nop 0
  buffer_load_dwordx4 v2, s[8:11], s24 offen offset:0 sc1 lds
  buffer_load_dwordx4 v2, s[8:11], s24 offen offset:1024 sc1 lds
  buffer_load_dwordx4 v2, s[8:11], s24 offen offset:2048 sc1 lds
  buffer_load_dwordx4 v2, s[8:11], s24 offen offset:3072 sc1 lds
  s_add_u32 m0, m0, 4096
  s_add_u32 s24, s24, 4096
  buffer_load_dwordx4 v2, s[8:11], s24 offen offset:0 sc1 lds
  buffer_load_dwordx4 v2, s[8:11], s24 offen offset:1024 sc1 lds
  buffer_load_dwordx4 v2, s[8:11], s24 offen offset:2048 sc1 lds
  s_mov_b32 s19, s34
  s_mov_b32 s32, 0
  s_mov_b32 s33, 57344
  s_waitcnt vmcnt(7)
  s_branch wg_f_in
wg_f_loop:
  s_waitcnt vmcnt(11)
wg_f_in:
  s_barrier
  s_add_u32 s30, s19, 2
  s_lshr_b32 s24, s30, 1
  s_lshl_b32 s24, s24, 2
  s_and_b32 s25, s30, 1
  s_add_u32 s24, s24, s25
  s_mul_i32 s24, s24, 14336
  s_add_u32 s24, s24, s23
  s_cmp_lt_u32 s30, s35
  s_cselect_b32 s24, s24, 0x10000000
  s_add_u32 m0, s33, s27
  s_nop 0
  buffer_load_dwordx4 v2, s[8:11], s24 offen offset:0 sc1 lds
  buffer_load_dwordx4 v2, s[8:11], s24 offen offset:1024 sc1 lds
  buffer_load_dwordx4 v2, s[8:11], s24 offen offset:2048 sc1 lds
  buffer_load_dwordx4 v2, s[8:11], s24 offen offset:3072 sc1 lds
  s_add_u32 m0, m0, 4096
  s_add_u32 s24, s24, 4096
  buffer_load_dwordx4 v2, s[8:11], s24 offen offset:0 sc1 lds
  buffer_load_dwordx4 v2, s[8:11], s24 offen offset:1024 sc1 lds
  buffer_load_dwordx4 v2, s[8:11], s24 offen offset:2048 sc1 lds
  v_add_u32 v5, s32, v2
  ds_read_b128 v[8:11], v5 offset:0
  ds_read_b128 v[12:15], v5 offset:14336
  ds_read_b128 v[16:19], v5 offset:1024
  ds_read_b128 v[20:23], v5 offset:15360
  ds_read_b128 v[24:27], v5 offset:2048
  ds_read_b128 v[28:31], v5 offset:16384
  ds_read_b128 v[32:35], v5 offset:3072
  s_waitcnt lgkmcnt(6)
  v_mfma_f32_16x16x32_bf16 v[40:43], v[8:11], a[0:3], 0
  v_mfma_f32_16x16x32_bf16 v[44:47], v[8:11], a[56:59], 0
  v_mfma_f32_16x16x32_bf16 v[48:51], v[8:11], a[112:115], 0
  v_mfma_f32_16x16x32_bf16 v[52:55], v[8:11], a[168:171], 0
  ds_read_b128 v[36:39], v5 offset:17408
  s_waitcnt lgkmcnt(6)
  v_mfma_f32_16x16x32_bf16 v[56:59], v[12:15], a[0:3], 0
  v_mfma_f32_16x16x32_bf16 v[60:63], v[12:15], a[56:59], 0
  v_mfma_f32_16x16x32_bf16 v[64:67], v[12:15], a[112:115], 0
  v_mfma_f32_16x16x32_bf16 v[68:71], v[12:15], a[168:171], 0
  ds_read_b128 v[8:11], v5 offset:4096
  s_waitcnt lgkmcnt(6)
  v_mfma_f32_16x16x32_bf16 v[40:43], v[16:19], a[4:7], v[40:43]
  v_mfma_f32_16x16x32_bf16 v[44:47], v[16:19], a[60:63], v[44:47]
  v_mfma_f32_16x16x32_bf16 v[48:51], v[16:19], a[116:119], v[48:51]
  v_mfma_f32_16x16x32_bf16 v[52:55], v[16:19], a[172:175], v[52:55]
  ds_read_b128 v[12:15], v5 offset:18432
  s_waitcnt lgkmcnt(6)
  v_mfma_f32_16x16x32_bf16 v[56:59], v[20:23], a[4:7], v[56:59]
  v_mfma_f32_16x16x32_bf16 v[60:63], v[20:23], a[60:63], v[60:63]
  v_mfma_f32_16x16x32_bf16 v[64:67], v[20:23], a[116:119], v[64:67]
  v_mfma_f32_16x16x32_bf16 v[68:71], v[20:23], a[172:175], v[68:71]
  ds_read_b128 v[16:19], v5 offset:5120
  s_waitcnt lgkmcnt(6)
  v_mfma_f32_16x16x32_bf16 v[40:43], v[24:27], a[8:11], v[40:43]
  v_mfma_f32_16x16x32_bf16 v[44:47], v[24:27], a[64:67], v[44:47]
  v_mfma_f32_16x16x32_bf16 v[48:51], v[24:27], a[120:123], v[48:51]
  v_mfma_f32_16x16x32_bf16 v[52:55], v[24:27], a[176:179], v[52:55]
  ds_read_b128 v[20:23], v5 offset:19456
  s_waitcnt lgkmcnt(6)
  v_mfma_f32_16x16x32_bf16 v[56:59], v[28:31], a[8:11], v[56:59]
  v_mfma_f32_16x16x32_bf16 v[60:63], v[28:31], a[64:67], v[60:63]
  v_mfma_f32_16x16x32_bf16 v[64:67], v[28:31], a[120:123], v[64:67]
  v_mfma_f32_16x16x32_bf16 v[68:71], v[28:31], a[176:179], v[68:71]
  ds_read_b128 v[24:27], v5 offset:6144
  s_waitcnt lgkmcnt(6)
  v_mfma_f32_16x16x32_bf16 v[40:43], v[32:35], a[12:15], v[40:43]
  v_mfma_f32_16x16x32_bf16 v[44:47], v[32:35], a[68:71], v[44:47]
  v_mfma_f32_16x16x32_bf16 v[48:51], v[32:35], a[124:127], v[48:51]
  v_mfma_f32_16x16x32_bf16 v[52:55], v[32:35], a[180:183], v[52:55]
  ds_read_b128 v[28:31], v5 offset:20480
  s_waitcnt lgkmcnt(6)
  v_mfma_f32_16x16x32_bf16 v[56:59], v[36:39], a[12:15], v[56:59]
  v_mfma_f32_16x16x32_bf16 v[60:63], v[36:39], a[68:71], v[60:63]
  v_mfma_f32_16x16x32_bf16 v[64:67], v[36:39], a[124:127], v[64:67]
  v_mfma_f32_16x16x32_bf16 v[68:71], v[36:39], a[180:183], v[68:71]
  ds_read_b128 v[32:35], v5 offset:7168
  s_waitcnt lgkmcnt(6)
  v_mfma_f32_16x16x32_bf16 v[40:43], v[8:11], a[16:19], v[40:43]
  v_mfma_f32_16x16x32_bf16 v[44:47], v[8:11], a[72:75], v[44:47]
  v_mfma_f32_16x16x32_bf16 v[48:51], v[8:11], a[128:131], v[48:51]
  v_mfma_f32_16x16x32_bf16 v[52:55], v[8:11], a[184:187], v[52:55]
  ds_read_b128 v[36:39], v5 offset:21504
  s_waitcnt lgkmcnt(6)
  v_mfma_f32_16x16x32_bf16 v[56:59], v[12:15], a[16:19], v[56:59]
  v_mfma_f32_16x16x32_bf16 v[60:63], v[12:15], a[72:75], v[60:63]
  v_mfma_f32_16x16x32_bf16 v[64:67], v[12:15], a[128:131], v[64:67]
  v_mfma_f32_16x16x32_bf16 v[68:71], v[12:15], a[184:187], v[68:71]
  ds_read_b128 v[8:11], v5 offset:8192
  s_waitcnt lgkmcnt(6)
  v_mfma_f32_16x16x32_bf16 v[40:43], v[16:19], a[20:23], v[40:43]
  v_mfma_f32_16x16x32_bf16 v[44:47], v[16:19], a[76:79], v[44:47]
  v_mfma_f32_16x16x32_bf16 v[48:51], v[16:19], a[132:135], v[48:51]
  v_mfma_f32_16x16x32_bf16 v[52:55], v[16:19], a[188:191], v[52:55]
  ds_read_b128 v[12:15], v5 offset:22528
  s_waitcnt lgkmcnt(6)
  v_mfma_f32_16x16x32_bf16 v[56:59], v[20:23], a[20:23], v[56:59]
  v_mfma_f32_16x16x32_bf16 v[60:63], v[20:23], a[76:79], v[60:63]
  v_mfma_f32_16x16x32_bf16 v[64:67], v[20:23], a[132:135], v[64:67]
  v_mfma_f32_16x16x32_bf16 v[68:71], v[20:23], a[188:191], v[68:71]
  ds_read_b128 v[16:19], v5 offset:9216
  s_waitcnt lgkmcnt(6)
  v_mfma_f32_16x16x32_bf16 v[40:43], v[24:27], a[24:27], v[40:43]
  v_mfma_f32_16x16x32_bf16 v[44:47], v[24:27], a[80:83], v[44:47]
  v_mfma_f32_16x16x32_bf16 v[48:51], v[24:27], a[136:139], v[48:51]
  v_mfma_f32_16x16x32_bf16 v[52:55], v[24:27], a[192:195], v[52:55]
  ds_read_b128 v[20:23], v5 offset:23552
  s_waitcnt lgkmcnt(6)
  v_mfma_f32_16x16x32_bf16 v[56:59], v[28:31], a[24:27], v[56:59]
  v_mfma_f32_16x16x32_bf16 v[60:63], v[28:31], a[80:83], v[60:63]
  v_mfma_f32_16x16x32_bf16 v[64:67], v[28:31], a[136:139], v[64:67]
  v_mfma_f32_16x16x32_bf16 v[68:71], v[28:31], a[192:195], v[68:71]
  ds_read_b128 v[24:27], v5 offset:10240
  s_waitcnt lgkmcnt(6)
  v_mfma_f32_16x16x32_bf16 v[40:43], v[32:35], a[28:31], v[40:43]
  v_mfma_f32_16x16x32_bf16 v[44:47], v[32:35], a[84:87], v[44:47]
  v_mfma_f32_16x16x32_bf16 v[48:51], v[32:35], a[140:143], v[48:51]
  v_mfma_f32_16x16x32_bf16 v[52:55], v[32:35], a[196:199], v[52:55]
  ds_read_b128 v[28:31], v5 offset:24576
  s_waitcnt lgkmcnt(6)
  v_mfma_f32_16x16x32_bf16 v[56:59], v[36:39], a[28:31], v[56:59]
  v_mfma_f32_16x16x32_bf16 v[60:63], v[36:39], a[84:87], v[60:63]
  v_mfma_f32_16x16x32_bf16 v[64:67], v[36:39], a[140:143], v[64:67]
  v_mfma_f32_16x16x32_bf16 v[68:71], v[36:39], a[196:199], v[68:71]
  ds_read_b128 v[32:35], v5 offset:11264
  s_waitcnt lgkmcnt(6)
  v_mfma_f32_16x16x32_bf16 v[40:43], v[8:11], a[32:35], v[40:43]
  v_mfma_f32_16x16x32_bf16 v[44:47], v[8:11], a[88:91], v[44:47]
  v_mfma_f32_16x16x32_bf16 v[48:51], v[8:11], a[144:147], v[48:51]
  v_mfma_f32_16x16x32_bf16 v[52:55], v[8:11], a[200:203], v[52:55]
  ds_read_b128 v[36:39], v5 offset:25600
  s_waitcnt lgkmcnt(6)
  v_mfma_f32_16x16x32_bf16 v[56:59], v[12:15], a[32:35], v[56:59]
  v_mfma_f32_16x16x32_bf16 v[60:63], v[12:15], a[88:91], v[60:63]
  v_mfma_f32_16x16x32_bf16 v[64:67], v[12:15], a[144:147], v[64:67]
  v_mfma_f32_16x16x32_bf16 v[68:71], v[12:15], a[200:203], v[68:71]
  ds_read_b128 v[8:11], v5 offset:12288
  s_waitcnt lgkmcnt(6)
  v_mfma_f32_16x16x32_bf16 v[40:43], v[16:19], a[36:39], v[40:43]
  v_mfma_f32_16x16x32_bf16 v[44:47], v[16:19], a[92:95], v[44:47]
  v_mfma_f32_16x16x32_bf16 v[48:51], v[16:19], a[148:151], v[48:51]
  v_mfma_f32_16x16x32_bf16 v[52:55], v[16:19], a[204:207], v[52:55]
  ds_read_b128 v[12:15], v5 offset:26624
  s_waitcnt lgkmcnt(6)
  v_mfma_f32_16x16x32_bf16 v[56:59], v[20:23], a[36:39], v[56:59]
  v_mfma_f32_16x16x32_bf16 v[60:63], v[20:23], a[92:95], v[60:63]
  v_mfma_f32_16x16x32_bf16 v[64:67], v[20:23], a[148:151], v[64:67]
  v_mfma_f32_16x16x32_bf16 v[68:71], v[20:23], a[204:207], v[68:71]
  ds_read_b128 v[16:19], v5 offset:13312
  s_waitcnt lgkmcnt(6)
  v_mfma_f32_16x16x32_bf16 v[40:43], v[24:27], a[40:43], v[40:43]
  v_mfma_f32_16x16x32_bf16 v[44:47], v[24:27], a[96:99], v[44:47]
  v_mfma_f32_16x16x32_bf16 v[48:51], v[24:27], a[152:155], v[48:51]
  v_mfma_f32_16x16x32_bf16 v[52:55], v[24:27], a[208:211], v[52:55]
  ds_read_b128 v[20:23], v5 offset:27648
  s_waitcnt lgkmcnt(6)
  v_mfma_f32_16x16x32_bf16 v[56:59], v[28:31], a[40:43], v[56:59]
  v_mfma_f32_16x16x32_bf16 v[60:63], v[28:31], a[96:99], v[60:63]
  v_mfma_f32_16x16x32_bf16 v[64:67], v[28:31], a[152:155], v[64:67]
  v_mfma_f32_16x16x32_bf16 v[68:71], v[28:31], a[208:211], v[68:71]
  s_waitcnt lgkmcnt(5)
  v_mfma_f32_16x16x32_bf16 v[40:43], v[32:35], a[44:47], v[40:43]
  v_mfma_f32_16x16x32_bf16 v[44:47], v[32:35], a[100:103], v[44:47]
  v_mfma_f32_16x16x32_bf16 v[48:51], v[32:35], a[156:159], v[48:51]
  v_mfma_f32_16x16x32_bf16 v[52:55], v[32:35], a[212:215], v[52:55]
  s_waitcnt lgkmcnt(4)
  v_mfma_f32_16x16x32_bf16 v[56:59], v[36:39], a[44:47], v[56:59]
  v_mfma_f32_16x16x32_bf16 v[60:63], v[36:39], a[100:103], v[60:63]
  v_mfma_f32_16x16x32_bf16 v[64:67], v[36:39], a[156:159], v[64:67]
  v_mfma_f32_16x16x32_bf16 v[68:71], v[36:39], a[212:215], v[68:71]
  s_waitcnt lgkmcnt(3)
  v_mfma_f32_16x16x32_bf16 v[40:43], v[8:11], a[48:51], v[40:43]
  v_mfma_f32_16x16x32_bf16 v[44:47], v[8:11], a[104:107], v[44:47]
  v_mfma_f32_16x16x32_bf16 v[48:51], v[8:11], a[160:163], v[48:51]
  v_mfma_f32_16x16x32_bf16 v[52:55], v[8:11], a[216:219], v[52:55]
  s_waitcnt lgkmcnt(2)
  v_mfma_f32_16x16x32_bf16 v[56:59], v[12:15], a[48:51], v[56:59]
  v_mfma_f32_16x16x32_bf16 v[60:63], v[12:15], a[104:107], v[60:63]
  v_mfma_f32_16x16x32_bf16 v[64:67], v[12:15], a[160:163], v[64:67]
  v_mfma_f32_16x16x32_bf16 v[68:71], v[12:15], a[216:219], v[68:71]
  s_waitcnt lgkmcnt(1)
  v_mfma_f32_16x16x32_bf16 v[40:43], v[16:19], a[52:55], v[40:43]
  v_mfma_f32_16x16x32_bf16 v[44:47], v[16:19], a[108:111], v[44:47]
  v_mfma_f32_16x16x32_bf16 v[48:51], v[16:19], a[164:167], v[48:51]
  v_mfma_f32_16x16x32_bf16 v[52:55], v[16:19], a[220:223], v[52:55]
  s_waitcnt lgkmcnt(0)
  v_mfma_f32_16x16x32_bf16 v[56:59], v[20:23], a[52:55], v[56:59]
  v_mfma_f32_16x16x32_bf16 v[60:63], v[20:23], a[108:111], v[60:63]
  v_mfma_f32_16x16x32_bf16 v[64:67], v[20:23], a[164:167], v[64:67]
  v_mfma_f32_16x16x32_bf16 v[68:71], v[20:23], a[220:223], v[68:71]
  s_lshl_b32 s24, s19, 10
  s_add_u32 s24, s24, s29
  v_cvt_pk_bf16_f32 v72, v40, v41
  v_cvt_pk_bf16_f32 v73, v42, v43
  v_cvt_pk_bf16_f32 v74, v56, v57
  v_cvt_pk_bf16_f32 v75, v58, v59
  s_add_u32 s25, s24, 0
  buffer_store_dwordx4 v[72:75], v2, s[8:11], s25 offen sc1
  v_cvt_pk_bf16_f32 v76, v44, v45
  v_cvt_pk_bf16_f32 v77, v46, v47
  v_cvt_pk_bf16_f32 v78, v60, v61
  v_cvt_pk_bf16_f32 v79, v62, v63
  s_add_u32 s25, s24, 14336
  buffer_store_dwordx4 v[76:79], v2, s[8:11], s25 offen sc1
  v_cvt_pk_bf16_f32 v80, v48, v49
  v_cvt_pk_bf16_f32 v81, v50, v51
  v_cvt_pk_bf16_f32 v82, v64, v65
  v_cvt_pk_bf16_f32 v83, v66, v67
  s_add_u32 s25, s24, 458752
  buffer_store_dwordx4 v[80:83], v2, s[8:11], s25 offen sc1
  v_cvt_pk_bf16_f32 v84, v52, v53
  v_cvt_pk_bf16_f32 v85, v54, v55
  v_cvt_pk_bf16_f32 v86, v68, v69
  v_cvt_pk_bf16_f32 v87, v70, v71
  s_add_u32 s25, s24, 473088
  buffer_store_dwordx4 v[84:87], v2, s[8:11], s25 offen sc1
  s_mov_b32 s33, s32
  s_add_u32 s32, s32, 28672
  s_cmp_eq_u32 s32, 86016
  s_cselect_b32 s32, 0, s32
  s_add_u32 s19, s19, 1
  s_cmp_lt_u32 s19, s35
  s_cbranch_scc1 wg_f_loop
  s_branch wg_done
wg_vo:
  s_sub_u32 s29, s17, 16
  s_lshl_b32 s29, s29, 6
  s_add_u32 s29, s29, s28
  s_mul_i32 s29, s29, 28672
  s_add_u32 s29, s29, 42205184
  v_mul_u32_u24 v6, 28, v3
  s_mov_b32 s31, 0
  s_lshl_b32 s24, s34, 1
  s_mul_i32 s24, s24, 14336
  s_add_u32 s24, s24, s23
  s_cmp_lt_u32 s34, s35
  s_cselect_b32 s24, s24, 0x10000000
  s_add_u32 m0, s31, s27
  s_nop 0
  buffer_load_dwordx4 v2, s[8:11], s24 offen offset:0 sc1 lds
  buffer_load_dwordx4 v2, s[8:11], s24 offen offset:1024 sc1 lds
  buffer_load_dwordx4 v2, s[8:11], s24 offen offset:2048 sc1 lds
  buffer_load_dwordx4 v2, s[8:11], s24 offen offset:3072 sc1 lds
  s_add_u32 m0, m0, 4096
  s_add_u32 s24, s24, 4096
  buffer_load_dwordx4 v2, s[8:11], s24 offen offset:0 sc1 lds
  buffer_load_dwordx4 v2, s[8:11], s24 offen offset:1024 sc1 lds
  buffer_load_dwordx4 v2, s[8:11], s24 offen offset:2048 sc1 lds
  s_add_u32 s30, s34, 1
  s_mov_b32 s31, 28672
  s_lshl_b32 s24, s30, 1
  s_mul_i32 s24, s24, 14336
  s_add_u32 s24, s24, s23
  s_cmp_lt_u32 s30, s35
  s_cselect_b32 s24, s24, 0x10000000
  s_add_u32 m0, s31, s27
  s_nop 0
  buffer_load_dwordx4 v2, s[8:11], s24 offen offset:0 sc1 lds
  buffer_load_dwordx4 v2, s[8:11], s24 offen offset:1024 sc1 lds
  buffer_load_dwordx4 v2, s[8:11], s24 offen offset:2048 sc1 lds
  buffer_load_dwordx4 v2, s[8:11], s24 offen offset:3072 sc1 lds
  s_add_u32 m0, m0, 4096
  s_add_u32 s24, s24, 4096
  buffer_load_dwordx4 v2, s[8:11], s24 offen offset:0 sc1 lds
  buffer_load_dwordx4 v2, s[8:11], s24 offen offset:1024 sc1 lds
  buffer_load_dwordx4 v2, s[8:11], s24 offen offset:2048 sc1 lds
  s_mov_b32 s19, s34
  s_mov_b32 s32, 0
  s_mov_b32 s33, 57344
  s_waitcnt vmcnt(7)
  s_branch wg_vo_in
wg_vo_loop:
  s_waitcnt vmcnt(11)
wg_vo_in:
  s_barrier
  s_add_u32 s30, s19, 2
  s_lshl_b32 s24, s30, 1
  s_mul_i32 s24, s24, 14336
  s_add_u32 s24, s24, s23
  s_cmp_lt_u32 s30, s35
  s_cselect_b32 s24, s24, 0x10000000
  s_add_u32 m0, s33, s27
  s_nop 0
  buffer_load_dwordx4 v2, s[8:11], s24 offen offset:0 sc1 lds
  buffer_load_dwordx4 v2, s[8:11], s24 offen offset:1024 sc1 lds
  buffer_load_dwordx4 v2, s[8:11], s24 offen offset:2048 sc1 lds
  buffer_load_dwordx4 v2, s[8:11], s24 offen offset:3072 sc1 lds
  s_add_u32 m0, m0, 4096
  s_add_u32 s24, s24, 4096
  buffer_load_dwordx4 v2, s[8:11], s24 offen offset:0 sc1 lds
  buffer_load_dwordx4 v2, s[8:11], s24 offen offset:1024 sc1 lds
  buffer_load_dwordx4 v2, s[8:11], s24 offen offset:2048 sc1 lds
  v_add_u32 v5, s32, v2
  ds_read_b128 v[8:11], v5 offset:0
  ds_read_b128 v[12:15], v5 offset:14336
  ds_read_b128 v[16:19], v5 offset:1024
  ds_read_b128 v[20:23], v5 offset:15360
  ds_read_b128 v[24:27], v5 offset:2048
  ds_read_b128 v[28:31], v5 offset:16384
  ds_read_b128 v[32:35], v5 offset:3072
  s_waitcnt lgkmcnt(6)
  v_mfma_f32_16x16x32_bf16 v[40:43], a[0:3], v[8:11], 0
  v_mfma_f32_16x16x32_bf16 v[44:47], a[56:59], v[8:11], 0
  v_mfma_f32_16x16x32_bf16 v[48:51], a[112:115], v[8:11], 0
  v_mfma_f32_16x16x32_bf16 v[52:55], a[168:171], v[8:11], 0
  ds_read_b128 v[36:39], v5 offset:17408
  s_waitcnt lgkmcnt(6)
  v_mfma_f32_16x16x32_bf16 v[56:59], a[0:3], v[12:15], 0
  v_mfma_f32_16x16x32_bf16 v[60:63], a[56:59], v[12:15], 0
  v_mfma_f32_16x16x32_bf16 v[64:67], a[112:115], v[12:15], 0
  v_mfma_f32_16x16x32_bf16 v[68:71], a[168:171], v[12:15], 0
  ds_read_b128 v[8:11], v5 offset:4096
  s_waitcnt lgkmcnt(6)
  v_mfma_f32_16x16x32_bf16 v[40:43], a[4:7], v[16:19], v[40:43]
  v_mfma_f32_16x16x32_bf16 v[44:47], a[60:63], v[16:19], v[44:47]
  v_mfma_f32_16x16x32_bf16 v[48:51], a[116:119], v[16:19], v[48:51]
  v_mfma_f32_16x16x32_bf16 v[52:55], a[172:175], v[16:19], v[52:55]
  ds_read_b128 v[12:15], v5 offset:18432
  s_waitcnt lgkmcnt(6)
  v_mfma_f32_16x16x32_bf16 v[56:59], a[4:7], v[20:23], v[56:59]
  v_mfma_f32_16x16x32_bf16 v[60:63], a[60:63], v[20:23], v[60:63]
  v_mfma_f32_16x16x32_bf16 v[64:67], a[116:119], v[20:23], v[64:67]
  v_mfma_f32_16x16x32_bf16 v[68:71], a[172:175], v[20:23], v[68:71]
  ds_read_b128 v[16:19], v5 offset:5120
  s_waitcnt lgkmcnt(6)
  v_mfma_f32_16x16x32_bf16 v[40:43], a[8:11], v[24:27], v[40:43]
  v_mfma_f32_16x16x32_bf16 v[44:47], a[64:67], v[24:27], v[44:47]
  v_mfma_f32_16x16x32_bf16 v[48:51], a[120:123], v[24:27], v[48:51]
  v_mfma_f32_16x16x32_bf16 v[52:55], a[176:179], v[24:27], v[52:55]
  ds_read_b128 v[20:23], v5 offset:19456
  s_waitcnt lgkmcnt(6)
  v_mfma_f32_16x16x32_bf16 v[56:59], a[8:11], v[28:31], v[56:59]
  v_mfma_f32_16x16x32_bf16 v[60:63], a[64:67], v[28:31], v[60:63]
  v_mfma_f32_16x16x32_bf16 v[64:67], a[120:123], v[28:31], v[64:67]
  v_mfma_f32_16x16x32_bf16 v[68:71], a[176:179], v[28:31], v[68:71]
  ds_read_b128 v[24:27], v5 offset:6144
  s_waitcnt lgkmcnt(6)
  v_mfma_f32_16x16x32_bf16 v[40:43], a[12:15], v[32:35], v[40:43]
  v_mfma_f32_16x16x32_bf16 v[44:47], a[68:71], v[32:35], v[44:47]
  v_mfma_f32_16x16x32_bf16 v[48:51], a[124:127], v[32:35], v[48:51]
  v_mfma_f32_16x16x32_bf16 v[52:55], a[180:183], v[32:35], v[52:55]
  ds_read_b128 v[28:31], v5 offset:20480
  s_waitcnt lgkmcnt(6)
  v_mfma_f32_16x16x32_bf16 v[56:59], a[12:15], v[36:39], v[56:59]
  v_mfma_f32_16x16x32_bf16 v[60:63], a[68:71], v[36:39], v[60:63]
  v_mfma_f32_16x16x32_bf16 v[64:67], a[124:127], v[36:39], v[64:67]
  v_mfma_f32_16x16x32_bf16 v[68:71], a[180:183], v[36:39], v[68:71]
  ds_read_b128 v[32:35], v5 offset:7168
  s_waitcnt lgkmcnt(6)
  v_mfma_f32_16x16x32_bf16 v[40:43], a[16:19], v[8:11], v[40:43]
  v_mfma_f32_16x16x32_bf16 v[44:47], a[72:75], v[8:11], v[44:47]
  v_mfma_f32_16x16x32_bf16 v[48:51], a[128:131], v[8:11], v[48:51]
  v_mfma_f32_16x16x32_bf16 v[52:55], a[184:187], v[8:11], v[52:55]
  ds_read_b128 v[36:39], v5 offset:21504
  s_waitcnt lgkmcnt(6)
  v_mfma_f32_16x16x32_bf16 v[56:59], a[16:19], v[12:15], v[56:59]
  v_mfma_f32_16x16x32_bf16 v[60:63], a[72:75], v[12:15], v[60:63]
  v_mfma_f32_16x16x32_bf16 v[64:67], a[128:131], v[12:15], v[64:67]
  v_mfma_f32_16x16x32_bf16 v[68:71], a[184:187], v[12:15], v[68:71]
  ds_read_b128 v[8:11], v5 offset:8192
  s_waitcnt lgkmcnt(6)
  v_mfma_f32_16x16x32_bf16 v[40:43], a[20:23], v[16:19], v[40:43]
  v_mfma_f32_16x16x32_bf16 v[44:47], a[76:79], v[16:19], v[44:47]
  v_mfma_f32_16x16x32_bf16 v[48:51], a[132:135], v[16:19], v[48:51]
  v_mfma_f32_16x16x32_bf16 v[52:55], a[188:191], v[16:19], v[52:55]
  ds_read_b128 v[12:15], v5 offset:22528
  s_waitcnt lgkmcnt(6)
  v_mfma_f32_16x16x32_bf16 v[56:59], a[20:23], v[20:23], v[56:59]
  v_mfma_f32_16x16x32_bf16 v[60:63], a[76:79], v[20:23], v[60:63]
  v_mfma_f32_16x16x32_bf16 v[64:67], a[132:135], v[20:23], v[64:67]
  v_mfma_f32_16x16x32_bf16 v[68:71], a[188:191], v[20:23], v[68:71]
  ds_read_b128 v[16:19], v5 offset:9216
  s_waitcnt lgkmcnt(6)
  v_mfma_f32_16x16x32_bf16 v[40:43], a[24:27], v[24:27], v[40:43]
  v_mfma_f32_16x16x32_bf16 v[44:47], a[80:83], v[24:27], v[44:47]
  v_mfma_f32_16x16x32_bf16 v[48:51], a[136:139], v[24:27], v[48:51]
  v_mfma_f32_16x16x32_bf16 v[52:55], a[192:195], v[24:27], v[52:55]
  ds_read_b128 v[20:23], v5 offset:23552
  s_waitcnt lgkmcnt(6)
  v_mfma_f32_16x16x32_bf16 v[56:59], a[24:27], v[28:31], v[56:59]
  v_mfma_f32_16x16x32_bf16 v[60:63], a[80:83], v[28:31], v[60:63]
  v_mfma_f32_16x16x32_bf16 v[64:67], a[136:139], v[28:31], v[64:67]
  v_mfma_f32_16x16x32_bf16 v[68:71], a[192:195], v[28:31], v[68:71]
  ds_read_b128 v[24:27], v5 offset:10240
  s_waitcnt lgkmcnt(6)
  v_mfma_f32_16x16x32_bf16 v[40:43], a[28:31], v[32:35], v[40:43]
  v_mfma_f32_16x16x32_bf16 v[44:47], a[84:87], v[32:35], v[44:47]
  v_mfma_f32_16x16x32_bf16 v[48:51], a[140:143], v[32:35], v[48:51]
  v_mfma_f32_16x16x32_bf16 v[52:55], a[196:199], v[32:35], v[52:55]
  ds_read_b128 v[28:31], v5 offset:24576
  s_waitcnt lgkmcnt(6)
  v_mfma_f32_16x16x32_bf16 v[56:59], a[28:31], v[36:39], v[56:59]
  v_mfma_f32_16x16x32_bf16 v[60:63], a[84:87], v[36:39], v[60:63]
  v_mfma_f32_16x16x32_bf16 v[64:67], a[140:143], v[36:39], v[64:67]
  v_mfma_f32_16x16x32_bf16 v[68:71], a[196:199], v[36:39], v[68:71]
  ds_read_b128 v[32:35], v5 offset:11264
  s_waitcnt lgkmcnt(6)
  v_mfma_f32_16x16x32_bf16 v[40:43], a[32:35], v[8:11], v[40:43]
  v_mfma_f32_16x16x32_bf16 v[44:47], a[88:91], v[8:11], v[44:47]
  v_mfma_f32_16x16x32_bf16 v[48:51], a[144:147], v[8:11], v[48:51]
  v_mfma_f32_16x16x32_bf16 v[52:55], a[200:203], v[8:11], v[52:55]
  ds_read_b128 v[36:39], v5 offset:25600
  s_waitcnt lgkmcnt(6)
  v_mfma_f32_16x16x32_bf16 v[56:59], a[32:35], v[12:15], v[56:59]
  v_mfma_f32_16x16x32_bf16 v[60:63], a[88:91], v[12:15], v[60:63]
  v_mfma_f32_16x16x32_bf16 v[64:67], a[144:147], v[12:15], v[64:67]
  v_mfma_f32_16x16x32_bf16 v[68:71], a[200:203], v[12:15], v[68:71]
  ds_read_b128 v[8:11], v5 offset:12288
  s_waitcnt lgkmcnt(6)
  v_mfma_f32_16x16x32_bf16 v[40:43], a[36:39], v[16:19], v[40:43]
  v_mfma_f32_16x16x32_bf16 v[44:47], a[92:95], v[16:19], v[44:47]
  v_mfma_f32_16x16x32_bf16 v[48:51], a[148:151], v[16:19], v[48:51]
  v_mfma_f32_16x16x32_bf16 v[52:55], a[204:207], v[16:19], v[52:55]
  ds_read_b128 v[12:15], v5 offset:26624
  s_waitcnt lgkmcnt(6)
  v_mfma_f32_16x16x32_bf16 v[56:59], a[36:39], v[20:23], v[56:59]
  v_mfma_f32_16x16x32_bf16 v[60:63], a[92:95], v[20:23], v[60:63]
  v_mfma_f32_16x16x32_bf16 v[64:67], a[148:151], v[20:23], v[64:67]
  v_mfma_f32_16x16x32_bf16 v[68:71], a[204:207], v[20:23], v[68:71]
  ds_read_b128 v[16:19], v5 offset:13312
  s_waitcnt lgkmcnt(6)
  v_mfma_f32_16x16x32_bf16 v[40:43], a[40:43], v[24:27], v[40:43]
  v_mfma_f32_16x16x32_bf16 v[44:47], a[96:99], v[24:27], v[44:47]
  v_mfma_f32_16x16x32_bf16 v[48:51], a[152:155], v[24:27], v[48:51]
  v_mfma_f32_16x16x32_bf16 v[52:55], a[208:211], v[24:27], v[52:55]
  ds_read_b128 v[20:23], v5 offset:27648
  s_waitcnt lgkmcnt(6)
  v_mfma_f32_16x16x32_bf16 v[56:59], a[40:43], v[28:31], v[56:59]
  v_mfma_f32_16x16x32_bf16 v[60:63], a[96:99], v[28:31], v[60:63]
  v_mfma_f32_16x16x32_bf16 v[64:67], a[152:155], v[28:31], v[64:67]
  v_mfma_f32_16x16x32_bf16 v[68:71], a[208:211], v[28:31], v[68:71]
  s_waitcnt lgkmcnt(5)
  v_mfma_f32_16x16x32_bf16 v[40:43], a[44:47], v[32:35], v[40:43]
  v_mfma_f32_16x16x32_bf16 v[44:47], a[100:103], v[32:35], v[44:47]
  v_mfma_f32_16x16x32_bf16 v[48:51], a[156:159], v[32:35], v[48:51]
  v_mfma_f32_16x16x32_bf16 v[52:55], a[212:215], v[32:35], v[52:55]
  s_waitcnt lgkmcnt(4)
  v_mfma_f32_16x16x32_bf16 v[56:59], a[44:47], v[36:39], v[56:59]
  v_mfma_f32_16x16x32_bf16 v[60:63], a[100:103], v[36:39], v[60:63]
  v_mfma_f32_16x16x32_bf16 v[64:67], a[156:159], v[36:39], v[64:67]
  v_mfma_f32_16x16x32_bf16 v[68:71], a[212:215], v[36:39], v[68:71]
  s_waitcnt lgkmcnt(3)
  v_mfma_f32_16x16x32_bf16 v[40:43], a[48:51], v[8:11], v[40:43]
  v_mfma_f32_16x16x32_bf16 v[44:47], a[104:107], v[8:11], v[44:47]
  v_mfma_f32_16x16x32_bf16 v[48:51], a[160:163], v[8:11], v[48:51]
  v_mfma_f32_16x16x32_bf16 v[52:55], a[216:219], v[8:11], v[52:55]
  s_waitcnt lgkmcnt(2)
  v_mfma_f32_16x16x32_bf16 v[56:59], a[48:51], v[12:15], v[56:59]
  v_mfma_f32_16x16x32_bf16 v[60:63], a[104:107], v[12:15], v[60:63]
  v_mfma_f32_16x16x32_bf16 v[64:67], a[160:163], v[12:15], v[64:67]
  v_mfma_f32_16x16x32_bf16 v[68:71], a[216:219], v[12:15], v[68:71]
  s_waitcnt lgkmcnt(1)
  v_mfma_f32_16x16x32_bf16 v[40:43], a[52:55], v[16:19], v[40:43]
  v_mfma_f32_16x16x32_bf16 v[44:47], a[108:111], v[16:19], v[44:47]
  v_mfma_f32_16x16x32_bf16 v[48:51], a[164:167], v[16:19], v[48:51]
  v_mfma_f32_16x16x32_bf16 v[52:55], a[220:223], v[16:19], v[52:55]
  s_waitcnt lgkmcnt(0)
  v_mfma_f32_16x16x32_bf16 v[56:59], a[52:55], v[20:23], v[56:59]
  v_mfma_f32_16x16x32_bf16 v[60:63], a[108:111], v[20:23], v[60:63]
  v_mfma_f32_16x16x32_bf16 v[64:67], a[164:167], v[20:23], v[64:67]
  v_mfma_f32_16x16x32_bf16 v[68:71], a[220:223], v[20:23], v[68:71]
  s_add_u32 s25, s29, 28672
  s_lshl_b32 s24, s19, 5
  s_add_u32 s24, s24, 0
  v_add_u32 v88, s24, v4
  v_mul_u32_u24 v89, 2341, v88
  v_lshrrev_b32 v89, 16, v89
  v_mul_u32_u24 v89, 84, v89
  v_add3_u32 v88, v88, v89, v6
  v_lshlrev_b32 v90, 4, v88
  v_cvt_pk_bf16_f32 v72, v40, v41
  v_cvt_pk_bf16_f32 v73, v42, v43
  v_cvt_pk_bf16_f32 v74, v44, v45
  v_cvt_pk_bf16_f32 v75, v46, v47
  buffer_store_dwordx4 v[72:75], v90, s[8:11], s29 offen sc1
  v_cvt_pk_bf16_f32 v76, v48, v49
  v_cvt_pk_bf16_f32 v77, v50, v51
  v_cvt_pk_bf16_f32 v78, v52, v53
  v_cvt_pk_bf16_f32 v79, v54, v55
  buffer_store_dwordx4 v[76:79], v90, s[8:11], s25 offen sc1
  s_lshl_b32 s24, s19, 5
  s_add_u32 s24, s24, 16
  v_add_u32 v88, s24, v4
  v_mul_u32_u24 v89, 2341, v88
  v_lshrrev_b32 v89, 16, v89
  v_mul_u32_u24 v89, 84, v89
  v_add3_u32 v88, v88, v89, v6
  v_lshlrev_b32 v91, 4, v88
  v_cvt_pk_bf16_f32 v80, v56, v57
  v_cvt_pk_bf16_f32 v81, v58, v59
  v_cvt_pk_bf16_f32 v82, v60, v61
  v_cvt_pk_bf16_f32 v83, v62, v63
  buffer_store_dwordx4 v[80:83], v91, s[8:11], s29 offen sc1
  v_cvt_pk_bf16_f32 v84, v64, v65
  v_cvt_pk_bf16_f32 v85, v66, v67
  v_cvt_pk_bf16_f32 v86, v68, v69
  v_cvt_pk_bf16_f32 v87, v70, v71
  buffer_store_dwordx4 v[84:87], v91, s[8:11], s25 offen sc1
  s_mov_b32 s33, s32
  s_add_u32 s32, s32, 28672
  s_cmp_eq_u32 s32, 86016
  s_cselect_b32 s32, 0, s32
  s_add_u32 s19, s19, 1
  s_cmp_lt_u32 s19, s35
  s_cbranch_scc1 wg_vo_loop
  s_branch wg_done
wg_done:
  s_lshl_b32 s20, s18, 4
  s_and_b32 s21, s17, 15
  s_add_u32 s20, s20, s21
  s_lshl_b32 s20, s20, 7
  s_cmp_lt_u32 s17, 16
  s_cselect_b32 s21, 16384, 0
  s_add_u32 s20, s20, s21
  s_add_u32 s20, s20, 88528896
  s_sub_u32 s21, s35, s34
  v_mov_b32 v5, s21
  v_mov_b32 v6, 0
  s_waitcnt vmcnt(0)
  s_mov_b64 exec, 1
  buffer_atomic_add v5, v6, s[8:11], s20 offen
  s_mov_b64 exec, -1
  s_branch wk_loop
wk_a:
  s_load_dwordx8 s[36:43], s[0:1], 56
  s_load_dwordx4 s[44:47], s[0:1], 88
  s_sub_u32 s3, s3, 432
  s_and_b32 s17, s3, 15
  s_lshr_b32 s19, s3, 5
  s_bitcmp1_b32 s3, 4
  s_cselect_b32 s31, 7, 0
  s_waitcnt lgkmcnt(0)
  s_mov_b32 s60, s40
  s_and_b32 s61, s41, 0xffff
  s_mov_b32 s62, 3670016
  s_mov_b32 s63, 0x20000
  s_mov_b32 s56, s42
  s_and_b32 s57, s43, 0xffff
  s_mov_b32 s58, 3670016
  s_mov_b32 s59, 0x20000
  s_lshl_b32 s30, s16, 13
  s_lshl_b32 s27, s19, 19
  s_lshl_b32 s29, s16, 17
  s_add_u32 s27, s27, s29
  s_lshl_b32 s29, s17, 9
  s_add_u32 s27, s27, s29
  v_lshrrev_b32 v5, 5, v1
  v_and_b32 v6, 31, v1
  v_xor_b32 v6, v6, v5
  v_lshlrev_b32 v6, 4, v6
  v_lshl_add_u32 v6, v5, 13, v6
  s_add_u32 m0, s30, 0
  s_add_u32 s22, s27, 0
  v_xor_b32 v7, 0, v6
  buffer_load_dwordx4 v7, s[56:59], s22 offen offset:0 lds
  s_add_u32 s22, s27, 15360
  v_xor_b32 v7, 32, v6
  buffer_load_dwordx4 v7, s[56:59], s22 offen offset:1024 lds
  s_add_u32 s22, s27, 30720
  v_xor_b32 v7, 64, v6
  buffer_load_dwordx4 v7, s[56:59], s22 offen offset:2048 lds
  s_add_u32 s22, s27, 46080
  v_xor_b32 v7, 96, v6
  buffer_load_dwordx4 v7, s[56:59], s22 offen offset:3072 lds
  s_add_u32 m0, s30, 4096
  s_add_u32 s22, s27, 65536
  v_xor_b32 v7, 128, v6
  buffer_load_dwordx4 v7, s[56:59], s22 offen offset:0 lds
  s_add_u32 s22, s27, 80896
  v_xor_b32 v7, 160, v6
  buffer_load_dwordx4 v7, s[56:59], s22 offen offset:1024 lds
  s_add_u32 s22, s27, 96256
  v_xor_b32 v7, 192, v6
  buffer_load_dwordx4 v7, s[56:59], s22 offen offset:2048 lds
  s_add_u32 s22, s27, 111616
  v_xor_b32 v7, 224, v6
  buffer_load_dwordx4 v7, s[56:59], s22 offen offset:3072 lds
  v_lshrrev_b32 v5, 5, v1
  v_and_b32 v6, 31, v1
  s_lshl_b32 s25, s16, 15
  s_add_u32 s25, s25, 32768
  s_lshl_b32 s26, s17, 9
  s_add_u32 s28, s19, s16
  s_cmp_ge_u32 s28, 7
  s_cselect_b32 s20, 7, 0
  s_sub_u32 s28, s28, s20
  s_add_u32 s28, s28, s31
  s_add_u32 s29, s19, s16
  s_add_u32 s29, s29, 4
  s_cmp_ge_u32 s29, 7
  s_cselect_b32 s20, 7, 0
  s_sub_u32 s29, s29, s20
  s_add_u32 s29, s29, s31
  s_lshl_b32 s32, s28, 18
  s_add_u32 s32, s32, s26
  s_lshl_b32 s33, s29, 18
  s_add_u32 s33, s33, s26
  v_xor_b32 v8, v6, v5
  v_lshlrev_b32 v8, 4, v8
  v_lshl_add_u32 v8, v5, 13, v8
  v_xor_b32 v12, 0, v8
  v_xor_b32 v13, 32, v8
  v_add_u32 v13, 15360, v13
  v_xor_b32 v14, 0, v8
  v_add_u32 v14, 30720, v14
  v_xor_b32 v15, 32, v8
  v_add_u32 v15, 46080, v15
  s_add_u32 s20, s16, 0
  s_and_b32 s20, s20, 3
  s_mul_i32 s21, s20, 65600
  s_lshl_b32 s20, s20, 12
  s_add_u32 s48, s20, s25
  s_mov_b32 m0, s48
  v_xor_b32 v16, s21, v12
  buffer_load_dwordx4 v16, s[60:63], s32 offen offset:0 lds
  v_xor_b32 v17, s21, v13
  buffer_load_dwordx4 v17, s[60:63], s32 offen offset:1024 lds
  v_xor_b32 v18, s21, v14
  buffer_load_dwordx4 v18, s[60:63], s32 offen offset:2048 lds
  v_xor_b32 v19, s21, v15
  buffer_load_dwordx4 v19, s[60:63], s32 offen offset:3072 lds
  s_add_u32 s20, s16, 1
  s_and_b32 s20, s20, 3
  s_mul_i32 s21, s20, 65600
  s_lshl_b32 s20, s20, 12
  s_add_u32 s49, s20, s25
  s_mov_b32 m0, s49
  v_xor_b32 v20, s21, v12
  buffer_load_dwordx4 v20, s[60:63], s32 offen offset:0 lds
  v_xor_b32 v21, s21, v13
  buffer_load_dwordx4 v21, s[60:63], s32 offen offset:1024 lds
  v_xor_b32 v22, s21, v14
  buffer_load_dwordx4 v22, s[60:63], s32 offen offset:2048 lds
  v_xor_b32 v23, s21, v15
  buffer_load_dwordx4 v23, s[60:63], s32 offen offset:3072 lds
  s_add_u32 s20, s16, 2
  s_and_b32 s20, s20, 3
  s_mul_i32 s21, s20, 65600
  s_lshl_b32 s20, s20, 12
  s_add_u32 s50, s20, s25
  s_mov_b32 m0, s50
  v_xor_b32 v24, s21, v12
  buffer_load_dwordx4 v24, s[60:63], s32 offen offset:0 lds
  v_xor_b32 v25, s21, v13
  buffer_load_dwordx4 v25, s[60:63], s32 offen offset:1024 lds
  v_xor_b32 v26, s21, v14
  buffer_load_dwordx4 v26, s[60:63], s32 offen offset:2048 lds
  v_xor_b32 v27, s21, v15
  buffer_load_dwordx4 v27, s[60:63], s32 offen offset:3072 lds
  s_add_u32 s20, s16, 3
  s_and_b32 s20, s20, 3
  s_mul_i32 s21, s20, 65600
  s_lshl_b32 s20, s20, 12
  s_add_u32 s51, s20, s25
  s_mov_b32 m0, s51
  v_xor_b32 v28, s21, v12
  buffer_load_dwordx4 v28, s[60:63], s32 offen offset:0 lds
  v_xor_b32 v29, s21, v13
  buffer_load_dwordx4 v29, s[60:63], s32 offen offset:1024 lds
  v_xor_b32 v30, s21, v14
  buffer_load_dwordx4 v30, s[60:63], s32 offen offset:2048 lds
  v_xor_b32 v31, s21, v15
  buffer_load_dwordx4 v31, s[60:63], s32 offen offset:3072 lds
  s_mul_i32 s30, s17, 401408
  s_mul_i32 s20, s19, 57344
  s_add_u32 s30, s30, s20
  v_add_u32 v12, s30, v2
  v_add_u32 v13, 14336, v12
  v_add_u32 v14, 28672, v12
  v_add_u32 v15, 43008, v12
  v_lshrrev_b32 v7, 2, v4
  v_lshlrev_b32 v7, 3, v7
  v_and_b32 v8, 3, v4
  v_add_u32 v7, v7, v8
  v_xor_b32 v10, v3, v4
  v_lshlrev_b32 v10, 4, v10
  v_lshl_add_u32 v10, v7, 9, v10
  v_add_u32 v10, s25, v10
  v_xor_b32 v32, 0, v10
  v_xor_b32 v33, 64, v10
  v_xor_b32 v34, 128, v10
  v_xor_b32 v35, 192, v10
  v_and_b32 v8, 2, v4
  v_lshlrev_b32 v8, 1, v8
  v_and_b32 v9, 1, v4
  v_add_u32 v8, v8, v9
  v_lshrrev_b32 v7, 2, v4
  v_lshl_add_u32 v7, v7, 4, v8
  v_xor_b32 v8, v8, v3
  v_lshlrev_b32 v8, 4, v8
  v_lshl_add_u32 v7, v7, 9, v8
  s_mov_b32 s24, 1035512379
  s_waitcnt vmcnt(16)
  s_barrier
  s_cmp_eq_u32 s16, 3
  s_cbranch_scc1 aj_np0
  s_add_u32 m0, s48, 16384
  s_nop 0
  buffer_load_dwordx4 v16, s[60:63], s33 offen offset:0 lds
  buffer_load_dwordx4 v17, s[60:63], s33 offen offset:1024 lds
  buffer_load_dwordx4 v18, s[60:63], s33 offen offset:2048 lds
  buffer_load_dwordx4 v19, s[60:63], s33 offen offset:3072 lds
aj_np0:
  v_xor_b32 v8, 0, v7
  ds_read_b128 v[128:131], v8 offset:0
  v_xor_b32 v9, 64, v7
  ds_read_b128 v[132:135], v9 offset:0
  v_xor_b32 v10, 128, v7
  ds_read_b128 v[136:139], v10 offset:0
  v_xor_b32 v11, 192, v7
  ds_read_b128 v[140:143], v11 offset:0
  ds_read_b128 v[144:147], v8 offset:256
  ds_read_b128 v[148:151], v9 offset:256
  ds_read_b128 v[152:155], v10 offset:256
  ds_read_b128 v[156:159], v11 offset:256
  s_waitcnt lgkmcnt(4)
  s_cmp_eq_u32 s16, 3
  s_cbranch_scc1 aj_np1
  s_add_u32 m0, s49, 16384
  s_nop 0
  buffer_load_dwordx4 v20, s[60:63], s33 offen offset:0 lds
  buffer_load_dwordx4 v21, s[60:63], s33 offen offset:1024 lds
  buffer_load_dwordx4 v22, s[60:63], s33 offen offset:2048 lds
  buffer_load_dwordx4 v23, s[60:63], s33 offen offset:3072 lds
aj_np1:
  v_xor_b32 v8, 32, v7
  ds_read_b128 v[160:163], v8 offset:1024
  v_xor_b32 v9, 96, v7
  ds_read_b128 v[164:167], v9 offset:1024
  v_xor_b32 v10, 160, v7
  ds_read_b128 v[168:171], v10 offset:1024
  v_xor_b32 v11, 224, v7
  ds_read_b128 v[172:175], v11 offset:1024
  ds_read_b128 v[176:179], v8 offset:1280
  ds_read_b128 v[180:183], v9 offset:1280
  ds_read_b128 v[184:187], v10 offset:1280
  ds_read_b128 v[188:191], v11 offset:1280
  s_waitcnt lgkmcnt(4)
  s_cmp_eq_u32 s16, 3
  s_cbranch_scc1 aj_np2
  s_add_u32 m0, s50, 16384
  s_nop 0
  buffer_load_dwordx4 v24, s[60:63], s33 offen offset:0 lds
  buffer_load_dwordx4 v25, s[60:63], s33 offen offset:1024 lds
  buffer_load_dwordx4 v26, s[60:63], s33 offen offset:2048 lds
  buffer_load_dwordx4 v27, s[60:63], s33 offen offset:3072 lds
aj_np2:
  v_xor_b32 v8, 128, v7
  ds_read_b128 v[192:195], v8 offset:4096
  v_xor_b32 v9, 192, v7
  ds_read_b128 v[196:199], v9 offset:4096
  v_xor_b32 v10, 0, v7
  ds_read_b128 v[200:203], v10 offset:4096
  v_xor_b32 v11, 64, v7
  ds_read_b128 v[204:207], v11 offset:4096
  ds_read_b128 v[208:211], v8 offset:4352
  ds_read_b128 v[212:215], v9 offset:4352
  ds_read_b128 v[216:219], v10 offset:4352
  ds_read_b128 v[220:223], v11 offset:4352
  s_waitcnt lgkmcnt(4)
  s_cmp_eq_u32 s16, 3
  s_cbranch_scc1 aj_np3
  s_add_u32 m0, s51, 16384
  s_nop 0
  buffer_load_dwordx4 v28, s[60:63], s33 offen offset:0 lds
  buffer_load_dwordx4 v29, s[60:63], s33 offen offset:1024 lds
  buffer_load_dwordx4 v30, s[60:63], s33 offen offset:2048 lds
  buffer_load_dwordx4 v31, s[60:63], s33 offen offset:3072 lds
aj_np3:
  v_xor_b32 v8, 160, v7
  ds_read_b128 v[224:227], v8 offset:5120
  v_xor_b32 v9, 224, v7
  ds_read_b128 v[228:231], v9 offset:5120
  v_xor_b32 v10, 32, v7
  ds_read_b128 v[232:235], v10 offset:5120
  v_xor_b32 v11, 96, v7
  ds_read_b128 v[236:239], v11 offset:5120
  ds_read_b128 v[240:243], v8 offset:5376
  ds_read_b128 v[244:247], v9 offset:5376
  ds_read_b128 v[248:251], v10 offset:5376
  ds_read_b128 v[252:255], v11 offset:5376
  s_waitcnt lgkmcnt(4)
  s_waitcnt vmcnt(16) lgkmcnt(0)
  s_cmp_lg_u32 s16, 3
  s_cbranch_scc1 w3_37
  s_waitcnt vmcnt(0)
w3_37:
  ds_read_b128 v[52:55], v32 offset:0
  ds_read_b128 v[56:59], v33 offset:0
  ds_read_b128 v[60:63], v34 offset:0
  ds_read_b128 v[64:67], v35 offset:0
  s_waitcnt lgkmcnt(3)
  v_mfma_f32_16x16x32_bf16 v[96:99], v[52:55], v[128:131], 0
  v_mfma_f32_16x16x32_bf16 v[100:103], v[52:55], v[160:163], 0
  v_mfma_f32_16x16x32_bf16 v[104:107], v[52:55], v[192:195], 0
  v_mfma_f32_16x16x32_bf16 v[108:111], v[52:55], v[224:227], 0
  ds_read_b128 v[52:55], v32 offset:256
  s_waitcnt lgkmcnt(3)
  v_mfma_f32_16x16x32_bf16 v[96:99], v[56:59], v[132:135], v[96:99]
  v_mfma_f32_16x16x32_bf16 v[100:103], v[56:59], v[164:167], v[100:103]
  v_mfma_f32_16x16x32_bf16 v[104:107], v[56:59], v[196:199], v[104:107]
  v_mfma_f32_16x16x32_bf16 v[108:111], v[56:59], v[228:231], v[108:111]
  ds_read_b128 v[56:59], v33 offset:256
  s_waitcnt lgkmcnt(3)
  v_mfma_f32_16x16x32_bf16 v[96:99], v[60:63], v[136:139], v[96:99]
  v_mfma_f32_16x16x32_bf16 v[100:103], v[60:63], v[168:171], v[100:103]
  v_mfma_f32_16x16x32_bf16 v[104:107], v[60:63], v[200:203], v[104:107]
  v_mfma_f32_16x16x32_bf16 v[108:111], v[60:63], v[232:235], v[108:111]
  ds_read_b128 v[60:63], v34 offset:256
  s_waitcnt lgkmcnt(3)
  v_mfma_f32_16x16x32_bf16 v[96:99], v[64:67], v[140:143], v[96:99]
  v_mfma_f32_16x16x32_bf16 v[100:103], v[64:67], v[172:175], v[100:103]
  v_mfma_f32_16x16x32_bf16 v[104:107], v[64:67], v[204:207], v[104:107]
  v_mfma_f32_16x16x32_bf16 v[108:111], v[64:67], v[236:239], v[108:111]
  ds_read_b128 v[64:67], v35 offset:256
  s_waitcnt lgkmcnt(3)
  v_mfma_f32_16x16x32_bf16 v[96:99], v[52:55], v[144:147], v[96:99]
  v_mfma_f32_16x16x32_bf16 v[100:103], v[52:55], v[176:179], v[100:103]
  v_mfma_f32_16x16x32_bf16 v[104:107], v[52:55], v[208:211], v[104:107]
  v_mfma_f32_16x16x32_bf16 v[108:111], v[52:55], v[240:243], v[108:111]
  ds_read_b128 v[52:55], v32 offset:2048
  s_waitcnt lgkmcnt(3)
  v_mfma_f32_16x16x32_bf16 v[96:99], v[56:59], v[148:151], v[96:99]
  v_mfma_f32_16x16x32_bf16 v[100:103], v[56:59], v[180:183], v[100:103]
  v_mfma_f32_16x16x32_bf16 v[104:107], v[56:59], v[212:215], v[104:107]
  v_mfma_f32_16x16x32_bf16 v[108:111], v[56:59], v[244:247], v[108:111]
  ds_read_b128 v[56:59], v33 offset:2048
  s_waitcnt lgkmcnt(3)
  v_mfma_f32_16x16x32_bf16 v[96:99], v[60:63], v[152:155], v[96:99]
  v_mfma_f32_16x16x32_bf16 v[100:103], v[60:63], v[184:187], v[100:103]
  v_mfma_f32_16x16x32_bf16 v[104:107], v[60:63], v[216:219], v[104:107]
  v_mfma_f32_16x16x32_bf16 v[108:111], v[60:63], v[248:251], v[108:111]
  ds_read_b128 v[60:63], v34 offset:2048
  s_waitcnt lgkmcnt(3)
  v_mfma_f32_16x16x32_bf16 v[96:99], v[64:67], v[156:159], v[96:99]
  v_mfma_f32_16x16x32_bf16 v[100:103], v[64:67], v[188:191], v[100:103]
  v_mfma_f32_16x16x32_bf16 v[104:107], v[64:67], v[220:223], v[104:107]
  v_mfma_f32_16x16x32_bf16 v[108:111], v[64:67], v[252:255], v[108:111]
  ds_read_b128 v[64:67], v35 offset:2048
  s_waitcnt lgkmcnt(3)
  v_mfma_f32_16x16x32_bf16 v[112:115], v[52:55], v[128:131], 0
  v_mfma_f32_16x16x32_bf16 v[116:119], v[52:55], v[160:163], 0
  v_mfma_f32_16x16x32_bf16 v[120:123], v[52:55], v[192:195], 0
  v_mfma_f32_16x16x32_bf16 v[124:127], v[52:55], v[224:227], 0
  ds_read_b128 v[52:55], v32 offset:2304
  s_waitcnt lgkmcnt(3)
  v_mfma_f32_16x16x32_bf16 v[112:115], v[56:59], v[132:135], v[112:115]
  v_mfma_f32_16x16x32_bf16 v[116:119], v[56:59], v[164:167], v[116:119]
  v_mfma_f32_16x16x32_bf16 v[120:123], v[56:59], v[196:199], v[120:123]
  v_mfma_f32_16x16x32_bf16 v[124:127], v[56:59], v[228:231], v[124:127]
  ds_read_b128 v[56:59], v33 offset:2304
  s_waitcnt lgkmcnt(3)
  v_mfma_f32_16x16x32_bf16 v[112:115], v[60:63], v[136:139], v[112:115]
  v_mfma_f32_16x16x32_bf16 v[116:119], v[60:63], v[168:171], v[116:119]
  v_mfma_f32_16x16x32_bf16 v[120:123], v[60:63], v[200:203], v[120:123]
  v_mfma_f32_16x16x32_bf16 v[124:127], v[60:63], v[232:235], v[124:127]
  ds_read_b128 v[60:63], v34 offset:2304
  s_waitcnt lgkmcnt(3)
  v_mfma_f32_16x16x32_bf16 v[112:115], v[64:67], v[140:143], v[112:115]
  v_mfma_f32_16x16x32_bf16 v[116:119], v[64:67], v[172:175], v[116:119]
  v_mfma_f32_16x16x32_bf16 v[120:123], v[64:67], v[204:207], v[120:123]
  v_mfma_f32_16x16x32_bf16 v[124:127], v[64:67], v[236:239], v[124:127]
  ds_read_b128 v[64:67], v35 offset:2304
  s_waitcnt lgkmcnt(3)
  v_mfma_f32_16x16x32_bf16 v[112:115], v[52:55], v[144:147], v[112:115]
  v_mfma_f32_16x16x32_bf16 v[116:119], v[52:55], v[176:179], v[116:119]
  v_mfma_f32_16x16x32_bf16 v[120:123], v[52:55], v[208:211], v[120:123]
  v_mfma_f32_16x16x32_bf16 v[124:127], v[52:55], v[240:243], v[124:127]
  s_waitcnt lgkmcnt(2)
  v_mfma_f32_16x16x32_bf16 v[112:115], v[56:59], v[148:151], v[112:115]
  v_mfma_f32_16x16x32_bf16 v[116:119], v[56:59], v[180:183], v[116:119]
  v_mfma_f32_16x16x32_bf16 v[120:123], v[56:59], v[212:215], v[120:123]
  v_mfma_f32_16x16x32_bf16 v[124:127], v[56:59], v[244:247], v[124:127]
  s_waitcnt lgkmcnt(1)
  v_mfma_f32_16x16x32_bf16 v[112:115], v[60:63], v[152:155], v[112:115]
  v_mfma_f32_16x16x32_bf16 v[116:119], v[60:63], v[184:187], v[116:119]
  v_mfma_f32_16x16x32_bf16 v[120:123], v[60:63], v[216:219], v[120:123]
  v_mfma_f32_16x16x32_bf16 v[124:127], v[60:63], v[248:251], v[124:127]
  s_waitcnt lgkmcnt(0)
  v_mfma_f32_16x16x32_bf16 v[112:115], v[64:67], v[156:159], v[112:115]
  v_mfma_f32_16x16x32_bf16 v[116:119], v[64:67], v[188:191], v[116:119]
  v_mfma_f32_16x16x32_bf16 v[120:123], v[64:67], v[220:223], v[120:123]
  v_mfma_f32_16x16x32_bf16 v[124:127], v[64:67], v[252:255], v[124:127]
  s_lshl_b32 s30, s28, 10
  v_mul_f32 v96, s24, v96
  v_mul_f32 v97, s24, v97
  v_mul_f32 v98, s24, v98
  v_mul_f32 v99, s24, v99
  v_cvt_pk_bf16_f32 v68, v96, v97
  v_cvt_pk_bf16_f32 v69, v98, v99
  v_mul_f32 v112, s24, v112
  v_mul_f32 v113, s24, v113
  v_mul_f32 v114, s24, v114
  v_mul_f32 v115, s24, v115
  v_cvt_pk_bf16_f32 v70, v112, v113
  v_cvt_pk_bf16_f32 v71, v114, v115
  buffer_store_dwordx4 v[68:71], v12, s[8:11], s30 offen sc1
  v_mul_f32 v100, s24, v100
  v_mul_f32 v101, s24, v101
  v_mul_f32 v102, s24, v102
  v_mul_f32 v103, s24, v103
  v_cvt_pk_bf16_f32 v72, v100, v101
  v_cvt_pk_bf16_f32 v73, v102, v103
  v_mul_f32 v116, s24, v116
  v_mul_f32 v117, s24, v117
  v_mul_f32 v118, s24, v118
  v_mul_f32 v119, s24, v119
  v_cvt_pk_bf16_f32 v74, v116, v117
  v_cvt_pk_bf16_f32 v75, v118, v119
  buffer_store_dwordx4 v[72:75], v13, s[8:11], s30 offen sc1
  v_mul_f32 v104, s24, v104
  v_mul_f32 v105, s24, v105
  v_mul_f32 v106, s24, v106
  v_mul_f32 v107, s24, v107
  v_cvt_pk_bf16_f32 v76, v104, v105
  v_cvt_pk_bf16_f32 v77, v106, v107
  v_mul_f32 v120, s24, v120
  v_mul_f32 v121, s24, v121
  v_mul_f32 v122, s24, v122
  v_mul_f32 v123, s24, v123
  v_cvt_pk_bf16_f32 v78, v120, v121
  v_cvt_pk_bf16_f32 v79, v122, v123
  buffer_store_dwordx4 v[76:79], v14, s[8:11], s30 offen sc1
  v_mul_f32 v108, s24, v108
  v_mul_f32 v109, s24, v109
  v_mul_f32 v110, s24, v110
  v_mul_f32 v111, s24, v111
  v_cvt_pk_bf16_f32 v80, v108, v109
  v_cvt_pk_bf16_f32 v81, v110, v111
  v_mul_f32 v124, s24, v124
  v_mul_f32 v125, s24, v125
  v_mul_f32 v126, s24, v126
  v_mul_f32 v127, s24, v127
  v_cvt_pk_bf16_f32 v82, v124, v125
  v_cvt_pk_bf16_f32 v83, v126, v127
  buffer_store_dwordx4 v[80:83], v15, s[8:11], s30 offen sc1
  s_cmp_eq_u32 s16, 3
  s_cbranch_scc1 aj_w3
  s_waitcnt vmcnt(4)
  ds_read_b128 v[52:55], v32 offset:16384
  ds_read_b128 v[56:59], v33 offset:16384
  ds_read_b128 v[60:63], v34 offset:16384
  ds_read_b128 v[64:67], v35 offset:16384
  s_waitcnt lgkmcnt(3)
  v_mfma_f32_16x16x32_bf16 v[96:99], v[52:55], v[128:131], 0
  v_mfma_f32_16x16x32_bf16 v[100:103], v[52:55], v[160:163], 0
  v_mfma_f32_16x16x32_bf16 v[104:107], v[52:55], v[192:195], 0
  v_mfma_f32_16x16x32_bf16 v[108:111], v[52:55], v[224:227], 0
  ds_read_b128 v[52:55], v32 offset:16640
  s_waitcnt lgkmcnt(3)
  v_mfma_f32_16x16x32_bf16 v[96:99], v[56:59], v[132:135], v[96:99]
  v_mfma_f32_16x16x32_bf16 v[100:103], v[56:59], v[164:167], v[100:103]
  v_mfma_f32_16x16x32_bf16 v[104:107], v[56:59], v[196:199], v[104:107]
  v_mfma_f32_16x16x32_bf16 v[108:111], v[56:59], v[228:231], v[108:111]
  ds_read_b128 v[56:59], v33 offset:16640
  s_waitcnt lgkmcnt(3)
  v_mfma_f32_16x16x32_bf16 v[96:99], v[60:63], v[136:139], v[96:99]
  v_mfma_f32_16x16x32_bf16 v[100:103], v[60:63], v[168:171], v[100:103]
  v_mfma_f32_16x16x32_bf16 v[104:107], v[60:63], v[200:203], v[104:107]
  v_mfma_f32_16x16x32_bf16 v[108:111], v[60:63], v[232:235], v[108:111]
  ds_read_b128 v[60:63], v34 offset:16640
  s_waitcnt lgkmcnt(3)
  v_mfma_f32_16x16x32_bf16 v[96:99], v[64:67], v[140:143], v[96:99]
  v_mfma_f32_16x16x32_bf16 v[100:103], v[64:67], v[172:175], v[100:103]
  v_mfma_f32_16x16x32_bf16 v[104:107], v[64:67], v[204:207], v[104:107]
  v_mfma_f32_16x16x32_bf16 v[108:111], v[64:67], v[236:239], v[108:111]
  ds_read_b128 v[64:67], v35 offset:16640
  s_waitcnt lgkmcnt(3)
  v_mfma_f32_16x16x32_bf16 v[96:99], v[52:55], v[144:147], v[96:99]
  v_mfma_f32_16x16x32_bf16 v[100:103], v[52:55], v[176:179], v[100:103]
  v_mfma_f32_16x16x32_bf16 v[104:107], v[52:55], v[208:211], v[104:107]
  v_mfma_f32_16x16x32_bf16 v[108:111], v[52:55], v[240:243], v[108:111]
  ds_read_b128 v[52:55], v32 offset:18432
  s_waitcnt lgkmcnt(3)
  v_mfma_f32_16x16x32_bf16 v[96:99], v[56:59], v[148:151], v[96:99]
  v_mfma_f32_16x16x32_bf16 v[100:103], v[56:59], v[180:183], v[100:103]
  v_mfma_f32_16x16x32_bf16 v[104:107], v[56:59], v[212:215], v[104:107]
  v_mfma_f32_16x16x32_bf16 v[108:111], v[56:59], v[244:247], v[108:111]
  ds_read_b128 v[56:59], v33 offset:18432
  s_waitcnt lgkmcnt(3)
  v_mfma_f32_16x16x32_bf16 v[96:99], v[60:63], v[152:155], v[96:99]
  v_mfma_f32_16x16x32_bf16 v[100:103], v[60:63], v[184:187], v[100:103]
  v_mfma_f32_16x16x32_bf16 v[104:107], v[60:63], v[216:219], v[104:107]
  v_mfma_f32_16x16x32_bf16 v[108:111], v[60:63], v[248:251], v[108:111]
  ds_read_b128 v[60:63], v34 offset:18432
  s_waitcnt lgkmcnt(3)
  v_mfma_f32_16x16x32_bf16 v[96:99], v[64:67], v[156:159], v[96:99]
  v_mfma_f32_16x16x32_bf16 v[100:103], v[64:67], v[188:191], v[100:103]
  v_mfma_f32_16x16x32_bf16 v[104:107], v[64:67], v[220:223], v[104:107]
  v_mfma_f32_16x16x32_bf16 v[108:111], v[64:67], v[252:255], v[108:111]
  ds_read_b128 v[64:67], v35 offset:18432
  s_waitcnt lgkmcnt(3)
  v_mfma_f32_16x16x32_bf16 v[112:115], v[52:55], v[128:131], 0
  v_mfma_f32_16x16x32_bf16 v[116:119], v[52:55], v[160:163], 0
  v_mfma_f32_16x16x32_bf16 v[120:123], v[52:55], v[192:195], 0
  v_mfma_f32_16x16x32_bf16 v[124:127], v[52:55], v[224:227], 0
  ds_read_b128 v[52:55], v32 offset:18688
  s_waitcnt lgkmcnt(3)
  v_mfma_f32_16x16x32_bf16 v[112:115], v[56:59], v[132:135], v[112:115]
  v_mfma_f32_16x16x32_bf16 v[116:119], v[56:59], v[164:167], v[116:119]
  v_mfma_f32_16x16x32_bf16 v[120:123], v[56:59], v[196:199], v[120:123]
  v_mfma_f32_16x16x32_bf16 v[124:127], v[56:59], v[228:231], v[124:127]
  ds_read_b128 v[56:59], v33 offset:18688
  s_waitcnt lgkmcnt(3)
  v_mfma_f32_16x16x32_bf16 v[112:115], v[60:63], v[136:139], v[112:115]
  v_mfma_f32_16x16x32_bf16 v[116:119], v[60:63], v[168:171], v[116:119]
  v_mfma_f32_16x16x32_bf16 v[120:123], v[60:63], v[200:203], v[120:123]
  v_mfma_f32_16x16x32_bf16 v[124:127], v[60:63], v[232:235], v[124:127]
  ds_read_b128 v[60:63], v34 offset:18688
  s_waitcnt lgkmcnt(3)
  v_mfma_f32_16x16x32_bf16 v[112:115], v[64:67], v[140:143], v[112:115]
  v_mfma_f32_16x16x32_bf16 v[116:119], v[64:67], v[172:175], v[116:119]
  v_mfma_f32_16x16x32_bf16 v[120:123], v[64:67], v[204:207], v[120:123]
  v_mfma_f32_16x16x32_bf16 v[124:127], v[64:67], v[236:239], v[124:127]
  ds_read_b128 v[64:67], v35 offset:18688
  s_waitcnt lgkmcnt(3)
  v_mfma_f32_16x16x32_bf16 v[112:115], v[52:55], v[144:147], v[112:115]
  v_mfma_f32_16x16x32_bf16 v[116:119], v[52:55], v[176:179], v[116:119]
  v_mfma_f32_16x16x32_bf16 v[120:123], v[52:55], v[208:211], v[120:123]
  v_mfma_f32_16x16x32_bf16 v[124:127], v[52:55], v[240:243], v[124:127]
  s_waitcnt lgkmcnt(2)
  v_mfma_f32_16x16x32_bf16 v[112:115], v[56:59], v[148:151], v[112:115]
  v_mfma_f32_16x16x32_bf16 v[116:119], v[56:59], v[180:183], v[116:119]
  v_mfma_f32_16x16x32_bf16 v[120:123], v[56:59], v[212:215], v[120:123]
  v_mfma_f32_16x16x32_bf16 v[124:127], v[56:59], v[244:247], v[124:127]
  s_waitcnt lgkmcnt(1)
  v_mfma_f32_16x16x32_bf16 v[112:115], v[60:63], v[152:155], v[112:115]
  v_mfma_f32_16x16x32_bf16 v[116:119], v[60:63], v[184:187], v[116:119]
  v_mfma_f32_16x16x32_bf16 v[120:123], v[60:63], v[216:219], v[120:123]
  v_mfma_f32_16x16x32_bf16 v[124:127], v[60:63], v[248:251], v[124:127]
  s_waitcnt lgkmcnt(0)
  v_mfma_f32_16x16x32_bf16 v[112:115], v[64:67], v[156:159], v[112:115]
  v_mfma_f32_16x16x32_bf16 v[116:119], v[64:67], v[188:191], v[116:119]
  v_mfma_f32_16x16x32_bf16 v[120:123], v[64:67], v[220:223], v[120:123]
  v_mfma_f32_16x16x32_bf16 v[124:127], v[64:67], v[252:255], v[124:127]
  s_lshl_b32 s30, s29, 10
  v_mul_f32 v96, s24, v96
  v_mul_f32 v97, s24, v97
  v_mul_f32 v98, s24, v98
  v_mul_f32 v99, s24, v99
  v_cvt_pk_bf16_f32 v68, v96, v97
  v_cvt_pk_bf16_f32 v69, v98, v99
  v_mul_f32 v112, s24, v112
  v_mul_f32 v113, s24, v113
  v_mul_f32 v114, s24, v114
  v_mul_f32 v115, s24, v115
  v_cvt_pk_bf16_f32 v70, v112, v113
  v_cvt_pk_bf16_f32 v71, v114, v115
  buffer_store_dwordx4 v[68:71], v12, s[8:11], s30 offen sc1
  v_mul_f32 v100, s24, v100
  v_mul_f32 v101, s24, v101
  v_mul_f32 v102, s24, v102
  v_mul_f32 v103, s24, v103
  v_cvt_pk_bf16_f32 v72, v100, v101
  v_cvt_pk_bf16_f32 v73, v102, v103
  v_mul_f32 v116, s24, v116
  v_mul_f32 v117, s24, v117
  v_mul_f32 v118, s24, v118
  v_mul_f32 v119, s24, v119
  v_cvt_pk_bf16_f32 v74, v116, v117
  v_cvt_pk_bf16_f32 v75, v118, v119
  buffer_store_dwordx4 v[72:75], v13, s[8:11], s30 offen sc1
  v_mul_f32 v104, s24, v104
  v_mul_f32 v105, s24, v105
  v_mul_f32 v106, s24, v106
  v_mul_f32 v107, s24, v107
  v_cvt_pk_bf16_f32 v76, v104, v105
  v_cvt_pk_bf16_f32 v77, v106, v107
  v_mul_f32 v120, s24, v120
  v_mul_f32 v121, s24, v121
  v_mul_f32 v122, s24, v122
  v_mul_f32 v123, s24, v123
  v_cvt_pk_bf16_f32 v78, v120, v121
  v_cvt_pk_bf16_f32 v79, v122, v123
  buffer_store_dwordx4 v[76:79], v14, s[8:11], s30 offen sc1
  v_mul_f32 v108, s24, v108
  v_mul_f32 v109, s24, v109
  v_mul_f32 v110, s24, v110
  v_mul_f32 v111, s24, v111
  v_cvt_pk_bf16_f32 v80, v108, v109
  v_cvt_pk_bf16_f32 v81, v110, v111
  v_mul_f32 v124, s24, v124
  v_mul_f32 v125, s24, v125
  v_mul_f32 v126, s24, v126
  v_mul_f32 v127, s24, v127
  v_cvt_pk_bf16_f32 v82, v124, v125
  v_cvt_pk_bf16_f32 v83, v126, v127
  buffer_store_dwordx4 v[80:83], v15, s[8:11], s30 offen sc1
aj_w3:
  s_lshl_b32 s28, s17, 7
  s_lshl_b32 s21, s19, 4
  s_add_u32 s28, s28, s21
  s_cmp_lg_u32 s31, 0
  s_cselect_b32 s21, 8, 0
  s_add_u32 s28, s28, s21
  s_add_u32 s28, s28, 88621056
  s_waitcnt vmcnt(0)
  s_barrier
  s_cmp_lg_u32 s16, 0
  s_cbranch_scc1 pub_38
  v_mul_u32_u24 v26, 2048, v1
  v_mov_b32 v24, s88
  v_mov_b32 v25, s89
  s_mov_b64 exec, 1
  buffer_store_dwordx2 v[24:25], v26, s[8:11], s28 offen sc1
  s_mov_b64 exec, -1
pub_38:
  v_mov_b32 v250, 0
  s_branch wk_loop
wk_srv:
  s_sub_u32 s3, s3, 224
  s_and_b32 s18, s3, 15
  s_lshr_b32 s19, s3, 4
  s_and_b32 s19, s19, 1
  s_mul_i32 s20, s18, 401408
  s_mul_i32 s21, s16, 100352
  s_add_u32 s20, s20, s21
  s_add_u32 s20, s20, 6422528
  s_add_u32 s22, s20, 0
  buffer_load_dwordx4 a[0:3], v2, s[8:11], s22 offen offset:0 sc1
  buffer_load_dwordx4 a[4:7], v2, s[8:11], s22 offen offset:1024 sc1
  buffer_load_dwordx4 a[8:11], v2, s[8:11], s22 offen offset:2048 sc1
  buffer_load_dwordx4 a[12:15], v2, s[8:11], s22 offen offset:3072 sc1
  s_add_u32 s22, s20, 4096
  buffer_load_dwordx4 a[16:19], v2, s[8:11], s22 offen offset:0 sc1
  buffer_load_dwordx4 a[20:23], v2, s[8:11], s22 offen offset:1024 sc1
  buffer_load_dwordx4 a[24:27], v2, s[8:11], s22 offen offset:2048 sc1
  buffer_load_dwordx4 a[28:31], v2, s[8:11], s22 offen offset:3072 sc1
  s_add_u32 s22, s20, 8192
  buffer_load_dwordx4 a[32:35], v2, s[8:11], s22 offen offset:0 sc1
  buffer_load_dwordx4 a[36:39], v2, s[8:11], s22 offen offset:1024 sc1
  buffer_load_dwordx4 a[40:43], v2, s[8:11], s22 offen offset:2048 sc1
  buffer_load_dwordx4 a[44:47], v2, s[8:11], s22 offen offset:3072 sc1
  s_add_u32 s22, s20, 12288
  buffer_load_dwordx4 a[48:51], v2, s[8:11], s22 offen offset:0 sc1
  buffer_load_dwordx4 a[52:55], v2, s[8:11], s22 offen offset:1024 sc1
  buffer_load_dwordx4 a[56:59], v2, s[8:11], s22 offen offset:2048 sc1
  buffer_load_dwordx4 a[60:63], v2, s[8:11], s22 offen offset:3072 sc1
  s_add_u32 s22, s20, 16384
  buffer_load_dwordx4 a[64:67], v2, s[8:11], s22 offen offset:0 sc1
  buffer_load_dwordx4 a[68:71], v2, s[8:11], s22 offen offset:1024 sc1
  buffer_load_dwordx4 a[72:75], v2, s[8:11], s22 offen offset:2048 sc1
  buffer_load_dwordx4 a[76:79], v2, s[8:11], s22 offen offset:3072 sc1
  s_add_u32 s22, s20, 20480
  buffer_load_dwordx4 a[80:83], v2, s[8:11], s22 offen offset:0 sc1
  buffer_load_dwordx4 a[84:87], v2, s[8:11], s22 offen offset:1024 sc1
  buffer_load_dwordx4 a[88:91], v2, s[8:11], s22 offen offset:2048 sc1
  buffer_load_dwordx4 a[92:95], v2, s[8:11], s22 offen offset:3072 sc1
  s_add_u32 s22, s20, 24576
  buffer_load_dwordx4 a[96:99], v2, s[8:11], s22 offen offset:0 sc1
  buffer_load_dwordx4 a[100:103], v2, s[8:11], s22 offen offset:1024 sc1
  buffer_load_dwordx4 a[104:107], v2, s[8:11], s22 offen offset:2048 sc1
  buffer_load_dwordx4 a[108:111], v2, s[8:11], s22 offen offset:3072 sc1
  s_add_u32 s22, s20, 28672
  buffer_load_dwordx4 a[112:115], v2, s[8:11], s22 offen offset:0 sc1
  buffer_load_dwordx4 a[116:119], v2, s[8:11], s22 offen offset:1024 sc1
  buffer_load_dwordx4 a[120:123], v2, s[8:11], s22 offen offset:2048 sc1
  buffer_load_dwordx4 a[124:127], v2, s[8:11], s22 offen offset:3072 sc1
  s_waitcnt vmcnt(24)
  s_add_u32 s22, s20, 32768
  buffer_load_dwordx4 a[128:131], v2, s[8:11], s22 offen offset:0 sc1
  buffer_load_dwordx4 a[132:135], v2, s[8:11], s22 offen offset:1024 sc1
  buffer_load_dwordx4 a[136:139], v2, s[8:11], s22 offen offset:2048 sc1
  buffer_load_dwordx4 a[140:143], v2, s[8:11], s22 offen offset:3072 sc1
  s_add_u32 s22, s20, 36864
  buffer_load_dwordx4 a[144:147], v2, s[8:11], s22 offen offset:0 sc1
  buffer_load_dwordx4 a[148:151], v2, s[8:11], s22 offen offset:1024 sc1
  buffer_load_dwordx4 a[152:155], v2, s[8:11], s22 offen offset:2048 sc1
  buffer_load_dwordx4 a[156:159], v2, s[8:11], s22 offen offset:3072 sc1
  s_add_u32 s22, s20, 40960
  buffer_load_dwordx4 a[160:163], v2, s[8:11], s22 offen offset:0 sc1
  buffer_load_dwordx4 a[164:167], v2, s[8:11], s22 offen offset:1024 sc1
  buffer_load_dwordx4 a[168:171], v2, s[8:11], s22 offen offset:2048 sc1
  buffer_load_dwordx4 a[172:175], v2, s[8:11], s22 offen offset:3072 sc1
  s_add_u32 s22, s20, 45056
  buffer_load_dwordx4 a[176:179], v2, s[8:11], s22 offen offset:0 sc1
  buffer_load_dwordx4 a[180:183], v2, s[8:11], s22 offen offset:1024 sc1
  buffer_load_dwordx4 a[184:187], v2, s[8:11], s22 offen offset:2048 sc1
  buffer_load_dwordx4 a[188:191], v2, s[8:11], s22 offen offset:3072 sc1
  s_add_u32 s22, s20, 49152
  buffer_load_dwordx4 a[192:195], v2, s[8:11], s22 offen offset:0 sc1
  buffer_load_dwordx4 a[196:199], v2, s[8:11], s22 offen offset:1024 sc1
  buffer_load_dwordx4 a[200:203], v2, s[8:11], s22 offen offset:2048 sc1
  buffer_load_dwordx4 a[204:207], v2, s[8:11], s22 offen offset:3072 sc1
  s_add_u32 s22, s20, 53248
  buffer_load_dwordx4 a[208:211], v2, s[8:11], s22 offen offset:0 sc1
  buffer_load_dwordx4 a[212:215], v2, s[8:11], s22 offen offset:1024 sc1
  buffer_load_dwordx4 a[216:219], v2, s[8:11], s22 offen offset:2048 sc1
  buffer_load_dwordx4 a[220:223], v2, s[8:11], s22 offen offset:3072 sc1
  s_add_u32 s22, s20, 57344
  buffer_load_dwordx4 a[224:227], v2, s[8:11], s22 offen offset:0 sc1
  buffer_load_dwordx4 a[228:231], v2, s[8:11], s22 offen offset:1024 sc1
  buffer_load_dwordx4 a[232:235], v2, s[8:11], s22 offen offset:2048 sc1
  buffer_load_dwordx4 a[236:239], v2, s[8:11], s22 offen offset:3072 sc1
  s_add_u32 s22, s20, 61440
  buffer_load_dwordx4 a[240:243], v2, s[8:11], s22 offen offset:0 sc1
  buffer_load_dwordx4 a[244:247], v2, s[8:11], s22 offen offset:1024 sc1
  buffer_load_dwordx4 a[248:251], v2, s[8:11], s22 offen offset:2048 sc1
  buffer_load_dwordx4 a[252:255], v2, s[8:11], s22 offen offset:3072 sc1
  s_waitcnt vmcnt(24)
  s_add_u32 s22, s20, 65536
  buffer_load_dwordx4 v[120:123], v2, s[8:11], s22 offen offset:0 sc1
  buffer_load_dwordx4 v[124:127], v2, s[8:11], s22 offen offset:1024 sc1
  buffer_load_dwordx4 v[128:131], v2, s[8:11], s22 offen offset:2048 sc1
  buffer_load_dwordx4 v[132:135], v2, s[8:11], s22 offen offset:3072 sc1
  s_add_u32 s22, s20, 69632
  buffer_load_dwordx4 v[136:139], v2, s[8:11], s22 offen offset:0 sc1
  buffer_load_dwordx4 v[140:143], v2, s[8:11], s22 offen offset:1024 sc1
  buffer_load_dwordx4 v[144:147], v2, s[8:11], s22 offen offset:2048 sc1
  buffer_load_dwordx4 v[148:151], v2, s[8:11], s22 offen offset:3072 sc1
  s_add_u32 s22, s20, 73728
  buffer_load_dwordx4 v[152:155], v2, s[8:11], s22 offen offset:0 sc1
  buffer_load_dwordx4 v[156:159], v2, s[8:11], s22 offen offset:1024 sc1
  buffer_load_dwordx4 v[160:163], v2, s[8:11], s22 offen offset:2048 sc1
  buffer_load_dwordx4 v[164:167], v2, s[8:11], s22 offen offset:3072 sc1
  s_add_u32 s22, s20, 77824
  buffer_load_dwordx4 v[168:171], v2, s[8:11], s22 offen offset:0 sc1
  buffer_load_dwordx4 v[172:175], v2, s[8:11], s22 offen offset:1024 sc1
  buffer_load_dwordx4 v[176:179], v2, s[8:11], s22 offen offset:2048 sc1
  buffer_load_dwordx4 v[180:183], v2, s[8:11], s22 offen offset:3072 sc1
  s_add_u32 s22, s20, 81920
  buffer_load_dwordx4 v[184:187], v2, s[8:11], s22 offen offset:0 sc1
  buffer_load_dwordx4 v[188:191], v2, s[8:11], s22 offen offset:1024 sc1
  buffer_load_dwordx4 v[192:195], v2, s[8:11], s22 offen offset:2048 sc1
  buffer_load_dwordx4 v[196:199], v2, s[8:11], s22 offen offset:3072 sc1
  s_add_u32 s22, s20, 86016
  buffer_load_dwordx4 v[200:203], v2, s[8:11], s22 offen offset:0 sc1
  buffer_load_dwordx4 v[204:207], v2, s[8:11], s22 offen offset:1024 sc1
  buffer_load_dwordx4 v[208:211], v2, s[8:11], s22 offen offset:2048 sc1
  buffer_load_dwordx4 v[212:215], v2, s[8:11], s22 offen offset:3072 sc1
  s_add_u32 s22, s20, 90112
  buffer_load_dwordx4 v[216:219], v2, s[8:11], s22 offen offset:0 sc1
  buffer_load_dwordx4 v[220:223], v2, s[8:11], s22 offen offset:1024 sc1
  buffer_load_dwordx4 v[224:227], v2, s[8:11], s22 offen offset:2048 sc1
  buffer_load_dwordx4 v[228:231], v2, s[8:11], s22 offen offset:3072 sc1
  s_add_u32 s22, s20, 94208
  buffer_load_dwordx4 v[232:235], v2, s[8:11], s22 offen offset:0 sc1
  buffer_load_dwordx4 v[236:239], v2, s[8:11], s22 offen offset:1024 sc1
  buffer_load_dwordx4 v[240:243], v2, s[8:11], s22 offen offset:2048 sc1
  buffer_load_dwordx4 v[244:247], v2, s[8:11], s22 offen offset:3072 sc1
  s_waitcnt vmcnt(24)
  s_add_u32 s22, s20, 98304
  buffer_load_dwordx4 v[248:251], v2, s[8:11], s22 offen offset:0 sc1
  buffer_load_dwordx4 v[252:255], v2, s[8:11], s22 offen offset:1024 sc1
  v_mov_b32 v5, 0x4444
  v_mov_b32 v6, 0xeeee
  v_cmp_lt_u32 vcc, 7, v4
  s_nop 1
  v_cndmask_b32 v5, v5, v6, vcc
  s_lshl_b32 s23, s16, 11
  v_lshrrev_b32 v80, 1, v3
  v_and_b32 v81, 1, v3
  v_add_u32 v82, 0, v80
  v_lshl_add_u32 v82, v82, 4, v4
  v_mul_u32_u24 v83, 2341, v82
  v_lshrrev_b32 v83, 16, v83
  v_mul_u32_u24 v84, 28, v83
  v_sub_u32 v84, v82, v84
  v_lshrrev_b32 v85, 4, v84
  v_and_b32 v84, 15, v84
  v_lshlrev_b32 v86, 10, v85
  v_lshl_add_u32 v86, v83, 8, v86
  v_lshl_add_u32 v86, v84, 4, v86
  v_lshl_add_u32 v86, v81, 3, v86
  v_add_u32 v72, s23, v86
  v_add_u32 v82, 2, v80
  v_lshl_add_u32 v82, v82, 4, v4
  v_mul_u32_u24 v83, 2341, v82
  v_lshrrev_b32 v83, 16, v83
  v_mul_u32_u24 v84, 28, v83
  v_sub_u32 v84, v82, v84
  v_lshrrev_b32 v85, 4, v84
  v_and_b32 v84, 15, v84
  v_lshlrev_b32 v86, 10, v85
  v_lshl_add_u32 v86, v83, 8, v86
  v_lshl_add_u32 v86, v84, 4, v86
  v_lshl_add_u32 v86, v81, 3, v86
  v_add_u32 v73, s23, v86
  v_add_u32 v82, 4, v80
  v_lshl_add_u32 v82, v82, 4, v4
  v_mul_u32_u24 v83, 2341, v82
  v_lshrrev_b32 v83, 16, v83
  v_mul_u32_u24 v84, 28, v83
  v_sub_u32 v84, v82, v84
  v_lshrrev_b32 v85, 4, v84
  v_and_b32 v84, 15, v84
  v_lshlrev_b32 v86, 10, v85
  v_lshl_add_u32 v86, v83, 8, v86
  v_lshl_add_u32 v86, v84, 4, v86
  v_lshl_add_u32 v86, v81, 3, v86
  v_add_u32 v74, s23, v86
  v_mov_b32 v82, 6
  v_lshl_add_u32 v82, v82, 4, v4
  v_mul_u32_u24 v83, 2341, v82
  v_lshrrev_b32 v83, 16, v83
  v_mul_u32_u24 v84, 28, v83
  v_sub_u32 v84, v82, v84
  v_lshrrev_b32 v85, 4, v84
  v_and_b32 v84, 15, v84
  v_lshlrev_b32 v86, 10, v85
  v_lshl_add_u32 v86, v83, 8, v86
  v_lshl_add_u32 v86, v84, 4, v86
  v_lshl_add_u32 v86, v81, 3, v86
  v_add_u32 v75, s23, v86
  v_add_u32 v76, s23, v2
  s_mul_i32 s27, s18, 448
  v_mov_b32 v77, s27
  v_mov_b32 v78, 1
  s_mov_b32 s17, s19
  s_mul_i32 s24, s19, 7168
  s_add_u32 s24, s24, 88068096
  s_mul_i32 s25, s18, 65
  s_add_u32 s25, s25, s19
  s_lshl_b32 s25, s25, 13
  s_add_u32 s25, s25, s23
  s_add_u32 s25, s25, 76935168
  s_lshl_b32 s26, s18, 6
  s_add_u32 s26, s26, s19
  s_lshl_b32 s26, s26, 4
  s_lshl_b32 s27, s16, 2
  s_add_u32 s26, s26, s27
  s_add_u32 s26, s26, 88569856
  v_mov_b32 v87, -1
ws_loop:
  v_mov_b32 v36, 0
  v_mov_b32 v37, 0
  v_mov_b32 v38, 0
  v_mov_b32 v39, 0
  v_mov_b32 v40, 0
  v_mov_b32 v41, 0
  v_mov_b32 v42, 0
  v_mov_b32 v43, 0
  v_mov_b32 v44, 0
  v_mov_b32 v45, 0
  v_mov_b32 v46, 0
  v_mov_b32 v47, 0
  v_mov_b32 v48, 0
  v_mov_b32 v49, 0
  v_mov_b32 v50, 0
  v_mov_b32 v51, 0
  v_mov_b32 v52, 0
  v_mov_b32 v53, 0
  v_mov_b32 v54, 0
  v_mov_b32 v55, 0
  v_mov_b32 v56, 0
  v_mov_b32 v57, 0
  v_mov_b32 v58, 0
  v_mov_b32 v59, 0
  v_mov_b32 v60, 0
  v_mov_b32 v61, 0
  v_mov_b32 v62, 0
  v_mov_b32 v63, 0
  s_mov_b32 s30, 0
  v_cmp_eq_u32 vcc, -1, v87
  s_cbranch_vccz ws_fl
ws_pm:
  s_cmp_ge_u32 s17, 61
  s_cbranch_scc1 mp_39a
  v_mov_b32 v79, 0
  s_mov_b64 exec, 1
  buffer_atomic_or v79, v77, s[8:11], s24 offen sc0
  s_mov_b64 exec, -1
  s_branch mp_39b
mp_39a:
  buffer_load_dword v79, v77, s[8:11], s24 offen sc1
mp_39b:
  s_waitcnt vmcnt(0)
  v_cmp_eq_u32 vcc, -1, v79
  s_cbranch_vccnz ws_pr
ws_fl:
  s_add_u32 s22, s24, 4096
  buffer_load_dwordx4 v[8:11], v2, s[8:11], s24 offen offset:0 sc1
  buffer_load_dwordx4 v[12:15], v2, s[8:11], s24 offen offset:1024 sc1
  buffer_load_dwordx4 v[16:19], v2, s[8:11], s24 offen offset:2048 sc1
  buffer_load_dwordx4 v[20:23], v2, s[8:11], s24 offen offset:3072 sc1
  buffer_load_dwordx4 v[24:27], v2, s[8:11], s22 offen offset:0 sc1
  buffer_load_dwordx4 v[28:31], v2, s[8:11], s22 offen offset:1024 sc1
  buffer_load_dwordx4 v[32:35], v2, s[8:11], s22 offen offset:2048 sc1
  s_waitcnt vmcnt(0)
  v_max_u32 v79, v8, v9
  v_max3_u32 v79, v79, v10, v11
  v_max3_u32 v79, v79, v12, v13
  v_max3_u32 v79, v79, v14, v15
  v_max3_u32 v79, v79, v16, v17
  v_max3_u32 v79, v79, v18, v19
  v_max3_u32 v79, v79, v20, v21
  v_max3_u32 v79, v79, v22, v23
  v_max3_u32 v79, v79, v24, v25
  v_max3_u32 v79, v79, v26, v27
  v_max3_u32 v79, v79, v28, v29
  v_max3_u32 v79, v79, v30, v31
  v_max3_u32 v79, v79, v32, v33
  v_max3_u32 v79, v79, v34, v35
  v_cmp_eq_u32 vcc, -1, v79
  s_cbranch_vccz ws_pk
ws_pr:
  s_sleep 1
  s_cmp_ge_u32 s17, 61
  s_cbranch_scc1 ws_sh
  s_sleep 6
ws_sh:
  s_add_u32 s30, s30, 1
  s_cmp_lt_u32 s30, 30000
  s_cbranch_scc1 ws_pm
  s_branch cA_abort
ws_pk:
  s_cmp_ge_u32 s17, 62
  s_cbranch_scc1 ws_na
  s_add_u32 s22, s24, 14336
  s_cmp_ge_u32 s17, 61
  s_cbranch_scc1 mp_40a
  v_mov_b32 v87, 0
  s_mov_b64 exec, 1
  buffer_atomic_or v87, v77, s[8:11], s22 offen sc0
  s_mov_b64 exec, -1
  s_branch mp_40b
mp_40a:
  buffer_load_dword v87, v77, s[8:11], s22 offen sc1
mp_40b:
ws_na:
  v_smfmac_f32_16x16x64_bf16 v[36:39], v[8:11], a[0:7], v5
  v_smfmac_f32_16x16x64_bf16 v[36:39], v[12:15], a[8:15], v5
  v_smfmac_f32_16x16x64_bf16 v[36:39], v[16:19], a[16:23], v5
  v_smfmac_f32_16x16x64_bf16 v[36:39], v[20:23], a[24:31], v5
  v_smfmac_f32_16x16x64_bf16 v[36:39], v[24:27], a[32:39], v5
  v_smfmac_f32_16x16x64_bf16 v[36:39], v[28:31], a[40:47], v5
  v_smfmac_f32_16x16x64_bf16 v[36:39], v[32:35], a[48:55], v5
  v_smfmac_f32_16x16x64_bf16 v[40:43], v[8:11], a[56:63], v5
  v_smfmac_f32_16x16x64_bf16 v[40:43], v[12:15], a[64:71], v5
  v_smfmac_f32_16x16x64_bf16 v[40:43], v[16:19], a[72:79], v5
  v_smfmac_f32_16x16x64_bf16 v[40:43], v[20:23], a[80:87], v5
  v_smfmac_f32_16x16x64_bf16 v[40:43], v[24:27], a[88:95], v5
  v_smfmac_f32_16x16x64_bf16 v[40:43], v[28:31], a[96:103], v5
  v_smfmac_f32_16x16x64_bf16 v[40:43], v[32:35], a[104:111], v5
  v_smfmac_f32_16x16x64_bf16 v[44:47], v[8:11], a[112:119], v5
  v_smfmac_f32_16x16x64_bf16 v[44:47], v[12:15], a[120:127], v5
  v_smfmac_f32_16x16x64_bf16 v[44:47], v[16:19], a[128:135], v5
  v_smfmac_f32_16x16x64_bf16 v[44:47], v[20:23], a[136:143], v5
  v_smfmac_f32_16x16x64_bf16 v[44:47], v[24:27], a[144:151], v5
  v_smfmac_f32_16x16x64_bf16 v[44:47], v[28:31], a[152:159], v5
  v_smfmac_f32_16x16x64_bf16 v[44:47], v[32:35], a[160:167], v5
  v_smfmac_f32_16x16x64_bf16 v[48:51], v[8:11], a[168:175], v5
  v_smfmac_f32_16x16x64_bf16 v[48:51], v[12:15], a[176:183], v5
  v_smfmac_f32_16x16x64_bf16 v[48:51], v[16:19], a[184:191], v5
  v_smfmac_f32_16x16x64_bf16 v[48:51], v[20:23], a[192:199], v5
  v_smfmac_f32_16x16x64_bf16 v[48:51], v[24:27], a[200:207], v5
  v_smfmac_f32_16x16x64_bf16 v[48:51], v[28:31], a[208:215], v5
  v_smfmac_f32_16x16x64_bf16 v[48:51], v[32:35], a[216:223], v5
  v_smfmac_f32_16x16x64_bf16 v[52:55], v[8:11], a[224:231], v5
  v_smfmac_f32_16x16x64_bf16 v[52:55], v[12:15], a[232:239], v5
  v_smfmac_f32_16x16x64_bf16 v[52:55], v[16:19], a[240:247], v5
  v_smfmac_f32_16x16x64_bf16 v[52:55], v[20:23], a[248:255], v5
  v_smfmac_f32_16x16x64_bf16 v[52:55], v[24:27], v[120:127], v5
  v_smfmac_f32_16x16x64_bf16 v[52:55], v[28:31], v[128:135], v5
  v_smfmac_f32_16x16x64_bf16 v[52:55], v[32:35], v[136:143], v5
  v_smfmac_f32_16x16x64_bf16 v[56:59], v[8:11], v[144:151], v5
  v_smfmac_f32_16x16x64_bf16 v[56:59], v[12:15], v[152:159], v5
  v_smfmac_f32_16x16x64_bf16 v[56:59], v[16:19], v[160:167], v5
  v_smfmac_f32_16x16x64_bf16 v[56:59], v[20:23], v[168:175], v5
  v_smfmac_f32_16x16x64_bf16 v[56:59], v[24:27], v[176:183], v5
  v_smfmac_f32_16x16x64_bf16 v[56:59], v[28:31], v[184:191], v5
  v_smfmac_f32_16x16x64_bf16 v[56:59], v[32:35], v[192:199], v5
  v_smfmac_f32_16x16x64_bf16 v[60:63], v[8:11], v[200:207], v5
  v_smfmac_f32_16x16x64_bf16 v[60:63], v[12:15], v[208:215], v5
  v_smfmac_f32_16x16x64_bf16 v[60:63], v[16:19], v[216:223], v5
  v_smfmac_f32_16x16x64_bf16 v[60:63], v[20:23], v[224:231], v5
  v_smfmac_f32_16x16x64_bf16 v[60:63], v[24:27], v[232:239], v5
  v_smfmac_f32_16x16x64_bf16 v[60:63], v[28:31], v[240:247], v5
  v_smfmac_f32_16x16x64_bf16 v[60:63], v[32:35], v[248:255], v5
  v_permlane32_swap_b32 v36, v40
  v_permlane32_swap_b32 v37, v41
  v_permlane32_swap_b32 v38, v42
  v_permlane32_swap_b32 v39, v43
  v_add_f32 v36, v36, v40
  v_add_f32 v37, v37, v41
  v_add_f32 v38, v38, v42
  v_add_f32 v39, v39, v43
  v_cvt_pk_bf16_f32 v40, v36, v37
  v_cvt_pk_bf16_f32 v41, v38, v39
  ds_write_b64 v72, v[40:41]
  v_permlane32_swap_b32 v44, v48
  v_permlane32_swap_b32 v45, v49
  v_permlane32_swap_b32 v46, v50
  v_permlane32_swap_b32 v47, v51
  v_add_f32 v44, v44, v48
  v_add_f32 v45, v45, v49
  v_add_f32 v46, v46, v50
  v_add_f32 v47, v47, v51
  v_cvt_pk_bf16_f32 v48, v44, v45
  v_cvt_pk_bf16_f32 v49, v46, v47
  ds_write_b64 v73, v[48:49]
  v_permlane32_swap_b32 v52, v56
  v_permlane32_swap_b32 v53, v57
  v_permlane32_swap_b32 v54, v58
  v_permlane32_swap_b32 v55, v59
  v_add_f32 v52, v52, v56
  v_add_f32 v53, v53, v57
  v_add_f32 v54, v54, v58
  v_add_f32 v55, v55, v59
  v_cvt_pk_bf16_f32 v56, v52, v53
  v_cvt_pk_bf16_f32 v57, v54, v55
  ds_write_b64 v74, v[56:57]
  v_mov_b32 v64, v60
  v_mov_b32 v65, v61
  v_mov_b32 v66, v62
  v_mov_b32 v67, v63
  v_permlane32_swap_b32 v60, v64
  v_permlane32_swap_b32 v61, v65
  v_permlane32_swap_b32 v62, v66
  v_permlane32_swap_b32 v63, v67
  v_add_f32 v60, v60, v64
  v_add_f32 v61, v61, v65
  v_add_f32 v62, v62, v66
  v_add_f32 v63, v63, v67
  v_cvt_pk_bf16_f32 v64, v60, v61
  v_cvt_pk_bf16_f32 v65, v62, v63
  ds_write_b64 v75, v[64:65]
  s_waitcnt lgkmcnt(0)
  ds_read_b128 v[64:67], v76
  ds_read_b128 v[68:71], v76 offset:1024
  s_waitcnt lgkmcnt(0)
  buffer_store_dwordx4 v[64:67], v2, s[8:11], s25 offen sc1
  buffer_store_dwordx4 v[68:71], v2, s[8:11], s25 offen offset:1024 sc1
  s_waitcnt vmcnt(0)
  s_mov_b64 exec, 1
  buffer_store_dword v78, v2, s[8:11], s26 offen sc1
  s_mov_b64 exec, -1
  s_add_u32 s24, s24, 14336
  s_add_u32 s25, s25, 16384
  s_add_u32 s26, s26, 32
  s_add_u32 s17, s17, 2
  s_cmp_lt_u32 s17, 64
  s_cbranch_scc1 ws_loop
  v_mov_b32 v250, 0
  s_branch wk_loop
wk_s4d:
  s_cmp_lg_u32 s16, 0
  s_cbranch_scc1 w0_41
  s_getreg_b32 s20, hwreg(HW_REG_XCC_ID)
  s_sub_u32 s20, s20, 1
  s_and_b32 s20, s20, 7
  s_mov_b64 exec, 1
s4_l:
  s_cmp_ge_u32 s20, 7
  s_cselect_b32 s20, 0, s20
  s_lshl_b32 s21, s20, 7
  s_add_u32 s21, s21, 88586240
  v_mov_b32 v242, 1
  buffer_atomic_add v242, off, s[8:11], s21 sc0
  s_waitcnt vmcnt(0)
  v_readfirstlane_b32 s21, v242
  s_lshl_b32 s22, s20, 4
  s_add_u32 s20, s20, 1
  s_cmp_ge_u32 s21, 16
  s_cbranch_scc1 s4_l
  v_add_u32 v242, s22, v242
  s_mov_b64 exec, -1
w0_41:
  v_mov_b32 v243, 160000
  s_add_u32 s101, s101, 1
  s_barrier
  s_mov_b64 exec, 1
  s_cmp_lg_u32 s16, 0
  s_cbranch_scc1 w0_42
  ds_write_b32 v243, v242 offset:0
  s_waitcnt lgkmcnt(0)
  v_mov_b32 v242, s101
  ds_write_b32 v243, v242 offset:16
  s_waitcnt lgkmcnt(0)
w0_42:
  s_mov_b64 exec, -1
  s_barrier
  ds_read_b32 v242, v243 offset:0
  ds_read_b32 v243, v243 offset:16
  s_waitcnt lgkmcnt(0)
  v_readfirstlane_b32 s3, v242
  v_cmp_ne_u32 vcc, s101, v243
  s_cbranch_vccnz ch_end
  s_load_dwordx8 s[40:47], s[0:1], 0
  s_load_dwordx4 s[48:51], s[0:1], 32
  s_load_dwordx2 s[52:53], s[0:1], 48
  s_load_dwordx2 s[54:55], s[0:1], 112
  v_lshrrev_b32 v1, 6, v0
  s_nop 0
  v_readfirstlane_b32 s16, v1
  v_and_b32 v1, 63, v0
  v_lshrrev_b32 v3, 4, v1
  v_and_b32 v4, 15, v1
  s_mul_i32 s17, s16, 24576
  s_waitcnt lgkmcnt(0)
  s_mov_b32 s60, s40
  s_and_b32 s61, s41, 0xffff
  s_mov_b32 s62, 1835008
  s_mov_b32 s63, 0x20000
  s_mov_b32 s64, s42
  s_and_b32 s65, s43, 0xffff
  s_mov_b32 s66, 229376
  s_mov_b32 s67, 0x20000
  s_mov_b32 s68, s44
  s_and_b32 s69, s45, 0xffff
  s_mov_b32 s70, 229376
  s_mov_b32 s71, 0x20000
  s_mov_b32 s72, s46
  s_and_b32 s73, s47, 0xffff
  s_mov_b32 s74, 229376
  s_mov_b32 s75, 0x20000
  s_mov_b32 s76, s48
  s_and_b32 s77, s49, 0xffff
  s_mov_b32 s78, 229376
  s_mov_b32 s79, 0x20000
  s_mov_b32 s80, s50
  s_and_b32 s81, s51, 0xffff
  s_mov_b32 s82, 896
  s_mov_b32 s83, 0x20000
  s_mov_b32 s84, s52
  s_and_b32 s85, s53, 0xffff
  s_mov_b32 s86, 896
  s_mov_b32 s87, 0x20000
  s_mov_b32 s92, s54
  s_and_b32 s93, s55, 0xffff
  s_mov_b32 s94, 3670016
  s_mov_b32 s95, 0x20000
  v_lshlrev_b32 v5, 5, v1
  v_sub_u32 v5, 2047, v5
  s_add_u32 s18, s17, 13056
  v_subrev_u32 v6, 0, v5
  v_max_i32 v7, 0, v6
  v_cvt_f32_u32 v7, v7
  v_cvt_pk_bf16_f32 v8, v7, v7
  v_and_b32 v7, 0xffff0000, v8
  v_lshrrev_b32 v8, 23, v7
  v_subrev_u32 v8, 134, v8
  v_max_i32 v8, 0, v8
  v_cvt_u32_f32 v7, v7
  v_lshrrev_b32 v7, v8, v7
  v_lshl_add_u32 v7, v8, 8, v7
  v_lshl_add_u32 v200, v7, 2, s18
  v_subrev_u32 v6, 1, v5
  v_max_i32 v7, 0, v6
  v_cvt_f32_u32 v7, v7
  v_cvt_pk_bf16_f32 v8, v7, v7
  v_and_b32 v7, 0xffff0000, v8
  v_lshrrev_b32 v8, 23, v7
  v_subrev_u32 v8, 134, v8
  v_max_i32 v8, 0, v8
  v_cvt_u32_f32 v7, v7
  v_lshrrev_b32 v7, v8, v7
  v_lshl_add_u32 v7, v8, 8, v7
  v_lshl_add_u32 v201, v7, 2, s18
  v_subrev_u32 v6, 2, v5
  v_max_i32 v7, 0, v6
  v_cvt_f32_u32 v7, v7
  v_cvt_pk_bf16_f32 v8, v7, v7
  v_and_b32 v7, 0xffff0000, v8
  v_lshrrev_b32 v8, 23, v7
  v_subrev_u32 v8, 134, v8
  v_max_i32 v8, 0, v8
  v_cvt_u32_f32 v7, v7
  v_lshrrev_b32 v7, v8, v7
  v_lshl_add_u32 v7, v8, 8, v7
  v_lshl_add_u32 v202, v7, 2, s18
  v_subrev_u32 v6, 3, v5
  v_max_i32 v7, 0, v6
  v_cvt_f32_u32 v7, v7
  v_cvt_pk_bf16_f32 v8, v7, v7
  v_and_b32 v7, 0xffff0000, v8
  v_lshrrev_b32 v8, 23, v7
  v_subrev_u32 v8, 134, v8
  v_max_i32 v8, 0, v8
  v_cvt_u32_f32 v7, v7
  v_lshrrev_b32 v7, v8, v7
  v_lshl_add_u32 v7, v8, 8, v7
  v_lshl_add_u32 v203, v7, 2, s18
  v_subrev_u32 v6, 4, v5
  v_max_i32 v7, 0, v6
  v_cvt_f32_u32 v7, v7
  v_cvt_pk_bf16_f32 v8, v7, v7
  v_and_b32 v7, 0xffff0000, v8
  v_lshrrev_b32 v8, 23, v7
  v_subrev_u32 v8, 134, v8
  v_max_i32 v8, 0, v8
  v_cvt_u32_f32 v7, v7
  v_lshrrev_b32 v7, v8, v7
  v_lshl_add_u32 v7, v8, 8, v7
  v_lshl_add_u32 v204, v7, 2, s18
  v_subrev_u32 v6, 5, v5
  v_max_i32 v7, 0, v6
  v_cvt_f32_u32 v7, v7
  v_cvt_pk_bf16_f32 v8, v7, v7
  v_and_b32 v7, 0xffff0000, v8
  v_lshrrev_b32 v8, 23, v7
  v_subrev_u32 v8, 134, v8
  v_max_i32 v8, 0, v8
  v_cvt_u32_f32 v7, v7
  v_lshrrev_b32 v7, v8, v7
  v_lshl_add_u32 v7, v8, 8, v7
  v_lshl_add_u32 v205, v7, 2, s18
  v_subrev_u32 v6, 6, v5
  v_max_i32 v7, 0, v6
  v_cvt_f32_u32 v7, v7
  v_cvt_pk_bf16_f32 v8, v7, v7
  v_and_b32 v7, 0xffff0000, v8
  v_lshrrev_b32 v8, 23, v7
  v_subrev_u32 v8, 134, v8
  v_max_i32 v8, 0, v8
  v_cvt_u32_f32 v7, v7
  v_lshrrev_b32 v7, v8, v7
  v_lshl_add_u32 v7, v8, 8, v7
  v_lshl_add_u32 v206, v7, 2, s18
  v_subrev_u32 v6, 7, v5
  v_max_i32 v7, 0, v6
  v_cvt_f32_u32 v7, v7
  v_cvt_pk_bf16_f32 v8, v7, v7
  v_and_b32 v7, 0xffff0000, v8
  v_lshrrev_b32 v8, 23, v7
  v_subrev_u32 v8, 134, v8
  v_max_i32 v8, 0, v8
  v_cvt_u32_f32 v7, v7
  v_lshrrev_b32 v7, v8, v7
  v_lshl_add_u32 v7, v8, 8, v7
  v_lshl_add_u32 v207, v7, 2, s18
  v_subrev_u32 v6, 8, v5
  v_max_i32 v7, 0, v6
  v_cvt_f32_u32 v7, v7
  v_cvt_pk_bf16_f32 v8, v7, v7
  v_and_b32 v7, 0xffff0000, v8
  v_lshrrev_b32 v8, 23, v7
  v_subrev_u32 v8, 134, v8
  v_max_i32 v8, 0, v8
  v_cvt_u32_f32 v7, v7
  v_lshrrev_b32 v7, v8, v7
  v_lshl_add_u32 v7, v8, 8, v7
  v_lshl_add_u32 v208, v7, 2, s18
  v_subrev_u32 v6, 9, v5
  v_max_i32 v7, 0, v6
  v_cvt_f32_u32 v7, v7
  v_cvt_pk_bf16_f32 v8, v7, v7
  v_and_b32 v7, 0xffff0000, v8
  v_lshrrev_b32 v8, 23, v7
  v_subrev_u32 v8, 134, v8
  v_max_i32 v8, 0, v8
  v_cvt_u32_f32 v7, v7
  v_lshrrev_b32 v7, v8, v7
  v_lshl_add_u32 v7, v8, 8, v7
  v_lshl_add_u32 v209, v7, 2, s18
  v_subrev_u32 v6, 10, v5
  v_max_i32 v7, 0, v6
  v_cvt_f32_u32 v7, v7
  v_cvt_pk_bf16_f32 v8, v7, v7
  v_and_b32 v7, 0xffff0000, v8
  v_lshrrev_b32 v8, 23, v7
  v_subrev_u32 v8, 134, v8
  v_max_i32 v8, 0, v8
  v_cvt_u32_f32 v7, v7
  v_lshrrev_b32 v7, v8, v7
  v_lshl_add_u32 v7, v8, 8, v7
  v_lshl_add_u32 v210, v7, 2, s18
  v_subrev_u32 v6, 11, v5
  v_max_i32 v7, 0, v6
  v_cvt_f32_u32 v7, v7
  v_cvt_pk_bf16_f32 v8, v7, v7
  v_and_b32 v7, 0xffff0000, v8
  v_lshrrev_b32 v8, 23, v7
  v_subrev_u32 v8, 134, v8
  v_max_i32 v8, 0, v8
  v_cvt_u32_f32 v7, v7
  v_lshrrev_b32 v7, v8, v7
  v_lshl_add_u32 v7, v8, 8, v7
  v_lshl_add_u32 v211, v7, 2, s18
  v_subrev_u32 v6, 12, v5
  v_max_i32 v7, 0, v6
  v_cvt_f32_u32 v7, v7
  v_cvt_pk_bf16_f32 v8, v7, v7
  v_and_b32 v7, 0xffff0000, v8
  v_lshrrev_b32 v8, 23, v7
  v_subrev_u32 v8, 134, v8
  v_max_i32 v8, 0, v8
  v_cvt_u32_f32 v7, v7
  v_lshrrev_b32 v7, v8, v7
  v_lshl_add_u32 v7, v8, 8, v7
  v_lshl_add_u32 v212, v7, 2, s18
  v_subrev_u32 v6, 13, v5
  v_max_i32 v7, 0, v6
  v_cvt_f32_u32 v7, v7
  v_cvt_pk_bf16_f32 v8, v7, v7
  v_and_b32 v7, 0xffff0000, v8
  v_lshrrev_b32 v8, 23, v7
  v_subrev_u32 v8, 134, v8
  v_max_i32 v8, 0, v8
  v_cvt_u32_f32 v7, v7
  v_lshrrev_b32 v7, v8, v7
  v_lshl_add_u32 v7, v8, 8, v7
  v_lshl_add_u32 v213, v7, 2, s18
  v_subrev_u32 v6, 14, v5
  v_max_i32 v7, 0, v6
  v_cvt_f32_u32 v7, v7
  v_cvt_pk_bf16_f32 v8, v7, v7
  v_and_b32 v7, 0xffff0000, v8
  v_lshrrev_b32 v8, 23, v7
  v_subrev_u32 v8, 134, v8
  v_max_i32 v8, 0, v8
  v_cvt_u32_f32 v7, v7
  v_lshrrev_b32 v7, v8, v7
  v_lshl_add_u32 v7, v8, 8, v7
  v_lshl_add_u32 v214, v7, 2, s18
  v_subrev_u32 v6, 15, v5
  v_max_i32 v7, 0, v6
  v_cvt_f32_u32 v7, v7
  v_cvt_pk_bf16_f32 v8, v7, v7
  v_and_b32 v7, 0xffff0000, v8
  v_lshrrev_b32 v8, 23, v7
  v_subrev_u32 v8, 134, v8
  v_max_i32 v8, 0, v8
  v_cvt_u32_f32 v7, v7
  v_lshrrev_b32 v7, v8, v7
  v_lshl_add_u32 v7, v8, 8, v7
  v_lshl_add_u32 v215, v7, 2, s18
  v_subrev_u32 v6, 16, v5
  v_max_i32 v7, 0, v6
  v_cvt_f32_u32 v7, v7
  v_cvt_pk_bf16_f32 v8, v7, v7
  v_and_b32 v7, 0xffff0000, v8
  v_lshrrev_b32 v8, 23, v7
  v_subrev_u32 v8, 134, v8
  v_max_i32 v8, 0, v8
  v_cvt_u32_f32 v7, v7
  v_lshrrev_b32 v7, v8, v7
  v_lshl_add_u32 v7, v8, 8, v7
  v_lshl_add_u32 v216, v7, 2, s18
  v_subrev_u32 v6, 17, v5
  v_max_i32 v7, 0, v6
  v_cvt_f32_u32 v7, v7
  v_cvt_pk_bf16_f32 v8, v7, v7
  v_and_b32 v7, 0xffff0000, v8
  v_lshrrev_b32 v8, 23, v7
  v_subrev_u32 v8, 134, v8
  v_max_i32 v8, 0, v8
  v_cvt_u32_f32 v7, v7
  v_lshrrev_b32 v7, v8, v7
  v_lshl_add_u32 v7, v8, 8, v7
  v_lshl_add_u32 v217, v7, 2, s18
  v_subrev_u32 v6, 18, v5
  v_max_i32 v7, 0, v6
  v_cvt_f32_u32 v7, v7
  v_cvt_pk_bf16_f32 v8, v7, v7
  v_and_b32 v7, 0xffff0000, v8
  v_lshrrev_b32 v8, 23, v7
  v_subrev_u32 v8, 134, v8
  v_max_i32 v8, 0, v8
  v_cvt_u32_f32 v7, v7
  v_lshrrev_b32 v7, v8, v7
  v_lshl_add_u32 v7, v8, 8, v7
  v_lshl_add_u32 v218, v7, 2, s18
  v_subrev_u32 v6, 19, v5
  v_max_i32 v7, 0, v6
  v_cvt_f32_u32 v7, v7
  v_cvt_pk_bf16_f32 v8, v7, v7
  v_and_b32 v7, 0xffff0000, v8
  v_lshrrev_b32 v8, 23, v7
  v_subrev_u32 v8, 134, v8
  v_max_i32 v8, 0, v8
  v_cvt_u32_f32 v7, v7
  v_lshrrev_b32 v7, v8, v7
  v_lshl_add_u32 v7, v8, 8, v7
  v_lshl_add_u32 v219, v7, 2, s18
  v_subrev_u32 v6, 20, v5
  v_max_i32 v7, 0, v6
  v_cvt_f32_u32 v7, v7
  v_cvt_pk_bf16_f32 v8, v7, v7
  v_and_b32 v7, 0xffff0000, v8
  v_lshrrev_b32 v8, 23, v7
  v_subrev_u32 v8, 134, v8
  v_max_i32 v8, 0, v8
  v_cvt_u32_f32 v7, v7
  v_lshrrev_b32 v7, v8, v7
  v_lshl_add_u32 v7, v8, 8, v7
  v_lshl_add_u32 v220, v7, 2, s18
  v_subrev_u32 v6, 21, v5
  v_max_i32 v7, 0, v6
  v_cvt_f32_u32 v7, v7
  v_cvt_pk_bf16_f32 v8, v7, v7
  v_and_b32 v7, 0xffff0000, v8
  v_lshrrev_b32 v8, 23, v7
  v_subrev_u32 v8, 134, v8
  v_max_i32 v8, 0, v8
  v_cvt_u32_f32 v7, v7
  v_lshrrev_b32 v7, v8, v7
  v_lshl_add_u32 v7, v8, 8, v7
  v_lshl_add_u32 v221, v7, 2, s18
  v_subrev_u32 v6, 22, v5
  v_max_i32 v7, 0, v6
  v_cvt_f32_u32 v7, v7
  v_cvt_pk_bf16_f32 v8, v7, v7
  v_and_b32 v7, 0xffff0000, v8
  v_lshrrev_b32 v8, 23, v7
  v_subrev_u32 v8, 134, v8
  v_max_i32 v8, 0, v8
  v_cvt_u32_f32 v7, v7
  v_lshrrev_b32 v7, v8, v7
  v_lshl_add_u32 v7, v8, 8, v7
  v_lshl_add_u32 v222, v7, 2, s18
  v_subrev_u32 v6, 23, v5
  v_max_i32 v7, 0, v6
  v_cvt_f32_u32 v7, v7
  v_cvt_pk_bf16_f32 v8, v7, v7
  v_and_b32 v7, 0xffff0000, v8
  v_lshrrev_b32 v8, 23, v7
  v_subrev_u32 v8, 134, v8
  v_max_i32 v8, 0, v8
  v_cvt_u32_f32 v7, v7
  v_lshrrev_b32 v7, v8, v7
  v_lshl_add_u32 v7, v8, 8, v7
  v_lshl_add_u32 v223, v7, 2, s18
  v_subrev_u32 v6, 24, v5
  v_max_i32 v7, 0, v6
  v_cvt_f32_u32 v7, v7
  v_cvt_pk_bf16_f32 v8, v7, v7
  v_and_b32 v7, 0xffff0000, v8
  v_lshrrev_b32 v8, 23, v7
  v_subrev_u32 v8, 134, v8
  v_max_i32 v8, 0, v8
  v_cvt_u32_f32 v7, v7
  v_lshrrev_b32 v7, v8, v7
  v_lshl_add_u32 v7, v8, 8, v7
  v_lshl_add_u32 v224, v7, 2, s18
  v_subrev_u32 v6, 25, v5
  v_max_i32 v7, 0, v6
  v_cvt_f32_u32 v7, v7
  v_cvt_pk_bf16_f32 v8, v7, v7
  v_and_b32 v7, 0xffff0000, v8
  v_lshrrev_b32 v8, 23, v7
  v_subrev_u32 v8, 134, v8
  v_max_i32 v8, 0, v8
  v_cvt_u32_f32 v7, v7
  v_lshrrev_b32 v7, v8, v7
  v_lshl_add_u32 v7, v8, 8, v7
  v_lshl_add_u32 v225, v7, 2, s18
  v_subrev_u32 v6, 26, v5
  v_max_i32 v7, 0, v6
  v_cvt_f32_u32 v7, v7
  v_cvt_pk_bf16_f32 v8, v7, v7
  v_and_b32 v7, 0xffff0000, v8
  v_lshrrev_b32 v8, 23, v7
  v_subrev_u32 v8, 134, v8
  v_max_i32 v8, 0, v8
  v_cvt_u32_f32 v7, v7
  v_lshrrev_b32 v7, v8, v7
  v_lshl_add_u32 v7, v8, 8, v7
  v_lshl_add_u32 v226, v7, 2, s18
  v_subrev_u32 v6, 27, v5
  v_max_i32 v7, 0, v6
  v_cvt_f32_u32 v7, v7
  v_cvt_pk_bf16_f32 v8, v7, v7
  v_and_b32 v7, 0xffff0000, v8
  v_lshrrev_b32 v8, 23, v7
  v_subrev_u32 v8, 134, v8
  v_max_i32 v8, 0, v8
  v_cvt_u32_f32 v7, v7
  v_lshrrev_b32 v7, v8, v7
  v_lshl_add_u32 v7, v8, 8, v7
  v_lshl_add_u32 v227, v7, 2, s18
  v_subrev_u32 v6, 28, v5
  v_max_i32 v7, 0, v6
  v_cvt_f32_u32 v7, v7
  v_cvt_pk_bf16_f32 v8, v7, v7
  v_and_b32 v7, 0xffff0000, v8
  v_lshrrev_b32 v8, 23, v7
  v_subrev_u32 v8, 134, v8
  v_max_i32 v8, 0, v8
  v_cvt_u32_f32 v7, v7
  v_lshrrev_b32 v7, v8, v7
  v_lshl_add_u32 v7, v8, 8, v7
  v_lshl_add_u32 v228, v7, 2, s18
  v_subrev_u32 v6, 29, v5
  v_max_i32 v7, 0, v6
  v_cvt_f32_u32 v7, v7
  v_cvt_pk_bf16_f32 v8, v7, v7
  v_and_b32 v7, 0xffff0000, v8
  v_lshrrev_b32 v8, 23, v7
  v_subrev_u32 v8, 134, v8
  v_max_i32 v8, 0, v8
  v_cvt_u32_f32 v7, v7
  v_lshrrev_b32 v7, v8, v7
  v_lshl_add_u32 v7, v8, 8, v7
  v_lshl_add_u32 v229, v7, 2, s18
  v_subrev_u32 v6, 30, v5
  v_max_i32 v7, 0, v6
  v_cvt_f32_u32 v7, v7
  v_cvt_pk_bf16_f32 v8, v7, v7
  v_and_b32 v7, 0xffff0000, v8
  v_lshrrev_b32 v8, 23, v7
  v_subrev_u32 v8, 134, v8
  v_max_i32 v8, 0, v8
  v_cvt_u32_f32 v7, v7
  v_lshrrev_b32 v7, v8, v7
  v_lshl_add_u32 v7, v8, 8, v7
  v_lshl_add_u32 v230, v7, 2, s18
  v_subrev_u32 v6, 31, v5
  v_max_i32 v7, 0, v6
  v_cvt_f32_u32 v7, v7
  v_cvt_pk_bf16_f32 v8, v7, v7
  v_and_b32 v7, 0xffff0000, v8
  v_lshrrev_b32 v8, 23, v7
  v_subrev_u32 v8, 134, v8
  v_max_i32 v8, 0, v8
  v_cvt_u32_f32 v7, v7
  v_lshrrev_b32 v7, v8, v7
  v_lshl_add_u32 v7, v8, 8, v7
  v_lshl_add_u32 v231, v7, 2, s18
  v_subrev_u32 v6, 32, v5
  v_max_i32 v7, 0, v6
  v_cvt_f32_u32 v7, v7
  v_cvt_pk_bf16_f32 v8, v7, v7
  v_and_b32 v7, 0xffff0000, v8
  v_lshrrev_b32 v8, 23, v7
  v_subrev_u32 v8, 134, v8
  v_max_i32 v8, 0, v8
  v_cvt_u32_f32 v7, v7
  v_lshrrev_b32 v7, v8, v7
  v_lshl_add_u32 v7, v8, 8, v7
  v_mov_b32 v8, 1280
  v_cmp_gt_i32 vcc, 0, v6
  s_nop 1
  v_cndmask_b32 v7, v7, v8, vcc
  v_lshl_add_u32 v232, v7, 2, s18
  v_mov_b32 v8, 0
  v_mov_b32 v9, 0
  v_lshlrev_b32 v5, 3, v1
  v_add_u32 v5, s17, v5
  ds_write_b64 v5, v[8:9]
  v_and_b32 v6, 15, v1
  v_lshlrev_b32 v6, 3, v6
  v_add_u32 v6, s17, v6
  ds_write_b64 v6, v[8:9] offset:8704
  ds_write_b64 v6, v[8:9] offset:12928
  v_mov_b32 v6, s17
  ds_write_b64 v6, v[8:9] offset:18176
  s_lshl_b32 s19, s3, 2
  s_add_u32 s20, s19, s16
  s_lshl_b32 s21, s3, 3
  v_mul_u32_u24 v5, 3584, v0
  v_mul_u32_u24 v141, 1792, v0
  s_lshl_b32 s22, s20, 9
  v_lshlrev_b32 v6, 3, v1
  buffer_load_dwordx2 v[24:25], v6, s[64:67], s22 offen
  buffer_load_dwordx2 v[26:27], v6, s[68:71], s22 offen
  buffer_load_dwordx2 v[28:29], v6, s[72:75], s22 offen
  buffer_load_dwordx2 v[30:31], v6, s[76:79], s22 offen
  s_lshl_b32 s22, s20, 1
  v_mov_b32 v7, 0
  buffer_load_ushort v32, v7, s[80:83], s22 offen
  buffer_load_ushort v33, v7, s[84:87], s22 offen
  s_mov_b32 s24, 0x05040100
  s_mov_b32 s25, 0x07060302
  s_barrier
  s_waitcnt vmcnt(0)
  s_mov_b32 s26, 1069066811
  s_mov_b32 s27, 1042479491
  v_lshlrev_b32 v32, 16, v32
  v_lshlrev_b32 v33, 16, v33
  v_mul_f32 v32, s26, v32
  v_exp_f32 v32, v32
  s_nop 0
  v_cvt_pk_bf16_f32 v34, v32, v32
  v_and_b32 v32, 0xffff0000, v34
  v_lshlrev_b32 v37, 6, v1
  v_add_u32 v37, s17, v37
  v_lshlrev_b32 v40, 16, v24
  v_lshlrev_b32 v41, 16, v26
  v_lshlrev_b32 v42, 16, v28
  v_lshlrev_b32 v43, 16, v30
  v_mul_f32 v40, s26, v40
  v_exp_f32 v40, v40
  s_nop 0
  v_cvt_pk_bf16_f32 v34, v40, v40
  v_and_b32 v40, 0xffff0000, v34
  v_mul_f32 v40, v40, v32
  v_mul_f32 v40, s26, v40
  v_sub_f32 v40, 0, v40
  v_mul_f32 v41, v41, v32
  v_mul_f32 v41, s27, v41
  v_mul_f32 v42, v42, v32
  v_mul_f32 v43, v43, v32
  v_add_f32 v42, v42, v42
  v_add_f32 v43, v43, v43
  ds_write_b128 v37, v[40:43] offset:18240
  v_and_b32 v40, 0xffff0000, v24
  v_and_b32 v41, 0xffff0000, v26
  v_and_b32 v42, 0xffff0000, v28
  v_and_b32 v43, 0xffff0000, v30
  v_mul_f32 v40, s26, v40
  v_exp_f32 v40, v40
  s_nop 0
  v_cvt_pk_bf16_f32 v34, v40, v40
  v_and_b32 v40, 0xffff0000, v34
  v_mul_f32 v40, v40, v32
  v_mul_f32 v40, s26, v40
  v_sub_f32 v40, 0, v40
  v_mul_f32 v41, v41, v32
  v_mul_f32 v41, s27, v41
  v_mul_f32 v42, v42, v32
  v_mul_f32 v43, v43, v32
  v_add_f32 v42, v42, v42
  v_add_f32 v43, v43, v43
  ds_write_b128 v37, v[40:43] offset:18256
  v_lshlrev_b32 v40, 16, v25
  v_lshlrev_b32 v41, 16, v27
  v_lshlrev_b32 v42, 16, v29
  v_lshlrev_b32 v43, 16, v31
  v_mul_f32 v40, s26, v40
  v_exp_f32 v40, v40
  s_nop 0
  v_cvt_pk_bf16_f32 v34, v40, v40
  v_and_b32 v40, 0xffff0000, v34
  v_mul_f32 v40, v40, v32
  v_mul_f32 v40, s26, v40
  v_sub_f32 v40, 0, v40
  v_mul_f32 v41, v41, v32
  v_mul_f32 v41, s27, v41
  v_mul_f32 v42, v42, v32
  v_mul_f32 v43, v43, v32
  v_add_f32 v42, v42, v42
  v_add_f32 v43, v43, v43
  ds_write_b128 v37, v[40:43] offset:18272
  v_and_b32 v40, 0xffff0000, v25
  v_and_b32 v41, 0xffff0000, v27
  v_and_b32 v42, 0xffff0000, v29
  v_and_b32 v43, 0xffff0000, v31
  v_mul_f32 v40, s26, v40
  v_exp_f32 v40, v40
  s_nop 0
  v_cvt_pk_bf16_f32 v34, v40, v40
  v_and_b32 v40, 0xffff0000, v34
  v_mul_f32 v40, v40, v32
  v_mul_f32 v40, s26, v40
  v_sub_f32 v40, 0, v40
  v_mul_f32 v41, v41, v32
  v_mul_f32 v41, s27, v41
  v_mul_f32 v42, v42, v32
  v_mul_f32 v43, v43, v32
  v_add_f32 v42, v42, v42
  v_add_f32 v43, v43, v43
  ds_write_b128 v37, v[40:43] offset:18288
  v_cvt_f32_u32 v44, v4
  v_lshlrev_b32 v45, 4, v4
  v_cvt_f32_u32 v45, v45
  v_lshlrev_b32 v46, 4, v3
  v_add_u32 v46, s17, v46
  v_mov_b32 v48, 0
  v_mov_b32 v49, 0
  v_mov_b32 v50, 0
  v_mov_b32 v51, 0
  v_mov_b32 v52, 0
  v_mov_b32 v53, 0
  v_mov_b32 v54, 0
  v_mov_b32 v55, 0
  v_mov_b32 v56, 0
  v_mov_b32 v57, 0
  v_mov_b32 v58, 0
  v_mov_b32 v59, 0
  v_mov_b32 v60, 0
  v_mov_b32 v61, 0
  v_mov_b32 v62, 0
  v_mov_b32 v63, 0
  v_mov_b32 v64, 0
  v_mov_b32 v65, 0
  v_mov_b32 v66, 0
  v_mov_b32 v67, 0
  s_waitcnt lgkmcnt(0)
  ds_read_b128 v[68:71], v46 offset:18240
  s_add_u32 s22, s21, 0
  buffer_load_dwordx2 v[8:9], v5, s[60:63], s22 offen offset:0
  s_mov_b32 s28, 0
  s_call_b64 s[30:31], wk_kl
  s_mov_b32 s28, 0
  s_call_b64 s[30:31], wk_kl
  s_add_u32 s22, s21, 0
  buffer_load_dwordx2 v[10:11], v5, s[60:63], s22 offen offset:896
  s_mov_b32 s28, 0
  s_call_b64 s[30:31], wk_kl
  s_mov_b32 s28, 0
  s_call_b64 s[30:31], wk_kl
  s_add_u32 s22, s21, 0
  buffer_load_dwordx2 v[12:13], v5, s[60:63], s22 offen offset:1792
  s_mov_b32 s28, 0
  s_call_b64 s[30:31], wk_kl
  s_mov_b32 s28, 0
  s_call_b64 s[30:31], wk_kl
  s_add_u32 s22, s21, 0
  buffer_load_dwordx2 v[14:15], v5, s[60:63], s22 offen offset:2688
  s_mov_b32 s28, 0
  s_call_b64 s[30:31], wk_kl
  s_mov_b32 s28, 0
  s_call_b64 s[30:31], wk_kl
  s_add_u32 s22, s21, 917504
  buffer_load_dwordx2 v[16:17], v5, s[60:63], s22 offen offset:0
  s_mov_b32 s28, 0
  s_call_b64 s[30:31], wk_kl
  s_mov_b32 s28, 0
  s_call_b64 s[30:31], wk_kl
  s_add_u32 s22, s21, 917504
  buffer_load_dwordx2 v[18:19], v5, s[60:63], s22 offen offset:896
  s_mov_b32 s28, 0
  s_call_b64 s[30:31], wk_kl
  s_mov_b32 s28, 0
  s_call_b64 s[30:31], wk_kl
  s_add_u32 s22, s21, 917504
  buffer_load_dwordx2 v[20:21], v5, s[60:63], s22 offen offset:1792
  s_mov_b32 s28, 0
  s_call_b64 s[30:31], wk_kl
  s_mov_b32 s28, 0
  s_call_b64 s[30:31], wk_kl
  s_add_u32 s22, s21, 917504
  buffer_load_dwordx2 v[22:23], v5, s[60:63], s22 offen offset:2688
  s_mov_b32 s28, 0
  s_call_b64 s[30:31], wk_kl
  s_mov_b32 s28, 0
  s_call_b64 s[30:31], wk_kl
  s_branch wk_kd
wk_kl:
  s_waitcnt lgkmcnt(0)
  v_mov_b32 v72, v68
  v_mov_b32 v73, v69
  v_mov_b32 v74, v70
  v_mov_b32 v75, v71
  v_add_u32 v46, 64, v46
  ds_read_b128 v[68:71], v46 offset:18240
  v_mul_f32 v80, v72, v45
  v_mul_f32 v81, v73, v45
  v_exp_f32 v80, v80
  v_fract_f32 v81, v81
  v_cos_f32 v76, v81
  v_sin_f32 v77, v81
  v_mul_f32 v76, v76, v80
  v_mul_f32 v77, v77, v80
  v_mul_f32 v80, v72, v44
  v_mul_f32 v81, v73, v44
  v_exp_f32 v80, v80
  v_fract_f32 v81, v81
  v_cos_f32 v78, v81
  v_sin_f32 v79, v81
  v_mul_f32 v78, v78, v80
  v_mul_f32 v79, v79, v80
  v_mul_f32 v82, v74, v76
  v_mul_f32 v83, v74, v77
  v_fma_f32 v82, -v75, v77, v82
  v_fma_f32 v83, -v75, v76, -v83
  v_mul_f32 v86, v76, v76
  v_mul_f32 v87, v76, v77
  v_fma_f32 v86, -v77, v77, v86
  v_add_f32 v87, v87, v87
  v_mfma_f32_16x16x4_f32 v[48:51], v82, v78, v[48:51]
  v_mul_f32 v88, v78, v78
  v_mul_f32 v89, v78, v79
  v_fma_f32 v88, -v79, v79, v88
  v_add_f32 v89, v89, v89
  v_mfma_f32_16x16x4_f32 v[48:51], v83, v79, v[48:51]
  v_mul_f32 v84, v74, v86
  v_mul_f32 v85, v74, v87
  v_fma_f32 v84, -v75, v87, v84
  v_fma_f32 v85, -v75, v86, -v85
  v_mul_f32 v76, v86, v86
  v_mul_f32 v77, v86, v87
  v_fma_f32 v76, -v87, v87, v76
  v_add_f32 v77, v77, v77
  v_mfma_f32_16x16x4_f32 v[52:55], v84, v88, v[52:55]
  v_mul_f32 v78, v88, v88
  v_mul_f32 v79, v88, v89
  v_fma_f32 v78, -v89, v89, v78
  v_add_f32 v79, v79, v79
  v_mfma_f32_16x16x4_f32 v[52:55], v85, v89, v[52:55]
  v_mul_f32 v82, v74, v76
  v_mul_f32 v83, v74, v77
  v_fma_f32 v82, -v75, v77, v82
  v_fma_f32 v83, -v75, v76, -v83
  v_mul_f32 v86, v76, v76
  v_mul_f32 v87, v76, v77
  v_fma_f32 v86, -v77, v77, v86
  v_add_f32 v87, v87, v87
  v_mfma_f32_16x16x4_f32 v[56:59], v82, v78, v[56:59]
  v_mul_f32 v88, v78, v78
  v_mul_f32 v89, v78, v79
  v_fma_f32 v88, -v79, v79, v88
  v_add_f32 v89, v89, v89
  v_mfma_f32_16x16x4_f32 v[56:59], v83, v79, v[56:59]
  v_mul_f32 v84, v74, v86
  v_mul_f32 v85, v74, v87
  v_fma_f32 v84, -v75, v87, v84
  v_fma_f32 v85, -v75, v86, -v85
  v_mul_f32 v76, v86, v86
  v_mul_f32 v77, v86, v87
  v_fma_f32 v76, -v87, v87, v76
  v_add_f32 v77, v77, v77
  v_mfma_f32_16x16x4_f32 v[60:63], v84, v88, v[60:63]
  v_mfma_f32_16x16x4_f32 v[60:63], v85, v89, v[60:63]
  v_mul_f32 v82, v74, v76
  v_fma_f32 v82, -v75, v77, v82
  s_nop 1
  v_mfma_f32_16x16x4_f32 v[64:67], v82, v88, v[64:67]
  s_add_u32 s28, s28, 1
  s_cmp_lt_u32 s28, 4
  s_cbranch_scc1 wk_kl
  s_setpc_b64 s[30:31]
wk_kd:
  s_nop 15
  s_nop 3
  s_waitcnt vmcnt(0)
  v_lshlrev_b32 v6, 3, v0
  v_perm_b32 v34, v10, v8, s24
  v_perm_b32 v35, v14, v12, s24
  v_add_u32 v36, 512, v6
  ds_write_b64 v36, v[34:35]
  v_perm_b32 v34, v10, v8, s25
  v_perm_b32 v35, v14, v12, s25
  v_add_u32 v36, 25088, v6
  ds_write_b64 v36, v[34:35]
  v_perm_b32 v34, v11, v9, s24
  v_perm_b32 v35, v15, v13, s24
  v_add_u32 v36, 49664, v6
  ds_write_b64 v36, v[34:35]
  v_perm_b32 v34, v11, v9, s25
  v_perm_b32 v35, v15, v13, s25
  v_add_u32 v36, 74240, v6
  ds_write_b64 v36, v[34:35]
  v_perm_b32 v34, v18, v16, s24
  v_perm_b32 v35, v22, v20, s24
  v_add_u32 v36, 2560, v6
  ds_write_b64 v36, v[34:35]
  v_perm_b32 v34, v18, v16, s25
  v_perm_b32 v35, v22, v20, s25
  v_add_u32 v36, 27136, v6
  ds_write_b64 v36, v[34:35]
  v_perm_b32 v34, v19, v17, s24
  v_perm_b32 v35, v23, v21, s24
  v_add_u32 v36, 51712, v6
  ds_write_b64 v36, v[34:35]
  v_perm_b32 v34, v19, v17, s25
  v_perm_b32 v35, v23, v21, s25
  v_add_u32 v36, 76288, v6
  ds_write_b64 v36, v[34:35]
  v_lshlrev_b32 v46, 8, v3
  v_lshl_add_u32 v46, v4, 2, v46
  v_add_u32 v46, s17, v46
  ds_write_b32 v46, v48 offset:13056
  ds_write_b32 v46, v49 offset:13120
  ds_write_b32 v46, v50 offset:13184
  ds_write_b32 v46, v51 offset:13248
  s_waitcnt lgkmcnt(8)
  ds_write_b32 v46, v52 offset:14080
  ds_write_b32 v46, v53 offset:14144
  ds_write_b32 v46, v54 offset:14208
  ds_write_b32 v46, v55 offset:14272
  s_waitcnt lgkmcnt(8)
  ds_write_b32 v46, v56 offset:15104
  ds_write_b32 v46, v57 offset:15168
  ds_write_b32 v46, v58 offset:15232
  ds_write_b32 v46, v59 offset:15296
  s_waitcnt lgkmcnt(8)
  ds_write_b32 v46, v60 offset:16128
  ds_write_b32 v46, v61 offset:16192
  ds_write_b32 v46, v62 offset:16256
  ds_write_b32 v46, v63 offset:16320
  s_waitcnt lgkmcnt(8)
  ds_write_b32 v46, v64 offset:17152
  ds_write_b32 v46, v65 offset:17216
  ds_write_b32 v46, v66 offset:17280
  ds_write_b32 v46, v67 offset:17344
  s_waitcnt lgkmcnt(8)
  s_waitcnt lgkmcnt(0)
  ds_read_b32 v48, v200
  ds_read_b32 v49, v201
  ds_read_b32 v50, v202
  ds_read_b32 v51, v203
  ds_read_b32 v52, v204
  ds_read_b32 v53, v205
  ds_read_b32 v54, v206
  ds_read_b32 v55, v207
  s_waitcnt lgkmcnt(4)
  ds_read_b32 v56, v208
  ds_read_b32 v57, v209
  ds_read_b32 v58, v210
  ds_read_b32 v59, v211
  ds_read_b32 v60, v212
  ds_read_b32 v61, v213
  ds_read_b32 v62, v214
  ds_read_b32 v63, v215
  s_waitcnt lgkmcnt(4)
  ds_read_b32 v64, v216
  ds_read_b32 v65, v217
  ds_read_b32 v66, v218
  ds_read_b32 v67, v219
  ds_read_b32 v68, v220
  ds_read_b32 v69, v221
  ds_read_b32 v70, v222
  ds_read_b32 v71, v223
  s_waitcnt lgkmcnt(4)
  ds_read_b32 v72, v224
  ds_read_b32 v73, v225
  ds_read_b32 v74, v226
  ds_read_b32 v75, v227
  ds_read_b32 v76, v228
  ds_read_b32 v77, v229
  ds_read_b32 v78, v230
  ds_read_b32 v79, v231
  s_waitcnt lgkmcnt(4)
  ds_read_b32 v80, v232
  s_waitcnt lgkmcnt(0)
  v_lshlrev_b32 v46, 6, v1
  v_add_u32 v46, s17, v46
  v_cvt_pk_bf16_f32 v84, v48, v49
  v_cvt_pk_bf16_f32 v88, v49, v50
  v_cvt_pk_bf16_f32 v85, v50, v51
  v_cvt_pk_bf16_f32 v89, v51, v52
  v_cvt_pk_bf16_f32 v86, v52, v53
  v_cvt_pk_bf16_f32 v90, v53, v54
  v_cvt_pk_bf16_f32 v87, v54, v55
  v_cvt_pk_bf16_f32 v91, v55, v56
  ds_write_b128 v46, v[84:87] offset:4608
  ds_write_b128 v46, v[88:91] offset:8832
  s_waitcnt lgkmcnt(0)
  v_cvt_pk_bf16_f32 v84, v56, v57
  v_cvt_pk_bf16_f32 v88, v57, v58
  v_cvt_pk_bf16_f32 v85, v58, v59
  v_cvt_pk_bf16_f32 v89, v59, v60
  v_cvt_pk_bf16_f32 v86, v60, v61
  v_cvt_pk_bf16_f32 v90, v61, v62
  v_cvt_pk_bf16_f32 v87, v62, v63
  v_cvt_pk_bf16_f32 v91, v63, v64
  ds_write_b128 v46, v[84:87] offset:4624
  ds_write_b128 v46, v[88:91] offset:8848
  s_waitcnt lgkmcnt(0)
  v_cvt_pk_bf16_f32 v84, v64, v65
  v_cvt_pk_bf16_f32 v88, v65, v66
  v_cvt_pk_bf16_f32 v85, v66, v67
  v_cvt_pk_bf16_f32 v89, v67, v68
  v_cvt_pk_bf16_f32 v86, v68, v69
  v_cvt_pk_bf16_f32 v90, v69, v70
  v_cvt_pk_bf16_f32 v87, v70, v71
  v_cvt_pk_bf16_f32 v91, v71, v72
  ds_write_b128 v46, v[84:87] offset:4640
  ds_write_b128 v46, v[88:91] offset:8864
  s_waitcnt lgkmcnt(0)
  v_cvt_pk_bf16_f32 v84, v72, v73
  v_cvt_pk_bf16_f32 v88, v73, v74
  v_cvt_pk_bf16_f32 v85, v74, v75
  v_cvt_pk_bf16_f32 v89, v75, v76
  v_cvt_pk_bf16_f32 v86, v76, v77
  v_cvt_pk_bf16_f32 v90, v77, v78
  v_cvt_pk_bf16_f32 v87, v78, v79
  v_cvt_pk_bf16_f32 v91, v79, v80
  ds_write_b128 v46, v[84:87] offset:4656
  ds_write_b128 v46, v[88:91] offset:8880
  s_waitcnt lgkmcnt(0)
  s_barrier
  v_lshrrev_b32 v47, 1, v3
  v_sub_u32 v46, v4, v47
  v_add_u32 v46, 1, v46
  v_lshlrev_b32 v46, 5, v46
  v_and_b32 v48, 1, v3
  v_lshl_add_u32 v46, v48, 4, v46
  v_add_u32 v46, s17, v46
  ds_read_b128 a[0:3], v46 offset:32
  ds_read_b128 a[4:7], v46 offset:96
  ds_read_b128 a[8:11], v46 offset:160
  ds_read_b128 a[12:15], v46 offset:224
  ds_read_b128 a[16:19], v46 offset:288
  ds_read_b128 a[20:23], v46 offset:352
  ds_read_b128 a[24:27], v46 offset:416
  ds_read_b128 a[28:31], v46 offset:480
  s_waitcnt lgkmcnt(4)
  ds_read_b128 a[32:35], v46 offset:544
  ds_read_b128 a[36:39], v46 offset:608
  ds_read_b128 a[40:43], v46 offset:672
  ds_read_b128 a[44:47], v46 offset:736
  ds_read_b128 a[48:51], v46 offset:800
  ds_read_b128 a[52:55], v46 offset:864
  ds_read_b128 a[56:59], v46 offset:928
  ds_read_b128 a[60:63], v46 offset:992
  s_waitcnt lgkmcnt(4)
  ds_read_b128 a[64:67], v46 offset:1056
  ds_read_b128 a[68:71], v46 offset:1120
  ds_read_b128 a[72:75], v46 offset:1184
  ds_read_b128 a[76:79], v46 offset:1248
  ds_read_b128 a[80:83], v46 offset:1312
  ds_read_b128 a[84:87], v46 offset:1376
  ds_read_b128 a[88:91], v46 offset:1440
  ds_read_b128 a[92:95], v46 offset:1504
  s_waitcnt lgkmcnt(4)
  ds_read_b128 a[96:99], v46 offset:1568
  ds_read_b128 a[100:103], v46 offset:1632
  ds_read_b128 a[104:107], v46 offset:1696
  ds_read_b128 a[108:111], v46 offset:1760
  ds_read_b128 a[112:115], v46 offset:1824
  ds_read_b128 a[116:119], v46 offset:1888
  ds_read_b128 a[120:123], v46 offset:1952
  ds_read_b128 a[124:127], v46 offset:2016
  s_waitcnt lgkmcnt(4)
  ds_read_b128 a[128:131], v46 offset:2080
  ds_read_b128 a[132:135], v46 offset:2144
  ds_read_b128 a[136:139], v46 offset:2208
  ds_read_b128 a[140:143], v46 offset:2272
  ds_read_b128 a[144:147], v46 offset:2336
  ds_read_b128 a[148:151], v46 offset:2400
  ds_read_b128 a[152:155], v46 offset:2464
  ds_read_b128 a[156:159], v46 offset:2528
  s_waitcnt lgkmcnt(4)
  ds_read_b128 a[160:163], v46 offset:2592
  ds_read_b128 a[164:167], v46 offset:2656
  ds_read_b128 a[168:171], v46 offset:2720
  ds_read_b128 a[172:175], v46 offset:2784
  ds_read_b128 a[176:179], v46 offset:2848
  ds_read_b128 a[180:183], v46 offset:2912
  ds_read_b128 a[184:187], v46 offset:2976
  ds_read_b128 a[188:191], v46 offset:3040
  s_waitcnt lgkmcnt(4)
  ds_read_b128 a[192:195], v46 offset:3104
  ds_read_b128 a[196:199], v46 offset:3168
  ds_read_b128 a[200:203], v46 offset:3232
  ds_read_b128 a[204:207], v46 offset:3296
  ds_read_b128 a[208:211], v46 offset:3360
  ds_read_b128 a[212:215], v46 offset:3424
  ds_read_b128 a[216:219], v46 offset:3488
  ds_read_b128 a[220:223], v46 offset:3552
  s_waitcnt lgkmcnt(4)
  ds_read_b128 a[224:227], v46 offset:3616
  ds_read_b128 a[228:231], v46 offset:3680
  ds_read_b128 a[232:235], v46 offset:3744
  ds_read_b128 a[236:239], v46 offset:3808
  ds_read_b128 a[240:243], v46 offset:3872
  ds_read_b128 a[244:247], v46 offset:3936
  ds_read_b128 a[248:251], v46 offset:4000
  ds_read_b128 a[252:255], v46 offset:4064
  s_waitcnt lgkmcnt(4)
  v_lshlrev_b32 v49, 4, v47
  v_add_u32 v49, v49, v4
  v_sub_u32 v49, 2047, v49
  v_lshl_add_u32 v49, v48, 3, v49
  v_and_b32 v50, 1, v49
  v_lshrrev_b32 v49, 1, v49
  v_lshlrev_b32 v49, 2, v49
  v_mul_u32_u24 v50, 4224, v50
  v_add3_u32 v49, v49, v50, s17
  v_add_u32 v49, 4608, v49
  v_subrev_u32 v52, 896, v49
  v_subrev_u32 v53, 1856, v49
  v_subrev_u32 v54, 2816, v49
  v_subrev_u32 v55, 3776, v49
  v_subrev_u32 v56, 4736, v49
  s_waitcnt lgkmcnt(0)
  ds_read2_b32 v[92:93], v52 offset0:224 offset1:225
  ds_read2_b32 v[94:95], v52 offset0:226 offset1:227
  ds_read2_b32 v[96:97], v52 offset0:208 offset1:209
  ds_read2_b32 v[98:99], v52 offset0:210 offset1:211
  ds_read2_b32 v[100:101], v52 offset0:192 offset1:193
  ds_read2_b32 v[102:103], v52 offset0:194 offset1:195
  ds_read2_b32 v[104:105], v52 offset0:176 offset1:177
  ds_read2_b32 v[106:107], v52 offset0:178 offset1:179
  s_waitcnt lgkmcnt(6)
  v_mfma_f32_16x16x32_bf16 v[60:63], v[92:95], a[28:31], 0
  v_mfma_f32_16x16x32_bf16 v[64:67], v[92:95], a[60:63], 0
  v_mfma_f32_16x16x32_bf16 v[68:71], v[92:95], a[92:95], 0
  v_mfma_f32_16x16x32_bf16 v[72:75], v[92:95], a[124:127], 0
  v_mfma_f32_16x16x32_bf16 v[76:79], v[92:95], a[156:159], 0
  v_mfma_f32_16x16x32_bf16 v[80:83], v[92:95], a[188:191], 0
  v_mfma_f32_16x16x32_bf16 v[84:87], v[92:95], a[220:223], 0
  v_mfma_f32_16x16x32_bf16 v[88:91], v[92:95], a[252:255], 0
  ds_read2_b32 v[92:93], v52 offset0:160 offset1:161
  ds_read2_b32 v[94:95], v52 offset0:162 offset1:163
  s_waitcnt lgkmcnt(6)
  v_mfma_f32_16x16x32_bf16 v[60:63], v[96:99], a[24:27], v[60:63]
  v_mfma_f32_16x16x32_bf16 v[64:67], v[96:99], a[56:59], v[64:67]
  v_mfma_f32_16x16x32_bf16 v[68:71], v[96:99], a[88:91], v[68:71]
  v_mfma_f32_16x16x32_bf16 v[72:75], v[96:99], a[120:123], v[72:75]
  v_mfma_f32_16x16x32_bf16 v[76:79], v[96:99], a[152:155], v[76:79]
  v_mfma_f32_16x16x32_bf16 v[80:83], v[96:99], a[184:187], v[80:83]
  v_mfma_f32_16x16x32_bf16 v[84:87], v[96:99], a[216:219], v[84:87]
  v_mfma_f32_16x16x32_bf16 v[88:91], v[96:99], a[248:251], v[88:91]
  ds_read2_b32 v[96:97], v52 offset0:144 offset1:145
  ds_read2_b32 v[98:99], v52 offset0:146 offset1:147
  s_waitcnt lgkmcnt(6)
  v_mfma_f32_16x16x32_bf16 v[60:63], v[100:103], a[20:23], v[60:63]
  v_mfma_f32_16x16x32_bf16 v[64:67], v[100:103], a[52:55], v[64:67]
  v_mfma_f32_16x16x32_bf16 v[68:71], v[100:103], a[84:87], v[68:71]
  v_mfma_f32_16x16x32_bf16 v[72:75], v[100:103], a[116:119], v[72:75]
  v_mfma_f32_16x16x32_bf16 v[76:79], v[100:103], a[148:151], v[76:79]
  v_mfma_f32_16x16x32_bf16 v[80:83], v[100:103], a[180:183], v[80:83]
  v_mfma_f32_16x16x32_bf16 v[84:87], v[100:103], a[212:215], v[84:87]
  v_mfma_f32_16x16x32_bf16 v[88:91], v[100:103], a[244:247], v[88:91]
  ds_read2_b32 v[100:101], v52 offset0:128 offset1:129
  ds_read2_b32 v[102:103], v52 offset0:130 offset1:131
  s_waitcnt lgkmcnt(6)
  v_mfma_f32_16x16x32_bf16 v[60:63], v[104:107], a[16:19], v[60:63]
  v_mfma_f32_16x16x32_bf16 v[64:67], v[104:107], a[48:51], v[64:67]
  v_mfma_f32_16x16x32_bf16 v[68:71], v[104:107], a[80:83], v[68:71]
  v_mfma_f32_16x16x32_bf16 v[72:75], v[104:107], a[112:115], v[72:75]
  v_mfma_f32_16x16x32_bf16 v[76:79], v[104:107], a[144:147], v[76:79]
  v_mfma_f32_16x16x32_bf16 v[80:83], v[104:107], a[176:179], v[80:83]
  v_mfma_f32_16x16x32_bf16 v[84:87], v[104:107], a[208:211], v[84:87]
  v_mfma_f32_16x16x32_bf16 v[88:91], v[104:107], a[240:243], v[88:91]
  ds_read2_b32 v[104:105], v52 offset0:112 offset1:113
  ds_read2_b32 v[106:107], v52 offset0:114 offset1:115
  s_waitcnt lgkmcnt(6)
  v_mfma_f32_16x16x32_bf16 v[60:63], v[92:95], a[12:15], v[60:63]
  v_mfma_f32_16x16x32_bf16 v[64:67], v[92:95], a[44:47], v[64:67]
  v_mfma_f32_16x16x32_bf16 v[68:71], v[92:95], a[76:79], v[68:71]
  v_mfma_f32_16x16x32_bf16 v[72:75], v[92:95], a[108:111], v[72:75]
  v_mfma_f32_16x16x32_bf16 v[76:79], v[92:95], a[140:143], v[76:79]
  v_mfma_f32_16x16x32_bf16 v[80:83], v[92:95], a[172:175], v[80:83]
  v_mfma_f32_16x16x32_bf16 v[84:87], v[92:95], a[204:207], v[84:87]
  v_mfma_f32_16x16x32_bf16 v[88:91], v[92:95], a[236:239], v[88:91]
  ds_read2_b32 v[92:93], v52 offset0:96 offset1:97
  ds_read2_b32 v[94:95], v52 offset0:98 offset1:99
  s_waitcnt lgkmcnt(6)
  v_mfma_f32_16x16x32_bf16 v[60:63], v[96:99], a[8:11], v[60:63]
  v_mfma_f32_16x16x32_bf16 v[64:67], v[96:99], a[40:43], v[64:67]
  v_mfma_f32_16x16x32_bf16 v[68:71], v[96:99], a[72:75], v[68:71]
  v_mfma_f32_16x16x32_bf16 v[72:75], v[96:99], a[104:107], v[72:75]
  v_mfma_f32_16x16x32_bf16 v[76:79], v[96:99], a[136:139], v[76:79]
  v_mfma_f32_16x16x32_bf16 v[80:83], v[96:99], a[168:171], v[80:83]
  v_mfma_f32_16x16x32_bf16 v[84:87], v[96:99], a[200:203], v[84:87]
  v_mfma_f32_16x16x32_bf16 v[88:91], v[96:99], a[232:235], v[88:91]
  ds_read2_b32 v[96:97], v52 offset0:80 offset1:81
  ds_read2_b32 v[98:99], v52 offset0:82 offset1:83
  s_waitcnt lgkmcnt(6)
  v_mfma_f32_16x16x32_bf16 v[60:63], v[100:103], a[4:7], v[60:63]
  v_mfma_f32_16x16x32_bf16 v[64:67], v[100:103], a[36:39], v[64:67]
  v_mfma_f32_16x16x32_bf16 v[68:71], v[100:103], a[68:71], v[68:71]
  v_mfma_f32_16x16x32_bf16 v[72:75], v[100:103], a[100:103], v[72:75]
  v_mfma_f32_16x16x32_bf16 v[76:79], v[100:103], a[132:135], v[76:79]
  v_mfma_f32_16x16x32_bf16 v[80:83], v[100:103], a[164:167], v[80:83]
  v_mfma_f32_16x16x32_bf16 v[84:87], v[100:103], a[196:199], v[84:87]
  v_mfma_f32_16x16x32_bf16 v[88:91], v[100:103], a[228:231], v[88:91]
  ds_read2_b32 v[100:101], v52 offset0:64 offset1:65
  ds_read2_b32 v[102:103], v52 offset0:66 offset1:67
  s_waitcnt lgkmcnt(6)
  v_mfma_f32_16x16x32_bf16 v[60:63], v[104:107], a[0:3], v[60:63]
  v_mfma_f32_16x16x32_bf16 v[64:67], v[104:107], a[32:35], v[64:67]
  v_mfma_f32_16x16x32_bf16 v[68:71], v[104:107], a[64:67], v[68:71]
  v_mfma_f32_16x16x32_bf16 v[72:75], v[104:107], a[96:99], v[72:75]
  v_mfma_f32_16x16x32_bf16 v[76:79], v[104:107], a[128:131], v[76:79]
  v_mfma_f32_16x16x32_bf16 v[80:83], v[104:107], a[160:163], v[80:83]
  v_mfma_f32_16x16x32_bf16 v[84:87], v[104:107], a[192:195], v[84:87]
  v_mfma_f32_16x16x32_bf16 v[88:91], v[104:107], a[224:227], v[88:91]
  ds_read2_b32 v[104:105], v52 offset0:48 offset1:49
  ds_read2_b32 v[106:107], v52 offset0:50 offset1:51
  s_waitcnt lgkmcnt(6)
  v_mfma_f32_16x16x32_bf16 v[64:67], v[92:95], a[28:31], v[64:67]
  v_mfma_f32_16x16x32_bf16 v[68:71], v[92:95], a[60:63], v[68:71]
  v_mfma_f32_16x16x32_bf16 v[72:75], v[92:95], a[92:95], v[72:75]
  v_mfma_f32_16x16x32_bf16 v[76:79], v[92:95], a[124:127], v[76:79]
  v_mfma_f32_16x16x32_bf16 v[80:83], v[92:95], a[156:159], v[80:83]
  v_mfma_f32_16x16x32_bf16 v[84:87], v[92:95], a[188:191], v[84:87]
  v_mfma_f32_16x16x32_bf16 v[88:91], v[92:95], a[220:223], v[88:91]
  ds_read2_b32 v[92:93], v52 offset0:32 offset1:33
  ds_read2_b32 v[94:95], v52 offset0:34 offset1:35
  s_waitcnt lgkmcnt(6)
  v_mfma_f32_16x16x32_bf16 v[64:67], v[96:99], a[24:27], v[64:67]
  v_mfma_f32_16x16x32_bf16 v[68:71], v[96:99], a[56:59], v[68:71]
  v_mfma_f32_16x16x32_bf16 v[72:75], v[96:99], a[88:91], v[72:75]
  v_mfma_f32_16x16x32_bf16 v[76:79], v[96:99], a[120:123], v[76:79]
  v_mfma_f32_16x16x32_bf16 v[80:83], v[96:99], a[152:155], v[80:83]
  v_mfma_f32_16x16x32_bf16 v[84:87], v[96:99], a[184:187], v[84:87]
  v_mfma_f32_16x16x32_bf16 v[88:91], v[96:99], a[216:219], v[88:91]
  ds_read2_b32 v[96:97], v52 offset0:16 offset1:17
  ds_read2_b32 v[98:99], v52 offset0:18 offset1:19
  s_waitcnt lgkmcnt(6)
  v_mfma_f32_16x16x32_bf16 v[64:67], v[100:103], a[20:23], v[64:67]
  v_mfma_f32_16x16x32_bf16 v[68:71], v[100:103], a[52:55], v[68:71]
  v_mfma_f32_16x16x32_bf16 v[72:75], v[100:103], a[84:87], v[72:75]
  v_mfma_f32_16x16x32_bf16 v[76:79], v[100:103], a[116:119], v[76:79]
  v_mfma_f32_16x16x32_bf16 v[80:83], v[100:103], a[148:151], v[80:83]
  v_mfma_f32_16x16x32_bf16 v[84:87], v[100:103], a[180:183], v[84:87]
  v_mfma_f32_16x16x32_bf16 v[88:91], v[100:103], a[212:215], v[88:91]
  ds_read2_b32 v[100:101], v52 offset0:0 offset1:1
  ds_read2_b32 v[102:103], v52 offset0:2 offset1:3
  s_waitcnt lgkmcnt(6)
  v_mfma_f32_16x16x32_bf16 v[64:67], v[104:107], a[16:19], v[64:67]
  v_mfma_f32_16x16x32_bf16 v[68:71], v[104:107], a[48:51], v[68:71]
  v_mfma_f32_16x16x32_bf16 v[72:75], v[104:107], a[80:83], v[72:75]
  v_mfma_f32_16x16x32_bf16 v[76:79], v[104:107], a[112:115], v[76:79]
  v_mfma_f32_16x16x32_bf16 v[80:83], v[104:107], a[144:147], v[80:83]
  v_mfma_f32_16x16x32_bf16 v[84:87], v[104:107], a[176:179], v[84:87]
  v_mfma_f32_16x16x32_bf16 v[88:91], v[104:107], a[208:211], v[88:91]
  ds_read2_b32 v[104:105], v53 offset0:224 offset1:225
  ds_read2_b32 v[106:107], v53 offset0:226 offset1:227
  s_waitcnt lgkmcnt(6)
  v_mfma_f32_16x16x32_bf16 v[64:67], v[92:95], a[12:15], v[64:67]
  v_mfma_f32_16x16x32_bf16 v[68:71], v[92:95], a[44:47], v[68:71]
  v_mfma_f32_16x16x32_bf16 v[72:75], v[92:95], a[76:79], v[72:75]
  v_mfma_f32_16x16x32_bf16 v[76:79], v[92:95], a[108:111], v[76:79]
  v_mfma_f32_16x16x32_bf16 v[80:83], v[92:95], a[140:143], v[80:83]
  v_mfma_f32_16x16x32_bf16 v[84:87], v[92:95], a[172:175], v[84:87]
  v_mfma_f32_16x16x32_bf16 v[88:91], v[92:95], a[204:207], v[88:91]
  ds_read2_b32 v[92:93], v53 offset0:208 offset1:209
  ds_read2_b32 v[94:95], v53 offset0:210 offset1:211
  s_waitcnt lgkmcnt(6)
  v_mfma_f32_16x16x32_bf16 v[64:67], v[96:99], a[8:11], v[64:67]
  v_mfma_f32_16x16x32_bf16 v[68:71], v[96:99], a[40:43], v[68:71]
  v_mfma_f32_16x16x32_bf16 v[72:75], v[96:99], a[72:75], v[72:75]
  v_mfma_f32_16x16x32_bf16 v[76:79], v[96:99], a[104:107], v[76:79]
  v_mfma_f32_16x16x32_bf16 v[80:83], v[96:99], a[136:139], v[80:83]
  v_mfma_f32_16x16x32_bf16 v[84:87], v[96:99], a[168:171], v[84:87]
  v_mfma_f32_16x16x32_bf16 v[88:91], v[96:99], a[200:203], v[88:91]
  ds_read2_b32 v[96:97], v53 offset0:192 offset1:193
  ds_read2_b32 v[98:99], v53 offset0:194 offset1:195
  s_waitcnt lgkmcnt(6)
  v_mfma_f32_16x16x32_bf16 v[64:67], v[100:103], a[4:7], v[64:67]
  v_mfma_f32_16x16x32_bf16 v[68:71], v[100:103], a[36:39], v[68:71]
  v_mfma_f32_16x16x32_bf16 v[72:75], v[100:103], a[68:71], v[72:75]
  v_mfma_f32_16x16x32_bf16 v[76:79], v[100:103], a[100:103], v[76:79]
  v_mfma_f32_16x16x32_bf16 v[80:83], v[100:103], a[132:135], v[80:83]
  v_mfma_f32_16x16x32_bf16 v[84:87], v[100:103], a[164:167], v[84:87]
  v_mfma_f32_16x16x32_bf16 v[88:91], v[100:103], a[196:199], v[88:91]
  ds_read2_b32 v[100:101], v53 offset0:176 offset1:177
  ds_read2_b32 v[102:103], v53 offset0:178 offset1:179
  s_waitcnt lgkmcnt(6)
  v_mfma_f32_16x16x32_bf16 v[64:67], v[104:107], a[0:3], v[64:67]
  v_mfma_f32_16x16x32_bf16 v[68:71], v[104:107], a[32:35], v[68:71]
  v_mfma_f32_16x16x32_bf16 v[72:75], v[104:107], a[64:67], v[72:75]
  v_mfma_f32_16x16x32_bf16 v[76:79], v[104:107], a[96:99], v[76:79]
  v_mfma_f32_16x16x32_bf16 v[80:83], v[104:107], a[128:131], v[80:83]
  v_mfma_f32_16x16x32_bf16 v[84:87], v[104:107], a[160:163], v[84:87]
  v_mfma_f32_16x16x32_bf16 v[88:91], v[104:107], a[192:195], v[88:91]
  ds_read2_b32 v[104:105], v53 offset0:160 offset1:161
  ds_read2_b32 v[106:107], v53 offset0:162 offset1:163
  s_waitcnt lgkmcnt(6)
  v_mfma_f32_16x16x32_bf16 v[68:71], v[92:95], a[28:31], v[68:71]
  v_mfma_f32_16x16x32_bf16 v[72:75], v[92:95], a[60:63], v[72:75]
  v_mfma_f32_16x16x32_bf16 v[76:79], v[92:95], a[92:95], v[76:79]
  v_mfma_f32_16x16x32_bf16 v[80:83], v[92:95], a[124:127], v[80:83]
  v_mfma_f32_16x16x32_bf16 v[84:87], v[92:95], a[156:159], v[84:87]
  v_mfma_f32_16x16x32_bf16 v[88:91], v[92:95], a[188:191], v[88:91]
  ds_read2_b32 v[92:93], v53 offset0:144 offset1:145
  ds_read2_b32 v[94:95], v53 offset0:146 offset1:147
  s_waitcnt lgkmcnt(6)
  v_mfma_f32_16x16x32_bf16 v[68:71], v[96:99], a[24:27], v[68:71]
  v_mfma_f32_16x16x32_bf16 v[72:75], v[96:99], a[56:59], v[72:75]
  v_mfma_f32_16x16x32_bf16 v[76:79], v[96:99], a[88:91], v[76:79]
  v_mfma_f32_16x16x32_bf16 v[80:83], v[96:99], a[120:123], v[80:83]
  v_mfma_f32_16x16x32_bf16 v[84:87], v[96:99], a[152:155], v[84:87]
  v_mfma_f32_16x16x32_bf16 v[88:91], v[96:99], a[184:187], v[88:91]
  ds_read2_b32 v[96:97], v53 offset0:128 offset1:129
  ds_read2_b32 v[98:99], v53 offset0:130 offset1:131
  s_waitcnt lgkmcnt(6)
  v_mfma_f32_16x16x32_bf16 v[68:71], v[100:103], a[20:23], v[68:71]
  v_mfma_f32_16x16x32_bf16 v[72:75], v[100:103], a[52:55], v[72:75]
  v_mfma_f32_16x16x32_bf16 v[76:79], v[100:103], a[84:87], v[76:79]
  v_mfma_f32_16x16x32_bf16 v[80:83], v[100:103], a[116:119], v[80:83]
  v_mfma_f32_16x16x32_bf16 v[84:87], v[100:103], a[148:151], v[84:87]
  v_mfma_f32_16x16x32_bf16 v[88:91], v[100:103], a[180:183], v[88:91]
  ds_read2_b32 v[100:101], v53 offset0:112 offset1:113
  ds_read2_b32 v[102:103], v53 offset0:114 offset1:115
  s_waitcnt lgkmcnt(6)
  v_mfma_f32_16x16x32_bf16 v[68:71], v[104:107], a[16:19], v[68:71]
  v_mfma_f32_16x16x32_bf16 v[72:75], v[104:107], a[48:51], v[72:75]
  v_mfma_f32_16x16x32_bf16 v[76:79], v[104:107], a[80:83], v[76:79]
  v_mfma_f32_16x16x32_bf16 v[80:83], v[104:107], a[112:115], v[80:83]
  v_mfma_f32_16x16x32_bf16 v[84:87], v[104:107], a[144:147], v[84:87]
  v_mfma_f32_16x16x32_bf16 v[88:91], v[104:107], a[176:179], v[88:91]
  ds_read2_b32 v[104:105], v53 offset0:96 offset1:97
  ds_read2_b32 v[106:107], v53 offset0:98 offset1:99
  s_waitcnt lgkmcnt(6)
  v_mfma_f32_16x16x32_bf16 v[68:71], v[92:95], a[12:15], v[68:71]
  v_mfma_f32_16x16x32_bf16 v[72:75], v[92:95], a[44:47], v[72:75]
  v_mfma_f32_16x16x32_bf16 v[76:79], v[92:95], a[76:79], v[76:79]
  v_mfma_f32_16x16x32_bf16 v[80:83], v[92:95], a[108:111], v[80:83]
  v_mfma_f32_16x16x32_bf16 v[84:87], v[92:95], a[140:143], v[84:87]
  v_mfma_f32_16x16x32_bf16 v[88:91], v[92:95], a[172:175], v[88:91]
  ds_read2_b32 v[92:93], v53 offset0:80 offset1:81
  ds_read2_b32 v[94:95], v53 offset0:82 offset1:83
  s_waitcnt lgkmcnt(6)
  v_mfma_f32_16x16x32_bf16 v[68:71], v[96:99], a[8:11], v[68:71]
  v_mfma_f32_16x16x32_bf16 v[72:75], v[96:99], a[40:43], v[72:75]
  v_mfma_f32_16x16x32_bf16 v[76:79], v[96:99], a[72:75], v[76:79]
  v_mfma_f32_16x16x32_bf16 v[80:83], v[96:99], a[104:107], v[80:83]
  v_mfma_f32_16x16x32_bf16 v[84:87], v[96:99], a[136:139], v[84:87]
  v_mfma_f32_16x16x32_bf16 v[88:91], v[96:99], a[168:171], v[88:91]
  ds_read2_b32 v[96:97], v53 offset0:64 offset1:65
  ds_read2_b32 v[98:99], v53 offset0:66 offset1:67
  s_waitcnt lgkmcnt(6)
  v_mfma_f32_16x16x32_bf16 v[68:71], v[100:103], a[4:7], v[68:71]
  v_mfma_f32_16x16x32_bf16 v[72:75], v[100:103], a[36:39], v[72:75]
  v_mfma_f32_16x16x32_bf16 v[76:79], v[100:103], a[68:71], v[76:79]
  v_mfma_f32_16x16x32_bf16 v[80:83], v[100:103], a[100:103], v[80:83]
  v_mfma_f32_16x16x32_bf16 v[84:87], v[100:103], a[132:135], v[84:87]
  v_mfma_f32_16x16x32_bf16 v[88:91], v[100:103], a[164:167], v[88:91]
  ds_read2_b32 v[100:101], v53 offset0:48 offset1:49
  ds_read2_b32 v[102:103], v53 offset0:50 offset1:51
  s_waitcnt lgkmcnt(6)
  v_mfma_f32_16x16x32_bf16 v[68:71], v[104:107], a[0:3], v[68:71]
  v_mfma_f32_16x16x32_bf16 v[72:75], v[104:107], a[32:35], v[72:75]
  v_mfma_f32_16x16x32_bf16 v[76:79], v[104:107], a[64:67], v[76:79]
  v_mfma_f32_16x16x32_bf16 v[80:83], v[104:107], a[96:99], v[80:83]
  v_mfma_f32_16x16x32_bf16 v[84:87], v[104:107], a[128:131], v[84:87]
  v_mfma_f32_16x16x32_bf16 v[88:91], v[104:107], a[160:163], v[88:91]
  ds_read2_b32 v[104:105], v53 offset0:32 offset1:33
  ds_read2_b32 v[106:107], v53 offset0:34 offset1:35
  s_waitcnt lgkmcnt(6)
  v_mfma_f32_16x16x32_bf16 v[72:75], v[92:95], a[28:31], v[72:75]
  v_mfma_f32_16x16x32_bf16 v[76:79], v[92:95], a[60:63], v[76:79]
  v_mfma_f32_16x16x32_bf16 v[80:83], v[92:95], a[92:95], v[80:83]
  v_mfma_f32_16x16x32_bf16 v[84:87], v[92:95], a[124:127], v[84:87]
  v_mfma_f32_16x16x32_bf16 v[88:91], v[92:95], a[156:159], v[88:91]
  ds_read2_b32 v[92:93], v53 offset0:16 offset1:17
  ds_read2_b32 v[94:95], v53 offset0:18 offset1:19
  s_waitcnt lgkmcnt(6)
  v_mfma_f32_16x16x32_bf16 v[72:75], v[96:99], a[24:27], v[72:75]
  v_mfma_f32_16x16x32_bf16 v[76:79], v[96:99], a[56:59], v[76:79]
  v_mfma_f32_16x16x32_bf16 v[80:83], v[96:99], a[88:91], v[80:83]
  v_mfma_f32_16x16x32_bf16 v[84:87], v[96:99], a[120:123], v[84:87]
  v_mfma_f32_16x16x32_bf16 v[88:91], v[96:99], a[152:155], v[88:91]
  ds_read2_b32 v[96:97], v53 offset0:0 offset1:1
  ds_read2_b32 v[98:99], v53 offset0:2 offset1:3
  s_waitcnt lgkmcnt(6)
  v_mfma_f32_16x16x32_bf16 v[72:75], v[100:103], a[20:23], v[72:75]
  v_mfma_f32_16x16x32_bf16 v[76:79], v[100:103], a[52:55], v[76:79]
  v_mfma_f32_16x16x32_bf16 v[80:83], v[100:103], a[84:87], v[80:83]
  v_mfma_f32_16x16x32_bf16 v[84:87], v[100:103], a[116:119], v[84:87]
  v_mfma_f32_16x16x32_bf16 v[88:91], v[100:103], a[148:151], v[88:91]
  ds_read2_b32 v[100:101], v54 offset0:224 offset1:225
  ds_read2_b32 v[102:103], v54 offset0:226 offset1:227
  s_waitcnt lgkmcnt(6)
  v_mfma_f32_16x16x32_bf16 v[72:75], v[104:107], a[16:19], v[72:75]
  v_mfma_f32_16x16x32_bf16 v[76:79], v[104:107], a[48:51], v[76:79]
  v_mfma_f32_16x16x32_bf16 v[80:83], v[104:107], a[80:83], v[80:83]
  v_mfma_f32_16x16x32_bf16 v[84:87], v[104:107], a[112:115], v[84:87]
  v_mfma_f32_16x16x32_bf16 v[88:91], v[104:107], a[144:147], v[88:91]
  ds_read2_b32 v[104:105], v54 offset0:208 offset1:209
  ds_read2_b32 v[106:107], v54 offset0:210 offset1:211
  s_waitcnt lgkmcnt(6)
  v_mfma_f32_16x16x32_bf16 v[72:75], v[92:95], a[12:15], v[72:75]
  v_mfma_f32_16x16x32_bf16 v[76:79], v[92:95], a[44:47], v[76:79]
  v_mfma_f32_16x16x32_bf16 v[80:83], v[92:95], a[76:79], v[80:83]
  v_mfma_f32_16x16x32_bf16 v[84:87], v[92:95], a[108:111], v[84:87]
  v_mfma_f32_16x16x32_bf16 v[88:91], v[92:95], a[140:143], v[88:91]
  ds_read2_b32 v[92:93], v54 offset0:192 offset1:193
  ds_read2_b32 v[94:95], v54 offset0:194 offset1:195
  s_waitcnt lgkmcnt(6)
  v_mfma_f32_16x16x32_bf16 v[72:75], v[96:99], a[8:11], v[72:75]
  v_mfma_f32_16x16x32_bf16 v[76:79], v[96:99], a[40:43], v[76:79]
  v_mfma_f32_16x16x32_bf16 v[80:83], v[96:99], a[72:75], v[80:83]
  v_mfma_f32_16x16x32_bf16 v[84:87], v[96:99], a[104:107], v[84:87]
  v_mfma_f32_16x16x32_bf16 v[88:91], v[96:99], a[136:139], v[88:91]
  ds_read2_b32 v[96:97], v54 offset0:176 offset1:177
  ds_read2_b32 v[98:99], v54 offset0:178 offset1:179
  s_waitcnt lgkmcnt(6)
  v_mfma_f32_16x16x32_bf16 v[72:75], v[100:103], a[4:7], v[72:75]
  v_mfma_f32_16x16x32_bf16 v[76:79], v[100:103], a[36:39], v[76:79]
  v_mfma_f32_16x16x32_bf16 v[80:83], v[100:103], a[68:71], v[80:83]
  v_mfma_f32_16x16x32_bf16 v[84:87], v[100:103], a[100:103], v[84:87]
  v_mfma_f32_16x16x32_bf16 v[88:91], v[100:103], a[132:135], v[88:91]
  ds_read2_b32 v[100:101], v54 offset0:160 offset1:161
  ds_read2_b32 v[102:103], v54 offset0:162 offset1:163
  s_waitcnt lgkmcnt(6)
  v_mfma_f32_16x16x32_bf16 v[72:75], v[104:107], a[0:3], v[72:75]
  v_mfma_f32_16x16x32_bf16 v[76:79], v[104:107], a[32:35], v[76:79]
  v_mfma_f32_16x16x32_bf16 v[80:83], v[104:107], a[64:67], v[80:83]
  v_mfma_f32_16x16x32_bf16 v[84:87], v[104:107], a[96:99], v[84:87]
  v_mfma_f32_16x16x32_bf16 v[88:91], v[104:107], a[128:131], v[88:91]
  ds_read2_b32 v[104:105], v54 offset0:144 offset1:145
  ds_read2_b32 v[106:107], v54 offset0:146 offset1:147
  s_waitcnt lgkmcnt(6)
  v_mfma_f32_16x16x32_bf16 v[76:79], v[92:95], a[28:31], v[76:79]
  v_mfma_f32_16x16x32_bf16 v[80:83], v[92:95], a[60:63], v[80:83]
  v_mfma_f32_16x16x32_bf16 v[84:87], v[92:95], a[92:95], v[84:87]
  v_mfma_f32_16x16x32_bf16 v[88:91], v[92:95], a[124:127], v[88:91]
  ds_read2_b32 v[92:93], v54 offset0:128 offset1:129
  ds_read2_b32 v[94:95], v54 offset0:130 offset1:131
  s_waitcnt lgkmcnt(6)
  v_mfma_f32_16x16x32_bf16 v[76:79], v[96:99], a[24:27], v[76:79]
  v_mfma_f32_16x16x32_bf16 v[80:83], v[96:99], a[56:59], v[80:83]
  v_mfma_f32_16x16x32_bf16 v[84:87], v[96:99], a[88:91], v[84:87]
  v_mfma_f32_16x16x32_bf16 v[88:91], v[96:99], a[120:123], v[88:91]
  ds_read2_b32 v[96:97], v54 offset0:112 offset1:113
  ds_read2_b32 v[98:99], v54 offset0:114 offset1:115
  s_waitcnt lgkmcnt(6)
  v_mfma_f32_16x16x32_bf16 v[76:79], v[100:103], a[20:23], v[76:79]
  v_mfma_f32_16x16x32_bf16 v[80:83], v[100:103], a[52:55], v[80:83]
  v_mfma_f32_16x16x32_bf16 v[84:87], v[100:103], a[84:87], v[84:87]
  v_mfma_f32_16x16x32_bf16 v[88:91], v[100:103], a[116:119], v[88:91]
  ds_read2_b32 v[100:101], v54 offset0:96 offset1:97
  ds_read2_b32 v[102:103], v54 offset0:98 offset1:99
  s_waitcnt lgkmcnt(6)
  v_mfma_f32_16x16x32_bf16 v[76:79], v[104:107], a[16:19], v[76:79]
  v_mfma_f32_16x16x32_bf16 v[80:83], v[104:107], a[48:51], v[80:83]
  v_mfma_f32_16x16x32_bf16 v[84:87], v[104:107], a[80:83], v[84:87]
  v_mfma_f32_16x16x32_bf16 v[88:91], v[104:107], a[112:115], v[88:91]
  ds_read2_b32 v[104:105], v54 offset0:80 offset1:81
  ds_read2_b32 v[106:107], v54 offset0:82 offset1:83
  s_waitcnt lgkmcnt(6)
  v_mfma_f32_16x16x32_bf16 v[76:79], v[92:95], a[12:15], v[76:79]
  v_mfma_f32_16x16x32_bf16 v[80:83], v[92:95], a[44:47], v[80:83]
  v_mfma_f32_16x16x32_bf16 v[84:87], v[92:95], a[76:79], v[84:87]
  v_mfma_f32_16x16x32_bf16 v[88:91], v[92:95], a[108:111], v[88:91]
  ds_read2_b32 v[92:93], v54 offset0:64 offset1:65
  ds_read2_b32 v[94:95], v54 offset0:66 offset1:67
  s_waitcnt lgkmcnt(6)
  v_mfma_f32_16x16x32_bf16 v[76:79], v[96:99], a[8:11], v[76:79]
  v_mfma_f32_16x16x32_bf16 v[80:83], v[96:99], a[40:43], v[80:83]
  v_mfma_f32_16x16x32_bf16 v[84:87], v[96:99], a[72:75], v[84:87]
  v_mfma_f32_16x16x32_bf16 v[88:91], v[96:99], a[104:107], v[88:91]
  ds_read2_b32 v[96:97], v54 offset0:48 offset1:49
  ds_read2_b32 v[98:99], v54 offset0:50 offset1:51
  s_waitcnt lgkmcnt(6)
  v_mfma_f32_16x16x32_bf16 v[76:79], v[100:103], a[4:7], v[76:79]
  v_mfma_f32_16x16x32_bf16 v[80:83], v[100:103], a[36:39], v[80:83]
  v_mfma_f32_16x16x32_bf16 v[84:87], v[100:103], a[68:71], v[84:87]
  v_mfma_f32_16x16x32_bf16 v[88:91], v[100:103], a[100:103], v[88:91]
  ds_read2_b32 v[100:101], v54 offset0:32 offset1:33
  ds_read2_b32 v[102:103], v54 offset0:34 offset1:35
  s_waitcnt lgkmcnt(6)
  v_mfma_f32_16x16x32_bf16 v[76:79], v[104:107], a[0:3], v[76:79]
  v_mfma_f32_16x16x32_bf16 v[80:83], v[104:107], a[32:35], v[80:83]
  v_mfma_f32_16x16x32_bf16 v[84:87], v[104:107], a[64:67], v[84:87]
  v_mfma_f32_16x16x32_bf16 v[88:91], v[104:107], a[96:99], v[88:91]
  ds_read2_b32 v[104:105], v54 offset0:16 offset1:17
  ds_read2_b32 v[106:107], v54 offset0:18 offset1:19
  s_waitcnt lgkmcnt(6)
  v_mfma_f32_16x16x32_bf16 v[80:83], v[92:95], a[28:31], v[80:83]
  v_mfma_f32_16x16x32_bf16 v[84:87], v[92:95], a[60:63], v[84:87]
  v_mfma_f32_16x16x32_bf16 v[88:91], v[92:95], a[92:95], v[88:91]
  ds_read2_b32 v[92:93], v54 offset0:0 offset1:1
  ds_read2_b32 v[94:95], v54 offset0:2 offset1:3
  s_waitcnt lgkmcnt(6)
  v_mfma_f32_16x16x32_bf16 v[80:83], v[96:99], a[24:27], v[80:83]
  v_mfma_f32_16x16x32_bf16 v[84:87], v[96:99], a[56:59], v[84:87]
  v_mfma_f32_16x16x32_bf16 v[88:91], v[96:99], a[88:91], v[88:91]
  ds_read2_b32 v[96:97], v55 offset0:224 offset1:225
  ds_read2_b32 v[98:99], v55 offset0:226 offset1:227
  s_waitcnt lgkmcnt(6)
  v_mfma_f32_16x16x32_bf16 v[80:83], v[100:103], a[20:23], v[80:83]
  v_mfma_f32_16x16x32_bf16 v[84:87], v[100:103], a[52:55], v[84:87]
  v_mfma_f32_16x16x32_bf16 v[88:91], v[100:103], a[84:87], v[88:91]
  ds_read2_b32 v[100:101], v55 offset0:208 offset1:209
  ds_read2_b32 v[102:103], v55 offset0:210 offset1:211
  s_waitcnt lgkmcnt(6)
  v_mfma_f32_16x16x32_bf16 v[80:83], v[104:107], a[16:19], v[80:83]
  v_mfma_f32_16x16x32_bf16 v[84:87], v[104:107], a[48:51], v[84:87]
  v_mfma_f32_16x16x32_bf16 v[88:91], v[104:107], a[80:83], v[88:91]
  ds_read2_b32 v[104:105], v55 offset0:192 offset1:193
  ds_read2_b32 v[106:107], v55 offset0:194 offset1:195
  s_waitcnt lgkmcnt(6)
  v_mfma_f32_16x16x32_bf16 v[80:83], v[92:95], a[12:15], v[80:83]
  v_mfma_f32_16x16x32_bf16 v[84:87], v[92:95], a[44:47], v[84:87]
  v_mfma_f32_16x16x32_bf16 v[88:91], v[92:95], a[76:79], v[88:91]
  ds_read2_b32 v[92:93], v55 offset0:176 offset1:177
  ds_read2_b32 v[94:95], v55 offset0:178 offset1:179
  s_waitcnt lgkmcnt(6)
  v_mfma_f32_16x16x32_bf16 v[80:83], v[96:99], a[8:11], v[80:83]
  v_mfma_f32_16x16x32_bf16 v[84:87], v[96:99], a[40:43], v[84:87]
  v_mfma_f32_16x16x32_bf16 v[88:91], v[96:99], a[72:75], v[88:91]
  ds_read2_b32 v[96:97], v55 offset0:160 offset1:161
  ds_read2_b32 v[98:99], v55 offset0:162 offset1:163
  s_waitcnt lgkmcnt(6)
  v_mfma_f32_16x16x32_bf16 v[80:83], v[100:103], a[4:7], v[80:83]
  v_mfma_f32_16x16x32_bf16 v[84:87], v[100:103], a[36:39], v[84:87]
  v_mfma_f32_16x16x32_bf16 v[88:91], v[100:103], a[68:71], v[88:91]
  ds_read2_b32 v[100:101], v55 offset0:144 offset1:145
  ds_read2_b32 v[102:103], v55 offset0:146 offset1:147
  s_waitcnt lgkmcnt(6)
  v_mfma_f32_16x16x32_bf16 v[80:83], v[104:107], a[0:3], v[80:83]
  v_mfma_f32_16x16x32_bf16 v[84:87], v[104:107], a[32:35], v[84:87]
  v_mfma_f32_16x16x32_bf16 v[88:91], v[104:107], a[64:67], v[88:91]
  ds_read2_b32 v[104:105], v55 offset0:128 offset1:129
  ds_read2_b32 v[106:107], v55 offset0:130 offset1:131
  s_waitcnt lgkmcnt(6)
  v_mfma_f32_16x16x32_bf16 v[84:87], v[92:95], a[28:31], v[84:87]
  v_mfma_f32_16x16x32_bf16 v[88:91], v[92:95], a[60:63], v[88:91]
  ds_read2_b32 v[92:93], v55 offset0:112 offset1:113
  ds_read2_b32 v[94:95], v55 offset0:114 offset1:115
  s_waitcnt lgkmcnt(6)
  v_mfma_f32_16x16x32_bf16 v[84:87], v[96:99], a[24:27], v[84:87]
  v_mfma_f32_16x16x32_bf16 v[88:91], v[96:99], a[56:59], v[88:91]
  ds_read2_b32 v[96:97], v55 offset0:96 offset1:97
  ds_read2_b32 v[98:99], v55 offset0:98 offset1:99
  s_waitcnt lgkmcnt(6)
  v_mfma_f32_16x16x32_bf16 v[84:87], v[100:103], a[20:23], v[84:87]
  v_mfma_f32_16x16x32_bf16 v[88:91], v[100:103], a[52:55], v[88:91]
  ds_read2_b32 v[100:101], v55 offset0:80 offset1:81
  ds_read2_b32 v[102:103], v55 offset0:82 offset1:83
  s_waitcnt lgkmcnt(6)
  v_mfma_f32_16x16x32_bf16 v[84:87], v[104:107], a[16:19], v[84:87]
  v_mfma_f32_16x16x32_bf16 v[88:91], v[104:107], a[48:51], v[88:91]
  ds_read2_b32 v[104:105], v55 offset0:64 offset1:65
  ds_read2_b32 v[106:107], v55 offset0:66 offset1:67
  s_waitcnt lgkmcnt(6)
  v_mfma_f32_16x16x32_bf16 v[84:87], v[92:95], a[12:15], v[84:87]
  v_mfma_f32_16x16x32_bf16 v[88:91], v[92:95], a[44:47], v[88:91]
  ds_read2_b32 v[92:93], v55 offset0:48 offset1:49
  ds_read2_b32 v[94:95], v55 offset0:50 offset1:51
  s_waitcnt lgkmcnt(6)
  v_mfma_f32_16x16x32_bf16 v[84:87], v[96:99], a[8:11], v[84:87]
  v_mfma_f32_16x16x32_bf16 v[88:91], v[96:99], a[40:43], v[88:91]
  ds_read2_b32 v[96:97], v55 offset0:32 offset1:33
  ds_read2_b32 v[98:99], v55 offset0:34 offset1:35
  s_waitcnt lgkmcnt(6)
  v_mfma_f32_16x16x32_bf16 v[84:87], v[100:103], a[4:7], v[84:87]
  v_mfma_f32_16x16x32_bf16 v[88:91], v[100:103], a[36:39], v[88:91]
  ds_read2_b32 v[100:101], v55 offset0:16 offset1:17
  ds_read2_b32 v[102:103], v55 offset0:18 offset1:19
  s_waitcnt lgkmcnt(6)
  v_mfma_f32_16x16x32_bf16 v[84:87], v[104:107], a[0:3], v[84:87]
  v_mfma_f32_16x16x32_bf16 v[88:91], v[104:107], a[32:35], v[88:91]
  ds_read2_b32 v[104:105], v55 offset0:0 offset1:1
  ds_read2_b32 v[106:107], v55 offset0:2 offset1:3
  s_waitcnt lgkmcnt(6)
  v_mfma_f32_16x16x32_bf16 v[88:91], v[92:95], a[28:31], v[88:91]
  ds_read2_b32 v[92:93], v56 offset0:224 offset1:225
  ds_read2_b32 v[94:95], v56 offset0:226 offset1:227
  s_waitcnt lgkmcnt(6)
  v_mfma_f32_16x16x32_bf16 v[88:91], v[96:99], a[24:27], v[88:91]
  ds_read2_b32 v[96:97], v56 offset0:208 offset1:209
  ds_read2_b32 v[98:99], v56 offset0:210 offset1:211
  s_waitcnt lgkmcnt(6)
  v_mfma_f32_16x16x32_bf16 v[88:91], v[100:103], a[20:23], v[88:91]
  ds_read2_b32 v[100:101], v56 offset0:192 offset1:193
  ds_read2_b32 v[102:103], v56 offset0:194 offset1:195
  s_waitcnt lgkmcnt(6)
  v_mfma_f32_16x16x32_bf16 v[88:91], v[104:107], a[16:19], v[88:91]
  ds_read2_b32 v[104:105], v56 offset0:176 offset1:177
  ds_read2_b32 v[106:107], v56 offset0:178 offset1:179
  s_waitcnt lgkmcnt(6)
  v_mfma_f32_16x16x32_bf16 v[88:91], v[92:95], a[12:15], v[88:91]
  s_waitcnt lgkmcnt(4)
  v_mfma_f32_16x16x32_bf16 v[88:91], v[96:99], a[8:11], v[88:91]
  s_waitcnt lgkmcnt(2)
  v_mfma_f32_16x16x32_bf16 v[88:91], v[100:103], a[4:7], v[88:91]
  s_waitcnt lgkmcnt(0)
  v_mfma_f32_16x16x32_bf16 v[88:91], v[104:107], a[0:3], v[88:91]
  v_lshlrev_b32 v46, 5, v4
  v_lshl_add_u32 v46, v3, 3, v46
  v_add_u32 v46, s17, v46
  ds_read_b64 v[108:109], v46 offset:512
  ds_read_b64 v[110:111], v46 offset:1024
  ds_read_b64 v[112:113], v46 offset:1536
  ds_read_b64 v[114:115], v46 offset:2048
  ds_read_b64 v[116:117], v46 offset:2560
  ds_read_b64 v[118:119], v46 offset:3072
  ds_read_b64 v[120:121], v46 offset:3584
  ds_read_b64 v[122:123], v46 offset:4096
  s_waitcnt lgkmcnt(0)
  v_lshlrev_b32 v124, 16, v108
  v_and_b32 v125, 0xffff0000, v108
  v_lshlrev_b32 v126, 16, v109
  v_and_b32 v127, 0xffff0000, v109
  v_mul_f32 v124, v124, v33
  v_mul_f32 v125, v125, v33
  v_mul_f32 v126, v126, v33
  v_mul_f32 v127, v127, v33
  v_cvt_pk_bf16_f32 v128, v124, v125
  v_cvt_pk_bf16_f32 v129, v126, v127
  v_cvt_pk_bf16_f32 v130, v60, v61
  v_cvt_pk_bf16_f32 v131, v62, v63
  v_lshlrev_b32 v124, 16, v128
  v_and_b32 v125, 0xffff0000, v128
  v_lshlrev_b32 v132, 16, v130
  v_and_b32 v133, 0xffff0000, v130
  v_lshlrev_b32 v126, 16, v129
  v_and_b32 v127, 0xffff0000, v129
  v_lshlrev_b32 v134, 16, v131
  v_and_b32 v135, 0xffff0000, v131
  v_add_f32 v124, v124, v132
  v_add_f32 v125, v125, v133
  v_add_f32 v126, v126, v134
  v_add_f32 v127, v127, v135
  v_cvt_pk_bf16_f32 v108, v124, v125
  v_cvt_pk_bf16_f32 v109, v126, v127
  ds_write_b64 v46, v[108:109] offset:512
  v_lshlrev_b32 v124, 16, v110
  v_and_b32 v125, 0xffff0000, v110
  v_lshlrev_b32 v126, 16, v111
  v_and_b32 v127, 0xffff0000, v111
  v_mul_f32 v124, v124, v33
  v_mul_f32 v125, v125, v33
  v_mul_f32 v126, v126, v33
  v_mul_f32 v127, v127, v33
  v_cvt_pk_bf16_f32 v128, v124, v125
  v_cvt_pk_bf16_f32 v129, v126, v127
  v_cvt_pk_bf16_f32 v130, v64, v65
  v_cvt_pk_bf16_f32 v131, v66, v67
  v_lshlrev_b32 v124, 16, v128
  v_and_b32 v125, 0xffff0000, v128
  v_lshlrev_b32 v132, 16, v130
  v_and_b32 v133, 0xffff0000, v130
  v_lshlrev_b32 v126, 16, v129
  v_and_b32 v127, 0xffff0000, v129
  v_lshlrev_b32 v134, 16, v131
  v_and_b32 v135, 0xffff0000, v131
  v_add_f32 v124, v124, v132
  v_add_f32 v125, v125, v133
  v_add_f32 v126, v126, v134
  v_add_f32 v127, v127, v135
  v_cvt_pk_bf16_f32 v110, v124, v125
  v_cvt_pk_bf16_f32 v111, v126, v127
  ds_write_b64 v46, v[110:111] offset:1024
  v_lshlrev_b32 v124, 16, v112
  v_and_b32 v125, 0xffff0000, v112
  v_lshlrev_b32 v126, 16, v113
  v_and_b32 v127, 0xffff0000, v113
  v_mul_f32 v124, v124, v33
  v_mul_f32 v125, v125, v33
  v_mul_f32 v126, v126, v33
  v_mul_f32 v127, v127, v33
  v_cvt_pk_bf16_f32 v128, v124, v125
  v_cvt_pk_bf16_f32 v129, v126, v127
  v_cvt_pk_bf16_f32 v130, v68, v69
  v_cvt_pk_bf16_f32 v131, v70, v71
  v_lshlrev_b32 v124, 16, v128
  v_and_b32 v125, 0xffff0000, v128
  v_lshlrev_b32 v132, 16, v130
  v_and_b32 v133, 0xffff0000, v130
  v_lshlrev_b32 v126, 16, v129
  v_and_b32 v127, 0xffff0000, v129
  v_lshlrev_b32 v134, 16, v131
  v_and_b32 v135, 0xffff0000, v131
  v_add_f32 v124, v124, v132
  v_add_f32 v125, v125, v133
  v_add_f32 v126, v126, v134
  v_add_f32 v127, v127, v135
  v_cvt_pk_bf16_f32 v112, v124, v125
  v_cvt_pk_bf16_f32 v113, v126, v127
  ds_write_b64 v46, v[112:113] offset:1536
  v_lshlrev_b32 v124, 16, v114
  v_and_b32 v125, 0xffff0000, v114
  v_lshlrev_b32 v126, 16, v115
  v_and_b32 v127, 0xffff0000, v115
  v_mul_f32 v124, v124, v33
  v_mul_f32 v125, v125, v33
  v_mul_f32 v126, v126, v33
  v_mul_f32 v127, v127, v33
  v_cvt_pk_bf16_f32 v128, v124, v125
  v_cvt_pk_bf16_f32 v129, v126, v127
  v_cvt_pk_bf16_f32 v130, v72, v73
  v_cvt_pk_bf16_f32 v131, v74, v75
  v_lshlrev_b32 v124, 16, v128
  v_and_b32 v125, 0xffff0000, v128
  v_lshlrev_b32 v132, 16, v130
  v_and_b32 v133, 0xffff0000, v130
  v_lshlrev_b32 v126, 16, v129
  v_and_b32 v127, 0xffff0000, v129
  v_lshlrev_b32 v134, 16, v131
  v_and_b32 v135, 0xffff0000, v131
  v_add_f32 v124, v124, v132
  v_add_f32 v125, v125, v133
  v_add_f32 v126, v126, v134
  v_add_f32 v127, v127, v135
  v_cvt_pk_bf16_f32 v114, v124, v125
  v_cvt_pk_bf16_f32 v115, v126, v127
  ds_write_b64 v46, v[114:115] offset:2048
  v_lshlrev_b32 v124, 16, v116
  v_and_b32 v125, 0xffff0000, v116
  v_lshlrev_b32 v126, 16, v117
  v_and_b32 v127, 0xffff0000, v117
  v_mul_f32 v124, v124, v33
  v_mul_f32 v125, v125, v33
  v_mul_f32 v126, v126, v33
  v_mul_f32 v127, v127, v33
  v_cvt_pk_bf16_f32 v128, v124, v125
  v_cvt_pk_bf16_f32 v129, v126, v127
  v_cvt_pk_bf16_f32 v130, v76, v77
  v_cvt_pk_bf16_f32 v131, v78, v79
  v_lshlrev_b32 v124, 16, v128
  v_and_b32 v125, 0xffff0000, v128
  v_lshlrev_b32 v132, 16, v130
  v_and_b32 v133, 0xffff0000, v130
  v_lshlrev_b32 v126, 16, v129
  v_and_b32 v127, 0xffff0000, v129
  v_lshlrev_b32 v134, 16, v131
  v_and_b32 v135, 0xffff0000, v131
  v_add_f32 v124, v124, v132
  v_add_f32 v125, v125, v133
  v_add_f32 v126, v126, v134
  v_add_f32 v127, v127, v135
  v_cvt_pk_bf16_f32 v116, v124, v125
  v_cvt_pk_bf16_f32 v117, v126, v127
  ds_write_b64 v46, v[116:117] offset:2560
  v_lshlrev_b32 v124, 16, v118
  v_and_b32 v125, 0xffff0000, v118
  v_lshlrev_b32 v126, 16, v119
  v_and_b32 v127, 0xffff0000, v119
  v_mul_f32 v124, v124, v33
  v_mul_f32 v125, v125, v33
  v_mul_f32 v126, v126, v33
  v_mul_f32 v127, v127, v33
  v_cvt_pk_bf16_f32 v128, v124, v125
  v_cvt_pk_bf16_f32 v129, v126, v127
  v_cvt_pk_bf16_f32 v130, v80, v81
  v_cvt_pk_bf16_f32 v131, v82, v83
  v_lshlrev_b32 v124, 16, v128
  v_and_b32 v125, 0xffff0000, v128
  v_lshlrev_b32 v132, 16, v130
  v_and_b32 v133, 0xffff0000, v130
  v_lshlrev_b32 v126, 16, v129
  v_and_b32 v127, 0xffff0000, v129
  v_lshlrev_b32 v134, 16, v131
  v_and_b32 v135, 0xffff0000, v131
  v_add_f32 v124, v124, v132
  v_add_f32 v125, v125, v133
  v_add_f32 v126, v126, v134
  v_add_f32 v127, v127, v135
  v_cvt_pk_bf16_f32 v118, v124, v125
  v_cvt_pk_bf16_f32 v119, v126, v127
  ds_write_b64 v46, v[118:119] offset:3072
  v_lshlrev_b32 v124, 16, v120
  v_and_b32 v125, 0xffff0000, v120
  v_lshlrev_b32 v126, 16, v121
  v_and_b32 v127, 0xffff0000, v121
  v_mul_f32 v124, v124, v33
  v_mul_f32 v125, v125, v33
  v_mul_f32 v126, v126, v33
  v_mul_f32 v127, v127, v33
  v_cvt_pk_bf16_f32 v128, v124, v125
  v_cvt_pk_bf16_f32 v129, v126, v127
  v_cvt_pk_bf16_f32 v130, v84, v85
  v_cvt_pk_bf16_f32 v131, v86, v87
  v_lshlrev_b32 v124, 16, v128
  v_and_b32 v125, 0xffff0000, v128
  v_lshlrev_b32 v132, 16, v130
  v_and_b32 v133, 0xffff0000, v130
  v_lshlrev_b32 v126, 16, v129
  v_and_b32 v127, 0xffff0000, v129
  v_lshlrev_b32 v134, 16, v131
  v_and_b32 v135, 0xffff0000, v131
  v_add_f32 v124, v124, v132
  v_add_f32 v125, v125, v133
  v_add_f32 v126, v126, v134
  v_add_f32 v127, v127, v135
  v_cvt_pk_bf16_f32 v120, v124, v125
  v_cvt_pk_bf16_f32 v121, v126, v127
  ds_write_b64 v46, v[120:121] offset:3584
  v_lshlrev_b32 v124, 16, v122
  v_and_b32 v125, 0xffff0000, v122
  v_lshlrev_b32 v126, 16, v123
  v_and_b32 v127, 0xffff0000, v123
  v_mul_f32 v124, v124, v33
  v_mul_f32 v125, v125, v33
  v_mul_f32 v126, v126, v33
  v_mul_f32 v127, v127, v33
  v_cvt_pk_bf16_f32 v128, v124, v125
  v_cvt_pk_bf16_f32 v129, v126, v127
  v_cvt_pk_bf16_f32 v130, v88, v89
  v_cvt_pk_bf16_f32 v131, v90, v91
  v_lshlrev_b32 v124, 16, v128
  v_and_b32 v125, 0xffff0000, v128
  v_lshlrev_b32 v132, 16, v130
  v_and_b32 v133, 0xffff0000, v130
  v_lshlrev_b32 v126, 16, v129
  v_and_b32 v127, 0xffff0000, v129
  v_lshlrev_b32 v134, 16, v131
  v_and_b32 v135, 0xffff0000, v131
  v_add_f32 v124, v124, v132
  v_add_f32 v125, v125, v133
  v_add_f32 v126, v126, v134
  v_add_f32 v127, v127, v135
  v_cvt_pk_bf16_f32 v122, v124, v125
  v_cvt_pk_bf16_f32 v123, v126, v127
  ds_write_b64 v46, v[122:123] offset:4096
  s_waitcnt lgkmcnt(0)
  s_barrier
  v_lshlrev_b32 v6, 3, v0
  v_mul_u32_u24 v5, 7168, v0
  v_add_u32 v36, 512, v6
  ds_read_b64 v[8:9], v36
  v_add_u32 v36, 25088, v6
  ds_read_b64 v[10:11], v36
  v_add_u32 v36, 49664, v6
  ds_read_b64 v[12:13], v36
  v_add_u32 v36, 74240, v6
  ds_read_b64 v[14:15], v36
  s_waitcnt lgkmcnt(0)
  s_add_u32 s22, s21, 0
  s_add_u32 s23, s22, 3584
  v_perm_b32 v16, v10, v8, s24
  v_perm_b32 v17, v14, v12, s24
  buffer_store_dwordx2 v[16:17], v5, s[92:95], s22 offen offset:0
  v_perm_b32 v18, v10, v8, s25
  v_perm_b32 v19, v14, v12, s25
  buffer_store_dwordx2 v[18:19], v5, s[92:95], s22 offen offset:1792
  v_perm_b32 v20, v11, v9, s24
  v_perm_b32 v21, v15, v13, s24
  buffer_store_dwordx2 v[20:21], v5, s[92:95], s23 offen offset:0
  v_perm_b32 v22, v11, v9, s25
  v_perm_b32 v23, v15, v13, s25
  buffer_store_dwordx2 v[22:23], v5, s[92:95], s23 offen offset:1792
  v_add_u32 v36, 2560, v6
  ds_read_b64 v[8:9], v36
  v_add_u32 v36, 27136, v6
  ds_read_b64 v[10:11], v36
  v_add_u32 v36, 51712, v6
  ds_read_b64 v[12:13], v36
  v_add_u32 v36, 76288, v6
  ds_read_b64 v[14:15], v36
  s_waitcnt lgkmcnt(0)
  s_add_u32 s22, s21, 1835008
  s_add_u32 s23, s22, 3584
  v_perm_b32 v24, v10, v8, s24
  v_perm_b32 v25, v14, v12, s24
  buffer_store_dwordx2 v[24:25], v5, s[92:95], s22 offen offset:0
  v_perm_b32 v26, v10, v8, s25
  v_perm_b32 v27, v14, v12, s25
  buffer_store_dwordx2 v[26:27], v5, s[92:95], s22 offen offset:1792
  v_perm_b32 v28, v11, v9, s24
  v_perm_b32 v29, v15, v13, s24
  buffer_store_dwordx2 v[28:29], v5, s[92:95], s23 offen offset:0
  v_perm_b32 v30, v11, v9, s25
  v_perm_b32 v31, v15, v13, s25
  buffer_store_dwordx2 v[30:31], v5, s[92:95], s23 offen offset:1792
  s_branch wk_loop
wk_tok:
  s_sub_u32 s3, s3, 864
  s_and_b32 s18, s3, 3
  s_lshr_b32 s17, s3, 2
  s_cmp_lt_u32 s17, 8
  s_cbranch_scc1 wk_tokp
  s_sub_u32 s17, s17, 64
  s_cmp_ge_i32 s17, 56
  s_cbranch_scc1 wk_toko
  s_add_u32 s20, s17, 56
  s_lshr_b32 s17, s20, 1
  s_bitcmp0_b32 s20, 0
  s_cbranch_scc1 wk_toko
  s_add_u32 s17, s17, 8
wk_tokp:
  s_lshl_b32 s20, s18, 2
  s_add_u32 s20, s20, s16
  s_lshl_b32 s21, s17, 4
  s_add_u32 s21, s21, s20
  s_mul_i32 s21, s21, 28672
  s_add_u32 s21, s21, 12845056
  s_mul_i32 s23, s17, 28672
  s_add_u32 s23, s23, 73400320
  s_mul_i32 s24, s17, 7168
  s_add_u32 s24, s24, 88068096
  s_lshr_b32 s25, s17, 3
  s_lshl_b32 s25, s25, 4
  s_add_u32 s25, s25, s20
  s_lshl_b32 s25, s25, 7
  s_add_u32 s25, s25, 88545280
  v_mov_b32 v60, 0
  s_mov_b32 s30, 0
wp_wf:
  buffer_load_dword v61, v60, s[8:11], s25 offen sc1
  s_waitcnt vmcnt(0)
  v_cmp_ne_u32 vcc, 56, v61
  s_cbranch_vccz wp_wf_ok
  s_sleep 1
  s_cmp_ge_u32 s17, 61
  s_cbranch_scc1 wp_wf_bo
  s_sleep 4
  s_cmp_ge_u32 s17, 56
  s_cbranch_scc1 wp_wf_bo
  s_sleep 40
wp_wf_bo:
  s_add_u32 s30, s30, 1
  s_cmp_lt_u32 s30, 30000
  s_cbranch_scc1 wp_wf
  s_branch wp_abort
wp_wf_ok:
  s_add_u32 s22, s21, 0
  buffer_load_dwordx4 a[0:3], v2, s[8:11], s22 offen offset:0 sc1
  buffer_load_dwordx4 a[4:7], v2, s[8:11], s22 offen offset:1024 sc1
  buffer_load_dwordx4 a[8:11], v2, s[8:11], s22 offen offset:2048 sc1
  buffer_load_dwordx4 a[12:15], v2, s[8:11], s22 offen offset:3072 sc1
  s_add_u32 s22, s21, 4096
  buffer_load_dwordx4 a[16:19], v2, s[8:11], s22 offen offset:0 sc1
  buffer_load_dwordx4 a[20:23], v2, s[8:11], s22 offen offset:1024 sc1
  buffer_load_dwordx4 a[24:27], v2, s[8:11], s22 offen offset:2048 sc1
  buffer_load_dwordx4 a[28:31], v2, s[8:11], s22 offen offset:3072 sc1
  s_add_u32 s22, s21, 8192
  buffer_load_dwordx4 a[32:35], v2, s[8:11], s22 offen offset:0 sc1
  buffer_load_dwordx4 a[36:39], v2, s[8:11], s22 offen offset:1024 sc1
  buffer_load_dwordx4 a[40:43], v2, s[8:11], s22 offen offset:2048 sc1
  buffer_load_dwordx4 a[44:47], v2, s[8:11], s22 offen offset:3072 sc1
  s_add_u32 s22, s21, 12288
  buffer_load_dwordx4 a[48:51], v2, s[8:11], s22 offen offset:0 sc1
  buffer_load_dwordx4 a[52:55], v2, s[8:11], s22 offen offset:1024 sc1
  buffer_load_dwordx4 a[56:59], v2, s[8:11], s22 offen offset:2048 sc1
  buffer_load_dwordx4 a[60:63], v2, s[8:11], s22 offen offset:3072 sc1
  s_add_u32 s22, s21, 16384
  buffer_load_dwordx4 a[64:67], v2, s[8:11], s22 offen offset:0 sc1
  buffer_load_dwordx4 a[68:71], v2, s[8:11], s22 offen offset:1024 sc1
  buffer_load_dwordx4 a[72:75], v2, s[8:11], s22 offen offset:2048 sc1
  buffer_load_dwordx4 a[76:79], v2, s[8:11], s22 offen offset:3072 sc1
  s_add_u32 s22, s21, 20480
  buffer_load_dwordx4 a[80:83], v2, s[8:11], s22 offen offset:0 sc1
  buffer_load_dwordx4 a[84:87], v2, s[8:11], s22 offen offset:1024 sc1
  buffer_load_dwordx4 a[88:91], v2, s[8:11], s22 offen offset:2048 sc1
  buffer_load_dwordx4 a[92:95], v2, s[8:11], s22 offen offset:3072 sc1
  s_add_u32 s22, s21, 24576
  buffer_load_dwordx4 a[96:99], v2, s[8:11], s22 offen offset:0 sc1
  buffer_load_dwordx4 a[100:103], v2, s[8:11], s22 offen offset:1024 sc1
  buffer_load_dwordx4 a[104:107], v2, s[8:11], s22 offen offset:2048 sc1
  buffer_load_dwordx4 a[108:111], v2, s[8:11], s22 offen offset:3072 sc1
  s_add_u32 s22, s23, 0
  buffer_load_dwordx4 a[112:115], v2, s[8:11], s22 offen offset:0 sc1
  buffer_load_dwordx4 a[116:119], v2, s[8:11], s22 offen offset:1024 sc1
  buffer_load_dwordx4 a[120:123], v2, s[8:11], s22 offen offset:2048 sc1
  buffer_load_dwordx4 a[124:127], v2, s[8:11], s22 offen offset:3072 sc1
  s_add_u32 s22, s23, 4096
  buffer_load_dwordx4 a[128:131], v2, s[8:11], s22 offen offset:0 sc1
  buffer_load_dwordx4 a[132:135], v2, s[8:11], s22 offen offset:1024 sc1
  buffer_load_dwordx4 a[136:139], v2, s[8:11], s22 offen offset:2048 sc1
  buffer_load_dwordx4 a[140:143], v2, s[8:11], s22 offen offset:3072 sc1
  s_add_u32 s22, s23, 8192
  buffer_load_dwordx4 a[144:147], v2, s[8:11], s22 offen offset:0 sc1
  buffer_load_dwordx4 a[148:151], v2, s[8:11], s22 offen offset:1024 sc1
  buffer_load_dwordx4 a[152:155], v2, s[8:11], s22 offen offset:2048 sc1
  buffer_load_dwordx4 a[156:159], v2, s[8:11], s22 offen offset:3072 sc1
  s_add_u32 s22, s23, 12288
  buffer_load_dwordx4 a[160:163], v2, s[8:11], s22 offen offset:0 sc1
  buffer_load_dwordx4 a[164:167], v2, s[8:11], s22 offen offset:1024 sc1
  buffer_load_dwordx4 a[168:171], v2, s[8:11], s22 offen offset:2048 sc1
  buffer_load_dwordx4 a[172:175], v2, s[8:11], s22 offen offset:3072 sc1
  s_add_u32 s22, s23, 16384
  buffer_load_dwordx4 a[176:179], v2, s[8:11], s22 offen offset:0 sc1
  buffer_load_dwordx4 a[180:183], v2, s[8:11], s22 offen offset:1024 sc1
  buffer_load_dwordx4 a[184:187], v2, s[8:11], s22 offen offset:2048 sc1
  buffer_load_dwordx4 a[188:191], v2, s[8:11], s22 offen offset:3072 sc1
  s_add_u32 s22, s23, 20480
  buffer_load_dwordx4 a[192:195], v2, s[8:11], s22 offen offset:0 sc1
  buffer_load_dwordx4 a[196:199], v2, s[8:11], s22 offen offset:1024 sc1
  buffer_load_dwordx4 a[200:203], v2, s[8:11], s22 offen offset:2048 sc1
  buffer_load_dwordx4 a[204:207], v2, s[8:11], s22 offen offset:3072 sc1
  s_add_u32 s22, s23, 24576
  buffer_load_dwordx4 a[208:211], v2, s[8:11], s22 offen offset:0 sc1
  buffer_load_dwordx4 a[212:215], v2, s[8:11], s22 offen offset:1024 sc1
  buffer_load_dwordx4 a[216:219], v2, s[8:11], s22 offen offset:2048 sc1
  buffer_load_dwordx4 a[220:223], v2, s[8:11], s22 offen offset:3072 sc1
  v_lshl_add_u32 v5, v3, 2, 0
  v_cmp_le_u32 s[40:41], v5, v4
  v_lshl_add_u32 v5, v3, 2, 1
  v_cmp_le_u32 s[42:43], v5, v4
  v_lshl_add_u32 v5, v3, 2, 2
  v_cmp_le_u32 s[44:45], v5, v4
  v_lshl_add_u32 v5, v3, 2, 3
  v_cmp_le_u32 s[46:47], v5, v4
  v_cmp_gt_u32 s[48:49], 2, v3
  v_mov_b32 v6, 0xff800000
  s_waitcnt vmcnt(0)
  v_mfma_f32_16x16x32_bf16 v[8:11], a[112:115], a[0:3], 0
  v_mfma_f32_16x16x32_bf16 v[12:15], a[112:115], a[56:59], 0
  v_mfma_f32_16x16x32_bf16 v[16:19], a[168:171], a[56:59], 0
  v_mfma_f32_16x16x32_bf16 v[8:11], a[116:119], a[4:7], v[8:11]
  v_mfma_f32_16x16x32_bf16 v[12:15], a[116:119], a[60:63], v[12:15]
  v_mfma_f32_16x16x32_bf16 v[16:19], a[172:175], a[60:63], v[16:19]
  v_mfma_f32_16x16x32_bf16 v[8:11], a[120:123], a[8:11], v[8:11]
  v_mfma_f32_16x16x32_bf16 v[12:15], a[120:123], a[64:67], v[12:15]
  v_mfma_f32_16x16x32_bf16 v[16:19], a[176:179], a[64:67], v[16:19]
  v_mfma_f32_16x16x32_bf16 v[8:11], a[124:127], a[12:15], v[8:11]
  v_mfma_f32_16x16x32_bf16 v[12:15], a[124:127], a[68:71], v[12:15]
  v_mfma_f32_16x16x32_bf16 v[16:19], a[180:183], a[68:71], v[16:19]
  v_mfma_f32_16x16x32_bf16 v[8:11], a[128:131], a[16:19], v[8:11]
  v_mfma_f32_16x16x32_bf16 v[12:15], a[128:131], a[72:75], v[12:15]
  v_mfma_f32_16x16x32_bf16 v[16:19], a[184:187], a[72:75], v[16:19]
  v_mfma_f32_16x16x32_bf16 v[8:11], a[132:135], a[20:23], v[8:11]
  v_mfma_f32_16x16x32_bf16 v[12:15], a[132:135], a[76:79], v[12:15]
  v_mfma_f32_16x16x32_bf16 v[16:19], a[188:191], a[76:79], v[16:19]
  v_mfma_f32_16x16x32_bf16 v[8:11], a[136:139], a[24:27], v[8:11]
  v_mfma_f32_16x16x32_bf16 v[12:15], a[136:139], a[80:83], v[12:15]
  v_mfma_f32_16x16x32_bf16 v[16:19], a[192:195], a[80:83], v[16:19]
  v_mfma_f32_16x16x32_bf16 v[8:11], a[140:143], a[28:31], v[8:11]
  v_mfma_f32_16x16x32_bf16 v[12:15], a[140:143], a[84:87], v[12:15]
  v_mfma_f32_16x16x32_bf16 v[16:19], a[196:199], a[84:87], v[16:19]
  v_mfma_f32_16x16x32_bf16 v[8:11], a[144:147], a[32:35], v[8:11]
  v_mfma_f32_16x16x32_bf16 v[12:15], a[144:147], a[88:91], v[12:15]
  v_mfma_f32_16x16x32_bf16 v[16:19], a[200:203], a[88:91], v[16:19]
  v_mfma_f32_16x16x32_bf16 v[8:11], a[148:151], a[36:39], v[8:11]
  v_mfma_f32_16x16x32_bf16 v[12:15], a[148:151], a[92:95], v[12:15]
  v_mfma_f32_16x16x32_bf16 v[16:19], a[204:207], a[92:95], v[16:19]
  v_mfma_f32_16x16x32_bf16 v[8:11], a[152:155], a[40:43], v[8:11]
  v_mfma_f32_16x16x32_bf16 v[12:15], a[152:155], a[96:99], v[12:15]
  v_mfma_f32_16x16x32_bf16 v[16:19], a[208:211], a[96:99], v[16:19]
  v_mfma_f32_16x16x32_bf16 v[8:11], a[156:159], a[44:47], v[8:11]
  v_mfma_f32_16x16x32_bf16 v[12:15], a[156:159], a[100:103], v[12:15]
  v_mfma_f32_16x16x32_bf16 v[16:19], a[212:215], a[100:103], v[16:19]
  v_mfma_f32_16x16x32_bf16 v[8:11], a[160:163], a[48:51], v[8:11]
  v_mfma_f32_16x16x32_bf16 v[12:15], a[160:163], a[104:107], v[12:15]
  v_mfma_f32_16x16x32_bf16 v[16:19], a[216:219], a[104:107], v[16:19]
  v_mfma_f32_16x16x32_bf16 v[8:11], a[164:167], a[52:55], v[8:11]
  v_mfma_f32_16x16x32_bf16 v[12:15], a[164:167], a[108:111], v[12:15]
  v_mfma_f32_16x16x32_bf16 v[16:19], a[220:223], a[108:111], v[16:19]
  s_mul_i32 s22, s20, 448
  v_mov_b32 v62, s22
  s_mov_b32 s30, 0
wp_pm:
  s_cmp_ge_u32 s17, 64
  s_cbranch_scc1 wp_pf
  s_cmp_ge_u32 s17, 61
  s_cbranch_scc1 mp_43a
  v_mov_b32 v61, 0
  s_mov_b64 exec, 1
  buffer_atomic_or v61, v62, s[8:11], s24 offen sc0
  s_mov_b64 exec, -1
  s_branch mp_43b
mp_43a:
  buffer_load_dword v61, v62, s[8:11], s24 offen sc1
mp_43b:
  s_waitcnt vmcnt(0)
  v_cmp_eq_u32 vcc, -1, v61
  s_cbranch_vccnz wp_pr
wp_pf:
  s_add_u32 s22, s24, 4096
  buffer_load_dwordx4 v[64:67], v2, s[8:11], s24 offen offset:0 sc1
  buffer_load_dwordx4 v[68:71], v2, s[8:11], s24 offen offset:1024 sc1
  buffer_load_dwordx4 v[72:75], v2, s[8:11], s24 offen offset:2048 sc1
  buffer_load_dwordx4 v[76:79], v2, s[8:11], s24 offen offset:3072 sc1
  buffer_load_dwordx4 v[80:83], v2, s[8:11], s22 offen offset:0 sc1
  buffer_load_dwordx4 v[84:87], v2, s[8:11], s22 offen offset:1024 sc1
  buffer_load_dwordx4 v[88:91], v2, s[8:11], s22 offen offset:2048 sc1
  s_waitcnt vmcnt(0)
  v_max_u32 v61, v64, v65
  v_max3_u32 v61, v61, v66, v67
  v_max3_u32 v61, v61, v68, v69
  v_max3_u32 v61, v61, v70, v71
  v_max3_u32 v61, v61, v72, v73
  v_max3_u32 v61, v61, v74, v75
  v_max3_u32 v61, v61, v76, v77
  v_max3_u32 v61, v61, v78, v79
  v_max3_u32 v61, v61, v80, v81
  v_max3_u32 v61, v61, v82, v83
  v_max3_u32 v61, v61, v84, v85
  v_max3_u32 v61, v61, v86, v87
  v_max3_u32 v61, v61, v88, v89
  v_max3_u32 v61, v61, v90, v91
  v_cmp_eq_u32 vcc, -1, v61
  s_cbranch_vccz wp_pk
wp_pr:
  s_sleep 1
  s_cmp_ge_u32 s17, 61
  s_cbranch_scc1 wp_pm_bo
  s_sleep 4
  s_cmp_ge_u32 s17, 56
  s_cbranch_scc1 wp_pm_bo
  s_sleep 40
wp_pm_bo:
  s_add_u32 s30, s30, 1
  s_cmp_lt_u32 s30, 30000
  s_cbranch_scc1 wp_pm
  s_branch wp_abort
wp_pk:
  s_cmp_lt_u32 s17, 56
  s_cbranch_scc1 pk_44
  buffer_load_dword v250, v251, s[12:15], 0 offen sc1
pk_44:
  v_mfma_f32_16x16x32_bf16 v[20:23], v[64:67], a[0:3], 0
  v_mfma_f32_16x16x32_bf16 v[24:27], v[64:67], a[4:7], 0
  v_mfma_f32_16x16x32_bf16 v[28:31], v[64:67], a[56:59], 0
  v_mfma_f32_16x16x32_bf16 v[32:35], v[64:67], a[60:63], 0
  v_mfma_f32_16x16x32_bf16 v[20:23], v[68:71], a[8:11], v[20:23]
  v_mfma_f32_16x16x32_bf16 v[24:27], v[68:71], a[12:15], v[24:27]
  v_mfma_f32_16x16x32_bf16 v[28:31], v[68:71], a[64:67], v[28:31]
  v_mfma_f32_16x16x32_bf16 v[32:35], v[68:71], a[68:71], v[32:35]
  v_mfma_f32_16x16x32_bf16 v[20:23], v[72:75], a[16:19], v[20:23]
  v_mfma_f32_16x16x32_bf16 v[24:27], v[72:75], a[20:23], v[24:27]
  v_mfma_f32_16x16x32_bf16 v[28:31], v[72:75], a[72:75], v[28:31]
  v_mfma_f32_16x16x32_bf16 v[32:35], v[72:75], a[76:79], v[32:35]
  v_mfma_f32_16x16x32_bf16 v[20:23], v[76:79], a[24:27], v[20:23]
  v_mfma_f32_16x16x32_bf16 v[24:27], v[76:79], a[28:31], v[24:27]
  v_mfma_f32_16x16x32_bf16 v[28:31], v[76:79], a[80:83], v[28:31]
  v_mfma_f32_16x16x32_bf16 v[32:35], v[76:79], a[84:87], v[32:35]
  v_mfma_f32_16x16x32_bf16 v[20:23], v[80:83], a[32:35], v[20:23]
  v_mfma_f32_16x16x32_bf16 v[24:27], v[80:83], a[36:39], v[24:27]
  v_mfma_f32_16x16x32_bf16 v[28:31], v[80:83], a[88:91], v[28:31]
  v_mfma_f32_16x16x32_bf16 v[32:35], v[80:83], a[92:95], v[32:35]
  v_mfma_f32_16x16x32_bf16 v[20:23], v[84:87], a[40:43], v[20:23]
  v_mfma_f32_16x16x32_bf16 v[24:27], v[84:87], a[44:47], v[24:27]
  v_mfma_f32_16x16x32_bf16 v[28:31], v[84:87], a[96:99], v[28:31]
  v_mfma_f32_16x16x32_bf16 v[32:35], v[84:87], a[100:103], v[32:35]
  v_mfma_f32_16x16x32_bf16 v[20:23], v[88:91], a[48:51], v[20:23]
  v_mfma_f32_16x16x32_bf16 v[24:27], v[88:91], a[52:55], v[24:27]
  v_mfma_f32_16x16x32_bf16 v[28:31], v[88:91], a[104:107], v[28:31]
  v_mfma_f32_16x16x32_bf16 v[32:35], v[88:91], a[108:111], v[32:35]
  s_lshl_b32 s25, s17, 1
  s_mul_i32 s25, s25, 20480
  s_add_u32 s25, s25, 85446656
  s_lshl_b32 s26, s20, 10
  s_add_u32 s26, s26, s25
  s_lshl_b32 s27, s18, 10
  s_add_u32 s27, s27, s25
  s_lshr_b32 s28, s16, 1
  s_lshl_b32 s28, s28, 3
  s_add_u32 s27, s27, s28
  s_add_u32 s27, s27, 16384
  s_and_b32 s28, s16, 1
  s_cmp_eq_u32 s28, 0
  s_cselect_b32 s50, -1, 0
  s_cselect_b32 s51, 0, -1
  v_cndmask_b32 v8, v6, v8, s[40:41]
  v_cndmask_b32 v9, v6, v9, s[42:43]
  v_cndmask_b32 v10, v6, v10, s[44:45]
  v_cndmask_b32 v11, v6, v11, s[46:47]
  v_cndmask_b32 v20, v24, v20, s[48:49]
  v_cndmask_b32 v21, v25, v21, s[48:49]
  v_cndmask_b32 v22, v26, v22, s[48:49]
  v_cndmask_b32 v23, v27, v23, s[48:49]
  v_mov_b32 v24, v20
  v_mov_b32 v25, v21
  v_mov_b32 v26, v22
  v_mov_b32 v27, v23
  v_permlane32_swap_b32 v20, v24
  v_permlane32_swap_b32 v21, v25
  v_permlane32_swap_b32 v22, v26
  v_permlane32_swap_b32 v23, v27
  v_add_f32 v20, v20, v24
  v_add_f32 v21, v21, v25
  v_add_f32 v22, v22, v26
  v_add_f32 v23, v23, v27
  v_max3_f32 v40, v8, v9, v10
  v_max3_f32 v40, v40, v11, v20
  v_max3_f32 v40, v40, v21, v22
  v_max_f32 v40, v40, v23
  v_mov_b32 v41, v40
  s_nop 1
  v_permlane16_swap_b32 v40, v41
  v_max_f32 v40, v40, v41
  v_mov_b32 v41, v40
  s_nop 1
  v_permlane32_swap_b32 v40, v41
  v_max_f32 v40, v40, v41
  v_sub_f32 v8, v8, v40
  v_sub_f32 v9, v9, v40
  v_sub_f32 v10, v10, v40
  v_sub_f32 v11, v11, v40
  v_sub_f32 v20, v20, v40
  v_sub_f32 v21, v21, v40
  v_sub_f32 v22, v22, v40
  v_sub_f32 v23, v23, v40
  v_exp_f32 v8, v8
  v_exp_f32 v9, v9
  v_exp_f32 v10, v10
  v_exp_f32 v11, v11
  v_exp_f32 v20, v20
  v_exp_f32 v21, v21
  v_exp_f32 v22, v22
  v_exp_f32 v23, v23
  v_add_f32 v42, v20, v21
  v_add_f32 v43, v22, v23
  v_add_f32 v42, v42, v43
  v_mul_f32 v42, 0.5, v42
  v_add_f32 v42, v42, v8
  v_add_f32 v42, v42, v9
  v_add_f32 v42, v42, v10
  v_add_f32 v42, v42, v11
  v_mov_b32 v41, v42
  s_nop 1
  v_permlane16_swap_b32 v42, v41
  v_add_f32 v42, v42, v41
  v_mov_b32 v41, v42
  s_nop 1
  v_permlane32_swap_b32 v42, v41
  v_add_f32 v42, v42, v41
  v_rcp_f32 v42, v42
  s_nop 0
  v_mul_f32 v8, v8, v42
  v_mul_f32 v9, v9, v42
  v_mul_f32 v10, v10, v42
  v_mul_f32 v11, v11, v42
  v_mul_f32 v20, v20, v42
  v_mul_f32 v21, v21, v42
  v_mul_f32 v22, v22, v42
  v_mul_f32 v23, v23, v42
  v_cvt_pk_bf16_f32 v44, v8, v9
  v_cvt_pk_bf16_f32 v45, v10, v11
  v_mov_b32 v46, 0
  v_mov_b32 v47, 0
  v_cvt_pk_bf16_f32 v48, v20, v21
  v_cvt_pk_bf16_f32 v49, v22, v23
  v_min_u32 v44, -2, v44
  v_min_u32 v45, -2, v45
  v_min_u32 v46, -2, v46
  v_min_u32 v47, -2, v47
  v_min_u32 v48, -2, v48
  v_min_u32 v49, -2, v49
  buffer_store_dwordx4 v[44:47], v2, s[8:11], s26 offen sc1
  s_mov_b64 exec, s[50:51]
  buffer_store_dwordx2 v[48:49], v2, s[8:11], s27 offen sc1
  s_mov_b64 exec, -1
  s_add_u32 s26, s26, 20480
  s_add_u32 s27, s27, 20480
  v_cndmask_b32 v16, v6, v16, s[40:41]
  v_cndmask_b32 v17, v6, v17, s[42:43]
  v_cndmask_b32 v18, v6, v18, s[44:45]
  v_cndmask_b32 v19, v6, v19, s[46:47]
  v_cndmask_b32 v28, v32, v28, s[48:49]
  v_cndmask_b32 v29, v33, v29, s[48:49]
  v_cndmask_b32 v30, v34, v30, s[48:49]
  v_cndmask_b32 v31, v35, v31, s[48:49]
  v_mov_b32 v32, v28
  v_mov_b32 v33, v29
  v_mov_b32 v34, v30
  v_mov_b32 v35, v31
  v_permlane32_swap_b32 v28, v32
  v_permlane32_swap_b32 v29, v33
  v_permlane32_swap_b32 v30, v34
  v_permlane32_swap_b32 v31, v35
  v_add_f32 v28, v28, v32
  v_add_f32 v29, v29, v33
  v_add_f32 v30, v30, v34
  v_add_f32 v31, v31, v35
  v_max3_f32 v40, v12, v13, v14
  v_max3_f32 v40, v40, v15, v16
  v_max3_f32 v40, v40, v17, v18
  v_max3_f32 v40, v40, v19, v28
  v_max3_f32 v40, v40, v29, v30
  v_max_f32 v40, v40, v31
  v_mov_b32 v41, v40
  s_nop 1
  v_permlane16_swap_b32 v40, v41
  v_max_f32 v40, v40, v41
  v_mov_b32 v41, v40
  s_nop 1
  v_permlane32_swap_b32 v40, v41
  v_max_f32 v40, v40, v41
  v_sub_f32 v12, v12, v40
  v_sub_f32 v13, v13, v40
  v_sub_f32 v14, v14, v40
  v_sub_f32 v15, v15, v40
  v_sub_f32 v16, v16, v40
  v_sub_f32 v17, v17, v40
  v_sub_f32 v18, v18, v40
  v_sub_f32 v19, v19, v40
  v_sub_f32 v28, v28, v40
  v_sub_f32 v29, v29, v40
  v_sub_f32 v30, v30, v40
  v_sub_f32 v31, v31, v40
  v_exp_f32 v12, v12
  v_exp_f32 v13, v13
  v_exp_f32 v14, v14
  v_exp_f32 v15, v15
  v_exp_f32 v16, v16
  v_exp_f32 v17, v17
  v_exp_f32 v18, v18
  v_exp_f32 v19, v19
  v_exp_f32 v28, v28
  v_exp_f32 v29, v29
  v_exp_f32 v30, v30
  v_exp_f32 v31, v31
  v_add_f32 v42, v28, v29
  v_add_f32 v43, v30, v31
  v_add_f32 v42, v42, v43
  v_mul_f32 v42, 0.5, v42
  v_add_f32 v42, v42, v12
  v_add_f32 v42, v42, v13
  v_add_f32 v42, v42, v14
  v_add_f32 v42, v42, v15
  v_add_f32 v42, v42, v16
  v_add_f32 v42, v42, v17
  v_add_f32 v42, v42, v18
  v_add_f32 v42, v42, v19
  v_mov_b32 v41, v42
  s_nop 1
  v_permlane16_swap_b32 v42, v41
  v_add_f32 v42, v42, v41
  v_mov_b32 v41, v42
  s_nop 1
  v_permlane32_swap_b32 v42, v41
  v_add_f32 v42, v42, v41
  v_rcp_f32 v42, v42
  s_nop 0
  v_mul_f32 v12, v12, v42
  v_mul_f32 v13, v13, v42
  v_mul_f32 v14, v14, v42
  v_mul_f32 v15, v15, v42
  v_mul_f32 v16, v16, v42
  v_mul_f32 v17, v17, v42
  v_mul_f32 v18, v18, v42
  v_mul_f32 v19, v19, v42
  v_mul_f32 v28, v28, v42
  v_mul_f32 v29, v29, v42
  v_mul_f32 v30, v30, v42
  v_mul_f32 v31, v31, v42
  v_cvt_pk_bf16_f32 v52, v12, v13
  v_cvt_pk_bf16_f32 v53, v14, v15
  v_cvt_pk_bf16_f32 v54, v16, v17
  v_cvt_pk_bf16_f32 v55, v18, v19
  v_cvt_pk_bf16_f32 v56, v28, v29
  v_cvt_pk_bf16_f32 v57, v30, v31
  v_min_u32 v52, -2, v52
  v_min_u32 v53, -2, v53
  v_min_u32 v54, -2, v54
  v_min_u32 v55, -2, v55
  v_min_u32 v56, -2, v56
  v_min_u32 v57, -2, v57
  buffer_store_dwordx4 v[52:55], v2, s[8:11], s26 offen sc1
  s_mov_b64 exec, s[50:51]
  buffer_store_dwordx2 v[56:57], v2, s[8:11], s27 offen sc1
  s_mov_b64 exec, -1
  s_lshl_b32 s25, s17, 7
  s_add_u32 s25, s25, 88561664
  v_mov_b32 v5, 1
  v_mov_b32 v6, 0
  s_waitcnt vmcnt(0)
  s_mov_b64 exec, 1
  buffer_atomic_add v5, v6, s[8:11], s25 offen
  s_mov_b64 exec, -1
  s_branch wk_loop
wk_toko:
  s_lshl_b32 s20, s18, 2
  s_add_u32 s20, s20, s16
  s_mul_i32 s24, s20, 65
  s_add_u32 s24, s24, s17
  s_lshl_b32 s24, s24, 13
  s_add_u32 s24, s24, 76935168
  s_lshl_b32 s21, s20, 6
  s_add_u32 s21, s21, s17
  s_mul_i32 s21, s21, 28672
  s_add_u32 s21, s21, 42205184
  s_lshl_b32 s25, s17, 1
  s_mul_i32 s25, s25, 20480
  s_add_u32 s25, s25, 85446656
  v_lshrrev_b32 v8, 5, v1
  v_and_b32 v9, 31, v1
  v_min_u32 v5, 27, v9
  v_mad_u32_u24 v5, v8, 28, v5
  v_lshlrev_b32 v5, 4, v5
  v_lshrrev_b32 v10, 4, v9
  v_lshlrev_b32 v7, 10, v10
  v_lshl_add_u32 v7, v4, 4, v7
  v_lshl_add_u32 v7, v8, 3, v7
  v_mul_u32_u24 v6, 20480, v10
  v_lshl_add_u32 v6, v8, 8, v6
  v_lshl_add_u32 v6, v4, 4, v6
  s_lshr_b32 s26, s17, 3
  s_lshl_b32 s26, s26, 4
  s_add_u32 s26, s26, s20
  s_lshl_b32 s26, s26, 7
  s_add_u32 s26, s26, 88528896
  v_mov_b32 v60, 0
  s_mov_b32 s30, 0
wo_wv:
  buffer_load_dword v61, v60, s[8:11], s26 offen sc1
  s_waitcnt vmcnt(0)
  v_cmp_ne_u32 vcc, 56, v61
  s_cbranch_vccz wo_wv_ok
  s_sleep 1
  s_cmp_ge_u32 s17, 61
  s_cbranch_scc1 wo_wv_bo
  s_sleep 4
  s_cmp_ge_u32 s17, 56
  s_cbranch_scc1 wo_wv_bo
  s_sleep 40
wo_wv_bo:
  s_add_u32 s30, s30, 1
  s_cmp_lt_u32 s30, 30000
  s_cbranch_scc1 wo_wv
  s_branch wo_abort
wo_wv_ok:
  s_add_u32 s22, s21, 0
  buffer_load_dwordx4 a[0:3], v5, s[8:11], s22 offen offset:0 sc1
  buffer_load_dwordx4 a[4:7], v5, s[8:11], s22 offen offset:896 sc1
  buffer_load_dwordx4 a[8:11], v5, s[8:11], s22 offen offset:1792 sc1
  buffer_load_dwordx4 a[12:15], v5, s[8:11], s22 offen offset:2688 sc1
  s_add_u32 s22, s21, 3584
  buffer_load_dwordx4 a[16:19], v5, s[8:11], s22 offen offset:0 sc1
  buffer_load_dwordx4 a[20:23], v5, s[8:11], s22 offen offset:896 sc1
  buffer_load_dwordx4 a[24:27], v5, s[8:11], s22 offen offset:1792 sc1
  buffer_load_dwordx4 a[28:31], v5, s[8:11], s22 offen offset:2688 sc1
  s_add_u32 s22, s21, 7168
  buffer_load_dwordx4 a[32:35], v5, s[8:11], s22 offen offset:0 sc1
  buffer_load_dwordx4 a[36:39], v5, s[8:11], s22 offen offset:896 sc1
  buffer_load_dwordx4 a[40:43], v5, s[8:11], s22 offen offset:1792 sc1
  buffer_load_dwordx4 a[44:47], v5, s[8:11], s22 offen offset:2688 sc1
  s_add_u32 s22, s21, 10752
  buffer_load_dwordx4 a[48:51], v5, s[8:11], s22 offen offset:0 sc1
  buffer_load_dwordx4 a[52:55], v5, s[8:11], s22 offen offset:896 sc1
  buffer_load_dwordx4 a[56:59], v5, s[8:11], s22 offen offset:1792 sc1
  buffer_load_dwordx4 a[60:63], v5, s[8:11], s22 offen offset:2688 sc1
  s_add_u32 s22, s21, 14336
  buffer_load_dwordx4 a[64:67], v5, s[8:11], s22 offen offset:0 sc1
  buffer_load_dwordx4 a[68:71], v5, s[8:11], s22 offen offset:896 sc1
  buffer_load_dwordx4 a[72:75], v5, s[8:11], s22 offen offset:1792 sc1
  buffer_load_dwordx4 a[76:79], v5, s[8:11], s22 offen offset:2688 sc1
  s_add_u32 s22, s21, 17920
  buffer_load_dwordx4 a[80:83], v5, s[8:11], s22 offen offset:0 sc1
  buffer_load_dwordx4 a[84:87], v5, s[8:11], s22 offen offset:896 sc1
  buffer_load_dwordx4 a[88:91], v5, s[8:11], s22 offen offset:1792 sc1
  buffer_load_dwordx4 a[92:95], v5, s[8:11], s22 offen offset:2688 sc1
  s_add_u32 s22, s21, 21504
  buffer_load_dwordx4 a[96:99], v5, s[8:11], s22 offen offset:0 sc1
  buffer_load_dwordx4 a[100:103], v5, s[8:11], s22 offen offset:896 sc1
  buffer_load_dwordx4 a[104:107], v5, s[8:11], s22 offen offset:1792 sc1
  buffer_load_dwordx4 a[108:111], v5, s[8:11], s22 offen offset:2688 sc1
  s_add_u32 s22, s21, 25088
  buffer_load_dwordx4 a[112:115], v5, s[8:11], s22 offen offset:0 sc1
  buffer_load_dwordx4 a[116:119], v5, s[8:11], s22 offen offset:896 sc1
  buffer_load_dwordx4 a[120:123], v5, s[8:11], s22 offen offset:1792 sc1
  buffer_load_dwordx4 a[124:127], v5, s[8:11], s22 offen offset:2688 sc1
  s_cmp_ge_u32 s17, 61
  s_cbranch_scc1 wo_lm
  s_lshl_b32 s26, s17, 7
  s_add_u32 s26, s26, 88561664
  v_mov_b32 v60, 0
  s_mov_b32 s30, 0
wo_wp:
  buffer_load_dword v61, v60, s[8:11], s26 offen sc1
  s_waitcnt vmcnt(0)
  v_cmp_ne_u32 vcc, 16, v61
  s_cbranch_vccz wo_wp_ok
  s_sleep 2
  s_cmp_ge_u32 s17, 61
  s_cbranch_scc1 wo_wp_bo
  s_sleep 4
  s_cmp_ge_u32 s17, 56
  s_cbranch_scc1 wo_wp_bo
  s_sleep 40
wo_wp_bo:
  s_add_u32 s30, s30, 1
  s_cmp_lt_u32 s30, 30000
  s_cbranch_scc1 wo_wp
  s_branch wo_abort
wo_wp_ok:
  s_branch wo_lp
wo_lm:
  s_mul_i32 s26, s17, 7168
  s_add_u32 s26, s26, 88068096
  v_mov_b32 v60, 0
  s_mov_b32 s30, 0
wo_wm:
  buffer_load_dword v61, v60, s[8:11], s26 offen sc1
  s_waitcnt vmcnt(0)
  v_cmp_eq_u32 vcc, -1, v61
  s_cbranch_vccz wo_wm_ok
  s_sleep 2
  s_cmp_ge_u32 s17, 61
  s_cbranch_scc1 wo_wm_bo
  s_sleep 4
  s_cmp_ge_u32 s17, 56
  s_cbranch_scc1 wo_wm_bo
  s_sleep 40
wo_wm_bo:
  s_add_u32 s30, s30, 1
  s_cmp_lt_u32 s30, 30000
  s_cbranch_scc1 wo_wm
  s_branch wo_abort
wo_wm_ok:
wo_lp:
  s_mul_i32 s26, s16, 10240
  s_add_u32 s27, s25, s26
  v_add_u32 v11, s26, v2
  s_lshl_b32 s26, s20, 6
  s_add_u32 s26, s26, s17
  s_lshl_b32 s26, s26, 4
  s_add_u32 s26, s26, 88569856
  v_lshlrev_b32 v60, 2, v3
  s_mov_b32 s30, 0
wo_pl:
  s_add_u32 s22, s27, 0
  buffer_load_dwordx4 v[128:131], v2, s[8:11], s22 offen offset:0 sc1
  buffer_load_dwordx4 v[132:135], v2, s[8:11], s22 offen offset:1024 sc1
  buffer_load_dwordx4 v[136:139], v2, s[8:11], s22 offen offset:2048 sc1
  buffer_load_dwordx4 v[140:143], v2, s[8:11], s22 offen offset:3072 sc1
  s_add_u32 s22, s27, 4096
  buffer_load_dwordx4 v[144:147], v2, s[8:11], s22 offen offset:0 sc1
  buffer_load_dwordx4 v[148:151], v2, s[8:11], s22 offen offset:1024 sc1
  buffer_load_dwordx4 v[152:155], v2, s[8:11], s22 offen offset:2048 sc1
  buffer_load_dwordx4 v[156:159], v2, s[8:11], s22 offen offset:3072 sc1
  s_add_u32 s22, s27, 8192
  buffer_load_dwordx4 v[160:163], v2, s[8:11], s22 offen offset:0 sc1
  buffer_load_dwordx4 v[164:167], v2, s[8:11], s22 offen offset:1024 sc1
  buffer_load_dword v61, v60, s[8:11], s26 offen sc1
  s_waitcnt vmcnt(1)
  v_max_u32 v62, v128, v129
  v_max3_u32 v62, v62, v130, v131
  v_max3_u32 v62, v62, v132, v133
  v_max3_u32 v62, v62, v134, v135
  v_max3_u32 v62, v62, v136, v137
  v_max3_u32 v62, v62, v138, v139
  v_max3_u32 v62, v62, v140, v141
  v_max3_u32 v62, v62, v142, v143
  v_max3_u32 v62, v62, v144, v145
  v_max3_u32 v62, v62, v146, v147
  v_max3_u32 v62, v62, v148, v149
  v_max3_u32 v62, v62, v150, v151
  v_max3_u32 v62, v62, v152, v153
  v_max3_u32 v62, v62, v154, v155
  v_max3_u32 v62, v62, v156, v157
  v_max3_u32 v62, v62, v158, v159
  v_max3_u32 v62, v62, v160, v161
  v_max3_u32 v62, v62, v162, v163
  v_max3_u32 v62, v62, v164, v165
  v_max3_u32 v62, v62, v166, v167
  v_cmp_eq_u32 vcc, -1, v62
  s_cbranch_vccz wo_pk
  s_add_u32 s30, s30, 1
  s_cmp_lt_u32 s30, 30000
  s_cbranch_scc1 wo_pl
  s_branch wo_abort
wo_pk:
  ds_write_b128 v11, v[128:131] offset:0
  ds_write_b128 v11, v[132:135] offset:1024
  ds_write_b128 v11, v[136:139] offset:2048
  ds_write_b128 v11, v[140:143] offset:3072
  ds_write_b128 v11, v[144:147] offset:4096
  ds_write_b128 v11, v[148:151] offset:5120
  ds_write_b128 v11, v[152:155] offset:6144
  ds_write_b128 v11, v[156:159] offset:7168
  ds_write_b128 v11, v[160:163] offset:8192
  ds_write_b128 v11, v[164:167] offset:9216
  s_waitcnt vmcnt(0)
  v_cmp_ne_u32 vcc, 1, v61
  s_mov_b32 s28, 0
  s_cbranch_vccnz wo_nt
  s_add_u32 s22, s24, 0
  buffer_load_dwordx2 v[28:29], v7, s[8:11], s22 offen offset:0 sc1
  buffer_load_dwordx2 v[30:31], v7, s[8:11], s22 offen offset:512 sc1
  buffer_load_dwordx2 v[32:33], v7, s[8:11], s22 offen offset:256 sc1
  buffer_load_dwordx2 v[34:35], v7, s[8:11], s22 offen offset:768 sc1
  buffer_load_dwordx2 v[36:37], v7, s[8:11], s22 offen offset:2048 sc1
  buffer_load_dwordx2 v[38:39], v7, s[8:11], s22 offen offset:2560 sc1
  buffer_load_dwordx2 v[40:41], v7, s[8:11], s22 offen offset:2304 sc1
  buffer_load_dwordx2 v[42:43], v7, s[8:11], s22 offen offset:2816 sc1
  s_add_u32 s22, s24, 4096
  buffer_load_dwordx2 v[44:45], v7, s[8:11], s22 offen offset:0 sc1
  buffer_load_dwordx2 v[46:47], v7, s[8:11], s22 offen offset:512 sc1
  buffer_load_dwordx2 v[48:49], v7, s[8:11], s22 offen offset:256 sc1
  buffer_load_dwordx2 v[50:51], v7, s[8:11], s22 offen offset:768 sc1
  buffer_load_dwordx2 v[52:53], v7, s[8:11], s22 offen offset:2048 sc1
  buffer_load_dwordx2 v[54:55], v7, s[8:11], s22 offen offset:2560 sc1
  buffer_load_dwordx2 v[56:57], v7, s[8:11], s22 offen offset:2304 sc1
  buffer_load_dwordx2 v[58:59], v7, s[8:11], s22 offen offset:2816 sc1
  s_mov_b32 s28, 1
wo_nt:
  s_cmp_lt_u32 s17, 56
  s_cbranch_scc1 pk_45
  buffer_load_dword v250, v251, s[12:15], 0 offen sc1
pk_45:
  s_waitcnt lgkmcnt(0)
  s_barrier
  buffer_load_dword v61, v60, s[8:11], s26 offen sc1
  ds_read_b128 v[64:67], v6 offset:0
  ds_read_b128 v[68:71], v6 offset:512
  ds_read_b128 v[72:75], v6 offset:1024
  ds_read_b128 v[76:79], v6 offset:1536
  ds_read_b128 v[80:83], v6 offset:2048
  ds_read_b128 v[84:87], v6 offset:2560
  ds_read_b128 v[88:91], v6 offset:3072
  s_waitcnt lgkmcnt(6)
  v_mfma_f32_32x32x16_bf16 v[12:27], a[0:3], v[64:67], 0
  ds_read_b128 v[92:95], v6 offset:3584
  s_waitcnt lgkmcnt(6)
  v_mfma_f32_32x32x16_bf16 v[12:27], a[4:7], v[68:71], v[12:27]
  ds_read_b128 v[64:67], v6 offset:4096
  s_waitcnt lgkmcnt(6)
  v_mfma_f32_32x32x16_bf16 v[12:27], a[8:11], v[72:75], v[12:27]
  ds_read_b128 v[68:71], v6 offset:4608
  s_waitcnt lgkmcnt(6)
  v_mfma_f32_32x32x16_bf16 v[12:27], a[12:15], v[76:79], v[12:27]
  ds_read_b128 v[72:75], v6 offset:5120
  s_waitcnt lgkmcnt(6)
  v_mfma_f32_32x32x16_bf16 v[12:27], a[16:19], v[80:83], v[12:27]
  ds_read_b128 v[76:79], v6 offset:5632
  s_waitcnt lgkmcnt(6)
  v_mfma_f32_32x32x16_bf16 v[12:27], a[20:23], v[84:87], v[12:27]
  ds_read_b128 v[80:83], v6 offset:6144
  s_waitcnt lgkmcnt(6)
  v_mfma_f32_32x32x16_bf16 v[12:27], a[24:27], v[88:91], v[12:27]
  ds_read_b128 v[84:87], v6 offset:6656
  s_waitcnt lgkmcnt(6)
  v_mfma_f32_32x32x16_bf16 v[12:27], a[28:31], v[92:95], v[12:27]
  ds_read_b128 v[88:91], v6 offset:7168
  s_waitcnt lgkmcnt(6)
  v_mfma_f32_32x32x16_bf16 v[12:27], a[32:35], v[64:67], v[12:27]
  ds_read_b128 v[92:95], v6 offset:7680
  s_waitcnt lgkmcnt(6)
  v_mfma_f32_32x32x16_bf16 v[12:27], a[36:39], v[68:71], v[12:27]
  ds_read_b128 v[64:67], v6 offset:8192
  s_waitcnt lgkmcnt(6)
  v_mfma_f32_32x32x16_bf16 v[12:27], a[40:43], v[72:75], v[12:27]
  ds_read_b128 v[68:71], v6 offset:8704
  s_waitcnt lgkmcnt(6)
  v_mfma_f32_32x32x16_bf16 v[12:27], a[44:47], v[76:79], v[12:27]
  ds_read_b128 v[72:75], v6 offset:9216
  s_waitcnt lgkmcnt(6)
  v_mfma_f32_32x32x16_bf16 v[12:27], a[48:51], v[80:83], v[12:27]
  ds_read_b128 v[76:79], v6 offset:9728
  s_waitcnt lgkmcnt(6)
  v_mfma_f32_32x32x16_bf16 v[12:27], a[52:55], v[84:87], v[12:27]
  ds_read_b128 v[80:83], v6 offset:10240
  s_waitcnt lgkmcnt(6)
  v_mfma_f32_32x32x16_bf16 v[12:27], a[56:59], v[88:91], v[12:27]
  ds_read_b128 v[84:87], v6 offset:10752
  s_waitcnt lgkmcnt(6)
  v_mfma_f32_32x32x16_bf16 v[12:27], a[60:63], v[92:95], v[12:27]
  ds_read_b128 v[88:91], v6 offset:11264
  s_waitcnt lgkmcnt(6)
  v_mfma_f32_32x32x16_bf16 v[12:27], a[64:67], v[64:67], v[12:27]
  ds_read_b128 v[92:95], v6 offset:11776
  s_waitcnt lgkmcnt(6)
  v_mfma_f32_32x32x16_bf16 v[12:27], a[68:71], v[68:71], v[12:27]
  ds_read_b128 v[64:67], v6 offset:12288
  s_waitcnt lgkmcnt(6)
  v_mfma_f32_32x32x16_bf16 v[12:27], a[72:75], v[72:75], v[12:27]
  ds_read_b128 v[68:71], v6 offset:12800
  s_waitcnt lgkmcnt(6)
  v_mfma_f32_32x32x16_bf16 v[12:27], a[76:79], v[76:79], v[12:27]
  s_cmp_lg_u32 s28, 0
  s_cbranch_scc1 wo_h2
  s_waitcnt vmcnt(0)
  v_cmp_ne_u32 vcc, 1, v61
  s_cbranch_vccnz wo_h2
  s_add_u32 s22, s24, 0
  buffer_load_dwordx2 v[28:29], v7, s[8:11], s22 offen offset:0 sc1
  buffer_load_dwordx2 v[30:31], v7, s[8:11], s22 offen offset:512 sc1
  buffer_load_dwordx2 v[32:33], v7, s[8:11], s22 offen offset:256 sc1
  buffer_load_dwordx2 v[34:35], v7, s[8:11], s22 offen offset:768 sc1
  buffer_load_dwordx2 v[36:37], v7, s[8:11], s22 offen offset:2048 sc1
  buffer_load_dwordx2 v[38:39], v7, s[8:11], s22 offen offset:2560 sc1
  buffer_load_dwordx2 v[40:41], v7, s[8:11], s22 offen offset:2304 sc1
  buffer_load_dwordx2 v[42:43], v7, s[8:11], s22 offen offset:2816 sc1
  s_add_u32 s22, s24, 4096
  buffer_load_dwordx2 v[44:45], v7, s[8:11], s22 offen offset:0 sc1
  buffer_load_dwordx2 v[46:47], v7, s[8:11], s22 offen offset:512 sc1
  buffer_load_dwordx2 v[48:49], v7, s[8:11], s22 offen offset:256 sc1
  buffer_load_dwordx2 v[50:51], v7, s[8:11], s22 offen offset:768 sc1
  buffer_load_dwordx2 v[52:53], v7, s[8:11], s22 offen offset:2048 sc1
  buffer_load_dwordx2 v[54:55], v7, s[8:11], s22 offen offset:2560 sc1
  buffer_load_dwordx2 v[56:57], v7, s[8:11], s22 offen offset:2304 sc1
  buffer_load_dwordx2 v[58:59], v7, s[8:11], s22 offen offset:2816 sc1
  s_mov_b32 s28, 1
wo_h2:
  ds_read_b128 v[72:75], v6 offset:13312
  s_waitcnt lgkmcnt(6)
  v_mfma_f32_32x32x16_bf16 v[12:27], a[80:83], v[80:83], v[12:27]
  ds_read_b128 v[76:79], v6 offset:13824
  s_waitcnt lgkmcnt(6)
  v_mfma_f32_32x32x16_bf16 v[12:27], a[84:87], v[84:87], v[12:27]
  ds_read_b128 v[80:83], v6 offset:14336
  s_waitcnt lgkmcnt(6)
  v_mfma_f32_32x32x16_bf16 v[12:27], a[88:91], v[88:91], v[12:27]
  ds_read_b128 v[84:87], v6 offset:14848
  s_waitcnt lgkmcnt(6)
  v_mfma_f32_32x32x16_bf16 v[12:27], a[92:95], v[92:95], v[12:27]
  ds_read_b128 v[88:91], v6 offset:15360
  s_waitcnt lgkmcnt(6)
  v_mfma_f32_32x32x16_bf16 v[12:27], a[96:99], v[64:67], v[12:27]
  ds_read_b128 v[92:95], v6 offset:15872
  s_waitcnt lgkmcnt(6)
  v_mfma_f32_32x32x16_bf16 v[12:27], a[100:103], v[68:71], v[12:27]
  ds_read_b128 v[64:67], v6 offset:16384
  s_waitcnt lgkmcnt(6)
  v_mfma_f32_32x32x16_bf16 v[12:27], a[104:107], v[72:75], v[12:27]
  ds_read_b128 v[68:71], v6 offset:16896
  s_waitcnt lgkmcnt(6)
  v_mfma_f32_32x32x16_bf16 v[12:27], a[108:111], v[76:79], v[12:27]
  ds_read_b128 v[72:75], v6 offset:17408
  s_waitcnt lgkmcnt(6)
  v_mfma_f32_32x32x16_bf16 v[12:27], a[112:115], v[80:83], v[12:27]
  ds_read_b128 v[76:79], v6 offset:17920
  s_waitcnt lgkmcnt(6)
  v_mfma_f32_32x32x16_bf16 v[12:27], a[116:119], v[84:87], v[12:27]
  ds_read_b128 v[80:83], v6 offset:18432
  s_waitcnt lgkmcnt(6)
  v_mfma_f32_32x32x16_bf16 v[12:27], a[120:123], v[88:91], v[12:27]
  ds_read_b128 v[84:87], v6 offset:18944
  s_waitcnt lgkmcnt(6)
  v_mfma_f32_32x32x16_bf16 v[12:27], a[124:127], v[92:95], v[12:27]
  s_cmp_lg_u32 s28, 0
  s_cbranch_scc1 wo_ht
  v_lshlrev_b32 v60, 2, v3
  s_mov_b32 s30, 0
wo_wt:
  buffer_load_dword v61, v60, s[8:11], s26 offen sc1
  s_waitcnt vmcnt(0)
  v_cmp_ne_u32 vcc, 1, v61
  s_cbranch_vccz wo_wt_ok
  s_sleep 1
  s_cmp_ge_u32 s17, 61
  s_cbranch_scc1 wo_wt_bo
  s_sleep 4
  s_cmp_ge_u32 s17, 56
  s_cbranch_scc1 wo_wt_bo
  s_sleep 40
wo_wt_bo:
  s_add_u32 s30, s30, 1
  s_cmp_lt_u32 s30, 30000
  s_cbranch_scc1 wo_wt
  s_branch wo_abort
wo_wt_ok:
  s_add_u32 s22, s24, 0
  buffer_load_dwordx2 v[28:29], v7, s[8:11], s22 offen offset:0 sc1
  buffer_load_dwordx2 v[30:31], v7, s[8:11], s22 offen offset:512 sc1
  buffer_load_dwordx2 v[32:33], v7, s[8:11], s22 offen offset:256 sc1
  buffer_load_dwordx2 v[34:35], v7, s[8:11], s22 offen offset:768 sc1
  buffer_load_dwordx2 v[36:37], v7, s[8:11], s22 offen offset:2048 sc1
  buffer_load_dwordx2 v[38:39], v7, s[8:11], s22 offen offset:2560 sc1
  buffer_load_dwordx2 v[40:41], v7, s[8:11], s22 offen offset:2304 sc1
  buffer_load_dwordx2 v[42:43], v7, s[8:11], s22 offen offset:2816 sc1
  s_add_u32 s22, s24, 4096
  buffer_load_dwordx2 v[44:45], v7, s[8:11], s22 offen offset:0 sc1
  buffer_load_dwordx2 v[46:47], v7, s[8:11], s22 offen offset:512 sc1
  buffer_load_dwordx2 v[48:49], v7, s[8:11], s22 offen offset:256 sc1
  buffer_load_dwordx2 v[50:51], v7, s[8:11], s22 offen offset:768 sc1
  buffer_load_dwordx2 v[52:53], v7, s[8:11], s22 offen offset:2048 sc1
  buffer_load_dwordx2 v[54:55], v7, s[8:11], s22 offen offset:2560 sc1
  buffer_load_dwordx2 v[56:57], v7, s[8:11], s22 offen offset:2304 sc1
  buffer_load_dwordx2 v[58:59], v7, s[8:11], s22 offen offset:2816 sc1
wo_ht:
  ds_read_b128 v[88:91], v6 offset:19456
  s_waitcnt lgkmcnt(6) vmcnt(0)
  v_mfma_f32_32x32x16_bf16 v[12:27], v[28:31], v[64:67], v[12:27]
  ds_read_b128 v[92:95], v6 offset:19968
  s_waitcnt lgkmcnt(6)
  v_mfma_f32_32x32x16_bf16 v[12:27], v[32:35], v[68:71], v[12:27]
  s_waitcnt lgkmcnt(5)
  v_mfma_f32_32x32x16_bf16 v[12:27], v[36:39], v[72:75], v[12:27]
  s_waitcnt lgkmcnt(4)
  v_mfma_f32_32x32x16_bf16 v[12:27], v[40:43], v[76:79], v[12:27]
  s_waitcnt lgkmcnt(3)
  v_mfma_f32_32x32x16_bf16 v[12:27], v[44:47], v[80:83], v[12:27]
  s_waitcnt lgkmcnt(2)
  v_mfma_f32_32x32x16_bf16 v[12:27], v[48:51], v[84:87], v[12:27]
  s_waitcnt lgkmcnt(1)
  v_mfma_f32_32x32x16_bf16 v[12:27], v[52:55], v[88:91], v[12:27]
  s_waitcnt lgkmcnt(0)
  v_mfma_f32_32x32x16_bf16 v[12:27], v[56:59], v[92:95], v[12:27]
  v_mul_u32_u24 v9, 240, v9
  s_movk_i32 s23, 240
  v_lshl_add_u32 v8, v8, 3, v9
  s_mul_i32 s22, s16, 56
  v_add_u32 v8, s22, v8
  v_min_u32 v11, 223, v0
  v_mul_u32_u24 v9, 4682, v11
  v_lshrrev_b32 v9, 16, v9
  v_mul_u32_u24 v10, 14, v9
  v_sub_u32 v10, v11, v10
  v_lshlrev_b32 v10, 4, v10
  v_mad_u32_u24 v11, v9, s23, v10
  v_mul_u32_u24 v9, 1792, v9
  v_add_u32 v10, v9, v10
  s_mul_i32 s26, s17, 57344
  s_mul_i32 s22, s18, 224
  s_add_u32 s26, s26, s22
  s_add_u32 s26, s26, 896
  s_add_u32 s27, s26, 28672
  v_cvt_pk_bf16_f32 v96, v12, v13
  v_cvt_pk_bf16_f32 v97, v14, v15
  ds_write_b64 v8, v[96:97] offset:49152
  v_cvt_pk_bf16_f32 v98, v16, v17
  v_cvt_pk_bf16_f32 v99, v18, v19
  ds_write_b64 v8, v[98:99] offset:49168
  v_cvt_pk_bf16_f32 v100, v20, v21
  v_cvt_pk_bf16_f32 v101, v22, v23
  ds_write_b64 v8, v[100:101] offset:49184
  v_cvt_pk_bf16_f32 v102, v24, v25
  v_cvt_pk_bf16_f32 v103, v26, v27
  s_mov_b32 exec_hi, 0
  ds_write_b64 v8, v[102:103] offset:49200
  s_mov_b64 exec, -1
  s_waitcnt lgkmcnt(0)
  s_barrier
  ds_read_b128 v[104:107], v11 offset:49152
  ds_read_b128 v[108:111], v11 offset:52992
  s_cmp_lg_u32 s16, 3
  s_cselect_b32 exec_hi, -1, 0
  s_waitcnt lgkmcnt(1)
  buffer_store_dwordx4 v[104:107], v10, s[92:95], s26 offen
  s_waitcnt lgkmcnt(0)
  buffer_store_dwordx4 v[108:111], v10, s[92:95], s27 offen
  s_mov_b64 exec, -1
  v_readfirstlane_b32 s22, v250
  s_cmp_ge_u32 s22, 1376
  s_cbranch_scc1 ch_end
  s_branch wk_loop
wp_abort:
wo_abort:
  s_branch cA_abort
ch_end:
  s_endpgm

.section .rodata,"a"
.p2align 6
.amdhsa_kernel main_kernel
  .amdhsa_next_free_vgpr 512
  .amdhsa_next_free_sgpr 102
  .amdhsa_accum_offset 256
  .amdhsa_group_segment_fixed_size 0
  .amdhsa_kernarg_size 136
  .amdhsa_user_sgpr_count 2
  .amdhsa_user_sgpr_kernarg_segment_ptr 1
  .amdhsa_system_sgpr_workgroup_id_x 1
.end_amdhsa_kernel
```

```asm
; @launch kernel=main_kernel grid=(256,1,1) block=(256,1,1) lds=163840
.amdgcn_target "amdgcn-amd-amdhsa--gfx950"
.text
.globl main_kernel
.p2align 8
.type main_kernel,@function
main_kernel:
  s_cmp_ge_u32 s2, 256
  s_cbranch_scc1 ch_end
  s_load_dwordx4 s[4:7], s[0:1], 120
  s_load_dwordx2 s[92:93], s[0:1], 112
  s_load_dwordx8 s[36:43], s[0:1], 56
  s_load_dwordx4 s[44:47], s[0:1], 88
  s_memrealtime s[88:89]
  s_getpc_b64 s[98:99]
pf_main_kernel_1:
  s_sub_u32 s98, s98, pf_main_kernel_1-main_kernel
  s_subb_u32 s99, s99, 0
  s_lshr_b32 s20, s2, 3
  v_lshl_add_u32 v60, v0, 5, s20
  v_lshlrev_b32 v60, 7, v60
  v_min_u32 v60, ch_end-main_kernel-4, v60
  v_cmp_gt_u32 vcc, 32, v0
  s_and_saveexec_b64 s[22:23], vcc
  s_cbranch_execz pf_main_kernel_1_n
  global_load_dword v62, v60, s[98:99]
pf_main_kernel_1_n:
  s_mov_b64 exec, -1
  s_getreg_b32 s67, hwreg(HW_REG_XCC_ID)
  s_and_b32 s67, s67, 7
  v_lshrrev_b32 v1, 6, v0
  s_nop 0
  v_readfirstlane_b32 s16, v1
  s_mov_b32 s66, 0
  s_mov_b32 s68, 0
  s_mov_b32 s69, 0
  s_mov_b32 s96, 0
  s_mov_b32 s97, 0
  s_mov_b32 s101, 0x5eed0000
  s_sub_u32 s20, s67, 0
  s_lshr_b32 s21, s2, 3
  s_and_b32 s20, s20, 7
  s_lshl_b32 s3, s20, 5
  s_add_u32 s3, s3, s21
  s_waitcnt lgkmcnt(0)
  s_mov_b32 s8, s6
  s_and_b32 s9, s7, 0xffff
  s_mov_b32 s10, 0x10000000
  s_mov_b32 s11, 0x20000
  s_mov_b32 s12, s4
  s_and_b32 s13, s5, 0xffff
  s_mov_b32 s14, 256
  s_mov_b32 s15, 0x20000
  s_or_b32 s88, s88, 1
  s_and_b32 s93, s93, 0xffff
  s_mov_b32 s94, 3670016
  s_mov_b32 s95, 0x20000
m_start:
  s_cmp_ge_u32 s3, 32
  s_cbranch_scc1 m_bjob
  v_and_b32 v1, 63, v0
  v_lshlrev_b32 v2, 4, v1
  v_lshrrev_b32 v116, 4, v1
  v_and_b32 v117, 15, v1
  v_mov_b32 v3, 0x4444
  v_mov_b32 v118, 0xeeee
  v_cmp_lt_u32 vcc, 7, v117
  s_nop 1
  v_cndmask_b32 v3, v3, v118, vcc
  s_and_b32 s17, s3, 15
  s_cmp_ge_u32 s3, 16
  s_cbranch_scc1 m_val
  s_mov_b32 s60, s42
  s_and_b32 s61, s43, 0xffff
  s_mov_b32 s62, 3670016
  s_mov_b32 s63, 0x20000
  v_lshrrev_b32 v24, 5, v1
  v_and_b32 v25, 31, v1
  s_lshl_b32 s26, s17, 9
  s_lshl_b32 s25, s16, 12
  v_xor_b32 v26, v25, v24
  v_lshlrev_b32 v26, 4, v26
  v_lshl_add_u32 v26, v24, 13, v26
  v_xor_b32 v100, 0, v26
  v_xor_b32 v101, 0, v26
  v_add_u32 v101, 15360, v101
  v_xor_b32 v102, 32, v26
  v_add_u32 v102, 30720, v102
  v_xor_b32 v103, 32, v26
  v_add_u32 v103, 46080, v103
  s_lshl_b32 s23, s16, 19
  s_add_u32 s23, s23, s26
  s_add_u32 m0, s25, 16384
  s_nop 0
  buffer_load_dwordx4 v100, s[60:63], s23 offen offset:0 lds
  buffer_load_dwordx4 v101, s[60:63], s23 offen offset:1024 lds
  buffer_load_dwordx4 v102, s[60:63], s23 offen offset:2048 lds
  buffer_load_dwordx4 v103, s[60:63], s23 offen offset:3072 lds
  s_add_u32 m0, s25, 32768
  s_add_u32 s23, s23, 65536
  buffer_load_dwordx4 v100, s[60:63], s23 offen offset:0 lds
  buffer_load_dwordx4 v101, s[60:63], s23 offen offset:1024 lds
  buffer_load_dwordx4 v102, s[60:63], s23 offen offset:2048 lds
  buffer_load_dwordx4 v103, s[60:63], s23 offen offset:3072 lds
  v_xor_b32 v100, 64, v100
  v_xor_b32 v101, 64, v101
  v_xor_b32 v102, 64, v102
  v_xor_b32 v103, 64, v103
  s_add_u32 m0, s25, 49152
  s_add_u32 s23, s23, 65536
  buffer_load_dwordx4 v100, s[60:63], s23 offen offset:0 lds
  buffer_load_dwordx4 v101, s[60:63], s23 offen offset:1024 lds
  buffer_load_dwordx4 v102, s[60:63], s23 offen offset:2048 lds
  buffer_load_dwordx4 v103, s[60:63], s23 offen offset:3072 lds
  s_add_u32 m0, s25, 65536
  s_add_u32 s23, s23, 65536
  buffer_load_dwordx4 v100, s[60:63], s23 offen offset:0 lds
  buffer_load_dwordx4 v101, s[60:63], s23 offen offset:1024 lds
  buffer_load_dwordx4 v102, s[60:63], s23 offen offset:2048 lds
  buffer_load_dwordx4 v103, s[60:63], s23 offen offset:3072 lds
  v_xor_b32 v100, 192, v100
  v_xor_b32 v101, 192, v101
  v_xor_b32 v102, 192, v102
  v_xor_b32 v103, 192, v103
  s_add_u32 m0, s25, 81920
  s_add_u32 s23, s23, 65536
  buffer_load_dwordx4 v100, s[60:63], s23 offen offset:0 lds
  buffer_load_dwordx4 v101, s[60:63], s23 offen offset:1024 lds
  buffer_load_dwordx4 v102, s[60:63], s23 offen offset:2048 lds
  buffer_load_dwordx4 v103, s[60:63], s23 offen offset:3072 lds
  s_add_u32 m0, s25, 98304
  s_add_u32 s23, s23, 65536
  buffer_load_dwordx4 v100, s[60:63], s23 offen offset:0 lds
  buffer_load_dwordx4 v101, s[60:63], s23 offen offset:1024 lds
  buffer_load_dwordx4 v102, s[60:63], s23 offen offset:2048 lds
  buffer_load_dwordx4 v103, s[60:63], s23 offen offset:3072 lds
  v_xor_b32 v100, 64, v100
  v_xor_b32 v101, 64, v101
  v_xor_b32 v102, 64, v102
  v_xor_b32 v103, 64, v103
  s_add_u32 m0, s25, 114688
  s_add_u32 s23, s23, 65536
  buffer_load_dwordx4 v100, s[60:63], s23 offen offset:0 lds
  buffer_load_dwordx4 v101, s[60:63], s23 offen offset:1024 lds
  buffer_load_dwordx4 v102, s[60:63], s23 offen offset:2048 lds
  buffer_load_dwordx4 v103, s[60:63], s23 offen offset:3072 lds
  s_add_u32 m0, s25, 131072
  s_add_u32 s23, s23, 65536
  buffer_load_dwordx4 v100, s[60:63], s23 offen offset:0 lds
  buffer_load_dwordx4 v101, s[60:63], s23 offen offset:1024 lds
  buffer_load_dwordx4 v102, s[60:63], s23 offen offset:2048 lds
  buffer_load_dwordx4 v103, s[60:63], s23 offen offset:3072 lds
  s_mov_b32 s56, s40
  s_and_b32 s57, s41, 0xffff
  s_mov_b32 s58, 3670016
  s_mov_b32 s59, 0x20000
  s_lshl_b32 s21, s16, 16
  s_add_u32 s27, s26, s21
  s_lshr_b32 s20, s16, 1
  s_lshl_b32 s20, s20, 6
  v_xor_b32 v26, s20, v26
  v_xor_b32 v4, 0, v26
  v_xor_b32 v5, 32, v26
  v_add_u32 v5, 15360, v5
  v_xor_b32 v6, 128, v26
  v_add_u32 v6, 30720, v6
  v_xor_b32 v7, 160, v26
  v_add_u32 v7, 46080, v7
  s_add_u32 s22, s27, 0
  s_add_u32 m0, s25, 0
  s_nop 0
  buffer_load_dwordx4 v4, s[56:59], s22 offen offset:0 lds
  buffer_load_dwordx4 v5, s[56:59], s22 offen offset:1024 lds
  buffer_load_dwordx4 v6, s[56:59], s22 offen offset:2048 lds
  buffer_load_dwordx4 v7, s[56:59], s22 offen offset:3072 lds
  s_cmp_lg_u32 s66, 0
  s_cbranch_scc1 sc_ci
  s_cmp_lg_u32 s16, 0
  s_cbranch_scc1 w0_2
  s_lshr_b32 s70, s3, 5
  s_and_b32 s71, s70, 4
  s_mul_i32 s71, s71, 12
  s_lshl_b32 s70, s70, 2
  s_add_u32 s70, s70, s71
  s_lshl_b32 s71, 1, s3
  v_mov_b32 v248, s71
  v_mov_b32 v249, 32
  s_mov_b64 exec, 1
  buffer_atomic_or v248, v249, s[12:15], s70 offen sc0
  buffer_load_dwordx2 v[250:251], v249, s[12:15], 0 offen offset:96 sc1
  s_mov_b64 exec, -1
w0_2:
sc_ci:
  v_and_b32 v26, 15, v25
  v_xor_b32 v27, v26, v24
  v_lshlrev_b32 v27, 4, v27
  v_bfe_u32 v28, v25, 2, 1
  v_lshlrev_b32 v28, 4, v28
  v_lshrrev_b32 v29, 3, v25
  v_lshl_add_u32 v28, v29, 2, v28
  v_and_b32 v29, 3, v25
  v_add_u32 v28, v28, v29
  v_lshl_add_u32 v28, v28, 9, v27
  v_lshrrev_b32 v29, 2, v26
  v_lshlrev_b32 v29, 15, v29
  v_bfe_u32 v30, v26, 1, 1
  v_lshl_add_u32 v29, v30, 11, v29
  v_lshrrev_b32 v30, 4, v25
  v_lshl_add_u32 v29, v30, 10, v29
  v_and_b32 v31, 1, v26
  v_lshl_add_u32 v29, v31, 9, v29
  v_add_u32 v29, v29, v27
  v_add_u32 v29, s25, v29
  v_xor_b32 v8, 0, v28
  v_xor_b32 v104, 0, v29
  v_xor_b32 v9, 32, v28
  v_xor_b32 v105, 32, v29
  v_xor_b32 v10, 64, v28
  v_xor_b32 v106, 64, v29
  v_xor_b32 v11, 96, v28
  v_xor_b32 v107, 96, v29
  v_xor_b32 v12, 128, v28
  v_xor_b32 v108, 128, v29
  v_xor_b32 v13, 160, v28
  v_xor_b32 v109, 160, v29
  v_xor_b32 v14, 192, v28
  v_xor_b32 v110, 192, v29
  v_xor_b32 v15, 224, v28
  v_xor_b32 v111, 224, v29
  s_mov_b32 s52, 1035512379
  s_waitcnt vmcnt(4)
  ds_read_b128 v[120:123], v104 offset:16384
  ds_read_b128 v[124:127], v105 offset:16384
  ds_read_b128 v[128:131], v106 offset:16384
  ds_read_b128 v[132:135], v107 offset:16384
  ds_read_b128 v[136:139], v108 offset:16384
  ds_read_b128 v[140:143], v109 offset:16384
  ds_read_b128 v[144:147], v110 offset:16384
  ds_read_b128 v[148:151], v111 offset:16384
  s_waitcnt lgkmcnt(4)
  ds_read_b128 v[152:155], v104 offset:16640
  ds_read_b128 v[156:159], v105 offset:16640
  ds_read_b128 v[160:163], v106 offset:16640
  ds_read_b128 v[164:167], v107 offset:16640
  ds_read_b128 v[168:171], v108 offset:16640
  ds_read_b128 v[172:175], v109 offset:16640
  ds_read_b128 v[176:179], v110 offset:16640
  ds_read_b128 v[180:183], v111 offset:16640
  s_waitcnt lgkmcnt(4)
  ds_read_b128 v[184:187], v104 offset:32768
  ds_read_b128 v[188:191], v105 offset:32768
  ds_read_b128 v[192:195], v106 offset:32768
  ds_read_b128 v[196:199], v107 offset:32768
  ds_read_b128 v[200:203], v108 offset:32768
  ds_read_b128 v[204:207], v109 offset:32768
  ds_read_b128 v[208:211], v110 offset:32768
  ds_read_b128 v[212:215], v111 offset:32768
  s_waitcnt lgkmcnt(4)
  ds_read_b128 v[216:219], v104 offset:33024
  ds_read_b128 v[220:223], v105 offset:33024
  ds_read_b128 v[224:227], v106 offset:33024
  ds_read_b128 v[228:231], v107 offset:33024
  ds_read_b128 v[232:235], v108 offset:33024
  ds_read_b128 v[236:239], v109 offset:33024
  ds_read_b128 v[240:243], v110 offset:33024
  ds_read_b128 v[244:247], v111 offset:33024
  s_waitcnt lgkmcnt(4)
  s_waitcnt lgkmcnt(0)
  s_add_u32 s22, s27, 262144
  s_add_u32 m0, s25, 16384
  s_nop 0
  buffer_load_dwordx4 v4, s[56:59], s22 offen offset:0 lds
  buffer_load_dwordx4 v5, s[56:59], s22 offen offset:1024 lds
  buffer_load_dwordx4 v6, s[56:59], s22 offen offset:2048 lds
  buffer_load_dwordx4 v7, s[56:59], s22 offen offset:3072 lds
  s_add_u32 s22, s27, 524288
  s_add_u32 m0, s25, 32768
  s_nop 0
  buffer_load_dwordx4 v4, s[56:59], s22 offen offset:0 lds
  buffer_load_dwordx4 v5, s[56:59], s22 offen offset:1024 lds
  buffer_load_dwordx4 v6, s[56:59], s22 offen offset:2048 lds
  buffer_load_dwordx4 v7, s[56:59], s22 offen offset:3072 lds
  s_add_u32 s22, s27, 786432
  s_add_u32 m0, s25, 49152
  s_nop 0
  buffer_load_dwordx4 v4, s[56:59], s22 offen offset:0 lds
  buffer_load_dwordx4 v5, s[56:59], s22 offen offset:1024 lds
  buffer_load_dwordx4 v6, s[56:59], s22 offen offset:2048 lds
  buffer_load_dwordx4 v7, s[56:59], s22 offen offset:3072 lds
  s_cmp_lg_u32 s66, 0
  s_cbranch_scc1 sc_cf
  s_cmp_lg_u32 s16, 0
  s_cbranch_scc1 w0_3
  s_waitcnt vmcnt(12)
  v_readfirstlane_b32 s70, v250
  s_cmp_lg_u32 s70, 0
  s_cbranch_scc1 sc_nz
  v_mov_b32 v249, 128
  v_mov_b32 v250, s88
  v_mov_b32 v251, s89
  v_mov_b32 v252, 0
  v_mov_b32 v253, 0
  s_mov_b64 exec, 1
  buffer_atomic_cmpswap_x2 v[250:253], v249, s[12:15], 0 offen sc0
  s_mov_b64 exec, -1
  s_waitcnt vmcnt(0)
  v_readfirstlane_b32 s70, v250
  s_cmp_lg_u32 s70, 0
  s_cbranch_scc1 sc_nz
  v_mov_b32 v250, s88
  v_mov_b32 v251, s89
sc_nz:
w0_3:
  v_mov_b32 v249, 160000
  s_add_u32 s101, s101, 1
  s_barrier
  s_mov_b64 exec, 1
  s_cmp_lg_u32 s16, 0
  s_cbranch_scc1 w0_4
  ds_write_b32 v249, v248 offset:0
  ds_write_b32 v249, v250 offset:4
  ds_write_b32 v249, v251 offset:8
  s_waitcnt lgkmcnt(0)
  v_mov_b32 v248, s101
  ds_write_b32 v249, v248 offset:16
  s_waitcnt lgkmcnt(0)
w0_4:
  s_mov_b64 exec, -1
  s_barrier
  ds_read_b32 v248, v249 offset:0
  ds_read_b32 v250, v249 offset:4
  ds_read_b32 v251, v249 offset:8
  ds_read_b32 v249, v249 offset:16
  s_waitcnt lgkmcnt(0)
  v_readfirstlane_b32 s70, v248
  v_readfirstlane_b32 s88, v250
  v_readfirstlane_b32 s89, v251
  v_cmp_ne_u32 vcc, s101, v249
  s_cbranch_vccnz ch_end
  s_mov_b32 s66, 1
  s_bitcmp1_b32 s70, s3
  s_cbranch_scc1 m_reclaim
sc_cf:
  s_cmp_lg_u32 s16, 0
  s_cbranch_scc1 w0_5
  s_cmp_eq_u32 s67, 0
  s_cselect_b32 s20, 1, 0x10001
  v_mov_b32 v248, s20
  v_mov_b32 v249, 0
  s_mov_b64 exec, 1
  buffer_atomic_add v248, v249, s[12:15], 0 offen
  s_mov_b64 exec, -1
w0_5:
  s_lshl_b32 s28, s17, 7
  s_add_u32 s28, s28, 88635392
  v_min_u32 v113, 96, v2
  s_mov_b32 s29, 88602624
  v_add_u32 v112, 1024, v2
  v_min_u32 v112, 1776, v112
  s_mul_i32 s32, s17, 401408
  s_mul_i32 s33, s16, 14336
  s_add_u32 s32, s32, s33
  s_add_u32 s33, s32, s33
  s_add_u32 s32, s32, 344064
  s_add_u32 s33, s33, 229376
  s_waitcnt vmcnt(8)
  s_barrier
  ds_read_b128 v[16:19], v8 offset:0
  ds_read_b128 v[20:23], v9 offset:0
  ds_read_b128 v[24:27], v10 offset:0
  ds_read_b128 v[28:31], v11 offset:0
  s_waitcnt lgkmcnt(3)
  v_mfma_f32_32x32x16_bf16 v[32:47], v[16:19], v[120:123], 0
  s_add_u32 s22, s27, 1048576
  s_add_u32 m0, s25, 65536
  s_nop 0
  buffer_load_dwordx4 v4, s[56:59], s22 offen offset:0 lds
  v_mfma_f32_32x32x16_bf16 v[48:63], v[16:19], v[184:187], 0
  ds_read_b128 v[16:19], v12 offset:0
  s_waitcnt lgkmcnt(3)
  v_mfma_f32_32x32x16_bf16 v[32:47], v[20:23], v[124:127], v[32:47]
  buffer_load_dwordx4 v5, s[56:59], s22 offen offset:1024 lds
  v_mfma_f32_32x32x16_bf16 v[48:63], v[20:23], v[188:191], v[48:63]
  ds_read_b128 v[20:23], v13 offset:0
  s_waitcnt lgkmcnt(3)
  v_mfma_f32_32x32x16_bf16 v[32:47], v[24:27], v[128:131], v[32:47]
  buffer_load_dwordx4 v6, s[56:59], s22 offen offset:2048 lds
  v_mfma_f32_32x32x16_bf16 v[48:63], v[24:27], v[192:195], v[48:63]
  ds_read_b128 v[24:27], v14 offset:0
  s_waitcnt lgkmcnt(3)
  v_mfma_f32_32x32x16_bf16 v[32:47], v[28:31], v[132:135], v[32:47]
  buffer_load_dwordx4 v7, s[56:59], s22 offen offset:3072 lds
  v_mfma_f32_32x32x16_bf16 v[48:63], v[28:31], v[196:199], v[48:63]
  ds_read_b128 v[28:31], v15 offset:0
  s_waitcnt lgkmcnt(3)
  v_mfma_f32_32x32x16_bf16 v[32:47], v[16:19], v[136:139], v[32:47]
  s_add_u32 s22, s27, 1310720
  s_add_u32 m0, s25, 81920
  s_nop 0
  buffer_load_dwordx4 v4, s[56:59], s22 offen offset:0 lds
  v_mfma_f32_32x32x16_bf16 v[48:63], v[16:19], v[200:203], v[48:63]
  ds_read_b128 v[16:19], v8 offset:256
  s_waitcnt lgkmcnt(3)
  v_mfma_f32_32x32x16_bf16 v[32:47], v[20:23], v[140:143], v[32:47]
  buffer_load_dwordx4 v5, s[56:59], s22 offen offset:1024 lds
  v_mfma_f32_32x32x16_bf16 v[48:63], v[20:23], v[204:207], v[48:63]
  ds_read_b128 v[20:23], v9 offset:256
  s_waitcnt lgkmcnt(3)
  v_mfma_f32_32x32x16_bf16 v[32:47], v[24:27], v[144:147], v[32:47]
  buffer_load_dwordx4 v6, s[56:59], s22 offen offset:2048 lds
  v_mfma_f32_32x32x16_bf16 v[48:63], v[24:27], v[208:211], v[48:63]
  ds_read_b128 v[24:27], v10 offset:256
  s_waitcnt lgkmcnt(3)
  v_mfma_f32_32x32x16_bf16 v[32:47], v[28:31], v[148:151], v[32:47]
  buffer_load_dwordx4 v7, s[56:59], s22 offen offset:3072 lds
  v_mfma_f32_32x32x16_bf16 v[48:63], v[28:31], v[212:215], v[48:63]
  ds_read_b128 v[28:31], v11 offset:256
  s_waitcnt lgkmcnt(3)
  v_mfma_f32_32x32x16_bf16 v[32:47], v[16:19], v[152:155], v[32:47]
  s_add_u32 s22, s27, 1572864
  s_add_u32 m0, s25, 98304
  s_nop 0
  buffer_load_dwordx4 v4, s[56:59], s22 offen offset:0 lds
  v_mfma_f32_32x32x16_bf16 v[48:63], v[16:19], v[216:219], v[48:63]
  ds_read_b128 v[16:19], v12 offset:256
  s_waitcnt lgkmcnt(3)
  v_mfma_f32_32x32x16_bf16 v[32:47], v[20:23], v[156:159], v[32:47]
  buffer_load_dwordx4 v5, s[56:59], s22 offen offset:1024 lds
  v_mfma_f32_32x32x16_bf16 v[48:63], v[20:23], v[220:223], v[48:63]
  ds_read_b128 v[20:23], v13 offset:256
  s_waitcnt lgkmcnt(3)
  v_mfma_f32_32x32x16_bf16 v[32:47], v[24:27], v[160:163], v[32:47]
  buffer_load_dwordx4 v6, s[56:59], s22 offen offset:2048 lds
  v_mfma_f32_32x32x16_bf16 v[48:63], v[24:27], v[224:227], v[48:63]
  ds_read_b128 v[24:27], v14 offset:256
  s_waitcnt lgkmcnt(3)
  v_mfma_f32_32x32x16_bf16 v[32:47], v[28:31], v[164:167], v[32:47]
  buffer_load_dwordx4 v7, s[56:59], s22 offen offset:3072 lds
  v_mfma_f32_32x32x16_bf16 v[48:63], v[28:31], v[228:231], v[48:63]
  ds_read_b128 v[28:31], v15 offset:256
  s_waitcnt lgkmcnt(3)
  v_mfma_f32_32x32x16_bf16 v[32:47], v[16:19], v[168:171], v[32:47]
  s_add_u32 s22, s27, 1835008
  s_add_u32 m0, s25, 114688
  s_nop 0
  buffer_load_dwordx4 v4, s[56:59], s22 offen offset:0 lds
  v_mfma_f32_32x32x16_bf16 v[48:63], v[16:19], v[232:235], v[48:63]
  ds_read_b128 v[16:19], v8 offset:16384
  s_waitcnt lgkmcnt(3)
  v_mfma_f32_32x32x16_bf16 v[32:47], v[20:23], v[172:175], v[32:47]
  buffer_load_dwordx4 v5, s[56:59], s22 offen offset:1024 lds
  v_mfma_f32_32x32x16_bf16 v[48:63], v[20:23], v[236:239], v[48:63]
  ds_read_b128 v[20:23], v9 offset:16384
  s_waitcnt lgkmcnt(3)
  v_mfma_f32_32x32x16_bf16 v[32:47], v[24:27], v[176:179], v[32:47]
  buffer_load_dwordx4 v6, s[56:59], s22 offen offset:2048 lds
  v_mfma_f32_32x32x16_bf16 v[48:63], v[24:27], v[240:243], v[48:63]
  ds_read_b128 v[24:27], v10 offset:16384
  s_waitcnt lgkmcnt(3)
  v_mfma_f32_32x32x16_bf16 v[32:47], v[28:31], v[180:183], v[32:47]
  buffer_load_dwordx4 v7, s[56:59], s22 offen offset:3072 lds
  v_mfma_f32_32x32x16_bf16 v[48:63], v[28:31], v[244:247], v[48:63]
  s_waitcnt vmcnt(16)
  s_barrier
  ds_read_b128 v[28:31], v11 offset:16384
  s_waitcnt lgkmcnt(3)
  v_mfma_f32_32x32x16_bf16 v[64:79], v[16:19], v[120:123], 0
  s_add_u32 s22, s27, 2097152
  s_add_u32 m0, s25, 131072
  s_nop 0
  buffer_load_dwordx4 v4, s[56:59], s22 offen offset:0 lds
  v_mfma_f32_32x32x16_bf16 v[80:95], v[16:19], v[184:187], 0
  ds_read_b128 v[16:19], v12 offset:16384
  s_waitcnt lgkmcnt(3)
  v_mfma_f32_32x32x16_bf16 v[64:79], v[20:23], v[124:127], v[64:79]
  buffer_load_dwordx4 v5, s[56:59], s22 offen offset:1024 lds
  v_mul_f32 v32, s52, v32
  v_mul_f32 v33, s52, v33
  v_cvt_pk_bf16_f32 v32, v32, v33
  v_mfma_f32_32x32x16_bf16 v[80:95], v[20:23], v[188:191], v[80:95]
  v_mul_f32 v34, s52, v34
  v_mul_f32 v35, s52, v35
  ds_read_b128 v[20:23], v13 offset:16384
  s_waitcnt lgkmcnt(3)
  v_mfma_f32_32x32x16_bf16 v[64:79], v[24:27], v[128:131], v[64:79]
  buffer_load_dwordx4 v6, s[56:59], s22 offen offset:2048 lds
  v_cvt_pk_bf16_f32 v33, v34, v35
  v_mul_f32 v36, s52, v36
  v_mul_f32 v37, s52, v37
  v_mfma_f32_32x32x16_bf16 v[80:95], v[24:27], v[192:195], v[80:95]
  v_cvt_pk_bf16_f32 v34, v36, v37
  v_mul_f32 v38, s52, v38
  ds_read_b128 v[24:27], v14 offset:16384
  s_waitcnt lgkmcnt(3)
  v_mfma_f32_32x32x16_bf16 v[64:79], v[28:31], v[132:135], v[64:79]
  buffer_load_dwordx4 v7, s[56:59], s22 offen offset:3072 lds
  v_mul_f32 v39, s52, v39
  v_cvt_pk_bf16_f32 v35, v38, v39
  v_mul_f32 v40, s52, v40
  v_mfma_f32_32x32x16_bf16 v[80:95], v[28:31], v[196:199], v[80:95]
  v_mul_f32 v41, s52, v41
  v_cvt_pk_bf16_f32 v40, v40, v41
  ds_read_b128 v[28:31], v15 offset:16384
  s_waitcnt lgkmcnt(3)
  v_mfma_f32_32x32x16_bf16 v[64:79], v[16:19], v[136:139], v[64:79]
  s_add_u32 s22, s27, 2359296
  s_add_u32 m0, s25, 0
  s_nop 0
  buffer_load_dwordx4 v4, s[56:59], s22 offen offset:0 lds
  v_mul_f32 v42, s52, v42
  v_mul_f32 v43, s52, v43
  v_cvt_pk_bf16_f32 v41, v42, v43
  v_mfma_f32_32x32x16_bf16 v[80:95], v[16:19], v[200:203], v[80:95]
  v_mul_f32 v44, s52, v44
  v_mul_f32 v45, s52, v45
  ds_read_b128 v[16:19], v8 offset:16640
  s_waitcnt lgkmcnt(3)
  v_mfma_f32_32x32x16_bf16 v[64:79], v[20:23], v[140:143], v[64:79]
  buffer_load_dwordx4 v5, s[56:59], s22 offen offset:1024 lds
  v_cvt_pk_bf16_f32 v42, v44, v45
  v_mul_f32 v46, s52, v46
  v_mul_f32 v47, s52, v47
  v_mfma_f32_32x32x16_bf16 v[80:95], v[20:23], v[204:207], v[80:95]
  v_cvt_pk_bf16_f32 v43, v46, v47
  v_permlane16_swap_b32 v32, v40
  ds_read_b128 v[20:23], v9 offset:16640
  s_waitcnt lgkmcnt(3)
  v_mfma_f32_32x32x16_bf16 v[64:79], v[24:27], v[144:147], v[64:79]
  buffer_load_dwordx4 v6, s[56:59], s22 offen offset:2048 lds
  v_permlane16_swap_b32 v33, v41
  v_permlane16_swap_b32 v34, v42
  v_permlane16_swap_b32 v35, v43
  v_mfma_f32_32x32x16_bf16 v[80:95], v[24:27], v[208:211], v[80:95]
  v_accvgpr_write_b32 a0, v32
  v_accvgpr_write_b32 a1, v33
  ds_read_b128 v[24:27], v10 offset:16640
  s_waitcnt lgkmcnt(3)
  v_mfma_f32_32x32x16_bf16 v[64:79], v[28:31], v[148:151], v[64:79]
  buffer_load_dwordx4 v7, s[56:59], s22 offen offset:3072 lds
  v_accvgpr_write_b32 a2, v34
  v_accvgpr_write_b32 a3, v35
  v_accvgpr_write_b32 a56, v40
  v_mfma_f32_32x32x16_bf16 v[80:95], v[28:31], v[212:215], v[80:95]
  v_accvgpr_write_b32 a57, v41
  v_accvgpr_write_b32 a58, v42
  ds_read_b128 v[28:31], v11 offset:16640
  s_waitcnt lgkmcnt(3)
  v_mfma_f32_32x32x16_bf16 v[64:79], v[16:19], v[152:155], v[64:79]
  v_accvgpr_write_b32 a59, v43
  v_mul_f32 v48, s52, v48
  v_mul_f32 v49, s52, v49
  v_mfma_f32_32x32x16_bf16 v[80:95], v[16:19], v[216:219], v[80:95]
  v_cvt_pk_bf16_f32 v48, v48, v49
  v_mul_f32 v50, s52, v50
  ds_read_b128 v[16:19], v12 offset:16640
  s_waitcnt lgkmcnt(3)
  v_mfma_f32_32x32x16_bf16 v[64:79], v[20:23], v[156:159], v[64:79]
  v_mul_f32 v51, s52, v51
  v_cvt_pk_bf16_f32 v49, v50, v51
  v_mul_f32 v52, s52, v52
  v_mfma_f32_32x32x16_bf16 v[80:95], v[20:23], v[220:223], v[80:95]
  v_mul_f32 v53, s52, v53
  v_cvt_pk_bf16_f32 v50, v52, v53
  ds_read_b128 v[20:23], v13 offset:16640
  s_waitcnt lgkmcnt(3)
  v_mfma_f32_32x32x16_bf16 v[64:79], v[24:27], v[160:163], v[64:79]
  v_mul_f32 v54, s52, v54
  v_mul_f32 v55, s52, v55
  v_cvt_pk_bf16_f32 v51, v54, v55
  v_mfma_f32_32x32x16_bf16 v[80:95], v[24:27], v[224:227], v[80:95]
  v_mul_f32 v56, s52, v56
  v_mul_f32 v57, s52, v57
  ds_read_b128 v[24:27], v14 offset:16640
  s_waitcnt lgkmcnt(3)
  v_mfma_f32_32x32x16_bf16 v[64:79], v[28:31], v[164:167], v[64:79]
  v_cvt_pk_bf16_f32 v56, v56, v57
  v_mul_f32 v58, s52, v58
  v_mul_f32 v59, s52, v59
  v_mfma_f32_32x32x16_bf16 v[80:95], v[28:31], v[228:231], v[80:95]
  v_cvt_pk_bf16_f32 v57, v58, v59
  v_mul_f32 v60, s52, v60
  ds_read_b128 v[28:31], v15 offset:16640
  s_waitcnt lgkmcnt(3)
  v_mfma_f32_32x32x16_bf16 v[64:79], v[16:19], v[168:171], v[64:79]
  v_mul_f32 v61, s52, v61
  v_cvt_pk_bf16_f32 v58, v60, v61
  v_mul_f32 v62, s52, v62
  v_mfma_f32_32x32x16_bf16 v[80:95], v[16:19], v[232:235], v[80:95]
  v_mul_f32 v63, s52, v63
  v_cvt_pk_bf16_f32 v59, v62, v63
  ds_read_b128 v[16:19], v8 offset:32768
  s_waitcnt lgkmcnt(3)
  v_mfma_f32_32x32x16_bf16 v[64:79], v[20:23], v[172:175], v[64:79]
  v_permlane16_swap_b32 v48, v56
  v_permlane16_swap_b32 v49, v57
  v_permlane16_swap_b32 v50, v58
  v_mfma_f32_32x32x16_bf16 v[80:95], v[20:23], v[236:239], v[80:95]
  v_permlane16_swap_b32 v51, v59
  v_accvgpr_write_b32 a112, v48
  ds_read_b128 v[20:23], v9 offset:32768
  s_waitcnt lgkmcnt(3)
  v_mfma_f32_32x32x16_bf16 v[64:79], v[24:27], v[176:179], v[64:79]
  v_accvgpr_write_b32 a113, v49
  v_accvgpr_write_b32 a114, v50
  v_accvgpr_write_b32 a115, v51
  v_mfma_f32_32x32x16_bf16 v[80:95], v[24:27], v[240:243], v[80:95]
  v_accvgpr_write_b32 a168, v56
  v_accvgpr_write_b32 a169, v57
  ds_read_b128 v[24:27], v10 offset:32768
  s_waitcnt lgkmcnt(3)
  v_mfma_f32_32x32x16_bf16 v[64:79], v[28:31], v[180:183], v[64:79]
  v_accvgpr_write_b32 a170, v58
  v_accvgpr_write_b32 a171, v59
  v_mfma_f32_32x32x16_bf16 v[80:95], v[28:31], v[244:247], v[80:95]
  ds_read_b128 v[28:31], v11 offset:32768
  s_waitcnt lgkmcnt(3)
  v_mfma_f32_32x32x16_bf16 v[32:47], v[16:19], v[120:123], 0
  v_mfma_f32_32x32x16_bf16 v[48:63], v[16:19], v[184:187], 0
  ds_read_b128 v[16:19], v12 offset:32768
  s_waitcnt lgkmcnt(3)
  v_mfma_f32_32x32x16_bf16 v[32:47], v[20:23], v[124:127], v[32:47]
  v_mul_f32 v64, s52, v64
  v_mul_f32 v65, s52, v65
  v_cvt_pk_bf16_f32 v64, v64, v65
  v_mfma_f32_32x32x16_bf16 v[48:63], v[20:23], v[188:191], v[48:63]
  v_mul_f32 v66, s52, v66
  v_mul_f32 v67, s52, v67
  ds_read_b128 v[20:23], v13 offset:32768
  s_waitcnt lgkmcnt(3)
  v_mfma_f32_32x32x16_bf16 v[32:47], v[24:27], v[128:131], v[32:47]
  v_cvt_pk_bf16_f32 v65, v66, v67
  v_mul_f32 v68, s52, v68
  v_mul_f32 v69, s52, v69
  v_mfma_f32_32x32x16_bf16 v[48:63], v[24:27], v[192:195], v[48:63]
  v_cvt_pk_bf16_f32 v66, v68, v69
  v_mul_f32 v70, s52, v70
  ds_read_b128 v[24:27], v14 offset:32768
  s_waitcnt lgkmcnt(3)
  v_mfma_f32_32x32x16_bf16 v[32:47], v[28:31], v[132:135], v[32:47]
  v_mul_f32 v71, s52, v71
  v_cvt_pk_bf16_f32 v67, v70, v71
  v_mul_f32 v72, s52, v72
  v_mfma_f32_32x32x16_bf16 v[48:63], v[28:31], v[196:199], v[48:63]
  v_mul_f32 v73, s52, v73
  v_cvt_pk_bf16_f32 v72, v72, v73
  ds_read_b128 v[28:31], v15 offset:32768
  s_waitcnt lgkmcnt(3)
  v_mfma_f32_32x32x16_bf16 v[32:47], v[16:19], v[136:139], v[32:47]
  v_mul_f32 v74, s52, v74
  v_mul_f32 v75, s52, v75
  v_cvt_pk_bf16_f32 v73, v74, v75
  v_mfma_f32_32x32x16_bf16 v[48:63], v[16:19], v[200:203], v[48:63]
  v_mul_f32 v76, s52, v76
  v_mul_f32 v77, s52, v77
  ds_read_b128 v[16:19], v8 offset:33024
  s_waitcnt lgkmcnt(3)
  v_mfma_f32_32x32x16_bf16 v[32:47], v[20:23], v[140:143], v[32:47]
  v_cvt_pk_bf16_f32 v74, v76, v77
  v_mul_f32 v78, s52, v78
  v_mul_f32 v79, s52, v79
  v_mfma_f32_32x32x16_bf16 v[48:63], v[20:23], v[204:207], v[48:63]
  v_cvt_pk_bf16_f32 v75, v78, v79
  v_permlane16_swap_b32 v64, v72
  ds_read_b128 v[20:23], v9 offset:33024
  s_waitcnt lgkmcnt(3)
  v_mfma_f32_32x32x16_bf16 v[32:47], v[24:27], v[144:147], v[32:47]
  v_permlane16_swap_b32 v65, v73
  v_permlane16_swap_b32 v66, v74
  v_permlane16_swap_b32 v67, v75
  v_mfma_f32_32x32x16_bf16 v[48:63], v[24:27], v[208:211], v[48:63]
  v_accvgpr_write_b32 a4, v64
  v_accvgpr_write_b32 a5, v65
  ds_read_b128 v[24:27], v10 offset:33024
  s_waitcnt lgkmcnt(3)
  v_mfma_f32_32x32x16_bf16 v[32:47], v[28:31], v[148:151], v[32:47]
  v_accvgpr_write_b32 a6, v66
  v_accvgpr_write_b32 a7, v67
  v_accvgpr_write_b32 a60, v72
  v_mfma_f32_32x32x16_bf16 v[48:63], v[28:31], v[212:215], v[48:63]
  v_accvgpr_write_b32 a61, v73
  v_accvgpr_write_b32 a62, v74
  ds_read_b128 v[28:31], v11 offset:33024
  s_waitcnt lgkmcnt(3)
  v_mfma_f32_32x32x16_bf16 v[32:47], v[16:19], v[152:155], v[32:47]
  v_accvgpr_write_b32 a63, v75
  v_mul_f32 v80, s52, v80
  v_mul_f32 v81, s52, v81
  v_mfma_f32_32x32x16_bf16 v[48:63], v[16:19], v[216:219], v[48:63]
  v_cvt_pk_bf16_f32 v80, v80, v81
  v_mul_f32 v82, s52, v82
  ds_read_b128 v[16:19], v12 offset:33024
  s_waitcnt lgkmcnt(3)
  v_mfma_f32_32x32x16_bf16 v[32:47], v[20:23], v[156:159], v[32:47]
  v_mul_f32 v83, s52, v83
  v_cvt_pk_bf16_f32 v81, v82, v83
  v_mul_f32 v84, s52, v84
  v_mfma_f32_32x32x16_bf16 v[48:63], v[20:23], v[220:223], v[48:63]
  v_mul_f32 v85, s52, v85
  v_cvt_pk_bf16_f32 v82, v84, v85
  ds_read_b128 v[20:23], v13 offset:33024
  s_waitcnt lgkmcnt(3)
  v_mfma_f32_32x32x16_bf16 v[32:47], v[24:27], v[160:163], v[32:47]
  v_mul_f32 v86, s52, v86
  v_mul_f32 v87, s52, v87
  v_cvt_pk_bf16_f32 v83, v86, v87
  v_mfma_f32_32x32x16_bf16 v[48:63], v[24:27], v[224:227], v[48:63]
  v_mul_f32 v88, s52, v88
  v_mul_f32 v89, s52, v89
  ds_read_b128 v[24:27], v14 offset:33024
  s_waitcnt lgkmcnt(3)
  v_mfma_f32_32x32x16_bf16 v[32:47], v[28:31], v[164:167], v[32:47]
  v_cvt_pk_bf16_f32 v88, v88, v89
  v_mul_f32 v90, s52, v90
  v_mul_f32 v91, s52, v91
  v_mfma_f32_32x32x16_bf16 v[48:63], v[28:31], v[228:231], v[48:63]
  v_cvt_pk_bf16_f32 v89, v90, v91
  v_mul_f32 v92, s52, v92
  ds_read_b128 v[28:31], v15 offset:33024
  s_waitcnt lgkmcnt(3)
  v_mfma_f32_32x32x16_bf16 v[32:47], v[16:19], v[168:171], v[32:47]
  v_mul_f32 v93, s52, v93
  v_cvt_pk_bf16_f32 v90, v92, v93
  v_mul_f32 v94, s52, v94
  v_mfma_f32_32x32x16_bf16 v[48:63], v[16:19], v[232:235], v[48:63]
  v_mul_f32 v95, s52, v95
  v_cvt_pk_bf16_f32 v91, v94, v95
  ds_read_b128 v[16:19], v8 offset:49152
  s_waitcnt lgkmcnt(3)
  v_mfma_f32_32x32x16_bf16 v[32:47], v[20:23], v[172:175], v[32:47]
  v_permlane16_swap_b32 v80, v88
  v_permlane16_swap_b32 v81, v89
  v_permlane16_swap_b32 v82, v90
  v_mfma_f32_32x32x16_bf16 v[48:63], v[20:23], v[236:239], v[48:63]
  v_permlane16_swap_b32 v83, v91
  v_accvgpr_write_b32 a116, v80
  ds_read_b128 v[20:23], v9 offset:49152
  s_waitcnt lgkmcnt(3)
  v_mfma_f32_32x32x16_bf16 v[32:47], v[24:27], v[176:179], v[32:47]
  v_accvgpr_write_b32 a117, v81
  v_accvgpr_write_b32 a118, v82
  v_accvgpr_write_b32 a119, v83
  v_mfma_f32_32x32x16_bf16 v[48:63], v[24:27], v[240:243], v[48:63]
  v_accvgpr_write_b32 a172, v88
  v_accvgpr_write_b32 a173, v89
  ds_read_b128 v[24:27], v10 offset:49152
  s_waitcnt lgkmcnt(3)
  v_mfma_f32_32x32x16_bf16 v[32:47], v[28:31], v[180:183], v[32:47]
  v_accvgpr_write_b32 a174, v90
  v_accvgpr_write_b32 a175, v91
  v_mfma_f32_32x32x16_bf16 v[48:63], v[28:31], v[244:247], v[48:63]
  s_waitcnt vmcnt(16)
  s_barrier
  ds_read_b128 v[28:31], v11 offset:49152
  s_waitcnt lgkmcnt(3)
  v_mfma_f32_32x32x16_bf16 v[64:79], v[16:19], v[120:123], 0
  s_add_u32 s22, s27, 2621440
  s_add_u32 m0, s25, 16384
  s_nop 0
  buffer_load_dwordx4 v4, s[56:59], s22 offen offset:0 lds
  v_mfma_f32_32x32x16_bf16 v[80:95], v[16:19], v[184:187], 0
  ds_read_b128 v[16:19], v12 offset:49152
  s_waitcnt lgkmcnt(3)
  v_mfma_f32_32x32x16_bf16 v[64:79], v[20:23], v[124:127], v[64:79]
  buffer_load_dwordx4 v5, s[56:59], s22 offen offset:1024 lds
  v_mul_f32 v32, s52, v32
  v_mul_f32 v33, s52, v33
  v_cvt_pk_bf16_f32 v32, v32, v33
  v_mfma_f32_32x32x16_bf16 v[80:95], v[20:23], v[188:191], v[80:95]
  v_mul_f32 v34, s52, v34
  v_mul_f32 v35, s52, v35
  ds_read_b128 v[20:23], v13 offset:49152
  s_waitcnt lgkmcnt(3)
  v_mfma_f32_32x32x16_bf16 v[64:79], v[24:27], v[128:131], v[64:79]
  buffer_load_dwordx4 v6, s[56:59], s22 offen offset:2048 lds
  v_cvt_pk_bf16_f32 v33, v34, v35
  v_mul_f32 v36, s52, v36
  v_mul_f32 v37, s52, v37
  v_mfma_f32_32x32x16_bf16 v[80:95], v[24:27], v[192:195], v[80:95]
  v_cvt_pk_bf16_f32 v34, v36, v37
  v_mul_f32 v38, s52, v38
  ds_read_b128 v[24:27], v14 offset:49152
  s_waitcnt lgkmcnt(3)
  v_mfma_f32_32x32x16_bf16 v[64:79], v[28:31], v[132:135], v[64:79]
  buffer_load_dwordx4 v7, s[56:59], s22 offen offset:3072 lds
  v_mul_f32 v39, s52, v39
  v_cvt_pk_bf16_f32 v35, v38, v39
  v_mul_f32 v40, s52, v40
  v_mfma_f32_32x32x16_bf16 v[80:95], v[28:31], v[196:199], v[80:95]
  v_mul_f32 v41, s52, v41
  v_cvt_pk_bf16_f32 v40, v40, v41
  ds_read_b128 v[28:31], v15 offset:49152
  s_waitcnt lgkmcnt(3)
  v_mfma_f32_32x32x16_bf16 v[64:79], v[16:19], v[136:139], v[64:79]
  s_add_u32 s22, s27, 2883584
  s_add_u32 m0, s25, 32768
  s_nop 0
  buffer_load_dwordx4 v4, s[56:59], s22 offen offset:0 lds
  v_mul_f32 v42, s52, v42
  v_mul_f32 v43, s52, v43
  v_cvt_pk_bf16_f32 v41, v42, v43
  v_mfma_f32_32x32x16_bf16 v[80:95], v[16:19], v[200:203], v[80:95]
  v_mul_f32 v44, s52, v44
  v_mul_f32 v45, s52, v45
  ds_read_b128 v[16:19], v8 offset:49408
  s_waitcnt lgkmcnt(3)
  v_mfma_f32_32x32x16_bf16 v[64:79], v[20:23], v[140:143], v[64:79]
  buffer_load_dwordx4 v5, s[56:59], s22 offen offset:1024 lds
  v_cvt_pk_bf16_f32 v42, v44, v45
  v_mul_f32 v46, s52, v46
  v_mul_f32 v47, s52, v47
  v_mfma_f32_32x32x16_bf16 v[80:95], v[20:23], v[204:207], v[80:95]
  v_cvt_pk_bf16_f32 v43, v46, v47
  v_permlane16_swap_b32 v32, v40
  ds_read_b128 v[20:23], v9 offset:49408
  s_waitcnt lgkmcnt(3)
  v_mfma_f32_32x32x16_bf16 v[64:79], v[24:27], v[144:147], v[64:79]
  buffer_load_dwordx4 v6, s[56:59], s22 offen offset:2048 lds
  v_permlane16_swap_b32 v33, v41
  v_permlane16_swap_b32 v34, v42
  v_permlane16_swap_b32 v35, v43
  v_mfma_f32_32x32x16_bf16 v[80:95], v[24:27], v[208:211], v[80:95]
  v_accvgpr_write_b32 a8, v32
  v_accvgpr_write_b32 a9, v33
  ds_read_b128 v[24:27], v10 offset:49408
  s_waitcnt lgkmcnt(3)
  v_mfma_f32_32x32x16_bf16 v[64:79], v[28:31], v[148:151], v[64:79]
  buffer_load_dwordx4 v7, s[56:59], s22 offen offset:3072 lds
  v_accvgpr_write_b32 a10, v34
  v_accvgpr_write_b32 a11, v35
  v_accvgpr_write_b32 a64, v40
  v_mfma_f32_32x32x16_bf16 v[80:95], v[28:31], v[212:215], v[80:95]
  v_accvgpr_write_b32 a65, v41
  v_accvgpr_write_b32 a66, v42
  ds_read_b128 v[28:31], v11 offset:49408
  s_waitcnt lgkmcnt(3)
  v_mfma_f32_32x32x16_bf16 v[64:79], v[16:19], v[152:155], v[64:79]
  v_accvgpr_write_b32 a67, v43
  v_mul_f32 v48, s52, v48
  v_mul_f32 v49, s52, v49
  v_mfma_f32_32x32x16_bf16 v[80:95], v[16:19], v[216:219], v[80:95]
  v_cvt_pk_bf16_f32 v48, v48, v49
  v_mul_f32 v50, s52, v50
  ds_read_b128 v[16:19], v12 offset:49408
  s_waitcnt lgkmcnt(3)
  v_mfma_f32_32x32x16_bf16 v[64:79], v[20:23], v[156:159], v[64:79]
  v_mul_f32 v51, s52, v51
  v_cvt_pk_bf16_f32 v49, v50, v51
  v_mul_f32 v52, s52, v52
  v_mfma_f32_32x32x16_bf16 v[80:95], v[20:23], v[220:223], v[80:95]
  v_mul_f32 v53, s52, v53
  v_cvt_pk_bf16_f32 v50, v52, v53
  ds_read_b128 v[20:23], v13 offset:49408
  s_waitcnt lgkmcnt(3)
  v_mfma_f32_32x32x16_bf16 v[64:79], v[24:27], v[160:163], v[64:79]
  v_mul_f32 v54, s52, v54
  v_mul_f32 v55, s52, v55
  v_cvt_pk_bf16_f32 v51, v54, v55
  v_mfma_f32_32x32x16_bf16 v[80:95], v[24:27], v[224:227], v[80:95]
  v_mul_f32 v56, s52, v56
  v_mul_f32 v57, s52, v57
  ds_read_b128 v[24:27], v14 offset:49408
  s_waitcnt lgkmcnt(3)
  v_mfma_f32_32x32x16_bf16 v[64:79], v[28:31], v[164:167], v[64:79]
  v_cvt_pk_bf16_f32 v56, v56, v57
  v_mul_f32 v58, s52, v58
  v_mul_f32 v59, s52, v59
  v_mfma_f32_32x32x16_bf16 v[80:95], v[28:31], v[228:231], v[80:95]
  v_cvt_pk_bf16_f32 v57, v58, v59
  v_mul_f32 v60, s52, v60
  ds_read_b128 v[28:31], v15 offset:49408
  s_waitcnt lgkmcnt(3)
  v_mfma_f32_32x32x16_bf16 v[64:79], v[16:19], v[168:171], v[64:79]
  v_mul_f32 v61, s52, v61
  v_cvt_pk_bf16_f32 v58, v60, v61
  v_mul_f32 v62, s52, v62
  v_mfma_f32_32x32x16_bf16 v[80:95], v[16:19], v[232:235], v[80:95]
  v_mul_f32 v63, s52, v63
  v_cvt_pk_bf16_f32 v59, v62, v63
  v_xor_b32 v8, 65536, v8
  ds_read_b128 v[16:19], v8 offset:0
  s_waitcnt lgkmcnt(3)
  v_mfma_f32_32x32x16_bf16 v[64:79], v[20:23], v[172:175], v[64:79]
  v_permlane16_swap_b32 v48, v56
  v_permlane16_swap_b32 v49, v57
  v_permlane16_swap_b32 v50, v58
  v_mfma_f32_32x32x16_bf16 v[80:95], v[20:23], v[236:239], v[80:95]
  v_permlane16_swap_b32 v51, v59
  v_accvgpr_write_b32 a120, v48
  v_xor_b32 v9, 65536, v9
  ds_read_b128 v[20:23], v9 offset:0
  s_waitcnt lgkmcnt(3)
  v_mfma_f32_32x32x16_bf16 v[64:79], v[24:27], v[176:179], v[64:79]
  v_accvgpr_write_b32 a121, v49
  v_accvgpr_write_b32 a122, v50
  v_accvgpr_write_b32 a123, v51
  v_mfma_f32_32x32x16_bf16 v[80:95], v[24:27], v[240:243], v[80:95]
  v_accvgpr_write_b32 a176, v56
  v_accvgpr_write_b32 a177, v57
  v_xor_b32 v10, 65536, v10
  ds_read_b128 v[24:27], v10 offset:0
  s_waitcnt lgkmcnt(3)
  v_mfma_f32_32x32x16_bf16 v[64:79], v[28:31], v[180:183], v[64:79]
  v_accvgpr_write_b32 a178, v58
  v_accvgpr_write_b32 a179, v59
  v_mfma_f32_32x32x16_bf16 v[80:95], v[28:31], v[244:247], v[80:95]
  v_xor_b32 v11, 65536, v11
  ds_read_b128 v[28:31], v11 offset:0
  s_waitcnt lgkmcnt(3)
  v_mfma_f32_32x32x16_bf16 v[32:47], v[16:19], v[120:123], 0
  v_mfma_f32_32x32x16_bf16 v[48:63], v[16:19], v[184:187], 0
  v_xor_b32 v12, 65536, v12
  ds_read_b128 v[16:19], v12 offset:0
  s_waitcnt lgkmcnt(3)
  v_mfma_f32_32x32x16_bf16 v[32:47], v[20:23], v[124:127], v[32:47]
  v_mul_f32 v64, s52, v64
  v_mul_f32 v65, s52, v65
  v_cvt_pk_bf16_f32 v64, v64, v65
  v_mfma_f32_32x32x16_bf16 v[48:63], v[20:23], v[188:191], v[48:63]
  v_mul_f32 v66, s52, v66
  v_mul_f32 v67, s52, v67
  v_xor_b32 v13, 65536, v13
  ds_read_b128 v[20:23], v13 offset:0
  s_waitcnt lgkmcnt(3)
  v_mfma_f32_32x32x16_bf16 v[32:47], v[24:27], v[128:131], v[32:47]
  v_cvt_pk_bf16_f32 v65, v66, v67
  v_mul_f32 v68, s52, v68
  v_mul_f32 v69, s52, v69
  v_mfma_f32_32x32x16_bf16 v[48:63], v[24:27], v[192:195], v[48:63]
  v_cvt_pk_bf16_f32 v66, v68, v69
  v_mul_f32 v70, s52, v70
  v_xor_b32 v14, 65536, v14
  ds_read_b128 v[24:27], v14 offset:0
  s_waitcnt lgkmcnt(3)
  v_mfma_f32_32x32x16_bf16 v[32:47], v[28:31], v[132:135], v[32:47]
  v_mul_f32 v71, s52, v71
  v_cvt_pk_bf16_f32 v67, v70, v71
  v_mul_f32 v72, s52, v72
  v_mfma_f32_32x32x16_bf16 v[48:63], v[28:31], v[196:199], v[48:63]
  v_mul_f32 v73, s52, v73
  v_cvt_pk_bf16_f32 v72, v72, v73
  v_xor_b32 v15, 65536, v15
  ds_read_b128 v[28:31], v15 offset:0
  s_waitcnt lgkmcnt(3)
  v_mfma_f32_32x32x16_bf16 v[32:47], v[16:19], v[136:139], v[32:47]
  v_mul_f32 v74, s52, v74
  v_mul_f32 v75, s52, v75
  v_cvt_pk_bf16_f32 v73, v74, v75
  v_mfma_f32_32x32x16_bf16 v[48:63], v[16:19], v[200:203], v[48:63]
  v_mul_f32 v76, s52, v76
  v_mul_f32 v77, s52, v77
  ds_read_b128 v[16:19], v8 offset:256
  s_waitcnt lgkmcnt(3)
  v_mfma_f32_32x32x16_bf16 v[32:47], v[20:23], v[140:143], v[32:47]
  v_cvt_pk_bf16_f32 v74, v76, v77
  v_mul_f32 v78, s52, v78
  v_mul_f32 v79, s52, v79
  v_mfma_f32_32x32x16_bf16 v[48:63], v[20:23], v[204:207], v[48:63]
  v_cvt_pk_bf16_f32 v75, v78, v79
  v_permlane16_swap_b32 v64, v72
  ds_read_b128 v[20:23], v9 offset:256
  s_waitcnt lgkmcnt(3)
  v_mfma_f32_32x32x16_bf16 v[32:47], v[24:27], v[144:147], v[32:47]
  v_permlane16_swap_b32 v65, v73
  v_permlane16_swap_b32 v66, v74
  v_permlane16_swap_b32 v67, v75
  v_mfma_f32_32x32x16_bf16 v[48:63], v[24:27], v[208:211], v[48:63]
  v_accvgpr_write_b32 a12, v64
  v_accvgpr_write_b32 a13, v65
  ds_read_b128 v[24:27], v10 offset:256
  s_waitcnt lgkmcnt(3)
  v_mfma_f32_32x32x16_bf16 v[32:47], v[28:31], v[148:151], v[32:47]
  v_accvgpr_write_b32 a14, v66
  v_accvgpr_write_b32 a15, v67
  v_accvgpr_write_b32 a68, v72
  v_mfma_f32_32x32x16_bf16 v[48:63], v[28:31], v[212:215], v[48:63]
  v_accvgpr_write_b32 a69, v73
  v_accvgpr_write_b32 a70, v74
  ds_read_b128 v[28:31], v11 offset:256
  s_waitcnt lgkmcnt(3)
  v_mfma_f32_32x32x16_bf16 v[32:47], v[16:19], v[152:155], v[32:47]
  v_accvgpr_write_b32 a71, v75
  v_mul_f32 v80, s52, v80
  v_mul_f32 v81, s52, v81
  v_mfma_f32_32x32x16_bf16 v[48:63], v[16:19], v[216:219], v[48:63]
  v_cvt_pk_bf16_f32 v80, v80, v81
  v_mul_f32 v82, s52, v82
  ds_read_b128 v[16:19], v12 offset:256
  s_waitcnt lgkmcnt(3)
  v_mfma_f32_32x32x16_bf16 v[32:47], v[20:23], v[156:159], v[32:47]
  v_mul_f32 v83, s52, v83
  v_cvt_pk_bf16_f32 v81, v82, v83
  v_mul_f32 v84, s52, v84
  v_mfma_f32_32x32x16_bf16 v[48:63], v[20:23], v[220:223], v[48:63]
  v_mul_f32 v85, s52, v85
  v_cvt_pk_bf16_f32 v82, v84, v85
  ds_read_b128 v[20:23], v13 offset:256
  s_waitcnt lgkmcnt(3)
  v_mfma_f32_32x32x16_bf16 v[32:47], v[24:27], v[160:163], v[32:47]
  v_mul_f32 v86, s52, v86
  v_mul_f32 v87, s52, v87
  v_cvt_pk_bf16_f32 v83, v86, v87
  v_mfma_f32_32x32x16_bf16 v[48:63], v[24:27], v[224:227], v[48:63]
  v_mul_f32 v88, s52, v88
  v_mul_f32 v89, s52, v89
  ds_read_b128 v[24:27], v14 offset:256
  s_waitcnt lgkmcnt(3)
  v_mfma_f32_32x32x16_bf16 v[32:47], v[28:31], v[164:167], v[32:47]
  v_cvt_pk_bf16_f32 v88, v88, v89
  v_mul_f32 v90, s52, v90
  v_mul_f32 v91, s52, v91
  v_mfma_f32_32x32x16_bf16 v[48:63], v[28:31], v[228:231], v[48:63]
  v_cvt_pk_bf16_f32 v89, v90, v91
  v_mul_f32 v92, s52, v92
  ds_read_b128 v[28:31], v15 offset:256
  s_waitcnt lgkmcnt(3)
  v_mfma_f32_32x32x16_bf16 v[32:47], v[16:19], v[168:171], v[32:47]
  v_mul_f32 v93, s52, v93
  v_cvt_pk_bf16_f32 v90, v92, v93
  v_mul_f32 v94, s52, v94
  v_mfma_f32_32x32x16_bf16 v[48:63], v[16:19], v[232:235], v[48:63]
  v_mul_f32 v95, s52, v95
  v_cvt_pk_bf16_f32 v91, v94, v95
  ds_read_b128 v[16:19], v8 offset:16384
  s_waitcnt lgkmcnt(3)
  v_mfma_f32_32x32x16_bf16 v[32:47], v[20:23], v[172:175], v[32:47]
  v_permlane16_swap_b32 v80, v88
  v_permlane16_swap_b32 v81, v89
  v_permlane16_swap_b32 v82, v90
  v_mfma_f32_32x32x16_bf16 v[48:63], v[20:23], v[236:239], v[48:63]
  v_permlane16_swap_b32 v83, v91
  v_accvgpr_write_b32 a124, v80
  ds_read_b128 v[20:23], v9 offset:16384
  s_waitcnt lgkmcnt(3)
  v_mfma_f32_32x32x16_bf16 v[32:47], v[24:27], v[176:179], v[32:47]
  v_accvgpr_write_b32 a125, v81
  v_accvgpr_write_b32 a126, v82
  v_accvgpr_write_b32 a127, v83
  v_mfma_f32_32x32x16_bf16 v[48:63], v[24:27], v[240:243], v[48:63]
  v_accvgpr_write_b32 a180, v88
  v_accvgpr_write_b32 a181, v89
  ds_read_b128 v[24:27], v10 offset:16384
  s_waitcnt lgkmcnt(3)
  v_mfma_f32_32x32x16_bf16 v[32:47], v[28:31], v[180:183], v[32:47]
  v_accvgpr_write_b32 a182, v90
  v_accvgpr_write_b32 a183, v91
  v_mfma_f32_32x32x16_bf16 v[48:63], v[28:31], v[244:247], v[48:63]
  s_waitcnt vmcnt(16)
  s_barrier
  ds_read_b128 v[28:31], v11 offset:16384
  s_waitcnt lgkmcnt(3)
  v_mfma_f32_32x32x16_bf16 v[64:79], v[16:19], v[120:123], 0
  s_add_u32 s22, s27, 3145728
  s_add_u32 m0, s25, 49152
  s_nop 0
  buffer_load_dwordx4 v4, s[56:59], s22 offen offset:0 lds
  v_mfma_f32_32x32x16_bf16 v[80:95], v[16:19], v[184:187], 0
  ds_read_b128 v[16:19], v12 offset:16384
  s_waitcnt lgkmcnt(3)
  v_mfma_f32_32x32x16_bf16 v[64:79], v[20:23], v[124:127], v[64:79]
  buffer_load_dwordx4 v5, s[56:59], s22 offen offset:1024 lds
  v_mul_f32 v32, s52, v32
  v_mul_f32 v33, s52, v33
  v_cvt_pk_bf16_f32 v32, v32, v33
  v_mfma_f32_32x32x16_bf16 v[80:95], v[20:23], v[188:191], v[80:95]
  v_mul_f32 v34, s52, v34
  v_mul_f32 v35, s52, v35
  ds_read_b128 v[20:23], v13 offset:16384
  s_waitcnt lgkmcnt(3)
  v_mfma_f32_32x32x16_bf16 v[64:79], v[24:27], v[128:131], v[64:79]
  buffer_load_dwordx4 v6, s[56:59], s22 offen offset:2048 lds
  v_cvt_pk_bf16_f32 v33, v34, v35
  v_mul_f32 v36, s52, v36
  v_mul_f32 v37, s52, v37
  v_mfma_f32_32x32x16_bf16 v[80:95], v[24:27], v[192:195], v[80:95]
  v_cvt_pk_bf16_f32 v34, v36, v37
  v_mul_f32 v38, s52, v38
  ds_read_b128 v[24:27], v14 offset:16384
  s_waitcnt lgkmcnt(3)
  v_mfma_f32_32x32x16_bf16 v[64:79], v[28:31], v[132:135], v[64:79]
  buffer_load_dwordx4 v7, s[56:59], s22 offen offset:3072 lds
  v_mul_f32 v39, s52, v39
  v_cvt_pk_bf16_f32 v35, v38, v39
  v_mul_f32 v40, s52, v40
  v_mfma_f32_32x32x16_bf16 v[80:95], v[28:31], v[196:199], v[80:95]
  v_mul_f32 v41, s52, v41
  v_cvt_pk_bf16_f32 v40, v40, v41
  ds_read_b128 v[28:31], v15 offset:16384
  s_waitcnt lgkmcnt(3)
  v_mfma_f32_32x32x16_bf16 v[64:79], v[16:19], v[136:139], v[64:79]
  s_add_u32 s22, s27, 3407872
  s_add_u32 m0, s25, 65536
  s_nop 0
  buffer_load_dwordx4 v4, s[56:59], s22 offen offset:0 lds
  v_mul_f32 v42, s52, v42
  v_mul_f32 v43, s52, v43
  v_cvt_pk_bf16_f32 v41, v42, v43
  v_mfma_f32_32x32x16_bf16 v[80:95], v[16:19], v[200:203], v[80:95]
  v_mul_f32 v44, s52, v44
  v_mul_f32 v45, s52, v45
  ds_read_b128 v[16:19], v8 offset:16640
  s_waitcnt lgkmcnt(3)
  v_mfma_f32_32x32x16_bf16 v[64:79], v[20:23], v[140:143], v[64:79]
  buffer_load_dwordx4 v5, s[56:59], s22 offen offset:1024 lds
  v_cvt_pk_bf16_f32 v42, v44, v45
  v_mul_f32 v46, s52, v46
  v_mul_f32 v47, s52, v47
  v_mfma_f32_32x32x16_bf16 v[80:95], v[20:23], v[204:207], v[80:95]
  v_cvt_pk_bf16_f32 v43, v46, v47
  v_permlane16_swap_b32 v32, v40
  ds_read_b128 v[20:23], v9 offset:16640
  s_waitcnt lgkmcnt(3)
  v_mfma_f32_32x32x16_bf16 v[64:79], v[24:27], v[144:147], v[64:79]
  buffer_load_dwordx4 v6, s[56:59], s22 offen offset:2048 lds
  v_permlane16_swap_b32 v33, v41
  v_permlane16_swap_b32 v34, v42
  v_permlane16_swap_b32 v35, v43
  v_mfma_f32_32x32x16_bf16 v[80:95], v[24:27], v[208:211], v[80:95]
  v_accvgpr_write_b32 a16, v32
  v_accvgpr_write_b32 a17, v33
  ds_read_b128 v[24:27], v10 offset:16640
  s_waitcnt lgkmcnt(3)
  v_mfma_f32_32x32x16_bf16 v[64:79], v[28:31], v[148:151], v[64:79]
  buffer_load_dwordx4 v7, s[56:59], s22 offen offset:3072 lds
  v_accvgpr_write_b32 a18, v34
  v_accvgpr_write_b32 a19, v35
  v_accvgpr_write_b32 a72, v40
  v_mfma_f32_32x32x16_bf16 v[80:95], v[28:31], v[212:215], v[80:95]
  v_accvgpr_write_b32 a73, v41
  v_accvgpr_write_b32 a74, v42
  ds_read_b128 v[28:31], v11 offset:16640
  s_waitcnt lgkmcnt(3)
  v_mfma_f32_32x32x16_bf16 v[64:79], v[16:19], v[152:155], v[64:79]
  v_accvgpr_write_b32 a75, v43
  v_mul_f32 v48, s52, v48
  v_mul_f32 v49, s52, v49
  v_mfma_f32_32x32x16_bf16 v[80:95], v[16:19], v[216:219], v[80:95]
  v_cvt_pk_bf16_f32 v48, v48, v49
  v_mul_f32 v50, s52, v50
  ds_read_b128 v[16:19], v12 offset:16640
  s_waitcnt lgkmcnt(3)
  v_mfma_f32_32x32x16_bf16 v[64:79], v[20:23], v[156:159], v[64:79]
  v_mul_f32 v51, s52, v51
  v_cvt_pk_bf16_f32 v49, v50, v51
  v_mul_f32 v52, s52, v52
  v_mfma_f32_32x32x16_bf16 v[80:95], v[20:23], v[220:223], v[80:95]
  v_mul_f32 v53, s52, v53
  v_cvt_pk_bf16_f32 v50, v52, v53
  ds_read_b128 v[20:23], v13 offset:16640
  s_waitcnt lgkmcnt(3)
  v_mfma_f32_32x32x16_bf16 v[64:79], v[24:27], v[160:163], v[64:79]
  v_mul_f32 v54, s52, v54
  v_mul_f32 v55, s52, v55
  v_cvt_pk_bf16_f32 v51, v54, v55
  v_mfma_f32_32x32x16_bf16 v[80:95], v[24:27], v[224:227], v[80:95]
  v_mul_f32 v56, s52, v56
  v_mul_f32 v57, s52, v57
  ds_read_b128 v[24:27], v14 offset:16640
  s_waitcnt lgkmcnt(3)
  v_mfma_f32_32x32x16_bf16 v[64:79], v[28:31], v[164:167], v[64:79]
  v_cvt_pk_bf16_f32 v56, v56, v57
  v_mul_f32 v58, s52, v58
  v_mul_f32 v59, s52, v59
  v_mfma_f32_32x32x16_bf16 v[80:95], v[28:31], v[228:231], v[80:95]
  v_cvt_pk_bf16_f32 v57, v58, v59
  v_mul_f32 v60, s52, v60
  ds_read_b128 v[28:31], v15 offset:16640
  s_waitcnt lgkmcnt(3)
  v_mfma_f32_32x32x16_bf16 v[64:79], v[16:19], v[168:171], v[64:79]
  v_mul_f32 v61, s52, v61
  v_cvt_pk_bf16_f32 v58, v60, v61
  v_mul_f32 v62, s52, v62
  v_mfma_f32_32x32x16_bf16 v[80:95], v[16:19], v[232:235], v[80:95]
  v_mul_f32 v63, s52, v63
  v_cvt_pk_bf16_f32 v59, v62, v63
  ds_read_b128 v[16:19], v8 offset:32768
  s_waitcnt lgkmcnt(3)
  v_mfma_f32_32x32x16_bf16 v[64:79], v[20:23], v[172:175], v[64:79]
  v_permlane16_swap_b32 v48, v56
  v_permlane16_swap_b32 v49, v57
  v_permlane16_swap_b32 v50, v58
  v_mfma_f32_32x32x16_bf16 v[80:95], v[20:23], v[236:239], v[80:95]
  v_permlane16_swap_b32 v51, v59
  v_accvgpr_write_b32 a128, v48
  ds_read_b128 v[20:23], v9 offset:32768
  s_waitcnt lgkmcnt(3)
  v_mfma_f32_32x32x16_bf16 v[64:79], v[24:27], v[176:179], v[64:79]
  v_accvgpr_write_b32 a129, v49
  v_accvgpr_write_b32 a130, v50
  v_accvgpr_write_b32 a131, v51
  v_mfma_f32_32x32x16_bf16 v[80:95], v[24:27], v[240:243], v[80:95]
  v_accvgpr_write_b32 a184, v56
  v_accvgpr_write_b32 a185, v57
  ds_read_b128 v[24:27], v10 offset:32768
  s_waitcnt lgkmcnt(3)
  v_mfma_f32_32x32x16_bf16 v[64:79], v[28:31], v[180:183], v[64:79]
  v_accvgpr_write_b32 a186, v58
  v_accvgpr_write_b32 a187, v59
  v_mfma_f32_32x32x16_bf16 v[80:95], v[28:31], v[244:247], v[80:95]
  ds_read_b128 v[28:31], v11 offset:32768
  s_waitcnt lgkmcnt(3)
  v_mfma_f32_32x32x16_bf16 v[32:47], v[16:19], v[120:123], 0
  v_mfma_f32_32x32x16_bf16 v[48:63], v[16:19], v[184:187], 0
  ds_read_b128 v[16:19], v12 offset:32768
  s_waitcnt lgkmcnt(3)
  v_mfma_f32_32x32x16_bf16 v[32:47], v[20:23], v[124:127], v[32:47]
  v_mul_f32 v64, s52, v64
  v_mul_f32 v65, s52, v65
  v_cvt_pk_bf16_f32 v64, v64, v65
  v_mfma_f32_32x32x16_bf16 v[48:63], v[20:23], v[188:191], v[48:63]
  v_mul_f32 v66, s52, v66
  v_mul_f32 v67, s52, v67
  ds_read_b128 v[20:23], v13 offset:32768
  s_waitcnt lgkmcnt(3)
  v_mfma_f32_32x32x16_bf16 v[32:47], v[24:27], v[128:131], v[32:47]
  v_cvt_pk_bf16_f32 v65, v66, v67
  v_mul_f32 v68, s52, v68
  v_mul_f32 v69, s52, v69
  v_mfma_f32_32x32x16_bf16 v[48:63], v[24:27], v[192:195], v[48:63]
  v_cvt_pk_bf16_f32 v66, v68, v69
  v_mul_f32 v70, s52, v70
  ds_read_b128 v[24:27], v14 offset:32768
  s_waitcnt lgkmcnt(3)
  v_mfma_f32_32x32x16_bf16 v[32:47], v[28:31], v[132:135], v[32:47]
  v_mul_f32 v71, s52, v71
  v_cvt_pk_bf16_f32 v67, v70, v71
  v_mul_f32 v72, s52, v72
  v_mfma_f32_32x32x16_bf16 v[48:63], v[28:31], v[196:199], v[48:63]
  v_mul_f32 v73, s52, v73
  v_cvt_pk_bf16_f32 v72, v72, v73
  ds_read_b128 v[28:31], v15 offset:32768
  s_waitcnt lgkmcnt(3)
  v_mfma_f32_32x32x16_bf16 v[32:47], v[16:19], v[136:139], v[32:47]
  v_mul_f32 v74, s52, v74
  v_mul_f32 v75, s52, v75
  v_cvt_pk_bf16_f32 v73, v74, v75
  v_mfma_f32_32x32x16_bf16 v[48:63], v[16:19], v[200:203], v[48:63]
  v_mul_f32 v76, s52, v76
  v_mul_f32 v77, s52, v77
  ds_read_b128 v[16:19], v8 offset:33024
  s_waitcnt lgkmcnt(3)
  v_mfma_f32_32x32x16_bf16 v[32:47], v[20:23], v[140:143], v[32:47]
  v_cvt_pk_bf16_f32 v74, v76, v77
  v_mul_f32 v78, s52, v78
  v_mul_f32 v79, s52, v79
  v_mfma_f32_32x32x16_bf16 v[48:63], v[20:23], v[204:207], v[48:63]
  v_cvt_pk_bf16_f32 v75, v78, v79
  v_permlane16_swap_b32 v64, v72
  ds_read_b128 v[20:23], v9 offset:33024
  s_waitcnt lgkmcnt(3)
  v_mfma_f32_32x32x16_bf16 v[32:47], v[24:27], v[144:147], v[32:47]
  v_permlane16_swap_b32 v65, v73
  v_permlane16_swap_b32 v66, v74
  v_permlane16_swap_b32 v67, v75
  v_mfma_f32_32x32x16_bf16 v[48:63], v[24:27], v[208:211], v[48:63]
  v_accvgpr_write_b32 a20, v64
  v_accvgpr_write_b32 a21, v65
  ds_read_b128 v[24:27], v10 offset:33024
  s_waitcnt lgkmcnt(3)
  v_mfma_f32_32x32x16_bf16 v[32:47], v[28:31], v[148:151], v[32:47]
  v_accvgpr_write_b32 a22, v66
  v_accvgpr_write_b32 a23, v67
  v_accvgpr_write_b32 a76, v72
  v_mfma_f32_32x32x16_bf16 v[48:63], v[28:31], v[212:215], v[48:63]
  v_accvgpr_write_b32 a77, v73
  v_accvgpr_write_b32 a78, v74
  ds_read_b128 v[28:31], v11 offset:33024
  s_waitcnt lgkmcnt(3)
  v_mfma_f32_32x32x16_bf16 v[32:47], v[16:19], v[152:155], v[32:47]
  v_accvgpr_write_b32 a79, v75
  v_mul_f32 v80, s52, v80
  v_mul_f32 v81, s52, v81
  v_mfma_f32_32x32x16_bf16 v[48:63], v[16:19], v[216:219], v[48:63]
  v_cvt_pk_bf16_f32 v80, v80, v81
  v_mul_f32 v82, s52, v82
  ds_read_b128 v[16:19], v12 offset:33024
  s_waitcnt lgkmcnt(3)
  v_mfma_f32_32x32x16_bf16 v[32:47], v[20:23], v[156:159], v[32:47]
  v_mul_f32 v83, s52, v83
  v_cvt_pk_bf16_f32 v81, v82, v83
  v_mul_f32 v84, s52, v84
  v_mfma_f32_32x32x16_bf16 v[48:63], v[20:23], v[220:223], v[48:63]
  v_mul_f32 v85, s52, v85
  v_cvt_pk_bf16_f32 v82, v84, v85
  ds_read_b128 v[20:23], v13 offset:33024
  s_waitcnt lgkmcnt(3)
  v_mfma_f32_32x32x16_bf16 v[32:47], v[24:27], v[160:163], v[32:47]
  v_mul_f32 v86, s52, v86
  v_mul_f32 v87, s52, v87
  v_cvt_pk_bf16_f32 v83, v86, v87
  v_mfma_f32_32x32x16_bf16 v[48:63], v[24:27], v[224:227], v[48:63]
  v_mul_f32 v88, s52, v88
  v_mul_f32 v89, s52, v89
  ds_read_b128 v[24:27], v14 offset:33024
  s_waitcnt lgkmcnt(3)
  v_mfma_f32_32x32x16_bf16 v[32:47], v[28:31], v[164:167], v[32:47]
  v_cvt_pk_bf16_f32 v88, v88, v89
  v_mul_f32 v90, s52, v90
  v_mul_f32 v91, s52, v91
  v_mfma_f32_32x32x16_bf16 v[48:63], v[28:31], v[228:231], v[48:63]
  v_cvt_pk_bf16_f32 v89, v90, v91
  v_mul_f32 v92, s52, v92
  ds_read_b128 v[28:31], v15 offset:33024
  s_waitcnt lgkmcnt(3)
  v_mfma_f32_32x32x16_bf16 v[32:47], v[16:19], v[168:171], v[32:47]
  v_mul_f32 v93, s52, v93
  v_cvt_pk_bf16_f32 v90, v92, v93
  v_mul_f32 v94, s52, v94
  v_mfma_f32_32x32x16_bf16 v[48:63], v[16:19], v[232:235], v[48:63]
  v_mul_f32 v95, s52, v95
  v_cvt_pk_bf16_f32 v91, v94, v95
  ds_read_b128 v[16:19], v8 offset:49152
  s_waitcnt lgkmcnt(3)
  v_mfma_f32_32x32x16_bf16 v[32:47], v[20:23], v[172:175], v[32:47]
  v_permlane16_swap_b32 v80, v88
  v_permlane16_swap_b32 v81, v89
  v_permlane16_swap_b32 v82, v90
  v_mfma_f32_32x32x16_bf16 v[48:63], v[20:23], v[236:239], v[48:63]
  v_permlane16_swap_b32 v83, v91
  v_accvgpr_write_b32 a132, v80
  ds_read_b128 v[20:23], v9 offset:49152
  s_waitcnt lgkmcnt(3)
  v_mfma_f32_32x32x16_bf16 v[32:47], v[24:27], v[176:179], v[32:47]
  v_accvgpr_write_b32 a133, v81
  v_accvgpr_write_b32 a134, v82
  v_accvgpr_write_b32 a135, v83
  v_mfma_f32_32x32x16_bf16 v[48:63], v[24:27], v[240:243], v[48:63]
  v_accvgpr_write_b32 a188, v88
  v_accvgpr_write_b32 a189, v89
  ds_read_b128 v[24:27], v10 offset:49152
  s_waitcnt lgkmcnt(3)
  v_mfma_f32_32x32x16_bf16 v[32:47], v[28:31], v[180:183], v[32:47]
  v_accvgpr_write_b32 a190, v90
  v_accvgpr_write_b32 a191, v91
  v_mfma_f32_32x32x16_bf16 v[48:63], v[28:31], v[244:247], v[48:63]
  s_waitcnt vmcnt(16)
  s_barrier
  ds_read_b128 v[28:31], v11 offset:49152
  s_waitcnt lgkmcnt(3)
  v_mfma_f32_32x32x16_bf16 v[64:79], v[16:19], v[120:123], 0
  v_mfma_f32_32x32x16_bf16 v[80:95], v[16:19], v[184:187], 0
  ds_read_b128 v[16:19], v12 offset:49152
  s_waitcnt lgkmcnt(3)
  v_mfma_f32_32x32x16_bf16 v[64:79], v[20:23], v[124:127], v[64:79]
  v_mul_f32 v32, s52, v32
  v_mul_f32 v33, s52, v33
  v_cvt_pk_bf16_f32 v32, v32, v33
  v_mfma_f32_32x32x16_bf16 v[80:95], v[20:23], v[188:191], v[80:95]
  v_mul_f32 v34, s52, v34
  v_mul_f32 v35, s52, v35
  ds_read_b128 v[20:23], v13 offset:49152
  s_waitcnt lgkmcnt(3)
  v_mfma_f32_32x32x16_bf16 v[64:79], v[24:27], v[128:131], v[64:79]
  v_cvt_pk_bf16_f32 v33, v34, v35
  v_mul_f32 v36, s52, v36
  v_mul_f32 v37, s52, v37
  v_mfma_f32_32x32x16_bf16 v[80:95], v[24:27], v[192:195], v[80:95]
  v_cvt_pk_bf16_f32 v34, v36, v37
  v_mul_f32 v38, s52, v38
  ds_read_b128 v[24:27], v14 offset:49152
  s_waitcnt lgkmcnt(3)
  v_mfma_f32_32x32x16_bf16 v[64:79], v[28:31], v[132:135], v[64:79]
  v_mul_f32 v39, s52, v39
  v_cvt_pk_bf16_f32 v35, v38, v39
  v_mul_f32 v40, s52, v40
  v_mfma_f32_32x32x16_bf16 v[80:95], v[28:31], v[196:199], v[80:95]
  v_mul_f32 v41, s52, v41
  v_cvt_pk_bf16_f32 v40, v40, v41
  ds_read_b128 v[28:31], v15 offset:49152
  s_waitcnt lgkmcnt(3)
  v_mfma_f32_32x32x16_bf16 v[64:79], v[16:19], v[136:139], v[64:79]
  v_mul_f32 v42, s52, v42
  v_mul_f32 v43, s52, v43
  v_cvt_pk_bf16_f32 v41, v42, v43
  v_mfma_f32_32x32x16_bf16 v[80:95], v[16:19], v[200:203], v[80:95]
  v_mul_f32 v44, s52, v44
  v_mul_f32 v45, s52, v45
  ds_read_b128 v[16:19], v8 offset:49408
  s_waitcnt lgkmcnt(3)
  v_mfma_f32_32x32x16_bf16 v[64:79], v[20:23], v[140:143], v[64:79]
  v_cvt_pk_bf16_f32 v42, v44, v45
  v_mul_f32 v46, s52, v46
  v_mul_f32 v47, s52, v47
  v_mfma_f32_32x32x16_bf16 v[80:95], v[20:23], v[204:207], v[80:95]
  v_cvt_pk_bf16_f32 v43, v46, v47
  v_permlane16_swap_b32 v32, v40
  ds_read_b128 v[20:23], v9 offset:49408
  s_waitcnt lgkmcnt(3)
  v_mfma_f32_32x32x16_bf16 v[64:79], v[24:27], v[144:147], v[64:79]
  v_permlane16_swap_b32 v33, v41
  v_permlane16_swap_b32 v34, v42
  v_permlane16_swap_b32 v35, v43
  v_mfma_f32_32x32x16_bf16 v[80:95], v[24:27], v[208:211], v[80:95]
  v_accvgpr_write_b32 a24, v32
  v_accvgpr_write_b32 a25, v33
  ds_read_b128 v[24:27], v10 offset:49408
  s_waitcnt lgkmcnt(3)
  v_mfma_f32_32x32x16_bf16 v[64:79], v[28:31], v[148:151], v[64:79]
  v_accvgpr_write_b32 a26, v34
  v_accvgpr_write_b32 a27, v35
  v_accvgpr_write_b32 a80, v40
  v_mfma_f32_32x32x16_bf16 v[80:95], v[28:31], v[212:215], v[80:95]
  v_accvgpr_write_b32 a81, v41
  v_accvgpr_write_b32 a82, v42
  ds_read_b128 v[28:31], v11 offset:49408
  s_waitcnt lgkmcnt(3)
  v_mfma_f32_32x32x16_bf16 v[64:79], v[16:19], v[152:155], v[64:79]
  v_accvgpr_write_b32 a83, v43
  v_mul_f32 v48, s52, v48
  v_mul_f32 v49, s52, v49
  v_mfma_f32_32x32x16_bf16 v[80:95], v[16:19], v[216:219], v[80:95]
  v_cvt_pk_bf16_f32 v48, v48, v49
  v_mul_f32 v50, s52, v50
  ds_read_b128 v[16:19], v12 offset:49408
  s_waitcnt lgkmcnt(3)
  v_mfma_f32_32x32x16_bf16 v[64:79], v[20:23], v[156:159], v[64:79]
  v_mul_f32 v51, s52, v51
  v_cvt_pk_bf16_f32 v49, v50, v51
  v_mul_f32 v52, s52, v52
  v_mfma_f32_32x32x16_bf16 v[80:95], v[20:23], v[220:223], v[80:95]
  v_mul_f32 v53, s52, v53
  v_cvt_pk_bf16_f32 v50, v52, v53
  ds_read_b128 v[20:23], v13 offset:49408
  s_waitcnt lgkmcnt(3)
  v_mfma_f32_32x32x16_bf16 v[64:79], v[24:27], v[160:163], v[64:79]
  v_mul_f32 v54, s52, v54
  v_mul_f32 v55, s52, v55
  v_cvt_pk_bf16_f32 v51, v54, v55
  v_mfma_f32_32x32x16_bf16 v[80:95], v[24:27], v[224:227], v[80:95]
  v_mul_f32 v56, s52, v56
  v_mul_f32 v57, s52, v57
  ds_read_b128 v[24:27], v14 offset:49408
  s_waitcnt lgkmcnt(3)
  v_mfma_f32_32x32x16_bf16 v[64:79], v[28:31], v[164:167], v[64:79]
  v_cvt_pk_bf16_f32 v56, v56, v57
  v_mul_f32 v58, s52, v58
  v_mul_f32 v59, s52, v59
  v_mfma_f32_32x32x16_bf16 v[80:95], v[28:31], v[228:231], v[80:95]
  v_cvt_pk_bf16_f32 v57, v58, v59
  v_mul_f32 v60, s52, v60
  ds_read_b128 v[28:31], v15 offset:49408
  s_waitcnt lgkmcnt(3)
  v_mfma_f32_32x32x16_bf16 v[64:79], v[16:19], v[168:171], v[64:79]
  v_mul_f32 v61, s52, v61
  v_cvt_pk_bf16_f32 v58, v60, v61
  v_mul_f32 v62, s52, v62
  v_mfma_f32_32x32x16_bf16 v[80:95], v[16:19], v[232:235], v[80:95]
  v_mul_f32 v63, s52, v63
  v_cvt_pk_bf16_f32 v59, v62, v63
  v_xor_b32 v8, 196608, v8
  ds_read_b128 v[16:19], v8 offset:0
  s_waitcnt lgkmcnt(3)
  v_mfma_f32_32x32x16_bf16 v[64:79], v[20:23], v[172:175], v[64:79]
  v_permlane16_swap_b32 v48, v56
  v_permlane16_swap_b32 v49, v57
  v_permlane16_swap_b32 v50, v58
  v_mfma_f32_32x32x16_bf16 v[80:95], v[20:23], v[236:239], v[80:95]
  v_permlane16_swap_b32 v51, v59
  v_accvgpr_write_b32 a136, v48
  v_xor_b32 v9, 196608, v9
  ds_read_b128 v[20:23], v9 offset:0
  s_waitcnt lgkmcnt(3)
  v_mfma_f32_32x32x16_bf16 v[64:79], v[24:27], v[176:179], v[64:79]
  v_accvgpr_write_b32 a137, v49
  v_accvgpr_write_b32 a138, v50
  v_accvgpr_write_b32 a139, v51
  v_mfma_f32_32x32x16_bf16 v[80:95], v[24:27], v[240:243], v[80:95]
  v_accvgpr_write_b32 a192, v56
  v_accvgpr_write_b32 a193, v57
  v_xor_b32 v10, 196608, v10
  ds_read_b128 v[24:27], v10 offset:0
  s_waitcnt lgkmcnt(3)
  v_mfma_f32_32x32x16_bf16 v[64:79], v[28:31], v[180:183], v[64:79]
  v_accvgpr_write_b32 a194, v58
  v_accvgpr_write_b32 a195, v59
  v_mfma_f32_32x32x16_bf16 v[80:95], v[28:31], v[244:247], v[80:95]
  v_xor_b32 v11, 196608, v11
  ds_read_b128 v[28:31], v11 offset:0
  s_waitcnt lgkmcnt(3)
  v_mfma_f32_32x32x16_bf16 v[32:47], v[16:19], v[120:123], 0
  v_mfma_f32_32x32x16_bf16 v[48:63], v[16:19], v[184:187], 0
  v_xor_b32 v12, 196608, v12
  ds_read_b128 v[16:19], v12 offset:0
  s_waitcnt lgkmcnt(3)
  v_mfma_f32_32x32x16_bf16 v[32:47], v[20:23], v[124:127], v[32:47]
  v_mul_f32 v64, s52, v64
  v_mul_f32 v65, s52, v65
  v_cvt_pk_bf16_f32 v64, v64, v65
  v_mfma_f32_32x32x16_bf16 v[48:63], v[20:23], v[188:191], v[48:63]
  v_mul_f32 v66, s52, v66
  v_mul_f32 v67, s52, v67
  v_xor_b32 v13, 196608, v13
  ds_read_b128 v[20:23], v13 offset:0
  s_waitcnt lgkmcnt(3)
  v_mfma_f32_32x32x16_bf16 v[32:47], v[24:27], v[128:131], v[32:47]
  v_cvt_pk_bf16_f32 v65, v66, v67
  v_mul_f32 v68, s52, v68
  v_mul_f32 v69, s52, v69
  v_mfma_f32_32x32x16_bf16 v[48:63], v[24:27], v[192:195], v[48:63]
  v_cvt_pk_bf16_f32 v66, v68, v69
  v_mul_f32 v70, s52, v70
  v_xor_b32 v14, 196608, v14
  ds_read_b128 v[24:27], v14 offset:0
  s_waitcnt lgkmcnt(3)
  v_mfma_f32_32x32x16_bf16 v[32:47], v[28:31], v[132:135], v[32:47]
  v_mul_f32 v71, s52, v71
  v_cvt_pk_bf16_f32 v67, v70, v71
  v_mul_f32 v72, s52, v72
  v_mfma_f32_32x32x16_bf16 v[48:63], v[28:31], v[196:199], v[48:63]
  v_mul_f32 v73, s52, v73
  v_cvt_pk_bf16_f32 v72, v72, v73
  v_xor_b32 v15, 196608, v15
  ds_read_b128 v[28:31], v15 offset:0
  s_waitcnt lgkmcnt(3)
  v_mfma_f32_32x32x16_bf16 v[32:47], v[16:19], v[136:139], v[32:47]
  v_mul_f32 v74, s52, v74
  v_mul_f32 v75, s52, v75
  v_cvt_pk_bf16_f32 v73, v74, v75
  v_mfma_f32_32x32x16_bf16 v[48:63], v[16:19], v[200:203], v[48:63]
  v_mul_f32 v76, s52, v76
  v_mul_f32 v77, s52, v77
  ds_read_b128 v[16:19], v8 offset:256
  s_waitcnt lgkmcnt(3)
  v_mfma_f32_32x32x16_bf16 v[32:47], v[20:23], v[140:143], v[32:47]
  v_cvt_pk_bf16_f32 v74, v76, v77
  v_mul_f32 v78, s52, v78
  v_mul_f32 v79, s52, v79
  v_mfma_f32_32x32x16_bf16 v[48:63], v[20:23], v[204:207], v[48:63]
  v_cvt_pk_bf16_f32 v75, v78, v79
  v_permlane16_swap_b32 v64, v72
  ds_read_b128 v[20:23], v9 offset:256
  s_waitcnt lgkmcnt(3)
  v_mfma_f32_32x32x16_bf16 v[32:47], v[24:27], v[144:147], v[32:47]
  v_permlane16_swap_b32 v65, v73
  v_permlane16_swap_b32 v66, v74
  v_permlane16_swap_b32 v67, v75
  v_mfma_f32_32x32x16_bf16 v[48:63], v[24:27], v[208:211], v[48:63]
  v_accvgpr_write_b32 a28, v64
  v_accvgpr_write_b32 a29, v65
  ds_read_b128 v[24:27], v10 offset:256
  s_waitcnt lgkmcnt(3)
  v_mfma_f32_32x32x16_bf16 v[32:47], v[28:31], v[148:151], v[32:47]
  v_accvgpr_write_b32 a30, v66
  v_accvgpr_write_b32 a31, v67
  v_accvgpr_write_b32 a84, v72
  v_mfma_f32_32x32x16_bf16 v[48:63], v[28:31], v[212:215], v[48:63]
  v_accvgpr_write_b32 a85, v73
  v_accvgpr_write_b32 a86, v74
  ds_read_b128 v[28:31], v11 offset:256
  s_waitcnt lgkmcnt(3)
  v_mfma_f32_32x32x16_bf16 v[32:47], v[16:19], v[152:155], v[32:47]
  v_accvgpr_write_b32 a87, v75
  v_mul_f32 v80, s52, v80
  v_mul_f32 v81, s52, v81
  v_mfma_f32_32x32x16_bf16 v[48:63], v[16:19], v[216:219], v[48:63]
  v_cvt_pk_bf16_f32 v80, v80, v81
  v_mul_f32 v82, s52, v82
  ds_read_b128 v[16:19], v12 offset:256
  s_waitcnt lgkmcnt(3)
  v_mfma_f32_32x32x16_bf16 v[32:47], v[20:23], v[156:159], v[32:47]
  v_mul_f32 v83, s52, v83
  v_cvt_pk_bf16_f32 v81, v82, v83
  v_mul_f32 v84, s52, v84
  v_mfma_f32_32x32x16_bf16 v[48:63], v[20:23], v[220:223], v[48:63]
  v_mul_f32 v85, s52, v85
  v_cvt_pk_bf16_f32 v82, v84, v85
  ds_read_b128 v[20:23], v13 offset:256
  s_waitcnt lgkmcnt(3)
  v_mfma_f32_32x32x16_bf16 v[32:47], v[24:27], v[160:163], v[32:47]
  v_mul_f32 v86, s52, v86
  v_mul_f32 v87, s52, v87
  v_cvt_pk_bf16_f32 v83, v86, v87
  v_mfma_f32_32x32x16_bf16 v[48:63], v[24:27], v[224:227], v[48:63]
  v_mul_f32 v88, s52, v88
  v_mul_f32 v89, s52, v89
  ds_read_b128 v[24:27], v14 offset:256
  s_waitcnt lgkmcnt(3)
  v_mfma_f32_32x32x16_bf16 v[32:47], v[28:31], v[164:167], v[32:47]
  v_cvt_pk_bf16_f32 v88, v88, v89
  v_mul_f32 v90, s52, v90
  v_mul_f32 v91, s52, v91
  v_mfma_f32_32x32x16_bf16 v[48:63], v[28:31], v[228:231], v[48:63]
  v_cvt_pk_bf16_f32 v89, v90, v91
  v_mul_f32 v92, s52, v92
  ds_read_b128 v[28:31], v15 offset:256
  s_waitcnt lgkmcnt(3)
  v_mfma_f32_32x32x16_bf16 v[32:47], v[16:19], v[168:171], v[32:47]
  v_mul_f32 v93, s52, v93
  v_cvt_pk_bf16_f32 v90, v92, v93
  v_mul_f32 v94, s52, v94
  v_mfma_f32_32x32x16_bf16 v[48:63], v[16:19], v[232:235], v[48:63]
  v_mul_f32 v95, s52, v95
  v_cvt_pk_bf16_f32 v91, v94, v95
  v_xor_b32 v8, 131072, v8
  ds_read_b128 v[16:19], v8 offset:0
  s_waitcnt lgkmcnt(3)
  v_mfma_f32_32x32x16_bf16 v[32:47], v[20:23], v[172:175], v[32:47]
  v_permlane16_swap_b32 v80, v88
  v_permlane16_swap_b32 v81, v89
  v_permlane16_swap_b32 v82, v90
  v_mfma_f32_32x32x16_bf16 v[48:63], v[20:23], v[236:239], v[48:63]
  v_permlane16_swap_b32 v83, v91
  v_accvgpr_write_b32 a140, v80
  v_xor_b32 v9, 131072, v9
  ds_read_b128 v[20:23], v9 offset:0
  s_waitcnt lgkmcnt(3)
  v_mfma_f32_32x32x16_bf16 v[32:47], v[24:27], v[176:179], v[32:47]
  v_accvgpr_write_b32 a141, v81
  v_accvgpr_write_b32 a142, v82
  v_accvgpr_write_b32 a143, v83
  v_mfma_f32_32x32x16_bf16 v[48:63], v[24:27], v[240:243], v[48:63]
  v_accvgpr_write_b32 a196, v88
  v_accvgpr_write_b32 a197, v89
  v_xor_b32 v10, 131072, v10
  ds_read_b128 v[24:27], v10 offset:0
  s_waitcnt lgkmcnt(3)
  v_mfma_f32_32x32x16_bf16 v[32:47], v[28:31], v[180:183], v[32:47]
  v_accvgpr_write_b32 a198, v90
  v_accvgpr_write_b32 a199, v91
  v_mfma_f32_32x32x16_bf16 v[48:63], v[28:31], v[244:247], v[48:63]
  s_waitcnt vmcnt(8)
  s_barrier
  v_xor_b32 v11, 131072, v11
  ds_read_b128 v[28:31], v11 offset:0
  s_waitcnt lgkmcnt(3)
  v_mfma_f32_32x32x16_bf16 v[64:79], v[16:19], v[120:123], 0
  v_mfma_f32_32x32x16_bf16 v[80:95], v[16:19], v[184:187], 0
  v_xor_b32 v12, 131072, v12
  ds_read_b128 v[16:19], v12 offset:0
  s_waitcnt lgkmcnt(3)
  v_mfma_f32_32x32x16_bf16 v[64:79], v[20:23], v[124:127], v[64:79]
  v_mul_f32 v32, s52, v32
  v_mul_f32 v33, s52, v33
  v_cvt_pk_bf16_f32 v32, v32, v33
  v_mfma_f32_32x32x16_bf16 v[80:95], v[20:23], v[188:191], v[80:95]
  v_mul_f32 v34, s52, v34
  v_mul_f32 v35, s52, v35
  v_xor_b32 v13, 131072, v13
  ds_read_b128 v[20:23], v13 offset:0
  s_waitcnt lgkmcnt(3)
  v_mfma_f32_32x32x16_bf16 v[64:79], v[24:27], v[128:131], v[64:79]
  v_cvt_pk_bf16_f32 v33, v34, v35
  v_mul_f32 v36, s52, v36
  v_mul_f32 v37, s52, v37
  v_mfma_f32_32x32x16_bf16 v[80:95], v[24:27], v[192:195], v[80:95]
  v_cvt_pk_bf16_f32 v34, v36, v37
  v_mul_f32 v38, s52, v38
  v_xor_b32 v14, 131072, v14
  ds_read_b128 v[24:27], v14 offset:0
  s_waitcnt lgkmcnt(3)
  v_mfma_f32_32x32x16_bf16 v[64:79], v[28:31], v[132:135], v[64:79]
  v_mul_f32 v39, s52, v39
  v_cvt_pk_bf16_f32 v35, v38, v39
  v_mul_f32 v40, s52, v40
  v_mfma_f32_32x32x16_bf16 v[80:95], v[28:31], v[196:199], v[80:95]
  v_mul_f32 v41, s52, v41
  v_cvt_pk_bf16_f32 v40, v40, v41
  v_xor_b32 v15, 131072, v15
  ds_read_b128 v[28:31], v15 offset:0
  s_waitcnt lgkmcnt(3)
  v_mfma_f32_32x32x16_bf16 v[64:79], v[16:19], v[136:139], v[64:79]
  v_mul_f32 v42, s52, v42
  v_mul_f32 v43, s52, v43
  v_cvt_pk_bf16_f32 v41, v42, v43
  v_mfma_f32_32x32x16_bf16 v[80:95], v[16:19], v[200:203], v[80:95]
  v_mul_f32 v44, s52, v44
  v_mul_f32 v45, s52, v45
  ds_read_b128 v[16:19], v8 offset:256
  s_waitcnt lgkmcnt(3)
  v_mfma_f32_32x32x16_bf16 v[64:79], v[20:23], v[140:143], v[64:79]
  v_cvt_pk_bf16_f32 v42, v44, v45
  v_mul_f32 v46, s52, v46
  v_mul_f32 v47, s52, v47
  v_mfma_f32_32x32x16_bf16 v[80:95], v[20:23], v[204:207], v[80:95]
  v_cvt_pk_bf16_f32 v43, v46, v47
  v_permlane16_swap_b32 v32, v40
  ds_read_b128 v[20:23], v9 offset:256
  s_waitcnt lgkmcnt(3)
  v_mfma_f32_32x32x16_bf16 v[64:79], v[24:27], v[144:147], v[64:79]
  v_permlane16_swap_b32 v33, v41
  v_permlane16_swap_b32 v34, v42
  v_permlane16_swap_b32 v35, v43
  v_mfma_f32_32x32x16_bf16 v[80:95], v[24:27], v[208:211], v[80:95]
  v_accvgpr_write_b32 a32, v32
  v_accvgpr_write_b32 a33, v33
  ds_read_b128 v[24:27], v10 offset:256
  s_waitcnt lgkmcnt(3)
  v_mfma_f32_32x32x16_bf16 v[64:79], v[28:31], v[148:151], v[64:79]
  v_accvgpr_write_b32 a34, v34
  v_accvgpr_write_b32 a35, v35
  v_accvgpr_write_b32 a88, v40
  v_mfma_f32_32x32x16_bf16 v[80:95], v[28:31], v[212:215], v[80:95]
  v_accvgpr_write_b32 a89, v41
  v_accvgpr_write_b32 a90, v42
  ds_read_b128 v[28:31], v11 offset:256
  s_waitcnt lgkmcnt(3)
  v_mfma_f32_32x32x16_bf16 v[64:79], v[16:19], v[152:155], v[64:79]
  v_accvgpr_write_b32 a91, v43
  v_mul_f32 v48, s52, v48
  v_mul_f32 v49, s52, v49
  v_mfma_f32_32x32x16_bf16 v[80:95], v[16:19], v[216:219], v[80:95]
  v_cvt_pk_bf16_f32 v48, v48, v49
  v_mul_f32 v50, s52, v50
  ds_read_b128 v[16:19], v12 offset:256
  s_waitcnt lgkmcnt(3)
  v_mfma_f32_32x32x16_bf16 v[64:79], v[20:23], v[156:159], v[64:79]
  v_mul_f32 v51, s52, v51
  v_cvt_pk_bf16_f32 v49, v50, v51
  v_mul_f32 v52, s52, v52
  v_mfma_f32_32x32x16_bf16 v[80:95], v[20:23], v[220:223], v[80:95]
  v_mul_f32 v53, s52, v53
  v_cvt_pk_bf16_f32 v50, v52, v53
  ds_read_b128 v[20:23], v13 offset:256
  s_waitcnt lgkmcnt(3)
  v_mfma_f32_32x32x16_bf16 v[64:79], v[24:27], v[160:163], v[64:79]
  v_mul_f32 v54, s52, v54
  v_mul_f32 v55, s52, v55
  v_cvt_pk_bf16_f32 v51, v54, v55
  v_mfma_f32_32x32x16_bf16 v[80:95], v[24:27], v[224:227], v[80:95]
  v_mul_f32 v56, s52, v56
  v_mul_f32 v57, s52, v57
  ds_read_b128 v[24:27], v14 offset:256
  s_waitcnt lgkmcnt(3)
  v_mfma_f32_32x32x16_bf16 v[64:79], v[28:31], v[164:167], v[64:79]
  v_cvt_pk_bf16_f32 v56, v56, v57
  v_mul_f32 v58, s52, v58
  v_mul_f32 v59, s52, v59
  v_mfma_f32_32x32x16_bf16 v[80:95], v[28:31], v[228:231], v[80:95]
  v_cvt_pk_bf16_f32 v57, v58, v59
  v_mul_f32 v60, s52, v60
  ds_read_b128 v[28:31], v15 offset:256
  s_waitcnt lgkmcnt(3)
  v_mfma_f32_32x32x16_bf16 v[64:79], v[16:19], v[168:171], v[64:79]
  v_mul_f32 v61, s52, v61
  v_cvt_pk_bf16_f32 v58, v60, v61
  v_mul_f32 v62, s52, v62
  v_mfma_f32_32x32x16_bf16 v[80:95], v[16:19], v[232:235], v[80:95]
  v_mul_f32 v63, s52, v63
  v_cvt_pk_bf16_f32 v59, v62, v63
  ds_read_b128 v[16:19], v8 offset:16384
  s_waitcnt lgkmcnt(3)
  v_mfma_f32_32x32x16_bf16 v[64:79], v[20:23], v[172:175], v[64:79]
  v_permlane16_swap_b32 v48, v56
  v_permlane16_swap_b32 v49, v57
  v_permlane16_swap_b32 v50, v58
  v_mfma_f32_32x32x16_bf16 v[80:95], v[20:23], v[236:239], v[80:95]
  v_permlane16_swap_b32 v51, v59
  v_accvgpr_write_b32 a144, v48
  ds_read_b128 v[20:23], v9 offset:16384
  s_waitcnt lgkmcnt(3)
  v_mfma_f32_32x32x16_bf16 v[64:79], v[24:27], v[176:179], v[64:79]
  v_accvgpr_write_b32 a145, v49
  v_accvgpr_write_b32 a146, v50
  v_accvgpr_write_b32 a147, v51
  v_mfma_f32_32x32x16_bf16 v[80:95], v[24:27], v[240:243], v[80:95]
  v_accvgpr_write_b32 a200, v56
  v_accvgpr_write_b32 a201, v57
  ds_read_b128 v[24:27], v10 offset:16384
  s_waitcnt lgkmcnt(3)
  v_mfma_f32_32x32x16_bf16 v[64:79], v[28:31], v[180:183], v[64:79]
  v_accvgpr_write_b32 a202, v58
  v_accvgpr_write_b32 a203, v59
  v_mfma_f32_32x32x16_bf16 v[80:95], v[28:31], v[244:247], v[80:95]
  ds_read_b128 v[28:31], v11 offset:16384
  s_waitcnt lgkmcnt(3)
  v_mfma_f32_32x32x16_bf16 v[32:47], v[16:19], v[120:123], 0
  v_mfma_f32_32x32x16_bf16 v[48:63], v[16:19], v[184:187], 0
  ds_read_b128 v[16:19], v12 offset:16384
  s_waitcnt lgkmcnt(3)
  v_mfma_f32_32x32x16_bf16 v[32:47], v[20:23], v[124:127], v[32:47]
  v_mul_f32 v64, s52, v64
  v_mul_f32 v65, s52, v65
  v_cvt_pk_bf16_f32 v64, v64, v65
  v_mfma_f32_32x32x16_bf16 v[48:63], v[20:23], v[188:191], v[48:63]
  v_mul_f32 v66, s52, v66
  v_mul_f32 v67, s52, v67
  ds_read_b128 v[20:23], v13 offset:16384
  s_waitcnt lgkmcnt(3)
  v_mfma_f32_32x32x16_bf16 v[32:47], v[24:27], v[128:131], v[32:47]
  v_cvt_pk_bf16_f32 v65, v66, v67
  v_mul_f32 v68, s52, v68
  v_mul_f32 v69, s52, v69
  v_mfma_f32_32x32x16_bf16 v[48:63], v[24:27], v[192:195], v[48:63]
  v_cvt_pk_bf16_f32 v66, v68, v69
  v_mul_f32 v70, s52, v70
  ds_read_b128 v[24:27], v14 offset:16384
  s_waitcnt lgkmcnt(3)
  v_mfma_f32_32x32x16_bf16 v[32:47], v[28:31], v[132:135], v[32:47]
  v_mul_f32 v71, s52, v71
  v_cvt_pk_bf16_f32 v67, v70, v71
  v_mul_f32 v72, s52, v72
  v_mfma_f32_32x32x16_bf16 v[48:63], v[28:31], v[196:199], v[48:63]
  v_mul_f32 v73, s52, v73
  v_cvt_pk_bf16_f32 v72, v72, v73
  ds_read_b128 v[28:31], v15 offset:16384
  s_waitcnt lgkmcnt(3)
  v_mfma_f32_32x32x16_bf16 v[32:47], v[16:19], v[136:139], v[32:47]
  buffer_load_dwordx4 v[100:103], v113, s[8:11], s28 offen sc1
  v_mul_f32 v74, s52, v74
  v_mul_f32 v75, s52, v75
  v_cvt_pk_bf16_f32 v73, v74, v75
  v_mfma_f32_32x32x16_bf16 v[48:63], v[16:19], v[200:203], v[48:63]
  v_mul_f32 v76, s52, v76
  v_mul_f32 v77, s52, v77
  ds_read_b128 v[16:19], v8 offset:16640
  s_waitcnt lgkmcnt(3)
  v_mfma_f32_32x32x16_bf16 v[32:47], v[20:23], v[140:143], v[32:47]
  v_cvt_pk_bf16_f32 v74, v76, v77
  v_mul_f32 v78, s52, v78
  v_mul_f32 v79, s52, v79
  v_mfma_f32_32x32x16_bf16 v[48:63], v[20:23], v[204:207], v[48:63]
  v_cvt_pk_bf16_f32 v75, v78, v79
  v_permlane16_swap_b32 v64, v72
  ds_read_b128 v[20:23], v9 offset:16640
  s_waitcnt lgkmcnt(3)
  v_mfma_f32_32x32x16_bf16 v[32:47], v[24:27], v[144:147], v[32:47]
  v_permlane16_swap_b32 v65, v73
  v_permlane16_swap_b32 v66, v74
  v_permlane16_swap_b32 v67, v75
  v_mfma_f32_32x32x16_bf16 v[48:63], v[24:27], v[208:211], v[48:63]
  v_accvgpr_write_b32 a36, v64
  v_accvgpr_write_b32 a37, v65
  ds_read_b128 v[24:27], v10 offset:16640
  s_waitcnt lgkmcnt(3)
  v_mfma_f32_32x32x16_bf16 v[32:47], v[28:31], v[148:151], v[32:47]
  v_accvgpr_write_b32 a38, v66
  v_accvgpr_write_b32 a39, v67
  v_accvgpr_write_b32 a92, v72
  v_mfma_f32_32x32x16_bf16 v[48:63], v[28:31], v[212:215], v[48:63]
  v_accvgpr_write_b32 a93, v73
  v_accvgpr_write_b32 a94, v74
  ds_read_b128 v[28:31], v11 offset:16640
  s_waitcnt lgkmcnt(3)
  v_mfma_f32_32x32x16_bf16 v[32:47], v[16:19], v[152:155], v[32:47]
  v_accvgpr_write_b32 a95, v75
  v_mul_f32 v80, s52, v80
  v_mul_f32 v81, s52, v81
  v_mfma_f32_32x32x16_bf16 v[48:63], v[16:19], v[216:219], v[48:63]
  v_cvt_pk_bf16_f32 v80, v80, v81
  v_mul_f32 v82, s52, v82
  ds_read_b128 v[16:19], v12 offset:16640
  s_waitcnt lgkmcnt(3)
  v_mfma_f32_32x32x16_bf16 v[32:47], v[20:23], v[156:159], v[32:47]
  v_mul_f32 v83, s52, v83
  v_cvt_pk_bf16_f32 v81, v82, v83
  v_mul_f32 v84, s52, v84
  v_mfma_f32_32x32x16_bf16 v[48:63], v[20:23], v[220:223], v[48:63]
  v_mul_f32 v85, s52, v85
  v_cvt_pk_bf16_f32 v82, v84, v85
  ds_read_b128 v[20:23], v13 offset:16640
  s_waitcnt lgkmcnt(3)
  v_mfma_f32_32x32x16_bf16 v[32:47], v[24:27], v[160:163], v[32:47]
  v_mul_f32 v86, s52, v86
  v_mul_f32 v87, s52, v87
  v_cvt_pk_bf16_f32 v83, v86, v87
  v_mfma_f32_32x32x16_bf16 v[48:63], v[24:27], v[224:227], v[48:63]
  v_mul_f32 v88, s52, v88
  v_mul_f32 v89, s52, v89
  ds_read_b128 v[24:27], v14 offset:16640
  s_waitcnt lgkmcnt(3)
  v_mfma_f32_32x32x16_bf16 v[32:47], v[28:31], v[164:167], v[32:47]
  v_cvt_pk_bf16_f32 v88, v88, v89
  v_mul_f32 v90, s52, v90
  v_mul_f32 v91, s52, v91
  v_mfma_f32_32x32x16_bf16 v[48:63], v[28:31], v[228:231], v[48:63]
  v_cvt_pk_bf16_f32 v89, v90, v91
  v_mul_f32 v92, s52, v92
  ds_read_b128 v[28:31], v15 offset:16640
  s_waitcnt lgkmcnt(3)
  v_mfma_f32_32x32x16_bf16 v[32:47], v[16:19], v[168:171], v[32:47]
  v_mul_f32 v93, s52, v93
  v_cvt_pk_bf16_f32 v90, v92, v93
  v_mul_f32 v94, s52, v94
  v_mfma_f32_32x32x16_bf16 v[48:63], v[16:19], v[232:235], v[48:63]
  v_mul_f32 v95, s52, v95
  v_cvt_pk_bf16_f32 v91, v94, v95
  ds_read_b128 v[16:19], v8 offset:32768
  s_waitcnt lgkmcnt(3)
  v_mfma_f32_32x32x16_bf16 v[32:47], v[20:23], v[172:175], v[32:47]
  v_permlane16_swap_b32 v80, v88
  v_permlane16_swap_b32 v81, v89
  v_permlane16_swap_b32 v82, v90
  v_mfma_f32_32x32x16_bf16 v[48:63], v[20:23], v[236:239], v[48:63]
  v_permlane16_swap_b32 v83, v91
  v_accvgpr_write_b32 a148, v80
  ds_read_b128 v[20:23], v9 offset:32768
  s_waitcnt lgkmcnt(3)
  v_mfma_f32_32x32x16_bf16 v[32:47], v[24:27], v[176:179], v[32:47]
  v_accvgpr_write_b32 a149, v81
  v_accvgpr_write_b32 a150, v82
  v_accvgpr_write_b32 a151, v83
  v_mfma_f32_32x32x16_bf16 v[48:63], v[24:27], v[240:243], v[48:63]
  v_accvgpr_write_b32 a204, v88
  v_accvgpr_write_b32 a205, v89
  ds_read_b128 v[24:27], v10 offset:32768
  s_waitcnt lgkmcnt(3)
  v_mfma_f32_32x32x16_bf16 v[32:47], v[28:31], v[180:183], v[32:47]
  v_accvgpr_write_b32 a206, v90
  v_accvgpr_write_b32 a207, v91
  v_mfma_f32_32x32x16_bf16 v[48:63], v[28:31], v[244:247], v[48:63]
  s_waitcnt vmcnt(1)
  s_barrier
  ds_read_b128 v[28:31], v11 offset:32768
  s_waitcnt lgkmcnt(3)
  v_mfma_f32_32x32x16_bf16 v[64:79], v[16:19], v[120:123], 0
  s_waitcnt vmcnt(0)
  v_cmp_ne_u64 vcc, s[88:89], v[100:101]
  v_cmp_ne_u64 s[54:55], s[88:89], v[102:103]
  s_add_u32 s48, s33, 14336
  v_mfma_f32_32x32x16_bf16 v[80:95], v[16:19], v[184:187], 0
  ds_read_b128 v[16:19], v12 offset:32768
  s_waitcnt lgkmcnt(3)
  v_mfma_f32_32x32x16_bf16 v[64:79], v[20:23], v[124:127], v[64:79]
  s_or_b64 vcc, vcc, s[54:55]
  s_cselect_b32 s48, 0x10000000, s48
  s_add_u32 s22, s48, 0
  s_add_u32 m0, s25, 0
  s_nop 0
  buffer_load_dwordx4 v2, s[8:11], s22 offen sc1 lds
  v_mul_f32 v32, s52, v32
  v_mul_f32 v33, s52, v33
  v_cvt_pk_bf16_f32 v32, v32, v33
  v_mfma_f32_32x32x16_bf16 v[80:95], v[20:23], v[188:191], v[80:95]
  v_mul_f32 v34, s52, v34
  v_mul_f32 v35, s52, v35
  ds_read_b128 v[20:23], v13 offset:32768
  s_waitcnt lgkmcnt(3)
  v_mfma_f32_32x32x16_bf16 v[64:79], v[24:27], v[128:131], v[64:79]
  s_add_u32 s22, s48, 1024
  s_add_u32 m0, s25, 1024
  s_nop 0
  buffer_load_dwordx4 v2, s[8:11], s22 offen sc1 lds
  v_cvt_pk_bf16_f32 v33, v34, v35
  v_mul_f32 v36, s52, v36
  v_mul_f32 v37, s52, v37
  v_mfma_f32_32x32x16_bf16 v[80:95], v[24:27], v[192:195], v[80:95]
  v_cvt_pk_bf16_f32 v34, v36, v37
  v_mul_f32 v38, s52, v38
  ds_read_b128 v[24:27], v14 offset:32768
  s_waitcnt lgkmcnt(3)
  v_mfma_f32_32x32x16_bf16 v[64:79], v[28:31], v[132:135], v[64:79]
  s_add_u32 s22, s48, 2048
  s_add_u32 m0, s25, 2048
  s_nop 0
  buffer_load_dwordx4 v2, s[8:11], s22 offen sc1 lds
  v_mul_f32 v39, s52, v39
  v_cvt_pk_bf16_f32 v35, v38, v39
  v_mul_f32 v40, s52, v40
  v_mfma_f32_32x32x16_bf16 v[80:95], v[28:31], v[196:199], v[80:95]
  v_mul_f32 v41, s52, v41
  v_cvt_pk_bf16_f32 v40, v40, v41
  ds_read_b128 v[28:31], v15 offset:32768
  s_waitcnt lgkmcnt(3)
  v_mfma_f32_32x32x16_bf16 v[64:79], v[16:19], v[136:139], v[64:79]
  s_add_u32 s22, s48, 3072
  s_add_u32 m0, s25, 3072
  s_nop 0
  buffer_load_dwordx4 v2, s[8:11], s22 offen sc1 lds
  v_mul_f32 v42, s52, v42
  v_mul_f32 v43, s52, v43
  v_cvt_pk_bf16_f32 v41, v42, v43
  v_mfma_f32_32x32x16_bf16 v[80:95], v[16:19], v[200:203], v[80:95]
  v_mul_f32 v44, s52, v44
  v_mul_f32 v45, s52, v45
  ds_read_b128 v[16:19], v8 offset:33024
  s_waitcnt lgkmcnt(3)
  v_mfma_f32_32x32x16_bf16 v[64:79], v[20:23], v[140:143], v[64:79]
  s_add_u32 s22, s48, 4096
  s_add_u32 m0, s25, 16384
  s_nop 0
  buffer_load_dwordx4 v2, s[8:11], s22 offen sc1 lds
  buffer_load_dwordx4 v[100:103], v113, s[8:11], s28 offen sc1
  v_cvt_pk_bf16_f32 v42, v44, v45
  v_mul_f32 v46, s52, v46
  v_mul_f32 v47, s52, v47
  v_mfma_f32_32x32x16_bf16 v[80:95], v[20:23], v[204:207], v[80:95]
  v_cvt_pk_bf16_f32 v43, v46, v47
  v_permlane16_swap_b32 v32, v40
  ds_read_b128 v[20:23], v9 offset:33024
  s_waitcnt lgkmcnt(3)
  v_mfma_f32_32x32x16_bf16 v[64:79], v[24:27], v[144:147], v[64:79]
  s_add_u32 s22, s48, 5120
  s_add_u32 m0, s25, 17408
  s_nop 0
  buffer_load_dwordx4 v2, s[8:11], s22 offen sc1 lds
  v_permlane16_swap_b32 v33, v41
  v_permlane16_swap_b32 v34, v42
  v_permlane16_swap_b32 v35, v43
  v_mfma_f32_32x32x16_bf16 v[80:95], v[24:27], v[208:211], v[80:95]
  v_accvgpr_write_b32 a40, v32
  v_accvgpr_write_b32 a41, v33
  ds_read_b128 v[24:27], v10 offset:33024
  s_waitcnt lgkmcnt(3)
  v_mfma_f32_32x32x16_bf16 v[64:79], v[28:31], v[148:151], v[64:79]
  s_add_u32 s22, s48, 6144
  s_add_u32 m0, s25, 18432
  s_nop 0
  buffer_load_dwordx4 v2, s[8:11], s22 offen sc1 lds
  v_accvgpr_write_b32 a42, v34
  v_accvgpr_write_b32 a43, v35
  v_accvgpr_write_b32 a96, v40
  v_mfma_f32_32x32x16_bf16 v[80:95], v[28:31], v[212:215], v[80:95]
  v_accvgpr_write_b32 a97, v41
  v_accvgpr_write_b32 a98, v42
  ds_read_b128 v[28:31], v11 offset:33024
  s_waitcnt lgkmcnt(3)
  v_mfma_f32_32x32x16_bf16 v[64:79], v[16:19], v[152:155], v[64:79]
  s_add_u32 s22, s48, 7168
  s_add_u32 m0, s25, 19456
  s_nop 0
  buffer_load_dwordx4 v2, s[8:11], s22 offen sc1 lds
  v_accvgpr_write_b32 a99, v43
  v_mul_f32 v48, s52, v48
  v_mul_f32 v49, s52, v49
  v_mfma_f32_32x32x16_bf16 v[80:95], v[16:19], v[216:219], v[80:95]
  v_cvt_pk_bf16_f32 v48, v48, v49
  v_mul_f32 v50, s52, v50
  ds_read_b128 v[16:19], v12 offset:33024
  s_waitcnt lgkmcnt(3)
  v_mfma_f32_32x32x16_bf16 v[64:79], v[20:23], v[156:159], v[64:79]
  s_add_u32 s22, s48, 8192
  s_add_u32 m0, s25, 81920
  s_nop 0
  buffer_load_dwordx4 v2, s[8:11], s22 offen sc1 lds
  v_mul_f32 v51, s52, v51
  v_cvt_pk_bf16_f32 v49, v50, v51
  v_mul_f32 v52, s52, v52
  v_mfma_f32_32x32x16_bf16 v[80:95], v[20:23], v[220:223], v[80:95]
  v_mul_f32 v53, s52, v53
  v_cvt_pk_bf16_f32 v50, v52, v53
  ds_read_b128 v[20:23], v13 offset:33024
  s_waitcnt lgkmcnt(3)
  v_mfma_f32_32x32x16_bf16 v[64:79], v[24:27], v[160:163], v[64:79]
  s_add_u32 s22, s48, 9216
  s_add_u32 m0, s25, 82944
  s_nop 0
  buffer_load_dwordx4 v2, s[8:11], s22 offen sc1 lds
  v_mul_f32 v54, s52, v54
  v_mul_f32 v55, s52, v55
  v_cvt_pk_bf16_f32 v51, v54, v55
  v_mfma_f32_32x32x16_bf16 v[80:95], v[24:27], v[224:227], v[80:95]
  v_mul_f32 v56, s52, v56
  v_mul_f32 v57, s52, v57
  ds_read_b128 v[24:27], v14 offset:33024
  s_waitcnt lgkmcnt(3)
  v_mfma_f32_32x32x16_bf16 v[64:79], v[28:31], v[164:167], v[64:79]
  s_add_u32 s22, s48, 10240
  s_add_u32 m0, s25, 83968
  s_nop 0
  buffer_load_dwordx4 v2, s[8:11], s22 offen sc1 lds
  v_cvt_pk_bf16_f32 v56, v56, v57
  v_mul_f32 v58, s52, v58
  v_mul_f32 v59, s52, v59
  v_mfma_f32_32x32x16_bf16 v[80:95], v[28:31], v[228:231], v[80:95]
  v_cvt_pk_bf16_f32 v57, v58, v59
  v_mul_f32 v60, s52, v60
  ds_read_b128 v[28:31], v15 offset:33024
  s_waitcnt lgkmcnt(3)
  v_mfma_f32_32x32x16_bf16 v[64:79], v[16:19], v[168:171], v[64:79]
  s_add_u32 s22, s48, 11264
  s_add_u32 m0, s25, 84992
  s_nop 0
  buffer_load_dwordx4 v2, s[8:11], s22 offen sc1 lds
  v_mul_f32 v61, s52, v61
  v_cvt_pk_bf16_f32 v58, v60, v61
  v_mul_f32 v62, s52, v62
  v_mfma_f32_32x32x16_bf16 v[80:95], v[16:19], v[232:235], v[80:95]
  v_mul_f32 v63, s52, v63
  v_cvt_pk_bf16_f32 v59, v62, v63
  ds_read_b128 v[16:19], v8 offset:49152
  s_waitcnt lgkmcnt(3)
  v_mfma_f32_32x32x16_bf16 v[64:79], v[20:23], v[172:175], v[64:79]
  s_add_u32 s22, s48, 12288
  s_add_u32 m0, s25, 98304
  s_nop 0
  buffer_load_dwordx4 v2, s[8:11], s22 offen sc1 lds
  v_permlane16_swap_b32 v48, v56
  v_permlane16_swap_b32 v49, v57
  v_permlane16_swap_b32 v50, v58
  v_mfma_f32_32x32x16_bf16 v[80:95], v[20:23], v[236:239], v[80:95]
  v_permlane16_swap_b32 v51, v59
  v_accvgpr_write_b32 a152, v48
  ds_read_b128 v[20:23], v9 offset:49152
  s_waitcnt lgkmcnt(3)
  v_mfma_f32_32x32x16_bf16 v[64:79], v[24:27], v[176:179], v[64:79]
  s_add_u32 s22, s48, 13312
  s_add_u32 m0, s25, 99328
  s_nop 0
  buffer_load_dwordx4 v2, s[8:11], s22 offen sc1 lds
  v_accvgpr_write_b32 a153, v49
  v_accvgpr_write_b32 a154, v50
  v_accvgpr_write_b32 a155, v51
  v_mfma_f32_32x32x16_bf16 v[80:95], v[24:27], v[240:243], v[80:95]
  v_accvgpr_write_b32 a208, v56
  v_accvgpr_write_b32 a209, v57
  ds_read_b128 v[24:27], v10 offset:49152
  s_waitcnt lgkmcnt(3)
  v_mfma_f32_32x32x16_bf16 v[64:79], v[28:31], v[180:183], v[64:79]
  v_accvgpr_write_b32 a210, v58
  v_accvgpr_write_b32 a211, v59
  v_mfma_f32_32x32x16_bf16 v[80:95], v[28:31], v[244:247], v[80:95]
  ds_read_b128 v[28:31], v11 offset:49152
  s_waitcnt lgkmcnt(3)
  v_mfma_f32_32x32x16_bf16 v[32:47], v[16:19], v[120:123], 0
  s_waitcnt vmcnt(9)
  v_cmp_ne_u64 vcc, s[88:89], v[100:101]
  v_cmp_ne_u64 s[54:55], s[88:89], v[102:103]
  s_add_u32 s49, s32, 0
  v_mfma_f32_32x32x16_bf16 v[48:63], v[16:19], v[184:187], 0
  ds_read_b128 v[16:19], v12 offset:49152
  s_waitcnt lgkmcnt(3)
  v_mfma_f32_32x32x16_bf16 v[32:47], v[20:23], v[124:127], v[32:47]
  s_or_b64 vcc, vcc, s[54:55]
  s_cselect_b32 s49, 0x10000000, s49
  s_add_u32 s22, s49, 0
  s_add_u32 m0, s25, 100352
  s_nop 0
  buffer_load_dwordx4 v2, s[8:11], s22 offen sc1 lds
  v_mul_f32 v64, s52, v64
  v_mul_f32 v65, s52, v65
  v_cvt_pk_bf16_f32 v64, v64, v65
  v_mfma_f32_32x32x16_bf16 v[48:63], v[20:23], v[188:191], v[48:63]
  v_mul_f32 v66, s52, v66
  v_mul_f32 v67, s52, v67
  ds_read_b128 v[20:23], v13 offset:49152
  s_waitcnt lgkmcnt(3)
  v_mfma_f32_32x32x16_bf16 v[32:47], v[24:27], v[128:131], v[32:47]
  s_add_u32 s22, s49, 1024
  s_add_u32 m0, s25, 101376
  s_nop 0
  buffer_load_dwordx4 v2, s[8:11], s22 offen sc1 lds
  v_cvt_pk_bf16_f32 v65, v66, v67
  v_mul_f32 v68, s52, v68
  v_mul_f32 v69, s52, v69
  v_mfma_f32_32x32x16_bf16 v[48:63], v[24:27], v[192:195], v[48:63]
  v_cvt_pk_bf16_f32 v66, v68, v69
  v_mul_f32 v70, s52, v70
  ds_read_b128 v[24:27], v14 offset:49152
  s_waitcnt lgkmcnt(3)
  v_mfma_f32_32x32x16_bf16 v[32:47], v[28:31], v[132:135], v[32:47]
  s_add_u32 s22, s49, 2048
  s_add_u32 m0, s25, 114688
  s_nop 0
  buffer_load_dwordx4 v2, s[8:11], s22 offen sc1 lds
  v_mul_f32 v71, s52, v71
  v_cvt_pk_bf16_f32 v67, v70, v71
  v_mul_f32 v72, s52, v72
  v_mfma_f32_32x32x16_bf16 v[48:63], v[28:31], v[196:199], v[48:63]
  v_mul_f32 v73, s52, v73
  v_cvt_pk_bf16_f32 v72, v72, v73
  ds_read_b128 v[28:31], v15 offset:49152
  s_waitcnt lgkmcnt(3)
  v_mfma_f32_32x32x16_bf16 v[32:47], v[16:19], v[136:139], v[32:47]
  s_add_u32 s22, s49, 3072
  s_add_u32 m0, s25, 115712
  s_nop 0
  buffer_load_dwordx4 v2, s[8:11], s22 offen sc1 lds
  v_mul_f32 v74, s52, v74
  v_mul_f32 v75, s52, v75
  v_cvt_pk_bf16_f32 v73, v74, v75
  v_mfma_f32_32x32x16_bf16 v[48:63], v[16:19], v[200:203], v[48:63]
  v_mul_f32 v76, s52, v76
  v_mul_f32 v77, s52, v77
  ds_read_b128 v[16:19], v8 offset:49408
  s_waitcnt lgkmcnt(3)
  v_mfma_f32_32x32x16_bf16 v[32:47], v[20:23], v[140:143], v[32:47]
  s_add_u32 s22, s49, 4096
  s_add_u32 m0, s25, 116736
  s_nop 0
  buffer_load_dwordx4 v2, s[8:11], s22 offen sc1 lds
  buffer_load_dwordx4 v[100:103], v113, s[8:11], s28 offen sc1
  v_cvt_pk_bf16_f32 v74, v76, v77
  v_mul_f32 v78, s52, v78
  v_mul_f32 v79, s52, v79
  v_mfma_f32_32x32x16_bf16 v[48:63], v[20:23], v[204:207], v[48:63]
  v_cvt_pk_bf16_f32 v75, v78, v79
  v_permlane16_swap_b32 v64, v72
  ds_read_b128 v[20:23], v9 offset:49408
  s_waitcnt lgkmcnt(3)
  v_mfma_f32_32x32x16_bf16 v[32:47], v[24:27], v[144:147], v[32:47]
  s_add_u32 s22, s49, 5120
  s_add_u32 m0, s25, 117760
  s_nop 0
  buffer_load_dwordx4 v2, s[8:11], s22 offen sc1 lds
  v_permlane16_swap_b32 v65, v73
  v_permlane16_swap_b32 v66, v74
  v_permlane16_swap_b32 v67, v75
  v_mfma_f32_32x32x16_bf16 v[48:63], v[24:27], v[208:211], v[48:63]
  v_accvgpr_write_b32 a44, v64
  v_accvgpr_write_b32 a45, v65
  ds_read_b128 v[24:27], v10 offset:49408
  s_waitcnt lgkmcnt(3)
  v_mfma_f32_32x32x16_bf16 v[32:47], v[28:31], v[148:151], v[32:47]
  s_add_u32 s22, s49, 6144
  s_add_u32 m0, s25, 131072
  s_nop 0
  buffer_load_dwordx4 v2, s[8:11], s22 offen sc1 lds
  v_accvgpr_write_b32 a46, v66
  v_accvgpr_write_b32 a47, v67
  v_accvgpr_write_b32 a100, v72
  v_mfma_f32_32x32x16_bf16 v[48:63], v[28:31], v[212:215], v[48:63]
  v_accvgpr_write_b32 a101, v73
  v_accvgpr_write_b32 a102, v74
  ds_read_b128 v[28:31], v11 offset:49408
  s_waitcnt lgkmcnt(3)
  v_mfma_f32_32x32x16_bf16 v[32:47], v[16:19], v[152:155], v[32:47]
  s_add_u32 s22, s49, 7168
  s_add_u32 m0, s25, 132096
  s_nop 0
  buffer_load_dwordx4 v2, s[8:11], s22 offen sc1 lds
  v_accvgpr_write_b32 a103, v75
  v_mul_f32 v80, s52, v80
  v_mul_f32 v81, s52, v81
  v_mfma_f32_32x32x16_bf16 v[48:63], v[16:19], v[216:219], v[48:63]
  v_cvt_pk_bf16_f32 v80, v80, v81
  v_mul_f32 v82, s52, v82
  ds_read_b128 v[16:19], v12 offset:49408
  s_waitcnt lgkmcnt(3)
  v_mfma_f32_32x32x16_bf16 v[32:47], v[20:23], v[156:159], v[32:47]
  s_add_u32 s22, s49, 8192
  s_add_u32 m0, s25, 133120
  s_nop 0
  buffer_load_dwordx4 v2, s[8:11], s22 offen sc1 lds
  v_mul_f32 v83, s52, v83
  v_cvt_pk_bf16_f32 v81, v82, v83
  v_mul_f32 v84, s52, v84
  v_mfma_f32_32x32x16_bf16 v[48:63], v[20:23], v[220:223], v[48:63]
  v_mul_f32 v85, s52, v85
  v_cvt_pk_bf16_f32 v82, v84, v85
  ds_read_b128 v[20:23], v13 offset:49408
  s_waitcnt lgkmcnt(3)
  v_mfma_f32_32x32x16_bf16 v[32:47], v[24:27], v[160:163], v[32:47]
  s_add_u32 s22, s49, 9216
  s_add_u32 m0, s25, 134144
  s_nop 0
  buffer_load_dwordx4 v2, s[8:11], s22 offen sc1 lds
  v_mul_f32 v86, s52, v86
  v_mul_f32 v87, s52, v87
  v_cvt_pk_bf16_f32 v83, v86, v87
  v_mfma_f32_32x32x16_bf16 v[48:63], v[24:27], v[224:227], v[48:63]
  v_mul_f32 v88, s52, v88
  v_mul_f32 v89, s52, v89
  ds_read_b128 v[24:27], v14 offset:49408
  s_waitcnt lgkmcnt(3)
  v_mfma_f32_32x32x16_bf16 v[32:47], v[28:31], v[164:167], v[32:47]
  s_add_u32 s22, s49, 10240
  s_add_u32 m0, s25, 147456
  s_nop 0
  buffer_load_dwordx4 v2, s[8:11], s22 offen sc1 lds
  v_cvt_pk_bf16_f32 v88, v88, v89
  v_mul_f32 v90, s52, v90
  v_mul_f32 v91, s52, v91
  v_mfma_f32_32x32x16_bf16 v[48:63], v[28:31], v[228:231], v[48:63]
  v_cvt_pk_bf16_f32 v89, v90, v91
  v_mul_f32 v92, s52, v92
  ds_read_b128 v[28:31], v15 offset:49408
  s_waitcnt lgkmcnt(3)
  v_mfma_f32_32x32x16_bf16 v[32:47], v[16:19], v[168:171], v[32:47]
  s_add_u32 s22, s49, 11264
  s_add_u32 m0, s25, 148480
  s_nop 0
  buffer_load_dwordx4 v2, s[8:11], s22 offen sc1 lds
  v_mul_f32 v93, s52, v93
  v_cvt_pk_bf16_f32 v90, v92, v93
  v_mul_f32 v94, s52, v94
  v_mfma_f32_32x32x16_bf16 v[48:63], v[16:19], v[232:235], v[48:63]
  v_mul_f32 v95, s52, v95
  v_cvt_pk_bf16_f32 v91, v94, v95
  v_xor_b32 v8, 65536, v8
  ds_read_b128 v[16:19], v8 offset:0
  s_waitcnt lgkmcnt(3)
  v_mfma_f32_32x32x16_bf16 v[32:47], v[20:23], v[172:175], v[32:47]
  s_add_u32 s22, s49, 12288
  s_add_u32 m0, s25, 149504
  s_nop 0
  buffer_load_dwordx4 v2, s[8:11], s22 offen sc1 lds
  v_permlane16_swap_b32 v80, v88
  v_permlane16_swap_b32 v81, v89
  v_permlane16_swap_b32 v82, v90
  v_mfma_f32_32x32x16_bf16 v[48:63], v[20:23], v[236:239], v[48:63]
  v_permlane16_swap_b32 v83, v91
  v_accvgpr_write_b32 a156, v80
  v_xor_b32 v9, 65536, v9
  ds_read_b128 v[20:23], v9 offset:0
  s_waitcnt lgkmcnt(3)
  v_mfma_f32_32x32x16_bf16 v[32:47], v[24:27], v[176:179], v[32:47]
  s_add_u32 s22, s49, 13312
  s_add_u32 m0, s25, 150528
  s_nop 0
  buffer_load_dwordx4 v2, s[8:11], s22 offen sc1 lds
  v_accvgpr_write_b32 a157, v81
  v_accvgpr_write_b32 a158, v82
  v_accvgpr_write_b32 a159, v83
  v_mfma_f32_32x32x16_bf16 v[48:63], v[24:27], v[240:243], v[48:63]
  v_accvgpr_write_b32 a212, v88
  v_accvgpr_write_b32 a213, v89
  v_xor_b32 v10, 65536, v10
  ds_read_b128 v[24:27], v10 offset:0
  s_waitcnt lgkmcnt(3)
  v_mfma_f32_32x32x16_bf16 v[32:47], v[28:31], v[180:183], v[32:47]
  v_accvgpr_write_b32 a214, v90
  v_accvgpr_write_b32 a215, v91
  v_mfma_f32_32x32x16_bf16 v[48:63], v[28:31], v[244:247], v[48:63]
  s_barrier
  v_xor_b32 v11, 65536, v11
  ds_read_b128 v[28:31], v11 offset:0
  s_waitcnt lgkmcnt(3)
  v_mfma_f32_32x32x16_bf16 v[64:79], v[16:19], v[120:123], 0
  s_waitcnt vmcnt(9)
  v_cmp_ne_u64 vcc, s[88:89], v[100:101]
  v_cmp_ne_u64 s[54:55], s[88:89], v[102:103]
  s_add_u32 s50, s33, 0
  v_mfma_f32_32x32x16_bf16 v[80:95], v[16:19], v[184:187], 0
  v_xor_b32 v12, 65536, v12
  ds_read_b128 v[16:19], v12 offset:0
  s_waitcnt lgkmcnt(3)
  v_mfma_f32_32x32x16_bf16 v[64:79], v[20:23], v[124:127], v[64:79]
  s_or_b64 vcc, vcc, s[54:55]
  s_cselect_b32 s50, 0x10000000, s50
  s_add_u32 s22, s50, 0
  buffer_load_dwordx4 a[224:227], v2, s[8:11], s22 offen sc1
  v_mul_f32 v32, s52, v32
  v_mul_f32 v33, s52, v33
  v_cvt_pk_bf16_f32 v32, v32, v33
  v_mfma_f32_32x32x16_bf16 v[80:95], v[20:23], v[188:191], v[80:95]
  v_mul_f32 v34, s52, v34
  v_mul_f32 v35, s52, v35
  v_xor_b32 v13, 65536, v13
  ds_read_b128 v[20:23], v13 offset:0
  s_waitcnt lgkmcnt(3)
  v_mfma_f32_32x32x16_bf16 v[64:79], v[24:27], v[128:131], v[64:79]
  s_add_u32 s22, s50, 1024
  buffer_load_dwordx4 a[228:231], v2, s[8:11], s22 offen sc1
  v_cvt_pk_bf16_f32 v33, v34, v35
  v_mul_f32 v36, s52, v36
  v_mul_f32 v37, s52, v37
  v_mfma_f32_32x32x16_bf16 v[80:95], v[24:27], v[192:195], v[80:95]
  v_cvt_pk_bf16_f32 v34, v36, v37
  v_mul_f32 v38, s52, v38
  v_xor_b32 v14, 65536, v14
  ds_read_b128 v[24:27], v14 offset:0
  s_waitcnt lgkmcnt(3)
  v_mfma_f32_32x32x16_bf16 v[64:79], v[28:31], v[132:135], v[64:79]
  s_add_u32 s22, s50, 2048
  buffer_load_dwordx4 a[232:235], v2, s[8:11], s22 offen sc1
  v_mul_f32 v39, s52, v39
  v_cvt_pk_bf16_f32 v35, v38, v39
  v_mul_f32 v40, s52, v40
  v_mfma_f32_32x32x16_bf16 v[80:95], v[28:31], v[196:199], v[80:95]
  v_mul_f32 v41, s52, v41
  v_cvt_pk_bf16_f32 v40, v40, v41
  v_xor_b32 v15, 65536, v15
  ds_read_b128 v[28:31], v15 offset:0
  s_waitcnt lgkmcnt(3)
  v_mfma_f32_32x32x16_bf16 v[64:79], v[16:19], v[136:139], v[64:79]
  s_add_u32 s22, s50, 3072
  buffer_load_dwordx4 a[236:239], v2, s[8:11], s22 offen sc1
  v_mul_f32 v42, s52, v42
  v_mul_f32 v43, s52, v43
  v_cvt_pk_bf16_f32 v41, v42, v43
  v_mfma_f32_32x32x16_bf16 v[80:95], v[16:19], v[200:203], v[80:95]
  v_mul_f32 v44, s52, v44
  v_mul_f32 v45, s52, v45
  ds_read_b128 v[16:19], v8 offset:256
  s_waitcnt lgkmcnt(3)
  v_mfma_f32_32x32x16_bf16 v[64:79], v[20:23], v[140:143], v[64:79]
  s_add_u32 s22, s50, 4096
  buffer_load_dwordx4 a[240:243], v2, s[8:11], s22 offen sc1
  v_cvt_pk_bf16_f32 v42, v44, v45
  v_mul_f32 v46, s52, v46
  v_mul_f32 v47, s52, v47
  v_mfma_f32_32x32x16_bf16 v[80:95], v[20:23], v[204:207], v[80:95]
  v_cvt_pk_bf16_f32 v43, v46, v47
  v_permlane16_swap_b32 v32, v40
  ds_read_b128 v[20:23], v9 offset:256
  s_waitcnt lgkmcnt(3)
  v_mfma_f32_32x32x16_bf16 v[64:79], v[24:27], v[144:147], v[64:79]
  s_add_u32 s22, s50, 5120
  buffer_load_dwordx4 a[244:247], v2, s[8:11], s22 offen sc1
  v_permlane16_swap_b32 v33, v41
  v_permlane16_swap_b32 v34, v42
  v_permlane16_swap_b32 v35, v43
  v_mfma_f32_32x32x16_bf16 v[80:95], v[24:27], v[208:211], v[80:95]
  v_accvgpr_write_b32 a48, v32
  v_accvgpr_write_b32 a49, v33
  ds_read_b128 v[24:27], v10 offset:256
  s_waitcnt lgkmcnt(3)
  v_mfma_f32_32x32x16_bf16 v[64:79], v[28:31], v[148:151], v[64:79]
  s_add_u32 s22, s50, 6144
  buffer_load_dwordx4 a[248:251], v2, s[8:11], s22 offen sc1
  v_accvgpr_write_b32 a50, v34
  v_accvgpr_write_b32 a51, v35
  v_accvgpr_write_b32 a104, v40
  v_mfma_f32_32x32x16_bf16 v[80:95], v[28:31], v[212:215], v[80:95]
  v_accvgpr_write_b32 a105, v41
  v_accvgpr_write_b32 a106, v42
  ds_read_b128 v[28:31], v11 offset:256
  s_waitcnt lgkmcnt(3)
  v_mfma_f32_32x32x16_bf16 v[64:79], v[16:19], v[152:155], v[64:79]
  s_add_u32 s22, s50, 7168
  buffer_load_dwordx4 a[252:255], v2, s[8:11], s22 offen sc1
  v_accvgpr_write_b32 a107, v43
  v_mul_f32 v48, s52, v48
  v_mul_f32 v49, s52, v49
  v_mfma_f32_32x32x16_bf16 v[80:95], v[16:19], v[216:219], v[80:95]
  v_cvt_pk_bf16_f32 v48, v48, v49
  v_mul_f32 v50, s52, v50
  ds_read_b128 v[16:19], v12 offset:256
  s_waitcnt lgkmcnt(3)
  v_mfma_f32_32x32x16_bf16 v[64:79], v[20:23], v[156:159], v[64:79]
  s_add_u32 s22, s50, 8192
  s_add_u32 m0, s25, 32768
  s_nop 0
  buffer_load_dwordx4 v2, s[8:11], s22 offen sc1 lds
  v_mul_f32 v51, s52, v51
  v_cvt_pk_bf16_f32 v49, v50, v51
  v_mul_f32 v52, s52, v52
  v_mfma_f32_32x32x16_bf16 v[80:95], v[20:23], v[220:223], v[80:95]
  v_mul_f32 v53, s52, v53
  v_cvt_pk_bf16_f32 v50, v52, v53
  ds_read_b128 v[20:23], v13 offset:256
  s_waitcnt lgkmcnt(3)
  v_mfma_f32_32x32x16_bf16 v[64:79], v[24:27], v[160:163], v[64:79]
  s_add_u32 s22, s50, 9216
  s_add_u32 m0, s25, 33792
  s_nop 0
  buffer_load_dwordx4 v2, s[8:11], s22 offen sc1 lds
  v_mul_f32 v54, s52, v54
  v_mul_f32 v55, s52, v55
  v_cvt_pk_bf16_f32 v51, v54, v55
  v_mfma_f32_32x32x16_bf16 v[80:95], v[24:27], v[224:227], v[80:95]
  v_mul_f32 v56, s52, v56
  v_mul_f32 v57, s52, v57
  ds_read_b128 v[24:27], v14 offset:256
  s_waitcnt lgkmcnt(3)
  v_mfma_f32_32x32x16_bf16 v[64:79], v[28:31], v[164:167], v[64:79]
  s_add_u32 s22, s50, 10240
  s_add_u32 m0, s25, 34816
  s_nop 0
  buffer_load_dwordx4 v2, s[8:11], s22 offen sc1 lds
  v_cvt_pk_bf16_f32 v56, v56, v57
  v_mul_f32 v58, s52, v58
  v_mul_f32 v59, s52, v59
  v_mfma_f32_32x32x16_bf16 v[80:95], v[28:31], v[228:231], v[80:95]
  v_cvt_pk_bf16_f32 v57, v58, v59
  v_mul_f32 v60, s52, v60
  ds_read_b128 v[28:31], v15 offset:256
  s_waitcnt lgkmcnt(3)
  v_mfma_f32_32x32x16_bf16 v[64:79], v[16:19], v[168:171], v[64:79]
  s_add_u32 s22, s50, 11264
  s_add_u32 m0, s25, 35840
  s_nop 0
  buffer_load_dwordx4 v2, s[8:11], s22 offen sc1 lds
  v_mul_f32 v61, s52, v61
  v_cvt_pk_bf16_f32 v58, v60, v61
  v_mul_f32 v62, s52, v62
  v_mfma_f32_32x32x16_bf16 v[80:95], v[16:19], v[232:235], v[80:95]
  v_mul_f32 v63, s52, v63
  v_cvt_pk_bf16_f32 v59, v62, v63
  s_waitcnt lgkmcnt(2)
  v_mfma_f32_32x32x16_bf16 v[64:79], v[20:23], v[172:175], v[64:79]
  s_add_u32 s22, s50, 12288
  s_add_u32 m0, s25, 49152
  s_nop 0
  buffer_load_dwordx4 v2, s[8:11], s22 offen sc1 lds
  v_permlane16_swap_b32 v48, v56
  v_permlane16_swap_b32 v49, v57
  v_permlane16_swap_b32 v50, v58
  v_mfma_f32_32x32x16_bf16 v[80:95], v[20:23], v[236:239], v[80:95]
  v_permlane16_swap_b32 v51, v59
  v_accvgpr_write_b32 a160, v48
  s_waitcnt lgkmcnt(1)
  v_mfma_f32_32x32x16_bf16 v[64:79], v[24:27], v[176:179], v[64:79]
  s_add_u32 s22, s50, 13312
  s_add_u32 m0, s25, 50176
  s_nop 0
  buffer_load_dwordx4 v2, s[8:11], s22 offen sc1 lds
  v_accvgpr_write_b32 a161, v49
  v_accvgpr_write_b32 a162, v50
  v_accvgpr_write_b32 a163, v51
  v_mfma_f32_32x32x16_bf16 v[80:95], v[24:27], v[240:243], v[80:95]
  v_accvgpr_write_b32 a216, v56
  v_accvgpr_write_b32 a217, v57
  s_waitcnt lgkmcnt(0)
  v_mfma_f32_32x32x16_bf16 v[64:79], v[28:31], v[180:183], v[64:79]
  buffer_load_dwordx4 v[100:103], v113, s[8:11], s28 offen sc1
  buffer_load_dwordx4 v[104:107], v2, s[8:11], s29 offen sc1
  buffer_load_dwordx4 v[108:111], v112, s[8:11], s29 offen sc1
  v_accvgpr_write_b32 a218, v58
  v_accvgpr_write_b32 a219, v59
  v_mfma_f32_32x32x16_bf16 v[80:95], v[28:31], v[244:247], v[80:95]
  s_nop 4
  v_mul_f32 v64, s52, v64
  v_mul_f32 v65, s52, v65
  v_cvt_pk_bf16_f32 v64, v64, v65
  v_mul_f32 v66, s52, v66
  v_mul_f32 v67, s52, v67
  v_cvt_pk_bf16_f32 v65, v66, v67
  v_mul_f32 v68, s52, v68
  v_mul_f32 v69, s52, v69
  v_cvt_pk_bf16_f32 v66, v68, v69
  v_mul_f32 v70, s52, v70
  v_mul_f32 v71, s52, v71
  v_cvt_pk_bf16_f32 v67, v70, v71
  v_mul_f32 v72, s52, v72
  v_mul_f32 v73, s52, v73
  v_cvt_pk_bf16_f32 v72, v72, v73
  v_mul_f32 v74, s52, v74
  v_mul_f32 v75, s52, v75
  v_cvt_pk_bf16_f32 v73, v74, v75
  v_mul_f32 v76, s52, v76
  v_mul_f32 v77, s52, v77
  v_cvt_pk_bf16_f32 v74, v76, v77
  v_mul_f32 v78, s52, v78
  v_mul_f32 v79, s52, v79
  v_cvt_pk_bf16_f32 v75, v78, v79
  v_permlane16_swap_b32 v64, v72
  v_permlane16_swap_b32 v65, v73
  v_permlane16_swap_b32 v66, v74
  v_permlane16_swap_b32 v67, v75
  v_accvgpr_write_b32 a52, v64
  v_accvgpr_write_b32 a53, v65
  v_accvgpr_write_b32 a54, v66
  v_accvgpr_write_b32 a55, v67
  v_accvgpr_write_b32 a108, v72
  v_accvgpr_write_b32 a109, v73
  v_accvgpr_write_b32 a110, v74
  v_accvgpr_write_b32 a111, v75
  v_mul_f32 v80, s52, v80
  v_mul_f32 v81, s52, v81
  v_cvt_pk_bf16_f32 v80, v80, v81
  v_mul_f32 v82, s52, v82
  v_mul_f32 v83, s52, v83
  v_cvt_pk_bf16_f32 v81, v82, v83
  v_mul_f32 v84, s52, v84
  v_mul_f32 v85, s52, v85
  v_cvt_pk_bf16_f32 v82, v84, v85
  v_mul_f32 v86, s52, v86
  v_mul_f32 v87, s52, v87
  v_cvt_pk_bf16_f32 v83, v86, v87
  v_mul_f32 v88, s52, v88
  v_mul_f32 v89, s52, v89
  v_cvt_pk_bf16_f32 v88, v88, v89
  v_mul_f32 v90, s52, v90
  v_mul_f32 v91, s52, v91
  v_cvt_pk_bf16_f32 v89, v90, v91
  v_mul_f32 v92, s52, v92
  v_mul_f32 v93, s52, v93
  v_cvt_pk_bf16_f32 v90, v92, v93
  v_mul_f32 v94, s52, v94
  v_mul_f32 v95, s52, v95
  v_cvt_pk_bf16_f32 v91, v94, v95
  v_permlane16_swap_b32 v80, v88
  v_permlane16_swap_b32 v81, v89
  v_permlane16_swap_b32 v82, v90
  v_permlane16_swap_b32 v83, v91
  v_accvgpr_write_b32 a164, v80
  v_accvgpr_write_b32 a165, v81
  v_accvgpr_write_b32 a166, v82
  v_accvgpr_write_b32 a167, v83
  v_accvgpr_write_b32 a220, v88
  v_accvgpr_write_b32 a221, v89
  v_accvgpr_write_b32 a222, v90
  v_accvgpr_write_b32 a223, v91
  s_mov_b32 s30, 0
  s_branch sc_aw_w
sc_aw:
  buffer_load_dwordx4 v[100:103], v113, s[8:11], s28 offen sc1
  buffer_load_dwordx4 v[104:107], v2, s[8:11], s29 offen sc1
  buffer_load_dwordx4 v[108:111], v112, s[8:11], s29 offen sc1
sc_aw_w:
  s_waitcnt vmcnt(0)
  v_cmp_ne_u64 vcc, s[88:89], v[100:101]
  s_cbranch_vccnz sc_aw_no
  v_cmp_ne_u64 vcc, s[88:89], v[102:103]
  s_cbranch_vccnz sc_aw_no
  v_cmp_ne_u64 vcc, s[88:89], v[104:105]
  s_cbranch_vccnz sc_aw_no
  v_cmp_ne_u64 vcc, s[88:89], v[106:107]
  s_cbranch_vccnz sc_aw_no
  v_cmp_ne_u64 vcc, s[88:89], v[108:109]
  s_cbranch_vccnz sc_aw_no
  v_cmp_ne_u64 vcc, s[88:89], v[110:111]
  s_cbranch_vccnz sc_aw_no
  s_branch sc_aw_ok
sc_aw_no:
  s_sleep 1
  s_add_u32 s30, s30, 1
  s_cmp_lt_u32 s30, 50000
  s_cbranch_scc1 sc_aw
  s_branch cA_abort
sc_aw_ok:
  v_add_u32 v4, s25, v2
  v_add_u32 v5, 0x10000, v4
  v_add_u32 v6, 0x20000, v4
  s_cmp_eq_u32 s48, 0x10000000
  s_cbranch_scc1 sc_d0
  ds_read_b128 v[144:147], v4 offset:0
  ds_read_b128 v[148:151], v4 offset:1024
  ds_read_b128 v[152:155], v4 offset:2048
  ds_read_b128 v[156:159], v4 offset:3072
  ds_read_b128 v[160:163], v4 offset:16384
  ds_read_b128 v[164:167], v4 offset:17408
  ds_read_b128 v[168:171], v4 offset:18432
  ds_read_b128 v[172:175], v4 offset:19456
  ds_read_b128 v[176:179], v5 offset:16384
  ds_read_b128 v[180:183], v5 offset:17408
  ds_read_b128 v[184:187], v5 offset:18432
  ds_read_b128 v[188:191], v5 offset:19456
  ds_read_b128 v[192:195], v5 offset:32768
  ds_read_b128 v[196:199], v5 offset:33792
  s_waitcnt lgkmcnt(0)
  s_branch sc_e0
sc_d0:
  s_add_u32 s22, s33, 12288
  buffer_load_dwordx4 v[144:147], v2, s[8:11], s22 offen offset:2048 sc1
  buffer_load_dwordx4 v[148:151], v2, s[8:11], s22 offen offset:3072 sc1
  s_add_u32 s22, s33, 16384
  buffer_load_dwordx4 v[152:155], v2, s[8:11], s22 offen offset:0 sc1
  buffer_load_dwordx4 v[156:159], v2, s[8:11], s22 offen offset:1024 sc1
  buffer_load_dwordx4 v[160:163], v2, s[8:11], s22 offen offset:2048 sc1
  buffer_load_dwordx4 v[164:167], v2, s[8:11], s22 offen offset:3072 sc1
  s_add_u32 s22, s33, 20480
  buffer_load_dwordx4 v[168:171], v2, s[8:11], s22 offen offset:0 sc1
  buffer_load_dwordx4 v[172:175], v2, s[8:11], s22 offen offset:1024 sc1
  buffer_load_dwordx4 v[176:179], v2, s[8:11], s22 offen offset:2048 sc1
  buffer_load_dwordx4 v[180:183], v2, s[8:11], s22 offen offset:3072 sc1
  s_add_u32 s22, s33, 24576
  buffer_load_dwordx4 v[184:187], v2, s[8:11], s22 offen offset:0 sc1
  buffer_load_dwordx4 v[188:191], v2, s[8:11], s22 offen offset:1024 sc1
  buffer_load_dwordx4 v[192:195], v2, s[8:11], s22 offen offset:2048 sc1
  buffer_load_dwordx4 v[196:199], v2, s[8:11], s22 offen offset:3072 sc1
sc_e0:
  s_cmp_eq_u32 s49, 0x10000000
  s_cbranch_scc1 sc_d1
  ds_read_b128 v[200:203], v5 offset:34816
  ds_read_b128 v[204:207], v5 offset:35840
  ds_read_b128 v[208:211], v5 offset:49152
  ds_read_b128 v[212:215], v5 offset:50176
  ds_read_b128 v[216:219], v5 offset:51200
  ds_read_b128 v[220:223], v5 offset:52224
  ds_read_b128 v[224:227], v6 offset:0
  ds_read_b128 v[228:231], v6 offset:1024
  ds_read_b128 v[232:235], v6 offset:2048
  ds_read_b128 v[236:239], v6 offset:3072
  ds_read_b128 v[240:243], v6 offset:16384
  ds_read_b128 v[244:247], v6 offset:17408
  ds_read_b128 v[248:251], v6 offset:18432
  ds_read_b128 v[252:255], v6 offset:19456
  s_waitcnt lgkmcnt(0)
  s_branch sc_e1
sc_d1:
  s_add_u32 s22, s32, 0
  buffer_load_dwordx4 v[200:203], v2, s[8:11], s22 offen offset:0 sc1
  buffer_load_dwordx4 v[204:207], v2, s[8:11], s22 offen offset:1024 sc1
  buffer_load_dwordx4 v[208:211], v2, s[8:11], s22 offen offset:2048 sc1
  buffer_load_dwordx4 v[212:215], v2, s[8:11], s22 offen offset:3072 sc1
  s_add_u32 s22, s32, 4096
  buffer_load_dwordx4 v[216:219], v2, s[8:11], s22 offen offset:0 sc1
  buffer_load_dwordx4 v[220:223], v2, s[8:11], s22 offen offset:1024 sc1
  buffer_load_dwordx4 v[224:227], v2, s[8:11], s22 offen offset:2048 sc1
  buffer_load_dwordx4 v[228:231], v2, s[8:11], s22 offen offset:3072 sc1
  s_add_u32 s22, s32, 8192
  buffer_load_dwordx4 v[232:235], v2, s[8:11], s22 offen offset:0 sc1
  buffer_load_dwordx4 v[236:239], v2, s[8:11], s22 offen offset:1024 sc1
  buffer_load_dwordx4 v[240:243], v2, s[8:11], s22 offen offset:2048 sc1
  buffer_load_dwordx4 v[244:247], v2, s[8:11], s22 offen offset:3072 sc1
  s_add_u32 s22, s32, 12288
  buffer_load_dwordx4 v[248:251], v2, s[8:11], s22 offen offset:0 sc1
  buffer_load_dwordx4 v[252:255], v2, s[8:11], s22 offen offset:1024 sc1
sc_e1:
  s_cmp_eq_u32 s50, 0x10000000
  s_cbranch_scc1 sc_d2
  ds_read_b128 v[120:123], v4 offset:32768
  ds_read_b128 v[124:127], v4 offset:33792
  ds_read_b128 v[128:131], v4 offset:34816
  ds_read_b128 v[132:135], v4 offset:35840
  ds_read_b128 v[136:139], v4 offset:49152
  ds_read_b128 v[140:143], v4 offset:50176
  s_waitcnt lgkmcnt(0)
  s_branch sc_e2
sc_d2:
  s_add_u32 s22, s33, 0
  buffer_load_dwordx4 a[224:227], v2, s[8:11], s22 offen offset:0 sc1
  buffer_load_dwordx4 a[228:231], v2, s[8:11], s22 offen offset:1024 sc1
  buffer_load_dwordx4 a[232:235], v2, s[8:11], s22 offen offset:2048 sc1
  buffer_load_dwordx4 a[236:239], v2, s[8:11], s22 offen offset:3072 sc1
  s_add_u32 s22, s33, 4096
  buffer_load_dwordx4 a[240:243], v2, s[8:11], s22 offen offset:0 sc1
  buffer_load_dwordx4 a[244:247], v2, s[8:11], s22 offen offset:1024 sc1
  buffer_load_dwordx4 a[248:251], v2, s[8:11], s22 offen offset:2048 sc1
  buffer_load_dwordx4 a[252:255], v2, s[8:11], s22 offen offset:3072 sc1
  s_add_u32 s22, s33, 8192
  buffer_load_dwordx4 v[120:123], v2, s[8:11], s22 offen offset:0 sc1
  buffer_load_dwordx4 v[124:127], v2, s[8:11], s22 offen offset:1024 sc1
  buffer_load_dwordx4 v[128:131], v2, s[8:11], s22 offen offset:2048 sc1
  buffer_load_dwordx4 v[132:135], v2, s[8:11], s22 offen offset:3072 sc1
  s_add_u32 s22, s33, 12288
  buffer_load_dwordx4 v[136:139], v2, s[8:11], s22 offen offset:0 sc1
  buffer_load_dwordx4 v[140:143], v2, s[8:11], s22 offen offset:1024 sc1
sc_e2:
  s_barrier
  s_branch m_role
m_val:
  s_cmp_lg_u32 s16, 0
  s_cbranch_scc1 w0_6
  v_mov_b32 v233, 128
  v_mov_b32 v234, s88
  v_mov_b32 v235, s89
  v_mov_b32 v236, 0
  v_mov_b32 v237, 0
  s_mov_b64 exec, 1
  buffer_atomic_cmpswap_x2 v[234:237], v233, s[12:15], 0 offen sc0
  s_mov_b64 exec, -1
w0_6:
  s_cmp_lg_u32 s66, 0
  s_cbranch_scc1 va_ci
  s_cmp_lg_u32 s16, 0
  s_cbranch_scc1 w0_7
  s_lshr_b32 s70, s3, 5
  s_and_b32 s71, s70, 4
  s_mul_i32 s71, s71, 12
  s_lshl_b32 s70, s70, 2
  s_add_u32 s70, s70, s71
  s_lshl_b32 s71, 1, s3
  v_mov_b32 v242, s71
  v_mov_b32 v243, 32
  s_mov_b64 exec, 1
  buffer_atomic_or v242, v243, s[12:15], s70 offen sc0
  buffer_load_dwordx2 v[244:245], v243, s[12:15], 0 offen offset:96 sc1
  s_mov_b64 exec, -1
w0_7:
va_ci:
  s_mov_b32 s56, s40
  s_and_b32 s57, s41, 0xffff
  s_mov_b32 s58, 3670016
  s_mov_b32 s59, 0x20000
  v_lshrrev_b32 v24, 5, v1
  v_and_b32 v25, 31, v1
  v_lshlrev_b32 v25, 4, v25
  v_lshl_add_u32 v24, v24, 13, v25
  s_mov_b32 s60, s42
  s_and_b32 s61, s43, 0xffff
  s_mov_b32 s62, 3670016
  s_mov_b32 s63, 0x20000
  s_lshl_b32 s22, s17, 9
  s_lshl_b32 s23, s16, 19
  s_add_u32 s23, s22, s23
  s_add_u32 s21, s23, 262144
  buffer_load_dwordx4 v[28:31], v24, s[60:63], s21 offen
  s_add_u32 s21, s23, 278528
  buffer_load_dwordx4 v[28:31], v24, s[60:63], s21 offen
  s_add_u32 s21, s23, 294912
  buffer_load_dwordx4 v[28:31], v24, s[60:63], s21 offen
  s_add_u32 s21, s23, 311296
  buffer_load_dwordx4 v[28:31], v24, s[60:63], s21 offen
  s_add_u32 s21, s23, 327680
  buffer_load_dwordx4 v[28:31], v24, s[60:63], s21 offen
  s_add_u32 s21, s23, 344064
  buffer_load_dwordx4 v[28:31], v24, s[60:63], s21 offen
  s_add_u32 s21, s23, 360448
  buffer_load_dwordx4 v[28:31], v24, s[60:63], s21 offen
  s_add_u32 s21, s23, 376832
  buffer_load_dwordx4 v[28:31], v24, s[60:63], s21 offen
  s_add_u32 s21, s23, 393216
  buffer_load_dwordx4 v[28:31], v24, s[60:63], s21 offen
  s_add_u32 s21, s23, 409600
  buffer_load_dwordx4 v[28:31], v24, s[60:63], s21 offen
  s_add_u32 s21, s23, 425984
  buffer_load_dwordx4 v[28:31], v24, s[60:63], s21 offen
  s_add_u32 s21, s23, 442368
  buffer_load_dwordx4 v[28:31], v24, s[60:63], s21 offen
  s_add_u32 s21, s23, 458752
  buffer_load_dwordx4 v[28:31], v24, s[60:63], s21 offen
  s_add_u32 s21, s23, 475136
  buffer_load_dwordx4 v[28:31], v24, s[60:63], s21 offen
  s_add_u32 s21, s23, 491520
  buffer_load_dwordx4 v[28:31], v24, s[60:63], s21 offen
  s_add_u32 s21, s23, 507904
  buffer_load_dwordx4 v[28:31], v24, s[60:63], s21 offen
  s_lshl_b32 s23, s16, 14
  s_add_u32 s22, s22, s23
  s_mov_b32 s30, 0
va_pf:
  buffer_load_dwordx4 v[28:31], v24, s[56:59], s22 offen
  s_waitcnt vmcnt(40)
  s_add_u32 s22, s22, 65536
  s_add_u32 s30, s30, 1
  s_cmp_lt_u32 s30, 56
  s_cbranch_scc1 va_pf
  s_cmp_lg_u32 s66, 0
  s_cbranch_scc1 va_cf
  s_cmp_lg_u32 s16, 0
  s_cbranch_scc1 w0_8
  s_waitcnt vmcnt(40)
  v_readfirstlane_b32 s70, v244
  s_cmp_lg_u32 s70, 0
  s_cbranch_scc1 va_nz
  v_mov_b32 v243, 128
  v_mov_b32 v244, s88
  v_mov_b32 v245, s89
  v_mov_b32 v246, 0
  v_mov_b32 v247, 0
  s_mov_b64 exec, 1
  buffer_atomic_cmpswap_x2 v[244:247], v243, s[12:15], 0 offen sc0
  s_mov_b64 exec, -1
  s_waitcnt vmcnt(0)
  v_readfirstlane_b32 s70, v244
  s_cmp_lg_u32 s70, 0
  s_cbranch_scc1 va_nz
  v_mov_b32 v244, s88
  v_mov_b32 v245, s89
va_nz:
w0_8:
  v_mov_b32 v243, 160000
  s_add_u32 s101, s101, 1
  s_barrier
  s_mov_b64 exec, 1
  s_cmp_lg_u32 s16, 0
  s_cbranch_scc1 w0_9
  ds_write_b32 v243, v242 offset:0
  ds_write_b32 v243, v244 offset:4
  ds_write_b32 v243, v245 offset:8
  s_waitcnt lgkmcnt(0)
  v_mov_b32 v242, s101
  ds_write_b32 v243, v242 offset:16
  s_waitcnt lgkmcnt(0)
w0_9:
  s_mov_b64 exec, -1
  s_barrier
  ds_read_b32 v242, v243 offset:0
  ds_read_b32 v244, v243 offset:4
  ds_read_b32 v245, v243 offset:8
  ds_read_b32 v243, v243 offset:16
  s_waitcnt lgkmcnt(0)
  v_readfirstlane_b32 s70, v242
  v_readfirstlane_b32 s88, v244
  v_readfirstlane_b32 s89, v245
  v_cmp_ne_u32 vcc, s101, v243
  s_cbranch_vccnz ch_end
  s_mov_b32 s66, 1
  s_bitcmp1_b32 s70, s3
  s_cbranch_scc1 m_reclaim
va_cf:
  s_cmp_lg_u32 s16, 0
  s_cbranch_scc1 w0_10
  s_cmp_eq_u32 s67, 0
  s_cselect_b32 s20, 1, 0x10001
  v_mov_b32 v242, s20
  v_mov_b32 v243, 0
  s_mov_b64 exec, 1
  buffer_atomic_add v242, v243, s[12:15], 0 offen
  s_mov_b64 exec, -1
w0_10:
m_role:
  s_mov_b32 s17, s3
  v_and_b32 v1, 63, v0
  v_lshlrev_b32 v2, 4, v1
  v_lshrrev_b32 v116, 4, v1
  v_and_b32 v117, 15, v1
  v_mov_b32 v3, 0x4444
  v_mov_b32 v118, 0xeeee
  v_cmp_lt_u32 vcc, 7, v117
  s_nop 1
  v_cndmask_b32 v3, v3, v118, vcc
  s_mov_b32 s19, 0
  s_mov_b32 s20, 88653824
  s_lshr_b32 s22, s17, 4
  s_lshl_b32 s22, s22, 2
  s_add_u32 s22, s22, s16
  s_and_b32 s17, s17, 15
  s_cmp_eq_u32 s22, 0
  s_cbranch_scc1 ch_init0
  s_cmp_eq_u32 s22, 1
  s_cbranch_scc1 ch_init1
  s_cmp_eq_u32 s22, 2
  s_cbranch_scc1 ch_init2
  s_cmp_eq_u32 s22, 3
  s_cbranch_scc1 ch_init3
  s_cmp_eq_u32 s22, 4
  s_cbranch_scc1 ch_init4
  s_cmp_eq_u32 s22, 5
  s_cbranch_scc1 ch_init5
  s_cmp_eq_u32 s22, 6
  s_cbranch_scc1 ch_init6
  s_cmp_eq_u32 s22, 7
  s_cbranch_scc1 ch_init7
  s_branch ch_end
ch_init0:
  s_mul_i32 s31, s17, 401408
  s_add_u32 s31, s31, 0
  s_mov_b32 s24, 71565312
  s_mov_b32 s25, 0
  s_add_u32 m0, s25, 0
  s_nop 0
  buffer_load_dwordx4 v2, s[8:11], s24 offen offset:0 sc1 lds
  buffer_load_dwordx4 v2, s[8:11], s24 offen offset:1024 sc1 lds
  buffer_load_dwordx4 v2, s[8:11], s24 offen offset:2048 sc1 lds
  buffer_load_dwordx4 v2, s[8:11], s24 offen offset:3072 sc1 lds
  s_add_u32 m0, s25, 4096
  s_add_u32 s22, s24, 4096
  buffer_load_dwordx4 v2, s[8:11], s22 offen offset:0 sc1 lds
  buffer_load_dwordx4 v2, s[8:11], s22 offen offset:1024 sc1 lds
  buffer_load_dwordx4 v2, s[8:11], s22 offen offset:2048 sc1 lds
  v_lshrrev_b32 v64, 1, v117
  v_and_b32 v65, 1, v116
  v_lshlrev_b32 v65, 2, v65
  v_sub_u32 v64, v64, v65
  v_and_b32 v65, 1, v117
  v_lshl_add_u32 v66, v65, 2, v64
  v_cmp_gt_u32 vcc, 4, v64
  v_mov_b32 v67, 99
  s_nop 0
  v_cndmask_b32 v66, v67, v66, vcc
  v_mov_b32 v68, 0x3f80
  v_mov_b32 v69, 0x3f800000
  v_mov_b32 v4, 0
  v_cmp_eq_u32 vcc, 0, v66
  s_nop 1
  v_cndmask_b32 v4, v4, v68, vcc
  v_cmp_eq_u32 vcc, 1, v66
  s_nop 1
  v_cndmask_b32 v4, v4, v69, vcc
  v_mov_b32 v5, 0
  v_cmp_eq_u32 vcc, 2, v66
  s_nop 1
  v_cndmask_b32 v5, v5, v68, vcc
  v_cmp_eq_u32 vcc, 3, v66
  s_nop 1
  v_cndmask_b32 v5, v5, v69, vcc
  v_mov_b32 v6, 0
  v_cmp_eq_u32 vcc, 4, v66
  s_nop 1
  v_cndmask_b32 v6, v6, v68, vcc
  v_cmp_eq_u32 vcc, 5, v66
  s_nop 1
  v_cndmask_b32 v6, v6, v69, vcc
  v_mov_b32 v7, 0
  v_cmp_eq_u32 vcc, 6, v66
  s_nop 1
  v_cndmask_b32 v7, v7, v68, vcc
  v_cmp_eq_u32 vcc, 7, v66
  s_nop 1
  v_cndmask_b32 v7, v7, v69, vcc
  v_lshrrev_b32 v64, 1, v116
  v_lshrrev_b32 v65, 3, v117
  v_cmp_eq_u32 s[26:27], v64, v65
  v_and_b32 v66, 1, v116
  v_add_u32 v64, 0, v64
  v_lshrrev_b32 v67, 1, v116
  v_lshlrev_b32 v67, 8, v67
  v_lshl_add_u32 v67, v66, 9, v67
  v_lshl_add_u32 v67, v117, 4, v67
  v_add_u32 v112, 57344, v67
  v_and_b32 v68, 7, v117
  v_lshlrev_b32 v67, 8, v64
  v_lshl_add_u32 v67, v68, 5, v67
  v_lshl_add_u32 v67, v66, 4, v67
  v_add_u32 v113, 65536, v67
  v_lshrrev_b32 v64, 5, v1
  v_and_b32 v65, 31, v1
  v_lshrrev_b32 v66, 3, v65
  v_and_b32 v67, 7, v65
  v_and_b32 v68, 3, v67
  v_lshl_add_u32 v68, v66, 2, v68
  v_lshrrev_b32 v69, 2, v67
  v_lshl_add_u32 v68, v69, 4, v68
  v_lshlrev_b32 v69, 11, v64
  v_lshl_add_u32 v69, v68, 4, v69
  v_add_u32 v114, 57344, v69
  v_add_u32 v70, 0, v64
  v_lshlrev_b32 v69, 9, v66
  v_lshl_add_u32 v69, v70, 5, v69
  v_lshl_add_u32 v69, v67, 2, v69
  v_add_u32 v115, 65536, v69
  v_lshlrev_b32 v69, 4, v68
  v_lshl_add_u32 v69, v64, 9, v69
  v_add_u32 v114, 57344, v69
  v_mul_u32_u24 v69, 144, v70
  v_lshl_add_u32 v69, v67, 4, v69
  v_add_u32 v115, 65536, v69
  v_and_b32 v71, 1, v116
  v_mul_u32_u24 v69, 2048, v71
  v_lshl_add_u32 v69, v64, 8, v69
  v_lshl_add_u32 v69, v117, 4, v69
  v_add_u32 v112, 57344, v69
  v_mul_u32_u24 v69, 144, v117
  v_lshl_add_u32 v69, v71, 6, v69
  v_lshl_add_u32 v69, v64, 5, v69
  v_add_u32 v113, 65536, v69
  v_mul_u32_u24 v69, 1024, v116
  v_lshl_add_u32 v69, v117, 4, v69
  v_and_b32 v72, 8, v117
  v_xor_b32 v72, 0, v72
  v_add_u32 v69, v69, v72
  v_add_u32 v112, 57344, v69
  v_lshrrev_b32 v72, 3, v117
  v_lshl_add_u32 v72, v71, 1, v72
  v_xor_b32 v72, 0, v72
  v_lshlrev_b32 v69, 10, v116
  v_lshl_add_u32 v69, v117, 4, v69
  v_lshl_add_u32 v69, v72, 2, v69
  v_add_u32 v112, 57344, v69
  v_lshrrev_b32 v69, 1, v117
  v_and_b32 v72, 1, v117
  v_lshl_add_u32 v69, v72, 3, v69
  v_mul_u32_u24 v69, 144, v69
  v_lshl_add_u32 v69, v71, 6, v69
  v_lshl_add_u32 v69, v64, 5, v69
  v_lshl_add_u32 v72, v72, 1, v71
  v_xor_b32 v72, 0, v72
  v_lshl_add_u32 v69, v72, 2, v69
  v_add_u32 v113, 65536, v69
  v_and_b32 v71, 1, v1
  v_cmp_eq_u32 s[38:39], 0, v71
  v_cmp_gt_u32 vcc, 8, v65
  s_or_b64 s[28:29], s[38:39], vcc
  v_lshrrev_b32 v72, 1, v67
  v_lshlrev_b32 v72, 2, v72
  v_lshl_add_u32 v72, v70, 4, v72
  s_lshl_b32 s22, s17, 9
  s_add_u32 s22, s22, 9216
  v_lshl_add_u32 v73, v66, 7, v72
  v_add_u32 v73, s22, v73
  s_lshl_b32 s22, s17, 7
  s_add_u32 s22, s22, 7168
  v_add_u32 v74, s22, v72
  v_bfe_u32 v72, v65, 1, 1
  v_lshlrev_b32 v72, 7, v72
  v_lshl_add_u32 v72, v70, 4, v72
  v_bfe_u32 v73, v65, 2, 2
  v_lshl_add_u32 v72, v73, 2, v72
  v_lshrrev_b32 v73, 4, v65
  v_lshl_add_u32 v73, v73, 8, v72
  s_lshl_b32 s22, s17, 9
  s_add_u32 s22, s22, 9216
  v_add_u32 v73, s22, v73
  s_lshr_b32 s22, s17, 1
  s_lshl_b32 s22, s22, 8
  s_and_b32 s34, s17, 1
  s_lshl_b32 s34, s34, 3
  s_add_u32 s22, s22, s34
  s_add_u32 s22, s22, 7168
  v_add_u32 v74, s22, v72
  v_bfe_u32 v72, v65, 1, 1
  v_lshl_add_u32 v72, v64, 1, v72
  v_lshlrev_b32 v72, 4, v72
  v_bfe_u32 v73, v65, 2, 2
  v_lshl_add_u32 v72, v73, 2, v72
  v_lshrrev_b32 v73, 4, v65
  v_lshl_add_u32 v73, v73, 6, v72
  s_lshl_b32 s22, s17, 9
  s_add_u32 s22, s22, 9216
  v_add_u32 v73, s22, v73
  v_lshrrev_b32 v72, 1, v65
  v_lshlrev_b32 v72, 2, v72
  v_lshl_add_u32 v72, v64, 5, v72
  s_lshr_b32 s22, s17, 1
  s_lshl_b32 s22, s22, 8
  s_and_b32 s34, s17, 1
  s_lshl_b32 s34, s34, 4
  s_add_u32 s22, s22, s34
  s_add_u32 s22, s22, 7168
  v_add_u32 v74, s22, v72
  v_lshlrev_b32 v0, 2, v65
  v_and_b32 v0, 0x78, v0
  s_and_b32 s22, s17, 15
  s_lshl_b32 s22, s22, 7
  s_add_u32 s22, s22, 18432
  v_add_u32 v0, s22, v0
  v_cndmask_b32 v1, v74, v73, s[38:39]
  s_lshl_b32 s36, s17, 2
  s_add_u32 s36, s36, 17408
  s_mov_b32 s37, 0x3e800000
  v_mov_b32 v64, 0
  v_mov_b32 v65, 0
  v_mov_b32 v66, 0
  v_mov_b32 v67, 0
  v_mov_b32 v68, 0
  v_mov_b32 v69, 0
  v_mov_b32 v70, 0
  v_mov_b32 v71, 0
  v_mov_b32 v72, 0
  v_mov_b32 v73, 0
  v_mov_b32 v74, 0
  v_mov_b32 v75, 0
  v_mov_b32 v76, 0
  v_mov_b32 v77, 0
  v_mov_b32 v78, 0
  v_mov_b32 v79, 0
  v_mov_b32 v80, 0
  v_mov_b32 v81, 0
  v_mov_b32 v82, 0
  v_mov_b32 v83, 0
  v_mov_b32 v84, 0
  v_mov_b32 v85, 0
  v_mov_b32 v86, 0
  v_mov_b32 v87, 0
  v_mov_b32 v88, 0
  v_mov_b32 v89, 0
  v_mov_b32 v90, 0
  v_mov_b32 v91, 0
  v_mov_b32 v92, 0
  v_mov_b32 v93, 0
  v_mov_b32 v94, 0
  v_mov_b32 v95, 0
  v_mov_b32 v96, 0
  v_mov_b32 v97, 0
  v_mov_b32 v98, 0
  v_mov_b32 v99, 0
  v_mov_b32 v100, 0
  v_mov_b32 v101, 0
  v_mov_b32 v102, 0
  v_mov_b32 v103, 0
  v_mov_b32 v104, 0
  v_mov_b32 v105, 0
  v_mov_b32 v106, 0
  v_mov_b32 v107, 0
  v_mov_b32 v108, 0
  v_mov_b32 v109, 0
  v_mov_b32 v110, 0
  v_mov_b32 v111, 0
  v_and_b32 v118, 1, v116
  v_cmp_eq_u32 vcc, 0, v118
  v_mov_b32 v118, 12288
  v_mov_b32 v119, 8192
  v_cndmask_b32 v118, v118, v119, vcc
  v_lshrrev_b32 v116, 1, v116
  v_lshl_add_u32 v118, v116, 9, v118
  v_lshl_add_u32 v117, v117, 4, v118
  s_mov_b32 s57, 28672
  v_bfe_u32 v118, v2, 4, 1
  v_mul_u32_u24 v118, 0xaaaa, v118
  v_add_u32 v118, 0x4444, v118
  s_mov_b32 s56, 0x42800000
  v_mov_b32 v116, v2
  s_mul_i32 s35, s17, 1835008
  s_add_u32 s35, s35, 42262528
  s_mov_b32 s30, 0
  v_mov_b32 v36, 0
ch_md0:
  buffer_load_dword v37, v36, s[12:15], 0 offen sc1
  s_waitcnt vmcnt(0)
  v_readfirstlane_b32 s22, v37
  s_and_b32 s31, s22, 0xffff
  s_cmp_ge_u32 s31, 32
  s_cbranch_scc1 ch_go0
  s_sleep 2
  s_add_u32 s30, s30, 1
  s_cmp_lt_u32 s30, 50000
  s_cbranch_scc1 ch_md0
  s_branch ch_end
ch_go0:
  s_mov_b32 s31, 0
  s_lshr_b32 s22, s22, 16
  s_cmp_lg_u32 s22, 0
  s_cbranch_scc1 cB_sc0_loop
  s_branch cA_sc0_loop
ch_init1:
  s_mul_i32 s31, s17, 401408
  s_add_u32 s31, s31, 0
  s_mov_b32 s24, 71572480
  s_mov_b32 s25, 0
  s_add_u32 m0, s25, 7168
  s_nop 0
  buffer_load_dwordx4 v2, s[8:11], s24 offen offset:0 sc1 lds
  buffer_load_dwordx4 v2, s[8:11], s24 offen offset:1024 sc1 lds
  buffer_load_dwordx4 v2, s[8:11], s24 offen offset:2048 sc1 lds
  buffer_load_dwordx4 v2, s[8:11], s24 offen offset:3072 sc1 lds
  s_add_u32 m0, s25, 11264
  s_add_u32 s22, s24, 4096
  buffer_load_dwordx4 v2, s[8:11], s22 offen offset:0 sc1 lds
  buffer_load_dwordx4 v2, s[8:11], s22 offen offset:1024 sc1 lds
  buffer_load_dwordx4 v2, s[8:11], s22 offen offset:2048 sc1 lds
  v_lshrrev_b32 v64, 1, v117
  v_and_b32 v65, 1, v116
  v_lshlrev_b32 v65, 2, v65
  v_sub_u32 v64, v64, v65
  v_and_b32 v65, 1, v117
  v_lshl_add_u32 v66, v65, 2, v64
  v_cmp_gt_u32 vcc, 4, v64
  v_mov_b32 v67, 99
  s_nop 0
  v_cndmask_b32 v66, v67, v66, vcc
  v_mov_b32 v68, 0x3f80
  v_mov_b32 v69, 0x3f800000
  v_mov_b32 v4, 0
  v_cmp_eq_u32 vcc, 0, v66
  s_nop 1
  v_cndmask_b32 v4, v4, v68, vcc
  v_cmp_eq_u32 vcc, 1, v66
  s_nop 1
  v_cndmask_b32 v4, v4, v69, vcc
  v_mov_b32 v5, 0
  v_cmp_eq_u32 vcc, 2, v66
  s_nop 1
  v_cndmask_b32 v5, v5, v68, vcc
  v_cmp_eq_u32 vcc, 3, v66
  s_nop 1
  v_cndmask_b32 v5, v5, v69, vcc
  v_mov_b32 v6, 0
  v_cmp_eq_u32 vcc, 4, v66
  s_nop 1
  v_cndmask_b32 v6, v6, v68, vcc
  v_cmp_eq_u32 vcc, 5, v66
  s_nop 1
  v_cndmask_b32 v6, v6, v69, vcc
  v_mov_b32 v7, 0
  v_cmp_eq_u32 vcc, 6, v66
  s_nop 1
  v_cndmask_b32 v7, v7, v68, vcc
  v_cmp_eq_u32 vcc, 7, v66
  s_nop 1
  v_cndmask_b32 v7, v7, v69, vcc
  v_lshrrev_b32 v64, 1, v116
  v_lshrrev_b32 v65, 3, v117
  v_cmp_eq_u32 s[26:27], v64, v65
  v_and_b32 v66, 1, v116
  v_add_u32 v64, 2, v64
  v_lshrrev_b32 v67, 1, v116
  v_lshlrev_b32 v67, 8, v67
  v_lshl_add_u32 v67, v66, 9, v67
  v_lshl_add_u32 v67, v117, 4, v67
  v_add_u32 v112, 58368, v67
  v_and_b32 v68, 7, v117
  v_lshlrev_b32 v67, 8, v64
  v_lshl_add_u32 v67, v68, 5, v67
  v_lshl_add_u32 v67, v66, 4, v67
  v_add_u32 v113, 65536, v67
  v_lshrrev_b32 v64, 5, v1
  v_and_b32 v65, 31, v1
  v_lshrrev_b32 v66, 3, v65
  v_and_b32 v67, 7, v65
  v_and_b32 v68, 3, v67
  v_lshl_add_u32 v68, v66, 2, v68
  v_lshrrev_b32 v69, 2, v67
  v_lshl_add_u32 v68, v69, 4, v68
  v_lshlrev_b32 v69, 11, v64
  v_lshl_add_u32 v69, v68, 4, v69
  v_add_u32 v114, 57352, v69
  v_add_u32 v70, 2, v64
  v_lshlrev_b32 v69, 9, v66
  v_lshl_add_u32 v69, v70, 5, v69
  v_lshl_add_u32 v69, v67, 2, v69
  v_add_u32 v115, 65536, v69
  v_lshlrev_b32 v69, 4, v68
  v_lshl_add_u32 v69, v64, 9, v69
  v_add_u32 v114, 58368, v69
  v_mul_u32_u24 v69, 144, v70
  v_lshl_add_u32 v69, v67, 4, v69
  v_add_u32 v115, 65536, v69
  v_and_b32 v71, 1, v116
  v_mul_u32_u24 v69, 2048, v71
  v_lshl_add_u32 v69, v64, 8, v69
  v_lshl_add_u32 v69, v117, 4, v69
  v_add_u32 v112, 57352, v69
  v_mul_u32_u24 v69, 144, v117
  v_lshl_add_u32 v69, v71, 6, v69
  v_lshl_add_u32 v69, v64, 5, v69
  v_add_u32 v113, 65540, v69
  v_mul_u32_u24 v69, 1024, v116
  v_lshl_add_u32 v69, v117, 4, v69
  v_and_b32 v72, 8, v117
  v_xor_b32 v72, 8, v72
  v_add_u32 v69, v69, v72
  v_add_u32 v112, 57344, v69
  v_lshrrev_b32 v72, 3, v117
  v_lshl_add_u32 v72, v71, 1, v72
  v_xor_b32 v72, 1, v72
  v_lshlrev_b32 v69, 10, v116
  v_lshl_add_u32 v69, v117, 4, v69
  v_lshl_add_u32 v69, v72, 2, v69
  v_add_u32 v112, 57344, v69
  v_lshrrev_b32 v69, 1, v117
  v_and_b32 v72, 1, v117
  v_lshl_add_u32 v69, v72, 3, v69
  v_mul_u32_u24 v69, 144, v69
  v_lshl_add_u32 v69, v71, 6, v69
  v_lshl_add_u32 v69, v64, 5, v69
  v_lshl_add_u32 v72, v72, 1, v71
  v_xor_b32 v72, 1, v72
  v_lshl_add_u32 v69, v72, 2, v69
  v_add_u32 v113, 65536, v69
  v_and_b32 v71, 1, v1
  v_cmp_eq_u32 s[38:39], 0, v71
  v_cmp_gt_u32 vcc, 8, v65
  s_or_b64 s[28:29], s[38:39], vcc
  v_lshrrev_b32 v72, 1, v67
  v_lshlrev_b32 v72, 2, v72
  v_lshl_add_u32 v72, v70, 4, v72
  s_lshl_b32 s22, s17, 9
  s_add_u32 s22, s22, 9216
  v_lshl_add_u32 v73, v66, 7, v72
  v_add_u32 v73, s22, v73
  s_lshl_b32 s22, s17, 7
  s_add_u32 s22, s22, 7168
  v_add_u32 v74, s22, v72
  v_bfe_u32 v72, v65, 1, 1
  v_lshlrev_b32 v72, 7, v72
  v_lshl_add_u32 v72, v70, 4, v72
  v_bfe_u32 v73, v65, 2, 2
  v_lshl_add_u32 v72, v73, 2, v72
  v_lshrrev_b32 v73, 4, v65
  v_lshl_add_u32 v73, v73, 8, v72
  s_lshl_b32 s22, s17, 9
  s_add_u32 s22, s22, 9216
  v_add_u32 v73, s22, v73
  s_lshr_b32 s22, s17, 1
  s_lshl_b32 s22, s22, 8
  s_and_b32 s34, s17, 1
  s_lshl_b32 s34, s34, 3
  s_add_u32 s22, s22, s34
  s_add_u32 s22, s22, 7168
  v_add_u32 v74, s22, v72
  v_bfe_u32 v72, v65, 1, 1
  v_lshl_add_u32 v72, v64, 1, v72
  v_lshlrev_b32 v72, 4, v72
  v_bfe_u32 v73, v65, 2, 2
  v_lshl_add_u32 v72, v73, 2, v72
  v_lshrrev_b32 v73, 4, v65
  v_lshl_add_u32 v73, v73, 6, v72
  s_lshl_b32 s22, s17, 9
  s_add_u32 s22, s22, 9344
  v_add_u32 v73, s22, v73
  v_lshrrev_b32 v72, 1, v65
  v_lshlrev_b32 v72, 2, v72
  v_lshl_add_u32 v72, v64, 5, v72
  s_lshr_b32 s22, s17, 1
  s_lshl_b32 s22, s22, 8
  s_and_b32 s34, s17, 1
  s_lshl_b32 s34, s34, 4
  s_add_u32 s22, s22, s34
  s_add_u32 s22, s22, 7232
  v_add_u32 v74, s22, v72
  v_lshlrev_b32 v0, 2, v65
  v_and_b32 v0, 0x78, v0
  s_and_b32 s22, s17, 15
  s_lshl_b32 s22, s22, 7
  s_add_u32 s22, s22, 18432
  v_add_u32 v0, s22, v0
  v_cndmask_b32 v1, v74, v73, s[38:39]
  s_lshl_b32 s36, s17, 2
  s_add_u32 s36, s36, 17408
  s_mov_b32 s37, 0x3e800000
  v_mov_b32 v64, 0
  v_mov_b32 v65, 0
  v_mov_b32 v66, 0
  v_mov_b32 v67, 0
  v_mov_b32 v68, 0
  v_mov_b32 v69, 0
  v_mov_b32 v70, 0
  v_mov_b32 v71, 0
  v_mov_b32 v72, 0
  v_mov_b32 v73, 0
  v_mov_b32 v74, 0
  v_mov_b32 v75, 0
  v_mov_b32 v76, 0
  v_mov_b32 v77, 0
  v_mov_b32 v78, 0
  v_mov_b32 v79, 0
  v_mov_b32 v80, 0
  v_mov_b32 v81, 0
  v_mov_b32 v82, 0
  v_mov_b32 v83, 0
  v_mov_b32 v84, 0
  v_mov_b32 v85, 0
  v_mov_b32 v86, 0
  v_mov_b32 v87, 0
  v_mov_b32 v88, 0
  v_mov_b32 v89, 0
  v_mov_b32 v90, 0
  v_mov_b32 v91, 0
  v_mov_b32 v92, 0
  v_mov_b32 v93, 0
  v_mov_b32 v94, 0
  v_mov_b32 v95, 0
  v_mov_b32 v96, 0
  v_mov_b32 v97, 0
  v_mov_b32 v98, 0
  v_mov_b32 v99, 0
  v_mov_b32 v100, 0
  v_mov_b32 v101, 0
  v_mov_b32 v102, 0
  v_mov_b32 v103, 0
  v_mov_b32 v104, 0
  v_mov_b32 v105, 0
  v_mov_b32 v106, 0
  v_mov_b32 v107, 0
  v_mov_b32 v108, 0
  v_mov_b32 v109, 0
  v_mov_b32 v110, 0
  v_mov_b32 v111, 0
  v_and_b32 v118, 1, v116
  v_cmp_eq_u32 vcc, 0, v118
  v_mov_b32 v118, 12288
  v_mov_b32 v119, 8448
  v_cndmask_b32 v118, v118, v119, vcc
  v_lshrrev_b32 v116, 1, v116
  v_lshl_add_u32 v118, v116, 9, v118
  v_lshl_add_u32 v117, v117, 4, v118
  s_mov_b32 s57, 28672
  v_bfe_u32 v118, v2, 4, 1
  v_mul_u32_u24 v118, 0xaaaa, v118
  v_add_u32 v118, 0x4444, v118
  s_mov_b32 s56, 0x42800000
  v_mov_b32 v116, v2
  v_lshrrev_b32 v0, 4, v2
  v_min_u32 v0, 9, v0
  s_mul_i32 s22, s17, 10
  v_add_u32 v0, s22, v0
  v_lshlrev_b32 v0, 7, v0
  v_add_u32 v0, 40960, v0
  s_mov_b32 s22, 88633344
  buffer_load_dword v119, v0, s[8:11], s22 offen sc1
  s_mov_b32 s22, 88612864
  buffer_load_dword v119, v0, s[8:11], s22 offen sc1
  s_mul_i32 s35, s17, 1835008
  s_add_u32 s35, s35, 42269696
  s_mov_b32 s30, 0
  v_mov_b32 v36, 0
ch_md1:
  buffer_load_dword v37, v36, s[12:15], 0 offen sc1
  s_waitcnt vmcnt(0)
  v_readfirstlane_b32 s22, v37
  s_and_b32 s31, s22, 0xffff
  s_cmp_ge_u32 s31, 32
  s_cbranch_scc1 ch_go1
  s_sleep 2
  s_add_u32 s30, s30, 1
  s_cmp_lt_u32 s30, 50000
  s_cbranch_scc1 ch_md1
  s_branch ch_end
ch_go1:
  s_mov_b32 s31, 0
  s_lshr_b32 s22, s22, 16
  s_cmp_lg_u32 s22, 0
  s_cbranch_scc1 cB_sc1_loop
  s_branch cA_sc1_loop
ch_init2:
  s_mul_i32 s31, s17, 401408
  s_add_u32 s31, s31, 0
  s_mov_b32 s24, 71579648
  s_mov_b32 s25, 0
  s_add_u32 m0, s25, 14336
  s_nop 0
  buffer_load_dwordx4 v2, s[8:11], s24 offen offset:0 sc1 lds
  buffer_load_dwordx4 v2, s[8:11], s24 offen offset:1024 sc1 lds
  buffer_load_dwordx4 v2, s[8:11], s24 offen offset:2048 sc1 lds
  buffer_load_dwordx4 v2, s[8:11], s24 offen offset:3072 sc1 lds
  s_add_u32 m0, s25, 18432
  s_add_u32 s22, s24, 4096
  buffer_load_dwordx4 v2, s[8:11], s22 offen offset:0 sc1 lds
  buffer_load_dwordx4 v2, s[8:11], s22 offen offset:1024 sc1 lds
  buffer_load_dwordx4 v2, s[8:11], s22 offen offset:2048 sc1 lds
  v_lshrrev_b32 v64, 1, v117
  v_and_b32 v65, 1, v116
  v_lshlrev_b32 v65, 2, v65
  v_sub_u32 v64, v64, v65
  v_and_b32 v65, 1, v117
  v_lshl_add_u32 v66, v65, 2, v64
  v_cmp_gt_u32 vcc, 4, v64
  v_mov_b32 v67, 99
  s_nop 0
  v_cndmask_b32 v66, v67, v66, vcc
  v_mov_b32 v68, 0x3f80
  v_mov_b32 v69, 0x3f800000
  v_mov_b32 v4, 0
  v_cmp_eq_u32 vcc, 0, v66
  s_nop 1
  v_cndmask_b32 v4, v4, v68, vcc
  v_cmp_eq_u32 vcc, 1, v66
  s_nop 1
  v_cndmask_b32 v4, v4, v69, vcc
  v_mov_b32 v5, 0
  v_cmp_eq_u32 vcc, 2, v66
  s_nop 1
  v_cndmask_b32 v5, v5, v68, vcc
  v_cmp_eq_u32 vcc, 3, v66
  s_nop 1
  v_cndmask_b32 v5, v5, v69, vcc
  v_mov_b32 v6, 0
  v_cmp_eq_u32 vcc, 4, v66
  s_nop 1
  v_cndmask_b32 v6, v6, v68, vcc
  v_cmp_eq_u32 vcc, 5, v66
  s_nop 1
  v_cndmask_b32 v6, v6, v69, vcc
  v_mov_b32 v7, 0
  v_cmp_eq_u32 vcc, 6, v66
  s_nop 1
  v_cndmask_b32 v7, v7, v68, vcc
  v_cmp_eq_u32 vcc, 7, v66
  s_nop 1
  v_cndmask_b32 v7, v7, v69, vcc
  v_lshrrev_b32 v64, 1, v116
  v_lshrrev_b32 v65, 3, v117
  v_cmp_eq_u32 s[26:27], v64, v65
  v_and_b32 v66, 1, v116
  v_add_u32 v64, 4, v64
  v_lshrrev_b32 v67, 1, v116
  v_lshlrev_b32 v67, 8, v67
  v_lshl_add_u32 v67, v66, 9, v67
  v_lshl_add_u32 v67, v117, 4, v67
  v_add_u32 v112, 59392, v67
  v_and_b32 v68, 7, v117
  v_lshlrev_b32 v67, 8, v64
  v_lshl_add_u32 v67, v68, 5, v67
  v_lshl_add_u32 v67, v66, 4, v67
  v_add_u32 v113, 65536, v67
  v_lshrrev_b32 v64, 5, v1
  v_and_b32 v65, 31, v1
  v_lshrrev_b32 v66, 3, v65
  v_and_b32 v67, 7, v65
  v_and_b32 v68, 3, v67
  v_lshl_add_u32 v68, v66, 2, v68
  v_lshrrev_b32 v69, 2, v67
  v_lshl_add_u32 v68, v69, 4, v68
  v_lshlrev_b32 v69, 11, v64
  v_lshl_add_u32 v69, v68, 4, v69
  v_add_u32 v114, 57856, v69
  v_add_u32 v70, 4, v64
  v_lshlrev_b32 v69, 9, v66
  v_lshl_add_u32 v69, v70, 5, v69
  v_lshl_add_u32 v69, v67, 2, v69
  v_add_u32 v115, 65536, v69
  v_lshlrev_b32 v69, 4, v68
  v_lshl_add_u32 v69, v64, 9, v69
  v_add_u32 v114, 59392, v69
  v_mul_u32_u24 v69, 144, v70
  v_lshl_add_u32 v69, v67, 4, v69
  v_add_u32 v115, 65536, v69
  v_and_b32 v71, 1, v116
  v_mul_u32_u24 v69, 2048, v71
  v_lshl_add_u32 v69, v64, 8, v69
  v_lshl_add_u32 v69, v117, 4, v69
  v_add_u32 v112, 57856, v69
  v_mul_u32_u24 v69, 144, v117
  v_lshl_add_u32 v69, v71, 6, v69
  v_lshl_add_u32 v69, v64, 5, v69
  v_add_u32 v113, 65544, v69
  v_mul_u32_u24 v69, 1024, v116
  v_lshl_add_u32 v69, v117, 4, v69
  v_and_b32 v72, 8, v117
  v_xor_b32 v72, 0, v72
  v_add_u32 v69, v69, v72
  v_add_u32 v112, 57856, v69
  v_lshrrev_b32 v72, 3, v117
  v_lshl_add_u32 v72, v71, 1, v72
  v_xor_b32 v72, 2, v72
  v_lshlrev_b32 v69, 10, v116
  v_lshl_add_u32 v69, v117, 4, v69
  v_lshl_add_u32 v69, v72, 2, v69
  v_add_u32 v112, 57344, v69
  v_lshrrev_b32 v69, 1, v117
  v_and_b32 v72, 1, v117
  v_lshl_add_u32 v69, v72, 3, v69
  v_mul_u32_u24 v69, 144, v69
  v_lshl_add_u32 v69, v71, 6, v69
  v_lshl_add_u32 v69, v64, 5, v69
  v_lshl_add_u32 v72, v72, 1, v71
  v_xor_b32 v72, 2, v72
  v_lshl_add_u32 v69, v72, 2, v69
  v_add_u32 v113, 65536, v69
  v_and_b32 v71, 1, v1
  v_cmp_eq_u32 s[38:39], 0, v71
  v_cmp_gt_u32 vcc, 8, v65
  s_or_b64 s[28:29], s[38:39], vcc
  v_lshrrev_b32 v72, 1, v67
  v_lshlrev_b32 v72, 2, v72
  v_lshl_add_u32 v72, v70, 4, v72
  s_lshl_b32 s22, s17, 9
  s_add_u32 s22, s22, 9216
  v_lshl_add_u32 v73, v66, 7, v72
  v_add_u32 v73, s22, v73
  s_lshl_b32 s22, s17, 7
  s_add_u32 s22, s22, 7168
  v_add_u32 v74, s22, v72
  v_bfe_u32 v72, v65, 1, 1
  v_lshlrev_b32 v72, 7, v72
  v_lshl_add_u32 v72, v70, 4, v72
  v_bfe_u32 v73, v65, 2, 2
  v_lshl_add_u32 v72, v73, 2, v72
  v_lshrrev_b32 v73, 4, v65
  v_lshl_add_u32 v73, v73, 8, v72
  s_lshl_b32 s22, s17, 9
  s_add_u32 s22, s22, 9216
  v_add_u32 v73, s22, v73
  s_lshr_b32 s22, s17, 1
  s_lshl_b32 s22, s22, 8
  s_and_b32 s34, s17, 1
  s_lshl_b32 s34, s34, 3
  s_add_u32 s22, s22, s34
  s_add_u32 s22, s22, 7168
  v_add_u32 v74, s22, v72
  v_bfe_u32 v72, v65, 1, 1
  v_lshl_add_u32 v72, v64, 1, v72
  v_lshlrev_b32 v72, 4, v72
  v_bfe_u32 v73, v65, 2, 2
  v_lshl_add_u32 v72, v73, 2, v72
  v_lshrrev_b32 v73, 4, v65
  v_lshl_add_u32 v73, v73, 6, v72
  s_lshl_b32 s22, s17, 9
  s_add_u32 s22, s22, 9472
  v_add_u32 v73, s22, v73
  v_lshrrev_b32 v72, 1, v65
  v_lshlrev_b32 v72, 2, v72
  v_lshl_add_u32 v72, v64, 5, v72
  s_lshr_b32 s22, s17, 1
  s_lshl_b32 s22, s22, 8
  s_and_b32 s34, s17, 1
  s_lshl_b32 s34, s34, 4
  s_add_u32 s22, s22, s34
  s_add_u32 s22, s22, 7296
  v_add_u32 v74, s22, v72
  v_lshlrev_b32 v0, 2, v65
  v_and_b32 v0, 0x78, v0
  s_and_b32 s22, s17, 15
  s_lshl_b32 s22, s22, 7
  s_add_u32 s22, s22, 18432
  v_add_u32 v0, s22, v0
  v_cndmask_b32 v1, v74, v73, s[38:39]
  s_lshl_b32 s36, s17, 2
  s_add_u32 s36, s36, 17408
  s_mov_b32 s37, 0x3e800000
  v_mov_b32 v64, 0
  v_mov_b32 v65, 0
  v_mov_b32 v66, 0
  v_mov_b32 v67, 0
  v_mov_b32 v68, 0
  v_mov_b32 v69, 0
  v_mov_b32 v70, 0
  v_mov_b32 v71, 0
  v_mov_b32 v72, 0
  v_mov_b32 v73, 0
  v_mov_b32 v74, 0
  v_mov_b32 v75, 0
  v_mov_b32 v76, 0
  v_mov_b32 v77, 0
  v_mov_b32 v78, 0
  v_mov_b32 v79, 0
  v_mov_b32 v80, 0
  v_mov_b32 v81, 0
  v_mov_b32 v82, 0
  v_mov_b32 v83, 0
  v_mov_b32 v84, 0
  v_mov_b32 v85, 0
  v_mov_b32 v86, 0
  v_mov_b32 v87, 0
  v_mov_b32 v88, 0
  v_mov_b32 v89, 0
  v_mov_b32 v90, 0
  v_mov_b32 v91, 0
  v_mov_b32 v92, 0
  v_mov_b32 v93, 0
  v_mov_b32 v94, 0
  v_mov_b32 v95, 0
  v_mov_b32 v96, 0
  v_mov_b32 v97, 0
  v_mov_b32 v98, 0
  v_mov_b32 v99, 0
  v_mov_b32 v100, 0
  v_mov_b32 v101, 0
  v_mov_b32 v102, 0
  v_mov_b32 v103, 0
  v_mov_b32 v104, 0
  v_mov_b32 v105, 0
  v_mov_b32 v106, 0
  v_mov_b32 v107, 0
  v_mov_b32 v108, 0
  v_mov_b32 v109, 0
  v_mov_b32 v110, 0
  v_mov_b32 v111, 0
  v_and_b32 v118, 1, v116
  v_cmp_eq_u32 vcc, 0, v118
  v_mov_b32 v118, 12544
  v_mov_b32 v119, 10240
  v_cndmask_b32 v118, v118, v119, vcc
  v_lshrrev_b32 v116, 1, v116
  v_lshl_add_u32 v118, v116, 9, v118
  v_lshl_add_u32 v117, v117, 4, v118
  s_mov_b32 s57, 28672
  v_bfe_u32 v118, v2, 4, 1
  v_mul_u32_u24 v118, 0xaaaa, v118
  v_add_u32 v118, 0x4444, v118
  s_mov_b32 s56, 0x42800000
  v_mov_b32 v116, v2
  v_lshrrev_b32 v0, 4, v2
  v_min_u32 v0, 13, v0
  s_mul_i32 s22, s17, 14
  v_add_u32 v0, s22, v0
  v_lshlrev_b32 v0, 7, v0
  v_add_u32 v0, 43008, v0
  s_mov_b32 s22, 71550976
  buffer_load_dword v119, v0, s[8:11], s22 offen sc1
  s_mov_b32 s22, 71522304
  buffer_load_dword v119, v0, s[8:11], s22 offen sc1
  s_mul_i32 s35, s17, 1835008
  s_add_u32 s35, s35, 42276864
  s_mov_b32 s30, 0
  v_mov_b32 v36, 0
ch_md2:
  buffer_load_dword v37, v36, s[12:15], 0 offen sc1
  s_waitcnt vmcnt(0)
  v_readfirstlane_b32 s22, v37
  s_and_b32 s31, s22, 0xffff
  s_cmp_ge_u32 s31, 32
  s_cbranch_scc1 ch_go2
  s_sleep 2
  s_add_u32 s30, s30, 1
  s_cmp_lt_u32 s30, 50000
  s_cbranch_scc1 ch_md2
  s_branch ch_end
ch_go2:
  s_mov_b32 s31, 0
  s_lshr_b32 s22, s22, 16
  s_cmp_lg_u32 s22, 0
  s_cbranch_scc1 cB_sc2_loop
  s_branch cA_sc2_loop
ch_init3:
  s_mul_i32 s31, s17, 401408
  s_add_u32 s31, s31, 0
  s_mov_b32 s24, 71586816
  s_mov_b32 s25, 0
  s_add_u32 m0, s25, 21504
  s_nop 0
  buffer_load_dwordx4 v2, s[8:11], s24 offen offset:0 sc1 lds
  buffer_load_dwordx4 v2, s[8:11], s24 offen offset:1024 sc1 lds
  buffer_load_dwordx4 v2, s[8:11], s24 offen offset:2048 sc1 lds
  buffer_load_dwordx4 v2, s[8:11], s24 offen offset:3072 sc1 lds
  s_add_u32 m0, s25, 25600
  s_add_u32 s22, s24, 4096
  buffer_load_dwordx4 v2, s[8:11], s22 offen offset:0 sc1 lds
  buffer_load_dwordx4 v2, s[8:11], s22 offen offset:1024 sc1 lds
  buffer_load_dwordx4 v2, s[8:11], s22 offen offset:2048 sc1 lds
  v_lshrrev_b32 v64, 1, v117
  v_and_b32 v65, 1, v116
  v_lshlrev_b32 v65, 2, v65
  v_sub_u32 v64, v64, v65
  v_and_b32 v65, 1, v117
  v_lshl_add_u32 v66, v65, 2, v64
  v_cmp_gt_u32 vcc, 4, v64
  v_mov_b32 v67, 99
  s_nop 0
  v_cndmask_b32 v66, v67, v66, vcc
  v_mov_b32 v68, 0x3f80
  v_mov_b32 v69, 0x3f800000
  v_mov_b32 v4, 0
  v_cmp_eq_u32 vcc, 0, v66
  s_nop 1
  v_cndmask_b32 v4, v4, v68, vcc
  v_cmp_eq_u32 vcc, 1, v66
  s_nop 1
  v_cndmask_b32 v4, v4, v69, vcc
  v_mov_b32 v5, 0
  v_cmp_eq_u32 vcc, 2, v66
  s_nop 1
  v_cndmask_b32 v5, v5, v68, vcc
  v_cmp_eq_u32 vcc, 3, v66
  s_nop 1
  v_cndmask_b32 v5, v5, v69, vcc
  v_mov_b32 v6, 0
  v_cmp_eq_u32 vcc, 4, v66
  s_nop 1
  v_cndmask_b32 v6, v6, v68, vcc
  v_cmp_eq_u32 vcc, 5, v66
  s_nop 1
  v_cndmask_b32 v6, v6, v69, vcc
  v_mov_b32 v7, 0
  v_cmp_eq_u32 vcc, 6, v66
  s_nop 1
  v_cndmask_b32 v7, v7, v68, vcc
  v_cmp_eq_u32 vcc, 7, v66
  s_nop 1
  v_cndmask_b32 v7, v7, v69, vcc
  v_lshrrev_b32 v64, 1, v116
  v_lshrrev_b32 v65, 3, v117
  v_cmp_eq_u32 s[26:27], v64, v65
  v_and_b32 v66, 1, v116
  v_add_u32 v64, 6, v64
  v_lshrrev_b32 v67, 1, v116
  v_lshlrev_b32 v67, 8, v67
  v_lshl_add_u32 v67, v66, 9, v67
  v_lshl_add_u32 v67, v117, 4, v67
  v_add_u32 v112, 60416, v67
  v_and_b32 v68, 7, v117
  v_lshlrev_b32 v67, 8, v64
  v_lshl_add_u32 v67, v68, 5, v67
  v_lshl_add_u32 v67, v66, 4, v67
  v_add_u32 v113, 65536, v67
  v_lshrrev_b32 v64, 5, v1
  v_and_b32 v65, 31, v1
  v_lshrrev_b32 v66, 3, v65
  v_and_b32 v67, 7, v65
  v_and_b32 v68, 3, v67
  v_lshl_add_u32 v68, v66, 2, v68
  v_lshrrev_b32 v69, 2, v67
  v_lshl_add_u32 v68, v69, 4, v68
  v_lshlrev_b32 v69, 11, v64
  v_lshl_add_u32 v69, v68, 4, v69
  v_add_u32 v114, 57864, v69
  v_add_u32 v70, 6, v64
  v_lshlrev_b32 v69, 9, v66
  v_lshl_add_u32 v69, v70, 5, v69
  v_lshl_add_u32 v69, v67, 2, v69
  v_add_u32 v115, 65536, v69
  v_lshlrev_b32 v69, 4, v68
  v_lshl_add_u32 v69, v64, 9, v69
  v_add_u32 v114, 60416, v69
  v_mul_u32_u24 v69, 144, v70
  v_lshl_add_u32 v69, v67, 4, v69
  v_add_u32 v115, 65536, v69
  v_and_b32 v71, 1, v116
  v_mul_u32_u24 v69, 2048, v71
  v_lshl_add_u32 v69, v64, 8, v69
  v_lshl_add_u32 v69, v117, 4, v69
  v_add_u32 v112, 57864, v69
  v_mul_u32_u24 v69, 144, v117
  v_lshl_add_u32 v69, v71, 6, v69
  v_lshl_add_u32 v69, v64, 5, v69
  v_add_u32 v113, 65548, v69
  v_mul_u32_u24 v69, 1024, v116
  v_lshl_add_u32 v69, v117, 4, v69
  v_and_b32 v72, 8, v117
  v_xor_b32 v72, 8, v72
  v_add_u32 v69, v69, v72
  v_add_u32 v112, 57856, v69
  v_lshrrev_b32 v72, 3, v117
  v_lshl_add_u32 v72, v71, 1, v72
  v_xor_b32 v72, 3, v72
  v_lshlrev_b32 v69, 10, v116
  v_lshl_add_u32 v69, v117, 4, v69
  v_lshl_add_u32 v69, v72, 2, v69
  v_add_u32 v112, 57344, v69
  v_lshrrev_b32 v69, 1, v117
  v_and_b32 v72, 1, v117
  v_lshl_add_u32 v69, v72, 3, v69
  v_mul_u32_u24 v69, 144, v69
  v_lshl_add_u32 v69, v71, 6, v69
  v_lshl_add_u32 v69, v64, 5, v69
  v_lshl_add_u32 v72, v72, 1, v71
  v_xor_b32 v72, 3, v72
  v_lshl_add_u32 v69, v72, 2, v69
  v_add_u32 v113, 65536, v69
  v_and_b32 v71, 1, v1
  v_cmp_eq_u32 s[38:39], 0, v71
  v_cmp_gt_u32 vcc, 8, v65
  s_or_b64 s[28:29], s[38:39], vcc
  v_lshrrev_b32 v72, 1, v67
  v_lshlrev_b32 v72, 2, v72
  v_lshl_add_u32 v72, v70, 4, v72
  s_lshl_b32 s22, s17, 9
  s_add_u32 s22, s22, 9216
  v_lshl_add_u32 v73, v66, 7, v72
  v_add_u32 v73, s22, v73
  s_lshl_b32 s22, s17, 7
  s_add_u32 s22, s22, 7168
  v_add_u32 v74, s22, v72
  v_bfe_u32 v72, v65, 1, 1
  v_lshlrev_b32 v72, 7, v72
  v_lshl_add_u32 v72, v70, 4, v72
  v_bfe_u32 v73, v65, 2, 2
  v_lshl_add_u32 v72, v73, 2, v72
  v_lshrrev_b32 v73, 4, v65
  v_lshl_add_u32 v73, v73, 8, v72
  s_lshl_b32 s22, s17, 9
  s_add_u32 s22, s22, 9216
  v_add_u32 v73, s22, v73
  s_lshr_b32 s22, s17, 1
  s_lshl_b32 s22, s22, 8
  s_and_b32 s34, s17, 1
  s_lshl_b32 s34, s34, 3
  s_add_u32 s22, s22, s34
  s_add_u32 s22, s22, 7168
  v_add_u32 v74, s22, v72
  v_bfe_u32 v72, v65, 1, 1
  v_lshl_add_u32 v72, v64, 1, v72
  v_lshlrev_b32 v72, 4, v72
  v_bfe_u32 v73, v65, 2, 2
  v_lshl_add_u32 v72, v73, 2, v72
  v_lshrrev_b32 v73, 4, v65
  v_lshl_add_u32 v73, v73, 6, v72
  s_lshl_b32 s22, s17, 9
  s_add_u32 s22, s22, 9600
  v_add_u32 v73, s22, v73
  v_lshrrev_b32 v72, 1, v65
  v_lshlrev_b32 v72, 2, v72
  v_lshl_add_u32 v72, v64, 5, v72
  s_lshr_b32 s22, s17, 1
  s_lshl_b32 s22, s22, 8
  s_and_b32 s34, s17, 1
  s_lshl_b32 s34, s34, 4
  s_add_u32 s22, s22, s34
  s_add_u32 s22, s22, 7360
  v_add_u32 v74, s22, v72
  v_lshlrev_b32 v0, 2, v65
  v_and_b32 v0, 0x78, v0
  s_and_b32 s22, s17, 15
  s_lshl_b32 s22, s22, 7
  s_add_u32 s22, s22, 18432
  v_add_u32 v0, s22, v0
  v_cndmask_b32 v1, v74, v73, s[38:39]
  s_lshl_b32 s36, s17, 2
  s_add_u32 s36, s36, 17408
  s_mov_b32 s37, 0x3e800000
  v_mov_b32 v64, 0
  v_mov_b32 v65, 0
  v_mov_b32 v66, 0
  v_mov_b32 v67, 0
  v_mov_b32 v68, 0
  v_mov_b32 v69, 0
  v_mov_b32 v70, 0
  v_mov_b32 v71, 0
  v_mov_b32 v72, 0
  v_mov_b32 v73, 0
  v_mov_b32 v74, 0
  v_mov_b32 v75, 0
  v_mov_b32 v76, 0
  v_mov_b32 v77, 0
  v_mov_b32 v78, 0
  v_mov_b32 v79, 0
  v_mov_b32 v80, 0
  v_mov_b32 v81, 0
  v_mov_b32 v82, 0
  v_mov_b32 v83, 0
  v_mov_b32 v84, 0
  v_mov_b32 v85, 0
  v_mov_b32 v86, 0
  v_mov_b32 v87, 0
  v_mov_b32 v88, 0
  v_mov_b32 v89, 0
  v_mov_b32 v90, 0
  v_mov_b32 v91, 0
  v_mov_b32 v92, 0
  v_mov_b32 v93, 0
  v_mov_b32 v94, 0
  v_mov_b32 v95, 0
  v_mov_b32 v96, 0
  v_mov_b32 v97, 0
  v_mov_b32 v98, 0
  v_mov_b32 v99, 0
  v_mov_b32 v100, 0
  v_mov_b32 v101, 0
  v_mov_b32 v102, 0
  v_mov_b32 v103, 0
  v_mov_b32 v104, 0
  v_mov_b32 v105, 0
  v_mov_b32 v106, 0
  v_mov_b32 v107, 0
  v_mov_b32 v108, 0
  v_mov_b32 v109, 0
  v_mov_b32 v110, 0
  v_mov_b32 v111, 0
  v_and_b32 v118, 1, v116
  v_cmp_eq_u32 vcc, 0, v118
  v_mov_b32 v118, 12544
  v_mov_b32 v119, 10496
  v_cndmask_b32 v118, v118, v119, vcc
  v_lshrrev_b32 v116, 1, v116
  v_lshl_add_u32 v118, v116, 9, v118
  v_lshl_add_u32 v117, v117, 4, v118
  s_mov_b32 s57, 28672
  v_bfe_u32 v118, v2, 4, 1
  v_mul_u32_u24 v118, 0xaaaa, v118
  v_add_u32 v118, 0x4444, v118
  s_mov_b32 s56, 0x42800000
  v_mov_b32 v116, v2
  s_mul_i32 s35, s17, 1835008
  s_add_u32 s35, s35, 42284032
  s_mov_b32 s30, 0
  v_mov_b32 v36, 0
ch_md3:
  buffer_load_dword v37, v36, s[12:15], 0 offen sc1
  s_waitcnt vmcnt(0)
  v_readfirstlane_b32 s22, v37
  s_and_b32 s31, s22, 0xffff
  s_cmp_ge_u32 s31, 32
  s_cbranch_scc1 ch_go3
  s_sleep 2
  s_add_u32 s30, s30, 1
  s_cmp_lt_u32 s30, 50000
  s_cbranch_scc1 ch_md3
  s_branch ch_end
ch_go3:
  s_mov_b32 s31, 0
  s_lshr_b32 s22, s22, 16
  s_cmp_lg_u32 s22, 0
  s_cbranch_scc1 cB_sc3_loop
  s_branch cA_sc3_loop
ch_init4:
  s_mul_i32 s31, s17, 401408
  s_add_u32 s31, s31, 6422528
  s_mul_i32 s22, s17, 12
  s_add_u32 s23, s22, 267
  s_add_u32 s22, s22, 256
  v_mov_b32 v36, s23
  v_mov_b32 v37, s22
  v_cmp_eq_u32 vcc, 1, v116
  s_lshl_b32 s22, s17, 4
  s_nop 0
  v_cndmask_b32 v36, v36, v37, vcc
  v_mov_b32 v37, s22
  v_cmp_eq_u32 vcc, 0, v116
  s_nop 1
  v_cndmask_b32 v36, v36, v37, vcc
  v_lshrrev_b32 v36, 6, v36
  v_lshlrev_b32 v36, 8, v36
  v_med3_u32 v37, v117, 0, 3
  v_lshl_add_u32 v36, v37, 4, v36
  s_mov_b32 s22, 88600576
  s_mov_b32 s30, 0
va_bw_11:
  buffer_load_dwordx4 v[40:43], v36, s[8:11], s22 offen sc1
  s_waitcnt vmcnt(0)
  v_cmp_ne_u64 vcc, s[88:89], v[40:41]
  s_cbranch_vccnz va_bw_11_no
  v_cmp_ne_u64 vcc, s[88:89], v[42:43]
  s_cbranch_vccnz va_bw_11_no
  s_branch va_bw_11_ok
va_bw_11_no:
  s_sleep 2
  s_add_u32 s30, s30, 1
  s_cmp_lt_u32 s30, 50000
  s_cbranch_scc1 va_bw_11
  s_branch cA_abort
va_bw_11_ok:
  s_add_u32 s22, s31, 0
  buffer_load_dwordx4 a[0:3], v2, s[8:11], s22 offen offset:0 sc1
  buffer_load_dwordx4 a[4:7], v2, s[8:11], s22 offen offset:1024 sc1
  buffer_load_dwordx4 a[8:11], v2, s[8:11], s22 offen offset:2048 sc1
  buffer_load_dwordx4 a[12:15], v2, s[8:11], s22 offen offset:3072 sc1
  s_add_u32 s22, s31, 4096
  buffer_load_dwordx4 a[16:19], v2, s[8:11], s22 offen offset:0 sc1
  buffer_load_dwordx4 a[20:23], v2, s[8:11], s22 offen offset:1024 sc1
  buffer_load_dwordx4 a[24:27], v2, s[8:11], s22 offen offset:2048 sc1
  buffer_load_dwordx4 a[28:31], v2, s[8:11], s22 offen offset:3072 sc1
  s_add_u32 s22, s31, 8192
  buffer_load_dwordx4 a[32:35], v2, s[8:11], s22 offen offset:0 sc1
  buffer_load_dwordx4 a[36:39], v2, s[8:11], s22 offen offset:1024 sc1
  buffer_load_dwordx4 a[40:43], v2, s[8:11], s22 offen offset:2048 sc1
  buffer_load_dwordx4 a[44:47], v2, s[8:11], s22 offen offset:3072 sc1
  s_add_u32 s22, s31, 12288
  buffer_load_dwordx4 a[48:51], v2, s[8:11], s22 offen offset:0 sc1
  buffer_load_dwordx4 a[52:55], v2, s[8:11], s22 offen offset:1024 sc1
  buffer_load_dwordx4 a[56:59], v2, s[8:11], s22 offen offset:2048 sc1
  buffer_load_dwordx4 a[60:63], v2, s[8:11], s22 offen offset:3072 sc1
  s_add_u32 s22, s31, 16384
  buffer_load_dwordx4 a[64:67], v2, s[8:11], s22 offen offset:0 sc1
  buffer_load_dwordx4 a[68:71], v2, s[8:11], s22 offen offset:1024 sc1
  buffer_load_dwordx4 a[72:75], v2, s[8:11], s22 offen offset:2048 sc1
  buffer_load_dwordx4 a[76:79], v2, s[8:11], s22 offen offset:3072 sc1
  s_add_u32 s22, s31, 20480
  buffer_load_dwordx4 a[80:83], v2, s[8:11], s22 offen offset:0 sc1
  buffer_load_dwordx4 a[84:87], v2, s[8:11], s22 offen offset:1024 sc1
  buffer_load_dwordx4 a[88:91], v2, s[8:11], s22 offen offset:2048 sc1
  buffer_load_dwordx4 a[92:95], v2, s[8:11], s22 offen offset:3072 sc1
  s_add_u32 s22, s31, 24576
  buffer_load_dwordx4 a[96:99], v2, s[8:11], s22 offen offset:0 sc1
  buffer_load_dwordx4 a[100:103], v2, s[8:11], s22 offen offset:1024 sc1
  buffer_load_dwordx4 a[104:107], v2, s[8:11], s22 offen offset:2048 sc1
  buffer_load_dwordx4 a[108:111], v2, s[8:11], s22 offen offset:3072 sc1
  s_add_u32 s22, s31, 28672
  buffer_load_dwordx4 a[112:115], v2, s[8:11], s22 offen offset:0 sc1
  buffer_load_dwordx4 a[116:119], v2, s[8:11], s22 offen offset:1024 sc1
  buffer_load_dwordx4 a[120:123], v2, s[8:11], s22 offen offset:2048 sc1
  buffer_load_dwordx4 a[124:127], v2, s[8:11], s22 offen offset:3072 sc1
  s_waitcnt vmcnt(24)
  s_add_u32 s22, s31, 32768
  buffer_load_dwordx4 a[128:131], v2, s[8:11], s22 offen offset:0 sc1
  buffer_load_dwordx4 a[132:135], v2, s[8:11], s22 offen offset:1024 sc1
  buffer_load_dwordx4 a[136:139], v2, s[8:11], s22 offen offset:2048 sc1
  buffer_load_dwordx4 a[140:143], v2, s[8:11], s22 offen offset:3072 sc1
  s_add_u32 s22, s31, 36864
  buffer_load_dwordx4 a[144:147], v2, s[8:11], s22 offen offset:0 sc1
  buffer_load_dwordx4 a[148:151], v2, s[8:11], s22 offen offset:1024 sc1
  buffer_load_dwordx4 a[152:155], v2, s[8:11], s22 offen offset:2048 sc1
  buffer_load_dwordx4 a[156:159], v2, s[8:11], s22 offen offset:3072 sc1
  s_add_u32 s22, s31, 40960
  buffer_load_dwordx4 a[160:163], v2, s[8:11], s22 offen offset:0 sc1
  buffer_load_dwordx4 a[164:167], v2, s[8:11], s22 offen offset:1024 sc1
  buffer_load_dwordx4 a[168:171], v2, s[8:11], s22 offen offset:2048 sc1
  buffer_load_dwordx4 a[172:175], v2, s[8:11], s22 offen offset:3072 sc1
  s_add_u32 s22, s31, 45056
  buffer_load_dwordx4 a[176:179], v2, s[8:11], s22 offen offset:0 sc1
  buffer_load_dwordx4 a[180:183], v2, s[8:11], s22 offen offset:1024 sc1
  buffer_load_dwordx4 a[184:187], v2, s[8:11], s22 offen offset:2048 sc1
  buffer_load_dwordx4 a[188:191], v2, s[8:11], s22 offen offset:3072 sc1
  s_add_u32 s22, s31, 49152
  buffer_load_dwordx4 a[192:195], v2, s[8:11], s22 offen offset:0 sc1
  buffer_load_dwordx4 a[196:199], v2, s[8:11], s22 offen offset:1024 sc1
  buffer_load_dwordx4 a[200:203], v2, s[8:11], s22 offen offset:2048 sc1
  buffer_load_dwordx4 a[204:207], v2, s[8:11], s22 offen offset:3072 sc1
  s_add_u32 s22, s31, 53248
  buffer_load_dwordx4 a[208:211], v2, s[8:11], s22 offen offset:0 sc1
  buffer_load_dwordx4 a[212:215], v2, s[8:11], s22 offen offset:1024 sc1
  buffer_load_dwordx4 a[216:219], v2, s[8:11], s22 offen offset:2048 sc1
  buffer_load_dwordx4 a[220:223], v2, s[8:11], s22 offen offset:3072 sc1
  s_add_u32 s22, s31, 57344
  buffer_load_dwordx4 a[224:227], v2, s[8:11], s22 offen offset:0 sc1
  buffer_load_dwordx4 a[228:231], v2, s[8:11], s22 offen offset:1024 sc1
  buffer_load_dwordx4 a[232:235], v2, s[8:11], s22 offen offset:2048 sc1
  buffer_load_dwordx4 a[236:239], v2, s[8:11], s22 offen offset:3072 sc1
  s_add_u32 s22, s31, 61440
  buffer_load_dwordx4 a[240:243], v2, s[8:11], s22 offen offset:0 sc1
  buffer_load_dwordx4 a[244:247], v2, s[8:11], s22 offen offset:1024 sc1
  buffer_load_dwordx4 a[248:251], v2, s[8:11], s22 offen offset:2048 sc1
  buffer_load_dwordx4 a[252:255], v2, s[8:11], s22 offen offset:3072 sc1
  s_waitcnt vmcnt(24)
  s_add_u32 s22, s31, 65536
  buffer_load_dwordx4 v[176:179], v2, s[8:11], s22 offen offset:0 sc1
  buffer_load_dwordx4 v[180:183], v2, s[8:11], s22 offen offset:1024 sc1
  buffer_load_dwordx4 v[184:187], v2, s[8:11], s22 offen offset:2048 sc1
  buffer_load_dwordx4 v[188:191], v2, s[8:11], s22 offen offset:3072 sc1
  s_add_u32 s22, s31, 69632
  buffer_load_dwordx4 v[192:195], v2, s[8:11], s22 offen offset:0 sc1
  buffer_load_dwordx4 v[196:199], v2, s[8:11], s22 offen offset:1024 sc1
  buffer_load_dwordx4 v[200:203], v2, s[8:11], s22 offen offset:2048 sc1
  buffer_load_dwordx4 v[204:207], v2, s[8:11], s22 offen offset:3072 sc1
  s_add_u32 s22, s31, 73728
  buffer_load_dwordx4 v[208:211], v2, s[8:11], s22 offen offset:0 sc1
  buffer_load_dwordx4 v[212:215], v2, s[8:11], s22 offen offset:1024 sc1
  buffer_load_dwordx4 v[216:219], v2, s[8:11], s22 offen offset:2048 sc1
  buffer_load_dwordx4 v[220:223], v2, s[8:11], s22 offen offset:3072 sc1
  s_add_u32 s22, s31, 77824
  buffer_load_dwordx4 v[224:227], v2, s[8:11], s22 offen offset:0 sc1
  buffer_load_dwordx4 v[228:231], v2, s[8:11], s22 offen offset:1024 sc1
  buffer_load_dwordx4 v[232:235], v2, s[8:11], s22 offen offset:2048 sc1
  buffer_load_dwordx4 v[236:239], v2, s[8:11], s22 offen offset:3072 sc1
  s_add_u32 s22, s31, 81920
  buffer_load_dwordx4 v[240:243], v2, s[8:11], s22 offen offset:0 sc1
  buffer_load_dwordx4 v[244:247], v2, s[8:11], s22 offen offset:1024 sc1
  buffer_load_dwordx4 v[248:251], v2, s[8:11], s22 offen offset:2048 sc1
  buffer_load_dwordx4 v[252:255], v2, s[8:11], s22 offen offset:3072 sc1
  s_mul_i32 s22, s17, 12
  s_add_u32 s23, s22, 267
  s_add_u32 s22, s22, 256
  v_mov_b32 v36, s23
  v_mov_b32 v37, s22
  v_cmp_eq_u32 vcc, 1, v116
  s_lshl_b32 s22, s17, 4
  s_nop 0
  v_cndmask_b32 v36, v36, v37, vcc
  v_mov_b32 v37, s22
  v_cmp_eq_u32 vcc, 0, v116
  s_nop 1
  v_cndmask_b32 v36, v36, v37, vcc
  v_lshrrev_b32 v36, 6, v36
  v_lshlrev_b32 v36, 8, v36
  v_med3_u32 v37, v117, 10, 11
  v_lshl_add_u32 v36, v37, 4, v36
  s_mov_b32 s22, 88600576
  s_mov_b32 s30, 0
va_bw_12:
  buffer_load_dwordx4 v[40:43], v36, s[8:11], s22 offen sc1
  s_waitcnt vmcnt(0)
  v_cmp_ne_u64 vcc, s[88:89], v[40:41]
  s_cbranch_vccnz va_bw_12_no
  v_cmp_ne_u64 vcc, s[88:89], v[42:43]
  s_cbranch_vccnz va_bw_12_no
  s_branch va_bw_12_ok
va_bw_12_no:
  s_sleep 2
  s_add_u32 s30, s30, 1
  s_cmp_lt_u32 s30, 50000
  s_cbranch_scc1 va_bw_12
  s_branch cA_abort
va_bw_12_ok:
  s_mov_b32 m0, 16384
  s_add_u32 s22, s31, 272384
  buffer_load_dwordx4 v2, s[8:11], s22 offen offset:0 sc1 lds
  buffer_load_dwordx4 v2, s[8:11], s22 offen offset:1024 sc1 lds
  buffer_load_dwordx4 v2, s[8:11], s22 offen offset:2048 sc1 lds
  buffer_load_dwordx4 v2, s[8:11], s22 offen offset:3072 sc1 lds
  s_mov_b32 m0, 20480
  s_add_u32 s22, s31, 276480
  buffer_load_dwordx4 v2, s[8:11], s22 offen offset:0 sc1 lds
  buffer_load_dwordx4 v2, s[8:11], s22 offen offset:1024 sc1 lds
  buffer_load_dwordx4 v2, s[8:11], s22 offen offset:2048 sc1 lds
  buffer_load_dwordx4 v2, s[8:11], s22 offen offset:3072 sc1 lds
  s_mov_b32 m0, 24576
  s_add_u32 s22, s31, 280576
  buffer_load_dwordx4 v2, s[8:11], s22 offen offset:0 sc1 lds
  buffer_load_dwordx4 v2, s[8:11], s22 offen offset:1024 sc1 lds
  buffer_load_dwordx4 v2, s[8:11], s22 offen offset:2048 sc1 lds
  buffer_load_dwordx4 v2, s[8:11], s22 offen offset:3072 sc1 lds
  s_mov_b32 m0, 28672
  s_add_u32 s22, s31, 284672
  buffer_load_dwordx4 v2, s[8:11], s22 offen offset:0 sc1 lds
  buffer_load_dwordx4 v2, s[8:11], s22 offen offset:1024 sc1 lds
  v_mov_b32 v72, v116
  v_mov_b32 v73, v117
  v_lshrrev_b32 v65, 1, v72
  v_and_b32 v66, 1, v72
  v_add_u32 v67, 0, v65
  v_lshl_add_u32 v67, v67, 4, v73
  v_mul_u32_u24 v68, 2341, v67
  v_lshrrev_b32 v68, 16, v68
  v_mul_u32_u24 v69, 28, v68
  v_sub_u32 v69, v67, v69
  v_lshrrev_b32 v70, 4, v69
  v_and_b32 v69, 15, v69
  v_and_b32 v71, 1, v69
  v_lshrrev_b32 v69, 1, v69
  v_lshl_add_u32 v69, v71, 3, v69
  v_lshlrev_b32 v71, 12, v70
  v_lshrrev_b32 v70, 1, v68
  v_lshl_add_u32 v71, v70, 9, v71
  v_and_b32 v70, 1, v68
  v_lshl_add_u32 v71, v70, 2, v71
  v_lshl_add_u32 v71, v69, 4, v71
  v_lshl_add_u32 v60, v66, 8, v71
  v_add_u32 v67, 2, v65
  v_lshl_add_u32 v67, v67, 4, v73
  v_mul_u32_u24 v68, 2341, v67
  v_lshrrev_b32 v68, 16, v68
  v_mul_u32_u24 v69, 28, v68
  v_sub_u32 v69, v67, v69
  v_lshrrev_b32 v70, 4, v69
  v_and_b32 v69, 15, v69
  v_and_b32 v71, 1, v69
  v_lshrrev_b32 v69, 1, v69
  v_lshl_add_u32 v69, v71, 3, v69
  v_lshlrev_b32 v71, 12, v70
  v_lshrrev_b32 v70, 1, v68
  v_lshl_add_u32 v71, v70, 9, v71
  v_and_b32 v70, 1, v68
  v_lshl_add_u32 v71, v70, 2, v71
  v_lshl_add_u32 v71, v69, 4, v71
  v_lshl_add_u32 v61, v66, 8, v71
  v_add_u32 v67, 4, v65
  v_lshl_add_u32 v67, v67, 4, v73
  v_mul_u32_u24 v68, 2341, v67
  v_lshrrev_b32 v68, 16, v68
  v_mul_u32_u24 v69, 28, v68
  v_sub_u32 v69, v67, v69
  v_lshrrev_b32 v70, 4, v69
  v_and_b32 v69, 15, v69
  v_and_b32 v71, 1, v69
  v_lshrrev_b32 v69, 1, v69
  v_lshl_add_u32 v69, v71, 3, v69
  v_lshlrev_b32 v71, 12, v70
  v_lshrrev_b32 v70, 1, v68
  v_lshl_add_u32 v71, v70, 9, v71
  v_and_b32 v70, 1, v68
  v_lshl_add_u32 v71, v70, 2, v71
  v_lshl_add_u32 v71, v69, 4, v71
  v_lshl_add_u32 v62, v66, 8, v71
  v_and_b32 v0, 31, v1
  v_lshlrev_b32 v0, 2, v0
  v_add_u32 v0, 18432, v0
  v_lshlrev_b32 v4, 2, v73
  s_and_b32 s22, s17, 3
  s_lshl_b32 s22, s22, 7
  s_add_u32 s22, s22, 17408
  v_add_u32 v4, s22, v4
  v_and_b32 v64, 7, v73
  v_lshlrev_b32 v5, 4, v64
  v_lshl_add_u32 v5, v72, 7, v5
  v_lshrrev_b32 v65, 3, v73
  v_lshl_add_u32 v5, v65, 9, v5
  s_lshl_b32 s22, s17, 3
  s_add_u32 s22, s22, 18432
  v_lshl_add_u32 v7, v2, 3, s22
  v_add_u32 v65, 0, v73
  v_min_u32 v65, 27, v65
  v_mad_u32_u24 v65, v72, 28, v65
  v_lshlrev_b32 v6, 4, v65
  s_lshr_b32 s22, s17, 1
  s_mul_i32 s22, s22, 7
  s_and_b32 s34, s17, 1
  s_lshl_b32 s35, s34, 2
  v_add_u32 v70, s35, v72
  v_mov_b32 v71, s34
  v_mov_b32 v69, 0
  v_cmp_eq_u32 vcc, 3, v72
  s_nop 1
  v_cndmask_b32 v70, v70, v72, vcc
  v_cndmask_b32 v69, v69, v71, vcc
  v_add_u32 v70, s22, v70
  v_lshrrev_b32 v68, 1, v70
  v_lshlrev_b32 v68, 8, v68
  v_lshl_add_u32 v68, v69, 7, v68
  v_and_b32 v69, 1, v70
  v_lshl_add_u32 v68, v69, 3, v68
  v_lshl_add_u32 v1, v64, 4, v68
  v_cmp_gt_u32 s[26:27], 8, v73
  v_lshrrev_b32 v65, 3, v73
  v_lshl_add_u32 v66, v64, 1, v65
  v_add_u32 v66, 0, v66
  v_min_u32 v66, 27, v66
  v_mad_u32_u24 v66, v72, 28, v66
  v_lshlrev_b32 v6, 4, v66
  s_mul_i32 s22, s17, 16
  s_add_u32 s22, s22, 0
  v_lshl_add_u32 v70, v64, 1, s22
  v_lshrrev_b32 v68, 4, v70
  v_lshlrev_b32 v68, 8, v68
  v_bfe_u32 v69, v70, 1, 1
  v_lshl_add_u32 v68, v69, 7, v68
  v_bfe_u32 v69, v70, 2, 2
  v_lshl_add_u32 v68, v69, 2, v68
  v_and_b32 v69, 1, v72
  v_lshl_add_u32 v65, v69, 2, v65
  v_lshrrev_b32 v69, 1, v72
  v_lshl_add_u32 v65, v69, 1, v65
  v_lshrrev_b32 v65, 3, v73
  v_lshl_add_u32 v65, v72, 1, v65
  v_lshrrev_b32 v5, 1, v72
  v_lshlrev_b32 v5, 9, v5
  v_lshrrev_b32 v69, 2, v73
  v_lshl_add_u32 v5, v69, 7, v5
  v_and_b32 v69, 1, v72
  v_lshl_add_u32 v5, v69, 6, v5
  v_and_b32 v69, 3, v73
  v_lshl_add_u32 v5, v69, 4, v5
  v_and_b32 v69, 1, v73
  v_mul_u32_u24 v69, 0xaaaa, v69
  v_add_u32 v0, 0x4444, v69
  v_lshl_add_u32 v1, v65, 4, v68
  v_cmp_gt_u32 s[26:27], 6, v64
  v_mov_b32 v156, 0
  v_mov_b32 v157, 0
  v_mov_b32 v158, 0
  v_mov_b32 v159, 0
  ds_write_b128 v2, v[156:159] offset:0
  ds_write_b128 v2, v[156:159] offset:1024
  ds_write_b128 v2, v[156:159] offset:2048
  ds_write_b128 v2, v[156:159] offset:3072
  s_mul_i32 s22, s17, 1835008
  s_add_u32 s25, s22, 42205184
  s_lshl_b32 s35, s17, 7
  s_add_u32 s35, s35, 88539136
  s_add_u32 s39, s35, 16384
  s_mov_b32 s38, 0
  v_mov_b32 v63, 0
  s_lshl_b32 s22, 0, 11
  s_add_u32 s22, s22, 88602624
  v_add_u32 v36, 1024, v2
  v_min_u32 v36, 1776, v36
  s_mov_b32 s30, 0
va_iw4:
  buffer_load_dwordx4 v[40:43], v2, s[8:11], s22 offen sc1
  buffer_load_dwordx4 v[44:47], v36, s[8:11], s22 offen sc1
  s_waitcnt vmcnt(0)
  v_cmp_ne_u64 vcc, s[88:89], v[40:41]
  s_cbranch_vccnz va_iw4_no
  v_cmp_ne_u64 vcc, s[88:89], v[42:43]
  s_cbranch_vccnz va_iw4_no
  v_cmp_ne_u64 vcc, s[88:89], v[44:45]
  s_cbranch_vccnz va_iw4_no
  v_cmp_ne_u64 vcc, s[88:89], v[46:47]
  s_cbranch_vccnz va_iw4_no
  s_branch va_iw4_ok
va_iw4_no:
  s_sleep 2
  s_add_u32 s30, s30, 1
  s_cmp_lt_u32 s30, 50000
  s_cbranch_scc1 va_iw4
  s_branch cA_abort
va_iw4_ok:
  s_mov_b32 s30, 0
  v_mov_b32 v36, 0
ch_md4:
  buffer_load_dword v37, v36, s[12:15], 0 offen sc1
  s_waitcnt vmcnt(0)
  v_readfirstlane_b32 s22, v37
  s_and_b32 s31, s22, 0xffff
  s_cmp_ge_u32 s31, 32
  s_cbranch_scc1 ch_go4
  s_sleep 2
  s_add_u32 s30, s30, 1
  s_cmp_lt_u32 s30, 50000
  s_cbranch_scc1 ch_md4
  s_branch ch_end
ch_go4:
  s_mov_b32 s31, 0
  v_mov_b32 v36, 0
  v_mov_b32 v37, 0
  v_mov_b32 v38, 0
  v_mov_b32 v39, 0
  v_mov_b32 v40, 0
  v_mov_b32 v41, 0
  v_mov_b32 v42, 0
  v_mov_b32 v43, 0
  v_mov_b32 v44, 0
  v_mov_b32 v45, 0
  v_mov_b32 v46, 0
  v_mov_b32 v47, 0
  v_mov_b32 v48, 0
  v_mov_b32 v49, 0
  v_mov_b32 v50, 0
  v_mov_b32 v51, 0
  v_mov_b32 v52, 0
  v_mov_b32 v53, 0
  v_mov_b32 v54, 0
  v_mov_b32 v55, 0
  v_mov_b32 v56, 0
  v_mov_b32 v57, 0
  v_mov_b32 v58, 0
  v_mov_b32 v59, 0
  s_lshr_b32 s22, s22, 16
  s_cmp_lg_u32 s22, 0
  s_cbranch_scc1 cB_va0_loop
  s_branch cA_va0_loop
ch_init5:
  s_mul_i32 s31, s17, 401408
  s_add_u32 s31, s31, 6422528
  s_mul_i32 s22, s17, 12
  s_add_u32 s23, s22, 267
  s_add_u32 s22, s22, 256
  v_mov_b32 v36, s23
  v_mov_b32 v37, s22
  v_cmp_eq_u32 vcc, 1, v116
  s_lshl_b32 s22, s17, 4
  s_nop 0
  v_cndmask_b32 v36, v36, v37, vcc
  v_mov_b32 v37, s22
  v_cmp_eq_u32 vcc, 0, v116
  s_nop 1
  v_cndmask_b32 v36, v36, v37, vcc
  v_lshrrev_b32 v36, 6, v36
  v_lshlrev_b32 v36, 8, v36
  v_med3_u32 v37, v117, 3, 6
  v_lshl_add_u32 v36, v37, 4, v36
  s_mov_b32 s22, 88600576
  s_mov_b32 s30, 0
va_bw_13:
  buffer_load_dwordx4 v[40:43], v36, s[8:11], s22 offen sc1
  s_waitcnt vmcnt(0)
  v_cmp_ne_u64 vcc, s[88:89], v[40:41]
  s_cbranch_vccnz va_bw_13_no
  v_cmp_ne_u64 vcc, s[88:89], v[42:43]
  s_cbranch_vccnz va_bw_13_no
  s_branch va_bw_13_ok
va_bw_13_no:
  s_sleep 2
  s_add_u32 s30, s30, 1
  s_cmp_lt_u32 s30, 50000
  s_cbranch_scc1 va_bw_13
  s_branch cA_abort
va_bw_13_ok:
  s_add_u32 s22, s31, 86016
  buffer_load_dwordx4 a[0:3], v2, s[8:11], s22 offen offset:0 sc1
  buffer_load_dwordx4 a[4:7], v2, s[8:11], s22 offen offset:1024 sc1
  buffer_load_dwordx4 a[8:11], v2, s[8:11], s22 offen offset:2048 sc1
  buffer_load_dwordx4 a[12:15], v2, s[8:11], s22 offen offset:3072 sc1
  s_add_u32 s22, s31, 90112
  buffer_load_dwordx4 a[16:19], v2, s[8:11], s22 offen offset:0 sc1
  buffer_load_dwordx4 a[20:23], v2, s[8:11], s22 offen offset:1024 sc1
  buffer_load_dwordx4 a[24:27], v2, s[8:11], s22 offen offset:2048 sc1
  buffer_load_dwordx4 a[28:31], v2, s[8:11], s22 offen offset:3072 sc1
  s_add_u32 s22, s31, 94208
  buffer_load_dwordx4 a[32:35], v2, s[8:11], s22 offen offset:0 sc1
  buffer_load_dwordx4 a[36:39], v2, s[8:11], s22 offen offset:1024 sc1
  buffer_load_dwordx4 a[40:43], v2, s[8:11], s22 offen offset:2048 sc1
  buffer_load_dwordx4 a[44:47], v2, s[8:11], s22 offen offset:3072 sc1
  s_add_u32 s22, s31, 98304
  buffer_load_dwordx4 a[48:51], v2, s[8:11], s22 offen offset:0 sc1
  buffer_load_dwordx4 a[52:55], v2, s[8:11], s22 offen offset:1024 sc1
  buffer_load_dwordx4 a[56:59], v2, s[8:11], s22 offen offset:2048 sc1
  buffer_load_dwordx4 a[60:63], v2, s[8:11], s22 offen offset:3072 sc1
  s_add_u32 s22, s31, 102400
  buffer_load_dwordx4 a[64:67], v2, s[8:11], s22 offen offset:0 sc1
  buffer_load_dwordx4 a[68:71], v2, s[8:11], s22 offen offset:1024 sc1
  buffer_load_dwordx4 a[72:75], v2, s[8:11], s22 offen offset:2048 sc1
  buffer_load_dwordx4 a[76:79], v2, s[8:11], s22 offen offset:3072 sc1
  s_add_u32 s22, s31, 106496
  buffer_load_dwordx4 a[80:83], v2, s[8:11], s22 offen offset:0 sc1
  buffer_load_dwordx4 a[84:87], v2, s[8:11], s22 offen offset:1024 sc1
  buffer_load_dwordx4 a[88:91], v2, s[8:11], s22 offen offset:2048 sc1
  buffer_load_dwordx4 a[92:95], v2, s[8:11], s22 offen offset:3072 sc1
  s_add_u32 s22, s31, 110592
  buffer_load_dwordx4 a[96:99], v2, s[8:11], s22 offen offset:0 sc1
  buffer_load_dwordx4 a[100:103], v2, s[8:11], s22 offen offset:1024 sc1
  buffer_load_dwordx4 a[104:107], v2, s[8:11], s22 offen offset:2048 sc1
  buffer_load_dwordx4 a[108:111], v2, s[8:11], s22 offen offset:3072 sc1
  s_add_u32 s22, s31, 114688
  buffer_load_dwordx4 a[112:115], v2, s[8:11], s22 offen offset:0 sc1
  buffer_load_dwordx4 a[116:119], v2, s[8:11], s22 offen offset:1024 sc1
  buffer_load_dwordx4 a[120:123], v2, s[8:11], s22 offen offset:2048 sc1
  buffer_load_dwordx4 a[124:127], v2, s[8:11], s22 offen offset:3072 sc1
  s_waitcnt vmcnt(24)
  s_add_u32 s22, s31, 118784
  buffer_load_dwordx4 a[128:131], v2, s[8:11], s22 offen offset:0 sc1
  buffer_load_dwordx4 a[132:135], v2, s[8:11], s22 offen offset:1024 sc1
  buffer_load_dwordx4 a[136:139], v2, s[8:11], s22 offen offset:2048 sc1
  buffer_load_dwordx4 a[140:143], v2, s[8:11], s22 offen offset:3072 sc1
  s_add_u32 s22, s31, 122880
  buffer_load_dwordx4 a[144:147], v2, s[8:11], s22 offen offset:0 sc1
  buffer_load_dwordx4 a[148:151], v2, s[8:11], s22 offen offset:1024 sc1
  buffer_load_dwordx4 a[152:155], v2, s[8:11], s22 offen offset:2048 sc1
  buffer_load_dwordx4 a[156:159], v2, s[8:11], s22 offen offset:3072 sc1
  s_add_u32 s22, s31, 126976
  buffer_load_dwordx4 a[160:163], v2, s[8:11], s22 offen offset:0 sc1
  buffer_load_dwordx4 a[164:167], v2, s[8:11], s22 offen offset:1024 sc1
  buffer_load_dwordx4 a[168:171], v2, s[8:11], s22 offen offset:2048 sc1
  buffer_load_dwordx4 a[172:175], v2, s[8:11], s22 offen offset:3072 sc1
  s_add_u32 s22, s31, 131072
  buffer_load_dwordx4 a[176:179], v2, s[8:11], s22 offen offset:0 sc1
  buffer_load_dwordx4 a[180:183], v2, s[8:11], s22 offen offset:1024 sc1
  buffer_load_dwordx4 a[184:187], v2, s[8:11], s22 offen offset:2048 sc1
  buffer_load_dwordx4 a[188:191], v2, s[8:11], s22 offen offset:3072 sc1
  s_add_u32 s22, s31, 135168
  buffer_load_dwordx4 a[192:195], v2, s[8:11], s22 offen offset:0 sc1
  buffer_load_dwordx4 a[196:199], v2, s[8:11], s22 offen offset:1024 sc1
  buffer_load_dwordx4 a[200:203], v2, s[8:11], s22 offen offset:2048 sc1
  buffer_load_dwordx4 a[204:207], v2, s[8:11], s22 offen offset:3072 sc1
  s_add_u32 s22, s31, 139264
  buffer_load_dwordx4 a[208:211], v2, s[8:11], s22 offen offset:0 sc1
  buffer_load_dwordx4 a[212:215], v2, s[8:11], s22 offen offset:1024 sc1
  buffer_load_dwordx4 a[216:219], v2, s[8:11], s22 offen offset:2048 sc1
  buffer_load_dwordx4 a[220:223], v2, s[8:11], s22 offen offset:3072 sc1
  s_add_u32 s22, s31, 143360
  buffer_load_dwordx4 a[224:227], v2, s[8:11], s22 offen offset:0 sc1
  buffer_load_dwordx4 a[228:231], v2, s[8:11], s22 offen offset:1024 sc1
  buffer_load_dwordx4 a[232:235], v2, s[8:11], s22 offen offset:2048 sc1
  buffer_load_dwordx4 a[236:239], v2, s[8:11], s22 offen offset:3072 sc1
  s_add_u32 s22, s31, 147456
  buffer_load_dwordx4 a[240:243], v2, s[8:11], s22 offen offset:0 sc1
  buffer_load_dwordx4 a[244:247], v2, s[8:11], s22 offen offset:1024 sc1
  buffer_load_dwordx4 a[248:251], v2, s[8:11], s22 offen offset:2048 sc1
  buffer_load_dwordx4 a[252:255], v2, s[8:11], s22 offen offset:3072 sc1
  s_waitcnt vmcnt(24)
  s_add_u32 s22, s31, 151552
  buffer_load_dwordx4 v[176:179], v2, s[8:11], s22 offen offset:0 sc1
  buffer_load_dwordx4 v[180:183], v2, s[8:11], s22 offen offset:1024 sc1
  buffer_load_dwordx4 v[184:187], v2, s[8:11], s22 offen offset:2048 sc1
  buffer_load_dwordx4 v[188:191], v2, s[8:11], s22 offen offset:3072 sc1
  s_add_u32 s22, s31, 155648
  buffer_load_dwordx4 v[192:195], v2, s[8:11], s22 offen offset:0 sc1
  buffer_load_dwordx4 v[196:199], v2, s[8:11], s22 offen offset:1024 sc1
  buffer_load_dwordx4 v[200:203], v2, s[8:11], s22 offen offset:2048 sc1
  buffer_load_dwordx4 v[204:207], v2, s[8:11], s22 offen offset:3072 sc1
  s_add_u32 s22, s31, 159744
  buffer_load_dwordx4 v[208:211], v2, s[8:11], s22 offen offset:0 sc1
  buffer_load_dwordx4 v[212:215], v2, s[8:11], s22 offen offset:1024 sc1
  buffer_load_dwordx4 v[216:219], v2, s[8:11], s22 offen offset:2048 sc1
  buffer_load_dwordx4 v[220:223], v2, s[8:11], s22 offen offset:3072 sc1
  s_add_u32 s22, s31, 163840
  buffer_load_dwordx4 v[224:227], v2, s[8:11], s22 offen offset:0 sc1
  buffer_load_dwordx4 v[228:231], v2, s[8:11], s22 offen offset:1024 sc1
  buffer_load_dwordx4 v[232:235], v2, s[8:11], s22 offen offset:2048 sc1
  buffer_load_dwordx4 v[236:239], v2, s[8:11], s22 offen offset:3072 sc1
  s_add_u32 s22, s31, 167936
  buffer_load_dwordx4 v[240:243], v2, s[8:11], s22 offen offset:0 sc1
  buffer_load_dwordx4 v[244:247], v2, s[8:11], s22 offen offset:1024 sc1
  buffer_load_dwordx4 v[248:251], v2, s[8:11], s22 offen offset:2048 sc1
  buffer_load_dwordx4 v[252:255], v2, s[8:11], s22 offen offset:3072 sc1
  s_mul_i32 s22, s17, 12
  s_add_u32 s23, s22, 267
  s_add_u32 s22, s22, 256
  v_mov_b32 v36, s23
  v_mov_b32 v37, s22
  v_cmp_eq_u32 vcc, 1, v116
  s_lshl_b32 s22, s17, 4
  s_nop 0
  v_cndmask_b32 v36, v36, v37, vcc
  v_mov_b32 v37, s22
  v_cmp_eq_u32 vcc, 0, v116
  s_nop 1
  v_cndmask_b32 v36, v36, v37, vcc
  v_lshrrev_b32 v36, 6, v36
  v_lshlrev_b32 v36, 8, v36
  v_med3_u32 v37, v117, 15, 15
  v_lshl_add_u32 v36, v37, 4, v36
  s_mov_b32 s22, 88600576
  s_mov_b32 s30, 0
va_bw_14:
  buffer_load_dwordx4 v[40:43], v36, s[8:11], s22 offen sc1
  s_waitcnt vmcnt(0)
  v_cmp_ne_u64 vcc, s[88:89], v[40:41]
  s_cbranch_vccnz va_bw_14_no
  v_cmp_ne_u64 vcc, s[88:89], v[42:43]
  s_cbranch_vccnz va_bw_14_no
  s_branch va_bw_14_ok
va_bw_14_no:
  s_sleep 2
  s_add_u32 s30, s30, 1
  s_cmp_lt_u32 s30, 50000
  s_cbranch_scc1 va_bw_14
  s_branch cA_abort
va_bw_14_ok:
  s_mov_b32 m0, 59392
  s_add_u32 s22, s31, 387072
  buffer_load_dwordx4 v2, s[8:11], s22 offen offset:0 sc1 lds
  buffer_load_dwordx4 v2, s[8:11], s22 offen offset:1024 sc1 lds
  buffer_load_dwordx4 v2, s[8:11], s22 offen offset:2048 sc1 lds
  buffer_load_dwordx4 v2, s[8:11], s22 offen offset:3072 sc1 lds
  s_mov_b32 m0, 63488
  s_add_u32 s22, s31, 391168
  buffer_load_dwordx4 v2, s[8:11], s22 offen offset:0 sc1 lds
  buffer_load_dwordx4 v2, s[8:11], s22 offen offset:1024 sc1 lds
  buffer_load_dwordx4 v2, s[8:11], s22 offen offset:2048 sc1 lds
  buffer_load_dwordx4 v2, s[8:11], s22 offen offset:3072 sc1 lds
  s_mov_b32 m0, 67584
  s_add_u32 s22, s31, 395264
  buffer_load_dwordx4 v2, s[8:11], s22 offen offset:0 sc1 lds
  buffer_load_dwordx4 v2, s[8:11], s22 offen offset:1024 sc1 lds
  buffer_load_dwordx4 v2, s[8:11], s22 offen offset:2048 sc1 lds
  buffer_load_dwordx4 v2, s[8:11], s22 offen offset:3072 sc1 lds
  s_mov_b32 m0, 71680
  s_add_u32 s22, s31, 399360
  buffer_load_dwordx4 v2, s[8:11], s22 offen offset:0 sc1 lds
  buffer_load_dwordx4 v2, s[8:11], s22 offen offset:1024 sc1 lds
  v_mov_b32 v72, v116
  v_mov_b32 v73, v117
  v_lshrrev_b32 v65, 1, v72
  v_and_b32 v66, 1, v72
  v_add_u32 v67, 6, v65
  v_lshl_add_u32 v67, v67, 4, v73
  v_mul_u32_u24 v68, 2341, v67
  v_lshrrev_b32 v68, 16, v68
  v_mul_u32_u24 v69, 28, v68
  v_sub_u32 v69, v67, v69
  v_lshrrev_b32 v70, 4, v69
  v_and_b32 v69, 15, v69
  v_and_b32 v71, 1, v69
  v_lshrrev_b32 v69, 1, v69
  v_lshl_add_u32 v69, v71, 3, v69
  v_lshlrev_b32 v71, 12, v70
  v_lshrrev_b32 v70, 1, v68
  v_lshl_add_u32 v71, v70, 9, v71
  v_and_b32 v70, 1, v68
  v_lshl_add_u32 v71, v70, 2, v71
  v_lshl_add_u32 v71, v69, 4, v71
  v_lshl_add_u32 v60, v66, 8, v71
  v_add_u32 v67, 8, v65
  v_lshl_add_u32 v67, v67, 4, v73
  v_mul_u32_u24 v68, 2341, v67
  v_lshrrev_b32 v68, 16, v68
  v_mul_u32_u24 v69, 28, v68
  v_sub_u32 v69, v67, v69
  v_lshrrev_b32 v70, 4, v69
  v_and_b32 v69, 15, v69
  v_and_b32 v71, 1, v69
  v_lshrrev_b32 v69, 1, v69
  v_lshl_add_u32 v69, v71, 3, v69
  v_lshlrev_b32 v71, 12, v70
  v_lshrrev_b32 v70, 1, v68
  v_lshl_add_u32 v71, v70, 9, v71
  v_and_b32 v70, 1, v68
  v_lshl_add_u32 v71, v70, 2, v71
  v_lshl_add_u32 v71, v69, 4, v71
  v_lshl_add_u32 v61, v66, 8, v71
  v_add_u32 v67, 10, v65
  v_lshl_add_u32 v67, v67, 4, v73
  v_mul_u32_u24 v68, 2341, v67
  v_lshrrev_b32 v68, 16, v68
  v_mul_u32_u24 v69, 28, v68
  v_sub_u32 v69, v67, v69
  v_lshrrev_b32 v70, 4, v69
  v_and_b32 v69, 15, v69
  v_and_b32 v71, 1, v69
  v_lshrrev_b32 v69, 1, v69
  v_lshl_add_u32 v69, v71, 3, v69
  v_lshlrev_b32 v71, 12, v70
  v_lshrrev_b32 v70, 1, v68
  v_lshl_add_u32 v71, v70, 9, v71
  v_and_b32 v70, 1, v68
  v_lshl_add_u32 v71, v70, 2, v71
  v_lshl_add_u32 v71, v69, 4, v71
  v_lshl_add_u32 v62, v66, 8, v71
  v_and_b32 v0, 31, v1
  v_lshlrev_b32 v0, 2, v0
  v_add_u32 v0, 18432, v0
  v_lshlrev_b32 v4, 2, v73
  s_and_b32 s22, s17, 3
  s_lshl_b32 s22, s22, 7
  s_add_u32 s22, s22, 17408
  v_add_u32 v4, s22, v4
  v_and_b32 v64, 7, v73
  v_lshlrev_b32 v5, 4, v64
  v_lshl_add_u32 v5, v72, 7, v5
  v_lshrrev_b32 v65, 3, v73
  v_lshl_add_u32 v5, v65, 9, v5
  s_lshl_b32 s22, s17, 3
  s_add_u32 s22, s22, 18436
  v_lshl_add_u32 v7, v2, 3, s22
  v_add_u32 v65, 16, v73
  v_min_u32 v65, 27, v65
  v_mad_u32_u24 v65, v72, 28, v65
  v_lshlrev_b32 v6, 4, v65
  s_lshr_b32 s22, s17, 1
  s_mul_i32 s22, s22, 7
  s_and_b32 s34, s17, 1
  s_lshl_b32 s35, s34, 2
  v_add_u32 v70, s35, v72
  v_mov_b32 v71, s34
  v_mov_b32 v69, 1
  v_cmp_eq_u32 vcc, 3, v72
  s_nop 1
  v_cndmask_b32 v70, v70, v72, vcc
  v_cndmask_b32 v69, v69, v71, vcc
  v_add_u32 v70, s22, v70
  v_lshrrev_b32 v68, 1, v70
  v_lshlrev_b32 v68, 8, v68
  v_lshl_add_u32 v68, v69, 7, v68
  v_and_b32 v69, 1, v70
  v_lshl_add_u32 v68, v69, 3, v68
  v_lshl_add_u32 v1, v64, 4, v68
  v_cmp_gt_u32 s[26:27], 8, v73
  v_cmp_gt_u32 vcc, 3, v72
  s_and_b64 s[26:27], s[26:27], vcc
  v_lshrrev_b32 v65, 3, v73
  v_lshl_add_u32 v66, v64, 1, v65
  v_add_u32 v66, 16, v66
  v_min_u32 v66, 27, v66
  v_mad_u32_u24 v66, v72, 28, v66
  v_lshlrev_b32 v6, 4, v66
  s_mul_i32 s22, s17, 12
  s_add_u32 s22, s22, 256
  v_lshl_add_u32 v70, v64, 1, s22
  v_lshrrev_b32 v68, 4, v70
  v_lshlrev_b32 v68, 8, v68
  v_bfe_u32 v69, v70, 1, 1
  v_lshl_add_u32 v68, v69, 7, v68
  v_bfe_u32 v69, v70, 2, 2
  v_lshl_add_u32 v68, v69, 2, v68
  v_and_b32 v69, 1, v72
  v_lshl_add_u32 v65, v69, 2, v65
  v_lshrrev_b32 v69, 1, v72
  v_lshl_add_u32 v65, v69, 1, v65
  v_lshrrev_b32 v65, 3, v73
  v_lshl_add_u32 v65, v72, 1, v65
  v_lshrrev_b32 v5, 1, v72
  v_lshlrev_b32 v5, 9, v5
  v_lshrrev_b32 v69, 2, v73
  v_lshl_add_u32 v5, v69, 7, v5
  v_and_b32 v69, 1, v72
  v_lshl_add_u32 v5, v69, 6, v5
  v_and_b32 v69, 3, v73
  v_lshl_add_u32 v5, v69, 4, v5
  v_and_b32 v69, 1, v73
  v_mul_u32_u24 v69, 0xaaaa, v69
  v_add_u32 v0, 0x4444, v69
  v_lshl_add_u32 v1, v65, 4, v68
  v_cmp_gt_u32 s[26:27], 6, v64
  v_mov_b32 v156, 0
  v_mov_b32 v157, 0
  v_mov_b32 v158, 0
  v_mov_b32 v159, 0
  ds_write_b128 v2, v[156:159] offset:4096
  ds_write_b128 v2, v[156:159] offset:5120
  ds_write_b128 v2, v[156:159] offset:6144
  ds_write_b128 v2, v[156:159] offset:7168
  s_mul_i32 s22, s17, 1835008
  s_add_u32 s25, s22, 42205184
  s_lshl_b32 s35, s17, 7
  s_add_u32 s35, s35, 88539136
  s_add_u32 s39, s35, 16384
  s_mov_b32 s38, 0
  v_mov_b32 v63, 0
  s_lshl_b32 s22, 0, 11
  s_add_u32 s22, s22, 88602624
  v_add_u32 v36, 1024, v2
  v_min_u32 v36, 1776, v36
  s_mov_b32 s30, 0
va_iw5:
  buffer_load_dwordx4 v[40:43], v2, s[8:11], s22 offen sc1
  buffer_load_dwordx4 v[44:47], v36, s[8:11], s22 offen sc1
  s_waitcnt vmcnt(0)
  v_cmp_ne_u64 vcc, s[88:89], v[40:41]
  s_cbranch_vccnz va_iw5_no
  v_cmp_ne_u64 vcc, s[88:89], v[42:43]
  s_cbranch_vccnz va_iw5_no
  v_cmp_ne_u64 vcc, s[88:89], v[44:45]
  s_cbranch_vccnz va_iw5_no
  v_cmp_ne_u64 vcc, s[88:89], v[46:47]
  s_cbranch_vccnz va_iw5_no
  s_branch va_iw5_ok
va_iw5_no:
  s_sleep 2
  s_add_u32 s30, s30, 1
  s_cmp_lt_u32 s30, 50000
  s_cbranch_scc1 va_iw5
  s_branch cA_abort
va_iw5_ok:
  s_mov_b32 s30, 0
  v_mov_b32 v36, 0
ch_md5:
  buffer_load_dword v37, v36, s[12:15], 0 offen sc1
  s_waitcnt vmcnt(0)
  v_readfirstlane_b32 s22, v37
  s_and_b32 s31, s22, 0xffff
  s_cmp_ge_u32 s31, 32
  s_cbranch_scc1 ch_go5
  s_sleep 2
  s_add_u32 s30, s30, 1
  s_cmp_lt_u32 s30, 50000
  s_cbranch_scc1 ch_md5
  s_branch ch_end
ch_go5:
  s_mov_b32 s31, 0
  v_mov_b32 v36, 0
  v_mov_b32 v37, 0
  v_mov_b32 v38, 0
  v_mov_b32 v39, 0
  v_mov_b32 v40, 0
  v_mov_b32 v41, 0
  v_mov_b32 v42, 0
  v_mov_b32 v43, 0
  v_mov_b32 v44, 0
  v_mov_b32 v45, 0
  v_mov_b32 v46, 0
  v_mov_b32 v47, 0
  v_mov_b32 v48, 0
  v_mov_b32 v49, 0
  v_mov_b32 v50, 0
  v_mov_b32 v51, 0
  v_mov_b32 v52, 0
  v_mov_b32 v53, 0
  v_mov_b32 v54, 0
  v_mov_b32 v55, 0
  v_mov_b32 v56, 0
  v_mov_b32 v57, 0
  v_mov_b32 v58, 0
  v_mov_b32 v59, 0
  s_lshr_b32 s22, s22, 16
  s_cmp_lg_u32 s22, 0
  s_cbranch_scc1 cB_va1_loop
  s_branch cA_va1_loop
ch_init6:
  s_mul_i32 s31, s17, 401408
  s_add_u32 s31, s31, 6422528
  s_mul_i32 s22, s17, 12
  s_add_u32 s23, s22, 267
  s_add_u32 s22, s22, 256
  v_mov_b32 v36, s23
  v_mov_b32 v37, s22
  v_cmp_eq_u32 vcc, 1, v116
  s_lshl_b32 s22, s17, 4
  s_nop 0
  v_cndmask_b32 v36, v36, v37, vcc
  v_mov_b32 v37, s22
  v_cmp_eq_u32 vcc, 0, v116
  s_nop 1
  v_cndmask_b32 v36, v36, v37, vcc
  v_lshrrev_b32 v36, 6, v36
  v_lshlrev_b32 v36, 8, v36
  v_med3_u32 v37, v117, 6, 10
  v_lshl_add_u32 v36, v37, 4, v36
  s_mov_b32 s22, 88600576
  s_mov_b32 s30, 0
va_bw_15:
  buffer_load_dwordx4 v[40:43], v36, s[8:11], s22 offen sc1
  s_waitcnt vmcnt(0)
  v_cmp_ne_u64 vcc, s[88:89], v[40:41]
  s_cbranch_vccnz va_bw_15_no
  v_cmp_ne_u64 vcc, s[88:89], v[42:43]
  s_cbranch_vccnz va_bw_15_no
  s_branch va_bw_15_ok
va_bw_15_no:
  s_sleep 2
  s_add_u32 s30, s30, 1
  s_cmp_lt_u32 s30, 50000
  s_cbranch_scc1 va_bw_15
  s_branch cA_abort
va_bw_15_ok:
  s_add_u32 s22, s31, 172032
  buffer_load_dwordx4 a[0:3], v2, s[8:11], s22 offen offset:0 sc1
  buffer_load_dwordx4 a[4:7], v2, s[8:11], s22 offen offset:1024 sc1
  buffer_load_dwordx4 a[8:11], v2, s[8:11], s22 offen offset:2048 sc1
  buffer_load_dwordx4 a[12:15], v2, s[8:11], s22 offen offset:3072 sc1
  s_add_u32 s22, s31, 176128
  buffer_load_dwordx4 a[16:19], v2, s[8:11], s22 offen offset:0 sc1
  buffer_load_dwordx4 a[20:23], v2, s[8:11], s22 offen offset:1024 sc1
  buffer_load_dwordx4 a[24:27], v2, s[8:11], s22 offen offset:2048 sc1
  buffer_load_dwordx4 a[28:31], v2, s[8:11], s22 offen offset:3072 sc1
  s_add_u32 s22, s31, 180224
  buffer_load_dwordx4 a[32:35], v2, s[8:11], s22 offen offset:0 sc1
  buffer_load_dwordx4 a[36:39], v2, s[8:11], s22 offen offset:1024 sc1
  buffer_load_dwordx4 a[40:43], v2, s[8:11], s22 offen offset:2048 sc1
  buffer_load_dwordx4 a[44:47], v2, s[8:11], s22 offen offset:3072 sc1
  s_add_u32 s22, s31, 184320
  buffer_load_dwordx4 a[48:51], v2, s[8:11], s22 offen offset:0 sc1
  buffer_load_dwordx4 a[52:55], v2, s[8:11], s22 offen offset:1024 sc1
  buffer_load_dwordx4 a[56:59], v2, s[8:11], s22 offen offset:2048 sc1
  buffer_load_dwordx4 a[60:63], v2, s[8:11], s22 offen offset:3072 sc1
  s_add_u32 s22, s31, 188416
  buffer_load_dwordx4 a[64:67], v2, s[8:11], s22 offen offset:0 sc1
  buffer_load_dwordx4 a[68:71], v2, s[8:11], s22 offen offset:1024 sc1
  buffer_load_dwordx4 a[72:75], v2, s[8:11], s22 offen offset:2048 sc1
  buffer_load_dwordx4 a[76:79], v2, s[8:11], s22 offen offset:3072 sc1
  s_add_u32 s22, s31, 192512
  buffer_load_dwordx4 a[80:83], v2, s[8:11], s22 offen offset:0 sc1
  buffer_load_dwordx4 a[84:87], v2, s[8:11], s22 offen offset:1024 sc1
  buffer_load_dwordx4 a[88:91], v2, s[8:11], s22 offen offset:2048 sc1
  buffer_load_dwordx4 a[92:95], v2, s[8:11], s22 offen offset:3072 sc1
  s_add_u32 s22, s31, 196608
  buffer_load_dwordx4 a[96:99], v2, s[8:11], s22 offen offset:0 sc1
  buffer_load_dwordx4 a[100:103], v2, s[8:11], s22 offen offset:1024 sc1
  buffer_load_dwordx4 a[104:107], v2, s[8:11], s22 offen offset:2048 sc1
  buffer_load_dwordx4 a[108:111], v2, s[8:11], s22 offen offset:3072 sc1
  s_add_u32 s22, s31, 200704
  buffer_load_dwordx4 a[112:115], v2, s[8:11], s22 offen offset:0 sc1
  buffer_load_dwordx4 a[116:119], v2, s[8:11], s22 offen offset:1024 sc1
  buffer_load_dwordx4 a[120:123], v2, s[8:11], s22 offen offset:2048 sc1
  buffer_load_dwordx4 a[124:127], v2, s[8:11], s22 offen offset:3072 sc1
  s_waitcnt vmcnt(24)
  s_add_u32 s22, s31, 204800
  buffer_load_dwordx4 a[128:131], v2, s[8:11], s22 offen offset:0 sc1
  buffer_load_dwordx4 a[132:135], v2, s[8:11], s22 offen offset:1024 sc1
  buffer_load_dwordx4 a[136:139], v2, s[8:11], s22 offen offset:2048 sc1
  buffer_load_dwordx4 a[140:143], v2, s[8:11], s22 offen offset:3072 sc1
  s_add_u32 s22, s31, 208896
  buffer_load_dwordx4 a[144:147], v2, s[8:11], s22 offen offset:0 sc1
  buffer_load_dwordx4 a[148:151], v2, s[8:11], s22 offen offset:1024 sc1
  buffer_load_dwordx4 a[152:155], v2, s[8:11], s22 offen offset:2048 sc1
  buffer_load_dwordx4 a[156:159], v2, s[8:11], s22 offen offset:3072 sc1
  s_add_u32 s22, s31, 212992
  buffer_load_dwordx4 a[160:163], v2, s[8:11], s22 offen offset:0 sc1
  buffer_load_dwordx4 a[164:167], v2, s[8:11], s22 offen offset:1024 sc1
  buffer_load_dwordx4 a[168:171], v2, s[8:11], s22 offen offset:2048 sc1
  buffer_load_dwordx4 a[172:175], v2, s[8:11], s22 offen offset:3072 sc1
  s_add_u32 s22, s31, 217088
  buffer_load_dwordx4 a[176:179], v2, s[8:11], s22 offen offset:0 sc1
  buffer_load_dwordx4 a[180:183], v2, s[8:11], s22 offen offset:1024 sc1
  buffer_load_dwordx4 a[184:187], v2, s[8:11], s22 offen offset:2048 sc1
  buffer_load_dwordx4 a[188:191], v2, s[8:11], s22 offen offset:3072 sc1
  s_add_u32 s22, s31, 221184
  buffer_load_dwordx4 a[192:195], v2, s[8:11], s22 offen offset:0 sc1
  buffer_load_dwordx4 a[196:199], v2, s[8:11], s22 offen offset:1024 sc1
  buffer_load_dwordx4 a[200:203], v2, s[8:11], s22 offen offset:2048 sc1
  buffer_load_dwordx4 a[204:207], v2, s[8:11], s22 offen offset:3072 sc1
  s_add_u32 s22, s31, 225280
  buffer_load_dwordx4 a[208:211], v2, s[8:11], s22 offen offset:0 sc1
  buffer_load_dwordx4 a[212:215], v2, s[8:11], s22 offen offset:1024 sc1
  buffer_load_dwordx4 a[216:219], v2, s[8:11], s22 offen offset:2048 sc1
  buffer_load_dwordx4 a[220:223], v2, s[8:11], s22 offen offset:3072 sc1
  s_add_u32 s22, s31, 229376
  buffer_load_dwordx4 a[224:227], v2, s[8:11], s22 offen offset:0 sc1
  buffer_load_dwordx4 a[228:231], v2, s[8:11], s22 offen offset:1024 sc1
  buffer_load_dwordx4 a[232:235], v2, s[8:11], s22 offen offset:2048 sc1
  buffer_load_dwordx4 a[236:239], v2, s[8:11], s22 offen offset:3072 sc1
  s_add_u32 s22, s31, 233472
  buffer_load_dwordx4 a[240:243], v2, s[8:11], s22 offen offset:0 sc1
  buffer_load_dwordx4 a[244:247], v2, s[8:11], s22 offen offset:1024 sc1
  buffer_load_dwordx4 a[248:251], v2, s[8:11], s22 offen offset:2048 sc1
  buffer_load_dwordx4 a[252:255], v2, s[8:11], s22 offen offset:3072 sc1
  s_waitcnt vmcnt(24)
  s_add_u32 s22, s31, 237568
  buffer_load_dwordx4 v[120:123], v2, s[8:11], s22 offen offset:0 sc1
  buffer_load_dwordx4 v[124:127], v2, s[8:11], s22 offen offset:1024 sc1
  buffer_load_dwordx4 v[128:131], v2, s[8:11], s22 offen offset:2048 sc1
  buffer_load_dwordx4 v[132:135], v2, s[8:11], s22 offen offset:3072 sc1
  s_add_u32 s22, s31, 241664
  buffer_load_dwordx4 v[136:139], v2, s[8:11], s22 offen offset:0 sc1
  buffer_load_dwordx4 v[140:143], v2, s[8:11], s22 offen offset:1024 sc1
  buffer_load_dwordx4 v[144:147], v2, s[8:11], s22 offen offset:2048 sc1
  buffer_load_dwordx4 v[148:151], v2, s[8:11], s22 offen offset:3072 sc1
  s_add_u32 s22, s31, 245760
  buffer_load_dwordx4 v[152:155], v2, s[8:11], s22 offen offset:0 sc1
  buffer_load_dwordx4 v[156:159], v2, s[8:11], s22 offen offset:1024 sc1
  buffer_load_dwordx4 v[160:163], v2, s[8:11], s22 offen offset:2048 sc1
  buffer_load_dwordx4 v[164:167], v2, s[8:11], s22 offen offset:3072 sc1
  s_add_u32 s22, s31, 249856
  buffer_load_dwordx4 v[168:171], v2, s[8:11], s22 offen offset:0 sc1
  buffer_load_dwordx4 v[172:175], v2, s[8:11], s22 offen offset:1024 sc1
  buffer_load_dwordx4 v[176:179], v2, s[8:11], s22 offen offset:2048 sc1
  buffer_load_dwordx4 v[180:183], v2, s[8:11], s22 offen offset:3072 sc1
  s_add_u32 s22, s31, 253952
  buffer_load_dwordx4 v[184:187], v2, s[8:11], s22 offen offset:0 sc1
  buffer_load_dwordx4 v[188:191], v2, s[8:11], s22 offen offset:1024 sc1
  buffer_load_dwordx4 v[192:195], v2, s[8:11], s22 offen offset:2048 sc1
  buffer_load_dwordx4 v[196:199], v2, s[8:11], s22 offen offset:3072 sc1
  s_add_u32 s22, s31, 258048
  buffer_load_dwordx4 v[200:203], v2, s[8:11], s22 offen offset:0 sc1
  buffer_load_dwordx4 v[204:207], v2, s[8:11], s22 offen offset:1024 sc1
  buffer_load_dwordx4 v[208:211], v2, s[8:11], s22 offen offset:2048 sc1
  buffer_load_dwordx4 v[212:215], v2, s[8:11], s22 offen offset:3072 sc1
  s_add_u32 s22, s31, 262144
  buffer_load_dwordx4 v[216:219], v2, s[8:11], s22 offen offset:0 sc1
  buffer_load_dwordx4 v[220:223], v2, s[8:11], s22 offen offset:1024 sc1
  buffer_load_dwordx4 v[224:227], v2, s[8:11], s22 offen offset:2048 sc1
  buffer_load_dwordx4 v[228:231], v2, s[8:11], s22 offen offset:3072 sc1
  s_add_u32 s22, s31, 266240
  buffer_load_dwordx4 v[232:235], v2, s[8:11], s22 offen offset:0 sc1
  buffer_load_dwordx4 v[236:239], v2, s[8:11], s22 offen offset:1024 sc1
  buffer_load_dwordx4 v[240:243], v2, s[8:11], s22 offen offset:2048 sc1
  buffer_load_dwordx4 v[244:247], v2, s[8:11], s22 offen offset:3072 sc1
  s_waitcnt vmcnt(24)
  s_add_u32 s22, s31, 270336
  buffer_load_dwordx4 v[248:251], v2, s[8:11], s22 offen offset:0 sc1
  buffer_load_dwordx4 v[252:255], v2, s[8:11], s22 offen offset:1024 sc1
  v_mov_b32 v72, v116
  v_mov_b32 v73, v117
  v_lshrrev_b32 v65, 1, v72
  v_and_b32 v66, 1, v72
  v_add_u32 v67, 12, v65
  v_lshl_add_u32 v67, v67, 4, v73
  v_mul_u32_u24 v68, 2341, v67
  v_lshrrev_b32 v68, 16, v68
  v_mul_u32_u24 v69, 28, v68
  v_sub_u32 v69, v67, v69
  v_lshrrev_b32 v70, 4, v69
  v_and_b32 v69, 15, v69
  v_and_b32 v71, 1, v69
  v_lshrrev_b32 v69, 1, v69
  v_lshl_add_u32 v69, v71, 3, v69
  v_lshlrev_b32 v71, 12, v70
  v_lshrrev_b32 v70, 1, v68
  v_lshl_add_u32 v71, v70, 9, v71
  v_and_b32 v70, 1, v68
  v_lshl_add_u32 v71, v70, 2, v71
  v_lshl_add_u32 v71, v69, 4, v71
  v_lshl_add_u32 v112, v66, 8, v71
  v_add_u32 v67, 14, v65
  v_lshl_add_u32 v67, v67, 4, v73
  v_mul_u32_u24 v68, 2341, v67
  v_lshrrev_b32 v68, 16, v68
  v_mul_u32_u24 v69, 28, v68
  v_sub_u32 v69, v67, v69
  v_lshrrev_b32 v70, 4, v69
  v_and_b32 v69, 15, v69
  v_and_b32 v71, 1, v69
  v_lshrrev_b32 v69, 1, v69
  v_lshl_add_u32 v69, v71, 3, v69
  v_lshlrev_b32 v71, 12, v70
  v_lshrrev_b32 v70, 1, v68
  v_lshl_add_u32 v71, v70, 9, v71
  v_and_b32 v70, 1, v68
  v_lshl_add_u32 v71, v70, 2, v71
  v_lshl_add_u32 v71, v69, 4, v71
  v_lshl_add_u32 v113, v66, 8, v71
  v_add_u32 v67, 16, v65
  v_lshl_add_u32 v67, v67, 4, v73
  v_mul_u32_u24 v68, 2341, v67
  v_lshrrev_b32 v68, 16, v68
  v_mul_u32_u24 v69, 28, v68
  v_sub_u32 v69, v67, v69
  v_lshrrev_b32 v70, 4, v69
  v_and_b32 v69, 15, v69
  v_and_b32 v71, 1, v69
  v_lshrrev_b32 v69, 1, v69
  v_lshl_add_u32 v69, v71, 3, v69
  v_lshlrev_b32 v71, 12, v70
  v_lshrrev_b32 v70, 1, v68
  v_lshl_add_u32 v71, v70, 9, v71
  v_and_b32 v70, 1, v68
  v_lshl_add_u32 v71, v70, 2, v71
  v_lshl_add_u32 v71, v69, 4, v71
  v_lshl_add_u32 v114, v66, 8, v71
  v_add_u32 v67, 18, v65
  v_lshl_add_u32 v67, v67, 4, v73
  v_mul_u32_u24 v68, 2341, v67
  v_lshrrev_b32 v68, 16, v68
  v_mul_u32_u24 v69, 28, v68
  v_sub_u32 v69, v67, v69
  v_lshrrev_b32 v70, 4, v69
  v_and_b32 v69, 15, v69
  v_and_b32 v71, 1, v69
  v_lshrrev_b32 v69, 1, v69
  v_lshl_add_u32 v69, v71, 3, v69
  v_lshlrev_b32 v71, 12, v70
  v_lshrrev_b32 v70, 1, v68
  v_lshl_add_u32 v71, v70, 9, v71
  v_and_b32 v70, 1, v68
  v_lshl_add_u32 v71, v70, 2, v71
  v_lshl_add_u32 v71, v69, 4, v71
  v_lshl_add_u32 v115, v66, 8, v71
  s_mul_i32 s24, s17, 532480
  s_add_u32 s24, s24, 76939264
  s_mul_i32 s34, s17, 640
  s_add_u32 s34, s34, 88582144
  s_mul_i32 s36, s17, 448
  v_add_u32 v0, s36, v2
  v_add_u32 v0, 8192, v0
  s_add_u32 s36, s36, 88080384
  v_cmp_gt_u32 s[26:27], 28, v1
  v_and_b32 v119, 31, v1
  v_lshlrev_b32 v119, 2, v119
  v_and_b32 v119, 0x78, v119
  v_or_b32 v119, 0, v119
  s_add_u32 s22, s17, 16
  s_and_b32 s22, s22, 15
  s_lshl_b32 s22, s22, 7
  s_add_u32 s22, s22, 18432
  v_add_u32 v119, s22, v119
  v_min_u32 v118, 9, v1
  s_mul_i32 s22, s17, 10
  v_add_u32 v118, s22, v118
  v_lshlrev_b32 v118, 7, v118
  v_add_u32 v118, 40960, v118
  s_mov_b32 s39, 71565312
  v_add_u32 v1, 16384, v2
  v_mov_b32 v117, 1
  s_mul_i32 s38, s17, 1104
  s_add_u32 s38, s38, 20480
  s_lshl_b32 s22, 0, 11
  s_add_u32 s22, s22, 88602624
  v_add_u32 v36, 1024, v2
  v_min_u32 v36, 1776, v36
  s_mov_b32 s30, 0
va_iw6:
  buffer_load_dwordx4 v[40:43], v2, s[8:11], s22 offen sc1
  buffer_load_dwordx4 v[44:47], v36, s[8:11], s22 offen sc1
  s_waitcnt vmcnt(0)
  v_cmp_ne_u64 vcc, s[88:89], v[40:41]
  s_cbranch_vccnz va_iw6_no
  v_cmp_ne_u64 vcc, s[88:89], v[42:43]
  s_cbranch_vccnz va_iw6_no
  v_cmp_ne_u64 vcc, s[88:89], v[44:45]
  s_cbranch_vccnz va_iw6_no
  v_cmp_ne_u64 vcc, s[88:89], v[46:47]
  s_cbranch_vccnz va_iw6_no
  s_branch va_iw6_ok
va_iw6_no:
  s_sleep 2
  s_add_u32 s30, s30, 1
  s_cmp_lt_u32 s30, 50000
  s_cbranch_scc1 va_iw6
  s_branch cA_abort
va_iw6_ok:
  s_mov_b32 s30, 0
  v_mov_b32 v36, 0
ch_md6:
  buffer_load_dword v37, v36, s[12:15], 0 offen sc1
  s_waitcnt vmcnt(0)
  v_readfirstlane_b32 s22, v37
  s_and_b32 s31, s22, 0xffff
  s_cmp_ge_u32 s31, 32
  s_cbranch_scc1 ch_go6
  s_sleep 2
  s_add_u32 s30, s30, 1
  s_cmp_lt_u32 s30, 50000
  s_cbranch_scc1 ch_md6
  s_branch ch_end
ch_go6:
  s_mov_b32 s31, 0
  s_lshr_b32 s22, s22, 16
  s_cmp_lg_u32 s22, 0
  s_cbranch_scc1 cB_va2_loop
  s_branch cA_va2_loop
ch_init7:
  s_mul_i32 s31, s17, 401408
  s_add_u32 s31, s31, 6422528
  s_mul_i32 s22, s17, 12
  s_add_u32 s23, s22, 267
  s_add_u32 s22, s22, 256
  v_mov_b32 v36, s23
  v_mov_b32 v37, s22
  v_cmp_eq_u32 vcc, 1, v116
  s_lshl_b32 s22, s17, 4
  s_nop 0
  v_cndmask_b32 v36, v36, v37, vcc
  v_mov_b32 v37, s22
  v_cmp_eq_u32 vcc, 0, v116
  s_nop 1
  v_cndmask_b32 v36, v36, v37, vcc
  v_lshrrev_b32 v36, 6, v36
  v_lshlrev_b32 v36, 8, v36
  v_med3_u32 v37, v117, 11, 15
  v_lshl_add_u32 v36, v37, 4, v36
  s_mov_b32 s22, 88600576
  s_mov_b32 s30, 0
va_bw_16:
  buffer_load_dwordx4 v[40:43], v36, s[8:11], s22 offen sc1
  s_waitcnt vmcnt(0)
  v_cmp_ne_u64 vcc, s[88:89], v[40:41]
  s_cbranch_vccnz va_bw_16_no
  v_cmp_ne_u64 vcc, s[88:89], v[42:43]
  s_cbranch_vccnz va_bw_16_no
  s_branch va_bw_16_ok
va_bw_16_no:
  s_sleep 2
  s_add_u32 s30, s30, 1
  s_cmp_lt_u32 s30, 50000
  s_cbranch_scc1 va_bw_16
  s_branch cA_abort
va_bw_16_ok:
  s_add_u32 s22, s31, 286720
  buffer_load_dwordx4 a[0:3], v2, s[8:11], s22 offen offset:0 sc1
  buffer_load_dwordx4 a[4:7], v2, s[8:11], s22 offen offset:1024 sc1
  buffer_load_dwordx4 a[8:11], v2, s[8:11], s22 offen offset:2048 sc1
  buffer_load_dwordx4 a[12:15], v2, s[8:11], s22 offen offset:3072 sc1
  s_add_u32 s22, s31, 290816
  buffer_load_dwordx4 a[16:19], v2, s[8:11], s22 offen offset:0 sc1
  buffer_load_dwordx4 a[20:23], v2, s[8:11], s22 offen offset:1024 sc1
  buffer_load_dwordx4 a[24:27], v2, s[8:11], s22 offen offset:2048 sc1
  buffer_load_dwordx4 a[28:31], v2, s[8:11], s22 offen offset:3072 sc1
  s_add_u32 s22, s31, 294912
  buffer_load_dwordx4 a[32:35], v2, s[8:11], s22 offen offset:0 sc1
  buffer_load_dwordx4 a[36:39], v2, s[8:11], s22 offen offset:1024 sc1
  buffer_load_dwordx4 a[40:43], v2, s[8:11], s22 offen offset:2048 sc1
  buffer_load_dwordx4 a[44:47], v2, s[8:11], s22 offen offset:3072 sc1
  s_add_u32 s22, s31, 299008
  buffer_load_dwordx4 a[48:51], v2, s[8:11], s22 offen offset:0 sc1
  buffer_load_dwordx4 a[52:55], v2, s[8:11], s22 offen offset:1024 sc1
  buffer_load_dwordx4 a[56:59], v2, s[8:11], s22 offen offset:2048 sc1
  buffer_load_dwordx4 a[60:63], v2, s[8:11], s22 offen offset:3072 sc1
  s_add_u32 s22, s31, 303104
  buffer_load_dwordx4 a[64:67], v2, s[8:11], s22 offen offset:0 sc1
  buffer_load_dwordx4 a[68:71], v2, s[8:11], s22 offen offset:1024 sc1
  buffer_load_dwordx4 a[72:75], v2, s[8:11], s22 offen offset:2048 sc1
  buffer_load_dwordx4 a[76:79], v2, s[8:11], s22 offen offset:3072 sc1
  s_add_u32 s22, s31, 307200
  buffer_load_dwordx4 a[80:83], v2, s[8:11], s22 offen offset:0 sc1
  buffer_load_dwordx4 a[84:87], v2, s[8:11], s22 offen offset:1024 sc1
  buffer_load_dwordx4 a[88:91], v2, s[8:11], s22 offen offset:2048 sc1
  buffer_load_dwordx4 a[92:95], v2, s[8:11], s22 offen offset:3072 sc1
  s_add_u32 s22, s31, 311296
  buffer_load_dwordx4 a[96:99], v2, s[8:11], s22 offen offset:0 sc1
  buffer_load_dwordx4 a[100:103], v2, s[8:11], s22 offen offset:1024 sc1
  buffer_load_dwordx4 a[104:107], v2, s[8:11], s22 offen offset:2048 sc1
  buffer_load_dwordx4 a[108:111], v2, s[8:11], s22 offen offset:3072 sc1
  s_add_u32 s22, s31, 315392
  buffer_load_dwordx4 a[112:115], v2, s[8:11], s22 offen offset:0 sc1
  buffer_load_dwordx4 a[116:119], v2, s[8:11], s22 offen offset:1024 sc1
  buffer_load_dwordx4 a[120:123], v2, s[8:11], s22 offen offset:2048 sc1
  buffer_load_dwordx4 a[124:127], v2, s[8:11], s22 offen offset:3072 sc1
  s_waitcnt vmcnt(24)
  s_add_u32 s22, s31, 319488
  buffer_load_dwordx4 a[128:131], v2, s[8:11], s22 offen offset:0 sc1
  buffer_load_dwordx4 a[132:135], v2, s[8:11], s22 offen offset:1024 sc1
  buffer_load_dwordx4 a[136:139], v2, s[8:11], s22 offen offset:2048 sc1
  buffer_load_dwordx4 a[140:143], v2, s[8:11], s22 offen offset:3072 sc1
  s_add_u32 s22, s31, 323584
  buffer_load_dwordx4 a[144:147], v2, s[8:11], s22 offen offset:0 sc1
  buffer_load_dwordx4 a[148:151], v2, s[8:11], s22 offen offset:1024 sc1
  buffer_load_dwordx4 a[152:155], v2, s[8:11], s22 offen offset:2048 sc1
  buffer_load_dwordx4 a[156:159], v2, s[8:11], s22 offen offset:3072 sc1
  s_add_u32 s22, s31, 327680
  buffer_load_dwordx4 a[160:163], v2, s[8:11], s22 offen offset:0 sc1
  buffer_load_dwordx4 a[164:167], v2, s[8:11], s22 offen offset:1024 sc1
  buffer_load_dwordx4 a[168:171], v2, s[8:11], s22 offen offset:2048 sc1
  buffer_load_dwordx4 a[172:175], v2, s[8:11], s22 offen offset:3072 sc1
  s_add_u32 s22, s31, 331776
  buffer_load_dwordx4 a[176:179], v2, s[8:11], s22 offen offset:0 sc1
  buffer_load_dwordx4 a[180:183], v2, s[8:11], s22 offen offset:1024 sc1
  buffer_load_dwordx4 a[184:187], v2, s[8:11], s22 offen offset:2048 sc1
  buffer_load_dwordx4 a[188:191], v2, s[8:11], s22 offen offset:3072 sc1
  s_add_u32 s22, s31, 335872
  buffer_load_dwordx4 a[192:195], v2, s[8:11], s22 offen offset:0 sc1
  buffer_load_dwordx4 a[196:199], v2, s[8:11], s22 offen offset:1024 sc1
  buffer_load_dwordx4 a[200:203], v2, s[8:11], s22 offen offset:2048 sc1
  buffer_load_dwordx4 a[204:207], v2, s[8:11], s22 offen offset:3072 sc1
  s_add_u32 s22, s31, 339968
  buffer_load_dwordx4 a[208:211], v2, s[8:11], s22 offen offset:0 sc1
  buffer_load_dwordx4 a[212:215], v2, s[8:11], s22 offen offset:1024 sc1
  buffer_load_dwordx4 a[216:219], v2, s[8:11], s22 offen offset:2048 sc1
  buffer_load_dwordx4 a[220:223], v2, s[8:11], s22 offen offset:3072 sc1
  s_add_u32 s22, s31, 344064
  buffer_load_dwordx4 a[224:227], v2, s[8:11], s22 offen offset:0 sc1
  buffer_load_dwordx4 a[228:231], v2, s[8:11], s22 offen offset:1024 sc1
  buffer_load_dwordx4 a[232:235], v2, s[8:11], s22 offen offset:2048 sc1
  buffer_load_dwordx4 a[236:239], v2, s[8:11], s22 offen offset:3072 sc1
  s_add_u32 s22, s31, 348160
  buffer_load_dwordx4 a[240:243], v2, s[8:11], s22 offen offset:0 sc1
  buffer_load_dwordx4 a[244:247], v2, s[8:11], s22 offen offset:1024 sc1
  buffer_load_dwordx4 a[248:251], v2, s[8:11], s22 offen offset:2048 sc1
  buffer_load_dwordx4 a[252:255], v2, s[8:11], s22 offen offset:3072 sc1
  s_waitcnt vmcnt(24)
  s_add_u32 s22, s31, 352256
  buffer_load_dwordx4 v[120:123], v2, s[8:11], s22 offen offset:0 sc1
  buffer_load_dwordx4 v[124:127], v2, s[8:11], s22 offen offset:1024 sc1
  buffer_load_dwordx4 v[128:131], v2, s[8:11], s22 offen offset:2048 sc1
  buffer_load_dwordx4 v[132:135], v2, s[8:11], s22 offen offset:3072 sc1
  s_add_u32 s22, s31, 356352
  buffer_load_dwordx4 v[136:139], v2, s[8:11], s22 offen offset:0 sc1
  buffer_load_dwordx4 v[140:143], v2, s[8:11], s22 offen offset:1024 sc1
  buffer_load_dwordx4 v[144:147], v2, s[8:11], s22 offen offset:2048 sc1
  buffer_load_dwordx4 v[148:151], v2, s[8:11], s22 offen offset:3072 sc1
  s_add_u32 s22, s31, 360448
  buffer_load_dwordx4 v[152:155], v2, s[8:11], s22 offen offset:0 sc1
  buffer_load_dwordx4 v[156:159], v2, s[8:11], s22 offen offset:1024 sc1
  buffer_load_dwordx4 v[160:163], v2, s[8:11], s22 offen offset:2048 sc1
  buffer_load_dwordx4 v[164:167], v2, s[8:11], s22 offen offset:3072 sc1
  s_add_u32 s22, s31, 364544
  buffer_load_dwordx4 v[168:171], v2, s[8:11], s22 offen offset:0 sc1
  buffer_load_dwordx4 v[172:175], v2, s[8:11], s22 offen offset:1024 sc1
  buffer_load_dwordx4 v[176:179], v2, s[8:11], s22 offen offset:2048 sc1
  buffer_load_dwordx4 v[180:183], v2, s[8:11], s22 offen offset:3072 sc1
  s_add_u32 s22, s31, 368640
  buffer_load_dwordx4 v[184:187], v2, s[8:11], s22 offen offset:0 sc1
  buffer_load_dwordx4 v[188:191], v2, s[8:11], s22 offen offset:1024 sc1
  buffer_load_dwordx4 v[192:195], v2, s[8:11], s22 offen offset:2048 sc1
  buffer_load_dwordx4 v[196:199], v2, s[8:11], s22 offen offset:3072 sc1
  s_add_u32 s22, s31, 372736
  buffer_load_dwordx4 v[200:203], v2, s[8:11], s22 offen offset:0 sc1
  buffer_load_dwordx4 v[204:207], v2, s[8:11], s22 offen offset:1024 sc1
  buffer_load_dwordx4 v[208:211], v2, s[8:11], s22 offen offset:2048 sc1
  buffer_load_dwordx4 v[212:215], v2, s[8:11], s22 offen offset:3072 sc1
  s_add_u32 s22, s31, 376832
  buffer_load_dwordx4 v[216:219], v2, s[8:11], s22 offen offset:0 sc1
  buffer_load_dwordx4 v[220:223], v2, s[8:11], s22 offen offset:1024 sc1
  buffer_load_dwordx4 v[224:227], v2, s[8:11], s22 offen offset:2048 sc1
  buffer_load_dwordx4 v[228:231], v2, s[8:11], s22 offen offset:3072 sc1
  s_add_u32 s22, s31, 380928
  buffer_load_dwordx4 v[232:235], v2, s[8:11], s22 offen offset:0 sc1
  buffer_load_dwordx4 v[236:239], v2, s[8:11], s22 offen offset:1024 sc1
  buffer_load_dwordx4 v[240:243], v2, s[8:11], s22 offen offset:2048 sc1
  buffer_load_dwordx4 v[244:247], v2, s[8:11], s22 offen offset:3072 sc1
  s_waitcnt vmcnt(24)
  s_add_u32 s22, s31, 385024
  buffer_load_dwordx4 v[248:251], v2, s[8:11], s22 offen offset:0 sc1
  buffer_load_dwordx4 v[252:255], v2, s[8:11], s22 offen offset:1024 sc1
  v_mov_b32 v72, v116
  v_mov_b32 v73, v117
  v_lshrrev_b32 v65, 1, v72
  v_and_b32 v66, 1, v72
  v_add_u32 v67, 20, v65
  v_lshl_add_u32 v67, v67, 4, v73
  v_mul_u32_u24 v68, 2341, v67
  v_lshrrev_b32 v68, 16, v68
  v_mul_u32_u24 v69, 28, v68
  v_sub_u32 v69, v67, v69
  v_lshrrev_b32 v70, 4, v69
  v_and_b32 v69, 15, v69
  v_and_b32 v71, 1, v69
  v_lshrrev_b32 v69, 1, v69
  v_lshl_add_u32 v69, v71, 3, v69
  v_lshlrev_b32 v71, 12, v70
  v_lshrrev_b32 v70, 1, v68
  v_lshl_add_u32 v71, v70, 9, v71
  v_and_b32 v70, 1, v68
  v_lshl_add_u32 v71, v70, 2, v71
  v_lshl_add_u32 v71, v69, 4, v71
  v_lshl_add_u32 v112, v66, 8, v71
  v_add_u32 v67, 22, v65
  v_lshl_add_u32 v67, v67, 4, v73
  v_mul_u32_u24 v68, 2341, v67
  v_lshrrev_b32 v68, 16, v68
  v_mul_u32_u24 v69, 28, v68
  v_sub_u32 v69, v67, v69
  v_lshrrev_b32 v70, 4, v69
  v_and_b32 v69, 15, v69
  v_and_b32 v71, 1, v69
  v_lshrrev_b32 v69, 1, v69
  v_lshl_add_u32 v69, v71, 3, v69
  v_lshlrev_b32 v71, 12, v70
  v_lshrrev_b32 v70, 1, v68
  v_lshl_add_u32 v71, v70, 9, v71
  v_and_b32 v70, 1, v68
  v_lshl_add_u32 v71, v70, 2, v71
  v_lshl_add_u32 v71, v69, 4, v71
  v_lshl_add_u32 v113, v66, 8, v71
  v_add_u32 v67, 24, v65
  v_lshl_add_u32 v67, v67, 4, v73
  v_mul_u32_u24 v68, 2341, v67
  v_lshrrev_b32 v68, 16, v68
  v_mul_u32_u24 v69, 28, v68
  v_sub_u32 v69, v67, v69
  v_lshrrev_b32 v70, 4, v69
  v_and_b32 v69, 15, v69
  v_and_b32 v71, 1, v69
  v_lshrrev_b32 v69, 1, v69
  v_lshl_add_u32 v69, v71, 3, v69
  v_lshlrev_b32 v71, 12, v70
  v_lshrrev_b32 v70, 1, v68
  v_lshl_add_u32 v71, v70, 9, v71
  v_and_b32 v70, 1, v68
  v_lshl_add_u32 v71, v70, 2, v71
  v_lshl_add_u32 v71, v69, 4, v71
  v_lshl_add_u32 v114, v66, 8, v71
  v_add_u32 v67, 26, v65
  v_lshl_add_u32 v67, v67, 4, v73
  v_mul_u32_u24 v68, 2341, v67
  v_lshrrev_b32 v68, 16, v68
  v_mul_u32_u24 v69, 28, v68
  v_sub_u32 v69, v67, v69
  v_lshrrev_b32 v70, 4, v69
  v_and_b32 v69, 15, v69
  v_and_b32 v71, 1, v69
  v_lshrrev_b32 v69, 1, v69
  v_lshl_add_u32 v69, v71, 3, v69
  v_lshlrev_b32 v71, 12, v70
  v_lshrrev_b32 v70, 1, v68
  v_lshl_add_u32 v71, v70, 9, v71
  v_and_b32 v70, 1, v68
  v_lshl_add_u32 v71, v70, 2, v71
  v_lshl_add_u32 v71, v69, 4, v71
  v_lshl_add_u32 v115, v66, 8, v71
  s_mul_i32 s24, s17, 532480
  s_add_u32 s24, s24, 76943360
  s_mul_i32 s34, s17, 640
  s_add_u32 s34, s34, 88582148
  s_mul_i32 s36, s17, 448
  v_add_u32 v0, s36, v2
  v_add_u32 v0, 8192, v0
  s_add_u32 s36, s36, 88080384
  v_cmp_gt_u32 s[26:27], 28, v1
  v_and_b32 v119, 31, v1
  v_lshlrev_b32 v119, 2, v119
  v_and_b32 v119, 0x78, v119
  v_or_b32 v119, 4, v119
  s_add_u32 s22, s17, 16
  s_and_b32 s22, s22, 15
  s_lshl_b32 s22, s22, 7
  s_add_u32 s22, s22, 18432
  v_add_u32 v119, s22, v119
  v_min_u32 v118, 13, v1
  s_mul_i32 s22, s17, 14
  v_add_u32 v118, s22, v118
  v_lshlrev_b32 v118, 7, v118
  v_add_u32 v118, 57344, v118
  s_mov_b32 s39, 71565312
  v_add_u32 v1, 59392, v2
  v_mov_b32 v117, 1
  s_mul_i32 s38, s17, 1104
  s_add_u32 s38, s38, 21504
  s_lshl_b32 s22, 0, 11
  s_add_u32 s22, s22, 88602624
  v_add_u32 v36, 1024, v2
  v_min_u32 v36, 1776, v36
  s_mov_b32 s30, 0
va_iw7:
  buffer_load_dwordx4 v[40:43], v2, s[8:11], s22 offen sc1
  buffer_load_dwordx4 v[44:47], v36, s[8:11], s22 offen sc1
  s_waitcnt vmcnt(0)
  v_cmp_ne_u64 vcc, s[88:89], v[40:41]
  s_cbranch_vccnz va_iw7_no
  v_cmp_ne_u64 vcc, s[88:89], v[42:43]
  s_cbranch_vccnz va_iw7_no
  v_cmp_ne_u64 vcc, s[88:89], v[44:45]
  s_cbranch_vccnz va_iw7_no
  v_cmp_ne_u64 vcc, s[88:89], v[46:47]
  s_cbranch_vccnz va_iw7_no
  s_branch va_iw7_ok
va_iw7_no:
  s_sleep 2
  s_add_u32 s30, s30, 1
  s_cmp_lt_u32 s30, 50000
  s_cbranch_scc1 va_iw7
  s_branch cA_abort
va_iw7_ok:
  s_mov_b32 s30, 0
  v_mov_b32 v36, 0
ch_md7:
  buffer_load_dword v37, v36, s[12:15], 0 offen sc1
  s_waitcnt vmcnt(0)
  v_readfirstlane_b32 s22, v37
  s_and_b32 s31, s22, 0xffff
  s_cmp_ge_u32 s31, 32
  s_cbranch_scc1 ch_go7
  s_sleep 2
  s_add_u32 s30, s30, 1
  s_cmp_lt_u32 s30, 50000
  s_cbranch_scc1 ch_md7
  s_branch ch_end
ch_go7:
  s_mov_b32 s31, 0
  s_lshr_b32 s22, s22, 16
  s_cmp_lg_u32 s22, 0
  s_cbranch_scc1 cB_va3_loop
  s_branch cA_va3_loop
.p2align 6

cA_sc0_loop:
  s_add_u32 s23, s20, 4096
  s_add_u32 s21, s20, 20480
  v_mov_b32 v48, 0
  v_mov_b32 v49, 0
  v_mov_b32 v50, 0
  v_mov_b32 v51, 0
  v_mov_b32 v52, 0
  v_mov_b32 v53, 0
  v_mov_b32 v54, 0
  v_mov_b32 v55, 0
  v_mov_b32 v56, 0
  v_mov_b32 v57, 0
  v_mov_b32 v58, 0
  v_mov_b32 v59, 0
  v_mov_b32 v60, 0
  v_mov_b32 v61, 0
  v_mov_b32 v62, 0
  v_mov_b32 v63, 0
  v_mov_b32 v88, 0
  v_mov_b32 v89, 0
  v_mov_b32 v90, 0
  v_mov_b32 v91, 0
  v_mov_b32 v92, 0
  v_mov_b32 v93, 0
  v_mov_b32 v94, 0
  v_mov_b32 v95, 0
  v_mov_b32 v66, 0
  v_mov_b32 v67, 0
  s_mov_b32 s30, 0
  s_mov_b32 s62, 0
  buffer_load_dword v68, v0, s[8:11], s20 offen sc1
  s_nop 7
  buffer_load_dword v69, v0, s[8:11], s20 offen sc1
  s_nop 7
  buffer_load_dword v70, v0, s[8:11], s20 offen sc1
  s_nop 7
  buffer_load_dword v71, v0, s[8:11], s20 offen sc1
  s_nop 7
  buffer_load_dword v72, v0, s[8:11], s20 offen sc1
cA_sc0_fp_l:
  s_waitcnt vmcnt(4)
  v_cmp_eq_u32 vcc, -1, v68
  s_cbranch_vccz cA_sc0_fp_d
  buffer_load_dword v68, v0, s[8:11], s20 offen sc1
  s_waitcnt vmcnt(4)
  v_cmp_eq_u32 vcc, -1, v69
  s_cbranch_vccz cA_sc0_fp_d
  buffer_load_dword v69, v0, s[8:11], s20 offen sc1
  s_waitcnt vmcnt(4)
  v_cmp_eq_u32 vcc, -1, v70
  s_cbranch_vccz cA_sc0_fp_d
  buffer_load_dword v70, v0, s[8:11], s20 offen sc1
  s_waitcnt vmcnt(4)
  v_cmp_eq_u32 vcc, -1, v71
  s_cbranch_vccz cA_sc0_fp_d
  buffer_load_dword v71, v0, s[8:11], s20 offen sc1
  s_waitcnt vmcnt(4)
  v_cmp_eq_u32 vcc, -1, v72
  s_cbranch_vccz cA_sc0_fp_d
  buffer_load_dword v72, v0, s[8:11], s20 offen sc1
  s_add_u32 s30, s30, 1
  s_cmp_lt_u32 s30, 400000
  s_cbranch_scc1 cA_sc0_fp_l
  s_branch cA_abort
cA_sc0_fp_d:
  buffer_load_dwordx4 v[8:11], v2, s[8:11], s20 offen offset:0
  s_barrier
  s_branch cA_sc0_ld1
cA_sc0_ld:
  buffer_load_dwordx4 v[8:11], v2, s[8:11], s20 offen offset:0
cA_sc0_ld1:
  v_mov_b32 v36, 0
  v_mov_b32 v37, 0
  v_mov_b32 v38, 0
  v_mov_b32 v39, 0
  buffer_load_dwordx4 v[12:15], v2, s[8:11], s20 offen offset:1024
  v_mov_b32 v40, 0
  v_mov_b32 v41, 0
  v_mov_b32 v42, 0
  v_mov_b32 v43, 0
  buffer_load_dwordx4 v[16:19], v2, s[8:11], s20 offen offset:2048
  v_mov_b32 v44, 0
  v_mov_b32 v45, 0
  v_mov_b32 v46, 0
  v_mov_b32 v47, 0
  ds_read_b128 v[96:99], v117 offset:0
  ds_read_b128 v[100:103], v117 offset:1024
  ds_read_b128 v[104:107], v117 offset:14336
  ds_read_b128 v[108:111], v117 offset:15360
  s_waitcnt vmcnt(2)
  v_smfmac_f32_16x16x64_bf16 v[36:39], v[8:11], a[0:7], v3
  v_smfmac_f32_16x16x64_bf16 v[40:43], v[8:11], a[56:63], v3
  buffer_load_dwordx4 v[20:23], v2, s[8:11], s20 offen offset:3072
  v_smfmac_f32_16x16x64_bf16 v[44:47], v[8:11], a[112:119], v3
  v_smfmac_f32_16x16x64_bf16 v[48:51], v[8:11], a[168:175], v3
  v_smfmac_f32_16x16x64_bf16 v[52:55], v[8:11], a[224:231], v3
  buffer_load_dwordx4 v[24:27], v2, s[8:11], s23 offen offset:0
  v_smfmac_f32_16x16x64_bf16 v[56:59], v[8:11], v[144:151], v3
  v_smfmac_f32_16x16x64_bf16 v[60:63], v[8:11], v[200:207], v3
  s_waitcnt vmcnt(3)
  v_smfmac_f32_16x16x64_bf16 v[36:39], v[12:15], a[8:15], v3
  v_smfmac_f32_16x16x64_bf16 v[40:43], v[12:15], a[64:71], v3
  buffer_load_dwordx4 v[28:31], v2, s[8:11], s23 offen offset:1024
  v_smfmac_f32_16x16x64_bf16 v[44:47], v[12:15], a[120:127], v3
  v_smfmac_f32_16x16x64_bf16 v[48:51], v[12:15], a[176:183], v3
  v_smfmac_f32_16x16x64_bf16 v[52:55], v[12:15], a[232:239], v3
  buffer_load_dwordx4 v[32:35], v2, s[8:11], s23 offen offset:2048
  v_smfmac_f32_16x16x64_bf16 v[56:59], v[12:15], v[152:159], v3
  v_smfmac_f32_16x16x64_bf16 v[60:63], v[12:15], v[208:215], v3
  s_waitcnt vmcnt(4)
  v_smfmac_f32_16x16x64_bf16 v[36:39], v[16:19], a[16:23], v3
  v_smfmac_f32_16x16x64_bf16 v[40:43], v[16:19], a[72:79], v3
  v_smfmac_f32_16x16x64_bf16 v[44:47], v[16:19], a[128:135], v3
  v_smfmac_f32_16x16x64_bf16 v[48:51], v[16:19], a[184:191], v3
  v_smfmac_f32_16x16x64_bf16 v[52:55], v[16:19], a[240:247], v3
  v_smfmac_f32_16x16x64_bf16 v[56:59], v[16:19], v[160:167], v3
  v_smfmac_f32_16x16x64_bf16 v[60:63], v[16:19], v[216:223], v3
  s_waitcnt vmcnt(3)
  v_smfmac_f32_16x16x64_bf16 v[36:39], v[20:23], a[24:31], v3
  v_smfmac_f32_16x16x64_bf16 v[40:43], v[20:23], a[80:87], v3
  v_smfmac_f32_16x16x64_bf16 v[44:47], v[20:23], a[136:143], v3
  v_smfmac_f32_16x16x64_bf16 v[48:51], v[20:23], a[192:199], v3
  v_smfmac_f32_16x16x64_bf16 v[52:55], v[20:23], a[248:255], v3
  v_smfmac_f32_16x16x64_bf16 v[56:59], v[20:23], v[168:175], v3
  v_smfmac_f32_16x16x64_bf16 v[60:63], v[20:23], v[224:231], v3
  s_waitcnt vmcnt(0)
cA_sc0_ph2:
  v_smfmac_f32_16x16x64_bf16 v[60:63], v[24:27], v[232:239], v3
  ds_read_b128 v[12:15], v116 offset:0
  ds_read_b128 v[16:19], v116 offset:1024
  v_smfmac_f32_16x16x64_bf16 v[60:63], v[28:31], v[240:247], v3
  v_smfmac_f32_16x16x64_bf16 v[60:63], v[32:35], v[248:255], v3
  v_mov_b32 v80, v24
  v_smfmac_f32_16x16x64_bf16 v[52:55], v[24:27], v[120:127], v3
  v_mov_b32 v81, v25
  v_smfmac_f32_16x16x64_bf16 v[52:55], v[28:31], v[128:135], v3
  v_mov_b32 v82, v32
  v_smfmac_f32_16x16x64_bf16 v[52:55], v[32:35], v[136:143], v3
  v_cvt_pk_bf16_f32 v64, v60, v61
  v_smfmac_f32_16x16x64_bf16 v[56:59], v[24:27], v[176:183], v3
  v_cvt_pk_bf16_f32 v65, v62, v63
  v_smfmac_f32_16x16x64_bf16 v[56:59], v[28:31], v[184:191], v3
  v_mov_b32 v83, v33
  v_mfma_f32_16x16x32_bf16 v[68:71], v[64:67], v[4:7], 0
  v_smfmac_f32_16x16x64_bf16 v[56:59], v[32:35], v[192:199], v3
  v_cvt_pk_bf16_f32 v64, v52, v53
  v_smfmac_f32_16x16x64_bf16 v[36:39], v[24:27], a[32:39], v3
  v_cvt_pk_bf16_f32 v65, v54, v55
  v_smfmac_f32_16x16x64_bf16 v[36:39], v[28:31], a[40:47], v3
  v_cvt_pk_bf16_f32 v78, v68, v69
  v_smfmac_f32_16x16x64_bf16 v[36:39], v[32:35], a[48:55], v3
  v_cvt_pk_bf16_f32 v79, v70, v71
  v_cvt_pk_bf16_f32 v66, v56, v57
  v_smfmac_f32_16x16x64_bf16 v[40:43], v[24:27], a[88:95], v3
  v_cvt_pk_bf16_f32 v67, v58, v59
  v_smfmac_f32_16x16x64_bf16 v[40:43], v[28:31], a[96:103], v3
  v_mfma_f32_16x16x32_bf16 v[72:75], v[64:67], v[4:7], 0
  ds_read_b128 v[52:55], v116 offset:14336
  ds_read_b128 v[56:59], v116 offset:15360
  v_smfmac_f32_16x16x64_bf16 v[40:43], v[32:35], a[104:111], v3
  v_cvt_pk_bf16_f32 v64, v36, v37
  v_smfmac_f32_16x16x64_bf16 v[44:47], v[24:27], a[144:151], v3
  v_cvt_pk_bf16_f32 v65, v38, v39
  v_smfmac_f32_16x16x64_bf16 v[44:47], v[28:31], a[152:159], v3
  v_cvt_pk_bf16_f32 v76, v72, v73
  v_smfmac_f32_16x16x64_bf16 v[44:47], v[32:35], a[160:167], v3
  v_cvt_pk_bf16_f32 v77, v74, v75
  v_cvt_pk_bf16_f32 v66, v40, v41
  v_smfmac_f32_16x16x64_bf16 v[48:51], v[24:27], a[200:207], v3
  v_cvt_pk_bf16_f32 v67, v42, v43
  v_smfmac_f32_16x16x64_bf16 v[48:51], v[28:31], a[208:215], v3
  v_mfma_f32_16x16x32_bf16 v[68:71], v[64:67], v[4:7], 0
  v_smfmac_f32_16x16x64_bf16 v[48:51], v[32:35], a[216:223], v3
  v_cvt_pk_bf16_f32 v64, v44, v45
  v_mfma_f32_16x16x32_bf16 v[84:87], v[80:83], v[76:79], 0
  v_cvt_pk_bf16_f32 v65, v46, v47
  s_waitcnt lgkmcnt(0)
  v_smfmac_f32_16x16x64_bf16 v[88:91], v[76:79], v[96:103], v118
  v_cvt_pk_bf16_f32 v60, v68, v69
  v_cvt_pk_bf16_f32 v61, v70, v71
  v_cvt_pk_bf16_f32 v66, v48, v49
  v_cvt_pk_bf16_f32 v67, v50, v51
  s_nop 1
  v_mfma_f32_16x16x32_bf16 v[72:75], v[64:67], v[4:7], 0
  v_smfmac_f32_16x16x64_bf16 v[92:95], v[76:79], v[104:111], v118
  s_nop 4
  v_cvt_pk_bf16_f32 v62, v72, v73
  v_cvt_pk_bf16_f32 v63, v74, v75
  s_nop 1
  v_mfma_f32_16x16x32_bf16 v[84:87], v[8:11], v[60:63], v[84:87]
  v_smfmac_f32_16x16x64_bf16 v[88:91], v[60:63], v[12:19], v118
  v_smfmac_f32_16x16x64_bf16 v[92:95], v[60:63], v[52:59], v118
  s_nop 1
  v_permlane32_swap_b32 v84, v86
  v_permlane32_swap_b32 v85, v87
  s_nop 0
  v_add_f32 v88, v88, v89
  v_add_f32_dpp v84, v86, v84 quad_perm:[1,0,3,2] row_mask:0xf bank_mask:0xf
  v_add_f32_dpp v85, v87, v85 quad_perm:[1,0,3,2] row_mask:0xf bank_mask:0xf
  v_add_f32 v89, v90, v91
  ds_write2_b32 v113, v84, v85 offset0:0 offset1:4
  ds_write2_b32 v112, v88, v89 offset0:0 offset1:128
  v_add_f32 v90, v92, v93
  v_add_f32 v91, v94, v95
  ds_write2_b32 v112, v90, v91 offset0:64 offset1:192
  v_cmp_u_f32 vcc, v88, v89
  s_cbranch_vccnz cA_sc0_retry
cA_sc0_cont:
  s_waitcnt lgkmcnt(0)
  s_barrier
  ds_read_b128 v[36:39], v114
  ds_read_b128 v[44:47], v115
  s_waitcnt lgkmcnt(0)
  v_add_f32 v36, v36, v38
  v_add_f32 v37, v37, v39
  v_add_f32 v44, v44, v45
  v_add_f32 v46, v46, v47
  v_add_f32 v44, v44, v46
  v_add_f32 v36, v36, v37
  v_exp_f32 v49, v44
  v_exp_f32 v48, v36
  v_add_f32 v50, abs(v36), abs(v44)
  v_fma_f32 v39, v49, s37, v48
  v_cmp_ngt_f32 vcc, s56, v50
  v_cndmask_b32 v41, v48, v49, s[38:39]
  v_add_f32_dpp v39, v39, v39 quad_perm:[1,0,3,2] row_mask:0xf bank_mask:0xf
  v_cndmask_b32 v40, v49, v48, s[38:39]
  v_mov_b32_dpp v46, v41 quad_perm:[1,0,3,2] row_mask:0xf bank_mask:0xf
  v_add_f32_dpp v39, v39, v39 quad_perm:[2,3,0,1] row_mask:0xf bank_mask:0xf
  v_cndmask_b32 v42, v46, v40, s[38:39]
  v_cndmask_b32 v43, v40, v46, s[38:39]
  v_add_f32_dpp v39, v39, v39 row_half_mirror row_mask:0xf bank_mask:0xf
  s_cbranch_vccnz cA_sc0_slow
  s_nop 0
  v_add_f32_dpp v47, v39, v39 row_mirror row_mask:0xf bank_mask:0xf
  v_add_f32_dpp v39, v39, v39 row_mirror row_mask:0xf bank_mask:0xf
  s_nop 1
  v_permlane16_swap_b32 v39, v47
  v_add_f32 v39, v39, v47
  v_rcp_f32 v39, v39
  s_mov_b64 exec, s[28:29]
  v_mul_f32 v42, v42, v39
  v_mul_f32 v43, v43, v39
  v_cvt_pk_bf16_f32 v42, v42, v43
cA_sc0_pst:
  buffer_store_dword v42, v1, s[8:11], s20 offen
  s_mov_b64 exec, -1
  s_barrier
  s_add_u32 s24, s24, 28672
  s_add_u32 s35, s35, 28672
  s_xor_b32 s25, s25, 28672
  s_add_u32 m0, s25, 0
  s_nop 0
  buffer_load_dwordx4 v2, s[8:11], s24 offen offset:0 sc1 lds
  buffer_load_dwordx4 v2, s[8:11], s24 offen offset:1024 sc1 lds
  buffer_load_dwordx4 v2, s[8:11], s24 offen offset:2048 sc1 lds
  buffer_load_dwordx4 v2, s[8:11], s24 offen offset:3072 sc1 lds
  s_add_u32 m0, s25, 4096
  s_add_u32 s22, s24, 4096
  buffer_load_dwordx4 v2, s[8:11], s22 offen offset:0 sc1 lds
  buffer_load_dwordx4 v2, s[8:11], s22 offen offset:1024 sc1 lds
  buffer_load_dwordx4 v2, s[8:11], s22 offen offset:2048 sc1 lds
  v_xor_b32 v116, 28672, v116
  v_add_u32 v117, s57, v117
  s_sub_u32 s57, 0, s57
  s_add_u32 s19, s19, 1
  s_mov_b32 s20, s21
  s_cmp_lt_u32 s19, 63
  s_cbranch_scc1 cA_sc0_loop
  s_branch cA_done
cA_sc0_slow:
  v_max_f32 v50, v36, v44
  s_nop 1
  v_max_f32_dpp v50, v50, v50 quad_perm:[1,0,3,2] row_mask:0xf bank_mask:0xf
  s_nop 1
  v_max_f32_dpp v50, v50, v50 quad_perm:[2,3,0,1] row_mask:0xf bank_mask:0xf
  s_nop 1
  v_max_f32_dpp v50, v50, v50 row_half_mirror row_mask:0xf bank_mask:0xf
  s_nop 1
  v_max_f32_dpp v50, v50, v50 row_mirror row_mask:0xf bank_mask:0xf
  v_mov_b32 v47, v50
  s_nop 1
  v_permlane16_swap_b32 v50, v47
  v_max_f32 v50, v50, v47
  v_sub_f32 v48, v36, v50
  v_sub_f32 v49, v44, v50
  v_exp_f32 v48, v48
  v_exp_f32 v49, v49
  s_add_u32 s31, s31, 0x100
  v_fma_f32 v39, v49, s37, v48
  v_cndmask_b32 v41, v48, v49, s[38:39]
  s_nop 0
  v_add_f32_dpp v39, v39, v39 quad_perm:[1,0,3,2] row_mask:0xf bank_mask:0xf
  v_cndmask_b32 v40, v49, v48, s[38:39]
  v_mov_b32_dpp v46, v41 quad_perm:[1,0,3,2] row_mask:0xf bank_mask:0xf
  v_add_f32_dpp v39, v39, v39 quad_perm:[2,3,0,1] row_mask:0xf bank_mask:0xf
  v_cndmask_b32 v42, v46, v40, s[38:39]
  v_cndmask_b32 v43, v40, v46, s[38:39]
  v_add_f32_dpp v39, v39, v39 row_half_mirror row_mask:0xf bank_mask:0xf
  s_nop 1
  v_add_f32_dpp v47, v39, v39 row_mirror row_mask:0xf bank_mask:0xf
  v_add_f32_dpp v39, v39, v39 row_mirror row_mask:0xf bank_mask:0xf
  s_nop 1
  v_permlane16_swap_b32 v39, v47
  v_add_f32 v39, v39, v47
  v_rcp_f32 v39, v39
  s_mov_b64 exec, s[28:29]
  v_mul_f32 v42, v42, v39
  v_mul_f32 v43, v43, v39
  v_cvt_pk_bf16_f32 v42, v42, v43
  v_min_u32 v42, -2, v42
  s_branch cA_sc0_pst
cA_sc0_retry:
  s_cmp_lg_u32 s62, 0
  s_cbranch_scc1 cA_sc0_cont
  s_waitcnt vmcnt(0) lgkmcnt(0)
cA_sc0_rv:
  buffer_load_dwordx4 v[8:11], v2, s[8:11], s20 offen offset:0 sc1
  buffer_load_dwordx4 v[12:15], v2, s[8:11], s20 offen offset:1024 sc1
  buffer_load_dwordx4 v[16:19], v2, s[8:11], s20 offen offset:2048 sc1
  buffer_load_dwordx4 v[20:23], v2, s[8:11], s20 offen offset:3072 sc1
  buffer_load_dwordx4 v[24:27], v2, s[8:11], s23 offen offset:0 sc1
  buffer_load_dwordx4 v[28:31], v2, s[8:11], s23 offen offset:1024 sc1
  buffer_load_dwordx4 v[32:35], v2, s[8:11], s23 offen offset:2048 sc1
  s_waitcnt vmcnt(0)
  v_max3_u32 v68, v8, v9, v10
  v_max3_u32 v68, v68, v11, v12
  v_max3_u32 v68, v68, v13, v14
  v_max3_u32 v68, v68, v15, v16
  v_max3_u32 v68, v68, v17, v18
  v_max3_u32 v68, v68, v19, v20
  v_max3_u32 v68, v68, v21, v22
  v_max3_u32 v68, v68, v23, v24
  v_max3_u32 v68, v68, v25, v26
  v_max3_u32 v68, v68, v27, v28
  v_max3_u32 v68, v68, v29, v30
  v_max3_u32 v68, v68, v31, v32
  v_max3_u32 v68, v68, v33, v34
  v_max_u32 v68, v68, v35
  v_cmp_eq_u32 vcc, -1, v68
  s_cbranch_vccz cA_sc0_rk
  s_add_u32 s30, s30, 1
  s_cmp_lt_u32 s30, 400000
  s_cbranch_scc1 cA_sc0_rv
  s_branch cA_abort
cA_sc0_rk:
  s_mov_b32 s62, 1
  v_mov_b32 v36, 0
  v_mov_b32 v37, 0
  v_mov_b32 v38, 0
  v_mov_b32 v39, 0
  v_mov_b32 v40, 0
  v_mov_b32 v41, 0
  v_mov_b32 v42, 0
  v_mov_b32 v43, 0
  v_mov_b32 v44, 0
  v_mov_b32 v45, 0
  v_mov_b32 v46, 0
  v_mov_b32 v47, 0
  v_mov_b32 v48, 0
  v_mov_b32 v49, 0
  v_mov_b32 v50, 0
  v_mov_b32 v51, 0
  v_mov_b32 v52, 0
  v_mov_b32 v53, 0
  v_mov_b32 v54, 0
  v_mov_b32 v55, 0
  v_mov_b32 v56, 0
  v_mov_b32 v57, 0
  v_mov_b32 v58, 0
  v_mov_b32 v59, 0
  v_mov_b32 v60, 0
  v_mov_b32 v61, 0
  v_mov_b32 v62, 0
  v_mov_b32 v63, 0
  v_mov_b32 v88, 0
  v_mov_b32 v89, 0
  v_mov_b32 v90, 0
  v_mov_b32 v91, 0
  v_mov_b32 v92, 0
  v_mov_b32 v93, 0
  v_mov_b32 v94, 0
  v_mov_b32 v95, 0
  v_mov_b32 v66, 0
  v_mov_b32 v67, 0
  s_add_u32 s31, s31, 1
  ds_read_b128 v[96:99], v117 offset:0
  ds_read_b128 v[100:103], v117 offset:1024
  ds_read_b128 v[104:107], v117 offset:14336
  ds_read_b128 v[108:111], v117 offset:15360
  v_smfmac_f32_16x16x64_bf16 v[36:39], v[8:11], a[0:7], v3
  v_smfmac_f32_16x16x64_bf16 v[40:43], v[8:11], a[56:63], v3
  v_smfmac_f32_16x16x64_bf16 v[44:47], v[8:11], a[112:119], v3
  v_smfmac_f32_16x16x64_bf16 v[48:51], v[8:11], a[168:175], v3
  v_smfmac_f32_16x16x64_bf16 v[52:55], v[8:11], a[224:231], v3
  v_smfmac_f32_16x16x64_bf16 v[56:59], v[8:11], v[144:151], v3
  v_smfmac_f32_16x16x64_bf16 v[60:63], v[8:11], v[200:207], v3
  v_smfmac_f32_16x16x64_bf16 v[36:39], v[12:15], a[8:15], v3
  v_smfmac_f32_16x16x64_bf16 v[40:43], v[12:15], a[64:71], v3
  v_smfmac_f32_16x16x64_bf16 v[44:47], v[12:15], a[120:127], v3
  v_smfmac_f32_16x16x64_bf16 v[48:51], v[12:15], a[176:183], v3
  v_smfmac_f32_16x16x64_bf16 v[52:55], v[12:15], a[232:239], v3
  v_smfmac_f32_16x16x64_bf16 v[56:59], v[12:15], v[152:159], v3
  v_smfmac_f32_16x16x64_bf16 v[60:63], v[12:15], v[208:215], v3
  v_smfmac_f32_16x16x64_bf16 v[36:39], v[16:19], a[16:23], v3
  v_smfmac_f32_16x16x64_bf16 v[40:43], v[16:19], a[72:79], v3
  v_smfmac_f32_16x16x64_bf16 v[44:47], v[16:19], a[128:135], v3
  v_smfmac_f32_16x16x64_bf16 v[48:51], v[16:19], a[184:191], v3
  v_smfmac_f32_16x16x64_bf16 v[52:55], v[16:19], a[240:247], v3
  v_smfmac_f32_16x16x64_bf16 v[56:59], v[16:19], v[160:167], v3
  v_smfmac_f32_16x16x64_bf16 v[60:63], v[16:19], v[216:223], v3
  v_smfmac_f32_16x16x64_bf16 v[36:39], v[20:23], a[24:31], v3
  v_smfmac_f32_16x16x64_bf16 v[40:43], v[20:23], a[80:87], v3
  v_smfmac_f32_16x16x64_bf16 v[44:47], v[20:23], a[136:143], v3
  v_smfmac_f32_16x16x64_bf16 v[48:51], v[20:23], a[192:199], v3
  v_smfmac_f32_16x16x64_bf16 v[52:55], v[20:23], a[248:255], v3
  v_smfmac_f32_16x16x64_bf16 v[56:59], v[20:23], v[168:175], v3
  v_smfmac_f32_16x16x64_bf16 v[60:63], v[20:23], v[224:231], v3
  s_branch cA_sc0_ph2
.p2align 6

cA_sc1_loop:
  s_add_u32 s23, s20, 4096
  s_add_u32 s21, s20, 20480
  v_mov_b32 v48, 0
  v_mov_b32 v49, 0
  v_mov_b32 v50, 0
  v_mov_b32 v51, 0
  v_mov_b32 v52, 0
  v_mov_b32 v53, 0
  v_mov_b32 v54, 0
  v_mov_b32 v55, 0
  v_mov_b32 v56, 0
  v_mov_b32 v57, 0
  v_mov_b32 v58, 0
  v_mov_b32 v59, 0
  v_mov_b32 v60, 0
  v_mov_b32 v61, 0
  v_mov_b32 v62, 0
  v_mov_b32 v63, 0
  v_mov_b32 v88, 0
  v_mov_b32 v89, 0
  v_mov_b32 v90, 0
  v_mov_b32 v91, 0
  v_mov_b32 v92, 0
  v_mov_b32 v93, 0
  v_mov_b32 v94, 0
  v_mov_b32 v95, 0
  v_mov_b32 v64, 0
  v_mov_b32 v65, 0
  s_mov_b32 s30, 0
  s_mov_b32 s62, 0
  s_waitcnt vmcnt(0)
  s_barrier
cA_sc1_ld:
  buffer_load_dwordx4 v[8:11], v2, s[8:11], s20 offen offset:0
  v_mov_b32 v36, 0
  v_mov_b32 v37, 0
  v_mov_b32 v38, 0
  v_mov_b32 v39, 0
  buffer_load_dwordx4 v[12:15], v2, s[8:11], s20 offen offset:1024
  v_mov_b32 v40, 0
  v_mov_b32 v41, 0
  v_mov_b32 v42, 0
  v_mov_b32 v43, 0
  buffer_load_dwordx4 v[16:19], v2, s[8:11], s20 offen offset:2048
  v_mov_b32 v44, 0
  v_mov_b32 v45, 0
  v_mov_b32 v46, 0
  v_mov_b32 v47, 0
  ds_read_b128 v[96:99], v117 offset:0
  ds_read_b128 v[100:103], v117 offset:1024
  ds_read_b128 v[104:107], v117 offset:14336
  ds_read_b128 v[108:111], v117 offset:15360
  s_waitcnt vmcnt(2)
  v_smfmac_f32_16x16x64_bf16 v[36:39], v[8:11], a[0:7], v3
  v_smfmac_f32_16x16x64_bf16 v[40:43], v[8:11], a[56:63], v3
  buffer_load_dwordx4 v[20:23], v2, s[8:11], s20 offen offset:3072
  v_smfmac_f32_16x16x64_bf16 v[44:47], v[8:11], a[112:119], v3
  v_smfmac_f32_16x16x64_bf16 v[48:51], v[8:11], a[168:175], v3
  v_smfmac_f32_16x16x64_bf16 v[52:55], v[8:11], a[224:231], v3
  buffer_load_dwordx4 v[24:27], v2, s[8:11], s23 offen offset:0
  v_smfmac_f32_16x16x64_bf16 v[56:59], v[8:11], v[144:151], v3
  v_smfmac_f32_16x16x64_bf16 v[60:63], v[8:11], v[200:207], v3
  s_waitcnt vmcnt(3)
  v_smfmac_f32_16x16x64_bf16 v[36:39], v[12:15], a[8:15], v3
  v_smfmac_f32_16x16x64_bf16 v[40:43], v[12:15], a[64:71], v3
  buffer_load_dwordx4 v[28:31], v2, s[8:11], s23 offen offset:1024
  v_smfmac_f32_16x16x64_bf16 v[44:47], v[12:15], a[120:127], v3
  v_smfmac_f32_16x16x64_bf16 v[48:51], v[12:15], a[176:183], v3
  v_smfmac_f32_16x16x64_bf16 v[52:55], v[12:15], a[232:239], v3
  buffer_load_dwordx4 v[32:35], v2, s[8:11], s23 offen offset:2048
  v_smfmac_f32_16x16x64_bf16 v[56:59], v[12:15], v[152:159], v3
  v_smfmac_f32_16x16x64_bf16 v[60:63], v[12:15], v[208:215], v3
  s_waitcnt vmcnt(4)
  v_smfmac_f32_16x16x64_bf16 v[36:39], v[16:19], a[16:23], v3
  v_smfmac_f32_16x16x64_bf16 v[40:43], v[16:19], a[72:79], v3
  v_smfmac_f32_16x16x64_bf16 v[44:47], v[16:19], a[128:135], v3
  v_smfmac_f32_16x16x64_bf16 v[48:51], v[16:19], a[184:191], v3
  v_smfmac_f32_16x16x64_bf16 v[52:55], v[16:19], a[240:247], v3
  v_smfmac_f32_16x16x64_bf16 v[56:59], v[16:19], v[160:167], v3
  v_smfmac_f32_16x16x64_bf16 v[60:63], v[16:19], v[216:223], v3
  s_waitcnt vmcnt(3)
  v_smfmac_f32_16x16x64_bf16 v[36:39], v[20:23], a[24:31], v3
  v_smfmac_f32_16x16x64_bf16 v[40:43], v[20:23], a[80:87], v3
  v_smfmac_f32_16x16x64_bf16 v[44:47], v[20:23], a[136:143], v3
  v_smfmac_f32_16x16x64_bf16 v[48:51], v[20:23], a[192:199], v3
  v_smfmac_f32_16x16x64_bf16 v[52:55], v[20:23], a[248:255], v3
  v_smfmac_f32_16x16x64_bf16 v[56:59], v[20:23], v[168:175], v3
  v_smfmac_f32_16x16x64_bf16 v[60:63], v[20:23], v[224:231], v3
  s_waitcnt vmcnt(0)
cA_sc1_ph2:
  v_smfmac_f32_16x16x64_bf16 v[60:63], v[24:27], v[232:239], v3
  ds_read_b128 v[16:19], v116 offset:2048
  ds_read_b128 v[20:23], v116 offset:3072
  v_smfmac_f32_16x16x64_bf16 v[60:63], v[28:31], v[240:247], v3
  buffer_load_dword v119, v0, s[8:11], s20 offen sc1
  v_smfmac_f32_16x16x64_bf16 v[60:63], v[32:35], v[248:255], v3
  v_mov_b32 v80, v26
  v_smfmac_f32_16x16x64_bf16 v[52:55], v[24:27], v[120:127], v3
  v_mov_b32 v81, v27
  v_smfmac_f32_16x16x64_bf16 v[52:55], v[28:31], v[128:135], v3
  v_mov_b32 v82, v32
  v_smfmac_f32_16x16x64_bf16 v[52:55], v[32:35], v[136:143], v3
  v_cvt_pk_bf16_f32 v66, v60, v61
  v_smfmac_f32_16x16x64_bf16 v[56:59], v[24:27], v[176:183], v3
  v_cvt_pk_bf16_f32 v67, v62, v63
  v_smfmac_f32_16x16x64_bf16 v[56:59], v[28:31], v[184:191], v3
  v_mov_b32 v83, v33
  v_mfma_f32_16x16x32_bf16 v[68:71], v[64:67], v[4:7], 0
  v_smfmac_f32_16x16x64_bf16 v[56:59], v[32:35], v[192:199], v3
  v_cvt_pk_bf16_f32 v64, v52, v53
  v_smfmac_f32_16x16x64_bf16 v[36:39], v[24:27], a[32:39], v3
  v_cvt_pk_bf16_f32 v65, v54, v55
  v_smfmac_f32_16x16x64_bf16 v[36:39], v[28:31], a[40:47], v3
  v_cvt_pk_bf16_f32 v78, v68, v69
  v_smfmac_f32_16x16x64_bf16 v[36:39], v[32:35], a[48:55], v3
  v_cvt_pk_bf16_f32 v79, v70, v71
  v_cvt_pk_bf16_f32 v66, v56, v57
  v_smfmac_f32_16x16x64_bf16 v[40:43], v[24:27], a[88:95], v3
  v_cvt_pk_bf16_f32 v67, v58, v59
  v_smfmac_f32_16x16x64_bf16 v[40:43], v[28:31], a[96:103], v3
  v_mfma_f32_16x16x32_bf16 v[72:75], v[64:67], v[4:7], 0
  ds_read_b128 v[52:55], v116 offset:16384
  ds_read_b128 v[56:59], v116 offset:17408
  v_smfmac_f32_16x16x64_bf16 v[40:43], v[32:35], a[104:111], v3
  v_cvt_pk_bf16_f32 v64, v36, v37
  v_smfmac_f32_16x16x64_bf16 v[44:47], v[24:27], a[144:151], v3
  v_cvt_pk_bf16_f32 v65, v38, v39
  v_smfmac_f32_16x16x64_bf16 v[44:47], v[28:31], a[152:159], v3
  v_cvt_pk_bf16_f32 v76, v72, v73
  v_smfmac_f32_16x16x64_bf16 v[44:47], v[32:35], a[160:167], v3
  v_cvt_pk_bf16_f32 v77, v74, v75
  v_cvt_pk_bf16_f32 v66, v40, v41
  v_smfmac_f32_16x16x64_bf16 v[48:51], v[24:27], a[200:207], v3
  v_cvt_pk_bf16_f32 v67, v42, v43
  v_smfmac_f32_16x16x64_bf16 v[48:51], v[28:31], a[208:215], v3
  v_mfma_f32_16x16x32_bf16 v[68:71], v[64:67], v[4:7], 0
  v_smfmac_f32_16x16x64_bf16 v[48:51], v[32:35], a[216:223], v3
  v_cvt_pk_bf16_f32 v64, v44, v45
  v_mfma_f32_16x16x32_bf16 v[84:87], v[80:83], v[76:79], 0
  v_cvt_pk_bf16_f32 v65, v46, v47
  s_waitcnt lgkmcnt(0)
  v_smfmac_f32_16x16x64_bf16 v[88:91], v[76:79], v[96:103], v118
  v_cvt_pk_bf16_f32 v60, v68, v69
  v_cvt_pk_bf16_f32 v61, v70, v71
  v_cvt_pk_bf16_f32 v66, v48, v49
  v_cvt_pk_bf16_f32 v67, v50, v51
  s_nop 1
  v_mfma_f32_16x16x32_bf16 v[72:75], v[64:67], v[4:7], 0
  v_smfmac_f32_16x16x64_bf16 v[92:95], v[76:79], v[104:111], v118
  s_nop 4
  v_cvt_pk_bf16_f32 v62, v72, v73
  v_cvt_pk_bf16_f32 v63, v74, v75
  s_nop 1
  v_mfma_f32_16x16x32_bf16 v[84:87], v[12:15], v[60:63], v[84:87]
  v_smfmac_f32_16x16x64_bf16 v[88:91], v[60:63], v[16:23], v118
  v_smfmac_f32_16x16x64_bf16 v[92:95], v[60:63], v[52:59], v118
  s_nop 1
  v_permlane32_swap_b32 v84, v86
  v_permlane32_swap_b32 v85, v87
  s_nop 0
  v_add_f32 v88, v88, v89
  v_add_f32_dpp v84, v86, v84 quad_perm:[1,0,3,2] row_mask:0xf bank_mask:0xf
  v_add_f32_dpp v85, v87, v85 quad_perm:[1,0,3,2] row_mask:0xf bank_mask:0xf
  v_add_f32 v89, v90, v91
  ds_write2_b32 v113, v84, v85 offset0:0 offset1:4
  ds_write2_b32 v112, v88, v89 offset0:0 offset1:128
  v_add_f32 v90, v92, v93
  v_add_f32 v91, v94, v95
  ds_write2_b32 v112, v90, v91 offset0:64 offset1:192
  v_cmp_u_f32 vcc, v88, v89
  s_cbranch_vccnz cA_sc1_retry
cA_sc1_cont:
  s_waitcnt lgkmcnt(0)
  s_barrier
  ds_read_b128 v[36:39], v114
  ds_read_b128 v[44:47], v115
  s_waitcnt lgkmcnt(0)
  v_add_f32 v36, v36, v38
  v_add_f32 v37, v37, v39
  v_add_f32 v44, v44, v45
  v_add_f32 v46, v46, v47
  v_add_f32 v44, v44, v46
  v_add_f32 v36, v36, v37
  v_exp_f32 v49, v44
  v_exp_f32 v48, v36
  v_add_f32 v50, abs(v36), abs(v44)
  v_fma_f32 v39, v49, s37, v48
  v_cmp_ngt_f32 vcc, s56, v50
  v_cndmask_b32 v41, v48, v49, s[38:39]
  v_add_f32_dpp v39, v39, v39 quad_perm:[1,0,3,2] row_mask:0xf bank_mask:0xf
  v_cndmask_b32 v40, v49, v48, s[38:39]
  v_mov_b32_dpp v46, v41 quad_perm:[1,0,3,2] row_mask:0xf bank_mask:0xf
  v_add_f32_dpp v39, v39, v39 quad_perm:[2,3,0,1] row_mask:0xf bank_mask:0xf
  v_cndmask_b32 v42, v46, v40, s[38:39]
  v_cndmask_b32 v43, v40, v46, s[38:39]
  v_add_f32_dpp v39, v39, v39 row_half_mirror row_mask:0xf bank_mask:0xf
  s_cbranch_vccnz cA_sc1_slow
  s_nop 0
  v_add_f32_dpp v47, v39, v39 row_mirror row_mask:0xf bank_mask:0xf
  v_add_f32_dpp v39, v39, v39 row_mirror row_mask:0xf bank_mask:0xf
  s_nop 1
  v_permlane16_swap_b32 v39, v47
  v_add_f32 v39, v39, v47
  v_rcp_f32 v39, v39
  s_mov_b64 exec, s[28:29]
  v_mul_f32 v42, v42, v39
  v_mul_f32 v43, v43, v39
  v_cvt_pk_bf16_f32 v42, v42, v43
cA_sc1_pst:
  buffer_store_dword v42, v1, s[8:11], s20 offen
  s_mov_b64 exec, -1
  s_barrier
  s_add_u32 s24, s24, 28672
  s_add_u32 s35, s35, 28672
  s_xor_b32 s25, s25, 28672
  s_add_u32 m0, s25, 7168
  s_nop 0
  buffer_load_dwordx4 v2, s[8:11], s24 offen offset:0 sc1 lds
  buffer_load_dwordx4 v2, s[8:11], s24 offen offset:1024 sc1 lds
  buffer_load_dwordx4 v2, s[8:11], s24 offen offset:2048 sc1 lds
  buffer_load_dwordx4 v2, s[8:11], s24 offen offset:3072 sc1 lds
  s_add_u32 m0, s25, 11264
  s_add_u32 s22, s24, 4096
  buffer_load_dwordx4 v2, s[8:11], s22 offen offset:0 sc1 lds
  buffer_load_dwordx4 v2, s[8:11], s22 offen offset:1024 sc1 lds
  buffer_load_dwordx4 v2, s[8:11], s22 offen offset:2048 sc1 lds
  v_xor_b32 v116, 28672, v116
  v_add_u32 v117, s57, v117
  s_sub_u32 s57, 0, s57
  s_add_u32 s19, s19, 1
  s_mov_b32 s20, s21
  s_cmp_lt_u32 s19, 63
  s_cbranch_scc1 cA_sc1_loop
  s_branch cA_done
cA_sc1_slow:
  v_max_f32 v50, v36, v44
  s_nop 1
  v_max_f32_dpp v50, v50, v50 quad_perm:[1,0,3,2] row_mask:0xf bank_mask:0xf
  s_nop 1
  v_max_f32_dpp v50, v50, v50 quad_perm:[2,3,0,1] row_mask:0xf bank_mask:0xf
  s_nop 1
  v_max_f32_dpp v50, v50, v50 row_half_mirror row_mask:0xf bank_mask:0xf
  s_nop 1
  v_max_f32_dpp v50, v50, v50 row_mirror row_mask:0xf bank_mask:0xf
  v_mov_b32 v47, v50
  s_nop 1
  v_permlane16_swap_b32 v50, v47
  v_max_f32 v50, v50, v47
  v_sub_f32 v48, v36, v50
  v_sub_f32 v49, v44, v50
  v_exp_f32 v48, v48
  v_exp_f32 v49, v49
  s_add_u32 s31, s31, 0x100
  v_fma_f32 v39, v49, s37, v48
  v_cndmask_b32 v41, v48, v49, s[38:39]
  s_nop 0
  v_add_f32_dpp v39, v39, v39 quad_perm:[1,0,3,2] row_mask:0xf bank_mask:0xf
  v_cndmask_b32 v40, v49, v48, s[38:39]
  v_mov_b32_dpp v46, v41 quad_perm:[1,0,3,2] row_mask:0xf bank_mask:0xf
  v_add_f32_dpp v39, v39, v39 quad_perm:[2,3,0,1] row_mask:0xf bank_mask:0xf
  v_cndmask_b32 v42, v46, v40, s[38:39]
  v_cndmask_b32 v43, v40, v46, s[38:39]
  v_add_f32_dpp v39, v39, v39 row_half_mirror row_mask:0xf bank_mask:0xf
  s_nop 1
  v_add_f32_dpp v47, v39, v39 row_mirror row_mask:0xf bank_mask:0xf
  v_add_f32_dpp v39, v39, v39 row_mirror row_mask:0xf bank_mask:0xf
  s_nop 1
  v_permlane16_swap_b32 v39, v47
  v_add_f32 v39, v39, v47
  v_rcp_f32 v39, v39
  s_mov_b64 exec, s[28:29]
  v_mul_f32 v42, v42, v39
  v_mul_f32 v43, v43, v39
  v_cvt_pk_bf16_f32 v42, v42, v43
  v_min_u32 v42, -2, v42
  s_branch cA_sc1_pst
cA_sc1_retry:
  s_cmp_lg_u32 s62, 0
  s_cbranch_scc1 cA_sc1_cont
  s_waitcnt vmcnt(0) lgkmcnt(0)
cA_sc1_rv:
  buffer_load_dwordx4 v[8:11], v2, s[8:11], s20 offen offset:0 sc1
  buffer_load_dwordx4 v[12:15], v2, s[8:11], s20 offen offset:1024 sc1
  buffer_load_dwordx4 v[16:19], v2, s[8:11], s20 offen offset:2048 sc1
  buffer_load_dwordx4 v[20:23], v2, s[8:11], s20 offen offset:3072 sc1
  buffer_load_dwordx4 v[24:27], v2, s[8:11], s23 offen offset:0 sc1
  buffer_load_dwordx4 v[28:31], v2, s[8:11], s23 offen offset:1024 sc1
  buffer_load_dwordx4 v[32:35], v2, s[8:11], s23 offen offset:2048 sc1
  s_waitcnt vmcnt(0)
  v_max3_u32 v68, v8, v9, v10
  v_max3_u32 v68, v68, v11, v12
  v_max3_u32 v68, v68, v13, v14
  v_max3_u32 v68, v68, v15, v16
  v_max3_u32 v68, v68, v17, v18
  v_max3_u32 v68, v68, v19, v20
  v_max3_u32 v68, v68, v21, v22
  v_max3_u32 v68, v68, v23, v24
  v_max3_u32 v68, v68, v25, v26
  v_max3_u32 v68, v68, v27, v28
  v_max3_u32 v68, v68, v29, v30
  v_max3_u32 v68, v68, v31, v32
  v_max3_u32 v68, v68, v33, v34
  v_max_u32 v68, v68, v35
  v_cmp_eq_u32 vcc, -1, v68
  s_cbranch_vccz cA_sc1_rk
  s_add_u32 s30, s30, 1
  s_cmp_lt_u32 s30, 400000
  s_cbranch_scc1 cA_sc1_rv
  s_branch cA_abort
cA_sc1_rk:
  s_mov_b32 s62, 1
  v_mov_b32 v36, 0
  v_mov_b32 v37, 0
  v_mov_b32 v38, 0
  v_mov_b32 v39, 0
  v_mov_b32 v40, 0
  v_mov_b32 v41, 0
  v_mov_b32 v42, 0
  v_mov_b32 v43, 0
  v_mov_b32 v44, 0
  v_mov_b32 v45, 0
  v_mov_b32 v46, 0
  v_mov_b32 v47, 0
  v_mov_b32 v48, 0
  v_mov_b32 v49, 0
  v_mov_b32 v50, 0
  v_mov_b32 v51, 0
  v_mov_b32 v52, 0
  v_mov_b32 v53, 0
  v_mov_b32 v54, 0
  v_mov_b32 v55, 0
  v_mov_b32 v56, 0
  v_mov_b32 v57, 0
  v_mov_b32 v58, 0
  v_mov_b32 v59, 0
  v_mov_b32 v60, 0
  v_mov_b32 v61, 0
  v_mov_b32 v62, 0
  v_mov_b32 v63, 0
  v_mov_b32 v88, 0
  v_mov_b32 v89, 0
  v_mov_b32 v90, 0
  v_mov_b32 v91, 0
  v_mov_b32 v92, 0
  v_mov_b32 v93, 0
  v_mov_b32 v94, 0
  v_mov_b32 v95, 0
  v_mov_b32 v64, 0
  v_mov_b32 v65, 0
  s_add_u32 s31, s31, 1
  ds_read_b128 v[96:99], v117 offset:0
  ds_read_b128 v[100:103], v117 offset:1024
  ds_read_b128 v[104:107], v117 offset:14336
  ds_read_b128 v[108:111], v117 offset:15360
  v_smfmac_f32_16x16x64_bf16 v[36:39], v[8:11], a[0:7], v3
  v_smfmac_f32_16x16x64_bf16 v[40:43], v[8:11], a[56:63], v3
  v_smfmac_f32_16x16x64_bf16 v[44:47], v[8:11], a[112:119], v3
  v_smfmac_f32_16x16x64_bf16 v[48:51], v[8:11], a[168:175], v3
  v_smfmac_f32_16x16x64_bf16 v[52:55], v[8:11], a[224:231], v3
  v_smfmac_f32_16x16x64_bf16 v[56:59], v[8:11], v[144:151], v3
  v_smfmac_f32_16x16x64_bf16 v[60:63], v[8:11], v[200:207], v3
  v_smfmac_f32_16x16x64_bf16 v[36:39], v[12:15], a[8:15], v3
  v_smfmac_f32_16x16x64_bf16 v[40:43], v[12:15], a[64:71], v3
  v_smfmac_f32_16x16x64_bf16 v[44:47], v[12:15], a[120:127], v3
  v_smfmac_f32_16x16x64_bf16 v[48:51], v[12:15], a[176:183], v3
  v_smfmac_f32_16x16x64_bf16 v[52:55], v[12:15], a[232:239], v3
  v_smfmac_f32_16x16x64_bf16 v[56:59], v[12:15], v[152:159], v3
  v_smfmac_f32_16x16x64_bf16 v[60:63], v[12:15], v[208:215], v3
  v_smfmac_f32_16x16x64_bf16 v[36:39], v[16:19], a[16:23], v3
  v_smfmac_f32_16x16x64_bf16 v[40:43], v[16:19], a[72:79], v3
  v_smfmac_f32_16x16x64_bf16 v[44:47], v[16:19], a[128:135], v3
  v_smfmac_f32_16x16x64_bf16 v[48:51], v[16:19], a[184:191], v3
  v_smfmac_f32_16x16x64_bf16 v[52:55], v[16:19], a[240:247], v3
  v_smfmac_f32_16x16x64_bf16 v[56:59], v[16:19], v[160:167], v3
  v_smfmac_f32_16x16x64_bf16 v[60:63], v[16:19], v[216:223], v3
  v_smfmac_f32_16x16x64_bf16 v[36:39], v[20:23], a[24:31], v3
  v_smfmac_f32_16x16x64_bf16 v[40:43], v[20:23], a[80:87], v3
  v_smfmac_f32_16x16x64_bf16 v[44:47], v[20:23], a[136:143], v3
  v_smfmac_f32_16x16x64_bf16 v[48:51], v[20:23], a[192:199], v3
  v_smfmac_f32_16x16x64_bf16 v[52:55], v[20:23], a[248:255], v3
  v_smfmac_f32_16x16x64_bf16 v[56:59], v[20:23], v[168:175], v3
  v_smfmac_f32_16x16x64_bf16 v[60:63], v[20:23], v[224:231], v3
  s_branch cA_sc1_ph2
.p2align 6

cA_sc2_loop:
  s_add_u32 s23, s20, 4096
  s_add_u32 s21, s20, 20480
  v_mov_b32 v48, 0
  v_mov_b32 v49, 0
  v_mov_b32 v50, 0
  v_mov_b32 v51, 0
  v_mov_b32 v52, 0
  v_mov_b32 v53, 0
  v_mov_b32 v54, 0
  v_mov_b32 v55, 0
  v_mov_b32 v56, 0
  v_mov_b32 v57, 0
  v_mov_b32 v58, 0
  v_mov_b32 v59, 0
  v_mov_b32 v60, 0
  v_mov_b32 v61, 0
  v_mov_b32 v62, 0
  v_mov_b32 v63, 0
  v_mov_b32 v88, 0
  v_mov_b32 v89, 0
  v_mov_b32 v90, 0
  v_mov_b32 v91, 0
  v_mov_b32 v92, 0
  v_mov_b32 v93, 0
  v_mov_b32 v94, 0
  v_mov_b32 v95, 0
  v_mov_b32 v66, 0
  v_mov_b32 v67, 0
  s_mov_b32 s30, 0
  s_mov_b32 s62, 0
  s_waitcnt vmcnt(0)
  s_barrier
cA_sc2_ld:
  buffer_load_dwordx4 v[8:11], v2, s[8:11], s20 offen offset:0
  v_mov_b32 v36, 0
  v_mov_b32 v37, 0
  v_mov_b32 v38, 0
  v_mov_b32 v39, 0
  buffer_load_dwordx4 v[12:15], v2, s[8:11], s20 offen offset:1024
  v_mov_b32 v40, 0
  v_mov_b32 v41, 0
  v_mov_b32 v42, 0
  v_mov_b32 v43, 0
  buffer_load_dwordx4 v[16:19], v2, s[8:11], s20 offen offset:2048
  v_mov_b32 v44, 0
  v_mov_b32 v45, 0
  v_mov_b32 v46, 0
  v_mov_b32 v47, 0
  ds_read_b128 v[96:99], v117 offset:0
  ds_read_b128 v[100:103], v117 offset:1024
  ds_read_b128 v[104:107], v117 offset:14336
  ds_read_b128 v[108:111], v117 offset:15360
  s_waitcnt vmcnt(2)
  v_smfmac_f32_16x16x64_bf16 v[36:39], v[8:11], a[0:7], v3
  v_smfmac_f32_16x16x64_bf16 v[40:43], v[8:11], a[56:63], v3
  buffer_load_dwordx4 v[20:23], v2, s[8:11], s20 offen offset:3072
  v_smfmac_f32_16x16x64_bf16 v[44:47], v[8:11], a[112:119], v3
  v_smfmac_f32_16x16x64_bf16 v[48:51], v[8:11], a[168:175], v3
  v_smfmac_f32_16x16x64_bf16 v[52:55], v[8:11], a[224:231], v3
  buffer_load_dwordx4 v[24:27], v2, s[8:11], s23 offen offset:0
  v_smfmac_f32_16x16x64_bf16 v[56:59], v[8:11], v[144:151], v3
  v_smfmac_f32_16x16x64_bf16 v[60:63], v[8:11], v[200:207], v3
  s_waitcnt vmcnt(3)
  v_smfmac_f32_16x16x64_bf16 v[36:39], v[12:15], a[8:15], v3
  v_smfmac_f32_16x16x64_bf16 v[40:43], v[12:15], a[64:71], v3
  buffer_load_dwordx4 v[28:31], v2, s[8:11], s23 offen offset:1024
  v_smfmac_f32_16x16x64_bf16 v[44:47], v[12:15], a[120:127], v3
  v_smfmac_f32_16x16x64_bf16 v[48:51], v[12:15], a[176:183], v3
  v_smfmac_f32_16x16x64_bf16 v[52:55], v[12:15], a[232:239], v3
  buffer_load_dwordx4 v[32:35], v2, s[8:11], s23 offen offset:2048
  v_smfmac_f32_16x16x64_bf16 v[56:59], v[12:15], v[152:159], v3
  v_smfmac_f32_16x16x64_bf16 v[60:63], v[12:15], v[208:215], v3
  s_waitcnt vmcnt(4)
  v_smfmac_f32_16x16x64_bf16 v[36:39], v[16:19], a[16:23], v3
  v_smfmac_f32_16x16x64_bf16 v[40:43], v[16:19], a[72:79], v3
  v_smfmac_f32_16x16x64_bf16 v[44:47], v[16:19], a[128:135], v3
  v_smfmac_f32_16x16x64_bf16 v[48:51], v[16:19], a[184:191], v3
  v_smfmac_f32_16x16x64_bf16 v[52:55], v[16:19], a[240:247], v3
  v_smfmac_f32_16x16x64_bf16 v[56:59], v[16:19], v[160:167], v3
  v_smfmac_f32_16x16x64_bf16 v[60:63], v[16:19], v[216:223], v3
  s_waitcnt vmcnt(3)
  v_smfmac_f32_16x16x64_bf16 v[36:39], v[20:23], a[24:31], v3
  v_smfmac_f32_16x16x64_bf16 v[40:43], v[20:23], a[80:87], v3
  v_smfmac_f32_16x16x64_bf16 v[44:47], v[20:23], a[136:143], v3
  v_smfmac_f32_16x16x64_bf16 v[48:51], v[20:23], a[192:199], v3
  v_smfmac_f32_16x16x64_bf16 v[52:55], v[20:23], a[248:255], v3
  v_smfmac_f32_16x16x64_bf16 v[56:59], v[20:23], v[168:175], v3
  v_smfmac_f32_16x16x64_bf16 v[60:63], v[20:23], v[224:231], v3
  s_waitcnt vmcnt(0)
cA_sc2_ph2:
  v_smfmac_f32_16x16x64_bf16 v[60:63], v[24:27], v[232:239], v3
  ds_read_b128 v[8:11], v116 offset:4096
  ds_read_b128 v[12:15], v116 offset:5120
  v_smfmac_f32_16x16x64_bf16 v[60:63], v[28:31], v[240:247], v3
  buffer_load_dword v119, v0, s[8:11], s24 offen sc1
  v_smfmac_f32_16x16x64_bf16 v[60:63], v[32:35], v[248:255], v3
  v_mov_b32 v80, v28
  v_smfmac_f32_16x16x64_bf16 v[52:55], v[24:27], v[120:127], v3
  v_mov_b32 v81, v29
  v_smfmac_f32_16x16x64_bf16 v[52:55], v[28:31], v[128:135], v3
  v_mov_b32 v82, v34
  v_smfmac_f32_16x16x64_bf16 v[52:55], v[32:35], v[136:143], v3
  v_cvt_pk_bf16_f32 v64, v60, v61
  v_smfmac_f32_16x16x64_bf16 v[56:59], v[24:27], v[176:183], v3
  v_cvt_pk_bf16_f32 v65, v62, v63
  v_smfmac_f32_16x16x64_bf16 v[56:59], v[28:31], v[184:191], v3
  v_mov_b32 v83, v35
  v_mfma_f32_16x16x32_bf16 v[68:71], v[64:67], v[4:7], 0
  v_smfmac_f32_16x16x64_bf16 v[56:59], v[32:35], v[192:199], v3
  v_cvt_pk_bf16_f32 v64, v52, v53
  v_smfmac_f32_16x16x64_bf16 v[36:39], v[24:27], a[32:39], v3
  v_cvt_pk_bf16_f32 v65, v54, v55
  v_smfmac_f32_16x16x64_bf16 v[36:39], v[28:31], a[40:47], v3
  v_cvt_pk_bf16_f32 v78, v68, v69
  v_smfmac_f32_16x16x64_bf16 v[36:39], v[32:35], a[48:55], v3
  v_cvt_pk_bf16_f32 v79, v70, v71
  v_cvt_pk_bf16_f32 v66, v56, v57
  v_smfmac_f32_16x16x64_bf16 v[40:43], v[24:27], a[88:95], v3
  v_cvt_pk_bf16_f32 v67, v58, v59
  v_smfmac_f32_16x16x64_bf16 v[40:43], v[28:31], a[96:103], v3
  v_mfma_f32_16x16x32_bf16 v[72:75], v[64:67], v[4:7], 0
  ds_read_b128 v[52:55], v116 offset:18432
  ds_read_b128 v[56:59], v116 offset:19456
  v_smfmac_f32_16x16x64_bf16 v[40:43], v[32:35], a[104:111], v3
  v_cvt_pk_bf16_f32 v64, v36, v37
  v_smfmac_f32_16x16x64_bf16 v[44:47], v[24:27], a[144:151], v3
  v_cvt_pk_bf16_f32 v65, v38, v39
  v_smfmac_f32_16x16x64_bf16 v[44:47], v[28:31], a[152:159], v3
  v_cvt_pk_bf16_f32 v76, v72, v73
  v_smfmac_f32_16x16x64_bf16 v[44:47], v[32:35], a[160:167], v3
  v_cvt_pk_bf16_f32 v77, v74, v75
  v_cvt_pk_bf16_f32 v66, v40, v41
  v_smfmac_f32_16x16x64_bf16 v[48:51], v[24:27], a[200:207], v3
  v_cvt_pk_bf16_f32 v67, v42, v43
  v_smfmac_f32_16x16x64_bf16 v[48:51], v[28:31], a[208:215], v3
  v_mfma_f32_16x16x32_bf16 v[68:71], v[64:67], v[4:7], 0
  v_smfmac_f32_16x16x64_bf16 v[48:51], v[32:35], a[216:223], v3
  v_cvt_pk_bf16_f32 v64, v44, v45
  v_mfma_f32_16x16x32_bf16 v[84:87], v[80:83], v[76:79], 0
  v_cvt_pk_bf16_f32 v65, v46, v47
  s_waitcnt lgkmcnt(0)
  v_smfmac_f32_16x16x64_bf16 v[88:91], v[76:79], v[96:103], v118
  v_cvt_pk_bf16_f32 v60, v68, v69
  v_cvt_pk_bf16_f32 v61, v70, v71
  v_cvt_pk_bf16_f32 v66, v48, v49
  v_cvt_pk_bf16_f32 v67, v50, v51
  s_nop 1
  v_mfma_f32_16x16x32_bf16 v[72:75], v[64:67], v[4:7], 0
  v_smfmac_f32_16x16x64_bf16 v[92:95], v[76:79], v[104:111], v118
  s_nop 4
  v_cvt_pk_bf16_f32 v62, v72, v73
  v_cvt_pk_bf16_f32 v63, v74, v75
  s_nop 1
  v_mfma_f32_16x16x32_bf16 v[84:87], v[16:19], v[60:63], v[84:87]
  v_smfmac_f32_16x16x64_bf16 v[88:91], v[60:63], v[8:15], v118
  v_smfmac_f32_16x16x64_bf16 v[92:95], v[60:63], v[52:59], v118
  s_nop 1
  v_permlane32_swap_b32 v84, v86
  v_permlane32_swap_b32 v85, v87
  s_nop 0
  v_add_f32 v88, v88, v89
  v_add_f32_dpp v84, v86, v84 quad_perm:[1,0,3,2] row_mask:0xf bank_mask:0xf
  v_add_f32_dpp v85, v87, v85 quad_perm:[1,0,3,2] row_mask:0xf bank_mask:0xf
  v_add_f32 v89, v90, v91
  ds_write2_b32 v113, v84, v85 offset0:0 offset1:4
  ds_write2_b32 v112, v88, v89 offset0:0 offset1:128
  v_add_f32 v90, v92, v93
  v_add_f32 v91, v94, v95
  ds_write2_b32 v112, v90, v91 offset0:64 offset1:192
  v_cmp_u_f32 vcc, v88, v89
  s_cbranch_vccnz cA_sc2_retry
cA_sc2_cont:
  s_waitcnt lgkmcnt(0)
  s_barrier
  ds_read_b128 v[36:39], v114
  ds_read_b128 v[44:47], v115
  v_lshl_add_u32 v56, v2, 3, s36
  s_waitcnt lgkmcnt(0)
  v_add_f32 v36, v36, v38
  v_add_f32 v37, v37, v39
  v_add_f32 v44, v44, v45
  s_mov_b64 exec, 15
  buffer_store_dword v2, v56, s[8:11], s20 offen
  s_mov_b64 exec, -1
  v_add_f32 v46, v46, v47
  v_add_f32 v44, v44, v46
  v_add_f32 v36, v36, v37
  v_exp_f32 v49, v44
  v_exp_f32 v48, v36
  v_add_f32 v50, abs(v36), abs(v44)
  v_fma_f32 v39, v49, s37, v48
  v_cmp_ngt_f32 vcc, s56, v50
  v_cndmask_b32 v41, v48, v49, s[38:39]
  v_add_f32_dpp v39, v39, v39 quad_perm:[1,0,3,2] row_mask:0xf bank_mask:0xf
  v_cndmask_b32 v40, v49, v48, s[38:39]
  v_mov_b32_dpp v46, v41 quad_perm:[1,0,3,2] row_mask:0xf bank_mask:0xf
  v_add_f32_dpp v39, v39, v39 quad_perm:[2,3,0,1] row_mask:0xf bank_mask:0xf
  v_cndmask_b32 v42, v46, v40, s[38:39]
  v_cndmask_b32 v43, v40, v46, s[38:39]
  v_add_f32_dpp v39, v39, v39 row_half_mirror row_mask:0xf bank_mask:0xf
  s_cbranch_vccnz cA_sc2_slow
  s_nop 0
  v_add_f32_dpp v47, v39, v39 row_mirror row_mask:0xf bank_mask:0xf
  v_add_f32_dpp v39, v39, v39 row_mirror row_mask:0xf bank_mask:0xf
  s_nop 1
  v_permlane16_swap_b32 v39, v47
  v_add_f32 v39, v39, v47
  v_rcp_f32 v39, v39
  s_mov_b64 exec, s[28:29]
  v_mul_f32 v42, v42, v39
  v_mul_f32 v43, v43, v39
  v_cvt_pk_bf16_f32 v42, v42, v43
cA_sc2_pst:
  buffer_store_dword v42, v1, s[8:11], s20 offen
  s_mov_b64 exec, -1
  s_barrier
  s_add_u32 s24, s24, 28672
  s_add_u32 s35, s35, 28672
  s_xor_b32 s25, s25, 28672
  s_add_u32 m0, s25, 14336
  s_nop 0
  buffer_load_dwordx4 v2, s[8:11], s24 offen offset:0 sc1 lds
  buffer_load_dwordx4 v2, s[8:11], s24 offen offset:1024 sc1 lds
  buffer_load_dwordx4 v2, s[8:11], s24 offen offset:2048 sc1 lds
  buffer_load_dwordx4 v2, s[8:11], s24 offen offset:3072 sc1 lds
  s_add_u32 m0, s25, 18432
  s_add_u32 s22, s24, 4096
  buffer_load_dwordx4 v2, s[8:11], s22 offen offset:0 sc1 lds
  buffer_load_dwordx4 v2, s[8:11], s22 offen offset:1024 sc1 lds
  buffer_load_dwordx4 v2, s[8:11], s22 offen offset:2048 sc1 lds
  v_xor_b32 v116, 28672, v116
  v_add_u32 v117, s57, v117
  s_sub_u32 s57, 0, s57
  s_add_u32 s19, s19, 1
  s_mov_b32 s20, s21
  s_cmp_lt_u32 s19, 63
  s_cbranch_scc1 cA_sc2_loop
  s_branch cA_done
cA_sc2_slow:
  v_max_f32 v50, v36, v44
  s_nop 1
  v_max_f32_dpp v50, v50, v50 quad_perm:[1,0,3,2] row_mask:0xf bank_mask:0xf
  s_nop 1
  v_max_f32_dpp v50, v50, v50 quad_perm:[2,3,0,1] row_mask:0xf bank_mask:0xf
  s_nop 1
  v_max_f32_dpp v50, v50, v50 row_half_mirror row_mask:0xf bank_mask:0xf
  s_nop 1
  v_max_f32_dpp v50, v50, v50 row_mirror row_mask:0xf bank_mask:0xf
  v_mov_b32 v47, v50
  s_nop 1
  v_permlane16_swap_b32 v50, v47
  v_max_f32 v50, v50, v47
  v_sub_f32 v48, v36, v50
  v_sub_f32 v49, v44, v50
  v_exp_f32 v48, v48
  v_exp_f32 v49, v49
  s_add_u32 s31, s31, 0x100
  v_fma_f32 v39, v49, s37, v48
  v_cndmask_b32 v41, v48, v49, s[38:39]
  s_nop 0
  v_add_f32_dpp v39, v39, v39 quad_perm:[1,0,3,2] row_mask:0xf bank_mask:0xf
  v_cndmask_b32 v40, v49, v48, s[38:39]
  v_mov_b32_dpp v46, v41 quad_perm:[1,0,3,2] row_mask:0xf bank_mask:0xf
  v_add_f32_dpp v39, v39, v39 quad_perm:[2,3,0,1] row_mask:0xf bank_mask:0xf
  v_cndmask_b32 v42, v46, v40, s[38:39]
  v_cndmask_b32 v43, v40, v46, s[38:39]
  v_add_f32_dpp v39, v39, v39 row_half_mirror row_mask:0xf bank_mask:0xf
  s_nop 1
  v_add_f32_dpp v47, v39, v39 row_mirror row_mask:0xf bank_mask:0xf
  v_add_f32_dpp v39, v39, v39 row_mirror row_mask:0xf bank_mask:0xf
  s_nop 1
  v_permlane16_swap_b32 v39, v47
  v_add_f32 v39, v39, v47
  v_rcp_f32 v39, v39
  s_mov_b64 exec, s[28:29]
  v_mul_f32 v42, v42, v39
  v_mul_f32 v43, v43, v39
  v_cvt_pk_bf16_f32 v42, v42, v43
  v_min_u32 v42, -2, v42
  s_branch cA_sc2_pst
cA_sc2_retry:
  s_cmp_lg_u32 s62, 0
  s_cbranch_scc1 cA_sc2_cont
  s_waitcnt vmcnt(0) lgkmcnt(0)
cA_sc2_rv:
  buffer_load_dwordx4 v[8:11], v2, s[8:11], s20 offen offset:0 sc1
  buffer_load_dwordx4 v[12:15], v2, s[8:11], s20 offen offset:1024 sc1
  buffer_load_dwordx4 v[16:19], v2, s[8:11], s20 offen offset:2048 sc1
  buffer_load_dwordx4 v[20:23], v2, s[8:11], s20 offen offset:3072 sc1
  buffer_load_dwordx4 v[24:27], v2, s[8:11], s23 offen offset:0 sc1
  buffer_load_dwordx4 v[28:31], v2, s[8:11], s23 offen offset:1024 sc1
  buffer_load_dwordx4 v[32:35], v2, s[8:11], s23 offen offset:2048 sc1
  s_waitcnt vmcnt(0)
  v_max3_u32 v68, v8, v9, v10
  v_max3_u32 v68, v68, v11, v12
  v_max3_u32 v68, v68, v13, v14
  v_max3_u32 v68, v68, v15, v16
  v_max3_u32 v68, v68, v17, v18
  v_max3_u32 v68, v68, v19, v20
  v_max3_u32 v68, v68, v21, v22
  v_max3_u32 v68, v68, v23, v24
  v_max3_u32 v68, v68, v25, v26
  v_max3_u32 v68, v68, v27, v28
  v_max3_u32 v68, v68, v29, v30
  v_max3_u32 v68, v68, v31, v32
  v_max3_u32 v68, v68, v33, v34
  v_max_u32 v68, v68, v35
  v_cmp_eq_u32 vcc, -1, v68
  s_cbranch_vccz cA_sc2_rk
  s_add_u32 s30, s30, 1
  s_cmp_lt_u32 s30, 400000
  s_cbranch_scc1 cA_sc2_rv
  s_branch cA_abort
cA_sc2_rk:
  s_mov_b32 s62, 1
  v_mov_b32 v36, 0
  v_mov_b32 v37, 0
  v_mov_b32 v38, 0
  v_mov_b32 v39, 0
  v_mov_b32 v40, 0
  v_mov_b32 v41, 0
  v_mov_b32 v42, 0
  v_mov_b32 v43, 0
  v_mov_b32 v44, 0
  v_mov_b32 v45, 0
  v_mov_b32 v46, 0
  v_mov_b32 v47, 0
  v_mov_b32 v48, 0
  v_mov_b32 v49, 0
  v_mov_b32 v50, 0
  v_mov_b32 v51, 0
  v_mov_b32 v52, 0
  v_mov_b32 v53, 0
  v_mov_b32 v54, 0
  v_mov_b32 v55, 0
  v_mov_b32 v56, 0
  v_mov_b32 v57, 0
  v_mov_b32 v58, 0
  v_mov_b32 v59, 0
  v_mov_b32 v60, 0
  v_mov_b32 v61, 0
  v_mov_b32 v62, 0
  v_mov_b32 v63, 0
  v_mov_b32 v88, 0
  v_mov_b32 v89, 0
  v_mov_b32 v90, 0
  v_mov_b32 v91, 0
  v_mov_b32 v92, 0
  v_mov_b32 v93, 0
  v_mov_b32 v94, 0
  v_mov_b32 v95, 0
  v_mov_b32 v66, 0
  v_mov_b32 v67, 0
  s_add_u32 s31, s31, 1
  ds_read_b128 v[96:99], v117 offset:0
  ds_read_b128 v[100:103], v117 offset:1024
  ds_read_b128 v[104:107], v117 offset:14336
  ds_read_b128 v[108:111], v117 offset:15360
  v_smfmac_f32_16x16x64_bf16 v[36:39], v[8:11], a[0:7], v3
  v_smfmac_f32_16x16x64_bf16 v[40:43], v[8:11], a[56:63], v3
  v_smfmac_f32_16x16x64_bf16 v[44:47], v[8:11], a[112:119], v3
  v_smfmac_f32_16x16x64_bf16 v[48:51], v[8:11], a[168:175], v3
  v_smfmac_f32_16x16x64_bf16 v[52:55], v[8:11], a[224:231], v3
  v_smfmac_f32_16x16x64_bf16 v[56:59], v[8:11], v[144:151], v3
  v_smfmac_f32_16x16x64_bf16 v[60:63], v[8:11], v[200:207], v3
  v_smfmac_f32_16x16x64_bf16 v[36:39], v[12:15], a[8:15], v3
  v_smfmac_f32_16x16x64_bf16 v[40:43], v[12:15], a[64:71], v3
  v_smfmac_f32_16x16x64_bf16 v[44:47], v[12:15], a[120:127], v3
  v_smfmac_f32_16x16x64_bf16 v[48:51], v[12:15], a[176:183], v3
  v_smfmac_f32_16x16x64_bf16 v[52:55], v[12:15], a[232:239], v3
  v_smfmac_f32_16x16x64_bf16 v[56:59], v[12:15], v[152:159], v3
  v_smfmac_f32_16x16x64_bf16 v[60:63], v[12:15], v[208:215], v3
  v_smfmac_f32_16x16x64_bf16 v[36:39], v[16:19], a[16:23], v3
  v_smfmac_f32_16x16x64_bf16 v[40:43], v[16:19], a[72:79], v3
  v_smfmac_f32_16x16x64_bf16 v[44:47], v[16:19], a[128:135], v3
  v_smfmac_f32_16x16x64_bf16 v[48:51], v[16:19], a[184:191], v3
  v_smfmac_f32_16x16x64_bf16 v[52:55], v[16:19], a[240:247], v3
  v_smfmac_f32_16x16x64_bf16 v[56:59], v[16:19], v[160:167], v3
  v_smfmac_f32_16x16x64_bf16 v[60:63], v[16:19], v[216:223], v3
  v_smfmac_f32_16x16x64_bf16 v[36:39], v[20:23], a[24:31], v3
  v_smfmac_f32_16x16x64_bf16 v[40:43], v[20:23], a[80:87], v3
  v_smfmac_f32_16x16x64_bf16 v[44:47], v[20:23], a[136:143], v3
  v_smfmac_f32_16x16x64_bf16 v[48:51], v[20:23], a[192:199], v3
  v_smfmac_f32_16x16x64_bf16 v[52:55], v[20:23], a[248:255], v3
  v_smfmac_f32_16x16x64_bf16 v[56:59], v[20:23], v[168:175], v3
  v_smfmac_f32_16x16x64_bf16 v[60:63], v[20:23], v[224:231], v3
  s_branch cA_sc2_ph2
.p2align 6

cA_sc3_loop:
  s_add_u32 s23, s20, 4096
  s_add_u32 s21, s20, 20480
  v_mov_b32 v48, 0
  v_mov_b32 v49, 0
  v_mov_b32 v50, 0
  v_mov_b32 v51, 0
  v_mov_b32 v52, 0
  v_mov_b32 v53, 0
  v_mov_b32 v54, 0
  v_mov_b32 v55, 0
  v_mov_b32 v56, 0
  v_mov_b32 v57, 0
  v_mov_b32 v58, 0
  v_mov_b32 v59, 0
  v_mov_b32 v60, 0
  v_mov_b32 v61, 0
  v_mov_b32 v62, 0
  v_mov_b32 v63, 0
  v_mov_b32 v88, 0
  v_mov_b32 v89, 0
  v_mov_b32 v90, 0
  v_mov_b32 v91, 0
  v_mov_b32 v92, 0
  v_mov_b32 v93, 0
  v_mov_b32 v94, 0
  v_mov_b32 v95, 0
  v_mov_b32 v64, 0
  v_mov_b32 v65, 0
  s_mov_b32 s30, 0
  s_mov_b32 s62, 0
  s_waitcnt vmcnt(0)
  s_barrier
cA_sc3_ld:
  buffer_load_dwordx4 v[8:11], v2, s[8:11], s20 offen offset:0
  v_mov_b32 v36, 0
  v_mov_b32 v37, 0
  v_mov_b32 v38, 0
  v_mov_b32 v39, 0
  buffer_load_dwordx4 v[12:15], v2, s[8:11], s20 offen offset:1024
  v_mov_b32 v40, 0
  v_mov_b32 v41, 0
  v_mov_b32 v42, 0
  v_mov_b32 v43, 0
  buffer_load_dwordx4 v[16:19], v2, s[8:11], s20 offen offset:2048
  v_mov_b32 v44, 0
  v_mov_b32 v45, 0
  v_mov_b32 v46, 0
  v_mov_b32 v47, 0
  ds_read_b128 v[96:99], v117 offset:0
  ds_read_b128 v[100:103], v117 offset:1024
  ds_read_b128 v[104:107], v117 offset:14336
  ds_read_b128 v[108:111], v117 offset:15360
  s_waitcnt vmcnt(2)
  v_smfmac_f32_16x16x64_bf16 v[36:39], v[8:11], a[0:7], v3
  v_smfmac_f32_16x16x64_bf16 v[40:43], v[8:11], a[56:63], v3
  buffer_load_dwordx4 v[20:23], v2, s[8:11], s20 offen offset:3072
  v_smfmac_f32_16x16x64_bf16 v[44:47], v[8:11], a[112:119], v3
  v_smfmac_f32_16x16x64_bf16 v[48:51], v[8:11], a[168:175], v3
  v_smfmac_f32_16x16x64_bf16 v[52:55], v[8:11], a[224:231], v3
  buffer_load_dwordx4 v[24:27], v2, s[8:11], s23 offen offset:0
  v_smfmac_f32_16x16x64_bf16 v[56:59], v[8:11], v[144:151], v3
  v_smfmac_f32_16x16x64_bf16 v[60:63], v[8:11], v[200:207], v3
  s_waitcnt vmcnt(3)
  v_smfmac_f32_16x16x64_bf16 v[36:39], v[12:15], a[8:15], v3
  v_smfmac_f32_16x16x64_bf16 v[40:43], v[12:15], a[64:71], v3
  buffer_load_dwordx4 v[28:31], v2, s[8:11], s23 offen offset:1024
  v_smfmac_f32_16x16x64_bf16 v[44:47], v[12:15], a[120:127], v3
  v_smfmac_f32_16x16x64_bf16 v[48:51], v[12:15], a[176:183], v3
  v_smfmac_f32_16x16x64_bf16 v[52:55], v[12:15], a[232:239], v3
  buffer_load_dwordx4 v[32:35], v2, s[8:11], s23 offen offset:2048
  v_smfmac_f32_16x16x64_bf16 v[56:59], v[12:15], v[152:159], v3
  v_smfmac_f32_16x16x64_bf16 v[60:63], v[12:15], v[208:215], v3
  s_waitcnt vmcnt(4)
  v_smfmac_f32_16x16x64_bf16 v[36:39], v[16:19], a[16:23], v3
  v_smfmac_f32_16x16x64_bf16 v[40:43], v[16:19], a[72:79], v3
  v_smfmac_f32_16x16x64_bf16 v[44:47], v[16:19], a[128:135], v3
  v_smfmac_f32_16x16x64_bf16 v[48:51], v[16:19], a[184:191], v3
  v_smfmac_f32_16x16x64_bf16 v[52:55], v[16:19], a[240:247], v3
  v_smfmac_f32_16x16x64_bf16 v[56:59], v[16:19], v[160:167], v3
  v_smfmac_f32_16x16x64_bf16 v[60:63], v[16:19], v[216:223], v3
  s_waitcnt vmcnt(3)
  v_smfmac_f32_16x16x64_bf16 v[36:39], v[20:23], a[24:31], v3
  v_smfmac_f32_16x16x64_bf16 v[40:43], v[20:23], a[80:87], v3
  v_smfmac_f32_16x16x64_bf16 v[44:47], v[20:23], a[136:143], v3
  v_smfmac_f32_16x16x64_bf16 v[48:51], v[20:23], a[192:199], v3
  v_smfmac_f32_16x16x64_bf16 v[52:55], v[20:23], a[248:255], v3
  v_smfmac_f32_16x16x64_bf16 v[56:59], v[20:23], v[168:175], v3
  v_smfmac_f32_16x16x64_bf16 v[60:63], v[20:23], v[224:231], v3
  s_waitcnt vmcnt(0)
cA_sc3_ph2:
  v_smfmac_f32_16x16x64_bf16 v[60:63], v[24:27], v[232:239], v3
  ds_read_b128 v[8:11], v116 offset:6144
  ds_read_b128 v[12:15], v116 offset:7168
  v_smfmac_f32_16x16x64_bf16 v[60:63], v[28:31], v[240:247], v3
  v_smfmac_f32_16x16x64_bf16 v[60:63], v[32:35], v[248:255], v3
  v_mov_b32 v80, v30
  v_smfmac_f32_16x16x64_bf16 v[52:55], v[24:27], v[120:127], v3
  v_mov_b32 v81, v31
  v_smfmac_f32_16x16x64_bf16 v[52:55], v[28:31], v[128:135], v3
  v_mov_b32 v82, v34
  v_smfmac_f32_16x16x64_bf16 v[52:55], v[32:35], v[136:143], v3
  v_cvt_pk_bf16_f32 v66, v60, v61
  v_smfmac_f32_16x16x64_bf16 v[56:59], v[24:27], v[176:183], v3
  v_cvt_pk_bf16_f32 v67, v62, v63
  v_smfmac_f32_16x16x64_bf16 v[56:59], v[28:31], v[184:191], v3
  v_mov_b32 v83, v35
  v_mfma_f32_16x16x32_bf16 v[68:71], v[64:67], v[4:7], 0
  v_smfmac_f32_16x16x64_bf16 v[56:59], v[32:35], v[192:199], v3
  v_cvt_pk_bf16_f32 v64, v52, v53
  v_smfmac_f32_16x16x64_bf16 v[36:39], v[24:27], a[32:39], v3
  v_cvt_pk_bf16_f32 v65, v54, v55
  v_smfmac_f32_16x16x64_bf16 v[36:39], v[28:31], a[40:47], v3
  v_cvt_pk_bf16_f32 v78, v68, v69
  v_smfmac_f32_16x16x64_bf16 v[36:39], v[32:35], a[48:55], v3
  v_cvt_pk_bf16_f32 v79, v70, v71
  v_cvt_pk_bf16_f32 v66, v56, v57
  v_smfmac_f32_16x16x64_bf16 v[40:43], v[24:27], a[88:95], v3
  v_cvt_pk_bf16_f32 v67, v58, v59
  v_smfmac_f32_16x16x64_bf16 v[40:43], v[28:31], a[96:103], v3
  v_mfma_f32_16x16x32_bf16 v[72:75], v[64:67], v[4:7], 0
  ds_read_b128 v[52:55], v116 offset:20480
  ds_read_b128 v[56:59], v116 offset:21504
  v_smfmac_f32_16x16x64_bf16 v[40:43], v[32:35], a[104:111], v3
  v_cvt_pk_bf16_f32 v64, v36, v37
  v_smfmac_f32_16x16x64_bf16 v[44:47], v[24:27], a[144:151], v3
  v_cvt_pk_bf16_f32 v65, v38, v39
  v_smfmac_f32_16x16x64_bf16 v[44:47], v[28:31], a[152:159], v3
  v_cvt_pk_bf16_f32 v76, v72, v73
  v_smfmac_f32_16x16x64_bf16 v[44:47], v[32:35], a[160:167], v3
  v_cvt_pk_bf16_f32 v77, v74, v75
  v_cvt_pk_bf16_f32 v66, v40, v41
  v_smfmac_f32_16x16x64_bf16 v[48:51], v[24:27], a[200:207], v3
  v_cvt_pk_bf16_f32 v67, v42, v43
  v_smfmac_f32_16x16x64_bf16 v[48:51], v[28:31], a[208:215], v3
  v_mfma_f32_16x16x32_bf16 v[68:71], v[64:67], v[4:7], 0
  v_smfmac_f32_16x16x64_bf16 v[48:51], v[32:35], a[216:223], v3
  v_cvt_pk_bf16_f32 v64, v44, v45
  v_mfma_f32_16x16x32_bf16 v[84:87], v[80:83], v[76:79], 0
  v_cvt_pk_bf16_f32 v65, v46, v47
  s_waitcnt lgkmcnt(0)
  v_smfmac_f32_16x16x64_bf16 v[88:91], v[76:79], v[96:103], v118
  v_cvt_pk_bf16_f32 v60, v68, v69
  v_cvt_pk_bf16_f32 v61, v70, v71
  v_cvt_pk_bf16_f32 v66, v48, v49
  v_cvt_pk_bf16_f32 v67, v50, v51
  s_nop 1
  v_mfma_f32_16x16x32_bf16 v[72:75], v[64:67], v[4:7], 0
  v_smfmac_f32_16x16x64_bf16 v[92:95], v[76:79], v[104:111], v118
  s_nop 4
  v_cvt_pk_bf16_f32 v62, v72, v73
  v_cvt_pk_bf16_f32 v63, v74, v75
  s_nop 1
  v_mfma_f32_16x16x32_bf16 v[84:87], v[20:23], v[60:63], v[84:87]
  v_smfmac_f32_16x16x64_bf16 v[88:91], v[60:63], v[8:15], v118
  v_smfmac_f32_16x16x64_bf16 v[92:95], v[60:63], v[52:59], v118
  s_nop 1
  v_permlane32_swap_b32 v84, v86
  v_permlane32_swap_b32 v85, v87
  s_nop 0
  v_add_f32 v88, v88, v89
  v_add_f32_dpp v84, v86, v84 quad_perm:[1,0,3,2] row_mask:0xf bank_mask:0xf
  v_add_f32_dpp v85, v87, v85 quad_perm:[1,0,3,2] row_mask:0xf bank_mask:0xf
  v_add_f32 v89, v90, v91
  ds_write2_b32 v113, v84, v85 offset0:0 offset1:4
  ds_write2_b32 v112, v88, v89 offset0:0 offset1:128
  v_add_f32 v90, v92, v93
  v_add_f32 v91, v94, v95
  ds_write2_b32 v112, v90, v91 offset0:64 offset1:192
  v_cmp_u_f32 vcc, v88, v89
  s_cbranch_vccnz cA_sc3_retry
cA_sc3_cont:
  s_waitcnt lgkmcnt(0)
  s_barrier
  ds_read_b128 v[36:39], v114
  ds_read_b128 v[44:47], v115
  s_waitcnt lgkmcnt(0)
  v_add_f32 v36, v36, v38
  v_add_f32 v37, v37, v39
  v_add_f32 v44, v44, v45
  v_add_f32 v46, v46, v47
  v_add_f32 v44, v44, v46
  v_add_f32 v36, v36, v37
  v_exp_f32 v49, v44
  v_exp_f32 v48, v36
  v_add_f32 v50, abs(v36), abs(v44)
  v_fma_f32 v39, v49, s37, v48
  v_cmp_ngt_f32 vcc, s56, v50
  v_cndmask_b32 v41, v48, v49, s[38:39]
  v_add_f32_dpp v39, v39, v39 quad_perm:[1,0,3,2] row_mask:0xf bank_mask:0xf
  v_cndmask_b32 v40, v49, v48, s[38:39]
  v_mov_b32_dpp v46, v41 quad_perm:[1,0,3,2] row_mask:0xf bank_mask:0xf
  v_add_f32_dpp v39, v39, v39 quad_perm:[2,3,0,1] row_mask:0xf bank_mask:0xf
  v_cndmask_b32 v42, v46, v40, s[38:39]
  v_cndmask_b32 v43, v40, v46, s[38:39]
  v_add_f32_dpp v39, v39, v39 row_half_mirror row_mask:0xf bank_mask:0xf
  s_cbranch_vccnz cA_sc3_slow
  s_nop 0
  v_add_f32_dpp v47, v39, v39 row_mirror row_mask:0xf bank_mask:0xf
  v_add_f32_dpp v39, v39, v39 row_mirror row_mask:0xf bank_mask:0xf
  s_nop 1
  v_permlane16_swap_b32 v39, v47
  v_add_f32 v39, v39, v47
  v_rcp_f32 v39, v39
  s_mov_b64 exec, s[28:29]
  v_mul_f32 v42, v42, v39
  v_mul_f32 v43, v43, v39
  v_cvt_pk_bf16_f32 v42, v42, v43
cA_sc3_pst:
  buffer_store_dword v42, v1, s[8:11], s20 offen
  s_mov_b64 exec, -1
  s_barrier
  s_add_u32 s24, s24, 28672
  s_add_u32 s35, s35, 28672
  s_xor_b32 s25, s25, 28672
  s_add_u32 m0, s25, 21504
  s_nop 0
  buffer_load_dwordx4 v2, s[8:11], s24 offen offset:0 sc1 lds
  buffer_load_dwordx4 v2, s[8:11], s24 offen offset:1024 sc1 lds
  buffer_load_dwordx4 v2, s[8:11], s24 offen offset:2048 sc1 lds
  buffer_load_dwordx4 v2, s[8:11], s24 offen offset:3072 sc1 lds
  s_add_u32 m0, s25, 25600
  s_add_u32 s22, s24, 4096
  buffer_load_dwordx4 v2, s[8:11], s22 offen offset:0 sc1 lds
  buffer_load_dwordx4 v2, s[8:11], s22 offen offset:1024 sc1 lds
  buffer_load_dwordx4 v2, s[8:11], s22 offen offset:2048 sc1 lds
  v_xor_b32 v116, 28672, v116
  v_add_u32 v117, s57, v117
  s_sub_u32 s57, 0, s57
  s_add_u32 s19, s19, 1
  s_mov_b32 s20, s21
  s_cmp_lt_u32 s19, 63
  s_cbranch_scc1 cA_sc3_loop
  s_branch cA_done
cA_sc3_slow:
  v_max_f32 v50, v36, v44
  s_nop 1
  v_max_f32_dpp v50, v50, v50 quad_perm:[1,0,3,2] row_mask:0xf bank_mask:0xf
  s_nop 1
  v_max_f32_dpp v50, v50, v50 quad_perm:[2,3,0,1] row_mask:0xf bank_mask:0xf
  s_nop 1
  v_max_f32_dpp v50, v50, v50 row_half_mirror row_mask:0xf bank_mask:0xf
  s_nop 1
  v_max_f32_dpp v50, v50, v50 row_mirror row_mask:0xf bank_mask:0xf
  v_mov_b32 v47, v50
  s_nop 1
  v_permlane16_swap_b32 v50, v47
  v_max_f32 v50, v50, v47
  v_sub_f32 v48, v36, v50
  v_sub_f32 v49, v44, v50
  v_exp_f32 v48, v48
  v_exp_f32 v49, v49
  s_add_u32 s31, s31, 0x100
  v_fma_f32 v39, v49, s37, v48
  v_cndmask_b32 v41, v48, v49, s[38:39]
  s_nop 0
  v_add_f32_dpp v39, v39, v39 quad_perm:[1,0,3,2] row_mask:0xf bank_mask:0xf
  v_cndmask_b32 v40, v49, v48, s[38:39]
  v_mov_b32_dpp v46, v41 quad_perm:[1,0,3,2] row_mask:0xf bank_mask:0xf
  v_add_f32_dpp v39, v39, v39 quad_perm:[2,3,0,1] row_mask:0xf bank_mask:0xf
  v_cndmask_b32 v42, v46, v40, s[38:39]
  v_cndmask_b32 v43, v40, v46, s[38:39]
  v_add_f32_dpp v39, v39, v39 row_half_mirror row_mask:0xf bank_mask:0xf
  s_nop 1
  v_add_f32_dpp v47, v39, v39 row_mirror row_mask:0xf bank_mask:0xf
  v_add_f32_dpp v39, v39, v39 row_mirror row_mask:0xf bank_mask:0xf
  s_nop 1
  v_permlane16_swap_b32 v39, v47
  v_add_f32 v39, v39, v47
  v_rcp_f32 v39, v39
  s_mov_b64 exec, s[28:29]
  v_mul_f32 v42, v42, v39
  v_mul_f32 v43, v43, v39
  v_cvt_pk_bf16_f32 v42, v42, v43
  v_min_u32 v42, -2, v42
  s_branch cA_sc3_pst
cA_sc3_retry:
  s_cmp_lg_u32 s62, 0
  s_cbranch_scc1 cA_sc3_cont
  s_waitcnt vmcnt(0) lgkmcnt(0)
cA_sc3_rv:
  buffer_load_dwordx4 v[8:11], v2, s[8:11], s20 offen offset:0 sc1
  buffer_load_dwordx4 v[12:15], v2, s[8:11], s20 offen offset:1024 sc1
  buffer_load_dwordx4 v[16:19], v2, s[8:11], s20 offen offset:2048 sc1
  buffer_load_dwordx4 v[20:23], v2, s[8:11], s20 offen offset:3072 sc1
  buffer_load_dwordx4 v[24:27], v2, s[8:11], s23 offen offset:0 sc1
  buffer_load_dwordx4 v[28:31], v2, s[8:11], s23 offen offset:1024 sc1
  buffer_load_dwordx4 v[32:35], v2, s[8:11], s23 offen offset:2048 sc1
  s_waitcnt vmcnt(0)
  v_max3_u32 v68, v8, v9, v10
  v_max3_u32 v68, v68, v11, v12
  v_max3_u32 v68, v68, v13, v14
  v_max3_u32 v68, v68, v15, v16
  v_max3_u32 v68, v68, v17, v18
  v_max3_u32 v68, v68, v19, v20
  v_max3_u32 v68, v68, v21, v22
  v_max3_u32 v68, v68, v23, v24
  v_max3_u32 v68, v68, v25, v26
  v_max3_u32 v68, v68, v27, v28
  v_max3_u32 v68, v68, v29, v30
  v_max3_u32 v68, v68, v31, v32
  v_max3_u32 v68, v68, v33, v34
  v_max_u32 v68, v68, v35
  v_cmp_eq_u32 vcc, -1, v68
  s_cbranch_vccz cA_sc3_rk
  s_add_u32 s30, s30, 1
  s_cmp_lt_u32 s30, 400000
  s_cbranch_scc1 cA_sc3_rv
  s_branch cA_abort
cA_sc3_rk:
  s_mov_b32 s62, 1
  v_mov_b32 v36, 0
  v_mov_b32 v37, 0
  v_mov_b32 v38, 0
  v_mov_b32 v39, 0
  v_mov_b32 v40, 0
  v_mov_b32 v41, 0
  v_mov_b32 v42, 0
  v_mov_b32 v43, 0
  v_mov_b32 v44, 0
  v_mov_b32 v45, 0
  v_mov_b32 v46, 0
  v_mov_b32 v47, 0
  v_mov_b32 v48, 0
  v_mov_b32 v49, 0
  v_mov_b32 v50, 0
  v_mov_b32 v51, 0
  v_mov_b32 v52, 0
  v_mov_b32 v53, 0
  v_mov_b32 v54, 0
  v_mov_b32 v55, 0
  v_mov_b32 v56, 0
  v_mov_b32 v57, 0
  v_mov_b32 v58, 0
  v_mov_b32 v59, 0
  v_mov_b32 v60, 0
  v_mov_b32 v61, 0
  v_mov_b32 v62, 0
  v_mov_b32 v63, 0
  v_mov_b32 v88, 0
  v_mov_b32 v89, 0
  v_mov_b32 v90, 0
  v_mov_b32 v91, 0
  v_mov_b32 v92, 0
  v_mov_b32 v93, 0
  v_mov_b32 v94, 0
  v_mov_b32 v95, 0
  v_mov_b32 v64, 0
  v_mov_b32 v65, 0
  s_add_u32 s31, s31, 1
  ds_read_b128 v[96:99], v117 offset:0
  ds_read_b128 v[100:103], v117 offset:1024
  ds_read_b128 v[104:107], v117 offset:14336
  ds_read_b128 v[108:111], v117 offset:15360
  v_smfmac_f32_16x16x64_bf16 v[36:39], v[8:11], a[0:7], v3
  v_smfmac_f32_16x16x64_bf16 v[40:43], v[8:11], a[56:63], v3
  v_smfmac_f32_16x16x64_bf16 v[44:47], v[8:11], a[112:119], v3
  v_smfmac_f32_16x16x64_bf16 v[48:51], v[8:11], a[168:175], v3
  v_smfmac_f32_16x16x64_bf16 v[52:55], v[8:11], a[224:231], v3
  v_smfmac_f32_16x16x64_bf16 v[56:59], v[8:11], v[144:151], v3
  v_smfmac_f32_16x16x64_bf16 v[60:63], v[8:11], v[200:207], v3
  v_smfmac_f32_16x16x64_bf16 v[36:39], v[12:15], a[8:15], v3
  v_smfmac_f32_16x16x64_bf16 v[40:43], v[12:15], a[64:71], v3
  v_smfmac_f32_16x16x64_bf16 v[44:47], v[12:15], a[120:127], v3
  v_smfmac_f32_16x16x64_bf16 v[48:51], v[12:15], a[176:183], v3
  v_smfmac_f32_16x16x64_bf16 v[52:55], v[12:15], a[232:239], v3
  v_smfmac_f32_16x16x64_bf16 v[56:59], v[12:15], v[152:159], v3
  v_smfmac_f32_16x16x64_bf16 v[60:63], v[12:15], v[208:215], v3
  v_smfmac_f32_16x16x64_bf16 v[36:39], v[16:19], a[16:23], v3
  v_smfmac_f32_16x16x64_bf16 v[40:43], v[16:19], a[72:79], v3
  v_smfmac_f32_16x16x64_bf16 v[44:47], v[16:19], a[128:135], v3
  v_smfmac_f32_16x16x64_bf16 v[48:51], v[16:19], a[184:191], v3
  v_smfmac_f32_16x16x64_bf16 v[52:55], v[16:19], a[240:247], v3
  v_smfmac_f32_16x16x64_bf16 v[56:59], v[16:19], v[160:167], v3
  v_smfmac_f32_16x16x64_bf16 v[60:63], v[16:19], v[216:223], v3
  v_smfmac_f32_16x16x64_bf16 v[36:39], v[20:23], a[24:31], v3
  v_smfmac_f32_16x16x64_bf16 v[40:43], v[20:23], a[80:87], v3
  v_smfmac_f32_16x16x64_bf16 v[44:47], v[20:23], a[136:143], v3
  v_smfmac_f32_16x16x64_bf16 v[48:51], v[20:23], a[192:199], v3
  v_smfmac_f32_16x16x64_bf16 v[52:55], v[20:23], a[248:255], v3
  v_smfmac_f32_16x16x64_bf16 v[56:59], v[20:23], v[168:175], v3
  v_smfmac_f32_16x16x64_bf16 v[60:63], v[20:23], v[224:231], v3
  s_branch cA_sc3_ph2
.p2align 6

cA_va0_loop:
  s_add_u32 s23, s20, 4096
  s_add_u32 s21, s20, 20480
  s_mov_b32 s30, 0
  s_cmp_lg_u32 s19, s38
  s_cbranch_scc1 cA_va0_vok
  s_branch cA_va0_voc
cA_va0_vow:
  s_sub_u32 s22, s39, s35
  v_lshlrev_b32 v63, 7, v2
  v_min_u32 v63, s22, v63
  buffer_load_dword v63, v63, s[8:11], s35 offen sc1
  s_waitcnt vmcnt(0)
cA_va0_voc:
  v_readfirstlane_b32 s22, v63
  s_cmp_eq_u32 s22, 56
  s_cbranch_scc1 cA_va0_vod
  s_sleep 1
  s_add_u32 s30, s30, 1
  s_cmp_lt_u32 s30, 400000
  s_cbranch_scc1 cA_va0_vow
  s_branch cA_abort
cA_va0_vod:
  s_add_u32 s35, s35, 2048
  s_add_u32 s38, s19, 8
  s_and_b32 s38, s38, -8
  s_cmp_eq_u32 s19, 0
  s_cselect_b32 s38, 4, s38
  v_cmp_ne_u32 vcc, 56, v63
  s_nop 3
  s_cmp_eq_u64 vcc, 0
  s_cselect_b32 s38, 99, s38
cA_va0_vok:
  s_cmp_eq_u32 s19, 63
  s_cbranch_scc1 cA_done
  s_barrier
  s_add_u32 s22, s25, 0
  buffer_load_dwordx4 v[80:83], v6, s[8:11], s22 offen offset:0 sc1
  buffer_load_dwordx4 v[84:87], v6, s[8:11], s22 offen offset:1792 sc1
  s_add_u32 s22, s25, 3584
  buffer_load_dwordx4 v[88:91], v6, s[8:11], s22 offen offset:0 sc1
  buffer_load_dwordx4 v[92:95], v6, s[8:11], s22 offen offset:1792 sc1
  s_add_u32 s22, s25, 7168
  buffer_load_dwordx4 v[96:99], v6, s[8:11], s22 offen offset:0 sc1
  buffer_load_dwordx4 v[100:103], v6, s[8:11], s22 offen offset:1792 sc1
  s_add_u32 s22, s25, 10752
  buffer_load_dwordx4 v[104:107], v6, s[8:11], s22 offen offset:0 sc1
  buffer_load_dwordx4 v[108:111], v6, s[8:11], s22 offen offset:1792 sc1
  s_add_u32 s22, s25, 14336
  buffer_load_dwordx4 v[112:115], v6, s[8:11], s22 offen offset:0 sc1
  buffer_load_dwordx4 v[116:119], v6, s[8:11], s22 offen offset:1792 sc1
  s_add_u32 s22, s19, 1
  s_cmp_lg_u32 s22, s38
  s_cbranch_scc1 cA_va0_nk
  s_sub_u32 s22, s39, s35
  v_lshlrev_b32 v63, 7, v2
  v_min_u32 v63, s22, v63
  buffer_load_dword v63, v63, s[8:11], s35 offen sc1
cA_va0_nk:
  s_barrier
  ds_read_b128 v[8:11], v2 offset:8192
  ds_read_b128 v[12:15], v2 offset:9216
  ds_read_b128 v[16:19], v2 offset:10240
  ds_read_b128 v[20:23], v2 offset:11264
  ds_read_b128 v[24:27], v2 offset:12288
  ds_read_b128 v[28:31], v2 offset:13312
  ds_read_b128 v[32:35], v2 offset:14336
  s_waitcnt lgkmcnt(0)
  v_smfmac_f32_16x16x64_bf16 v[36:39], v[8:11], a[0:7], v3
  s_add_u32 s22, s25, 17920
  buffer_load_dwordx4 v[120:123], v6, s[8:11], s22 offen sc1
  v_smfmac_f32_16x16x64_bf16 v[36:39], v[12:15], a[8:15], v3
  v_smfmac_f32_16x16x64_bf16 v[36:39], v[16:19], a[16:23], v3
  s_add_u32 s22, s25, 19712
  buffer_load_dwordx4 v[124:127], v6, s[8:11], s22 offen sc1
  v_smfmac_f32_16x16x64_bf16 v[36:39], v[20:23], a[24:31], v3
  v_smfmac_f32_16x16x64_bf16 v[36:39], v[24:27], a[32:39], v3
  s_add_u32 s22, s25, 21504
  buffer_load_dwordx4 v[128:131], v6, s[8:11], s22 offen sc1
  v_smfmac_f32_16x16x64_bf16 v[36:39], v[28:31], a[40:47], v3
  v_smfmac_f32_16x16x64_bf16 v[36:39], v[32:35], a[48:55], v3
  s_add_u32 s22, s25, 23296
  buffer_load_dwordx4 v[132:135], v6, s[8:11], s22 offen sc1
  v_smfmac_f32_16x16x64_bf16 v[40:43], v[8:11], a[56:63], v3
  v_smfmac_f32_16x16x64_bf16 v[40:43], v[12:15], a[64:71], v3
  s_add_u32 s22, s25, 25088
  buffer_load_dwordx4 v[136:139], v6, s[8:11], s22 offen sc1
  v_smfmac_f32_16x16x64_bf16 v[40:43], v[16:19], a[72:79], v3
  v_smfmac_f32_16x16x64_bf16 v[40:43], v[20:23], a[80:87], v3
  s_add_u32 s22, s25, 26880
  buffer_load_dwordx4 v[140:143], v6, s[8:11], s22 offen sc1
  v_smfmac_f32_16x16x64_bf16 v[40:43], v[24:27], a[88:95], v3
  v_smfmac_f32_16x16x64_bf16 v[40:43], v[28:31], a[96:103], v3
  v_smfmac_f32_16x16x64_bf16 v[40:43], v[32:35], a[104:111], v3
  v_smfmac_f32_16x16x64_bf16 v[44:47], v[8:11], a[112:119], v3
  v_smfmac_f32_16x16x64_bf16 v[44:47], v[12:15], a[120:127], v3
  v_smfmac_f32_16x16x64_bf16 v[44:47], v[16:19], a[128:135], v3
  v_smfmac_f32_16x16x64_bf16 v[44:47], v[20:23], a[136:143], v3
  v_permlane32_swap_b32 v36, v40
  v_smfmac_f32_16x16x64_bf16 v[44:47], v[24:27], a[144:151], v3
  v_permlane32_swap_b32 v37, v41
  v_smfmac_f32_16x16x64_bf16 v[44:47], v[28:31], a[152:159], v3
  v_permlane32_swap_b32 v38, v42
  v_smfmac_f32_16x16x64_bf16 v[44:47], v[32:35], a[160:167], v3
  v_permlane32_swap_b32 v39, v43
  v_smfmac_f32_16x16x64_bf16 v[48:51], v[8:11], a[168:175], v3
  v_add_f32 v36, v36, v40
  v_smfmac_f32_16x16x64_bf16 v[48:51], v[12:15], a[176:183], v3
  v_add_f32 v37, v37, v41
  v_smfmac_f32_16x16x64_bf16 v[48:51], v[16:19], a[184:191], v3
  v_add_f32 v38, v38, v42
  v_smfmac_f32_16x16x64_bf16 v[48:51], v[20:23], a[192:199], v3
  v_add_f32 v39, v39, v43
  v_smfmac_f32_16x16x64_bf16 v[48:51], v[24:27], a[200:207], v3
  v_cvt_pk_bf16_f32 v40, v36, v37
  v_smfmac_f32_16x16x64_bf16 v[48:51], v[28:31], a[208:215], v3
  v_cvt_pk_bf16_f32 v41, v38, v39
  v_smfmac_f32_16x16x64_bf16 v[48:51], v[32:35], a[216:223], v3
  ds_write2_b32 v60, v40, v41 offset0:0 offset1:2
  v_smfmac_f32_16x16x64_bf16 v[52:55], v[8:11], a[224:231], v3
  v_smfmac_f32_16x16x64_bf16 v[52:55], v[12:15], a[232:239], v3
  v_smfmac_f32_16x16x64_bf16 v[52:55], v[16:19], a[240:247], v3
  v_smfmac_f32_16x16x64_bf16 v[52:55], v[20:23], a[248:255], v3
  v_permlane32_swap_b32 v44, v48
  v_smfmac_f32_16x16x64_bf16 v[52:55], v[24:27], v[176:183], v3
  v_permlane32_swap_b32 v45, v49
  v_smfmac_f32_16x16x64_bf16 v[52:55], v[28:31], v[184:191], v3
  v_permlane32_swap_b32 v46, v50
  v_smfmac_f32_16x16x64_bf16 v[52:55], v[32:35], v[192:199], v3
  v_permlane32_swap_b32 v47, v51
  v_smfmac_f32_16x16x64_bf16 v[56:59], v[8:11], v[200:207], v3
  v_add_f32 v44, v44, v48
  v_smfmac_f32_16x16x64_bf16 v[56:59], v[12:15], v[208:215], v3
  v_add_f32 v45, v45, v49
  v_smfmac_f32_16x16x64_bf16 v[56:59], v[16:19], v[216:223], v3
  v_add_f32 v46, v46, v50
  v_smfmac_f32_16x16x64_bf16 v[56:59], v[20:23], v[224:231], v3
  v_add_f32 v47, v47, v51
  v_smfmac_f32_16x16x64_bf16 v[56:59], v[24:27], v[232:239], v3
  v_cvt_pk_bf16_f32 v48, v44, v45
  v_smfmac_f32_16x16x64_bf16 v[56:59], v[28:31], v[240:247], v3
  v_cvt_pk_bf16_f32 v49, v46, v47
  v_smfmac_f32_16x16x64_bf16 v[56:59], v[32:35], v[248:255], v3
  ds_write2_b32 v61, v48, v49 offset0:0 offset1:2
  s_nop 6
  v_permlane32_swap_b32 v52, v56
  v_permlane32_swap_b32 v53, v57
  v_permlane32_swap_b32 v54, v58
  v_permlane32_swap_b32 v55, v59
  v_add_f32 v52, v52, v56
  v_add_f32 v53, v53, v57
  v_add_f32 v54, v54, v58
  v_add_f32 v55, v55, v59
  v_cvt_pk_bf16_f32 v56, v52, v53
  v_cvt_pk_bf16_f32 v57, v54, v55
  ds_write2_b32 v62, v56, v57 offset0:0 offset1:2
  buffer_load_dword v164, v4, s[8:11], s20 offen sc1
  s_waitcnt lgkmcnt(0)
  v_mov_b32 v36, 0
  v_mov_b32 v37, 0
  v_mov_b32 v38, 0
  v_mov_b32 v39, 0
  v_mov_b32 v40, 0
  v_mov_b32 v41, 0
  v_mov_b32 v42, 0
  v_mov_b32 v43, 0
  buffer_load_dword v165, v4, s[8:11], s20 offen sc1
  v_mov_b32 v44, 0
  v_mov_b32 v45, 0
  v_mov_b32 v46, 0
  v_mov_b32 v47, 0
  v_mov_b32 v48, 0
  v_mov_b32 v49, 0
  v_mov_b32 v50, 0
  v_mov_b32 v51, 0
  buffer_load_dword v166, v4, s[8:11], s20 offen sc1
  v_mov_b32 v52, 0
  v_mov_b32 v53, 0
  v_mov_b32 v54, 0
  v_mov_b32 v55, 0
  v_mov_b32 v56, 0
  v_mov_b32 v57, 0
  v_mov_b32 v58, 0
  v_mov_b32 v59, 0
  buffer_load_dword v167, v4, s[8:11], s20 offen sc1
  s_cmp_eq_u32 s19, 63
  s_cbranch_scc1 cA_va0_last
  s_add_u32 s22, s20, 9216
  s_add_u32 s34, s20, 13312
  s_add_u32 s36, s20, 7168
  s_mov_b32 s37, 0
  v_mov_b32 v156, 0
  v_mov_b32 v157, 0
  v_mov_b32 v158, 0
  v_mov_b32 v159, 0
  buffer_load_dword v168, v4, s[8:11], s20 offen sc1
cA_va0_fw_l:
  s_waitcnt vmcnt(4)
  v_cmp_eq_u32 vcc, -1, v164
  s_cbranch_vccz cA_va0_fw_d
  buffer_load_dword v164, v4, s[8:11], s20 offen sc1
  s_waitcnt vmcnt(4)
  v_cmp_eq_u32 vcc, -1, v165
  s_cbranch_vccz cA_va0_fw_d
  buffer_load_dword v165, v4, s[8:11], s20 offen sc1
  s_waitcnt vmcnt(4)
  v_cmp_eq_u32 vcc, -1, v166
  s_cbranch_vccz cA_va0_fw_d
  buffer_load_dword v166, v4, s[8:11], s20 offen sc1
  s_waitcnt vmcnt(4)
  v_cmp_eq_u32 vcc, -1, v167
  s_cbranch_vccz cA_va0_fw_d
  buffer_load_dword v167, v4, s[8:11], s20 offen sc1
  s_waitcnt vmcnt(4)
  v_cmp_eq_u32 vcc, -1, v168
  s_cbranch_vccz cA_va0_fw_d
  buffer_load_dword v168, v4, s[8:11], s20 offen sc1
  s_add_u32 s30, s30, 1
  s_cmp_lt_u32 s30, 400000
  s_cbranch_scc1 cA_va0_fw_l
  s_branch cA_abort
cA_va0_fw_d:
  s_waitcnt lgkmcnt(0)
  buffer_load_dwordx4 v[8:11], v5, s[8:11], s22 offen offset:0
  buffer_load_dwordx4 v[12:15], v5, s[8:11], s22 offen offset:1024
  buffer_load_dwordx4 v[16:19], v5, s[8:11], s22 offen offset:2048
  buffer_load_dwordx4 v[20:23], v5, s[8:11], s22 offen offset:3072
  buffer_load_dwordx4 v[24:27], v5, s[8:11], s34 offen offset:0
  buffer_load_dwordx4 v[28:31], v5, s[8:11], s34 offen offset:1024
  buffer_load_dwordx4 v[32:35], v5, s[8:11], s34 offen offset:2048
  buffer_load_dwordx4 v[144:147], v5, s[8:11], s34 offen offset:3072
  buffer_load_dwordx4 v[148:151], v2, s[8:11], s36 offen offset:0
  buffer_load_dwordx4 v[152:155], v2, s[8:11], s36 offen offset:1024
  s_barrier
  ds_read_b128 v[64:67], v2 offset:0
  ds_read_b128 v[68:71], v2 offset:1024
  ds_read_b128 v[72:75], v2 offset:2048
  ds_read_b128 v[76:79], v2 offset:3072
  s_waitcnt vmcnt(9)
  v_smfmac_f32_16x16x64_bf16 v[156:159], v[8:11], v[80:87], v0
  s_waitcnt vmcnt(8)
  v_smfmac_f32_16x16x64_bf16 v[156:159], v[12:15], v[88:95], v0
  s_mov_b64 exec, 65535
  buffer_store_dword v2, v7, s[8:11], s21 offen
  s_mov_b64 exec, -1
  s_waitcnt vmcnt(8)
  v_smfmac_f32_16x16x64_bf16 v[156:159], v[16:19], v[96:103], v0
  s_waitcnt vmcnt(7)
  v_smfmac_f32_16x16x64_bf16 v[156:159], v[20:23], v[104:111], v0
  s_waitcnt vmcnt(6)
  v_smfmac_f32_16x16x64_bf16 v[156:159], v[24:27], v[112:119], v0
  s_waitcnt vmcnt(5)
  v_smfmac_f32_16x16x64_bf16 v[156:159], v[28:31], v[120:127], v0
  s_waitcnt vmcnt(4)
  v_smfmac_f32_16x16x64_bf16 v[156:159], v[32:35], v[128:135], v0
  s_waitcnt vmcnt(3)
  v_smfmac_f32_16x16x64_bf16 v[156:159], v[144:147], v[136:143], v0
  s_waitcnt vmcnt(2) lgkmcnt(0)
  v_smfmac_f32_16x16x64_bf16 v[156:159], v[148:151], v[64:71], v0
  s_waitcnt vmcnt(1)
  v_smfmac_f32_16x16x64_bf16 v[156:159], v[152:155], v[72:79], v0
cA_va0_ep:
  s_nop 7
  v_add_f32 v160, v156, v157
  v_add_f32 v161, v158, v159
  v_cmp_u_f32 vcc, v160, v161
  v_mov_b32_dpp v162, v160 row_ror:8 row_mask:0xf bank_mask:0xf
  v_mov_b32_dpp v160, v161 row_ror:8 row_mask:0xf bank_mask:0xc
  s_cbranch_vccnz cA_va0_rp
  v_mov_b32_dpp v161, v162 quad_perm:[0,1,2,3] row_mask:0xf bank_mask:0x3
  v_cvt_pk_bf16_f32 v160, v160, v161
cA_va0_pc:
  buffer_store_dword v160, v1, s[8:11], s21 offen
  s_cmp_lg_u32 s19, 62
  s_cbranch_scc1 cA_va0_nl
  s_mov_b32 s22, 88531968
  buffer_store_dword v160, v1, s[8:11], s22 offen sc1
  s_mov_b64 exec, -1
  s_branch cA_done
cA_va0_nl:
  s_mov_b64 exec, -1
  s_add_u32 s25, s25, 28672
  s_add_u32 s19, s19, 1
  s_mov_b32 s20, s21
  s_branch cA_va0_loop
cA_va0_last:
  s_waitcnt lgkmcnt(0)
  s_barrier
  s_branch cA_done
cA_va0_rp:
  s_cmp_eq_u32 s37, 0
  s_cbranch_scc1 cA_va0_rv
  v_mov_b32_dpp v161, v162 quad_perm:[0,1,2,3] row_mask:0xf bank_mask:0x3
  v_cvt_pk_bf16_f32 v160, v160, v161
  v_min_u32 v160, -2, v160
  s_branch cA_va0_pc
cA_va0_rv:
  buffer_load_dwordx4 v[8:11], v5, s[8:11], s22 offen offset:0 sc1
  buffer_load_dwordx4 v[12:15], v5, s[8:11], s22 offen offset:1024 sc1
  buffer_load_dwordx4 v[16:19], v5, s[8:11], s22 offen offset:2048 sc1
  buffer_load_dwordx4 v[20:23], v5, s[8:11], s22 offen offset:3072 sc1
  buffer_load_dwordx4 v[24:27], v5, s[8:11], s34 offen offset:0 sc1
  buffer_load_dwordx4 v[28:31], v5, s[8:11], s34 offen offset:1024 sc1
  buffer_load_dwordx4 v[32:35], v5, s[8:11], s34 offen offset:2048 sc1
  buffer_load_dwordx4 v[144:147], v5, s[8:11], s34 offen offset:3072 sc1
  buffer_load_dwordx4 v[148:151], v2, s[8:11], s36 offen offset:0 sc1
  buffer_load_dwordx4 v[152:155], v2, s[8:11], s36 offen offset:1024 sc1
  s_waitcnt vmcnt(0)
  v_max3_u32 v175, v8, v9, v10
  v_max3_u32 v175, v175, v11, v12
  v_max3_u32 v175, v175, v13, v14
  v_max3_u32 v175, v175, v15, v16
  v_max3_u32 v175, v175, v17, v18
  v_max3_u32 v175, v175, v19, v20
  v_max3_u32 v175, v175, v21, v22
  v_max3_u32 v175, v175, v23, v24
  v_max3_u32 v175, v175, v25, v26
  v_max3_u32 v175, v175, v27, v28
  v_max3_u32 v175, v175, v29, v30
  v_max3_u32 v175, v175, v31, v32
  v_max3_u32 v175, v175, v33, v34
  v_max3_u32 v175, v175, v35, v144
  v_max3_u32 v175, v175, v145, v146
  v_max3_u32 v175, v175, v147, v148
  v_max3_u32 v175, v175, v149, v150
  v_max3_u32 v175, v175, v151, v152
  v_max3_u32 v175, v175, v153, v154
  v_max_u32 v175, v175, v155
  v_cmp_eq_u32 vcc, -1, v175
  s_cbranch_vccz cA_va0_rk
  s_add_u32 s30, s30, 1
  s_cmp_lt_u32 s30, 400000
  s_cbranch_scc1 cA_va0_rv
  s_branch cA_abort
cA_va0_rk:
  s_mov_b32 s37, 1
  s_add_u32 s31, s31, 0x10000
  v_mov_b32 v156, 0
  v_mov_b32 v157, 0
  v_mov_b32 v158, 0
  v_mov_b32 v159, 0
  s_nop 1
  v_smfmac_f32_16x16x64_bf16 v[156:159], v[8:11], v[80:87], v0
  v_smfmac_f32_16x16x64_bf16 v[156:159], v[12:15], v[88:95], v0
  v_smfmac_f32_16x16x64_bf16 v[156:159], v[16:19], v[96:103], v0
  v_smfmac_f32_16x16x64_bf16 v[156:159], v[20:23], v[104:111], v0
  v_smfmac_f32_16x16x64_bf16 v[156:159], v[24:27], v[112:119], v0
  v_smfmac_f32_16x16x64_bf16 v[156:159], v[28:31], v[120:127], v0
  v_smfmac_f32_16x16x64_bf16 v[156:159], v[32:35], v[128:135], v0
  v_smfmac_f32_16x16x64_bf16 v[156:159], v[144:147], v[136:143], v0
  v_smfmac_f32_16x16x64_bf16 v[156:159], v[148:151], v[64:71], v0
  v_smfmac_f32_16x16x64_bf16 v[156:159], v[152:155], v[72:79], v0
  s_nop 7
  s_branch cA_va0_ep
.p2align 6

cA_va1_loop:
  s_add_u32 s23, s20, 4096
  s_add_u32 s21, s20, 20480
  s_mov_b32 s30, 0
  s_cmp_lg_u32 s19, s38
  s_cbranch_scc1 cA_va1_vok
  s_branch cA_va1_voc
cA_va1_vow:
  s_sub_u32 s22, s39, s35
  v_lshlrev_b32 v63, 7, v2
  v_min_u32 v63, s22, v63
  buffer_load_dword v63, v63, s[8:11], s35 offen sc1
  s_waitcnt vmcnt(0)
cA_va1_voc:
  v_readfirstlane_b32 s22, v63
  s_cmp_eq_u32 s22, 56
  s_cbranch_scc1 cA_va1_vod
  s_sleep 1
  s_add_u32 s30, s30, 1
  s_cmp_lt_u32 s30, 400000
  s_cbranch_scc1 cA_va1_vow
  s_branch cA_abort
cA_va1_vod:
  s_add_u32 s35, s35, 2048
  s_add_u32 s38, s19, 8
  s_and_b32 s38, s38, -8
  s_cmp_eq_u32 s19, 0
  s_cselect_b32 s38, 4, s38
  v_cmp_ne_u32 vcc, 56, v63
  s_nop 3
  s_cmp_eq_u64 vcc, 0
  s_cselect_b32 s38, 99, s38
cA_va1_vok:
  s_cmp_eq_u32 s19, 63
  s_cbranch_scc1 cA_done
  s_barrier
  s_add_u32 s22, s25, 0
  buffer_load_dwordx4 v[80:83], v6, s[8:11], s22 offen offset:0 sc1
  buffer_load_dwordx4 v[84:87], v6, s[8:11], s22 offen offset:1792 sc1
  s_add_u32 s22, s25, 3584
  buffer_load_dwordx4 v[88:91], v6, s[8:11], s22 offen offset:0 sc1
  buffer_load_dwordx4 v[92:95], v6, s[8:11], s22 offen offset:1792 sc1
  s_add_u32 s22, s25, 7168
  buffer_load_dwordx4 v[96:99], v6, s[8:11], s22 offen offset:0 sc1
  buffer_load_dwordx4 v[100:103], v6, s[8:11], s22 offen offset:1792 sc1
  s_add_u32 s22, s25, 10752
  buffer_load_dwordx4 v[104:107], v6, s[8:11], s22 offen offset:0 sc1
  buffer_load_dwordx4 v[108:111], v6, s[8:11], s22 offen offset:1792 sc1
  s_add_u32 s22, s25, 14336
  buffer_load_dwordx4 v[112:115], v6, s[8:11], s22 offen offset:0 sc1
  buffer_load_dwordx4 v[116:119], v6, s[8:11], s22 offen offset:1792 sc1
  s_add_u32 s22, s19, 1
  s_cmp_lg_u32 s22, s38
  s_cbranch_scc1 cA_va1_nk
  s_sub_u32 s22, s39, s35
  v_lshlrev_b32 v63, 7, v2
  v_min_u32 v63, s22, v63
  buffer_load_dword v63, v63, s[8:11], s35 offen sc1
cA_va1_nk:
  s_barrier
  ds_read_b128 v[8:11], v2 offset:8192
  ds_read_b128 v[12:15], v2 offset:9216
  ds_read_b128 v[16:19], v2 offset:10240
  ds_read_b128 v[20:23], v2 offset:11264
  ds_read_b128 v[24:27], v2 offset:12288
  ds_read_b128 v[28:31], v2 offset:13312
  ds_read_b128 v[32:35], v2 offset:14336
  s_waitcnt lgkmcnt(0)
  v_smfmac_f32_16x16x64_bf16 v[36:39], v[8:11], a[0:7], v3
  s_add_u32 s22, s25, 17920
  buffer_load_dwordx4 v[120:123], v6, s[8:11], s22 offen sc1
  v_smfmac_f32_16x16x64_bf16 v[36:39], v[12:15], a[8:15], v3
  v_smfmac_f32_16x16x64_bf16 v[36:39], v[16:19], a[16:23], v3
  s_add_u32 s22, s25, 19712
  buffer_load_dwordx4 v[124:127], v6, s[8:11], s22 offen sc1
  v_smfmac_f32_16x16x64_bf16 v[36:39], v[20:23], a[24:31], v3
  v_smfmac_f32_16x16x64_bf16 v[36:39], v[24:27], a[32:39], v3
  s_add_u32 s22, s25, 21504
  buffer_load_dwordx4 v[128:131], v6, s[8:11], s22 offen sc1
  v_smfmac_f32_16x16x64_bf16 v[36:39], v[28:31], a[40:47], v3
  v_smfmac_f32_16x16x64_bf16 v[36:39], v[32:35], a[48:55], v3
  s_add_u32 s22, s25, 23296
  buffer_load_dwordx4 v[132:135], v6, s[8:11], s22 offen sc1
  v_smfmac_f32_16x16x64_bf16 v[40:43], v[8:11], a[56:63], v3
  v_smfmac_f32_16x16x64_bf16 v[40:43], v[12:15], a[64:71], v3
  s_add_u32 s22, s25, 25088
  buffer_load_dwordx4 v[136:139], v6, s[8:11], s22 offen sc1
  v_smfmac_f32_16x16x64_bf16 v[40:43], v[16:19], a[72:79], v3
  v_smfmac_f32_16x16x64_bf16 v[40:43], v[20:23], a[80:87], v3
  s_add_u32 s22, s25, 26880
  buffer_load_dwordx4 v[140:143], v6, s[8:11], s22 offen sc1
  v_smfmac_f32_16x16x64_bf16 v[40:43], v[24:27], a[88:95], v3
  v_smfmac_f32_16x16x64_bf16 v[40:43], v[28:31], a[96:103], v3
  v_smfmac_f32_16x16x64_bf16 v[40:43], v[32:35], a[104:111], v3
  v_smfmac_f32_16x16x64_bf16 v[44:47], v[8:11], a[112:119], v3
  v_smfmac_f32_16x16x64_bf16 v[44:47], v[12:15], a[120:127], v3
  v_smfmac_f32_16x16x64_bf16 v[44:47], v[16:19], a[128:135], v3
  v_smfmac_f32_16x16x64_bf16 v[44:47], v[20:23], a[136:143], v3
  v_permlane32_swap_b32 v36, v40
  v_smfmac_f32_16x16x64_bf16 v[44:47], v[24:27], a[144:151], v3
  v_permlane32_swap_b32 v37, v41
  v_smfmac_f32_16x16x64_bf16 v[44:47], v[28:31], a[152:159], v3
  v_permlane32_swap_b32 v38, v42
  v_smfmac_f32_16x16x64_bf16 v[44:47], v[32:35], a[160:167], v3
  v_permlane32_swap_b32 v39, v43
  v_smfmac_f32_16x16x64_bf16 v[48:51], v[8:11], a[168:175], v3
  v_add_f32 v36, v36, v40
  v_smfmac_f32_16x16x64_bf16 v[48:51], v[12:15], a[176:183], v3
  v_add_f32 v37, v37, v41
  v_smfmac_f32_16x16x64_bf16 v[48:51], v[16:19], a[184:191], v3
  v_add_f32 v38, v38, v42
  v_smfmac_f32_16x16x64_bf16 v[48:51], v[20:23], a[192:199], v3
  v_add_f32 v39, v39, v43
  v_smfmac_f32_16x16x64_bf16 v[48:51], v[24:27], a[200:207], v3
  v_cvt_pk_bf16_f32 v40, v36, v37
  v_smfmac_f32_16x16x64_bf16 v[48:51], v[28:31], a[208:215], v3
  v_cvt_pk_bf16_f32 v41, v38, v39
  v_smfmac_f32_16x16x64_bf16 v[48:51], v[32:35], a[216:223], v3
  ds_write2_b32 v60, v40, v41 offset0:0 offset1:2
  v_smfmac_f32_16x16x64_bf16 v[52:55], v[8:11], a[224:231], v3
  v_smfmac_f32_16x16x64_bf16 v[52:55], v[12:15], a[232:239], v3
  v_smfmac_f32_16x16x64_bf16 v[52:55], v[16:19], a[240:247], v3
  v_smfmac_f32_16x16x64_bf16 v[52:55], v[20:23], a[248:255], v3
  v_permlane32_swap_b32 v44, v48
  v_smfmac_f32_16x16x64_bf16 v[52:55], v[24:27], v[176:183], v3
  v_permlane32_swap_b32 v45, v49
  v_smfmac_f32_16x16x64_bf16 v[52:55], v[28:31], v[184:191], v3
  v_permlane32_swap_b32 v46, v50
  v_smfmac_f32_16x16x64_bf16 v[52:55], v[32:35], v[192:199], v3
  v_permlane32_swap_b32 v47, v51
  v_smfmac_f32_16x16x64_bf16 v[56:59], v[8:11], v[200:207], v3
  v_add_f32 v44, v44, v48
  v_smfmac_f32_16x16x64_bf16 v[56:59], v[12:15], v[208:215], v3
  v_add_f32 v45, v45, v49
  v_smfmac_f32_16x16x64_bf16 v[56:59], v[16:19], v[216:223], v3
  v_add_f32 v46, v46, v50
  v_smfmac_f32_16x16x64_bf16 v[56:59], v[20:23], v[224:231], v3
  v_add_f32 v47, v47, v51
  v_smfmac_f32_16x16x64_bf16 v[56:59], v[24:27], v[232:239], v3
  v_cvt_pk_bf16_f32 v48, v44, v45
  v_smfmac_f32_16x16x64_bf16 v[56:59], v[28:31], v[240:247], v3
  v_cvt_pk_bf16_f32 v49, v46, v47
  v_smfmac_f32_16x16x64_bf16 v[56:59], v[32:35], v[248:255], v3
  ds_write2_b32 v61, v48, v49 offset0:0 offset1:2
  s_nop 6
  v_permlane32_swap_b32 v52, v56
  v_permlane32_swap_b32 v53, v57
  v_permlane32_swap_b32 v54, v58
  v_permlane32_swap_b32 v55, v59
  v_add_f32 v52, v52, v56
  v_add_f32 v53, v53, v57
  v_add_f32 v54, v54, v58
  v_add_f32 v55, v55, v59
  v_cvt_pk_bf16_f32 v56, v52, v53
  v_cvt_pk_bf16_f32 v57, v54, v55
  ds_write2_b32 v62, v56, v57 offset0:0 offset1:2
  s_waitcnt lgkmcnt(0)
  v_mov_b32 v36, 0
  v_mov_b32 v37, 0
  v_mov_b32 v38, 0
  v_mov_b32 v39, 0
  v_mov_b32 v40, 0
  v_mov_b32 v41, 0
  v_mov_b32 v42, 0
  v_mov_b32 v43, 0
  v_mov_b32 v44, 0
  v_mov_b32 v45, 0
  v_mov_b32 v46, 0
  v_mov_b32 v47, 0
  v_mov_b32 v48, 0
  v_mov_b32 v49, 0
  v_mov_b32 v50, 0
  v_mov_b32 v51, 0
  v_mov_b32 v52, 0
  v_mov_b32 v53, 0
  v_mov_b32 v54, 0
  v_mov_b32 v55, 0
  v_mov_b32 v56, 0
  v_mov_b32 v57, 0
  v_mov_b32 v58, 0
  v_mov_b32 v59, 0
  s_cmp_eq_u32 s19, 63
  s_cbranch_scc1 cA_va1_last
  s_add_u32 s22, s20, 9216
  s_add_u32 s34, s20, 13312
  s_add_u32 s36, s20, 7168
  s_mov_b32 s37, 0
  v_mov_b32 v156, 0
  v_mov_b32 v157, 0
  v_mov_b32 v158, 0
  v_mov_b32 v159, 0
  s_barrier
  s_waitcnt lgkmcnt(0)
  buffer_load_dwordx4 v[8:11], v5, s[8:11], s22 offen offset:0
  buffer_load_dwordx4 v[12:15], v5, s[8:11], s22 offen offset:1024
  buffer_load_dwordx4 v[16:19], v5, s[8:11], s22 offen offset:2048
  buffer_load_dwordx4 v[20:23], v5, s[8:11], s22 offen offset:3072
  buffer_load_dwordx4 v[24:27], v5, s[8:11], s34 offen offset:0
  buffer_load_dwordx4 v[28:31], v5, s[8:11], s34 offen offset:1024
  buffer_load_dwordx4 v[32:35], v5, s[8:11], s34 offen offset:2048
  buffer_load_dwordx4 v[144:147], v5, s[8:11], s34 offen offset:3072
  buffer_load_dwordx4 v[148:151], v2, s[8:11], s36 offen offset:0
  buffer_load_dwordx4 v[152:155], v2, s[8:11], s36 offen offset:1024
  ds_read_b128 v[64:67], v2 offset:4096
  ds_read_b128 v[68:71], v2 offset:5120
  ds_read_b128 v[72:75], v2 offset:6144
  ds_read_b128 v[76:79], v2 offset:7168
  s_waitcnt vmcnt(9)
  v_smfmac_f32_16x16x64_bf16 v[156:159], v[8:11], v[80:87], v0
  s_waitcnt vmcnt(8)
  v_smfmac_f32_16x16x64_bf16 v[156:159], v[12:15], v[88:95], v0
  s_waitcnt vmcnt(7)
  v_smfmac_f32_16x16x64_bf16 v[156:159], v[16:19], v[96:103], v0
  s_waitcnt vmcnt(6)
  v_smfmac_f32_16x16x64_bf16 v[156:159], v[20:23], v[104:111], v0
  s_waitcnt vmcnt(5)
  v_smfmac_f32_16x16x64_bf16 v[156:159], v[24:27], v[112:119], v0
  s_mov_b64 exec, 65535
  buffer_store_dword v2, v7, s[8:11], s21 offen
  s_mov_b64 exec, -1
  s_waitcnt vmcnt(5)
  v_smfmac_f32_16x16x64_bf16 v[156:159], v[28:31], v[120:127], v0
  s_waitcnt vmcnt(4)
  v_smfmac_f32_16x16x64_bf16 v[156:159], v[32:35], v[128:135], v0
  s_waitcnt vmcnt(3)
  v_smfmac_f32_16x16x64_bf16 v[156:159], v[144:147], v[136:143], v0
  s_waitcnt vmcnt(2) lgkmcnt(0)
  v_smfmac_f32_16x16x64_bf16 v[156:159], v[148:151], v[64:71], v0
  s_waitcnt vmcnt(1)
  v_smfmac_f32_16x16x64_bf16 v[156:159], v[152:155], v[72:79], v0
cA_va1_ep:
  s_nop 7
  v_add_f32 v160, v156, v157
  v_add_f32 v161, v158, v159
  v_cmp_u_f32 vcc, v160, v161
  v_mov_b32_dpp v162, v160 row_ror:8 row_mask:0xf bank_mask:0xf
  v_mov_b32_dpp v160, v161 row_ror:8 row_mask:0xf bank_mask:0xc
  s_cbranch_vccnz cA_va1_rp
  v_mov_b32_dpp v161, v162 quad_perm:[0,1,2,3] row_mask:0xf bank_mask:0x3
  v_cvt_pk_bf16_f32 v160, v160, v161
cA_va1_pc:
  s_mov_b64 exec, s[26:27]
  buffer_store_dword v160, v1, s[8:11], s21 offen
  s_cmp_lg_u32 s19, 62
  s_cbranch_scc1 cA_va1_nl
  s_mov_b32 s22, 88531968
  buffer_store_dword v160, v1, s[8:11], s22 offen sc1
  s_mov_b64 exec, -1
  s_branch cA_done
cA_va1_nl:
  s_mov_b64 exec, -1
  s_add_u32 s25, s25, 28672
  s_add_u32 s19, s19, 1
  s_mov_b32 s20, s21
  s_branch cA_va1_loop
cA_va1_last:
  s_waitcnt lgkmcnt(0)
  s_barrier
  s_branch cA_done
cA_va1_rp:
  s_cmp_eq_u32 s37, 0
  s_cbranch_scc1 cA_va1_rv
  v_mov_b32_dpp v161, v162 quad_perm:[0,1,2,3] row_mask:0xf bank_mask:0x3
  v_cvt_pk_bf16_f32 v160, v160, v161
  v_min_u32 v160, -2, v160
  s_branch cA_va1_pc
cA_va1_rv:
  buffer_load_dwordx4 v[8:11], v5, s[8:11], s22 offen offset:0 sc1
  buffer_load_dwordx4 v[12:15], v5, s[8:11], s22 offen offset:1024 sc1
  buffer_load_dwordx4 v[16:19], v5, s[8:11], s22 offen offset:2048 sc1
  buffer_load_dwordx4 v[20:23], v5, s[8:11], s22 offen offset:3072 sc1
  buffer_load_dwordx4 v[24:27], v5, s[8:11], s34 offen offset:0 sc1
  buffer_load_dwordx4 v[28:31], v5, s[8:11], s34 offen offset:1024 sc1
  buffer_load_dwordx4 v[32:35], v5, s[8:11], s34 offen offset:2048 sc1
  buffer_load_dwordx4 v[144:147], v5, s[8:11], s34 offen offset:3072 sc1
  buffer_load_dwordx4 v[148:151], v2, s[8:11], s36 offen offset:0 sc1
  buffer_load_dwordx4 v[152:155], v2, s[8:11], s36 offen offset:1024 sc1
  s_waitcnt vmcnt(0)
  v_max3_u32 v175, v8, v9, v10
  v_max3_u32 v175, v175, v11, v12
  v_max3_u32 v175, v175, v13, v14
  v_max3_u32 v175, v175, v15, v16
  v_max3_u32 v175, v175, v17, v18
  v_max3_u32 v175, v175, v19, v20
  v_max3_u32 v175, v175, v21, v22
  v_max3_u32 v175, v175, v23, v24
  v_max3_u32 v175, v175, v25, v26
  v_max3_u32 v175, v175, v27, v28
  v_max3_u32 v175, v175, v29, v30
  v_max3_u32 v175, v175, v31, v32
  v_max3_u32 v175, v175, v33, v34
  v_max3_u32 v175, v175, v35, v144
  v_max3_u32 v175, v175, v145, v146
  v_max3_u32 v175, v175, v147, v148
  v_max3_u32 v175, v175, v149, v150
  v_max3_u32 v175, v175, v151, v152
  v_max3_u32 v175, v175, v153, v154
  v_max_u32 v175, v175, v155
  v_cmp_eq_u32 vcc, -1, v175
  s_cbranch_vccz cA_va1_rk
  s_add_u32 s30, s30, 1
  s_cmp_lt_u32 s30, 400000
  s_cbranch_scc1 cA_va1_rv
  s_branch cA_abort
cA_va1_rk:
  s_mov_b32 s37, 1
  s_add_u32 s31, s31, 0x10000
  v_mov_b32 v156, 0
  v_mov_b32 v157, 0
  v_mov_b32 v158, 0
  v_mov_b32 v159, 0
  s_nop 1
  v_smfmac_f32_16x16x64_bf16 v[156:159], v[8:11], v[80:87], v0
  v_smfmac_f32_16x16x64_bf16 v[156:159], v[12:15], v[88:95], v0
  v_smfmac_f32_16x16x64_bf16 v[156:159], v[16:19], v[96:103], v0
  v_smfmac_f32_16x16x64_bf16 v[156:159], v[20:23], v[104:111], v0
  v_smfmac_f32_16x16x64_bf16 v[156:159], v[24:27], v[112:119], v0
  v_smfmac_f32_16x16x64_bf16 v[156:159], v[28:31], v[120:127], v0
  v_smfmac_f32_16x16x64_bf16 v[156:159], v[32:35], v[128:135], v0
  v_smfmac_f32_16x16x64_bf16 v[156:159], v[144:147], v[136:143], v0
  v_smfmac_f32_16x16x64_bf16 v[156:159], v[148:151], v[64:71], v0
  v_smfmac_f32_16x16x64_bf16 v[156:159], v[152:155], v[72:79], v0
  s_nop 7
  s_branch cA_va1_ep
.p2align 6

cA_va2_loop:
  s_add_u32 s23, s20, 4096
  s_add_u32 s21, s20, 20480
  v_mov_b32 v36, 0
  v_mov_b32 v37, 0
  v_mov_b32 v38, 0
  v_mov_b32 v39, 0
  v_mov_b32 v40, 0
  v_mov_b32 v41, 0
  v_mov_b32 v42, 0
  v_mov_b32 v43, 0
  v_mov_b32 v44, 0
  v_mov_b32 v45, 0
  v_mov_b32 v46, 0
  v_mov_b32 v47, 0
  v_mov_b32 v48, 0
  v_mov_b32 v49, 0
  v_mov_b32 v50, 0
  v_mov_b32 v51, 0
  v_mov_b32 v52, 0
  v_mov_b32 v53, 0
  v_mov_b32 v54, 0
  v_mov_b32 v55, 0
  v_mov_b32 v56, 0
  v_mov_b32 v57, 0
  v_mov_b32 v58, 0
  v_mov_b32 v59, 0
  v_mov_b32 v60, 0
  v_mov_b32 v61, 0
  v_mov_b32 v62, 0
  v_mov_b32 v63, 0
  v_mov_b32 v64, 0
  v_mov_b32 v65, 0
  v_mov_b32 v66, 0
  v_mov_b32 v67, 0
  s_mov_b32 s30, 0
  buffer_load_dword v76, v119, s[8:11], s20 offen sc1
  buffer_load_dword v77, v119, s[8:11], s20 offen sc1
  buffer_load_dword v78, v119, s[8:11], s20 offen sc1
cA_va2_fp_l:
  s_waitcnt vmcnt(2)
  v_cmp_eq_u32 vcc, -1, v76
  s_cbranch_vccz cA_va2_fp_d
  buffer_load_dword v76, v119, s[8:11], s20 offen sc1
  s_waitcnt vmcnt(2)
  v_cmp_eq_u32 vcc, -1, v77
  s_cbranch_vccz cA_va2_fp_d
  buffer_load_dword v77, v119, s[8:11], s20 offen sc1
  s_waitcnt vmcnt(2)
  v_cmp_eq_u32 vcc, -1, v78
  s_cbranch_vccz cA_va2_fp_d
  buffer_load_dword v78, v119, s[8:11], s20 offen sc1
  s_add_u32 s30, s30, 1
  s_cmp_lt_u32 s30, 400000
  s_cbranch_scc1 cA_va2_fp_l
  s_branch cA_abort
cA_va2_fp_d:
  s_nop 15
  s_nop 3
  buffer_load_dwordx4 v[8:11], v2, s[8:11], s20 offen offset:0 sc1
  buffer_load_dwordx4 v[12:15], v2, s[8:11], s20 offen offset:1024 sc1
  buffer_load_dwordx4 v[16:19], v2, s[8:11], s20 offen offset:2048 sc1
  buffer_load_dwordx4 v[20:23], v2, s[8:11], s20 offen offset:3072 sc1
  s_barrier
cA_va2_ld:
  s_waitcnt vmcnt(0)
  v_max3_u32 v84, v8, v9, v10
  v_max3_u32 v84, v84, v11, v12
  v_max3_u32 v84, v84, v13, v14
  v_max3_u32 v84, v84, v15, v16
  v_max3_u32 v84, v84, v17, v18
  v_max3_u32 v84, v84, v19, v20
  v_max3_u32 v84, v84, v21, v22
  v_max_u32 v84, v84, v23
  v_cmp_eq_u32 vcc, -1, v84
  ds_write_b128 v2, v[8:11] offset:8192
  ds_write_b128 v2, v[12:15] offset:9216
  ds_write_b128 v2, v[16:19] offset:10240
  ds_write_b128 v2, v[20:23] offset:11264
  s_cbranch_vccnz cA_va2_retry
  s_waitcnt lgkmcnt(0)
  s_barrier
  ds_read_b128 v[24:27], v2 offset:12288
  ds_read_b128 v[28:31], v2 offset:13312
  ds_read_b128 v[32:35], v2 offset:14336
  ds_read_b128 v[92:95], v0
  s_waitcnt lgkmcnt(0)
  s_mov_b64 exec, s[26:27]
  buffer_store_dwordx4 v[92:95], v2, s[8:11], s36 offen sc1
  s_mov_b64 exec, -1
  s_add_u32 s36, s36, 7168
  s_cmp_eq_u32 s19, 63
  s_cbranch_scc1 cA_done
  ds_read_b128 v[76:79], v1 offset:0
  ds_read_b128 v[80:83], v1 offset:1024
  ds_read_b128 v[84:87], v1 offset:2048
  ds_read_b128 v[88:91], v1 offset:3072
  ds_read_b128 v[92:95], v1 offset:4096
  ds_read_b128 v[96:99], v1 offset:5120
  v_smfmac_f32_16x16x64_bf16 v[60:63], v[8:11], v[200:207], v3
  v_smfmac_f32_16x16x64_bf16 v[60:63], v[12:15], v[208:215], v3
  s_waitcnt lgkmcnt(4)
  v_smfmac_f32_16x16x64_bf16 v[64:67], v[8:11], v[76:83], v3
  ds_read_b128 v[76:79], v1 offset:6144
  ds_read_b128 v[80:83], v1 offset:7168
  v_smfmac_f32_16x16x64_bf16 v[60:63], v[16:19], v[216:223], v3
  v_smfmac_f32_16x16x64_bf16 v[60:63], v[20:23], v[224:231], v3
  s_waitcnt lgkmcnt(4)
  v_smfmac_f32_16x16x64_bf16 v[64:67], v[12:15], v[84:91], v3
  ds_read_b128 v[84:87], v1 offset:8192
  ds_read_b128 v[88:91], v1 offset:9216
  v_smfmac_f32_16x16x64_bf16 v[60:63], v[24:27], v[232:239], v3
  v_smfmac_f32_16x16x64_bf16 v[60:63], v[28:31], v[240:247], v3
  s_waitcnt lgkmcnt(4)
  v_smfmac_f32_16x16x64_bf16 v[64:67], v[16:19], v[92:99], v3
  ds_read_b128 v[92:95], v1 offset:10240
  ds_read_b128 v[96:99], v1 offset:11264
  v_smfmac_f32_16x16x64_bf16 v[60:63], v[32:35], v[248:255], v3
  v_smfmac_f32_16x16x64_bf16 v[36:39], v[8:11], a[0:7], v3
  s_waitcnt lgkmcnt(4)
  v_smfmac_f32_16x16x64_bf16 v[64:67], v[20:23], v[76:83], v3
  ds_read_b128 v[76:79], v1 offset:12288
  ds_read_b128 v[80:83], v1 offset:13312
  v_smfmac_f32_16x16x64_bf16 v[36:39], v[12:15], a[8:15], v3
  v_smfmac_f32_16x16x64_bf16 v[36:39], v[16:19], a[16:23], v3
  s_waitcnt lgkmcnt(4)
  v_smfmac_f32_16x16x64_bf16 v[64:67], v[24:27], v[84:91], v3
  v_smfmac_f32_16x16x64_bf16 v[36:39], v[20:23], a[24:31], v3
  v_smfmac_f32_16x16x64_bf16 v[36:39], v[24:27], a[32:39], v3
  s_waitcnt lgkmcnt(2)
  v_smfmac_f32_16x16x64_bf16 v[64:67], v[28:31], v[92:99], v3
  v_smfmac_f32_16x16x64_bf16 v[36:39], v[28:31], a[40:47], v3
  v_smfmac_f32_16x16x64_bf16 v[36:39], v[32:35], a[48:55], v3
  s_waitcnt lgkmcnt(0)
  v_smfmac_f32_16x16x64_bf16 v[64:67], v[32:35], v[76:83], v3
  v_smfmac_f32_16x16x64_bf16 v[40:43], v[8:11], a[56:63], v3
  v_smfmac_f32_16x16x64_bf16 v[40:43], v[12:15], a[64:71], v3
  v_smfmac_f32_16x16x64_bf16 v[40:43], v[16:19], a[72:79], v3
  v_smfmac_f32_16x16x64_bf16 v[40:43], v[20:23], a[80:87], v3
  v_permlane32_swap_b32 v60, v64
  v_smfmac_f32_16x16x64_bf16 v[40:43], v[24:27], a[88:95], v3
  v_permlane32_swap_b32 v61, v65
  v_smfmac_f32_16x16x64_bf16 v[40:43], v[28:31], a[96:103], v3
  v_permlane32_swap_b32 v62, v66
  v_smfmac_f32_16x16x64_bf16 v[40:43], v[32:35], a[104:111], v3
  v_permlane32_swap_b32 v63, v67
  v_smfmac_f32_16x16x64_bf16 v[44:47], v[8:11], a[112:119], v3
  v_smfmac_f32_16x16x64_bf16 v[44:47], v[12:15], a[120:127], v3
  v_smfmac_f32_16x16x64_bf16 v[44:47], v[16:19], a[128:135], v3
  v_smfmac_f32_16x16x64_bf16 v[44:47], v[20:23], a[136:143], v3
  v_add_f32 v60, v60, v64
  v_add_f32 v61, v61, v65
  v_smfmac_f32_16x16x64_bf16 v[44:47], v[24:27], a[144:151], v3
  v_add_f32 v62, v62, v66
  v_add_f32 v63, v63, v67
  v_smfmac_f32_16x16x64_bf16 v[44:47], v[28:31], a[152:159], v3
  v_cvt_pk_bf16_f32 v64, v60, v61
  v_cvt_pk_bf16_f32 v65, v62, v63
  v_smfmac_f32_16x16x64_bf16 v[44:47], v[32:35], a[160:167], v3
  ds_write2_b32 v115, v64, v65 offset0:0 offset1:2
  v_smfmac_f32_16x16x64_bf16 v[48:51], v[8:11], a[168:175], v3
  v_permlane32_swap_b32 v36, v40
  v_smfmac_f32_16x16x64_bf16 v[48:51], v[12:15], a[176:183], v3
  v_permlane32_swap_b32 v37, v41
  v_smfmac_f32_16x16x64_bf16 v[48:51], v[16:19], a[184:191], v3
  v_permlane32_swap_b32 v38, v42
  v_smfmac_f32_16x16x64_bf16 v[48:51], v[20:23], a[192:199], v3
  v_permlane32_swap_b32 v39, v43
  v_smfmac_f32_16x16x64_bf16 v[48:51], v[24:27], a[200:207], v3
  v_add_f32 v36, v36, v40
  v_smfmac_f32_16x16x64_bf16 v[48:51], v[28:31], a[208:215], v3
  v_add_f32 v37, v37, v41
  v_smfmac_f32_16x16x64_bf16 v[48:51], v[32:35], a[216:223], v3
  v_add_f32 v38, v38, v42
  v_smfmac_f32_16x16x64_bf16 v[52:55], v[8:11], a[224:231], v3
  v_smfmac_f32_16x16x64_bf16 v[52:55], v[12:15], a[232:239], v3
  v_smfmac_f32_16x16x64_bf16 v[52:55], v[16:19], a[240:247], v3
  v_smfmac_f32_16x16x64_bf16 v[52:55], v[20:23], a[248:255], v3
  v_add_f32 v39, v39, v43
  v_cvt_pk_bf16_f32 v40, v36, v37
  v_smfmac_f32_16x16x64_bf16 v[52:55], v[24:27], v[120:127], v3
  v_cvt_pk_bf16_f32 v41, v38, v39
  v_smfmac_f32_16x16x64_bf16 v[52:55], v[28:31], v[128:135], v3
  ds_write2_b32 v112, v40, v41 offset0:0 offset1:2
  v_smfmac_f32_16x16x64_bf16 v[52:55], v[32:35], v[136:143], v3
  v_permlane32_swap_b32 v44, v48
  v_smfmac_f32_16x16x64_bf16 v[56:59], v[8:11], v[144:151], v3
  v_permlane32_swap_b32 v45, v49
  v_smfmac_f32_16x16x64_bf16 v[56:59], v[12:15], v[152:159], v3
  v_permlane32_swap_b32 v46, v50
  v_smfmac_f32_16x16x64_bf16 v[56:59], v[16:19], v[160:167], v3
  v_permlane32_swap_b32 v47, v51
  v_smfmac_f32_16x16x64_bf16 v[56:59], v[20:23], v[168:175], v3
  v_add_f32 v44, v44, v48
  v_smfmac_f32_16x16x64_bf16 v[56:59], v[24:27], v[176:183], v3
  v_add_f32 v45, v45, v49
  v_smfmac_f32_16x16x64_bf16 v[56:59], v[28:31], v[184:191], v3
  v_add_f32 v46, v46, v50
  v_smfmac_f32_16x16x64_bf16 v[56:59], v[32:35], v[192:199], v3
  v_add_f32 v47, v47, v51
  v_cvt_pk_bf16_f32 v48, v44, v45
  v_cvt_pk_bf16_f32 v49, v46, v47
  ds_write2_b32 v113, v48, v49 offset0:0 offset1:2
  s_nop 3
  v_permlane32_swap_b32 v52, v56
  v_permlane32_swap_b32 v53, v57
  v_permlane32_swap_b32 v54, v58
  v_permlane32_swap_b32 v55, v59
  v_add_f32 v52, v52, v56
  v_add_f32 v53, v53, v57
  v_add_f32 v54, v54, v58
  v_add_f32 v55, v55, v59
  v_cvt_pk_bf16_f32 v56, v52, v53
  v_cvt_pk_bf16_f32 v57, v54, v55
  ds_write2_b32 v114, v56, v57 offset0:0 offset1:2
  s_waitcnt lgkmcnt(0)
  s_barrier
  s_cmp_eq_u32 s19, 62
  s_cbranch_scc1 cA_done
  s_waitcnt vmcnt(0) lgkmcnt(0)
  s_add_u32 s19, s19, 1
  s_mov_b32 s20, s21
  s_branch cA_va2_loop
cA_va2_retry:
  s_waitcnt lgkmcnt(0)
  buffer_load_dwordx4 v[8:11], v2, s[8:11], s20 offen offset:0 sc1
  buffer_load_dwordx4 v[12:15], v2, s[8:11], s20 offen offset:1024 sc1
  buffer_load_dwordx4 v[16:19], v2, s[8:11], s20 offen offset:2048 sc1
  buffer_load_dwordx4 v[20:23], v2, s[8:11], s20 offen offset:3072 sc1
  s_add_u32 s31, s31, 1
  s_add_u32 s30, s30, 1
  s_cmp_lt_u32 s30, 400000
  s_cbranch_scc1 cA_va2_ld
  s_branch cA_abort
cA_va2_last:
  s_waitcnt lgkmcnt(0)
  buffer_store_dwordx4 v[100:103], v2, s[8:11], s24 offen offset:0 sc1
  buffer_store_dwordx4 v[104:107], v2, s[8:11], s24 offen offset:1024 sc1
  buffer_store_dwordx4 v[108:111], v2, s[8:11], s24 offen offset:2048 sc1
  buffer_store_dwordx4 v[4:7], v2, s[8:11], s24 offen offset:3072 sc1
  s_add_u32 s24, s24, 8192
  s_waitcnt vmcnt(0)
  s_mov_b64 exec, 1
  buffer_store_dword v117, v2, s[8:11], s34 offen sc1
  s_mov_b64 exec, -1
  s_add_u32 s34, s34, 8
  s_mov_b64 exec, 1
  buffer_store_dword v117, v2, s[8:11], s34 offen sc1
  s_mov_b64 exec, -1
  s_add_u32 s34, s34, 8
  s_branch cA_done
.p2align 6

cA_va3_loop:
  s_add_u32 s23, s20, 4096
  s_add_u32 s21, s20, 20480
  v_mov_b32 v36, 0
  v_mov_b32 v37, 0
  v_mov_b32 v38, 0
  v_mov_b32 v39, 0
  v_mov_b32 v40, 0
  v_mov_b32 v41, 0
  v_mov_b32 v42, 0
  v_mov_b32 v43, 0
  v_mov_b32 v44, 0
  v_mov_b32 v45, 0
  v_mov_b32 v46, 0
  v_mov_b32 v47, 0
  v_mov_b32 v48, 0
  v_mov_b32 v49, 0
  v_mov_b32 v50, 0
  v_mov_b32 v51, 0
  v_mov_b32 v52, 0
  v_mov_b32 v53, 0
  v_mov_b32 v54, 0
  v_mov_b32 v55, 0
  v_mov_b32 v56, 0
  v_mov_b32 v57, 0
  v_mov_b32 v58, 0
  v_mov_b32 v59, 0
  v_mov_b32 v60, 0
  v_mov_b32 v61, 0
  v_mov_b32 v62, 0
  v_mov_b32 v63, 0
  v_mov_b32 v64, 0
  v_mov_b32 v65, 0
  v_mov_b32 v66, 0
  v_mov_b32 v67, 0
  s_mov_b32 s30, 0
  buffer_load_dword v76, v119, s[8:11], s20 offen sc1
  buffer_load_dword v77, v119, s[8:11], s20 offen sc1
  buffer_load_dword v78, v119, s[8:11], s20 offen sc1
cA_va3_fp_l:
  s_waitcnt vmcnt(2)
  v_cmp_eq_u32 vcc, -1, v76
  s_cbranch_vccz cA_va3_fp_d
  buffer_load_dword v76, v119, s[8:11], s20 offen sc1
  s_waitcnt vmcnt(2)
  v_cmp_eq_u32 vcc, -1, v77
  s_cbranch_vccz cA_va3_fp_d
  buffer_load_dword v77, v119, s[8:11], s20 offen sc1
  s_waitcnt vmcnt(2)
  v_cmp_eq_u32 vcc, -1, v78
  s_cbranch_vccz cA_va3_fp_d
  buffer_load_dword v78, v119, s[8:11], s20 offen sc1
  s_add_u32 s30, s30, 1
  s_cmp_lt_u32 s30, 400000
  s_cbranch_scc1 cA_va3_fp_l
  s_branch cA_abort
cA_va3_fp_d:
  buffer_load_dwordx4 v[24:27], v2, s[8:11], s23 offen offset:0 sc1
  buffer_load_dwordx4 v[28:31], v2, s[8:11], s23 offen offset:1024 sc1
  buffer_load_dwordx4 v[32:35], v2, s[8:11], s23 offen offset:2048 sc1
  s_barrier
cA_va3_ld:
  s_waitcnt vmcnt(0)
  v_max3_u32 v84, v24, v25, v26
  v_max3_u32 v84, v84, v27, v28
  v_max3_u32 v84, v84, v29, v30
  v_max3_u32 v84, v84, v31, v32
  v_max3_u32 v84, v84, v33, v34
  v_max_u32 v84, v84, v35
  v_cmp_eq_u32 vcc, -1, v84
  ds_write_b128 v2, v[24:27] offset:12288
  ds_write_b128 v2, v[28:31] offset:13312
  ds_write_b128 v2, v[32:35] offset:14336
  s_cbranch_vccnz cA_va3_retry
  s_waitcnt lgkmcnt(0)
  s_barrier
  ds_read_b128 v[8:11], v2 offset:8192
  ds_read_b128 v[12:15], v2 offset:9216
  ds_read_b128 v[16:19], v2 offset:10240
  ds_read_b128 v[20:23], v2 offset:11264
  s_waitcnt lgkmcnt(0)
  s_cmp_eq_u32 s19, 63
  s_cbranch_scc1 cA_done
  ds_read_b128 v[76:79], v1 offset:0
  ds_read_b128 v[80:83], v1 offset:1024
  ds_read_b128 v[84:87], v1 offset:2048
  ds_read_b128 v[88:91], v1 offset:3072
  ds_read_b128 v[92:95], v1 offset:4096
  ds_read_b128 v[96:99], v1 offset:5120
  v_smfmac_f32_16x16x64_bf16 v[60:63], v[8:11], v[200:207], v3
  v_smfmac_f32_16x16x64_bf16 v[60:63], v[12:15], v[208:215], v3
  s_waitcnt lgkmcnt(4)
  v_smfmac_f32_16x16x64_bf16 v[64:67], v[8:11], v[76:83], v3
  ds_read_b128 v[76:79], v1 offset:6144
  ds_read_b128 v[80:83], v1 offset:7168
  v_smfmac_f32_16x16x64_bf16 v[60:63], v[16:19], v[216:223], v3
  v_smfmac_f32_16x16x64_bf16 v[60:63], v[20:23], v[224:231], v3
  s_waitcnt lgkmcnt(4)
  v_smfmac_f32_16x16x64_bf16 v[64:67], v[12:15], v[84:91], v3
  ds_read_b128 v[84:87], v1 offset:8192
  ds_read_b128 v[88:91], v1 offset:9216
  v_smfmac_f32_16x16x64_bf16 v[60:63], v[24:27], v[232:239], v3
  v_smfmac_f32_16x16x64_bf16 v[60:63], v[28:31], v[240:247], v3
  s_waitcnt lgkmcnt(4)
  v_smfmac_f32_16x16x64_bf16 v[64:67], v[16:19], v[92:99], v3
  ds_read_b128 v[92:95], v1 offset:10240
  ds_read_b128 v[96:99], v1 offset:11264
  v_smfmac_f32_16x16x64_bf16 v[60:63], v[32:35], v[248:255], v3
  v_smfmac_f32_16x16x64_bf16 v[36:39], v[8:11], a[0:7], v3
  s_waitcnt lgkmcnt(4)
  v_smfmac_f32_16x16x64_bf16 v[64:67], v[20:23], v[76:83], v3
  ds_read_b128 v[76:79], v1 offset:12288
  ds_read_b128 v[80:83], v1 offset:13312
  v_smfmac_f32_16x16x64_bf16 v[36:39], v[12:15], a[8:15], v3
  v_smfmac_f32_16x16x64_bf16 v[36:39], v[16:19], a[16:23], v3
  s_waitcnt lgkmcnt(4)
  v_smfmac_f32_16x16x64_bf16 v[64:67], v[24:27], v[84:91], v3
  v_smfmac_f32_16x16x64_bf16 v[36:39], v[20:23], a[24:31], v3
  v_smfmac_f32_16x16x64_bf16 v[36:39], v[24:27], a[32:39], v3
  s_waitcnt lgkmcnt(2)
  v_smfmac_f32_16x16x64_bf16 v[64:67], v[28:31], v[92:99], v3
  v_smfmac_f32_16x16x64_bf16 v[36:39], v[28:31], a[40:47], v3
  v_smfmac_f32_16x16x64_bf16 v[36:39], v[32:35], a[48:55], v3
  s_waitcnt lgkmcnt(0)
  v_smfmac_f32_16x16x64_bf16 v[64:67], v[32:35], v[76:83], v3
  v_smfmac_f32_16x16x64_bf16 v[40:43], v[8:11], a[56:63], v3
  v_smfmac_f32_16x16x64_bf16 v[40:43], v[12:15], a[64:71], v3
  v_smfmac_f32_16x16x64_bf16 v[40:43], v[16:19], a[72:79], v3
  v_smfmac_f32_16x16x64_bf16 v[40:43], v[20:23], a[80:87], v3
  v_permlane32_swap_b32 v60, v64
  v_smfmac_f32_16x16x64_bf16 v[40:43], v[24:27], a[88:95], v3
  v_permlane32_swap_b32 v61, v65
  v_smfmac_f32_16x16x64_bf16 v[40:43], v[28:31], a[96:103], v3
  v_permlane32_swap_b32 v62, v66
  v_smfmac_f32_16x16x64_bf16 v[40:43], v[32:35], a[104:111], v3
  v_permlane32_swap_b32 v63, v67
  v_smfmac_f32_16x16x64_bf16 v[44:47], v[8:11], a[112:119], v3
  v_smfmac_f32_16x16x64_bf16 v[44:47], v[12:15], a[120:127], v3
  v_smfmac_f32_16x16x64_bf16 v[44:47], v[16:19], a[128:135], v3
  v_smfmac_f32_16x16x64_bf16 v[44:47], v[20:23], a[136:143], v3
  v_add_f32 v60, v60, v64
  v_add_f32 v61, v61, v65
  v_smfmac_f32_16x16x64_bf16 v[44:47], v[24:27], a[144:151], v3
  v_add_f32 v62, v62, v66
  v_add_f32 v63, v63, v67
  v_smfmac_f32_16x16x64_bf16 v[44:47], v[28:31], a[152:159], v3
  v_cvt_pk_bf16_f32 v64, v60, v61
  v_cvt_pk_bf16_f32 v65, v62, v63
  v_smfmac_f32_16x16x64_bf16 v[44:47], v[32:35], a[160:167], v3
  ds_write2_b32 v115, v64, v65 offset0:0 offset1:2
  v_smfmac_f32_16x16x64_bf16 v[48:51], v[8:11], a[168:175], v3
  v_permlane32_swap_b32 v36, v40
  v_smfmac_f32_16x16x64_bf16 v[48:51], v[12:15], a[176:183], v3
  v_permlane32_swap_b32 v37, v41
  v_smfmac_f32_16x16x64_bf16 v[48:51], v[16:19], a[184:191], v3
  v_permlane32_swap_b32 v38, v42
  v_smfmac_f32_16x16x64_bf16 v[48:51], v[20:23], a[192:199], v3
  v_permlane32_swap_b32 v39, v43
  v_smfmac_f32_16x16x64_bf16 v[48:51], v[24:27], a[200:207], v3
  v_add_f32 v36, v36, v40
  v_smfmac_f32_16x16x64_bf16 v[48:51], v[28:31], a[208:215], v3
  v_add_f32 v37, v37, v41
  v_smfmac_f32_16x16x64_bf16 v[48:51], v[32:35], a[216:223], v3
  v_add_f32 v38, v38, v42
  v_smfmac_f32_16x16x64_bf16 v[52:55], v[8:11], a[224:231], v3
  v_smfmac_f32_16x16x64_bf16 v[52:55], v[12:15], a[232:239], v3
  v_smfmac_f32_16x16x64_bf16 v[52:55], v[16:19], a[240:247], v3
  v_smfmac_f32_16x16x64_bf16 v[52:55], v[20:23], a[248:255], v3
  v_add_f32 v39, v39, v43
  v_cvt_pk_bf16_f32 v40, v36, v37
  v_smfmac_f32_16x16x64_bf16 v[52:55], v[24:27], v[120:127], v3
  v_cvt_pk_bf16_f32 v41, v38, v39
  v_smfmac_f32_16x16x64_bf16 v[52:55], v[28:31], v[128:135], v3
  ds_write2_b32 v112, v40, v41 offset0:0 offset1:2
  v_smfmac_f32_16x16x64_bf16 v[52:55], v[32:35], v[136:143], v3
  v_permlane32_swap_b32 v44, v48
  v_smfmac_f32_16x16x64_bf16 v[56:59], v[8:11], v[144:151], v3
  v_permlane32_swap_b32 v45, v49
  v_smfmac_f32_16x16x64_bf16 v[56:59], v[12:15], v[152:159], v3
  v_permlane32_swap_b32 v46, v50
  v_smfmac_f32_16x16x64_bf16 v[56:59], v[16:19], v[160:167], v3
  v_permlane32_swap_b32 v47, v51
  v_smfmac_f32_16x16x64_bf16 v[56:59], v[20:23], v[168:175], v3
  v_add_f32 v44, v44, v48
  v_smfmac_f32_16x16x64_bf16 v[56:59], v[24:27], v[176:183], v3
  v_add_f32 v45, v45, v49
  v_smfmac_f32_16x16x64_bf16 v[56:59], v[28:31], v[184:191], v3
  v_add_f32 v46, v46, v50
  v_smfmac_f32_16x16x64_bf16 v[56:59], v[32:35], v[192:199], v3
  v_add_f32 v47, v47, v51
  v_cvt_pk_bf16_f32 v48, v44, v45
  v_cvt_pk_bf16_f32 v49, v46, v47
  ds_write2_b32 v113, v48, v49 offset0:0 offset1:2
  s_nop 3
  v_permlane32_swap_b32 v52, v56
  v_permlane32_swap_b32 v53, v57
  v_permlane32_swap_b32 v54, v58
  v_permlane32_swap_b32 v55, v59
  v_add_f32 v52, v52, v56
  v_add_f32 v53, v53, v57
  v_add_f32 v54, v54, v58
  v_add_f32 v55, v55, v59
  v_cvt_pk_bf16_f32 v56, v52, v53
  v_cvt_pk_bf16_f32 v57, v54, v55
  ds_write2_b32 v114, v56, v57 offset0:0 offset1:2
  s_waitcnt lgkmcnt(0)
  s_barrier
  s_cmp_eq_u32 s19, 62
  s_cbranch_scc1 cA_done
  s_waitcnt vmcnt(0) lgkmcnt(0)
  s_add_u32 s19, s19, 1
  s_mov_b32 s20, s21
  s_branch cA_va3_loop
cA_va3_retry:
  s_waitcnt lgkmcnt(0)
  buffer_load_dwordx4 v[24:27], v2, s[8:11], s23 offen offset:0 sc1
  buffer_load_dwordx4 v[28:31], v2, s[8:11], s23 offen offset:1024 sc1
  buffer_load_dwordx4 v[32:35], v2, s[8:11], s23 offen offset:2048 sc1
  s_add_u32 s31, s31, 1
  s_add_u32 s30, s30, 1
  s_cmp_lt_u32 s30, 400000
  s_cbranch_scc1 cA_va3_ld
  s_branch cA_abort
cA_va3_last:
  s_waitcnt lgkmcnt(0)
  buffer_store_dwordx4 v[100:103], v2, s[8:11], s24 offen offset:0 sc1
  buffer_store_dwordx4 v[104:107], v2, s[8:11], s24 offen offset:1024 sc1
  buffer_store_dwordx4 v[108:111], v2, s[8:11], s24 offen offset:2048 sc1
  buffer_store_dwordx4 v[4:7], v2, s[8:11], s24 offen offset:3072 sc1
  s_add_u32 s24, s24, 8192
  s_waitcnt vmcnt(0)
  s_mov_b64 exec, 1
  buffer_store_dword v117, v2, s[8:11], s34 offen sc1
  s_mov_b64 exec, -1
  s_add_u32 s34, s34, 8
  s_mov_b64 exec, 1
  buffer_store_dword v117, v2, s[8:11], s34 offen sc1
  s_mov_b64 exec, -1
  s_add_u32 s34, s34, 8
  s_branch cA_done
cA_abort:
  v_mov_b32 v4, 0xdead
  v_mov_b32 v5, 16
  buffer_store_dword v4, v5, s[12:15], 0 offen
  s_branch ch_end
cA_done:
  s_branch ch_end
.p2align 6

cB_sc0_loop:
  s_add_u32 s23, s20, 4096
  s_add_u32 s21, s20, 20480
  v_mov_b32 v48, 0
  v_mov_b32 v49, 0
  v_mov_b32 v50, 0
  v_mov_b32 v51, 0
  v_mov_b32 v52, 0
  v_mov_b32 v53, 0
  v_mov_b32 v54, 0
  v_mov_b32 v55, 0
  v_mov_b32 v56, 0
  v_mov_b32 v57, 0
  v_mov_b32 v58, 0
  v_mov_b32 v59, 0
  v_mov_b32 v60, 0
  v_mov_b32 v61, 0
  v_mov_b32 v62, 0
  v_mov_b32 v63, 0
  v_mov_b32 v88, 0
  v_mov_b32 v89, 0
  v_mov_b32 v90, 0
  v_mov_b32 v91, 0
  v_mov_b32 v92, 0
  v_mov_b32 v93, 0
  v_mov_b32 v94, 0
  v_mov_b32 v95, 0
  v_mov_b32 v66, 0
  v_mov_b32 v67, 0
  s_mov_b32 s30, 0
  s_mov_b32 s62, 0
  buffer_load_dword v68, v0, s[8:11], s20 offen sc1
  s_nop 7
  buffer_load_dword v69, v0, s[8:11], s20 offen sc1
  s_nop 7
  buffer_load_dword v70, v0, s[8:11], s20 offen sc1
  s_nop 7
  buffer_load_dword v71, v0, s[8:11], s20 offen sc1
  s_nop 7
  buffer_load_dword v72, v0, s[8:11], s20 offen sc1
cB_sc0_fp_l:
  s_waitcnt vmcnt(4)
  v_cmp_eq_u32 vcc, -1, v68
  s_cbranch_vccz cB_sc0_fp_d
  buffer_load_dword v68, v0, s[8:11], s20 offen sc1
  s_waitcnt vmcnt(4)
  v_cmp_eq_u32 vcc, -1, v69
  s_cbranch_vccz cB_sc0_fp_d
  buffer_load_dword v69, v0, s[8:11], s20 offen sc1
  s_waitcnt vmcnt(4)
  v_cmp_eq_u32 vcc, -1, v70
  s_cbranch_vccz cB_sc0_fp_d
  buffer_load_dword v70, v0, s[8:11], s20 offen sc1
  s_waitcnt vmcnt(4)
  v_cmp_eq_u32 vcc, -1, v71
  s_cbranch_vccz cB_sc0_fp_d
  buffer_load_dword v71, v0, s[8:11], s20 offen sc1
  s_waitcnt vmcnt(4)
  v_cmp_eq_u32 vcc, -1, v72
  s_cbranch_vccz cB_sc0_fp_d
  buffer_load_dword v72, v0, s[8:11], s20 offen sc1
  s_add_u32 s30, s30, 1
  s_cmp_lt_u32 s30, 400000
  s_cbranch_scc1 cB_sc0_fp_l
  s_branch cB_abort
cB_sc0_fp_d:
  buffer_load_dwordx4 v[8:11], v2, s[8:11], s20 offen offset:0 sc1
  s_barrier
  s_branch cB_sc0_ld1
cB_sc0_ld:
  buffer_load_dwordx4 v[8:11], v2, s[8:11], s20 offen offset:0 sc1
cB_sc0_ld1:
  v_mov_b32 v36, 0
  v_mov_b32 v37, 0
  v_mov_b32 v38, 0
  v_mov_b32 v39, 0
  buffer_load_dwordx4 v[12:15], v2, s[8:11], s20 offen offset:1024 sc1
  v_mov_b32 v40, 0
  v_mov_b32 v41, 0
  v_mov_b32 v42, 0
  v_mov_b32 v43, 0
  buffer_load_dwordx4 v[16:19], v2, s[8:11], s20 offen offset:2048 sc1
  v_mov_b32 v44, 0
  v_mov_b32 v45, 0
  v_mov_b32 v46, 0
  v_mov_b32 v47, 0
  ds_read_b128 v[96:99], v117 offset:0
  ds_read_b128 v[100:103], v117 offset:1024
  ds_read_b128 v[104:107], v117 offset:14336
  ds_read_b128 v[108:111], v117 offset:15360
  s_waitcnt vmcnt(2)
  v_smfmac_f32_16x16x64_bf16 v[36:39], v[8:11], a[0:7], v3
  v_smfmac_f32_16x16x64_bf16 v[40:43], v[8:11], a[56:63], v3
  buffer_load_dwordx4 v[20:23], v2, s[8:11], s20 offen offset:3072 sc1
  v_smfmac_f32_16x16x64_bf16 v[44:47], v[8:11], a[112:119], v3
  v_smfmac_f32_16x16x64_bf16 v[48:51], v[8:11], a[168:175], v3
  v_smfmac_f32_16x16x64_bf16 v[52:55], v[8:11], a[224:231], v3
  buffer_load_dwordx4 v[24:27], v2, s[8:11], s23 offen offset:0 sc1
  v_smfmac_f32_16x16x64_bf16 v[56:59], v[8:11], v[144:151], v3
  v_smfmac_f32_16x16x64_bf16 v[60:63], v[8:11], v[200:207], v3
  s_waitcnt vmcnt(3)
  v_smfmac_f32_16x16x64_bf16 v[36:39], v[12:15], a[8:15], v3
  v_smfmac_f32_16x16x64_bf16 v[40:43], v[12:15], a[64:71], v3
  buffer_load_dwordx4 v[28:31], v2, s[8:11], s23 offen offset:1024 sc1
  v_smfmac_f32_16x16x64_bf16 v[44:47], v[12:15], a[120:127], v3
  v_smfmac_f32_16x16x64_bf16 v[48:51], v[12:15], a[176:183], v3
  v_smfmac_f32_16x16x64_bf16 v[52:55], v[12:15], a[232:239], v3
  buffer_load_dwordx4 v[32:35], v2, s[8:11], s23 offen offset:2048 sc1
  v_smfmac_f32_16x16x64_bf16 v[56:59], v[12:15], v[152:159], v3
  v_smfmac_f32_16x16x64_bf16 v[60:63], v[12:15], v[208:215], v3
  s_waitcnt vmcnt(4)
  v_smfmac_f32_16x16x64_bf16 v[36:39], v[16:19], a[16:23], v3
  v_smfmac_f32_16x16x64_bf16 v[40:43], v[16:19], a[72:79], v3
  v_smfmac_f32_16x16x64_bf16 v[44:47], v[16:19], a[128:135], v3
  v_smfmac_f32_16x16x64_bf16 v[48:51], v[16:19], a[184:191], v3
  v_smfmac_f32_16x16x64_bf16 v[52:55], v[16:19], a[240:247], v3
  v_smfmac_f32_16x16x64_bf16 v[56:59], v[16:19], v[160:167], v3
  v_smfmac_f32_16x16x64_bf16 v[60:63], v[16:19], v[216:223], v3
  s_waitcnt vmcnt(3)
  v_smfmac_f32_16x16x64_bf16 v[36:39], v[20:23], a[24:31], v3
  v_smfmac_f32_16x16x64_bf16 v[40:43], v[20:23], a[80:87], v3
  v_smfmac_f32_16x16x64_bf16 v[44:47], v[20:23], a[136:143], v3
  v_smfmac_f32_16x16x64_bf16 v[48:51], v[20:23], a[192:199], v3
  v_smfmac_f32_16x16x64_bf16 v[52:55], v[20:23], a[248:255], v3
  v_smfmac_f32_16x16x64_bf16 v[56:59], v[20:23], v[168:175], v3
  v_smfmac_f32_16x16x64_bf16 v[60:63], v[20:23], v[224:231], v3
  s_waitcnt vmcnt(0)
cB_sc0_ph2:
  v_smfmac_f32_16x16x64_bf16 v[60:63], v[24:27], v[232:239], v3
  ds_read_b128 v[12:15], v116 offset:0
  ds_read_b128 v[16:19], v116 offset:1024
  v_smfmac_f32_16x16x64_bf16 v[60:63], v[28:31], v[240:247], v3
  v_smfmac_f32_16x16x64_bf16 v[60:63], v[32:35], v[248:255], v3
  v_mov_b32 v80, v24
  v_smfmac_f32_16x16x64_bf16 v[52:55], v[24:27], v[120:127], v3
  v_mov_b32 v81, v25
  v_smfmac_f32_16x16x64_bf16 v[52:55], v[28:31], v[128:135], v3
  v_mov_b32 v82, v32
  v_smfmac_f32_16x16x64_bf16 v[52:55], v[32:35], v[136:143], v3
  v_cvt_pk_bf16_f32 v64, v60, v61
  v_smfmac_f32_16x16x64_bf16 v[56:59], v[24:27], v[176:183], v3
  v_cvt_pk_bf16_f32 v65, v62, v63
  v_smfmac_f32_16x16x64_bf16 v[56:59], v[28:31], v[184:191], v3
  v_mov_b32 v83, v33
  v_mfma_f32_16x16x32_bf16 v[68:71], v[64:67], v[4:7], 0
  v_smfmac_f32_16x16x64_bf16 v[56:59], v[32:35], v[192:199], v3
  v_cvt_pk_bf16_f32 v64, v52, v53
  v_smfmac_f32_16x16x64_bf16 v[36:39], v[24:27], a[32:39], v3
  v_cvt_pk_bf16_f32 v65, v54, v55
  v_smfmac_f32_16x16x64_bf16 v[36:39], v[28:31], a[40:47], v3
  v_cvt_pk_bf16_f32 v78, v68, v69
  v_smfmac_f32_16x16x64_bf16 v[36:39], v[32:35], a[48:55], v3
  v_cvt_pk_bf16_f32 v79, v70, v71
  v_cvt_pk_bf16_f32 v66, v56, v57
  v_smfmac_f32_16x16x64_bf16 v[40:43], v[24:27], a[88:95], v3
  v_cvt_pk_bf16_f32 v67, v58, v59
  v_smfmac_f32_16x16x64_bf16 v[40:43], v[28:31], a[96:103], v3
  v_mfma_f32_16x16x32_bf16 v[72:75], v[64:67], v[4:7], 0
  ds_read_b128 v[52:55], v116 offset:14336
  ds_read_b128 v[56:59], v116 offset:15360
  v_smfmac_f32_16x16x64_bf16 v[40:43], v[32:35], a[104:111], v3
  v_cvt_pk_bf16_f32 v64, v36, v37
  v_smfmac_f32_16x16x64_bf16 v[44:47], v[24:27], a[144:151], v3
  v_cvt_pk_bf16_f32 v65, v38, v39
  v_smfmac_f32_16x16x64_bf16 v[44:47], v[28:31], a[152:159], v3
  v_cvt_pk_bf16_f32 v76, v72, v73
  v_smfmac_f32_16x16x64_bf16 v[44:47], v[32:35], a[160:167], v3
  v_cvt_pk_bf16_f32 v77, v74, v75
  v_cvt_pk_bf16_f32 v66, v40, v41
  v_smfmac_f32_16x16x64_bf16 v[48:51], v[24:27], a[200:207], v3
  v_cvt_pk_bf16_f32 v67, v42, v43
  v_smfmac_f32_16x16x64_bf16 v[48:51], v[28:31], a[208:215], v3
  v_mfma_f32_16x16x32_bf16 v[68:71], v[64:67], v[4:7], 0
  v_smfmac_f32_16x16x64_bf16 v[48:51], v[32:35], a[216:223], v3
  v_cvt_pk_bf16_f32 v64, v44, v45
  v_mfma_f32_16x16x32_bf16 v[84:87], v[80:83], v[76:79], 0
  v_cvt_pk_bf16_f32 v65, v46, v47
  s_waitcnt lgkmcnt(0)
  v_smfmac_f32_16x16x64_bf16 v[88:91], v[76:79], v[96:103], v118
  v_cvt_pk_bf16_f32 v60, v68, v69
  v_cvt_pk_bf16_f32 v61, v70, v71
  v_cvt_pk_bf16_f32 v66, v48, v49
  v_cvt_pk_bf16_f32 v67, v50, v51
  s_nop 1
  v_mfma_f32_16x16x32_bf16 v[72:75], v[64:67], v[4:7], 0
  v_smfmac_f32_16x16x64_bf16 v[92:95], v[76:79], v[104:111], v118
  s_nop 4
  v_cvt_pk_bf16_f32 v62, v72, v73
  v_cvt_pk_bf16_f32 v63, v74, v75
  s_nop 1
  v_mfma_f32_16x16x32_bf16 v[84:87], v[8:11], v[60:63], v[84:87]
  v_smfmac_f32_16x16x64_bf16 v[88:91], v[60:63], v[12:19], v118
  v_smfmac_f32_16x16x64_bf16 v[92:95], v[60:63], v[52:59], v118
  s_nop 1
  v_permlane32_swap_b32 v84, v86
  v_permlane32_swap_b32 v85, v87
  s_nop 0
  v_add_f32 v88, v88, v89
  v_add_f32_dpp v84, v86, v84 quad_perm:[1,0,3,2] row_mask:0xf bank_mask:0xf
  v_add_f32_dpp v85, v87, v85 quad_perm:[1,0,3,2] row_mask:0xf bank_mask:0xf
  v_add_f32 v89, v90, v91
  ds_write2_b32 v113, v84, v85 offset0:0 offset1:4
  ds_write2_b32 v112, v88, v89 offset0:0 offset1:128
  v_add_f32 v90, v92, v93
  v_add_f32 v91, v94, v95
  ds_write2_b32 v112, v90, v91 offset0:64 offset1:192
  v_cmp_u_f32 vcc, v88, v89
  s_cbranch_vccnz cB_sc0_retry
cB_sc0_cont:
  s_waitcnt lgkmcnt(0)
  s_barrier
  ds_read_b128 v[36:39], v114
  ds_read_b128 v[44:47], v115
  s_waitcnt lgkmcnt(0)
  v_add_f32 v36, v36, v38
  v_add_f32 v37, v37, v39
  v_add_f32 v44, v44, v45
  v_add_f32 v46, v46, v47
  v_add_f32 v44, v44, v46
  v_add_f32 v36, v36, v37
  v_exp_f32 v49, v44
  v_exp_f32 v48, v36
  v_add_f32 v50, abs(v36), abs(v44)
  v_fma_f32 v39, v49, s37, v48
  v_cmp_ngt_f32 vcc, s56, v50
  v_cndmask_b32 v41, v48, v49, s[38:39]
  v_add_f32_dpp v39, v39, v39 quad_perm:[1,0,3,2] row_mask:0xf bank_mask:0xf
  v_cndmask_b32 v40, v49, v48, s[38:39]
  v_mov_b32_dpp v46, v41 quad_perm:[1,0,3,2] row_mask:0xf bank_mask:0xf
  v_add_f32_dpp v39, v39, v39 quad_perm:[2,3,0,1] row_mask:0xf bank_mask:0xf
  v_cndmask_b32 v42, v46, v40, s[38:39]
  v_cndmask_b32 v43, v40, v46, s[38:39]
  v_add_f32_dpp v39, v39, v39 row_half_mirror row_mask:0xf bank_mask:0xf
  s_cbranch_vccnz cB_sc0_slow
  s_nop 0
  v_add_f32_dpp v47, v39, v39 row_mirror row_mask:0xf bank_mask:0xf
  v_add_f32_dpp v39, v39, v39 row_mirror row_mask:0xf bank_mask:0xf
  s_nop 1
  v_permlane16_swap_b32 v39, v47
  v_add_f32 v39, v39, v47
  v_rcp_f32 v39, v39
  s_mov_b64 exec, s[28:29]
  v_mul_f32 v42, v42, v39
  v_mul_f32 v43, v43, v39
  v_cvt_pk_bf16_f32 v42, v42, v43
cB_sc0_pst:
  buffer_store_dword v42, v1, s[8:11], s20 offen sc1
  s_mov_b64 exec, -1
  s_barrier
  s_add_u32 s24, s24, 28672
  s_add_u32 s35, s35, 28672
  s_xor_b32 s25, s25, 28672
  s_add_u32 m0, s25, 0
  s_nop 0
  buffer_load_dwordx4 v2, s[8:11], s24 offen offset:0 sc1 lds
  buffer_load_dwordx4 v2, s[8:11], s24 offen offset:1024 sc1 lds
  buffer_load_dwordx4 v2, s[8:11], s24 offen offset:2048 sc1 lds
  buffer_load_dwordx4 v2, s[8:11], s24 offen offset:3072 sc1 lds
  s_add_u32 m0, s25, 4096
  s_add_u32 s22, s24, 4096
  buffer_load_dwordx4 v2, s[8:11], s22 offen offset:0 sc1 lds
  buffer_load_dwordx4 v2, s[8:11], s22 offen offset:1024 sc1 lds
  buffer_load_dwordx4 v2, s[8:11], s22 offen offset:2048 sc1 lds
  v_xor_b32 v116, 28672, v116
  v_add_u32 v117, s57, v117
  s_sub_u32 s57, 0, s57
  s_add_u32 s19, s19, 1
  s_mov_b32 s20, s21
  s_cmp_lt_u32 s19, 63
  s_cbranch_scc1 cB_sc0_loop
  s_branch cB_done
cB_sc0_slow:
  v_max_f32 v50, v36, v44
  s_nop 1
  v_max_f32_dpp v50, v50, v50 quad_perm:[1,0,3,2] row_mask:0xf bank_mask:0xf
  s_nop 1
  v_max_f32_dpp v50, v50, v50 quad_perm:[2,3,0,1] row_mask:0xf bank_mask:0xf
  s_nop 1
  v_max_f32_dpp v50, v50, v50 row_half_mirror row_mask:0xf bank_mask:0xf
  s_nop 1
  v_max_f32_dpp v50, v50, v50 row_mirror row_mask:0xf bank_mask:0xf
  v_mov_b32 v47, v50
  s_nop 1
  v_permlane16_swap_b32 v50, v47
  v_max_f32 v50, v50, v47
  v_sub_f32 v48, v36, v50
  v_sub_f32 v49, v44, v50
  v_exp_f32 v48, v48
  v_exp_f32 v49, v49
  s_add_u32 s31, s31, 0x100
  v_fma_f32 v39, v49, s37, v48
  v_cndmask_b32 v41, v48, v49, s[38:39]
  s_nop 0
  v_add_f32_dpp v39, v39, v39 quad_perm:[1,0,3,2] row_mask:0xf bank_mask:0xf
  v_cndmask_b32 v40, v49, v48, s[38:39]
  v_mov_b32_dpp v46, v41 quad_perm:[1,0,3,2] row_mask:0xf bank_mask:0xf
  v_add_f32_dpp v39, v39, v39 quad_perm:[2,3,0,1] row_mask:0xf bank_mask:0xf
  v_cndmask_b32 v42, v46, v40, s[38:39]
  v_cndmask_b32 v43, v40, v46, s[38:39]
  v_add_f32_dpp v39, v39, v39 row_half_mirror row_mask:0xf bank_mask:0xf
  s_nop 1
  v_add_f32_dpp v47, v39, v39 row_mirror row_mask:0xf bank_mask:0xf
  v_add_f32_dpp v39, v39, v39 row_mirror row_mask:0xf bank_mask:0xf
  s_nop 1
  v_permlane16_swap_b32 v39, v47
  v_add_f32 v39, v39, v47
  v_rcp_f32 v39, v39
  s_mov_b64 exec, s[28:29]
  v_mul_f32 v42, v42, v39
  v_mul_f32 v43, v43, v39
  v_cvt_pk_bf16_f32 v42, v42, v43
  v_min_u32 v42, -2, v42
  s_branch cB_sc0_pst
cB_sc0_retry:
  s_cmp_lg_u32 s62, 0
  s_cbranch_scc1 cB_sc0_cont
  s_waitcnt vmcnt(0) lgkmcnt(0)
cB_sc0_rv:
  buffer_load_dwordx4 v[8:11], v2, s[8:11], s20 offen offset:0 sc1
  buffer_load_dwordx4 v[12:15], v2, s[8:11], s20 offen offset:1024 sc1
  buffer_load_dwordx4 v[16:19], v2, s[8:11], s20 offen offset:2048 sc1
  buffer_load_dwordx4 v[20:23], v2, s[8:11], s20 offen offset:3072 sc1
  buffer_load_dwordx4 v[24:27], v2, s[8:11], s23 offen offset:0 sc1
  buffer_load_dwordx4 v[28:31], v2, s[8:11], s23 offen offset:1024 sc1
  buffer_load_dwordx4 v[32:35], v2, s[8:11], s23 offen offset:2048 sc1
  s_waitcnt vmcnt(0)
  v_max3_u32 v68, v8, v9, v10
  v_max3_u32 v68, v68, v11, v12
  v_max3_u32 v68, v68, v13, v14
  v_max3_u32 v68, v68, v15, v16
  v_max3_u32 v68, v68, v17, v18
  v_max3_u32 v68, v68, v19, v20
  v_max3_u32 v68, v68, v21, v22
  v_max3_u32 v68, v68, v23, v24
  v_max3_u32 v68, v68, v25, v26
  v_max3_u32 v68, v68, v27, v28
  v_max3_u32 v68, v68, v29, v30
  v_max3_u32 v68, v68, v31, v32
  v_max3_u32 v68, v68, v33, v34
  v_max_u32 v68, v68, v35
  v_cmp_eq_u32 vcc, -1, v68
  s_cbranch_vccz cB_sc0_rk
  s_add_u32 s30, s30, 1
  s_cmp_lt_u32 s30, 400000
  s_cbranch_scc1 cB_sc0_rv
  s_branch cB_abort
cB_sc0_rk:
  s_mov_b32 s62, 1
  v_mov_b32 v36, 0
  v_mov_b32 v37, 0
  v_mov_b32 v38, 0
  v_mov_b32 v39, 0
  v_mov_b32 v40, 0
  v_mov_b32 v41, 0
  v_mov_b32 v42, 0
  v_mov_b32 v43, 0
  v_mov_b32 v44, 0
  v_mov_b32 v45, 0
  v_mov_b32 v46, 0
  v_mov_b32 v47, 0
  v_mov_b32 v48, 0
  v_mov_b32 v49, 0
  v_mov_b32 v50, 0
  v_mov_b32 v51, 0
  v_mov_b32 v52, 0
  v_mov_b32 v53, 0
  v_mov_b32 v54, 0
  v_mov_b32 v55, 0
  v_mov_b32 v56, 0
  v_mov_b32 v57, 0
  v_mov_b32 v58, 0
  v_mov_b32 v59, 0
  v_mov_b32 v60, 0
  v_mov_b32 v61, 0
  v_mov_b32 v62, 0
  v_mov_b32 v63, 0
  v_mov_b32 v88, 0
  v_mov_b32 v89, 0
  v_mov_b32 v90, 0
  v_mov_b32 v91, 0
  v_mov_b32 v92, 0
  v_mov_b32 v93, 0
  v_mov_b32 v94, 0
  v_mov_b32 v95, 0
  v_mov_b32 v66, 0
  v_mov_b32 v67, 0
  s_add_u32 s31, s31, 1
  ds_read_b128 v[96:99], v117 offset:0
  ds_read_b128 v[100:103], v117 offset:1024
  ds_read_b128 v[104:107], v117 offset:14336
  ds_read_b128 v[108:111], v117 offset:15360
  v_smfmac_f32_16x16x64_bf16 v[36:39], v[8:11], a[0:7], v3
  v_smfmac_f32_16x16x64_bf16 v[40:43], v[8:11], a[56:63], v3
  v_smfmac_f32_16x16x64_bf16 v[44:47], v[8:11], a[112:119], v3
  v_smfmac_f32_16x16x64_bf16 v[48:51], v[8:11], a[168:175], v3
  v_smfmac_f32_16x16x64_bf16 v[52:55], v[8:11], a[224:231], v3
  v_smfmac_f32_16x16x64_bf16 v[56:59], v[8:11], v[144:151], v3
  v_smfmac_f32_16x16x64_bf16 v[60:63], v[8:11], v[200:207], v3
  v_smfmac_f32_16x16x64_bf16 v[36:39], v[12:15], a[8:15], v3
  v_smfmac_f32_16x16x64_bf16 v[40:43], v[12:15], a[64:71], v3
  v_smfmac_f32_16x16x64_bf16 v[44:47], v[12:15], a[120:127], v3
  v_smfmac_f32_16x16x64_bf16 v[48:51], v[12:15], a[176:183], v3
  v_smfmac_f32_16x16x64_bf16 v[52:55], v[12:15], a[232:239], v3
  v_smfmac_f32_16x16x64_bf16 v[56:59], v[12:15], v[152:159], v3
  v_smfmac_f32_16x16x64_bf16 v[60:63], v[12:15], v[208:215], v3
  v_smfmac_f32_16x16x64_bf16 v[36:39], v[16:19], a[16:23], v3
  v_smfmac_f32_16x16x64_bf16 v[40:43], v[16:19], a[72:79], v3
  v_smfmac_f32_16x16x64_bf16 v[44:47], v[16:19], a[128:135], v3
  v_smfmac_f32_16x16x64_bf16 v[48:51], v[16:19], a[184:191], v3
  v_smfmac_f32_16x16x64_bf16 v[52:55], v[16:19], a[240:247], v3
  v_smfmac_f32_16x16x64_bf16 v[56:59], v[16:19], v[160:167], v3
  v_smfmac_f32_16x16x64_bf16 v[60:63], v[16:19], v[216:223], v3
  v_smfmac_f32_16x16x64_bf16 v[36:39], v[20:23], a[24:31], v3
  v_smfmac_f32_16x16x64_bf16 v[40:43], v[20:23], a[80:87], v3
  v_smfmac_f32_16x16x64_bf16 v[44:47], v[20:23], a[136:143], v3
  v_smfmac_f32_16x16x64_bf16 v[48:51], v[20:23], a[192:199], v3
  v_smfmac_f32_16x16x64_bf16 v[52:55], v[20:23], a[248:255], v3
  v_smfmac_f32_16x16x64_bf16 v[56:59], v[20:23], v[168:175], v3
  v_smfmac_f32_16x16x64_bf16 v[60:63], v[20:23], v[224:231], v3
  s_branch cB_sc0_ph2
.p2align 6

cB_sc1_loop:
  s_add_u32 s23, s20, 4096
  s_add_u32 s21, s20, 20480
  v_mov_b32 v48, 0
  v_mov_b32 v49, 0
  v_mov_b32 v50, 0
  v_mov_b32 v51, 0
  v_mov_b32 v52, 0
  v_mov_b32 v53, 0
  v_mov_b32 v54, 0
  v_mov_b32 v55, 0
  v_mov_b32 v56, 0
  v_mov_b32 v57, 0
  v_mov_b32 v58, 0
  v_mov_b32 v59, 0
  v_mov_b32 v60, 0
  v_mov_b32 v61, 0
  v_mov_b32 v62, 0
  v_mov_b32 v63, 0
  v_mov_b32 v88, 0
  v_mov_b32 v89, 0
  v_mov_b32 v90, 0
  v_mov_b32 v91, 0
  v_mov_b32 v92, 0
  v_mov_b32 v93, 0
  v_mov_b32 v94, 0
  v_mov_b32 v95, 0
  v_mov_b32 v64, 0
  v_mov_b32 v65, 0
  s_mov_b32 s30, 0
  s_mov_b32 s62, 0
  s_waitcnt vmcnt(0)
  s_barrier
cB_sc1_ld:
  buffer_load_dwordx4 v[8:11], v2, s[8:11], s20 offen offset:0 sc1
  v_mov_b32 v36, 0
  v_mov_b32 v37, 0
  v_mov_b32 v38, 0
  v_mov_b32 v39, 0
  buffer_load_dwordx4 v[12:15], v2, s[8:11], s20 offen offset:1024 sc1
  v_mov_b32 v40, 0
  v_mov_b32 v41, 0
  v_mov_b32 v42, 0
  v_mov_b32 v43, 0
  buffer_load_dwordx4 v[16:19], v2, s[8:11], s20 offen offset:2048 sc1
  v_mov_b32 v44, 0
  v_mov_b32 v45, 0
  v_mov_b32 v46, 0
  v_mov_b32 v47, 0
  ds_read_b128 v[96:99], v117 offset:0
  ds_read_b128 v[100:103], v117 offset:1024
  ds_read_b128 v[104:107], v117 offset:14336
  ds_read_b128 v[108:111], v117 offset:15360
  s_waitcnt vmcnt(2)
  v_smfmac_f32_16x16x64_bf16 v[36:39], v[8:11], a[0:7], v3
  v_smfmac_f32_16x16x64_bf16 v[40:43], v[8:11], a[56:63], v3
  buffer_load_dwordx4 v[20:23], v2, s[8:11], s20 offen offset:3072 sc1
  v_smfmac_f32_16x16x64_bf16 v[44:47], v[8:11], a[112:119], v3
  v_smfmac_f32_16x16x64_bf16 v[48:51], v[8:11], a[168:175], v3
  v_smfmac_f32_16x16x64_bf16 v[52:55], v[8:11], a[224:231], v3
  buffer_load_dwordx4 v[24:27], v2, s[8:11], s23 offen offset:0 sc1
  v_smfmac_f32_16x16x64_bf16 v[56:59], v[8:11], v[144:151], v3
  v_smfmac_f32_16x16x64_bf16 v[60:63], v[8:11], v[200:207], v3
  s_waitcnt vmcnt(3)
  v_smfmac_f32_16x16x64_bf16 v[36:39], v[12:15], a[8:15], v3
  v_smfmac_f32_16x16x64_bf16 v[40:43], v[12:15], a[64:71], v3
  buffer_load_dwordx4 v[28:31], v2, s[8:11], s23 offen offset:1024 sc1
  v_smfmac_f32_16x16x64_bf16 v[44:47], v[12:15], a[120:127], v3
  v_smfmac_f32_16x16x64_bf16 v[48:51], v[12:15], a[176:183], v3
  v_smfmac_f32_16x16x64_bf16 v[52:55], v[12:15], a[232:239], v3
  buffer_load_dwordx4 v[32:35], v2, s[8:11], s23 offen offset:2048 sc1
  v_smfmac_f32_16x16x64_bf16 v[56:59], v[12:15], v[152:159], v3
  v_smfmac_f32_16x16x64_bf16 v[60:63], v[12:15], v[208:215], v3
  s_waitcnt vmcnt(4)
  v_smfmac_f32_16x16x64_bf16 v[36:39], v[16:19], a[16:23], v3
  v_smfmac_f32_16x16x64_bf16 v[40:43], v[16:19], a[72:79], v3
  v_smfmac_f32_16x16x64_bf16 v[44:47], v[16:19], a[128:135], v3
  v_smfmac_f32_16x16x64_bf16 v[48:51], v[16:19], a[184:191], v3
  v_smfmac_f32_16x16x64_bf16 v[52:55], v[16:19], a[240:247], v3
  v_smfmac_f32_16x16x64_bf16 v[56:59], v[16:19], v[160:167], v3
  v_smfmac_f32_16x16x64_bf16 v[60:63], v[16:19], v[216:223], v3
  s_waitcnt vmcnt(3)
  v_smfmac_f32_16x16x64_bf16 v[36:39], v[20:23], a[24:31], v3
  v_smfmac_f32_16x16x64_bf16 v[40:43], v[20:23], a[80:87], v3
  v_smfmac_f32_16x16x64_bf16 v[44:47], v[20:23], a[136:143], v3
  v_smfmac_f32_16x16x64_bf16 v[48:51], v[20:23], a[192:199], v3
  v_smfmac_f32_16x16x64_bf16 v[52:55], v[20:23], a[248:255], v3
  v_smfmac_f32_16x16x64_bf16 v[56:59], v[20:23], v[168:175], v3
  v_smfmac_f32_16x16x64_bf16 v[60:63], v[20:23], v[224:231], v3
  s_waitcnt vmcnt(0)
cB_sc1_ph2:
  v_smfmac_f32_16x16x64_bf16 v[60:63], v[24:27], v[232:239], v3
  ds_read_b128 v[16:19], v116 offset:2048
  ds_read_b128 v[20:23], v116 offset:3072
  v_smfmac_f32_16x16x64_bf16 v[60:63], v[28:31], v[240:247], v3
  buffer_load_dword v119, v0, s[8:11], s20 offen sc1
  v_smfmac_f32_16x16x64_bf16 v[60:63], v[32:35], v[248:255], v3
  v_mov_b32 v80, v26
  v_smfmac_f32_16x16x64_bf16 v[52:55], v[24:27], v[120:127], v3
  v_mov_b32 v81, v27
  v_smfmac_f32_16x16x64_bf16 v[52:55], v[28:31], v[128:135], v3
  v_mov_b32 v82, v32
  v_smfmac_f32_16x16x64_bf16 v[52:55], v[32:35], v[136:143], v3
  v_cvt_pk_bf16_f32 v66, v60, v61
  v_smfmac_f32_16x16x64_bf16 v[56:59], v[24:27], v[176:183], v3
  v_cvt_pk_bf16_f32 v67, v62, v63
  v_smfmac_f32_16x16x64_bf16 v[56:59], v[28:31], v[184:191], v3
  v_mov_b32 v83, v33
  v_mfma_f32_16x16x32_bf16 v[68:71], v[64:67], v[4:7], 0
  v_smfmac_f32_16x16x64_bf16 v[56:59], v[32:35], v[192:199], v3
  v_cvt_pk_bf16_f32 v64, v52, v53
  v_smfmac_f32_16x16x64_bf16 v[36:39], v[24:27], a[32:39], v3
  v_cvt_pk_bf16_f32 v65, v54, v55
  v_smfmac_f32_16x16x64_bf16 v[36:39], v[28:31], a[40:47], v3
  v_cvt_pk_bf16_f32 v78, v68, v69
  v_smfmac_f32_16x16x64_bf16 v[36:39], v[32:35], a[48:55], v3
  v_cvt_pk_bf16_f32 v79, v70, v71
  v_cvt_pk_bf16_f32 v66, v56, v57
  v_smfmac_f32_16x16x64_bf16 v[40:43], v[24:27], a[88:95], v3
  v_cvt_pk_bf16_f32 v67, v58, v59
  v_smfmac_f32_16x16x64_bf16 v[40:43], v[28:31], a[96:103], v3
  v_mfma_f32_16x16x32_bf16 v[72:75], v[64:67], v[4:7], 0
  ds_read_b128 v[52:55], v116 offset:16384
  ds_read_b128 v[56:59], v116 offset:17408
  v_smfmac_f32_16x16x64_bf16 v[40:43], v[32:35], a[104:111], v3
  v_cvt_pk_bf16_f32 v64, v36, v37
  v_smfmac_f32_16x16x64_bf16 v[44:47], v[24:27], a[144:151], v3
  v_cvt_pk_bf16_f32 v65, v38, v39
  v_smfmac_f32_16x16x64_bf16 v[44:47], v[28:31], a[152:159], v3
  v_cvt_pk_bf16_f32 v76, v72, v73
  v_smfmac_f32_16x16x64_bf16 v[44:47], v[32:35], a[160:167], v3
  v_cvt_pk_bf16_f32 v77, v74, v75
  v_cvt_pk_bf16_f32 v66, v40, v41
  v_smfmac_f32_16x16x64_bf16 v[48:51], v[24:27], a[200:207], v3
  v_cvt_pk_bf16_f32 v67, v42, v43
  v_smfmac_f32_16x16x64_bf16 v[48:51], v[28:31], a[208:215], v3
  v_mfma_f32_16x16x32_bf16 v[68:71], v[64:67], v[4:7], 0
  v_smfmac_f32_16x16x64_bf16 v[48:51], v[32:35], a[216:223], v3
  v_cvt_pk_bf16_f32 v64, v44, v45
  v_mfma_f32_16x16x32_bf16 v[84:87], v[80:83], v[76:79], 0
  v_cvt_pk_bf16_f32 v65, v46, v47
  s_waitcnt lgkmcnt(0)
  v_smfmac_f32_16x16x64_bf16 v[88:91], v[76:79], v[96:103], v118
  v_cvt_pk_bf16_f32 v60, v68, v69
  v_cvt_pk_bf16_f32 v61, v70, v71
  v_cvt_pk_bf16_f32 v66, v48, v49
  v_cvt_pk_bf16_f32 v67, v50, v51
  s_nop 1
  v_mfma_f32_16x16x32_bf16 v[72:75], v[64:67], v[4:7], 0
  v_smfmac_f32_16x16x64_bf16 v[92:95], v[76:79], v[104:111], v118
  s_nop 4
  v_cvt_pk_bf16_f32 v62, v72, v73
  v_cvt_pk_bf16_f32 v63, v74, v75
  s_nop 1
  v_mfma_f32_16x16x32_bf16 v[84:87], v[12:15], v[60:63], v[84:87]
  v_smfmac_f32_16x16x64_bf16 v[88:91], v[60:63], v[16:23], v118
  v_smfmac_f32_16x16x64_bf16 v[92:95], v[60:63], v[52:59], v118
  s_nop 1
  v_permlane32_swap_b32 v84, v86
  v_permlane32_swap_b32 v85, v87
  s_nop 0
  v_add_f32 v88, v88, v89
  v_add_f32_dpp v84, v86, v84 quad_perm:[1,0,3,2] row_mask:0xf bank_mask:0xf
  v_add_f32_dpp v85, v87, v85 quad_perm:[1,0,3,2] row_mask:0xf bank_mask:0xf
  v_add_f32 v89, v90, v91
  ds_write2_b32 v113, v84, v85 offset0:0 offset1:4
  ds_write2_b32 v112, v88, v89 offset0:0 offset1:128
  v_add_f32 v90, v92, v93
  v_add_f32 v91, v94, v95
  ds_write2_b32 v112, v90, v91 offset0:64 offset1:192
  v_cmp_u_f32 vcc, v88, v89
  s_cbranch_vccnz cB_sc1_retry
cB_sc1_cont:
  s_waitcnt lgkmcnt(0)
  s_barrier
  ds_read_b128 v[36:39], v114
  ds_read_b128 v[44:47], v115
  s_waitcnt lgkmcnt(0)
  v_add_f32 v36, v36, v38
  v_add_f32 v37, v37, v39
  v_add_f32 v44, v44, v45
  v_add_f32 v46, v46, v47
  v_add_f32 v44, v44, v46
  v_add_f32 v36, v36, v37
  v_exp_f32 v49, v44
  v_exp_f32 v48, v36
  v_add_f32 v50, abs(v36), abs(v44)
  v_fma_f32 v39, v49, s37, v48
  v_cmp_ngt_f32 vcc, s56, v50
  v_cndmask_b32 v41, v48, v49, s[38:39]
  v_add_f32_dpp v39, v39, v39 quad_perm:[1,0,3,2] row_mask:0xf bank_mask:0xf
  v_cndmask_b32 v40, v49, v48, s[38:39]
  v_mov_b32_dpp v46, v41 quad_perm:[1,0,3,2] row_mask:0xf bank_mask:0xf
  v_add_f32_dpp v39, v39, v39 quad_perm:[2,3,0,1] row_mask:0xf bank_mask:0xf
  v_cndmask_b32 v42, v46, v40, s[38:39]
  v_cndmask_b32 v43, v40, v46, s[38:39]
  v_add_f32_dpp v39, v39, v39 row_half_mirror row_mask:0xf bank_mask:0xf
  s_cbranch_vccnz cB_sc1_slow
  s_nop 0
  v_add_f32_dpp v47, v39, v39 row_mirror row_mask:0xf bank_mask:0xf
  v_add_f32_dpp v39, v39, v39 row_mirror row_mask:0xf bank_mask:0xf
  s_nop 1
  v_permlane16_swap_b32 v39, v47
  v_add_f32 v39, v39, v47
  v_rcp_f32 v39, v39
  s_mov_b64 exec, s[28:29]
  v_mul_f32 v42, v42, v39
  v_mul_f32 v43, v43, v39
  v_cvt_pk_bf16_f32 v42, v42, v43
cB_sc1_pst:
  buffer_store_dword v42, v1, s[8:11], s20 offen sc1
  s_mov_b64 exec, -1
  s_barrier
  s_add_u32 s24, s24, 28672
  s_add_u32 s35, s35, 28672
  s_xor_b32 s25, s25, 28672
  s_add_u32 m0, s25, 7168
  s_nop 0
  buffer_load_dwordx4 v2, s[8:11], s24 offen offset:0 sc1 lds
  buffer_load_dwordx4 v2, s[8:11], s24 offen offset:1024 sc1 lds
  buffer_load_dwordx4 v2, s[8:11], s24 offen offset:2048 sc1 lds
  buffer_load_dwordx4 v2, s[8:11], s24 offen offset:3072 sc1 lds
  s_add_u32 m0, s25, 11264
  s_add_u32 s22, s24, 4096
  buffer_load_dwordx4 v2, s[8:11], s22 offen offset:0 sc1 lds
  buffer_load_dwordx4 v2, s[8:11], s22 offen offset:1024 sc1 lds
  buffer_load_dwordx4 v2, s[8:11], s22 offen offset:2048 sc1 lds
  v_xor_b32 v116, 28672, v116
  v_add_u32 v117, s57, v117
  s_sub_u32 s57, 0, s57
  s_add_u32 s19, s19, 1
  s_mov_b32 s20, s21
  s_cmp_lt_u32 s19, 63
  s_cbranch_scc1 cB_sc1_loop
  s_branch cB_done
cB_sc1_slow:
  v_max_f32 v50, v36, v44
  s_nop 1
  v_max_f32_dpp v50, v50, v50 quad_perm:[1,0,3,2] row_mask:0xf bank_mask:0xf
  s_nop 1
  v_max_f32_dpp v50, v50, v50 quad_perm:[2,3,0,1] row_mask:0xf bank_mask:0xf
  s_nop 1
  v_max_f32_dpp v50, v50, v50 row_half_mirror row_mask:0xf bank_mask:0xf
  s_nop 1
  v_max_f32_dpp v50, v50, v50 row_mirror row_mask:0xf bank_mask:0xf
  v_mov_b32 v47, v50
  s_nop 1
  v_permlane16_swap_b32 v50, v47
  v_max_f32 v50, v50, v47
  v_sub_f32 v48, v36, v50
  v_sub_f32 v49, v44, v50
  v_exp_f32 v48, v48
  v_exp_f32 v49, v49
  s_add_u32 s31, s31, 0x100
  v_fma_f32 v39, v49, s37, v48
  v_cndmask_b32 v41, v48, v49, s[38:39]
  s_nop 0
  v_add_f32_dpp v39, v39, v39 quad_perm:[1,0,3,2] row_mask:0xf bank_mask:0xf
  v_cndmask_b32 v40, v49, v48, s[38:39]
  v_mov_b32_dpp v46, v41 quad_perm:[1,0,3,2] row_mask:0xf bank_mask:0xf
  v_add_f32_dpp v39, v39, v39 quad_perm:[2,3,0,1] row_mask:0xf bank_mask:0xf
  v_cndmask_b32 v42, v46, v40, s[38:39]
  v_cndmask_b32 v43, v40, v46, s[38:39]
  v_add_f32_dpp v39, v39, v39 row_half_mirror row_mask:0xf bank_mask:0xf
  s_nop 1
  v_add_f32_dpp v47, v39, v39 row_mirror row_mask:0xf bank_mask:0xf
  v_add_f32_dpp v39, v39, v39 row_mirror row_mask:0xf bank_mask:0xf
  s_nop 1
  v_permlane16_swap_b32 v39, v47
  v_add_f32 v39, v39, v47
  v_rcp_f32 v39, v39
  s_mov_b64 exec, s[28:29]
  v_mul_f32 v42, v42, v39
  v_mul_f32 v43, v43, v39
  v_cvt_pk_bf16_f32 v42, v42, v43
  v_min_u32 v42, -2, v42
  s_branch cB_sc1_pst
cB_sc1_retry:
  s_cmp_lg_u32 s62, 0
  s_cbranch_scc1 cB_sc1_cont
  s_waitcnt vmcnt(0) lgkmcnt(0)
cB_sc1_rv:
  buffer_load_dwordx4 v[8:11], v2, s[8:11], s20 offen offset:0 sc1
  buffer_load_dwordx4 v[12:15], v2, s[8:11], s20 offen offset:1024 sc1
  buffer_load_dwordx4 v[16:19], v2, s[8:11], s20 offen offset:2048 sc1
  buffer_load_dwordx4 v[20:23], v2, s[8:11], s20 offen offset:3072 sc1
  buffer_load_dwordx4 v[24:27], v2, s[8:11], s23 offen offset:0 sc1
  buffer_load_dwordx4 v[28:31], v2, s[8:11], s23 offen offset:1024 sc1
  buffer_load_dwordx4 v[32:35], v2, s[8:11], s23 offen offset:2048 sc1
  s_waitcnt vmcnt(0)
  v_max3_u32 v68, v8, v9, v10
  v_max3_u32 v68, v68, v11, v12
  v_max3_u32 v68, v68, v13, v14
  v_max3_u32 v68, v68, v15, v16
  v_max3_u32 v68, v68, v17, v18
  v_max3_u32 v68, v68, v19, v20
  v_max3_u32 v68, v68, v21, v22
  v_max3_u32 v68, v68, v23, v24
  v_max3_u32 v68, v68, v25, v26
  v_max3_u32 v68, v68, v27, v28
  v_max3_u32 v68, v68, v29, v30
  v_max3_u32 v68, v68, v31, v32
  v_max3_u32 v68, v68, v33, v34
  v_max_u32 v68, v68, v35
  v_cmp_eq_u32 vcc, -1, v68
  s_cbranch_vccz cB_sc1_rk
  s_add_u32 s30, s30, 1
  s_cmp_lt_u32 s30, 400000
  s_cbranch_scc1 cB_sc1_rv
  s_branch cB_abort
cB_sc1_rk:
  s_mov_b32 s62, 1
  v_mov_b32 v36, 0
  v_mov_b32 v37, 0
  v_mov_b32 v38, 0
  v_mov_b32 v39, 0
  v_mov_b32 v40, 0
  v_mov_b32 v41, 0
  v_mov_b32 v42, 0
  v_mov_b32 v43, 0
  v_mov_b32 v44, 0
  v_mov_b32 v45, 0
  v_mov_b32 v46, 0
  v_mov_b32 v47, 0
  v_mov_b32 v48, 0
  v_mov_b32 v49, 0
  v_mov_b32 v50, 0
  v_mov_b32 v51, 0
  v_mov_b32 v52, 0
  v_mov_b32 v53, 0
  v_mov_b32 v54, 0
  v_mov_b32 v55, 0
  v_mov_b32 v56, 0
  v_mov_b32 v57, 0
  v_mov_b32 v58, 0
  v_mov_b32 v59, 0
  v_mov_b32 v60, 0
  v_mov_b32 v61, 0
  v_mov_b32 v62, 0
  v_mov_b32 v63, 0
  v_mov_b32 v88, 0
  v_mov_b32 v89, 0
  v_mov_b32 v90, 0
  v_mov_b32 v91, 0
  v_mov_b32 v92, 0
  v_mov_b32 v93, 0
  v_mov_b32 v94, 0
  v_mov_b32 v95, 0
  v_mov_b32 v64, 0
  v_mov_b32 v65, 0
  s_add_u32 s31, s31, 1
  ds_read_b128 v[96:99], v117 offset:0
  ds_read_b128 v[100:103], v117 offset:1024
  ds_read_b128 v[104:107], v117 offset:14336
  ds_read_b128 v[108:111], v117 offset:15360
  v_smfmac_f32_16x16x64_bf16 v[36:39], v[8:11], a[0:7], v3
  v_smfmac_f32_16x16x64_bf16 v[40:43], v[8:11], a[56:63], v3
  v_smfmac_f32_16x16x64_bf16 v[44:47], v[8:11], a[112:119], v3
  v_smfmac_f32_16x16x64_bf16 v[48:51], v[8:11], a[168:175], v3
  v_smfmac_f32_16x16x64_bf16 v[52:55], v[8:11], a[224:231], v3
  v_smfmac_f32_16x16x64_bf16 v[56:59], v[8:11], v[144:151], v3
  v_smfmac_f32_16x16x64_bf16 v[60:63], v[8:11], v[200:207], v3
  v_smfmac_f32_16x16x64_bf16 v[36:39], v[12:15], a[8:15], v3
  v_smfmac_f32_16x16x64_bf16 v[40:43], v[12:15], a[64:71], v3
  v_smfmac_f32_16x16x64_bf16 v[44:47], v[12:15], a[120:127], v3
  v_smfmac_f32_16x16x64_bf16 v[48:51], v[12:15], a[176:183], v3
  v_smfmac_f32_16x16x64_bf16 v[52:55], v[12:15], a[232:239], v3
  v_smfmac_f32_16x16x64_bf16 v[56:59], v[12:15], v[152:159], v3
  v_smfmac_f32_16x16x64_bf16 v[60:63], v[12:15], v[208:215], v3
  v_smfmac_f32_16x16x64_bf16 v[36:39], v[16:19], a[16:23], v3
  v_smfmac_f32_16x16x64_bf16 v[40:43], v[16:19], a[72:79], v3
  v_smfmac_f32_16x16x64_bf16 v[44:47], v[16:19], a[128:135], v3
  v_smfmac_f32_16x16x64_bf16 v[48:51], v[16:19], a[184:191], v3
  v_smfmac_f32_16x16x64_bf16 v[52:55], v[16:19], a[240:247], v3
  v_smfmac_f32_16x16x64_bf16 v[56:59], v[16:19], v[160:167], v3
  v_smfmac_f32_16x16x64_bf16 v[60:63], v[16:19], v[216:223], v3
  v_smfmac_f32_16x16x64_bf16 v[36:39], v[20:23], a[24:31], v3
  v_smfmac_f32_16x16x64_bf16 v[40:43], v[20:23], a[80:87], v3
  v_smfmac_f32_16x16x64_bf16 v[44:47], v[20:23], a[136:143], v3
  v_smfmac_f32_16x16x64_bf16 v[48:51], v[20:23], a[192:199], v3
  v_smfmac_f32_16x16x64_bf16 v[52:55], v[20:23], a[248:255], v3
  v_smfmac_f32_16x16x64_bf16 v[56:59], v[20:23], v[168:175], v3
  v_smfmac_f32_16x16x64_bf16 v[60:63], v[20:23], v[224:231], v3
  s_branch cB_sc1_ph2
.p2align 6

cB_sc2_loop:
  s_add_u32 s23, s20, 4096
  s_add_u32 s21, s20, 20480
  v_mov_b32 v48, 0
  v_mov_b32 v49, 0
  v_mov_b32 v50, 0
  v_mov_b32 v51, 0
  v_mov_b32 v52, 0
  v_mov_b32 v53, 0
  v_mov_b32 v54, 0
  v_mov_b32 v55, 0
  v_mov_b32 v56, 0
  v_mov_b32 v57, 0
  v_mov_b32 v58, 0
  v_mov_b32 v59, 0
  v_mov_b32 v60, 0
  v_mov_b32 v61, 0
  v_mov_b32 v62, 0
  v_mov_b32 v63, 0
  v_mov_b32 v88, 0
  v_mov_b32 v89, 0
  v_mov_b32 v90, 0
  v_mov_b32 v91, 0
  v_mov_b32 v92, 0
  v_mov_b32 v93, 0
  v_mov_b32 v94, 0
  v_mov_b32 v95, 0
  v_mov_b32 v66, 0
  v_mov_b32 v67, 0
  s_mov_b32 s30, 0
  s_mov_b32 s62, 0
  s_waitcnt vmcnt(0)
  s_barrier
cB_sc2_ld:
  buffer_load_dwordx4 v[8:11], v2, s[8:11], s20 offen offset:0 sc1
  v_mov_b32 v36, 0
  v_mov_b32 v37, 0
  v_mov_b32 v38, 0
  v_mov_b32 v39, 0
  buffer_load_dwordx4 v[12:15], v2, s[8:11], s20 offen offset:1024 sc1
  v_mov_b32 v40, 0
  v_mov_b32 v41, 0
  v_mov_b32 v42, 0
  v_mov_b32 v43, 0
  buffer_load_dwordx4 v[16:19], v2, s[8:11], s20 offen offset:2048 sc1
  v_mov_b32 v44, 0
  v_mov_b32 v45, 0
  v_mov_b32 v46, 0
  v_mov_b32 v47, 0
  ds_read_b128 v[96:99], v117 offset:0
  ds_read_b128 v[100:103], v117 offset:1024
  ds_read_b128 v[104:107], v117 offset:14336
  ds_read_b128 v[108:111], v117 offset:15360
  s_waitcnt vmcnt(2)
  v_smfmac_f32_16x16x64_bf16 v[36:39], v[8:11], a[0:7], v3
  v_smfmac_f32_16x16x64_bf16 v[40:43], v[8:11], a[56:63], v3
  buffer_load_dwordx4 v[20:23], v2, s[8:11], s20 offen offset:3072 sc1
  v_smfmac_f32_16x16x64_bf16 v[44:47], v[8:11], a[112:119], v3
  v_smfmac_f32_16x16x64_bf16 v[48:51], v[8:11], a[168:175], v3
  v_smfmac_f32_16x16x64_bf16 v[52:55], v[8:11], a[224:231], v3
  buffer_load_dwordx4 v[24:27], v2, s[8:11], s23 offen offset:0 sc1
  v_smfmac_f32_16x16x64_bf16 v[56:59], v[8:11], v[144:151], v3
  v_smfmac_f32_16x16x64_bf16 v[60:63], v[8:11], v[200:207], v3
  s_waitcnt vmcnt(3)
  v_smfmac_f32_16x16x64_bf16 v[36:39], v[12:15], a[8:15], v3
  v_smfmac_f32_16x16x64_bf16 v[40:43], v[12:15], a[64:71], v3
  buffer_load_dwordx4 v[28:31], v2, s[8:11], s23 offen offset:1024 sc1
  v_smfmac_f32_16x16x64_bf16 v[44:47], v[12:15], a[120:127], v3
  v_smfmac_f32_16x16x64_bf16 v[48:51], v[12:15], a[176:183], v3
  v_smfmac_f32_16x16x64_bf16 v[52:55], v[12:15], a[232:239], v3
  buffer_load_dwordx4 v[32:35], v2, s[8:11], s23 offen offset:2048 sc1
  v_smfmac_f32_16x16x64_bf16 v[56:59], v[12:15], v[152:159], v3
  v_smfmac_f32_16x16x64_bf16 v[60:63], v[12:15], v[208:215], v3
  s_waitcnt vmcnt(4)
  v_smfmac_f32_16x16x64_bf16 v[36:39], v[16:19], a[16:23], v3
  v_smfmac_f32_16x16x64_bf16 v[40:43], v[16:19], a[72:79], v3
  v_smfmac_f32_16x16x64_bf16 v[44:47], v[16:19], a[128:135], v3
  v_smfmac_f32_16x16x64_bf16 v[48:51], v[16:19], a[184:191], v3
  v_smfmac_f32_16x16x64_bf16 v[52:55], v[16:19], a[240:247], v3
  v_smfmac_f32_16x16x64_bf16 v[56:59], v[16:19], v[160:167], v3
  v_smfmac_f32_16x16x64_bf16 v[60:63], v[16:19], v[216:223], v3
  s_waitcnt vmcnt(3)
  v_smfmac_f32_16x16x64_bf16 v[36:39], v[20:23], a[24:31], v3
  v_smfmac_f32_16x16x64_bf16 v[40:43], v[20:23], a[80:87], v3
  v_smfmac_f32_16x16x64_bf16 v[44:47], v[20:23], a[136:143], v3
  v_smfmac_f32_16x16x64_bf16 v[48:51], v[20:23], a[192:199], v3
  v_smfmac_f32_16x16x64_bf16 v[52:55], v[20:23], a[248:255], v3
  v_smfmac_f32_16x16x64_bf16 v[56:59], v[20:23], v[168:175], v3
  v_smfmac_f32_16x16x64_bf16 v[60:63], v[20:23], v[224:231], v3
  s_waitcnt vmcnt(0)
cB_sc2_ph2:
  v_smfmac_f32_16x16x64_bf16 v[60:63], v[24:27], v[232:239], v3
  ds_read_b128 v[8:11], v116 offset:4096
  ds_read_b128 v[12:15], v116 offset:5120
  v_smfmac_f32_16x16x64_bf16 v[60:63], v[28:31], v[240:247], v3
  buffer_load_dword v119, v0, s[8:11], s24 offen sc1
  v_smfmac_f32_16x16x64_bf16 v[60:63], v[32:35], v[248:255], v3
  v_mov_b32 v80, v28
  v_smfmac_f32_16x16x64_bf16 v[52:55], v[24:27], v[120:127], v3
  v_mov_b32 v81, v29
  v_smfmac_f32_16x16x64_bf16 v[52:55], v[28:31], v[128:135], v3
  v_mov_b32 v82, v34
  v_smfmac_f32_16x16x64_bf16 v[52:55], v[32:35], v[136:143], v3
  v_cvt_pk_bf16_f32 v64, v60, v61
  v_smfmac_f32_16x16x64_bf16 v[56:59], v[24:27], v[176:183], v3
  v_cvt_pk_bf16_f32 v65, v62, v63
  v_smfmac_f32_16x16x64_bf16 v[56:59], v[28:31], v[184:191], v3
  v_mov_b32 v83, v35
  v_mfma_f32_16x16x32_bf16 v[68:71], v[64:67], v[4:7], 0
  v_smfmac_f32_16x16x64_bf16 v[56:59], v[32:35], v[192:199], v3
  v_cvt_pk_bf16_f32 v64, v52, v53
  v_smfmac_f32_16x16x64_bf16 v[36:39], v[24:27], a[32:39], v3
  v_cvt_pk_bf16_f32 v65, v54, v55
  v_smfmac_f32_16x16x64_bf16 v[36:39], v[28:31], a[40:47], v3
  v_cvt_pk_bf16_f32 v78, v68, v69
  v_smfmac_f32_16x16x64_bf16 v[36:39], v[32:35], a[48:55], v3
  v_cvt_pk_bf16_f32 v79, v70, v71
  v_cvt_pk_bf16_f32 v66, v56, v57
  v_smfmac_f32_16x16x64_bf16 v[40:43], v[24:27], a[88:95], v3
  v_cvt_pk_bf16_f32 v67, v58, v59
  v_smfmac_f32_16x16x64_bf16 v[40:43], v[28:31], a[96:103], v3
  v_mfma_f32_16x16x32_bf16 v[72:75], v[64:67], v[4:7], 0
  ds_read_b128 v[52:55], v116 offset:18432
  ds_read_b128 v[56:59], v116 offset:19456
  v_smfmac_f32_16x16x64_bf16 v[40:43], v[32:35], a[104:111], v3
  v_cvt_pk_bf16_f32 v64, v36, v37
  v_smfmac_f32_16x16x64_bf16 v[44:47], v[24:27], a[144:151], v3
  v_cvt_pk_bf16_f32 v65, v38, v39
  v_smfmac_f32_16x16x64_bf16 v[44:47], v[28:31], a[152:159], v3
  v_cvt_pk_bf16_f32 v76, v72, v73
  v_smfmac_f32_16x16x64_bf16 v[44:47], v[32:35], a[160:167], v3
  v_cvt_pk_bf16_f32 v77, v74, v75
  v_cvt_pk_bf16_f32 v66, v40, v41
  v_smfmac_f32_16x16x64_bf16 v[48:51], v[24:27], a[200:207], v3
  v_cvt_pk_bf16_f32 v67, v42, v43
  v_smfmac_f32_16x16x64_bf16 v[48:51], v[28:31], a[208:215], v3
  v_mfma_f32_16x16x32_bf16 v[68:71], v[64:67], v[4:7], 0
  v_smfmac_f32_16x16x64_bf16 v[48:51], v[32:35], a[216:223], v3
  v_cvt_pk_bf16_f32 v64, v44, v45
  v_mfma_f32_16x16x32_bf16 v[84:87], v[80:83], v[76:79], 0
  v_cvt_pk_bf16_f32 v65, v46, v47
  s_waitcnt lgkmcnt(0)
  v_smfmac_f32_16x16x64_bf16 v[88:91], v[76:79], v[96:103], v118
  v_cvt_pk_bf16_f32 v60, v68, v69
  v_cvt_pk_bf16_f32 v61, v70, v71
  v_cvt_pk_bf16_f32 v66, v48, v49
  v_cvt_pk_bf16_f32 v67, v50, v51
  s_nop 1
  v_mfma_f32_16x16x32_bf16 v[72:75], v[64:67], v[4:7], 0
  v_smfmac_f32_16x16x64_bf16 v[92:95], v[76:79], v[104:111], v118
  s_nop 4
  v_cvt_pk_bf16_f32 v62, v72, v73
  v_cvt_pk_bf16_f32 v63, v74, v75
  s_nop 1
  v_mfma_f32_16x16x32_bf16 v[84:87], v[16:19], v[60:63], v[84:87]
  v_smfmac_f32_16x16x64_bf16 v[88:91], v[60:63], v[8:15], v118
  v_smfmac_f32_16x16x64_bf16 v[92:95], v[60:63], v[52:59], v118
  s_nop 1
  v_permlane32_swap_b32 v84, v86
  v_permlane32_swap_b32 v85, v87
  s_nop 0
  v_add_f32 v88, v88, v89
  v_add_f32_dpp v84, v86, v84 quad_perm:[1,0,3,2] row_mask:0xf bank_mask:0xf
  v_add_f32_dpp v85, v87, v85 quad_perm:[1,0,3,2] row_mask:0xf bank_mask:0xf
  v_add_f32 v89, v90, v91
  ds_write2_b32 v113, v84, v85 offset0:0 offset1:4
  ds_write2_b32 v112, v88, v89 offset0:0 offset1:128
  v_add_f32 v90, v92, v93
  v_add_f32 v91, v94, v95
  ds_write2_b32 v112, v90, v91 offset0:64 offset1:192
  v_cmp_u_f32 vcc, v88, v89
  s_cbranch_vccnz cB_sc2_retry
cB_sc2_cont:
  s_waitcnt lgkmcnt(0)
  s_barrier
  ds_read_b128 v[36:39], v114
  ds_read_b128 v[44:47], v115
  v_lshl_add_u32 v56, v2, 3, s36
  s_waitcnt lgkmcnt(0)
  v_add_f32 v36, v36, v38
  v_add_f32 v37, v37, v39
  v_add_f32 v44, v44, v45
  s_mov_b64 exec, 15
  buffer_store_dword v2, v56, s[8:11], s20 offen sc1
  s_mov_b64 exec, -1
  v_add_f32 v46, v46, v47
  v_add_f32 v44, v44, v46
  v_add_f32 v36, v36, v37
  v_exp_f32 v49, v44
  v_exp_f32 v48, v36
  v_add_f32 v50, abs(v36), abs(v44)
  v_fma_f32 v39, v49, s37, v48
  v_cmp_ngt_f32 vcc, s56, v50
  v_cndmask_b32 v41, v48, v49, s[38:39]
  v_add_f32_dpp v39, v39, v39 quad_perm:[1,0,3,2] row_mask:0xf bank_mask:0xf
  v_cndmask_b32 v40, v49, v48, s[38:39]
  v_mov_b32_dpp v46, v41 quad_perm:[1,0,3,2] row_mask:0xf bank_mask:0xf
  v_add_f32_dpp v39, v39, v39 quad_perm:[2,3,0,1] row_mask:0xf bank_mask:0xf
  v_cndmask_b32 v42, v46, v40, s[38:39]
  v_cndmask_b32 v43, v40, v46, s[38:39]
  v_add_f32_dpp v39, v39, v39 row_half_mirror row_mask:0xf bank_mask:0xf
  s_cbranch_vccnz cB_sc2_slow
  s_nop 0
  v_add_f32_dpp v47, v39, v39 row_mirror row_mask:0xf bank_mask:0xf
  v_add_f32_dpp v39, v39, v39 row_mirror row_mask:0xf bank_mask:0xf
  s_nop 1
  v_permlane16_swap_b32 v39, v47
  v_add_f32 v39, v39, v47
  v_rcp_f32 v39, v39
  s_mov_b64 exec, s[28:29]
  v_mul_f32 v42, v42, v39
  v_mul_f32 v43, v43, v39
  v_cvt_pk_bf16_f32 v42, v42, v43
cB_sc2_pst:
  buffer_store_dword v42, v1, s[8:11], s20 offen sc1
  s_mov_b64 exec, -1
  s_barrier
  s_add_u32 s24, s24, 28672
  s_add_u32 s35, s35, 28672
  s_xor_b32 s25, s25, 28672
  s_add_u32 m0, s25, 14336
  s_nop 0
  buffer_load_dwordx4 v2, s[8:11], s24 offen offset:0 sc1 lds
  buffer_load_dwordx4 v2, s[8:11], s24 offen offset:1024 sc1 lds
  buffer_load_dwordx4 v2, s[8:11], s24 offen offset:2048 sc1 lds
  buffer_load_dwordx4 v2, s[8:11], s24 offen offset:3072 sc1 lds
  s_add_u32 m0, s25, 18432
  s_add_u32 s22, s24, 4096
  buffer_load_dwordx4 v2, s[8:11], s22 offen offset:0 sc1 lds
  buffer_load_dwordx4 v2, s[8:11], s22 offen offset:1024 sc1 lds
  buffer_load_dwordx4 v2, s[8:11], s22 offen offset:2048 sc1 lds
  v_xor_b32 v116, 28672, v116
  v_add_u32 v117, s57, v117
  s_sub_u32 s57, 0, s57
  s_add_u32 s19, s19, 1
  s_mov_b32 s20, s21
  s_cmp_lt_u32 s19, 63
  s_cbranch_scc1 cB_sc2_loop
  s_branch cB_done
cB_sc2_slow:
  v_max_f32 v50, v36, v44
  s_nop 1
  v_max_f32_dpp v50, v50, v50 quad_perm:[1,0,3,2] row_mask:0xf bank_mask:0xf
  s_nop 1
  v_max_f32_dpp v50, v50, v50 quad_perm:[2,3,0,1] row_mask:0xf bank_mask:0xf
  s_nop 1
  v_max_f32_dpp v50, v50, v50 row_half_mirror row_mask:0xf bank_mask:0xf
  s_nop 1
  v_max_f32_dpp v50, v50, v50 row_mirror row_mask:0xf bank_mask:0xf
  v_mov_b32 v47, v50
  s_nop 1
  v_permlane16_swap_b32 v50, v47
  v_max_f32 v50, v50, v47
  v_sub_f32 v48, v36, v50
  v_sub_f32 v49, v44, v50
  v_exp_f32 v48, v48
  v_exp_f32 v49, v49
  s_add_u32 s31, s31, 0x100
  v_fma_f32 v39, v49, s37, v48
  v_cndmask_b32 v41, v48, v49, s[38:39]
  s_nop 0
  v_add_f32_dpp v39, v39, v39 quad_perm:[1,0,3,2] row_mask:0xf bank_mask:0xf
  v_cndmask_b32 v40, v49, v48, s[38:39]
  v_mov_b32_dpp v46, v41 quad_perm:[1,0,3,2] row_mask:0xf bank_mask:0xf
  v_add_f32_dpp v39, v39, v39 quad_perm:[2,3,0,1] row_mask:0xf bank_mask:0xf
  v_cndmask_b32 v42, v46, v40, s[38:39]
  v_cndmask_b32 v43, v40, v46, s[38:39]
  v_add_f32_dpp v39, v39, v39 row_half_mirror row_mask:0xf bank_mask:0xf
  s_nop 1
  v_add_f32_dpp v47, v39, v39 row_mirror row_mask:0xf bank_mask:0xf
  v_add_f32_dpp v39, v39, v39 row_mirror row_mask:0xf bank_mask:0xf
  s_nop 1
  v_permlane16_swap_b32 v39, v47
  v_add_f32 v39, v39, v47
  v_rcp_f32 v39, v39
  s_mov_b64 exec, s[28:29]
  v_mul_f32 v42, v42, v39
  v_mul_f32 v43, v43, v39
  v_cvt_pk_bf16_f32 v42, v42, v43
  v_min_u32 v42, -2, v42
  s_branch cB_sc2_pst
cB_sc2_retry:
  s_cmp_lg_u32 s62, 0
  s_cbranch_scc1 cB_sc2_cont
  s_waitcnt vmcnt(0) lgkmcnt(0)
cB_sc2_rv:
  buffer_load_dwordx4 v[8:11], v2, s[8:11], s20 offen offset:0 sc1
  buffer_load_dwordx4 v[12:15], v2, s[8:11], s20 offen offset:1024 sc1
  buffer_load_dwordx4 v[16:19], v2, s[8:11], s20 offen offset:2048 sc1
  buffer_load_dwordx4 v[20:23], v2, s[8:11], s20 offen offset:3072 sc1
  buffer_load_dwordx4 v[24:27], v2, s[8:11], s23 offen offset:0 sc1
  buffer_load_dwordx4 v[28:31], v2, s[8:11], s23 offen offset:1024 sc1
  buffer_load_dwordx4 v[32:35], v2, s[8:11], s23 offen offset:2048 sc1
  s_waitcnt vmcnt(0)
  v_max3_u32 v68, v8, v9, v10
  v_max3_u32 v68, v68, v11, v12
  v_max3_u32 v68, v68, v13, v14
  v_max3_u32 v68, v68, v15, v16
  v_max3_u32 v68, v68, v17, v18
  v_max3_u32 v68, v68, v19, v20
  v_max3_u32 v68, v68, v21, v22
  v_max3_u32 v68, v68, v23, v24
  v_max3_u32 v68, v68, v25, v26
  v_max3_u32 v68, v68, v27, v28
  v_max3_u32 v68, v68, v29, v30
  v_max3_u32 v68, v68, v31, v32
  v_max3_u32 v68, v68, v33, v34
  v_max_u32 v68, v68, v35
  v_cmp_eq_u32 vcc, -1, v68
  s_cbranch_vccz cB_sc2_rk
  s_add_u32 s30, s30, 1
  s_cmp_lt_u32 s30, 400000
  s_cbranch_scc1 cB_sc2_rv
  s_branch cB_abort
cB_sc2_rk:
  s_mov_b32 s62, 1
  v_mov_b32 v36, 0
  v_mov_b32 v37, 0
  v_mov_b32 v38, 0
  v_mov_b32 v39, 0
  v_mov_b32 v40, 0
  v_mov_b32 v41, 0
  v_mov_b32 v42, 0
  v_mov_b32 v43, 0
  v_mov_b32 v44, 0
  v_mov_b32 v45, 0
  v_mov_b32 v46, 0
  v_mov_b32 v47, 0
  v_mov_b32 v48, 0
  v_mov_b32 v49, 0
  v_mov_b32 v50, 0
  v_mov_b32 v51, 0
  v_mov_b32 v52, 0
  v_mov_b32 v53, 0
  v_mov_b32 v54, 0
  v_mov_b32 v55, 0
  v_mov_b32 v56, 0
  v_mov_b32 v57, 0
  v_mov_b32 v58, 0
  v_mov_b32 v59, 0
  v_mov_b32 v60, 0
  v_mov_b32 v61, 0
  v_mov_b32 v62, 0
  v_mov_b32 v63, 0
  v_mov_b32 v88, 0
  v_mov_b32 v89, 0
  v_mov_b32 v90, 0
  v_mov_b32 v91, 0
  v_mov_b32 v92, 0
  v_mov_b32 v93, 0
  v_mov_b32 v94, 0
  v_mov_b32 v95, 0
  v_mov_b32 v66, 0
  v_mov_b32 v67, 0
  s_add_u32 s31, s31, 1
  ds_read_b128 v[96:99], v117 offset:0
  ds_read_b128 v[100:103], v117 offset:1024
  ds_read_b128 v[104:107], v117 offset:14336
  ds_read_b128 v[108:111], v117 offset:15360
  v_smfmac_f32_16x16x64_bf16 v[36:39], v[8:11], a[0:7], v3
  v_smfmac_f32_16x16x64_bf16 v[40:43], v[8:11], a[56:63], v3
  v_smfmac_f32_16x16x64_bf16 v[44:47], v[8:11], a[112:119], v3
  v_smfmac_f32_16x16x64_bf16 v[48:51], v[8:11], a[168:175], v3
  v_smfmac_f32_16x16x64_bf16 v[52:55], v[8:11], a[224:231], v3
  v_smfmac_f32_16x16x64_bf16 v[56:59], v[8:11], v[144:151], v3
  v_smfmac_f32_16x16x64_bf16 v[60:63], v[8:11], v[200:207], v3
  v_smfmac_f32_16x16x64_bf16 v[36:39], v[12:15], a[8:15], v3
  v_smfmac_f32_16x16x64_bf16 v[40:43], v[12:15], a[64:71], v3
  v_smfmac_f32_16x16x64_bf16 v[44:47], v[12:15], a[120:127], v3
  v_smfmac_f32_16x16x64_bf16 v[48:51], v[12:15], a[176:183], v3
  v_smfmac_f32_16x16x64_bf16 v[52:55], v[12:15], a[232:239], v3
  v_smfmac_f32_16x16x64_bf16 v[56:59], v[12:15], v[152:159], v3
  v_smfmac_f32_16x16x64_bf16 v[60:63], v[12:15], v[208:215], v3
  v_smfmac_f32_16x16x64_bf16 v[36:39], v[16:19], a[16:23], v3
  v_smfmac_f32_16x16x64_bf16 v[40:43], v[16:19], a[72:79], v3
  v_smfmac_f32_16x16x64_bf16 v[44:47], v[16:19], a[128:135], v3
  v_smfmac_f32_16x16x64_bf16 v[48:51], v[16:19], a[184:191], v3
  v_smfmac_f32_16x16x64_bf16 v[52:55], v[16:19], a[240:247], v3
  v_smfmac_f32_16x16x64_bf16 v[56:59], v[16:19], v[160:167], v3
  v_smfmac_f32_16x16x64_bf16 v[60:63], v[16:19], v[216:223], v3
  v_smfmac_f32_16x16x64_bf16 v[36:39], v[20:23], a[24:31], v3
  v_smfmac_f32_16x16x64_bf16 v[40:43], v[20:23], a[80:87], v3
  v_smfmac_f32_16x16x64_bf16 v[44:47], v[20:23], a[136:143], v3
  v_smfmac_f32_16x16x64_bf16 v[48:51], v[20:23], a[192:199], v3
  v_smfmac_f32_16x16x64_bf16 v[52:55], v[20:23], a[248:255], v3
  v_smfmac_f32_16x16x64_bf16 v[56:59], v[20:23], v[168:175], v3
  v_smfmac_f32_16x16x64_bf16 v[60:63], v[20:23], v[224:231], v3
  s_branch cB_sc2_ph2
.p2align 6

cB_sc3_loop:
  s_add_u32 s23, s20, 4096
  s_add_u32 s21, s20, 20480
  v_mov_b32 v48, 0
  v_mov_b32 v49, 0
  v_mov_b32 v50, 0
  v_mov_b32 v51, 0
  v_mov_b32 v52, 0
  v_mov_b32 v53, 0
  v_mov_b32 v54, 0
  v_mov_b32 v55, 0
  v_mov_b32 v56, 0
  v_mov_b32 v57, 0
  v_mov_b32 v58, 0
  v_mov_b32 v59, 0
  v_mov_b32 v60, 0
  v_mov_b32 v61, 0
  v_mov_b32 v62, 0
  v_mov_b32 v63, 0
  v_mov_b32 v88, 0
  v_mov_b32 v89, 0
  v_mov_b32 v90, 0
  v_mov_b32 v91, 0
  v_mov_b32 v92, 0
  v_mov_b32 v93, 0
  v_mov_b32 v94, 0
  v_mov_b32 v95, 0
  v_mov_b32 v64, 0
  v_mov_b32 v65, 0
  s_mov_b32 s30, 0
  s_mov_b32 s62, 0
  s_waitcnt vmcnt(0)
  s_barrier
cB_sc3_ld:
  buffer_load_dwordx4 v[8:11], v2, s[8:11], s20 offen offset:0 sc1
  v_mov_b32 v36, 0
  v_mov_b32 v37, 0
  v_mov_b32 v38, 0
  v_mov_b32 v39, 0
  buffer_load_dwordx4 v[12:15], v2, s[8:11], s20 offen offset:1024 sc1
  v_mov_b32 v40, 0
  v_mov_b32 v41, 0
  v_mov_b32 v42, 0
  v_mov_b32 v43, 0
  buffer_load_dwordx4 v[16:19], v2, s[8:11], s20 offen offset:2048 sc1
  v_mov_b32 v44, 0
  v_mov_b32 v45, 0
  v_mov_b32 v46, 0
  v_mov_b32 v47, 0
  ds_read_b128 v[96:99], v117 offset:0
  ds_read_b128 v[100:103], v117 offset:1024
  ds_read_b128 v[104:107], v117 offset:14336
  ds_read_b128 v[108:111], v117 offset:15360
  s_waitcnt vmcnt(2)
  v_smfmac_f32_16x16x64_bf16 v[36:39], v[8:11], a[0:7], v3
  v_smfmac_f32_16x16x64_bf16 v[40:43], v[8:11], a[56:63], v3
  buffer_load_dwordx4 v[20:23], v2, s[8:11], s20 offen offset:3072 sc1
  v_smfmac_f32_16x16x64_bf16 v[44:47], v[8:11], a[112:119], v3
  v_smfmac_f32_16x16x64_bf16 v[48:51], v[8:11], a[168:175], v3
  v_smfmac_f32_16x16x64_bf16 v[52:55], v[8:11], a[224:231], v3
  buffer_load_dwordx4 v[24:27], v2, s[8:11], s23 offen offset:0 sc1
  v_smfmac_f32_16x16x64_bf16 v[56:59], v[8:11], v[144:151], v3
  v_smfmac_f32_16x16x64_bf16 v[60:63], v[8:11], v[200:207], v3
  s_waitcnt vmcnt(3)
  v_smfmac_f32_16x16x64_bf16 v[36:39], v[12:15], a[8:15], v3
  v_smfmac_f32_16x16x64_bf16 v[40:43], v[12:15], a[64:71], v3
  buffer_load_dwordx4 v[28:31], v2, s[8:11], s23 offen offset:1024 sc1
  v_smfmac_f32_16x16x64_bf16 v[44:47], v[12:15], a[120:127], v3
  v_smfmac_f32_16x16x64_bf16 v[48:51], v[12:15], a[176:183], v3
  v_smfmac_f32_16x16x64_bf16 v[52:55], v[12:15], a[232:239], v3
  buffer_load_dwordx4 v[32:35], v2, s[8:11], s23 offen offset:2048 sc1
  v_smfmac_f32_16x16x64_bf16 v[56:59], v[12:15], v[152:159], v3
  v_smfmac_f32_16x16x64_bf16 v[60:63], v[12:15], v[208:215], v3
  s_waitcnt vmcnt(4)
  v_smfmac_f32_16x16x64_bf16 v[36:39], v[16:19], a[16:23], v3
  v_smfmac_f32_16x16x64_bf16 v[40:43], v[16:19], a[72:79], v3
  v_smfmac_f32_16x16x64_bf16 v[44:47], v[16:19], a[128:135], v3
  v_smfmac_f32_16x16x64_bf16 v[48:51], v[16:19], a[184:191], v3
  v_smfmac_f32_16x16x64_bf16 v[52:55], v[16:19], a[240:247], v3
  v_smfmac_f32_16x16x64_bf16 v[56:59], v[16:19], v[160:167], v3
  v_smfmac_f32_16x16x64_bf16 v[60:63], v[16:19], v[216:223], v3
  s_waitcnt vmcnt(3)
  v_smfmac_f32_16x16x64_bf16 v[36:39], v[20:23], a[24:31], v3
  v_smfmac_f32_16x16x64_bf16 v[40:43], v[20:23], a[80:87], v3
  v_smfmac_f32_16x16x64_bf16 v[44:47], v[20:23], a[136:143], v3
  v_smfmac_f32_16x16x64_bf16 v[48:51], v[20:23], a[192:199], v3
  v_smfmac_f32_16x16x64_bf16 v[52:55], v[20:23], a[248:255], v3
  v_smfmac_f32_16x16x64_bf16 v[56:59], v[20:23], v[168:175], v3
  v_smfmac_f32_16x16x64_bf16 v[60:63], v[20:23], v[224:231], v3
  s_waitcnt vmcnt(0)
cB_sc3_ph2:
  v_smfmac_f32_16x16x64_bf16 v[60:63], v[24:27], v[232:239], v3
  ds_read_b128 v[8:11], v116 offset:6144
  ds_read_b128 v[12:15], v116 offset:7168
  v_smfmac_f32_16x16x64_bf16 v[60:63], v[28:31], v[240:247], v3
  v_smfmac_f32_16x16x64_bf16 v[60:63], v[32:35], v[248:255], v3
  v_mov_b32 v80, v30
  v_smfmac_f32_16x16x64_bf16 v[52:55], v[24:27], v[120:127], v3
  v_mov_b32 v81, v31
  v_smfmac_f32_16x16x64_bf16 v[52:55], v[28:31], v[128:135], v3
  v_mov_b32 v82, v34
  v_smfmac_f32_16x16x64_bf16 v[52:55], v[32:35], v[136:143], v3
  v_cvt_pk_bf16_f32 v66, v60, v61
  v_smfmac_f32_16x16x64_bf16 v[56:59], v[24:27], v[176:183], v3
  v_cvt_pk_bf16_f32 v67, v62, v63
  v_smfmac_f32_16x16x64_bf16 v[56:59], v[28:31], v[184:191], v3
  v_mov_b32 v83, v35
  v_mfma_f32_16x16x32_bf16 v[68:71], v[64:67], v[4:7], 0
  v_smfmac_f32_16x16x64_bf16 v[56:59], v[32:35], v[192:199], v3
  v_cvt_pk_bf16_f32 v64, v52, v53
  v_smfmac_f32_16x16x64_bf16 v[36:39], v[24:27], a[32:39], v3
  v_cvt_pk_bf16_f32 v65, v54, v55
  v_smfmac_f32_16x16x64_bf16 v[36:39], v[28:31], a[40:47], v3
  v_cvt_pk_bf16_f32 v78, v68, v69
  v_smfmac_f32_16x16x64_bf16 v[36:39], v[32:35], a[48:55], v3
  v_cvt_pk_bf16_f32 v79, v70, v71
  v_cvt_pk_bf16_f32 v66, v56, v57
  v_smfmac_f32_16x16x64_bf16 v[40:43], v[24:27], a[88:95], v3
  v_cvt_pk_bf16_f32 v67, v58, v59
  v_smfmac_f32_16x16x64_bf16 v[40:43], v[28:31], a[96:103], v3
  v_mfma_f32_16x16x32_bf16 v[72:75], v[64:67], v[4:7], 0
  ds_read_b128 v[52:55], v116 offset:20480
  ds_read_b128 v[56:59], v116 offset:21504
  v_smfmac_f32_16x16x64_bf16 v[40:43], v[32:35], a[104:111], v3
  v_cvt_pk_bf16_f32 v64, v36, v37
  v_smfmac_f32_16x16x64_bf16 v[44:47], v[24:27], a[144:151], v3
  v_cvt_pk_bf16_f32 v65, v38, v39
  v_smfmac_f32_16x16x64_bf16 v[44:47], v[28:31], a[152:159], v3
  v_cvt_pk_bf16_f32 v76, v72, v73
  v_smfmac_f32_16x16x64_bf16 v[44:47], v[32:35], a[160:167], v3
  v_cvt_pk_bf16_f32 v77, v74, v75
  v_cvt_pk_bf16_f32 v66, v40, v41
  v_smfmac_f32_16x16x64_bf16 v[48:51], v[24:27], a[200:207], v3
  v_cvt_pk_bf16_f32 v67, v42, v43
  v_smfmac_f32_16x16x64_bf16 v[48:51], v[28:31], a[208:215], v3
  v_mfma_f32_16x16x32_bf16 v[68:71], v[64:67], v[4:7], 0
  v_smfmac_f32_16x16x64_bf16 v[48:51], v[32:35], a[216:223], v3
  v_cvt_pk_bf16_f32 v64, v44, v45
  v_mfma_f32_16x16x32_bf16 v[84:87], v[80:83], v[76:79], 0
  v_cvt_pk_bf16_f32 v65, v46, v47
  s_waitcnt lgkmcnt(0)
  v_smfmac_f32_16x16x64_bf16 v[88:91], v[76:79], v[96:103], v118
  v_cvt_pk_bf16_f32 v60, v68, v69
  v_cvt_pk_bf16_f32 v61, v70, v71
  v_cvt_pk_bf16_f32 v66, v48, v49
  v_cvt_pk_bf16_f32 v67, v50, v51
  s_nop 1
  v_mfma_f32_16x16x32_bf16 v[72:75], v[64:67], v[4:7], 0
  v_smfmac_f32_16x16x64_bf16 v[92:95], v[76:79], v[104:111], v118
  s_nop 4
  v_cvt_pk_bf16_f32 v62, v72, v73
  v_cvt_pk_bf16_f32 v63, v74, v75
  s_nop 1
  v_mfma_f32_16x16x32_bf16 v[84:87], v[20:23], v[60:63], v[84:87]
  v_smfmac_f32_16x16x64_bf16 v[88:91], v[60:63], v[8:15], v118
  v_smfmac_f32_16x16x64_bf16 v[92:95], v[60:63], v[52:59], v118
  s_nop 1
  v_permlane32_swap_b32 v84, v86
  v_permlane32_swap_b32 v85, v87
  s_nop 0
  v_add_f32 v88, v88, v89
  v_add_f32_dpp v84, v86, v84 quad_perm:[1,0,3,2] row_mask:0xf bank_mask:0xf
  v_add_f32_dpp v85, v87, v85 quad_perm:[1,0,3,2] row_mask:0xf bank_mask:0xf
  v_add_f32 v89, v90, v91
  ds_write2_b32 v113, v84, v85 offset0:0 offset1:4
  ds_write2_b32 v112, v88, v89 offset0:0 offset1:128
  v_add_f32 v90, v92, v93
  v_add_f32 v91, v94, v95
  ds_write2_b32 v112, v90, v91 offset0:64 offset1:192
  v_cmp_u_f32 vcc, v88, v89
  s_cbranch_vccnz cB_sc3_retry
cB_sc3_cont:
  s_waitcnt lgkmcnt(0)
  s_barrier
  ds_read_b128 v[36:39], v114
  ds_read_b128 v[44:47], v115
  s_waitcnt lgkmcnt(0)
  v_add_f32 v36, v36, v38
  v_add_f32 v37, v37, v39
  v_add_f32 v44, v44, v45
  v_add_f32 v46, v46, v47
  v_add_f32 v44, v44, v46
  v_add_f32 v36, v36, v37
  v_exp_f32 v49, v44
  v_exp_f32 v48, v36
  v_add_f32 v50, abs(v36), abs(v44)
  v_fma_f32 v39, v49, s37, v48
  v_cmp_ngt_f32 vcc, s56, v50
  v_cndmask_b32 v41, v48, v49, s[38:39]
  v_add_f32_dpp v39, v39, v39 quad_perm:[1,0,3,2] row_mask:0xf bank_mask:0xf
  v_cndmask_b32 v40, v49, v48, s[38:39]
  v_mov_b32_dpp v46, v41 quad_perm:[1,0,3,2] row_mask:0xf bank_mask:0xf
  v_add_f32_dpp v39, v39, v39 quad_perm:[2,3,0,1] row_mask:0xf bank_mask:0xf
  v_cndmask_b32 v42, v46, v40, s[38:39]
  v_cndmask_b32 v43, v40, v46, s[38:39]
  v_add_f32_dpp v39, v39, v39 row_half_mirror row_mask:0xf bank_mask:0xf
  s_cbranch_vccnz cB_sc3_slow
  s_nop 0
  v_add_f32_dpp v47, v39, v39 row_mirror row_mask:0xf bank_mask:0xf
  v_add_f32_dpp v39, v39, v39 row_mirror row_mask:0xf bank_mask:0xf
  s_nop 1
  v_permlane16_swap_b32 v39, v47
  v_add_f32 v39, v39, v47
  v_rcp_f32 v39, v39
  s_mov_b64 exec, s[28:29]
  v_mul_f32 v42, v42, v39
  v_mul_f32 v43, v43, v39
  v_cvt_pk_bf16_f32 v42, v42, v43
cB_sc3_pst:
  buffer_store_dword v42, v1, s[8:11], s20 offen sc1
  s_mov_b64 exec, -1
  s_barrier
  s_add_u32 s24, s24, 28672
  s_add_u32 s35, s35, 28672
  s_xor_b32 s25, s25, 28672
  s_add_u32 m0, s25, 21504
  s_nop 0
  buffer_load_dwordx4 v2, s[8:11], s24 offen offset:0 sc1 lds
  buffer_load_dwordx4 v2, s[8:11], s24 offen offset:1024 sc1 lds
  buffer_load_dwordx4 v2, s[8:11], s24 offen offset:2048 sc1 lds
  buffer_load_dwordx4 v2, s[8:11], s24 offen offset:3072 sc1 lds
  s_add_u32 m0, s25, 25600
  s_add_u32 s22, s24, 4096
  buffer_load_dwordx4 v2, s[8:11], s22 offen offset:0 sc1 lds
  buffer_load_dwordx4 v2, s[8:11], s22 offen offset:1024 sc1 lds
  buffer_load_dwordx4 v2, s[8:11], s22 offen offset:2048 sc1 lds
  v_xor_b32 v116, 28672, v116
  v_add_u32 v117, s57, v117
  s_sub_u32 s57, 0, s57
  s_add_u32 s19, s19, 1
  s_mov_b32 s20, s21
  s_cmp_lt_u32 s19, 63
  s_cbranch_scc1 cB_sc3_loop
  s_branch cB_done
cB_sc3_slow:
  v_max_f32 v50, v36, v44
  s_nop 1
  v_max_f32_dpp v50, v50, v50 quad_perm:[1,0,3,2] row_mask:0xf bank_mask:0xf
  s_nop 1
  v_max_f32_dpp v50, v50, v50 quad_perm:[2,3,0,1] row_mask:0xf bank_mask:0xf
  s_nop 1
  v_max_f32_dpp v50, v50, v50 row_half_mirror row_mask:0xf bank_mask:0xf
  s_nop 1
  v_max_f32_dpp v50, v50, v50 row_mirror row_mask:0xf bank_mask:0xf
  v_mov_b32 v47, v50
  s_nop 1
  v_permlane16_swap_b32 v50, v47
  v_max_f32 v50, v50, v47
  v_sub_f32 v48, v36, v50
  v_sub_f32 v49, v44, v50
  v_exp_f32 v48, v48
  v_exp_f32 v49, v49
  s_add_u32 s31, s31, 0x100
  v_fma_f32 v39, v49, s37, v48
  v_cndmask_b32 v41, v48, v49, s[38:39]
  s_nop 0
  v_add_f32_dpp v39, v39, v39 quad_perm:[1,0,3,2] row_mask:0xf bank_mask:0xf
  v_cndmask_b32 v40, v49, v48, s[38:39]
  v_mov_b32_dpp v46, v41 quad_perm:[1,0,3,2] row_mask:0xf bank_mask:0xf
  v_add_f32_dpp v39, v39, v39 quad_perm:[2,3,0,1] row_mask:0xf bank_mask:0xf
  v_cndmask_b32 v42, v46, v40, s[38:39]
  v_cndmask_b32 v43, v40, v46, s[38:39]
  v_add_f32_dpp v39, v39, v39 row_half_mirror row_mask:0xf bank_mask:0xf
  s_nop 1
  v_add_f32_dpp v47, v39, v39 row_mirror row_mask:0xf bank_mask:0xf
  v_add_f32_dpp v39, v39, v39 row_mirror row_mask:0xf bank_mask:0xf
  s_nop 1
  v_permlane16_swap_b32 v39, v47
  v_add_f32 v39, v39, v47
  v_rcp_f32 v39, v39
  s_mov_b64 exec, s[28:29]
  v_mul_f32 v42, v42, v39
  v_mul_f32 v43, v43, v39
  v_cvt_pk_bf16_f32 v42, v42, v43
  v_min_u32 v42, -2, v42
  s_branch cB_sc3_pst
cB_sc3_retry:
  s_cmp_lg_u32 s62, 0
  s_cbranch_scc1 cB_sc3_cont
  s_waitcnt vmcnt(0) lgkmcnt(0)
cB_sc3_rv:
  buffer_load_dwordx4 v[8:11], v2, s[8:11], s20 offen offset:0 sc1
  buffer_load_dwordx4 v[12:15], v2, s[8:11], s20 offen offset:1024 sc1
  buffer_load_dwordx4 v[16:19], v2, s[8:11], s20 offen offset:2048 sc1
  buffer_load_dwordx4 v[20:23], v2, s[8:11], s20 offen offset:3072 sc1
  buffer_load_dwordx4 v[24:27], v2, s[8:11], s23 offen offset:0 sc1
  buffer_load_dwordx4 v[28:31], v2, s[8:11], s23 offen offset:1024 sc1
  buffer_load_dwordx4 v[32:35], v2, s[8:11], s23 offen offset:2048 sc1
  s_waitcnt vmcnt(0)
  v_max3_u32 v68, v8, v9, v10
  v_max3_u32 v68, v68, v11, v12
  v_max3_u32 v68, v68, v13, v14
  v_max3_u32 v68, v68, v15, v16
  v_max3_u32 v68, v68, v17, v18
  v_max3_u32 v68, v68, v19, v20
  v_max3_u32 v68, v68, v21, v22
  v_max3_u32 v68, v68, v23, v24
  v_max3_u32 v68, v68, v25, v26
  v_max3_u32 v68, v68, v27, v28
  v_max3_u32 v68, v68, v29, v30
  v_max3_u32 v68, v68, v31, v32
  v_max3_u32 v68, v68, v33, v34
  v_max_u32 v68, v68, v35
  v_cmp_eq_u32 vcc, -1, v68
  s_cbranch_vccz cB_sc3_rk
  s_add_u32 s30, s30, 1
  s_cmp_lt_u32 s30, 400000
  s_cbranch_scc1 cB_sc3_rv
  s_branch cB_abort
cB_sc3_rk:
  s_mov_b32 s62, 1
  v_mov_b32 v36, 0
  v_mov_b32 v37, 0
  v_mov_b32 v38, 0
  v_mov_b32 v39, 0
  v_mov_b32 v40, 0
  v_mov_b32 v41, 0
  v_mov_b32 v42, 0
  v_mov_b32 v43, 0
  v_mov_b32 v44, 0
  v_mov_b32 v45, 0
  v_mov_b32 v46, 0
  v_mov_b32 v47, 0
  v_mov_b32 v48, 0
  v_mov_b32 v49, 0
  v_mov_b32 v50, 0
  v_mov_b32 v51, 0
  v_mov_b32 v52, 0
  v_mov_b32 v53, 0
  v_mov_b32 v54, 0
  v_mov_b32 v55, 0
  v_mov_b32 v56, 0
  v_mov_b32 v57, 0
  v_mov_b32 v58, 0
  v_mov_b32 v59, 0
  v_mov_b32 v60, 0
  v_mov_b32 v61, 0
  v_mov_b32 v62, 0
  v_mov_b32 v63, 0
  v_mov_b32 v88, 0
  v_mov_b32 v89, 0
  v_mov_b32 v90, 0
  v_mov_b32 v91, 0
  v_mov_b32 v92, 0
  v_mov_b32 v93, 0
  v_mov_b32 v94, 0
  v_mov_b32 v95, 0
  v_mov_b32 v64, 0
  v_mov_b32 v65, 0
  s_add_u32 s31, s31, 1
  ds_read_b128 v[96:99], v117 offset:0
  ds_read_b128 v[100:103], v117 offset:1024
  ds_read_b128 v[104:107], v117 offset:14336
  ds_read_b128 v[108:111], v117 offset:15360
  v_smfmac_f32_16x16x64_bf16 v[36:39], v[8:11], a[0:7], v3
  v_smfmac_f32_16x16x64_bf16 v[40:43], v[8:11], a[56:63], v3
  v_smfmac_f32_16x16x64_bf16 v[44:47], v[8:11], a[112:119], v3
  v_smfmac_f32_16x16x64_bf16 v[48:51], v[8:11], a[168:175], v3
  v_smfmac_f32_16x16x64_bf16 v[52:55], v[8:11], a[224:231], v3
  v_smfmac_f32_16x16x64_bf16 v[56:59], v[8:11], v[144:151], v3
  v_smfmac_f32_16x16x64_bf16 v[60:63], v[8:11], v[200:207], v3
  v_smfmac_f32_16x16x64_bf16 v[36:39], v[12:15], a[8:15], v3
  v_smfmac_f32_16x16x64_bf16 v[40:43], v[12:15], a[64:71], v3
  v_smfmac_f32_16x16x64_bf16 v[44:47], v[12:15], a[120:127], v3
  v_smfmac_f32_16x16x64_bf16 v[48:51], v[12:15], a[176:183], v3
  v_smfmac_f32_16x16x64_bf16 v[52:55], v[12:15], a[232:239], v3
  v_smfmac_f32_16x16x64_bf16 v[56:59], v[12:15], v[152:159], v3
  v_smfmac_f32_16x16x64_bf16 v[60:63], v[12:15], v[208:215], v3
  v_smfmac_f32_16x16x64_bf16 v[36:39], v[16:19], a[16:23], v3
  v_smfmac_f32_16x16x64_bf16 v[40:43], v[16:19], a[72:79], v3
  v_smfmac_f32_16x16x64_bf16 v[44:47], v[16:19], a[128:135], v3
  v_smfmac_f32_16x16x64_bf16 v[48:51], v[16:19], a[184:191], v3
  v_smfmac_f32_16x16x64_bf16 v[52:55], v[16:19], a[240:247], v3
  v_smfmac_f32_16x16x64_bf16 v[56:59], v[16:19], v[160:167], v3
  v_smfmac_f32_16x16x64_bf16 v[60:63], v[16:19], v[216:223], v3
  v_smfmac_f32_16x16x64_bf16 v[36:39], v[20:23], a[24:31], v3
  v_smfmac_f32_16x16x64_bf16 v[40:43], v[20:23], a[80:87], v3
  v_smfmac_f32_16x16x64_bf16 v[44:47], v[20:23], a[136:143], v3
  v_smfmac_f32_16x16x64_bf16 v[48:51], v[20:23], a[192:199], v3
  v_smfmac_f32_16x16x64_bf16 v[52:55], v[20:23], a[248:255], v3
  v_smfmac_f32_16x16x64_bf16 v[56:59], v[20:23], v[168:175], v3
  v_smfmac_f32_16x16x64_bf16 v[60:63], v[20:23], v[224:231], v3
  s_branch cB_sc3_ph2
.p2align 6

cB_va0_loop:
  s_add_u32 s23, s20, 4096
  s_add_u32 s21, s20, 20480
  s_mov_b32 s30, 0
  s_cmp_lg_u32 s19, s38
  s_cbranch_scc1 cB_va0_vok
  s_branch cB_va0_voc
cB_va0_vow:
  s_sub_u32 s22, s39, s35
  v_lshlrev_b32 v63, 7, v2
  v_min_u32 v63, s22, v63
  buffer_load_dword v63, v63, s[8:11], s35 offen sc1
  s_waitcnt vmcnt(0)
cB_va0_voc:
  v_readfirstlane_b32 s22, v63
  s_cmp_eq_u32 s22, 56
  s_cbranch_scc1 cB_va0_vod
  s_sleep 1
  s_add_u32 s30, s30, 1
  s_cmp_lt_u32 s30, 400000
  s_cbranch_scc1 cB_va0_vow
  s_branch cB_abort
cB_va0_vod:
  s_add_u32 s35, s35, 2048
  s_add_u32 s38, s19, 8
  s_and_b32 s38, s38, -8
  s_cmp_eq_u32 s19, 0
  s_cselect_b32 s38, 4, s38
  v_cmp_ne_u32 vcc, 56, v63
  s_nop 3
  s_cmp_eq_u64 vcc, 0
  s_cselect_b32 s38, 99, s38
cB_va0_vok:
  s_cmp_eq_u32 s19, 63
  s_cbranch_scc1 cB_done
  s_barrier
  s_add_u32 s22, s25, 0
  buffer_load_dwordx4 v[80:83], v6, s[8:11], s22 offen offset:0 sc1
  buffer_load_dwordx4 v[84:87], v6, s[8:11], s22 offen offset:1792 sc1
  s_add_u32 s22, s25, 3584
  buffer_load_dwordx4 v[88:91], v6, s[8:11], s22 offen offset:0 sc1
  buffer_load_dwordx4 v[92:95], v6, s[8:11], s22 offen offset:1792 sc1
  s_add_u32 s22, s25, 7168
  buffer_load_dwordx4 v[96:99], v6, s[8:11], s22 offen offset:0 sc1
  buffer_load_dwordx4 v[100:103], v6, s[8:11], s22 offen offset:1792 sc1
  s_add_u32 s22, s25, 10752
  buffer_load_dwordx4 v[104:107], v6, s[8:11], s22 offen offset:0 sc1
  buffer_load_dwordx4 v[108:111], v6, s[8:11], s22 offen offset:1792 sc1
  s_add_u32 s22, s25, 14336
  buffer_load_dwordx4 v[112:115], v6, s[8:11], s22 offen offset:0 sc1
  buffer_load_dwordx4 v[116:119], v6, s[8:11], s22 offen offset:1792 sc1
  s_add_u32 s22, s19, 1
  s_cmp_lg_u32 s22, s38
  s_cbranch_scc1 cB_va0_nk
  s_sub_u32 s22, s39, s35
  v_lshlrev_b32 v63, 7, v2
  v_min_u32 v63, s22, v63
  buffer_load_dword v63, v63, s[8:11], s35 offen sc1
cB_va0_nk:
  s_barrier
  ds_read_b128 v[8:11], v2 offset:8192
  ds_read_b128 v[12:15], v2 offset:9216
  ds_read_b128 v[16:19], v2 offset:10240
  ds_read_b128 v[20:23], v2 offset:11264
  ds_read_b128 v[24:27], v2 offset:12288
  ds_read_b128 v[28:31], v2 offset:13312
  ds_read_b128 v[32:35], v2 offset:14336
  s_waitcnt lgkmcnt(0)
  v_smfmac_f32_16x16x64_bf16 v[36:39], v[8:11], a[0:7], v3
  s_add_u32 s22, s25, 17920
  buffer_load_dwordx4 v[120:123], v6, s[8:11], s22 offen sc1
  v_smfmac_f32_16x16x64_bf16 v[36:39], v[12:15], a[8:15], v3
  v_smfmac_f32_16x16x64_bf16 v[36:39], v[16:19], a[16:23], v3
  s_add_u32 s22, s25, 19712
  buffer_load_dwordx4 v[124:127], v6, s[8:11], s22 offen sc1
  v_smfmac_f32_16x16x64_bf16 v[36:39], v[20:23], a[24:31], v3
  v_smfmac_f32_16x16x64_bf16 v[36:39], v[24:27], a[32:39], v3
  s_add_u32 s22, s25, 21504
  buffer_load_dwordx4 v[128:131], v6, s[8:11], s22 offen sc1
  v_smfmac_f32_16x16x64_bf16 v[36:39], v[28:31], a[40:47], v3
  v_smfmac_f32_16x16x64_bf16 v[36:39], v[32:35], a[48:55], v3
  s_add_u32 s22, s25, 23296
  buffer_load_dwordx4 v[132:135], v6, s[8:11], s22 offen sc1
  v_smfmac_f32_16x16x64_bf16 v[40:43], v[8:11], a[56:63], v3
  v_smfmac_f32_16x16x64_bf16 v[40:43], v[12:15], a[64:71], v3
  s_add_u32 s22, s25, 25088
  buffer_load_dwordx4 v[136:139], v6, s[8:11], s22 offen sc1
  v_smfmac_f32_16x16x64_bf16 v[40:43], v[16:19], a[72:79], v3
  v_smfmac_f32_16x16x64_bf16 v[40:43], v[20:23], a[80:87], v3
  s_add_u32 s22, s25, 26880
  buffer_load_dwordx4 v[140:143], v6, s[8:11], s22 offen sc1
  v_smfmac_f32_16x16x64_bf16 v[40:43], v[24:27], a[88:95], v3
  v_smfmac_f32_16x16x64_bf16 v[40:43], v[28:31], a[96:103], v3
  v_smfmac_f32_16x16x64_bf16 v[40:43], v[32:35], a[104:111], v3
  v_smfmac_f32_16x16x64_bf16 v[44:47], v[8:11], a[112:119], v3
  v_smfmac_f32_16x16x64_bf16 v[44:47], v[12:15], a[120:127], v3
  v_smfmac_f32_16x16x64_bf16 v[44:47], v[16:19], a[128:135], v3
  v_smfmac_f32_16x16x64_bf16 v[44:47], v[20:23], a[136:143], v3
  v_permlane32_swap_b32 v36, v40
  v_smfmac_f32_16x16x64_bf16 v[44:47], v[24:27], a[144:151], v3
  v_permlane32_swap_b32 v37, v41
  v_smfmac_f32_16x16x64_bf16 v[44:47], v[28:31], a[152:159], v3
  v_permlane32_swap_b32 v38, v42
  v_smfmac_f32_16x16x64_bf16 v[44:47], v[32:35], a[160:167], v3
  v_permlane32_swap_b32 v39, v43
  v_smfmac_f32_16x16x64_bf16 v[48:51], v[8:11], a[168:175], v3
  v_add_f32 v36, v36, v40
  v_smfmac_f32_16x16x64_bf16 v[48:51], v[12:15], a[176:183], v3
  v_add_f32 v37, v37, v41
  v_smfmac_f32_16x16x64_bf16 v[48:51], v[16:19], a[184:191], v3
  v_add_f32 v38, v38, v42
  v_smfmac_f32_16x16x64_bf16 v[48:51], v[20:23], a[192:199], v3
  v_add_f32 v39, v39, v43
  v_smfmac_f32_16x16x64_bf16 v[48:51], v[24:27], a[200:207], v3
  v_cvt_pk_bf16_f32 v40, v36, v37
  v_smfmac_f32_16x16x64_bf16 v[48:51], v[28:31], a[208:215], v3
  v_cvt_pk_bf16_f32 v41, v38, v39
  v_smfmac_f32_16x16x64_bf16 v[48:51], v[32:35], a[216:223], v3
  ds_write2_b32 v60, v40, v41 offset0:0 offset1:2
  v_smfmac_f32_16x16x64_bf16 v[52:55], v[8:11], a[224:231], v3
  v_smfmac_f32_16x16x64_bf16 v[52:55], v[12:15], a[232:239], v3
  v_smfmac_f32_16x16x64_bf16 v[52:55], v[16:19], a[240:247], v3
  v_smfmac_f32_16x16x64_bf16 v[52:55], v[20:23], a[248:255], v3
  v_permlane32_swap_b32 v44, v48
  v_smfmac_f32_16x16x64_bf16 v[52:55], v[24:27], v[176:183], v3
  v_permlane32_swap_b32 v45, v49
  v_smfmac_f32_16x16x64_bf16 v[52:55], v[28:31], v[184:191], v3
  v_permlane32_swap_b32 v46, v50
  v_smfmac_f32_16x16x64_bf16 v[52:55], v[32:35], v[192:199], v3
  v_permlane32_swap_b32 v47, v51
  v_smfmac_f32_16x16x64_bf16 v[56:59], v[8:11], v[200:207], v3
  v_add_f32 v44, v44, v48
  v_smfmac_f32_16x16x64_bf16 v[56:59], v[12:15], v[208:215], v3
  v_add_f32 v45, v45, v49
  v_smfmac_f32_16x16x64_bf16 v[56:59], v[16:19], v[216:223], v3
  v_add_f32 v46, v46, v50
  v_smfmac_f32_16x16x64_bf16 v[56:59], v[20:23], v[224:231], v3
  v_add_f32 v47, v47, v51
  v_smfmac_f32_16x16x64_bf16 v[56:59], v[24:27], v[232:239], v3
  v_cvt_pk_bf16_f32 v48, v44, v45
  v_smfmac_f32_16x16x64_bf16 v[56:59], v[28:31], v[240:247], v3
  v_cvt_pk_bf16_f32 v49, v46, v47
  v_smfmac_f32_16x16x64_bf16 v[56:59], v[32:35], v[248:255], v3
  ds_write2_b32 v61, v48, v49 offset0:0 offset1:2
  s_nop 6
  v_permlane32_swap_b32 v52, v56
  v_permlane32_swap_b32 v53, v57
  v_permlane32_swap_b32 v54, v58
  v_permlane32_swap_b32 v55, v59
  v_add_f32 v52, v52, v56
  v_add_f32 v53, v53, v57
  v_add_f32 v54, v54, v58
  v_add_f32 v55, v55, v59
  v_cvt_pk_bf16_f32 v56, v52, v53
  v_cvt_pk_bf16_f32 v57, v54, v55
  ds_write2_b32 v62, v56, v57 offset0:0 offset1:2
  buffer_load_dword v164, v4, s[8:11], s20 offen sc1
  s_waitcnt lgkmcnt(0)
  v_mov_b32 v36, 0
  v_mov_b32 v37, 0
  v_mov_b32 v38, 0
  v_mov_b32 v39, 0
  v_mov_b32 v40, 0
  v_mov_b32 v41, 0
  v_mov_b32 v42, 0
  v_mov_b32 v43, 0
  buffer_load_dword v165, v4, s[8:11], s20 offen sc1
  v_mov_b32 v44, 0
  v_mov_b32 v45, 0
  v_mov_b32 v46, 0
  v_mov_b32 v47, 0
  v_mov_b32 v48, 0
  v_mov_b32 v49, 0
  v_mov_b32 v50, 0
  v_mov_b32 v51, 0
  buffer_load_dword v166, v4, s[8:11], s20 offen sc1
  v_mov_b32 v52, 0
  v_mov_b32 v53, 0
  v_mov_b32 v54, 0
  v_mov_b32 v55, 0
  v_mov_b32 v56, 0
  v_mov_b32 v57, 0
  v_mov_b32 v58, 0
  v_mov_b32 v59, 0
  buffer_load_dword v167, v4, s[8:11], s20 offen sc1
  s_cmp_eq_u32 s19, 63
  s_cbranch_scc1 cB_va0_last
  s_add_u32 s22, s20, 9216
  s_add_u32 s34, s20, 13312
  s_add_u32 s36, s20, 7168
  s_mov_b32 s37, 0
  v_mov_b32 v156, 0
  v_mov_b32 v157, 0
  v_mov_b32 v158, 0
  v_mov_b32 v159, 0
  buffer_load_dword v168, v4, s[8:11], s20 offen sc1
cB_va0_fw_l:
  s_waitcnt vmcnt(4)
  v_cmp_eq_u32 vcc, -1, v164
  s_cbranch_vccz cB_va0_fw_d
  buffer_load_dword v164, v4, s[8:11], s20 offen sc1
  s_waitcnt vmcnt(4)
  v_cmp_eq_u32 vcc, -1, v165
  s_cbranch_vccz cB_va0_fw_d
  buffer_load_dword v165, v4, s[8:11], s20 offen sc1
  s_waitcnt vmcnt(4)
  v_cmp_eq_u32 vcc, -1, v166
  s_cbranch_vccz cB_va0_fw_d
  buffer_load_dword v166, v4, s[8:11], s20 offen sc1
  s_waitcnt vmcnt(4)
  v_cmp_eq_u32 vcc, -1, v167
  s_cbranch_vccz cB_va0_fw_d
  buffer_load_dword v167, v4, s[8:11], s20 offen sc1
  s_waitcnt vmcnt(4)
  v_cmp_eq_u32 vcc, -1, v168
  s_cbranch_vccz cB_va0_fw_d
  buffer_load_dword v168, v4, s[8:11], s20 offen sc1
  s_add_u32 s30, s30, 1
  s_cmp_lt_u32 s30, 400000
  s_cbranch_scc1 cB_va0_fw_l
  s_branch cB_abort
cB_va0_fw_d:
  s_waitcnt lgkmcnt(0)
  buffer_load_dwordx4 v[8:11], v5, s[8:11], s22 offen offset:0 sc1
  buffer_load_dwordx4 v[12:15], v5, s[8:11], s22 offen offset:1024 sc1
  buffer_load_dwordx4 v[16:19], v5, s[8:11], s22 offen offset:2048 sc1
  buffer_load_dwordx4 v[20:23], v5, s[8:11], s22 offen offset:3072 sc1
  buffer_load_dwordx4 v[24:27], v5, s[8:11], s34 offen offset:0 sc1
  buffer_load_dwordx4 v[28:31], v5, s[8:11], s34 offen offset:1024 sc1
  buffer_load_dwordx4 v[32:35], v5, s[8:11], s34 offen offset:2048 sc1
  buffer_load_dwordx4 v[144:147], v5, s[8:11], s34 offen offset:3072 sc1
  buffer_load_dwordx4 v[148:151], v2, s[8:11], s36 offen offset:0 sc1
  buffer_load_dwordx4 v[152:155], v2, s[8:11], s36 offen offset:1024 sc1
  s_barrier
  ds_read_b128 v[64:67], v2 offset:0
  ds_read_b128 v[68:71], v2 offset:1024
  ds_read_b128 v[72:75], v2 offset:2048
  ds_read_b128 v[76:79], v2 offset:3072
  s_waitcnt vmcnt(9)
  v_smfmac_f32_16x16x64_bf16 v[156:159], v[8:11], v[80:87], v0
  s_waitcnt vmcnt(8)
  v_smfmac_f32_16x16x64_bf16 v[156:159], v[12:15], v[88:95], v0
  s_mov_b64 exec, 65535
  buffer_store_dword v2, v7, s[8:11], s21 offen sc1
  s_mov_b64 exec, -1
  s_waitcnt vmcnt(8)
  v_smfmac_f32_16x16x64_bf16 v[156:159], v[16:19], v[96:103], v0
  s_waitcnt vmcnt(7)
  v_smfmac_f32_16x16x64_bf16 v[156:159], v[20:23], v[104:111], v0
  s_waitcnt vmcnt(6)
  v_smfmac_f32_16x16x64_bf16 v[156:159], v[24:27], v[112:119], v0
  s_waitcnt vmcnt(5)
  v_smfmac_f32_16x16x64_bf16 v[156:159], v[28:31], v[120:127], v0
  s_waitcnt vmcnt(4)
  v_smfmac_f32_16x16x64_bf16 v[156:159], v[32:35], v[128:135], v0
  s_waitcnt vmcnt(3)
  v_smfmac_f32_16x16x64_bf16 v[156:159], v[144:147], v[136:143], v0
  s_waitcnt vmcnt(2) lgkmcnt(0)
  v_smfmac_f32_16x16x64_bf16 v[156:159], v[148:151], v[64:71], v0
  s_waitcnt vmcnt(1)
  v_smfmac_f32_16x16x64_bf16 v[156:159], v[152:155], v[72:79], v0
cB_va0_ep:
  s_nop 7
  v_add_f32 v160, v156, v157
  v_add_f32 v161, v158, v159
  v_cmp_u_f32 vcc, v160, v161
  v_mov_b32_dpp v162, v160 row_ror:8 row_mask:0xf bank_mask:0xf
  v_mov_b32_dpp v160, v161 row_ror:8 row_mask:0xf bank_mask:0xc
  s_cbranch_vccnz cB_va0_rp
  v_mov_b32_dpp v161, v162 quad_perm:[0,1,2,3] row_mask:0xf bank_mask:0x3
  v_cvt_pk_bf16_f32 v160, v160, v161
cB_va0_pc:
  buffer_store_dword v160, v1, s[8:11], s21 offen sc1
  s_cmp_lg_u32 s19, 62
  s_cbranch_scc1 cB_va0_nl
  s_mov_b32 s22, 88531968
  buffer_store_dword v160, v1, s[8:11], s22 offen sc1
  s_mov_b64 exec, -1
  s_branch cB_done
cB_va0_nl:
  s_mov_b64 exec, -1
  s_add_u32 s25, s25, 28672
  s_add_u32 s19, s19, 1
  s_mov_b32 s20, s21
  s_branch cB_va0_loop
cB_va0_last:
  s_waitcnt lgkmcnt(0)
  s_barrier
  s_branch cB_done
cB_va0_rp:
  s_cmp_eq_u32 s37, 0
  s_cbranch_scc1 cB_va0_rv
  v_mov_b32_dpp v161, v162 quad_perm:[0,1,2,3] row_mask:0xf bank_mask:0x3
  v_cvt_pk_bf16_f32 v160, v160, v161
  v_min_u32 v160, -2, v160
  s_branch cB_va0_pc
cB_va0_rv:
  buffer_load_dwordx4 v[8:11], v5, s[8:11], s22 offen offset:0 sc1
  buffer_load_dwordx4 v[12:15], v5, s[8:11], s22 offen offset:1024 sc1
  buffer_load_dwordx4 v[16:19], v5, s[8:11], s22 offen offset:2048 sc1
  buffer_load_dwordx4 v[20:23], v5, s[8:11], s22 offen offset:3072 sc1
  buffer_load_dwordx4 v[24:27], v5, s[8:11], s34 offen offset:0 sc1
  buffer_load_dwordx4 v[28:31], v5, s[8:11], s34 offen offset:1024 sc1
  buffer_load_dwordx4 v[32:35], v5, s[8:11], s34 offen offset:2048 sc1
  buffer_load_dwordx4 v[144:147], v5, s[8:11], s34 offen offset:3072 sc1
  buffer_load_dwordx4 v[148:151], v2, s[8:11], s36 offen offset:0 sc1
  buffer_load_dwordx4 v[152:155], v2, s[8:11], s36 offen offset:1024 sc1
  s_waitcnt vmcnt(0)
  v_max3_u32 v175, v8, v9, v10
  v_max3_u32 v175, v175, v11, v12
  v_max3_u32 v175, v175, v13, v14
  v_max3_u32 v175, v175, v15, v16
  v_max3_u32 v175, v175, v17, v18
  v_max3_u32 v175, v175, v19, v20
  v_max3_u32 v175, v175, v21, v22
  v_max3_u32 v175, v175, v23, v24
  v_max3_u32 v175, v175, v25, v26
  v_max3_u32 v175, v175, v27, v28
  v_max3_u32 v175, v175, v29, v30
  v_max3_u32 v175, v175, v31, v32
  v_max3_u32 v175, v175, v33, v34
  v_max3_u32 v175, v175, v35, v144
  v_max3_u32 v175, v175, v145, v146
  v_max3_u32 v175, v175, v147, v148
  v_max3_u32 v175, v175, v149, v150
  v_max3_u32 v175, v175, v151, v152
  v_max3_u32 v175, v175, v153, v154
  v_max_u32 v175, v175, v155
  v_cmp_eq_u32 vcc, -1, v175
  s_cbranch_vccz cB_va0_rk
  s_add_u32 s30, s30, 1
  s_cmp_lt_u32 s30, 400000
  s_cbranch_scc1 cB_va0_rv
  s_branch cB_abort
cB_va0_rk:
  s_mov_b32 s37, 1
  s_add_u32 s31, s31, 0x10000
  v_mov_b32 v156, 0
  v_mov_b32 v157, 0
  v_mov_b32 v158, 0
  v_mov_b32 v159, 0
  s_nop 1
  v_smfmac_f32_16x16x64_bf16 v[156:159], v[8:11], v[80:87], v0
  v_smfmac_f32_16x16x64_bf16 v[156:159], v[12:15], v[88:95], v0
  v_smfmac_f32_16x16x64_bf16 v[156:159], v[16:19], v[96:103], v0
  v_smfmac_f32_16x16x64_bf16 v[156:159], v[20:23], v[104:111], v0
  v_smfmac_f32_16x16x64_bf16 v[156:159], v[24:27], v[112:119], v0
  v_smfmac_f32_16x16x64_bf16 v[156:159], v[28:31], v[120:127], v0
  v_smfmac_f32_16x16x64_bf16 v[156:159], v[32:35], v[128:135], v0
  v_smfmac_f32_16x16x64_bf16 v[156:159], v[144:147], v[136:143], v0
  v_smfmac_f32_16x16x64_bf16 v[156:159], v[148:151], v[64:71], v0
  v_smfmac_f32_16x16x64_bf16 v[156:159], v[152:155], v[72:79], v0
  s_nop 7
  s_branch cB_va0_ep
.p2align 6

cB_va1_loop:
  s_add_u32 s23, s20, 4096
  s_add_u32 s21, s20, 20480
  s_mov_b32 s30, 0
  s_cmp_lg_u32 s19, s38
  s_cbranch_scc1 cB_va1_vok
  s_branch cB_va1_voc
cB_va1_vow:
  s_sub_u32 s22, s39, s35
  v_lshlrev_b32 v63, 7, v2
  v_min_u32 v63, s22, v63
  buffer_load_dword v63, v63, s[8:11], s35 offen sc1
  s_waitcnt vmcnt(0)
cB_va1_voc:
  v_readfirstlane_b32 s22, v63
  s_cmp_eq_u32 s22, 56
  s_cbranch_scc1 cB_va1_vod
  s_sleep 1
  s_add_u32 s30, s30, 1
  s_cmp_lt_u32 s30, 400000
  s_cbranch_scc1 cB_va1_vow
  s_branch cB_abort
cB_va1_vod:
  s_add_u32 s35, s35, 2048
  s_add_u32 s38, s19, 8
  s_and_b32 s38, s38, -8
  s_cmp_eq_u32 s19, 0
  s_cselect_b32 s38, 4, s38
  v_cmp_ne_u32 vcc, 56, v63
  s_nop 3
  s_cmp_eq_u64 vcc, 0
  s_cselect_b32 s38, 99, s38
cB_va1_vok:
  s_cmp_eq_u32 s19, 63
  s_cbranch_scc1 cB_done
  s_barrier
  s_add_u32 s22, s25, 0
  buffer_load_dwordx4 v[80:83], v6, s[8:11], s22 offen offset:0 sc1
  buffer_load_dwordx4 v[84:87], v6, s[8:11], s22 offen offset:1792 sc1
  s_add_u32 s22, s25, 3584
  buffer_load_dwordx4 v[88:91], v6, s[8:11], s22 offen offset:0 sc1
  buffer_load_dwordx4 v[92:95], v6, s[8:11], s22 offen offset:1792 sc1
  s_add_u32 s22, s25, 7168
  buffer_load_dwordx4 v[96:99], v6, s[8:11], s22 offen offset:0 sc1
  buffer_load_dwordx4 v[100:103], v6, s[8:11], s22 offen offset:1792 sc1
  s_add_u32 s22, s25, 10752
  buffer_load_dwordx4 v[104:107], v6, s[8:11], s22 offen offset:0 sc1
  buffer_load_dwordx4 v[108:111], v6, s[8:11], s22 offen offset:1792 sc1
  s_add_u32 s22, s25, 14336
  buffer_load_dwordx4 v[112:115], v6, s[8:11], s22 offen offset:0 sc1
  buffer_load_dwordx4 v[116:119], v6, s[8:11], s22 offen offset:1792 sc1
  s_add_u32 s22, s19, 1
  s_cmp_lg_u32 s22, s38
  s_cbranch_scc1 cB_va1_nk
  s_sub_u32 s22, s39, s35
  v_lshlrev_b32 v63, 7, v2
  v_min_u32 v63, s22, v63
  buffer_load_dword v63, v63, s[8:11], s35 offen sc1
cB_va1_nk:
  s_barrier
  ds_read_b128 v[8:11], v2 offset:8192
  ds_read_b128 v[12:15], v2 offset:9216
  ds_read_b128 v[16:19], v2 offset:10240
  ds_read_b128 v[20:23], v2 offset:11264
  ds_read_b128 v[24:27], v2 offset:12288
  ds_read_b128 v[28:31], v2 offset:13312
  ds_read_b128 v[32:35], v2 offset:14336
  s_waitcnt lgkmcnt(0)
  v_smfmac_f32_16x16x64_bf16 v[36:39], v[8:11], a[0:7], v3
  s_add_u32 s22, s25, 17920
  buffer_load_dwordx4 v[120:123], v6, s[8:11], s22 offen sc1
  v_smfmac_f32_16x16x64_bf16 v[36:39], v[12:15], a[8:15], v3
  v_smfmac_f32_16x16x64_bf16 v[36:39], v[16:19], a[16:23], v3
  s_add_u32 s22, s25, 19712
  buffer_load_dwordx4 v[124:127], v6, s[8:11], s22 offen sc1
  v_smfmac_f32_16x16x64_bf16 v[36:39], v[20:23], a[24:31], v3
  v_smfmac_f32_16x16x64_bf16 v[36:39], v[24:27], a[32:39], v3
  s_add_u32 s22, s25, 21504
  buffer_load_dwordx4 v[128:131], v6, s[8:11], s22 offen sc1
  v_smfmac_f32_16x16x64_bf16 v[36:39], v[28:31], a[40:47], v3
  v_smfmac_f32_16x16x64_bf16 v[36:39], v[32:35], a[48:55], v3
  s_add_u32 s22, s25, 23296
  buffer_load_dwordx4 v[132:135], v6, s[8:11], s22 offen sc1
  v_smfmac_f32_16x16x64_bf16 v[40:43], v[8:11], a[56:63], v3
  v_smfmac_f32_16x16x64_bf16 v[40:43], v[12:15], a[64:71], v3
  s_add_u32 s22, s25, 25088
  buffer_load_dwordx4 v[136:139], v6, s[8:11], s22 offen sc1
  v_smfmac_f32_16x16x64_bf16 v[40:43], v[16:19], a[72:79], v3
  v_smfmac_f32_16x16x64_bf16 v[40:43], v[20:23], a[80:87], v3
  s_add_u32 s22, s25, 26880
  buffer_load_dwordx4 v[140:143], v6, s[8:11], s22 offen sc1
  v_smfmac_f32_16x16x64_bf16 v[40:43], v[24:27], a[88:95], v3
  v_smfmac_f32_16x16x64_bf16 v[40:43], v[28:31], a[96:103], v3
  v_smfmac_f32_16x16x64_bf16 v[40:43], v[32:35], a[104:111], v3
  v_smfmac_f32_16x16x64_bf16 v[44:47], v[8:11], a[112:119], v3
  v_smfmac_f32_16x16x64_bf16 v[44:47], v[12:15], a[120:127], v3
  v_smfmac_f32_16x16x64_bf16 v[44:47], v[16:19], a[128:135], v3
  v_smfmac_f32_16x16x64_bf16 v[44:47], v[20:23], a[136:143], v3
  v_permlane32_swap_b32 v36, v40
  v_smfmac_f32_16x16x64_bf16 v[44:47], v[24:27], a[144:151], v3
  v_permlane32_swap_b32 v37, v41
  v_smfmac_f32_16x16x64_bf16 v[44:47], v[28:31], a[152:159], v3
  v_permlane32_swap_b32 v38, v42
  v_smfmac_f32_16x16x64_bf16 v[44:47], v[32:35], a[160:167], v3
  v_permlane32_swap_b32 v39, v43
  v_smfmac_f32_16x16x64_bf16 v[48:51], v[8:11], a[168:175], v3
  v_add_f32 v36, v36, v40
  v_smfmac_f32_16x16x64_bf16 v[48:51], v[12:15], a[176:183], v3
  v_add_f32 v37, v37, v41
  v_smfmac_f32_16x16x64_bf16 v[48:51], v[16:19], a[184:191], v3
  v_add_f32 v38, v38, v42
  v_smfmac_f32_16x16x64_bf16 v[48:51], v[20:23], a[192:199], v3
  v_add_f32 v39, v39, v43
  v_smfmac_f32_16x16x64_bf16 v[48:51], v[24:27], a[200:207], v3
  v_cvt_pk_bf16_f32 v40, v36, v37
  v_smfmac_f32_16x16x64_bf16 v[48:51], v[28:31], a[208:215], v3
  v_cvt_pk_bf16_f32 v41, v38, v39
  v_smfmac_f32_16x16x64_bf16 v[48:51], v[32:35], a[216:223], v3
  ds_write2_b32 v60, v40, v41 offset0:0 offset1:2
  v_smfmac_f32_16x16x64_bf16 v[52:55], v[8:11], a[224:231], v3
  v_smfmac_f32_16x16x64_bf16 v[52:55], v[12:15], a[232:239], v3
  v_smfmac_f32_16x16x64_bf16 v[52:55], v[16:19], a[240:247], v3
  v_smfmac_f32_16x16x64_bf16 v[52:55], v[20:23], a[248:255], v3
  v_permlane32_swap_b32 v44, v48
  v_smfmac_f32_16x16x64_bf16 v[52:55], v[24:27], v[176:183], v3
  v_permlane32_swap_b32 v45, v49
  v_smfmac_f32_16x16x64_bf16 v[52:55], v[28:31], v[184:191], v3
  v_permlane32_swap_b32 v46, v50
  v_smfmac_f32_16x16x64_bf16 v[52:55], v[32:35], v[192:199], v3
  v_permlane32_swap_b32 v47, v51
  v_smfmac_f32_16x16x64_bf16 v[56:59], v[8:11], v[200:207], v3
  v_add_f32 v44, v44, v48
  v_smfmac_f32_16x16x64_bf16 v[56:59], v[12:15], v[208:215], v3
  v_add_f32 v45, v45, v49
  v_smfmac_f32_16x16x64_bf16 v[56:59], v[16:19], v[216:223], v3
  v_add_f32 v46, v46, v50
  v_smfmac_f32_16x16x64_bf16 v[56:59], v[20:23], v[224:231], v3
  v_add_f32 v47, v47, v51
  v_smfmac_f32_16x16x64_bf16 v[56:59], v[24:27], v[232:239], v3
  v_cvt_pk_bf16_f32 v48, v44, v45
  v_smfmac_f32_16x16x64_bf16 v[56:59], v[28:31], v[240:247], v3
  v_cvt_pk_bf16_f32 v49, v46, v47
  v_smfmac_f32_16x16x64_bf16 v[56:59], v[32:35], v[248:255], v3
  ds_write2_b32 v61, v48, v49 offset0:0 offset1:2
  s_nop 6
  v_permlane32_swap_b32 v52, v56
  v_permlane32_swap_b32 v53, v57
  v_permlane32_swap_b32 v54, v58
  v_permlane32_swap_b32 v55, v59
  v_add_f32 v52, v52, v56
  v_add_f32 v53, v53, v57
  v_add_f32 v54, v54, v58
  v_add_f32 v55, v55, v59
  v_cvt_pk_bf16_f32 v56, v52, v53
  v_cvt_pk_bf16_f32 v57, v54, v55
  ds_write2_b32 v62, v56, v57 offset0:0 offset1:2
  s_waitcnt lgkmcnt(0)
  v_mov_b32 v36, 0
  v_mov_b32 v37, 0
  v_mov_b32 v38, 0
  v_mov_b32 v39, 0
  v_mov_b32 v40, 0
  v_mov_b32 v41, 0
  v_mov_b32 v42, 0
  v_mov_b32 v43, 0
  v_mov_b32 v44, 0
  v_mov_b32 v45, 0
  v_mov_b32 v46, 0
  v_mov_b32 v47, 0
  v_mov_b32 v48, 0
  v_mov_b32 v49, 0
  v_mov_b32 v50, 0
  v_mov_b32 v51, 0
  v_mov_b32 v52, 0
  v_mov_b32 v53, 0
  v_mov_b32 v54, 0
  v_mov_b32 v55, 0
  v_mov_b32 v56, 0
  v_mov_b32 v57, 0
  v_mov_b32 v58, 0
  v_mov_b32 v59, 0
  s_cmp_eq_u32 s19, 63
  s_cbranch_scc1 cB_va1_last
  s_add_u32 s22, s20, 9216
  s_add_u32 s34, s20, 13312
  s_add_u32 s36, s20, 7168
  s_mov_b32 s37, 0
  v_mov_b32 v156, 0
  v_mov_b32 v157, 0
  v_mov_b32 v158, 0
  v_mov_b32 v159, 0
  s_barrier
  s_waitcnt lgkmcnt(0)
  buffer_load_dwordx4 v[8:11], v5, s[8:11], s22 offen offset:0 sc1
  buffer_load_dwordx4 v[12:15], v5, s[8:11], s22 offen offset:1024 sc1
  buffer_load_dwordx4 v[16:19], v5, s[8:11], s22 offen offset:2048 sc1
  buffer_load_dwordx4 v[20:23], v5, s[8:11], s22 offen offset:3072 sc1
  buffer_load_dwordx4 v[24:27], v5, s[8:11], s34 offen offset:0 sc1
  buffer_load_dwordx4 v[28:31], v5, s[8:11], s34 offen offset:1024 sc1
  buffer_load_dwordx4 v[32:35], v5, s[8:11], s34 offen offset:2048 sc1
  buffer_load_dwordx4 v[144:147], v5, s[8:11], s34 offen offset:3072 sc1
  buffer_load_dwordx4 v[148:151], v2, s[8:11], s36 offen offset:0 sc1
  buffer_load_dwordx4 v[152:155], v2, s[8:11], s36 offen offset:1024 sc1
  ds_read_b128 v[64:67], v2 offset:4096
  ds_read_b128 v[68:71], v2 offset:5120
  ds_read_b128 v[72:75], v2 offset:6144
  ds_read_b128 v[76:79], v2 offset:7168
  s_waitcnt vmcnt(9)
  v_smfmac_f32_16x16x64_bf16 v[156:159], v[8:11], v[80:87], v0
  s_waitcnt vmcnt(8)
  v_smfmac_f32_16x16x64_bf16 v[156:159], v[12:15], v[88:95], v0
  s_waitcnt vmcnt(7)
  v_smfmac_f32_16x16x64_bf16 v[156:159], v[16:19], v[96:103], v0
  s_waitcnt vmcnt(6)
  v_smfmac_f32_16x16x64_bf16 v[156:159], v[20:23], v[104:111], v0
  s_waitcnt vmcnt(5)
  v_smfmac_f32_16x16x64_bf16 v[156:159], v[24:27], v[112:119], v0
  s_mov_b64 exec, 65535
  buffer_store_dword v2, v7, s[8:11], s21 offen sc1
  s_mov_b64 exec, -1
  s_waitcnt vmcnt(5)
  v_smfmac_f32_16x16x64_bf16 v[156:159], v[28:31], v[120:127], v0
  s_waitcnt vmcnt(4)
  v_smfmac_f32_16x16x64_bf16 v[156:159], v[32:35], v[128:135], v0
  s_waitcnt vmcnt(3)
  v_smfmac_f32_16x16x64_bf16 v[156:159], v[144:147], v[136:143], v0
  s_waitcnt vmcnt(2) lgkmcnt(0)
  v_smfmac_f32_16x16x64_bf16 v[156:159], v[148:151], v[64:71], v0
  s_waitcnt vmcnt(1)
  v_smfmac_f32_16x16x64_bf16 v[156:159], v[152:155], v[72:79], v0
cB_va1_ep:
  s_nop 7
  v_add_f32 v160, v156, v157
  v_add_f32 v161, v158, v159
  v_cmp_u_f32 vcc, v160, v161
  v_mov_b32_dpp v162, v160 row_ror:8 row_mask:0xf bank_mask:0xf
  v_mov_b32_dpp v160, v161 row_ror:8 row_mask:0xf bank_mask:0xc
  s_cbranch_vccnz cB_va1_rp
  v_mov_b32_dpp v161, v162 quad_perm:[0,1,2,3] row_mask:0xf bank_mask:0x3
  v_cvt_pk_bf16_f32 v160, v160, v161
cB_va1_pc:
  s_mov_b64 exec, s[26:27]
  buffer_store_dword v160, v1, s[8:11], s21 offen sc1
  s_cmp_lg_u32 s19, 62
  s_cbranch_scc1 cB_va1_nl
  s_mov_b32 s22, 88531968
  buffer_store_dword v160, v1, s[8:11], s22 offen sc1
  s_mov_b64 exec, -1
  s_branch cB_done
cB_va1_nl:
  s_mov_b64 exec, -1
  s_add_u32 s25, s25, 28672
  s_add_u32 s19, s19, 1
  s_mov_b32 s20, s21
  s_branch cB_va1_loop
cB_va1_last:
  s_waitcnt lgkmcnt(0)
  s_barrier
  s_branch cB_done
cB_va1_rp:
  s_cmp_eq_u32 s37, 0
  s_cbranch_scc1 cB_va1_rv
  v_mov_b32_dpp v161, v162 quad_perm:[0,1,2,3] row_mask:0xf bank_mask:0x3
  v_cvt_pk_bf16_f32 v160, v160, v161
  v_min_u32 v160, -2, v160
  s_branch cB_va1_pc
cB_va1_rv:
  buffer_load_dwordx4 v[8:11], v5, s[8:11], s22 offen offset:0 sc1
  buffer_load_dwordx4 v[12:15], v5, s[8:11], s22 offen offset:1024 sc1
  buffer_load_dwordx4 v[16:19], v5, s[8:11], s22 offen offset:2048 sc1
  buffer_load_dwordx4 v[20:23], v5, s[8:11], s22 offen offset:3072 sc1
  buffer_load_dwordx4 v[24:27], v5, s[8:11], s34 offen offset:0 sc1
  buffer_load_dwordx4 v[28:31], v5, s[8:11], s34 offen offset:1024 sc1
  buffer_load_dwordx4 v[32:35], v5, s[8:11], s34 offen offset:2048 sc1
  buffer_load_dwordx4 v[144:147], v5, s[8:11], s34 offen offset:3072 sc1
  buffer_load_dwordx4 v[148:151], v2, s[8:11], s36 offen offset:0 sc1
  buffer_load_dwordx4 v[152:155], v2, s[8:11], s36 offen offset:1024 sc1
  s_waitcnt vmcnt(0)
  v_max3_u32 v175, v8, v9, v10
  v_max3_u32 v175, v175, v11, v12
  v_max3_u32 v175, v175, v13, v14
  v_max3_u32 v175, v175, v15, v16
  v_max3_u32 v175, v175, v17, v18
  v_max3_u32 v175, v175, v19, v20
  v_max3_u32 v175, v175, v21, v22
  v_max3_u32 v175, v175, v23, v24
  v_max3_u32 v175, v175, v25, v26
  v_max3_u32 v175, v175, v27, v28
  v_max3_u32 v175, v175, v29, v30
  v_max3_u32 v175, v175, v31, v32
  v_max3_u32 v175, v175, v33, v34
  v_max3_u32 v175, v175, v35, v144
  v_max3_u32 v175, v175, v145, v146
  v_max3_u32 v175, v175, v147, v148
  v_max3_u32 v175, v175, v149, v150
  v_max3_u32 v175, v175, v151, v152
  v_max3_u32 v175, v175, v153, v154
  v_max_u32 v175, v175, v155
  v_cmp_eq_u32 vcc, -1, v175
  s_cbranch_vccz cB_va1_rk
  s_add_u32 s30, s30, 1
  s_cmp_lt_u32 s30, 400000
  s_cbranch_scc1 cB_va1_rv
  s_branch cB_abort
cB_va1_rk:
  s_mov_b32 s37, 1
  s_add_u32 s31, s31, 0x10000
  v_mov_b32 v156, 0
  v_mov_b32 v157, 0
  v_mov_b32 v158, 0
  v_mov_b32 v159, 0
  s_nop 1
  v_smfmac_f32_16x16x64_bf16 v[156:159], v[8:11], v[80:87], v0
  v_smfmac_f32_16x16x64_bf16 v[156:159], v[12:15], v[88:95], v0
  v_smfmac_f32_16x16x64_bf16 v[156:159], v[16:19], v[96:103], v0
  v_smfmac_f32_16x16x64_bf16 v[156:159], v[20:23], v[104:111], v0
  v_smfmac_f32_16x16x64_bf16 v[156:159], v[24:27], v[112:119], v0
  v_smfmac_f32_16x16x64_bf16 v[156:159], v[28:31], v[120:127], v0
  v_smfmac_f32_16x16x64_bf16 v[156:159], v[32:35], v[128:135], v0
  v_smfmac_f32_16x16x64_bf16 v[156:159], v[144:147], v[136:143], v0
  v_smfmac_f32_16x16x64_bf16 v[156:159], v[148:151], v[64:71], v0
  v_smfmac_f32_16x16x64_bf16 v[156:159], v[152:155], v[72:79], v0
  s_nop 7
  s_branch cB_va1_ep
.p2align 6

cB_va2_loop:
  s_add_u32 s23, s20, 4096
  s_add_u32 s21, s20, 20480
  v_mov_b32 v36, 0
  v_mov_b32 v37, 0
  v_mov_b32 v38, 0
  v_mov_b32 v39, 0
  v_mov_b32 v40, 0
  v_mov_b32 v41, 0
  v_mov_b32 v42, 0
  v_mov_b32 v43, 0
  v_mov_b32 v44, 0
  v_mov_b32 v45, 0
  v_mov_b32 v46, 0
  v_mov_b32 v47, 0
  v_mov_b32 v48, 0
  v_mov_b32 v49, 0
  v_mov_b32 v50, 0
  v_mov_b32 v51, 0
  v_mov_b32 v52, 0
  v_mov_b32 v53, 0
  v_mov_b32 v54, 0
  v_mov_b32 v55, 0
  v_mov_b32 v56, 0
  v_mov_b32 v57, 0
  v_mov_b32 v58, 0
  v_mov_b32 v59, 0
  v_mov_b32 v60, 0
  v_mov_b32 v61, 0
  v_mov_b32 v62, 0
  v_mov_b32 v63, 0
  v_mov_b32 v64, 0
  v_mov_b32 v65, 0
  v_mov_b32 v66, 0
  v_mov_b32 v67, 0
  s_mov_b32 s30, 0
  buffer_load_dword v76, v119, s[8:11], s20 offen sc1
  buffer_load_dword v77, v119, s[8:11], s20 offen sc1
  buffer_load_dword v78, v119, s[8:11], s20 offen sc1
cB_va2_fp_l:
  s_waitcnt vmcnt(2)
  v_cmp_eq_u32 vcc, -1, v76
  s_cbranch_vccz cB_va2_fp_d
  buffer_load_dword v76, v119, s[8:11], s20 offen sc1
  s_waitcnt vmcnt(2)
  v_cmp_eq_u32 vcc, -1, v77
  s_cbranch_vccz cB_va2_fp_d
  buffer_load_dword v77, v119, s[8:11], s20 offen sc1
  s_waitcnt vmcnt(2)
  v_cmp_eq_u32 vcc, -1, v78
  s_cbranch_vccz cB_va2_fp_d
  buffer_load_dword v78, v119, s[8:11], s20 offen sc1
  s_add_u32 s30, s30, 1
  s_cmp_lt_u32 s30, 400000
  s_cbranch_scc1 cB_va2_fp_l
  s_branch cB_abort
cB_va2_fp_d:
  s_nop 15
  s_nop 3
  buffer_load_dwordx4 v[8:11], v2, s[8:11], s20 offen offset:0 sc1
  buffer_load_dwordx4 v[12:15], v2, s[8:11], s20 offen offset:1024 sc1
  buffer_load_dwordx4 v[16:19], v2, s[8:11], s20 offen offset:2048 sc1
  buffer_load_dwordx4 v[20:23], v2, s[8:11], s20 offen offset:3072 sc1
  s_barrier
cB_va2_ld:
  s_waitcnt vmcnt(0)
  v_max3_u32 v84, v8, v9, v10
  v_max3_u32 v84, v84, v11, v12
  v_max3_u32 v84, v84, v13, v14
  v_max3_u32 v84, v84, v15, v16
  v_max3_u32 v84, v84, v17, v18
  v_max3_u32 v84, v84, v19, v20
  v_max3_u32 v84, v84, v21, v22
  v_max_u32 v84, v84, v23
  v_cmp_eq_u32 vcc, -1, v84
  ds_write_b128 v2, v[8:11] offset:8192
  ds_write_b128 v2, v[12:15] offset:9216
  ds_write_b128 v2, v[16:19] offset:10240
  ds_write_b128 v2, v[20:23] offset:11264
  s_cbranch_vccnz cB_va2_retry
  s_waitcnt lgkmcnt(0)
  s_barrier
  ds_read_b128 v[24:27], v2 offset:12288
  ds_read_b128 v[28:31], v2 offset:13312
  ds_read_b128 v[32:35], v2 offset:14336
  ds_read_b128 v[92:95], v0
  s_waitcnt lgkmcnt(0)
  s_mov_b64 exec, s[26:27]
  buffer_store_dwordx4 v[92:95], v2, s[8:11], s36 offen sc1
  s_mov_b64 exec, -1
  s_add_u32 s36, s36, 7168
  s_cmp_eq_u32 s19, 63
  s_cbranch_scc1 cB_done
  ds_read_b128 v[76:79], v1 offset:0
  ds_read_b128 v[80:83], v1 offset:1024
  ds_read_b128 v[84:87], v1 offset:2048
  ds_read_b128 v[88:91], v1 offset:3072
  ds_read_b128 v[92:95], v1 offset:4096
  ds_read_b128 v[96:99], v1 offset:5120
  v_smfmac_f32_16x16x64_bf16 v[60:63], v[8:11], v[200:207], v3
  v_smfmac_f32_16x16x64_bf16 v[60:63], v[12:15], v[208:215], v3
  s_waitcnt lgkmcnt(4)
  v_smfmac_f32_16x16x64_bf16 v[64:67], v[8:11], v[76:83], v3
  ds_read_b128 v[76:79], v1 offset:6144
  ds_read_b128 v[80:83], v1 offset:7168
  v_smfmac_f32_16x16x64_bf16 v[60:63], v[16:19], v[216:223], v3
  v_smfmac_f32_16x16x64_bf16 v[60:63], v[20:23], v[224:231], v3
  s_waitcnt lgkmcnt(4)
  v_smfmac_f32_16x16x64_bf16 v[64:67], v[12:15], v[84:91], v3
  ds_read_b128 v[84:87], v1 offset:8192
  ds_read_b128 v[88:91], v1 offset:9216
  v_smfmac_f32_16x16x64_bf16 v[60:63], v[24:27], v[232:239], v3
  v_smfmac_f32_16x16x64_bf16 v[60:63], v[28:31], v[240:247], v3
  s_waitcnt lgkmcnt(4)
  v_smfmac_f32_16x16x64_bf16 v[64:67], v[16:19], v[92:99], v3
  ds_read_b128 v[92:95], v1 offset:10240
  ds_read_b128 v[96:99], v1 offset:11264
  v_smfmac_f32_16x16x64_bf16 v[60:63], v[32:35], v[248:255], v3
  v_smfmac_f32_16x16x64_bf16 v[36:39], v[8:11], a[0:7], v3
  s_waitcnt lgkmcnt(4)
  v_smfmac_f32_16x16x64_bf16 v[64:67], v[20:23], v[76:83], v3
  ds_read_b128 v[76:79], v1 offset:12288
  ds_read_b128 v[80:83], v1 offset:13312
  v_smfmac_f32_16x16x64_bf16 v[36:39], v[12:15], a[8:15], v3
  v_smfmac_f32_16x16x64_bf16 v[36:39], v[16:19], a[16:23], v3
  s_waitcnt lgkmcnt(4)
  v_smfmac_f32_16x16x64_bf16 v[64:67], v[24:27], v[84:91], v3
  v_smfmac_f32_16x16x64_bf16 v[36:39], v[20:23], a[24:31], v3
  v_smfmac_f32_16x16x64_bf16 v[36:39], v[24:27], a[32:39], v3
  s_waitcnt lgkmcnt(2)
  v_smfmac_f32_16x16x64_bf16 v[64:67], v[28:31], v[92:99], v3
  v_smfmac_f32_16x16x64_bf16 v[36:39], v[28:31], a[40:47], v3
  v_smfmac_f32_16x16x64_bf16 v[36:39], v[32:35], a[48:55], v3
  s_waitcnt lgkmcnt(0)
  v_smfmac_f32_16x16x64_bf16 v[64:67], v[32:35], v[76:83], v3
  v_smfmac_f32_16x16x64_bf16 v[40:43], v[8:11], a[56:63], v3
  v_smfmac_f32_16x16x64_bf16 v[40:43], v[12:15], a[64:71], v3
  v_smfmac_f32_16x16x64_bf16 v[40:43], v[16:19], a[72:79], v3
  v_smfmac_f32_16x16x64_bf16 v[40:43], v[20:23], a[80:87], v3
  v_permlane32_swap_b32 v60, v64
  v_smfmac_f32_16x16x64_bf16 v[40:43], v[24:27], a[88:95], v3
  v_permlane32_swap_b32 v61, v65
  v_smfmac_f32_16x16x64_bf16 v[40:43], v[28:31], a[96:103], v3
  v_permlane32_swap_b32 v62, v66
  v_smfmac_f32_16x16x64_bf16 v[40:43], v[32:35], a[104:111], v3
  v_permlane32_swap_b32 v63, v67
  v_smfmac_f32_16x16x64_bf16 v[44:47], v[8:11], a[112:119], v3
  v_smfmac_f32_16x16x64_bf16 v[44:47], v[12:15], a[120:127], v3
  v_smfmac_f32_16x16x64_bf16 v[44:47], v[16:19], a[128:135], v3
  v_smfmac_f32_16x16x64_bf16 v[44:47], v[20:23], a[136:143], v3
  v_add_f32 v60, v60, v64
  v_add_f32 v61, v61, v65
  v_smfmac_f32_16x16x64_bf16 v[44:47], v[24:27], a[144:151], v3
  v_add_f32 v62, v62, v66
  v_add_f32 v63, v63, v67
  v_smfmac_f32_16x16x64_bf16 v[44:47], v[28:31], a[152:159], v3
  v_cvt_pk_bf16_f32 v64, v60, v61
  v_cvt_pk_bf16_f32 v65, v62, v63
  v_smfmac_f32_16x16x64_bf16 v[44:47], v[32:35], a[160:167], v3
  ds_write2_b32 v115, v64, v65 offset0:0 offset1:2
  v_smfmac_f32_16x16x64_bf16 v[48:51], v[8:11], a[168:175], v3
  v_permlane32_swap_b32 v36, v40
  v_smfmac_f32_16x16x64_bf16 v[48:51], v[12:15], a[176:183], v3
  v_permlane32_swap_b32 v37, v41
  v_smfmac_f32_16x16x64_bf16 v[48:51], v[16:19], a[184:191], v3
  v_permlane32_swap_b32 v38, v42
  v_smfmac_f32_16x16x64_bf16 v[48:51], v[20:23], a[192:199], v3
  v_permlane32_swap_b32 v39, v43
  v_smfmac_f32_16x16x64_bf16 v[48:51], v[24:27], a[200:207], v3
  v_add_f32 v36, v36, v40
  v_smfmac_f32_16x16x64_bf16 v[48:51], v[28:31], a[208:215], v3
  v_add_f32 v37, v37, v41
  v_smfmac_f32_16x16x64_bf16 v[48:51], v[32:35], a[216:223], v3
  v_add_f32 v38, v38, v42
  v_smfmac_f32_16x16x64_bf16 v[52:55], v[8:11], a[224:231], v3
  v_smfmac_f32_16x16x64_bf16 v[52:55], v[12:15], a[232:239], v3
  v_smfmac_f32_16x16x64_bf16 v[52:55], v[16:19], a[240:247], v3
  v_smfmac_f32_16x16x64_bf16 v[52:55], v[20:23], a[248:255], v3
  v_add_f32 v39, v39, v43
  v_cvt_pk_bf16_f32 v40, v36, v37
  v_smfmac_f32_16x16x64_bf16 v[52:55], v[24:27], v[120:127], v3
  v_cvt_pk_bf16_f32 v41, v38, v39
  v_smfmac_f32_16x16x64_bf16 v[52:55], v[28:31], v[128:135], v3
  ds_write2_b32 v112, v40, v41 offset0:0 offset1:2
  v_smfmac_f32_16x16x64_bf16 v[52:55], v[32:35], v[136:143], v3
  v_permlane32_swap_b32 v44, v48
  v_smfmac_f32_16x16x64_bf16 v[56:59], v[8:11], v[144:151], v3
  v_permlane32_swap_b32 v45, v49
  v_smfmac_f32_16x16x64_bf16 v[56:59], v[12:15], v[152:159], v3
  v_permlane32_swap_b32 v46, v50
  v_smfmac_f32_16x16x64_bf16 v[56:59], v[16:19], v[160:167], v3
  v_permlane32_swap_b32 v47, v51
  v_smfmac_f32_16x16x64_bf16 v[56:59], v[20:23], v[168:175], v3
  v_add_f32 v44, v44, v48
  v_smfmac_f32_16x16x64_bf16 v[56:59], v[24:27], v[176:183], v3
  v_add_f32 v45, v45, v49
  v_smfmac_f32_16x16x64_bf16 v[56:59], v[28:31], v[184:191], v3
  v_add_f32 v46, v46, v50
  v_smfmac_f32_16x16x64_bf16 v[56:59], v[32:35], v[192:199], v3
  v_add_f32 v47, v47, v51
  v_cvt_pk_bf16_f32 v48, v44, v45
  v_cvt_pk_bf16_f32 v49, v46, v47
  ds_write2_b32 v113, v48, v49 offset0:0 offset1:2
  s_nop 3
  v_permlane32_swap_b32 v52, v56
  v_permlane32_swap_b32 v53, v57
  v_permlane32_swap_b32 v54, v58
  v_permlane32_swap_b32 v55, v59
  v_add_f32 v52, v52, v56
  v_add_f32 v53, v53, v57
  v_add_f32 v54, v54, v58
  v_add_f32 v55, v55, v59
  v_cvt_pk_bf16_f32 v56, v52, v53
  v_cvt_pk_bf16_f32 v57, v54, v55
  ds_write2_b32 v114, v56, v57 offset0:0 offset1:2
  s_waitcnt lgkmcnt(0)
  s_barrier
  s_cmp_eq_u32 s19, 62
  s_cbranch_scc1 cB_done
  s_waitcnt vmcnt(0) lgkmcnt(0)
  s_add_u32 s19, s19, 1
  s_mov_b32 s20, s21
  s_branch cB_va2_loop
cB_va2_retry:
  s_waitcnt lgkmcnt(0)
  buffer_load_dwordx4 v[8:11], v2, s[8:11], s20 offen offset:0 sc1
  buffer_load_dwordx4 v[12:15], v2, s[8:11], s20 offen offset:1024 sc1
  buffer_load_dwordx4 v[16:19], v2, s[8:11], s20 offen offset:2048 sc1
  buffer_load_dwordx4 v[20:23], v2, s[8:11], s20 offen offset:3072 sc1
  s_add_u32 s31, s31, 1
  s_add_u32 s30, s30, 1
  s_cmp_lt_u32 s30, 400000
  s_cbranch_scc1 cB_va2_ld
  s_branch cB_abort
cB_va2_last:
  s_waitcnt lgkmcnt(0)
  buffer_store_dwordx4 v[100:103], v2, s[8:11], s24 offen offset:0 sc1
  buffer_store_dwordx4 v[104:107], v2, s[8:11], s24 offen offset:1024 sc1
  buffer_store_dwordx4 v[108:111], v2, s[8:11], s24 offen offset:2048 sc1
  buffer_store_dwordx4 v[4:7], v2, s[8:11], s24 offen offset:3072 sc1
  s_add_u32 s24, s24, 8192
  s_waitcnt vmcnt(0)
  s_mov_b64 exec, 1
  buffer_store_dword v117, v2, s[8:11], s34 offen sc1
  s_mov_b64 exec, -1
  s_add_u32 s34, s34, 8
  s_mov_b64 exec, 1
  buffer_store_dword v117, v2, s[8:11], s34 offen sc1
  s_mov_b64 exec, -1
  s_add_u32 s34, s34, 8
  s_branch cB_done
.p2align 6

cB_va3_loop:
  s_add_u32 s23, s20, 4096
  s_add_u32 s21, s20, 20480
  v_mov_b32 v36, 0
  v_mov_b32 v37, 0
  v_mov_b32 v38, 0
  v_mov_b32 v39, 0
  v_mov_b32 v40, 0
  v_mov_b32 v41, 0
  v_mov_b32 v42, 0
  v_mov_b32 v43, 0
  v_mov_b32 v44, 0
  v_mov_b32 v45, 0
  v_mov_b32 v46, 0
  v_mov_b32 v47, 0
  v_mov_b32 v48, 0
  v_mov_b32 v49, 0
  v_mov_b32 v50, 0
  v_mov_b32 v51, 0
  v_mov_b32 v52, 0
  v_mov_b32 v53, 0
  v_mov_b32 v54, 0
  v_mov_b32 v55, 0
  v_mov_b32 v56, 0
  v_mov_b32 v57, 0
  v_mov_b32 v58, 0
  v_mov_b32 v59, 0
  v_mov_b32 v60, 0
  v_mov_b32 v61, 0
  v_mov_b32 v62, 0
  v_mov_b32 v63, 0
  v_mov_b32 v64, 0
  v_mov_b32 v65, 0
  v_mov_b32 v66, 0
  v_mov_b32 v67, 0
  s_mov_b32 s30, 0
  buffer_load_dword v76, v119, s[8:11], s20 offen sc1
  buffer_load_dword v77, v119, s[8:11], s20 offen sc1
  buffer_load_dword v78, v119, s[8:11], s20 offen sc1
cB_va3_fp_l:
  s_waitcnt vmcnt(2)
  v_cmp_eq_u32 vcc, -1, v76
  s_cbranch_vccz cB_va3_fp_d
  buffer_load_dword v76, v119, s[8:11], s20 offen sc1
  s_waitcnt vmcnt(2)
  v_cmp_eq_u32 vcc, -1, v77
  s_cbranch_vccz cB_va3_fp_d
  buffer_load_dword v77, v119, s[8:11], s20 offen sc1
  s_waitcnt vmcnt(2)
  v_cmp_eq_u32 vcc, -1, v78
  s_cbranch_vccz cB_va3_fp_d
  buffer_load_dword v78, v119, s[8:11], s20 offen sc1
  s_add_u32 s30, s30, 1
  s_cmp_lt_u32 s30, 400000
  s_cbranch_scc1 cB_va3_fp_l
  s_branch cB_abort
cB_va3_fp_d:
  buffer_load_dwordx4 v[24:27], v2, s[8:11], s23 offen offset:0 sc1
  buffer_load_dwordx4 v[28:31], v2, s[8:11], s23 offen offset:1024 sc1
  buffer_load_dwordx4 v[32:35], v2, s[8:11], s23 offen offset:2048 sc1
  s_barrier
cB_va3_ld:
  s_waitcnt vmcnt(0)
  v_max3_u32 v84, v24, v25, v26
  v_max3_u32 v84, v84, v27, v28
  v_max3_u32 v84, v84, v29, v30
  v_max3_u32 v84, v84, v31, v32
  v_max3_u32 v84, v84, v33, v34
  v_max_u32 v84, v84, v35
  v_cmp_eq_u32 vcc, -1, v84
  ds_write_b128 v2, v[24:27] offset:12288
  ds_write_b128 v2, v[28:31] offset:13312
  ds_write_b128 v2, v[32:35] offset:14336
  s_cbranch_vccnz cB_va3_retry
  s_waitcnt lgkmcnt(0)
  s_barrier
  ds_read_b128 v[8:11], v2 offset:8192
  ds_read_b128 v[12:15], v2 offset:9216
  ds_read_b128 v[16:19], v2 offset:10240
  ds_read_b128 v[20:23], v2 offset:11264
  s_waitcnt lgkmcnt(0)
  s_cmp_eq_u32 s19, 63
  s_cbranch_scc1 cB_done
  ds_read_b128 v[76:79], v1 offset:0
  ds_read_b128 v[80:83], v1 offset:1024
  ds_read_b128 v[84:87], v1 offset:2048
  ds_read_b128 v[88:91], v1 offset:3072
  ds_read_b128 v[92:95], v1 offset:4096
  ds_read_b128 v[96:99], v1 offset:5120
  v_smfmac_f32_16x16x64_bf16 v[60:63], v[8:11], v[200:207], v3
  v_smfmac_f32_16x16x64_bf16 v[60:63], v[12:15], v[208:215], v3
  s_waitcnt lgkmcnt(4)
  v_smfmac_f32_16x16x64_bf16 v[64:67], v[8:11], v[76:83], v3
  ds_read_b128 v[76:79], v1 offset:6144
  ds_read_b128 v[80:83], v1 offset:7168
  v_smfmac_f32_16x16x64_bf16 v[60:63], v[16:19], v[216:223], v3
  v_smfmac_f32_16x16x64_bf16 v[60:63], v[20:23], v[224:231], v3
  s_waitcnt lgkmcnt(4)
  v_smfmac_f32_16x16x64_bf16 v[64:67], v[12:15], v[84:91], v3
  ds_read_b128 v[84:87], v1 offset:8192
  ds_read_b128 v[88:91], v1 offset:9216
  v_smfmac_f32_16x16x64_bf16 v[60:63], v[24:27], v[232:239], v3
  v_smfmac_f32_16x16x64_bf16 v[60:63], v[28:31], v[240:247], v3
  s_waitcnt lgkmcnt(4)
  v_smfmac_f32_16x16x64_bf16 v[64:67], v[16:19], v[92:99], v3
  ds_read_b128 v[92:95], v1 offset:10240
  ds_read_b128 v[96:99], v1 offset:11264
  v_smfmac_f32_16x16x64_bf16 v[60:63], v[32:35], v[248:255], v3
  v_smfmac_f32_16x16x64_bf16 v[36:39], v[8:11], a[0:7], v3
  s_waitcnt lgkmcnt(4)
  v_smfmac_f32_16x16x64_bf16 v[64:67], v[20:23], v[76:83], v3
  ds_read_b128 v[76:79], v1 offset:12288
  ds_read_b128 v[80:83], v1 offset:13312
  v_smfmac_f32_16x16x64_bf16 v[36:39], v[12:15], a[8:15], v3
  v_smfmac_f32_16x16x64_bf16 v[36:39], v[16:19], a[16:23], v3
  s_waitcnt lgkmcnt(4)
  v_smfmac_f32_16x16x64_bf16 v[64:67], v[24:27], v[84:91], v3
  v_smfmac_f32_16x16x64_bf16 v[36:39], v[20:23], a[24:31], v3
  v_smfmac_f32_16x16x64_bf16 v[36:39], v[24:27], a[32:39], v3
  s_waitcnt lgkmcnt(2)
  v_smfmac_f32_16x16x64_bf16 v[64:67], v[28:31], v[92:99], v3
  v_smfmac_f32_16x16x64_bf16 v[36:39], v[28:31], a[40:47], v3
  v_smfmac_f32_16x16x64_bf16 v[36:39], v[32:35], a[48:55], v3
  s_waitcnt lgkmcnt(0)
  v_smfmac_f32_16x16x64_bf16 v[64:67], v[32:35], v[76:83], v3
  v_smfmac_f32_16x16x64_bf16 v[40:43], v[8:11], a[56:63], v3
  v_smfmac_f32_16x16x64_bf16 v[40:43], v[12:15], a[64:71], v3
  v_smfmac_f32_16x16x64_bf16 v[40:43], v[16:19], a[72:79], v3
  v_smfmac_f32_16x16x64_bf16 v[40:43], v[20:23], a[80:87], v3
  v_permlane32_swap_b32 v60, v64
  v_smfmac_f32_16x16x64_bf16 v[40:43], v[24:27], a[88:95], v3
  v_permlane32_swap_b32 v61, v65
  v_smfmac_f32_16x16x64_bf16 v[40:43], v[28:31], a[96:103], v3
  v_permlane32_swap_b32 v62, v66
  v_smfmac_f32_16x16x64_bf16 v[40:43], v[32:35], a[104:111], v3
  v_permlane32_swap_b32 v63, v67
  v_smfmac_f32_16x16x64_bf16 v[44:47], v[8:11], a[112:119], v3
  v_smfmac_f32_16x16x64_bf16 v[44:47], v[12:15], a[120:127], v3
  v_smfmac_f32_16x16x64_bf16 v[44:47], v[16:19], a[128:135], v3
  v_smfmac_f32_16x16x64_bf16 v[44:47], v[20:23], a[136:143], v3
  v_add_f32 v60, v60, v64
  v_add_f32 v61, v61, v65
  v_smfmac_f32_16x16x64_bf16 v[44:47], v[24:27], a[144:151], v3
  v_add_f32 v62, v62, v66
  v_add_f32 v63, v63, v67
  v_smfmac_f32_16x16x64_bf16 v[44:47], v[28:31], a[152:159], v3
  v_cvt_pk_bf16_f32 v64, v60, v61
  v_cvt_pk_bf16_f32 v65, v62, v63
  v_smfmac_f32_16x16x64_bf16 v[44:47], v[32:35], a[160:167], v3
  ds_write2_b32 v115, v64, v65 offset0:0 offset1:2
  v_smfmac_f32_16x16x64_bf16 v[48:51], v[8:11], a[168:175], v3
  v_permlane32_swap_b32 v36, v40
  v_smfmac_f32_16x16x64_bf16 v[48:51], v[12:15], a[176:183], v3
  v_permlane32_swap_b32 v37, v41
  v_smfmac_f32_16x16x64_bf16 v[48:51], v[16:19], a[184:191], v3
  v_permlane32_swap_b32 v38, v42
  v_smfmac_f32_16x16x64_bf16 v[48:51], v[20:23], a[192:199], v3
  v_permlane32_swap_b32 v39, v43
  v_smfmac_f32_16x16x64_bf16 v[48:51], v[24:27], a[200:207], v3
  v_add_f32 v36, v36, v40
  v_smfmac_f32_16x16x64_bf16 v[48:51], v[28:31], a[208:215], v3
  v_add_f32 v37, v37, v41
  v_smfmac_f32_16x16x64_bf16 v[48:51], v[32:35], a[216:223], v3
  v_add_f32 v38, v38, v42
  v_smfmac_f32_16x16x64_bf16 v[52:55], v[8:11], a[224:231], v3
  v_smfmac_f32_16x16x64_bf16 v[52:55], v[12:15], a[232:239], v3
  v_smfmac_f32_16x16x64_bf16 v[52:55], v[16:19], a[240:247], v3
  v_smfmac_f32_16x16x64_bf16 v[52:55], v[20:23], a[248:255], v3
  v_add_f32 v39, v39, v43
  v_cvt_pk_bf16_f32 v40, v36, v37
  v_smfmac_f32_16x16x64_bf16 v[52:55], v[24:27], v[120:127], v3
  v_cvt_pk_bf16_f32 v41, v38, v39
  v_smfmac_f32_16x16x64_bf16 v[52:55], v[28:31], v[128:135], v3
  ds_write2_b32 v112, v40, v41 offset0:0 offset1:2
  v_smfmac_f32_16x16x64_bf16 v[52:55], v[32:35], v[136:143], v3
  v_permlane32_swap_b32 v44, v48
  v_smfmac_f32_16x16x64_bf16 v[56:59], v[8:11], v[144:151], v3
  v_permlane32_swap_b32 v45, v49
  v_smfmac_f32_16x16x64_bf16 v[56:59], v[12:15], v[152:159], v3
  v_permlane32_swap_b32 v46, v50
  v_smfmac_f32_16x16x64_bf16 v[56:59], v[16:19], v[160:167], v3
  v_permlane32_swap_b32 v47, v51
  v_smfmac_f32_16x16x64_bf16 v[56:59], v[20:23], v[168:175], v3
  v_add_f32 v44, v44, v48
  v_smfmac_f32_16x16x64_bf16 v[56:59], v[24:27], v[176:183], v3
  v_add_f32 v45, v45, v49
  v_smfmac_f32_16x16x64_bf16 v[56:59], v[28:31], v[184:191], v3
  v_add_f32 v46, v46, v50
  v_smfmac_f32_16x16x64_bf16 v[56:59], v[32:35], v[192:199], v3
  v_add_f32 v47, v47, v51
  v_cvt_pk_bf16_f32 v48, v44, v45
  v_cvt_pk_bf16_f32 v49, v46, v47
  ds_write2_b32 v113, v48, v49 offset0:0 offset1:2
  s_nop 3
  v_permlane32_swap_b32 v52, v56
  v_permlane32_swap_b32 v53, v57
  v_permlane32_swap_b32 v54, v58
  v_permlane32_swap_b32 v55, v59
  v_add_f32 v52, v52, v56
  v_add_f32 v53, v53, v57
  v_add_f32 v54, v54, v58
  v_add_f32 v55, v55, v59
  v_cvt_pk_bf16_f32 v56, v52, v53
  v_cvt_pk_bf16_f32 v57, v54, v55
  ds_write2_b32 v114, v56, v57 offset0:0 offset1:2
  s_waitcnt lgkmcnt(0)
  s_barrier
  s_cmp_eq_u32 s19, 62
  s_cbranch_scc1 cB_done
  s_waitcnt vmcnt(0) lgkmcnt(0)
  s_add_u32 s19, s19, 1
  s_mov_b32 s20, s21
  s_branch cB_va3_loop
cB_va3_retry:
  s_waitcnt lgkmcnt(0)
  buffer_load_dwordx4 v[24:27], v2, s[8:11], s23 offen offset:0 sc1
  buffer_load_dwordx4 v[28:31], v2, s[8:11], s23 offen offset:1024 sc1
  buffer_load_dwordx4 v[32:35], v2, s[8:11], s23 offen offset:2048 sc1
  s_add_u32 s31, s31, 1
  s_add_u32 s30, s30, 1
  s_cmp_lt_u32 s30, 400000
  s_cbranch_scc1 cB_va3_ld
  s_branch cB_abort
cB_va3_last:
  s_waitcnt lgkmcnt(0)
  buffer_store_dwordx4 v[100:103], v2, s[8:11], s24 offen offset:0 sc1
  buffer_store_dwordx4 v[104:107], v2, s[8:11], s24 offen offset:1024 sc1
  buffer_store_dwordx4 v[108:111], v2, s[8:11], s24 offen offset:2048 sc1
  buffer_store_dwordx4 v[4:7], v2, s[8:11], s24 offen offset:3072 sc1
  s_add_u32 s24, s24, 8192
  s_waitcnt vmcnt(0)
  s_mov_b64 exec, 1
  buffer_store_dword v117, v2, s[8:11], s34 offen sc1
  s_mov_b64 exec, -1
  s_add_u32 s34, s34, 8
  s_mov_b64 exec, 1
  buffer_store_dword v117, v2, s[8:11], s34 offen sc1
  s_mov_b64 exec, -1
  s_add_u32 s34, s34, 8
  s_branch cB_done
cB_abort:
  v_mov_b32 v4, 0xdead
  v_mov_b32 v5, 16
  buffer_store_dword v4, v5, s[12:15], 0 offen
  s_branch ch_end
cB_done:
  s_branch ch_end
m_reclaim:
  s_waitcnt vmcnt(0)
  s_lshr_b32 s20, s3, 5
  s_cmp_lg_u32 s16, 0
  s_cbranch_scc1 w0_17
  s_mov_b32 s21, 0
  s_mov_b64 exec, 1
rc_l:
  s_cmp_lg_u32 s70, -1
  s_cbranch_scc1 rc_t
  s_add_u32 s20, s20, 1
  s_cmp_lt_u32 s20, 8
  s_cselect_b32 s20, s20, 0
  s_mov_b32 s70, 0
  s_mov_b32 s3, -1
  s_add_u32 s21, s21, 1
  s_cmp_ge_u32 s21, 9
  s_cbranch_scc1 rc_d
rc_t:
  s_ff0_i32_b32 s22, s70
  s_lshl_b32 s23, 1, s22
  s_and_b32 s71, s20, 4
  s_mul_i32 s71, s71, 12
  s_lshl_b32 s3, s20, 2
  s_add_u32 s3, s3, s71
  v_mov_b32 v242, s23
  v_mov_b32 v243, 32
  buffer_atomic_or v242, v243, s[12:15], s3 offen sc0
  s_waitcnt vmcnt(0)
  v_readfirstlane_b32 s70, v242
  s_lshl_b32 s3, s20, 5
  s_add_u32 s3, s3, s22
  s_bitcmp1_b32 s70, s22
  s_cbranch_scc1 rc_l
rc_d:
  s_mov_b64 exec, -1
  v_mov_b32 v242, s3
w0_17:
  v_mov_b32 v250, 160000
  s_add_u32 s101, s101, 1
  s_barrier
  s_mov_b64 exec, 1
  s_cmp_lg_u32 s16, 0
  s_cbranch_scc1 w0_18
  ds_write_b32 v250, v242 offset:0
  s_waitcnt lgkmcnt(0)
  v_mov_b32 v242, s101
  ds_write_b32 v250, v242 offset:16
  s_waitcnt lgkmcnt(0)
w0_18:
  s_mov_b64 exec, -1
  s_barrier
  ds_read_b32 v242, v250 offset:0
  ds_read_b32 v250, v250 offset:16
  s_waitcnt lgkmcnt(0)
  v_readfirstlane_b32 s3, v242
  v_cmp_ne_u32 vcc, s101, v250
  s_cbranch_vccnz ch_end
  s_cmp_lg_u32 s3, -1
  s_cbranch_scc1 m_start
  v_mov_b32 v250, 0
  s_branch wk_ask
m_bjob:
  v_and_b32 v1, 63, v0
  v_lshlrev_b32 v2, 4, v1
  v_lshrrev_b32 v3, 4, v1
  v_and_b32 v4, 15, v1
  s_sub_u32 s18, s3, 32
  s_mul_i32 s17, s18, 4682
  s_lshr_b32 s17, s17, 16
  s_mul_i32 s20, s17, 14
  s_sub_u32 s19, s18, s20
  s_cmp_ge_u32 s19, 7
  s_cselect_b32 s31, 7, 0
  s_sub_u32 s19, s19, s31
  s_mov_b32 s60, s44
  s_and_b32 s61, s45, 0xffff
  s_mov_b32 s62, 3670016
  s_mov_b32 s63, 0x20000
  s_mov_b32 s56, s46
  s_and_b32 s57, s47, 0xffff
  s_mov_b32 s58, 3670016
  s_mov_b32 s59, 0x20000
  s_lshl_b32 s30, s16, 13
  s_mul_i32 s27, s17, 229376
  s_lshl_b32 s29, s19, 7
  s_add_u32 s27, s27, s29
  v_lshrrev_b32 v7, 3, v1
  v_and_b32 v8, 7, v1
  v_and_b32 v9, 2, v7
  v_xor_b32 v8, v8, v9
  s_lshl_b32 s29, s16, 6
  v_add_u32 v7, s29, v7
  v_mul_u32_u24 v7, 896, v7
  v_lshl_add_u32 v7, v8, 4, v7
  v_xor_b32 v8, 64, v7
  s_add_u32 m0, s30, 0
  s_add_u32 s22, s27, 0
  buffer_load_dwordx4 v7, s[56:59], s22 offen offset:0 lds
  s_add_u32 s22, s27, 6144
  buffer_load_dwordx4 v8, s[56:59], s22 offen offset:1024 lds
  s_add_u32 s22, s27, 12288
  buffer_load_dwordx4 v7, s[56:59], s22 offen offset:2048 lds
  s_add_u32 s22, s27, 18432
  buffer_load_dwordx4 v8, s[56:59], s22 offen offset:3072 lds
  s_add_u32 m0, s30, 4096
  s_add_u32 s22, s27, 28672
  buffer_load_dwordx4 v7, s[56:59], s22 offen offset:0 lds
  s_add_u32 s22, s27, 34816
  buffer_load_dwordx4 v8, s[56:59], s22 offen offset:1024 lds
  s_add_u32 s22, s27, 40960
  buffer_load_dwordx4 v7, s[56:59], s22 offen offset:2048 lds
  s_add_u32 s22, s27, 47104
  buffer_load_dwordx4 v8, s[56:59], s22 offen offset:3072 lds
  v_lshrrev_b32 v5, 5, v1
  v_and_b32 v6, 31, v1
  s_lshl_b32 s25, s16, 15
  s_add_u32 s25, s25, 32768
  s_lshl_b32 s26, s17, 9
  s_add_u32 s28, s19, s16
  s_cmp_ge_u32 s28, 7
  s_cselect_b32 s20, 7, 0
  s_sub_u32 s28, s28, s20
  s_add_u32 s28, s28, s31
  s_add_u32 s29, s19, s16
  s_add_u32 s29, s29, 4
  s_cmp_ge_u32 s29, 7
  s_cselect_b32 s20, 7, 0
  s_sub_u32 s29, s29, s20
  s_add_u32 s29, s29, s31
  s_lshl_b32 s32, s28, 18
  s_add_u32 s32, s32, s26
  s_lshl_b32 s33, s29, 18
  s_add_u32 s33, s33, s26
  v_xor_b32 v8, v6, v5
  v_lshlrev_b32 v8, 4, v8
  v_lshl_add_u32 v8, v5, 13, v8
  v_xor_b32 v12, 0, v8
  v_xor_b32 v13, 32, v8
  v_add_u32 v13, 15360, v13
  v_xor_b32 v14, 0, v8
  v_add_u32 v14, 30720, v14
  v_xor_b32 v15, 32, v8
  v_add_u32 v15, 46080, v15
  s_add_u32 s20, s16, 0
  s_and_b32 s20, s20, 3
  s_mul_i32 s21, s20, 65600
  s_lshl_b32 s20, s20, 12
  s_add_u32 s48, s20, s25
  s_mov_b32 m0, s48
  v_xor_b32 v16, s21, v12
  buffer_load_dwordx4 v16, s[60:63], s32 offen offset:0 lds
  v_xor_b32 v17, s21, v13
  buffer_load_dwordx4 v17, s[60:63], s32 offen offset:1024 lds
  v_xor_b32 v18, s21, v14
  buffer_load_dwordx4 v18, s[60:63], s32 offen offset:2048 lds
  v_xor_b32 v19, s21, v15
  buffer_load_dwordx4 v19, s[60:63], s32 offen offset:3072 lds
  s_add_u32 s20, s16, 1
  s_and_b32 s20, s20, 3
  s_mul_i32 s21, s20, 65600
  s_lshl_b32 s20, s20, 12
  s_add_u32 s49, s20, s25
  s_mov_b32 m0, s49
  v_xor_b32 v20, s21, v12
  buffer_load_dwordx4 v20, s[60:63], s32 offen offset:0 lds
  v_xor_b32 v21, s21, v13
  buffer_load_dwordx4 v21, s[60:63], s32 offen offset:1024 lds
  v_xor_b32 v22, s21, v14
  buffer_load_dwordx4 v22, s[60:63], s32 offen offset:2048 lds
  v_xor_b32 v23, s21, v15
  buffer_load_dwordx4 v23, s[60:63], s32 offen offset:3072 lds
  s_add_u32 s20, s16, 2
  s_and_b32 s20, s20, 3
  s_mul_i32 s21, s20, 65600
  s_lshl_b32 s20, s20, 12
  s_add_u32 s50, s20, s25
  s_mov_b32 m0, s50
  v_xor_b32 v24, s21, v12
  buffer_load_dwordx4 v24, s[60:63], s32 offen offset:0 lds
  v_xor_b32 v25, s21, v13
  buffer_load_dwordx4 v25, s[60:63], s32 offen offset:1024 lds
  v_xor_b32 v26, s21, v14
  buffer_load_dwordx4 v26, s[60:63], s32 offen offset:2048 lds
  v_xor_b32 v27, s21, v15
  buffer_load_dwordx4 v27, s[60:63], s32 offen offset:3072 lds
  s_add_u32 s20, s16, 3
  s_and_b32 s20, s20, 3
  s_mul_i32 s21, s20, 65600
  s_lshl_b32 s20, s20, 12
  s_add_u32 s51, s20, s25
  s_mov_b32 m0, s51
  v_xor_b32 v28, s21, v12
  buffer_load_dwordx4 v28, s[60:63], s32 offen offset:0 lds
  v_xor_b32 v29, s21, v13
  buffer_load_dwordx4 v29, s[60:63], s32 offen offset:1024 lds
  v_xor_b32 v30, s21, v14
  buffer_load_dwordx4 v30, s[60:63], s32 offen offset:2048 lds
  v_xor_b32 v31, s21, v15
  buffer_load_dwordx4 v31, s[60:63], s32 offen offset:3072 lds
  s_cmp_lg_u32 s66, 0
  s_cbranch_scc1 bj_ci
  s_cmp_lg_u32 s16, 0
  s_cbranch_scc1 w0_19
  s_lshr_b32 s70, s3, 5
  s_and_b32 s71, s70, 4
  s_mul_i32 s71, s71, 12
  s_lshl_b32 s70, s70, 2
  s_add_u32 s70, s70, s71
  s_lshl_b32 s71, 1, s3
  v_mov_b32 v44, s71
  v_mov_b32 v45, 32
  s_mov_b64 exec, 1
  buffer_atomic_or v44, v45, s[12:15], s70 offen sc0
  buffer_load_dwordx2 v[46:47], v45, s[12:15], 0 offen offset:96 sc1
  s_mov_b64 exec, -1
w0_19:
bj_ci:
  s_lshl_b32 s30, s19, 6
  s_add_u32 s30, s30, 0
  s_cmp_lt_u32 s19, 4
  s_cselect_b32 s20, 0, 256
  s_sub_u32 s30, s30, s20
  v_add_u32 v8, s30, v4
  s_lshr_b32 s20, s20, 4
  s_cmp_lt_u32 s19, 4
  s_movk_i32 s21, 5462
  s_cselect_b32 s21, 4096, s21
  s_cselect_b32 s30, 16, 12
  v_mul_u32_u24 v10, s21, v8
  v_lshrrev_b32 v10, 16, v10
  v_mul_u32_u24 v11, s30, v10
  v_sub_u32 v32, v8, v11
  v_add_u32 v32, s20, v32
  s_mul_i32 s30, s17, 28
  v_add_u32 v32, s30, v32
  v_lshrrev_b32 v33, 4, v32
  v_and_b32 v32, 15, v32
  s_mov_b32 s30, 401408
  v_mul_lo_u32 v10, v10, s30
  v_mul_u32_u24 v33, 14336, v33
  v_add_u32 v10, v10, v33
  v_lshl_add_u32 v10, v3, 8, v10
  v_lshl_add_u32 v10, v32, 4, v10
  v_add_u32 v12, 6422528, v10
  s_lshl_b32 s30, s19, 6
  s_add_u32 s30, s30, 16
  s_cmp_lt_u32 s19, 4
  s_cselect_b32 s20, 0, 256
  s_sub_u32 s30, s30, s20
  v_add_u32 v8, s30, v4
  s_lshr_b32 s20, s20, 4
  s_cmp_lt_u32 s19, 4
  s_movk_i32 s21, 5462
  s_cselect_b32 s21, 4096, s21
  s_cselect_b32 s30, 16, 12
  v_mul_u32_u24 v10, s21, v8
  v_lshrrev_b32 v10, 16, v10
  v_mul_u32_u24 v11, s30, v10
  v_sub_u32 v32, v8, v11
  v_add_u32 v32, s20, v32
  s_mul_i32 s30, s17, 28
  v_add_u32 v32, s30, v32
  v_lshrrev_b32 v33, 4, v32
  v_and_b32 v32, 15, v32
  s_mov_b32 s30, 401408
  v_mul_lo_u32 v10, v10, s30
  v_mul_u32_u24 v33, 14336, v33
  v_add_u32 v10, v10, v33
  v_lshl_add_u32 v10, v3, 8, v10
  v_lshl_add_u32 v10, v32, 4, v10
  v_add_u32 v13, 6422528, v10
  s_lshl_b32 s30, s19, 6
  s_add_u32 s30, s30, 32
  s_cmp_lt_u32 s19, 4
  s_cselect_b32 s20, 0, 256
  s_sub_u32 s30, s30, s20
  v_add_u32 v8, s30, v4
  s_lshr_b32 s20, s20, 4
  s_cmp_lt_u32 s19, 4
  s_movk_i32 s21, 5462
  s_cselect_b32 s21, 4096, s21
  s_cselect_b32 s30, 16, 12
  v_mul_u32_u24 v10, s21, v8
  v_lshrrev_b32 v10, 16, v10
  v_mul_u32_u24 v11, s30, v10
  v_sub_u32 v32, v8, v11
  v_add_u32 v32, s20, v32
  s_mul_i32 s30, s17, 28
  v_add_u32 v32, s30, v32
  v_lshrrev_b32 v33, 4, v32
  v_and_b32 v32, 15, v32
  s_mov_b32 s30, 401408
  v_mul_lo_u32 v10, v10, s30
  v_mul_u32_u24 v33, 14336, v33
  v_add_u32 v10, v10, v33
  v_lshl_add_u32 v10, v3, 8, v10
  v_lshl_add_u32 v10, v32, 4, v10
  v_add_u32 v14, 6422528, v10
  s_lshl_b32 s30, s19, 6
  s_add_u32 s30, s30, 48
  s_cmp_lt_u32 s19, 4
  s_cselect_b32 s20, 0, 256
  s_sub_u32 s30, s30, s20
  v_add_u32 v8, s30, v4
  s_lshr_b32 s20, s20, 4
  s_cmp_lt_u32 s19, 4
  s_movk_i32 s21, 5462
  s_cselect_b32 s21, 4096, s21
  s_cselect_b32 s30, 16, 12
  v_mul_u32_u24 v10, s21, v8
  v_lshrrev_b32 v10, 16, v10
  v_mul_u32_u24 v11, s30, v10
  v_sub_u32 v32, v8, v11
  v_add_u32 v32, s20, v32
  s_mul_i32 s30, s17, 28
  v_add_u32 v32, s30, v32
  v_lshrrev_b32 v33, 4, v32
  v_and_b32 v32, 15, v32
  s_mov_b32 s30, 401408
  v_mul_lo_u32 v10, v10, s30
  v_mul_u32_u24 v33, 14336, v33
  v_add_u32 v10, v10, v33
  v_lshl_add_u32 v10, v3, 8, v10
  v_lshl_add_u32 v10, v32, 4, v10
  v_add_u32 v15, 6422528, v10
  v_lshrrev_b32 v7, 2, v4
  v_lshlrev_b32 v7, 3, v7
  v_and_b32 v8, 3, v4
  v_add_u32 v7, v7, v8
  v_xor_b32 v10, v3, v4
  v_lshlrev_b32 v10, 4, v10
  v_lshl_add_u32 v10, v7, 9, v10
  v_add_u32 v10, s25, v10
  v_xor_b32 v32, 0, v10
  v_xor_b32 v33, 64, v10
  v_xor_b32 v34, 128, v10
  v_xor_b32 v35, 192, v10
  v_lshrrev_b32 v7, 2, v4
  v_lshl_add_u32 v7, v3, 3, v7
  v_lshlrev_b32 v7, 7, v7
  v_and_b32 v8, 3, v4
  v_lshl_add_u32 v7, v8, 3, v7
  v_lshrrev_b32 v8, 3, v4
  v_lshl_add_u32 v7, v8, 5, v7
  v_and_b32 v8, 1, v3
  v_lshl_add_u32 v7, v8, 6, v7
  s_waitcnt vmcnt(16)
  s_barrier
  s_cmp_eq_u32 s16, 3
  s_cbranch_scc1 bj_np0
  s_add_u32 m0, s48, 16384
  s_nop 0
  buffer_load_dwordx4 v16, s[60:63], s33 offen offset:0 lds
  buffer_load_dwordx4 v17, s[60:63], s33 offen offset:1024 lds
  buffer_load_dwordx4 v18, s[60:63], s33 offen offset:2048 lds
  buffer_load_dwordx4 v19, s[60:63], s33 offen offset:3072 lds
bj_np0:
  v_xor_b32 v9, 0, v7
  ds_read_b64_tr_b16 v[128:129], v9 offset:0
  ds_read_b64_tr_b16 v[130:131], v9 offset:512
  ds_read_b64_tr_b16 v[132:133], v9 offset:4096
  ds_read_b64_tr_b16 v[134:135], v9 offset:4608
  ds_read_b64_tr_b16 v[136:137], v9 offset:8192
  ds_read_b64_tr_b16 v[138:139], v9 offset:8704
  ds_read_b64_tr_b16 v[140:141], v9 offset:12288
  ds_read_b64_tr_b16 v[142:143], v9 offset:12800
  s_waitcnt lgkmcnt(6)
  ds_read_b64_tr_b16 v[144:145], v9 offset:16384
  ds_read_b64_tr_b16 v[146:147], v9 offset:16896
  ds_read_b64_tr_b16 v[148:149], v9 offset:20480
  ds_read_b64_tr_b16 v[150:151], v9 offset:20992
  ds_read_b64_tr_b16 v[152:153], v9 offset:24576
  ds_read_b64_tr_b16 v[154:155], v9 offset:25088
  ds_read_b64_tr_b16 v[156:157], v9 offset:28672
  ds_read_b64_tr_b16 v[158:159], v9 offset:29184
  s_waitcnt lgkmcnt(6)
  s_cmp_eq_u32 s16, 3
  s_cbranch_scc1 bj_np1
  s_add_u32 m0, s49, 16384
  s_nop 0
  buffer_load_dwordx4 v20, s[60:63], s33 offen offset:0 lds
  buffer_load_dwordx4 v21, s[60:63], s33 offen offset:1024 lds
  buffer_load_dwordx4 v22, s[60:63], s33 offen offset:2048 lds
  buffer_load_dwordx4 v23, s[60:63], s33 offen offset:3072 lds
bj_np1:
  v_xor_b32 v9, 32, v7
  ds_read_b64_tr_b16 v[160:161], v9 offset:0
  ds_read_b64_tr_b16 v[162:163], v9 offset:512
  ds_read_b64_tr_b16 v[164:165], v9 offset:4096
  ds_read_b64_tr_b16 v[166:167], v9 offset:4608
  ds_read_b64_tr_b16 v[168:169], v9 offset:8192
  ds_read_b64_tr_b16 v[170:171], v9 offset:8704
  ds_read_b64_tr_b16 v[172:173], v9 offset:12288
  ds_read_b64_tr_b16 v[174:175], v9 offset:12800
  s_waitcnt lgkmcnt(6)
  ds_read_b64_tr_b16 v[176:177], v9 offset:16384
  ds_read_b64_tr_b16 v[178:179], v9 offset:16896
  ds_read_b64_tr_b16 v[180:181], v9 offset:20480
  ds_read_b64_tr_b16 v[182:183], v9 offset:20992
  ds_read_b64_tr_b16 v[184:185], v9 offset:24576
  ds_read_b64_tr_b16 v[186:187], v9 offset:25088
  ds_read_b64_tr_b16 v[188:189], v9 offset:28672
  ds_read_b64_tr_b16 v[190:191], v9 offset:29184
  s_waitcnt lgkmcnt(6)
  s_cmp_eq_u32 s16, 3
  s_cbranch_scc1 bj_np2
  s_add_u32 m0, s50, 16384
  s_nop 0
  buffer_load_dwordx4 v24, s[60:63], s33 offen offset:0 lds
  buffer_load_dwordx4 v25, s[60:63], s33 offen offset:1024 lds
  buffer_load_dwordx4 v26, s[60:63], s33 offen offset:2048 lds
  buffer_load_dwordx4 v27, s[60:63], s33 offen offset:3072 lds
bj_np2:
  v_xor_b32 v9, 64, v7
  ds_read_b64_tr_b16 v[192:193], v9 offset:0
  ds_read_b64_tr_b16 v[194:195], v9 offset:512
  ds_read_b64_tr_b16 v[196:197], v9 offset:4096
  ds_read_b64_tr_b16 v[198:199], v9 offset:4608
  ds_read_b64_tr_b16 v[200:201], v9 offset:8192
  ds_read_b64_tr_b16 v[202:203], v9 offset:8704
  ds_read_b64_tr_b16 v[204:205], v9 offset:12288
  ds_read_b64_tr_b16 v[206:207], v9 offset:12800
  s_waitcnt lgkmcnt(6)
  ds_read_b64_tr_b16 v[208:209], v9 offset:16384
  ds_read_b64_tr_b16 v[210:211], v9 offset:16896
  ds_read_b64_tr_b16 v[212:213], v9 offset:20480
  ds_read_b64_tr_b16 v[214:215], v9 offset:20992
  ds_read_b64_tr_b16 v[216:217], v9 offset:24576
  ds_read_b64_tr_b16 v[218:219], v9 offset:25088
  ds_read_b64_tr_b16 v[220:221], v9 offset:28672
  ds_read_b64_tr_b16 v[222:223], v9 offset:29184
  s_waitcnt lgkmcnt(6)
  s_cmp_eq_u32 s16, 3
  s_cbranch_scc1 bj_np3
  s_add_u32 m0, s51, 16384
  s_nop 0
  buffer_load_dwordx4 v28, s[60:63], s33 offen offset:0 lds
  buffer_load_dwordx4 v29, s[60:63], s33 offen offset:1024 lds
  buffer_load_dwordx4 v30, s[60:63], s33 offen offset:2048 lds
  buffer_load_dwordx4 v31, s[60:63], s33 offen offset:3072 lds
bj_np3:
  v_xor_b32 v9, 96, v7
  ds_read_b64_tr_b16 v[224:225], v9 offset:0
  ds_read_b64_tr_b16 v[226:227], v9 offset:512
  ds_read_b64_tr_b16 v[228:229], v9 offset:4096
  ds_read_b64_tr_b16 v[230:231], v9 offset:4608
  ds_read_b64_tr_b16 v[232:233], v9 offset:8192
  ds_read_b64_tr_b16 v[234:235], v9 offset:8704
  ds_read_b64_tr_b16 v[236:237], v9 offset:12288
  ds_read_b64_tr_b16 v[238:239], v9 offset:12800
  s_waitcnt lgkmcnt(6)
  ds_read_b64_tr_b16 v[240:241], v9 offset:16384
  ds_read_b64_tr_b16 v[242:243], v9 offset:16896
  ds_read_b64_tr_b16 v[244:245], v9 offset:20480
  ds_read_b64_tr_b16 v[246:247], v9 offset:20992
  ds_read_b64_tr_b16 v[248:249], v9 offset:24576
  ds_read_b64_tr_b16 v[250:251], v9 offset:25088
  ds_read_b64_tr_b16 v[252:253], v9 offset:28672
  ds_read_b64_tr_b16 v[254:255], v9 offset:29184
  s_waitcnt lgkmcnt(6)
  s_mov_b32 s52, s36
  s_and_b32 s53, s37, 0xffff
  s_mov_b32 s54, 1835008
  s_mov_b32 s55, 0x20000
  s_lshl_b32 s20, s18, 8
  v_add_u32 v95, s20, v0
  s_mov_b32 s21, 9586981
  v_mul_hi_u32 v6, v95, s21
  v_mul_u32_u24 v7, 448, v6
  v_sub_u32 v7, v95, v7
  v_lshrrev_b32 v8, 4, v7
  v_and_b32 v7, 15, v7
  v_lshl_add_u32 v9, v6, 4, v7
  v_mul_u32_u24 v9, 896, v9
  v_lshl_add_u32 v9, v8, 5, v9
  buffer_load_dwordx4 v[84:87], v9, s[52:55], 0 offen
  buffer_load_dwordx4 v[88:91], v9, s[52:55], 0 offen offset:16
  v_mul_u32_u24 v6, 14336, v6
  v_lshl_add_u32 v6, v7, 4, v6
  v_lshl_add_u32 v92, v8, 9, v6
  v_lshrrev_b32 v7, 2, v8
  v_lshl_add_u32 v6, v7, 11, v6
  v_and_b32 v7, 3, v8
  v_lshl_add_u32 v93, v7, 8, v6
  s_mov_b32 s72, s38
  s_and_b32 s73, s39, 0xffff
  s_mov_b32 s74, 7168
  s_mov_b32 s75, 0x20000
  v_min_u32 v6, 223, v0
  v_lshrrev_b32 v7, 3, v6
  v_and_b32 v6, 7, v6
  v_mul_u32_u24 v9, 896, v6
  v_lshl_add_u32 v9, v7, 5, v9
  buffer_load_dwordx4 v[36:39], v9, s[72:75], 0 offen
  buffer_load_dwordx4 v[40:43], v9, s[72:75], 0 offen offset:16
  v_lshlrev_b32 v7, 8, v7
  v_lshl_add_u32 v94, v6, 4, v7
  s_lshl_b32 s26, s17, 9
  s_waitcnt vmcnt(20) lgkmcnt(0)
  s_cmp_lg_u32 s16, 3
  s_cbranch_scc1 w3_20
  s_waitcnt vmcnt(4)
w3_20:
  ds_read_b128 v[52:55], v32 offset:0
  ds_read_b128 v[56:59], v33 offset:0
  ds_read_b128 v[60:63], v34 offset:0
  ds_read_b128 v[64:67], v35 offset:0
  s_waitcnt lgkmcnt(3)
  v_mfma_f32_16x16x32_bf16 v[96:99], v[52:55], v[128:131], 0
  v_mfma_f32_16x16x32_bf16 v[100:103], v[52:55], v[160:163], 0
  v_mfma_f32_16x16x32_bf16 v[104:107], v[52:55], v[192:195], 0
  v_mfma_f32_16x16x32_bf16 v[108:111], v[52:55], v[224:227], 0
  ds_read_b128 v[52:55], v32 offset:256
  s_waitcnt lgkmcnt(3)
  v_mfma_f32_16x16x32_bf16 v[96:99], v[56:59], v[132:135], v[96:99]
  v_mfma_f32_16x16x32_bf16 v[100:103], v[56:59], v[164:167], v[100:103]
  v_mfma_f32_16x16x32_bf16 v[104:107], v[56:59], v[196:199], v[104:107]
  v_mfma_f32_16x16x32_bf16 v[108:111], v[56:59], v[228:231], v[108:111]
  ds_read_b128 v[56:59], v33 offset:256
  s_waitcnt lgkmcnt(3)
  v_mfma_f32_16x16x32_bf16 v[96:99], v[60:63], v[136:139], v[96:99]
  v_mfma_f32_16x16x32_bf16 v[100:103], v[60:63], v[168:171], v[100:103]
  v_mfma_f32_16x16x32_bf16 v[104:107], v[60:63], v[200:203], v[104:107]
  v_mfma_f32_16x16x32_bf16 v[108:111], v[60:63], v[232:235], v[108:111]
  ds_read_b128 v[60:63], v34 offset:256
  s_waitcnt lgkmcnt(3)
  v_mfma_f32_16x16x32_bf16 v[96:99], v[64:67], v[140:143], v[96:99]
  v_mfma_f32_16x16x32_bf16 v[100:103], v[64:67], v[172:175], v[100:103]
  v_mfma_f32_16x16x32_bf16 v[104:107], v[64:67], v[204:207], v[104:107]
  v_mfma_f32_16x16x32_bf16 v[108:111], v[64:67], v[236:239], v[108:111]
  ds_read_b128 v[64:67], v35 offset:256
  s_waitcnt lgkmcnt(3)
  v_mfma_f32_16x16x32_bf16 v[96:99], v[52:55], v[144:147], v[96:99]
  v_mfma_f32_16x16x32_bf16 v[100:103], v[52:55], v[176:179], v[100:103]
  v_mfma_f32_16x16x32_bf16 v[104:107], v[52:55], v[208:211], v[104:107]
  v_mfma_f32_16x16x32_bf16 v[108:111], v[52:55], v[240:243], v[108:111]
  ds_read_b128 v[52:55], v32 offset:2048
  s_waitcnt lgkmcnt(3)
  v_mfma_f32_16x16x32_bf16 v[96:99], v[56:59], v[148:151], v[96:99]
  v_mfma_f32_16x16x32_bf16 v[100:103], v[56:59], v[180:183], v[100:103]
  v_mfma_f32_16x16x32_bf16 v[104:107], v[56:59], v[212:215], v[104:107]
  v_mfma_f32_16x16x32_bf16 v[108:111], v[56:59], v[244:247], v[108:111]
  ds_read_b128 v[56:59], v33 offset:2048
  s_waitcnt lgkmcnt(3)
  v_mfma_f32_16x16x32_bf16 v[96:99], v[60:63], v[152:155], v[96:99]
  v_mfma_f32_16x16x32_bf16 v[100:103], v[60:63], v[184:187], v[100:103]
  v_mfma_f32_16x16x32_bf16 v[104:107], v[60:63], v[216:219], v[104:107]
  v_mfma_f32_16x16x32_bf16 v[108:111], v[60:63], v[248:251], v[108:111]
  ds_read_b128 v[60:63], v34 offset:2048
  s_waitcnt lgkmcnt(3)
  v_mfma_f32_16x16x32_bf16 v[96:99], v[64:67], v[156:159], v[96:99]
  v_mfma_f32_16x16x32_bf16 v[100:103], v[64:67], v[188:191], v[100:103]
  v_mfma_f32_16x16x32_bf16 v[104:107], v[64:67], v[220:223], v[104:107]
  v_mfma_f32_16x16x32_bf16 v[108:111], v[64:67], v[252:255], v[108:111]
  ds_read_b128 v[64:67], v35 offset:2048
  s_waitcnt lgkmcnt(3)
  v_mfma_f32_16x16x32_bf16 v[112:115], v[52:55], v[128:131], 0
  v_mfma_f32_16x16x32_bf16 v[116:119], v[52:55], v[160:163], 0
  v_mfma_f32_16x16x32_bf16 v[120:123], v[52:55], v[192:195], 0
  v_mfma_f32_16x16x32_bf16 v[124:127], v[52:55], v[224:227], 0
  ds_read_b128 v[52:55], v32 offset:2304
  s_waitcnt lgkmcnt(3)
  v_mfma_f32_16x16x32_bf16 v[112:115], v[56:59], v[132:135], v[112:115]
  v_mfma_f32_16x16x32_bf16 v[116:119], v[56:59], v[164:167], v[116:119]
  v_mfma_f32_16x16x32_bf16 v[120:123], v[56:59], v[196:199], v[120:123]
  v_mfma_f32_16x16x32_bf16 v[124:127], v[56:59], v[228:231], v[124:127]
  ds_read_b128 v[56:59], v33 offset:2304
  s_waitcnt lgkmcnt(3)
  v_mfma_f32_16x16x32_bf16 v[112:115], v[60:63], v[136:139], v[112:115]
  v_mfma_f32_16x16x32_bf16 v[116:119], v[60:63], v[168:171], v[116:119]
  v_mfma_f32_16x16x32_bf16 v[120:123], v[60:63], v[200:203], v[120:123]
  v_mfma_f32_16x16x32_bf16 v[124:127], v[60:63], v[232:235], v[124:127]
  ds_read_b128 v[60:63], v34 offset:2304
  s_waitcnt lgkmcnt(3)
  v_mfma_f32_16x16x32_bf16 v[112:115], v[64:67], v[140:143], v[112:115]
  v_mfma_f32_16x16x32_bf16 v[116:119], v[64:67], v[172:175], v[116:119]
  v_mfma_f32_16x16x32_bf16 v[120:123], v[64:67], v[204:207], v[120:123]
  v_mfma_f32_16x16x32_bf16 v[124:127], v[64:67], v[236:239], v[124:127]
  ds_read_b128 v[64:67], v35 offset:2304
  s_waitcnt lgkmcnt(3)
  v_mfma_f32_16x16x32_bf16 v[112:115], v[52:55], v[144:147], v[112:115]
  v_mfma_f32_16x16x32_bf16 v[116:119], v[52:55], v[176:179], v[116:119]
  v_mfma_f32_16x16x32_bf16 v[120:123], v[52:55], v[208:211], v[120:123]
  v_mfma_f32_16x16x32_bf16 v[124:127], v[52:55], v[240:243], v[124:127]
  s_waitcnt lgkmcnt(2)
  v_mfma_f32_16x16x32_bf16 v[112:115], v[56:59], v[148:151], v[112:115]
  v_mfma_f32_16x16x32_bf16 v[116:119], v[56:59], v[180:183], v[116:119]
  v_mfma_f32_16x16x32_bf16 v[120:123], v[56:59], v[212:215], v[120:123]
  v_mfma_f32_16x16x32_bf16 v[124:127], v[56:59], v[244:247], v[124:127]
  s_waitcnt lgkmcnt(1)
  v_mfma_f32_16x16x32_bf16 v[112:115], v[60:63], v[152:155], v[112:115]
  v_mfma_f32_16x16x32_bf16 v[116:119], v[60:63], v[184:187], v[116:119]
  v_mfma_f32_16x16x32_bf16 v[120:123], v[60:63], v[216:219], v[120:123]
  v_mfma_f32_16x16x32_bf16 v[124:127], v[60:63], v[248:251], v[124:127]
  s_waitcnt lgkmcnt(0)
  v_mfma_f32_16x16x32_bf16 v[112:115], v[64:67], v[156:159], v[112:115]
  v_mfma_f32_16x16x32_bf16 v[116:119], v[64:67], v[188:191], v[116:119]
  v_mfma_f32_16x16x32_bf16 v[120:123], v[64:67], v[220:223], v[120:123]
  v_mfma_f32_16x16x32_bf16 v[124:127], v[64:67], v[252:255], v[124:127]
  s_lshl_b32 s30, s28, 10
  v_cvt_pk_bf16_f32 v68, v96, v97
  v_cvt_pk_bf16_f32 v69, v98, v99
  v_cvt_pk_bf16_f32 v70, v112, v113
  v_cvt_pk_bf16_f32 v71, v114, v115
  buffer_store_dwordx4 v[68:71], v12, s[8:11], s30 offen sc1
  v_cvt_pk_bf16_f32 v72, v100, v101
  v_cvt_pk_bf16_f32 v73, v102, v103
  v_cvt_pk_bf16_f32 v74, v116, v117
  v_cvt_pk_bf16_f32 v75, v118, v119
  buffer_store_dwordx4 v[72:75], v13, s[8:11], s30 offen sc1
  v_cvt_pk_bf16_f32 v76, v104, v105
  v_cvt_pk_bf16_f32 v77, v106, v107
  v_cvt_pk_bf16_f32 v78, v120, v121
  v_cvt_pk_bf16_f32 v79, v122, v123
  buffer_store_dwordx4 v[76:79], v14, s[8:11], s30 offen sc1
  v_cvt_pk_bf16_f32 v80, v108, v109
  v_cvt_pk_bf16_f32 v81, v110, v111
  v_cvt_pk_bf16_f32 v82, v124, v125
  v_cvt_pk_bf16_f32 v83, v126, v127
  buffer_store_dwordx4 v[80:83], v15, s[8:11], s30 offen sc1
  s_cmp_eq_u32 s16, 3
  s_cbranch_scc1 bj_w3
  s_waitcnt vmcnt(8)
  ds_read_b128 v[52:55], v32 offset:16384
  ds_read_b128 v[56:59], v33 offset:16384
  ds_read_b128 v[60:63], v34 offset:16384
  ds_read_b128 v[64:67], v35 offset:16384
  s_waitcnt lgkmcnt(3)
  v_mfma_f32_16x16x32_bf16 v[96:99], v[52:55], v[128:131], 0
  v_mfma_f32_16x16x32_bf16 v[100:103], v[52:55], v[160:163], 0
  v_mfma_f32_16x16x32_bf16 v[104:107], v[52:55], v[192:195], 0
  v_mfma_f32_16x16x32_bf16 v[108:111], v[52:55], v[224:227], 0
  ds_read_b128 v[52:55], v32 offset:16640
  s_waitcnt lgkmcnt(3)
  v_mfma_f32_16x16x32_bf16 v[96:99], v[56:59], v[132:135], v[96:99]
  v_mfma_f32_16x16x32_bf16 v[100:103], v[56:59], v[164:167], v[100:103]
  v_mfma_f32_16x16x32_bf16 v[104:107], v[56:59], v[196:199], v[104:107]
  v_mfma_f32_16x16x32_bf16 v[108:111], v[56:59], v[228:231], v[108:111]
  ds_read_b128 v[56:59], v33 offset:16640
  s_waitcnt lgkmcnt(3)
  v_mfma_f32_16x16x32_bf16 v[96:99], v[60:63], v[136:139], v[96:99]
  v_mfma_f32_16x16x32_bf16 v[100:103], v[60:63], v[168:171], v[100:103]
  v_mfma_f32_16x16x32_bf16 v[104:107], v[60:63], v[200:203], v[104:107]
  v_mfma_f32_16x16x32_bf16 v[108:111], v[60:63], v[232:235], v[108:111]
  ds_read_b128 v[60:63], v34 offset:16640
  s_waitcnt lgkmcnt(3)
  v_mfma_f32_16x16x32_bf16 v[96:99], v[64:67], v[140:143], v[96:99]
  v_mfma_f32_16x16x32_bf16 v[100:103], v[64:67], v[172:175], v[100:103]
  v_mfma_f32_16x16x32_bf16 v[104:107], v[64:67], v[204:207], v[104:107]
  v_mfma_f32_16x16x32_bf16 v[108:111], v[64:67], v[236:239], v[108:111]
  ds_read_b128 v[64:67], v35 offset:16640
  s_waitcnt lgkmcnt(3)
  v_mfma_f32_16x16x32_bf16 v[96:99], v[52:55], v[144:147], v[96:99]
  v_mfma_f32_16x16x32_bf16 v[100:103], v[52:55], v[176:179], v[100:103]
  v_mfma_f32_16x16x32_bf16 v[104:107], v[52:55], v[208:211], v[104:107]
  v_mfma_f32_16x16x32_bf16 v[108:111], v[52:55], v[240:243], v[108:111]
  ds_read_b128 v[52:55], v32 offset:18432
  s_waitcnt lgkmcnt(3)
  v_mfma_f32_16x16x32_bf16 v[96:99], v[56:59], v[148:151], v[96:99]
  v_mfma_f32_16x16x32_bf16 v[100:103], v[56:59], v[180:183], v[100:103]
  v_mfma_f32_16x16x32_bf16 v[104:107], v[56:59], v[212:215], v[104:107]
  v_mfma_f32_16x16x32_bf16 v[108:111], v[56:59], v[244:247], v[108:111]
  ds_read_b128 v[56:59], v33 offset:18432
  s_waitcnt lgkmcnt(3)
  v_mfma_f32_16x16x32_bf16 v[96:99], v[60:63], v[152:155], v[96:99]
  v_mfma_f32_16x16x32_bf16 v[100:103], v[60:63], v[184:187], v[100:103]
  v_mfma_f32_16x16x32_bf16 v[104:107], v[60:63], v[216:219], v[104:107]
  v_mfma_f32_16x16x32_bf16 v[108:111], v[60:63], v[248:251], v[108:111]
  ds_read_b128 v[60:63], v34 offset:18432
  s_waitcnt lgkmcnt(3)
  v_mfma_f32_16x16x32_bf16 v[96:99], v[64:67], v[156:159], v[96:99]
  v_mfma_f32_16x16x32_bf16 v[100:103], v[64:67], v[188:191], v[100:103]
  v_mfma_f32_16x16x32_bf16 v[104:107], v[64:67], v[220:223], v[104:107]
  v_mfma_f32_16x16x32_bf16 v[108:111], v[64:67], v[252:255], v[108:111]
  ds_read_b128 v[64:67], v35 offset:18432
  s_waitcnt lgkmcnt(3)
  v_mfma_f32_16x16x32_bf16 v[112:115], v[52:55], v[128:131], 0
  v_mfma_f32_16x16x32_bf16 v[116:119], v[52:55], v[160:163], 0
  v_mfma_f32_16x16x32_bf16 v[120:123], v[52:55], v[192:195], 0
  v_mfma_f32_16x16x32_bf16 v[124:127], v[52:55], v[224:227], 0
  ds_read_b128 v[52:55], v32 offset:18688
  s_waitcnt lgkmcnt(3)
  v_mfma_f32_16x16x32_bf16 v[112:115], v[56:59], v[132:135], v[112:115]
  v_mfma_f32_16x16x32_bf16 v[116:119], v[56:59], v[164:167], v[116:119]
  v_mfma_f32_16x16x32_bf16 v[120:123], v[56:59], v[196:199], v[120:123]
  v_mfma_f32_16x16x32_bf16 v[124:127], v[56:59], v[228:231], v[124:127]
  ds_read_b128 v[56:59], v33 offset:18688
  s_waitcnt lgkmcnt(3)
  v_mfma_f32_16x16x32_bf16 v[112:115], v[60:63], v[136:139], v[112:115]
  v_mfma_f32_16x16x32_bf16 v[116:119], v[60:63], v[168:171], v[116:119]
  v_mfma_f32_16x16x32_bf16 v[120:123], v[60:63], v[200:203], v[120:123]
  v_mfma_f32_16x16x32_bf16 v[124:127], v[60:63], v[232:235], v[124:127]
  ds_read_b128 v[60:63], v34 offset:18688
  s_waitcnt lgkmcnt(3)
  v_mfma_f32_16x16x32_bf16 v[112:115], v[64:67], v[140:143], v[112:115]
  v_mfma_f32_16x16x32_bf16 v[116:119], v[64:67], v[172:175], v[116:119]
  v_mfma_f32_16x16x32_bf16 v[120:123], v[64:67], v[204:207], v[120:123]
  v_mfma_f32_16x16x32_bf16 v[124:127], v[64:67], v[236:239], v[124:127]
  ds_read_b128 v[64:67], v35 offset:18688
  s_waitcnt lgkmcnt(3)
  v_mfma_f32_16x16x32_bf16 v[112:115], v[52:55], v[144:147], v[112:115]
  v_mfma_f32_16x16x32_bf16 v[116:119], v[52:55], v[176:179], v[116:119]
  v_mfma_f32_16x16x32_bf16 v[120:123], v[52:55], v[208:211], v[120:123]
  v_mfma_f32_16x16x32_bf16 v[124:127], v[52:55], v[240:243], v[124:127]
  s_waitcnt lgkmcnt(2)
  v_mfma_f32_16x16x32_bf16 v[112:115], v[56:59], v[148:151], v[112:115]
  v_mfma_f32_16x16x32_bf16 v[116:119], v[56:59], v[180:183], v[116:119]
  v_mfma_f32_16x16x32_bf16 v[120:123], v[56:59], v[212:215], v[120:123]
  v_mfma_f32_16x16x32_bf16 v[124:127], v[56:59], v[244:247], v[124:127]
  s_waitcnt lgkmcnt(1)
  v_mfma_f32_16x16x32_bf16 v[112:115], v[60:63], v[152:155], v[112:115]
  v_mfma_f32_16x16x32_bf16 v[116:119], v[60:63], v[184:187], v[116:119]
  v_mfma_f32_16x16x32_bf16 v[120:123], v[60:63], v[216:219], v[120:123]
  v_mfma_f32_16x16x32_bf16 v[124:127], v[60:63], v[248:251], v[124:127]
  s_waitcnt lgkmcnt(0)
  v_mfma_f32_16x16x32_bf16 v[112:115], v[64:67], v[156:159], v[112:115]
  v_mfma_f32_16x16x32_bf16 v[116:119], v[64:67], v[188:191], v[116:119]
  v_mfma_f32_16x16x32_bf16 v[120:123], v[64:67], v[220:223], v[120:123]
  v_mfma_f32_16x16x32_bf16 v[124:127], v[64:67], v[252:255], v[124:127]
  s_lshl_b32 s30, s29, 10
  v_cvt_pk_bf16_f32 v68, v96, v97
  v_cvt_pk_bf16_f32 v69, v98, v99
  v_cvt_pk_bf16_f32 v70, v112, v113
  v_cvt_pk_bf16_f32 v71, v114, v115
  buffer_store_dwordx4 v[68:71], v12, s[8:11], s30 offen sc1
  v_cvt_pk_bf16_f32 v72, v100, v101
  v_cvt_pk_bf16_f32 v73, v102, v103
  v_cvt_pk_bf16_f32 v74, v116, v117
  v_cvt_pk_bf16_f32 v75, v118, v119
  buffer_store_dwordx4 v[72:75], v13, s[8:11], s30 offen sc1
  v_cvt_pk_bf16_f32 v76, v104, v105
  v_cvt_pk_bf16_f32 v77, v106, v107
  v_cvt_pk_bf16_f32 v78, v120, v121
  v_cvt_pk_bf16_f32 v79, v122, v123
  buffer_store_dwordx4 v[76:79], v14, s[8:11], s30 offen sc1
  v_cvt_pk_bf16_f32 v80, v108, v109
  v_cvt_pk_bf16_f32 v81, v110, v111
  v_cvt_pk_bf16_f32 v82, v124, v125
  v_cvt_pk_bf16_f32 v83, v126, v127
  buffer_store_dwordx4 v[80:83], v15, s[8:11], s30 offen sc1
bj_w3:
  s_lshl_b32 s77, s19, 8
  s_lshl_b32 s21, s17, 4
  s_add_u32 s77, s77, s21
  s_cmp_lg_u32 s31, 0
  s_cselect_b32 s21, 8, 0
  s_add_u32 s77, s77, s21
  s_add_u32 s77, s77, 88600576
  s_add_u32 s78, s77, 2048
  s_cmp_lg_u32 s66, 0
  s_cbranch_scc1 bj_cf
  s_cmp_lg_u32 s16, 0
  s_cbranch_scc1 w0_21
  s_waitcnt vmcnt(8)
  v_readfirstlane_b32 s70, v46
  s_cmp_lg_u32 s70, 0
  s_cbranch_scc1 bj_nz
  v_mov_b32 v45, 128
  v_mov_b32 v46, s88
  v_mov_b32 v47, s89
  v_mov_b32 v48, 0
  v_mov_b32 v49, 0
  s_mov_b64 exec, 1
  buffer_atomic_cmpswap_x2 v[46:49], v45, s[12:15], 0 offen sc0
  s_mov_b64 exec, -1
  s_waitcnt vmcnt(0)
  v_readfirstlane_b32 s70, v46
  s_cmp_lg_u32 s70, 0
  s_cbranch_scc1 bj_nz
  v_mov_b32 v46, s88
  v_mov_b32 v47, s89
bj_nz:
w0_21:
  v_mov_b32 v45, 160000
  s_add_u32 s101, s101, 1
  s_barrier
  s_mov_b64 exec, 1
  s_cmp_lg_u32 s16, 0
  s_cbranch_scc1 w0_22
  ds_write_b32 v45, v44 offset:0
  ds_write_b32 v45, v46 offset:4
  ds_write_b32 v45, v47 offset:8
  s_waitcnt lgkmcnt(0)
  v_mov_b32 v44, s101
  ds_write_b32 v45, v44 offset:16
  s_waitcnt lgkmcnt(0)
w0_22:
  s_mov_b64 exec, -1
  s_barrier
  ds_read_b32 v44, v45 offset:0
  ds_read_b32 v46, v45 offset:4
  ds_read_b32 v47, v45 offset:8
  ds_read_b32 v45, v45 offset:16
  s_waitcnt lgkmcnt(0)
  v_readfirstlane_b32 s70, v44
  v_readfirstlane_b32 s88, v46
  v_readfirstlane_b32 s89, v47
  v_cmp_ne_u32 vcc, s101, v45
  s_cbranch_vccnz ch_end
  s_mov_b32 s66, 1
  s_bitcmp1_b32 s70, s3
  s_cbranch_scc1 m_reclaim
bj_cf:
  s_barrier
  s_mov_b32 s56, s40
  s_and_b32 s57, s41, 0xffff
  s_mov_b32 s58, 3670016
  s_mov_b32 s59, 0x20000
  s_mov_b32 s60, s42
  s_and_b32 s61, s43, 0xffff
  s_mov_b32 s62, 3670016
  s_mov_b32 s63, 0x20000
  s_add_u32 s28, s31, s19
  v_lshrrev_b32 v5, 5, v1
  v_and_b32 v6, 31, v1
  v_xor_b32 v6, v6, v5
  v_lshlrev_b32 v6, 4, v6
  v_lshl_add_u32 v6, v5, 13, v6
  s_lshl_b32 s20, s16, 6
  v_xor_b32 v7, s20, v6
  s_lshl_b32 s22, s28, 18
  s_lshl_b32 s21, s16, 16
  s_add_u32 s22, s22, s21
  s_add_u32 s22, s22, s26
  s_lshl_b32 m0, s16, 12
  v_xor_b32 v8, 0, v7
  buffer_load_dwordx4 v8, s[56:59], s22 offen offset:0 lds
  v_xor_b32 v8, 32, v7
  v_add_u32 v8, 15360, v8
  buffer_load_dwordx4 v8, s[56:59], s22 offen offset:1024 lds
  v_xor_b32 v8, 0, v7
  v_add_u32 v8, 30720, v8
  buffer_load_dwordx4 v8, s[56:59], s22 offen offset:2048 lds
  v_xor_b32 v8, 32, v7
  v_add_u32 v8, 46080, v8
  buffer_load_dwordx4 v8, s[56:59], s22 offen offset:3072 lds
  v_xor_b32 v16, 0, v6
  v_xor_b32 v17, 32, v6
  v_add_u32 v17, 31744, v17
  v_xor_b32 v18, 64, v6
  v_add_u32 v18, 129024, v18
  v_xor_b32 v19, 96, v6
  v_add_u32 v19, 160768, v19
  v_xor_b32 v20, 128, v6
  v_add_u32 v20, 262144, v20
  v_xor_b32 v21, 160, v6
  v_add_u32 v21, 293888, v21
  v_xor_b32 v22, 192, v6
  v_add_u32 v22, 391168, v22
  v_xor_b32 v23, 224, v6
  v_add_u32 v23, 422912, v23
  s_lshr_b32 s20, s16, 1
  s_lshl_b32 s20, s20, 16
  s_and_b32 s21, s16, 1
  s_lshl_b32 s21, s21, 14
  s_add_u32 s20, s20, s21
  s_add_u32 s29, s20, s26
  s_mul_i32 s25, s16, 24576
  s_add_u32 s25, s25, 16384
  s_add_u32 s22, s29, 2097152
  s_add_u32 m0, s25, 0
  s_nop 0
  buffer_load_dwordx4 v16, s[60:63], s22 offen offset:0 lds
  buffer_load_dwordx4 v17, s[60:63], s22 offen offset:1024 lds
  buffer_load_dwordx4 v18, s[60:63], s22 offen offset:2048 lds
  buffer_load_dwordx4 v19, s[60:63], s22 offen offset:3072 lds
  s_add_u32 m0, s25, 4096
  s_nop 0
  buffer_load_dwordx4 v20, s[60:63], s22 offen offset:0 lds
  buffer_load_dwordx4 v21, s[60:63], s22 offen offset:1024 lds
  buffer_load_dwordx4 v22, s[60:63], s22 offen offset:2048 lds
  buffer_load_dwordx4 v23, s[60:63], s22 offen offset:3072 lds
  s_waitcnt vmcnt(12)
  s_barrier
  s_cmp_lg_u32 s16, 0
  s_cbranch_scc1 pub_23
  v_mul_u32_u24 v50, 2048, v1
  v_mov_b32 v48, s88
  v_mov_b32 v49, s89
  s_mov_b64 exec, 1
  buffer_store_dwordx2 v[48:49], v50, s[8:11], s77 offen sc1
  s_mov_b64 exec, -1
pub_23:
  s_cmp_ge_u32 s18, 70
  s_cbranch_scc1 bk_nm
  s_mov_b32 s20, 71565312
  buffer_store_dwordx4 v[84:87], v92, s[8:11], s20 offen sc1
  buffer_store_dwordx4 v[88:91], v92, s[8:11], s20 offen offset:256 sc1
  s_cmp_lg_u32 s18, 0
  s_cbranch_scc1 bk_nm
  v_min_u32 v104, -2, v36
  v_min_u32 v108, -2, v37
  v_min_u32 v105, -2, v38
  v_min_u32 v109, -2, v39
  v_min_u32 v106, -2, v40
  v_min_u32 v110, -2, v41
  v_min_u32 v107, -2, v42
  v_min_u32 v111, -2, v43
  s_mov_b32 s20, 88653824
  s_mov_b32 s21, 88080384
  buffer_store_dwordx4 v[104:107], v94, s[8:11], s20 offen sc1
  buffer_store_dwordx4 v[108:111], v94, s[8:11], s20 offen offset:128 sc1
  buffer_store_dwordx4 v[104:107], v94, s[8:11], s21 offen sc1
  buffer_store_dwordx4 v[108:111], v94, s[8:11], s21 offen offset:128 sc1
bk_nm:
  s_mov_b32 s23, 88653824
  v_add_u32 v6, 448, v95
  v_subrev_u32 v7, 1152, v6
  v_mov_b32 v52, -1
  v_mov_b32 v9, 0
  v_cmp_gt_u32 vcc, 128, v7
  s_nop 1
  v_cndmask_b32 v52, v52, v9, vcc
  v_mov_b32 v53, v52
  v_mov_b32 v54, v52
  v_mov_b32 v55, v52
  v_lshlrev_b32 v8, 4, v6
  v_mov_b32 v9, 0x10000000
  v_cmp_lt_u32 vcc, 25599, v6
  s_nop 1
  v_cndmask_b32 v8, v8, v9, vcc
  buffer_store_dwordx4 v[52:55], v8, s[8:11], s23 offen sc1
  s_mov_b32 s23, 87957504
  v_add_u32 v6, 448, v95
  v_cmp_gt_u32 vcc, 7680, v95
  s_nop 1
  v_cndmask_b32 v6, v6, v95, vcc
  v_subrev_u32 v7, 36352, v6
  v_mov_b32 v56, -1
  v_mov_b32 v9, 0
  v_cmp_gt_u32 vcc, 1048576, v7
  s_nop 1
  v_cndmask_b32 v56, v56, v9, vcc
  v_mov_b32 v57, v56
  v_mov_b32 v58, v56
  v_mov_b32 v59, v56
  v_lshlrev_b32 v8, 4, v6
  v_mov_b32 v9, 0x10000000
  v_cmp_lt_u32 vcc, 40191, v6
  s_nop 1
  v_cndmask_b32 v8, v8, v9, vcc
  buffer_store_dwordx4 v[56:59], v8, s[8:11], s23 offen sc1
  s_add_u32 s22, s29, 2621440
  s_add_u32 m0, s25, 8192
  s_nop 0
  buffer_load_dwordx4 v16, s[60:63], s22 offen offset:0 lds
  buffer_load_dwordx4 v17, s[60:63], s22 offen offset:1024 lds
  buffer_load_dwordx4 v18, s[60:63], s22 offen offset:2048 lds
  buffer_load_dwordx4 v19, s[60:63], s22 offen offset:3072 lds
  s_add_u32 m0, s25, 12288
  s_nop 0
  buffer_load_dwordx4 v20, s[60:63], s22 offen offset:0 lds
  buffer_load_dwordx4 v21, s[60:63], s22 offen offset:1024 lds
  buffer_load_dwordx4 v22, s[60:63], s22 offen offset:2048 lds
  buffer_load_dwordx4 v23, s[60:63], s22 offen offset:3072 lds
  s_add_u32 s22, s29, 3145728
  s_add_u32 m0, s25, 16384
  s_nop 0
  buffer_load_dwordx4 v16, s[60:63], s22 offen offset:0 lds
  buffer_load_dwordx4 v17, s[60:63], s22 offen offset:1024 lds
  buffer_load_dwordx4 v18, s[60:63], s22 offen offset:2048 lds
  buffer_load_dwordx4 v19, s[60:63], s22 offen offset:3072 lds
  s_add_u32 m0, s25, 20480
  s_nop 0
  buffer_load_dwordx4 v20, s[60:63], s22 offen offset:0 lds
  buffer_load_dwordx4 v21, s[60:63], s22 offen offset:1024 lds
  buffer_load_dwordx4 v22, s[60:63], s22 offen offset:2048 lds
  buffer_load_dwordx4 v23, s[60:63], s22 offen offset:3072 lds
  v_mov_b32 v250, s68
  s_or_b32 s20, s69, s16
  s_cbranch_scc1 bj_ht
  s_cmp_lg_u32 s16, 0
  s_cbranch_scc1 w0_24
  v_mov_b32 v250, 1
  v_mov_b32 v251, 192
  s_mov_b64 exec, 1
  buffer_atomic_add v250, v251, s[12:15], 0 offen sc0
  s_mov_b64 exec, -1
w0_24:
  s_branch bj_h2
bj_ht:
  buffer_load_dword v251, off, s[8:11], s77
bj_h2:
  v_lshrrev_b32 v7, 2, v4
  v_lshlrev_b32 v7, 3, v7
  v_and_b32 v8, 3, v4
  v_add_u32 v7, v7, v8
  v_xor_b32 v10, v3, v4
  v_lshlrev_b32 v10, 4, v10
  v_lshl_add_u32 v11, v4, 9, v10
  v_add_u32 v11, s25, v11
  v_lshl_add_u32 v10, v7, 9, v10
  v_xor_b32 v32, 0, v10
  v_xor_b32 v36, 0, v11
  v_xor_b32 v33, 64, v10
  v_xor_b32 v37, 64, v11
  v_xor_b32 v34, 128, v10
  v_xor_b32 v38, 128, v11
  v_xor_b32 v35, 192, v10
  v_xor_b32 v39, 192, v11
  s_mul_i32 s30, s17, 401408
  s_mul_i32 s20, s16, 14336
  s_add_u32 s30, s30, s20
  s_lshl_b32 s20, s28, 10
  s_add_u32 s30, s30, s20
  s_mov_b32 s24, 1035512379
  s_lshl_b32 s20, s17, 7
  s_lshl_b32 s28, s28, 3
  s_add_u32 s28, s28, s20
  s_add_u32 s28, s28, 88635392
  s_waitcnt vmcnt(1)
  s_barrier
  s_cmp_lg_u32 s16, 0
  s_cbranch_scc1 w0_25
  v_mul_u32_u24 v50, 2048, v1
  v_mov_b32 v48, s88
  v_mov_b32 v49, s89
  s_mov_b64 exec, 511
  buffer_store_dwordx2 v[48:49], v50, s[8:11], s78 offen sc1
  s_mov_b64 exec, -1
w0_25:
  ds_read_b128 v[128:131], v32 offset:0
  ds_read_b128 v[132:135], v32 offset:2048
  ds_read_b128 v[136:139], v36 offset:0
  ds_read_b128 v[140:143], v36 offset:8192
  ds_read_b128 v[144:147], v36 offset:16384
  ds_read_b128 v[148:151], v33 offset:0
  ds_read_b128 v[152:155], v33 offset:2048
  ds_read_b128 v[156:159], v37 offset:0
  ds_read_b128 v[160:163], v37 offset:8192
  ds_read_b128 v[164:167], v37 offset:16384
  ds_read_b128 v[168:171], v34 offset:0
  ds_read_b128 v[172:175], v34 offset:2048
  ds_read_b128 v[176:179], v38 offset:0
  ds_read_b128 v[180:183], v38 offset:8192
  ds_read_b128 v[184:187], v38 offset:16384
  s_waitcnt lgkmcnt(10)
  v_mfma_f32_16x16x32_bf16 v[96:99], v[128:131], v[136:139], 0
  v_mfma_f32_16x16x32_bf16 v[100:103], v[132:135], v[136:139], 0
  v_mfma_f32_16x16x32_bf16 v[104:107], v[128:131], v[140:143], 0
  v_mfma_f32_16x16x32_bf16 v[108:111], v[132:135], v[140:143], 0
  v_mfma_f32_16x16x32_bf16 v[112:115], v[128:131], v[144:147], 0
  v_mfma_f32_16x16x32_bf16 v[116:119], v[132:135], v[144:147], 0
  ds_read_b128 v[128:131], v35 offset:0
  ds_read_b128 v[132:135], v35 offset:2048
  ds_read_b128 v[136:139], v39 offset:0
  ds_read_b128 v[140:143], v39 offset:8192
  ds_read_b128 v[144:147], v39 offset:16384
  s_waitcnt lgkmcnt(10)
  v_mfma_f32_16x16x32_bf16 v[96:99], v[148:151], v[156:159], v[96:99]
  v_mfma_f32_16x16x32_bf16 v[100:103], v[152:155], v[156:159], v[100:103]
  v_mfma_f32_16x16x32_bf16 v[104:107], v[148:151], v[160:163], v[104:107]
  v_mfma_f32_16x16x32_bf16 v[108:111], v[152:155], v[160:163], v[108:111]
  v_mfma_f32_16x16x32_bf16 v[112:115], v[148:151], v[164:167], v[112:115]
  v_mfma_f32_16x16x32_bf16 v[116:119], v[152:155], v[164:167], v[116:119]
  ds_read_b128 v[148:151], v32 offset:256
  ds_read_b128 v[152:155], v32 offset:2304
  ds_read_b128 v[156:159], v36 offset:256
  ds_read_b128 v[160:163], v36 offset:8448
  ds_read_b128 v[164:167], v36 offset:16640
  s_waitcnt lgkmcnt(10)
  v_mfma_f32_16x16x32_bf16 v[96:99], v[168:171], v[176:179], v[96:99]
  v_mfma_f32_16x16x32_bf16 v[100:103], v[172:175], v[176:179], v[100:103]
  v_mfma_f32_16x16x32_bf16 v[104:107], v[168:171], v[180:183], v[104:107]
  v_mfma_f32_16x16x32_bf16 v[108:111], v[172:175], v[180:183], v[108:111]
  v_mfma_f32_16x16x32_bf16 v[112:115], v[168:171], v[184:187], v[112:115]
  v_mfma_f32_16x16x32_bf16 v[116:119], v[172:175], v[184:187], v[116:119]
  ds_read_b128 v[168:171], v33 offset:256
  ds_read_b128 v[172:175], v33 offset:2304
  ds_read_b128 v[176:179], v37 offset:256
  ds_read_b128 v[180:183], v37 offset:8448
  ds_read_b128 v[184:187], v37 offset:16640
  s_waitcnt lgkmcnt(10)
  v_mfma_f32_16x16x32_bf16 v[96:99], v[128:131], v[136:139], v[96:99]
  v_mfma_f32_16x16x32_bf16 v[100:103], v[132:135], v[136:139], v[100:103]
  v_mfma_f32_16x16x32_bf16 v[104:107], v[128:131], v[140:143], v[104:107]
  v_mfma_f32_16x16x32_bf16 v[108:111], v[132:135], v[140:143], v[108:111]
  v_mfma_f32_16x16x32_bf16 v[112:115], v[128:131], v[144:147], v[112:115]
  v_mfma_f32_16x16x32_bf16 v[116:119], v[132:135], v[144:147], v[116:119]
  ds_read_b128 v[128:131], v34 offset:256
  ds_read_b128 v[132:135], v34 offset:2304
  ds_read_b128 v[136:139], v38 offset:256
  ds_read_b128 v[140:143], v38 offset:8448
  ds_read_b128 v[144:147], v38 offset:16640
  s_waitcnt lgkmcnt(10)
  v_mfma_f32_16x16x32_bf16 v[96:99], v[148:151], v[156:159], v[96:99]
  v_mfma_f32_16x16x32_bf16 v[100:103], v[152:155], v[156:159], v[100:103]
  v_mfma_f32_16x16x32_bf16 v[104:107], v[148:151], v[160:163], v[104:107]
  v_mfma_f32_16x16x32_bf16 v[108:111], v[152:155], v[160:163], v[108:111]
  v_mfma_f32_16x16x32_bf16 v[112:115], v[148:151], v[164:167], v[112:115]
  v_mfma_f32_16x16x32_bf16 v[116:119], v[152:155], v[164:167], v[116:119]
  ds_read_b128 v[148:151], v35 offset:256
  ds_read_b128 v[152:155], v35 offset:2304
  ds_read_b128 v[156:159], v39 offset:256
  ds_read_b128 v[160:163], v39 offset:8448
  ds_read_b128 v[164:167], v39 offset:16640
  s_waitcnt lgkmcnt(10)
  v_mfma_f32_16x16x32_bf16 v[96:99], v[168:171], v[176:179], v[96:99]
  v_mfma_f32_16x16x32_bf16 v[100:103], v[172:175], v[176:179], v[100:103]
  v_mfma_f32_16x16x32_bf16 v[104:107], v[168:171], v[180:183], v[104:107]
  v_mfma_f32_16x16x32_bf16 v[108:111], v[172:175], v[180:183], v[108:111]
  v_mfma_f32_16x16x32_bf16 v[112:115], v[168:171], v[184:187], v[112:115]
  v_mfma_f32_16x16x32_bf16 v[116:119], v[172:175], v[184:187], v[116:119]
  s_waitcnt lgkmcnt(5)
  v_mfma_f32_16x16x32_bf16 v[96:99], v[128:131], v[136:139], v[96:99]
  v_mfma_f32_16x16x32_bf16 v[100:103], v[132:135], v[136:139], v[100:103]
  v_mfma_f32_16x16x32_bf16 v[104:107], v[128:131], v[140:143], v[104:107]
  v_mfma_f32_16x16x32_bf16 v[108:111], v[132:135], v[140:143], v[108:111]
  v_mfma_f32_16x16x32_bf16 v[112:115], v[128:131], v[144:147], v[112:115]
  v_mfma_f32_16x16x32_bf16 v[116:119], v[132:135], v[144:147], v[116:119]
  s_waitcnt lgkmcnt(0)
  v_mfma_f32_16x16x32_bf16 v[96:99], v[148:151], v[156:159], v[96:99]
  v_mfma_f32_16x16x32_bf16 v[100:103], v[152:155], v[156:159], v[100:103]
  v_mfma_f32_16x16x32_bf16 v[104:107], v[148:151], v[160:163], v[104:107]
  v_mfma_f32_16x16x32_bf16 v[108:111], v[152:155], v[160:163], v[108:111]
  v_mfma_f32_16x16x32_bf16 v[112:115], v[148:151], v[164:167], v[112:115]
  v_mfma_f32_16x16x32_bf16 v[116:119], v[152:155], v[164:167], v[116:119]
  v_mul_f32 v96, s24, v96
  v_mul_f32 v97, s24, v97
  v_mul_f32 v98, s24, v98
  v_mul_f32 v99, s24, v99
  v_mul_f32 v100, s24, v100
  v_mul_f32 v101, s24, v101
  v_mul_f32 v102, s24, v102
  v_mul_f32 v103, s24, v103
  v_cvt_pk_bf16_f32 v68, v96, v97
  v_cvt_pk_bf16_f32 v69, v98, v99
  v_cvt_pk_bf16_f32 v70, v100, v101
  v_cvt_pk_bf16_f32 v71, v102, v103
  s_add_u32 s20, s30, 229376
  buffer_store_dwordx4 v[68:71], v2, s[8:11], s20 offen sc1
  v_mul_f32 v104, s24, v104
  v_mul_f32 v105, s24, v105
  v_mul_f32 v106, s24, v106
  v_mul_f32 v107, s24, v107
  v_mul_f32 v108, s24, v108
  v_mul_f32 v109, s24, v109
  v_mul_f32 v110, s24, v110
  v_mul_f32 v111, s24, v111
  v_cvt_pk_bf16_f32 v72, v104, v105
  v_cvt_pk_bf16_f32 v73, v106, v107
  v_cvt_pk_bf16_f32 v74, v108, v109
  v_cvt_pk_bf16_f32 v75, v110, v111
  s_add_u32 s20, s30, 286720
  buffer_store_dwordx4 v[72:75], v2, s[8:11], s20 offen sc1
  v_mul_f32 v112, s24, v112
  v_mul_f32 v113, s24, v113
  v_mul_f32 v114, s24, v114
  v_mul_f32 v115, s24, v115
  v_mul_f32 v116, s24, v116
  v_mul_f32 v117, s24, v117
  v_mul_f32 v118, s24, v118
  v_mul_f32 v119, s24, v119
  v_cvt_pk_bf16_f32 v76, v112, v113
  v_cvt_pk_bf16_f32 v77, v114, v115
  v_cvt_pk_bf16_f32 v78, v116, v117
  v_cvt_pk_bf16_f32 v79, v118, v119
  s_add_u32 s20, s30, 344064
  buffer_store_dwordx4 v[76:79], v2, s[8:11], s20 offen sc1
  s_waitcnt vmcnt(0)
  s_barrier
  s_cmp_lg_u32 s16, 0
  s_cbranch_scc1 pub_26
  v_mul_u32_u24 v26, 2048, v1
  v_mov_b32 v24, s88
  v_mov_b32 v25, s89
  s_mov_b64 exec, 1
  buffer_store_dwordx2 v[24:25], v26, s[8:11], s28 offen sc1
  s_mov_b64 exec, -1
pub_26:
  v_mov_b32 v6, 160000
  s_add_u32 s101, s101, 1
  s_barrier
  s_mov_b64 exec, 1
  s_cmp_lg_u32 s16, 0
  s_cbranch_scc1 w0_27
  ds_write_b32 v6, v250 offset:0
  s_waitcnt lgkmcnt(0)
  v_mov_b32 v250, s101
  ds_write_b32 v6, v250 offset:16
  s_waitcnt lgkmcnt(0)
w0_27:
  s_mov_b64 exec, -1
  s_barrier
  ds_read_b32 v250, v6 offset:0
  ds_read_b32 v6, v6 offset:16
  s_waitcnt lgkmcnt(0)
  v_readfirstlane_b32 s3, v250
  v_cmp_ne_u32 vcc, s101, v6
  s_cbranch_vccnz ch_end
  s_branch wk_have
wk_loop:
  s_waitcnt vmcnt(0) lgkmcnt(0)
  s_cmp_eq_u32 s96, 1
  s_cbranch_scc1 wk_ask
  s_mov_b32 s96, 1
  s_cmp_lg_u32 s16, 0
  s_cbranch_scc1 w0_28
  s_mov_b32 s30, 0
  v_mov_b32 v243, 32
sf_l:
  buffer_load_dword v242, v243, s[12:15], 0 offen sc1
  s_waitcnt vmcnt(0)
  v_readfirstlane_b32 s70, v242
  s_cmp_eq_u32 s70, -1
  s_cbranch_scc1 sf_d
  s_sleep 16
  s_add_u32 s30, s30, 1
  s_cmp_lt_u32 s30, 64
  s_cbranch_scc1 sf_l
  s_mov_b32 s20, 0
  s_mov_b32 s21, 0
  s_mov_b64 exec, 1
sf_c_l:
  s_cmp_lg_u32 s70, -1
  s_cbranch_scc1 sf_c_t
  s_add_u32 s20, s20, 1
  s_cmp_lt_u32 s20, 8
  s_cselect_b32 s20, s20, 0
  s_mov_b32 s70, 0
  s_mov_b32 s3, -1
  s_add_u32 s21, s21, 1
  s_cmp_ge_u32 s21, 1
  s_cbranch_scc1 sf_c_d
sf_c_t:
  s_ff0_i32_b32 s22, s70
  s_lshl_b32 s23, 1, s22
  s_and_b32 s71, s20, 4
  s_mul_i32 s71, s71, 12
  s_lshl_b32 s3, s20, 2
  s_add_u32 s3, s3, s71
  v_mov_b32 v242, s23
  v_mov_b32 v243, 32
  buffer_atomic_or v242, v243, s[12:15], s3 offen sc0
  s_waitcnt vmcnt(0)
  v_readfirstlane_b32 s70, v242
  s_lshl_b32 s3, s20, 5
  s_add_u32 s3, s3, s22
  s_bitcmp1_b32 s70, s22
  s_cbranch_scc1 sf_c_l
sf_c_d:
  s_mov_b64 exec, -1
  v_mov_b32 v242, s3
sf_d:
w0_28:
  v_mov_b32 v243, 160000
  s_add_u32 s101, s101, 1
  s_barrier
  s_mov_b64 exec, 1
  s_cmp_lg_u32 s16, 0
  s_cbranch_scc1 w0_29
  ds_write_b32 v243, v242 offset:0
  s_waitcnt lgkmcnt(0)
  v_mov_b32 v242, s101
  ds_write_b32 v243, v242 offset:16
  s_waitcnt lgkmcnt(0)
w0_29:
  s_mov_b64 exec, -1
  s_barrier
  ds_read_b32 v242, v243 offset:0
  ds_read_b32 v243, v243 offset:16
  s_waitcnt lgkmcnt(0)
  v_readfirstlane_b32 s3, v242
  v_cmp_ne_u32 vcc, s101, v243
  s_cbranch_vccnz ch_end
  s_cmp_eq_u32 s3, -1
  s_cbranch_scc1 wk_ask
  s_load_dwordx8 s[36:43], s[0:1], 56
  s_load_dwordx4 s[44:47], s[0:1], 88
  s_getreg_b32 s67, hwreg(HW_REG_XCC_ID)
  s_and_b32 s67, s67, 7
  s_mov_b32 s66, 1
  s_waitcnt lgkmcnt(0)
  s_branch m_start
wk_ask:
  v_readfirstlane_b32 s22, v250
  s_cmp_ge_u32 s22, 1440
  s_cbranch_scc1 wk_next
  s_cmp_lg_u32 s16, 0
  s_cbranch_scc1 w0_30
  v_mov_b32 v250, 1
  v_mov_b32 v251, 192
  s_mov_b64 exec, 1
  buffer_atomic_add v250, v251, s[12:15], 0 offen sc0
  s_mov_b64 exec, -1
w0_30:
wk_next:
  s_waitcnt vmcnt(0)
  v_mov_b32 v6, 160000
  s_add_u32 s101, s101, 1
  s_barrier
  s_mov_b64 exec, 1
  s_cmp_lg_u32 s16, 0
  s_cbranch_scc1 w0_31
  ds_write_b32 v6, v250 offset:0
  s_waitcnt lgkmcnt(0)
  v_mov_b32 v250, s101
  ds_write_b32 v6, v250 offset:16
  s_waitcnt lgkmcnt(0)
w0_31:
  s_mov_b64 exec, -1
  s_barrier
  ds_read_b32 v250, v6 offset:0
  ds_read_b32 v6, v6 offset:16
  s_waitcnt lgkmcnt(0)
  v_readfirstlane_b32 s3, v250
  v_cmp_ne_u32 vcc, s101, v6
  s_cbranch_vccnz ch_end
wk_have:
  s_cmp_ge_u32 s3, 1440
  s_cbranch_scc1 ch_end
  v_mov_b32 v250, 0
  v_mov_b32 v251, 192
  v_and_b32 v1, 63, v0
  v_lshlrev_b32 v2, 4, v1
  v_lshrrev_b32 v3, 4, v1
  v_and_b32 v4, 15, v1
  s_cmp_lg_u32 s97, 0
  s_cbranch_scc1 wk_go
  s_mov_b32 s68, s3
  s_mov_b32 s69, 1
  s_cmp_lg_u32 s16, 0
  s_cbranch_scc1 w0_32
  s_add_u32 s20, s67, 1
  s_lshl_b32 s22, s20, 11
  s_add_u32 s22, s22, 88602624
  v_add_u32 v24, 1024, v2
  v_min_u32 v24, 1776, v24
  s_mov_b32 s30, 0
wk_af:
  buffer_load_dwordx4 v[28:31], v2, s[8:11], s22 offen sc1
  buffer_load_dwordx4 v[32:35], v24, s[8:11], s22 offen sc1
  s_waitcnt vmcnt(0)
  v_cmp_ne_u64 vcc, s[88:89], v[28:29]
  s_cbranch_vccnz wk_af_no
  v_cmp_ne_u64 vcc, s[88:89], v[30:31]
  s_cbranch_vccnz wk_af_no
  v_cmp_ne_u64 vcc, s[88:89], v[32:33]
  s_cbranch_vccnz wk_af_no
  v_cmp_ne_u64 vcc, s[88:89], v[34:35]
  s_cbranch_vccnz wk_af_no
  s_branch wk_af_ok
wk_af_no:
  s_sleep 4
  s_add_u32 s30, s30, 1
  s_and_b32 s20, s30, 63
  s_cbranch_scc1 wk_ns
  s_mov_b32 s20, 1
  s_mov_b32 s70, 0
  s_mov_b32 s21, 0
  s_mov_b64 exec, 1
wk_st_l:
  s_cmp_lg_u32 s70, -1
  s_cbranch_scc1 wk_st_t
  s_add_u32 s20, s20, 1
  s_cmp_lt_u32 s20, 8
  s_cselect_b32 s20, s20, 1
  s_mov_b32 s70, 0
  s_mov_b32 s3, -1
  s_add_u32 s21, s21, 1
  s_cmp_ge_u32 s21, 7
  s_cbranch_scc1 wk_st_d
wk_st_t:
  s_ff0_i32_b32 s22, s70
  s_lshl_b32 s23, 1, s22
  s_and_b32 s71, s20, 4
  s_mul_i32 s71, s71, 12
  s_lshl_b32 s3, s20, 2
  s_add_u32 s3, s3, s71
  v_mov_b32 v242, s23
  v_mov_b32 v243, 32
  buffer_atomic_or v242, v243, s[12:15], s3 offen sc0
  s_waitcnt vmcnt(0)
  v_readfirstlane_b32 s70, v242
  s_lshl_b32 s3, s20, 5
  s_add_u32 s3, s3, s22
  s_bitcmp1_b32 s70, s22
  s_cbranch_scc1 wk_st_l
wk_st_d:
  s_mov_b64 exec, -1
  v_mov_b32 v242, s3
  s_cmp_lg_u32 s3, -1
  s_cbranch_scc1 wk_pd
  s_add_u32 s20, s67, 1
  s_lshl_b32 s22, s20, 11
  s_add_u32 s22, s22, 88602624
wk_ns:
  s_cmp_lt_u32 s30, 50000
  s_cbranch_scc1 wk_af
  s_branch cA_abort
wk_af_ok:
  v_mov_b32 v242, -1
wk_pd:
w0_32:
  v_mov_b32 v243, 160000
  s_add_u32 s101, s101, 1
  s_barrier
  s_mov_b64 exec, 1
  s_cmp_lg_u32 s16, 0
  s_cbranch_scc1 w0_33
  ds_write_b32 v243, v242 offset:0
  s_waitcnt lgkmcnt(0)
  v_mov_b32 v242, s101
  ds_write_b32 v243, v242 offset:16
  s_waitcnt lgkmcnt(0)
w0_33:
  s_mov_b64 exec, -1
  s_barrier
  ds_read_b32 v242, v243 offset:0
  ds_read_b32 v243, v243 offset:16
  s_waitcnt lgkmcnt(0)
  v_readfirstlane_b32 s3, v242
  v_cmp_ne_u32 vcc, s101, v243
  s_cbranch_vccnz ch_end
  s_cmp_lg_u32 s3, -1
  s_cbranch_scc1 m_bjob
  s_mov_b32 s3, s68
  s_mov_b32 s97, 1
wk_go:
  s_cmp_lt_u32 s3, 368
  s_cbranch_scc1 wk_g2
  s_sub_u32 s20, s3, 432
  s_cmp_lt_u32 s20, 128
  s_cbranch_scc1 wk_g2
  s_cmp_eq_u32 s97, 2
  s_cbranch_scc1 wk_g2
  s_getreg_b32 s20, hwreg(HW_REG_XCC_ID)
  s_and_b32 s20, s20, 7
  s_cmp_lg_u32 s16, 0
  s_cbranch_scc1 w0_34
  s_lshl_b32 s22, s20, 11
  s_add_u32 s22, s22, 88637440
  v_add_u32 v24, 1024, v2
  v_min_u32 v24, 1776, v24
  s_mov_b32 s30, 0
wk_i2:
  buffer_load_dwordx4 v[28:31], v2, s[8:11], s22 offen sc1
  buffer_load_dwordx4 v[32:35], v24, s[8:11], s22 offen sc1
  s_waitcnt vmcnt(0)
  v_cmp_ne_u64 vcc, s[88:89], v[28:29]
  s_cbranch_vccnz wk_i2_no
  v_cmp_ne_u64 vcc, s[88:89], v[30:31]
  s_cbranch_vccnz wk_i2_no
  v_cmp_ne_u64 vcc, s[88:89], v[32:33]
  s_cbranch_vccnz wk_i2_no
  v_cmp_ne_u64 vcc, s[88:89], v[34:35]
  s_cbranch_vccnz wk_i2_no
  s_branch wk_i2_ok
wk_i2_no:
  s_sleep 4
  s_add_u32 s30, s30, 1
  s_cmp_lt_u32 s30, 50000
  s_cbranch_scc1 wk_i2
  s_branch cA_abort
wk_i2_ok:
w0_34:
  v_mov_b32 v242, 0
  v_mov_b32 v243, 160000
  s_add_u32 s101, s101, 1
  s_barrier
  s_mov_b64 exec, 1
  s_cmp_lg_u32 s16, 0
  s_cbranch_scc1 w0_35
  ds_write_b32 v243, v242 offset:0
  s_waitcnt lgkmcnt(0)
  v_mov_b32 v242, s101
  ds_write_b32 v243, v242 offset:16
  s_waitcnt lgkmcnt(0)
w0_35:
  s_mov_b64 exec, -1
  s_barrier
  ds_read_b32 v242, v243 offset:0
  ds_read_b32 v243, v243 offset:16
  s_waitcnt lgkmcnt(0)
  v_readfirstlane_b32 s20, v242
  v_cmp_ne_u32 vcc, s101, v243
  s_cbranch_vccnz ch_end
  s_mov_b32 s97, 2
wk_g2:
  s_cmp_ge_u32 s3, 864
  s_cbranch_scc1 wk_tok
  s_cmp_ge_u32 s3, 752
  s_cbranch_scc1 wk_s4d
  s_cmp_ge_u32 s3, 624
  s_cbranch_scc1 wk_f
  s_cmp_ge_u32 s3, 560
  s_cbranch_scc1 wk_vf
  s_cmp_ge_u32 s3, 432
  s_cbranch_scc1 wk_a
  s_cmp_ge_u32 s3, 368
  s_cbranch_scc1 wk_vh
  s_cmp_ge_u32 s3, 256
  s_cbranch_scc1 wk_v7
  s_cmp_ge_u32 s3, 224
  s_cbranch_scc1 wk_srv
  s_sub_u32 s20, s3, 0
  s_cmp_ge_u32 s20, 112
  s_cselect_b32 s18, 1, 0
  s_cselect_b32 s21, 112, 0
  s_sub_u32 s20, s20, s21
  s_and_b32 s17, s20, 15
  s_add_u32 s17, s17, 16
  s_lshr_b32 s34, s20, 4
  s_lshl_b32 s34, s34, 1
  s_add_u32 s35, s34, 2
  s_cmp_eq_u32 s18, 0
  s_cbranch_scc1 wf_nw
  s_and_b32 s20, s3, 3
  s_lshl_b32 s20, s20, 3
  s_add_u32 s20, s20, 8
  s_cmp_eq_u32 s16, 0
  s_cselect_b32 s20, 0, s20
  s_cmp_ge_u32 s16, 2
  s_cselect_b32 s20, 112, s20
  s_load_dwordx2 s[72:73], s[0:1], s20
  s_lshr_b32 s21, s3, 2
  s_lshl_b32 s21, s21, 12
  s_mov_b32 s74, 229376
  s_lshl_b32 s22, s3, 13
  s_cmp_eq_u32 s16, 0
  s_cselect_b32 s21, s22, s21
  s_cselect_b32 s74, 1835008, s74
  s_lshl_b32 s22, s3, 1
  s_add_u32 s22, s22, s16
  s_sub_u32 s22, s22, 2
  s_lshl_b32 s22, s22, 13
  s_cmp_ge_u32 s16, 2
  s_cselect_b32 s21, s22, s21
  s_cselect_b32 s74, 3670016, s74
  v_lshlrev_b32 v6, 3, v2
  s_cmp_lt_u32 s16, 2
  s_cbranch_scc1 lw_36
  s_lshl_b32 s21, s3, 6
  v_add_u32 v6, s21, v1
  v_mul_u32_u24 v7, 37450, v6
  v_lshrrev_b32 v7, 18, v7
  v_add_u32 v7, 1, v7
  v_mul_u32_u24 v7, 7, v7
  v_add_u32 v6, v6, v7
  v_lshlrev_b32 v6, 7, v6
  s_mov_b32 s21, 0
  s_cmp_eq_u32 s16, 3
  s_cselect_b32 s74, 0, s74
lw_36:
  s_cmp_eq_u32 s16, 1
  s_cselect_b32 exec_hi, 0, -1
  s_waitcnt lgkmcnt(0)
  s_and_b32 s73, s73, 0xffff
  s_mov_b32 s75, 0x20000
  buffer_load_dword v7, v6, s[72:75], s21 offen
  s_mov_b64 exec, -1
  s_sub_u32 s3, s3, 112
  s_and_b32 s20, s3, 3
  s_lshl_b32 s20, s20, 3
  s_add_u32 s20, s20, 8
  s_cmp_eq_u32 s16, 0
  s_cselect_b32 s20, 0, s20
  s_cmp_ge_u32 s16, 2
  s_cselect_b32 s20, 112, s20
  s_load_dwordx2 s[72:73], s[0:1], s20
  s_lshr_b32 s21, s3, 2
  s_lshl_b32 s21, s21, 12
  s_mov_b32 s74, 229376
  s_lshl_b32 s22, s3, 13
  s_cmp_eq_u32 s16, 0
  s_cselect_b32 s21, s22, s21
  s_cselect_b32 s74, 1835008, s74
  s_lshl_b32 s22, s3, 1
  s_add_u32 s22, s22, s16
  s_sub_u32 s22, s22, 2
  s_lshl_b32 s22, s22, 13
  s_cmp_ge_u32 s16, 2
  s_cselect_b32 s21, s22, s21
  s_cselect_b32 s74, 3670016, s74
  v_lshlrev_b32 v6, 3, v2
  s_cmp_lt_u32 s16, 2
  s_cbranch_scc1 lw_37
  s_lshl_b32 s21, s3, 6
  v_add_u32 v6, s21, v1
  v_mul_u32_u24 v7, 37450, v6
  v_lshrrev_b32 v7, 18, v7
  v_add_u32 v7, 1, v7
  v_mul_u32_u24 v7, 7, v7
  v_add_u32 v6, v6, v7
  v_lshlrev_b32 v6, 7, v6
  s_mov_b32 s21, 0
  s_cmp_eq_u32 s16, 3
  s_cselect_b32 s74, 0, s74
lw_37:
  s_cmp_eq_u32 s16, 1
  s_cselect_b32 exec_hi, 0, -1
  s_waitcnt lgkmcnt(0)
  s_and_b32 s73, s73, 0xffff
  s_mov_b32 s75, 0x20000
  buffer_load_dword v7, v6, s[72:75], s21 offen
  s_mov_b64 exec, -1
  s_add_u32 s3, s3, 112
wf_nw:
  s_lshl_b32 s20, s18, 3
  s_lshl_b32 s21, s16, 1
  s_add_u32 s20, s20, s21
  s_mul_i32 s21, s20, 14336
  s_add_u32 s21, s21, 71565312
  s_add_u32 s22, s21, 0
  buffer_load_dwordx4 a[0:3], v2, s[8:11], s22 offen offset:0 sc1
  buffer_load_dwordx4 a[4:7], v2, s[8:11], s22 offen offset:1024 sc1
  buffer_load_dwordx4 a[8:11], v2, s[8:11], s22 offen offset:2048 sc1
  buffer_load_dwordx4 a[12:15], v2, s[8:11], s22 offen offset:3072 sc1
  s_add_u32 s22, s21, 4096
  buffer_load_dwordx4 a[16:19], v2, s[8:11], s22 offen offset:0 sc1
  buffer_load_dwordx4 a[20:23], v2, s[8:11], s22 offen offset:1024 sc1
  buffer_load_dwordx4 a[24:27], v2, s[8:11], s22 offen offset:2048 sc1
  buffer_load_dwordx4 a[28:31], v2, s[8:11], s22 offen offset:3072 sc1
  s_add_u32 s22, s21, 8192
  buffer_load_dwordx4 a[32:35], v2, s[8:11], s22 offen offset:0 sc1
  buffer_load_dwordx4 a[36:39], v2, s[8:11], s22 offen offset:1024 sc1
  buffer_load_dwordx4 a[40:43], v2, s[8:11], s22 offen offset:2048 sc1
  buffer_load_dwordx4 a[44:47], v2, s[8:11], s22 offen offset:3072 sc1
  s_add_u32 s22, s21, 12288
  buffer_load_dwordx4 a[48:51], v2, s[8:11], s22 offen offset:0 sc1
  buffer_load_dwordx4 a[52:55], v2, s[8:11], s22 offen offset:1024 sc1
  buffer_load_dwordx4 a[56:59], v2, s[8:11], s22 offen offset:2048 sc1
  buffer_load_dwordx4 a[60:63], v2, s[8:11], s22 offen offset:3072 sc1
  s_add_u32 s22, s21, 16384
  buffer_load_dwordx4 a[64:67], v2, s[8:11], s22 offen offset:0 sc1
  buffer_load_dwordx4 a[68:71], v2, s[8:11], s22 offen offset:1024 sc1
  buffer_load_dwordx4 a[72:75], v2, s[8:11], s22 offen offset:2048 sc1
  buffer_load_dwordx4 a[76:79], v2, s[8:11], s22 offen offset:3072 sc1
  s_add_u32 s22, s21, 20480
  buffer_load_dwordx4 a[80:83], v2, s[8:11], s22 offen offset:0 sc1
  buffer_load_dwordx4 a[84:87], v2, s[8:11], s22 offen offset:1024 sc1
  buffer_load_dwordx4 a[88:91], v2, s[8:11], s22 offen offset:2048 sc1
  buffer_load_dwordx4 a[92:95], v2, s[8:11], s22 offen offset:3072 sc1
  s_add_u32 s22, s21, 24576
  buffer_load_dwordx4 a[96:99], v2, s[8:11], s22 offen offset:0 sc1
  buffer_load_dwordx4 a[100:103], v2, s[8:11], s22 offen offset:1024 sc1
  buffer_load_dwordx4 a[104:107], v2, s[8:11], s22 offen offset:2048 sc1
  buffer_load_dwordx4 a[108:111], v2, s[8:11], s22 offen offset:3072 sc1
  s_waitcnt vmcnt(40)
  s_mul_i32 s23, s17, 401408
  s_and_b32 s22, s16, 1
  s_mul_i32 s22, s22, 7168
  s_add_u32 s23, s23, s22
  s_add_u32 s23, s23, 0
  s_lshr_b32 s22, s16, 1
  s_mul_i32 s22, s22, 14336
  s_add_u32 s23, s23, s22
  s_mul_i32 s27, s16, 7168
  s_lshr_b32 s28, s20, 1
wf_vo:
  s_sub_u32 s29, s17, 16
  s_lshl_b32 s29, s29, 6
  s_add_u32 s29, s29, s28
  s_mul_i32 s29, s29, 28672
  s_add_u32 s29, s29, 42205184
  v_mul_u32_u24 v6, 28, v3
  s_mov_b32 s31, 0
  s_lshl_b32 s24, s34, 1
  s_mul_i32 s24, s24, 14336
  s_add_u32 s24, s24, s23
  s_cmp_lt_u32 s34, s35
  s_cselect_b32 s24, s24, 0x10000000
  s_add_u32 m0, s31, s27
  s_nop 0
  buffer_load_dwordx4 v2, s[8:11], s24 offen offset:0 sc1 lds
  buffer_load_dwordx4 v2, s[8:11], s24 offen offset:1024 sc1 lds
  buffer_load_dwordx4 v2, s[8:11], s24 offen offset:2048 sc1 lds
  buffer_load_dwordx4 v2, s[8:11], s24 offen offset:3072 sc1 lds
  s_add_u32 m0, m0, 4096
  s_add_u32 s24, s24, 4096
  buffer_load_dwordx4 v2, s[8:11], s24 offen offset:0 sc1 lds
  buffer_load_dwordx4 v2, s[8:11], s24 offen offset:1024 sc1 lds
  buffer_load_dwordx4 v2, s[8:11], s24 offen offset:2048 sc1 lds
  s_add_u32 s30, s34, 1
  s_mov_b32 s31, 28672
  s_lshl_b32 s24, s30, 1
  s_mul_i32 s24, s24, 14336
  s_add_u32 s24, s24, s23
  s_cmp_lt_u32 s30, s35
  s_cselect_b32 s24, s24, 0x10000000
  s_add_u32 m0, s31, s27
  s_nop 0
  buffer_load_dwordx4 v2, s[8:11], s24 offen offset:0 sc1 lds
  buffer_load_dwordx4 v2, s[8:11], s24 offen offset:1024 sc1 lds
  buffer_load_dwordx4 v2, s[8:11], s24 offen offset:2048 sc1 lds
  buffer_load_dwordx4 v2, s[8:11], s24 offen offset:3072 sc1 lds
  s_add_u32 m0, m0, 4096
  s_add_u32 s24, s24, 4096
  buffer_load_dwordx4 v2, s[8:11], s24 offen offset:0 sc1 lds
  buffer_load_dwordx4 v2, s[8:11], s24 offen offset:1024 sc1 lds
  buffer_load_dwordx4 v2, s[8:11], s24 offen offset:2048 sc1 lds
  s_mov_b32 s19, s34
  s_mov_b32 s32, 0
  s_mov_b32 s33, 57344
  s_waitcnt vmcnt(7)
  s_branch wf_vo_in
wf_vo_loop:
  s_waitcnt vmcnt(9)
wf_vo_in:
  s_barrier
  s_add_u32 s30, s19, 2
  s_lshl_b32 s24, s30, 1
  s_mul_i32 s24, s24, 14336
  s_add_u32 s24, s24, s23
  s_cmp_lt_u32 s30, s35
  s_cselect_b32 s24, s24, 0x10000000
  s_add_u32 m0, s33, s27
  s_nop 0
  buffer_load_dwordx4 v2, s[8:11], s24 offen offset:0 sc1 lds
  buffer_load_dwordx4 v2, s[8:11], s24 offen offset:1024 sc1 lds
  buffer_load_dwordx4 v2, s[8:11], s24 offen offset:2048 sc1 lds
  buffer_load_dwordx4 v2, s[8:11], s24 offen offset:3072 sc1 lds
  s_add_u32 m0, m0, 4096
  s_add_u32 s24, s24, 4096
  buffer_load_dwordx4 v2, s[8:11], s24 offen offset:0 sc1 lds
  buffer_load_dwordx4 v2, s[8:11], s24 offen offset:1024 sc1 lds
  buffer_load_dwordx4 v2, s[8:11], s24 offen offset:2048 sc1 lds
  v_add_u32 v5, s32, v2
  ds_read_b128 v[8:11], v5 offset:0
  ds_read_b128 v[12:15], v5 offset:14336
  ds_read_b128 v[16:19], v5 offset:1024
  ds_read_b128 v[20:23], v5 offset:15360
  ds_read_b128 v[24:27], v5 offset:2048
  ds_read_b128 v[28:31], v5 offset:16384
  ds_read_b128 v[32:35], v5 offset:3072
  s_waitcnt lgkmcnt(6)
  v_mfma_f32_16x16x32_bf16 v[40:43], a[0:3], v[8:11], 0
  v_mfma_f32_16x16x32_bf16 v[44:47], a[56:59], v[8:11], 0
  ds_read_b128 v[36:39], v5 offset:17408
  s_waitcnt lgkmcnt(6)
  v_mfma_f32_16x16x32_bf16 v[56:59], a[0:3], v[12:15], 0
  v_mfma_f32_16x16x32_bf16 v[60:63], a[56:59], v[12:15], 0
  ds_read_b128 v[8:11], v5 offset:4096
  s_waitcnt lgkmcnt(6)
  v_mfma_f32_16x16x32_bf16 v[40:43], a[4:7], v[16:19], v[40:43]
  v_mfma_f32_16x16x32_bf16 v[44:47], a[60:63], v[16:19], v[44:47]
  ds_read_b128 v[12:15], v5 offset:18432
  s_waitcnt lgkmcnt(6)
  v_mfma_f32_16x16x32_bf16 v[56:59], a[4:7], v[20:23], v[56:59]
  v_mfma_f32_16x16x32_bf16 v[60:63], a[60:63], v[20:23], v[60:63]
  ds_read_b128 v[16:19], v5 offset:5120
  s_waitcnt lgkmcnt(6)
  v_mfma_f32_16x16x32_bf16 v[40:43], a[8:11], v[24:27], v[40:43]
  v_mfma_f32_16x16x32_bf16 v[44:47], a[64:67], v[24:27], v[44:47]
  ds_read_b128 v[20:23], v5 offset:19456
  s_waitcnt lgkmcnt(6)
  v_mfma_f32_16x16x32_bf16 v[56:59], a[8:11], v[28:31], v[56:59]
  v_mfma_f32_16x16x32_bf16 v[60:63], a[64:67], v[28:31], v[60:63]
  ds_read_b128 v[24:27], v5 offset:6144
  s_waitcnt lgkmcnt(6)
  v_mfma_f32_16x16x32_bf16 v[40:43], a[12:15], v[32:35], v[40:43]
  v_mfma_f32_16x16x32_bf16 v[44:47], a[68:71], v[32:35], v[44:47]
  ds_read_b128 v[28:31], v5 offset:20480
  s_waitcnt lgkmcnt(6)
  v_mfma_f32_16x16x32_bf16 v[56:59], a[12:15], v[36:39], v[56:59]
  v_mfma_f32_16x16x32_bf16 v[60:63], a[68:71], v[36:39], v[60:63]
  ds_read_b128 v[32:35], v5 offset:7168
  s_waitcnt lgkmcnt(6)
  v_mfma_f32_16x16x32_bf16 v[40:43], a[16:19], v[8:11], v[40:43]
  v_mfma_f32_16x16x32_bf16 v[44:47], a[72:75], v[8:11], v[44:47]
  ds_read_b128 v[36:39], v5 offset:21504
  s_waitcnt lgkmcnt(6)
  v_mfma_f32_16x16x32_bf16 v[56:59], a[16:19], v[12:15], v[56:59]
  v_mfma_f32_16x16x32_bf16 v[60:63], a[72:75], v[12:15], v[60:63]
  ds_read_b128 v[8:11], v5 offset:8192
  s_waitcnt lgkmcnt(6)
  v_mfma_f32_16x16x32_bf16 v[40:43], a[20:23], v[16:19], v[40:43]
  v_mfma_f32_16x16x32_bf16 v[44:47], a[76:79], v[16:19], v[44:47]
  ds_read_b128 v[12:15], v5 offset:22528
  s_waitcnt lgkmcnt(6)
  v_mfma_f32_16x16x32_bf16 v[56:59], a[20:23], v[20:23], v[56:59]
  v_mfma_f32_16x16x32_bf16 v[60:63], a[76:79], v[20:23], v[60:63]
  ds_read_b128 v[16:19], v5 offset:9216
  s_waitcnt lgkmcnt(6)
  v_mfma_f32_16x16x32_bf16 v[40:43], a[24:27], v[24:27], v[40:43]
  v_mfma_f32_16x16x32_bf16 v[44:47], a[80:83], v[24:27], v[44:47]
  ds_read_b128 v[20:23], v5 offset:23552
  s_waitcnt lgkmcnt(6)
  v_mfma_f32_16x16x32_bf16 v[56:59], a[24:27], v[28:31], v[56:59]
  v_mfma_f32_16x16x32_bf16 v[60:63], a[80:83], v[28:31], v[60:63]
  ds_read_b128 v[24:27], v5 offset:10240
  s_waitcnt lgkmcnt(6)
  v_mfma_f32_16x16x32_bf16 v[40:43], a[28:31], v[32:35], v[40:43]
  v_mfma_f32_16x16x32_bf16 v[44:47], a[84:87], v[32:35], v[44:47]
  ds_read_b128 v[28:31], v5 offset:24576
  s_waitcnt lgkmcnt(6)
  v_mfma_f32_16x16x32_bf16 v[56:59], a[28:31], v[36:39], v[56:59]
  v_mfma_f32_16x16x32_bf16 v[60:63], a[84:87], v[36:39], v[60:63]
  ds_read_b128 v[32:35], v5 offset:11264
  s_waitcnt lgkmcnt(6)
  v_mfma_f32_16x16x32_bf16 v[40:43], a[32:35], v[8:11], v[40:43]
  v_mfma_f32_16x16x32_bf16 v[44:47], a[88:91], v[8:11], v[44:47]
  ds_read_b128 v[36:39], v5 offset:25600
  s_waitcnt lgkmcnt(6)
  v_mfma_f32_16x16x32_bf16 v[56:59], a[32:35], v[12:15], v[56:59]
  v_mfma_f32_16x16x32_bf16 v[60:63], a[88:91], v[12:15], v[60:63]
  ds_read_b128 v[8:11], v5 offset:12288
  s_waitcnt lgkmcnt(6)
  v_mfma_f32_16x16x32_bf16 v[40:43], a[36:39], v[16:19], v[40:43]
  v_mfma_f32_16x16x32_bf16 v[44:47], a[92:95], v[16:19], v[44:47]
  ds_read_b128 v[12:15], v5 offset:26624
  s_waitcnt lgkmcnt(6)
  v_mfma_f32_16x16x32_bf16 v[56:59], a[36:39], v[20:23], v[56:59]
  v_mfma_f32_16x16x32_bf16 v[60:63], a[92:95], v[20:23], v[60:63]
  ds_read_b128 v[16:19], v5 offset:13312
  s_waitcnt lgkmcnt(6)
  v_mfma_f32_16x16x32_bf16 v[40:43], a[40:43], v[24:27], v[40:43]
  v_mfma_f32_16x16x32_bf16 v[44:47], a[96:99], v[24:27], v[44:47]
  ds_read_b128 v[20:23], v5 offset:27648
  s_waitcnt lgkmcnt(6)
  v_mfma_f32_16x16x32_bf16 v[56:59], a[40:43], v[28:31], v[56:59]
  v_mfma_f32_16x16x32_bf16 v[60:63], a[96:99], v[28:31], v[60:63]
  s_waitcnt lgkmcnt(5)
  v_mfma_f32_16x16x32_bf16 v[40:43], a[44:47], v[32:35], v[40:43]
  v_mfma_f32_16x16x32_bf16 v[44:47], a[100:103], v[32:35], v[44:47]
  s_waitcnt lgkmcnt(4)
  v_mfma_f32_16x16x32_bf16 v[56:59], a[44:47], v[36:39], v[56:59]
  v_mfma_f32_16x16x32_bf16 v[60:63], a[100:103], v[36:39], v[60:63]
  s_waitcnt lgkmcnt(3)
  v_mfma_f32_16x16x32_bf16 v[40:43], a[48:51], v[8:11], v[40:43]
  v_mfma_f32_16x16x32_bf16 v[44:47], a[104:107], v[8:11], v[44:47]
  s_waitcnt lgkmcnt(2)
  v_mfma_f32_16x16x32_bf16 v[56:59], a[48:51], v[12:15], v[56:59]
  v_mfma_f32_16x16x32_bf16 v[60:63], a[104:107], v[12:15], v[60:63]
  s_waitcnt lgkmcnt(1)
  v_mfma_f32_16x16x32_bf16 v[40:43], a[52:55], v[16:19], v[40:43]
  v_mfma_f32_16x16x32_bf16 v[44:47], a[108:111], v[16:19], v[44:47]
  s_waitcnt lgkmcnt(0)
  v_mfma_f32_16x16x32_bf16 v[56:59], a[52:55], v[20:23], v[56:59]
  v_mfma_f32_16x16x32_bf16 v[60:63], a[108:111], v[20:23], v[60:63]
  s_add_u32 s25, s29, 28672
  s_lshl_b32 s24, s19, 5
  s_add_u32 s24, s24, 0
  v_add_u32 v88, s24, v4
  v_mul_u32_u24 v89, 2341, v88
  v_lshrrev_b32 v89, 16, v89
  v_mul_u32_u24 v89, 84, v89
  v_add3_u32 v88, v88, v89, v6
  v_lshlrev_b32 v90, 4, v88
  v_cvt_pk_bf16_f32 v72, v40, v41
  v_cvt_pk_bf16_f32 v73, v42, v43
  v_cvt_pk_bf16_f32 v74, v44, v45
  v_cvt_pk_bf16_f32 v75, v46, v47
  buffer_store_dwordx4 v[72:75], v90, s[8:11], s29 offen sc1
  s_lshl_b32 s24, s19, 5
  s_add_u32 s24, s24, 16
  v_add_u32 v88, s24, v4
  v_mul_u32_u24 v89, 2341, v88
  v_lshrrev_b32 v89, 16, v89
  v_mul_u32_u24 v89, 84, v89
  v_add3_u32 v88, v88, v89, v6
  v_lshlrev_b32 v91, 4, v88
  v_cvt_pk_bf16_f32 v80, v56, v57
  v_cvt_pk_bf16_f32 v81, v58, v59
  v_cvt_pk_bf16_f32 v82, v60, v61
  v_cvt_pk_bf16_f32 v83, v62, v63
  buffer_store_dwordx4 v[80:83], v91, s[8:11], s29 offen sc1
  s_mov_b32 s33, s32
  s_add_u32 s32, s32, 28672
  s_cmp_eq_u32 s32, 86016
  s_cselect_b32 s32, 0, s32
  s_add_u32 s19, s19, 1
  s_cmp_lt_u32 s19, s35
  s_cbranch_scc1 wf_vo_loop
  s_branch wf_done
wf_done:
  s_lshr_b32 s20, s18, 1
  s_lshl_b32 s20, s20, 4
  s_and_b32 s21, s17, 15
  s_add_u32 s20, s20, s21
  s_lshl_b32 s20, s20, 7
  s_cmp_lt_u32 s17, 16
  s_cselect_b32 s21, 16384, 0
  s_add_u32 s20, s20, s21
  s_add_u32 s20, s20, 88541184
  s_sub_u32 s21, s35, s34
  s_lshr_b32 s21, s21, 1
  v_mov_b32 v5, s21
  v_mov_b32 v6, 0
  s_waitcnt vmcnt(0)
  s_mov_b64 exec, 1
  s_cmp_lg_u32 s18, 0
  s_cbranch_scc1 wf_h1
  v_mov_b32 v7, 2
  s_sub_u32 s21, s20, 2048
  buffer_atomic_add v7, v6, s[8:11], s21 offen
wf_h1:
  buffer_atomic_add v5, v6, s[8:11], s20 offen
  s_mov_b64 exec, -1
  s_load_dwordx8 s[36:43], s[0:1], 56
  s_load_dwordx4 s[44:47], s[0:1], 88
  s_waitcnt lgkmcnt(0)
  s_mov_b32 s52, s36
  s_and_b32 s53, s37, 0xffff
  s_mov_b32 s54, 1835008
  s_mov_b32 s55, 0x20000
  s_lshl_b32 s20, s3, 8
  v_add_u32 v95, s20, v0
  s_mov_b32 s21, 9586981
  v_mul_hi_u32 v6, v95, s21
  v_mul_u32_u24 v7, 448, v6
  v_sub_u32 v7, v95, v7
  v_lshrrev_b32 v8, 4, v7
  v_and_b32 v7, 15, v7
  v_lshl_add_u32 v9, v6, 4, v7
  v_mul_u32_u24 v9, 896, v9
  v_lshl_add_u32 v9, v8, 5, v9
  buffer_load_dwordx4 v[84:87], v9, s[52:55], 0 offen
  buffer_load_dwordx4 v[88:91], v9, s[52:55], 0 offen offset:16
  v_mul_u32_u24 v6, 14336, v6
  v_lshl_add_u32 v6, v7, 4, v6
  v_lshl_add_u32 v92, v8, 9, v6
  v_lshrrev_b32 v7, 2, v8
  v_lshl_add_u32 v6, v7, 11, v6
  v_and_b32 v7, 3, v8
  v_lshl_add_u32 v93, v7, 8, v6
  v_mov_b32 v52, -1
  v_mov_b32 v53, -1
  v_mov_b32 v54, -1
  v_mov_b32 v55, -1
  s_mov_b32 s23, 89063424
  v_lshlrev_b32 v8, 4, v95
  buffer_store_dwordx4 v[52:55], v8, s[8:11], s23 offen sc1
  v_add_u32 v8, 917504, v8
  v_mov_b32 v9, 0x10000000
  v_cmp_lt_u32 vcc, 1535, v95
  s_nop 1
  v_cndmask_b32 v8, v8, v9, vcc
  buffer_store_dwordx4 v[52:55], v8, s[8:11], s23 offen sc1
  s_waitcnt vmcnt(1)
  v_mov_b32 v96, v84
  v_mov_b32 v100, v85
  v_mov_b32 v97, v86
  v_mov_b32 v101, v87
  v_mov_b32 v98, v88
  v_mov_b32 v102, v89
  v_mov_b32 v99, v90
  v_mov_b32 v103, v91
  s_mov_b32 s20, 71565312
  s_mov_b32 s21, 73400320
  buffer_store_dwordx4 v[96:99], v93, s[8:11], s21 offen sc1
  buffer_store_dwordx4 v[100:103], v93, s[8:11], s21 offen offset:1024 sc1
  s_cmp_lt_u32 s3, 70
  s_cbranch_scc1 i2_nx
  buffer_store_dwordx4 v[84:87], v92, s[8:11], s20 offen sc1
  buffer_store_dwordx4 v[88:91], v92, s[8:11], s20 offen offset:256 sc1
i2_nx:
  s_lshl_b32 s20, s3, 3
  s_add_u32 s20, s20, 88637440
  s_waitcnt vmcnt(0)
  s_barrier
  s_cmp_lg_u32 s16, 0
  s_cbranch_scc1 pub_38
  v_mul_u32_u24 v26, 2048, v1
  v_mov_b32 v24, s88
  v_mov_b32 v25, s89
  s_mov_b64 exec, 255
  buffer_store_dwordx2 v[24:25], v26, s[8:11], s20 offen sc1
  s_mov_b64 exec, -1
pub_38:
  s_branch wk_loop
wk_v7:
  s_sub_u32 s20, s3, 256
  s_mov_b32 s18, 1
  s_and_b32 s17, s20, 15
  s_add_u32 s17, s17, 16
  s_lshr_b32 s34, s20, 4
  s_lshl_b32 s34, s34, 1
  s_add_u32 s35, s34, 2
  s_branch wk_gemm
wk_vh:
  s_sub_u32 s20, s3, 368
  s_and_b32 s17, s20, 15
  s_add_u32 s17, s17, 16
  s_lshr_b32 s18, s20, 5
  s_add_u32 s18, s18, 2
  s_bitcmp1_b32 s20, 4
  s_cselect_b32 s34, 7, 0
  s_add_u32 s35, s34, 7
  s_branch wk_gemm
wk_vf:
  s_sub_u32 s20, s3, 560
  s_and_b32 s17, s20, 15
  s_add_u32 s17, s17, 16
  s_lshr_b32 s18, s20, 4
  s_add_u32 s18, s18, 4
  s_mov_b32 s34, 0
  s_mov_b32 s35, 14
  s_branch wk_gemm
wk_f:
  s_sub_u32 s20, s3, 624
  s_and_b32 s17, s20, 15
  s_lshr_b32 s18, s20, 4
  s_mov_b32 s34, 0
  s_mov_b32 s35, 14
  s_lshl_b32 s22, s17, 7
  s_add_u32 s22, s22, 88633344
  s_add_u32 s23, s22, 2048
  v_min_u32 v24, 48, v2
  v_min_u32 v25, 96, v2
  s_mov_b32 s30, 0
wk_aw:
  buffer_load_dwordx4 v[28:31], v24, s[8:11], s22 offen sc1
  buffer_load_dwordx4 v[32:35], v25, s[8:11], s23 offen sc1
  s_waitcnt vmcnt(0)
  v_cmp_ne_u64 vcc, s[88:89], v[28:29]
  s_cbranch_vccnz wk_aw_no
  v_cmp_ne_u64 vcc, s[88:89], v[30:31]
  s_cbranch_vccnz wk_aw_no
  v_cmp_ne_u64 vcc, s[88:89], v[32:33]
  s_cbranch_vccnz wk_aw_no
  v_cmp_ne_u64 vcc, s[88:89], v[34:35]
  s_cbranch_vccnz wk_aw_no
  s_branch wk_aw_ok
wk_aw_no:
  s_sleep 6
  s_add_u32 s30, s30, 1
  s_cmp_lt_u32 s30, 50000
  s_cbranch_scc1 wk_aw
  s_branch cA_abort
wk_aw_ok:
wk_gemm:
  s_lshl_b32 s20, s18, 4
  s_lshl_b32 s21, s16, 2
  s_add_u32 s20, s20, s21
  s_mul_i32 s21, s20, 14336
  s_add_u32 s21, s21, 71565312
  s_add_u32 s22, s21, 0
  buffer_load_dwordx4 a[0:3], v2, s[8:11], s22 offen offset:0 sc1
  buffer_load_dwordx4 a[4:7], v2, s[8:11], s22 offen offset:1024 sc1
  buffer_load_dwordx4 a[8:11], v2, s[8:11], s22 offen offset:2048 sc1
  buffer_load_dwordx4 a[12:15], v2, s[8:11], s22 offen offset:3072 sc1
  s_add_u32 s22, s21, 4096
  buffer_load_dwordx4 a[16:19], v2, s[8:11], s22 offen offset:0 sc1
  buffer_load_dwordx4 a[20:23], v2, s[8:11], s22 offen offset:1024 sc1
  buffer_load_dwordx4 a[24:27], v2, s[8:11], s22 offen offset:2048 sc1
  buffer_load_dwordx4 a[28:31], v2, s[8:11], s22 offen offset:3072 sc1
  s_add_u32 s22, s21, 8192
  buffer_load_dwordx4 a[32:35], v2, s[8:11], s22 offen offset:0 sc1
  buffer_load_dwordx4 a[36:39], v2, s[8:11], s22 offen offset:1024 sc1
  buffer_load_dwordx4 a[40:43], v2, s[8:11], s22 offen offset:2048 sc1
  buffer_load_dwordx4 a[44:47], v2, s[8:11], s22 offen offset:3072 sc1
  s_add_u32 s22, s21, 12288
  buffer_load_dwordx4 a[48:51], v2, s[8:11], s22 offen offset:0 sc1
  buffer_load_dwordx4 a[52:55], v2, s[8:11], s22 offen offset:1024 sc1
  buffer_load_dwordx4 a[56:59], v2, s[8:11], s22 offen offset:2048 sc1
  buffer_load_dwordx4 a[60:63], v2, s[8:11], s22 offen offset:3072 sc1
  s_add_u32 s22, s21, 16384
  buffer_load_dwordx4 a[64:67], v2, s[8:11], s22 offen offset:0 sc1
  buffer_load_dwordx4 a[68:71], v2, s[8:11], s22 offen offset:1024 sc1
  buffer_load_dwordx4 a[72:75], v2, s[8:11], s22 offen offset:2048 sc1
  buffer_load_dwordx4 a[76:79], v2, s[8:11], s22 offen offset:3072 sc1
  s_add_u32 s22, s21, 20480
  buffer_load_dwordx4 a[80:83], v2, s[8:11], s22 offen offset:0 sc1
  buffer_load_dwordx4 a[84:87], v2, s[8:11], s22 offen offset:1024 sc1
  buffer_load_dwordx4 a[88:91], v2, s[8:11], s22 offen offset:2048 sc1
  buffer_load_dwordx4 a[92:95], v2, s[8:11], s22 offen offset:3072 sc1
  s_add_u32 s22, s21, 24576
  buffer_load_dwordx4 a[96:99], v2, s[8:11], s22 offen offset:0 sc1
  buffer_load_dwordx4 a[100:103], v2, s[8:11], s22 offen offset:1024 sc1
  buffer_load_dwordx4 a[104:107], v2, s[8:11], s22 offen offset:2048 sc1
  buffer_load_dwordx4 a[108:111], v2, s[8:11], s22 offen offset:3072 sc1
  s_add_u32 s22, s21, 28672
  buffer_load_dwordx4 a[112:115], v2, s[8:11], s22 offen offset:0 sc1
  buffer_load_dwordx4 a[116:119], v2, s[8:11], s22 offen offset:1024 sc1
  buffer_load_dwordx4 a[120:123], v2, s[8:11], s22 offen offset:2048 sc1
  buffer_load_dwordx4 a[124:127], v2, s[8:11], s22 offen offset:3072 sc1
  s_add_u32 s22, s21, 32768
  buffer_load_dwordx4 a[128:131], v2, s[8:11], s22 offen offset:0 sc1
  buffer_load_dwordx4 a[132:135], v2, s[8:11], s22 offen offset:1024 sc1
  buffer_load_dwordx4 a[136:139], v2, s[8:11], s22 offen offset:2048 sc1
  buffer_load_dwordx4 a[140:143], v2, s[8:11], s22 offen offset:3072 sc1
  s_add_u32 s22, s21, 36864
  buffer_load_dwordx4 a[144:147], v2, s[8:11], s22 offen offset:0 sc1
  buffer_load_dwordx4 a[148:151], v2, s[8:11], s22 offen offset:1024 sc1
  buffer_load_dwordx4 a[152:155], v2, s[8:11], s22 offen offset:2048 sc1
  buffer_load_dwordx4 a[156:159], v2, s[8:11], s22 offen offset:3072 sc1
  s_add_u32 s22, s21, 40960
  buffer_load_dwordx4 a[160:163], v2, s[8:11], s22 offen offset:0 sc1
  buffer_load_dwordx4 a[164:167], v2, s[8:11], s22 offen offset:1024 sc1
  buffer_load_dwordx4 a[168:171], v2, s[8:11], s22 offen offset:2048 sc1
  buffer_load_dwordx4 a[172:175], v2, s[8:11], s22 offen offset:3072 sc1
  s_add_u32 s22, s21, 45056
  buffer_load_dwordx4 a[176:179], v2, s[8:11], s22 offen offset:0 sc1
  buffer_load_dwordx4 a[180:183], v2, s[8:11], s22 offen offset:1024 sc1
  buffer_load_dwordx4 a[184:187], v2, s[8:11], s22 offen offset:2048 sc1
  buffer_load_dwordx4 a[188:191], v2, s[8:11], s22 offen offset:3072 sc1
  s_add_u32 s22, s21, 49152
  buffer_load_dwordx4 a[192:195], v2, s[8:11], s22 offen offset:0 sc1
  buffer_load_dwordx4 a[196:199], v2, s[8:11], s22 offen offset:1024 sc1
  buffer_load_dwordx4 a[200:203], v2, s[8:11], s22 offen offset:2048 sc1
  buffer_load_dwordx4 a[204:207], v2, s[8:11], s22 offen offset:3072 sc1
  s_add_u32 s22, s21, 53248
  buffer_load_dwordx4 a[208:211], v2, s[8:11], s22 offen offset:0 sc1
  buffer_load_dwordx4 a[212:215], v2, s[8:11], s22 offen offset:1024 sc1
  buffer_load_dwordx4 a[216:219], v2, s[8:11], s22 offen offset:2048 sc1
  buffer_load_dwordx4 a[220:223], v2, s[8:11], s22 offen offset:3072 sc1
  s_waitcnt vmcnt(40)
  s_mul_i32 s23, s17, 401408
  s_and_b32 s22, s16, 1
  s_mul_i32 s22, s22, 7168
  s_add_u32 s23, s23, s22
  s_add_u32 s23, s23, 0
  s_lshr_b32 s22, s16, 1
  s_mul_i32 s22, s22, 14336
  s_add_u32 s23, s23, s22
  s_mul_i32 s27, s16, 7168
  s_lshr_b32 s28, s20, 1
  s_cmp_lt_u32 s17, 16
  s_cbranch_scc0 wg_vo
  s_add_u32 s23, s23, s22
  s_lshl_b32 s29, s28, 4
  s_add_u32 s29, s29, s17
  s_mul_i32 s29, s29, 28672
  s_add_u32 s29, s29, 12845056
  s_mov_b32 s31, 0
  s_lshr_b32 s24, s34, 1
  s_lshl_b32 s24, s24, 2
  s_and_b32 s25, s34, 1
  s_add_u32 s24, s24, s25
  s_mul_i32 s24, s24, 14336
  s_add_u32 s24, s24, s23
  s_cmp_lt_u32 s34, s35
  s_cselect_b32 s24, s24, 0x10000000
  s_add_u32 m0, s31, s27
  s_nop 0
  buffer_load_dwordx4 v2, s[8:11], s24 offen offset:0 sc1 lds
  buffer_load_dwordx4 v2, s[8:11], s24 offen offset:1024 sc1 lds
  buffer_load_dwordx4 v2, s[8:11], s24 offen offset:2048 sc1 lds
  buffer_load_dwordx4 v2, s[8:11], s24 offen offset:3072 sc1 lds
  s_add_u32 m0, m0, 4096
  s_add_u32 s24, s24, 4096
  buffer_load_dwordx4 v2, s[8:11], s24 offen offset:0 sc1 lds
  buffer_load_dwordx4 v2, s[8:11], s24 offen offset:1024 sc1 lds
  buffer_load_dwordx4 v2, s[8:11], s24 offen offset:2048 sc1 lds
  s_add_u32 s30, s34, 1
  s_mov_b32 s31, 28672
  s_lshr_b32 s24, s30, 1
  s_lshl_b32 s24, s24, 2
  s_and_b32 s25, s30, 1
  s_add_u32 s24, s24, s25
  s_mul_i32 s24, s24, 14336
  s_add_u32 s24, s24, s23
  s_cmp_lt_u32 s30, s35
  s_cselect_b32 s24, s24, 0x10000000
  s_add_u32 m0, s31, s27
  s_nop 0
  buffer_load_dwordx4 v2, s[8:11], s24 offen offset:0 sc1 lds
  buffer_load_dwordx4 v2, s[8:11], s24 offen offset:1024 sc1 lds
  buffer_load_dwordx4 v2, s[8:11], s24 offen offset:2048 sc1 lds
  buffer_load_dwordx4 v2, s[8:11], s24 offen offset:3072 sc1 lds
  s_add_u32 m0, m0, 4096
  s_add_u32 s24, s24, 4096
  buffer_load_dwordx4 v2, s[8:11], s24 offen offset:0 sc1 lds
  buffer_load_dwordx4 v2, s[8:11], s24 offen offset:1024 sc1 lds
  buffer_load_dwordx4 v2, s[8:11], s24 offen offset:2048 sc1 lds
  s_mov_b32 s19, s34
  s_mov_b32 s32, 0
  s_mov_b32 s33, 57344
  s_waitcnt vmcnt(7)
  s_branch wg_f_in
wg_f_loop:
  s_waitcnt vmcnt(11)
wg_f_in:
  s_barrier
  s_add_u32 s30, s19, 2
  s_lshr_b32 s24, s30, 1
  s_lshl_b32 s24, s24, 2
  s_and_b32 s25, s30, 1
  s_add_u32 s24, s24, s25
  s_mul_i32 s24, s24, 14336
  s_add_u32 s24, s24, s23
  s_cmp_lt_u32 s30, s35
  s_cselect_b32 s24, s24, 0x10000000
  s_add_u32 m0, s33, s27
  s_nop 0
  buffer_load_dwordx4 v2, s[8:11], s24 offen offset:0 sc1 lds
  buffer_load_dwordx4 v2, s[8:11], s24 offen offset:1024 sc1 lds
  buffer_load_dwordx4 v2, s[8:11], s24 offen offset:2048 sc1 lds
  buffer_load_dwordx4 v2, s[8:11], s24 offen offset:3072 sc1 lds
  s_add_u32 m0, m0, 4096
  s_add_u32 s24, s24, 4096
  buffer_load_dwordx4 v2, s[8:11], s24 offen offset:0 sc1 lds
  buffer_load_dwordx4 v2, s[8:11], s24 offen offset:1024 sc1 lds
  buffer_load_dwordx4 v2, s[8:11], s24 offen offset:2048 sc1 lds
  v_add_u32 v5, s32, v2
  ds_read_b128 v[8:11], v5 offset:0
  ds_read_b128 v[12:15], v5 offset:14336
  ds_read_b128 v[16:19], v5 offset:1024
  ds_read_b128 v[20:23], v5 offset:15360
  ds_read_b128 v[24:27], v5 offset:2048
  ds_read_b128 v[28:31], v5 offset:16384
  ds_read_b128 v[32:35], v5 offset:3072
  s_waitcnt lgkmcnt(6)
  v_mfma_f32_16x16x32_bf16 v[40:43], v[8:11], a[0:3], 0
  v_mfma_f32_16x16x32_bf16 v[44:47], v[8:11], a[56:59], 0
  v_mfma_f32_16x16x32_bf16 v[48:51], v[8:11], a[112:115], 0
  v_mfma_f32_16x16x32_bf16 v[52:55], v[8:11], a[168:171], 0
  ds_read_b128 v[36:39], v5 offset:17408
  s_waitcnt lgkmcnt(6)
  v_mfma_f32_16x16x32_bf16 v[56:59], v[12:15], a[0:3], 0
  v_mfma_f32_16x16x32_bf16 v[60:63], v[12:15], a[56:59], 0
  v_mfma_f32_16x16x32_bf16 v[64:67], v[12:15], a[112:115], 0
  v_mfma_f32_16x16x32_bf16 v[68:71], v[12:15], a[168:171], 0
  ds_read_b128 v[8:11], v5 offset:4096
  s_waitcnt lgkmcnt(6)
  v_mfma_f32_16x16x32_bf16 v[40:43], v[16:19], a[4:7], v[40:43]
  v_mfma_f32_16x16x32_bf16 v[44:47], v[16:19], a[60:63], v[44:47]
  v_mfma_f32_16x16x32_bf16 v[48:51], v[16:19], a[116:119], v[48:51]
  v_mfma_f32_16x16x32_bf16 v[52:55], v[16:19], a[172:175], v[52:55]
  ds_read_b128 v[12:15], v5 offset:18432
  s_waitcnt lgkmcnt(6)
  v_mfma_f32_16x16x32_bf16 v[56:59], v[20:23], a[4:7], v[56:59]
  v_mfma_f32_16x16x32_bf16 v[60:63], v[20:23], a[60:63], v[60:63]
  v_mfma_f32_16x16x32_bf16 v[64:67], v[20:23], a[116:119], v[64:67]
  v_mfma_f32_16x16x32_bf16 v[68:71], v[20:23], a[172:175], v[68:71]
  ds_read_b128 v[16:19], v5 offset:5120
  s_waitcnt lgkmcnt(6)
  v_mfma_f32_16x16x32_bf16 v[40:43], v[24:27], a[8:11], v[40:43]
  v_mfma_f32_16x16x32_bf16 v[44:47], v[24:27], a[64:67], v[44:47]
  v_mfma_f32_16x16x32_bf16 v[48:51], v[24:27], a[120:123], v[48:51]
  v_mfma_f32_16x16x32_bf16 v[52:55], v[24:27], a[176:179], v[52:55]
  ds_read_b128 v[20:23], v5 offset:19456
  s_waitcnt lgkmcnt(6)
  v_mfma_f32_16x16x32_bf16 v[56:59], v[28:31], a[8:11], v[56:59]
  v_mfma_f32_16x16x32_bf16 v[60:63], v[28:31], a[64:67], v[60:63]
  v_mfma_f32_16x16x32_bf16 v[64:67], v[28:31], a[120:123], v[64:67]
  v_mfma_f32_16x16x32_bf16 v[68:71], v[28:31], a[176:179], v[68:71]
  ds_read_b128 v[24:27], v5 offset:6144
  s_waitcnt lgkmcnt(6)
  v_mfma_f32_16x16x32_bf16 v[40:43], v[32:35], a[12:15], v[40:43]
  v_mfma_f32_16x16x32_bf16 v[44:47], v[32:35], a[68:71], v[44:47]
  v_mfma_f32_16x16x32_bf16 v[48:51], v[32:35], a[124:127], v[48:51]
  v_mfma_f32_16x16x32_bf16 v[52:55], v[32:35], a[180:183], v[52:55]
  ds_read_b128 v[28:31], v5 offset:20480
  s_waitcnt lgkmcnt(6)
  v_mfma_f32_16x16x32_bf16 v[56:59], v[36:39], a[12:15], v[56:59]
  v_mfma_f32_16x16x32_bf16 v[60:63], v[36:39], a[68:71], v[60:63]
  v_mfma_f32_16x16x32_bf16 v[64:67], v[36:39], a[124:127], v[64:67]
  v_mfma_f32_16x16x32_bf16 v[68:71], v[36:39], a[180:183], v[68:71]
  ds_read_b128 v[32:35], v5 offset:7168
  s_waitcnt lgkmcnt(6)
  v_mfma_f32_16x16x32_bf16 v[40:43], v[8:11], a[16:19], v[40:43]
  v_mfma_f32_16x16x32_bf16 v[44:47], v[8:11], a[72:75], v[44:47]
  v_mfma_f32_16x16x32_bf16 v[48:51], v[8:11], a[128:131], v[48:51]
  v_mfma_f32_16x16x32_bf16 v[52:55], v[8:11], a[184:187], v[52:55]
  ds_read_b128 v[36:39], v5 offset:21504
  s_waitcnt lgkmcnt(6)
  v_mfma_f32_16x16x32_bf16 v[56:59], v[12:15], a[16:19], v[56:59]
  v_mfma_f32_16x16x32_bf16 v[60:63], v[12:15], a[72:75], v[60:63]
  v_mfma_f32_16x16x32_bf16 v[64:67], v[12:15], a[128:131], v[64:67]
  v_mfma_f32_16x16x32_bf16 v[68:71], v[12:15], a[184:187], v[68:71]
  ds_read_b128 v[8:11], v5 offset:8192
  s_waitcnt lgkmcnt(6)
  v_mfma_f32_16x16x32_bf16 v[40:43], v[16:19], a[20:23], v[40:43]
  v_mfma_f32_16x16x32_bf16 v[44:47], v[16:19], a[76:79], v[44:47]
  v_mfma_f32_16x16x32_bf16 v[48:51], v[16:19], a[132:135], v[48:51]
  v_mfma_f32_16x16x32_bf16 v[52:55], v[16:19], a[188:191], v[52:55]
  ds_read_b128 v[12:15], v5 offset:22528
  s_waitcnt lgkmcnt(6)
  v_mfma_f32_16x16x32_bf16 v[56:59], v[20:23], a[20:23], v[56:59]
  v_mfma_f32_16x16x32_bf16 v[60:63], v[20:23], a[76:79], v[60:63]
  v_mfma_f32_16x16x32_bf16 v[64:67], v[20:23], a[132:135], v[64:67]
  v_mfma_f32_16x16x32_bf16 v[68:71], v[20:23], a[188:191], v[68:71]
  ds_read_b128 v[16:19], v5 offset:9216
  s_waitcnt lgkmcnt(6)
  v_mfma_f32_16x16x32_bf16 v[40:43], v[24:27], a[24:27], v[40:43]
  v_mfma_f32_16x16x32_bf16 v[44:47], v[24:27], a[80:83], v[44:47]
  v_mfma_f32_16x16x32_bf16 v[48:51], v[24:27], a[136:139], v[48:51]
  v_mfma_f32_16x16x32_bf16 v[52:55], v[24:27], a[192:195], v[52:55]
  ds_read_b128 v[20:23], v5 offset:23552
  s_waitcnt lgkmcnt(6)
  v_mfma_f32_16x16x32_bf16 v[56:59], v[28:31], a[24:27], v[56:59]
  v_mfma_f32_16x16x32_bf16 v[60:63], v[28:31], a[80:83], v[60:63]
  v_mfma_f32_16x16x32_bf16 v[64:67], v[28:31], a[136:139], v[64:67]
  v_mfma_f32_16x16x32_bf16 v[68:71], v[28:31], a[192:195], v[68:71]
  ds_read_b128 v[24:27], v5 offset:10240
  s_waitcnt lgkmcnt(6)
  v_mfma_f32_16x16x32_bf16 v[40:43], v[32:35], a[28:31], v[40:43]
  v_mfma_f32_16x16x32_bf16 v[44:47], v[32:35], a[84:87], v[44:47]
  v_mfma_f32_16x16x32_bf16 v[48:51], v[32:35], a[140:143], v[48:51]
  v_mfma_f32_16x16x32_bf16 v[52:55], v[32:35], a[196:199], v[52:55]
  ds_read_b128 v[28:31], v5 offset:24576
  s_waitcnt lgkmcnt(6)
  v_mfma_f32_16x16x32_bf16 v[56:59], v[36:39], a[28:31], v[56:59]
  v_mfma_f32_16x16x32_bf16 v[60:63], v[36:39], a[84:87], v[60:63]
  v_mfma_f32_16x16x32_bf16 v[64:67], v[36:39], a[140:143], v[64:67]
  v_mfma_f32_16x16x32_bf16 v[68:71], v[36:39], a[196:199], v[68:71]
  ds_read_b128 v[32:35], v5 offset:11264
  s_waitcnt lgkmcnt(6)
  v_mfma_f32_16x16x32_bf16 v[40:43], v[8:11], a[32:35], v[40:43]
  v_mfma_f32_16x16x32_bf16 v[44:47], v[8:11], a[88:91], v[44:47]
  v_mfma_f32_16x16x32_bf16 v[48:51], v[8:11], a[144:147], v[48:51]
  v_mfma_f32_16x16x32_bf16 v[52:55], v[8:11], a[200:203], v[52:55]
  ds_read_b128 v[36:39], v5 offset:25600
  s_waitcnt lgkmcnt(6)
  v_mfma_f32_16x16x32_bf16 v[56:59], v[12:15], a[32:35], v[56:59]
  v_mfma_f32_16x16x32_bf16 v[60:63], v[12:15], a[88:91], v[60:63]
  v_mfma_f32_16x16x32_bf16 v[64:67], v[12:15], a[144:147], v[64:67]
  v_mfma_f32_16x16x32_bf16 v[68:71], v[12:15], a[200:203], v[68:71]
  ds_read_b128 v[8:11], v5 offset:12288
  s_waitcnt lgkmcnt(6)
  v_mfma_f32_16x16x32_bf16 v[40:43], v[16:19], a[36:39], v[40:43]
  v_mfma_f32_16x16x32_bf16 v[44:47], v[16:19], a[92:95], v[44:47]
  v_mfma_f32_16x16x32_bf16 v[48:51], v[16:19], a[148:151], v[48:51]
  v_mfma_f32_16x16x32_bf16 v[52:55], v[16:19], a[204:207], v[52:55]
  ds_read_b128 v[12:15], v5 offset:26624
  s_waitcnt lgkmcnt(6)
  v_mfma_f32_16x16x32_bf16 v[56:59], v[20:23], a[36:39], v[56:59]
  v_mfma_f32_16x16x32_bf16 v[60:63], v[20:23], a[92:95], v[60:63]
  v_mfma_f32_16x16x32_bf16 v[64:67], v[20:23], a[148:151], v[64:67]
  v_mfma_f32_16x16x32_bf16 v[68:71], v[20:23], a[204:207], v[68:71]
  ds_read_b128 v[16:19], v5 offset:13312
  s_waitcnt lgkmcnt(6)
  v_mfma_f32_16x16x32_bf16 v[40:43], v[24:27], a[40:43], v[40:43]
  v_mfma_f32_16x16x32_bf16 v[44:47], v[24:27], a[96:99], v[44:47]
  v_mfma_f32_16x16x32_bf16 v[48:51], v[24:27], a[152:155], v[48:51]
  v_mfma_f32_16x16x32_bf16 v[52:55], v[24:27], a[208:211], v[52:55]
  ds_read_b128 v[20:23], v5 offset:27648
  s_waitcnt lgkmcnt(6)
  v_mfma_f32_16x16x32_bf16 v[56:59], v[28:31], a[40:43], v[56:59]
  v_mfma_f32_16x16x32_bf16 v[60:63], v[28:31], a[96:99], v[60:63]
  v_mfma_f32_16x16x32_bf16 v[64:67], v[28:31], a[152:155], v[64:67]
  v_mfma_f32_16x16x32_bf16 v[68:71], v[28:31], a[208:211], v[68:71]
  s_waitcnt lgkmcnt(5)
  v_mfma_f32_16x16x32_bf16 v[40:43], v[32:35], a[44:47], v[40:43]
  v_mfma_f32_16x16x32_bf16 v[44:47], v[32:35], a[100:103], v[44:47]
  v_mfma_f32_16x16x32_bf16 v[48:51], v[32:35], a[156:159], v[48:51]
  v_mfma_f32_16x16x32_bf16 v[52:55], v[32:35], a[212:215], v[52:55]
  s_waitcnt lgkmcnt(4)
  v_mfma_f32_16x16x32_bf16 v[56:59], v[36:39], a[44:47], v[56:59]
  v_mfma_f32_16x16x32_bf16 v[60:63], v[36:39], a[100:103], v[60:63]
  v_mfma_f32_16x16x32_bf16 v[64:67], v[36:39], a[156:159], v[64:67]
  v_mfma_f32_16x16x32_bf16 v[68:71], v[36:39], a[212:215], v[68:71]
  s_waitcnt lgkmcnt(3)
  v_mfma_f32_16x16x32_bf16 v[40:43], v[8:11], a[48:51], v[40:43]
  v_mfma_f32_16x16x32_bf16 v[44:47], v[8:11], a[104:107], v[44:47]
  v_mfma_f32_16x16x32_bf16 v[48:51], v[8:11], a[160:163], v[48:51]
  v_mfma_f32_16x16x32_bf16 v[52:55], v[8:11], a[216:219], v[52:55]
  s_waitcnt lgkmcnt(2)
  v_mfma_f32_16x16x32_bf16 v[56:59], v[12:15], a[48:51], v[56:59]
  v_mfma_f32_16x16x32_bf16 v[60:63], v[12:15], a[104:107], v[60:63]
  v_mfma_f32_16x16x32_bf16 v[64:67], v[12:15], a[160:163], v[64:67]
  v_mfma_f32_16x16x32_bf16 v[68:71], v[12:15], a[216:219], v[68:71]
  s_waitcnt lgkmcnt(1)
  v_mfma_f32_16x16x32_bf16 v[40:43], v[16:19], a[52:55], v[40:43]
  v_mfma_f32_16x16x32_bf16 v[44:47], v[16:19], a[108:111], v[44:47]
  v_mfma_f32_16x16x32_bf16 v[48:51], v[16:19], a[164:167], v[48:51]
  v_mfma_f32_16x16x32_bf16 v[52:55], v[16:19], a[220:223], v[52:55]
  s_waitcnt lgkmcnt(0)
  v_mfma_f32_16x16x32_bf16 v[56:59], v[20:23], a[52:55], v[56:59]
  v_mfma_f32_16x16x32_bf16 v[60:63], v[20:23], a[108:111], v[60:63]
  v_mfma_f32_16x16x32_bf16 v[64:67], v[20:23], a[164:167], v[64:67]
  v_mfma_f32_16x16x32_bf16 v[68:71], v[20:23], a[220:223], v[68:71]
  s_lshl_b32 s24, s19, 10
  s_add_u32 s24, s24, s29
  v_cvt_pk_bf16_f32 v72, v40, v41
  v_cvt_pk_bf16_f32 v73, v42, v43
  v_cvt_pk_bf16_f32 v74, v56, v57
  v_cvt_pk_bf16_f32 v75, v58, v59
  s_add_u32 s25, s24, 0
  buffer_store_dwordx4 v[72:75], v2, s[8:11], s25 offen sc1
  v_cvt_pk_bf16_f32 v76, v44, v45
  v_cvt_pk_bf16_f32 v77, v46, v47
  v_cvt_pk_bf16_f32 v78, v60, v61
  v_cvt_pk_bf16_f32 v79, v62, v63
  s_add_u32 s25, s24, 14336
  buffer_store_dwordx4 v[76:79], v2, s[8:11], s25 offen sc1
  v_cvt_pk_bf16_f32 v80, v48, v49
  v_cvt_pk_bf16_f32 v81, v50, v51
  v_cvt_pk_bf16_f32 v82, v64, v65
  v_cvt_pk_bf16_f32 v83, v66, v67
  s_add_u32 s25, s24, 458752
  buffer_store_dwordx4 v[80:83], v2, s[8:11], s25 offen sc1
  v_cvt_pk_bf16_f32 v84, v52, v53
  v_cvt_pk_bf16_f32 v85, v54, v55
  v_cvt_pk_bf16_f32 v86, v68, v69
  v_cvt_pk_bf16_f32 v87, v70, v71
  s_add_u32 s25, s24, 473088
  buffer_store_dwordx4 v[84:87], v2, s[8:11], s25 offen sc1
  s_mov_b32 s33, s32
  s_add_u32 s32, s32, 28672
  s_cmp_eq_u32 s32, 86016
  s_cselect_b32 s32, 0, s32
  s_add_u32 s19, s19, 1
  s_cmp_lt_u32 s19, s35
  s_cbranch_scc1 wg_f_loop
  s_branch wg_done
wg_vo:
  s_sub_u32 s29, s17, 16
  s_lshl_b32 s29, s29, 6
  s_add_u32 s29, s29, s28
  s_mul_i32 s29, s29, 28672
  s_add_u32 s29, s29, 42205184
  v_mul_u32_u24 v6, 28, v3
  s_mov_b32 s31, 0
  s_lshl_b32 s24, s34, 1
  s_mul_i32 s24, s24, 14336
  s_add_u32 s24, s24, s23
  s_cmp_lt_u32 s34, s35
  s_cselect_b32 s24, s24, 0x10000000
  s_add_u32 m0, s31, s27
  s_nop 0
  buffer_load_dwordx4 v2, s[8:11], s24 offen offset:0 sc1 lds
  buffer_load_dwordx4 v2, s[8:11], s24 offen offset:1024 sc1 lds
  buffer_load_dwordx4 v2, s[8:11], s24 offen offset:2048 sc1 lds
  buffer_load_dwordx4 v2, s[8:11], s24 offen offset:3072 sc1 lds
  s_add_u32 m0, m0, 4096
  s_add_u32 s24, s24, 4096
  buffer_load_dwordx4 v2, s[8:11], s24 offen offset:0 sc1 lds
  buffer_load_dwordx4 v2, s[8:11], s24 offen offset:1024 sc1 lds
  buffer_load_dwordx4 v2, s[8:11], s24 offen offset:2048 sc1 lds
  s_add_u32 s30, s34, 1
  s_mov_b32 s31, 28672
  s_lshl_b32 s24, s30, 1
  s_mul_i32 s24, s24, 14336
  s_add_u32 s24, s24, s23
  s_cmp_lt_u32 s30, s35
  s_cselect_b32 s24, s24, 0x10000000
  s_add_u32 m0, s31, s27
  s_nop 0
  buffer_load_dwordx4 v2, s[8:11], s24 offen offset:0 sc1 lds
  buffer_load_dwordx4 v2, s[8:11], s24 offen offset:1024 sc1 lds
  buffer_load_dwordx4 v2, s[8:11], s24 offen offset:2048 sc1 lds
  buffer_load_dwordx4 v2, s[8:11], s24 offen offset:3072 sc1 lds
  s_add_u32 m0, m0, 4096
  s_add_u32 s24, s24, 4096
  buffer_load_dwordx4 v2, s[8:11], s24 offen offset:0 sc1 lds
  buffer_load_dwordx4 v2, s[8:11], s24 offen offset:1024 sc1 lds
  buffer_load_dwordx4 v2, s[8:11], s24 offen offset:2048 sc1 lds
  s_mov_b32 s19, s34
  s_mov_b32 s32, 0
  s_mov_b32 s33, 57344
  s_waitcnt vmcnt(7)
  s_branch wg_vo_in
wg_vo_loop:
  s_waitcnt vmcnt(11)
wg_vo_in:
  s_barrier
  s_add_u32 s30, s19, 2
  s_lshl_b32 s24, s30, 1
  s_mul_i32 s24, s24, 14336
  s_add_u32 s24, s24, s23
  s_cmp_lt_u32 s30, s35
  s_cselect_b32 s24, s24, 0x10000000
  s_add_u32 m0, s33, s27
  s_nop 0
  buffer_load_dwordx4 v2, s[8:11], s24 offen offset:0 sc1 lds
  buffer_load_dwordx4 v2, s[8:11], s24 offen offset:1024 sc1 lds
  buffer_load_dwordx4 v2, s[8:11], s24 offen offset:2048 sc1 lds
  buffer_load_dwordx4 v2, s[8:11], s24 offen offset:3072 sc1 lds
  s_add_u32 m0, m0, 4096
  s_add_u32 s24, s24, 4096
  buffer_load_dwordx4 v2, s[8:11], s24 offen offset:0 sc1 lds
  buffer_load_dwordx4 v2, s[8:11], s24 offen offset:1024 sc1 lds
  buffer_load_dwordx4 v2, s[8:11], s24 offen offset:2048 sc1 lds
  v_add_u32 v5, s32, v2
  ds_read_b128 v[8:11], v5 offset:0
  ds_read_b128 v[12:15], v5 offset:14336
  ds_read_b128 v[16:19], v5 offset:1024
  ds_read_b128 v[20:23], v5 offset:15360
  ds_read_b128 v[24:27], v5 offset:2048
  ds_read_b128 v[28:31], v5 offset:16384
  ds_read_b128 v[32:35], v5 offset:3072
  s_waitcnt lgkmcnt(6)
  v_mfma_f32_16x16x32_bf16 v[40:43], a[0:3], v[8:11], 0
  v_mfma_f32_16x16x32_bf16 v[44:47], a[56:59], v[8:11], 0
  v_mfma_f32_16x16x32_bf16 v[48:51], a[112:115], v[8:11], 0
  v_mfma_f32_16x16x32_bf16 v[52:55], a[168:171], v[8:11], 0
  ds_read_b128 v[36:39], v5 offset:17408
  s_waitcnt lgkmcnt(6)
  v_mfma_f32_16x16x32_bf16 v[56:59], a[0:3], v[12:15], 0
  v_mfma_f32_16x16x32_bf16 v[60:63], a[56:59], v[12:15], 0
  v_mfma_f32_16x16x32_bf16 v[64:67], a[112:115], v[12:15], 0
  v_mfma_f32_16x16x32_bf16 v[68:71], a[168:171], v[12:15], 0
  ds_read_b128 v[8:11], v5 offset:4096
  s_waitcnt lgkmcnt(6)
  v_mfma_f32_16x16x32_bf16 v[40:43], a[4:7], v[16:19], v[40:43]
  v_mfma_f32_16x16x32_bf16 v[44:47], a[60:63], v[16:19], v[44:47]
  v_mfma_f32_16x16x32_bf16 v[48:51], a[116:119], v[16:19], v[48:51]
  v_mfma_f32_16x16x32_bf16 v[52:55], a[172:175], v[16:19], v[52:55]
  ds_read_b128 v[12:15], v5 offset:18432
  s_waitcnt lgkmcnt(6)
  v_mfma_f32_16x16x32_bf16 v[56:59], a[4:7], v[20:23], v[56:59]
  v_mfma_f32_16x16x32_bf16 v[60:63], a[60:63], v[20:23], v[60:63]
  v_mfma_f32_16x16x32_bf16 v[64:67], a[116:119], v[20:23], v[64:67]
  v_mfma_f32_16x16x32_bf16 v[68:71], a[172:175], v[20:23], v[68:71]
  ds_read_b128 v[16:19], v5 offset:5120
  s_waitcnt lgkmcnt(6)
  v_mfma_f32_16x16x32_bf16 v[40:43], a[8:11], v[24:27], v[40:43]
  v_mfma_f32_16x16x32_bf16 v[44:47], a[64:67], v[24:27], v[44:47]
  v_mfma_f32_16x16x32_bf16 v[48:51], a[120:123], v[24:27], v[48:51]
  v_mfma_f32_16x16x32_bf16 v[52:55], a[176:179], v[24:27], v[52:55]
  ds_read_b128 v[20:23], v5 offset:19456
  s_waitcnt lgkmcnt(6)
  v_mfma_f32_16x16x32_bf16 v[56:59], a[8:11], v[28:31], v[56:59]
  v_mfma_f32_16x16x32_bf16 v[60:63], a[64:67], v[28:31], v[60:63]
  v_mfma_f32_16x16x32_bf16 v[64:67], a[120:123], v[28:31], v[64:67]
  v_mfma_f32_16x16x32_bf16 v[68:71], a[176:179], v[28:31], v[68:71]
  ds_read_b128 v[24:27], v5 offset:6144
  s_waitcnt lgkmcnt(6)
  v_mfma_f32_16x16x32_bf16 v[40:43], a[12:15], v[32:35], v[40:43]
  v_mfma_f32_16x16x32_bf16 v[44:47], a[68:71], v[32:35], v[44:47]
  v_mfma_f32_16x16x32_bf16 v[48:51], a[124:127], v[32:35], v[48:51]
  v_mfma_f32_16x16x32_bf16 v[52:55], a[180:183], v[32:35], v[52:55]
  ds_read_b128 v[28:31], v5 offset:20480
  s_waitcnt lgkmcnt(6)
  v_mfma_f32_16x16x32_bf16 v[56:59], a[12:15], v[36:39], v[56:59]
  v_mfma_f32_16x16x32_bf16 v[60:63], a[68:71], v[36:39], v[60:63]
  v_mfma_f32_16x16x32_bf16 v[64:67], a[124:127], v[36:39], v[64:67]
  v_mfma_f32_16x16x32_bf16 v[68:71], a[180:183], v[36:39], v[68:71]
  ds_read_b128 v[32:35], v5 offset:7168
  s_waitcnt lgkmcnt(6)
  v_mfma_f32_16x16x32_bf16 v[40:43], a[16:19], v[8:11], v[40:43]
  v_mfma_f32_16x16x32_bf16 v[44:47], a[72:75], v[8:11], v[44:47]
  v_mfma_f32_16x16x32_bf16 v[48:51], a[128:131], v[8:11], v[48:51]
  v_mfma_f32_16x16x32_bf16 v[52:55], a[184:187], v[8:11], v[52:55]
  ds_read_b128 v[36:39], v5 offset:21504
  s_waitcnt lgkmcnt(6)
  v_mfma_f32_16x16x32_bf16 v[56:59], a[16:19], v[12:15], v[56:59]
  v_mfma_f32_16x16x32_bf16 v[60:63], a[72:75], v[12:15], v[60:63]
  v_mfma_f32_16x16x32_bf16 v[64:67], a[128:131], v[12:15], v[64:67]
  v_mfma_f32_16x16x32_bf16 v[68:71], a[184:187], v[12:15], v[68:71]
  ds_read_b128 v[8:11], v5 offset:8192
  s_waitcnt lgkmcnt(6)
  v_mfma_f32_16x16x32_bf16 v[40:43], a[20:23], v[16:19], v[40:43]
  v_mfma_f32_16x16x32_bf16 v[44:47], a[76:79], v[16:19], v[44:47]
  v_mfma_f32_16x16x32_bf16 v[48:51], a[132:135], v[16:19], v[48:51]
  v_mfma_f32_16x16x32_bf16 v[52:55], a[188:191], v[16:19], v[52:55]
  ds_read_b128 v[12:15], v5 offset:22528
  s_waitcnt lgkmcnt(6)
  v_mfma_f32_16x16x32_bf16 v[56:59], a[20:23], v[20:23], v[56:59]
  v_mfma_f32_16x16x32_bf16 v[60:63], a[76:79], v[20:23], v[60:63]
  v_mfma_f32_16x16x32_bf16 v[64:67], a[132:135], v[20:23], v[64:67]
  v_mfma_f32_16x16x32_bf16 v[68:71], a[188:191], v[20:23], v[68:71]
  ds_read_b128 v[16:19], v5 offset:9216
  s_waitcnt lgkmcnt(6)
  v_mfma_f32_16x16x32_bf16 v[40:43], a[24:27], v[24:27], v[40:43]
  v_mfma_f32_16x16x32_bf16 v[44:47], a[80:83], v[24:27], v[44:47]
  v_mfma_f32_16x16x32_bf16 v[48:51], a[136:139], v[24:27], v[48:51]
  v_mfma_f32_16x16x32_bf16 v[52:55], a[192:195], v[24:27], v[52:55]
  ds_read_b128 v[20:23], v5 offset:23552
  s_waitcnt lgkmcnt(6)
  v_mfma_f32_16x16x32_bf16 v[56:59], a[24:27], v[28:31], v[56:59]
  v_mfma_f32_16x16x32_bf16 v[60:63], a[80:83], v[28:31], v[60:63]
  v_mfma_f32_16x16x32_bf16 v[64:67], a[136:139], v[28:31], v[64:67]
  v_mfma_f32_16x16x32_bf16 v[68:71], a[192:195], v[28:31], v[68:71]
  ds_read_b128 v[24:27], v5 offset:10240
  s_waitcnt lgkmcnt(6)
  v_mfma_f32_16x16x32_bf16 v[40:43], a[28:31], v[32:35], v[40:43]
  v_mfma_f32_16x16x32_bf16 v[44:47], a[84:87], v[32:35], v[44:47]
  v_mfma_f32_16x16x32_bf16 v[48:51], a[140:143], v[32:35], v[48:51]
  v_mfma_f32_16x16x32_bf16 v[52:55], a[196:199], v[32:35], v[52:55]
  ds_read_b128 v[28:31], v5 offset:24576
  s_waitcnt lgkmcnt(6)
  v_mfma_f32_16x16x32_bf16 v[56:59], a[28:31], v[36:39], v[56:59]
  v_mfma_f32_16x16x32_bf16 v[60:63], a[84:87], v[36:39], v[60:63]
  v_mfma_f32_16x16x32_bf16 v[64:67], a[140:143], v[36:39], v[64:67]
  v_mfma_f32_16x16x32_bf16 v[68:71], a[196:199], v[36:39], v[68:71]
  ds_read_b128 v[32:35], v5 offset:11264
  s_waitcnt lgkmcnt(6)
  v_mfma_f32_16x16x32_bf16 v[40:43], a[32:35], v[8:11], v[40:43]
  v_mfma_f32_16x16x32_bf16 v[44:47], a[88:91], v[8:11], v[44:47]
  v_mfma_f32_16x16x32_bf16 v[48:51], a[144:147], v[8:11], v[48:51]
  v_mfma_f32_16x16x32_bf16 v[52:55], a[200:203], v[8:11], v[52:55]
  ds_read_b128 v[36:39], v5 offset:25600
  s_waitcnt lgkmcnt(6)
  v_mfma_f32_16x16x32_bf16 v[56:59], a[32:35], v[12:15], v[56:59]
  v_mfma_f32_16x16x32_bf16 v[60:63], a[88:91], v[12:15], v[60:63]
  v_mfma_f32_16x16x32_bf16 v[64:67], a[144:147], v[12:15], v[64:67]
  v_mfma_f32_16x16x32_bf16 v[68:71], a[200:203], v[12:15], v[68:71]
  ds_read_b128 v[8:11], v5 offset:12288
  s_waitcnt lgkmcnt(6)
  v_mfma_f32_16x16x32_bf16 v[40:43], a[36:39], v[16:19], v[40:43]
  v_mfma_f32_16x16x32_bf16 v[44:47], a[92:95], v[16:19], v[44:47]
  v_mfma_f32_16x16x32_bf16 v[48:51], a[148:151], v[16:19], v[48:51]
  v_mfma_f32_16x16x32_bf16 v[52:55], a[204:207], v[16:19], v[52:55]
  ds_read_b128 v[12:15], v5 offset:26624
  s_waitcnt lgkmcnt(6)
  v_mfma_f32_16x16x32_bf16 v[56:59], a[36:39], v[20:23], v[56:59]
  v_mfma_f32_16x16x32_bf16 v[60:63], a[92:95], v[20:23], v[60:63]
  v_mfma_f32_16x16x32_bf16 v[64:67], a[148:151], v[20:23], v[64:67]
  v_mfma_f32_16x16x32_bf16 v[68:71], a[204:207], v[20:23], v[68:71]
  ds_read_b128 v[16:19], v5 offset:13312
  s_waitcnt lgkmcnt(6)
  v_mfma_f32_16x16x32_bf16 v[40:43], a[40:43], v[24:27], v[40:43]
  v_mfma_f32_16x16x32_bf16 v[44:47], a[96:99], v[24:27], v[44:47]
  v_mfma_f32_16x16x32_bf16 v[48:51], a[152:155], v[24:27], v[48:51]
  v_mfma_f32_16x16x32_bf16 v[52:55], a[208:211], v[24:27], v[52:55]
  ds_read_b128 v[20:23], v5 offset:27648
  s_waitcnt lgkmcnt(6)
  v_mfma_f32_16x16x32_bf16 v[56:59], a[40:43], v[28:31], v[56:59]
  v_mfma_f32_16x16x32_bf16 v[60:63], a[96:99], v[28:31], v[60:63]
  v_mfma_f32_16x16x32_bf16 v[64:67], a[152:155], v[28:31], v[64:67]
  v_mfma_f32_16x16x32_bf16 v[68:71], a[208:211], v[28:31], v[68:71]
  s_waitcnt lgkmcnt(5)
  v_mfma_f32_16x16x32_bf16 v[40:43], a[44:47], v[32:35], v[40:43]
  v_mfma_f32_16x16x32_bf16 v[44:47], a[100:103], v[32:35], v[44:47]
  v_mfma_f32_16x16x32_bf16 v[48:51], a[156:159], v[32:35], v[48:51]
  v_mfma_f32_16x16x32_bf16 v[52:55], a[212:215], v[32:35], v[52:55]
  s_waitcnt lgkmcnt(4)
  v_mfma_f32_16x16x32_bf16 v[56:59], a[44:47], v[36:39], v[56:59]
  v_mfma_f32_16x16x32_bf16 v[60:63], a[100:103], v[36:39], v[60:63]
  v_mfma_f32_16x16x32_bf16 v[64:67], a[156:159], v[36:39], v[64:67]
  v_mfma_f32_16x16x32_bf16 v[68:71], a[212:215], v[36:39], v[68:71]
  s_waitcnt lgkmcnt(3)
  v_mfma_f32_16x16x32_bf16 v[40:43], a[48:51], v[8:11], v[40:43]
  v_mfma_f32_16x16x32_bf16 v[44:47], a[104:107], v[8:11], v[44:47]
  v_mfma_f32_16x16x32_bf16 v[48:51], a[160:163], v[8:11], v[48:51]
  v_mfma_f32_16x16x32_bf16 v[52:55], a[216:219], v[8:11], v[52:55]
  s_waitcnt lgkmcnt(2)
  v_mfma_f32_16x16x32_bf16 v[56:59], a[48:51], v[12:15], v[56:59]
  v_mfma_f32_16x16x32_bf16 v[60:63], a[104:107], v[12:15], v[60:63]
  v_mfma_f32_16x16x32_bf16 v[64:67], a[160:163], v[12:15], v[64:67]
  v_mfma_f32_16x16x32_bf16 v[68:71], a[216:219], v[12:15], v[68:71]
  s_waitcnt lgkmcnt(1)
  v_mfma_f32_16x16x32_bf16 v[40:43], a[52:55], v[16:19], v[40:43]
  v_mfma_f32_16x16x32_bf16 v[44:47], a[108:111], v[16:19], v[44:47]
  v_mfma_f32_16x16x32_bf16 v[48:51], a[164:167], v[16:19], v[48:51]
  v_mfma_f32_16x16x32_bf16 v[52:55], a[220:223], v[16:19], v[52:55]
  s_waitcnt lgkmcnt(0)
  v_mfma_f32_16x16x32_bf16 v[56:59], a[52:55], v[20:23], v[56:59]
  v_mfma_f32_16x16x32_bf16 v[60:63], a[108:111], v[20:23], v[60:63]
  v_mfma_f32_16x16x32_bf16 v[64:67], a[164:167], v[20:23], v[64:67]
  v_mfma_f32_16x16x32_bf16 v[68:71], a[220:223], v[20:23], v[68:71]
  s_add_u32 s25, s29, 28672
  s_lshl_b32 s24, s19, 5
  s_add_u32 s24, s24, 0
  v_add_u32 v88, s24, v4
  v_mul_u32_u24 v89, 2341, v88
  v_lshrrev_b32 v89, 16, v89
  v_mul_u32_u24 v89, 84, v89
  v_add3_u32 v88, v88, v89, v6
  v_lshlrev_b32 v90, 4, v88
  v_cvt_pk_bf16_f32 v72, v40, v41
  v_cvt_pk_bf16_f32 v73, v42, v43
  v_cvt_pk_bf16_f32 v74, v44, v45
  v_cvt_pk_bf16_f32 v75, v46, v47
  buffer_store_dwordx4 v[72:75], v90, s[8:11], s29 offen sc1
  v_cvt_pk_bf16_f32 v76, v48, v49
  v_cvt_pk_bf16_f32 v77, v50, v51
  v_cvt_pk_bf16_f32 v78, v52, v53
  v_cvt_pk_bf16_f32 v79, v54, v55
  buffer_store_dwordx4 v[76:79], v90, s[8:11], s25 offen sc1
  s_lshl_b32 s24, s19, 5
  s_add_u32 s24, s24, 16
  v_add_u32 v88, s24, v4
  v_mul_u32_u24 v89, 2341, v88
  v_lshrrev_b32 v89, 16, v89
  v_mul_u32_u24 v89, 84, v89
  v_add3_u32 v88, v88, v89, v6
  v_lshlrev_b32 v91, 4, v88
  v_cvt_pk_bf16_f32 v80, v56, v57
  v_cvt_pk_bf16_f32 v81, v58, v59
  v_cvt_pk_bf16_f32 v82, v60, v61
  v_cvt_pk_bf16_f32 v83, v62, v63
  buffer_store_dwordx4 v[80:83], v91, s[8:11], s29 offen sc1
  v_cvt_pk_bf16_f32 v84, v64, v65
  v_cvt_pk_bf16_f32 v85, v66, v67
  v_cvt_pk_bf16_f32 v86, v68, v69
  v_cvt_pk_bf16_f32 v87, v70, v71
  buffer_store_dwordx4 v[84:87], v91, s[8:11], s25 offen sc1
  s_mov_b32 s33, s32
  s_add_u32 s32, s32, 28672
  s_cmp_eq_u32 s32, 86016
  s_cselect_b32 s32, 0, s32
  s_add_u32 s19, s19, 1
  s_cmp_lt_u32 s19, s35
  s_cbranch_scc1 wg_vo_loop
  s_branch wg_done
wg_done:
  s_lshl_b32 s20, s18, 4
  s_and_b32 s21, s17, 15
  s_add_u32 s20, s20, s21
  s_lshl_b32 s20, s20, 7
  s_cmp_lt_u32 s17, 16
  s_cselect_b32 s21, 16384, 0
  s_add_u32 s20, s20, s21
  s_add_u32 s20, s20, 88541184
  s_sub_u32 s21, s35, s34
  v_mov_b32 v5, s21
  v_mov_b32 v6, 0
  s_waitcnt vmcnt(0)
  s_mov_b64 exec, 1
  buffer_atomic_add v5, v6, s[8:11], s20 offen
  s_mov_b64 exec, -1
  s_branch wk_loop
wk_a:
  s_load_dwordx8 s[36:43], s[0:1], 56
  s_load_dwordx4 s[44:47], s[0:1], 88
  s_sub_u32 s3, s3, 432
  s_and_b32 s17, s3, 15
  s_lshr_b32 s19, s3, 5
  s_bitcmp1_b32 s3, 4
  s_cselect_b32 s31, 7, 0
  s_waitcnt lgkmcnt(0)
  s_mov_b32 s60, s40
  s_and_b32 s61, s41, 0xffff
  s_mov_b32 s62, 3670016
  s_mov_b32 s63, 0x20000
  s_mov_b32 s56, s42
  s_and_b32 s57, s43, 0xffff
  s_mov_b32 s58, 3670016
  s_mov_b32 s59, 0x20000
  s_lshl_b32 s30, s16, 13
  s_lshl_b32 s27, s19, 19
  s_lshl_b32 s29, s16, 17
  s_add_u32 s27, s27, s29
  s_lshl_b32 s29, s17, 9
  s_add_u32 s27, s27, s29
  v_lshrrev_b32 v5, 5, v1
  v_and_b32 v6, 31, v1
  v_xor_b32 v6, v6, v5
  v_lshlrev_b32 v6, 4, v6
  v_lshl_add_u32 v6, v5, 13, v6
  s_add_u32 m0, s30, 0
  s_add_u32 s22, s27, 0
  v_xor_b32 v7, 0, v6
  buffer_load_dwordx4 v7, s[56:59], s22 offen offset:0 lds
  s_add_u32 s22, s27, 15360
  v_xor_b32 v7, 32, v6
  buffer_load_dwordx4 v7, s[56:59], s22 offen offset:1024 lds
  s_add_u32 s22, s27, 30720
  v_xor_b32 v7, 64, v6
  buffer_load_dwordx4 v7, s[56:59], s22 offen offset:2048 lds
  s_add_u32 s22, s27, 46080
  v_xor_b32 v7, 96, v6
  buffer_load_dwordx4 v7, s[56:59], s22 offen offset:3072 lds
  s_add_u32 m0, s30, 4096
  s_add_u32 s22, s27, 65536
  v_xor_b32 v7, 128, v6
  buffer_load_dwordx4 v7, s[56:59], s22 offen offset:0 lds
  s_add_u32 s22, s27, 80896
  v_xor_b32 v7, 160, v6
  buffer_load_dwordx4 v7, s[56:59], s22 offen offset:1024 lds
  s_add_u32 s22, s27, 96256
  v_xor_b32 v7, 192, v6
  buffer_load_dwordx4 v7, s[56:59], s22 offen offset:2048 lds
  s_add_u32 s22, s27, 111616
  v_xor_b32 v7, 224, v6
  buffer_load_dwordx4 v7, s[56:59], s22 offen offset:3072 lds
  v_lshrrev_b32 v5, 5, v1
  v_and_b32 v6, 31, v1
  s_lshl_b32 s25, s16, 15
  s_add_u32 s25, s25, 32768
  s_lshl_b32 s26, s17, 9
  s_add_u32 s28, s19, s16
  s_cmp_ge_u32 s28, 7
  s_cselect_b32 s20, 7, 0
  s_sub_u32 s28, s28, s20
  s_add_u32 s28, s28, s31
  s_add_u32 s29, s19, s16
  s_add_u32 s29, s29, 4
  s_cmp_ge_u32 s29, 7
  s_cselect_b32 s20, 7, 0
  s_sub_u32 s29, s29, s20
  s_add_u32 s29, s29, s31
  s_lshl_b32 s32, s28, 18
  s_add_u32 s32, s32, s26
  s_lshl_b32 s33, s29, 18
  s_add_u32 s33, s33, s26
  v_xor_b32 v8, v6, v5
  v_lshlrev_b32 v8, 4, v8
  v_lshl_add_u32 v8, v5, 13, v8
  v_xor_b32 v12, 0, v8
  v_xor_b32 v13, 32, v8
  v_add_u32 v13, 15360, v13
  v_xor_b32 v14, 0, v8
  v_add_u32 v14, 30720, v14
  v_xor_b32 v15, 32, v8
  v_add_u32 v15, 46080, v15
  s_add_u32 s20, s16, 0
  s_and_b32 s20, s20, 3
  s_mul_i32 s21, s20, 65600
  s_lshl_b32 s20, s20, 12
  s_add_u32 s48, s20, s25
  s_mov_b32 m0, s48
  v_xor_b32 v16, s21, v12
  buffer_load_dwordx4 v16, s[60:63], s32 offen offset:0 lds
  v_xor_b32 v17, s21, v13
  buffer_load_dwordx4 v17, s[60:63], s32 offen offset:1024 lds
  v_xor_b32 v18, s21, v14
  buffer_load_dwordx4 v18, s[60:63], s32 offen offset:2048 lds
  v_xor_b32 v19, s21, v15
  buffer_load_dwordx4 v19, s[60:63], s32 offen offset:3072 lds
  s_add_u32 s20, s16, 1
  s_and_b32 s20, s20, 3
  s_mul_i32 s21, s20, 65600
  s_lshl_b32 s20, s20, 12
  s_add_u32 s49, s20, s25
  s_mov_b32 m0, s49
  v_xor_b32 v20, s21, v12
  buffer_load_dwordx4 v20, s[60:63], s32 offen offset:0 lds
  v_xor_b32 v21, s21, v13
  buffer_load_dwordx4 v21, s[60:63], s32 offen offset:1024 lds
  v_xor_b32 v22, s21, v14
  buffer_load_dwordx4 v22, s[60:63], s32 offen offset:2048 lds
  v_xor_b32 v23, s21, v15
  buffer_load_dwordx4 v23, s[60:63], s32 offen offset:3072 lds
  s_add_u32 s20, s16, 2
  s_and_b32 s20, s20, 3
  s_mul_i32 s21, s20, 65600
  s_lshl_b32 s20, s20, 12
  s_add_u32 s50, s20, s25
  s_mov_b32 m0, s50
  v_xor_b32 v24, s21, v12
  buffer_load_dwordx4 v24, s[60:63], s32 offen offset:0 lds
  v_xor_b32 v25, s21, v13
  buffer_load_dwordx4 v25, s[60:63], s32 offen offset:1024 lds
  v_xor_b32 v26, s21, v14
  buffer_load_dwordx4 v26, s[60:63], s32 offen offset:2048 lds
  v_xor_b32 v27, s21, v15
  buffer_load_dwordx4 v27, s[60:63], s32 offen offset:3072 lds
  s_add_u32 s20, s16, 3
  s_and_b32 s20, s20, 3
  s_mul_i32 s21, s20, 65600
  s_lshl_b32 s20, s20, 12
  s_add_u32 s51, s20, s25
  s_mov_b32 m0, s51
  v_xor_b32 v28, s21, v12
  buffer_load_dwordx4 v28, s[60:63], s32 offen offset:0 lds
  v_xor_b32 v29, s21, v13
  buffer_load_dwordx4 v29, s[60:63], s32 offen offset:1024 lds
  v_xor_b32 v30, s21, v14
  buffer_load_dwordx4 v30, s[60:63], s32 offen offset:2048 lds
  v_xor_b32 v31, s21, v15
  buffer_load_dwordx4 v31, s[60:63], s32 offen offset:3072 lds
  s_mul_i32 s30, s17, 401408
  s_mul_i32 s20, s19, 57344
  s_add_u32 s30, s30, s20
  v_add_u32 v12, s30, v2
  v_add_u32 v13, 14336, v12
  v_add_u32 v14, 28672, v12
  v_add_u32 v15, 43008, v12
  v_lshrrev_b32 v7, 2, v4
  v_lshlrev_b32 v7, 3, v7
  v_and_b32 v8, 3, v4
  v_add_u32 v7, v7, v8
  v_xor_b32 v10, v3, v4
  v_lshlrev_b32 v10, 4, v10
  v_lshl_add_u32 v10, v7, 9, v10
  v_add_u32 v10, s25, v10
  v_xor_b32 v32, 0, v10
  v_xor_b32 v33, 64, v10
  v_xor_b32 v34, 128, v10
  v_xor_b32 v35, 192, v10
  v_and_b32 v8, 2, v4
  v_lshlrev_b32 v8, 1, v8
  v_and_b32 v9, 1, v4
  v_add_u32 v8, v8, v9
  v_lshrrev_b32 v7, 2, v4
  v_lshl_add_u32 v7, v7, 4, v8
  v_xor_b32 v8, v8, v3
  v_lshlrev_b32 v8, 4, v8
  v_lshl_add_u32 v7, v7, 9, v8
  s_mov_b32 s24, 1035512379
  s_waitcnt vmcnt(16)
  s_barrier
  s_cmp_eq_u32 s16, 3
  s_cbranch_scc1 aj_np0
  s_add_u32 m0, s48, 16384
  s_nop 0
  buffer_load_dwordx4 v16, s[60:63], s33 offen offset:0 lds
  buffer_load_dwordx4 v17, s[60:63], s33 offen offset:1024 lds
  buffer_load_dwordx4 v18, s[60:63], s33 offen offset:2048 lds
  buffer_load_dwordx4 v19, s[60:63], s33 offen offset:3072 lds
aj_np0:
  v_xor_b32 v8, 0, v7
  ds_read_b128 v[128:131], v8 offset:0
  v_xor_b32 v9, 64, v7
  ds_read_b128 v[132:135], v9 offset:0
  v_xor_b32 v10, 128, v7
  ds_read_b128 v[136:139], v10 offset:0
  v_xor_b32 v11, 192, v7
  ds_read_b128 v[140:143], v11 offset:0
  ds_read_b128 v[144:147], v8 offset:256
  ds_read_b128 v[148:151], v9 offset:256
  ds_read_b128 v[152:155], v10 offset:256
  ds_read_b128 v[156:159], v11 offset:256
  s_waitcnt lgkmcnt(4)
  s_cmp_eq_u32 s16, 3
  s_cbranch_scc1 aj_np1
  s_add_u32 m0, s49, 16384
  s_nop 0
  buffer_load_dwordx4 v20, s[60:63], s33 offen offset:0 lds
  buffer_load_dwordx4 v21, s[60:63], s33 offen offset:1024 lds
  buffer_load_dwordx4 v22, s[60:63], s33 offen offset:2048 lds
  buffer_load_dwordx4 v23, s[60:63], s33 offen offset:3072 lds
aj_np1:
  v_xor_b32 v8, 32, v7
  ds_read_b128 v[160:163], v8 offset:1024
  v_xor_b32 v9, 96, v7
  ds_read_b128 v[164:167], v9 offset:1024
  v_xor_b32 v10, 160, v7
  ds_read_b128 v[168:171], v10 offset:1024
  v_xor_b32 v11, 224, v7
  ds_read_b128 v[172:175], v11 offset:1024
  ds_read_b128 v[176:179], v8 offset:1280
  ds_read_b128 v[180:183], v9 offset:1280
  ds_read_b128 v[184:187], v10 offset:1280
  ds_read_b128 v[188:191], v11 offset:1280
  s_waitcnt lgkmcnt(4)
  s_cmp_eq_u32 s16, 3
  s_cbranch_scc1 aj_np2
  s_add_u32 m0, s50, 16384
  s_nop 0
  buffer_load_dwordx4 v24, s[60:63], s33 offen offset:0 lds
  buffer_load_dwordx4 v25, s[60:63], s33 offen offset:1024 lds
  buffer_load_dwordx4 v26, s[60:63], s33 offen offset:2048 lds
  buffer_load_dwordx4 v27, s[60:63], s33 offen offset:3072 lds
aj_np2:
  v_xor_b32 v8, 128, v7
  ds_read_b128 v[192:195], v8 offset:4096
  v_xor_b32 v9, 192, v7
  ds_read_b128 v[196:199], v9 offset:4096
  v_xor_b32 v10, 0, v7
  ds_read_b128 v[200:203], v10 offset:4096
  v_xor_b32 v11, 64, v7
  ds_read_b128 v[204:207], v11 offset:4096
  ds_read_b128 v[208:211], v8 offset:4352
  ds_read_b128 v[212:215], v9 offset:4352
  ds_read_b128 v[216:219], v10 offset:4352
  ds_read_b128 v[220:223], v11 offset:4352
  s_waitcnt lgkmcnt(4)
  s_cmp_eq_u32 s16, 3
  s_cbranch_scc1 aj_np3
  s_add_u32 m0, s51, 16384
  s_nop 0
  buffer_load_dwordx4 v28, s[60:63], s33 offen offset:0 lds
  buffer_load_dwordx4 v29, s[60:63], s33 offen offset:1024 lds
  buffer_load_dwordx4 v30, s[60:63], s33 offen offset:2048 lds
  buffer_load_dwordx4 v31, s[60:63], s33 offen offset:3072 lds
aj_np3:
  v_xor_b32 v8, 160, v7
  ds_read_b128 v[224:227], v8 offset:5120
  v_xor_b32 v9, 224, v7
  ds_read_b128 v[228:231], v9 offset:5120
  v_xor_b32 v10, 32, v7
  ds_read_b128 v[232:235], v10 offset:5120
  v_xor_b32 v11, 96, v7
  ds_read_b128 v[236:239], v11 offset:5120
  ds_read_b128 v[240:243], v8 offset:5376
  ds_read_b128 v[244:247], v9 offset:5376
  ds_read_b128 v[248:251], v10 offset:5376
  ds_read_b128 v[252:255], v11 offset:5376
  s_waitcnt lgkmcnt(4)
  s_waitcnt vmcnt(16) lgkmcnt(0)
  s_cmp_lg_u32 s16, 3
  s_cbranch_scc1 w3_39
  s_waitcnt vmcnt(0)
w3_39:
  ds_read_b128 v[52:55], v32 offset:0
  ds_read_b128 v[56:59], v33 offset:0
  ds_read_b128 v[60:63], v34 offset:0
  ds_read_b128 v[64:67], v35 offset:0
  s_waitcnt lgkmcnt(3)
  v_mfma_f32_16x16x32_bf16 v[96:99], v[52:55], v[128:131], 0
  v_mfma_f32_16x16x32_bf16 v[100:103], v[52:55], v[160:163], 0
  v_mfma_f32_16x16x32_bf16 v[104:107], v[52:55], v[192:195], 0
  v_mfma_f32_16x16x32_bf16 v[108:111], v[52:55], v[224:227], 0
  ds_read_b128 v[52:55], v32 offset:256
  s_waitcnt lgkmcnt(3)
  v_mfma_f32_16x16x32_bf16 v[96:99], v[56:59], v[132:135], v[96:99]
  v_mfma_f32_16x16x32_bf16 v[100:103], v[56:59], v[164:167], v[100:103]
  v_mfma_f32_16x16x32_bf16 v[104:107], v[56:59], v[196:199], v[104:107]
  v_mfma_f32_16x16x32_bf16 v[108:111], v[56:59], v[228:231], v[108:111]
  ds_read_b128 v[56:59], v33 offset:256
  s_waitcnt lgkmcnt(3)
  v_mfma_f32_16x16x32_bf16 v[96:99], v[60:63], v[136:139], v[96:99]
  v_mfma_f32_16x16x32_bf16 v[100:103], v[60:63], v[168:171], v[100:103]
  v_mfma_f32_16x16x32_bf16 v[104:107], v[60:63], v[200:203], v[104:107]
  v_mfma_f32_16x16x32_bf16 v[108:111], v[60:63], v[232:235], v[108:111]
  ds_read_b128 v[60:63], v34 offset:256
  s_waitcnt lgkmcnt(3)
  v_mfma_f32_16x16x32_bf16 v[96:99], v[64:67], v[140:143], v[96:99]
  v_mfma_f32_16x16x32_bf16 v[100:103], v[64:67], v[172:175], v[100:103]
  v_mfma_f32_16x16x32_bf16 v[104:107], v[64:67], v[204:207], v[104:107]
  v_mfma_f32_16x16x32_bf16 v[108:111], v[64:67], v[236:239], v[108:111]
  ds_read_b128 v[64:67], v35 offset:256
  s_waitcnt lgkmcnt(3)
  v_mfma_f32_16x16x32_bf16 v[96:99], v[52:55], v[144:147], v[96:99]
  v_mfma_f32_16x16x32_bf16 v[100:103], v[52:55], v[176:179], v[100:103]
  v_mfma_f32_16x16x32_bf16 v[104:107], v[52:55], v[208:211], v[104:107]
  v_mfma_f32_16x16x32_bf16 v[108:111], v[52:55], v[240:243], v[108:111]
  ds_read_b128 v[52:55], v32 offset:2048
  s_waitcnt lgkmcnt(3)
  v_mfma_f32_16x16x32_bf16 v[96:99], v[56:59], v[148:151], v[96:99]
  v_mfma_f32_16x16x32_bf16 v[100:103], v[56:59], v[180:183], v[100:103]
  v_mfma_f32_16x16x32_bf16 v[104:107], v[56:59], v[212:215], v[104:107]
  v_mfma_f32_16x16x32_bf16 v[108:111], v[56:59], v[244:247], v[108:111]
  ds_read_b128 v[56:59], v33 offset:2048
  s_waitcnt lgkmcnt(3)
  v_mfma_f32_16x16x32_bf16 v[96:99], v[60:63], v[152:155], v[96:99]
  v_mfma_f32_16x16x32_bf16 v[100:103], v[60:63], v[184:187], v[100:103]
  v_mfma_f32_16x16x32_bf16 v[104:107], v[60:63], v[216:219], v[104:107]
  v_mfma_f32_16x16x32_bf16 v[108:111], v[60:63], v[248:251], v[108:111]
  ds_read_b128 v[60:63], v34 offset:2048
  s_waitcnt lgkmcnt(3)
  v_mfma_f32_16x16x32_bf16 v[96:99], v[64:67], v[156:159], v[96:99]
  v_mfma_f32_16x16x32_bf16 v[100:103], v[64:67], v[188:191], v[100:103]
  v_mfma_f32_16x16x32_bf16 v[104:107], v[64:67], v[220:223], v[104:107]
  v_mfma_f32_16x16x32_bf16 v[108:111], v[64:67], v[252:255], v[108:111]
  ds_read_b128 v[64:67], v35 offset:2048
  s_waitcnt lgkmcnt(3)
  v_mfma_f32_16x16x32_bf16 v[112:115], v[52:55], v[128:131], 0
  v_mfma_f32_16x16x32_bf16 v[116:119], v[52:55], v[160:163], 0
  v_mfma_f32_16x16x32_bf16 v[120:123], v[52:55], v[192:195], 0
  v_mfma_f32_16x16x32_bf16 v[124:127], v[52:55], v[224:227], 0
  ds_read_b128 v[52:55], v32 offset:2304
  s_waitcnt lgkmcnt(3)
  v_mfma_f32_16x16x32_bf16 v[112:115], v[56:59], v[132:135], v[112:115]
  v_mfma_f32_16x16x32_bf16 v[116:119], v[56:59], v[164:167], v[116:119]
  v_mfma_f32_16x16x32_bf16 v[120:123], v[56:59], v[196:199], v[120:123]
  v_mfma_f32_16x16x32_bf16 v[124:127], v[56:59], v[228:231], v[124:127]
  ds_read_b128 v[56:59], v33 offset:2304
  s_waitcnt lgkmcnt(3)
  v_mfma_f32_16x16x32_bf16 v[112:115], v[60:63], v[136:139], v[112:115]
  v_mfma_f32_16x16x32_bf16 v[116:119], v[60:63], v[168:171], v[116:119]
  v_mfma_f32_16x16x32_bf16 v[120:123], v[60:63], v[200:203], v[120:123]
  v_mfma_f32_16x16x32_bf16 v[124:127], v[60:63], v[232:235], v[124:127]
  ds_read_b128 v[60:63], v34 offset:2304
  s_waitcnt lgkmcnt(3)
  v_mfma_f32_16x16x32_bf16 v[112:115], v[64:67], v[140:143], v[112:115]
  v_mfma_f32_16x16x32_bf16 v[116:119], v[64:67], v[172:175], v[116:119]
  v_mfma_f32_16x16x32_bf16 v[120:123], v[64:67], v[204:207], v[120:123]
  v_mfma_f32_16x16x32_bf16 v[124:127], v[64:67], v[236:239], v[124:127]
  ds_read_b128 v[64:67], v35 offset:2304
  s_waitcnt lgkmcnt(3)
  v_mfma_f32_16x16x32_bf16 v[112:115], v[52:55], v[144:147], v[112:115]
  v_mfma_f32_16x16x32_bf16 v[116:119], v[52:55], v[176:179], v[116:119]
  v_mfma_f32_16x16x32_bf16 v[120:123], v[52:55], v[208:211], v[120:123]
  v_mfma_f32_16x16x32_bf16 v[124:127], v[52:55], v[240:243], v[124:127]
  s_waitcnt lgkmcnt(2)
  v_mfma_f32_16x16x32_bf16 v[112:115], v[56:59], v[148:151], v[112:115]
  v_mfma_f32_16x16x32_bf16 v[116:119], v[56:59], v[180:183], v[116:119]
  v_mfma_f32_16x16x32_bf16 v[120:123], v[56:59], v[212:215], v[120:123]
  v_mfma_f32_16x16x32_bf16 v[124:127], v[56:59], v[244:247], v[124:127]
  s_waitcnt lgkmcnt(1)
  v_mfma_f32_16x16x32_bf16 v[112:115], v[60:63], v[152:155], v[112:115]
  v_mfma_f32_16x16x32_bf16 v[116:119], v[60:63], v[184:187], v[116:119]
  v_mfma_f32_16x16x32_bf16 v[120:123], v[60:63], v[216:219], v[120:123]
  v_mfma_f32_16x16x32_bf16 v[124:127], v[60:63], v[248:251], v[124:127]
  s_waitcnt lgkmcnt(0)
  v_mfma_f32_16x16x32_bf16 v[112:115], v[64:67], v[156:159], v[112:115]
  v_mfma_f32_16x16x32_bf16 v[116:119], v[64:67], v[188:191], v[116:119]
  v_mfma_f32_16x16x32_bf16 v[120:123], v[64:67], v[220:223], v[120:123]
  v_mfma_f32_16x16x32_bf16 v[124:127], v[64:67], v[252:255], v[124:127]
  s_lshl_b32 s30, s28, 10
  v_mul_f32 v96, s24, v96
  v_mul_f32 v97, s24, v97
  v_mul_f32 v98, s24, v98
  v_mul_f32 v99, s24, v99
  v_cvt_pk_bf16_f32 v68, v96, v97
  v_cvt_pk_bf16_f32 v69, v98, v99
  v_mul_f32 v112, s24, v112
  v_mul_f32 v113, s24, v113
  v_mul_f32 v114, s24, v114
  v_mul_f32 v115, s24, v115
  v_cvt_pk_bf16_f32 v70, v112, v113
  v_cvt_pk_bf16_f32 v71, v114, v115
  buffer_store_dwordx4 v[68:71], v12, s[8:11], s30 offen sc1
  v_mul_f32 v100, s24, v100
  v_mul_f32 v101, s24, v101
  v_mul_f32 v102, s24, v102
  v_mul_f32 v103, s24, v103
  v_cvt_pk_bf16_f32 v72, v100, v101
  v_cvt_pk_bf16_f32 v73, v102, v103
  v_mul_f32 v116, s24, v116
  v_mul_f32 v117, s24, v117
  v_mul_f32 v118, s24, v118
  v_mul_f32 v119, s24, v119
  v_cvt_pk_bf16_f32 v74, v116, v117
  v_cvt_pk_bf16_f32 v75, v118, v119
  buffer_store_dwordx4 v[72:75], v13, s[8:11], s30 offen sc1
  v_mul_f32 v104, s24, v104
  v_mul_f32 v105, s24, v105
  v_mul_f32 v106, s24, v106
  v_mul_f32 v107, s24, v107
  v_cvt_pk_bf16_f32 v76, v104, v105
  v_cvt_pk_bf16_f32 v77, v106, v107
  v_mul_f32 v120, s24, v120
  v_mul_f32 v121, s24, v121
  v_mul_f32 v122, s24, v122
  v_mul_f32 v123, s24, v123
  v_cvt_pk_bf16_f32 v78, v120, v121
  v_cvt_pk_bf16_f32 v79, v122, v123
  buffer_store_dwordx4 v[76:79], v14, s[8:11], s30 offen sc1
  v_mul_f32 v108, s24, v108
  v_mul_f32 v109, s24, v109
  v_mul_f32 v110, s24, v110
  v_mul_f32 v111, s24, v111
  v_cvt_pk_bf16_f32 v80, v108, v109
  v_cvt_pk_bf16_f32 v81, v110, v111
  v_mul_f32 v124, s24, v124
  v_mul_f32 v125, s24, v125
  v_mul_f32 v126, s24, v126
  v_mul_f32 v127, s24, v127
  v_cvt_pk_bf16_f32 v82, v124, v125
  v_cvt_pk_bf16_f32 v83, v126, v127
  buffer_store_dwordx4 v[80:83], v15, s[8:11], s30 offen sc1
  s_cmp_eq_u32 s16, 3
  s_cbranch_scc1 aj_w3
  s_waitcnt vmcnt(4)
  ds_read_b128 v[52:55], v32 offset:16384
  ds_read_b128 v[56:59], v33 offset:16384
  ds_read_b128 v[60:63], v34 offset:16384
  ds_read_b128 v[64:67], v35 offset:16384
  s_waitcnt lgkmcnt(3)
  v_mfma_f32_16x16x32_bf16 v[96:99], v[52:55], v[128:131], 0
  v_mfma_f32_16x16x32_bf16 v[100:103], v[52:55], v[160:163], 0
  v_mfma_f32_16x16x32_bf16 v[104:107], v[52:55], v[192:195], 0
  v_mfma_f32_16x16x32_bf16 v[108:111], v[52:55], v[224:227], 0
  ds_read_b128 v[52:55], v32 offset:16640
  s_waitcnt lgkmcnt(3)
  v_mfma_f32_16x16x32_bf16 v[96:99], v[56:59], v[132:135], v[96:99]
  v_mfma_f32_16x16x32_bf16 v[100:103], v[56:59], v[164:167], v[100:103]
  v_mfma_f32_16x16x32_bf16 v[104:107], v[56:59], v[196:199], v[104:107]
  v_mfma_f32_16x16x32_bf16 v[108:111], v[56:59], v[228:231], v[108:111]
  ds_read_b128 v[56:59], v33 offset:16640
  s_waitcnt lgkmcnt(3)
  v_mfma_f32_16x16x32_bf16 v[96:99], v[60:63], v[136:139], v[96:99]
  v_mfma_f32_16x16x32_bf16 v[100:103], v[60:63], v[168:171], v[100:103]
  v_mfma_f32_16x16x32_bf16 v[104:107], v[60:63], v[200:203], v[104:107]
  v_mfma_f32_16x16x32_bf16 v[108:111], v[60:63], v[232:235], v[108:111]
  ds_read_b128 v[60:63], v34 offset:16640
  s_waitcnt lgkmcnt(3)
  v_mfma_f32_16x16x32_bf16 v[96:99], v[64:67], v[140:143], v[96:99]
  v_mfma_f32_16x16x32_bf16 v[100:103], v[64:67], v[172:175], v[100:103]
  v_mfma_f32_16x16x32_bf16 v[104:107], v[64:67], v[204:207], v[104:107]
  v_mfma_f32_16x16x32_bf16 v[108:111], v[64:67], v[236:239], v[108:111]
  ds_read_b128 v[64:67], v35 offset:16640
  s_waitcnt lgkmcnt(3)
  v_mfma_f32_16x16x32_bf16 v[96:99], v[52:55], v[144:147], v[96:99]
  v_mfma_f32_16x16x32_bf16 v[100:103], v[52:55], v[176:179], v[100:103]
  v_mfma_f32_16x16x32_bf16 v[104:107], v[52:55], v[208:211], v[104:107]
  v_mfma_f32_16x16x32_bf16 v[108:111], v[52:55], v[240:243], v[108:111]
  ds_read_b128 v[52:55], v32 offset:18432
  s_waitcnt lgkmcnt(3)
  v_mfma_f32_16x16x32_bf16 v[96:99], v[56:59], v[148:151], v[96:99]
  v_mfma_f32_16x16x32_bf16 v[100:103], v[56:59], v[180:183], v[100:103]
  v_mfma_f32_16x16x32_bf16 v[104:107], v[56:59], v[212:215], v[104:107]
  v_mfma_f32_16x16x32_bf16 v[108:111], v[56:59], v[244:247], v[108:111]
  ds_read_b128 v[56:59], v33 offset:18432
  s_waitcnt lgkmcnt(3)
  v_mfma_f32_16x16x32_bf16 v[96:99], v[60:63], v[152:155], v[96:99]
  v_mfma_f32_16x16x32_bf16 v[100:103], v[60:63], v[184:187], v[100:103]
  v_mfma_f32_16x16x32_bf16 v[104:107], v[60:63], v[216:219], v[104:107]
  v_mfma_f32_16x16x32_bf16 v[108:111], v[60:63], v[248:251], v[108:111]
  ds_read_b128 v[60:63], v34 offset:18432
  s_waitcnt lgkmcnt(3)
  v_mfma_f32_16x16x32_bf16 v[96:99], v[64:67], v[156:159], v[96:99]
  v_mfma_f32_16x16x32_bf16 v[100:103], v[64:67], v[188:191], v[100:103]
  v_mfma_f32_16x16x32_bf16 v[104:107], v[64:67], v[220:223], v[104:107]
  v_mfma_f32_16x16x32_bf16 v[108:111], v[64:67], v[252:255], v[108:111]
  ds_read_b128 v[64:67], v35 offset:18432
  s_waitcnt lgkmcnt(3)
  v_mfma_f32_16x16x32_bf16 v[112:115], v[52:55], v[128:131], 0
  v_mfma_f32_16x16x32_bf16 v[116:119], v[52:55], v[160:163], 0
  v_mfma_f32_16x16x32_bf16 v[120:123], v[52:55], v[192:195], 0
  v_mfma_f32_16x16x32_bf16 v[124:127], v[52:55], v[224:227], 0
  ds_read_b128 v[52:55], v32 offset:18688
  s_waitcnt lgkmcnt(3)
  v_mfma_f32_16x16x32_bf16 v[112:115], v[56:59], v[132:135], v[112:115]
  v_mfma_f32_16x16x32_bf16 v[116:119], v[56:59], v[164:167], v[116:119]
  v_mfma_f32_16x16x32_bf16 v[120:123], v[56:59], v[196:199], v[120:123]
  v_mfma_f32_16x16x32_bf16 v[124:127], v[56:59], v[228:231], v[124:127]
  ds_read_b128 v[56:59], v33 offset:18688
  s_waitcnt lgkmcnt(3)
  v_mfma_f32_16x16x32_bf16 v[112:115], v[60:63], v[136:139], v[112:115]
  v_mfma_f32_16x16x32_bf16 v[116:119], v[60:63], v[168:171], v[116:119]
  v_mfma_f32_16x16x32_bf16 v[120:123], v[60:63], v[200:203], v[120:123]
  v_mfma_f32_16x16x32_bf16 v[124:127], v[60:63], v[232:235], v[124:127]
  ds_read_b128 v[60:63], v34 offset:18688
  s_waitcnt lgkmcnt(3)
  v_mfma_f32_16x16x32_bf16 v[112:115], v[64:67], v[140:143], v[112:115]
  v_mfma_f32_16x16x32_bf16 v[116:119], v[64:67], v[172:175], v[116:119]
  v_mfma_f32_16x16x32_bf16 v[120:123], v[64:67], v[204:207], v[120:123]
  v_mfma_f32_16x16x32_bf16 v[124:127], v[64:67], v[236:239], v[124:127]
  ds_read_b128 v[64:67], v35 offset:18688
  s_waitcnt lgkmcnt(3)
  v_mfma_f32_16x16x32_bf16 v[112:115], v[52:55], v[144:147], v[112:115]
  v_mfma_f32_16x16x32_bf16 v[116:119], v[52:55], v[176:179], v[116:119]
  v_mfma_f32_16x16x32_bf16 v[120:123], v[52:55], v[208:211], v[120:123]
  v_mfma_f32_16x16x32_bf16 v[124:127], v[52:55], v[240:243], v[124:127]
  s_waitcnt lgkmcnt(2)
  v_mfma_f32_16x16x32_bf16 v[112:115], v[56:59], v[148:151], v[112:115]
  v_mfma_f32_16x16x32_bf16 v[116:119], v[56:59], v[180:183], v[116:119]
  v_mfma_f32_16x16x32_bf16 v[120:123], v[56:59], v[212:215], v[120:123]
  v_mfma_f32_16x16x32_bf16 v[124:127], v[56:59], v[244:247], v[124:127]
  s_waitcnt lgkmcnt(1)
  v_mfma_f32_16x16x32_bf16 v[112:115], v[60:63], v[152:155], v[112:115]
  v_mfma_f32_16x16x32_bf16 v[116:119], v[60:63], v[184:187], v[116:119]
  v_mfma_f32_16x16x32_bf16 v[120:123], v[60:63], v[216:219], v[120:123]
  v_mfma_f32_16x16x32_bf16 v[124:127], v[60:63], v[248:251], v[124:127]
  s_waitcnt lgkmcnt(0)
  v_mfma_f32_16x16x32_bf16 v[112:115], v[64:67], v[156:159], v[112:115]
  v_mfma_f32_16x16x32_bf16 v[116:119], v[64:67], v[188:191], v[116:119]
  v_mfma_f32_16x16x32_bf16 v[120:123], v[64:67], v[220:223], v[120:123]
  v_mfma_f32_16x16x32_bf16 v[124:127], v[64:67], v[252:255], v[124:127]
  s_lshl_b32 s30, s29, 10
  v_mul_f32 v96, s24, v96
  v_mul_f32 v97, s24, v97
  v_mul_f32 v98, s24, v98
  v_mul_f32 v99, s24, v99
  v_cvt_pk_bf16_f32 v68, v96, v97
  v_cvt_pk_bf16_f32 v69, v98, v99
  v_mul_f32 v112, s24, v112
  v_mul_f32 v113, s24, v113
  v_mul_f32 v114, s24, v114
  v_mul_f32 v115, s24, v115
  v_cvt_pk_bf16_f32 v70, v112, v113
  v_cvt_pk_bf16_f32 v71, v114, v115
  buffer_store_dwordx4 v[68:71], v12, s[8:11], s30 offen sc1
  v_mul_f32 v100, s24, v100
  v_mul_f32 v101, s24, v101
  v_mul_f32 v102, s24, v102
  v_mul_f32 v103, s24, v103
  v_cvt_pk_bf16_f32 v72, v100, v101
  v_cvt_pk_bf16_f32 v73, v102, v103
  v_mul_f32 v116, s24, v116
  v_mul_f32 v117, s24, v117
  v_mul_f32 v118, s24, v118
  v_mul_f32 v119, s24, v119
  v_cvt_pk_bf16_f32 v74, v116, v117
  v_cvt_pk_bf16_f32 v75, v118, v119
  buffer_store_dwordx4 v[72:75], v13, s[8:11], s30 offen sc1
  v_mul_f32 v104, s24, v104
  v_mul_f32 v105, s24, v105
  v_mul_f32 v106, s24, v106
  v_mul_f32 v107, s24, v107
  v_cvt_pk_bf16_f32 v76, v104, v105
  v_cvt_pk_bf16_f32 v77, v106, v107
  v_mul_f32 v120, s24, v120
  v_mul_f32 v121, s24, v121
  v_mul_f32 v122, s24, v122
  v_mul_f32 v123, s24, v123
  v_cvt_pk_bf16_f32 v78, v120, v121
  v_cvt_pk_bf16_f32 v79, v122, v123
  buffer_store_dwordx4 v[76:79], v14, s[8:11], s30 offen sc1
  v_mul_f32 v108, s24, v108
  v_mul_f32 v109, s24, v109
  v_mul_f32 v110, s24, v110
  v_mul_f32 v111, s24, v111
  v_cvt_pk_bf16_f32 v80, v108, v109
  v_cvt_pk_bf16_f32 v81, v110, v111
  v_mul_f32 v124, s24, v124
  v_mul_f32 v125, s24, v125
  v_mul_f32 v126, s24, v126
  v_mul_f32 v127, s24, v127
  v_cvt_pk_bf16_f32 v82, v124, v125
  v_cvt_pk_bf16_f32 v83, v126, v127
  buffer_store_dwordx4 v[80:83], v15, s[8:11], s30 offen sc1
aj_w3:
  s_lshl_b32 s28, s17, 7
  s_lshl_b32 s21, s19, 4
  s_add_u32 s28, s28, s21
  s_cmp_lg_u32 s31, 0
  s_cselect_b32 s21, 8, 0
  s_add_u32 s28, s28, s21
  s_add_u32 s28, s28, 88633344
  s_waitcnt vmcnt(0)
  s_barrier
  s_cmp_lg_u32 s16, 0
  s_cbranch_scc1 pub_40
  v_mul_u32_u24 v26, 2048, v1
  v_mov_b32 v24, s88
  v_mov_b32 v25, s89
  s_mov_b64 exec, 1
  buffer_store_dwordx2 v[24:25], v26, s[8:11], s28 offen sc1
  s_mov_b64 exec, -1
pub_40:
  v_mov_b32 v250, 0
  s_branch wk_loop
wk_srv:
  s_sub_u32 s3, s3, 224
  s_and_b32 s18, s3, 15
  s_lshr_b32 s19, s3, 4
  s_and_b32 s19, s19, 1
  s_mul_i32 s20, s18, 401408
  s_mul_i32 s21, s16, 100352
  s_add_u32 s20, s20, s21
  s_add_u32 s20, s20, 6422528
  s_add_u32 s22, s20, 0
  buffer_load_dwordx4 a[0:3], v2, s[8:11], s22 offen offset:0 sc1
  buffer_load_dwordx4 a[4:7], v2, s[8:11], s22 offen offset:1024 sc1
  buffer_load_dwordx4 a[8:11], v2, s[8:11], s22 offen offset:2048 sc1
  buffer_load_dwordx4 a[12:15], v2, s[8:11], s22 offen offset:3072 sc1
  s_add_u32 s22, s20, 4096
  buffer_load_dwordx4 a[16:19], v2, s[8:11], s22 offen offset:0 sc1
  buffer_load_dwordx4 a[20:23], v2, s[8:11], s22 offen offset:1024 sc1
  buffer_load_dwordx4 a[24:27], v2, s[8:11], s22 offen offset:2048 sc1
  buffer_load_dwordx4 a[28:31], v2, s[8:11], s22 offen offset:3072 sc1
  s_add_u32 s22, s20, 8192
  buffer_load_dwordx4 a[32:35], v2, s[8:11], s22 offen offset:0 sc1
  buffer_load_dwordx4 a[36:39], v2, s[8:11], s22 offen offset:1024 sc1
  buffer_load_dwordx4 a[40:43], v2, s[8:11], s22 offen offset:2048 sc1
  buffer_load_dwordx4 a[44:47], v2, s[8:11], s22 offen offset:3072 sc1
  s_add_u32 s22, s20, 12288
  buffer_load_dwordx4 a[48:51], v2, s[8:11], s22 offen offset:0 sc1
  buffer_load_dwordx4 a[52:55], v2, s[8:11], s22 offen offset:1024 sc1
  buffer_load_dwordx4 a[56:59], v2, s[8:11], s22 offen offset:2048 sc1
  buffer_load_dwordx4 a[60:63], v2, s[8:11], s22 offen offset:3072 sc1
  s_add_u32 s22, s20, 16384
  buffer_load_dwordx4 a[64:67], v2, s[8:11], s22 offen offset:0 sc1
  buffer_load_dwordx4 a[68:71], v2, s[8:11], s22 offen offset:1024 sc1
  buffer_load_dwordx4 a[72:75], v2, s[8:11], s22 offen offset:2048 sc1
  buffer_load_dwordx4 a[76:79], v2, s[8:11], s22 offen offset:3072 sc1
  s_add_u32 s22, s20, 20480
  buffer_load_dwordx4 a[80:83], v2, s[8:11], s22 offen offset:0 sc1
  buffer_load_dwordx4 a[84:87], v2, s[8:11], s22 offen offset:1024 sc1
  buffer_load_dwordx4 a[88:91], v2, s[8:11], s22 offen offset:2048 sc1
  buffer_load_dwordx4 a[92:95], v2, s[8:11], s22 offen offset:3072 sc1
  s_add_u32 s22, s20, 24576
  buffer_load_dwordx4 a[96:99], v2, s[8:11], s22 offen offset:0 sc1
  buffer_load_dwordx4 a[100:103], v2, s[8:11], s22 offen offset:1024 sc1
  buffer_load_dwordx4 a[104:107], v2, s[8:11], s22 offen offset:2048 sc1
  buffer_load_dwordx4 a[108:111], v2, s[8:11], s22 offen offset:3072 sc1
  s_add_u32 s22, s20, 28672
  buffer_load_dwordx4 a[112:115], v2, s[8:11], s22 offen offset:0 sc1
  buffer_load_dwordx4 a[116:119], v2, s[8:11], s22 offen offset:1024 sc1
  buffer_load_dwordx4 a[120:123], v2, s[8:11], s22 offen offset:2048 sc1
  buffer_load_dwordx4 a[124:127], v2, s[8:11], s22 offen offset:3072 sc1
  s_waitcnt vmcnt(24)
  s_add_u32 s22, s20, 32768
  buffer_load_dwordx4 a[128:131], v2, s[8:11], s22 offen offset:0 sc1
  buffer_load_dwordx4 a[132:135], v2, s[8:11], s22 offen offset:1024 sc1
  buffer_load_dwordx4 a[136:139], v2, s[8:11], s22 offen offset:2048 sc1
  buffer_load_dwordx4 a[140:143], v2, s[8:11], s22 offen offset:3072 sc1
  s_add_u32 s22, s20, 36864
  buffer_load_dwordx4 a[144:147], v2, s[8:11], s22 offen offset:0 sc1
  buffer_load_dwordx4 a[148:151], v2, s[8:11], s22 offen offset:1024 sc1
  buffer_load_dwordx4 a[152:155], v2, s[8:11], s22 offen offset:2048 sc1
  buffer_load_dwordx4 a[156:159], v2, s[8:11], s22 offen offset:3072 sc1
  s_add_u32 s22, s20, 40960
  buffer_load_dwordx4 a[160:163], v2, s[8:11], s22 offen offset:0 sc1
  buffer_load_dwordx4 a[164:167], v2, s[8:11], s22 offen offset:1024 sc1
  buffer_load_dwordx4 a[168:171], v2, s[8:11], s22 offen offset:2048 sc1
  buffer_load_dwordx4 a[172:175], v2, s[8:11], s22 offen offset:3072 sc1
  s_add_u32 s22, s20, 45056
  buffer_load_dwordx4 a[176:179], v2, s[8:11], s22 offen offset:0 sc1
  buffer_load_dwordx4 a[180:183], v2, s[8:11], s22 offen offset:1024 sc1
  buffer_load_dwordx4 a[184:187], v2, s[8:11], s22 offen offset:2048 sc1
  buffer_load_dwordx4 a[188:191], v2, s[8:11], s22 offen offset:3072 sc1
  s_add_u32 s22, s20, 49152
  buffer_load_dwordx4 a[192:195], v2, s[8:11], s22 offen offset:0 sc1
  buffer_load_dwordx4 a[196:199], v2, s[8:11], s22 offen offset:1024 sc1
  buffer_load_dwordx4 a[200:203], v2, s[8:11], s22 offen offset:2048 sc1
  buffer_load_dwordx4 a[204:207], v2, s[8:11], s22 offen offset:3072 sc1
  s_add_u32 s22, s20, 53248
  buffer_load_dwordx4 a[208:211], v2, s[8:11], s22 offen offset:0 sc1
  buffer_load_dwordx4 a[212:215], v2, s[8:11], s22 offen offset:1024 sc1
  buffer_load_dwordx4 a[216:219], v2, s[8:11], s22 offen offset:2048 sc1
  buffer_load_dwordx4 a[220:223], v2, s[8:11], s22 offen offset:3072 sc1
  s_add_u32 s22, s20, 57344
  buffer_load_dwordx4 a[224:227], v2, s[8:11], s22 offen offset:0 sc1
  buffer_load_dwordx4 a[228:231], v2, s[8:11], s22 offen offset:1024 sc1
  buffer_load_dwordx4 a[232:235], v2, s[8:11], s22 offen offset:2048 sc1
  buffer_load_dwordx4 a[236:239], v2, s[8:11], s22 offen offset:3072 sc1
  s_add_u32 s22, s20, 61440
  buffer_load_dwordx4 a[240:243], v2, s[8:11], s22 offen offset:0 sc1
  buffer_load_dwordx4 a[244:247], v2, s[8:11], s22 offen offset:1024 sc1
  buffer_load_dwordx4 a[248:251], v2, s[8:11], s22 offen offset:2048 sc1
  buffer_load_dwordx4 a[252:255], v2, s[8:11], s22 offen offset:3072 sc1
  s_waitcnt vmcnt(24)
  s_add_u32 s22, s20, 65536
  buffer_load_dwordx4 v[120:123], v2, s[8:11], s22 offen offset:0 sc1
  buffer_load_dwordx4 v[124:127], v2, s[8:11], s22 offen offset:1024 sc1
  buffer_load_dwordx4 v[128:131], v2, s[8:11], s22 offen offset:2048 sc1
  buffer_load_dwordx4 v[132:135], v2, s[8:11], s22 offen offset:3072 sc1
  s_add_u32 s22, s20, 69632
  buffer_load_dwordx4 v[136:139], v2, s[8:11], s22 offen offset:0 sc1
  buffer_load_dwordx4 v[140:143], v2, s[8:11], s22 offen offset:1024 sc1
  buffer_load_dwordx4 v[144:147], v2, s[8:11], s22 offen offset:2048 sc1
  buffer_load_dwordx4 v[148:151], v2, s[8:11], s22 offen offset:3072 sc1
  s_add_u32 s22, s20, 73728
  buffer_load_dwordx4 v[152:155], v2, s[8:11], s22 offen offset:0 sc1
  buffer_load_dwordx4 v[156:159], v2, s[8:11], s22 offen offset:1024 sc1
  buffer_load_dwordx4 v[160:163], v2, s[8:11], s22 offen offset:2048 sc1
  buffer_load_dwordx4 v[164:167], v2, s[8:11], s22 offen offset:3072 sc1
  s_add_u32 s22, s20, 77824
  buffer_load_dwordx4 v[168:171], v2, s[8:11], s22 offen offset:0 sc1
  buffer_load_dwordx4 v[172:175], v2, s[8:11], s22 offen offset:1024 sc1
  buffer_load_dwordx4 v[176:179], v2, s[8:11], s22 offen offset:2048 sc1
  buffer_load_dwordx4 v[180:183], v2, s[8:11], s22 offen offset:3072 sc1
  s_add_u32 s22, s20, 81920
  buffer_load_dwordx4 v[184:187], v2, s[8:11], s22 offen offset:0 sc1
  buffer_load_dwordx4 v[188:191], v2, s[8:11], s22 offen offset:1024 sc1
  buffer_load_dwordx4 v[192:195], v2, s[8:11], s22 offen offset:2048 sc1
  buffer_load_dwordx4 v[196:199], v2, s[8:11], s22 offen offset:3072 sc1
  s_add_u32 s22, s20, 86016
  buffer_load_dwordx4 v[200:203], v2, s[8:11], s22 offen offset:0 sc1
  buffer_load_dwordx4 v[204:207], v2, s[8:11], s22 offen offset:1024 sc1
  buffer_load_dwordx4 v[208:211], v2, s[8:11], s22 offen offset:2048 sc1
  buffer_load_dwordx4 v[212:215], v2, s[8:11], s22 offen offset:3072 sc1
  s_add_u32 s22, s20, 90112
  buffer_load_dwordx4 v[216:219], v2, s[8:11], s22 offen offset:0 sc1
  buffer_load_dwordx4 v[220:223], v2, s[8:11], s22 offen offset:1024 sc1
  buffer_load_dwordx4 v[224:227], v2, s[8:11], s22 offen offset:2048 sc1
  buffer_load_dwordx4 v[228:231], v2, s[8:11], s22 offen offset:3072 sc1
  s_add_u32 s22, s20, 94208
  buffer_load_dwordx4 v[232:235], v2, s[8:11], s22 offen offset:0 sc1
  buffer_load_dwordx4 v[236:239], v2, s[8:11], s22 offen offset:1024 sc1
  buffer_load_dwordx4 v[240:243], v2, s[8:11], s22 offen offset:2048 sc1
  buffer_load_dwordx4 v[244:247], v2, s[8:11], s22 offen offset:3072 sc1
  s_waitcnt vmcnt(24)
  s_add_u32 s22, s20, 98304
  buffer_load_dwordx4 v[248:251], v2, s[8:11], s22 offen offset:0 sc1
  buffer_load_dwordx4 v[252:255], v2, s[8:11], s22 offen offset:1024 sc1
  v_mov_b32 v5, 0x4444
  v_mov_b32 v6, 0xeeee
  v_cmp_lt_u32 vcc, 7, v4
  s_nop 1
  v_cndmask_b32 v5, v5, v6, vcc
  s_lshl_b32 s23, s16, 11
  v_lshrrev_b32 v80, 1, v3
  v_and_b32 v81, 1, v3
  v_add_u32 v82, 0, v80
  v_lshl_add_u32 v82, v82, 4, v4
  v_mul_u32_u24 v83, 2341, v82
  v_lshrrev_b32 v83, 16, v83
  v_mul_u32_u24 v84, 28, v83
  v_sub_u32 v84, v82, v84
  v_lshrrev_b32 v85, 4, v84
  v_and_b32 v84, 15, v84
  v_lshlrev_b32 v86, 10, v85
  v_lshl_add_u32 v86, v83, 8, v86
  v_lshl_add_u32 v86, v84, 4, v86
  v_lshl_add_u32 v86, v81, 3, v86
  v_add_u32 v72, s23, v86
  v_add_u32 v82, 2, v80
  v_lshl_add_u32 v82, v82, 4, v4
  v_mul_u32_u24 v83, 2341, v82
  v_lshrrev_b32 v83, 16, v83
  v_mul_u32_u24 v84, 28, v83
  v_sub_u32 v84, v82, v84
  v_lshrrev_b32 v85, 4, v84
  v_and_b32 v84, 15, v84
  v_lshlrev_b32 v86, 10, v85
  v_lshl_add_u32 v86, v83, 8, v86
  v_lshl_add_u32 v86, v84, 4, v86
  v_lshl_add_u32 v86, v81, 3, v86
  v_add_u32 v73, s23, v86
  v_add_u32 v82, 4, v80
  v_lshl_add_u32 v82, v82, 4, v4
  v_mul_u32_u24 v83, 2341, v82
  v_lshrrev_b32 v83, 16, v83
  v_mul_u32_u24 v84, 28, v83
  v_sub_u32 v84, v82, v84
  v_lshrrev_b32 v85, 4, v84
  v_and_b32 v84, 15, v84
  v_lshlrev_b32 v86, 10, v85
  v_lshl_add_u32 v86, v83, 8, v86
  v_lshl_add_u32 v86, v84, 4, v86
  v_lshl_add_u32 v86, v81, 3, v86
  v_add_u32 v74, s23, v86
  v_mov_b32 v82, 6
  v_lshl_add_u32 v82, v82, 4, v4
  v_mul_u32_u24 v83, 2341, v82
  v_lshrrev_b32 v83, 16, v83
  v_mul_u32_u24 v84, 28, v83
  v_sub_u32 v84, v82, v84
  v_lshrrev_b32 v85, 4, v84
  v_and_b32 v84, 15, v84
  v_lshlrev_b32 v86, 10, v85
  v_lshl_add_u32 v86, v83, 8, v86
  v_lshl_add_u32 v86, v84, 4, v86
  v_lshl_add_u32 v86, v81, 3, v86
  v_add_u32 v75, s23, v86
  v_add_u32 v76, s23, v2
  s_mul_i32 s27, s18, 448
  v_mov_b32 v77, s27
  v_mov_b32 v78, 1
  s_mov_b32 s17, s19
  s_mul_i32 s24, s19, 7168
  s_add_u32 s24, s24, 88080384
  s_mul_i32 s25, s18, 65
  s_add_u32 s25, s25, s19
  s_lshl_b32 s25, s25, 13
  s_add_u32 s25, s25, s23
  s_add_u32 s25, s25, 76947456
  s_lshl_b32 s26, s18, 6
  s_add_u32 s26, s26, s19
  s_lshl_b32 s26, s26, 4
  s_lshl_b32 s27, s16, 2
  s_add_u32 s26, s26, s27
  s_add_u32 s26, s26, 88582144
  v_mov_b32 v87, -1
ws_loop:
  v_mov_b32 v36, 0
  v_mov_b32 v37, 0
  v_mov_b32 v38, 0
  v_mov_b32 v39, 0
  v_mov_b32 v40, 0
  v_mov_b32 v41, 0
  v_mov_b32 v42, 0
  v_mov_b32 v43, 0
  v_mov_b32 v44, 0
  v_mov_b32 v45, 0
  v_mov_b32 v46, 0
  v_mov_b32 v47, 0
  v_mov_b32 v48, 0
  v_mov_b32 v49, 0
  v_mov_b32 v50, 0
  v_mov_b32 v51, 0
  v_mov_b32 v52, 0
  v_mov_b32 v53, 0
  v_mov_b32 v54, 0
  v_mov_b32 v55, 0
  v_mov_b32 v56, 0
  v_mov_b32 v57, 0
  v_mov_b32 v58, 0
  v_mov_b32 v59, 0
  v_mov_b32 v60, 0
  v_mov_b32 v61, 0
  v_mov_b32 v62, 0
  v_mov_b32 v63, 0
  s_mov_b32 s30, 0
  v_cmp_eq_u32 vcc, -1, v87
  s_cbranch_vccz ws_fl
ws_pm:
  s_cmp_ge_u32 s17, 61
  s_cbranch_scc1 mp_41a
  v_mov_b32 v79, 0
  s_mov_b64 exec, 1
  buffer_atomic_or v79, v77, s[8:11], s24 offen sc0
  s_mov_b64 exec, -1
  s_branch mp_41b
mp_41a:
  buffer_load_dword v79, v77, s[8:11], s24 offen sc1
mp_41b:
  s_waitcnt vmcnt(0)
  v_cmp_eq_u32 vcc, -1, v79
  s_cbranch_vccnz ws_pr
ws_fl:
  s_add_u32 s22, s24, 4096
  buffer_load_dwordx4 v[8:11], v2, s[8:11], s24 offen offset:0 sc1
  buffer_load_dwordx4 v[12:15], v2, s[8:11], s24 offen offset:1024 sc1
  buffer_load_dwordx4 v[16:19], v2, s[8:11], s24 offen offset:2048 sc1
  buffer_load_dwordx4 v[20:23], v2, s[8:11], s24 offen offset:3072 sc1
  buffer_load_dwordx4 v[24:27], v2, s[8:11], s22 offen offset:0 sc1
  buffer_load_dwordx4 v[28:31], v2, s[8:11], s22 offen offset:1024 sc1
  buffer_load_dwordx4 v[32:35], v2, s[8:11], s22 offen offset:2048 sc1
  s_waitcnt vmcnt(0)
  v_max_u32 v79, v8, v9
  v_max3_u32 v79, v79, v10, v11
  v_max3_u32 v79, v79, v12, v13
  v_max3_u32 v79, v79, v14, v15
  v_max3_u32 v79, v79, v16, v17
  v_max3_u32 v79, v79, v18, v19
  v_max3_u32 v79, v79, v20, v21
  v_max3_u32 v79, v79, v22, v23
  v_max3_u32 v79, v79, v24, v25
  v_max3_u32 v79, v79, v26, v27
  v_max3_u32 v79, v79, v28, v29
  v_max3_u32 v79, v79, v30, v31
  v_max3_u32 v79, v79, v32, v33
  v_max3_u32 v79, v79, v34, v35
  v_cmp_eq_u32 vcc, -1, v79
  s_cbranch_vccz ws_pk
ws_pr:
  s_sleep 1
  s_cmp_ge_u32 s17, 61
  s_cbranch_scc1 ws_sh
  s_sleep 6
ws_sh:
  s_add_u32 s30, s30, 1
  s_cmp_lt_u32 s30, 30000
  s_cbranch_scc1 ws_pm
  s_branch cA_abort
ws_pk:
  s_cmp_ge_u32 s17, 62
  s_cbranch_scc1 ws_na
  s_add_u32 s22, s24, 14336
  s_cmp_ge_u32 s17, 61
  s_cbranch_scc1 mp_42a
  v_mov_b32 v87, 0
  s_mov_b64 exec, 1
  buffer_atomic_or v87, v77, s[8:11], s22 offen sc0
  s_mov_b64 exec, -1
  s_branch mp_42b
mp_42a:
  buffer_load_dword v87, v77, s[8:11], s22 offen sc1
mp_42b:
ws_na:
  v_smfmac_f32_16x16x64_bf16 v[36:39], v[8:11], a[0:7], v5
  v_smfmac_f32_16x16x64_bf16 v[36:39], v[12:15], a[8:15], v5
  v_smfmac_f32_16x16x64_bf16 v[36:39], v[16:19], a[16:23], v5
  v_smfmac_f32_16x16x64_bf16 v[36:39], v[20:23], a[24:31], v5
  v_smfmac_f32_16x16x64_bf16 v[36:39], v[24:27], a[32:39], v5
  v_smfmac_f32_16x16x64_bf16 v[36:39], v[28:31], a[40:47], v5
  v_smfmac_f32_16x16x64_bf16 v[36:39], v[32:35], a[48:55], v5
  v_smfmac_f32_16x16x64_bf16 v[40:43], v[8:11], a[56:63], v5
  v_smfmac_f32_16x16x64_bf16 v[40:43], v[12:15], a[64:71], v5
  v_smfmac_f32_16x16x64_bf16 v[40:43], v[16:19], a[72:79], v5
  v_smfmac_f32_16x16x64_bf16 v[40:43], v[20:23], a[80:87], v5
  v_smfmac_f32_16x16x64_bf16 v[40:43], v[24:27], a[88:95], v5
  v_smfmac_f32_16x16x64_bf16 v[40:43], v[28:31], a[96:103], v5
  v_smfmac_f32_16x16x64_bf16 v[40:43], v[32:35], a[104:111], v5
  v_smfmac_f32_16x16x64_bf16 v[44:47], v[8:11], a[112:119], v5
  v_smfmac_f32_16x16x64_bf16 v[44:47], v[12:15], a[120:127], v5
  v_smfmac_f32_16x16x64_bf16 v[44:47], v[16:19], a[128:135], v5
  v_smfmac_f32_16x16x64_bf16 v[44:47], v[20:23], a[136:143], v5
  v_smfmac_f32_16x16x64_bf16 v[44:47], v[24:27], a[144:151], v5
  v_smfmac_f32_16x16x64_bf16 v[44:47], v[28:31], a[152:159], v5
  v_smfmac_f32_16x16x64_bf16 v[44:47], v[32:35], a[160:167], v5
  v_smfmac_f32_16x16x64_bf16 v[48:51], v[8:11], a[168:175], v5
  v_smfmac_f32_16x16x64_bf16 v[48:51], v[12:15], a[176:183], v5
  v_smfmac_f32_16x16x64_bf16 v[48:51], v[16:19], a[184:191], v5
  v_smfmac_f32_16x16x64_bf16 v[48:51], v[20:23], a[192:199], v5
  v_smfmac_f32_16x16x64_bf16 v[48:51], v[24:27], a[200:207], v5
  v_smfmac_f32_16x16x64_bf16 v[48:51], v[28:31], a[208:215], v5
  v_smfmac_f32_16x16x64_bf16 v[48:51], v[32:35], a[216:223], v5
  v_smfmac_f32_16x16x64_bf16 v[52:55], v[8:11], a[224:231], v5
  v_smfmac_f32_16x16x64_bf16 v[52:55], v[12:15], a[232:239], v5
  v_smfmac_f32_16x16x64_bf16 v[52:55], v[16:19], a[240:247], v5
  v_smfmac_f32_16x16x64_bf16 v[52:55], v[20:23], a[248:255], v5
  v_smfmac_f32_16x16x64_bf16 v[52:55], v[24:27], v[120:127], v5
  v_smfmac_f32_16x16x64_bf16 v[52:55], v[28:31], v[128:135], v5
  v_smfmac_f32_16x16x64_bf16 v[52:55], v[32:35], v[136:143], v5
  v_smfmac_f32_16x16x64_bf16 v[56:59], v[8:11], v[144:151], v5
  v_smfmac_f32_16x16x64_bf16 v[56:59], v[12:15], v[152:159], v5
  v_smfmac_f32_16x16x64_bf16 v[56:59], v[16:19], v[160:167], v5
  v_smfmac_f32_16x16x64_bf16 v[56:59], v[20:23], v[168:175], v5
  v_smfmac_f32_16x16x64_bf16 v[56:59], v[24:27], v[176:183], v5
  v_smfmac_f32_16x16x64_bf16 v[56:59], v[28:31], v[184:191], v5
  v_smfmac_f32_16x16x64_bf16 v[56:59], v[32:35], v[192:199], v5
  v_smfmac_f32_16x16x64_bf16 v[60:63], v[8:11], v[200:207], v5
  v_smfmac_f32_16x16x64_bf16 v[60:63], v[12:15], v[208:215], v5
  v_smfmac_f32_16x16x64_bf16 v[60:63], v[16:19], v[216:223], v5
  v_smfmac_f32_16x16x64_bf16 v[60:63], v[20:23], v[224:231], v5
  v_smfmac_f32_16x16x64_bf16 v[60:63], v[24:27], v[232:239], v5
  v_smfmac_f32_16x16x64_bf16 v[60:63], v[28:31], v[240:247], v5
  v_smfmac_f32_16x16x64_bf16 v[60:63], v[32:35], v[248:255], v5
  v_permlane32_swap_b32 v36, v40
  v_permlane32_swap_b32 v37, v41
  v_permlane32_swap_b32 v38, v42
  v_permlane32_swap_b32 v39, v43
  v_add_f32 v36, v36, v40
  v_add_f32 v37, v37, v41
  v_add_f32 v38, v38, v42
  v_add_f32 v39, v39, v43
  v_cvt_pk_bf16_f32 v40, v36, v37
  v_cvt_pk_bf16_f32 v41, v38, v39
  ds_write_b64 v72, v[40:41]
  v_permlane32_swap_b32 v44, v48
  v_permlane32_swap_b32 v45, v49
  v_permlane32_swap_b32 v46, v50
  v_permlane32_swap_b32 v47, v51
  v_add_f32 v44, v44, v48
  v_add_f32 v45, v45, v49
  v_add_f32 v46, v46, v50
  v_add_f32 v47, v47, v51
  v_cvt_pk_bf16_f32 v48, v44, v45
  v_cvt_pk_bf16_f32 v49, v46, v47
  ds_write_b64 v73, v[48:49]
  v_permlane32_swap_b32 v52, v56
  v_permlane32_swap_b32 v53, v57
  v_permlane32_swap_b32 v54, v58
  v_permlane32_swap_b32 v55, v59
  v_add_f32 v52, v52, v56
  v_add_f32 v53, v53, v57
  v_add_f32 v54, v54, v58
  v_add_f32 v55, v55, v59
  v_cvt_pk_bf16_f32 v56, v52, v53
  v_cvt_pk_bf16_f32 v57, v54, v55
  ds_write_b64 v74, v[56:57]
  v_mov_b32 v64, v60
  v_mov_b32 v65, v61
  v_mov_b32 v66, v62
  v_mov_b32 v67, v63
  v_permlane32_swap_b32 v60, v64
  v_permlane32_swap_b32 v61, v65
  v_permlane32_swap_b32 v62, v66
  v_permlane32_swap_b32 v63, v67
  v_add_f32 v60, v60, v64
  v_add_f32 v61, v61, v65
  v_add_f32 v62, v62, v66
  v_add_f32 v63, v63, v67
  v_cvt_pk_bf16_f32 v64, v60, v61
  v_cvt_pk_bf16_f32 v65, v62, v63
  ds_write_b64 v75, v[64:65]
  s_waitcnt lgkmcnt(0)
  ds_read_b128 v[64:67], v76
  ds_read_b128 v[68:71], v76 offset:1024
  s_waitcnt lgkmcnt(0)
  buffer_store_dwordx4 v[64:67], v2, s[8:11], s25 offen sc1
  buffer_store_dwordx4 v[68:71], v2, s[8:11], s25 offen offset:1024 sc1
  s_waitcnt vmcnt(0)
  s_mov_b64 exec, 1
  buffer_store_dword v78, v2, s[8:11], s26 offen sc1
  s_mov_b64 exec, -1
  s_add_u32 s24, s24, 14336
  s_add_u32 s25, s25, 16384
  s_add_u32 s26, s26, 32
  s_add_u32 s17, s17, 2
  s_cmp_lt_u32 s17, 64
  s_cbranch_scc1 ws_loop
  v_mov_b32 v250, 0
  s_branch wk_loop
wk_s4d:
  s_cmp_lg_u32 s16, 0
  s_cbranch_scc1 w0_43
  s_getreg_b32 s20, hwreg(HW_REG_XCC_ID)
  s_sub_u32 s20, s20, 1
  s_and_b32 s20, s20, 7
  s_mov_b64 exec, 1
s4_l:
  s_cmp_ge_u32 s20, 7
  s_cselect_b32 s20, 0, s20
  s_lshl_b32 s21, s20, 7
  s_add_u32 s21, s21, 88598528
  v_mov_b32 v242, 1
  buffer_atomic_add v242, off, s[8:11], s21 sc0
  s_waitcnt vmcnt(0)
  v_readfirstlane_b32 s21, v242
  s_lshl_b32 s22, s20, 4
  s_add_u32 s20, s20, 1
  s_cmp_ge_u32 s21, 16
  s_cbranch_scc1 s4_l
  v_add_u32 v242, s22, v242
  s_mov_b64 exec, -1
w0_43:
  v_mov_b32 v243, 160000
  s_add_u32 s101, s101, 1
  s_barrier
  s_mov_b64 exec, 1
  s_cmp_lg_u32 s16, 0
  s_cbranch_scc1 w0_44
  ds_write_b32 v243, v242 offset:0
  s_waitcnt lgkmcnt(0)
  v_mov_b32 v242, s101
  ds_write_b32 v243, v242 offset:16
  s_waitcnt lgkmcnt(0)
w0_44:
  s_mov_b64 exec, -1
  s_barrier
  ds_read_b32 v242, v243 offset:0
  ds_read_b32 v243, v243 offset:16
  s_waitcnt lgkmcnt(0)
  v_readfirstlane_b32 s3, v242
  v_cmp_ne_u32 vcc, s101, v243
  s_cbranch_vccnz ch_end
  s_load_dwordx8 s[40:47], s[0:1], 0
  s_load_dwordx4 s[48:51], s[0:1], 32
  s_load_dwordx2 s[52:53], s[0:1], 48
  s_load_dwordx2 s[54:55], s[0:1], 112
  v_lshrrev_b32 v1, 6, v0
  s_nop 0
  v_readfirstlane_b32 s16, v1
  v_and_b32 v1, 63, v0
  v_lshrrev_b32 v3, 4, v1
  v_and_b32 v4, 15, v1
  s_mul_i32 s17, s16, 24576
  s_waitcnt lgkmcnt(0)
  s_mov_b32 s60, s40
  s_and_b32 s61, s41, 0xffff
  s_mov_b32 s62, 1835008
  s_mov_b32 s63, 0x20000
  s_mov_b32 s64, s42
  s_and_b32 s65, s43, 0xffff
  s_mov_b32 s66, 229376
  s_mov_b32 s67, 0x20000
  s_mov_b32 s68, s44
  s_and_b32 s69, s45, 0xffff
  s_mov_b32 s70, 229376
  s_mov_b32 s71, 0x20000
  s_mov_b32 s72, s46
  s_and_b32 s73, s47, 0xffff
  s_mov_b32 s74, 229376
  s_mov_b32 s75, 0x20000
  s_mov_b32 s76, s48
  s_and_b32 s77, s49, 0xffff
  s_mov_b32 s78, 229376
  s_mov_b32 s79, 0x20000
  s_mov_b32 s80, s50
  s_and_b32 s81, s51, 0xffff
  s_mov_b32 s82, 896
  s_mov_b32 s83, 0x20000
  s_mov_b32 s84, s52
  s_and_b32 s85, s53, 0xffff
  s_mov_b32 s86, 896
  s_mov_b32 s87, 0x20000
  s_mov_b32 s92, s54
  s_and_b32 s93, s55, 0xffff
  s_mov_b32 s94, 3670016
  s_mov_b32 s95, 0x20000
  v_lshlrev_b32 v5, 5, v1
  v_sub_u32 v5, 2047, v5
  s_add_u32 s18, s17, 13056
  v_subrev_u32 v6, 0, v5
  v_max_i32 v7, 0, v6
  v_cvt_f32_u32 v7, v7
  v_cvt_pk_bf16_f32 v8, v7, v7
  v_and_b32 v7, 0xffff0000, v8
  v_lshrrev_b32 v8, 23, v7
  v_subrev_u32 v8, 134, v8
  v_max_i32 v8, 0, v8
  v_cvt_u32_f32 v7, v7
  v_lshrrev_b32 v7, v8, v7
  v_lshl_add_u32 v7, v8, 8, v7
  v_lshl_add_u32 v200, v7, 2, s18
  v_subrev_u32 v6, 1, v5
  v_max_i32 v7, 0, v6
  v_cvt_f32_u32 v7, v7
  v_cvt_pk_bf16_f32 v8, v7, v7
  v_and_b32 v7, 0xffff0000, v8
  v_lshrrev_b32 v8, 23, v7
  v_subrev_u32 v8, 134, v8
  v_max_i32 v8, 0, v8
  v_cvt_u32_f32 v7, v7
  v_lshrrev_b32 v7, v8, v7
  v_lshl_add_u32 v7, v8, 8, v7
  v_lshl_add_u32 v201, v7, 2, s18
  v_subrev_u32 v6, 2, v5
  v_max_i32 v7, 0, v6
  v_cvt_f32_u32 v7, v7
  v_cvt_pk_bf16_f32 v8, v7, v7
  v_and_b32 v7, 0xffff0000, v8
  v_lshrrev_b32 v8, 23, v7
  v_subrev_u32 v8, 134, v8
  v_max_i32 v8, 0, v8
  v_cvt_u32_f32 v7, v7
  v_lshrrev_b32 v7, v8, v7
  v_lshl_add_u32 v7, v8, 8, v7
  v_lshl_add_u32 v202, v7, 2, s18
  v_subrev_u32 v6, 3, v5
  v_max_i32 v7, 0, v6
  v_cvt_f32_u32 v7, v7
  v_cvt_pk_bf16_f32 v8, v7, v7
  v_and_b32 v7, 0xffff0000, v8
  v_lshrrev_b32 v8, 23, v7
  v_subrev_u32 v8, 134, v8
  v_max_i32 v8, 0, v8
  v_cvt_u32_f32 v7, v7
  v_lshrrev_b32 v7, v8, v7
  v_lshl_add_u32 v7, v8, 8, v7
  v_lshl_add_u32 v203, v7, 2, s18
  v_subrev_u32 v6, 4, v5
  v_max_i32 v7, 0, v6
  v_cvt_f32_u32 v7, v7
  v_cvt_pk_bf16_f32 v8, v7, v7
  v_and_b32 v7, 0xffff0000, v8
  v_lshrrev_b32 v8, 23, v7
  v_subrev_u32 v8, 134, v8
  v_max_i32 v8, 0, v8
  v_cvt_u32_f32 v7, v7
  v_lshrrev_b32 v7, v8, v7
  v_lshl_add_u32 v7, v8, 8, v7
  v_lshl_add_u32 v204, v7, 2, s18
  v_subrev_u32 v6, 5, v5
  v_max_i32 v7, 0, v6
  v_cvt_f32_u32 v7, v7
  v_cvt_pk_bf16_f32 v8, v7, v7
  v_and_b32 v7, 0xffff0000, v8
  v_lshrrev_b32 v8, 23, v7
  v_subrev_u32 v8, 134, v8
  v_max_i32 v8, 0, v8
  v_cvt_u32_f32 v7, v7
  v_lshrrev_b32 v7, v8, v7
  v_lshl_add_u32 v7, v8, 8, v7
  v_lshl_add_u32 v205, v7, 2, s18
  v_subrev_u32 v6, 6, v5
  v_max_i32 v7, 0, v6
  v_cvt_f32_u32 v7, v7
  v_cvt_pk_bf16_f32 v8, v7, v7
  v_and_b32 v7, 0xffff0000, v8
  v_lshrrev_b32 v8, 23, v7
  v_subrev_u32 v8, 134, v8
  v_max_i32 v8, 0, v8
  v_cvt_u32_f32 v7, v7
  v_lshrrev_b32 v7, v8, v7
  v_lshl_add_u32 v7, v8, 8, v7
  v_lshl_add_u32 v206, v7, 2, s18
  v_subrev_u32 v6, 7, v5
  v_max_i32 v7, 0, v6
  v_cvt_f32_u32 v7, v7
  v_cvt_pk_bf16_f32 v8, v7, v7
  v_and_b32 v7, 0xffff0000, v8
  v_lshrrev_b32 v8, 23, v7
  v_subrev_u32 v8, 134, v8
  v_max_i32 v8, 0, v8
  v_cvt_u32_f32 v7, v7
  v_lshrrev_b32 v7, v8, v7
  v_lshl_add_u32 v7, v8, 8, v7
  v_lshl_add_u32 v207, v7, 2, s18
  v_subrev_u32 v6, 8, v5
  v_max_i32 v7, 0, v6
  v_cvt_f32_u32 v7, v7
  v_cvt_pk_bf16_f32 v8, v7, v7
  v_and_b32 v7, 0xffff0000, v8
  v_lshrrev_b32 v8, 23, v7
  v_subrev_u32 v8, 134, v8
  v_max_i32 v8, 0, v8
  v_cvt_u32_f32 v7, v7
  v_lshrrev_b32 v7, v8, v7
  v_lshl_add_u32 v7, v8, 8, v7
  v_lshl_add_u32 v208, v7, 2, s18
  v_subrev_u32 v6, 9, v5
  v_max_i32 v7, 0, v6
  v_cvt_f32_u32 v7, v7
  v_cvt_pk_bf16_f32 v8, v7, v7
  v_and_b32 v7, 0xffff0000, v8
  v_lshrrev_b32 v8, 23, v7
  v_subrev_u32 v8, 134, v8
  v_max_i32 v8, 0, v8
  v_cvt_u32_f32 v7, v7
  v_lshrrev_b32 v7, v8, v7
  v_lshl_add_u32 v7, v8, 8, v7
  v_lshl_add_u32 v209, v7, 2, s18
  v_subrev_u32 v6, 10, v5
  v_max_i32 v7, 0, v6
  v_cvt_f32_u32 v7, v7
  v_cvt_pk_bf16_f32 v8, v7, v7
  v_and_b32 v7, 0xffff0000, v8
  v_lshrrev_b32 v8, 23, v7
  v_subrev_u32 v8, 134, v8
  v_max_i32 v8, 0, v8
  v_cvt_u32_f32 v7, v7
  v_lshrrev_b32 v7, v8, v7
  v_lshl_add_u32 v7, v8, 8, v7
  v_lshl_add_u32 v210, v7, 2, s18
  v_subrev_u32 v6, 11, v5
  v_max_i32 v7, 0, v6
  v_cvt_f32_u32 v7, v7
  v_cvt_pk_bf16_f32 v8, v7, v7
  v_and_b32 v7, 0xffff0000, v8
  v_lshrrev_b32 v8, 23, v7
  v_subrev_u32 v8, 134, v8
  v_max_i32 v8, 0, v8
  v_cvt_u32_f32 v7, v7
  v_lshrrev_b32 v7, v8, v7
  v_lshl_add_u32 v7, v8, 8, v7
  v_lshl_add_u32 v211, v7, 2, s18
  v_subrev_u32 v6, 12, v5
  v_max_i32 v7, 0, v6
  v_cvt_f32_u32 v7, v7
  v_cvt_pk_bf16_f32 v8, v7, v7
  v_and_b32 v7, 0xffff0000, v8
  v_lshrrev_b32 v8, 23, v7
  v_subrev_u32 v8, 134, v8
  v_max_i32 v8, 0, v8
  v_cvt_u32_f32 v7, v7
  v_lshrrev_b32 v7, v8, v7
  v_lshl_add_u32 v7, v8, 8, v7
  v_lshl_add_u32 v212, v7, 2, s18
  v_subrev_u32 v6, 13, v5
  v_max_i32 v7, 0, v6
  v_cvt_f32_u32 v7, v7
  v_cvt_pk_bf16_f32 v8, v7, v7
  v_and_b32 v7, 0xffff0000, v8
  v_lshrrev_b32 v8, 23, v7
  v_subrev_u32 v8, 134, v8
  v_max_i32 v8, 0, v8
  v_cvt_u32_f32 v7, v7
  v_lshrrev_b32 v7, v8, v7
  v_lshl_add_u32 v7, v8, 8, v7
  v_lshl_add_u32 v213, v7, 2, s18
  v_subrev_u32 v6, 14, v5
  v_max_i32 v7, 0, v6
  v_cvt_f32_u32 v7, v7
  v_cvt_pk_bf16_f32 v8, v7, v7
  v_and_b32 v7, 0xffff0000, v8
  v_lshrrev_b32 v8, 23, v7
  v_subrev_u32 v8, 134, v8
  v_max_i32 v8, 0, v8
  v_cvt_u32_f32 v7, v7
  v_lshrrev_b32 v7, v8, v7
  v_lshl_add_u32 v7, v8, 8, v7
  v_lshl_add_u32 v214, v7, 2, s18
  v_subrev_u32 v6, 15, v5
  v_max_i32 v7, 0, v6
  v_cvt_f32_u32 v7, v7
  v_cvt_pk_bf16_f32 v8, v7, v7
  v_and_b32 v7, 0xffff0000, v8
  v_lshrrev_b32 v8, 23, v7
  v_subrev_u32 v8, 134, v8
  v_max_i32 v8, 0, v8
  v_cvt_u32_f32 v7, v7
  v_lshrrev_b32 v7, v8, v7
  v_lshl_add_u32 v7, v8, 8, v7
  v_lshl_add_u32 v215, v7, 2, s18
  v_subrev_u32 v6, 16, v5
  v_max_i32 v7, 0, v6
  v_cvt_f32_u32 v7, v7
  v_cvt_pk_bf16_f32 v8, v7, v7
  v_and_b32 v7, 0xffff0000, v8
  v_lshrrev_b32 v8, 23, v7
  v_subrev_u32 v8, 134, v8
  v_max_i32 v8, 0, v8
  v_cvt_u32_f32 v7, v7
  v_lshrrev_b32 v7, v8, v7
  v_lshl_add_u32 v7, v8, 8, v7
  v_lshl_add_u32 v216, v7, 2, s18
  v_subrev_u32 v6, 17, v5
  v_max_i32 v7, 0, v6
  v_cvt_f32_u32 v7, v7
  v_cvt_pk_bf16_f32 v8, v7, v7
  v_and_b32 v7, 0xffff0000, v8
  v_lshrrev_b32 v8, 23, v7
  v_subrev_u32 v8, 134, v8
  v_max_i32 v8, 0, v8
  v_cvt_u32_f32 v7, v7
  v_lshrrev_b32 v7, v8, v7
  v_lshl_add_u32 v7, v8, 8, v7
  v_lshl_add_u32 v217, v7, 2, s18
  v_subrev_u32 v6, 18, v5
  v_max_i32 v7, 0, v6
  v_cvt_f32_u32 v7, v7
  v_cvt_pk_bf16_f32 v8, v7, v7
  v_and_b32 v7, 0xffff0000, v8
  v_lshrrev_b32 v8, 23, v7
  v_subrev_u32 v8, 134, v8
  v_max_i32 v8, 0, v8
  v_cvt_u32_f32 v7, v7
  v_lshrrev_b32 v7, v8, v7
  v_lshl_add_u32 v7, v8, 8, v7
  v_lshl_add_u32 v218, v7, 2, s18
  v_subrev_u32 v6, 19, v5
  v_max_i32 v7, 0, v6
  v_cvt_f32_u32 v7, v7
  v_cvt_pk_bf16_f32 v8, v7, v7
  v_and_b32 v7, 0xffff0000, v8
  v_lshrrev_b32 v8, 23, v7
  v_subrev_u32 v8, 134, v8
  v_max_i32 v8, 0, v8
  v_cvt_u32_f32 v7, v7
  v_lshrrev_b32 v7, v8, v7
  v_lshl_add_u32 v7, v8, 8, v7
  v_lshl_add_u32 v219, v7, 2, s18
  v_subrev_u32 v6, 20, v5
  v_max_i32 v7, 0, v6
  v_cvt_f32_u32 v7, v7
  v_cvt_pk_bf16_f32 v8, v7, v7
  v_and_b32 v7, 0xffff0000, v8
  v_lshrrev_b32 v8, 23, v7
  v_subrev_u32 v8, 134, v8
  v_max_i32 v8, 0, v8
  v_cvt_u32_f32 v7, v7
  v_lshrrev_b32 v7, v8, v7
  v_lshl_add_u32 v7, v8, 8, v7
  v_lshl_add_u32 v220, v7, 2, s18
  v_subrev_u32 v6, 21, v5
  v_max_i32 v7, 0, v6
  v_cvt_f32_u32 v7, v7
  v_cvt_pk_bf16_f32 v8, v7, v7
  v_and_b32 v7, 0xffff0000, v8
  v_lshrrev_b32 v8, 23, v7
  v_subrev_u32 v8, 134, v8
  v_max_i32 v8, 0, v8
  v_cvt_u32_f32 v7, v7
  v_lshrrev_b32 v7, v8, v7
  v_lshl_add_u32 v7, v8, 8, v7
  v_lshl_add_u32 v221, v7, 2, s18
  v_subrev_u32 v6, 22, v5
  v_max_i32 v7, 0, v6
  v_cvt_f32_u32 v7, v7
  v_cvt_pk_bf16_f32 v8, v7, v7
  v_and_b32 v7, 0xffff0000, v8
  v_lshrrev_b32 v8, 23, v7
  v_subrev_u32 v8, 134, v8
  v_max_i32 v8, 0, v8
  v_cvt_u32_f32 v7, v7
  v_lshrrev_b32 v7, v8, v7
  v_lshl_add_u32 v7, v8, 8, v7
  v_lshl_add_u32 v222, v7, 2, s18
  v_subrev_u32 v6, 23, v5
  v_max_i32 v7, 0, v6
  v_cvt_f32_u32 v7, v7
  v_cvt_pk_bf16_f32 v8, v7, v7
  v_and_b32 v7, 0xffff0000, v8
  v_lshrrev_b32 v8, 23, v7
  v_subrev_u32 v8, 134, v8
  v_max_i32 v8, 0, v8
  v_cvt_u32_f32 v7, v7
  v_lshrrev_b32 v7, v8, v7
  v_lshl_add_u32 v7, v8, 8, v7
  v_lshl_add_u32 v223, v7, 2, s18
  v_subrev_u32 v6, 24, v5
  v_max_i32 v7, 0, v6
  v_cvt_f32_u32 v7, v7
  v_cvt_pk_bf16_f32 v8, v7, v7
  v_and_b32 v7, 0xffff0000, v8
  v_lshrrev_b32 v8, 23, v7
  v_subrev_u32 v8, 134, v8
  v_max_i32 v8, 0, v8
  v_cvt_u32_f32 v7, v7
  v_lshrrev_b32 v7, v8, v7
  v_lshl_add_u32 v7, v8, 8, v7
  v_lshl_add_u32 v224, v7, 2, s18
  v_subrev_u32 v6, 25, v5
  v_max_i32 v7, 0, v6
  v_cvt_f32_u32 v7, v7
  v_cvt_pk_bf16_f32 v8, v7, v7
  v_and_b32 v7, 0xffff0000, v8
  v_lshrrev_b32 v8, 23, v7
  v_subrev_u32 v8, 134, v8
  v_max_i32 v8, 0, v8
  v_cvt_u32_f32 v7, v7
  v_lshrrev_b32 v7, v8, v7
  v_lshl_add_u32 v7, v8, 8, v7
  v_lshl_add_u32 v225, v7, 2, s18
  v_subrev_u32 v6, 26, v5
  v_max_i32 v7, 0, v6
  v_cvt_f32_u32 v7, v7
  v_cvt_pk_bf16_f32 v8, v7, v7
  v_and_b32 v7, 0xffff0000, v8
  v_lshrrev_b32 v8, 23, v7
  v_subrev_u32 v8, 134, v8
  v_max_i32 v8, 0, v8
  v_cvt_u32_f32 v7, v7
  v_lshrrev_b32 v7, v8, v7
  v_lshl_add_u32 v7, v8, 8, v7
  v_lshl_add_u32 v226, v7, 2, s18
  v_subrev_u32 v6, 27, v5
  v_max_i32 v7, 0, v6
  v_cvt_f32_u32 v7, v7
  v_cvt_pk_bf16_f32 v8, v7, v7
  v_and_b32 v7, 0xffff0000, v8
  v_lshrrev_b32 v8, 23, v7
  v_subrev_u32 v8, 134, v8
  v_max_i32 v8, 0, v8
  v_cvt_u32_f32 v7, v7
  v_lshrrev_b32 v7, v8, v7
  v_lshl_add_u32 v7, v8, 8, v7
  v_lshl_add_u32 v227, v7, 2, s18
  v_subrev_u32 v6, 28, v5
  v_max_i32 v7, 0, v6
  v_cvt_f32_u32 v7, v7
  v_cvt_pk_bf16_f32 v8, v7, v7
  v_and_b32 v7, 0xffff0000, v8
  v_lshrrev_b32 v8, 23, v7
  v_subrev_u32 v8, 134, v8
  v_max_i32 v8, 0, v8
  v_cvt_u32_f32 v7, v7
  v_lshrrev_b32 v7, v8, v7
  v_lshl_add_u32 v7, v8, 8, v7
  v_lshl_add_u32 v228, v7, 2, s18
  v_subrev_u32 v6, 29, v5
  v_max_i32 v7, 0, v6
  v_cvt_f32_u32 v7, v7
  v_cvt_pk_bf16_f32 v8, v7, v7
  v_and_b32 v7, 0xffff0000, v8
  v_lshrrev_b32 v8, 23, v7
  v_subrev_u32 v8, 134, v8
  v_max_i32 v8, 0, v8
  v_cvt_u32_f32 v7, v7
  v_lshrrev_b32 v7, v8, v7
  v_lshl_add_u32 v7, v8, 8, v7
  v_lshl_add_u32 v229, v7, 2, s18
  v_subrev_u32 v6, 30, v5
  v_max_i32 v7, 0, v6
  v_cvt_f32_u32 v7, v7
  v_cvt_pk_bf16_f32 v8, v7, v7
  v_and_b32 v7, 0xffff0000, v8
  v_lshrrev_b32 v8, 23, v7
  v_subrev_u32 v8, 134, v8
  v_max_i32 v8, 0, v8
  v_cvt_u32_f32 v7, v7
  v_lshrrev_b32 v7, v8, v7
  v_lshl_add_u32 v7, v8, 8, v7
  v_lshl_add_u32 v230, v7, 2, s18
  v_subrev_u32 v6, 31, v5
  v_max_i32 v7, 0, v6
  v_cvt_f32_u32 v7, v7
  v_cvt_pk_bf16_f32 v8, v7, v7
  v_and_b32 v7, 0xffff0000, v8
  v_lshrrev_b32 v8, 23, v7
  v_subrev_u32 v8, 134, v8
  v_max_i32 v8, 0, v8
  v_cvt_u32_f32 v7, v7
  v_lshrrev_b32 v7, v8, v7
  v_lshl_add_u32 v7, v8, 8, v7
  v_lshl_add_u32 v231, v7, 2, s18
  v_subrev_u32 v6, 32, v5
  v_max_i32 v7, 0, v6
  v_cvt_f32_u32 v7, v7
  v_cvt_pk_bf16_f32 v8, v7, v7
  v_and_b32 v7, 0xffff0000, v8
  v_lshrrev_b32 v8, 23, v7
  v_subrev_u32 v8, 134, v8
  v_max_i32 v8, 0, v8
  v_cvt_u32_f32 v7, v7
  v_lshrrev_b32 v7, v8, v7
  v_lshl_add_u32 v7, v8, 8, v7
  v_mov_b32 v8, 1280
  v_cmp_gt_i32 vcc, 0, v6
  s_nop 1
  v_cndmask_b32 v7, v7, v8, vcc
  v_lshl_add_u32 v232, v7, 2, s18
  v_mov_b32 v8, 0
  v_mov_b32 v9, 0
  v_lshlrev_b32 v5, 3, v1
  v_add_u32 v5, s17, v5
  ds_write_b64 v5, v[8:9]
  v_and_b32 v6, 15, v1
  v_lshlrev_b32 v6, 3, v6
  v_add_u32 v6, s17, v6
  ds_write_b64 v6, v[8:9] offset:8704
  ds_write_b64 v6, v[8:9] offset:12928
  v_mov_b32 v6, s17
  ds_write_b64 v6, v[8:9] offset:18176
  s_lshl_b32 s19, s3, 2
  s_add_u32 s20, s19, s16
  s_lshl_b32 s21, s3, 3
  v_mul_u32_u24 v5, 3584, v0
  v_mul_u32_u24 v141, 1792, v0
  s_lshl_b32 s22, s20, 9
  v_lshlrev_b32 v6, 3, v1
  buffer_load_dwordx2 v[24:25], v6, s[64:67], s22 offen
  buffer_load_dwordx2 v[26:27], v6, s[68:71], s22 offen
  buffer_load_dwordx2 v[28:29], v6, s[72:75], s22 offen
  buffer_load_dwordx2 v[30:31], v6, s[76:79], s22 offen
  s_lshl_b32 s22, s20, 1
  v_mov_b32 v7, 0
  buffer_load_ushort v32, v7, s[80:83], s22 offen
  buffer_load_ushort v33, v7, s[84:87], s22 offen
  s_mov_b32 s24, 0x05040100
  s_mov_b32 s25, 0x07060302
  s_barrier
  s_waitcnt vmcnt(0)
  s_mov_b32 s26, 1069066811
  s_mov_b32 s27, 1042479491
  v_lshlrev_b32 v32, 16, v32
  v_lshlrev_b32 v33, 16, v33
  v_mul_f32 v32, s26, v32
  v_exp_f32 v32, v32
  s_nop 0
  v_cvt_pk_bf16_f32 v34, v32, v32
  v_and_b32 v32, 0xffff0000, v34
  v_lshlrev_b32 v37, 6, v1
  v_add_u32 v37, s17, v37
  v_lshlrev_b32 v40, 16, v24
  v_lshlrev_b32 v41, 16, v26
  v_lshlrev_b32 v42, 16, v28
  v_lshlrev_b32 v43, 16, v30
  v_mul_f32 v40, s26, v40
  v_exp_f32 v40, v40
  s_nop 0
  v_cvt_pk_bf16_f32 v34, v40, v40
  v_and_b32 v40, 0xffff0000, v34
  v_mul_f32 v40, v40, v32
  v_mul_f32 v40, s26, v40
  v_sub_f32 v40, 0, v40
  v_mul_f32 v41, v41, v32
  v_mul_f32 v41, s27, v41
  v_mul_f32 v42, v42, v32
  v_mul_f32 v43, v43, v32
  v_add_f32 v42, v42, v42
  v_add_f32 v43, v43, v43
  ds_write_b128 v37, v[40:43] offset:18240
  v_and_b32 v40, 0xffff0000, v24
  v_and_b32 v41, 0xffff0000, v26
  v_and_b32 v42, 0xffff0000, v28
  v_and_b32 v43, 0xffff0000, v30
  v_mul_f32 v40, s26, v40
  v_exp_f32 v40, v40
  s_nop 0
  v_cvt_pk_bf16_f32 v34, v40, v40
  v_and_b32 v40, 0xffff0000, v34
  v_mul_f32 v40, v40, v32
  v_mul_f32 v40, s26, v40
  v_sub_f32 v40, 0, v40
  v_mul_f32 v41, v41, v32
  v_mul_f32 v41, s27, v41
  v_mul_f32 v42, v42, v32
  v_mul_f32 v43, v43, v32
  v_add_f32 v42, v42, v42
  v_add_f32 v43, v43, v43
  ds_write_b128 v37, v[40:43] offset:18256
  v_lshlrev_b32 v40, 16, v25
  v_lshlrev_b32 v41, 16, v27
  v_lshlrev_b32 v42, 16, v29
  v_lshlrev_b32 v43, 16, v31
  v_mul_f32 v40, s26, v40
  v_exp_f32 v40, v40
  s_nop 0
  v_cvt_pk_bf16_f32 v34, v40, v40
  v_and_b32 v40, 0xffff0000, v34
  v_mul_f32 v40, v40, v32
  v_mul_f32 v40, s26, v40
  v_sub_f32 v40, 0, v40
  v_mul_f32 v41, v41, v32
  v_mul_f32 v41, s27, v41
  v_mul_f32 v42, v42, v32
  v_mul_f32 v43, v43, v32
  v_add_f32 v42, v42, v42
  v_add_f32 v43, v43, v43
  ds_write_b128 v37, v[40:43] offset:18272
  v_and_b32 v40, 0xffff0000, v25
  v_and_b32 v41, 0xffff0000, v27
  v_and_b32 v42, 0xffff0000, v29
  v_and_b32 v43, 0xffff0000, v31
  v_mul_f32 v40, s26, v40
  v_exp_f32 v40, v40
  s_nop 0
  v_cvt_pk_bf16_f32 v34, v40, v40
  v_and_b32 v40, 0xffff0000, v34
  v_mul_f32 v40, v40, v32
  v_mul_f32 v40, s26, v40
  v_sub_f32 v40, 0, v40
  v_mul_f32 v41, v41, v32
  v_mul_f32 v41, s27, v41
  v_mul_f32 v42, v42, v32
  v_mul_f32 v43, v43, v32
  v_add_f32 v42, v42, v42
  v_add_f32 v43, v43, v43
  ds_write_b128 v37, v[40:43] offset:18288
  v_cvt_f32_u32 v44, v4
  v_lshlrev_b32 v45, 4, v4
  v_cvt_f32_u32 v45, v45
  v_lshlrev_b32 v46, 4, v3
  v_add_u32 v46, s17, v46
  v_mov_b32 v48, 0
  v_mov_b32 v49, 0
  v_mov_b32 v50, 0
  v_mov_b32 v51, 0
  v_mov_b32 v52, 0
  v_mov_b32 v53, 0
  v_mov_b32 v54, 0
  v_mov_b32 v55, 0
  v_mov_b32 v56, 0
  v_mov_b32 v57, 0
  v_mov_b32 v58, 0
  v_mov_b32 v59, 0
  v_mov_b32 v60, 0
  v_mov_b32 v61, 0
  v_mov_b32 v62, 0
  v_mov_b32 v63, 0
  v_mov_b32 v64, 0
  v_mov_b32 v65, 0
  v_mov_b32 v66, 0
  v_mov_b32 v67, 0
  s_waitcnt lgkmcnt(0)
  ds_read_b128 v[68:71], v46 offset:18240
  s_add_u32 s22, s21, 0
  buffer_load_dwordx2 v[8:9], v5, s[60:63], s22 offen offset:0
  s_mov_b32 s28, 0
  s_call_b64 s[30:31], wk_kl
  s_mov_b32 s28, 0
  s_call_b64 s[30:31], wk_kl
  s_add_u32 s22, s21, 0
  buffer_load_dwordx2 v[10:11], v5, s[60:63], s22 offen offset:896
  s_mov_b32 s28, 0
  s_call_b64 s[30:31], wk_kl
  s_mov_b32 s28, 0
  s_call_b64 s[30:31], wk_kl
  s_add_u32 s22, s21, 0
  buffer_load_dwordx2 v[12:13], v5, s[60:63], s22 offen offset:1792
  s_mov_b32 s28, 0
  s_call_b64 s[30:31], wk_kl
  s_mov_b32 s28, 0
  s_call_b64 s[30:31], wk_kl
  s_add_u32 s22, s21, 0
  buffer_load_dwordx2 v[14:15], v5, s[60:63], s22 offen offset:2688
  s_mov_b32 s28, 0
  s_call_b64 s[30:31], wk_kl
  s_mov_b32 s28, 0
  s_call_b64 s[30:31], wk_kl
  s_add_u32 s22, s21, 917504
  buffer_load_dwordx2 v[16:17], v5, s[60:63], s22 offen offset:0
  s_mov_b32 s28, 0
  s_call_b64 s[30:31], wk_kl
  s_mov_b32 s28, 0
  s_call_b64 s[30:31], wk_kl
  s_add_u32 s22, s21, 917504
  buffer_load_dwordx2 v[18:19], v5, s[60:63], s22 offen offset:896
  s_mov_b32 s28, 0
  s_call_b64 s[30:31], wk_kl
  s_mov_b32 s28, 0
  s_call_b64 s[30:31], wk_kl
  s_add_u32 s22, s21, 917504
  buffer_load_dwordx2 v[20:21], v5, s[60:63], s22 offen offset:1792
  s_mov_b32 s28, 0
  s_call_b64 s[30:31], wk_kl
  s_mov_b32 s28, 0
  s_call_b64 s[30:31], wk_kl
  s_add_u32 s22, s21, 917504
  buffer_load_dwordx2 v[22:23], v5, s[60:63], s22 offen offset:2688
  s_mov_b32 s28, 0
  s_call_b64 s[30:31], wk_kl
  s_mov_b32 s28, 0
  s_call_b64 s[30:31], wk_kl
  s_branch wk_kd
wk_kl:
  s_waitcnt lgkmcnt(0)
  v_mov_b32 v72, v68
  v_mov_b32 v73, v69
  v_mov_b32 v74, v70
  v_mov_b32 v75, v71
  v_add_u32 v46, 64, v46
  ds_read_b128 v[68:71], v46 offset:18240
  v_mul_f32 v80, v72, v45
  v_mul_f32 v81, v73, v45
  v_exp_f32 v80, v80
  v_fract_f32 v81, v81
  v_cos_f32 v76, v81
  v_sin_f32 v77, v81
  v_mul_f32 v76, v76, v80
  v_mul_f32 v77, v77, v80
  v_mul_f32 v80, v72, v44
  v_mul_f32 v81, v73, v44
  v_exp_f32 v80, v80
  v_fract_f32 v81, v81
  v_cos_f32 v78, v81
  v_sin_f32 v79, v81
  v_mul_f32 v78, v78, v80
  v_mul_f32 v79, v79, v80
  v_mul_f32 v82, v74, v76
  v_mul_f32 v83, v74, v77
  v_fma_f32 v82, -v75, v77, v82
  v_fma_f32 v83, -v75, v76, -v83
  v_mul_f32 v86, v76, v76
  v_mul_f32 v87, v76, v77
  v_fma_f32 v86, -v77, v77, v86
  v_add_f32 v87, v87, v87
  v_mfma_f32_16x16x4_f32 v[48:51], v82, v78, v[48:51]
  v_mul_f32 v88, v78, v78
  v_mul_f32 v89, v78, v79
  v_fma_f32 v88, -v79, v79, v88
  v_add_f32 v89, v89, v89
  v_mfma_f32_16x16x4_f32 v[48:51], v83, v79, v[48:51]
  v_mul_f32 v84, v74, v86
  v_mul_f32 v85, v74, v87
  v_fma_f32 v84, -v75, v87, v84
  v_fma_f32 v85, -v75, v86, -v85
  v_mul_f32 v76, v86, v86
  v_mul_f32 v77, v86, v87
  v_fma_f32 v76, -v87, v87, v76
  v_add_f32 v77, v77, v77
  v_mfma_f32_16x16x4_f32 v[52:55], v84, v88, v[52:55]
  v_mul_f32 v78, v88, v88
  v_mul_f32 v79, v88, v89
  v_fma_f32 v78, -v89, v89, v78
  v_add_f32 v79, v79, v79
  v_mfma_f32_16x16x4_f32 v[52:55], v85, v89, v[52:55]
  v_mul_f32 v82, v74, v76
  v_mul_f32 v83, v74, v77
  v_fma_f32 v82, -v75, v77, v82
  v_fma_f32 v83, -v75, v76, -v83
  v_mul_f32 v86, v76, v76
  v_mul_f32 v87, v76, v77
  v_fma_f32 v86, -v77, v77, v86
  v_add_f32 v87, v87, v87
  v_mfma_f32_16x16x4_f32 v[56:59], v82, v78, v[56:59]
  v_mul_f32 v88, v78, v78
  v_mul_f32 v89, v78, v79
  v_fma_f32 v88, -v79, v79, v88
  v_add_f32 v89, v89, v89
  v_mfma_f32_16x16x4_f32 v[56:59], v83, v79, v[56:59]
  v_mul_f32 v84, v74, v86
  v_mul_f32 v85, v74, v87
  v_fma_f32 v84, -v75, v87, v84
  v_fma_f32 v85, -v75, v86, -v85
  v_mul_f32 v76, v86, v86
  v_mul_f32 v77, v86, v87
  v_fma_f32 v76, -v87, v87, v76
  v_add_f32 v77, v77, v77
  v_mfma_f32_16x16x4_f32 v[60:63], v84, v88, v[60:63]
  v_mfma_f32_16x16x4_f32 v[60:63], v85, v89, v[60:63]
  v_mul_f32 v82, v74, v76
  v_fma_f32 v82, -v75, v77, v82
  s_nop 1
  v_mfma_f32_16x16x4_f32 v[64:67], v82, v88, v[64:67]
  s_add_u32 s28, s28, 1
  s_cmp_lt_u32 s28, 4
  s_cbranch_scc1 wk_kl
  s_setpc_b64 s[30:31]
wk_kd:
  s_nop 15
  s_nop 3
  s_waitcnt vmcnt(0)
  v_lshlrev_b32 v6, 3, v0
  v_perm_b32 v34, v10, v8, s24
  v_perm_b32 v35, v14, v12, s24
  v_add_u32 v36, 512, v6
  ds_write_b64 v36, v[34:35]
  v_perm_b32 v34, v10, v8, s25
  v_perm_b32 v35, v14, v12, s25
  v_add_u32 v36, 25088, v6
  ds_write_b64 v36, v[34:35]
  v_perm_b32 v34, v11, v9, s24
  v_perm_b32 v35, v15, v13, s24
  v_add_u32 v36, 49664, v6
  ds_write_b64 v36, v[34:35]
  v_perm_b32 v34, v11, v9, s25
  v_perm_b32 v35, v15, v13, s25
  v_add_u32 v36, 74240, v6
  ds_write_b64 v36, v[34:35]
  v_perm_b32 v34, v18, v16, s24
  v_perm_b32 v35, v22, v20, s24
  v_add_u32 v36, 2560, v6
  ds_write_b64 v36, v[34:35]
  v_perm_b32 v34, v18, v16, s25
  v_perm_b32 v35, v22, v20, s25
  v_add_u32 v36, 27136, v6
  ds_write_b64 v36, v[34:35]
  v_perm_b32 v34, v19, v17, s24
  v_perm_b32 v35, v23, v21, s24
  v_add_u32 v36, 51712, v6
  ds_write_b64 v36, v[34:35]
  v_perm_b32 v34, v19, v17, s25
  v_perm_b32 v35, v23, v21, s25
  v_add_u32 v36, 76288, v6
  ds_write_b64 v36, v[34:35]
  v_lshlrev_b32 v46, 8, v3
  v_lshl_add_u32 v46, v4, 2, v46
  v_add_u32 v46, s17, v46
  ds_write_b32 v46, v48 offset:13056
  ds_write_b32 v46, v49 offset:13120
  ds_write_b32 v46, v50 offset:13184
  ds_write_b32 v46, v51 offset:13248
  s_waitcnt lgkmcnt(8)
  ds_write_b32 v46, v52 offset:14080
  ds_write_b32 v46, v53 offset:14144
  ds_write_b32 v46, v54 offset:14208
  ds_write_b32 v46, v55 offset:14272
  s_waitcnt lgkmcnt(8)
  ds_write_b32 v46, v56 offset:15104
  ds_write_b32 v46, v57 offset:15168
  ds_write_b32 v46, v58 offset:15232
  ds_write_b32 v46, v59 offset:15296
  s_waitcnt lgkmcnt(8)
  ds_write_b32 v46, v60 offset:16128
  ds_write_b32 v46, v61 offset:16192
  ds_write_b32 v46, v62 offset:16256
  ds_write_b32 v46, v63 offset:16320
  s_waitcnt lgkmcnt(8)
  ds_write_b32 v46, v64 offset:17152
  ds_write_b32 v46, v65 offset:17216
  ds_write_b32 v46, v66 offset:17280
  ds_write_b32 v46, v67 offset:17344
  s_waitcnt lgkmcnt(8)
  s_waitcnt lgkmcnt(0)
  ds_read_b32 v48, v200
  ds_read_b32 v49, v201
  ds_read_b32 v50, v202
  ds_read_b32 v51, v203
  ds_read_b32 v52, v204
  ds_read_b32 v53, v205
  ds_read_b32 v54, v206
  ds_read_b32 v55, v207
  s_waitcnt lgkmcnt(4)
  ds_read_b32 v56, v208
  ds_read_b32 v57, v209
  ds_read_b32 v58, v210
  ds_read_b32 v59, v211
  ds_read_b32 v60, v212
  ds_read_b32 v61, v213
  ds_read_b32 v62, v214
  ds_read_b32 v63, v215
  s_waitcnt lgkmcnt(4)
  ds_read_b32 v64, v216
  ds_read_b32 v65, v217
  ds_read_b32 v66, v218
  ds_read_b32 v67, v219
  ds_read_b32 v68, v220
  ds_read_b32 v69, v221
  ds_read_b32 v70, v222
  ds_read_b32 v71, v223
  s_waitcnt lgkmcnt(4)
  ds_read_b32 v72, v224
  ds_read_b32 v73, v225
  ds_read_b32 v74, v226
  ds_read_b32 v75, v227
  ds_read_b32 v76, v228
  ds_read_b32 v77, v229
  ds_read_b32 v78, v230
  ds_read_b32 v79, v231
  s_waitcnt lgkmcnt(4)
  ds_read_b32 v80, v232
  s_waitcnt lgkmcnt(0)
  v_lshlrev_b32 v46, 6, v1
  v_add_u32 v46, s17, v46
  v_cvt_pk_bf16_f32 v84, v48, v49
  v_cvt_pk_bf16_f32 v88, v49, v50
  v_cvt_pk_bf16_f32 v85, v50, v51
  v_cvt_pk_bf16_f32 v89, v51, v52
  v_cvt_pk_bf16_f32 v86, v52, v53
  v_cvt_pk_bf16_f32 v90, v53, v54
  v_cvt_pk_bf16_f32 v87, v54, v55
  v_cvt_pk_bf16_f32 v91, v55, v56
  ds_write_b128 v46, v[84:87] offset:4608
  ds_write_b128 v46, v[88:91] offset:8832
  s_waitcnt lgkmcnt(0)
  v_cvt_pk_bf16_f32 v84, v56, v57
  v_cvt_pk_bf16_f32 v88, v57, v58
  v_cvt_pk_bf16_f32 v85, v58, v59
  v_cvt_pk_bf16_f32 v89, v59, v60
  v_cvt_pk_bf16_f32 v86, v60, v61
  v_cvt_pk_bf16_f32 v90, v61, v62
  v_cvt_pk_bf16_f32 v87, v62, v63
  v_cvt_pk_bf16_f32 v91, v63, v64
  ds_write_b128 v46, v[84:87] offset:4624
  ds_write_b128 v46, v[88:91] offset:8848
  s_waitcnt lgkmcnt(0)
  v_cvt_pk_bf16_f32 v84, v64, v65
  v_cvt_pk_bf16_f32 v88, v65, v66
  v_cvt_pk_bf16_f32 v85, v66, v67
  v_cvt_pk_bf16_f32 v89, v67, v68
  v_cvt_pk_bf16_f32 v86, v68, v69
  v_cvt_pk_bf16_f32 v90, v69, v70
  v_cvt_pk_bf16_f32 v87, v70, v71
  v_cvt_pk_bf16_f32 v91, v71, v72
  ds_write_b128 v46, v[84:87] offset:4640
  ds_write_b128 v46, v[88:91] offset:8864
  s_waitcnt lgkmcnt(0)
  v_cvt_pk_bf16_f32 v84, v72, v73
  v_cvt_pk_bf16_f32 v88, v73, v74
  v_cvt_pk_bf16_f32 v85, v74, v75
  v_cvt_pk_bf16_f32 v89, v75, v76
  v_cvt_pk_bf16_f32 v86, v76, v77
  v_cvt_pk_bf16_f32 v90, v77, v78
  v_cvt_pk_bf16_f32 v87, v78, v79
  v_cvt_pk_bf16_f32 v91, v79, v80
  ds_write_b128 v46, v[84:87] offset:4656
  ds_write_b128 v46, v[88:91] offset:8880
  s_waitcnt lgkmcnt(0)
  s_barrier
  v_lshrrev_b32 v47, 1, v3
  v_sub_u32 v46, v4, v47
  v_add_u32 v46, 1, v46
  v_lshlrev_b32 v46, 5, v46
  v_and_b32 v48, 1, v3
  v_lshl_add_u32 v46, v48, 4, v46
  v_add_u32 v46, s17, v46
  ds_read_b128 a[0:3], v46 offset:32
  ds_read_b128 a[4:7], v46 offset:96
  ds_read_b128 a[8:11], v46 offset:160
  ds_read_b128 a[12:15], v46 offset:224
  ds_read_b128 a[16:19], v46 offset:288
  ds_read_b128 a[20:23], v46 offset:352
  ds_read_b128 a[24:27], v46 offset:416
  ds_read_b128 a[28:31], v46 offset:480
  s_waitcnt lgkmcnt(4)
  ds_read_b128 a[32:35], v46 offset:544
  ds_read_b128 a[36:39], v46 offset:608
  ds_read_b128 a[40:43], v46 offset:672
  ds_read_b128 a[44:47], v46 offset:736
  ds_read_b128 a[48:51], v46 offset:800
  ds_read_b128 a[52:55], v46 offset:864
  ds_read_b128 a[56:59], v46 offset:928
  ds_read_b128 a[60:63], v46 offset:992
  s_waitcnt lgkmcnt(4)
  ds_read_b128 a[64:67], v46 offset:1056
  ds_read_b128 a[68:71], v46 offset:1120
  ds_read_b128 a[72:75], v46 offset:1184
  ds_read_b128 a[76:79], v46 offset:1248
  ds_read_b128 a[80:83], v46 offset:1312
  ds_read_b128 a[84:87], v46 offset:1376
  ds_read_b128 a[88:91], v46 offset:1440
  ds_read_b128 a[92:95], v46 offset:1504
  s_waitcnt lgkmcnt(4)
  ds_read_b128 a[96:99], v46 offset:1568
  ds_read_b128 a[100:103], v46 offset:1632
  ds_read_b128 a[104:107], v46 offset:1696
  ds_read_b128 a[108:111], v46 offset:1760
  ds_read_b128 a[112:115], v46 offset:1824
  ds_read_b128 a[116:119], v46 offset:1888
  ds_read_b128 a[120:123], v46 offset:1952
  ds_read_b128 a[124:127], v46 offset:2016
  s_waitcnt lgkmcnt(4)
  ds_read_b128 a[128:131], v46 offset:2080
  ds_read_b128 a[132:135], v46 offset:2144
  ds_read_b128 a[136:139], v46 offset:2208
  ds_read_b128 a[140:143], v46 offset:2272
  ds_read_b128 a[144:147], v46 offset:2336
  ds_read_b128 a[148:151], v46 offset:2400
  ds_read_b128 a[152:155], v46 offset:2464
  ds_read_b128 a[156:159], v46 offset:2528
  s_waitcnt lgkmcnt(4)
  ds_read_b128 a[160:163], v46 offset:2592
  ds_read_b128 a[164:167], v46 offset:2656
  ds_read_b128 a[168:171], v46 offset:2720
  ds_read_b128 a[172:175], v46 offset:2784
  ds_read_b128 a[176:179], v46 offset:2848
  ds_read_b128 a[180:183], v46 offset:2912
  ds_read_b128 a[184:187], v46 offset:2976
  ds_read_b128 a[188:191], v46 offset:3040
  s_waitcnt lgkmcnt(4)
  ds_read_b128 a[192:195], v46 offset:3104
  ds_read_b128 a[196:199], v46 offset:3168
  ds_read_b128 a[200:203], v46 offset:3232
  ds_read_b128 a[204:207], v46 offset:3296
  ds_read_b128 a[208:211], v46 offset:3360
  ds_read_b128 a[212:215], v46 offset:3424
  ds_read_b128 a[216:219], v46 offset:3488
  ds_read_b128 a[220:223], v46 offset:3552
  s_waitcnt lgkmcnt(4)
  ds_read_b128 a[224:227], v46 offset:3616
  ds_read_b128 a[228:231], v46 offset:3680
  ds_read_b128 a[232:235], v46 offset:3744
  ds_read_b128 a[236:239], v46 offset:3808
  ds_read_b128 a[240:243], v46 offset:3872
  ds_read_b128 a[244:247], v46 offset:3936
  ds_read_b128 a[248:251], v46 offset:4000
  ds_read_b128 a[252:255], v46 offset:4064
  s_waitcnt lgkmcnt(4)
  v_lshlrev_b32 v49, 4, v47
  v_add_u32 v49, v49, v4
  v_sub_u32 v49, 2047, v49
  v_lshl_add_u32 v49, v48, 3, v49
  v_and_b32 v50, 1, v49
  v_lshrrev_b32 v49, 1, v49
  v_lshlrev_b32 v49, 2, v49
  v_mul_u32_u24 v50, 4224, v50
  v_add3_u32 v49, v49, v50, s17
  v_add_u32 v49, 4608, v49
  v_subrev_u32 v52, 896, v49
  v_subrev_u32 v53, 1856, v49
  v_subrev_u32 v54, 2816, v49
  v_subrev_u32 v55, 3776, v49
  v_subrev_u32 v56, 4736, v49
  s_waitcnt lgkmcnt(0)
  ds_read2_b32 v[92:93], v52 offset0:224 offset1:225
  ds_read2_b32 v[94:95], v52 offset0:226 offset1:227
  ds_read2_b32 v[96:97], v52 offset0:208 offset1:209
  ds_read2_b32 v[98:99], v52 offset0:210 offset1:211
  ds_read2_b32 v[100:101], v52 offset0:192 offset1:193
  ds_read2_b32 v[102:103], v52 offset0:194 offset1:195
  ds_read2_b32 v[104:105], v52 offset0:176 offset1:177
  ds_read2_b32 v[106:107], v52 offset0:178 offset1:179
  s_waitcnt lgkmcnt(6)
  v_mfma_f32_16x16x32_bf16 v[60:63], v[92:95], a[28:31], 0
  v_mfma_f32_16x16x32_bf16 v[64:67], v[92:95], a[60:63], 0
  v_mfma_f32_16x16x32_bf16 v[68:71], v[92:95], a[92:95], 0
  v_mfma_f32_16x16x32_bf16 v[72:75], v[92:95], a[124:127], 0
  v_mfma_f32_16x16x32_bf16 v[76:79], v[92:95], a[156:159], 0
  v_mfma_f32_16x16x32_bf16 v[80:83], v[92:95], a[188:191], 0
  v_mfma_f32_16x16x32_bf16 v[84:87], v[92:95], a[220:223], 0
  v_mfma_f32_16x16x32_bf16 v[88:91], v[92:95], a[252:255], 0
  ds_read2_b32 v[92:93], v52 offset0:160 offset1:161
  ds_read2_b32 v[94:95], v52 offset0:162 offset1:163
  s_waitcnt lgkmcnt(6)
  v_mfma_f32_16x16x32_bf16 v[60:63], v[96:99], a[24:27], v[60:63]
  v_mfma_f32_16x16x32_bf16 v[64:67], v[96:99], a[56:59], v[64:67]
  v_mfma_f32_16x16x32_bf16 v[68:71], v[96:99], a[88:91], v[68:71]
  v_mfma_f32_16x16x32_bf16 v[72:75], v[96:99], a[120:123], v[72:75]
  v_mfma_f32_16x16x32_bf16 v[76:79], v[96:99], a[152:155], v[76:79]
  v_mfma_f32_16x16x32_bf16 v[80:83], v[96:99], a[184:187], v[80:83]
  v_mfma_f32_16x16x32_bf16 v[84:87], v[96:99], a[216:219], v[84:87]
  v_mfma_f32_16x16x32_bf16 v[88:91], v[96:99], a[248:251], v[88:91]
  ds_read2_b32 v[96:97], v52 offset0:144 offset1:145
  ds_read2_b32 v[98:99], v52 offset0:146 offset1:147
  s_waitcnt lgkmcnt(6)
  v_mfma_f32_16x16x32_bf16 v[60:63], v[100:103], a[20:23], v[60:63]
  v_mfma_f32_16x16x32_bf16 v[64:67], v[100:103], a[52:55], v[64:67]
  v_mfma_f32_16x16x32_bf16 v[68:71], v[100:103], a[84:87], v[68:71]
  v_mfma_f32_16x16x32_bf16 v[72:75], v[100:103], a[116:119], v[72:75]
  v_mfma_f32_16x16x32_bf16 v[76:79], v[100:103], a[148:151], v[76:79]
  v_mfma_f32_16x16x32_bf16 v[80:83], v[100:103], a[180:183], v[80:83]
  v_mfma_f32_16x16x32_bf16 v[84:87], v[100:103], a[212:215], v[84:87]
  v_mfma_f32_16x16x32_bf16 v[88:91], v[100:103], a[244:247], v[88:91]
  ds_read2_b32 v[100:101], v52 offset0:128 offset1:129
  ds_read2_b32 v[102:103], v52 offset0:130 offset1:131
  s_waitcnt lgkmcnt(6)
  v_mfma_f32_16x16x32_bf16 v[60:63], v[104:107], a[16:19], v[60:63]
  v_mfma_f32_16x16x32_bf16 v[64:67], v[104:107], a[48:51], v[64:67]
  v_mfma_f32_16x16x32_bf16 v[68:71], v[104:107], a[80:83], v[68:71]
  v_mfma_f32_16x16x32_bf16 v[72:75], v[104:107], a[112:115], v[72:75]
  v_mfma_f32_16x16x32_bf16 v[76:79], v[104:107], a[144:147], v[76:79]
  v_mfma_f32_16x16x32_bf16 v[80:83], v[104:107], a[176:179], v[80:83]
  v_mfma_f32_16x16x32_bf16 v[84:87], v[104:107], a[208:211], v[84:87]
  v_mfma_f32_16x16x32_bf16 v[88:91], v[104:107], a[240:243], v[88:91]
  ds_read2_b32 v[104:105], v52 offset0:112 offset1:113
  ds_read2_b32 v[106:107], v52 offset0:114 offset1:115
  s_waitcnt lgkmcnt(6)
  v_mfma_f32_16x16x32_bf16 v[60:63], v[92:95], a[12:15], v[60:63]
  v_mfma_f32_16x16x32_bf16 v[64:67], v[92:95], a[44:47], v[64:67]
  v_mfma_f32_16x16x32_bf16 v[68:71], v[92:95], a[76:79], v[68:71]
  v_mfma_f32_16x16x32_bf16 v[72:75], v[92:95], a[108:111], v[72:75]
  v_mfma_f32_16x16x32_bf16 v[76:79], v[92:95], a[140:143], v[76:79]
  v_mfma_f32_16x16x32_bf16 v[80:83], v[92:95], a[172:175], v[80:83]
  v_mfma_f32_16x16x32_bf16 v[84:87], v[92:95], a[204:207], v[84:87]
  v_mfma_f32_16x16x32_bf16 v[88:91], v[92:95], a[236:239], v[88:91]
  ds_read2_b32 v[92:93], v52 offset0:96 offset1:97
  ds_read2_b32 v[94:95], v52 offset0:98 offset1:99
  s_waitcnt lgkmcnt(6)
  v_mfma_f32_16x16x32_bf16 v[60:63], v[96:99], a[8:11], v[60:63]
  v_mfma_f32_16x16x32_bf16 v[64:67], v[96:99], a[40:43], v[64:67]
  v_mfma_f32_16x16x32_bf16 v[68:71], v[96:99], a[72:75], v[68:71]
  v_mfma_f32_16x16x32_bf16 v[72:75], v[96:99], a[104:107], v[72:75]
  v_mfma_f32_16x16x32_bf16 v[76:79], v[96:99], a[136:139], v[76:79]
  v_mfma_f32_16x16x32_bf16 v[80:83], v[96:99], a[168:171], v[80:83]
  v_mfma_f32_16x16x32_bf16 v[84:87], v[96:99], a[200:203], v[84:87]
  v_mfma_f32_16x16x32_bf16 v[88:91], v[96:99], a[232:235], v[88:91]
  ds_read2_b32 v[96:97], v52 offset0:80 offset1:81
  ds_read2_b32 v[98:99], v52 offset0:82 offset1:83
  s_waitcnt lgkmcnt(6)
  v_mfma_f32_16x16x32_bf16 v[60:63], v[100:103], a[4:7], v[60:63]
  v_mfma_f32_16x16x32_bf16 v[64:67], v[100:103], a[36:39], v[64:67]
  v_mfma_f32_16x16x32_bf16 v[68:71], v[100:103], a[68:71], v[68:71]
  v_mfma_f32_16x16x32_bf16 v[72:75], v[100:103], a[100:103], v[72:75]
  v_mfma_f32_16x16x32_bf16 v[76:79], v[100:103], a[132:135], v[76:79]
  v_mfma_f32_16x16x32_bf16 v[80:83], v[100:103], a[164:167], v[80:83]
  v_mfma_f32_16x16x32_bf16 v[84:87], v[100:103], a[196:199], v[84:87]
  v_mfma_f32_16x16x32_bf16 v[88:91], v[100:103], a[228:231], v[88:91]
  ds_read2_b32 v[100:101], v52 offset0:64 offset1:65
  ds_read2_b32 v[102:103], v52 offset0:66 offset1:67
  s_waitcnt lgkmcnt(6)
  v_mfma_f32_16x16x32_bf16 v[60:63], v[104:107], a[0:3], v[60:63]
  v_mfma_f32_16x16x32_bf16 v[64:67], v[104:107], a[32:35], v[64:67]
  v_mfma_f32_16x16x32_bf16 v[68:71], v[104:107], a[64:67], v[68:71]
  v_mfma_f32_16x16x32_bf16 v[72:75], v[104:107], a[96:99], v[72:75]
  v_mfma_f32_16x16x32_bf16 v[76:79], v[104:107], a[128:131], v[76:79]
  v_mfma_f32_16x16x32_bf16 v[80:83], v[104:107], a[160:163], v[80:83]
  v_mfma_f32_16x16x32_bf16 v[84:87], v[104:107], a[192:195], v[84:87]
  v_mfma_f32_16x16x32_bf16 v[88:91], v[104:107], a[224:227], v[88:91]
  ds_read2_b32 v[104:105], v52 offset0:48 offset1:49
  ds_read2_b32 v[106:107], v52 offset0:50 offset1:51
  s_waitcnt lgkmcnt(6)
  v_mfma_f32_16x16x32_bf16 v[64:67], v[92:95], a[28:31], v[64:67]
  v_mfma_f32_16x16x32_bf16 v[68:71], v[92:95], a[60:63], v[68:71]
  v_mfma_f32_16x16x32_bf16 v[72:75], v[92:95], a[92:95], v[72:75]
  v_mfma_f32_16x16x32_bf16 v[76:79], v[92:95], a[124:127], v[76:79]
  v_mfma_f32_16x16x32_bf16 v[80:83], v[92:95], a[156:159], v[80:83]
  v_mfma_f32_16x16x32_bf16 v[84:87], v[92:95], a[188:191], v[84:87]
  v_mfma_f32_16x16x32_bf16 v[88:91], v[92:95], a[220:223], v[88:91]
  ds_read2_b32 v[92:93], v52 offset0:32 offset1:33
  ds_read2_b32 v[94:95], v52 offset0:34 offset1:35
  s_waitcnt lgkmcnt(6)
  v_mfma_f32_16x16x32_bf16 v[64:67], v[96:99], a[24:27], v[64:67]
  v_mfma_f32_16x16x32_bf16 v[68:71], v[96:99], a[56:59], v[68:71]
  v_mfma_f32_16x16x32_bf16 v[72:75], v[96:99], a[88:91], v[72:75]
  v_mfma_f32_16x16x32_bf16 v[76:79], v[96:99], a[120:123], v[76:79]
  v_mfma_f32_16x16x32_bf16 v[80:83], v[96:99], a[152:155], v[80:83]
  v_mfma_f32_16x16x32_bf16 v[84:87], v[96:99], a[184:187], v[84:87]
  v_mfma_f32_16x16x32_bf16 v[88:91], v[96:99], a[216:219], v[88:91]
  ds_read2_b32 v[96:97], v52 offset0:16 offset1:17
  ds_read2_b32 v[98:99], v52 offset0:18 offset1:19
  s_waitcnt lgkmcnt(6)
  v_mfma_f32_16x16x32_bf16 v[64:67], v[100:103], a[20:23], v[64:67]
  v_mfma_f32_16x16x32_bf16 v[68:71], v[100:103], a[52:55], v[68:71]
  v_mfma_f32_16x16x32_bf16 v[72:75], v[100:103], a[84:87], v[72:75]
  v_mfma_f32_16x16x32_bf16 v[76:79], v[100:103], a[116:119], v[76:79]
  v_mfma_f32_16x16x32_bf16 v[80:83], v[100:103], a[148:151], v[80:83]
  v_mfma_f32_16x16x32_bf16 v[84:87], v[100:103], a[180:183], v[84:87]
  v_mfma_f32_16x16x32_bf16 v[88:91], v[100:103], a[212:215], v[88:91]
  ds_read2_b32 v[100:101], v52 offset0:0 offset1:1
  ds_read2_b32 v[102:103], v52 offset0:2 offset1:3
  s_waitcnt lgkmcnt(6)
  v_mfma_f32_16x16x32_bf16 v[64:67], v[104:107], a[16:19], v[64:67]
  v_mfma_f32_16x16x32_bf16 v[68:71], v[104:107], a[48:51], v[68:71]
  v_mfma_f32_16x16x32_bf16 v[72:75], v[104:107], a[80:83], v[72:75]
  v_mfma_f32_16x16x32_bf16 v[76:79], v[104:107], a[112:115], v[76:79]
  v_mfma_f32_16x16x32_bf16 v[80:83], v[104:107], a[144:147], v[80:83]
  v_mfma_f32_16x16x32_bf16 v[84:87], v[104:107], a[176:179], v[84:87]
  v_mfma_f32_16x16x32_bf16 v[88:91], v[104:107], a[208:211], v[88:91]
  ds_read2_b32 v[104:105], v53 offset0:224 offset1:225
  ds_read2_b32 v[106:107], v53 offset0:226 offset1:227
  s_waitcnt lgkmcnt(6)
  v_mfma_f32_16x16x32_bf16 v[64:67], v[92:95], a[12:15], v[64:67]
  v_mfma_f32_16x16x32_bf16 v[68:71], v[92:95], a[44:47], v[68:71]
  v_mfma_f32_16x16x32_bf16 v[72:75], v[92:95], a[76:79], v[72:75]
  v_mfma_f32_16x16x32_bf16 v[76:79], v[92:95], a[108:111], v[76:79]
  v_mfma_f32_16x16x32_bf16 v[80:83], v[92:95], a[140:143], v[80:83]
  v_mfma_f32_16x16x32_bf16 v[84:87], v[92:95], a[172:175], v[84:87]
  v_mfma_f32_16x16x32_bf16 v[88:91], v[92:95], a[204:207], v[88:91]
  ds_read2_b32 v[92:93], v53 offset0:208 offset1:209
  ds_read2_b32 v[94:95], v53 offset0:210 offset1:211
  s_waitcnt lgkmcnt(6)
  v_mfma_f32_16x16x32_bf16 v[64:67], v[96:99], a[8:11], v[64:67]
  v_mfma_f32_16x16x32_bf16 v[68:71], v[96:99], a[40:43], v[68:71]
  v_mfma_f32_16x16x32_bf16 v[72:75], v[96:99], a[72:75], v[72:75]
  v_mfma_f32_16x16x32_bf16 v[76:79], v[96:99], a[104:107], v[76:79]
  v_mfma_f32_16x16x32_bf16 v[80:83], v[96:99], a[136:139], v[80:83]
  v_mfma_f32_16x16x32_bf16 v[84:87], v[96:99], a[168:171], v[84:87]
  v_mfma_f32_16x16x32_bf16 v[88:91], v[96:99], a[200:203], v[88:91]
  ds_read2_b32 v[96:97], v53 offset0:192 offset1:193
  ds_read2_b32 v[98:99], v53 offset0:194 offset1:195
  s_waitcnt lgkmcnt(6)
  v_mfma_f32_16x16x32_bf16 v[64:67], v[100:103], a[4:7], v[64:67]
  v_mfma_f32_16x16x32_bf16 v[68:71], v[100:103], a[36:39], v[68:71]
  v_mfma_f32_16x16x32_bf16 v[72:75], v[100:103], a[68:71], v[72:75]
  v_mfma_f32_16x16x32_bf16 v[76:79], v[100:103], a[100:103], v[76:79]
  v_mfma_f32_16x16x32_bf16 v[80:83], v[100:103], a[132:135], v[80:83]
  v_mfma_f32_16x16x32_bf16 v[84:87], v[100:103], a[164:167], v[84:87]
  v_mfma_f32_16x16x32_bf16 v[88:91], v[100:103], a[196:199], v[88:91]
  ds_read2_b32 v[100:101], v53 offset0:176 offset1:177
  ds_read2_b32 v[102:103], v53 offset0:178 offset1:179
  s_waitcnt lgkmcnt(6)
  v_mfma_f32_16x16x32_bf16 v[64:67], v[104:107], a[0:3], v[64:67]
  v_mfma_f32_16x16x32_bf16 v[68:71], v[104:107], a[32:35], v[68:71]
  v_mfma_f32_16x16x32_bf16 v[72:75], v[104:107], a[64:67], v[72:75]
  v_mfma_f32_16x16x32_bf16 v[76:79], v[104:107], a[96:99], v[76:79]
  v_mfma_f32_16x16x32_bf16 v[80:83], v[104:107], a[128:131], v[80:83]
  v_mfma_f32_16x16x32_bf16 v[84:87], v[104:107], a[160:163], v[84:87]
  v_mfma_f32_16x16x32_bf16 v[88:91], v[104:107], a[192:195], v[88:91]
  ds_read2_b32 v[104:105], v53 offset0:160 offset1:161
  ds_read2_b32 v[106:107], v53 offset0:162 offset1:163
  s_waitcnt lgkmcnt(6)
  v_mfma_f32_16x16x32_bf16 v[68:71], v[92:95], a[28:31], v[68:71]
  v_mfma_f32_16x16x32_bf16 v[72:75], v[92:95], a[60:63], v[72:75]
  v_mfma_f32_16x16x32_bf16 v[76:79], v[92:95], a[92:95], v[76:79]
  v_mfma_f32_16x16x32_bf16 v[80:83], v[92:95], a[124:127], v[80:83]
  v_mfma_f32_16x16x32_bf16 v[84:87], v[92:95], a[156:159], v[84:87]
  v_mfma_f32_16x16x32_bf16 v[88:91], v[92:95], a[188:191], v[88:91]
  ds_read2_b32 v[92:93], v53 offset0:144 offset1:145
  ds_read2_b32 v[94:95], v53 offset0:146 offset1:147
  s_waitcnt lgkmcnt(6)
  v_mfma_f32_16x16x32_bf16 v[68:71], v[96:99], a[24:27], v[68:71]
  v_mfma_f32_16x16x32_bf16 v[72:75], v[96:99], a[56:59], v[72:75]
  v_mfma_f32_16x16x32_bf16 v[76:79], v[96:99], a[88:91], v[76:79]
  v_mfma_f32_16x16x32_bf16 v[80:83], v[96:99], a[120:123], v[80:83]
  v_mfma_f32_16x16x32_bf16 v[84:87], v[96:99], a[152:155], v[84:87]
  v_mfma_f32_16x16x32_bf16 v[88:91], v[96:99], a[184:187], v[88:91]
  ds_read2_b32 v[96:97], v53 offset0:128 offset1:129
  ds_read2_b32 v[98:99], v53 offset0:130 offset1:131
  s_waitcnt lgkmcnt(6)
  v_mfma_f32_16x16x32_bf16 v[68:71], v[100:103], a[20:23], v[68:71]
  v_mfma_f32_16x16x32_bf16 v[72:75], v[100:103], a[52:55], v[72:75]
  v_mfma_f32_16x16x32_bf16 v[76:79], v[100:103], a[84:87], v[76:79]
  v_mfma_f32_16x16x32_bf16 v[80:83], v[100:103], a[116:119], v[80:83]
  v_mfma_f32_16x16x32_bf16 v[84:87], v[100:103], a[148:151], v[84:87]
  v_mfma_f32_16x16x32_bf16 v[88:91], v[100:103], a[180:183], v[88:91]
  ds_read2_b32 v[100:101], v53 offset0:112 offset1:113
  ds_read2_b32 v[102:103], v53 offset0:114 offset1:115
  s_waitcnt lgkmcnt(6)
  v_mfma_f32_16x16x32_bf16 v[68:71], v[104:107], a[16:19], v[68:71]
  v_mfma_f32_16x16x32_bf16 v[72:75], v[104:107], a[48:51], v[72:75]
  v_mfma_f32_16x16x32_bf16 v[76:79], v[104:107], a[80:83], v[76:79]
  v_mfma_f32_16x16x32_bf16 v[80:83], v[104:107], a[112:115], v[80:83]
  v_mfma_f32_16x16x32_bf16 v[84:87], v[104:107], a[144:147], v[84:87]
  v_mfma_f32_16x16x32_bf16 v[88:91], v[104:107], a[176:179], v[88:91]
  ds_read2_b32 v[104:105], v53 offset0:96 offset1:97
  ds_read2_b32 v[106:107], v53 offset0:98 offset1:99
  s_waitcnt lgkmcnt(6)
  v_mfma_f32_16x16x32_bf16 v[68:71], v[92:95], a[12:15], v[68:71]
  v_mfma_f32_16x16x32_bf16 v[72:75], v[92:95], a[44:47], v[72:75]
  v_mfma_f32_16x16x32_bf16 v[76:79], v[92:95], a[76:79], v[76:79]
  v_mfma_f32_16x16x32_bf16 v[80:83], v[92:95], a[108:111], v[80:83]
  v_mfma_f32_16x16x32_bf16 v[84:87], v[92:95], a[140:143], v[84:87]
  v_mfma_f32_16x16x32_bf16 v[88:91], v[92:95], a[172:175], v[88:91]
  ds_read2_b32 v[92:93], v53 offset0:80 offset1:81
  ds_read2_b32 v[94:95], v53 offset0:82 offset1:83
  s_waitcnt lgkmcnt(6)
  v_mfma_f32_16x16x32_bf16 v[68:71], v[96:99], a[8:11], v[68:71]
  v_mfma_f32_16x16x32_bf16 v[72:75], v[96:99], a[40:43], v[72:75]
  v_mfma_f32_16x16x32_bf16 v[76:79], v[96:99], a[72:75], v[76:79]
  v_mfma_f32_16x16x32_bf16 v[80:83], v[96:99], a[104:107], v[80:83]
  v_mfma_f32_16x16x32_bf16 v[84:87], v[96:99], a[136:139], v[84:87]
  v_mfma_f32_16x16x32_bf16 v[88:91], v[96:99], a[168:171], v[88:91]
  ds_read2_b32 v[96:97], v53 offset0:64 offset1:65
  ds_read2_b32 v[98:99], v53 offset0:66 offset1:67
  s_waitcnt lgkmcnt(6)
  v_mfma_f32_16x16x32_bf16 v[68:71], v[100:103], a[4:7], v[68:71]
  v_mfma_f32_16x16x32_bf16 v[72:75], v[100:103], a[36:39], v[72:75]
  v_mfma_f32_16x16x32_bf16 v[76:79], v[100:103], a[68:71], v[76:79]
  v_mfma_f32_16x16x32_bf16 v[80:83], v[100:103], a[100:103], v[80:83]
  v_mfma_f32_16x16x32_bf16 v[84:87], v[100:103], a[132:135], v[84:87]
  v_mfma_f32_16x16x32_bf16 v[88:91], v[100:103], a[164:167], v[88:91]
  ds_read2_b32 v[100:101], v53 offset0:48 offset1:49
  ds_read2_b32 v[102:103], v53 offset0:50 offset1:51
  s_waitcnt lgkmcnt(6)
  v_mfma_f32_16x16x32_bf16 v[68:71], v[104:107], a[0:3], v[68:71]
  v_mfma_f32_16x16x32_bf16 v[72:75], v[104:107], a[32:35], v[72:75]
  v_mfma_f32_16x16x32_bf16 v[76:79], v[104:107], a[64:67], v[76:79]
  v_mfma_f32_16x16x32_bf16 v[80:83], v[104:107], a[96:99], v[80:83]
  v_mfma_f32_16x16x32_bf16 v[84:87], v[104:107], a[128:131], v[84:87]
  v_mfma_f32_16x16x32_bf16 v[88:91], v[104:107], a[160:163], v[88:91]
  ds_read2_b32 v[104:105], v53 offset0:32 offset1:33
  ds_read2_b32 v[106:107], v53 offset0:34 offset1:35
  s_waitcnt lgkmcnt(6)
  v_mfma_f32_16x16x32_bf16 v[72:75], v[92:95], a[28:31], v[72:75]
  v_mfma_f32_16x16x32_bf16 v[76:79], v[92:95], a[60:63], v[76:79]
  v_mfma_f32_16x16x32_bf16 v[80:83], v[92:95], a[92:95], v[80:83]
  v_mfma_f32_16x16x32_bf16 v[84:87], v[92:95], a[124:127], v[84:87]
  v_mfma_f32_16x16x32_bf16 v[88:91], v[92:95], a[156:159], v[88:91]
  ds_read2_b32 v[92:93], v53 offset0:16 offset1:17
  ds_read2_b32 v[94:95], v53 offset0:18 offset1:19
  s_waitcnt lgkmcnt(6)
  v_mfma_f32_16x16x32_bf16 v[72:75], v[96:99], a[24:27], v[72:75]
  v_mfma_f32_16x16x32_bf16 v[76:79], v[96:99], a[56:59], v[76:79]
  v_mfma_f32_16x16x32_bf16 v[80:83], v[96:99], a[88:91], v[80:83]
  v_mfma_f32_16x16x32_bf16 v[84:87], v[96:99], a[120:123], v[84:87]
  v_mfma_f32_16x16x32_bf16 v[88:91], v[96:99], a[152:155], v[88:91]
  ds_read2_b32 v[96:97], v53 offset0:0 offset1:1
  ds_read2_b32 v[98:99], v53 offset0:2 offset1:3
  s_waitcnt lgkmcnt(6)
  v_mfma_f32_16x16x32_bf16 v[72:75], v[100:103], a[20:23], v[72:75]
  v_mfma_f32_16x16x32_bf16 v[76:79], v[100:103], a[52:55], v[76:79]
  v_mfma_f32_16x16x32_bf16 v[80:83], v[100:103], a[84:87], v[80:83]
  v_mfma_f32_16x16x32_bf16 v[84:87], v[100:103], a[116:119], v[84:87]
  v_mfma_f32_16x16x32_bf16 v[88:91], v[100:103], a[148:151], v[88:91]
  ds_read2_b32 v[100:101], v54 offset0:224 offset1:225
  ds_read2_b32 v[102:103], v54 offset0:226 offset1:227
  s_waitcnt lgkmcnt(6)
  v_mfma_f32_16x16x32_bf16 v[72:75], v[104:107], a[16:19], v[72:75]
  v_mfma_f32_16x16x32_bf16 v[76:79], v[104:107], a[48:51], v[76:79]
  v_mfma_f32_16x16x32_bf16 v[80:83], v[104:107], a[80:83], v[80:83]
  v_mfma_f32_16x16x32_bf16 v[84:87], v[104:107], a[112:115], v[84:87]
  v_mfma_f32_16x16x32_bf16 v[88:91], v[104:107], a[144:147], v[88:91]
  ds_read2_b32 v[104:105], v54 offset0:208 offset1:209
  ds_read2_b32 v[106:107], v54 offset0:210 offset1:211
  s_waitcnt lgkmcnt(6)
  v_mfma_f32_16x16x32_bf16 v[72:75], v[92:95], a[12:15], v[72:75]
  v_mfma_f32_16x16x32_bf16 v[76:79], v[92:95], a[44:47], v[76:79]
  v_mfma_f32_16x16x32_bf16 v[80:83], v[92:95], a[76:79], v[80:83]
  v_mfma_f32_16x16x32_bf16 v[84:87], v[92:95], a[108:111], v[84:87]
  v_mfma_f32_16x16x32_bf16 v[88:91], v[92:95], a[140:143], v[88:91]
  ds_read2_b32 v[92:93], v54 offset0:192 offset1:193
  ds_read2_b32 v[94:95], v54 offset0:194 offset1:195
  s_waitcnt lgkmcnt(6)
  v_mfma_f32_16x16x32_bf16 v[72:75], v[96:99], a[8:11], v[72:75]
  v_mfma_f32_16x16x32_bf16 v[76:79], v[96:99], a[40:43], v[76:79]
  v_mfma_f32_16x16x32_bf16 v[80:83], v[96:99], a[72:75], v[80:83]
  v_mfma_f32_16x16x32_bf16 v[84:87], v[96:99], a[104:107], v[84:87]
  v_mfma_f32_16x16x32_bf16 v[88:91], v[96:99], a[136:139], v[88:91]
  ds_read2_b32 v[96:97], v54 offset0:176 offset1:177
  ds_read2_b32 v[98:99], v54 offset0:178 offset1:179
  s_waitcnt lgkmcnt(6)
  v_mfma_f32_16x16x32_bf16 v[72:75], v[100:103], a[4:7], v[72:75]
  v_mfma_f32_16x16x32_bf16 v[76:79], v[100:103], a[36:39], v[76:79]
  v_mfma_f32_16x16x32_bf16 v[80:83], v[100:103], a[68:71], v[80:83]
  v_mfma_f32_16x16x32_bf16 v[84:87], v[100:103], a[100:103], v[84:87]
  v_mfma_f32_16x16x32_bf16 v[88:91], v[100:103], a[132:135], v[88:91]
  ds_read2_b32 v[100:101], v54 offset0:160 offset1:161
  ds_read2_b32 v[102:103], v54 offset0:162 offset1:163
  s_waitcnt lgkmcnt(6)
  v_mfma_f32_16x16x32_bf16 v[72:75], v[104:107], a[0:3], v[72:75]
  v_mfma_f32_16x16x32_bf16 v[76:79], v[104:107], a[32:35], v[76:79]
  v_mfma_f32_16x16x32_bf16 v[80:83], v[104:107], a[64:67], v[80:83]
  v_mfma_f32_16x16x32_bf16 v[84:87], v[104:107], a[96:99], v[84:87]
  v_mfma_f32_16x16x32_bf16 v[88:91], v[104:107], a[128:131], v[88:91]
  ds_read2_b32 v[104:105], v54 offset0:144 offset1:145
  ds_read2_b32 v[106:107], v54 offset0:146 offset1:147
  s_waitcnt lgkmcnt(6)
  v_mfma_f32_16x16x32_bf16 v[76:79], v[92:95], a[28:31], v[76:79]
  v_mfma_f32_16x16x32_bf16 v[80:83], v[92:95], a[60:63], v[80:83]
  v_mfma_f32_16x16x32_bf16 v[84:87], v[92:95], a[92:95], v[84:87]
  v_mfma_f32_16x16x32_bf16 v[88:91], v[92:95], a[124:127], v[88:91]
  ds_read2_b32 v[92:93], v54 offset0:128 offset1:129
  ds_read2_b32 v[94:95], v54 offset0:130 offset1:131
  s_waitcnt lgkmcnt(6)
  v_mfma_f32_16x16x32_bf16 v[76:79], v[96:99], a[24:27], v[76:79]
  v_mfma_f32_16x16x32_bf16 v[80:83], v[96:99], a[56:59], v[80:83]
  v_mfma_f32_16x16x32_bf16 v[84:87], v[96:99], a[88:91], v[84:87]
  v_mfma_f32_16x16x32_bf16 v[88:91], v[96:99], a[120:123], v[88:91]
  ds_read2_b32 v[96:97], v54 offset0:112 offset1:113
  ds_read2_b32 v[98:99], v54 offset0:114 offset1:115
  s_waitcnt lgkmcnt(6)
  v_mfma_f32_16x16x32_bf16 v[76:79], v[100:103], a[20:23], v[76:79]
  v_mfma_f32_16x16x32_bf16 v[80:83], v[100:103], a[52:55], v[80:83]
  v_mfma_f32_16x16x32_bf16 v[84:87], v[100:103], a[84:87], v[84:87]
  v_mfma_f32_16x16x32_bf16 v[88:91], v[100:103], a[116:119], v[88:91]
  ds_read2_b32 v[100:101], v54 offset0:96 offset1:97
  ds_read2_b32 v[102:103], v54 offset0:98 offset1:99
  s_waitcnt lgkmcnt(6)
  v_mfma_f32_16x16x32_bf16 v[76:79], v[104:107], a[16:19], v[76:79]
  v_mfma_f32_16x16x32_bf16 v[80:83], v[104:107], a[48:51], v[80:83]
  v_mfma_f32_16x16x32_bf16 v[84:87], v[104:107], a[80:83], v[84:87]
  v_mfma_f32_16x16x32_bf16 v[88:91], v[104:107], a[112:115], v[88:91]
  ds_read2_b32 v[104:105], v54 offset0:80 offset1:81
  ds_read2_b32 v[106:107], v54 offset0:82 offset1:83
  s_waitcnt lgkmcnt(6)
  v_mfma_f32_16x16x32_bf16 v[76:79], v[92:95], a[12:15], v[76:79]
  v_mfma_f32_16x16x32_bf16 v[80:83], v[92:95], a[44:47], v[80:83]
  v_mfma_f32_16x16x32_bf16 v[84:87], v[92:95], a[76:79], v[84:87]
  v_mfma_f32_16x16x32_bf16 v[88:91], v[92:95], a[108:111], v[88:91]
  ds_read2_b32 v[92:93], v54 offset0:64 offset1:65
  ds_read2_b32 v[94:95], v54 offset0:66 offset1:67
  s_waitcnt lgkmcnt(6)
  v_mfma_f32_16x16x32_bf16 v[76:79], v[96:99], a[8:11], v[76:79]
  v_mfma_f32_16x16x32_bf16 v[80:83], v[96:99], a[40:43], v[80:83]
  v_mfma_f32_16x16x32_bf16 v[84:87], v[96:99], a[72:75], v[84:87]
  v_mfma_f32_16x16x32_bf16 v[88:91], v[96:99], a[104:107], v[88:91]
  ds_read2_b32 v[96:97], v54 offset0:48 offset1:49
  ds_read2_b32 v[98:99], v54 offset0:50 offset1:51
  s_waitcnt lgkmcnt(6)
  v_mfma_f32_16x16x32_bf16 v[76:79], v[100:103], a[4:7], v[76:79]
  v_mfma_f32_16x16x32_bf16 v[80:83], v[100:103], a[36:39], v[80:83]
  v_mfma_f32_16x16x32_bf16 v[84:87], v[100:103], a[68:71], v[84:87]
  v_mfma_f32_16x16x32_bf16 v[88:91], v[100:103], a[100:103], v[88:91]
  ds_read2_b32 v[100:101], v54 offset0:32 offset1:33
  ds_read2_b32 v[102:103], v54 offset0:34 offset1:35
  s_waitcnt lgkmcnt(6)
  v_mfma_f32_16x16x32_bf16 v[76:79], v[104:107], a[0:3], v[76:79]
  v_mfma_f32_16x16x32_bf16 v[80:83], v[104:107], a[32:35], v[80:83]
  v_mfma_f32_16x16x32_bf16 v[84:87], v[104:107], a[64:67], v[84:87]
  v_mfma_f32_16x16x32_bf16 v[88:91], v[104:107], a[96:99], v[88:91]
  ds_read2_b32 v[104:105], v54 offset0:16 offset1:17
  ds_read2_b32 v[106:107], v54 offset0:18 offset1:19
  s_waitcnt lgkmcnt(6)
  v_mfma_f32_16x16x32_bf16 v[80:83], v[92:95], a[28:31], v[80:83]
  v_mfma_f32_16x16x32_bf16 v[84:87], v[92:95], a[60:63], v[84:87]
  v_mfma_f32_16x16x32_bf16 v[88:91], v[92:95], a[92:95], v[88:91]
  ds_read2_b32 v[92:93], v54 offset0:0 offset1:1
  ds_read2_b32 v[94:95], v54 offset0:2 offset1:3
  s_waitcnt lgkmcnt(6)
  v_mfma_f32_16x16x32_bf16 v[80:83], v[96:99], a[24:27], v[80:83]
  v_mfma_f32_16x16x32_bf16 v[84:87], v[96:99], a[56:59], v[84:87]
  v_mfma_f32_16x16x32_bf16 v[88:91], v[96:99], a[88:91], v[88:91]
  ds_read2_b32 v[96:97], v55 offset0:224 offset1:225
  ds_read2_b32 v[98:99], v55 offset0:226 offset1:227
  s_waitcnt lgkmcnt(6)
  v_mfma_f32_16x16x32_bf16 v[80:83], v[100:103], a[20:23], v[80:83]
  v_mfma_f32_16x16x32_bf16 v[84:87], v[100:103], a[52:55], v[84:87]
  v_mfma_f32_16x16x32_bf16 v[88:91], v[100:103], a[84:87], v[88:91]
  ds_read2_b32 v[100:101], v55 offset0:208 offset1:209
  ds_read2_b32 v[102:103], v55 offset0:210 offset1:211
  s_waitcnt lgkmcnt(6)
  v_mfma_f32_16x16x32_bf16 v[80:83], v[104:107], a[16:19], v[80:83]
  v_mfma_f32_16x16x32_bf16 v[84:87], v[104:107], a[48:51], v[84:87]
  v_mfma_f32_16x16x32_bf16 v[88:91], v[104:107], a[80:83], v[88:91]
  ds_read2_b32 v[104:105], v55 offset0:192 offset1:193
  ds_read2_b32 v[106:107], v55 offset0:194 offset1:195
  s_waitcnt lgkmcnt(6)
  v_mfma_f32_16x16x32_bf16 v[80:83], v[92:95], a[12:15], v[80:83]
  v_mfma_f32_16x16x32_bf16 v[84:87], v[92:95], a[44:47], v[84:87]
  v_mfma_f32_16x16x32_bf16 v[88:91], v[92:95], a[76:79], v[88:91]
  ds_read2_b32 v[92:93], v55 offset0:176 offset1:177
  ds_read2_b32 v[94:95], v55 offset0:178 offset1:179
  s_waitcnt lgkmcnt(6)
  v_mfma_f32_16x16x32_bf16 v[80:83], v[96:99], a[8:11], v[80:83]
  v_mfma_f32_16x16x32_bf16 v[84:87], v[96:99], a[40:43], v[84:87]
  v_mfma_f32_16x16x32_bf16 v[88:91], v[96:99], a[72:75], v[88:91]
  ds_read2_b32 v[96:97], v55 offset0:160 offset1:161
  ds_read2_b32 v[98:99], v55 offset0:162 offset1:163
  s_waitcnt lgkmcnt(6)
  v_mfma_f32_16x16x32_bf16 v[80:83], v[100:103], a[4:7], v[80:83]
  v_mfma_f32_16x16x32_bf16 v[84:87], v[100:103], a[36:39], v[84:87]
  v_mfma_f32_16x16x32_bf16 v[88:91], v[100:103], a[68:71], v[88:91]
  ds_read2_b32 v[100:101], v55 offset0:144 offset1:145
  ds_read2_b32 v[102:103], v55 offset0:146 offset1:147
  s_waitcnt lgkmcnt(6)
  v_mfma_f32_16x16x32_bf16 v[80:83], v[104:107], a[0:3], v[80:83]
  v_mfma_f32_16x16x32_bf16 v[84:87], v[104:107], a[32:35], v[84:87]
  v_mfma_f32_16x16x32_bf16 v[88:91], v[104:107], a[64:67], v[88:91]
  ds_read2_b32 v[104:105], v55 offset0:128 offset1:129
  ds_read2_b32 v[106:107], v55 offset0:130 offset1:131
  s_waitcnt lgkmcnt(6)
  v_mfma_f32_16x16x32_bf16 v[84:87], v[92:95], a[28:31], v[84:87]
  v_mfma_f32_16x16x32_bf16 v[88:91], v[92:95], a[60:63], v[88:91]
  ds_read2_b32 v[92:93], v55 offset0:112 offset1:113
  ds_read2_b32 v[94:95], v55 offset0:114 offset1:115
  s_waitcnt lgkmcnt(6)
  v_mfma_f32_16x16x32_bf16 v[84:87], v[96:99], a[24:27], v[84:87]
  v_mfma_f32_16x16x32_bf16 v[88:91], v[96:99], a[56:59], v[88:91]
  ds_read2_b32 v[96:97], v55 offset0:96 offset1:97
  ds_read2_b32 v[98:99], v55 offset0:98 offset1:99
  s_waitcnt lgkmcnt(6)
  v_mfma_f32_16x16x32_bf16 v[84:87], v[100:103], a[20:23], v[84:87]
  v_mfma_f32_16x16x32_bf16 v[88:91], v[100:103], a[52:55], v[88:91]
  ds_read2_b32 v[100:101], v55 offset0:80 offset1:81
  ds_read2_b32 v[102:103], v55 offset0:82 offset1:83
  s_waitcnt lgkmcnt(6)
  v_mfma_f32_16x16x32_bf16 v[84:87], v[104:107], a[16:19], v[84:87]
  v_mfma_f32_16x16x32_bf16 v[88:91], v[104:107], a[48:51], v[88:91]
  ds_read2_b32 v[104:105], v55 offset0:64 offset1:65
  ds_read2_b32 v[106:107], v55 offset0:66 offset1:67
  s_waitcnt lgkmcnt(6)
  v_mfma_f32_16x16x32_bf16 v[84:87], v[92:95], a[12:15], v[84:87]
  v_mfma_f32_16x16x32_bf16 v[88:91], v[92:95], a[44:47], v[88:91]
  ds_read2_b32 v[92:93], v55 offset0:48 offset1:49
  ds_read2_b32 v[94:95], v55 offset0:50 offset1:51
  s_waitcnt lgkmcnt(6)
  v_mfma_f32_16x16x32_bf16 v[84:87], v[96:99], a[8:11], v[84:87]
  v_mfma_f32_16x16x32_bf16 v[88:91], v[96:99], a[40:43], v[88:91]
  ds_read2_b32 v[96:97], v55 offset0:32 offset1:33
  ds_read2_b32 v[98:99], v55 offset0:34 offset1:35
  s_waitcnt lgkmcnt(6)
  v_mfma_f32_16x16x32_bf16 v[84:87], v[100:103], a[4:7], v[84:87]
  v_mfma_f32_16x16x32_bf16 v[88:91], v[100:103], a[36:39], v[88:91]
  ds_read2_b32 v[100:101], v55 offset0:16 offset1:17
  ds_read2_b32 v[102:103], v55 offset0:18 offset1:19
  s_waitcnt lgkmcnt(6)
  v_mfma_f32_16x16x32_bf16 v[84:87], v[104:107], a[0:3], v[84:87]
  v_mfma_f32_16x16x32_bf16 v[88:91], v[104:107], a[32:35], v[88:91]
  ds_read2_b32 v[104:105], v55 offset0:0 offset1:1
  ds_read2_b32 v[106:107], v55 offset0:2 offset1:3
  s_waitcnt lgkmcnt(6)
  v_mfma_f32_16x16x32_bf16 v[88:91], v[92:95], a[28:31], v[88:91]
  ds_read2_b32 v[92:93], v56 offset0:224 offset1:225
  ds_read2_b32 v[94:95], v56 offset0:226 offset1:227
  s_waitcnt lgkmcnt(6)
  v_mfma_f32_16x16x32_bf16 v[88:91], v[96:99], a[24:27], v[88:91]
  ds_read2_b32 v[96:97], v56 offset0:208 offset1:209
  ds_read2_b32 v[98:99], v56 offset0:210 offset1:211
  s_waitcnt lgkmcnt(6)
  v_mfma_f32_16x16x32_bf16 v[88:91], v[100:103], a[20:23], v[88:91]
  ds_read2_b32 v[100:101], v56 offset0:192 offset1:193
  ds_read2_b32 v[102:103], v56 offset0:194 offset1:195
  s_waitcnt lgkmcnt(6)
  v_mfma_f32_16x16x32_bf16 v[88:91], v[104:107], a[16:19], v[88:91]
  ds_read2_b32 v[104:105], v56 offset0:176 offset1:177
  ds_read2_b32 v[106:107], v56 offset0:178 offset1:179
  s_waitcnt lgkmcnt(6)
  v_mfma_f32_16x16x32_bf16 v[88:91], v[92:95], a[12:15], v[88:91]
  s_waitcnt lgkmcnt(4)
  v_mfma_f32_16x16x32_bf16 v[88:91], v[96:99], a[8:11], v[88:91]
  s_waitcnt lgkmcnt(2)
  v_mfma_f32_16x16x32_bf16 v[88:91], v[100:103], a[4:7], v[88:91]
  s_waitcnt lgkmcnt(0)
  v_mfma_f32_16x16x32_bf16 v[88:91], v[104:107], a[0:3], v[88:91]
  v_lshlrev_b32 v46, 5, v4
  v_lshl_add_u32 v46, v3, 3, v46
  v_add_u32 v46, s17, v46
  ds_read_b64 v[108:109], v46 offset:512
  ds_read_b64 v[110:111], v46 offset:1024
  ds_read_b64 v[112:113], v46 offset:1536
  ds_read_b64 v[114:115], v46 offset:2048
  ds_read_b64 v[116:117], v46 offset:2560
  ds_read_b64 v[118:119], v46 offset:3072
  ds_read_b64 v[120:121], v46 offset:3584
  ds_read_b64 v[122:123], v46 offset:4096
  s_waitcnt lgkmcnt(0)
  v_lshlrev_b32 v124, 16, v108
  v_and_b32 v125, 0xffff0000, v108
  v_lshlrev_b32 v126, 16, v109
  v_and_b32 v127, 0xffff0000, v109
  v_mul_f32 v124, v124, v33
  v_mul_f32 v125, v125, v33
  v_mul_f32 v126, v126, v33
  v_mul_f32 v127, v127, v33
  v_cvt_pk_bf16_f32 v128, v124, v125
  v_cvt_pk_bf16_f32 v129, v126, v127
  v_cvt_pk_bf16_f32 v130, v60, v61
  v_cvt_pk_bf16_f32 v131, v62, v63
  v_lshlrev_b32 v124, 16, v128
  v_and_b32 v125, 0xffff0000, v128
  v_lshlrev_b32 v132, 16, v130
  v_and_b32 v133, 0xffff0000, v130
  v_lshlrev_b32 v126, 16, v129
  v_and_b32 v127, 0xffff0000, v129
  v_lshlrev_b32 v134, 16, v131
  v_and_b32 v135, 0xffff0000, v131
  v_add_f32 v124, v124, v132
  v_add_f32 v125, v125, v133
  v_add_f32 v126, v126, v134
  v_add_f32 v127, v127, v135
  v_cvt_pk_bf16_f32 v108, v124, v125
  v_cvt_pk_bf16_f32 v109, v126, v127
  ds_write_b64 v46, v[108:109] offset:512
  v_lshlrev_b32 v124, 16, v110
  v_and_b32 v125, 0xffff0000, v110
  v_lshlrev_b32 v126, 16, v111
  v_and_b32 v127, 0xffff0000, v111
  v_mul_f32 v124, v124, v33
  v_mul_f32 v125, v125, v33
  v_mul_f32 v126, v126, v33
  v_mul_f32 v127, v127, v33
  v_cvt_pk_bf16_f32 v128, v124, v125
  v_cvt_pk_bf16_f32 v129, v126, v127
  v_cvt_pk_bf16_f32 v130, v64, v65
  v_cvt_pk_bf16_f32 v131, v66, v67
  v_lshlrev_b32 v124, 16, v128
  v_and_b32 v125, 0xffff0000, v128
  v_lshlrev_b32 v132, 16, v130
  v_and_b32 v133, 0xffff0000, v130
  v_lshlrev_b32 v126, 16, v129
  v_and_b32 v127, 0xffff0000, v129
  v_lshlrev_b32 v134, 16, v131
  v_and_b32 v135, 0xffff0000, v131
  v_add_f32 v124, v124, v132
  v_add_f32 v125, v125, v133
  v_add_f32 v126, v126, v134
  v_add_f32 v127, v127, v135
  v_cvt_pk_bf16_f32 v110, v124, v125
  v_cvt_pk_bf16_f32 v111, v126, v127
  ds_write_b64 v46, v[110:111] offset:1024
  v_lshlrev_b32 v124, 16, v112
  v_and_b32 v125, 0xffff0000, v112
  v_lshlrev_b32 v126, 16, v113
  v_and_b32 v127, 0xffff0000, v113
  v_mul_f32 v124, v124, v33
  v_mul_f32 v125, v125, v33
  v_mul_f32 v126, v126, v33
  v_mul_f32 v127, v127, v33
  v_cvt_pk_bf16_f32 v128, v124, v125
  v_cvt_pk_bf16_f32 v129, v126, v127
  v_cvt_pk_bf16_f32 v130, v68, v69
  v_cvt_pk_bf16_f32 v131, v70, v71
  v_lshlrev_b32 v124, 16, v128
  v_and_b32 v125, 0xffff0000, v128
  v_lshlrev_b32 v132, 16, v130
  v_and_b32 v133, 0xffff0000, v130
  v_lshlrev_b32 v126, 16, v129
  v_and_b32 v127, 0xffff0000, v129
  v_lshlrev_b32 v134, 16, v131
  v_and_b32 v135, 0xffff0000, v131
  v_add_f32 v124, v124, v132
  v_add_f32 v125, v125, v133
  v_add_f32 v126, v126, v134
  v_add_f32 v127, v127, v135
  v_cvt_pk_bf16_f32 v112, v124, v125
  v_cvt_pk_bf16_f32 v113, v126, v127
  ds_write_b64 v46, v[112:113] offset:1536
  v_lshlrev_b32 v124, 16, v114
  v_and_b32 v125, 0xffff0000, v114
  v_lshlrev_b32 v126, 16, v115
  v_and_b32 v127, 0xffff0000, v115
  v_mul_f32 v124, v124, v33
  v_mul_f32 v125, v125, v33
  v_mul_f32 v126, v126, v33
  v_mul_f32 v127, v127, v33
  v_cvt_pk_bf16_f32 v128, v124, v125
  v_cvt_pk_bf16_f32 v129, v126, v127
  v_cvt_pk_bf16_f32 v130, v72, v73
  v_cvt_pk_bf16_f32 v131, v74, v75
  v_lshlrev_b32 v124, 16, v128
  v_and_b32 v125, 0xffff0000, v128
  v_lshlrev_b32 v132, 16, v130
  v_and_b32 v133, 0xffff0000, v130
  v_lshlrev_b32 v126, 16, v129
  v_and_b32 v127, 0xffff0000, v129
  v_lshlrev_b32 v134, 16, v131
  v_and_b32 v135, 0xffff0000, v131
  v_add_f32 v124, v124, v132
  v_add_f32 v125, v125, v133
  v_add_f32 v126, v126, v134
  v_add_f32 v127, v127, v135
  v_cvt_pk_bf16_f32 v114, v124, v125
  v_cvt_pk_bf16_f32 v115, v126, v127
  ds_write_b64 v46, v[114:115] offset:2048
  v_lshlrev_b32 v124, 16, v116
  v_and_b32 v125, 0xffff0000, v116
  v_lshlrev_b32 v126, 16, v117
  v_and_b32 v127, 0xffff0000, v117
  v_mul_f32 v124, v124, v33
  v_mul_f32 v125, v125, v33
  v_mul_f32 v126, v126, v33
  v_mul_f32 v127, v127, v33
  v_cvt_pk_bf16_f32 v128, v124, v125
  v_cvt_pk_bf16_f32 v129, v126, v127
  v_cvt_pk_bf16_f32 v130, v76, v77
  v_cvt_pk_bf16_f32 v131, v78, v79
  v_lshlrev_b32 v124, 16, v128
  v_and_b32 v125, 0xffff0000, v128
  v_lshlrev_b32 v132, 16, v130
  v_and_b32 v133, 0xffff0000, v130
  v_lshlrev_b32 v126, 16, v129
  v_and_b32 v127, 0xffff0000, v129
  v_lshlrev_b32 v134, 16, v131
  v_and_b32 v135, 0xffff0000, v131
  v_add_f32 v124, v124, v132
  v_add_f32 v125, v125, v133
  v_add_f32 v126, v126, v134
  v_add_f32 v127, v127, v135
  v_cvt_pk_bf16_f32 v116, v124, v125
  v_cvt_pk_bf16_f32 v117, v126, v127
  ds_write_b64 v46, v[116:117] offset:2560
  v_lshlrev_b32 v124, 16, v118
  v_and_b32 v125, 0xffff0000, v118
  v_lshlrev_b32 v126, 16, v119
  v_and_b32 v127, 0xffff0000, v119
  v_mul_f32 v124, v124, v33
  v_mul_f32 v125, v125, v33
  v_mul_f32 v126, v126, v33
  v_mul_f32 v127, v127, v33
  v_cvt_pk_bf16_f32 v128, v124, v125
  v_cvt_pk_bf16_f32 v129, v126, v127
  v_cvt_pk_bf16_f32 v130, v80, v81
  v_cvt_pk_bf16_f32 v131, v82, v83
  v_lshlrev_b32 v124, 16, v128
  v_and_b32 v125, 0xffff0000, v128
  v_lshlrev_b32 v132, 16, v130
  v_and_b32 v133, 0xffff0000, v130
  v_lshlrev_b32 v126, 16, v129
  v_and_b32 v127, 0xffff0000, v129
  v_lshlrev_b32 v134, 16, v131
  v_and_b32 v135, 0xffff0000, v131
  v_add_f32 v124, v124, v132
  v_add_f32 v125, v125, v133
  v_add_f32 v126, v126, v134
  v_add_f32 v127, v127, v135
  v_cvt_pk_bf16_f32 v118, v124, v125
  v_cvt_pk_bf16_f32 v119, v126, v127
  ds_write_b64 v46, v[118:119] offset:3072
  v_lshlrev_b32 v124, 16, v120
  v_and_b32 v125, 0xffff0000, v120
  v_lshlrev_b32 v126, 16, v121
  v_and_b32 v127, 0xffff0000, v121
  v_mul_f32 v124, v124, v33
  v_mul_f32 v125, v125, v33
  v_mul_f32 v126, v126, v33
  v_mul_f32 v127, v127, v33
  v_cvt_pk_bf16_f32 v128, v124, v125
  v_cvt_pk_bf16_f32 v129, v126, v127
  v_cvt_pk_bf16_f32 v130, v84, v85
  v_cvt_pk_bf16_f32 v131, v86, v87
  v_lshlrev_b32 v124, 16, v128
  v_and_b32 v125, 0xffff0000, v128
  v_lshlrev_b32 v132, 16, v130
  v_and_b32 v133, 0xffff0000, v130
  v_lshlrev_b32 v126, 16, v129
  v_and_b32 v127, 0xffff0000, v129
  v_lshlrev_b32 v134, 16, v131
  v_and_b32 v135, 0xffff0000, v131
  v_add_f32 v124, v124, v132
  v_add_f32 v125, v125, v133
  v_add_f32 v126, v126, v134
  v_add_f32 v127, v127, v135
  v_cvt_pk_bf16_f32 v120, v124, v125
  v_cvt_pk_bf16_f32 v121, v126, v127
  ds_write_b64 v46, v[120:121] offset:3584
  v_lshlrev_b32 v124, 16, v122
  v_and_b32 v125, 0xffff0000, v122
  v_lshlrev_b32 v126, 16, v123
  v_and_b32 v127, 0xffff0000, v123
  v_mul_f32 v124, v124, v33
  v_mul_f32 v125, v125, v33
  v_mul_f32 v126, v126, v33
  v_mul_f32 v127, v127, v33
  v_cvt_pk_bf16_f32 v128, v124, v125
  v_cvt_pk_bf16_f32 v129, v126, v127
  v_cvt_pk_bf16_f32 v130, v88, v89
  v_cvt_pk_bf16_f32 v131, v90, v91
  v_lshlrev_b32 v124, 16, v128
  v_and_b32 v125, 0xffff0000, v128
  v_lshlrev_b32 v132, 16, v130
  v_and_b32 v133, 0xffff0000, v130
  v_lshlrev_b32 v126, 16, v129
  v_and_b32 v127, 0xffff0000, v129
  v_lshlrev_b32 v134, 16, v131
  v_and_b32 v135, 0xffff0000, v131
  v_add_f32 v124, v124, v132
  v_add_f32 v125, v125, v133
  v_add_f32 v126, v126, v134
  v_add_f32 v127, v127, v135
  v_cvt_pk_bf16_f32 v122, v124, v125
  v_cvt_pk_bf16_f32 v123, v126, v127
  ds_write_b64 v46, v[122:123] offset:4096
  s_waitcnt lgkmcnt(0)
  s_barrier
  v_lshlrev_b32 v6, 3, v0
  v_lshlrev_b32 v5, 4, v0
  v_add_u32 v36, 512, v6
  ds_read_b64 v[8:9], v36
  v_add_u32 v36, 25088, v6
  ds_read_b64 v[10:11], v36
  v_add_u32 v36, 49664, v6
  ds_read_b64 v[12:13], v36
  v_add_u32 v36, 74240, v6
  ds_read_b64 v[14:15], v36
  s_waitcnt lgkmcnt(0)
  s_add_u32 s22, s21, 0
  s_add_u32 s23, s22, 3584
  v_perm_b32 v16, v10, v8, s24
  v_perm_b32 v17, v14, v12, s24
  s_lshl_b32 s22, s21, 11
  s_add_u32 s22, s22, 90177536
  v_perm_b32 v18, v10, v8, s25
  v_perm_b32 v19, v14, v12, s25
  buffer_store_dwordx4 v[16:19], v5, s[8:11], s22 offen sc1
  v_perm_b32 v20, v11, v9, s24
  v_perm_b32 v21, v15, v13, s24
  v_perm_b32 v22, v11, v9, s25
  v_perm_b32 v23, v15, v13, s25
  s_add_u32 s22, s22, 4096
  buffer_store_dwordx4 v[20:23], v5, s[8:11], s22 offen sc1
  v_add_u32 v36, 2560, v6
  ds_read_b64 v[8:9], v36
  v_add_u32 v36, 27136, v6
  ds_read_b64 v[10:11], v36
  v_add_u32 v36, 51712, v6
  ds_read_b64 v[12:13], v36
  v_add_u32 v36, 76288, v6
  ds_read_b64 v[14:15], v36
  s_waitcnt lgkmcnt(0)
  s_add_u32 s22, s21, 1835008
  s_add_u32 s23, s22, 3584
  v_perm_b32 v24, v10, v8, s24
  v_perm_b32 v25, v14, v12, s24
  s_lshl_b32 s22, s21, 11
  s_add_u32 s22, s22, 90185728
  v_perm_b32 v26, v10, v8, s25
  v_perm_b32 v27, v14, v12, s25
  buffer_store_dwordx4 v[24:27], v5, s[8:11], s22 offen sc1
  v_perm_b32 v28, v11, v9, s24
  v_perm_b32 v29, v15, v13, s24
  v_perm_b32 v30, v11, v9, s25
  v_perm_b32 v31, v15, v13, s25
  s_add_u32 s22, s22, 4096
  buffer_store_dwordx4 v[28:31], v5, s[8:11], s22 offen sc1
  s_waitcnt vmcnt(0)
  s_barrier
  s_cmp_lg_u32 s16, 0
  s_cbranch_scc1 wk_nc
  v_mov_b32 v5, 1
  s_mov_b32 s22, 88599424
  s_mov_b64 exec, 1
  buffer_atomic_add v5, off, s[8:11], s22
  s_mov_b64 exec, -1
wk_nc:
  s_branch wk_loop
wk_tok:
  s_sub_u32 s3, s3, 864
  s_cmp_lt_u32 s3, 512
  s_cbranch_scc1 wk_tk
  s_sub_u32 s3, s3, 64
  s_cmp_ge_i32 s3, 512
  s_cbranch_scc1 wk_tk
  s_sub_u32 s18, s3, 448
  s_mov_b32 s20, 88599424
  v_mov_b32 v8, 0
  s_mov_b32 s30, 0
wk_cw:
  buffer_load_dword v9, v8, s[8:11], s20 offen sc1
  s_waitcnt vmcnt(0)
  v_cmp_ne_u32 vcc, 112, v9
  s_cbranch_vccz wk_cw_ok
  s_sleep 32
  s_add_u32 s30, s30, 1
  s_cmp_lt_u32 s30, 50000
  s_cbranch_scc1 wk_cw
  s_branch cA_abort
wk_cw_ok:
  v_lshlrev_b32 v5, 14, v3
  v_and_b32 v6, 1, v4
  v_lshl_add_u32 v5, v6, 12, v5
  v_lshrrev_b32 v6, 1, v4
  v_lshl_add_u32 v5, v6, 4, v5
  s_mul_i32 s20, s16, 458752
  s_lshl_b32 s21, s18, 7
  s_add_u32 s20, s20, s21
  s_and_b32 s21, s18, 32
  s_lshl_b32 s21, s21, 7
  s_add_u32 s20, s20, s21
  s_add_u32 s20, s20, 90177536
  buffer_load_dwordx4 v[8:11], v5, s[8:11], s20 offen sc1
  s_add_u32 s20, s20, 65536
  buffer_load_dwordx4 v[12:15], v5, s[8:11], s20 offen sc1
  s_add_u32 s20, s20, 65536
  buffer_load_dwordx4 v[16:19], v5, s[8:11], s20 offen sc1
  s_add_u32 s20, s20, 65536
  buffer_load_dwordx4 v[20:23], v5, s[8:11], s20 offen sc1
  s_add_u32 s20, s20, 65536
  buffer_load_dwordx4 v[24:27], v5, s[8:11], s20 offen sc1
  s_add_u32 s20, s20, 65536
  buffer_load_dwordx4 v[28:31], v5, s[8:11], s20 offen sc1
  s_add_u32 s20, s20, 65536
  buffer_load_dwordx4 v[32:35], v5, s[8:11], s20 offen sc1
  s_add_u32 s20, s20, 65536
  v_mul_u32_u24 v6, 1824, v4
  v_lshl_add_u32 v6, v3, 3, v6
  s_mul_i32 s20, s16, 224
  v_add_u32 v6, s20, v6
  s_movk_i32 s22, 912
  v_add_u32 v36, 0, v0
  v_mul_u32_u24 v37, 18725, v36
  v_lshrrev_b32 v37, 20, v37
  v_mul_u32_u24 v38, 56, v37
  v_sub_u32 v36, v36, v38
  v_lshlrev_b32 v36, 4, v36
  v_mad_u32_u24 v40, v37, s22, v36
  v_mul_u32_u24 v37, 1792, v37
  v_add_u32 v48, v37, v36
  v_add_u32 v36, 256, v0
  v_mul_u32_u24 v37, 18725, v36
  v_lshrrev_b32 v37, 20, v37
  v_mul_u32_u24 v38, 56, v37
  v_sub_u32 v36, v36, v38
  v_lshlrev_b32 v36, 4, v36
  v_mad_u32_u24 v41, v37, s22, v36
  v_mul_u32_u24 v37, 1792, v37
  v_add_u32 v49, v37, v36
  v_add_u32 v36, 512, v0
  v_mul_u32_u24 v37, 18725, v36
  v_lshrrev_b32 v37, 20, v37
  v_mul_u32_u24 v38, 56, v37
  v_sub_u32 v36, v36, v38
  v_lshlrev_b32 v36, 4, v36
  v_mad_u32_u24 v42, v37, s22, v36
  v_mul_u32_u24 v37, 1792, v37
  v_add_u32 v50, v37, v36
  v_add_u32 v36, 768, v0
  v_mul_u32_u24 v37, 18725, v36
  v_lshrrev_b32 v37, 20, v37
  v_mul_u32_u24 v38, 56, v37
  v_sub_u32 v36, v36, v38
  v_lshlrev_b32 v36, 4, v36
  v_mad_u32_u24 v43, v37, s22, v36
  v_mul_u32_u24 v37, 1792, v37
  v_add_u32 v51, v37, v36
  v_add_u32 v36, 1024, v0
  v_mul_u32_u24 v37, 18725, v36
  v_lshrrev_b32 v37, 20, v37
  v_mul_u32_u24 v38, 56, v37
  v_sub_u32 v36, v36, v38
  v_lshlrev_b32 v36, 4, v36
  v_mad_u32_u24 v44, v37, s22, v36
  v_mul_u32_u24 v37, 1792, v37
  v_add_u32 v52, v37, v36
  v_add_u32 v36, 1280, v0
  v_mul_u32_u24 v37, 18725, v36
  v_lshrrev_b32 v37, 20, v37
  v_mul_u32_u24 v38, 56, v37
  v_sub_u32 v36, v36, v38
  v_lshlrev_b32 v36, 4, v36
  v_mad_u32_u24 v45, v37, s22, v36
  v_mul_u32_u24 v37, 1792, v37
  v_add_u32 v53, v37, v36
  v_add_u32 v36, 1536, v0
  v_mul_u32_u24 v37, 18725, v36
  v_lshrrev_b32 v37, 20, v37
  v_mul_u32_u24 v38, 56, v37
  v_sub_u32 v36, v36, v38
  v_lshlrev_b32 v36, 4, v36
  v_mad_u32_u24 v46, v37, s22, v36
  v_mul_u32_u24 v37, 1792, v37
  v_add_u32 v54, v37, v36
  s_waitcnt vmcnt(6)
  ds_write_b64 v6, v[8:9] offset:0
  ds_write_b64 v6, v[10:11] offset:912
  s_waitcnt vmcnt(5)
  ds_write_b64 v6, v[12:13] offset:32
  ds_write_b64 v6, v[14:15] offset:944
  s_waitcnt vmcnt(4)
  ds_write_b64 v6, v[16:17] offset:64
  ds_write_b64 v6, v[18:19] offset:976
  s_waitcnt vmcnt(3)
  ds_write_b64 v6, v[20:21] offset:96
  ds_write_b64 v6, v[22:23] offset:1008
  s_waitcnt vmcnt(2)
  ds_write_b64 v6, v[24:25] offset:128
  ds_write_b64 v6, v[26:27] offset:1040
  s_waitcnt vmcnt(1)
  ds_write_b64 v6, v[28:29] offset:160
  ds_write_b64 v6, v[30:31] offset:1072
  s_waitcnt vmcnt(0)
  ds_write_b64 v6, v[32:33] offset:192
  ds_write_b64 v6, v[34:35] offset:1104
  s_waitcnt lgkmcnt(0)
  s_barrier
  s_mul_i32 s20, s18, 57344
  ds_read_b128 v[8:11], v40
  ds_read_b128 v[12:15], v41
  ds_read_b128 v[16:19], v42
  ds_read_b128 v[20:23], v43
  ds_read_b128 v[24:27], v44
  ds_read_b128 v[28:31], v45
  ds_read_b128 v[32:35], v46
  s_waitcnt lgkmcnt(6)
  buffer_store_dwordx4 v[8:11], v48, s[92:95], s20 offen
  s_waitcnt lgkmcnt(5)
  buffer_store_dwordx4 v[12:15], v49, s[92:95], s20 offen
  s_waitcnt lgkmcnt(4)
  buffer_store_dwordx4 v[16:19], v50, s[92:95], s20 offen
  s_waitcnt lgkmcnt(3)
  buffer_store_dwordx4 v[20:23], v51, s[92:95], s20 offen
  s_waitcnt lgkmcnt(2)
  buffer_store_dwordx4 v[24:27], v52, s[92:95], s20 offen
  s_waitcnt lgkmcnt(1)
  buffer_store_dwordx4 v[28:31], v53, s[92:95], s20 offen
  s_waitcnt lgkmcnt(0)
  buffer_store_dwordx4 v[32:35], v54, s[92:95], s20 offen
  s_branch wk_loop
wk_tk:
  s_and_b32 s18, s3, 3
  s_lshr_b32 s17, s3, 2
  s_cmp_lt_u32 s17, 8
  s_cbranch_scc1 wk_tokp
  s_sub_u32 s17, s17, 64
  s_cmp_ge_i32 s17, 56
  s_cbranch_scc1 wk_toko
  s_add_u32 s20, s17, 56
  s_lshr_b32 s17, s20, 1
  s_bitcmp0_b32 s20, 0
  s_cbranch_scc1 wk_toko
  s_add_u32 s17, s17, 8
wk_tokp:
  s_lshl_b32 s20, s18, 2
  s_add_u32 s20, s20, s16
  s_lshl_b32 s21, s17, 4
  s_add_u32 s21, s21, s20
  s_mul_i32 s21, s21, 28672
  s_add_u32 s21, s21, 12845056
  s_mul_i32 s23, s17, 28672
  s_add_u32 s23, s23, 73400320
  s_mul_i32 s24, s17, 7168
  s_add_u32 s24, s24, 88080384
  s_lshr_b32 s25, s17, 3
  s_lshl_b32 s25, s25, 4
  s_add_u32 s25, s25, s20
  s_lshl_b32 s25, s25, 7
  s_add_u32 s25, s25, 88557568
  v_mov_b32 v60, 0
  s_mov_b32 s30, 0
wp_wf:
  buffer_load_dword v61, v60, s[8:11], s25 offen sc1
  s_waitcnt vmcnt(0)
  v_cmp_ne_u32 vcc, 56, v61
  s_cbranch_vccz wp_wf_ok
  s_sleep 1
  s_cmp_ge_u32 s17, 61
  s_cbranch_scc1 wp_wf_bo
  s_sleep 4
  s_cmp_ge_u32 s17, 56
  s_cbranch_scc1 wp_wf_bo
  s_sleep 40
wp_wf_bo:
  s_add_u32 s30, s30, 1
  s_cmp_lt_u32 s30, 30000
  s_cbranch_scc1 wp_wf
  s_branch wp_abort
wp_wf_ok:
  s_add_u32 s22, s21, 0
  buffer_load_dwordx4 a[0:3], v2, s[8:11], s22 offen offset:0 sc1
  buffer_load_dwordx4 a[4:7], v2, s[8:11], s22 offen offset:1024 sc1
  buffer_load_dwordx4 a[8:11], v2, s[8:11], s22 offen offset:2048 sc1
  buffer_load_dwordx4 a[12:15], v2, s[8:11], s22 offen offset:3072 sc1
  s_add_u32 s22, s21, 4096
  buffer_load_dwordx4 a[16:19], v2, s[8:11], s22 offen offset:0 sc1
  buffer_load_dwordx4 a[20:23], v2, s[8:11], s22 offen offset:1024 sc1
  buffer_load_dwordx4 a[24:27], v2, s[8:11], s22 offen offset:2048 sc1
  buffer_load_dwordx4 a[28:31], v2, s[8:11], s22 offen offset:3072 sc1
  s_add_u32 s22, s21, 8192
  buffer_load_dwordx4 a[32:35], v2, s[8:11], s22 offen offset:0 sc1
  buffer_load_dwordx4 a[36:39], v2, s[8:11], s22 offen offset:1024 sc1
  buffer_load_dwordx4 a[40:43], v2, s[8:11], s22 offen offset:2048 sc1
  buffer_load_dwordx4 a[44:47], v2, s[8:11], s22 offen offset:3072 sc1
  s_add_u32 s22, s21, 12288
  buffer_load_dwordx4 a[48:51], v2, s[8:11], s22 offen offset:0 sc1
  buffer_load_dwordx4 a[52:55], v2, s[8:11], s22 offen offset:1024 sc1
  buffer_load_dwordx4 a[56:59], v2, s[8:11], s22 offen offset:2048 sc1
  buffer_load_dwordx4 a[60:63], v2, s[8:11], s22 offen offset:3072 sc1
  s_add_u32 s22, s21, 16384
  buffer_load_dwordx4 a[64:67], v2, s[8:11], s22 offen offset:0 sc1
  buffer_load_dwordx4 a[68:71], v2, s[8:11], s22 offen offset:1024 sc1
  buffer_load_dwordx4 a[72:75], v2, s[8:11], s22 offen offset:2048 sc1
  buffer_load_dwordx4 a[76:79], v2, s[8:11], s22 offen offset:3072 sc1
  s_add_u32 s22, s21, 20480
  buffer_load_dwordx4 a[80:83], v2, s[8:11], s22 offen offset:0 sc1
  buffer_load_dwordx4 a[84:87], v2, s[8:11], s22 offen offset:1024 sc1
  buffer_load_dwordx4 a[88:91], v2, s[8:11], s22 offen offset:2048 sc1
  buffer_load_dwordx4 a[92:95], v2, s[8:11], s22 offen offset:3072 sc1
  s_add_u32 s22, s21, 24576
  buffer_load_dwordx4 a[96:99], v2, s[8:11], s22 offen offset:0 sc1
  buffer_load_dwordx4 a[100:103], v2, s[8:11], s22 offen offset:1024 sc1
  buffer_load_dwordx4 a[104:107], v2, s[8:11], s22 offen offset:2048 sc1
  buffer_load_dwordx4 a[108:111], v2, s[8:11], s22 offen offset:3072 sc1
  s_add_u32 s22, s23, 0
  buffer_load_dwordx4 a[112:115], v2, s[8:11], s22 offen offset:0 sc1
  buffer_load_dwordx4 a[116:119], v2, s[8:11], s22 offen offset:1024 sc1
  buffer_load_dwordx4 a[120:123], v2, s[8:11], s22 offen offset:2048 sc1
  buffer_load_dwordx4 a[124:127], v2, s[8:11], s22 offen offset:3072 sc1
  s_add_u32 s22, s23, 4096
  buffer_load_dwordx4 a[128:131], v2, s[8:11], s22 offen offset:0 sc1
  buffer_load_dwordx4 a[132:135], v2, s[8:11], s22 offen offset:1024 sc1
  buffer_load_dwordx4 a[136:139], v2, s[8:11], s22 offen offset:2048 sc1
  buffer_load_dwordx4 a[140:143], v2, s[8:11], s22 offen offset:3072 sc1
  s_add_u32 s22, s23, 8192
  buffer_load_dwordx4 a[144:147], v2, s[8:11], s22 offen offset:0 sc1
  buffer_load_dwordx4 a[148:151], v2, s[8:11], s22 offen offset:1024 sc1
  buffer_load_dwordx4 a[152:155], v2, s[8:11], s22 offen offset:2048 sc1
  buffer_load_dwordx4 a[156:159], v2, s[8:11], s22 offen offset:3072 sc1
  s_add_u32 s22, s23, 12288
  buffer_load_dwordx4 a[160:163], v2, s[8:11], s22 offen offset:0 sc1
  buffer_load_dwordx4 a[164:167], v2, s[8:11], s22 offen offset:1024 sc1
  buffer_load_dwordx4 a[168:171], v2, s[8:11], s22 offen offset:2048 sc1
  buffer_load_dwordx4 a[172:175], v2, s[8:11], s22 offen offset:3072 sc1
  s_add_u32 s22, s23, 16384
  buffer_load_dwordx4 a[176:179], v2, s[8:11], s22 offen offset:0 sc1
  buffer_load_dwordx4 a[180:183], v2, s[8:11], s22 offen offset:1024 sc1
  buffer_load_dwordx4 a[184:187], v2, s[8:11], s22 offen offset:2048 sc1
  buffer_load_dwordx4 a[188:191], v2, s[8:11], s22 offen offset:3072 sc1
  s_add_u32 s22, s23, 20480
  buffer_load_dwordx4 a[192:195], v2, s[8:11], s22 offen offset:0 sc1
  buffer_load_dwordx4 a[196:199], v2, s[8:11], s22 offen offset:1024 sc1
  buffer_load_dwordx4 a[200:203], v2, s[8:11], s22 offen offset:2048 sc1
  buffer_load_dwordx4 a[204:207], v2, s[8:11], s22 offen offset:3072 sc1
  s_add_u32 s22, s23, 24576
  buffer_load_dwordx4 a[208:211], v2, s[8:11], s22 offen offset:0 sc1
  buffer_load_dwordx4 a[212:215], v2, s[8:11], s22 offen offset:1024 sc1
  buffer_load_dwordx4 a[216:219], v2, s[8:11], s22 offen offset:2048 sc1
  buffer_load_dwordx4 a[220:223], v2, s[8:11], s22 offen offset:3072 sc1
  v_lshl_add_u32 v5, v3, 2, 0
  v_cmp_le_u32 s[40:41], v5, v4
  v_lshl_add_u32 v5, v3, 2, 1
  v_cmp_le_u32 s[42:43], v5, v4
  v_lshl_add_u32 v5, v3, 2, 2
  v_cmp_le_u32 s[44:45], v5, v4
  v_lshl_add_u32 v5, v3, 2, 3
  v_cmp_le_u32 s[46:47], v5, v4
  v_cmp_gt_u32 s[48:49], 2, v3
  v_mov_b32 v6, 0xff800000
  s_waitcnt vmcnt(0)
  v_mfma_f32_16x16x32_bf16 v[8:11], a[112:115], a[0:3], 0
  v_mfma_f32_16x16x32_bf16 v[12:15], a[112:115], a[56:59], 0
  v_mfma_f32_16x16x32_bf16 v[16:19], a[168:171], a[56:59], 0
  v_mfma_f32_16x16x32_bf16 v[8:11], a[116:119], a[4:7], v[8:11]
  v_mfma_f32_16x16x32_bf16 v[12:15], a[116:119], a[60:63], v[12:15]
  v_mfma_f32_16x16x32_bf16 v[16:19], a[172:175], a[60:63], v[16:19]
  v_mfma_f32_16x16x32_bf16 v[8:11], a[120:123], a[8:11], v[8:11]
  v_mfma_f32_16x16x32_bf16 v[12:15], a[120:123], a[64:67], v[12:15]
  v_mfma_f32_16x16x32_bf16 v[16:19], a[176:179], a[64:67], v[16:19]
  v_mfma_f32_16x16x32_bf16 v[8:11], a[124:127], a[12:15], v[8:11]
  v_mfma_f32_16x16x32_bf16 v[12:15], a[124:127], a[68:71], v[12:15]
  v_mfma_f32_16x16x32_bf16 v[16:19], a[180:183], a[68:71], v[16:19]
  v_mfma_f32_16x16x32_bf16 v[8:11], a[128:131], a[16:19], v[8:11]
  v_mfma_f32_16x16x32_bf16 v[12:15], a[128:131], a[72:75], v[12:15]
  v_mfma_f32_16x16x32_bf16 v[16:19], a[184:187], a[72:75], v[16:19]
  v_mfma_f32_16x16x32_bf16 v[8:11], a[132:135], a[20:23], v[8:11]
  v_mfma_f32_16x16x32_bf16 v[12:15], a[132:135], a[76:79], v[12:15]
  v_mfma_f32_16x16x32_bf16 v[16:19], a[188:191], a[76:79], v[16:19]
  v_mfma_f32_16x16x32_bf16 v[8:11], a[136:139], a[24:27], v[8:11]
  v_mfma_f32_16x16x32_bf16 v[12:15], a[136:139], a[80:83], v[12:15]
  v_mfma_f32_16x16x32_bf16 v[16:19], a[192:195], a[80:83], v[16:19]
  v_mfma_f32_16x16x32_bf16 v[8:11], a[140:143], a[28:31], v[8:11]
  v_mfma_f32_16x16x32_bf16 v[12:15], a[140:143], a[84:87], v[12:15]
  v_mfma_f32_16x16x32_bf16 v[16:19], a[196:199], a[84:87], v[16:19]
  v_mfma_f32_16x16x32_bf16 v[8:11], a[144:147], a[32:35], v[8:11]
  v_mfma_f32_16x16x32_bf16 v[12:15], a[144:147], a[88:91], v[12:15]
  v_mfma_f32_16x16x32_bf16 v[16:19], a[200:203], a[88:91], v[16:19]
  v_mfma_f32_16x16x32_bf16 v[8:11], a[148:151], a[36:39], v[8:11]
  v_mfma_f32_16x16x32_bf16 v[12:15], a[148:151], a[92:95], v[12:15]
  v_mfma_f32_16x16x32_bf16 v[16:19], a[204:207], a[92:95], v[16:19]
  v_mfma_f32_16x16x32_bf16 v[8:11], a[152:155], a[40:43], v[8:11]
  v_mfma_f32_16x16x32_bf16 v[12:15], a[152:155], a[96:99], v[12:15]
  v_mfma_f32_16x16x32_bf16 v[16:19], a[208:211], a[96:99], v[16:19]
  v_mfma_f32_16x16x32_bf16 v[8:11], a[156:159], a[44:47], v[8:11]
  v_mfma_f32_16x16x32_bf16 v[12:15], a[156:159], a[100:103], v[12:15]
  v_mfma_f32_16x16x32_bf16 v[16:19], a[212:215], a[100:103], v[16:19]
  v_mfma_f32_16x16x32_bf16 v[8:11], a[160:163], a[48:51], v[8:11]
  v_mfma_f32_16x16x32_bf16 v[12:15], a[160:163], a[104:107], v[12:15]
  v_mfma_f32_16x16x32_bf16 v[16:19], a[216:219], a[104:107], v[16:19]
  v_mfma_f32_16x16x32_bf16 v[8:11], a[164:167], a[52:55], v[8:11]
  v_mfma_f32_16x16x32_bf16 v[12:15], a[164:167], a[108:111], v[12:15]
  v_mfma_f32_16x16x32_bf16 v[16:19], a[220:223], a[108:111], v[16:19]
  s_mul_i32 s22, s20, 448
  v_mov_b32 v62, s22
  s_mov_b32 s30, 0
wp_pm:
  s_cmp_ge_u32 s17, 64
  s_cbranch_scc1 wp_pf
  s_cmp_ge_u32 s17, 61
  s_cbranch_scc1 mp_45a
  v_mov_b32 v61, 0
  s_mov_b64 exec, 1
  buffer_atomic_or v61, v62, s[8:11], s24 offen sc0
  s_mov_b64 exec, -1
  s_branch mp_45b
mp_45a:
  buffer_load_dword v61, v62, s[8:11], s24 offen sc1
mp_45b:
  s_waitcnt vmcnt(0)
  v_cmp_eq_u32 vcc, -1, v61
  s_cbranch_vccnz wp_pr
wp_pf:
  s_add_u32 s22, s24, 4096
  buffer_load_dwordx4 v[64:67], v2, s[8:11], s24 offen offset:0 sc1
  buffer_load_dwordx4 v[68:71], v2, s[8:11], s24 offen offset:1024 sc1
  buffer_load_dwordx4 v[72:75], v2, s[8:11], s24 offen offset:2048 sc1
  buffer_load_dwordx4 v[76:79], v2, s[8:11], s24 offen offset:3072 sc1
  buffer_load_dwordx4 v[80:83], v2, s[8:11], s22 offen offset:0 sc1
  buffer_load_dwordx4 v[84:87], v2, s[8:11], s22 offen offset:1024 sc1
  buffer_load_dwordx4 v[88:91], v2, s[8:11], s22 offen offset:2048 sc1
  s_waitcnt vmcnt(0)
  v_max_u32 v61, v64, v65
  v_max3_u32 v61, v61, v66, v67
  v_max3_u32 v61, v61, v68, v69
  v_max3_u32 v61, v61, v70, v71
  v_max3_u32 v61, v61, v72, v73
  v_max3_u32 v61, v61, v74, v75
  v_max3_u32 v61, v61, v76, v77
  v_max3_u32 v61, v61, v78, v79
  v_max3_u32 v61, v61, v80, v81
  v_max3_u32 v61, v61, v82, v83
  v_max3_u32 v61, v61, v84, v85
  v_max3_u32 v61, v61, v86, v87
  v_max3_u32 v61, v61, v88, v89
  v_max3_u32 v61, v61, v90, v91
  v_cmp_eq_u32 vcc, -1, v61
  s_cbranch_vccz wp_pk
wp_pr:
  s_sleep 1
  s_cmp_ge_u32 s17, 61
  s_cbranch_scc1 wp_pm_bo
  s_sleep 4
  s_cmp_ge_u32 s17, 56
  s_cbranch_scc1 wp_pm_bo
  s_sleep 40
wp_pm_bo:
  s_add_u32 s30, s30, 1
  s_cmp_lt_u32 s30, 30000
  s_cbranch_scc1 wp_pm
  s_branch wp_abort
wp_pk:
  s_cmp_lt_u32 s17, 56
  s_cbranch_scc1 pk_46
  buffer_load_dword v250, v251, s[12:15], 0 offen sc1
pk_46:
  v_mfma_f32_16x16x32_bf16 v[20:23], v[64:67], a[0:3], 0
  v_mfma_f32_16x16x32_bf16 v[24:27], v[64:67], a[4:7], 0
  v_mfma_f32_16x16x32_bf16 v[28:31], v[64:67], a[56:59], 0
  v_mfma_f32_16x16x32_bf16 v[32:35], v[64:67], a[60:63], 0
  v_mfma_f32_16x16x32_bf16 v[20:23], v[68:71], a[8:11], v[20:23]
  v_mfma_f32_16x16x32_bf16 v[24:27], v[68:71], a[12:15], v[24:27]
  v_mfma_f32_16x16x32_bf16 v[28:31], v[68:71], a[64:67], v[28:31]
  v_mfma_f32_16x16x32_bf16 v[32:35], v[68:71], a[68:71], v[32:35]
  v_mfma_f32_16x16x32_bf16 v[20:23], v[72:75], a[16:19], v[20:23]
  v_mfma_f32_16x16x32_bf16 v[24:27], v[72:75], a[20:23], v[24:27]
  v_mfma_f32_16x16x32_bf16 v[28:31], v[72:75], a[72:75], v[28:31]
  v_mfma_f32_16x16x32_bf16 v[32:35], v[72:75], a[76:79], v[32:35]
  v_mfma_f32_16x16x32_bf16 v[20:23], v[76:79], a[24:27], v[20:23]
  v_mfma_f32_16x16x32_bf16 v[24:27], v[76:79], a[28:31], v[24:27]
  v_mfma_f32_16x16x32_bf16 v[28:31], v[76:79], a[80:83], v[28:31]
  v_mfma_f32_16x16x32_bf16 v[32:35], v[76:79], a[84:87], v[32:35]
  v_mfma_f32_16x16x32_bf16 v[20:23], v[80:83], a[32:35], v[20:23]
  v_mfma_f32_16x16x32_bf16 v[24:27], v[80:83], a[36:39], v[24:27]
  v_mfma_f32_16x16x32_bf16 v[28:31], v[80:83], a[88:91], v[28:31]
  v_mfma_f32_16x16x32_bf16 v[32:35], v[80:83], a[92:95], v[32:35]
  v_mfma_f32_16x16x32_bf16 v[20:23], v[84:87], a[40:43], v[20:23]
  v_mfma_f32_16x16x32_bf16 v[24:27], v[84:87], a[44:47], v[24:27]
  v_mfma_f32_16x16x32_bf16 v[28:31], v[84:87], a[96:99], v[28:31]
  v_mfma_f32_16x16x32_bf16 v[32:35], v[84:87], a[100:103], v[32:35]
  v_mfma_f32_16x16x32_bf16 v[20:23], v[88:91], a[48:51], v[20:23]
  v_mfma_f32_16x16x32_bf16 v[24:27], v[88:91], a[52:55], v[24:27]
  v_mfma_f32_16x16x32_bf16 v[28:31], v[88:91], a[104:107], v[28:31]
  v_mfma_f32_16x16x32_bf16 v[32:35], v[88:91], a[108:111], v[32:35]
  s_lshl_b32 s25, s17, 1
  s_mul_i32 s25, s25, 20480
  s_add_u32 s25, s25, 85458944
  s_lshl_b32 s26, s20, 10
  s_add_u32 s26, s26, s25
  s_lshl_b32 s27, s18, 10
  s_add_u32 s27, s27, s25
  s_lshr_b32 s28, s16, 1
  s_lshl_b32 s28, s28, 3
  s_add_u32 s27, s27, s28
  s_add_u32 s27, s27, 16384
  s_and_b32 s28, s16, 1
  s_cmp_eq_u32 s28, 0
  s_cselect_b32 s50, -1, 0
  s_cselect_b32 s51, 0, -1
  v_cndmask_b32 v8, v6, v8, s[40:41]
  v_cndmask_b32 v9, v6, v9, s[42:43]
  v_cndmask_b32 v10, v6, v10, s[44:45]
  v_cndmask_b32 v11, v6, v11, s[46:47]
  v_cndmask_b32 v20, v24, v20, s[48:49]
  v_cndmask_b32 v21, v25, v21, s[48:49]
  v_cndmask_b32 v22, v26, v22, s[48:49]
  v_cndmask_b32 v23, v27, v23, s[48:49]
  v_mov_b32 v24, v20
  v_mov_b32 v25, v21
  v_mov_b32 v26, v22
  v_mov_b32 v27, v23
  v_permlane32_swap_b32 v20, v24
  v_permlane32_swap_b32 v21, v25
  v_permlane32_swap_b32 v22, v26
  v_permlane32_swap_b32 v23, v27
  v_add_f32 v20, v20, v24
  v_add_f32 v21, v21, v25
  v_add_f32 v22, v22, v26
  v_add_f32 v23, v23, v27
  v_max3_f32 v40, v8, v9, v10
  v_max3_f32 v40, v40, v11, v20
  v_max3_f32 v40, v40, v21, v22
  v_max_f32 v40, v40, v23
  v_mov_b32 v41, v40
  s_nop 1
  v_permlane16_swap_b32 v40, v41
  v_max_f32 v40, v40, v41
  v_mov_b32 v41, v40
  s_nop 1
  v_permlane32_swap_b32 v40, v41
  v_max_f32 v40, v40, v41
  v_sub_f32 v8, v8, v40
  v_sub_f32 v9, v9, v40
  v_sub_f32 v10, v10, v40
  v_sub_f32 v11, v11, v40
  v_sub_f32 v20, v20, v40
  v_sub_f32 v21, v21, v40
  v_sub_f32 v22, v22, v40
  v_sub_f32 v23, v23, v40
  v_exp_f32 v8, v8
  v_exp_f32 v9, v9
  v_exp_f32 v10, v10
  v_exp_f32 v11, v11
  v_exp_f32 v20, v20
  v_exp_f32 v21, v21
  v_exp_f32 v22, v22
  v_exp_f32 v23, v23
  v_add_f32 v42, v20, v21
  v_add_f32 v43, v22, v23
  v_add_f32 v42, v42, v43
  v_mul_f32 v42, 0.5, v42
  v_add_f32 v42, v42, v8
  v_add_f32 v42, v42, v9
  v_add_f32 v42, v42, v10
  v_add_f32 v42, v42, v11
  v_mov_b32 v41, v42
  s_nop 1
  v_permlane16_swap_b32 v42, v41
  v_add_f32 v42, v42, v41
  v_mov_b32 v41, v42
  s_nop 1
  v_permlane32_swap_b32 v42, v41
  v_add_f32 v42, v42, v41
  v_rcp_f32 v42, v42
  s_nop 0
  v_mul_f32 v8, v8, v42
  v_mul_f32 v9, v9, v42
  v_mul_f32 v10, v10, v42
  v_mul_f32 v11, v11, v42
  v_mul_f32 v20, v20, v42
  v_mul_f32 v21, v21, v42
  v_mul_f32 v22, v22, v42
  v_mul_f32 v23, v23, v42
  v_cvt_pk_bf16_f32 v44, v8, v9
  v_cvt_pk_bf16_f32 v45, v10, v11
  v_mov_b32 v46, 0
  v_mov_b32 v47, 0
  v_cvt_pk_bf16_f32 v48, v20, v21
  v_cvt_pk_bf16_f32 v49, v22, v23
  v_min_u32 v44, -2, v44
  v_min_u32 v45, -2, v45
  v_min_u32 v46, -2, v46
  v_min_u32 v47, -2, v47
  v_min_u32 v48, -2, v48
  v_min_u32 v49, -2, v49
  buffer_store_dwordx4 v[44:47], v2, s[8:11], s26 offen sc1
  s_mov_b64 exec, s[50:51]
  buffer_store_dwordx2 v[48:49], v2, s[8:11], s27 offen sc1
  s_mov_b64 exec, -1
  s_add_u32 s26, s26, 20480
  s_add_u32 s27, s27, 20480
  v_cndmask_b32 v16, v6, v16, s[40:41]
  v_cndmask_b32 v17, v6, v17, s[42:43]
  v_cndmask_b32 v18, v6, v18, s[44:45]
  v_cndmask_b32 v19, v6, v19, s[46:47]
  v_cndmask_b32 v28, v32, v28, s[48:49]
  v_cndmask_b32 v29, v33, v29, s[48:49]
  v_cndmask_b32 v30, v34, v30, s[48:49]
  v_cndmask_b32 v31, v35, v31, s[48:49]
  v_mov_b32 v32, v28
  v_mov_b32 v33, v29
  v_mov_b32 v34, v30
  v_mov_b32 v35, v31
  v_permlane32_swap_b32 v28, v32
  v_permlane32_swap_b32 v29, v33
  v_permlane32_swap_b32 v30, v34
  v_permlane32_swap_b32 v31, v35
  v_add_f32 v28, v28, v32
  v_add_f32 v29, v29, v33
  v_add_f32 v30, v30, v34
  v_add_f32 v31, v31, v35
  v_max3_f32 v40, v12, v13, v14
  v_max3_f32 v40, v40, v15, v16
  v_max3_f32 v40, v40, v17, v18
  v_max3_f32 v40, v40, v19, v28
  v_max3_f32 v40, v40, v29, v30
  v_max_f32 v40, v40, v31
  v_mov_b32 v41, v40
  s_nop 1
  v_permlane16_swap_b32 v40, v41
  v_max_f32 v40, v40, v41
  v_mov_b32 v41, v40
  s_nop 1
  v_permlane32_swap_b32 v40, v41
  v_max_f32 v40, v40, v41
  v_sub_f32 v12, v12, v40
  v_sub_f32 v13, v13, v40
  v_sub_f32 v14, v14, v40
  v_sub_f32 v15, v15, v40
  v_sub_f32 v16, v16, v40
  v_sub_f32 v17, v17, v40
  v_sub_f32 v18, v18, v40
  v_sub_f32 v19, v19, v40
  v_sub_f32 v28, v28, v40
  v_sub_f32 v29, v29, v40
  v_sub_f32 v30, v30, v40
  v_sub_f32 v31, v31, v40
  v_exp_f32 v12, v12
  v_exp_f32 v13, v13
  v_exp_f32 v14, v14
  v_exp_f32 v15, v15
  v_exp_f32 v16, v16
  v_exp_f32 v17, v17
  v_exp_f32 v18, v18
  v_exp_f32 v19, v19
  v_exp_f32 v28, v28
  v_exp_f32 v29, v29
  v_exp_f32 v30, v30
  v_exp_f32 v31, v31
  v_add_f32 v42, v28, v29
  v_add_f32 v43, v30, v31
  v_add_f32 v42, v42, v43
  v_mul_f32 v42, 0.5, v42
  v_add_f32 v42, v42, v12
  v_add_f32 v42, v42, v13
  v_add_f32 v42, v42, v14
  v_add_f32 v42, v42, v15
  v_add_f32 v42, v42, v16
  v_add_f32 v42, v42, v17
  v_add_f32 v42, v42, v18
  v_add_f32 v42, v42, v19
  v_mov_b32 v41, v42
  s_nop 1
  v_permlane16_swap_b32 v42, v41
  v_add_f32 v42, v42, v41
  v_mov_b32 v41, v42
  s_nop 1
  v_permlane32_swap_b32 v42, v41
  v_add_f32 v42, v42, v41
  v_rcp_f32 v42, v42
  s_nop 0
  v_mul_f32 v12, v12, v42
  v_mul_f32 v13, v13, v42
  v_mul_f32 v14, v14, v42
  v_mul_f32 v15, v15, v42
  v_mul_f32 v16, v16, v42
  v_mul_f32 v17, v17, v42
  v_mul_f32 v18, v18, v42
  v_mul_f32 v19, v19, v42
  v_mul_f32 v28, v28, v42
  v_mul_f32 v29, v29, v42
  v_mul_f32 v30, v30, v42
  v_mul_f32 v31, v31, v42
  v_cvt_pk_bf16_f32 v52, v12, v13
  v_cvt_pk_bf16_f32 v53, v14, v15
  v_cvt_pk_bf16_f32 v54, v16, v17
  v_cvt_pk_bf16_f32 v55, v18, v19
  v_cvt_pk_bf16_f32 v56, v28, v29
  v_cvt_pk_bf16_f32 v57, v30, v31
  v_min_u32 v52, -2, v52
  v_min_u32 v53, -2, v53
  v_min_u32 v54, -2, v54
  v_min_u32 v55, -2, v55
  v_min_u32 v56, -2, v56
  v_min_u32 v57, -2, v57
  buffer_store_dwordx4 v[52:55], v2, s[8:11], s26 offen sc1
  s_mov_b64 exec, s[50:51]
  buffer_store_dwordx2 v[56:57], v2, s[8:11], s27 offen sc1
  s_mov_b64 exec, -1
  s_lshl_b32 s25, s17, 7
  s_add_u32 s25, s25, 88573952
  v_mov_b32 v5, 1
  v_mov_b32 v6, 0
  s_waitcnt vmcnt(0)
  s_mov_b64 exec, 1
  buffer_atomic_add v5, v6, s[8:11], s25 offen
  s_mov_b64 exec, -1
  s_branch wk_loop
wk_toko:
  s_lshl_b32 s20, s18, 2
  s_add_u32 s20, s20, s16
  s_mul_i32 s24, s20, 65
  s_add_u32 s24, s24, s17
  s_lshl_b32 s24, s24, 13
  s_add_u32 s24, s24, 76947456
  s_lshl_b32 s21, s20, 6
  s_add_u32 s21, s21, s17
  s_mul_i32 s21, s21, 28672
  s_add_u32 s21, s21, 42205184
  s_lshl_b32 s25, s17, 1
  s_mul_i32 s25, s25, 20480
  s_add_u32 s25, s25, 85458944
  v_lshrrev_b32 v8, 5, v1
  v_and_b32 v9, 31, v1
  v_min_u32 v5, 27, v9
  v_mad_u32_u24 v5, v8, 28, v5
  v_lshlrev_b32 v5, 4, v5
  v_lshrrev_b32 v10, 4, v9
  v_lshlrev_b32 v7, 10, v10
  v_lshl_add_u32 v7, v4, 4, v7
  v_lshl_add_u32 v7, v8, 3, v7
  v_mul_u32_u24 v6, 20480, v10
  v_lshl_add_u32 v6, v8, 8, v6
  v_lshl_add_u32 v6, v4, 4, v6
  s_lshr_b32 s26, s17, 3
  s_lshl_b32 s26, s26, 4
  s_add_u32 s26, s26, s20
  s_lshl_b32 s26, s26, 7
  s_add_u32 s26, s26, 88541184
  v_mov_b32 v60, 0
  s_mov_b32 s30, 0
wo_wv:
  buffer_load_dword v61, v60, s[8:11], s26 offen sc1
  s_waitcnt vmcnt(0)
  v_cmp_ne_u32 vcc, 56, v61
  s_cbranch_vccz wo_wv_ok
  s_sleep 1
  s_cmp_ge_u32 s17, 61
  s_cbranch_scc1 wo_wv_bo
  s_sleep 4
  s_cmp_ge_u32 s17, 56
  s_cbranch_scc1 wo_wv_bo
  s_sleep 40
wo_wv_bo:
  s_add_u32 s30, s30, 1
  s_cmp_lt_u32 s30, 30000
  s_cbranch_scc1 wo_wv
  s_branch wo_abort
wo_wv_ok:
  s_add_u32 s22, s21, 0
  buffer_load_dwordx4 a[0:3], v5, s[8:11], s22 offen offset:0 sc1
  buffer_load_dwordx4 a[4:7], v5, s[8:11], s22 offen offset:896 sc1
  buffer_load_dwordx4 a[8:11], v5, s[8:11], s22 offen offset:1792 sc1
  buffer_load_dwordx4 a[12:15], v5, s[8:11], s22 offen offset:2688 sc1
  s_add_u32 s22, s21, 3584
  buffer_load_dwordx4 a[16:19], v5, s[8:11], s22 offen offset:0 sc1
  buffer_load_dwordx4 a[20:23], v5, s[8:11], s22 offen offset:896 sc1
  buffer_load_dwordx4 a[24:27], v5, s[8:11], s22 offen offset:1792 sc1
  buffer_load_dwordx4 a[28:31], v5, s[8:11], s22 offen offset:2688 sc1
  s_add_u32 s22, s21, 7168
  buffer_load_dwordx4 a[32:35], v5, s[8:11], s22 offen offset:0 sc1
  buffer_load_dwordx4 a[36:39], v5, s[8:11], s22 offen offset:896 sc1
  buffer_load_dwordx4 a[40:43], v5, s[8:11], s22 offen offset:1792 sc1
  buffer_load_dwordx4 a[44:47], v5, s[8:11], s22 offen offset:2688 sc1
  s_add_u32 s22, s21, 10752
  buffer_load_dwordx4 a[48:51], v5, s[8:11], s22 offen offset:0 sc1
  buffer_load_dwordx4 a[52:55], v5, s[8:11], s22 offen offset:896 sc1
  buffer_load_dwordx4 a[56:59], v5, s[8:11], s22 offen offset:1792 sc1
  buffer_load_dwordx4 a[60:63], v5, s[8:11], s22 offen offset:2688 sc1
  s_add_u32 s22, s21, 14336
  buffer_load_dwordx4 a[64:67], v5, s[8:11], s22 offen offset:0 sc1
  buffer_load_dwordx4 a[68:71], v5, s[8:11], s22 offen offset:896 sc1
  buffer_load_dwordx4 a[72:75], v5, s[8:11], s22 offen offset:1792 sc1
  buffer_load_dwordx4 a[76:79], v5, s[8:11], s22 offen offset:2688 sc1
  s_add_u32 s22, s21, 17920
  buffer_load_dwordx4 a[80:83], v5, s[8:11], s22 offen offset:0 sc1
  buffer_load_dwordx4 a[84:87], v5, s[8:11], s22 offen offset:896 sc1
  buffer_load_dwordx4 a[88:91], v5, s[8:11], s22 offen offset:1792 sc1
  buffer_load_dwordx4 a[92:95], v5, s[8:11], s22 offen offset:2688 sc1
  s_add_u32 s22, s21, 21504
  buffer_load_dwordx4 a[96:99], v5, s[8:11], s22 offen offset:0 sc1
  buffer_load_dwordx4 a[100:103], v5, s[8:11], s22 offen offset:896 sc1
  buffer_load_dwordx4 a[104:107], v5, s[8:11], s22 offen offset:1792 sc1
  buffer_load_dwordx4 a[108:111], v5, s[8:11], s22 offen offset:2688 sc1
  s_add_u32 s22, s21, 25088
  buffer_load_dwordx4 a[112:115], v5, s[8:11], s22 offen offset:0 sc1
  buffer_load_dwordx4 a[116:119], v5, s[8:11], s22 offen offset:896 sc1
  buffer_load_dwordx4 a[120:123], v5, s[8:11], s22 offen offset:1792 sc1
  buffer_load_dwordx4 a[124:127], v5, s[8:11], s22 offen offset:2688 sc1
  s_cmp_ge_u32 s17, 61
  s_cbranch_scc1 wo_lm
  s_lshl_b32 s26, s17, 7
  s_add_u32 s26, s26, 88573952
  v_mov_b32 v60, 0
  s_mov_b32 s30, 0
wo_wp:
  buffer_load_dword v61, v60, s[8:11], s26 offen sc1
  s_waitcnt vmcnt(0)
  v_cmp_ne_u32 vcc, 16, v61
  s_cbranch_vccz wo_wp_ok
  s_sleep 2
  s_cmp_ge_u32 s17, 61
  s_cbranch_scc1 wo_wp_bo
  s_sleep 4
  s_cmp_ge_u32 s17, 56
  s_cbranch_scc1 wo_wp_bo
  s_sleep 40
wo_wp_bo:
  s_add_u32 s30, s30, 1
  s_cmp_lt_u32 s30, 30000
  s_cbranch_scc1 wo_wp
  s_branch wo_abort
wo_wp_ok:
  s_branch wo_lp
wo_lm:
  s_mul_i32 s26, s17, 7168
  s_add_u32 s26, s26, 88080384
  v_mov_b32 v60, 0
  s_mov_b32 s30, 0
wo_wm:
  buffer_load_dword v61, v60, s[8:11], s26 offen sc1
  s_waitcnt vmcnt(0)
  v_cmp_eq_u32 vcc, -1, v61
  s_cbranch_vccz wo_wm_ok
  s_sleep 2
  s_cmp_ge_u32 s17, 61
  s_cbranch_scc1 wo_wm_bo
  s_sleep 4
  s_cmp_ge_u32 s17, 56
  s_cbranch_scc1 wo_wm_bo
  s_sleep 40
wo_wm_bo:
  s_add_u32 s30, s30, 1
  s_cmp_lt_u32 s30, 30000
  s_cbranch_scc1 wo_wm
  s_branch wo_abort
wo_wm_ok:
wo_lp:
  s_mul_i32 s26, s16, 10240
  s_add_u32 s27, s25, s26
  v_add_u32 v11, s26, v2
  s_lshl_b32 s26, s20, 6
  s_add_u32 s26, s26, s17
  s_lshl_b32 s26, s26, 4
  s_add_u32 s26, s26, 88582144
  v_lshlrev_b32 v60, 2, v3
  s_mov_b32 s30, 0
wo_pl:
  s_add_u32 s22, s27, 0
  buffer_load_dwordx4 v[128:131], v2, s[8:11], s22 offen offset:0 sc1
  buffer_load_dwordx4 v[132:135], v2, s[8:11], s22 offen offset:1024 sc1
  buffer_load_dwordx4 v[136:139], v2, s[8:11], s22 offen offset:2048 sc1
  buffer_load_dwordx4 v[140:143], v2, s[8:11], s22 offen offset:3072 sc1
  s_add_u32 s22, s27, 4096
  buffer_load_dwordx4 v[144:147], v2, s[8:11], s22 offen offset:0 sc1
  buffer_load_dwordx4 v[148:151], v2, s[8:11], s22 offen offset:1024 sc1
  buffer_load_dwordx4 v[152:155], v2, s[8:11], s22 offen offset:2048 sc1
  buffer_load_dwordx4 v[156:159], v2, s[8:11], s22 offen offset:3072 sc1
  s_add_u32 s22, s27, 8192
  buffer_load_dwordx4 v[160:163], v2, s[8:11], s22 offen offset:0 sc1
  buffer_load_dwordx4 v[164:167], v2, s[8:11], s22 offen offset:1024 sc1
  buffer_load_dword v61, v60, s[8:11], s26 offen sc1
  s_waitcnt vmcnt(1)
  v_max_u32 v62, v128, v129
  v_max3_u32 v62, v62, v130, v131
  v_max3_u32 v62, v62, v132, v133
  v_max3_u32 v62, v62, v134, v135
  v_max3_u32 v62, v62, v136, v137
  v_max3_u32 v62, v62, v138, v139
  v_max3_u32 v62, v62, v140, v141
  v_max3_u32 v62, v62, v142, v143
  v_max3_u32 v62, v62, v144, v145
  v_max3_u32 v62, v62, v146, v147
  v_max3_u32 v62, v62, v148, v149
  v_max3_u32 v62, v62, v150, v151
  v_max3_u32 v62, v62, v152, v153
  v_max3_u32 v62, v62, v154, v155
  v_max3_u32 v62, v62, v156, v157
  v_max3_u32 v62, v62, v158, v159
  v_max3_u32 v62, v62, v160, v161
  v_max3_u32 v62, v62, v162, v163
  v_max3_u32 v62, v62, v164, v165
  v_max3_u32 v62, v62, v166, v167
  v_cmp_eq_u32 vcc, -1, v62
  s_cbranch_vccz wo_pk
  s_add_u32 s30, s30, 1
  s_cmp_lt_u32 s30, 30000
  s_cbranch_scc1 wo_pl
  s_branch wo_abort
wo_pk:
  ds_write_b128 v11, v[128:131] offset:0
  ds_write_b128 v11, v[132:135] offset:1024
  ds_write_b128 v11, v[136:139] offset:2048
  ds_write_b128 v11, v[140:143] offset:3072
  ds_write_b128 v11, v[144:147] offset:4096
  ds_write_b128 v11, v[148:151] offset:5120
  ds_write_b128 v11, v[152:155] offset:6144
  ds_write_b128 v11, v[156:159] offset:7168
  ds_write_b128 v11, v[160:163] offset:8192
  ds_write_b128 v11, v[164:167] offset:9216
  s_waitcnt vmcnt(0)
  v_cmp_ne_u32 vcc, 1, v61
  s_mov_b32 s28, 0
  s_cbranch_vccnz wo_nt
  s_add_u32 s22, s24, 0
  buffer_load_dwordx2 v[28:29], v7, s[8:11], s22 offen offset:0 sc1
  buffer_load_dwordx2 v[30:31], v7, s[8:11], s22 offen offset:512 sc1
  buffer_load_dwordx2 v[32:33], v7, s[8:11], s22 offen offset:256 sc1
  buffer_load_dwordx2 v[34:35], v7, s[8:11], s22 offen offset:768 sc1
  buffer_load_dwordx2 v[36:37], v7, s[8:11], s22 offen offset:2048 sc1
  buffer_load_dwordx2 v[38:39], v7, s[8:11], s22 offen offset:2560 sc1
  buffer_load_dwordx2 v[40:41], v7, s[8:11], s22 offen offset:2304 sc1
  buffer_load_dwordx2 v[42:43], v7, s[8:11], s22 offen offset:2816 sc1
  s_add_u32 s22, s24, 4096
  buffer_load_dwordx2 v[44:45], v7, s[8:11], s22 offen offset:0 sc1
  buffer_load_dwordx2 v[46:47], v7, s[8:11], s22 offen offset:512 sc1
  buffer_load_dwordx2 v[48:49], v7, s[8:11], s22 offen offset:256 sc1
  buffer_load_dwordx2 v[50:51], v7, s[8:11], s22 offen offset:768 sc1
  buffer_load_dwordx2 v[52:53], v7, s[8:11], s22 offen offset:2048 sc1
  buffer_load_dwordx2 v[54:55], v7, s[8:11], s22 offen offset:2560 sc1
  buffer_load_dwordx2 v[56:57], v7, s[8:11], s22 offen offset:2304 sc1
  buffer_load_dwordx2 v[58:59], v7, s[8:11], s22 offen offset:2816 sc1
  s_mov_b32 s28, 1
wo_nt:
  s_cmp_lt_u32 s17, 56
  s_cbranch_scc1 pk_47
  buffer_load_dword v250, v251, s[12:15], 0 offen sc1
pk_47:
  s_waitcnt lgkmcnt(0)
  s_barrier
  buffer_load_dword v61, v60, s[8:11], s26 offen sc1
  ds_read_b128 v[64:67], v6 offset:0
  ds_read_b128 v[68:71], v6 offset:512
  ds_read_b128 v[72:75], v6 offset:1024
  ds_read_b128 v[76:79], v6 offset:1536
  ds_read_b128 v[80:83], v6 offset:2048
  ds_read_b128 v[84:87], v6 offset:2560
  ds_read_b128 v[88:91], v6 offset:3072
  s_waitcnt lgkmcnt(6)
  v_mfma_f32_32x32x16_bf16 v[12:27], a[0:3], v[64:67], 0
  ds_read_b128 v[92:95], v6 offset:3584
  s_waitcnt lgkmcnt(6)
  v_mfma_f32_32x32x16_bf16 v[12:27], a[4:7], v[68:71], v[12:27]
  ds_read_b128 v[64:67], v6 offset:4096
  s_waitcnt lgkmcnt(6)
  v_mfma_f32_32x32x16_bf16 v[12:27], a[8:11], v[72:75], v[12:27]
  ds_read_b128 v[68:71], v6 offset:4608
  s_waitcnt lgkmcnt(6)
  v_mfma_f32_32x32x16_bf16 v[12:27], a[12:15], v[76:79], v[12:27]
  ds_read_b128 v[72:75], v6 offset:5120
  s_waitcnt lgkmcnt(6)
  v_mfma_f32_32x32x16_bf16 v[12:27], a[16:19], v[80:83], v[12:27]
  ds_read_b128 v[76:79], v6 offset:5632
  s_waitcnt lgkmcnt(6)
  v_mfma_f32_32x32x16_bf16 v[12:27], a[20:23], v[84:87], v[12:27]
  ds_read_b128 v[80:83], v6 offset:6144
  s_waitcnt lgkmcnt(6)
  v_mfma_f32_32x32x16_bf16 v[12:27], a[24:27], v[88:91], v[12:27]
  ds_read_b128 v[84:87], v6 offset:6656
  s_waitcnt lgkmcnt(6)
  v_mfma_f32_32x32x16_bf16 v[12:27], a[28:31], v[92:95], v[12:27]
  ds_read_b128 v[88:91], v6 offset:7168
  s_waitcnt lgkmcnt(6)
  v_mfma_f32_32x32x16_bf16 v[12:27], a[32:35], v[64:67], v[12:27]
  ds_read_b128 v[92:95], v6 offset:7680
  s_waitcnt lgkmcnt(6)
  v_mfma_f32_32x32x16_bf16 v[12:27], a[36:39], v[68:71], v[12:27]
  ds_read_b128 v[64:67], v6 offset:8192
  s_waitcnt lgkmcnt(6)
  v_mfma_f32_32x32x16_bf16 v[12:27], a[40:43], v[72:75], v[12:27]
  ds_read_b128 v[68:71], v6 offset:8704
  s_waitcnt lgkmcnt(6)
  v_mfma_f32_32x32x16_bf16 v[12:27], a[44:47], v[76:79], v[12:27]
  ds_read_b128 v[72:75], v6 offset:9216
  s_waitcnt lgkmcnt(6)
  v_mfma_f32_32x32x16_bf16 v[12:27], a[48:51], v[80:83], v[12:27]
  ds_read_b128 v[76:79], v6 offset:9728
  s_waitcnt lgkmcnt(6)
  v_mfma_f32_32x32x16_bf16 v[12:27], a[52:55], v[84:87], v[12:27]
  ds_read_b128 v[80:83], v6 offset:10240
  s_waitcnt lgkmcnt(6)
  v_mfma_f32_32x32x16_bf16 v[12:27], a[56:59], v[88:91], v[12:27]
  ds_read_b128 v[84:87], v6 offset:10752
  s_waitcnt lgkmcnt(6)
  v_mfma_f32_32x32x16_bf16 v[12:27], a[60:63], v[92:95], v[12:27]
  ds_read_b128 v[88:91], v6 offset:11264
  s_waitcnt lgkmcnt(6)
  v_mfma_f32_32x32x16_bf16 v[12:27], a[64:67], v[64:67], v[12:27]
  ds_read_b128 v[92:95], v6 offset:11776
  s_waitcnt lgkmcnt(6)
  v_mfma_f32_32x32x16_bf16 v[12:27], a[68:71], v[68:71], v[12:27]
  ds_read_b128 v[64:67], v6 offset:12288
  s_waitcnt lgkmcnt(6)
  v_mfma_f32_32x32x16_bf16 v[12:27], a[72:75], v[72:75], v[12:27]
  ds_read_b128 v[68:71], v6 offset:12800
  s_waitcnt lgkmcnt(6)
  v_mfma_f32_32x32x16_bf16 v[12:27], a[76:79], v[76:79], v[12:27]
  s_cmp_lg_u32 s28, 0
  s_cbranch_scc1 wo_h2
  s_waitcnt vmcnt(0)
  v_cmp_ne_u32 vcc, 1, v61
  s_cbranch_vccnz wo_h2
  s_add_u32 s22, s24, 0
  buffer_load_dwordx2 v[28:29], v7, s[8:11], s22 offen offset:0 sc1
  buffer_load_dwordx2 v[30:31], v7, s[8:11], s22 offen offset:512 sc1
  buffer_load_dwordx2 v[32:33], v7, s[8:11], s22 offen offset:256 sc1
  buffer_load_dwordx2 v[34:35], v7, s[8:11], s22 offen offset:768 sc1
  buffer_load_dwordx2 v[36:37], v7, s[8:11], s22 offen offset:2048 sc1
  buffer_load_dwordx2 v[38:39], v7, s[8:11], s22 offen offset:2560 sc1
  buffer_load_dwordx2 v[40:41], v7, s[8:11], s22 offen offset:2304 sc1
  buffer_load_dwordx2 v[42:43], v7, s[8:11], s22 offen offset:2816 sc1
  s_add_u32 s22, s24, 4096
  buffer_load_dwordx2 v[44:45], v7, s[8:11], s22 offen offset:0 sc1
  buffer_load_dwordx2 v[46:47], v7, s[8:11], s22 offen offset:512 sc1
  buffer_load_dwordx2 v[48:49], v7, s[8:11], s22 offen offset:256 sc1
  buffer_load_dwordx2 v[50:51], v7, s[8:11], s22 offen offset:768 sc1
  buffer_load_dwordx2 v[52:53], v7, s[8:11], s22 offen offset:2048 sc1
  buffer_load_dwordx2 v[54:55], v7, s[8:11], s22 offen offset:2560 sc1
  buffer_load_dwordx2 v[56:57], v7, s[8:11], s22 offen offset:2304 sc1
  buffer_load_dwordx2 v[58:59], v7, s[8:11], s22 offen offset:2816 sc1
  s_mov_b32 s28, 1
wo_h2:
  ds_read_b128 v[72:75], v6 offset:13312
  s_waitcnt lgkmcnt(6)
  v_mfma_f32_32x32x16_bf16 v[12:27], a[80:83], v[80:83], v[12:27]
  ds_read_b128 v[76:79], v6 offset:13824
  s_waitcnt lgkmcnt(6)
  v_mfma_f32_32x32x16_bf16 v[12:27], a[84:87], v[84:87], v[12:27]
  ds_read_b128 v[80:83], v6 offset:14336
  s_waitcnt lgkmcnt(6)
  v_mfma_f32_32x32x16_bf16 v[12:27], a[88:91], v[88:91], v[12:27]
  ds_read_b128 v[84:87], v6 offset:14848
  s_waitcnt lgkmcnt(6)
  v_mfma_f32_32x32x16_bf16 v[12:27], a[92:95], v[92:95], v[12:27]
  ds_read_b128 v[88:91], v6 offset:15360
  s_waitcnt lgkmcnt(6)
  v_mfma_f32_32x32x16_bf16 v[12:27], a[96:99], v[64:67], v[12:27]
  ds_read_b128 v[92:95], v6 offset:15872
  s_waitcnt lgkmcnt(6)
  v_mfma_f32_32x32x16_bf16 v[12:27], a[100:103], v[68:71], v[12:27]
  ds_read_b128 v[64:67], v6 offset:16384
  s_waitcnt lgkmcnt(6)
  v_mfma_f32_32x32x16_bf16 v[12:27], a[104:107], v[72:75], v[12:27]
  ds_read_b128 v[68:71], v6 offset:16896
  s_waitcnt lgkmcnt(6)
  v_mfma_f32_32x32x16_bf16 v[12:27], a[108:111], v[76:79], v[12:27]
  ds_read_b128 v[72:75], v6 offset:17408
  s_waitcnt lgkmcnt(6)
  v_mfma_f32_32x32x16_bf16 v[12:27], a[112:115], v[80:83], v[12:27]
  ds_read_b128 v[76:79], v6 offset:17920
  s_waitcnt lgkmcnt(6)
  v_mfma_f32_32x32x16_bf16 v[12:27], a[116:119], v[84:87], v[12:27]
  ds_read_b128 v[80:83], v6 offset:18432
  s_waitcnt lgkmcnt(6)
  v_mfma_f32_32x32x16_bf16 v[12:27], a[120:123], v[88:91], v[12:27]
  ds_read_b128 v[84:87], v6 offset:18944
  s_waitcnt lgkmcnt(6)
  v_mfma_f32_32x32x16_bf16 v[12:27], a[124:127], v[92:95], v[12:27]
  s_cmp_lg_u32 s28, 0
  s_cbranch_scc1 wo_ht
  v_lshlrev_b32 v60, 2, v3
  s_mov_b32 s30, 0
wo_wt:
  buffer_load_dword v61, v60, s[8:11], s26 offen sc1
  s_waitcnt vmcnt(0)
  v_cmp_ne_u32 vcc, 1, v61
  s_cbranch_vccz wo_wt_ok
  s_sleep 1
  s_cmp_ge_u32 s17, 61
  s_cbranch_scc1 wo_wt_bo
  s_sleep 4
  s_cmp_ge_u32 s17, 56
  s_cbranch_scc1 wo_wt_bo
  s_sleep 40
wo_wt_bo:
  s_add_u32 s30, s30, 1
  s_cmp_lt_u32 s30, 30000
  s_cbranch_scc1 wo_wt
  s_branch wo_abort
wo_wt_ok:
  s_add_u32 s22, s24, 0
  buffer_load_dwordx2 v[28:29], v7, s[8:11], s22 offen offset:0 sc1
  buffer_load_dwordx2 v[30:31], v7, s[8:11], s22 offen offset:512 sc1
  buffer_load_dwordx2 v[32:33], v7, s[8:11], s22 offen offset:256 sc1
  buffer_load_dwordx2 v[34:35], v7, s[8:11], s22 offen offset:768 sc1
  buffer_load_dwordx2 v[36:37], v7, s[8:11], s22 offen offset:2048 sc1
  buffer_load_dwordx2 v[38:39], v7, s[8:11], s22 offen offset:2560 sc1
  buffer_load_dwordx2 v[40:41], v7, s[8:11], s22 offen offset:2304 sc1
  buffer_load_dwordx2 v[42:43], v7, s[8:11], s22 offen offset:2816 sc1
  s_add_u32 s22, s24, 4096
  buffer_load_dwordx2 v[44:45], v7, s[8:11], s22 offen offset:0 sc1
  buffer_load_dwordx2 v[46:47], v7, s[8:11], s22 offen offset:512 sc1
  buffer_load_dwordx2 v[48:49], v7, s[8:11], s22 offen offset:256 sc1
  buffer_load_dwordx2 v[50:51], v7, s[8:11], s22 offen offset:768 sc1
  buffer_load_dwordx2 v[52:53], v7, s[8:11], s22 offen offset:2048 sc1
  buffer_load_dwordx2 v[54:55], v7, s[8:11], s22 offen offset:2560 sc1
  buffer_load_dwordx2 v[56:57], v7, s[8:11], s22 offen offset:2304 sc1
  buffer_load_dwordx2 v[58:59], v7, s[8:11], s22 offen offset:2816 sc1
wo_ht:
  ds_read_b128 v[88:91], v6 offset:19456
  s_waitcnt lgkmcnt(6) vmcnt(0)
  v_mfma_f32_32x32x16_bf16 v[12:27], v[28:31], v[64:67], v[12:27]
  ds_read_b128 v[92:95], v6 offset:19968
  s_waitcnt lgkmcnt(6)
  v_mfma_f32_32x32x16_bf16 v[12:27], v[32:35], v[68:71], v[12:27]
  s_waitcnt lgkmcnt(5)
  v_mfma_f32_32x32x16_bf16 v[12:27], v[36:39], v[72:75], v[12:27]
  s_waitcnt lgkmcnt(4)
  v_mfma_f32_32x32x16_bf16 v[12:27], v[40:43], v[76:79], v[12:27]
  s_waitcnt lgkmcnt(3)
  v_mfma_f32_32x32x16_bf16 v[12:27], v[44:47], v[80:83], v[12:27]
  s_waitcnt lgkmcnt(2)
  v_mfma_f32_32x32x16_bf16 v[12:27], v[48:51], v[84:87], v[12:27]
  s_waitcnt lgkmcnt(1)
  v_mfma_f32_32x32x16_bf16 v[12:27], v[52:55], v[88:91], v[12:27]
  s_waitcnt lgkmcnt(0)
  v_mfma_f32_32x32x16_bf16 v[12:27], v[56:59], v[92:95], v[12:27]
  v_mul_u32_u24 v9, 240, v9
  s_movk_i32 s23, 240
  v_lshl_add_u32 v8, v8, 3, v9
  s_mul_i32 s22, s16, 24
  v_add_u32 v7, s22, v8
  s_lshl_b32 s22, s16, 5
  v_add_u32 v8, s22, v8
  v_min_u32 v11, 223, v0
  v_mul_u32_u24 v9, 4682, v11
  v_lshrrev_b32 v9, 16, v9
  v_mul_u32_u24 v10, 14, v9
  v_sub_u32 v10, v11, v10
  v_cmp_gt_u32 vcc, 8, v10
  v_lshlrev_b32 v10, 4, v10
  v_mad_u32_u24 v11, v9, s23, v10
  v_mul_u32_u24 v9, 1792, v9
  v_add_u32 v10, v9, v10
  s_lshl_b32 s22, s18, 7
  s_mul_i32 s27, s18, 96
  s_add_u32 s27, s27, 384
  v_mov_b32 v9, s22
  v_mov_b32 v5, s27
  v_cndmask_b32 v9, v5, v9, vcc
  v_add_u32 v10, v9, v10
  s_mul_i32 s26, s17, 57344
  s_add_u32 s26, s26, 896
  s_add_u32 s27, s26, 28672
  v_cvt_pk_bf16_f32 v96, v12, v13
  v_cvt_pk_bf16_f32 v97, v14, v15
  ds_write_b64 v8, v[96:97] offset:49152
  v_cvt_pk_bf16_f32 v98, v16, v17
  v_cvt_pk_bf16_f32 v99, v18, v19
  ds_write_b64 v8, v[98:99] offset:49168
  v_cvt_pk_bf16_f32 v100, v20, v21
  v_cvt_pk_bf16_f32 v101, v22, v23
  ds_write_b64 v7, v[100:101] offset:49280
  v_cvt_pk_bf16_f32 v102, v24, v25
  v_cvt_pk_bf16_f32 v103, v26, v27
  s_mov_b32 exec_hi, 0
  ds_write_b64 v7, v[102:103] offset:49296
  s_mov_b64 exec, -1
  s_waitcnt lgkmcnt(0)
  s_barrier
  ds_read_b128 v[104:107], v11 offset:49152
  ds_read_b128 v[108:111], v11 offset:52992
  s_cmp_lg_u32 s16, 3
  s_cselect_b32 exec_hi, -1, 0
  s_waitcnt lgkmcnt(1)
  buffer_store_dwordx4 v[104:107], v10, s[92:95], s26 offen
  s_waitcnt lgkmcnt(0)
  buffer_store_dwordx4 v[108:111], v10, s[92:95], s27 offen
  s_mov_b64 exec, -1
  v_readfirstlane_b32 s22, v250
  s_cmp_ge_u32 s22, 1440
  s_cbranch_scc1 ch_end
  s_branch wk_loop
wp_abort:
wo_abort:
  s_branch cA_abort
ch_end:
  s_endpgm

.section .rodata,"a"
.p2align 6
.amdhsa_kernel main_kernel
  .amdhsa_next_free_vgpr 512
  .amdhsa_next_free_sgpr 102
  .amdhsa_accum_offset 256
  .amdhsa_group_segment_fixed_size 0
  .amdhsa_kernarg_size 136
  .amdhsa_user_sgpr_count 2
  .amdhsa_user_sgpr_kernarg_segment_ptr 1
  .amdhsa_system_sgpr_workgroup_id_x 1
.end_amdhsa_kernel
```

```asm
; @launch kernel=main_kernel grid=(256,1,1) block=(256,1,1) lds=163840
.amdgcn_target "amdgcn-amd-amdhsa--gfx950"
.text
.globl main_kernel
.p2align 8
.type main_kernel,@function
main_kernel:
  s_cmp_ge_u32 s2, 256
  s_cbranch_scc1 ch_end
  s_load_dwordx4 s[4:7], s[0:1], 120
  s_load_dwordx2 s[92:93], s[0:1], 112
  s_load_dwordx8 s[36:43], s[0:1], 56
  s_load_dwordx4 s[44:47], s[0:1], 88
  s_memrealtime s[88:89]
  s_getpc_b64 s[98:99]
pf_main_kernel_1:
  s_sub_u32 s98, s98, pf_main_kernel_1-main_kernel
  s_subb_u32 s99, s99, 0
  s_lshr_b32 s20, s2, 3
  v_lshl_add_u32 v60, v0, 5, s20
  v_lshlrev_b32 v60, 7, v60
  v_min_u32 v60, ch_end-main_kernel-4, v60
  v_cmp_gt_u32 vcc, 32, v0
  s_and_saveexec_b64 s[22:23], vcc
  s_cbranch_execz pf_main_kernel_1_n
  global_load_dword v62, v60, s[98:99]
pf_main_kernel_1_n:
  s_mov_b64 exec, -1
  s_getreg_b32 s67, hwreg(HW_REG_XCC_ID)
  s_and_b32 s67, s67, 7
  v_lshrrev_b32 v1, 6, v0
  s_nop 0
  v_readfirstlane_b32 s16, v1
  s_mov_b32 s66, 0
  s_mov_b32 s68, 0
  s_mov_b32 s69, 0
  s_mov_b32 s96, 0
  s_mov_b32 s97, 0
  s_mov_b32 s101, 0x5eed0000
  s_sub_u32 s20, s67, 0
  s_lshr_b32 s21, s2, 3
  s_and_b32 s20, s20, 7
  s_lshl_b32 s3, s20, 5
  s_add_u32 s3, s3, s21
  s_waitcnt lgkmcnt(0)
  s_mov_b32 s8, s6
  s_and_b32 s9, s7, 0xffff
  s_mov_b32 s10, 0x10000000
  s_mov_b32 s11, 0x20000
  s_mov_b32 s12, s4
  s_and_b32 s13, s5, 0xffff
  s_mov_b32 s14, 256
  s_mov_b32 s15, 0x20000
  s_or_b32 s88, s88, 1
  s_and_b32 s93, s93, 0xffff
  s_mov_b32 s94, 3670016
  s_mov_b32 s95, 0x20000
m_start:
  s_cmp_ge_u32 s3, 32
  s_cbranch_scc1 m_bjob
  v_and_b32 v1, 63, v0
  v_lshlrev_b32 v2, 4, v1
  v_lshrrev_b32 v116, 4, v1
  v_and_b32 v117, 15, v1
  v_mov_b32 v3, 0x4444
  v_mov_b32 v118, 0xeeee
  v_cmp_lt_u32 vcc, 7, v117
  s_nop 1
  v_cndmask_b32 v3, v3, v118, vcc
  s_and_b32 s17, s3, 15
  s_cmp_ge_u32 s3, 16
  s_cbranch_scc1 m_val
  s_mov_b32 s60, s42
  s_and_b32 s61, s43, 0xffff
  s_mov_b32 s62, 3670016
  s_mov_b32 s63, 0x20000
  v_lshrrev_b32 v24, 5, v1
  v_and_b32 v25, 31, v1
  s_lshl_b32 s26, s17, 9
  s_lshl_b32 s25, s16, 12
  v_xor_b32 v26, v25, v24
  v_lshlrev_b32 v26, 4, v26
  v_lshl_add_u32 v26, v24, 13, v26
  v_xor_b32 v100, 0, v26
  v_xor_b32 v101, 0, v26
  v_add_u32 v101, 15360, v101
  v_xor_b32 v102, 32, v26
  v_add_u32 v102, 30720, v102
  v_xor_b32 v103, 32, v26
  v_add_u32 v103, 46080, v103
  s_lshl_b32 s23, s16, 19
  s_add_u32 s23, s23, s26
  s_add_u32 m0, s25, 16384
  s_nop 0
  buffer_load_dwordx4 v100, s[60:63], s23 offen offset:0 lds
  buffer_load_dwordx4 v101, s[60:63], s23 offen offset:1024 lds
  buffer_load_dwordx4 v102, s[60:63], s23 offen offset:2048 lds
  buffer_load_dwordx4 v103, s[60:63], s23 offen offset:3072 lds
  s_add_u32 m0, s25, 32768
  s_add_u32 s23, s23, 65536
  buffer_load_dwordx4 v100, s[60:63], s23 offen offset:0 lds
  buffer_load_dwordx4 v101, s[60:63], s23 offen offset:1024 lds
  buffer_load_dwordx4 v102, s[60:63], s23 offen offset:2048 lds
  buffer_load_dwordx4 v103, s[60:63], s23 offen offset:3072 lds
  v_xor_b32 v100, 64, v100
  v_xor_b32 v101, 64, v101
  v_xor_b32 v102, 64, v102
  v_xor_b32 v103, 64, v103
  s_add_u32 m0, s25, 49152
  s_add_u32 s23, s23, 65536
  buffer_load_dwordx4 v100, s[60:63], s23 offen offset:0 lds
  buffer_load_dwordx4 v101, s[60:63], s23 offen offset:1024 lds
  buffer_load_dwordx4 v102, s[60:63], s23 offen offset:2048 lds
  buffer_load_dwordx4 v103, s[60:63], s23 offen offset:3072 lds
  s_add_u32 m0, s25, 65536
  s_add_u32 s23, s23, 65536
  buffer_load_dwordx4 v100, s[60:63], s23 offen offset:0 lds
  buffer_load_dwordx4 v101, s[60:63], s23 offen offset:1024 lds
  buffer_load_dwordx4 v102, s[60:63], s23 offen offset:2048 lds
  buffer_load_dwordx4 v103, s[60:63], s23 offen offset:3072 lds
  v_xor_b32 v100, 192, v100
  v_xor_b32 v101, 192, v101
  v_xor_b32 v102, 192, v102
  v_xor_b32 v103, 192, v103
  s_add_u32 m0, s25, 81920
  s_add_u32 s23, s23, 65536
  buffer_load_dwordx4 v100, s[60:63], s23 offen offset:0 lds
  buffer_load_dwordx4 v101, s[60:63], s23 offen offset:1024 lds
  buffer_load_dwordx4 v102, s[60:63], s23 offen offset:2048 lds
  buffer_load_dwordx4 v103, s[60:63], s23 offen offset:3072 lds
  s_add_u32 m0, s25, 98304
  s_add_u32 s23, s23, 65536
  buffer_load_dwordx4 v100, s[60:63], s23 offen offset:0 lds
  buffer_load_dwordx4 v101, s[60:63], s23 offen offset:1024 lds
  buffer_load_dwordx4 v102, s[60:63], s23 offen offset:2048 lds
  buffer_load_dwordx4 v103, s[60:63], s23 offen offset:3072 lds
  v_xor_b32 v100, 64, v100
  v_xor_b32 v101, 64, v101
  v_xor_b32 v102, 64, v102
  v_xor_b32 v103, 64, v103
  s_add_u32 m0, s25, 114688
  s_add_u32 s23, s23, 65536
  buffer_load_dwordx4 v100, s[60:63], s23 offen offset:0 lds
  buffer_load_dwordx4 v101, s[60:63], s23 offen offset:1024 lds
  buffer_load_dwordx4 v102, s[60:63], s23 offen offset:2048 lds
  buffer_load_dwordx4 v103, s[60:63], s23 offen offset:3072 lds
  s_add_u32 m0, s25, 131072
  s_add_u32 s23, s23, 65536
  buffer_load_dwordx4 v100, s[60:63], s23 offen offset:0 lds
  buffer_load_dwordx4 v101, s[60:63], s23 offen offset:1024 lds
  buffer_load_dwordx4 v102, s[60:63], s23 offen offset:2048 lds
  buffer_load_dwordx4 v103, s[60:63], s23 offen offset:3072 lds
  s_mov_b32 s56, s40
  s_and_b32 s57, s41, 0xffff
  s_mov_b32 s58, 3670016
  s_mov_b32 s59, 0x20000
  s_lshl_b32 s21, s16, 16
  s_add_u32 s27, s26, s21
  s_lshr_b32 s20, s16, 1
  s_lshl_b32 s20, s20, 6
  v_xor_b32 v26, s20, v26
  v_xor_b32 v4, 0, v26
  v_xor_b32 v5, 32, v26
  v_add_u32 v5, 15360, v5
  v_xor_b32 v6, 128, v26
  v_add_u32 v6, 30720, v6
  v_xor_b32 v7, 160, v26
  v_add_u32 v7, 46080, v7
  s_add_u32 s22, s27, 0
  s_add_u32 m0, s25, 0
  s_nop 0
  buffer_load_dwordx4 v4, s[56:59], s22 offen offset:0 lds
  buffer_load_dwordx4 v5, s[56:59], s22 offen offset:1024 lds
  buffer_load_dwordx4 v6, s[56:59], s22 offen offset:2048 lds
  buffer_load_dwordx4 v7, s[56:59], s22 offen offset:3072 lds
  s_cmp_lg_u32 s66, 0
  s_cbranch_scc1 sc_ci
  s_cmp_lg_u32 s16, 0
  s_cbranch_scc1 w0_2
  s_lshr_b32 s70, s3, 5
  s_and_b32 s71, s70, 4
  s_mul_i32 s71, s71, 12
  s_lshl_b32 s70, s70, 2
  s_add_u32 s70, s70, s71
  s_lshl_b32 s71, 1, s3
  v_mov_b32 v248, s71
  v_mov_b32 v249, 32
  s_mov_b64 exec, 1
  buffer_atomic_or v248, v249, s[12:15], s70 offen sc0
  buffer_load_dwordx2 v[250:251], v249, s[12:15], 0 offen offset:96 sc1
  s_mov_b64 exec, -1
w0_2:
sc_ci:
  v_and_b32 v26, 15, v25
  v_xor_b32 v27, v26, v24
  v_lshlrev_b32 v27, 4, v27
  v_bfe_u32 v28, v25, 2, 1
  v_lshlrev_b32 v28, 4, v28
  v_lshrrev_b32 v29, 3, v25
  v_lshl_add_u32 v28, v29, 2, v28
  v_and_b32 v29, 3, v25
  v_add_u32 v28, v28, v29
  v_lshl_add_u32 v28, v28, 9, v27
  v_lshrrev_b32 v29, 2, v26
  v_lshlrev_b32 v29, 15, v29
  v_bfe_u32 v30, v26, 1, 1
  v_lshl_add_u32 v29, v30, 11, v29
  v_lshrrev_b32 v30, 4, v25
  v_lshl_add_u32 v29, v30, 10, v29
  v_and_b32 v31, 1, v26
  v_lshl_add_u32 v29, v31, 9, v29
  v_add_u32 v29, v29, v27
  v_add_u32 v29, s25, v29
  v_xor_b32 v8, 0, v28
  v_xor_b32 v104, 0, v29
  v_xor_b32 v9, 32, v28
  v_xor_b32 v105, 32, v29
  v_xor_b32 v10, 64, v28
  v_xor_b32 v106, 64, v29
  v_xor_b32 v11, 96, v28
  v_xor_b32 v107, 96, v29
  v_xor_b32 v12, 128, v28
  v_xor_b32 v108, 128, v29
  v_xor_b32 v13, 160, v28
  v_xor_b32 v109, 160, v29
  v_xor_b32 v14, 192, v28
  v_xor_b32 v110, 192, v29
  v_xor_b32 v15, 224, v28
  v_xor_b32 v111, 224, v29
  s_mov_b32 s52, 1035512379
  s_waitcnt vmcnt(4)
  ds_read_b128 v[120:123], v104 offset:16384
  ds_read_b128 v[124:127], v105 offset:16384
  ds_read_b128 v[128:131], v106 offset:16384
  ds_read_b128 v[132:135], v107 offset:16384
  ds_read_b128 v[136:139], v108 offset:16384
  ds_read_b128 v[140:143], v109 offset:16384
  ds_read_b128 v[144:147], v110 offset:16384
  ds_read_b128 v[148:151], v111 offset:16384
  s_waitcnt lgkmcnt(4)
  ds_read_b128 v[152:155], v104 offset:16640
  ds_read_b128 v[156:159], v105 offset:16640
  ds_read_b128 v[160:163], v106 offset:16640
  ds_read_b128 v[164:167], v107 offset:16640
  ds_read_b128 v[168:171], v108 offset:16640
  ds_read_b128 v[172:175], v109 offset:16640
  ds_read_b128 v[176:179], v110 offset:16640
  ds_read_b128 v[180:183], v111 offset:16640
  s_waitcnt lgkmcnt(4)
  ds_read_b128 v[184:187], v104 offset:32768
  ds_read_b128 v[188:191], v105 offset:32768
  ds_read_b128 v[192:195], v106 offset:32768
  ds_read_b128 v[196:199], v107 offset:32768
  ds_read_b128 v[200:203], v108 offset:32768
  ds_read_b128 v[204:207], v109 offset:32768
  ds_read_b128 v[208:211], v110 offset:32768
  ds_read_b128 v[212:215], v111 offset:32768
  s_waitcnt lgkmcnt(4)
  ds_read_b128 v[216:219], v104 offset:33024
  ds_read_b128 v[220:223], v105 offset:33024
  ds_read_b128 v[224:227], v106 offset:33024
  ds_read_b128 v[228:231], v107 offset:33024
  ds_read_b128 v[232:235], v108 offset:33024
  ds_read_b128 v[236:239], v109 offset:33024
  ds_read_b128 v[240:243], v110 offset:33024
  ds_read_b128 v[244:247], v111 offset:33024
  s_waitcnt lgkmcnt(4)
  s_waitcnt lgkmcnt(0)
  s_add_u32 s22, s27, 262144
  s_add_u32 m0, s25, 16384
  s_nop 0
  buffer_load_dwordx4 v4, s[56:59], s22 offen offset:0 lds
  buffer_load_dwordx4 v5, s[56:59], s22 offen offset:1024 lds
  buffer_load_dwordx4 v6, s[56:59], s22 offen offset:2048 lds
  buffer_load_dwordx4 v7, s[56:59], s22 offen offset:3072 lds
  s_add_u32 s22, s27, 524288
  s_add_u32 m0, s25, 32768
  s_nop 0
  buffer_load_dwordx4 v4, s[56:59], s22 offen offset:0 lds
  buffer_load_dwordx4 v5, s[56:59], s22 offen offset:1024 lds
  buffer_load_dwordx4 v6, s[56:59], s22 offen offset:2048 lds
  buffer_load_dwordx4 v7, s[56:59], s22 offen offset:3072 lds
  s_add_u32 s22, s27, 786432
  s_add_u32 m0, s25, 49152
  s_nop 0
  buffer_load_dwordx4 v4, s[56:59], s22 offen offset:0 lds
  buffer_load_dwordx4 v5, s[56:59], s22 offen offset:1024 lds
  buffer_load_dwordx4 v6, s[56:59], s22 offen offset:2048 lds
  buffer_load_dwordx4 v7, s[56:59], s22 offen offset:3072 lds
  s_cmp_lg_u32 s66, 0
  s_cbranch_scc1 sc_cf
  s_cmp_lg_u32 s16, 0
  s_cbranch_scc1 w0_3
  s_waitcnt vmcnt(12)
  v_readfirstlane_b32 s70, v250
  s_cmp_lg_u32 s70, 0
  s_cbranch_scc1 sc_nz
  v_mov_b32 v249, 128
  v_mov_b32 v250, s88
  v_mov_b32 v251, s89
  v_mov_b32 v252, 0
  v_mov_b32 v253, 0
  s_mov_b64 exec, 1
  buffer_atomic_cmpswap_x2 v[250:253], v249, s[12:15], 0 offen sc0
  s_mov_b64 exec, -1
  s_waitcnt vmcnt(0)
  v_readfirstlane_b32 s70, v250
  s_cmp_lg_u32 s70, 0
  s_cbranch_scc1 sc_nz
  v_mov_b32 v250, s88
  v_mov_b32 v251, s89
sc_nz:
w0_3:
  v_mov_b32 v249, 160000
  s_add_u32 s101, s101, 1
  s_barrier
  s_mov_b64 exec, 1
  s_cmp_lg_u32 s16, 0
  s_cbranch_scc1 w0_4
  ds_write_b32 v249, v248 offset:0
  ds_write_b32 v249, v250 offset:4
  ds_write_b32 v249, v251 offset:8
  s_waitcnt lgkmcnt(0)
  v_mov_b32 v248, s101
  ds_write_b32 v249, v248 offset:16
  s_waitcnt lgkmcnt(0)
w0_4:
  s_mov_b64 exec, -1
  s_barrier
  ds_read_b32 v248, v249 offset:0
  ds_read_b32 v250, v249 offset:4
  ds_read_b32 v251, v249 offset:8
  ds_read_b32 v249, v249 offset:16
  s_waitcnt lgkmcnt(0)
  v_readfirstlane_b32 s70, v248
  v_readfirstlane_b32 s88, v250
  v_readfirstlane_b32 s89, v251
  v_cmp_ne_u32 vcc, s101, v249
  s_cbranch_vccnz ch_end
  s_mov_b32 s66, 1
  s_bitcmp1_b32 s70, s3
  s_cbranch_scc1 m_reclaim
sc_cf:
  s_cmp_lg_u32 s16, 0
  s_cbranch_scc1 w0_5
  s_cmp_eq_u32 s67, 0
  s_cselect_b32 s20, 1, 0x10001
  v_mov_b32 v248, s20
  v_mov_b32 v249, 0
  s_mov_b64 exec, 1
  buffer_atomic_add v248, v249, s[12:15], 0 offen
  s_mov_b64 exec, -1
w0_5:
  s_lshl_b32 s28, s17, 7
  s_add_u32 s28, s28, 88635392
  v_min_u32 v113, 96, v2
  s_mov_b32 s29, 88602624
  v_add_u32 v112, 1024, v2
  v_min_u32 v112, 1776, v112
  s_mul_i32 s32, s17, 401408
  s_mul_i32 s33, s16, 14336
  s_add_u32 s32, s32, s33
  s_add_u32 s33, s32, s33
  s_add_u32 s32, s32, 344064
  s_add_u32 s33, s33, 229376
  s_waitcnt vmcnt(8)
  s_barrier
  ds_read_b128 v[16:19], v8 offset:0
  ds_read_b128 v[20:23], v9 offset:0
  ds_read_b128 v[24:27], v10 offset:0
  ds_read_b128 v[28:31], v11 offset:0
  s_waitcnt lgkmcnt(3)
  v_mfma_f32_32x32x16_bf16 v[32:47], v[16:19], v[120:123], 0
  s_add_u32 s22, s27, 1048576
  s_add_u32 m0, s25, 65536
  s_nop 0
  buffer_load_dwordx4 v4, s[56:59], s22 offen offset:0 lds
  v_mfma_f32_32x32x16_bf16 v[48:63], v[16:19], v[184:187], 0
  ds_read_b128 v[16:19], v12 offset:0
  s_waitcnt lgkmcnt(3)
  v_mfma_f32_32x32x16_bf16 v[32:47], v[20:23], v[124:127], v[32:47]
  buffer_load_dwordx4 v5, s[56:59], s22 offen offset:1024 lds
  v_mfma_f32_32x32x16_bf16 v[48:63], v[20:23], v[188:191], v[48:63]
  ds_read_b128 v[20:23], v13 offset:0
  s_waitcnt lgkmcnt(3)
  v_mfma_f32_32x32x16_bf16 v[32:47], v[24:27], v[128:131], v[32:47]
  buffer_load_dwordx4 v6, s[56:59], s22 offen offset:2048 lds
  v_mfma_f32_32x32x16_bf16 v[48:63], v[24:27], v[192:195], v[48:63]
  ds_read_b128 v[24:27], v14 offset:0
  s_waitcnt lgkmcnt(3)
  v_mfma_f32_32x32x16_bf16 v[32:47], v[28:31], v[132:135], v[32:47]
  buffer_load_dwordx4 v7, s[56:59], s22 offen offset:3072 lds
  v_mfma_f32_32x32x16_bf16 v[48:63], v[28:31], v[196:199], v[48:63]
  ds_read_b128 v[28:31], v15 offset:0
  s_waitcnt lgkmcnt(3)
  v_mfma_f32_32x32x16_bf16 v[32:47], v[16:19], v[136:139], v[32:47]
  s_add_u32 s22, s27, 1310720
  s_add_u32 m0, s25, 81920
  s_nop 0
  buffer_load_dwordx4 v4, s[56:59], s22 offen offset:0 lds
  v_mfma_f32_32x32x16_bf16 v[48:63], v[16:19], v[200:203], v[48:63]
  ds_read_b128 v[16:19], v8 offset:256
  s_waitcnt lgkmcnt(3)
  v_mfma_f32_32x32x16_bf16 v[32:47], v[20:23], v[140:143], v[32:47]
  buffer_load_dwordx4 v5, s[56:59], s22 offen offset:1024 lds
  v_mfma_f32_32x32x16_bf16 v[48:63], v[20:23], v[204:207], v[48:63]
  ds_read_b128 v[20:23], v9 offset:256
  s_waitcnt lgkmcnt(3)
  v_mfma_f32_32x32x16_bf16 v[32:47], v[24:27], v[144:147], v[32:47]
  buffer_load_dwordx4 v6, s[56:59], s22 offen offset:2048 lds
  v_mfma_f32_32x32x16_bf16 v[48:63], v[24:27], v[208:211], v[48:63]
  ds_read_b128 v[24:27], v10 offset:256
  s_waitcnt lgkmcnt(3)
  v_mfma_f32_32x32x16_bf16 v[32:47], v[28:31], v[148:151], v[32:47]
  buffer_load_dwordx4 v7, s[56:59], s22 offen offset:3072 lds
  v_mfma_f32_32x32x16_bf16 v[48:63], v[28:31], v[212:215], v[48:63]
  ds_read_b128 v[28:31], v11 offset:256
  s_waitcnt lgkmcnt(3)
  v_mfma_f32_32x32x16_bf16 v[32:47], v[16:19], v[152:155], v[32:47]
  s_add_u32 s22, s27, 1572864
  s_add_u32 m0, s25, 98304
  s_nop 0
  buffer_load_dwordx4 v4, s[56:59], s22 offen offset:0 lds
  v_mfma_f32_32x32x16_bf16 v[48:63], v[16:19], v[216:219], v[48:63]
  ds_read_b128 v[16:19], v12 offset:256
  s_waitcnt lgkmcnt(3)
  v_mfma_f32_32x32x16_bf16 v[32:47], v[20:23], v[156:159], v[32:47]
  buffer_load_dwordx4 v5, s[56:59], s22 offen offset:1024 lds
  v_mfma_f32_32x32x16_bf16 v[48:63], v[20:23], v[220:223], v[48:63]
  ds_read_b128 v[20:23], v13 offset:256
  s_waitcnt lgkmcnt(3)
  v_mfma_f32_32x32x16_bf16 v[32:47], v[24:27], v[160:163], v[32:47]
  buffer_load_dwordx4 v6, s[56:59], s22 offen offset:2048 lds
  v_mfma_f32_32x32x16_bf16 v[48:63], v[24:27], v[224:227], v[48:63]
  ds_read_b128 v[24:27], v14 offset:256
  s_waitcnt lgkmcnt(3)
  v_mfma_f32_32x32x16_bf16 v[32:47], v[28:31], v[164:167], v[32:47]
  buffer_load_dwordx4 v7, s[56:59], s22 offen offset:3072 lds
  v_mfma_f32_32x32x16_bf16 v[48:63], v[28:31], v[228:231], v[48:63]
  ds_read_b128 v[28:31], v15 offset:256
  s_waitcnt lgkmcnt(3)
  v_mfma_f32_32x32x16_bf16 v[32:47], v[16:19], v[168:171], v[32:47]
  s_add_u32 s22, s27, 1835008
  s_add_u32 m0, s25, 114688
  s_nop 0
  buffer_load_dwordx4 v4, s[56:59], s22 offen offset:0 lds
  v_mfma_f32_32x32x16_bf16 v[48:63], v[16:19], v[232:235], v[48:63]
  ds_read_b128 v[16:19], v8 offset:16384
  s_waitcnt lgkmcnt(3)
  v_mfma_f32_32x32x16_bf16 v[32:47], v[20:23], v[172:175], v[32:47]
  buffer_load_dwordx4 v5, s[56:59], s22 offen offset:1024 lds
  v_mfma_f32_32x32x16_bf16 v[48:63], v[20:23], v[236:239], v[48:63]
  ds_read_b128 v[20:23], v9 offset:16384
  s_waitcnt lgkmcnt(3)
  v_mfma_f32_32x32x16_bf16 v[32:47], v[24:27], v[176:179], v[32:47]
  buffer_load_dwordx4 v6, s[56:59], s22 offen offset:2048 lds
  v_mfma_f32_32x32x16_bf16 v[48:63], v[24:27], v[240:243], v[48:63]
  ds_read_b128 v[24:27], v10 offset:16384
  s_waitcnt lgkmcnt(3)
  v_mfma_f32_32x32x16_bf16 v[32:47], v[28:31], v[180:183], v[32:47]
  buffer_load_dwordx4 v7, s[56:59], s22 offen offset:3072 lds
  v_mfma_f32_32x32x16_bf16 v[48:63], v[28:31], v[244:247], v[48:63]
  s_waitcnt vmcnt(16)
  s_barrier
  ds_read_b128 v[28:31], v11 offset:16384
  s_waitcnt lgkmcnt(3)
  v_mfma_f32_32x32x16_bf16 v[64:79], v[16:19], v[120:123], 0
  s_add_u32 s22, s27, 2097152
  s_add_u32 m0, s25, 131072
  s_nop 0
  buffer_load_dwordx4 v4, s[56:59], s22 offen offset:0 lds
  v_mfma_f32_32x32x16_bf16 v[80:95], v[16:19], v[184:187], 0
  ds_read_b128 v[16:19], v12 offset:16384
  s_waitcnt lgkmcnt(3)
  v_mfma_f32_32x32x16_bf16 v[64:79], v[20:23], v[124:127], v[64:79]
  buffer_load_dwordx4 v5, s[56:59], s22 offen offset:1024 lds
  v_mul_f32 v32, s52, v32
  v_mul_f32 v33, s52, v33
  v_cvt_pk_bf16_f32 v32, v32, v33
  v_mfma_f32_32x32x16_bf16 v[80:95], v[20:23], v[188:191], v[80:95]
  v_mul_f32 v34, s52, v34
  v_mul_f32 v35, s52, v35
  ds_read_b128 v[20:23], v13 offset:16384
  s_waitcnt lgkmcnt(3)
  v_mfma_f32_32x32x16_bf16 v[64:79], v[24:27], v[128:131], v[64:79]
  buffer_load_dwordx4 v6, s[56:59], s22 offen offset:2048 lds
  v_cvt_pk_bf16_f32 v33, v34, v35
  v_mul_f32 v36, s52, v36
  v_mul_f32 v37, s52, v37
  v_mfma_f32_32x32x16_bf16 v[80:95], v[24:27], v[192:195], v[80:95]
  v_cvt_pk_bf16_f32 v34, v36, v37
  v_mul_f32 v38, s52, v38
  ds_read_b128 v[24:27], v14 offset:16384
  s_waitcnt lgkmcnt(3)
  v_mfma_f32_32x32x16_bf16 v[64:79], v[28:31], v[132:135], v[64:79]
  buffer_load_dwordx4 v7, s[56:59], s22 offen offset:3072 lds
  v_mul_f32 v39, s52, v39
  v_cvt_pk_bf16_f32 v35, v38, v39
  v_mul_f32 v40, s52, v40
  v_mfma_f32_32x32x16_bf16 v[80:95], v[28:31], v[196:199], v[80:95]
  v_mul_f32 v41, s52, v41
  v_cvt_pk_bf16_f32 v40, v40, v41
  ds_read_b128 v[28:31], v15 offset:16384
  s_waitcnt lgkmcnt(3)
  v_mfma_f32_32x32x16_bf16 v[64:79], v[16:19], v[136:139], v[64:79]
  s_add_u32 s22, s27, 2359296
  s_add_u32 m0, s25, 0
  s_nop 0
  buffer_load_dwordx4 v4, s[56:59], s22 offen offset:0 lds
  v_mul_f32 v42, s52, v42
  v_mul_f32 v43, s52, v43
  v_cvt_pk_bf16_f32 v41, v42, v43
  v_mfma_f32_32x32x16_bf16 v[80:95], v[16:19], v[200:203], v[80:95]
  v_mul_f32 v44, s52, v44
  v_mul_f32 v45, s52, v45
  ds_read_b128 v[16:19], v8 offset:16640
  s_waitcnt lgkmcnt(3)
  v_mfma_f32_32x32x16_bf16 v[64:79], v[20:23], v[140:143], v[64:79]
  buffer_load_dwordx4 v5, s[56:59], s22 offen offset:1024 lds
  v_cvt_pk_bf16_f32 v42, v44, v45
  v_mul_f32 v46, s52, v46
  v_mul_f32 v47, s52, v47
  v_mfma_f32_32x32x16_bf16 v[80:95], v[20:23], v[204:207], v[80:95]
  v_cvt_pk_bf16_f32 v43, v46, v47
  v_permlane16_swap_b32 v32, v40
  ds_read_b128 v[20:23], v9 offset:16640
  s_waitcnt lgkmcnt(3)
  v_mfma_f32_32x32x16_bf16 v[64:79], v[24:27], v[144:147], v[64:79]
  buffer_load_dwordx4 v6, s[56:59], s22 offen offset:2048 lds
  v_permlane16_swap_b32 v33, v41
  v_permlane16_swap_b32 v34, v42
  v_permlane16_swap_b32 v35, v43
  v_mfma_f32_32x32x16_bf16 v[80:95], v[24:27], v[208:211], v[80:95]
  v_accvgpr_write_b32 a0, v32
  v_accvgpr_write_b32 a1, v33
  ds_read_b128 v[24:27], v10 offset:16640
  s_waitcnt lgkmcnt(3)
  v_mfma_f32_32x32x16_bf16 v[64:79], v[28:31], v[148:151], v[64:79]
  buffer_load_dwordx4 v7, s[56:59], s22 offen offset:3072 lds
  v_accvgpr_write_b32 a2, v34
  v_accvgpr_write_b32 a3, v35
  v_accvgpr_write_b32 a56, v40
  v_mfma_f32_32x32x16_bf16 v[80:95], v[28:31], v[212:215], v[80:95]
  v_accvgpr_write_b32 a57, v41
  v_accvgpr_write_b32 a58, v42
  ds_read_b128 v[28:31], v11 offset:16640
  s_waitcnt lgkmcnt(3)
  v_mfma_f32_32x32x16_bf16 v[64:79], v[16:19], v[152:155], v[64:79]
  v_accvgpr_write_b32 a59, v43
  v_mul_f32 v48, s52, v48
  v_mul_f32 v49, s52, v49
  v_mfma_f32_32x32x16_bf16 v[80:95], v[16:19], v[216:219], v[80:95]
  v_cvt_pk_bf16_f32 v48, v48, v49
  v_mul_f32 v50, s52, v50
  ds_read_b128 v[16:19], v12 offset:16640
  s_waitcnt lgkmcnt(3)
  v_mfma_f32_32x32x16_bf16 v[64:79], v[20:23], v[156:159], v[64:79]
  v_mul_f32 v51, s52, v51
  v_cvt_pk_bf16_f32 v49, v50, v51
  v_mul_f32 v52, s52, v52
  v_mfma_f32_32x32x16_bf16 v[80:95], v[20:23], v[220:223], v[80:95]
  v_mul_f32 v53, s52, v53
  v_cvt_pk_bf16_f32 v50, v52, v53
  ds_read_b128 v[20:23], v13 offset:16640
  s_waitcnt lgkmcnt(3)
  v_mfma_f32_32x32x16_bf16 v[64:79], v[24:27], v[160:163], v[64:79]
  v_mul_f32 v54, s52, v54
  v_mul_f32 v55, s52, v55
  v_cvt_pk_bf16_f32 v51, v54, v55
  v_mfma_f32_32x32x16_bf16 v[80:95], v[24:27], v[224:227], v[80:95]
  v_mul_f32 v56, s52, v56
  v_mul_f32 v57, s52, v57
  ds_read_b128 v[24:27], v14 offset:16640
  s_waitcnt lgkmcnt(3)
  v_mfma_f32_32x32x16_bf16 v[64:79], v[28:31], v[164:167], v[64:79]
  v_cvt_pk_bf16_f32 v56, v56, v57
  v_mul_f32 v58, s52, v58
  v_mul_f32 v59, s52, v59
  v_mfma_f32_32x32x16_bf16 v[80:95], v[28:31], v[228:231], v[80:95]
  v_cvt_pk_bf16_f32 v57, v58, v59
  v_mul_f32 v60, s52, v60
  ds_read_b128 v[28:31], v15 offset:16640
  s_waitcnt lgkmcnt(3)
  v_mfma_f32_32x32x16_bf16 v[64:79], v[16:19], v[168:171], v[64:79]
  v_mul_f32 v61, s52, v61
  v_cvt_pk_bf16_f32 v58, v60, v61
  v_mul_f32 v62, s52, v62
  v_mfma_f32_32x32x16_bf16 v[80:95], v[16:19], v[232:235], v[80:95]
  v_mul_f32 v63, s52, v63
  v_cvt_pk_bf16_f32 v59, v62, v63
  ds_read_b128 v[16:19], v8 offset:32768
  s_waitcnt lgkmcnt(3)
  v_mfma_f32_32x32x16_bf16 v[64:79], v[20:23], v[172:175], v[64:79]
  v_permlane16_swap_b32 v48, v56
  v_permlane16_swap_b32 v49, v57
  v_permlane16_swap_b32 v50, v58
  v_mfma_f32_32x32x16_bf16 v[80:95], v[20:23], v[236:239], v[80:95]
  v_permlane16_swap_b32 v51, v59
  v_accvgpr_write_b32 a112, v48
  ds_read_b128 v[20:23], v9 offset:32768
  s_waitcnt lgkmcnt(3)
  v_mfma_f32_32x32x16_bf16 v[64:79], v[24:27], v[176:179], v[64:79]
  v_accvgpr_write_b32 a113, v49
  v_accvgpr_write_b32 a114, v50
  v_accvgpr_write_b32 a115, v51
  v_mfma_f32_32x32x16_bf16 v[80:95], v[24:27], v[240:243], v[80:95]
  v_accvgpr_write_b32 a168, v56
  v_accvgpr_write_b32 a169, v57
  ds_read_b128 v[24:27], v10 offset:32768
  s_waitcnt lgkmcnt(3)
  v_mfma_f32_32x32x16_bf16 v[64:79], v[28:31], v[180:183], v[64:79]
  v_accvgpr_write_b32 a170, v58
  v_accvgpr_write_b32 a171, v59
  v_mfma_f32_32x32x16_bf16 v[80:95], v[28:31], v[244:247], v[80:95]
  ds_read_b128 v[28:31], v11 offset:32768
  s_waitcnt lgkmcnt(3)
  v_mfma_f32_32x32x16_bf16 v[32:47], v[16:19], v[120:123], 0
  v_mfma_f32_32x32x16_bf16 v[48:63], v[16:19], v[184:187], 0
  ds_read_b128 v[16:19], v12 offset:32768
  s_waitcnt lgkmcnt(3)
  v_mfma_f32_32x32x16_bf16 v[32:47], v[20:23], v[124:127], v[32:47]
  v_mul_f32 v64, s52, v64
  v_mul_f32 v65, s52, v65
  v_cvt_pk_bf16_f32 v64, v64, v65
  v_mfma_f32_32x32x16_bf16 v[48:63], v[20:23], v[188:191], v[48:63]
  v_mul_f32 v66, s52, v66
  v_mul_f32 v67, s52, v67
  ds_read_b128 v[20:23], v13 offset:32768
  s_waitcnt lgkmcnt(3)
  v_mfma_f32_32x32x16_bf16 v[32:47], v[24:27], v[128:131], v[32:47]
  v_cvt_pk_bf16_f32 v65, v66, v67
  v_mul_f32 v68, s52, v68
  v_mul_f32 v69, s52, v69
  v_mfma_f32_32x32x16_bf16 v[48:63], v[24:27], v[192:195], v[48:63]
  v_cvt_pk_bf16_f32 v66, v68, v69
  v_mul_f32 v70, s52, v70
  ds_read_b128 v[24:27], v14 offset:32768
  s_waitcnt lgkmcnt(3)
  v_mfma_f32_32x32x16_bf16 v[32:47], v[28:31], v[132:135], v[32:47]
  v_mul_f32 v71, s52, v71
  v_cvt_pk_bf16_f32 v67, v70, v71
  v_mul_f32 v72, s52, v72
  v_mfma_f32_32x32x16_bf16 v[48:63], v[28:31], v[196:199], v[48:63]
  v_mul_f32 v73, s52, v73
  v_cvt_pk_bf16_f32 v72, v72, v73
  ds_read_b128 v[28:31], v15 offset:32768
  s_waitcnt lgkmcnt(3)
  v_mfma_f32_32x32x16_bf16 v[32:47], v[16:19], v[136:139], v[32:47]
  v_mul_f32 v74, s52, v74
  v_mul_f32 v75, s52, v75
  v_cvt_pk_bf16_f32 v73, v74, v75
  v_mfma_f32_32x32x16_bf16 v[48:63], v[16:19], v[200:203], v[48:63]
  v_mul_f32 v76, s52, v76
  v_mul_f32 v77, s52, v77
  ds_read_b128 v[16:19], v8 offset:33024
  s_waitcnt lgkmcnt(3)
  v_mfma_f32_32x32x16_bf16 v[32:47], v[20:23], v[140:143], v[32:47]
  v_cvt_pk_bf16_f32 v74, v76, v77
  v_mul_f32 v78, s52, v78
  v_mul_f32 v79, s52, v79
  v_mfma_f32_32x32x16_bf16 v[48:63], v[20:23], v[204:207], v[48:63]
  v_cvt_pk_bf16_f32 v75, v78, v79
  v_permlane16_swap_b32 v64, v72
  ds_read_b128 v[20:23], v9 offset:33024
  s_waitcnt lgkmcnt(3)
  v_mfma_f32_32x32x16_bf16 v[32:47], v[24:27], v[144:147], v[32:47]
  v_permlane16_swap_b32 v65, v73
  v_permlane16_swap_b32 v66, v74
  v_permlane16_swap_b32 v67, v75
  v_mfma_f32_32x32x16_bf16 v[48:63], v[24:27], v[208:211], v[48:63]
  v_accvgpr_write_b32 a4, v64
  v_accvgpr_write_b32 a5, v65
  ds_read_b128 v[24:27], v10 offset:33024
  s_waitcnt lgkmcnt(3)
  v_mfma_f32_32x32x16_bf16 v[32:47], v[28:31], v[148:151], v[32:47]
  v_accvgpr_write_b32 a6, v66
  v_accvgpr_write_b32 a7, v67
  v_accvgpr_write_b32 a60, v72
  v_mfma_f32_32x32x16_bf16 v[48:63], v[28:31], v[212:215], v[48:63]
  v_accvgpr_write_b32 a61, v73
  v_accvgpr_write_b32 a62, v74
  ds_read_b128 v[28:31], v11 offset:33024
  s_waitcnt lgkmcnt(3)
  v_mfma_f32_32x32x16_bf16 v[32:47], v[16:19], v[152:155], v[32:47]
  v_accvgpr_write_b32 a63, v75
  v_mul_f32 v80, s52, v80
  v_mul_f32 v81, s52, v81
  v_mfma_f32_32x32x16_bf16 v[48:63], v[16:19], v[216:219], v[48:63]
  v_cvt_pk_bf16_f32 v80, v80, v81
  v_mul_f32 v82, s52, v82
  ds_read_b128 v[16:19], v12 offset:33024
  s_waitcnt lgkmcnt(3)
  v_mfma_f32_32x32x16_bf16 v[32:47], v[20:23], v[156:159], v[32:47]
  v_mul_f32 v83, s52, v83
  v_cvt_pk_bf16_f32 v81, v82, v83
  v_mul_f32 v84, s52, v84
  v_mfma_f32_32x32x16_bf16 v[48:63], v[20:23], v[220:223], v[48:63]
  v_mul_f32 v85, s52, v85
  v_cvt_pk_bf16_f32 v82, v84, v85
  ds_read_b128 v[20:23], v13 offset:33024
  s_waitcnt lgkmcnt(3)
  v_mfma_f32_32x32x16_bf16 v[32:47], v[24:27], v[160:163], v[32:47]
  v_mul_f32 v86, s52, v86
  v_mul_f32 v87, s52, v87
  v_cvt_pk_bf16_f32 v83, v86, v87
  v_mfma_f32_32x32x16_bf16 v[48:63], v[24:27], v[224:227], v[48:63]
  v_mul_f32 v88, s52, v88
  v_mul_f32 v89, s52, v89
  ds_read_b128 v[24:27], v14 offset:33024
  s_waitcnt lgkmcnt(3)
  v_mfma_f32_32x32x16_bf16 v[32:47], v[28:31], v[164:167], v[32:47]
  v_cvt_pk_bf16_f32 v88, v88, v89
  v_mul_f32 v90, s52, v90
  v_mul_f32 v91, s52, v91
  v_mfma_f32_32x32x16_bf16 v[48:63], v[28:31], v[228:231], v[48:63]
  v_cvt_pk_bf16_f32 v89, v90, v91
  v_mul_f32 v92, s52, v92
  ds_read_b128 v[28:31], v15 offset:33024
  s_waitcnt lgkmcnt(3)
  v_mfma_f32_32x32x16_bf16 v[32:47], v[16:19], v[168:171], v[32:47]
  v_mul_f32 v93, s52, v93
  v_cvt_pk_bf16_f32 v90, v92, v93
  v_mul_f32 v94, s52, v94
  v_mfma_f32_32x32x16_bf16 v[48:63], v[16:19], v[232:235], v[48:63]
  v_mul_f32 v95, s52, v95
  v_cvt_pk_bf16_f32 v91, v94, v95
  ds_read_b128 v[16:19], v8 offset:49152
  s_waitcnt lgkmcnt(3)
  v_mfma_f32_32x32x16_bf16 v[32:47], v[20:23], v[172:175], v[32:47]
  v_permlane16_swap_b32 v80, v88
  v_permlane16_swap_b32 v81, v89
  v_permlane16_swap_b32 v82, v90
  v_mfma_f32_32x32x16_bf16 v[48:63], v[20:23], v[236:239], v[48:63]
  v_permlane16_swap_b32 v83, v91
  v_accvgpr_write_b32 a116, v80
  ds_read_b128 v[20:23], v9 offset:49152
  s_waitcnt lgkmcnt(3)
  v_mfma_f32_32x32x16_bf16 v[32:47], v[24:27], v[176:179], v[32:47]
  v_accvgpr_write_b32 a117, v81
  v_accvgpr_write_b32 a118, v82
  v_accvgpr_write_b32 a119, v83
  v_mfma_f32_32x32x16_bf16 v[48:63], v[24:27], v[240:243], v[48:63]
  v_accvgpr_write_b32 a172, v88
  v_accvgpr_write_b32 a173, v89
  ds_read_b128 v[24:27], v10 offset:49152
  s_waitcnt lgkmcnt(3)
  v_mfma_f32_32x32x16_bf16 v[32:47], v[28:31], v[180:183], v[32:47]
  v_accvgpr_write_b32 a174, v90
  v_accvgpr_write_b32 a175, v91
  v_mfma_f32_32x32x16_bf16 v[48:63], v[28:31], v[244:247], v[48:63]
  s_waitcnt vmcnt(16)
  s_barrier
  ds_read_b128 v[28:31], v11 offset:49152
  s_waitcnt lgkmcnt(3)
  v_mfma_f32_32x32x16_bf16 v[64:79], v[16:19], v[120:123], 0
  s_add_u32 s22, s27, 2621440
  s_add_u32 m0, s25, 16384
  s_nop 0
  buffer_load_dwordx4 v4, s[56:59], s22 offen offset:0 lds
  v_mfma_f32_32x32x16_bf16 v[80:95], v[16:19], v[184:187], 0
  ds_read_b128 v[16:19], v12 offset:49152
  s_waitcnt lgkmcnt(3)
  v_mfma_f32_32x32x16_bf16 v[64:79], v[20:23], v[124:127], v[64:79]
  buffer_load_dwordx4 v5, s[56:59], s22 offen offset:1024 lds
  v_mul_f32 v32, s52, v32
  v_mul_f32 v33, s52, v33
  v_cvt_pk_bf16_f32 v32, v32, v33
  v_mfma_f32_32x32x16_bf16 v[80:95], v[20:23], v[188:191], v[80:95]
  v_mul_f32 v34, s52, v34
  v_mul_f32 v35, s52, v35
  ds_read_b128 v[20:23], v13 offset:49152
  s_waitcnt lgkmcnt(3)
  v_mfma_f32_32x32x16_bf16 v[64:79], v[24:27], v[128:131], v[64:79]
  buffer_load_dwordx4 v6, s[56:59], s22 offen offset:2048 lds
  v_cvt_pk_bf16_f32 v33, v34, v35
  v_mul_f32 v36, s52, v36
  v_mul_f32 v37, s52, v37
  v_mfma_f32_32x32x16_bf16 v[80:95], v[24:27], v[192:195], v[80:95]
  v_cvt_pk_bf16_f32 v34, v36, v37
  v_mul_f32 v38, s52, v38
  ds_read_b128 v[24:27], v14 offset:49152
  s_waitcnt lgkmcnt(3)
  v_mfma_f32_32x32x16_bf16 v[64:79], v[28:31], v[132:135], v[64:79]
  buffer_load_dwordx4 v7, s[56:59], s22 offen offset:3072 lds
  v_mul_f32 v39, s52, v39
  v_cvt_pk_bf16_f32 v35, v38, v39
  v_mul_f32 v40, s52, v40
  v_mfma_f32_32x32x16_bf16 v[80:95], v[28:31], v[196:199], v[80:95]
  v_mul_f32 v41, s52, v41
  v_cvt_pk_bf16_f32 v40, v40, v41
  ds_read_b128 v[28:31], v15 offset:49152
  s_waitcnt lgkmcnt(3)
  v_mfma_f32_32x32x16_bf16 v[64:79], v[16:19], v[136:139], v[64:79]
  s_add_u32 s22, s27, 2883584
  s_add_u32 m0, s25, 32768
  s_nop 0
  buffer_load_dwordx4 v4, s[56:59], s22 offen offset:0 lds
  v_mul_f32 v42, s52, v42
  v_mul_f32 v43, s52, v43
  v_cvt_pk_bf16_f32 v41, v42, v43
  v_mfma_f32_32x32x16_bf16 v[80:95], v[16:19], v[200:203], v[80:95]
  v_mul_f32 v44, s52, v44
  v_mul_f32 v45, s52, v45
  ds_read_b128 v[16:19], v8 offset:49408
  s_waitcnt lgkmcnt(3)
  v_mfma_f32_32x32x16_bf16 v[64:79], v[20:23], v[140:143], v[64:79]
  buffer_load_dwordx4 v5, s[56:59], s22 offen offset:1024 lds
  v_cvt_pk_bf16_f32 v42, v44, v45
  v_mul_f32 v46, s52, v46
  v_mul_f32 v47, s52, v47
  v_mfma_f32_32x32x16_bf16 v[80:95], v[20:23], v[204:207], v[80:95]
  v_cvt_pk_bf16_f32 v43, v46, v47
  v_permlane16_swap_b32 v32, v40
  ds_read_b128 v[20:23], v9 offset:49408
  s_waitcnt lgkmcnt(3)
  v_mfma_f32_32x32x16_bf16 v[64:79], v[24:27], v[144:147], v[64:79]
  buffer_load_dwordx4 v6, s[56:59], s22 offen offset:2048 lds
  v_permlane16_swap_b32 v33, v41
  v_permlane16_swap_b32 v34, v42
  v_permlane16_swap_b32 v35, v43
  v_mfma_f32_32x32x16_bf16 v[80:95], v[24:27], v[208:211], v[80:95]
  v_accvgpr_write_b32 a8, v32
  v_accvgpr_write_b32 a9, v33
  ds_read_b128 v[24:27], v10 offset:49408
  s_waitcnt lgkmcnt(3)
  v_mfma_f32_32x32x16_bf16 v[64:79], v[28:31], v[148:151], v[64:79]
  buffer_load_dwordx4 v7, s[56:59], s22 offen offset:3072 lds
  v_accvgpr_write_b32 a10, v34
  v_accvgpr_write_b32 a11, v35
  v_accvgpr_write_b32 a64, v40
  v_mfma_f32_32x32x16_bf16 v[80:95], v[28:31], v[212:215], v[80:95]
  v_accvgpr_write_b32 a65, v41
  v_accvgpr_write_b32 a66, v42
  ds_read_b128 v[28:31], v11 offset:49408
  s_waitcnt lgkmcnt(3)
  v_mfma_f32_32x32x16_bf16 v[64:79], v[16:19], v[152:155], v[64:79]
  v_accvgpr_write_b32 a67, v43
  v_mul_f32 v48, s52, v48
  v_mul_f32 v49, s52, v49
  v_mfma_f32_32x32x16_bf16 v[80:95], v[16:19], v[216:219], v[80:95]
  v_cvt_pk_bf16_f32 v48, v48, v49
  v_mul_f32 v50, s52, v50
  ds_read_b128 v[16:19], v12 offset:49408
  s_waitcnt lgkmcnt(3)
  v_mfma_f32_32x32x16_bf16 v[64:79], v[20:23], v[156:159], v[64:79]
  v_mul_f32 v51, s52, v51
  v_cvt_pk_bf16_f32 v49, v50, v51
  v_mul_f32 v52, s52, v52
  v_mfma_f32_32x32x16_bf16 v[80:95], v[20:23], v[220:223], v[80:95]
  v_mul_f32 v53, s52, v53
  v_cvt_pk_bf16_f32 v50, v52, v53
  ds_read_b128 v[20:23], v13 offset:49408
  s_waitcnt lgkmcnt(3)
  v_mfma_f32_32x32x16_bf16 v[64:79], v[24:27], v[160:163], v[64:79]
  v_mul_f32 v54, s52, v54
  v_mul_f32 v55, s52, v55
  v_cvt_pk_bf16_f32 v51, v54, v55
  v_mfma_f32_32x32x16_bf16 v[80:95], v[24:27], v[224:227], v[80:95]
  v_mul_f32 v56, s52, v56
  v_mul_f32 v57, s52, v57
  ds_read_b128 v[24:27], v14 offset:49408
  s_waitcnt lgkmcnt(3)
  v_mfma_f32_32x32x16_bf16 v[64:79], v[28:31], v[164:167], v[64:79]
  v_cvt_pk_bf16_f32 v56, v56, v57
  v_mul_f32 v58, s52, v58
  v_mul_f32 v59, s52, v59
  v_mfma_f32_32x32x16_bf16 v[80:95], v[28:31], v[228:231], v[80:95]
  v_cvt_pk_bf16_f32 v57, v58, v59
  v_mul_f32 v60, s52, v60
  ds_read_b128 v[28:31], v15 offset:49408
  s_waitcnt lgkmcnt(3)
  v_mfma_f32_32x32x16_bf16 v[64:79], v[16:19], v[168:171], v[64:79]
  v_mul_f32 v61, s52, v61
  v_cvt_pk_bf16_f32 v58, v60, v61
  v_mul_f32 v62, s52, v62
  v_mfma_f32_32x32x16_bf16 v[80:95], v[16:19], v[232:235], v[80:95]
  v_mul_f32 v63, s52, v63
  v_cvt_pk_bf16_f32 v59, v62, v63
  v_xor_b32 v8, 65536, v8
  ds_read_b128 v[16:19], v8 offset:0
  s_waitcnt lgkmcnt(3)
  v_mfma_f32_32x32x16_bf16 v[64:79], v[20:23], v[172:175], v[64:79]
  v_permlane16_swap_b32 v48, v56
  v_permlane16_swap_b32 v49, v57
  v_permlane16_swap_b32 v50, v58
  v_mfma_f32_32x32x16_bf16 v[80:95], v[20:23], v[236:239], v[80:95]
  v_permlane16_swap_b32 v51, v59
  v_accvgpr_write_b32 a120, v48
  v_xor_b32 v9, 65536, v9
  ds_read_b128 v[20:23], v9 offset:0
  s_waitcnt lgkmcnt(3)
  v_mfma_f32_32x32x16_bf16 v[64:79], v[24:27], v[176:179], v[64:79]
  v_accvgpr_write_b32 a121, v49
  v_accvgpr_write_b32 a122, v50
  v_accvgpr_write_b32 a123, v51
  v_mfma_f32_32x32x16_bf16 v[80:95], v[24:27], v[240:243], v[80:95]
  v_accvgpr_write_b32 a176, v56
  v_accvgpr_write_b32 a177, v57
  v_xor_b32 v10, 65536, v10
  ds_read_b128 v[24:27], v10 offset:0
  s_waitcnt lgkmcnt(3)
  v_mfma_f32_32x32x16_bf16 v[64:79], v[28:31], v[180:183], v[64:79]
  v_accvgpr_write_b32 a178, v58
  v_accvgpr_write_b32 a179, v59
  v_mfma_f32_32x32x16_bf16 v[80:95], v[28:31], v[244:247], v[80:95]
  v_xor_b32 v11, 65536, v11
  ds_read_b128 v[28:31], v11 offset:0
  s_waitcnt lgkmcnt(3)
  v_mfma_f32_32x32x16_bf16 v[32:47], v[16:19], v[120:123], 0
  v_mfma_f32_32x32x16_bf16 v[48:63], v[16:19], v[184:187], 0
  v_xor_b32 v12, 65536, v12
  ds_read_b128 v[16:19], v12 offset:0
  s_waitcnt lgkmcnt(3)
  v_mfma_f32_32x32x16_bf16 v[32:47], v[20:23], v[124:127], v[32:47]
  v_mul_f32 v64, s52, v64
  v_mul_f32 v65, s52, v65
  v_cvt_pk_bf16_f32 v64, v64, v65
  v_mfma_f32_32x32x16_bf16 v[48:63], v[20:23], v[188:191], v[48:63]
  v_mul_f32 v66, s52, v66
  v_mul_f32 v67, s52, v67
  v_xor_b32 v13, 65536, v13
  ds_read_b128 v[20:23], v13 offset:0
  s_waitcnt lgkmcnt(3)
  v_mfma_f32_32x32x16_bf16 v[32:47], v[24:27], v[128:131], v[32:47]
  v_cvt_pk_bf16_f32 v65, v66, v67
  v_mul_f32 v68, s52, v68
  v_mul_f32 v69, s52, v69
  v_mfma_f32_32x32x16_bf16 v[48:63], v[24:27], v[192:195], v[48:63]
  v_cvt_pk_bf16_f32 v66, v68, v69
  v_mul_f32 v70, s52, v70
  v_xor_b32 v14, 65536, v14
  ds_read_b128 v[24:27], v14 offset:0
  s_waitcnt lgkmcnt(3)
  v_mfma_f32_32x32x16_bf16 v[32:47], v[28:31], v[132:135], v[32:47]
  v_mul_f32 v71, s52, v71
  v_cvt_pk_bf16_f32 v67, v70, v71
  v_mul_f32 v72, s52, v72
  v_mfma_f32_32x32x16_bf16 v[48:63], v[28:31], v[196:199], v[48:63]
  v_mul_f32 v73, s52, v73
  v_cvt_pk_bf16_f32 v72, v72, v73
  v_xor_b32 v15, 65536, v15
  ds_read_b128 v[28:31], v15 offset:0
  s_waitcnt lgkmcnt(3)
  v_mfma_f32_32x32x16_bf16 v[32:47], v[16:19], v[136:139], v[32:47]
  v_mul_f32 v74, s52, v74
  v_mul_f32 v75, s52, v75
  v_cvt_pk_bf16_f32 v73, v74, v75
  v_mfma_f32_32x32x16_bf16 v[48:63], v[16:19], v[200:203], v[48:63]
  v_mul_f32 v76, s52, v76
  v_mul_f32 v77, s52, v77
  ds_read_b128 v[16:19], v8 offset:256
  s_waitcnt lgkmcnt(3)
  v_mfma_f32_32x32x16_bf16 v[32:47], v[20:23], v[140:143], v[32:47]
  v_cvt_pk_bf16_f32 v74, v76, v77
  v_mul_f32 v78, s52, v78
  v_mul_f32 v79, s52, v79
  v_mfma_f32_32x32x16_bf16 v[48:63], v[20:23], v[204:207], v[48:63]
  v_cvt_pk_bf16_f32 v75, v78, v79
  v_permlane16_swap_b32 v64, v72
  ds_read_b128 v[20:23], v9 offset:256
  s_waitcnt lgkmcnt(3)
  v_mfma_f32_32x32x16_bf16 v[32:47], v[24:27], v[144:147], v[32:47]
  v_permlane16_swap_b32 v65, v73
  v_permlane16_swap_b32 v66, v74
  v_permlane16_swap_b32 v67, v75
  v_mfma_f32_32x32x16_bf16 v[48:63], v[24:27], v[208:211], v[48:63]
  v_accvgpr_write_b32 a12, v64
  v_accvgpr_write_b32 a13, v65
  ds_read_b128 v[24:27], v10 offset:256
  s_waitcnt lgkmcnt(3)
  v_mfma_f32_32x32x16_bf16 v[32:47], v[28:31], v[148:151], v[32:47]
  v_accvgpr_write_b32 a14, v66
  v_accvgpr_write_b32 a15, v67
  v_accvgpr_write_b32 a68, v72
  v_mfma_f32_32x32x16_bf16 v[48:63], v[28:31], v[212:215], v[48:63]
  v_accvgpr_write_b32 a69, v73
  v_accvgpr_write_b32 a70, v74
  ds_read_b128 v[28:31], v11 offset:256
  s_waitcnt lgkmcnt(3)
  v_mfma_f32_32x32x16_bf16 v[32:47], v[16:19], v[152:155], v[32:47]
  v_accvgpr_write_b32 a71, v75
  v_mul_f32 v80, s52, v80
  v_mul_f32 v81, s52, v81
  v_mfma_f32_32x32x16_bf16 v[48:63], v[16:19], v[216:219], v[48:63]
  v_cvt_pk_bf16_f32 v80, v80, v81
  v_mul_f32 v82, s52, v82
  ds_read_b128 v[16:19], v12 offset:256
  s_waitcnt lgkmcnt(3)
  v_mfma_f32_32x32x16_bf16 v[32:47], v[20:23], v[156:159], v[32:47]
  v_mul_f32 v83, s52, v83
  v_cvt_pk_bf16_f32 v81, v82, v83
  v_mul_f32 v84, s52, v84
  v_mfma_f32_32x32x16_bf16 v[48:63], v[20:23], v[220:223], v[48:63]
  v_mul_f32 v85, s52, v85
  v_cvt_pk_bf16_f32 v82, v84, v85
  ds_read_b128 v[20:23], v13 offset:256
  s_waitcnt lgkmcnt(3)
  v_mfma_f32_32x32x16_bf16 v[32:47], v[24:27], v[160:163], v[32:47]
  v_mul_f32 v86, s52, v86
  v_mul_f32 v87, s52, v87
  v_cvt_pk_bf16_f32 v83, v86, v87
  v_mfma_f32_32x32x16_bf16 v[48:63], v[24:27], v[224:227], v[48:63]
  v_mul_f32 v88, s52, v88
  v_mul_f32 v89, s52, v89
  ds_read_b128 v[24:27], v14 offset:256
  s_waitcnt lgkmcnt(3)
  v_mfma_f32_32x32x16_bf16 v[32:47], v[28:31], v[164:167], v[32:47]
  v_cvt_pk_bf16_f32 v88, v88, v89
  v_mul_f32 v90, s52, v90
  v_mul_f32 v91, s52, v91
  v_mfma_f32_32x32x16_bf16 v[48:63], v[28:31], v[228:231], v[48:63]
  v_cvt_pk_bf16_f32 v89, v90, v91
  v_mul_f32 v92, s52, v92
  ds_read_b128 v[28:31], v15 offset:256
  s_waitcnt lgkmcnt(3)
  v_mfma_f32_32x32x16_bf16 v[32:47], v[16:19], v[168:171], v[32:47]
  v_mul_f32 v93, s52, v93
  v_cvt_pk_bf16_f32 v90, v92, v93
  v_mul_f32 v94, s52, v94
  v_mfma_f32_32x32x16_bf16 v[48:63], v[16:19], v[232:235], v[48:63]
  v_mul_f32 v95, s52, v95
  v_cvt_pk_bf16_f32 v91, v94, v95
  ds_read_b128 v[16:19], v8 offset:16384
  s_waitcnt lgkmcnt(3)
  v_mfma_f32_32x32x16_bf16 v[32:47], v[20:23], v[172:175], v[32:47]
  v_permlane16_swap_b32 v80, v88
  v_permlane16_swap_b32 v81, v89
  v_permlane16_swap_b32 v82, v90
  v_mfma_f32_32x32x16_bf16 v[48:63], v[20:23], v[236:239], v[48:63]
  v_permlane16_swap_b32 v83, v91
  v_accvgpr_write_b32 a124, v80
  ds_read_b128 v[20:23], v9 offset:16384
  s_waitcnt lgkmcnt(3)
  v_mfma_f32_32x32x16_bf16 v[32:47], v[24:27], v[176:179], v[32:47]
  v_accvgpr_write_b32 a125, v81
  v_accvgpr_write_b32 a126, v82
  v_accvgpr_write_b32 a127, v83
  v_mfma_f32_32x32x16_bf16 v[48:63], v[24:27], v[240:243], v[48:63]
  v_accvgpr_write_b32 a180, v88
  v_accvgpr_write_b32 a181, v89
  ds_read_b128 v[24:27], v10 offset:16384
  s_waitcnt lgkmcnt(3)
  v_mfma_f32_32x32x16_bf16 v[32:47], v[28:31], v[180:183], v[32:47]
  v_accvgpr_write_b32 a182, v90
  v_accvgpr_write_b32 a183, v91
  v_mfma_f32_32x32x16_bf16 v[48:63], v[28:31], v[244:247], v[48:63]
  s_waitcnt vmcnt(16)
  s_barrier
  ds_read_b128 v[28:31], v11 offset:16384
  s_waitcnt lgkmcnt(3)
  v_mfma_f32_32x32x16_bf16 v[64:79], v[16:19], v[120:123], 0
  s_add_u32 s22, s27, 3145728
  s_add_u32 m0, s25, 49152
  s_nop 0
  buffer_load_dwordx4 v4, s[56:59], s22 offen offset:0 lds
  v_mfma_f32_32x32x16_bf16 v[80:95], v[16:19], v[184:187], 0
  ds_read_b128 v[16:19], v12 offset:16384
  s_waitcnt lgkmcnt(3)
  v_mfma_f32_32x32x16_bf16 v[64:79], v[20:23], v[124:127], v[64:79]
  buffer_load_dwordx4 v5, s[56:59], s22 offen offset:1024 lds
  v_mul_f32 v32, s52, v32
  v_mul_f32 v33, s52, v33
  v_cvt_pk_bf16_f32 v32, v32, v33
  v_mfma_f32_32x32x16_bf16 v[80:95], v[20:23], v[188:191], v[80:95]
  v_mul_f32 v34, s52, v34
  v_mul_f32 v35, s52, v35
  ds_read_b128 v[20:23], v13 offset:16384
  s_waitcnt lgkmcnt(3)
  v_mfma_f32_32x32x16_bf16 v[64:79], v[24:27], v[128:131], v[64:79]
  buffer_load_dwordx4 v6, s[56:59], s22 offen offset:2048 lds
  v_cvt_pk_bf16_f32 v33, v34, v35
  v_mul_f32 v36, s52, v36
  v_mul_f32 v37, s52, v37
  v_mfma_f32_32x32x16_bf16 v[80:95], v[24:27], v[192:195], v[80:95]
  v_cvt_pk_bf16_f32 v34, v36, v37
  v_mul_f32 v38, s52, v38
  ds_read_b128 v[24:27], v14 offset:16384
  s_waitcnt lgkmcnt(3)
  v_mfma_f32_32x32x16_bf16 v[64:79], v[28:31], v[132:135], v[64:79]
  buffer_load_dwordx4 v7, s[56:59], s22 offen offset:3072 lds
  v_mul_f32 v39, s52, v39
  v_cvt_pk_bf16_f32 v35, v38, v39
  v_mul_f32 v40, s52, v40
  v_mfma_f32_32x32x16_bf16 v[80:95], v[28:31], v[196:199], v[80:95]
  v_mul_f32 v41, s52, v41
  v_cvt_pk_bf16_f32 v40, v40, v41
  ds_read_b128 v[28:31], v15 offset:16384
  s_waitcnt lgkmcnt(3)
  v_mfma_f32_32x32x16_bf16 v[64:79], v[16:19], v[136:139], v[64:79]
  s_add_u32 s22, s27, 3407872
  s_add_u32 m0, s25, 65536
  s_nop 0
  buffer_load_dwordx4 v4, s[56:59], s22 offen offset:0 lds
  v_mul_f32 v42, s52, v42
  v_mul_f32 v43, s52, v43
  v_cvt_pk_bf16_f32 v41, v42, v43
  v_mfma_f32_32x32x16_bf16 v[80:95], v[16:19], v[200:203], v[80:95]
  v_mul_f32 v44, s52, v44
  v_mul_f32 v45, s52, v45
  ds_read_b128 v[16:19], v8 offset:16640
  s_waitcnt lgkmcnt(3)
  v_mfma_f32_32x32x16_bf16 v[64:79], v[20:23], v[140:143], v[64:79]
  buffer_load_dwordx4 v5, s[56:59], s22 offen offset:1024 lds
  v_cvt_pk_bf16_f32 v42, v44, v45
  v_mul_f32 v46, s52, v46
  v_mul_f32 v47, s52, v47
  v_mfma_f32_32x32x16_bf16 v[80:95], v[20:23], v[204:207], v[80:95]
  v_cvt_pk_bf16_f32 v43, v46, v47
  v_permlane16_swap_b32 v32, v40
  ds_read_b128 v[20:23], v9 offset:16640
  s_waitcnt lgkmcnt(3)
  v_mfma_f32_32x32x16_bf16 v[64:79], v[24:27], v[144:147], v[64:79]
  buffer_load_dwordx4 v6, s[56:59], s22 offen offset:2048 lds
  v_permlane16_swap_b32 v33, v41
  v_permlane16_swap_b32 v34, v42
  v_permlane16_swap_b32 v35, v43
  v_mfma_f32_32x32x16_bf16 v[80:95], v[24:27], v[208:211], v[80:95]
  v_accvgpr_write_b32 a16, v32
  v_accvgpr_write_b32 a17, v33
  ds_read_b128 v[24:27], v10 offset:16640
  s_waitcnt lgkmcnt(3)
  v_mfma_f32_32x32x16_bf16 v[64:79], v[28:31], v[148:151], v[64:79]
  buffer_load_dwordx4 v7, s[56:59], s22 offen offset:3072 lds
  v_accvgpr_write_b32 a18, v34
  v_accvgpr_write_b32 a19, v35
  v_accvgpr_write_b32 a72, v40
  v_mfma_f32_32x32x16_bf16 v[80:95], v[28:31], v[212:215], v[80:95]
  v_accvgpr_write_b32 a73, v41
  v_accvgpr_write_b32 a74, v42
  ds_read_b128 v[28:31], v11 offset:16640
  s_waitcnt lgkmcnt(3)
  v_mfma_f32_32x32x16_bf16 v[64:79], v[16:19], v[152:155], v[64:79]
  v_accvgpr_write_b32 a75, v43
  v_mul_f32 v48, s52, v48
  v_mul_f32 v49, s52, v49
  v_mfma_f32_32x32x16_bf16 v[80:95], v[16:19], v[216:219], v[80:95]
  v_cvt_pk_bf16_f32 v48, v48, v49
  v_mul_f32 v50, s52, v50
  ds_read_b128 v[16:19], v12 offset:16640
  s_waitcnt lgkmcnt(3)
  v_mfma_f32_32x32x16_bf16 v[64:79], v[20:23], v[156:159], v[64:79]
  v_mul_f32 v51, s52, v51
  v_cvt_pk_bf16_f32 v49, v50, v51
  v_mul_f32 v52, s52, v52
  v_mfma_f32_32x32x16_bf16 v[80:95], v[20:23], v[220:223], v[80:95]
  v_mul_f32 v53, s52, v53
  v_cvt_pk_bf16_f32 v50, v52, v53
  ds_read_b128 v[20:23], v13 offset:16640
  s_waitcnt lgkmcnt(3)
  v_mfma_f32_32x32x16_bf16 v[64:79], v[24:27], v[160:163], v[64:79]
  v_mul_f32 v54, s52, v54
  v_mul_f32 v55, s52, v55
  v_cvt_pk_bf16_f32 v51, v54, v55
  v_mfma_f32_32x32x16_bf16 v[80:95], v[24:27], v[224:227], v[80:95]
  v_mul_f32 v56, s52, v56
  v_mul_f32 v57, s52, v57
  ds_read_b128 v[24:27], v14 offset:16640
  s_waitcnt lgkmcnt(3)
  v_mfma_f32_32x32x16_bf16 v[64:79], v[28:31], v[164:167], v[64:79]
  v_cvt_pk_bf16_f32 v56, v56, v57
  v_mul_f32 v58, s52, v58
  v_mul_f32 v59, s52, v59
  v_mfma_f32_32x32x16_bf16 v[80:95], v[28:31], v[228:231], v[80:95]
  v_cvt_pk_bf16_f32 v57, v58, v59
  v_mul_f32 v60, s52, v60
  ds_read_b128 v[28:31], v15 offset:16640
  s_waitcnt lgkmcnt(3)
  v_mfma_f32_32x32x16_bf16 v[64:79], v[16:19], v[168:171], v[64:79]
  v_mul_f32 v61, s52, v61
  v_cvt_pk_bf16_f32 v58, v60, v61
  v_mul_f32 v62, s52, v62
  v_mfma_f32_32x32x16_bf16 v[80:95], v[16:19], v[232:235], v[80:95]
  v_mul_f32 v63, s52, v63
  v_cvt_pk_bf16_f32 v59, v62, v63
  ds_read_b128 v[16:19], v8 offset:32768
  s_waitcnt lgkmcnt(3)
  v_mfma_f32_32x32x16_bf16 v[64:79], v[20:23], v[172:175], v[64:79]
  v_permlane16_swap_b32 v48, v56
  v_permlane16_swap_b32 v49, v57
  v_permlane16_swap_b32 v50, v58
  v_mfma_f32_32x32x16_bf16 v[80:95], v[20:23], v[236:239], v[80:95]
  v_permlane16_swap_b32 v51, v59
  v_accvgpr_write_b32 a128, v48
  ds_read_b128 v[20:23], v9 offset:32768
  s_waitcnt lgkmcnt(3)
  v_mfma_f32_32x32x16_bf16 v[64:79], v[24:27], v[176:179], v[64:79]
  v_accvgpr_write_b32 a129, v49
  v_accvgpr_write_b32 a130, v50
  v_accvgpr_write_b32 a131, v51
  v_mfma_f32_32x32x16_bf16 v[80:95], v[24:27], v[240:243], v[80:95]
  v_accvgpr_write_b32 a184, v56
  v_accvgpr_write_b32 a185, v57
  ds_read_b128 v[24:27], v10 offset:32768
  s_waitcnt lgkmcnt(3)
  v_mfma_f32_32x32x16_bf16 v[64:79], v[28:31], v[180:183], v[64:79]
  v_accvgpr_write_b32 a186, v58
  v_accvgpr_write_b32 a187, v59
  v_mfma_f32_32x32x16_bf16 v[80:95], v[28:31], v[244:247], v[80:95]
  ds_read_b128 v[28:31], v11 offset:32768
  s_waitcnt lgkmcnt(3)
  v_mfma_f32_32x32x16_bf16 v[32:47], v[16:19], v[120:123], 0
  v_mfma_f32_32x32x16_bf16 v[48:63], v[16:19], v[184:187], 0
  ds_read_b128 v[16:19], v12 offset:32768
  s_waitcnt lgkmcnt(3)
  v_mfma_f32_32x32x16_bf16 v[32:47], v[20:23], v[124:127], v[32:47]
  v_mul_f32 v64, s52, v64
  v_mul_f32 v65, s52, v65
  v_cvt_pk_bf16_f32 v64, v64, v65
  v_mfma_f32_32x32x16_bf16 v[48:63], v[20:23], v[188:191], v[48:63]
  v_mul_f32 v66, s52, v66
  v_mul_f32 v67, s52, v67
  ds_read_b128 v[20:23], v13 offset:32768
  s_waitcnt lgkmcnt(3)
  v_mfma_f32_32x32x16_bf16 v[32:47], v[24:27], v[128:131], v[32:47]
  v_cvt_pk_bf16_f32 v65, v66, v67
  v_mul_f32 v68, s52, v68
  v_mul_f32 v69, s52, v69
  v_mfma_f32_32x32x16_bf16 v[48:63], v[24:27], v[192:195], v[48:63]
  v_cvt_pk_bf16_f32 v66, v68, v69
  v_mul_f32 v70, s52, v70
  ds_read_b128 v[24:27], v14 offset:32768
  s_waitcnt lgkmcnt(3)
  v_mfma_f32_32x32x16_bf16 v[32:47], v[28:31], v[132:135], v[32:47]
  v_mul_f32 v71, s52, v71
  v_cvt_pk_bf16_f32 v67, v70, v71
  v_mul_f32 v72, s52, v72
  v_mfma_f32_32x32x16_bf16 v[48:63], v[28:31], v[196:199], v[48:63]
  v_mul_f32 v73, s52, v73
  v_cvt_pk_bf16_f32 v72, v72, v73
  ds_read_b128 v[28:31], v15 offset:32768
  s_waitcnt lgkmcnt(3)
  v_mfma_f32_32x32x16_bf16 v[32:47], v[16:19], v[136:139], v[32:47]
  v_mul_f32 v74, s52, v74
  v_mul_f32 v75, s52, v75
  v_cvt_pk_bf16_f32 v73, v74, v75
  v_mfma_f32_32x32x16_bf16 v[48:63], v[16:19], v[200:203], v[48:63]
  v_mul_f32 v76, s52, v76
  v_mul_f32 v77, s52, v77
  ds_read_b128 v[16:19], v8 offset:33024
  s_waitcnt lgkmcnt(3)
  v_mfma_f32_32x32x16_bf16 v[32:47], v[20:23], v[140:143], v[32:47]
  v_cvt_pk_bf16_f32 v74, v76, v77
  v_mul_f32 v78, s52, v78
  v_mul_f32 v79, s52, v79
  v_mfma_f32_32x32x16_bf16 v[48:63], v[20:23], v[204:207], v[48:63]
  v_cvt_pk_bf16_f32 v75, v78, v79
  v_permlane16_swap_b32 v64, v72
  ds_read_b128 v[20:23], v9 offset:33024
  s_waitcnt lgkmcnt(3)
  v_mfma_f32_32x32x16_bf16 v[32:47], v[24:27], v[144:147], v[32:47]
  v_permlane16_swap_b32 v65, v73
  v_permlane16_swap_b32 v66, v74
  v_permlane16_swap_b32 v67, v75
  v_mfma_f32_32x32x16_bf16 v[48:63], v[24:27], v[208:211], v[48:63]
  v_accvgpr_write_b32 a20, v64
  v_accvgpr_write_b32 a21, v65
  ds_read_b128 v[24:27], v10 offset:33024
  s_waitcnt lgkmcnt(3)
  v_mfma_f32_32x32x16_bf16 v[32:47], v[28:31], v[148:151], v[32:47]
  v_accvgpr_write_b32 a22, v66
  v_accvgpr_write_b32 a23, v67
  v_accvgpr_write_b32 a76, v72
  v_mfma_f32_32x32x16_bf16 v[48:63], v[28:31], v[212:215], v[48:63]
  v_accvgpr_write_b32 a77, v73
  v_accvgpr_write_b32 a78, v74
  ds_read_b128 v[28:31], v11 offset:33024
  s_waitcnt lgkmcnt(3)
  v_mfma_f32_32x32x16_bf16 v[32:47], v[16:19], v[152:155], v[32:47]
  v_accvgpr_write_b32 a79, v75
  v_mul_f32 v80, s52, v80
  v_mul_f32 v81, s52, v81
  v_mfma_f32_32x32x16_bf16 v[48:63], v[16:19], v[216:219], v[48:63]
  v_cvt_pk_bf16_f32 v80, v80, v81
  v_mul_f32 v82, s52, v82
  ds_read_b128 v[16:19], v12 offset:33024
  s_waitcnt lgkmcnt(3)
  v_mfma_f32_32x32x16_bf16 v[32:47], v[20:23], v[156:159], v[32:47]
  v_mul_f32 v83, s52, v83
  v_cvt_pk_bf16_f32 v81, v82, v83
  v_mul_f32 v84, s52, v84
  v_mfma_f32_32x32x16_bf16 v[48:63], v[20:23], v[220:223], v[48:63]
  v_mul_f32 v85, s52, v85
  v_cvt_pk_bf16_f32 v82, v84, v85
  ds_read_b128 v[20:23], v13 offset:33024
  s_waitcnt lgkmcnt(3)
  v_mfma_f32_32x32x16_bf16 v[32:47], v[24:27], v[160:163], v[32:47]
  v_mul_f32 v86, s52, v86
  v_mul_f32 v87, s52, v87
  v_cvt_pk_bf16_f32 v83, v86, v87
  v_mfma_f32_32x32x16_bf16 v[48:63], v[24:27], v[224:227], v[48:63]
  v_mul_f32 v88, s52, v88
  v_mul_f32 v89, s52, v89
  ds_read_b128 v[24:27], v14 offset:33024
  s_waitcnt lgkmcnt(3)
  v_mfma_f32_32x32x16_bf16 v[32:47], v[28:31], v[164:167], v[32:47]
  v_cvt_pk_bf16_f32 v88, v88, v89
  v_mul_f32 v90, s52, v90
  v_mul_f32 v91, s52, v91
  v_mfma_f32_32x32x16_bf16 v[48:63], v[28:31], v[228:231], v[48:63]
  v_cvt_pk_bf16_f32 v89, v90, v91
  v_mul_f32 v92, s52, v92
  ds_read_b128 v[28:31], v15 offset:33024
  s_waitcnt lgkmcnt(3)
  v_mfma_f32_32x32x16_bf16 v[32:47], v[16:19], v[168:171], v[32:47]
  v_mul_f32 v93, s52, v93
  v_cvt_pk_bf16_f32 v90, v92, v93
  v_mul_f32 v94, s52, v94
  v_mfma_f32_32x32x16_bf16 v[48:63], v[16:19], v[232:235], v[48:63]
  v_mul_f32 v95, s52, v95
  v_cvt_pk_bf16_f32 v91, v94, v95
  ds_read_b128 v[16:19], v8 offset:49152
  s_waitcnt lgkmcnt(3)
  v_mfma_f32_32x32x16_bf16 v[32:47], v[20:23], v[172:175], v[32:47]
  v_permlane16_swap_b32 v80, v88
  v_permlane16_swap_b32 v81, v89
  v_permlane16_swap_b32 v82, v90
  v_mfma_f32_32x32x16_bf16 v[48:63], v[20:23], v[236:239], v[48:63]
  v_permlane16_swap_b32 v83, v91
  v_accvgpr_write_b32 a132, v80
  ds_read_b128 v[20:23], v9 offset:49152
  s_waitcnt lgkmcnt(3)
  v_mfma_f32_32x32x16_bf16 v[32:47], v[24:27], v[176:179], v[32:47]
  v_accvgpr_write_b32 a133, v81
  v_accvgpr_write_b32 a134, v82
  v_accvgpr_write_b32 a135, v83
  v_mfma_f32_32x32x16_bf16 v[48:63], v[24:27], v[240:243], v[48:63]
  v_accvgpr_write_b32 a188, v88
  v_accvgpr_write_b32 a189, v89
  ds_read_b128 v[24:27], v10 offset:49152
  s_waitcnt lgkmcnt(3)
  v_mfma_f32_32x32x16_bf16 v[32:47], v[28:31], v[180:183], v[32:47]
  v_accvgpr_write_b32 a190, v90
  v_accvgpr_write_b32 a191, v91
  v_mfma_f32_32x32x16_bf16 v[48:63], v[28:31], v[244:247], v[48:63]
  s_waitcnt vmcnt(16)
  s_barrier
  ds_read_b128 v[28:31], v11 offset:49152
  s_waitcnt lgkmcnt(3)
  v_mfma_f32_32x32x16_bf16 v[64:79], v[16:19], v[120:123], 0
  v_mfma_f32_32x32x16_bf16 v[80:95], v[16:19], v[184:187], 0
  ds_read_b128 v[16:19], v12 offset:49152
  s_waitcnt lgkmcnt(3)
  v_mfma_f32_32x32x16_bf16 v[64:79], v[20:23], v[124:127], v[64:79]
  v_mul_f32 v32, s52, v32
  v_mul_f32 v33, s52, v33
  v_cvt_pk_bf16_f32 v32, v32, v33
  v_mfma_f32_32x32x16_bf16 v[80:95], v[20:23], v[188:191], v[80:95]
  v_mul_f32 v34, s52, v34
  v_mul_f32 v35, s52, v35
  ds_read_b128 v[20:23], v13 offset:49152
  s_waitcnt lgkmcnt(3)
  v_mfma_f32_32x32x16_bf16 v[64:79], v[24:27], v[128:131], v[64:79]
  v_cvt_pk_bf16_f32 v33, v34, v35
  v_mul_f32 v36, s52, v36
  v_mul_f32 v37, s52, v37
  v_mfma_f32_32x32x16_bf16 v[80:95], v[24:27], v[192:195], v[80:95]
  v_cvt_pk_bf16_f32 v34, v36, v37
  v_mul_f32 v38, s52, v38
  ds_read_b128 v[24:27], v14 offset:49152
  s_waitcnt lgkmcnt(3)
  v_mfma_f32_32x32x16_bf16 v[64:79], v[28:31], v[132:135], v[64:79]
  v_mul_f32 v39, s52, v39
  v_cvt_pk_bf16_f32 v35, v38, v39
  v_mul_f32 v40, s52, v40
  v_mfma_f32_32x32x16_bf16 v[80:95], v[28:31], v[196:199], v[80:95]
  v_mul_f32 v41, s52, v41
  v_cvt_pk_bf16_f32 v40, v40, v41
  ds_read_b128 v[28:31], v15 offset:49152
  s_waitcnt lgkmcnt(3)
  v_mfma_f32_32x32x16_bf16 v[64:79], v[16:19], v[136:139], v[64:79]
  v_mul_f32 v42, s52, v42
  v_mul_f32 v43, s52, v43
  v_cvt_pk_bf16_f32 v41, v42, v43
  v_mfma_f32_32x32x16_bf16 v[80:95], v[16:19], v[200:203], v[80:95]
  v_mul_f32 v44, s52, v44
  v_mul_f32 v45, s52, v45
  ds_read_b128 v[16:19], v8 offset:49408
  s_waitcnt lgkmcnt(3)
  v_mfma_f32_32x32x16_bf16 v[64:79], v[20:23], v[140:143], v[64:79]
  v_cvt_pk_bf16_f32 v42, v44, v45
  v_mul_f32 v46, s52, v46
  v_mul_f32 v47, s52, v47
  v_mfma_f32_32x32x16_bf16 v[80:95], v[20:23], v[204:207], v[80:95]
  v_cvt_pk_bf16_f32 v43, v46, v47
  v_permlane16_swap_b32 v32, v40
  ds_read_b128 v[20:23], v9 offset:49408
  s_waitcnt lgkmcnt(3)
  v_mfma_f32_32x32x16_bf16 v[64:79], v[24:27], v[144:147], v[64:79]
  v_permlane16_swap_b32 v33, v41
  v_permlane16_swap_b32 v34, v42
  v_permlane16_swap_b32 v35, v43
  v_mfma_f32_32x32x16_bf16 v[80:95], v[24:27], v[208:211], v[80:95]
  v_accvgpr_write_b32 a24, v32
  v_accvgpr_write_b32 a25, v33
  ds_read_b128 v[24:27], v10 offset:49408
  s_waitcnt lgkmcnt(3)
  v_mfma_f32_32x32x16_bf16 v[64:79], v[28:31], v[148:151], v[64:79]
  v_accvgpr_write_b32 a26, v34
  v_accvgpr_write_b32 a27, v35
  v_accvgpr_write_b32 a80, v40
  v_mfma_f32_32x32x16_bf16 v[80:95], v[28:31], v[212:215], v[80:95]
  v_accvgpr_write_b32 a81, v41
  v_accvgpr_write_b32 a82, v42
  ds_read_b128 v[28:31], v11 offset:49408
  s_waitcnt lgkmcnt(3)
  v_mfma_f32_32x32x16_bf16 v[64:79], v[16:19], v[152:155], v[64:79]
  v_accvgpr_write_b32 a83, v43
  v_mul_f32 v48, s52, v48
  v_mul_f32 v49, s52, v49
  v_mfma_f32_32x32x16_bf16 v[80:95], v[16:19], v[216:219], v[80:95]
  v_cvt_pk_bf16_f32 v48, v48, v49
  v_mul_f32 v50, s52, v50
  ds_read_b128 v[16:19], v12 offset:49408
  s_waitcnt lgkmcnt(3)
  v_mfma_f32_32x32x16_bf16 v[64:79], v[20:23], v[156:159], v[64:79]
  v_mul_f32 v51, s52, v51
  v_cvt_pk_bf16_f32 v49, v50, v51
  v_mul_f32 v52, s52, v52
  v_mfma_f32_32x32x16_bf16 v[80:95], v[20:23], v[220:223], v[80:95]
  v_mul_f32 v53, s52, v53
  v_cvt_pk_bf16_f32 v50, v52, v53
  ds_read_b128 v[20:23], v13 offset:49408
  s_waitcnt lgkmcnt(3)
  v_mfma_f32_32x32x16_bf16 v[64:79], v[24:27], v[160:163], v[64:79]
  v_mul_f32 v54, s52, v54
  v_mul_f32 v55, s52, v55
  v_cvt_pk_bf16_f32 v51, v54, v55
  v_mfma_f32_32x32x16_bf16 v[80:95], v[24:27], v[224:227], v[80:95]
  v_mul_f32 v56, s52, v56
  v_mul_f32 v57, s52, v57
  ds_read_b128 v[24:27], v14 offset:49408
  s_waitcnt lgkmcnt(3)
  v_mfma_f32_32x32x16_bf16 v[64:79], v[28:31], v[164:167], v[64:79]
  v_cvt_pk_bf16_f32 v56, v56, v57
  v_mul_f32 v58, s52, v58
  v_mul_f32 v59, s52, v59
  v_mfma_f32_32x32x16_bf16 v[80:95], v[28:31], v[228:231], v[80:95]
  v_cvt_pk_bf16_f32 v57, v58, v59
  v_mul_f32 v60, s52, v60
  ds_read_b128 v[28:31], v15 offset:49408
  s_waitcnt lgkmcnt(3)
  v_mfma_f32_32x32x16_bf16 v[64:79], v[16:19], v[168:171], v[64:79]
  v_mul_f32 v61, s52, v61
  v_cvt_pk_bf16_f32 v58, v60, v61
  v_mul_f32 v62, s52, v62
  v_mfma_f32_32x32x16_bf16 v[80:95], v[16:19], v[232:235], v[80:95]
  v_mul_f32 v63, s52, v63
  v_cvt_pk_bf16_f32 v59, v62, v63
  v_xor_b32 v8, 196608, v8
  ds_read_b128 v[16:19], v8 offset:0
  s_waitcnt lgkmcnt(3)
  v_mfma_f32_32x32x16_bf16 v[64:79], v[20:23], v[172:175], v[64:79]
  v_permlane16_swap_b32 v48, v56
  v_permlane16_swap_b32 v49, v57
  v_permlane16_swap_b32 v50, v58
  v_mfma_f32_32x32x16_bf16 v[80:95], v[20:23], v[236:239], v[80:95]
  v_permlane16_swap_b32 v51, v59
  v_accvgpr_write_b32 a136, v48
  v_xor_b32 v9, 196608, v9
  ds_read_b128 v[20:23], v9 offset:0
  s_waitcnt lgkmcnt(3)
  v_mfma_f32_32x32x16_bf16 v[64:79], v[24:27], v[176:179], v[64:79]
  v_accvgpr_write_b32 a137, v49
  v_accvgpr_write_b32 a138, v50
  v_accvgpr_write_b32 a139, v51
  v_mfma_f32_32x32x16_bf16 v[80:95], v[24:27], v[240:243], v[80:95]
  v_accvgpr_write_b32 a192, v56
  v_accvgpr_write_b32 a193, v57
  v_xor_b32 v10, 196608, v10
  ds_read_b128 v[24:27], v10 offset:0
  s_waitcnt lgkmcnt(3)
  v_mfma_f32_32x32x16_bf16 v[64:79], v[28:31], v[180:183], v[64:79]
  v_accvgpr_write_b32 a194, v58
  v_accvgpr_write_b32 a195, v59
  v_mfma_f32_32x32x16_bf16 v[80:95], v[28:31], v[244:247], v[80:95]
  v_xor_b32 v11, 196608, v11
  ds_read_b128 v[28:31], v11 offset:0
  s_waitcnt lgkmcnt(3)
  v_mfma_f32_32x32x16_bf16 v[32:47], v[16:19], v[120:123], 0
  v_mfma_f32_32x32x16_bf16 v[48:63], v[16:19], v[184:187], 0
  v_xor_b32 v12, 196608, v12
  ds_read_b128 v[16:19], v12 offset:0
  s_waitcnt lgkmcnt(3)
  v_mfma_f32_32x32x16_bf16 v[32:47], v[20:23], v[124:127], v[32:47]
  v_mul_f32 v64, s52, v64
  v_mul_f32 v65, s52, v65
  v_cvt_pk_bf16_f32 v64, v64, v65
  v_mfma_f32_32x32x16_bf16 v[48:63], v[20:23], v[188:191], v[48:63]
  v_mul_f32 v66, s52, v66
  v_mul_f32 v67, s52, v67
  v_xor_b32 v13, 196608, v13
  ds_read_b128 v[20:23], v13 offset:0
  s_waitcnt lgkmcnt(3)
  v_mfma_f32_32x32x16_bf16 v[32:47], v[24:27], v[128:131], v[32:47]
  v_cvt_pk_bf16_f32 v65, v66, v67
  v_mul_f32 v68, s52, v68
  v_mul_f32 v69, s52, v69
  v_mfma_f32_32x32x16_bf16 v[48:63], v[24:27], v[192:195], v[48:63]
  v_cvt_pk_bf16_f32 v66, v68, v69
  v_mul_f32 v70, s52, v70
  v_xor_b32 v14, 196608, v14
  ds_read_b128 v[24:27], v14 offset:0
  s_waitcnt lgkmcnt(3)
  v_mfma_f32_32x32x16_bf16 v[32:47], v[28:31], v[132:135], v[32:47]
  v_mul_f32 v71, s52, v71
  v_cvt_pk_bf16_f32 v67, v70, v71
  v_mul_f32 v72, s52, v72
  v_mfma_f32_32x32x16_bf16 v[48:63], v[28:31], v[196:199], v[48:63]
  v_mul_f32 v73, s52, v73
  v_cvt_pk_bf16_f32 v72, v72, v73
  v_xor_b32 v15, 196608, v15
  ds_read_b128 v[28:31], v15 offset:0
  s_waitcnt lgkmcnt(3)
  v_mfma_f32_32x32x16_bf16 v[32:47], v[16:19], v[136:139], v[32:47]
  v_mul_f32 v74, s52, v74
  v_mul_f32 v75, s52, v75
  v_cvt_pk_bf16_f32 v73, v74, v75
  v_mfma_f32_32x32x16_bf16 v[48:63], v[16:19], v[200:203], v[48:63]
  v_mul_f32 v76, s52, v76
  v_mul_f32 v77, s52, v77
  ds_read_b128 v[16:19], v8 offset:256
  s_waitcnt lgkmcnt(3)
  v_mfma_f32_32x32x16_bf16 v[32:47], v[20:23], v[140:143], v[32:47]
  v_cvt_pk_bf16_f32 v74, v76, v77
  v_mul_f32 v78, s52, v78
  v_mul_f32 v79, s52, v79
  v_mfma_f32_32x32x16_bf16 v[48:63], v[20:23], v[204:207], v[48:63]
  v_cvt_pk_bf16_f32 v75, v78, v79
  v_permlane16_swap_b32 v64, v72
  ds_read_b128 v[20:23], v9 offset:256
  s_waitcnt lgkmcnt(3)
  v_mfma_f32_32x32x16_bf16 v[32:47], v[24:27], v[144:147], v[32:47]
  v_permlane16_swap_b32 v65, v73
  v_permlane16_swap_b32 v66, v74
  v_permlane16_swap_b32 v67, v75
  v_mfma_f32_32x32x16_bf16 v[48:63], v[24:27], v[208:211], v[48:63]
  v_accvgpr_write_b32 a28, v64
  v_accvgpr_write_b32 a29, v65
  ds_read_b128 v[24:27], v10 offset:256
  s_waitcnt lgkmcnt(3)
  v_mfma_f32_32x32x16_bf16 v[32:47], v[28:31], v[148:151], v[32:47]
  v_accvgpr_write_b32 a30, v66
  v_accvgpr_write_b32 a31, v67
  v_accvgpr_write_b32 a84, v72
  v_mfma_f32_32x32x16_bf16 v[48:63], v[28:31], v[212:215], v[48:63]
  v_accvgpr_write_b32 a85, v73
  v_accvgpr_write_b32 a86, v74
  ds_read_b128 v[28:31], v11 offset:256
  s_waitcnt lgkmcnt(3)
  v_mfma_f32_32x32x16_bf16 v[32:47], v[16:19], v[152:155], v[32:47]
  v_accvgpr_write_b32 a87, v75
  v_mul_f32 v80, s52, v80
  v_mul_f32 v81, s52, v81
  v_mfma_f32_32x32x16_bf16 v[48:63], v[16:19], v[216:219], v[48:63]
  v_cvt_pk_bf16_f32 v80, v80, v81
  v_mul_f32 v82, s52, v82
  ds_read_b128 v[16:19], v12 offset:256
  s_waitcnt lgkmcnt(3)
  v_mfma_f32_32x32x16_bf16 v[32:47], v[20:23], v[156:159], v[32:47]
  v_mul_f32 v83, s52, v83
  v_cvt_pk_bf16_f32 v81, v82, v83
  v_mul_f32 v84, s52, v84
  v_mfma_f32_32x32x16_bf16 v[48:63], v[20:23], v[220:223], v[48:63]
  v_mul_f32 v85, s52, v85
  v_cvt_pk_bf16_f32 v82, v84, v85
  ds_read_b128 v[20:23], v13 offset:256
  s_waitcnt lgkmcnt(3)
  v_mfma_f32_32x32x16_bf16 v[32:47], v[24:27], v[160:163], v[32:47]
  v_mul_f32 v86, s52, v86
  v_mul_f32 v87, s52, v87
  v_cvt_pk_bf16_f32 v83, v86, v87
  v_mfma_f32_32x32x16_bf16 v[48:63], v[24:27], v[224:227], v[48:63]
  v_mul_f32 v88, s52, v88
  v_mul_f32 v89, s52, v89
  ds_read_b128 v[24:27], v14 offset:256
  s_waitcnt lgkmcnt(3)
  v_mfma_f32_32x32x16_bf16 v[32:47], v[28:31], v[164:167], v[32:47]
  v_cvt_pk_bf16_f32 v88, v88, v89
  v_mul_f32 v90, s52, v90
  v_mul_f32 v91, s52, v91
  v_mfma_f32_32x32x16_bf16 v[48:63], v[28:31], v[228:231], v[48:63]
  v_cvt_pk_bf16_f32 v89, v90, v91
  v_mul_f32 v92, s52, v92
  ds_read_b128 v[28:31], v15 offset:256
  s_waitcnt lgkmcnt(3)
  v_mfma_f32_32x32x16_bf16 v[32:47], v[16:19], v[168:171], v[32:47]
  v_mul_f32 v93, s52, v93
  v_cvt_pk_bf16_f32 v90, v92, v93
  v_mul_f32 v94, s52, v94
  v_mfma_f32_32x32x16_bf16 v[48:63], v[16:19], v[232:235], v[48:63]
  v_mul_f32 v95, s52, v95
  v_cvt_pk_bf16_f32 v91, v94, v95
  v_xor_b32 v8, 131072, v8
  ds_read_b128 v[16:19], v8 offset:0
  s_waitcnt lgkmcnt(3)
  v_mfma_f32_32x32x16_bf16 v[32:47], v[20:23], v[172:175], v[32:47]
  v_permlane16_swap_b32 v80, v88
  v_permlane16_swap_b32 v81, v89
  v_permlane16_swap_b32 v82, v90
  v_mfma_f32_32x32x16_bf16 v[48:63], v[20:23], v[236:239], v[48:63]
  v_permlane16_swap_b32 v83, v91
  v_accvgpr_write_b32 a140, v80
  v_xor_b32 v9, 131072, v9
  ds_read_b128 v[20:23], v9 offset:0
  s_waitcnt lgkmcnt(3)
  v_mfma_f32_32x32x16_bf16 v[32:47], v[24:27], v[176:179], v[32:47]
  v_accvgpr_write_b32 a141, v81
  v_accvgpr_write_b32 a142, v82
  v_accvgpr_write_b32 a143, v83
  v_mfma_f32_32x32x16_bf16 v[48:63], v[24:27], v[240:243], v[48:63]
  v_accvgpr_write_b32 a196, v88
  v_accvgpr_write_b32 a197, v89
  v_xor_b32 v10, 131072, v10
  ds_read_b128 v[24:27], v10 offset:0
  s_waitcnt lgkmcnt(3)
  v_mfma_f32_32x32x16_bf16 v[32:47], v[28:31], v[180:183], v[32:47]
  v_accvgpr_write_b32 a198, v90
  v_accvgpr_write_b32 a199, v91
  v_mfma_f32_32x32x16_bf16 v[48:63], v[28:31], v[244:247], v[48:63]
  s_waitcnt vmcnt(8)
  s_barrier
  v_xor_b32 v11, 131072, v11
  ds_read_b128 v[28:31], v11 offset:0
  s_waitcnt lgkmcnt(3)
  v_mfma_f32_32x32x16_bf16 v[64:79], v[16:19], v[120:123], 0
  v_mfma_f32_32x32x16_bf16 v[80:95], v[16:19], v[184:187], 0
  v_xor_b32 v12, 131072, v12
  ds_read_b128 v[16:19], v12 offset:0
  s_waitcnt lgkmcnt(3)
  v_mfma_f32_32x32x16_bf16 v[64:79], v[20:23], v[124:127], v[64:79]
  v_mul_f32 v32, s52, v32
  v_mul_f32 v33, s52, v33
  v_cvt_pk_bf16_f32 v32, v32, v33
  v_mfma_f32_32x32x16_bf16 v[80:95], v[20:23], v[188:191], v[80:95]
  v_mul_f32 v34, s52, v34
  v_mul_f32 v35, s52, v35
  v_xor_b32 v13, 131072, v13
  ds_read_b128 v[20:23], v13 offset:0
  s_waitcnt lgkmcnt(3)
  v_mfma_f32_32x32x16_bf16 v[64:79], v[24:27], v[128:131], v[64:79]
  v_cvt_pk_bf16_f32 v33, v34, v35
  v_mul_f32 v36, s52, v36
  v_mul_f32 v37, s52, v37
  v_mfma_f32_32x32x16_bf16 v[80:95], v[24:27], v[192:195], v[80:95]
  v_cvt_pk_bf16_f32 v34, v36, v37
  v_mul_f32 v38, s52, v38
  v_xor_b32 v14, 131072, v14
  ds_read_b128 v[24:27], v14 offset:0
  s_waitcnt lgkmcnt(3)
  v_mfma_f32_32x32x16_bf16 v[64:79], v[28:31], v[132:135], v[64:79]
  v_mul_f32 v39, s52, v39
  v_cvt_pk_bf16_f32 v35, v38, v39
  v_mul_f32 v40, s52, v40
  v_mfma_f32_32x32x16_bf16 v[80:95], v[28:31], v[196:199], v[80:95]
  v_mul_f32 v41, s52, v41
  v_cvt_pk_bf16_f32 v40, v40, v41
  v_xor_b32 v15, 131072, v15
  ds_read_b128 v[28:31], v15 offset:0
  s_waitcnt lgkmcnt(3)
  v_mfma_f32_32x32x16_bf16 v[64:79], v[16:19], v[136:139], v[64:79]
  v_mul_f32 v42, s52, v42
  v_mul_f32 v43, s52, v43
  v_cvt_pk_bf16_f32 v41, v42, v43
  v_mfma_f32_32x32x16_bf16 v[80:95], v[16:19], v[200:203], v[80:95]
  v_mul_f32 v44, s52, v44
  v_mul_f32 v45, s52, v45
  ds_read_b128 v[16:19], v8 offset:256
  s_waitcnt lgkmcnt(3)
  v_mfma_f32_32x32x16_bf16 v[64:79], v[20:23], v[140:143], v[64:79]
  v_cvt_pk_bf16_f32 v42, v44, v45
  v_mul_f32 v46, s52, v46
  v_mul_f32 v47, s52, v47
  v_mfma_f32_32x32x16_bf16 v[80:95], v[20:23], v[204:207], v[80:95]
  v_cvt_pk_bf16_f32 v43, v46, v47
  v_permlane16_swap_b32 v32, v40
  ds_read_b128 v[20:23], v9 offset:256
  s_waitcnt lgkmcnt(3)
  v_mfma_f32_32x32x16_bf16 v[64:79], v[24:27], v[144:147], v[64:79]
  v_permlane16_swap_b32 v33, v41
  v_permlane16_swap_b32 v34, v42
  v_permlane16_swap_b32 v35, v43
  v_mfma_f32_32x32x16_bf16 v[80:95], v[24:27], v[208:211], v[80:95]
  v_accvgpr_write_b32 a32, v32
  v_accvgpr_write_b32 a33, v33
  ds_read_b128 v[24:27], v10 offset:256
  s_waitcnt lgkmcnt(3)
  v_mfma_f32_32x32x16_bf16 v[64:79], v[28:31], v[148:151], v[64:79]
  v_accvgpr_write_b32 a34, v34
  v_accvgpr_write_b32 a35, v35
  v_accvgpr_write_b32 a88, v40
  v_mfma_f32_32x32x16_bf16 v[80:95], v[28:31], v[212:215], v[80:95]
  v_accvgpr_write_b32 a89, v41
  v_accvgpr_write_b32 a90, v42
  ds_read_b128 v[28:31], v11 offset:256
  s_waitcnt lgkmcnt(3)
  v_mfma_f32_32x32x16_bf16 v[64:79], v[16:19], v[152:155], v[64:79]
  v_accvgpr_write_b32 a91, v43
  v_mul_f32 v48, s52, v48
  v_mul_f32 v49, s52, v49
  v_mfma_f32_32x32x16_bf16 v[80:95], v[16:19], v[216:219], v[80:95]
  v_cvt_pk_bf16_f32 v48, v48, v49
  v_mul_f32 v50, s52, v50
  ds_read_b128 v[16:19], v12 offset:256
  s_waitcnt lgkmcnt(3)
  v_mfma_f32_32x32x16_bf16 v[64:79], v[20:23], v[156:159], v[64:79]
  v_mul_f32 v51, s52, v51
  v_cvt_pk_bf16_f32 v49, v50, v51
  v_mul_f32 v52, s52, v52
  v_mfma_f32_32x32x16_bf16 v[80:95], v[20:23], v[220:223], v[80:95]
  v_mul_f32 v53, s52, v53
  v_cvt_pk_bf16_f32 v50, v52, v53
  ds_read_b128 v[20:23], v13 offset:256
  s_waitcnt lgkmcnt(3)
  v_mfma_f32_32x32x16_bf16 v[64:79], v[24:27], v[160:163], v[64:79]
  v_mul_f32 v54, s52, v54
  v_mul_f32 v55, s52, v55
  v_cvt_pk_bf16_f32 v51, v54, v55
  v_mfma_f32_32x32x16_bf16 v[80:95], v[24:27], v[224:227], v[80:95]
  v_mul_f32 v56, s52, v56
  v_mul_f32 v57, s52, v57
  ds_read_b128 v[24:27], v14 offset:256
  s_waitcnt lgkmcnt(3)
  v_mfma_f32_32x32x16_bf16 v[64:79], v[28:31], v[164:167], v[64:79]
  v_cvt_pk_bf16_f32 v56, v56, v57
  v_mul_f32 v58, s52, v58
  v_mul_f32 v59, s52, v59
  v_mfma_f32_32x32x16_bf16 v[80:95], v[28:31], v[228:231], v[80:95]
  v_cvt_pk_bf16_f32 v57, v58, v59
  v_mul_f32 v60, s52, v60
  ds_read_b128 v[28:31], v15 offset:256
  s_waitcnt lgkmcnt(3)
  v_mfma_f32_32x32x16_bf16 v[64:79], v[16:19], v[168:171], v[64:79]
  v_mul_f32 v61, s52, v61
  v_cvt_pk_bf16_f32 v58, v60, v61
  v_mul_f32 v62, s52, v62
  v_mfma_f32_32x32x16_bf16 v[80:95], v[16:19], v[232:235], v[80:95]
  v_mul_f32 v63, s52, v63
  v_cvt_pk_bf16_f32 v59, v62, v63
  ds_read_b128 v[16:19], v8 offset:16384
  s_waitcnt lgkmcnt(3)
  v_mfma_f32_32x32x16_bf16 v[64:79], v[20:23], v[172:175], v[64:79]
  v_permlane16_swap_b32 v48, v56
  v_permlane16_swap_b32 v49, v57
  v_permlane16_swap_b32 v50, v58
  v_mfma_f32_32x32x16_bf16 v[80:95], v[20:23], v[236:239], v[80:95]
  v_permlane16_swap_b32 v51, v59
  v_accvgpr_write_b32 a144, v48
  ds_read_b128 v[20:23], v9 offset:16384
  s_waitcnt lgkmcnt(3)
  v_mfma_f32_32x32x16_bf16 v[64:79], v[24:27], v[176:179], v[64:79]
  v_accvgpr_write_b32 a145, v49
  v_accvgpr_write_b32 a146, v50
  v_accvgpr_write_b32 a147, v51
  v_mfma_f32_32x32x16_bf16 v[80:95], v[24:27], v[240:243], v[80:95]
  v_accvgpr_write_b32 a200, v56
  v_accvgpr_write_b32 a201, v57
  ds_read_b128 v[24:27], v10 offset:16384
  s_waitcnt lgkmcnt(3)
  v_mfma_f32_32x32x16_bf16 v[64:79], v[28:31], v[180:183], v[64:79]
  v_accvgpr_write_b32 a202, v58
  v_accvgpr_write_b32 a203, v59
  v_mfma_f32_32x32x16_bf16 v[80:95], v[28:31], v[244:247], v[80:95]
  ds_read_b128 v[28:31], v11 offset:16384
  s_waitcnt lgkmcnt(3)
  v_mfma_f32_32x32x16_bf16 v[32:47], v[16:19], v[120:123], 0
  v_mfma_f32_32x32x16_bf16 v[48:63], v[16:19], v[184:187], 0
  ds_read_b128 v[16:19], v12 offset:16384
  s_waitcnt lgkmcnt(3)
  v_mfma_f32_32x32x16_bf16 v[32:47], v[20:23], v[124:127], v[32:47]
  v_mul_f32 v64, s52, v64
  v_mul_f32 v65, s52, v65
  v_cvt_pk_bf16_f32 v64, v64, v65
  v_mfma_f32_32x32x16_bf16 v[48:63], v[20:23], v[188:191], v[48:63]
  v_mul_f32 v66, s52, v66
  v_mul_f32 v67, s52, v67
  ds_read_b128 v[20:23], v13 offset:16384
  s_waitcnt lgkmcnt(3)
  v_mfma_f32_32x32x16_bf16 v[32:47], v[24:27], v[128:131], v[32:47]
  v_cvt_pk_bf16_f32 v65, v66, v67
  v_mul_f32 v68, s52, v68
  v_mul_f32 v69, s52, v69
  v_mfma_f32_32x32x16_bf16 v[48:63], v[24:27], v[192:195], v[48:63]
  v_cvt_pk_bf16_f32 v66, v68, v69
  v_mul_f32 v70, s52, v70
  ds_read_b128 v[24:27], v14 offset:16384
  s_waitcnt lgkmcnt(3)
  v_mfma_f32_32x32x16_bf16 v[32:47], v[28:31], v[132:135], v[32:47]
  v_mul_f32 v71, s52, v71
  v_cvt_pk_bf16_f32 v67, v70, v71
  v_mul_f32 v72, s52, v72
  v_mfma_f32_32x32x16_bf16 v[48:63], v[28:31], v[196:199], v[48:63]
  v_mul_f32 v73, s52, v73
  v_cvt_pk_bf16_f32 v72, v72, v73
  ds_read_b128 v[28:31], v15 offset:16384
  s_waitcnt lgkmcnt(3)
  v_mfma_f32_32x32x16_bf16 v[32:47], v[16:19], v[136:139], v[32:47]
  buffer_load_dwordx4 v[100:103], v113, s[8:11], s28 offen sc1
  v_mul_f32 v74, s52, v74
  v_mul_f32 v75, s52, v75
  v_cvt_pk_bf16_f32 v73, v74, v75
  v_mfma_f32_32x32x16_bf16 v[48:63], v[16:19], v[200:203], v[48:63]
  v_mul_f32 v76, s52, v76
  v_mul_f32 v77, s52, v77
  ds_read_b128 v[16:19], v8 offset:16640
  s_waitcnt lgkmcnt(3)
  v_mfma_f32_32x32x16_bf16 v[32:47], v[20:23], v[140:143], v[32:47]
  v_cvt_pk_bf16_f32 v74, v76, v77
  v_mul_f32 v78, s52, v78
  v_mul_f32 v79, s52, v79
  v_mfma_f32_32x32x16_bf16 v[48:63], v[20:23], v[204:207], v[48:63]
  v_cvt_pk_bf16_f32 v75, v78, v79
  v_permlane16_swap_b32 v64, v72
  ds_read_b128 v[20:23], v9 offset:16640
  s_waitcnt lgkmcnt(3)
  v_mfma_f32_32x32x16_bf16 v[32:47], v[24:27], v[144:147], v[32:47]
  v_permlane16_swap_b32 v65, v73
  v_permlane16_swap_b32 v66, v74
  v_permlane16_swap_b32 v67, v75
  v_mfma_f32_32x32x16_bf16 v[48:63], v[24:27], v[208:211], v[48:63]
  v_accvgpr_write_b32 a36, v64
  v_accvgpr_write_b32 a37, v65
  ds_read_b128 v[24:27], v10 offset:16640
  s_waitcnt lgkmcnt(3)
  v_mfma_f32_32x32x16_bf16 v[32:47], v[28:31], v[148:151], v[32:47]
  v_accvgpr_write_b32 a38, v66
  v_accvgpr_write_b32 a39, v67
  v_accvgpr_write_b32 a92, v72
  v_mfma_f32_32x32x16_bf16 v[48:63], v[28:31], v[212:215], v[48:63]
  v_accvgpr_write_b32 a93, v73
  v_accvgpr_write_b32 a94, v74
  ds_read_b128 v[28:31], v11 offset:16640
  s_waitcnt lgkmcnt(3)
  v_mfma_f32_32x32x16_bf16 v[32:47], v[16:19], v[152:155], v[32:47]
  v_accvgpr_write_b32 a95, v75
  v_mul_f32 v80, s52, v80
  v_mul_f32 v81, s52, v81
  v_mfma_f32_32x32x16_bf16 v[48:63], v[16:19], v[216:219], v[48:63]
  v_cvt_pk_bf16_f32 v80, v80, v81
  v_mul_f32 v82, s52, v82
  ds_read_b128 v[16:19], v12 offset:16640
  s_waitcnt lgkmcnt(3)
  v_mfma_f32_32x32x16_bf16 v[32:47], v[20:23], v[156:159], v[32:47]
  v_mul_f32 v83, s52, v83
  v_cvt_pk_bf16_f32 v81, v82, v83
  v_mul_f32 v84, s52, v84
  v_mfma_f32_32x32x16_bf16 v[48:63], v[20:23], v[220:223], v[48:63]
  v_mul_f32 v85, s52, v85
  v_cvt_pk_bf16_f32 v82, v84, v85
  ds_read_b128 v[20:23], v13 offset:16640
  s_waitcnt lgkmcnt(3)
  v_mfma_f32_32x32x16_bf16 v[32:47], v[24:27], v[160:163], v[32:47]
  v_mul_f32 v86, s52, v86
  v_mul_f32 v87, s52, v87
  v_cvt_pk_bf16_f32 v83, v86, v87
  v_mfma_f32_32x32x16_bf16 v[48:63], v[24:27], v[224:227], v[48:63]
  v_mul_f32 v88, s52, v88
  v_mul_f32 v89, s52, v89
  ds_read_b128 v[24:27], v14 offset:16640
  s_waitcnt lgkmcnt(3)
  v_mfma_f32_32x32x16_bf16 v[32:47], v[28:31], v[164:167], v[32:47]
  v_cvt_pk_bf16_f32 v88, v88, v89
  v_mul_f32 v90, s52, v90
  v_mul_f32 v91, s52, v91
  v_mfma_f32_32x32x16_bf16 v[48:63], v[28:31], v[228:231], v[48:63]
  v_cvt_pk_bf16_f32 v89, v90, v91
  v_mul_f32 v92, s52, v92
  ds_read_b128 v[28:31], v15 offset:16640
  s_waitcnt lgkmcnt(3)
  v_mfma_f32_32x32x16_bf16 v[32:47], v[16:19], v[168:171], v[32:47]
  v_mul_f32 v93, s52, v93
  v_cvt_pk_bf16_f32 v90, v92, v93
  v_mul_f32 v94, s52, v94
  v_mfma_f32_32x32x16_bf16 v[48:63], v[16:19], v[232:235], v[48:63]
  v_mul_f32 v95, s52, v95
  v_cvt_pk_bf16_f32 v91, v94, v95
  ds_read_b128 v[16:19], v8 offset:32768
  s_waitcnt lgkmcnt(3)
  v_mfma_f32_32x32x16_bf16 v[32:47], v[20:23], v[172:175], v[32:47]
  v_permlane16_swap_b32 v80, v88
  v_permlane16_swap_b32 v81, v89
  v_permlane16_swap_b32 v82, v90
  v_mfma_f32_32x32x16_bf16 v[48:63], v[20:23], v[236:239], v[48:63]
  v_permlane16_swap_b32 v83, v91
  v_accvgpr_write_b32 a148, v80
  ds_read_b128 v[20:23], v9 offset:32768
  s_waitcnt lgkmcnt(3)
  v_mfma_f32_32x32x16_bf16 v[32:47], v[24:27], v[176:179], v[32:47]
  v_accvgpr_write_b32 a149, v81
  v_accvgpr_write_b32 a150, v82
  v_accvgpr_write_b32 a151, v83
  v_mfma_f32_32x32x16_bf16 v[48:63], v[24:27], v[240:243], v[48:63]
  v_accvgpr_write_b32 a204, v88
  v_accvgpr_write_b32 a205, v89
  ds_read_b128 v[24:27], v10 offset:32768
  s_waitcnt lgkmcnt(3)
  v_mfma_f32_32x32x16_bf16 v[32:47], v[28:31], v[180:183], v[32:47]
  v_accvgpr_write_b32 a206, v90
  v_accvgpr_write_b32 a207, v91
  v_mfma_f32_32x32x16_bf16 v[48:63], v[28:31], v[244:247], v[48:63]
  s_waitcnt vmcnt(1)
  s_barrier
  ds_read_b128 v[28:31], v11 offset:32768
  s_waitcnt lgkmcnt(3)
  v_mfma_f32_32x32x16_bf16 v[64:79], v[16:19], v[120:123], 0
  s_waitcnt vmcnt(0)
  v_cmp_ne_u64 vcc, s[88:89], v[100:101]
  v_cmp_ne_u64 s[54:55], s[88:89], v[102:103]
  s_add_u32 s48, s33, 14336
  v_mfma_f32_32x32x16_bf16 v[80:95], v[16:19], v[184:187], 0
  ds_read_b128 v[16:19], v12 offset:32768
  s_waitcnt lgkmcnt(3)
  v_mfma_f32_32x32x16_bf16 v[64:79], v[20:23], v[124:127], v[64:79]
  s_or_b64 vcc, vcc, s[54:55]
  s_cselect_b32 s48, 0x10000000, s48
  s_add_u32 s22, s48, 0
  s_add_u32 m0, s25, 0
  s_nop 0
  buffer_load_dwordx4 v2, s[8:11], s22 offen sc1 lds
  v_mul_f32 v32, s52, v32
  v_mul_f32 v33, s52, v33
  v_cvt_pk_bf16_f32 v32, v32, v33
  v_mfma_f32_32x32x16_bf16 v[80:95], v[20:23], v[188:191], v[80:95]
  v_mul_f32 v34, s52, v34
  v_mul_f32 v35, s52, v35
  ds_read_b128 v[20:23], v13 offset:32768
  s_waitcnt lgkmcnt(3)
  v_mfma_f32_32x32x16_bf16 v[64:79], v[24:27], v[128:131], v[64:79]
  s_add_u32 s22, s48, 1024
  s_add_u32 m0, s25, 1024
  s_nop 0
  buffer_load_dwordx4 v2, s[8:11], s22 offen sc1 lds
  v_cvt_pk_bf16_f32 v33, v34, v35
  v_mul_f32 v36, s52, v36
  v_mul_f32 v37, s52, v37
  v_mfma_f32_32x32x16_bf16 v[80:95], v[24:27], v[192:195], v[80:95]
  v_cvt_pk_bf16_f32 v34, v36, v37
  v_mul_f32 v38, s52, v38
  ds_read_b128 v[24:27], v14 offset:32768
  s_waitcnt lgkmcnt(3)
  v_mfma_f32_32x32x16_bf16 v[64:79], v[28:31], v[132:135], v[64:79]
  s_add_u32 s22, s48, 2048
  s_add_u32 m0, s25, 2048
  s_nop 0
  buffer_load_dwordx4 v2, s[8:11], s22 offen sc1 lds
  v_mul_f32 v39, s52, v39
  v_cvt_pk_bf16_f32 v35, v38, v39
  v_mul_f32 v40, s52, v40
  v_mfma_f32_32x32x16_bf16 v[80:95], v[28:31], v[196:199], v[80:95]
  v_mul_f32 v41, s52, v41
  v_cvt_pk_bf16_f32 v40, v40, v41
  ds_read_b128 v[28:31], v15 offset:32768
  s_waitcnt lgkmcnt(3)
  v_mfma_f32_32x32x16_bf16 v[64:79], v[16:19], v[136:139], v[64:79]
  s_add_u32 s22, s48, 3072
  s_add_u32 m0, s25, 3072
  s_nop 0
  buffer_load_dwordx4 v2, s[8:11], s22 offen sc1 lds
  v_mul_f32 v42, s52, v42
  v_mul_f32 v43, s52, v43
  v_cvt_pk_bf16_f32 v41, v42, v43
  v_mfma_f32_32x32x16_bf16 v[80:95], v[16:19], v[200:203], v[80:95]
  v_mul_f32 v44, s52, v44
  v_mul_f32 v45, s52, v45
  ds_read_b128 v[16:19], v8 offset:33024
  s_waitcnt lgkmcnt(3)
  v_mfma_f32_32x32x16_bf16 v[64:79], v[20:23], v[140:143], v[64:79]
  s_add_u32 s22, s48, 4096
  s_add_u32 m0, s25, 16384
  s_nop 0
  buffer_load_dwordx4 v2, s[8:11], s22 offen sc1 lds
  buffer_load_dwordx4 v[100:103], v113, s[8:11], s28 offen sc1
  v_cvt_pk_bf16_f32 v42, v44, v45
  v_mul_f32 v46, s52, v46
  v_mul_f32 v47, s52, v47
  v_mfma_f32_32x32x16_bf16 v[80:95], v[20:23], v[204:207], v[80:95]
  v_cvt_pk_bf16_f32 v43, v46, v47
  v_permlane16_swap_b32 v32, v40
  ds_read_b128 v[20:23], v9 offset:33024
  s_waitcnt lgkmcnt(3)
  v_mfma_f32_32x32x16_bf16 v[64:79], v[24:27], v[144:147], v[64:79]
  s_add_u32 s22, s48, 5120
  s_add_u32 m0, s25, 17408
  s_nop 0
  buffer_load_dwordx4 v2, s[8:11], s22 offen sc1 lds
  v_permlane16_swap_b32 v33, v41
  v_permlane16_swap_b32 v34, v42
  v_permlane16_swap_b32 v35, v43
  v_mfma_f32_32x32x16_bf16 v[80:95], v[24:27], v[208:211], v[80:95]
  v_accvgpr_write_b32 a40, v32
  v_accvgpr_write_b32 a41, v33
  ds_read_b128 v[24:27], v10 offset:33024
  s_waitcnt lgkmcnt(3)
  v_mfma_f32_32x32x16_bf16 v[64:79], v[28:31], v[148:151], v[64:79]
  s_add_u32 s22, s48, 6144
  s_add_u32 m0, s25, 18432
  s_nop 0
  buffer_load_dwordx4 v2, s[8:11], s22 offen sc1 lds
  v_accvgpr_write_b32 a42, v34
  v_accvgpr_write_b32 a43, v35
  v_accvgpr_write_b32 a96, v40
  v_mfma_f32_32x32x16_bf16 v[80:95], v[28:31], v[212:215], v[80:95]
  v_accvgpr_write_b32 a97, v41
  v_accvgpr_write_b32 a98, v42
  ds_read_b128 v[28:31], v11 offset:33024
  s_waitcnt lgkmcnt(3)
  v_mfma_f32_32x32x16_bf16 v[64:79], v[16:19], v[152:155], v[64:79]
  s_add_u32 s22, s48, 7168
  s_add_u32 m0, s25, 19456
  s_nop 0
  buffer_load_dwordx4 v2, s[8:11], s22 offen sc1 lds
  v_accvgpr_write_b32 a99, v43
  v_mul_f32 v48, s52, v48
  v_mul_f32 v49, s52, v49
  v_mfma_f32_32x32x16_bf16 v[80:95], v[16:19], v[216:219], v[80:95]
  v_cvt_pk_bf16_f32 v48, v48, v49
  v_mul_f32 v50, s52, v50
  ds_read_b128 v[16:19], v12 offset:33024
  s_waitcnt lgkmcnt(3)
  v_mfma_f32_32x32x16_bf16 v[64:79], v[20:23], v[156:159], v[64:79]
  s_add_u32 s22, s48, 8192
  s_add_u32 m0, s25, 81920
  s_nop 0
  buffer_load_dwordx4 v2, s[8:11], s22 offen sc1 lds
  v_mul_f32 v51, s52, v51
  v_cvt_pk_bf16_f32 v49, v50, v51
  v_mul_f32 v52, s52, v52
  v_mfma_f32_32x32x16_bf16 v[80:95], v[20:23], v[220:223], v[80:95]
  v_mul_f32 v53, s52, v53
  v_cvt_pk_bf16_f32 v50, v52, v53
  ds_read_b128 v[20:23], v13 offset:33024
  s_waitcnt lgkmcnt(3)
  v_mfma_f32_32x32x16_bf16 v[64:79], v[24:27], v[160:163], v[64:79]
  s_add_u32 s22, s48, 9216
  s_add_u32 m0, s25, 82944
  s_nop 0
  buffer_load_dwordx4 v2, s[8:11], s22 offen sc1 lds
  v_mul_f32 v54, s52, v54
  v_mul_f32 v55, s52, v55
  v_cvt_pk_bf16_f32 v51, v54, v55
  v_mfma_f32_32x32x16_bf16 v[80:95], v[24:27], v[224:227], v[80:95]
  v_mul_f32 v56, s52, v56
  v_mul_f32 v57, s52, v57
  ds_read_b128 v[24:27], v14 offset:33024
  s_waitcnt lgkmcnt(3)
  v_mfma_f32_32x32x16_bf16 v[64:79], v[28:31], v[164:167], v[64:79]
  s_add_u32 s22, s48, 10240
  s_add_u32 m0, s25, 83968
  s_nop 0
  buffer_load_dwordx4 v2, s[8:11], s22 offen sc1 lds
  v_cvt_pk_bf16_f32 v56, v56, v57
  v_mul_f32 v58, s52, v58
  v_mul_f32 v59, s52, v59
  v_mfma_f32_32x32x16_bf16 v[80:95], v[28:31], v[228:231], v[80:95]
  v_cvt_pk_bf16_f32 v57, v58, v59
  v_mul_f32 v60, s52, v60
  ds_read_b128 v[28:31], v15 offset:33024
  s_waitcnt lgkmcnt(3)
  v_mfma_f32_32x32x16_bf16 v[64:79], v[16:19], v[168:171], v[64:79]
  s_add_u32 s22, s48, 11264
  s_add_u32 m0, s25, 84992
  s_nop 0
  buffer_load_dwordx4 v2, s[8:11], s22 offen sc1 lds
  v_mul_f32 v61, s52, v61
  v_cvt_pk_bf16_f32 v58, v60, v61
  v_mul_f32 v62, s52, v62
  v_mfma_f32_32x32x16_bf16 v[80:95], v[16:19], v[232:235], v[80:95]
  v_mul_f32 v63, s52, v63
  v_cvt_pk_bf16_f32 v59, v62, v63
  ds_read_b128 v[16:19], v8 offset:49152
  s_waitcnt lgkmcnt(3)
  v_mfma_f32_32x32x16_bf16 v[64:79], v[20:23], v[172:175], v[64:79]
  s_add_u32 s22, s48, 12288
  s_add_u32 m0, s25, 98304
  s_nop 0
  buffer_load_dwordx4 v2, s[8:11], s22 offen sc1 lds
  v_permlane16_swap_b32 v48, v56
  v_permlane16_swap_b32 v49, v57
  v_permlane16_swap_b32 v50, v58
  v_mfma_f32_32x32x16_bf16 v[80:95], v[20:23], v[236:239], v[80:95]
  v_permlane16_swap_b32 v51, v59
  v_accvgpr_write_b32 a152, v48
  ds_read_b128 v[20:23], v9 offset:49152
  s_waitcnt lgkmcnt(3)
  v_mfma_f32_32x32x16_bf16 v[64:79], v[24:27], v[176:179], v[64:79]
  s_add_u32 s22, s48, 13312
  s_add_u32 m0, s25, 99328
  s_nop 0
  buffer_load_dwordx4 v2, s[8:11], s22 offen sc1 lds
  v_accvgpr_write_b32 a153, v49
  v_accvgpr_write_b32 a154, v50
  v_accvgpr_write_b32 a155, v51
  v_mfma_f32_32x32x16_bf16 v[80:95], v[24:27], v[240:243], v[80:95]
  v_accvgpr_write_b32 a208, v56
  v_accvgpr_write_b32 a209, v57
  ds_read_b128 v[24:27], v10 offset:49152
  s_waitcnt lgkmcnt(3)
  v_mfma_f32_32x32x16_bf16 v[64:79], v[28:31], v[180:183], v[64:79]
  v_accvgpr_write_b32 a210, v58
  v_accvgpr_write_b32 a211, v59
  v_mfma_f32_32x32x16_bf16 v[80:95], v[28:31], v[244:247], v[80:95]
  ds_read_b128 v[28:31], v11 offset:49152
  s_waitcnt lgkmcnt(3)
  v_mfma_f32_32x32x16_bf16 v[32:47], v[16:19], v[120:123], 0
  s_waitcnt vmcnt(9)
  v_cmp_ne_u64 vcc, s[88:89], v[100:101]
  v_cmp_ne_u64 s[54:55], s[88:89], v[102:103]
  s_add_u32 s49, s32, 0
  v_mfma_f32_32x32x16_bf16 v[48:63], v[16:19], v[184:187], 0
  ds_read_b128 v[16:19], v12 offset:49152
  s_waitcnt lgkmcnt(3)
  v_mfma_f32_32x32x16_bf16 v[32:47], v[20:23], v[124:127], v[32:47]
  s_or_b64 vcc, vcc, s[54:55]
  s_cselect_b32 s49, 0x10000000, s49
  s_add_u32 s22, s49, 0
  s_add_u32 m0, s25, 100352
  s_nop 0
  buffer_load_dwordx4 v2, s[8:11], s22 offen sc1 lds
  v_mul_f32 v64, s52, v64
  v_mul_f32 v65, s52, v65
  v_cvt_pk_bf16_f32 v64, v64, v65
  v_mfma_f32_32x32x16_bf16 v[48:63], v[20:23], v[188:191], v[48:63]
  v_mul_f32 v66, s52, v66
  v_mul_f32 v67, s52, v67
  ds_read_b128 v[20:23], v13 offset:49152
  s_waitcnt lgkmcnt(3)
  v_mfma_f32_32x32x16_bf16 v[32:47], v[24:27], v[128:131], v[32:47]
  s_add_u32 s22, s49, 1024
  s_add_u32 m0, s25, 101376
  s_nop 0
  buffer_load_dwordx4 v2, s[8:11], s22 offen sc1 lds
  v_cvt_pk_bf16_f32 v65, v66, v67
  v_mul_f32 v68, s52, v68
  v_mul_f32 v69, s52, v69
  v_mfma_f32_32x32x16_bf16 v[48:63], v[24:27], v[192:195], v[48:63]
  v_cvt_pk_bf16_f32 v66, v68, v69
  v_mul_f32 v70, s52, v70
  ds_read_b128 v[24:27], v14 offset:49152
  s_waitcnt lgkmcnt(3)
  v_mfma_f32_32x32x16_bf16 v[32:47], v[28:31], v[132:135], v[32:47]
  s_add_u32 s22, s49, 2048
  s_add_u32 m0, s25, 114688
  s_nop 0
  buffer_load_dwordx4 v2, s[8:11], s22 offen sc1 lds
  v_mul_f32 v71, s52, v71
  v_cvt_pk_bf16_f32 v67, v70, v71
  v_mul_f32 v72, s52, v72
  v_mfma_f32_32x32x16_bf16 v[48:63], v[28:31], v[196:199], v[48:63]
  v_mul_f32 v73, s52, v73
  v_cvt_pk_bf16_f32 v72, v72, v73
  ds_read_b128 v[28:31], v15 offset:49152
  s_waitcnt lgkmcnt(3)
  v_mfma_f32_32x32x16_bf16 v[32:47], v[16:19], v[136:139], v[32:47]
  s_add_u32 s22, s49, 3072
  s_add_u32 m0, s25, 115712
  s_nop 0
  buffer_load_dwordx4 v2, s[8:11], s22 offen sc1 lds
  v_mul_f32 v74, s52, v74
  v_mul_f32 v75, s52, v75
  v_cvt_pk_bf16_f32 v73, v74, v75
  v_mfma_f32_32x32x16_bf16 v[48:63], v[16:19], v[200:203], v[48:63]
  v_mul_f32 v76, s52, v76
  v_mul_f32 v77, s52, v77
  ds_read_b128 v[16:19], v8 offset:49408
  s_waitcnt lgkmcnt(3)
  v_mfma_f32_32x32x16_bf16 v[32:47], v[20:23], v[140:143], v[32:47]
  s_add_u32 s22, s49, 4096
  s_add_u32 m0, s25, 116736
  s_nop 0
  buffer_load_dwordx4 v2, s[8:11], s22 offen sc1 lds
  buffer_load_dwordx4 v[100:103], v113, s[8:11], s28 offen sc1
  v_cvt_pk_bf16_f32 v74, v76, v77
  v_mul_f32 v78, s52, v78
  v_mul_f32 v79, s52, v79
  v_mfma_f32_32x32x16_bf16 v[48:63], v[20:23], v[204:207], v[48:63]
  v_cvt_pk_bf16_f32 v75, v78, v79
  v_permlane16_swap_b32 v64, v72
  ds_read_b128 v[20:23], v9 offset:49408
  s_waitcnt lgkmcnt(3)
  v_mfma_f32_32x32x16_bf16 v[32:47], v[24:27], v[144:147], v[32:47]
  s_add_u32 s22, s49, 5120
  s_add_u32 m0, s25, 117760
  s_nop 0
  buffer_load_dwordx4 v2, s[8:11], s22 offen sc1 lds
  v_permlane16_swap_b32 v65, v73
  v_permlane16_swap_b32 v66, v74
  v_permlane16_swap_b32 v67, v75
  v_mfma_f32_32x32x16_bf16 v[48:63], v[24:27], v[208:211], v[48:63]
  v_accvgpr_write_b32 a44, v64
  v_accvgpr_write_b32 a45, v65
  ds_read_b128 v[24:27], v10 offset:49408
  s_waitcnt lgkmcnt(3)
  v_mfma_f32_32x32x16_bf16 v[32:47], v[28:31], v[148:151], v[32:47]
  s_add_u32 s22, s49, 6144
  s_add_u32 m0, s25, 131072
  s_nop 0
  buffer_load_dwordx4 v2, s[8:11], s22 offen sc1 lds
  v_accvgpr_write_b32 a46, v66
  v_accvgpr_write_b32 a47, v67
  v_accvgpr_write_b32 a100, v72
  v_mfma_f32_32x32x16_bf16 v[48:63], v[28:31], v[212:215], v[48:63]
  v_accvgpr_write_b32 a101, v73
  v_accvgpr_write_b32 a102, v74
  ds_read_b128 v[28:31], v11 offset:49408
  s_waitcnt lgkmcnt(3)
  v_mfma_f32_32x32x16_bf16 v[32:47], v[16:19], v[152:155], v[32:47]
  s_add_u32 s22, s49, 7168
  s_add_u32 m0, s25, 132096
  s_nop 0
  buffer_load_dwordx4 v2, s[8:11], s22 offen sc1 lds
  v_accvgpr_write_b32 a103, v75
  v_mul_f32 v80, s52, v80
  v_mul_f32 v81, s52, v81
  v_mfma_f32_32x32x16_bf16 v[48:63], v[16:19], v[216:219], v[48:63]
  v_cvt_pk_bf16_f32 v80, v80, v81
  v_mul_f32 v82, s52, v82
  ds_read_b128 v[16:19], v12 offset:49408
  s_waitcnt lgkmcnt(3)
  v_mfma_f32_32x32x16_bf16 v[32:47], v[20:23], v[156:159], v[32:47]
  s_add_u32 s22, s49, 8192
  s_add_u32 m0, s25, 133120
  s_nop 0
  buffer_load_dwordx4 v2, s[8:11], s22 offen sc1 lds
  v_mul_f32 v83, s52, v83
  v_cvt_pk_bf16_f32 v81, v82, v83
  v_mul_f32 v84, s52, v84
  v_mfma_f32_32x32x16_bf16 v[48:63], v[20:23], v[220:223], v[48:63]
  v_mul_f32 v85, s52, v85
  v_cvt_pk_bf16_f32 v82, v84, v85
  ds_read_b128 v[20:23], v13 offset:49408
  s_waitcnt lgkmcnt(3)
  v_mfma_f32_32x32x16_bf16 v[32:47], v[24:27], v[160:163], v[32:47]
  s_add_u32 s22, s49, 9216
  s_add_u32 m0, s25, 134144
  s_nop 0
  buffer_load_dwordx4 v2, s[8:11], s22 offen sc1 lds
  v_mul_f32 v86, s52, v86
  v_mul_f32 v87, s52, v87
  v_cvt_pk_bf16_f32 v83, v86, v87
  v_mfma_f32_32x32x16_bf16 v[48:63], v[24:27], v[224:227], v[48:63]
  v_mul_f32 v88, s52, v88
  v_mul_f32 v89, s52, v89
  ds_read_b128 v[24:27], v14 offset:49408
  s_waitcnt lgkmcnt(3)
  v_mfma_f32_32x32x16_bf16 v[32:47], v[28:31], v[164:167], v[32:47]
  s_add_u32 s22, s49, 10240
  s_add_u32 m0, s25, 147456
  s_nop 0
  buffer_load_dwordx4 v2, s[8:11], s22 offen sc1 lds
  v_cvt_pk_bf16_f32 v88, v88, v89
  v_mul_f32 v90, s52, v90
  v_mul_f32 v91, s52, v91
  v_mfma_f32_32x32x16_bf16 v[48:63], v[28:31], v[228:231], v[48:63]
  v_cvt_pk_bf16_f32 v89, v90, v91
  v_mul_f32 v92, s52, v92
  ds_read_b128 v[28:31], v15 offset:49408
  s_waitcnt lgkmcnt(3)
  v_mfma_f32_32x32x16_bf16 v[32:47], v[16:19], v[168:171], v[32:47]
  s_add_u32 s22, s49, 11264
  s_add_u32 m0, s25, 148480
  s_nop 0
  buffer_load_dwordx4 v2, s[8:11], s22 offen sc1 lds
  v_mul_f32 v93, s52, v93
  v_cvt_pk_bf16_f32 v90, v92, v93
  v_mul_f32 v94, s52, v94
  v_mfma_f32_32x32x16_bf16 v[48:63], v[16:19], v[232:235], v[48:63]
  v_mul_f32 v95, s52, v95
  v_cvt_pk_bf16_f32 v91, v94, v95
  v_xor_b32 v8, 65536, v8
  ds_read_b128 v[16:19], v8 offset:0
  s_waitcnt lgkmcnt(3)
  v_mfma_f32_32x32x16_bf16 v[32:47], v[20:23], v[172:175], v[32:47]
  s_add_u32 s22, s49, 12288
  s_add_u32 m0, s25, 149504
  s_nop 0
  buffer_load_dwordx4 v2, s[8:11], s22 offen sc1 lds
  v_permlane16_swap_b32 v80, v88
  v_permlane16_swap_b32 v81, v89
  v_permlane16_swap_b32 v82, v90
  v_mfma_f32_32x32x16_bf16 v[48:63], v[20:23], v[236:239], v[48:63]
  v_permlane16_swap_b32 v83, v91
  v_accvgpr_write_b32 a156, v80
  v_xor_b32 v9, 65536, v9
  ds_read_b128 v[20:23], v9 offset:0
  s_waitcnt lgkmcnt(3)
  v_mfma_f32_32x32x16_bf16 v[32:47], v[24:27], v[176:179], v[32:47]
  s_add_u32 s22, s49, 13312
  s_add_u32 m0, s25, 150528
  s_nop 0
  buffer_load_dwordx4 v2, s[8:11], s22 offen sc1 lds
  v_accvgpr_write_b32 a157, v81
  v_accvgpr_write_b32 a158, v82
  v_accvgpr_write_b32 a159, v83
  v_mfma_f32_32x32x16_bf16 v[48:63], v[24:27], v[240:243], v[48:63]
  v_accvgpr_write_b32 a212, v88
  v_accvgpr_write_b32 a213, v89
  v_xor_b32 v10, 65536, v10
  ds_read_b128 v[24:27], v10 offset:0
  s_waitcnt lgkmcnt(3)
  v_mfma_f32_32x32x16_bf16 v[32:47], v[28:31], v[180:183], v[32:47]
  v_accvgpr_write_b32 a214, v90
  v_accvgpr_write_b32 a215, v91
  v_mfma_f32_32x32x16_bf16 v[48:63], v[28:31], v[244:247], v[48:63]
  s_barrier
  v_xor_b32 v11, 65536, v11
  ds_read_b128 v[28:31], v11 offset:0
  s_waitcnt lgkmcnt(3)
  v_mfma_f32_32x32x16_bf16 v[64:79], v[16:19], v[120:123], 0
  s_waitcnt vmcnt(9)
  v_cmp_ne_u64 vcc, s[88:89], v[100:101]
  v_cmp_ne_u64 s[54:55], s[88:89], v[102:103]
  s_add_u32 s50, s33, 0
  v_mfma_f32_32x32x16_bf16 v[80:95], v[16:19], v[184:187], 0
  v_xor_b32 v12, 65536, v12
  ds_read_b128 v[16:19], v12 offset:0
  s_waitcnt lgkmcnt(3)
  v_mfma_f32_32x32x16_bf16 v[64:79], v[20:23], v[124:127], v[64:79]
  s_or_b64 vcc, vcc, s[54:55]
  s_cselect_b32 s50, 0x10000000, s50
  s_add_u32 s22, s50, 0
  buffer_load_dwordx4 a[224:227], v2, s[8:11], s22 offen sc1
  v_mul_f32 v32, s52, v32
  v_mul_f32 v33, s52, v33
  v_cvt_pk_bf16_f32 v32, v32, v33
  v_mfma_f32_32x32x16_bf16 v[80:95], v[20:23], v[188:191], v[80:95]
  v_mul_f32 v34, s52, v34
  v_mul_f32 v35, s52, v35
  v_xor_b32 v13, 65536, v13
  ds_read_b128 v[20:23], v13 offset:0
  s_waitcnt lgkmcnt(3)
  v_mfma_f32_32x32x16_bf16 v[64:79], v[24:27], v[128:131], v[64:79]
  s_add_u32 s22, s50, 1024
  buffer_load_dwordx4 a[228:231], v2, s[8:11], s22 offen sc1
  v_cvt_pk_bf16_f32 v33, v34, v35
  v_mul_f32 v36, s52, v36
  v_mul_f32 v37, s52, v37
  v_mfma_f32_32x32x16_bf16 v[80:95], v[24:27], v[192:195], v[80:95]
  v_cvt_pk_bf16_f32 v34, v36, v37
  v_mul_f32 v38, s52, v38
  v_xor_b32 v14, 65536, v14
  ds_read_b128 v[24:27], v14 offset:0
  s_waitcnt lgkmcnt(3)
  v_mfma_f32_32x32x16_bf16 v[64:79], v[28:31], v[132:135], v[64:79]
  s_add_u32 s22, s50, 2048
  buffer_load_dwordx4 a[232:235], v2, s[8:11], s22 offen sc1
  v_mul_f32 v39, s52, v39
  v_cvt_pk_bf16_f32 v35, v38, v39
  v_mul_f32 v40, s52, v40
  v_mfma_f32_32x32x16_bf16 v[80:95], v[28:31], v[196:199], v[80:95]
  v_mul_f32 v41, s52, v41
  v_cvt_pk_bf16_f32 v40, v40, v41
  v_xor_b32 v15, 65536, v15
  ds_read_b128 v[28:31], v15 offset:0
  s_waitcnt lgkmcnt(3)
  v_mfma_f32_32x32x16_bf16 v[64:79], v[16:19], v[136:139], v[64:79]
  s_add_u32 s22, s50, 3072
  buffer_load_dwordx4 a[236:239], v2, s[8:11], s22 offen sc1
  v_mul_f32 v42, s52, v42
  v_mul_f32 v43, s52, v43
  v_cvt_pk_bf16_f32 v41, v42, v43
  v_mfma_f32_32x32x16_bf16 v[80:95], v[16:19], v[200:203], v[80:95]
  v_mul_f32 v44, s52, v44
  v_mul_f32 v45, s52, v45
  ds_read_b128 v[16:19], v8 offset:256
  s_waitcnt lgkmcnt(3)
  v_mfma_f32_32x32x16_bf16 v[64:79], v[20:23], v[140:143], v[64:79]
  s_add_u32 s22, s50, 4096
  buffer_load_dwordx4 a[240:243], v2, s[8:11], s22 offen sc1
  v_cvt_pk_bf16_f32 v42, v44, v45
  v_mul_f32 v46, s52, v46
  v_mul_f32 v47, s52, v47
  v_mfma_f32_32x32x16_bf16 v[80:95], v[20:23], v[204:207], v[80:95]
  v_cvt_pk_bf16_f32 v43, v46, v47
  v_permlane16_swap_b32 v32, v40
  ds_read_b128 v[20:23], v9 offset:256
  s_waitcnt lgkmcnt(3)
  v_mfma_f32_32x32x16_bf16 v[64:79], v[24:27], v[144:147], v[64:79]
  s_add_u32 s22, s50, 5120
  buffer_load_dwordx4 a[244:247], v2, s[8:11], s22 offen sc1
  v_permlane16_swap_b32 v33, v41
  v_permlane16_swap_b32 v34, v42
  v_permlane16_swap_b32 v35, v43
  v_mfma_f32_32x32x16_bf16 v[80:95], v[24:27], v[208:211], v[80:95]
  v_accvgpr_write_b32 a48, v32
  v_accvgpr_write_b32 a49, v33
  ds_read_b128 v[24:27], v10 offset:256
  s_waitcnt lgkmcnt(3)
  v_mfma_f32_32x32x16_bf16 v[64:79], v[28:31], v[148:151], v[64:79]
  s_add_u32 s22, s50, 6144
  buffer_load_dwordx4 a[248:251], v2, s[8:11], s22 offen sc1
  v_accvgpr_write_b32 a50, v34
  v_accvgpr_write_b32 a51, v35
  v_accvgpr_write_b32 a104, v40
  v_mfma_f32_32x32x16_bf16 v[80:95], v[28:31], v[212:215], v[80:95]
  v_accvgpr_write_b32 a105, v41
  v_accvgpr_write_b32 a106, v42
  ds_read_b128 v[28:31], v11 offset:256
  s_waitcnt lgkmcnt(3)
  v_mfma_f32_32x32x16_bf16 v[64:79], v[16:19], v[152:155], v[64:79]
  s_add_u32 s22, s50, 7168
  buffer_load_dwordx4 a[252:255], v2, s[8:11], s22 offen sc1
  v_accvgpr_write_b32 a107, v43
  v_mul_f32 v48, s52, v48
  v_mul_f32 v49, s52, v49
  v_mfma_f32_32x32x16_bf16 v[80:95], v[16:19], v[216:219], v[80:95]
  v_cvt_pk_bf16_f32 v48, v48, v49
  v_mul_f32 v50, s52, v50
  ds_read_b128 v[16:19], v12 offset:256
  s_waitcnt lgkmcnt(3)
  v_mfma_f32_32x32x16_bf16 v[64:79], v[20:23], v[156:159], v[64:79]
  s_add_u32 s22, s50, 8192
  s_add_u32 m0, s25, 32768
  s_nop 0
  buffer_load_dwordx4 v2, s[8:11], s22 offen sc1 lds
  v_mul_f32 v51, s52, v51
  v_cvt_pk_bf16_f32 v49, v50, v51
  v_mul_f32 v52, s52, v52
  v_mfma_f32_32x32x16_bf16 v[80:95], v[20:23], v[220:223], v[80:95]
  v_mul_f32 v53, s52, v53
  v_cvt_pk_bf16_f32 v50, v52, v53
  ds_read_b128 v[20:23], v13 offset:256
  s_waitcnt lgkmcnt(3)
  v_mfma_f32_32x32x16_bf16 v[64:79], v[24:27], v[160:163], v[64:79]
  s_add_u32 s22, s50, 9216
  s_add_u32 m0, s25, 33792
  s_nop 0
  buffer_load_dwordx4 v2, s[8:11], s22 offen sc1 lds
  v_mul_f32 v54, s52, v54
  v_mul_f32 v55, s52, v55
  v_cvt_pk_bf16_f32 v51, v54, v55
  v_mfma_f32_32x32x16_bf16 v[80:95], v[24:27], v[224:227], v[80:95]
  v_mul_f32 v56, s52, v56
  v_mul_f32 v57, s52, v57
  ds_read_b128 v[24:27], v14 offset:256
  s_waitcnt lgkmcnt(3)
  v_mfma_f32_32x32x16_bf16 v[64:79], v[28:31], v[164:167], v[64:79]
  s_add_u32 s22, s50, 10240
  s_add_u32 m0, s25, 34816
  s_nop 0
  buffer_load_dwordx4 v2, s[8:11], s22 offen sc1 lds
  v_cvt_pk_bf16_f32 v56, v56, v57
  v_mul_f32 v58, s52, v58
  v_mul_f32 v59, s52, v59
  v_mfma_f32_32x32x16_bf16 v[80:95], v[28:31], v[228:231], v[80:95]
  v_cvt_pk_bf16_f32 v57, v58, v59
  v_mul_f32 v60, s52, v60
  ds_read_b128 v[28:31], v15 offset:256
  s_waitcnt lgkmcnt(3)
  v_mfma_f32_32x32x16_bf16 v[64:79], v[16:19], v[168:171], v[64:79]
  s_add_u32 s22, s50, 11264
  s_add_u32 m0, s25, 35840
  s_nop 0
  buffer_load_dwordx4 v2, s[8:11], s22 offen sc1 lds
  v_mul_f32 v61, s52, v61
  v_cvt_pk_bf16_f32 v58, v60, v61
  v_mul_f32 v62, s52, v62
  v_mfma_f32_32x32x16_bf16 v[80:95], v[16:19], v[232:235], v[80:95]
  v_mul_f32 v63, s52, v63
  v_cvt_pk_bf16_f32 v59, v62, v63
  s_waitcnt lgkmcnt(2)
  v_mfma_f32_32x32x16_bf16 v[64:79], v[20:23], v[172:175], v[64:79]
  s_add_u32 s22, s50, 12288
  s_add_u32 m0, s25, 49152
  s_nop 0
  buffer_load_dwordx4 v2, s[8:11], s22 offen sc1 lds
  v_permlane16_swap_b32 v48, v56
  v_permlane16_swap_b32 v49, v57
  v_permlane16_swap_b32 v50, v58
  v_mfma_f32_32x32x16_bf16 v[80:95], v[20:23], v[236:239], v[80:95]
  v_permlane16_swap_b32 v51, v59
  v_accvgpr_write_b32 a160, v48
  s_waitcnt lgkmcnt(1)
  v_mfma_f32_32x32x16_bf16 v[64:79], v[24:27], v[176:179], v[64:79]
  s_add_u32 s22, s50, 13312
  s_add_u32 m0, s25, 50176
  s_nop 0
  buffer_load_dwordx4 v2, s[8:11], s22 offen sc1 lds
  v_accvgpr_write_b32 a161, v49
  v_accvgpr_write_b32 a162, v50
  v_accvgpr_write_b32 a163, v51
  v_mfma_f32_32x32x16_bf16 v[80:95], v[24:27], v[240:243], v[80:95]
  v_accvgpr_write_b32 a216, v56
  v_accvgpr_write_b32 a217, v57
  s_waitcnt lgkmcnt(0)
  v_mfma_f32_32x32x16_bf16 v[64:79], v[28:31], v[180:183], v[64:79]
  buffer_load_dwordx4 v[100:103], v113, s[8:11], s28 offen sc1
  buffer_load_dwordx4 v[104:107], v2, s[8:11], s29 offen sc1
  buffer_load_dwordx4 v[108:111], v112, s[8:11], s29 offen sc1
  v_accvgpr_write_b32 a218, v58
  v_accvgpr_write_b32 a219, v59
  v_mfma_f32_32x32x16_bf16 v[80:95], v[28:31], v[244:247], v[80:95]
  s_nop 4
  v_mul_f32 v64, s52, v64
  v_mul_f32 v65, s52, v65
  v_cvt_pk_bf16_f32 v64, v64, v65
  v_mul_f32 v66, s52, v66
  v_mul_f32 v67, s52, v67
  v_cvt_pk_bf16_f32 v65, v66, v67
  v_mul_f32 v68, s52, v68
  v_mul_f32 v69, s52, v69
  v_cvt_pk_bf16_f32 v66, v68, v69
  v_mul_f32 v70, s52, v70
  v_mul_f32 v71, s52, v71
  v_cvt_pk_bf16_f32 v67, v70, v71
  v_mul_f32 v72, s52, v72
  v_mul_f32 v73, s52, v73
  v_cvt_pk_bf16_f32 v72, v72, v73
  v_mul_f32 v74, s52, v74
  v_mul_f32 v75, s52, v75
  v_cvt_pk_bf16_f32 v73, v74, v75
  v_mul_f32 v76, s52, v76
  v_mul_f32 v77, s52, v77
  v_cvt_pk_bf16_f32 v74, v76, v77
  v_mul_f32 v78, s52, v78
  v_mul_f32 v79, s52, v79
  v_cvt_pk_bf16_f32 v75, v78, v79
  v_permlane16_swap_b32 v64, v72
  v_permlane16_swap_b32 v65, v73
  v_permlane16_swap_b32 v66, v74
  v_permlane16_swap_b32 v67, v75
  v_accvgpr_write_b32 a52, v64
  v_accvgpr_write_b32 a53, v65
  v_accvgpr_write_b32 a54, v66
  v_accvgpr_write_b32 a55, v67
  v_accvgpr_write_b32 a108, v72
  v_accvgpr_write_b32 a109, v73
  v_accvgpr_write_b32 a110, v74
  v_accvgpr_write_b32 a111, v75
  v_mul_f32 v80, s52, v80
  v_mul_f32 v81, s52, v81
  v_cvt_pk_bf16_f32 v80, v80, v81
  v_mul_f32 v82, s52, v82
  v_mul_f32 v83, s52, v83
  v_cvt_pk_bf16_f32 v81, v82, v83
  v_mul_f32 v84, s52, v84
  v_mul_f32 v85, s52, v85
  v_cvt_pk_bf16_f32 v82, v84, v85
  v_mul_f32 v86, s52, v86
  v_mul_f32 v87, s52, v87
  v_cvt_pk_bf16_f32 v83, v86, v87
  v_mul_f32 v88, s52, v88
  v_mul_f32 v89, s52, v89
  v_cvt_pk_bf16_f32 v88, v88, v89
  v_mul_f32 v90, s52, v90
  v_mul_f32 v91, s52, v91
  v_cvt_pk_bf16_f32 v89, v90, v91
  v_mul_f32 v92, s52, v92
  v_mul_f32 v93, s52, v93
  v_cvt_pk_bf16_f32 v90, v92, v93
  v_mul_f32 v94, s52, v94
  v_mul_f32 v95, s52, v95
  v_cvt_pk_bf16_f32 v91, v94, v95
  v_permlane16_swap_b32 v80, v88
  v_permlane16_swap_b32 v81, v89
  v_permlane16_swap_b32 v82, v90
  v_permlane16_swap_b32 v83, v91
  v_accvgpr_write_b32 a164, v80
  v_accvgpr_write_b32 a165, v81
  v_accvgpr_write_b32 a166, v82
  v_accvgpr_write_b32 a167, v83
  v_accvgpr_write_b32 a220, v88
  v_accvgpr_write_b32 a221, v89
  v_accvgpr_write_b32 a222, v90
  v_accvgpr_write_b32 a223, v91
  s_mov_b32 s30, 0
  s_branch sc_aw_w
sc_aw:
  buffer_load_dwordx4 v[100:103], v113, s[8:11], s28 offen sc1
  buffer_load_dwordx4 v[104:107], v2, s[8:11], s29 offen sc1
  buffer_load_dwordx4 v[108:111], v112, s[8:11], s29 offen sc1
sc_aw_w:
  s_waitcnt vmcnt(0)
  v_cmp_ne_u64 vcc, s[88:89], v[100:101]
  s_cbranch_vccnz sc_aw_no
  v_cmp_ne_u64 vcc, s[88:89], v[102:103]
  s_cbranch_vccnz sc_aw_no
  v_cmp_ne_u64 vcc, s[88:89], v[104:105]
  s_cbranch_vccnz sc_aw_no
  v_cmp_ne_u64 vcc, s[88:89], v[106:107]
  s_cbranch_vccnz sc_aw_no
  v_cmp_ne_u64 vcc, s[88:89], v[108:109]
  s_cbranch_vccnz sc_aw_no
  v_cmp_ne_u64 vcc, s[88:89], v[110:111]
  s_cbranch_vccnz sc_aw_no
  s_branch sc_aw_ok
sc_aw_no:
  s_sleep 1
  s_add_u32 s30, s30, 1
  s_cmp_lt_u32 s30, 50000
  s_cbranch_scc1 sc_aw
  s_branch cA_abort
sc_aw_ok:
  v_add_u32 v4, s25, v2
  v_add_u32 v5, 0x10000, v4
  v_add_u32 v6, 0x20000, v4
  s_cmp_eq_u32 s48, 0x10000000
  s_cbranch_scc1 sc_d0
  ds_read_b128 v[144:147], v4 offset:0
  ds_read_b128 v[148:151], v4 offset:1024
  ds_read_b128 v[152:155], v4 offset:2048
  ds_read_b128 v[156:159], v4 offset:3072
  ds_read_b128 v[160:163], v4 offset:16384
  ds_read_b128 v[164:167], v4 offset:17408
  ds_read_b128 v[168:171], v4 offset:18432
  ds_read_b128 v[172:175], v4 offset:19456
  ds_read_b128 v[176:179], v5 offset:16384
  ds_read_b128 v[180:183], v5 offset:17408
  ds_read_b128 v[184:187], v5 offset:18432
  ds_read_b128 v[188:191], v5 offset:19456
  ds_read_b128 v[192:195], v5 offset:32768
  ds_read_b128 v[196:199], v5 offset:33792
  s_waitcnt lgkmcnt(0)
  s_branch sc_e0
sc_d0:
  s_add_u32 s22, s33, 12288
  buffer_load_dwordx4 v[144:147], v2, s[8:11], s22 offen offset:2048 sc1
  buffer_load_dwordx4 v[148:151], v2, s[8:11], s22 offen offset:3072 sc1
  s_add_u32 s22, s33, 16384
  buffer_load_dwordx4 v[152:155], v2, s[8:11], s22 offen offset:0 sc1
  buffer_load_dwordx4 v[156:159], v2, s[8:11], s22 offen offset:1024 sc1
  buffer_load_dwordx4 v[160:163], v2, s[8:11], s22 offen offset:2048 sc1
  buffer_load_dwordx4 v[164:167], v2, s[8:11], s22 offen offset:3072 sc1
  s_add_u32 s22, s33, 20480
  buffer_load_dwordx4 v[168:171], v2, s[8:11], s22 offen offset:0 sc1
  buffer_load_dwordx4 v[172:175], v2, s[8:11], s22 offen offset:1024 sc1
  buffer_load_dwordx4 v[176:179], v2, s[8:11], s22 offen offset:2048 sc1
  buffer_load_dwordx4 v[180:183], v2, s[8:11], s22 offen offset:3072 sc1
  s_add_u32 s22, s33, 24576
  buffer_load_dwordx4 v[184:187], v2, s[8:11], s22 offen offset:0 sc1
  buffer_load_dwordx4 v[188:191], v2, s[8:11], s22 offen offset:1024 sc1
  buffer_load_dwordx4 v[192:195], v2, s[8:11], s22 offen offset:2048 sc1
  buffer_load_dwordx4 v[196:199], v2, s[8:11], s22 offen offset:3072 sc1
sc_e0:
  s_cmp_eq_u32 s49, 0x10000000
  s_cbranch_scc1 sc_d1
  ds_read_b128 v[200:203], v5 offset:34816
  ds_read_b128 v[204:207], v5 offset:35840
  ds_read_b128 v[208:211], v5 offset:49152
  ds_read_b128 v[212:215], v5 offset:50176
  ds_read_b128 v[216:219], v5 offset:51200
  ds_read_b128 v[220:223], v5 offset:52224
  ds_read_b128 v[224:227], v6 offset:0
  ds_read_b128 v[228:231], v6 offset:1024
  ds_read_b128 v[232:235], v6 offset:2048
  ds_read_b128 v[236:239], v6 offset:3072
  ds_read_b128 v[240:243], v6 offset:16384
  ds_read_b128 v[244:247], v6 offset:17408
  ds_read_b128 v[248:251], v6 offset:18432
  ds_read_b128 v[252:255], v6 offset:19456
  s_waitcnt lgkmcnt(0)
  s_branch sc_e1
sc_d1:
  s_add_u32 s22, s32, 0
  buffer_load_dwordx4 v[200:203], v2, s[8:11], s22 offen offset:0 sc1
  buffer_load_dwordx4 v[204:207], v2, s[8:11], s22 offen offset:1024 sc1
  buffer_load_dwordx4 v[208:211], v2, s[8:11], s22 offen offset:2048 sc1
  buffer_load_dwordx4 v[212:215], v2, s[8:11], s22 offen offset:3072 sc1
  s_add_u32 s22, s32, 4096
  buffer_load_dwordx4 v[216:219], v2, s[8:11], s22 offen offset:0 sc1
  buffer_load_dwordx4 v[220:223], v2, s[8:11], s22 offen offset:1024 sc1
  buffer_load_dwordx4 v[224:227], v2, s[8:11], s22 offen offset:2048 sc1
  buffer_load_dwordx4 v[228:231], v2, s[8:11], s22 offen offset:3072 sc1
  s_add_u32 s22, s32, 8192
  buffer_load_dwordx4 v[232:235], v2, s[8:11], s22 offen offset:0 sc1
  buffer_load_dwordx4 v[236:239], v2, s[8:11], s22 offen offset:1024 sc1
  buffer_load_dwordx4 v[240:243], v2, s[8:11], s22 offen offset:2048 sc1
  buffer_load_dwordx4 v[244:247], v2, s[8:11], s22 offen offset:3072 sc1
  s_add_u32 s22, s32, 12288
  buffer_load_dwordx4 v[248:251], v2, s[8:11], s22 offen offset:0 sc1
  buffer_load_dwordx4 v[252:255], v2, s[8:11], s22 offen offset:1024 sc1
sc_e1:
  s_cmp_eq_u32 s50, 0x10000000
  s_cbranch_scc1 sc_d2
  ds_read_b128 v[120:123], v4 offset:32768
  ds_read_b128 v[124:127], v4 offset:33792
  ds_read_b128 v[128:131], v4 offset:34816
  ds_read_b128 v[132:135], v4 offset:35840
  ds_read_b128 v[136:139], v4 offset:49152
  ds_read_b128 v[140:143], v4 offset:50176
  s_waitcnt lgkmcnt(0)
  s_branch sc_e2
sc_d2:
  s_add_u32 s22, s33, 0
  buffer_load_dwordx4 a[224:227], v2, s[8:11], s22 offen offset:0 sc1
  buffer_load_dwordx4 a[228:231], v2, s[8:11], s22 offen offset:1024 sc1
  buffer_load_dwordx4 a[232:235], v2, s[8:11], s22 offen offset:2048 sc1
  buffer_load_dwordx4 a[236:239], v2, s[8:11], s22 offen offset:3072 sc1
  s_add_u32 s22, s33, 4096
  buffer_load_dwordx4 a[240:243], v2, s[8:11], s22 offen offset:0 sc1
  buffer_load_dwordx4 a[244:247], v2, s[8:11], s22 offen offset:1024 sc1
  buffer_load_dwordx4 a[248:251], v2, s[8:11], s22 offen offset:2048 sc1
  buffer_load_dwordx4 a[252:255], v2, s[8:11], s22 offen offset:3072 sc1
  s_add_u32 s22, s33, 8192
  buffer_load_dwordx4 v[120:123], v2, s[8:11], s22 offen offset:0 sc1
  buffer_load_dwordx4 v[124:127], v2, s[8:11], s22 offen offset:1024 sc1
  buffer_load_dwordx4 v[128:131], v2, s[8:11], s22 offen offset:2048 sc1
  buffer_load_dwordx4 v[132:135], v2, s[8:11], s22 offen offset:3072 sc1
  s_add_u32 s22, s33, 12288
  buffer_load_dwordx4 v[136:139], v2, s[8:11], s22 offen offset:0 sc1
  buffer_load_dwordx4 v[140:143], v2, s[8:11], s22 offen offset:1024 sc1
sc_e2:
  s_barrier
  s_branch m_role
m_val:
  s_cmp_lg_u32 s16, 0
  s_cbranch_scc1 w0_6
  v_mov_b32 v233, 128
  v_mov_b32 v234, s88
  v_mov_b32 v235, s89
  v_mov_b32 v236, 0
  v_mov_b32 v237, 0
  s_mov_b64 exec, 1
  buffer_atomic_cmpswap_x2 v[234:237], v233, s[12:15], 0 offen sc0
  s_mov_b64 exec, -1
w0_6:
  s_cmp_lg_u32 s66, 0
  s_cbranch_scc1 va_ci
  s_cmp_lg_u32 s16, 0
  s_cbranch_scc1 w0_7
  s_lshr_b32 s70, s3, 5
  s_and_b32 s71, s70, 4
  s_mul_i32 s71, s71, 12
  s_lshl_b32 s70, s70, 2
  s_add_u32 s70, s70, s71
  s_lshl_b32 s71, 1, s3
  v_mov_b32 v242, s71
  v_mov_b32 v243, 32
  s_mov_b64 exec, 1
  buffer_atomic_or v242, v243, s[12:15], s70 offen sc0
  buffer_load_dwordx2 v[244:245], v243, s[12:15], 0 offen offset:96 sc1
  s_mov_b64 exec, -1
w0_7:
va_ci:
  s_mov_b32 s56, s40
  s_and_b32 s57, s41, 0xffff
  s_mov_b32 s58, 3670016
  s_mov_b32 s59, 0x20000
  v_lshrrev_b32 v24, 5, v1
  v_and_b32 v25, 31, v1
  v_lshlrev_b32 v25, 4, v25
  v_lshl_add_u32 v24, v24, 13, v25
  s_mov_b32 s60, s42
  s_and_b32 s61, s43, 0xffff
  s_mov_b32 s62, 3670016
  s_mov_b32 s63, 0x20000
  s_lshl_b32 s22, s17, 9
  s_lshl_b32 s23, s16, 19
  s_add_u32 s23, s22, s23
  s_add_u32 s21, s23, 262144
  buffer_load_dwordx4 v[28:31], v24, s[60:63], s21 offen
  s_add_u32 s21, s23, 278528
  buffer_load_dwordx4 v[28:31], v24, s[60:63], s21 offen
  s_add_u32 s21, s23, 294912
  buffer_load_dwordx4 v[28:31], v24, s[60:63], s21 offen
  s_add_u32 s21, s23, 311296
  buffer_load_dwordx4 v[28:31], v24, s[60:63], s21 offen
  s_add_u32 s21, s23, 327680
  buffer_load_dwordx4 v[28:31], v24, s[60:63], s21 offen
  s_add_u32 s21, s23, 344064
  buffer_load_dwordx4 v[28:31], v24, s[60:63], s21 offen
  s_add_u32 s21, s23, 360448
  buffer_load_dwordx4 v[28:31], v24, s[60:63], s21 offen
  s_add_u32 s21, s23, 376832
  buffer_load_dwordx4 v[28:31], v24, s[60:63], s21 offen
  s_add_u32 s21, s23, 393216
  buffer_load_dwordx4 v[28:31], v24, s[60:63], s21 offen
  s_add_u32 s21, s23, 409600
  buffer_load_dwordx4 v[28:31], v24, s[60:63], s21 offen
  s_add_u32 s21, s23, 425984
  buffer_load_dwordx4 v[28:31], v24, s[60:63], s21 offen
  s_add_u32 s21, s23, 442368
  buffer_load_dwordx4 v[28:31], v24, s[60:63], s21 offen
  s_add_u32 s21, s23, 458752
  buffer_load_dwordx4 v[28:31], v24, s[60:63], s21 offen
  s_add_u32 s21, s23, 475136
  buffer_load_dwordx4 v[28:31], v24, s[60:63], s21 offen
  s_add_u32 s21, s23, 491520
  buffer_load_dwordx4 v[28:31], v24, s[60:63], s21 offen
  s_add_u32 s21, s23, 507904
  buffer_load_dwordx4 v[28:31], v24, s[60:63], s21 offen
  s_lshl_b32 s23, s16, 14
  s_add_u32 s22, s22, s23
  s_mov_b32 s30, 0
va_pf:
  buffer_load_dwordx4 v[28:31], v24, s[56:59], s22 offen
  s_waitcnt vmcnt(40)
  s_add_u32 s22, s22, 65536
  s_add_u32 s30, s30, 1
  s_cmp_lt_u32 s30, 56
  s_cbranch_scc1 va_pf
  s_cmp_lg_u32 s66, 0
  s_cbranch_scc1 va_cf
  s_cmp_lg_u32 s16, 0
  s_cbranch_scc1 w0_8
  s_waitcnt vmcnt(40)
  v_readfirstlane_b32 s70, v244
  s_cmp_lg_u32 s70, 0
  s_cbranch_scc1 va_nz
  v_mov_b32 v243, 128
  v_mov_b32 v244, s88
  v_mov_b32 v245, s89
  v_mov_b32 v246, 0
  v_mov_b32 v247, 0
  s_mov_b64 exec, 1
  buffer_atomic_cmpswap_x2 v[244:247], v243, s[12:15], 0 offen sc0
  s_mov_b64 exec, -1
  s_waitcnt vmcnt(0)
  v_readfirstlane_b32 s70, v244
  s_cmp_lg_u32 s70, 0
  s_cbranch_scc1 va_nz
  v_mov_b32 v244, s88
  v_mov_b32 v245, s89
va_nz:
w0_8:
  v_mov_b32 v243, 160000
  s_add_u32 s101, s101, 1
  s_barrier
  s_mov_b64 exec, 1
  s_cmp_lg_u32 s16, 0
  s_cbranch_scc1 w0_9
  ds_write_b32 v243, v242 offset:0
  ds_write_b32 v243, v244 offset:4
  ds_write_b32 v243, v245 offset:8
  s_waitcnt lgkmcnt(0)
  v_mov_b32 v242, s101
  ds_write_b32 v243, v242 offset:16
  s_waitcnt lgkmcnt(0)
w0_9:
  s_mov_b64 exec, -1
  s_barrier
  ds_read_b32 v242, v243 offset:0
  ds_read_b32 v244, v243 offset:4
  ds_read_b32 v245, v243 offset:8
  ds_read_b32 v243, v243 offset:16
  s_waitcnt lgkmcnt(0)
  v_readfirstlane_b32 s70, v242
  v_readfirstlane_b32 s88, v244
  v_readfirstlane_b32 s89, v245
  v_cmp_ne_u32 vcc, s101, v243
  s_cbranch_vccnz ch_end
  s_mov_b32 s66, 1
  s_bitcmp1_b32 s70, s3
  s_cbranch_scc1 m_reclaim
va_cf:
  s_cmp_lg_u32 s16, 0
  s_cbranch_scc1 w0_10
  s_cmp_eq_u32 s67, 0
  s_cselect_b32 s20, 1, 0x10001
  v_mov_b32 v242, s20
  v_mov_b32 v243, 0
  s_mov_b64 exec, 1
  buffer_atomic_add v242, v243, s[12:15], 0 offen
  s_mov_b64 exec, -1
w0_10:
m_role:
  s_mov_b32 s17, s3
  v_and_b32 v1, 63, v0
  v_lshlrev_b32 v2, 4, v1
  v_lshrrev_b32 v116, 4, v1
  v_and_b32 v117, 15, v1
  v_mov_b32 v3, 0x4444
  v_mov_b32 v118, 0xeeee
  v_cmp_lt_u32 vcc, 7, v117
  s_nop 1
  v_cndmask_b32 v3, v3, v118, vcc
  s_mov_b32 s19, 0
  s_mov_b32 s20, 88653824
  s_lshr_b32 s22, s17, 4
  s_lshl_b32 s22, s22, 2
  s_add_u32 s22, s22, s16
  s_and_b32 s17, s17, 15
  s_cmp_eq_u32 s22, 0
  s_cbranch_scc1 ch_init0
  s_cmp_eq_u32 s22, 1
  s_cbranch_scc1 ch_init1
  s_cmp_eq_u32 s22, 2
  s_cbranch_scc1 ch_init2
  s_cmp_eq_u32 s22, 3
  s_cbranch_scc1 ch_init3
  s_cmp_eq_u32 s22, 4
  s_cbranch_scc1 ch_init4
  s_cmp_eq_u32 s22, 5
  s_cbranch_scc1 ch_init5
  s_cmp_eq_u32 s22, 6
  s_cbranch_scc1 ch_init6
  s_cmp_eq_u32 s22, 7
  s_cbranch_scc1 ch_init7
  s_branch ch_end
ch_init0:
  s_mul_i32 s31, s17, 401408
  s_add_u32 s31, s31, 0
  s_mov_b32 s24, 71565312
  s_mov_b32 s25, 0
  s_add_u32 m0, s25, 0
  s_nop 0
  buffer_load_dwordx4 v2, s[8:11], s24 offen offset:0 sc1 lds
  buffer_load_dwordx4 v2, s[8:11], s24 offen offset:1024 sc1 lds
  buffer_load_dwordx4 v2, s[8:11], s24 offen offset:2048 sc1 lds
  buffer_load_dwordx4 v2, s[8:11], s24 offen offset:3072 sc1 lds
  s_add_u32 m0, s25, 4096
  s_add_u32 s22, s24, 4096
  buffer_load_dwordx4 v2, s[8:11], s22 offen offset:0 sc1 lds
  buffer_load_dwordx4 v2, s[8:11], s22 offen offset:1024 sc1 lds
  buffer_load_dwordx4 v2, s[8:11], s22 offen offset:2048 sc1 lds
  v_lshrrev_b32 v64, 1, v117
  v_and_b32 v65, 1, v116
  v_lshlrev_b32 v65, 2, v65
  v_sub_u32 v64, v64, v65
  v_and_b32 v65, 1, v117
  v_lshl_add_u32 v66, v65, 2, v64
  v_cmp_gt_u32 vcc, 4, v64
  v_mov_b32 v67, 99
  s_nop 0
  v_cndmask_b32 v66, v67, v66, vcc
  v_mov_b32 v68, 0x3f80
  v_mov_b32 v69, 0x3f800000
  v_mov_b32 v4, 0
  v_cmp_eq_u32 vcc, 0, v66
  s_nop 1
  v_cndmask_b32 v4, v4, v68, vcc
  v_cmp_eq_u32 vcc, 1, v66
  s_nop 1
  v_cndmask_b32 v4, v4, v69, vcc
  v_mov_b32 v5, 0
  v_cmp_eq_u32 vcc, 2, v66
  s_nop 1
  v_cndmask_b32 v5, v5, v68, vcc
  v_cmp_eq_u32 vcc, 3, v66
  s_nop 1
  v_cndmask_b32 v5, v5, v69, vcc
  v_mov_b32 v6, 0
  v_cmp_eq_u32 vcc, 4, v66
  s_nop 1
  v_cndmask_b32 v6, v6, v68, vcc
  v_cmp_eq_u32 vcc, 5, v66
  s_nop 1
  v_cndmask_b32 v6, v6, v69, vcc
  v_mov_b32 v7, 0
  v_cmp_eq_u32 vcc, 6, v66
  s_nop 1
  v_cndmask_b32 v7, v7, v68, vcc
  v_cmp_eq_u32 vcc, 7, v66
  s_nop 1
  v_cndmask_b32 v7, v7, v69, vcc
  v_lshrrev_b32 v64, 1, v116
  v_lshrrev_b32 v65, 3, v117
  v_cmp_eq_u32 s[26:27], v64, v65
  v_and_b32 v66, 1, v116
  v_add_u32 v64, 0, v64
  v_lshrrev_b32 v67, 1, v116
  v_lshlrev_b32 v67, 8, v67
  v_lshl_add_u32 v67, v66, 9, v67
  v_lshl_add_u32 v67, v117, 4, v67
  v_add_u32 v112, 57344, v67
  v_and_b32 v68, 7, v117
  v_lshlrev_b32 v67, 8, v64
  v_lshl_add_u32 v67, v68, 5, v67
  v_lshl_add_u32 v67, v66, 4, v67
  v_add_u32 v113, 65536, v67
  v_lshrrev_b32 v64, 5, v1
  v_and_b32 v65, 31, v1
  v_lshrrev_b32 v66, 3, v65
  v_and_b32 v67, 7, v65
  v_and_b32 v68, 3, v67
  v_lshl_add_u32 v68, v66, 2, v68
  v_lshrrev_b32 v69, 2, v67
  v_lshl_add_u32 v68, v69, 4, v68
  v_lshlrev_b32 v69, 11, v64
  v_lshl_add_u32 v69, v68, 4, v69
  v_add_u32 v114, 57344, v69
  v_add_u32 v70, 0, v64
  v_lshlrev_b32 v69, 9, v66
  v_lshl_add_u32 v69, v70, 5, v69
  v_lshl_add_u32 v69, v67, 2, v69
  v_add_u32 v115, 65536, v69
  v_lshlrev_b32 v69, 4, v68
  v_lshl_add_u32 v69, v64, 9, v69
  v_add_u32 v114, 57344, v69
  v_mul_u32_u24 v69, 144, v70
  v_lshl_add_u32 v69, v67, 4, v69
  v_add_u32 v115, 65536, v69
  v_and_b32 v71, 1, v116
  v_mul_u32_u24 v69, 2048, v71
  v_lshl_add_u32 v69, v64, 8, v69
  v_lshl_add_u32 v69, v117, 4, v69
  v_add_u32 v112, 57344, v69
  v_mul_u32_u24 v69, 144, v117
  v_lshl_add_u32 v69, v71, 6, v69
  v_lshl_add_u32 v69, v64, 5, v69
  v_add_u32 v113, 65536, v69
  v_mul_u32_u24 v69, 1024, v116
  v_lshl_add_u32 v69, v117, 4, v69
  v_and_b32 v72, 8, v117
  v_xor_b32 v72, 0, v72
  v_add_u32 v69, v69, v72
  v_add_u32 v112, 57344, v69
  v_lshrrev_b32 v72, 3, v117
  v_lshl_add_u32 v72, v71, 1, v72
  v_xor_b32 v72, 0, v72
  v_lshlrev_b32 v69, 10, v116
  v_lshl_add_u32 v69, v117, 4, v69
  v_lshl_add_u32 v69, v72, 2, v69
  v_add_u32 v112, 57344, v69
  v_lshrrev_b32 v69, 1, v117
  v_and_b32 v72, 1, v117
  v_lshl_add_u32 v69, v72, 3, v69
  v_mul_u32_u24 v69, 144, v69
  v_lshl_add_u32 v69, v71, 6, v69
  v_lshl_add_u32 v69, v64, 5, v69
  v_lshl_add_u32 v72, v72, 1, v71
  v_xor_b32 v72, 0, v72
  v_lshl_add_u32 v69, v72, 2, v69
  v_add_u32 v113, 65536, v69
  v_and_b32 v71, 1, v1
  v_cmp_eq_u32 s[38:39], 0, v71
  v_cmp_gt_u32 vcc, 8, v65
  s_or_b64 s[28:29], s[38:39], vcc
  v_lshrrev_b32 v72, 1, v67
  v_lshlrev_b32 v72, 2, v72
  v_lshl_add_u32 v72, v70, 4, v72
  s_lshl_b32 s22, s17, 9
  s_add_u32 s22, s22, 9216
  v_lshl_add_u32 v73, v66, 7, v72
  v_add_u32 v73, s22, v73
  s_lshl_b32 s22, s17, 7
  s_add_u32 s22, s22, 7168
  v_add_u32 v74, s22, v72
  v_bfe_u32 v72, v65, 1, 1
  v_lshlrev_b32 v72, 7, v72
  v_lshl_add_u32 v72, v70, 4, v72
  v_bfe_u32 v73, v65, 2, 2
  v_lshl_add_u32 v72, v73, 2, v72
  v_lshrrev_b32 v73, 4, v65
  v_lshl_add_u32 v73, v73, 8, v72
  s_lshl_b32 s22, s17, 9
  s_add_u32 s22, s22, 9216
  v_add_u32 v73, s22, v73
  s_lshr_b32 s22, s17, 1
  s_lshl_b32 s22, s22, 8
  s_and_b32 s34, s17, 1
  s_lshl_b32 s34, s34, 3
  s_add_u32 s22, s22, s34
  s_add_u32 s22, s22, 7168
  v_add_u32 v74, s22, v72
  v_bfe_u32 v72, v65, 1, 1
  v_lshl_add_u32 v72, v64, 1, v72
  v_lshlrev_b32 v72, 4, v72
  v_bfe_u32 v73, v65, 2, 2
  v_lshl_add_u32 v72, v73, 2, v72
  v_lshrrev_b32 v73, 4, v65
  v_lshl_add_u32 v73, v73, 6, v72
  s_lshl_b32 s22, s17, 9
  s_add_u32 s22, s22, 9216
  v_add_u32 v73, s22, v73
  v_lshrrev_b32 v72, 1, v65
  v_lshlrev_b32 v72, 2, v72
  v_lshl_add_u32 v72, v64, 5, v72
  s_lshr_b32 s22, s17, 1
  s_lshl_b32 s22, s22, 8
  s_and_b32 s34, s17, 1
  s_lshl_b32 s34, s34, 4
  s_add_u32 s22, s22, s34
  s_add_u32 s22, s22, 7168
  v_add_u32 v74, s22, v72
  v_lshlrev_b32 v0, 2, v65
  v_and_b32 v0, 0x78, v0
  s_and_b32 s22, s17, 15
  s_lshl_b32 s22, s22, 7
  s_add_u32 s22, s22, 18432
  v_add_u32 v0, s22, v0
  v_cndmask_b32 v1, v74, v73, s[38:39]
  s_lshl_b32 s36, s17, 2
  s_add_u32 s36, s36, 17408
  s_mov_b32 s37, 0x3e800000
  v_mov_b32 v64, 0
  v_mov_b32 v65, 0
  v_mov_b32 v66, 0
  v_mov_b32 v67, 0
  v_mov_b32 v68, 0
  v_mov_b32 v69, 0
  v_mov_b32 v70, 0
  v_mov_b32 v71, 0
  v_mov_b32 v72, 0
  v_mov_b32 v73, 0
  v_mov_b32 v74, 0
  v_mov_b32 v75, 0
  v_mov_b32 v76, 0
  v_mov_b32 v77, 0
  v_mov_b32 v78, 0
  v_mov_b32 v79, 0
  v_mov_b32 v80, 0
  v_mov_b32 v81, 0
  v_mov_b32 v82, 0
  v_mov_b32 v83, 0
  v_mov_b32 v84, 0
  v_mov_b32 v85, 0
  v_mov_b32 v86, 0
  v_mov_b32 v87, 0
  v_mov_b32 v88, 0
  v_mov_b32 v89, 0
  v_mov_b32 v90, 0
  v_mov_b32 v91, 0
  v_mov_b32 v92, 0
  v_mov_b32 v93, 0
  v_mov_b32 v94, 0
  v_mov_b32 v95, 0
  v_mov_b32 v96, 0
  v_mov_b32 v97, 0
  v_mov_b32 v98, 0
  v_mov_b32 v99, 0
  v_mov_b32 v100, 0
  v_mov_b32 v101, 0
  v_mov_b32 v102, 0
  v_mov_b32 v103, 0
  v_mov_b32 v104, 0
  v_mov_b32 v105, 0
  v_mov_b32 v106, 0
  v_mov_b32 v107, 0
  v_mov_b32 v108, 0
  v_mov_b32 v109, 0
  v_mov_b32 v110, 0
  v_mov_b32 v111, 0
  v_and_b32 v118, 1, v116
  v_cmp_eq_u32 vcc, 0, v118
  v_mov_b32 v118, 12288
  v_mov_b32 v119, 8192
  v_cndmask_b32 v118, v118, v119, vcc
  v_lshrrev_b32 v116, 1, v116
  v_lshl_add_u32 v118, v116, 9, v118
  v_lshl_add_u32 v117, v117, 4, v118
  s_mov_b32 s57, 28672
  v_bfe_u32 v118, v2, 4, 1
  v_mul_u32_u24 v118, 0xaaaa, v118
  v_add_u32 v118, 0x4444, v118
  s_mov_b32 s56, 0x42800000
  v_mov_b32 v116, v2
  s_mul_i32 s35, s17, 1835008
  s_add_u32 s35, s35, 42262528
  s_mov_b32 s30, 0
  v_mov_b32 v36, 0
ch_md0:
  buffer_load_dword v37, v36, s[12:15], 0 offen sc1
  s_waitcnt vmcnt(0)
  v_readfirstlane_b32 s22, v37
  s_and_b32 s31, s22, 0xffff
  s_cmp_ge_u32 s31, 32
  s_cbranch_scc1 ch_go0
  s_sleep 2
  s_add_u32 s30, s30, 1
  s_cmp_lt_u32 s30, 50000
  s_cbranch_scc1 ch_md0
  s_branch ch_end
ch_go0:
  s_mov_b32 s31, 0
  s_lshr_b32 s22, s22, 16
  s_cmp_lg_u32 s22, 0
  s_cbranch_scc1 cB_sc0_loop
  s_branch cA_sc0_loop
ch_init1:
  s_mul_i32 s31, s17, 401408
  s_add_u32 s31, s31, 0
  s_mov_b32 s24, 71572480
  s_mov_b32 s25, 0
  s_add_u32 m0, s25, 7168
  s_nop 0
  buffer_load_dwordx4 v2, s[8:11], s24 offen offset:0 sc1 lds
  buffer_load_dwordx4 v2, s[8:11], s24 offen offset:1024 sc1 lds
  buffer_load_dwordx4 v2, s[8:11], s24 offen offset:2048 sc1 lds
  buffer_load_dwordx4 v2, s[8:11], s24 offen offset:3072 sc1 lds
  s_add_u32 m0, s25, 11264
  s_add_u32 s22, s24, 4096
  buffer_load_dwordx4 v2, s[8:11], s22 offen offset:0 sc1 lds
  buffer_load_dwordx4 v2, s[8:11], s22 offen offset:1024 sc1 lds
  buffer_load_dwordx4 v2, s[8:11], s22 offen offset:2048 sc1 lds
  v_lshrrev_b32 v64, 1, v117
  v_and_b32 v65, 1, v116
  v_lshlrev_b32 v65, 2, v65
  v_sub_u32 v64, v64, v65
  v_and_b32 v65, 1, v117
  v_lshl_add_u32 v66, v65, 2, v64
  v_cmp_gt_u32 vcc, 4, v64
  v_mov_b32 v67, 99
  s_nop 0
  v_cndmask_b32 v66, v67, v66, vcc
  v_mov_b32 v68, 0x3f80
  v_mov_b32 v69, 0x3f800000
  v_mov_b32 v4, 0
  v_cmp_eq_u32 vcc, 0, v66
  s_nop 1
  v_cndmask_b32 v4, v4, v68, vcc
  v_cmp_eq_u32 vcc, 1, v66
  s_nop 1
  v_cndmask_b32 v4, v4, v69, vcc
  v_mov_b32 v5, 0
  v_cmp_eq_u32 vcc, 2, v66
  s_nop 1
  v_cndmask_b32 v5, v5, v68, vcc
  v_cmp_eq_u32 vcc, 3, v66
  s_nop 1
  v_cndmask_b32 v5, v5, v69, vcc
  v_mov_b32 v6, 0
  v_cmp_eq_u32 vcc, 4, v66
  s_nop 1
  v_cndmask_b32 v6, v6, v68, vcc
  v_cmp_eq_u32 vcc, 5, v66
  s_nop 1
  v_cndmask_b32 v6, v6, v69, vcc
  v_mov_b32 v7, 0
  v_cmp_eq_u32 vcc, 6, v66
  s_nop 1
  v_cndmask_b32 v7, v7, v68, vcc
  v_cmp_eq_u32 vcc, 7, v66
  s_nop 1
  v_cndmask_b32 v7, v7, v69, vcc
  v_lshrrev_b32 v64, 1, v116
  v_lshrrev_b32 v65, 3, v117
  v_cmp_eq_u32 s[26:27], v64, v65
  v_and_b32 v66, 1, v116
  v_add_u32 v64, 2, v64
  v_lshrrev_b32 v67, 1, v116
  v_lshlrev_b32 v67, 8, v67
  v_lshl_add_u32 v67, v66, 9, v67
  v_lshl_add_u32 v67, v117, 4, v67
  v_add_u32 v112, 58368, v67
  v_and_b32 v68, 7, v117
  v_lshlrev_b32 v67, 8, v64
  v_lshl_add_u32 v67, v68, 5, v67
  v_lshl_add_u32 v67, v66, 4, v67
  v_add_u32 v113, 65536, v67
  v_lshrrev_b32 v64, 5, v1
  v_and_b32 v65, 31, v1
  v_lshrrev_b32 v66, 3, v65
  v_and_b32 v67, 7, v65
  v_and_b32 v68, 3, v67
  v_lshl_add_u32 v68, v66, 2, v68
  v_lshrrev_b32 v69, 2, v67
  v_lshl_add_u32 v68, v69, 4, v68
  v_lshlrev_b32 v69, 11, v64
  v_lshl_add_u32 v69, v68, 4, v69
  v_add_u32 v114, 57352, v69
  v_add_u32 v70, 2, v64
  v_lshlrev_b32 v69, 9, v66
  v_lshl_add_u32 v69, v70, 5, v69
  v_lshl_add_u32 v69, v67, 2, v69
  v_add_u32 v115, 65536, v69
  v_lshlrev_b32 v69, 4, v68
  v_lshl_add_u32 v69, v64, 9, v69
  v_add_u32 v114, 58368, v69
  v_mul_u32_u24 v69, 144, v70
  v_lshl_add_u32 v69, v67, 4, v69
  v_add_u32 v115, 65536, v69
  v_and_b32 v71, 1, v116
  v_mul_u32_u24 v69, 2048, v71
  v_lshl_add_u32 v69, v64, 8, v69
  v_lshl_add_u32 v69, v117, 4, v69
  v_add_u32 v112, 57352, v69
  v_mul_u32_u24 v69, 144, v117
  v_lshl_add_u32 v69, v71, 6, v69
  v_lshl_add_u32 v69, v64, 5, v69
  v_add_u32 v113, 65540, v69
  v_mul_u32_u24 v69, 1024, v116
  v_lshl_add_u32 v69, v117, 4, v69
  v_and_b32 v72, 8, v117
  v_xor_b32 v72, 8, v72
  v_add_u32 v69, v69, v72
  v_add_u32 v112, 57344, v69
  v_lshrrev_b32 v72, 3, v117
  v_lshl_add_u32 v72, v71, 1, v72
  v_xor_b32 v72, 1, v72
  v_lshlrev_b32 v69, 10, v116
  v_lshl_add_u32 v69, v117, 4, v69
  v_lshl_add_u32 v69, v72, 2, v69
  v_add_u32 v112, 57344, v69
  v_lshrrev_b32 v69, 1, v117
  v_and_b32 v72, 1, v117
  v_lshl_add_u32 v69, v72, 3, v69
  v_mul_u32_u24 v69, 144, v69
  v_lshl_add_u32 v69, v71, 6, v69
  v_lshl_add_u32 v69, v64, 5, v69
  v_lshl_add_u32 v72, v72, 1, v71
  v_xor_b32 v72, 1, v72
  v_lshl_add_u32 v69, v72, 2, v69
  v_add_u32 v113, 65536, v69
  v_and_b32 v71, 1, v1
  v_cmp_eq_u32 s[38:39], 0, v71
  v_cmp_gt_u32 vcc, 8, v65
  s_or_b64 s[28:29], s[38:39], vcc
  v_lshrrev_b32 v72, 1, v67
  v_lshlrev_b32 v72, 2, v72
  v_lshl_add_u32 v72, v70, 4, v72
  s_lshl_b32 s22, s17, 9
  s_add_u32 s22, s22, 9216
  v_lshl_add_u32 v73, v66, 7, v72
  v_add_u32 v73, s22, v73
  s_lshl_b32 s22, s17, 7
  s_add_u32 s22, s22, 7168
  v_add_u32 v74, s22, v72
  v_bfe_u32 v72, v65, 1, 1
  v_lshlrev_b32 v72, 7, v72
  v_lshl_add_u32 v72, v70, 4, v72
  v_bfe_u32 v73, v65, 2, 2
  v_lshl_add_u32 v72, v73, 2, v72
  v_lshrrev_b32 v73, 4, v65
  v_lshl_add_u32 v73, v73, 8, v72
  s_lshl_b32 s22, s17, 9
  s_add_u32 s22, s22, 9216
  v_add_u32 v73, s22, v73
  s_lshr_b32 s22, s17, 1
  s_lshl_b32 s22, s22, 8
  s_and_b32 s34, s17, 1
  s_lshl_b32 s34, s34, 3
  s_add_u32 s22, s22, s34
  s_add_u32 s22, s22, 7168
  v_add_u32 v74, s22, v72
  v_bfe_u32 v72, v65, 1, 1
  v_lshl_add_u32 v72, v64, 1, v72
  v_lshlrev_b32 v72, 4, v72
  v_bfe_u32 v73, v65, 2, 2
  v_lshl_add_u32 v72, v73, 2, v72
  v_lshrrev_b32 v73, 4, v65
  v_lshl_add_u32 v73, v73, 6, v72
  s_lshl_b32 s22, s17, 9
  s_add_u32 s22, s22, 9344
  v_add_u32 v73, s22, v73
  v_lshrrev_b32 v72, 1, v65
  v_lshlrev_b32 v72, 2, v72
  v_lshl_add_u32 v72, v64, 5, v72
  s_lshr_b32 s22, s17, 1
  s_lshl_b32 s22, s22, 8
  s_and_b32 s34, s17, 1
  s_lshl_b32 s34, s34, 4
  s_add_u32 s22, s22, s34
  s_add_u32 s22, s22, 7232
  v_add_u32 v74, s22, v72
  v_lshlrev_b32 v0, 2, v65
  v_and_b32 v0, 0x78, v0
  s_and_b32 s22, s17, 15
  s_lshl_b32 s22, s22, 7
  s_add_u32 s22, s22, 18432
  v_add_u32 v0, s22, v0
  v_cndmask_b32 v1, v74, v73, s[38:39]
  s_lshl_b32 s36, s17, 2
  s_add_u32 s36, s36, 17408
  s_mov_b32 s37, 0x3e800000
  v_mov_b32 v64, 0
  v_mov_b32 v65, 0
  v_mov_b32 v66, 0
  v_mov_b32 v67, 0
  v_mov_b32 v68, 0
  v_mov_b32 v69, 0
  v_mov_b32 v70, 0
  v_mov_b32 v71, 0
  v_mov_b32 v72, 0
  v_mov_b32 v73, 0
  v_mov_b32 v74, 0
  v_mov_b32 v75, 0
  v_mov_b32 v76, 0
  v_mov_b32 v77, 0
  v_mov_b32 v78, 0
  v_mov_b32 v79, 0
  v_mov_b32 v80, 0
  v_mov_b32 v81, 0
  v_mov_b32 v82, 0
  v_mov_b32 v83, 0
  v_mov_b32 v84, 0
  v_mov_b32 v85, 0
  v_mov_b32 v86, 0
  v_mov_b32 v87, 0
  v_mov_b32 v88, 0
  v_mov_b32 v89, 0
  v_mov_b32 v90, 0
  v_mov_b32 v91, 0
  v_mov_b32 v92, 0
  v_mov_b32 v93, 0
  v_mov_b32 v94, 0
  v_mov_b32 v95, 0
  v_mov_b32 v96, 0
  v_mov_b32 v97, 0
  v_mov_b32 v98, 0
  v_mov_b32 v99, 0
  v_mov_b32 v100, 0
  v_mov_b32 v101, 0
  v_mov_b32 v102, 0
  v_mov_b32 v103, 0
  v_mov_b32 v104, 0
  v_mov_b32 v105, 0
  v_mov_b32 v106, 0
  v_mov_b32 v107, 0
  v_mov_b32 v108, 0
  v_mov_b32 v109, 0
  v_mov_b32 v110, 0
  v_mov_b32 v111, 0
  v_and_b32 v118, 1, v116
  v_cmp_eq_u32 vcc, 0, v118
  v_mov_b32 v118, 12288
  v_mov_b32 v119, 8448
  v_cndmask_b32 v118, v118, v119, vcc
  v_lshrrev_b32 v116, 1, v116
  v_lshl_add_u32 v118, v116, 9, v118
  v_lshl_add_u32 v117, v117, 4, v118
  s_mov_b32 s57, 28672
  v_bfe_u32 v118, v2, 4, 1
  v_mul_u32_u24 v118, 0xaaaa, v118
  v_add_u32 v118, 0x4444, v118
  s_mov_b32 s56, 0x42800000
  v_mov_b32 v116, v2
  v_lshrrev_b32 v0, 4, v2
  v_min_u32 v0, 9, v0
  s_mul_i32 s22, s17, 10
  v_add_u32 v0, s22, v0
  v_lshlrev_b32 v0, 7, v0
  v_add_u32 v0, 40960, v0
  s_mov_b32 s22, 88633344
  buffer_load_dword v119, v0, s[8:11], s22 offen sc1
  s_mov_b32 s22, 88612864
  buffer_load_dword v119, v0, s[8:11], s22 offen sc1
  s_mul_i32 s35, s17, 1835008
  s_add_u32 s35, s35, 42269696
  s_mov_b32 s30, 0
  v_mov_b32 v36, 0
ch_md1:
  buffer_load_dword v37, v36, s[12:15], 0 offen sc1
  s_waitcnt vmcnt(0)
  v_readfirstlane_b32 s22, v37
  s_and_b32 s31, s22, 0xffff
  s_cmp_ge_u32 s31, 32
  s_cbranch_scc1 ch_go1
  s_sleep 2
  s_add_u32 s30, s30, 1
  s_cmp_lt_u32 s30, 50000
  s_cbranch_scc1 ch_md1
  s_branch ch_end
ch_go1:
  s_mov_b32 s31, 0
  s_lshr_b32 s22, s22, 16
  s_cmp_lg_u32 s22, 0
  s_cbranch_scc1 cB_sc1_loop
  s_branch cA_sc1_loop
ch_init2:
  s_mul_i32 s31, s17, 401408
  s_add_u32 s31, s31, 0
  s_mov_b32 s24, 71579648
  s_mov_b32 s25, 0
  s_add_u32 m0, s25, 14336
  s_nop 0
  buffer_load_dwordx4 v2, s[8:11], s24 offen offset:0 sc1 lds
  buffer_load_dwordx4 v2, s[8:11], s24 offen offset:1024 sc1 lds
  buffer_load_dwordx4 v2, s[8:11], s24 offen offset:2048 sc1 lds
  buffer_load_dwordx4 v2, s[8:11], s24 offen offset:3072 sc1 lds
  s_add_u32 m0, s25, 18432
  s_add_u32 s22, s24, 4096
  buffer_load_dwordx4 v2, s[8:11], s22 offen offset:0 sc1 lds
  buffer_load_dwordx4 v2, s[8:11], s22 offen offset:1024 sc1 lds
  buffer_load_dwordx4 v2, s[8:11], s22 offen offset:2048 sc1 lds
  v_lshrrev_b32 v64, 1, v117
  v_and_b32 v65, 1, v116
  v_lshlrev_b32 v65, 2, v65
  v_sub_u32 v64, v64, v65
  v_and_b32 v65, 1, v117
  v_lshl_add_u32 v66, v65, 2, v64
  v_cmp_gt_u32 vcc, 4, v64
  v_mov_b32 v67, 99
  s_nop 0
  v_cndmask_b32 v66, v67, v66, vcc
  v_mov_b32 v68, 0x3f80
  v_mov_b32 v69, 0x3f800000
  v_mov_b32 v4, 0
  v_cmp_eq_u32 vcc, 0, v66
  s_nop 1
  v_cndmask_b32 v4, v4, v68, vcc
  v_cmp_eq_u32 vcc, 1, v66
  s_nop 1
  v_cndmask_b32 v4, v4, v69, vcc
  v_mov_b32 v5, 0
  v_cmp_eq_u32 vcc, 2, v66
  s_nop 1
  v_cndmask_b32 v5, v5, v68, vcc
  v_cmp_eq_u32 vcc, 3, v66
  s_nop 1
  v_cndmask_b32 v5, v5, v69, vcc
  v_mov_b32 v6, 0
  v_cmp_eq_u32 vcc, 4, v66
  s_nop 1
  v_cndmask_b32 v6, v6, v68, vcc
  v_cmp_eq_u32 vcc, 5, v66
  s_nop 1
  v_cndmask_b32 v6, v6, v69, vcc
  v_mov_b32 v7, 0
  v_cmp_eq_u32 vcc, 6, v66
  s_nop 1
  v_cndmask_b32 v7, v7, v68, vcc
  v_cmp_eq_u32 vcc, 7, v66
  s_nop 1
  v_cndmask_b32 v7, v7, v69, vcc
  v_lshrrev_b32 v64, 1, v116
  v_lshrrev_b32 v65, 3, v117
  v_cmp_eq_u32 s[26:27], v64, v65
  v_and_b32 v66, 1, v116
  v_add_u32 v64, 4, v64
  v_lshrrev_b32 v67, 1, v116
  v_lshlrev_b32 v67, 8, v67
  v_lshl_add_u32 v67, v66, 9, v67
  v_lshl_add_u32 v67, v117, 4, v67
  v_add_u32 v112, 59392, v67
  v_and_b32 v68, 7, v117
  v_lshlrev_b32 v67, 8, v64
  v_lshl_add_u32 v67, v68, 5, v67
  v_lshl_add_u32 v67, v66, 4, v67
  v_add_u32 v113, 65536, v67
  v_lshrrev_b32 v64, 5, v1
  v_and_b32 v65, 31, v1
  v_lshrrev_b32 v66, 3, v65
  v_and_b32 v67, 7, v65
  v_and_b32 v68, 3, v67
  v_lshl_add_u32 v68, v66, 2, v68
  v_lshrrev_b32 v69, 2, v67
  v_lshl_add_u32 v68, v69, 4, v68
  v_lshlrev_b32 v69, 11, v64
  v_lshl_add_u32 v69, v68, 4, v69
  v_add_u32 v114, 57856, v69
  v_add_u32 v70, 4, v64
  v_lshlrev_b32 v69, 9, v66
  v_lshl_add_u32 v69, v70, 5, v69
  v_lshl_add_u32 v69, v67, 2, v69
  v_add_u32 v115, 65536, v69
  v_lshlrev_b32 v69, 4, v68
  v_lshl_add_u32 v69, v64, 9, v69
  v_add_u32 v114, 59392, v69
  v_mul_u32_u24 v69, 144, v70
  v_lshl_add_u32 v69, v67, 4, v69
  v_add_u32 v115, 65536, v69
  v_and_b32 v71, 1, v116
  v_mul_u32_u24 v69, 2048, v71
  v_lshl_add_u32 v69, v64, 8, v69
  v_lshl_add_u32 v69, v117, 4, v69
  v_add_u32 v112, 57856, v69
  v_mul_u32_u24 v69, 144, v117
  v_lshl_add_u32 v69, v71, 6, v69
  v_lshl_add_u32 v69, v64, 5, v69
  v_add_u32 v113, 65544, v69
  v_mul_u32_u24 v69, 1024, v116
  v_lshl_add_u32 v69, v117, 4, v69
  v_and_b32 v72, 8, v117
  v_xor_b32 v72, 0, v72
  v_add_u32 v69, v69, v72
  v_add_u32 v112, 57856, v69
  v_lshrrev_b32 v72, 3, v117
  v_lshl_add_u32 v72, v71, 1, v72
  v_xor_b32 v72, 2, v72
  v_lshlrev_b32 v69, 10, v116
  v_lshl_add_u32 v69, v117, 4, v69
  v_lshl_add_u32 v69, v72, 2, v69
  v_add_u32 v112, 57344, v69
  v_lshrrev_b32 v69, 1, v117
  v_and_b32 v72, 1, v117
  v_lshl_add_u32 v69, v72, 3, v69
  v_mul_u32_u24 v69, 144, v69
  v_lshl_add_u32 v69, v71, 6, v69
  v_lshl_add_u32 v69, v64, 5, v69
  v_lshl_add_u32 v72, v72, 1, v71
  v_xor_b32 v72, 2, v72
  v_lshl_add_u32 v69, v72, 2, v69
  v_add_u32 v113, 65536, v69
  v_and_b32 v71, 1, v1
  v_cmp_eq_u32 s[38:39], 0, v71
  v_cmp_gt_u32 vcc, 8, v65
  s_or_b64 s[28:29], s[38:39], vcc
  v_lshrrev_b32 v72, 1, v67
  v_lshlrev_b32 v72, 2, v72
  v_lshl_add_u32 v72, v70, 4, v72
  s_lshl_b32 s22, s17, 9
  s_add_u32 s22, s22, 9216
  v_lshl_add_u32 v73, v66, 7, v72
  v_add_u32 v73, s22, v73
  s_lshl_b32 s22, s17, 7
  s_add_u32 s22, s22, 7168
  v_add_u32 v74, s22, v72
  v_bfe_u32 v72, v65, 1, 1
  v_lshlrev_b32 v72, 7, v72
  v_lshl_add_u32 v72, v70, 4, v72
  v_bfe_u32 v73, v65, 2, 2
  v_lshl_add_u32 v72, v73, 2, v72
  v_lshrrev_b32 v73, 4, v65
  v_lshl_add_u32 v73, v73, 8, v72
  s_lshl_b32 s22, s17, 9
  s_add_u32 s22, s22, 9216
  v_add_u32 v73, s22, v73
  s_lshr_b32 s22, s17, 1
  s_lshl_b32 s22, s22, 8
  s_and_b32 s34, s17, 1
  s_lshl_b32 s34, s34, 3
  s_add_u32 s22, s22, s34
  s_add_u32 s22, s22, 7168
  v_add_u32 v74, s22, v72
  v_bfe_u32 v72, v65, 1, 1
  v_lshl_add_u32 v72, v64, 1, v72
  v_lshlrev_b32 v72, 4, v72
  v_bfe_u32 v73, v65, 2, 2
  v_lshl_add_u32 v72, v73, 2, v72
  v_lshrrev_b32 v73, 4, v65
  v_lshl_add_u32 v73, v73, 6, v72
  s_lshl_b32 s22, s17, 9
  s_add_u32 s22, s22, 9472
  v_add_u32 v73, s22, v73
  v_lshrrev_b32 v72, 1, v65
  v_lshlrev_b32 v72, 2, v72
  v_lshl_add_u32 v72, v64, 5, v72
  s_lshr_b32 s22, s17, 1
  s_lshl_b32 s22, s22, 8
  s_and_b32 s34, s17, 1
  s_lshl_b32 s34, s34, 4
  s_add_u32 s22, s22, s34
  s_add_u32 s22, s22, 7296
  v_add_u32 v74, s22, v72
  v_lshlrev_b32 v0, 2, v65
  v_and_b32 v0, 0x78, v0
  s_and_b32 s22, s17, 15
  s_lshl_b32 s22, s22, 7
  s_add_u32 s22, s22, 18432
  v_add_u32 v0, s22, v0
  v_cndmask_b32 v1, v74, v73, s[38:39]
  s_lshl_b32 s36, s17, 2
  s_add_u32 s36, s36, 17408
  s_mov_b32 s37, 0x3e800000
  v_mov_b32 v64, 0
  v_mov_b32 v65, 0
  v_mov_b32 v66, 0
  v_mov_b32 v67, 0
  v_mov_b32 v68, 0
  v_mov_b32 v69, 0
  v_mov_b32 v70, 0
  v_mov_b32 v71, 0
  v_mov_b32 v72, 0
  v_mov_b32 v73, 0
  v_mov_b32 v74, 0
  v_mov_b32 v75, 0
  v_mov_b32 v76, 0
  v_mov_b32 v77, 0
  v_mov_b32 v78, 0
  v_mov_b32 v79, 0
  v_mov_b32 v80, 0
  v_mov_b32 v81, 0
  v_mov_b32 v82, 0
  v_mov_b32 v83, 0
  v_mov_b32 v84, 0
  v_mov_b32 v85, 0
  v_mov_b32 v86, 0
  v_mov_b32 v87, 0
  v_mov_b32 v88, 0
  v_mov_b32 v89, 0
  v_mov_b32 v90, 0
  v_mov_b32 v91, 0
  v_mov_b32 v92, 0
  v_mov_b32 v93, 0
  v_mov_b32 v94, 0
  v_mov_b32 v95, 0
  v_mov_b32 v96, 0
  v_mov_b32 v97, 0
  v_mov_b32 v98, 0
  v_mov_b32 v99, 0
  v_mov_b32 v100, 0
  v_mov_b32 v101, 0
  v_mov_b32 v102, 0
  v_mov_b32 v103, 0
  v_mov_b32 v104, 0
  v_mov_b32 v105, 0
  v_mov_b32 v106, 0
  v_mov_b32 v107, 0
  v_mov_b32 v108, 0
  v_mov_b32 v109, 0
  v_mov_b32 v110, 0
  v_mov_b32 v111, 0
  v_and_b32 v118, 1, v116
  v_cmp_eq_u32 vcc, 0, v118
  v_mov_b32 v118, 12544
  v_mov_b32 v119, 10240
  v_cndmask_b32 v118, v118, v119, vcc
  v_lshrrev_b32 v116, 1, v116
  v_lshl_add_u32 v118, v116, 9, v118
  v_lshl_add_u32 v117, v117, 4, v118
  s_mov_b32 s57, 28672
  v_bfe_u32 v118, v2, 4, 1
  v_mul_u32_u24 v118, 0xaaaa, v118
  v_add_u32 v118, 0x4444, v118
  s_mov_b32 s56, 0x42800000
  v_mov_b32 v116, v2
  v_lshrrev_b32 v0, 4, v2
  v_min_u32 v0, 13, v0
  s_mul_i32 s22, s17, 14
  v_add_u32 v0, s22, v0
  v_lshlrev_b32 v0, 7, v0
  v_add_u32 v0, 43008, v0
  s_mov_b32 s22, 71550976
  buffer_load_dword v119, v0, s[8:11], s22 offen sc1
  s_mov_b32 s22, 71522304
  buffer_load_dword v119, v0, s[8:11], s22 offen sc1
  s_mul_i32 s35, s17, 1835008
  s_add_u32 s35, s35, 42276864
  s_mov_b32 s30, 0
  v_mov_b32 v36, 0
ch_md2:
  buffer_load_dword v37, v36, s[12:15], 0 offen sc1
  s_waitcnt vmcnt(0)
  v_readfirstlane_b32 s22, v37
  s_and_b32 s31, s22, 0xffff
  s_cmp_ge_u32 s31, 32
  s_cbranch_scc1 ch_go2
  s_sleep 2
  s_add_u32 s30, s30, 1
  s_cmp_lt_u32 s30, 50000
  s_cbranch_scc1 ch_md2
  s_branch ch_end
ch_go2:
  s_mov_b32 s31, 0
  s_lshr_b32 s22, s22, 16
  s_cmp_lg_u32 s22, 0
  s_cbranch_scc1 cB_sc2_loop
  s_branch cA_sc2_loop
ch_init3:
  s_mul_i32 s31, s17, 401408
  s_add_u32 s31, s31, 0
  s_mov_b32 s24, 71586816
  s_mov_b32 s25, 0
  s_add_u32 m0, s25, 21504
  s_nop 0
  buffer_load_dwordx4 v2, s[8:11], s24 offen offset:0 sc1 lds
  buffer_load_dwordx4 v2, s[8:11], s24 offen offset:1024 sc1 lds
  buffer_load_dwordx4 v2, s[8:11], s24 offen offset:2048 sc1 lds
  buffer_load_dwordx4 v2, s[8:11], s24 offen offset:3072 sc1 lds
  s_add_u32 m0, s25, 25600
  s_add_u32 s22, s24, 4096
  buffer_load_dwordx4 v2, s[8:11], s22 offen offset:0 sc1 lds
  buffer_load_dwordx4 v2, s[8:11], s22 offen offset:1024 sc1 lds
  buffer_load_dwordx4 v2, s[8:11], s22 offen offset:2048 sc1 lds
  v_lshrrev_b32 v64, 1, v117
  v_and_b32 v65, 1, v116
  v_lshlrev_b32 v65, 2, v65
  v_sub_u32 v64, v64, v65
  v_and_b32 v65, 1, v117
  v_lshl_add_u32 v66, v65, 2, v64
  v_cmp_gt_u32 vcc, 4, v64
  v_mov_b32 v67, 99
  s_nop 0
  v_cndmask_b32 v66, v67, v66, vcc
  v_mov_b32 v68, 0x3f80
  v_mov_b32 v69, 0x3f800000
  v_mov_b32 v4, 0
  v_cmp_eq_u32 vcc, 0, v66
  s_nop 1
  v_cndmask_b32 v4, v4, v68, vcc
  v_cmp_eq_u32 vcc, 1, v66
  s_nop 1
  v_cndmask_b32 v4, v4, v69, vcc
  v_mov_b32 v5, 0
  v_cmp_eq_u32 vcc, 2, v66
  s_nop 1
  v_cndmask_b32 v5, v5, v68, vcc
  v_cmp_eq_u32 vcc, 3, v66
  s_nop 1
  v_cndmask_b32 v5, v5, v69, vcc
  v_mov_b32 v6, 0
  v_cmp_eq_u32 vcc, 4, v66
  s_nop 1
  v_cndmask_b32 v6, v6, v68, vcc
  v_cmp_eq_u32 vcc, 5, v66
  s_nop 1
  v_cndmask_b32 v6, v6, v69, vcc
  v_mov_b32 v7, 0
  v_cmp_eq_u32 vcc, 6, v66
  s_nop 1
  v_cndmask_b32 v7, v7, v68, vcc
  v_cmp_eq_u32 vcc, 7, v66
  s_nop 1
  v_cndmask_b32 v7, v7, v69, vcc
  v_lshrrev_b32 v64, 1, v116
  v_lshrrev_b32 v65, 3, v117
  v_cmp_eq_u32 s[26:27], v64, v65
  v_and_b32 v66, 1, v116
  v_add_u32 v64, 6, v64
  v_lshrrev_b32 v67, 1, v116
  v_lshlrev_b32 v67, 8, v67
  v_lshl_add_u32 v67, v66, 9, v67
  v_lshl_add_u32 v67, v117, 4, v67
  v_add_u32 v112, 60416, v67
  v_and_b32 v68, 7, v117
  v_lshlrev_b32 v67, 8, v64
  v_lshl_add_u32 v67, v68, 5, v67
  v_lshl_add_u32 v67, v66, 4, v67
  v_add_u32 v113, 65536, v67
  v_lshrrev_b32 v64, 5, v1
  v_and_b32 v65, 31, v1
  v_lshrrev_b32 v66, 3, v65
  v_and_b32 v67, 7, v65
  v_and_b32 v68, 3, v67
  v_lshl_add_u32 v68, v66, 2, v68
  v_lshrrev_b32 v69, 2, v67
  v_lshl_add_u32 v68, v69, 4, v68
  v_lshlrev_b32 v69, 11, v64
  v_lshl_add_u32 v69, v68, 4, v69
  v_add_u32 v114, 57864, v69
  v_add_u32 v70, 6, v64
  v_lshlrev_b32 v69, 9, v66
  v_lshl_add_u32 v69, v70, 5, v69
  v_lshl_add_u32 v69, v67, 2, v69
  v_add_u32 v115, 65536, v69
  v_lshlrev_b32 v69, 4, v68
  v_lshl_add_u32 v69, v64, 9, v69
  v_add_u32 v114, 60416, v69
  v_mul_u32_u24 v69, 144, v70
  v_lshl_add_u32 v69, v67, 4, v69
  v_add_u32 v115, 65536, v69
  v_and_b32 v71, 1, v116
  v_mul_u32_u24 v69, 2048, v71
  v_lshl_add_u32 v69, v64, 8, v69
  v_lshl_add_u32 v69, v117, 4, v69
  v_add_u32 v112, 57864, v69
  v_mul_u32_u24 v69, 144, v117
  v_lshl_add_u32 v69, v71, 6, v69
  v_lshl_add_u32 v69, v64, 5, v69
  v_add_u32 v113, 65548, v69
  v_mul_u32_u24 v69, 1024, v116
  v_lshl_add_u32 v69, v117, 4, v69
  v_and_b32 v72, 8, v117
  v_xor_b32 v72, 8, v72
  v_add_u32 v69, v69, v72
  v_add_u32 v112, 57856, v69
  v_lshrrev_b32 v72, 3, v117
  v_lshl_add_u32 v72, v71, 1, v72
  v_xor_b32 v72, 3, v72
  v_lshlrev_b32 v69, 10, v116
  v_lshl_add_u32 v69, v117, 4, v69
  v_lshl_add_u32 v69, v72, 2, v69
  v_add_u32 v112, 57344, v69
  v_lshrrev_b32 v69, 1, v117
  v_and_b32 v72, 1, v117
  v_lshl_add_u32 v69, v72, 3, v69
  v_mul_u32_u24 v69, 144, v69
  v_lshl_add_u32 v69, v71, 6, v69
  v_lshl_add_u32 v69, v64, 5, v69
  v_lshl_add_u32 v72, v72, 1, v71
  v_xor_b32 v72, 3, v72
  v_lshl_add_u32 v69, v72, 2, v69
  v_add_u32 v113, 65536, v69
  v_and_b32 v71, 1, v1
  v_cmp_eq_u32 s[38:39], 0, v71
  v_cmp_gt_u32 vcc, 8, v65
  s_or_b64 s[28:29], s[38:39], vcc
  v_lshrrev_b32 v72, 1, v67
  v_lshlrev_b32 v72, 2, v72
  v_lshl_add_u32 v72, v70, 4, v72
  s_lshl_b32 s22, s17, 9
  s_add_u32 s22, s22, 9216
  v_lshl_add_u32 v73, v66, 7, v72
  v_add_u32 v73, s22, v73
  s_lshl_b32 s22, s17, 7
  s_add_u32 s22, s22, 7168
  v_add_u32 v74, s22, v72
  v_bfe_u32 v72, v65, 1, 1
  v_lshlrev_b32 v72, 7, v72
  v_lshl_add_u32 v72, v70, 4, v72
  v_bfe_u32 v73, v65, 2, 2
  v_lshl_add_u32 v72, v73, 2, v72
  v_lshrrev_b32 v73, 4, v65
  v_lshl_add_u32 v73, v73, 8, v72
  s_lshl_b32 s22, s17, 9
  s_add_u32 s22, s22, 9216
  v_add_u32 v73, s22, v73
  s_lshr_b32 s22, s17, 1
  s_lshl_b32 s22, s22, 8
  s_and_b32 s34, s17, 1
  s_lshl_b32 s34, s34, 3
  s_add_u32 s22, s22, s34
  s_add_u32 s22, s22, 7168
  v_add_u32 v74, s22, v72
  v_bfe_u32 v72, v65, 1, 1
  v_lshl_add_u32 v72, v64, 1, v72
  v_lshlrev_b32 v72, 4, v72
  v_bfe_u32 v73, v65, 2, 2
  v_lshl_add_u32 v72, v73, 2, v72
  v_lshrrev_b32 v73, 4, v65
  v_lshl_add_u32 v73, v73, 6, v72
  s_lshl_b32 s22, s17, 9
  s_add_u32 s22, s22, 9600
  v_add_u32 v73, s22, v73
  v_lshrrev_b32 v72, 1, v65
  v_lshlrev_b32 v72, 2, v72
  v_lshl_add_u32 v72, v64, 5, v72
  s_lshr_b32 s22, s17, 1
  s_lshl_b32 s22, s22, 8
  s_and_b32 s34, s17, 1
  s_lshl_b32 s34, s34, 4
  s_add_u32 s22, s22, s34
  s_add_u32 s22, s22, 7360
  v_add_u32 v74, s22, v72
  v_lshlrev_b32 v0, 2, v65
  v_and_b32 v0, 0x78, v0
  s_and_b32 s22, s17, 15
  s_lshl_b32 s22, s22, 7
  s_add_u32 s22, s22, 18432
  v_add_u32 v0, s22, v0
  v_cndmask_b32 v1, v74, v73, s[38:39]
  s_lshl_b32 s36, s17, 2
  s_add_u32 s36, s36, 17408
  s_mov_b32 s37, 0x3e800000
  v_mov_b32 v64, 0
  v_mov_b32 v65, 0
  v_mov_b32 v66, 0
  v_mov_b32 v67, 0
  v_mov_b32 v68, 0
  v_mov_b32 v69, 0
  v_mov_b32 v70, 0
  v_mov_b32 v71, 0
  v_mov_b32 v72, 0
  v_mov_b32 v73, 0
  v_mov_b32 v74, 0
  v_mov_b32 v75, 0
  v_mov_b32 v76, 0
  v_mov_b32 v77, 0
  v_mov_b32 v78, 0
  v_mov_b32 v79, 0
  v_mov_b32 v80, 0
  v_mov_b32 v81, 0
  v_mov_b32 v82, 0
  v_mov_b32 v83, 0
  v_mov_b32 v84, 0
  v_mov_b32 v85, 0
  v_mov_b32 v86, 0
  v_mov_b32 v87, 0
  v_mov_b32 v88, 0
  v_mov_b32 v89, 0
  v_mov_b32 v90, 0
  v_mov_b32 v91, 0
  v_mov_b32 v92, 0
  v_mov_b32 v93, 0
  v_mov_b32 v94, 0
  v_mov_b32 v95, 0
  v_mov_b32 v96, 0
  v_mov_b32 v97, 0
  v_mov_b32 v98, 0
  v_mov_b32 v99, 0
  v_mov_b32 v100, 0
  v_mov_b32 v101, 0
  v_mov_b32 v102, 0
  v_mov_b32 v103, 0
  v_mov_b32 v104, 0
  v_mov_b32 v105, 0
  v_mov_b32 v106, 0
  v_mov_b32 v107, 0
  v_mov_b32 v108, 0
  v_mov_b32 v109, 0
  v_mov_b32 v110, 0
  v_mov_b32 v111, 0
  v_and_b32 v118, 1, v116
  v_cmp_eq_u32 vcc, 0, v118
  v_mov_b32 v118, 12544
  v_mov_b32 v119, 10496
  v_cndmask_b32 v118, v118, v119, vcc
  v_lshrrev_b32 v116, 1, v116
  v_lshl_add_u32 v118, v116, 9, v118
  v_lshl_add_u32 v117, v117, 4, v118
  s_mov_b32 s57, 28672
  v_bfe_u32 v118, v2, 4, 1
  v_mul_u32_u24 v118, 0xaaaa, v118
  v_add_u32 v118, 0x4444, v118
  s_mov_b32 s56, 0x42800000
  v_mov_b32 v116, v2
  s_mul_i32 s35, s17, 1835008
  s_add_u32 s35, s35, 42284032
  s_mov_b32 s30, 0
  v_mov_b32 v36, 0
ch_md3:
  buffer_load_dword v37, v36, s[12:15], 0 offen sc1
  s_waitcnt vmcnt(0)
  v_readfirstlane_b32 s22, v37
  s_and_b32 s31, s22, 0xffff
  s_cmp_ge_u32 s31, 32
  s_cbranch_scc1 ch_go3
  s_sleep 2
  s_add_u32 s30, s30, 1
  s_cmp_lt_u32 s30, 50000
  s_cbranch_scc1 ch_md3
  s_branch ch_end
ch_go3:
  s_mov_b32 s31, 0
  s_lshr_b32 s22, s22, 16
  s_cmp_lg_u32 s22, 0
  s_cbranch_scc1 cB_sc3_loop
  s_branch cA_sc3_loop
ch_init4:
  s_mul_i32 s31, s17, 401408
  s_add_u32 s31, s31, 6422528
  s_mul_i32 s22, s17, 12
  s_add_u32 s23, s22, 267
  s_add_u32 s22, s22, 256
  v_mov_b32 v36, s23
  v_mov_b32 v37, s22
  v_cmp_eq_u32 vcc, 1, v116
  s_lshl_b32 s22, s17, 4
  s_nop 0
  v_cndmask_b32 v36, v36, v37, vcc
  v_mov_b32 v37, s22
  v_cmp_eq_u32 vcc, 0, v116
  s_nop 1
  v_cndmask_b32 v36, v36, v37, vcc
  v_lshrrev_b32 v36, 6, v36
  v_lshlrev_b32 v36, 8, v36
  v_med3_u32 v37, v117, 0, 3
  v_lshl_add_u32 v36, v37, 4, v36
  s_mov_b32 s22, 88600576
  s_mov_b32 s30, 0
va_bw_11:
  buffer_load_dwordx4 v[40:43], v36, s[8:11], s22 offen sc1
  s_waitcnt vmcnt(0)
  v_cmp_ne_u64 vcc, s[88:89], v[40:41]
  s_cbranch_vccnz va_bw_11_no
  v_cmp_ne_u64 vcc, s[88:89], v[42:43]
  s_cbranch_vccnz va_bw_11_no
  s_branch va_bw_11_ok
va_bw_11_no:
  s_sleep 2
  s_add_u32 s30, s30, 1
  s_cmp_lt_u32 s30, 50000
  s_cbranch_scc1 va_bw_11
  s_branch cA_abort
va_bw_11_ok:
  s_add_u32 s22, s31, 0
  buffer_load_dwordx4 a[0:3], v2, s[8:11], s22 offen offset:0 sc1
  buffer_load_dwordx4 a[4:7], v2, s[8:11], s22 offen offset:1024 sc1
  buffer_load_dwordx4 a[8:11], v2, s[8:11], s22 offen offset:2048 sc1
  buffer_load_dwordx4 a[12:15], v2, s[8:11], s22 offen offset:3072 sc1
  s_add_u32 s22, s31, 4096
  buffer_load_dwordx4 a[16:19], v2, s[8:11], s22 offen offset:0 sc1
  buffer_load_dwordx4 a[20:23], v2, s[8:11], s22 offen offset:1024 sc1
  buffer_load_dwordx4 a[24:27], v2, s[8:11], s22 offen offset:2048 sc1
  buffer_load_dwordx4 a[28:31], v2, s[8:11], s22 offen offset:3072 sc1
  s_add_u32 s22, s31, 8192
  buffer_load_dwordx4 a[32:35], v2, s[8:11], s22 offen offset:0 sc1
  buffer_load_dwordx4 a[36:39], v2, s[8:11], s22 offen offset:1024 sc1
  buffer_load_dwordx4 a[40:43], v2, s[8:11], s22 offen offset:2048 sc1
  buffer_load_dwordx4 a[44:47], v2, s[8:11], s22 offen offset:3072 sc1
  s_add_u32 s22, s31, 12288
  buffer_load_dwordx4 a[48:51], v2, s[8:11], s22 offen offset:0 sc1
  buffer_load_dwordx4 a[52:55], v2, s[8:11], s22 offen offset:1024 sc1
  buffer_load_dwordx4 a[56:59], v2, s[8:11], s22 offen offset:2048 sc1
  buffer_load_dwordx4 a[60:63], v2, s[8:11], s22 offen offset:3072 sc1
  s_add_u32 s22, s31, 16384
  buffer_load_dwordx4 a[64:67], v2, s[8:11], s22 offen offset:0 sc1
  buffer_load_dwordx4 a[68:71], v2, s[8:11], s22 offen offset:1024 sc1
  buffer_load_dwordx4 a[72:75], v2, s[8:11], s22 offen offset:2048 sc1
  buffer_load_dwordx4 a[76:79], v2, s[8:11], s22 offen offset:3072 sc1
  s_add_u32 s22, s31, 20480
  buffer_load_dwordx4 a[80:83], v2, s[8:11], s22 offen offset:0 sc1
  buffer_load_dwordx4 a[84:87], v2, s[8:11], s22 offen offset:1024 sc1
  buffer_load_dwordx4 a[88:91], v2, s[8:11], s22 offen offset:2048 sc1
  buffer_load_dwordx4 a[92:95], v2, s[8:11], s22 offen offset:3072 sc1
  s_add_u32 s22, s31, 24576
  buffer_load_dwordx4 a[96:99], v2, s[8:11], s22 offen offset:0 sc1
  buffer_load_dwordx4 a[100:103], v2, s[8:11], s22 offen offset:1024 sc1
  buffer_load_dwordx4 a[104:107], v2, s[8:11], s22 offen offset:2048 sc1
  buffer_load_dwordx4 a[108:111], v2, s[8:11], s22 offen offset:3072 sc1
  s_add_u32 s22, s31, 28672
  buffer_load_dwordx4 a[112:115], v2, s[8:11], s22 offen offset:0 sc1
  buffer_load_dwordx4 a[116:119], v2, s[8:11], s22 offen offset:1024 sc1
  buffer_load_dwordx4 a[120:123], v2, s[8:11], s22 offen offset:2048 sc1
  buffer_load_dwordx4 a[124:127], v2, s[8:11], s22 offen offset:3072 sc1
  s_waitcnt vmcnt(24)
  s_add_u32 s22, s31, 32768
  buffer_load_dwordx4 a[128:131], v2, s[8:11], s22 offen offset:0 sc1
  buffer_load_dwordx4 a[132:135], v2, s[8:11], s22 offen offset:1024 sc1
  buffer_load_dwordx4 a[136:139], v2, s[8:11], s22 offen offset:2048 sc1
  buffer_load_dwordx4 a[140:143], v2, s[8:11], s22 offen offset:3072 sc1
  s_add_u32 s22, s31, 36864
  buffer_load_dwordx4 a[144:147], v2, s[8:11], s22 offen offset:0 sc1
  buffer_load_dwordx4 a[148:151], v2, s[8:11], s22 offen offset:1024 sc1
  buffer_load_dwordx4 a[152:155], v2, s[8:11], s22 offen offset:2048 sc1
  buffer_load_dwordx4 a[156:159], v2, s[8:11], s22 offen offset:3072 sc1
  s_add_u32 s22, s31, 40960
  buffer_load_dwordx4 a[160:163], v2, s[8:11], s22 offen offset:0 sc1
  buffer_load_dwordx4 a[164:167], v2, s[8:11], s22 offen offset:1024 sc1
  buffer_load_dwordx4 a[168:171], v2, s[8:11], s22 offen offset:2048 sc1
  buffer_load_dwordx4 a[172:175], v2, s[8:11], s22 offen offset:3072 sc1
  s_add_u32 s22, s31, 45056
  buffer_load_dwordx4 a[176:179], v2, s[8:11], s22 offen offset:0 sc1
  buffer_load_dwordx4 a[180:183], v2, s[8:11], s22 offen offset:1024 sc1
  buffer_load_dwordx4 a[184:187], v2, s[8:11], s22 offen offset:2048 sc1
  buffer_load_dwordx4 a[188:191], v2, s[8:11], s22 offen offset:3072 sc1
  s_add_u32 s22, s31, 49152
  buffer_load_dwordx4 a[192:195], v2, s[8:11], s22 offen offset:0 sc1
  buffer_load_dwordx4 a[196:199], v2, s[8:11], s22 offen offset:1024 sc1
  buffer_load_dwordx4 a[200:203], v2, s[8:11], s22 offen offset:2048 sc1
  buffer_load_dwordx4 a[204:207], v2, s[8:11], s22 offen offset:3072 sc1
  s_add_u32 s22, s31, 53248
  buffer_load_dwordx4 a[208:211], v2, s[8:11], s22 offen offset:0 sc1
  buffer_load_dwordx4 a[212:215], v2, s[8:11], s22 offen offset:1024 sc1
  buffer_load_dwordx4 a[216:219], v2, s[8:11], s22 offen offset:2048 sc1
  buffer_load_dwordx4 a[220:223], v2, s[8:11], s22 offen offset:3072 sc1
  s_add_u32 s22, s31, 57344
  buffer_load_dwordx4 a[224:227], v2, s[8:11], s22 offen offset:0 sc1
  buffer_load_dwordx4 a[228:231], v2, s[8:11], s22 offen offset:1024 sc1
  buffer_load_dwordx4 a[232:235], v2, s[8:11], s22 offen offset:2048 sc1
  buffer_load_dwordx4 a[236:239], v2, s[8:11], s22 offen offset:3072 sc1
  s_add_u32 s22, s31, 61440
  buffer_load_dwordx4 a[240:243], v2, s[8:11], s22 offen offset:0 sc1
  buffer_load_dwordx4 a[244:247], v2, s[8:11], s22 offen offset:1024 sc1
  buffer_load_dwordx4 a[248:251], v2, s[8:11], s22 offen offset:2048 sc1
  buffer_load_dwordx4 a[252:255], v2, s[8:11], s22 offen offset:3072 sc1
  s_waitcnt vmcnt(24)
  s_add_u32 s22, s31, 65536
  buffer_load_dwordx4 v[176:179], v2, s[8:11], s22 offen offset:0 sc1
  buffer_load_dwordx4 v[180:183], v2, s[8:11], s22 offen offset:1024 sc1
  buffer_load_dwordx4 v[184:187], v2, s[8:11], s22 offen offset:2048 sc1
  buffer_load_dwordx4 v[188:191], v2, s[8:11], s22 offen offset:3072 sc1
  s_add_u32 s22, s31, 69632
  buffer_load_dwordx4 v[192:195], v2, s[8:11], s22 offen offset:0 sc1
  buffer_load_dwordx4 v[196:199], v2, s[8:11], s22 offen offset:1024 sc1
  buffer_load_dwordx4 v[200:203], v2, s[8:11], s22 offen offset:2048 sc1
  buffer_load_dwordx4 v[204:207], v2, s[8:11], s22 offen offset:3072 sc1
  s_add_u32 s22, s31, 73728
  buffer_load_dwordx4 v[208:211], v2, s[8:11], s22 offen offset:0 sc1
  buffer_load_dwordx4 v[212:215], v2, s[8:11], s22 offen offset:1024 sc1
  buffer_load_dwordx4 v[216:219], v2, s[8:11], s22 offen offset:2048 sc1
  buffer_load_dwordx4 v[220:223], v2, s[8:11], s22 offen offset:3072 sc1
  s_add_u32 s22, s31, 77824
  buffer_load_dwordx4 v[224:227], v2, s[8:11], s22 offen offset:0 sc1
  buffer_load_dwordx4 v[228:231], v2, s[8:11], s22 offen offset:1024 sc1
  buffer_load_dwordx4 v[232:235], v2, s[8:11], s22 offen offset:2048 sc1
  buffer_load_dwordx4 v[236:239], v2, s[8:11], s22 offen offset:3072 sc1
  s_add_u32 s22, s31, 81920
  buffer_load_dwordx4 v[240:243], v2, s[8:11], s22 offen offset:0 sc1
  buffer_load_dwordx4 v[244:247], v2, s[8:11], s22 offen offset:1024 sc1
  buffer_load_dwordx4 v[248:251], v2, s[8:11], s22 offen offset:2048 sc1
  buffer_load_dwordx4 v[252:255], v2, s[8:11], s22 offen offset:3072 sc1
  s_mul_i32 s22, s17, 12
  s_add_u32 s23, s22, 267
  s_add_u32 s22, s22, 256
  v_mov_b32 v36, s23
  v_mov_b32 v37, s22
  v_cmp_eq_u32 vcc, 1, v116
  s_lshl_b32 s22, s17, 4
  s_nop 0
  v_cndmask_b32 v36, v36, v37, vcc
  v_mov_b32 v37, s22
  v_cmp_eq_u32 vcc, 0, v116
  s_nop 1
  v_cndmask_b32 v36, v36, v37, vcc
  v_lshrrev_b32 v36, 6, v36
  v_lshlrev_b32 v36, 8, v36
  v_med3_u32 v37, v117, 10, 11
  v_lshl_add_u32 v36, v37, 4, v36
  s_mov_b32 s22, 88600576
  s_mov_b32 s30, 0
va_bw_12:
  buffer_load_dwordx4 v[40:43], v36, s[8:11], s22 offen sc1
  s_waitcnt vmcnt(0)
  v_cmp_ne_u64 vcc, s[88:89], v[40:41]
  s_cbranch_vccnz va_bw_12_no
  v_cmp_ne_u64 vcc, s[88:89], v[42:43]
  s_cbranch_vccnz va_bw_12_no
  s_branch va_bw_12_ok
va_bw_12_no:
  s_sleep 2
  s_add_u32 s30, s30, 1
  s_cmp_lt_u32 s30, 50000
  s_cbranch_scc1 va_bw_12
  s_branch cA_abort
va_bw_12_ok:
  s_mov_b32 m0, 16384
  s_add_u32 s22, s31, 272384
  buffer_load_dwordx4 v2, s[8:11], s22 offen offset:0 sc1 lds
  buffer_load_dwordx4 v2, s[8:11], s22 offen offset:1024 sc1 lds
  buffer_load_dwordx4 v2, s[8:11], s22 offen offset:2048 sc1 lds
  buffer_load_dwordx4 v2, s[8:11], s22 offen offset:3072 sc1 lds
  s_mov_b32 m0, 20480
  s_add_u32 s22, s31, 276480
  buffer_load_dwordx4 v2, s[8:11], s22 offen offset:0 sc1 lds
  buffer_load_dwordx4 v2, s[8:11], s22 offen offset:1024 sc1 lds
  buffer_load_dwordx4 v2, s[8:11], s22 offen offset:2048 sc1 lds
  buffer_load_dwordx4 v2, s[8:11], s22 offen offset:3072 sc1 lds
  s_mov_b32 m0, 24576
  s_add_u32 s22, s31, 280576
  buffer_load_dwordx4 v2, s[8:11], s22 offen offset:0 sc1 lds
  buffer_load_dwordx4 v2, s[8:11], s22 offen offset:1024 sc1 lds
  buffer_load_dwordx4 v2, s[8:11], s22 offen offset:2048 sc1 lds
  buffer_load_dwordx4 v2, s[8:11], s22 offen offset:3072 sc1 lds
  s_mov_b32 m0, 28672
  s_add_u32 s22, s31, 284672
  buffer_load_dwordx4 v2, s[8:11], s22 offen offset:0 sc1 lds
  buffer_load_dwordx4 v2, s[8:11], s22 offen offset:1024 sc1 lds
  v_mov_b32 v72, v116
  v_mov_b32 v73, v117
  v_lshrrev_b32 v65, 1, v72
  v_and_b32 v66, 1, v72
  v_mov_b32 v67, 0
  v_lshl_add_u32 v67, v67, 4, v73
  v_mul_u32_u24 v68, 2341, v67
  v_lshrrev_b32 v68, 16, v68
  v_mul_u32_u24 v69, 28, v68
  v_sub_u32 v69, v67, v69
  v_lshrrev_b32 v70, 4, v69
  v_and_b32 v69, 15, v69
  v_and_b32 v71, 1, v69
  v_lshrrev_b32 v69, 1, v69
  v_lshl_add_u32 v69, v71, 3, v69
  v_lshlrev_b32 v71, 12, v70
  v_lshrrev_b32 v70, 1, v68
  v_lshl_add_u32 v71, v70, 9, v71
  v_and_b32 v70, 1, v68
  v_lshl_add_u32 v71, v70, 2, v71
  v_lshl_add_u32 v71, v69, 4, v71
  v_lshl_add_u32 v71, v65, 8, v71
  v_lshl_add_u32 v60, v66, 3, v71
  v_mov_b32 v67, 1
  v_lshl_add_u32 v67, v67, 4, v73
  v_mul_u32_u24 v68, 2341, v67
  v_lshrrev_b32 v68, 16, v68
  v_mul_u32_u24 v69, 28, v68
  v_sub_u32 v69, v67, v69
  v_lshrrev_b32 v70, 4, v69
  v_and_b32 v69, 15, v69
  v_and_b32 v71, 1, v69
  v_lshrrev_b32 v69, 1, v69
  v_lshl_add_u32 v69, v71, 3, v69
  v_lshlrev_b32 v71, 12, v70
  v_lshrrev_b32 v70, 1, v68
  v_lshl_add_u32 v71, v70, 9, v71
  v_and_b32 v70, 1, v68
  v_lshl_add_u32 v71, v70, 2, v71
  v_lshl_add_u32 v71, v69, 4, v71
  v_lshl_add_u32 v71, v65, 8, v71
  v_lshl_add_u32 v61, v66, 3, v71
  v_mov_b32 v67, 2
  v_lshl_add_u32 v67, v67, 4, v73
  v_mul_u32_u24 v68, 2341, v67
  v_lshrrev_b32 v68, 16, v68
  v_mul_u32_u24 v69, 28, v68
  v_sub_u32 v69, v67, v69
  v_lshrrev_b32 v70, 4, v69
  v_and_b32 v69, 15, v69
  v_and_b32 v71, 1, v69
  v_lshrrev_b32 v69, 1, v69
  v_lshl_add_u32 v69, v71, 3, v69
  v_lshlrev_b32 v71, 12, v70
  v_lshrrev_b32 v70, 1, v68
  v_lshl_add_u32 v71, v70, 9, v71
  v_and_b32 v70, 1, v68
  v_lshl_add_u32 v71, v70, 2, v71
  v_lshl_add_u32 v71, v69, 4, v71
  v_lshl_add_u32 v71, v65, 8, v71
  v_lshl_add_u32 v62, v66, 3, v71
  v_mov_b32 v67, 3
  v_lshl_add_u32 v67, v67, 4, v73
  v_mul_u32_u24 v68, 2341, v67
  v_lshrrev_b32 v68, 16, v68
  v_mul_u32_u24 v69, 28, v68
  v_sub_u32 v69, v67, v69
  v_lshrrev_b32 v70, 4, v69
  v_and_b32 v69, 15, v69
  v_and_b32 v71, 1, v69
  v_lshrrev_b32 v69, 1, v69
  v_lshl_add_u32 v69, v71, 3, v69
  v_lshlrev_b32 v71, 12, v70
  v_lshrrev_b32 v70, 1, v68
  v_lshl_add_u32 v71, v70, 9, v71
  v_and_b32 v70, 1, v68
  v_lshl_add_u32 v71, v70, 2, v71
  v_lshl_add_u32 v71, v69, 4, v71
  v_lshl_add_u32 v71, v65, 8, v71
  v_lshl_add_u32 v170, v66, 3, v71
  v_mov_b32 v67, 4
  v_lshl_add_u32 v67, v67, 4, v73
  v_mul_u32_u24 v68, 2341, v67
  v_lshrrev_b32 v68, 16, v68
  v_mul_u32_u24 v69, 28, v68
  v_sub_u32 v69, v67, v69
  v_lshrrev_b32 v70, 4, v69
  v_and_b32 v69, 15, v69
  v_and_b32 v71, 1, v69
  v_lshrrev_b32 v69, 1, v69
  v_lshl_add_u32 v69, v71, 3, v69
  v_lshlrev_b32 v71, 12, v70
  v_lshrrev_b32 v70, 1, v68
  v_lshl_add_u32 v71, v70, 9, v71
  v_and_b32 v70, 1, v68
  v_lshl_add_u32 v71, v70, 2, v71
  v_lshl_add_u32 v71, v69, 4, v71
  v_lshl_add_u32 v71, v65, 8, v71
  v_lshl_add_u32 v171, v66, 3, v71
  v_mov_b32 v67, 5
  v_lshl_add_u32 v67, v67, 4, v73
  v_mul_u32_u24 v68, 2341, v67
  v_lshrrev_b32 v68, 16, v68
  v_mul_u32_u24 v69, 28, v68
  v_sub_u32 v69, v67, v69
  v_lshrrev_b32 v70, 4, v69
  v_and_b32 v69, 15, v69
  v_and_b32 v71, 1, v69
  v_lshrrev_b32 v69, 1, v69
  v_lshl_add_u32 v69, v71, 3, v69
  v_lshlrev_b32 v71, 12, v70
  v_lshrrev_b32 v70, 1, v68
  v_lshl_add_u32 v71, v70, 9, v71
  v_and_b32 v70, 1, v68
  v_lshl_add_u32 v71, v70, 2, v71
  v_lshl_add_u32 v71, v69, 4, v71
  v_lshl_add_u32 v71, v65, 8, v71
  v_lshl_add_u32 v172, v66, 3, v71
  v_and_b32 v0, 31, v1
  v_lshlrev_b32 v0, 2, v0
  v_add_u32 v0, 18432, v0
  v_lshlrev_b32 v4, 2, v73
  s_and_b32 s22, s17, 3
  s_lshl_b32 s22, s22, 7
  s_add_u32 s22, s22, 17408
  v_add_u32 v4, s22, v4
  v_and_b32 v64, 7, v73
  v_lshlrev_b32 v5, 4, v64
  v_lshl_add_u32 v5, v72, 7, v5
  v_lshrrev_b32 v65, 3, v73
  v_lshl_add_u32 v5, v65, 9, v5
  s_lshl_b32 s22, s17, 3
  s_add_u32 s22, s22, 18432
  v_lshl_add_u32 v7, v2, 3, s22
  v_add_u32 v65, 0, v73
  v_min_u32 v65, 27, v65
  v_mad_u32_u24 v65, v72, 28, v65
  v_lshlrev_b32 v6, 4, v65
  s_lshr_b32 s22, s17, 1
  s_mul_i32 s22, s22, 7
  s_and_b32 s34, s17, 1
  s_lshl_b32 s35, s34, 2
  v_add_u32 v70, s35, v72
  v_mov_b32 v71, s34
  v_mov_b32 v69, 0
  v_cmp_eq_u32 vcc, 3, v72
  s_nop 1
  v_cndmask_b32 v70, v70, v72, vcc
  v_cndmask_b32 v69, v69, v71, vcc
  v_add_u32 v70, s22, v70
  v_lshrrev_b32 v68, 1, v70
  v_lshlrev_b32 v68, 8, v68
  v_lshl_add_u32 v68, v69, 7, v68
  v_and_b32 v69, 1, v70
  v_lshl_add_u32 v68, v69, 3, v68
  v_lshl_add_u32 v1, v64, 4, v68
  v_cmp_gt_u32 s[26:27], 8, v73
  v_lshrrev_b32 v65, 3, v73
  v_lshl_add_u32 v66, v64, 1, v65
  v_add_u32 v66, 0, v66
  v_min_u32 v66, 27, v66
  v_mad_u32_u24 v66, v72, 28, v66
  v_lshlrev_b32 v6, 4, v66
  s_mul_i32 s22, s17, 16
  s_add_u32 s22, s22, 0
  v_lshl_add_u32 v70, v64, 1, s22
  v_lshrrev_b32 v68, 4, v70
  v_lshlrev_b32 v68, 8, v68
  v_bfe_u32 v69, v70, 1, 1
  v_lshl_add_u32 v68, v69, 7, v68
  v_bfe_u32 v69, v70, 2, 2
  v_lshl_add_u32 v68, v69, 2, v68
  v_and_b32 v69, 1, v72
  v_lshl_add_u32 v65, v69, 2, v65
  v_lshrrev_b32 v69, 1, v72
  v_lshl_add_u32 v65, v69, 1, v65
  v_lshrrev_b32 v65, 3, v73
  v_lshl_add_u32 v65, v72, 1, v65
  v_lshrrev_b32 v5, 1, v72
  v_lshlrev_b32 v5, 9, v5
  v_lshrrev_b32 v69, 2, v73
  v_lshl_add_u32 v5, v69, 7, v5
  v_and_b32 v69, 1, v72
  v_lshl_add_u32 v5, v69, 6, v5
  v_and_b32 v69, 3, v73
  v_lshl_add_u32 v5, v69, 4, v5
  v_and_b32 v69, 1, v73
  v_mul_u32_u24 v69, 0xaaaa, v69
  v_add_u32 v0, 0x4444, v69
  v_lshl_add_u32 v1, v65, 4, v68
  v_cmp_gt_u32 s[26:27], 6, v64
  v_mov_b32 v156, 0
  v_mov_b32 v157, 0
  v_mov_b32 v158, 0
  v_mov_b32 v159, 0
  ds_write_b128 v2, v[156:159] offset:0
  ds_write_b128 v2, v[156:159] offset:1024
  ds_write_b128 v2, v[156:159] offset:2048
  ds_write_b128 v2, v[156:159] offset:3072
  s_mul_i32 s22, s17, 1835008
  s_add_u32 s25, s22, 42205184
  s_lshl_b32 s35, s17, 7
  s_add_u32 s35, s35, 88539136
  s_add_u32 s39, s35, 16384
  s_mov_b32 s38, 0
  v_mov_b32 v63, 0
  v_bfe_u32 v8, v2, 4, 1
  v_mul_u32_u24 v3, 0xaaaa, v8
  v_add_u32 v3, 0x4444, v3
  v_bfe_u32 v9, v2, 5, 3
  v_lshl_add_u32 v8, v8, 3, v9
  v_and_b32 v9, 0x300, v2
  v_lshl_add_u32 v0, v8, 4, v9
  s_lshl_b32 s22, 0, 11
  s_add_u32 s22, s22, 88602624
  v_add_u32 v36, 1024, v2
  v_min_u32 v36, 1776, v36
  s_mov_b32 s30, 0
va_iw4:
  buffer_load_dwordx4 v[40:43], v2, s[8:11], s22 offen sc1
  buffer_load_dwordx4 v[44:47], v36, s[8:11], s22 offen sc1
  s_waitcnt vmcnt(0)
  v_cmp_ne_u64 vcc, s[88:89], v[40:41]
  s_cbranch_vccnz va_iw4_no
  v_cmp_ne_u64 vcc, s[88:89], v[42:43]
  s_cbranch_vccnz va_iw4_no
  v_cmp_ne_u64 vcc, s[88:89], v[44:45]
  s_cbranch_vccnz va_iw4_no
  v_cmp_ne_u64 vcc, s[88:89], v[46:47]
  s_cbranch_vccnz va_iw4_no
  s_branch va_iw4_ok
va_iw4_no:
  s_sleep 2
  s_add_u32 s30, s30, 1
  s_cmp_lt_u32 s30, 50000
  s_cbranch_scc1 va_iw4
  s_branch cA_abort
va_iw4_ok:
  s_mov_b32 s30, 0
  v_mov_b32 v36, 0
ch_md4:
  buffer_load_dword v37, v36, s[12:15], 0 offen sc1
  s_waitcnt vmcnt(0)
  v_readfirstlane_b32 s22, v37
  s_and_b32 s31, s22, 0xffff
  s_cmp_ge_u32 s31, 32
  s_cbranch_scc1 ch_go4
  s_sleep 2
  s_add_u32 s30, s30, 1
  s_cmp_lt_u32 s30, 50000
  s_cbranch_scc1 ch_md4
  s_branch ch_end
ch_go4:
  s_mov_b32 s31, 0
  v_mov_b32 v36, 0
  v_mov_b32 v37, 0
  v_mov_b32 v38, 0
  v_mov_b32 v39, 0
  v_mov_b32 v40, 0
  v_mov_b32 v41, 0
  v_mov_b32 v42, 0
  v_mov_b32 v43, 0
  v_mov_b32 v44, 0
  v_mov_b32 v45, 0
  v_mov_b32 v46, 0
  v_mov_b32 v47, 0
  v_mov_b32 v48, 0
  v_mov_b32 v49, 0
  v_mov_b32 v50, 0
  v_mov_b32 v51, 0
  v_mov_b32 v52, 0
  v_mov_b32 v53, 0
  v_mov_b32 v54, 0
  v_mov_b32 v55, 0
  v_mov_b32 v56, 0
  v_mov_b32 v57, 0
  v_mov_b32 v58, 0
  v_mov_b32 v59, 0
  s_lshr_b32 s22, s22, 16
  s_cmp_lg_u32 s22, 0
  s_cbranch_scc1 cB_va0_loop
  s_branch cA_va0_loop
ch_init5:
  s_mul_i32 s31, s17, 401408
  s_add_u32 s31, s31, 6422528
  s_mul_i32 s22, s17, 12
  s_add_u32 s23, s22, 267
  s_add_u32 s22, s22, 256
  v_mov_b32 v36, s23
  v_mov_b32 v37, s22
  v_cmp_eq_u32 vcc, 1, v116
  s_lshl_b32 s22, s17, 4
  s_nop 0
  v_cndmask_b32 v36, v36, v37, vcc
  v_mov_b32 v37, s22
  v_cmp_eq_u32 vcc, 0, v116
  s_nop 1
  v_cndmask_b32 v36, v36, v37, vcc
  v_lshrrev_b32 v36, 6, v36
  v_lshlrev_b32 v36, 8, v36
  v_med3_u32 v37, v117, 3, 6
  v_lshl_add_u32 v36, v37, 4, v36
  s_mov_b32 s22, 88600576
  s_mov_b32 s30, 0
va_bw_13:
  buffer_load_dwordx4 v[40:43], v36, s[8:11], s22 offen sc1
  s_waitcnt vmcnt(0)
  v_cmp_ne_u64 vcc, s[88:89], v[40:41]
  s_cbranch_vccnz va_bw_13_no
  v_cmp_ne_u64 vcc, s[88:89], v[42:43]
  s_cbranch_vccnz va_bw_13_no
  s_branch va_bw_13_ok
va_bw_13_no:
  s_sleep 2
  s_add_u32 s30, s30, 1
  s_cmp_lt_u32 s30, 50000
  s_cbranch_scc1 va_bw_13
  s_branch cA_abort
va_bw_13_ok:
  s_add_u32 s22, s31, 86016
  buffer_load_dwordx4 a[0:3], v2, s[8:11], s22 offen offset:0 sc1
  buffer_load_dwordx4 a[4:7], v2, s[8:11], s22 offen offset:1024 sc1
  buffer_load_dwordx4 a[8:11], v2, s[8:11], s22 offen offset:2048 sc1
  buffer_load_dwordx4 a[12:15], v2, s[8:11], s22 offen offset:3072 sc1
  s_add_u32 s22, s31, 90112
  buffer_load_dwordx4 a[16:19], v2, s[8:11], s22 offen offset:0 sc1
  buffer_load_dwordx4 a[20:23], v2, s[8:11], s22 offen offset:1024 sc1
  buffer_load_dwordx4 a[24:27], v2, s[8:11], s22 offen offset:2048 sc1
  buffer_load_dwordx4 a[28:31], v2, s[8:11], s22 offen offset:3072 sc1
  s_add_u32 s22, s31, 94208
  buffer_load_dwordx4 a[32:35], v2, s[8:11], s22 offen offset:0 sc1
  buffer_load_dwordx4 a[36:39], v2, s[8:11], s22 offen offset:1024 sc1
  buffer_load_dwordx4 a[40:43], v2, s[8:11], s22 offen offset:2048 sc1
  buffer_load_dwordx4 a[44:47], v2, s[8:11], s22 offen offset:3072 sc1
  s_add_u32 s22, s31, 98304
  buffer_load_dwordx4 a[48:51], v2, s[8:11], s22 offen offset:0 sc1
  buffer_load_dwordx4 a[52:55], v2, s[8:11], s22 offen offset:1024 sc1
  buffer_load_dwordx4 a[56:59], v2, s[8:11], s22 offen offset:2048 sc1
  buffer_load_dwordx4 a[60:63], v2, s[8:11], s22 offen offset:3072 sc1
  s_add_u32 s22, s31, 102400
  buffer_load_dwordx4 a[64:67], v2, s[8:11], s22 offen offset:0 sc1
  buffer_load_dwordx4 a[68:71], v2, s[8:11], s22 offen offset:1024 sc1
  buffer_load_dwordx4 a[72:75], v2, s[8:11], s22 offen offset:2048 sc1
  buffer_load_dwordx4 a[76:79], v2, s[8:11], s22 offen offset:3072 sc1
  s_add_u32 s22, s31, 106496
  buffer_load_dwordx4 a[80:83], v2, s[8:11], s22 offen offset:0 sc1
  buffer_load_dwordx4 a[84:87], v2, s[8:11], s22 offen offset:1024 sc1
  buffer_load_dwordx4 a[88:91], v2, s[8:11], s22 offen offset:2048 sc1
  buffer_load_dwordx4 a[92:95], v2, s[8:11], s22 offen offset:3072 sc1
  s_add_u32 s22, s31, 110592
  buffer_load_dwordx4 a[96:99], v2, s[8:11], s22 offen offset:0 sc1
  buffer_load_dwordx4 a[100:103], v2, s[8:11], s22 offen offset:1024 sc1
  buffer_load_dwordx4 a[104:107], v2, s[8:11], s22 offen offset:2048 sc1
  buffer_load_dwordx4 a[108:111], v2, s[8:11], s22 offen offset:3072 sc1
  s_add_u32 s22, s31, 114688
  buffer_load_dwordx4 a[112:115], v2, s[8:11], s22 offen offset:0 sc1
  buffer_load_dwordx4 a[116:119], v2, s[8:11], s22 offen offset:1024 sc1
  buffer_load_dwordx4 a[120:123], v2, s[8:11], s22 offen offset:2048 sc1
  buffer_load_dwordx4 a[124:127], v2, s[8:11], s22 offen offset:3072 sc1
  s_waitcnt vmcnt(24)
  s_add_u32 s22, s31, 118784
  buffer_load_dwordx4 a[128:131], v2, s[8:11], s22 offen offset:0 sc1
  buffer_load_dwordx4 a[132:135], v2, s[8:11], s22 offen offset:1024 sc1
  buffer_load_dwordx4 a[136:139], v2, s[8:11], s22 offen offset:2048 sc1
  buffer_load_dwordx4 a[140:143], v2, s[8:11], s22 offen offset:3072 sc1
  s_add_u32 s22, s31, 122880
  buffer_load_dwordx4 a[144:147], v2, s[8:11], s22 offen offset:0 sc1
  buffer_load_dwordx4 a[148:151], v2, s[8:11], s22 offen offset:1024 sc1
  buffer_load_dwordx4 a[152:155], v2, s[8:11], s22 offen offset:2048 sc1
  buffer_load_dwordx4 a[156:159], v2, s[8:11], s22 offen offset:3072 sc1
  s_add_u32 s22, s31, 126976
  buffer_load_dwordx4 a[160:163], v2, s[8:11], s22 offen offset:0 sc1
  buffer_load_dwordx4 a[164:167], v2, s[8:11], s22 offen offset:1024 sc1
  buffer_load_dwordx4 a[168:171], v2, s[8:11], s22 offen offset:2048 sc1
  buffer_load_dwordx4 a[172:175], v2, s[8:11], s22 offen offset:3072 sc1
  s_add_u32 s22, s31, 131072
  buffer_load_dwordx4 a[176:179], v2, s[8:11], s22 offen offset:0 sc1
  buffer_load_dwordx4 a[180:183], v2, s[8:11], s22 offen offset:1024 sc1
  buffer_load_dwordx4 a[184:187], v2, s[8:11], s22 offen offset:2048 sc1
  buffer_load_dwordx4 a[188:191], v2, s[8:11], s22 offen offset:3072 sc1
  s_add_u32 s22, s31, 135168
  buffer_load_dwordx4 a[192:195], v2, s[8:11], s22 offen offset:0 sc1
  buffer_load_dwordx4 a[196:199], v2, s[8:11], s22 offen offset:1024 sc1
  buffer_load_dwordx4 a[200:203], v2, s[8:11], s22 offen offset:2048 sc1
  buffer_load_dwordx4 a[204:207], v2, s[8:11], s22 offen offset:3072 sc1
  s_add_u32 s22, s31, 139264
  buffer_load_dwordx4 a[208:211], v2, s[8:11], s22 offen offset:0 sc1
  buffer_load_dwordx4 a[212:215], v2, s[8:11], s22 offen offset:1024 sc1
  buffer_load_dwordx4 a[216:219], v2, s[8:11], s22 offen offset:2048 sc1
  buffer_load_dwordx4 a[220:223], v2, s[8:11], s22 offen offset:3072 sc1
  s_add_u32 s22, s31, 143360
  buffer_load_dwordx4 a[224:227], v2, s[8:11], s22 offen offset:0 sc1
  buffer_load_dwordx4 a[228:231], v2, s[8:11], s22 offen offset:1024 sc1
  buffer_load_dwordx4 a[232:235], v2, s[8:11], s22 offen offset:2048 sc1
  buffer_load_dwordx4 a[236:239], v2, s[8:11], s22 offen offset:3072 sc1
  s_add_u32 s22, s31, 147456
  buffer_load_dwordx4 a[240:243], v2, s[8:11], s22 offen offset:0 sc1
  buffer_load_dwordx4 a[244:247], v2, s[8:11], s22 offen offset:1024 sc1
  buffer_load_dwordx4 a[248:251], v2, s[8:11], s22 offen offset:2048 sc1
  buffer_load_dwordx4 a[252:255], v2, s[8:11], s22 offen offset:3072 sc1
  s_waitcnt vmcnt(24)
  s_add_u32 s22, s31, 151552
  buffer_load_dwordx4 v[176:179], v2, s[8:11], s22 offen offset:0 sc1
  buffer_load_dwordx4 v[180:183], v2, s[8:11], s22 offen offset:1024 sc1
  buffer_load_dwordx4 v[184:187], v2, s[8:11], s22 offen offset:2048 sc1
  buffer_load_dwordx4 v[188:191], v2, s[8:11], s22 offen offset:3072 sc1
  s_add_u32 s22, s31, 155648
  buffer_load_dwordx4 v[192:195], v2, s[8:11], s22 offen offset:0 sc1
  buffer_load_dwordx4 v[196:199], v2, s[8:11], s22 offen offset:1024 sc1
  buffer_load_dwordx4 v[200:203], v2, s[8:11], s22 offen offset:2048 sc1
  buffer_load_dwordx4 v[204:207], v2, s[8:11], s22 offen offset:3072 sc1
  s_add_u32 s22, s31, 159744
  buffer_load_dwordx4 v[208:211], v2, s[8:11], s22 offen offset:0 sc1
  buffer_load_dwordx4 v[212:215], v2, s[8:11], s22 offen offset:1024 sc1
  buffer_load_dwordx4 v[216:219], v2, s[8:11], s22 offen offset:2048 sc1
  buffer_load_dwordx4 v[220:223], v2, s[8:11], s22 offen offset:3072 sc1
  s_add_u32 s22, s31, 163840
  buffer_load_dwordx4 v[224:227], v2, s[8:11], s22 offen offset:0 sc1
  buffer_load_dwordx4 v[228:231], v2, s[8:11], s22 offen offset:1024 sc1
  buffer_load_dwordx4 v[232:235], v2, s[8:11], s22 offen offset:2048 sc1
  buffer_load_dwordx4 v[236:239], v2, s[8:11], s22 offen offset:3072 sc1
  s_add_u32 s22, s31, 167936
  buffer_load_dwordx4 v[240:243], v2, s[8:11], s22 offen offset:0 sc1
  buffer_load_dwordx4 v[244:247], v2, s[8:11], s22 offen offset:1024 sc1
  buffer_load_dwordx4 v[248:251], v2, s[8:11], s22 offen offset:2048 sc1
  buffer_load_dwordx4 v[252:255], v2, s[8:11], s22 offen offset:3072 sc1
  s_mul_i32 s22, s17, 12
  s_add_u32 s23, s22, 267
  s_add_u32 s22, s22, 256
  v_mov_b32 v36, s23
  v_mov_b32 v37, s22
  v_cmp_eq_u32 vcc, 1, v116
  s_lshl_b32 s22, s17, 4
  s_nop 0
  v_cndmask_b32 v36, v36, v37, vcc
  v_mov_b32 v37, s22
  v_cmp_eq_u32 vcc, 0, v116
  s_nop 1
  v_cndmask_b32 v36, v36, v37, vcc
  v_lshrrev_b32 v36, 6, v36
  v_lshlrev_b32 v36, 8, v36
  v_med3_u32 v37, v117, 15, 15
  v_lshl_add_u32 v36, v37, 4, v36
  s_mov_b32 s22, 88600576
  s_mov_b32 s30, 0
va_bw_14:
  buffer_load_dwordx4 v[40:43], v36, s[8:11], s22 offen sc1
  s_waitcnt vmcnt(0)
  v_cmp_ne_u64 vcc, s[88:89], v[40:41]
  s_cbranch_vccnz va_bw_14_no
  v_cmp_ne_u64 vcc, s[88:89], v[42:43]
  s_cbranch_vccnz va_bw_14_no
  s_branch va_bw_14_ok
va_bw_14_no:
  s_sleep 2
  s_add_u32 s30, s30, 1
  s_cmp_lt_u32 s30, 50000
  s_cbranch_scc1 va_bw_14
  s_branch cA_abort
va_bw_14_ok:
  s_mov_b32 m0, 59392
  s_add_u32 s22, s31, 387072
  buffer_load_dwordx4 v2, s[8:11], s22 offen offset:0 sc1 lds
  buffer_load_dwordx4 v2, s[8:11], s22 offen offset:1024 sc1 lds
  buffer_load_dwordx4 v2, s[8:11], s22 offen offset:2048 sc1 lds
  buffer_load_dwordx4 v2, s[8:11], s22 offen offset:3072 sc1 lds
  s_mov_b32 m0, 63488
  s_add_u32 s22, s31, 391168
  buffer_load_dwordx4 v2, s[8:11], s22 offen offset:0 sc1 lds
  buffer_load_dwordx4 v2, s[8:11], s22 offen offset:1024 sc1 lds
  buffer_load_dwordx4 v2, s[8:11], s22 offen offset:2048 sc1 lds
  buffer_load_dwordx4 v2, s[8:11], s22 offen offset:3072 sc1 lds
  s_mov_b32 m0, 67584
  s_add_u32 s22, s31, 395264
  buffer_load_dwordx4 v2, s[8:11], s22 offen offset:0 sc1 lds
  buffer_load_dwordx4 v2, s[8:11], s22 offen offset:1024 sc1 lds
  buffer_load_dwordx4 v2, s[8:11], s22 offen offset:2048 sc1 lds
  buffer_load_dwordx4 v2, s[8:11], s22 offen offset:3072 sc1 lds
  s_mov_b32 m0, 71680
  s_add_u32 s22, s31, 399360
  buffer_load_dwordx4 v2, s[8:11], s22 offen offset:0 sc1 lds
  buffer_load_dwordx4 v2, s[8:11], s22 offen offset:1024 sc1 lds
  v_mov_b32 v72, v116
  v_mov_b32 v73, v117
  v_lshrrev_b32 v65, 1, v72
  v_and_b32 v66, 1, v72
  v_mov_b32 v67, 6
  v_lshl_add_u32 v67, v67, 4, v73
  v_mul_u32_u24 v68, 2341, v67
  v_lshrrev_b32 v68, 16, v68
  v_mul_u32_u24 v69, 28, v68
  v_sub_u32 v69, v67, v69
  v_lshrrev_b32 v70, 4, v69
  v_and_b32 v69, 15, v69
  v_and_b32 v71, 1, v69
  v_lshrrev_b32 v69, 1, v69
  v_lshl_add_u32 v69, v71, 3, v69
  v_lshlrev_b32 v71, 12, v70
  v_lshrrev_b32 v70, 1, v68
  v_lshl_add_u32 v71, v70, 9, v71
  v_and_b32 v70, 1, v68
  v_lshl_add_u32 v71, v70, 2, v71
  v_lshl_add_u32 v71, v69, 4, v71
  v_lshl_add_u32 v71, v65, 8, v71
  v_lshl_add_u32 v60, v66, 3, v71
  v_mov_b32 v67, 7
  v_lshl_add_u32 v67, v67, 4, v73
  v_mul_u32_u24 v68, 2341, v67
  v_lshrrev_b32 v68, 16, v68
  v_mul_u32_u24 v69, 28, v68
  v_sub_u32 v69, v67, v69
  v_lshrrev_b32 v70, 4, v69
  v_and_b32 v69, 15, v69
  v_and_b32 v71, 1, v69
  v_lshrrev_b32 v69, 1, v69
  v_lshl_add_u32 v69, v71, 3, v69
  v_lshlrev_b32 v71, 12, v70
  v_lshrrev_b32 v70, 1, v68
  v_lshl_add_u32 v71, v70, 9, v71
  v_and_b32 v70, 1, v68
  v_lshl_add_u32 v71, v70, 2, v71
  v_lshl_add_u32 v71, v69, 4, v71
  v_lshl_add_u32 v71, v65, 8, v71
  v_lshl_add_u32 v61, v66, 3, v71
  v_mov_b32 v67, 8
  v_lshl_add_u32 v67, v67, 4, v73
  v_mul_u32_u24 v68, 2341, v67
  v_lshrrev_b32 v68, 16, v68
  v_mul_u32_u24 v69, 28, v68
  v_sub_u32 v69, v67, v69
  v_lshrrev_b32 v70, 4, v69
  v_and_b32 v69, 15, v69
  v_and_b32 v71, 1, v69
  v_lshrrev_b32 v69, 1, v69
  v_lshl_add_u32 v69, v71, 3, v69
  v_lshlrev_b32 v71, 12, v70
  v_lshrrev_b32 v70, 1, v68
  v_lshl_add_u32 v71, v70, 9, v71
  v_and_b32 v70, 1, v68
  v_lshl_add_u32 v71, v70, 2, v71
  v_lshl_add_u32 v71, v69, 4, v71
  v_lshl_add_u32 v71, v65, 8, v71
  v_lshl_add_u32 v62, v66, 3, v71
  v_mov_b32 v67, 9
  v_lshl_add_u32 v67, v67, 4, v73
  v_mul_u32_u24 v68, 2341, v67
  v_lshrrev_b32 v68, 16, v68
  v_mul_u32_u24 v69, 28, v68
  v_sub_u32 v69, v67, v69
  v_lshrrev_b32 v70, 4, v69
  v_and_b32 v69, 15, v69
  v_and_b32 v71, 1, v69
  v_lshrrev_b32 v69, 1, v69
  v_lshl_add_u32 v69, v71, 3, v69
  v_lshlrev_b32 v71, 12, v70
  v_lshrrev_b32 v70, 1, v68
  v_lshl_add_u32 v71, v70, 9, v71
  v_and_b32 v70, 1, v68
  v_lshl_add_u32 v71, v70, 2, v71
  v_lshl_add_u32 v71, v69, 4, v71
  v_lshl_add_u32 v71, v65, 8, v71
  v_lshl_add_u32 v170, v66, 3, v71
  v_mov_b32 v67, 10
  v_lshl_add_u32 v67, v67, 4, v73
  v_mul_u32_u24 v68, 2341, v67
  v_lshrrev_b32 v68, 16, v68
  v_mul_u32_u24 v69, 28, v68
  v_sub_u32 v69, v67, v69
  v_lshrrev_b32 v70, 4, v69
  v_and_b32 v69, 15, v69
  v_and_b32 v71, 1, v69
  v_lshrrev_b32 v69, 1, v69
  v_lshl_add_u32 v69, v71, 3, v69
  v_lshlrev_b32 v71, 12, v70
  v_lshrrev_b32 v70, 1, v68
  v_lshl_add_u32 v71, v70, 9, v71
  v_and_b32 v70, 1, v68
  v_lshl_add_u32 v71, v70, 2, v71
  v_lshl_add_u32 v71, v69, 4, v71
  v_lshl_add_u32 v71, v65, 8, v71
  v_lshl_add_u32 v171, v66, 3, v71
  v_mov_b32 v67, 11
  v_lshl_add_u32 v67, v67, 4, v73
  v_mul_u32_u24 v68, 2341, v67
  v_lshrrev_b32 v68, 16, v68
  v_mul_u32_u24 v69, 28, v68
  v_sub_u32 v69, v67, v69
  v_lshrrev_b32 v70, 4, v69
  v_and_b32 v69, 15, v69
  v_and_b32 v71, 1, v69
  v_lshrrev_b32 v69, 1, v69
  v_lshl_add_u32 v69, v71, 3, v69
  v_lshlrev_b32 v71, 12, v70
  v_lshrrev_b32 v70, 1, v68
  v_lshl_add_u32 v71, v70, 9, v71
  v_and_b32 v70, 1, v68
  v_lshl_add_u32 v71, v70, 2, v71
  v_lshl_add_u32 v71, v69, 4, v71
  v_lshl_add_u32 v71, v65, 8, v71
  v_lshl_add_u32 v172, v66, 3, v71
  v_and_b32 v0, 31, v1
  v_lshlrev_b32 v0, 2, v0
  v_add_u32 v0, 18432, v0
  v_lshlrev_b32 v4, 2, v73
  s_and_b32 s22, s17, 3
  s_lshl_b32 s22, s22, 7
  s_add_u32 s22, s22, 17408
  v_add_u32 v4, s22, v4
  v_and_b32 v64, 7, v73
  v_lshlrev_b32 v5, 4, v64
  v_lshl_add_u32 v5, v72, 7, v5
  v_lshrrev_b32 v65, 3, v73
  v_lshl_add_u32 v5, v65, 9, v5
  s_lshl_b32 s22, s17, 3
  s_add_u32 s22, s22, 18436
  v_lshl_add_u32 v7, v2, 3, s22
  v_add_u32 v65, 16, v73
  v_min_u32 v65, 27, v65
  v_mad_u32_u24 v65, v72, 28, v65
  v_lshlrev_b32 v6, 4, v65
  s_lshr_b32 s22, s17, 1
  s_mul_i32 s22, s22, 7
  s_and_b32 s34, s17, 1
  s_lshl_b32 s35, s34, 2
  v_add_u32 v70, s35, v72
  v_mov_b32 v71, s34
  v_mov_b32 v69, 1
  v_cmp_eq_u32 vcc, 3, v72
  s_nop 1
  v_cndmask_b32 v70, v70, v72, vcc
  v_cndmask_b32 v69, v69, v71, vcc
  v_add_u32 v70, s22, v70
  v_lshrrev_b32 v68, 1, v70
  v_lshlrev_b32 v68, 8, v68
  v_lshl_add_u32 v68, v69, 7, v68
  v_and_b32 v69, 1, v70
  v_lshl_add_u32 v68, v69, 3, v68
  v_lshl_add_u32 v1, v64, 4, v68
  v_cmp_gt_u32 s[26:27], 8, v73
  v_cmp_gt_u32 vcc, 3, v72
  s_and_b64 s[26:27], s[26:27], vcc
  v_lshrrev_b32 v65, 3, v73
  v_lshl_add_u32 v66, v64, 1, v65
  v_add_u32 v66, 16, v66
  v_min_u32 v66, 27, v66
  v_mad_u32_u24 v66, v72, 28, v66
  v_lshlrev_b32 v6, 4, v66
  s_mul_i32 s22, s17, 12
  s_add_u32 s22, s22, 256
  v_lshl_add_u32 v70, v64, 1, s22
  v_lshrrev_b32 v68, 4, v70
  v_lshlrev_b32 v68, 8, v68
  v_bfe_u32 v69, v70, 1, 1
  v_lshl_add_u32 v68, v69, 7, v68
  v_bfe_u32 v69, v70, 2, 2
  v_lshl_add_u32 v68, v69, 2, v68
  v_and_b32 v69, 1, v72
  v_lshl_add_u32 v65, v69, 2, v65
  v_lshrrev_b32 v69, 1, v72
  v_lshl_add_u32 v65, v69, 1, v65
  v_lshrrev_b32 v65, 3, v73
  v_lshl_add_u32 v65, v72, 1, v65
  v_lshrrev_b32 v5, 1, v72
  v_lshlrev_b32 v5, 9, v5
  v_lshrrev_b32 v69, 2, v73
  v_lshl_add_u32 v5, v69, 7, v5
  v_and_b32 v69, 1, v72
  v_lshl_add_u32 v5, v69, 6, v5
  v_and_b32 v69, 3, v73
  v_lshl_add_u32 v5, v69, 4, v5
  v_and_b32 v69, 1, v73
  v_mul_u32_u24 v69, 0xaaaa, v69
  v_add_u32 v0, 0x4444, v69
  v_lshl_add_u32 v1, v65, 4, v68
  v_cmp_gt_u32 s[26:27], 6, v64
  v_mov_b32 v156, 0
  v_mov_b32 v157, 0
  v_mov_b32 v158, 0
  v_mov_b32 v159, 0
  ds_write_b128 v2, v[156:159] offset:4096
  ds_write_b128 v2, v[156:159] offset:5120
  ds_write_b128 v2, v[156:159] offset:6144
  ds_write_b128 v2, v[156:159] offset:7168
  s_mul_i32 s22, s17, 1835008
  s_add_u32 s25, s22, 42205184
  s_lshl_b32 s35, s17, 7
  s_add_u32 s35, s35, 88539136
  s_add_u32 s39, s35, 16384
  s_mov_b32 s38, 0
  v_mov_b32 v63, 0
  v_bfe_u32 v8, v2, 4, 1
  v_mul_u32_u24 v3, 0xaaaa, v8
  v_add_u32 v3, 0x4444, v3
  v_bfe_u32 v9, v2, 5, 3
  v_lshl_add_u32 v8, v8, 3, v9
  v_and_b32 v9, 0x300, v2
  v_lshl_add_u32 v0, v8, 4, v9
  s_lshl_b32 s22, 0, 11
  s_add_u32 s22, s22, 88602624
  v_add_u32 v36, 1024, v2
  v_min_u32 v36, 1776, v36
  s_mov_b32 s30, 0
va_iw5:
  buffer_load_dwordx4 v[40:43], v2, s[8:11], s22 offen sc1
  buffer_load_dwordx4 v[44:47], v36, s[8:11], s22 offen sc1
  s_waitcnt vmcnt(0)
  v_cmp_ne_u64 vcc, s[88:89], v[40:41]
  s_cbranch_vccnz va_iw5_no
  v_cmp_ne_u64 vcc, s[88:89], v[42:43]
  s_cbranch_vccnz va_iw5_no
  v_cmp_ne_u64 vcc, s[88:89], v[44:45]
  s_cbranch_vccnz va_iw5_no
  v_cmp_ne_u64 vcc, s[88:89], v[46:47]
  s_cbranch_vccnz va_iw5_no
  s_branch va_iw5_ok
va_iw5_no:
  s_sleep 2
  s_add_u32 s30, s30, 1
  s_cmp_lt_u32 s30, 50000
  s_cbranch_scc1 va_iw5
  s_branch cA_abort
va_iw5_ok:
  s_mov_b32 s30, 0
  v_mov_b32 v36, 0
ch_md5:
  buffer_load_dword v37, v36, s[12:15], 0 offen sc1
  s_waitcnt vmcnt(0)
  v_readfirstlane_b32 s22, v37
  s_and_b32 s31, s22, 0xffff
  s_cmp_ge_u32 s31, 32
  s_cbranch_scc1 ch_go5
  s_sleep 2
  s_add_u32 s30, s30, 1
  s_cmp_lt_u32 s30, 50000
  s_cbranch_scc1 ch_md5
  s_branch ch_end
ch_go5:
  s_mov_b32 s31, 0
  v_mov_b32 v36, 0
  v_mov_b32 v37, 0
  v_mov_b32 v38, 0
  v_mov_b32 v39, 0
  v_mov_b32 v40, 0
  v_mov_b32 v41, 0
  v_mov_b32 v42, 0
  v_mov_b32 v43, 0
  v_mov_b32 v44, 0
  v_mov_b32 v45, 0
  v_mov_b32 v46, 0
  v_mov_b32 v47, 0
  v_mov_b32 v48, 0
  v_mov_b32 v49, 0
  v_mov_b32 v50, 0
  v_mov_b32 v51, 0
  v_mov_b32 v52, 0
  v_mov_b32 v53, 0
  v_mov_b32 v54, 0
  v_mov_b32 v55, 0
  v_mov_b32 v56, 0
  v_mov_b32 v57, 0
  v_mov_b32 v58, 0
  v_mov_b32 v59, 0
  s_lshr_b32 s22, s22, 16
  s_cmp_lg_u32 s22, 0
  s_cbranch_scc1 cB_va1_loop
  s_branch cA_va1_loop
ch_init6:
  s_mul_i32 s31, s17, 401408
  s_add_u32 s31, s31, 6422528
  s_mul_i32 s22, s17, 12
  s_add_u32 s23, s22, 267
  s_add_u32 s22, s22, 256
  v_mov_b32 v36, s23
  v_mov_b32 v37, s22
  v_cmp_eq_u32 vcc, 1, v116
  s_lshl_b32 s22, s17, 4
  s_nop 0
  v_cndmask_b32 v36, v36, v37, vcc
  v_mov_b32 v37, s22
  v_cmp_eq_u32 vcc, 0, v116
  s_nop 1
  v_cndmask_b32 v36, v36, v37, vcc
  v_lshrrev_b32 v36, 6, v36
  v_lshlrev_b32 v36, 8, v36
  v_med3_u32 v37, v117, 6, 10
  v_lshl_add_u32 v36, v37, 4, v36
  s_mov_b32 s22, 88600576
  s_mov_b32 s30, 0
va_bw_15:
  buffer_load_dwordx4 v[40:43], v36, s[8:11], s22 offen sc1
  s_waitcnt vmcnt(0)
  v_cmp_ne_u64 vcc, s[88:89], v[40:41]
  s_cbranch_vccnz va_bw_15_no
  v_cmp_ne_u64 vcc, s[88:89], v[42:43]
  s_cbranch_vccnz va_bw_15_no
  s_branch va_bw_15_ok
va_bw_15_no:
  s_sleep 2
  s_add_u32 s30, s30, 1
  s_cmp_lt_u32 s30, 50000
  s_cbranch_scc1 va_bw_15
  s_branch cA_abort
va_bw_15_ok:
  s_add_u32 s22, s31, 172032
  buffer_load_dwordx4 a[0:3], v2, s[8:11], s22 offen offset:0 sc1
  buffer_load_dwordx4 a[4:7], v2, s[8:11], s22 offen offset:1024 sc1
  buffer_load_dwordx4 a[8:11], v2, s[8:11], s22 offen offset:2048 sc1
  buffer_load_dwordx4 a[12:15], v2, s[8:11], s22 offen offset:3072 sc1
  s_add_u32 s22, s31, 176128
  buffer_load_dwordx4 a[16:19], v2, s[8:11], s22 offen offset:0 sc1
  buffer_load_dwordx4 a[20:23], v2, s[8:11], s22 offen offset:1024 sc1
  buffer_load_dwordx4 a[24:27], v2, s[8:11], s22 offen offset:2048 sc1
  buffer_load_dwordx4 a[28:31], v2, s[8:11], s22 offen offset:3072 sc1
  s_add_u32 s22, s31, 180224
  buffer_load_dwordx4 a[32:35], v2, s[8:11], s22 offen offset:0 sc1
  buffer_load_dwordx4 a[36:39], v2, s[8:11], s22 offen offset:1024 sc1
  buffer_load_dwordx4 a[40:43], v2, s[8:11], s22 offen offset:2048 sc1
  buffer_load_dwordx4 a[44:47], v2, s[8:11], s22 offen offset:3072 sc1
  s_add_u32 s22, s31, 184320
  buffer_load_dwordx4 a[48:51], v2, s[8:11], s22 offen offset:0 sc1
  buffer_load_dwordx4 a[52:55], v2, s[8:11], s22 offen offset:1024 sc1
  buffer_load_dwordx4 a[56:59], v2, s[8:11], s22 offen offset:2048 sc1
  buffer_load_dwordx4 a[60:63], v2, s[8:11], s22 offen offset:3072 sc1
  s_add_u32 s22, s31, 188416
  buffer_load_dwordx4 a[64:67], v2, s[8:11], s22 offen offset:0 sc1
  buffer_load_dwordx4 a[68:71], v2, s[8:11], s22 offen offset:1024 sc1
  buffer_load_dwordx4 a[72:75], v2, s[8:11], s22 offen offset:2048 sc1
  buffer_load_dwordx4 a[76:79], v2, s[8:11], s22 offen offset:3072 sc1
  s_add_u32 s22, s31, 192512
  buffer_load_dwordx4 a[80:83], v2, s[8:11], s22 offen offset:0 sc1
  buffer_load_dwordx4 a[84:87], v2, s[8:11], s22 offen offset:1024 sc1
  buffer_load_dwordx4 a[88:91], v2, s[8:11], s22 offen offset:2048 sc1
  buffer_load_dwordx4 a[92:95], v2, s[8:11], s22 offen offset:3072 sc1
  s_add_u32 s22, s31, 196608
  buffer_load_dwordx4 a[96:99], v2, s[8:11], s22 offen offset:0 sc1
  buffer_load_dwordx4 a[100:103], v2, s[8:11], s22 offen offset:1024 sc1
  buffer_load_dwordx4 a[104:107], v2, s[8:11], s22 offen offset:2048 sc1
  buffer_load_dwordx4 a[108:111], v2, s[8:11], s22 offen offset:3072 sc1
  s_add_u32 s22, s31, 200704
  buffer_load_dwordx4 a[112:115], v2, s[8:11], s22 offen offset:0 sc1
  buffer_load_dwordx4 a[116:119], v2, s[8:11], s22 offen offset:1024 sc1
  buffer_load_dwordx4 a[120:123], v2, s[8:11], s22 offen offset:2048 sc1
  buffer_load_dwordx4 a[124:127], v2, s[8:11], s22 offen offset:3072 sc1
  s_waitcnt vmcnt(24)
  s_add_u32 s22, s31, 204800
  buffer_load_dwordx4 a[128:131], v2, s[8:11], s22 offen offset:0 sc1
  buffer_load_dwordx4 a[132:135], v2, s[8:11], s22 offen offset:1024 sc1
  buffer_load_dwordx4 a[136:139], v2, s[8:11], s22 offen offset:2048 sc1
  buffer_load_dwordx4 a[140:143], v2, s[8:11], s22 offen offset:3072 sc1
  s_add_u32 s22, s31, 208896
  buffer_load_dwordx4 a[144:147], v2, s[8:11], s22 offen offset:0 sc1
  buffer_load_dwordx4 a[148:151], v2, s[8:11], s22 offen offset:1024 sc1
  buffer_load_dwordx4 a[152:155], v2, s[8:11], s22 offen offset:2048 sc1
  buffer_load_dwordx4 a[156:159], v2, s[8:11], s22 offen offset:3072 sc1
  s_add_u32 s22, s31, 212992
  buffer_load_dwordx4 a[160:163], v2, s[8:11], s22 offen offset:0 sc1
  buffer_load_dwordx4 a[164:167], v2, s[8:11], s22 offen offset:1024 sc1
  buffer_load_dwordx4 a[168:171], v2, s[8:11], s22 offen offset:2048 sc1
  buffer_load_dwordx4 a[172:175], v2, s[8:11], s22 offen offset:3072 sc1
  s_add_u32 s22, s31, 217088
  buffer_load_dwordx4 a[176:179], v2, s[8:11], s22 offen offset:0 sc1
  buffer_load_dwordx4 a[180:183], v2, s[8:11], s22 offen offset:1024 sc1
  buffer_load_dwordx4 a[184:187], v2, s[8:11], s22 offen offset:2048 sc1
  buffer_load_dwordx4 a[188:191], v2, s[8:11], s22 offen offset:3072 sc1
  s_add_u32 s22, s31, 221184
  buffer_load_dwordx4 a[192:195], v2, s[8:11], s22 offen offset:0 sc1
  buffer_load_dwordx4 a[196:199], v2, s[8:11], s22 offen offset:1024 sc1
  buffer_load_dwordx4 a[200:203], v2, s[8:11], s22 offen offset:2048 sc1
  buffer_load_dwordx4 a[204:207], v2, s[8:11], s22 offen offset:3072 sc1
  s_add_u32 s22, s31, 225280
  buffer_load_dwordx4 a[208:211], v2, s[8:11], s22 offen offset:0 sc1
  buffer_load_dwordx4 a[212:215], v2, s[8:11], s22 offen offset:1024 sc1
  buffer_load_dwordx4 a[216:219], v2, s[8:11], s22 offen offset:2048 sc1
  buffer_load_dwordx4 a[220:223], v2, s[8:11], s22 offen offset:3072 sc1
  s_add_u32 s22, s31, 229376
  buffer_load_dwordx4 a[224:227], v2, s[8:11], s22 offen offset:0 sc1
  buffer_load_dwordx4 a[228:231], v2, s[8:11], s22 offen offset:1024 sc1
  buffer_load_dwordx4 a[232:235], v2, s[8:11], s22 offen offset:2048 sc1
  buffer_load_dwordx4 a[236:239], v2, s[8:11], s22 offen offset:3072 sc1
  s_add_u32 s22, s31, 233472
  buffer_load_dwordx4 a[240:243], v2, s[8:11], s22 offen offset:0 sc1
  buffer_load_dwordx4 a[244:247], v2, s[8:11], s22 offen offset:1024 sc1
  buffer_load_dwordx4 a[248:251], v2, s[8:11], s22 offen offset:2048 sc1
  buffer_load_dwordx4 a[252:255], v2, s[8:11], s22 offen offset:3072 sc1
  s_waitcnt vmcnt(24)
  s_add_u32 s22, s31, 237568
  buffer_load_dwordx4 v[120:123], v2, s[8:11], s22 offen offset:0 sc1
  buffer_load_dwordx4 v[124:127], v2, s[8:11], s22 offen offset:1024 sc1
  buffer_load_dwordx4 v[128:131], v2, s[8:11], s22 offen offset:2048 sc1
  buffer_load_dwordx4 v[132:135], v2, s[8:11], s22 offen offset:3072 sc1
  s_add_u32 s22, s31, 241664
  buffer_load_dwordx4 v[136:139], v2, s[8:11], s22 offen offset:0 sc1
  buffer_load_dwordx4 v[140:143], v2, s[8:11], s22 offen offset:1024 sc1
  buffer_load_dwordx4 v[144:147], v2, s[8:11], s22 offen offset:2048 sc1
  buffer_load_dwordx4 v[148:151], v2, s[8:11], s22 offen offset:3072 sc1
  s_add_u32 s22, s31, 245760
  buffer_load_dwordx4 v[152:155], v2, s[8:11], s22 offen offset:0 sc1
  buffer_load_dwordx4 v[156:159], v2, s[8:11], s22 offen offset:1024 sc1
  buffer_load_dwordx4 v[160:163], v2, s[8:11], s22 offen offset:2048 sc1
  buffer_load_dwordx4 v[164:167], v2, s[8:11], s22 offen offset:3072 sc1
  s_add_u32 s22, s31, 249856
  buffer_load_dwordx4 v[168:171], v2, s[8:11], s22 offen offset:0 sc1
  buffer_load_dwordx4 v[172:175], v2, s[8:11], s22 offen offset:1024 sc1
  buffer_load_dwordx4 v[176:179], v2, s[8:11], s22 offen offset:2048 sc1
  buffer_load_dwordx4 v[180:183], v2, s[8:11], s22 offen offset:3072 sc1
  s_add_u32 s22, s31, 253952
  buffer_load_dwordx4 v[184:187], v2, s[8:11], s22 offen offset:0 sc1
  buffer_load_dwordx4 v[188:191], v2, s[8:11], s22 offen offset:1024 sc1
  buffer_load_dwordx4 v[192:195], v2, s[8:11], s22 offen offset:2048 sc1
  buffer_load_dwordx4 v[196:199], v2, s[8:11], s22 offen offset:3072 sc1
  s_add_u32 s22, s31, 258048
  buffer_load_dwordx4 v[200:203], v2, s[8:11], s22 offen offset:0 sc1
  buffer_load_dwordx4 v[204:207], v2, s[8:11], s22 offen offset:1024 sc1
  buffer_load_dwordx4 v[208:211], v2, s[8:11], s22 offen offset:2048 sc1
  buffer_load_dwordx4 v[212:215], v2, s[8:11], s22 offen offset:3072 sc1
  s_add_u32 s22, s31, 262144
  buffer_load_dwordx4 v[216:219], v2, s[8:11], s22 offen offset:0 sc1
  buffer_load_dwordx4 v[220:223], v2, s[8:11], s22 offen offset:1024 sc1
  buffer_load_dwordx4 v[224:227], v2, s[8:11], s22 offen offset:2048 sc1
  buffer_load_dwordx4 v[228:231], v2, s[8:11], s22 offen offset:3072 sc1
  s_add_u32 s22, s31, 266240
  buffer_load_dwordx4 v[232:235], v2, s[8:11], s22 offen offset:0 sc1
  buffer_load_dwordx4 v[236:239], v2, s[8:11], s22 offen offset:1024 sc1
  buffer_load_dwordx4 v[240:243], v2, s[8:11], s22 offen offset:2048 sc1
  buffer_load_dwordx4 v[244:247], v2, s[8:11], s22 offen offset:3072 sc1
  s_waitcnt vmcnt(24)
  s_add_u32 s22, s31, 270336
  buffer_load_dwordx4 v[248:251], v2, s[8:11], s22 offen offset:0 sc1
  buffer_load_dwordx4 v[252:255], v2, s[8:11], s22 offen offset:1024 sc1
  v_mov_b32 v72, v116
  v_mov_b32 v73, v117
  v_lshrrev_b32 v65, 1, v72
  v_and_b32 v66, 1, v72
  v_mov_b32 v67, 12
  v_lshl_add_u32 v67, v67, 4, v73
  v_mul_u32_u24 v68, 2341, v67
  v_lshrrev_b32 v68, 16, v68
  v_mul_u32_u24 v69, 28, v68
  v_sub_u32 v69, v67, v69
  v_lshrrev_b32 v70, 4, v69
  v_and_b32 v69, 15, v69
  v_and_b32 v71, 1, v69
  v_lshrrev_b32 v69, 1, v69
  v_lshl_add_u32 v69, v71, 3, v69
  v_lshlrev_b32 v71, 12, v70
  v_lshrrev_b32 v70, 1, v68
  v_lshl_add_u32 v71, v70, 9, v71
  v_and_b32 v70, 1, v68
  v_lshl_add_u32 v71, v70, 2, v71
  v_lshl_add_u32 v71, v69, 4, v71
  v_lshl_add_u32 v71, v65, 8, v71
  v_lshl_add_u32 v100, v66, 3, v71
  v_mov_b32 v67, 13
  v_lshl_add_u32 v67, v67, 4, v73
  v_mul_u32_u24 v68, 2341, v67
  v_lshrrev_b32 v68, 16, v68
  v_mul_u32_u24 v69, 28, v68
  v_sub_u32 v69, v67, v69
  v_lshrrev_b32 v70, 4, v69
  v_and_b32 v69, 15, v69
  v_and_b32 v71, 1, v69
  v_lshrrev_b32 v69, 1, v69
  v_lshl_add_u32 v69, v71, 3, v69
  v_lshlrev_b32 v71, 12, v70
  v_lshrrev_b32 v70, 1, v68
  v_lshl_add_u32 v71, v70, 9, v71
  v_and_b32 v70, 1, v68
  v_lshl_add_u32 v71, v70, 2, v71
  v_lshl_add_u32 v71, v69, 4, v71
  v_lshl_add_u32 v71, v65, 8, v71
  v_lshl_add_u32 v101, v66, 3, v71
  v_mov_b32 v67, 14
  v_lshl_add_u32 v67, v67, 4, v73
  v_mul_u32_u24 v68, 2341, v67
  v_lshrrev_b32 v68, 16, v68
  v_mul_u32_u24 v69, 28, v68
  v_sub_u32 v69, v67, v69
  v_lshrrev_b32 v70, 4, v69
  v_and_b32 v69, 15, v69
  v_and_b32 v71, 1, v69
  v_lshrrev_b32 v69, 1, v69
  v_lshl_add_u32 v69, v71, 3, v69
  v_lshlrev_b32 v71, 12, v70
  v_lshrrev_b32 v70, 1, v68
  v_lshl_add_u32 v71, v70, 9, v71
  v_and_b32 v70, 1, v68
  v_lshl_add_u32 v71, v70, 2, v71
  v_lshl_add_u32 v71, v69, 4, v71
  v_lshl_add_u32 v71, v65, 8, v71
  v_lshl_add_u32 v102, v66, 3, v71
  v_mov_b32 v67, 15
  v_lshl_add_u32 v67, v67, 4, v73
  v_mul_u32_u24 v68, 2341, v67
  v_lshrrev_b32 v68, 16, v68
  v_mul_u32_u24 v69, 28, v68
  v_sub_u32 v69, v67, v69
  v_lshrrev_b32 v70, 4, v69
  v_and_b32 v69, 15, v69
  v_and_b32 v71, 1, v69
  v_lshrrev_b32 v69, 1, v69
  v_lshl_add_u32 v69, v71, 3, v69
  v_lshlrev_b32 v71, 12, v70
  v_lshrrev_b32 v70, 1, v68
  v_lshl_add_u32 v71, v70, 9, v71
  v_and_b32 v70, 1, v68
  v_lshl_add_u32 v71, v70, 2, v71
  v_lshl_add_u32 v71, v69, 4, v71
  v_lshl_add_u32 v71, v65, 8, v71
  v_lshl_add_u32 v103, v66, 3, v71
  v_mov_b32 v67, 16
  v_lshl_add_u32 v67, v67, 4, v73
  v_mul_u32_u24 v68, 2341, v67
  v_lshrrev_b32 v68, 16, v68
  v_mul_u32_u24 v69, 28, v68
  v_sub_u32 v69, v67, v69
  v_lshrrev_b32 v70, 4, v69
  v_and_b32 v69, 15, v69
  v_and_b32 v71, 1, v69
  v_lshrrev_b32 v69, 1, v69
  v_lshl_add_u32 v69, v71, 3, v69
  v_lshlrev_b32 v71, 12, v70
  v_lshrrev_b32 v70, 1, v68
  v_lshl_add_u32 v71, v70, 9, v71
  v_and_b32 v70, 1, v68
  v_lshl_add_u32 v71, v70, 2, v71
  v_lshl_add_u32 v71, v69, 4, v71
  v_lshl_add_u32 v71, v65, 8, v71
  v_lshl_add_u32 v104, v66, 3, v71
  v_mov_b32 v67, 17
  v_lshl_add_u32 v67, v67, 4, v73
  v_mul_u32_u24 v68, 2341, v67
  v_lshrrev_b32 v68, 16, v68
  v_mul_u32_u24 v69, 28, v68
  v_sub_u32 v69, v67, v69
  v_lshrrev_b32 v70, 4, v69
  v_and_b32 v69, 15, v69
  v_and_b32 v71, 1, v69
  v_lshrrev_b32 v69, 1, v69
  v_lshl_add_u32 v69, v71, 3, v69
  v_lshlrev_b32 v71, 12, v70
  v_lshrrev_b32 v70, 1, v68
  v_lshl_add_u32 v71, v70, 9, v71
  v_and_b32 v70, 1, v68
  v_lshl_add_u32 v71, v70, 2, v71
  v_lshl_add_u32 v71, v69, 4, v71
  v_lshl_add_u32 v71, v65, 8, v71
  v_lshl_add_u32 v105, v66, 3, v71
  v_mov_b32 v67, 18
  v_lshl_add_u32 v67, v67, 4, v73
  v_mul_u32_u24 v68, 2341, v67
  v_lshrrev_b32 v68, 16, v68
  v_mul_u32_u24 v69, 28, v68
  v_sub_u32 v69, v67, v69
  v_lshrrev_b32 v70, 4, v69
  v_and_b32 v69, 15, v69
  v_and_b32 v71, 1, v69
  v_lshrrev_b32 v69, 1, v69
  v_lshl_add_u32 v69, v71, 3, v69
  v_lshlrev_b32 v71, 12, v70
  v_lshrrev_b32 v70, 1, v68
  v_lshl_add_u32 v71, v70, 9, v71
  v_and_b32 v70, 1, v68
  v_lshl_add_u32 v71, v70, 2, v71
  v_lshl_add_u32 v71, v69, 4, v71
  v_lshl_add_u32 v71, v65, 8, v71
  v_lshl_add_u32 v106, v66, 3, v71
  v_mov_b32 v67, 19
  v_lshl_add_u32 v67, v67, 4, v73
  v_mul_u32_u24 v68, 2341, v67
  v_lshrrev_b32 v68, 16, v68
  v_mul_u32_u24 v69, 28, v68
  v_sub_u32 v69, v67, v69
  v_lshrrev_b32 v70, 4, v69
  v_and_b32 v69, 15, v69
  v_and_b32 v71, 1, v69
  v_lshrrev_b32 v69, 1, v69
  v_lshl_add_u32 v69, v71, 3, v69
  v_lshlrev_b32 v71, 12, v70
  v_lshrrev_b32 v70, 1, v68
  v_lshl_add_u32 v71, v70, 9, v71
  v_and_b32 v70, 1, v68
  v_lshl_add_u32 v71, v70, 2, v71
  v_lshl_add_u32 v71, v69, 4, v71
  v_lshl_add_u32 v71, v65, 8, v71
  v_lshl_add_u32 v107, v66, 3, v71
  s_mul_i32 s24, s17, 532480
  s_add_u32 s24, s24, 76939264
  s_mul_i32 s34, s17, 640
  s_add_u32 s34, s34, 88582144
  s_mul_i32 s36, s17, 448
  v_add_u32 v0, s36, v2
  v_add_u32 v0, 8192, v0
  s_add_u32 s36, s36, 88080384
  s_mov_b32 s37, 76939264
  v_cmp_gt_u32 s[26:27], 28, v1
  v_and_b32 v119, 31, v1
  v_lshlrev_b32 v119, 2, v119
  v_and_b32 v119, 0x78, v119
  v_or_b32 v119, 0, v119
  s_add_u32 s22, s17, 16
  s_and_b32 s22, s22, 15
  s_lshl_b32 s22, s22, 7
  s_add_u32 s22, s22, 18432
  v_add_u32 v119, s22, v119
  v_min_u32 v118, 9, v1
  s_mul_i32 s22, s17, 10
  v_add_u32 v118, s22, v118
  v_lshlrev_b32 v118, 7, v118
  v_add_u32 v118, 40960, v118
  s_mov_b32 s39, 71565312
  v_add_u32 v1, 16384, v2
  v_mov_b32 v117, 1
  s_mul_i32 s38, s17, 1104
  s_add_u32 s38, s38, 20480
  v_bfe_u32 v8, v2, 4, 1
  v_mul_u32_u24 v3, 0xaaaa, v8
  v_add_u32 v3, 0x4444, v3
  v_bfe_u32 v9, v2, 5, 3
  v_lshl_add_u32 v8, v8, 3, v9
  v_and_b32 v9, 0x300, v2
  v_lshl_add_u32 v5, v8, 4, v9
  s_lshl_b32 s22, 0, 11
  s_add_u32 s22, s22, 88602624
  v_add_u32 v36, 1024, v2
  v_min_u32 v36, 1776, v36
  s_mov_b32 s30, 0
va_iw6:
  buffer_load_dwordx4 v[40:43], v2, s[8:11], s22 offen sc1
  buffer_load_dwordx4 v[44:47], v36, s[8:11], s22 offen sc1
  s_waitcnt vmcnt(0)
  v_cmp_ne_u64 vcc, s[88:89], v[40:41]
  s_cbranch_vccnz va_iw6_no
  v_cmp_ne_u64 vcc, s[88:89], v[42:43]
  s_cbranch_vccnz va_iw6_no
  v_cmp_ne_u64 vcc, s[88:89], v[44:45]
  s_cbranch_vccnz va_iw6_no
  v_cmp_ne_u64 vcc, s[88:89], v[46:47]
  s_cbranch_vccnz va_iw6_no
  s_branch va_iw6_ok
va_iw6_no:
  s_sleep 2
  s_add_u32 s30, s30, 1
  s_cmp_lt_u32 s30, 50000
  s_cbranch_scc1 va_iw6
  s_branch cA_abort
va_iw6_ok:
  s_mov_b32 s30, 0
  v_mov_b32 v36, 0
ch_md6:
  buffer_load_dword v37, v36, s[12:15], 0 offen sc1
  s_waitcnt vmcnt(0)
  v_readfirstlane_b32 s22, v37
  s_and_b32 s31, s22, 0xffff
  s_cmp_ge_u32 s31, 32
  s_cbranch_scc1 ch_go6
  s_sleep 2
  s_add_u32 s30, s30, 1
  s_cmp_lt_u32 s30, 50000
  s_cbranch_scc1 ch_md6
  s_branch ch_end
ch_go6:
  s_mov_b32 s31, 0
  s_lshr_b32 s22, s22, 16
  s_cmp_lg_u32 s22, 0
  s_cbranch_scc1 cB_va2_loop
  s_branch cA_va2_loop
ch_init7:
  s_mul_i32 s31, s17, 401408
  s_add_u32 s31, s31, 6422528
  s_mul_i32 s22, s17, 12
  s_add_u32 s23, s22, 267
  s_add_u32 s22, s22, 256
  v_mov_b32 v36, s23
  v_mov_b32 v37, s22
  v_cmp_eq_u32 vcc, 1, v116
  s_lshl_b32 s22, s17, 4
  s_nop 0
  v_cndmask_b32 v36, v36, v37, vcc
  v_mov_b32 v37, s22
  v_cmp_eq_u32 vcc, 0, v116
  s_nop 1
  v_cndmask_b32 v36, v36, v37, vcc
  v_lshrrev_b32 v36, 6, v36
  v_lshlrev_b32 v36, 8, v36
  v_med3_u32 v37, v117, 11, 15
  v_lshl_add_u32 v36, v37, 4, v36
  s_mov_b32 s22, 88600576
  s_mov_b32 s30, 0
va_bw_16:
  buffer_load_dwordx4 v[40:43], v36, s[8:11], s22 offen sc1
  s_waitcnt vmcnt(0)
  v_cmp_ne_u64 vcc, s[88:89], v[40:41]
  s_cbranch_vccnz va_bw_16_no
  v_cmp_ne_u64 vcc, s[88:89], v[42:43]
  s_cbranch_vccnz va_bw_16_no
  s_branch va_bw_16_ok
va_bw_16_no:
  s_sleep 2
  s_add_u32 s30, s30, 1
  s_cmp_lt_u32 s30, 50000
  s_cbranch_scc1 va_bw_16
  s_branch cA_abort
va_bw_16_ok:
  s_add_u32 s22, s31, 286720
  buffer_load_dwordx4 a[0:3], v2, s[8:11], s22 offen offset:0 sc1
  buffer_load_dwordx4 a[4:7], v2, s[8:11], s22 offen offset:1024 sc1
  buffer_load_dwordx4 a[8:11], v2, s[8:11], s22 offen offset:2048 sc1
  buffer_load_dwordx4 a[12:15], v2, s[8:11], s22 offen offset:3072 sc1
  s_add_u32 s22, s31, 290816
  buffer_load_dwordx4 a[16:19], v2, s[8:11], s22 offen offset:0 sc1
  buffer_load_dwordx4 a[20:23], v2, s[8:11], s22 offen offset:1024 sc1
  buffer_load_dwordx4 a[24:27], v2, s[8:11], s22 offen offset:2048 sc1
  buffer_load_dwordx4 a[28:31], v2, s[8:11], s22 offen offset:3072 sc1
  s_add_u32 s22, s31, 294912
  buffer_load_dwordx4 a[32:35], v2, s[8:11], s22 offen offset:0 sc1
  buffer_load_dwordx4 a[36:39], v2, s[8:11], s22 offen offset:1024 sc1
  buffer_load_dwordx4 a[40:43], v2, s[8:11], s22 offen offset:2048 sc1
  buffer_load_dwordx4 a[44:47], v2, s[8:11], s22 offen offset:3072 sc1
  s_add_u32 s22, s31, 299008
  buffer_load_dwordx4 a[48:51], v2, s[8:11], s22 offen offset:0 sc1
  buffer_load_dwordx4 a[52:55], v2, s[8:11], s22 offen offset:1024 sc1
  buffer_load_dwordx4 a[56:59], v2, s[8:11], s22 offen offset:2048 sc1
  buffer_load_dwordx4 a[60:63], v2, s[8:11], s22 offen offset:3072 sc1
  s_add_u32 s22, s31, 303104
  buffer_load_dwordx4 a[64:67], v2, s[8:11], s22 offen offset:0 sc1
  buffer_load_dwordx4 a[68:71], v2, s[8:11], s22 offen offset:1024 sc1
  buffer_load_dwordx4 a[72:75], v2, s[8:11], s22 offen offset:2048 sc1
  buffer_load_dwordx4 a[76:79], v2, s[8:11], s22 offen offset:3072 sc1
  s_add_u32 s22, s31, 307200
  buffer_load_dwordx4 a[80:83], v2, s[8:11], s22 offen offset:0 sc1
  buffer_load_dwordx4 a[84:87], v2, s[8:11], s22 offen offset:1024 sc1
  buffer_load_dwordx4 a[88:91], v2, s[8:11], s22 offen offset:2048 sc1
  buffer_load_dwordx4 a[92:95], v2, s[8:11], s22 offen offset:3072 sc1
  s_add_u32 s22, s31, 311296
  buffer_load_dwordx4 a[96:99], v2, s[8:11], s22 offen offset:0 sc1
  buffer_load_dwordx4 a[100:103], v2, s[8:11], s22 offen offset:1024 sc1
  buffer_load_dwordx4 a[104:107], v2, s[8:11], s22 offen offset:2048 sc1
  buffer_load_dwordx4 a[108:111], v2, s[8:11], s22 offen offset:3072 sc1
  s_add_u32 s22, s31, 315392
  buffer_load_dwordx4 a[112:115], v2, s[8:11], s22 offen offset:0 sc1
  buffer_load_dwordx4 a[116:119], v2, s[8:11], s22 offen offset:1024 sc1
  buffer_load_dwordx4 a[120:123], v2, s[8:11], s22 offen offset:2048 sc1
  buffer_load_dwordx4 a[124:127], v2, s[8:11], s22 offen offset:3072 sc1
  s_waitcnt vmcnt(24)
  s_add_u32 s22, s31, 319488
  buffer_load_dwordx4 a[128:131], v2, s[8:11], s22 offen offset:0 sc1
  buffer_load_dwordx4 a[132:135], v2, s[8:11], s22 offen offset:1024 sc1
  buffer_load_dwordx4 a[136:139], v2, s[8:11], s22 offen offset:2048 sc1
  buffer_load_dwordx4 a[140:143], v2, s[8:11], s22 offen offset:3072 sc1
  s_add_u32 s22, s31, 323584
  buffer_load_dwordx4 a[144:147], v2, s[8:11], s22 offen offset:0 sc1
  buffer_load_dwordx4 a[148:151], v2, s[8:11], s22 offen offset:1024 sc1
  buffer_load_dwordx4 a[152:155], v2, s[8:11], s22 offen offset:2048 sc1
  buffer_load_dwordx4 a[156:159], v2, s[8:11], s22 offen offset:3072 sc1
  s_add_u32 s22, s31, 327680
  buffer_load_dwordx4 a[160:163], v2, s[8:11], s22 offen offset:0 sc1
  buffer_load_dwordx4 a[164:167], v2, s[8:11], s22 offen offset:1024 sc1
  buffer_load_dwordx4 a[168:171], v2, s[8:11], s22 offen offset:2048 sc1
  buffer_load_dwordx4 a[172:175], v2, s[8:11], s22 offen offset:3072 sc1
  s_add_u32 s22, s31, 331776
  buffer_load_dwordx4 a[176:179], v2, s[8:11], s22 offen offset:0 sc1
  buffer_load_dwordx4 a[180:183], v2, s[8:11], s22 offen offset:1024 sc1
  buffer_load_dwordx4 a[184:187], v2, s[8:11], s22 offen offset:2048 sc1
  buffer_load_dwordx4 a[188:191], v2, s[8:11], s22 offen offset:3072 sc1
  s_add_u32 s22, s31, 335872
  buffer_load_dwordx4 a[192:195], v2, s[8:11], s22 offen offset:0 sc1
  buffer_load_dwordx4 a[196:199], v2, s[8:11], s22 offen offset:1024 sc1
  buffer_load_dwordx4 a[200:203], v2, s[8:11], s22 offen offset:2048 sc1
  buffer_load_dwordx4 a[204:207], v2, s[8:11], s22 offen offset:3072 sc1
  s_add_u32 s22, s31, 339968
  buffer_load_dwordx4 a[208:211], v2, s[8:11], s22 offen offset:0 sc1
  buffer_load_dwordx4 a[212:215], v2, s[8:11], s22 offen offset:1024 sc1
  buffer_load_dwordx4 a[216:219], v2, s[8:11], s22 offen offset:2048 sc1
  buffer_load_dwordx4 a[220:223], v2, s[8:11], s22 offen offset:3072 sc1
  s_add_u32 s22, s31, 344064
  buffer_load_dwordx4 a[224:227], v2, s[8:11], s22 offen offset:0 sc1
  buffer_load_dwordx4 a[228:231], v2, s[8:11], s22 offen offset:1024 sc1
  buffer_load_dwordx4 a[232:235], v2, s[8:11], s22 offen offset:2048 sc1
  buffer_load_dwordx4 a[236:239], v2, s[8:11], s22 offen offset:3072 sc1
  s_add_u32 s22, s31, 348160
  buffer_load_dwordx4 a[240:243], v2, s[8:11], s22 offen offset:0 sc1
  buffer_load_dwordx4 a[244:247], v2, s[8:11], s22 offen offset:1024 sc1
  buffer_load_dwordx4 a[248:251], v2, s[8:11], s22 offen offset:2048 sc1
  buffer_load_dwordx4 a[252:255], v2, s[8:11], s22 offen offset:3072 sc1
  s_waitcnt vmcnt(24)
  s_add_u32 s22, s31, 352256
  buffer_load_dwordx4 v[120:123], v2, s[8:11], s22 offen offset:0 sc1
  buffer_load_dwordx4 v[124:127], v2, s[8:11], s22 offen offset:1024 sc1
  buffer_load_dwordx4 v[128:131], v2, s[8:11], s22 offen offset:2048 sc1
  buffer_load_dwordx4 v[132:135], v2, s[8:11], s22 offen offset:3072 sc1
  s_add_u32 s22, s31, 356352
  buffer_load_dwordx4 v[136:139], v2, s[8:11], s22 offen offset:0 sc1
  buffer_load_dwordx4 v[140:143], v2, s[8:11], s22 offen offset:1024 sc1
  buffer_load_dwordx4 v[144:147], v2, s[8:11], s22 offen offset:2048 sc1
  buffer_load_dwordx4 v[148:151], v2, s[8:11], s22 offen offset:3072 sc1
  s_add_u32 s22, s31, 360448
  buffer_load_dwordx4 v[152:155], v2, s[8:11], s22 offen offset:0 sc1
  buffer_load_dwordx4 v[156:159], v2, s[8:11], s22 offen offset:1024 sc1
  buffer_load_dwordx4 v[160:163], v2, s[8:11], s22 offen offset:2048 sc1
  buffer_load_dwordx4 v[164:167], v2, s[8:11], s22 offen offset:3072 sc1
  s_add_u32 s22, s31, 364544
  buffer_load_dwordx4 v[168:171], v2, s[8:11], s22 offen offset:0 sc1
  buffer_load_dwordx4 v[172:175], v2, s[8:11], s22 offen offset:1024 sc1
  buffer_load_dwordx4 v[176:179], v2, s[8:11], s22 offen offset:2048 sc1
  buffer_load_dwordx4 v[180:183], v2, s[8:11], s22 offen offset:3072 sc1
  s_add_u32 s22, s31, 368640
  buffer_load_dwordx4 v[184:187], v2, s[8:11], s22 offen offset:0 sc1
  buffer_load_dwordx4 v[188:191], v2, s[8:11], s22 offen offset:1024 sc1
  buffer_load_dwordx4 v[192:195], v2, s[8:11], s22 offen offset:2048 sc1
  buffer_load_dwordx4 v[196:199], v2, s[8:11], s22 offen offset:3072 sc1
  s_add_u32 s22, s31, 372736
  buffer_load_dwordx4 v[200:203], v2, s[8:11], s22 offen offset:0 sc1
  buffer_load_dwordx4 v[204:207], v2, s[8:11], s22 offen offset:1024 sc1
  buffer_load_dwordx4 v[208:211], v2, s[8:11], s22 offen offset:2048 sc1
  buffer_load_dwordx4 v[212:215], v2, s[8:11], s22 offen offset:3072 sc1
  s_add_u32 s22, s31, 376832
  buffer_load_dwordx4 v[216:219], v2, s[8:11], s22 offen offset:0 sc1
  buffer_load_dwordx4 v[220:223], v2, s[8:11], s22 offen offset:1024 sc1
  buffer_load_dwordx4 v[224:227], v2, s[8:11], s22 offen offset:2048 sc1
  buffer_load_dwordx4 v[228:231], v2, s[8:11], s22 offen offset:3072 sc1
  s_add_u32 s22, s31, 380928
  buffer_load_dwordx4 v[232:235], v2, s[8:11], s22 offen offset:0 sc1
  buffer_load_dwordx4 v[236:239], v2, s[8:11], s22 offen offset:1024 sc1
  buffer_load_dwordx4 v[240:243], v2, s[8:11], s22 offen offset:2048 sc1
  buffer_load_dwordx4 v[244:247], v2, s[8:11], s22 offen offset:3072 sc1
  s_waitcnt vmcnt(24)
  s_add_u32 s22, s31, 385024
  buffer_load_dwordx4 v[248:251], v2, s[8:11], s22 offen offset:0 sc1
  buffer_load_dwordx4 v[252:255], v2, s[8:11], s22 offen offset:1024 sc1
  v_mov_b32 v72, v116
  v_mov_b32 v73, v117
  v_lshrrev_b32 v65, 1, v72
  v_and_b32 v66, 1, v72
  v_mov_b32 v67, 20
  v_lshl_add_u32 v67, v67, 4, v73
  v_mul_u32_u24 v68, 2341, v67
  v_lshrrev_b32 v68, 16, v68
  v_mul_u32_u24 v69, 28, v68
  v_sub_u32 v69, v67, v69
  v_lshrrev_b32 v70, 4, v69
  v_and_b32 v69, 15, v69
  v_and_b32 v71, 1, v69
  v_lshrrev_b32 v69, 1, v69
  v_lshl_add_u32 v69, v71, 3, v69
  v_lshlrev_b32 v71, 12, v70
  v_lshrrev_b32 v70, 1, v68
  v_lshl_add_u32 v71, v70, 9, v71
  v_and_b32 v70, 1, v68
  v_lshl_add_u32 v71, v70, 2, v71
  v_lshl_add_u32 v71, v69, 4, v71
  v_lshl_add_u32 v71, v65, 8, v71
  v_lshl_add_u32 v100, v66, 3, v71
  v_mov_b32 v67, 21
  v_lshl_add_u32 v67, v67, 4, v73
  v_mul_u32_u24 v68, 2341, v67
  v_lshrrev_b32 v68, 16, v68
  v_mul_u32_u24 v69, 28, v68
  v_sub_u32 v69, v67, v69
  v_lshrrev_b32 v70, 4, v69
  v_and_b32 v69, 15, v69
  v_and_b32 v71, 1, v69
  v_lshrrev_b32 v69, 1, v69
  v_lshl_add_u32 v69, v71, 3, v69
  v_lshlrev_b32 v71, 12, v70
  v_lshrrev_b32 v70, 1, v68
  v_lshl_add_u32 v71, v70, 9, v71
  v_and_b32 v70, 1, v68
  v_lshl_add_u32 v71, v70, 2, v71
  v_lshl_add_u32 v71, v69, 4, v71
  v_lshl_add_u32 v71, v65, 8, v71
  v_lshl_add_u32 v101, v66, 3, v71
  v_mov_b32 v67, 22
  v_lshl_add_u32 v67, v67, 4, v73
  v_mul_u32_u24 v68, 2341, v67
  v_lshrrev_b32 v68, 16, v68
  v_mul_u32_u24 v69, 28, v68
  v_sub_u32 v69, v67, v69
  v_lshrrev_b32 v70, 4, v69
  v_and_b32 v69, 15, v69
  v_and_b32 v71, 1, v69
  v_lshrrev_b32 v69, 1, v69
  v_lshl_add_u32 v69, v71, 3, v69
  v_lshlrev_b32 v71, 12, v70
  v_lshrrev_b32 v70, 1, v68
  v_lshl_add_u32 v71, v70, 9, v71
  v_and_b32 v70, 1, v68
  v_lshl_add_u32 v71, v70, 2, v71
  v_lshl_add_u32 v71, v69, 4, v71
  v_lshl_add_u32 v71, v65, 8, v71
  v_lshl_add_u32 v102, v66, 3, v71
  v_mov_b32 v67, 23
  v_lshl_add_u32 v67, v67, 4, v73
  v_mul_u32_u24 v68, 2341, v67
  v_lshrrev_b32 v68, 16, v68
  v_mul_u32_u24 v69, 28, v68
  v_sub_u32 v69, v67, v69
  v_lshrrev_b32 v70, 4, v69
  v_and_b32 v69, 15, v69
  v_and_b32 v71, 1, v69
  v_lshrrev_b32 v69, 1, v69
  v_lshl_add_u32 v69, v71, 3, v69
  v_lshlrev_b32 v71, 12, v70
  v_lshrrev_b32 v70, 1, v68
  v_lshl_add_u32 v71, v70, 9, v71
  v_and_b32 v70, 1, v68
  v_lshl_add_u32 v71, v70, 2, v71
  v_lshl_add_u32 v71, v69, 4, v71
  v_lshl_add_u32 v71, v65, 8, v71
  v_lshl_add_u32 v103, v66, 3, v71
  v_mov_b32 v67, 24
  v_lshl_add_u32 v67, v67, 4, v73
  v_mul_u32_u24 v68, 2341, v67
  v_lshrrev_b32 v68, 16, v68
  v_mul_u32_u24 v69, 28, v68
  v_sub_u32 v69, v67, v69
  v_lshrrev_b32 v70, 4, v69
  v_and_b32 v69, 15, v69
  v_and_b32 v71, 1, v69
  v_lshrrev_b32 v69, 1, v69
  v_lshl_add_u32 v69, v71, 3, v69
  v_lshlrev_b32 v71, 12, v70
  v_lshrrev_b32 v70, 1, v68
  v_lshl_add_u32 v71, v70, 9, v71
  v_and_b32 v70, 1, v68
  v_lshl_add_u32 v71, v70, 2, v71
  v_lshl_add_u32 v71, v69, 4, v71
  v_lshl_add_u32 v71, v65, 8, v71
  v_lshl_add_u32 v104, v66, 3, v71
  v_mov_b32 v67, 25
  v_lshl_add_u32 v67, v67, 4, v73
  v_mul_u32_u24 v68, 2341, v67
  v_lshrrev_b32 v68, 16, v68
  v_mul_u32_u24 v69, 28, v68
  v_sub_u32 v69, v67, v69
  v_lshrrev_b32 v70, 4, v69
  v_and_b32 v69, 15, v69
  v_and_b32 v71, 1, v69
  v_lshrrev_b32 v69, 1, v69
  v_lshl_add_u32 v69, v71, 3, v69
  v_lshlrev_b32 v71, 12, v70
  v_lshrrev_b32 v70, 1, v68
  v_lshl_add_u32 v71, v70, 9, v71
  v_and_b32 v70, 1, v68
  v_lshl_add_u32 v71, v70, 2, v71
  v_lshl_add_u32 v71, v69, 4, v71
  v_lshl_add_u32 v71, v65, 8, v71
  v_lshl_add_u32 v105, v66, 3, v71
  v_mov_b32 v67, 26
  v_lshl_add_u32 v67, v67, 4, v73
  v_mul_u32_u24 v68, 2341, v67
  v_lshrrev_b32 v68, 16, v68
  v_mul_u32_u24 v69, 28, v68
  v_sub_u32 v69, v67, v69
  v_lshrrev_b32 v70, 4, v69
  v_and_b32 v69, 15, v69
  v_and_b32 v71, 1, v69
  v_lshrrev_b32 v69, 1, v69
  v_lshl_add_u32 v69, v71, 3, v69
  v_lshlrev_b32 v71, 12, v70
  v_lshrrev_b32 v70, 1, v68
  v_lshl_add_u32 v71, v70, 9, v71
  v_and_b32 v70, 1, v68
  v_lshl_add_u32 v71, v70, 2, v71
  v_lshl_add_u32 v71, v69, 4, v71
  v_lshl_add_u32 v71, v65, 8, v71
  v_lshl_add_u32 v106, v66, 3, v71
  v_mov_b32 v67, 27
  v_lshl_add_u32 v67, v67, 4, v73
  v_mul_u32_u24 v68, 2341, v67
  v_lshrrev_b32 v68, 16, v68
  v_mul_u32_u24 v69, 28, v68
  v_sub_u32 v69, v67, v69
  v_lshrrev_b32 v70, 4, v69
  v_and_b32 v69, 15, v69
  v_and_b32 v71, 1, v69
  v_lshrrev_b32 v69, 1, v69
  v_lshl_add_u32 v69, v71, 3, v69
  v_lshlrev_b32 v71, 12, v70
  v_lshrrev_b32 v70, 1, v68
  v_lshl_add_u32 v71, v70, 9, v71
  v_and_b32 v70, 1, v68
  v_lshl_add_u32 v71, v70, 2, v71
  v_lshl_add_u32 v71, v69, 4, v71
  v_lshl_add_u32 v71, v65, 8, v71
  v_lshl_add_u32 v107, v66, 3, v71
  s_mul_i32 s24, s17, 532480
  s_add_u32 s24, s24, 76943360
  s_mul_i32 s34, s17, 640
  s_add_u32 s34, s34, 88582148
  s_mul_i32 s36, s17, 448
  v_add_u32 v0, s36, v2
  v_add_u32 v0, 8192, v0
  s_add_u32 s36, s36, 88080384
  s_mov_b32 s37, 76939264
  v_cmp_gt_u32 s[26:27], 28, v1
  v_and_b32 v119, 31, v1
  v_lshlrev_b32 v119, 2, v119
  v_and_b32 v119, 0x78, v119
  v_or_b32 v119, 4, v119
  s_add_u32 s22, s17, 16
  s_and_b32 s22, s22, 15
  s_lshl_b32 s22, s22, 7
  s_add_u32 s22, s22, 18432
  v_add_u32 v119, s22, v119
  v_min_u32 v118, 13, v1
  s_mul_i32 s22, s17, 14
  v_add_u32 v118, s22, v118
  v_lshlrev_b32 v118, 7, v118
  v_add_u32 v118, 57344, v118
  s_mov_b32 s39, 71565312
  v_add_u32 v1, 59392, v2
  v_mov_b32 v117, 1
  s_mul_i32 s38, s17, 1104
  s_add_u32 s38, s38, 21504
  v_bfe_u32 v8, v2, 4, 1
  v_mul_u32_u24 v3, 0xaaaa, v8
  v_add_u32 v3, 0x4444, v3
  v_bfe_u32 v9, v2, 5, 3
  v_lshl_add_u32 v8, v8, 3, v9
  v_and_b32 v9, 0x300, v2
  v_lshl_add_u32 v5, v8, 4, v9
  s_lshl_b32 s22, 0, 11
  s_add_u32 s22, s22, 88602624
  v_add_u32 v36, 1024, v2
  v_min_u32 v36, 1776, v36
  s_mov_b32 s30, 0
va_iw7:
  buffer_load_dwordx4 v[40:43], v2, s[8:11], s22 offen sc1
  buffer_load_dwordx4 v[44:47], v36, s[8:11], s22 offen sc1
  s_waitcnt vmcnt(0)
  v_cmp_ne_u64 vcc, s[88:89], v[40:41]
  s_cbranch_vccnz va_iw7_no
  v_cmp_ne_u64 vcc, s[88:89], v[42:43]
  s_cbranch_vccnz va_iw7_no
  v_cmp_ne_u64 vcc, s[88:89], v[44:45]
  s_cbranch_vccnz va_iw7_no
  v_cmp_ne_u64 vcc, s[88:89], v[46:47]
  s_cbranch_vccnz va_iw7_no
  s_branch va_iw7_ok
va_iw7_no:
  s_sleep 2
  s_add_u32 s30, s30, 1
  s_cmp_lt_u32 s30, 50000
  s_cbranch_scc1 va_iw7
  s_branch cA_abort
va_iw7_ok:
  s_mov_b32 s30, 0
  v_mov_b32 v36, 0
ch_md7:
  buffer_load_dword v37, v36, s[12:15], 0 offen sc1
  s_waitcnt vmcnt(0)
  v_readfirstlane_b32 s22, v37
  s_and_b32 s31, s22, 0xffff
  s_cmp_ge_u32 s31, 32
  s_cbranch_scc1 ch_go7
  s_sleep 2
  s_add_u32 s30, s30, 1
  s_cmp_lt_u32 s30, 50000
  s_cbranch_scc1 ch_md7
  s_branch ch_end
ch_go7:
  s_mov_b32 s31, 0
  s_lshr_b32 s22, s22, 16
  s_cmp_lg_u32 s22, 0
  s_cbranch_scc1 cB_va3_loop
  s_branch cA_va3_loop
.p2align 6

cA_sc0_loop:
  s_add_u32 s23, s20, 4096
  s_add_u32 s21, s20, 20480
  v_mov_b32 v48, 0
  v_mov_b32 v49, 0
  v_mov_b32 v50, 0
  v_mov_b32 v51, 0
  v_mov_b32 v52, 0
  v_mov_b32 v53, 0
  v_mov_b32 v54, 0
  v_mov_b32 v55, 0
  v_mov_b32 v56, 0
  v_mov_b32 v57, 0
  v_mov_b32 v58, 0
  v_mov_b32 v59, 0
  v_mov_b32 v60, 0
  v_mov_b32 v61, 0
  v_mov_b32 v62, 0
  v_mov_b32 v63, 0
  v_mov_b32 v88, 0
  v_mov_b32 v89, 0
  v_mov_b32 v90, 0
  v_mov_b32 v91, 0
  v_mov_b32 v92, 0
  v_mov_b32 v93, 0
  v_mov_b32 v94, 0
  v_mov_b32 v95, 0
  v_mov_b32 v66, 0
  v_mov_b32 v67, 0
  s_mov_b32 s30, 0
  s_mov_b32 s62, 0
  buffer_load_dword v68, v0, s[8:11], s20 offen sc1
  s_nop 7
  buffer_load_dword v69, v0, s[8:11], s20 offen sc1
  s_nop 7
  buffer_load_dword v70, v0, s[8:11], s20 offen sc1
  s_nop 7
  buffer_load_dword v71, v0, s[8:11], s20 offen sc1
  s_nop 7
  buffer_load_dword v72, v0, s[8:11], s20 offen sc1
cA_sc0_fp_l:
  s_waitcnt vmcnt(4)
  v_cmp_eq_u32 vcc, -1, v68
  s_cbranch_vccz cA_sc0_fp_d
  buffer_load_dword v68, v0, s[8:11], s20 offen sc1
  s_waitcnt vmcnt(4)
  v_cmp_eq_u32 vcc, -1, v69
  s_cbranch_vccz cA_sc0_fp_d
  buffer_load_dword v69, v0, s[8:11], s20 offen sc1
  s_waitcnt vmcnt(4)
  v_cmp_eq_u32 vcc, -1, v70
  s_cbranch_vccz cA_sc0_fp_d
  buffer_load_dword v70, v0, s[8:11], s20 offen sc1
  s_waitcnt vmcnt(4)
  v_cmp_eq_u32 vcc, -1, v71
  s_cbranch_vccz cA_sc0_fp_d
  buffer_load_dword v71, v0, s[8:11], s20 offen sc1
  s_waitcnt vmcnt(4)
  v_cmp_eq_u32 vcc, -1, v72
  s_cbranch_vccz cA_sc0_fp_d
  buffer_load_dword v72, v0, s[8:11], s20 offen sc1
  s_add_u32 s30, s30, 1
  s_cmp_lt_u32 s30, 400000
  s_cbranch_scc1 cA_sc0_fp_l
  s_branch cA_abort
cA_sc0_fp_d:
  buffer_load_dwordx4 v[8:11], v2, s[8:11], s20 offen offset:0
  s_barrier
  s_branch cA_sc0_ld1
cA_sc0_ld:
  buffer_load_dwordx4 v[8:11], v2, s[8:11], s20 offen offset:0
cA_sc0_ld1:
  v_mov_b32 v36, 0
  v_mov_b32 v37, 0
  v_mov_b32 v38, 0
  v_mov_b32 v39, 0
  buffer_load_dwordx4 v[12:15], v2, s[8:11], s20 offen offset:1024
  v_mov_b32 v40, 0
  v_mov_b32 v41, 0
  v_mov_b32 v42, 0
  v_mov_b32 v43, 0
  buffer_load_dwordx4 v[16:19], v2, s[8:11], s20 offen offset:2048
  v_mov_b32 v44, 0
  v_mov_b32 v45, 0
  v_mov_b32 v46, 0
  v_mov_b32 v47, 0
  ds_read_b128 v[96:99], v117 offset:0
  ds_read_b128 v[100:103], v117 offset:1024
  ds_read_b128 v[104:107], v117 offset:14336
  ds_read_b128 v[108:111], v117 offset:15360
  s_waitcnt vmcnt(2)
  v_smfmac_f32_16x16x64_bf16 v[36:39], v[8:11], a[0:7], v3
  v_smfmac_f32_16x16x64_bf16 v[40:43], v[8:11], a[56:63], v3
  buffer_load_dwordx4 v[20:23], v2, s[8:11], s20 offen offset:3072
  v_smfmac_f32_16x16x64_bf16 v[44:47], v[8:11], a[112:119], v3
  v_smfmac_f32_16x16x64_bf16 v[48:51], v[8:11], a[168:175], v3
  v_smfmac_f32_16x16x64_bf16 v[52:55], v[8:11], a[224:231], v3
  buffer_load_dwordx4 v[24:27], v2, s[8:11], s23 offen offset:0
  v_smfmac_f32_16x16x64_bf16 v[56:59], v[8:11], v[144:151], v3
  v_smfmac_f32_16x16x64_bf16 v[60:63], v[8:11], v[200:207], v3
  s_waitcnt vmcnt(3)
  v_smfmac_f32_16x16x64_bf16 v[36:39], v[12:15], a[8:15], v3
  v_smfmac_f32_16x16x64_bf16 v[40:43], v[12:15], a[64:71], v3
  buffer_load_dwordx4 v[28:31], v2, s[8:11], s23 offen offset:1024
  v_smfmac_f32_16x16x64_bf16 v[44:47], v[12:15], a[120:127], v3
  v_smfmac_f32_16x16x64_bf16 v[48:51], v[12:15], a[176:183], v3
  v_smfmac_f32_16x16x64_bf16 v[52:55], v[12:15], a[232:239], v3
  buffer_load_dwordx4 v[32:35], v2, s[8:11], s23 offen offset:2048
  v_smfmac_f32_16x16x64_bf16 v[56:59], v[12:15], v[152:159], v3
  v_smfmac_f32_16x16x64_bf16 v[60:63], v[12:15], v[208:215], v3
  s_xor_b32 s58, s25, 28672
  s_add_u32 s59, s24, 28672
  s_add_u32 m0, s58, 0
  s_waitcnt vmcnt(4)
  v_smfmac_f32_16x16x64_bf16 v[36:39], v[16:19], a[16:23], v3
  buffer_load_dwordx4 v2, s[8:11], s59 offen offset:0 sc1 lds
  v_smfmac_f32_16x16x64_bf16 v[40:43], v[16:19], a[72:79], v3
  v_smfmac_f32_16x16x64_bf16 v[44:47], v[16:19], a[128:135], v3
  v_smfmac_f32_16x16x64_bf16 v[48:51], v[16:19], a[184:191], v3
  v_smfmac_f32_16x16x64_bf16 v[52:55], v[16:19], a[240:247], v3
  buffer_load_dwordx4 v2, s[8:11], s59 offen offset:1024 sc1 lds
  v_smfmac_f32_16x16x64_bf16 v[56:59], v[16:19], v[160:167], v3
  v_smfmac_f32_16x16x64_bf16 v[60:63], v[16:19], v[216:223], v3
  s_waitcnt vmcnt(5)
  v_smfmac_f32_16x16x64_bf16 v[36:39], v[20:23], a[24:31], v3
  v_smfmac_f32_16x16x64_bf16 v[40:43], v[20:23], a[80:87], v3
  buffer_load_dwordx4 v2, s[8:11], s59 offen offset:2048 sc1 lds
  v_smfmac_f32_16x16x64_bf16 v[44:47], v[20:23], a[136:143], v3
  v_smfmac_f32_16x16x64_bf16 v[48:51], v[20:23], a[192:199], v3
  v_smfmac_f32_16x16x64_bf16 v[52:55], v[20:23], a[248:255], v3
  v_smfmac_f32_16x16x64_bf16 v[56:59], v[20:23], v[168:175], v3
  buffer_load_dwordx4 v2, s[8:11], s59 offen offset:3072 sc1 lds
  v_smfmac_f32_16x16x64_bf16 v[60:63], v[20:23], v[224:231], v3
  s_waitcnt vmcnt(4)
cA_sc0_ph2:
  v_smfmac_f32_16x16x64_bf16 v[60:63], v[24:27], v[232:239], v3
  ds_read_b128 v[12:15], v116 offset:0
  ds_read_b128 v[16:19], v116 offset:1024
  v_smfmac_f32_16x16x64_bf16 v[60:63], v[28:31], v[240:247], v3
  v_smfmac_f32_16x16x64_bf16 v[60:63], v[32:35], v[248:255], v3
  v_mov_b32 v80, v24
  v_smfmac_f32_16x16x64_bf16 v[52:55], v[24:27], v[120:127], v3
  v_mov_b32 v81, v25
  v_smfmac_f32_16x16x64_bf16 v[52:55], v[28:31], v[128:135], v3
  v_mov_b32 v82, v32
  v_smfmac_f32_16x16x64_bf16 v[52:55], v[32:35], v[136:143], v3
  v_cvt_pk_bf16_f32 v64, v60, v61
  v_smfmac_f32_16x16x64_bf16 v[56:59], v[24:27], v[176:183], v3
  v_cvt_pk_bf16_f32 v65, v62, v63
  v_smfmac_f32_16x16x64_bf16 v[56:59], v[28:31], v[184:191], v3
  v_mov_b32 v83, v33
  v_mfma_f32_16x16x32_bf16 v[68:71], v[64:67], v[4:7], 0
  v_smfmac_f32_16x16x64_bf16 v[56:59], v[32:35], v[192:199], v3
  v_cvt_pk_bf16_f32 v64, v52, v53
  v_smfmac_f32_16x16x64_bf16 v[36:39], v[24:27], a[32:39], v3
  v_cvt_pk_bf16_f32 v65, v54, v55
  v_smfmac_f32_16x16x64_bf16 v[36:39], v[28:31], a[40:47], v3
  v_cvt_pk_bf16_f32 v78, v68, v69
  v_smfmac_f32_16x16x64_bf16 v[36:39], v[32:35], a[48:55], v3
  v_cvt_pk_bf16_f32 v79, v70, v71
  v_cvt_pk_bf16_f32 v66, v56, v57
  v_smfmac_f32_16x16x64_bf16 v[40:43], v[24:27], a[88:95], v3
  v_cvt_pk_bf16_f32 v67, v58, v59
  v_smfmac_f32_16x16x64_bf16 v[40:43], v[28:31], a[96:103], v3
  v_mfma_f32_16x16x32_bf16 v[72:75], v[64:67], v[4:7], 0
  ds_read_b128 v[52:55], v116 offset:14336
  ds_read_b128 v[56:59], v116 offset:15360
  v_smfmac_f32_16x16x64_bf16 v[40:43], v[32:35], a[104:111], v3
  v_cvt_pk_bf16_f32 v64, v36, v37
  v_smfmac_f32_16x16x64_bf16 v[44:47], v[24:27], a[144:151], v3
  v_cvt_pk_bf16_f32 v65, v38, v39
  v_smfmac_f32_16x16x64_bf16 v[44:47], v[28:31], a[152:159], v3
  v_cvt_pk_bf16_f32 v76, v72, v73
  v_smfmac_f32_16x16x64_bf16 v[44:47], v[32:35], a[160:167], v3
  v_cvt_pk_bf16_f32 v77, v74, v75
  v_cvt_pk_bf16_f32 v66, v40, v41
  v_smfmac_f32_16x16x64_bf16 v[48:51], v[24:27], a[200:207], v3
  v_cvt_pk_bf16_f32 v67, v42, v43
  v_smfmac_f32_16x16x64_bf16 v[48:51], v[28:31], a[208:215], v3
  v_mfma_f32_16x16x32_bf16 v[68:71], v[64:67], v[4:7], 0
  v_smfmac_f32_16x16x64_bf16 v[48:51], v[32:35], a[216:223], v3
  v_cvt_pk_bf16_f32 v64, v44, v45
  v_mfma_f32_16x16x32_bf16 v[84:87], v[80:83], v[76:79], 0
  v_cvt_pk_bf16_f32 v65, v46, v47
  s_waitcnt lgkmcnt(0)
  v_smfmac_f32_16x16x64_bf16 v[88:91], v[76:79], v[96:103], v118
  v_cvt_pk_bf16_f32 v60, v68, v69
  v_cvt_pk_bf16_f32 v61, v70, v71
  v_cvt_pk_bf16_f32 v66, v48, v49
  v_cvt_pk_bf16_f32 v67, v50, v51
  s_nop 1
  v_mfma_f32_16x16x32_bf16 v[72:75], v[64:67], v[4:7], 0
  v_smfmac_f32_16x16x64_bf16 v[92:95], v[76:79], v[104:111], v118
  s_nop 4
  v_cvt_pk_bf16_f32 v62, v72, v73
  v_cvt_pk_bf16_f32 v63, v74, v75
  s_nop 1
  v_mfma_f32_16x16x32_bf16 v[84:87], v[8:11], v[60:63], v[84:87]
  v_smfmac_f32_16x16x64_bf16 v[88:91], v[60:63], v[12:19], v118
  v_smfmac_f32_16x16x64_bf16 v[92:95], v[60:63], v[52:59], v118
  s_nop 1
  v_permlane32_swap_b32 v84, v86
  v_permlane32_swap_b32 v85, v87
  s_nop 0
  v_add_f32 v88, v88, v89
  v_add_f32_dpp v84, v86, v84 quad_perm:[1,0,3,2] row_mask:0xf bank_mask:0xf
  v_add_f32_dpp v85, v87, v85 quad_perm:[1,0,3,2] row_mask:0xf bank_mask:0xf
  v_add_f32 v89, v90, v91
  ds_write2_b32 v113, v84, v85 offset0:0 offset1:4
  ds_write2_b32 v112, v88, v89 offset0:0 offset1:128
  v_add_f32 v90, v92, v93
  v_add_f32 v91, v94, v95
  ds_write2_b32 v112, v90, v91 offset0:64 offset1:192
  v_cmp_u_f32 vcc, v88, v89
  s_cbranch_vccnz cA_sc0_retry
cA_sc0_cont:
  s_waitcnt lgkmcnt(0)
  s_barrier
  ds_read_b128 v[36:39], v114
  ds_read_b128 v[44:47], v115
  s_waitcnt lgkmcnt(0)
  v_add_f32 v36, v36, v38
  v_add_f32 v37, v37, v39
  v_add_f32 v44, v44, v45
  v_add_f32 v46, v46, v47
  v_add_f32 v44, v44, v46
  v_add_f32 v36, v36, v37
  v_exp_f32 v49, v44
  v_exp_f32 v48, v36
  v_add_f32 v50, abs(v36), abs(v44)
  v_fma_f32 v39, v49, s37, v48
  v_cmp_ngt_f32 vcc, s56, v50
  v_cndmask_b32 v41, v48, v49, s[38:39]
  v_add_f32_dpp v39, v39, v39 quad_perm:[1,0,3,2] row_mask:0xf bank_mask:0xf
  v_cndmask_b32 v40, v49, v48, s[38:39]
  v_mov_b32_dpp v46, v41 quad_perm:[1,0,3,2] row_mask:0xf bank_mask:0xf
  v_add_f32_dpp v39, v39, v39 quad_perm:[2,3,0,1] row_mask:0xf bank_mask:0xf
  v_cndmask_b32 v42, v46, v40, s[38:39]
  v_cndmask_b32 v43, v40, v46, s[38:39]
  v_add_f32_dpp v39, v39, v39 row_half_mirror row_mask:0xf bank_mask:0xf
  s_cbranch_vccnz cA_sc0_slow
  s_nop 0
  v_add_f32_dpp v47, v39, v39 row_mirror row_mask:0xf bank_mask:0xf
  v_add_f32_dpp v39, v39, v39 row_mirror row_mask:0xf bank_mask:0xf
  s_nop 1
  v_permlane16_swap_b32 v39, v47
  v_add_f32 v39, v39, v47
  v_rcp_f32 v39, v39
  s_mov_b64 exec, s[28:29]
  v_mul_f32 v42, v42, v39
  v_mul_f32 v43, v43, v39
  v_cvt_pk_bf16_f32 v42, v42, v43
cA_sc0_pst:
  buffer_store_dword v42, v1, s[8:11], s20 offen
  s_mov_b64 exec, -1
  s_barrier
  s_add_u32 s24, s24, 28672
  s_add_u32 s35, s35, 28672
  s_xor_b32 s25, s25, 28672
  s_add_u32 m0, s25, 0
  s_add_u32 m0, s25, 4096
  s_add_u32 s22, s24, 4096
  buffer_load_dwordx4 v2, s[8:11], s22 offen offset:0 sc1 lds
  s_nop 5
  buffer_load_dwordx4 v2, s[8:11], s22 offen offset:1024 sc1 lds
  s_nop 5
  buffer_load_dwordx4 v2, s[8:11], s22 offen offset:2048 sc1 lds
  s_nop 5
  v_xor_b32 v116, 28672, v116
  v_add_u32 v117, s57, v117
  s_sub_u32 s57, 0, s57
  s_add_u32 s19, s19, 1
  s_mov_b32 s20, s21
  s_cmp_lt_u32 s19, 63
  s_cbranch_scc1 cA_sc0_loop
  s_branch cA_done
cA_sc0_slow:
  v_max_f32 v50, v36, v44
  s_nop 1
  v_max_f32_dpp v50, v50, v50 quad_perm:[1,0,3,2] row_mask:0xf bank_mask:0xf
  s_nop 1
  v_max_f32_dpp v50, v50, v50 quad_perm:[2,3,0,1] row_mask:0xf bank_mask:0xf
  s_nop 1
  v_max_f32_dpp v50, v50, v50 row_half_mirror row_mask:0xf bank_mask:0xf
  s_nop 1
  v_max_f32_dpp v50, v50, v50 row_mirror row_mask:0xf bank_mask:0xf
  v_mov_b32 v47, v50
  s_nop 1
  v_permlane16_swap_b32 v50, v47
  v_max_f32 v50, v50, v47
  v_sub_f32 v48, v36, v50
  v_sub_f32 v49, v44, v50
  v_exp_f32 v48, v48
  v_exp_f32 v49, v49
  s_add_u32 s31, s31, 0x100
  v_fma_f32 v39, v49, s37, v48
  v_cndmask_b32 v41, v48, v49, s[38:39]
  s_nop 0
  v_add_f32_dpp v39, v39, v39 quad_perm:[1,0,3,2] row_mask:0xf bank_mask:0xf
  v_cndmask_b32 v40, v49, v48, s[38:39]
  v_mov_b32_dpp v46, v41 quad_perm:[1,0,3,2] row_mask:0xf bank_mask:0xf
  v_add_f32_dpp v39, v39, v39 quad_perm:[2,3,0,1] row_mask:0xf bank_mask:0xf
  v_cndmask_b32 v42, v46, v40, s[38:39]
  v_cndmask_b32 v43, v40, v46, s[38:39]
  v_add_f32_dpp v39, v39, v39 row_half_mirror row_mask:0xf bank_mask:0xf
  s_nop 1
  v_add_f32_dpp v47, v39, v39 row_mirror row_mask:0xf bank_mask:0xf
  v_add_f32_dpp v39, v39, v39 row_mirror row_mask:0xf bank_mask:0xf
  s_nop 1
  v_permlane16_swap_b32 v39, v47
  v_add_f32 v39, v39, v47
  v_rcp_f32 v39, v39
  s_mov_b64 exec, s[28:29]
  v_mul_f32 v42, v42, v39
  v_mul_f32 v43, v43, v39
  v_cvt_pk_bf16_f32 v42, v42, v43
  v_min_u32 v42, -2, v42
  s_branch cA_sc0_pst
cA_sc0_retry:
  s_cmp_lg_u32 s62, 0
  s_cbranch_scc1 cA_sc0_cont
  s_waitcnt vmcnt(0) lgkmcnt(0)
cA_sc0_rv:
  buffer_load_dwordx4 v[8:11], v2, s[8:11], s20 offen offset:0 sc1
  buffer_load_dwordx4 v[12:15], v2, s[8:11], s20 offen offset:1024 sc1
  buffer_load_dwordx4 v[16:19], v2, s[8:11], s20 offen offset:2048 sc1
  buffer_load_dwordx4 v[20:23], v2, s[8:11], s20 offen offset:3072 sc1
  buffer_load_dwordx4 v[24:27], v2, s[8:11], s23 offen offset:0 sc1
  buffer_load_dwordx4 v[28:31], v2, s[8:11], s23 offen offset:1024 sc1
  buffer_load_dwordx4 v[32:35], v2, s[8:11], s23 offen offset:2048 sc1
  s_waitcnt vmcnt(0)
  v_max3_u32 v68, v8, v9, v10
  v_max3_u32 v68, v68, v11, v12
  v_max3_u32 v68, v68, v13, v14
  v_max3_u32 v68, v68, v15, v16
  v_max3_u32 v68, v68, v17, v18
  v_max3_u32 v68, v68, v19, v20
  v_max3_u32 v68, v68, v21, v22
  v_max3_u32 v68, v68, v23, v24
  v_max3_u32 v68, v68, v25, v26
  v_max3_u32 v68, v68, v27, v28
  v_max3_u32 v68, v68, v29, v30
  v_max3_u32 v68, v68, v31, v32
  v_max3_u32 v68, v68, v33, v34
  v_max_u32 v68, v68, v35
  v_cmp_eq_u32 vcc, -1, v68
  s_cbranch_vccz cA_sc0_rk
  s_add_u32 s30, s30, 1
  s_cmp_lt_u32 s30, 400000
  s_cbranch_scc1 cA_sc0_rv
  s_branch cA_abort
cA_sc0_rk:
  s_mov_b32 s62, 1
  v_mov_b32 v36, 0
  v_mov_b32 v37, 0
  v_mov_b32 v38, 0
  v_mov_b32 v39, 0
  v_mov_b32 v40, 0
  v_mov_b32 v41, 0
  v_mov_b32 v42, 0
  v_mov_b32 v43, 0
  v_mov_b32 v44, 0
  v_mov_b32 v45, 0
  v_mov_b32 v46, 0
  v_mov_b32 v47, 0
  v_mov_b32 v48, 0
  v_mov_b32 v49, 0
  v_mov_b32 v50, 0
  v_mov_b32 v51, 0
  v_mov_b32 v52, 0
  v_mov_b32 v53, 0
  v_mov_b32 v54, 0
  v_mov_b32 v55, 0
  v_mov_b32 v56, 0
  v_mov_b32 v57, 0
  v_mov_b32 v58, 0
  v_mov_b32 v59, 0
  v_mov_b32 v60, 0
  v_mov_b32 v61, 0
  v_mov_b32 v62, 0
  v_mov_b32 v63, 0
  v_mov_b32 v88, 0
  v_mov_b32 v89, 0
  v_mov_b32 v90, 0
  v_mov_b32 v91, 0
  v_mov_b32 v92, 0
  v_mov_b32 v93, 0
  v_mov_b32 v94, 0
  v_mov_b32 v95, 0
  v_mov_b32 v66, 0
  v_mov_b32 v67, 0
  s_add_u32 s31, s31, 1
  ds_read_b128 v[96:99], v117 offset:0
  ds_read_b128 v[100:103], v117 offset:1024
  ds_read_b128 v[104:107], v117 offset:14336
  ds_read_b128 v[108:111], v117 offset:15360
  v_smfmac_f32_16x16x64_bf16 v[36:39], v[8:11], a[0:7], v3
  v_smfmac_f32_16x16x64_bf16 v[40:43], v[8:11], a[56:63], v3
  v_smfmac_f32_16x16x64_bf16 v[44:47], v[8:11], a[112:119], v3
  v_smfmac_f32_16x16x64_bf16 v[48:51], v[8:11], a[168:175], v3
  v_smfmac_f32_16x16x64_bf16 v[52:55], v[8:11], a[224:231], v3
  v_smfmac_f32_16x16x64_bf16 v[56:59], v[8:11], v[144:151], v3
  v_smfmac_f32_16x16x64_bf16 v[60:63], v[8:11], v[200:207], v3
  v_smfmac_f32_16x16x64_bf16 v[36:39], v[12:15], a[8:15], v3
  v_smfmac_f32_16x16x64_bf16 v[40:43], v[12:15], a[64:71], v3
  v_smfmac_f32_16x16x64_bf16 v[44:47], v[12:15], a[120:127], v3
  v_smfmac_f32_16x16x64_bf16 v[48:51], v[12:15], a[176:183], v3
  v_smfmac_f32_16x16x64_bf16 v[52:55], v[12:15], a[232:239], v3
  v_smfmac_f32_16x16x64_bf16 v[56:59], v[12:15], v[152:159], v3
  v_smfmac_f32_16x16x64_bf16 v[60:63], v[12:15], v[208:215], v3
  v_smfmac_f32_16x16x64_bf16 v[36:39], v[16:19], a[16:23], v3
  v_smfmac_f32_16x16x64_bf16 v[40:43], v[16:19], a[72:79], v3
  v_smfmac_f32_16x16x64_bf16 v[44:47], v[16:19], a[128:135], v3
  v_smfmac_f32_16x16x64_bf16 v[48:51], v[16:19], a[184:191], v3
  v_smfmac_f32_16x16x64_bf16 v[52:55], v[16:19], a[240:247], v3
  v_smfmac_f32_16x16x64_bf16 v[56:59], v[16:19], v[160:167], v3
  v_smfmac_f32_16x16x64_bf16 v[60:63], v[16:19], v[216:223], v3
  v_smfmac_f32_16x16x64_bf16 v[36:39], v[20:23], a[24:31], v3
  v_smfmac_f32_16x16x64_bf16 v[40:43], v[20:23], a[80:87], v3
  v_smfmac_f32_16x16x64_bf16 v[44:47], v[20:23], a[136:143], v3
  v_smfmac_f32_16x16x64_bf16 v[48:51], v[20:23], a[192:199], v3
  v_smfmac_f32_16x16x64_bf16 v[52:55], v[20:23], a[248:255], v3
  v_smfmac_f32_16x16x64_bf16 v[56:59], v[20:23], v[168:175], v3
  v_smfmac_f32_16x16x64_bf16 v[60:63], v[20:23], v[224:231], v3
  s_xor_b32 s58, s25, 28672
  s_add_u32 s59, s24, 28672
  s_add_u32 m0, s58, 0
  s_branch cA_sc0_ph2
.p2align 6

cA_sc1_loop:
  s_add_u32 s23, s20, 4096
  s_add_u32 s21, s20, 20480
  v_mov_b32 v48, 0
  v_mov_b32 v49, 0
  v_mov_b32 v50, 0
  v_mov_b32 v51, 0
  v_mov_b32 v52, 0
  v_mov_b32 v53, 0
  v_mov_b32 v54, 0
  v_mov_b32 v55, 0
  v_mov_b32 v56, 0
  v_mov_b32 v57, 0
  v_mov_b32 v58, 0
  v_mov_b32 v59, 0
  v_mov_b32 v60, 0
  v_mov_b32 v61, 0
  v_mov_b32 v62, 0
  v_mov_b32 v63, 0
  v_mov_b32 v88, 0
  v_mov_b32 v89, 0
  v_mov_b32 v90, 0
  v_mov_b32 v91, 0
  v_mov_b32 v92, 0
  v_mov_b32 v93, 0
  v_mov_b32 v94, 0
  v_mov_b32 v95, 0
  v_mov_b32 v64, 0
  v_mov_b32 v65, 0
  s_mov_b32 s30, 0
  s_mov_b32 s62, 0
  s_waitcnt vmcnt(0)
  s_barrier
cA_sc1_ld:
  buffer_load_dwordx4 v[8:11], v2, s[8:11], s20 offen offset:0
  v_mov_b32 v36, 0
  v_mov_b32 v37, 0
  v_mov_b32 v38, 0
  v_mov_b32 v39, 0
  buffer_load_dwordx4 v[12:15], v2, s[8:11], s20 offen offset:1024
  v_mov_b32 v40, 0
  v_mov_b32 v41, 0
  v_mov_b32 v42, 0
  v_mov_b32 v43, 0
  buffer_load_dwordx4 v[16:19], v2, s[8:11], s20 offen offset:2048
  v_mov_b32 v44, 0
  v_mov_b32 v45, 0
  v_mov_b32 v46, 0
  v_mov_b32 v47, 0
  ds_read_b128 v[96:99], v117 offset:0
  ds_read_b128 v[100:103], v117 offset:1024
  ds_read_b128 v[104:107], v117 offset:14336
  ds_read_b128 v[108:111], v117 offset:15360
  s_waitcnt vmcnt(2)
  v_smfmac_f32_16x16x64_bf16 v[36:39], v[8:11], a[0:7], v3
  v_smfmac_f32_16x16x64_bf16 v[40:43], v[8:11], a[56:63], v3
  buffer_load_dwordx4 v[20:23], v2, s[8:11], s20 offen offset:3072
  v_smfmac_f32_16x16x64_bf16 v[44:47], v[8:11], a[112:119], v3
  v_smfmac_f32_16x16x64_bf16 v[48:51], v[8:11], a[168:175], v3
  v_smfmac_f32_16x16x64_bf16 v[52:55], v[8:11], a[224:231], v3
  buffer_load_dwordx4 v[24:27], v2, s[8:11], s23 offen offset:0
  v_smfmac_f32_16x16x64_bf16 v[56:59], v[8:11], v[144:151], v3
  v_smfmac_f32_16x16x64_bf16 v[60:63], v[8:11], v[200:207], v3
  s_waitcnt vmcnt(3)
  v_smfmac_f32_16x16x64_bf16 v[36:39], v[12:15], a[8:15], v3
  v_smfmac_f32_16x16x64_bf16 v[40:43], v[12:15], a[64:71], v3
  buffer_load_dwordx4 v[28:31], v2, s[8:11], s23 offen offset:1024
  v_smfmac_f32_16x16x64_bf16 v[44:47], v[12:15], a[120:127], v3
  v_smfmac_f32_16x16x64_bf16 v[48:51], v[12:15], a[176:183], v3
  v_smfmac_f32_16x16x64_bf16 v[52:55], v[12:15], a[232:239], v3
  buffer_load_dwordx4 v[32:35], v2, s[8:11], s23 offen offset:2048
  v_smfmac_f32_16x16x64_bf16 v[56:59], v[12:15], v[152:159], v3
  v_smfmac_f32_16x16x64_bf16 v[60:63], v[12:15], v[208:215], v3
  s_waitcnt vmcnt(4)
  v_smfmac_f32_16x16x64_bf16 v[36:39], v[16:19], a[16:23], v3
  s_xor_b32 s58, s25, 28672
  s_add_u32 s59, s24, 28672
  s_add_u32 m0, s58, 7168
  v_smfmac_f32_16x16x64_bf16 v[40:43], v[16:19], a[72:79], v3
  buffer_load_dwordx4 v2, s[8:11], s59 offen offset:0 sc1 lds
  v_smfmac_f32_16x16x64_bf16 v[44:47], v[16:19], a[128:135], v3
  v_smfmac_f32_16x16x64_bf16 v[48:51], v[16:19], a[184:191], v3
  v_smfmac_f32_16x16x64_bf16 v[52:55], v[16:19], a[240:247], v3
  v_smfmac_f32_16x16x64_bf16 v[56:59], v[16:19], v[160:167], v3
  buffer_load_dwordx4 v2, s[8:11], s59 offen offset:1024 sc1 lds
  v_smfmac_f32_16x16x64_bf16 v[60:63], v[16:19], v[216:223], v3
  s_waitcnt vmcnt(5)
  v_smfmac_f32_16x16x64_bf16 v[36:39], v[20:23], a[24:31], v3
  v_smfmac_f32_16x16x64_bf16 v[40:43], v[20:23], a[80:87], v3
  v_smfmac_f32_16x16x64_bf16 v[44:47], v[20:23], a[136:143], v3
  buffer_load_dwordx4 v2, s[8:11], s59 offen offset:2048 sc1 lds
  v_smfmac_f32_16x16x64_bf16 v[48:51], v[20:23], a[192:199], v3
  v_smfmac_f32_16x16x64_bf16 v[52:55], v[20:23], a[248:255], v3
  v_smfmac_f32_16x16x64_bf16 v[56:59], v[20:23], v[168:175], v3
  v_smfmac_f32_16x16x64_bf16 v[60:63], v[20:23], v[224:231], v3
  buffer_load_dwordx4 v2, s[8:11], s59 offen offset:3072 sc1 lds
  s_waitcnt vmcnt(4)
cA_sc1_ph2:
  v_smfmac_f32_16x16x64_bf16 v[60:63], v[24:27], v[232:239], v3
  ds_read_b128 v[16:19], v116 offset:2048
  ds_read_b128 v[20:23], v116 offset:3072
  v_smfmac_f32_16x16x64_bf16 v[60:63], v[28:31], v[240:247], v3
  buffer_load_dword v119, v0, s[8:11], s20 offen sc1
  v_smfmac_f32_16x16x64_bf16 v[60:63], v[32:35], v[248:255], v3
  v_mov_b32 v80, v26
  v_smfmac_f32_16x16x64_bf16 v[52:55], v[24:27], v[120:127], v3
  v_mov_b32 v81, v27
  v_smfmac_f32_16x16x64_bf16 v[52:55], v[28:31], v[128:135], v3
  v_mov_b32 v82, v32
  v_smfmac_f32_16x16x64_bf16 v[52:55], v[32:35], v[136:143], v3
  v_cvt_pk_bf16_f32 v66, v60, v61
  v_smfmac_f32_16x16x64_bf16 v[56:59], v[24:27], v[176:183], v3
  v_cvt_pk_bf16_f32 v67, v62, v63
  v_smfmac_f32_16x16x64_bf16 v[56:59], v[28:31], v[184:191], v3
  v_mov_b32 v83, v33
  v_mfma_f32_16x16x32_bf16 v[68:71], v[64:67], v[4:7], 0
  v_smfmac_f32_16x16x64_bf16 v[56:59], v[32:35], v[192:199], v3
  v_cvt_pk_bf16_f32 v64, v52, v53
  v_smfmac_f32_16x16x64_bf16 v[36:39], v[24:27], a[32:39], v3
  v_cvt_pk_bf16_f32 v65, v54, v55
  v_smfmac_f32_16x16x64_bf16 v[36:39], v[28:31], a[40:47], v3
  v_cvt_pk_bf16_f32 v78, v68, v69
  v_smfmac_f32_16x16x64_bf16 v[36:39], v[32:35], a[48:55], v3
  v_cvt_pk_bf16_f32 v79, v70, v71
  v_cvt_pk_bf16_f32 v66, v56, v57
  v_smfmac_f32_16x16x64_bf16 v[40:43], v[24:27], a[88:95], v3
  v_cvt_pk_bf16_f32 v67, v58, v59
  v_smfmac_f32_16x16x64_bf16 v[40:43], v[28:31], a[96:103], v3
  v_mfma_f32_16x16x32_bf16 v[72:75], v[64:67], v[4:7], 0
  ds_read_b128 v[52:55], v116 offset:16384
  ds_read_b128 v[56:59], v116 offset:17408
  v_smfmac_f32_16x16x64_bf16 v[40:43], v[32:35], a[104:111], v3
  v_cvt_pk_bf16_f32 v64, v36, v37
  v_smfmac_f32_16x16x64_bf16 v[44:47], v[24:27], a[144:151], v3
  v_cvt_pk_bf16_f32 v65, v38, v39
  v_smfmac_f32_16x16x64_bf16 v[44:47], v[28:31], a[152:159], v3
  v_cvt_pk_bf16_f32 v76, v72, v73
  v_smfmac_f32_16x16x64_bf16 v[44:47], v[32:35], a[160:167], v3
  v_cvt_pk_bf16_f32 v77, v74, v75
  v_cvt_pk_bf16_f32 v66, v40, v41
  v_smfmac_f32_16x16x64_bf16 v[48:51], v[24:27], a[200:207], v3
  v_cvt_pk_bf16_f32 v67, v42, v43
  v_smfmac_f32_16x16x64_bf16 v[48:51], v[28:31], a[208:215], v3
  v_mfma_f32_16x16x32_bf16 v[68:71], v[64:67], v[4:7], 0
  v_smfmac_f32_16x16x64_bf16 v[48:51], v[32:35], a[216:223], v3
  v_cvt_pk_bf16_f32 v64, v44, v45
  v_mfma_f32_16x16x32_bf16 v[84:87], v[80:83], v[76:79], 0
  v_cvt_pk_bf16_f32 v65, v46, v47
  s_waitcnt lgkmcnt(0)
  v_smfmac_f32_16x16x64_bf16 v[88:91], v[76:79], v[96:103], v118
  v_cvt_pk_bf16_f32 v60, v68, v69
  v_cvt_pk_bf16_f32 v61, v70, v71
  v_cvt_pk_bf16_f32 v66, v48, v49
  v_cvt_pk_bf16_f32 v67, v50, v51
  s_nop 1
  v_mfma_f32_16x16x32_bf16 v[72:75], v[64:67], v[4:7], 0
  v_smfmac_f32_16x16x64_bf16 v[92:95], v[76:79], v[104:111], v118
  s_nop 4
  v_cvt_pk_bf16_f32 v62, v72, v73
  v_cvt_pk_bf16_f32 v63, v74, v75
  s_nop 1
  v_mfma_f32_16x16x32_bf16 v[84:87], v[12:15], v[60:63], v[84:87]
  v_smfmac_f32_16x16x64_bf16 v[88:91], v[60:63], v[16:23], v118
  v_smfmac_f32_16x16x64_bf16 v[92:95], v[60:63], v[52:59], v118
  s_nop 1
  v_permlane32_swap_b32 v84, v86
  v_permlane32_swap_b32 v85, v87
  s_nop 0
  v_add_f32 v88, v88, v89
  v_add_f32_dpp v84, v86, v84 quad_perm:[1,0,3,2] row_mask:0xf bank_mask:0xf
  v_add_f32_dpp v85, v87, v85 quad_perm:[1,0,3,2] row_mask:0xf bank_mask:0xf
  v_add_f32 v89, v90, v91
  ds_write2_b32 v113, v84, v85 offset0:0 offset1:4
  ds_write2_b32 v112, v88, v89 offset0:0 offset1:128
  v_add_f32 v90, v92, v93
  v_add_f32 v91, v94, v95
  ds_write2_b32 v112, v90, v91 offset0:64 offset1:192
  v_cmp_u_f32 vcc, v88, v89
  s_cbranch_vccnz cA_sc1_retry
cA_sc1_cont:
  s_waitcnt lgkmcnt(0)
  s_barrier
  ds_read_b128 v[36:39], v114
  ds_read_b128 v[44:47], v115
  s_waitcnt lgkmcnt(0)
  v_add_f32 v36, v36, v38
  v_add_f32 v37, v37, v39
  v_add_f32 v44, v44, v45
  v_add_f32 v46, v46, v47
  v_add_f32 v44, v44, v46
  v_add_f32 v36, v36, v37
  v_exp_f32 v49, v44
  v_exp_f32 v48, v36
  v_add_f32 v50, abs(v36), abs(v44)
  v_fma_f32 v39, v49, s37, v48
  v_cmp_ngt_f32 vcc, s56, v50
  v_cndmask_b32 v41, v48, v49, s[38:39]
  v_add_f32_dpp v39, v39, v39 quad_perm:[1,0,3,2] row_mask:0xf bank_mask:0xf
  v_cndmask_b32 v40, v49, v48, s[38:39]
  v_mov_b32_dpp v46, v41 quad_perm:[1,0,3,2] row_mask:0xf bank_mask:0xf
  v_add_f32_dpp v39, v39, v39 quad_perm:[2,3,0,1] row_mask:0xf bank_mask:0xf
  v_cndmask_b32 v42, v46, v40, s[38:39]
  v_cndmask_b32 v43, v40, v46, s[38:39]
  v_add_f32_dpp v39, v39, v39 row_half_mirror row_mask:0xf bank_mask:0xf
  s_cbranch_vccnz cA_sc1_slow
  s_nop 0
  v_add_f32_dpp v47, v39, v39 row_mirror row_mask:0xf bank_mask:0xf
  v_add_f32_dpp v39, v39, v39 row_mirror row_mask:0xf bank_mask:0xf
  s_nop 1
  v_permlane16_swap_b32 v39, v47
  v_add_f32 v39, v39, v47
  v_rcp_f32 v39, v39
  s_mov_b64 exec, s[28:29]
  v_mul_f32 v42, v42, v39
  v_mul_f32 v43, v43, v39
  v_cvt_pk_bf16_f32 v42, v42, v43
cA_sc1_pst:
  buffer_store_dword v42, v1, s[8:11], s20 offen
  s_mov_b64 exec, -1
  s_barrier
  s_add_u32 s24, s24, 28672
  s_add_u32 s35, s35, 28672
  s_xor_b32 s25, s25, 28672
  s_add_u32 m0, s25, 7168
  s_add_u32 m0, s25, 11264
  s_add_u32 s22, s24, 4096
  buffer_load_dwordx4 v2, s[8:11], s22 offen offset:0 sc1 lds
  s_nop 5
  buffer_load_dwordx4 v2, s[8:11], s22 offen offset:1024 sc1 lds
  s_nop 5
  buffer_load_dwordx4 v2, s[8:11], s22 offen offset:2048 sc1 lds
  s_nop 5
  v_xor_b32 v116, 28672, v116
  v_add_u32 v117, s57, v117
  s_sub_u32 s57, 0, s57
  s_add_u32 s19, s19, 1
  s_mov_b32 s20, s21
  s_cmp_lt_u32 s19, 63
  s_cbranch_scc1 cA_sc1_loop
  s_branch cA_done
cA_sc1_slow:
  v_max_f32 v50, v36, v44
  s_nop 1
  v_max_f32_dpp v50, v50, v50 quad_perm:[1,0,3,2] row_mask:0xf bank_mask:0xf
  s_nop 1
  v_max_f32_dpp v50, v50, v50 quad_perm:[2,3,0,1] row_mask:0xf bank_mask:0xf
  s_nop 1
  v_max_f32_dpp v50, v50, v50 row_half_mirror row_mask:0xf bank_mask:0xf
  s_nop 1
  v_max_f32_dpp v50, v50, v50 row_mirror row_mask:0xf bank_mask:0xf
  v_mov_b32 v47, v50
  s_nop 1
  v_permlane16_swap_b32 v50, v47
  v_max_f32 v50, v50, v47
  v_sub_f32 v48, v36, v50
  v_sub_f32 v49, v44, v50
  v_exp_f32 v48, v48
  v_exp_f32 v49, v49
  s_add_u32 s31, s31, 0x100
  v_fma_f32 v39, v49, s37, v48
  v_cndmask_b32 v41, v48, v49, s[38:39]
  s_nop 0
  v_add_f32_dpp v39, v39, v39 quad_perm:[1,0,3,2] row_mask:0xf bank_mask:0xf
  v_cndmask_b32 v40, v49, v48, s[38:39]
  v_mov_b32_dpp v46, v41 quad_perm:[1,0,3,2] row_mask:0xf bank_mask:0xf
  v_add_f32_dpp v39, v39, v39 quad_perm:[2,3,0,1] row_mask:0xf bank_mask:0xf
  v_cndmask_b32 v42, v46, v40, s[38:39]
  v_cndmask_b32 v43, v40, v46, s[38:39]
  v_add_f32_dpp v39, v39, v39 row_half_mirror row_mask:0xf bank_mask:0xf
  s_nop 1
  v_add_f32_dpp v47, v39, v39 row_mirror row_mask:0xf bank_mask:0xf
  v_add_f32_dpp v39, v39, v39 row_mirror row_mask:0xf bank_mask:0xf
  s_nop 1
  v_permlane16_swap_b32 v39, v47
  v_add_f32 v39, v39, v47
  v_rcp_f32 v39, v39
  s_mov_b64 exec, s[28:29]
  v_mul_f32 v42, v42, v39
  v_mul_f32 v43, v43, v39
  v_cvt_pk_bf16_f32 v42, v42, v43
  v_min_u32 v42, -2, v42
  s_branch cA_sc1_pst
cA_sc1_retry:
  s_cmp_lg_u32 s62, 0
  s_cbranch_scc1 cA_sc1_cont
  s_waitcnt vmcnt(0) lgkmcnt(0)
cA_sc1_rv:
  buffer_load_dwordx4 v[8:11], v2, s[8:11], s20 offen offset:0 sc1
  buffer_load_dwordx4 v[12:15], v2, s[8:11], s20 offen offset:1024 sc1
  buffer_load_dwordx4 v[16:19], v2, s[8:11], s20 offen offset:2048 sc1
  buffer_load_dwordx4 v[20:23], v2, s[8:11], s20 offen offset:3072 sc1
  buffer_load_dwordx4 v[24:27], v2, s[8:11], s23 offen offset:0 sc1
  buffer_load_dwordx4 v[28:31], v2, s[8:11], s23 offen offset:1024 sc1
  buffer_load_dwordx4 v[32:35], v2, s[8:11], s23 offen offset:2048 sc1
  s_waitcnt vmcnt(0)
  v_max3_u32 v68, v8, v9, v10
  v_max3_u32 v68, v68, v11, v12
  v_max3_u32 v68, v68, v13, v14
  v_max3_u32 v68, v68, v15, v16
  v_max3_u32 v68, v68, v17, v18
  v_max3_u32 v68, v68, v19, v20
  v_max3_u32 v68, v68, v21, v22
  v_max3_u32 v68, v68, v23, v24
  v_max3_u32 v68, v68, v25, v26
  v_max3_u32 v68, v68, v27, v28
  v_max3_u32 v68, v68, v29, v30
  v_max3_u32 v68, v68, v31, v32
  v_max3_u32 v68, v68, v33, v34
  v_max_u32 v68, v68, v35
  v_cmp_eq_u32 vcc, -1, v68
  s_cbranch_vccz cA_sc1_rk
  s_add_u32 s30, s30, 1
  s_cmp_lt_u32 s30, 400000
  s_cbranch_scc1 cA_sc1_rv
  s_branch cA_abort
cA_sc1_rk:
  s_mov_b32 s62, 1
  v_mov_b32 v36, 0
  v_mov_b32 v37, 0
  v_mov_b32 v38, 0
  v_mov_b32 v39, 0
  v_mov_b32 v40, 0
  v_mov_b32 v41, 0
  v_mov_b32 v42, 0
  v_mov_b32 v43, 0
  v_mov_b32 v44, 0
  v_mov_b32 v45, 0
  v_mov_b32 v46, 0
  v_mov_b32 v47, 0
  v_mov_b32 v48, 0
  v_mov_b32 v49, 0
  v_mov_b32 v50, 0
  v_mov_b32 v51, 0
  v_mov_b32 v52, 0
  v_mov_b32 v53, 0
  v_mov_b32 v54, 0
  v_mov_b32 v55, 0
  v_mov_b32 v56, 0
  v_mov_b32 v57, 0
  v_mov_b32 v58, 0
  v_mov_b32 v59, 0
  v_mov_b32 v60, 0
  v_mov_b32 v61, 0
  v_mov_b32 v62, 0
  v_mov_b32 v63, 0
  v_mov_b32 v88, 0
  v_mov_b32 v89, 0
  v_mov_b32 v90, 0
  v_mov_b32 v91, 0
  v_mov_b32 v92, 0
  v_mov_b32 v93, 0
  v_mov_b32 v94, 0
  v_mov_b32 v95, 0
  v_mov_b32 v64, 0
  v_mov_b32 v65, 0
  s_add_u32 s31, s31, 1
  ds_read_b128 v[96:99], v117 offset:0
  ds_read_b128 v[100:103], v117 offset:1024
  ds_read_b128 v[104:107], v117 offset:14336
  ds_read_b128 v[108:111], v117 offset:15360
  v_smfmac_f32_16x16x64_bf16 v[36:39], v[8:11], a[0:7], v3
  v_smfmac_f32_16x16x64_bf16 v[40:43], v[8:11], a[56:63], v3
  v_smfmac_f32_16x16x64_bf16 v[44:47], v[8:11], a[112:119], v3
  v_smfmac_f32_16x16x64_bf16 v[48:51], v[8:11], a[168:175], v3
  v_smfmac_f32_16x16x64_bf16 v[52:55], v[8:11], a[224:231], v3
  v_smfmac_f32_16x16x64_bf16 v[56:59], v[8:11], v[144:151], v3
  v_smfmac_f32_16x16x64_bf16 v[60:63], v[8:11], v[200:207], v3
  v_smfmac_f32_16x16x64_bf16 v[36:39], v[12:15], a[8:15], v3
  v_smfmac_f32_16x16x64_bf16 v[40:43], v[12:15], a[64:71], v3
  v_smfmac_f32_16x16x64_bf16 v[44:47], v[12:15], a[120:127], v3
  v_smfmac_f32_16x16x64_bf16 v[48:51], v[12:15], a[176:183], v3
  v_smfmac_f32_16x16x64_bf16 v[52:55], v[12:15], a[232:239], v3
  v_smfmac_f32_16x16x64_bf16 v[56:59], v[12:15], v[152:159], v3
  v_smfmac_f32_16x16x64_bf16 v[60:63], v[12:15], v[208:215], v3
  v_smfmac_f32_16x16x64_bf16 v[36:39], v[16:19], a[16:23], v3
  v_smfmac_f32_16x16x64_bf16 v[40:43], v[16:19], a[72:79], v3
  v_smfmac_f32_16x16x64_bf16 v[44:47], v[16:19], a[128:135], v3
  v_smfmac_f32_16x16x64_bf16 v[48:51], v[16:19], a[184:191], v3
  v_smfmac_f32_16x16x64_bf16 v[52:55], v[16:19], a[240:247], v3
  v_smfmac_f32_16x16x64_bf16 v[56:59], v[16:19], v[160:167], v3
  v_smfmac_f32_16x16x64_bf16 v[60:63], v[16:19], v[216:223], v3
  v_smfmac_f32_16x16x64_bf16 v[36:39], v[20:23], a[24:31], v3
  v_smfmac_f32_16x16x64_bf16 v[40:43], v[20:23], a[80:87], v3
  v_smfmac_f32_16x16x64_bf16 v[44:47], v[20:23], a[136:143], v3
  v_smfmac_f32_16x16x64_bf16 v[48:51], v[20:23], a[192:199], v3
  v_smfmac_f32_16x16x64_bf16 v[52:55], v[20:23], a[248:255], v3
  v_smfmac_f32_16x16x64_bf16 v[56:59], v[20:23], v[168:175], v3
  v_smfmac_f32_16x16x64_bf16 v[60:63], v[20:23], v[224:231], v3
  s_xor_b32 s58, s25, 28672
  s_add_u32 s59, s24, 28672
  s_add_u32 m0, s58, 7168
  s_branch cA_sc1_ph2
.p2align 6

cA_sc2_loop:
  s_add_u32 s23, s20, 4096
  s_add_u32 s21, s20, 20480
  v_mov_b32 v48, 0
  v_mov_b32 v49, 0
  v_mov_b32 v50, 0
  v_mov_b32 v51, 0
  v_mov_b32 v52, 0
  v_mov_b32 v53, 0
  v_mov_b32 v54, 0
  v_mov_b32 v55, 0
  v_mov_b32 v56, 0
  v_mov_b32 v57, 0
  v_mov_b32 v58, 0
  v_mov_b32 v59, 0
  v_mov_b32 v60, 0
  v_mov_b32 v61, 0
  v_mov_b32 v62, 0
  v_mov_b32 v63, 0
  v_mov_b32 v88, 0
  v_mov_b32 v89, 0
  v_mov_b32 v90, 0
  v_mov_b32 v91, 0
  v_mov_b32 v92, 0
  v_mov_b32 v93, 0
  v_mov_b32 v94, 0
  v_mov_b32 v95, 0
  v_mov_b32 v66, 0
  v_mov_b32 v67, 0
  s_mov_b32 s30, 0
  s_mov_b32 s62, 0
  s_waitcnt vmcnt(0)
  s_barrier
cA_sc2_ld:
  buffer_load_dwordx4 v[8:11], v2, s[8:11], s20 offen offset:0
  v_mov_b32 v36, 0
  v_mov_b32 v37, 0
  v_mov_b32 v38, 0
  v_mov_b32 v39, 0
  buffer_load_dwordx4 v[12:15], v2, s[8:11], s20 offen offset:1024
  v_mov_b32 v40, 0
  v_mov_b32 v41, 0
  v_mov_b32 v42, 0
  v_mov_b32 v43, 0
  buffer_load_dwordx4 v[16:19], v2, s[8:11], s20 offen offset:2048
  v_mov_b32 v44, 0
  v_mov_b32 v45, 0
  v_mov_b32 v46, 0
  v_mov_b32 v47, 0
  ds_read_b128 v[96:99], v117 offset:0
  ds_read_b128 v[100:103], v117 offset:1024
  ds_read_b128 v[104:107], v117 offset:14336
  ds_read_b128 v[108:111], v117 offset:15360
  s_waitcnt vmcnt(2)
  v_smfmac_f32_16x16x64_bf16 v[36:39], v[8:11], a[0:7], v3
  v_smfmac_f32_16x16x64_bf16 v[40:43], v[8:11], a[56:63], v3
  buffer_load_dwordx4 v[20:23], v2, s[8:11], s20 offen offset:3072
  v_smfmac_f32_16x16x64_bf16 v[44:47], v[8:11], a[112:119], v3
  v_smfmac_f32_16x16x64_bf16 v[48:51], v[8:11], a[168:175], v3
  v_smfmac_f32_16x16x64_bf16 v[52:55], v[8:11], a[224:231], v3
  buffer_load_dwordx4 v[24:27], v2, s[8:11], s23 offen offset:0
  v_smfmac_f32_16x16x64_bf16 v[56:59], v[8:11], v[144:151], v3
  v_smfmac_f32_16x16x64_bf16 v[60:63], v[8:11], v[200:207], v3
  s_waitcnt vmcnt(3)
  v_smfmac_f32_16x16x64_bf16 v[36:39], v[12:15], a[8:15], v3
  v_smfmac_f32_16x16x64_bf16 v[40:43], v[12:15], a[64:71], v3
  buffer_load_dwordx4 v[28:31], v2, s[8:11], s23 offen offset:1024
  v_smfmac_f32_16x16x64_bf16 v[44:47], v[12:15], a[120:127], v3
  v_smfmac_f32_16x16x64_bf16 v[48:51], v[12:15], a[176:183], v3
  v_smfmac_f32_16x16x64_bf16 v[52:55], v[12:15], a[232:239], v3
  buffer_load_dwordx4 v[32:35], v2, s[8:11], s23 offen offset:2048
  v_smfmac_f32_16x16x64_bf16 v[56:59], v[12:15], v[152:159], v3
  v_smfmac_f32_16x16x64_bf16 v[60:63], v[12:15], v[208:215], v3
  s_waitcnt vmcnt(4)
  v_smfmac_f32_16x16x64_bf16 v[36:39], v[16:19], a[16:23], v3
  v_smfmac_f32_16x16x64_bf16 v[40:43], v[16:19], a[72:79], v3
  s_xor_b32 s58, s25, 28672
  s_add_u32 s59, s24, 28672
  s_add_u32 m0, s58, 14336
  v_smfmac_f32_16x16x64_bf16 v[44:47], v[16:19], a[128:135], v3
  buffer_load_dwordx4 v2, s[8:11], s59 offen offset:0 sc1 lds
  v_smfmac_f32_16x16x64_bf16 v[48:51], v[16:19], a[184:191], v3
  v_smfmac_f32_16x16x64_bf16 v[52:55], v[16:19], a[240:247], v3
  v_smfmac_f32_16x16x64_bf16 v[56:59], v[16:19], v[160:167], v3
  v_smfmac_f32_16x16x64_bf16 v[60:63], v[16:19], v[216:223], v3
  buffer_load_dwordx4 v2, s[8:11], s59 offen offset:1024 sc1 lds
  s_waitcnt vmcnt(5)
  v_smfmac_f32_16x16x64_bf16 v[36:39], v[20:23], a[24:31], v3
  v_smfmac_f32_16x16x64_bf16 v[40:43], v[20:23], a[80:87], v3
  v_smfmac_f32_16x16x64_bf16 v[44:47], v[20:23], a[136:143], v3
  v_smfmac_f32_16x16x64_bf16 v[48:51], v[20:23], a[192:199], v3
  buffer_load_dwordx4 v2, s[8:11], s59 offen offset:2048 sc1 lds
  v_smfmac_f32_16x16x64_bf16 v[52:55], v[20:23], a[248:255], v3
  v_smfmac_f32_16x16x64_bf16 v[56:59], v[20:23], v[168:175], v3
  v_smfmac_f32_16x16x64_bf16 v[60:63], v[20:23], v[224:231], v3
  s_waitcnt vmcnt(3)
cA_sc2_ph2:
  v_smfmac_f32_16x16x64_bf16 v[60:63], v[24:27], v[232:239], v3
  buffer_load_dwordx4 v2, s[8:11], s59 offen offset:3072 sc1 lds
  ds_read_b128 v[8:11], v116 offset:4096
  ds_read_b128 v[12:15], v116 offset:5120
  v_smfmac_f32_16x16x64_bf16 v[60:63], v[28:31], v[240:247], v3
  buffer_load_dword v119, v0, s[8:11], s24 offen sc1
  v_smfmac_f32_16x16x64_bf16 v[60:63], v[32:35], v[248:255], v3
  v_mov_b32 v80, v28
  v_smfmac_f32_16x16x64_bf16 v[52:55], v[24:27], v[120:127], v3
  v_mov_b32 v81, v29
  v_smfmac_f32_16x16x64_bf16 v[52:55], v[28:31], v[128:135], v3
  v_mov_b32 v82, v34
  v_smfmac_f32_16x16x64_bf16 v[52:55], v[32:35], v[136:143], v3
  v_cvt_pk_bf16_f32 v64, v60, v61
  v_smfmac_f32_16x16x64_bf16 v[56:59], v[24:27], v[176:183], v3
  v_cvt_pk_bf16_f32 v65, v62, v63
  v_smfmac_f32_16x16x64_bf16 v[56:59], v[28:31], v[184:191], v3
  v_mov_b32 v83, v35
  v_mfma_f32_16x16x32_bf16 v[68:71], v[64:67], v[4:7], 0
  v_smfmac_f32_16x16x64_bf16 v[56:59], v[32:35], v[192:199], v3
  v_cvt_pk_bf16_f32 v64, v52, v53
  v_smfmac_f32_16x16x64_bf16 v[36:39], v[24:27], a[32:39], v3
  v_cvt_pk_bf16_f32 v65, v54, v55
  v_smfmac_f32_16x16x64_bf16 v[36:39], v[28:31], a[40:47], v3
  v_cvt_pk_bf16_f32 v78, v68, v69
  v_smfmac_f32_16x16x64_bf16 v[36:39], v[32:35], a[48:55], v3
  v_cvt_pk_bf16_f32 v79, v70, v71
  v_cvt_pk_bf16_f32 v66, v56, v57
  v_smfmac_f32_16x16x64_bf16 v[40:43], v[24:27], a[88:95], v3
  v_cvt_pk_bf16_f32 v67, v58, v59
  v_smfmac_f32_16x16x64_bf16 v[40:43], v[28:31], a[96:103], v3
  v_mfma_f32_16x16x32_bf16 v[72:75], v[64:67], v[4:7], 0
  ds_read_b128 v[52:55], v116 offset:18432
  ds_read_b128 v[56:59], v116 offset:19456
  v_smfmac_f32_16x16x64_bf16 v[40:43], v[32:35], a[104:111], v3
  v_cvt_pk_bf16_f32 v64, v36, v37
  v_smfmac_f32_16x16x64_bf16 v[44:47], v[24:27], a[144:151], v3
  v_cvt_pk_bf16_f32 v65, v38, v39
  v_smfmac_f32_16x16x64_bf16 v[44:47], v[28:31], a[152:159], v3
  v_cvt_pk_bf16_f32 v76, v72, v73
  v_smfmac_f32_16x16x64_bf16 v[44:47], v[32:35], a[160:167], v3
  v_cvt_pk_bf16_f32 v77, v74, v75
  v_cvt_pk_bf16_f32 v66, v40, v41
  v_smfmac_f32_16x16x64_bf16 v[48:51], v[24:27], a[200:207], v3
  v_cvt_pk_bf16_f32 v67, v42, v43
  v_smfmac_f32_16x16x64_bf16 v[48:51], v[28:31], a[208:215], v3
  v_mfma_f32_16x16x32_bf16 v[68:71], v[64:67], v[4:7], 0
  v_smfmac_f32_16x16x64_bf16 v[48:51], v[32:35], a[216:223], v3
  v_cvt_pk_bf16_f32 v64, v44, v45
  v_mfma_f32_16x16x32_bf16 v[84:87], v[80:83], v[76:79], 0
  v_cvt_pk_bf16_f32 v65, v46, v47
  s_waitcnt lgkmcnt(0)
  v_smfmac_f32_16x16x64_bf16 v[88:91], v[76:79], v[96:103], v118
  v_cvt_pk_bf16_f32 v60, v68, v69
  v_cvt_pk_bf16_f32 v61, v70, v71
  v_cvt_pk_bf16_f32 v66, v48, v49
  v_cvt_pk_bf16_f32 v67, v50, v51
  s_nop 1
  v_mfma_f32_16x16x32_bf16 v[72:75], v[64:67], v[4:7], 0
  v_smfmac_f32_16x16x64_bf16 v[92:95], v[76:79], v[104:111], v118
  s_nop 4
  v_cvt_pk_bf16_f32 v62, v72, v73
  v_cvt_pk_bf16_f32 v63, v74, v75
  s_nop 1
  v_mfma_f32_16x16x32_bf16 v[84:87], v[16:19], v[60:63], v[84:87]
  v_smfmac_f32_16x16x64_bf16 v[88:91], v[60:63], v[8:15], v118
  v_smfmac_f32_16x16x64_bf16 v[92:95], v[60:63], v[52:59], v118
  s_nop 1
  v_permlane32_swap_b32 v84, v86
  v_permlane32_swap_b32 v85, v87
  s_nop 0
  v_add_f32 v88, v88, v89
  v_add_f32_dpp v84, v86, v84 quad_perm:[1,0,3,2] row_mask:0xf bank_mask:0xf
  v_add_f32_dpp v85, v87, v85 quad_perm:[1,0,3,2] row_mask:0xf bank_mask:0xf
  v_add_f32 v89, v90, v91
  ds_write2_b32 v113, v84, v85 offset0:0 offset1:4
  ds_write2_b32 v112, v88, v89 offset0:0 offset1:128
  v_add_f32 v90, v92, v93
  v_add_f32 v91, v94, v95
  ds_write2_b32 v112, v90, v91 offset0:64 offset1:192
  v_cmp_u_f32 vcc, v88, v89
  s_cbranch_vccnz cA_sc2_retry
cA_sc2_cont:
  s_waitcnt lgkmcnt(0)
  s_barrier
  ds_read_b128 v[36:39], v114
  ds_read_b128 v[44:47], v115
  v_lshl_add_u32 v56, v2, 3, s36
  s_waitcnt lgkmcnt(0)
  v_add_f32 v36, v36, v38
  v_add_f32 v37, v37, v39
  v_add_f32 v44, v44, v45
  s_mov_b64 exec, 15
  buffer_store_dword v2, v56, s[8:11], s20 offen
  s_mov_b64 exec, -1
  v_add_f32 v46, v46, v47
  v_add_f32 v44, v44, v46
  v_add_f32 v36, v36, v37
  v_exp_f32 v49, v44
  v_exp_f32 v48, v36
  v_add_f32 v50, abs(v36), abs(v44)
  v_fma_f32 v39, v49, s37, v48
  v_cmp_ngt_f32 vcc, s56, v50
  v_cndmask_b32 v41, v48, v49, s[38:39]
  v_add_f32_dpp v39, v39, v39 quad_perm:[1,0,3,2] row_mask:0xf bank_mask:0xf
  v_cndmask_b32 v40, v49, v48, s[38:39]
  v_mov_b32_dpp v46, v41 quad_perm:[1,0,3,2] row_mask:0xf bank_mask:0xf
  v_add_f32_dpp v39, v39, v39 quad_perm:[2,3,0,1] row_mask:0xf bank_mask:0xf
  v_cndmask_b32 v42, v46, v40, s[38:39]
  v_cndmask_b32 v43, v40, v46, s[38:39]
  v_add_f32_dpp v39, v39, v39 row_half_mirror row_mask:0xf bank_mask:0xf
  s_cbranch_vccnz cA_sc2_slow
  s_nop 0
  v_add_f32_dpp v47, v39, v39 row_mirror row_mask:0xf bank_mask:0xf
  v_add_f32_dpp v39, v39, v39 row_mirror row_mask:0xf bank_mask:0xf
  s_nop 1
  v_permlane16_swap_b32 v39, v47
  v_add_f32 v39, v39, v47
  v_rcp_f32 v39, v39
  s_mov_b64 exec, s[28:29]
  v_mul_f32 v42, v42, v39
  v_mul_f32 v43, v43, v39
  v_cvt_pk_bf16_f32 v42, v42, v43
cA_sc2_pst:
  buffer_store_dword v42, v1, s[8:11], s20 offen
  s_mov_b64 exec, -1
  s_barrier
  s_add_u32 s24, s24, 28672
  s_add_u32 s35, s35, 28672
  s_xor_b32 s25, s25, 28672
  s_add_u32 m0, s25, 14336
  s_add_u32 m0, s25, 18432
  s_add_u32 s22, s24, 4096
  buffer_load_dwordx4 v2, s[8:11], s22 offen offset:0 sc1 lds
  s_nop 5
  buffer_load_dwordx4 v2, s[8:11], s22 offen offset:1024 sc1 lds
  s_nop 5
  buffer_load_dwordx4 v2, s[8:11], s22 offen offset:2048 sc1 lds
  s_nop 5
  v_xor_b32 v116, 28672, v116
  v_add_u32 v117, s57, v117
  s_sub_u32 s57, 0, s57
  s_add_u32 s19, s19, 1
  s_mov_b32 s20, s21
  s_cmp_lt_u32 s19, 63
  s_cbranch_scc1 cA_sc2_loop
  s_branch cA_done
cA_sc2_slow:
  v_max_f32 v50, v36, v44
  s_nop 1
  v_max_f32_dpp v50, v50, v50 quad_perm:[1,0,3,2] row_mask:0xf bank_mask:0xf
  s_nop 1
  v_max_f32_dpp v50, v50, v50 quad_perm:[2,3,0,1] row_mask:0xf bank_mask:0xf
  s_nop 1
  v_max_f32_dpp v50, v50, v50 row_half_mirror row_mask:0xf bank_mask:0xf
  s_nop 1
  v_max_f32_dpp v50, v50, v50 row_mirror row_mask:0xf bank_mask:0xf
  v_mov_b32 v47, v50
  s_nop 1
  v_permlane16_swap_b32 v50, v47
  v_max_f32 v50, v50, v47
  v_sub_f32 v48, v36, v50
  v_sub_f32 v49, v44, v50
  v_exp_f32 v48, v48
  v_exp_f32 v49, v49
  s_add_u32 s31, s31, 0x100
  v_fma_f32 v39, v49, s37, v48
  v_cndmask_b32 v41, v48, v49, s[38:39]
  s_nop 0
  v_add_f32_dpp v39, v39, v39 quad_perm:[1,0,3,2] row_mask:0xf bank_mask:0xf
  v_cndmask_b32 v40, v49, v48, s[38:39]
  v_mov_b32_dpp v46, v41 quad_perm:[1,0,3,2] row_mask:0xf bank_mask:0xf
  v_add_f32_dpp v39, v39, v39 quad_perm:[2,3,0,1] row_mask:0xf bank_mask:0xf
  v_cndmask_b32 v42, v46, v40, s[38:39]
  v_cndmask_b32 v43, v40, v46, s[38:39]
  v_add_f32_dpp v39, v39, v39 row_half_mirror row_mask:0xf bank_mask:0xf
  s_nop 1
  v_add_f32_dpp v47, v39, v39 row_mirror row_mask:0xf bank_mask:0xf
  v_add_f32_dpp v39, v39, v39 row_mirror row_mask:0xf bank_mask:0xf
  s_nop 1
  v_permlane16_swap_b32 v39, v47
  v_add_f32 v39, v39, v47
  v_rcp_f32 v39, v39
  s_mov_b64 exec, s[28:29]
  v_mul_f32 v42, v42, v39
  v_mul_f32 v43, v43, v39
  v_cvt_pk_bf16_f32 v42, v42, v43
  v_min_u32 v42, -2, v42
  s_branch cA_sc2_pst
cA_sc2_retry:
  s_cmp_lg_u32 s62, 0
  s_cbranch_scc1 cA_sc2_cont
  s_waitcnt vmcnt(0) lgkmcnt(0)
cA_sc2_rv:
  buffer_load_dwordx4 v[8:11], v2, s[8:11], s20 offen offset:0 sc1
  buffer_load_dwordx4 v[12:15], v2, s[8:11], s20 offen offset:1024 sc1
  buffer_load_dwordx4 v[16:19], v2, s[8:11], s20 offen offset:2048 sc1
  buffer_load_dwordx4 v[20:23], v2, s[8:11], s20 offen offset:3072 sc1
  buffer_load_dwordx4 v[24:27], v2, s[8:11], s23 offen offset:0 sc1
  buffer_load_dwordx4 v[28:31], v2, s[8:11], s23 offen offset:1024 sc1
  buffer_load_dwordx4 v[32:35], v2, s[8:11], s23 offen offset:2048 sc1
  s_waitcnt vmcnt(0)
  v_max3_u32 v68, v8, v9, v10
  v_max3_u32 v68, v68, v11, v12
  v_max3_u32 v68, v68, v13, v14
  v_max3_u32 v68, v68, v15, v16
  v_max3_u32 v68, v68, v17, v18
  v_max3_u32 v68, v68, v19, v20
  v_max3_u32 v68, v68, v21, v22
  v_max3_u32 v68, v68, v23, v24
  v_max3_u32 v68, v68, v25, v26
  v_max3_u32 v68, v68, v27, v28
  v_max3_u32 v68, v68, v29, v30
  v_max3_u32 v68, v68, v31, v32
  v_max3_u32 v68, v68, v33, v34
  v_max_u32 v68, v68, v35
  v_cmp_eq_u32 vcc, -1, v68
  s_cbranch_vccz cA_sc2_rk
  s_add_u32 s30, s30, 1
  s_cmp_lt_u32 s30, 400000
  s_cbranch_scc1 cA_sc2_rv
  s_branch cA_abort
cA_sc2_rk:
  s_mov_b32 s62, 1
  v_mov_b32 v36, 0
  v_mov_b32 v37, 0
  v_mov_b32 v38, 0
  v_mov_b32 v39, 0
  v_mov_b32 v40, 0
  v_mov_b32 v41, 0
  v_mov_b32 v42, 0
  v_mov_b32 v43, 0
  v_mov_b32 v44, 0
  v_mov_b32 v45, 0
  v_mov_b32 v46, 0
  v_mov_b32 v47, 0
  v_mov_b32 v48, 0
  v_mov_b32 v49, 0
  v_mov_b32 v50, 0
  v_mov_b32 v51, 0
  v_mov_b32 v52, 0
  v_mov_b32 v53, 0
  v_mov_b32 v54, 0
  v_mov_b32 v55, 0
  v_mov_b32 v56, 0
  v_mov_b32 v57, 0
  v_mov_b32 v58, 0
  v_mov_b32 v59, 0
  v_mov_b32 v60, 0
  v_mov_b32 v61, 0
  v_mov_b32 v62, 0
  v_mov_b32 v63, 0
  v_mov_b32 v88, 0
  v_mov_b32 v89, 0
  v_mov_b32 v90, 0
  v_mov_b32 v91, 0
  v_mov_b32 v92, 0
  v_mov_b32 v93, 0
  v_mov_b32 v94, 0
  v_mov_b32 v95, 0
  v_mov_b32 v66, 0
  v_mov_b32 v67, 0
  s_add_u32 s31, s31, 1
  ds_read_b128 v[96:99], v117 offset:0
  ds_read_b128 v[100:103], v117 offset:1024
  ds_read_b128 v[104:107], v117 offset:14336
  ds_read_b128 v[108:111], v117 offset:15360
  v_smfmac_f32_16x16x64_bf16 v[36:39], v[8:11], a[0:7], v3
  v_smfmac_f32_16x16x64_bf16 v[40:43], v[8:11], a[56:63], v3
  v_smfmac_f32_16x16x64_bf16 v[44:47], v[8:11], a[112:119], v3
  v_smfmac_f32_16x16x64_bf16 v[48:51], v[8:11], a[168:175], v3
  v_smfmac_f32_16x16x64_bf16 v[52:55], v[8:11], a[224:231], v3
  v_smfmac_f32_16x16x64_bf16 v[56:59], v[8:11], v[144:151], v3
  v_smfmac_f32_16x16x64_bf16 v[60:63], v[8:11], v[200:207], v3
  v_smfmac_f32_16x16x64_bf16 v[36:39], v[12:15], a[8:15], v3
  v_smfmac_f32_16x16x64_bf16 v[40:43], v[12:15], a[64:71], v3
  v_smfmac_f32_16x16x64_bf16 v[44:47], v[12:15], a[120:127], v3
  v_smfmac_f32_16x16x64_bf16 v[48:51], v[12:15], a[176:183], v3
  v_smfmac_f32_16x16x64_bf16 v[52:55], v[12:15], a[232:239], v3
  v_smfmac_f32_16x16x64_bf16 v[56:59], v[12:15], v[152:159], v3
  v_smfmac_f32_16x16x64_bf16 v[60:63], v[12:15], v[208:215], v3
  v_smfmac_f32_16x16x64_bf16 v[36:39], v[16:19], a[16:23], v3
  v_smfmac_f32_16x16x64_bf16 v[40:43], v[16:19], a[72:79], v3
  v_smfmac_f32_16x16x64_bf16 v[44:47], v[16:19], a[128:135], v3
  v_smfmac_f32_16x16x64_bf16 v[48:51], v[16:19], a[184:191], v3
  v_smfmac_f32_16x16x64_bf16 v[52:55], v[16:19], a[240:247], v3
  v_smfmac_f32_16x16x64_bf16 v[56:59], v[16:19], v[160:167], v3
  v_smfmac_f32_16x16x64_bf16 v[60:63], v[16:19], v[216:223], v3
  v_smfmac_f32_16x16x64_bf16 v[36:39], v[20:23], a[24:31], v3
  v_smfmac_f32_16x16x64_bf16 v[40:43], v[20:23], a[80:87], v3
  v_smfmac_f32_16x16x64_bf16 v[44:47], v[20:23], a[136:143], v3
  v_smfmac_f32_16x16x64_bf16 v[48:51], v[20:23], a[192:199], v3
  v_smfmac_f32_16x16x64_bf16 v[52:55], v[20:23], a[248:255], v3
  v_smfmac_f32_16x16x64_bf16 v[56:59], v[20:23], v[168:175], v3
  v_smfmac_f32_16x16x64_bf16 v[60:63], v[20:23], v[224:231], v3
  s_xor_b32 s58, s25, 28672
  s_add_u32 s59, s24, 28672
  s_add_u32 m0, s58, 14336
  s_branch cA_sc2_ph2
.p2align 6

cA_sc3_loop:
  s_add_u32 s23, s20, 4096
  s_add_u32 s21, s20, 20480
  v_mov_b32 v48, 0
  v_mov_b32 v49, 0
  v_mov_b32 v50, 0
  v_mov_b32 v51, 0
  v_mov_b32 v52, 0
  v_mov_b32 v53, 0
  v_mov_b32 v54, 0
  v_mov_b32 v55, 0
  v_mov_b32 v56, 0
  v_mov_b32 v57, 0
  v_mov_b32 v58, 0
  v_mov_b32 v59, 0
  v_mov_b32 v60, 0
  v_mov_b32 v61, 0
  v_mov_b32 v62, 0
  v_mov_b32 v63, 0
  v_mov_b32 v88, 0
  v_mov_b32 v89, 0
  v_mov_b32 v90, 0
  v_mov_b32 v91, 0
  v_mov_b32 v92, 0
  v_mov_b32 v93, 0
  v_mov_b32 v94, 0
  v_mov_b32 v95, 0
  v_mov_b32 v64, 0
  v_mov_b32 v65, 0
  s_mov_b32 s30, 0
  s_mov_b32 s62, 0
  s_waitcnt vmcnt(0)
  s_barrier
cA_sc3_ld:
  buffer_load_dwordx4 v[8:11], v2, s[8:11], s20 offen offset:0
  v_mov_b32 v36, 0
  v_mov_b32 v37, 0
  v_mov_b32 v38, 0
  v_mov_b32 v39, 0
  buffer_load_dwordx4 v[12:15], v2, s[8:11], s20 offen offset:1024
  v_mov_b32 v40, 0
  v_mov_b32 v41, 0
  v_mov_b32 v42, 0
  v_mov_b32 v43, 0
  buffer_load_dwordx4 v[16:19], v2, s[8:11], s20 offen offset:2048
  v_mov_b32 v44, 0
  v_mov_b32 v45, 0
  v_mov_b32 v46, 0
  v_mov_b32 v47, 0
  ds_read_b128 v[96:99], v117 offset:0
  ds_read_b128 v[100:103], v117 offset:1024
  ds_read_b128 v[104:107], v117 offset:14336
  ds_read_b128 v[108:111], v117 offset:15360
  s_waitcnt vmcnt(2)
  v_smfmac_f32_16x16x64_bf16 v[36:39], v[8:11], a[0:7], v3
  v_smfmac_f32_16x16x64_bf16 v[40:43], v[8:11], a[56:63], v3
  buffer_load_dwordx4 v[20:23], v2, s[8:11], s20 offen offset:3072
  v_smfmac_f32_16x16x64_bf16 v[44:47], v[8:11], a[112:119], v3
  v_smfmac_f32_16x16x64_bf16 v[48:51], v[8:11], a[168:175], v3
  v_smfmac_f32_16x16x64_bf16 v[52:55], v[8:11], a[224:231], v3
  buffer_load_dwordx4 v[24:27], v2, s[8:11], s23 offen offset:0
  v_smfmac_f32_16x16x64_bf16 v[56:59], v[8:11], v[144:151], v3
  v_smfmac_f32_16x16x64_bf16 v[60:63], v[8:11], v[200:207], v3
  s_waitcnt vmcnt(3)
  v_smfmac_f32_16x16x64_bf16 v[36:39], v[12:15], a[8:15], v3
  v_smfmac_f32_16x16x64_bf16 v[40:43], v[12:15], a[64:71], v3
  buffer_load_dwordx4 v[28:31], v2, s[8:11], s23 offen offset:1024
  v_smfmac_f32_16x16x64_bf16 v[44:47], v[12:15], a[120:127], v3
  v_smfmac_f32_16x16x64_bf16 v[48:51], v[12:15], a[176:183], v3
  v_smfmac_f32_16x16x64_bf16 v[52:55], v[12:15], a[232:239], v3
  buffer_load_dwordx4 v[32:35], v2, s[8:11], s23 offen offset:2048
  v_smfmac_f32_16x16x64_bf16 v[56:59], v[12:15], v[152:159], v3
  v_smfmac_f32_16x16x64_bf16 v[60:63], v[12:15], v[208:215], v3
  s_waitcnt vmcnt(4)
  v_smfmac_f32_16x16x64_bf16 v[36:39], v[16:19], a[16:23], v3
  v_smfmac_f32_16x16x64_bf16 v[40:43], v[16:19], a[72:79], v3
  v_smfmac_f32_16x16x64_bf16 v[44:47], v[16:19], a[128:135], v3
  s_xor_b32 s58, s25, 28672
  s_add_u32 s59, s24, 28672
  s_add_u32 m0, s58, 21504
  v_smfmac_f32_16x16x64_bf16 v[48:51], v[16:19], a[184:191], v3
  buffer_load_dwordx4 v2, s[8:11], s59 offen offset:0 sc1 lds
  v_smfmac_f32_16x16x64_bf16 v[52:55], v[16:19], a[240:247], v3
  v_smfmac_f32_16x16x64_bf16 v[56:59], v[16:19], v[160:167], v3
  v_smfmac_f32_16x16x64_bf16 v[60:63], v[16:19], v[216:223], v3
  s_waitcnt vmcnt(4)
  v_smfmac_f32_16x16x64_bf16 v[36:39], v[20:23], a[24:31], v3
  buffer_load_dwordx4 v2, s[8:11], s59 offen offset:1024 sc1 lds
  v_smfmac_f32_16x16x64_bf16 v[40:43], v[20:23], a[80:87], v3
  v_smfmac_f32_16x16x64_bf16 v[44:47], v[20:23], a[136:143], v3
  v_smfmac_f32_16x16x64_bf16 v[48:51], v[20:23], a[192:199], v3
  v_smfmac_f32_16x16x64_bf16 v[52:55], v[20:23], a[248:255], v3
  buffer_load_dwordx4 v2, s[8:11], s59 offen offset:2048 sc1 lds
  v_smfmac_f32_16x16x64_bf16 v[56:59], v[20:23], v[168:175], v3
  v_smfmac_f32_16x16x64_bf16 v[60:63], v[20:23], v[224:231], v3
  s_waitcnt vmcnt(3)
cA_sc3_ph2:
  v_smfmac_f32_16x16x64_bf16 v[60:63], v[24:27], v[232:239], v3
  ds_read_b128 v[8:11], v116 offset:6144
  ds_read_b128 v[12:15], v116 offset:7168
  v_smfmac_f32_16x16x64_bf16 v[60:63], v[28:31], v[240:247], v3
  buffer_load_dwordx4 v2, s[8:11], s59 offen offset:3072 sc1 lds
  v_smfmac_f32_16x16x64_bf16 v[60:63], v[32:35], v[248:255], v3
  v_mov_b32 v80, v30
  v_smfmac_f32_16x16x64_bf16 v[52:55], v[24:27], v[120:127], v3
  v_mov_b32 v81, v31
  v_smfmac_f32_16x16x64_bf16 v[52:55], v[28:31], v[128:135], v3
  v_mov_b32 v82, v34
  v_smfmac_f32_16x16x64_bf16 v[52:55], v[32:35], v[136:143], v3
  v_cvt_pk_bf16_f32 v66, v60, v61
  v_smfmac_f32_16x16x64_bf16 v[56:59], v[24:27], v[176:183], v3
  v_cvt_pk_bf16_f32 v67, v62, v63
  v_smfmac_f32_16x16x64_bf16 v[56:59], v[28:31], v[184:191], v3
  v_mov_b32 v83, v35
  v_mfma_f32_16x16x32_bf16 v[68:71], v[64:67], v[4:7], 0
  v_smfmac_f32_16x16x64_bf16 v[56:59], v[32:35], v[192:199], v3
  v_cvt_pk_bf16_f32 v64, v52, v53
  v_smfmac_f32_16x16x64_bf16 v[36:39], v[24:27], a[32:39], v3
  v_cvt_pk_bf16_f32 v65, v54, v55
  v_smfmac_f32_16x16x64_bf16 v[36:39], v[28:31], a[40:47], v3
  v_cvt_pk_bf16_f32 v78, v68, v69
  v_smfmac_f32_16x16x64_bf16 v[36:39], v[32:35], a[48:55], v3
  v_cvt_pk_bf16_f32 v79, v70, v71
  v_cvt_pk_bf16_f32 v66, v56, v57
  v_smfmac_f32_16x16x64_bf16 v[40:43], v[24:27], a[88:95], v3
  v_cvt_pk_bf16_f32 v67, v58, v59
  v_smfmac_f32_16x16x64_bf16 v[40:43], v[28:31], a[96:103], v3
  v_mfma_f32_16x16x32_bf16 v[72:75], v[64:67], v[4:7], 0
  ds_read_b128 v[52:55], v116 offset:20480
  ds_read_b128 v[56:59], v116 offset:21504
  v_smfmac_f32_16x16x64_bf16 v[40:43], v[32:35], a[104:111], v3
  v_cvt_pk_bf16_f32 v64, v36, v37
  v_smfmac_f32_16x16x64_bf16 v[44:47], v[24:27], a[144:151], v3
  v_cvt_pk_bf16_f32 v65, v38, v39
  v_smfmac_f32_16x16x64_bf16 v[44:47], v[28:31], a[152:159], v3
  v_cvt_pk_bf16_f32 v76, v72, v73
  v_smfmac_f32_16x16x64_bf16 v[44:47], v[32:35], a[160:167], v3
  v_cvt_pk_bf16_f32 v77, v74, v75
  v_cvt_pk_bf16_f32 v66, v40, v41
  v_smfmac_f32_16x16x64_bf16 v[48:51], v[24:27], a[200:207], v3
  v_cvt_pk_bf16_f32 v67, v42, v43
  v_smfmac_f32_16x16x64_bf16 v[48:51], v[28:31], a[208:215], v3
  v_mfma_f32_16x16x32_bf16 v[68:71], v[64:67], v[4:7], 0
  v_smfmac_f32_16x16x64_bf16 v[48:51], v[32:35], a[216:223], v3
  v_cvt_pk_bf16_f32 v64, v44, v45
  v_mfma_f32_16x16x32_bf16 v[84:87], v[80:83], v[76:79], 0
  v_cvt_pk_bf16_f32 v65, v46, v47
  s_waitcnt lgkmcnt(0)
  v_smfmac_f32_16x16x64_bf16 v[88:91], v[76:79], v[96:103], v118
  v_cvt_pk_bf16_f32 v60, v68, v69
  v_cvt_pk_bf16_f32 v61, v70, v71
  v_cvt_pk_bf16_f32 v66, v48, v49
  v_cvt_pk_bf16_f32 v67, v50, v51
  s_nop 1
  v_mfma_f32_16x16x32_bf16 v[72:75], v[64:67], v[4:7], 0
  v_smfmac_f32_16x16x64_bf16 v[92:95], v[76:79], v[104:111], v118
  s_nop 4
  v_cvt_pk_bf16_f32 v62, v72, v73
  v_cvt_pk_bf16_f32 v63, v74, v75
  s_nop 1
  v_mfma_f32_16x16x32_bf16 v[84:87], v[20:23], v[60:63], v[84:87]
  v_smfmac_f32_16x16x64_bf16 v[88:91], v[60:63], v[8:15], v118
  v_smfmac_f32_16x16x64_bf16 v[92:95], v[60:63], v[52:59], v118
  s_nop 1
  v_permlane32_swap_b32 v84, v86
  v_permlane32_swap_b32 v85, v87
  s_nop 0
  v_add_f32 v88, v88, v89
  v_add_f32_dpp v84, v86, v84 quad_perm:[1,0,3,2] row_mask:0xf bank_mask:0xf
  v_add_f32_dpp v85, v87, v85 quad_perm:[1,0,3,2] row_mask:0xf bank_mask:0xf
  v_add_f32 v89, v90, v91
  ds_write2_b32 v113, v84, v85 offset0:0 offset1:4
  ds_write2_b32 v112, v88, v89 offset0:0 offset1:128
  v_add_f32 v90, v92, v93
  v_add_f32 v91, v94, v95
  ds_write2_b32 v112, v90, v91 offset0:64 offset1:192
  v_cmp_u_f32 vcc, v88, v89
  s_cbranch_vccnz cA_sc3_retry
cA_sc3_cont:
  s_waitcnt lgkmcnt(0)
  s_barrier
  ds_read_b128 v[36:39], v114
  ds_read_b128 v[44:47], v115
  s_waitcnt lgkmcnt(0)
  v_add_f32 v36, v36, v38
  v_add_f32 v37, v37, v39
  v_add_f32 v44, v44, v45
  v_add_f32 v46, v46, v47
  v_add_f32 v44, v44, v46
  v_add_f32 v36, v36, v37
  v_exp_f32 v49, v44
  v_exp_f32 v48, v36
  v_add_f32 v50, abs(v36), abs(v44)
  v_fma_f32 v39, v49, s37, v48
  v_cmp_ngt_f32 vcc, s56, v50
  v_cndmask_b32 v41, v48, v49, s[38:39]
  v_add_f32_dpp v39, v39, v39 quad_perm:[1,0,3,2] row_mask:0xf bank_mask:0xf
  v_cndmask_b32 v40, v49, v48, s[38:39]
  v_mov_b32_dpp v46, v41 quad_perm:[1,0,3,2] row_mask:0xf bank_mask:0xf
  v_add_f32_dpp v39, v39, v39 quad_perm:[2,3,0,1] row_mask:0xf bank_mask:0xf
  v_cndmask_b32 v42, v46, v40, s[38:39]
  v_cndmask_b32 v43, v40, v46, s[38:39]
  v_add_f32_dpp v39, v39, v39 row_half_mirror row_mask:0xf bank_mask:0xf
  s_cbranch_vccnz cA_sc3_slow
  s_nop 0
  v_add_f32_dpp v47, v39, v39 row_mirror row_mask:0xf bank_mask:0xf
  v_add_f32_dpp v39, v39, v39 row_mirror row_mask:0xf bank_mask:0xf
  s_nop 1
  v_permlane16_swap_b32 v39, v47
  v_add_f32 v39, v39, v47
  v_rcp_f32 v39, v39
  s_mov_b64 exec, s[28:29]
  v_mul_f32 v42, v42, v39
  v_mul_f32 v43, v43, v39
  v_cvt_pk_bf16_f32 v42, v42, v43
cA_sc3_pst:
  buffer_store_dword v42, v1, s[8:11], s20 offen
  s_mov_b64 exec, -1
  s_barrier
  s_add_u32 s24, s24, 28672
  s_add_u32 s35, s35, 28672
  s_xor_b32 s25, s25, 28672
  s_add_u32 m0, s25, 21504
  s_add_u32 m0, s25, 25600
  s_add_u32 s22, s24, 4096
  buffer_load_dwordx4 v2, s[8:11], s22 offen offset:0 sc1 lds
  s_nop 5
  buffer_load_dwordx4 v2, s[8:11], s22 offen offset:1024 sc1 lds
  s_nop 5
  buffer_load_dwordx4 v2, s[8:11], s22 offen offset:2048 sc1 lds
  s_nop 5
  v_xor_b32 v116, 28672, v116
  v_add_u32 v117, s57, v117
  s_sub_u32 s57, 0, s57
  s_add_u32 s19, s19, 1
  s_mov_b32 s20, s21
  s_cmp_lt_u32 s19, 63
  s_cbranch_scc1 cA_sc3_loop
  s_branch cA_done
cA_sc3_slow:
  v_max_f32 v50, v36, v44
  s_nop 1
  v_max_f32_dpp v50, v50, v50 quad_perm:[1,0,3,2] row_mask:0xf bank_mask:0xf
  s_nop 1
  v_max_f32_dpp v50, v50, v50 quad_perm:[2,3,0,1] row_mask:0xf bank_mask:0xf
  s_nop 1
  v_max_f32_dpp v50, v50, v50 row_half_mirror row_mask:0xf bank_mask:0xf
  s_nop 1
  v_max_f32_dpp v50, v50, v50 row_mirror row_mask:0xf bank_mask:0xf
  v_mov_b32 v47, v50
  s_nop 1
  v_permlane16_swap_b32 v50, v47
  v_max_f32 v50, v50, v47
  v_sub_f32 v48, v36, v50
  v_sub_f32 v49, v44, v50
  v_exp_f32 v48, v48
  v_exp_f32 v49, v49
  s_add_u32 s31, s31, 0x100
  v_fma_f32 v39, v49, s37, v48
  v_cndmask_b32 v41, v48, v49, s[38:39]
  s_nop 0
  v_add_f32_dpp v39, v39, v39 quad_perm:[1,0,3,2] row_mask:0xf bank_mask:0xf
  v_cndmask_b32 v40, v49, v48, s[38:39]
  v_mov_b32_dpp v46, v41 quad_perm:[1,0,3,2] row_mask:0xf bank_mask:0xf
  v_add_f32_dpp v39, v39, v39 quad_perm:[2,3,0,1] row_mask:0xf bank_mask:0xf
  v_cndmask_b32 v42, v46, v40, s[38:39]
  v_cndmask_b32 v43, v40, v46, s[38:39]
  v_add_f32_dpp v39, v39, v39 row_half_mirror row_mask:0xf bank_mask:0xf
  s_nop 1
  v_add_f32_dpp v47, v39, v39 row_mirror row_mask:0xf bank_mask:0xf
  v_add_f32_dpp v39, v39, v39 row_mirror row_mask:0xf bank_mask:0xf
  s_nop 1
  v_permlane16_swap_b32 v39, v47
  v_add_f32 v39, v39, v47
  v_rcp_f32 v39, v39
  s_mov_b64 exec, s[28:29]
  v_mul_f32 v42, v42, v39
  v_mul_f32 v43, v43, v39
  v_cvt_pk_bf16_f32 v42, v42, v43
  v_min_u32 v42, -2, v42
  s_branch cA_sc3_pst
cA_sc3_retry:
  s_cmp_lg_u32 s62, 0
  s_cbranch_scc1 cA_sc3_cont
  s_waitcnt vmcnt(0) lgkmcnt(0)
cA_sc3_rv:
  buffer_load_dwordx4 v[8:11], v2, s[8:11], s20 offen offset:0 sc1
  buffer_load_dwordx4 v[12:15], v2, s[8:11], s20 offen offset:1024 sc1
  buffer_load_dwordx4 v[16:19], v2, s[8:11], s20 offen offset:2048 sc1
  buffer_load_dwordx4 v[20:23], v2, s[8:11], s20 offen offset:3072 sc1
  buffer_load_dwordx4 v[24:27], v2, s[8:11], s23 offen offset:0 sc1
  buffer_load_dwordx4 v[28:31], v2, s[8:11], s23 offen offset:1024 sc1
  buffer_load_dwordx4 v[32:35], v2, s[8:11], s23 offen offset:2048 sc1
  s_waitcnt vmcnt(0)
  v_max3_u32 v68, v8, v9, v10
  v_max3_u32 v68, v68, v11, v12
  v_max3_u32 v68, v68, v13, v14
  v_max3_u32 v68, v68, v15, v16
  v_max3_u32 v68, v68, v17, v18
  v_max3_u32 v68, v68, v19, v20
  v_max3_u32 v68, v68, v21, v22
  v_max3_u32 v68, v68, v23, v24
  v_max3_u32 v68, v68, v25, v26
  v_max3_u32 v68, v68, v27, v28
  v_max3_u32 v68, v68, v29, v30
  v_max3_u32 v68, v68, v31, v32
  v_max3_u32 v68, v68, v33, v34
  v_max_u32 v68, v68, v35
  v_cmp_eq_u32 vcc, -1, v68
  s_cbranch_vccz cA_sc3_rk
  s_add_u32 s30, s30, 1
  s_cmp_lt_u32 s30, 400000
  s_cbranch_scc1 cA_sc3_rv
  s_branch cA_abort
cA_sc3_rk:
  s_mov_b32 s62, 1
  v_mov_b32 v36, 0
  v_mov_b32 v37, 0
  v_mov_b32 v38, 0
  v_mov_b32 v39, 0
  v_mov_b32 v40, 0
  v_mov_b32 v41, 0
  v_mov_b32 v42, 0
  v_mov_b32 v43, 0
  v_mov_b32 v44, 0
  v_mov_b32 v45, 0
  v_mov_b32 v46, 0
  v_mov_b32 v47, 0
  v_mov_b32 v48, 0
  v_mov_b32 v49, 0
  v_mov_b32 v50, 0
  v_mov_b32 v51, 0
  v_mov_b32 v52, 0
  v_mov_b32 v53, 0
  v_mov_b32 v54, 0
  v_mov_b32 v55, 0
  v_mov_b32 v56, 0
  v_mov_b32 v57, 0
  v_mov_b32 v58, 0
  v_mov_b32 v59, 0
  v_mov_b32 v60, 0
  v_mov_b32 v61, 0
  v_mov_b32 v62, 0
  v_mov_b32 v63, 0
  v_mov_b32 v88, 0
  v_mov_b32 v89, 0
  v_mov_b32 v90, 0
  v_mov_b32 v91, 0
  v_mov_b32 v92, 0
  v_mov_b32 v93, 0
  v_mov_b32 v94, 0
  v_mov_b32 v95, 0
  v_mov_b32 v64, 0
  v_mov_b32 v65, 0
  s_add_u32 s31, s31, 1
  ds_read_b128 v[96:99], v117 offset:0
  ds_read_b128 v[100:103], v117 offset:1024
  ds_read_b128 v[104:107], v117 offset:14336
  ds_read_b128 v[108:111], v117 offset:15360
  v_smfmac_f32_16x16x64_bf16 v[36:39], v[8:11], a[0:7], v3
  v_smfmac_f32_16x16x64_bf16 v[40:43], v[8:11], a[56:63], v3
  v_smfmac_f32_16x16x64_bf16 v[44:47], v[8:11], a[112:119], v3
  v_smfmac_f32_16x16x64_bf16 v[48:51], v[8:11], a[168:175], v3
  v_smfmac_f32_16x16x64_bf16 v[52:55], v[8:11], a[224:231], v3
  v_smfmac_f32_16x16x64_bf16 v[56:59], v[8:11], v[144:151], v3
  v_smfmac_f32_16x16x64_bf16 v[60:63], v[8:11], v[200:207], v3
  v_smfmac_f32_16x16x64_bf16 v[36:39], v[12:15], a[8:15], v3
  v_smfmac_f32_16x16x64_bf16 v[40:43], v[12:15], a[64:71], v3
  v_smfmac_f32_16x16x64_bf16 v[44:47], v[12:15], a[120:127], v3
  v_smfmac_f32_16x16x64_bf16 v[48:51], v[12:15], a[176:183], v3
  v_smfmac_f32_16x16x64_bf16 v[52:55], v[12:15], a[232:239], v3
  v_smfmac_f32_16x16x64_bf16 v[56:59], v[12:15], v[152:159], v3
  v_smfmac_f32_16x16x64_bf16 v[60:63], v[12:15], v[208:215], v3
  v_smfmac_f32_16x16x64_bf16 v[36:39], v[16:19], a[16:23], v3
  v_smfmac_f32_16x16x64_bf16 v[40:43], v[16:19], a[72:79], v3
  v_smfmac_f32_16x16x64_bf16 v[44:47], v[16:19], a[128:135], v3
  v_smfmac_f32_16x16x64_bf16 v[48:51], v[16:19], a[184:191], v3
  v_smfmac_f32_16x16x64_bf16 v[52:55], v[16:19], a[240:247], v3
  v_smfmac_f32_16x16x64_bf16 v[56:59], v[16:19], v[160:167], v3
  v_smfmac_f32_16x16x64_bf16 v[60:63], v[16:19], v[216:223], v3
  v_smfmac_f32_16x16x64_bf16 v[36:39], v[20:23], a[24:31], v3
  v_smfmac_f32_16x16x64_bf16 v[40:43], v[20:23], a[80:87], v3
  v_smfmac_f32_16x16x64_bf16 v[44:47], v[20:23], a[136:143], v3
  v_smfmac_f32_16x16x64_bf16 v[48:51], v[20:23], a[192:199], v3
  v_smfmac_f32_16x16x64_bf16 v[52:55], v[20:23], a[248:255], v3
  v_smfmac_f32_16x16x64_bf16 v[56:59], v[20:23], v[168:175], v3
  v_smfmac_f32_16x16x64_bf16 v[60:63], v[20:23], v[224:231], v3
  s_xor_b32 s58, s25, 28672
  s_add_u32 s59, s24, 28672
  s_add_u32 m0, s58, 21504
  s_branch cA_sc3_ph2
.p2align 6

cA_va0_loop:
  s_add_u32 s23, s20, 4096
  s_add_u32 s21, s20, 20480
  s_mov_b32 s30, 0
  s_cmp_lg_u32 s19, s38
  s_cbranch_scc1 cA_va0_vok
  s_branch cA_va0_voc
cA_va0_vow:
  s_sub_u32 s22, s39, s35
  v_lshlrev_b32 v63, 7, v2
  v_min_u32 v63, s22, v63
  buffer_load_dword v63, v63, s[8:11], s35 offen sc1
  s_waitcnt vmcnt(0)
cA_va0_voc:
  v_readfirstlane_b32 s22, v63
  s_cmp_eq_u32 s22, 56
  s_cbranch_scc1 cA_va0_vod
  s_sleep 1
  s_add_u32 s30, s30, 1
  s_cmp_lt_u32 s30, 400000
  s_cbranch_scc1 cA_va0_vow
  s_branch cA_abort
cA_va0_vod:
  s_add_u32 s35, s35, 2048
  s_add_u32 s38, s19, 8
  s_and_b32 s38, s38, -8
  s_cmp_eq_u32 s19, 0
  s_cselect_b32 s38, 4, s38
  v_cmp_ne_u32 vcc, 56, v63
  s_nop 3
  s_cmp_eq_u64 vcc, 0
  s_cselect_b32 s38, 99, s38
cA_va0_vok:
  s_cmp_eq_u32 s19, 63
  s_cbranch_scc1 cA_done
  s_barrier
  s_add_u32 s22, s25, 0
  buffer_load_dwordx4 v[80:83], v6, s[8:11], s22 offen offset:0 sc1
  buffer_load_dwordx4 v[84:87], v6, s[8:11], s22 offen offset:1792 sc1
  s_add_u32 s22, s25, 3584
  buffer_load_dwordx4 v[88:91], v6, s[8:11], s22 offen offset:0 sc1
  buffer_load_dwordx4 v[92:95], v6, s[8:11], s22 offen offset:1792 sc1
  s_add_u32 s22, s25, 7168
  buffer_load_dwordx4 v[96:99], v6, s[8:11], s22 offen offset:0 sc1
  buffer_load_dwordx4 v[100:103], v6, s[8:11], s22 offen offset:1792 sc1
  s_add_u32 s22, s25, 10752
  buffer_load_dwordx4 v[104:107], v6, s[8:11], s22 offen offset:0 sc1
  buffer_load_dwordx4 v[108:111], v6, s[8:11], s22 offen offset:1792 sc1
  s_add_u32 s22, s25, 14336
  buffer_load_dwordx4 v[112:115], v6, s[8:11], s22 offen offset:0 sc1
  buffer_load_dwordx4 v[116:119], v6, s[8:11], s22 offen offset:1792 sc1
  s_add_u32 s22, s25, 17920
  buffer_load_dwordx4 v[120:123], v6, s[8:11], s22 offen offset:0 sc1
  buffer_load_dwordx4 v[124:127], v6, s[8:11], s22 offen offset:1792 sc1
  s_add_u32 s22, s19, 1
  s_cmp_lg_u32 s22, s38
  s_cbranch_scc1 cA_va0_nk
  s_sub_u32 s22, s39, s35
  v_lshlrev_b32 v63, 7, v2
  v_min_u32 v63, s22, v63
  buffer_load_dword v63, v63, s[8:11], s35 offen sc1
cA_va0_nk:
  s_barrier
  ds_read_b128 v[8:11], v0 offset:8192
  ds_read_b128 v[12:15], v0 offset:9216
  ds_read_b128 v[16:19], v0 offset:10240
  ds_read_b128 v[20:23], v0 offset:11264
  ds_read_b128 v[24:27], v0 offset:12288
  ds_read_b128 v[28:31], v0 offset:13312
  ds_read_b128 v[32:35], v0 offset:14336
  s_waitcnt lgkmcnt(0)
  v_smfmac_f32_16x16x64_bf16 v[36:39], v[8:11], a[0:7], v3
  s_add_u32 s22, s25, 21504
  buffer_load_dwordx4 v[128:131], v6, s[8:11], s22 offen offset:0 sc1
  v_smfmac_f32_16x16x64_bf16 v[36:39], v[12:15], a[8:15], v3
  v_smfmac_f32_16x16x64_bf16 v[36:39], v[16:19], a[16:23], v3
  s_add_u32 s22, s25, 21504
  buffer_load_dwordx4 v[132:135], v6, s[8:11], s22 offen offset:1792 sc1
  v_smfmac_f32_16x16x64_bf16 v[36:39], v[20:23], a[24:31], v3
  v_smfmac_f32_16x16x64_bf16 v[36:39], v[24:27], a[32:39], v3
  s_add_u32 s22, s25, 25088
  buffer_load_dwordx4 v[136:139], v6, s[8:11], s22 offen offset:0 sc1
  v_smfmac_f32_16x16x64_bf16 v[36:39], v[28:31], a[40:47], v3
  v_smfmac_f32_16x16x64_bf16 v[36:39], v[32:35], a[48:55], v3
  s_add_u32 s22, s25, 25088
  buffer_load_dwordx4 v[140:143], v6, s[8:11], s22 offen offset:1792 sc1
  v_smfmac_f32_16x16x64_bf16 v[40:43], v[8:11], a[56:63], v3
  v_smfmac_f32_16x16x64_bf16 v[40:43], v[12:15], a[64:71], v3
  v_smfmac_f32_16x16x64_bf16 v[40:43], v[16:19], a[72:79], v3
  v_add_f32 v36, v36, v37
  v_smfmac_f32_16x16x64_bf16 v[40:43], v[20:23], a[80:87], v3
  v_add_f32 v38, v38, v39
  v_smfmac_f32_16x16x64_bf16 v[40:43], v[24:27], a[88:95], v3
  v_cvt_pk_bf16_f32 v36, v36, v38
  v_smfmac_f32_16x16x64_bf16 v[40:43], v[28:31], a[96:103], v3
  ds_write_b32 v60, v36
  v_smfmac_f32_16x16x64_bf16 v[40:43], v[32:35], a[104:111], v3
  v_smfmac_f32_16x16x64_bf16 v[44:47], v[8:11], a[112:119], v3
  v_smfmac_f32_16x16x64_bf16 v[44:47], v[12:15], a[120:127], v3
  v_smfmac_f32_16x16x64_bf16 v[44:47], v[16:19], a[128:135], v3
  v_add_f32 v40, v40, v41
  v_smfmac_f32_16x16x64_bf16 v[44:47], v[20:23], a[136:143], v3
  v_add_f32 v42, v42, v43
  v_smfmac_f32_16x16x64_bf16 v[44:47], v[24:27], a[144:151], v3
  v_cvt_pk_bf16_f32 v40, v40, v42
  v_smfmac_f32_16x16x64_bf16 v[44:47], v[28:31], a[152:159], v3
  ds_write_b32 v61, v40
  v_smfmac_f32_16x16x64_bf16 v[44:47], v[32:35], a[160:167], v3
  v_smfmac_f32_16x16x64_bf16 v[48:51], v[8:11], a[168:175], v3
  v_smfmac_f32_16x16x64_bf16 v[48:51], v[12:15], a[176:183], v3
  v_smfmac_f32_16x16x64_bf16 v[48:51], v[16:19], a[184:191], v3
  v_add_f32 v44, v44, v45
  v_smfmac_f32_16x16x64_bf16 v[48:51], v[20:23], a[192:199], v3
  v_add_f32 v46, v46, v47
  v_smfmac_f32_16x16x64_bf16 v[48:51], v[24:27], a[200:207], v3
  v_cvt_pk_bf16_f32 v44, v44, v46
  v_smfmac_f32_16x16x64_bf16 v[48:51], v[28:31], a[208:215], v3
  ds_write_b32 v62, v44
  v_smfmac_f32_16x16x64_bf16 v[48:51], v[32:35], a[216:223], v3
  v_smfmac_f32_16x16x64_bf16 v[52:55], v[8:11], a[224:231], v3
  v_smfmac_f32_16x16x64_bf16 v[52:55], v[12:15], a[232:239], v3
  v_smfmac_f32_16x16x64_bf16 v[52:55], v[16:19], a[240:247], v3
  v_add_f32 v48, v48, v49
  v_smfmac_f32_16x16x64_bf16 v[52:55], v[20:23], a[248:255], v3
  v_add_f32 v50, v50, v51
  v_smfmac_f32_16x16x64_bf16 v[52:55], v[24:27], v[176:183], v3
  v_cvt_pk_bf16_f32 v48, v48, v50
  v_smfmac_f32_16x16x64_bf16 v[52:55], v[28:31], v[184:191], v3
  ds_write_b32 v170, v48
  v_smfmac_f32_16x16x64_bf16 v[52:55], v[32:35], v[192:199], v3
  v_smfmac_f32_16x16x64_bf16 v[56:59], v[8:11], v[200:207], v3
  v_smfmac_f32_16x16x64_bf16 v[56:59], v[12:15], v[208:215], v3
  v_smfmac_f32_16x16x64_bf16 v[56:59], v[16:19], v[216:223], v3
  v_add_f32 v52, v52, v53
  v_smfmac_f32_16x16x64_bf16 v[56:59], v[20:23], v[224:231], v3
  v_add_f32 v54, v54, v55
  v_smfmac_f32_16x16x64_bf16 v[56:59], v[24:27], v[232:239], v3
  v_cvt_pk_bf16_f32 v52, v52, v54
  v_smfmac_f32_16x16x64_bf16 v[56:59], v[28:31], v[240:247], v3
  ds_write_b32 v171, v52
  v_smfmac_f32_16x16x64_bf16 v[56:59], v[32:35], v[248:255], v3
  s_nop 7
  v_add_f32 v56, v56, v57
  v_add_f32 v58, v58, v59
  v_cvt_pk_bf16_f32 v56, v56, v58
  ds_write_b32 v172, v56
  buffer_load_dword v164, v4, s[8:11], s20 offen sc1
  s_waitcnt lgkmcnt(0)
  v_mov_b32 v36, 0
  v_mov_b32 v37, 0
  v_mov_b32 v38, 0
  v_mov_b32 v39, 0
  v_mov_b32 v40, 0
  v_mov_b32 v41, 0
  v_mov_b32 v42, 0
  v_mov_b32 v43, 0
  buffer_load_dword v165, v4, s[8:11], s20 offen sc1
  v_mov_b32 v44, 0
  v_mov_b32 v45, 0
  v_mov_b32 v46, 0
  v_mov_b32 v47, 0
  v_mov_b32 v48, 0
  v_mov_b32 v49, 0
  v_mov_b32 v50, 0
  v_mov_b32 v51, 0
  buffer_load_dword v166, v4, s[8:11], s20 offen sc1
  v_mov_b32 v52, 0
  v_mov_b32 v53, 0
  v_mov_b32 v54, 0
  v_mov_b32 v55, 0
  v_mov_b32 v56, 0
  v_mov_b32 v57, 0
  v_mov_b32 v58, 0
  v_mov_b32 v59, 0
  buffer_load_dword v167, v4, s[8:11], s20 offen sc1
  s_cmp_eq_u32 s19, 63
  s_cbranch_scc1 cA_va0_last
  s_add_u32 s22, s20, 9216
  s_add_u32 s34, s20, 13312
  s_add_u32 s36, s20, 7168
  s_mov_b32 s37, 0
  v_mov_b32 v156, 0
  v_mov_b32 v157, 0
  v_mov_b32 v158, 0
  v_mov_b32 v159, 0
  buffer_load_dword v168, v4, s[8:11], s20 offen sc1
cA_va0_fw_l:
  s_waitcnt vmcnt(4)
  v_cmp_eq_u32 vcc, -1, v164
  s_cbranch_vccz cA_va0_fw_d
  buffer_load_dword v164, v4, s[8:11], s20 offen sc1
  s_waitcnt vmcnt(4)
  v_cmp_eq_u32 vcc, -1, v165
  s_cbranch_vccz cA_va0_fw_d
  buffer_load_dword v165, v4, s[8:11], s20 offen sc1
  s_waitcnt vmcnt(4)
  v_cmp_eq_u32 vcc, -1, v166
  s_cbranch_vccz cA_va0_fw_d
  buffer_load_dword v166, v4, s[8:11], s20 offen sc1
  s_waitcnt vmcnt(4)
  v_cmp_eq_u32 vcc, -1, v167
  s_cbranch_vccz cA_va0_fw_d
  buffer_load_dword v167, v4, s[8:11], s20 offen sc1
  s_waitcnt vmcnt(4)
  v_cmp_eq_u32 vcc, -1, v168
  s_cbranch_vccz cA_va0_fw_d
  buffer_load_dword v168, v4, s[8:11], s20 offen sc1
  s_add_u32 s30, s30, 1
  s_cmp_lt_u32 s30, 400000
  s_cbranch_scc1 cA_va0_fw_l
  s_branch cA_abort
cA_va0_fw_d:
  s_waitcnt lgkmcnt(0)
  buffer_load_dwordx4 v[8:11], v5, s[8:11], s22 offen offset:0
  buffer_load_dwordx4 v[12:15], v5, s[8:11], s22 offen offset:1024
  buffer_load_dwordx4 v[16:19], v5, s[8:11], s22 offen offset:2048
  buffer_load_dwordx4 v[20:23], v5, s[8:11], s22 offen offset:3072
  buffer_load_dwordx4 v[24:27], v5, s[8:11], s34 offen offset:0
  buffer_load_dwordx4 v[28:31], v5, s[8:11], s34 offen offset:1024
  buffer_load_dwordx4 v[32:35], v5, s[8:11], s34 offen offset:2048
  buffer_load_dwordx4 v[144:147], v5, s[8:11], s34 offen offset:3072
  buffer_load_dwordx4 v[148:151], v2, s[8:11], s36 offen offset:0
  buffer_load_dwordx4 v[152:155], v2, s[8:11], s36 offen offset:1024
  s_barrier
  ds_read_b128 v[64:67], v2 offset:0
  ds_read_b128 v[68:71], v2 offset:1024
  ds_read_b128 v[72:75], v2 offset:2048
  ds_read_b128 v[76:79], v2 offset:3072
  s_waitcnt vmcnt(9)
  v_smfmac_f32_16x16x64_bf16 v[156:159], v[8:11], v[80:87], v3
  s_waitcnt vmcnt(8)
  v_smfmac_f32_16x16x64_bf16 v[156:159], v[12:15], v[88:95], v3
  s_waitcnt vmcnt(7)
  v_smfmac_f32_16x16x64_bf16 v[156:159], v[16:19], v[96:103], v3
  s_waitcnt vmcnt(6)
  v_smfmac_f32_16x16x64_bf16 v[156:159], v[20:23], v[104:111], v3
  s_waitcnt vmcnt(5)
  v_smfmac_f32_16x16x64_bf16 v[156:159], v[24:27], v[112:119], v3
  s_waitcnt vmcnt(4)
  v_smfmac_f32_16x16x64_bf16 v[156:159], v[28:31], v[120:127], v3
  s_waitcnt vmcnt(3)
  v_smfmac_f32_16x16x64_bf16 v[156:159], v[32:35], v[128:135], v3
  s_waitcnt vmcnt(2)
  v_smfmac_f32_16x16x64_bf16 v[156:159], v[144:147], v[136:143], v3
  s_waitcnt vmcnt(1) lgkmcnt(0)
  v_smfmac_f32_16x16x64_bf16 v[156:159], v[148:151], v[64:71], v3
  s_waitcnt vmcnt(0)
  v_smfmac_f32_16x16x64_bf16 v[156:159], v[152:155], v[72:79], v3
cA_va0_ep:
  s_nop 7
  v_add_f32 v160, v156, v157
  v_add_f32 v161, v158, v159
  v_cmp_u_f32 vcc, v160, v161
  v_mov_b32_dpp v162, v160 row_ror:8 row_mask:0xf bank_mask:0xf
  v_mov_b32_dpp v160, v161 row_ror:8 row_mask:0xf bank_mask:0xc
  s_cbranch_vccnz cA_va0_rp
  v_mov_b32_dpp v161, v162 quad_perm:[0,1,2,3] row_mask:0xf bank_mask:0x3
  v_cvt_pk_bf16_f32 v160, v160, v161
cA_va0_pc:
  buffer_store_dword v160, v1, s[8:11], s21 offen
  s_cmp_lg_u32 s19, 62
  s_cbranch_scc1 cA_va0_nl
  s_mov_b32 s22, 88531968
  buffer_store_dword v160, v1, s[8:11], s22 offen sc1
  s_mov_b64 exec, -1
  s_branch cA_done
cA_va0_nl:
  s_mov_b64 exec, -1
  s_add_u32 s25, s25, 28672
  s_add_u32 s19, s19, 1
  s_mov_b32 s20, s21
  s_branch cA_va0_loop
cA_va0_last:
  s_waitcnt lgkmcnt(0)
  s_barrier
  s_branch cA_done
cA_va0_rp:
  s_cmp_eq_u32 s37, 0
  s_cbranch_scc1 cA_va0_rv
  v_mov_b32_dpp v161, v162 quad_perm:[0,1,2,3] row_mask:0xf bank_mask:0x3
  v_cvt_pk_bf16_f32 v160, v160, v161
  v_min_u32 v160, -2, v160
  s_branch cA_va0_pc
cA_va0_rv:
  buffer_load_dwordx4 v[8:11], v5, s[8:11], s22 offen offset:0 sc1
  buffer_load_dwordx4 v[12:15], v5, s[8:11], s22 offen offset:1024 sc1
  buffer_load_dwordx4 v[16:19], v5, s[8:11], s22 offen offset:2048 sc1
  buffer_load_dwordx4 v[20:23], v5, s[8:11], s22 offen offset:3072 sc1
  buffer_load_dwordx4 v[24:27], v5, s[8:11], s34 offen offset:0 sc1
  buffer_load_dwordx4 v[28:31], v5, s[8:11], s34 offen offset:1024 sc1
  buffer_load_dwordx4 v[32:35], v5, s[8:11], s34 offen offset:2048 sc1
  buffer_load_dwordx4 v[144:147], v5, s[8:11], s34 offen offset:3072 sc1
  buffer_load_dwordx4 v[148:151], v2, s[8:11], s36 offen offset:0 sc1
  buffer_load_dwordx4 v[152:155], v2, s[8:11], s36 offen offset:1024 sc1
  s_waitcnt vmcnt(0)
  v_max3_u32 v175, v8, v9, v10
  v_max3_u32 v175, v175, v11, v12
  v_max3_u32 v175, v175, v13, v14
  v_max3_u32 v175, v175, v15, v16
  v_max3_u32 v175, v175, v17, v18
  v_max3_u32 v175, v175, v19, v20
  v_max3_u32 v175, v175, v21, v22
  v_max3_u32 v175, v175, v23, v24
  v_max3_u32 v175, v175, v25, v26
  v_max3_u32 v175, v175, v27, v28
  v_max3_u32 v175, v175, v29, v30
  v_max3_u32 v175, v175, v31, v32
  v_max3_u32 v175, v175, v33, v34
  v_max3_u32 v175, v175, v35, v144
  v_max3_u32 v175, v175, v145, v146
  v_max3_u32 v175, v175, v147, v148
  v_max3_u32 v175, v175, v149, v150
  v_max3_u32 v175, v175, v151, v152
  v_max3_u32 v175, v175, v153, v154
  v_max_u32 v175, v175, v155
  v_cmp_eq_u32 vcc, -1, v175
  s_cbranch_vccz cA_va0_rk
  s_add_u32 s30, s30, 1
  s_cmp_lt_u32 s30, 400000
  s_cbranch_scc1 cA_va0_rv
  s_branch cA_abort
cA_va0_rk:
  s_mov_b32 s37, 1
  s_add_u32 s31, s31, 0x10000
  v_mov_b32 v156, 0
  v_mov_b32 v157, 0
  v_mov_b32 v158, 0
  v_mov_b32 v159, 0
  s_nop 1
  v_smfmac_f32_16x16x64_bf16 v[156:159], v[8:11], v[80:87], v3
  v_smfmac_f32_16x16x64_bf16 v[156:159], v[12:15], v[88:95], v3
  v_smfmac_f32_16x16x64_bf16 v[156:159], v[16:19], v[96:103], v3
  v_smfmac_f32_16x16x64_bf16 v[156:159], v[20:23], v[104:111], v3
  v_smfmac_f32_16x16x64_bf16 v[156:159], v[24:27], v[112:119], v3
  v_smfmac_f32_16x16x64_bf16 v[156:159], v[28:31], v[120:127], v3
  v_smfmac_f32_16x16x64_bf16 v[156:159], v[32:35], v[128:135], v3
  v_smfmac_f32_16x16x64_bf16 v[156:159], v[144:147], v[136:143], v3
  v_smfmac_f32_16x16x64_bf16 v[156:159], v[148:151], v[64:71], v3
  v_smfmac_f32_16x16x64_bf16 v[156:159], v[152:155], v[72:79], v3
  s_nop 7
  s_branch cA_va0_ep
.p2align 6

cA_va1_loop:
  s_add_u32 s23, s20, 4096
  s_add_u32 s21, s20, 20480
  s_mov_b32 s30, 0
  s_cmp_lg_u32 s19, s38
  s_cbranch_scc1 cA_va1_vok
  s_branch cA_va1_voc
cA_va1_vow:
  s_sub_u32 s22, s39, s35
  v_lshlrev_b32 v63, 7, v2
  v_min_u32 v63, s22, v63
  buffer_load_dword v63, v63, s[8:11], s35 offen sc1
  s_waitcnt vmcnt(0)
cA_va1_voc:
  v_readfirstlane_b32 s22, v63
  s_cmp_eq_u32 s22, 56
  s_cbranch_scc1 cA_va1_vod
  s_sleep 1
  s_add_u32 s30, s30, 1
  s_cmp_lt_u32 s30, 400000
  s_cbranch_scc1 cA_va1_vow
  s_branch cA_abort
cA_va1_vod:
  s_add_u32 s35, s35, 2048
  s_add_u32 s38, s19, 8
  s_and_b32 s38, s38, -8
  s_cmp_eq_u32 s19, 0
  s_cselect_b32 s38, 4, s38
  v_cmp_ne_u32 vcc, 56, v63
  s_nop 3
  s_cmp_eq_u64 vcc, 0
  s_cselect_b32 s38, 99, s38
cA_va1_vok:
  s_cmp_eq_u32 s19, 63
  s_cbranch_scc1 cA_done
  s_barrier
  s_add_u32 s22, s25, 0
  buffer_load_dwordx4 v[80:83], v6, s[8:11], s22 offen offset:0 sc1
  buffer_load_dwordx4 v[84:87], v6, s[8:11], s22 offen offset:1792 sc1
  s_add_u32 s22, s25, 3584
  buffer_load_dwordx4 v[88:91], v6, s[8:11], s22 offen offset:0 sc1
  buffer_load_dwordx4 v[92:95], v6, s[8:11], s22 offen offset:1792 sc1
  s_add_u32 s22, s25, 7168
  buffer_load_dwordx4 v[96:99], v6, s[8:11], s22 offen offset:0 sc1
  buffer_load_dwordx4 v[100:103], v6, s[8:11], s22 offen offset:1792 sc1
  s_add_u32 s22, s25, 10752
  buffer_load_dwordx4 v[104:107], v6, s[8:11], s22 offen offset:0 sc1
  buffer_load_dwordx4 v[108:111], v6, s[8:11], s22 offen offset:1792 sc1
  s_add_u32 s22, s25, 14336
  buffer_load_dwordx4 v[112:115], v6, s[8:11], s22 offen offset:0 sc1
  buffer_load_dwordx4 v[116:119], v6, s[8:11], s22 offen offset:1792 sc1
  s_add_u32 s22, s25, 17920
  buffer_load_dwordx4 v[120:123], v6, s[8:11], s22 offen offset:0 sc1
  buffer_load_dwordx4 v[124:127], v6, s[8:11], s22 offen offset:1792 sc1
  s_add_u32 s22, s19, 1
  s_cmp_lg_u32 s22, s38
  s_cbranch_scc1 cA_va1_nk
  s_sub_u32 s22, s39, s35
  v_lshlrev_b32 v63, 7, v2
  v_min_u32 v63, s22, v63
  buffer_load_dword v63, v63, s[8:11], s35 offen sc1
cA_va1_nk:
  s_barrier
  ds_read_b128 v[8:11], v0 offset:8192
  ds_read_b128 v[12:15], v0 offset:9216
  ds_read_b128 v[16:19], v0 offset:10240
  ds_read_b128 v[20:23], v0 offset:11264
  ds_read_b128 v[24:27], v0 offset:12288
  ds_read_b128 v[28:31], v0 offset:13312
  ds_read_b128 v[32:35], v0 offset:14336
  s_waitcnt lgkmcnt(0)
  v_smfmac_f32_16x16x64_bf16 v[36:39], v[8:11], a[0:7], v3
  s_add_u32 s22, s25, 21504
  buffer_load_dwordx4 v[128:131], v6, s[8:11], s22 offen offset:0 sc1
  v_smfmac_f32_16x16x64_bf16 v[36:39], v[12:15], a[8:15], v3
  v_smfmac_f32_16x16x64_bf16 v[36:39], v[16:19], a[16:23], v3
  s_add_u32 s22, s25, 21504
  buffer_load_dwordx4 v[132:135], v6, s[8:11], s22 offen offset:1792 sc1
  v_smfmac_f32_16x16x64_bf16 v[36:39], v[20:23], a[24:31], v3
  v_smfmac_f32_16x16x64_bf16 v[36:39], v[24:27], a[32:39], v3
  s_add_u32 s22, s25, 25088
  buffer_load_dwordx4 v[136:139], v6, s[8:11], s22 offen offset:0 sc1
  v_smfmac_f32_16x16x64_bf16 v[36:39], v[28:31], a[40:47], v3
  v_smfmac_f32_16x16x64_bf16 v[36:39], v[32:35], a[48:55], v3
  s_add_u32 s22, s25, 25088
  buffer_load_dwordx4 v[140:143], v6, s[8:11], s22 offen offset:1792 sc1
  v_smfmac_f32_16x16x64_bf16 v[40:43], v[8:11], a[56:63], v3
  v_smfmac_f32_16x16x64_bf16 v[40:43], v[12:15], a[64:71], v3
  v_smfmac_f32_16x16x64_bf16 v[40:43], v[16:19], a[72:79], v3
  v_add_f32 v36, v36, v37
  v_smfmac_f32_16x16x64_bf16 v[40:43], v[20:23], a[80:87], v3
  v_add_f32 v38, v38, v39
  v_smfmac_f32_16x16x64_bf16 v[40:43], v[24:27], a[88:95], v3
  v_cvt_pk_bf16_f32 v36, v36, v38
  v_smfmac_f32_16x16x64_bf16 v[40:43], v[28:31], a[96:103], v3
  ds_write_b32 v60, v36
  v_smfmac_f32_16x16x64_bf16 v[40:43], v[32:35], a[104:111], v3
  v_smfmac_f32_16x16x64_bf16 v[44:47], v[8:11], a[112:119], v3
  v_smfmac_f32_16x16x64_bf16 v[44:47], v[12:15], a[120:127], v3
  v_smfmac_f32_16x16x64_bf16 v[44:47], v[16:19], a[128:135], v3
  v_add_f32 v40, v40, v41
  v_smfmac_f32_16x16x64_bf16 v[44:47], v[20:23], a[136:143], v3
  v_add_f32 v42, v42, v43
  v_smfmac_f32_16x16x64_bf16 v[44:47], v[24:27], a[144:151], v3
  v_cvt_pk_bf16_f32 v40, v40, v42
  v_smfmac_f32_16x16x64_bf16 v[44:47], v[28:31], a[152:159], v3
  ds_write_b32 v61, v40
  v_smfmac_f32_16x16x64_bf16 v[44:47], v[32:35], a[160:167], v3
  v_smfmac_f32_16x16x64_bf16 v[48:51], v[8:11], a[168:175], v3
  v_smfmac_f32_16x16x64_bf16 v[48:51], v[12:15], a[176:183], v3
  v_smfmac_f32_16x16x64_bf16 v[48:51], v[16:19], a[184:191], v3
  v_add_f32 v44, v44, v45
  v_smfmac_f32_16x16x64_bf16 v[48:51], v[20:23], a[192:199], v3
  v_add_f32 v46, v46, v47
  v_smfmac_f32_16x16x64_bf16 v[48:51], v[24:27], a[200:207], v3
  v_cvt_pk_bf16_f32 v44, v44, v46
  v_smfmac_f32_16x16x64_bf16 v[48:51], v[28:31], a[208:215], v3
  ds_write_b32 v62, v44
  v_smfmac_f32_16x16x64_bf16 v[48:51], v[32:35], a[216:223], v3
  v_smfmac_f32_16x16x64_bf16 v[52:55], v[8:11], a[224:231], v3
  v_smfmac_f32_16x16x64_bf16 v[52:55], v[12:15], a[232:239], v3
  v_smfmac_f32_16x16x64_bf16 v[52:55], v[16:19], a[240:247], v3
  v_add_f32 v48, v48, v49
  v_smfmac_f32_16x16x64_bf16 v[52:55], v[20:23], a[248:255], v3
  v_add_f32 v50, v50, v51
  v_smfmac_f32_16x16x64_bf16 v[52:55], v[24:27], v[176:183], v3
  v_cvt_pk_bf16_f32 v48, v48, v50
  v_smfmac_f32_16x16x64_bf16 v[52:55], v[28:31], v[184:191], v3
  ds_write_b32 v170, v48
  v_smfmac_f32_16x16x64_bf16 v[52:55], v[32:35], v[192:199], v3
  v_smfmac_f32_16x16x64_bf16 v[56:59], v[8:11], v[200:207], v3
  v_smfmac_f32_16x16x64_bf16 v[56:59], v[12:15], v[208:215], v3
  v_smfmac_f32_16x16x64_bf16 v[56:59], v[16:19], v[216:223], v3
  v_add_f32 v52, v52, v53
  v_smfmac_f32_16x16x64_bf16 v[56:59], v[20:23], v[224:231], v3
  v_add_f32 v54, v54, v55
  v_smfmac_f32_16x16x64_bf16 v[56:59], v[24:27], v[232:239], v3
  v_cvt_pk_bf16_f32 v52, v52, v54
  v_smfmac_f32_16x16x64_bf16 v[56:59], v[28:31], v[240:247], v3
  ds_write_b32 v171, v52
  v_smfmac_f32_16x16x64_bf16 v[56:59], v[32:35], v[248:255], v3
  s_nop 7
  v_add_f32 v56, v56, v57
  v_add_f32 v58, v58, v59
  v_cvt_pk_bf16_f32 v56, v56, v58
  ds_write_b32 v172, v56
  s_waitcnt lgkmcnt(0)
  v_mov_b32 v36, 0
  v_mov_b32 v37, 0
  v_mov_b32 v38, 0
  v_mov_b32 v39, 0
  v_mov_b32 v40, 0
  v_mov_b32 v41, 0
  v_mov_b32 v42, 0
  v_mov_b32 v43, 0
  v_mov_b32 v44, 0
  v_mov_b32 v45, 0
  v_mov_b32 v46, 0
  v_mov_b32 v47, 0
  v_mov_b32 v48, 0
  v_mov_b32 v49, 0
  v_mov_b32 v50, 0
  v_mov_b32 v51, 0
  v_mov_b32 v52, 0
  v_mov_b32 v53, 0
  v_mov_b32 v54, 0
  v_mov_b32 v55, 0
  v_mov_b32 v56, 0
  v_mov_b32 v57, 0
  v_mov_b32 v58, 0
  v_mov_b32 v59, 0
  s_cmp_eq_u32 s19, 63
  s_cbranch_scc1 cA_va1_last
  s_add_u32 s22, s20, 9216
  s_add_u32 s34, s20, 13312
  s_add_u32 s36, s20, 7168
  s_mov_b32 s37, 0
  v_mov_b32 v156, 0
  v_mov_b32 v157, 0
  v_mov_b32 v158, 0
  v_mov_b32 v159, 0
  s_barrier
  s_waitcnt lgkmcnt(0)
  buffer_load_dwordx4 v[8:11], v5, s[8:11], s22 offen offset:0
  buffer_load_dwordx4 v[12:15], v5, s[8:11], s22 offen offset:1024
  buffer_load_dwordx4 v[16:19], v5, s[8:11], s22 offen offset:2048
  buffer_load_dwordx4 v[20:23], v5, s[8:11], s22 offen offset:3072
  buffer_load_dwordx4 v[24:27], v5, s[8:11], s34 offen offset:0
  buffer_load_dwordx4 v[28:31], v5, s[8:11], s34 offen offset:1024
  buffer_load_dwordx4 v[32:35], v5, s[8:11], s34 offen offset:2048
  buffer_load_dwordx4 v[144:147], v5, s[8:11], s34 offen offset:3072
  s_cmp_lg_u32 s19, 0
  s_cbranch_scc1 cA_va1_s0
  s_sleep 6
cA_va1_s0:
  s_sub_u32 s23, s21, 4
  s_mov_b64 exec, 65535
  buffer_store_dword v2, v7, s[8:11], s23 offen
  s_mov_b64 exec, -1
  buffer_load_dwordx4 v[148:151], v2, s[8:11], s36 offen offset:0
  buffer_load_dwordx4 v[152:155], v2, s[8:11], s36 offen offset:1024
  ds_read_b128 v[64:67], v2 offset:4096
  ds_read_b128 v[68:71], v2 offset:5120
  ds_read_b128 v[72:75], v2 offset:6144
  ds_read_b128 v[76:79], v2 offset:7168
  s_waitcnt vmcnt(10)
  v_smfmac_f32_16x16x64_bf16 v[156:159], v[8:11], v[80:87], v3
  s_waitcnt vmcnt(9)
  v_smfmac_f32_16x16x64_bf16 v[156:159], v[12:15], v[88:95], v3
  s_waitcnt vmcnt(8)
  v_smfmac_f32_16x16x64_bf16 v[156:159], v[16:19], v[96:103], v3
  s_waitcnt vmcnt(7)
  v_smfmac_f32_16x16x64_bf16 v[156:159], v[20:23], v[104:111], v3
  s_waitcnt vmcnt(6)
  v_smfmac_f32_16x16x64_bf16 v[156:159], v[24:27], v[112:119], v3
  s_mov_b64 exec, 65535
  buffer_store_dword v2, v7, s[8:11], s21 offen
  s_mov_b64 exec, -1
  s_waitcnt vmcnt(6)
  v_smfmac_f32_16x16x64_bf16 v[156:159], v[28:31], v[120:127], v3
  s_waitcnt vmcnt(5)
  v_smfmac_f32_16x16x64_bf16 v[156:159], v[32:35], v[128:135], v3
  s_waitcnt vmcnt(4)
  v_smfmac_f32_16x16x64_bf16 v[156:159], v[144:147], v[136:143], v3
  s_waitcnt vmcnt(2) lgkmcnt(0)
  v_smfmac_f32_16x16x64_bf16 v[156:159], v[148:151], v[64:71], v3
  s_waitcnt vmcnt(1)
  v_smfmac_f32_16x16x64_bf16 v[156:159], v[152:155], v[72:79], v3
cA_va1_ep:
  s_nop 7
  v_add_f32 v160, v156, v157
  v_add_f32 v161, v158, v159
  v_cmp_u_f32 vcc, v160, v161
  v_mov_b32_dpp v162, v160 row_ror:8 row_mask:0xf bank_mask:0xf
  v_mov_b32_dpp v160, v161 row_ror:8 row_mask:0xf bank_mask:0xc
  s_cbranch_vccnz cA_va1_rp
  v_mov_b32_dpp v161, v162 quad_perm:[0,1,2,3] row_mask:0xf bank_mask:0x3
  v_cvt_pk_bf16_f32 v160, v160, v161
cA_va1_pc:
  s_mov_b64 exec, s[26:27]
  buffer_store_dword v160, v1, s[8:11], s21 offen
  s_cmp_lg_u32 s19, 62
  s_cbranch_scc1 cA_va1_nl
  s_mov_b32 s22, 88531968
  buffer_store_dword v160, v1, s[8:11], s22 offen sc1
  s_mov_b64 exec, -1
  s_branch cA_done
cA_va1_nl:
  s_mov_b64 exec, -1
  s_add_u32 s25, s25, 28672
  s_add_u32 s19, s19, 1
  s_mov_b32 s20, s21
  s_branch cA_va1_loop
cA_va1_last:
  s_waitcnt lgkmcnt(0)
  s_barrier
  s_branch cA_done
cA_va1_rp:
  s_cmp_eq_u32 s37, 0
  s_cbranch_scc1 cA_va1_rv
  v_mov_b32_dpp v161, v162 quad_perm:[0,1,2,3] row_mask:0xf bank_mask:0x3
  v_cvt_pk_bf16_f32 v160, v160, v161
  v_min_u32 v160, -2, v160
  s_branch cA_va1_pc
cA_va1_rv:
  buffer_load_dwordx4 v[8:11], v5, s[8:11], s22 offen offset:0 sc1
  buffer_load_dwordx4 v[12:15], v5, s[8:11], s22 offen offset:1024 sc1
  buffer_load_dwordx4 v[16:19], v5, s[8:11], s22 offen offset:2048 sc1
  buffer_load_dwordx4 v[20:23], v5, s[8:11], s22 offen offset:3072 sc1
  buffer_load_dwordx4 v[24:27], v5, s[8:11], s34 offen offset:0 sc1
  buffer_load_dwordx4 v[28:31], v5, s[8:11], s34 offen offset:1024 sc1
  buffer_load_dwordx4 v[32:35], v5, s[8:11], s34 offen offset:2048 sc1
  buffer_load_dwordx4 v[144:147], v5, s[8:11], s34 offen offset:3072 sc1
  buffer_load_dwordx4 v[148:151], v2, s[8:11], s36 offen offset:0 sc1
  buffer_load_dwordx4 v[152:155], v2, s[8:11], s36 offen offset:1024 sc1
  s_waitcnt vmcnt(0)
  v_max3_u32 v175, v8, v9, v10
  v_max3_u32 v175, v175, v11, v12
  v_max3_u32 v175, v175, v13, v14
  v_max3_u32 v175, v175, v15, v16
  v_max3_u32 v175, v175, v17, v18
  v_max3_u32 v175, v175, v19, v20
  v_max3_u32 v175, v175, v21, v22
  v_max3_u32 v175, v175, v23, v24
  v_max3_u32 v175, v175, v25, v26
  v_max3_u32 v175, v175, v27, v28
  v_max3_u32 v175, v175, v29, v30
  v_max3_u32 v175, v175, v31, v32
  v_max3_u32 v175, v175, v33, v34
  v_max3_u32 v175, v175, v35, v144
  v_max3_u32 v175, v175, v145, v146
  v_max3_u32 v175, v175, v147, v148
  v_max3_u32 v175, v175, v149, v150
  v_max3_u32 v175, v175, v151, v152
  v_max3_u32 v175, v175, v153, v154
  v_max_u32 v175, v175, v155
  v_cmp_eq_u32 vcc, -1, v175
  s_cbranch_vccz cA_va1_rk
  s_add_u32 s30, s30, 1
  s_cmp_lt_u32 s30, 400000
  s_cbranch_scc1 cA_va1_rv
  s_branch cA_abort
cA_va1_rk:
  s_mov_b32 s37, 1
  s_add_u32 s31, s31, 0x10000
  v_mov_b32 v156, 0
  v_mov_b32 v157, 0
  v_mov_b32 v158, 0
  v_mov_b32 v159, 0
  s_nop 1
  v_smfmac_f32_16x16x64_bf16 v[156:159], v[8:11], v[80:87], v3
  v_smfmac_f32_16x16x64_bf16 v[156:159], v[12:15], v[88:95], v3
  v_smfmac_f32_16x16x64_bf16 v[156:159], v[16:19], v[96:103], v3
  v_smfmac_f32_16x16x64_bf16 v[156:159], v[20:23], v[104:111], v3
  v_smfmac_f32_16x16x64_bf16 v[156:159], v[24:27], v[112:119], v3
  v_smfmac_f32_16x16x64_bf16 v[156:159], v[28:31], v[120:127], v3
  v_smfmac_f32_16x16x64_bf16 v[156:159], v[32:35], v[128:135], v3
  v_smfmac_f32_16x16x64_bf16 v[156:159], v[144:147], v[136:143], v3
  v_smfmac_f32_16x16x64_bf16 v[156:159], v[148:151], v[64:71], v3
  v_smfmac_f32_16x16x64_bf16 v[156:159], v[152:155], v[72:79], v3
  s_nop 7
  s_branch cA_va1_ep
.p2align 6

cA_va2_loop:
  s_add_u32 s23, s20, 4096
  s_add_u32 s21, s20, 20480
  v_mov_b32 v36, 0
  v_mov_b32 v37, 0
  v_mov_b32 v38, 0
  v_mov_b32 v39, 0
  v_mov_b32 v40, 0
  v_mov_b32 v41, 0
  v_mov_b32 v42, 0
  v_mov_b32 v43, 0
  v_mov_b32 v44, 0
  v_mov_b32 v45, 0
  v_mov_b32 v46, 0
  v_mov_b32 v47, 0
  v_mov_b32 v48, 0
  v_mov_b32 v49, 0
  v_mov_b32 v50, 0
  v_mov_b32 v51, 0
  v_mov_b32 v52, 0
  v_mov_b32 v53, 0
  v_mov_b32 v54, 0
  v_mov_b32 v55, 0
  v_mov_b32 v56, 0
  v_mov_b32 v57, 0
  v_mov_b32 v58, 0
  v_mov_b32 v59, 0
  v_mov_b32 v60, 0
  v_mov_b32 v61, 0
  v_mov_b32 v62, 0
  v_mov_b32 v63, 0
  v_mov_b32 v64, 0
  v_mov_b32 v65, 0
  v_mov_b32 v66, 0
  v_mov_b32 v67, 0
  s_mov_b32 s30, 0
  buffer_load_dword v76, v119, s[8:11], s20 offen sc1
  buffer_load_dword v77, v119, s[8:11], s20 offen sc1
  buffer_load_dword v78, v119, s[8:11], s20 offen sc1
cA_va2_fp_l:
  s_waitcnt vmcnt(2)
  v_cmp_eq_u32 vcc, -1, v76
  s_cbranch_vccz cA_va2_fp_d
  buffer_load_dword v76, v119, s[8:11], s20 offen sc1
  s_waitcnt vmcnt(2)
  v_cmp_eq_u32 vcc, -1, v77
  s_cbranch_vccz cA_va2_fp_d
  buffer_load_dword v77, v119, s[8:11], s20 offen sc1
  s_waitcnt vmcnt(2)
  v_cmp_eq_u32 vcc, -1, v78
  s_cbranch_vccz cA_va2_fp_d
  buffer_load_dword v78, v119, s[8:11], s20 offen sc1
  s_add_u32 s30, s30, 1
  s_cmp_lt_u32 s30, 400000
  s_cbranch_scc1 cA_va2_fp_l
  s_branch cA_abort
cA_va2_fp_d:
  s_nop 15
  s_nop 3
  buffer_load_dwordx4 v[8:11], v2, s[8:11], s20 offen offset:0 sc1
  buffer_load_dwordx4 v[12:15], v2, s[8:11], s20 offen offset:1024 sc1
  buffer_load_dwordx4 v[16:19], v2, s[8:11], s20 offen offset:2048 sc1
  buffer_load_dwordx4 v[20:23], v2, s[8:11], s20 offen offset:3072 sc1
  s_barrier
cA_va2_ld:
  s_waitcnt vmcnt(0)
  v_max3_u32 v84, v8, v9, v10
  v_max3_u32 v84, v84, v11, v12
  v_max3_u32 v84, v84, v13, v14
  v_max3_u32 v84, v84, v15, v16
  v_max3_u32 v84, v84, v17, v18
  v_max3_u32 v84, v84, v19, v20
  v_max3_u32 v84, v84, v21, v22
  v_max_u32 v84, v84, v23
  v_cmp_eq_u32 vcc, -1, v84
  ds_write_b128 v2, v[8:11] offset:8192
  ds_write_b128 v2, v[12:15] offset:9216
  ds_write_b128 v2, v[16:19] offset:10240
  ds_write_b128 v2, v[20:23] offset:11264
  s_cbranch_vccnz cA_va2_retry
  s_waitcnt lgkmcnt(0)
  s_barrier
  ds_read_b128 v[8:11], v5 offset:8192
  ds_read_b128 v[12:15], v5 offset:9216
  ds_read_b128 v[16:19], v5 offset:10240
  ds_read_b128 v[20:23], v5 offset:11264
  ds_read_b128 v[24:27], v5 offset:12288
  ds_read_b128 v[28:31], v5 offset:13312
  ds_read_b128 v[32:35], v5 offset:14336
  ds_read_b128 v[92:95], v0
  s_waitcnt lgkmcnt(0)
  s_mov_b64 exec, s[26:27]
  buffer_store_dwordx4 v[92:95], v2, s[8:11], s36 offen sc1
  s_mov_b64 exec, -1
  s_add_u32 s36, s36, 7168
  s_cmp_eq_u32 s19, 63
  s_cbranch_scc1 cA_done
  ds_read_b128 v[76:79], v1 offset:0
  ds_read_b128 v[80:83], v1 offset:1024
  ds_read_b128 v[84:87], v1 offset:2048
  ds_read_b128 v[88:91], v1 offset:3072
  ds_read_b128 v[92:95], v1 offset:4096
  ds_read_b128 v[96:99], v1 offset:5120
  v_smfmac_f32_16x16x64_bf16 v[60:63], v[8:11], v[200:207], v3
  v_smfmac_f32_16x16x64_bf16 v[60:63], v[12:15], v[208:215], v3
  s_waitcnt lgkmcnt(4)
  v_smfmac_f32_16x16x64_bf16 v[64:67], v[8:11], v[76:83], v3
  ds_read_b128 v[76:79], v1 offset:6144
  ds_read_b128 v[80:83], v1 offset:7168
  v_smfmac_f32_16x16x64_bf16 v[60:63], v[16:19], v[216:223], v3
  v_smfmac_f32_16x16x64_bf16 v[60:63], v[20:23], v[224:231], v3
  s_waitcnt lgkmcnt(4)
  v_smfmac_f32_16x16x64_bf16 v[64:67], v[12:15], v[84:91], v3
  ds_read_b128 v[84:87], v1 offset:8192
  ds_read_b128 v[88:91], v1 offset:9216
  v_smfmac_f32_16x16x64_bf16 v[60:63], v[24:27], v[232:239], v3
  v_smfmac_f32_16x16x64_bf16 v[60:63], v[28:31], v[240:247], v3
  s_waitcnt lgkmcnt(4)
  v_smfmac_f32_16x16x64_bf16 v[64:67], v[16:19], v[92:99], v3
  ds_read_b128 v[92:95], v1 offset:10240
  ds_read_b128 v[96:99], v1 offset:11264
  v_smfmac_f32_16x16x64_bf16 v[60:63], v[32:35], v[248:255], v3
  v_smfmac_f32_16x16x64_bf16 v[36:39], v[8:11], a[0:7], v3
  s_waitcnt lgkmcnt(4)
  v_smfmac_f32_16x16x64_bf16 v[64:67], v[20:23], v[76:83], v3
  ds_read_b128 v[76:79], v1 offset:12288
  ds_read_b128 v[80:83], v1 offset:13312
  v_smfmac_f32_16x16x64_bf16 v[36:39], v[12:15], a[8:15], v3
  v_add_f32 v60, v60, v61
  v_smfmac_f32_16x16x64_bf16 v[36:39], v[16:19], a[16:23], v3
  v_add_f32 v62, v62, v63
  s_waitcnt lgkmcnt(4)
  v_smfmac_f32_16x16x64_bf16 v[64:67], v[24:27], v[84:91], v3
  v_cvt_pk_bf16_f32 v60, v60, v62
  v_smfmac_f32_16x16x64_bf16 v[36:39], v[20:23], a[24:31], v3
  ds_write_b32 v106, v60
  v_smfmac_f32_16x16x64_bf16 v[36:39], v[24:27], a[32:39], v3
  s_waitcnt lgkmcnt(2)
  v_smfmac_f32_16x16x64_bf16 v[64:67], v[28:31], v[92:99], v3
  v_smfmac_f32_16x16x64_bf16 v[36:39], v[28:31], a[40:47], v3
  v_smfmac_f32_16x16x64_bf16 v[36:39], v[32:35], a[48:55], v3
  s_waitcnt lgkmcnt(0)
  v_smfmac_f32_16x16x64_bf16 v[64:67], v[32:35], v[76:83], v3
  v_smfmac_f32_16x16x64_bf16 v[40:43], v[8:11], a[56:63], v3
  v_smfmac_f32_16x16x64_bf16 v[40:43], v[12:15], a[64:71], v3
  v_add_f32 v36, v36, v37
  v_smfmac_f32_16x16x64_bf16 v[40:43], v[16:19], a[72:79], v3
  v_add_f32 v38, v38, v39
  v_smfmac_f32_16x16x64_bf16 v[40:43], v[20:23], a[80:87], v3
  v_cvt_pk_bf16_f32 v36, v36, v38
  v_smfmac_f32_16x16x64_bf16 v[40:43], v[24:27], a[88:95], v3
  ds_write_b32 v100, v36
  v_smfmac_f32_16x16x64_bf16 v[40:43], v[28:31], a[96:103], v3
  v_add_f32 v64, v64, v65
  v_smfmac_f32_16x16x64_bf16 v[40:43], v[32:35], a[104:111], v3
  v_add_f32 v66, v66, v67
  v_smfmac_f32_16x16x64_bf16 v[44:47], v[8:11], a[112:119], v3
  v_cvt_pk_bf16_f32 v64, v64, v66
  v_smfmac_f32_16x16x64_bf16 v[44:47], v[12:15], a[120:127], v3
  ds_write_b32 v107, v64
  v_smfmac_f32_16x16x64_bf16 v[44:47], v[16:19], a[128:135], v3
  v_add_f32 v40, v40, v41
  v_smfmac_f32_16x16x64_bf16 v[44:47], v[20:23], a[136:143], v3
  v_add_f32 v42, v42, v43
  v_smfmac_f32_16x16x64_bf16 v[44:47], v[24:27], a[144:151], v3
  v_cvt_pk_bf16_f32 v40, v40, v42
  v_smfmac_f32_16x16x64_bf16 v[44:47], v[28:31], a[152:159], v3
  ds_write_b32 v101, v40
  v_smfmac_f32_16x16x64_bf16 v[44:47], v[32:35], a[160:167], v3
  v_smfmac_f32_16x16x64_bf16 v[48:51], v[8:11], a[168:175], v3
  v_smfmac_f32_16x16x64_bf16 v[48:51], v[12:15], a[176:183], v3
  v_smfmac_f32_16x16x64_bf16 v[48:51], v[16:19], a[184:191], v3
  v_add_f32 v44, v44, v45
  v_smfmac_f32_16x16x64_bf16 v[48:51], v[20:23], a[192:199], v3
  v_add_f32 v46, v46, v47
  v_smfmac_f32_16x16x64_bf16 v[48:51], v[24:27], a[200:207], v3
  v_cvt_pk_bf16_f32 v44, v44, v46
  v_smfmac_f32_16x16x64_bf16 v[48:51], v[28:31], a[208:215], v3
  ds_write_b32 v102, v44
  v_smfmac_f32_16x16x64_bf16 v[48:51], v[32:35], a[216:223], v3
  v_smfmac_f32_16x16x64_bf16 v[52:55], v[8:11], a[224:231], v3
  v_smfmac_f32_16x16x64_bf16 v[52:55], v[12:15], a[232:239], v3
  v_smfmac_f32_16x16x64_bf16 v[52:55], v[16:19], a[240:247], v3
  v_add_f32 v48, v48, v49
  v_smfmac_f32_16x16x64_bf16 v[52:55], v[20:23], a[248:255], v3
  v_add_f32 v50, v50, v51
  v_smfmac_f32_16x16x64_bf16 v[52:55], v[24:27], v[120:127], v3
  v_cvt_pk_bf16_f32 v48, v48, v50
  v_smfmac_f32_16x16x64_bf16 v[52:55], v[28:31], v[128:135], v3
  ds_write_b32 v103, v48
  v_smfmac_f32_16x16x64_bf16 v[52:55], v[32:35], v[136:143], v3
  v_smfmac_f32_16x16x64_bf16 v[56:59], v[8:11], v[144:151], v3
  v_smfmac_f32_16x16x64_bf16 v[56:59], v[12:15], v[152:159], v3
  v_smfmac_f32_16x16x64_bf16 v[56:59], v[16:19], v[160:167], v3
  v_add_f32 v52, v52, v53
  v_smfmac_f32_16x16x64_bf16 v[56:59], v[20:23], v[168:175], v3
  v_add_f32 v54, v54, v55
  v_smfmac_f32_16x16x64_bf16 v[56:59], v[24:27], v[176:183], v3
  v_cvt_pk_bf16_f32 v52, v52, v54
  v_smfmac_f32_16x16x64_bf16 v[56:59], v[28:31], v[184:191], v3
  ds_write_b32 v104, v52
  v_smfmac_f32_16x16x64_bf16 v[56:59], v[32:35], v[192:199], v3
  s_nop 7
  v_add_f32 v56, v56, v57
  v_add_f32 v58, v58, v59
  v_cvt_pk_bf16_f32 v56, v56, v58
  ds_write_b32 v105, v56
  s_waitcnt lgkmcnt(0)
  s_barrier
  s_cmp_eq_u32 s19, 62
  s_cbranch_scc1 cA_done
  s_waitcnt vmcnt(0) lgkmcnt(0)
  s_add_u32 s19, s19, 1
  s_mov_b32 s20, s21
  s_branch cA_va2_loop
cA_va2_retry:
  s_waitcnt lgkmcnt(0)
  buffer_load_dwordx4 v[8:11], v2, s[8:11], s20 offen offset:0 sc1
  buffer_load_dwordx4 v[12:15], v2, s[8:11], s20 offen offset:1024 sc1
  buffer_load_dwordx4 v[16:19], v2, s[8:11], s20 offen offset:2048 sc1
  buffer_load_dwordx4 v[20:23], v2, s[8:11], s20 offen offset:3072 sc1
  s_add_u32 s31, s31, 1
  s_add_u32 s30, s30, 1
  s_cmp_lt_u32 s30, 400000
  s_cbranch_scc1 cA_va2_ld
  s_branch cA_abort
cA_va2_last:
  s_waitcnt lgkmcnt(0)
  buffer_store_dwordx4 v[100:103], v2, s[8:11], s24 offen offset:0 sc1
  buffer_store_dwordx4 v[104:107], v2, s[8:11], s24 offen offset:1024 sc1
  buffer_store_dwordx4 v[108:111], v2, s[8:11], s24 offen offset:2048 sc1
  buffer_store_dwordx4 v[4:7], v2, s[8:11], s24 offen offset:3072 sc1
  s_add_u32 s24, s24, 8192
  s_waitcnt vmcnt(0)
  s_mov_b64 exec, 1
  buffer_store_dword v117, v2, s[8:11], s34 offen sc1
  s_mov_b64 exec, -1
  s_add_u32 s34, s34, 8
  s_mov_b64 exec, 1
  buffer_store_dword v117, v2, s[8:11], s34 offen sc1
  s_mov_b64 exec, -1
  s_add_u32 s34, s34, 8
  s_branch cA_done
.p2align 6

cA_va3_loop:
  s_add_u32 s23, s20, 4096
  s_add_u32 s21, s20, 20480
  v_mov_b32 v36, 0
  v_mov_b32 v37, 0
  v_mov_b32 v38, 0
  v_mov_b32 v39, 0
  v_mov_b32 v40, 0
  v_mov_b32 v41, 0
  v_mov_b32 v42, 0
  v_mov_b32 v43, 0
  v_mov_b32 v44, 0
  v_mov_b32 v45, 0
  v_mov_b32 v46, 0
  v_mov_b32 v47, 0
  v_mov_b32 v48, 0
  v_mov_b32 v49, 0
  v_mov_b32 v50, 0
  v_mov_b32 v51, 0
  v_mov_b32 v52, 0
  v_mov_b32 v53, 0
  v_mov_b32 v54, 0
  v_mov_b32 v55, 0
  v_mov_b32 v56, 0
  v_mov_b32 v57, 0
  v_mov_b32 v58, 0
  v_mov_b32 v59, 0
  v_mov_b32 v60, 0
  v_mov_b32 v61, 0
  v_mov_b32 v62, 0
  v_mov_b32 v63, 0
  v_mov_b32 v64, 0
  v_mov_b32 v65, 0
  v_mov_b32 v66, 0
  v_mov_b32 v67, 0
  s_mov_b32 s30, 0
  buffer_load_dword v76, v119, s[8:11], s20 offen sc1
  buffer_load_dword v77, v119, s[8:11], s20 offen sc1
  buffer_load_dword v78, v119, s[8:11], s20 offen sc1
cA_va3_fp_l:
  s_waitcnt vmcnt(2)
  v_cmp_eq_u32 vcc, -1, v76
  s_cbranch_vccz cA_va3_fp_d
  buffer_load_dword v76, v119, s[8:11], s20 offen sc1
  s_waitcnt vmcnt(2)
  v_cmp_eq_u32 vcc, -1, v77
  s_cbranch_vccz cA_va3_fp_d
  buffer_load_dword v77, v119, s[8:11], s20 offen sc1
  s_waitcnt vmcnt(2)
  v_cmp_eq_u32 vcc, -1, v78
  s_cbranch_vccz cA_va3_fp_d
  buffer_load_dword v78, v119, s[8:11], s20 offen sc1
  s_add_u32 s30, s30, 1
  s_cmp_lt_u32 s30, 400000
  s_cbranch_scc1 cA_va3_fp_l
  s_branch cA_abort
cA_va3_fp_d:
  buffer_load_dwordx4 v[24:27], v2, s[8:11], s23 offen offset:0 sc1
  buffer_load_dwordx4 v[28:31], v2, s[8:11], s23 offen offset:1024 sc1
  buffer_load_dwordx4 v[32:35], v2, s[8:11], s23 offen offset:2048 sc1
  s_barrier
cA_va3_ld:
  s_waitcnt vmcnt(0)
  v_max3_u32 v84, v24, v25, v26
  v_max3_u32 v84, v84, v27, v28
  v_max3_u32 v84, v84, v29, v30
  v_max3_u32 v84, v84, v31, v32
  v_max3_u32 v84, v84, v33, v34
  v_max_u32 v84, v84, v35
  v_cmp_eq_u32 vcc, -1, v84
  ds_write_b128 v2, v[24:27] offset:12288
  ds_write_b128 v2, v[28:31] offset:13312
  ds_write_b128 v2, v[32:35] offset:14336
  s_cbranch_vccnz cA_va3_retry
  s_waitcnt lgkmcnt(0)
  s_barrier
  ds_read_b128 v[8:11], v5 offset:8192
  ds_read_b128 v[12:15], v5 offset:9216
  ds_read_b128 v[16:19], v5 offset:10240
  ds_read_b128 v[20:23], v5 offset:11264
  ds_read_b128 v[24:27], v5 offset:12288
  ds_read_b128 v[28:31], v5 offset:13312
  ds_read_b128 v[32:35], v5 offset:14336
  s_waitcnt lgkmcnt(0)
  s_cmp_eq_u32 s19, 63
  s_cbranch_scc1 cA_done
  ds_read_b128 v[76:79], v1 offset:0
  ds_read_b128 v[80:83], v1 offset:1024
  ds_read_b128 v[84:87], v1 offset:2048
  ds_read_b128 v[88:91], v1 offset:3072
  ds_read_b128 v[92:95], v1 offset:4096
  ds_read_b128 v[96:99], v1 offset:5120
  v_smfmac_f32_16x16x64_bf16 v[60:63], v[8:11], v[200:207], v3
  v_smfmac_f32_16x16x64_bf16 v[60:63], v[12:15], v[208:215], v3
  s_waitcnt lgkmcnt(4)
  v_smfmac_f32_16x16x64_bf16 v[64:67], v[8:11], v[76:83], v3
  ds_read_b128 v[76:79], v1 offset:6144
  ds_read_b128 v[80:83], v1 offset:7168
  v_smfmac_f32_16x16x64_bf16 v[60:63], v[16:19], v[216:223], v3
  v_smfmac_f32_16x16x64_bf16 v[60:63], v[20:23], v[224:231], v3
  s_waitcnt lgkmcnt(4)
  v_smfmac_f32_16x16x64_bf16 v[64:67], v[12:15], v[84:91], v3
  ds_read_b128 v[84:87], v1 offset:8192
  ds_read_b128 v[88:91], v1 offset:9216
  v_smfmac_f32_16x16x64_bf16 v[60:63], v[24:27], v[232:239], v3
  v_smfmac_f32_16x16x64_bf16 v[60:63], v[28:31], v[240:247], v3
  s_waitcnt lgkmcnt(4)
  v_smfmac_f32_16x16x64_bf16 v[64:67], v[16:19], v[92:99], v3
  ds_read_b128 v[92:95], v1 offset:10240
  ds_read_b128 v[96:99], v1 offset:11264
  v_smfmac_f32_16x16x64_bf16 v[60:63], v[32:35], v[248:255], v3
  v_smfmac_f32_16x16x64_bf16 v[36:39], v[8:11], a[0:7], v3
  s_waitcnt lgkmcnt(4)
  v_smfmac_f32_16x16x64_bf16 v[64:67], v[20:23], v[76:83], v3
  ds_read_b128 v[76:79], v1 offset:12288
  ds_read_b128 v[80:83], v1 offset:13312
  v_smfmac_f32_16x16x64_bf16 v[36:39], v[12:15], a[8:15], v3
  v_add_f32 v60, v60, v61
  v_smfmac_f32_16x16x64_bf16 v[36:39], v[16:19], a[16:23], v3
  v_add_f32 v62, v62, v63
  s_waitcnt lgkmcnt(4)
  v_smfmac_f32_16x16x64_bf16 v[64:67], v[24:27], v[84:91], v3
  v_cvt_pk_bf16_f32 v60, v60, v62
  v_smfmac_f32_16x16x64_bf16 v[36:39], v[20:23], a[24:31], v3
  ds_write_b32 v106, v60
  v_smfmac_f32_16x16x64_bf16 v[36:39], v[24:27], a[32:39], v3
  s_waitcnt lgkmcnt(2)
  v_smfmac_f32_16x16x64_bf16 v[64:67], v[28:31], v[92:99], v3
  v_smfmac_f32_16x16x64_bf16 v[36:39], v[28:31], a[40:47], v3
  v_smfmac_f32_16x16x64_bf16 v[36:39], v[32:35], a[48:55], v3
  s_waitcnt lgkmcnt(0)
  v_smfmac_f32_16x16x64_bf16 v[64:67], v[32:35], v[76:83], v3
  v_smfmac_f32_16x16x64_bf16 v[40:43], v[8:11], a[56:63], v3
  v_smfmac_f32_16x16x64_bf16 v[40:43], v[12:15], a[64:71], v3
  v_add_f32 v36, v36, v37
  v_smfmac_f32_16x16x64_bf16 v[40:43], v[16:19], a[72:79], v3
  v_add_f32 v38, v38, v39
  v_smfmac_f32_16x16x64_bf16 v[40:43], v[20:23], a[80:87], v3
  v_cvt_pk_bf16_f32 v36, v36, v38
  v_smfmac_f32_16x16x64_bf16 v[40:43], v[24:27], a[88:95], v3
  ds_write_b32 v100, v36
  v_smfmac_f32_16x16x64_bf16 v[40:43], v[28:31], a[96:103], v3
  v_add_f32 v64, v64, v65
  v_smfmac_f32_16x16x64_bf16 v[40:43], v[32:35], a[104:111], v3
  v_add_f32 v66, v66, v67
  v_smfmac_f32_16x16x64_bf16 v[44:47], v[8:11], a[112:119], v3
  v_cvt_pk_bf16_f32 v64, v64, v66
  v_smfmac_f32_16x16x64_bf16 v[44:47], v[12:15], a[120:127], v3
  ds_write_b32 v107, v64
  v_smfmac_f32_16x16x64_bf16 v[44:47], v[16:19], a[128:135], v3
  v_add_f32 v40, v40, v41
  v_smfmac_f32_16x16x64_bf16 v[44:47], v[20:23], a[136:143], v3
  v_add_f32 v42, v42, v43
  v_smfmac_f32_16x16x64_bf16 v[44:47], v[24:27], a[144:151], v3
  v_cvt_pk_bf16_f32 v40, v40, v42
  v_smfmac_f32_16x16x64_bf16 v[44:47], v[28:31], a[152:159], v3
  ds_write_b32 v101, v40
  v_smfmac_f32_16x16x64_bf16 v[44:47], v[32:35], a[160:167], v3
  v_smfmac_f32_16x16x64_bf16 v[48:51], v[8:11], a[168:175], v3
  v_smfmac_f32_16x16x64_bf16 v[48:51], v[12:15], a[176:183], v3
  v_smfmac_f32_16x16x64_bf16 v[48:51], v[16:19], a[184:191], v3
  v_add_f32 v44, v44, v45
  v_smfmac_f32_16x16x64_bf16 v[48:51], v[20:23], a[192:199], v3
  v_add_f32 v46, v46, v47
  v_smfmac_f32_16x16x64_bf16 v[48:51], v[24:27], a[200:207], v3
  v_cvt_pk_bf16_f32 v44, v44, v46
  v_smfmac_f32_16x16x64_bf16 v[48:51], v[28:31], a[208:215], v3
  ds_write_b32 v102, v44
  v_smfmac_f32_16x16x64_bf16 v[48:51], v[32:35], a[216:223], v3
  v_smfmac_f32_16x16x64_bf16 v[52:55], v[8:11], a[224:231], v3
  v_smfmac_f32_16x16x64_bf16 v[52:55], v[12:15], a[232:239], v3
  v_smfmac_f32_16x16x64_bf16 v[52:55], v[16:19], a[240:247], v3
  v_add_f32 v48, v48, v49
  v_smfmac_f32_16x16x64_bf16 v[52:55], v[20:23], a[248:255], v3
  v_add_f32 v50, v50, v51
  v_smfmac_f32_16x16x64_bf16 v[52:55], v[24:27], v[120:127], v3
  v_cvt_pk_bf16_f32 v48, v48, v50
  v_smfmac_f32_16x16x64_bf16 v[52:55], v[28:31], v[128:135], v3
  ds_write_b32 v103, v48
  v_smfmac_f32_16x16x64_bf16 v[52:55], v[32:35], v[136:143], v3
  v_smfmac_f32_16x16x64_bf16 v[56:59], v[8:11], v[144:151], v3
  v_smfmac_f32_16x16x64_bf16 v[56:59], v[12:15], v[152:159], v3
  v_smfmac_f32_16x16x64_bf16 v[56:59], v[16:19], v[160:167], v3
  v_add_f32 v52, v52, v53
  v_smfmac_f32_16x16x64_bf16 v[56:59], v[20:23], v[168:175], v3
  v_add_f32 v54, v54, v55
  v_smfmac_f32_16x16x64_bf16 v[56:59], v[24:27], v[176:183], v3
  v_cvt_pk_bf16_f32 v52, v52, v54
  v_smfmac_f32_16x16x64_bf16 v[56:59], v[28:31], v[184:191], v3
  ds_write_b32 v104, v52
  v_smfmac_f32_16x16x64_bf16 v[56:59], v[32:35], v[192:199], v3
  s_nop 7
  v_add_f32 v56, v56, v57
  v_add_f32 v58, v58, v59
  v_cvt_pk_bf16_f32 v56, v56, v58
  ds_write_b32 v105, v56
  s_waitcnt lgkmcnt(0)
  s_barrier
  s_cmp_eq_u32 s19, 62
  s_cbranch_scc1 cA_done
  s_waitcnt vmcnt(0) lgkmcnt(0)
  s_add_u32 s19, s19, 1
  s_mov_b32 s20, s21
  s_branch cA_va3_loop
cA_va3_retry:
  s_waitcnt lgkmcnt(0)
  buffer_load_dwordx4 v[24:27], v2, s[8:11], s23 offen offset:0 sc1
  buffer_load_dwordx4 v[28:31], v2, s[8:11], s23 offen offset:1024 sc1
  buffer_load_dwordx4 v[32:35], v2, s[8:11], s23 offen offset:2048 sc1
  s_add_u32 s31, s31, 1
  s_add_u32 s30, s30, 1
  s_cmp_lt_u32 s30, 400000
  s_cbranch_scc1 cA_va3_ld
  s_branch cA_abort
cA_va3_last:
  s_waitcnt lgkmcnt(0)
  buffer_store_dwordx4 v[100:103], v2, s[8:11], s24 offen offset:0 sc1
  buffer_store_dwordx4 v[104:107], v2, s[8:11], s24 offen offset:1024 sc1
  buffer_store_dwordx4 v[108:111], v2, s[8:11], s24 offen offset:2048 sc1
  buffer_store_dwordx4 v[4:7], v2, s[8:11], s24 offen offset:3072 sc1
  s_add_u32 s24, s24, 8192
  s_waitcnt vmcnt(0)
  s_mov_b64 exec, 1
  buffer_store_dword v117, v2, s[8:11], s34 offen sc1
  s_mov_b64 exec, -1
  s_add_u32 s34, s34, 8
  s_mov_b64 exec, 1
  buffer_store_dword v117, v2, s[8:11], s34 offen sc1
  s_mov_b64 exec, -1
  s_add_u32 s34, s34, 8
  s_branch cA_done
cA_abort:
  v_mov_b32 v4, 0xdead
  v_mov_b32 v5, 16
  buffer_store_dword v4, v5, s[12:15], 0 offen
  s_branch ch_end
cA_done:
  s_branch ch_end
.p2align 6

cB_sc0_loop:
  s_add_u32 s23, s20, 4096
  s_add_u32 s21, s20, 20480
  v_mov_b32 v48, 0
  v_mov_b32 v49, 0
  v_mov_b32 v50, 0
  v_mov_b32 v51, 0
  v_mov_b32 v52, 0
  v_mov_b32 v53, 0
  v_mov_b32 v54, 0
  v_mov_b32 v55, 0
  v_mov_b32 v56, 0
  v_mov_b32 v57, 0
  v_mov_b32 v58, 0
  v_mov_b32 v59, 0
  v_mov_b32 v60, 0
  v_mov_b32 v61, 0
  v_mov_b32 v62, 0
  v_mov_b32 v63, 0
  v_mov_b32 v88, 0
  v_mov_b32 v89, 0
  v_mov_b32 v90, 0
  v_mov_b32 v91, 0
  v_mov_b32 v92, 0
  v_mov_b32 v93, 0
  v_mov_b32 v94, 0
  v_mov_b32 v95, 0
  v_mov_b32 v66, 0
  v_mov_b32 v67, 0
  s_mov_b32 s30, 0
  s_mov_b32 s62, 0
  buffer_load_dword v68, v0, s[8:11], s20 offen sc1
  s_nop 7
  buffer_load_dword v69, v0, s[8:11], s20 offen sc1
  s_nop 7
  buffer_load_dword v70, v0, s[8:11], s20 offen sc1
  s_nop 7
  buffer_load_dword v71, v0, s[8:11], s20 offen sc1
  s_nop 7
  buffer_load_dword v72, v0, s[8:11], s20 offen sc1
cB_sc0_fp_l:
  s_waitcnt vmcnt(4)
  v_cmp_eq_u32 vcc, -1, v68
  s_cbranch_vccz cB_sc0_fp_d
  buffer_load_dword v68, v0, s[8:11], s20 offen sc1
  s_waitcnt vmcnt(4)
  v_cmp_eq_u32 vcc, -1, v69
  s_cbranch_vccz cB_sc0_fp_d
  buffer_load_dword v69, v0, s[8:11], s20 offen sc1
  s_waitcnt vmcnt(4)
  v_cmp_eq_u32 vcc, -1, v70
  s_cbranch_vccz cB_sc0_fp_d
  buffer_load_dword v70, v0, s[8:11], s20 offen sc1
  s_waitcnt vmcnt(4)
  v_cmp_eq_u32 vcc, -1, v71
  s_cbranch_vccz cB_sc0_fp_d
  buffer_load_dword v71, v0, s[8:11], s20 offen sc1
  s_waitcnt vmcnt(4)
  v_cmp_eq_u32 vcc, -1, v72
  s_cbranch_vccz cB_sc0_fp_d
  buffer_load_dword v72, v0, s[8:11], s20 offen sc1
  s_add_u32 s30, s30, 1
  s_cmp_lt_u32 s30, 400000
  s_cbranch_scc1 cB_sc0_fp_l
  s_branch cB_abort
cB_sc0_fp_d:
  buffer_load_dwordx4 v[8:11], v2, s[8:11], s20 offen offset:0 sc1
  s_barrier
  s_branch cB_sc0_ld1
cB_sc0_ld:
  buffer_load_dwordx4 v[8:11], v2, s[8:11], s20 offen offset:0 sc1
cB_sc0_ld1:
  v_mov_b32 v36, 0
  v_mov_b32 v37, 0
  v_mov_b32 v38, 0
  v_mov_b32 v39, 0
  buffer_load_dwordx4 v[12:15], v2, s[8:11], s20 offen offset:1024 sc1
  v_mov_b32 v40, 0
  v_mov_b32 v41, 0
  v_mov_b32 v42, 0
  v_mov_b32 v43, 0
  buffer_load_dwordx4 v[16:19], v2, s[8:11], s20 offen offset:2048 sc1
  v_mov_b32 v44, 0
  v_mov_b32 v45, 0
  v_mov_b32 v46, 0
  v_mov_b32 v47, 0
  ds_read_b128 v[96:99], v117 offset:0
  ds_read_b128 v[100:103], v117 offset:1024
  ds_read_b128 v[104:107], v117 offset:14336
  ds_read_b128 v[108:111], v117 offset:15360
  s_waitcnt vmcnt(2)
  v_smfmac_f32_16x16x64_bf16 v[36:39], v[8:11], a[0:7], v3
  v_smfmac_f32_16x16x64_bf16 v[40:43], v[8:11], a[56:63], v3
  buffer_load_dwordx4 v[20:23], v2, s[8:11], s20 offen offset:3072 sc1
  v_smfmac_f32_16x16x64_bf16 v[44:47], v[8:11], a[112:119], v3
  v_smfmac_f32_16x16x64_bf16 v[48:51], v[8:11], a[168:175], v3
  v_smfmac_f32_16x16x64_bf16 v[52:55], v[8:11], a[224:231], v3
  buffer_load_dwordx4 v[24:27], v2, s[8:11], s23 offen offset:0 sc1
  v_smfmac_f32_16x16x64_bf16 v[56:59], v[8:11], v[144:151], v3
  v_smfmac_f32_16x16x64_bf16 v[60:63], v[8:11], v[200:207], v3
  s_waitcnt vmcnt(3)
  v_smfmac_f32_16x16x64_bf16 v[36:39], v[12:15], a[8:15], v3
  v_smfmac_f32_16x16x64_bf16 v[40:43], v[12:15], a[64:71], v3
  buffer_load_dwordx4 v[28:31], v2, s[8:11], s23 offen offset:1024 sc1
  v_smfmac_f32_16x16x64_bf16 v[44:47], v[12:15], a[120:127], v3
  v_smfmac_f32_16x16x64_bf16 v[48:51], v[12:15], a[176:183], v3
  v_smfmac_f32_16x16x64_bf16 v[52:55], v[12:15], a[232:239], v3
  buffer_load_dwordx4 v[32:35], v2, s[8:11], s23 offen offset:2048 sc1
  v_smfmac_f32_16x16x64_bf16 v[56:59], v[12:15], v[152:159], v3
  v_smfmac_f32_16x16x64_bf16 v[60:63], v[12:15], v[208:215], v3
  s_xor_b32 s58, s25, 28672
  s_add_u32 s59, s24, 28672
  s_add_u32 m0, s58, 0
  s_waitcnt vmcnt(4)
  v_smfmac_f32_16x16x64_bf16 v[36:39], v[16:19], a[16:23], v3
  buffer_load_dwordx4 v2, s[8:11], s59 offen offset:0 sc1 lds
  v_smfmac_f32_16x16x64_bf16 v[40:43], v[16:19], a[72:79], v3
  v_smfmac_f32_16x16x64_bf16 v[44:47], v[16:19], a[128:135], v3
  v_smfmac_f32_16x16x64_bf16 v[48:51], v[16:19], a[184:191], v3
  v_smfmac_f32_16x16x64_bf16 v[52:55], v[16:19], a[240:247], v3
  buffer_load_dwordx4 v2, s[8:11], s59 offen offset:1024 sc1 lds
  v_smfmac_f32_16x16x64_bf16 v[56:59], v[16:19], v[160:167], v3
  v_smfmac_f32_16x16x64_bf16 v[60:63], v[16:19], v[216:223], v3
  s_waitcnt vmcnt(5)
  v_smfmac_f32_16x16x64_bf16 v[36:39], v[20:23], a[24:31], v3
  v_smfmac_f32_16x16x64_bf16 v[40:43], v[20:23], a[80:87], v3
  buffer_load_dwordx4 v2, s[8:11], s59 offen offset:2048 sc1 lds
  v_smfmac_f32_16x16x64_bf16 v[44:47], v[20:23], a[136:143], v3
  v_smfmac_f32_16x16x64_bf16 v[48:51], v[20:23], a[192:199], v3
  v_smfmac_f32_16x16x64_bf16 v[52:55], v[20:23], a[248:255], v3
  v_smfmac_f32_16x16x64_bf16 v[56:59], v[20:23], v[168:175], v3
  buffer_load_dwordx4 v2, s[8:11], s59 offen offset:3072 sc1 lds
  v_smfmac_f32_16x16x64_bf16 v[60:63], v[20:23], v[224:231], v3
  s_waitcnt vmcnt(4)
cB_sc0_ph2:
  v_smfmac_f32_16x16x64_bf16 v[60:63], v[24:27], v[232:239], v3
  ds_read_b128 v[12:15], v116 offset:0
  ds_read_b128 v[16:19], v116 offset:1024
  v_smfmac_f32_16x16x64_bf16 v[60:63], v[28:31], v[240:247], v3
  v_smfmac_f32_16x16x64_bf16 v[60:63], v[32:35], v[248:255], v3
  v_mov_b32 v80, v24
  v_smfmac_f32_16x16x64_bf16 v[52:55], v[24:27], v[120:127], v3
  v_mov_b32 v81, v25
  v_smfmac_f32_16x16x64_bf16 v[52:55], v[28:31], v[128:135], v3
  v_mov_b32 v82, v32
  v_smfmac_f32_16x16x64_bf16 v[52:55], v[32:35], v[136:143], v3
  v_cvt_pk_bf16_f32 v64, v60, v61
  v_smfmac_f32_16x16x64_bf16 v[56:59], v[24:27], v[176:183], v3
  v_cvt_pk_bf16_f32 v65, v62, v63
  v_smfmac_f32_16x16x64_bf16 v[56:59], v[28:31], v[184:191], v3
  v_mov_b32 v83, v33
  v_mfma_f32_16x16x32_bf16 v[68:71], v[64:67], v[4:7], 0
  v_smfmac_f32_16x16x64_bf16 v[56:59], v[32:35], v[192:199], v3
  v_cvt_pk_bf16_f32 v64, v52, v53
  v_smfmac_f32_16x16x64_bf16 v[36:39], v[24:27], a[32:39], v3
  v_cvt_pk_bf16_f32 v65, v54, v55
  v_smfmac_f32_16x16x64_bf16 v[36:39], v[28:31], a[40:47], v3
  v_cvt_pk_bf16_f32 v78, v68, v69
  v_smfmac_f32_16x16x64_bf16 v[36:39], v[32:35], a[48:55], v3
  v_cvt_pk_bf16_f32 v79, v70, v71
  v_cvt_pk_bf16_f32 v66, v56, v57
  v_smfmac_f32_16x16x64_bf16 v[40:43], v[24:27], a[88:95], v3
  v_cvt_pk_bf16_f32 v67, v58, v59
  v_smfmac_f32_16x16x64_bf16 v[40:43], v[28:31], a[96:103], v3
  v_mfma_f32_16x16x32_bf16 v[72:75], v[64:67], v[4:7], 0
  ds_read_b128 v[52:55], v116 offset:14336
  ds_read_b128 v[56:59], v116 offset:15360
  v_smfmac_f32_16x16x64_bf16 v[40:43], v[32:35], a[104:111], v3
  v_cvt_pk_bf16_f32 v64, v36, v37
  v_smfmac_f32_16x16x64_bf16 v[44:47], v[24:27], a[144:151], v3
  v_cvt_pk_bf16_f32 v65, v38, v39
  v_smfmac_f32_16x16x64_bf16 v[44:47], v[28:31], a[152:159], v3
  v_cvt_pk_bf16_f32 v76, v72, v73
  v_smfmac_f32_16x16x64_bf16 v[44:47], v[32:35], a[160:167], v3
  v_cvt_pk_bf16_f32 v77, v74, v75
  v_cvt_pk_bf16_f32 v66, v40, v41
  v_smfmac_f32_16x16x64_bf16 v[48:51], v[24:27], a[200:207], v3
  v_cvt_pk_bf16_f32 v67, v42, v43
  v_smfmac_f32_16x16x64_bf16 v[48:51], v[28:31], a[208:215], v3
  v_mfma_f32_16x16x32_bf16 v[68:71], v[64:67], v[4:7], 0
  v_smfmac_f32_16x16x64_bf16 v[48:51], v[32:35], a[216:223], v3
  v_cvt_pk_bf16_f32 v64, v44, v45
  v_mfma_f32_16x16x32_bf16 v[84:87], v[80:83], v[76:79], 0
  v_cvt_pk_bf16_f32 v65, v46, v47
  s_waitcnt lgkmcnt(0)
  v_smfmac_f32_16x16x64_bf16 v[88:91], v[76:79], v[96:103], v118
  v_cvt_pk_bf16_f32 v60, v68, v69
  v_cvt_pk_bf16_f32 v61, v70, v71
  v_cvt_pk_bf16_f32 v66, v48, v49
  v_cvt_pk_bf16_f32 v67, v50, v51
  s_nop 1
  v_mfma_f32_16x16x32_bf16 v[72:75], v[64:67], v[4:7], 0
  v_smfmac_f32_16x16x64_bf16 v[92:95], v[76:79], v[104:111], v118
  s_nop 4
  v_cvt_pk_bf16_f32 v62, v72, v73
  v_cvt_pk_bf16_f32 v63, v74, v75
  s_nop 1
  v_mfma_f32_16x16x32_bf16 v[84:87], v[8:11], v[60:63], v[84:87]
  v_smfmac_f32_16x16x64_bf16 v[88:91], v[60:63], v[12:19], v118
  v_smfmac_f32_16x16x64_bf16 v[92:95], v[60:63], v[52:59], v118
  s_nop 1
  v_permlane32_swap_b32 v84, v86
  v_permlane32_swap_b32 v85, v87
  s_nop 0
  v_add_f32 v88, v88, v89
  v_add_f32_dpp v84, v86, v84 quad_perm:[1,0,3,2] row_mask:0xf bank_mask:0xf
  v_add_f32_dpp v85, v87, v85 quad_perm:[1,0,3,2] row_mask:0xf bank_mask:0xf
  v_add_f32 v89, v90, v91
  ds_write2_b32 v113, v84, v85 offset0:0 offset1:4
  ds_write2_b32 v112, v88, v89 offset0:0 offset1:128
  v_add_f32 v90, v92, v93
  v_add_f32 v91, v94, v95
  ds_write2_b32 v112, v90, v91 offset0:64 offset1:192
  v_cmp_u_f32 vcc, v88, v89
  s_cbranch_vccnz cB_sc0_retry
cB_sc0_cont:
  s_waitcnt lgkmcnt(0)
  s_barrier
  ds_read_b128 v[36:39], v114
  ds_read_b128 v[44:47], v115
  s_waitcnt lgkmcnt(0)
  v_add_f32 v36, v36, v38
  v_add_f32 v37, v37, v39
  v_add_f32 v44, v44, v45
  v_add_f32 v46, v46, v47
  v_add_f32 v44, v44, v46
  v_add_f32 v36, v36, v37
  v_exp_f32 v49, v44
  v_exp_f32 v48, v36
  v_add_f32 v50, abs(v36), abs(v44)
  v_fma_f32 v39, v49, s37, v48
  v_cmp_ngt_f32 vcc, s56, v50
  v_cndmask_b32 v41, v48, v49, s[38:39]
  v_add_f32_dpp v39, v39, v39 quad_perm:[1,0,3,2] row_mask:0xf bank_mask:0xf
  v_cndmask_b32 v40, v49, v48, s[38:39]
  v_mov_b32_dpp v46, v41 quad_perm:[1,0,3,2] row_mask:0xf bank_mask:0xf
  v_add_f32_dpp v39, v39, v39 quad_perm:[2,3,0,1] row_mask:0xf bank_mask:0xf
  v_cndmask_b32 v42, v46, v40, s[38:39]
  v_cndmask_b32 v43, v40, v46, s[38:39]
  v_add_f32_dpp v39, v39, v39 row_half_mirror row_mask:0xf bank_mask:0xf
  s_cbranch_vccnz cB_sc0_slow
  s_nop 0
  v_add_f32_dpp v47, v39, v39 row_mirror row_mask:0xf bank_mask:0xf
  v_add_f32_dpp v39, v39, v39 row_mirror row_mask:0xf bank_mask:0xf
  s_nop 1
  v_permlane16_swap_b32 v39, v47
  v_add_f32 v39, v39, v47
  v_rcp_f32 v39, v39
  s_mov_b64 exec, s[28:29]
  v_mul_f32 v42, v42, v39
  v_mul_f32 v43, v43, v39
  v_cvt_pk_bf16_f32 v42, v42, v43
cB_sc0_pst:
  buffer_store_dword v42, v1, s[8:11], s20 offen sc1
  s_mov_b64 exec, -1
  s_barrier
  s_add_u32 s24, s24, 28672
  s_add_u32 s35, s35, 28672
  s_xor_b32 s25, s25, 28672
  s_add_u32 m0, s25, 0
  s_add_u32 m0, s25, 4096
  s_add_u32 s22, s24, 4096
  buffer_load_dwordx4 v2, s[8:11], s22 offen offset:0 sc1 lds
  s_nop 5
  buffer_load_dwordx4 v2, s[8:11], s22 offen offset:1024 sc1 lds
  s_nop 5
  buffer_load_dwordx4 v2, s[8:11], s22 offen offset:2048 sc1 lds
  s_nop 5
  v_xor_b32 v116, 28672, v116
  v_add_u32 v117, s57, v117
  s_sub_u32 s57, 0, s57
  s_add_u32 s19, s19, 1
  s_mov_b32 s20, s21
  s_cmp_lt_u32 s19, 63
  s_cbranch_scc1 cB_sc0_loop
  s_branch cB_done
cB_sc0_slow:
  v_max_f32 v50, v36, v44
  s_nop 1
  v_max_f32_dpp v50, v50, v50 quad_perm:[1,0,3,2] row_mask:0xf bank_mask:0xf
  s_nop 1
  v_max_f32_dpp v50, v50, v50 quad_perm:[2,3,0,1] row_mask:0xf bank_mask:0xf
  s_nop 1
  v_max_f32_dpp v50, v50, v50 row_half_mirror row_mask:0xf bank_mask:0xf
  s_nop 1
  v_max_f32_dpp v50, v50, v50 row_mirror row_mask:0xf bank_mask:0xf
  v_mov_b32 v47, v50
  s_nop 1
  v_permlane16_swap_b32 v50, v47
  v_max_f32 v50, v50, v47
  v_sub_f32 v48, v36, v50
  v_sub_f32 v49, v44, v50
  v_exp_f32 v48, v48
  v_exp_f32 v49, v49
  s_add_u32 s31, s31, 0x100
  v_fma_f32 v39, v49, s37, v48
  v_cndmask_b32 v41, v48, v49, s[38:39]
  s_nop 0
  v_add_f32_dpp v39, v39, v39 quad_perm:[1,0,3,2] row_mask:0xf bank_mask:0xf
  v_cndmask_b32 v40, v49, v48, s[38:39]
  v_mov_b32_dpp v46, v41 quad_perm:[1,0,3,2] row_mask:0xf bank_mask:0xf
  v_add_f32_dpp v39, v39, v39 quad_perm:[2,3,0,1] row_mask:0xf bank_mask:0xf
  v_cndmask_b32 v42, v46, v40, s[38:39]
  v_cndmask_b32 v43, v40, v46, s[38:39]
  v_add_f32_dpp v39, v39, v39 row_half_mirror row_mask:0xf bank_mask:0xf
  s_nop 1
  v_add_f32_dpp v47, v39, v39 row_mirror row_mask:0xf bank_mask:0xf
  v_add_f32_dpp v39, v39, v39 row_mirror row_mask:0xf bank_mask:0xf
  s_nop 1
  v_permlane16_swap_b32 v39, v47
  v_add_f32 v39, v39, v47
  v_rcp_f32 v39, v39
  s_mov_b64 exec, s[28:29]
  v_mul_f32 v42, v42, v39
  v_mul_f32 v43, v43, v39
  v_cvt_pk_bf16_f32 v42, v42, v43
  v_min_u32 v42, -2, v42
  s_branch cB_sc0_pst
cB_sc0_retry:
  s_cmp_lg_u32 s62, 0
  s_cbranch_scc1 cB_sc0_cont
  s_waitcnt vmcnt(0) lgkmcnt(0)
cB_sc0_rv:
  buffer_load_dwordx4 v[8:11], v2, s[8:11], s20 offen offset:0 sc1
  buffer_load_dwordx4 v[12:15], v2, s[8:11], s20 offen offset:1024 sc1
  buffer_load_dwordx4 v[16:19], v2, s[8:11], s20 offen offset:2048 sc1
  buffer_load_dwordx4 v[20:23], v2, s[8:11], s20 offen offset:3072 sc1
  buffer_load_dwordx4 v[24:27], v2, s[8:11], s23 offen offset:0 sc1
  buffer_load_dwordx4 v[28:31], v2, s[8:11], s23 offen offset:1024 sc1
  buffer_load_dwordx4 v[32:35], v2, s[8:11], s23 offen offset:2048 sc1
  s_waitcnt vmcnt(0)
  v_max3_u32 v68, v8, v9, v10
  v_max3_u32 v68, v68, v11, v12
  v_max3_u32 v68, v68, v13, v14
  v_max3_u32 v68, v68, v15, v16
  v_max3_u32 v68, v68, v17, v18
  v_max3_u32 v68, v68, v19, v20
  v_max3_u32 v68, v68, v21, v22
  v_max3_u32 v68, v68, v23, v24
  v_max3_u32 v68, v68, v25, v26
  v_max3_u32 v68, v68, v27, v28
  v_max3_u32 v68, v68, v29, v30
  v_max3_u32 v68, v68, v31, v32
  v_max3_u32 v68, v68, v33, v34
  v_max_u32 v68, v68, v35
  v_cmp_eq_u32 vcc, -1, v68
  s_cbranch_vccz cB_sc0_rk
  s_add_u32 s30, s30, 1
  s_cmp_lt_u32 s30, 400000
  s_cbranch_scc1 cB_sc0_rv
  s_branch cB_abort
cB_sc0_rk:
  s_mov_b32 s62, 1
  v_mov_b32 v36, 0
  v_mov_b32 v37, 0
  v_mov_b32 v38, 0
  v_mov_b32 v39, 0
  v_mov_b32 v40, 0
  v_mov_b32 v41, 0
  v_mov_b32 v42, 0
  v_mov_b32 v43, 0
  v_mov_b32 v44, 0
  v_mov_b32 v45, 0
  v_mov_b32 v46, 0
  v_mov_b32 v47, 0
  v_mov_b32 v48, 0
  v_mov_b32 v49, 0
  v_mov_b32 v50, 0
  v_mov_b32 v51, 0
  v_mov_b32 v52, 0
  v_mov_b32 v53, 0
  v_mov_b32 v54, 0
  v_mov_b32 v55, 0
  v_mov_b32 v56, 0
  v_mov_b32 v57, 0
  v_mov_b32 v58, 0
  v_mov_b32 v59, 0
  v_mov_b32 v60, 0
  v_mov_b32 v61, 0
  v_mov_b32 v62, 0
  v_mov_b32 v63, 0
  v_mov_b32 v88, 0
  v_mov_b32 v89, 0
  v_mov_b32 v90, 0
  v_mov_b32 v91, 0
  v_mov_b32 v92, 0
  v_mov_b32 v93, 0
  v_mov_b32 v94, 0
  v_mov_b32 v95, 0
  v_mov_b32 v66, 0
  v_mov_b32 v67, 0
  s_add_u32 s31, s31, 1
  ds_read_b128 v[96:99], v117 offset:0
  ds_read_b128 v[100:103], v117 offset:1024
  ds_read_b128 v[104:107], v117 offset:14336
  ds_read_b128 v[108:111], v117 offset:15360
  v_smfmac_f32_16x16x64_bf16 v[36:39], v[8:11], a[0:7], v3
  v_smfmac_f32_16x16x64_bf16 v[40:43], v[8:11], a[56:63], v3
  v_smfmac_f32_16x16x64_bf16 v[44:47], v[8:11], a[112:119], v3
  v_smfmac_f32_16x16x64_bf16 v[48:51], v[8:11], a[168:175], v3
  v_smfmac_f32_16x16x64_bf16 v[52:55], v[8:11], a[224:231], v3
  v_smfmac_f32_16x16x64_bf16 v[56:59], v[8:11], v[144:151], v3
  v_smfmac_f32_16x16x64_bf16 v[60:63], v[8:11], v[200:207], v3
  v_smfmac_f32_16x16x64_bf16 v[36:39], v[12:15], a[8:15], v3
  v_smfmac_f32_16x16x64_bf16 v[40:43], v[12:15], a[64:71], v3
  v_smfmac_f32_16x16x64_bf16 v[44:47], v[12:15], a[120:127], v3
  v_smfmac_f32_16x16x64_bf16 v[48:51], v[12:15], a[176:183], v3
  v_smfmac_f32_16x16x64_bf16 v[52:55], v[12:15], a[232:239], v3
  v_smfmac_f32_16x16x64_bf16 v[56:59], v[12:15], v[152:159], v3
  v_smfmac_f32_16x16x64_bf16 v[60:63], v[12:15], v[208:215], v3
  v_smfmac_f32_16x16x64_bf16 v[36:39], v[16:19], a[16:23], v3
  v_smfmac_f32_16x16x64_bf16 v[40:43], v[16:19], a[72:79], v3
  v_smfmac_f32_16x16x64_bf16 v[44:47], v[16:19], a[128:135], v3
  v_smfmac_f32_16x16x64_bf16 v[48:51], v[16:19], a[184:191], v3
  v_smfmac_f32_16x16x64_bf16 v[52:55], v[16:19], a[240:247], v3
  v_smfmac_f32_16x16x64_bf16 v[56:59], v[16:19], v[160:167], v3
  v_smfmac_f32_16x16x64_bf16 v[60:63], v[16:19], v[216:223], v3
  v_smfmac_f32_16x16x64_bf16 v[36:39], v[20:23], a[24:31], v3
  v_smfmac_f32_16x16x64_bf16 v[40:43], v[20:23], a[80:87], v3
  v_smfmac_f32_16x16x64_bf16 v[44:47], v[20:23], a[136:143], v3
  v_smfmac_f32_16x16x64_bf16 v[48:51], v[20:23], a[192:199], v3
  v_smfmac_f32_16x16x64_bf16 v[52:55], v[20:23], a[248:255], v3
  v_smfmac_f32_16x16x64_bf16 v[56:59], v[20:23], v[168:175], v3
  v_smfmac_f32_16x16x64_bf16 v[60:63], v[20:23], v[224:231], v3
  s_xor_b32 s58, s25, 28672
  s_add_u32 s59, s24, 28672
  s_add_u32 m0, s58, 0
  s_branch cB_sc0_ph2
.p2align 6

cB_sc1_loop:
  s_add_u32 s23, s20, 4096
  s_add_u32 s21, s20, 20480
  v_mov_b32 v48, 0
  v_mov_b32 v49, 0
  v_mov_b32 v50, 0
  v_mov_b32 v51, 0
  v_mov_b32 v52, 0
  v_mov_b32 v53, 0
  v_mov_b32 v54, 0
  v_mov_b32 v55, 0
  v_mov_b32 v56, 0
  v_mov_b32 v57, 0
  v_mov_b32 v58, 0
  v_mov_b32 v59, 0
  v_mov_b32 v60, 0
  v_mov_b32 v61, 0
  v_mov_b32 v62, 0
  v_mov_b32 v63, 0
  v_mov_b32 v88, 0
  v_mov_b32 v89, 0
  v_mov_b32 v90, 0
  v_mov_b32 v91, 0
  v_mov_b32 v92, 0
  v_mov_b32 v93, 0
  v_mov_b32 v94, 0
  v_mov_b32 v95, 0
  v_mov_b32 v64, 0
  v_mov_b32 v65, 0
  s_mov_b32 s30, 0
  s_mov_b32 s62, 0
  s_waitcnt vmcnt(0)
  s_barrier
cB_sc1_ld:
  buffer_load_dwordx4 v[8:11], v2, s[8:11], s20 offen offset:0 sc1
  v_mov_b32 v36, 0
  v_mov_b32 v37, 0
  v_mov_b32 v38, 0
  v_mov_b32 v39, 0
  buffer_load_dwordx4 v[12:15], v2, s[8:11], s20 offen offset:1024 sc1
  v_mov_b32 v40, 0
  v_mov_b32 v41, 0
  v_mov_b32 v42, 0
  v_mov_b32 v43, 0
  buffer_load_dwordx4 v[16:19], v2, s[8:11], s20 offen offset:2048 sc1
  v_mov_b32 v44, 0
  v_mov_b32 v45, 0
  v_mov_b32 v46, 0
  v_mov_b32 v47, 0
  ds_read_b128 v[96:99], v117 offset:0
  ds_read_b128 v[100:103], v117 offset:1024
  ds_read_b128 v[104:107], v117 offset:14336
  ds_read_b128 v[108:111], v117 offset:15360
  s_waitcnt vmcnt(2)
  v_smfmac_f32_16x16x64_bf16 v[36:39], v[8:11], a[0:7], v3
  v_smfmac_f32_16x16x64_bf16 v[40:43], v[8:11], a[56:63], v3
  buffer_load_dwordx4 v[20:23], v2, s[8:11], s20 offen offset:3072 sc1
  v_smfmac_f32_16x16x64_bf16 v[44:47], v[8:11], a[112:119], v3
  v_smfmac_f32_16x16x64_bf16 v[48:51], v[8:11], a[168:175], v3
  v_smfmac_f32_16x16x64_bf16 v[52:55], v[8:11], a[224:231], v3
  buffer_load_dwordx4 v[24:27], v2, s[8:11], s23 offen offset:0 sc1
  v_smfmac_f32_16x16x64_bf16 v[56:59], v[8:11], v[144:151], v3
  v_smfmac_f32_16x16x64_bf16 v[60:63], v[8:11], v[200:207], v3
  s_waitcnt vmcnt(3)
  v_smfmac_f32_16x16x64_bf16 v[36:39], v[12:15], a[8:15], v3
  v_smfmac_f32_16x16x64_bf16 v[40:43], v[12:15], a[64:71], v3
  buffer_load_dwordx4 v[28:31], v2, s[8:11], s23 offen offset:1024 sc1
  v_smfmac_f32_16x16x64_bf16 v[44:47], v[12:15], a[120:127], v3
  v_smfmac_f32_16x16x64_bf16 v[48:51], v[12:15], a[176:183], v3
  v_smfmac_f32_16x16x64_bf16 v[52:55], v[12:15], a[232:239], v3
  buffer_load_dwordx4 v[32:35], v2, s[8:11], s23 offen offset:2048 sc1
  v_smfmac_f32_16x16x64_bf16 v[56:59], v[12:15], v[152:159], v3
  v_smfmac_f32_16x16x64_bf16 v[60:63], v[12:15], v[208:215], v3
  s_waitcnt vmcnt(4)
  v_smfmac_f32_16x16x64_bf16 v[36:39], v[16:19], a[16:23], v3
  s_xor_b32 s58, s25, 28672
  s_add_u32 s59, s24, 28672
  s_add_u32 m0, s58, 7168
  v_smfmac_f32_16x16x64_bf16 v[40:43], v[16:19], a[72:79], v3
  buffer_load_dwordx4 v2, s[8:11], s59 offen offset:0 sc1 lds
  v_smfmac_f32_16x16x64_bf16 v[44:47], v[16:19], a[128:135], v3
  v_smfmac_f32_16x16x64_bf16 v[48:51], v[16:19], a[184:191], v3
  v_smfmac_f32_16x16x64_bf16 v[52:55], v[16:19], a[240:247], v3
  v_smfmac_f32_16x16x64_bf16 v[56:59], v[16:19], v[160:167], v3
  buffer_load_dwordx4 v2, s[8:11], s59 offen offset:1024 sc1 lds
  v_smfmac_f32_16x16x64_bf16 v[60:63], v[16:19], v[216:223], v3
  s_waitcnt vmcnt(5)
  v_smfmac_f32_16x16x64_bf16 v[36:39], v[20:23], a[24:31], v3
  v_smfmac_f32_16x16x64_bf16 v[40:43], v[20:23], a[80:87], v3
  v_smfmac_f32_16x16x64_bf16 v[44:47], v[20:23], a[136:143], v3
  buffer_load_dwordx4 v2, s[8:11], s59 offen offset:2048 sc1 lds
  v_smfmac_f32_16x16x64_bf16 v[48:51], v[20:23], a[192:199], v3
  v_smfmac_f32_16x16x64_bf16 v[52:55], v[20:23], a[248:255], v3
  v_smfmac_f32_16x16x64_bf16 v[56:59], v[20:23], v[168:175], v3
  v_smfmac_f32_16x16x64_bf16 v[60:63], v[20:23], v[224:231], v3
  buffer_load_dwordx4 v2, s[8:11], s59 offen offset:3072 sc1 lds
  s_waitcnt vmcnt(4)
cB_sc1_ph2:
  v_smfmac_f32_16x16x64_bf16 v[60:63], v[24:27], v[232:239], v3
  ds_read_b128 v[16:19], v116 offset:2048
  ds_read_b128 v[20:23], v116 offset:3072
  v_smfmac_f32_16x16x64_bf16 v[60:63], v[28:31], v[240:247], v3
  buffer_load_dword v119, v0, s[8:11], s20 offen sc1
  v_smfmac_f32_16x16x64_bf16 v[60:63], v[32:35], v[248:255], v3
  v_mov_b32 v80, v26
  v_smfmac_f32_16x16x64_bf16 v[52:55], v[24:27], v[120:127], v3
  v_mov_b32 v81, v27
  v_smfmac_f32_16x16x64_bf16 v[52:55], v[28:31], v[128:135], v3
  v_mov_b32 v82, v32
  v_smfmac_f32_16x16x64_bf16 v[52:55], v[32:35], v[136:143], v3
  v_cvt_pk_bf16_f32 v66, v60, v61
  v_smfmac_f32_16x16x64_bf16 v[56:59], v[24:27], v[176:183], v3
  v_cvt_pk_bf16_f32 v67, v62, v63
  v_smfmac_f32_16x16x64_bf16 v[56:59], v[28:31], v[184:191], v3
  v_mov_b32 v83, v33
  v_mfma_f32_16x16x32_bf16 v[68:71], v[64:67], v[4:7], 0
  v_smfmac_f32_16x16x64_bf16 v[56:59], v[32:35], v[192:199], v3
  v_cvt_pk_bf16_f32 v64, v52, v53
  v_smfmac_f32_16x16x64_bf16 v[36:39], v[24:27], a[32:39], v3
  v_cvt_pk_bf16_f32 v65, v54, v55
  v_smfmac_f32_16x16x64_bf16 v[36:39], v[28:31], a[40:47], v3
  v_cvt_pk_bf16_f32 v78, v68, v69
  v_smfmac_f32_16x16x64_bf16 v[36:39], v[32:35], a[48:55], v3
  v_cvt_pk_bf16_f32 v79, v70, v71
  v_cvt_pk_bf16_f32 v66, v56, v57
  v_smfmac_f32_16x16x64_bf16 v[40:43], v[24:27], a[88:95], v3
  v_cvt_pk_bf16_f32 v67, v58, v59
  v_smfmac_f32_16x16x64_bf16 v[40:43], v[28:31], a[96:103], v3
  v_mfma_f32_16x16x32_bf16 v[72:75], v[64:67], v[4:7], 0
  ds_read_b128 v[52:55], v116 offset:16384
  ds_read_b128 v[56:59], v116 offset:17408
  v_smfmac_f32_16x16x64_bf16 v[40:43], v[32:35], a[104:111], v3
  v_cvt_pk_bf16_f32 v64, v36, v37
  v_smfmac_f32_16x16x64_bf16 v[44:47], v[24:27], a[144:151], v3
  v_cvt_pk_bf16_f32 v65, v38, v39
  v_smfmac_f32_16x16x64_bf16 v[44:47], v[28:31], a[152:159], v3
  v_cvt_pk_bf16_f32 v76, v72, v73
  v_smfmac_f32_16x16x64_bf16 v[44:47], v[32:35], a[160:167], v3
  v_cvt_pk_bf16_f32 v77, v74, v75
  v_cvt_pk_bf16_f32 v66, v40, v41
  v_smfmac_f32_16x16x64_bf16 v[48:51], v[24:27], a[200:207], v3
  v_cvt_pk_bf16_f32 v67, v42, v43
  v_smfmac_f32_16x16x64_bf16 v[48:51], v[28:31], a[208:215], v3
  v_mfma_f32_16x16x32_bf16 v[68:71], v[64:67], v[4:7], 0
  v_smfmac_f32_16x16x64_bf16 v[48:51], v[32:35], a[216:223], v3
  v_cvt_pk_bf16_f32 v64, v44, v45
  v_mfma_f32_16x16x32_bf16 v[84:87], v[80:83], v[76:79], 0
  v_cvt_pk_bf16_f32 v65, v46, v47
  s_waitcnt lgkmcnt(0)
  v_smfmac_f32_16x16x64_bf16 v[88:91], v[76:79], v[96:103], v118
  v_cvt_pk_bf16_f32 v60, v68, v69
  v_cvt_pk_bf16_f32 v61, v70, v71
  v_cvt_pk_bf16_f32 v66, v48, v49
  v_cvt_pk_bf16_f32 v67, v50, v51
  s_nop 1
  v_mfma_f32_16x16x32_bf16 v[72:75], v[64:67], v[4:7], 0
  v_smfmac_f32_16x16x64_bf16 v[92:95], v[76:79], v[104:111], v118
  s_nop 4
  v_cvt_pk_bf16_f32 v62, v72, v73
  v_cvt_pk_bf16_f32 v63, v74, v75
  s_nop 1
  v_mfma_f32_16x16x32_bf16 v[84:87], v[12:15], v[60:63], v[84:87]
  v_smfmac_f32_16x16x64_bf16 v[88:91], v[60:63], v[16:23], v118
  v_smfmac_f32_16x16x64_bf16 v[92:95], v[60:63], v[52:59], v118
  s_nop 1
  v_permlane32_swap_b32 v84, v86
  v_permlane32_swap_b32 v85, v87
  s_nop 0
  v_add_f32 v88, v88, v89
  v_add_f32_dpp v84, v86, v84 quad_perm:[1,0,3,2] row_mask:0xf bank_mask:0xf
  v_add_f32_dpp v85, v87, v85 quad_perm:[1,0,3,2] row_mask:0xf bank_mask:0xf
  v_add_f32 v89, v90, v91
  ds_write2_b32 v113, v84, v85 offset0:0 offset1:4
  ds_write2_b32 v112, v88, v89 offset0:0 offset1:128
  v_add_f32 v90, v92, v93
  v_add_f32 v91, v94, v95
  ds_write2_b32 v112, v90, v91 offset0:64 offset1:192
  v_cmp_u_f32 vcc, v88, v89
  s_cbranch_vccnz cB_sc1_retry
cB_sc1_cont:
  s_waitcnt lgkmcnt(0)
  s_barrier
  ds_read_b128 v[36:39], v114
  ds_read_b128 v[44:47], v115
  s_waitcnt lgkmcnt(0)
  v_add_f32 v36, v36, v38
  v_add_f32 v37, v37, v39
  v_add_f32 v44, v44, v45
  v_add_f32 v46, v46, v47
  v_add_f32 v44, v44, v46
  v_add_f32 v36, v36, v37
  v_exp_f32 v49, v44
  v_exp_f32 v48, v36
  v_add_f32 v50, abs(v36), abs(v44)
  v_fma_f32 v39, v49, s37, v48
  v_cmp_ngt_f32 vcc, s56, v50
  v_cndmask_b32 v41, v48, v49, s[38:39]
  v_add_f32_dpp v39, v39, v39 quad_perm:[1,0,3,2] row_mask:0xf bank_mask:0xf
  v_cndmask_b32 v40, v49, v48, s[38:39]
  v_mov_b32_dpp v46, v41 quad_perm:[1,0,3,2] row_mask:0xf bank_mask:0xf
  v_add_f32_dpp v39, v39, v39 quad_perm:[2,3,0,1] row_mask:0xf bank_mask:0xf
  v_cndmask_b32 v42, v46, v40, s[38:39]
  v_cndmask_b32 v43, v40, v46, s[38:39]
  v_add_f32_dpp v39, v39, v39 row_half_mirror row_mask:0xf bank_mask:0xf
  s_cbranch_vccnz cB_sc1_slow
  s_nop 0
  v_add_f32_dpp v47, v39, v39 row_mirror row_mask:0xf bank_mask:0xf
  v_add_f32_dpp v39, v39, v39 row_mirror row_mask:0xf bank_mask:0xf
  s_nop 1
  v_permlane16_swap_b32 v39, v47
  v_add_f32 v39, v39, v47
  v_rcp_f32 v39, v39
  s_mov_b64 exec, s[28:29]
  v_mul_f32 v42, v42, v39
  v_mul_f32 v43, v43, v39
  v_cvt_pk_bf16_f32 v42, v42, v43
cB_sc1_pst:
  buffer_store_dword v42, v1, s[8:11], s20 offen sc1
  s_mov_b64 exec, -1
  s_barrier
  s_add_u32 s24, s24, 28672
  s_add_u32 s35, s35, 28672
  s_xor_b32 s25, s25, 28672
  s_add_u32 m0, s25, 7168
  s_add_u32 m0, s25, 11264
  s_add_u32 s22, s24, 4096
  buffer_load_dwordx4 v2, s[8:11], s22 offen offset:0 sc1 lds
  s_nop 5
  buffer_load_dwordx4 v2, s[8:11], s22 offen offset:1024 sc1 lds
  s_nop 5
  buffer_load_dwordx4 v2, s[8:11], s22 offen offset:2048 sc1 lds
  s_nop 5
  v_xor_b32 v116, 28672, v116
  v_add_u32 v117, s57, v117
  s_sub_u32 s57, 0, s57
  s_add_u32 s19, s19, 1
  s_mov_b32 s20, s21
  s_cmp_lt_u32 s19, 63
  s_cbranch_scc1 cB_sc1_loop
  s_branch cB_done
cB_sc1_slow:
  v_max_f32 v50, v36, v44
  s_nop 1
  v_max_f32_dpp v50, v50, v50 quad_perm:[1,0,3,2] row_mask:0xf bank_mask:0xf
  s_nop 1
  v_max_f32_dpp v50, v50, v50 quad_perm:[2,3,0,1] row_mask:0xf bank_mask:0xf
  s_nop 1
  v_max_f32_dpp v50, v50, v50 row_half_mirror row_mask:0xf bank_mask:0xf
  s_nop 1
  v_max_f32_dpp v50, v50, v50 row_mirror row_mask:0xf bank_mask:0xf
  v_mov_b32 v47, v50
  s_nop 1
  v_permlane16_swap_b32 v50, v47
  v_max_f32 v50, v50, v47
  v_sub_f32 v48, v36, v50
  v_sub_f32 v49, v44, v50
  v_exp_f32 v48, v48
  v_exp_f32 v49, v49
  s_add_u32 s31, s31, 0x100
  v_fma_f32 v39, v49, s37, v48
  v_cndmask_b32 v41, v48, v49, s[38:39]
  s_nop 0
  v_add_f32_dpp v39, v39, v39 quad_perm:[1,0,3,2] row_mask:0xf bank_mask:0xf
  v_cndmask_b32 v40, v49, v48, s[38:39]
  v_mov_b32_dpp v46, v41 quad_perm:[1,0,3,2] row_mask:0xf bank_mask:0xf
  v_add_f32_dpp v39, v39, v39 quad_perm:[2,3,0,1] row_mask:0xf bank_mask:0xf
  v_cndmask_b32 v42, v46, v40, s[38:39]
  v_cndmask_b32 v43, v40, v46, s[38:39]
  v_add_f32_dpp v39, v39, v39 row_half_mirror row_mask:0xf bank_mask:0xf
  s_nop 1
  v_add_f32_dpp v47, v39, v39 row_mirror row_mask:0xf bank_mask:0xf
  v_add_f32_dpp v39, v39, v39 row_mirror row_mask:0xf bank_mask:0xf
  s_nop 1
  v_permlane16_swap_b32 v39, v47
  v_add_f32 v39, v39, v47
  v_rcp_f32 v39, v39
  s_mov_b64 exec, s[28:29]
  v_mul_f32 v42, v42, v39
  v_mul_f32 v43, v43, v39
  v_cvt_pk_bf16_f32 v42, v42, v43
  v_min_u32 v42, -2, v42
  s_branch cB_sc1_pst
cB_sc1_retry:
  s_cmp_lg_u32 s62, 0
  s_cbranch_scc1 cB_sc1_cont
  s_waitcnt vmcnt(0) lgkmcnt(0)
cB_sc1_rv:
  buffer_load_dwordx4 v[8:11], v2, s[8:11], s20 offen offset:0 sc1
  buffer_load_dwordx4 v[12:15], v2, s[8:11], s20 offen offset:1024 sc1
  buffer_load_dwordx4 v[16:19], v2, s[8:11], s20 offen offset:2048 sc1
  buffer_load_dwordx4 v[20:23], v2, s[8:11], s20 offen offset:3072 sc1
  buffer_load_dwordx4 v[24:27], v2, s[8:11], s23 offen offset:0 sc1
  buffer_load_dwordx4 v[28:31], v2, s[8:11], s23 offen offset:1024 sc1
  buffer_load_dwordx4 v[32:35], v2, s[8:11], s23 offen offset:2048 sc1
  s_waitcnt vmcnt(0)
  v_max3_u32 v68, v8, v9, v10
  v_max3_u32 v68, v68, v11, v12
  v_max3_u32 v68, v68, v13, v14
  v_max3_u32 v68, v68, v15, v16
  v_max3_u32 v68, v68, v17, v18
  v_max3_u32 v68, v68, v19, v20
  v_max3_u32 v68, v68, v21, v22
  v_max3_u32 v68, v68, v23, v24
  v_max3_u32 v68, v68, v25, v26
  v_max3_u32 v68, v68, v27, v28
  v_max3_u32 v68, v68, v29, v30
  v_max3_u32 v68, v68, v31, v32
  v_max3_u32 v68, v68, v33, v34
  v_max_u32 v68, v68, v35
  v_cmp_eq_u32 vcc, -1, v68
  s_cbranch_vccz cB_sc1_rk
  s_add_u32 s30, s30, 1
  s_cmp_lt_u32 s30, 400000
  s_cbranch_scc1 cB_sc1_rv
  s_branch cB_abort
cB_sc1_rk:
  s_mov_b32 s62, 1
  v_mov_b32 v36, 0
  v_mov_b32 v37, 0
  v_mov_b32 v38, 0
  v_mov_b32 v39, 0
  v_mov_b32 v40, 0
  v_mov_b32 v41, 0
  v_mov_b32 v42, 0
  v_mov_b32 v43, 0
  v_mov_b32 v44, 0
  v_mov_b32 v45, 0
  v_mov_b32 v46, 0
  v_mov_b32 v47, 0
  v_mov_b32 v48, 0
  v_mov_b32 v49, 0
  v_mov_b32 v50, 0
  v_mov_b32 v51, 0
  v_mov_b32 v52, 0
  v_mov_b32 v53, 0
  v_mov_b32 v54, 0
  v_mov_b32 v55, 0
  v_mov_b32 v56, 0
  v_mov_b32 v57, 0
  v_mov_b32 v58, 0
  v_mov_b32 v59, 0
  v_mov_b32 v60, 0
  v_mov_b32 v61, 0
  v_mov_b32 v62, 0
  v_mov_b32 v63, 0
  v_mov_b32 v88, 0
  v_mov_b32 v89, 0
  v_mov_b32 v90, 0
  v_mov_b32 v91, 0
  v_mov_b32 v92, 0
  v_mov_b32 v93, 0
  v_mov_b32 v94, 0
  v_mov_b32 v95, 0
  v_mov_b32 v64, 0
  v_mov_b32 v65, 0
  s_add_u32 s31, s31, 1
  ds_read_b128 v[96:99], v117 offset:0
  ds_read_b128 v[100:103], v117 offset:1024
  ds_read_b128 v[104:107], v117 offset:14336
  ds_read_b128 v[108:111], v117 offset:15360
  v_smfmac_f32_16x16x64_bf16 v[36:39], v[8:11], a[0:7], v3
  v_smfmac_f32_16x16x64_bf16 v[40:43], v[8:11], a[56:63], v3
  v_smfmac_f32_16x16x64_bf16 v[44:47], v[8:11], a[112:119], v3
  v_smfmac_f32_16x16x64_bf16 v[48:51], v[8:11], a[168:175], v3
  v_smfmac_f32_16x16x64_bf16 v[52:55], v[8:11], a[224:231], v3
  v_smfmac_f32_16x16x64_bf16 v[56:59], v[8:11], v[144:151], v3
  v_smfmac_f32_16x16x64_bf16 v[60:63], v[8:11], v[200:207], v3
  v_smfmac_f32_16x16x64_bf16 v[36:39], v[12:15], a[8:15], v3
  v_smfmac_f32_16x16x64_bf16 v[40:43], v[12:15], a[64:71], v3
  v_smfmac_f32_16x16x64_bf16 v[44:47], v[12:15], a[120:127], v3
  v_smfmac_f32_16x16x64_bf16 v[48:51], v[12:15], a[176:183], v3
  v_smfmac_f32_16x16x64_bf16 v[52:55], v[12:15], a[232:239], v3
  v_smfmac_f32_16x16x64_bf16 v[56:59], v[12:15], v[152:159], v3
  v_smfmac_f32_16x16x64_bf16 v[60:63], v[12:15], v[208:215], v3
  v_smfmac_f32_16x16x64_bf16 v[36:39], v[16:19], a[16:23], v3
  v_smfmac_f32_16x16x64_bf16 v[40:43], v[16:19], a[72:79], v3
  v_smfmac_f32_16x16x64_bf16 v[44:47], v[16:19], a[128:135], v3
  v_smfmac_f32_16x16x64_bf16 v[48:51], v[16:19], a[184:191], v3
  v_smfmac_f32_16x16x64_bf16 v[52:55], v[16:19], a[240:247], v3
  v_smfmac_f32_16x16x64_bf16 v[56:59], v[16:19], v[160:167], v3
  v_smfmac_f32_16x16x64_bf16 v[60:63], v[16:19], v[216:223], v3
  v_smfmac_f32_16x16x64_bf16 v[36:39], v[20:23], a[24:31], v3
  v_smfmac_f32_16x16x64_bf16 v[40:43], v[20:23], a[80:87], v3
  v_smfmac_f32_16x16x64_bf16 v[44:47], v[20:23], a[136:143], v3
  v_smfmac_f32_16x16x64_bf16 v[48:51], v[20:23], a[192:199], v3
  v_smfmac_f32_16x16x64_bf16 v[52:55], v[20:23], a[248:255], v3
  v_smfmac_f32_16x16x64_bf16 v[56:59], v[20:23], v[168:175], v3
  v_smfmac_f32_16x16x64_bf16 v[60:63], v[20:23], v[224:231], v3
  s_xor_b32 s58, s25, 28672
  s_add_u32 s59, s24, 28672
  s_add_u32 m0, s58, 7168
  s_branch cB_sc1_ph2
.p2align 6

cB_sc2_loop:
  s_add_u32 s23, s20, 4096
  s_add_u32 s21, s20, 20480
  v_mov_b32 v48, 0
  v_mov_b32 v49, 0
  v_mov_b32 v50, 0
  v_mov_b32 v51, 0
  v_mov_b32 v52, 0
  v_mov_b32 v53, 0
  v_mov_b32 v54, 0
  v_mov_b32 v55, 0
  v_mov_b32 v56, 0
  v_mov_b32 v57, 0
  v_mov_b32 v58, 0
  v_mov_b32 v59, 0
  v_mov_b32 v60, 0
  v_mov_b32 v61, 0
  v_mov_b32 v62, 0
  v_mov_b32 v63, 0
  v_mov_b32 v88, 0
  v_mov_b32 v89, 0
  v_mov_b32 v90, 0
  v_mov_b32 v91, 0
  v_mov_b32 v92, 0
  v_mov_b32 v93, 0
  v_mov_b32 v94, 0
  v_mov_b32 v95, 0
  v_mov_b32 v66, 0
  v_mov_b32 v67, 0
  s_mov_b32 s30, 0
  s_mov_b32 s62, 0
  s_waitcnt vmcnt(0)
  s_barrier
cB_sc2_ld:
  buffer_load_dwordx4 v[8:11], v2, s[8:11], s20 offen offset:0 sc1
  v_mov_b32 v36, 0
  v_mov_b32 v37, 0
  v_mov_b32 v38, 0
  v_mov_b32 v39, 0
  buffer_load_dwordx4 v[12:15], v2, s[8:11], s20 offen offset:1024 sc1
  v_mov_b32 v40, 0
  v_mov_b32 v41, 0
  v_mov_b32 v42, 0
  v_mov_b32 v43, 0
  buffer_load_dwordx4 v[16:19], v2, s[8:11], s20 offen offset:2048 sc1
  v_mov_b32 v44, 0
  v_mov_b32 v45, 0
  v_mov_b32 v46, 0
  v_mov_b32 v47, 0
  ds_read_b128 v[96:99], v117 offset:0
  ds_read_b128 v[100:103], v117 offset:1024
  ds_read_b128 v[104:107], v117 offset:14336
  ds_read_b128 v[108:111], v117 offset:15360
  s_waitcnt vmcnt(2)
  v_smfmac_f32_16x16x64_bf16 v[36:39], v[8:11], a[0:7], v3
  v_smfmac_f32_16x16x64_bf16 v[40:43], v[8:11], a[56:63], v3
  buffer_load_dwordx4 v[20:23], v2, s[8:11], s20 offen offset:3072 sc1
  v_smfmac_f32_16x16x64_bf16 v[44:47], v[8:11], a[112:119], v3
  v_smfmac_f32_16x16x64_bf16 v[48:51], v[8:11], a[168:175], v3
  v_smfmac_f32_16x16x64_bf16 v[52:55], v[8:11], a[224:231], v3
  buffer_load_dwordx4 v[24:27], v2, s[8:11], s23 offen offset:0 sc1
  v_smfmac_f32_16x16x64_bf16 v[56:59], v[8:11], v[144:151], v3
  v_smfmac_f32_16x16x64_bf16 v[60:63], v[8:11], v[200:207], v3
  s_waitcnt vmcnt(3)
  v_smfmac_f32_16x16x64_bf16 v[36:39], v[12:15], a[8:15], v3
  v_smfmac_f32_16x16x64_bf16 v[40:43], v[12:15], a[64:71], v3
  buffer_load_dwordx4 v[28:31], v2, s[8:11], s23 offen offset:1024 sc1
  v_smfmac_f32_16x16x64_bf16 v[44:47], v[12:15], a[120:127], v3
  v_smfmac_f32_16x16x64_bf16 v[48:51], v[12:15], a[176:183], v3
  v_smfmac_f32_16x16x64_bf16 v[52:55], v[12:15], a[232:239], v3
  buffer_load_dwordx4 v[32:35], v2, s[8:11], s23 offen offset:2048 sc1
  v_smfmac_f32_16x16x64_bf16 v[56:59], v[12:15], v[152:159], v3
  v_smfmac_f32_16x16x64_bf16 v[60:63], v[12:15], v[208:215], v3
  s_waitcnt vmcnt(4)
  v_smfmac_f32_16x16x64_bf16 v[36:39], v[16:19], a[16:23], v3
  v_smfmac_f32_16x16x64_bf16 v[40:43], v[16:19], a[72:79], v3
  s_xor_b32 s58, s25, 28672
  s_add_u32 s59, s24, 28672
  s_add_u32 m0, s58, 14336
  v_smfmac_f32_16x16x64_bf16 v[44:47], v[16:19], a[128:135], v3
  buffer_load_dwordx4 v2, s[8:11], s59 offen offset:0 sc1 lds
  v_smfmac_f32_16x16x64_bf16 v[48:51], v[16:19], a[184:191], v3
  v_smfmac_f32_16x16x64_bf16 v[52:55], v[16:19], a[240:247], v3
  v_smfmac_f32_16x16x64_bf16 v[56:59], v[16:19], v[160:167], v3
  v_smfmac_f32_16x16x64_bf16 v[60:63], v[16:19], v[216:223], v3
  buffer_load_dwordx4 v2, s[8:11], s59 offen offset:1024 sc1 lds
  s_waitcnt vmcnt(5)
  v_smfmac_f32_16x16x64_bf16 v[36:39], v[20:23], a[24:31], v3
  v_smfmac_f32_16x16x64_bf16 v[40:43], v[20:23], a[80:87], v3
  v_smfmac_f32_16x16x64_bf16 v[44:47], v[20:23], a[136:143], v3
  v_smfmac_f32_16x16x64_bf16 v[48:51], v[20:23], a[192:199], v3
  buffer_load_dwordx4 v2, s[8:11], s59 offen offset:2048 sc1 lds
  v_smfmac_f32_16x16x64_bf16 v[52:55], v[20:23], a[248:255], v3
  v_smfmac_f32_16x16x64_bf16 v[56:59], v[20:23], v[168:175], v3
  v_smfmac_f32_16x16x64_bf16 v[60:63], v[20:23], v[224:231], v3
  s_waitcnt vmcnt(3)
cB_sc2_ph2:
  v_smfmac_f32_16x16x64_bf16 v[60:63], v[24:27], v[232:239], v3
  buffer_load_dwordx4 v2, s[8:11], s59 offen offset:3072 sc1 lds
  ds_read_b128 v[8:11], v116 offset:4096
  ds_read_b128 v[12:15], v116 offset:5120
  v_smfmac_f32_16x16x64_bf16 v[60:63], v[28:31], v[240:247], v3
  buffer_load_dword v119, v0, s[8:11], s24 offen sc1
  v_smfmac_f32_16x16x64_bf16 v[60:63], v[32:35], v[248:255], v3
  v_mov_b32 v80, v28
  v_smfmac_f32_16x16x64_bf16 v[52:55], v[24:27], v[120:127], v3
  v_mov_b32 v81, v29
  v_smfmac_f32_16x16x64_bf16 v[52:55], v[28:31], v[128:135], v3
  v_mov_b32 v82, v34
  v_smfmac_f32_16x16x64_bf16 v[52:55], v[32:35], v[136:143], v3
  v_cvt_pk_bf16_f32 v64, v60, v61
  v_smfmac_f32_16x16x64_bf16 v[56:59], v[24:27], v[176:183], v3
  v_cvt_pk_bf16_f32 v65, v62, v63
  v_smfmac_f32_16x16x64_bf16 v[56:59], v[28:31], v[184:191], v3
  v_mov_b32 v83, v35
  v_mfma_f32_16x16x32_bf16 v[68:71], v[64:67], v[4:7], 0
  v_smfmac_f32_16x16x64_bf16 v[56:59], v[32:35], v[192:199], v3
  v_cvt_pk_bf16_f32 v64, v52, v53
  v_smfmac_f32_16x16x64_bf16 v[36:39], v[24:27], a[32:39], v3
  v_cvt_pk_bf16_f32 v65, v54, v55
  v_smfmac_f32_16x16x64_bf16 v[36:39], v[28:31], a[40:47], v3
  v_cvt_pk_bf16_f32 v78, v68, v69
  v_smfmac_f32_16x16x64_bf16 v[36:39], v[32:35], a[48:55], v3
  v_cvt_pk_bf16_f32 v79, v70, v71
  v_cvt_pk_bf16_f32 v66, v56, v57
  v_smfmac_f32_16x16x64_bf16 v[40:43], v[24:27], a[88:95], v3
  v_cvt_pk_bf16_f32 v67, v58, v59
  v_smfmac_f32_16x16x64_bf16 v[40:43], v[28:31], a[96:103], v3
  v_mfma_f32_16x16x32_bf16 v[72:75], v[64:67], v[4:7], 0
  ds_read_b128 v[52:55], v116 offset:18432
  ds_read_b128 v[56:59], v116 offset:19456
  v_smfmac_f32_16x16x64_bf16 v[40:43], v[32:35], a[104:111], v3
  v_cvt_pk_bf16_f32 v64, v36, v37
  v_smfmac_f32_16x16x64_bf16 v[44:47], v[24:27], a[144:151], v3
  v_cvt_pk_bf16_f32 v65, v38, v39
  v_smfmac_f32_16x16x64_bf16 v[44:47], v[28:31], a[152:159], v3
  v_cvt_pk_bf16_f32 v76, v72, v73
  v_smfmac_f32_16x16x64_bf16 v[44:47], v[32:35], a[160:167], v3
  v_cvt_pk_bf16_f32 v77, v74, v75
  v_cvt_pk_bf16_f32 v66, v40, v41
  v_smfmac_f32_16x16x64_bf16 v[48:51], v[24:27], a[200:207], v3
  v_cvt_pk_bf16_f32 v67, v42, v43
  v_smfmac_f32_16x16x64_bf16 v[48:51], v[28:31], a[208:215], v3
  v_mfma_f32_16x16x32_bf16 v[68:71], v[64:67], v[4:7], 0
  v_smfmac_f32_16x16x64_bf16 v[48:51], v[32:35], a[216:223], v3
  v_cvt_pk_bf16_f32 v64, v44, v45
  v_mfma_f32_16x16x32_bf16 v[84:87], v[80:83], v[76:79], 0
  v_cvt_pk_bf16_f32 v65, v46, v47
  s_waitcnt lgkmcnt(0)
  v_smfmac_f32_16x16x64_bf16 v[88:91], v[76:79], v[96:103], v118
  v_cvt_pk_bf16_f32 v60, v68, v69
  v_cvt_pk_bf16_f32 v61, v70, v71
  v_cvt_pk_bf16_f32 v66, v48, v49
  v_cvt_pk_bf16_f32 v67, v50, v51
  s_nop 1
  v_mfma_f32_16x16x32_bf16 v[72:75], v[64:67], v[4:7], 0
  v_smfmac_f32_16x16x64_bf16 v[92:95], v[76:79], v[104:111], v118
  s_nop 4
  v_cvt_pk_bf16_f32 v62, v72, v73
  v_cvt_pk_bf16_f32 v63, v74, v75
  s_nop 1
  v_mfma_f32_16x16x32_bf16 v[84:87], v[16:19], v[60:63], v[84:87]
  v_smfmac_f32_16x16x64_bf16 v[88:91], v[60:63], v[8:15], v118
  v_smfmac_f32_16x16x64_bf16 v[92:95], v[60:63], v[52:59], v118
  s_nop 1
  v_permlane32_swap_b32 v84, v86
  v_permlane32_swap_b32 v85, v87
  s_nop 0
  v_add_f32 v88, v88, v89
  v_add_f32_dpp v84, v86, v84 quad_perm:[1,0,3,2] row_mask:0xf bank_mask:0xf
  v_add_f32_dpp v85, v87, v85 quad_perm:[1,0,3,2] row_mask:0xf bank_mask:0xf
  v_add_f32 v89, v90, v91
  ds_write2_b32 v113, v84, v85 offset0:0 offset1:4
  ds_write2_b32 v112, v88, v89 offset0:0 offset1:128
  v_add_f32 v90, v92, v93
  v_add_f32 v91, v94, v95
  ds_write2_b32 v112, v90, v91 offset0:64 offset1:192
  v_cmp_u_f32 vcc, v88, v89
  s_cbranch_vccnz cB_sc2_retry
cB_sc2_cont:
  s_waitcnt lgkmcnt(0)
  s_barrier
  ds_read_b128 v[36:39], v114
  ds_read_b128 v[44:47], v115
  v_lshl_add_u32 v56, v2, 3, s36
  s_waitcnt lgkmcnt(0)
  v_add_f32 v36, v36, v38
  v_add_f32 v37, v37, v39
  v_add_f32 v44, v44, v45
  s_mov_b64 exec, 15
  buffer_store_dword v2, v56, s[8:11], s20 offen sc1
  s_mov_b64 exec, -1
  v_add_f32 v46, v46, v47
  v_add_f32 v44, v44, v46
  v_add_f32 v36, v36, v37
  v_exp_f32 v49, v44
  v_exp_f32 v48, v36
  v_add_f32 v50, abs(v36), abs(v44)
  v_fma_f32 v39, v49, s37, v48
  v_cmp_ngt_f32 vcc, s56, v50
  v_cndmask_b32 v41, v48, v49, s[38:39]
  v_add_f32_dpp v39, v39, v39 quad_perm:[1,0,3,2] row_mask:0xf bank_mask:0xf
  v_cndmask_b32 v40, v49, v48, s[38:39]
  v_mov_b32_dpp v46, v41 quad_perm:[1,0,3,2] row_mask:0xf bank_mask:0xf
  v_add_f32_dpp v39, v39, v39 quad_perm:[2,3,0,1] row_mask:0xf bank_mask:0xf
  v_cndmask_b32 v42, v46, v40, s[38:39]
  v_cndmask_b32 v43, v40, v46, s[38:39]
  v_add_f32_dpp v39, v39, v39 row_half_mirror row_mask:0xf bank_mask:0xf
  s_cbranch_vccnz cB_sc2_slow
  s_nop 0
  v_add_f32_dpp v47, v39, v39 row_mirror row_mask:0xf bank_mask:0xf
  v_add_f32_dpp v39, v39, v39 row_mirror row_mask:0xf bank_mask:0xf
  s_nop 1
  v_permlane16_swap_b32 v39, v47
  v_add_f32 v39, v39, v47
  v_rcp_f32 v39, v39
  s_mov_b64 exec, s[28:29]
  v_mul_f32 v42, v42, v39
  v_mul_f32 v43, v43, v39
  v_cvt_pk_bf16_f32 v42, v42, v43
cB_sc2_pst:
  buffer_store_dword v42, v1, s[8:11], s20 offen sc1
  s_mov_b64 exec, -1
  s_barrier
  s_add_u32 s24, s24, 28672
  s_add_u32 s35, s35, 28672
  s_xor_b32 s25, s25, 28672
  s_add_u32 m0, s25, 14336
  s_add_u32 m0, s25, 18432
  s_add_u32 s22, s24, 4096
  buffer_load_dwordx4 v2, s[8:11], s22 offen offset:0 sc1 lds
  s_nop 5
  buffer_load_dwordx4 v2, s[8:11], s22 offen offset:1024 sc1 lds
  s_nop 5
  buffer_load_dwordx4 v2, s[8:11], s22 offen offset:2048 sc1 lds
  s_nop 5
  v_xor_b32 v116, 28672, v116
  v_add_u32 v117, s57, v117
  s_sub_u32 s57, 0, s57
  s_add_u32 s19, s19, 1
  s_mov_b32 s20, s21
  s_cmp_lt_u32 s19, 63
  s_cbranch_scc1 cB_sc2_loop
  s_branch cB_done
cB_sc2_slow:
  v_max_f32 v50, v36, v44
  s_nop 1
  v_max_f32_dpp v50, v50, v50 quad_perm:[1,0,3,2] row_mask:0xf bank_mask:0xf
  s_nop 1
  v_max_f32_dpp v50, v50, v50 quad_perm:[2,3,0,1] row_mask:0xf bank_mask:0xf
  s_nop 1
  v_max_f32_dpp v50, v50, v50 row_half_mirror row_mask:0xf bank_mask:0xf
  s_nop 1
  v_max_f32_dpp v50, v50, v50 row_mirror row_mask:0xf bank_mask:0xf
  v_mov_b32 v47, v50
  s_nop 1
  v_permlane16_swap_b32 v50, v47
  v_max_f32 v50, v50, v47
  v_sub_f32 v48, v36, v50
  v_sub_f32 v49, v44, v50
  v_exp_f32 v48, v48
  v_exp_f32 v49, v49
  s_add_u32 s31, s31, 0x100
  v_fma_f32 v39, v49, s37, v48
  v_cndmask_b32 v41, v48, v49, s[38:39]
  s_nop 0
  v_add_f32_dpp v39, v39, v39 quad_perm:[1,0,3,2] row_mask:0xf bank_mask:0xf
  v_cndmask_b32 v40, v49, v48, s[38:39]
  v_mov_b32_dpp v46, v41 quad_perm:[1,0,3,2] row_mask:0xf bank_mask:0xf
  v_add_f32_dpp v39, v39, v39 quad_perm:[2,3,0,1] row_mask:0xf bank_mask:0xf
  v_cndmask_b32 v42, v46, v40, s[38:39]
  v_cndmask_b32 v43, v40, v46, s[38:39]
  v_add_f32_dpp v39, v39, v39 row_half_mirror row_mask:0xf bank_mask:0xf
  s_nop 1
  v_add_f32_dpp v47, v39, v39 row_mirror row_mask:0xf bank_mask:0xf
  v_add_f32_dpp v39, v39, v39 row_mirror row_mask:0xf bank_mask:0xf
  s_nop 1
  v_permlane16_swap_b32 v39, v47
  v_add_f32 v39, v39, v47
  v_rcp_f32 v39, v39
  s_mov_b64 exec, s[28:29]
  v_mul_f32 v42, v42, v39
  v_mul_f32 v43, v43, v39
  v_cvt_pk_bf16_f32 v42, v42, v43
  v_min_u32 v42, -2, v42
  s_branch cB_sc2_pst
cB_sc2_retry:
  s_cmp_lg_u32 s62, 0
  s_cbranch_scc1 cB_sc2_cont
  s_waitcnt vmcnt(0) lgkmcnt(0)
cB_sc2_rv:
  buffer_load_dwordx4 v[8:11], v2, s[8:11], s20 offen offset:0 sc1
  buffer_load_dwordx4 v[12:15], v2, s[8:11], s20 offen offset:1024 sc1
  buffer_load_dwordx4 v[16:19], v2, s[8:11], s20 offen offset:2048 sc1
  buffer_load_dwordx4 v[20:23], v2, s[8:11], s20 offen offset:3072 sc1
  buffer_load_dwordx4 v[24:27], v2, s[8:11], s23 offen offset:0 sc1
  buffer_load_dwordx4 v[28:31], v2, s[8:11], s23 offen offset:1024 sc1
  buffer_load_dwordx4 v[32:35], v2, s[8:11], s23 offen offset:2048 sc1
  s_waitcnt vmcnt(0)
  v_max3_u32 v68, v8, v9, v10
  v_max3_u32 v68, v68, v11, v12
  v_max3_u32 v68, v68, v13, v14
  v_max3_u32 v68, v68, v15, v16
  v_max3_u32 v68, v68, v17, v18
  v_max3_u32 v68, v68, v19, v20
  v_max3_u32 v68, v68, v21, v22
  v_max3_u32 v68, v68, v23, v24
  v_max3_u32 v68, v68, v25, v26
  v_max3_u32 v68, v68, v27, v28
  v_max3_u32 v68, v68, v29, v30
  v_max3_u32 v68, v68, v31, v32
  v_max3_u32 v68, v68, v33, v34
  v_max_u32 v68, v68, v35
  v_cmp_eq_u32 vcc, -1, v68
  s_cbranch_vccz cB_sc2_rk
  s_add_u32 s30, s30, 1
  s_cmp_lt_u32 s30, 400000
  s_cbranch_scc1 cB_sc2_rv
  s_branch cB_abort
cB_sc2_rk:
  s_mov_b32 s62, 1
  v_mov_b32 v36, 0
  v_mov_b32 v37, 0
  v_mov_b32 v38, 0
  v_mov_b32 v39, 0
  v_mov_b32 v40, 0
  v_mov_b32 v41, 0
  v_mov_b32 v42, 0
  v_mov_b32 v43, 0
  v_mov_b32 v44, 0
  v_mov_b32 v45, 0
  v_mov_b32 v46, 0
  v_mov_b32 v47, 0
  v_mov_b32 v48, 0
  v_mov_b32 v49, 0
  v_mov_b32 v50, 0
  v_mov_b32 v51, 0
  v_mov_b32 v52, 0
  v_mov_b32 v53, 0
  v_mov_b32 v54, 0
  v_mov_b32 v55, 0
  v_mov_b32 v56, 0
  v_mov_b32 v57, 0
  v_mov_b32 v58, 0
  v_mov_b32 v59, 0
  v_mov_b32 v60, 0
  v_mov_b32 v61, 0
  v_mov_b32 v62, 0
  v_mov_b32 v63, 0
  v_mov_b32 v88, 0
  v_mov_b32 v89, 0
  v_mov_b32 v90, 0
  v_mov_b32 v91, 0
  v_mov_b32 v92, 0
  v_mov_b32 v93, 0
  v_mov_b32 v94, 0
  v_mov_b32 v95, 0
  v_mov_b32 v66, 0
  v_mov_b32 v67, 0
  s_add_u32 s31, s31, 1
  ds_read_b128 v[96:99], v117 offset:0
  ds_read_b128 v[100:103], v117 offset:1024
  ds_read_b128 v[104:107], v117 offset:14336
  ds_read_b128 v[108:111], v117 offset:15360
  v_smfmac_f32_16x16x64_bf16 v[36:39], v[8:11], a[0:7], v3
  v_smfmac_f32_16x16x64_bf16 v[40:43], v[8:11], a[56:63], v3
  v_smfmac_f32_16x16x64_bf16 v[44:47], v[8:11], a[112:119], v3
  v_smfmac_f32_16x16x64_bf16 v[48:51], v[8:11], a[168:175], v3
  v_smfmac_f32_16x16x64_bf16 v[52:55], v[8:11], a[224:231], v3
  v_smfmac_f32_16x16x64_bf16 v[56:59], v[8:11], v[144:151], v3
  v_smfmac_f32_16x16x64_bf16 v[60:63], v[8:11], v[200:207], v3
  v_smfmac_f32_16x16x64_bf16 v[36:39], v[12:15], a[8:15], v3
  v_smfmac_f32_16x16x64_bf16 v[40:43], v[12:15], a[64:71], v3
  v_smfmac_f32_16x16x64_bf16 v[44:47], v[12:15], a[120:127], v3
  v_smfmac_f32_16x16x64_bf16 v[48:51], v[12:15], a[176:183], v3
  v_smfmac_f32_16x16x64_bf16 v[52:55], v[12:15], a[232:239], v3
  v_smfmac_f32_16x16x64_bf16 v[56:59], v[12:15], v[152:159], v3
  v_smfmac_f32_16x16x64_bf16 v[60:63], v[12:15], v[208:215], v3
  v_smfmac_f32_16x16x64_bf16 v[36:39], v[16:19], a[16:23], v3
  v_smfmac_f32_16x16x64_bf16 v[40:43], v[16:19], a[72:79], v3
  v_smfmac_f32_16x16x64_bf16 v[44:47], v[16:19], a[128:135], v3
  v_smfmac_f32_16x16x64_bf16 v[48:51], v[16:19], a[184:191], v3
  v_smfmac_f32_16x16x64_bf16 v[52:55], v[16:19], a[240:247], v3
  v_smfmac_f32_16x16x64_bf16 v[56:59], v[16:19], v[160:167], v3
  v_smfmac_f32_16x16x64_bf16 v[60:63], v[16:19], v[216:223], v3
  v_smfmac_f32_16x16x64_bf16 v[36:39], v[20:23], a[24:31], v3
  v_smfmac_f32_16x16x64_bf16 v[40:43], v[20:23], a[80:87], v3
  v_smfmac_f32_16x16x64_bf16 v[44:47], v[20:23], a[136:143], v3
  v_smfmac_f32_16x16x64_bf16 v[48:51], v[20:23], a[192:199], v3
  v_smfmac_f32_16x16x64_bf16 v[52:55], v[20:23], a[248:255], v3
  v_smfmac_f32_16x16x64_bf16 v[56:59], v[20:23], v[168:175], v3
  v_smfmac_f32_16x16x64_bf16 v[60:63], v[20:23], v[224:231], v3
  s_xor_b32 s58, s25, 28672
  s_add_u32 s59, s24, 28672
  s_add_u32 m0, s58, 14336
  s_branch cB_sc2_ph2
.p2align 6

cB_sc3_loop:
  s_add_u32 s23, s20, 4096
  s_add_u32 s21, s20, 20480
  v_mov_b32 v48, 0
  v_mov_b32 v49, 0
  v_mov_b32 v50, 0
  v_mov_b32 v51, 0
  v_mov_b32 v52, 0
  v_mov_b32 v53, 0
  v_mov_b32 v54, 0
  v_mov_b32 v55, 0
  v_mov_b32 v56, 0
  v_mov_b32 v57, 0
  v_mov_b32 v58, 0
  v_mov_b32 v59, 0
  v_mov_b32 v60, 0
  v_mov_b32 v61, 0
  v_mov_b32 v62, 0
  v_mov_b32 v63, 0
  v_mov_b32 v88, 0
  v_mov_b32 v89, 0
  v_mov_b32 v90, 0
  v_mov_b32 v91, 0
  v_mov_b32 v92, 0
  v_mov_b32 v93, 0
  v_mov_b32 v94, 0
  v_mov_b32 v95, 0
  v_mov_b32 v64, 0
  v_mov_b32 v65, 0
  s_mov_b32 s30, 0
  s_mov_b32 s62, 0
  s_waitcnt vmcnt(0)
  s_barrier
cB_sc3_ld:
  buffer_load_dwordx4 v[8:11], v2, s[8:11], s20 offen offset:0 sc1
  v_mov_b32 v36, 0
  v_mov_b32 v37, 0
  v_mov_b32 v38, 0
  v_mov_b32 v39, 0
  buffer_load_dwordx4 v[12:15], v2, s[8:11], s20 offen offset:1024 sc1
  v_mov_b32 v40, 0
  v_mov_b32 v41, 0
  v_mov_b32 v42, 0
  v_mov_b32 v43, 0
  buffer_load_dwordx4 v[16:19], v2, s[8:11], s20 offen offset:2048 sc1
  v_mov_b32 v44, 0
  v_mov_b32 v45, 0
  v_mov_b32 v46, 0
  v_mov_b32 v47, 0
  ds_read_b128 v[96:99], v117 offset:0
  ds_read_b128 v[100:103], v117 offset:1024
  ds_read_b128 v[104:107], v117 offset:14336
  ds_read_b128 v[108:111], v117 offset:15360
  s_waitcnt vmcnt(2)
  v_smfmac_f32_16x16x64_bf16 v[36:39], v[8:11], a[0:7], v3
  v_smfmac_f32_16x16x64_bf16 v[40:43], v[8:11], a[56:63], v3
  buffer_load_dwordx4 v[20:23], v2, s[8:11], s20 offen offset:3072 sc1
  v_smfmac_f32_16x16x64_bf16 v[44:47], v[8:11], a[112:119], v3
  v_smfmac_f32_16x16x64_bf16 v[48:51], v[8:11], a[168:175], v3
  v_smfmac_f32_16x16x64_bf16 v[52:55], v[8:11], a[224:231], v3
  buffer_load_dwordx4 v[24:27], v2, s[8:11], s23 offen offset:0 sc1
  v_smfmac_f32_16x16x64_bf16 v[56:59], v[8:11], v[144:151], v3
  v_smfmac_f32_16x16x64_bf16 v[60:63], v[8:11], v[200:207], v3
  s_waitcnt vmcnt(3)
  v_smfmac_f32_16x16x64_bf16 v[36:39], v[12:15], a[8:15], v3
  v_smfmac_f32_16x16x64_bf16 v[40:43], v[12:15], a[64:71], v3
  buffer_load_dwordx4 v[28:31], v2, s[8:11], s23 offen offset:1024 sc1
  v_smfmac_f32_16x16x64_bf16 v[44:47], v[12:15], a[120:127], v3
  v_smfmac_f32_16x16x64_bf16 v[48:51], v[12:15], a[176:183], v3
  v_smfmac_f32_16x16x64_bf16 v[52:55], v[12:15], a[232:239], v3
  buffer_load_dwordx4 v[32:35], v2, s[8:11], s23 offen offset:2048 sc1
  v_smfmac_f32_16x16x64_bf16 v[56:59], v[12:15], v[152:159], v3
  v_smfmac_f32_16x16x64_bf16 v[60:63], v[12:15], v[208:215], v3
  s_waitcnt vmcnt(4)
  v_smfmac_f32_16x16x64_bf16 v[36:39], v[16:19], a[16:23], v3
  v_smfmac_f32_16x16x64_bf16 v[40:43], v[16:19], a[72:79], v3
  v_smfmac_f32_16x16x64_bf16 v[44:47], v[16:19], a[128:135], v3
  s_xor_b32 s58, s25, 28672
  s_add_u32 s59, s24, 28672
  s_add_u32 m0, s58, 21504
  v_smfmac_f32_16x16x64_bf16 v[48:51], v[16:19], a[184:191], v3
  buffer_load_dwordx4 v2, s[8:11], s59 offen offset:0 sc1 lds
  v_smfmac_f32_16x16x64_bf16 v[52:55], v[16:19], a[240:247], v3
  v_smfmac_f32_16x16x64_bf16 v[56:59], v[16:19], v[160:167], v3
  v_smfmac_f32_16x16x64_bf16 v[60:63], v[16:19], v[216:223], v3
  s_waitcnt vmcnt(4)
  v_smfmac_f32_16x16x64_bf16 v[36:39], v[20:23], a[24:31], v3
  buffer_load_dwordx4 v2, s[8:11], s59 offen offset:1024 sc1 lds
  v_smfmac_f32_16x16x64_bf16 v[40:43], v[20:23], a[80:87], v3
  v_smfmac_f32_16x16x64_bf16 v[44:47], v[20:23], a[136:143], v3
  v_smfmac_f32_16x16x64_bf16 v[48:51], v[20:23], a[192:199], v3
  v_smfmac_f32_16x16x64_bf16 v[52:55], v[20:23], a[248:255], v3
  buffer_load_dwordx4 v2, s[8:11], s59 offen offset:2048 sc1 lds
  v_smfmac_f32_16x16x64_bf16 v[56:59], v[20:23], v[168:175], v3
  v_smfmac_f32_16x16x64_bf16 v[60:63], v[20:23], v[224:231], v3
  s_waitcnt vmcnt(3)
cB_sc3_ph2:
  v_smfmac_f32_16x16x64_bf16 v[60:63], v[24:27], v[232:239], v3
  ds_read_b128 v[8:11], v116 offset:6144
  ds_read_b128 v[12:15], v116 offset:7168
  v_smfmac_f32_16x16x64_bf16 v[60:63], v[28:31], v[240:247], v3
  buffer_load_dwordx4 v2, s[8:11], s59 offen offset:3072 sc1 lds
  v_smfmac_f32_16x16x64_bf16 v[60:63], v[32:35], v[248:255], v3
  v_mov_b32 v80, v30
  v_smfmac_f32_16x16x64_bf16 v[52:55], v[24:27], v[120:127], v3
  v_mov_b32 v81, v31
  v_smfmac_f32_16x16x64_bf16 v[52:55], v[28:31], v[128:135], v3
  v_mov_b32 v82, v34
  v_smfmac_f32_16x16x64_bf16 v[52:55], v[32:35], v[136:143], v3
  v_cvt_pk_bf16_f32 v66, v60, v61
  v_smfmac_f32_16x16x64_bf16 v[56:59], v[24:27], v[176:183], v3
  v_cvt_pk_bf16_f32 v67, v62, v63
  v_smfmac_f32_16x16x64_bf16 v[56:59], v[28:31], v[184:191], v3
  v_mov_b32 v83, v35
  v_mfma_f32_16x16x32_bf16 v[68:71], v[64:67], v[4:7], 0
  v_smfmac_f32_16x16x64_bf16 v[56:59], v[32:35], v[192:199], v3
  v_cvt_pk_bf16_f32 v64, v52, v53
  v_smfmac_f32_16x16x64_bf16 v[36:39], v[24:27], a[32:39], v3
  v_cvt_pk_bf16_f32 v65, v54, v55
  v_smfmac_f32_16x16x64_bf16 v[36:39], v[28:31], a[40:47], v3
  v_cvt_pk_bf16_f32 v78, v68, v69
  v_smfmac_f32_16x16x64_bf16 v[36:39], v[32:35], a[48:55], v3
  v_cvt_pk_bf16_f32 v79, v70, v71
  v_cvt_pk_bf16_f32 v66, v56, v57
  v_smfmac_f32_16x16x64_bf16 v[40:43], v[24:27], a[88:95], v3
  v_cvt_pk_bf16_f32 v67, v58, v59
  v_smfmac_f32_16x16x64_bf16 v[40:43], v[28:31], a[96:103], v3
  v_mfma_f32_16x16x32_bf16 v[72:75], v[64:67], v[4:7], 0
  ds_read_b128 v[52:55], v116 offset:20480
  ds_read_b128 v[56:59], v116 offset:21504
  v_smfmac_f32_16x16x64_bf16 v[40:43], v[32:35], a[104:111], v3
  v_cvt_pk_bf16_f32 v64, v36, v37
  v_smfmac_f32_16x16x64_bf16 v[44:47], v[24:27], a[144:151], v3
  v_cvt_pk_bf16_f32 v65, v38, v39
  v_smfmac_f32_16x16x64_bf16 v[44:47], v[28:31], a[152:159], v3
  v_cvt_pk_bf16_f32 v76, v72, v73
  v_smfmac_f32_16x16x64_bf16 v[44:47], v[32:35], a[160:167], v3
  v_cvt_pk_bf16_f32 v77, v74, v75
  v_cvt_pk_bf16_f32 v66, v40, v41
  v_smfmac_f32_16x16x64_bf16 v[48:51], v[24:27], a[200:207], v3
  v_cvt_pk_bf16_f32 v67, v42, v43
  v_smfmac_f32_16x16x64_bf16 v[48:51], v[28:31], a[208:215], v3
  v_mfma_f32_16x16x32_bf16 v[68:71], v[64:67], v[4:7], 0
  v_smfmac_f32_16x16x64_bf16 v[48:51], v[32:35], a[216:223], v3
  v_cvt_pk_bf16_f32 v64, v44, v45
  v_mfma_f32_16x16x32_bf16 v[84:87], v[80:83], v[76:79], 0
  v_cvt_pk_bf16_f32 v65, v46, v47
  s_waitcnt lgkmcnt(0)
  v_smfmac_f32_16x16x64_bf16 v[88:91], v[76:79], v[96:103], v118
  v_cvt_pk_bf16_f32 v60, v68, v69
  v_cvt_pk_bf16_f32 v61, v70, v71
  v_cvt_pk_bf16_f32 v66, v48, v49
  v_cvt_pk_bf16_f32 v67, v50, v51
  s_nop 1
  v_mfma_f32_16x16x32_bf16 v[72:75], v[64:67], v[4:7], 0
  v_smfmac_f32_16x16x64_bf16 v[92:95], v[76:79], v[104:111], v118
  s_nop 4
  v_cvt_pk_bf16_f32 v62, v72, v73
  v_cvt_pk_bf16_f32 v63, v74, v75
  s_nop 1
  v_mfma_f32_16x16x32_bf16 v[84:87], v[20:23], v[60:63], v[84:87]
  v_smfmac_f32_16x16x64_bf16 v[88:91], v[60:63], v[8:15], v118
  v_smfmac_f32_16x16x64_bf16 v[92:95], v[60:63], v[52:59], v118
  s_nop 1
  v_permlane32_swap_b32 v84, v86
  v_permlane32_swap_b32 v85, v87
  s_nop 0
  v_add_f32 v88, v88, v89
  v_add_f32_dpp v84, v86, v84 quad_perm:[1,0,3,2] row_mask:0xf bank_mask:0xf
  v_add_f32_dpp v85, v87, v85 quad_perm:[1,0,3,2] row_mask:0xf bank_mask:0xf
  v_add_f32 v89, v90, v91
  ds_write2_b32 v113, v84, v85 offset0:0 offset1:4
  ds_write2_b32 v112, v88, v89 offset0:0 offset1:128
  v_add_f32 v90, v92, v93
  v_add_f32 v91, v94, v95
  ds_write2_b32 v112, v90, v91 offset0:64 offset1:192
  v_cmp_u_f32 vcc, v88, v89
  s_cbranch_vccnz cB_sc3_retry
cB_sc3_cont:
  s_waitcnt lgkmcnt(0)
  s_barrier
  ds_read_b128 v[36:39], v114
  ds_read_b128 v[44:47], v115
  s_waitcnt lgkmcnt(0)
  v_add_f32 v36, v36, v38
  v_add_f32 v37, v37, v39
  v_add_f32 v44, v44, v45
  v_add_f32 v46, v46, v47
  v_add_f32 v44, v44, v46
  v_add_f32 v36, v36, v37
  v_exp_f32 v49, v44
  v_exp_f32 v48, v36
  v_add_f32 v50, abs(v36), abs(v44)
  v_fma_f32 v39, v49, s37, v48
  v_cmp_ngt_f32 vcc, s56, v50
  v_cndmask_b32 v41, v48, v49, s[38:39]
  v_add_f32_dpp v39, v39, v39 quad_perm:[1,0,3,2] row_mask:0xf bank_mask:0xf
  v_cndmask_b32 v40, v49, v48, s[38:39]
  v_mov_b32_dpp v46, v41 quad_perm:[1,0,3,2] row_mask:0xf bank_mask:0xf
  v_add_f32_dpp v39, v39, v39 quad_perm:[2,3,0,1] row_mask:0xf bank_mask:0xf
  v_cndmask_b32 v42, v46, v40, s[38:39]
  v_cndmask_b32 v43, v40, v46, s[38:39]
  v_add_f32_dpp v39, v39, v39 row_half_mirror row_mask:0xf bank_mask:0xf
  s_cbranch_vccnz cB_sc3_slow
  s_nop 0
  v_add_f32_dpp v47, v39, v39 row_mirror row_mask:0xf bank_mask:0xf
  v_add_f32_dpp v39, v39, v39 row_mirror row_mask:0xf bank_mask:0xf
  s_nop 1
  v_permlane16_swap_b32 v39, v47
  v_add_f32 v39, v39, v47
  v_rcp_f32 v39, v39
  s_mov_b64 exec, s[28:29]
  v_mul_f32 v42, v42, v39
  v_mul_f32 v43, v43, v39
  v_cvt_pk_bf16_f32 v42, v42, v43
cB_sc3_pst:
  buffer_store_dword v42, v1, s[8:11], s20 offen sc1
  s_mov_b64 exec, -1
  s_barrier
  s_add_u32 s24, s24, 28672
  s_add_u32 s35, s35, 28672
  s_xor_b32 s25, s25, 28672
  s_add_u32 m0, s25, 21504
  s_add_u32 m0, s25, 25600
  s_add_u32 s22, s24, 4096
  buffer_load_dwordx4 v2, s[8:11], s22 offen offset:0 sc1 lds
  s_nop 5
  buffer_load_dwordx4 v2, s[8:11], s22 offen offset:1024 sc1 lds
  s_nop 5
  buffer_load_dwordx4 v2, s[8:11], s22 offen offset:2048 sc1 lds
  s_nop 5
  v_xor_b32 v116, 28672, v116
  v_add_u32 v117, s57, v117
  s_sub_u32 s57, 0, s57
  s_add_u32 s19, s19, 1
  s_mov_b32 s20, s21
  s_cmp_lt_u32 s19, 63
  s_cbranch_scc1 cB_sc3_loop
  s_branch cB_done
cB_sc3_slow:
  v_max_f32 v50, v36, v44
  s_nop 1
  v_max_f32_dpp v50, v50, v50 quad_perm:[1,0,3,2] row_mask:0xf bank_mask:0xf
  s_nop 1
  v_max_f32_dpp v50, v50, v50 quad_perm:[2,3,0,1] row_mask:0xf bank_mask:0xf
  s_nop 1
  v_max_f32_dpp v50, v50, v50 row_half_mirror row_mask:0xf bank_mask:0xf
  s_nop 1
  v_max_f32_dpp v50, v50, v50 row_mirror row_mask:0xf bank_mask:0xf
  v_mov_b32 v47, v50
  s_nop 1
  v_permlane16_swap_b32 v50, v47
  v_max_f32 v50, v50, v47
  v_sub_f32 v48, v36, v50
  v_sub_f32 v49, v44, v50
  v_exp_f32 v48, v48
  v_exp_f32 v49, v49
  s_add_u32 s31, s31, 0x100
  v_fma_f32 v39, v49, s37, v48
  v_cndmask_b32 v41, v48, v49, s[38:39]
  s_nop 0
  v_add_f32_dpp v39, v39, v39 quad_perm:[1,0,3,2] row_mask:0xf bank_mask:0xf
  v_cndmask_b32 v40, v49, v48, s[38:39]
  v_mov_b32_dpp v46, v41 quad_perm:[1,0,3,2] row_mask:0xf bank_mask:0xf
  v_add_f32_dpp v39, v39, v39 quad_perm:[2,3,0,1] row_mask:0xf bank_mask:0xf
  v_cndmask_b32 v42, v46, v40, s[38:39]
  v_cndmask_b32 v43, v40, v46, s[38:39]
  v_add_f32_dpp v39, v39, v39 row_half_mirror row_mask:0xf bank_mask:0xf
  s_nop 1
  v_add_f32_dpp v47, v39, v39 row_mirror row_mask:0xf bank_mask:0xf
  v_add_f32_dpp v39, v39, v39 row_mirror row_mask:0xf bank_mask:0xf
  s_nop 1
  v_permlane16_swap_b32 v39, v47
  v_add_f32 v39, v39, v47
  v_rcp_f32 v39, v39
  s_mov_b64 exec, s[28:29]
  v_mul_f32 v42, v42, v39
  v_mul_f32 v43, v43, v39
  v_cvt_pk_bf16_f32 v42, v42, v43
  v_min_u32 v42, -2, v42
  s_branch cB_sc3_pst
cB_sc3_retry:
  s_cmp_lg_u32 s62, 0
  s_cbranch_scc1 cB_sc3_cont
  s_waitcnt vmcnt(0) lgkmcnt(0)
cB_sc3_rv:
  buffer_load_dwordx4 v[8:11], v2, s[8:11], s20 offen offset:0 sc1
  buffer_load_dwordx4 v[12:15], v2, s[8:11], s20 offen offset:1024 sc1
  buffer_load_dwordx4 v[16:19], v2, s[8:11], s20 offen offset:2048 sc1
  buffer_load_dwordx4 v[20:23], v2, s[8:11], s20 offen offset:3072 sc1
  buffer_load_dwordx4 v[24:27], v2, s[8:11], s23 offen offset:0 sc1
  buffer_load_dwordx4 v[28:31], v2, s[8:11], s23 offen offset:1024 sc1
  buffer_load_dwordx4 v[32:35], v2, s[8:11], s23 offen offset:2048 sc1
  s_waitcnt vmcnt(0)
  v_max3_u32 v68, v8, v9, v10
  v_max3_u32 v68, v68, v11, v12
  v_max3_u32 v68, v68, v13, v14
  v_max3_u32 v68, v68, v15, v16
  v_max3_u32 v68, v68, v17, v18
  v_max3_u32 v68, v68, v19, v20
  v_max3_u32 v68, v68, v21, v22
  v_max3_u32 v68, v68, v23, v24
  v_max3_u32 v68, v68, v25, v26
  v_max3_u32 v68, v68, v27, v28
  v_max3_u32 v68, v68, v29, v30
  v_max3_u32 v68, v68, v31, v32
  v_max3_u32 v68, v68, v33, v34
  v_max_u32 v68, v68, v35
  v_cmp_eq_u32 vcc, -1, v68
  s_cbranch_vccz cB_sc3_rk
  s_add_u32 s30, s30, 1
  s_cmp_lt_u32 s30, 400000
  s_cbranch_scc1 cB_sc3_rv
  s_branch cB_abort
cB_sc3_rk:
  s_mov_b32 s62, 1
  v_mov_b32 v36, 0
  v_mov_b32 v37, 0
  v_mov_b32 v38, 0
  v_mov_b32 v39, 0
  v_mov_b32 v40, 0
  v_mov_b32 v41, 0
  v_mov_b32 v42, 0
  v_mov_b32 v43, 0
  v_mov_b32 v44, 0
  v_mov_b32 v45, 0
  v_mov_b32 v46, 0
  v_mov_b32 v47, 0
  v_mov_b32 v48, 0
  v_mov_b32 v49, 0
  v_mov_b32 v50, 0
  v_mov_b32 v51, 0
  v_mov_b32 v52, 0
  v_mov_b32 v53, 0
  v_mov_b32 v54, 0
  v_mov_b32 v55, 0
  v_mov_b32 v56, 0
  v_mov_b32 v57, 0
  v_mov_b32 v58, 0
  v_mov_b32 v59, 0
  v_mov_b32 v60, 0
  v_mov_b32 v61, 0
  v_mov_b32 v62, 0
  v_mov_b32 v63, 0
  v_mov_b32 v88, 0
  v_mov_b32 v89, 0
  v_mov_b32 v90, 0
  v_mov_b32 v91, 0
  v_mov_b32 v92, 0
  v_mov_b32 v93, 0
  v_mov_b32 v94, 0
  v_mov_b32 v95, 0
  v_mov_b32 v64, 0
  v_mov_b32 v65, 0
  s_add_u32 s31, s31, 1
  ds_read_b128 v[96:99], v117 offset:0
  ds_read_b128 v[100:103], v117 offset:1024
  ds_read_b128 v[104:107], v117 offset:14336
  ds_read_b128 v[108:111], v117 offset:15360
  v_smfmac_f32_16x16x64_bf16 v[36:39], v[8:11], a[0:7], v3
  v_smfmac_f32_16x16x64_bf16 v[40:43], v[8:11], a[56:63], v3
  v_smfmac_f32_16x16x64_bf16 v[44:47], v[8:11], a[112:119], v3
  v_smfmac_f32_16x16x64_bf16 v[48:51], v[8:11], a[168:175], v3
  v_smfmac_f32_16x16x64_bf16 v[52:55], v[8:11], a[224:231], v3
  v_smfmac_f32_16x16x64_bf16 v[56:59], v[8:11], v[144:151], v3
  v_smfmac_f32_16x16x64_bf16 v[60:63], v[8:11], v[200:207], v3
  v_smfmac_f32_16x16x64_bf16 v[36:39], v[12:15], a[8:15], v3
  v_smfmac_f32_16x16x64_bf16 v[40:43], v[12:15], a[64:71], v3
  v_smfmac_f32_16x16x64_bf16 v[44:47], v[12:15], a[120:127], v3
  v_smfmac_f32_16x16x64_bf16 v[48:51], v[12:15], a[176:183], v3
  v_smfmac_f32_16x16x64_bf16 v[52:55], v[12:15], a[232:239], v3
  v_smfmac_f32_16x16x64_bf16 v[56:59], v[12:15], v[152:159], v3
  v_smfmac_f32_16x16x64_bf16 v[60:63], v[12:15], v[208:215], v3
  v_smfmac_f32_16x16x64_bf16 v[36:39], v[16:19], a[16:23], v3
  v_smfmac_f32_16x16x64_bf16 v[40:43], v[16:19], a[72:79], v3
  v_smfmac_f32_16x16x64_bf16 v[44:47], v[16:19], a[128:135], v3
  v_smfmac_f32_16x16x64_bf16 v[48:51], v[16:19], a[184:191], v3
  v_smfmac_f32_16x16x64_bf16 v[52:55], v[16:19], a[240:247], v3
  v_smfmac_f32_16x16x64_bf16 v[56:59], v[16:19], v[160:167], v3
  v_smfmac_f32_16x16x64_bf16 v[60:63], v[16:19], v[216:223], v3
  v_smfmac_f32_16x16x64_bf16 v[36:39], v[20:23], a[24:31], v3
  v_smfmac_f32_16x16x64_bf16 v[40:43], v[20:23], a[80:87], v3
  v_smfmac_f32_16x16x64_bf16 v[44:47], v[20:23], a[136:143], v3
  v_smfmac_f32_16x16x64_bf16 v[48:51], v[20:23], a[192:199], v3
  v_smfmac_f32_16x16x64_bf16 v[52:55], v[20:23], a[248:255], v3
  v_smfmac_f32_16x16x64_bf16 v[56:59], v[20:23], v[168:175], v3
  v_smfmac_f32_16x16x64_bf16 v[60:63], v[20:23], v[224:231], v3
  s_xor_b32 s58, s25, 28672
  s_add_u32 s59, s24, 28672
  s_add_u32 m0, s58, 21504
  s_branch cB_sc3_ph2
.p2align 6

cB_va0_loop:
  s_add_u32 s23, s20, 4096
  s_add_u32 s21, s20, 20480
  s_mov_b32 s30, 0
  s_cmp_lg_u32 s19, s38
  s_cbranch_scc1 cB_va0_vok
  s_branch cB_va0_voc
cB_va0_vow:
  s_sub_u32 s22, s39, s35
  v_lshlrev_b32 v63, 7, v2
  v_min_u32 v63, s22, v63
  buffer_load_dword v63, v63, s[8:11], s35 offen sc1
  s_waitcnt vmcnt(0)
cB_va0_voc:
  v_readfirstlane_b32 s22, v63
  s_cmp_eq_u32 s22, 56
  s_cbranch_scc1 cB_va0_vod
  s_sleep 1
  s_add_u32 s30, s30, 1
  s_cmp_lt_u32 s30, 400000
  s_cbranch_scc1 cB_va0_vow
  s_branch cB_abort
cB_va0_vod:
  s_add_u32 s35, s35, 2048
  s_add_u32 s38, s19, 8
  s_and_b32 s38, s38, -8
  s_cmp_eq_u32 s19, 0
  s_cselect_b32 s38, 4, s38
  v_cmp_ne_u32 vcc, 56, v63
  s_nop 3
  s_cmp_eq_u64 vcc, 0
  s_cselect_b32 s38, 99, s38
cB_va0_vok:
  s_cmp_eq_u32 s19, 63
  s_cbranch_scc1 cB_done
  s_barrier
  s_add_u32 s22, s25, 0
  buffer_load_dwordx4 v[80:83], v6, s[8:11], s22 offen offset:0 sc1
  buffer_load_dwordx4 v[84:87], v6, s[8:11], s22 offen offset:1792 sc1
  s_add_u32 s22, s25, 3584
  buffer_load_dwordx4 v[88:91], v6, s[8:11], s22 offen offset:0 sc1
  buffer_load_dwordx4 v[92:95], v6, s[8:11], s22 offen offset:1792 sc1
  s_add_u32 s22, s25, 7168
  buffer_load_dwordx4 v[96:99], v6, s[8:11], s22 offen offset:0 sc1
  buffer_load_dwordx4 v[100:103], v6, s[8:11], s22 offen offset:1792 sc1
  s_add_u32 s22, s25, 10752
  buffer_load_dwordx4 v[104:107], v6, s[8:11], s22 offen offset:0 sc1
  buffer_load_dwordx4 v[108:111], v6, s[8:11], s22 offen offset:1792 sc1
  s_add_u32 s22, s25, 14336
  buffer_load_dwordx4 v[112:115], v6, s[8:11], s22 offen offset:0 sc1
  buffer_load_dwordx4 v[116:119], v6, s[8:11], s22 offen offset:1792 sc1
  s_add_u32 s22, s25, 17920
  buffer_load_dwordx4 v[120:123], v6, s[8:11], s22 offen offset:0 sc1
  buffer_load_dwordx4 v[124:127], v6, s[8:11], s22 offen offset:1792 sc1
  s_add_u32 s22, s19, 1
  s_cmp_lg_u32 s22, s38
  s_cbranch_scc1 cB_va0_nk
  s_sub_u32 s22, s39, s35
  v_lshlrev_b32 v63, 7, v2
  v_min_u32 v63, s22, v63
  buffer_load_dword v63, v63, s[8:11], s35 offen sc1
cB_va0_nk:
  s_barrier
  ds_read_b128 v[8:11], v0 offset:8192
  ds_read_b128 v[12:15], v0 offset:9216
  ds_read_b128 v[16:19], v0 offset:10240
  ds_read_b128 v[20:23], v0 offset:11264
  ds_read_b128 v[24:27], v0 offset:12288
  ds_read_b128 v[28:31], v0 offset:13312
  ds_read_b128 v[32:35], v0 offset:14336
  s_waitcnt lgkmcnt(0)
  v_smfmac_f32_16x16x64_bf16 v[36:39], v[8:11], a[0:7], v3
  s_add_u32 s22, s25, 21504
  buffer_load_dwordx4 v[128:131], v6, s[8:11], s22 offen offset:0 sc1
  v_smfmac_f32_16x16x64_bf16 v[36:39], v[12:15], a[8:15], v3
  v_smfmac_f32_16x16x64_bf16 v[36:39], v[16:19], a[16:23], v3
  s_add_u32 s22, s25, 21504
  buffer_load_dwordx4 v[132:135], v6, s[8:11], s22 offen offset:1792 sc1
  v_smfmac_f32_16x16x64_bf16 v[36:39], v[20:23], a[24:31], v3
  v_smfmac_f32_16x16x64_bf16 v[36:39], v[24:27], a[32:39], v3
  s_add_u32 s22, s25, 25088
  buffer_load_dwordx4 v[136:139], v6, s[8:11], s22 offen offset:0 sc1
  v_smfmac_f32_16x16x64_bf16 v[36:39], v[28:31], a[40:47], v3
  v_smfmac_f32_16x16x64_bf16 v[36:39], v[32:35], a[48:55], v3
  s_add_u32 s22, s25, 25088
  buffer_load_dwordx4 v[140:143], v6, s[8:11], s22 offen offset:1792 sc1
  v_smfmac_f32_16x16x64_bf16 v[40:43], v[8:11], a[56:63], v3
  v_smfmac_f32_16x16x64_bf16 v[40:43], v[12:15], a[64:71], v3
  v_smfmac_f32_16x16x64_bf16 v[40:43], v[16:19], a[72:79], v3
  v_add_f32 v36, v36, v37
  v_smfmac_f32_16x16x64_bf16 v[40:43], v[20:23], a[80:87], v3
  v_add_f32 v38, v38, v39
  v_smfmac_f32_16x16x64_bf16 v[40:43], v[24:27], a[88:95], v3
  v_cvt_pk_bf16_f32 v36, v36, v38
  v_smfmac_f32_16x16x64_bf16 v[40:43], v[28:31], a[96:103], v3
  ds_write_b32 v60, v36
  v_smfmac_f32_16x16x64_bf16 v[40:43], v[32:35], a[104:111], v3
  v_smfmac_f32_16x16x64_bf16 v[44:47], v[8:11], a[112:119], v3
  v_smfmac_f32_16x16x64_bf16 v[44:47], v[12:15], a[120:127], v3
  v_smfmac_f32_16x16x64_bf16 v[44:47], v[16:19], a[128:135], v3
  v_add_f32 v40, v40, v41
  v_smfmac_f32_16x16x64_bf16 v[44:47], v[20:23], a[136:143], v3
  v_add_f32 v42, v42, v43
  v_smfmac_f32_16x16x64_bf16 v[44:47], v[24:27], a[144:151], v3
  v_cvt_pk_bf16_f32 v40, v40, v42
  v_smfmac_f32_16x16x64_bf16 v[44:47], v[28:31], a[152:159], v3
  ds_write_b32 v61, v40
  v_smfmac_f32_16x16x64_bf16 v[44:47], v[32:35], a[160:167], v3
  v_smfmac_f32_16x16x64_bf16 v[48:51], v[8:11], a[168:175], v3
  v_smfmac_f32_16x16x64_bf16 v[48:51], v[12:15], a[176:183], v3
  v_smfmac_f32_16x16x64_bf16 v[48:51], v[16:19], a[184:191], v3
  v_add_f32 v44, v44, v45
  v_smfmac_f32_16x16x64_bf16 v[48:51], v[20:23], a[192:199], v3
  v_add_f32 v46, v46, v47
  v_smfmac_f32_16x16x64_bf16 v[48:51], v[24:27], a[200:207], v3
  v_cvt_pk_bf16_f32 v44, v44, v46
  v_smfmac_f32_16x16x64_bf16 v[48:51], v[28:31], a[208:215], v3
  ds_write_b32 v62, v44
  v_smfmac_f32_16x16x64_bf16 v[48:51], v[32:35], a[216:223], v3
  v_smfmac_f32_16x16x64_bf16 v[52:55], v[8:11], a[224:231], v3
  v_smfmac_f32_16x16x64_bf16 v[52:55], v[12:15], a[232:239], v3
  v_smfmac_f32_16x16x64_bf16 v[52:55], v[16:19], a[240:247], v3
  v_add_f32 v48, v48, v49
  v_smfmac_f32_16x16x64_bf16 v[52:55], v[20:23], a[248:255], v3
  v_add_f32 v50, v50, v51
  v_smfmac_f32_16x16x64_bf16 v[52:55], v[24:27], v[176:183], v3
  v_cvt_pk_bf16_f32 v48, v48, v50
  v_smfmac_f32_16x16x64_bf16 v[52:55], v[28:31], v[184:191], v3
  ds_write_b32 v170, v48
  v_smfmac_f32_16x16x64_bf16 v[52:55], v[32:35], v[192:199], v3
  v_smfmac_f32_16x16x64_bf16 v[56:59], v[8:11], v[200:207], v3
  v_smfmac_f32_16x16x64_bf16 v[56:59], v[12:15], v[208:215], v3
  v_smfmac_f32_16x16x64_bf16 v[56:59], v[16:19], v[216:223], v3
  v_add_f32 v52, v52, v53
  v_smfmac_f32_16x16x64_bf16 v[56:59], v[20:23], v[224:231], v3
  v_add_f32 v54, v54, v55
  v_smfmac_f32_16x16x64_bf16 v[56:59], v[24:27], v[232:239], v3
  v_cvt_pk_bf16_f32 v52, v52, v54
  v_smfmac_f32_16x16x64_bf16 v[56:59], v[28:31], v[240:247], v3
  ds_write_b32 v171, v52
  v_smfmac_f32_16x16x64_bf16 v[56:59], v[32:35], v[248:255], v3
  s_nop 7
  v_add_f32 v56, v56, v57
  v_add_f32 v58, v58, v59
  v_cvt_pk_bf16_f32 v56, v56, v58
  ds_write_b32 v172, v56
  buffer_load_dword v164, v4, s[8:11], s20 offen sc1
  s_waitcnt lgkmcnt(0)
  v_mov_b32 v36, 0
  v_mov_b32 v37, 0
  v_mov_b32 v38, 0
  v_mov_b32 v39, 0
  v_mov_b32 v40, 0
  v_mov_b32 v41, 0
  v_mov_b32 v42, 0
  v_mov_b32 v43, 0
  buffer_load_dword v165, v4, s[8:11], s20 offen sc1
  v_mov_b32 v44, 0
  v_mov_b32 v45, 0
  v_mov_b32 v46, 0
  v_mov_b32 v47, 0
  v_mov_b32 v48, 0
  v_mov_b32 v49, 0
  v_mov_b32 v50, 0
  v_mov_b32 v51, 0
  buffer_load_dword v166, v4, s[8:11], s20 offen sc1
  v_mov_b32 v52, 0
  v_mov_b32 v53, 0
  v_mov_b32 v54, 0
  v_mov_b32 v55, 0
  v_mov_b32 v56, 0
  v_mov_b32 v57, 0
  v_mov_b32 v58, 0
  v_mov_b32 v59, 0
  buffer_load_dword v167, v4, s[8:11], s20 offen sc1
  s_cmp_eq_u32 s19, 63
  s_cbranch_scc1 cB_va0_last
  s_add_u32 s22, s20, 9216
  s_add_u32 s34, s20, 13312
  s_add_u32 s36, s20, 7168
  s_mov_b32 s37, 0
  v_mov_b32 v156, 0
  v_mov_b32 v157, 0
  v_mov_b32 v158, 0
  v_mov_b32 v159, 0
  buffer_load_dword v168, v4, s[8:11], s20 offen sc1
cB_va0_fw_l:
  s_waitcnt vmcnt(4)
  v_cmp_eq_u32 vcc, -1, v164
  s_cbranch_vccz cB_va0_fw_d
  buffer_load_dword v164, v4, s[8:11], s20 offen sc1
  s_waitcnt vmcnt(4)
  v_cmp_eq_u32 vcc, -1, v165
  s_cbranch_vccz cB_va0_fw_d
  buffer_load_dword v165, v4, s[8:11], s20 offen sc1
  s_waitcnt vmcnt(4)
  v_cmp_eq_u32 vcc, -1, v166
  s_cbranch_vccz cB_va0_fw_d
  buffer_load_dword v166, v4, s[8:11], s20 offen sc1
  s_waitcnt vmcnt(4)
  v_cmp_eq_u32 vcc, -1, v167
  s_cbranch_vccz cB_va0_fw_d
  buffer_load_dword v167, v4, s[8:11], s20 offen sc1
  s_waitcnt vmcnt(4)
  v_cmp_eq_u32 vcc, -1, v168
  s_cbranch_vccz cB_va0_fw_d
  buffer_load_dword v168, v4, s[8:11], s20 offen sc1
  s_add_u32 s30, s30, 1
  s_cmp_lt_u32 s30, 400000
  s_cbranch_scc1 cB_va0_fw_l
  s_branch cB_abort
cB_va0_fw_d:
  s_waitcnt lgkmcnt(0)
  buffer_load_dwordx4 v[8:11], v5, s[8:11], s22 offen offset:0 sc1
  buffer_load_dwordx4 v[12:15], v5, s[8:11], s22 offen offset:1024 sc1
  buffer_load_dwordx4 v[16:19], v5, s[8:11], s22 offen offset:2048 sc1
  buffer_load_dwordx4 v[20:23], v5, s[8:11], s22 offen offset:3072 sc1
  buffer_load_dwordx4 v[24:27], v5, s[8:11], s34 offen offset:0 sc1
  buffer_load_dwordx4 v[28:31], v5, s[8:11], s34 offen offset:1024 sc1
  buffer_load_dwordx4 v[32:35], v5, s[8:11], s34 offen offset:2048 sc1
  buffer_load_dwordx4 v[144:147], v5, s[8:11], s34 offen offset:3072 sc1
  buffer_load_dwordx4 v[148:151], v2, s[8:11], s36 offen offset:0 sc1
  buffer_load_dwordx4 v[152:155], v2, s[8:11], s36 offen offset:1024 sc1
  s_barrier
  ds_read_b128 v[64:67], v2 offset:0
  ds_read_b128 v[68:71], v2 offset:1024
  ds_read_b128 v[72:75], v2 offset:2048
  ds_read_b128 v[76:79], v2 offset:3072
  s_waitcnt vmcnt(9)
  v_smfmac_f32_16x16x64_bf16 v[156:159], v[8:11], v[80:87], v3
  s_waitcnt vmcnt(8)
  v_smfmac_f32_16x16x64_bf16 v[156:159], v[12:15], v[88:95], v3
  s_waitcnt vmcnt(7)
  v_smfmac_f32_16x16x64_bf16 v[156:159], v[16:19], v[96:103], v3
  s_waitcnt vmcnt(6)
  v_smfmac_f32_16x16x64_bf16 v[156:159], v[20:23], v[104:111], v3
  s_waitcnt vmcnt(5)
  v_smfmac_f32_16x16x64_bf16 v[156:159], v[24:27], v[112:119], v3
  s_waitcnt vmcnt(4)
  v_smfmac_f32_16x16x64_bf16 v[156:159], v[28:31], v[120:127], v3
  s_waitcnt vmcnt(3)
  v_smfmac_f32_16x16x64_bf16 v[156:159], v[32:35], v[128:135], v3
  s_waitcnt vmcnt(2)
  v_smfmac_f32_16x16x64_bf16 v[156:159], v[144:147], v[136:143], v3
  s_waitcnt vmcnt(1) lgkmcnt(0)
  v_smfmac_f32_16x16x64_bf16 v[156:159], v[148:151], v[64:71], v3
  s_waitcnt vmcnt(0)
  v_smfmac_f32_16x16x64_bf16 v[156:159], v[152:155], v[72:79], v3
cB_va0_ep:
  s_nop 7
  v_add_f32 v160, v156, v157
  v_add_f32 v161, v158, v159
  v_cmp_u_f32 vcc, v160, v161
  v_mov_b32_dpp v162, v160 row_ror:8 row_mask:0xf bank_mask:0xf
  v_mov_b32_dpp v160, v161 row_ror:8 row_mask:0xf bank_mask:0xc
  s_cbranch_vccnz cB_va0_rp
  v_mov_b32_dpp v161, v162 quad_perm:[0,1,2,3] row_mask:0xf bank_mask:0x3
  v_cvt_pk_bf16_f32 v160, v160, v161
cB_va0_pc:
  buffer_store_dword v160, v1, s[8:11], s21 offen sc1
  s_cmp_lg_u32 s19, 62
  s_cbranch_scc1 cB_va0_nl
  s_mov_b32 s22, 88531968
  buffer_store_dword v160, v1, s[8:11], s22 offen sc1
  s_mov_b64 exec, -1
  s_branch cB_done
cB_va0_nl:
  s_mov_b64 exec, -1
  s_add_u32 s25, s25, 28672
  s_add_u32 s19, s19, 1
  s_mov_b32 s20, s21
  s_branch cB_va0_loop
cB_va0_last:
  s_waitcnt lgkmcnt(0)
  s_barrier
  s_branch cB_done
cB_va0_rp:
  s_cmp_eq_u32 s37, 0
  s_cbranch_scc1 cB_va0_rv
  v_mov_b32_dpp v161, v162 quad_perm:[0,1,2,3] row_mask:0xf bank_mask:0x3
  v_cvt_pk_bf16_f32 v160, v160, v161
  v_min_u32 v160, -2, v160
  s_branch cB_va0_pc
cB_va0_rv:
  buffer_load_dwordx4 v[8:11], v5, s[8:11], s22 offen offset:0 sc1
  buffer_load_dwordx4 v[12:15], v5, s[8:11], s22 offen offset:1024 sc1
  buffer_load_dwordx4 v[16:19], v5, s[8:11], s22 offen offset:2048 sc1
  buffer_load_dwordx4 v[20:23], v5, s[8:11], s22 offen offset:3072 sc1
  buffer_load_dwordx4 v[24:27], v5, s[8:11], s34 offen offset:0 sc1
  buffer_load_dwordx4 v[28:31], v5, s[8:11], s34 offen offset:1024 sc1
  buffer_load_dwordx4 v[32:35], v5, s[8:11], s34 offen offset:2048 sc1
  buffer_load_dwordx4 v[144:147], v5, s[8:11], s34 offen offset:3072 sc1
  buffer_load_dwordx4 v[148:151], v2, s[8:11], s36 offen offset:0 sc1
  buffer_load_dwordx4 v[152:155], v2, s[8:11], s36 offen offset:1024 sc1
  s_waitcnt vmcnt(0)
  v_max3_u32 v175, v8, v9, v10
  v_max3_u32 v175, v175, v11, v12
  v_max3_u32 v175, v175, v13, v14
  v_max3_u32 v175, v175, v15, v16
  v_max3_u32 v175, v175, v17, v18
  v_max3_u32 v175, v175, v19, v20
  v_max3_u32 v175, v175, v21, v22
  v_max3_u32 v175, v175, v23, v24
  v_max3_u32 v175, v175, v25, v26
  v_max3_u32 v175, v175, v27, v28
  v_max3_u32 v175, v175, v29, v30
  v_max3_u32 v175, v175, v31, v32
  v_max3_u32 v175, v175, v33, v34
  v_max3_u32 v175, v175, v35, v144
  v_max3_u32 v175, v175, v145, v146
  v_max3_u32 v175, v175, v147, v148
  v_max3_u32 v175, v175, v149, v150
  v_max3_u32 v175, v175, v151, v152
  v_max3_u32 v175, v175, v153, v154
  v_max_u32 v175, v175, v155
  v_cmp_eq_u32 vcc, -1, v175
  s_cbranch_vccz cB_va0_rk
  s_add_u32 s30, s30, 1
  s_cmp_lt_u32 s30, 400000
  s_cbranch_scc1 cB_va0_rv
  s_branch cB_abort
cB_va0_rk:
  s_mov_b32 s37, 1
  s_add_u32 s31, s31, 0x10000
  v_mov_b32 v156, 0
  v_mov_b32 v157, 0
  v_mov_b32 v158, 0
  v_mov_b32 v159, 0
  s_nop 1
  v_smfmac_f32_16x16x64_bf16 v[156:159], v[8:11], v[80:87], v3
  v_smfmac_f32_16x16x64_bf16 v[156:159], v[12:15], v[88:95], v3
  v_smfmac_f32_16x16x64_bf16 v[156:159], v[16:19], v[96:103], v3
  v_smfmac_f32_16x16x64_bf16 v[156:159], v[20:23], v[104:111], v3
  v_smfmac_f32_16x16x64_bf16 v[156:159], v[24:27], v[112:119], v3
  v_smfmac_f32_16x16x64_bf16 v[156:159], v[28:31], v[120:127], v3
  v_smfmac_f32_16x16x64_bf16 v[156:159], v[32:35], v[128:135], v3
  v_smfmac_f32_16x16x64_bf16 v[156:159], v[144:147], v[136:143], v3
  v_smfmac_f32_16x16x64_bf16 v[156:159], v[148:151], v[64:71], v3
  v_smfmac_f32_16x16x64_bf16 v[156:159], v[152:155], v[72:79], v3
  s_nop 7
  s_branch cB_va0_ep
.p2align 6

cB_va1_loop:
  s_add_u32 s23, s20, 4096
  s_add_u32 s21, s20, 20480
  s_mov_b32 s30, 0
  s_cmp_lg_u32 s19, s38
  s_cbranch_scc1 cB_va1_vok
  s_branch cB_va1_voc
cB_va1_vow:
  s_sub_u32 s22, s39, s35
  v_lshlrev_b32 v63, 7, v2
  v_min_u32 v63, s22, v63
  buffer_load_dword v63, v63, s[8:11], s35 offen sc1
  s_waitcnt vmcnt(0)
cB_va1_voc:
  v_readfirstlane_b32 s22, v63
  s_cmp_eq_u32 s22, 56
  s_cbranch_scc1 cB_va1_vod
  s_sleep 1
  s_add_u32 s30, s30, 1
  s_cmp_lt_u32 s30, 400000
  s_cbranch_scc1 cB_va1_vow
  s_branch cB_abort
cB_va1_vod:
  s_add_u32 s35, s35, 2048
  s_add_u32 s38, s19, 8
  s_and_b32 s38, s38, -8
  s_cmp_eq_u32 s19, 0
  s_cselect_b32 s38, 4, s38
  v_cmp_ne_u32 vcc, 56, v63
  s_nop 3
  s_cmp_eq_u64 vcc, 0
  s_cselect_b32 s38, 99, s38
cB_va1_vok:
  s_cmp_eq_u32 s19, 63
  s_cbranch_scc1 cB_done
  s_barrier
  s_add_u32 s22, s25, 0
  buffer_load_dwordx4 v[80:83], v6, s[8:11], s22 offen offset:0 sc1
  buffer_load_dwordx4 v[84:87], v6, s[8:11], s22 offen offset:1792 sc1
  s_add_u32 s22, s25, 3584
  buffer_load_dwordx4 v[88:91], v6, s[8:11], s22 offen offset:0 sc1
  buffer_load_dwordx4 v[92:95], v6, s[8:11], s22 offen offset:1792 sc1
  s_add_u32 s22, s25, 7168
  buffer_load_dwordx4 v[96:99], v6, s[8:11], s22 offen offset:0 sc1
  buffer_load_dwordx4 v[100:103], v6, s[8:11], s22 offen offset:1792 sc1
  s_add_u32 s22, s25, 10752
  buffer_load_dwordx4 v[104:107], v6, s[8:11], s22 offen offset:0 sc1
  buffer_load_dwordx4 v[108:111], v6, s[8:11], s22 offen offset:1792 sc1
  s_add_u32 s22, s25, 14336
  buffer_load_dwordx4 v[112:115], v6, s[8:11], s22 offen offset:0 sc1
  buffer_load_dwordx4 v[116:119], v6, s[8:11], s22 offen offset:1792 sc1
  s_add_u32 s22, s25, 17920
  buffer_load_dwordx4 v[120:123], v6, s[8:11], s22 offen offset:0 sc1
  buffer_load_dwordx4 v[124:127], v6, s[8:11], s22 offen offset:1792 sc1
  s_add_u32 s22, s19, 1
  s_cmp_lg_u32 s22, s38
  s_cbranch_scc1 cB_va1_nk
  s_sub_u32 s22, s39, s35
  v_lshlrev_b32 v63, 7, v2
  v_min_u32 v63, s22, v63
  buffer_load_dword v63, v63, s[8:11], s35 offen sc1
cB_va1_nk:
  s_barrier
  ds_read_b128 v[8:11], v0 offset:8192
  ds_read_b128 v[12:15], v0 offset:9216
  ds_read_b128 v[16:19], v0 offset:10240
  ds_read_b128 v[20:23], v0 offset:11264
  ds_read_b128 v[24:27], v0 offset:12288
  ds_read_b128 v[28:31], v0 offset:13312
  ds_read_b128 v[32:35], v0 offset:14336
  s_waitcnt lgkmcnt(0)
  v_smfmac_f32_16x16x64_bf16 v[36:39], v[8:11], a[0:7], v3
  s_add_u32 s22, s25, 21504
  buffer_load_dwordx4 v[128:131], v6, s[8:11], s22 offen offset:0 sc1
  v_smfmac_f32_16x16x64_bf16 v[36:39], v[12:15], a[8:15], v3
  v_smfmac_f32_16x16x64_bf16 v[36:39], v[16:19], a[16:23], v3
  s_add_u32 s22, s25, 21504
  buffer_load_dwordx4 v[132:135], v6, s[8:11], s22 offen offset:1792 sc1
  v_smfmac_f32_16x16x64_bf16 v[36:39], v[20:23], a[24:31], v3
  v_smfmac_f32_16x16x64_bf16 v[36:39], v[24:27], a[32:39], v3
  s_add_u32 s22, s25, 25088
  buffer_load_dwordx4 v[136:139], v6, s[8:11], s22 offen offset:0 sc1
  v_smfmac_f32_16x16x64_bf16 v[36:39], v[28:31], a[40:47], v3
  v_smfmac_f32_16x16x64_bf16 v[36:39], v[32:35], a[48:55], v3
  s_add_u32 s22, s25, 25088
  buffer_load_dwordx4 v[140:143], v6, s[8:11], s22 offen offset:1792 sc1
  v_smfmac_f32_16x16x64_bf16 v[40:43], v[8:11], a[56:63], v3
  v_smfmac_f32_16x16x64_bf16 v[40:43], v[12:15], a[64:71], v3
  v_smfmac_f32_16x16x64_bf16 v[40:43], v[16:19], a[72:79], v3
  v_add_f32 v36, v36, v37
  v_smfmac_f32_16x16x64_bf16 v[40:43], v[20:23], a[80:87], v3
  v_add_f32 v38, v38, v39
  v_smfmac_f32_16x16x64_bf16 v[40:43], v[24:27], a[88:95], v3
  v_cvt_pk_bf16_f32 v36, v36, v38
  v_smfmac_f32_16x16x64_bf16 v[40:43], v[28:31], a[96:103], v3
  ds_write_b32 v60, v36
  v_smfmac_f32_16x16x64_bf16 v[40:43], v[32:35], a[104:111], v3
  v_smfmac_f32_16x16x64_bf16 v[44:47], v[8:11], a[112:119], v3
  v_smfmac_f32_16x16x64_bf16 v[44:47], v[12:15], a[120:127], v3
  v_smfmac_f32_16x16x64_bf16 v[44:47], v[16:19], a[128:135], v3
  v_add_f32 v40, v40, v41
  v_smfmac_f32_16x16x64_bf16 v[44:47], v[20:23], a[136:143], v3
  v_add_f32 v42, v42, v43
  v_smfmac_f32_16x16x64_bf16 v[44:47], v[24:27], a[144:151], v3
  v_cvt_pk_bf16_f32 v40, v40, v42
  v_smfmac_f32_16x16x64_bf16 v[44:47], v[28:31], a[152:159], v3
  ds_write_b32 v61, v40
  v_smfmac_f32_16x16x64_bf16 v[44:47], v[32:35], a[160:167], v3
  v_smfmac_f32_16x16x64_bf16 v[48:51], v[8:11], a[168:175], v3
  v_smfmac_f32_16x16x64_bf16 v[48:51], v[12:15], a[176:183], v3
  v_smfmac_f32_16x16x64_bf16 v[48:51], v[16:19], a[184:191], v3
  v_add_f32 v44, v44, v45
  v_smfmac_f32_16x16x64_bf16 v[48:51], v[20:23], a[192:199], v3
  v_add_f32 v46, v46, v47
  v_smfmac_f32_16x16x64_bf16 v[48:51], v[24:27], a[200:207], v3
  v_cvt_pk_bf16_f32 v44, v44, v46
  v_smfmac_f32_16x16x64_bf16 v[48:51], v[28:31], a[208:215], v3
  ds_write_b32 v62, v44
  v_smfmac_f32_16x16x64_bf16 v[48:51], v[32:35], a[216:223], v3
  v_smfmac_f32_16x16x64_bf16 v[52:55], v[8:11], a[224:231], v3
  v_smfmac_f32_16x16x64_bf16 v[52:55], v[12:15], a[232:239], v3
  v_smfmac_f32_16x16x64_bf16 v[52:55], v[16:19], a[240:247], v3
  v_add_f32 v48, v48, v49
  v_smfmac_f32_16x16x64_bf16 v[52:55], v[20:23], a[248:255], v3
  v_add_f32 v50, v50, v51
  v_smfmac_f32_16x16x64_bf16 v[52:55], v[24:27], v[176:183], v3
  v_cvt_pk_bf16_f32 v48, v48, v50
  v_smfmac_f32_16x16x64_bf16 v[52:55], v[28:31], v[184:191], v3
  ds_write_b32 v170, v48
  v_smfmac_f32_16x16x64_bf16 v[52:55], v[32:35], v[192:199], v3
  v_smfmac_f32_16x16x64_bf16 v[56:59], v[8:11], v[200:207], v3
  v_smfmac_f32_16x16x64_bf16 v[56:59], v[12:15], v[208:215], v3
  v_smfmac_f32_16x16x64_bf16 v[56:59], v[16:19], v[216:223], v3
  v_add_f32 v52, v52, v53
  v_smfmac_f32_16x16x64_bf16 v[56:59], v[20:23], v[224:231], v3
  v_add_f32 v54, v54, v55
  v_smfmac_f32_16x16x64_bf16 v[56:59], v[24:27], v[232:239], v3
  v_cvt_pk_bf16_f32 v52, v52, v54
  v_smfmac_f32_16x16x64_bf16 v[56:59], v[28:31], v[240:247], v3
  ds_write_b32 v171, v52
  v_smfmac_f32_16x16x64_bf16 v[56:59], v[32:35], v[248:255], v3
  s_nop 7
  v_add_f32 v56, v56, v57
  v_add_f32 v58, v58, v59
  v_cvt_pk_bf16_f32 v56, v56, v58
  ds_write_b32 v172, v56
  s_waitcnt lgkmcnt(0)
  v_mov_b32 v36, 0
  v_mov_b32 v37, 0
  v_mov_b32 v38, 0
  v_mov_b32 v39, 0
  v_mov_b32 v40, 0
  v_mov_b32 v41, 0
  v_mov_b32 v42, 0
  v_mov_b32 v43, 0
  v_mov_b32 v44, 0
  v_mov_b32 v45, 0
  v_mov_b32 v46, 0
  v_mov_b32 v47, 0
  v_mov_b32 v48, 0
  v_mov_b32 v49, 0
  v_mov_b32 v50, 0
  v_mov_b32 v51, 0
  v_mov_b32 v52, 0
  v_mov_b32 v53, 0
  v_mov_b32 v54, 0
  v_mov_b32 v55, 0
  v_mov_b32 v56, 0
  v_mov_b32 v57, 0
  v_mov_b32 v58, 0
  v_mov_b32 v59, 0
  s_cmp_eq_u32 s19, 63
  s_cbranch_scc1 cB_va1_last
  s_add_u32 s22, s20, 9216
  s_add_u32 s34, s20, 13312
  s_add_u32 s36, s20, 7168
  s_mov_b32 s37, 0
  v_mov_b32 v156, 0
  v_mov_b32 v157, 0
  v_mov_b32 v158, 0
  v_mov_b32 v159, 0
  s_barrier
  s_waitcnt lgkmcnt(0)
  buffer_load_dwordx4 v[8:11], v5, s[8:11], s22 offen offset:0 sc1
  buffer_load_dwordx4 v[12:15], v5, s[8:11], s22 offen offset:1024 sc1
  buffer_load_dwordx4 v[16:19], v5, s[8:11], s22 offen offset:2048 sc1
  buffer_load_dwordx4 v[20:23], v5, s[8:11], s22 offen offset:3072 sc1
  buffer_load_dwordx4 v[24:27], v5, s[8:11], s34 offen offset:0 sc1
  buffer_load_dwordx4 v[28:31], v5, s[8:11], s34 offen offset:1024 sc1
  buffer_load_dwordx4 v[32:35], v5, s[8:11], s34 offen offset:2048 sc1
  buffer_load_dwordx4 v[144:147], v5, s[8:11], s34 offen offset:3072 sc1
  s_cmp_lg_u32 s19, 0
  s_cbranch_scc1 cB_va1_s0
  s_sleep 6
cB_va1_s0:
  s_sub_u32 s23, s21, 4
  s_mov_b64 exec, 65535
  buffer_store_dword v2, v7, s[8:11], s23 offen sc1
  s_mov_b64 exec, -1
  buffer_load_dwordx4 v[148:151], v2, s[8:11], s36 offen offset:0 sc1
  buffer_load_dwordx4 v[152:155], v2, s[8:11], s36 offen offset:1024 sc1
  ds_read_b128 v[64:67], v2 offset:4096
  ds_read_b128 v[68:71], v2 offset:5120
  ds_read_b128 v[72:75], v2 offset:6144
  ds_read_b128 v[76:79], v2 offset:7168
  s_waitcnt vmcnt(10)
  v_smfmac_f32_16x16x64_bf16 v[156:159], v[8:11], v[80:87], v3
  s_waitcnt vmcnt(9)
  v_smfmac_f32_16x16x64_bf16 v[156:159], v[12:15], v[88:95], v3
  s_waitcnt vmcnt(8)
  v_smfmac_f32_16x16x64_bf16 v[156:159], v[16:19], v[96:103], v3
  s_waitcnt vmcnt(7)
  v_smfmac_f32_16x16x64_bf16 v[156:159], v[20:23], v[104:111], v3
  s_waitcnt vmcnt(6)
  v_smfmac_f32_16x16x64_bf16 v[156:159], v[24:27], v[112:119], v3
  s_mov_b64 exec, 65535
  buffer_store_dword v2, v7, s[8:11], s21 offen sc1
  s_mov_b64 exec, -1
  s_waitcnt vmcnt(6)
  v_smfmac_f32_16x16x64_bf16 v[156:159], v[28:31], v[120:127], v3
  s_waitcnt vmcnt(5)
  v_smfmac_f32_16x16x64_bf16 v[156:159], v[32:35], v[128:135], v3
  s_waitcnt vmcnt(4)
  v_smfmac_f32_16x16x64_bf16 v[156:159], v[144:147], v[136:143], v3
  s_waitcnt vmcnt(2) lgkmcnt(0)
  v_smfmac_f32_16x16x64_bf16 v[156:159], v[148:151], v[64:71], v3
  s_waitcnt vmcnt(1)
  v_smfmac_f32_16x16x64_bf16 v[156:159], v[152:155], v[72:79], v3
cB_va1_ep:
  s_nop 7
  v_add_f32 v160, v156, v157
  v_add_f32 v161, v158, v159
  v_cmp_u_f32 vcc, v160, v161
  v_mov_b32_dpp v162, v160 row_ror:8 row_mask:0xf bank_mask:0xf
  v_mov_b32_dpp v160, v161 row_ror:8 row_mask:0xf bank_mask:0xc
  s_cbranch_vccnz cB_va1_rp
  v_mov_b32_dpp v161, v162 quad_perm:[0,1,2,3] row_mask:0xf bank_mask:0x3
  v_cvt_pk_bf16_f32 v160, v160, v161
cB_va1_pc:
  s_mov_b64 exec, s[26:27]
  buffer_store_dword v160, v1, s[8:11], s21 offen sc1
  s_cmp_lg_u32 s19, 62
  s_cbranch_scc1 cB_va1_nl
  s_mov_b32 s22, 88531968
  buffer_store_dword v160, v1, s[8:11], s22 offen sc1
  s_mov_b64 exec, -1
  s_branch cB_done
cB_va1_nl:
  s_mov_b64 exec, -1
  s_add_u32 s25, s25, 28672
  s_add_u32 s19, s19, 1
  s_mov_b32 s20, s21
  s_branch cB_va1_loop
cB_va1_last:
  s_waitcnt lgkmcnt(0)
  s_barrier
  s_branch cB_done
cB_va1_rp:
  s_cmp_eq_u32 s37, 0
  s_cbranch_scc1 cB_va1_rv
  v_mov_b32_dpp v161, v162 quad_perm:[0,1,2,3] row_mask:0xf bank_mask:0x3
  v_cvt_pk_bf16_f32 v160, v160, v161
  v_min_u32 v160, -2, v160
  s_branch cB_va1_pc
cB_va1_rv:
  buffer_load_dwordx4 v[8:11], v5, s[8:11], s22 offen offset:0 sc1
  buffer_load_dwordx4 v[12:15], v5, s[8:11], s22 offen offset:1024 sc1
  buffer_load_dwordx4 v[16:19], v5, s[8:11], s22 offen offset:2048 sc1
  buffer_load_dwordx4 v[20:23], v5, s[8:11], s22 offen offset:3072 sc1
  buffer_load_dwordx4 v[24:27], v5, s[8:11], s34 offen offset:0 sc1
  buffer_load_dwordx4 v[28:31], v5, s[8:11], s34 offen offset:1024 sc1
  buffer_load_dwordx4 v[32:35], v5, s[8:11], s34 offen offset:2048 sc1
  buffer_load_dwordx4 v[144:147], v5, s[8:11], s34 offen offset:3072 sc1
  buffer_load_dwordx4 v[148:151], v2, s[8:11], s36 offen offset:0 sc1
  buffer_load_dwordx4 v[152:155], v2, s[8:11], s36 offen offset:1024 sc1
  s_waitcnt vmcnt(0)
  v_max3_u32 v175, v8, v9, v10
  v_max3_u32 v175, v175, v11, v12
  v_max3_u32 v175, v175, v13, v14
  v_max3_u32 v175, v175, v15, v16
  v_max3_u32 v175, v175, v17, v18
  v_max3_u32 v175, v175, v19, v20
  v_max3_u32 v175, v175, v21, v22
  v_max3_u32 v175, v175, v23, v24
  v_max3_u32 v175, v175, v25, v26
  v_max3_u32 v175, v175, v27, v28
  v_max3_u32 v175, v175, v29, v30
  v_max3_u32 v175, v175, v31, v32
  v_max3_u32 v175, v175, v33, v34
  v_max3_u32 v175, v175, v35, v144
  v_max3_u32 v175, v175, v145, v146
  v_max3_u32 v175, v175, v147, v148
  v_max3_u32 v175, v175, v149, v150
  v_max3_u32 v175, v175, v151, v152
  v_max3_u32 v175, v175, v153, v154
  v_max_u32 v175, v175, v155
  v_cmp_eq_u32 vcc, -1, v175
  s_cbranch_vccz cB_va1_rk
  s_add_u32 s30, s30, 1
  s_cmp_lt_u32 s30, 400000
  s_cbranch_scc1 cB_va1_rv
  s_branch cB_abort
cB_va1_rk:
  s_mov_b32 s37, 1
  s_add_u32 s31, s31, 0x10000
  v_mov_b32 v156, 0
  v_mov_b32 v157, 0
  v_mov_b32 v158, 0
  v_mov_b32 v159, 0
  s_nop 1
  v_smfmac_f32_16x16x64_bf16 v[156:159], v[8:11], v[80:87], v3
  v_smfmac_f32_16x16x64_bf16 v[156:159], v[12:15], v[88:95], v3
  v_smfmac_f32_16x16x64_bf16 v[156:159], v[16:19], v[96:103], v3
  v_smfmac_f32_16x16x64_bf16 v[156:159], v[20:23], v[104:111], v3
  v_smfmac_f32_16x16x64_bf16 v[156:159], v[24:27], v[112:119], v3
  v_smfmac_f32_16x16x64_bf16 v[156:159], v[28:31], v[120:127], v3
  v_smfmac_f32_16x16x64_bf16 v[156:159], v[32:35], v[128:135], v3
  v_smfmac_f32_16x16x64_bf16 v[156:159], v[144:147], v[136:143], v3
  v_smfmac_f32_16x16x64_bf16 v[156:159], v[148:151], v[64:71], v3
  v_smfmac_f32_16x16x64_bf16 v[156:159], v[152:155], v[72:79], v3
  s_nop 7
  s_branch cB_va1_ep
.p2align 6

cB_va2_loop:
  s_add_u32 s23, s20, 4096
  s_add_u32 s21, s20, 20480
  v_mov_b32 v36, 0
  v_mov_b32 v37, 0
  v_mov_b32 v38, 0
  v_mov_b32 v39, 0
  v_mov_b32 v40, 0
  v_mov_b32 v41, 0
  v_mov_b32 v42, 0
  v_mov_b32 v43, 0
  v_mov_b32 v44, 0
  v_mov_b32 v45, 0
  v_mov_b32 v46, 0
  v_mov_b32 v47, 0
  v_mov_b32 v48, 0
  v_mov_b32 v49, 0
  v_mov_b32 v50, 0
  v_mov_b32 v51, 0
  v_mov_b32 v52, 0
  v_mov_b32 v53, 0
  v_mov_b32 v54, 0
  v_mov_b32 v55, 0
  v_mov_b32 v56, 0
  v_mov_b32 v57, 0
  v_mov_b32 v58, 0
  v_mov_b32 v59, 0
  v_mov_b32 v60, 0
  v_mov_b32 v61, 0
  v_mov_b32 v62, 0
  v_mov_b32 v63, 0
  v_mov_b32 v64, 0
  v_mov_b32 v65, 0
  v_mov_b32 v66, 0
  v_mov_b32 v67, 0
  s_mov_b32 s30, 0
  buffer_load_dword v76, v119, s[8:11], s20 offen sc1
  buffer_load_dword v77, v119, s[8:11], s20 offen sc1
  buffer_load_dword v78, v119, s[8:11], s20 offen sc1
cB_va2_fp_l:
  s_waitcnt vmcnt(2)
  v_cmp_eq_u32 vcc, -1, v76
  s_cbranch_vccz cB_va2_fp_d
  buffer_load_dword v76, v119, s[8:11], s20 offen sc1
  s_waitcnt vmcnt(2)
  v_cmp_eq_u32 vcc, -1, v77
  s_cbranch_vccz cB_va2_fp_d
  buffer_load_dword v77, v119, s[8:11], s20 offen sc1
  s_waitcnt vmcnt(2)
  v_cmp_eq_u32 vcc, -1, v78
  s_cbranch_vccz cB_va2_fp_d
  buffer_load_dword v78, v119, s[8:11], s20 offen sc1
  s_add_u32 s30, s30, 1
  s_cmp_lt_u32 s30, 400000
  s_cbranch_scc1 cB_va2_fp_l
  s_branch cB_abort
cB_va2_fp_d:
  s_nop 15
  s_nop 3
  buffer_load_dwordx4 v[8:11], v2, s[8:11], s20 offen offset:0 sc1
  buffer_load_dwordx4 v[12:15], v2, s[8:11], s20 offen offset:1024 sc1
  buffer_load_dwordx4 v[16:19], v2, s[8:11], s20 offen offset:2048 sc1
  buffer_load_dwordx4 v[20:23], v2, s[8:11], s20 offen offset:3072 sc1
  s_barrier
cB_va2_ld:
  s_waitcnt vmcnt(0)
  v_max3_u32 v84, v8, v9, v10
  v_max3_u32 v84, v84, v11, v12
  v_max3_u32 v84, v84, v13, v14
  v_max3_u32 v84, v84, v15, v16
  v_max3_u32 v84, v84, v17, v18
  v_max3_u32 v84, v84, v19, v20
  v_max3_u32 v84, v84, v21, v22
  v_max_u32 v84, v84, v23
  v_cmp_eq_u32 vcc, -1, v84
  ds_write_b128 v2, v[8:11] offset:8192
  ds_write_b128 v2, v[12:15] offset:9216
  ds_write_b128 v2, v[16:19] offset:10240
  ds_write_b128 v2, v[20:23] offset:11264
  s_cbranch_vccnz cB_va2_retry
  s_waitcnt lgkmcnt(0)
  s_barrier
  ds_read_b128 v[8:11], v5 offset:8192
  ds_read_b128 v[12:15], v5 offset:9216
  ds_read_b128 v[16:19], v5 offset:10240
  ds_read_b128 v[20:23], v5 offset:11264
  ds_read_b128 v[24:27], v5 offset:12288
  ds_read_b128 v[28:31], v5 offset:13312
  ds_read_b128 v[32:35], v5 offset:14336
  ds_read_b128 v[92:95], v0
  s_waitcnt lgkmcnt(0)
  s_mov_b64 exec, s[26:27]
  buffer_store_dwordx4 v[92:95], v2, s[8:11], s36 offen sc1
  s_mov_b64 exec, -1
  s_add_u32 s36, s36, 7168
  s_cmp_eq_u32 s19, 63
  s_cbranch_scc1 cB_done
  ds_read_b128 v[76:79], v1 offset:0
  ds_read_b128 v[80:83], v1 offset:1024
  ds_read_b128 v[84:87], v1 offset:2048
  ds_read_b128 v[88:91], v1 offset:3072
  ds_read_b128 v[92:95], v1 offset:4096
  ds_read_b128 v[96:99], v1 offset:5120
  v_smfmac_f32_16x16x64_bf16 v[60:63], v[8:11], v[200:207], v3
  v_smfmac_f32_16x16x64_bf16 v[60:63], v[12:15], v[208:215], v3
  s_waitcnt lgkmcnt(4)
  v_smfmac_f32_16x16x64_bf16 v[64:67], v[8:11], v[76:83], v3
  ds_read_b128 v[76:79], v1 offset:6144
  ds_read_b128 v[80:83], v1 offset:7168
  v_smfmac_f32_16x16x64_bf16 v[60:63], v[16:19], v[216:223], v3
  v_smfmac_f32_16x16x64_bf16 v[60:63], v[20:23], v[224:231], v3
  s_waitcnt lgkmcnt(4)
  v_smfmac_f32_16x16x64_bf16 v[64:67], v[12:15], v[84:91], v3
  ds_read_b128 v[84:87], v1 offset:8192
  ds_read_b128 v[88:91], v1 offset:9216
  v_smfmac_f32_16x16x64_bf16 v[60:63], v[24:27], v[232:239], v3
  v_smfmac_f32_16x16x64_bf16 v[60:63], v[28:31], v[240:247], v3
  s_waitcnt lgkmcnt(4)
  v_smfmac_f32_16x16x64_bf16 v[64:67], v[16:19], v[92:99], v3
  ds_read_b128 v[92:95], v1 offset:10240
  ds_read_b128 v[96:99], v1 offset:11264
  v_smfmac_f32_16x16x64_bf16 v[60:63], v[32:35], v[248:255], v3
  v_smfmac_f32_16x16x64_bf16 v[36:39], v[8:11], a[0:7], v3
  s_waitcnt lgkmcnt(4)
  v_smfmac_f32_16x16x64_bf16 v[64:67], v[20:23], v[76:83], v3
  ds_read_b128 v[76:79], v1 offset:12288
  ds_read_b128 v[80:83], v1 offset:13312
  v_smfmac_f32_16x16x64_bf16 v[36:39], v[12:15], a[8:15], v3
  v_add_f32 v60, v60, v61
  v_smfmac_f32_16x16x64_bf16 v[36:39], v[16:19], a[16:23], v3
  v_add_f32 v62, v62, v63
  s_waitcnt lgkmcnt(4)
  v_smfmac_f32_16x16x64_bf16 v[64:67], v[24:27], v[84:91], v3
  v_cvt_pk_bf16_f32 v60, v60, v62
  v_smfmac_f32_16x16x64_bf16 v[36:39], v[20:23], a[24:31], v3
  ds_write_b32 v106, v60
  v_smfmac_f32_16x16x64_bf16 v[36:39], v[24:27], a[32:39], v3
  s_waitcnt lgkmcnt(2)
  v_smfmac_f32_16x16x64_bf16 v[64:67], v[28:31], v[92:99], v3
  v_smfmac_f32_16x16x64_bf16 v[36:39], v[28:31], a[40:47], v3
  v_smfmac_f32_16x16x64_bf16 v[36:39], v[32:35], a[48:55], v3
  s_waitcnt lgkmcnt(0)
  v_smfmac_f32_16x16x64_bf16 v[64:67], v[32:35], v[76:83], v3
  v_smfmac_f32_16x16x64_bf16 v[40:43], v[8:11], a[56:63], v3
  v_smfmac_f32_16x16x64_bf16 v[40:43], v[12:15], a[64:71], v3
  v_add_f32 v36, v36, v37
  v_smfmac_f32_16x16x64_bf16 v[40:43], v[16:19], a[72:79], v3
  v_add_f32 v38, v38, v39
  v_smfmac_f32_16x16x64_bf16 v[40:43], v[20:23], a[80:87], v3
  v_cvt_pk_bf16_f32 v36, v36, v38
  v_smfmac_f32_16x16x64_bf16 v[40:43], v[24:27], a[88:95], v3
  ds_write_b32 v100, v36
  v_smfmac_f32_16x16x64_bf16 v[40:43], v[28:31], a[96:103], v3
  v_add_f32 v64, v64, v65
  v_smfmac_f32_16x16x64_bf16 v[40:43], v[32:35], a[104:111], v3
  v_add_f32 v66, v66, v67
  v_smfmac_f32_16x16x64_bf16 v[44:47], v[8:11], a[112:119], v3
  v_cvt_pk_bf16_f32 v64, v64, v66
  v_smfmac_f32_16x16x64_bf16 v[44:47], v[12:15], a[120:127], v3
  ds_write_b32 v107, v64
  v_smfmac_f32_16x16x64_bf16 v[44:47], v[16:19], a[128:135], v3
  v_add_f32 v40, v40, v41
  v_smfmac_f32_16x16x64_bf16 v[44:47], v[20:23], a[136:143], v3
  v_add_f32 v42, v42, v43
  v_smfmac_f32_16x16x64_bf16 v[44:47], v[24:27], a[144:151], v3
  v_cvt_pk_bf16_f32 v40, v40, v42
  v_smfmac_f32_16x16x64_bf16 v[44:47], v[28:31], a[152:159], v3
  ds_write_b32 v101, v40
  v_smfmac_f32_16x16x64_bf16 v[44:47], v[32:35], a[160:167], v3
  v_smfmac_f32_16x16x64_bf16 v[48:51], v[8:11], a[168:175], v3
  v_smfmac_f32_16x16x64_bf16 v[48:51], v[12:15], a[176:183], v3
  v_smfmac_f32_16x16x64_bf16 v[48:51], v[16:19], a[184:191], v3
  v_add_f32 v44, v44, v45
  v_smfmac_f32_16x16x64_bf16 v[48:51], v[20:23], a[192:199], v3
  v_add_f32 v46, v46, v47
  v_smfmac_f32_16x16x64_bf16 v[48:51], v[24:27], a[200:207], v3
  v_cvt_pk_bf16_f32 v44, v44, v46
  v_smfmac_f32_16x16x64_bf16 v[48:51], v[28:31], a[208:215], v3
  ds_write_b32 v102, v44
  v_smfmac_f32_16x16x64_bf16 v[48:51], v[32:35], a[216:223], v3
  v_smfmac_f32_16x16x64_bf16 v[52:55], v[8:11], a[224:231], v3
  v_smfmac_f32_16x16x64_bf16 v[52:55], v[12:15], a[232:239], v3
  v_smfmac_f32_16x16x64_bf16 v[52:55], v[16:19], a[240:247], v3
  v_add_f32 v48, v48, v49
  v_smfmac_f32_16x16x64_bf16 v[52:55], v[20:23], a[248:255], v3
  v_add_f32 v50, v50, v51
  v_smfmac_f32_16x16x64_bf16 v[52:55], v[24:27], v[120:127], v3
  v_cvt_pk_bf16_f32 v48, v48, v50
  v_smfmac_f32_16x16x64_bf16 v[52:55], v[28:31], v[128:135], v3
  ds_write_b32 v103, v48
  v_smfmac_f32_16x16x64_bf16 v[52:55], v[32:35], v[136:143], v3
  v_smfmac_f32_16x16x64_bf16 v[56:59], v[8:11], v[144:151], v3
  v_smfmac_f32_16x16x64_bf16 v[56:59], v[12:15], v[152:159], v3
  v_smfmac_f32_16x16x64_bf16 v[56:59], v[16:19], v[160:167], v3
  v_add_f32 v52, v52, v53
  v_smfmac_f32_16x16x64_bf16 v[56:59], v[20:23], v[168:175], v3
  v_add_f32 v54, v54, v55
  v_smfmac_f32_16x16x64_bf16 v[56:59], v[24:27], v[176:183], v3
  v_cvt_pk_bf16_f32 v52, v52, v54
  v_smfmac_f32_16x16x64_bf16 v[56:59], v[28:31], v[184:191], v3
  ds_write_b32 v104, v52
  v_smfmac_f32_16x16x64_bf16 v[56:59], v[32:35], v[192:199], v3
  s_nop 7
  v_add_f32 v56, v56, v57
  v_add_f32 v58, v58, v59
  v_cvt_pk_bf16_f32 v56, v56, v58
  ds_write_b32 v105, v56
  s_waitcnt lgkmcnt(0)
  s_barrier
  s_cmp_eq_u32 s19, 62
  s_cbranch_scc1 cB_done
  s_waitcnt vmcnt(0) lgkmcnt(0)
  s_add_u32 s19, s19, 1
  s_mov_b32 s20, s21
  s_branch cB_va2_loop
cB_va2_retry:
  s_waitcnt lgkmcnt(0)
  buffer_load_dwordx4 v[8:11], v2, s[8:11], s20 offen offset:0 sc1
  buffer_load_dwordx4 v[12:15], v2, s[8:11], s20 offen offset:1024 sc1
  buffer_load_dwordx4 v[16:19], v2, s[8:11], s20 offen offset:2048 sc1
  buffer_load_dwordx4 v[20:23], v2, s[8:11], s20 offen offset:3072 sc1
  s_add_u32 s31, s31, 1
  s_add_u32 s30, s30, 1
  s_cmp_lt_u32 s30, 400000
  s_cbranch_scc1 cB_va2_ld
  s_branch cB_abort
cB_va2_last:
  s_waitcnt lgkmcnt(0)
  buffer_store_dwordx4 v[100:103], v2, s[8:11], s24 offen offset:0 sc1
  buffer_store_dwordx4 v[104:107], v2, s[8:11], s24 offen offset:1024 sc1
  buffer_store_dwordx4 v[108:111], v2, s[8:11], s24 offen offset:2048 sc1
  buffer_store_dwordx4 v[4:7], v2, s[8:11], s24 offen offset:3072 sc1
  s_add_u32 s24, s24, 8192
  s_waitcnt vmcnt(0)
  s_mov_b64 exec, 1
  buffer_store_dword v117, v2, s[8:11], s34 offen sc1
  s_mov_b64 exec, -1
  s_add_u32 s34, s34, 8
  s_mov_b64 exec, 1
  buffer_store_dword v117, v2, s[8:11], s34 offen sc1
  s_mov_b64 exec, -1
  s_add_u32 s34, s34, 8
  s_branch cB_done
.p2align 6

cB_va3_loop:
  s_add_u32 s23, s20, 4096
  s_add_u32 s21, s20, 20480
  v_mov_b32 v36, 0
  v_mov_b32 v37, 0
  v_mov_b32 v38, 0
  v_mov_b32 v39, 0
  v_mov_b32 v40, 0
  v_mov_b32 v41, 0
  v_mov_b32 v42, 0
  v_mov_b32 v43, 0
  v_mov_b32 v44, 0
  v_mov_b32 v45, 0
  v_mov_b32 v46, 0
  v_mov_b32 v47, 0
  v_mov_b32 v48, 0
  v_mov_b32 v49, 0
  v_mov_b32 v50, 0
  v_mov_b32 v51, 0
  v_mov_b32 v52, 0
  v_mov_b32 v53, 0
  v_mov_b32 v54, 0
  v_mov_b32 v55, 0
  v_mov_b32 v56, 0
  v_mov_b32 v57, 0
  v_mov_b32 v58, 0
  v_mov_b32 v59, 0
  v_mov_b32 v60, 0
  v_mov_b32 v61, 0
  v_mov_b32 v62, 0
  v_mov_b32 v63, 0
  v_mov_b32 v64, 0
  v_mov_b32 v65, 0
  v_mov_b32 v66, 0
  v_mov_b32 v67, 0
  s_mov_b32 s30, 0
  buffer_load_dword v76, v119, s[8:11], s20 offen sc1
  buffer_load_dword v77, v119, s[8:11], s20 offen sc1
  buffer_load_dword v78, v119, s[8:11], s20 offen sc1
cB_va3_fp_l:
  s_waitcnt vmcnt(2)
  v_cmp_eq_u32 vcc, -1, v76
  s_cbranch_vccz cB_va3_fp_d
  buffer_load_dword v76, v119, s[8:11], s20 offen sc1
  s_waitcnt vmcnt(2)
  v_cmp_eq_u32 vcc, -1, v77
  s_cbranch_vccz cB_va3_fp_d
  buffer_load_dword v77, v119, s[8:11], s20 offen sc1
  s_waitcnt vmcnt(2)
  v_cmp_eq_u32 vcc, -1, v78
  s_cbranch_vccz cB_va3_fp_d
  buffer_load_dword v78, v119, s[8:11], s20 offen sc1
  s_add_u32 s30, s30, 1
  s_cmp_lt_u32 s30, 400000
  s_cbranch_scc1 cB_va3_fp_l
  s_branch cB_abort
cB_va3_fp_d:
  buffer_load_dwordx4 v[24:27], v2, s[8:11], s23 offen offset:0 sc1
  buffer_load_dwordx4 v[28:31], v2, s[8:11], s23 offen offset:1024 sc1
  buffer_load_dwordx4 v[32:35], v2, s[8:11], s23 offen offset:2048 sc1
  s_barrier
cB_va3_ld:
  s_waitcnt vmcnt(0)
  v_max3_u32 v84, v24, v25, v26
  v_max3_u32 v84, v84, v27, v28
  v_max3_u32 v84, v84, v29, v30
  v_max3_u32 v84, v84, v31, v32
  v_max3_u32 v84, v84, v33, v34
  v_max_u32 v84, v84, v35
  v_cmp_eq_u32 vcc, -1, v84
  ds_write_b128 v2, v[24:27] offset:12288
  ds_write_b128 v2, v[28:31] offset:13312
  ds_write_b128 v2, v[32:35] offset:14336
  s_cbranch_vccnz cB_va3_retry
  s_waitcnt lgkmcnt(0)
  s_barrier
  ds_read_b128 v[8:11], v5 offset:8192
  ds_read_b128 v[12:15], v5 offset:9216
  ds_read_b128 v[16:19], v5 offset:10240
  ds_read_b128 v[20:23], v5 offset:11264
  ds_read_b128 v[24:27], v5 offset:12288
  ds_read_b128 v[28:31], v5 offset:13312
  ds_read_b128 v[32:35], v5 offset:14336
  s_waitcnt lgkmcnt(0)
  s_cmp_eq_u32 s19, 63
  s_cbranch_scc1 cB_done
  ds_read_b128 v[76:79], v1 offset:0
  ds_read_b128 v[80:83], v1 offset:1024
  ds_read_b128 v[84:87], v1 offset:2048
  ds_read_b128 v[88:91], v1 offset:3072
  ds_read_b128 v[92:95], v1 offset:4096
  ds_read_b128 v[96:99], v1 offset:5120
  v_smfmac_f32_16x16x64_bf16 v[60:63], v[8:11], v[200:207], v3
  v_smfmac_f32_16x16x64_bf16 v[60:63], v[12:15], v[208:215], v3
  s_waitcnt lgkmcnt(4)
  v_smfmac_f32_16x16x64_bf16 v[64:67], v[8:11], v[76:83], v3
  ds_read_b128 v[76:79], v1 offset:6144
  ds_read_b128 v[80:83], v1 offset:7168
  v_smfmac_f32_16x16x64_bf16 v[60:63], v[16:19], v[216:223], v3
  v_smfmac_f32_16x16x64_bf16 v[60:63], v[20:23], v[224:231], v3
  s_waitcnt lgkmcnt(4)
  v_smfmac_f32_16x16x64_bf16 v[64:67], v[12:15], v[84:91], v3
  ds_read_b128 v[84:87], v1 offset:8192
  ds_read_b128 v[88:91], v1 offset:9216
  v_smfmac_f32_16x16x64_bf16 v[60:63], v[24:27], v[232:239], v3
  v_smfmac_f32_16x16x64_bf16 v[60:63], v[28:31], v[240:247], v3
  s_waitcnt lgkmcnt(4)
  v_smfmac_f32_16x16x64_bf16 v[64:67], v[16:19], v[92:99], v3
  ds_read_b128 v[92:95], v1 offset:10240
  ds_read_b128 v[96:99], v1 offset:11264
  v_smfmac_f32_16x16x64_bf16 v[60:63], v[32:35], v[248:255], v3
  v_smfmac_f32_16x16x64_bf16 v[36:39], v[8:11], a[0:7], v3
  s_waitcnt lgkmcnt(4)
  v_smfmac_f32_16x16x64_bf16 v[64:67], v[20:23], v[76:83], v3
  ds_read_b128 v[76:79], v1 offset:12288
  ds_read_b128 v[80:83], v1 offset:13312
  v_smfmac_f32_16x16x64_bf16 v[36:39], v[12:15], a[8:15], v3
  v_add_f32 v60, v60, v61
  v_smfmac_f32_16x16x64_bf16 v[36:39], v[16:19], a[16:23], v3
  v_add_f32 v62, v62, v63
  s_waitcnt lgkmcnt(4)
  v_smfmac_f32_16x16x64_bf16 v[64:67], v[24:27], v[84:91], v3
  v_cvt_pk_bf16_f32 v60, v60, v62
  v_smfmac_f32_16x16x64_bf16 v[36:39], v[20:23], a[24:31], v3
  ds_write_b32 v106, v60
  v_smfmac_f32_16x16x64_bf16 v[36:39], v[24:27], a[32:39], v3
  s_waitcnt lgkmcnt(2)
  v_smfmac_f32_16x16x64_bf16 v[64:67], v[28:31], v[92:99], v3
  v_smfmac_f32_16x16x64_bf16 v[36:39], v[28:31], a[40:47], v3
  v_smfmac_f32_16x16x64_bf16 v[36:39], v[32:35], a[48:55], v3
  s_waitcnt lgkmcnt(0)
  v_smfmac_f32_16x16x64_bf16 v[64:67], v[32:35], v[76:83], v3
  v_smfmac_f32_16x16x64_bf16 v[40:43], v[8:11], a[56:63], v3
  v_smfmac_f32_16x16x64_bf16 v[40:43], v[12:15], a[64:71], v3
  v_add_f32 v36, v36, v37
  v_smfmac_f32_16x16x64_bf16 v[40:43], v[16:19], a[72:79], v3
  v_add_f32 v38, v38, v39
  v_smfmac_f32_16x16x64_bf16 v[40:43], v[20:23], a[80:87], v3
  v_cvt_pk_bf16_f32 v36, v36, v38
  v_smfmac_f32_16x16x64_bf16 v[40:43], v[24:27], a[88:95], v3
  ds_write_b32 v100, v36
  v_smfmac_f32_16x16x64_bf16 v[40:43], v[28:31], a[96:103], v3
  v_add_f32 v64, v64, v65
  v_smfmac_f32_16x16x64_bf16 v[40:43], v[32:35], a[104:111], v3
  v_add_f32 v66, v66, v67
  v_smfmac_f32_16x16x64_bf16 v[44:47], v[8:11], a[112:119], v3
  v_cvt_pk_bf16_f32 v64, v64, v66
  v_smfmac_f32_16x16x64_bf16 v[44:47], v[12:15], a[120:127], v3
  ds_write_b32 v107, v64
  v_smfmac_f32_16x16x64_bf16 v[44:47], v[16:19], a[128:135], v3
  v_add_f32 v40, v40, v41
  v_smfmac_f32_16x16x64_bf16 v[44:47], v[20:23], a[136:143], v3
  v_add_f32 v42, v42, v43
  v_smfmac_f32_16x16x64_bf16 v[44:47], v[24:27], a[144:151], v3
  v_cvt_pk_bf16_f32 v40, v40, v42
  v_smfmac_f32_16x16x64_bf16 v[44:47], v[28:31], a[152:159], v3
  ds_write_b32 v101, v40
  v_smfmac_f32_16x16x64_bf16 v[44:47], v[32:35], a[160:167], v3
  v_smfmac_f32_16x16x64_bf16 v[48:51], v[8:11], a[168:175], v3
  v_smfmac_f32_16x16x64_bf16 v[48:51], v[12:15], a[176:183], v3
  v_smfmac_f32_16x16x64_bf16 v[48:51], v[16:19], a[184:191], v3
  v_add_f32 v44, v44, v45
  v_smfmac_f32_16x16x64_bf16 v[48:51], v[20:23], a[192:199], v3
  v_add_f32 v46, v46, v47
  v_smfmac_f32_16x16x64_bf16 v[48:51], v[24:27], a[200:207], v3
  v_cvt_pk_bf16_f32 v44, v44, v46
  v_smfmac_f32_16x16x64_bf16 v[48:51], v[28:31], a[208:215], v3
  ds_write_b32 v102, v44
  v_smfmac_f32_16x16x64_bf16 v[48:51], v[32:35], a[216:223], v3
  v_smfmac_f32_16x16x64_bf16 v[52:55], v[8:11], a[224:231], v3
  v_smfmac_f32_16x16x64_bf16 v[52:55], v[12:15], a[232:239], v3
  v_smfmac_f32_16x16x64_bf16 v[52:55], v[16:19], a[240:247], v3
  v_add_f32 v48, v48, v49
  v_smfmac_f32_16x16x64_bf16 v[52:55], v[20:23], a[248:255], v3
  v_add_f32 v50, v50, v51
  v_smfmac_f32_16x16x64_bf16 v[52:55], v[24:27], v[120:127], v3
  v_cvt_pk_bf16_f32 v48, v48, v50
  v_smfmac_f32_16x16x64_bf16 v[52:55], v[28:31], v[128:135], v3
  ds_write_b32 v103, v48
  v_smfmac_f32_16x16x64_bf16 v[52:55], v[32:35], v[136:143], v3
  v_smfmac_f32_16x16x64_bf16 v[56:59], v[8:11], v[144:151], v3
  v_smfmac_f32_16x16x64_bf16 v[56:59], v[12:15], v[152:159], v3
  v_smfmac_f32_16x16x64_bf16 v[56:59], v[16:19], v[160:167], v3
  v_add_f32 v52, v52, v53
  v_smfmac_f32_16x16x64_bf16 v[56:59], v[20:23], v[168:175], v3
  v_add_f32 v54, v54, v55
  v_smfmac_f32_16x16x64_bf16 v[56:59], v[24:27], v[176:183], v3
  v_cvt_pk_bf16_f32 v52, v52, v54
  v_smfmac_f32_16x16x64_bf16 v[56:59], v[28:31], v[184:191], v3
  ds_write_b32 v104, v52
  v_smfmac_f32_16x16x64_bf16 v[56:59], v[32:35], v[192:199], v3
  s_nop 7
  v_add_f32 v56, v56, v57
  v_add_f32 v58, v58, v59
  v_cvt_pk_bf16_f32 v56, v56, v58
  ds_write_b32 v105, v56
  s_waitcnt lgkmcnt(0)
  s_barrier
  s_cmp_eq_u32 s19, 62
  s_cbranch_scc1 cB_done
  s_waitcnt vmcnt(0) lgkmcnt(0)
  s_add_u32 s19, s19, 1
  s_mov_b32 s20, s21
  s_branch cB_va3_loop
cB_va3_retry:
  s_waitcnt lgkmcnt(0)
  buffer_load_dwordx4 v[24:27], v2, s[8:11], s23 offen offset:0 sc1
  buffer_load_dwordx4 v[28:31], v2, s[8:11], s23 offen offset:1024 sc1
  buffer_load_dwordx4 v[32:35], v2, s[8:11], s23 offen offset:2048 sc1
  s_add_u32 s31, s31, 1
  s_add_u32 s30, s30, 1
  s_cmp_lt_u32 s30, 400000
  s_cbranch_scc1 cB_va3_ld
  s_branch cB_abort
cB_va3_last:
  s_waitcnt lgkmcnt(0)
  buffer_store_dwordx4 v[100:103], v2, s[8:11], s24 offen offset:0 sc1
  buffer_store_dwordx4 v[104:107], v2, s[8:11], s24 offen offset:1024 sc1
  buffer_store_dwordx4 v[108:111], v2, s[8:11], s24 offen offset:2048 sc1
  buffer_store_dwordx4 v[4:7], v2, s[8:11], s24 offen offset:3072 sc1
  s_add_u32 s24, s24, 8192
  s_waitcnt vmcnt(0)
  s_mov_b64 exec, 1
  buffer_store_dword v117, v2, s[8:11], s34 offen sc1
  s_mov_b64 exec, -1
  s_add_u32 s34, s34, 8
  s_mov_b64 exec, 1
  buffer_store_dword v117, v2, s[8:11], s34 offen sc1
  s_mov_b64 exec, -1
  s_add_u32 s34, s34, 8
  s_branch cB_done
cB_abort:
  v_mov_b32 v4, 0xdead
  v_mov_b32 v5, 16
  buffer_store_dword v4, v5, s[12:15], 0 offen
  s_branch ch_end
cB_done:
  s_branch ch_end
m_reclaim:
  s_waitcnt vmcnt(0)
  s_lshr_b32 s20, s3, 5
  s_cmp_lg_u32 s16, 0
  s_cbranch_scc1 w0_17
  s_mov_b32 s21, 0
  s_mov_b64 exec, 1
rc_l:
  s_cmp_lg_u32 s70, -1
  s_cbranch_scc1 rc_t
  s_add_u32 s20, s20, 1
  s_cmp_lt_u32 s20, 8
  s_cselect_b32 s20, s20, 0
  s_mov_b32 s70, 0
  s_mov_b32 s3, -1
  s_add_u32 s21, s21, 1
  s_cmp_ge_u32 s21, 9
  s_cbranch_scc1 rc_d
rc_t:
  s_ff0_i32_b32 s22, s70
  s_lshl_b32 s23, 1, s22
  s_and_b32 s71, s20, 4
  s_mul_i32 s71, s71, 12
  s_lshl_b32 s3, s20, 2
  s_add_u32 s3, s3, s71
  v_mov_b32 v242, s23
  v_mov_b32 v243, 32
  buffer_atomic_or v242, v243, s[12:15], s3 offen sc0
  s_waitcnt vmcnt(0)
  v_readfirstlane_b32 s70, v242
  s_lshl_b32 s3, s20, 5
  s_add_u32 s3, s3, s22
  s_bitcmp1_b32 s70, s22
  s_cbranch_scc1 rc_l
rc_d:
  s_mov_b64 exec, -1
  v_mov_b32 v242, s3
w0_17:
  v_mov_b32 v250, 160000
  s_add_u32 s101, s101, 1
  s_barrier
  s_mov_b64 exec, 1
  s_cmp_lg_u32 s16, 0
  s_cbranch_scc1 w0_18
  ds_write_b32 v250, v242 offset:0
  s_waitcnt lgkmcnt(0)
  v_mov_b32 v242, s101
  ds_write_b32 v250, v242 offset:16
  s_waitcnt lgkmcnt(0)
w0_18:
  s_mov_b64 exec, -1
  s_barrier
  ds_read_b32 v242, v250 offset:0
  ds_read_b32 v250, v250 offset:16
  s_waitcnt lgkmcnt(0)
  v_readfirstlane_b32 s3, v242
  v_cmp_ne_u32 vcc, s101, v250
  s_cbranch_vccnz ch_end
  s_cmp_lg_u32 s3, -1
  s_cbranch_scc1 m_start
  v_mov_b32 v250, 0
  s_branch wk_ask
m_bjob:
  v_and_b32 v1, 63, v0
  v_lshlrev_b32 v2, 4, v1
  v_lshrrev_b32 v3, 4, v1
  v_and_b32 v4, 15, v1
  s_sub_u32 s18, s3, 32
  s_mul_i32 s17, s18, 4682
  s_lshr_b32 s17, s17, 16
  s_mul_i32 s20, s17, 14
  s_sub_u32 s19, s18, s20
  s_cmp_ge_u32 s19, 7
  s_cselect_b32 s31, 7, 0
  s_sub_u32 s19, s19, s31
  s_mov_b32 s60, s44
  s_and_b32 s61, s45, 0xffff
  s_mov_b32 s62, 3670016
  s_mov_b32 s63, 0x20000
  s_mov_b32 s56, s46
  s_and_b32 s57, s47, 0xffff
  s_mov_b32 s58, 3670016
  s_mov_b32 s59, 0x20000
  s_lshl_b32 s30, s16, 13
  s_mul_i32 s27, s17, 229376
  s_lshl_b32 s29, s19, 7
  s_add_u32 s27, s27, s29
  v_lshrrev_b32 v7, 3, v1
  v_and_b32 v8, 7, v1
  v_and_b32 v9, 2, v7
  v_xor_b32 v8, v8, v9
  s_lshl_b32 s29, s16, 6
  v_add_u32 v7, s29, v7
  v_mul_u32_u24 v7, 896, v7
  v_lshl_add_u32 v7, v8, 4, v7
  v_xor_b32 v8, 64, v7
  s_add_u32 m0, s30, 0
  s_add_u32 s22, s27, 0
  buffer_load_dwordx4 v7, s[56:59], s22 offen offset:0 lds
  s_add_u32 s22, s27, 6144
  buffer_load_dwordx4 v8, s[56:59], s22 offen offset:1024 lds
  s_add_u32 s22, s27, 12288
  buffer_load_dwordx4 v7, s[56:59], s22 offen offset:2048 lds
  s_add_u32 s22, s27, 18432
  buffer_load_dwordx4 v8, s[56:59], s22 offen offset:3072 lds
  s_add_u32 m0, s30, 4096
  s_add_u32 s22, s27, 28672
  buffer_load_dwordx4 v7, s[56:59], s22 offen offset:0 lds
  s_add_u32 s22, s27, 34816
  buffer_load_dwordx4 v8, s[56:59], s22 offen offset:1024 lds
  s_add_u32 s22, s27, 40960
  buffer_load_dwordx4 v7, s[56:59], s22 offen offset:2048 lds
  s_add_u32 s22, s27, 47104
  buffer_load_dwordx4 v8, s[56:59], s22 offen offset:3072 lds
  v_lshrrev_b32 v5, 5, v1
  v_and_b32 v6, 31, v1
  s_lshl_b32 s25, s16, 15
  s_add_u32 s25, s25, 32768
  s_lshl_b32 s26, s17, 9
  s_add_u32 s28, s19, s16
  s_cmp_ge_u32 s28, 7
  s_cselect_b32 s20, 7, 0
  s_sub_u32 s28, s28, s20
  s_add_u32 s28, s28, s31
  s_add_u32 s29, s19, s16
  s_add_u32 s29, s29, 4
  s_cmp_ge_u32 s29, 7
  s_cselect_b32 s20, 7, 0
  s_sub_u32 s29, s29, s20
  s_add_u32 s29, s29, s31
  s_lshl_b32 s32, s28, 18
  s_add_u32 s32, s32, s26
  s_lshl_b32 s33, s29, 18
  s_add_u32 s33, s33, s26
  v_xor_b32 v8, v6, v5
  v_lshlrev_b32 v8, 4, v8
  v_lshl_add_u32 v8, v5, 13, v8
  v_xor_b32 v12, 0, v8
  v_xor_b32 v13, 32, v8
  v_add_u32 v13, 15360, v13
  v_xor_b32 v14, 0, v8
  v_add_u32 v14, 30720, v14
  v_xor_b32 v15, 32, v8
  v_add_u32 v15, 46080, v15
  s_add_u32 s20, s16, 0
  s_and_b32 s20, s20, 3
  s_mul_i32 s21, s20, 65600
  s_lshl_b32 s20, s20, 12
  s_add_u32 s48, s20, s25
  s_mov_b32 m0, s48
  v_xor_b32 v16, s21, v12
  buffer_load_dwordx4 v16, s[60:63], s32 offen offset:0 lds
  v_xor_b32 v17, s21, v13
  buffer_load_dwordx4 v17, s[60:63], s32 offen offset:1024 lds
  v_xor_b32 v18, s21, v14
  buffer_load_dwordx4 v18, s[60:63], s32 offen offset:2048 lds
  v_xor_b32 v19, s21, v15
  buffer_load_dwordx4 v19, s[60:63], s32 offen offset:3072 lds
  s_add_u32 s20, s16, 1
  s_and_b32 s20, s20, 3
  s_mul_i32 s21, s20, 65600
  s_lshl_b32 s20, s20, 12
  s_add_u32 s49, s20, s25
  s_mov_b32 m0, s49
  v_xor_b32 v20, s21, v12
  buffer_load_dwordx4 v20, s[60:63], s32 offen offset:0 lds
  v_xor_b32 v21, s21, v13
  buffer_load_dwordx4 v21, s[60:63], s32 offen offset:1024 lds
  v_xor_b32 v22, s21, v14
  buffer_load_dwordx4 v22, s[60:63], s32 offen offset:2048 lds
  v_xor_b32 v23, s21, v15
  buffer_load_dwordx4 v23, s[60:63], s32 offen offset:3072 lds
  s_add_u32 s20, s16, 2
  s_and_b32 s20, s20, 3
  s_mul_i32 s21, s20, 65600
  s_lshl_b32 s20, s20, 12
  s_add_u32 s50, s20, s25
  s_mov_b32 m0, s50
  v_xor_b32 v24, s21, v12
  buffer_load_dwordx4 v24, s[60:63], s32 offen offset:0 lds
  v_xor_b32 v25, s21, v13
  buffer_load_dwordx4 v25, s[60:63], s32 offen offset:1024 lds
  v_xor_b32 v26, s21, v14
  buffer_load_dwordx4 v26, s[60:63], s32 offen offset:2048 lds
  v_xor_b32 v27, s21, v15
  buffer_load_dwordx4 v27, s[60:63], s32 offen offset:3072 lds
  s_add_u32 s20, s16, 3
  s_and_b32 s20, s20, 3
  s_mul_i32 s21, s20, 65600
  s_lshl_b32 s20, s20, 12
  s_add_u32 s51, s20, s25
  s_mov_b32 m0, s51
  v_xor_b32 v28, s21, v12
  buffer_load_dwordx4 v28, s[60:63], s32 offen offset:0 lds
  v_xor_b32 v29, s21, v13
  buffer_load_dwordx4 v29, s[60:63], s32 offen offset:1024 lds
  v_xor_b32 v30, s21, v14
  buffer_load_dwordx4 v30, s[60:63], s32 offen offset:2048 lds
  v_xor_b32 v31, s21, v15
  buffer_load_dwordx4 v31, s[60:63], s32 offen offset:3072 lds
  s_cmp_lg_u32 s66, 0
  s_cbranch_scc1 bj_ci
  s_cmp_lg_u32 s16, 0
  s_cbranch_scc1 w0_19
  s_lshr_b32 s70, s3, 5
  s_and_b32 s71, s70, 4
  s_mul_i32 s71, s71, 12
  s_lshl_b32 s70, s70, 2
  s_add_u32 s70, s70, s71
  s_lshl_b32 s71, 1, s3
  v_mov_b32 v44, s71
  v_mov_b32 v45, 32
  s_mov_b64 exec, 1
  buffer_atomic_or v44, v45, s[12:15], s70 offen sc0
  buffer_load_dwordx2 v[46:47], v45, s[12:15], 0 offen offset:96 sc1
  s_mov_b64 exec, -1
w0_19:
bj_ci:
  s_lshl_b32 s30, s19, 6
  s_add_u32 s30, s30, 0
  s_cmp_lt_u32 s19, 4
  s_cselect_b32 s20, 0, 256
  s_sub_u32 s30, s30, s20
  v_add_u32 v8, s30, v4
  s_lshr_b32 s20, s20, 4
  s_cmp_lt_u32 s19, 4
  s_movk_i32 s21, 5462
  s_cselect_b32 s21, 4096, s21
  s_cselect_b32 s30, 16, 12
  v_mul_u32_u24 v10, s21, v8
  v_lshrrev_b32 v10, 16, v10
  v_mul_u32_u24 v11, s30, v10
  v_sub_u32 v32, v8, v11
  v_add_u32 v32, s20, v32
  s_mul_i32 s30, s17, 28
  v_add_u32 v32, s30, v32
  v_lshrrev_b32 v33, 4, v32
  v_and_b32 v32, 15, v32
  s_mov_b32 s30, 401408
  v_mul_lo_u32 v10, v10, s30
  v_mul_u32_u24 v33, 14336, v33
  v_add_u32 v10, v10, v33
  v_lshl_add_u32 v10, v3, 8, v10
  v_lshl_add_u32 v10, v32, 4, v10
  v_add_u32 v12, 6422528, v10
  s_lshl_b32 s30, s19, 6
  s_add_u32 s30, s30, 16
  s_cmp_lt_u32 s19, 4
  s_cselect_b32 s20, 0, 256
  s_sub_u32 s30, s30, s20
  v_add_u32 v8, s30, v4
  s_lshr_b32 s20, s20, 4
  s_cmp_lt_u32 s19, 4
  s_movk_i32 s21, 5462
  s_cselect_b32 s21, 4096, s21
  s_cselect_b32 s30, 16, 12
  v_mul_u32_u24 v10, s21, v8
  v_lshrrev_b32 v10, 16, v10
  v_mul_u32_u24 v11, s30, v10
  v_sub_u32 v32, v8, v11
  v_add_u32 v32, s20, v32
  s_mul_i32 s30, s17, 28
  v_add_u32 v32, s30, v32
  v_lshrrev_b32 v33, 4, v32
  v_and_b32 v32, 15, v32
  s_mov_b32 s30, 401408
  v_mul_lo_u32 v10, v10, s30
  v_mul_u32_u24 v33, 14336, v33
  v_add_u32 v10, v10, v33
  v_lshl_add_u32 v10, v3, 8, v10
  v_lshl_add_u32 v10, v32, 4, v10
  v_add_u32 v13, 6422528, v10
  s_lshl_b32 s30, s19, 6
  s_add_u32 s30, s30, 32
  s_cmp_lt_u32 s19, 4
  s_cselect_b32 s20, 0, 256
  s_sub_u32 s30, s30, s20
  v_add_u32 v8, s30, v4
  s_lshr_b32 s20, s20, 4
  s_cmp_lt_u32 s19, 4
  s_movk_i32 s21, 5462
  s_cselect_b32 s21, 4096, s21
  s_cselect_b32 s30, 16, 12
  v_mul_u32_u24 v10, s21, v8
  v_lshrrev_b32 v10, 16, v10
  v_mul_u32_u24 v11, s30, v10
  v_sub_u32 v32, v8, v11
  v_add_u32 v32, s20, v32
  s_mul_i32 s30, s17, 28
  v_add_u32 v32, s30, v32
  v_lshrrev_b32 v33, 4, v32
  v_and_b32 v32, 15, v32
  s_mov_b32 s30, 401408
  v_mul_lo_u32 v10, v10, s30
  v_mul_u32_u24 v33, 14336, v33
  v_add_u32 v10, v10, v33
  v_lshl_add_u32 v10, v3, 8, v10
  v_lshl_add_u32 v10, v32, 4, v10
  v_add_u32 v14, 6422528, v10
  s_lshl_b32 s30, s19, 6
  s_add_u32 s30, s30, 48
  s_cmp_lt_u32 s19, 4
  s_cselect_b32 s20, 0, 256
  s_sub_u32 s30, s30, s20
  v_add_u32 v8, s30, v4
  s_lshr_b32 s20, s20, 4
  s_cmp_lt_u32 s19, 4
  s_movk_i32 s21, 5462
  s_cselect_b32 s21, 4096, s21
  s_cselect_b32 s30, 16, 12
  v_mul_u32_u24 v10, s21, v8
  v_lshrrev_b32 v10, 16, v10
  v_mul_u32_u24 v11, s30, v10
  v_sub_u32 v32, v8, v11
  v_add_u32 v32, s20, v32
  s_mul_i32 s30, s17, 28
  v_add_u32 v32, s30, v32
  v_lshrrev_b32 v33, 4, v32
  v_and_b32 v32, 15, v32
  s_mov_b32 s30, 401408
  v_mul_lo_u32 v10, v10, s30
  v_mul_u32_u24 v33, 14336, v33
  v_add_u32 v10, v10, v33
  v_lshl_add_u32 v10, v3, 8, v10
  v_lshl_add_u32 v10, v32, 4, v10
  v_add_u32 v15, 6422528, v10
  v_lshrrev_b32 v7, 2, v4
  v_lshlrev_b32 v7, 3, v7
  v_and_b32 v8, 3, v4
  v_add_u32 v7, v7, v8
  v_xor_b32 v10, v3, v4
  v_lshlrev_b32 v10, 4, v10
  v_lshl_add_u32 v10, v7, 9, v10
  v_add_u32 v10, s25, v10
  v_xor_b32 v32, 0, v10
  v_xor_b32 v33, 64, v10
  v_xor_b32 v34, 128, v10
  v_xor_b32 v35, 192, v10
  v_lshrrev_b32 v7, 2, v4
  v_lshl_add_u32 v7, v3, 3, v7
  v_lshlrev_b32 v7, 7, v7
  v_and_b32 v8, 3, v4
  v_lshl_add_u32 v7, v8, 3, v7
  v_lshrrev_b32 v8, 3, v4
  v_lshl_add_u32 v7, v8, 5, v7
  v_and_b32 v8, 1, v3
  v_lshl_add_u32 v7, v8, 6, v7
  s_waitcnt vmcnt(16)
  s_barrier
  s_cmp_eq_u32 s16, 3
  s_cbranch_scc1 bj_np0
  s_add_u32 m0, s48, 16384
  s_nop 0
  buffer_load_dwordx4 v16, s[60:63], s33 offen offset:0 lds
  buffer_load_dwordx4 v17, s[60:63], s33 offen offset:1024 lds
  buffer_load_dwordx4 v18, s[60:63], s33 offen offset:2048 lds
  buffer_load_dwordx4 v19, s[60:63], s33 offen offset:3072 lds
bj_np0:
  v_xor_b32 v9, 0, v7
  ds_read_b64_tr_b16 v[128:129], v9 offset:0
  ds_read_b64_tr_b16 v[130:131], v9 offset:512
  ds_read_b64_tr_b16 v[132:133], v9 offset:4096
  ds_read_b64_tr_b16 v[134:135], v9 offset:4608
  ds_read_b64_tr_b16 v[136:137], v9 offset:8192
  ds_read_b64_tr_b16 v[138:139], v9 offset:8704
  ds_read_b64_tr_b16 v[140:141], v9 offset:12288
  ds_read_b64_tr_b16 v[142:143], v9 offset:12800
  s_waitcnt lgkmcnt(6)
  ds_read_b64_tr_b16 v[144:145], v9 offset:16384
  ds_read_b64_tr_b16 v[146:147], v9 offset:16896
  ds_read_b64_tr_b16 v[148:149], v9 offset:20480
  ds_read_b64_tr_b16 v[150:151], v9 offset:20992
  ds_read_b64_tr_b16 v[152:153], v9 offset:24576
  ds_read_b64_tr_b16 v[154:155], v9 offset:25088
  ds_read_b64_tr_b16 v[156:157], v9 offset:28672
  ds_read_b64_tr_b16 v[158:159], v9 offset:29184
  s_waitcnt lgkmcnt(6)
  s_cmp_eq_u32 s16, 3
  s_cbranch_scc1 bj_np1
  s_add_u32 m0, s49, 16384
  s_nop 0
  buffer_load_dwordx4 v20, s[60:63], s33 offen offset:0 lds
  buffer_load_dwordx4 v21, s[60:63], s33 offen offset:1024 lds
  buffer_load_dwordx4 v22, s[60:63], s33 offen offset:2048 lds
  buffer_load_dwordx4 v23, s[60:63], s33 offen offset:3072 lds
bj_np1:
  v_xor_b32 v9, 32, v7
  ds_read_b64_tr_b16 v[160:161], v9 offset:0
  ds_read_b64_tr_b16 v[162:163], v9 offset:512
  ds_read_b64_tr_b16 v[164:165], v9 offset:4096
  ds_read_b64_tr_b16 v[166:167], v9 offset:4608
  ds_read_b64_tr_b16 v[168:169], v9 offset:8192
  ds_read_b64_tr_b16 v[170:171], v9 offset:8704
  ds_read_b64_tr_b16 v[172:173], v9 offset:12288
  ds_read_b64_tr_b16 v[174:175], v9 offset:12800
  s_waitcnt lgkmcnt(6)
  ds_read_b64_tr_b16 v[176:177], v9 offset:16384
  ds_read_b64_tr_b16 v[178:179], v9 offset:16896
  ds_read_b64_tr_b16 v[180:181], v9 offset:20480
  ds_read_b64_tr_b16 v[182:183], v9 offset:20992
  ds_read_b64_tr_b16 v[184:185], v9 offset:24576
  ds_read_b64_tr_b16 v[186:187], v9 offset:25088
  ds_read_b64_tr_b16 v[188:189], v9 offset:28672
  ds_read_b64_tr_b16 v[190:191], v9 offset:29184
  s_waitcnt lgkmcnt(6)
  s_cmp_eq_u32 s16, 3
  s_cbranch_scc1 bj_np2
  s_add_u32 m0, s50, 16384
  s_nop 0
  buffer_load_dwordx4 v24, s[60:63], s33 offen offset:0 lds
  buffer_load_dwordx4 v25, s[60:63], s33 offen offset:1024 lds
  buffer_load_dwordx4 v26, s[60:63], s33 offen offset:2048 lds
  buffer_load_dwordx4 v27, s[60:63], s33 offen offset:3072 lds
bj_np2:
  v_xor_b32 v9, 64, v7
  ds_read_b64_tr_b16 v[192:193], v9 offset:0
  ds_read_b64_tr_b16 v[194:195], v9 offset:512
  ds_read_b64_tr_b16 v[196:197], v9 offset:4096
  ds_read_b64_tr_b16 v[198:199], v9 offset:4608
  ds_read_b64_tr_b16 v[200:201], v9 offset:8192
  ds_read_b64_tr_b16 v[202:203], v9 offset:8704
  ds_read_b64_tr_b16 v[204:205], v9 offset:12288
  ds_read_b64_tr_b16 v[206:207], v9 offset:12800
  s_waitcnt lgkmcnt(6)
  ds_read_b64_tr_b16 v[208:209], v9 offset:16384
  ds_read_b64_tr_b16 v[210:211], v9 offset:16896
  ds_read_b64_tr_b16 v[212:213], v9 offset:20480
  ds_read_b64_tr_b16 v[214:215], v9 offset:20992
  ds_read_b64_tr_b16 v[216:217], v9 offset:24576
  ds_read_b64_tr_b16 v[218:219], v9 offset:25088
  ds_read_b64_tr_b16 v[220:221], v9 offset:28672
  ds_read_b64_tr_b16 v[222:223], v9 offset:29184
  s_waitcnt lgkmcnt(6)
  s_cmp_eq_u32 s16, 3
  s_cbranch_scc1 bj_np3
  s_add_u32 m0, s51, 16384
  s_nop 0
  buffer_load_dwordx4 v28, s[60:63], s33 offen offset:0 lds
  buffer_load_dwordx4 v29, s[60:63], s33 offen offset:1024 lds
  buffer_load_dwordx4 v30, s[60:63], s33 offen offset:2048 lds
  buffer_load_dwordx4 v31, s[60:63], s33 offen offset:3072 lds
bj_np3:
  v_xor_b32 v9, 96, v7
  ds_read_b64_tr_b16 v[224:225], v9 offset:0
  ds_read_b64_tr_b16 v[226:227], v9 offset:512
  ds_read_b64_tr_b16 v[228:229], v9 offset:4096
  ds_read_b64_tr_b16 v[230:231], v9 offset:4608
  ds_read_b64_tr_b16 v[232:233], v9 offset:8192
  ds_read_b64_tr_b16 v[234:235], v9 offset:8704
  ds_read_b64_tr_b16 v[236:237], v9 offset:12288
  ds_read_b64_tr_b16 v[238:239], v9 offset:12800
  s_waitcnt lgkmcnt(6)
  ds_read_b64_tr_b16 v[240:241], v9 offset:16384
  ds_read_b64_tr_b16 v[242:243], v9 offset:16896
  ds_read_b64_tr_b16 v[244:245], v9 offset:20480
  ds_read_b64_tr_b16 v[246:247], v9 offset:20992
  ds_read_b64_tr_b16 v[248:249], v9 offset:24576
  ds_read_b64_tr_b16 v[250:251], v9 offset:25088
  ds_read_b64_tr_b16 v[252:253], v9 offset:28672
  ds_read_b64_tr_b16 v[254:255], v9 offset:29184
  s_waitcnt lgkmcnt(6)
  s_mov_b32 s52, s36
  s_and_b32 s53, s37, 0xffff
  s_mov_b32 s54, 1835008
  s_mov_b32 s55, 0x20000
  s_lshl_b32 s20, s18, 8
  v_add_u32 v95, s20, v0
  s_mov_b32 s21, 9586981
  v_mul_hi_u32 v6, v95, s21
  v_mul_u32_u24 v7, 448, v6
  v_sub_u32 v7, v95, v7
  v_lshrrev_b32 v8, 4, v7
  v_and_b32 v7, 15, v7
  v_lshl_add_u32 v9, v6, 4, v7
  v_mul_u32_u24 v9, 896, v9
  v_lshl_add_u32 v9, v8, 5, v9
  buffer_load_dwordx4 v[84:87], v9, s[52:55], 0 offen
  buffer_load_dwordx4 v[88:91], v9, s[52:55], 0 offen offset:16
  v_mul_u32_u24 v6, 14336, v6
  v_lshl_add_u32 v6, v7, 4, v6
  v_lshl_add_u32 v92, v8, 9, v6
  v_lshrrev_b32 v7, 2, v8
  v_lshl_add_u32 v6, v7, 11, v6
  v_and_b32 v7, 3, v8
  v_lshl_add_u32 v93, v7, 8, v6
  s_mov_b32 s72, s38
  s_and_b32 s73, s39, 0xffff
  s_mov_b32 s74, 7168
  s_mov_b32 s75, 0x20000
  v_min_u32 v6, 223, v0
  v_lshrrev_b32 v7, 3, v6
  v_and_b32 v6, 7, v6
  v_mul_u32_u24 v9, 896, v6
  v_lshl_add_u32 v9, v7, 5, v9
  buffer_load_dwordx4 v[36:39], v9, s[72:75], 0 offen
  buffer_load_dwordx4 v[40:43], v9, s[72:75], 0 offen offset:16
  v_lshlrev_b32 v7, 8, v7
  v_lshl_add_u32 v94, v6, 4, v7
  s_lshl_b32 s26, s17, 9
  s_waitcnt vmcnt(20) lgkmcnt(0)
  s_cmp_lg_u32 s16, 3
  s_cbranch_scc1 w3_20
  s_waitcnt vmcnt(4)
w3_20:
  ds_read_b128 v[52:55], v32 offset:0
  ds_read_b128 v[56:59], v33 offset:0
  ds_read_b128 v[60:63], v34 offset:0
  ds_read_b128 v[64:67], v35 offset:0
  s_waitcnt lgkmcnt(3)
  v_mfma_f32_16x16x32_bf16 v[96:99], v[52:55], v[128:131], 0
  v_mfma_f32_16x16x32_bf16 v[100:103], v[52:55], v[160:163], 0
  v_mfma_f32_16x16x32_bf16 v[104:107], v[52:55], v[192:195], 0
  v_mfma_f32_16x16x32_bf16 v[108:111], v[52:55], v[224:227], 0
  ds_read_b128 v[52:55], v32 offset:256
  s_waitcnt lgkmcnt(3)
  v_mfma_f32_16x16x32_bf16 v[96:99], v[56:59], v[132:135], v[96:99]
  v_mfma_f32_16x16x32_bf16 v[100:103], v[56:59], v[164:167], v[100:103]
  v_mfma_f32_16x16x32_bf16 v[104:107], v[56:59], v[196:199], v[104:107]
  v_mfma_f32_16x16x32_bf16 v[108:111], v[56:59], v[228:231], v[108:111]
  ds_read_b128 v[56:59], v33 offset:256
  s_waitcnt lgkmcnt(3)
  v_mfma_f32_16x16x32_bf16 v[96:99], v[60:63], v[136:139], v[96:99]
  v_mfma_f32_16x16x32_bf16 v[100:103], v[60:63], v[168:171], v[100:103]
  v_mfma_f32_16x16x32_bf16 v[104:107], v[60:63], v[200:203], v[104:107]
  v_mfma_f32_16x16x32_bf16 v[108:111], v[60:63], v[232:235], v[108:111]
  ds_read_b128 v[60:63], v34 offset:256
  s_waitcnt lgkmcnt(3)
  v_mfma_f32_16x16x32_bf16 v[96:99], v[64:67], v[140:143], v[96:99]
  v_mfma_f32_16x16x32_bf16 v[100:103], v[64:67], v[172:175], v[100:103]
  v_mfma_f32_16x16x32_bf16 v[104:107], v[64:67], v[204:207], v[104:107]
  v_mfma_f32_16x16x32_bf16 v[108:111], v[64:67], v[236:239], v[108:111]
  ds_read_b128 v[64:67], v35 offset:256
  s_waitcnt lgkmcnt(3)
  v_mfma_f32_16x16x32_bf16 v[96:99], v[52:55], v[144:147], v[96:99]
  v_mfma_f32_16x16x32_bf16 v[100:103], v[52:55], v[176:179], v[100:103]
  v_mfma_f32_16x16x32_bf16 v[104:107], v[52:55], v[208:211], v[104:107]
  v_mfma_f32_16x16x32_bf16 v[108:111], v[52:55], v[240:243], v[108:111]
  ds_read_b128 v[52:55], v32 offset:2048
  s_waitcnt lgkmcnt(3)
  v_mfma_f32_16x16x32_bf16 v[96:99], v[56:59], v[148:151], v[96:99]
  v_mfma_f32_16x16x32_bf16 v[100:103], v[56:59], v[180:183], v[100:103]
  v_mfma_f32_16x16x32_bf16 v[104:107], v[56:59], v[212:215], v[104:107]
  v_mfma_f32_16x16x32_bf16 v[108:111], v[56:59], v[244:247], v[108:111]
  ds_read_b128 v[56:59], v33 offset:2048
  s_waitcnt lgkmcnt(3)
  v_mfma_f32_16x16x32_bf16 v[96:99], v[60:63], v[152:155], v[96:99]
  v_mfma_f32_16x16x32_bf16 v[100:103], v[60:63], v[184:187], v[100:103]
  v_mfma_f32_16x16x32_bf16 v[104:107], v[60:63], v[216:219], v[104:107]
  v_mfma_f32_16x16x32_bf16 v[108:111], v[60:63], v[248:251], v[108:111]
  ds_read_b128 v[60:63], v34 offset:2048
  s_waitcnt lgkmcnt(3)
  v_mfma_f32_16x16x32_bf16 v[96:99], v[64:67], v[156:159], v[96:99]
  v_mfma_f32_16x16x32_bf16 v[100:103], v[64:67], v[188:191], v[100:103]
  v_mfma_f32_16x16x32_bf16 v[104:107], v[64:67], v[220:223], v[104:107]
  v_mfma_f32_16x16x32_bf16 v[108:111], v[64:67], v[252:255], v[108:111]
  ds_read_b128 v[64:67], v35 offset:2048
  s_waitcnt lgkmcnt(3)
  v_mfma_f32_16x16x32_bf16 v[112:115], v[52:55], v[128:131], 0
  v_mfma_f32_16x16x32_bf16 v[116:119], v[52:55], v[160:163], 0
  v_mfma_f32_16x16x32_bf16 v[120:123], v[52:55], v[192:195], 0
  v_mfma_f32_16x16x32_bf16 v[124:127], v[52:55], v[224:227], 0
  ds_read_b128 v[52:55], v32 offset:2304
  s_waitcnt lgkmcnt(3)
  v_mfma_f32_16x16x32_bf16 v[112:115], v[56:59], v[132:135], v[112:115]
  v_mfma_f32_16x16x32_bf16 v[116:119], v[56:59], v[164:167], v[116:119]
  v_mfma_f32_16x16x32_bf16 v[120:123], v[56:59], v[196:199], v[120:123]
  v_mfma_f32_16x16x32_bf16 v[124:127], v[56:59], v[228:231], v[124:127]
  ds_read_b128 v[56:59], v33 offset:2304
  s_waitcnt lgkmcnt(3)
  v_mfma_f32_16x16x32_bf16 v[112:115], v[60:63], v[136:139], v[112:115]
  v_mfma_f32_16x16x32_bf16 v[116:119], v[60:63], v[168:171], v[116:119]
  v_mfma_f32_16x16x32_bf16 v[120:123], v[60:63], v[200:203], v[120:123]
  v_mfma_f32_16x16x32_bf16 v[124:127], v[60:63], v[232:235], v[124:127]
  ds_read_b128 v[60:63], v34 offset:2304
  s_waitcnt lgkmcnt(3)
  v_mfma_f32_16x16x32_bf16 v[112:115], v[64:67], v[140:143], v[112:115]
  v_mfma_f32_16x16x32_bf16 v[116:119], v[64:67], v[172:175], v[116:119]
  v_mfma_f32_16x16x32_bf16 v[120:123], v[64:67], v[204:207], v[120:123]
  v_mfma_f32_16x16x32_bf16 v[124:127], v[64:67], v[236:239], v[124:127]
  ds_read_b128 v[64:67], v35 offset:2304
  s_waitcnt lgkmcnt(3)
  v_mfma_f32_16x16x32_bf16 v[112:115], v[52:55], v[144:147], v[112:115]
  v_mfma_f32_16x16x32_bf16 v[116:119], v[52:55], v[176:179], v[116:119]
  v_mfma_f32_16x16x32_bf16 v[120:123], v[52:55], v[208:211], v[120:123]
  v_mfma_f32_16x16x32_bf16 v[124:127], v[52:55], v[240:243], v[124:127]
  s_waitcnt lgkmcnt(2)
  v_mfma_f32_16x16x32_bf16 v[112:115], v[56:59], v[148:151], v[112:115]
  v_mfma_f32_16x16x32_bf16 v[116:119], v[56:59], v[180:183], v[116:119]
  v_mfma_f32_16x16x32_bf16 v[120:123], v[56:59], v[212:215], v[120:123]
  v_mfma_f32_16x16x32_bf16 v[124:127], v[56:59], v[244:247], v[124:127]
  s_waitcnt lgkmcnt(1)
  v_mfma_f32_16x16x32_bf16 v[112:115], v[60:63], v[152:155], v[112:115]
  v_mfma_f32_16x16x32_bf16 v[116:119], v[60:63], v[184:187], v[116:119]
  v_mfma_f32_16x16x32_bf16 v[120:123], v[60:63], v[216:219], v[120:123]
  v_mfma_f32_16x16x32_bf16 v[124:127], v[60:63], v[248:251], v[124:127]
  s_waitcnt lgkmcnt(0)
  v_mfma_f32_16x16x32_bf16 v[112:115], v[64:67], v[156:159], v[112:115]
  v_mfma_f32_16x16x32_bf16 v[116:119], v[64:67], v[188:191], v[116:119]
  v_mfma_f32_16x16x32_bf16 v[120:123], v[64:67], v[220:223], v[120:123]
  v_mfma_f32_16x16x32_bf16 v[124:127], v[64:67], v[252:255], v[124:127]
  s_lshl_b32 s30, s28, 10
  v_cvt_pk_bf16_f32 v68, v96, v97
  v_cvt_pk_bf16_f32 v69, v98, v99
  v_cvt_pk_bf16_f32 v70, v112, v113
  v_cvt_pk_bf16_f32 v71, v114, v115
  buffer_store_dwordx4 v[68:71], v12, s[8:11], s30 offen sc1
  v_cvt_pk_bf16_f32 v72, v100, v101
  v_cvt_pk_bf16_f32 v73, v102, v103
  v_cvt_pk_bf16_f32 v74, v116, v117
  v_cvt_pk_bf16_f32 v75, v118, v119
  buffer_store_dwordx4 v[72:75], v13, s[8:11], s30 offen sc1
  v_cvt_pk_bf16_f32 v76, v104, v105
  v_cvt_pk_bf16_f32 v77, v106, v107
  v_cvt_pk_bf16_f32 v78, v120, v121
  v_cvt_pk_bf16_f32 v79, v122, v123
  buffer_store_dwordx4 v[76:79], v14, s[8:11], s30 offen sc1
  v_cvt_pk_bf16_f32 v80, v108, v109
  v_cvt_pk_bf16_f32 v81, v110, v111
  v_cvt_pk_bf16_f32 v82, v124, v125
  v_cvt_pk_bf16_f32 v83, v126, v127
  buffer_store_dwordx4 v[80:83], v15, s[8:11], s30 offen sc1
  s_cmp_eq_u32 s16, 3
  s_cbranch_scc1 bj_w3
  s_waitcnt vmcnt(8)
  ds_read_b128 v[52:55], v32 offset:16384
  ds_read_b128 v[56:59], v33 offset:16384
  ds_read_b128 v[60:63], v34 offset:16384
  ds_read_b128 v[64:67], v35 offset:16384
  s_waitcnt lgkmcnt(3)
  v_mfma_f32_16x16x32_bf16 v[96:99], v[52:55], v[128:131], 0
  v_mfma_f32_16x16x32_bf16 v[100:103], v[52:55], v[160:163], 0
  v_mfma_f32_16x16x32_bf16 v[104:107], v[52:55], v[192:195], 0
  v_mfma_f32_16x16x32_bf16 v[108:111], v[52:55], v[224:227], 0
  ds_read_b128 v[52:55], v32 offset:16640
  s_waitcnt lgkmcnt(3)
  v_mfma_f32_16x16x32_bf16 v[96:99], v[56:59], v[132:135], v[96:99]
  v_mfma_f32_16x16x32_bf16 v[100:103], v[56:59], v[164:167], v[100:103]
  v_mfma_f32_16x16x32_bf16 v[104:107], v[56:59], v[196:199], v[104:107]
  v_mfma_f32_16x16x32_bf16 v[108:111], v[56:59], v[228:231], v[108:111]
  ds_read_b128 v[56:59], v33 offset:16640
  s_waitcnt lgkmcnt(3)
  v_mfma_f32_16x16x32_bf16 v[96:99], v[60:63], v[136:139], v[96:99]
  v_mfma_f32_16x16x32_bf16 v[100:103], v[60:63], v[168:171], v[100:103]
  v_mfma_f32_16x16x32_bf16 v[104:107], v[60:63], v[200:203], v[104:107]
  v_mfma_f32_16x16x32_bf16 v[108:111], v[60:63], v[232:235], v[108:111]
  ds_read_b128 v[60:63], v34 offset:16640
  s_waitcnt lgkmcnt(3)
  v_mfma_f32_16x16x32_bf16 v[96:99], v[64:67], v[140:143], v[96:99]
  v_mfma_f32_16x16x32_bf16 v[100:103], v[64:67], v[172:175], v[100:103]
  v_mfma_f32_16x16x32_bf16 v[104:107], v[64:67], v[204:207], v[104:107]
  v_mfma_f32_16x16x32_bf16 v[108:111], v[64:67], v[236:239], v[108:111]
  ds_read_b128 v[64:67], v35 offset:16640
  s_waitcnt lgkmcnt(3)
  v_mfma_f32_16x16x32_bf16 v[96:99], v[52:55], v[144:147], v[96:99]
  v_mfma_f32_16x16x32_bf16 v[100:103], v[52:55], v[176:179], v[100:103]
  v_mfma_f32_16x16x32_bf16 v[104:107], v[52:55], v[208:211], v[104:107]
  v_mfma_f32_16x16x32_bf16 v[108:111], v[52:55], v[240:243], v[108:111]
  ds_read_b128 v[52:55], v32 offset:18432
  s_waitcnt lgkmcnt(3)
  v_mfma_f32_16x16x32_bf16 v[96:99], v[56:59], v[148:151], v[96:99]
  v_mfma_f32_16x16x32_bf16 v[100:103], v[56:59], v[180:183], v[100:103]
  v_mfma_f32_16x16x32_bf16 v[104:107], v[56:59], v[212:215], v[104:107]
  v_mfma_f32_16x16x32_bf16 v[108:111], v[56:59], v[244:247], v[108:111]
  ds_read_b128 v[56:59], v33 offset:18432
  s_waitcnt lgkmcnt(3)
  v_mfma_f32_16x16x32_bf16 v[96:99], v[60:63], v[152:155], v[96:99]
  v_mfma_f32_16x16x32_bf16 v[100:103], v[60:63], v[184:187], v[100:103]
  v_mfma_f32_16x16x32_bf16 v[104:107], v[60:63], v[216:219], v[104:107]
  v_mfma_f32_16x16x32_bf16 v[108:111], v[60:63], v[248:251], v[108:111]
  ds_read_b128 v[60:63], v34 offset:18432
  s_waitcnt lgkmcnt(3)
  v_mfma_f32_16x16x32_bf16 v[96:99], v[64:67], v[156:159], v[96:99]
  v_mfma_f32_16x16x32_bf16 v[100:103], v[64:67], v[188:191], v[100:103]
  v_mfma_f32_16x16x32_bf16 v[104:107], v[64:67], v[220:223], v[104:107]
  v_mfma_f32_16x16x32_bf16 v[108:111], v[64:67], v[252:255], v[108:111]
  ds_read_b128 v[64:67], v35 offset:18432
  s_waitcnt lgkmcnt(3)
  v_mfma_f32_16x16x32_bf16 v[112:115], v[52:55], v[128:131], 0
  v_mfma_f32_16x16x32_bf16 v[116:119], v[52:55], v[160:163], 0
  v_mfma_f32_16x16x32_bf16 v[120:123], v[52:55], v[192:195], 0
  v_mfma_f32_16x16x32_bf16 v[124:127], v[52:55], v[224:227], 0
  ds_read_b128 v[52:55], v32 offset:18688
  s_waitcnt lgkmcnt(3)
  v_mfma_f32_16x16x32_bf16 v[112:115], v[56:59], v[132:135], v[112:115]
  v_mfma_f32_16x16x32_bf16 v[116:119], v[56:59], v[164:167], v[116:119]
  v_mfma_f32_16x16x32_bf16 v[120:123], v[56:59], v[196:199], v[120:123]
  v_mfma_f32_16x16x32_bf16 v[124:127], v[56:59], v[228:231], v[124:127]
  ds_read_b128 v[56:59], v33 offset:18688
  s_waitcnt lgkmcnt(3)
  v_mfma_f32_16x16x32_bf16 v[112:115], v[60:63], v[136:139], v[112:115]
  v_mfma_f32_16x16x32_bf16 v[116:119], v[60:63], v[168:171], v[116:119]
  v_mfma_f32_16x16x32_bf16 v[120:123], v[60:63], v[200:203], v[120:123]
  v_mfma_f32_16x16x32_bf16 v[124:127], v[60:63], v[232:235], v[124:127]
  ds_read_b128 v[60:63], v34 offset:18688
  s_waitcnt lgkmcnt(3)
  v_mfma_f32_16x16x32_bf16 v[112:115], v[64:67], v[140:143], v[112:115]
  v_mfma_f32_16x16x32_bf16 v[116:119], v[64:67], v[172:175], v[116:119]
  v_mfma_f32_16x16x32_bf16 v[120:123], v[64:67], v[204:207], v[120:123]
  v_mfma_f32_16x16x32_bf16 v[124:127], v[64:67], v[236:239], v[124:127]
  ds_read_b128 v[64:67], v35 offset:18688
  s_waitcnt lgkmcnt(3)
  v_mfma_f32_16x16x32_bf16 v[112:115], v[52:55], v[144:147], v[112:115]
  v_mfma_f32_16x16x32_bf16 v[116:119], v[52:55], v[176:179], v[116:119]
  v_mfma_f32_16x16x32_bf16 v[120:123], v[52:55], v[208:211], v[120:123]
  v_mfma_f32_16x16x32_bf16 v[124:127], v[52:55], v[240:243], v[124:127]
  s_waitcnt lgkmcnt(2)
  v_mfma_f32_16x16x32_bf16 v[112:115], v[56:59], v[148:151], v[112:115]
  v_mfma_f32_16x16x32_bf16 v[116:119], v[56:59], v[180:183], v[116:119]
  v_mfma_f32_16x16x32_bf16 v[120:123], v[56:59], v[212:215], v[120:123]
  v_mfma_f32_16x16x32_bf16 v[124:127], v[56:59], v[244:247], v[124:127]
  s_waitcnt lgkmcnt(1)
  v_mfma_f32_16x16x32_bf16 v[112:115], v[60:63], v[152:155], v[112:115]
  v_mfma_f32_16x16x32_bf16 v[116:119], v[60:63], v[184:187], v[116:119]
  v_mfma_f32_16x16x32_bf16 v[120:123], v[60:63], v[216:219], v[120:123]
  v_mfma_f32_16x16x32_bf16 v[124:127], v[60:63], v[248:251], v[124:127]
  s_waitcnt lgkmcnt(0)
  v_mfma_f32_16x16x32_bf16 v[112:115], v[64:67], v[156:159], v[112:115]
  v_mfma_f32_16x16x32_bf16 v[116:119], v[64:67], v[188:191], v[116:119]
  v_mfma_f32_16x16x32_bf16 v[120:123], v[64:67], v[220:223], v[120:123]
  v_mfma_f32_16x16x32_bf16 v[124:127], v[64:67], v[252:255], v[124:127]
  s_lshl_b32 s30, s29, 10
  v_cvt_pk_bf16_f32 v68, v96, v97
  v_cvt_pk_bf16_f32 v69, v98, v99
  v_cvt_pk_bf16_f32 v70, v112, v113
  v_cvt_pk_bf16_f32 v71, v114, v115
  buffer_store_dwordx4 v[68:71], v12, s[8:11], s30 offen sc1
  v_cvt_pk_bf16_f32 v72, v100, v101
  v_cvt_pk_bf16_f32 v73, v102, v103
  v_cvt_pk_bf16_f32 v74, v116, v117
  v_cvt_pk_bf16_f32 v75, v118, v119
  buffer_store_dwordx4 v[72:75], v13, s[8:11], s30 offen sc1
  v_cvt_pk_bf16_f32 v76, v104, v105
  v_cvt_pk_bf16_f32 v77, v106, v107
  v_cvt_pk_bf16_f32 v78, v120, v121
  v_cvt_pk_bf16_f32 v79, v122, v123
  buffer_store_dwordx4 v[76:79], v14, s[8:11], s30 offen sc1
  v_cvt_pk_bf16_f32 v80, v108, v109
  v_cvt_pk_bf16_f32 v81, v110, v111
  v_cvt_pk_bf16_f32 v82, v124, v125
  v_cvt_pk_bf16_f32 v83, v126, v127
  buffer_store_dwordx4 v[80:83], v15, s[8:11], s30 offen sc1
bj_w3:
  s_lshl_b32 s77, s19, 8
  s_lshl_b32 s21, s17, 4
  s_add_u32 s77, s77, s21
  s_cmp_lg_u32 s31, 0
  s_cselect_b32 s21, 8, 0
  s_add_u32 s77, s77, s21
  s_add_u32 s77, s77, 88600576
  s_add_u32 s78, s77, 2048
  s_cmp_lg_u32 s66, 0
  s_cbranch_scc1 bj_cf
  s_cmp_lg_u32 s16, 0
  s_cbranch_scc1 w0_21
  s_waitcnt vmcnt(8)
  v_readfirstlane_b32 s70, v46
  s_cmp_lg_u32 s70, 0
  s_cbranch_scc1 bj_nz
  v_mov_b32 v45, 128
  v_mov_b32 v46, s88
  v_mov_b32 v47, s89
  v_mov_b32 v48, 0
  v_mov_b32 v49, 0
  s_mov_b64 exec, 1
  buffer_atomic_cmpswap_x2 v[46:49], v45, s[12:15], 0 offen sc0
  s_mov_b64 exec, -1
  s_waitcnt vmcnt(0)
  v_readfirstlane_b32 s70, v46
  s_cmp_lg_u32 s70, 0
  s_cbranch_scc1 bj_nz
  v_mov_b32 v46, s88
  v_mov_b32 v47, s89
bj_nz:
w0_21:
  v_mov_b32 v45, 160000
  s_add_u32 s101, s101, 1
  s_barrier
  s_mov_b64 exec, 1
  s_cmp_lg_u32 s16, 0
  s_cbranch_scc1 w0_22
  ds_write_b32 v45, v44 offset:0
  ds_write_b32 v45, v46 offset:4
  ds_write_b32 v45, v47 offset:8
  s_waitcnt lgkmcnt(0)
  v_mov_b32 v44, s101
  ds_write_b32 v45, v44 offset:16
  s_waitcnt lgkmcnt(0)
w0_22:
  s_mov_b64 exec, -1
  s_barrier
  ds_read_b32 v44, v45 offset:0
  ds_read_b32 v46, v45 offset:4
  ds_read_b32 v47, v45 offset:8
  ds_read_b32 v45, v45 offset:16
  s_waitcnt lgkmcnt(0)
  v_readfirstlane_b32 s70, v44
  v_readfirstlane_b32 s88, v46
  v_readfirstlane_b32 s89, v47
  v_cmp_ne_u32 vcc, s101, v45
  s_cbranch_vccnz ch_end
  s_mov_b32 s66, 1
  s_bitcmp1_b32 s70, s3
  s_cbranch_scc1 m_reclaim
bj_cf:
  s_barrier
  s_mov_b32 s56, s40
  s_and_b32 s57, s41, 0xffff
  s_mov_b32 s58, 3670016
  s_mov_b32 s59, 0x20000
  s_mov_b32 s60, s42
  s_and_b32 s61, s43, 0xffff
  s_mov_b32 s62, 3670016
  s_mov_b32 s63, 0x20000
  s_add_u32 s28, s31, s19
  v_lshrrev_b32 v5, 5, v1
  v_and_b32 v6, 31, v1
  v_xor_b32 v6, v6, v5
  v_lshlrev_b32 v6, 4, v6
  v_lshl_add_u32 v6, v5, 13, v6
  s_lshl_b32 s20, s16, 6
  v_xor_b32 v7, s20, v6
  s_lshl_b32 s22, s28, 18
  s_lshl_b32 s21, s16, 16
  s_add_u32 s22, s22, s21
  s_add_u32 s22, s22, s26
  s_lshl_b32 m0, s16, 12
  v_xor_b32 v8, 0, v7
  buffer_load_dwordx4 v8, s[56:59], s22 offen offset:0 lds
  v_xor_b32 v8, 32, v7
  v_add_u32 v8, 15360, v8
  buffer_load_dwordx4 v8, s[56:59], s22 offen offset:1024 lds
  v_xor_b32 v8, 0, v7
  v_add_u32 v8, 30720, v8
  buffer_load_dwordx4 v8, s[56:59], s22 offen offset:2048 lds
  v_xor_b32 v8, 32, v7
  v_add_u32 v8, 46080, v8
  buffer_load_dwordx4 v8, s[56:59], s22 offen offset:3072 lds
  v_xor_b32 v16, 0, v6
  v_xor_b32 v17, 32, v6
  v_add_u32 v17, 31744, v17
  v_xor_b32 v18, 64, v6
  v_add_u32 v18, 129024, v18
  v_xor_b32 v19, 96, v6
  v_add_u32 v19, 160768, v19
  v_xor_b32 v20, 128, v6
  v_add_u32 v20, 262144, v20
  v_xor_b32 v21, 160, v6
  v_add_u32 v21, 293888, v21
  v_xor_b32 v22, 192, v6
  v_add_u32 v22, 391168, v22
  v_xor_b32 v23, 224, v6
  v_add_u32 v23, 422912, v23
  s_lshr_b32 s20, s16, 1
  s_lshl_b32 s20, s20, 16
  s_and_b32 s21, s16, 1
  s_lshl_b32 s21, s21, 14
  s_add_u32 s20, s20, s21
  s_add_u32 s29, s20, s26
  s_mul_i32 s25, s16, 24576
  s_add_u32 s25, s25, 16384
  s_add_u32 s22, s29, 2097152
  s_add_u32 m0, s25, 0
  s_nop 0
  buffer_load_dwordx4 v16, s[60:63], s22 offen offset:0 lds
  buffer_load_dwordx4 v17, s[60:63], s22 offen offset:1024 lds
  buffer_load_dwordx4 v18, s[60:63], s22 offen offset:2048 lds
  buffer_load_dwordx4 v19, s[60:63], s22 offen offset:3072 lds
  s_add_u32 m0, s25, 4096
  s_nop 0
  buffer_load_dwordx4 v20, s[60:63], s22 offen offset:0 lds
  buffer_load_dwordx4 v21, s[60:63], s22 offen offset:1024 lds
  buffer_load_dwordx4 v22, s[60:63], s22 offen offset:2048 lds
  buffer_load_dwordx4 v23, s[60:63], s22 offen offset:3072 lds
  s_waitcnt vmcnt(12)
  s_barrier
  s_cmp_lg_u32 s16, 0
  s_cbranch_scc1 pub_23
  v_mul_u32_u24 v50, 2048, v1
  v_mov_b32 v48, s88
  v_mov_b32 v49, s89
  s_mov_b64 exec, 1
  buffer_store_dwordx2 v[48:49], v50, s[8:11], s77 offen sc1
  s_mov_b64 exec, -1
pub_23:
  s_cmp_ge_u32 s18, 70
  s_cbranch_scc1 bk_nm
  s_mov_b32 s20, 71565312
  buffer_store_dwordx4 v[84:87], v92, s[8:11], s20 offen sc1
  buffer_store_dwordx4 v[88:91], v92, s[8:11], s20 offen offset:256 sc1
  s_cmp_lg_u32 s18, 0
  s_cbranch_scc1 bk_nm
  v_min_u32 v104, -2, v36
  v_min_u32 v108, -2, v37
  v_min_u32 v105, -2, v38
  v_min_u32 v109, -2, v39
  v_min_u32 v106, -2, v40
  v_min_u32 v110, -2, v41
  v_min_u32 v107, -2, v42
  v_min_u32 v111, -2, v43
  s_mov_b32 s20, 88653824
  s_mov_b32 s21, 88080384
  buffer_store_dwordx4 v[104:107], v94, s[8:11], s20 offen sc1
  buffer_store_dwordx4 v[108:111], v94, s[8:11], s20 offen offset:128 sc1
  buffer_store_dwordx4 v[104:107], v94, s[8:11], s21 offen sc1
  buffer_store_dwordx4 v[108:111], v94, s[8:11], s21 offen offset:128 sc1
bk_nm:
  s_mov_b32 s23, 88653824
  v_add_u32 v6, 448, v95
  v_subrev_u32 v7, 1152, v6
  v_mov_b32 v52, -1
  v_mov_b32 v9, 0
  v_cmp_gt_u32 vcc, 128, v7
  s_nop 1
  v_cndmask_b32 v52, v52, v9, vcc
  v_mov_b32 v53, v52
  v_mov_b32 v54, v52
  v_mov_b32 v55, v52
  v_lshlrev_b32 v8, 4, v6
  v_mov_b32 v9, 0x10000000
  v_cmp_lt_u32 vcc, 25599, v6
  s_nop 1
  v_cndmask_b32 v8, v8, v9, vcc
  buffer_store_dwordx4 v[52:55], v8, s[8:11], s23 offen sc1
  s_mov_b32 s23, 87957504
  v_add_u32 v6, 448, v95
  v_cmp_gt_u32 vcc, 7680, v95
  s_nop 1
  v_cndmask_b32 v6, v6, v95, vcc
  v_subrev_u32 v7, 36352, v6
  v_mov_b32 v56, -1
  v_mov_b32 v9, 0
  v_cmp_gt_u32 vcc, 1048576, v7
  s_nop 1
  v_cndmask_b32 v56, v56, v9, vcc
  v_mov_b32 v57, v56
  v_mov_b32 v58, v56
  v_mov_b32 v59, v56
  v_lshlrev_b32 v8, 4, v6
  v_mov_b32 v9, 0x10000000
  v_cmp_lt_u32 vcc, 40191, v6
  s_nop 1
  v_cndmask_b32 v8, v8, v9, vcc
  buffer_store_dwordx4 v[56:59], v8, s[8:11], s23 offen sc1
  s_add_u32 s22, s29, 2621440
  s_add_u32 m0, s25, 8192
  s_nop 0
  buffer_load_dwordx4 v16, s[60:63], s22 offen offset:0 lds
  buffer_load_dwordx4 v17, s[60:63], s22 offen offset:1024 lds
  buffer_load_dwordx4 v18, s[60:63], s22 offen offset:2048 lds
  buffer_load_dwordx4 v19, s[60:63], s22 offen offset:3072 lds
  s_add_u32 m0, s25, 12288
  s_nop 0
  buffer_load_dwordx4 v20, s[60:63], s22 offen offset:0 lds
  buffer_load_dwordx4 v21, s[60:63], s22 offen offset:1024 lds
  buffer_load_dwordx4 v22, s[60:63], s22 offen offset:2048 lds
  buffer_load_dwordx4 v23, s[60:63], s22 offen offset:3072 lds
  s_add_u32 s22, s29, 3145728
  s_add_u32 m0, s25, 16384
  s_nop 0
  buffer_load_dwordx4 v16, s[60:63], s22 offen offset:0 lds
  buffer_load_dwordx4 v17, s[60:63], s22 offen offset:1024 lds
  buffer_load_dwordx4 v18, s[60:63], s22 offen offset:2048 lds
  buffer_load_dwordx4 v19, s[60:63], s22 offen offset:3072 lds
  s_add_u32 m0, s25, 20480
  s_nop 0
  buffer_load_dwordx4 v20, s[60:63], s22 offen offset:0 lds
  buffer_load_dwordx4 v21, s[60:63], s22 offen offset:1024 lds
  buffer_load_dwordx4 v22, s[60:63], s22 offen offset:2048 lds
  buffer_load_dwordx4 v23, s[60:63], s22 offen offset:3072 lds
  v_mov_b32 v250, s68
  s_or_b32 s20, s69, s16
  s_cbranch_scc1 bj_ht
  s_cmp_lg_u32 s16, 0
  s_cbranch_scc1 w0_24
  v_mov_b32 v250, 1
  v_mov_b32 v251, 192
  s_mov_b64 exec, 1
  buffer_atomic_add v250, v251, s[12:15], 0 offen sc0
  s_mov_b64 exec, -1
w0_24:
  s_branch bj_h2
bj_ht:
  buffer_load_dword v251, off, s[8:11], s77
bj_h2:
  v_lshrrev_b32 v7, 2, v4
  v_lshlrev_b32 v7, 3, v7
  v_and_b32 v8, 3, v4
  v_add_u32 v7, v7, v8
  v_xor_b32 v10, v3, v4
  v_lshlrev_b32 v10, 4, v10
  v_lshl_add_u32 v11, v4, 9, v10
  v_add_u32 v11, s25, v11
  v_lshl_add_u32 v10, v7, 9, v10
  v_xor_b32 v32, 0, v10
  v_xor_b32 v36, 0, v11
  v_xor_b32 v33, 64, v10
  v_xor_b32 v37, 64, v11
  v_xor_b32 v34, 128, v10
  v_xor_b32 v38, 128, v11
  v_xor_b32 v35, 192, v10
  v_xor_b32 v39, 192, v11
  s_mul_i32 s30, s17, 401408
  s_mul_i32 s20, s16, 14336
  s_add_u32 s30, s30, s20
  s_lshl_b32 s20, s28, 10
  s_add_u32 s30, s30, s20
  s_mov_b32 s24, 1035512379
  s_lshl_b32 s20, s17, 7
  s_lshl_b32 s28, s28, 3
  s_add_u32 s28, s28, s20
  s_add_u32 s28, s28, 88635392
  s_waitcnt vmcnt(1)
  s_barrier
  s_cmp_lg_u32 s16, 0
  s_cbranch_scc1 w0_25
  v_mul_u32_u24 v50, 2048, v1
  v_mov_b32 v48, s88
  v_mov_b32 v49, s89
  s_mov_b64 exec, 511
  buffer_store_dwordx2 v[48:49], v50, s[8:11], s78 offen sc1
  s_mov_b64 exec, -1
w0_25:
  ds_read_b128 v[128:131], v32 offset:0
  ds_read_b128 v[132:135], v32 offset:2048
  ds_read_b128 v[136:139], v36 offset:0
  ds_read_b128 v[140:143], v36 offset:8192
  ds_read_b128 v[144:147], v36 offset:16384
  ds_read_b128 v[148:151], v33 offset:0
  ds_read_b128 v[152:155], v33 offset:2048
  ds_read_b128 v[156:159], v37 offset:0
  ds_read_b128 v[160:163], v37 offset:8192
  ds_read_b128 v[164:167], v37 offset:16384
  ds_read_b128 v[168:171], v34 offset:0
  ds_read_b128 v[172:175], v34 offset:2048
  ds_read_b128 v[176:179], v38 offset:0
  ds_read_b128 v[180:183], v38 offset:8192
  ds_read_b128 v[184:187], v38 offset:16384
  s_waitcnt lgkmcnt(10)
  v_mfma_f32_16x16x32_bf16 v[96:99], v[128:131], v[136:139], 0
  v_mfma_f32_16x16x32_bf16 v[100:103], v[132:135], v[136:139], 0
  v_mfma_f32_16x16x32_bf16 v[104:107], v[128:131], v[140:143], 0
  v_mfma_f32_16x16x32_bf16 v[108:111], v[132:135], v[140:143], 0
  v_mfma_f32_16x16x32_bf16 v[112:115], v[128:131], v[144:147], 0
  v_mfma_f32_16x16x32_bf16 v[116:119], v[132:135], v[144:147], 0
  ds_read_b128 v[128:131], v35 offset:0
  ds_read_b128 v[132:135], v35 offset:2048
  ds_read_b128 v[136:139], v39 offset:0
  ds_read_b128 v[140:143], v39 offset:8192
  ds_read_b128 v[144:147], v39 offset:16384
  s_waitcnt lgkmcnt(10)
  v_mfma_f32_16x16x32_bf16 v[96:99], v[148:151], v[156:159], v[96:99]
  v_mfma_f32_16x16x32_bf16 v[100:103], v[152:155], v[156:159], v[100:103]
  v_mfma_f32_16x16x32_bf16 v[104:107], v[148:151], v[160:163], v[104:107]
  v_mfma_f32_16x16x32_bf16 v[108:111], v[152:155], v[160:163], v[108:111]
  v_mfma_f32_16x16x32_bf16 v[112:115], v[148:151], v[164:167], v[112:115]
  v_mfma_f32_16x16x32_bf16 v[116:119], v[152:155], v[164:167], v[116:119]
  ds_read_b128 v[148:151], v32 offset:256
  ds_read_b128 v[152:155], v32 offset:2304
  ds_read_b128 v[156:159], v36 offset:256
  ds_read_b128 v[160:163], v36 offset:8448
  ds_read_b128 v[164:167], v36 offset:16640
  s_waitcnt lgkmcnt(10)
  v_mfma_f32_16x16x32_bf16 v[96:99], v[168:171], v[176:179], v[96:99]
  v_mfma_f32_16x16x32_bf16 v[100:103], v[172:175], v[176:179], v[100:103]
  v_mfma_f32_16x16x32_bf16 v[104:107], v[168:171], v[180:183], v[104:107]
  v_mfma_f32_16x16x32_bf16 v[108:111], v[172:175], v[180:183], v[108:111]
  v_mfma_f32_16x16x32_bf16 v[112:115], v[168:171], v[184:187], v[112:115]
  v_mfma_f32_16x16x32_bf16 v[116:119], v[172:175], v[184:187], v[116:119]
  ds_read_b128 v[168:171], v33 offset:256
  ds_read_b128 v[172:175], v33 offset:2304
  ds_read_b128 v[176:179], v37 offset:256
  ds_read_b128 v[180:183], v37 offset:8448
  ds_read_b128 v[184:187], v37 offset:16640
  s_waitcnt lgkmcnt(10)
  v_mfma_f32_16x16x32_bf16 v[96:99], v[128:131], v[136:139], v[96:99]
  v_mfma_f32_16x16x32_bf16 v[100:103], v[132:135], v[136:139], v[100:103]
  v_mfma_f32_16x16x32_bf16 v[104:107], v[128:131], v[140:143], v[104:107]
  v_mfma_f32_16x16x32_bf16 v[108:111], v[132:135], v[140:143], v[108:111]
  v_mfma_f32_16x16x32_bf16 v[112:115], v[128:131], v[144:147], v[112:115]
  v_mfma_f32_16x16x32_bf16 v[116:119], v[132:135], v[144:147], v[116:119]
  ds_read_b128 v[128:131], v34 offset:256
  ds_read_b128 v[132:135], v34 offset:2304
  ds_read_b128 v[136:139], v38 offset:256
  ds_read_b128 v[140:143], v38 offset:8448
  ds_read_b128 v[144:147], v38 offset:16640
  s_waitcnt lgkmcnt(10)
  v_mfma_f32_16x16x32_bf16 v[96:99], v[148:151], v[156:159], v[96:99]
  v_mfma_f32_16x16x32_bf16 v[100:103], v[152:155], v[156:159], v[100:103]
  v_mfma_f32_16x16x32_bf16 v[104:107], v[148:151], v[160:163], v[104:107]
  v_mfma_f32_16x16x32_bf16 v[108:111], v[152:155], v[160:163], v[108:111]
  v_mfma_f32_16x16x32_bf16 v[112:115], v[148:151], v[164:167], v[112:115]
  v_mfma_f32_16x16x32_bf16 v[116:119], v[152:155], v[164:167], v[116:119]
  ds_read_b128 v[148:151], v35 offset:256
  ds_read_b128 v[152:155], v35 offset:2304
  ds_read_b128 v[156:159], v39 offset:256
  ds_read_b128 v[160:163], v39 offset:8448
  ds_read_b128 v[164:167], v39 offset:16640
  s_waitcnt lgkmcnt(10)
  v_mfma_f32_16x16x32_bf16 v[96:99], v[168:171], v[176:179], v[96:99]
  v_mfma_f32_16x16x32_bf16 v[100:103], v[172:175], v[176:179], v[100:103]
  v_mfma_f32_16x16x32_bf16 v[104:107], v[168:171], v[180:183], v[104:107]
  v_mfma_f32_16x16x32_bf16 v[108:111], v[172:175], v[180:183], v[108:111]
  v_mfma_f32_16x16x32_bf16 v[112:115], v[168:171], v[184:187], v[112:115]
  v_mfma_f32_16x16x32_bf16 v[116:119], v[172:175], v[184:187], v[116:119]
  s_waitcnt lgkmcnt(5)
  v_mfma_f32_16x16x32_bf16 v[96:99], v[128:131], v[136:139], v[96:99]
  v_mfma_f32_16x16x32_bf16 v[100:103], v[132:135], v[136:139], v[100:103]
  v_mfma_f32_16x16x32_bf16 v[104:107], v[128:131], v[140:143], v[104:107]
  v_mfma_f32_16x16x32_bf16 v[108:111], v[132:135], v[140:143], v[108:111]
  v_mfma_f32_16x16x32_bf16 v[112:115], v[128:131], v[144:147], v[112:115]
  v_mfma_f32_16x16x32_bf16 v[116:119], v[132:135], v[144:147], v[116:119]
  s_waitcnt lgkmcnt(0)
  v_mfma_f32_16x16x32_bf16 v[96:99], v[148:151], v[156:159], v[96:99]
  v_mfma_f32_16x16x32_bf16 v[100:103], v[152:155], v[156:159], v[100:103]
  v_mfma_f32_16x16x32_bf16 v[104:107], v[148:151], v[160:163], v[104:107]
  v_mfma_f32_16x16x32_bf16 v[108:111], v[152:155], v[160:163], v[108:111]
  v_mfma_f32_16x16x32_bf16 v[112:115], v[148:151], v[164:167], v[112:115]
  v_mfma_f32_16x16x32_bf16 v[116:119], v[152:155], v[164:167], v[116:119]
  v_mul_f32 v96, s24, v96
  v_mul_f32 v97, s24, v97
  v_mul_f32 v98, s24, v98
  v_mul_f32 v99, s24, v99
  v_mul_f32 v100, s24, v100
  v_mul_f32 v101, s24, v101
  v_mul_f32 v102, s24, v102
  v_mul_f32 v103, s24, v103
  v_cvt_pk_bf16_f32 v68, v96, v97
  v_cvt_pk_bf16_f32 v69, v98, v99
  v_cvt_pk_bf16_f32 v70, v100, v101
  v_cvt_pk_bf16_f32 v71, v102, v103
  s_add_u32 s20, s30, 229376
  buffer_store_dwordx4 v[68:71], v2, s[8:11], s20 offen sc1
  v_mul_f32 v104, s24, v104
  v_mul_f32 v105, s24, v105
  v_mul_f32 v106, s24, v106
  v_mul_f32 v107, s24, v107
  v_mul_f32 v108, s24, v108
  v_mul_f32 v109, s24, v109
  v_mul_f32 v110, s24, v110
  v_mul_f32 v111, s24, v111
  v_cvt_pk_bf16_f32 v72, v104, v105
  v_cvt_pk_bf16_f32 v73, v106, v107
  v_cvt_pk_bf16_f32 v74, v108, v109
  v_cvt_pk_bf16_f32 v75, v110, v111
  s_add_u32 s20, s30, 286720
  buffer_store_dwordx4 v[72:75], v2, s[8:11], s20 offen sc1
  v_mul_f32 v112, s24, v112
  v_mul_f32 v113, s24, v113
  v_mul_f32 v114, s24, v114
  v_mul_f32 v115, s24, v115
  v_mul_f32 v116, s24, v116
  v_mul_f32 v117, s24, v117
  v_mul_f32 v118, s24, v118
  v_mul_f32 v119, s24, v119
  v_cvt_pk_bf16_f32 v76, v112, v113
  v_cvt_pk_bf16_f32 v77, v114, v115
  v_cvt_pk_bf16_f32 v78, v116, v117
  v_cvt_pk_bf16_f32 v79, v118, v119
  s_add_u32 s20, s30, 344064
  buffer_store_dwordx4 v[76:79], v2, s[8:11], s20 offen sc1
  s_waitcnt vmcnt(0)
  s_barrier
  s_cmp_lg_u32 s16, 0
  s_cbranch_scc1 pub_26
  v_mul_u32_u24 v26, 2048, v1
  v_mov_b32 v24, s88
  v_mov_b32 v25, s89
  s_mov_b64 exec, 1
  buffer_store_dwordx2 v[24:25], v26, s[8:11], s28 offen sc1
  s_mov_b64 exec, -1
pub_26:
  v_mov_b32 v6, 160000
  s_add_u32 s101, s101, 1
  s_barrier
  s_mov_b64 exec, 1
  s_cmp_lg_u32 s16, 0
  s_cbranch_scc1 w0_27
  ds_write_b32 v6, v250 offset:0
  s_waitcnt lgkmcnt(0)
  v_mov_b32 v250, s101
  ds_write_b32 v6, v250 offset:16
  s_waitcnt lgkmcnt(0)
w0_27:
  s_mov_b64 exec, -1
  s_barrier
  ds_read_b32 v250, v6 offset:0
  ds_read_b32 v6, v6 offset:16
  s_waitcnt lgkmcnt(0)
  v_readfirstlane_b32 s3, v250
  v_cmp_ne_u32 vcc, s101, v6
  s_cbranch_vccnz ch_end
  s_branch wk_have
wk_loop:
  s_waitcnt vmcnt(0) lgkmcnt(0)
  s_cmp_eq_u32 s96, 1
  s_cbranch_scc1 wk_ask
  s_mov_b32 s96, 1
  s_cmp_lg_u32 s16, 0
  s_cbranch_scc1 w0_28
  s_mov_b32 s30, 0
  v_mov_b32 v243, 32
sf_l:
  buffer_load_dword v242, v243, s[12:15], 0 offen sc1
  s_waitcnt vmcnt(0)
  v_readfirstlane_b32 s70, v242
  s_cmp_eq_u32 s70, -1
  s_cbranch_scc1 sf_d
  s_sleep 16
  s_add_u32 s30, s30, 1
  s_cmp_lt_u32 s30, 64
  s_cbranch_scc1 sf_l
  s_mov_b32 s20, 0
  s_mov_b32 s21, 0
  s_mov_b64 exec, 1
sf_c_l:
  s_cmp_lg_u32 s70, -1
  s_cbranch_scc1 sf_c_t
  s_add_u32 s20, s20, 1
  s_cmp_lt_u32 s20, 8
  s_cselect_b32 s20, s20, 0
  s_mov_b32 s70, 0
  s_mov_b32 s3, -1
  s_add_u32 s21, s21, 1
  s_cmp_ge_u32 s21, 1
  s_cbranch_scc1 sf_c_d
sf_c_t:
  s_ff0_i32_b32 s22, s70
  s_lshl_b32 s23, 1, s22
  s_and_b32 s71, s20, 4
  s_mul_i32 s71, s71, 12
  s_lshl_b32 s3, s20, 2
  s_add_u32 s3, s3, s71
  v_mov_b32 v242, s23
  v_mov_b32 v243, 32
  buffer_atomic_or v242, v243, s[12:15], s3 offen sc0
  s_waitcnt vmcnt(0)
  v_readfirstlane_b32 s70, v242
  s_lshl_b32 s3, s20, 5
  s_add_u32 s3, s3, s22
  s_bitcmp1_b32 s70, s22
  s_cbranch_scc1 sf_c_l
sf_c_d:
  s_mov_b64 exec, -1
  v_mov_b32 v242, s3
sf_d:
w0_28:
  v_mov_b32 v243, 160000
  s_add_u32 s101, s101, 1
  s_barrier
  s_mov_b64 exec, 1
  s_cmp_lg_u32 s16, 0
  s_cbranch_scc1 w0_29
  ds_write_b32 v243, v242 offset:0
  s_waitcnt lgkmcnt(0)
  v_mov_b32 v242, s101
  ds_write_b32 v243, v242 offset:16
  s_waitcnt lgkmcnt(0)
w0_29:
  s_mov_b64 exec, -1
  s_barrier
  ds_read_b32 v242, v243 offset:0
  ds_read_b32 v243, v243 offset:16
  s_waitcnt lgkmcnt(0)
  v_readfirstlane_b32 s3, v242
  v_cmp_ne_u32 vcc, s101, v243
  s_cbranch_vccnz ch_end
  s_cmp_eq_u32 s3, -1
  s_cbranch_scc1 wk_ask
  s_load_dwordx8 s[36:43], s[0:1], 56
  s_load_dwordx4 s[44:47], s[0:1], 88
  s_getreg_b32 s67, hwreg(HW_REG_XCC_ID)
  s_and_b32 s67, s67, 7
  s_mov_b32 s66, 1
  s_waitcnt lgkmcnt(0)
  s_branch m_start
wk_ask:
  v_readfirstlane_b32 s22, v250
  s_cmp_ge_u32 s22, 1440
  s_cbranch_scc1 wk_next
  s_cmp_lg_u32 s16, 0
  s_cbranch_scc1 w0_30
  v_mov_b32 v250, 1
  v_mov_b32 v251, 192
  s_mov_b64 exec, 1
  buffer_atomic_add v250, v251, s[12:15], 0 offen sc0
  s_mov_b64 exec, -1
w0_30:
wk_next:
  s_waitcnt vmcnt(0)
  v_mov_b32 v6, 160000
  s_add_u32 s101, s101, 1
  s_barrier
  s_mov_b64 exec, 1
  s_cmp_lg_u32 s16, 0
  s_cbranch_scc1 w0_31
  ds_write_b32 v6, v250 offset:0
  s_waitcnt lgkmcnt(0)
  v_mov_b32 v250, s101
  ds_write_b32 v6, v250 offset:16
  s_waitcnt lgkmcnt(0)
w0_31:
  s_mov_b64 exec, -1
  s_barrier
  ds_read_b32 v250, v6 offset:0
  ds_read_b32 v6, v6 offset:16
  s_waitcnt lgkmcnt(0)
  v_readfirstlane_b32 s3, v250
  v_cmp_ne_u32 vcc, s101, v6
  s_cbranch_vccnz ch_end
wk_have:
  s_cmp_ge_u32 s3, 1440
  s_cbranch_scc1 ch_end
  v_mov_b32 v250, 0
  v_mov_b32 v251, 192
  v_and_b32 v1, 63, v0
  v_lshlrev_b32 v2, 4, v1
  v_lshrrev_b32 v3, 4, v1
  v_and_b32 v4, 15, v1
  s_cmp_lg_u32 s97, 0
  s_cbranch_scc1 wk_go
  s_mov_b32 s68, s3
  s_mov_b32 s69, 1
  s_cmp_lg_u32 s16, 0
  s_cbranch_scc1 w0_32
  s_add_u32 s20, s67, 1
  s_lshl_b32 s22, s20, 11
  s_add_u32 s22, s22, 88602624
  v_add_u32 v24, 1024, v2
  v_min_u32 v24, 1776, v24
  s_mov_b32 s30, 0
wk_af:
  buffer_load_dwordx4 v[28:31], v2, s[8:11], s22 offen sc1
  buffer_load_dwordx4 v[32:35], v24, s[8:11], s22 offen sc1
  s_waitcnt vmcnt(0)
  v_cmp_ne_u64 vcc, s[88:89], v[28:29]
  s_cbranch_vccnz wk_af_no
  v_cmp_ne_u64 vcc, s[88:89], v[30:31]
  s_cbranch_vccnz wk_af_no
  v_cmp_ne_u64 vcc, s[88:89], v[32:33]
  s_cbranch_vccnz wk_af_no
  v_cmp_ne_u64 vcc, s[88:89], v[34:35]
  s_cbranch_vccnz wk_af_no
  s_branch wk_af_ok
wk_af_no:
  s_sleep 4
  s_add_u32 s30, s30, 1
  s_and_b32 s20, s30, 63
  s_cbranch_scc1 wk_ns
  s_mov_b32 s20, 1
  s_mov_b32 s70, 0
  s_mov_b32 s21, 0
  s_mov_b64 exec, 1
wk_st_l:
  s_cmp_lg_u32 s70, -1
  s_cbranch_scc1 wk_st_t
  s_add_u32 s20, s20, 1
  s_cmp_lt_u32 s20, 8
  s_cselect_b32 s20, s20, 1
  s_mov_b32 s70, 0
  s_mov_b32 s3, -1
  s_add_u32 s21, s21, 1
  s_cmp_ge_u32 s21, 7
  s_cbranch_scc1 wk_st_d
wk_st_t:
  s_ff0_i32_b32 s22, s70
  s_lshl_b32 s23, 1, s22
  s_and_b32 s71, s20, 4
  s_mul_i32 s71, s71, 12
  s_lshl_b32 s3, s20, 2
  s_add_u32 s3, s3, s71
  v_mov_b32 v242, s23
  v_mov_b32 v243, 32
  buffer_atomic_or v242, v243, s[12:15], s3 offen sc0
  s_waitcnt vmcnt(0)
  v_readfirstlane_b32 s70, v242
  s_lshl_b32 s3, s20, 5
  s_add_u32 s3, s3, s22
  s_bitcmp1_b32 s70, s22
  s_cbranch_scc1 wk_st_l
wk_st_d:
  s_mov_b64 exec, -1
  v_mov_b32 v242, s3
  s_cmp_lg_u32 s3, -1
  s_cbranch_scc1 wk_pd
  s_add_u32 s20, s67, 1
  s_lshl_b32 s22, s20, 11
  s_add_u32 s22, s22, 88602624
wk_ns:
  s_cmp_lt_u32 s30, 50000
  s_cbranch_scc1 wk_af
  s_branch cA_abort
wk_af_ok:
  v_mov_b32 v242, -1
wk_pd:
w0_32:
  v_mov_b32 v243, 160000
  s_add_u32 s101, s101, 1
  s_barrier
  s_mov_b64 exec, 1
  s_cmp_lg_u32 s16, 0
  s_cbranch_scc1 w0_33
  ds_write_b32 v243, v242 offset:0
  s_waitcnt lgkmcnt(0)
  v_mov_b32 v242, s101
  ds_write_b32 v243, v242 offset:16
  s_waitcnt lgkmcnt(0)
w0_33:
  s_mov_b64 exec, -1
  s_barrier
  ds_read_b32 v242, v243 offset:0
  ds_read_b32 v243, v243 offset:16
  s_waitcnt lgkmcnt(0)
  v_readfirstlane_b32 s3, v242
  v_cmp_ne_u32 vcc, s101, v243
  s_cbranch_vccnz ch_end
  s_cmp_lg_u32 s3, -1
  s_cbranch_scc1 m_bjob
  s_mov_b32 s3, s68
  s_mov_b32 s97, 1
wk_go:
  s_cmp_lt_u32 s3, 368
  s_cbranch_scc1 wk_g2
  s_sub_u32 s20, s3, 432
  s_cmp_lt_u32 s20, 128
  s_cbranch_scc1 wk_g2
  s_cmp_eq_u32 s97, 2
  s_cbranch_scc1 wk_g2
  s_getreg_b32 s20, hwreg(HW_REG_XCC_ID)
  s_and_b32 s20, s20, 7
  s_cmp_lg_u32 s16, 0
  s_cbranch_scc1 w0_34
  s_lshl_b32 s22, s20, 11
  s_add_u32 s22, s22, 88637440
  v_add_u32 v24, 1024, v2
  v_min_u32 v24, 1776, v24
  s_mov_b32 s30, 0
wk_i2:
  buffer_load_dwordx4 v[28:31], v2, s[8:11], s22 offen sc1
  buffer_load_dwordx4 v[32:35], v24, s[8:11], s22 offen sc1
  s_waitcnt vmcnt(0)
  v_cmp_ne_u64 vcc, s[88:89], v[28:29]
  s_cbranch_vccnz wk_i2_no
  v_cmp_ne_u64 vcc, s[88:89], v[30:31]
  s_cbranch_vccnz wk_i2_no
  v_cmp_ne_u64 vcc, s[88:89], v[32:33]
  s_cbranch_vccnz wk_i2_no
  v_cmp_ne_u64 vcc, s[88:89], v[34:35]
  s_cbranch_vccnz wk_i2_no
  s_branch wk_i2_ok
wk_i2_no:
  s_sleep 4
  s_add_u32 s30, s30, 1
  s_cmp_lt_u32 s30, 50000
  s_cbranch_scc1 wk_i2
  s_branch cA_abort
wk_i2_ok:
w0_34:
  v_mov_b32 v242, 0
  v_mov_b32 v243, 160000
  s_add_u32 s101, s101, 1
  s_barrier
  s_mov_b64 exec, 1
  s_cmp_lg_u32 s16, 0
  s_cbranch_scc1 w0_35
  ds_write_b32 v243, v242 offset:0
  s_waitcnt lgkmcnt(0)
  v_mov_b32 v242, s101
  ds_write_b32 v243, v242 offset:16
  s_waitcnt lgkmcnt(0)
w0_35:
  s_mov_b64 exec, -1
  s_barrier
  ds_read_b32 v242, v243 offset:0
  ds_read_b32 v243, v243 offset:16
  s_waitcnt lgkmcnt(0)
  v_readfirstlane_b32 s20, v242
  v_cmp_ne_u32 vcc, s101, v243
  s_cbranch_vccnz ch_end
  s_mov_b32 s97, 2
wk_g2:
  s_cmp_ge_u32 s3, 864
  s_cbranch_scc1 wk_tok
  s_cmp_ge_u32 s3, 752
  s_cbranch_scc1 wk_s4d
  s_cmp_ge_u32 s3, 624
  s_cbranch_scc1 wk_f
  s_cmp_ge_u32 s3, 560
  s_cbranch_scc1 wk_vf
  s_cmp_ge_u32 s3, 432
  s_cbranch_scc1 wk_a
  s_cmp_ge_u32 s3, 368
  s_cbranch_scc1 wk_vh
  s_cmp_ge_u32 s3, 256
  s_cbranch_scc1 wk_v7
  s_cmp_ge_u32 s3, 224
  s_cbranch_scc1 wk_srv
  s_sub_u32 s20, s3, 0
  s_cmp_ge_u32 s20, 112
  s_cselect_b32 s18, 1, 0
  s_cselect_b32 s21, 112, 0
  s_sub_u32 s20, s20, s21
  s_and_b32 s17, s20, 15
  s_add_u32 s17, s17, 16
  s_lshr_b32 s34, s20, 4
  s_lshl_b32 s34, s34, 1
  s_add_u32 s35, s34, 2
  s_cmp_eq_u32 s18, 0
  s_cbranch_scc1 wf_nw
  s_and_b32 s20, s3, 3
  s_lshl_b32 s20, s20, 3
  s_add_u32 s20, s20, 8
  s_cmp_eq_u32 s16, 0
  s_cselect_b32 s20, 0, s20
  s_cmp_ge_u32 s16, 2
  s_cselect_b32 s20, 112, s20
  s_load_dwordx2 s[72:73], s[0:1], s20
  s_lshr_b32 s21, s3, 2
  s_lshl_b32 s21, s21, 12
  s_mov_b32 s74, 229376
  s_lshl_b32 s22, s3, 13
  s_cmp_eq_u32 s16, 0
  s_cselect_b32 s21, s22, s21
  s_cselect_b32 s74, 1835008, s74
  s_lshl_b32 s22, s3, 1
  s_add_u32 s22, s22, s16
  s_sub_u32 s22, s22, 2
  s_lshl_b32 s22, s22, 13
  s_cmp_ge_u32 s16, 2
  s_cselect_b32 s21, s22, s21
  s_cselect_b32 s74, 3670016, s74
  v_lshlrev_b32 v6, 3, v2
  s_cmp_lt_u32 s16, 2
  s_cbranch_scc1 lw_36
  s_lshl_b32 s21, s3, 6
  v_add_u32 v6, s21, v1
  v_mul_u32_u24 v7, 37450, v6
  v_lshrrev_b32 v7, 18, v7
  v_add_u32 v7, 1, v7
  v_mul_u32_u24 v7, 7, v7
  v_add_u32 v6, v6, v7
  v_lshlrev_b32 v6, 7, v6
  s_mov_b32 s21, 0
  s_cmp_eq_u32 s16, 3
  s_cselect_b32 s74, 0, s74
lw_36:
  s_cmp_eq_u32 s16, 1
  s_cselect_b32 exec_hi, 0, -1
  s_waitcnt lgkmcnt(0)
  s_and_b32 s73, s73, 0xffff
  s_mov_b32 s75, 0x20000
  buffer_load_dword v7, v6, s[72:75], s21 offen
  s_mov_b64 exec, -1
  s_sub_u32 s3, s3, 112
  s_and_b32 s20, s3, 3
  s_lshl_b32 s20, s20, 3
  s_add_u32 s20, s20, 8
  s_cmp_eq_u32 s16, 0
  s_cselect_b32 s20, 0, s20
  s_cmp_ge_u32 s16, 2
  s_cselect_b32 s20, 112, s20
  s_load_dwordx2 s[72:73], s[0:1], s20
  s_lshr_b32 s21, s3, 2
  s_lshl_b32 s21, s21, 12
  s_mov_b32 s74, 229376
  s_lshl_b32 s22, s3, 13
  s_cmp_eq_u32 s16, 0
  s_cselect_b32 s21, s22, s21
  s_cselect_b32 s74, 1835008, s74
  s_lshl_b32 s22, s3, 1
  s_add_u32 s22, s22, s16
  s_sub_u32 s22, s22, 2
  s_lshl_b32 s22, s22, 13
  s_cmp_ge_u32 s16, 2
  s_cselect_b32 s21, s22, s21
  s_cselect_b32 s74, 3670016, s74
  v_lshlrev_b32 v6, 3, v2
  s_cmp_lt_u32 s16, 2
  s_cbranch_scc1 lw_37
  s_lshl_b32 s21, s3, 6
  v_add_u32 v6, s21, v1
  v_mul_u32_u24 v7, 37450, v6
  v_lshrrev_b32 v7, 18, v7
  v_add_u32 v7, 1, v7
  v_mul_u32_u24 v7, 7, v7
  v_add_u32 v6, v6, v7
  v_lshlrev_b32 v6, 7, v6
  s_mov_b32 s21, 0
  s_cmp_eq_u32 s16, 3
  s_cselect_b32 s74, 0, s74
lw_37:
  s_cmp_eq_u32 s16, 1
  s_cselect_b32 exec_hi, 0, -1
  s_waitcnt lgkmcnt(0)
  s_and_b32 s73, s73, 0xffff
  s_mov_b32 s75, 0x20000
  buffer_load_dword v7, v6, s[72:75], s21 offen
  s_mov_b64 exec, -1
  s_add_u32 s3, s3, 112
wf_nw:
  s_lshl_b32 s20, s18, 3
  s_lshl_b32 s21, s16, 1
  s_add_u32 s20, s20, s21
  s_mul_i32 s21, s20, 14336
  s_add_u32 s21, s21, 71565312
  s_add_u32 s22, s21, 0
  buffer_load_dwordx4 a[0:3], v2, s[8:11], s22 offen offset:0 sc1
  buffer_load_dwordx4 a[4:7], v2, s[8:11], s22 offen offset:1024 sc1
  buffer_load_dwordx4 a[8:11], v2, s[8:11], s22 offen offset:2048 sc1
  buffer_load_dwordx4 a[12:15], v2, s[8:11], s22 offen offset:3072 sc1
  s_add_u32 s22, s21, 4096
  buffer_load_dwordx4 a[16:19], v2, s[8:11], s22 offen offset:0 sc1
  buffer_load_dwordx4 a[20:23], v2, s[8:11], s22 offen offset:1024 sc1
  buffer_load_dwordx4 a[24:27], v2, s[8:11], s22 offen offset:2048 sc1
  buffer_load_dwordx4 a[28:31], v2, s[8:11], s22 offen offset:3072 sc1
  s_add_u32 s22, s21, 8192
  buffer_load_dwordx4 a[32:35], v2, s[8:11], s22 offen offset:0 sc1
  buffer_load_dwordx4 a[36:39], v2, s[8:11], s22 offen offset:1024 sc1
  buffer_load_dwordx4 a[40:43], v2, s[8:11], s22 offen offset:2048 sc1
  buffer_load_dwordx4 a[44:47], v2, s[8:11], s22 offen offset:3072 sc1
  s_add_u32 s22, s21, 12288
  buffer_load_dwordx4 a[48:51], v2, s[8:11], s22 offen offset:0 sc1
  buffer_load_dwordx4 a[52:55], v2, s[8:11], s22 offen offset:1024 sc1
  buffer_load_dwordx4 a[56:59], v2, s[8:11], s22 offen offset:2048 sc1
  buffer_load_dwordx4 a[60:63], v2, s[8:11], s22 offen offset:3072 sc1
  s_add_u32 s22, s21, 16384
  buffer_load_dwordx4 a[64:67], v2, s[8:11], s22 offen offset:0 sc1
  buffer_load_dwordx4 a[68:71], v2, s[8:11], s22 offen offset:1024 sc1
  buffer_load_dwordx4 a[72:75], v2, s[8:11], s22 offen offset:2048 sc1
  buffer_load_dwordx4 a[76:79], v2, s[8:11], s22 offen offset:3072 sc1
  s_add_u32 s22, s21, 20480
  buffer_load_dwordx4 a[80:83], v2, s[8:11], s22 offen offset:0 sc1
  buffer_load_dwordx4 a[84:87], v2, s[8:11], s22 offen offset:1024 sc1
  buffer_load_dwordx4 a[88:91], v2, s[8:11], s22 offen offset:2048 sc1
  buffer_load_dwordx4 a[92:95], v2, s[8:11], s22 offen offset:3072 sc1
  s_add_u32 s22, s21, 24576
  buffer_load_dwordx4 a[96:99], v2, s[8:11], s22 offen offset:0 sc1
  buffer_load_dwordx4 a[100:103], v2, s[8:11], s22 offen offset:1024 sc1
  buffer_load_dwordx4 a[104:107], v2, s[8:11], s22 offen offset:2048 sc1
  buffer_load_dwordx4 a[108:111], v2, s[8:11], s22 offen offset:3072 sc1
  s_waitcnt vmcnt(40)
  s_mul_i32 s23, s17, 401408
  s_and_b32 s22, s16, 1
  s_mul_i32 s22, s22, 7168
  s_add_u32 s23, s23, s22
  s_add_u32 s23, s23, 0
  s_lshr_b32 s22, s16, 1
  s_mul_i32 s22, s22, 14336
  s_add_u32 s23, s23, s22
  s_mul_i32 s27, s16, 7168
  s_lshr_b32 s28, s20, 1
wf_vo:
  s_sub_u32 s29, s17, 16
  s_lshl_b32 s29, s29, 6
  s_add_u32 s29, s29, s28
  s_mul_i32 s29, s29, 28672
  s_add_u32 s29, s29, 42205184
  v_mul_u32_u24 v6, 28, v3
  s_mov_b32 s31, 0
  s_lshl_b32 s24, s34, 1
  s_mul_i32 s24, s24, 14336
  s_add_u32 s24, s24, s23
  s_cmp_lt_u32 s34, s35
  s_cselect_b32 s24, s24, 0x10000000
  s_add_u32 m0, s31, s27
  s_nop 0
  buffer_load_dwordx4 v2, s[8:11], s24 offen offset:0 sc1 lds
  buffer_load_dwordx4 v2, s[8:11], s24 offen offset:1024 sc1 lds
  buffer_load_dwordx4 v2, s[8:11], s24 offen offset:2048 sc1 lds
  buffer_load_dwordx4 v2, s[8:11], s24 offen offset:3072 sc1 lds
  s_add_u32 m0, m0, 4096
  s_add_u32 s24, s24, 4096
  buffer_load_dwordx4 v2, s[8:11], s24 offen offset:0 sc1 lds
  buffer_load_dwordx4 v2, s[8:11], s24 offen offset:1024 sc1 lds
  buffer_load_dwordx4 v2, s[8:11], s24 offen offset:2048 sc1 lds
  s_add_u32 s30, s34, 1
  s_mov_b32 s31, 28672
  s_lshl_b32 s24, s30, 1
  s_mul_i32 s24, s24, 14336
  s_add_u32 s24, s24, s23
  s_cmp_lt_u32 s30, s35
  s_cselect_b32 s24, s24, 0x10000000
  s_add_u32 m0, s31, s27
  s_nop 0
  buffer_load_dwordx4 v2, s[8:11], s24 offen offset:0 sc1 lds
  buffer_load_dwordx4 v2, s[8:11], s24 offen offset:1024 sc1 lds
  buffer_load_dwordx4 v2, s[8:11], s24 offen offset:2048 sc1 lds
  buffer_load_dwordx4 v2, s[8:11], s24 offen offset:3072 sc1 lds
  s_add_u32 m0, m0, 4096
  s_add_u32 s24, s24, 4096
  buffer_load_dwordx4 v2, s[8:11], s24 offen offset:0 sc1 lds
  buffer_load_dwordx4 v2, s[8:11], s24 offen offset:1024 sc1 lds
  buffer_load_dwordx4 v2, s[8:11], s24 offen offset:2048 sc1 lds
  s_mov_b32 s19, s34
  s_mov_b32 s32, 0
  s_mov_b32 s33, 57344
  s_waitcnt vmcnt(7)
  s_branch wf_vo_in
wf_vo_loop:
  s_waitcnt vmcnt(9)
wf_vo_in:
  s_barrier
  s_add_u32 s30, s19, 2
  s_lshl_b32 s24, s30, 1
  s_mul_i32 s24, s24, 14336
  s_add_u32 s24, s24, s23
  s_cmp_lt_u32 s30, s35
  s_cselect_b32 s24, s24, 0x10000000
  s_add_u32 m0, s33, s27
  s_nop 0
  buffer_load_dwordx4 v2, s[8:11], s24 offen offset:0 sc1 lds
  buffer_load_dwordx4 v2, s[8:11], s24 offen offset:1024 sc1 lds
  buffer_load_dwordx4 v2, s[8:11], s24 offen offset:2048 sc1 lds
  buffer_load_dwordx4 v2, s[8:11], s24 offen offset:3072 sc1 lds
  s_add_u32 m0, m0, 4096
  s_add_u32 s24, s24, 4096
  buffer_load_dwordx4 v2, s[8:11], s24 offen offset:0 sc1 lds
  buffer_load_dwordx4 v2, s[8:11], s24 offen offset:1024 sc1 lds
  buffer_load_dwordx4 v2, s[8:11], s24 offen offset:2048 sc1 lds
  v_add_u32 v5, s32, v2
  ds_read_b128 v[8:11], v5 offset:0
  ds_read_b128 v[12:15], v5 offset:14336
  ds_read_b128 v[16:19], v5 offset:1024
  ds_read_b128 v[20:23], v5 offset:15360
  ds_read_b128 v[24:27], v5 offset:2048
  ds_read_b128 v[28:31], v5 offset:16384
  ds_read_b128 v[32:35], v5 offset:3072
  s_waitcnt lgkmcnt(6)
  v_mfma_f32_16x16x32_bf16 v[40:43], a[0:3], v[8:11], 0
  v_mfma_f32_16x16x32_bf16 v[44:47], a[56:59], v[8:11], 0
  ds_read_b128 v[36:39], v5 offset:17408
  s_waitcnt lgkmcnt(6)
  v_mfma_f32_16x16x32_bf16 v[56:59], a[0:3], v[12:15], 0
  v_mfma_f32_16x16x32_bf16 v[60:63], a[56:59], v[12:15], 0
  ds_read_b128 v[8:11], v5 offset:4096
  s_waitcnt lgkmcnt(6)
  v_mfma_f32_16x16x32_bf16 v[40:43], a[4:7], v[16:19], v[40:43]
  v_mfma_f32_16x16x32_bf16 v[44:47], a[60:63], v[16:19], v[44:47]
  ds_read_b128 v[12:15], v5 offset:18432
  s_waitcnt lgkmcnt(6)
  v_mfma_f32_16x16x32_bf16 v[56:59], a[4:7], v[20:23], v[56:59]
  v_mfma_f32_16x16x32_bf16 v[60:63], a[60:63], v[20:23], v[60:63]
  ds_read_b128 v[16:19], v5 offset:5120
  s_waitcnt lgkmcnt(6)
  v_mfma_f32_16x16x32_bf16 v[40:43], a[8:11], v[24:27], v[40:43]
  v_mfma_f32_16x16x32_bf16 v[44:47], a[64:67], v[24:27], v[44:47]
  ds_read_b128 v[20:23], v5 offset:19456
  s_waitcnt lgkmcnt(6)
  v_mfma_f32_16x16x32_bf16 v[56:59], a[8:11], v[28:31], v[56:59]
  v_mfma_f32_16x16x32_bf16 v[60:63], a[64:67], v[28:31], v[60:63]
  ds_read_b128 v[24:27], v5 offset:6144
  s_waitcnt lgkmcnt(6)
  v_mfma_f32_16x16x32_bf16 v[40:43], a[12:15], v[32:35], v[40:43]
  v_mfma_f32_16x16x32_bf16 v[44:47], a[68:71], v[32:35], v[44:47]
  ds_read_b128 v[28:31], v5 offset:20480
  s_waitcnt lgkmcnt(6)
  v_mfma_f32_16x16x32_bf16 v[56:59], a[12:15], v[36:39], v[56:59]
  v_mfma_f32_16x16x32_bf16 v[60:63], a[68:71], v[36:39], v[60:63]
  ds_read_b128 v[32:35], v5 offset:7168
  s_waitcnt lgkmcnt(6)
  v_mfma_f32_16x16x32_bf16 v[40:43], a[16:19], v[8:11], v[40:43]
  v_mfma_f32_16x16x32_bf16 v[44:47], a[72:75], v[8:11], v[44:47]
  ds_read_b128 v[36:39], v5 offset:21504
  s_waitcnt lgkmcnt(6)
  v_mfma_f32_16x16x32_bf16 v[56:59], a[16:19], v[12:15], v[56:59]
  v_mfma_f32_16x16x32_bf16 v[60:63], a[72:75], v[12:15], v[60:63]
  ds_read_b128 v[8:11], v5 offset:8192
  s_waitcnt lgkmcnt(6)
  v_mfma_f32_16x16x32_bf16 v[40:43], a[20:23], v[16:19], v[40:43]
  v_mfma_f32_16x16x32_bf16 v[44:47], a[76:79], v[16:19], v[44:47]
  ds_read_b128 v[12:15], v5 offset:22528
  s_waitcnt lgkmcnt(6)
  v_mfma_f32_16x16x32_bf16 v[56:59], a[20:23], v[20:23], v[56:59]
  v_mfma_f32_16x16x32_bf16 v[60:63], a[76:79], v[20:23], v[60:63]
  ds_read_b128 v[16:19], v5 offset:9216
  s_waitcnt lgkmcnt(6)
  v_mfma_f32_16x16x32_bf16 v[40:43], a[24:27], v[24:27], v[40:43]
  v_mfma_f32_16x16x32_bf16 v[44:47], a[80:83], v[24:27], v[44:47]
  ds_read_b128 v[20:23], v5 offset:23552
  s_waitcnt lgkmcnt(6)
  v_mfma_f32_16x16x32_bf16 v[56:59], a[24:27], v[28:31], v[56:59]
  v_mfma_f32_16x16x32_bf16 v[60:63], a[80:83], v[28:31], v[60:63]
  ds_read_b128 v[24:27], v5 offset:10240
  s_waitcnt lgkmcnt(6)
  v_mfma_f32_16x16x32_bf16 v[40:43], a[28:31], v[32:35], v[40:43]
  v_mfma_f32_16x16x32_bf16 v[44:47], a[84:87], v[32:35], v[44:47]
  ds_read_b128 v[28:31], v5 offset:24576
  s_waitcnt lgkmcnt(6)
  v_mfma_f32_16x16x32_bf16 v[56:59], a[28:31], v[36:39], v[56:59]
  v_mfma_f32_16x16x32_bf16 v[60:63], a[84:87], v[36:39], v[60:63]
  ds_read_b128 v[32:35], v5 offset:11264
  s_waitcnt lgkmcnt(6)
  v_mfma_f32_16x16x32_bf16 v[40:43], a[32:35], v[8:11], v[40:43]
  v_mfma_f32_16x16x32_bf16 v[44:47], a[88:91], v[8:11], v[44:47]
  ds_read_b128 v[36:39], v5 offset:25600
  s_waitcnt lgkmcnt(6)
  v_mfma_f32_16x16x32_bf16 v[56:59], a[32:35], v[12:15], v[56:59]
  v_mfma_f32_16x16x32_bf16 v[60:63], a[88:91], v[12:15], v[60:63]
  ds_read_b128 v[8:11], v5 offset:12288
  s_waitcnt lgkmcnt(6)
  v_mfma_f32_16x16x32_bf16 v[40:43], a[36:39], v[16:19], v[40:43]
  v_mfma_f32_16x16x32_bf16 v[44:47], a[92:95], v[16:19], v[44:47]
  ds_read_b128 v[12:15], v5 offset:26624
  s_waitcnt lgkmcnt(6)
  v_mfma_f32_16x16x32_bf16 v[56:59], a[36:39], v[20:23], v[56:59]
  v_mfma_f32_16x16x32_bf16 v[60:63], a[92:95], v[20:23], v[60:63]
  ds_read_b128 v[16:19], v5 offset:13312
  s_waitcnt lgkmcnt(6)
  v_mfma_f32_16x16x32_bf16 v[40:43], a[40:43], v[24:27], v[40:43]
  v_mfma_f32_16x16x32_bf16 v[44:47], a[96:99], v[24:27], v[44:47]
  ds_read_b128 v[20:23], v5 offset:27648
  s_waitcnt lgkmcnt(6)
  v_mfma_f32_16x16x32_bf16 v[56:59], a[40:43], v[28:31], v[56:59]
  v_mfma_f32_16x16x32_bf16 v[60:63], a[96:99], v[28:31], v[60:63]
  s_waitcnt lgkmcnt(5)
  v_mfma_f32_16x16x32_bf16 v[40:43], a[44:47], v[32:35], v[40:43]
  v_mfma_f32_16x16x32_bf16 v[44:47], a[100:103], v[32:35], v[44:47]
  s_waitcnt lgkmcnt(4)
  v_mfma_f32_16x16x32_bf16 v[56:59], a[44:47], v[36:39], v[56:59]
  v_mfma_f32_16x16x32_bf16 v[60:63], a[100:103], v[36:39], v[60:63]
  s_waitcnt lgkmcnt(3)
  v_mfma_f32_16x16x32_bf16 v[40:43], a[48:51], v[8:11], v[40:43]
  v_mfma_f32_16x16x32_bf16 v[44:47], a[104:107], v[8:11], v[44:47]
  s_waitcnt lgkmcnt(2)
  v_mfma_f32_16x16x32_bf16 v[56:59], a[48:51], v[12:15], v[56:59]
  v_mfma_f32_16x16x32_bf16 v[60:63], a[104:107], v[12:15], v[60:63]
  s_waitcnt lgkmcnt(1)
  v_mfma_f32_16x16x32_bf16 v[40:43], a[52:55], v[16:19], v[40:43]
  v_mfma_f32_16x16x32_bf16 v[44:47], a[108:111], v[16:19], v[44:47]
  s_waitcnt lgkmcnt(0)
  v_mfma_f32_16x16x32_bf16 v[56:59], a[52:55], v[20:23], v[56:59]
  v_mfma_f32_16x16x32_bf16 v[60:63], a[108:111], v[20:23], v[60:63]
  s_add_u32 s25, s29, 28672
  s_lshl_b32 s24, s19, 5
  s_add_u32 s24, s24, 0
  v_add_u32 v88, s24, v4
  v_mul_u32_u24 v89, 2341, v88
  v_lshrrev_b32 v89, 16, v89
  v_mul_u32_u24 v89, 84, v89
  v_add3_u32 v88, v88, v89, v6
  v_lshlrev_b32 v90, 4, v88
  v_cvt_pk_bf16_f32 v72, v40, v41
  v_cvt_pk_bf16_f32 v73, v42, v43
  v_cvt_pk_bf16_f32 v74, v44, v45
  v_cvt_pk_bf16_f32 v75, v46, v47
  buffer_store_dwordx4 v[72:75], v90, s[8:11], s29 offen sc1
  s_lshl_b32 s24, s19, 5
  s_add_u32 s24, s24, 16
  v_add_u32 v88, s24, v4
  v_mul_u32_u24 v89, 2341, v88
  v_lshrrev_b32 v89, 16, v89
  v_mul_u32_u24 v89, 84, v89
  v_add3_u32 v88, v88, v89, v6
  v_lshlrev_b32 v91, 4, v88
  v_cvt_pk_bf16_f32 v80, v56, v57
  v_cvt_pk_bf16_f32 v81, v58, v59
  v_cvt_pk_bf16_f32 v82, v60, v61
  v_cvt_pk_bf16_f32 v83, v62, v63
  buffer_store_dwordx4 v[80:83], v91, s[8:11], s29 offen sc1
  s_mov_b32 s33, s32
  s_add_u32 s32, s32, 28672
  s_cmp_eq_u32 s32, 86016
  s_cselect_b32 s32, 0, s32
  s_add_u32 s19, s19, 1
  s_cmp_lt_u32 s19, s35
  s_cbranch_scc1 wf_vo_loop
  s_branch wf_done
wf_done:
  s_lshr_b32 s20, s18, 1
  s_lshl_b32 s20, s20, 4
  s_and_b32 s21, s17, 15
  s_add_u32 s20, s20, s21
  s_lshl_b32 s20, s20, 7
  s_cmp_lt_u32 s17, 16
  s_cselect_b32 s21, 16384, 0
  s_add_u32 s20, s20, s21
  s_add_u32 s20, s20, 88541184
  s_sub_u32 s21, s35, s34
  s_lshr_b32 s21, s21, 1
  v_mov_b32 v5, s21
  v_mov_b32 v6, 0
  s_waitcnt vmcnt(0)
  s_mov_b64 exec, 1
  s_cmp_lg_u32 s18, 0
  s_cbranch_scc1 wf_h1
  v_mov_b32 v7, 2
  s_sub_u32 s21, s20, 2048
  buffer_atomic_add v7, v6, s[8:11], s21 offen
wf_h1:
  buffer_atomic_add v5, v6, s[8:11], s20 offen
  s_mov_b64 exec, -1
  s_load_dwordx8 s[36:43], s[0:1], 56
  s_load_dwordx4 s[44:47], s[0:1], 88
  s_waitcnt lgkmcnt(0)
  s_mov_b32 s52, s36
  s_and_b32 s53, s37, 0xffff
  s_mov_b32 s54, 1835008
  s_mov_b32 s55, 0x20000
  s_lshl_b32 s20, s3, 8
  v_add_u32 v95, s20, v0
  s_mov_b32 s21, 9586981
  v_mul_hi_u32 v6, v95, s21
  v_mul_u32_u24 v7, 448, v6
  v_sub_u32 v7, v95, v7
  v_lshrrev_b32 v8, 4, v7
  v_and_b32 v7, 15, v7
  v_lshl_add_u32 v9, v6, 4, v7
  v_mul_u32_u24 v9, 896, v9
  v_lshl_add_u32 v9, v8, 5, v9
  buffer_load_dwordx4 v[84:87], v9, s[52:55], 0 offen
  buffer_load_dwordx4 v[88:91], v9, s[52:55], 0 offen offset:16
  v_mul_u32_u24 v6, 14336, v6
  v_lshl_add_u32 v6, v7, 4, v6
  v_lshl_add_u32 v92, v8, 9, v6
  v_lshrrev_b32 v7, 2, v8
  v_lshl_add_u32 v6, v7, 11, v6
  v_and_b32 v7, 3, v8
  v_lshl_add_u32 v93, v7, 8, v6
  v_mov_b32 v52, -1
  v_mov_b32 v53, -1
  v_mov_b32 v54, -1
  v_mov_b32 v55, -1
  s_mov_b32 s23, 89063424
  v_lshlrev_b32 v8, 4, v95
  buffer_store_dwordx4 v[52:55], v8, s[8:11], s23 offen sc1
  v_add_u32 v8, 917504, v8
  v_mov_b32 v9, 0x10000000
  v_cmp_lt_u32 vcc, 1535, v95
  s_nop 1
  v_cndmask_b32 v8, v8, v9, vcc
  buffer_store_dwordx4 v[52:55], v8, s[8:11], s23 offen sc1
  s_waitcnt vmcnt(1)
  v_mov_b32 v96, v84
  v_mov_b32 v100, v85
  v_mov_b32 v97, v86
  v_mov_b32 v101, v87
  v_mov_b32 v98, v88
  v_mov_b32 v102, v89
  v_mov_b32 v99, v90
  v_mov_b32 v103, v91
  s_mov_b32 s20, 71565312
  s_mov_b32 s21, 73400320
  buffer_store_dwordx4 v[96:99], v93, s[8:11], s21 offen sc1
  buffer_store_dwordx4 v[100:103], v93, s[8:11], s21 offen offset:1024 sc1
  s_cmp_lt_u32 s3, 70
  s_cbranch_scc1 i2_nx
  buffer_store_dwordx4 v[84:87], v92, s[8:11], s20 offen sc1
  buffer_store_dwordx4 v[88:91], v92, s[8:11], s20 offen offset:256 sc1
i2_nx:
  s_lshl_b32 s20, s3, 3
  s_add_u32 s20, s20, 88637440
  s_waitcnt vmcnt(0)
  s_barrier
  s_cmp_lg_u32 s16, 0
  s_cbranch_scc1 pub_38
  v_mul_u32_u24 v26, 2048, v1
  v_mov_b32 v24, s88
  v_mov_b32 v25, s89
  s_mov_b64 exec, 255
  buffer_store_dwordx2 v[24:25], v26, s[8:11], s20 offen sc1
  s_mov_b64 exec, -1
pub_38:
  s_branch wk_loop
wk_v7:
  s_sub_u32 s20, s3, 256
  s_mov_b32 s18, 1
  s_and_b32 s17, s20, 15
  s_add_u32 s17, s17, 16
  s_lshr_b32 s34, s20, 4
  s_lshl_b32 s34, s34, 1
  s_add_u32 s35, s34, 2
  s_branch wk_gemm
wk_vh:
  s_sub_u32 s20, s3, 368
  s_and_b32 s17, s20, 15
  s_add_u32 s17, s17, 16
  s_lshr_b32 s18, s20, 5
  s_add_u32 s18, s18, 2
  s_bitcmp1_b32 s20, 4
  s_cselect_b32 s34, 7, 0
  s_add_u32 s35, s34, 7
  s_branch wk_gemm
wk_vf:
  s_sub_u32 s20, s3, 560
  s_and_b32 s17, s20, 15
  s_add_u32 s17, s17, 16
  s_lshr_b32 s18, s20, 4
  s_add_u32 s18, s18, 4
  s_mov_b32 s34, 0
  s_mov_b32 s35, 14
  s_branch wk_gemm
wk_f:
  s_sub_u32 s20, s3, 624
  s_and_b32 s17, s20, 15
  s_lshr_b32 s18, s20, 4
  s_mov_b32 s34, 0
  s_mov_b32 s35, 14
  s_lshl_b32 s22, s17, 7
  s_add_u32 s22, s22, 88633344
  s_add_u32 s23, s22, 2048
  v_min_u32 v24, 48, v2
  v_min_u32 v25, 96, v2
  s_mov_b32 s30, 0
wk_aw:
  buffer_load_dwordx4 v[28:31], v24, s[8:11], s22 offen sc1
  buffer_load_dwordx4 v[32:35], v25, s[8:11], s23 offen sc1
  s_waitcnt vmcnt(0)
  v_cmp_ne_u64 vcc, s[88:89], v[28:29]
  s_cbranch_vccnz wk_aw_no
  v_cmp_ne_u64 vcc, s[88:89], v[30:31]
  s_cbranch_vccnz wk_aw_no
  v_cmp_ne_u64 vcc, s[88:89], v[32:33]
  s_cbranch_vccnz wk_aw_no
  v_cmp_ne_u64 vcc, s[88:89], v[34:35]
  s_cbranch_vccnz wk_aw_no
  s_branch wk_aw_ok
wk_aw_no:
  s_sleep 6
  s_add_u32 s30, s30, 1
  s_cmp_lt_u32 s30, 50000
  s_cbranch_scc1 wk_aw
  s_branch cA_abort
wk_aw_ok:
wk_gemm:
  s_lshl_b32 s20, s18, 4
  s_lshl_b32 s21, s16, 2
  s_add_u32 s20, s20, s21
  s_mul_i32 s21, s20, 14336
  s_add_u32 s21, s21, 71565312
  s_add_u32 s22, s21, 0
  buffer_load_dwordx4 a[0:3], v2, s[8:11], s22 offen offset:0 sc1
  buffer_load_dwordx4 a[4:7], v2, s[8:11], s22 offen offset:1024 sc1
  buffer_load_dwordx4 a[8:11], v2, s[8:11], s22 offen offset:2048 sc1
  buffer_load_dwordx4 a[12:15], v2, s[8:11], s22 offen offset:3072 sc1
  s_add_u32 s22, s21, 4096
  buffer_load_dwordx4 a[16:19], v2, s[8:11], s22 offen offset:0 sc1
  buffer_load_dwordx4 a[20:23], v2, s[8:11], s22 offen offset:1024 sc1
  buffer_load_dwordx4 a[24:27], v2, s[8:11], s22 offen offset:2048 sc1
  buffer_load_dwordx4 a[28:31], v2, s[8:11], s22 offen offset:3072 sc1
  s_add_u32 s22, s21, 8192
  buffer_load_dwordx4 a[32:35], v2, s[8:11], s22 offen offset:0 sc1
  buffer_load_dwordx4 a[36:39], v2, s[8:11], s22 offen offset:1024 sc1
  buffer_load_dwordx4 a[40:43], v2, s[8:11], s22 offen offset:2048 sc1
  buffer_load_dwordx4 a[44:47], v2, s[8:11], s22 offen offset:3072 sc1
  s_add_u32 s22, s21, 12288
  buffer_load_dwordx4 a[48:51], v2, s[8:11], s22 offen offset:0 sc1
  buffer_load_dwordx4 a[52:55], v2, s[8:11], s22 offen offset:1024 sc1
  buffer_load_dwordx4 a[56:59], v2, s[8:11], s22 offen offset:2048 sc1
  buffer_load_dwordx4 a[60:63], v2, s[8:11], s22 offen offset:3072 sc1
  s_add_u32 s22, s21, 16384
  buffer_load_dwordx4 a[64:67], v2, s[8:11], s22 offen offset:0 sc1
  buffer_load_dwordx4 a[68:71], v2, s[8:11], s22 offen offset:1024 sc1
  buffer_load_dwordx4 a[72:75], v2, s[8:11], s22 offen offset:2048 sc1
  buffer_load_dwordx4 a[76:79], v2, s[8:11], s22 offen offset:3072 sc1
  s_add_u32 s22, s21, 20480
  buffer_load_dwordx4 a[80:83], v2, s[8:11], s22 offen offset:0 sc1
  buffer_load_dwordx4 a[84:87], v2, s[8:11], s22 offen offset:1024 sc1
  buffer_load_dwordx4 a[88:91], v2, s[8:11], s22 offen offset:2048 sc1
  buffer_load_dwordx4 a[92:95], v2, s[8:11], s22 offen offset:3072 sc1
  s_add_u32 s22, s21, 24576
  buffer_load_dwordx4 a[96:99], v2, s[8:11], s22 offen offset:0 sc1
  buffer_load_dwordx4 a[100:103], v2, s[8:11], s22 offen offset:1024 sc1
  buffer_load_dwordx4 a[104:107], v2, s[8:11], s22 offen offset:2048 sc1
  buffer_load_dwordx4 a[108:111], v2, s[8:11], s22 offen offset:3072 sc1
  s_add_u32 s22, s21, 28672
  buffer_load_dwordx4 a[112:115], v2, s[8:11], s22 offen offset:0 sc1
  buffer_load_dwordx4 a[116:119], v2, s[8:11], s22 offen offset:1024 sc1
  buffer_load_dwordx4 a[120:123], v2, s[8:11], s22 offen offset:2048 sc1
  buffer_load_dwordx4 a[124:127], v2, s[8:11], s22 offen offset:3072 sc1
  s_add_u32 s22, s21, 32768
  buffer_load_dwordx4 a[128:131], v2, s[8:11], s22 offen offset:0 sc1
  buffer_load_dwordx4 a[132:135], v2, s[8:11], s22 offen offset:1024 sc1
  buffer_load_dwordx4 a[136:139], v2, s[8:11], s22 offen offset:2048 sc1
  buffer_load_dwordx4 a[140:143], v2, s[8:11], s22 offen offset:3072 sc1
  s_add_u32 s22, s21, 36864
  buffer_load_dwordx4 a[144:147], v2, s[8:11], s22 offen offset:0 sc1
  buffer_load_dwordx4 a[148:151], v2, s[8:11], s22 offen offset:1024 sc1
  buffer_load_dwordx4 a[152:155], v2, s[8:11], s22 offen offset:2048 sc1
  buffer_load_dwordx4 a[156:159], v2, s[8:11], s22 offen offset:3072 sc1
  s_add_u32 s22, s21, 40960
  buffer_load_dwordx4 a[160:163], v2, s[8:11], s22 offen offset:0 sc1
  buffer_load_dwordx4 a[164:167], v2, s[8:11], s22 offen offset:1024 sc1
  buffer_load_dwordx4 a[168:171], v2, s[8:11], s22 offen offset:2048 sc1
  buffer_load_dwordx4 a[172:175], v2, s[8:11], s22 offen offset:3072 sc1
  s_add_u32 s22, s21, 45056
  buffer_load_dwordx4 a[176:179], v2, s[8:11], s22 offen offset:0 sc1
  buffer_load_dwordx4 a[180:183], v2, s[8:11], s22 offen offset:1024 sc1
  buffer_load_dwordx4 a[184:187], v2, s[8:11], s22 offen offset:2048 sc1
  buffer_load_dwordx4 a[188:191], v2, s[8:11], s22 offen offset:3072 sc1
  s_add_u32 s22, s21, 49152
  buffer_load_dwordx4 a[192:195], v2, s[8:11], s22 offen offset:0 sc1
  buffer_load_dwordx4 a[196:199], v2, s[8:11], s22 offen offset:1024 sc1
  buffer_load_dwordx4 a[200:203], v2, s[8:11], s22 offen offset:2048 sc1
  buffer_load_dwordx4 a[204:207], v2, s[8:11], s22 offen offset:3072 sc1
  s_add_u32 s22, s21, 53248
  buffer_load_dwordx4 a[208:211], v2, s[8:11], s22 offen offset:0 sc1
  buffer_load_dwordx4 a[212:215], v2, s[8:11], s22 offen offset:1024 sc1
  buffer_load_dwordx4 a[216:219], v2, s[8:11], s22 offen offset:2048 sc1
  buffer_load_dwordx4 a[220:223], v2, s[8:11], s22 offen offset:3072 sc1
  s_waitcnt vmcnt(40)
  s_mul_i32 s23, s17, 401408
  s_and_b32 s22, s16, 1
  s_mul_i32 s22, s22, 7168
  s_add_u32 s23, s23, s22
  s_add_u32 s23, s23, 0
  s_lshr_b32 s22, s16, 1
  s_mul_i32 s22, s22, 14336
  s_add_u32 s23, s23, s22
  s_mul_i32 s27, s16, 7168
  s_lshr_b32 s28, s20, 1
  s_cmp_lt_u32 s17, 16
  s_cbranch_scc0 wg_vo
  s_add_u32 s23, s23, s22
  s_lshl_b32 s29, s28, 4
  s_add_u32 s29, s29, s17
  s_mul_i32 s29, s29, 28672
  s_add_u32 s29, s29, 12845056
  s_mov_b32 s31, 0
  s_lshr_b32 s24, s34, 1
  s_lshl_b32 s24, s24, 2
  s_and_b32 s25, s34, 1
  s_add_u32 s24, s24, s25
  s_mul_i32 s24, s24, 14336
  s_add_u32 s24, s24, s23
  s_cmp_lt_u32 s34, s35
  s_cselect_b32 s24, s24, 0x10000000
  s_add_u32 m0, s31, s27
  s_nop 0
  buffer_load_dwordx4 v2, s[8:11], s24 offen offset:0 sc1 lds
  buffer_load_dwordx4 v2, s[8:11], s24 offen offset:1024 sc1 lds
  buffer_load_dwordx4 v2, s[8:11], s24 offen offset:2048 sc1 lds
  buffer_load_dwordx4 v2, s[8:11], s24 offen offset:3072 sc1 lds
  s_add_u32 m0, m0, 4096
  s_add_u32 s24, s24, 4096
  buffer_load_dwordx4 v2, s[8:11], s24 offen offset:0 sc1 lds
  buffer_load_dwordx4 v2, s[8:11], s24 offen offset:1024 sc1 lds
  buffer_load_dwordx4 v2, s[8:11], s24 offen offset:2048 sc1 lds
  s_add_u32 s30, s34, 1
  s_mov_b32 s31, 28672
  s_lshr_b32 s24, s30, 1
  s_lshl_b32 s24, s24, 2
  s_and_b32 s25, s30, 1
  s_add_u32 s24, s24, s25
  s_mul_i32 s24, s24, 14336
  s_add_u32 s24, s24, s23
  s_cmp_lt_u32 s30, s35
  s_cselect_b32 s24, s24, 0x10000000
  s_add_u32 m0, s31, s27
  s_nop 0
  buffer_load_dwordx4 v2, s[8:11], s24 offen offset:0 sc1 lds
  buffer_load_dwordx4 v2, s[8:11], s24 offen offset:1024 sc1 lds
  buffer_load_dwordx4 v2, s[8:11], s24 offen offset:2048 sc1 lds
  buffer_load_dwordx4 v2, s[8:11], s24 offen offset:3072 sc1 lds
  s_add_u32 m0, m0, 4096
  s_add_u32 s24, s24, 4096
  buffer_load_dwordx4 v2, s[8:11], s24 offen offset:0 sc1 lds
  buffer_load_dwordx4 v2, s[8:11], s24 offen offset:1024 sc1 lds
  buffer_load_dwordx4 v2, s[8:11], s24 offen offset:2048 sc1 lds
  s_mov_b32 s19, s34
  s_mov_b32 s32, 0
  s_mov_b32 s33, 57344
  s_waitcnt vmcnt(7)
  s_branch wg_f_in
wg_f_loop:
  s_waitcnt vmcnt(11)
wg_f_in:
  s_barrier
  s_add_u32 s30, s19, 2
  s_lshr_b32 s24, s30, 1
  s_lshl_b32 s24, s24, 2
  s_and_b32 s25, s30, 1
  s_add_u32 s24, s24, s25
  s_mul_i32 s24, s24, 14336
  s_add_u32 s24, s24, s23
  s_cmp_lt_u32 s30, s35
  s_cselect_b32 s24, s24, 0x10000000
  s_add_u32 m0, s33, s27
  s_nop 0
  buffer_load_dwordx4 v2, s[8:11], s24 offen offset:0 sc1 lds
  buffer_load_dwordx4 v2, s[8:11], s24 offen offset:1024 sc1 lds
  buffer_load_dwordx4 v2, s[8:11], s24 offen offset:2048 sc1 lds
  buffer_load_dwordx4 v2, s[8:11], s24 offen offset:3072 sc1 lds
  s_add_u32 m0, m0, 4096
  s_add_u32 s24, s24, 4096
  buffer_load_dwordx4 v2, s[8:11], s24 offen offset:0 sc1 lds
  buffer_load_dwordx4 v2, s[8:11], s24 offen offset:1024 sc1 lds
  buffer_load_dwordx4 v2, s[8:11], s24 offen offset:2048 sc1 lds
  v_add_u32 v5, s32, v2
  ds_read_b128 v[8:11], v5 offset:0
  ds_read_b128 v[12:15], v5 offset:14336
  ds_read_b128 v[16:19], v5 offset:1024
  ds_read_b128 v[20:23], v5 offset:15360
  ds_read_b128 v[24:27], v5 offset:2048
  ds_read_b128 v[28:31], v5 offset:16384
  ds_read_b128 v[32:35], v5 offset:3072
  s_waitcnt lgkmcnt(6)
  v_mfma_f32_16x16x32_bf16 v[40:43], v[8:11], a[0:3], 0
  v_mfma_f32_16x16x32_bf16 v[44:47], v[8:11], a[56:59], 0
  v_mfma_f32_16x16x32_bf16 v[48:51], v[8:11], a[112:115], 0
  v_mfma_f32_16x16x32_bf16 v[52:55], v[8:11], a[168:171], 0
  ds_read_b128 v[36:39], v5 offset:17408
  s_waitcnt lgkmcnt(6)
  v_mfma_f32_16x16x32_bf16 v[56:59], v[12:15], a[0:3], 0
  v_mfma_f32_16x16x32_bf16 v[60:63], v[12:15], a[56:59], 0
  v_mfma_f32_16x16x32_bf16 v[64:67], v[12:15], a[112:115], 0
  v_mfma_f32_16x16x32_bf16 v[68:71], v[12:15], a[168:171], 0
  ds_read_b128 v[8:11], v5 offset:4096
  s_waitcnt lgkmcnt(6)
  v_mfma_f32_16x16x32_bf16 v[40:43], v[16:19], a[4:7], v[40:43]
  v_mfma_f32_16x16x32_bf16 v[44:47], v[16:19], a[60:63], v[44:47]
  v_mfma_f32_16x16x32_bf16 v[48:51], v[16:19], a[116:119], v[48:51]
  v_mfma_f32_16x16x32_bf16 v[52:55], v[16:19], a[172:175], v[52:55]
  ds_read_b128 v[12:15], v5 offset:18432
  s_waitcnt lgkmcnt(6)
  v_mfma_f32_16x16x32_bf16 v[56:59], v[20:23], a[4:7], v[56:59]
  v_mfma_f32_16x16x32_bf16 v[60:63], v[20:23], a[60:63], v[60:63]
  v_mfma_f32_16x16x32_bf16 v[64:67], v[20:23], a[116:119], v[64:67]
  v_mfma_f32_16x16x32_bf16 v[68:71], v[20:23], a[172:175], v[68:71]
  ds_read_b128 v[16:19], v5 offset:5120
  s_waitcnt lgkmcnt(6)
  v_mfma_f32_16x16x32_bf16 v[40:43], v[24:27], a[8:11], v[40:43]
  v_mfma_f32_16x16x32_bf16 v[44:47], v[24:27], a[64:67], v[44:47]
  v_mfma_f32_16x16x32_bf16 v[48:51], v[24:27], a[120:123], v[48:51]
  v_mfma_f32_16x16x32_bf16 v[52:55], v[24:27], a[176:179], v[52:55]
  ds_read_b128 v[20:23], v5 offset:19456
  s_waitcnt lgkmcnt(6)
  v_mfma_f32_16x16x32_bf16 v[56:59], v[28:31], a[8:11], v[56:59]
  v_mfma_f32_16x16x32_bf16 v[60:63], v[28:31], a[64:67], v[60:63]
  v_mfma_f32_16x16x32_bf16 v[64:67], v[28:31], a[120:123], v[64:67]
  v_mfma_f32_16x16x32_bf16 v[68:71], v[28:31], a[176:179], v[68:71]
  ds_read_b128 v[24:27], v5 offset:6144
  s_waitcnt lgkmcnt(6)
  v_mfma_f32_16x16x32_bf16 v[40:43], v[32:35], a[12:15], v[40:43]
  v_mfma_f32_16x16x32_bf16 v[44:47], v[32:35], a[68:71], v[44:47]
  v_mfma_f32_16x16x32_bf16 v[48:51], v[32:35], a[124:127], v[48:51]
  v_mfma_f32_16x16x32_bf16 v[52:55], v[32:35], a[180:183], v[52:55]
  ds_read_b128 v[28:31], v5 offset:20480
  s_waitcnt lgkmcnt(6)
  v_mfma_f32_16x16x32_bf16 v[56:59], v[36:39], a[12:15], v[56:59]
  v_mfma_f32_16x16x32_bf16 v[60:63], v[36:39], a[68:71], v[60:63]
  v_mfma_f32_16x16x32_bf16 v[64:67], v[36:39], a[124:127], v[64:67]
  v_mfma_f32_16x16x32_bf16 v[68:71], v[36:39], a[180:183], v[68:71]
  ds_read_b128 v[32:35], v5 offset:7168
  s_waitcnt lgkmcnt(6)
  v_mfma_f32_16x16x32_bf16 v[40:43], v[8:11], a[16:19], v[40:43]
  v_mfma_f32_16x16x32_bf16 v[44:47], v[8:11], a[72:75], v[44:47]
  v_mfma_f32_16x16x32_bf16 v[48:51], v[8:11], a[128:131], v[48:51]
  v_mfma_f32_16x16x32_bf16 v[52:55], v[8:11], a[184:187], v[52:55]
  ds_read_b128 v[36:39], v5 offset:21504
  s_waitcnt lgkmcnt(6)
  v_mfma_f32_16x16x32_bf16 v[56:59], v[12:15], a[16:19], v[56:59]
  v_mfma_f32_16x16x32_bf16 v[60:63], v[12:15], a[72:75], v[60:63]
  v_mfma_f32_16x16x32_bf16 v[64:67], v[12:15], a[128:131], v[64:67]
  v_mfma_f32_16x16x32_bf16 v[68:71], v[12:15], a[184:187], v[68:71]
  ds_read_b128 v[8:11], v5 offset:8192
  s_waitcnt lgkmcnt(6)
  v_mfma_f32_16x16x32_bf16 v[40:43], v[16:19], a[20:23], v[40:43]
  v_mfma_f32_16x16x32_bf16 v[44:47], v[16:19], a[76:79], v[44:47]
  v_mfma_f32_16x16x32_bf16 v[48:51], v[16:19], a[132:135], v[48:51]
  v_mfma_f32_16x16x32_bf16 v[52:55], v[16:19], a[188:191], v[52:55]
  ds_read_b128 v[12:15], v5 offset:22528
  s_waitcnt lgkmcnt(6)
  v_mfma_f32_16x16x32_bf16 v[56:59], v[20:23], a[20:23], v[56:59]
  v_mfma_f32_16x16x32_bf16 v[60:63], v[20:23], a[76:79], v[60:63]
  v_mfma_f32_16x16x32_bf16 v[64:67], v[20:23], a[132:135], v[64:67]
  v_mfma_f32_16x16x32_bf16 v[68:71], v[20:23], a[188:191], v[68:71]
  ds_read_b128 v[16:19], v5 offset:9216
  s_waitcnt lgkmcnt(6)
  v_mfma_f32_16x16x32_bf16 v[40:43], v[24:27], a[24:27], v[40:43]
  v_mfma_f32_16x16x32_bf16 v[44:47], v[24:27], a[80:83], v[44:47]
  v_mfma_f32_16x16x32_bf16 v[48:51], v[24:27], a[136:139], v[48:51]
  v_mfma_f32_16x16x32_bf16 v[52:55], v[24:27], a[192:195], v[52:55]
  ds_read_b128 v[20:23], v5 offset:23552
  s_waitcnt lgkmcnt(6)
  v_mfma_f32_16x16x32_bf16 v[56:59], v[28:31], a[24:27], v[56:59]
  v_mfma_f32_16x16x32_bf16 v[60:63], v[28:31], a[80:83], v[60:63]
  v_mfma_f32_16x16x32_bf16 v[64:67], v[28:31], a[136:139], v[64:67]
  v_mfma_f32_16x16x32_bf16 v[68:71], v[28:31], a[192:195], v[68:71]
  ds_read_b128 v[24:27], v5 offset:10240
  s_waitcnt lgkmcnt(6)
  v_mfma_f32_16x16x32_bf16 v[40:43], v[32:35], a[28:31], v[40:43]
  v_mfma_f32_16x16x32_bf16 v[44:47], v[32:35], a[84:87], v[44:47]
  v_mfma_f32_16x16x32_bf16 v[48:51], v[32:35], a[140:143], v[48:51]
  v_mfma_f32_16x16x32_bf16 v[52:55], v[32:35], a[196:199], v[52:55]
  ds_read_b128 v[28:31], v5 offset:24576
  s_waitcnt lgkmcnt(6)
  v_mfma_f32_16x16x32_bf16 v[56:59], v[36:39], a[28:31], v[56:59]
  v_mfma_f32_16x16x32_bf16 v[60:63], v[36:39], a[84:87], v[60:63]
  v_mfma_f32_16x16x32_bf16 v[64:67], v[36:39], a[140:143], v[64:67]
  v_mfma_f32_16x16x32_bf16 v[68:71], v[36:39], a[196:199], v[68:71]
  ds_read_b128 v[32:35], v5 offset:11264
  s_waitcnt lgkmcnt(6)
  v_mfma_f32_16x16x32_bf16 v[40:43], v[8:11], a[32:35], v[40:43]
  v_mfma_f32_16x16x32_bf16 v[44:47], v[8:11], a[88:91], v[44:47]
  v_mfma_f32_16x16x32_bf16 v[48:51], v[8:11], a[144:147], v[48:51]
  v_mfma_f32_16x16x32_bf16 v[52:55], v[8:11], a[200:203], v[52:55]
  ds_read_b128 v[36:39], v5 offset:25600
  s_waitcnt lgkmcnt(6)
  v_mfma_f32_16x16x32_bf16 v[56:59], v[12:15], a[32:35], v[56:59]
  v_mfma_f32_16x16x32_bf16 v[60:63], v[12:15], a[88:91], v[60:63]
  v_mfma_f32_16x16x32_bf16 v[64:67], v[12:15], a[144:147], v[64:67]
  v_mfma_f32_16x16x32_bf16 v[68:71], v[12:15], a[200:203], v[68:71]
  ds_read_b128 v[8:11], v5 offset:12288
  s_waitcnt lgkmcnt(6)
  v_mfma_f32_16x16x32_bf16 v[40:43], v[16:19], a[36:39], v[40:43]
  v_mfma_f32_16x16x32_bf16 v[44:47], v[16:19], a[92:95], v[44:47]
  v_mfma_f32_16x16x32_bf16 v[48:51], v[16:19], a[148:151], v[48:51]
  v_mfma_f32_16x16x32_bf16 v[52:55], v[16:19], a[204:207], v[52:55]
  ds_read_b128 v[12:15], v5 offset:26624
  s_waitcnt lgkmcnt(6)
  v_mfma_f32_16x16x32_bf16 v[56:59], v[20:23], a[36:39], v[56:59]
  v_mfma_f32_16x16x32_bf16 v[60:63], v[20:23], a[92:95], v[60:63]
  v_mfma_f32_16x16x32_bf16 v[64:67], v[20:23], a[148:151], v[64:67]
  v_mfma_f32_16x16x32_bf16 v[68:71], v[20:23], a[204:207], v[68:71]
  ds_read_b128 v[16:19], v5 offset:13312
  s_waitcnt lgkmcnt(6)
  v_mfma_f32_16x16x32_bf16 v[40:43], v[24:27], a[40:43], v[40:43]
  v_mfma_f32_16x16x32_bf16 v[44:47], v[24:27], a[96:99], v[44:47]
  v_mfma_f32_16x16x32_bf16 v[48:51], v[24:27], a[152:155], v[48:51]
  v_mfma_f32_16x16x32_bf16 v[52:55], v[24:27], a[208:211], v[52:55]
  ds_read_b128 v[20:23], v5 offset:27648
  s_waitcnt lgkmcnt(6)
  v_mfma_f32_16x16x32_bf16 v[56:59], v[28:31], a[40:43], v[56:59]
  v_mfma_f32_16x16x32_bf16 v[60:63], v[28:31], a[96:99], v[60:63]
  v_mfma_f32_16x16x32_bf16 v[64:67], v[28:31], a[152:155], v[64:67]
  v_mfma_f32_16x16x32_bf16 v[68:71], v[28:31], a[208:211], v[68:71]
  s_waitcnt lgkmcnt(5)
  v_mfma_f32_16x16x32_bf16 v[40:43], v[32:35], a[44:47], v[40:43]
  v_mfma_f32_16x16x32_bf16 v[44:47], v[32:35], a[100:103], v[44:47]
  v_mfma_f32_16x16x32_bf16 v[48:51], v[32:35], a[156:159], v[48:51]
  v_mfma_f32_16x16x32_bf16 v[52:55], v[32:35], a[212:215], v[52:55]
  s_waitcnt lgkmcnt(4)
  v_mfma_f32_16x16x32_bf16 v[56:59], v[36:39], a[44:47], v[56:59]
  v_mfma_f32_16x16x32_bf16 v[60:63], v[36:39], a[100:103], v[60:63]
  v_mfma_f32_16x16x32_bf16 v[64:67], v[36:39], a[156:159], v[64:67]
  v_mfma_f32_16x16x32_bf16 v[68:71], v[36:39], a[212:215], v[68:71]
  s_waitcnt lgkmcnt(3)
  v_mfma_f32_16x16x32_bf16 v[40:43], v[8:11], a[48:51], v[40:43]
  v_mfma_f32_16x16x32_bf16 v[44:47], v[8:11], a[104:107], v[44:47]
  v_mfma_f32_16x16x32_bf16 v[48:51], v[8:11], a[160:163], v[48:51]
  v_mfma_f32_16x16x32_bf16 v[52:55], v[8:11], a[216:219], v[52:55]
  s_waitcnt lgkmcnt(2)
  v_mfma_f32_16x16x32_bf16 v[56:59], v[12:15], a[48:51], v[56:59]
  v_mfma_f32_16x16x32_bf16 v[60:63], v[12:15], a[104:107], v[60:63]
  v_mfma_f32_16x16x32_bf16 v[64:67], v[12:15], a[160:163], v[64:67]
  v_mfma_f32_16x16x32_bf16 v[68:71], v[12:15], a[216:219], v[68:71]
  s_waitcnt lgkmcnt(1)
  v_mfma_f32_16x16x32_bf16 v[40:43], v[16:19], a[52:55], v[40:43]
  v_mfma_f32_16x16x32_bf16 v[44:47], v[16:19], a[108:111], v[44:47]
  v_mfma_f32_16x16x32_bf16 v[48:51], v[16:19], a[164:167], v[48:51]
  v_mfma_f32_16x16x32_bf16 v[52:55], v[16:19], a[220:223], v[52:55]
  s_waitcnt lgkmcnt(0)
  v_mfma_f32_16x16x32_bf16 v[56:59], v[20:23], a[52:55], v[56:59]
  v_mfma_f32_16x16x32_bf16 v[60:63], v[20:23], a[108:111], v[60:63]
  v_mfma_f32_16x16x32_bf16 v[64:67], v[20:23], a[164:167], v[64:67]
  v_mfma_f32_16x16x32_bf16 v[68:71], v[20:23], a[220:223], v[68:71]
  s_lshl_b32 s24, s19, 10
  s_add_u32 s24, s24, s29
  v_cvt_pk_bf16_f32 v72, v40, v41
  v_cvt_pk_bf16_f32 v73, v42, v43
  v_cvt_pk_bf16_f32 v74, v56, v57
  v_cvt_pk_bf16_f32 v75, v58, v59
  s_add_u32 s25, s24, 0
  buffer_store_dwordx4 v[72:75], v2, s[8:11], s25 offen sc1
  v_cvt_pk_bf16_f32 v76, v44, v45
  v_cvt_pk_bf16_f32 v77, v46, v47
  v_cvt_pk_bf16_f32 v78, v60, v61
  v_cvt_pk_bf16_f32 v79, v62, v63
  s_add_u32 s25, s24, 14336
  buffer_store_dwordx4 v[76:79], v2, s[8:11], s25 offen sc1
  v_cvt_pk_bf16_f32 v80, v48, v49
  v_cvt_pk_bf16_f32 v81, v50, v51
  v_cvt_pk_bf16_f32 v82, v64, v65
  v_cvt_pk_bf16_f32 v83, v66, v67
  s_add_u32 s25, s24, 458752
  buffer_store_dwordx4 v[80:83], v2, s[8:11], s25 offen sc1
  v_cvt_pk_bf16_f32 v84, v52, v53
  v_cvt_pk_bf16_f32 v85, v54, v55
  v_cvt_pk_bf16_f32 v86, v68, v69
  v_cvt_pk_bf16_f32 v87, v70, v71
  s_add_u32 s25, s24, 473088
  buffer_store_dwordx4 v[84:87], v2, s[8:11], s25 offen sc1
  s_mov_b32 s33, s32
  s_add_u32 s32, s32, 28672
  s_cmp_eq_u32 s32, 86016
  s_cselect_b32 s32, 0, s32
  s_add_u32 s19, s19, 1
  s_cmp_lt_u32 s19, s35
  s_cbranch_scc1 wg_f_loop
  s_branch wg_done
wg_vo:
  s_sub_u32 s29, s17, 16
  s_lshl_b32 s29, s29, 6
  s_add_u32 s29, s29, s28
  s_mul_i32 s29, s29, 28672
  s_add_u32 s29, s29, 42205184
  v_mul_u32_u24 v6, 28, v3
  s_mov_b32 s31, 0
  s_lshl_b32 s24, s34, 1
  s_mul_i32 s24, s24, 14336
  s_add_u32 s24, s24, s23
  s_cmp_lt_u32 s34, s35
  s_cselect_b32 s24, s24, 0x10000000
  s_add_u32 m0, s31, s27
  s_nop 0
  buffer_load_dwordx4 v2, s[8:11], s24 offen offset:0 sc1 lds
  buffer_load_dwordx4 v2, s[8:11], s24 offen offset:1024 sc1 lds
  buffer_load_dwordx4 v2, s[8:11], s24 offen offset:2048 sc1 lds
  buffer_load_dwordx4 v2, s[8:11], s24 offen offset:3072 sc1 lds
  s_add_u32 m0, m0, 4096
  s_add_u32 s24, s24, 4096
  buffer_load_dwordx4 v2, s[8:11], s24 offen offset:0 sc1 lds
  buffer_load_dwordx4 v2, s[8:11], s24 offen offset:1024 sc1 lds
  buffer_load_dwordx4 v2, s[8:11], s24 offen offset:2048 sc1 lds
  s_add_u32 s30, s34, 1
  s_mov_b32 s31, 28672
  s_lshl_b32 s24, s30, 1
  s_mul_i32 s24, s24, 14336
  s_add_u32 s24, s24, s23
  s_cmp_lt_u32 s30, s35
  s_cselect_b32 s24, s24, 0x10000000
  s_add_u32 m0, s31, s27
  s_nop 0
  buffer_load_dwordx4 v2, s[8:11], s24 offen offset:0 sc1 lds
  buffer_load_dwordx4 v2, s[8:11], s24 offen offset:1024 sc1 lds
  buffer_load_dwordx4 v2, s[8:11], s24 offen offset:2048 sc1 lds
  buffer_load_dwordx4 v2, s[8:11], s24 offen offset:3072 sc1 lds
  s_add_u32 m0, m0, 4096
  s_add_u32 s24, s24, 4096
  buffer_load_dwordx4 v2, s[8:11], s24 offen offset:0 sc1 lds
  buffer_load_dwordx4 v2, s[8:11], s24 offen offset:1024 sc1 lds
  buffer_load_dwordx4 v2, s[8:11], s24 offen offset:2048 sc1 lds
  s_mov_b32 s19, s34
  s_mov_b32 s32, 0
  s_mov_b32 s33, 57344
  s_waitcnt vmcnt(7)
  s_branch wg_vo_in
wg_vo_loop:
  s_waitcnt vmcnt(11)
wg_vo_in:
  s_barrier
  s_add_u32 s30, s19, 2
  s_lshl_b32 s24, s30, 1
  s_mul_i32 s24, s24, 14336
  s_add_u32 s24, s24, s23
  s_cmp_lt_u32 s30, s35
  s_cselect_b32 s24, s24, 0x10000000
  s_add_u32 m0, s33, s27
  s_nop 0
  buffer_load_dwordx4 v2, s[8:11], s24 offen offset:0 sc1 lds
  buffer_load_dwordx4 v2, s[8:11], s24 offen offset:1024 sc1 lds
  buffer_load_dwordx4 v2, s[8:11], s24 offen offset:2048 sc1 lds
  buffer_load_dwordx4 v2, s[8:11], s24 offen offset:3072 sc1 lds
  s_add_u32 m0, m0, 4096
  s_add_u32 s24, s24, 4096
  buffer_load_dwordx4 v2, s[8:11], s24 offen offset:0 sc1 lds
  buffer_load_dwordx4 v2, s[8:11], s24 offen offset:1024 sc1 lds
  buffer_load_dwordx4 v2, s[8:11], s24 offen offset:2048 sc1 lds
  v_add_u32 v5, s32, v2
  ds_read_b128 v[8:11], v5 offset:0
  ds_read_b128 v[12:15], v5 offset:14336
  ds_read_b128 v[16:19], v5 offset:1024
  ds_read_b128 v[20:23], v5 offset:15360
  ds_read_b128 v[24:27], v5 offset:2048
  ds_read_b128 v[28:31], v5 offset:16384
  ds_read_b128 v[32:35], v5 offset:3072
  s_waitcnt lgkmcnt(6)
  v_mfma_f32_16x16x32_bf16 v[40:43], a[0:3], v[8:11], 0
  v_mfma_f32_16x16x32_bf16 v[44:47], a[56:59], v[8:11], 0
  v_mfma_f32_16x16x32_bf16 v[48:51], a[112:115], v[8:11], 0
  v_mfma_f32_16x16x32_bf16 v[52:55], a[168:171], v[8:11], 0
  ds_read_b128 v[36:39], v5 offset:17408
  s_waitcnt lgkmcnt(6)
  v_mfma_f32_16x16x32_bf16 v[56:59], a[0:3], v[12:15], 0
  v_mfma_f32_16x16x32_bf16 v[60:63], a[56:59], v[12:15], 0
  v_mfma_f32_16x16x32_bf16 v[64:67], a[112:115], v[12:15], 0
  v_mfma_f32_16x16x32_bf16 v[68:71], a[168:171], v[12:15], 0
  ds_read_b128 v[8:11], v5 offset:4096
  s_waitcnt lgkmcnt(6)
  v_mfma_f32_16x16x32_bf16 v[40:43], a[4:7], v[16:19], v[40:43]
  v_mfma_f32_16x16x32_bf16 v[44:47], a[60:63], v[16:19], v[44:47]
  v_mfma_f32_16x16x32_bf16 v[48:51], a[116:119], v[16:19], v[48:51]
  v_mfma_f32_16x16x32_bf16 v[52:55], a[172:175], v[16:19], v[52:55]
  ds_read_b128 v[12:15], v5 offset:18432
  s_waitcnt lgkmcnt(6)
  v_mfma_f32_16x16x32_bf16 v[56:59], a[4:7], v[20:23], v[56:59]
  v_mfma_f32_16x16x32_bf16 v[60:63], a[60:63], v[20:23], v[60:63]
  v_mfma_f32_16x16x32_bf16 v[64:67], a[116:119], v[20:23], v[64:67]
  v_mfma_f32_16x16x32_bf16 v[68:71], a[172:175], v[20:23], v[68:71]
  ds_read_b128 v[16:19], v5 offset:5120
  s_waitcnt lgkmcnt(6)
  v_mfma_f32_16x16x32_bf16 v[40:43], a[8:11], v[24:27], v[40:43]
  v_mfma_f32_16x16x32_bf16 v[44:47], a[64:67], v[24:27], v[44:47]
  v_mfma_f32_16x16x32_bf16 v[48:51], a[120:123], v[24:27], v[48:51]
  v_mfma_f32_16x16x32_bf16 v[52:55], a[176:179], v[24:27], v[52:55]
  ds_read_b128 v[20:23], v5 offset:19456
  s_waitcnt lgkmcnt(6)
  v_mfma_f32_16x16x32_bf16 v[56:59], a[8:11], v[28:31], v[56:59]
  v_mfma_f32_16x16x32_bf16 v[60:63], a[64:67], v[28:31], v[60:63]
  v_mfma_f32_16x16x32_bf16 v[64:67], a[120:123], v[28:31], v[64:67]
  v_mfma_f32_16x16x32_bf16 v[68:71], a[176:179], v[28:31], v[68:71]
  ds_read_b128 v[24:27], v5 offset:6144
  s_waitcnt lgkmcnt(6)
  v_mfma_f32_16x16x32_bf16 v[40:43], a[12:15], v[32:35], v[40:43]
  v_mfma_f32_16x16x32_bf16 v[44:47], a[68:71], v[32:35], v[44:47]
  v_mfma_f32_16x16x32_bf16 v[48:51], a[124:127], v[32:35], v[48:51]
  v_mfma_f32_16x16x32_bf16 v[52:55], a[180:183], v[32:35], v[52:55]
  ds_read_b128 v[28:31], v5 offset:20480
  s_waitcnt lgkmcnt(6)
  v_mfma_f32_16x16x32_bf16 v[56:59], a[12:15], v[36:39], v[56:59]
  v_mfma_f32_16x16x32_bf16 v[60:63], a[68:71], v[36:39], v[60:63]
  v_mfma_f32_16x16x32_bf16 v[64:67], a[124:127], v[36:39], v[64:67]
  v_mfma_f32_16x16x32_bf16 v[68:71], a[180:183], v[36:39], v[68:71]
  ds_read_b128 v[32:35], v5 offset:7168
  s_waitcnt lgkmcnt(6)
  v_mfma_f32_16x16x32_bf16 v[40:43], a[16:19], v[8:11], v[40:43]
  v_mfma_f32_16x16x32_bf16 v[44:47], a[72:75], v[8:11], v[44:47]
  v_mfma_f32_16x16x32_bf16 v[48:51], a[128:131], v[8:11], v[48:51]
  v_mfma_f32_16x16x32_bf16 v[52:55], a[184:187], v[8:11], v[52:55]
  ds_read_b128 v[36:39], v5 offset:21504
  s_waitcnt lgkmcnt(6)
  v_mfma_f32_16x16x32_bf16 v[56:59], a[16:19], v[12:15], v[56:59]
  v_mfma_f32_16x16x32_bf16 v[60:63], a[72:75], v[12:15], v[60:63]
  v_mfma_f32_16x16x32_bf16 v[64:67], a[128:131], v[12:15], v[64:67]
  v_mfma_f32_16x16x32_bf16 v[68:71], a[184:187], v[12:15], v[68:71]
  ds_read_b128 v[8:11], v5 offset:8192
  s_waitcnt lgkmcnt(6)
  v_mfma_f32_16x16x32_bf16 v[40:43], a[20:23], v[16:19], v[40:43]
  v_mfma_f32_16x16x32_bf16 v[44:47], a[76:79], v[16:19], v[44:47]
  v_mfma_f32_16x16x32_bf16 v[48:51], a[132:135], v[16:19], v[48:51]
  v_mfma_f32_16x16x32_bf16 v[52:55], a[188:191], v[16:19], v[52:55]
  ds_read_b128 v[12:15], v5 offset:22528
  s_waitcnt lgkmcnt(6)
  v_mfma_f32_16x16x32_bf16 v[56:59], a[20:23], v[20:23], v[56:59]
  v_mfma_f32_16x16x32_bf16 v[60:63], a[76:79], v[20:23], v[60:63]
  v_mfma_f32_16x16x32_bf16 v[64:67], a[132:135], v[20:23], v[64:67]
  v_mfma_f32_16x16x32_bf16 v[68:71], a[188:191], v[20:23], v[68:71]
  ds_read_b128 v[16:19], v5 offset:9216
  s_waitcnt lgkmcnt(6)
  v_mfma_f32_16x16x32_bf16 v[40:43], a[24:27], v[24:27], v[40:43]
  v_mfma_f32_16x16x32_bf16 v[44:47], a[80:83], v[24:27], v[44:47]
  v_mfma_f32_16x16x32_bf16 v[48:51], a[136:139], v[24:27], v[48:51]
  v_mfma_f32_16x16x32_bf16 v[52:55], a[192:195], v[24:27], v[52:55]
  ds_read_b128 v[20:23], v5 offset:23552
  s_waitcnt lgkmcnt(6)
  v_mfma_f32_16x16x32_bf16 v[56:59], a[24:27], v[28:31], v[56:59]
  v_mfma_f32_16x16x32_bf16 v[60:63], a[80:83], v[28:31], v[60:63]
  v_mfma_f32_16x16x32_bf16 v[64:67], a[136:139], v[28:31], v[64:67]
  v_mfma_f32_16x16x32_bf16 v[68:71], a[192:195], v[28:31], v[68:71]
  ds_read_b128 v[24:27], v5 offset:10240
  s_waitcnt lgkmcnt(6)
  v_mfma_f32_16x16x32_bf16 v[40:43], a[28:31], v[32:35], v[40:43]
  v_mfma_f32_16x16x32_bf16 v[44:47], a[84:87], v[32:35], v[44:47]
  v_mfma_f32_16x16x32_bf16 v[48:51], a[140:143], v[32:35], v[48:51]
  v_mfma_f32_16x16x32_bf16 v[52:55], a[196:199], v[32:35], v[52:55]
  ds_read_b128 v[28:31], v5 offset:24576
  s_waitcnt lgkmcnt(6)
  v_mfma_f32_16x16x32_bf16 v[56:59], a[28:31], v[36:39], v[56:59]
  v_mfma_f32_16x16x32_bf16 v[60:63], a[84:87], v[36:39], v[60:63]
  v_mfma_f32_16x16x32_bf16 v[64:67], a[140:143], v[36:39], v[64:67]
  v_mfma_f32_16x16x32_bf16 v[68:71], a[196:199], v[36:39], v[68:71]
  ds_read_b128 v[32:35], v5 offset:11264
  s_waitcnt lgkmcnt(6)
  v_mfma_f32_16x16x32_bf16 v[40:43], a[32:35], v[8:11], v[40:43]
  v_mfma_f32_16x16x32_bf16 v[44:47], a[88:91], v[8:11], v[44:47]
  v_mfma_f32_16x16x32_bf16 v[48:51], a[144:147], v[8:11], v[48:51]
  v_mfma_f32_16x16x32_bf16 v[52:55], a[200:203], v[8:11], v[52:55]
  ds_read_b128 v[36:39], v5 offset:25600
  s_waitcnt lgkmcnt(6)
  v_mfma_f32_16x16x32_bf16 v[56:59], a[32:35], v[12:15], v[56:59]
  v_mfma_f32_16x16x32_bf16 v[60:63], a[88:91], v[12:15], v[60:63]
  v_mfma_f32_16x16x32_bf16 v[64:67], a[144:147], v[12:15], v[64:67]
  v_mfma_f32_16x16x32_bf16 v[68:71], a[200:203], v[12:15], v[68:71]
  ds_read_b128 v[8:11], v5 offset:12288
  s_waitcnt lgkmcnt(6)
  v_mfma_f32_16x16x32_bf16 v[40:43], a[36:39], v[16:19], v[40:43]
  v_mfma_f32_16x16x32_bf16 v[44:47], a[92:95], v[16:19], v[44:47]
  v_mfma_f32_16x16x32_bf16 v[48:51], a[148:151], v[16:19], v[48:51]
  v_mfma_f32_16x16x32_bf16 v[52:55], a[204:207], v[16:19], v[52:55]
  ds_read_b128 v[12:15], v5 offset:26624
  s_waitcnt lgkmcnt(6)
  v_mfma_f32_16x16x32_bf16 v[56:59], a[36:39], v[20:23], v[56:59]
  v_mfma_f32_16x16x32_bf16 v[60:63], a[92:95], v[20:23], v[60:63]
  v_mfma_f32_16x16x32_bf16 v[64:67], a[148:151], v[20:23], v[64:67]
  v_mfma_f32_16x16x32_bf16 v[68:71], a[204:207], v[20:23], v[68:71]
  ds_read_b128 v[16:19], v5 offset:13312
  s_waitcnt lgkmcnt(6)
  v_mfma_f32_16x16x32_bf16 v[40:43], a[40:43], v[24:27], v[40:43]
  v_mfma_f32_16x16x32_bf16 v[44:47], a[96:99], v[24:27], v[44:47]
  v_mfma_f32_16x16x32_bf16 v[48:51], a[152:155], v[24:27], v[48:51]
  v_mfma_f32_16x16x32_bf16 v[52:55], a[208:211], v[24:27], v[52:55]
  ds_read_b128 v[20:23], v5 offset:27648
  s_waitcnt lgkmcnt(6)
  v_mfma_f32_16x16x32_bf16 v[56:59], a[40:43], v[28:31], v[56:59]
  v_mfma_f32_16x16x32_bf16 v[60:63], a[96:99], v[28:31], v[60:63]
  v_mfma_f32_16x16x32_bf16 v[64:67], a[152:155], v[28:31], v[64:67]
  v_mfma_f32_16x16x32_bf16 v[68:71], a[208:211], v[28:31], v[68:71]
  s_waitcnt lgkmcnt(5)
  v_mfma_f32_16x16x32_bf16 v[40:43], a[44:47], v[32:35], v[40:43]
  v_mfma_f32_16x16x32_bf16 v[44:47], a[100:103], v[32:35], v[44:47]
  v_mfma_f32_16x16x32_bf16 v[48:51], a[156:159], v[32:35], v[48:51]
  v_mfma_f32_16x16x32_bf16 v[52:55], a[212:215], v[32:35], v[52:55]
  s_waitcnt lgkmcnt(4)
  v_mfma_f32_16x16x32_bf16 v[56:59], a[44:47], v[36:39], v[56:59]
  v_mfma_f32_16x16x32_bf16 v[60:63], a[100:103], v[36:39], v[60:63]
  v_mfma_f32_16x16x32_bf16 v[64:67], a[156:159], v[36:39], v[64:67]
  v_mfma_f32_16x16x32_bf16 v[68:71], a[212:215], v[36:39], v[68:71]
  s_waitcnt lgkmcnt(3)
  v_mfma_f32_16x16x32_bf16 v[40:43], a[48:51], v[8:11], v[40:43]
  v_mfma_f32_16x16x32_bf16 v[44:47], a[104:107], v[8:11], v[44:47]
  v_mfma_f32_16x16x32_bf16 v[48:51], a[160:163], v[8:11], v[48:51]
  v_mfma_f32_16x16x32_bf16 v[52:55], a[216:219], v[8:11], v[52:55]
  s_waitcnt lgkmcnt(2)
  v_mfma_f32_16x16x32_bf16 v[56:59], a[48:51], v[12:15], v[56:59]
  v_mfma_f32_16x16x32_bf16 v[60:63], a[104:107], v[12:15], v[60:63]
  v_mfma_f32_16x16x32_bf16 v[64:67], a[160:163], v[12:15], v[64:67]
  v_mfma_f32_16x16x32_bf16 v[68:71], a[216:219], v[12:15], v[68:71]
  s_waitcnt lgkmcnt(1)
  v_mfma_f32_16x16x32_bf16 v[40:43], a[52:55], v[16:19], v[40:43]
  v_mfma_f32_16x16x32_bf16 v[44:47], a[108:111], v[16:19], v[44:47]
  v_mfma_f32_16x16x32_bf16 v[48:51], a[164:167], v[16:19], v[48:51]
  v_mfma_f32_16x16x32_bf16 v[52:55], a[220:223], v[16:19], v[52:55]
  s_waitcnt lgkmcnt(0)
  v_mfma_f32_16x16x32_bf16 v[56:59], a[52:55], v[20:23], v[56:59]
  v_mfma_f32_16x16x32_bf16 v[60:63], a[108:111], v[20:23], v[60:63]
  v_mfma_f32_16x16x32_bf16 v[64:67], a[164:167], v[20:23], v[64:67]
  v_mfma_f32_16x16x32_bf16 v[68:71], a[220:223], v[20:23], v[68:71]
  s_add_u32 s25, s29, 28672
  s_lshl_b32 s24, s19, 5
  s_add_u32 s24, s24, 0
  v_add_u32 v88, s24, v4
  v_mul_u32_u24 v89, 2341, v88
  v_lshrrev_b32 v89, 16, v89
  v_mul_u32_u24 v89, 84, v89
  v_add3_u32 v88, v88, v89, v6
  v_lshlrev_b32 v90, 4, v88
  v_cvt_pk_bf16_f32 v72, v40, v41
  v_cvt_pk_bf16_f32 v73, v42, v43
  v_cvt_pk_bf16_f32 v74, v44, v45
  v_cvt_pk_bf16_f32 v75, v46, v47
  buffer_store_dwordx4 v[72:75], v90, s[8:11], s29 offen sc1
  v_cvt_pk_bf16_f32 v76, v48, v49
  v_cvt_pk_bf16_f32 v77, v50, v51
  v_cvt_pk_bf16_f32 v78, v52, v53
  v_cvt_pk_bf16_f32 v79, v54, v55
  buffer_store_dwordx4 v[76:79], v90, s[8:11], s25 offen sc1
  s_lshl_b32 s24, s19, 5
  s_add_u32 s24, s24, 16
  v_add_u32 v88, s24, v4
  v_mul_u32_u24 v89, 2341, v88
  v_lshrrev_b32 v89, 16, v89
  v_mul_u32_u24 v89, 84, v89
  v_add3_u32 v88, v88, v89, v6
  v_lshlrev_b32 v91, 4, v88
  v_cvt_pk_bf16_f32 v80, v56, v57
  v_cvt_pk_bf16_f32 v81, v58, v59
  v_cvt_pk_bf16_f32 v82, v60, v61
  v_cvt_pk_bf16_f32 v83, v62, v63
  buffer_store_dwordx4 v[80:83], v91, s[8:11], s29 offen sc1
  v_cvt_pk_bf16_f32 v84, v64, v65
  v_cvt_pk_bf16_f32 v85, v66, v67
  v_cvt_pk_bf16_f32 v86, v68, v69
  v_cvt_pk_bf16_f32 v87, v70, v71
  buffer_store_dwordx4 v[84:87], v91, s[8:11], s25 offen sc1
  s_mov_b32 s33, s32
  s_add_u32 s32, s32, 28672
  s_cmp_eq_u32 s32, 86016
  s_cselect_b32 s32, 0, s32
  s_add_u32 s19, s19, 1
  s_cmp_lt_u32 s19, s35
  s_cbranch_scc1 wg_vo_loop
  s_branch wg_done
wg_done:
  s_lshl_b32 s20, s18, 4
  s_and_b32 s21, s17, 15
  s_add_u32 s20, s20, s21
  s_lshl_b32 s20, s20, 7
  s_cmp_lt_u32 s17, 16
  s_cselect_b32 s21, 16384, 0
  s_add_u32 s20, s20, s21
  s_add_u32 s20, s20, 88541184
  s_sub_u32 s21, s35, s34
  v_mov_b32 v5, s21
  v_mov_b32 v6, 0
  s_waitcnt vmcnt(0)
  s_mov_b64 exec, 1
  buffer_atomic_add v5, v6, s[8:11], s20 offen
  s_mov_b64 exec, -1
  s_branch wk_loop
wk_a:
  s_load_dwordx8 s[36:43], s[0:1], 56
  s_load_dwordx4 s[44:47], s[0:1], 88
  s_sub_u32 s3, s3, 432
  s_and_b32 s17, s3, 15
  s_lshr_b32 s19, s3, 5
  s_bitcmp1_b32 s3, 4
  s_cselect_b32 s31, 7, 0
  s_waitcnt lgkmcnt(0)
  s_mov_b32 s60, s40
  s_and_b32 s61, s41, 0xffff
  s_mov_b32 s62, 3670016
  s_mov_b32 s63, 0x20000
  s_mov_b32 s56, s42
  s_and_b32 s57, s43, 0xffff
  s_mov_b32 s58, 3670016
  s_mov_b32 s59, 0x20000
  s_lshl_b32 s30, s16, 13
  s_lshl_b32 s27, s19, 19
  s_lshl_b32 s29, s16, 17
  s_add_u32 s27, s27, s29
  s_lshl_b32 s29, s17, 9
  s_add_u32 s27, s27, s29
  v_lshrrev_b32 v5, 5, v1
  v_and_b32 v6, 31, v1
  v_xor_b32 v6, v6, v5
  v_lshlrev_b32 v6, 4, v6
  v_lshl_add_u32 v6, v5, 13, v6
  s_add_u32 m0, s30, 0
  s_add_u32 s22, s27, 0
  v_xor_b32 v7, 0, v6
  buffer_load_dwordx4 v7, s[56:59], s22 offen offset:0 lds
  s_add_u32 s22, s27, 15360
  v_xor_b32 v7, 32, v6
  buffer_load_dwordx4 v7, s[56:59], s22 offen offset:1024 lds
  s_add_u32 s22, s27, 30720
  v_xor_b32 v7, 64, v6
  buffer_load_dwordx4 v7, s[56:59], s22 offen offset:2048 lds
  s_add_u32 s22, s27, 46080
  v_xor_b32 v7, 96, v6
  buffer_load_dwordx4 v7, s[56:59], s22 offen offset:3072 lds
  s_add_u32 m0, s30, 4096
  s_add_u32 s22, s27, 65536
  v_xor_b32 v7, 128, v6
  buffer_load_dwordx4 v7, s[56:59], s22 offen offset:0 lds
  s_add_u32 s22, s27, 80896
  v_xor_b32 v7, 160, v6
  buffer_load_dwordx4 v7, s[56:59], s22 offen offset:1024 lds
  s_add_u32 s22, s27, 96256
  v_xor_b32 v7, 192, v6
  buffer_load_dwordx4 v7, s[56:59], s22 offen offset:2048 lds
  s_add_u32 s22, s27, 111616
  v_xor_b32 v7, 224, v6
  buffer_load_dwordx4 v7, s[56:59], s22 offen offset:3072 lds
  v_lshrrev_b32 v5, 5, v1
  v_and_b32 v6, 31, v1
  s_lshl_b32 s25, s16, 15
  s_add_u32 s25, s25, 32768
  s_lshl_b32 s26, s17, 9
  s_add_u32 s28, s19, s16
  s_cmp_ge_u32 s28, 7
  s_cselect_b32 s20, 7, 0
  s_sub_u32 s28, s28, s20
  s_add_u32 s28, s28, s31
  s_add_u32 s29, s19, s16
  s_add_u32 s29, s29, 4
  s_cmp_ge_u32 s29, 7
  s_cselect_b32 s20, 7, 0
  s_sub_u32 s29, s29, s20
  s_add_u32 s29, s29, s31
  s_lshl_b32 s32, s28, 18
  s_add_u32 s32, s32, s26
  s_lshl_b32 s33, s29, 18
  s_add_u32 s33, s33, s26
  v_xor_b32 v8, v6, v5
  v_lshlrev_b32 v8, 4, v8
  v_lshl_add_u32 v8, v5, 13, v8
  v_xor_b32 v12, 0, v8
  v_xor_b32 v13, 32, v8
  v_add_u32 v13, 15360, v13
  v_xor_b32 v14, 0, v8
  v_add_u32 v14, 30720, v14
  v_xor_b32 v15, 32, v8
  v_add_u32 v15, 46080, v15
  s_add_u32 s20, s16, 0
  s_and_b32 s20, s20, 3
  s_mul_i32 s21, s20, 65600
  s_lshl_b32 s20, s20, 12
  s_add_u32 s48, s20, s25
  s_mov_b32 m0, s48
  v_xor_b32 v16, s21, v12
  buffer_load_dwordx4 v16, s[60:63], s32 offen offset:0 lds
  v_xor_b32 v17, s21, v13
  buffer_load_dwordx4 v17, s[60:63], s32 offen offset:1024 lds
  v_xor_b32 v18, s21, v14
  buffer_load_dwordx4 v18, s[60:63], s32 offen offset:2048 lds
  v_xor_b32 v19, s21, v15
  buffer_load_dwordx4 v19, s[60:63], s32 offen offset:3072 lds
  s_add_u32 s20, s16, 1
  s_and_b32 s20, s20, 3
  s_mul_i32 s21, s20, 65600
  s_lshl_b32 s20, s20, 12
  s_add_u32 s49, s20, s25
  s_mov_b32 m0, s49
  v_xor_b32 v20, s21, v12
  buffer_load_dwordx4 v20, s[60:63], s32 offen offset:0 lds
  v_xor_b32 v21, s21, v13
  buffer_load_dwordx4 v21, s[60:63], s32 offen offset:1024 lds
  v_xor_b32 v22, s21, v14
  buffer_load_dwordx4 v22, s[60:63], s32 offen offset:2048 lds
  v_xor_b32 v23, s21, v15
  buffer_load_dwordx4 v23, s[60:63], s32 offen offset:3072 lds
  s_add_u32 s20, s16, 2
  s_and_b32 s20, s20, 3
  s_mul_i32 s21, s20, 65600
  s_lshl_b32 s20, s20, 12
  s_add_u32 s50, s20, s25
  s_mov_b32 m0, s50
  v_xor_b32 v24, s21, v12
  buffer_load_dwordx4 v24, s[60:63], s32 offen offset:0 lds
  v_xor_b32 v25, s21, v13
  buffer_load_dwordx4 v25, s[60:63], s32 offen offset:1024 lds
  v_xor_b32 v26, s21, v14
  buffer_load_dwordx4 v26, s[60:63], s32 offen offset:2048 lds
  v_xor_b32 v27, s21, v15
  buffer_load_dwordx4 v27, s[60:63], s32 offen offset:3072 lds
  s_add_u32 s20, s16, 3
  s_and_b32 s20, s20, 3
  s_mul_i32 s21, s20, 65600
  s_lshl_b32 s20, s20, 12
  s_add_u32 s51, s20, s25
  s_mov_b32 m0, s51
  v_xor_b32 v28, s21, v12
  buffer_load_dwordx4 v28, s[60:63], s32 offen offset:0 lds
  v_xor_b32 v29, s21, v13
  buffer_load_dwordx4 v29, s[60:63], s32 offen offset:1024 lds
  v_xor_b32 v30, s21, v14
  buffer_load_dwordx4 v30, s[60:63], s32 offen offset:2048 lds
  v_xor_b32 v31, s21, v15
  buffer_load_dwordx4 v31, s[60:63], s32 offen offset:3072 lds
  s_mul_i32 s30, s17, 401408
  s_mul_i32 s20, s19, 57344
  s_add_u32 s30, s30, s20
  v_add_u32 v12, s30, v2
  v_add_u32 v13, 14336, v12
  v_add_u32 v14, 28672, v12
  v_add_u32 v15, 43008, v12
  v_lshrrev_b32 v7, 2, v4
  v_lshlrev_b32 v7, 3, v7
  v_and_b32 v8, 3, v4
  v_add_u32 v7, v7, v8
  v_xor_b32 v10, v3, v4
  v_lshlrev_b32 v10, 4, v10
  v_lshl_add_u32 v10, v7, 9, v10
  v_add_u32 v10, s25, v10
  v_xor_b32 v32, 0, v10
  v_xor_b32 v33, 64, v10
  v_xor_b32 v34, 128, v10
  v_xor_b32 v35, 192, v10
  v_and_b32 v8, 2, v4
  v_lshlrev_b32 v8, 1, v8
  v_and_b32 v9, 1, v4
  v_add_u32 v8, v8, v9
  v_lshrrev_b32 v7, 2, v4
  v_lshl_add_u32 v7, v7, 4, v8
  v_xor_b32 v8, v8, v3
  v_lshlrev_b32 v8, 4, v8
  v_lshl_add_u32 v7, v7, 9, v8
  s_mov_b32 s24, 1035512379
  s_waitcnt vmcnt(16)
  s_barrier
  s_cmp_eq_u32 s16, 3
  s_cbranch_scc1 aj_np0
  s_add_u32 m0, s48, 16384
  s_nop 0
  buffer_load_dwordx4 v16, s[60:63], s33 offen offset:0 lds
  buffer_load_dwordx4 v17, s[60:63], s33 offen offset:1024 lds
  buffer_load_dwordx4 v18, s[60:63], s33 offen offset:2048 lds
  buffer_load_dwordx4 v19, s[60:63], s33 offen offset:3072 lds
aj_np0:
  v_xor_b32 v8, 0, v7
  ds_read_b128 v[128:131], v8 offset:0
  v_xor_b32 v9, 64, v7
  ds_read_b128 v[132:135], v9 offset:0
  v_xor_b32 v10, 128, v7
  ds_read_b128 v[136:139], v10 offset:0
  v_xor_b32 v11, 192, v7
  ds_read_b128 v[140:143], v11 offset:0
  ds_read_b128 v[144:147], v8 offset:256
  ds_read_b128 v[148:151], v9 offset:256
  ds_read_b128 v[152:155], v10 offset:256
  ds_read_b128 v[156:159], v11 offset:256
  s_waitcnt lgkmcnt(4)
  s_cmp_eq_u32 s16, 3
  s_cbranch_scc1 aj_np1
  s_add_u32 m0, s49, 16384
  s_nop 0
  buffer_load_dwordx4 v20, s[60:63], s33 offen offset:0 lds
  buffer_load_dwordx4 v21, s[60:63], s33 offen offset:1024 lds
  buffer_load_dwordx4 v22, s[60:63], s33 offen offset:2048 lds
  buffer_load_dwordx4 v23, s[60:63], s33 offen offset:3072 lds
aj_np1:
  v_xor_b32 v8, 32, v7
  ds_read_b128 v[160:163], v8 offset:1024
  v_xor_b32 v9, 96, v7
  ds_read_b128 v[164:167], v9 offset:1024
  v_xor_b32 v10, 160, v7
  ds_read_b128 v[168:171], v10 offset:1024
  v_xor_b32 v11, 224, v7
  ds_read_b128 v[172:175], v11 offset:1024
  ds_read_b128 v[176:179], v8 offset:1280
  ds_read_b128 v[180:183], v9 offset:1280
  ds_read_b128 v[184:187], v10 offset:1280
  ds_read_b128 v[188:191], v11 offset:1280
  s_waitcnt lgkmcnt(4)
  s_cmp_eq_u32 s16, 3
  s_cbranch_scc1 aj_np2
  s_add_u32 m0, s50, 16384
  s_nop 0
  buffer_load_dwordx4 v24, s[60:63], s33 offen offset:0 lds
  buffer_load_dwordx4 v25, s[60:63], s33 offen offset:1024 lds
  buffer_load_dwordx4 v26, s[60:63], s33 offen offset:2048 lds
  buffer_load_dwordx4 v27, s[60:63], s33 offen offset:3072 lds
aj_np2:
  v_xor_b32 v8, 128, v7
  ds_read_b128 v[192:195], v8 offset:4096
  v_xor_b32 v9, 192, v7
  ds_read_b128 v[196:199], v9 offset:4096
  v_xor_b32 v10, 0, v7
  ds_read_b128 v[200:203], v10 offset:4096
  v_xor_b32 v11, 64, v7
  ds_read_b128 v[204:207], v11 offset:4096
  ds_read_b128 v[208:211], v8 offset:4352
  ds_read_b128 v[212:215], v9 offset:4352
  ds_read_b128 v[216:219], v10 offset:4352
  ds_read_b128 v[220:223], v11 offset:4352
  s_waitcnt lgkmcnt(4)
  s_cmp_eq_u32 s16, 3
  s_cbranch_scc1 aj_np3
  s_add_u32 m0, s51, 16384
  s_nop 0
  buffer_load_dwordx4 v28, s[60:63], s33 offen offset:0 lds
  buffer_load_dwordx4 v29, s[60:63], s33 offen offset:1024 lds
  buffer_load_dwordx4 v30, s[60:63], s33 offen offset:2048 lds
  buffer_load_dwordx4 v31, s[60:63], s33 offen offset:3072 lds
aj_np3:
  v_xor_b32 v8, 160, v7
  ds_read_b128 v[224:227], v8 offset:5120
  v_xor_b32 v9, 224, v7
  ds_read_b128 v[228:231], v9 offset:5120
  v_xor_b32 v10, 32, v7
  ds_read_b128 v[232:235], v10 offset:5120
  v_xor_b32 v11, 96, v7
  ds_read_b128 v[236:239], v11 offset:5120
  ds_read_b128 v[240:243], v8 offset:5376
  ds_read_b128 v[244:247], v9 offset:5376
  ds_read_b128 v[248:251], v10 offset:5376
  ds_read_b128 v[252:255], v11 offset:5376
  s_waitcnt lgkmcnt(4)
  s_waitcnt vmcnt(16) lgkmcnt(0)
  s_cmp_lg_u32 s16, 3
  s_cbranch_scc1 w3_39
  s_waitcnt vmcnt(0)
w3_39:
  ds_read_b128 v[52:55], v32 offset:0
  ds_read_b128 v[56:59], v33 offset:0
  ds_read_b128 v[60:63], v34 offset:0
  ds_read_b128 v[64:67], v35 offset:0
  s_waitcnt lgkmcnt(3)
  v_mfma_f32_16x16x32_bf16 v[96:99], v[52:55], v[128:131], 0
  v_mfma_f32_16x16x32_bf16 v[100:103], v[52:55], v[160:163], 0
  v_mfma_f32_16x16x32_bf16 v[104:107], v[52:55], v[192:195], 0
  v_mfma_f32_16x16x32_bf16 v[108:111], v[52:55], v[224:227], 0
  ds_read_b128 v[52:55], v32 offset:256
  s_waitcnt lgkmcnt(3)
  v_mfma_f32_16x16x32_bf16 v[96:99], v[56:59], v[132:135], v[96:99]
  v_mfma_f32_16x16x32_bf16 v[100:103], v[56:59], v[164:167], v[100:103]
  v_mfma_f32_16x16x32_bf16 v[104:107], v[56:59], v[196:199], v[104:107]
  v_mfma_f32_16x16x32_bf16 v[108:111], v[56:59], v[228:231], v[108:111]
  ds_read_b128 v[56:59], v33 offset:256
  s_waitcnt lgkmcnt(3)
  v_mfma_f32_16x16x32_bf16 v[96:99], v[60:63], v[136:139], v[96:99]
  v_mfma_f32_16x16x32_bf16 v[100:103], v[60:63], v[168:171], v[100:103]
  v_mfma_f32_16x16x32_bf16 v[104:107], v[60:63], v[200:203], v[104:107]
  v_mfma_f32_16x16x32_bf16 v[108:111], v[60:63], v[232:235], v[108:111]
  ds_read_b128 v[60:63], v34 offset:256
  s_waitcnt lgkmcnt(3)
  v_mfma_f32_16x16x32_bf16 v[96:99], v[64:67], v[140:143], v[96:99]
  v_mfma_f32_16x16x32_bf16 v[100:103], v[64:67], v[172:175], v[100:103]
  v_mfma_f32_16x16x32_bf16 v[104:107], v[64:67], v[204:207], v[104:107]
  v_mfma_f32_16x16x32_bf16 v[108:111], v[64:67], v[236:239], v[108:111]
  ds_read_b128 v[64:67], v35 offset:256
  s_waitcnt lgkmcnt(3)
  v_mfma_f32_16x16x32_bf16 v[96:99], v[52:55], v[144:147], v[96:99]
  v_mfma_f32_16x16x32_bf16 v[100:103], v[52:55], v[176:179], v[100:103]
  v_mfma_f32_16x16x32_bf16 v[104:107], v[52:55], v[208:211], v[104:107]
  v_mfma_f32_16x16x32_bf16 v[108:111], v[52:55], v[240:243], v[108:111]
  ds_read_b128 v[52:55], v32 offset:2048
  s_waitcnt lgkmcnt(3)
  v_mfma_f32_16x16x32_bf16 v[96:99], v[56:59], v[148:151], v[96:99]
  v_mfma_f32_16x16x32_bf16 v[100:103], v[56:59], v[180:183], v[100:103]
  v_mfma_f32_16x16x32_bf16 v[104:107], v[56:59], v[212:215], v[104:107]
  v_mfma_f32_16x16x32_bf16 v[108:111], v[56:59], v[244:247], v[108:111]
  ds_read_b128 v[56:59], v33 offset:2048
  s_waitcnt lgkmcnt(3)
  v_mfma_f32_16x16x32_bf16 v[96:99], v[60:63], v[152:155], v[96:99]
  v_mfma_f32_16x16x32_bf16 v[100:103], v[60:63], v[184:187], v[100:103]
  v_mfma_f32_16x16x32_bf16 v[104:107], v[60:63], v[216:219], v[104:107]
  v_mfma_f32_16x16x32_bf16 v[108:111], v[60:63], v[248:251], v[108:111]
  ds_read_b128 v[60:63], v34 offset:2048
  s_waitcnt lgkmcnt(3)
  v_mfma_f32_16x16x32_bf16 v[96:99], v[64:67], v[156:159], v[96:99]
  v_mfma_f32_16x16x32_bf16 v[100:103], v[64:67], v[188:191], v[100:103]
  v_mfma_f32_16x16x32_bf16 v[104:107], v[64:67], v[220:223], v[104:107]
  v_mfma_f32_16x16x32_bf16 v[108:111], v[64:67], v[252:255], v[108:111]
  ds_read_b128 v[64:67], v35 offset:2048
  s_waitcnt lgkmcnt(3)
  v_mfma_f32_16x16x32_bf16 v[112:115], v[52:55], v[128:131], 0
  v_mfma_f32_16x16x32_bf16 v[116:119], v[52:55], v[160:163], 0
  v_mfma_f32_16x16x32_bf16 v[120:123], v[52:55], v[192:195], 0
  v_mfma_f32_16x16x32_bf16 v[124:127], v[52:55], v[224:227], 0
  ds_read_b128 v[52:55], v32 offset:2304
  s_waitcnt lgkmcnt(3)
  v_mfma_f32_16x16x32_bf16 v[112:115], v[56:59], v[132:135], v[112:115]
  v_mfma_f32_16x16x32_bf16 v[116:119], v[56:59], v[164:167], v[116:119]
  v_mfma_f32_16x16x32_bf16 v[120:123], v[56:59], v[196:199], v[120:123]
  v_mfma_f32_16x16x32_bf16 v[124:127], v[56:59], v[228:231], v[124:127]
  ds_read_b128 v[56:59], v33 offset:2304
  s_waitcnt lgkmcnt(3)
  v_mfma_f32_16x16x32_bf16 v[112:115], v[60:63], v[136:139], v[112:115]
  v_mfma_f32_16x16x32_bf16 v[116:119], v[60:63], v[168:171], v[116:119]
  v_mfma_f32_16x16x32_bf16 v[120:123], v[60:63], v[200:203], v[120:123]
  v_mfma_f32_16x16x32_bf16 v[124:127], v[60:63], v[232:235], v[124:127]
  ds_read_b128 v[60:63], v34 offset:2304
  s_waitcnt lgkmcnt(3)
  v_mfma_f32_16x16x32_bf16 v[112:115], v[64:67], v[140:143], v[112:115]
  v_mfma_f32_16x16x32_bf16 v[116:119], v[64:67], v[172:175], v[116:119]
  v_mfma_f32_16x16x32_bf16 v[120:123], v[64:67], v[204:207], v[120:123]
  v_mfma_f32_16x16x32_bf16 v[124:127], v[64:67], v[236:239], v[124:127]
  ds_read_b128 v[64:67], v35 offset:2304
  s_waitcnt lgkmcnt(3)
  v_mfma_f32_16x16x32_bf16 v[112:115], v[52:55], v[144:147], v[112:115]
  v_mfma_f32_16x16x32_bf16 v[116:119], v[52:55], v[176:179], v[116:119]
  v_mfma_f32_16x16x32_bf16 v[120:123], v[52:55], v[208:211], v[120:123]
  v_mfma_f32_16x16x32_bf16 v[124:127], v[52:55], v[240:243], v[124:127]
  s_waitcnt lgkmcnt(2)
  v_mfma_f32_16x16x32_bf16 v[112:115], v[56:59], v[148:151], v[112:115]
  v_mfma_f32_16x16x32_bf16 v[116:119], v[56:59], v[180:183], v[116:119]
  v_mfma_f32_16x16x32_bf16 v[120:123], v[56:59], v[212:215], v[120:123]
  v_mfma_f32_16x16x32_bf16 v[124:127], v[56:59], v[244:247], v[124:127]
  s_waitcnt lgkmcnt(1)
  v_mfma_f32_16x16x32_bf16 v[112:115], v[60:63], v[152:155], v[112:115]
  v_mfma_f32_16x16x32_bf16 v[116:119], v[60:63], v[184:187], v[116:119]
  v_mfma_f32_16x16x32_bf16 v[120:123], v[60:63], v[216:219], v[120:123]
  v_mfma_f32_16x16x32_bf16 v[124:127], v[60:63], v[248:251], v[124:127]
  s_waitcnt lgkmcnt(0)
  v_mfma_f32_16x16x32_bf16 v[112:115], v[64:67], v[156:159], v[112:115]
  v_mfma_f32_16x16x32_bf16 v[116:119], v[64:67], v[188:191], v[116:119]
  v_mfma_f32_16x16x32_bf16 v[120:123], v[64:67], v[220:223], v[120:123]
  v_mfma_f32_16x16x32_bf16 v[124:127], v[64:67], v[252:255], v[124:127]
  s_lshl_b32 s30, s28, 10
  v_mul_f32 v96, s24, v96
  v_mul_f32 v97, s24, v97
  v_mul_f32 v98, s24, v98
  v_mul_f32 v99, s24, v99
  v_cvt_pk_bf16_f32 v68, v96, v97
  v_cvt_pk_bf16_f32 v69, v98, v99
  v_mul_f32 v112, s24, v112
  v_mul_f32 v113, s24, v113
  v_mul_f32 v114, s24, v114
  v_mul_f32 v115, s24, v115
  v_cvt_pk_bf16_f32 v70, v112, v113
  v_cvt_pk_bf16_f32 v71, v114, v115
  buffer_store_dwordx4 v[68:71], v12, s[8:11], s30 offen sc1
  v_mul_f32 v100, s24, v100
  v_mul_f32 v101, s24, v101
  v_mul_f32 v102, s24, v102
  v_mul_f32 v103, s24, v103
  v_cvt_pk_bf16_f32 v72, v100, v101
  v_cvt_pk_bf16_f32 v73, v102, v103
  v_mul_f32 v116, s24, v116
  v_mul_f32 v117, s24, v117
  v_mul_f32 v118, s24, v118
  v_mul_f32 v119, s24, v119
  v_cvt_pk_bf16_f32 v74, v116, v117
  v_cvt_pk_bf16_f32 v75, v118, v119
  buffer_store_dwordx4 v[72:75], v13, s[8:11], s30 offen sc1
  v_mul_f32 v104, s24, v104
  v_mul_f32 v105, s24, v105
  v_mul_f32 v106, s24, v106
  v_mul_f32 v107, s24, v107
  v_cvt_pk_bf16_f32 v76, v104, v105
  v_cvt_pk_bf16_f32 v77, v106, v107
  v_mul_f32 v120, s24, v120
  v_mul_f32 v121, s24, v121
  v_mul_f32 v122, s24, v122
  v_mul_f32 v123, s24, v123
  v_cvt_pk_bf16_f32 v78, v120, v121
  v_cvt_pk_bf16_f32 v79, v122, v123
  buffer_store_dwordx4 v[76:79], v14, s[8:11], s30 offen sc1
  v_mul_f32 v108, s24, v108
  v_mul_f32 v109, s24, v109
  v_mul_f32 v110, s24, v110
  v_mul_f32 v111, s24, v111
  v_cvt_pk_bf16_f32 v80, v108, v109
  v_cvt_pk_bf16_f32 v81, v110, v111
  v_mul_f32 v124, s24, v124
  v_mul_f32 v125, s24, v125
  v_mul_f32 v126, s24, v126
  v_mul_f32 v127, s24, v127
  v_cvt_pk_bf16_f32 v82, v124, v125
  v_cvt_pk_bf16_f32 v83, v126, v127
  buffer_store_dwordx4 v[80:83], v15, s[8:11], s30 offen sc1
  s_cmp_eq_u32 s16, 3
  s_cbranch_scc1 aj_w3
  s_waitcnt vmcnt(4)
  ds_read_b128 v[52:55], v32 offset:16384
  ds_read_b128 v[56:59], v33 offset:16384
  ds_read_b128 v[60:63], v34 offset:16384
  ds_read_b128 v[64:67], v35 offset:16384
  s_waitcnt lgkmcnt(3)
  v_mfma_f32_16x16x32_bf16 v[96:99], v[52:55], v[128:131], 0
  v_mfma_f32_16x16x32_bf16 v[100:103], v[52:55], v[160:163], 0
  v_mfma_f32_16x16x32_bf16 v[104:107], v[52:55], v[192:195], 0
  v_mfma_f32_16x16x32_bf16 v[108:111], v[52:55], v[224:227], 0
  ds_read_b128 v[52:55], v32 offset:16640
  s_waitcnt lgkmcnt(3)
  v_mfma_f32_16x16x32_bf16 v[96:99], v[56:59], v[132:135], v[96:99]
  v_mfma_f32_16x16x32_bf16 v[100:103], v[56:59], v[164:167], v[100:103]
  v_mfma_f32_16x16x32_bf16 v[104:107], v[56:59], v[196:199], v[104:107]
  v_mfma_f32_16x16x32_bf16 v[108:111], v[56:59], v[228:231], v[108:111]
  ds_read_b128 v[56:59], v33 offset:16640
  s_waitcnt lgkmcnt(3)
  v_mfma_f32_16x16x32_bf16 v[96:99], v[60:63], v[136:139], v[96:99]
  v_mfma_f32_16x16x32_bf16 v[100:103], v[60:63], v[168:171], v[100:103]
  v_mfma_f32_16x16x32_bf16 v[104:107], v[60:63], v[200:203], v[104:107]
  v_mfma_f32_16x16x32_bf16 v[108:111], v[60:63], v[232:235], v[108:111]
  ds_read_b128 v[60:63], v34 offset:16640
  s_waitcnt lgkmcnt(3)
  v_mfma_f32_16x16x32_bf16 v[96:99], v[64:67], v[140:143], v[96:99]
  v_mfma_f32_16x16x32_bf16 v[100:103], v[64:67], v[172:175], v[100:103]
  v_mfma_f32_16x16x32_bf16 v[104:107], v[64:67], v[204:207], v[104:107]
  v_mfma_f32_16x16x32_bf16 v[108:111], v[64:67], v[236:239], v[108:111]
  ds_read_b128 v[64:67], v35 offset:16640
  s_waitcnt lgkmcnt(3)
  v_mfma_f32_16x16x32_bf16 v[96:99], v[52:55], v[144:147], v[96:99]
  v_mfma_f32_16x16x32_bf16 v[100:103], v[52:55], v[176:179], v[100:103]
  v_mfma_f32_16x16x32_bf16 v[104:107], v[52:55], v[208:211], v[104:107]
  v_mfma_f32_16x16x32_bf16 v[108:111], v[52:55], v[240:243], v[108:111]
  ds_read_b128 v[52:55], v32 offset:18432
  s_waitcnt lgkmcnt(3)
  v_mfma_f32_16x16x32_bf16 v[96:99], v[56:59], v[148:151], v[96:99]
  v_mfma_f32_16x16x32_bf16 v[100:103], v[56:59], v[180:183], v[100:103]
  v_mfma_f32_16x16x32_bf16 v[104:107], v[56:59], v[212:215], v[104:107]
  v_mfma_f32_16x16x32_bf16 v[108:111], v[56:59], v[244:247], v[108:111]
  ds_read_b128 v[56:59], v33 offset:18432
  s_waitcnt lgkmcnt(3)
  v_mfma_f32_16x16x32_bf16 v[96:99], v[60:63], v[152:155], v[96:99]
  v_mfma_f32_16x16x32_bf16 v[100:103], v[60:63], v[184:187], v[100:103]
  v_mfma_f32_16x16x32_bf16 v[104:107], v[60:63], v[216:219], v[104:107]
  v_mfma_f32_16x16x32_bf16 v[108:111], v[60:63], v[248:251], v[108:111]
  ds_read_b128 v[60:63], v34 offset:18432
  s_waitcnt lgkmcnt(3)
  v_mfma_f32_16x16x32_bf16 v[96:99], v[64:67], v[156:159], v[96:99]
  v_mfma_f32_16x16x32_bf16 v[100:103], v[64:67], v[188:191], v[100:103]
  v_mfma_f32_16x16x32_bf16 v[104:107], v[64:67], v[220:223], v[104:107]
  v_mfma_f32_16x16x32_bf16 v[108:111], v[64:67], v[252:255], v[108:111]
  ds_read_b128 v[64:67], v35 offset:18432
  s_waitcnt lgkmcnt(3)
  v_mfma_f32_16x16x32_bf16 v[112:115], v[52:55], v[128:131], 0
  v_mfma_f32_16x16x32_bf16 v[116:119], v[52:55], v[160:163], 0
  v_mfma_f32_16x16x32_bf16 v[120:123], v[52:55], v[192:195], 0
  v_mfma_f32_16x16x32_bf16 v[124:127], v[52:55], v[224:227], 0
  ds_read_b128 v[52:55], v32 offset:18688
  s_waitcnt lgkmcnt(3)
  v_mfma_f32_16x16x32_bf16 v[112:115], v[56:59], v[132:135], v[112:115]
  v_mfma_f32_16x16x32_bf16 v[116:119], v[56:59], v[164:167], v[116:119]
  v_mfma_f32_16x16x32_bf16 v[120:123], v[56:59], v[196:199], v[120:123]
  v_mfma_f32_16x16x32_bf16 v[124:127], v[56:59], v[228:231], v[124:127]
  ds_read_b128 v[56:59], v33 offset:18688
  s_waitcnt lgkmcnt(3)
  v_mfma_f32_16x16x32_bf16 v[112:115], v[60:63], v[136:139], v[112:115]
  v_mfma_f32_16x16x32_bf16 v[116:119], v[60:63], v[168:171], v[116:119]
  v_mfma_f32_16x16x32_bf16 v[120:123], v[60:63], v[200:203], v[120:123]
  v_mfma_f32_16x16x32_bf16 v[124:127], v[60:63], v[232:235], v[124:127]
  ds_read_b128 v[60:63], v34 offset:18688
  s_waitcnt lgkmcnt(3)
  v_mfma_f32_16x16x32_bf16 v[112:115], v[64:67], v[140:143], v[112:115]
  v_mfma_f32_16x16x32_bf16 v[116:119], v[64:67], v[172:175], v[116:119]
  v_mfma_f32_16x16x32_bf16 v[120:123], v[64:67], v[204:207], v[120:123]
  v_mfma_f32_16x16x32_bf16 v[124:127], v[64:67], v[236:239], v[124:127]
  ds_read_b128 v[64:67], v35 offset:18688
  s_waitcnt lgkmcnt(3)
  v_mfma_f32_16x16x32_bf16 v[112:115], v[52:55], v[144:147], v[112:115]
  v_mfma_f32_16x16x32_bf16 v[116:119], v[52:55], v[176:179], v[116:119]
  v_mfma_f32_16x16x32_bf16 v[120:123], v[52:55], v[208:211], v[120:123]
  v_mfma_f32_16x16x32_bf16 v[124:127], v[52:55], v[240:243], v[124:127]
  s_waitcnt lgkmcnt(2)
  v_mfma_f32_16x16x32_bf16 v[112:115], v[56:59], v[148:151], v[112:115]
  v_mfma_f32_16x16x32_bf16 v[116:119], v[56:59], v[180:183], v[116:119]
  v_mfma_f32_16x16x32_bf16 v[120:123], v[56:59], v[212:215], v[120:123]
  v_mfma_f32_16x16x32_bf16 v[124:127], v[56:59], v[244:247], v[124:127]
  s_waitcnt lgkmcnt(1)
  v_mfma_f32_16x16x32_bf16 v[112:115], v[60:63], v[152:155], v[112:115]
  v_mfma_f32_16x16x32_bf16 v[116:119], v[60:63], v[184:187], v[116:119]
  v_mfma_f32_16x16x32_bf16 v[120:123], v[60:63], v[216:219], v[120:123]
  v_mfma_f32_16x16x32_bf16 v[124:127], v[60:63], v[248:251], v[124:127]
  s_waitcnt lgkmcnt(0)
  v_mfma_f32_16x16x32_bf16 v[112:115], v[64:67], v[156:159], v[112:115]
  v_mfma_f32_16x16x32_bf16 v[116:119], v[64:67], v[188:191], v[116:119]
  v_mfma_f32_16x16x32_bf16 v[120:123], v[64:67], v[220:223], v[120:123]
  v_mfma_f32_16x16x32_bf16 v[124:127], v[64:67], v[252:255], v[124:127]
  s_lshl_b32 s30, s29, 10
  v_mul_f32 v96, s24, v96
  v_mul_f32 v97, s24, v97
  v_mul_f32 v98, s24, v98
  v_mul_f32 v99, s24, v99
  v_cvt_pk_bf16_f32 v68, v96, v97
  v_cvt_pk_bf16_f32 v69, v98, v99
  v_mul_f32 v112, s24, v112
  v_mul_f32 v113, s24, v113
  v_mul_f32 v114, s24, v114
  v_mul_f32 v115, s24, v115
  v_cvt_pk_bf16_f32 v70, v112, v113
  v_cvt_pk_bf16_f32 v71, v114, v115
  buffer_store_dwordx4 v[68:71], v12, s[8:11], s30 offen sc1
  v_mul_f32 v100, s24, v100
  v_mul_f32 v101, s24, v101
  v_mul_f32 v102, s24, v102
  v_mul_f32 v103, s24, v103
  v_cvt_pk_bf16_f32 v72, v100, v101
  v_cvt_pk_bf16_f32 v73, v102, v103
  v_mul_f32 v116, s24, v116
  v_mul_f32 v117, s24, v117
  v_mul_f32 v118, s24, v118
  v_mul_f32 v119, s24, v119
  v_cvt_pk_bf16_f32 v74, v116, v117
  v_cvt_pk_bf16_f32 v75, v118, v119
  buffer_store_dwordx4 v[72:75], v13, s[8:11], s30 offen sc1
  v_mul_f32 v104, s24, v104
  v_mul_f32 v105, s24, v105
  v_mul_f32 v106, s24, v106
  v_mul_f32 v107, s24, v107
  v_cvt_pk_bf16_f32 v76, v104, v105
  v_cvt_pk_bf16_f32 v77, v106, v107
  v_mul_f32 v120, s24, v120
  v_mul_f32 v121, s24, v121
  v_mul_f32 v122, s24, v122
  v_mul_f32 v123, s24, v123
  v_cvt_pk_bf16_f32 v78, v120, v121
  v_cvt_pk_bf16_f32 v79, v122, v123
  buffer_store_dwordx4 v[76:79], v14, s[8:11], s30 offen sc1
  v_mul_f32 v108, s24, v108
  v_mul_f32 v109, s24, v109
  v_mul_f32 v110, s24, v110
  v_mul_f32 v111, s24, v111
  v_cvt_pk_bf16_f32 v80, v108, v109
  v_cvt_pk_bf16_f32 v81, v110, v111
  v_mul_f32 v124, s24, v124
  v_mul_f32 v125, s24, v125
  v_mul_f32 v126, s24, v126
  v_mul_f32 v127, s24, v127
  v_cvt_pk_bf16_f32 v82, v124, v125
  v_cvt_pk_bf16_f32 v83, v126, v127
  buffer_store_dwordx4 v[80:83], v15, s[8:11], s30 offen sc1
aj_w3:
  s_lshl_b32 s28, s17, 7
  s_lshl_b32 s21, s19, 4
  s_add_u32 s28, s28, s21
  s_cmp_lg_u32 s31, 0
  s_cselect_b32 s21, 8, 0
  s_add_u32 s28, s28, s21
  s_add_u32 s28, s28, 88633344
  s_waitcnt vmcnt(0)
  s_barrier
  s_cmp_lg_u32 s16, 0
  s_cbranch_scc1 pub_40
  v_mul_u32_u24 v26, 2048, v1
  v_mov_b32 v24, s88
  v_mov_b32 v25, s89
  s_mov_b64 exec, 1
  buffer_store_dwordx2 v[24:25], v26, s[8:11], s28 offen sc1
  s_mov_b64 exec, -1
pub_40:
  v_mov_b32 v250, 0
  s_branch wk_loop
wk_srv:
  s_sub_u32 s3, s3, 224
  s_and_b32 s18, s3, 15
  s_lshr_b32 s19, s3, 4
  s_and_b32 s19, s19, 1
  s_mul_i32 s20, s18, 401408
  s_mul_i32 s21, s16, 100352
  s_add_u32 s20, s20, s21
  s_add_u32 s20, s20, 6422528
  s_add_u32 s22, s20, 0
  buffer_load_dwordx4 a[0:3], v2, s[8:11], s22 offen offset:0 sc1
  buffer_load_dwordx4 a[4:7], v2, s[8:11], s22 offen offset:1024 sc1
  buffer_load_dwordx4 a[8:11], v2, s[8:11], s22 offen offset:2048 sc1
  buffer_load_dwordx4 a[12:15], v2, s[8:11], s22 offen offset:3072 sc1
  s_add_u32 s22, s20, 4096
  buffer_load_dwordx4 a[16:19], v2, s[8:11], s22 offen offset:0 sc1
  buffer_load_dwordx4 a[20:23], v2, s[8:11], s22 offen offset:1024 sc1
  buffer_load_dwordx4 a[24:27], v2, s[8:11], s22 offen offset:2048 sc1
  buffer_load_dwordx4 a[28:31], v2, s[8:11], s22 offen offset:3072 sc1
  s_add_u32 s22, s20, 8192
  buffer_load_dwordx4 a[32:35], v2, s[8:11], s22 offen offset:0 sc1
  buffer_load_dwordx4 a[36:39], v2, s[8:11], s22 offen offset:1024 sc1
  buffer_load_dwordx4 a[40:43], v2, s[8:11], s22 offen offset:2048 sc1
  buffer_load_dwordx4 a[44:47], v2, s[8:11], s22 offen offset:3072 sc1
  s_add_u32 s22, s20, 12288
  buffer_load_dwordx4 a[48:51], v2, s[8:11], s22 offen offset:0 sc1
  buffer_load_dwordx4 a[52:55], v2, s[8:11], s22 offen offset:1024 sc1
  buffer_load_dwordx4 a[56:59], v2, s[8:11], s22 offen offset:2048 sc1
  buffer_load_dwordx4 a[60:63], v2, s[8:11], s22 offen offset:3072 sc1
  s_add_u32 s22, s20, 16384
  buffer_load_dwordx4 a[64:67], v2, s[8:11], s22 offen offset:0 sc1
  buffer_load_dwordx4 a[68:71], v2, s[8:11], s22 offen offset:1024 sc1
  buffer_load_dwordx4 a[72:75], v2, s[8:11], s22 offen offset:2048 sc1
  buffer_load_dwordx4 a[76:79], v2, s[8:11], s22 offen offset:3072 sc1
  s_add_u32 s22, s20, 20480
  buffer_load_dwordx4 a[80:83], v2, s[8:11], s22 offen offset:0 sc1
  buffer_load_dwordx4 a[84:87], v2, s[8:11], s22 offen offset:1024 sc1
  buffer_load_dwordx4 a[88:91], v2, s[8:11], s22 offen offset:2048 sc1
  buffer_load_dwordx4 a[92:95], v2, s[8:11], s22 offen offset:3072 sc1
  s_add_u32 s22, s20, 24576
  buffer_load_dwordx4 a[96:99], v2, s[8:11], s22 offen offset:0 sc1
  buffer_load_dwordx4 a[100:103], v2, s[8:11], s22 offen offset:1024 sc1
  buffer_load_dwordx4 a[104:107], v2, s[8:11], s22 offen offset:2048 sc1
  buffer_load_dwordx4 a[108:111], v2, s[8:11], s22 offen offset:3072 sc1
  s_add_u32 s22, s20, 28672
  buffer_load_dwordx4 a[112:115], v2, s[8:11], s22 offen offset:0 sc1
  buffer_load_dwordx4 a[116:119], v2, s[8:11], s22 offen offset:1024 sc1
  buffer_load_dwordx4 a[120:123], v2, s[8:11], s22 offen offset:2048 sc1
  buffer_load_dwordx4 a[124:127], v2, s[8:11], s22 offen offset:3072 sc1
  s_waitcnt vmcnt(24)
  s_add_u32 s22, s20, 32768
  buffer_load_dwordx4 a[128:131], v2, s[8:11], s22 offen offset:0 sc1
  buffer_load_dwordx4 a[132:135], v2, s[8:11], s22 offen offset:1024 sc1
  buffer_load_dwordx4 a[136:139], v2, s[8:11], s22 offen offset:2048 sc1
  buffer_load_dwordx4 a[140:143], v2, s[8:11], s22 offen offset:3072 sc1
  s_add_u32 s22, s20, 36864
  buffer_load_dwordx4 a[144:147], v2, s[8:11], s22 offen offset:0 sc1
  buffer_load_dwordx4 a[148:151], v2, s[8:11], s22 offen offset:1024 sc1
  buffer_load_dwordx4 a[152:155], v2, s[8:11], s22 offen offset:2048 sc1
  buffer_load_dwordx4 a[156:159], v2, s[8:11], s22 offen offset:3072 sc1
  s_add_u32 s22, s20, 40960
  buffer_load_dwordx4 a[160:163], v2, s[8:11], s22 offen offset:0 sc1
  buffer_load_dwordx4 a[164:167], v2, s[8:11], s22 offen offset:1024 sc1
  buffer_load_dwordx4 a[168:171], v2, s[8:11], s22 offen offset:2048 sc1
  buffer_load_dwordx4 a[172:175], v2, s[8:11], s22 offen offset:3072 sc1
  s_add_u32 s22, s20, 45056
  buffer_load_dwordx4 a[176:179], v2, s[8:11], s22 offen offset:0 sc1
  buffer_load_dwordx4 a[180:183], v2, s[8:11], s22 offen offset:1024 sc1
  buffer_load_dwordx4 a[184:187], v2, s[8:11], s22 offen offset:2048 sc1
  buffer_load_dwordx4 a[188:191], v2, s[8:11], s22 offen offset:3072 sc1
  s_add_u32 s22, s20, 49152
  buffer_load_dwordx4 a[192:195], v2, s[8:11], s22 offen offset:0 sc1
  buffer_load_dwordx4 a[196:199], v2, s[8:11], s22 offen offset:1024 sc1
  buffer_load_dwordx4 a[200:203], v2, s[8:11], s22 offen offset:2048 sc1
  buffer_load_dwordx4 a[204:207], v2, s[8:11], s22 offen offset:3072 sc1
  s_add_u32 s22, s20, 53248
  buffer_load_dwordx4 a[208:211], v2, s[8:11], s22 offen offset:0 sc1
  buffer_load_dwordx4 a[212:215], v2, s[8:11], s22 offen offset:1024 sc1
  buffer_load_dwordx4 a[216:219], v2, s[8:11], s22 offen offset:2048 sc1
  buffer_load_dwordx4 a[220:223], v2, s[8:11], s22 offen offset:3072 sc1
  s_add_u32 s22, s20, 57344
  buffer_load_dwordx4 a[224:227], v2, s[8:11], s22 offen offset:0 sc1
  buffer_load_dwordx4 a[228:231], v2, s[8:11], s22 offen offset:1024 sc1
  buffer_load_dwordx4 a[232:235], v2, s[8:11], s22 offen offset:2048 sc1
  buffer_load_dwordx4 a[236:239], v2, s[8:11], s22 offen offset:3072 sc1
  s_add_u32 s22, s20, 61440
  buffer_load_dwordx4 a[240:243], v2, s[8:11], s22 offen offset:0 sc1
  buffer_load_dwordx4 a[244:247], v2, s[8:11], s22 offen offset:1024 sc1
  buffer_load_dwordx4 a[248:251], v2, s[8:11], s22 offen offset:2048 sc1
  buffer_load_dwordx4 a[252:255], v2, s[8:11], s22 offen offset:3072 sc1
  s_waitcnt vmcnt(24)
  s_add_u32 s22, s20, 65536
  buffer_load_dwordx4 v[120:123], v2, s[8:11], s22 offen offset:0 sc1
  buffer_load_dwordx4 v[124:127], v2, s[8:11], s22 offen offset:1024 sc1
  buffer_load_dwordx4 v[128:131], v2, s[8:11], s22 offen offset:2048 sc1
  buffer_load_dwordx4 v[132:135], v2, s[8:11], s22 offen offset:3072 sc1
  s_add_u32 s22, s20, 69632
  buffer_load_dwordx4 v[136:139], v2, s[8:11], s22 offen offset:0 sc1
  buffer_load_dwordx4 v[140:143], v2, s[8:11], s22 offen offset:1024 sc1
  buffer_load_dwordx4 v[144:147], v2, s[8:11], s22 offen offset:2048 sc1
  buffer_load_dwordx4 v[148:151], v2, s[8:11], s22 offen offset:3072 sc1
  s_add_u32 s22, s20, 73728
  buffer_load_dwordx4 v[152:155], v2, s[8:11], s22 offen offset:0 sc1
  buffer_load_dwordx4 v[156:159], v2, s[8:11], s22 offen offset:1024 sc1
  buffer_load_dwordx4 v[160:163], v2, s[8:11], s22 offen offset:2048 sc1
  buffer_load_dwordx4 v[164:167], v2, s[8:11], s22 offen offset:3072 sc1
  s_add_u32 s22, s20, 77824
  buffer_load_dwordx4 v[168:171], v2, s[8:11], s22 offen offset:0 sc1
  buffer_load_dwordx4 v[172:175], v2, s[8:11], s22 offen offset:1024 sc1
  buffer_load_dwordx4 v[176:179], v2, s[8:11], s22 offen offset:2048 sc1
  buffer_load_dwordx4 v[180:183], v2, s[8:11], s22 offen offset:3072 sc1
  s_add_u32 s22, s20, 81920
  buffer_load_dwordx4 v[184:187], v2, s[8:11], s22 offen offset:0 sc1
  buffer_load_dwordx4 v[188:191], v2, s[8:11], s22 offen offset:1024 sc1
  buffer_load_dwordx4 v[192:195], v2, s[8:11], s22 offen offset:2048 sc1
  buffer_load_dwordx4 v[196:199], v2, s[8:11], s22 offen offset:3072 sc1
  s_add_u32 s22, s20, 86016
  buffer_load_dwordx4 v[200:203], v2, s[8:11], s22 offen offset:0 sc1
  buffer_load_dwordx4 v[204:207], v2, s[8:11], s22 offen offset:1024 sc1
  buffer_load_dwordx4 v[208:211], v2, s[8:11], s22 offen offset:2048 sc1
  buffer_load_dwordx4 v[212:215], v2, s[8:11], s22 offen offset:3072 sc1
  s_add_u32 s22, s20, 90112
  buffer_load_dwordx4 v[216:219], v2, s[8:11], s22 offen offset:0 sc1
  buffer_load_dwordx4 v[220:223], v2, s[8:11], s22 offen offset:1024 sc1
  buffer_load_dwordx4 v[224:227], v2, s[8:11], s22 offen offset:2048 sc1
  buffer_load_dwordx4 v[228:231], v2, s[8:11], s22 offen offset:3072 sc1
  s_add_u32 s22, s20, 94208
  buffer_load_dwordx4 v[232:235], v2, s[8:11], s22 offen offset:0 sc1
  buffer_load_dwordx4 v[236:239], v2, s[8:11], s22 offen offset:1024 sc1
  buffer_load_dwordx4 v[240:243], v2, s[8:11], s22 offen offset:2048 sc1
  buffer_load_dwordx4 v[244:247], v2, s[8:11], s22 offen offset:3072 sc1
  s_waitcnt vmcnt(24)
  s_add_u32 s22, s20, 98304
  buffer_load_dwordx4 v[248:251], v2, s[8:11], s22 offen offset:0 sc1
  buffer_load_dwordx4 v[252:255], v2, s[8:11], s22 offen offset:1024 sc1
  v_mov_b32 v5, 0x4444
  v_mov_b32 v6, 0xeeee
  v_cmp_lt_u32 vcc, 7, v4
  s_nop 1
  v_cndmask_b32 v5, v5, v6, vcc
  s_lshl_b32 s23, s16, 11
  v_lshrrev_b32 v80, 1, v3
  v_and_b32 v81, 1, v3
  v_add_u32 v82, 0, v80
  v_lshl_add_u32 v82, v82, 4, v4
  v_mul_u32_u24 v83, 2341, v82
  v_lshrrev_b32 v83, 16, v83
  v_mul_u32_u24 v84, 28, v83
  v_sub_u32 v84, v82, v84
  v_lshrrev_b32 v85, 4, v84
  v_and_b32 v84, 15, v84
  v_lshlrev_b32 v86, 10, v85
  v_lshl_add_u32 v86, v83, 8, v86
  v_lshl_add_u32 v86, v84, 4, v86
  v_lshl_add_u32 v86, v81, 3, v86
  v_add_u32 v72, s23, v86
  v_add_u32 v82, 2, v80
  v_lshl_add_u32 v82, v82, 4, v4
  v_mul_u32_u24 v83, 2341, v82
  v_lshrrev_b32 v83, 16, v83
  v_mul_u32_u24 v84, 28, v83
  v_sub_u32 v84, v82, v84
  v_lshrrev_b32 v85, 4, v84
  v_and_b32 v84, 15, v84
  v_lshlrev_b32 v86, 10, v85
  v_lshl_add_u32 v86, v83, 8, v86
  v_lshl_add_u32 v86, v84, 4, v86
  v_lshl_add_u32 v86, v81, 3, v86
  v_add_u32 v73, s23, v86
  v_add_u32 v82, 4, v80
  v_lshl_add_u32 v82, v82, 4, v4
  v_mul_u32_u24 v83, 2341, v82
  v_lshrrev_b32 v83, 16, v83
  v_mul_u32_u24 v84, 28, v83
  v_sub_u32 v84, v82, v84
  v_lshrrev_b32 v85, 4, v84
  v_and_b32 v84, 15, v84
  v_lshlrev_b32 v86, 10, v85
  v_lshl_add_u32 v86, v83, 8, v86
  v_lshl_add_u32 v86, v84, 4, v86
  v_lshl_add_u32 v86, v81, 3, v86
  v_add_u32 v74, s23, v86
  v_mov_b32 v82, 6
  v_lshl_add_u32 v82, v82, 4, v4
  v_mul_u32_u24 v83, 2341, v82
  v_lshrrev_b32 v83, 16, v83
  v_mul_u32_u24 v84, 28, v83
  v_sub_u32 v84, v82, v84
  v_lshrrev_b32 v85, 4, v84
  v_and_b32 v84, 15, v84
  v_lshlrev_b32 v86, 10, v85
  v_lshl_add_u32 v86, v83, 8, v86
  v_lshl_add_u32 v86, v84, 4, v86
  v_lshl_add_u32 v86, v81, 3, v86
  v_add_u32 v75, s23, v86
  v_add_u32 v76, s23, v2
  s_mul_i32 s27, s18, 448
  v_mov_b32 v77, s27
  v_mov_b32 v78, 1
  s_mov_b32 s17, s19
  s_mul_i32 s24, s19, 7168
  s_add_u32 s24, s24, 88080384
  s_mul_i32 s25, s18, 65
  s_add_u32 s25, s25, s19
  s_lshl_b32 s25, s25, 13
  s_add_u32 s25, s25, s23
  s_add_u32 s25, s25, 76947456
  s_lshl_b32 s26, s18, 6
  s_add_u32 s26, s26, s19
  s_lshl_b32 s26, s26, 4
  s_lshl_b32 s27, s16, 2
  s_add_u32 s26, s26, s27
  s_add_u32 s26, s26, 88582144
  v_mov_b32 v87, -1
ws_loop:
  v_mov_b32 v36, 0
  v_mov_b32 v37, 0
  v_mov_b32 v38, 0
  v_mov_b32 v39, 0
  v_mov_b32 v40, 0
  v_mov_b32 v41, 0
  v_mov_b32 v42, 0
  v_mov_b32 v43, 0
  v_mov_b32 v44, 0
  v_mov_b32 v45, 0
  v_mov_b32 v46, 0
  v_mov_b32 v47, 0
  v_mov_b32 v48, 0
  v_mov_b32 v49, 0
  v_mov_b32 v50, 0
  v_mov_b32 v51, 0
  v_mov_b32 v52, 0
  v_mov_b32 v53, 0
  v_mov_b32 v54, 0
  v_mov_b32 v55, 0
  v_mov_b32 v56, 0
  v_mov_b32 v57, 0
  v_mov_b32 v58, 0
  v_mov_b32 v59, 0
  v_mov_b32 v60, 0
  v_mov_b32 v61, 0
  v_mov_b32 v62, 0
  v_mov_b32 v63, 0
  s_mov_b32 s30, 0
  v_cmp_eq_u32 vcc, -1, v87
  s_cbranch_vccz ws_fl
ws_pm:
  s_cmp_ge_u32 s17, 61
  s_cbranch_scc1 mp_41a
  v_mov_b32 v79, 0
  s_mov_b64 exec, 1
  buffer_atomic_or v79, v77, s[8:11], s24 offen sc0
  s_mov_b64 exec, -1
  s_branch mp_41b
mp_41a:
  buffer_load_dword v79, v77, s[8:11], s24 offen sc1
mp_41b:
  s_waitcnt vmcnt(0)
  v_cmp_eq_u32 vcc, -1, v79
  s_cbranch_vccnz ws_pr
ws_fl:
  s_add_u32 s22, s24, 4096
  buffer_load_dwordx4 v[8:11], v2, s[8:11], s24 offen offset:0 sc1
  buffer_load_dwordx4 v[12:15], v2, s[8:11], s24 offen offset:1024 sc1
  buffer_load_dwordx4 v[16:19], v2, s[8:11], s24 offen offset:2048 sc1
  buffer_load_dwordx4 v[20:23], v2, s[8:11], s24 offen offset:3072 sc1
  buffer_load_dwordx4 v[24:27], v2, s[8:11], s22 offen offset:0 sc1
  buffer_load_dwordx4 v[28:31], v2, s[8:11], s22 offen offset:1024 sc1
  buffer_load_dwordx4 v[32:35], v2, s[8:11], s22 offen offset:2048 sc1
  s_waitcnt vmcnt(0)
  v_max_u32 v79, v8, v9
  v_max3_u32 v79, v79, v10, v11
  v_max3_u32 v79, v79, v12, v13
  v_max3_u32 v79, v79, v14, v15
  v_max3_u32 v79, v79, v16, v17
  v_max3_u32 v79, v79, v18, v19
  v_max3_u32 v79, v79, v20, v21
  v_max3_u32 v79, v79, v22, v23
  v_max3_u32 v79, v79, v24, v25
  v_max3_u32 v79, v79, v26, v27
  v_max3_u32 v79, v79, v28, v29
  v_max3_u32 v79, v79, v30, v31
  v_max3_u32 v79, v79, v32, v33
  v_max3_u32 v79, v79, v34, v35
  v_cmp_eq_u32 vcc, -1, v79
  s_cbranch_vccz ws_pk
ws_pr:
  s_sleep 1
  s_cmp_ge_u32 s17, 61
  s_cbranch_scc1 ws_sh
  s_sleep 6
ws_sh:
  s_add_u32 s30, s30, 1
  s_cmp_lt_u32 s30, 30000
  s_cbranch_scc1 ws_pm
  s_branch cA_abort
ws_pk:
  s_cmp_ge_u32 s17, 62
  s_cbranch_scc1 ws_na
  s_add_u32 s22, s24, 14336
  s_cmp_ge_u32 s17, 61
  s_cbranch_scc1 mp_42a
  v_mov_b32 v87, 0
  s_mov_b64 exec, 1
  buffer_atomic_or v87, v77, s[8:11], s22 offen sc0
  s_mov_b64 exec, -1
  s_branch mp_42b
mp_42a:
  buffer_load_dword v87, v77, s[8:11], s22 offen sc1
mp_42b:
ws_na:
  v_smfmac_f32_16x16x64_bf16 v[36:39], v[8:11], a[0:7], v5
  v_smfmac_f32_16x16x64_bf16 v[36:39], v[12:15], a[8:15], v5
  v_smfmac_f32_16x16x64_bf16 v[36:39], v[16:19], a[16:23], v5
  v_smfmac_f32_16x16x64_bf16 v[36:39], v[20:23], a[24:31], v5
  v_smfmac_f32_16x16x64_bf16 v[36:39], v[24:27], a[32:39], v5
  v_smfmac_f32_16x16x64_bf16 v[36:39], v[28:31], a[40:47], v5
  v_smfmac_f32_16x16x64_bf16 v[36:39], v[32:35], a[48:55], v5
  v_smfmac_f32_16x16x64_bf16 v[40:43], v[8:11], a[56:63], v5
  v_smfmac_f32_16x16x64_bf16 v[40:43], v[12:15], a[64:71], v5
  v_smfmac_f32_16x16x64_bf16 v[40:43], v[16:19], a[72:79], v5
  v_smfmac_f32_16x16x64_bf16 v[40:43], v[20:23], a[80:87], v5
  v_smfmac_f32_16x16x64_bf16 v[40:43], v[24:27], a[88:95], v5
  v_smfmac_f32_16x16x64_bf16 v[40:43], v[28:31], a[96:103], v5
  v_smfmac_f32_16x16x64_bf16 v[40:43], v[32:35], a[104:111], v5
  v_smfmac_f32_16x16x64_bf16 v[44:47], v[8:11], a[112:119], v5
  v_smfmac_f32_16x16x64_bf16 v[44:47], v[12:15], a[120:127], v5
  v_smfmac_f32_16x16x64_bf16 v[44:47], v[16:19], a[128:135], v5
  v_smfmac_f32_16x16x64_bf16 v[44:47], v[20:23], a[136:143], v5
  v_smfmac_f32_16x16x64_bf16 v[44:47], v[24:27], a[144:151], v5
  v_smfmac_f32_16x16x64_bf16 v[44:47], v[28:31], a[152:159], v5
  v_smfmac_f32_16x16x64_bf16 v[44:47], v[32:35], a[160:167], v5
  v_smfmac_f32_16x16x64_bf16 v[48:51], v[8:11], a[168:175], v5
  v_smfmac_f32_16x16x64_bf16 v[48:51], v[12:15], a[176:183], v5
  v_smfmac_f32_16x16x64_bf16 v[48:51], v[16:19], a[184:191], v5
  v_smfmac_f32_16x16x64_bf16 v[48:51], v[20:23], a[192:199], v5
  v_smfmac_f32_16x16x64_bf16 v[48:51], v[24:27], a[200:207], v5
  v_smfmac_f32_16x16x64_bf16 v[48:51], v[28:31], a[208:215], v5
  v_smfmac_f32_16x16x64_bf16 v[48:51], v[32:35], a[216:223], v5
  v_smfmac_f32_16x16x64_bf16 v[52:55], v[8:11], a[224:231], v5
  v_smfmac_f32_16x16x64_bf16 v[52:55], v[12:15], a[232:239], v5
  v_smfmac_f32_16x16x64_bf16 v[52:55], v[16:19], a[240:247], v5
  v_smfmac_f32_16x16x64_bf16 v[52:55], v[20:23], a[248:255], v5
  v_smfmac_f32_16x16x64_bf16 v[52:55], v[24:27], v[120:127], v5
  v_smfmac_f32_16x16x64_bf16 v[52:55], v[28:31], v[128:135], v5
  v_smfmac_f32_16x16x64_bf16 v[52:55], v[32:35], v[136:143], v5
  v_smfmac_f32_16x16x64_bf16 v[56:59], v[8:11], v[144:151], v5
  v_smfmac_f32_16x16x64_bf16 v[56:59], v[12:15], v[152:159], v5
  v_smfmac_f32_16x16x64_bf16 v[56:59], v[16:19], v[160:167], v5
  v_smfmac_f32_16x16x64_bf16 v[56:59], v[20:23], v[168:175], v5
  v_smfmac_f32_16x16x64_bf16 v[56:59], v[24:27], v[176:183], v5
  v_smfmac_f32_16x16x64_bf16 v[56:59], v[28:31], v[184:191], v5
  v_smfmac_f32_16x16x64_bf16 v[56:59], v[32:35], v[192:199], v5
  v_smfmac_f32_16x16x64_bf16 v[60:63], v[8:11], v[200:207], v5
  v_smfmac_f32_16x16x64_bf16 v[60:63], v[12:15], v[208:215], v5
  v_smfmac_f32_16x16x64_bf16 v[60:63], v[16:19], v[216:223], v5
  v_smfmac_f32_16x16x64_bf16 v[60:63], v[20:23], v[224:231], v5
  v_smfmac_f32_16x16x64_bf16 v[60:63], v[24:27], v[232:239], v5
  v_smfmac_f32_16x16x64_bf16 v[60:63], v[28:31], v[240:247], v5
  v_smfmac_f32_16x16x64_bf16 v[60:63], v[32:35], v[248:255], v5
  v_permlane32_swap_b32 v36, v40
  v_permlane32_swap_b32 v37, v41
  v_permlane32_swap_b32 v38, v42
  v_permlane32_swap_b32 v39, v43
  v_add_f32 v36, v36, v40
  v_add_f32 v37, v37, v41
  v_add_f32 v38, v38, v42
  v_add_f32 v39, v39, v43
  v_cvt_pk_bf16_f32 v40, v36, v37
  v_cvt_pk_bf16_f32 v41, v38, v39
  ds_write_b64 v72, v[40:41]
  v_permlane32_swap_b32 v44, v48
  v_permlane32_swap_b32 v45, v49
  v_permlane32_swap_b32 v46, v50
  v_permlane32_swap_b32 v47, v51
  v_add_f32 v44, v44, v48
  v_add_f32 v45, v45, v49
  v_add_f32 v46, v46, v50
  v_add_f32 v47, v47, v51
  v_cvt_pk_bf16_f32 v48, v44, v45
  v_cvt_pk_bf16_f32 v49, v46, v47
  ds_write_b64 v73, v[48:49]
  v_permlane32_swap_b32 v52, v56
  v_permlane32_swap_b32 v53, v57
  v_permlane32_swap_b32 v54, v58
  v_permlane32_swap_b32 v55, v59
  v_add_f32 v52, v52, v56
  v_add_f32 v53, v53, v57
  v_add_f32 v54, v54, v58
  v_add_f32 v55, v55, v59
  v_cvt_pk_bf16_f32 v56, v52, v53
  v_cvt_pk_bf16_f32 v57, v54, v55
  ds_write_b64 v74, v[56:57]
  v_mov_b32 v64, v60
  v_mov_b32 v65, v61
  v_mov_b32 v66, v62
  v_mov_b32 v67, v63
  v_permlane32_swap_b32 v60, v64
  v_permlane32_swap_b32 v61, v65
  v_permlane32_swap_b32 v62, v66
  v_permlane32_swap_b32 v63, v67
  v_add_f32 v60, v60, v64
  v_add_f32 v61, v61, v65
  v_add_f32 v62, v62, v66
  v_add_f32 v63, v63, v67
  v_cvt_pk_bf16_f32 v64, v60, v61
  v_cvt_pk_bf16_f32 v65, v62, v63
  ds_write_b64 v75, v[64:65]
  s_waitcnt lgkmcnt(0)
  ds_read_b128 v[64:67], v76
  ds_read_b128 v[68:71], v76 offset:1024
  s_waitcnt lgkmcnt(0)
  buffer_store_dwordx4 v[64:67], v2, s[8:11], s25 offen sc1
  buffer_store_dwordx4 v[68:71], v2, s[8:11], s25 offen offset:1024 sc1
  s_waitcnt vmcnt(0)
  s_mov_b64 exec, 1
  buffer_store_dword v78, v2, s[8:11], s26 offen sc1
  s_mov_b64 exec, -1
  s_add_u32 s24, s24, 14336
  s_add_u32 s25, s25, 16384
  s_add_u32 s26, s26, 32
  s_add_u32 s17, s17, 2
  s_cmp_lt_u32 s17, 64
  s_cbranch_scc1 ws_loop
  v_mov_b32 v250, 0
  s_branch wk_loop
wk_s4d:
  s_cmp_lg_u32 s16, 0
  s_cbranch_scc1 w0_43
  s_getreg_b32 s20, hwreg(HW_REG_XCC_ID)
  s_sub_u32 s20, s20, 1
  s_and_b32 s20, s20, 7
  s_mov_b64 exec, 1
s4_l:
  s_cmp_ge_u32 s20, 7
  s_cselect_b32 s20, 0, s20
  s_lshl_b32 s21, s20, 7
  s_add_u32 s21, s21, 88598528
  v_mov_b32 v242, 1
  buffer_atomic_add v242, off, s[8:11], s21 sc0
  s_waitcnt vmcnt(0)
  v_readfirstlane_b32 s21, v242
  s_lshl_b32 s22, s20, 4
  s_add_u32 s20, s20, 1
  s_cmp_ge_u32 s21, 16
  s_cbranch_scc1 s4_l
  v_add_u32 v242, s22, v242
  s_mov_b64 exec, -1
w0_43:
  v_mov_b32 v243, 160000
  s_add_u32 s101, s101, 1
  s_barrier
  s_mov_b64 exec, 1
  s_cmp_lg_u32 s16, 0
  s_cbranch_scc1 w0_44
  ds_write_b32 v243, v242 offset:0
  s_waitcnt lgkmcnt(0)
  v_mov_b32 v242, s101
  ds_write_b32 v243, v242 offset:16
  s_waitcnt lgkmcnt(0)
w0_44:
  s_mov_b64 exec, -1
  s_barrier
  ds_read_b32 v242, v243 offset:0
  ds_read_b32 v243, v243 offset:16
  s_waitcnt lgkmcnt(0)
  v_readfirstlane_b32 s3, v242
  v_cmp_ne_u32 vcc, s101, v243
  s_cbranch_vccnz ch_end
  s_load_dwordx8 s[40:47], s[0:1], 0
  s_load_dwordx4 s[48:51], s[0:1], 32
  s_load_dwordx2 s[52:53], s[0:1], 48
  s_load_dwordx2 s[54:55], s[0:1], 112
  v_lshrrev_b32 v1, 6, v0
  s_nop 0
  v_readfirstlane_b32 s16, v1
  v_and_b32 v1, 63, v0
  v_lshrrev_b32 v3, 4, v1
  v_and_b32 v4, 15, v1
  s_mul_i32 s17, s16, 24576
  s_waitcnt lgkmcnt(0)
  s_mov_b32 s60, s40
  s_and_b32 s61, s41, 0xffff
  s_mov_b32 s62, 1835008
  s_mov_b32 s63, 0x20000
  s_mov_b32 s64, s42
  s_and_b32 s65, s43, 0xffff
  s_mov_b32 s66, 229376
  s_mov_b32 s67, 0x20000
  s_mov_b32 s68, s44
  s_and_b32 s69, s45, 0xffff
  s_mov_b32 s70, 229376
  s_mov_b32 s71, 0x20000
  s_mov_b32 s72, s46
  s_and_b32 s73, s47, 0xffff
  s_mov_b32 s74, 229376
  s_mov_b32 s75, 0x20000
  s_mov_b32 s76, s48
  s_and_b32 s77, s49, 0xffff
  s_mov_b32 s78, 229376
  s_mov_b32 s79, 0x20000
  s_mov_b32 s80, s50
  s_and_b32 s81, s51, 0xffff
  s_mov_b32 s82, 896
  s_mov_b32 s83, 0x20000
  s_mov_b32 s84, s52
  s_and_b32 s85, s53, 0xffff
  s_mov_b32 s86, 896
  s_mov_b32 s87, 0x20000
  s_mov_b32 s92, s54
  s_and_b32 s93, s55, 0xffff
  s_mov_b32 s94, 3670016
  s_mov_b32 s95, 0x20000
  v_lshlrev_b32 v5, 5, v1
  v_sub_u32 v5, 2047, v5
  s_add_u32 s18, s17, 13056
  v_subrev_u32 v6, 0, v5
  v_max_i32 v7, 0, v6
  v_cvt_f32_u32 v7, v7
  v_cvt_pk_bf16_f32 v8, v7, v7
  v_and_b32 v7, 0xffff0000, v8
  v_lshrrev_b32 v8, 23, v7
  v_subrev_u32 v8, 134, v8
  v_max_i32 v8, 0, v8
  v_cvt_u32_f32 v7, v7
  v_lshrrev_b32 v7, v8, v7
  v_lshl_add_u32 v7, v8, 8, v7
  v_lshl_add_u32 v200, v7, 2, s18
  v_subrev_u32 v6, 1, v5
  v_max_i32 v7, 0, v6
  v_cvt_f32_u32 v7, v7
  v_cvt_pk_bf16_f32 v8, v7, v7
  v_and_b32 v7, 0xffff0000, v8
  v_lshrrev_b32 v8, 23, v7
  v_subrev_u32 v8, 134, v8
  v_max_i32 v8, 0, v8
  v_cvt_u32_f32 v7, v7
  v_lshrrev_b32 v7, v8, v7
  v_lshl_add_u32 v7, v8, 8, v7
  v_lshl_add_u32 v201, v7, 2, s18
  v_subrev_u32 v6, 2, v5
  v_max_i32 v7, 0, v6
  v_cvt_f32_u32 v7, v7
  v_cvt_pk_bf16_f32 v8, v7, v7
  v_and_b32 v7, 0xffff0000, v8
  v_lshrrev_b32 v8, 23, v7
  v_subrev_u32 v8, 134, v8
  v_max_i32 v8, 0, v8
  v_cvt_u32_f32 v7, v7
  v_lshrrev_b32 v7, v8, v7
  v_lshl_add_u32 v7, v8, 8, v7
  v_lshl_add_u32 v202, v7, 2, s18
  v_subrev_u32 v6, 3, v5
  v_max_i32 v7, 0, v6
  v_cvt_f32_u32 v7, v7
  v_cvt_pk_bf16_f32 v8, v7, v7
  v_and_b32 v7, 0xffff0000, v8
  v_lshrrev_b32 v8, 23, v7
  v_subrev_u32 v8, 134, v8
  v_max_i32 v8, 0, v8
  v_cvt_u32_f32 v7, v7
  v_lshrrev_b32 v7, v8, v7
  v_lshl_add_u32 v7, v8, 8, v7
  v_lshl_add_u32 v203, v7, 2, s18
  v_subrev_u32 v6, 4, v5
  v_max_i32 v7, 0, v6
  v_cvt_f32_u32 v7, v7
  v_cvt_pk_bf16_f32 v8, v7, v7
  v_and_b32 v7, 0xffff0000, v8
  v_lshrrev_b32 v8, 23, v7
  v_subrev_u32 v8, 134, v8
  v_max_i32 v8, 0, v8
  v_cvt_u32_f32 v7, v7
  v_lshrrev_b32 v7, v8, v7
  v_lshl_add_u32 v7, v8, 8, v7
  v_lshl_add_u32 v204, v7, 2, s18
  v_subrev_u32 v6, 5, v5
  v_max_i32 v7, 0, v6
  v_cvt_f32_u32 v7, v7
  v_cvt_pk_bf16_f32 v8, v7, v7
  v_and_b32 v7, 0xffff0000, v8
  v_lshrrev_b32 v8, 23, v7
  v_subrev_u32 v8, 134, v8
  v_max_i32 v8, 0, v8
  v_cvt_u32_f32 v7, v7
  v_lshrrev_b32 v7, v8, v7
  v_lshl_add_u32 v7, v8, 8, v7
  v_lshl_add_u32 v205, v7, 2, s18
  v_subrev_u32 v6, 6, v5
  v_max_i32 v7, 0, v6
  v_cvt_f32_u32 v7, v7
  v_cvt_pk_bf16_f32 v8, v7, v7
  v_and_b32 v7, 0xffff0000, v8
  v_lshrrev_b32 v8, 23, v7
  v_subrev_u32 v8, 134, v8
  v_max_i32 v8, 0, v8
  v_cvt_u32_f32 v7, v7
  v_lshrrev_b32 v7, v8, v7
  v_lshl_add_u32 v7, v8, 8, v7
  v_lshl_add_u32 v206, v7, 2, s18
  v_subrev_u32 v6, 7, v5
  v_max_i32 v7, 0, v6
  v_cvt_f32_u32 v7, v7
  v_cvt_pk_bf16_f32 v8, v7, v7
  v_and_b32 v7, 0xffff0000, v8
  v_lshrrev_b32 v8, 23, v7
  v_subrev_u32 v8, 134, v8
  v_max_i32 v8, 0, v8
  v_cvt_u32_f32 v7, v7
  v_lshrrev_b32 v7, v8, v7
  v_lshl_add_u32 v7, v8, 8, v7
  v_lshl_add_u32 v207, v7, 2, s18
  v_subrev_u32 v6, 8, v5
  v_max_i32 v7, 0, v6
  v_cvt_f32_u32 v7, v7
  v_cvt_pk_bf16_f32 v8, v7, v7
  v_and_b32 v7, 0xffff0000, v8
  v_lshrrev_b32 v8, 23, v7
  v_subrev_u32 v8, 134, v8
  v_max_i32 v8, 0, v8
  v_cvt_u32_f32 v7, v7
  v_lshrrev_b32 v7, v8, v7
  v_lshl_add_u32 v7, v8, 8, v7
  v_lshl_add_u32 v208, v7, 2, s18
  v_subrev_u32 v6, 9, v5
  v_max_i32 v7, 0, v6
  v_cvt_f32_u32 v7, v7
  v_cvt_pk_bf16_f32 v8, v7, v7
  v_and_b32 v7, 0xffff0000, v8
  v_lshrrev_b32 v8, 23, v7
  v_subrev_u32 v8, 134, v8
  v_max_i32 v8, 0, v8
  v_cvt_u32_f32 v7, v7
  v_lshrrev_b32 v7, v8, v7
  v_lshl_add_u32 v7, v8, 8, v7
  v_lshl_add_u32 v209, v7, 2, s18
  v_subrev_u32 v6, 10, v5
  v_max_i32 v7, 0, v6
  v_cvt_f32_u32 v7, v7
  v_cvt_pk_bf16_f32 v8, v7, v7
  v_and_b32 v7, 0xffff0000, v8
  v_lshrrev_b32 v8, 23, v7
  v_subrev_u32 v8, 134, v8
  v_max_i32 v8, 0, v8
  v_cvt_u32_f32 v7, v7
  v_lshrrev_b32 v7, v8, v7
  v_lshl_add_u32 v7, v8, 8, v7
  v_lshl_add_u32 v210, v7, 2, s18
  v_subrev_u32 v6, 11, v5
  v_max_i32 v7, 0, v6
  v_cvt_f32_u32 v7, v7
  v_cvt_pk_bf16_f32 v8, v7, v7
  v_and_b32 v7, 0xffff0000, v8
  v_lshrrev_b32 v8, 23, v7
  v_subrev_u32 v8, 134, v8
  v_max_i32 v8, 0, v8
  v_cvt_u32_f32 v7, v7
  v_lshrrev_b32 v7, v8, v7
  v_lshl_add_u32 v7, v8, 8, v7
  v_lshl_add_u32 v211, v7, 2, s18
  v_subrev_u32 v6, 12, v5
  v_max_i32 v7, 0, v6
  v_cvt_f32_u32 v7, v7
  v_cvt_pk_bf16_f32 v8, v7, v7
  v_and_b32 v7, 0xffff0000, v8
  v_lshrrev_b32 v8, 23, v7
  v_subrev_u32 v8, 134, v8
  v_max_i32 v8, 0, v8
  v_cvt_u32_f32 v7, v7
  v_lshrrev_b32 v7, v8, v7
  v_lshl_add_u32 v7, v8, 8, v7
  v_lshl_add_u32 v212, v7, 2, s18
  v_subrev_u32 v6, 13, v5
  v_max_i32 v7, 0, v6
  v_cvt_f32_u32 v7, v7
  v_cvt_pk_bf16_f32 v8, v7, v7
  v_and_b32 v7, 0xffff0000, v8
  v_lshrrev_b32 v8, 23, v7
  v_subrev_u32 v8, 134, v8
  v_max_i32 v8, 0, v8
  v_cvt_u32_f32 v7, v7
  v_lshrrev_b32 v7, v8, v7
  v_lshl_add_u32 v7, v8, 8, v7
  v_lshl_add_u32 v213, v7, 2, s18
  v_subrev_u32 v6, 14, v5
  v_max_i32 v7, 0, v6
  v_cvt_f32_u32 v7, v7
  v_cvt_pk_bf16_f32 v8, v7, v7
  v_and_b32 v7, 0xffff0000, v8
  v_lshrrev_b32 v8, 23, v7
  v_subrev_u32 v8, 134, v8
  v_max_i32 v8, 0, v8
  v_cvt_u32_f32 v7, v7
  v_lshrrev_b32 v7, v8, v7
  v_lshl_add_u32 v7, v8, 8, v7
  v_lshl_add_u32 v214, v7, 2, s18
  v_subrev_u32 v6, 15, v5
  v_max_i32 v7, 0, v6
  v_cvt_f32_u32 v7, v7
  v_cvt_pk_bf16_f32 v8, v7, v7
  v_and_b32 v7, 0xffff0000, v8
  v_lshrrev_b32 v8, 23, v7
  v_subrev_u32 v8, 134, v8
  v_max_i32 v8, 0, v8
  v_cvt_u32_f32 v7, v7
  v_lshrrev_b32 v7, v8, v7
  v_lshl_add_u32 v7, v8, 8, v7
  v_lshl_add_u32 v215, v7, 2, s18
  v_subrev_u32 v6, 16, v5
  v_max_i32 v7, 0, v6
  v_cvt_f32_u32 v7, v7
  v_cvt_pk_bf16_f32 v8, v7, v7
  v_and_b32 v7, 0xffff0000, v8
  v_lshrrev_b32 v8, 23, v7
  v_subrev_u32 v8, 134, v8
  v_max_i32 v8, 0, v8
  v_cvt_u32_f32 v7, v7
  v_lshrrev_b32 v7, v8, v7
  v_lshl_add_u32 v7, v8, 8, v7
  v_lshl_add_u32 v216, v7, 2, s18
  v_subrev_u32 v6, 17, v5
  v_max_i32 v7, 0, v6
  v_cvt_f32_u32 v7, v7
  v_cvt_pk_bf16_f32 v8, v7, v7
  v_and_b32 v7, 0xffff0000, v8
  v_lshrrev_b32 v8, 23, v7
  v_subrev_u32 v8, 134, v8
  v_max_i32 v8, 0, v8
  v_cvt_u32_f32 v7, v7
  v_lshrrev_b32 v7, v8, v7
  v_lshl_add_u32 v7, v8, 8, v7
  v_lshl_add_u32 v217, v7, 2, s18
  v_subrev_u32 v6, 18, v5
  v_max_i32 v7, 0, v6
  v_cvt_f32_u32 v7, v7
  v_cvt_pk_bf16_f32 v8, v7, v7
  v_and_b32 v7, 0xffff0000, v8
  v_lshrrev_b32 v8, 23, v7
  v_subrev_u32 v8, 134, v8
  v_max_i32 v8, 0, v8
  v_cvt_u32_f32 v7, v7
  v_lshrrev_b32 v7, v8, v7
  v_lshl_add_u32 v7, v8, 8, v7
  v_lshl_add_u32 v218, v7, 2, s18
  v_subrev_u32 v6, 19, v5
  v_max_i32 v7, 0, v6
  v_cvt_f32_u32 v7, v7
  v_cvt_pk_bf16_f32 v8, v7, v7
  v_and_b32 v7, 0xffff0000, v8
  v_lshrrev_b32 v8, 23, v7
  v_subrev_u32 v8, 134, v8
  v_max_i32 v8, 0, v8
  v_cvt_u32_f32 v7, v7
  v_lshrrev_b32 v7, v8, v7
  v_lshl_add_u32 v7, v8, 8, v7
  v_lshl_add_u32 v219, v7, 2, s18
  v_subrev_u32 v6, 20, v5
  v_max_i32 v7, 0, v6
  v_cvt_f32_u32 v7, v7
  v_cvt_pk_bf16_f32 v8, v7, v7
  v_and_b32 v7, 0xffff0000, v8
  v_lshrrev_b32 v8, 23, v7
  v_subrev_u32 v8, 134, v8
  v_max_i32 v8, 0, v8
  v_cvt_u32_f32 v7, v7
  v_lshrrev_b32 v7, v8, v7
  v_lshl_add_u32 v7, v8, 8, v7
  v_lshl_add_u32 v220, v7, 2, s18
  v_subrev_u32 v6, 21, v5
  v_max_i32 v7, 0, v6
  v_cvt_f32_u32 v7, v7
  v_cvt_pk_bf16_f32 v8, v7, v7
  v_and_b32 v7, 0xffff0000, v8
  v_lshrrev_b32 v8, 23, v7
  v_subrev_u32 v8, 134, v8
  v_max_i32 v8, 0, v8
  v_cvt_u32_f32 v7, v7
  v_lshrrev_b32 v7, v8, v7
  v_lshl_add_u32 v7, v8, 8, v7
  v_lshl_add_u32 v221, v7, 2, s18
  v_subrev_u32 v6, 22, v5
  v_max_i32 v7, 0, v6
  v_cvt_f32_u32 v7, v7
  v_cvt_pk_bf16_f32 v8, v7, v7
  v_and_b32 v7, 0xffff0000, v8
  v_lshrrev_b32 v8, 23, v7
  v_subrev_u32 v8, 134, v8
  v_max_i32 v8, 0, v8
  v_cvt_u32_f32 v7, v7
  v_lshrrev_b32 v7, v8, v7
  v_lshl_add_u32 v7, v8, 8, v7
  v_lshl_add_u32 v222, v7, 2, s18
  v_subrev_u32 v6, 23, v5
  v_max_i32 v7, 0, v6
  v_cvt_f32_u32 v7, v7
  v_cvt_pk_bf16_f32 v8, v7, v7
  v_and_b32 v7, 0xffff0000, v8
  v_lshrrev_b32 v8, 23, v7
  v_subrev_u32 v8, 134, v8
  v_max_i32 v8, 0, v8
  v_cvt_u32_f32 v7, v7
  v_lshrrev_b32 v7, v8, v7
  v_lshl_add_u32 v7, v8, 8, v7
  v_lshl_add_u32 v223, v7, 2, s18
  v_subrev_u32 v6, 24, v5
  v_max_i32 v7, 0, v6
  v_cvt_f32_u32 v7, v7
  v_cvt_pk_bf16_f32 v8, v7, v7
  v_and_b32 v7, 0xffff0000, v8
  v_lshrrev_b32 v8, 23, v7
  v_subrev_u32 v8, 134, v8
  v_max_i32 v8, 0, v8
  v_cvt_u32_f32 v7, v7
  v_lshrrev_b32 v7, v8, v7
  v_lshl_add_u32 v7, v8, 8, v7
  v_lshl_add_u32 v224, v7, 2, s18
  v_subrev_u32 v6, 25, v5
  v_max_i32 v7, 0, v6
  v_cvt_f32_u32 v7, v7
  v_cvt_pk_bf16_f32 v8, v7, v7
  v_and_b32 v7, 0xffff0000, v8
  v_lshrrev_b32 v8, 23, v7
  v_subrev_u32 v8, 134, v8
  v_max_i32 v8, 0, v8
  v_cvt_u32_f32 v7, v7
  v_lshrrev_b32 v7, v8, v7
  v_lshl_add_u32 v7, v8, 8, v7
  v_lshl_add_u32 v225, v7, 2, s18
  v_subrev_u32 v6, 26, v5
  v_max_i32 v7, 0, v6
  v_cvt_f32_u32 v7, v7
  v_cvt_pk_bf16_f32 v8, v7, v7
  v_and_b32 v7, 0xffff0000, v8
  v_lshrrev_b32 v8, 23, v7
  v_subrev_u32 v8, 134, v8
  v_max_i32 v8, 0, v8
  v_cvt_u32_f32 v7, v7
  v_lshrrev_b32 v7, v8, v7
  v_lshl_add_u32 v7, v8, 8, v7
  v_lshl_add_u32 v226, v7, 2, s18
  v_subrev_u32 v6, 27, v5
  v_max_i32 v7, 0, v6
  v_cvt_f32_u32 v7, v7
  v_cvt_pk_bf16_f32 v8, v7, v7
  v_and_b32 v7, 0xffff0000, v8
  v_lshrrev_b32 v8, 23, v7
  v_subrev_u32 v8, 134, v8
  v_max_i32 v8, 0, v8
  v_cvt_u32_f32 v7, v7
  v_lshrrev_b32 v7, v8, v7
  v_lshl_add_u32 v7, v8, 8, v7
  v_lshl_add_u32 v227, v7, 2, s18
  v_subrev_u32 v6, 28, v5
  v_max_i32 v7, 0, v6
  v_cvt_f32_u32 v7, v7
  v_cvt_pk_bf16_f32 v8, v7, v7
  v_and_b32 v7, 0xffff0000, v8
  v_lshrrev_b32 v8, 23, v7
  v_subrev_u32 v8, 134, v8
  v_max_i32 v8, 0, v8
  v_cvt_u32_f32 v7, v7
  v_lshrrev_b32 v7, v8, v7
  v_lshl_add_u32 v7, v8, 8, v7
  v_lshl_add_u32 v228, v7, 2, s18
  v_subrev_u32 v6, 29, v5
  v_max_i32 v7, 0, v6
  v_cvt_f32_u32 v7, v7
  v_cvt_pk_bf16_f32 v8, v7, v7
  v_and_b32 v7, 0xffff0000, v8
  v_lshrrev_b32 v8, 23, v7
  v_subrev_u32 v8, 134, v8
  v_max_i32 v8, 0, v8
  v_cvt_u32_f32 v7, v7
  v_lshrrev_b32 v7, v8, v7
  v_lshl_add_u32 v7, v8, 8, v7
  v_lshl_add_u32 v229, v7, 2, s18
  v_subrev_u32 v6, 30, v5
  v_max_i32 v7, 0, v6
  v_cvt_f32_u32 v7, v7
  v_cvt_pk_bf16_f32 v8, v7, v7
  v_and_b32 v7, 0xffff0000, v8
  v_lshrrev_b32 v8, 23, v7
  v_subrev_u32 v8, 134, v8
  v_max_i32 v8, 0, v8
  v_cvt_u32_f32 v7, v7
  v_lshrrev_b32 v7, v8, v7
  v_lshl_add_u32 v7, v8, 8, v7
  v_lshl_add_u32 v230, v7, 2, s18
  v_subrev_u32 v6, 31, v5
  v_max_i32 v7, 0, v6
  v_cvt_f32_u32 v7, v7
  v_cvt_pk_bf16_f32 v8, v7, v7
  v_and_b32 v7, 0xffff0000, v8
  v_lshrrev_b32 v8, 23, v7
  v_subrev_u32 v8, 134, v8
  v_max_i32 v8, 0, v8
  v_cvt_u32_f32 v7, v7
  v_lshrrev_b32 v7, v8, v7
  v_lshl_add_u32 v7, v8, 8, v7
  v_lshl_add_u32 v231, v7, 2, s18
  v_subrev_u32 v6, 32, v5
  v_max_i32 v7, 0, v6
  v_cvt_f32_u32 v7, v7
  v_cvt_pk_bf16_f32 v8, v7, v7
  v_and_b32 v7, 0xffff0000, v8
  v_lshrrev_b32 v8, 23, v7
  v_subrev_u32 v8, 134, v8
  v_max_i32 v8, 0, v8
  v_cvt_u32_f32 v7, v7
  v_lshrrev_b32 v7, v8, v7
  v_lshl_add_u32 v7, v8, 8, v7
  v_mov_b32 v8, 1280
  v_cmp_gt_i32 vcc, 0, v6
  s_nop 1
  v_cndmask_b32 v7, v7, v8, vcc
  v_lshl_add_u32 v232, v7, 2, s18
  v_mov_b32 v8, 0
  v_mov_b32 v9, 0
  v_lshlrev_b32 v5, 3, v1
  v_add_u32 v5, s17, v5
  ds_write_b64 v5, v[8:9]
  v_and_b32 v6, 15, v1
  v_lshlrev_b32 v6, 3, v6
  v_add_u32 v6, s17, v6
  ds_write_b64 v6, v[8:9] offset:8704
  ds_write_b64 v6, v[8:9] offset:12928
  v_mov_b32 v6, s17
  ds_write_b64 v6, v[8:9] offset:18176
  s_lshl_b32 s19, s3, 2
  s_add_u32 s20, s19, s16
  s_lshl_b32 s21, s3, 3
  v_mul_u32_u24 v5, 3584, v0
  v_mul_u32_u24 v141, 1792, v0
  s_lshl_b32 s22, s20, 9
  v_lshlrev_b32 v6, 3, v1
  buffer_load_dwordx2 v[24:25], v6, s[64:67], s22 offen
  buffer_load_dwordx2 v[26:27], v6, s[68:71], s22 offen
  buffer_load_dwordx2 v[28:29], v6, s[72:75], s22 offen
  buffer_load_dwordx2 v[30:31], v6, s[76:79], s22 offen
  s_lshl_b32 s22, s20, 1
  v_mov_b32 v7, 0
  buffer_load_ushort v32, v7, s[80:83], s22 offen
  buffer_load_ushort v33, v7, s[84:87], s22 offen
  s_mov_b32 s24, 0x05040100
  s_mov_b32 s25, 0x07060302
  s_barrier
  s_waitcnt vmcnt(0)
  s_mov_b32 s26, 1069066811
  s_mov_b32 s27, 1042479491
  v_lshlrev_b32 v32, 16, v32
  v_lshlrev_b32 v33, 16, v33
  v_mul_f32 v32, s26, v32
  v_exp_f32 v32, v32
  s_nop 0
  v_cvt_pk_bf16_f32 v34, v32, v32
  v_and_b32 v32, 0xffff0000, v34
  v_lshlrev_b32 v37, 6, v1
  v_add_u32 v37, s17, v37
  v_lshlrev_b32 v40, 16, v24
  v_lshlrev_b32 v41, 16, v26
  v_lshlrev_b32 v42, 16, v28
  v_lshlrev_b32 v43, 16, v30
  v_mul_f32 v40, s26, v40
  v_exp_f32 v40, v40
  s_nop 0
  v_cvt_pk_bf16_f32 v34, v40, v40
  v_and_b32 v40, 0xffff0000, v34
  v_mul_f32 v40, v40, v32
  v_mul_f32 v40, s26, v40
  v_sub_f32 v40, 0, v40
  v_mul_f32 v41, v41, v32
  v_mul_f32 v41, s27, v41
  v_mul_f32 v42, v42, v32
  v_mul_f32 v43, v43, v32
  v_add_f32 v42, v42, v42
  v_add_f32 v43, v43, v43
  ds_write_b128 v37, v[40:43] offset:18240
  v_and_b32 v40, 0xffff0000, v24
  v_and_b32 v41, 0xffff0000, v26
  v_and_b32 v42, 0xffff0000, v28
  v_and_b32 v43, 0xffff0000, v30
  v_mul_f32 v40, s26, v40
  v_exp_f32 v40, v40
  s_nop 0
  v_cvt_pk_bf16_f32 v34, v40, v40
  v_and_b32 v40, 0xffff0000, v34
  v_mul_f32 v40, v40, v32
  v_mul_f32 v40, s26, v40
  v_sub_f32 v40, 0, v40
  v_mul_f32 v41, v41, v32
  v_mul_f32 v41, s27, v41
  v_mul_f32 v42, v42, v32
  v_mul_f32 v43, v43, v32
  v_add_f32 v42, v42, v42
  v_add_f32 v43, v43, v43
  ds_write_b128 v37, v[40:43] offset:18256
  v_lshlrev_b32 v40, 16, v25
  v_lshlrev_b32 v41, 16, v27
  v_lshlrev_b32 v42, 16, v29
  v_lshlrev_b32 v43, 16, v31
  v_mul_f32 v40, s26, v40
  v_exp_f32 v40, v40
  s_nop 0
  v_cvt_pk_bf16_f32 v34, v40, v40
  v_and_b32 v40, 0xffff0000, v34
  v_mul_f32 v40, v40, v32
  v_mul_f32 v40, s26, v40
  v_sub_f32 v40, 0, v40
  v_mul_f32 v41, v41, v32
  v_mul_f32 v41, s27, v41
  v_mul_f32 v42, v42, v32
  v_mul_f32 v43, v43, v32
  v_add_f32 v42, v42, v42
  v_add_f32 v43, v43, v43
  ds_write_b128 v37, v[40:43] offset:18272
  v_and_b32 v40, 0xffff0000, v25
  v_and_b32 v41, 0xffff0000, v27
  v_and_b32 v42, 0xffff0000, v29
  v_and_b32 v43, 0xffff0000, v31
  v_mul_f32 v40, s26, v40
  v_exp_f32 v40, v40
  s_nop 0
  v_cvt_pk_bf16_f32 v34, v40, v40
  v_and_b32 v40, 0xffff0000, v34
  v_mul_f32 v40, v40, v32
  v_mul_f32 v40, s26, v40
  v_sub_f32 v40, 0, v40
  v_mul_f32 v41, v41, v32
  v_mul_f32 v41, s27, v41
  v_mul_f32 v42, v42, v32
  v_mul_f32 v43, v43, v32
  v_add_f32 v42, v42, v42
  v_add_f32 v43, v43, v43
  ds_write_b128 v37, v[40:43] offset:18288
  v_cvt_f32_u32 v44, v4
  v_lshlrev_b32 v45, 4, v4
  v_cvt_f32_u32 v45, v45
  v_lshlrev_b32 v46, 4, v3
  v_add_u32 v46, s17, v46
  v_mov_b32 v48, 0
  v_mov_b32 v49, 0
  v_mov_b32 v50, 0
  v_mov_b32 v51, 0
  v_mov_b32 v52, 0
  v_mov_b32 v53, 0
  v_mov_b32 v54, 0
  v_mov_b32 v55, 0
  v_mov_b32 v56, 0
  v_mov_b32 v57, 0
  v_mov_b32 v58, 0
  v_mov_b32 v59, 0
  v_mov_b32 v60, 0
  v_mov_b32 v61, 0
  v_mov_b32 v62, 0
  v_mov_b32 v63, 0
  v_mov_b32 v64, 0
  v_mov_b32 v65, 0
  v_mov_b32 v66, 0
  v_mov_b32 v67, 0
  s_waitcnt lgkmcnt(0)
  ds_read_b128 v[68:71], v46 offset:18240
  s_add_u32 s22, s21, 0
  buffer_load_dwordx2 v[8:9], v5, s[60:63], s22 offen offset:0
  s_mov_b32 s28, 0
  s_call_b64 s[30:31], wk_kl
  s_mov_b32 s28, 0
  s_call_b64 s[30:31], wk_kl
  s_add_u32 s22, s21, 0
  buffer_load_dwordx2 v[10:11], v5, s[60:63], s22 offen offset:896
  s_mov_b32 s28, 0
  s_call_b64 s[30:31], wk_kl
  s_mov_b32 s28, 0
  s_call_b64 s[30:31], wk_kl
  s_add_u32 s22, s21, 0
  buffer_load_dwordx2 v[12:13], v5, s[60:63], s22 offen offset:1792
  s_mov_b32 s28, 0
  s_call_b64 s[30:31], wk_kl
  s_mov_b32 s28, 0
  s_call_b64 s[30:31], wk_kl
  s_add_u32 s22, s21, 0
  buffer_load_dwordx2 v[14:15], v5, s[60:63], s22 offen offset:2688
  s_mov_b32 s28, 0
  s_call_b64 s[30:31], wk_kl
  s_mov_b32 s28, 0
  s_call_b64 s[30:31], wk_kl
  s_add_u32 s22, s21, 917504
  buffer_load_dwordx2 v[16:17], v5, s[60:63], s22 offen offset:0
  s_mov_b32 s28, 0
  s_call_b64 s[30:31], wk_kl
  s_mov_b32 s28, 0
  s_call_b64 s[30:31], wk_kl
  s_add_u32 s22, s21, 917504
  buffer_load_dwordx2 v[18:19], v5, s[60:63], s22 offen offset:896
  s_mov_b32 s28, 0
  s_call_b64 s[30:31], wk_kl
  s_mov_b32 s28, 0
  s_call_b64 s[30:31], wk_kl
  s_add_u32 s22, s21, 917504
  buffer_load_dwordx2 v[20:21], v5, s[60:63], s22 offen offset:1792
  s_mov_b32 s28, 0
  s_call_b64 s[30:31], wk_kl
  s_mov_b32 s28, 0
  s_call_b64 s[30:31], wk_kl
  s_add_u32 s22, s21, 917504
  buffer_load_dwordx2 v[22:23], v5, s[60:63], s22 offen offset:2688
  s_mov_b32 s28, 0
  s_call_b64 s[30:31], wk_kl
  s_mov_b32 s28, 0
  s_call_b64 s[30:31], wk_kl
  s_branch wk_kd
wk_kl:
  s_waitcnt lgkmcnt(0)
  v_mov_b32 v72, v68
  v_mov_b32 v73, v69
  v_mov_b32 v74, v70
  v_mov_b32 v75, v71
  v_add_u32 v46, 64, v46
  ds_read_b128 v[68:71], v46 offset:18240
  v_mul_f32 v80, v72, v45
  v_mul_f32 v81, v73, v45
  v_exp_f32 v80, v80
  v_fract_f32 v81, v81
  v_cos_f32 v76, v81
  v_sin_f32 v77, v81
  v_mul_f32 v76, v76, v80
  v_mul_f32 v77, v77, v80
  v_mul_f32 v80, v72, v44
  v_mul_f32 v81, v73, v44
  v_exp_f32 v80, v80
  v_fract_f32 v81, v81
  v_cos_f32 v78, v81
  v_sin_f32 v79, v81
  v_mul_f32 v78, v78, v80
  v_mul_f32 v79, v79, v80
  v_mul_f32 v82, v74, v76
  v_mul_f32 v83, v74, v77
  v_fma_f32 v82, -v75, v77, v82
  v_fma_f32 v83, -v75, v76, -v83
  v_mul_f32 v86, v76, v76
  v_mul_f32 v87, v76, v77
  v_fma_f32 v86, -v77, v77, v86
  v_add_f32 v87, v87, v87
  v_mfma_f32_16x16x4_f32 v[48:51], v82, v78, v[48:51]
  v_mul_f32 v88, v78, v78
  v_mul_f32 v89, v78, v79
  v_fma_f32 v88, -v79, v79, v88
  v_add_f32 v89, v89, v89
  v_mfma_f32_16x16x4_f32 v[48:51], v83, v79, v[48:51]
  v_mul_f32 v84, v74, v86
  v_mul_f32 v85, v74, v87
  v_fma_f32 v84, -v75, v87, v84
  v_fma_f32 v85, -v75, v86, -v85
  v_mul_f32 v76, v86, v86
  v_mul_f32 v77, v86, v87
  v_fma_f32 v76, -v87, v87, v76
  v_add_f32 v77, v77, v77
  v_mfma_f32_16x16x4_f32 v[52:55], v84, v88, v[52:55]
  v_mul_f32 v78, v88, v88
  v_mul_f32 v79, v88, v89
  v_fma_f32 v78, -v89, v89, v78
  v_add_f32 v79, v79, v79
  v_mfma_f32_16x16x4_f32 v[52:55], v85, v89, v[52:55]
  v_mul_f32 v82, v74, v76
  v_mul_f32 v83, v74, v77
  v_fma_f32 v82, -v75, v77, v82
  v_fma_f32 v83, -v75, v76, -v83
  v_mul_f32 v86, v76, v76
  v_mul_f32 v87, v76, v77
  v_fma_f32 v86, -v77, v77, v86
  v_add_f32 v87, v87, v87
  v_mfma_f32_16x16x4_f32 v[56:59], v82, v78, v[56:59]
  v_mul_f32 v88, v78, v78
  v_mul_f32 v89, v78, v79
  v_fma_f32 v88, -v79, v79, v88
  v_add_f32 v89, v89, v89
  v_mfma_f32_16x16x4_f32 v[56:59], v83, v79, v[56:59]
  v_mul_f32 v84, v74, v86
  v_mul_f32 v85, v74, v87
  v_fma_f32 v84, -v75, v87, v84
  v_fma_f32 v85, -v75, v86, -v85
  v_mul_f32 v76, v86, v86
  v_mul_f32 v77, v86, v87
  v_fma_f32 v76, -v87, v87, v76
  v_add_f32 v77, v77, v77
  v_mfma_f32_16x16x4_f32 v[60:63], v84, v88, v[60:63]
  v_mfma_f32_16x16x4_f32 v[60:63], v85, v89, v[60:63]
  v_mul_f32 v82, v74, v76
  v_fma_f32 v82, -v75, v77, v82
  s_nop 1
  v_mfma_f32_16x16x4_f32 v[64:67], v82, v88, v[64:67]
  s_add_u32 s28, s28, 1
  s_cmp_lt_u32 s28, 4
  s_cbranch_scc1 wk_kl
  s_setpc_b64 s[30:31]
wk_kd:
  s_nop 15
  s_nop 3
  s_waitcnt vmcnt(0)
  v_lshlrev_b32 v6, 3, v0
  v_perm_b32 v34, v10, v8, s24
  v_perm_b32 v35, v14, v12, s24
  v_add_u32 v36, 512, v6
  ds_write_b64 v36, v[34:35]
  v_perm_b32 v34, v10, v8, s25
  v_perm_b32 v35, v14, v12, s25
  v_add_u32 v36, 25088, v6
  ds_write_b64 v36, v[34:35]
  v_perm_b32 v34, v11, v9, s24
  v_perm_b32 v35, v15, v13, s24
  v_add_u32 v36, 49664, v6
  ds_write_b64 v36, v[34:35]
  v_perm_b32 v34, v11, v9, s25
  v_perm_b32 v35, v15, v13, s25
  v_add_u32 v36, 74240, v6
  ds_write_b64 v36, v[34:35]
  v_perm_b32 v34, v18, v16, s24
  v_perm_b32 v35, v22, v20, s24
  v_add_u32 v36, 2560, v6
  ds_write_b64 v36, v[34:35]
  v_perm_b32 v34, v18, v16, s25
  v_perm_b32 v35, v22, v20, s25
  v_add_u32 v36, 27136, v6
  ds_write_b64 v36, v[34:35]
  v_perm_b32 v34, v19, v17, s24
  v_perm_b32 v35, v23, v21, s24
  v_add_u32 v36, 51712, v6
  ds_write_b64 v36, v[34:35]
  v_perm_b32 v34, v19, v17, s25
  v_perm_b32 v35, v23, v21, s25
  v_add_u32 v36, 76288, v6
  ds_write_b64 v36, v[34:35]
  v_lshlrev_b32 v46, 8, v3
  v_lshl_add_u32 v46, v4, 2, v46
  v_add_u32 v46, s17, v46
  ds_write_b32 v46, v48 offset:13056
  ds_write_b32 v46, v49 offset:13120
  ds_write_b32 v46, v50 offset:13184
  ds_write_b32 v46, v51 offset:13248
  s_waitcnt lgkmcnt(8)
  ds_write_b32 v46, v52 offset:14080
  ds_write_b32 v46, v53 offset:14144
  ds_write_b32 v46, v54 offset:14208
  ds_write_b32 v46, v55 offset:14272
  s_waitcnt lgkmcnt(8)
  ds_write_b32 v46, v56 offset:15104
  ds_write_b32 v46, v57 offset:15168
  ds_write_b32 v46, v58 offset:15232
  ds_write_b32 v46, v59 offset:15296
  s_waitcnt lgkmcnt(8)
  ds_write_b32 v46, v60 offset:16128
  ds_write_b32 v46, v61 offset:16192
  ds_write_b32 v46, v62 offset:16256
  ds_write_b32 v46, v63 offset:16320
  s_waitcnt lgkmcnt(8)
  ds_write_b32 v46, v64 offset:17152
  ds_write_b32 v46, v65 offset:17216
  ds_write_b32 v46, v66 offset:17280
  ds_write_b32 v46, v67 offset:17344
  s_waitcnt lgkmcnt(8)
  s_waitcnt lgkmcnt(0)
  ds_read_b32 v48, v200
  ds_read_b32 v49, v201
  ds_read_b32 v50, v202
  ds_read_b32 v51, v203
  ds_read_b32 v52, v204
  ds_read_b32 v53, v205
  ds_read_b32 v54, v206
  ds_read_b32 v55, v207
  s_waitcnt lgkmcnt(4)
  ds_read_b32 v56, v208
  ds_read_b32 v57, v209
  ds_read_b32 v58, v210
  ds_read_b32 v59, v211
  ds_read_b32 v60, v212
  ds_read_b32 v61, v213
  ds_read_b32 v62, v214
  ds_read_b32 v63, v215
  s_waitcnt lgkmcnt(4)
  ds_read_b32 v64, v216
  ds_read_b32 v65, v217
  ds_read_b32 v66, v218
  ds_read_b32 v67, v219
  ds_read_b32 v68, v220
  ds_read_b32 v69, v221
  ds_read_b32 v70, v222
  ds_read_b32 v71, v223
  s_waitcnt lgkmcnt(4)
  ds_read_b32 v72, v224
  ds_read_b32 v73, v225
  ds_read_b32 v74, v226
  ds_read_b32 v75, v227
  ds_read_b32 v76, v228
  ds_read_b32 v77, v229
  ds_read_b32 v78, v230
  ds_read_b32 v79, v231
  s_waitcnt lgkmcnt(4)
  ds_read_b32 v80, v232
  s_waitcnt lgkmcnt(0)
  v_lshlrev_b32 v46, 6, v1
  v_add_u32 v46, s17, v46
  v_cvt_pk_bf16_f32 v84, v48, v49
  v_cvt_pk_bf16_f32 v88, v49, v50
  v_cvt_pk_bf16_f32 v85, v50, v51
  v_cvt_pk_bf16_f32 v89, v51, v52
  v_cvt_pk_bf16_f32 v86, v52, v53
  v_cvt_pk_bf16_f32 v90, v53, v54
  v_cvt_pk_bf16_f32 v87, v54, v55
  v_cvt_pk_bf16_f32 v91, v55, v56
  ds_write_b128 v46, v[84:87] offset:4608
  ds_write_b128 v46, v[88:91] offset:8832
  s_waitcnt lgkmcnt(0)
  v_cvt_pk_bf16_f32 v84, v56, v57
  v_cvt_pk_bf16_f32 v88, v57, v58
  v_cvt_pk_bf16_f32 v85, v58, v59
  v_cvt_pk_bf16_f32 v89, v59, v60
  v_cvt_pk_bf16_f32 v86, v60, v61
  v_cvt_pk_bf16_f32 v90, v61, v62
  v_cvt_pk_bf16_f32 v87, v62, v63
  v_cvt_pk_bf16_f32 v91, v63, v64
  ds_write_b128 v46, v[84:87] offset:4624
  ds_write_b128 v46, v[88:91] offset:8848
  s_waitcnt lgkmcnt(0)
  v_cvt_pk_bf16_f32 v84, v64, v65
  v_cvt_pk_bf16_f32 v88, v65, v66
  v_cvt_pk_bf16_f32 v85, v66, v67
  v_cvt_pk_bf16_f32 v89, v67, v68
  v_cvt_pk_bf16_f32 v86, v68, v69
  v_cvt_pk_bf16_f32 v90, v69, v70
  v_cvt_pk_bf16_f32 v87, v70, v71
  v_cvt_pk_bf16_f32 v91, v71, v72
  ds_write_b128 v46, v[84:87] offset:4640
  ds_write_b128 v46, v[88:91] offset:8864
  s_waitcnt lgkmcnt(0)
  v_cvt_pk_bf16_f32 v84, v72, v73
  v_cvt_pk_bf16_f32 v88, v73, v74
  v_cvt_pk_bf16_f32 v85, v74, v75
  v_cvt_pk_bf16_f32 v89, v75, v76
  v_cvt_pk_bf16_f32 v86, v76, v77
  v_cvt_pk_bf16_f32 v90, v77, v78
  v_cvt_pk_bf16_f32 v87, v78, v79
  v_cvt_pk_bf16_f32 v91, v79, v80
  ds_write_b128 v46, v[84:87] offset:4656
  ds_write_b128 v46, v[88:91] offset:8880
  s_waitcnt lgkmcnt(0)
  s_barrier
  v_lshrrev_b32 v47, 1, v3
  v_sub_u32 v46, v4, v47
  v_add_u32 v46, 1, v46
  v_lshlrev_b32 v46, 5, v46
  v_and_b32 v48, 1, v3
  v_lshl_add_u32 v46, v48, 4, v46
  v_add_u32 v46, s17, v46
  ds_read_b128 a[0:3], v46 offset:32
  ds_read_b128 a[4:7], v46 offset:96
  ds_read_b128 a[8:11], v46 offset:160
  ds_read_b128 a[12:15], v46 offset:224
  ds_read_b128 a[16:19], v46 offset:288
  ds_read_b128 a[20:23], v46 offset:352
  ds_read_b128 a[24:27], v46 offset:416
  ds_read_b128 a[28:31], v46 offset:480
  s_waitcnt lgkmcnt(4)
  ds_read_b128 a[32:35], v46 offset:544
  ds_read_b128 a[36:39], v46 offset:608
  ds_read_b128 a[40:43], v46 offset:672
  ds_read_b128 a[44:47], v46 offset:736
  ds_read_b128 a[48:51], v46 offset:800
  ds_read_b128 a[52:55], v46 offset:864
  ds_read_b128 a[56:59], v46 offset:928
  ds_read_b128 a[60:63], v46 offset:992
  s_waitcnt lgkmcnt(4)
  ds_read_b128 a[64:67], v46 offset:1056
  ds_read_b128 a[68:71], v46 offset:1120
  ds_read_b128 a[72:75], v46 offset:1184
  ds_read_b128 a[76:79], v46 offset:1248
  ds_read_b128 a[80:83], v46 offset:1312
  ds_read_b128 a[84:87], v46 offset:1376
  ds_read_b128 a[88:91], v46 offset:1440
  ds_read_b128 a[92:95], v46 offset:1504
  s_waitcnt lgkmcnt(4)
  ds_read_b128 a[96:99], v46 offset:1568
  ds_read_b128 a[100:103], v46 offset:1632
  ds_read_b128 a[104:107], v46 offset:1696
  ds_read_b128 a[108:111], v46 offset:1760
  ds_read_b128 a[112:115], v46 offset:1824
  ds_read_b128 a[116:119], v46 offset:1888
  ds_read_b128 a[120:123], v46 offset:1952
  ds_read_b128 a[124:127], v46 offset:2016
  s_waitcnt lgkmcnt(4)
  ds_read_b128 a[128:131], v46 offset:2080
  ds_read_b128 a[132:135], v46 offset:2144
  ds_read_b128 a[136:139], v46 offset:2208
  ds_read_b128 a[140:143], v46 offset:2272
  ds_read_b128 a[144:147], v46 offset:2336
  ds_read_b128 a[148:151], v46 offset:2400
  ds_read_b128 a[152:155], v46 offset:2464
  ds_read_b128 a[156:159], v46 offset:2528
  s_waitcnt lgkmcnt(4)
  ds_read_b128 a[160:163], v46 offset:2592
  ds_read_b128 a[164:167], v46 offset:2656
  ds_read_b128 a[168:171], v46 offset:2720
  ds_read_b128 a[172:175], v46 offset:2784
  ds_read_b128 a[176:179], v46 offset:2848
  ds_read_b128 a[180:183], v46 offset:2912
  ds_read_b128 a[184:187], v46 offset:2976
  ds_read_b128 a[188:191], v46 offset:3040
  s_waitcnt lgkmcnt(4)
  ds_read_b128 a[192:195], v46 offset:3104
  ds_read_b128 a[196:199], v46 offset:3168
  ds_read_b128 a[200:203], v46 offset:3232
  ds_read_b128 a[204:207], v46 offset:3296
  ds_read_b128 a[208:211], v46 offset:3360
  ds_read_b128 a[212:215], v46 offset:3424
  ds_read_b128 a[216:219], v46 offset:3488
  ds_read_b128 a[220:223], v46 offset:3552
  s_waitcnt lgkmcnt(4)
  ds_read_b128 a[224:227], v46 offset:3616
  ds_read_b128 a[228:231], v46 offset:3680
  ds_read_b128 a[232:235], v46 offset:3744
  ds_read_b128 a[236:239], v46 offset:3808
  ds_read_b128 a[240:243], v46 offset:3872
  ds_read_b128 a[244:247], v46 offset:3936
  ds_read_b128 a[248:251], v46 offset:4000
  ds_read_b128 a[252:255], v46 offset:4064
  s_waitcnt lgkmcnt(4)
  v_lshlrev_b32 v49, 4, v47
  v_add_u32 v49, v49, v4
  v_sub_u32 v49, 2047, v49
  v_lshl_add_u32 v49, v48, 3, v49
  v_and_b32 v50, 1, v49
  v_lshrrev_b32 v49, 1, v49
  v_lshlrev_b32 v49, 2, v49
  v_mul_u32_u24 v50, 4224, v50
  v_add3_u32 v49, v49, v50, s17
  v_add_u32 v49, 4608, v49
  v_subrev_u32 v52, 896, v49
  v_subrev_u32 v53, 1856, v49
  v_subrev_u32 v54, 2816, v49
  v_subrev_u32 v55, 3776, v49
  v_subrev_u32 v56, 4736, v49
  s_waitcnt lgkmcnt(0)
  ds_read2_b32 v[92:93], v52 offset0:224 offset1:225
  ds_read2_b32 v[94:95], v52 offset0:226 offset1:227
  ds_read2_b32 v[96:97], v52 offset0:208 offset1:209
  ds_read2_b32 v[98:99], v52 offset0:210 offset1:211
  ds_read2_b32 v[100:101], v52 offset0:192 offset1:193
  ds_read2_b32 v[102:103], v52 offset0:194 offset1:195
  ds_read2_b32 v[104:105], v52 offset0:176 offset1:177
  ds_read2_b32 v[106:107], v52 offset0:178 offset1:179
  s_waitcnt lgkmcnt(6)
  v_mfma_f32_16x16x32_bf16 v[60:63], v[92:95], a[28:31], 0
  v_mfma_f32_16x16x32_bf16 v[64:67], v[92:95], a[60:63], 0
  v_mfma_f32_16x16x32_bf16 v[68:71], v[92:95], a[92:95], 0
  v_mfma_f32_16x16x32_bf16 v[72:75], v[92:95], a[124:127], 0
  v_mfma_f32_16x16x32_bf16 v[76:79], v[92:95], a[156:159], 0
  v_mfma_f32_16x16x32_bf16 v[80:83], v[92:95], a[188:191], 0
  v_mfma_f32_16x16x32_bf16 v[84:87], v[92:95], a[220:223], 0
  v_mfma_f32_16x16x32_bf16 v[88:91], v[92:95], a[252:255], 0
  ds_read2_b32 v[92:93], v52 offset0:160 offset1:161
  ds_read2_b32 v[94:95], v52 offset0:162 offset1:163
  s_waitcnt lgkmcnt(6)
  v_mfma_f32_16x16x32_bf16 v[60:63], v[96:99], a[24:27], v[60:63]
  v_mfma_f32_16x16x32_bf16 v[64:67], v[96:99], a[56:59], v[64:67]
  v_mfma_f32_16x16x32_bf16 v[68:71], v[96:99], a[88:91], v[68:71]
  v_mfma_f32_16x16x32_bf16 v[72:75], v[96:99], a[120:123], v[72:75]
  v_mfma_f32_16x16x32_bf16 v[76:79], v[96:99], a[152:155], v[76:79]
  v_mfma_f32_16x16x32_bf16 v[80:83], v[96:99], a[184:187], v[80:83]
  v_mfma_f32_16x16x32_bf16 v[84:87], v[96:99], a[216:219], v[84:87]
  v_mfma_f32_16x16x32_bf16 v[88:91], v[96:99], a[248:251], v[88:91]
  ds_read2_b32 v[96:97], v52 offset0:144 offset1:145
  ds_read2_b32 v[98:99], v52 offset0:146 offset1:147
  s_waitcnt lgkmcnt(6)
  v_mfma_f32_16x16x32_bf16 v[60:63], v[100:103], a[20:23], v[60:63]
  v_mfma_f32_16x16x32_bf16 v[64:67], v[100:103], a[52:55], v[64:67]
  v_mfma_f32_16x16x32_bf16 v[68:71], v[100:103], a[84:87], v[68:71]
  v_mfma_f32_16x16x32_bf16 v[72:75], v[100:103], a[116:119], v[72:75]
  v_mfma_f32_16x16x32_bf16 v[76:79], v[100:103], a[148:151], v[76:79]
  v_mfma_f32_16x16x32_bf16 v[80:83], v[100:103], a[180:183], v[80:83]
  v_mfma_f32_16x16x32_bf16 v[84:87], v[100:103], a[212:215], v[84:87]
  v_mfma_f32_16x16x32_bf16 v[88:91], v[100:103], a[244:247], v[88:91]
  ds_read2_b32 v[100:101], v52 offset0:128 offset1:129
  ds_read2_b32 v[102:103], v52 offset0:130 offset1:131
  s_waitcnt lgkmcnt(6)
  v_mfma_f32_16x16x32_bf16 v[60:63], v[104:107], a[16:19], v[60:63]
  v_mfma_f32_16x16x32_bf16 v[64:67], v[104:107], a[48:51], v[64:67]
  v_mfma_f32_16x16x32_bf16 v[68:71], v[104:107], a[80:83], v[68:71]
  v_mfma_f32_16x16x32_bf16 v[72:75], v[104:107], a[112:115], v[72:75]
  v_mfma_f32_16x16x32_bf16 v[76:79], v[104:107], a[144:147], v[76:79]
  v_mfma_f32_16x16x32_bf16 v[80:83], v[104:107], a[176:179], v[80:83]
  v_mfma_f32_16x16x32_bf16 v[84:87], v[104:107], a[208:211], v[84:87]
  v_mfma_f32_16x16x32_bf16 v[88:91], v[104:107], a[240:243], v[88:91]
  ds_read2_b32 v[104:105], v52 offset0:112 offset1:113
  ds_read2_b32 v[106:107], v52 offset0:114 offset1:115
  s_waitcnt lgkmcnt(6)
  v_mfma_f32_16x16x32_bf16 v[60:63], v[92:95], a[12:15], v[60:63]
  v_mfma_f32_16x16x32_bf16 v[64:67], v[92:95], a[44:47], v[64:67]
  v_mfma_f32_16x16x32_bf16 v[68:71], v[92:95], a[76:79], v[68:71]
  v_mfma_f32_16x16x32_bf16 v[72:75], v[92:95], a[108:111], v[72:75]
  v_mfma_f32_16x16x32_bf16 v[76:79], v[92:95], a[140:143], v[76:79]
  v_mfma_f32_16x16x32_bf16 v[80:83], v[92:95], a[172:175], v[80:83]
  v_mfma_f32_16x16x32_bf16 v[84:87], v[92:95], a[204:207], v[84:87]
  v_mfma_f32_16x16x32_bf16 v[88:91], v[92:95], a[236:239], v[88:91]
  ds_read2_b32 v[92:93], v52 offset0:96 offset1:97
  ds_read2_b32 v[94:95], v52 offset0:98 offset1:99
  s_waitcnt lgkmcnt(6)
  v_mfma_f32_16x16x32_bf16 v[60:63], v[96:99], a[8:11], v[60:63]
  v_mfma_f32_16x16x32_bf16 v[64:67], v[96:99], a[40:43], v[64:67]
  v_mfma_f32_16x16x32_bf16 v[68:71], v[96:99], a[72:75], v[68:71]
  v_mfma_f32_16x16x32_bf16 v[72:75], v[96:99], a[104:107], v[72:75]
  v_mfma_f32_16x16x32_bf16 v[76:79], v[96:99], a[136:139], v[76:79]
  v_mfma_f32_16x16x32_bf16 v[80:83], v[96:99], a[168:171], v[80:83]
  v_mfma_f32_16x16x32_bf16 v[84:87], v[96:99], a[200:203], v[84:87]
  v_mfma_f32_16x16x32_bf16 v[88:91], v[96:99], a[232:235], v[88:91]
  ds_read2_b32 v[96:97], v52 offset0:80 offset1:81
  ds_read2_b32 v[98:99], v52 offset0:82 offset1:83
  s_waitcnt lgkmcnt(6)
  v_mfma_f32_16x16x32_bf16 v[60:63], v[100:103], a[4:7], v[60:63]
  v_mfma_f32_16x16x32_bf16 v[64:67], v[100:103], a[36:39], v[64:67]
  v_mfma_f32_16x16x32_bf16 v[68:71], v[100:103], a[68:71], v[68:71]
  v_mfma_f32_16x16x32_bf16 v[72:75], v[100:103], a[100:103], v[72:75]
  v_mfma_f32_16x16x32_bf16 v[76:79], v[100:103], a[132:135], v[76:79]
  v_mfma_f32_16x16x32_bf16 v[80:83], v[100:103], a[164:167], v[80:83]
  v_mfma_f32_16x16x32_bf16 v[84:87], v[100:103], a[196:199], v[84:87]
  v_mfma_f32_16x16x32_bf16 v[88:91], v[100:103], a[228:231], v[88:91]
  ds_read2_b32 v[100:101], v52 offset0:64 offset1:65
  ds_read2_b32 v[102:103], v52 offset0:66 offset1:67
  s_waitcnt lgkmcnt(6)
  v_mfma_f32_16x16x32_bf16 v[60:63], v[104:107], a[0:3], v[60:63]
  v_mfma_f32_16x16x32_bf16 v[64:67], v[104:107], a[32:35], v[64:67]
  v_mfma_f32_16x16x32_bf16 v[68:71], v[104:107], a[64:67], v[68:71]
  v_mfma_f32_16x16x32_bf16 v[72:75], v[104:107], a[96:99], v[72:75]
  v_mfma_f32_16x16x32_bf16 v[76:79], v[104:107], a[128:131], v[76:79]
  v_mfma_f32_16x16x32_bf16 v[80:83], v[104:107], a[160:163], v[80:83]
  v_mfma_f32_16x16x32_bf16 v[84:87], v[104:107], a[192:195], v[84:87]
  v_mfma_f32_16x16x32_bf16 v[88:91], v[104:107], a[224:227], v[88:91]
  ds_read2_b32 v[104:105], v52 offset0:48 offset1:49
  ds_read2_b32 v[106:107], v52 offset0:50 offset1:51
  s_waitcnt lgkmcnt(6)
  v_mfma_f32_16x16x32_bf16 v[64:67], v[92:95], a[28:31], v[64:67]
  v_mfma_f32_16x16x32_bf16 v[68:71], v[92:95], a[60:63], v[68:71]
  v_mfma_f32_16x16x32_bf16 v[72:75], v[92:95], a[92:95], v[72:75]
  v_mfma_f32_16x16x32_bf16 v[76:79], v[92:95], a[124:127], v[76:79]
  v_mfma_f32_16x16x32_bf16 v[80:83], v[92:95], a[156:159], v[80:83]
  v_mfma_f32_16x16x32_bf16 v[84:87], v[92:95], a[188:191], v[84:87]
  v_mfma_f32_16x16x32_bf16 v[88:91], v[92:95], a[220:223], v[88:91]
  ds_read2_b32 v[92:93], v52 offset0:32 offset1:33
  ds_read2_b32 v[94:95], v52 offset0:34 offset1:35
  s_waitcnt lgkmcnt(6)
  v_mfma_f32_16x16x32_bf16 v[64:67], v[96:99], a[24:27], v[64:67]
  v_mfma_f32_16x16x32_bf16 v[68:71], v[96:99], a[56:59], v[68:71]
  v_mfma_f32_16x16x32_bf16 v[72:75], v[96:99], a[88:91], v[72:75]
  v_mfma_f32_16x16x32_bf16 v[76:79], v[96:99], a[120:123], v[76:79]
  v_mfma_f32_16x16x32_bf16 v[80:83], v[96:99], a[152:155], v[80:83]
  v_mfma_f32_16x16x32_bf16 v[84:87], v[96:99], a[184:187], v[84:87]
  v_mfma_f32_16x16x32_bf16 v[88:91], v[96:99], a[216:219], v[88:91]
  ds_read2_b32 v[96:97], v52 offset0:16 offset1:17
  ds_read2_b32 v[98:99], v52 offset0:18 offset1:19
  s_waitcnt lgkmcnt(6)
  v_mfma_f32_16x16x32_bf16 v[64:67], v[100:103], a[20:23], v[64:67]
  v_mfma_f32_16x16x32_bf16 v[68:71], v[100:103], a[52:55], v[68:71]
  v_mfma_f32_16x16x32_bf16 v[72:75], v[100:103], a[84:87], v[72:75]
  v_mfma_f32_16x16x32_bf16 v[76:79], v[100:103], a[116:119], v[76:79]
  v_mfma_f32_16x16x32_bf16 v[80:83], v[100:103], a[148:151], v[80:83]
  v_mfma_f32_16x16x32_bf16 v[84:87], v[100:103], a[180:183], v[84:87]
  v_mfma_f32_16x16x32_bf16 v[88:91], v[100:103], a[212:215], v[88:91]
  ds_read2_b32 v[100:101], v52 offset0:0 offset1:1
  ds_read2_b32 v[102:103], v52 offset0:2 offset1:3
  s_waitcnt lgkmcnt(6)
  v_mfma_f32_16x16x32_bf16 v[64:67], v[104:107], a[16:19], v[64:67]
  v_mfma_f32_16x16x32_bf16 v[68:71], v[104:107], a[48:51], v[68:71]
  v_mfma_f32_16x16x32_bf16 v[72:75], v[104:107], a[80:83], v[72:75]
  v_mfma_f32_16x16x32_bf16 v[76:79], v[104:107], a[112:115], v[76:79]
  v_mfma_f32_16x16x32_bf16 v[80:83], v[104:107], a[144:147], v[80:83]
  v_mfma_f32_16x16x32_bf16 v[84:87], v[104:107], a[176:179], v[84:87]
  v_mfma_f32_16x16x32_bf16 v[88:91], v[104:107], a[208:211], v[88:91]
  ds_read2_b32 v[104:105], v53 offset0:224 offset1:225
  ds_read2_b32 v[106:107], v53 offset0:226 offset1:227
  s_waitcnt lgkmcnt(6)
  v_mfma_f32_16x16x32_bf16 v[64:67], v[92:95], a[12:15], v[64:67]
  v_mfma_f32_16x16x32_bf16 v[68:71], v[92:95], a[44:47], v[68:71]
  v_mfma_f32_16x16x32_bf16 v[72:75], v[92:95], a[76:79], v[72:75]
  v_mfma_f32_16x16x32_bf16 v[76:79], v[92:95], a[108:111], v[76:79]
  v_mfma_f32_16x16x32_bf16 v[80:83], v[92:95], a[140:143], v[80:83]
  v_mfma_f32_16x16x32_bf16 v[84:87], v[92:95], a[172:175], v[84:87]
  v_mfma_f32_16x16x32_bf16 v[88:91], v[92:95], a[204:207], v[88:91]
  ds_read2_b32 v[92:93], v53 offset0:208 offset1:209
  ds_read2_b32 v[94:95], v53 offset0:210 offset1:211
  s_waitcnt lgkmcnt(6)
  v_mfma_f32_16x16x32_bf16 v[64:67], v[96:99], a[8:11], v[64:67]
  v_mfma_f32_16x16x32_bf16 v[68:71], v[96:99], a[40:43], v[68:71]
  v_mfma_f32_16x16x32_bf16 v[72:75], v[96:99], a[72:75], v[72:75]
  v_mfma_f32_16x16x32_bf16 v[76:79], v[96:99], a[104:107], v[76:79]
  v_mfma_f32_16x16x32_bf16 v[80:83], v[96:99], a[136:139], v[80:83]
  v_mfma_f32_16x16x32_bf16 v[84:87], v[96:99], a[168:171], v[84:87]
  v_mfma_f32_16x16x32_bf16 v[88:91], v[96:99], a[200:203], v[88:91]
  ds_read2_b32 v[96:97], v53 offset0:192 offset1:193
  ds_read2_b32 v[98:99], v53 offset0:194 offset1:195
  s_waitcnt lgkmcnt(6)
  v_mfma_f32_16x16x32_bf16 v[64:67], v[100:103], a[4:7], v[64:67]
  v_mfma_f32_16x16x32_bf16 v[68:71], v[100:103], a[36:39], v[68:71]
  v_mfma_f32_16x16x32_bf16 v[72:75], v[100:103], a[68:71], v[72:75]
  v_mfma_f32_16x16x32_bf16 v[76:79], v[100:103], a[100:103], v[76:79]
  v_mfma_f32_16x16x32_bf16 v[80:83], v[100:103], a[132:135], v[80:83]
  v_mfma_f32_16x16x32_bf16 v[84:87], v[100:103], a[164:167], v[84:87]
  v_mfma_f32_16x16x32_bf16 v[88:91], v[100:103], a[196:199], v[88:91]
  ds_read2_b32 v[100:101], v53 offset0:176 offset1:177
  ds_read2_b32 v[102:103], v53 offset0:178 offset1:179
  s_waitcnt lgkmcnt(6)
  v_mfma_f32_16x16x32_bf16 v[64:67], v[104:107], a[0:3], v[64:67]
  v_mfma_f32_16x16x32_bf16 v[68:71], v[104:107], a[32:35], v[68:71]
  v_mfma_f32_16x16x32_bf16 v[72:75], v[104:107], a[64:67], v[72:75]
  v_mfma_f32_16x16x32_bf16 v[76:79], v[104:107], a[96:99], v[76:79]
  v_mfma_f32_16x16x32_bf16 v[80:83], v[104:107], a[128:131], v[80:83]
  v_mfma_f32_16x16x32_bf16 v[84:87], v[104:107], a[160:163], v[84:87]
  v_mfma_f32_16x16x32_bf16 v[88:91], v[104:107], a[192:195], v[88:91]
  ds_read2_b32 v[104:105], v53 offset0:160 offset1:161
  ds_read2_b32 v[106:107], v53 offset0:162 offset1:163
  s_waitcnt lgkmcnt(6)
  v_mfma_f32_16x16x32_bf16 v[68:71], v[92:95], a[28:31], v[68:71]
  v_mfma_f32_16x16x32_bf16 v[72:75], v[92:95], a[60:63], v[72:75]
  v_mfma_f32_16x16x32_bf16 v[76:79], v[92:95], a[92:95], v[76:79]
  v_mfma_f32_16x16x32_bf16 v[80:83], v[92:95], a[124:127], v[80:83]
  v_mfma_f32_16x16x32_bf16 v[84:87], v[92:95], a[156:159], v[84:87]
  v_mfma_f32_16x16x32_bf16 v[88:91], v[92:95], a[188:191], v[88:91]
  ds_read2_b32 v[92:93], v53 offset0:144 offset1:145
  ds_read2_b32 v[94:95], v53 offset0:146 offset1:147
  s_waitcnt lgkmcnt(6)
  v_mfma_f32_16x16x32_bf16 v[68:71], v[96:99], a[24:27], v[68:71]
  v_mfma_f32_16x16x32_bf16 v[72:75], v[96:99], a[56:59], v[72:75]
  v_mfma_f32_16x16x32_bf16 v[76:79], v[96:99], a[88:91], v[76:79]
  v_mfma_f32_16x16x32_bf16 v[80:83], v[96:99], a[120:123], v[80:83]
  v_mfma_f32_16x16x32_bf16 v[84:87], v[96:99], a[152:155], v[84:87]
  v_mfma_f32_16x16x32_bf16 v[88:91], v[96:99], a[184:187], v[88:91]
  ds_read2_b32 v[96:97], v53 offset0:128 offset1:129
  ds_read2_b32 v[98:99], v53 offset0:130 offset1:131
  s_waitcnt lgkmcnt(6)
  v_mfma_f32_16x16x32_bf16 v[68:71], v[100:103], a[20:23], v[68:71]
  v_mfma_f32_16x16x32_bf16 v[72:75], v[100:103], a[52:55], v[72:75]
  v_mfma_f32_16x16x32_bf16 v[76:79], v[100:103], a[84:87], v[76:79]
  v_mfma_f32_16x16x32_bf16 v[80:83], v[100:103], a[116:119], v[80:83]
  v_mfma_f32_16x16x32_bf16 v[84:87], v[100:103], a[148:151], v[84:87]
  v_mfma_f32_16x16x32_bf16 v[88:91], v[100:103], a[180:183], v[88:91]
  ds_read2_b32 v[100:101], v53 offset0:112 offset1:113
  ds_read2_b32 v[102:103], v53 offset0:114 offset1:115
  s_waitcnt lgkmcnt(6)
  v_mfma_f32_16x16x32_bf16 v[68:71], v[104:107], a[16:19], v[68:71]
  v_mfma_f32_16x16x32_bf16 v[72:75], v[104:107], a[48:51], v[72:75]
  v_mfma_f32_16x16x32_bf16 v[76:79], v[104:107], a[80:83], v[76:79]
  v_mfma_f32_16x16x32_bf16 v[80:83], v[104:107], a[112:115], v[80:83]
  v_mfma_f32_16x16x32_bf16 v[84:87], v[104:107], a[144:147], v[84:87]
  v_mfma_f32_16x16x32_bf16 v[88:91], v[104:107], a[176:179], v[88:91]
  ds_read2_b32 v[104:105], v53 offset0:96 offset1:97
  ds_read2_b32 v[106:107], v53 offset0:98 offset1:99
  s_waitcnt lgkmcnt(6)
  v_mfma_f32_16x16x32_bf16 v[68:71], v[92:95], a[12:15], v[68:71]
  v_mfma_f32_16x16x32_bf16 v[72:75], v[92:95], a[44:47], v[72:75]
  v_mfma_f32_16x16x32_bf16 v[76:79], v[92:95], a[76:79], v[76:79]
  v_mfma_f32_16x16x32_bf16 v[80:83], v[92:95], a[108:111], v[80:83]
  v_mfma_f32_16x16x32_bf16 v[84:87], v[92:95], a[140:143], v[84:87]
  v_mfma_f32_16x16x32_bf16 v[88:91], v[92:95], a[172:175], v[88:91]
  ds_read2_b32 v[92:93], v53 offset0:80 offset1:81
  ds_read2_b32 v[94:95], v53 offset0:82 offset1:83
  s_waitcnt lgkmcnt(6)
  v_mfma_f32_16x16x32_bf16 v[68:71], v[96:99], a[8:11], v[68:71]
  v_mfma_f32_16x16x32_bf16 v[72:75], v[96:99], a[40:43], v[72:75]
  v_mfma_f32_16x16x32_bf16 v[76:79], v[96:99], a[72:75], v[76:79]
  v_mfma_f32_16x16x32_bf16 v[80:83], v[96:99], a[104:107], v[80:83]
  v_mfma_f32_16x16x32_bf16 v[84:87], v[96:99], a[136:139], v[84:87]
  v_mfma_f32_16x16x32_bf16 v[88:91], v[96:99], a[168:171], v[88:91]
  ds_read2_b32 v[96:97], v53 offset0:64 offset1:65
  ds_read2_b32 v[98:99], v53 offset0:66 offset1:67
  s_waitcnt lgkmcnt(6)
  v_mfma_f32_16x16x32_bf16 v[68:71], v[100:103], a[4:7], v[68:71]
  v_mfma_f32_16x16x32_bf16 v[72:75], v[100:103], a[36:39], v[72:75]
  v_mfma_f32_16x16x32_bf16 v[76:79], v[100:103], a[68:71], v[76:79]
  v_mfma_f32_16x16x32_bf16 v[80:83], v[100:103], a[100:103], v[80:83]
  v_mfma_f32_16x16x32_bf16 v[84:87], v[100:103], a[132:135], v[84:87]
  v_mfma_f32_16x16x32_bf16 v[88:91], v[100:103], a[164:167], v[88:91]
  ds_read2_b32 v[100:101], v53 offset0:48 offset1:49
  ds_read2_b32 v[102:103], v53 offset0:50 offset1:51
  s_waitcnt lgkmcnt(6)
  v_mfma_f32_16x16x32_bf16 v[68:71], v[104:107], a[0:3], v[68:71]
  v_mfma_f32_16x16x32_bf16 v[72:75], v[104:107], a[32:35], v[72:75]
  v_mfma_f32_16x16x32_bf16 v[76:79], v[104:107], a[64:67], v[76:79]
  v_mfma_f32_16x16x32_bf16 v[80:83], v[104:107], a[96:99], v[80:83]
  v_mfma_f32_16x16x32_bf16 v[84:87], v[104:107], a[128:131], v[84:87]
  v_mfma_f32_16x16x32_bf16 v[88:91], v[104:107], a[160:163], v[88:91]
  ds_read2_b32 v[104:105], v53 offset0:32 offset1:33
  ds_read2_b32 v[106:107], v53 offset0:34 offset1:35
  s_waitcnt lgkmcnt(6)
  v_mfma_f32_16x16x32_bf16 v[72:75], v[92:95], a[28:31], v[72:75]
  v_mfma_f32_16x16x32_bf16 v[76:79], v[92:95], a[60:63], v[76:79]
  v_mfma_f32_16x16x32_bf16 v[80:83], v[92:95], a[92:95], v[80:83]
  v_mfma_f32_16x16x32_bf16 v[84:87], v[92:95], a[124:127], v[84:87]
  v_mfma_f32_16x16x32_bf16 v[88:91], v[92:95], a[156:159], v[88:91]
  ds_read2_b32 v[92:93], v53 offset0:16 offset1:17
  ds_read2_b32 v[94:95], v53 offset0:18 offset1:19
  s_waitcnt lgkmcnt(6)
  v_mfma_f32_16x16x32_bf16 v[72:75], v[96:99], a[24:27], v[72:75]
  v_mfma_f32_16x16x32_bf16 v[76:79], v[96:99], a[56:59], v[76:79]
  v_mfma_f32_16x16x32_bf16 v[80:83], v[96:99], a[88:91], v[80:83]
  v_mfma_f32_16x16x32_bf16 v[84:87], v[96:99], a[120:123], v[84:87]
  v_mfma_f32_16x16x32_bf16 v[88:91], v[96:99], a[152:155], v[88:91]
  ds_read2_b32 v[96:97], v53 offset0:0 offset1:1
  ds_read2_b32 v[98:99], v53 offset0:2 offset1:3
  s_waitcnt lgkmcnt(6)
  v_mfma_f32_16x16x32_bf16 v[72:75], v[100:103], a[20:23], v[72:75]
  v_mfma_f32_16x16x32_bf16 v[76:79], v[100:103], a[52:55], v[76:79]
  v_mfma_f32_16x16x32_bf16 v[80:83], v[100:103], a[84:87], v[80:83]
  v_mfma_f32_16x16x32_bf16 v[84:87], v[100:103], a[116:119], v[84:87]
  v_mfma_f32_16x16x32_bf16 v[88:91], v[100:103], a[148:151], v[88:91]
  ds_read2_b32 v[100:101], v54 offset0:224 offset1:225
  ds_read2_b32 v[102:103], v54 offset0:226 offset1:227
  s_waitcnt lgkmcnt(6)
  v_mfma_f32_16x16x32_bf16 v[72:75], v[104:107], a[16:19], v[72:75]
  v_mfma_f32_16x16x32_bf16 v[76:79], v[104:107], a[48:51], v[76:79]
  v_mfma_f32_16x16x32_bf16 v[80:83], v[104:107], a[80:83], v[80:83]
  v_mfma_f32_16x16x32_bf16 v[84:87], v[104:107], a[112:115], v[84:87]
  v_mfma_f32_16x16x32_bf16 v[88:91], v[104:107], a[144:147], v[88:91]
  ds_read2_b32 v[104:105], v54 offset0:208 offset1:209
  ds_read2_b32 v[106:107], v54 offset0:210 offset1:211
  s_waitcnt lgkmcnt(6)
  v_mfma_f32_16x16x32_bf16 v[72:75], v[92:95], a[12:15], v[72:75]
  v_mfma_f32_16x16x32_bf16 v[76:79], v[92:95], a[44:47], v[76:79]
  v_mfma_f32_16x16x32_bf16 v[80:83], v[92:95], a[76:79], v[80:83]
  v_mfma_f32_16x16x32_bf16 v[84:87], v[92:95], a[108:111], v[84:87]
  v_mfma_f32_16x16x32_bf16 v[88:91], v[92:95], a[140:143], v[88:91]
  ds_read2_b32 v[92:93], v54 offset0:192 offset1:193
  ds_read2_b32 v[94:95], v54 offset0:194 offset1:195
  s_waitcnt lgkmcnt(6)
  v_mfma_f32_16x16x32_bf16 v[72:75], v[96:99], a[8:11], v[72:75]
  v_mfma_f32_16x16x32_bf16 v[76:79], v[96:99], a[40:43], v[76:79]
  v_mfma_f32_16x16x32_bf16 v[80:83], v[96:99], a[72:75], v[80:83]
  v_mfma_f32_16x16x32_bf16 v[84:87], v[96:99], a[104:107], v[84:87]
  v_mfma_f32_16x16x32_bf16 v[88:91], v[96:99], a[136:139], v[88:91]
  ds_read2_b32 v[96:97], v54 offset0:176 offset1:177
  ds_read2_b32 v[98:99], v54 offset0:178 offset1:179
  s_waitcnt lgkmcnt(6)
  v_mfma_f32_16x16x32_bf16 v[72:75], v[100:103], a[4:7], v[72:75]
  v_mfma_f32_16x16x32_bf16 v[76:79], v[100:103], a[36:39], v[76:79]
  v_mfma_f32_16x16x32_bf16 v[80:83], v[100:103], a[68:71], v[80:83]
  v_mfma_f32_16x16x32_bf16 v[84:87], v[100:103], a[100:103], v[84:87]
  v_mfma_f32_16x16x32_bf16 v[88:91], v[100:103], a[132:135], v[88:91]
  ds_read2_b32 v[100:101], v54 offset0:160 offset1:161
  ds_read2_b32 v[102:103], v54 offset0:162 offset1:163
  s_waitcnt lgkmcnt(6)
  v_mfma_f32_16x16x32_bf16 v[72:75], v[104:107], a[0:3], v[72:75]
  v_mfma_f32_16x16x32_bf16 v[76:79], v[104:107], a[32:35], v[76:79]
  v_mfma_f32_16x16x32_bf16 v[80:83], v[104:107], a[64:67], v[80:83]
  v_mfma_f32_16x16x32_bf16 v[84:87], v[104:107], a[96:99], v[84:87]
  v_mfma_f32_16x16x32_bf16 v[88:91], v[104:107], a[128:131], v[88:91]
  ds_read2_b32 v[104:105], v54 offset0:144 offset1:145
  ds_read2_b32 v[106:107], v54 offset0:146 offset1:147
  s_waitcnt lgkmcnt(6)
  v_mfma_f32_16x16x32_bf16 v[76:79], v[92:95], a[28:31], v[76:79]
  v_mfma_f32_16x16x32_bf16 v[80:83], v[92:95], a[60:63], v[80:83]
  v_mfma_f32_16x16x32_bf16 v[84:87], v[92:95], a[92:95], v[84:87]
  v_mfma_f32_16x16x32_bf16 v[88:91], v[92:95], a[124:127], v[88:91]
  ds_read2_b32 v[92:93], v54 offset0:128 offset1:129
  ds_read2_b32 v[94:95], v54 offset0:130 offset1:131
  s_waitcnt lgkmcnt(6)
  v_mfma_f32_16x16x32_bf16 v[76:79], v[96:99], a[24:27], v[76:79]
  v_mfma_f32_16x16x32_bf16 v[80:83], v[96:99], a[56:59], v[80:83]
  v_mfma_f32_16x16x32_bf16 v[84:87], v[96:99], a[88:91], v[84:87]
  v_mfma_f32_16x16x32_bf16 v[88:91], v[96:99], a[120:123], v[88:91]
  ds_read2_b32 v[96:97], v54 offset0:112 offset1:113
  ds_read2_b32 v[98:99], v54 offset0:114 offset1:115
  s_waitcnt lgkmcnt(6)
  v_mfma_f32_16x16x32_bf16 v[76:79], v[100:103], a[20:23], v[76:79]
  v_mfma_f32_16x16x32_bf16 v[80:83], v[100:103], a[52:55], v[80:83]
  v_mfma_f32_16x16x32_bf16 v[84:87], v[100:103], a[84:87], v[84:87]
  v_mfma_f32_16x16x32_bf16 v[88:91], v[100:103], a[116:119], v[88:91]
  ds_read2_b32 v[100:101], v54 offset0:96 offset1:97
  ds_read2_b32 v[102:103], v54 offset0:98 offset1:99
  s_waitcnt lgkmcnt(6)
  v_mfma_f32_16x16x32_bf16 v[76:79], v[104:107], a[16:19], v[76:79]
  v_mfma_f32_16x16x32_bf16 v[80:83], v[104:107], a[48:51], v[80:83]
  v_mfma_f32_16x16x32_bf16 v[84:87], v[104:107], a[80:83], v[84:87]
  v_mfma_f32_16x16x32_bf16 v[88:91], v[104:107], a[112:115], v[88:91]
  ds_read2_b32 v[104:105], v54 offset0:80 offset1:81
  ds_read2_b32 v[106:107], v54 offset0:82 offset1:83
  s_waitcnt lgkmcnt(6)
  v_mfma_f32_16x16x32_bf16 v[76:79], v[92:95], a[12:15], v[76:79]
  v_mfma_f32_16x16x32_bf16 v[80:83], v[92:95], a[44:47], v[80:83]
  v_mfma_f32_16x16x32_bf16 v[84:87], v[92:95], a[76:79], v[84:87]
  v_mfma_f32_16x16x32_bf16 v[88:91], v[92:95], a[108:111], v[88:91]
  ds_read2_b32 v[92:93], v54 offset0:64 offset1:65
  ds_read2_b32 v[94:95], v54 offset0:66 offset1:67
  s_waitcnt lgkmcnt(6)
  v_mfma_f32_16x16x32_bf16 v[76:79], v[96:99], a[8:11], v[76:79]
  v_mfma_f32_16x16x32_bf16 v[80:83], v[96:99], a[40:43], v[80:83]
  v_mfma_f32_16x16x32_bf16 v[84:87], v[96:99], a[72:75], v[84:87]
  v_mfma_f32_16x16x32_bf16 v[88:91], v[96:99], a[104:107], v[88:91]
  ds_read2_b32 v[96:97], v54 offset0:48 offset1:49
  ds_read2_b32 v[98:99], v54 offset0:50 offset1:51
  s_waitcnt lgkmcnt(6)
  v_mfma_f32_16x16x32_bf16 v[76:79], v[100:103], a[4:7], v[76:79]
  v_mfma_f32_16x16x32_bf16 v[80:83], v[100:103], a[36:39], v[80:83]
  v_mfma_f32_16x16x32_bf16 v[84:87], v[100:103], a[68:71], v[84:87]
  v_mfma_f32_16x16x32_bf16 v[88:91], v[100:103], a[100:103], v[88:91]
  ds_read2_b32 v[100:101], v54 offset0:32 offset1:33
  ds_read2_b32 v[102:103], v54 offset0:34 offset1:35
  s_waitcnt lgkmcnt(6)
  v_mfma_f32_16x16x32_bf16 v[76:79], v[104:107], a[0:3], v[76:79]
  v_mfma_f32_16x16x32_bf16 v[80:83], v[104:107], a[32:35], v[80:83]
  v_mfma_f32_16x16x32_bf16 v[84:87], v[104:107], a[64:67], v[84:87]
  v_mfma_f32_16x16x32_bf16 v[88:91], v[104:107], a[96:99], v[88:91]
  ds_read2_b32 v[104:105], v54 offset0:16 offset1:17
  ds_read2_b32 v[106:107], v54 offset0:18 offset1:19
  s_waitcnt lgkmcnt(6)
  v_mfma_f32_16x16x32_bf16 v[80:83], v[92:95], a[28:31], v[80:83]
  v_mfma_f32_16x16x32_bf16 v[84:87], v[92:95], a[60:63], v[84:87]
  v_mfma_f32_16x16x32_bf16 v[88:91], v[92:95], a[92:95], v[88:91]
  ds_read2_b32 v[92:93], v54 offset0:0 offset1:1
  ds_read2_b32 v[94:95], v54 offset0:2 offset1:3
  s_waitcnt lgkmcnt(6)
  v_mfma_f32_16x16x32_bf16 v[80:83], v[96:99], a[24:27], v[80:83]
  v_mfma_f32_16x16x32_bf16 v[84:87], v[96:99], a[56:59], v[84:87]
  v_mfma_f32_16x16x32_bf16 v[88:91], v[96:99], a[88:91], v[88:91]
  ds_read2_b32 v[96:97], v55 offset0:224 offset1:225
  ds_read2_b32 v[98:99], v55 offset0:226 offset1:227
  s_waitcnt lgkmcnt(6)
  v_mfma_f32_16x16x32_bf16 v[80:83], v[100:103], a[20:23], v[80:83]
  v_mfma_f32_16x16x32_bf16 v[84:87], v[100:103], a[52:55], v[84:87]
  v_mfma_f32_16x16x32_bf16 v[88:91], v[100:103], a[84:87], v[88:91]
  ds_read2_b32 v[100:101], v55 offset0:208 offset1:209
  ds_read2_b32 v[102:103], v55 offset0:210 offset1:211
  s_waitcnt lgkmcnt(6)
  v_mfma_f32_16x16x32_bf16 v[80:83], v[104:107], a[16:19], v[80:83]
  v_mfma_f32_16x16x32_bf16 v[84:87], v[104:107], a[48:51], v[84:87]
  v_mfma_f32_16x16x32_bf16 v[88:91], v[104:107], a[80:83], v[88:91]
  ds_read2_b32 v[104:105], v55 offset0:192 offset1:193
  ds_read2_b32 v[106:107], v55 offset0:194 offset1:195
  s_waitcnt lgkmcnt(6)
  v_mfma_f32_16x16x32_bf16 v[80:83], v[92:95], a[12:15], v[80:83]
  v_mfma_f32_16x16x32_bf16 v[84:87], v[92:95], a[44:47], v[84:87]
  v_mfma_f32_16x16x32_bf16 v[88:91], v[92:95], a[76:79], v[88:91]
  ds_read2_b32 v[92:93], v55 offset0:176 offset1:177
  ds_read2_b32 v[94:95], v55 offset0:178 offset1:179
  s_waitcnt lgkmcnt(6)
  v_mfma_f32_16x16x32_bf16 v[80:83], v[96:99], a[8:11], v[80:83]
  v_mfma_f32_16x16x32_bf16 v[84:87], v[96:99], a[40:43], v[84:87]
  v_mfma_f32_16x16x32_bf16 v[88:91], v[96:99], a[72:75], v[88:91]
  ds_read2_b32 v[96:97], v55 offset0:160 offset1:161
  ds_read2_b32 v[98:99], v55 offset0:162 offset1:163
  s_waitcnt lgkmcnt(6)
  v_mfma_f32_16x16x32_bf16 v[80:83], v[100:103], a[4:7], v[80:83]
  v_mfma_f32_16x16x32_bf16 v[84:87], v[100:103], a[36:39], v[84:87]
  v_mfma_f32_16x16x32_bf16 v[88:91], v[100:103], a[68:71], v[88:91]
  ds_read2_b32 v[100:101], v55 offset0:144 offset1:145
  ds_read2_b32 v[102:103], v55 offset0:146 offset1:147
  s_waitcnt lgkmcnt(6)
  v_mfma_f32_16x16x32_bf16 v[80:83], v[104:107], a[0:3], v[80:83]
  v_mfma_f32_16x16x32_bf16 v[84:87], v[104:107], a[32:35], v[84:87]
  v_mfma_f32_16x16x32_bf16 v[88:91], v[104:107], a[64:67], v[88:91]
  ds_read2_b32 v[104:105], v55 offset0:128 offset1:129
  ds_read2_b32 v[106:107], v55 offset0:130 offset1:131
  s_waitcnt lgkmcnt(6)
  v_mfma_f32_16x16x32_bf16 v[84:87], v[92:95], a[28:31], v[84:87]
  v_mfma_f32_16x16x32_bf16 v[88:91], v[92:95], a[60:63], v[88:91]
  ds_read2_b32 v[92:93], v55 offset0:112 offset1:113
  ds_read2_b32 v[94:95], v55 offset0:114 offset1:115
  s_waitcnt lgkmcnt(6)
  v_mfma_f32_16x16x32_bf16 v[84:87], v[96:99], a[24:27], v[84:87]
  v_mfma_f32_16x16x32_bf16 v[88:91], v[96:99], a[56:59], v[88:91]
  ds_read2_b32 v[96:97], v55 offset0:96 offset1:97
  ds_read2_b32 v[98:99], v55 offset0:98 offset1:99
  s_waitcnt lgkmcnt(6)
  v_mfma_f32_16x16x32_bf16 v[84:87], v[100:103], a[20:23], v[84:87]
  v_mfma_f32_16x16x32_bf16 v[88:91], v[100:103], a[52:55], v[88:91]
  ds_read2_b32 v[100:101], v55 offset0:80 offset1:81
  ds_read2_b32 v[102:103], v55 offset0:82 offset1:83
  s_waitcnt lgkmcnt(6)
  v_mfma_f32_16x16x32_bf16 v[84:87], v[104:107], a[16:19], v[84:87]
  v_mfma_f32_16x16x32_bf16 v[88:91], v[104:107], a[48:51], v[88:91]
  ds_read2_b32 v[104:105], v55 offset0:64 offset1:65
  ds_read2_b32 v[106:107], v55 offset0:66 offset1:67
  s_waitcnt lgkmcnt(6)
  v_mfma_f32_16x16x32_bf16 v[84:87], v[92:95], a[12:15], v[84:87]
  v_mfma_f32_16x16x32_bf16 v[88:91], v[92:95], a[44:47], v[88:91]
  ds_read2_b32 v[92:93], v55 offset0:48 offset1:49
  ds_read2_b32 v[94:95], v55 offset0:50 offset1:51
  s_waitcnt lgkmcnt(6)
  v_mfma_f32_16x16x32_bf16 v[84:87], v[96:99], a[8:11], v[84:87]
  v_mfma_f32_16x16x32_bf16 v[88:91], v[96:99], a[40:43], v[88:91]
  ds_read2_b32 v[96:97], v55 offset0:32 offset1:33
  ds_read2_b32 v[98:99], v55 offset0:34 offset1:35
  s_waitcnt lgkmcnt(6)
  v_mfma_f32_16x16x32_bf16 v[84:87], v[100:103], a[4:7], v[84:87]
  v_mfma_f32_16x16x32_bf16 v[88:91], v[100:103], a[36:39], v[88:91]
  ds_read2_b32 v[100:101], v55 offset0:16 offset1:17
  ds_read2_b32 v[102:103], v55 offset0:18 offset1:19
  s_waitcnt lgkmcnt(6)
  v_mfma_f32_16x16x32_bf16 v[84:87], v[104:107], a[0:3], v[84:87]
  v_mfma_f32_16x16x32_bf16 v[88:91], v[104:107], a[32:35], v[88:91]
  ds_read2_b32 v[104:105], v55 offset0:0 offset1:1
  ds_read2_b32 v[106:107], v55 offset0:2 offset1:3
  s_waitcnt lgkmcnt(6)
  v_mfma_f32_16x16x32_bf16 v[88:91], v[92:95], a[28:31], v[88:91]
  ds_read2_b32 v[92:93], v56 offset0:224 offset1:225
  ds_read2_b32 v[94:95], v56 offset0:226 offset1:227
  s_waitcnt lgkmcnt(6)
  v_mfma_f32_16x16x32_bf16 v[88:91], v[96:99], a[24:27], v[88:91]
  ds_read2_b32 v[96:97], v56 offset0:208 offset1:209
  ds_read2_b32 v[98:99], v56 offset0:210 offset1:211
  s_waitcnt lgkmcnt(6)
  v_mfma_f32_16x16x32_bf16 v[88:91], v[100:103], a[20:23], v[88:91]
  ds_read2_b32 v[100:101], v56 offset0:192 offset1:193
  ds_read2_b32 v[102:103], v56 offset0:194 offset1:195
  s_waitcnt lgkmcnt(6)
  v_mfma_f32_16x16x32_bf16 v[88:91], v[104:107], a[16:19], v[88:91]
  ds_read2_b32 v[104:105], v56 offset0:176 offset1:177
  ds_read2_b32 v[106:107], v56 offset0:178 offset1:179
  s_waitcnt lgkmcnt(6)
  v_mfma_f32_16x16x32_bf16 v[88:91], v[92:95], a[12:15], v[88:91]
  s_waitcnt lgkmcnt(4)
  v_mfma_f32_16x16x32_bf16 v[88:91], v[96:99], a[8:11], v[88:91]
  s_waitcnt lgkmcnt(2)
  v_mfma_f32_16x16x32_bf16 v[88:91], v[100:103], a[4:7], v[88:91]
  s_waitcnt lgkmcnt(0)
  v_mfma_f32_16x16x32_bf16 v[88:91], v[104:107], a[0:3], v[88:91]
  v_lshlrev_b32 v46, 5, v4
  v_lshl_add_u32 v46, v3, 3, v46
  v_add_u32 v46, s17, v46
  ds_read_b64 v[108:109], v46 offset:512
  ds_read_b64 v[110:111], v46 offset:1024
  ds_read_b64 v[112:113], v46 offset:1536
  ds_read_b64 v[114:115], v46 offset:2048
  ds_read_b64 v[116:117], v46 offset:2560
  ds_read_b64 v[118:119], v46 offset:3072
  ds_read_b64 v[120:121], v46 offset:3584
  ds_read_b64 v[122:123], v46 offset:4096
  s_waitcnt lgkmcnt(0)
  v_lshlrev_b32 v124, 16, v108
  v_and_b32 v125, 0xffff0000, v108
  v_lshlrev_b32 v126, 16, v109
  v_and_b32 v127, 0xffff0000, v109
  v_mul_f32 v124, v124, v33
  v_mul_f32 v125, v125, v33
  v_mul_f32 v126, v126, v33
  v_mul_f32 v127, v127, v33
  v_cvt_pk_bf16_f32 v128, v124, v125
  v_cvt_pk_bf16_f32 v129, v126, v127
  v_cvt_pk_bf16_f32 v130, v60, v61
  v_cvt_pk_bf16_f32 v131, v62, v63
  v_lshlrev_b32 v124, 16, v128
  v_and_b32 v125, 0xffff0000, v128
  v_lshlrev_b32 v132, 16, v130
  v_and_b32 v133, 0xffff0000, v130
  v_lshlrev_b32 v126, 16, v129
  v_and_b32 v127, 0xffff0000, v129
  v_lshlrev_b32 v134, 16, v131
  v_and_b32 v135, 0xffff0000, v131
  v_add_f32 v124, v124, v132
  v_add_f32 v125, v125, v133
  v_add_f32 v126, v126, v134
  v_add_f32 v127, v127, v135
  v_cvt_pk_bf16_f32 v108, v124, v125
  v_cvt_pk_bf16_f32 v109, v126, v127
  ds_write_b64 v46, v[108:109] offset:512
  v_lshlrev_b32 v124, 16, v110
  v_and_b32 v125, 0xffff0000, v110
  v_lshlrev_b32 v126, 16, v111
  v_and_b32 v127, 0xffff0000, v111
  v_mul_f32 v124, v124, v33
  v_mul_f32 v125, v125, v33
  v_mul_f32 v126, v126, v33
  v_mul_f32 v127, v127, v33
  v_cvt_pk_bf16_f32 v128, v124, v125
  v_cvt_pk_bf16_f32 v129, v126, v127
  v_cvt_pk_bf16_f32 v130, v64, v65
  v_cvt_pk_bf16_f32 v131, v66, v67
  v_lshlrev_b32 v124, 16, v128
  v_and_b32 v125, 0xffff0000, v128
  v_lshlrev_b32 v132, 16, v130
  v_and_b32 v133, 0xffff0000, v130
  v_lshlrev_b32 v126, 16, v129
  v_and_b32 v127, 0xffff0000, v129
  v_lshlrev_b32 v134, 16, v131
  v_and_b32 v135, 0xffff0000, v131
  v_add_f32 v124, v124, v132
  v_add_f32 v125, v125, v133
  v_add_f32 v126, v126, v134
  v_add_f32 v127, v127, v135
  v_cvt_pk_bf16_f32 v110, v124, v125
  v_cvt_pk_bf16_f32 v111, v126, v127
  ds_write_b64 v46, v[110:111] offset:1024
  v_lshlrev_b32 v124, 16, v112
  v_and_b32 v125, 0xffff0000, v112
  v_lshlrev_b32 v126, 16, v113
  v_and_b32 v127, 0xffff0000, v113
  v_mul_f32 v124, v124, v33
  v_mul_f32 v125, v125, v33
  v_mul_f32 v126, v126, v33
  v_mul_f32 v127, v127, v33
  v_cvt_pk_bf16_f32 v128, v124, v125
  v_cvt_pk_bf16_f32 v129, v126, v127
  v_cvt_pk_bf16_f32 v130, v68, v69
  v_cvt_pk_bf16_f32 v131, v70, v71
  v_lshlrev_b32 v124, 16, v128
  v_and_b32 v125, 0xffff0000, v128
  v_lshlrev_b32 v132, 16, v130
  v_and_b32 v133, 0xffff0000, v130
  v_lshlrev_b32 v126, 16, v129
  v_and_b32 v127, 0xffff0000, v129
  v_lshlrev_b32 v134, 16, v131
  v_and_b32 v135, 0xffff0000, v131
  v_add_f32 v124, v124, v132
  v_add_f32 v125, v125, v133
  v_add_f32 v126, v126, v134
  v_add_f32 v127, v127, v135
  v_cvt_pk_bf16_f32 v112, v124, v125
  v_cvt_pk_bf16_f32 v113, v126, v127
  ds_write_b64 v46, v[112:113] offset:1536
  v_lshlrev_b32 v124, 16, v114
  v_and_b32 v125, 0xffff0000, v114
  v_lshlrev_b32 v126, 16, v115
  v_and_b32 v127, 0xffff0000, v115
  v_mul_f32 v124, v124, v33
  v_mul_f32 v125, v125, v33
  v_mul_f32 v126, v126, v33
  v_mul_f32 v127, v127, v33
  v_cvt_pk_bf16_f32 v128, v124, v125
  v_cvt_pk_bf16_f32 v129, v126, v127
  v_cvt_pk_bf16_f32 v130, v72, v73
  v_cvt_pk_bf16_f32 v131, v74, v75
  v_lshlrev_b32 v124, 16, v128
  v_and_b32 v125, 0xffff0000, v128
  v_lshlrev_b32 v132, 16, v130
  v_and_b32 v133, 0xffff0000, v130
  v_lshlrev_b32 v126, 16, v129
  v_and_b32 v127, 0xffff0000, v129
  v_lshlrev_b32 v134, 16, v131
  v_and_b32 v135, 0xffff0000, v131
  v_add_f32 v124, v124, v132
  v_add_f32 v125, v125, v133
  v_add_f32 v126, v126, v134
  v_add_f32 v127, v127, v135
  v_cvt_pk_bf16_f32 v114, v124, v125
  v_cvt_pk_bf16_f32 v115, v126, v127
  ds_write_b64 v46, v[114:115] offset:2048
  v_lshlrev_b32 v124, 16, v116
  v_and_b32 v125, 0xffff0000, v116
  v_lshlrev_b32 v126, 16, v117
  v_and_b32 v127, 0xffff0000, v117
  v_mul_f32 v124, v124, v33
  v_mul_f32 v125, v125, v33
  v_mul_f32 v126, v126, v33
  v_mul_f32 v127, v127, v33
  v_cvt_pk_bf16_f32 v128, v124, v125
  v_cvt_pk_bf16_f32 v129, v126, v127
  v_cvt_pk_bf16_f32 v130, v76, v77
  v_cvt_pk_bf16_f32 v131, v78, v79
  v_lshlrev_b32 v124, 16, v128
  v_and_b32 v125, 0xffff0000, v128
  v_lshlrev_b32 v132, 16, v130
  v_and_b32 v133, 0xffff0000, v130
  v_lshlrev_b32 v126, 16, v129
  v_and_b32 v127, 0xffff0000, v129
  v_lshlrev_b32 v134, 16, v131
  v_and_b32 v135, 0xffff0000, v131
  v_add_f32 v124, v124, v132
  v_add_f32 v125, v125, v133
  v_add_f32 v126, v126, v134
  v_add_f32 v127, v127, v135
  v_cvt_pk_bf16_f32 v116, v124, v125
  v_cvt_pk_bf16_f32 v117, v126, v127
  ds_write_b64 v46, v[116:117] offset:2560
  v_lshlrev_b32 v124, 16, v118
  v_and_b32 v125, 0xffff0000, v118
  v_lshlrev_b32 v126, 16, v119
  v_and_b32 v127, 0xffff0000, v119
  v_mul_f32 v124, v124, v33
  v_mul_f32 v125, v125, v33
  v_mul_f32 v126, v126, v33
  v_mul_f32 v127, v127, v33
  v_cvt_pk_bf16_f32 v128, v124, v125
  v_cvt_pk_bf16_f32 v129, v126, v127
  v_cvt_pk_bf16_f32 v130, v80, v81
  v_cvt_pk_bf16_f32 v131, v82, v83
  v_lshlrev_b32 v124, 16, v128
  v_and_b32 v125, 0xffff0000, v128
  v_lshlrev_b32 v132, 16, v130
  v_and_b32 v133, 0xffff0000, v130
  v_lshlrev_b32 v126, 16, v129
  v_and_b32 v127, 0xffff0000, v129
  v_lshlrev_b32 v134, 16, v131
  v_and_b32 v135, 0xffff0000, v131
  v_add_f32 v124, v124, v132
  v_add_f32 v125, v125, v133
  v_add_f32 v126, v126, v134
  v_add_f32 v127, v127, v135
  v_cvt_pk_bf16_f32 v118, v124, v125
  v_cvt_pk_bf16_f32 v119, v126, v127
  ds_write_b64 v46, v[118:119] offset:3072
  v_lshlrev_b32 v124, 16, v120
  v_and_b32 v125, 0xffff0000, v120
  v_lshlrev_b32 v126, 16, v121
  v_and_b32 v127, 0xffff0000, v121
  v_mul_f32 v124, v124, v33
  v_mul_f32 v125, v125, v33
  v_mul_f32 v126, v126, v33
  v_mul_f32 v127, v127, v33
  v_cvt_pk_bf16_f32 v128, v124, v125
  v_cvt_pk_bf16_f32 v129, v126, v127
  v_cvt_pk_bf16_f32 v130, v84, v85
  v_cvt_pk_bf16_f32 v131, v86, v87
  v_lshlrev_b32 v124, 16, v128
  v_and_b32 v125, 0xffff0000, v128
  v_lshlrev_b32 v132, 16, v130
  v_and_b32 v133, 0xffff0000, v130
  v_lshlrev_b32 v126, 16, v129
  v_and_b32 v127, 0xffff0000, v129
  v_lshlrev_b32 v134, 16, v131
  v_and_b32 v135, 0xffff0000, v131
  v_add_f32 v124, v124, v132
  v_add_f32 v125, v125, v133
  v_add_f32 v126, v126, v134
  v_add_f32 v127, v127, v135
  v_cvt_pk_bf16_f32 v120, v124, v125
  v_cvt_pk_bf16_f32 v121, v126, v127
  ds_write_b64 v46, v[120:121] offset:3584
  v_lshlrev_b32 v124, 16, v122
  v_and_b32 v125, 0xffff0000, v122
  v_lshlrev_b32 v126, 16, v123
  v_and_b32 v127, 0xffff0000, v123
  v_mul_f32 v124, v124, v33
  v_mul_f32 v125, v125, v33
  v_mul_f32 v126, v126, v33
  v_mul_f32 v127, v127, v33
  v_cvt_pk_bf16_f32 v128, v124, v125
  v_cvt_pk_bf16_f32 v129, v126, v127
  v_cvt_pk_bf16_f32 v130, v88, v89
  v_cvt_pk_bf16_f32 v131, v90, v91
  v_lshlrev_b32 v124, 16, v128
  v_and_b32 v125, 0xffff0000, v128
  v_lshlrev_b32 v132, 16, v130
  v_and_b32 v133, 0xffff0000, v130
  v_lshlrev_b32 v126, 16, v129
  v_and_b32 v127, 0xffff0000, v129
  v_lshlrev_b32 v134, 16, v131
  v_and_b32 v135, 0xffff0000, v131
  v_add_f32 v124, v124, v132
  v_add_f32 v125, v125, v133
  v_add_f32 v126, v126, v134
  v_add_f32 v127, v127, v135
  v_cvt_pk_bf16_f32 v122, v124, v125
  v_cvt_pk_bf16_f32 v123, v126, v127
  ds_write_b64 v46, v[122:123] offset:4096
  s_waitcnt lgkmcnt(0)
  s_barrier
  v_lshlrev_b32 v6, 3, v0
  v_lshlrev_b32 v5, 4, v0
  v_add_u32 v36, 512, v6
  ds_read_b64 v[8:9], v36
  v_add_u32 v36, 25088, v6
  ds_read_b64 v[10:11], v36
  v_add_u32 v36, 49664, v6
  ds_read_b64 v[12:13], v36
  v_add_u32 v36, 74240, v6
  ds_read_b64 v[14:15], v36
  s_waitcnt lgkmcnt(0)
  s_add_u32 s22, s21, 0
  s_add_u32 s23, s22, 3584
  v_perm_b32 v16, v10, v8, s24
  v_perm_b32 v17, v14, v12, s24
  s_lshl_b32 s22, s21, 11
  s_add_u32 s22, s22, 90177536
  v_perm_b32 v18, v10, v8, s25
  v_perm_b32 v19, v14, v12, s25
  buffer_store_dwordx4 v[16:19], v5, s[8:11], s22 offen sc1
  v_perm_b32 v20, v11, v9, s24
  v_perm_b32 v21, v15, v13, s24
  v_perm_b32 v22, v11, v9, s25
  v_perm_b32 v23, v15, v13, s25
  s_add_u32 s22, s22, 4096
  buffer_store_dwordx4 v[20:23], v5, s[8:11], s22 offen sc1
  v_add_u32 v36, 2560, v6
  ds_read_b64 v[8:9], v36
  v_add_u32 v36, 27136, v6
  ds_read_b64 v[10:11], v36
  v_add_u32 v36, 51712, v6
  ds_read_b64 v[12:13], v36
  v_add_u32 v36, 76288, v6
  ds_read_b64 v[14:15], v36
  s_waitcnt lgkmcnt(0)
  s_add_u32 s22, s21, 1835008
  s_add_u32 s23, s22, 3584
  v_perm_b32 v24, v10, v8, s24
  v_perm_b32 v25, v14, v12, s24
  s_lshl_b32 s22, s21, 11
  s_add_u32 s22, s22, 90185728
  v_perm_b32 v26, v10, v8, s25
  v_perm_b32 v27, v14, v12, s25
  buffer_store_dwordx4 v[24:27], v5, s[8:11], s22 offen sc1
  v_perm_b32 v28, v11, v9, s24
  v_perm_b32 v29, v15, v13, s24
  v_perm_b32 v30, v11, v9, s25
  v_perm_b32 v31, v15, v13, s25
  s_add_u32 s22, s22, 4096
  buffer_store_dwordx4 v[28:31], v5, s[8:11], s22 offen sc1
  s_waitcnt vmcnt(0)
  s_barrier
  s_cmp_lg_u32 s16, 0
  s_cbranch_scc1 wk_nc
  v_mov_b32 v5, 1
  s_mov_b32 s22, 88599424
  s_mov_b64 exec, 1
  buffer_atomic_add v5, off, s[8:11], s22
  s_mov_b64 exec, -1
wk_nc:
  s_branch wk_loop
wk_tok:
  s_sub_u32 s3, s3, 864
  s_cmp_lt_u32 s3, 512
  s_cbranch_scc1 wk_tk
  s_sub_u32 s3, s3, 64
  s_cmp_ge_i32 s3, 512
  s_cbranch_scc1 wk_tk
  s_sub_u32 s18, s3, 448
  s_mov_b32 s20, 88599424
  v_mov_b32 v8, 0
  s_mov_b32 s30, 0
wk_cw:
  buffer_load_dword v9, v8, s[8:11], s20 offen sc1
  s_waitcnt vmcnt(0)
  v_cmp_ne_u32 vcc, 112, v9
  s_cbranch_vccz wk_cw_ok
  s_sleep 32
  s_add_u32 s30, s30, 1
  s_cmp_lt_u32 s30, 50000
  s_cbranch_scc1 wk_cw
  s_branch cA_abort
wk_cw_ok:
  v_lshlrev_b32 v5, 14, v3
  v_and_b32 v6, 1, v4
  v_lshl_add_u32 v5, v6, 12, v5
  v_lshrrev_b32 v6, 1, v4
  v_lshl_add_u32 v5, v6, 4, v5
  s_mul_i32 s20, s16, 458752
  s_lshl_b32 s21, s18, 7
  s_add_u32 s20, s20, s21
  s_and_b32 s21, s18, 32
  s_lshl_b32 s21, s21, 7
  s_add_u32 s20, s20, s21
  s_add_u32 s20, s20, 90177536
  buffer_load_dwordx4 v[8:11], v5, s[8:11], s20 offen sc1
  s_add_u32 s20, s20, 65536
  buffer_load_dwordx4 v[12:15], v5, s[8:11], s20 offen sc1
  s_add_u32 s20, s20, 65536
  buffer_load_dwordx4 v[16:19], v5, s[8:11], s20 offen sc1
  s_add_u32 s20, s20, 65536
  buffer_load_dwordx4 v[20:23], v5, s[8:11], s20 offen sc1
  s_add_u32 s20, s20, 65536
  buffer_load_dwordx4 v[24:27], v5, s[8:11], s20 offen sc1
  s_add_u32 s20, s20, 65536
  buffer_load_dwordx4 v[28:31], v5, s[8:11], s20 offen sc1
  s_add_u32 s20, s20, 65536
  buffer_load_dwordx4 v[32:35], v5, s[8:11], s20 offen sc1
  s_add_u32 s20, s20, 65536
  v_mul_u32_u24 v6, 1824, v4
  v_lshl_add_u32 v6, v3, 3, v6
  s_mul_i32 s20, s16, 224
  v_add_u32 v6, s20, v6
  s_movk_i32 s22, 912
  v_add_u32 v36, 0, v0
  v_mul_u32_u24 v37, 18725, v36
  v_lshrrev_b32 v37, 20, v37
  v_mul_u32_u24 v38, 56, v37
  v_sub_u32 v36, v36, v38
  v_lshlrev_b32 v36, 4, v36
  v_mad_u32_u24 v40, v37, s22, v36
  v_mul_u32_u24 v37, 1792, v37
  v_add_u32 v48, v37, v36
  v_add_u32 v36, 256, v0
  v_mul_u32_u24 v37, 18725, v36
  v_lshrrev_b32 v37, 20, v37
  v_mul_u32_u24 v38, 56, v37
  v_sub_u32 v36, v36, v38
  v_lshlrev_b32 v36, 4, v36
  v_mad_u32_u24 v41, v37, s22, v36
  v_mul_u32_u24 v37, 1792, v37
  v_add_u32 v49, v37, v36
  v_add_u32 v36, 512, v0
  v_mul_u32_u24 v37, 18725, v36
  v_lshrrev_b32 v37, 20, v37
  v_mul_u32_u24 v38, 56, v37
  v_sub_u32 v36, v36, v38
  v_lshlrev_b32 v36, 4, v36
  v_mad_u32_u24 v42, v37, s22, v36
  v_mul_u32_u24 v37, 1792, v37
  v_add_u32 v50, v37, v36
  v_add_u32 v36, 768, v0
  v_mul_u32_u24 v37, 18725, v36
  v_lshrrev_b32 v37, 20, v37
  v_mul_u32_u24 v38, 56, v37
  v_sub_u32 v36, v36, v38
  v_lshlrev_b32 v36, 4, v36
  v_mad_u32_u24 v43, v37, s22, v36
  v_mul_u32_u24 v37, 1792, v37
  v_add_u32 v51, v37, v36
  v_add_u32 v36, 1024, v0
  v_mul_u32_u24 v37, 18725, v36
  v_lshrrev_b32 v37, 20, v37
  v_mul_u32_u24 v38, 56, v37
  v_sub_u32 v36, v36, v38
  v_lshlrev_b32 v36, 4, v36
  v_mad_u32_u24 v44, v37, s22, v36
  v_mul_u32_u24 v37, 1792, v37
  v_add_u32 v52, v37, v36
  v_add_u32 v36, 1280, v0
  v_mul_u32_u24 v37, 18725, v36
  v_lshrrev_b32 v37, 20, v37
  v_mul_u32_u24 v38, 56, v37
  v_sub_u32 v36, v36, v38
  v_lshlrev_b32 v36, 4, v36
  v_mad_u32_u24 v45, v37, s22, v36
  v_mul_u32_u24 v37, 1792, v37
  v_add_u32 v53, v37, v36
  v_add_u32 v36, 1536, v0
  v_mul_u32_u24 v37, 18725, v36
  v_lshrrev_b32 v37, 20, v37
  v_mul_u32_u24 v38, 56, v37
  v_sub_u32 v36, v36, v38
  v_lshlrev_b32 v36, 4, v36
  v_mad_u32_u24 v46, v37, s22, v36
  v_mul_u32_u24 v37, 1792, v37
  v_add_u32 v54, v37, v36
  s_waitcnt vmcnt(6)
  ds_write_b64 v6, v[8:9] offset:0
  ds_write_b64 v6, v[10:11] offset:912
  s_waitcnt vmcnt(5)
  ds_write_b64 v6, v[12:13] offset:32
  ds_write_b64 v6, v[14:15] offset:944
  s_waitcnt vmcnt(4)
  ds_write_b64 v6, v[16:17] offset:64
  ds_write_b64 v6, v[18:19] offset:976
  s_waitcnt vmcnt(3)
  ds_write_b64 v6, v[20:21] offset:96
  ds_write_b64 v6, v[22:23] offset:1008
  s_waitcnt vmcnt(2)
  ds_write_b64 v6, v[24:25] offset:128
  ds_write_b64 v6, v[26:27] offset:1040
  s_waitcnt vmcnt(1)
  ds_write_b64 v6, v[28:29] offset:160
  ds_write_b64 v6, v[30:31] offset:1072
  s_waitcnt vmcnt(0)
  ds_write_b64 v6, v[32:33] offset:192
  ds_write_b64 v6, v[34:35] offset:1104
  s_waitcnt lgkmcnt(0)
  s_barrier
  s_mul_i32 s20, s18, 57344
  ds_read_b128 v[8:11], v40
  ds_read_b128 v[12:15], v41
  ds_read_b128 v[16:19], v42
  ds_read_b128 v[20:23], v43
  ds_read_b128 v[24:27], v44
  ds_read_b128 v[28:31], v45
  ds_read_b128 v[32:35], v46
  s_waitcnt lgkmcnt(6)
  buffer_store_dwordx4 v[8:11], v48, s[92:95], s20 offen
  s_waitcnt lgkmcnt(5)
  buffer_store_dwordx4 v[12:15], v49, s[92:95], s20 offen
  s_waitcnt lgkmcnt(4)
  buffer_store_dwordx4 v[16:19], v50, s[92:95], s20 offen
  s_waitcnt lgkmcnt(3)
  buffer_store_dwordx4 v[20:23], v51, s[92:95], s20 offen
  s_waitcnt lgkmcnt(2)
  buffer_store_dwordx4 v[24:27], v52, s[92:95], s20 offen
  s_waitcnt lgkmcnt(1)
  buffer_store_dwordx4 v[28:31], v53, s[92:95], s20 offen
  s_waitcnt lgkmcnt(0)
  buffer_store_dwordx4 v[32:35], v54, s[92:95], s20 offen
  s_branch wk_loop
wk_tk:
  s_and_b32 s18, s3, 3
  s_lshr_b32 s17, s3, 2
  s_cmp_lt_u32 s17, 8
  s_cbranch_scc1 wk_tokp
  s_sub_u32 s17, s17, 64
  s_cmp_ge_i32 s17, 56
  s_cbranch_scc1 wk_toko
  s_add_u32 s20, s17, 56
  s_lshr_b32 s17, s20, 1
  s_bitcmp0_b32 s20, 0
  s_cbranch_scc1 wk_toko
  s_add_u32 s17, s17, 8
wk_tokp:
  s_lshl_b32 s20, s18, 2
  s_add_u32 s20, s20, s16
  s_lshl_b32 s21, s17, 4
  s_add_u32 s21, s21, s20
  s_mul_i32 s21, s21, 28672
  s_add_u32 s21, s21, 12845056
  s_mul_i32 s23, s17, 28672
  s_add_u32 s23, s23, 73400320
  s_mul_i32 s24, s17, 7168
  s_add_u32 s24, s24, 88080384
  s_lshr_b32 s25, s17, 3
  s_lshl_b32 s25, s25, 4
  s_add_u32 s25, s25, s20
  s_lshl_b32 s25, s25, 7
  s_add_u32 s25, s25, 88557568
  v_mov_b32 v60, 0
  s_mov_b32 s30, 0
wp_wf:
  buffer_load_dword v61, v60, s[8:11], s25 offen sc1
  s_waitcnt vmcnt(0)
  v_cmp_ne_u32 vcc, 56, v61
  s_cbranch_vccz wp_wf_ok
  s_sleep 1
  s_cmp_ge_u32 s17, 61
  s_cbranch_scc1 wp_wf_bo
  s_sleep 4
  s_cmp_ge_u32 s17, 56
  s_cbranch_scc1 wp_wf_bo
  s_sleep 40
wp_wf_bo:
  s_add_u32 s30, s30, 1
  s_cmp_lt_u32 s30, 30000
  s_cbranch_scc1 wp_wf
  s_branch wp_abort
wp_wf_ok:
  s_add_u32 s22, s21, 0
  buffer_load_dwordx4 a[0:3], v2, s[8:11], s22 offen offset:0 sc1
  buffer_load_dwordx4 a[4:7], v2, s[8:11], s22 offen offset:1024 sc1
  buffer_load_dwordx4 a[8:11], v2, s[8:11], s22 offen offset:2048 sc1
  buffer_load_dwordx4 a[12:15], v2, s[8:11], s22 offen offset:3072 sc1
  s_add_u32 s22, s21, 4096
  buffer_load_dwordx4 a[16:19], v2, s[8:11], s22 offen offset:0 sc1
  buffer_load_dwordx4 a[20:23], v2, s[8:11], s22 offen offset:1024 sc1
  buffer_load_dwordx4 a[24:27], v2, s[8:11], s22 offen offset:2048 sc1
  buffer_load_dwordx4 a[28:31], v2, s[8:11], s22 offen offset:3072 sc1
  s_add_u32 s22, s21, 8192
  buffer_load_dwordx4 a[32:35], v2, s[8:11], s22 offen offset:0 sc1
  buffer_load_dwordx4 a[36:39], v2, s[8:11], s22 offen offset:1024 sc1
  buffer_load_dwordx4 a[40:43], v2, s[8:11], s22 offen offset:2048 sc1
  buffer_load_dwordx4 a[44:47], v2, s[8:11], s22 offen offset:3072 sc1
  s_add_u32 s22, s21, 12288
  buffer_load_dwordx4 a[48:51], v2, s[8:11], s22 offen offset:0 sc1
  buffer_load_dwordx4 a[52:55], v2, s[8:11], s22 offen offset:1024 sc1
  buffer_load_dwordx4 a[56:59], v2, s[8:11], s22 offen offset:2048 sc1
  buffer_load_dwordx4 a[60:63], v2, s[8:11], s22 offen offset:3072 sc1
  s_add_u32 s22, s21, 16384
  buffer_load_dwordx4 a[64:67], v2, s[8:11], s22 offen offset:0 sc1
  buffer_load_dwordx4 a[68:71], v2, s[8:11], s22 offen offset:1024 sc1
  buffer_load_dwordx4 a[72:75], v2, s[8:11], s22 offen offset:2048 sc1
  buffer_load_dwordx4 a[76:79], v2, s[8:11], s22 offen offset:3072 sc1
  s_add_u32 s22, s21, 20480
  buffer_load_dwordx4 a[80:83], v2, s[8:11], s22 offen offset:0 sc1
  buffer_load_dwordx4 a[84:87], v2, s[8:11], s22 offen offset:1024 sc1
  buffer_load_dwordx4 a[88:91], v2, s[8:11], s22 offen offset:2048 sc1
  buffer_load_dwordx4 a[92:95], v2, s[8:11], s22 offen offset:3072 sc1
  s_add_u32 s22, s21, 24576
  buffer_load_dwordx4 a[96:99], v2, s[8:11], s22 offen offset:0 sc1
  buffer_load_dwordx4 a[100:103], v2, s[8:11], s22 offen offset:1024 sc1
  buffer_load_dwordx4 a[104:107], v2, s[8:11], s22 offen offset:2048 sc1
  buffer_load_dwordx4 a[108:111], v2, s[8:11], s22 offen offset:3072 sc1
  s_add_u32 s22, s23, 0
  buffer_load_dwordx4 a[112:115], v2, s[8:11], s22 offen offset:0 sc1
  buffer_load_dwordx4 a[116:119], v2, s[8:11], s22 offen offset:1024 sc1
  buffer_load_dwordx4 a[120:123], v2, s[8:11], s22 offen offset:2048 sc1
  buffer_load_dwordx4 a[124:127], v2, s[8:11], s22 offen offset:3072 sc1
  s_add_u32 s22, s23, 4096
  buffer_load_dwordx4 a[128:131], v2, s[8:11], s22 offen offset:0 sc1
  buffer_load_dwordx4 a[132:135], v2, s[8:11], s22 offen offset:1024 sc1
  buffer_load_dwordx4 a[136:139], v2, s[8:11], s22 offen offset:2048 sc1
  buffer_load_dwordx4 a[140:143], v2, s[8:11], s22 offen offset:3072 sc1
  s_add_u32 s22, s23, 8192
  buffer_load_dwordx4 a[144:147], v2, s[8:11], s22 offen offset:0 sc1
  buffer_load_dwordx4 a[148:151], v2, s[8:11], s22 offen offset:1024 sc1
  buffer_load_dwordx4 a[152:155], v2, s[8:11], s22 offen offset:2048 sc1
  buffer_load_dwordx4 a[156:159], v2, s[8:11], s22 offen offset:3072 sc1
  s_add_u32 s22, s23, 12288
  buffer_load_dwordx4 a[160:163], v2, s[8:11], s22 offen offset:0 sc1
  buffer_load_dwordx4 a[164:167], v2, s[8:11], s22 offen offset:1024 sc1
  buffer_load_dwordx4 a[168:171], v2, s[8:11], s22 offen offset:2048 sc1
  buffer_load_dwordx4 a[172:175], v2, s[8:11], s22 offen offset:3072 sc1
  s_add_u32 s22, s23, 16384
  buffer_load_dwordx4 a[176:179], v2, s[8:11], s22 offen offset:0 sc1
  buffer_load_dwordx4 a[180:183], v2, s[8:11], s22 offen offset:1024 sc1
  buffer_load_dwordx4 a[184:187], v2, s[8:11], s22 offen offset:2048 sc1
  buffer_load_dwordx4 a[188:191], v2, s[8:11], s22 offen offset:3072 sc1
  s_add_u32 s22, s23, 20480
  buffer_load_dwordx4 a[192:195], v2, s[8:11], s22 offen offset:0 sc1
  buffer_load_dwordx4 a[196:199], v2, s[8:11], s22 offen offset:1024 sc1
  buffer_load_dwordx4 a[200:203], v2, s[8:11], s22 offen offset:2048 sc1
  buffer_load_dwordx4 a[204:207], v2, s[8:11], s22 offen offset:3072 sc1
  s_add_u32 s22, s23, 24576
  buffer_load_dwordx4 a[208:211], v2, s[8:11], s22 offen offset:0 sc1
  buffer_load_dwordx4 a[212:215], v2, s[8:11], s22 offen offset:1024 sc1
  buffer_load_dwordx4 a[216:219], v2, s[8:11], s22 offen offset:2048 sc1
  buffer_load_dwordx4 a[220:223], v2, s[8:11], s22 offen offset:3072 sc1
  v_lshl_add_u32 v5, v3, 2, 0
  v_cmp_le_u32 s[40:41], v5, v4
  v_lshl_add_u32 v5, v3, 2, 1
  v_cmp_le_u32 s[42:43], v5, v4
  v_lshl_add_u32 v5, v3, 2, 2
  v_cmp_le_u32 s[44:45], v5, v4
  v_lshl_add_u32 v5, v3, 2, 3
  v_cmp_le_u32 s[46:47], v5, v4
  v_cmp_gt_u32 s[48:49], 2, v3
  v_mov_b32 v6, 0xff800000
  s_waitcnt vmcnt(0)
  v_mfma_f32_16x16x32_bf16 v[8:11], a[112:115], a[0:3], 0
  v_mfma_f32_16x16x32_bf16 v[12:15], a[112:115], a[56:59], 0
  v_mfma_f32_16x16x32_bf16 v[16:19], a[168:171], a[56:59], 0
  v_mfma_f32_16x16x32_bf16 v[8:11], a[116:119], a[4:7], v[8:11]
  v_mfma_f32_16x16x32_bf16 v[12:15], a[116:119], a[60:63], v[12:15]
  v_mfma_f32_16x16x32_bf16 v[16:19], a[172:175], a[60:63], v[16:19]
  v_mfma_f32_16x16x32_bf16 v[8:11], a[120:123], a[8:11], v[8:11]
  v_mfma_f32_16x16x32_bf16 v[12:15], a[120:123], a[64:67], v[12:15]
  v_mfma_f32_16x16x32_bf16 v[16:19], a[176:179], a[64:67], v[16:19]
  v_mfma_f32_16x16x32_bf16 v[8:11], a[124:127], a[12:15], v[8:11]
  v_mfma_f32_16x16x32_bf16 v[12:15], a[124:127], a[68:71], v[12:15]
  v_mfma_f32_16x16x32_bf16 v[16:19], a[180:183], a[68:71], v[16:19]
  v_mfma_f32_16x16x32_bf16 v[8:11], a[128:131], a[16:19], v[8:11]
  v_mfma_f32_16x16x32_bf16 v[12:15], a[128:131], a[72:75], v[12:15]
  v_mfma_f32_16x16x32_bf16 v[16:19], a[184:187], a[72:75], v[16:19]
  v_mfma_f32_16x16x32_bf16 v[8:11], a[132:135], a[20:23], v[8:11]
  v_mfma_f32_16x16x32_bf16 v[12:15], a[132:135], a[76:79], v[12:15]
  v_mfma_f32_16x16x32_bf16 v[16:19], a[188:191], a[76:79], v[16:19]
  v_mfma_f32_16x16x32_bf16 v[8:11], a[136:139], a[24:27], v[8:11]
  v_mfma_f32_16x16x32_bf16 v[12:15], a[136:139], a[80:83], v[12:15]
  v_mfma_f32_16x16x32_bf16 v[16:19], a[192:195], a[80:83], v[16:19]
  v_mfma_f32_16x16x32_bf16 v[8:11], a[140:143], a[28:31], v[8:11]
  v_mfma_f32_16x16x32_bf16 v[12:15], a[140:143], a[84:87], v[12:15]
  v_mfma_f32_16x16x32_bf16 v[16:19], a[196:199], a[84:87], v[16:19]
  v_mfma_f32_16x16x32_bf16 v[8:11], a[144:147], a[32:35], v[8:11]
  v_mfma_f32_16x16x32_bf16 v[12:15], a[144:147], a[88:91], v[12:15]
  v_mfma_f32_16x16x32_bf16 v[16:19], a[200:203], a[88:91], v[16:19]
  v_mfma_f32_16x16x32_bf16 v[8:11], a[148:151], a[36:39], v[8:11]
  v_mfma_f32_16x16x32_bf16 v[12:15], a[148:151], a[92:95], v[12:15]
  v_mfma_f32_16x16x32_bf16 v[16:19], a[204:207], a[92:95], v[16:19]
  v_mfma_f32_16x16x32_bf16 v[8:11], a[152:155], a[40:43], v[8:11]
  v_mfma_f32_16x16x32_bf16 v[12:15], a[152:155], a[96:99], v[12:15]
  v_mfma_f32_16x16x32_bf16 v[16:19], a[208:211], a[96:99], v[16:19]
  v_mfma_f32_16x16x32_bf16 v[8:11], a[156:159], a[44:47], v[8:11]
  v_mfma_f32_16x16x32_bf16 v[12:15], a[156:159], a[100:103], v[12:15]
  v_mfma_f32_16x16x32_bf16 v[16:19], a[212:215], a[100:103], v[16:19]
  v_mfma_f32_16x16x32_bf16 v[8:11], a[160:163], a[48:51], v[8:11]
  v_mfma_f32_16x16x32_bf16 v[12:15], a[160:163], a[104:107], v[12:15]
  v_mfma_f32_16x16x32_bf16 v[16:19], a[216:219], a[104:107], v[16:19]
  v_mfma_f32_16x16x32_bf16 v[8:11], a[164:167], a[52:55], v[8:11]
  v_mfma_f32_16x16x32_bf16 v[12:15], a[164:167], a[108:111], v[12:15]
  v_mfma_f32_16x16x32_bf16 v[16:19], a[220:223], a[108:111], v[16:19]
  s_mul_i32 s22, s20, 448
  v_mov_b32 v62, s22
  s_mov_b32 s30, 0
wp_pm:
  s_cmp_ge_u32 s17, 64
  s_cbranch_scc1 wp_pf
  s_cmp_ge_u32 s17, 61
  s_cbranch_scc1 mp_45a
  v_mov_b32 v61, 0
  s_mov_b64 exec, 1
  buffer_atomic_or v61, v62, s[8:11], s24 offen sc0
  s_mov_b64 exec, -1
  s_branch mp_45b
mp_45a:
  buffer_load_dword v61, v62, s[8:11], s24 offen sc1
mp_45b:
  s_waitcnt vmcnt(0)
  v_cmp_eq_u32 vcc, -1, v61
  s_cbranch_vccnz wp_pr
wp_pf:
  s_add_u32 s22, s24, 4096
  buffer_load_dwordx4 v[64:67], v2, s[8:11], s24 offen offset:0 sc1
  buffer_load_dwordx4 v[68:71], v2, s[8:11], s24 offen offset:1024 sc1
  buffer_load_dwordx4 v[72:75], v2, s[8:11], s24 offen offset:2048 sc1
  buffer_load_dwordx4 v[76:79], v2, s[8:11], s24 offen offset:3072 sc1
  buffer_load_dwordx4 v[80:83], v2, s[8:11], s22 offen offset:0 sc1
  buffer_load_dwordx4 v[84:87], v2, s[8:11], s22 offen offset:1024 sc1
  buffer_load_dwordx4 v[88:91], v2, s[8:11], s22 offen offset:2048 sc1
  s_waitcnt vmcnt(0)
  v_max_u32 v61, v64, v65
  v_max3_u32 v61, v61, v66, v67
  v_max3_u32 v61, v61, v68, v69
  v_max3_u32 v61, v61, v70, v71
  v_max3_u32 v61, v61, v72, v73
  v_max3_u32 v61, v61, v74, v75
  v_max3_u32 v61, v61, v76, v77
  v_max3_u32 v61, v61, v78, v79
  v_max3_u32 v61, v61, v80, v81
  v_max3_u32 v61, v61, v82, v83
  v_max3_u32 v61, v61, v84, v85
  v_max3_u32 v61, v61, v86, v87
  v_max3_u32 v61, v61, v88, v89
  v_max3_u32 v61, v61, v90, v91
  v_cmp_eq_u32 vcc, -1, v61
  s_cbranch_vccz wp_pk
wp_pr:
  s_sleep 1
  s_cmp_ge_u32 s17, 61
  s_cbranch_scc1 wp_pm_bo
  s_sleep 4
  s_cmp_ge_u32 s17, 56
  s_cbranch_scc1 wp_pm_bo
  s_sleep 40
wp_pm_bo:
  s_add_u32 s30, s30, 1
  s_cmp_lt_u32 s30, 30000
  s_cbranch_scc1 wp_pm
  s_branch wp_abort
wp_pk:
  s_cmp_lt_u32 s17, 56
  s_cbranch_scc1 pk_46
  buffer_load_dword v250, v251, s[12:15], 0 offen sc1
pk_46:
  v_mfma_f32_16x16x32_bf16 v[20:23], v[64:67], a[0:3], 0
  v_mfma_f32_16x16x32_bf16 v[24:27], v[64:67], a[4:7], 0
  v_mfma_f32_16x16x32_bf16 v[28:31], v[64:67], a[56:59], 0
  v_mfma_f32_16x16x32_bf16 v[32:35], v[64:67], a[60:63], 0
  v_mfma_f32_16x16x32_bf16 v[20:23], v[68:71], a[8:11], v[20:23]
  v_mfma_f32_16x16x32_bf16 v[24:27], v[68:71], a[12:15], v[24:27]
  v_mfma_f32_16x16x32_bf16 v[28:31], v[68:71], a[64:67], v[28:31]
  v_mfma_f32_16x16x32_bf16 v[32:35], v[68:71], a[68:71], v[32:35]
  v_mfma_f32_16x16x32_bf16 v[20:23], v[72:75], a[16:19], v[20:23]
  v_mfma_f32_16x16x32_bf16 v[24:27], v[72:75], a[20:23], v[24:27]
  v_mfma_f32_16x16x32_bf16 v[28:31], v[72:75], a[72:75], v[28:31]
  v_mfma_f32_16x16x32_bf16 v[32:35], v[72:75], a[76:79], v[32:35]
  v_mfma_f32_16x16x32_bf16 v[20:23], v[76:79], a[24:27], v[20:23]
  v_mfma_f32_16x16x32_bf16 v[24:27], v[76:79], a[28:31], v[24:27]
  v_mfma_f32_16x16x32_bf16 v[28:31], v[76:79], a[80:83], v[28:31]
  v_mfma_f32_16x16x32_bf16 v[32:35], v[76:79], a[84:87], v[32:35]
  v_mfma_f32_16x16x32_bf16 v[20:23], v[80:83], a[32:35], v[20:23]
  v_mfma_f32_16x16x32_bf16 v[24:27], v[80:83], a[36:39], v[24:27]
  v_mfma_f32_16x16x32_bf16 v[28:31], v[80:83], a[88:91], v[28:31]
  v_mfma_f32_16x16x32_bf16 v[32:35], v[80:83], a[92:95], v[32:35]
  v_mfma_f32_16x16x32_bf16 v[20:23], v[84:87], a[40:43], v[20:23]
  v_mfma_f32_16x16x32_bf16 v[24:27], v[84:87], a[44:47], v[24:27]
  v_mfma_f32_16x16x32_bf16 v[28:31], v[84:87], a[96:99], v[28:31]
  v_mfma_f32_16x16x32_bf16 v[32:35], v[84:87], a[100:103], v[32:35]
  v_mfma_f32_16x16x32_bf16 v[20:23], v[88:91], a[48:51], v[20:23]
  v_mfma_f32_16x16x32_bf16 v[24:27], v[88:91], a[52:55], v[24:27]
  v_mfma_f32_16x16x32_bf16 v[28:31], v[88:91], a[104:107], v[28:31]
  v_mfma_f32_16x16x32_bf16 v[32:35], v[88:91], a[108:111], v[32:35]
  s_lshl_b32 s25, s17, 1
  s_mul_i32 s25, s25, 20480
  s_add_u32 s25, s25, 85458944
  s_lshl_b32 s26, s20, 10
  s_add_u32 s26, s26, s25
  s_lshl_b32 s27, s18, 10
  s_add_u32 s27, s27, s25
  s_lshr_b32 s28, s16, 1
  s_lshl_b32 s28, s28, 3
  s_add_u32 s27, s27, s28
  s_add_u32 s27, s27, 16384
  s_and_b32 s28, s16, 1
  s_cmp_eq_u32 s28, 0
  s_cselect_b32 s50, -1, 0
  s_cselect_b32 s51, 0, -1
  v_cndmask_b32 v8, v6, v8, s[40:41]
  v_cndmask_b32 v9, v6, v9, s[42:43]
  v_cndmask_b32 v10, v6, v10, s[44:45]
  v_cndmask_b32 v11, v6, v11, s[46:47]
  v_cndmask_b32 v20, v24, v20, s[48:49]
  v_cndmask_b32 v21, v25, v21, s[48:49]
  v_cndmask_b32 v22, v26, v22, s[48:49]
  v_cndmask_b32 v23, v27, v23, s[48:49]
  v_mov_b32 v24, v20
  v_mov_b32 v25, v21
  v_mov_b32 v26, v22
  v_mov_b32 v27, v23
  v_permlane32_swap_b32 v20, v24
  v_permlane32_swap_b32 v21, v25
  v_permlane32_swap_b32 v22, v26
  v_permlane32_swap_b32 v23, v27
  v_add_f32 v20, v20, v24
  v_add_f32 v21, v21, v25
  v_add_f32 v22, v22, v26
  v_add_f32 v23, v23, v27
  v_max3_f32 v40, v8, v9, v10
  v_max3_f32 v40, v40, v11, v20
  v_max3_f32 v40, v40, v21, v22
  v_max_f32 v40, v40, v23
  v_mov_b32 v41, v40
  s_nop 1
  v_permlane16_swap_b32 v40, v41
  v_max_f32 v40, v40, v41
  v_mov_b32 v41, v40
  s_nop 1
  v_permlane32_swap_b32 v40, v41
  v_max_f32 v40, v40, v41
  v_sub_f32 v8, v8, v40
  v_sub_f32 v9, v9, v40
  v_sub_f32 v10, v10, v40
  v_sub_f32 v11, v11, v40
  v_sub_f32 v20, v20, v40
  v_sub_f32 v21, v21, v40
  v_sub_f32 v22, v22, v40
  v_sub_f32 v23, v23, v40
  v_exp_f32 v8, v8
  v_exp_f32 v9, v9
  v_exp_f32 v10, v10
  v_exp_f32 v11, v11
  v_exp_f32 v20, v20
  v_exp_f32 v21, v21
  v_exp_f32 v22, v22
  v_exp_f32 v23, v23
  v_add_f32 v42, v20, v21
  v_add_f32 v43, v22, v23
  v_add_f32 v42, v42, v43
  v_mul_f32 v42, 0.5, v42
  v_add_f32 v42, v42, v8
  v_add_f32 v42, v42, v9
  v_add_f32 v42, v42, v10
  v_add_f32 v42, v42, v11
  v_mov_b32 v41, v42
  s_nop 1
  v_permlane16_swap_b32 v42, v41
  v_add_f32 v42, v42, v41
  v_mov_b32 v41, v42
  s_nop 1
  v_permlane32_swap_b32 v42, v41
  v_add_f32 v42, v42, v41
  v_rcp_f32 v42, v42
  s_nop 0
  v_mul_f32 v8, v8, v42
  v_mul_f32 v9, v9, v42
  v_mul_f32 v10, v10, v42
  v_mul_f32 v11, v11, v42
  v_mul_f32 v20, v20, v42
  v_mul_f32 v21, v21, v42
  v_mul_f32 v22, v22, v42
  v_mul_f32 v23, v23, v42
  v_cvt_pk_bf16_f32 v44, v8, v9
  v_cvt_pk_bf16_f32 v45, v10, v11
  v_mov_b32 v46, 0
  v_mov_b32 v47, 0
  v_cvt_pk_bf16_f32 v48, v20, v21
  v_cvt_pk_bf16_f32 v49, v22, v23
  v_min_u32 v44, -2, v44
  v_min_u32 v45, -2, v45
  v_min_u32 v46, -2, v46
  v_min_u32 v47, -2, v47
  v_min_u32 v48, -2, v48
  v_min_u32 v49, -2, v49
  buffer_store_dwordx4 v[44:47], v2, s[8:11], s26 offen sc1
  s_mov_b64 exec, s[50:51]
  buffer_store_dwordx2 v[48:49], v2, s[8:11], s27 offen sc1
  s_mov_b64 exec, -1
  s_add_u32 s26, s26, 20480
  s_add_u32 s27, s27, 20480
  v_cndmask_b32 v16, v6, v16, s[40:41]
  v_cndmask_b32 v17, v6, v17, s[42:43]
  v_cndmask_b32 v18, v6, v18, s[44:45]
  v_cndmask_b32 v19, v6, v19, s[46:47]
  v_cndmask_b32 v28, v32, v28, s[48:49]
  v_cndmask_b32 v29, v33, v29, s[48:49]
  v_cndmask_b32 v30, v34, v30, s[48:49]
  v_cndmask_b32 v31, v35, v31, s[48:49]
  v_mov_b32 v32, v28
  v_mov_b32 v33, v29
  v_mov_b32 v34, v30
  v_mov_b32 v35, v31
  v_permlane32_swap_b32 v28, v32
  v_permlane32_swap_b32 v29, v33
  v_permlane32_swap_b32 v30, v34
  v_permlane32_swap_b32 v31, v35
  v_add_f32 v28, v28, v32
  v_add_f32 v29, v29, v33
  v_add_f32 v30, v30, v34
  v_add_f32 v31, v31, v35
  v_max3_f32 v40, v12, v13, v14
  v_max3_f32 v40, v40, v15, v16
  v_max3_f32 v40, v40, v17, v18
  v_max3_f32 v40, v40, v19, v28
  v_max3_f32 v40, v40, v29, v30
  v_max_f32 v40, v40, v31
  v_mov_b32 v41, v40
  s_nop 1
  v_permlane16_swap_b32 v40, v41
  v_max_f32 v40, v40, v41
  v_mov_b32 v41, v40
  s_nop 1
  v_permlane32_swap_b32 v40, v41
  v_max_f32 v40, v40, v41
  v_sub_f32 v12, v12, v40
  v_sub_f32 v13, v13, v40
  v_sub_f32 v14, v14, v40
  v_sub_f32 v15, v15, v40
  v_sub_f32 v16, v16, v40
  v_sub_f32 v17, v17, v40
  v_sub_f32 v18, v18, v40
  v_sub_f32 v19, v19, v40
  v_sub_f32 v28, v28, v40
  v_sub_f32 v29, v29, v40
  v_sub_f32 v30, v30, v40
  v_sub_f32 v31, v31, v40
  v_exp_f32 v12, v12
  v_exp_f32 v13, v13
  v_exp_f32 v14, v14
  v_exp_f32 v15, v15
  v_exp_f32 v16, v16
  v_exp_f32 v17, v17
  v_exp_f32 v18, v18
  v_exp_f32 v19, v19
  v_exp_f32 v28, v28
  v_exp_f32 v29, v29
  v_exp_f32 v30, v30
  v_exp_f32 v31, v31
  v_add_f32 v42, v28, v29
  v_add_f32 v43, v30, v31
  v_add_f32 v42, v42, v43
  v_mul_f32 v42, 0.5, v42
  v_add_f32 v42, v42, v12
  v_add_f32 v42, v42, v13
  v_add_f32 v42, v42, v14
  v_add_f32 v42, v42, v15
  v_add_f32 v42, v42, v16
  v_add_f32 v42, v42, v17
  v_add_f32 v42, v42, v18
  v_add_f32 v42, v42, v19
  v_mov_b32 v41, v42
  s_nop 1
  v_permlane16_swap_b32 v42, v41
  v_add_f32 v42, v42, v41
  v_mov_b32 v41, v42
  s_nop 1
  v_permlane32_swap_b32 v42, v41
  v_add_f32 v42, v42, v41
  v_rcp_f32 v42, v42
  s_nop 0
  v_mul_f32 v12, v12, v42
  v_mul_f32 v13, v13, v42
  v_mul_f32 v14, v14, v42
  v_mul_f32 v15, v15, v42
  v_mul_f32 v16, v16, v42
  v_mul_f32 v17, v17, v42
  v_mul_f32 v18, v18, v42
  v_mul_f32 v19, v19, v42
  v_mul_f32 v28, v28, v42
  v_mul_f32 v29, v29, v42
  v_mul_f32 v30, v30, v42
  v_mul_f32 v31, v31, v42
  v_cvt_pk_bf16_f32 v52, v12, v13
  v_cvt_pk_bf16_f32 v53, v14, v15
  v_cvt_pk_bf16_f32 v54, v16, v17
  v_cvt_pk_bf16_f32 v55, v18, v19
  v_cvt_pk_bf16_f32 v56, v28, v29
  v_cvt_pk_bf16_f32 v57, v30, v31
  v_min_u32 v52, -2, v52
  v_min_u32 v53, -2, v53
  v_min_u32 v54, -2, v54
  v_min_u32 v55, -2, v55
  v_min_u32 v56, -2, v56
  v_min_u32 v57, -2, v57
  buffer_store_dwordx4 v[52:55], v2, s[8:11], s26 offen sc1
  s_mov_b64 exec, s[50:51]
  buffer_store_dwordx2 v[56:57], v2, s[8:11], s27 offen sc1
  s_mov_b64 exec, -1
  s_lshl_b32 s25, s17, 7
  s_add_u32 s25, s25, 88573952
  v_mov_b32 v5, 1
  v_mov_b32 v6, 0
  s_waitcnt vmcnt(0)
  s_mov_b64 exec, 1
  buffer_atomic_add v5, v6, s[8:11], s25 offen
  s_mov_b64 exec, -1
  s_branch wk_loop
wk_toko:
  s_lshl_b32 s20, s18, 2
  s_add_u32 s20, s20, s16
  s_mul_i32 s24, s20, 65
  s_add_u32 s24, s24, s17
  s_lshl_b32 s24, s24, 13
  s_add_u32 s24, s24, 76947456
  s_lshl_b32 s21, s20, 6
  s_add_u32 s21, s21, s17
  s_mul_i32 s21, s21, 28672
  s_add_u32 s21, s21, 42205184
  s_lshl_b32 s25, s17, 1
  s_mul_i32 s25, s25, 20480
  s_add_u32 s25, s25, 85458944
  v_lshrrev_b32 v8, 5, v1
  v_and_b32 v9, 31, v1
  v_min_u32 v5, 27, v9
  v_mad_u32_u24 v5, v8, 28, v5
  v_lshlrev_b32 v5, 4, v5
  v_lshrrev_b32 v10, 4, v9
  v_lshlrev_b32 v7, 10, v10
  v_lshl_add_u32 v7, v4, 4, v7
  v_lshl_add_u32 v7, v8, 3, v7
  v_mul_u32_u24 v6, 20480, v10
  v_lshl_add_u32 v6, v8, 8, v6
  v_lshl_add_u32 v6, v4, 4, v6
  s_lshr_b32 s26, s17, 3
  s_lshl_b32 s26, s26, 4
  s_add_u32 s26, s26, s20
  s_lshl_b32 s26, s26, 7
  s_add_u32 s26, s26, 88541184
  v_mov_b32 v60, 0
  s_mov_b32 s30, 0
wo_wv:
  buffer_load_dword v61, v60, s[8:11], s26 offen sc1
  s_waitcnt vmcnt(0)
  v_cmp_ne_u32 vcc, 56, v61
  s_cbranch_vccz wo_wv_ok
  s_sleep 1
  s_cmp_ge_u32 s17, 61
  s_cbranch_scc1 wo_wv_bo
  s_sleep 4
  s_cmp_ge_u32 s17, 56
  s_cbranch_scc1 wo_wv_bo
  s_sleep 40
wo_wv_bo:
  s_add_u32 s30, s30, 1
  s_cmp_lt_u32 s30, 30000
  s_cbranch_scc1 wo_wv
  s_branch wo_abort
wo_wv_ok:
  s_add_u32 s22, s21, 0
  buffer_load_dwordx4 a[0:3], v5, s[8:11], s22 offen offset:0 sc1
  buffer_load_dwordx4 a[4:7], v5, s[8:11], s22 offen offset:896 sc1
  buffer_load_dwordx4 a[8:11], v5, s[8:11], s22 offen offset:1792 sc1
  buffer_load_dwordx4 a[12:15], v5, s[8:11], s22 offen offset:2688 sc1
  s_add_u32 s22, s21, 3584
  buffer_load_dwordx4 a[16:19], v5, s[8:11], s22 offen offset:0 sc1
  buffer_load_dwordx4 a[20:23], v5, s[8:11], s22 offen offset:896 sc1
  buffer_load_dwordx4 a[24:27], v5, s[8:11], s22 offen offset:1792 sc1
  buffer_load_dwordx4 a[28:31], v5, s[8:11], s22 offen offset:2688 sc1
  s_add_u32 s22, s21, 7168
  buffer_load_dwordx4 a[32:35], v5, s[8:11], s22 offen offset:0 sc1
  buffer_load_dwordx4 a[36:39], v5, s[8:11], s22 offen offset:896 sc1
  buffer_load_dwordx4 a[40:43], v5, s[8:11], s22 offen offset:1792 sc1
  buffer_load_dwordx4 a[44:47], v5, s[8:11], s22 offen offset:2688 sc1
  s_add_u32 s22, s21, 10752
  buffer_load_dwordx4 a[48:51], v5, s[8:11], s22 offen offset:0 sc1
  buffer_load_dwordx4 a[52:55], v5, s[8:11], s22 offen offset:896 sc1
  buffer_load_dwordx4 a[56:59], v5, s[8:11], s22 offen offset:1792 sc1
  buffer_load_dwordx4 a[60:63], v5, s[8:11], s22 offen offset:2688 sc1
  s_add_u32 s22, s21, 14336
  buffer_load_dwordx4 a[64:67], v5, s[8:11], s22 offen offset:0 sc1
  buffer_load_dwordx4 a[68:71], v5, s[8:11], s22 offen offset:896 sc1
  buffer_load_dwordx4 a[72:75], v5, s[8:11], s22 offen offset:1792 sc1
  buffer_load_dwordx4 a[76:79], v5, s[8:11], s22 offen offset:2688 sc1
  s_add_u32 s22, s21, 17920
  buffer_load_dwordx4 a[80:83], v5, s[8:11], s22 offen offset:0 sc1
  buffer_load_dwordx4 a[84:87], v5, s[8:11], s22 offen offset:896 sc1
  buffer_load_dwordx4 a[88:91], v5, s[8:11], s22 offen offset:1792 sc1
  buffer_load_dwordx4 a[92:95], v5, s[8:11], s22 offen offset:2688 sc1
  s_add_u32 s22, s21, 21504
  buffer_load_dwordx4 a[96:99], v5, s[8:11], s22 offen offset:0 sc1
  buffer_load_dwordx4 a[100:103], v5, s[8:11], s22 offen offset:896 sc1
  buffer_load_dwordx4 a[104:107], v5, s[8:11], s22 offen offset:1792 sc1
  buffer_load_dwordx4 a[108:111], v5, s[8:11], s22 offen offset:2688 sc1
  s_add_u32 s22, s21, 25088
  buffer_load_dwordx4 a[112:115], v5, s[8:11], s22 offen offset:0 sc1
  buffer_load_dwordx4 a[116:119], v5, s[8:11], s22 offen offset:896 sc1
  buffer_load_dwordx4 a[120:123], v5, s[8:11], s22 offen offset:1792 sc1
  buffer_load_dwordx4 a[124:127], v5, s[8:11], s22 offen offset:2688 sc1
  s_cmp_ge_u32 s17, 61
  s_cbranch_scc1 wo_lm
  s_lshl_b32 s26, s17, 7
  s_add_u32 s26, s26, 88573952
  v_mov_b32 v60, 0
  s_mov_b32 s30, 0
wo_wp:
  buffer_load_dword v61, v60, s[8:11], s26 offen sc1
  s_waitcnt vmcnt(0)
  v_cmp_ne_u32 vcc, 16, v61
  s_cbranch_vccz wo_wp_ok
  s_sleep 2
  s_cmp_ge_u32 s17, 61
  s_cbranch_scc1 wo_wp_bo
  s_sleep 4
  s_cmp_ge_u32 s17, 56
  s_cbranch_scc1 wo_wp_bo
  s_sleep 40
wo_wp_bo:
  s_add_u32 s30, s30, 1
  s_cmp_lt_u32 s30, 30000
  s_cbranch_scc1 wo_wp
  s_branch wo_abort
wo_wp_ok:
  s_branch wo_lp
wo_lm:
  s_mul_i32 s26, s17, 7168
  s_add_u32 s26, s26, 88080384
  v_mov_b32 v60, 0
  s_mov_b32 s30, 0
wo_wm:
  buffer_load_dword v61, v60, s[8:11], s26 offen sc1
  s_waitcnt vmcnt(0)
  v_cmp_eq_u32 vcc, -1, v61
  s_cbranch_vccz wo_wm_ok
  s_sleep 2
  s_cmp_ge_u32 s17, 61
  s_cbranch_scc1 wo_wm_bo
  s_sleep 4
  s_cmp_ge_u32 s17, 56
  s_cbranch_scc1 wo_wm_bo
  s_sleep 40
wo_wm_bo:
  s_add_u32 s30, s30, 1
  s_cmp_lt_u32 s30, 30000
  s_cbranch_scc1 wo_wm
  s_branch wo_abort
wo_wm_ok:
wo_lp:
  s_mul_i32 s26, s16, 10240
  s_add_u32 s27, s25, s26
  v_add_u32 v11, s26, v2
  s_lshl_b32 s26, s20, 6
  s_add_u32 s26, s26, s17
  s_lshl_b32 s26, s26, 4
  s_add_u32 s26, s26, 88582144
  v_lshlrev_b32 v60, 2, v3
  s_mov_b32 s30, 0
wo_pl:
  s_add_u32 s22, s27, 0
  buffer_load_dwordx4 v[128:131], v2, s[8:11], s22 offen offset:0 sc1
  buffer_load_dwordx4 v[132:135], v2, s[8:11], s22 offen offset:1024 sc1
  buffer_load_dwordx4 v[136:139], v2, s[8:11], s22 offen offset:2048 sc1
  buffer_load_dwordx4 v[140:143], v2, s[8:11], s22 offen offset:3072 sc1
  s_add_u32 s22, s27, 4096
  buffer_load_dwordx4 v[144:147], v2, s[8:11], s22 offen offset:0 sc1
  buffer_load_dwordx4 v[148:151], v2, s[8:11], s22 offen offset:1024 sc1
  buffer_load_dwordx4 v[152:155], v2, s[8:11], s22 offen offset:2048 sc1
  buffer_load_dwordx4 v[156:159], v2, s[8:11], s22 offen offset:3072 sc1
  s_add_u32 s22, s27, 8192
  buffer_load_dwordx4 v[160:163], v2, s[8:11], s22 offen offset:0 sc1
  buffer_load_dwordx4 v[164:167], v2, s[8:11], s22 offen offset:1024 sc1
  buffer_load_dword v61, v60, s[8:11], s26 offen sc1
  s_waitcnt vmcnt(1)
  v_max_u32 v62, v128, v129
  v_max3_u32 v62, v62, v130, v131
  v_max3_u32 v62, v62, v132, v133
  v_max3_u32 v62, v62, v134, v135
  v_max3_u32 v62, v62, v136, v137
  v_max3_u32 v62, v62, v138, v139
  v_max3_u32 v62, v62, v140, v141
  v_max3_u32 v62, v62, v142, v143
  v_max3_u32 v62, v62, v144, v145
  v_max3_u32 v62, v62, v146, v147
  v_max3_u32 v62, v62, v148, v149
  v_max3_u32 v62, v62, v150, v151
  v_max3_u32 v62, v62, v152, v153
  v_max3_u32 v62, v62, v154, v155
  v_max3_u32 v62, v62, v156, v157
  v_max3_u32 v62, v62, v158, v159
  v_max3_u32 v62, v62, v160, v161
  v_max3_u32 v62, v62, v162, v163
  v_max3_u32 v62, v62, v164, v165
  v_max3_u32 v62, v62, v166, v167
  v_cmp_eq_u32 vcc, -1, v62
  s_cbranch_vccz wo_pk
  s_add_u32 s30, s30, 1
  s_cmp_lt_u32 s30, 30000
  s_cbranch_scc1 wo_pl
  s_branch wo_abort
wo_pk:
  ds_write_b128 v11, v[128:131] offset:0
  ds_write_b128 v11, v[132:135] offset:1024
  ds_write_b128 v11, v[136:139] offset:2048
  ds_write_b128 v11, v[140:143] offset:3072
  ds_write_b128 v11, v[144:147] offset:4096
  ds_write_b128 v11, v[148:151] offset:5120
  ds_write_b128 v11, v[152:155] offset:6144
  ds_write_b128 v11, v[156:159] offset:7168
  ds_write_b128 v11, v[160:163] offset:8192
  ds_write_b128 v11, v[164:167] offset:9216
  s_waitcnt vmcnt(0)
  v_cmp_ne_u32 vcc, 1, v61
  s_mov_b32 s28, 0
  s_cbranch_vccnz wo_nt
  s_add_u32 s22, s24, 0
  buffer_load_dwordx2 v[28:29], v7, s[8:11], s22 offen offset:0 sc1
  buffer_load_dwordx2 v[30:31], v7, s[8:11], s22 offen offset:512 sc1
  buffer_load_dwordx2 v[32:33], v7, s[8:11], s22 offen offset:256 sc1
  buffer_load_dwordx2 v[34:35], v7, s[8:11], s22 offen offset:768 sc1
  buffer_load_dwordx2 v[36:37], v7, s[8:11], s22 offen offset:2048 sc1
  buffer_load_dwordx2 v[38:39], v7, s[8:11], s22 offen offset:2560 sc1
  buffer_load_dwordx2 v[40:41], v7, s[8:11], s22 offen offset:2304 sc1
  buffer_load_dwordx2 v[42:43], v7, s[8:11], s22 offen offset:2816 sc1
  s_add_u32 s22, s24, 4096
  buffer_load_dwordx2 v[44:45], v7, s[8:11], s22 offen offset:0 sc1
  buffer_load_dwordx2 v[46:47], v7, s[8:11], s22 offen offset:512 sc1
  buffer_load_dwordx2 v[48:49], v7, s[8:11], s22 offen offset:256 sc1
  buffer_load_dwordx2 v[50:51], v7, s[8:11], s22 offen offset:768 sc1
  buffer_load_dwordx2 v[52:53], v7, s[8:11], s22 offen offset:2048 sc1
  buffer_load_dwordx2 v[54:55], v7, s[8:11], s22 offen offset:2560 sc1
  buffer_load_dwordx2 v[56:57], v7, s[8:11], s22 offen offset:2304 sc1
  buffer_load_dwordx2 v[58:59], v7, s[8:11], s22 offen offset:2816 sc1
  s_mov_b32 s28, 1
wo_nt:
  s_cmp_lt_u32 s17, 56
  s_cbranch_scc1 pk_47
  buffer_load_dword v250, v251, s[12:15], 0 offen sc1
pk_47:
  s_waitcnt lgkmcnt(0)
  s_barrier
  buffer_load_dword v61, v60, s[8:11], s26 offen sc1
  ds_read_b128 v[64:67], v6 offset:0
  ds_read_b128 v[68:71], v6 offset:512
  ds_read_b128 v[72:75], v6 offset:1024
  ds_read_b128 v[76:79], v6 offset:1536
  ds_read_b128 v[80:83], v6 offset:2048
  ds_read_b128 v[84:87], v6 offset:2560
  ds_read_b128 v[88:91], v6 offset:3072
  s_waitcnt lgkmcnt(6)
  v_mfma_f32_32x32x16_bf16 v[12:27], a[0:3], v[64:67], 0
  ds_read_b128 v[92:95], v6 offset:3584
  s_waitcnt lgkmcnt(6)
  v_mfma_f32_32x32x16_bf16 v[12:27], a[4:7], v[68:71], v[12:27]
  ds_read_b128 v[64:67], v6 offset:4096
  s_waitcnt lgkmcnt(6)
  v_mfma_f32_32x32x16_bf16 v[12:27], a[8:11], v[72:75], v[12:27]
  ds_read_b128 v[68:71], v6 offset:4608
  s_waitcnt lgkmcnt(6)
  v_mfma_f32_32x32x16_bf16 v[12:27], a[12:15], v[76:79], v[12:27]
  ds_read_b128 v[72:75], v6 offset:5120
  s_waitcnt lgkmcnt(6)
  v_mfma_f32_32x32x16_bf16 v[12:27], a[16:19], v[80:83], v[12:27]
  ds_read_b128 v[76:79], v6 offset:5632
  s_waitcnt lgkmcnt(6)
  v_mfma_f32_32x32x16_bf16 v[12:27], a[20:23], v[84:87], v[12:27]
  ds_read_b128 v[80:83], v6 offset:6144
  s_waitcnt lgkmcnt(6)
  v_mfma_f32_32x32x16_bf16 v[12:27], a[24:27], v[88:91], v[12:27]
  ds_read_b128 v[84:87], v6 offset:6656
  s_waitcnt lgkmcnt(6)
  v_mfma_f32_32x32x16_bf16 v[12:27], a[28:31], v[92:95], v[12:27]
  ds_read_b128 v[88:91], v6 offset:7168
  s_waitcnt lgkmcnt(6)
  v_mfma_f32_32x32x16_bf16 v[12:27], a[32:35], v[64:67], v[12:27]
  ds_read_b128 v[92:95], v6 offset:7680
  s_waitcnt lgkmcnt(6)
  v_mfma_f32_32x32x16_bf16 v[12:27], a[36:39], v[68:71], v[12:27]
  ds_read_b128 v[64:67], v6 offset:8192
  s_waitcnt lgkmcnt(6)
  v_mfma_f32_32x32x16_bf16 v[12:27], a[40:43], v[72:75], v[12:27]
  ds_read_b128 v[68:71], v6 offset:8704
  s_waitcnt lgkmcnt(6)
  v_mfma_f32_32x32x16_bf16 v[12:27], a[44:47], v[76:79], v[12:27]
  ds_read_b128 v[72:75], v6 offset:9216
  s_waitcnt lgkmcnt(6)
  v_mfma_f32_32x32x16_bf16 v[12:27], a[48:51], v[80:83], v[12:27]
  ds_read_b128 v[76:79], v6 offset:9728
  s_waitcnt lgkmcnt(6)
  v_mfma_f32_32x32x16_bf16 v[12:27], a[52:55], v[84:87], v[12:27]
  ds_read_b128 v[80:83], v6 offset:10240
  s_waitcnt lgkmcnt(6)
  v_mfma_f32_32x32x16_bf16 v[12:27], a[56:59], v[88:91], v[12:27]
  ds_read_b128 v[84:87], v6 offset:10752
  s_waitcnt lgkmcnt(6)
  v_mfma_f32_32x32x16_bf16 v[12:27], a[60:63], v[92:95], v[12:27]
  ds_read_b128 v[88:91], v6 offset:11264
  s_waitcnt lgkmcnt(6)
  v_mfma_f32_32x32x16_bf16 v[12:27], a[64:67], v[64:67], v[12:27]
  ds_read_b128 v[92:95], v6 offset:11776
  s_waitcnt lgkmcnt(6)
  v_mfma_f32_32x32x16_bf16 v[12:27], a[68:71], v[68:71], v[12:27]
  ds_read_b128 v[64:67], v6 offset:12288
  s_waitcnt lgkmcnt(6)
  v_mfma_f32_32x32x16_bf16 v[12:27], a[72:75], v[72:75], v[12:27]
  ds_read_b128 v[68:71], v6 offset:12800
  s_waitcnt lgkmcnt(6)
  v_mfma_f32_32x32x16_bf16 v[12:27], a[76:79], v[76:79], v[12:27]
  s_cmp_lg_u32 s28, 0
  s_cbranch_scc1 wo_h2
  s_waitcnt vmcnt(0)
  v_cmp_ne_u32 vcc, 1, v61
  s_cbranch_vccnz wo_h2
  s_add_u32 s22, s24, 0
  buffer_load_dwordx2 v[28:29], v7, s[8:11], s22 offen offset:0 sc1
  buffer_load_dwordx2 v[30:31], v7, s[8:11], s22 offen offset:512 sc1
  buffer_load_dwordx2 v[32:33], v7, s[8:11], s22 offen offset:256 sc1
  buffer_load_dwordx2 v[34:35], v7, s[8:11], s22 offen offset:768 sc1
  buffer_load_dwordx2 v[36:37], v7, s[8:11], s22 offen offset:2048 sc1
  buffer_load_dwordx2 v[38:39], v7, s[8:11], s22 offen offset:2560 sc1
  buffer_load_dwordx2 v[40:41], v7, s[8:11], s22 offen offset:2304 sc1
  buffer_load_dwordx2 v[42:43], v7, s[8:11], s22 offen offset:2816 sc1
  s_add_u32 s22, s24, 4096
  buffer_load_dwordx2 v[44:45], v7, s[8:11], s22 offen offset:0 sc1
  buffer_load_dwordx2 v[46:47], v7, s[8:11], s22 offen offset:512 sc1
  buffer_load_dwordx2 v[48:49], v7, s[8:11], s22 offen offset:256 sc1
  buffer_load_dwordx2 v[50:51], v7, s[8:11], s22 offen offset:768 sc1
  buffer_load_dwordx2 v[52:53], v7, s[8:11], s22 offen offset:2048 sc1
  buffer_load_dwordx2 v[54:55], v7, s[8:11], s22 offen offset:2560 sc1
  buffer_load_dwordx2 v[56:57], v7, s[8:11], s22 offen offset:2304 sc1
  buffer_load_dwordx2 v[58:59], v7, s[8:11], s22 offen offset:2816 sc1
  s_mov_b32 s28, 1
wo_h2:
  ds_read_b128 v[72:75], v6 offset:13312
  s_waitcnt lgkmcnt(6)
  v_mfma_f32_32x32x16_bf16 v[12:27], a[80:83], v[80:83], v[12:27]
  ds_read_b128 v[76:79], v6 offset:13824
  s_waitcnt lgkmcnt(6)
  v_mfma_f32_32x32x16_bf16 v[12:27], a[84:87], v[84:87], v[12:27]
  ds_read_b128 v[80:83], v6 offset:14336
  s_waitcnt lgkmcnt(6)
  v_mfma_f32_32x32x16_bf16 v[12:27], a[88:91], v[88:91], v[12:27]
  ds_read_b128 v[84:87], v6 offset:14848
  s_waitcnt lgkmcnt(6)
  v_mfma_f32_32x32x16_bf16 v[12:27], a[92:95], v[92:95], v[12:27]
  ds_read_b128 v[88:91], v6 offset:15360
  s_waitcnt lgkmcnt(6)
  v_mfma_f32_32x32x16_bf16 v[12:27], a[96:99], v[64:67], v[12:27]
  ds_read_b128 v[92:95], v6 offset:15872
  s_waitcnt lgkmcnt(6)
  v_mfma_f32_32x32x16_bf16 v[12:27], a[100:103], v[68:71], v[12:27]
  ds_read_b128 v[64:67], v6 offset:16384
  s_waitcnt lgkmcnt(6)
  v_mfma_f32_32x32x16_bf16 v[12:27], a[104:107], v[72:75], v[12:27]
  ds_read_b128 v[68:71], v6 offset:16896
  s_waitcnt lgkmcnt(6)
  v_mfma_f32_32x32x16_bf16 v[12:27], a[108:111], v[76:79], v[12:27]
  ds_read_b128 v[72:75], v6 offset:17408
  s_waitcnt lgkmcnt(6)
  v_mfma_f32_32x32x16_bf16 v[12:27], a[112:115], v[80:83], v[12:27]
  ds_read_b128 v[76:79], v6 offset:17920
  s_waitcnt lgkmcnt(6)
  v_mfma_f32_32x32x16_bf16 v[12:27], a[116:119], v[84:87], v[12:27]
  ds_read_b128 v[80:83], v6 offset:18432
  s_waitcnt lgkmcnt(6)
  v_mfma_f32_32x32x16_bf16 v[12:27], a[120:123], v[88:91], v[12:27]
  ds_read_b128 v[84:87], v6 offset:18944
  s_waitcnt lgkmcnt(6)
  v_mfma_f32_32x32x16_bf16 v[12:27], a[124:127], v[92:95], v[12:27]
  s_cmp_lg_u32 s28, 0
  s_cbranch_scc1 wo_ht
  v_lshlrev_b32 v60, 2, v3
  s_mov_b32 s30, 0
wo_wt:
  buffer_load_dword v61, v60, s[8:11], s26 offen sc1
  s_waitcnt vmcnt(0)
  v_cmp_ne_u32 vcc, 1, v61
  s_cbranch_vccz wo_wt_ok
  s_sleep 1
  s_cmp_ge_u32 s17, 61
  s_cbranch_scc1 wo_wt_bo
  s_sleep 4
  s_cmp_ge_u32 s17, 56
  s_cbranch_scc1 wo_wt_bo
  s_sleep 40
wo_wt_bo:
  s_add_u32 s30, s30, 1
  s_cmp_lt_u32 s30, 30000
  s_cbranch_scc1 wo_wt
  s_branch wo_abort
wo_wt_ok:
  s_add_u32 s22, s24, 0
  buffer_load_dwordx2 v[28:29], v7, s[8:11], s22 offen offset:0 sc1
  buffer_load_dwordx2 v[30:31], v7, s[8:11], s22 offen offset:512 sc1
  buffer_load_dwordx2 v[32:33], v7, s[8:11], s22 offen offset:256 sc1
  buffer_load_dwordx2 v[34:35], v7, s[8:11], s22 offen offset:768 sc1
  buffer_load_dwordx2 v[36:37], v7, s[8:11], s22 offen offset:2048 sc1
  buffer_load_dwordx2 v[38:39], v7, s[8:11], s22 offen offset:2560 sc1
  buffer_load_dwordx2 v[40:41], v7, s[8:11], s22 offen offset:2304 sc1
  buffer_load_dwordx2 v[42:43], v7, s[8:11], s22 offen offset:2816 sc1
  s_add_u32 s22, s24, 4096
  buffer_load_dwordx2 v[44:45], v7, s[8:11], s22 offen offset:0 sc1
  buffer_load_dwordx2 v[46:47], v7, s[8:11], s22 offen offset:512 sc1
  buffer_load_dwordx2 v[48:49], v7, s[8:11], s22 offen offset:256 sc1
  buffer_load_dwordx2 v[50:51], v7, s[8:11], s22 offen offset:768 sc1
  buffer_load_dwordx2 v[52:53], v7, s[8:11], s22 offen offset:2048 sc1
  buffer_load_dwordx2 v[54:55], v7, s[8:11], s22 offen offset:2560 sc1
  buffer_load_dwordx2 v[56:57], v7, s[8:11], s22 offen offset:2304 sc1
  buffer_load_dwordx2 v[58:59], v7, s[8:11], s22 offen offset:2816 sc1
wo_ht:
  ds_read_b128 v[88:91], v6 offset:19456
  s_waitcnt lgkmcnt(6) vmcnt(0)
  v_mfma_f32_32x32x16_bf16 v[12:27], v[28:31], v[64:67], v[12:27]
  ds_read_b128 v[92:95], v6 offset:19968
  s_waitcnt lgkmcnt(6)
  v_mfma_f32_32x32x16_bf16 v[12:27], v[32:35], v[68:71], v[12:27]
  s_waitcnt lgkmcnt(5)
  v_mfma_f32_32x32x16_bf16 v[12:27], v[36:39], v[72:75], v[12:27]
  s_waitcnt lgkmcnt(4)
  v_mfma_f32_32x32x16_bf16 v[12:27], v[40:43], v[76:79], v[12:27]
  s_waitcnt lgkmcnt(3)
  v_mfma_f32_32x32x16_bf16 v[12:27], v[44:47], v[80:83], v[12:27]
  s_waitcnt lgkmcnt(2)
  v_mfma_f32_32x32x16_bf16 v[12:27], v[48:51], v[84:87], v[12:27]
  s_waitcnt lgkmcnt(1)
  v_mfma_f32_32x32x16_bf16 v[12:27], v[52:55], v[88:91], v[12:27]
  s_waitcnt lgkmcnt(0)
  v_mfma_f32_32x32x16_bf16 v[12:27], v[56:59], v[92:95], v[12:27]
  v_mul_u32_u24 v9, 240, v9
  s_movk_i32 s23, 240
  v_lshl_add_u32 v8, v8, 3, v9
  s_mul_i32 s22, s16, 24
  v_add_u32 v7, s22, v8
  s_lshl_b32 s22, s16, 5
  v_add_u32 v8, s22, v8
  v_min_u32 v11, 223, v0
  v_mul_u32_u24 v9, 4682, v11
  v_lshrrev_b32 v9, 16, v9
  v_mul_u32_u24 v10, 14, v9
  v_sub_u32 v10, v11, v10
  v_cmp_gt_u32 vcc, 8, v10
  v_lshlrev_b32 v10, 4, v10
  v_mad_u32_u24 v11, v9, s23, v10
  v_mul_u32_u24 v9, 1792, v9
  v_add_u32 v10, v9, v10
  s_lshl_b32 s22, s18, 7
  s_mul_i32 s27, s18, 96
  s_add_u32 s27, s27, 384
  v_mov_b32 v9, s22
  v_mov_b32 v5, s27
  v_cndmask_b32 v9, v5, v9, vcc
  v_add_u32 v10, v9, v10
  s_mul_i32 s26, s17, 57344
  s_add_u32 s26, s26, 896
  s_add_u32 s27, s26, 28672
  v_cvt_pk_bf16_f32 v96, v12, v13
  v_cvt_pk_bf16_f32 v97, v14, v15
  ds_write_b64 v8, v[96:97] offset:49152
  v_cvt_pk_bf16_f32 v98, v16, v17
  v_cvt_pk_bf16_f32 v99, v18, v19
  ds_write_b64 v8, v[98:99] offset:49168
  v_cvt_pk_bf16_f32 v100, v20, v21
  v_cvt_pk_bf16_f32 v101, v22, v23
  ds_write_b64 v7, v[100:101] offset:49280
  v_cvt_pk_bf16_f32 v102, v24, v25
  v_cvt_pk_bf16_f32 v103, v26, v27
  s_mov_b32 exec_hi, 0
  ds_write_b64 v7, v[102:103] offset:49296
  s_mov_b64 exec, -1
  s_waitcnt lgkmcnt(0)
  s_barrier
  ds_read_b128 v[104:107], v11 offset:49152
  ds_read_b128 v[108:111], v11 offset:52992
  s_cmp_lg_u32 s16, 3
  s_cselect_b32 exec_hi, -1, 0
  s_waitcnt lgkmcnt(1)
  buffer_store_dwordx4 v[104:107], v10, s[92:95], s26 offen
  s_waitcnt lgkmcnt(0)
  buffer_store_dwordx4 v[108:111], v10, s[92:95], s27 offen
  s_mov_b64 exec, -1
  v_readfirstlane_b32 s22, v250
  s_cmp_ge_u32 s22, 1440
  s_cbranch_scc1 ch_end
  s_branch wk_loop
wp_abort:
wo_abort:
  s_branch cA_abort
ch_end:
  s_endpgm

.section .rodata,"a"
.p2align 6
.amdhsa_kernel main_kernel
  .amdhsa_next_free_vgpr 512
  .amdhsa_next_free_sgpr 102
  .amdhsa_accum_offset 256
  .amdhsa_group_segment_fixed_size 0
  .amdhsa_kernarg_size 136
  .amdhsa_user_sgpr_count 2
  .amdhsa_user_sgpr_kernarg_segment_ptr 1
  .amdhsa_system_sgpr_workgroup_id_x 1
.end_amdhsa_kernel
```

```asm
; @launch kernel=main_kernel grid=(256,1,1) block=(256,1,1) lds=163840
.amdgcn_target "amdgcn-amd-amdhsa--gfx950"
.text
.globl main_kernel
.p2align 8
.type main_kernel,@function
main_kernel:
  s_cmp_ge_u32 s2, 256
  s_cbranch_scc1 ch_end
  s_load_dwordx4 s[4:7], s[0:1], 120
  s_load_dwordx2 s[92:93], s[0:1], 112
  s_load_dwordx8 s[36:43], s[0:1], 56
  s_load_dwordx4 s[44:47], s[0:1], 88
  s_memrealtime s[88:89]
  s_getpc_b64 s[98:99]
pf_main_kernel_1:
  s_sub_u32 s98, s98, pf_main_kernel_1-main_kernel
  s_subb_u32 s99, s99, 0
  s_lshr_b32 s20, s2, 3
  v_lshl_add_u32 v60, v0, 5, s20
  v_lshlrev_b32 v60, 7, v60
  v_min_u32 v60, ch_end-main_kernel-4, v60
  v_cmp_gt_u32 vcc, 32, v0
  s_and_saveexec_b64 s[22:23], vcc
  s_cbranch_execz pf_main_kernel_1_n
  global_load_dword v62, v60, s[98:99]
pf_main_kernel_1_n:
  s_mov_b64 exec, -1
  s_getreg_b32 s67, hwreg(HW_REG_XCC_ID)
  s_and_b32 s67, s67, 7
  v_lshrrev_b32 v1, 6, v0
  s_nop 0
  v_readfirstlane_b32 s16, v1
  s_mov_b32 s66, 0
  s_mov_b32 s68, 0
  s_mov_b32 s69, 0
  s_mov_b32 s96, 0
  s_mov_b32 s97, 0
  s_mov_b32 s101, 0x5eed0000
  s_sub_u32 s20, s67, 0
  s_lshr_b32 s21, s2, 3
  s_and_b32 s20, s20, 7
  s_lshl_b32 s3, s20, 5
  s_add_u32 s3, s3, s21
  s_waitcnt lgkmcnt(0)
  s_mov_b32 s8, s6
  s_and_b32 s9, s7, 0xffff
  s_mov_b32 s10, 0x10000000
  s_mov_b32 s11, 0x20000
  s_mov_b32 s12, s4
  s_and_b32 s13, s5, 0xffff
  s_mov_b32 s14, 256
  s_mov_b32 s15, 0x20000
  s_or_b32 s88, s88, 1
  s_and_b32 s93, s93, 0xffff
  s_mov_b32 s94, 3670016
  s_mov_b32 s95, 0x20000
m_start:
  s_cmp_ge_u32 s3, 32
  s_cbranch_scc1 m_bjob
  v_and_b32 v1, 63, v0
  v_lshlrev_b32 v2, 4, v1
  v_lshrrev_b32 v116, 4, v1
  v_and_b32 v117, 15, v1
  v_mov_b32 v3, 0x4444
  v_mov_b32 v118, 0xeeee
  v_cmp_lt_u32 vcc, 7, v117
  s_nop 1
  v_cndmask_b32 v3, v3, v118, vcc
  s_and_b32 s17, s3, 15
  s_cmp_ge_u32 s3, 16
  s_cbranch_scc1 m_val
  s_mov_b32 s60, s42
  s_and_b32 s61, s43, 0xffff
  s_mov_b32 s62, 3670016
  s_mov_b32 s63, 0x20000
  v_lshrrev_b32 v24, 5, v1
  v_and_b32 v25, 31, v1
  s_lshl_b32 s26, s17, 9
  s_lshl_b32 s25, s16, 12
  v_xor_b32 v26, v25, v24
  v_lshlrev_b32 v26, 4, v26
  v_lshl_add_u32 v26, v24, 13, v26
  v_xor_b32 v100, 0, v26
  v_xor_b32 v101, 0, v26
  v_add_u32 v101, 15360, v101
  v_xor_b32 v102, 32, v26
  v_add_u32 v102, 30720, v102
  v_xor_b32 v103, 32, v26
  v_add_u32 v103, 46080, v103
  s_lshl_b32 s23, s16, 19
  s_add_u32 s23, s23, s26
  s_add_u32 m0, s25, 16384
  s_nop 0
  buffer_load_dwordx4 v100, s[60:63], s23 offen offset:0 lds
  buffer_load_dwordx4 v101, s[60:63], s23 offen offset:1024 lds
  buffer_load_dwordx4 v102, s[60:63], s23 offen offset:2048 lds
  buffer_load_dwordx4 v103, s[60:63], s23 offen offset:3072 lds
  s_add_u32 m0, s25, 32768
  s_add_u32 s23, s23, 65536
  buffer_load_dwordx4 v100, s[60:63], s23 offen offset:0 lds
  buffer_load_dwordx4 v101, s[60:63], s23 offen offset:1024 lds
  buffer_load_dwordx4 v102, s[60:63], s23 offen offset:2048 lds
  buffer_load_dwordx4 v103, s[60:63], s23 offen offset:3072 lds
  v_xor_b32 v100, 64, v100
  v_xor_b32 v101, 64, v101
  v_xor_b32 v102, 64, v102
  v_xor_b32 v103, 64, v103
  s_add_u32 m0, s25, 49152
  s_add_u32 s23, s23, 65536
  buffer_load_dwordx4 v100, s[60:63], s23 offen offset:0 lds
  buffer_load_dwordx4 v101, s[60:63], s23 offen offset:1024 lds
  buffer_load_dwordx4 v102, s[60:63], s23 offen offset:2048 lds
  buffer_load_dwordx4 v103, s[60:63], s23 offen offset:3072 lds
  s_add_u32 m0, s25, 65536
  s_add_u32 s23, s23, 65536
  buffer_load_dwordx4 v100, s[60:63], s23 offen offset:0 lds
  buffer_load_dwordx4 v101, s[60:63], s23 offen offset:1024 lds
  buffer_load_dwordx4 v102, s[60:63], s23 offen offset:2048 lds
  buffer_load_dwordx4 v103, s[60:63], s23 offen offset:3072 lds
  v_xor_b32 v100, 192, v100
  v_xor_b32 v101, 192, v101
  v_xor_b32 v102, 192, v102
  v_xor_b32 v103, 192, v103
  s_add_u32 m0, s25, 81920
  s_add_u32 s23, s23, 65536
  buffer_load_dwordx4 v100, s[60:63], s23 offen offset:0 lds
  buffer_load_dwordx4 v101, s[60:63], s23 offen offset:1024 lds
  buffer_load_dwordx4 v102, s[60:63], s23 offen offset:2048 lds
  buffer_load_dwordx4 v103, s[60:63], s23 offen offset:3072 lds
  s_add_u32 m0, s25, 98304
  s_add_u32 s23, s23, 65536
  buffer_load_dwordx4 v100, s[60:63], s23 offen offset:0 lds
  buffer_load_dwordx4 v101, s[60:63], s23 offen offset:1024 lds
  buffer_load_dwordx4 v102, s[60:63], s23 offen offset:2048 lds
  buffer_load_dwordx4 v103, s[60:63], s23 offen offset:3072 lds
  v_xor_b32 v100, 64, v100
  v_xor_b32 v101, 64, v101
  v_xor_b32 v102, 64, v102
  v_xor_b32 v103, 64, v103
  s_add_u32 m0, s25, 114688
  s_add_u32 s23, s23, 65536
  buffer_load_dwordx4 v100, s[60:63], s23 offen offset:0 lds
  buffer_load_dwordx4 v101, s[60:63], s23 offen offset:1024 lds
  buffer_load_dwordx4 v102, s[60:63], s23 offen offset:2048 lds
  buffer_load_dwordx4 v103, s[60:63], s23 offen offset:3072 lds
  s_add_u32 m0, s25, 131072
  s_add_u32 s23, s23, 65536
  buffer_load_dwordx4 v100, s[60:63], s23 offen offset:0 lds
  buffer_load_dwordx4 v101, s[60:63], s23 offen offset:1024 lds
  buffer_load_dwordx4 v102, s[60:63], s23 offen offset:2048 lds
  buffer_load_dwordx4 v103, s[60:63], s23 offen offset:3072 lds
  s_mov_b32 s56, s40
  s_and_b32 s57, s41, 0xffff
  s_mov_b32 s58, 3670016
  s_mov_b32 s59, 0x20000
  s_lshl_b32 s21, s16, 16
  s_add_u32 s27, s26, s21
  s_lshr_b32 s20, s16, 1
  s_lshl_b32 s20, s20, 6
  v_xor_b32 v26, s20, v26
  v_xor_b32 v4, 0, v26
  v_xor_b32 v5, 32, v26
  v_add_u32 v5, 15360, v5
  v_xor_b32 v6, 128, v26
  v_add_u32 v6, 30720, v6
  v_xor_b32 v7, 160, v26
  v_add_u32 v7, 46080, v7
  s_add_u32 s22, s27, 0
  s_add_u32 m0, s25, 0
  s_nop 0
  buffer_load_dwordx4 v4, s[56:59], s22 offen offset:0 lds
  buffer_load_dwordx4 v5, s[56:59], s22 offen offset:1024 lds
  buffer_load_dwordx4 v6, s[56:59], s22 offen offset:2048 lds
  buffer_load_dwordx4 v7, s[56:59], s22 offen offset:3072 lds
  s_cmp_lg_u32 s66, 0
  s_cbranch_scc1 sc_ci
  s_cmp_lg_u32 s16, 0
  s_cbranch_scc1 w0_2
  s_lshr_b32 s70, s3, 5
  s_and_b32 s71, s70, 4
  s_mul_i32 s71, s71, 12
  s_lshl_b32 s70, s70, 2
  s_add_u32 s70, s70, s71
  s_lshl_b32 s71, 1, s3
  v_mov_b32 v248, s71
  v_mov_b32 v249, 32
  s_mov_b64 exec, 1
  buffer_atomic_or v248, v249, s[12:15], s70 offen sc0
  buffer_load_dwordx2 v[250:251], v249, s[12:15], 0 offen offset:96 sc1
  s_mov_b64 exec, -1
w0_2:
sc_ci:
  v_and_b32 v26, 15, v25
  v_xor_b32 v27, v26, v24
  v_lshlrev_b32 v27, 4, v27
  v_bfe_u32 v28, v25, 2, 1
  v_lshlrev_b32 v28, 4, v28
  v_lshrrev_b32 v29, 3, v25
  v_lshl_add_u32 v28, v29, 2, v28
  v_and_b32 v29, 3, v25
  v_add_u32 v28, v28, v29
  v_lshl_add_u32 v28, v28, 9, v27
  v_lshrrev_b32 v29, 2, v26
  v_lshlrev_b32 v29, 15, v29
  v_bfe_u32 v30, v26, 1, 1
  v_lshl_add_u32 v29, v30, 11, v29
  v_lshrrev_b32 v30, 4, v25
  v_lshl_add_u32 v29, v30, 10, v29
  v_and_b32 v31, 1, v26
  v_lshl_add_u32 v29, v31, 9, v29
  v_add_u32 v29, v29, v27
  v_add_u32 v29, s25, v29
  v_xor_b32 v8, 0, v28
  v_xor_b32 v104, 0, v29
  v_xor_b32 v9, 32, v28
  v_xor_b32 v105, 32, v29
  v_xor_b32 v10, 64, v28
  v_xor_b32 v106, 64, v29
  v_xor_b32 v11, 96, v28
  v_xor_b32 v107, 96, v29
  v_xor_b32 v12, 128, v28
  v_xor_b32 v108, 128, v29
  v_xor_b32 v13, 160, v28
  v_xor_b32 v109, 160, v29
  v_xor_b32 v14, 192, v28
  v_xor_b32 v110, 192, v29
  v_xor_b32 v15, 224, v28
  v_xor_b32 v111, 224, v29
  s_mov_b32 s52, 1035512379
  s_waitcnt vmcnt(4)
  ds_read_b128 v[120:123], v104 offset:16384
  ds_read_b128 v[124:127], v105 offset:16384
  ds_read_b128 v[128:131], v106 offset:16384
  ds_read_b128 v[132:135], v107 offset:16384
  ds_read_b128 v[136:139], v108 offset:16384
  ds_read_b128 v[140:143], v109 offset:16384
  ds_read_b128 v[144:147], v110 offset:16384
  ds_read_b128 v[148:151], v111 offset:16384
  s_waitcnt lgkmcnt(4)
  ds_read_b128 v[152:155], v104 offset:16640
  ds_read_b128 v[156:159], v105 offset:16640
  ds_read_b128 v[160:163], v106 offset:16640
  ds_read_b128 v[164:167], v107 offset:16640
  ds_read_b128 v[168:171], v108 offset:16640
  ds_read_b128 v[172:175], v109 offset:16640
  ds_read_b128 v[176:179], v110 offset:16640
  ds_read_b128 v[180:183], v111 offset:16640
  s_waitcnt lgkmcnt(4)
  ds_read_b128 v[184:187], v104 offset:32768
  ds_read_b128 v[188:191], v105 offset:32768
  ds_read_b128 v[192:195], v106 offset:32768
  ds_read_b128 v[196:199], v107 offset:32768
  ds_read_b128 v[200:203], v108 offset:32768
  ds_read_b128 v[204:207], v109 offset:32768
  ds_read_b128 v[208:211], v110 offset:32768
  ds_read_b128 v[212:215], v111 offset:32768
  s_waitcnt lgkmcnt(4)
  ds_read_b128 v[216:219], v104 offset:33024
  ds_read_b128 v[220:223], v105 offset:33024
  ds_read_b128 v[224:227], v106 offset:33024
  ds_read_b128 v[228:231], v107 offset:33024
  ds_read_b128 v[232:235], v108 offset:33024
  ds_read_b128 v[236:239], v109 offset:33024
  ds_read_b128 v[240:243], v110 offset:33024
  ds_read_b128 v[244:247], v111 offset:33024
  s_waitcnt lgkmcnt(4)
  s_waitcnt lgkmcnt(0)
  s_add_u32 s22, s27, 262144
  s_add_u32 m0, s25, 16384
  s_nop 0
  buffer_load_dwordx4 v4, s[56:59], s22 offen offset:0 lds
  buffer_load_dwordx4 v5, s[56:59], s22 offen offset:1024 lds
  buffer_load_dwordx4 v6, s[56:59], s22 offen offset:2048 lds
  buffer_load_dwordx4 v7, s[56:59], s22 offen offset:3072 lds
  s_add_u32 s22, s27, 524288
  s_add_u32 m0, s25, 32768
  s_nop 0
  buffer_load_dwordx4 v4, s[56:59], s22 offen offset:0 lds
  buffer_load_dwordx4 v5, s[56:59], s22 offen offset:1024 lds
  buffer_load_dwordx4 v6, s[56:59], s22 offen offset:2048 lds
  buffer_load_dwordx4 v7, s[56:59], s22 offen offset:3072 lds
  s_add_u32 s22, s27, 786432
  s_add_u32 m0, s25, 49152
  s_nop 0
  buffer_load_dwordx4 v4, s[56:59], s22 offen offset:0 lds
  buffer_load_dwordx4 v5, s[56:59], s22 offen offset:1024 lds
  buffer_load_dwordx4 v6, s[56:59], s22 offen offset:2048 lds
  buffer_load_dwordx4 v7, s[56:59], s22 offen offset:3072 lds
  s_cmp_lg_u32 s66, 0
  s_cbranch_scc1 sc_cf
  s_cmp_lg_u32 s16, 0
  s_cbranch_scc1 w0_3
  s_waitcnt vmcnt(12)
  v_readfirstlane_b32 s70, v250
  s_cmp_lg_u32 s70, 0
  s_cbranch_scc1 sc_nz
  v_mov_b32 v249, 128
  v_mov_b32 v250, s88
  v_mov_b32 v251, s89
  v_mov_b32 v252, 0
  v_mov_b32 v253, 0
  s_mov_b64 exec, 1
  buffer_atomic_cmpswap_x2 v[250:253], v249, s[12:15], 0 offen sc0
  s_mov_b64 exec, -1
  s_waitcnt vmcnt(0)
  v_readfirstlane_b32 s70, v250
  s_cmp_lg_u32 s70, 0
  s_cbranch_scc1 sc_nz
  v_mov_b32 v250, s88
  v_mov_b32 v251, s89
sc_nz:
w0_3:
  v_mov_b32 v249, 160000
  s_add_u32 s101, s101, 1
  s_barrier
  s_mov_b64 exec, 1
  s_cmp_lg_u32 s16, 0
  s_cbranch_scc1 w0_4
  ds_write_b32 v249, v248 offset:0
  ds_write_b32 v249, v250 offset:4
  ds_write_b32 v249, v251 offset:8
  s_waitcnt lgkmcnt(0)
  v_mov_b32 v248, s101
  ds_write_b32 v249, v248 offset:16
  s_waitcnt lgkmcnt(0)
w0_4:
  s_mov_b64 exec, -1
  s_barrier
  ds_read_b32 v248, v249 offset:0
  ds_read_b32 v250, v249 offset:4
  ds_read_b32 v251, v249 offset:8
  ds_read_b32 v249, v249 offset:16
  s_waitcnt lgkmcnt(0)
  v_readfirstlane_b32 s70, v248
  v_readfirstlane_b32 s88, v250
  v_readfirstlane_b32 s89, v251
  v_cmp_ne_u32 vcc, s101, v249
  s_cbranch_vccnz ch_end
  s_mov_b32 s66, 1
  s_bitcmp1_b32 s70, s3
  s_cbranch_scc1 m_reclaim
sc_cf:
  s_cmp_lg_u32 s16, 0
  s_cbranch_scc1 w0_5
  s_cmp_eq_u32 s67, 0
  s_cselect_b32 s20, 1, 0x10001
  v_mov_b32 v248, s20
  v_mov_b32 v249, 0
  s_mov_b64 exec, 1
  buffer_atomic_add v248, v249, s[12:15], 0 offen
  s_mov_b64 exec, -1
w0_5:
  s_lshl_b32 s28, s17, 7
  s_add_u32 s28, s28, 88635392
  v_min_u32 v113, 96, v2
  s_mov_b32 s29, 88602624
  v_add_u32 v112, 1024, v2
  v_min_u32 v112, 1776, v112
  s_mul_i32 s32, s17, 401408
  s_mul_i32 s33, s16, 14336
  s_add_u32 s32, s32, s33
  s_add_u32 s33, s32, s33
  s_add_u32 s32, s32, 344064
  s_add_u32 s33, s33, 229376
  s_waitcnt vmcnt(8)
  s_barrier
  ds_read_b128 v[16:19], v8 offset:0
  ds_read_b128 v[20:23], v9 offset:0
  ds_read_b128 v[24:27], v10 offset:0
  ds_read_b128 v[28:31], v11 offset:0
  s_waitcnt lgkmcnt(3)
  v_mfma_f32_32x32x16_bf16 v[32:47], v[16:19], v[120:123], 0
  s_add_u32 s22, s27, 1048576
  s_add_u32 m0, s25, 65536
  s_nop 0
  buffer_load_dwordx4 v4, s[56:59], s22 offen offset:0 lds
  v_mfma_f32_32x32x16_bf16 v[48:63], v[16:19], v[184:187], 0
  ds_read_b128 v[16:19], v12 offset:0
  s_waitcnt lgkmcnt(3)
  v_mfma_f32_32x32x16_bf16 v[32:47], v[20:23], v[124:127], v[32:47]
  buffer_load_dwordx4 v5, s[56:59], s22 offen offset:1024 lds
  v_mfma_f32_32x32x16_bf16 v[48:63], v[20:23], v[188:191], v[48:63]
  ds_read_b128 v[20:23], v13 offset:0
  s_waitcnt lgkmcnt(3)
  v_mfma_f32_32x32x16_bf16 v[32:47], v[24:27], v[128:131], v[32:47]
  buffer_load_dwordx4 v6, s[56:59], s22 offen offset:2048 lds
  v_mfma_f32_32x32x16_bf16 v[48:63], v[24:27], v[192:195], v[48:63]
  ds_read_b128 v[24:27], v14 offset:0
  s_waitcnt lgkmcnt(3)
  v_mfma_f32_32x32x16_bf16 v[32:47], v[28:31], v[132:135], v[32:47]
  buffer_load_dwordx4 v7, s[56:59], s22 offen offset:3072 lds
  v_mfma_f32_32x32x16_bf16 v[48:63], v[28:31], v[196:199], v[48:63]
  ds_read_b128 v[28:31], v15 offset:0
  s_waitcnt lgkmcnt(3)
  v_mfma_f32_32x32x16_bf16 v[32:47], v[16:19], v[136:139], v[32:47]
  s_add_u32 s22, s27, 1310720
  s_add_u32 m0, s25, 81920
  s_nop 0
  buffer_load_dwordx4 v4, s[56:59], s22 offen offset:0 lds
  v_mfma_f32_32x32x16_bf16 v[48:63], v[16:19], v[200:203], v[48:63]
  ds_read_b128 v[16:19], v8 offset:256
  s_waitcnt lgkmcnt(3)
  v_mfma_f32_32x32x16_bf16 v[32:47], v[20:23], v[140:143], v[32:47]
  buffer_load_dwordx4 v5, s[56:59], s22 offen offset:1024 lds
  v_mfma_f32_32x32x16_bf16 v[48:63], v[20:23], v[204:207], v[48:63]
  ds_read_b128 v[20:23], v9 offset:256
  s_waitcnt lgkmcnt(3)
  v_mfma_f32_32x32x16_bf16 v[32:47], v[24:27], v[144:147], v[32:47]
  buffer_load_dwordx4 v6, s[56:59], s22 offen offset:2048 lds
  v_mfma_f32_32x32x16_bf16 v[48:63], v[24:27], v[208:211], v[48:63]
  ds_read_b128 v[24:27], v10 offset:256
  s_waitcnt lgkmcnt(3)
  v_mfma_f32_32x32x16_bf16 v[32:47], v[28:31], v[148:151], v[32:47]
  buffer_load_dwordx4 v7, s[56:59], s22 offen offset:3072 lds
  v_mfma_f32_32x32x16_bf16 v[48:63], v[28:31], v[212:215], v[48:63]
  ds_read_b128 v[28:31], v11 offset:256
  s_waitcnt lgkmcnt(3)
  v_mfma_f32_32x32x16_bf16 v[32:47], v[16:19], v[152:155], v[32:47]
  s_add_u32 s22, s27, 1572864
  s_add_u32 m0, s25, 98304
  s_nop 0
  buffer_load_dwordx4 v4, s[56:59], s22 offen offset:0 lds
  v_mfma_f32_32x32x16_bf16 v[48:63], v[16:19], v[216:219], v[48:63]
  ds_read_b128 v[16:19], v12 offset:256
  s_waitcnt lgkmcnt(3)
  v_mfma_f32_32x32x16_bf16 v[32:47], v[20:23], v[156:159], v[32:47]
  buffer_load_dwordx4 v5, s[56:59], s22 offen offset:1024 lds
  v_mfma_f32_32x32x16_bf16 v[48:63], v[20:23], v[220:223], v[48:63]
  ds_read_b128 v[20:23], v13 offset:256
  s_waitcnt lgkmcnt(3)
  v_mfma_f32_32x32x16_bf16 v[32:47], v[24:27], v[160:163], v[32:47]
  buffer_load_dwordx4 v6, s[56:59], s22 offen offset:2048 lds
  v_mfma_f32_32x32x16_bf16 v[48:63], v[24:27], v[224:227], v[48:63]
  ds_read_b128 v[24:27], v14 offset:256
  s_waitcnt lgkmcnt(3)
  v_mfma_f32_32x32x16_bf16 v[32:47], v[28:31], v[164:167], v[32:47]
  buffer_load_dwordx4 v7, s[56:59], s22 offen offset:3072 lds
  v_mfma_f32_32x32x16_bf16 v[48:63], v[28:31], v[228:231], v[48:63]
  ds_read_b128 v[28:31], v15 offset:256
  s_waitcnt lgkmcnt(3)
  v_mfma_f32_32x32x16_bf16 v[32:47], v[16:19], v[168:171], v[32:47]
  s_add_u32 s22, s27, 1835008
  s_add_u32 m0, s25, 114688
  s_nop 0
  buffer_load_dwordx4 v4, s[56:59], s22 offen offset:0 lds
  v_mfma_f32_32x32x16_bf16 v[48:63], v[16:19], v[232:235], v[48:63]
  ds_read_b128 v[16:19], v8 offset:16384
  s_waitcnt lgkmcnt(3)
  v_mfma_f32_32x32x16_bf16 v[32:47], v[20:23], v[172:175], v[32:47]
  buffer_load_dwordx4 v5, s[56:59], s22 offen offset:1024 lds
  v_mfma_f32_32x32x16_bf16 v[48:63], v[20:23], v[236:239], v[48:63]
  ds_read_b128 v[20:23], v9 offset:16384
  s_waitcnt lgkmcnt(3)
  v_mfma_f32_32x32x16_bf16 v[32:47], v[24:27], v[176:179], v[32:47]
  buffer_load_dwordx4 v6, s[56:59], s22 offen offset:2048 lds
  v_mfma_f32_32x32x16_bf16 v[48:63], v[24:27], v[240:243], v[48:63]
  ds_read_b128 v[24:27], v10 offset:16384
  s_waitcnt lgkmcnt(3)
  v_mfma_f32_32x32x16_bf16 v[32:47], v[28:31], v[180:183], v[32:47]
  buffer_load_dwordx4 v7, s[56:59], s22 offen offset:3072 lds
  v_mfma_f32_32x32x16_bf16 v[48:63], v[28:31], v[244:247], v[48:63]
  s_waitcnt vmcnt(16)
  s_barrier
  ds_read_b128 v[28:31], v11 offset:16384
  s_waitcnt lgkmcnt(3)
  v_mfma_f32_32x32x16_bf16 v[64:79], v[16:19], v[120:123], 0
  s_add_u32 s22, s27, 2097152
  s_add_u32 m0, s25, 131072
  s_nop 0
  buffer_load_dwordx4 v4, s[56:59], s22 offen offset:0 lds
  v_mfma_f32_32x32x16_bf16 v[80:95], v[16:19], v[184:187], 0
  ds_read_b128 v[16:19], v12 offset:16384
  s_waitcnt lgkmcnt(3)
  v_mfma_f32_32x32x16_bf16 v[64:79], v[20:23], v[124:127], v[64:79]
  buffer_load_dwordx4 v5, s[56:59], s22 offen offset:1024 lds
  v_mul_f32 v32, s52, v32
  v_mul_f32 v33, s52, v33
  v_cvt_pk_bf16_f32 v32, v32, v33
  v_mfma_f32_32x32x16_bf16 v[80:95], v[20:23], v[188:191], v[80:95]
  v_mul_f32 v34, s52, v34
  v_mul_f32 v35, s52, v35
  ds_read_b128 v[20:23], v13 offset:16384
  s_waitcnt lgkmcnt(3)
  v_mfma_f32_32x32x16_bf16 v[64:79], v[24:27], v[128:131], v[64:79]
  buffer_load_dwordx4 v6, s[56:59], s22 offen offset:2048 lds
  v_cvt_pk_bf16_f32 v33, v34, v35
  v_mul_f32 v36, s52, v36
  v_mul_f32 v37, s52, v37
  v_mfma_f32_32x32x16_bf16 v[80:95], v[24:27], v[192:195], v[80:95]
  v_cvt_pk_bf16_f32 v34, v36, v37
  v_mul_f32 v38, s52, v38
  ds_read_b128 v[24:27], v14 offset:16384
  s_waitcnt lgkmcnt(3)
  v_mfma_f32_32x32x16_bf16 v[64:79], v[28:31], v[132:135], v[64:79]
  buffer_load_dwordx4 v7, s[56:59], s22 offen offset:3072 lds
  v_mul_f32 v39, s52, v39
  v_cvt_pk_bf16_f32 v35, v38, v39
  v_mul_f32 v40, s52, v40
  v_mfma_f32_32x32x16_bf16 v[80:95], v[28:31], v[196:199], v[80:95]
  v_mul_f32 v41, s52, v41
  v_cvt_pk_bf16_f32 v40, v40, v41
  ds_read_b128 v[28:31], v15 offset:16384
  s_waitcnt lgkmcnt(3)
  v_mfma_f32_32x32x16_bf16 v[64:79], v[16:19], v[136:139], v[64:79]
  s_add_u32 s22, s27, 2359296
  s_add_u32 m0, s25, 0
  s_nop 0
  buffer_load_dwordx4 v4, s[56:59], s22 offen offset:0 lds
  v_mul_f32 v42, s52, v42
  v_mul_f32 v43, s52, v43
  v_cvt_pk_bf16_f32 v41, v42, v43
  v_mfma_f32_32x32x16_bf16 v[80:95], v[16:19], v[200:203], v[80:95]
  v_mul_f32 v44, s52, v44
  v_mul_f32 v45, s52, v45
  ds_read_b128 v[16:19], v8 offset:16640
  s_waitcnt lgkmcnt(3)
  v_mfma_f32_32x32x16_bf16 v[64:79], v[20:23], v[140:143], v[64:79]
  buffer_load_dwordx4 v5, s[56:59], s22 offen offset:1024 lds
  v_cvt_pk_bf16_f32 v42, v44, v45
  v_mul_f32 v46, s52, v46
  v_mul_f32 v47, s52, v47
  v_mfma_f32_32x32x16_bf16 v[80:95], v[20:23], v[204:207], v[80:95]
  v_cvt_pk_bf16_f32 v43, v46, v47
  v_permlane16_swap_b32 v32, v40
  ds_read_b128 v[20:23], v9 offset:16640
  s_waitcnt lgkmcnt(3)
  v_mfma_f32_32x32x16_bf16 v[64:79], v[24:27], v[144:147], v[64:79]
  buffer_load_dwordx4 v6, s[56:59], s22 offen offset:2048 lds
  v_permlane16_swap_b32 v33, v41
  v_permlane16_swap_b32 v34, v42
  v_permlane16_swap_b32 v35, v43
  v_mfma_f32_32x32x16_bf16 v[80:95], v[24:27], v[208:211], v[80:95]
  v_accvgpr_write_b32 a0, v32
  v_accvgpr_write_b32 a1, v33
  ds_read_b128 v[24:27], v10 offset:16640
  s_waitcnt lgkmcnt(3)
  v_mfma_f32_32x32x16_bf16 v[64:79], v[28:31], v[148:151], v[64:79]
  buffer_load_dwordx4 v7, s[56:59], s22 offen offset:3072 lds
  v_accvgpr_write_b32 a2, v34
  v_accvgpr_write_b32 a3, v35
  v_accvgpr_write_b32 a56, v40
  v_mfma_f32_32x32x16_bf16 v[80:95], v[28:31], v[212:215], v[80:95]
  v_accvgpr_write_b32 a57, v41
  v_accvgpr_write_b32 a58, v42
  ds_read_b128 v[28:31], v11 offset:16640
  s_waitcnt lgkmcnt(3)
  v_mfma_f32_32x32x16_bf16 v[64:79], v[16:19], v[152:155], v[64:79]
  v_accvgpr_write_b32 a59, v43
  v_mul_f32 v48, s52, v48
  v_mul_f32 v49, s52, v49
  v_mfma_f32_32x32x16_bf16 v[80:95], v[16:19], v[216:219], v[80:95]
  v_cvt_pk_bf16_f32 v48, v48, v49
  v_mul_f32 v50, s52, v50
  ds_read_b128 v[16:19], v12 offset:16640
  s_waitcnt lgkmcnt(3)
  v_mfma_f32_32x32x16_bf16 v[64:79], v[20:23], v[156:159], v[64:79]
  v_mul_f32 v51, s52, v51
  v_cvt_pk_bf16_f32 v49, v50, v51
  v_mul_f32 v52, s52, v52
  v_mfma_f32_32x32x16_bf16 v[80:95], v[20:23], v[220:223], v[80:95]
  v_mul_f32 v53, s52, v53
  v_cvt_pk_bf16_f32 v50, v52, v53
  ds_read_b128 v[20:23], v13 offset:16640
  s_waitcnt lgkmcnt(3)
  v_mfma_f32_32x32x16_bf16 v[64:79], v[24:27], v[160:163], v[64:79]
  v_mul_f32 v54, s52, v54
  v_mul_f32 v55, s52, v55
  v_cvt_pk_bf16_f32 v51, v54, v55
  v_mfma_f32_32x32x16_bf16 v[80:95], v[24:27], v[224:227], v[80:95]
  v_mul_f32 v56, s52, v56
  v_mul_f32 v57, s52, v57
  ds_read_b128 v[24:27], v14 offset:16640
  s_waitcnt lgkmcnt(3)
  v_mfma_f32_32x32x16_bf16 v[64:79], v[28:31], v[164:167], v[64:79]
  v_cvt_pk_bf16_f32 v56, v56, v57
  v_mul_f32 v58, s52, v58
  v_mul_f32 v59, s52, v59
  v_mfma_f32_32x32x16_bf16 v[80:95], v[28:31], v[228:231], v[80:95]
  v_cvt_pk_bf16_f32 v57, v58, v59
  v_mul_f32 v60, s52, v60
  ds_read_b128 v[28:31], v15 offset:16640
  s_waitcnt lgkmcnt(3)
  v_mfma_f32_32x32x16_bf16 v[64:79], v[16:19], v[168:171], v[64:79]
  v_mul_f32 v61, s52, v61
  v_cvt_pk_bf16_f32 v58, v60, v61
  v_mul_f32 v62, s52, v62
  v_mfma_f32_32x32x16_bf16 v[80:95], v[16:19], v[232:235], v[80:95]
  v_mul_f32 v63, s52, v63
  v_cvt_pk_bf16_f32 v59, v62, v63
  ds_read_b128 v[16:19], v8 offset:32768
  s_waitcnt lgkmcnt(3)
  v_mfma_f32_32x32x16_bf16 v[64:79], v[20:23], v[172:175], v[64:79]
  v_permlane16_swap_b32 v48, v56
  v_permlane16_swap_b32 v49, v57
  v_permlane16_swap_b32 v50, v58
  v_mfma_f32_32x32x16_bf16 v[80:95], v[20:23], v[236:239], v[80:95]
  v_permlane16_swap_b32 v51, v59
  v_accvgpr_write_b32 a112, v48
  ds_read_b128 v[20:23], v9 offset:32768
  s_waitcnt lgkmcnt(3)
  v_mfma_f32_32x32x16_bf16 v[64:79], v[24:27], v[176:179], v[64:79]
  v_accvgpr_write_b32 a113, v49
  v_accvgpr_write_b32 a114, v50
  v_accvgpr_write_b32 a115, v51
  v_mfma_f32_32x32x16_bf16 v[80:95], v[24:27], v[240:243], v[80:95]
  v_accvgpr_write_b32 a168, v56
  v_accvgpr_write_b32 a169, v57
  ds_read_b128 v[24:27], v10 offset:32768
  s_waitcnt lgkmcnt(3)
  v_mfma_f32_32x32x16_bf16 v[64:79], v[28:31], v[180:183], v[64:79]
  v_accvgpr_write_b32 a170, v58
  v_accvgpr_write_b32 a171, v59
  v_mfma_f32_32x32x16_bf16 v[80:95], v[28:31], v[244:247], v[80:95]
  ds_read_b128 v[28:31], v11 offset:32768
  s_waitcnt lgkmcnt(3)
  v_mfma_f32_32x32x16_bf16 v[32:47], v[16:19], v[120:123], 0
  v_mfma_f32_32x32x16_bf16 v[48:63], v[16:19], v[184:187], 0
  ds_read_b128 v[16:19], v12 offset:32768
  s_waitcnt lgkmcnt(3)
  v_mfma_f32_32x32x16_bf16 v[32:47], v[20:23], v[124:127], v[32:47]
  v_mul_f32 v64, s52, v64
  v_mul_f32 v65, s52, v65
  v_cvt_pk_bf16_f32 v64, v64, v65
  v_mfma_f32_32x32x16_bf16 v[48:63], v[20:23], v[188:191], v[48:63]
  v_mul_f32 v66, s52, v66
  v_mul_f32 v67, s52, v67
  ds_read_b128 v[20:23], v13 offset:32768
  s_waitcnt lgkmcnt(3)
  v_mfma_f32_32x32x16_bf16 v[32:47], v[24:27], v[128:131], v[32:47]
  v_cvt_pk_bf16_f32 v65, v66, v67
  v_mul_f32 v68, s52, v68
  v_mul_f32 v69, s52, v69
  v_mfma_f32_32x32x16_bf16 v[48:63], v[24:27], v[192:195], v[48:63]
  v_cvt_pk_bf16_f32 v66, v68, v69
  v_mul_f32 v70, s52, v70
  ds_read_b128 v[24:27], v14 offset:32768
  s_waitcnt lgkmcnt(3)
  v_mfma_f32_32x32x16_bf16 v[32:47], v[28:31], v[132:135], v[32:47]
  v_mul_f32 v71, s52, v71
  v_cvt_pk_bf16_f32 v67, v70, v71
  v_mul_f32 v72, s52, v72
  v_mfma_f32_32x32x16_bf16 v[48:63], v[28:31], v[196:199], v[48:63]
  v_mul_f32 v73, s52, v73
  v_cvt_pk_bf16_f32 v72, v72, v73
  ds_read_b128 v[28:31], v15 offset:32768
  s_waitcnt lgkmcnt(3)
  v_mfma_f32_32x32x16_bf16 v[32:47], v[16:19], v[136:139], v[32:47]
  v_mul_f32 v74, s52, v74
  v_mul_f32 v75, s52, v75
  v_cvt_pk_bf16_f32 v73, v74, v75
  v_mfma_f32_32x32x16_bf16 v[48:63], v[16:19], v[200:203], v[48:63]
  v_mul_f32 v76, s52, v76
  v_mul_f32 v77, s52, v77
  ds_read_b128 v[16:19], v8 offset:33024
  s_waitcnt lgkmcnt(3)
  v_mfma_f32_32x32x16_bf16 v[32:47], v[20:23], v[140:143], v[32:47]
  v_cvt_pk_bf16_f32 v74, v76, v77
  v_mul_f32 v78, s52, v78
  v_mul_f32 v79, s52, v79
  v_mfma_f32_32x32x16_bf16 v[48:63], v[20:23], v[204:207], v[48:63]
  v_cvt_pk_bf16_f32 v75, v78, v79
  v_permlane16_swap_b32 v64, v72
  ds_read_b128 v[20:23], v9 offset:33024
  s_waitcnt lgkmcnt(3)
  v_mfma_f32_32x32x16_bf16 v[32:47], v[24:27], v[144:147], v[32:47]
  v_permlane16_swap_b32 v65, v73
  v_permlane16_swap_b32 v66, v74
  v_permlane16_swap_b32 v67, v75
  v_mfma_f32_32x32x16_bf16 v[48:63], v[24:27], v[208:211], v[48:63]
  v_accvgpr_write_b32 a4, v64
  v_accvgpr_write_b32 a5, v65
  ds_read_b128 v[24:27], v10 offset:33024
  s_waitcnt lgkmcnt(3)
  v_mfma_f32_32x32x16_bf16 v[32:47], v[28:31], v[148:151], v[32:47]
  v_accvgpr_write_b32 a6, v66
  v_accvgpr_write_b32 a7, v67
  v_accvgpr_write_b32 a60, v72
  v_mfma_f32_32x32x16_bf16 v[48:63], v[28:31], v[212:215], v[48:63]
  v_accvgpr_write_b32 a61, v73
  v_accvgpr_write_b32 a62, v74
  ds_read_b128 v[28:31], v11 offset:33024
  s_waitcnt lgkmcnt(3)
  v_mfma_f32_32x32x16_bf16 v[32:47], v[16:19], v[152:155], v[32:47]
  v_accvgpr_write_b32 a63, v75
  v_mul_f32 v80, s52, v80
  v_mul_f32 v81, s52, v81
  v_mfma_f32_32x32x16_bf16 v[48:63], v[16:19], v[216:219], v[48:63]
  v_cvt_pk_bf16_f32 v80, v80, v81
  v_mul_f32 v82, s52, v82
  ds_read_b128 v[16:19], v12 offset:33024
  s_waitcnt lgkmcnt(3)
  v_mfma_f32_32x32x16_bf16 v[32:47], v[20:23], v[156:159], v[32:47]
  v_mul_f32 v83, s52, v83
  v_cvt_pk_bf16_f32 v81, v82, v83
  v_mul_f32 v84, s52, v84
  v_mfma_f32_32x32x16_bf16 v[48:63], v[20:23], v[220:223], v[48:63]
  v_mul_f32 v85, s52, v85
  v_cvt_pk_bf16_f32 v82, v84, v85
  ds_read_b128 v[20:23], v13 offset:33024
  s_waitcnt lgkmcnt(3)
  v_mfma_f32_32x32x16_bf16 v[32:47], v[24:27], v[160:163], v[32:47]
  v_mul_f32 v86, s52, v86
  v_mul_f32 v87, s52, v87
  v_cvt_pk_bf16_f32 v83, v86, v87
  v_mfma_f32_32x32x16_bf16 v[48:63], v[24:27], v[224:227], v[48:63]
  v_mul_f32 v88, s52, v88
  v_mul_f32 v89, s52, v89
  ds_read_b128 v[24:27], v14 offset:33024
  s_waitcnt lgkmcnt(3)
  v_mfma_f32_32x32x16_bf16 v[32:47], v[28:31], v[164:167], v[32:47]
  v_cvt_pk_bf16_f32 v88, v88, v89
  v_mul_f32 v90, s52, v90
  v_mul_f32 v91, s52, v91
  v_mfma_f32_32x32x16_bf16 v[48:63], v[28:31], v[228:231], v[48:63]
  v_cvt_pk_bf16_f32 v89, v90, v91
  v_mul_f32 v92, s52, v92
  ds_read_b128 v[28:31], v15 offset:33024
  s_waitcnt lgkmcnt(3)
  v_mfma_f32_32x32x16_bf16 v[32:47], v[16:19], v[168:171], v[32:47]
  v_mul_f32 v93, s52, v93
  v_cvt_pk_bf16_f32 v90, v92, v93
  v_mul_f32 v94, s52, v94
  v_mfma_f32_32x32x16_bf16 v[48:63], v[16:19], v[232:235], v[48:63]
  v_mul_f32 v95, s52, v95
  v_cvt_pk_bf16_f32 v91, v94, v95
  ds_read_b128 v[16:19], v8 offset:49152
  s_waitcnt lgkmcnt(3)
  v_mfma_f32_32x32x16_bf16 v[32:47], v[20:23], v[172:175], v[32:47]
  v_permlane16_swap_b32 v80, v88
  v_permlane16_swap_b32 v81, v89
  v_permlane16_swap_b32 v82, v90
  v_mfma_f32_32x32x16_bf16 v[48:63], v[20:23], v[236:239], v[48:63]
  v_permlane16_swap_b32 v83, v91
  v_accvgpr_write_b32 a116, v80
  ds_read_b128 v[20:23], v9 offset:49152
  s_waitcnt lgkmcnt(3)
  v_mfma_f32_32x32x16_bf16 v[32:47], v[24:27], v[176:179], v[32:47]
  v_accvgpr_write_b32 a117, v81
  v_accvgpr_write_b32 a118, v82
  v_accvgpr_write_b32 a119, v83
  v_mfma_f32_32x32x16_bf16 v[48:63], v[24:27], v[240:243], v[48:63]
  v_accvgpr_write_b32 a172, v88
  v_accvgpr_write_b32 a173, v89
  ds_read_b128 v[24:27], v10 offset:49152
  s_waitcnt lgkmcnt(3)
  v_mfma_f32_32x32x16_bf16 v[32:47], v[28:31], v[180:183], v[32:47]
  v_accvgpr_write_b32 a174, v90
  v_accvgpr_write_b32 a175, v91
  v_mfma_f32_32x32x16_bf16 v[48:63], v[28:31], v[244:247], v[48:63]
  s_waitcnt vmcnt(16)
  s_barrier
  ds_read_b128 v[28:31], v11 offset:49152
  s_waitcnt lgkmcnt(3)
  v_mfma_f32_32x32x16_bf16 v[64:79], v[16:19], v[120:123], 0
  s_add_u32 s22, s27, 2621440
  s_add_u32 m0, s25, 16384
  s_nop 0
  buffer_load_dwordx4 v4, s[56:59], s22 offen offset:0 lds
  v_mfma_f32_32x32x16_bf16 v[80:95], v[16:19], v[184:187], 0
  ds_read_b128 v[16:19], v12 offset:49152
  s_waitcnt lgkmcnt(3)
  v_mfma_f32_32x32x16_bf16 v[64:79], v[20:23], v[124:127], v[64:79]
  buffer_load_dwordx4 v5, s[56:59], s22 offen offset:1024 lds
  v_mul_f32 v32, s52, v32
  v_mul_f32 v33, s52, v33
  v_cvt_pk_bf16_f32 v32, v32, v33
  v_mfma_f32_32x32x16_bf16 v[80:95], v[20:23], v[188:191], v[80:95]
  v_mul_f32 v34, s52, v34
  v_mul_f32 v35, s52, v35
  ds_read_b128 v[20:23], v13 offset:49152
  s_waitcnt lgkmcnt(3)
  v_mfma_f32_32x32x16_bf16 v[64:79], v[24:27], v[128:131], v[64:79]
  buffer_load_dwordx4 v6, s[56:59], s22 offen offset:2048 lds
  v_cvt_pk_bf16_f32 v33, v34, v35
  v_mul_f32 v36, s52, v36
  v_mul_f32 v37, s52, v37
  v_mfma_f32_32x32x16_bf16 v[80:95], v[24:27], v[192:195], v[80:95]
  v_cvt_pk_bf16_f32 v34, v36, v37
  v_mul_f32 v38, s52, v38
  ds_read_b128 v[24:27], v14 offset:49152
  s_waitcnt lgkmcnt(3)
  v_mfma_f32_32x32x16_bf16 v[64:79], v[28:31], v[132:135], v[64:79]
  buffer_load_dwordx4 v7, s[56:59], s22 offen offset:3072 lds
  v_mul_f32 v39, s52, v39
  v_cvt_pk_bf16_f32 v35, v38, v39
  v_mul_f32 v40, s52, v40
  v_mfma_f32_32x32x16_bf16 v[80:95], v[28:31], v[196:199], v[80:95]
  v_mul_f32 v41, s52, v41
  v_cvt_pk_bf16_f32 v40, v40, v41
  ds_read_b128 v[28:31], v15 offset:49152
  s_waitcnt lgkmcnt(3)
  v_mfma_f32_32x32x16_bf16 v[64:79], v[16:19], v[136:139], v[64:79]
  s_add_u32 s22, s27, 2883584
  s_add_u32 m0, s25, 32768
  s_nop 0
  buffer_load_dwordx4 v4, s[56:59], s22 offen offset:0 lds
  v_mul_f32 v42, s52, v42
  v_mul_f32 v43, s52, v43
  v_cvt_pk_bf16_f32 v41, v42, v43
  v_mfma_f32_32x32x16_bf16 v[80:95], v[16:19], v[200:203], v[80:95]
  v_mul_f32 v44, s52, v44
  v_mul_f32 v45, s52, v45
  ds_read_b128 v[16:19], v8 offset:49408
  s_waitcnt lgkmcnt(3)
  v_mfma_f32_32x32x16_bf16 v[64:79], v[20:23], v[140:143], v[64:79]
  buffer_load_dwordx4 v5, s[56:59], s22 offen offset:1024 lds
  v_cvt_pk_bf16_f32 v42, v44, v45
  v_mul_f32 v46, s52, v46
  v_mul_f32 v47, s52, v47
  v_mfma_f32_32x32x16_bf16 v[80:95], v[20:23], v[204:207], v[80:95]
  v_cvt_pk_bf16_f32 v43, v46, v47
  v_permlane16_swap_b32 v32, v40
  ds_read_b128 v[20:23], v9 offset:49408
  s_waitcnt lgkmcnt(3)
  v_mfma_f32_32x32x16_bf16 v[64:79], v[24:27], v[144:147], v[64:79]
  buffer_load_dwordx4 v6, s[56:59], s22 offen offset:2048 lds
  v_permlane16_swap_b32 v33, v41
  v_permlane16_swap_b32 v34, v42
  v_permlane16_swap_b32 v35, v43
  v_mfma_f32_32x32x16_bf16 v[80:95], v[24:27], v[208:211], v[80:95]
  v_accvgpr_write_b32 a8, v32
  v_accvgpr_write_b32 a9, v33
  ds_read_b128 v[24:27], v10 offset:49408
  s_waitcnt lgkmcnt(3)
  v_mfma_f32_32x32x16_bf16 v[64:79], v[28:31], v[148:151], v[64:79]
  buffer_load_dwordx4 v7, s[56:59], s22 offen offset:3072 lds
  v_accvgpr_write_b32 a10, v34
  v_accvgpr_write_b32 a11, v35
  v_accvgpr_write_b32 a64, v40
  v_mfma_f32_32x32x16_bf16 v[80:95], v[28:31], v[212:215], v[80:95]
  v_accvgpr_write_b32 a65, v41
  v_accvgpr_write_b32 a66, v42
  ds_read_b128 v[28:31], v11 offset:49408
  s_waitcnt lgkmcnt(3)
  v_mfma_f32_32x32x16_bf16 v[64:79], v[16:19], v[152:155], v[64:79]
  v_accvgpr_write_b32 a67, v43
  v_mul_f32 v48, s52, v48
  v_mul_f32 v49, s52, v49
  v_mfma_f32_32x32x16_bf16 v[80:95], v[16:19], v[216:219], v[80:95]
  v_cvt_pk_bf16_f32 v48, v48, v49
  v_mul_f32 v50, s52, v50
  ds_read_b128 v[16:19], v12 offset:49408
  s_waitcnt lgkmcnt(3)
  v_mfma_f32_32x32x16_bf16 v[64:79], v[20:23], v[156:159], v[64:79]
  v_mul_f32 v51, s52, v51
  v_cvt_pk_bf16_f32 v49, v50, v51
  v_mul_f32 v52, s52, v52
  v_mfma_f32_32x32x16_bf16 v[80:95], v[20:23], v[220:223], v[80:95]
  v_mul_f32 v53, s52, v53
  v_cvt_pk_bf16_f32 v50, v52, v53
  ds_read_b128 v[20:23], v13 offset:49408
  s_waitcnt lgkmcnt(3)
  v_mfma_f32_32x32x16_bf16 v[64:79], v[24:27], v[160:163], v[64:79]
  v_mul_f32 v54, s52, v54
  v_mul_f32 v55, s52, v55
  v_cvt_pk_bf16_f32 v51, v54, v55
  v_mfma_f32_32x32x16_bf16 v[80:95], v[24:27], v[224:227], v[80:95]
  v_mul_f32 v56, s52, v56
  v_mul_f32 v57, s52, v57
  ds_read_b128 v[24:27], v14 offset:49408
  s_waitcnt lgkmcnt(3)
  v_mfma_f32_32x32x16_bf16 v[64:79], v[28:31], v[164:167], v[64:79]
  v_cvt_pk_bf16_f32 v56, v56, v57
  v_mul_f32 v58, s52, v58
  v_mul_f32 v59, s52, v59
  v_mfma_f32_32x32x16_bf16 v[80:95], v[28:31], v[228:231], v[80:95]
  v_cvt_pk_bf16_f32 v57, v58, v59
  v_mul_f32 v60, s52, v60
  ds_read_b128 v[28:31], v15 offset:49408
  s_waitcnt lgkmcnt(3)
  v_mfma_f32_32x32x16_bf16 v[64:79], v[16:19], v[168:171], v[64:79]
  v_mul_f32 v61, s52, v61
  v_cvt_pk_bf16_f32 v58, v60, v61
  v_mul_f32 v62, s52, v62
  v_mfma_f32_32x32x16_bf16 v[80:95], v[16:19], v[232:235], v[80:95]
  v_mul_f32 v63, s52, v63
  v_cvt_pk_bf16_f32 v59, v62, v63
  v_xor_b32 v8, 65536, v8
  ds_read_b128 v[16:19], v8 offset:0
  s_waitcnt lgkmcnt(3)
  v_mfma_f32_32x32x16_bf16 v[64:79], v[20:23], v[172:175], v[64:79]
  v_permlane16_swap_b32 v48, v56
  v_permlane16_swap_b32 v49, v57
  v_permlane16_swap_b32 v50, v58
  v_mfma_f32_32x32x16_bf16 v[80:95], v[20:23], v[236:239], v[80:95]
  v_permlane16_swap_b32 v51, v59
  v_accvgpr_write_b32 a120, v48
  v_xor_b32 v9, 65536, v9
  ds_read_b128 v[20:23], v9 offset:0
  s_waitcnt lgkmcnt(3)
  v_mfma_f32_32x32x16_bf16 v[64:79], v[24:27], v[176:179], v[64:79]
  v_accvgpr_write_b32 a121, v49
  v_accvgpr_write_b32 a122, v50
  v_accvgpr_write_b32 a123, v51
  v_mfma_f32_32x32x16_bf16 v[80:95], v[24:27], v[240:243], v[80:95]
  v_accvgpr_write_b32 a176, v56
  v_accvgpr_write_b32 a177, v57
  v_xor_b32 v10, 65536, v10
  ds_read_b128 v[24:27], v10 offset:0
  s_waitcnt lgkmcnt(3)
  v_mfma_f32_32x32x16_bf16 v[64:79], v[28:31], v[180:183], v[64:79]
  v_accvgpr_write_b32 a178, v58
  v_accvgpr_write_b32 a179, v59
  v_mfma_f32_32x32x16_bf16 v[80:95], v[28:31], v[244:247], v[80:95]
  v_xor_b32 v11, 65536, v11
  ds_read_b128 v[28:31], v11 offset:0
  s_waitcnt lgkmcnt(3)
  v_mfma_f32_32x32x16_bf16 v[32:47], v[16:19], v[120:123], 0
  v_mfma_f32_32x32x16_bf16 v[48:63], v[16:19], v[184:187], 0
  v_xor_b32 v12, 65536, v12
  ds_read_b128 v[16:19], v12 offset:0
  s_waitcnt lgkmcnt(3)
  v_mfma_f32_32x32x16_bf16 v[32:47], v[20:23], v[124:127], v[32:47]
  v_mul_f32 v64, s52, v64
  v_mul_f32 v65, s52, v65
  v_cvt_pk_bf16_f32 v64, v64, v65
  v_mfma_f32_32x32x16_bf16 v[48:63], v[20:23], v[188:191], v[48:63]
  v_mul_f32 v66, s52, v66
  v_mul_f32 v67, s52, v67
  v_xor_b32 v13, 65536, v13
  ds_read_b128 v[20:23], v13 offset:0
  s_waitcnt lgkmcnt(3)
  v_mfma_f32_32x32x16_bf16 v[32:47], v[24:27], v[128:131], v[32:47]
  v_cvt_pk_bf16_f32 v65, v66, v67
  v_mul_f32 v68, s52, v68
  v_mul_f32 v69, s52, v69
  v_mfma_f32_32x32x16_bf16 v[48:63], v[24:27], v[192:195], v[48:63]
  v_cvt_pk_bf16_f32 v66, v68, v69
  v_mul_f32 v70, s52, v70
  v_xor_b32 v14, 65536, v14
  ds_read_b128 v[24:27], v14 offset:0
  s_waitcnt lgkmcnt(3)
  v_mfma_f32_32x32x16_bf16 v[32:47], v[28:31], v[132:135], v[32:47]
  v_mul_f32 v71, s52, v71
  v_cvt_pk_bf16_f32 v67, v70, v71
  v_mul_f32 v72, s52, v72
  v_mfma_f32_32x32x16_bf16 v[48:63], v[28:31], v[196:199], v[48:63]
  v_mul_f32 v73, s52, v73
  v_cvt_pk_bf16_f32 v72, v72, v73
  v_xor_b32 v15, 65536, v15
  ds_read_b128 v[28:31], v15 offset:0
  s_waitcnt lgkmcnt(3)
  v_mfma_f32_32x32x16_bf16 v[32:47], v[16:19], v[136:139], v[32:47]
  v_mul_f32 v74, s52, v74
  v_mul_f32 v75, s52, v75
  v_cvt_pk_bf16_f32 v73, v74, v75
  v_mfma_f32_32x32x16_bf16 v[48:63], v[16:19], v[200:203], v[48:63]
  v_mul_f32 v76, s52, v76
  v_mul_f32 v77, s52, v77
  ds_read_b128 v[16:19], v8 offset:256
  s_waitcnt lgkmcnt(3)
  v_mfma_f32_32x32x16_bf16 v[32:47], v[20:23], v[140:143], v[32:47]
  v_cvt_pk_bf16_f32 v74, v76, v77
  v_mul_f32 v78, s52, v78
  v_mul_f32 v79, s52, v79
  v_mfma_f32_32x32x16_bf16 v[48:63], v[20:23], v[204:207], v[48:63]
  v_cvt_pk_bf16_f32 v75, v78, v79
  v_permlane16_swap_b32 v64, v72
  ds_read_b128 v[20:23], v9 offset:256
  s_waitcnt lgkmcnt(3)
  v_mfma_f32_32x32x16_bf16 v[32:47], v[24:27], v[144:147], v[32:47]
  v_permlane16_swap_b32 v65, v73
  v_permlane16_swap_b32 v66, v74
  v_permlane16_swap_b32 v67, v75
  v_mfma_f32_32x32x16_bf16 v[48:63], v[24:27], v[208:211], v[48:63]
  v_accvgpr_write_b32 a12, v64
  v_accvgpr_write_b32 a13, v65
  ds_read_b128 v[24:27], v10 offset:256
  s_waitcnt lgkmcnt(3)
  v_mfma_f32_32x32x16_bf16 v[32:47], v[28:31], v[148:151], v[32:47]
  v_accvgpr_write_b32 a14, v66
  v_accvgpr_write_b32 a15, v67
  v_accvgpr_write_b32 a68, v72
  v_mfma_f32_32x32x16_bf16 v[48:63], v[28:31], v[212:215], v[48:63]
  v_accvgpr_write_b32 a69, v73
  v_accvgpr_write_b32 a70, v74
  ds_read_b128 v[28:31], v11 offset:256
  s_waitcnt lgkmcnt(3)
  v_mfma_f32_32x32x16_bf16 v[32:47], v[16:19], v[152:155], v[32:47]
  v_accvgpr_write_b32 a71, v75
  v_mul_f32 v80, s52, v80
  v_mul_f32 v81, s52, v81
  v_mfma_f32_32x32x16_bf16 v[48:63], v[16:19], v[216:219], v[48:63]
  v_cvt_pk_bf16_f32 v80, v80, v81
  v_mul_f32 v82, s52, v82
  ds_read_b128 v[16:19], v12 offset:256
  s_waitcnt lgkmcnt(3)
  v_mfma_f32_32x32x16_bf16 v[32:47], v[20:23], v[156:159], v[32:47]
  v_mul_f32 v83, s52, v83
  v_cvt_pk_bf16_f32 v81, v82, v83
  v_mul_f32 v84, s52, v84
  v_mfma_f32_32x32x16_bf16 v[48:63], v[20:23], v[220:223], v[48:63]
  v_mul_f32 v85, s52, v85
  v_cvt_pk_bf16_f32 v82, v84, v85
  ds_read_b128 v[20:23], v13 offset:256
  s_waitcnt lgkmcnt(3)
  v_mfma_f32_32x32x16_bf16 v[32:47], v[24:27], v[160:163], v[32:47]
  v_mul_f32 v86, s52, v86
  v_mul_f32 v87, s52, v87
  v_cvt_pk_bf16_f32 v83, v86, v87
  v_mfma_f32_32x32x16_bf16 v[48:63], v[24:27], v[224:227], v[48:63]
  v_mul_f32 v88, s52, v88
  v_mul_f32 v89, s52, v89
  ds_read_b128 v[24:27], v14 offset:256
  s_waitcnt lgkmcnt(3)
  v_mfma_f32_32x32x16_bf16 v[32:47], v[28:31], v[164:167], v[32:47]
  v_cvt_pk_bf16_f32 v88, v88, v89
  v_mul_f32 v90, s52, v90
  v_mul_f32 v91, s52, v91
  v_mfma_f32_32x32x16_bf16 v[48:63], v[28:31], v[228:231], v[48:63]
  v_cvt_pk_bf16_f32 v89, v90, v91
  v_mul_f32 v92, s52, v92
  ds_read_b128 v[28:31], v15 offset:256
  s_waitcnt lgkmcnt(3)
  v_mfma_f32_32x32x16_bf16 v[32:47], v[16:19], v[168:171], v[32:47]
  v_mul_f32 v93, s52, v93
  v_cvt_pk_bf16_f32 v90, v92, v93
  v_mul_f32 v94, s52, v94
  v_mfma_f32_32x32x16_bf16 v[48:63], v[16:19], v[232:235], v[48:63]
  v_mul_f32 v95, s52, v95
  v_cvt_pk_bf16_f32 v91, v94, v95
  ds_read_b128 v[16:19], v8 offset:16384
  s_waitcnt lgkmcnt(3)
  v_mfma_f32_32x32x16_bf16 v[32:47], v[20:23], v[172:175], v[32:47]
  v_permlane16_swap_b32 v80, v88
  v_permlane16_swap_b32 v81, v89
  v_permlane16_swap_b32 v82, v90
  v_mfma_f32_32x32x16_bf16 v[48:63], v[20:23], v[236:239], v[48:63]
  v_permlane16_swap_b32 v83, v91
  v_accvgpr_write_b32 a124, v80
  ds_read_b128 v[20:23], v9 offset:16384
  s_waitcnt lgkmcnt(3)
  v_mfma_f32_32x32x16_bf16 v[32:47], v[24:27], v[176:179], v[32:47]
  v_accvgpr_write_b32 a125, v81
  v_accvgpr_write_b32 a126, v82
  v_accvgpr_write_b32 a127, v83
  v_mfma_f32_32x32x16_bf16 v[48:63], v[24:27], v[240:243], v[48:63]
  v_accvgpr_write_b32 a180, v88
  v_accvgpr_write_b32 a181, v89
  ds_read_b128 v[24:27], v10 offset:16384
  s_waitcnt lgkmcnt(3)
  v_mfma_f32_32x32x16_bf16 v[32:47], v[28:31], v[180:183], v[32:47]
  v_accvgpr_write_b32 a182, v90
  v_accvgpr_write_b32 a183, v91
  v_mfma_f32_32x32x16_bf16 v[48:63], v[28:31], v[244:247], v[48:63]
  s_waitcnt vmcnt(16)
  s_barrier
  ds_read_b128 v[28:31], v11 offset:16384
  s_waitcnt lgkmcnt(3)
  v_mfma_f32_32x32x16_bf16 v[64:79], v[16:19], v[120:123], 0
  s_add_u32 s22, s27, 3145728
  s_add_u32 m0, s25, 49152
  s_nop 0
  buffer_load_dwordx4 v4, s[56:59], s22 offen offset:0 lds
  v_mfma_f32_32x32x16_bf16 v[80:95], v[16:19], v[184:187], 0
  ds_read_b128 v[16:19], v12 offset:16384
  s_waitcnt lgkmcnt(3)
  v_mfma_f32_32x32x16_bf16 v[64:79], v[20:23], v[124:127], v[64:79]
  buffer_load_dwordx4 v5, s[56:59], s22 offen offset:1024 lds
  v_mul_f32 v32, s52, v32
  v_mul_f32 v33, s52, v33
  v_cvt_pk_bf16_f32 v32, v32, v33
  v_mfma_f32_32x32x16_bf16 v[80:95], v[20:23], v[188:191], v[80:95]
  v_mul_f32 v34, s52, v34
  v_mul_f32 v35, s52, v35
  ds_read_b128 v[20:23], v13 offset:16384
  s_waitcnt lgkmcnt(3)
  v_mfma_f32_32x32x16_bf16 v[64:79], v[24:27], v[128:131], v[64:79]
  buffer_load_dwordx4 v6, s[56:59], s22 offen offset:2048 lds
  v_cvt_pk_bf16_f32 v33, v34, v35
  v_mul_f32 v36, s52, v36
  v_mul_f32 v37, s52, v37
  v_mfma_f32_32x32x16_bf16 v[80:95], v[24:27], v[192:195], v[80:95]
  v_cvt_pk_bf16_f32 v34, v36, v37
  v_mul_f32 v38, s52, v38
  ds_read_b128 v[24:27], v14 offset:16384
  s_waitcnt lgkmcnt(3)
  v_mfma_f32_32x32x16_bf16 v[64:79], v[28:31], v[132:135], v[64:79]
  buffer_load_dwordx4 v7, s[56:59], s22 offen offset:3072 lds
  v_mul_f32 v39, s52, v39
  v_cvt_pk_bf16_f32 v35, v38, v39
  v_mul_f32 v40, s52, v40
  v_mfma_f32_32x32x16_bf16 v[80:95], v[28:31], v[196:199], v[80:95]
  v_mul_f32 v41, s52, v41
  v_cvt_pk_bf16_f32 v40, v40, v41
  ds_read_b128 v[28:31], v15 offset:16384
  s_waitcnt lgkmcnt(3)
  v_mfma_f32_32x32x16_bf16 v[64:79], v[16:19], v[136:139], v[64:79]
  s_add_u32 s22, s27, 3407872
  s_add_u32 m0, s25, 65536
  s_nop 0
  buffer_load_dwordx4 v4, s[56:59], s22 offen offset:0 lds
  v_mul_f32 v42, s52, v42
  v_mul_f32 v43, s52, v43
  v_cvt_pk_bf16_f32 v41, v42, v43
  v_mfma_f32_32x32x16_bf16 v[80:95], v[16:19], v[200:203], v[80:95]
  v_mul_f32 v44, s52, v44
  v_mul_f32 v45, s52, v45
  ds_read_b128 v[16:19], v8 offset:16640
  s_waitcnt lgkmcnt(3)
  v_mfma_f32_32x32x16_bf16 v[64:79], v[20:23], v[140:143], v[64:79]
  buffer_load_dwordx4 v5, s[56:59], s22 offen offset:1024 lds
  v_cvt_pk_bf16_f32 v42, v44, v45
  v_mul_f32 v46, s52, v46
  v_mul_f32 v47, s52, v47
  v_mfma_f32_32x32x16_bf16 v[80:95], v[20:23], v[204:207], v[80:95]
  v_cvt_pk_bf16_f32 v43, v46, v47
  v_permlane16_swap_b32 v32, v40
  ds_read_b128 v[20:23], v9 offset:16640
  s_waitcnt lgkmcnt(3)
  v_mfma_f32_32x32x16_bf16 v[64:79], v[24:27], v[144:147], v[64:79]
  buffer_load_dwordx4 v6, s[56:59], s22 offen offset:2048 lds
  v_permlane16_swap_b32 v33, v41
  v_permlane16_swap_b32 v34, v42
  v_permlane16_swap_b32 v35, v43
  v_mfma_f32_32x32x16_bf16 v[80:95], v[24:27], v[208:211], v[80:95]
  v_accvgpr_write_b32 a16, v32
  v_accvgpr_write_b32 a17, v33
  ds_read_b128 v[24:27], v10 offset:16640
  s_waitcnt lgkmcnt(3)
  v_mfma_f32_32x32x16_bf16 v[64:79], v[28:31], v[148:151], v[64:79]
  buffer_load_dwordx4 v7, s[56:59], s22 offen offset:3072 lds
  v_accvgpr_write_b32 a18, v34
  v_accvgpr_write_b32 a19, v35
  v_accvgpr_write_b32 a72, v40
  v_mfma_f32_32x32x16_bf16 v[80:95], v[28:31], v[212:215], v[80:95]
  v_accvgpr_write_b32 a73, v41
  v_accvgpr_write_b32 a74, v42
  ds_read_b128 v[28:31], v11 offset:16640
  s_waitcnt lgkmcnt(3)
  v_mfma_f32_32x32x16_bf16 v[64:79], v[16:19], v[152:155], v[64:79]
  v_accvgpr_write_b32 a75, v43
  v_mul_f32 v48, s52, v48
  v_mul_f32 v49, s52, v49
  v_mfma_f32_32x32x16_bf16 v[80:95], v[16:19], v[216:219], v[80:95]
  v_cvt_pk_bf16_f32 v48, v48, v49
  v_mul_f32 v50, s52, v50
  ds_read_b128 v[16:19], v12 offset:16640
  s_waitcnt lgkmcnt(3)
  v_mfma_f32_32x32x16_bf16 v[64:79], v[20:23], v[156:159], v[64:79]
  v_mul_f32 v51, s52, v51
  v_cvt_pk_bf16_f32 v49, v50, v51
  v_mul_f32 v52, s52, v52
  v_mfma_f32_32x32x16_bf16 v[80:95], v[20:23], v[220:223], v[80:95]
  v_mul_f32 v53, s52, v53
  v_cvt_pk_bf16_f32 v50, v52, v53
  ds_read_b128 v[20:23], v13 offset:16640
  s_waitcnt lgkmcnt(3)
  v_mfma_f32_32x32x16_bf16 v[64:79], v[24:27], v[160:163], v[64:79]
  v_mul_f32 v54, s52, v54
  v_mul_f32 v55, s52, v55
  v_cvt_pk_bf16_f32 v51, v54, v55
  v_mfma_f32_32x32x16_bf16 v[80:95], v[24:27], v[224:227], v[80:95]
  v_mul_f32 v56, s52, v56
  v_mul_f32 v57, s52, v57
  ds_read_b128 v[24:27], v14 offset:16640
  s_waitcnt lgkmcnt(3)
  v_mfma_f32_32x32x16_bf16 v[64:79], v[28:31], v[164:167], v[64:79]
  v_cvt_pk_bf16_f32 v56, v56, v57
  v_mul_f32 v58, s52, v58
  v_mul_f32 v59, s52, v59
  v_mfma_f32_32x32x16_bf16 v[80:95], v[28:31], v[228:231], v[80:95]
  v_cvt_pk_bf16_f32 v57, v58, v59
  v_mul_f32 v60, s52, v60
  ds_read_b128 v[28:31], v15 offset:16640
  s_waitcnt lgkmcnt(3)
  v_mfma_f32_32x32x16_bf16 v[64:79], v[16:19], v[168:171], v[64:79]
  v_mul_f32 v61, s52, v61
  v_cvt_pk_bf16_f32 v58, v60, v61
  v_mul_f32 v62, s52, v62
  v_mfma_f32_32x32x16_bf16 v[80:95], v[16:19], v[232:235], v[80:95]
  v_mul_f32 v63, s52, v63
  v_cvt_pk_bf16_f32 v59, v62, v63
  ds_read_b128 v[16:19], v8 offset:32768
  s_waitcnt lgkmcnt(3)
  v_mfma_f32_32x32x16_bf16 v[64:79], v[20:23], v[172:175], v[64:79]
  v_permlane16_swap_b32 v48, v56
  v_permlane16_swap_b32 v49, v57
  v_permlane16_swap_b32 v50, v58
  v_mfma_f32_32x32x16_bf16 v[80:95], v[20:23], v[236:239], v[80:95]
  v_permlane16_swap_b32 v51, v59
  v_accvgpr_write_b32 a128, v48
  ds_read_b128 v[20:23], v9 offset:32768
  s_waitcnt lgkmcnt(3)
  v_mfma_f32_32x32x16_bf16 v[64:79], v[24:27], v[176:179], v[64:79]
  v_accvgpr_write_b32 a129, v49
  v_accvgpr_write_b32 a130, v50
  v_accvgpr_write_b32 a131, v51
  v_mfma_f32_32x32x16_bf16 v[80:95], v[24:27], v[240:243], v[80:95]
  v_accvgpr_write_b32 a184, v56
  v_accvgpr_write_b32 a185, v57
  ds_read_b128 v[24:27], v10 offset:32768
  s_waitcnt lgkmcnt(3)
  v_mfma_f32_32x32x16_bf16 v[64:79], v[28:31], v[180:183], v[64:79]
  v_accvgpr_write_b32 a186, v58
  v_accvgpr_write_b32 a187, v59
  v_mfma_f32_32x32x16_bf16 v[80:95], v[28:31], v[244:247], v[80:95]
  ds_read_b128 v[28:31], v11 offset:32768
  s_waitcnt lgkmcnt(3)
  v_mfma_f32_32x32x16_bf16 v[32:47], v[16:19], v[120:123], 0
  v_mfma_f32_32x32x16_bf16 v[48:63], v[16:19], v[184:187], 0
  ds_read_b128 v[16:19], v12 offset:32768
  s_waitcnt lgkmcnt(3)
  v_mfma_f32_32x32x16_bf16 v[32:47], v[20:23], v[124:127], v[32:47]
  v_mul_f32 v64, s52, v64
  v_mul_f32 v65, s52, v65
  v_cvt_pk_bf16_f32 v64, v64, v65
  v_mfma_f32_32x32x16_bf16 v[48:63], v[20:23], v[188:191], v[48:63]
  v_mul_f32 v66, s52, v66
  v_mul_f32 v67, s52, v67
  ds_read_b128 v[20:23], v13 offset:32768
  s_waitcnt lgkmcnt(3)
  v_mfma_f32_32x32x16_bf16 v[32:47], v[24:27], v[128:131], v[32:47]
  v_cvt_pk_bf16_f32 v65, v66, v67
  v_mul_f32 v68, s52, v68
  v_mul_f32 v69, s52, v69
  v_mfma_f32_32x32x16_bf16 v[48:63], v[24:27], v[192:195], v[48:63]
  v_cvt_pk_bf16_f32 v66, v68, v69
  v_mul_f32 v70, s52, v70
  ds_read_b128 v[24:27], v14 offset:32768
  s_waitcnt lgkmcnt(3)
  v_mfma_f32_32x32x16_bf16 v[32:47], v[28:31], v[132:135], v[32:47]
  v_mul_f32 v71, s52, v71
  v_cvt_pk_bf16_f32 v67, v70, v71
  v_mul_f32 v72, s52, v72
  v_mfma_f32_32x32x16_bf16 v[48:63], v[28:31], v[196:199], v[48:63]
  v_mul_f32 v73, s52, v73
  v_cvt_pk_bf16_f32 v72, v72, v73
  ds_read_b128 v[28:31], v15 offset:32768
  s_waitcnt lgkmcnt(3)
  v_mfma_f32_32x32x16_bf16 v[32:47], v[16:19], v[136:139], v[32:47]
  v_mul_f32 v74, s52, v74
  v_mul_f32 v75, s52, v75
  v_cvt_pk_bf16_f32 v73, v74, v75
  v_mfma_f32_32x32x16_bf16 v[48:63], v[16:19], v[200:203], v[48:63]
  v_mul_f32 v76, s52, v76
  v_mul_f32 v77, s52, v77
  ds_read_b128 v[16:19], v8 offset:33024
  s_waitcnt lgkmcnt(3)
  v_mfma_f32_32x32x16_bf16 v[32:47], v[20:23], v[140:143], v[32:47]
  v_cvt_pk_bf16_f32 v74, v76, v77
  v_mul_f32 v78, s52, v78
  v_mul_f32 v79, s52, v79
  v_mfma_f32_32x32x16_bf16 v[48:63], v[20:23], v[204:207], v[48:63]
  v_cvt_pk_bf16_f32 v75, v78, v79
  v_permlane16_swap_b32 v64, v72
  ds_read_b128 v[20:23], v9 offset:33024
  s_waitcnt lgkmcnt(3)
  v_mfma_f32_32x32x16_bf16 v[32:47], v[24:27], v[144:147], v[32:47]
  v_permlane16_swap_b32 v65, v73
  v_permlane16_swap_b32 v66, v74
  v_permlane16_swap_b32 v67, v75
  v_mfma_f32_32x32x16_bf16 v[48:63], v[24:27], v[208:211], v[48:63]
  v_accvgpr_write_b32 a20, v64
  v_accvgpr_write_b32 a21, v65
  ds_read_b128 v[24:27], v10 offset:33024
  s_waitcnt lgkmcnt(3)
  v_mfma_f32_32x32x16_bf16 v[32:47], v[28:31], v[148:151], v[32:47]
  v_accvgpr_write_b32 a22, v66
  v_accvgpr_write_b32 a23, v67
  v_accvgpr_write_b32 a76, v72
  v_mfma_f32_32x32x16_bf16 v[48:63], v[28:31], v[212:215], v[48:63]
  v_accvgpr_write_b32 a77, v73
  v_accvgpr_write_b32 a78, v74
  ds_read_b128 v[28:31], v11 offset:33024
  s_waitcnt lgkmcnt(3)
  v_mfma_f32_32x32x16_bf16 v[32:47], v[16:19], v[152:155], v[32:47]
  v_accvgpr_write_b32 a79, v75
  v_mul_f32 v80, s52, v80
  v_mul_f32 v81, s52, v81
  v_mfma_f32_32x32x16_bf16 v[48:63], v[16:19], v[216:219], v[48:63]
  v_cvt_pk_bf16_f32 v80, v80, v81
  v_mul_f32 v82, s52, v82
  ds_read_b128 v[16:19], v12 offset:33024
  s_waitcnt lgkmcnt(3)
  v_mfma_f32_32x32x16_bf16 v[32:47], v[20:23], v[156:159], v[32:47]
  v_mul_f32 v83, s52, v83
  v_cvt_pk_bf16_f32 v81, v82, v83
  v_mul_f32 v84, s52, v84
  v_mfma_f32_32x32x16_bf16 v[48:63], v[20:23], v[220:223], v[48:63]
  v_mul_f32 v85, s52, v85
  v_cvt_pk_bf16_f32 v82, v84, v85
  ds_read_b128 v[20:23], v13 offset:33024
  s_waitcnt lgkmcnt(3)
  v_mfma_f32_32x32x16_bf16 v[32:47], v[24:27], v[160:163], v[32:47]
  v_mul_f32 v86, s52, v86
  v_mul_f32 v87, s52, v87
  v_cvt_pk_bf16_f32 v83, v86, v87
  v_mfma_f32_32x32x16_bf16 v[48:63], v[24:27], v[224:227], v[48:63]
  v_mul_f32 v88, s52, v88
  v_mul_f32 v89, s52, v89
  ds_read_b128 v[24:27], v14 offset:33024
  s_waitcnt lgkmcnt(3)
  v_mfma_f32_32x32x16_bf16 v[32:47], v[28:31], v[164:167], v[32:47]
  v_cvt_pk_bf16_f32 v88, v88, v89
  v_mul_f32 v90, s52, v90
  v_mul_f32 v91, s52, v91
  v_mfma_f32_32x32x16_bf16 v[48:63], v[28:31], v[228:231], v[48:63]
  v_cvt_pk_bf16_f32 v89, v90, v91
  v_mul_f32 v92, s52, v92
  ds_read_b128 v[28:31], v15 offset:33024
  s_waitcnt lgkmcnt(3)
  v_mfma_f32_32x32x16_bf16 v[32:47], v[16:19], v[168:171], v[32:47]
  v_mul_f32 v93, s52, v93
  v_cvt_pk_bf16_f32 v90, v92, v93
  v_mul_f32 v94, s52, v94
  v_mfma_f32_32x32x16_bf16 v[48:63], v[16:19], v[232:235], v[48:63]
  v_mul_f32 v95, s52, v95
  v_cvt_pk_bf16_f32 v91, v94, v95
  ds_read_b128 v[16:19], v8 offset:49152
  s_waitcnt lgkmcnt(3)
  v_mfma_f32_32x32x16_bf16 v[32:47], v[20:23], v[172:175], v[32:47]
  v_permlane16_swap_b32 v80, v88
  v_permlane16_swap_b32 v81, v89
  v_permlane16_swap_b32 v82, v90
  v_mfma_f32_32x32x16_bf16 v[48:63], v[20:23], v[236:239], v[48:63]
  v_permlane16_swap_b32 v83, v91
  v_accvgpr_write_b32 a132, v80
  ds_read_b128 v[20:23], v9 offset:49152
  s_waitcnt lgkmcnt(3)
  v_mfma_f32_32x32x16_bf16 v[32:47], v[24:27], v[176:179], v[32:47]
  v_accvgpr_write_b32 a133, v81
  v_accvgpr_write_b32 a134, v82
  v_accvgpr_write_b32 a135, v83
  v_mfma_f32_32x32x16_bf16 v[48:63], v[24:27], v[240:243], v[48:63]
  v_accvgpr_write_b32 a188, v88
  v_accvgpr_write_b32 a189, v89
  ds_read_b128 v[24:27], v10 offset:49152
  s_waitcnt lgkmcnt(3)
  v_mfma_f32_32x32x16_bf16 v[32:47], v[28:31], v[180:183], v[32:47]
  v_accvgpr_write_b32 a190, v90
  v_accvgpr_write_b32 a191, v91
  v_mfma_f32_32x32x16_bf16 v[48:63], v[28:31], v[244:247], v[48:63]
  s_waitcnt vmcnt(16)
  s_barrier
  ds_read_b128 v[28:31], v11 offset:49152
  s_waitcnt lgkmcnt(3)
  v_mfma_f32_32x32x16_bf16 v[64:79], v[16:19], v[120:123], 0
  v_mfma_f32_32x32x16_bf16 v[80:95], v[16:19], v[184:187], 0
  ds_read_b128 v[16:19], v12 offset:49152
  s_waitcnt lgkmcnt(3)
  v_mfma_f32_32x32x16_bf16 v[64:79], v[20:23], v[124:127], v[64:79]
  v_mul_f32 v32, s52, v32
  v_mul_f32 v33, s52, v33
  v_cvt_pk_bf16_f32 v32, v32, v33
  v_mfma_f32_32x32x16_bf16 v[80:95], v[20:23], v[188:191], v[80:95]
  v_mul_f32 v34, s52, v34
  v_mul_f32 v35, s52, v35
  ds_read_b128 v[20:23], v13 offset:49152
  s_waitcnt lgkmcnt(3)
  v_mfma_f32_32x32x16_bf16 v[64:79], v[24:27], v[128:131], v[64:79]
  v_cvt_pk_bf16_f32 v33, v34, v35
  v_mul_f32 v36, s52, v36
  v_mul_f32 v37, s52, v37
  v_mfma_f32_32x32x16_bf16 v[80:95], v[24:27], v[192:195], v[80:95]
  v_cvt_pk_bf16_f32 v34, v36, v37
  v_mul_f32 v38, s52, v38
  ds_read_b128 v[24:27], v14 offset:49152
  s_waitcnt lgkmcnt(3)
  v_mfma_f32_32x32x16_bf16 v[64:79], v[28:31], v[132:135], v[64:79]
  v_mul_f32 v39, s52, v39
  v_cvt_pk_bf16_f32 v35, v38, v39
  v_mul_f32 v40, s52, v40
  v_mfma_f32_32x32x16_bf16 v[80:95], v[28:31], v[196:199], v[80:95]
  v_mul_f32 v41, s52, v41
  v_cvt_pk_bf16_f32 v40, v40, v41
  ds_read_b128 v[28:31], v15 offset:49152
  s_waitcnt lgkmcnt(3)
  v_mfma_f32_32x32x16_bf16 v[64:79], v[16:19], v[136:139], v[64:79]
  v_mul_f32 v42, s52, v42
  v_mul_f32 v43, s52, v43
  v_cvt_pk_bf16_f32 v41, v42, v43
  v_mfma_f32_32x32x16_bf16 v[80:95], v[16:19], v[200:203], v[80:95]
  v_mul_f32 v44, s52, v44
  v_mul_f32 v45, s52, v45
  ds_read_b128 v[16:19], v8 offset:49408
  s_waitcnt lgkmcnt(3)
  v_mfma_f32_32x32x16_bf16 v[64:79], v[20:23], v[140:143], v[64:79]
  v_cvt_pk_bf16_f32 v42, v44, v45
  v_mul_f32 v46, s52, v46
  v_mul_f32 v47, s52, v47
  v_mfma_f32_32x32x16_bf16 v[80:95], v[20:23], v[204:207], v[80:95]
  v_cvt_pk_bf16_f32 v43, v46, v47
  v_permlane16_swap_b32 v32, v40
  ds_read_b128 v[20:23], v9 offset:49408
  s_waitcnt lgkmcnt(3)
  v_mfma_f32_32x32x16_bf16 v[64:79], v[24:27], v[144:147], v[64:79]
  v_permlane16_swap_b32 v33, v41
  v_permlane16_swap_b32 v34, v42
  v_permlane16_swap_b32 v35, v43
  v_mfma_f32_32x32x16_bf16 v[80:95], v[24:27], v[208:211], v[80:95]
  v_accvgpr_write_b32 a24, v32
  v_accvgpr_write_b32 a25, v33
  ds_read_b128 v[24:27], v10 offset:49408
  s_waitcnt lgkmcnt(3)
  v_mfma_f32_32x32x16_bf16 v[64:79], v[28:31], v[148:151], v[64:79]
  v_accvgpr_write_b32 a26, v34
  v_accvgpr_write_b32 a27, v35
  v_accvgpr_write_b32 a80, v40
  v_mfma_f32_32x32x16_bf16 v[80:95], v[28:31], v[212:215], v[80:95]
  v_accvgpr_write_b32 a81, v41
  v_accvgpr_write_b32 a82, v42
  ds_read_b128 v[28:31], v11 offset:49408
  s_waitcnt lgkmcnt(3)
  v_mfma_f32_32x32x16_bf16 v[64:79], v[16:19], v[152:155], v[64:79]
  v_accvgpr_write_b32 a83, v43
  v_mul_f32 v48, s52, v48
  v_mul_f32 v49, s52, v49
  v_mfma_f32_32x32x16_bf16 v[80:95], v[16:19], v[216:219], v[80:95]
  v_cvt_pk_bf16_f32 v48, v48, v49
  v_mul_f32 v50, s52, v50
  ds_read_b128 v[16:19], v12 offset:49408
  s_waitcnt lgkmcnt(3)
  v_mfma_f32_32x32x16_bf16 v[64:79], v[20:23], v[156:159], v[64:79]
  v_mul_f32 v51, s52, v51
  v_cvt_pk_bf16_f32 v49, v50, v51
  v_mul_f32 v52, s52, v52
  v_mfma_f32_32x32x16_bf16 v[80:95], v[20:23], v[220:223], v[80:95]
  v_mul_f32 v53, s52, v53
  v_cvt_pk_bf16_f32 v50, v52, v53
  ds_read_b128 v[20:23], v13 offset:49408
  s_waitcnt lgkmcnt(3)
  v_mfma_f32_32x32x16_bf16 v[64:79], v[24:27], v[160:163], v[64:79]
  v_mul_f32 v54, s52, v54
  v_mul_f32 v55, s52, v55
  v_cvt_pk_bf16_f32 v51, v54, v55
  v_mfma_f32_32x32x16_bf16 v[80:95], v[24:27], v[224:227], v[80:95]
  v_mul_f32 v56, s52, v56
  v_mul_f32 v57, s52, v57
  ds_read_b128 v[24:27], v14 offset:49408
  s_waitcnt lgkmcnt(3)
  v_mfma_f32_32x32x16_bf16 v[64:79], v[28:31], v[164:167], v[64:79]
  v_cvt_pk_bf16_f32 v56, v56, v57
  v_mul_f32 v58, s52, v58
  v_mul_f32 v59, s52, v59
  v_mfma_f32_32x32x16_bf16 v[80:95], v[28:31], v[228:231], v[80:95]
  v_cvt_pk_bf16_f32 v57, v58, v59
  v_mul_f32 v60, s52, v60
  ds_read_b128 v[28:31], v15 offset:49408
  s_waitcnt lgkmcnt(3)
  v_mfma_f32_32x32x16_bf16 v[64:79], v[16:19], v[168:171], v[64:79]
  v_mul_f32 v61, s52, v61
  v_cvt_pk_bf16_f32 v58, v60, v61
  v_mul_f32 v62, s52, v62
  v_mfma_f32_32x32x16_bf16 v[80:95], v[16:19], v[232:235], v[80:95]
  v_mul_f32 v63, s52, v63
  v_cvt_pk_bf16_f32 v59, v62, v63
  v_xor_b32 v8, 196608, v8
  ds_read_b128 v[16:19], v8 offset:0
  s_waitcnt lgkmcnt(3)
  v_mfma_f32_32x32x16_bf16 v[64:79], v[20:23], v[172:175], v[64:79]
  v_permlane16_swap_b32 v48, v56
  v_permlane16_swap_b32 v49, v57
  v_permlane16_swap_b32 v50, v58
  v_mfma_f32_32x32x16_bf16 v[80:95], v[20:23], v[236:239], v[80:95]
  v_permlane16_swap_b32 v51, v59
  v_accvgpr_write_b32 a136, v48
  v_xor_b32 v9, 196608, v9
  ds_read_b128 v[20:23], v9 offset:0
  s_waitcnt lgkmcnt(3)
  v_mfma_f32_32x32x16_bf16 v[64:79], v[24:27], v[176:179], v[64:79]
  v_accvgpr_write_b32 a137, v49
  v_accvgpr_write_b32 a138, v50
  v_accvgpr_write_b32 a139, v51
  v_mfma_f32_32x32x16_bf16 v[80:95], v[24:27], v[240:243], v[80:95]
  v_accvgpr_write_b32 a192, v56
  v_accvgpr_write_b32 a193, v57
  v_xor_b32 v10, 196608, v10
  ds_read_b128 v[24:27], v10 offset:0
  s_waitcnt lgkmcnt(3)
  v_mfma_f32_32x32x16_bf16 v[64:79], v[28:31], v[180:183], v[64:79]
  v_accvgpr_write_b32 a194, v58
  v_accvgpr_write_b32 a195, v59
  v_mfma_f32_32x32x16_bf16 v[80:95], v[28:31], v[244:247], v[80:95]
  v_xor_b32 v11, 196608, v11
  ds_read_b128 v[28:31], v11 offset:0
  s_waitcnt lgkmcnt(3)
  v_mfma_f32_32x32x16_bf16 v[32:47], v[16:19], v[120:123], 0
  v_mfma_f32_32x32x16_bf16 v[48:63], v[16:19], v[184:187], 0
  v_xor_b32 v12, 196608, v12
  ds_read_b128 v[16:19], v12 offset:0
  s_waitcnt lgkmcnt(3)
  v_mfma_f32_32x32x16_bf16 v[32:47], v[20:23], v[124:127], v[32:47]
  v_mul_f32 v64, s52, v64
  v_mul_f32 v65, s52, v65
  v_cvt_pk_bf16_f32 v64, v64, v65
  v_mfma_f32_32x32x16_bf16 v[48:63], v[20:23], v[188:191], v[48:63]
  v_mul_f32 v66, s52, v66
  v_mul_f32 v67, s52, v67
  v_xor_b32 v13, 196608, v13
  ds_read_b128 v[20:23], v13 offset:0
  s_waitcnt lgkmcnt(3)
  v_mfma_f32_32x32x16_bf16 v[32:47], v[24:27], v[128:131], v[32:47]
  v_cvt_pk_bf16_f32 v65, v66, v67
  v_mul_f32 v68, s52, v68
  v_mul_f32 v69, s52, v69
  v_mfma_f32_32x32x16_bf16 v[48:63], v[24:27], v[192:195], v[48:63]
  v_cvt_pk_bf16_f32 v66, v68, v69
  v_mul_f32 v70, s52, v70
  v_xor_b32 v14, 196608, v14
  ds_read_b128 v[24:27], v14 offset:0
  s_waitcnt lgkmcnt(3)
  v_mfma_f32_32x32x16_bf16 v[32:47], v[28:31], v[132:135], v[32:47]
  v_mul_f32 v71, s52, v71
  v_cvt_pk_bf16_f32 v67, v70, v71
  v_mul_f32 v72, s52, v72
  v_mfma_f32_32x32x16_bf16 v[48:63], v[28:31], v[196:199], v[48:63]
  v_mul_f32 v73, s52, v73
  v_cvt_pk_bf16_f32 v72, v72, v73
  v_xor_b32 v15, 196608, v15
  ds_read_b128 v[28:31], v15 offset:0
  s_waitcnt lgkmcnt(3)
  v_mfma_f32_32x32x16_bf16 v[32:47], v[16:19], v[136:139], v[32:47]
  v_mul_f32 v74, s52, v74
  v_mul_f32 v75, s52, v75
  v_cvt_pk_bf16_f32 v73, v74, v75
  v_mfma_f32_32x32x16_bf16 v[48:63], v[16:19], v[200:203], v[48:63]
  v_mul_f32 v76, s52, v76
  v_mul_f32 v77, s52, v77
  ds_read_b128 v[16:19], v8 offset:256
  s_waitcnt lgkmcnt(3)
  v_mfma_f32_32x32x16_bf16 v[32:47], v[20:23], v[140:143], v[32:47]
  v_cvt_pk_bf16_f32 v74, v76, v77
  v_mul_f32 v78, s52, v78
  v_mul_f32 v79, s52, v79
  v_mfma_f32_32x32x16_bf16 v[48:63], v[20:23], v[204:207], v[48:63]
  v_cvt_pk_bf16_f32 v75, v78, v79
  v_permlane16_swap_b32 v64, v72
  ds_read_b128 v[20:23], v9 offset:256
  s_waitcnt lgkmcnt(3)
  v_mfma_f32_32x32x16_bf16 v[32:47], v[24:27], v[144:147], v[32:47]
  v_permlane16_swap_b32 v65, v73
  v_permlane16_swap_b32 v66, v74
  v_permlane16_swap_b32 v67, v75
  v_mfma_f32_32x32x16_bf16 v[48:63], v[24:27], v[208:211], v[48:63]
  v_accvgpr_write_b32 a28, v64
  v_accvgpr_write_b32 a29, v65
  ds_read_b128 v[24:27], v10 offset:256
  s_waitcnt lgkmcnt(3)
  v_mfma_f32_32x32x16_bf16 v[32:47], v[28:31], v[148:151], v[32:47]
  v_accvgpr_write_b32 a30, v66
  v_accvgpr_write_b32 a31, v67
  v_accvgpr_write_b32 a84, v72
  v_mfma_f32_32x32x16_bf16 v[48:63], v[28:31], v[212:215], v[48:63]
  v_accvgpr_write_b32 a85, v73
  v_accvgpr_write_b32 a86, v74
  ds_read_b128 v[28:31], v11 offset:256
  s_waitcnt lgkmcnt(3)
  v_mfma_f32_32x32x16_bf16 v[32:47], v[16:19], v[152:155], v[32:47]
  v_accvgpr_write_b32 a87, v75
  v_mul_f32 v80, s52, v80
  v_mul_f32 v81, s52, v81
  v_mfma_f32_32x32x16_bf16 v[48:63], v[16:19], v[216:219], v[48:63]
  v_cvt_pk_bf16_f32 v80, v80, v81
  v_mul_f32 v82, s52, v82
  ds_read_b128 v[16:19], v12 offset:256
  s_waitcnt lgkmcnt(3)
  v_mfma_f32_32x32x16_bf16 v[32:47], v[20:23], v[156:159], v[32:47]
  v_mul_f32 v83, s52, v83
  v_cvt_pk_bf16_f32 v81, v82, v83
  v_mul_f32 v84, s52, v84
  v_mfma_f32_32x32x16_bf16 v[48:63], v[20:23], v[220:223], v[48:63]
  v_mul_f32 v85, s52, v85
  v_cvt_pk_bf16_f32 v82, v84, v85
  ds_read_b128 v[20:23], v13 offset:256
  s_waitcnt lgkmcnt(3)
  v_mfma_f32_32x32x16_bf16 v[32:47], v[24:27], v[160:163], v[32:47]
  v_mul_f32 v86, s52, v86
  v_mul_f32 v87, s52, v87
  v_cvt_pk_bf16_f32 v83, v86, v87
  v_mfma_f32_32x32x16_bf16 v[48:63], v[24:27], v[224:227], v[48:63]
  v_mul_f32 v88, s52, v88
  v_mul_f32 v89, s52, v89
  ds_read_b128 v[24:27], v14 offset:256
  s_waitcnt lgkmcnt(3)
  v_mfma_f32_32x32x16_bf16 v[32:47], v[28:31], v[164:167], v[32:47]
  v_cvt_pk_bf16_f32 v88, v88, v89
  v_mul_f32 v90, s52, v90
  v_mul_f32 v91, s52, v91
  v_mfma_f32_32x32x16_bf16 v[48:63], v[28:31], v[228:231], v[48:63]
  v_cvt_pk_bf16_f32 v89, v90, v91
  v_mul_f32 v92, s52, v92
  ds_read_b128 v[28:31], v15 offset:256
  s_waitcnt lgkmcnt(3)
  v_mfma_f32_32x32x16_bf16 v[32:47], v[16:19], v[168:171], v[32:47]
  v_mul_f32 v93, s52, v93
  v_cvt_pk_bf16_f32 v90, v92, v93
  v_mul_f32 v94, s52, v94
  v_mfma_f32_32x32x16_bf16 v[48:63], v[16:19], v[232:235], v[48:63]
  v_mul_f32 v95, s52, v95
  v_cvt_pk_bf16_f32 v91, v94, v95
  v_xor_b32 v8, 131072, v8
  ds_read_b128 v[16:19], v8 offset:0
  s_waitcnt lgkmcnt(3)
  v_mfma_f32_32x32x16_bf16 v[32:47], v[20:23], v[172:175], v[32:47]
  v_permlane16_swap_b32 v80, v88
  v_permlane16_swap_b32 v81, v89
  v_permlane16_swap_b32 v82, v90
  v_mfma_f32_32x32x16_bf16 v[48:63], v[20:23], v[236:239], v[48:63]
  v_permlane16_swap_b32 v83, v91
  v_accvgpr_write_b32 a140, v80
  v_xor_b32 v9, 131072, v9
  ds_read_b128 v[20:23], v9 offset:0
  s_waitcnt lgkmcnt(3)
  v_mfma_f32_32x32x16_bf16 v[32:47], v[24:27], v[176:179], v[32:47]
  v_accvgpr_write_b32 a141, v81
  v_accvgpr_write_b32 a142, v82
  v_accvgpr_write_b32 a143, v83
  v_mfma_f32_32x32x16_bf16 v[48:63], v[24:27], v[240:243], v[48:63]
  v_accvgpr_write_b32 a196, v88
  v_accvgpr_write_b32 a197, v89
  v_xor_b32 v10, 131072, v10
  ds_read_b128 v[24:27], v10 offset:0
  s_waitcnt lgkmcnt(3)
  v_mfma_f32_32x32x16_bf16 v[32:47], v[28:31], v[180:183], v[32:47]
  v_accvgpr_write_b32 a198, v90
  v_accvgpr_write_b32 a199, v91
  v_mfma_f32_32x32x16_bf16 v[48:63], v[28:31], v[244:247], v[48:63]
  s_waitcnt vmcnt(8)
  s_barrier
  v_xor_b32 v11, 131072, v11
  ds_read_b128 v[28:31], v11 offset:0
  s_waitcnt lgkmcnt(3)
  v_mfma_f32_32x32x16_bf16 v[64:79], v[16:19], v[120:123], 0
  v_mfma_f32_32x32x16_bf16 v[80:95], v[16:19], v[184:187], 0
  v_xor_b32 v12, 131072, v12
  ds_read_b128 v[16:19], v12 offset:0
  s_waitcnt lgkmcnt(3)
  v_mfma_f32_32x32x16_bf16 v[64:79], v[20:23], v[124:127], v[64:79]
  v_mul_f32 v32, s52, v32
  v_mul_f32 v33, s52, v33
  v_cvt_pk_bf16_f32 v32, v32, v33
  v_mfma_f32_32x32x16_bf16 v[80:95], v[20:23], v[188:191], v[80:95]
  v_mul_f32 v34, s52, v34
  v_mul_f32 v35, s52, v35
  v_xor_b32 v13, 131072, v13
  ds_read_b128 v[20:23], v13 offset:0
  s_waitcnt lgkmcnt(3)
  v_mfma_f32_32x32x16_bf16 v[64:79], v[24:27], v[128:131], v[64:79]
  v_cvt_pk_bf16_f32 v33, v34, v35
  v_mul_f32 v36, s52, v36
  v_mul_f32 v37, s52, v37
  v_mfma_f32_32x32x16_bf16 v[80:95], v[24:27], v[192:195], v[80:95]
  v_cvt_pk_bf16_f32 v34, v36, v37
  v_mul_f32 v38, s52, v38
  v_xor_b32 v14, 131072, v14
  ds_read_b128 v[24:27], v14 offset:0
  s_waitcnt lgkmcnt(3)
  v_mfma_f32_32x32x16_bf16 v[64:79], v[28:31], v[132:135], v[64:79]
  v_mul_f32 v39, s52, v39
  v_cvt_pk_bf16_f32 v35, v38, v39
  v_mul_f32 v40, s52, v40
  v_mfma_f32_32x32x16_bf16 v[80:95], v[28:31], v[196:199], v[80:95]
  v_mul_f32 v41, s52, v41
  v_cvt_pk_bf16_f32 v40, v40, v41
  v_xor_b32 v15, 131072, v15
  ds_read_b128 v[28:31], v15 offset:0
  s_waitcnt lgkmcnt(3)
  v_mfma_f32_32x32x16_bf16 v[64:79], v[16:19], v[136:139], v[64:79]
  v_mul_f32 v42, s52, v42
  v_mul_f32 v43, s52, v43
  v_cvt_pk_bf16_f32 v41, v42, v43
  v_mfma_f32_32x32x16_bf16 v[80:95], v[16:19], v[200:203], v[80:95]
  v_mul_f32 v44, s52, v44
  v_mul_f32 v45, s52, v45
  ds_read_b128 v[16:19], v8 offset:256
  s_waitcnt lgkmcnt(3)
  v_mfma_f32_32x32x16_bf16 v[64:79], v[20:23], v[140:143], v[64:79]
  v_cvt_pk_bf16_f32 v42, v44, v45
  v_mul_f32 v46, s52, v46
  v_mul_f32 v47, s52, v47
  v_mfma_f32_32x32x16_bf16 v[80:95], v[20:23], v[204:207], v[80:95]
  v_cvt_pk_bf16_f32 v43, v46, v47
  v_permlane16_swap_b32 v32, v40
  ds_read_b128 v[20:23], v9 offset:256
  s_waitcnt lgkmcnt(3)
  v_mfma_f32_32x32x16_bf16 v[64:79], v[24:27], v[144:147], v[64:79]
  v_permlane16_swap_b32 v33, v41
  v_permlane16_swap_b32 v34, v42
  v_permlane16_swap_b32 v35, v43
  v_mfma_f32_32x32x16_bf16 v[80:95], v[24:27], v[208:211], v[80:95]
  v_accvgpr_write_b32 a32, v32
  v_accvgpr_write_b32 a33, v33
  ds_read_b128 v[24:27], v10 offset:256
  s_waitcnt lgkmcnt(3)
  v_mfma_f32_32x32x16_bf16 v[64:79], v[28:31], v[148:151], v[64:79]
  v_accvgpr_write_b32 a34, v34
  v_accvgpr_write_b32 a35, v35
  v_accvgpr_write_b32 a88, v40
  v_mfma_f32_32x32x16_bf16 v[80:95], v[28:31], v[212:215], v[80:95]
  v_accvgpr_write_b32 a89, v41
  v_accvgpr_write_b32 a90, v42
  ds_read_b128 v[28:31], v11 offset:256
  s_waitcnt lgkmcnt(3)
  v_mfma_f32_32x32x16_bf16 v[64:79], v[16:19], v[152:155], v[64:79]
  v_accvgpr_write_b32 a91, v43
  v_mul_f32 v48, s52, v48
  v_mul_f32 v49, s52, v49
  v_mfma_f32_32x32x16_bf16 v[80:95], v[16:19], v[216:219], v[80:95]
  v_cvt_pk_bf16_f32 v48, v48, v49
  v_mul_f32 v50, s52, v50
  ds_read_b128 v[16:19], v12 offset:256
  s_waitcnt lgkmcnt(3)
  v_mfma_f32_32x32x16_bf16 v[64:79], v[20:23], v[156:159], v[64:79]
  v_mul_f32 v51, s52, v51
  v_cvt_pk_bf16_f32 v49, v50, v51
  v_mul_f32 v52, s52, v52
  v_mfma_f32_32x32x16_bf16 v[80:95], v[20:23], v[220:223], v[80:95]
  v_mul_f32 v53, s52, v53
  v_cvt_pk_bf16_f32 v50, v52, v53
  ds_read_b128 v[20:23], v13 offset:256
  s_waitcnt lgkmcnt(3)
  v_mfma_f32_32x32x16_bf16 v[64:79], v[24:27], v[160:163], v[64:79]
  v_mul_f32 v54, s52, v54
  v_mul_f32 v55, s52, v55
  v_cvt_pk_bf16_f32 v51, v54, v55
  v_mfma_f32_32x32x16_bf16 v[80:95], v[24:27], v[224:227], v[80:95]
  v_mul_f32 v56, s52, v56
  v_mul_f32 v57, s52, v57
  ds_read_b128 v[24:27], v14 offset:256
  s_waitcnt lgkmcnt(3)
  v_mfma_f32_32x32x16_bf16 v[64:79], v[28:31], v[164:167], v[64:79]
  v_cvt_pk_bf16_f32 v56, v56, v57
  v_mul_f32 v58, s52, v58
  v_mul_f32 v59, s52, v59
  v_mfma_f32_32x32x16_bf16 v[80:95], v[28:31], v[228:231], v[80:95]
  v_cvt_pk_bf16_f32 v57, v58, v59
  v_mul_f32 v60, s52, v60
  ds_read_b128 v[28:31], v15 offset:256
  s_waitcnt lgkmcnt(3)
  v_mfma_f32_32x32x16_bf16 v[64:79], v[16:19], v[168:171], v[64:79]
  v_mul_f32 v61, s52, v61
  v_cvt_pk_bf16_f32 v58, v60, v61
  v_mul_f32 v62, s52, v62
  v_mfma_f32_32x32x16_bf16 v[80:95], v[16:19], v[232:235], v[80:95]
  v_mul_f32 v63, s52, v63
  v_cvt_pk_bf16_f32 v59, v62, v63
  ds_read_b128 v[16:19], v8 offset:16384
  s_waitcnt lgkmcnt(3)
  v_mfma_f32_32x32x16_bf16 v[64:79], v[20:23], v[172:175], v[64:79]
  v_permlane16_swap_b32 v48, v56
  v_permlane16_swap_b32 v49, v57
  v_permlane16_swap_b32 v50, v58
  v_mfma_f32_32x32x16_bf16 v[80:95], v[20:23], v[236:239], v[80:95]
  v_permlane16_swap_b32 v51, v59
  v_accvgpr_write_b32 a144, v48
  ds_read_b128 v[20:23], v9 offset:16384
  s_waitcnt lgkmcnt(3)
  v_mfma_f32_32x32x16_bf16 v[64:79], v[24:27], v[176:179], v[64:79]
  v_accvgpr_write_b32 a145, v49
  v_accvgpr_write_b32 a146, v50
  v_accvgpr_write_b32 a147, v51
  v_mfma_f32_32x32x16_bf16 v[80:95], v[24:27], v[240:243], v[80:95]
  v_accvgpr_write_b32 a200, v56
  v_accvgpr_write_b32 a201, v57
  ds_read_b128 v[24:27], v10 offset:16384
  s_waitcnt lgkmcnt(3)
  v_mfma_f32_32x32x16_bf16 v[64:79], v[28:31], v[180:183], v[64:79]
  v_accvgpr_write_b32 a202, v58
  v_accvgpr_write_b32 a203, v59
  v_mfma_f32_32x32x16_bf16 v[80:95], v[28:31], v[244:247], v[80:95]
  ds_read_b128 v[28:31], v11 offset:16384
  s_waitcnt lgkmcnt(3)
  v_mfma_f32_32x32x16_bf16 v[32:47], v[16:19], v[120:123], 0
  v_mfma_f32_32x32x16_bf16 v[48:63], v[16:19], v[184:187], 0
  ds_read_b128 v[16:19], v12 offset:16384
  s_waitcnt lgkmcnt(3)
  v_mfma_f32_32x32x16_bf16 v[32:47], v[20:23], v[124:127], v[32:47]
  v_mul_f32 v64, s52, v64
  v_mul_f32 v65, s52, v65
  v_cvt_pk_bf16_f32 v64, v64, v65
  v_mfma_f32_32x32x16_bf16 v[48:63], v[20:23], v[188:191], v[48:63]
  v_mul_f32 v66, s52, v66
  v_mul_f32 v67, s52, v67
  ds_read_b128 v[20:23], v13 offset:16384
  s_waitcnt lgkmcnt(3)
  v_mfma_f32_32x32x16_bf16 v[32:47], v[24:27], v[128:131], v[32:47]
  v_cvt_pk_bf16_f32 v65, v66, v67
  v_mul_f32 v68, s52, v68
  v_mul_f32 v69, s52, v69
  v_mfma_f32_32x32x16_bf16 v[48:63], v[24:27], v[192:195], v[48:63]
  v_cvt_pk_bf16_f32 v66, v68, v69
  v_mul_f32 v70, s52, v70
  ds_read_b128 v[24:27], v14 offset:16384
  s_waitcnt lgkmcnt(3)
  v_mfma_f32_32x32x16_bf16 v[32:47], v[28:31], v[132:135], v[32:47]
  v_mul_f32 v71, s52, v71
  v_cvt_pk_bf16_f32 v67, v70, v71
  v_mul_f32 v72, s52, v72
  v_mfma_f32_32x32x16_bf16 v[48:63], v[28:31], v[196:199], v[48:63]
  v_mul_f32 v73, s52, v73
  v_cvt_pk_bf16_f32 v72, v72, v73
  ds_read_b128 v[28:31], v15 offset:16384
  s_waitcnt lgkmcnt(3)
  v_mfma_f32_32x32x16_bf16 v[32:47], v[16:19], v[136:139], v[32:47]
  buffer_load_dwordx4 v[100:103], v113, s[8:11], s28 offen sc1
  v_mul_f32 v74, s52, v74
  v_mul_f32 v75, s52, v75
  v_cvt_pk_bf16_f32 v73, v74, v75
  v_mfma_f32_32x32x16_bf16 v[48:63], v[16:19], v[200:203], v[48:63]
  v_mul_f32 v76, s52, v76
  v_mul_f32 v77, s52, v77
  ds_read_b128 v[16:19], v8 offset:16640
  s_waitcnt lgkmcnt(3)
  v_mfma_f32_32x32x16_bf16 v[32:47], v[20:23], v[140:143], v[32:47]
  v_cvt_pk_bf16_f32 v74, v76, v77
  v_mul_f32 v78, s52, v78
  v_mul_f32 v79, s52, v79
  v_mfma_f32_32x32x16_bf16 v[48:63], v[20:23], v[204:207], v[48:63]
  v_cvt_pk_bf16_f32 v75, v78, v79
  v_permlane16_swap_b32 v64, v72
  ds_read_b128 v[20:23], v9 offset:16640
  s_waitcnt lgkmcnt(3)
  v_mfma_f32_32x32x16_bf16 v[32:47], v[24:27], v[144:147], v[32:47]
  v_permlane16_swap_b32 v65, v73
  v_permlane16_swap_b32 v66, v74
  v_permlane16_swap_b32 v67, v75
  v_mfma_f32_32x32x16_bf16 v[48:63], v[24:27], v[208:211], v[48:63]
  v_accvgpr_write_b32 a36, v64
  v_accvgpr_write_b32 a37, v65
  ds_read_b128 v[24:27], v10 offset:16640
  s_waitcnt lgkmcnt(3)
  v_mfma_f32_32x32x16_bf16 v[32:47], v[28:31], v[148:151], v[32:47]
  v_accvgpr_write_b32 a38, v66
  v_accvgpr_write_b32 a39, v67
  v_accvgpr_write_b32 a92, v72
  v_mfma_f32_32x32x16_bf16 v[48:63], v[28:31], v[212:215], v[48:63]
  v_accvgpr_write_b32 a93, v73
  v_accvgpr_write_b32 a94, v74
  ds_read_b128 v[28:31], v11 offset:16640
  s_waitcnt lgkmcnt(3)
  v_mfma_f32_32x32x16_bf16 v[32:47], v[16:19], v[152:155], v[32:47]
  v_accvgpr_write_b32 a95, v75
  v_mul_f32 v80, s52, v80
  v_mul_f32 v81, s52, v81
  v_mfma_f32_32x32x16_bf16 v[48:63], v[16:19], v[216:219], v[48:63]
  v_cvt_pk_bf16_f32 v80, v80, v81
  v_mul_f32 v82, s52, v82
  ds_read_b128 v[16:19], v12 offset:16640
  s_waitcnt lgkmcnt(3)
  v_mfma_f32_32x32x16_bf16 v[32:47], v[20:23], v[156:159], v[32:47]
  v_mul_f32 v83, s52, v83
  v_cvt_pk_bf16_f32 v81, v82, v83
  v_mul_f32 v84, s52, v84
  v_mfma_f32_32x32x16_bf16 v[48:63], v[20:23], v[220:223], v[48:63]
  v_mul_f32 v85, s52, v85
  v_cvt_pk_bf16_f32 v82, v84, v85
  ds_read_b128 v[20:23], v13 offset:16640
  s_waitcnt lgkmcnt(3)
  v_mfma_f32_32x32x16_bf16 v[32:47], v[24:27], v[160:163], v[32:47]
  v_mul_f32 v86, s52, v86
  v_mul_f32 v87, s52, v87
  v_cvt_pk_bf16_f32 v83, v86, v87
  v_mfma_f32_32x32x16_bf16 v[48:63], v[24:27], v[224:227], v[48:63]
  v_mul_f32 v88, s52, v88
  v_mul_f32 v89, s52, v89
  ds_read_b128 v[24:27], v14 offset:16640
  s_waitcnt lgkmcnt(3)
  v_mfma_f32_32x32x16_bf16 v[32:47], v[28:31], v[164:167], v[32:47]
  v_cvt_pk_bf16_f32 v88, v88, v89
  v_mul_f32 v90, s52, v90
  v_mul_f32 v91, s52, v91
  v_mfma_f32_32x32x16_bf16 v[48:63], v[28:31], v[228:231], v[48:63]
  v_cvt_pk_bf16_f32 v89, v90, v91
  v_mul_f32 v92, s52, v92
  ds_read_b128 v[28:31], v15 offset:16640
  s_waitcnt lgkmcnt(3)
  v_mfma_f32_32x32x16_bf16 v[32:47], v[16:19], v[168:171], v[32:47]
  v_mul_f32 v93, s52, v93
  v_cvt_pk_bf16_f32 v90, v92, v93
  v_mul_f32 v94, s52, v94
  v_mfma_f32_32x32x16_bf16 v[48:63], v[16:19], v[232:235], v[48:63]
  v_mul_f32 v95, s52, v95
  v_cvt_pk_bf16_f32 v91, v94, v95
  ds_read_b128 v[16:19], v8 offset:32768
  s_waitcnt lgkmcnt(3)
  v_mfma_f32_32x32x16_bf16 v[32:47], v[20:23], v[172:175], v[32:47]
  v_permlane16_swap_b32 v80, v88
  v_permlane16_swap_b32 v81, v89
  v_permlane16_swap_b32 v82, v90
  v_mfma_f32_32x32x16_bf16 v[48:63], v[20:23], v[236:239], v[48:63]
  v_permlane16_swap_b32 v83, v91
  v_accvgpr_write_b32 a148, v80
  ds_read_b128 v[20:23], v9 offset:32768
  s_waitcnt lgkmcnt(3)
  v_mfma_f32_32x32x16_bf16 v[32:47], v[24:27], v[176:179], v[32:47]
  v_accvgpr_write_b32 a149, v81
  v_accvgpr_write_b32 a150, v82
  v_accvgpr_write_b32 a151, v83
  v_mfma_f32_32x32x16_bf16 v[48:63], v[24:27], v[240:243], v[48:63]
  v_accvgpr_write_b32 a204, v88
  v_accvgpr_write_b32 a205, v89
  ds_read_b128 v[24:27], v10 offset:32768
  s_waitcnt lgkmcnt(3)
  v_mfma_f32_32x32x16_bf16 v[32:47], v[28:31], v[180:183], v[32:47]
  v_accvgpr_write_b32 a206, v90
  v_accvgpr_write_b32 a207, v91
  v_mfma_f32_32x32x16_bf16 v[48:63], v[28:31], v[244:247], v[48:63]
  s_waitcnt vmcnt(1)
  s_barrier
  ds_read_b128 v[28:31], v11 offset:32768
  s_waitcnt lgkmcnt(3)
  v_mfma_f32_32x32x16_bf16 v[64:79], v[16:19], v[120:123], 0
  s_waitcnt vmcnt(0)
  v_cmp_ne_u64 vcc, s[88:89], v[100:101]
  v_cmp_ne_u64 s[54:55], s[88:89], v[102:103]
  s_add_u32 s48, s33, 14336
  v_mfma_f32_32x32x16_bf16 v[80:95], v[16:19], v[184:187], 0
  ds_read_b128 v[16:19], v12 offset:32768
  s_waitcnt lgkmcnt(3)
  v_mfma_f32_32x32x16_bf16 v[64:79], v[20:23], v[124:127], v[64:79]
  s_or_b64 vcc, vcc, s[54:55]
  s_cselect_b32 s48, 0x10000000, s48
  s_add_u32 s22, s48, 0
  s_add_u32 m0, s25, 0
  s_nop 0
  buffer_load_dwordx4 v2, s[8:11], s22 offen sc1 lds
  v_mul_f32 v32, s52, v32
  v_mul_f32 v33, s52, v33
  v_cvt_pk_bf16_f32 v32, v32, v33
  v_mfma_f32_32x32x16_bf16 v[80:95], v[20:23], v[188:191], v[80:95]
  v_mul_f32 v34, s52, v34
  v_mul_f32 v35, s52, v35
  ds_read_b128 v[20:23], v13 offset:32768
  s_waitcnt lgkmcnt(3)
  v_mfma_f32_32x32x16_bf16 v[64:79], v[24:27], v[128:131], v[64:79]
  s_add_u32 s22, s48, 1024
  s_add_u32 m0, s25, 1024
  s_nop 0
  buffer_load_dwordx4 v2, s[8:11], s22 offen sc1 lds
  v_cvt_pk_bf16_f32 v33, v34, v35
  v_mul_f32 v36, s52, v36
  v_mul_f32 v37, s52, v37
  v_mfma_f32_32x32x16_bf16 v[80:95], v[24:27], v[192:195], v[80:95]
  v_cvt_pk_bf16_f32 v34, v36, v37
  v_mul_f32 v38, s52, v38
  ds_read_b128 v[24:27], v14 offset:32768
  s_waitcnt lgkmcnt(3)
  v_mfma_f32_32x32x16_bf16 v[64:79], v[28:31], v[132:135], v[64:79]
  s_add_u32 s22, s48, 2048
  s_add_u32 m0, s25, 2048
  s_nop 0
  buffer_load_dwordx4 v2, s[8:11], s22 offen sc1 lds
  v_mul_f32 v39, s52, v39
  v_cvt_pk_bf16_f32 v35, v38, v39
  v_mul_f32 v40, s52, v40
  v_mfma_f32_32x32x16_bf16 v[80:95], v[28:31], v[196:199], v[80:95]
  v_mul_f32 v41, s52, v41
  v_cvt_pk_bf16_f32 v40, v40, v41
  ds_read_b128 v[28:31], v15 offset:32768
  s_waitcnt lgkmcnt(3)
  v_mfma_f32_32x32x16_bf16 v[64:79], v[16:19], v[136:139], v[64:79]
  s_add_u32 s22, s48, 3072
  s_add_u32 m0, s25, 3072
  s_nop 0
  buffer_load_dwordx4 v2, s[8:11], s22 offen sc1 lds
  v_mul_f32 v42, s52, v42
  v_mul_f32 v43, s52, v43
  v_cvt_pk_bf16_f32 v41, v42, v43
  v_mfma_f32_32x32x16_bf16 v[80:95], v[16:19], v[200:203], v[80:95]
  v_mul_f32 v44, s52, v44
  v_mul_f32 v45, s52, v45
  ds_read_b128 v[16:19], v8 offset:33024
  s_waitcnt lgkmcnt(3)
  v_mfma_f32_32x32x16_bf16 v[64:79], v[20:23], v[140:143], v[64:79]
  s_add_u32 s22, s48, 4096
  s_add_u32 m0, s25, 16384
  s_nop 0
  buffer_load_dwordx4 v2, s[8:11], s22 offen sc1 lds
  buffer_load_dwordx4 v[100:103], v113, s[8:11], s28 offen sc1
  v_cvt_pk_bf16_f32 v42, v44, v45
  v_mul_f32 v46, s52, v46
  v_mul_f32 v47, s52, v47
  v_mfma_f32_32x32x16_bf16 v[80:95], v[20:23], v[204:207], v[80:95]
  v_cvt_pk_bf16_f32 v43, v46, v47
  v_permlane16_swap_b32 v32, v40
  ds_read_b128 v[20:23], v9 offset:33024
  s_waitcnt lgkmcnt(3)
  v_mfma_f32_32x32x16_bf16 v[64:79], v[24:27], v[144:147], v[64:79]
  s_add_u32 s22, s48, 5120
  s_add_u32 m0, s25, 17408
  s_nop 0
  buffer_load_dwordx4 v2, s[8:11], s22 offen sc1 lds
  v_permlane16_swap_b32 v33, v41
  v_permlane16_swap_b32 v34, v42
  v_permlane16_swap_b32 v35, v43
  v_mfma_f32_32x32x16_bf16 v[80:95], v[24:27], v[208:211], v[80:95]
  v_accvgpr_write_b32 a40, v32
  v_accvgpr_write_b32 a41, v33
  ds_read_b128 v[24:27], v10 offset:33024
  s_waitcnt lgkmcnt(3)
  v_mfma_f32_32x32x16_bf16 v[64:79], v[28:31], v[148:151], v[64:79]
  s_add_u32 s22, s48, 6144
  s_add_u32 m0, s25, 18432
  s_nop 0
  buffer_load_dwordx4 v2, s[8:11], s22 offen sc1 lds
  v_accvgpr_write_b32 a42, v34
  v_accvgpr_write_b32 a43, v35
  v_accvgpr_write_b32 a96, v40
  v_mfma_f32_32x32x16_bf16 v[80:95], v[28:31], v[212:215], v[80:95]
  v_accvgpr_write_b32 a97, v41
  v_accvgpr_write_b32 a98, v42
  ds_read_b128 v[28:31], v11 offset:33024
  s_waitcnt lgkmcnt(3)
  v_mfma_f32_32x32x16_bf16 v[64:79], v[16:19], v[152:155], v[64:79]
  s_add_u32 s22, s48, 7168
  s_add_u32 m0, s25, 19456
  s_nop 0
  buffer_load_dwordx4 v2, s[8:11], s22 offen sc1 lds
  v_accvgpr_write_b32 a99, v43
  v_mul_f32 v48, s52, v48
  v_mul_f32 v49, s52, v49
  v_mfma_f32_32x32x16_bf16 v[80:95], v[16:19], v[216:219], v[80:95]
  v_cvt_pk_bf16_f32 v48, v48, v49
  v_mul_f32 v50, s52, v50
  ds_read_b128 v[16:19], v12 offset:33024
  s_waitcnt lgkmcnt(3)
  v_mfma_f32_32x32x16_bf16 v[64:79], v[20:23], v[156:159], v[64:79]
  s_add_u32 s22, s48, 8192
  s_add_u32 m0, s25, 81920
  s_nop 0
  buffer_load_dwordx4 v2, s[8:11], s22 offen sc1 lds
  v_mul_f32 v51, s52, v51
  v_cvt_pk_bf16_f32 v49, v50, v51
  v_mul_f32 v52, s52, v52
  v_mfma_f32_32x32x16_bf16 v[80:95], v[20:23], v[220:223], v[80:95]
  v_mul_f32 v53, s52, v53
  v_cvt_pk_bf16_f32 v50, v52, v53
  ds_read_b128 v[20:23], v13 offset:33024
  s_waitcnt lgkmcnt(3)
  v_mfma_f32_32x32x16_bf16 v[64:79], v[24:27], v[160:163], v[64:79]
  s_add_u32 s22, s48, 9216
  s_add_u32 m0, s25, 82944
  s_nop 0
  buffer_load_dwordx4 v2, s[8:11], s22 offen sc1 lds
  v_mul_f32 v54, s52, v54
  v_mul_f32 v55, s52, v55
  v_cvt_pk_bf16_f32 v51, v54, v55
  v_mfma_f32_32x32x16_bf16 v[80:95], v[24:27], v[224:227], v[80:95]
  v_mul_f32 v56, s52, v56
  v_mul_f32 v57, s52, v57
  ds_read_b128 v[24:27], v14 offset:33024
  s_waitcnt lgkmcnt(3)
  v_mfma_f32_32x32x16_bf16 v[64:79], v[28:31], v[164:167], v[64:79]
  s_add_u32 s22, s48, 10240
  s_add_u32 m0, s25, 83968
  s_nop 0
  buffer_load_dwordx4 v2, s[8:11], s22 offen sc1 lds
  v_cvt_pk_bf16_f32 v56, v56, v57
  v_mul_f32 v58, s52, v58
  v_mul_f32 v59, s52, v59
  v_mfma_f32_32x32x16_bf16 v[80:95], v[28:31], v[228:231], v[80:95]
  v_cvt_pk_bf16_f32 v57, v58, v59
  v_mul_f32 v60, s52, v60
  ds_read_b128 v[28:31], v15 offset:33024
  s_waitcnt lgkmcnt(3)
  v_mfma_f32_32x32x16_bf16 v[64:79], v[16:19], v[168:171], v[64:79]
  s_add_u32 s22, s48, 11264
  s_add_u32 m0, s25, 84992
  s_nop 0
  buffer_load_dwordx4 v2, s[8:11], s22 offen sc1 lds
  v_mul_f32 v61, s52, v61
  v_cvt_pk_bf16_f32 v58, v60, v61
  v_mul_f32 v62, s52, v62
  v_mfma_f32_32x32x16_bf16 v[80:95], v[16:19], v[232:235], v[80:95]
  v_mul_f32 v63, s52, v63
  v_cvt_pk_bf16_f32 v59, v62, v63
  ds_read_b128 v[16:19], v8 offset:49152
  s_waitcnt lgkmcnt(3)
  v_mfma_f32_32x32x16_bf16 v[64:79], v[20:23], v[172:175], v[64:79]
  s_add_u32 s22, s48, 12288
  s_add_u32 m0, s25, 98304
  s_nop 0
  buffer_load_dwordx4 v2, s[8:11], s22 offen sc1 lds
  v_permlane16_swap_b32 v48, v56
  v_permlane16_swap_b32 v49, v57
  v_permlane16_swap_b32 v50, v58
  v_mfma_f32_32x32x16_bf16 v[80:95], v[20:23], v[236:239], v[80:95]
  v_permlane16_swap_b32 v51, v59
  v_accvgpr_write_b32 a152, v48
  ds_read_b128 v[20:23], v9 offset:49152
  s_waitcnt lgkmcnt(3)
  v_mfma_f32_32x32x16_bf16 v[64:79], v[24:27], v[176:179], v[64:79]
  s_add_u32 s22, s48, 13312
  s_add_u32 m0, s25, 99328
  s_nop 0
  buffer_load_dwordx4 v2, s[8:11], s22 offen sc1 lds
  v_accvgpr_write_b32 a153, v49
  v_accvgpr_write_b32 a154, v50
  v_accvgpr_write_b32 a155, v51
  v_mfma_f32_32x32x16_bf16 v[80:95], v[24:27], v[240:243], v[80:95]
  v_accvgpr_write_b32 a208, v56
  v_accvgpr_write_b32 a209, v57
  ds_read_b128 v[24:27], v10 offset:49152
  s_waitcnt lgkmcnt(3)
  v_mfma_f32_32x32x16_bf16 v[64:79], v[28:31], v[180:183], v[64:79]
  v_accvgpr_write_b32 a210, v58
  v_accvgpr_write_b32 a211, v59
  v_mfma_f32_32x32x16_bf16 v[80:95], v[28:31], v[244:247], v[80:95]
  ds_read_b128 v[28:31], v11 offset:49152
  s_waitcnt lgkmcnt(3)
  v_mfma_f32_32x32x16_bf16 v[32:47], v[16:19], v[120:123], 0
  s_waitcnt vmcnt(9)
  v_cmp_ne_u64 vcc, s[88:89], v[100:101]
  v_cmp_ne_u64 s[54:55], s[88:89], v[102:103]
  s_add_u32 s49, s32, 0
  v_mfma_f32_32x32x16_bf16 v[48:63], v[16:19], v[184:187], 0
  ds_read_b128 v[16:19], v12 offset:49152
  s_waitcnt lgkmcnt(3)
  v_mfma_f32_32x32x16_bf16 v[32:47], v[20:23], v[124:127], v[32:47]
  s_or_b64 vcc, vcc, s[54:55]
  s_cselect_b32 s49, 0x10000000, s49
  s_add_u32 s22, s49, 0
  s_add_u32 m0, s25, 100352
  s_nop 0
  buffer_load_dwordx4 v2, s[8:11], s22 offen sc1 lds
  v_mul_f32 v64, s52, v64
  v_mul_f32 v65, s52, v65
  v_cvt_pk_bf16_f32 v64, v64, v65
  v_mfma_f32_32x32x16_bf16 v[48:63], v[20:23], v[188:191], v[48:63]
  v_mul_f32 v66, s52, v66
  v_mul_f32 v67, s52, v67
  ds_read_b128 v[20:23], v13 offset:49152
  s_waitcnt lgkmcnt(3)
  v_mfma_f32_32x32x16_bf16 v[32:47], v[24:27], v[128:131], v[32:47]
  s_add_u32 s22, s49, 1024
  s_add_u32 m0, s25, 101376
  s_nop 0
  buffer_load_dwordx4 v2, s[8:11], s22 offen sc1 lds
  v_cvt_pk_bf16_f32 v65, v66, v67
  v_mul_f32 v68, s52, v68
  v_mul_f32 v69, s52, v69
  v_mfma_f32_32x32x16_bf16 v[48:63], v[24:27], v[192:195], v[48:63]
  v_cvt_pk_bf16_f32 v66, v68, v69
  v_mul_f32 v70, s52, v70
  ds_read_b128 v[24:27], v14 offset:49152
  s_waitcnt lgkmcnt(3)
  v_mfma_f32_32x32x16_bf16 v[32:47], v[28:31], v[132:135], v[32:47]
  s_add_u32 s22, s49, 2048
  s_add_u32 m0, s25, 114688
  s_nop 0
  buffer_load_dwordx4 v2, s[8:11], s22 offen sc1 lds
  v_mul_f32 v71, s52, v71
  v_cvt_pk_bf16_f32 v67, v70, v71
  v_mul_f32 v72, s52, v72
  v_mfma_f32_32x32x16_bf16 v[48:63], v[28:31], v[196:199], v[48:63]
  v_mul_f32 v73, s52, v73
  v_cvt_pk_bf16_f32 v72, v72, v73
  ds_read_b128 v[28:31], v15 offset:49152
  s_waitcnt lgkmcnt(3)
  v_mfma_f32_32x32x16_bf16 v[32:47], v[16:19], v[136:139], v[32:47]
  s_add_u32 s22, s49, 3072
  s_add_u32 m0, s25, 115712
  s_nop 0
  buffer_load_dwordx4 v2, s[8:11], s22 offen sc1 lds
  v_mul_f32 v74, s52, v74
  v_mul_f32 v75, s52, v75
  v_cvt_pk_bf16_f32 v73, v74, v75
  v_mfma_f32_32x32x16_bf16 v[48:63], v[16:19], v[200:203], v[48:63]
  v_mul_f32 v76, s52, v76
  v_mul_f32 v77, s52, v77
  ds_read_b128 v[16:19], v8 offset:49408
  s_waitcnt lgkmcnt(3)
  v_mfma_f32_32x32x16_bf16 v[32:47], v[20:23], v[140:143], v[32:47]
  s_add_u32 s22, s49, 4096
  s_add_u32 m0, s25, 116736
  s_nop 0
  buffer_load_dwordx4 v2, s[8:11], s22 offen sc1 lds
  buffer_load_dwordx4 v[100:103], v113, s[8:11], s28 offen sc1
  v_cvt_pk_bf16_f32 v74, v76, v77
  v_mul_f32 v78, s52, v78
  v_mul_f32 v79, s52, v79
  v_mfma_f32_32x32x16_bf16 v[48:63], v[20:23], v[204:207], v[48:63]
  v_cvt_pk_bf16_f32 v75, v78, v79
  v_permlane16_swap_b32 v64, v72
  ds_read_b128 v[20:23], v9 offset:49408
  s_waitcnt lgkmcnt(3)
  v_mfma_f32_32x32x16_bf16 v[32:47], v[24:27], v[144:147], v[32:47]
  s_add_u32 s22, s49, 5120
  s_add_u32 m0, s25, 117760
  s_nop 0
  buffer_load_dwordx4 v2, s[8:11], s22 offen sc1 lds
  v_permlane16_swap_b32 v65, v73
  v_permlane16_swap_b32 v66, v74
  v_permlane16_swap_b32 v67, v75
  v_mfma_f32_32x32x16_bf16 v[48:63], v[24:27], v[208:211], v[48:63]
  v_accvgpr_write_b32 a44, v64
  v_accvgpr_write_b32 a45, v65
  ds_read_b128 v[24:27], v10 offset:49408
  s_waitcnt lgkmcnt(3)
  v_mfma_f32_32x32x16_bf16 v[32:47], v[28:31], v[148:151], v[32:47]
  s_add_u32 s22, s49, 6144
  s_add_u32 m0, s25, 131072
  s_nop 0
  buffer_load_dwordx4 v2, s[8:11], s22 offen sc1 lds
  v_accvgpr_write_b32 a46, v66
  v_accvgpr_write_b32 a47, v67
  v_accvgpr_write_b32 a100, v72
  v_mfma_f32_32x32x16_bf16 v[48:63], v[28:31], v[212:215], v[48:63]
  v_accvgpr_write_b32 a101, v73
  v_accvgpr_write_b32 a102, v74
  ds_read_b128 v[28:31], v11 offset:49408
  s_waitcnt lgkmcnt(3)
  v_mfma_f32_32x32x16_bf16 v[32:47], v[16:19], v[152:155], v[32:47]
  s_add_u32 s22, s49, 7168
  s_add_u32 m0, s25, 132096
  s_nop 0
  buffer_load_dwordx4 v2, s[8:11], s22 offen sc1 lds
  v_accvgpr_write_b32 a103, v75
  v_mul_f32 v80, s52, v80
  v_mul_f32 v81, s52, v81
  v_mfma_f32_32x32x16_bf16 v[48:63], v[16:19], v[216:219], v[48:63]
  v_cvt_pk_bf16_f32 v80, v80, v81
  v_mul_f32 v82, s52, v82
  ds_read_b128 v[16:19], v12 offset:49408
  s_waitcnt lgkmcnt(3)
  v_mfma_f32_32x32x16_bf16 v[32:47], v[20:23], v[156:159], v[32:47]
  s_add_u32 s22, s49, 8192
  s_add_u32 m0, s25, 133120
  s_nop 0
  buffer_load_dwordx4 v2, s[8:11], s22 offen sc1 lds
  v_mul_f32 v83, s52, v83
  v_cvt_pk_bf16_f32 v81, v82, v83
  v_mul_f32 v84, s52, v84
  v_mfma_f32_32x32x16_bf16 v[48:63], v[20:23], v[220:223], v[48:63]
  v_mul_f32 v85, s52, v85
  v_cvt_pk_bf16_f32 v82, v84, v85
  ds_read_b128 v[20:23], v13 offset:49408
  s_waitcnt lgkmcnt(3)
  v_mfma_f32_32x32x16_bf16 v[32:47], v[24:27], v[160:163], v[32:47]
  s_add_u32 s22, s49, 9216
  s_add_u32 m0, s25, 134144
  s_nop 0
  buffer_load_dwordx4 v2, s[8:11], s22 offen sc1 lds
  v_mul_f32 v86, s52, v86
  v_mul_f32 v87, s52, v87
  v_cvt_pk_bf16_f32 v83, v86, v87
  v_mfma_f32_32x32x16_bf16 v[48:63], v[24:27], v[224:227], v[48:63]
  v_mul_f32 v88, s52, v88
  v_mul_f32 v89, s52, v89
  ds_read_b128 v[24:27], v14 offset:49408
  s_waitcnt lgkmcnt(3)
  v_mfma_f32_32x32x16_bf16 v[32:47], v[28:31], v[164:167], v[32:47]
  s_add_u32 s22, s49, 10240
  s_add_u32 m0, s25, 147456
  s_nop 0
  buffer_load_dwordx4 v2, s[8:11], s22 offen sc1 lds
  v_cvt_pk_bf16_f32 v88, v88, v89
  v_mul_f32 v90, s52, v90
  v_mul_f32 v91, s52, v91
  v_mfma_f32_32x32x16_bf16 v[48:63], v[28:31], v[228:231], v[48:63]
  v_cvt_pk_bf16_f32 v89, v90, v91
  v_mul_f32 v92, s52, v92
  ds_read_b128 v[28:31], v15 offset:49408
  s_waitcnt lgkmcnt(3)
  v_mfma_f32_32x32x16_bf16 v[32:47], v[16:19], v[168:171], v[32:47]
  s_add_u32 s22, s49, 11264
  s_add_u32 m0, s25, 148480
  s_nop 0
  buffer_load_dwordx4 v2, s[8:11], s22 offen sc1 lds
  v_mul_f32 v93, s52, v93
  v_cvt_pk_bf16_f32 v90, v92, v93
  v_mul_f32 v94, s52, v94
  v_mfma_f32_32x32x16_bf16 v[48:63], v[16:19], v[232:235], v[48:63]
  v_mul_f32 v95, s52, v95
  v_cvt_pk_bf16_f32 v91, v94, v95
  v_xor_b32 v8, 65536, v8
  ds_read_b128 v[16:19], v8 offset:0
  s_waitcnt lgkmcnt(3)
  v_mfma_f32_32x32x16_bf16 v[32:47], v[20:23], v[172:175], v[32:47]
  s_add_u32 s22, s49, 12288
  s_add_u32 m0, s25, 149504
  s_nop 0
  buffer_load_dwordx4 v2, s[8:11], s22 offen sc1 lds
  v_permlane16_swap_b32 v80, v88
  v_permlane16_swap_b32 v81, v89
  v_permlane16_swap_b32 v82, v90
  v_mfma_f32_32x32x16_bf16 v[48:63], v[20:23], v[236:239], v[48:63]
  v_permlane16_swap_b32 v83, v91
  v_accvgpr_write_b32 a156, v80
  v_xor_b32 v9, 65536, v9
  ds_read_b128 v[20:23], v9 offset:0
  s_waitcnt lgkmcnt(3)
  v_mfma_f32_32x32x16_bf16 v[32:47], v[24:27], v[176:179], v[32:47]
  s_add_u32 s22, s49, 13312
  s_add_u32 m0, s25, 150528
  s_nop 0
  buffer_load_dwordx4 v2, s[8:11], s22 offen sc1 lds
  v_accvgpr_write_b32 a157, v81
  v_accvgpr_write_b32 a158, v82
  v_accvgpr_write_b32 a159, v83
  v_mfma_f32_32x32x16_bf16 v[48:63], v[24:27], v[240:243], v[48:63]
  v_accvgpr_write_b32 a212, v88
  v_accvgpr_write_b32 a213, v89
  v_xor_b32 v10, 65536, v10
  ds_read_b128 v[24:27], v10 offset:0
  s_waitcnt lgkmcnt(3)
  v_mfma_f32_32x32x16_bf16 v[32:47], v[28:31], v[180:183], v[32:47]
  v_accvgpr_write_b32 a214, v90
  v_accvgpr_write_b32 a215, v91
  v_mfma_f32_32x32x16_bf16 v[48:63], v[28:31], v[244:247], v[48:63]
  s_barrier
  v_xor_b32 v11, 65536, v11
  ds_read_b128 v[28:31], v11 offset:0
  s_waitcnt lgkmcnt(3)
  v_mfma_f32_32x32x16_bf16 v[64:79], v[16:19], v[120:123], 0
  s_waitcnt vmcnt(9)
  v_cmp_ne_u64 vcc, s[88:89], v[100:101]
  v_cmp_ne_u64 s[54:55], s[88:89], v[102:103]
  s_add_u32 s50, s33, 0
  v_mfma_f32_32x32x16_bf16 v[80:95], v[16:19], v[184:187], 0
  v_xor_b32 v12, 65536, v12
  ds_read_b128 v[16:19], v12 offset:0
  s_waitcnt lgkmcnt(3)
  v_mfma_f32_32x32x16_bf16 v[64:79], v[20:23], v[124:127], v[64:79]
  s_or_b64 vcc, vcc, s[54:55]
  s_cselect_b32 s50, 0x10000000, s50
  s_add_u32 s22, s50, 0
  buffer_load_dwordx4 a[224:227], v2, s[8:11], s22 offen sc1
  v_mul_f32 v32, s52, v32
  v_mul_f32 v33, s52, v33
  v_cvt_pk_bf16_f32 v32, v32, v33
  v_mfma_f32_32x32x16_bf16 v[80:95], v[20:23], v[188:191], v[80:95]
  v_mul_f32 v34, s52, v34
  v_mul_f32 v35, s52, v35
  v_xor_b32 v13, 65536, v13
  ds_read_b128 v[20:23], v13 offset:0
  s_waitcnt lgkmcnt(3)
  v_mfma_f32_32x32x16_bf16 v[64:79], v[24:27], v[128:131], v[64:79]
  s_add_u32 s22, s50, 1024
  buffer_load_dwordx4 a[228:231], v2, s[8:11], s22 offen sc1
  v_cvt_pk_bf16_f32 v33, v34, v35
  v_mul_f32 v36, s52, v36
  v_mul_f32 v37, s52, v37
  v_mfma_f32_32x32x16_bf16 v[80:95], v[24:27], v[192:195], v[80:95]
  v_cvt_pk_bf16_f32 v34, v36, v37
  v_mul_f32 v38, s52, v38
  v_xor_b32 v14, 65536, v14
  ds_read_b128 v[24:27], v14 offset:0
  s_waitcnt lgkmcnt(3)
  v_mfma_f32_32x32x16_bf16 v[64:79], v[28:31], v[132:135], v[64:79]
  s_add_u32 s22, s50, 2048
  buffer_load_dwordx4 a[232:235], v2, s[8:11], s22 offen sc1
  v_mul_f32 v39, s52, v39
  v_cvt_pk_bf16_f32 v35, v38, v39
  v_mul_f32 v40, s52, v40
  v_mfma_f32_32x32x16_bf16 v[80:95], v[28:31], v[196:199], v[80:95]
  v_mul_f32 v41, s52, v41
  v_cvt_pk_bf16_f32 v40, v40, v41
  v_xor_b32 v15, 65536, v15
  ds_read_b128 v[28:31], v15 offset:0
  s_waitcnt lgkmcnt(3)
  v_mfma_f32_32x32x16_bf16 v[64:79], v[16:19], v[136:139], v[64:79]
  s_add_u32 s22, s50, 3072
  buffer_load_dwordx4 a[236:239], v2, s[8:11], s22 offen sc1
  v_mul_f32 v42, s52, v42
  v_mul_f32 v43, s52, v43
  v_cvt_pk_bf16_f32 v41, v42, v43
  v_mfma_f32_32x32x16_bf16 v[80:95], v[16:19], v[200:203], v[80:95]
  v_mul_f32 v44, s52, v44
  v_mul_f32 v45, s52, v45
  ds_read_b128 v[16:19], v8 offset:256
  s_waitcnt lgkmcnt(3)
  v_mfma_f32_32x32x16_bf16 v[64:79], v[20:23], v[140:143], v[64:79]
  s_add_u32 s22, s50, 4096
  buffer_load_dwordx4 a[240:243], v2, s[8:11], s22 offen sc1
  v_cvt_pk_bf16_f32 v42, v44, v45
  v_mul_f32 v46, s52, v46
  v_mul_f32 v47, s52, v47
  v_mfma_f32_32x32x16_bf16 v[80:95], v[20:23], v[204:207], v[80:95]
  v_cvt_pk_bf16_f32 v43, v46, v47
  v_permlane16_swap_b32 v32, v40
  ds_read_b128 v[20:23], v9 offset:256
  s_waitcnt lgkmcnt(3)
  v_mfma_f32_32x32x16_bf16 v[64:79], v[24:27], v[144:147], v[64:79]
  s_add_u32 s22, s50, 5120
  buffer_load_dwordx4 a[244:247], v2, s[8:11], s22 offen sc1
  v_permlane16_swap_b32 v33, v41
  v_permlane16_swap_b32 v34, v42
  v_permlane16_swap_b32 v35, v43
  v_mfma_f32_32x32x16_bf16 v[80:95], v[24:27], v[208:211], v[80:95]
  v_accvgpr_write_b32 a48, v32
  v_accvgpr_write_b32 a49, v33
  ds_read_b128 v[24:27], v10 offset:256
  s_waitcnt lgkmcnt(3)
  v_mfma_f32_32x32x16_bf16 v[64:79], v[28:31], v[148:151], v[64:79]
  s_add_u32 s22, s50, 6144
  buffer_load_dwordx4 a[248:251], v2, s[8:11], s22 offen sc1
  v_accvgpr_write_b32 a50, v34
  v_accvgpr_write_b32 a51, v35
  v_accvgpr_write_b32 a104, v40
  v_mfma_f32_32x32x16_bf16 v[80:95], v[28:31], v[212:215], v[80:95]
  v_accvgpr_write_b32 a105, v41
  v_accvgpr_write_b32 a106, v42
  ds_read_b128 v[28:31], v11 offset:256
  s_waitcnt lgkmcnt(3)
  v_mfma_f32_32x32x16_bf16 v[64:79], v[16:19], v[152:155], v[64:79]
  s_add_u32 s22, s50, 7168
  buffer_load_dwordx4 a[252:255], v2, s[8:11], s22 offen sc1
  v_accvgpr_write_b32 a107, v43
  v_mul_f32 v48, s52, v48
  v_mul_f32 v49, s52, v49
  v_mfma_f32_32x32x16_bf16 v[80:95], v[16:19], v[216:219], v[80:95]
  v_cvt_pk_bf16_f32 v48, v48, v49
  v_mul_f32 v50, s52, v50
  ds_read_b128 v[16:19], v12 offset:256
  s_waitcnt lgkmcnt(3)
  v_mfma_f32_32x32x16_bf16 v[64:79], v[20:23], v[156:159], v[64:79]
  s_add_u32 s22, s50, 8192
  s_add_u32 m0, s25, 32768
  s_nop 0
  buffer_load_dwordx4 v2, s[8:11], s22 offen sc1 lds
  v_mul_f32 v51, s52, v51
  v_cvt_pk_bf16_f32 v49, v50, v51
  v_mul_f32 v52, s52, v52
  v_mfma_f32_32x32x16_bf16 v[80:95], v[20:23], v[220:223], v[80:95]
  v_mul_f32 v53, s52, v53
  v_cvt_pk_bf16_f32 v50, v52, v53
  ds_read_b128 v[20:23], v13 offset:256
  s_waitcnt lgkmcnt(3)
  v_mfma_f32_32x32x16_bf16 v[64:79], v[24:27], v[160:163], v[64:79]
  s_add_u32 s22, s50, 9216
  s_add_u32 m0, s25, 33792
  s_nop 0
  buffer_load_dwordx4 v2, s[8:11], s22 offen sc1 lds
  v_mul_f32 v54, s52, v54
  v_mul_f32 v55, s52, v55
  v_cvt_pk_bf16_f32 v51, v54, v55
  v_mfma_f32_32x32x16_bf16 v[80:95], v[24:27], v[224:227], v[80:95]
  v_mul_f32 v56, s52, v56
  v_mul_f32 v57, s52, v57
  ds_read_b128 v[24:27], v14 offset:256
  s_waitcnt lgkmcnt(3)
  v_mfma_f32_32x32x16_bf16 v[64:79], v[28:31], v[164:167], v[64:79]
  s_add_u32 s22, s50, 10240
  s_add_u32 m0, s25, 34816
  s_nop 0
  buffer_load_dwordx4 v2, s[8:11], s22 offen sc1 lds
  v_cvt_pk_bf16_f32 v56, v56, v57
  v_mul_f32 v58, s52, v58
  v_mul_f32 v59, s52, v59
  v_mfma_f32_32x32x16_bf16 v[80:95], v[28:31], v[228:231], v[80:95]
  v_cvt_pk_bf16_f32 v57, v58, v59
  v_mul_f32 v60, s52, v60
  ds_read_b128 v[28:31], v15 offset:256
  s_waitcnt lgkmcnt(3)
  v_mfma_f32_32x32x16_bf16 v[64:79], v[16:19], v[168:171], v[64:79]
  s_add_u32 s22, s50, 11264
  s_add_u32 m0, s25, 35840
  s_nop 0
  buffer_load_dwordx4 v2, s[8:11], s22 offen sc1 lds
  v_mul_f32 v61, s52, v61
  v_cvt_pk_bf16_f32 v58, v60, v61
  v_mul_f32 v62, s52, v62
  v_mfma_f32_32x32x16_bf16 v[80:95], v[16:19], v[232:235], v[80:95]
  v_mul_f32 v63, s52, v63
  v_cvt_pk_bf16_f32 v59, v62, v63
  s_waitcnt lgkmcnt(2)
  v_mfma_f32_32x32x16_bf16 v[64:79], v[20:23], v[172:175], v[64:79]
  s_add_u32 s22, s50, 12288
  s_add_u32 m0, s25, 49152
  s_nop 0
  buffer_load_dwordx4 v2, s[8:11], s22 offen sc1 lds
  v_permlane16_swap_b32 v48, v56
  v_permlane16_swap_b32 v49, v57
  v_permlane16_swap_b32 v50, v58
  v_mfma_f32_32x32x16_bf16 v[80:95], v[20:23], v[236:239], v[80:95]
  v_permlane16_swap_b32 v51, v59
  v_accvgpr_write_b32 a160, v48
  s_waitcnt lgkmcnt(1)
  v_mfma_f32_32x32x16_bf16 v[64:79], v[24:27], v[176:179], v[64:79]
  s_add_u32 s22, s50, 13312
  s_add_u32 m0, s25, 50176
  s_nop 0
  buffer_load_dwordx4 v2, s[8:11], s22 offen sc1 lds
  v_accvgpr_write_b32 a161, v49
  v_accvgpr_write_b32 a162, v50
  v_accvgpr_write_b32 a163, v51
  v_mfma_f32_32x32x16_bf16 v[80:95], v[24:27], v[240:243], v[80:95]
  v_accvgpr_write_b32 a216, v56
  v_accvgpr_write_b32 a217, v57
  s_waitcnt lgkmcnt(0)
  v_mfma_f32_32x32x16_bf16 v[64:79], v[28:31], v[180:183], v[64:79]
  buffer_load_dwordx4 v[100:103], v113, s[8:11], s28 offen sc1
  buffer_load_dwordx4 v[104:107], v2, s[8:11], s29 offen sc1
  buffer_load_dwordx4 v[108:111], v112, s[8:11], s29 offen sc1
  v_accvgpr_write_b32 a218, v58
  v_accvgpr_write_b32 a219, v59
  v_mfma_f32_32x32x16_bf16 v[80:95], v[28:31], v[244:247], v[80:95]
  s_nop 4
  v_mul_f32 v64, s52, v64
  v_mul_f32 v65, s52, v65
  v_cvt_pk_bf16_f32 v64, v64, v65
  v_mul_f32 v66, s52, v66
  v_mul_f32 v67, s52, v67
  v_cvt_pk_bf16_f32 v65, v66, v67
  v_mul_f32 v68, s52, v68
  v_mul_f32 v69, s52, v69
  v_cvt_pk_bf16_f32 v66, v68, v69
  v_mul_f32 v70, s52, v70
  v_mul_f32 v71, s52, v71
  v_cvt_pk_bf16_f32 v67, v70, v71
  v_mul_f32 v72, s52, v72
  v_mul_f32 v73, s52, v73
  v_cvt_pk_bf16_f32 v72, v72, v73
  v_mul_f32 v74, s52, v74
  v_mul_f32 v75, s52, v75
  v_cvt_pk_bf16_f32 v73, v74, v75
  v_mul_f32 v76, s52, v76
  v_mul_f32 v77, s52, v77
  v_cvt_pk_bf16_f32 v74, v76, v77
  v_mul_f32 v78, s52, v78
  v_mul_f32 v79, s52, v79
  v_cvt_pk_bf16_f32 v75, v78, v79
  v_permlane16_swap_b32 v64, v72
  v_permlane16_swap_b32 v65, v73
  v_permlane16_swap_b32 v66, v74
  v_permlane16_swap_b32 v67, v75
  v_accvgpr_write_b32 a52, v64
  v_accvgpr_write_b32 a53, v65
  v_accvgpr_write_b32 a54, v66
  v_accvgpr_write_b32 a55, v67
  v_accvgpr_write_b32 a108, v72
  v_accvgpr_write_b32 a109, v73
  v_accvgpr_write_b32 a110, v74
  v_accvgpr_write_b32 a111, v75
  v_mul_f32 v80, s52, v80
  v_mul_f32 v81, s52, v81
  v_cvt_pk_bf16_f32 v80, v80, v81
  v_mul_f32 v82, s52, v82
  v_mul_f32 v83, s52, v83
  v_cvt_pk_bf16_f32 v81, v82, v83
  v_mul_f32 v84, s52, v84
  v_mul_f32 v85, s52, v85
  v_cvt_pk_bf16_f32 v82, v84, v85
  v_mul_f32 v86, s52, v86
  v_mul_f32 v87, s52, v87
  v_cvt_pk_bf16_f32 v83, v86, v87
  v_mul_f32 v88, s52, v88
  v_mul_f32 v89, s52, v89
  v_cvt_pk_bf16_f32 v88, v88, v89
  v_mul_f32 v90, s52, v90
  v_mul_f32 v91, s52, v91
  v_cvt_pk_bf16_f32 v89, v90, v91
  v_mul_f32 v92, s52, v92
  v_mul_f32 v93, s52, v93
  v_cvt_pk_bf16_f32 v90, v92, v93
  v_mul_f32 v94, s52, v94
  v_mul_f32 v95, s52, v95
  v_cvt_pk_bf16_f32 v91, v94, v95
  v_permlane16_swap_b32 v80, v88
  v_permlane16_swap_b32 v81, v89
  v_permlane16_swap_b32 v82, v90
  v_permlane16_swap_b32 v83, v91
  v_accvgpr_write_b32 a164, v80
  v_accvgpr_write_b32 a165, v81
  v_accvgpr_write_b32 a166, v82
  v_accvgpr_write_b32 a167, v83
  v_accvgpr_write_b32 a220, v88
  v_accvgpr_write_b32 a221, v89
  v_accvgpr_write_b32 a222, v90
  v_accvgpr_write_b32 a223, v91
  s_mov_b32 s30, 0
  s_branch sc_aw_w
sc_aw:
  buffer_load_dwordx4 v[100:103], v113, s[8:11], s28 offen sc1
  buffer_load_dwordx4 v[104:107], v2, s[8:11], s29 offen sc1
  buffer_load_dwordx4 v[108:111], v112, s[8:11], s29 offen sc1
sc_aw_w:
  s_waitcnt vmcnt(0)
  v_cmp_ne_u64 vcc, s[88:89], v[100:101]
  s_cbranch_vccnz sc_aw_no
  v_cmp_ne_u64 vcc, s[88:89], v[102:103]
  s_cbranch_vccnz sc_aw_no
  v_cmp_ne_u64 vcc, s[88:89], v[104:105]
  s_cbranch_vccnz sc_aw_no
  v_cmp_ne_u64 vcc, s[88:89], v[106:107]
  s_cbranch_vccnz sc_aw_no
  v_cmp_ne_u64 vcc, s[88:89], v[108:109]
  s_cbranch_vccnz sc_aw_no
  v_cmp_ne_u64 vcc, s[88:89], v[110:111]
  s_cbranch_vccnz sc_aw_no
  s_branch sc_aw_ok
sc_aw_no:
  s_sleep 1
  s_add_u32 s30, s30, 1
  s_cmp_lt_u32 s30, 50000
  s_cbranch_scc1 sc_aw
  s_branch cA_abort
sc_aw_ok:
  v_add_u32 v4, s25, v2
  v_add_u32 v5, 0x10000, v4
  v_add_u32 v6, 0x20000, v4
  s_cmp_eq_u32 s48, 0x10000000
  s_cbranch_scc1 sc_d0
  ds_read_b128 v[144:147], v4 offset:0
  ds_read_b128 v[148:151], v4 offset:1024
  ds_read_b128 v[152:155], v4 offset:2048
  ds_read_b128 v[156:159], v4 offset:3072
  ds_read_b128 v[160:163], v4 offset:16384
  ds_read_b128 v[164:167], v4 offset:17408
  ds_read_b128 v[168:171], v4 offset:18432
  ds_read_b128 v[172:175], v4 offset:19456
  ds_read_b128 v[176:179], v5 offset:16384
  ds_read_b128 v[180:183], v5 offset:17408
  ds_read_b128 v[184:187], v5 offset:18432
  ds_read_b128 v[188:191], v5 offset:19456
  ds_read_b128 v[192:195], v5 offset:32768
  ds_read_b128 v[196:199], v5 offset:33792
  s_waitcnt lgkmcnt(0)
  s_branch sc_e0
sc_d0:
  s_add_u32 s22, s33, 12288
  buffer_load_dwordx4 v[144:147], v2, s[8:11], s22 offen offset:2048 sc1
  buffer_load_dwordx4 v[148:151], v2, s[8:11], s22 offen offset:3072 sc1
  s_add_u32 s22, s33, 16384
  buffer_load_dwordx4 v[152:155], v2, s[8:11], s22 offen offset:0 sc1
  buffer_load_dwordx4 v[156:159], v2, s[8:11], s22 offen offset:1024 sc1
  buffer_load_dwordx4 v[160:163], v2, s[8:11], s22 offen offset:2048 sc1
  buffer_load_dwordx4 v[164:167], v2, s[8:11], s22 offen offset:3072 sc1
  s_add_u32 s22, s33, 20480
  buffer_load_dwordx4 v[168:171], v2, s[8:11], s22 offen offset:0 sc1
  buffer_load_dwordx4 v[172:175], v2, s[8:11], s22 offen offset:1024 sc1
  buffer_load_dwordx4 v[176:179], v2, s[8:11], s22 offen offset:2048 sc1
  buffer_load_dwordx4 v[180:183], v2, s[8:11], s22 offen offset:3072 sc1
  s_add_u32 s22, s33, 24576
  buffer_load_dwordx4 v[184:187], v2, s[8:11], s22 offen offset:0 sc1
  buffer_load_dwordx4 v[188:191], v2, s[8:11], s22 offen offset:1024 sc1
  buffer_load_dwordx4 v[192:195], v2, s[8:11], s22 offen offset:2048 sc1
  buffer_load_dwordx4 v[196:199], v2, s[8:11], s22 offen offset:3072 sc1
sc_e0:
  s_cmp_eq_u32 s49, 0x10000000
  s_cbranch_scc1 sc_d1
  ds_read_b128 v[200:203], v5 offset:34816
  ds_read_b128 v[204:207], v5 offset:35840
  ds_read_b128 v[208:211], v5 offset:49152
  ds_read_b128 v[212:215], v5 offset:50176
  ds_read_b128 v[216:219], v5 offset:51200
  ds_read_b128 v[220:223], v5 offset:52224
  ds_read_b128 v[224:227], v6 offset:0
  ds_read_b128 v[228:231], v6 offset:1024
  ds_read_b128 v[232:235], v6 offset:2048
  ds_read_b128 v[236:239], v6 offset:3072
  ds_read_b128 v[240:243], v6 offset:16384
  ds_read_b128 v[244:247], v6 offset:17408
  ds_read_b128 v[248:251], v6 offset:18432
  ds_read_b128 v[252:255], v6 offset:19456
  s_waitcnt lgkmcnt(0)
  s_branch sc_e1
sc_d1:
  s_add_u32 s22, s32, 0
  buffer_load_dwordx4 v[200:203], v2, s[8:11], s22 offen offset:0 sc1
  buffer_load_dwordx4 v[204:207], v2, s[8:11], s22 offen offset:1024 sc1
  buffer_load_dwordx4 v[208:211], v2, s[8:11], s22 offen offset:2048 sc1
  buffer_load_dwordx4 v[212:215], v2, s[8:11], s22 offen offset:3072 sc1
  s_add_u32 s22, s32, 4096
  buffer_load_dwordx4 v[216:219], v2, s[8:11], s22 offen offset:0 sc1
  buffer_load_dwordx4 v[220:223], v2, s[8:11], s22 offen offset:1024 sc1
  buffer_load_dwordx4 v[224:227], v2, s[8:11], s22 offen offset:2048 sc1
  buffer_load_dwordx4 v[228:231], v2, s[8:11], s22 offen offset:3072 sc1
  s_add_u32 s22, s32, 8192
  buffer_load_dwordx4 v[232:235], v2, s[8:11], s22 offen offset:0 sc1
  buffer_load_dwordx4 v[236:239], v2, s[8:11], s22 offen offset:1024 sc1
  buffer_load_dwordx4 v[240:243], v2, s[8:11], s22 offen offset:2048 sc1
  buffer_load_dwordx4 v[244:247], v2, s[8:11], s22 offen offset:3072 sc1
  s_add_u32 s22, s32, 12288
  buffer_load_dwordx4 v[248:251], v2, s[8:11], s22 offen offset:0 sc1
  buffer_load_dwordx4 v[252:255], v2, s[8:11], s22 offen offset:1024 sc1
sc_e1:
  s_cmp_eq_u32 s50, 0x10000000
  s_cbranch_scc1 sc_d2
  ds_read_b128 v[120:123], v4 offset:32768
  ds_read_b128 v[124:127], v4 offset:33792
  ds_read_b128 v[128:131], v4 offset:34816
  ds_read_b128 v[132:135], v4 offset:35840
  ds_read_b128 v[136:139], v4 offset:49152
  ds_read_b128 v[140:143], v4 offset:50176
  s_waitcnt lgkmcnt(0)
  s_branch sc_e2
sc_d2:
  s_add_u32 s22, s33, 0
  buffer_load_dwordx4 a[224:227], v2, s[8:11], s22 offen offset:0 sc1
  buffer_load_dwordx4 a[228:231], v2, s[8:11], s22 offen offset:1024 sc1
  buffer_load_dwordx4 a[232:235], v2, s[8:11], s22 offen offset:2048 sc1
  buffer_load_dwordx4 a[236:239], v2, s[8:11], s22 offen offset:3072 sc1
  s_add_u32 s22, s33, 4096
  buffer_load_dwordx4 a[240:243], v2, s[8:11], s22 offen offset:0 sc1
  buffer_load_dwordx4 a[244:247], v2, s[8:11], s22 offen offset:1024 sc1
  buffer_load_dwordx4 a[248:251], v2, s[8:11], s22 offen offset:2048 sc1
  buffer_load_dwordx4 a[252:255], v2, s[8:11], s22 offen offset:3072 sc1
  s_add_u32 s22, s33, 8192
  buffer_load_dwordx4 v[120:123], v2, s[8:11], s22 offen offset:0 sc1
  buffer_load_dwordx4 v[124:127], v2, s[8:11], s22 offen offset:1024 sc1
  buffer_load_dwordx4 v[128:131], v2, s[8:11], s22 offen offset:2048 sc1
  buffer_load_dwordx4 v[132:135], v2, s[8:11], s22 offen offset:3072 sc1
  s_add_u32 s22, s33, 12288
  buffer_load_dwordx4 v[136:139], v2, s[8:11], s22 offen offset:0 sc1
  buffer_load_dwordx4 v[140:143], v2, s[8:11], s22 offen offset:1024 sc1
sc_e2:
  s_barrier
  s_branch m_role
m_val:
  s_cmp_lg_u32 s16, 0
  s_cbranch_scc1 w0_6
  v_mov_b32 v233, 128
  v_mov_b32 v234, s88
  v_mov_b32 v235, s89
  v_mov_b32 v236, 0
  v_mov_b32 v237, 0
  s_mov_b64 exec, 1
  buffer_atomic_cmpswap_x2 v[234:237], v233, s[12:15], 0 offen sc0
  s_mov_b64 exec, -1
w0_6:
  s_cmp_lg_u32 s66, 0
  s_cbranch_scc1 va_ci
  s_cmp_lg_u32 s16, 0
  s_cbranch_scc1 w0_7
  s_lshr_b32 s70, s3, 5
  s_and_b32 s71, s70, 4
  s_mul_i32 s71, s71, 12
  s_lshl_b32 s70, s70, 2
  s_add_u32 s70, s70, s71
  s_lshl_b32 s71, 1, s3
  v_mov_b32 v242, s71
  v_mov_b32 v243, 32
  s_mov_b64 exec, 1
  buffer_atomic_or v242, v243, s[12:15], s70 offen sc0
  buffer_load_dwordx2 v[244:245], v243, s[12:15], 0 offen offset:96 sc1
  s_mov_b64 exec, -1
w0_7:
va_ci:
  s_mov_b32 s56, s40
  s_and_b32 s57, s41, 0xffff
  s_mov_b32 s58, 3670016
  s_mov_b32 s59, 0x20000
  v_lshrrev_b32 v24, 5, v1
  v_and_b32 v25, 31, v1
  v_lshlrev_b32 v25, 4, v25
  v_lshl_add_u32 v24, v24, 13, v25
  s_mov_b32 s60, s42
  s_and_b32 s61, s43, 0xffff
  s_mov_b32 s62, 3670016
  s_mov_b32 s63, 0x20000
  s_lshl_b32 s22, s17, 9
  s_lshl_b32 s23, s16, 19
  s_add_u32 s23, s22, s23
  s_add_u32 s21, s23, 262144
  buffer_load_dwordx4 v[28:31], v24, s[60:63], s21 offen
  s_add_u32 s21, s23, 278528
  buffer_load_dwordx4 v[28:31], v24, s[60:63], s21 offen
  s_add_u32 s21, s23, 294912
  buffer_load_dwordx4 v[28:31], v24, s[60:63], s21 offen
  s_add_u32 s21, s23, 311296
  buffer_load_dwordx4 v[28:31], v24, s[60:63], s21 offen
  s_add_u32 s21, s23, 327680
  buffer_load_dwordx4 v[28:31], v24, s[60:63], s21 offen
  s_add_u32 s21, s23, 344064
  buffer_load_dwordx4 v[28:31], v24, s[60:63], s21 offen
  s_add_u32 s21, s23, 360448
  buffer_load_dwordx4 v[28:31], v24, s[60:63], s21 offen
  s_add_u32 s21, s23, 376832
  buffer_load_dwordx4 v[28:31], v24, s[60:63], s21 offen
  s_add_u32 s21, s23, 393216
  buffer_load_dwordx4 v[28:31], v24, s[60:63], s21 offen
  s_add_u32 s21, s23, 409600
  buffer_load_dwordx4 v[28:31], v24, s[60:63], s21 offen
  s_add_u32 s21, s23, 425984
  buffer_load_dwordx4 v[28:31], v24, s[60:63], s21 offen
  s_add_u32 s21, s23, 442368
  buffer_load_dwordx4 v[28:31], v24, s[60:63], s21 offen
  s_add_u32 s21, s23, 458752
  buffer_load_dwordx4 v[28:31], v24, s[60:63], s21 offen
  s_add_u32 s21, s23, 475136
  buffer_load_dwordx4 v[28:31], v24, s[60:63], s21 offen
  s_add_u32 s21, s23, 491520
  buffer_load_dwordx4 v[28:31], v24, s[60:63], s21 offen
  s_add_u32 s21, s23, 507904
  buffer_load_dwordx4 v[28:31], v24, s[60:63], s21 offen
  s_lshl_b32 s23, s16, 14
  s_add_u32 s22, s22, s23
  s_mov_b32 s30, 0
va_pf:
  buffer_load_dwordx4 v[28:31], v24, s[56:59], s22 offen
  s_waitcnt vmcnt(40)
  s_add_u32 s22, s22, 65536
  s_add_u32 s30, s30, 1
  s_cmp_lt_u32 s30, 56
  s_cbranch_scc1 va_pf
  s_cmp_lg_u32 s66, 0
  s_cbranch_scc1 va_cf
  s_cmp_lg_u32 s16, 0
  s_cbranch_scc1 w0_8
  s_waitcnt vmcnt(40)
  v_readfirstlane_b32 s70, v244
  s_cmp_lg_u32 s70, 0
  s_cbranch_scc1 va_nz
  v_mov_b32 v243, 128
  v_mov_b32 v244, s88
  v_mov_b32 v245, s89
  v_mov_b32 v246, 0
  v_mov_b32 v247, 0
  s_mov_b64 exec, 1
  buffer_atomic_cmpswap_x2 v[244:247], v243, s[12:15], 0 offen sc0
  s_mov_b64 exec, -1
  s_waitcnt vmcnt(0)
  v_readfirstlane_b32 s70, v244
  s_cmp_lg_u32 s70, 0
  s_cbranch_scc1 va_nz
  v_mov_b32 v244, s88
  v_mov_b32 v245, s89
va_nz:
w0_8:
  v_mov_b32 v243, 160000
  s_add_u32 s101, s101, 1
  s_barrier
  s_mov_b64 exec, 1
  s_cmp_lg_u32 s16, 0
  s_cbranch_scc1 w0_9
  ds_write_b32 v243, v242 offset:0
  ds_write_b32 v243, v244 offset:4
  ds_write_b32 v243, v245 offset:8
  s_waitcnt lgkmcnt(0)
  v_mov_b32 v242, s101
  ds_write_b32 v243, v242 offset:16
  s_waitcnt lgkmcnt(0)
w0_9:
  s_mov_b64 exec, -1
  s_barrier
  ds_read_b32 v242, v243 offset:0
  ds_read_b32 v244, v243 offset:4
  ds_read_b32 v245, v243 offset:8
  ds_read_b32 v243, v243 offset:16
  s_waitcnt lgkmcnt(0)
  v_readfirstlane_b32 s70, v242
  v_readfirstlane_b32 s88, v244
  v_readfirstlane_b32 s89, v245
  v_cmp_ne_u32 vcc, s101, v243
  s_cbranch_vccnz ch_end
  s_mov_b32 s66, 1
  s_bitcmp1_b32 s70, s3
  s_cbranch_scc1 m_reclaim
va_cf:
  s_cmp_lg_u32 s16, 0
  s_cbranch_scc1 w0_10
  s_cmp_eq_u32 s67, 0
  s_cselect_b32 s20, 1, 0x10001
  v_mov_b32 v242, s20
  v_mov_b32 v243, 0
  s_mov_b64 exec, 1
  buffer_atomic_add v242, v243, s[12:15], 0 offen
  s_mov_b64 exec, -1
w0_10:
m_role:
  s_mov_b32 s17, s3
  v_and_b32 v1, 63, v0
  v_lshlrev_b32 v2, 4, v1
  v_lshrrev_b32 v116, 4, v1
  v_and_b32 v117, 15, v1
  v_mov_b32 v3, 0x4444
  v_mov_b32 v118, 0xeeee
  v_cmp_lt_u32 vcc, 7, v117
  s_nop 1
  v_cndmask_b32 v3, v3, v118, vcc
  s_mov_b32 s19, 0
  s_mov_b32 s20, 88653824
  s_lshr_b32 s22, s17, 4
  s_lshl_b32 s22, s22, 2
  s_add_u32 s22, s22, s16
  s_and_b32 s17, s17, 15
  s_cmp_eq_u32 s22, 0
  s_cbranch_scc1 ch_init0
  s_cmp_eq_u32 s22, 1
  s_cbranch_scc1 ch_init1
  s_cmp_eq_u32 s22, 2
  s_cbranch_scc1 ch_init2
  s_cmp_eq_u32 s22, 3
  s_cbranch_scc1 ch_init3
  s_cmp_eq_u32 s22, 4
  s_cbranch_scc1 ch_init4
  s_cmp_eq_u32 s22, 5
  s_cbranch_scc1 ch_init5
  s_cmp_eq_u32 s22, 6
  s_cbranch_scc1 ch_init6
  s_cmp_eq_u32 s22, 7
  s_cbranch_scc1 ch_init7
  s_branch ch_end
ch_init0:
  s_mul_i32 s31, s17, 401408
  s_add_u32 s31, s31, 0
  s_mov_b32 s24, 71565312
  s_mov_b32 s25, 0
  s_add_u32 m0, s25, 0
  s_nop 0
  buffer_load_dwordx4 v2, s[8:11], s24 offen offset:0 sc1 lds
  buffer_load_dwordx4 v2, s[8:11], s24 offen offset:1024 sc1 lds
  buffer_load_dwordx4 v2, s[8:11], s24 offen offset:2048 sc1 lds
  buffer_load_dwordx4 v2, s[8:11], s24 offen offset:3072 sc1 lds
  s_add_u32 m0, s25, 4096
  s_add_u32 s22, s24, 4096
  buffer_load_dwordx4 v2, s[8:11], s22 offen offset:0 sc1 lds
  buffer_load_dwordx4 v2, s[8:11], s22 offen offset:1024 sc1 lds
  buffer_load_dwordx4 v2, s[8:11], s22 offen offset:2048 sc1 lds
  v_lshrrev_b32 v64, 1, v117
  v_and_b32 v65, 1, v116
  v_lshlrev_b32 v65, 2, v65
  v_sub_u32 v64, v64, v65
  v_and_b32 v65, 1, v117
  v_lshl_add_u32 v66, v65, 2, v64
  v_cmp_gt_u32 vcc, 4, v64
  v_mov_b32 v67, 99
  s_nop 0
  v_cndmask_b32 v66, v67, v66, vcc
  v_mov_b32 v68, 0x3f80
  v_mov_b32 v69, 0x3f800000
  v_mov_b32 v4, 0
  v_cmp_eq_u32 vcc, 0, v66
  s_nop 1
  v_cndmask_b32 v4, v4, v68, vcc
  v_cmp_eq_u32 vcc, 1, v66
  s_nop 1
  v_cndmask_b32 v4, v4, v69, vcc
  v_mov_b32 v5, 0
  v_cmp_eq_u32 vcc, 2, v66
  s_nop 1
  v_cndmask_b32 v5, v5, v68, vcc
  v_cmp_eq_u32 vcc, 3, v66
  s_nop 1
  v_cndmask_b32 v5, v5, v69, vcc
  v_mov_b32 v6, 0
  v_cmp_eq_u32 vcc, 4, v66
  s_nop 1
  v_cndmask_b32 v6, v6, v68, vcc
  v_cmp_eq_u32 vcc, 5, v66
  s_nop 1
  v_cndmask_b32 v6, v6, v69, vcc
  v_mov_b32 v7, 0
  v_cmp_eq_u32 vcc, 6, v66
  s_nop 1
  v_cndmask_b32 v7, v7, v68, vcc
  v_cmp_eq_u32 vcc, 7, v66
  s_nop 1
  v_cndmask_b32 v7, v7, v69, vcc
  v_lshrrev_b32 v64, 1, v116
  v_lshrrev_b32 v65, 3, v117
  v_cmp_eq_u32 s[26:27], v64, v65
  v_and_b32 v66, 1, v116
  v_add_u32 v64, 0, v64
  v_lshrrev_b32 v67, 1, v116
  v_lshlrev_b32 v67, 8, v67
  v_lshl_add_u32 v67, v66, 9, v67
  v_lshl_add_u32 v67, v117, 4, v67
  v_add_u32 v112, 57344, v67
  v_and_b32 v68, 7, v117
  v_lshlrev_b32 v67, 8, v64
  v_lshl_add_u32 v67, v68, 5, v67
  v_lshl_add_u32 v67, v66, 4, v67
  v_add_u32 v113, 65536, v67
  v_lshrrev_b32 v64, 5, v1
  v_and_b32 v65, 31, v1
  v_lshrrev_b32 v66, 3, v65
  v_and_b32 v67, 7, v65
  v_and_b32 v68, 3, v67
  v_lshl_add_u32 v68, v66, 2, v68
  v_lshrrev_b32 v69, 2, v67
  v_lshl_add_u32 v68, v69, 4, v68
  v_lshlrev_b32 v69, 11, v64
  v_lshl_add_u32 v69, v68, 4, v69
  v_add_u32 v114, 57344, v69
  v_add_u32 v70, 0, v64
  v_lshlrev_b32 v69, 9, v66
  v_lshl_add_u32 v69, v70, 5, v69
  v_lshl_add_u32 v69, v67, 2, v69
  v_add_u32 v115, 65536, v69
  v_lshlrev_b32 v69, 4, v68
  v_lshl_add_u32 v69, v64, 9, v69
  v_add_u32 v114, 57344, v69
  v_mul_u32_u24 v69, 144, v70
  v_lshl_add_u32 v69, v67, 4, v69
  v_add_u32 v115, 65536, v69
  v_and_b32 v71, 1, v116
  v_mul_u32_u24 v69, 2048, v71
  v_lshl_add_u32 v69, v64, 8, v69
  v_lshl_add_u32 v69, v117, 4, v69
  v_add_u32 v112, 57344, v69
  v_mul_u32_u24 v69, 144, v117
  v_lshl_add_u32 v69, v71, 6, v69
  v_lshl_add_u32 v69, v64, 5, v69
  v_add_u32 v113, 65536, v69
  v_mul_u32_u24 v69, 1024, v116
  v_lshl_add_u32 v69, v117, 4, v69
  v_and_b32 v72, 8, v117
  v_xor_b32 v72, 0, v72
  v_add_u32 v69, v69, v72
  v_add_u32 v112, 57344, v69
  v_lshrrev_b32 v72, 3, v117
  v_lshl_add_u32 v72, v71, 1, v72
  v_xor_b32 v72, 0, v72
  v_lshlrev_b32 v69, 10, v116
  v_lshl_add_u32 v69, v117, 4, v69
  v_lshl_add_u32 v69, v72, 2, v69
  v_add_u32 v112, 57344, v69
  v_lshrrev_b32 v69, 1, v117
  v_and_b32 v72, 1, v117
  v_lshl_add_u32 v69, v72, 3, v69
  v_mul_u32_u24 v69, 144, v69
  v_lshl_add_u32 v69, v71, 6, v69
  v_lshl_add_u32 v69, v64, 5, v69
  v_lshl_add_u32 v72, v72, 1, v71
  v_xor_b32 v72, 0, v72
  v_lshl_add_u32 v69, v72, 2, v69
  v_add_u32 v113, 65536, v69
  v_and_b32 v71, 1, v1
  v_cmp_eq_u32 s[38:39], 0, v71
  v_cmp_gt_u32 vcc, 8, v65
  s_or_b64 s[28:29], s[38:39], vcc
  v_lshrrev_b32 v72, 1, v67
  v_lshlrev_b32 v72, 2, v72
  v_lshl_add_u32 v72, v70, 4, v72
  s_lshl_b32 s22, s17, 9
  s_add_u32 s22, s22, 9216
  v_lshl_add_u32 v73, v66, 7, v72
  v_add_u32 v73, s22, v73
  s_lshl_b32 s22, s17, 7
  s_add_u32 s22, s22, 7168
  v_add_u32 v74, s22, v72
  v_bfe_u32 v72, v65, 1, 1
  v_lshlrev_b32 v72, 7, v72
  v_lshl_add_u32 v72, v70, 4, v72
  v_bfe_u32 v73, v65, 2, 2
  v_lshl_add_u32 v72, v73, 2, v72
  v_lshrrev_b32 v73, 4, v65
  v_lshl_add_u32 v73, v73, 8, v72
  s_lshl_b32 s22, s17, 9
  s_add_u32 s22, s22, 9216
  v_add_u32 v73, s22, v73
  s_lshr_b32 s22, s17, 1
  s_lshl_b32 s22, s22, 8
  s_and_b32 s34, s17, 1
  s_lshl_b32 s34, s34, 3
  s_add_u32 s22, s22, s34
  s_add_u32 s22, s22, 7168
  v_add_u32 v74, s22, v72
  v_bfe_u32 v72, v65, 1, 1
  v_lshl_add_u32 v72, v64, 1, v72
  v_lshlrev_b32 v72, 4, v72
  v_bfe_u32 v73, v65, 2, 2
  v_lshl_add_u32 v72, v73, 2, v72
  v_lshrrev_b32 v73, 4, v65
  v_lshl_add_u32 v73, v73, 6, v72
  s_lshl_b32 s22, s17, 9
  s_add_u32 s22, s22, 9216
  v_add_u32 v73, s22, v73
  v_lshrrev_b32 v72, 1, v65
  v_lshlrev_b32 v72, 2, v72
  v_lshl_add_u32 v72, v64, 5, v72
  s_lshr_b32 s22, s17, 1
  s_lshl_b32 s22, s22, 8
  s_and_b32 s34, s17, 1
  s_lshl_b32 s34, s34, 4
  s_add_u32 s22, s22, s34
  s_add_u32 s22, s22, 7168
  v_add_u32 v74, s22, v72
  v_lshlrev_b32 v0, 2, v65
  v_and_b32 v0, 120, v0
  s_and_b32 s22, s17, 15
  s_lshl_b32 s22, s22, 7
  s_add_u32 s22, s22, 18432
  v_add_u32 v0, s22, v0
  v_cndmask_b32 v1, v74, v73, s[38:39]
  s_lshl_b32 s36, s17, 2
  s_add_u32 s36, s36, 17472
  s_mov_b32 s37, 0x3e800000
  v_mov_b32 v64, 0
  v_mov_b32 v65, 0
  v_mov_b32 v66, 0
  v_mov_b32 v67, 0
  v_mov_b32 v68, 0
  v_mov_b32 v69, 0
  v_mov_b32 v70, 0
  v_mov_b32 v71, 0
  v_mov_b32 v72, 0
  v_mov_b32 v73, 0
  v_mov_b32 v74, 0
  v_mov_b32 v75, 0
  v_mov_b32 v76, 0
  v_mov_b32 v77, 0
  v_mov_b32 v78, 0
  v_mov_b32 v79, 0
  v_mov_b32 v80, 0
  v_mov_b32 v81, 0
  v_mov_b32 v82, 0
  v_mov_b32 v83, 0
  v_mov_b32 v84, 0
  v_mov_b32 v85, 0
  v_mov_b32 v86, 0
  v_mov_b32 v87, 0
  v_mov_b32 v88, 0
  v_mov_b32 v89, 0
  v_mov_b32 v90, 0
  v_mov_b32 v91, 0
  v_mov_b32 v92, 0
  v_mov_b32 v93, 0
  v_mov_b32 v94, 0
  v_mov_b32 v95, 0
  v_mov_b32 v96, 0
  v_mov_b32 v97, 0
  v_mov_b32 v98, 0
  v_mov_b32 v99, 0
  v_mov_b32 v100, 0
  v_mov_b32 v101, 0
  v_mov_b32 v102, 0
  v_mov_b32 v103, 0
  v_mov_b32 v104, 0
  v_mov_b32 v105, 0
  v_mov_b32 v106, 0
  v_mov_b32 v107, 0
  v_mov_b32 v108, 0
  v_mov_b32 v109, 0
  v_mov_b32 v110, 0
  v_mov_b32 v111, 0
  v_and_b32 v118, 1, v116
  v_cmp_eq_u32 vcc, 0, v118
  v_mov_b32 v118, 12288
  v_mov_b32 v119, 8192
  v_cndmask_b32 v118, v118, v119, vcc
  v_lshrrev_b32 v116, 1, v116
  v_lshl_add_u32 v118, v116, 9, v118
  v_lshl_add_u32 v117, v117, 4, v118
  s_mov_b32 s57, 28672
  v_bfe_u32 v118, v2, 4, 1
  v_mul_u32_u24 v118, 0xaaaa, v118
  v_add_u32 v118, 0x4444, v118
  s_mov_b32 s56, 0x42800000
  v_mov_b32 v116, v2
  s_mul_i32 s35, s17, 1835008
  s_add_u32 s35, s35, 42262528
  s_mov_b32 s30, 0
  v_mov_b32 v36, 0
ch_md0:
  buffer_load_dword v37, v36, s[12:15], 0 offen sc1
  s_waitcnt vmcnt(0)
  v_readfirstlane_b32 s22, v37
  s_and_b32 s31, s22, 0xffff
  s_cmp_ge_u32 s31, 32
  s_cbranch_scc1 ch_go0
  s_sleep 2
  s_add_u32 s30, s30, 1
  s_cmp_lt_u32 s30, 50000
  s_cbranch_scc1 ch_md0
  s_branch ch_end
ch_go0:
  s_mov_b32 s31, 0
  s_lshr_b32 s22, s22, 16
  s_cmp_lg_u32 s22, 0
  s_cbranch_scc1 cB_sc0_loop
  s_branch cA_sc0_loop
ch_init1:
  s_mul_i32 s31, s17, 401408
  s_add_u32 s31, s31, 0
  s_mov_b32 s24, 71572480
  s_mov_b32 s25, 0
  s_add_u32 m0, s25, 7168
  s_nop 0
  buffer_load_dwordx4 v2, s[8:11], s24 offen offset:0 sc1 lds
  buffer_load_dwordx4 v2, s[8:11], s24 offen offset:1024 sc1 lds
  buffer_load_dwordx4 v2, s[8:11], s24 offen offset:2048 sc1 lds
  buffer_load_dwordx4 v2, s[8:11], s24 offen offset:3072 sc1 lds
  s_add_u32 m0, s25, 11264
  s_add_u32 s22, s24, 4096
  buffer_load_dwordx4 v2, s[8:11], s22 offen offset:0 sc1 lds
  buffer_load_dwordx4 v2, s[8:11], s22 offen offset:1024 sc1 lds
  buffer_load_dwordx4 v2, s[8:11], s22 offen offset:2048 sc1 lds
  v_lshrrev_b32 v64, 1, v117
  v_and_b32 v65, 1, v116
  v_lshlrev_b32 v65, 2, v65
  v_sub_u32 v64, v64, v65
  v_and_b32 v65, 1, v117
  v_lshl_add_u32 v66, v65, 2, v64
  v_cmp_gt_u32 vcc, 4, v64
  v_mov_b32 v67, 99
  s_nop 0
  v_cndmask_b32 v66, v67, v66, vcc
  v_mov_b32 v68, 0x3f80
  v_mov_b32 v69, 0x3f800000
  v_mov_b32 v4, 0
  v_cmp_eq_u32 vcc, 0, v66
  s_nop 1
  v_cndmask_b32 v4, v4, v68, vcc
  v_cmp_eq_u32 vcc, 1, v66
  s_nop 1
  v_cndmask_b32 v4, v4, v69, vcc
  v_mov_b32 v5, 0
  v_cmp_eq_u32 vcc, 2, v66
  s_nop 1
  v_cndmask_b32 v5, v5, v68, vcc
  v_cmp_eq_u32 vcc, 3, v66
  s_nop 1
  v_cndmask_b32 v5, v5, v69, vcc
  v_mov_b32 v6, 0
  v_cmp_eq_u32 vcc, 4, v66
  s_nop 1
  v_cndmask_b32 v6, v6, v68, vcc
  v_cmp_eq_u32 vcc, 5, v66
  s_nop 1
  v_cndmask_b32 v6, v6, v69, vcc
  v_mov_b32 v7, 0
  v_cmp_eq_u32 vcc, 6, v66
  s_nop 1
  v_cndmask_b32 v7, v7, v68, vcc
  v_cmp_eq_u32 vcc, 7, v66
  s_nop 1
  v_cndmask_b32 v7, v7, v69, vcc
  v_lshrrev_b32 v64, 1, v116
  v_lshrrev_b32 v65, 3, v117
  v_cmp_eq_u32 s[26:27], v64, v65
  v_and_b32 v66, 1, v116
  v_add_u32 v64, 2, v64
  v_lshrrev_b32 v67, 1, v116
  v_lshlrev_b32 v67, 8, v67
  v_lshl_add_u32 v67, v66, 9, v67
  v_lshl_add_u32 v67, v117, 4, v67
  v_add_u32 v112, 58368, v67
  v_and_b32 v68, 7, v117
  v_lshlrev_b32 v67, 8, v64
  v_lshl_add_u32 v67, v68, 5, v67
  v_lshl_add_u32 v67, v66, 4, v67
  v_add_u32 v113, 65536, v67
  v_lshrrev_b32 v64, 5, v1
  v_and_b32 v65, 31, v1
  v_lshrrev_b32 v66, 3, v65
  v_and_b32 v67, 7, v65
  v_and_b32 v68, 3, v67
  v_lshl_add_u32 v68, v66, 2, v68
  v_lshrrev_b32 v69, 2, v67
  v_lshl_add_u32 v68, v69, 4, v68
  v_lshlrev_b32 v69, 11, v64
  v_lshl_add_u32 v69, v68, 4, v69
  v_add_u32 v114, 57352, v69
  v_add_u32 v70, 2, v64
  v_lshlrev_b32 v69, 9, v66
  v_lshl_add_u32 v69, v70, 5, v69
  v_lshl_add_u32 v69, v67, 2, v69
  v_add_u32 v115, 65536, v69
  v_lshlrev_b32 v69, 4, v68
  v_lshl_add_u32 v69, v64, 9, v69
  v_add_u32 v114, 58368, v69
  v_mul_u32_u24 v69, 144, v70
  v_lshl_add_u32 v69, v67, 4, v69
  v_add_u32 v115, 65536, v69
  v_and_b32 v71, 1, v116
  v_mul_u32_u24 v69, 2048, v71
  v_lshl_add_u32 v69, v64, 8, v69
  v_lshl_add_u32 v69, v117, 4, v69
  v_add_u32 v112, 57352, v69
  v_mul_u32_u24 v69, 144, v117
  v_lshl_add_u32 v69, v71, 6, v69
  v_lshl_add_u32 v69, v64, 5, v69
  v_add_u32 v113, 65540, v69
  v_mul_u32_u24 v69, 1024, v116
  v_lshl_add_u32 v69, v117, 4, v69
  v_and_b32 v72, 8, v117
  v_xor_b32 v72, 8, v72
  v_add_u32 v69, v69, v72
  v_add_u32 v112, 57344, v69
  v_lshrrev_b32 v72, 3, v117
  v_lshl_add_u32 v72, v71, 1, v72
  v_xor_b32 v72, 1, v72
  v_lshlrev_b32 v69, 10, v116
  v_lshl_add_u32 v69, v117, 4, v69
  v_lshl_add_u32 v69, v72, 2, v69
  v_add_u32 v112, 57344, v69
  v_lshrrev_b32 v69, 1, v117
  v_and_b32 v72, 1, v117
  v_lshl_add_u32 v69, v72, 3, v69
  v_mul_u32_u24 v69, 144, v69
  v_lshl_add_u32 v69, v71, 6, v69
  v_lshl_add_u32 v69, v64, 5, v69
  v_lshl_add_u32 v72, v72, 1, v71
  v_xor_b32 v72, 1, v72
  v_lshl_add_u32 v69, v72, 2, v69
  v_add_u32 v113, 65536, v69
  v_and_b32 v71, 1, v1
  v_cmp_eq_u32 s[38:39], 0, v71
  v_cmp_gt_u32 vcc, 8, v65
  s_or_b64 s[28:29], s[38:39], vcc
  v_lshrrev_b32 v72, 1, v67
  v_lshlrev_b32 v72, 2, v72
  v_lshl_add_u32 v72, v70, 4, v72
  s_lshl_b32 s22, s17, 9
  s_add_u32 s22, s22, 9216
  v_lshl_add_u32 v73, v66, 7, v72
  v_add_u32 v73, s22, v73
  s_lshl_b32 s22, s17, 7
  s_add_u32 s22, s22, 7168
  v_add_u32 v74, s22, v72
  v_bfe_u32 v72, v65, 1, 1
  v_lshlrev_b32 v72, 7, v72
  v_lshl_add_u32 v72, v70, 4, v72
  v_bfe_u32 v73, v65, 2, 2
  v_lshl_add_u32 v72, v73, 2, v72
  v_lshrrev_b32 v73, 4, v65
  v_lshl_add_u32 v73, v73, 8, v72
  s_lshl_b32 s22, s17, 9
  s_add_u32 s22, s22, 9216
  v_add_u32 v73, s22, v73
  s_lshr_b32 s22, s17, 1
  s_lshl_b32 s22, s22, 8
  s_and_b32 s34, s17, 1
  s_lshl_b32 s34, s34, 3
  s_add_u32 s22, s22, s34
  s_add_u32 s22, s22, 7168
  v_add_u32 v74, s22, v72
  v_bfe_u32 v72, v65, 1, 1
  v_lshl_add_u32 v72, v64, 1, v72
  v_lshlrev_b32 v72, 4, v72
  v_bfe_u32 v73, v65, 2, 2
  v_lshl_add_u32 v72, v73, 2, v72
  v_lshrrev_b32 v73, 4, v65
  v_lshl_add_u32 v73, v73, 6, v72
  s_lshl_b32 s22, s17, 9
  s_add_u32 s22, s22, 9344
  v_add_u32 v73, s22, v73
  v_lshrrev_b32 v72, 1, v65
  v_lshlrev_b32 v72, 2, v72
  v_lshl_add_u32 v72, v64, 5, v72
  s_lshr_b32 s22, s17, 1
  s_lshl_b32 s22, s22, 8
  s_and_b32 s34, s17, 1
  s_lshl_b32 s34, s34, 4
  s_add_u32 s22, s22, s34
  s_add_u32 s22, s22, 7232
  v_add_u32 v74, s22, v72
  v_lshlrev_b32 v0, 2, v65
  v_and_b32 v0, 120, v0
  s_and_b32 s22, s17, 15
  s_lshl_b32 s22, s22, 7
  s_add_u32 s22, s22, 18432
  v_add_u32 v0, s22, v0
  v_cndmask_b32 v1, v74, v73, s[38:39]
  s_lshl_b32 s36, s17, 2
  s_add_u32 s36, s36, 17472
  s_mov_b32 s37, 0x3e800000
  v_mov_b32 v64, 0
  v_mov_b32 v65, 0
  v_mov_b32 v66, 0
  v_mov_b32 v67, 0
  v_mov_b32 v68, 0
  v_mov_b32 v69, 0
  v_mov_b32 v70, 0
  v_mov_b32 v71, 0
  v_mov_b32 v72, 0
  v_mov_b32 v73, 0
  v_mov_b32 v74, 0
  v_mov_b32 v75, 0
  v_mov_b32 v76, 0
  v_mov_b32 v77, 0
  v_mov_b32 v78, 0
  v_mov_b32 v79, 0
  v_mov_b32 v80, 0
  v_mov_b32 v81, 0
  v_mov_b32 v82, 0
  v_mov_b32 v83, 0
  v_mov_b32 v84, 0
  v_mov_b32 v85, 0
  v_mov_b32 v86, 0
  v_mov_b32 v87, 0
  v_mov_b32 v88, 0
  v_mov_b32 v89, 0
  v_mov_b32 v90, 0
  v_mov_b32 v91, 0
  v_mov_b32 v92, 0
  v_mov_b32 v93, 0
  v_mov_b32 v94, 0
  v_mov_b32 v95, 0
  v_mov_b32 v96, 0
  v_mov_b32 v97, 0
  v_mov_b32 v98, 0
  v_mov_b32 v99, 0
  v_mov_b32 v100, 0
  v_mov_b32 v101, 0
  v_mov_b32 v102, 0
  v_mov_b32 v103, 0
  v_mov_b32 v104, 0
  v_mov_b32 v105, 0
  v_mov_b32 v106, 0
  v_mov_b32 v107, 0
  v_mov_b32 v108, 0
  v_mov_b32 v109, 0
  v_mov_b32 v110, 0
  v_mov_b32 v111, 0
  v_and_b32 v118, 1, v116
  v_cmp_eq_u32 vcc, 0, v118
  v_mov_b32 v118, 12288
  v_mov_b32 v119, 8448
  v_cndmask_b32 v118, v118, v119, vcc
  v_lshrrev_b32 v116, 1, v116
  v_lshl_add_u32 v118, v116, 9, v118
  v_lshl_add_u32 v117, v117, 4, v118
  s_mov_b32 s57, 28672
  v_bfe_u32 v118, v2, 4, 1
  v_mul_u32_u24 v118, 0xaaaa, v118
  v_add_u32 v118, 0x4444, v118
  s_mov_b32 s56, 0x42800000
  v_mov_b32 v116, v2
  v_lshrrev_b32 v0, 4, v2
  v_min_u32 v0, 9, v0
  s_mul_i32 s22, s17, 10
  v_add_u32 v0, s22, v0
  v_lshlrev_b32 v0, 7, v0
  v_add_u32 v0, 40960, v0
  s_mov_b32 s22, 88633344
  buffer_load_dword v119, v0, s[8:11], s22 offen sc1
  s_mov_b32 s22, 88612864
  buffer_load_dword v119, v0, s[8:11], s22 offen sc1
  s_mul_i32 s35, s17, 1835008
  s_add_u32 s35, s35, 42269696
  s_mov_b32 s30, 0
  v_mov_b32 v36, 0
ch_md1:
  buffer_load_dword v37, v36, s[12:15], 0 offen sc1
  s_waitcnt vmcnt(0)
  v_readfirstlane_b32 s22, v37
  s_and_b32 s31, s22, 0xffff
  s_cmp_ge_u32 s31, 32
  s_cbranch_scc1 ch_go1
  s_sleep 2
  s_add_u32 s30, s30, 1
  s_cmp_lt_u32 s30, 50000
  s_cbranch_scc1 ch_md1
  s_branch ch_end
ch_go1:
  s_mov_b32 s31, 0
  s_lshr_b32 s22, s22, 16
  s_cmp_lg_u32 s22, 0
  s_cbranch_scc1 cB_sc1_loop
  s_branch cA_sc1_loop
ch_init2:
  s_mul_i32 s31, s17, 401408
  s_add_u32 s31, s31, 0
  s_mov_b32 s24, 71579648
  s_mov_b32 s25, 0
  s_add_u32 m0, s25, 14336
  s_nop 0
  buffer_load_dwordx4 v2, s[8:11], s24 offen offset:0 sc1 lds
  buffer_load_dwordx4 v2, s[8:11], s24 offen offset:1024 sc1 lds
  buffer_load_dwordx4 v2, s[8:11], s24 offen offset:2048 sc1 lds
  buffer_load_dwordx4 v2, s[8:11], s24 offen offset:3072 sc1 lds
  s_add_u32 m0, s25, 18432
  s_add_u32 s22, s24, 4096
  buffer_load_dwordx4 v2, s[8:11], s22 offen offset:0 sc1 lds
  buffer_load_dwordx4 v2, s[8:11], s22 offen offset:1024 sc1 lds
  buffer_load_dwordx4 v2, s[8:11], s22 offen offset:2048 sc1 lds
  v_lshrrev_b32 v64, 1, v117
  v_and_b32 v65, 1, v116
  v_lshlrev_b32 v65, 2, v65
  v_sub_u32 v64, v64, v65
  v_and_b32 v65, 1, v117
  v_lshl_add_u32 v66, v65, 2, v64
  v_cmp_gt_u32 vcc, 4, v64
  v_mov_b32 v67, 99
  s_nop 0
  v_cndmask_b32 v66, v67, v66, vcc
  v_mov_b32 v68, 0x3f80
  v_mov_b32 v69, 0x3f800000
  v_mov_b32 v4, 0
  v_cmp_eq_u32 vcc, 0, v66
  s_nop 1
  v_cndmask_b32 v4, v4, v68, vcc
  v_cmp_eq_u32 vcc, 1, v66
  s_nop 1
  v_cndmask_b32 v4, v4, v69, vcc
  v_mov_b32 v5, 0
  v_cmp_eq_u32 vcc, 2, v66
  s_nop 1
  v_cndmask_b32 v5, v5, v68, vcc
  v_cmp_eq_u32 vcc, 3, v66
  s_nop 1
  v_cndmask_b32 v5, v5, v69, vcc
  v_mov_b32 v6, 0
  v_cmp_eq_u32 vcc, 4, v66
  s_nop 1
  v_cndmask_b32 v6, v6, v68, vcc
  v_cmp_eq_u32 vcc, 5, v66
  s_nop 1
  v_cndmask_b32 v6, v6, v69, vcc
  v_mov_b32 v7, 0
  v_cmp_eq_u32 vcc, 6, v66
  s_nop 1
  v_cndmask_b32 v7, v7, v68, vcc
  v_cmp_eq_u32 vcc, 7, v66
  s_nop 1
  v_cndmask_b32 v7, v7, v69, vcc
  v_lshrrev_b32 v64, 1, v116
  v_lshrrev_b32 v65, 3, v117
  v_cmp_eq_u32 s[26:27], v64, v65
  v_and_b32 v66, 1, v116
  v_add_u32 v64, 4, v64
  v_lshrrev_b32 v67, 1, v116
  v_lshlrev_b32 v67, 8, v67
  v_lshl_add_u32 v67, v66, 9, v67
  v_lshl_add_u32 v67, v117, 4, v67
  v_add_u32 v112, 59392, v67
  v_and_b32 v68, 7, v117
  v_lshlrev_b32 v67, 8, v64
  v_lshl_add_u32 v67, v68, 5, v67
  v_lshl_add_u32 v67, v66, 4, v67
  v_add_u32 v113, 65536, v67
  v_lshrrev_b32 v64, 5, v1
  v_and_b32 v65, 31, v1
  v_lshrrev_b32 v66, 3, v65
  v_and_b32 v67, 7, v65
  v_and_b32 v68, 3, v67
  v_lshl_add_u32 v68, v66, 2, v68
  v_lshrrev_b32 v69, 2, v67
  v_lshl_add_u32 v68, v69, 4, v68
  v_lshlrev_b32 v69, 11, v64
  v_lshl_add_u32 v69, v68, 4, v69
  v_add_u32 v114, 57856, v69
  v_add_u32 v70, 4, v64
  v_lshlrev_b32 v69, 9, v66
  v_lshl_add_u32 v69, v70, 5, v69
  v_lshl_add_u32 v69, v67, 2, v69
  v_add_u32 v115, 65536, v69
  v_lshlrev_b32 v69, 4, v68
  v_lshl_add_u32 v69, v64, 9, v69
  v_add_u32 v114, 59392, v69
  v_mul_u32_u24 v69, 144, v70
  v_lshl_add_u32 v69, v67, 4, v69
  v_add_u32 v115, 65536, v69
  v_and_b32 v71, 1, v116
  v_mul_u32_u24 v69, 2048, v71
  v_lshl_add_u32 v69, v64, 8, v69
  v_lshl_add_u32 v69, v117, 4, v69
  v_add_u32 v112, 57856, v69
  v_mul_u32_u24 v69, 144, v117
  v_lshl_add_u32 v69, v71, 6, v69
  v_lshl_add_u32 v69, v64, 5, v69
  v_add_u32 v113, 65544, v69
  v_mul_u32_u24 v69, 1024, v116
  v_lshl_add_u32 v69, v117, 4, v69
  v_and_b32 v72, 8, v117
  v_xor_b32 v72, 0, v72
  v_add_u32 v69, v69, v72
  v_add_u32 v112, 57856, v69
  v_lshrrev_b32 v72, 3, v117
  v_lshl_add_u32 v72, v71, 1, v72
  v_xor_b32 v72, 2, v72
  v_lshlrev_b32 v69, 10, v116
  v_lshl_add_u32 v69, v117, 4, v69
  v_lshl_add_u32 v69, v72, 2, v69
  v_add_u32 v112, 57344, v69
  v_lshrrev_b32 v69, 1, v117
  v_and_b32 v72, 1, v117
  v_lshl_add_u32 v69, v72, 3, v69
  v_mul_u32_u24 v69, 144, v69
  v_lshl_add_u32 v69, v71, 6, v69
  v_lshl_add_u32 v69, v64, 5, v69
  v_lshl_add_u32 v72, v72, 1, v71
  v_xor_b32 v72, 2, v72
  v_lshl_add_u32 v69, v72, 2, v69
  v_add_u32 v113, 65536, v69
  v_and_b32 v71, 1, v1
  v_cmp_eq_u32 s[38:39], 0, v71
  v_cmp_gt_u32 vcc, 8, v65
  s_or_b64 s[28:29], s[38:39], vcc
  v_lshrrev_b32 v72, 1, v67
  v_lshlrev_b32 v72, 2, v72
  v_lshl_add_u32 v72, v70, 4, v72
  s_lshl_b32 s22, s17, 9
  s_add_u32 s22, s22, 9216
  v_lshl_add_u32 v73, v66, 7, v72
  v_add_u32 v73, s22, v73
  s_lshl_b32 s22, s17, 7
  s_add_u32 s22, s22, 7168
  v_add_u32 v74, s22, v72
  v_bfe_u32 v72, v65, 1, 1
  v_lshlrev_b32 v72, 7, v72
  v_lshl_add_u32 v72, v70, 4, v72
  v_bfe_u32 v73, v65, 2, 2
  v_lshl_add_u32 v72, v73, 2, v72
  v_lshrrev_b32 v73, 4, v65
  v_lshl_add_u32 v73, v73, 8, v72
  s_lshl_b32 s22, s17, 9
  s_add_u32 s22, s22, 9216
  v_add_u32 v73, s22, v73
  s_lshr_b32 s22, s17, 1
  s_lshl_b32 s22, s22, 8
  s_and_b32 s34, s17, 1
  s_lshl_b32 s34, s34, 3
  s_add_u32 s22, s22, s34
  s_add_u32 s22, s22, 7168
  v_add_u32 v74, s22, v72
  v_bfe_u32 v72, v65, 1, 1
  v_lshl_add_u32 v72, v64, 1, v72
  v_lshlrev_b32 v72, 4, v72
  v_bfe_u32 v73, v65, 2, 2
  v_lshl_add_u32 v72, v73, 2, v72
  v_lshrrev_b32 v73, 4, v65
  v_lshl_add_u32 v73, v73, 6, v72
  s_lshl_b32 s22, s17, 9
  s_add_u32 s22, s22, 9472
  v_add_u32 v73, s22, v73
  v_lshrrev_b32 v72, 1, v65
  v_lshlrev_b32 v72, 2, v72
  v_lshl_add_u32 v72, v64, 5, v72
  s_lshr_b32 s22, s17, 1
  s_lshl_b32 s22, s22, 8
  s_and_b32 s34, s17, 1
  s_lshl_b32 s34, s34, 4
  s_add_u32 s22, s22, s34
  s_add_u32 s22, s22, 7296
  v_add_u32 v74, s22, v72
  v_lshlrev_b32 v0, 2, v65
  v_and_b32 v0, 120, v0
  s_and_b32 s22, s17, 15
  s_lshl_b32 s22, s22, 7
  s_add_u32 s22, s22, 18432
  v_add_u32 v0, s22, v0
  v_cndmask_b32 v1, v74, v73, s[38:39]
  s_lshl_b32 s36, s17, 2
  s_add_u32 s36, s36, 17472
  s_mov_b32 s37, 0x3e800000
  v_mov_b32 v64, 0
  v_mov_b32 v65, 0
  v_mov_b32 v66, 0
  v_mov_b32 v67, 0
  v_mov_b32 v68, 0
  v_mov_b32 v69, 0
  v_mov_b32 v70, 0
  v_mov_b32 v71, 0
  v_mov_b32 v72, 0
  v_mov_b32 v73, 0
  v_mov_b32 v74, 0
  v_mov_b32 v75, 0
  v_mov_b32 v76, 0
  v_mov_b32 v77, 0
  v_mov_b32 v78, 0
  v_mov_b32 v79, 0
  v_mov_b32 v80, 0
  v_mov_b32 v81, 0
  v_mov_b32 v82, 0
  v_mov_b32 v83, 0
  v_mov_b32 v84, 0
  v_mov_b32 v85, 0
  v_mov_b32 v86, 0
  v_mov_b32 v87, 0
  v_mov_b32 v88, 0
  v_mov_b32 v89, 0
  v_mov_b32 v90, 0
  v_mov_b32 v91, 0
  v_mov_b32 v92, 0
  v_mov_b32 v93, 0
  v_mov_b32 v94, 0
  v_mov_b32 v95, 0
  v_mov_b32 v96, 0
  v_mov_b32 v97, 0
  v_mov_b32 v98, 0
  v_mov_b32 v99, 0
  v_mov_b32 v100, 0
  v_mov_b32 v101, 0
  v_mov_b32 v102, 0
  v_mov_b32 v103, 0
  v_mov_b32 v104, 0
  v_mov_b32 v105, 0
  v_mov_b32 v106, 0
  v_mov_b32 v107, 0
  v_mov_b32 v108, 0
  v_mov_b32 v109, 0
  v_mov_b32 v110, 0
  v_mov_b32 v111, 0
  v_and_b32 v118, 1, v116
  v_cmp_eq_u32 vcc, 0, v118
  v_mov_b32 v118, 12544
  v_mov_b32 v119, 10240
  v_cndmask_b32 v118, v118, v119, vcc
  v_lshrrev_b32 v116, 1, v116
  v_lshl_add_u32 v118, v116, 9, v118
  v_lshl_add_u32 v117, v117, 4, v118
  s_mov_b32 s57, 28672
  v_bfe_u32 v118, v2, 4, 1
  v_mul_u32_u24 v118, 0xaaaa, v118
  v_add_u32 v118, 0x4444, v118
  s_mov_b32 s56, 0x42800000
  v_mov_b32 v116, v2
  v_lshrrev_b32 v0, 4, v2
  v_min_u32 v0, 13, v0
  s_mul_i32 s22, s17, 14
  v_add_u32 v0, s22, v0
  v_lshlrev_b32 v0, 7, v0
  v_add_u32 v0, 43008, v0
  s_mov_b32 s22, 71550976
  buffer_load_dword v119, v0, s[8:11], s22 offen sc1
  s_mov_b32 s22, 71522304
  buffer_load_dword v119, v0, s[8:11], s22 offen sc1
  s_mul_i32 s35, s17, 1835008
  s_add_u32 s35, s35, 42276864
  s_mov_b32 s30, 0
  v_mov_b32 v36, 0
ch_md2:
  buffer_load_dword v37, v36, s[12:15], 0 offen sc1
  s_waitcnt vmcnt(0)
  v_readfirstlane_b32 s22, v37
  s_and_b32 s31, s22, 0xffff
  s_cmp_ge_u32 s31, 32
  s_cbranch_scc1 ch_go2
  s_sleep 2
  s_add_u32 s30, s30, 1
  s_cmp_lt_u32 s30, 50000
  s_cbranch_scc1 ch_md2
  s_branch ch_end
ch_go2:
  s_mov_b32 s31, 0
  s_lshr_b32 s22, s22, 16
  s_cmp_lg_u32 s22, 0
  s_cbranch_scc1 cB_sc2_loop
  s_branch cA_sc2_loop
ch_init3:
  s_mul_i32 s31, s17, 401408
  s_add_u32 s31, s31, 0
  s_mov_b32 s24, 71586816
  s_mov_b32 s25, 0
  s_add_u32 m0, s25, 21504
  s_nop 0
  buffer_load_dwordx4 v2, s[8:11], s24 offen offset:0 sc1 lds
  buffer_load_dwordx4 v2, s[8:11], s24 offen offset:1024 sc1 lds
  buffer_load_dwordx4 v2, s[8:11], s24 offen offset:2048 sc1 lds
  buffer_load_dwordx4 v2, s[8:11], s24 offen offset:3072 sc1 lds
  s_add_u32 m0, s25, 25600
  s_add_u32 s22, s24, 4096
  buffer_load_dwordx4 v2, s[8:11], s22 offen offset:0 sc1 lds
  buffer_load_dwordx4 v2, s[8:11], s22 offen offset:1024 sc1 lds
  buffer_load_dwordx4 v2, s[8:11], s22 offen offset:2048 sc1 lds
  v_lshrrev_b32 v64, 1, v117
  v_and_b32 v65, 1, v116
  v_lshlrev_b32 v65, 2, v65
  v_sub_u32 v64, v64, v65
  v_and_b32 v65, 1, v117
  v_lshl_add_u32 v66, v65, 2, v64
  v_cmp_gt_u32 vcc, 4, v64
  v_mov_b32 v67, 99
  s_nop 0
  v_cndmask_b32 v66, v67, v66, vcc
  v_mov_b32 v68, 0x3f80
  v_mov_b32 v69, 0x3f800000
  v_mov_b32 v4, 0
  v_cmp_eq_u32 vcc, 0, v66
  s_nop 1
  v_cndmask_b32 v4, v4, v68, vcc
  v_cmp_eq_u32 vcc, 1, v66
  s_nop 1
  v_cndmask_b32 v4, v4, v69, vcc
  v_mov_b32 v5, 0
  v_cmp_eq_u32 vcc, 2, v66
  s_nop 1
  v_cndmask_b32 v5, v5, v68, vcc
  v_cmp_eq_u32 vcc, 3, v66
  s_nop 1
  v_cndmask_b32 v5, v5, v69, vcc
  v_mov_b32 v6, 0
  v_cmp_eq_u32 vcc, 4, v66
  s_nop 1
  v_cndmask_b32 v6, v6, v68, vcc
  v_cmp_eq_u32 vcc, 5, v66
  s_nop 1
  v_cndmask_b32 v6, v6, v69, vcc
  v_mov_b32 v7, 0
  v_cmp_eq_u32 vcc, 6, v66
  s_nop 1
  v_cndmask_b32 v7, v7, v68, vcc
  v_cmp_eq_u32 vcc, 7, v66
  s_nop 1
  v_cndmask_b32 v7, v7, v69, vcc
  v_lshrrev_b32 v64, 1, v116
  v_lshrrev_b32 v65, 3, v117
  v_cmp_eq_u32 s[26:27], v64, v65
  v_and_b32 v66, 1, v116
  v_add_u32 v64, 6, v64
  v_lshrrev_b32 v67, 1, v116
  v_lshlrev_b32 v67, 8, v67
  v_lshl_add_u32 v67, v66, 9, v67
  v_lshl_add_u32 v67, v117, 4, v67
  v_add_u32 v112, 60416, v67
  v_and_b32 v68, 7, v117
  v_lshlrev_b32 v67, 8, v64
  v_lshl_add_u32 v67, v68, 5, v67
  v_lshl_add_u32 v67, v66, 4, v67
  v_add_u32 v113, 65536, v67
  v_lshrrev_b32 v64, 5, v1
  v_and_b32 v65, 31, v1
  v_lshrrev_b32 v66, 3, v65
  v_and_b32 v67, 7, v65
  v_and_b32 v68, 3, v67
  v_lshl_add_u32 v68, v66, 2, v68
  v_lshrrev_b32 v69, 2, v67
  v_lshl_add_u32 v68, v69, 4, v68
  v_lshlrev_b32 v69, 11, v64
  v_lshl_add_u32 v69, v68, 4, v69
  v_add_u32 v114, 57864, v69
  v_add_u32 v70, 6, v64
  v_lshlrev_b32 v69, 9, v66
  v_lshl_add_u32 v69, v70, 5, v69
  v_lshl_add_u32 v69, v67, 2, v69
  v_add_u32 v115, 65536, v69
  v_lshlrev_b32 v69, 4, v68
  v_lshl_add_u32 v69, v64, 9, v69
  v_add_u32 v114, 60416, v69
  v_mul_u32_u24 v69, 144, v70
  v_lshl_add_u32 v69, v67, 4, v69
  v_add_u32 v115, 65536, v69
  v_and_b32 v71, 1, v116
  v_mul_u32_u24 v69, 2048, v71
  v_lshl_add_u32 v69, v64, 8, v69
  v_lshl_add_u32 v69, v117, 4, v69
  v_add_u32 v112, 57864, v69
  v_mul_u32_u24 v69, 144, v117
  v_lshl_add_u32 v69, v71, 6, v69
  v_lshl_add_u32 v69, v64, 5, v69
  v_add_u32 v113, 65548, v69
  v_mul_u32_u24 v69, 1024, v116
  v_lshl_add_u32 v69, v117, 4, v69
  v_and_b32 v72, 8, v117
  v_xor_b32 v72, 8, v72
  v_add_u32 v69, v69, v72
  v_add_u32 v112, 57856, v69
  v_lshrrev_b32 v72, 3, v117
  v_lshl_add_u32 v72, v71, 1, v72
  v_xor_b32 v72, 3, v72
  v_lshlrev_b32 v69, 10, v116
  v_lshl_add_u32 v69, v117, 4, v69
  v_lshl_add_u32 v69, v72, 2, v69
  v_add_u32 v112, 57344, v69
  v_lshrrev_b32 v69, 1, v117
  v_and_b32 v72, 1, v117
  v_lshl_add_u32 v69, v72, 3, v69
  v_mul_u32_u24 v69, 144, v69
  v_lshl_add_u32 v69, v71, 6, v69
  v_lshl_add_u32 v69, v64, 5, v69
  v_lshl_add_u32 v72, v72, 1, v71
  v_xor_b32 v72, 3, v72
  v_lshl_add_u32 v69, v72, 2, v69
  v_add_u32 v113, 65536, v69
  v_and_b32 v71, 1, v1
  v_cmp_eq_u32 s[38:39], 0, v71
  v_cmp_gt_u32 vcc, 8, v65
  s_or_b64 s[28:29], s[38:39], vcc
  v_lshrrev_b32 v72, 1, v67
  v_lshlrev_b32 v72, 2, v72
  v_lshl_add_u32 v72, v70, 4, v72
  s_lshl_b32 s22, s17, 9
  s_add_u32 s22, s22, 9216
  v_lshl_add_u32 v73, v66, 7, v72
  v_add_u32 v73, s22, v73
  s_lshl_b32 s22, s17, 7
  s_add_u32 s22, s22, 7168
  v_add_u32 v74, s22, v72
  v_bfe_u32 v72, v65, 1, 1
  v_lshlrev_b32 v72, 7, v72
  v_lshl_add_u32 v72, v70, 4, v72
  v_bfe_u32 v73, v65, 2, 2
  v_lshl_add_u32 v72, v73, 2, v72
  v_lshrrev_b32 v73, 4, v65
  v_lshl_add_u32 v73, v73, 8, v72
  s_lshl_b32 s22, s17, 9
  s_add_u32 s22, s22, 9216
  v_add_u32 v73, s22, v73
  s_lshr_b32 s22, s17, 1
  s_lshl_b32 s22, s22, 8
  s_and_b32 s34, s17, 1
  s_lshl_b32 s34, s34, 3
  s_add_u32 s22, s22, s34
  s_add_u32 s22, s22, 7168
  v_add_u32 v74, s22, v72
  v_bfe_u32 v72, v65, 1, 1
  v_lshl_add_u32 v72, v64, 1, v72
  v_lshlrev_b32 v72, 4, v72
  v_bfe_u32 v73, v65, 2, 2
  v_lshl_add_u32 v72, v73, 2, v72
  v_lshrrev_b32 v73, 4, v65
  v_lshl_add_u32 v73, v73, 6, v72
  s_lshl_b32 s22, s17, 9
  s_add_u32 s22, s22, 9600
  v_add_u32 v73, s22, v73
  v_lshrrev_b32 v72, 1, v65
  v_lshlrev_b32 v72, 2, v72
  v_lshl_add_u32 v72, v64, 5, v72
  s_lshr_b32 s22, s17, 1
  s_lshl_b32 s22, s22, 8
  s_and_b32 s34, s17, 1
  s_lshl_b32 s34, s34, 4
  s_add_u32 s22, s22, s34
  s_add_u32 s22, s22, 7360
  v_add_u32 v74, s22, v72
  v_lshlrev_b32 v0, 2, v65
  v_and_b32 v0, 120, v0
  s_and_b32 s22, s17, 15
  s_lshl_b32 s22, s22, 7
  s_add_u32 s22, s22, 18432
  v_add_u32 v0, s22, v0
  v_cndmask_b32 v1, v74, v73, s[38:39]
  s_lshl_b32 s36, s17, 2
  s_add_u32 s36, s36, 17472
  s_mov_b32 s37, 0x3e800000
  v_mov_b32 v64, 0
  v_mov_b32 v65, 0
  v_mov_b32 v66, 0
  v_mov_b32 v67, 0
  v_mov_b32 v68, 0
  v_mov_b32 v69, 0
  v_mov_b32 v70, 0
  v_mov_b32 v71, 0
  v_mov_b32 v72, 0
  v_mov_b32 v73, 0
  v_mov_b32 v74, 0
  v_mov_b32 v75, 0
  v_mov_b32 v76, 0
  v_mov_b32 v77, 0
  v_mov_b32 v78, 0
  v_mov_b32 v79, 0
  v_mov_b32 v80, 0
  v_mov_b32 v81, 0
  v_mov_b32 v82, 0
  v_mov_b32 v83, 0
  v_mov_b32 v84, 0
  v_mov_b32 v85, 0
  v_mov_b32 v86, 0
  v_mov_b32 v87, 0
  v_mov_b32 v88, 0
  v_mov_b32 v89, 0
  v_mov_b32 v90, 0
  v_mov_b32 v91, 0
  v_mov_b32 v92, 0
  v_mov_b32 v93, 0
  v_mov_b32 v94, 0
  v_mov_b32 v95, 0
  v_mov_b32 v96, 0
  v_mov_b32 v97, 0
  v_mov_b32 v98, 0
  v_mov_b32 v99, 0
  v_mov_b32 v100, 0
  v_mov_b32 v101, 0
  v_mov_b32 v102, 0
  v_mov_b32 v103, 0
  v_mov_b32 v104, 0
  v_mov_b32 v105, 0
  v_mov_b32 v106, 0
  v_mov_b32 v107, 0
  v_mov_b32 v108, 0
  v_mov_b32 v109, 0
  v_mov_b32 v110, 0
  v_mov_b32 v111, 0
  v_and_b32 v118, 1, v116
  v_cmp_eq_u32 vcc, 0, v118
  v_mov_b32 v118, 12544
  v_mov_b32 v119, 10496
  v_cndmask_b32 v118, v118, v119, vcc
  v_lshrrev_b32 v116, 1, v116
  v_lshl_add_u32 v118, v116, 9, v118
  v_lshl_add_u32 v117, v117, 4, v118
  s_mov_b32 s57, 28672
  v_bfe_u32 v118, v2, 4, 1
  v_mul_u32_u24 v118, 0xaaaa, v118
  v_add_u32 v118, 0x4444, v118
  s_mov_b32 s56, 0x42800000
  v_mov_b32 v116, v2
  s_mul_i32 s35, s17, 1835008
  s_add_u32 s35, s35, 42284032
  s_mov_b32 s30, 0
  v_mov_b32 v36, 0
ch_md3:
  buffer_load_dword v37, v36, s[12:15], 0 offen sc1
  s_waitcnt vmcnt(0)
  v_readfirstlane_b32 s22, v37
  s_and_b32 s31, s22, 0xffff
  s_cmp_ge_u32 s31, 32
  s_cbranch_scc1 ch_go3
  s_sleep 2
  s_add_u32 s30, s30, 1
  s_cmp_lt_u32 s30, 50000
  s_cbranch_scc1 ch_md3
  s_branch ch_end
ch_go3:
  s_mov_b32 s31, 0
  s_lshr_b32 s22, s22, 16
  s_cmp_lg_u32 s22, 0
  s_cbranch_scc1 cB_sc3_loop
  s_branch cA_sc3_loop
ch_init4:
  s_mul_i32 s31, s17, 401408
  s_add_u32 s31, s31, 6422528
  s_mul_i32 s22, s17, 12
  s_add_u32 s23, s22, 267
  s_add_u32 s22, s22, 256
  v_mov_b32 v36, s23
  v_mov_b32 v37, s22
  v_cmp_eq_u32 vcc, 1, v116
  s_lshl_b32 s22, s17, 4
  s_nop 0
  v_cndmask_b32 v36, v36, v37, vcc
  v_mov_b32 v37, s22
  v_cmp_eq_u32 vcc, 0, v116
  s_nop 1
  v_cndmask_b32 v36, v36, v37, vcc
  v_lshrrev_b32 v36, 6, v36
  v_lshlrev_b32 v36, 8, v36
  v_med3_u32 v37, v117, 0, 3
  v_lshl_add_u32 v36, v37, 4, v36
  s_mov_b32 s22, 88600576
  s_mov_b32 s30, 0
va_bw_11:
  buffer_load_dwordx4 v[40:43], v36, s[8:11], s22 offen sc1
  s_waitcnt vmcnt(0)
  v_cmp_ne_u64 vcc, s[88:89], v[40:41]
  s_cbranch_vccnz va_bw_11_no
  v_cmp_ne_u64 vcc, s[88:89], v[42:43]
  s_cbranch_vccnz va_bw_11_no
  s_branch va_bw_11_ok
va_bw_11_no:
  s_sleep 2
  s_add_u32 s30, s30, 1
  s_cmp_lt_u32 s30, 50000
  s_cbranch_scc1 va_bw_11
  s_branch cA_abort
va_bw_11_ok:
  s_add_u32 s22, s31, 0
  buffer_load_dwordx4 a[0:3], v2, s[8:11], s22 offen offset:0 sc1
  buffer_load_dwordx4 a[4:7], v2, s[8:11], s22 offen offset:1024 sc1
  buffer_load_dwordx4 a[8:11], v2, s[8:11], s22 offen offset:2048 sc1
  buffer_load_dwordx4 a[12:15], v2, s[8:11], s22 offen offset:3072 sc1
  s_add_u32 s22, s31, 4096
  buffer_load_dwordx4 a[16:19], v2, s[8:11], s22 offen offset:0 sc1
  buffer_load_dwordx4 a[20:23], v2, s[8:11], s22 offen offset:1024 sc1
  buffer_load_dwordx4 a[24:27], v2, s[8:11], s22 offen offset:2048 sc1
  buffer_load_dwordx4 a[28:31], v2, s[8:11], s22 offen offset:3072 sc1
  s_add_u32 s22, s31, 8192
  buffer_load_dwordx4 a[32:35], v2, s[8:11], s22 offen offset:0 sc1
  buffer_load_dwordx4 a[36:39], v2, s[8:11], s22 offen offset:1024 sc1
  buffer_load_dwordx4 a[40:43], v2, s[8:11], s22 offen offset:2048 sc1
  buffer_load_dwordx4 a[44:47], v2, s[8:11], s22 offen offset:3072 sc1
  s_add_u32 s22, s31, 12288
  buffer_load_dwordx4 a[48:51], v2, s[8:11], s22 offen offset:0 sc1
  buffer_load_dwordx4 a[52:55], v2, s[8:11], s22 offen offset:1024 sc1
  buffer_load_dwordx4 a[56:59], v2, s[8:11], s22 offen offset:2048 sc1
  buffer_load_dwordx4 a[60:63], v2, s[8:11], s22 offen offset:3072 sc1
  s_add_u32 s22, s31, 16384
  buffer_load_dwordx4 a[64:67], v2, s[8:11], s22 offen offset:0 sc1
  buffer_load_dwordx4 a[68:71], v2, s[8:11], s22 offen offset:1024 sc1
  buffer_load_dwordx4 a[72:75], v2, s[8:11], s22 offen offset:2048 sc1
  buffer_load_dwordx4 a[76:79], v2, s[8:11], s22 offen offset:3072 sc1
  s_add_u32 s22, s31, 20480
  buffer_load_dwordx4 a[80:83], v2, s[8:11], s22 offen offset:0 sc1
  buffer_load_dwordx4 a[84:87], v2, s[8:11], s22 offen offset:1024 sc1
  buffer_load_dwordx4 a[88:91], v2, s[8:11], s22 offen offset:2048 sc1
  buffer_load_dwordx4 a[92:95], v2, s[8:11], s22 offen offset:3072 sc1
  s_add_u32 s22, s31, 24576
  buffer_load_dwordx4 a[96:99], v2, s[8:11], s22 offen offset:0 sc1
  buffer_load_dwordx4 a[100:103], v2, s[8:11], s22 offen offset:1024 sc1
  buffer_load_dwordx4 a[104:107], v2, s[8:11], s22 offen offset:2048 sc1
  buffer_load_dwordx4 a[108:111], v2, s[8:11], s22 offen offset:3072 sc1
  s_add_u32 s22, s31, 28672
  buffer_load_dwordx4 a[112:115], v2, s[8:11], s22 offen offset:0 sc1
  buffer_load_dwordx4 a[116:119], v2, s[8:11], s22 offen offset:1024 sc1
  buffer_load_dwordx4 a[120:123], v2, s[8:11], s22 offen offset:2048 sc1
  buffer_load_dwordx4 a[124:127], v2, s[8:11], s22 offen offset:3072 sc1
  s_waitcnt vmcnt(24)
  s_add_u32 s22, s31, 32768
  buffer_load_dwordx4 a[128:131], v2, s[8:11], s22 offen offset:0 sc1
  buffer_load_dwordx4 a[132:135], v2, s[8:11], s22 offen offset:1024 sc1
  buffer_load_dwordx4 a[136:139], v2, s[8:11], s22 offen offset:2048 sc1
  buffer_load_dwordx4 a[140:143], v2, s[8:11], s22 offen offset:3072 sc1
  s_add_u32 s22, s31, 36864
  buffer_load_dwordx4 a[144:147], v2, s[8:11], s22 offen offset:0 sc1
  buffer_load_dwordx4 a[148:151], v2, s[8:11], s22 offen offset:1024 sc1
  buffer_load_dwordx4 a[152:155], v2, s[8:11], s22 offen offset:2048 sc1
  buffer_load_dwordx4 a[156:159], v2, s[8:11], s22 offen offset:3072 sc1
  s_add_u32 s22, s31, 40960
  buffer_load_dwordx4 a[160:163], v2, s[8:11], s22 offen offset:0 sc1
  buffer_load_dwordx4 a[164:167], v2, s[8:11], s22 offen offset:1024 sc1
  buffer_load_dwordx4 a[168:171], v2, s[8:11], s22 offen offset:2048 sc1
  buffer_load_dwordx4 a[172:175], v2, s[8:11], s22 offen offset:3072 sc1
  s_add_u32 s22, s31, 45056
  buffer_load_dwordx4 a[176:179], v2, s[8:11], s22 offen offset:0 sc1
  buffer_load_dwordx4 a[180:183], v2, s[8:11], s22 offen offset:1024 sc1
  buffer_load_dwordx4 a[184:187], v2, s[8:11], s22 offen offset:2048 sc1
  buffer_load_dwordx4 a[188:191], v2, s[8:11], s22 offen offset:3072 sc1
  s_add_u32 s22, s31, 49152
  buffer_load_dwordx4 a[192:195], v2, s[8:11], s22 offen offset:0 sc1
  buffer_load_dwordx4 a[196:199], v2, s[8:11], s22 offen offset:1024 sc1
  buffer_load_dwordx4 a[200:203], v2, s[8:11], s22 offen offset:2048 sc1
  buffer_load_dwordx4 a[204:207], v2, s[8:11], s22 offen offset:3072 sc1
  s_add_u32 s22, s31, 53248
  buffer_load_dwordx4 a[208:211], v2, s[8:11], s22 offen offset:0 sc1
  buffer_load_dwordx4 a[212:215], v2, s[8:11], s22 offen offset:1024 sc1
  buffer_load_dwordx4 a[216:219], v2, s[8:11], s22 offen offset:2048 sc1
  buffer_load_dwordx4 a[220:223], v2, s[8:11], s22 offen offset:3072 sc1
  s_add_u32 s22, s31, 57344
  buffer_load_dwordx4 a[224:227], v2, s[8:11], s22 offen offset:0 sc1
  buffer_load_dwordx4 a[228:231], v2, s[8:11], s22 offen offset:1024 sc1
  buffer_load_dwordx4 a[232:235], v2, s[8:11], s22 offen offset:2048 sc1
  buffer_load_dwordx4 a[236:239], v2, s[8:11], s22 offen offset:3072 sc1
  s_add_u32 s22, s31, 61440
  buffer_load_dwordx4 a[240:243], v2, s[8:11], s22 offen offset:0 sc1
  buffer_load_dwordx4 a[244:247], v2, s[8:11], s22 offen offset:1024 sc1
  buffer_load_dwordx4 a[248:251], v2, s[8:11], s22 offen offset:2048 sc1
  buffer_load_dwordx4 a[252:255], v2, s[8:11], s22 offen offset:3072 sc1
  s_waitcnt vmcnt(24)
  s_add_u32 s22, s31, 65536
  buffer_load_dwordx4 v[176:179], v2, s[8:11], s22 offen offset:0 sc1
  buffer_load_dwordx4 v[180:183], v2, s[8:11], s22 offen offset:1024 sc1
  buffer_load_dwordx4 v[184:187], v2, s[8:11], s22 offen offset:2048 sc1
  buffer_load_dwordx4 v[188:191], v2, s[8:11], s22 offen offset:3072 sc1
  s_add_u32 s22, s31, 69632
  buffer_load_dwordx4 v[192:195], v2, s[8:11], s22 offen offset:0 sc1
  buffer_load_dwordx4 v[196:199], v2, s[8:11], s22 offen offset:1024 sc1
  buffer_load_dwordx4 v[200:203], v2, s[8:11], s22 offen offset:2048 sc1
  buffer_load_dwordx4 v[204:207], v2, s[8:11], s22 offen offset:3072 sc1
  s_add_u32 s22, s31, 73728
  buffer_load_dwordx4 v[208:211], v2, s[8:11], s22 offen offset:0 sc1
  buffer_load_dwordx4 v[212:215], v2, s[8:11], s22 offen offset:1024 sc1
  buffer_load_dwordx4 v[216:219], v2, s[8:11], s22 offen offset:2048 sc1
  buffer_load_dwordx4 v[220:223], v2, s[8:11], s22 offen offset:3072 sc1
  s_add_u32 s22, s31, 77824
  buffer_load_dwordx4 v[224:227], v2, s[8:11], s22 offen offset:0 sc1
  buffer_load_dwordx4 v[228:231], v2, s[8:11], s22 offen offset:1024 sc1
  buffer_load_dwordx4 v[232:235], v2, s[8:11], s22 offen offset:2048 sc1
  buffer_load_dwordx4 v[236:239], v2, s[8:11], s22 offen offset:3072 sc1
  s_add_u32 s22, s31, 81920
  buffer_load_dwordx4 v[240:243], v2, s[8:11], s22 offen offset:0 sc1
  buffer_load_dwordx4 v[244:247], v2, s[8:11], s22 offen offset:1024 sc1
  buffer_load_dwordx4 v[248:251], v2, s[8:11], s22 offen offset:2048 sc1
  buffer_load_dwordx4 v[252:255], v2, s[8:11], s22 offen offset:3072 sc1
  s_mul_i32 s22, s17, 12
  s_add_u32 s23, s22, 267
  s_add_u32 s22, s22, 256
  v_mov_b32 v36, s23
  v_mov_b32 v37, s22
  v_cmp_eq_u32 vcc, 1, v116
  s_lshl_b32 s22, s17, 4
  s_nop 0
  v_cndmask_b32 v36, v36, v37, vcc
  v_mov_b32 v37, s22
  v_cmp_eq_u32 vcc, 0, v116
  s_nop 1
  v_cndmask_b32 v36, v36, v37, vcc
  v_lshrrev_b32 v36, 6, v36
  v_lshlrev_b32 v36, 8, v36
  v_med3_u32 v37, v117, 10, 11
  v_lshl_add_u32 v36, v37, 4, v36
  s_mov_b32 s22, 88600576
  s_mov_b32 s30, 0
va_bw_12:
  buffer_load_dwordx4 v[40:43], v36, s[8:11], s22 offen sc1
  s_waitcnt vmcnt(0)
  v_cmp_ne_u64 vcc, s[88:89], v[40:41]
  s_cbranch_vccnz va_bw_12_no
  v_cmp_ne_u64 vcc, s[88:89], v[42:43]
  s_cbranch_vccnz va_bw_12_no
  s_branch va_bw_12_ok
va_bw_12_no:
  s_sleep 2
  s_add_u32 s30, s30, 1
  s_cmp_lt_u32 s30, 50000
  s_cbranch_scc1 va_bw_12
  s_branch cA_abort
va_bw_12_ok:
  s_mov_b32 m0, 16384
  s_add_u32 s22, s31, 272384
  buffer_load_dwordx4 v2, s[8:11], s22 offen offset:0 sc1 lds
  buffer_load_dwordx4 v2, s[8:11], s22 offen offset:1024 sc1 lds
  buffer_load_dwordx4 v2, s[8:11], s22 offen offset:2048 sc1 lds
  buffer_load_dwordx4 v2, s[8:11], s22 offen offset:3072 sc1 lds
  s_mov_b32 m0, 20480
  s_add_u32 s22, s31, 276480
  buffer_load_dwordx4 v2, s[8:11], s22 offen offset:0 sc1 lds
  buffer_load_dwordx4 v2, s[8:11], s22 offen offset:1024 sc1 lds
  buffer_load_dwordx4 v2, s[8:11], s22 offen offset:2048 sc1 lds
  buffer_load_dwordx4 v2, s[8:11], s22 offen offset:3072 sc1 lds
  s_mov_b32 m0, 24576
  s_add_u32 s22, s31, 280576
  buffer_load_dwordx4 v2, s[8:11], s22 offen offset:0 sc1 lds
  buffer_load_dwordx4 v2, s[8:11], s22 offen offset:1024 sc1 lds
  buffer_load_dwordx4 v2, s[8:11], s22 offen offset:2048 sc1 lds
  buffer_load_dwordx4 v2, s[8:11], s22 offen offset:3072 sc1 lds
  s_mov_b32 m0, 28672
  s_add_u32 s22, s31, 284672
  buffer_load_dwordx4 v2, s[8:11], s22 offen offset:0 sc1 lds
  buffer_load_dwordx4 v2, s[8:11], s22 offen offset:1024 sc1 lds
  v_mov_b32 v72, v116
  v_mov_b32 v73, v117
  v_lshrrev_b32 v65, 1, v72
  v_and_b32 v66, 1, v72
  v_mov_b32 v67, 0
  v_lshl_add_u32 v67, v67, 4, v73
  v_mul_u32_u24 v68, 2341, v67
  v_lshrrev_b32 v68, 16, v68
  v_mul_u32_u24 v69, 28, v68
  v_sub_u32 v69, v67, v69
  v_lshrrev_b32 v70, 4, v69
  v_and_b32 v69, 15, v69
  v_and_b32 v71, 1, v69
  v_lshrrev_b32 v69, 1, v69
  v_lshl_add_u32 v69, v71, 3, v69
  v_lshlrev_b32 v71, 12, v70
  v_lshrrev_b32 v70, 1, v68
  v_lshl_add_u32 v71, v70, 9, v71
  v_and_b32 v70, 1, v68
  v_lshl_add_u32 v71, v70, 2, v71
  v_lshl_add_u32 v71, v69, 4, v71
  v_lshl_add_u32 v71, v65, 8, v71
  v_lshl_add_u32 v60, v66, 3, v71
  v_mov_b32 v67, 1
  v_lshl_add_u32 v67, v67, 4, v73
  v_mul_u32_u24 v68, 2341, v67
  v_lshrrev_b32 v68, 16, v68
  v_mul_u32_u24 v69, 28, v68
  v_sub_u32 v69, v67, v69
  v_lshrrev_b32 v70, 4, v69
  v_and_b32 v69, 15, v69
  v_and_b32 v71, 1, v69
  v_lshrrev_b32 v69, 1, v69
  v_lshl_add_u32 v69, v71, 3, v69
  v_lshlrev_b32 v71, 12, v70
  v_lshrrev_b32 v70, 1, v68
  v_lshl_add_u32 v71, v70, 9, v71
  v_and_b32 v70, 1, v68
  v_lshl_add_u32 v71, v70, 2, v71
  v_lshl_add_u32 v71, v69, 4, v71
  v_lshl_add_u32 v71, v65, 8, v71
  v_lshl_add_u32 v61, v66, 3, v71
  v_mov_b32 v67, 2
  v_lshl_add_u32 v67, v67, 4, v73
  v_mul_u32_u24 v68, 2341, v67
  v_lshrrev_b32 v68, 16, v68
  v_mul_u32_u24 v69, 28, v68
  v_sub_u32 v69, v67, v69
  v_lshrrev_b32 v70, 4, v69
  v_and_b32 v69, 15, v69
  v_and_b32 v71, 1, v69
  v_lshrrev_b32 v69, 1, v69
  v_lshl_add_u32 v69, v71, 3, v69
  v_lshlrev_b32 v71, 12, v70
  v_lshrrev_b32 v70, 1, v68
  v_lshl_add_u32 v71, v70, 9, v71
  v_and_b32 v70, 1, v68
  v_lshl_add_u32 v71, v70, 2, v71
  v_lshl_add_u32 v71, v69, 4, v71
  v_lshl_add_u32 v71, v65, 8, v71
  v_lshl_add_u32 v62, v66, 3, v71
  v_mov_b32 v67, 3
  v_lshl_add_u32 v67, v67, 4, v73
  v_mul_u32_u24 v68, 2341, v67
  v_lshrrev_b32 v68, 16, v68
  v_mul_u32_u24 v69, 28, v68
  v_sub_u32 v69, v67, v69
  v_lshrrev_b32 v70, 4, v69
  v_and_b32 v69, 15, v69
  v_and_b32 v71, 1, v69
  v_lshrrev_b32 v69, 1, v69
  v_lshl_add_u32 v69, v71, 3, v69
  v_lshlrev_b32 v71, 12, v70
  v_lshrrev_b32 v70, 1, v68
  v_lshl_add_u32 v71, v70, 9, v71
  v_and_b32 v70, 1, v68
  v_lshl_add_u32 v71, v70, 2, v71
  v_lshl_add_u32 v71, v69, 4, v71
  v_lshl_add_u32 v71, v65, 8, v71
  v_lshl_add_u32 v170, v66, 3, v71
  v_mov_b32 v67, 4
  v_lshl_add_u32 v67, v67, 4, v73
  v_mul_u32_u24 v68, 2341, v67
  v_lshrrev_b32 v68, 16, v68
  v_mul_u32_u24 v69, 28, v68
  v_sub_u32 v69, v67, v69
  v_lshrrev_b32 v70, 4, v69
  v_and_b32 v69, 15, v69
  v_and_b32 v71, 1, v69
  v_lshrrev_b32 v69, 1, v69
  v_lshl_add_u32 v69, v71, 3, v69
  v_lshlrev_b32 v71, 12, v70
  v_lshrrev_b32 v70, 1, v68
  v_lshl_add_u32 v71, v70, 9, v71
  v_and_b32 v70, 1, v68
  v_lshl_add_u32 v71, v70, 2, v71
  v_lshl_add_u32 v71, v69, 4, v71
  v_lshl_add_u32 v71, v65, 8, v71
  v_lshl_add_u32 v171, v66, 3, v71
  v_mov_b32 v67, 5
  v_lshl_add_u32 v67, v67, 4, v73
  v_mul_u32_u24 v68, 2341, v67
  v_lshrrev_b32 v68, 16, v68
  v_mul_u32_u24 v69, 28, v68
  v_sub_u32 v69, v67, v69
  v_lshrrev_b32 v70, 4, v69
  v_and_b32 v69, 15, v69
  v_and_b32 v71, 1, v69
  v_lshrrev_b32 v69, 1, v69
  v_lshl_add_u32 v69, v71, 3, v69
  v_lshlrev_b32 v71, 12, v70
  v_lshrrev_b32 v70, 1, v68
  v_lshl_add_u32 v71, v70, 9, v71
  v_and_b32 v70, 1, v68
  v_lshl_add_u32 v71, v70, 2, v71
  v_lshl_add_u32 v71, v69, 4, v71
  v_lshl_add_u32 v71, v65, 8, v71
  v_lshl_add_u32 v172, v66, 3, v71
  v_and_b32 v0, 31, v1
  v_lshlrev_b32 v0, 2, v0
  v_add_u32 v0, 18432, v0
  v_min_u32 v4, 15, v73
  v_lshlrev_b32 v4, 2, v4
  s_and_b32 s22, s17, 3
  s_lshl_b32 s22, s22, 7
  s_add_u32 s22, s22, 17408
  v_add_u32 v4, s22, v4
  v_and_b32 v64, 7, v73
  v_lshlrev_b32 v5, 4, v64
  v_lshl_add_u32 v5, v72, 7, v5
  v_lshrrev_b32 v65, 3, v73
  v_lshl_add_u32 v5, v65, 9, v5
  s_lshl_b32 s22, s17, 3
  s_add_u32 s22, s22, 18432
  v_lshl_add_u32 v7, v2, 3, s22
  v_add_u32 v65, 0, v73
  v_min_u32 v65, 27, v65
  v_mad_u32_u24 v65, v72, 28, v65
  v_lshlrev_b32 v6, 4, v65
  s_lshr_b32 s22, s17, 1
  s_mul_i32 s22, s22, 7
  s_and_b32 s34, s17, 1
  s_lshl_b32 s35, s34, 2
  v_add_u32 v70, s35, v72
  v_mov_b32 v71, s34
  v_mov_b32 v69, 0
  v_cmp_eq_u32 vcc, 3, v72
  s_nop 1
  v_cndmask_b32 v70, v70, v72, vcc
  v_cndmask_b32 v69, v69, v71, vcc
  v_add_u32 v70, s22, v70
  v_lshrrev_b32 v68, 1, v70
  v_lshlrev_b32 v68, 8, v68
  v_lshl_add_u32 v68, v69, 7, v68
  v_and_b32 v69, 1, v70
  v_lshl_add_u32 v68, v69, 3, v68
  v_lshl_add_u32 v1, v64, 4, v68
  v_cmp_gt_u32 s[26:27], 8, v73
  v_lshrrev_b32 v65, 3, v73
  v_lshl_add_u32 v66, v64, 1, v65
  v_add_u32 v66, 0, v66
  v_min_u32 v66, 27, v66
  v_mad_u32_u24 v66, v72, 28, v66
  v_lshlrev_b32 v6, 4, v66
  s_mul_i32 s22, s17, 16
  s_add_u32 s22, s22, 0
  v_lshl_add_u32 v70, v64, 1, s22
  v_lshrrev_b32 v68, 4, v70
  v_lshlrev_b32 v68, 8, v68
  v_bfe_u32 v69, v70, 1, 1
  v_lshl_add_u32 v68, v69, 7, v68
  v_bfe_u32 v69, v70, 2, 2
  v_lshl_add_u32 v68, v69, 2, v68
  v_and_b32 v69, 1, v72
  v_lshl_add_u32 v65, v69, 2, v65
  v_lshrrev_b32 v69, 1, v72
  v_lshl_add_u32 v65, v69, 1, v65
  v_lshrrev_b32 v65, 3, v73
  v_lshl_add_u32 v65, v72, 1, v65
  v_lshrrev_b32 v5, 1, v72
  v_lshlrev_b32 v5, 9, v5
  v_lshrrev_b32 v69, 2, v73
  v_lshl_add_u32 v5, v69, 7, v5
  v_and_b32 v69, 1, v72
  v_lshl_add_u32 v5, v69, 6, v5
  v_and_b32 v69, 3, v73
  v_lshl_add_u32 v5, v69, 4, v5
  v_and_b32 v69, 1, v73
  v_mul_u32_u24 v69, 0xaaaa, v69
  v_add_u32 v0, 0x4444, v69
  v_lshl_add_u32 v1, v65, 4, v68
  v_cmp_gt_u32 s[26:27], 6, v64
  v_mov_b32 v156, 0
  v_mov_b32 v157, 0
  v_mov_b32 v158, 0
  v_mov_b32 v159, 0
  ds_write_b128 v2, v[156:159] offset:0
  ds_write_b128 v2, v[156:159] offset:1024
  ds_write_b128 v2, v[156:159] offset:2048
  ds_write_b128 v2, v[156:159] offset:3072
  s_mul_i32 s22, s17, 1835008
  s_add_u32 s25, s22, 42205184
  s_lshl_b32 s35, s17, 7
  s_add_u32 s35, s35, 88539136
  s_add_u32 s39, s35, 16384
  s_mov_b32 s38, 0
  v_mov_b32 v63, 0
  v_bfe_u32 v8, v2, 4, 1
  v_mul_u32_u24 v3, 0xaaaa, v8
  v_add_u32 v3, 0x4444, v3
  v_bfe_u32 v9, v2, 5, 3
  v_lshl_add_u32 v8, v8, 3, v9
  v_and_b32 v9, 0x300, v2
  v_lshl_add_u32 v0, v8, 4, v9
  s_lshl_b32 s22, 0, 11
  s_add_u32 s22, s22, 88602624
  v_add_u32 v36, 1024, v2
  v_min_u32 v36, 1776, v36
  s_mov_b32 s30, 0
va_iw4:
  buffer_load_dwordx4 v[40:43], v2, s[8:11], s22 offen sc1
  buffer_load_dwordx4 v[44:47], v36, s[8:11], s22 offen sc1
  s_waitcnt vmcnt(0)
  v_cmp_ne_u64 vcc, s[88:89], v[40:41]
  s_cbranch_vccnz va_iw4_no
  v_cmp_ne_u64 vcc, s[88:89], v[42:43]
  s_cbranch_vccnz va_iw4_no
  v_cmp_ne_u64 vcc, s[88:89], v[44:45]
  s_cbranch_vccnz va_iw4_no
  v_cmp_ne_u64 vcc, s[88:89], v[46:47]
  s_cbranch_vccnz va_iw4_no
  s_branch va_iw4_ok
va_iw4_no:
  s_sleep 2
  s_add_u32 s30, s30, 1
  s_cmp_lt_u32 s30, 50000
  s_cbranch_scc1 va_iw4
  s_branch cA_abort
va_iw4_ok:
  s_mov_b32 s30, 0
  v_mov_b32 v36, 0
ch_md4:
  buffer_load_dword v37, v36, s[12:15], 0 offen sc1
  s_waitcnt vmcnt(0)
  v_readfirstlane_b32 s22, v37
  s_and_b32 s31, s22, 0xffff
  s_cmp_ge_u32 s31, 32
  s_cbranch_scc1 ch_go4
  s_sleep 2
  s_add_u32 s30, s30, 1
  s_cmp_lt_u32 s30, 50000
  s_cbranch_scc1 ch_md4
  s_branch ch_end
ch_go4:
  s_mov_b32 s31, 0
  v_mov_b32 v36, 0
  v_mov_b32 v37, 0
  v_mov_b32 v38, 0
  v_mov_b32 v39, 0
  v_mov_b32 v40, 0
  v_mov_b32 v41, 0
  v_mov_b32 v42, 0
  v_mov_b32 v43, 0
  v_mov_b32 v44, 0
  v_mov_b32 v45, 0
  v_mov_b32 v46, 0
  v_mov_b32 v47, 0
  v_mov_b32 v48, 0
  v_mov_b32 v49, 0
  v_mov_b32 v50, 0
  v_mov_b32 v51, 0
  v_mov_b32 v52, 0
  v_mov_b32 v53, 0
  v_mov_b32 v54, 0
  v_mov_b32 v55, 0
  v_mov_b32 v56, 0
  v_mov_b32 v57, 0
  v_mov_b32 v58, 0
  v_mov_b32 v59, 0
  s_lshr_b32 s22, s22, 16
  s_cmp_lg_u32 s22, 0
  s_cbranch_scc1 cB_va0_loop
  s_branch cA_va0_loop
ch_init5:
  s_mul_i32 s31, s17, 401408
  s_add_u32 s31, s31, 6422528
  s_mul_i32 s22, s17, 12
  s_add_u32 s23, s22, 267
  s_add_u32 s22, s22, 256
  v_mov_b32 v36, s23
  v_mov_b32 v37, s22
  v_cmp_eq_u32 vcc, 1, v116
  s_lshl_b32 s22, s17, 4
  s_nop 0
  v_cndmask_b32 v36, v36, v37, vcc
  v_mov_b32 v37, s22
  v_cmp_eq_u32 vcc, 0, v116
  s_nop 1
  v_cndmask_b32 v36, v36, v37, vcc
  v_lshrrev_b32 v36, 6, v36
  v_lshlrev_b32 v36, 8, v36
  v_med3_u32 v37, v117, 3, 6
  v_lshl_add_u32 v36, v37, 4, v36
  s_mov_b32 s22, 88600576
  s_mov_b32 s30, 0
va_bw_13:
  buffer_load_dwordx4 v[40:43], v36, s[8:11], s22 offen sc1
  s_waitcnt vmcnt(0)
  v_cmp_ne_u64 vcc, s[88:89], v[40:41]
  s_cbranch_vccnz va_bw_13_no
  v_cmp_ne_u64 vcc, s[88:89], v[42:43]
  s_cbranch_vccnz va_bw_13_no
  s_branch va_bw_13_ok
va_bw_13_no:
  s_sleep 2
  s_add_u32 s30, s30, 1
  s_cmp_lt_u32 s30, 50000
  s_cbranch_scc1 va_bw_13
  s_branch cA_abort
va_bw_13_ok:
  s_add_u32 s22, s31, 86016
  buffer_load_dwordx4 a[0:3], v2, s[8:11], s22 offen offset:0 sc1
  buffer_load_dwordx4 a[4:7], v2, s[8:11], s22 offen offset:1024 sc1
  buffer_load_dwordx4 a[8:11], v2, s[8:11], s22 offen offset:2048 sc1
  buffer_load_dwordx4 a[12:15], v2, s[8:11], s22 offen offset:3072 sc1
  s_add_u32 s22, s31, 90112
  buffer_load_dwordx4 a[16:19], v2, s[8:11], s22 offen offset:0 sc1
  buffer_load_dwordx4 a[20:23], v2, s[8:11], s22 offen offset:1024 sc1
  buffer_load_dwordx4 a[24:27], v2, s[8:11], s22 offen offset:2048 sc1
  buffer_load_dwordx4 a[28:31], v2, s[8:11], s22 offen offset:3072 sc1
  s_add_u32 s22, s31, 94208
  buffer_load_dwordx4 a[32:35], v2, s[8:11], s22 offen offset:0 sc1
  buffer_load_dwordx4 a[36:39], v2, s[8:11], s22 offen offset:1024 sc1
  buffer_load_dwordx4 a[40:43], v2, s[8:11], s22 offen offset:2048 sc1
  buffer_load_dwordx4 a[44:47], v2, s[8:11], s22 offen offset:3072 sc1
  s_add_u32 s22, s31, 98304
  buffer_load_dwordx4 a[48:51], v2, s[8:11], s22 offen offset:0 sc1
  buffer_load_dwordx4 a[52:55], v2, s[8:11], s22 offen offset:1024 sc1
  buffer_load_dwordx4 a[56:59], v2, s[8:11], s22 offen offset:2048 sc1
  buffer_load_dwordx4 a[60:63], v2, s[8:11], s22 offen offset:3072 sc1
  s_add_u32 s22, s31, 102400
  buffer_load_dwordx4 a[64:67], v2, s[8:11], s22 offen offset:0 sc1
  buffer_load_dwordx4 a[68:71], v2, s[8:11], s22 offen offset:1024 sc1
  buffer_load_dwordx4 a[72:75], v2, s[8:11], s22 offen offset:2048 sc1
  buffer_load_dwordx4 a[76:79], v2, s[8:11], s22 offen offset:3072 sc1
  s_add_u32 s22, s31, 106496
  buffer_load_dwordx4 a[80:83], v2, s[8:11], s22 offen offset:0 sc1
  buffer_load_dwordx4 a[84:87], v2, s[8:11], s22 offen offset:1024 sc1
  buffer_load_dwordx4 a[88:91], v2, s[8:11], s22 offen offset:2048 sc1
  buffer_load_dwordx4 a[92:95], v2, s[8:11], s22 offen offset:3072 sc1
  s_add_u32 s22, s31, 110592
  buffer_load_dwordx4 a[96:99], v2, s[8:11], s22 offen offset:0 sc1
  buffer_load_dwordx4 a[100:103], v2, s[8:11], s22 offen offset:1024 sc1
  buffer_load_dwordx4 a[104:107], v2, s[8:11], s22 offen offset:2048 sc1
  buffer_load_dwordx4 a[108:111], v2, s[8:11], s22 offen offset:3072 sc1
  s_add_u32 s22, s31, 114688
  buffer_load_dwordx4 a[112:115], v2, s[8:11], s22 offen offset:0 sc1
  buffer_load_dwordx4 a[116:119], v2, s[8:11], s22 offen offset:1024 sc1
  buffer_load_dwordx4 a[120:123], v2, s[8:11], s22 offen offset:2048 sc1
  buffer_load_dwordx4 a[124:127], v2, s[8:11], s22 offen offset:3072 sc1
  s_waitcnt vmcnt(24)
  s_add_u32 s22, s31, 118784
  buffer_load_dwordx4 a[128:131], v2, s[8:11], s22 offen offset:0 sc1
  buffer_load_dwordx4 a[132:135], v2, s[8:11], s22 offen offset:1024 sc1
  buffer_load_dwordx4 a[136:139], v2, s[8:11], s22 offen offset:2048 sc1
  buffer_load_dwordx4 a[140:143], v2, s[8:11], s22 offen offset:3072 sc1
  s_add_u32 s22, s31, 122880
  buffer_load_dwordx4 a[144:147], v2, s[8:11], s22 offen offset:0 sc1
  buffer_load_dwordx4 a[148:151], v2, s[8:11], s22 offen offset:1024 sc1
  buffer_load_dwordx4 a[152:155], v2, s[8:11], s22 offen offset:2048 sc1
  buffer_load_dwordx4 a[156:159], v2, s[8:11], s22 offen offset:3072 sc1
  s_add_u32 s22, s31, 126976
  buffer_load_dwordx4 a[160:163], v2, s[8:11], s22 offen offset:0 sc1
  buffer_load_dwordx4 a[164:167], v2, s[8:11], s22 offen offset:1024 sc1
  buffer_load_dwordx4 a[168:171], v2, s[8:11], s22 offen offset:2048 sc1
  buffer_load_dwordx4 a[172:175], v2, s[8:11], s22 offen offset:3072 sc1
  s_add_u32 s22, s31, 131072
  buffer_load_dwordx4 a[176:179], v2, s[8:11], s22 offen offset:0 sc1
  buffer_load_dwordx4 a[180:183], v2, s[8:11], s22 offen offset:1024 sc1
  buffer_load_dwordx4 a[184:187], v2, s[8:11], s22 offen offset:2048 sc1
  buffer_load_dwordx4 a[188:191], v2, s[8:11], s22 offen offset:3072 sc1
  s_add_u32 s22, s31, 135168
  buffer_load_dwordx4 a[192:195], v2, s[8:11], s22 offen offset:0 sc1
  buffer_load_dwordx4 a[196:199], v2, s[8:11], s22 offen offset:1024 sc1
  buffer_load_dwordx4 a[200:203], v2, s[8:11], s22 offen offset:2048 sc1
  buffer_load_dwordx4 a[204:207], v2, s[8:11], s22 offen offset:3072 sc1
  s_add_u32 s22, s31, 139264
  buffer_load_dwordx4 a[208:211], v2, s[8:11], s22 offen offset:0 sc1
  buffer_load_dwordx4 a[212:215], v2, s[8:11], s22 offen offset:1024 sc1
  buffer_load_dwordx4 a[216:219], v2, s[8:11], s22 offen offset:2048 sc1
  buffer_load_dwordx4 a[220:223], v2, s[8:11], s22 offen offset:3072 sc1
  s_add_u32 s22, s31, 143360
  buffer_load_dwordx4 a[224:227], v2, s[8:11], s22 offen offset:0 sc1
  buffer_load_dwordx4 a[228:231], v2, s[8:11], s22 offen offset:1024 sc1
  buffer_load_dwordx4 a[232:235], v2, s[8:11], s22 offen offset:2048 sc1
  buffer_load_dwordx4 a[236:239], v2, s[8:11], s22 offen offset:3072 sc1
  s_add_u32 s22, s31, 147456
  buffer_load_dwordx4 a[240:243], v2, s[8:11], s22 offen offset:0 sc1
  buffer_load_dwordx4 a[244:247], v2, s[8:11], s22 offen offset:1024 sc1
  buffer_load_dwordx4 a[248:251], v2, s[8:11], s22 offen offset:2048 sc1
  buffer_load_dwordx4 a[252:255], v2, s[8:11], s22 offen offset:3072 sc1
  s_waitcnt vmcnt(24)
  s_add_u32 s22, s31, 151552
  buffer_load_dwordx4 v[176:179], v2, s[8:11], s22 offen offset:0 sc1
  buffer_load_dwordx4 v[180:183], v2, s[8:11], s22 offen offset:1024 sc1
  buffer_load_dwordx4 v[184:187], v2, s[8:11], s22 offen offset:2048 sc1
  buffer_load_dwordx4 v[188:191], v2, s[8:11], s22 offen offset:3072 sc1
  s_add_u32 s22, s31, 155648
  buffer_load_dwordx4 v[192:195], v2, s[8:11], s22 offen offset:0 sc1
  buffer_load_dwordx4 v[196:199], v2, s[8:11], s22 offen offset:1024 sc1
  buffer_load_dwordx4 v[200:203], v2, s[8:11], s22 offen offset:2048 sc1
  buffer_load_dwordx4 v[204:207], v2, s[8:11], s22 offen offset:3072 sc1
  s_add_u32 s22, s31, 159744
  buffer_load_dwordx4 v[208:211], v2, s[8:11], s22 offen offset:0 sc1
  buffer_load_dwordx4 v[212:215], v2, s[8:11], s22 offen offset:1024 sc1
  buffer_load_dwordx4 v[216:219], v2, s[8:11], s22 offen offset:2048 sc1
  buffer_load_dwordx4 v[220:223], v2, s[8:11], s22 offen offset:3072 sc1
  s_add_u32 s22, s31, 163840
  buffer_load_dwordx4 v[224:227], v2, s[8:11], s22 offen offset:0 sc1
  buffer_load_dwordx4 v[228:231], v2, s[8:11], s22 offen offset:1024 sc1
  buffer_load_dwordx4 v[232:235], v2, s[8:11], s22 offen offset:2048 sc1
  buffer_load_dwordx4 v[236:239], v2, s[8:11], s22 offen offset:3072 sc1
  s_add_u32 s22, s31, 167936
  buffer_load_dwordx4 v[240:243], v2, s[8:11], s22 offen offset:0 sc1
  buffer_load_dwordx4 v[244:247], v2, s[8:11], s22 offen offset:1024 sc1
  buffer_load_dwordx4 v[248:251], v2, s[8:11], s22 offen offset:2048 sc1
  buffer_load_dwordx4 v[252:255], v2, s[8:11], s22 offen offset:3072 sc1
  s_mul_i32 s22, s17, 12
  s_add_u32 s23, s22, 267
  s_add_u32 s22, s22, 256
  v_mov_b32 v36, s23
  v_mov_b32 v37, s22
  v_cmp_eq_u32 vcc, 1, v116
  s_lshl_b32 s22, s17, 4
  s_nop 0
  v_cndmask_b32 v36, v36, v37, vcc
  v_mov_b32 v37, s22
  v_cmp_eq_u32 vcc, 0, v116
  s_nop 1
  v_cndmask_b32 v36, v36, v37, vcc
  v_lshrrev_b32 v36, 6, v36
  v_lshlrev_b32 v36, 8, v36
  v_med3_u32 v37, v117, 15, 15
  v_lshl_add_u32 v36, v37, 4, v36
  s_mov_b32 s22, 88600576
  s_mov_b32 s30, 0
va_bw_14:
  buffer_load_dwordx4 v[40:43], v36, s[8:11], s22 offen sc1
  s_waitcnt vmcnt(0)
  v_cmp_ne_u64 vcc, s[88:89], v[40:41]
  s_cbranch_vccnz va_bw_14_no
  v_cmp_ne_u64 vcc, s[88:89], v[42:43]
  s_cbranch_vccnz va_bw_14_no
  s_branch va_bw_14_ok
va_bw_14_no:
  s_sleep 2
  s_add_u32 s30, s30, 1
  s_cmp_lt_u32 s30, 50000
  s_cbranch_scc1 va_bw_14
  s_branch cA_abort
va_bw_14_ok:
  s_mov_b32 m0, 59392
  s_add_u32 s22, s31, 387072
  buffer_load_dwordx4 v2, s[8:11], s22 offen offset:0 sc1 lds
  buffer_load_dwordx4 v2, s[8:11], s22 offen offset:1024 sc1 lds
  buffer_load_dwordx4 v2, s[8:11], s22 offen offset:2048 sc1 lds
  buffer_load_dwordx4 v2, s[8:11], s22 offen offset:3072 sc1 lds
  s_mov_b32 m0, 63488
  s_add_u32 s22, s31, 391168
  buffer_load_dwordx4 v2, s[8:11], s22 offen offset:0 sc1 lds
  buffer_load_dwordx4 v2, s[8:11], s22 offen offset:1024 sc1 lds
  buffer_load_dwordx4 v2, s[8:11], s22 offen offset:2048 sc1 lds
  buffer_load_dwordx4 v2, s[8:11], s22 offen offset:3072 sc1 lds
  s_mov_b32 m0, 67584
  s_add_u32 s22, s31, 395264
  buffer_load_dwordx4 v2, s[8:11], s22 offen offset:0 sc1 lds
  buffer_load_dwordx4 v2, s[8:11], s22 offen offset:1024 sc1 lds
  buffer_load_dwordx4 v2, s[8:11], s22 offen offset:2048 sc1 lds
  buffer_load_dwordx4 v2, s[8:11], s22 offen offset:3072 sc1 lds
  s_mov_b32 m0, 71680
  s_add_u32 s22, s31, 399360
  buffer_load_dwordx4 v2, s[8:11], s22 offen offset:0 sc1 lds
  buffer_load_dwordx4 v2, s[8:11], s22 offen offset:1024 sc1 lds
  v_mov_b32 v72, v116
  v_mov_b32 v73, v117
  v_lshrrev_b32 v65, 1, v72
  v_and_b32 v66, 1, v72
  v_mov_b32 v67, 6
  v_lshl_add_u32 v67, v67, 4, v73
  v_mul_u32_u24 v68, 2341, v67
  v_lshrrev_b32 v68, 16, v68
  v_mul_u32_u24 v69, 28, v68
  v_sub_u32 v69, v67, v69
  v_lshrrev_b32 v70, 4, v69
  v_and_b32 v69, 15, v69
  v_and_b32 v71, 1, v69
  v_lshrrev_b32 v69, 1, v69
  v_lshl_add_u32 v69, v71, 3, v69
  v_lshlrev_b32 v71, 12, v70
  v_lshrrev_b32 v70, 1, v68
  v_lshl_add_u32 v71, v70, 9, v71
  v_and_b32 v70, 1, v68
  v_lshl_add_u32 v71, v70, 2, v71
  v_lshl_add_u32 v71, v69, 4, v71
  v_lshl_add_u32 v71, v65, 8, v71
  v_lshl_add_u32 v60, v66, 3, v71
  v_mov_b32 v67, 7
  v_lshl_add_u32 v67, v67, 4, v73
  v_mul_u32_u24 v68, 2341, v67
  v_lshrrev_b32 v68, 16, v68
  v_mul_u32_u24 v69, 28, v68
  v_sub_u32 v69, v67, v69
  v_lshrrev_b32 v70, 4, v69
  v_and_b32 v69, 15, v69
  v_and_b32 v71, 1, v69
  v_lshrrev_b32 v69, 1, v69
  v_lshl_add_u32 v69, v71, 3, v69
  v_lshlrev_b32 v71, 12, v70
  v_lshrrev_b32 v70, 1, v68
  v_lshl_add_u32 v71, v70, 9, v71
  v_and_b32 v70, 1, v68
  v_lshl_add_u32 v71, v70, 2, v71
  v_lshl_add_u32 v71, v69, 4, v71
  v_lshl_add_u32 v71, v65, 8, v71
  v_lshl_add_u32 v61, v66, 3, v71
  v_mov_b32 v67, 8
  v_lshl_add_u32 v67, v67, 4, v73
  v_mul_u32_u24 v68, 2341, v67
  v_lshrrev_b32 v68, 16, v68
  v_mul_u32_u24 v69, 28, v68
  v_sub_u32 v69, v67, v69
  v_lshrrev_b32 v70, 4, v69
  v_and_b32 v69, 15, v69
  v_and_b32 v71, 1, v69
  v_lshrrev_b32 v69, 1, v69
  v_lshl_add_u32 v69, v71, 3, v69
  v_lshlrev_b32 v71, 12, v70
  v_lshrrev_b32 v70, 1, v68
  v_lshl_add_u32 v71, v70, 9, v71
  v_and_b32 v70, 1, v68
  v_lshl_add_u32 v71, v70, 2, v71
  v_lshl_add_u32 v71, v69, 4, v71
  v_lshl_add_u32 v71, v65, 8, v71
  v_lshl_add_u32 v62, v66, 3, v71
  v_mov_b32 v67, 9
  v_lshl_add_u32 v67, v67, 4, v73
  v_mul_u32_u24 v68, 2341, v67
  v_lshrrev_b32 v68, 16, v68
  v_mul_u32_u24 v69, 28, v68
  v_sub_u32 v69, v67, v69
  v_lshrrev_b32 v70, 4, v69
  v_and_b32 v69, 15, v69
  v_and_b32 v71, 1, v69
  v_lshrrev_b32 v69, 1, v69
  v_lshl_add_u32 v69, v71, 3, v69
  v_lshlrev_b32 v71, 12, v70
  v_lshrrev_b32 v70, 1, v68
  v_lshl_add_u32 v71, v70, 9, v71
  v_and_b32 v70, 1, v68
  v_lshl_add_u32 v71, v70, 2, v71
  v_lshl_add_u32 v71, v69, 4, v71
  v_lshl_add_u32 v71, v65, 8, v71
  v_lshl_add_u32 v170, v66, 3, v71
  v_mov_b32 v67, 10
  v_lshl_add_u32 v67, v67, 4, v73
  v_mul_u32_u24 v68, 2341, v67
  v_lshrrev_b32 v68, 16, v68
  v_mul_u32_u24 v69, 28, v68
  v_sub_u32 v69, v67, v69
  v_lshrrev_b32 v70, 4, v69
  v_and_b32 v69, 15, v69
  v_and_b32 v71, 1, v69
  v_lshrrev_b32 v69, 1, v69
  v_lshl_add_u32 v69, v71, 3, v69
  v_lshlrev_b32 v71, 12, v70
  v_lshrrev_b32 v70, 1, v68
  v_lshl_add_u32 v71, v70, 9, v71
  v_and_b32 v70, 1, v68
  v_lshl_add_u32 v71, v70, 2, v71
  v_lshl_add_u32 v71, v69, 4, v71
  v_lshl_add_u32 v71, v65, 8, v71
  v_lshl_add_u32 v171, v66, 3, v71
  v_mov_b32 v67, 11
  v_lshl_add_u32 v67, v67, 4, v73
  v_mul_u32_u24 v68, 2341, v67
  v_lshrrev_b32 v68, 16, v68
  v_mul_u32_u24 v69, 28, v68
  v_sub_u32 v69, v67, v69
  v_lshrrev_b32 v70, 4, v69
  v_and_b32 v69, 15, v69
  v_and_b32 v71, 1, v69
  v_lshrrev_b32 v69, 1, v69
  v_lshl_add_u32 v69, v71, 3, v69
  v_lshlrev_b32 v71, 12, v70
  v_lshrrev_b32 v70, 1, v68
  v_lshl_add_u32 v71, v70, 9, v71
  v_and_b32 v70, 1, v68
  v_lshl_add_u32 v71, v70, 2, v71
  v_lshl_add_u32 v71, v69, 4, v71
  v_lshl_add_u32 v71, v65, 8, v71
  v_lshl_add_u32 v172, v66, 3, v71
  v_and_b32 v0, 31, v1
  v_lshlrev_b32 v0, 2, v0
  v_add_u32 v0, 18432, v0
  v_min_u32 v4, 15, v73
  v_lshlrev_b32 v4, 2, v4
  s_and_b32 s22, s17, 3
  s_lshl_b32 s22, s22, 7
  s_add_u32 s22, s22, 17408
  v_add_u32 v4, s22, v4
  v_and_b32 v64, 7, v73
  v_lshlrev_b32 v5, 4, v64
  v_lshl_add_u32 v5, v72, 7, v5
  v_lshrrev_b32 v65, 3, v73
  v_lshl_add_u32 v5, v65, 9, v5
  s_lshl_b32 s22, s17, 3
  s_add_u32 s22, s22, 17924
  v_mov_b32 v7, s22
  v_add_u32 v65, 16, v73
  v_min_u32 v65, 27, v65
  v_mad_u32_u24 v65, v72, 28, v65
  v_lshlrev_b32 v6, 4, v65
  s_lshr_b32 s22, s17, 1
  s_mul_i32 s22, s22, 7
  s_and_b32 s34, s17, 1
  s_lshl_b32 s35, s34, 2
  v_add_u32 v70, s35, v72
  v_mov_b32 v71, s34
  v_mov_b32 v69, 1
  v_cmp_eq_u32 vcc, 3, v72
  s_nop 1
  v_cndmask_b32 v70, v70, v72, vcc
  v_cndmask_b32 v69, v69, v71, vcc
  v_add_u32 v70, s22, v70
  v_lshrrev_b32 v68, 1, v70
  v_lshlrev_b32 v68, 8, v68
  v_lshl_add_u32 v68, v69, 7, v68
  v_and_b32 v69, 1, v70
  v_lshl_add_u32 v68, v69, 3, v68
  v_lshl_add_u32 v1, v64, 4, v68
  v_cmp_gt_u32 s[26:27], 8, v73
  v_cmp_gt_u32 vcc, 3, v72
  s_and_b64 s[26:27], s[26:27], vcc
  v_lshrrev_b32 v65, 3, v73
  v_lshl_add_u32 v66, v64, 1, v65
  v_add_u32 v66, 16, v66
  v_min_u32 v66, 27, v66
  v_mad_u32_u24 v66, v72, 28, v66
  v_lshlrev_b32 v6, 4, v66
  s_mul_i32 s22, s17, 12
  s_add_u32 s22, s22, 256
  v_lshl_add_u32 v70, v64, 1, s22
  v_lshrrev_b32 v68, 4, v70
  v_lshlrev_b32 v68, 8, v68
  v_bfe_u32 v69, v70, 1, 1
  v_lshl_add_u32 v68, v69, 7, v68
  v_bfe_u32 v69, v70, 2, 2
  v_lshl_add_u32 v68, v69, 2, v68
  v_and_b32 v69, 1, v72
  v_lshl_add_u32 v65, v69, 2, v65
  v_lshrrev_b32 v69, 1, v72
  v_lshl_add_u32 v65, v69, 1, v65
  v_lshrrev_b32 v65, 3, v73
  v_lshl_add_u32 v65, v72, 1, v65
  v_lshrrev_b32 v5, 1, v72
  v_lshlrev_b32 v5, 9, v5
  v_lshrrev_b32 v69, 2, v73
  v_lshl_add_u32 v5, v69, 7, v5
  v_and_b32 v69, 1, v72
  v_lshl_add_u32 v5, v69, 6, v5
  v_and_b32 v69, 3, v73
  v_lshl_add_u32 v5, v69, 4, v5
  v_and_b32 v69, 1, v73
  v_mul_u32_u24 v69, 0xaaaa, v69
  v_add_u32 v0, 0x4444, v69
  v_lshl_add_u32 v1, v65, 4, v68
  v_cmp_gt_u32 s[26:27], 6, v64
  v_mov_b32 v156, 0
  v_mov_b32 v157, 0
  v_mov_b32 v158, 0
  v_mov_b32 v159, 0
  ds_write_b128 v2, v[156:159] offset:4096
  ds_write_b128 v2, v[156:159] offset:5120
  ds_write_b128 v2, v[156:159] offset:6144
  ds_write_b128 v2, v[156:159] offset:7168
  s_mul_i32 s22, s17, 1835008
  s_add_u32 s25, s22, 42205184
  s_lshl_b32 s35, s17, 7
  s_add_u32 s35, s35, 88539136
  s_add_u32 s39, s35, 16384
  s_mov_b32 s38, 0
  v_mov_b32 v63, 0
  v_bfe_u32 v8, v2, 4, 1
  v_mul_u32_u24 v3, 0xaaaa, v8
  v_add_u32 v3, 0x4444, v3
  v_bfe_u32 v9, v2, 5, 3
  v_lshl_add_u32 v8, v8, 3, v9
  v_and_b32 v9, 0x300, v2
  v_lshl_add_u32 v0, v8, 4, v9
  s_lshl_b32 s22, 0, 11
  s_add_u32 s22, s22, 88602624
  v_add_u32 v36, 1024, v2
  v_min_u32 v36, 1776, v36
  s_mov_b32 s30, 0
va_iw5:
  buffer_load_dwordx4 v[40:43], v2, s[8:11], s22 offen sc1
  buffer_load_dwordx4 v[44:47], v36, s[8:11], s22 offen sc1
  s_waitcnt vmcnt(0)
  v_cmp_ne_u64 vcc, s[88:89], v[40:41]
  s_cbranch_vccnz va_iw5_no
  v_cmp_ne_u64 vcc, s[88:89], v[42:43]
  s_cbranch_vccnz va_iw5_no
  v_cmp_ne_u64 vcc, s[88:89], v[44:45]
  s_cbranch_vccnz va_iw5_no
  v_cmp_ne_u64 vcc, s[88:89], v[46:47]
  s_cbranch_vccnz va_iw5_no
  s_branch va_iw5_ok
va_iw5_no:
  s_sleep 2
  s_add_u32 s30, s30, 1
  s_cmp_lt_u32 s30, 50000
  s_cbranch_scc1 va_iw5
  s_branch cA_abort
va_iw5_ok:
  s_mov_b32 s30, 0
  v_mov_b32 v36, 0
ch_md5:
  buffer_load_dword v37, v36, s[12:15], 0 offen sc1
  s_waitcnt vmcnt(0)
  v_readfirstlane_b32 s22, v37
  s_and_b32 s31, s22, 0xffff
  s_cmp_ge_u32 s31, 32
  s_cbranch_scc1 ch_go5
  s_sleep 2
  s_add_u32 s30, s30, 1
  s_cmp_lt_u32 s30, 50000
  s_cbranch_scc1 ch_md5
  s_branch ch_end
ch_go5:
  s_mov_b32 s31, 0
  v_mov_b32 v36, 0
  v_mov_b32 v37, 0
  v_mov_b32 v38, 0
  v_mov_b32 v39, 0
  v_mov_b32 v40, 0
  v_mov_b32 v41, 0
  v_mov_b32 v42, 0
  v_mov_b32 v43, 0
  v_mov_b32 v44, 0
  v_mov_b32 v45, 0
  v_mov_b32 v46, 0
  v_mov_b32 v47, 0
  v_mov_b32 v48, 0
  v_mov_b32 v49, 0
  v_mov_b32 v50, 0
  v_mov_b32 v51, 0
  v_mov_b32 v52, 0
  v_mov_b32 v53, 0
  v_mov_b32 v54, 0
  v_mov_b32 v55, 0
  v_mov_b32 v56, 0
  v_mov_b32 v57, 0
  v_mov_b32 v58, 0
  v_mov_b32 v59, 0
  s_lshr_b32 s22, s22, 16
  s_cmp_lg_u32 s22, 0
  s_cbranch_scc1 cB_va1_loop
  s_branch cA_va1_loop
ch_init6:
  s_mul_i32 s31, s17, 401408
  s_add_u32 s31, s31, 6422528
  s_mul_i32 s22, s17, 12
  s_add_u32 s23, s22, 267
  s_add_u32 s22, s22, 256
  v_mov_b32 v36, s23
  v_mov_b32 v37, s22
  v_cmp_eq_u32 vcc, 1, v116
  s_lshl_b32 s22, s17, 4
  s_nop 0
  v_cndmask_b32 v36, v36, v37, vcc
  v_mov_b32 v37, s22
  v_cmp_eq_u32 vcc, 0, v116
  s_nop 1
  v_cndmask_b32 v36, v36, v37, vcc
  v_lshrrev_b32 v36, 6, v36
  v_lshlrev_b32 v36, 8, v36
  v_med3_u32 v37, v117, 6, 10
  v_lshl_add_u32 v36, v37, 4, v36
  s_mov_b32 s22, 88600576
  s_mov_b32 s30, 0
va_bw_15:
  buffer_load_dwordx4 v[40:43], v36, s[8:11], s22 offen sc1
  s_waitcnt vmcnt(0)
  v_cmp_ne_u64 vcc, s[88:89], v[40:41]
  s_cbranch_vccnz va_bw_15_no
  v_cmp_ne_u64 vcc, s[88:89], v[42:43]
  s_cbranch_vccnz va_bw_15_no
  s_branch va_bw_15_ok
va_bw_15_no:
  s_sleep 2
  s_add_u32 s30, s30, 1
  s_cmp_lt_u32 s30, 50000
  s_cbranch_scc1 va_bw_15
  s_branch cA_abort
va_bw_15_ok:
  s_add_u32 s22, s31, 172032
  buffer_load_dwordx4 a[0:3], v2, s[8:11], s22 offen offset:0 sc1
  buffer_load_dwordx4 a[4:7], v2, s[8:11], s22 offen offset:1024 sc1
  buffer_load_dwordx4 a[8:11], v2, s[8:11], s22 offen offset:2048 sc1
  buffer_load_dwordx4 a[12:15], v2, s[8:11], s22 offen offset:3072 sc1
  s_add_u32 s22, s31, 176128
  buffer_load_dwordx4 a[16:19], v2, s[8:11], s22 offen offset:0 sc1
  buffer_load_dwordx4 a[20:23], v2, s[8:11], s22 offen offset:1024 sc1
  buffer_load_dwordx4 a[24:27], v2, s[8:11], s22 offen offset:2048 sc1
  buffer_load_dwordx4 a[28:31], v2, s[8:11], s22 offen offset:3072 sc1
  s_add_u32 s22, s31, 180224
  buffer_load_dwordx4 a[32:35], v2, s[8:11], s22 offen offset:0 sc1
  buffer_load_dwordx4 a[36:39], v2, s[8:11], s22 offen offset:1024 sc1
  buffer_load_dwordx4 a[40:43], v2, s[8:11], s22 offen offset:2048 sc1
  buffer_load_dwordx4 a[44:47], v2, s[8:11], s22 offen offset:3072 sc1
  s_add_u32 s22, s31, 184320
  buffer_load_dwordx4 a[48:51], v2, s[8:11], s22 offen offset:0 sc1
  buffer_load_dwordx4 a[52:55], v2, s[8:11], s22 offen offset:1024 sc1
  buffer_load_dwordx4 a[56:59], v2, s[8:11], s22 offen offset:2048 sc1
  buffer_load_dwordx4 a[60:63], v2, s[8:11], s22 offen offset:3072 sc1
  s_add_u32 s22, s31, 188416
  buffer_load_dwordx4 a[64:67], v2, s[8:11], s22 offen offset:0 sc1
  buffer_load_dwordx4 a[68:71], v2, s[8:11], s22 offen offset:1024 sc1
  buffer_load_dwordx4 a[72:75], v2, s[8:11], s22 offen offset:2048 sc1
  buffer_load_dwordx4 a[76:79], v2, s[8:11], s22 offen offset:3072 sc1
  s_add_u32 s22, s31, 192512
  buffer_load_dwordx4 a[80:83], v2, s[8:11], s22 offen offset:0 sc1
  buffer_load_dwordx4 a[84:87], v2, s[8:11], s22 offen offset:1024 sc1
  buffer_load_dwordx4 a[88:91], v2, s[8:11], s22 offen offset:2048 sc1
  buffer_load_dwordx4 a[92:95], v2, s[8:11], s22 offen offset:3072 sc1
  s_add_u32 s22, s31, 196608
  buffer_load_dwordx4 a[96:99], v2, s[8:11], s22 offen offset:0 sc1
  buffer_load_dwordx4 a[100:103], v2, s[8:11], s22 offen offset:1024 sc1
  buffer_load_dwordx4 a[104:107], v2, s[8:11], s22 offen offset:2048 sc1
  buffer_load_dwordx4 a[108:111], v2, s[8:11], s22 offen offset:3072 sc1
  s_add_u32 s22, s31, 200704
  buffer_load_dwordx4 a[112:115], v2, s[8:11], s22 offen offset:0 sc1
  buffer_load_dwordx4 a[116:119], v2, s[8:11], s22 offen offset:1024 sc1
  buffer_load_dwordx4 a[120:123], v2, s[8:11], s22 offen offset:2048 sc1
  buffer_load_dwordx4 a[124:127], v2, s[8:11], s22 offen offset:3072 sc1
  s_waitcnt vmcnt(24)
  s_add_u32 s22, s31, 204800
  buffer_load_dwordx4 a[128:131], v2, s[8:11], s22 offen offset:0 sc1
  buffer_load_dwordx4 a[132:135], v2, s[8:11], s22 offen offset:1024 sc1
  buffer_load_dwordx4 a[136:139], v2, s[8:11], s22 offen offset:2048 sc1
  buffer_load_dwordx4 a[140:143], v2, s[8:11], s22 offen offset:3072 sc1
  s_add_u32 s22, s31, 208896
  buffer_load_dwordx4 a[144:147], v2, s[8:11], s22 offen offset:0 sc1
  buffer_load_dwordx4 a[148:151], v2, s[8:11], s22 offen offset:1024 sc1
  buffer_load_dwordx4 a[152:155], v2, s[8:11], s22 offen offset:2048 sc1
  buffer_load_dwordx4 a[156:159], v2, s[8:11], s22 offen offset:3072 sc1
  s_add_u32 s22, s31, 212992
  buffer_load_dwordx4 a[160:163], v2, s[8:11], s22 offen offset:0 sc1
  buffer_load_dwordx4 a[164:167], v2, s[8:11], s22 offen offset:1024 sc1
  buffer_load_dwordx4 a[168:171], v2, s[8:11], s22 offen offset:2048 sc1
  buffer_load_dwordx4 a[172:175], v2, s[8:11], s22 offen offset:3072 sc1
  s_add_u32 s22, s31, 217088
  buffer_load_dwordx4 a[176:179], v2, s[8:11], s22 offen offset:0 sc1
  buffer_load_dwordx4 a[180:183], v2, s[8:11], s22 offen offset:1024 sc1
  buffer_load_dwordx4 a[184:187], v2, s[8:11], s22 offen offset:2048 sc1
  buffer_load_dwordx4 a[188:191], v2, s[8:11], s22 offen offset:3072 sc1
  s_add_u32 s22, s31, 221184
  buffer_load_dwordx4 a[192:195], v2, s[8:11], s22 offen offset:0 sc1
  buffer_load_dwordx4 a[196:199], v2, s[8:11], s22 offen offset:1024 sc1
  buffer_load_dwordx4 a[200:203], v2, s[8:11], s22 offen offset:2048 sc1
  buffer_load_dwordx4 a[204:207], v2, s[8:11], s22 offen offset:3072 sc1
  s_add_u32 s22, s31, 225280
  buffer_load_dwordx4 a[208:211], v2, s[8:11], s22 offen offset:0 sc1
  buffer_load_dwordx4 a[212:215], v2, s[8:11], s22 offen offset:1024 sc1
  buffer_load_dwordx4 a[216:219], v2, s[8:11], s22 offen offset:2048 sc1
  buffer_load_dwordx4 a[220:223], v2, s[8:11], s22 offen offset:3072 sc1
  s_add_u32 s22, s31, 229376
  buffer_load_dwordx4 a[224:227], v2, s[8:11], s22 offen offset:0 sc1
  buffer_load_dwordx4 a[228:231], v2, s[8:11], s22 offen offset:1024 sc1
  buffer_load_dwordx4 a[232:235], v2, s[8:11], s22 offen offset:2048 sc1
  buffer_load_dwordx4 a[236:239], v2, s[8:11], s22 offen offset:3072 sc1
  s_add_u32 s22, s31, 233472
  buffer_load_dwordx4 a[240:243], v2, s[8:11], s22 offen offset:0 sc1
  buffer_load_dwordx4 a[244:247], v2, s[8:11], s22 offen offset:1024 sc1
  buffer_load_dwordx4 a[248:251], v2, s[8:11], s22 offen offset:2048 sc1
  buffer_load_dwordx4 a[252:255], v2, s[8:11], s22 offen offset:3072 sc1
  s_waitcnt vmcnt(24)
  s_add_u32 s22, s31, 237568
  buffer_load_dwordx4 v[120:123], v2, s[8:11], s22 offen offset:0 sc1
  buffer_load_dwordx4 v[124:127], v2, s[8:11], s22 offen offset:1024 sc1
  buffer_load_dwordx4 v[128:131], v2, s[8:11], s22 offen offset:2048 sc1
  buffer_load_dwordx4 v[132:135], v2, s[8:11], s22 offen offset:3072 sc1
  s_add_u32 s22, s31, 241664
  buffer_load_dwordx4 v[136:139], v2, s[8:11], s22 offen offset:0 sc1
  buffer_load_dwordx4 v[140:143], v2, s[8:11], s22 offen offset:1024 sc1
  buffer_load_dwordx4 v[144:147], v2, s[8:11], s22 offen offset:2048 sc1
  buffer_load_dwordx4 v[148:151], v2, s[8:11], s22 offen offset:3072 sc1
  s_add_u32 s22, s31, 245760
  buffer_load_dwordx4 v[152:155], v2, s[8:11], s22 offen offset:0 sc1
  buffer_load_dwordx4 v[156:159], v2, s[8:11], s22 offen offset:1024 sc1
  buffer_load_dwordx4 v[160:163], v2, s[8:11], s22 offen offset:2048 sc1
  buffer_load_dwordx4 v[164:167], v2, s[8:11], s22 offen offset:3072 sc1
  s_add_u32 s22, s31, 249856
  buffer_load_dwordx4 v[168:171], v2, s[8:11], s22 offen offset:0 sc1
  buffer_load_dwordx4 v[172:175], v2, s[8:11], s22 offen offset:1024 sc1
  buffer_load_dwordx4 v[176:179], v2, s[8:11], s22 offen offset:2048 sc1
  buffer_load_dwordx4 v[180:183], v2, s[8:11], s22 offen offset:3072 sc1
  s_add_u32 s22, s31, 253952
  buffer_load_dwordx4 v[184:187], v2, s[8:11], s22 offen offset:0 sc1
  buffer_load_dwordx4 v[188:191], v2, s[8:11], s22 offen offset:1024 sc1
  buffer_load_dwordx4 v[192:195], v2, s[8:11], s22 offen offset:2048 sc1
  buffer_load_dwordx4 v[196:199], v2, s[8:11], s22 offen offset:3072 sc1
  s_add_u32 s22, s31, 258048
  buffer_load_dwordx4 v[200:203], v2, s[8:11], s22 offen offset:0 sc1
  buffer_load_dwordx4 v[204:207], v2, s[8:11], s22 offen offset:1024 sc1
  buffer_load_dwordx4 v[208:211], v2, s[8:11], s22 offen offset:2048 sc1
  buffer_load_dwordx4 v[212:215], v2, s[8:11], s22 offen offset:3072 sc1
  s_add_u32 s22, s31, 262144
  buffer_load_dwordx4 v[216:219], v2, s[8:11], s22 offen offset:0 sc1
  buffer_load_dwordx4 v[220:223], v2, s[8:11], s22 offen offset:1024 sc1
  buffer_load_dwordx4 v[224:227], v2, s[8:11], s22 offen offset:2048 sc1
  buffer_load_dwordx4 v[228:231], v2, s[8:11], s22 offen offset:3072 sc1
  s_add_u32 s22, s31, 266240
  buffer_load_dwordx4 v[232:235], v2, s[8:11], s22 offen offset:0 sc1
  buffer_load_dwordx4 v[236:239], v2, s[8:11], s22 offen offset:1024 sc1
  buffer_load_dwordx4 v[240:243], v2, s[8:11], s22 offen offset:2048 sc1
  buffer_load_dwordx4 v[244:247], v2, s[8:11], s22 offen offset:3072 sc1
  s_waitcnt vmcnt(24)
  s_add_u32 s22, s31, 270336
  buffer_load_dwordx4 v[248:251], v2, s[8:11], s22 offen offset:0 sc1
  buffer_load_dwordx4 v[252:255], v2, s[8:11], s22 offen offset:1024 sc1
  v_mov_b32 v72, v116
  v_mov_b32 v73, v117
  v_lshrrev_b32 v65, 1, v72
  v_and_b32 v66, 1, v72
  v_mov_b32 v67, 12
  v_lshl_add_u32 v67, v67, 4, v73
  v_mul_u32_u24 v68, 2341, v67
  v_lshrrev_b32 v68, 16, v68
  v_mul_u32_u24 v69, 28, v68
  v_sub_u32 v69, v67, v69
  v_lshrrev_b32 v70, 4, v69
  v_and_b32 v69, 15, v69
  v_and_b32 v71, 1, v69
  v_lshrrev_b32 v69, 1, v69
  v_lshl_add_u32 v69, v71, 3, v69
  v_lshlrev_b32 v71, 12, v70
  v_lshrrev_b32 v70, 1, v68
  v_lshl_add_u32 v71, v70, 9, v71
  v_and_b32 v70, 1, v68
  v_lshl_add_u32 v71, v70, 2, v71
  v_lshl_add_u32 v71, v69, 4, v71
  v_lshl_add_u32 v71, v65, 8, v71
  v_lshl_add_u32 v100, v66, 3, v71
  v_mov_b32 v67, 13
  v_lshl_add_u32 v67, v67, 4, v73
  v_mul_u32_u24 v68, 2341, v67
  v_lshrrev_b32 v68, 16, v68
  v_mul_u32_u24 v69, 28, v68
  v_sub_u32 v69, v67, v69
  v_lshrrev_b32 v70, 4, v69
  v_and_b32 v69, 15, v69
  v_and_b32 v71, 1, v69
  v_lshrrev_b32 v69, 1, v69
  v_lshl_add_u32 v69, v71, 3, v69
  v_lshlrev_b32 v71, 12, v70
  v_lshrrev_b32 v70, 1, v68
  v_lshl_add_u32 v71, v70, 9, v71
  v_and_b32 v70, 1, v68
  v_lshl_add_u32 v71, v70, 2, v71
  v_lshl_add_u32 v71, v69, 4, v71
  v_lshl_add_u32 v71, v65, 8, v71
  v_lshl_add_u32 v101, v66, 3, v71
  v_mov_b32 v67, 14
  v_lshl_add_u32 v67, v67, 4, v73
  v_mul_u32_u24 v68, 2341, v67
  v_lshrrev_b32 v68, 16, v68
  v_mul_u32_u24 v69, 28, v68
  v_sub_u32 v69, v67, v69
  v_lshrrev_b32 v70, 4, v69
  v_and_b32 v69, 15, v69
  v_and_b32 v71, 1, v69
  v_lshrrev_b32 v69, 1, v69
  v_lshl_add_u32 v69, v71, 3, v69
  v_lshlrev_b32 v71, 12, v70
  v_lshrrev_b32 v70, 1, v68
  v_lshl_add_u32 v71, v70, 9, v71
  v_and_b32 v70, 1, v68
  v_lshl_add_u32 v71, v70, 2, v71
  v_lshl_add_u32 v71, v69, 4, v71
  v_lshl_add_u32 v71, v65, 8, v71
  v_lshl_add_u32 v102, v66, 3, v71
  v_mov_b32 v67, 15
  v_lshl_add_u32 v67, v67, 4, v73
  v_mul_u32_u24 v68, 2341, v67
  v_lshrrev_b32 v68, 16, v68
  v_mul_u32_u24 v69, 28, v68
  v_sub_u32 v69, v67, v69
  v_lshrrev_b32 v70, 4, v69
  v_and_b32 v69, 15, v69
  v_and_b32 v71, 1, v69
  v_lshrrev_b32 v69, 1, v69
  v_lshl_add_u32 v69, v71, 3, v69
  v_lshlrev_b32 v71, 12, v70
  v_lshrrev_b32 v70, 1, v68
  v_lshl_add_u32 v71, v70, 9, v71
  v_and_b32 v70, 1, v68
  v_lshl_add_u32 v71, v70, 2, v71
  v_lshl_add_u32 v71, v69, 4, v71
  v_lshl_add_u32 v71, v65, 8, v71
  v_lshl_add_u32 v103, v66, 3, v71
  v_mov_b32 v67, 16
  v_lshl_add_u32 v67, v67, 4, v73
  v_mul_u32_u24 v68, 2341, v67
  v_lshrrev_b32 v68, 16, v68
  v_mul_u32_u24 v69, 28, v68
  v_sub_u32 v69, v67, v69
  v_lshrrev_b32 v70, 4, v69
  v_and_b32 v69, 15, v69
  v_and_b32 v71, 1, v69
  v_lshrrev_b32 v69, 1, v69
  v_lshl_add_u32 v69, v71, 3, v69
  v_lshlrev_b32 v71, 12, v70
  v_lshrrev_b32 v70, 1, v68
  v_lshl_add_u32 v71, v70, 9, v71
  v_and_b32 v70, 1, v68
  v_lshl_add_u32 v71, v70, 2, v71
  v_lshl_add_u32 v71, v69, 4, v71
  v_lshl_add_u32 v71, v65, 8, v71
  v_lshl_add_u32 v104, v66, 3, v71
  v_mov_b32 v67, 17
  v_lshl_add_u32 v67, v67, 4, v73
  v_mul_u32_u24 v68, 2341, v67
  v_lshrrev_b32 v68, 16, v68
  v_mul_u32_u24 v69, 28, v68
  v_sub_u32 v69, v67, v69
  v_lshrrev_b32 v70, 4, v69
  v_and_b32 v69, 15, v69
  v_and_b32 v71, 1, v69
  v_lshrrev_b32 v69, 1, v69
  v_lshl_add_u32 v69, v71, 3, v69
  v_lshlrev_b32 v71, 12, v70
  v_lshrrev_b32 v70, 1, v68
  v_lshl_add_u32 v71, v70, 9, v71
  v_and_b32 v70, 1, v68
  v_lshl_add_u32 v71, v70, 2, v71
  v_lshl_add_u32 v71, v69, 4, v71
  v_lshl_add_u32 v71, v65, 8, v71
  v_lshl_add_u32 v105, v66, 3, v71
  v_mov_b32 v67, 18
  v_lshl_add_u32 v67, v67, 4, v73
  v_mul_u32_u24 v68, 2341, v67
  v_lshrrev_b32 v68, 16, v68
  v_mul_u32_u24 v69, 28, v68
  v_sub_u32 v69, v67, v69
  v_lshrrev_b32 v70, 4, v69
  v_and_b32 v69, 15, v69
  v_and_b32 v71, 1, v69
  v_lshrrev_b32 v69, 1, v69
  v_lshl_add_u32 v69, v71, 3, v69
  v_lshlrev_b32 v71, 12, v70
  v_lshrrev_b32 v70, 1, v68
  v_lshl_add_u32 v71, v70, 9, v71
  v_and_b32 v70, 1, v68
  v_lshl_add_u32 v71, v70, 2, v71
  v_lshl_add_u32 v71, v69, 4, v71
  v_lshl_add_u32 v71, v65, 8, v71
  v_lshl_add_u32 v106, v66, 3, v71
  v_mov_b32 v67, 19
  v_lshl_add_u32 v67, v67, 4, v73
  v_mul_u32_u24 v68, 2341, v67
  v_lshrrev_b32 v68, 16, v68
  v_mul_u32_u24 v69, 28, v68
  v_sub_u32 v69, v67, v69
  v_lshrrev_b32 v70, 4, v69
  v_and_b32 v69, 15, v69
  v_and_b32 v71, 1, v69
  v_lshrrev_b32 v69, 1, v69
  v_lshl_add_u32 v69, v71, 3, v69
  v_lshlrev_b32 v71, 12, v70
  v_lshrrev_b32 v70, 1, v68
  v_lshl_add_u32 v71, v70, 9, v71
  v_and_b32 v70, 1, v68
  v_lshl_add_u32 v71, v70, 2, v71
  v_lshl_add_u32 v71, v69, 4, v71
  v_lshl_add_u32 v71, v65, 8, v71
  v_lshl_add_u32 v107, v66, 3, v71
  s_mul_i32 s24, s17, 532480
  s_add_u32 s24, s24, 76939264
  s_mul_i32 s34, s17, 640
  s_add_u32 s34, s34, 88582144
  s_mul_i32 s36, s17, 448
  v_add_u32 v0, s36, v2
  v_add_u32 v0, 8192, v0
  s_add_u32 s36, s36, 88080384
  s_mov_b32 s37, 76939264
  v_cmp_gt_u32 s[26:27], 28, v1
  v_and_b32 v119, 31, v1
  v_lshlrev_b32 v119, 2, v119
  v_and_b32 v119, 0x78, v119
  v_or_b32 v119, 0, v119
  s_add_u32 s22, s17, 16
  s_and_b32 s22, s22, 15
  s_lshl_b32 s22, s22, 7
  s_add_u32 s22, s22, 18432
  v_add_u32 v119, s22, v119
  v_min_u32 v118, 9, v1
  s_mul_i32 s22, s17, 10
  v_add_u32 v118, s22, v118
  v_lshlrev_b32 v118, 7, v118
  v_add_u32 v118, 40960, v118
  s_mov_b32 s39, 71565312
  v_add_u32 v1, 16384, v2
  v_mov_b32 v117, 1
  s_mul_i32 s38, s17, 1104
  s_add_u32 s38, s38, 20480
  v_bfe_u32 v8, v2, 4, 1
  v_mul_u32_u24 v3, 0xaaaa, v8
  v_add_u32 v3, 0x4444, v3
  v_bfe_u32 v9, v2, 5, 3
  v_lshl_add_u32 v8, v8, 3, v9
  v_and_b32 v9, 0x300, v2
  v_lshl_add_u32 v5, v8, 4, v9
  s_lshl_b32 s22, 0, 11
  s_add_u32 s22, s22, 88602624
  v_add_u32 v36, 1024, v2
  v_min_u32 v36, 1776, v36
  s_mov_b32 s30, 0
va_iw6:
  buffer_load_dwordx4 v[40:43], v2, s[8:11], s22 offen sc1
  buffer_load_dwordx4 v[44:47], v36, s[8:11], s22 offen sc1
  s_waitcnt vmcnt(0)
  v_cmp_ne_u64 vcc, s[88:89], v[40:41]
  s_cbranch_vccnz va_iw6_no
  v_cmp_ne_u64 vcc, s[88:89], v[42:43]
  s_cbranch_vccnz va_iw6_no
  v_cmp_ne_u64 vcc, s[88:89], v[44:45]
  s_cbranch_vccnz va_iw6_no
  v_cmp_ne_u64 vcc, s[88:89], v[46:47]
  s_cbranch_vccnz va_iw6_no
  s_branch va_iw6_ok
va_iw6_no:
  s_sleep 2
  s_add_u32 s30, s30, 1
  s_cmp_lt_u32 s30, 50000
  s_cbranch_scc1 va_iw6
  s_branch cA_abort
va_iw6_ok:
  s_mov_b32 s30, 0
  v_mov_b32 v36, 0
ch_md6:
  buffer_load_dword v37, v36, s[12:15], 0 offen sc1
  s_waitcnt vmcnt(0)
  v_readfirstlane_b32 s22, v37
  s_and_b32 s31, s22, 0xffff
  s_cmp_ge_u32 s31, 32
  s_cbranch_scc1 ch_go6
  s_sleep 2
  s_add_u32 s30, s30, 1
  s_cmp_lt_u32 s30, 50000
  s_cbranch_scc1 ch_md6
  s_branch ch_end
ch_go6:
  s_mov_b32 s31, 0
  s_lshr_b32 s22, s22, 16
  s_cmp_lg_u32 s22, 0
  s_cbranch_scc1 cB_va2_loop
  s_branch cA_va2_loop
ch_init7:
  s_mul_i32 s31, s17, 401408
  s_add_u32 s31, s31, 6422528
  s_mul_i32 s22, s17, 12
  s_add_u32 s23, s22, 267
  s_add_u32 s22, s22, 256
  v_mov_b32 v36, s23
  v_mov_b32 v37, s22
  v_cmp_eq_u32 vcc, 1, v116
  s_lshl_b32 s22, s17, 4
  s_nop 0
  v_cndmask_b32 v36, v36, v37, vcc
  v_mov_b32 v37, s22
  v_cmp_eq_u32 vcc, 0, v116
  s_nop 1
  v_cndmask_b32 v36, v36, v37, vcc
  v_lshrrev_b32 v36, 6, v36
  v_lshlrev_b32 v36, 8, v36
  v_med3_u32 v37, v117, 11, 15
  v_lshl_add_u32 v36, v37, 4, v36
  s_mov_b32 s22, 88600576
  s_mov_b32 s30, 0
va_bw_16:
  buffer_load_dwordx4 v[40:43], v36, s[8:11], s22 offen sc1
  s_waitcnt vmcnt(0)
  v_cmp_ne_u64 vcc, s[88:89], v[40:41]
  s_cbranch_vccnz va_bw_16_no
  v_cmp_ne_u64 vcc, s[88:89], v[42:43]
  s_cbranch_vccnz va_bw_16_no
  s_branch va_bw_16_ok
va_bw_16_no:
  s_sleep 2
  s_add_u32 s30, s30, 1
  s_cmp_lt_u32 s30, 50000
  s_cbranch_scc1 va_bw_16
  s_branch cA_abort
va_bw_16_ok:
  s_add_u32 s22, s31, 286720
  buffer_load_dwordx4 a[0:3], v2, s[8:11], s22 offen offset:0 sc1
  buffer_load_dwordx4 a[4:7], v2, s[8:11], s22 offen offset:1024 sc1
  buffer_load_dwordx4 a[8:11], v2, s[8:11], s22 offen offset:2048 sc1
  buffer_load_dwordx4 a[12:15], v2, s[8:11], s22 offen offset:3072 sc1
  s_add_u32 s22, s31, 290816
  buffer_load_dwordx4 a[16:19], v2, s[8:11], s22 offen offset:0 sc1
  buffer_load_dwordx4 a[20:23], v2, s[8:11], s22 offen offset:1024 sc1
  buffer_load_dwordx4 a[24:27], v2, s[8:11], s22 offen offset:2048 sc1
  buffer_load_dwordx4 a[28:31], v2, s[8:11], s22 offen offset:3072 sc1
  s_add_u32 s22, s31, 294912
  buffer_load_dwordx4 a[32:35], v2, s[8:11], s22 offen offset:0 sc1
  buffer_load_dwordx4 a[36:39], v2, s[8:11], s22 offen offset:1024 sc1
  buffer_load_dwordx4 a[40:43], v2, s[8:11], s22 offen offset:2048 sc1
  buffer_load_dwordx4 a[44:47], v2, s[8:11], s22 offen offset:3072 sc1
  s_add_u32 s22, s31, 299008
  buffer_load_dwordx4 a[48:51], v2, s[8:11], s22 offen offset:0 sc1
  buffer_load_dwordx4 a[52:55], v2, s[8:11], s22 offen offset:1024 sc1
  buffer_load_dwordx4 a[56:59], v2, s[8:11], s22 offen offset:2048 sc1
  buffer_load_dwordx4 a[60:63], v2, s[8:11], s22 offen offset:3072 sc1
  s_add_u32 s22, s31, 303104
  buffer_load_dwordx4 a[64:67], v2, s[8:11], s22 offen offset:0 sc1
  buffer_load_dwordx4 a[68:71], v2, s[8:11], s22 offen offset:1024 sc1
  buffer_load_dwordx4 a[72:75], v2, s[8:11], s22 offen offset:2048 sc1
  buffer_load_dwordx4 a[76:79], v2, s[8:11], s22 offen offset:3072 sc1
  s_add_u32 s22, s31, 307200
  buffer_load_dwordx4 a[80:83], v2, s[8:11], s22 offen offset:0 sc1
  buffer_load_dwordx4 a[84:87], v2, s[8:11], s22 offen offset:1024 sc1
  buffer_load_dwordx4 a[88:91], v2, s[8:11], s22 offen offset:2048 sc1
  buffer_load_dwordx4 a[92:95], v2, s[8:11], s22 offen offset:3072 sc1
  s_add_u32 s22, s31, 311296
  buffer_load_dwordx4 a[96:99], v2, s[8:11], s22 offen offset:0 sc1
  buffer_load_dwordx4 a[100:103], v2, s[8:11], s22 offen offset:1024 sc1
  buffer_load_dwordx4 a[104:107], v2, s[8:11], s22 offen offset:2048 sc1
  buffer_load_dwordx4 a[108:111], v2, s[8:11], s22 offen offset:3072 sc1
  s_add_u32 s22, s31, 315392
  buffer_load_dwordx4 a[112:115], v2, s[8:11], s22 offen offset:0 sc1
  buffer_load_dwordx4 a[116:119], v2, s[8:11], s22 offen offset:1024 sc1
  buffer_load_dwordx4 a[120:123], v2, s[8:11], s22 offen offset:2048 sc1
  buffer_load_dwordx4 a[124:127], v2, s[8:11], s22 offen offset:3072 sc1
  s_waitcnt vmcnt(24)
  s_add_u32 s22, s31, 319488
  buffer_load_dwordx4 a[128:131], v2, s[8:11], s22 offen offset:0 sc1
  buffer_load_dwordx4 a[132:135], v2, s[8:11], s22 offen offset:1024 sc1
  buffer_load_dwordx4 a[136:139], v2, s[8:11], s22 offen offset:2048 sc1
  buffer_load_dwordx4 a[140:143], v2, s[8:11], s22 offen offset:3072 sc1
  s_add_u32 s22, s31, 323584
  buffer_load_dwordx4 a[144:147], v2, s[8:11], s22 offen offset:0 sc1
  buffer_load_dwordx4 a[148:151], v2, s[8:11], s22 offen offset:1024 sc1
  buffer_load_dwordx4 a[152:155], v2, s[8:11], s22 offen offset:2048 sc1
  buffer_load_dwordx4 a[156:159], v2, s[8:11], s22 offen offset:3072 sc1
  s_add_u32 s22, s31, 327680
  buffer_load_dwordx4 a[160:163], v2, s[8:11], s22 offen offset:0 sc1
  buffer_load_dwordx4 a[164:167], v2, s[8:11], s22 offen offset:1024 sc1
  buffer_load_dwordx4 a[168:171], v2, s[8:11], s22 offen offset:2048 sc1
  buffer_load_dwordx4 a[172:175], v2, s[8:11], s22 offen offset:3072 sc1
  s_add_u32 s22, s31, 331776
  buffer_load_dwordx4 a[176:179], v2, s[8:11], s22 offen offset:0 sc1
  buffer_load_dwordx4 a[180:183], v2, s[8:11], s22 offen offset:1024 sc1
  buffer_load_dwordx4 a[184:187], v2, s[8:11], s22 offen offset:2048 sc1
  buffer_load_dwordx4 a[188:191], v2, s[8:11], s22 offen offset:3072 sc1
  s_add_u32 s22, s31, 335872
  buffer_load_dwordx4 a[192:195], v2, s[8:11], s22 offen offset:0 sc1
  buffer_load_dwordx4 a[196:199], v2, s[8:11], s22 offen offset:1024 sc1
  buffer_load_dwordx4 a[200:203], v2, s[8:11], s22 offen offset:2048 sc1
  buffer_load_dwordx4 a[204:207], v2, s[8:11], s22 offen offset:3072 sc1
  s_add_u32 s22, s31, 339968
  buffer_load_dwordx4 a[208:211], v2, s[8:11], s22 offen offset:0 sc1
  buffer_load_dwordx4 a[212:215], v2, s[8:11], s22 offen offset:1024 sc1
  buffer_load_dwordx4 a[216:219], v2, s[8:11], s22 offen offset:2048 sc1
  buffer_load_dwordx4 a[220:223], v2, s[8:11], s22 offen offset:3072 sc1
  s_add_u32 s22, s31, 344064
  buffer_load_dwordx4 a[224:227], v2, s[8:11], s22 offen offset:0 sc1
  buffer_load_dwordx4 a[228:231], v2, s[8:11], s22 offen offset:1024 sc1
  buffer_load_dwordx4 a[232:235], v2, s[8:11], s22 offen offset:2048 sc1
  buffer_load_dwordx4 a[236:239], v2, s[8:11], s22 offen offset:3072 sc1
  s_add_u32 s22, s31, 348160
  buffer_load_dwordx4 a[240:243], v2, s[8:11], s22 offen offset:0 sc1
  buffer_load_dwordx4 a[244:247], v2, s[8:11], s22 offen offset:1024 sc1
  buffer_load_dwordx4 a[248:251], v2, s[8:11], s22 offen offset:2048 sc1
  buffer_load_dwordx4 a[252:255], v2, s[8:11], s22 offen offset:3072 sc1
  s_waitcnt vmcnt(24)
  s_add_u32 s22, s31, 352256
  buffer_load_dwordx4 v[120:123], v2, s[8:11], s22 offen offset:0 sc1
  buffer_load_dwordx4 v[124:127], v2, s[8:11], s22 offen offset:1024 sc1
  buffer_load_dwordx4 v[128:131], v2, s[8:11], s22 offen offset:2048 sc1
  buffer_load_dwordx4 v[132:135], v2, s[8:11], s22 offen offset:3072 sc1
  s_add_u32 s22, s31, 356352
  buffer_load_dwordx4 v[136:139], v2, s[8:11], s22 offen offset:0 sc1
  buffer_load_dwordx4 v[140:143], v2, s[8:11], s22 offen offset:1024 sc1
  buffer_load_dwordx4 v[144:147], v2, s[8:11], s22 offen offset:2048 sc1
  buffer_load_dwordx4 v[148:151], v2, s[8:11], s22 offen offset:3072 sc1
  s_add_u32 s22, s31, 360448
  buffer_load_dwordx4 v[152:155], v2, s[8:11], s22 offen offset:0 sc1
  buffer_load_dwordx4 v[156:159], v2, s[8:11], s22 offen offset:1024 sc1
  buffer_load_dwordx4 v[160:163], v2, s[8:11], s22 offen offset:2048 sc1
  buffer_load_dwordx4 v[164:167], v2, s[8:11], s22 offen offset:3072 sc1
  s_add_u32 s22, s31, 364544
  buffer_load_dwordx4 v[168:171], v2, s[8:11], s22 offen offset:0 sc1
  buffer_load_dwordx4 v[172:175], v2, s[8:11], s22 offen offset:1024 sc1
  buffer_load_dwordx4 v[176:179], v2, s[8:11], s22 offen offset:2048 sc1
  buffer_load_dwordx4 v[180:183], v2, s[8:11], s22 offen offset:3072 sc1
  s_add_u32 s22, s31, 368640
  buffer_load_dwordx4 v[184:187], v2, s[8:11], s22 offen offset:0 sc1
  buffer_load_dwordx4 v[188:191], v2, s[8:11], s22 offen offset:1024 sc1
  buffer_load_dwordx4 v[192:195], v2, s[8:11], s22 offen offset:2048 sc1
  buffer_load_dwordx4 v[196:199], v2, s[8:11], s22 offen offset:3072 sc1
  s_add_u32 s22, s31, 372736
  buffer_load_dwordx4 v[200:203], v2, s[8:11], s22 offen offset:0 sc1
  buffer_load_dwordx4 v[204:207], v2, s[8:11], s22 offen offset:1024 sc1
  buffer_load_dwordx4 v[208:211], v2, s[8:11], s22 offen offset:2048 sc1
  buffer_load_dwordx4 v[212:215], v2, s[8:11], s22 offen offset:3072 sc1
  s_add_u32 s22, s31, 376832
  buffer_load_dwordx4 v[216:219], v2, s[8:11], s22 offen offset:0 sc1
  buffer_load_dwordx4 v[220:223], v2, s[8:11], s22 offen offset:1024 sc1
  buffer_load_dwordx4 v[224:227], v2, s[8:11], s22 offen offset:2048 sc1
  buffer_load_dwordx4 v[228:231], v2, s[8:11], s22 offen offset:3072 sc1
  s_add_u32 s22, s31, 380928
  buffer_load_dwordx4 v[232:235], v2, s[8:11], s22 offen offset:0 sc1
  buffer_load_dwordx4 v[236:239], v2, s[8:11], s22 offen offset:1024 sc1
  buffer_load_dwordx4 v[240:243], v2, s[8:11], s22 offen offset:2048 sc1
  buffer_load_dwordx4 v[244:247], v2, s[8:11], s22 offen offset:3072 sc1
  s_waitcnt vmcnt(24)
  s_add_u32 s22, s31, 385024
  buffer_load_dwordx4 v[248:251], v2, s[8:11], s22 offen offset:0 sc1
  buffer_load_dwordx4 v[252:255], v2, s[8:11], s22 offen offset:1024 sc1
  v_mov_b32 v72, v116
  v_mov_b32 v73, v117
  v_lshrrev_b32 v65, 1, v72
  v_and_b32 v66, 1, v72
  v_mov_b32 v67, 20
  v_lshl_add_u32 v67, v67, 4, v73
  v_mul_u32_u24 v68, 2341, v67
  v_lshrrev_b32 v68, 16, v68
  v_mul_u32_u24 v69, 28, v68
  v_sub_u32 v69, v67, v69
  v_lshrrev_b32 v70, 4, v69
  v_and_b32 v69, 15, v69
  v_and_b32 v71, 1, v69
  v_lshrrev_b32 v69, 1, v69
  v_lshl_add_u32 v69, v71, 3, v69
  v_lshlrev_b32 v71, 12, v70
  v_lshrrev_b32 v70, 1, v68
  v_lshl_add_u32 v71, v70, 9, v71
  v_and_b32 v70, 1, v68
  v_lshl_add_u32 v71, v70, 2, v71
  v_lshl_add_u32 v71, v69, 4, v71
  v_lshl_add_u32 v71, v65, 8, v71
  v_lshl_add_u32 v100, v66, 3, v71
  v_mov_b32 v67, 21
  v_lshl_add_u32 v67, v67, 4, v73
  v_mul_u32_u24 v68, 2341, v67
  v_lshrrev_b32 v68, 16, v68
  v_mul_u32_u24 v69, 28, v68
  v_sub_u32 v69, v67, v69
  v_lshrrev_b32 v70, 4, v69
  v_and_b32 v69, 15, v69
  v_and_b32 v71, 1, v69
  v_lshrrev_b32 v69, 1, v69
  v_lshl_add_u32 v69, v71, 3, v69
  v_lshlrev_b32 v71, 12, v70
  v_lshrrev_b32 v70, 1, v68
  v_lshl_add_u32 v71, v70, 9, v71
  v_and_b32 v70, 1, v68
  v_lshl_add_u32 v71, v70, 2, v71
  v_lshl_add_u32 v71, v69, 4, v71
  v_lshl_add_u32 v71, v65, 8, v71
  v_lshl_add_u32 v101, v66, 3, v71
  v_mov_b32 v67, 22
  v_lshl_add_u32 v67, v67, 4, v73
  v_mul_u32_u24 v68, 2341, v67
  v_lshrrev_b32 v68, 16, v68
  v_mul_u32_u24 v69, 28, v68
  v_sub_u32 v69, v67, v69
  v_lshrrev_b32 v70, 4, v69
  v_and_b32 v69, 15, v69
  v_and_b32 v71, 1, v69
  v_lshrrev_b32 v69, 1, v69
  v_lshl_add_u32 v69, v71, 3, v69
  v_lshlrev_b32 v71, 12, v70
  v_lshrrev_b32 v70, 1, v68
  v_lshl_add_u32 v71, v70, 9, v71
  v_and_b32 v70, 1, v68
  v_lshl_add_u32 v71, v70, 2, v71
  v_lshl_add_u32 v71, v69, 4, v71
  v_lshl_add_u32 v71, v65, 8, v71
  v_lshl_add_u32 v102, v66, 3, v71
  v_mov_b32 v67, 23
  v_lshl_add_u32 v67, v67, 4, v73
  v_mul_u32_u24 v68, 2341, v67
  v_lshrrev_b32 v68, 16, v68
  v_mul_u32_u24 v69, 28, v68
  v_sub_u32 v69, v67, v69
  v_lshrrev_b32 v70, 4, v69
  v_and_b32 v69, 15, v69
  v_and_b32 v71, 1, v69
  v_lshrrev_b32 v69, 1, v69
  v_lshl_add_u32 v69, v71, 3, v69
  v_lshlrev_b32 v71, 12, v70
  v_lshrrev_b32 v70, 1, v68
  v_lshl_add_u32 v71, v70, 9, v71
  v_and_b32 v70, 1, v68
  v_lshl_add_u32 v71, v70, 2, v71
  v_lshl_add_u32 v71, v69, 4, v71
  v_lshl_add_u32 v71, v65, 8, v71
  v_lshl_add_u32 v103, v66, 3, v71
  v_mov_b32 v67, 24
  v_lshl_add_u32 v67, v67, 4, v73
  v_mul_u32_u24 v68, 2341, v67
  v_lshrrev_b32 v68, 16, v68
  v_mul_u32_u24 v69, 28, v68
  v_sub_u32 v69, v67, v69
  v_lshrrev_b32 v70, 4, v69
  v_and_b32 v69, 15, v69
  v_and_b32 v71, 1, v69
  v_lshrrev_b32 v69, 1, v69
  v_lshl_add_u32 v69, v71, 3, v69
  v_lshlrev_b32 v71, 12, v70
  v_lshrrev_b32 v70, 1, v68
  v_lshl_add_u32 v71, v70, 9, v71
  v_and_b32 v70, 1, v68
  v_lshl_add_u32 v71, v70, 2, v71
  v_lshl_add_u32 v71, v69, 4, v71
  v_lshl_add_u32 v71, v65, 8, v71
  v_lshl_add_u32 v104, v66, 3, v71
  v_mov_b32 v67, 25
  v_lshl_add_u32 v67, v67, 4, v73
  v_mul_u32_u24 v68, 2341, v67
  v_lshrrev_b32 v68, 16, v68
  v_mul_u32_u24 v69, 28, v68
  v_sub_u32 v69, v67, v69
  v_lshrrev_b32 v70, 4, v69
  v_and_b32 v69, 15, v69
  v_and_b32 v71, 1, v69
  v_lshrrev_b32 v69, 1, v69
  v_lshl_add_u32 v69, v71, 3, v69
  v_lshlrev_b32 v71, 12, v70
  v_lshrrev_b32 v70, 1, v68
  v_lshl_add_u32 v71, v70, 9, v71
  v_and_b32 v70, 1, v68
  v_lshl_add_u32 v71, v70, 2, v71
  v_lshl_add_u32 v71, v69, 4, v71
  v_lshl_add_u32 v71, v65, 8, v71
  v_lshl_add_u32 v105, v66, 3, v71
  v_mov_b32 v67, 26
  v_lshl_add_u32 v67, v67, 4, v73
  v_mul_u32_u24 v68, 2341, v67
  v_lshrrev_b32 v68, 16, v68
  v_mul_u32_u24 v69, 28, v68
  v_sub_u32 v69, v67, v69
  v_lshrrev_b32 v70, 4, v69
  v_and_b32 v69, 15, v69
  v_and_b32 v71, 1, v69
  v_lshrrev_b32 v69, 1, v69
  v_lshl_add_u32 v69, v71, 3, v69
  v_lshlrev_b32 v71, 12, v70
  v_lshrrev_b32 v70, 1, v68
  v_lshl_add_u32 v71, v70, 9, v71
  v_and_b32 v70, 1, v68
  v_lshl_add_u32 v71, v70, 2, v71
  v_lshl_add_u32 v71, v69, 4, v71
  v_lshl_add_u32 v71, v65, 8, v71
  v_lshl_add_u32 v106, v66, 3, v71
  v_mov_b32 v67, 27
  v_lshl_add_u32 v67, v67, 4, v73
  v_mul_u32_u24 v68, 2341, v67
  v_lshrrev_b32 v68, 16, v68
  v_mul_u32_u24 v69, 28, v68
  v_sub_u32 v69, v67, v69
  v_lshrrev_b32 v70, 4, v69
  v_and_b32 v69, 15, v69
  v_and_b32 v71, 1, v69
  v_lshrrev_b32 v69, 1, v69
  v_lshl_add_u32 v69, v71, 3, v69
  v_lshlrev_b32 v71, 12, v70
  v_lshrrev_b32 v70, 1, v68
  v_lshl_add_u32 v71, v70, 9, v71
  v_and_b32 v70, 1, v68
  v_lshl_add_u32 v71, v70, 2, v71
  v_lshl_add_u32 v71, v69, 4, v71
  v_lshl_add_u32 v71, v65, 8, v71
  v_lshl_add_u32 v107, v66, 3, v71
  s_mul_i32 s24, s17, 532480
  s_add_u32 s24, s24, 76943360
  s_mul_i32 s34, s17, 640
  s_add_u32 s34, s34, 88582148
  s_mul_i32 s36, s17, 448
  v_add_u32 v0, s36, v2
  v_add_u32 v0, 8192, v0
  s_add_u32 s36, s36, 88080384
  s_mov_b32 s37, 76939264
  v_cmp_gt_u32 s[26:27], 28, v1
  v_and_b32 v119, 31, v1
  v_lshlrev_b32 v119, 2, v119
  v_and_b32 v119, 0x78, v119
  v_or_b32 v119, 4, v119
  s_add_u32 s22, s17, 16
  s_and_b32 s22, s22, 15
  s_lshl_b32 s22, s22, 7
  s_add_u32 s22, s22, 18432
  v_add_u32 v119, s22, v119
  v_min_u32 v118, 13, v1
  s_mul_i32 s22, s17, 14
  v_add_u32 v118, s22, v118
  v_lshlrev_b32 v118, 7, v118
  v_add_u32 v118, 57344, v118
  s_mov_b32 s39, 71565312
  v_add_u32 v1, 59392, v2
  v_mov_b32 v117, 1
  s_mul_i32 s38, s17, 1104
  s_add_u32 s38, s38, 21504
  v_bfe_u32 v8, v2, 4, 1
  v_mul_u32_u24 v3, 0xaaaa, v8
  v_add_u32 v3, 0x4444, v3
  v_bfe_u32 v9, v2, 5, 3
  v_lshl_add_u32 v8, v8, 3, v9
  v_and_b32 v9, 0x300, v2
  v_lshl_add_u32 v5, v8, 4, v9
  s_lshl_b32 s22, 0, 11
  s_add_u32 s22, s22, 88602624
  v_add_u32 v36, 1024, v2
  v_min_u32 v36, 1776, v36
  s_mov_b32 s30, 0
va_iw7:
  buffer_load_dwordx4 v[40:43], v2, s[8:11], s22 offen sc1
  buffer_load_dwordx4 v[44:47], v36, s[8:11], s22 offen sc1
  s_waitcnt vmcnt(0)
  v_cmp_ne_u64 vcc, s[88:89], v[40:41]
  s_cbranch_vccnz va_iw7_no
  v_cmp_ne_u64 vcc, s[88:89], v[42:43]
  s_cbranch_vccnz va_iw7_no
  v_cmp_ne_u64 vcc, s[88:89], v[44:45]
  s_cbranch_vccnz va_iw7_no
  v_cmp_ne_u64 vcc, s[88:89], v[46:47]
  s_cbranch_vccnz va_iw7_no
  s_branch va_iw7_ok
va_iw7_no:
  s_sleep 2
  s_add_u32 s30, s30, 1
  s_cmp_lt_u32 s30, 50000
  s_cbranch_scc1 va_iw7
  s_branch cA_abort
va_iw7_ok:
  s_mov_b32 s30, 0
  v_mov_b32 v36, 0
ch_md7:
  buffer_load_dword v37, v36, s[12:15], 0 offen sc1
  s_waitcnt vmcnt(0)
  v_readfirstlane_b32 s22, v37
  s_and_b32 s31, s22, 0xffff
  s_cmp_ge_u32 s31, 32
  s_cbranch_scc1 ch_go7
  s_sleep 2
  s_add_u32 s30, s30, 1
  s_cmp_lt_u32 s30, 50000
  s_cbranch_scc1 ch_md7
  s_branch ch_end
ch_go7:
  s_mov_b32 s31, 0
  s_lshr_b32 s22, s22, 16
  s_cmp_lg_u32 s22, 0
  s_cbranch_scc1 cB_va3_loop
  s_branch cA_va3_loop
.p2align 6

cA_sc0_loop:
  s_add_u32 s23, s20, 4096
  s_add_u32 s21, s20, 20480
  v_mov_b32 v48, 0
  v_mov_b32 v49, 0
  v_mov_b32 v50, 0
  v_mov_b32 v51, 0
  v_mov_b32 v52, 0
  v_mov_b32 v53, 0
  v_mov_b32 v54, 0
  v_mov_b32 v55, 0
  v_mov_b32 v56, 0
  v_mov_b32 v57, 0
  v_mov_b32 v58, 0
  v_mov_b32 v59, 0
  v_mov_b32 v60, 0
  v_mov_b32 v61, 0
  v_mov_b32 v62, 0
  v_mov_b32 v63, 0
  v_mov_b32 v88, 0
  v_mov_b32 v89, 0
  v_mov_b32 v90, 0
  v_mov_b32 v91, 0
  v_mov_b32 v92, 0
  v_mov_b32 v93, 0
  v_mov_b32 v94, 0
  v_mov_b32 v95, 0
  v_mov_b32 v66, 0
  v_mov_b32 v67, 0
  s_mov_b32 s30, 0
  s_mov_b32 s62, 0
  buffer_load_dword v68, v0, s[8:11], s20 offen sc1
  s_nop 7
  buffer_load_dword v69, v0, s[8:11], s20 offen sc1
  s_nop 7
  buffer_load_dword v70, v0, s[8:11], s20 offen sc1
  s_nop 7
  buffer_load_dword v71, v0, s[8:11], s20 offen sc1
  s_nop 7
  buffer_load_dword v72, v0, s[8:11], s20 offen sc1
cA_sc0_fp_l:
  s_waitcnt vmcnt(4)
  v_cmp_eq_u32 vcc, -1, v68
  s_cbranch_vccz cA_sc0_fp_d
  buffer_load_dword v68, v0, s[8:11], s20 offen sc1
  s_waitcnt vmcnt(4)
  v_cmp_eq_u32 vcc, -1, v69
  s_cbranch_vccz cA_sc0_fp_d
  buffer_load_dword v69, v0, s[8:11], s20 offen sc1
  s_waitcnt vmcnt(4)
  v_cmp_eq_u32 vcc, -1, v70
  s_cbranch_vccz cA_sc0_fp_d
  buffer_load_dword v70, v0, s[8:11], s20 offen sc1
  s_waitcnt vmcnt(4)
  v_cmp_eq_u32 vcc, -1, v71
  s_cbranch_vccz cA_sc0_fp_d
  buffer_load_dword v71, v0, s[8:11], s20 offen sc1
  s_waitcnt vmcnt(4)
  v_cmp_eq_u32 vcc, -1, v72
  s_cbranch_vccz cA_sc0_fp_d
  buffer_load_dword v72, v0, s[8:11], s20 offen sc1
  s_add_u32 s30, s30, 1
  s_cmp_lt_u32 s30, 400000
  s_cbranch_scc1 cA_sc0_fp_l
  s_branch cA_abort
cA_sc0_fp_d:
  buffer_load_dwordx4 v[8:11], v2, s[8:11], s20 offen offset:0
  s_barrier
  s_branch cA_sc0_ld1
cA_sc0_ld:
  buffer_load_dwordx4 v[8:11], v2, s[8:11], s20 offen offset:0
cA_sc0_ld1:
  v_mov_b32 v36, 0
  v_mov_b32 v37, 0
  v_mov_b32 v38, 0
  v_mov_b32 v39, 0
  buffer_load_dwordx4 v[12:15], v2, s[8:11], s20 offen offset:1024
  v_mov_b32 v40, 0
  v_mov_b32 v41, 0
  v_mov_b32 v42, 0
  v_mov_b32 v43, 0
  buffer_load_dwordx4 v[16:19], v2, s[8:11], s20 offen offset:2048
  v_mov_b32 v44, 0
  v_mov_b32 v45, 0
  v_mov_b32 v46, 0
  v_mov_b32 v47, 0
  ds_read_b128 v[96:99], v117 offset:0
  ds_read_b128 v[100:103], v117 offset:1024
  ds_read_b128 v[104:107], v117 offset:14336
  ds_read_b128 v[108:111], v117 offset:15360
  s_waitcnt vmcnt(2)
  v_smfmac_f32_16x16x64_bf16 v[36:39], v[8:11], a[0:7], v3
  v_smfmac_f32_16x16x64_bf16 v[40:43], v[8:11], a[56:63], v3
  buffer_load_dwordx4 v[20:23], v2, s[8:11], s20 offen offset:3072
  v_smfmac_f32_16x16x64_bf16 v[44:47], v[8:11], a[112:119], v3
  v_smfmac_f32_16x16x64_bf16 v[48:51], v[8:11], a[168:175], v3
  v_smfmac_f32_16x16x64_bf16 v[52:55], v[8:11], a[224:231], v3
  buffer_load_dwordx4 v[24:27], v2, s[8:11], s23 offen offset:0
  v_smfmac_f32_16x16x64_bf16 v[56:59], v[8:11], v[144:151], v3
  v_smfmac_f32_16x16x64_bf16 v[60:63], v[8:11], v[200:207], v3
  s_waitcnt vmcnt(3)
  v_smfmac_f32_16x16x64_bf16 v[36:39], v[12:15], a[8:15], v3
  v_smfmac_f32_16x16x64_bf16 v[40:43], v[12:15], a[64:71], v3
  buffer_load_dwordx4 v[28:31], v2, s[8:11], s23 offen offset:1024
  v_smfmac_f32_16x16x64_bf16 v[44:47], v[12:15], a[120:127], v3
  v_smfmac_f32_16x16x64_bf16 v[48:51], v[12:15], a[176:183], v3
  v_smfmac_f32_16x16x64_bf16 v[52:55], v[12:15], a[232:239], v3
  buffer_load_dwordx4 v[32:35], v2, s[8:11], s23 offen offset:2048
  v_smfmac_f32_16x16x64_bf16 v[56:59], v[12:15], v[152:159], v3
  v_smfmac_f32_16x16x64_bf16 v[60:63], v[12:15], v[208:215], v3
  s_xor_b32 s58, s25, 28672
  s_add_u32 s59, s24, 28672
  s_add_u32 m0, s58, 0
  s_waitcnt vmcnt(4)
  v_smfmac_f32_16x16x64_bf16 v[36:39], v[16:19], a[16:23], v3
  buffer_load_dwordx4 v2, s[8:11], s59 offen offset:0 sc1 lds
  v_smfmac_f32_16x16x64_bf16 v[40:43], v[16:19], a[72:79], v3
  v_smfmac_f32_16x16x64_bf16 v[44:47], v[16:19], a[128:135], v3
  v_smfmac_f32_16x16x64_bf16 v[48:51], v[16:19], a[184:191], v3
  v_smfmac_f32_16x16x64_bf16 v[52:55], v[16:19], a[240:247], v3
  buffer_load_dwordx4 v2, s[8:11], s59 offen offset:1024 sc1 lds
  v_smfmac_f32_16x16x64_bf16 v[56:59], v[16:19], v[160:167], v3
  v_smfmac_f32_16x16x64_bf16 v[60:63], v[16:19], v[216:223], v3
  s_waitcnt vmcnt(5)
  v_smfmac_f32_16x16x64_bf16 v[36:39], v[20:23], a[24:31], v3
  v_smfmac_f32_16x16x64_bf16 v[40:43], v[20:23], a[80:87], v3
  buffer_load_dwordx4 v2, s[8:11], s59 offen offset:2048 sc1 lds
  v_smfmac_f32_16x16x64_bf16 v[44:47], v[20:23], a[136:143], v3
  v_smfmac_f32_16x16x64_bf16 v[48:51], v[20:23], a[192:199], v3
  v_smfmac_f32_16x16x64_bf16 v[52:55], v[20:23], a[248:255], v3
  v_smfmac_f32_16x16x64_bf16 v[56:59], v[20:23], v[168:175], v3
  buffer_load_dwordx4 v2, s[8:11], s59 offen offset:3072 sc1 lds
  v_smfmac_f32_16x16x64_bf16 v[60:63], v[20:23], v[224:231], v3
  s_waitcnt vmcnt(4)
cA_sc0_ph2:
  v_smfmac_f32_16x16x64_bf16 v[60:63], v[24:27], v[232:239], v3
  ds_read_b128 v[12:15], v116 offset:0
  ds_read_b128 v[16:19], v116 offset:1024
  v_smfmac_f32_16x16x64_bf16 v[60:63], v[28:31], v[240:247], v3
  v_smfmac_f32_16x16x64_bf16 v[60:63], v[32:35], v[248:255], v3
  v_mov_b32 v80, v24
  v_smfmac_f32_16x16x64_bf16 v[52:55], v[24:27], v[120:127], v3
  v_mov_b32 v81, v25
  v_smfmac_f32_16x16x64_bf16 v[52:55], v[28:31], v[128:135], v3
  v_mov_b32 v82, v32
  v_smfmac_f32_16x16x64_bf16 v[52:55], v[32:35], v[136:143], v3
  v_cvt_pk_bf16_f32 v64, v60, v61
  v_smfmac_f32_16x16x64_bf16 v[56:59], v[24:27], v[176:183], v3
  v_cvt_pk_bf16_f32 v65, v62, v63
  v_smfmac_f32_16x16x64_bf16 v[56:59], v[28:31], v[184:191], v3
  v_mov_b32 v83, v33
  v_mfma_f32_16x16x32_bf16 v[68:71], v[64:67], v[4:7], 0
  v_smfmac_f32_16x16x64_bf16 v[56:59], v[32:35], v[192:199], v3
  v_cvt_pk_bf16_f32 v64, v52, v53
  v_smfmac_f32_16x16x64_bf16 v[36:39], v[24:27], a[32:39], v3
  v_cvt_pk_bf16_f32 v65, v54, v55
  v_smfmac_f32_16x16x64_bf16 v[36:39], v[28:31], a[40:47], v3
  v_cvt_pk_bf16_f32 v78, v68, v69
  v_smfmac_f32_16x16x64_bf16 v[36:39], v[32:35], a[48:55], v3
  v_cvt_pk_bf16_f32 v79, v70, v71
  v_cvt_pk_bf16_f32 v66, v56, v57
  v_smfmac_f32_16x16x64_bf16 v[40:43], v[24:27], a[88:95], v3
  v_cvt_pk_bf16_f32 v67, v58, v59
  v_smfmac_f32_16x16x64_bf16 v[40:43], v[28:31], a[96:103], v3
  v_mfma_f32_16x16x32_bf16 v[72:75], v[64:67], v[4:7], 0
  ds_read_b128 v[52:55], v116 offset:14336
  ds_read_b128 v[56:59], v116 offset:15360
  v_smfmac_f32_16x16x64_bf16 v[40:43], v[32:35], a[104:111], v3
  v_cvt_pk_bf16_f32 v64, v36, v37
  v_smfmac_f32_16x16x64_bf16 v[44:47], v[24:27], a[144:151], v3
  v_cvt_pk_bf16_f32 v65, v38, v39
  v_smfmac_f32_16x16x64_bf16 v[44:47], v[28:31], a[152:159], v3
  v_cvt_pk_bf16_f32 v76, v72, v73
  v_smfmac_f32_16x16x64_bf16 v[44:47], v[32:35], a[160:167], v3
  v_cvt_pk_bf16_f32 v77, v74, v75
  v_cvt_pk_bf16_f32 v66, v40, v41
  v_smfmac_f32_16x16x64_bf16 v[48:51], v[24:27], a[200:207], v3
  v_cvt_pk_bf16_f32 v67, v42, v43
  v_smfmac_f32_16x16x64_bf16 v[48:51], v[28:31], a[208:215], v3
  v_mfma_f32_16x16x32_bf16 v[68:71], v[64:67], v[4:7], 0
  v_smfmac_f32_16x16x64_bf16 v[48:51], v[32:35], a[216:223], v3
  v_cvt_pk_bf16_f32 v64, v44, v45
  v_mfma_f32_16x16x32_bf16 v[84:87], v[80:83], v[76:79], 0
  v_cvt_pk_bf16_f32 v65, v46, v47
  s_waitcnt lgkmcnt(0)
  v_smfmac_f32_16x16x64_bf16 v[88:91], v[76:79], v[96:103], v118
  v_cvt_pk_bf16_f32 v60, v68, v69
  v_cvt_pk_bf16_f32 v61, v70, v71
  v_cvt_pk_bf16_f32 v66, v48, v49
  v_cvt_pk_bf16_f32 v67, v50, v51
  s_nop 1
  v_mfma_f32_16x16x32_bf16 v[72:75], v[64:67], v[4:7], 0
  v_smfmac_f32_16x16x64_bf16 v[92:95], v[76:79], v[104:111], v118
  s_nop 4
  v_cvt_pk_bf16_f32 v62, v72, v73
  v_cvt_pk_bf16_f32 v63, v74, v75
  s_nop 1
  v_mfma_f32_16x16x32_bf16 v[84:87], v[8:11], v[60:63], v[84:87]
  v_smfmac_f32_16x16x64_bf16 v[88:91], v[60:63], v[12:19], v118
  v_smfmac_f32_16x16x64_bf16 v[92:95], v[60:63], v[52:59], v118
  s_nop 1
  v_permlane32_swap_b32 v84, v86
  v_permlane32_swap_b32 v85, v87
  s_nop 0
  v_add_f32 v88, v88, v89
  v_add_f32_dpp v84, v86, v84 quad_perm:[1,0,3,2] row_mask:0xf bank_mask:0xf
  v_add_f32_dpp v85, v87, v85 quad_perm:[1,0,3,2] row_mask:0xf bank_mask:0xf
  v_add_f32 v89, v90, v91
  ds_write2_b32 v113, v84, v85 offset0:0 offset1:4
  ds_write2_b32 v112, v88, v89 offset0:0 offset1:128
  v_add_f32 v90, v92, v93
  v_add_f32 v91, v94, v95
  ds_write2_b32 v112, v90, v91 offset0:64 offset1:192
  v_cmp_u_f32 vcc, v88, v89
  s_cbranch_vccnz cA_sc0_retry
cA_sc0_cont:
  s_waitcnt lgkmcnt(0)
  s_barrier
  ds_read_b128 v[36:39], v114
  ds_read_b128 v[44:47], v115
  s_waitcnt lgkmcnt(0)
  v_add_f32 v36, v36, v38
  v_add_f32 v37, v37, v39
  v_add_f32 v44, v44, v45
  v_add_f32 v46, v46, v47
  v_add_f32 v44, v44, v46
  v_add_f32 v36, v36, v37
  v_exp_f32 v49, v44
  v_exp_f32 v48, v36
  v_add_f32 v50, abs(v36), abs(v44)
  v_fma_f32 v39, v49, s37, v48
  v_cmp_ngt_f32 vcc, s56, v50
  v_cndmask_b32 v41, v48, v49, s[38:39]
  v_add_f32_dpp v39, v39, v39 quad_perm:[1,0,3,2] row_mask:0xf bank_mask:0xf
  v_cndmask_b32 v40, v49, v48, s[38:39]
  v_mov_b32_dpp v46, v41 quad_perm:[1,0,3,2] row_mask:0xf bank_mask:0xf
  v_add_f32_dpp v39, v39, v39 quad_perm:[2,3,0,1] row_mask:0xf bank_mask:0xf
  v_cndmask_b32 v42, v46, v40, s[38:39]
  v_cndmask_b32 v43, v40, v46, s[38:39]
  v_add_f32_dpp v39, v39, v39 row_half_mirror row_mask:0xf bank_mask:0xf
  s_cbranch_vccnz cA_sc0_slow
  s_nop 0
  v_add_f32_dpp v47, v39, v39 row_mirror row_mask:0xf bank_mask:0xf
  v_add_f32_dpp v39, v39, v39 row_mirror row_mask:0xf bank_mask:0xf
  s_nop 1
  v_permlane16_swap_b32 v39, v47
  v_add_f32 v39, v39, v47
  v_rcp_f32 v39, v39
  s_mov_b64 exec, s[28:29]
  v_mul_f32 v42, v42, v39
  v_mul_f32 v43, v43, v39
  v_cvt_pk_bf16_f32 v42, v42, v43
cA_sc0_pst:
  buffer_store_dword v42, v1, s[8:11], s20 offen
  s_mov_b64 exec, -1
  s_barrier
  s_add_u32 s24, s24, 28672
  s_add_u32 s35, s35, 28672
  s_xor_b32 s25, s25, 28672
  s_add_u32 m0, s25, 0
  s_add_u32 m0, s25, 4096
  s_add_u32 s22, s24, 4096
  buffer_load_dwordx4 v2, s[8:11], s22 offen offset:0 sc1 lds
  s_nop 5
  buffer_load_dwordx4 v2, s[8:11], s22 offen offset:1024 sc1 lds
  s_nop 5
  buffer_load_dwordx4 v2, s[8:11], s22 offen offset:2048 sc1 lds
  s_nop 5
  v_xor_b32 v116, 28672, v116
  v_add_u32 v117, s57, v117
  s_sub_u32 s57, 0, s57
  s_add_u32 s19, s19, 1
  s_mov_b32 s20, s21
  s_cmp_lt_u32 s19, 63
  s_cbranch_scc1 cA_sc0_loop
  s_branch cA_done
cA_sc0_slow:
  v_max_f32 v50, v36, v44
  s_nop 1
  v_max_f32_dpp v50, v50, v50 quad_perm:[1,0,3,2] row_mask:0xf bank_mask:0xf
  s_nop 1
  v_max_f32_dpp v50, v50, v50 quad_perm:[2,3,0,1] row_mask:0xf bank_mask:0xf
  s_nop 1
  v_max_f32_dpp v50, v50, v50 row_half_mirror row_mask:0xf bank_mask:0xf
  s_nop 1
  v_max_f32_dpp v50, v50, v50 row_mirror row_mask:0xf bank_mask:0xf
  v_mov_b32 v47, v50
  s_nop 1
  v_permlane16_swap_b32 v50, v47
  v_max_f32 v50, v50, v47
  v_sub_f32 v48, v36, v50
  v_sub_f32 v49, v44, v50
  v_exp_f32 v48, v48
  v_exp_f32 v49, v49
  s_add_u32 s31, s31, 0x100
  v_fma_f32 v39, v49, s37, v48
  v_cndmask_b32 v41, v48, v49, s[38:39]
  s_nop 0
  v_add_f32_dpp v39, v39, v39 quad_perm:[1,0,3,2] row_mask:0xf bank_mask:0xf
  v_cndmask_b32 v40, v49, v48, s[38:39]
  v_mov_b32_dpp v46, v41 quad_perm:[1,0,3,2] row_mask:0xf bank_mask:0xf
  v_add_f32_dpp v39, v39, v39 quad_perm:[2,3,0,1] row_mask:0xf bank_mask:0xf
  v_cndmask_b32 v42, v46, v40, s[38:39]
  v_cndmask_b32 v43, v40, v46, s[38:39]
  v_add_f32_dpp v39, v39, v39 row_half_mirror row_mask:0xf bank_mask:0xf
  s_nop 1
  v_add_f32_dpp v47, v39, v39 row_mirror row_mask:0xf bank_mask:0xf
  v_add_f32_dpp v39, v39, v39 row_mirror row_mask:0xf bank_mask:0xf
  s_nop 1
  v_permlane16_swap_b32 v39, v47
  v_add_f32 v39, v39, v47
  v_rcp_f32 v39, v39
  s_mov_b64 exec, s[28:29]
  v_mul_f32 v42, v42, v39
  v_mul_f32 v43, v43, v39
  v_cvt_pk_bf16_f32 v42, v42, v43
  v_min_u32 v42, -2, v42
  s_branch cA_sc0_pst
cA_sc0_retry:
  s_cmp_lg_u32 s62, 0
  s_cbranch_scc1 cA_sc0_cont
  s_waitcnt vmcnt(0) lgkmcnt(0)
cA_sc0_rv:
  buffer_load_dwordx4 v[8:11], v2, s[8:11], s20 offen offset:0 sc1
  buffer_load_dwordx4 v[12:15], v2, s[8:11], s20 offen offset:1024 sc1
  buffer_load_dwordx4 v[16:19], v2, s[8:11], s20 offen offset:2048 sc1
  buffer_load_dwordx4 v[20:23], v2, s[8:11], s20 offen offset:3072 sc1
  buffer_load_dwordx4 v[24:27], v2, s[8:11], s23 offen offset:0 sc1
  buffer_load_dwordx4 v[28:31], v2, s[8:11], s23 offen offset:1024 sc1
  buffer_load_dwordx4 v[32:35], v2, s[8:11], s23 offen offset:2048 sc1
  s_waitcnt vmcnt(0)
  v_max3_u32 v68, v8, v9, v10
  v_max3_u32 v68, v68, v11, v12
  v_max3_u32 v68, v68, v13, v14
  v_max3_u32 v68, v68, v15, v16
  v_max3_u32 v68, v68, v17, v18
  v_max3_u32 v68, v68, v19, v20
  v_max3_u32 v68, v68, v21, v22
  v_max3_u32 v68, v68, v23, v24
  v_max3_u32 v68, v68, v25, v26
  v_max3_u32 v68, v68, v27, v28
  v_max3_u32 v68, v68, v29, v30
  v_max3_u32 v68, v68, v31, v32
  v_max3_u32 v68, v68, v33, v34
  v_max_u32 v68, v68, v35
  v_cmp_eq_u32 vcc, -1, v68
  s_cbranch_vccz cA_sc0_rk
  s_add_u32 s30, s30, 1
  s_cmp_lt_u32 s30, 400000
  s_cbranch_scc1 cA_sc0_rv
  s_branch cA_abort
cA_sc0_rk:
  s_mov_b32 s62, 1
  v_mov_b32 v36, 0
  v_mov_b32 v37, 0
  v_mov_b32 v38, 0
  v_mov_b32 v39, 0
  v_mov_b32 v40, 0
  v_mov_b32 v41, 0
  v_mov_b32 v42, 0
  v_mov_b32 v43, 0
  v_mov_b32 v44, 0
  v_mov_b32 v45, 0
  v_mov_b32 v46, 0
  v_mov_b32 v47, 0
  v_mov_b32 v48, 0
  v_mov_b32 v49, 0
  v_mov_b32 v50, 0
  v_mov_b32 v51, 0
  v_mov_b32 v52, 0
  v_mov_b32 v53, 0
  v_mov_b32 v54, 0
  v_mov_b32 v55, 0
  v_mov_b32 v56, 0
  v_mov_b32 v57, 0
  v_mov_b32 v58, 0
  v_mov_b32 v59, 0
  v_mov_b32 v60, 0
  v_mov_b32 v61, 0
  v_mov_b32 v62, 0
  v_mov_b32 v63, 0
  v_mov_b32 v88, 0
  v_mov_b32 v89, 0
  v_mov_b32 v90, 0
  v_mov_b32 v91, 0
  v_mov_b32 v92, 0
  v_mov_b32 v93, 0
  v_mov_b32 v94, 0
  v_mov_b32 v95, 0
  v_mov_b32 v66, 0
  v_mov_b32 v67, 0
  s_add_u32 s31, s31, 1
  ds_read_b128 v[96:99], v117 offset:0
  ds_read_b128 v[100:103], v117 offset:1024
  ds_read_b128 v[104:107], v117 offset:14336
  ds_read_b128 v[108:111], v117 offset:15360
  v_smfmac_f32_16x16x64_bf16 v[36:39], v[8:11], a[0:7], v3
  v_smfmac_f32_16x16x64_bf16 v[40:43], v[8:11], a[56:63], v3
  v_smfmac_f32_16x16x64_bf16 v[44:47], v[8:11], a[112:119], v3
  v_smfmac_f32_16x16x64_bf16 v[48:51], v[8:11], a[168:175], v3
  v_smfmac_f32_16x16x64_bf16 v[52:55], v[8:11], a[224:231], v3
  v_smfmac_f32_16x16x64_bf16 v[56:59], v[8:11], v[144:151], v3
  v_smfmac_f32_16x16x64_bf16 v[60:63], v[8:11], v[200:207], v3
  v_smfmac_f32_16x16x64_bf16 v[36:39], v[12:15], a[8:15], v3
  v_smfmac_f32_16x16x64_bf16 v[40:43], v[12:15], a[64:71], v3
  v_smfmac_f32_16x16x64_bf16 v[44:47], v[12:15], a[120:127], v3
  v_smfmac_f32_16x16x64_bf16 v[48:51], v[12:15], a[176:183], v3
  v_smfmac_f32_16x16x64_bf16 v[52:55], v[12:15], a[232:239], v3
  v_smfmac_f32_16x16x64_bf16 v[56:59], v[12:15], v[152:159], v3
  v_smfmac_f32_16x16x64_bf16 v[60:63], v[12:15], v[208:215], v3
  v_smfmac_f32_16x16x64_bf16 v[36:39], v[16:19], a[16:23], v3
  v_smfmac_f32_16x16x64_bf16 v[40:43], v[16:19], a[72:79], v3
  v_smfmac_f32_16x16x64_bf16 v[44:47], v[16:19], a[128:135], v3
  v_smfmac_f32_16x16x64_bf16 v[48:51], v[16:19], a[184:191], v3
  v_smfmac_f32_16x16x64_bf16 v[52:55], v[16:19], a[240:247], v3
  v_smfmac_f32_16x16x64_bf16 v[56:59], v[16:19], v[160:167], v3
  v_smfmac_f32_16x16x64_bf16 v[60:63], v[16:19], v[216:223], v3
  v_smfmac_f32_16x16x64_bf16 v[36:39], v[20:23], a[24:31], v3
  v_smfmac_f32_16x16x64_bf16 v[40:43], v[20:23], a[80:87], v3
  v_smfmac_f32_16x16x64_bf16 v[44:47], v[20:23], a[136:143], v3
  v_smfmac_f32_16x16x64_bf16 v[48:51], v[20:23], a[192:199], v3
  v_smfmac_f32_16x16x64_bf16 v[52:55], v[20:23], a[248:255], v3
  v_smfmac_f32_16x16x64_bf16 v[56:59], v[20:23], v[168:175], v3
  v_smfmac_f32_16x16x64_bf16 v[60:63], v[20:23], v[224:231], v3
  s_xor_b32 s58, s25, 28672
  s_add_u32 s59, s24, 28672
  s_add_u32 m0, s58, 0
  s_branch cA_sc0_ph2
.p2align 6

cA_sc1_loop:
  s_add_u32 s23, s20, 4096
  s_add_u32 s21, s20, 20480
  v_mov_b32 v48, 0
  v_mov_b32 v49, 0
  v_mov_b32 v50, 0
  v_mov_b32 v51, 0
  v_mov_b32 v52, 0
  v_mov_b32 v53, 0
  v_mov_b32 v54, 0
  v_mov_b32 v55, 0
  v_mov_b32 v56, 0
  v_mov_b32 v57, 0
  v_mov_b32 v58, 0
  v_mov_b32 v59, 0
  v_mov_b32 v60, 0
  v_mov_b32 v61, 0
  v_mov_b32 v62, 0
  v_mov_b32 v63, 0
  v_mov_b32 v88, 0
  v_mov_b32 v89, 0
  v_mov_b32 v90, 0
  v_mov_b32 v91, 0
  v_mov_b32 v92, 0
  v_mov_b32 v93, 0
  v_mov_b32 v94, 0
  v_mov_b32 v95, 0
  v_mov_b32 v64, 0
  v_mov_b32 v65, 0
  s_mov_b32 s30, 0
  s_mov_b32 s62, 0
  s_waitcnt vmcnt(0)
  s_barrier
cA_sc1_ld:
  buffer_load_dwordx4 v[8:11], v2, s[8:11], s20 offen offset:0
  v_mov_b32 v36, 0
  v_mov_b32 v37, 0
  v_mov_b32 v38, 0
  v_mov_b32 v39, 0
  buffer_load_dwordx4 v[12:15], v2, s[8:11], s20 offen offset:1024
  v_mov_b32 v40, 0
  v_mov_b32 v41, 0
  v_mov_b32 v42, 0
  v_mov_b32 v43, 0
  buffer_load_dwordx4 v[16:19], v2, s[8:11], s20 offen offset:2048
  v_mov_b32 v44, 0
  v_mov_b32 v45, 0
  v_mov_b32 v46, 0
  v_mov_b32 v47, 0
  ds_read_b128 v[96:99], v117 offset:0
  ds_read_b128 v[100:103], v117 offset:1024
  ds_read_b128 v[104:107], v117 offset:14336
  ds_read_b128 v[108:111], v117 offset:15360
  s_waitcnt vmcnt(2)
  v_smfmac_f32_16x16x64_bf16 v[36:39], v[8:11], a[0:7], v3
  v_smfmac_f32_16x16x64_bf16 v[40:43], v[8:11], a[56:63], v3
  buffer_load_dwordx4 v[20:23], v2, s[8:11], s20 offen offset:3072
  v_smfmac_f32_16x16x64_bf16 v[44:47], v[8:11], a[112:119], v3
  v_smfmac_f32_16x16x64_bf16 v[48:51], v[8:11], a[168:175], v3
  v_smfmac_f32_16x16x64_bf16 v[52:55], v[8:11], a[224:231], v3
  buffer_load_dwordx4 v[24:27], v2, s[8:11], s23 offen offset:0
  v_smfmac_f32_16x16x64_bf16 v[56:59], v[8:11], v[144:151], v3
  v_smfmac_f32_16x16x64_bf16 v[60:63], v[8:11], v[200:207], v3
  s_waitcnt vmcnt(3)
  v_smfmac_f32_16x16x64_bf16 v[36:39], v[12:15], a[8:15], v3
  v_smfmac_f32_16x16x64_bf16 v[40:43], v[12:15], a[64:71], v3
  buffer_load_dwordx4 v[28:31], v2, s[8:11], s23 offen offset:1024
  v_smfmac_f32_16x16x64_bf16 v[44:47], v[12:15], a[120:127], v3
  v_smfmac_f32_16x16x64_bf16 v[48:51], v[12:15], a[176:183], v3
  v_smfmac_f32_16x16x64_bf16 v[52:55], v[12:15], a[232:239], v3
  buffer_load_dwordx4 v[32:35], v2, s[8:11], s23 offen offset:2048
  v_smfmac_f32_16x16x64_bf16 v[56:59], v[12:15], v[152:159], v3
  v_smfmac_f32_16x16x64_bf16 v[60:63], v[12:15], v[208:215], v3
  s_waitcnt vmcnt(4)
  v_smfmac_f32_16x16x64_bf16 v[36:39], v[16:19], a[16:23], v3
  s_xor_b32 s58, s25, 28672
  s_add_u32 s59, s24, 28672
  s_add_u32 m0, s58, 7168
  v_smfmac_f32_16x16x64_bf16 v[40:43], v[16:19], a[72:79], v3
  buffer_load_dwordx4 v2, s[8:11], s59 offen offset:0 sc1 lds
  v_smfmac_f32_16x16x64_bf16 v[44:47], v[16:19], a[128:135], v3
  v_smfmac_f32_16x16x64_bf16 v[48:51], v[16:19], a[184:191], v3
  v_smfmac_f32_16x16x64_bf16 v[52:55], v[16:19], a[240:247], v3
  v_smfmac_f32_16x16x64_bf16 v[56:59], v[16:19], v[160:167], v3
  buffer_load_dwordx4 v2, s[8:11], s59 offen offset:1024 sc1 lds
  v_smfmac_f32_16x16x64_bf16 v[60:63], v[16:19], v[216:223], v3
  s_waitcnt vmcnt(5)
  v_smfmac_f32_16x16x64_bf16 v[36:39], v[20:23], a[24:31], v3
  v_smfmac_f32_16x16x64_bf16 v[40:43], v[20:23], a[80:87], v3
  v_smfmac_f32_16x16x64_bf16 v[44:47], v[20:23], a[136:143], v3
  buffer_load_dwordx4 v2, s[8:11], s59 offen offset:2048 sc1 lds
  v_smfmac_f32_16x16x64_bf16 v[48:51], v[20:23], a[192:199], v3
  v_smfmac_f32_16x16x64_bf16 v[52:55], v[20:23], a[248:255], v3
  v_smfmac_f32_16x16x64_bf16 v[56:59], v[20:23], v[168:175], v3
  v_smfmac_f32_16x16x64_bf16 v[60:63], v[20:23], v[224:231], v3
  buffer_load_dwordx4 v2, s[8:11], s59 offen offset:3072 sc1 lds
  s_waitcnt vmcnt(4)
cA_sc1_ph2:
  v_smfmac_f32_16x16x64_bf16 v[60:63], v[24:27], v[232:239], v3
  ds_read_b128 v[16:19], v116 offset:2048
  ds_read_b128 v[20:23], v116 offset:3072
  v_smfmac_f32_16x16x64_bf16 v[60:63], v[28:31], v[240:247], v3
  buffer_load_dword v119, v0, s[8:11], s20 offen sc1
  v_smfmac_f32_16x16x64_bf16 v[60:63], v[32:35], v[248:255], v3
  v_mov_b32 v80, v26
  v_smfmac_f32_16x16x64_bf16 v[52:55], v[24:27], v[120:127], v3
  v_mov_b32 v81, v27
  v_smfmac_f32_16x16x64_bf16 v[52:55], v[28:31], v[128:135], v3
  v_mov_b32 v82, v32
  v_smfmac_f32_16x16x64_bf16 v[52:55], v[32:35], v[136:143], v3
  v_cvt_pk_bf16_f32 v66, v60, v61
  v_smfmac_f32_16x16x64_bf16 v[56:59], v[24:27], v[176:183], v3
  v_cvt_pk_bf16_f32 v67, v62, v63
  v_smfmac_f32_16x16x64_bf16 v[56:59], v[28:31], v[184:191], v3
  v_mov_b32 v83, v33
  v_mfma_f32_16x16x32_bf16 v[68:71], v[64:67], v[4:7], 0
  v_smfmac_f32_16x16x64_bf16 v[56:59], v[32:35], v[192:199], v3
  v_cvt_pk_bf16_f32 v64, v52, v53
  v_smfmac_f32_16x16x64_bf16 v[36:39], v[24:27], a[32:39], v3
  v_cvt_pk_bf16_f32 v65, v54, v55
  v_smfmac_f32_16x16x64_bf16 v[36:39], v[28:31], a[40:47], v3
  v_cvt_pk_bf16_f32 v78, v68, v69
  v_smfmac_f32_16x16x64_bf16 v[36:39], v[32:35], a[48:55], v3
  v_cvt_pk_bf16_f32 v79, v70, v71
  v_cvt_pk_bf16_f32 v66, v56, v57
  v_smfmac_f32_16x16x64_bf16 v[40:43], v[24:27], a[88:95], v3
  v_cvt_pk_bf16_f32 v67, v58, v59
  v_smfmac_f32_16x16x64_bf16 v[40:43], v[28:31], a[96:103], v3
  v_mfma_f32_16x16x32_bf16 v[72:75], v[64:67], v[4:7], 0
  ds_read_b128 v[52:55], v116 offset:16384
  ds_read_b128 v[56:59], v116 offset:17408
  v_smfmac_f32_16x16x64_bf16 v[40:43], v[32:35], a[104:111], v3
  v_cvt_pk_bf16_f32 v64, v36, v37
  v_smfmac_f32_16x16x64_bf16 v[44:47], v[24:27], a[144:151], v3
  v_cvt_pk_bf16_f32 v65, v38, v39
  v_smfmac_f32_16x16x64_bf16 v[44:47], v[28:31], a[152:159], v3
  v_cvt_pk_bf16_f32 v76, v72, v73
  v_smfmac_f32_16x16x64_bf16 v[44:47], v[32:35], a[160:167], v3
  v_cvt_pk_bf16_f32 v77, v74, v75
  v_cvt_pk_bf16_f32 v66, v40, v41
  v_smfmac_f32_16x16x64_bf16 v[48:51], v[24:27], a[200:207], v3
  v_cvt_pk_bf16_f32 v67, v42, v43
  v_smfmac_f32_16x16x64_bf16 v[48:51], v[28:31], a[208:215], v3
  v_mfma_f32_16x16x32_bf16 v[68:71], v[64:67], v[4:7], 0
  v_smfmac_f32_16x16x64_bf16 v[48:51], v[32:35], a[216:223], v3
  v_cvt_pk_bf16_f32 v64, v44, v45
  v_mfma_f32_16x16x32_bf16 v[84:87], v[80:83], v[76:79], 0
  v_cvt_pk_bf16_f32 v65, v46, v47
  s_waitcnt lgkmcnt(0)
  v_smfmac_f32_16x16x64_bf16 v[88:91], v[76:79], v[96:103], v118
  v_cvt_pk_bf16_f32 v60, v68, v69
  v_cvt_pk_bf16_f32 v61, v70, v71
  v_cvt_pk_bf16_f32 v66, v48, v49
  v_cvt_pk_bf16_f32 v67, v50, v51
  s_nop 1
  v_mfma_f32_16x16x32_bf16 v[72:75], v[64:67], v[4:7], 0
  v_smfmac_f32_16x16x64_bf16 v[92:95], v[76:79], v[104:111], v118
  s_nop 4
  v_cvt_pk_bf16_f32 v62, v72, v73
  v_cvt_pk_bf16_f32 v63, v74, v75
  s_nop 1
  v_mfma_f32_16x16x32_bf16 v[84:87], v[12:15], v[60:63], v[84:87]
  v_smfmac_f32_16x16x64_bf16 v[88:91], v[60:63], v[16:23], v118
  v_smfmac_f32_16x16x64_bf16 v[92:95], v[60:63], v[52:59], v118
  s_nop 1
  v_permlane32_swap_b32 v84, v86
  v_permlane32_swap_b32 v85, v87
  s_nop 0
  v_add_f32 v88, v88, v89
  v_add_f32_dpp v84, v86, v84 quad_perm:[1,0,3,2] row_mask:0xf bank_mask:0xf
  v_add_f32_dpp v85, v87, v85 quad_perm:[1,0,3,2] row_mask:0xf bank_mask:0xf
  v_add_f32 v89, v90, v91
  ds_write2_b32 v113, v84, v85 offset0:0 offset1:4
  ds_write2_b32 v112, v88, v89 offset0:0 offset1:128
  v_add_f32 v90, v92, v93
  v_add_f32 v91, v94, v95
  ds_write2_b32 v112, v90, v91 offset0:64 offset1:192
  v_cmp_u_f32 vcc, v88, v89
  s_cbranch_vccnz cA_sc1_retry
cA_sc1_cont:
  s_waitcnt lgkmcnt(0)
  s_barrier
  ds_read_b128 v[36:39], v114
  ds_read_b128 v[44:47], v115
  s_waitcnt lgkmcnt(0)
  v_add_f32 v36, v36, v38
  v_add_f32 v37, v37, v39
  v_add_f32 v44, v44, v45
  v_add_f32 v46, v46, v47
  v_add_f32 v44, v44, v46
  v_add_f32 v36, v36, v37
  v_exp_f32 v49, v44
  v_exp_f32 v48, v36
  v_add_f32 v50, abs(v36), abs(v44)
  v_fma_f32 v39, v49, s37, v48
  v_cmp_ngt_f32 vcc, s56, v50
  v_cndmask_b32 v41, v48, v49, s[38:39]
  v_add_f32_dpp v39, v39, v39 quad_perm:[1,0,3,2] row_mask:0xf bank_mask:0xf
  v_cndmask_b32 v40, v49, v48, s[38:39]
  v_mov_b32_dpp v46, v41 quad_perm:[1,0,3,2] row_mask:0xf bank_mask:0xf
  v_add_f32_dpp v39, v39, v39 quad_perm:[2,3,0,1] row_mask:0xf bank_mask:0xf
  v_cndmask_b32 v42, v46, v40, s[38:39]
  v_cndmask_b32 v43, v40, v46, s[38:39]
  v_add_f32_dpp v39, v39, v39 row_half_mirror row_mask:0xf bank_mask:0xf
  s_cbranch_vccnz cA_sc1_slow
  s_nop 0
  v_add_f32_dpp v47, v39, v39 row_mirror row_mask:0xf bank_mask:0xf
  v_add_f32_dpp v39, v39, v39 row_mirror row_mask:0xf bank_mask:0xf
  s_nop 1
  v_permlane16_swap_b32 v39, v47
  v_add_f32 v39, v39, v47
  v_rcp_f32 v39, v39
  s_mov_b64 exec, s[28:29]
  v_mul_f32 v42, v42, v39
  v_mul_f32 v43, v43, v39
  v_cvt_pk_bf16_f32 v42, v42, v43
cA_sc1_pst:
  buffer_store_dword v42, v1, s[8:11], s20 offen
  s_mov_b64 exec, -1
  s_barrier
  s_add_u32 s24, s24, 28672
  s_add_u32 s35, s35, 28672
  s_xor_b32 s25, s25, 28672
  s_add_u32 m0, s25, 7168
  s_add_u32 m0, s25, 11264
  s_add_u32 s22, s24, 4096
  buffer_load_dwordx4 v2, s[8:11], s22 offen offset:0 sc1 lds
  s_nop 5
  buffer_load_dwordx4 v2, s[8:11], s22 offen offset:1024 sc1 lds
  s_nop 5
  buffer_load_dwordx4 v2, s[8:11], s22 offen offset:2048 sc1 lds
  s_nop 5
  v_xor_b32 v116, 28672, v116
  v_add_u32 v117, s57, v117
  s_sub_u32 s57, 0, s57
  s_add_u32 s19, s19, 1
  s_mov_b32 s20, s21
  s_cmp_lt_u32 s19, 63
  s_cbranch_scc1 cA_sc1_loop
  s_branch cA_done
cA_sc1_slow:
  v_max_f32 v50, v36, v44
  s_nop 1
  v_max_f32_dpp v50, v50, v50 quad_perm:[1,0,3,2] row_mask:0xf bank_mask:0xf
  s_nop 1
  v_max_f32_dpp v50, v50, v50 quad_perm:[2,3,0,1] row_mask:0xf bank_mask:0xf
  s_nop 1
  v_max_f32_dpp v50, v50, v50 row_half_mirror row_mask:0xf bank_mask:0xf
  s_nop 1
  v_max_f32_dpp v50, v50, v50 row_mirror row_mask:0xf bank_mask:0xf
  v_mov_b32 v47, v50
  s_nop 1
  v_permlane16_swap_b32 v50, v47
  v_max_f32 v50, v50, v47
  v_sub_f32 v48, v36, v50
  v_sub_f32 v49, v44, v50
  v_exp_f32 v48, v48
  v_exp_f32 v49, v49
  s_add_u32 s31, s31, 0x100
  v_fma_f32 v39, v49, s37, v48
  v_cndmask_b32 v41, v48, v49, s[38:39]
  s_nop 0
  v_add_f32_dpp v39, v39, v39 quad_perm:[1,0,3,2] row_mask:0xf bank_mask:0xf
  v_cndmask_b32 v40, v49, v48, s[38:39]
  v_mov_b32_dpp v46, v41 quad_perm:[1,0,3,2] row_mask:0xf bank_mask:0xf
  v_add_f32_dpp v39, v39, v39 quad_perm:[2,3,0,1] row_mask:0xf bank_mask:0xf
  v_cndmask_b32 v42, v46, v40, s[38:39]
  v_cndmask_b32 v43, v40, v46, s[38:39]
  v_add_f32_dpp v39, v39, v39 row_half_mirror row_mask:0xf bank_mask:0xf
  s_nop 1
  v_add_f32_dpp v47, v39, v39 row_mirror row_mask:0xf bank_mask:0xf
  v_add_f32_dpp v39, v39, v39 row_mirror row_mask:0xf bank_mask:0xf
  s_nop 1
  v_permlane16_swap_b32 v39, v47
  v_add_f32 v39, v39, v47
  v_rcp_f32 v39, v39
  s_mov_b64 exec, s[28:29]
  v_mul_f32 v42, v42, v39
  v_mul_f32 v43, v43, v39
  v_cvt_pk_bf16_f32 v42, v42, v43
  v_min_u32 v42, -2, v42
  s_branch cA_sc1_pst
cA_sc1_retry:
  s_cmp_lg_u32 s62, 0
  s_cbranch_scc1 cA_sc1_cont
  s_waitcnt vmcnt(0) lgkmcnt(0)
cA_sc1_rv:
  buffer_load_dwordx4 v[8:11], v2, s[8:11], s20 offen offset:0 sc1
  buffer_load_dwordx4 v[12:15], v2, s[8:11], s20 offen offset:1024 sc1
  buffer_load_dwordx4 v[16:19], v2, s[8:11], s20 offen offset:2048 sc1
  buffer_load_dwordx4 v[20:23], v2, s[8:11], s20 offen offset:3072 sc1
  buffer_load_dwordx4 v[24:27], v2, s[8:11], s23 offen offset:0 sc1
  buffer_load_dwordx4 v[28:31], v2, s[8:11], s23 offen offset:1024 sc1
  buffer_load_dwordx4 v[32:35], v2, s[8:11], s23 offen offset:2048 sc1
  s_waitcnt vmcnt(0)
  v_max3_u32 v68, v8, v9, v10
  v_max3_u32 v68, v68, v11, v12
  v_max3_u32 v68, v68, v13, v14
  v_max3_u32 v68, v68, v15, v16
  v_max3_u32 v68, v68, v17, v18
  v_max3_u32 v68, v68, v19, v20
  v_max3_u32 v68, v68, v21, v22
  v_max3_u32 v68, v68, v23, v24
  v_max3_u32 v68, v68, v25, v26
  v_max3_u32 v68, v68, v27, v28
  v_max3_u32 v68, v68, v29, v30
  v_max3_u32 v68, v68, v31, v32
  v_max3_u32 v68, v68, v33, v34
  v_max_u32 v68, v68, v35
  v_cmp_eq_u32 vcc, -1, v68
  s_cbranch_vccz cA_sc1_rk
  s_add_u32 s30, s30, 1
  s_cmp_lt_u32 s30, 400000
  s_cbranch_scc1 cA_sc1_rv
  s_branch cA_abort
cA_sc1_rk:
  s_mov_b32 s62, 1
  v_mov_b32 v36, 0
  v_mov_b32 v37, 0
  v_mov_b32 v38, 0
  v_mov_b32 v39, 0
  v_mov_b32 v40, 0
  v_mov_b32 v41, 0
  v_mov_b32 v42, 0
  v_mov_b32 v43, 0
  v_mov_b32 v44, 0
  v_mov_b32 v45, 0
  v_mov_b32 v46, 0
  v_mov_b32 v47, 0
  v_mov_b32 v48, 0
  v_mov_b32 v49, 0
  v_mov_b32 v50, 0
  v_mov_b32 v51, 0
  v_mov_b32 v52, 0
  v_mov_b32 v53, 0
  v_mov_b32 v54, 0
  v_mov_b32 v55, 0
  v_mov_b32 v56, 0
  v_mov_b32 v57, 0
  v_mov_b32 v58, 0
  v_mov_b32 v59, 0
  v_mov_b32 v60, 0
  v_mov_b32 v61, 0
  v_mov_b32 v62, 0
  v_mov_b32 v63, 0
  v_mov_b32 v88, 0
  v_mov_b32 v89, 0
  v_mov_b32 v90, 0
  v_mov_b32 v91, 0
  v_mov_b32 v92, 0
  v_mov_b32 v93, 0
  v_mov_b32 v94, 0
  v_mov_b32 v95, 0
  v_mov_b32 v64, 0
  v_mov_b32 v65, 0
  s_add_u32 s31, s31, 1
  ds_read_b128 v[96:99], v117 offset:0
  ds_read_b128 v[100:103], v117 offset:1024
  ds_read_b128 v[104:107], v117 offset:14336
  ds_read_b128 v[108:111], v117 offset:15360
  v_smfmac_f32_16x16x64_bf16 v[36:39], v[8:11], a[0:7], v3
  v_smfmac_f32_16x16x64_bf16 v[40:43], v[8:11], a[56:63], v3
  v_smfmac_f32_16x16x64_bf16 v[44:47], v[8:11], a[112:119], v3
  v_smfmac_f32_16x16x64_bf16 v[48:51], v[8:11], a[168:175], v3
  v_smfmac_f32_16x16x64_bf16 v[52:55], v[8:11], a[224:231], v3
  v_smfmac_f32_16x16x64_bf16 v[56:59], v[8:11], v[144:151], v3
  v_smfmac_f32_16x16x64_bf16 v[60:63], v[8:11], v[200:207], v3
  v_smfmac_f32_16x16x64_bf16 v[36:39], v[12:15], a[8:15], v3
  v_smfmac_f32_16x16x64_bf16 v[40:43], v[12:15], a[64:71], v3
  v_smfmac_f32_16x16x64_bf16 v[44:47], v[12:15], a[120:127], v3
  v_smfmac_f32_16x16x64_bf16 v[48:51], v[12:15], a[176:183], v3
  v_smfmac_f32_16x16x64_bf16 v[52:55], v[12:15], a[232:239], v3
  v_smfmac_f32_16x16x64_bf16 v[56:59], v[12:15], v[152:159], v3
  v_smfmac_f32_16x16x64_bf16 v[60:63], v[12:15], v[208:215], v3
  v_smfmac_f32_16x16x64_bf16 v[36:39], v[16:19], a[16:23], v3
  v_smfmac_f32_16x16x64_bf16 v[40:43], v[16:19], a[72:79], v3
  v_smfmac_f32_16x16x64_bf16 v[44:47], v[16:19], a[128:135], v3
  v_smfmac_f32_16x16x64_bf16 v[48:51], v[16:19], a[184:191], v3
  v_smfmac_f32_16x16x64_bf16 v[52:55], v[16:19], a[240:247], v3
  v_smfmac_f32_16x16x64_bf16 v[56:59], v[16:19], v[160:167], v3
  v_smfmac_f32_16x16x64_bf16 v[60:63], v[16:19], v[216:223], v3
  v_smfmac_f32_16x16x64_bf16 v[36:39], v[20:23], a[24:31], v3
  v_smfmac_f32_16x16x64_bf16 v[40:43], v[20:23], a[80:87], v3
  v_smfmac_f32_16x16x64_bf16 v[44:47], v[20:23], a[136:143], v3
  v_smfmac_f32_16x16x64_bf16 v[48:51], v[20:23], a[192:199], v3
  v_smfmac_f32_16x16x64_bf16 v[52:55], v[20:23], a[248:255], v3
  v_smfmac_f32_16x16x64_bf16 v[56:59], v[20:23], v[168:175], v3
  v_smfmac_f32_16x16x64_bf16 v[60:63], v[20:23], v[224:231], v3
  s_xor_b32 s58, s25, 28672
  s_add_u32 s59, s24, 28672
  s_add_u32 m0, s58, 7168
  s_branch cA_sc1_ph2
.p2align 6

cA_sc2_loop:
  s_add_u32 s23, s20, 4096
  s_add_u32 s21, s20, 20480
  v_mov_b32 v48, 0
  v_mov_b32 v49, 0
  v_mov_b32 v50, 0
  v_mov_b32 v51, 0
  v_mov_b32 v52, 0
  v_mov_b32 v53, 0
  v_mov_b32 v54, 0
  v_mov_b32 v55, 0
  v_mov_b32 v56, 0
  v_mov_b32 v57, 0
  v_mov_b32 v58, 0
  v_mov_b32 v59, 0
  v_mov_b32 v60, 0
  v_mov_b32 v61, 0
  v_mov_b32 v62, 0
  v_mov_b32 v63, 0
  v_mov_b32 v88, 0
  v_mov_b32 v89, 0
  v_mov_b32 v90, 0
  v_mov_b32 v91, 0
  v_mov_b32 v92, 0
  v_mov_b32 v93, 0
  v_mov_b32 v94, 0
  v_mov_b32 v95, 0
  v_mov_b32 v66, 0
  v_mov_b32 v67, 0
  s_mov_b32 s30, 0
  s_mov_b32 s62, 0
  s_waitcnt vmcnt(0)
  s_barrier
cA_sc2_ld:
  buffer_load_dwordx4 v[8:11], v2, s[8:11], s20 offen offset:0
  v_mov_b32 v36, 0
  v_mov_b32 v37, 0
  v_mov_b32 v38, 0
  v_mov_b32 v39, 0
  buffer_load_dwordx4 v[12:15], v2, s[8:11], s20 offen offset:1024
  v_mov_b32 v40, 0
  v_mov_b32 v41, 0
  v_mov_b32 v42, 0
  v_mov_b32 v43, 0
  buffer_load_dwordx4 v[16:19], v2, s[8:11], s20 offen offset:2048
  v_mov_b32 v44, 0
  v_mov_b32 v45, 0
  v_mov_b32 v46, 0
  v_mov_b32 v47, 0
  ds_read_b128 v[96:99], v117 offset:0
  ds_read_b128 v[100:103], v117 offset:1024
  ds_read_b128 v[104:107], v117 offset:14336
  ds_read_b128 v[108:111], v117 offset:15360
  s_waitcnt vmcnt(2)
  v_smfmac_f32_16x16x64_bf16 v[36:39], v[8:11], a[0:7], v3
  v_smfmac_f32_16x16x64_bf16 v[40:43], v[8:11], a[56:63], v3
  buffer_load_dwordx4 v[20:23], v2, s[8:11], s20 offen offset:3072
  v_smfmac_f32_16x16x64_bf16 v[44:47], v[8:11], a[112:119], v3
  v_smfmac_f32_16x16x64_bf16 v[48:51], v[8:11], a[168:175], v3
  v_smfmac_f32_16x16x64_bf16 v[52:55], v[8:11], a[224:231], v3
  buffer_load_dwordx4 v[24:27], v2, s[8:11], s23 offen offset:0
  v_smfmac_f32_16x16x64_bf16 v[56:59], v[8:11], v[144:151], v3
  v_smfmac_f32_16x16x64_bf16 v[60:63], v[8:11], v[200:207], v3
  s_waitcnt vmcnt(3)
  v_smfmac_f32_16x16x64_bf16 v[36:39], v[12:15], a[8:15], v3
  v_smfmac_f32_16x16x64_bf16 v[40:43], v[12:15], a[64:71], v3
  buffer_load_dwordx4 v[28:31], v2, s[8:11], s23 offen offset:1024
  v_smfmac_f32_16x16x64_bf16 v[44:47], v[12:15], a[120:127], v3
  v_smfmac_f32_16x16x64_bf16 v[48:51], v[12:15], a[176:183], v3
  v_smfmac_f32_16x16x64_bf16 v[52:55], v[12:15], a[232:239], v3
  buffer_load_dwordx4 v[32:35], v2, s[8:11], s23 offen offset:2048
  v_smfmac_f32_16x16x64_bf16 v[56:59], v[12:15], v[152:159], v3
  v_smfmac_f32_16x16x64_bf16 v[60:63], v[12:15], v[208:215], v3
  s_waitcnt vmcnt(4)
  v_smfmac_f32_16x16x64_bf16 v[36:39], v[16:19], a[16:23], v3
  v_smfmac_f32_16x16x64_bf16 v[40:43], v[16:19], a[72:79], v3
  s_xor_b32 s58, s25, 28672
  s_add_u32 s59, s24, 28672
  s_add_u32 m0, s58, 14336
  v_smfmac_f32_16x16x64_bf16 v[44:47], v[16:19], a[128:135], v3
  buffer_load_dwordx4 v2, s[8:11], s59 offen offset:0 sc1 lds
  v_smfmac_f32_16x16x64_bf16 v[48:51], v[16:19], a[184:191], v3
  v_smfmac_f32_16x16x64_bf16 v[52:55], v[16:19], a[240:247], v3
  v_smfmac_f32_16x16x64_bf16 v[56:59], v[16:19], v[160:167], v3
  v_smfmac_f32_16x16x64_bf16 v[60:63], v[16:19], v[216:223], v3
  buffer_load_dwordx4 v2, s[8:11], s59 offen offset:1024 sc1 lds
  s_waitcnt vmcnt(5)
  v_smfmac_f32_16x16x64_bf16 v[36:39], v[20:23], a[24:31], v3
  v_smfmac_f32_16x16x64_bf16 v[40:43], v[20:23], a[80:87], v3
  v_smfmac_f32_16x16x64_bf16 v[44:47], v[20:23], a[136:143], v3
  v_smfmac_f32_16x16x64_bf16 v[48:51], v[20:23], a[192:199], v3
  buffer_load_dwordx4 v2, s[8:11], s59 offen offset:2048 sc1 lds
  v_smfmac_f32_16x16x64_bf16 v[52:55], v[20:23], a[248:255], v3
  v_smfmac_f32_16x16x64_bf16 v[56:59], v[20:23], v[168:175], v3
  v_smfmac_f32_16x16x64_bf16 v[60:63], v[20:23], v[224:231], v3
  s_waitcnt vmcnt(3)
cA_sc2_ph2:
  v_smfmac_f32_16x16x64_bf16 v[60:63], v[24:27], v[232:239], v3
  buffer_load_dwordx4 v2, s[8:11], s59 offen offset:3072 sc1 lds
  ds_read_b128 v[8:11], v116 offset:4096
  ds_read_b128 v[12:15], v116 offset:5120
  v_smfmac_f32_16x16x64_bf16 v[60:63], v[28:31], v[240:247], v3
  buffer_load_dword v119, v0, s[8:11], s24 offen sc1
  v_smfmac_f32_16x16x64_bf16 v[60:63], v[32:35], v[248:255], v3
  v_mov_b32 v80, v28
  v_smfmac_f32_16x16x64_bf16 v[52:55], v[24:27], v[120:127], v3
  v_mov_b32 v81, v29
  v_smfmac_f32_16x16x64_bf16 v[52:55], v[28:31], v[128:135], v3
  v_mov_b32 v82, v34
  v_smfmac_f32_16x16x64_bf16 v[52:55], v[32:35], v[136:143], v3
  v_cvt_pk_bf16_f32 v64, v60, v61
  v_smfmac_f32_16x16x64_bf16 v[56:59], v[24:27], v[176:183], v3
  v_cvt_pk_bf16_f32 v65, v62, v63
  v_smfmac_f32_16x16x64_bf16 v[56:59], v[28:31], v[184:191], v3
  v_mov_b32 v83, v35
  v_mfma_f32_16x16x32_bf16 v[68:71], v[64:67], v[4:7], 0
  v_smfmac_f32_16x16x64_bf16 v[56:59], v[32:35], v[192:199], v3
  v_cvt_pk_bf16_f32 v64, v52, v53
  v_smfmac_f32_16x16x64_bf16 v[36:39], v[24:27], a[32:39], v3
  v_cvt_pk_bf16_f32 v65, v54, v55
  v_smfmac_f32_16x16x64_bf16 v[36:39], v[28:31], a[40:47], v3
  v_cvt_pk_bf16_f32 v78, v68, v69
  v_smfmac_f32_16x16x64_bf16 v[36:39], v[32:35], a[48:55], v3
  v_cvt_pk_bf16_f32 v79, v70, v71
  v_cvt_pk_bf16_f32 v66, v56, v57
  v_smfmac_f32_16x16x64_bf16 v[40:43], v[24:27], a[88:95], v3
  v_cvt_pk_bf16_f32 v67, v58, v59
  v_smfmac_f32_16x16x64_bf16 v[40:43], v[28:31], a[96:103], v3
  v_mfma_f32_16x16x32_bf16 v[72:75], v[64:67], v[4:7], 0
  ds_read_b128 v[52:55], v116 offset:18432
  ds_read_b128 v[56:59], v116 offset:19456
  v_smfmac_f32_16x16x64_bf16 v[40:43], v[32:35], a[104:111], v3
  v_cvt_pk_bf16_f32 v64, v36, v37
  v_smfmac_f32_16x16x64_bf16 v[44:47], v[24:27], a[144:151], v3
  v_cvt_pk_bf16_f32 v65, v38, v39
  v_smfmac_f32_16x16x64_bf16 v[44:47], v[28:31], a[152:159], v3
  v_cvt_pk_bf16_f32 v76, v72, v73
  v_smfmac_f32_16x16x64_bf16 v[44:47], v[32:35], a[160:167], v3
  v_cvt_pk_bf16_f32 v77, v74, v75
  v_cvt_pk_bf16_f32 v66, v40, v41
  v_smfmac_f32_16x16x64_bf16 v[48:51], v[24:27], a[200:207], v3
  v_cvt_pk_bf16_f32 v67, v42, v43
  v_smfmac_f32_16x16x64_bf16 v[48:51], v[28:31], a[208:215], v3
  v_mfma_f32_16x16x32_bf16 v[68:71], v[64:67], v[4:7], 0
  v_smfmac_f32_16x16x64_bf16 v[48:51], v[32:35], a[216:223], v3
  v_cvt_pk_bf16_f32 v64, v44, v45
  v_mfma_f32_16x16x32_bf16 v[84:87], v[80:83], v[76:79], 0
  v_cvt_pk_bf16_f32 v65, v46, v47
  s_waitcnt lgkmcnt(0)
  v_smfmac_f32_16x16x64_bf16 v[88:91], v[76:79], v[96:103], v118
  v_cvt_pk_bf16_f32 v60, v68, v69
  v_cvt_pk_bf16_f32 v61, v70, v71
  v_cvt_pk_bf16_f32 v66, v48, v49
  v_cvt_pk_bf16_f32 v67, v50, v51
  s_nop 1
  v_mfma_f32_16x16x32_bf16 v[72:75], v[64:67], v[4:7], 0
  v_smfmac_f32_16x16x64_bf16 v[92:95], v[76:79], v[104:111], v118
  s_nop 4
  v_cvt_pk_bf16_f32 v62, v72, v73
  v_cvt_pk_bf16_f32 v63, v74, v75
  s_nop 1
  v_mfma_f32_16x16x32_bf16 v[84:87], v[16:19], v[60:63], v[84:87]
  v_smfmac_f32_16x16x64_bf16 v[88:91], v[60:63], v[8:15], v118
  v_smfmac_f32_16x16x64_bf16 v[92:95], v[60:63], v[52:59], v118
  s_nop 1
  v_permlane32_swap_b32 v84, v86
  v_permlane32_swap_b32 v85, v87
  s_nop 0
  v_add_f32 v88, v88, v89
  v_add_f32_dpp v84, v86, v84 quad_perm:[1,0,3,2] row_mask:0xf bank_mask:0xf
  v_add_f32_dpp v85, v87, v85 quad_perm:[1,0,3,2] row_mask:0xf bank_mask:0xf
  v_add_f32 v89, v90, v91
  ds_write2_b32 v113, v84, v85 offset0:0 offset1:4
  ds_write2_b32 v112, v88, v89 offset0:0 offset1:128
  v_add_f32 v90, v92, v93
  v_add_f32 v91, v94, v95
  ds_write2_b32 v112, v90, v91 offset0:64 offset1:192
  v_cmp_u_f32 vcc, v88, v89
  s_cbranch_vccnz cA_sc2_retry
cA_sc2_cont:
  s_waitcnt lgkmcnt(0)
  s_barrier
  ds_read_b128 v[36:39], v114
  ds_read_b128 v[44:47], v115
  v_lshl_add_u32 v56, v2, 3, s36
  s_waitcnt lgkmcnt(0)
  v_add_f32 v36, v36, v38
  v_add_f32 v37, v37, v39
  v_add_f32 v44, v44, v45
  s_mov_b64 exec, 15
  buffer_store_dword v2, v56, s[8:11], s20 offen
  s_mov_b64 exec, -1
  v_add_f32 v46, v46, v47
  v_add_f32 v44, v44, v46
  v_add_f32 v36, v36, v37
  v_exp_f32 v49, v44
  v_exp_f32 v48, v36
  v_add_f32 v50, abs(v36), abs(v44)
  v_fma_f32 v39, v49, s37, v48
  v_cmp_ngt_f32 vcc, s56, v50
  v_cndmask_b32 v41, v48, v49, s[38:39]
  v_add_f32_dpp v39, v39, v39 quad_perm:[1,0,3,2] row_mask:0xf bank_mask:0xf
  v_cndmask_b32 v40, v49, v48, s[38:39]
  v_mov_b32_dpp v46, v41 quad_perm:[1,0,3,2] row_mask:0xf bank_mask:0xf
  v_add_f32_dpp v39, v39, v39 quad_perm:[2,3,0,1] row_mask:0xf bank_mask:0xf
  v_cndmask_b32 v42, v46, v40, s[38:39]
  v_cndmask_b32 v43, v40, v46, s[38:39]
  v_add_f32_dpp v39, v39, v39 row_half_mirror row_mask:0xf bank_mask:0xf
  s_cbranch_vccnz cA_sc2_slow
  s_nop 0
  v_add_f32_dpp v47, v39, v39 row_mirror row_mask:0xf bank_mask:0xf
  v_add_f32_dpp v39, v39, v39 row_mirror row_mask:0xf bank_mask:0xf
  s_nop 1
  v_permlane16_swap_b32 v39, v47
  v_add_f32 v39, v39, v47
  v_rcp_f32 v39, v39
  s_mov_b64 exec, s[28:29]
  v_mul_f32 v42, v42, v39
  v_mul_f32 v43, v43, v39
  v_cvt_pk_bf16_f32 v42, v42, v43
cA_sc2_pst:
  buffer_store_dword v42, v1, s[8:11], s20 offen
  s_mov_b64 exec, -1
  s_barrier
  s_cmp_lg_u32 s19, 0
  s_cbranch_scc1 cA_sc2_s0
  s_sub_u32 s36, s36, 64
  v_lshl_add_u32 v56, v2, 3, s36
  s_mov_b64 exec, 15
  buffer_store_dword v2, v56, s[8:11], s20 offen
  s_mov_b64 exec, -1
cA_sc2_s0:
  s_add_u32 s24, s24, 28672
  s_add_u32 s35, s35, 28672
  s_xor_b32 s25, s25, 28672
  s_add_u32 m0, s25, 14336
  s_add_u32 m0, s25, 18432
  s_add_u32 s22, s24, 4096
  buffer_load_dwordx4 v2, s[8:11], s22 offen offset:0 sc1 lds
  s_nop 5
  buffer_load_dwordx4 v2, s[8:11], s22 offen offset:1024 sc1 lds
  s_nop 5
  buffer_load_dwordx4 v2, s[8:11], s22 offen offset:2048 sc1 lds
  s_nop 5
  v_xor_b32 v116, 28672, v116
  v_add_u32 v117, s57, v117
  s_sub_u32 s57, 0, s57
  s_add_u32 s19, s19, 1
  s_mov_b32 s20, s21
  s_cmp_lt_u32 s19, 63
  s_cbranch_scc1 cA_sc2_loop
  s_branch cA_done
cA_sc2_slow:
  v_max_f32 v50, v36, v44
  s_nop 1
  v_max_f32_dpp v50, v50, v50 quad_perm:[1,0,3,2] row_mask:0xf bank_mask:0xf
  s_nop 1
  v_max_f32_dpp v50, v50, v50 quad_perm:[2,3,0,1] row_mask:0xf bank_mask:0xf
  s_nop 1
  v_max_f32_dpp v50, v50, v50 row_half_mirror row_mask:0xf bank_mask:0xf
  s_nop 1
  v_max_f32_dpp v50, v50, v50 row_mirror row_mask:0xf bank_mask:0xf
  v_mov_b32 v47, v50
  s_nop 1
  v_permlane16_swap_b32 v50, v47
  v_max_f32 v50, v50, v47
  v_sub_f32 v48, v36, v50
  v_sub_f32 v49, v44, v50
  v_exp_f32 v48, v48
  v_exp_f32 v49, v49
  s_add_u32 s31, s31, 0x100
  v_fma_f32 v39, v49, s37, v48
  v_cndmask_b32 v41, v48, v49, s[38:39]
  s_nop 0
  v_add_f32_dpp v39, v39, v39 quad_perm:[1,0,3,2] row_mask:0xf bank_mask:0xf
  v_cndmask_b32 v40, v49, v48, s[38:39]
  v_mov_b32_dpp v46, v41 quad_perm:[1,0,3,2] row_mask:0xf bank_mask:0xf
  v_add_f32_dpp v39, v39, v39 quad_perm:[2,3,0,1] row_mask:0xf bank_mask:0xf
  v_cndmask_b32 v42, v46, v40, s[38:39]
  v_cndmask_b32 v43, v40, v46, s[38:39]
  v_add_f32_dpp v39, v39, v39 row_half_mirror row_mask:0xf bank_mask:0xf
  s_nop 1
  v_add_f32_dpp v47, v39, v39 row_mirror row_mask:0xf bank_mask:0xf
  v_add_f32_dpp v39, v39, v39 row_mirror row_mask:0xf bank_mask:0xf
  s_nop 1
  v_permlane16_swap_b32 v39, v47
  v_add_f32 v39, v39, v47
  v_rcp_f32 v39, v39
  s_mov_b64 exec, s[28:29]
  v_mul_f32 v42, v42, v39
  v_mul_f32 v43, v43, v39
  v_cvt_pk_bf16_f32 v42, v42, v43
  v_min_u32 v42, -2, v42
  s_branch cA_sc2_pst
cA_sc2_retry:
  s_cmp_lg_u32 s62, 0
  s_cbranch_scc1 cA_sc2_cont
  s_waitcnt vmcnt(0) lgkmcnt(0)
cA_sc2_rv:
  buffer_load_dwordx4 v[8:11], v2, s[8:11], s20 offen offset:0 sc1
  buffer_load_dwordx4 v[12:15], v2, s[8:11], s20 offen offset:1024 sc1
  buffer_load_dwordx4 v[16:19], v2, s[8:11], s20 offen offset:2048 sc1
  buffer_load_dwordx4 v[20:23], v2, s[8:11], s20 offen offset:3072 sc1
  buffer_load_dwordx4 v[24:27], v2, s[8:11], s23 offen offset:0 sc1
  buffer_load_dwordx4 v[28:31], v2, s[8:11], s23 offen offset:1024 sc1
  buffer_load_dwordx4 v[32:35], v2, s[8:11], s23 offen offset:2048 sc1
  s_waitcnt vmcnt(0)
  v_max3_u32 v68, v8, v9, v10
  v_max3_u32 v68, v68, v11, v12
  v_max3_u32 v68, v68, v13, v14
  v_max3_u32 v68, v68, v15, v16
  v_max3_u32 v68, v68, v17, v18
  v_max3_u32 v68, v68, v19, v20
  v_max3_u32 v68, v68, v21, v22
  v_max3_u32 v68, v68, v23, v24
  v_max3_u32 v68, v68, v25, v26
  v_max3_u32 v68, v68, v27, v28
  v_max3_u32 v68, v68, v29, v30
  v_max3_u32 v68, v68, v31, v32
  v_max3_u32 v68, v68, v33, v34
  v_max_u32 v68, v68, v35
  v_cmp_eq_u32 vcc, -1, v68
  s_cbranch_vccz cA_sc2_rk
  s_add_u32 s30, s30, 1
  s_cmp_lt_u32 s30, 400000
  s_cbranch_scc1 cA_sc2_rv
  s_branch cA_abort
cA_sc2_rk:
  s_mov_b32 s62, 1
  v_mov_b32 v36, 0
  v_mov_b32 v37, 0
  v_mov_b32 v38, 0
  v_mov_b32 v39, 0
  v_mov_b32 v40, 0
  v_mov_b32 v41, 0
  v_mov_b32 v42, 0
  v_mov_b32 v43, 0
  v_mov_b32 v44, 0
  v_mov_b32 v45, 0
  v_mov_b32 v46, 0
  v_mov_b32 v47, 0
  v_mov_b32 v48, 0
  v_mov_b32 v49, 0
  v_mov_b32 v50, 0
  v_mov_b32 v51, 0
  v_mov_b32 v52, 0
  v_mov_b32 v53, 0
  v_mov_b32 v54, 0
  v_mov_b32 v55, 0
  v_mov_b32 v56, 0
  v_mov_b32 v57, 0
  v_mov_b32 v58, 0
  v_mov_b32 v59, 0
  v_mov_b32 v60, 0
  v_mov_b32 v61, 0
  v_mov_b32 v62, 0
  v_mov_b32 v63, 0
  v_mov_b32 v88, 0
  v_mov_b32 v89, 0
  v_mov_b32 v90, 0
  v_mov_b32 v91, 0
  v_mov_b32 v92, 0
  v_mov_b32 v93, 0
  v_mov_b32 v94, 0
  v_mov_b32 v95, 0
  v_mov_b32 v66, 0
  v_mov_b32 v67, 0
  s_add_u32 s31, s31, 1
  ds_read_b128 v[96:99], v117 offset:0
  ds_read_b128 v[100:103], v117 offset:1024
  ds_read_b128 v[104:107], v117 offset:14336
  ds_read_b128 v[108:111], v117 offset:15360
  v_smfmac_f32_16x16x64_bf16 v[36:39], v[8:11], a[0:7], v3
  v_smfmac_f32_16x16x64_bf16 v[40:43], v[8:11], a[56:63], v3
  v_smfmac_f32_16x16x64_bf16 v[44:47], v[8:11], a[112:119], v3
  v_smfmac_f32_16x16x64_bf16 v[48:51], v[8:11], a[168:175], v3
  v_smfmac_f32_16x16x64_bf16 v[52:55], v[8:11], a[224:231], v3
  v_smfmac_f32_16x16x64_bf16 v[56:59], v[8:11], v[144:151], v3
  v_smfmac_f32_16x16x64_bf16 v[60:63], v[8:11], v[200:207], v3
  v_smfmac_f32_16x16x64_bf16 v[36:39], v[12:15], a[8:15], v3
  v_smfmac_f32_16x16x64_bf16 v[40:43], v[12:15], a[64:71], v3
  v_smfmac_f32_16x16x64_bf16 v[44:47], v[12:15], a[120:127], v3
  v_smfmac_f32_16x16x64_bf16 v[48:51], v[12:15], a[176:183], v3
  v_smfmac_f32_16x16x64_bf16 v[52:55], v[12:15], a[232:239], v3
  v_smfmac_f32_16x16x64_bf16 v[56:59], v[12:15], v[152:159], v3
  v_smfmac_f32_16x16x64_bf16 v[60:63], v[12:15], v[208:215], v3
  v_smfmac_f32_16x16x64_bf16 v[36:39], v[16:19], a[16:23], v3
  v_smfmac_f32_16x16x64_bf16 v[40:43], v[16:19], a[72:79], v3
  v_smfmac_f32_16x16x64_bf16 v[44:47], v[16:19], a[128:135], v3
  v_smfmac_f32_16x16x64_bf16 v[48:51], v[16:19], a[184:191], v3
  v_smfmac_f32_16x16x64_bf16 v[52:55], v[16:19], a[240:247], v3
  v_smfmac_f32_16x16x64_bf16 v[56:59], v[16:19], v[160:167], v3
  v_smfmac_f32_16x16x64_bf16 v[60:63], v[16:19], v[216:223], v3
  v_smfmac_f32_16x16x64_bf16 v[36:39], v[20:23], a[24:31], v3
  v_smfmac_f32_16x16x64_bf16 v[40:43], v[20:23], a[80:87], v3
  v_smfmac_f32_16x16x64_bf16 v[44:47], v[20:23], a[136:143], v3
  v_smfmac_f32_16x16x64_bf16 v[48:51], v[20:23], a[192:199], v3
  v_smfmac_f32_16x16x64_bf16 v[52:55], v[20:23], a[248:255], v3
  v_smfmac_f32_16x16x64_bf16 v[56:59], v[20:23], v[168:175], v3
  v_smfmac_f32_16x16x64_bf16 v[60:63], v[20:23], v[224:231], v3
  s_xor_b32 s58, s25, 28672
  s_add_u32 s59, s24, 28672
  s_add_u32 m0, s58, 14336
  s_branch cA_sc2_ph2
.p2align 6

cA_sc3_loop:
  s_add_u32 s23, s20, 4096
  s_add_u32 s21, s20, 20480
  v_mov_b32 v48, 0
  v_mov_b32 v49, 0
  v_mov_b32 v50, 0
  v_mov_b32 v51, 0
  v_mov_b32 v52, 0
  v_mov_b32 v53, 0
  v_mov_b32 v54, 0
  v_mov_b32 v55, 0
  v_mov_b32 v56, 0
  v_mov_b32 v57, 0
  v_mov_b32 v58, 0
  v_mov_b32 v59, 0
  v_mov_b32 v60, 0
  v_mov_b32 v61, 0
  v_mov_b32 v62, 0
  v_mov_b32 v63, 0
  v_mov_b32 v88, 0
  v_mov_b32 v89, 0
  v_mov_b32 v90, 0
  v_mov_b32 v91, 0
  v_mov_b32 v92, 0
  v_mov_b32 v93, 0
  v_mov_b32 v94, 0
  v_mov_b32 v95, 0
  v_mov_b32 v64, 0
  v_mov_b32 v65, 0
  s_mov_b32 s30, 0
  s_mov_b32 s62, 0
  s_waitcnt vmcnt(0)
  s_barrier
cA_sc3_ld:
  buffer_load_dwordx4 v[8:11], v2, s[8:11], s20 offen offset:0
  v_mov_b32 v36, 0
  v_mov_b32 v37, 0
  v_mov_b32 v38, 0
  v_mov_b32 v39, 0
  buffer_load_dwordx4 v[12:15], v2, s[8:11], s20 offen offset:1024
  v_mov_b32 v40, 0
  v_mov_b32 v41, 0
  v_mov_b32 v42, 0
  v_mov_b32 v43, 0
  buffer_load_dwordx4 v[16:19], v2, s[8:11], s20 offen offset:2048
  v_mov_b32 v44, 0
  v_mov_b32 v45, 0
  v_mov_b32 v46, 0
  v_mov_b32 v47, 0
  ds_read_b128 v[96:99], v117 offset:0
  ds_read_b128 v[100:103], v117 offset:1024
  ds_read_b128 v[104:107], v117 offset:14336
  ds_read_b128 v[108:111], v117 offset:15360
  s_waitcnt vmcnt(2)
  v_smfmac_f32_16x16x64_bf16 v[36:39], v[8:11], a[0:7], v3
  v_smfmac_f32_16x16x64_bf16 v[40:43], v[8:11], a[56:63], v3
  buffer_load_dwordx4 v[20:23], v2, s[8:11], s20 offen offset:3072
  v_smfmac_f32_16x16x64_bf16 v[44:47], v[8:11], a[112:119], v3
  v_smfmac_f32_16x16x64_bf16 v[48:51], v[8:11], a[168:175], v3
  v_smfmac_f32_16x16x64_bf16 v[52:55], v[8:11], a[224:231], v3
  buffer_load_dwordx4 v[24:27], v2, s[8:11], s23 offen offset:0
  v_smfmac_f32_16x16x64_bf16 v[56:59], v[8:11], v[144:151], v3
  v_smfmac_f32_16x16x64_bf16 v[60:63], v[8:11], v[200:207], v3
  s_waitcnt vmcnt(3)
  v_smfmac_f32_16x16x64_bf16 v[36:39], v[12:15], a[8:15], v3
  v_smfmac_f32_16x16x64_bf16 v[40:43], v[12:15], a[64:71], v3
  buffer_load_dwordx4 v[28:31], v2, s[8:11], s23 offen offset:1024
  v_smfmac_f32_16x16x64_bf16 v[44:47], v[12:15], a[120:127], v3
  v_smfmac_f32_16x16x64_bf16 v[48:51], v[12:15], a[176:183], v3
  v_smfmac_f32_16x16x64_bf16 v[52:55], v[12:15], a[232:239], v3
  buffer_load_dwordx4 v[32:35], v2, s[8:11], s23 offen offset:2048
  v_smfmac_f32_16x16x64_bf16 v[56:59], v[12:15], v[152:159], v3
  v_smfmac_f32_16x16x64_bf16 v[60:63], v[12:15], v[208:215], v3
  s_waitcnt vmcnt(4)
  v_smfmac_f32_16x16x64_bf16 v[36:39], v[16:19], a[16:23], v3
  v_smfmac_f32_16x16x64_bf16 v[40:43], v[16:19], a[72:79], v3
  v_smfmac_f32_16x16x64_bf16 v[44:47], v[16:19], a[128:135], v3
  s_xor_b32 s58, s25, 28672
  s_add_u32 s59, s24, 28672
  s_add_u32 m0, s58, 21504
  v_smfmac_f32_16x16x64_bf16 v[48:51], v[16:19], a[184:191], v3
  buffer_load_dwordx4 v2, s[8:11], s59 offen offset:0 sc1 lds
  v_smfmac_f32_16x16x64_bf16 v[52:55], v[16:19], a[240:247], v3
  v_smfmac_f32_16x16x64_bf16 v[56:59], v[16:19], v[160:167], v3
  v_smfmac_f32_16x16x64_bf16 v[60:63], v[16:19], v[216:223], v3
  s_waitcnt vmcnt(4)
  v_smfmac_f32_16x16x64_bf16 v[36:39], v[20:23], a[24:31], v3
  buffer_load_dwordx4 v2, s[8:11], s59 offen offset:1024 sc1 lds
  v_smfmac_f32_16x16x64_bf16 v[40:43], v[20:23], a[80:87], v3
  v_smfmac_f32_16x16x64_bf16 v[44:47], v[20:23], a[136:143], v3
  v_smfmac_f32_16x16x64_bf16 v[48:51], v[20:23], a[192:199], v3
  v_smfmac_f32_16x16x64_bf16 v[52:55], v[20:23], a[248:255], v3
  buffer_load_dwordx4 v2, s[8:11], s59 offen offset:2048 sc1 lds
  v_smfmac_f32_16x16x64_bf16 v[56:59], v[20:23], v[168:175], v3
  v_smfmac_f32_16x16x64_bf16 v[60:63], v[20:23], v[224:231], v3
  s_waitcnt vmcnt(3)
cA_sc3_ph2:
  v_smfmac_f32_16x16x64_bf16 v[60:63], v[24:27], v[232:239], v3
  ds_read_b128 v[8:11], v116 offset:6144
  ds_read_b128 v[12:15], v116 offset:7168
  v_smfmac_f32_16x16x64_bf16 v[60:63], v[28:31], v[240:247], v3
  buffer_load_dwordx4 v2, s[8:11], s59 offen offset:3072 sc1 lds
  v_smfmac_f32_16x16x64_bf16 v[60:63], v[32:35], v[248:255], v3
  v_mov_b32 v80, v30
  v_smfmac_f32_16x16x64_bf16 v[52:55], v[24:27], v[120:127], v3
  v_mov_b32 v81, v31
  v_smfmac_f32_16x16x64_bf16 v[52:55], v[28:31], v[128:135], v3
  v_mov_b32 v82, v34
  v_smfmac_f32_16x16x64_bf16 v[52:55], v[32:35], v[136:143], v3
  v_cvt_pk_bf16_f32 v66, v60, v61
  v_smfmac_f32_16x16x64_bf16 v[56:59], v[24:27], v[176:183], v3
  v_cvt_pk_bf16_f32 v67, v62, v63
  v_smfmac_f32_16x16x64_bf16 v[56:59], v[28:31], v[184:191], v3
  v_mov_b32 v83, v35
  v_mfma_f32_16x16x32_bf16 v[68:71], v[64:67], v[4:7], 0
  v_smfmac_f32_16x16x64_bf16 v[56:59], v[32:35], v[192:199], v3
  v_cvt_pk_bf16_f32 v64, v52, v53
  v_smfmac_f32_16x16x64_bf16 v[36:39], v[24:27], a[32:39], v3
  v_cvt_pk_bf16_f32 v65, v54, v55
  v_smfmac_f32_16x16x64_bf16 v[36:39], v[28:31], a[40:47], v3
  v_cvt_pk_bf16_f32 v78, v68, v69
  v_smfmac_f32_16x16x64_bf16 v[36:39], v[32:35], a[48:55], v3
  v_cvt_pk_bf16_f32 v79, v70, v71
  v_cvt_pk_bf16_f32 v66, v56, v57
  v_smfmac_f32_16x16x64_bf16 v[40:43], v[24:27], a[88:95], v3
  v_cvt_pk_bf16_f32 v67, v58, v59
  v_smfmac_f32_16x16x64_bf16 v[40:43], v[28:31], a[96:103], v3
  v_mfma_f32_16x16x32_bf16 v[72:75], v[64:67], v[4:7], 0
  ds_read_b128 v[52:55], v116 offset:20480
  ds_read_b128 v[56:59], v116 offset:21504
  v_smfmac_f32_16x16x64_bf16 v[40:43], v[32:35], a[104:111], v3
  v_cvt_pk_bf16_f32 v64, v36, v37
  v_smfmac_f32_16x16x64_bf16 v[44:47], v[24:27], a[144:151], v3
  v_cvt_pk_bf16_f32 v65, v38, v39
  v_smfmac_f32_16x16x64_bf16 v[44:47], v[28:31], a[152:159], v3
  v_cvt_pk_bf16_f32 v76, v72, v73
  v_smfmac_f32_16x16x64_bf16 v[44:47], v[32:35], a[160:167], v3
  v_cvt_pk_bf16_f32 v77, v74, v75
  v_cvt_pk_bf16_f32 v66, v40, v41
  v_smfmac_f32_16x16x64_bf16 v[48:51], v[24:27], a[200:207], v3
  v_cvt_pk_bf16_f32 v67, v42, v43
  v_smfmac_f32_16x16x64_bf16 v[48:51], v[28:31], a[208:215], v3
  v_mfma_f32_16x16x32_bf16 v[68:71], v[64:67], v[4:7], 0
  v_smfmac_f32_16x16x64_bf16 v[48:51], v[32:35], a[216:223], v3
  v_cvt_pk_bf16_f32 v64, v44, v45
  v_mfma_f32_16x16x32_bf16 v[84:87], v[80:83], v[76:79], 0
  v_cvt_pk_bf16_f32 v65, v46, v47
  s_waitcnt lgkmcnt(0)
  v_smfmac_f32_16x16x64_bf16 v[88:91], v[76:79], v[96:103], v118
  v_cvt_pk_bf16_f32 v60, v68, v69
  v_cvt_pk_bf16_f32 v61, v70, v71
  v_cvt_pk_bf16_f32 v66, v48, v49
  v_cvt_pk_bf16_f32 v67, v50, v51
  s_nop 1
  v_mfma_f32_16x16x32_bf16 v[72:75], v[64:67], v[4:7], 0
  v_smfmac_f32_16x16x64_bf16 v[92:95], v[76:79], v[104:111], v118
  s_nop 4
  v_cvt_pk_bf16_f32 v62, v72, v73
  v_cvt_pk_bf16_f32 v63, v74, v75
  s_nop 1
  v_mfma_f32_16x16x32_bf16 v[84:87], v[20:23], v[60:63], v[84:87]
  v_smfmac_f32_16x16x64_bf16 v[88:91], v[60:63], v[8:15], v118
  v_smfmac_f32_16x16x64_bf16 v[92:95], v[60:63], v[52:59], v118
  s_nop 1
  v_permlane32_swap_b32 v84, v86
  v_permlane32_swap_b32 v85, v87
  s_nop 0
  v_add_f32 v88, v88, v89
  v_add_f32_dpp v84, v86, v84 quad_perm:[1,0,3,2] row_mask:0xf bank_mask:0xf
  v_add_f32_dpp v85, v87, v85 quad_perm:[1,0,3,2] row_mask:0xf bank_mask:0xf
  v_add_f32 v89, v90, v91
  ds_write2_b32 v113, v84, v85 offset0:0 offset1:4
  ds_write2_b32 v112, v88, v89 offset0:0 offset1:128
  v_add_f32 v90, v92, v93
  v_add_f32 v91, v94, v95
  ds_write2_b32 v112, v90, v91 offset0:64 offset1:192
  v_cmp_u_f32 vcc, v88, v89
  s_cbranch_vccnz cA_sc3_retry
cA_sc3_cont:
  s_waitcnt lgkmcnt(0)
  s_barrier
  ds_read_b128 v[36:39], v114
  ds_read_b128 v[44:47], v115
  s_waitcnt lgkmcnt(0)
  v_add_f32 v36, v36, v38
  v_add_f32 v37, v37, v39
  v_add_f32 v44, v44, v45
  v_add_f32 v46, v46, v47
  v_add_f32 v44, v44, v46
  v_add_f32 v36, v36, v37
  v_exp_f32 v49, v44
  v_exp_f32 v48, v36
  v_add_f32 v50, abs(v36), abs(v44)
  v_fma_f32 v39, v49, s37, v48
  v_cmp_ngt_f32 vcc, s56, v50
  v_cndmask_b32 v41, v48, v49, s[38:39]
  v_add_f32_dpp v39, v39, v39 quad_perm:[1,0,3,2] row_mask:0xf bank_mask:0xf
  v_cndmask_b32 v40, v49, v48, s[38:39]
  v_mov_b32_dpp v46, v41 quad_perm:[1,0,3,2] row_mask:0xf bank_mask:0xf
  v_add_f32_dpp v39, v39, v39 quad_perm:[2,3,0,1] row_mask:0xf bank_mask:0xf
  v_cndmask_b32 v42, v46, v40, s[38:39]
  v_cndmask_b32 v43, v40, v46, s[38:39]
  v_add_f32_dpp v39, v39, v39 row_half_mirror row_mask:0xf bank_mask:0xf
  s_cbranch_vccnz cA_sc3_slow
  s_nop 0
  v_add_f32_dpp v47, v39, v39 row_mirror row_mask:0xf bank_mask:0xf
  v_add_f32_dpp v39, v39, v39 row_mirror row_mask:0xf bank_mask:0xf
  s_nop 1
  v_permlane16_swap_b32 v39, v47
  v_add_f32 v39, v39, v47
  v_rcp_f32 v39, v39
  s_mov_b64 exec, s[28:29]
  v_mul_f32 v42, v42, v39
  v_mul_f32 v43, v43, v39
  v_cvt_pk_bf16_f32 v42, v42, v43
cA_sc3_pst:
  buffer_store_dword v42, v1, s[8:11], s20 offen
  s_mov_b64 exec, -1
  s_barrier
  s_add_u32 s24, s24, 28672
  s_add_u32 s35, s35, 28672
  s_xor_b32 s25, s25, 28672
  s_add_u32 m0, s25, 21504
  s_add_u32 m0, s25, 25600
  s_add_u32 s22, s24, 4096
  buffer_load_dwordx4 v2, s[8:11], s22 offen offset:0 sc1 lds
  s_nop 5
  buffer_load_dwordx4 v2, s[8:11], s22 offen offset:1024 sc1 lds
  s_nop 5
  buffer_load_dwordx4 v2, s[8:11], s22 offen offset:2048 sc1 lds
  s_nop 5
  v_xor_b32 v116, 28672, v116
  v_add_u32 v117, s57, v117
  s_sub_u32 s57, 0, s57
  s_add_u32 s19, s19, 1
  s_mov_b32 s20, s21
  s_cmp_lt_u32 s19, 63
  s_cbranch_scc1 cA_sc3_loop
  s_branch cA_done
cA_sc3_slow:
  v_max_f32 v50, v36, v44
  s_nop 1
  v_max_f32_dpp v50, v50, v50 quad_perm:[1,0,3,2] row_mask:0xf bank_mask:0xf
  s_nop 1
  v_max_f32_dpp v50, v50, v50 quad_perm:[2,3,0,1] row_mask:0xf bank_mask:0xf
  s_nop 1
  v_max_f32_dpp v50, v50, v50 row_half_mirror row_mask:0xf bank_mask:0xf
  s_nop 1
  v_max_f32_dpp v50, v50, v50 row_mirror row_mask:0xf bank_mask:0xf
  v_mov_b32 v47, v50
  s_nop 1
  v_permlane16_swap_b32 v50, v47
  v_max_f32 v50, v50, v47
  v_sub_f32 v48, v36, v50
  v_sub_f32 v49, v44, v50
  v_exp_f32 v48, v48
  v_exp_f32 v49, v49
  s_add_u32 s31, s31, 0x100
  v_fma_f32 v39, v49, s37, v48
  v_cndmask_b32 v41, v48, v49, s[38:39]
  s_nop 0
  v_add_f32_dpp v39, v39, v39 quad_perm:[1,0,3,2] row_mask:0xf bank_mask:0xf
  v_cndmask_b32 v40, v49, v48, s[38:39]
  v_mov_b32_dpp v46, v41 quad_perm:[1,0,3,2] row_mask:0xf bank_mask:0xf
  v_add_f32_dpp v39, v39, v39 quad_perm:[2,3,0,1] row_mask:0xf bank_mask:0xf
  v_cndmask_b32 v42, v46, v40, s[38:39]
  v_cndmask_b32 v43, v40, v46, s[38:39]
  v_add_f32_dpp v39, v39, v39 row_half_mirror row_mask:0xf bank_mask:0xf
  s_nop 1
  v_add_f32_dpp v47, v39, v39 row_mirror row_mask:0xf bank_mask:0xf
  v_add_f32_dpp v39, v39, v39 row_mirror row_mask:0xf bank_mask:0xf
  s_nop 1
  v_permlane16_swap_b32 v39, v47
  v_add_f32 v39, v39, v47
  v_rcp_f32 v39, v39
  s_mov_b64 exec, s[28:29]
  v_mul_f32 v42, v42, v39
  v_mul_f32 v43, v43, v39
  v_cvt_pk_bf16_f32 v42, v42, v43
  v_min_u32 v42, -2, v42
  s_branch cA_sc3_pst
cA_sc3_retry:
  s_cmp_lg_u32 s62, 0
  s_cbranch_scc1 cA_sc3_cont
  s_waitcnt vmcnt(0) lgkmcnt(0)
cA_sc3_rv:
  buffer_load_dwordx4 v[8:11], v2, s[8:11], s20 offen offset:0 sc1
  buffer_load_dwordx4 v[12:15], v2, s[8:11], s20 offen offset:1024 sc1
  buffer_load_dwordx4 v[16:19], v2, s[8:11], s20 offen offset:2048 sc1
  buffer_load_dwordx4 v[20:23], v2, s[8:11], s20 offen offset:3072 sc1
  buffer_load_dwordx4 v[24:27], v2, s[8:11], s23 offen offset:0 sc1
  buffer_load_dwordx4 v[28:31], v2, s[8:11], s23 offen offset:1024 sc1
  buffer_load_dwordx4 v[32:35], v2, s[8:11], s23 offen offset:2048 sc1
  s_waitcnt vmcnt(0)
  v_max3_u32 v68, v8, v9, v10
  v_max3_u32 v68, v68, v11, v12
  v_max3_u32 v68, v68, v13, v14
  v_max3_u32 v68, v68, v15, v16
  v_max3_u32 v68, v68, v17, v18
  v_max3_u32 v68, v68, v19, v20
  v_max3_u32 v68, v68, v21, v22
  v_max3_u32 v68, v68, v23, v24
  v_max3_u32 v68, v68, v25, v26
  v_max3_u32 v68, v68, v27, v28
  v_max3_u32 v68, v68, v29, v30
  v_max3_u32 v68, v68, v31, v32
  v_max3_u32 v68, v68, v33, v34
  v_max_u32 v68, v68, v35
  v_cmp_eq_u32 vcc, -1, v68
  s_cbranch_vccz cA_sc3_rk
  s_add_u32 s30, s30, 1
  s_cmp_lt_u32 s30, 400000
  s_cbranch_scc1 cA_sc3_rv
  s_branch cA_abort
cA_sc3_rk:
  s_mov_b32 s62, 1
  v_mov_b32 v36, 0
  v_mov_b32 v37, 0
  v_mov_b32 v38, 0
  v_mov_b32 v39, 0
  v_mov_b32 v40, 0
  v_mov_b32 v41, 0
  v_mov_b32 v42, 0
  v_mov_b32 v43, 0
  v_mov_b32 v44, 0
  v_mov_b32 v45, 0
  v_mov_b32 v46, 0
  v_mov_b32 v47, 0
  v_mov_b32 v48, 0
  v_mov_b32 v49, 0
  v_mov_b32 v50, 0
  v_mov_b32 v51, 0
  v_mov_b32 v52, 0
  v_mov_b32 v53, 0
  v_mov_b32 v54, 0
  v_mov_b32 v55, 0
  v_mov_b32 v56, 0
  v_mov_b32 v57, 0
  v_mov_b32 v58, 0
  v_mov_b32 v59, 0
  v_mov_b32 v60, 0
  v_mov_b32 v61, 0
  v_mov_b32 v62, 0
  v_mov_b32 v63, 0
  v_mov_b32 v88, 0
  v_mov_b32 v89, 0
  v_mov_b32 v90, 0
  v_mov_b32 v91, 0
  v_mov_b32 v92, 0
  v_mov_b32 v93, 0
  v_mov_b32 v94, 0
  v_mov_b32 v95, 0
  v_mov_b32 v64, 0
  v_mov_b32 v65, 0
  s_add_u32 s31, s31, 1
  ds_read_b128 v[96:99], v117 offset:0
  ds_read_b128 v[100:103], v117 offset:1024
  ds_read_b128 v[104:107], v117 offset:14336
  ds_read_b128 v[108:111], v117 offset:15360
  v_smfmac_f32_16x16x64_bf16 v[36:39], v[8:11], a[0:7], v3
  v_smfmac_f32_16x16x64_bf16 v[40:43], v[8:11], a[56:63], v3
  v_smfmac_f32_16x16x64_bf16 v[44:47], v[8:11], a[112:119], v3
  v_smfmac_f32_16x16x64_bf16 v[48:51], v[8:11], a[168:175], v3
  v_smfmac_f32_16x16x64_bf16 v[52:55], v[8:11], a[224:231], v3
  v_smfmac_f32_16x16x64_bf16 v[56:59], v[8:11], v[144:151], v3
  v_smfmac_f32_16x16x64_bf16 v[60:63], v[8:11], v[200:207], v3
  v_smfmac_f32_16x16x64_bf16 v[36:39], v[12:15], a[8:15], v3
  v_smfmac_f32_16x16x64_bf16 v[40:43], v[12:15], a[64:71], v3
  v_smfmac_f32_16x16x64_bf16 v[44:47], v[12:15], a[120:127], v3
  v_smfmac_f32_16x16x64_bf16 v[48:51], v[12:15], a[176:183], v3
  v_smfmac_f32_16x16x64_bf16 v[52:55], v[12:15], a[232:239], v3
  v_smfmac_f32_16x16x64_bf16 v[56:59], v[12:15], v[152:159], v3
  v_smfmac_f32_16x16x64_bf16 v[60:63], v[12:15], v[208:215], v3
  v_smfmac_f32_16x16x64_bf16 v[36:39], v[16:19], a[16:23], v3
  v_smfmac_f32_16x16x64_bf16 v[40:43], v[16:19], a[72:79], v3
  v_smfmac_f32_16x16x64_bf16 v[44:47], v[16:19], a[128:135], v3
  v_smfmac_f32_16x16x64_bf16 v[48:51], v[16:19], a[184:191], v3
  v_smfmac_f32_16x16x64_bf16 v[52:55], v[16:19], a[240:247], v3
  v_smfmac_f32_16x16x64_bf16 v[56:59], v[16:19], v[160:167], v3
  v_smfmac_f32_16x16x64_bf16 v[60:63], v[16:19], v[216:223], v3
  v_smfmac_f32_16x16x64_bf16 v[36:39], v[20:23], a[24:31], v3
  v_smfmac_f32_16x16x64_bf16 v[40:43], v[20:23], a[80:87], v3
  v_smfmac_f32_16x16x64_bf16 v[44:47], v[20:23], a[136:143], v3
  v_smfmac_f32_16x16x64_bf16 v[48:51], v[20:23], a[192:199], v3
  v_smfmac_f32_16x16x64_bf16 v[52:55], v[20:23], a[248:255], v3
  v_smfmac_f32_16x16x64_bf16 v[56:59], v[20:23], v[168:175], v3
  v_smfmac_f32_16x16x64_bf16 v[60:63], v[20:23], v[224:231], v3
  s_xor_b32 s58, s25, 28672
  s_add_u32 s59, s24, 28672
  s_add_u32 m0, s58, 21504
  s_branch cA_sc3_ph2
.p2align 6

cA_va0_loop:
  s_add_u32 s23, s20, 4096
  s_add_u32 s21, s20, 20480
  s_mov_b32 s30, 0
  s_cmp_lg_u32 s19, s38
  s_cbranch_scc1 cA_va0_vok
  s_branch cA_va0_voc
cA_va0_vow:
  s_sub_u32 s22, s39, s35
  v_lshlrev_b32 v63, 7, v2
  v_min_u32 v63, s22, v63
  buffer_load_dword v63, v63, s[8:11], s35 offen sc1
  s_waitcnt vmcnt(0)
cA_va0_voc:
  v_readfirstlane_b32 s22, v63
  s_cmp_eq_u32 s22, 56
  s_cbranch_scc1 cA_va0_vod
  s_sleep 1
  s_add_u32 s30, s30, 1
  s_cmp_lt_u32 s30, 400000
  s_cbranch_scc1 cA_va0_vow
  s_branch cA_abort
cA_va0_vod:
  s_add_u32 s35, s35, 2048
  s_add_u32 s38, s19, 8
  s_and_b32 s38, s38, -8
  s_cmp_eq_u32 s19, 0
  s_cselect_b32 s38, 4, s38
  v_cmp_ne_u32 vcc, 56, v63
  s_nop 3
  s_cmp_eq_u64 vcc, 0
  s_cselect_b32 s38, 99, s38
cA_va0_vok:
  s_cmp_eq_u32 s19, 63
  s_cbranch_scc1 cA_done
  s_barrier
  s_add_u32 s22, s25, 0
  buffer_load_dwordx4 v[80:83], v6, s[8:11], s22 offen offset:0 sc1
  buffer_load_dwordx4 v[84:87], v6, s[8:11], s22 offen offset:1792 sc1
  s_add_u32 s22, s25, 3584
  buffer_load_dwordx4 v[88:91], v6, s[8:11], s22 offen offset:0 sc1
  buffer_load_dwordx4 v[92:95], v6, s[8:11], s22 offen offset:1792 sc1
  s_add_u32 s22, s25, 7168
  buffer_load_dwordx4 v[96:99], v6, s[8:11], s22 offen offset:0 sc1
  buffer_load_dwordx4 v[100:103], v6, s[8:11], s22 offen offset:1792 sc1
  s_add_u32 s22, s25, 10752
  buffer_load_dwordx4 v[104:107], v6, s[8:11], s22 offen offset:0 sc1
  buffer_load_dwordx4 v[108:111], v6, s[8:11], s22 offen offset:1792 sc1
  s_add_u32 s22, s25, 14336
  buffer_load_dwordx4 v[112:115], v6, s[8:11], s22 offen offset:0 sc1
  buffer_load_dwordx4 v[116:119], v6, s[8:11], s22 offen offset:1792 sc1
  s_add_u32 s22, s25, 17920
  buffer_load_dwordx4 v[120:123], v6, s[8:11], s22 offen offset:0 sc1
  buffer_load_dwordx4 v[124:127], v6, s[8:11], s22 offen offset:1792 sc1
  s_add_u32 s22, s19, 1
  s_cmp_lg_u32 s22, s38
  s_cbranch_scc1 cA_va0_nk
  s_sub_u32 s22, s39, s35
  v_lshlrev_b32 v63, 7, v2
  v_min_u32 v63, s22, v63
  buffer_load_dword v63, v63, s[8:11], s35 offen sc1
cA_va0_nk:
  s_barrier
  ds_read_b128 v[8:11], v0 offset:8192
  ds_read_b128 v[12:15], v0 offset:9216
  ds_read_b128 v[16:19], v0 offset:10240
  ds_read_b128 v[20:23], v0 offset:11264
  ds_read_b128 v[24:27], v0 offset:12288
  ds_read_b128 v[28:31], v0 offset:13312
  ds_read_b128 v[32:35], v0 offset:14336
  s_waitcnt lgkmcnt(0)
  v_smfmac_f32_16x16x64_bf16 v[36:39], v[8:11], a[0:7], v3
  s_add_u32 s22, s25, 21504
  buffer_load_dwordx4 v[128:131], v6, s[8:11], s22 offen offset:0 sc1
  v_smfmac_f32_16x16x64_bf16 v[36:39], v[12:15], a[8:15], v3
  v_smfmac_f32_16x16x64_bf16 v[36:39], v[16:19], a[16:23], v3
  s_add_u32 s22, s25, 21504
  buffer_load_dwordx4 v[132:135], v6, s[8:11], s22 offen offset:1792 sc1
  v_smfmac_f32_16x16x64_bf16 v[36:39], v[20:23], a[24:31], v3
  v_smfmac_f32_16x16x64_bf16 v[36:39], v[24:27], a[32:39], v3
  s_add_u32 s22, s25, 25088
  buffer_load_dwordx4 v[136:139], v6, s[8:11], s22 offen offset:0 sc1
  v_smfmac_f32_16x16x64_bf16 v[36:39], v[28:31], a[40:47], v3
  v_smfmac_f32_16x16x64_bf16 v[36:39], v[32:35], a[48:55], v3
  s_add_u32 s22, s25, 25088
  buffer_load_dwordx4 v[140:143], v6, s[8:11], s22 offen offset:1792 sc1
  v_smfmac_f32_16x16x64_bf16 v[40:43], v[8:11], a[56:63], v3
  v_smfmac_f32_16x16x64_bf16 v[40:43], v[12:15], a[64:71], v3
  v_smfmac_f32_16x16x64_bf16 v[40:43], v[16:19], a[72:79], v3
  v_add_f32 v36, v36, v37
  v_smfmac_f32_16x16x64_bf16 v[40:43], v[20:23], a[80:87], v3
  v_add_f32 v38, v38, v39
  v_smfmac_f32_16x16x64_bf16 v[40:43], v[24:27], a[88:95], v3
  v_cvt_pk_bf16_f32 v36, v36, v38
  v_smfmac_f32_16x16x64_bf16 v[40:43], v[28:31], a[96:103], v3
  ds_write_b32 v60, v36
  v_smfmac_f32_16x16x64_bf16 v[40:43], v[32:35], a[104:111], v3
  v_smfmac_f32_16x16x64_bf16 v[44:47], v[8:11], a[112:119], v3
  v_smfmac_f32_16x16x64_bf16 v[44:47], v[12:15], a[120:127], v3
  v_smfmac_f32_16x16x64_bf16 v[44:47], v[16:19], a[128:135], v3
  v_add_f32 v40, v40, v41
  v_smfmac_f32_16x16x64_bf16 v[44:47], v[20:23], a[136:143], v3
  v_add_f32 v42, v42, v43
  v_smfmac_f32_16x16x64_bf16 v[44:47], v[24:27], a[144:151], v3
  v_cvt_pk_bf16_f32 v40, v40, v42
  v_smfmac_f32_16x16x64_bf16 v[44:47], v[28:31], a[152:159], v3
  ds_write_b32 v61, v40
  v_smfmac_f32_16x16x64_bf16 v[44:47], v[32:35], a[160:167], v3
  v_smfmac_f32_16x16x64_bf16 v[48:51], v[8:11], a[168:175], v3
  v_smfmac_f32_16x16x64_bf16 v[48:51], v[12:15], a[176:183], v3
  v_smfmac_f32_16x16x64_bf16 v[48:51], v[16:19], a[184:191], v3
  v_add_f32 v44, v44, v45
  v_smfmac_f32_16x16x64_bf16 v[48:51], v[20:23], a[192:199], v3
  v_add_f32 v46, v46, v47
  v_smfmac_f32_16x16x64_bf16 v[48:51], v[24:27], a[200:207], v3
  v_cvt_pk_bf16_f32 v44, v44, v46
  v_smfmac_f32_16x16x64_bf16 v[48:51], v[28:31], a[208:215], v3
  ds_write_b32 v62, v44
  v_smfmac_f32_16x16x64_bf16 v[48:51], v[32:35], a[216:223], v3
  v_smfmac_f32_16x16x64_bf16 v[52:55], v[8:11], a[224:231], v3
  v_smfmac_f32_16x16x64_bf16 v[52:55], v[12:15], a[232:239], v3
  v_smfmac_f32_16x16x64_bf16 v[52:55], v[16:19], a[240:247], v3
  v_add_f32 v48, v48, v49
  v_smfmac_f32_16x16x64_bf16 v[52:55], v[20:23], a[248:255], v3
  v_add_f32 v50, v50, v51
  v_smfmac_f32_16x16x64_bf16 v[52:55], v[24:27], v[176:183], v3
  v_cvt_pk_bf16_f32 v48, v48, v50
  v_smfmac_f32_16x16x64_bf16 v[52:55], v[28:31], v[184:191], v3
  ds_write_b32 v170, v48
  v_smfmac_f32_16x16x64_bf16 v[52:55], v[32:35], v[192:199], v3
  v_smfmac_f32_16x16x64_bf16 v[56:59], v[8:11], v[200:207], v3
  v_smfmac_f32_16x16x64_bf16 v[56:59], v[12:15], v[208:215], v3
  v_smfmac_f32_16x16x64_bf16 v[56:59], v[16:19], v[216:223], v3
  v_add_f32 v52, v52, v53
  v_smfmac_f32_16x16x64_bf16 v[56:59], v[20:23], v[224:231], v3
  v_add_f32 v54, v54, v55
  v_smfmac_f32_16x16x64_bf16 v[56:59], v[24:27], v[232:239], v3
  v_cvt_pk_bf16_f32 v52, v52, v54
  v_smfmac_f32_16x16x64_bf16 v[56:59], v[28:31], v[240:247], v3
  ds_write_b32 v171, v52
  v_smfmac_f32_16x16x64_bf16 v[56:59], v[32:35], v[248:255], v3
  s_nop 7
  v_add_f32 v56, v56, v57
  v_add_f32 v58, v58, v59
  v_cvt_pk_bf16_f32 v56, v56, v58
  ds_write_b32 v172, v56
  buffer_load_dword v164, v4, s[8:11], s20 offen sc1
  s_waitcnt lgkmcnt(0)
  v_mov_b32 v36, 0
  v_mov_b32 v37, 0
  v_mov_b32 v38, 0
  v_mov_b32 v39, 0
  v_mov_b32 v40, 0
  v_mov_b32 v41, 0
  v_mov_b32 v42, 0
  v_mov_b32 v43, 0
  buffer_load_dword v165, v4, s[8:11], s20 offen sc1
  v_mov_b32 v44, 0
  v_mov_b32 v45, 0
  v_mov_b32 v46, 0
  v_mov_b32 v47, 0
  v_mov_b32 v48, 0
  v_mov_b32 v49, 0
  v_mov_b32 v50, 0
  v_mov_b32 v51, 0
  buffer_load_dword v166, v4, s[8:11], s20 offen sc1
  v_mov_b32 v52, 0
  v_mov_b32 v53, 0
  v_mov_b32 v54, 0
  v_mov_b32 v55, 0
  v_mov_b32 v56, 0
  v_mov_b32 v57, 0
  v_mov_b32 v58, 0
  v_mov_b32 v59, 0
  buffer_load_dword v167, v4, s[8:11], s20 offen sc1
  s_cmp_eq_u32 s19, 63
  s_cbranch_scc1 cA_va0_last
  s_add_u32 s22, s20, 9216
  s_add_u32 s34, s20, 13312
  s_add_u32 s36, s20, 7168
  s_mov_b32 s37, 0
  v_mov_b32 v156, 0
  v_mov_b32 v157, 0
  v_mov_b32 v158, 0
  v_mov_b32 v159, 0
  buffer_load_dword v168, v4, s[8:11], s20 offen sc1
cA_va0_fw_l:
  s_waitcnt vmcnt(4)
  v_cmp_eq_u32 vcc, -1, v164
  s_cbranch_vccz cA_va0_fw_d
  buffer_load_dword v164, v4, s[8:11], s20 offen sc1
  s_waitcnt vmcnt(4)
  v_cmp_eq_u32 vcc, -1, v165
  s_cbranch_vccz cA_va0_fw_d
  buffer_load_dword v165, v4, s[8:11], s20 offen sc1
  s_waitcnt vmcnt(4)
  v_cmp_eq_u32 vcc, -1, v166
  s_cbranch_vccz cA_va0_fw_d
  buffer_load_dword v166, v4, s[8:11], s20 offen sc1
  s_waitcnt vmcnt(4)
  v_cmp_eq_u32 vcc, -1, v167
  s_cbranch_vccz cA_va0_fw_d
  buffer_load_dword v167, v4, s[8:11], s20 offen sc1
  s_waitcnt vmcnt(4)
  v_cmp_eq_u32 vcc, -1, v168
  s_cbranch_vccz cA_va0_fw_d
  buffer_load_dword v168, v4, s[8:11], s20 offen sc1
  s_add_u32 s30, s30, 1
  s_cmp_lt_u32 s30, 400000
  s_cbranch_scc1 cA_va0_fw_l
  s_branch cA_abort
cA_va0_fw_d:
  s_waitcnt lgkmcnt(0)
  buffer_load_dwordx4 v[8:11], v5, s[8:11], s22 offen offset:0
  buffer_load_dwordx4 v[12:15], v5, s[8:11], s22 offen offset:1024
  buffer_load_dwordx4 v[16:19], v5, s[8:11], s22 offen offset:2048
  buffer_load_dwordx4 v[20:23], v5, s[8:11], s22 offen offset:3072
  buffer_load_dwordx4 v[24:27], v5, s[8:11], s34 offen offset:0
  buffer_load_dwordx4 v[28:31], v5, s[8:11], s34 offen offset:1024
  buffer_load_dwordx4 v[32:35], v5, s[8:11], s34 offen offset:2048
  buffer_load_dwordx4 v[144:147], v5, s[8:11], s34 offen offset:3072
  buffer_load_dwordx4 v[148:151], v2, s[8:11], s36 offen offset:0
  buffer_load_dwordx4 v[152:155], v2, s[8:11], s36 offen offset:1024
  s_barrier
  ds_read_b128 v[64:67], v2 offset:0
  ds_read_b128 v[68:71], v2 offset:1024
  ds_read_b128 v[72:75], v2 offset:2048
  ds_read_b128 v[76:79], v2 offset:3072
  s_waitcnt vmcnt(9)
  v_smfmac_f32_16x16x64_bf16 v[156:159], v[8:11], v[80:87], v3
  s_waitcnt vmcnt(8)
  v_smfmac_f32_16x16x64_bf16 v[156:159], v[12:15], v[88:95], v3
  s_waitcnt vmcnt(7)
  v_smfmac_f32_16x16x64_bf16 v[156:159], v[16:19], v[96:103], v3
  s_waitcnt vmcnt(6)
  v_smfmac_f32_16x16x64_bf16 v[156:159], v[20:23], v[104:111], v3
  s_waitcnt vmcnt(5)
  v_smfmac_f32_16x16x64_bf16 v[156:159], v[24:27], v[112:119], v3
  s_waitcnt vmcnt(4)
  v_smfmac_f32_16x16x64_bf16 v[156:159], v[28:31], v[120:127], v3
  s_waitcnt vmcnt(3)
  v_smfmac_f32_16x16x64_bf16 v[156:159], v[32:35], v[128:135], v3
  s_waitcnt vmcnt(2)
  v_smfmac_f32_16x16x64_bf16 v[156:159], v[144:147], v[136:143], v3
  s_waitcnt vmcnt(1) lgkmcnt(0)
  v_smfmac_f32_16x16x64_bf16 v[156:159], v[148:151], v[64:71], v3
  s_waitcnt vmcnt(0)
  v_smfmac_f32_16x16x64_bf16 v[156:159], v[152:155], v[72:79], v3
cA_va0_ep:
  s_nop 7
  v_add_f32 v160, v156, v157
  v_add_f32 v161, v158, v159
  v_cmp_u_f32 vcc, v160, v161
  v_mov_b32_dpp v162, v160 row_ror:8 row_mask:0xf bank_mask:0xf
  v_mov_b32_dpp v160, v161 row_ror:8 row_mask:0xf bank_mask:0xc
  s_cbranch_vccnz cA_va0_rp
  v_mov_b32_dpp v161, v162 quad_perm:[0,1,2,3] row_mask:0xf bank_mask:0x3
  v_cvt_pk_bf16_f32 v160, v160, v161
cA_va0_pc:
  buffer_store_dword v160, v1, s[8:11], s21 offen
  s_cmp_lg_u32 s19, 62
  s_cbranch_scc1 cA_va0_nl
  s_mov_b32 s22, 88531968
  buffer_store_dword v160, v1, s[8:11], s22 offen sc1
  s_mov_b64 exec, -1
  s_branch cA_done
cA_va0_nl:
  s_mov_b64 exec, -1
  s_add_u32 s25, s25, 28672
  s_add_u32 s19, s19, 1
  s_mov_b32 s20, s21
  s_branch cA_va0_loop
cA_va0_last:
  s_waitcnt lgkmcnt(0)
  s_barrier
  s_branch cA_done
cA_va0_rp:
  s_cmp_eq_u32 s37, 0
  s_cbranch_scc1 cA_va0_rv
  v_mov_b32_dpp v161, v162 quad_perm:[0,1,2,3] row_mask:0xf bank_mask:0x3
  v_cvt_pk_bf16_f32 v160, v160, v161
  v_min_u32 v160, -2, v160
  s_branch cA_va0_pc
cA_va0_rv:
  buffer_load_dwordx4 v[8:11], v5, s[8:11], s22 offen offset:0 sc1
  buffer_load_dwordx4 v[12:15], v5, s[8:11], s22 offen offset:1024 sc1
  buffer_load_dwordx4 v[16:19], v5, s[8:11], s22 offen offset:2048 sc1
  buffer_load_dwordx4 v[20:23], v5, s[8:11], s22 offen offset:3072 sc1
  buffer_load_dwordx4 v[24:27], v5, s[8:11], s34 offen offset:0 sc1
  buffer_load_dwordx4 v[28:31], v5, s[8:11], s34 offen offset:1024 sc1
  buffer_load_dwordx4 v[32:35], v5, s[8:11], s34 offen offset:2048 sc1
  buffer_load_dwordx4 v[144:147], v5, s[8:11], s34 offen offset:3072 sc1
  buffer_load_dwordx4 v[148:151], v2, s[8:11], s36 offen offset:0 sc1
  buffer_load_dwordx4 v[152:155], v2, s[8:11], s36 offen offset:1024 sc1
  s_waitcnt vmcnt(0)
  v_max3_u32 v175, v8, v9, v10
  v_max3_u32 v175, v175, v11, v12
  v_max3_u32 v175, v175, v13, v14
  v_max3_u32 v175, v175, v15, v16
  v_max3_u32 v175, v175, v17, v18
  v_max3_u32 v175, v175, v19, v20
  v_max3_u32 v175, v175, v21, v22
  v_max3_u32 v175, v175, v23, v24
  v_max3_u32 v175, v175, v25, v26
  v_max3_u32 v175, v175, v27, v28
  v_max3_u32 v175, v175, v29, v30
  v_max3_u32 v175, v175, v31, v32
  v_max3_u32 v175, v175, v33, v34
  v_max3_u32 v175, v175, v35, v144
  v_max3_u32 v175, v175, v145, v146
  v_max3_u32 v175, v175, v147, v148
  v_max3_u32 v175, v175, v149, v150
  v_max3_u32 v175, v175, v151, v152
  v_max3_u32 v175, v175, v153, v154
  v_max_u32 v175, v175, v155
  v_cmp_eq_u32 vcc, -1, v175
  s_cbranch_vccz cA_va0_rk
  s_add_u32 s30, s30, 1
  s_cmp_lt_u32 s30, 400000
  s_cbranch_scc1 cA_va0_rv
  s_branch cA_abort
cA_va0_rk:
  s_mov_b32 s37, 1
  s_add_u32 s31, s31, 0x10000
  v_mov_b32 v156, 0
  v_mov_b32 v157, 0
  v_mov_b32 v158, 0
  v_mov_b32 v159, 0
  s_nop 1
  v_smfmac_f32_16x16x64_bf16 v[156:159], v[8:11], v[80:87], v3
  v_smfmac_f32_16x16x64_bf16 v[156:159], v[12:15], v[88:95], v3
  v_smfmac_f32_16x16x64_bf16 v[156:159], v[16:19], v[96:103], v3
  v_smfmac_f32_16x16x64_bf16 v[156:159], v[20:23], v[104:111], v3
  v_smfmac_f32_16x16x64_bf16 v[156:159], v[24:27], v[112:119], v3
  v_smfmac_f32_16x16x64_bf16 v[156:159], v[28:31], v[120:127], v3
  v_smfmac_f32_16x16x64_bf16 v[156:159], v[32:35], v[128:135], v3
  v_smfmac_f32_16x16x64_bf16 v[156:159], v[144:147], v[136:143], v3
  v_smfmac_f32_16x16x64_bf16 v[156:159], v[148:151], v[64:71], v3
  v_smfmac_f32_16x16x64_bf16 v[156:159], v[152:155], v[72:79], v3
  s_nop 7
  s_branch cA_va0_ep
.p2align 6

cA_va1_loop:
  s_add_u32 s23, s20, 4096
  s_add_u32 s21, s20, 20480
  s_mov_b32 s30, 0
  s_cmp_lg_u32 s19, s38
  s_cbranch_scc1 cA_va1_vok
  s_branch cA_va1_voc
cA_va1_vow:
  s_sub_u32 s22, s39, s35
  v_lshlrev_b32 v63, 7, v2
  v_min_u32 v63, s22, v63
  buffer_load_dword v63, v63, s[8:11], s35 offen sc1
  s_waitcnt vmcnt(0)
cA_va1_voc:
  v_readfirstlane_b32 s22, v63
  s_cmp_eq_u32 s22, 56
  s_cbranch_scc1 cA_va1_vod
  s_sleep 1
  s_add_u32 s30, s30, 1
  s_cmp_lt_u32 s30, 400000
  s_cbranch_scc1 cA_va1_vow
  s_branch cA_abort
cA_va1_vod:
  s_add_u32 s35, s35, 2048
  s_add_u32 s38, s19, 8
  s_and_b32 s38, s38, -8
  s_cmp_eq_u32 s19, 0
  s_cselect_b32 s38, 4, s38
  v_cmp_ne_u32 vcc, 56, v63
  s_nop 3
  s_cmp_eq_u64 vcc, 0
  s_cselect_b32 s38, 99, s38
cA_va1_vok:
  s_cmp_eq_u32 s19, 63
  s_cbranch_scc1 cA_done
  s_barrier
  s_add_u32 s22, s25, 0
  buffer_load_dwordx4 v[80:83], v6, s[8:11], s22 offen offset:0 sc1
  buffer_load_dwordx4 v[84:87], v6, s[8:11], s22 offen offset:1792 sc1
  s_add_u32 s22, s25, 3584
  buffer_load_dwordx4 v[88:91], v6, s[8:11], s22 offen offset:0 sc1
  buffer_load_dwordx4 v[92:95], v6, s[8:11], s22 offen offset:1792 sc1
  s_add_u32 s22, s25, 7168
  buffer_load_dwordx4 v[96:99], v6, s[8:11], s22 offen offset:0 sc1
  buffer_load_dwordx4 v[100:103], v6, s[8:11], s22 offen offset:1792 sc1
  s_add_u32 s22, s25, 10752
  buffer_load_dwordx4 v[104:107], v6, s[8:11], s22 offen offset:0 sc1
  buffer_load_dwordx4 v[108:111], v6, s[8:11], s22 offen offset:1792 sc1
  s_add_u32 s22, s25, 14336
  buffer_load_dwordx4 v[112:115], v6, s[8:11], s22 offen offset:0 sc1
  buffer_load_dwordx4 v[116:119], v6, s[8:11], s22 offen offset:1792 sc1
  s_add_u32 s22, s25, 17920
  buffer_load_dwordx4 v[120:123], v6, s[8:11], s22 offen offset:0 sc1
  buffer_load_dwordx4 v[124:127], v6, s[8:11], s22 offen offset:1792 sc1
  s_add_u32 s22, s19, 1
  s_cmp_lg_u32 s22, s38
  s_cbranch_scc1 cA_va1_nk
  s_sub_u32 s22, s39, s35
  v_lshlrev_b32 v63, 7, v2
  v_min_u32 v63, s22, v63
  buffer_load_dword v63, v63, s[8:11], s35 offen sc1
cA_va1_nk:
  s_barrier
  ds_read_b128 v[8:11], v0 offset:8192
  ds_read_b128 v[12:15], v0 offset:9216
  ds_read_b128 v[16:19], v0 offset:10240
  ds_read_b128 v[20:23], v0 offset:11264
  ds_read_b128 v[24:27], v0 offset:12288
  ds_read_b128 v[28:31], v0 offset:13312
  ds_read_b128 v[32:35], v0 offset:14336
  s_waitcnt lgkmcnt(0)
  v_smfmac_f32_16x16x64_bf16 v[36:39], v[8:11], a[0:7], v3
  s_add_u32 s22, s25, 21504
  buffer_load_dwordx4 v[128:131], v6, s[8:11], s22 offen offset:0 sc1
  v_smfmac_f32_16x16x64_bf16 v[36:39], v[12:15], a[8:15], v3
  v_smfmac_f32_16x16x64_bf16 v[36:39], v[16:19], a[16:23], v3
  s_add_u32 s22, s25, 21504
  buffer_load_dwordx4 v[132:135], v6, s[8:11], s22 offen offset:1792 sc1
  v_smfmac_f32_16x16x64_bf16 v[36:39], v[20:23], a[24:31], v3
  v_smfmac_f32_16x16x64_bf16 v[36:39], v[24:27], a[32:39], v3
  s_add_u32 s22, s25, 25088
  buffer_load_dwordx4 v[136:139], v6, s[8:11], s22 offen offset:0 sc1
  v_smfmac_f32_16x16x64_bf16 v[36:39], v[28:31], a[40:47], v3
  v_smfmac_f32_16x16x64_bf16 v[36:39], v[32:35], a[48:55], v3
  s_add_u32 s22, s25, 25088
  buffer_load_dwordx4 v[140:143], v6, s[8:11], s22 offen offset:1792 sc1
  v_smfmac_f32_16x16x64_bf16 v[40:43], v[8:11], a[56:63], v3
  v_smfmac_f32_16x16x64_bf16 v[40:43], v[12:15], a[64:71], v3
  v_smfmac_f32_16x16x64_bf16 v[40:43], v[16:19], a[72:79], v3
  v_add_f32 v36, v36, v37
  v_smfmac_f32_16x16x64_bf16 v[40:43], v[20:23], a[80:87], v3
  v_add_f32 v38, v38, v39
  v_smfmac_f32_16x16x64_bf16 v[40:43], v[24:27], a[88:95], v3
  v_cvt_pk_bf16_f32 v36, v36, v38
  v_smfmac_f32_16x16x64_bf16 v[40:43], v[28:31], a[96:103], v3
  ds_write_b32 v60, v36
  v_smfmac_f32_16x16x64_bf16 v[40:43], v[32:35], a[104:111], v3
  v_smfmac_f32_16x16x64_bf16 v[44:47], v[8:11], a[112:119], v3
  v_smfmac_f32_16x16x64_bf16 v[44:47], v[12:15], a[120:127], v3
  v_smfmac_f32_16x16x64_bf16 v[44:47], v[16:19], a[128:135], v3
  v_add_f32 v40, v40, v41
  v_smfmac_f32_16x16x64_bf16 v[44:47], v[20:23], a[136:143], v3
  v_add_f32 v42, v42, v43
  v_smfmac_f32_16x16x64_bf16 v[44:47], v[24:27], a[144:151], v3
  v_cvt_pk_bf16_f32 v40, v40, v42
  v_smfmac_f32_16x16x64_bf16 v[44:47], v[28:31], a[152:159], v3
  ds_write_b32 v61, v40
  v_smfmac_f32_16x16x64_bf16 v[44:47], v[32:35], a[160:167], v3
  v_smfmac_f32_16x16x64_bf16 v[48:51], v[8:11], a[168:175], v3
  v_smfmac_f32_16x16x64_bf16 v[48:51], v[12:15], a[176:183], v3
  v_smfmac_f32_16x16x64_bf16 v[48:51], v[16:19], a[184:191], v3
  v_add_f32 v44, v44, v45
  v_smfmac_f32_16x16x64_bf16 v[48:51], v[20:23], a[192:199], v3
  v_add_f32 v46, v46, v47
  v_smfmac_f32_16x16x64_bf16 v[48:51], v[24:27], a[200:207], v3
  v_cvt_pk_bf16_f32 v44, v44, v46
  v_smfmac_f32_16x16x64_bf16 v[48:51], v[28:31], a[208:215], v3
  ds_write_b32 v62, v44
  v_smfmac_f32_16x16x64_bf16 v[48:51], v[32:35], a[216:223], v3
  v_smfmac_f32_16x16x64_bf16 v[52:55], v[8:11], a[224:231], v3
  v_smfmac_f32_16x16x64_bf16 v[52:55], v[12:15], a[232:239], v3
  v_smfmac_f32_16x16x64_bf16 v[52:55], v[16:19], a[240:247], v3
  v_add_f32 v48, v48, v49
  v_smfmac_f32_16x16x64_bf16 v[52:55], v[20:23], a[248:255], v3
  v_add_f32 v50, v50, v51
  v_smfmac_f32_16x16x64_bf16 v[52:55], v[24:27], v[176:183], v3
  v_cvt_pk_bf16_f32 v48, v48, v50
  v_smfmac_f32_16x16x64_bf16 v[52:55], v[28:31], v[184:191], v3
  ds_write_b32 v170, v48
  v_smfmac_f32_16x16x64_bf16 v[52:55], v[32:35], v[192:199], v3
  v_smfmac_f32_16x16x64_bf16 v[56:59], v[8:11], v[200:207], v3
  v_smfmac_f32_16x16x64_bf16 v[56:59], v[12:15], v[208:215], v3
  v_smfmac_f32_16x16x64_bf16 v[56:59], v[16:19], v[216:223], v3
  v_add_f32 v52, v52, v53
  v_smfmac_f32_16x16x64_bf16 v[56:59], v[20:23], v[224:231], v3
  v_add_f32 v54, v54, v55
  v_smfmac_f32_16x16x64_bf16 v[56:59], v[24:27], v[232:239], v3
  v_cvt_pk_bf16_f32 v52, v52, v54
  v_smfmac_f32_16x16x64_bf16 v[56:59], v[28:31], v[240:247], v3
  ds_write_b32 v171, v52
  v_smfmac_f32_16x16x64_bf16 v[56:59], v[32:35], v[248:255], v3
  s_nop 7
  v_add_f32 v56, v56, v57
  v_add_f32 v58, v58, v59
  v_cvt_pk_bf16_f32 v56, v56, v58
  ds_write_b32 v172, v56
  s_waitcnt lgkmcnt(0)
  v_mov_b32 v36, 0
  v_mov_b32 v37, 0
  v_mov_b32 v38, 0
  v_mov_b32 v39, 0
  v_mov_b32 v40, 0
  v_mov_b32 v41, 0
  v_mov_b32 v42, 0
  v_mov_b32 v43, 0
  v_mov_b32 v44, 0
  v_mov_b32 v45, 0
  v_mov_b32 v46, 0
  v_mov_b32 v47, 0
  v_mov_b32 v48, 0
  v_mov_b32 v49, 0
  v_mov_b32 v50, 0
  v_mov_b32 v51, 0
  v_mov_b32 v52, 0
  v_mov_b32 v53, 0
  v_mov_b32 v54, 0
  v_mov_b32 v55, 0
  v_mov_b32 v56, 0
  v_mov_b32 v57, 0
  v_mov_b32 v58, 0
  v_mov_b32 v59, 0
  s_cmp_eq_u32 s19, 63
  s_cbranch_scc1 cA_va1_last
  s_add_u32 s22, s20, 9216
  s_add_u32 s34, s20, 13312
  s_add_u32 s36, s20, 7168
  s_mov_b32 s37, 0
  v_mov_b32 v156, 0
  v_mov_b32 v157, 0
  v_mov_b32 v158, 0
  v_mov_b32 v159, 0
  s_barrier
  s_waitcnt lgkmcnt(0)
  buffer_load_dwordx4 v[8:11], v5, s[8:11], s22 offen offset:0
  buffer_load_dwordx4 v[12:15], v5, s[8:11], s22 offen offset:1024
  buffer_load_dwordx4 v[16:19], v5, s[8:11], s22 offen offset:2048
  buffer_load_dwordx4 v[20:23], v5, s[8:11], s22 offen offset:3072
  buffer_load_dwordx4 v[24:27], v5, s[8:11], s34 offen offset:0
  buffer_load_dwordx4 v[28:31], v5, s[8:11], s34 offen offset:1024
  buffer_load_dwordx4 v[32:35], v5, s[8:11], s34 offen offset:2048
  buffer_load_dwordx4 v[144:147], v5, s[8:11], s34 offen offset:3072
  s_sub_u32 s23, s21, 4
  s_mov_b64 exec, 65535
  buffer_store_dword v2, v7, s[8:11], s23 offen
  s_mov_b64 exec, -1
  buffer_load_dwordx4 v[148:151], v2, s[8:11], s36 offen offset:0
  buffer_load_dwordx4 v[152:155], v2, s[8:11], s36 offen offset:1024
  ds_read_b128 v[64:67], v2 offset:4096
  ds_read_b128 v[68:71], v2 offset:5120
  ds_read_b128 v[72:75], v2 offset:6144
  ds_read_b128 v[76:79], v2 offset:7168
  s_waitcnt vmcnt(10)
  v_smfmac_f32_16x16x64_bf16 v[156:159], v[8:11], v[80:87], v3
  s_waitcnt vmcnt(9)
  v_smfmac_f32_16x16x64_bf16 v[156:159], v[12:15], v[88:95], v3
  s_waitcnt vmcnt(8)
  v_smfmac_f32_16x16x64_bf16 v[156:159], v[16:19], v[96:103], v3
  s_waitcnt vmcnt(7)
  v_smfmac_f32_16x16x64_bf16 v[156:159], v[20:23], v[104:111], v3
  s_waitcnt vmcnt(6)
  v_smfmac_f32_16x16x64_bf16 v[156:159], v[24:27], v[112:119], v3
  s_mov_b64 exec, 65535
  buffer_store_dword v2, v7, s[8:11], s21 offen
  s_mov_b64 exec, -1
  s_waitcnt vmcnt(6)
  v_smfmac_f32_16x16x64_bf16 v[156:159], v[28:31], v[120:127], v3
  s_waitcnt vmcnt(5)
  v_smfmac_f32_16x16x64_bf16 v[156:159], v[32:35], v[128:135], v3
  s_waitcnt vmcnt(4)
  v_smfmac_f32_16x16x64_bf16 v[156:159], v[144:147], v[136:143], v3
  s_waitcnt vmcnt(2) lgkmcnt(0)
  v_smfmac_f32_16x16x64_bf16 v[156:159], v[148:151], v[64:71], v3
  s_waitcnt vmcnt(1)
  v_smfmac_f32_16x16x64_bf16 v[156:159], v[152:155], v[72:79], v3
cA_va1_ep:
  s_nop 7
  v_add_f32 v160, v156, v157
  v_add_f32 v161, v158, v159
  v_cmp_u_f32 vcc, v160, v161
  v_mov_b32_dpp v162, v160 row_ror:8 row_mask:0xf bank_mask:0xf
  v_mov_b32_dpp v160, v161 row_ror:8 row_mask:0xf bank_mask:0xc
  s_cbranch_vccnz cA_va1_rp
  v_mov_b32_dpp v161, v162 quad_perm:[0,1,2,3] row_mask:0xf bank_mask:0x3
  v_cvt_pk_bf16_f32 v160, v160, v161
cA_va1_pc:
  s_mov_b64 exec, s[26:27]
  buffer_store_dword v160, v1, s[8:11], s21 offen
  s_cmp_lg_u32 s19, 62
  s_cbranch_scc1 cA_va1_nl
  s_mov_b32 s22, 88531968
  buffer_store_dword v160, v1, s[8:11], s22 offen sc1
  s_mov_b64 exec, -1
  s_branch cA_done
cA_va1_nl:
  s_mov_b64 exec, -1
  s_cmp_lg_u32 s19, 0
  s_cbranch_scc1 cA_va1_s0
  v_add_u32 v7, 512, v7
  v_lshl_add_u32 v7, v2, 3, v7
  s_mov_b64 exec, 65535
  buffer_store_dword v2, v7, s[8:11], s21 offen
  buffer_store_dword v2, v7, s[8:11], s23 offen
  s_mov_b64 exec, -1
cA_va1_s0:
  s_add_u32 s25, s25, 28672
  s_add_u32 s19, s19, 1
  s_mov_b32 s20, s21
  s_branch cA_va1_loop
cA_va1_last:
  s_waitcnt lgkmcnt(0)
  s_barrier
  s_branch cA_done
cA_va1_rp:
  s_cmp_eq_u32 s37, 0
  s_cbranch_scc1 cA_va1_rv
  v_mov_b32_dpp v161, v162 quad_perm:[0,1,2,3] row_mask:0xf bank_mask:0x3
  v_cvt_pk_bf16_f32 v160, v160, v161
  v_min_u32 v160, -2, v160
  s_branch cA_va1_pc
cA_va1_rv:
  buffer_load_dwordx4 v[8:11], v5, s[8:11], s22 offen offset:0 sc1
  buffer_load_dwordx4 v[12:15], v5, s[8:11], s22 offen offset:1024 sc1
  buffer_load_dwordx4 v[16:19], v5, s[8:11], s22 offen offset:2048 sc1
  buffer_load_dwordx4 v[20:23], v5, s[8:11], s22 offen offset:3072 sc1
  buffer_load_dwordx4 v[24:27], v5, s[8:11], s34 offen offset:0 sc1
  buffer_load_dwordx4 v[28:31], v5, s[8:11], s34 offen offset:1024 sc1
  buffer_load_dwordx4 v[32:35], v5, s[8:11], s34 offen offset:2048 sc1
  buffer_load_dwordx4 v[144:147], v5, s[8:11], s34 offen offset:3072 sc1
  buffer_load_dwordx4 v[148:151], v2, s[8:11], s36 offen offset:0 sc1
  buffer_load_dwordx4 v[152:155], v2, s[8:11], s36 offen offset:1024 sc1
  s_waitcnt vmcnt(0)
  v_max3_u32 v175, v8, v9, v10
  v_max3_u32 v175, v175, v11, v12
  v_max3_u32 v175, v175, v13, v14
  v_max3_u32 v175, v175, v15, v16
  v_max3_u32 v175, v175, v17, v18
  v_max3_u32 v175, v175, v19, v20
  v_max3_u32 v175, v175, v21, v22
  v_max3_u32 v175, v175, v23, v24
  v_max3_u32 v175, v175, v25, v26
  v_max3_u32 v175, v175, v27, v28
  v_max3_u32 v175, v175, v29, v30
  v_max3_u32 v175, v175, v31, v32
  v_max3_u32 v175, v175, v33, v34
  v_max3_u32 v175, v175, v35, v144
  v_max3_u32 v175, v175, v145, v146
  v_max3_u32 v175, v175, v147, v148
  v_max3_u32 v175, v175, v149, v150
  v_max3_u32 v175, v175, v151, v152
  v_max3_u32 v175, v175, v153, v154
  v_max_u32 v175, v175, v155
  v_cmp_eq_u32 vcc, -1, v175
  s_cbranch_vccz cA_va1_rk
  s_add_u32 s30, s30, 1
  s_cmp_lt_u32 s30, 400000
  s_cbranch_scc1 cA_va1_rv
  s_branch cA_abort
cA_va1_rk:
  s_mov_b32 s37, 1
  s_add_u32 s31, s31, 0x10000
  v_mov_b32 v156, 0
  v_mov_b32 v157, 0
  v_mov_b32 v158, 0
  v_mov_b32 v159, 0
  s_nop 1
  v_smfmac_f32_16x16x64_bf16 v[156:159], v[8:11], v[80:87], v3
  v_smfmac_f32_16x16x64_bf16 v[156:159], v[12:15], v[88:95], v3
  v_smfmac_f32_16x16x64_bf16 v[156:159], v[16:19], v[96:103], v3
  v_smfmac_f32_16x16x64_bf16 v[156:159], v[20:23], v[104:111], v3
  v_smfmac_f32_16x16x64_bf16 v[156:159], v[24:27], v[112:119], v3
  v_smfmac_f32_16x16x64_bf16 v[156:159], v[28:31], v[120:127], v3
  v_smfmac_f32_16x16x64_bf16 v[156:159], v[32:35], v[128:135], v3
  v_smfmac_f32_16x16x64_bf16 v[156:159], v[144:147], v[136:143], v3
  v_smfmac_f32_16x16x64_bf16 v[156:159], v[148:151], v[64:71], v3
  v_smfmac_f32_16x16x64_bf16 v[156:159], v[152:155], v[72:79], v3
  s_nop 7
  s_branch cA_va1_ep
.p2align 6

cA_va2_loop:
  s_add_u32 s23, s20, 4096
  s_add_u32 s21, s20, 20480
  v_mov_b32 v36, 0
  v_mov_b32 v37, 0
  v_mov_b32 v38, 0
  v_mov_b32 v39, 0
  v_mov_b32 v40, 0
  v_mov_b32 v41, 0
  v_mov_b32 v42, 0
  v_mov_b32 v43, 0
  v_mov_b32 v44, 0
  v_mov_b32 v45, 0
  v_mov_b32 v46, 0
  v_mov_b32 v47, 0
  v_mov_b32 v48, 0
  v_mov_b32 v49, 0
  v_mov_b32 v50, 0
  v_mov_b32 v51, 0
  v_mov_b32 v52, 0
  v_mov_b32 v53, 0
  v_mov_b32 v54, 0
  v_mov_b32 v55, 0
  v_mov_b32 v56, 0
  v_mov_b32 v57, 0
  v_mov_b32 v58, 0
  v_mov_b32 v59, 0
  v_mov_b32 v60, 0
  v_mov_b32 v61, 0
  v_mov_b32 v62, 0
  v_mov_b32 v63, 0
  v_mov_b32 v64, 0
  v_mov_b32 v65, 0
  v_mov_b32 v66, 0
  v_mov_b32 v67, 0
  s_mov_b32 s30, 0
  buffer_load_dword v76, v119, s[8:11], s20 offen sc1
  buffer_load_dword v77, v119, s[8:11], s20 offen sc1
  buffer_load_dword v78, v119, s[8:11], s20 offen sc1
cA_va2_fp_l:
  s_waitcnt vmcnt(2)
  v_cmp_eq_u32 vcc, -1, v76
  s_cbranch_vccz cA_va2_fp_d
  buffer_load_dword v76, v119, s[8:11], s20 offen sc1
  s_waitcnt vmcnt(2)
  v_cmp_eq_u32 vcc, -1, v77
  s_cbranch_vccz cA_va2_fp_d
  buffer_load_dword v77, v119, s[8:11], s20 offen sc1
  s_waitcnt vmcnt(2)
  v_cmp_eq_u32 vcc, -1, v78
  s_cbranch_vccz cA_va2_fp_d
  buffer_load_dword v78, v119, s[8:11], s20 offen sc1
  s_add_u32 s30, s30, 1
  s_cmp_lt_u32 s30, 400000
  s_cbranch_scc1 cA_va2_fp_l
  s_branch cA_abort
cA_va2_fp_d:
  s_nop 15
  s_nop 3
  buffer_load_dwordx4 v[8:11], v2, s[8:11], s20 offen offset:0 sc1
  buffer_load_dwordx4 v[12:15], v2, s[8:11], s20 offen offset:1024 sc1
  buffer_load_dwordx4 v[16:19], v2, s[8:11], s20 offen offset:2048 sc1
  buffer_load_dwordx4 v[20:23], v2, s[8:11], s20 offen offset:3072 sc1
  s_barrier
cA_va2_ld:
  s_waitcnt vmcnt(0)
  v_max3_u32 v84, v8, v9, v10
  v_max3_u32 v84, v84, v11, v12
  v_max3_u32 v84, v84, v13, v14
  v_max3_u32 v84, v84, v15, v16
  v_max3_u32 v84, v84, v17, v18
  v_max3_u32 v84, v84, v19, v20
  v_max3_u32 v84, v84, v21, v22
  v_max_u32 v84, v84, v23
  v_cmp_eq_u32 vcc, -1, v84
  ds_write_b128 v2, v[8:11] offset:8192
  ds_write_b128 v2, v[12:15] offset:9216
  ds_write_b128 v2, v[16:19] offset:10240
  ds_write_b128 v2, v[20:23] offset:11264
  s_cbranch_vccnz cA_va2_retry
  s_waitcnt lgkmcnt(0)
  s_barrier
  ds_read_b128 v[8:11], v5 offset:8192
  ds_read_b128 v[12:15], v5 offset:9216
  ds_read_b128 v[16:19], v5 offset:10240
  ds_read_b128 v[20:23], v5 offset:11264
  ds_read_b128 v[24:27], v5 offset:12288
  ds_read_b128 v[28:31], v5 offset:13312
  ds_read_b128 v[32:35], v5 offset:14336
  ds_read_b128 v[92:95], v0
  s_waitcnt lgkmcnt(0)
  s_mov_b64 exec, s[26:27]
  buffer_store_dwordx4 v[92:95], v2, s[8:11], s36 offen sc1
  s_mov_b64 exec, -1
  s_add_u32 s36, s36, 7168
  s_cmp_eq_u32 s19, 63
  s_cbranch_scc1 cA_done
  ds_read_b128 v[76:79], v1 offset:0
  ds_read_b128 v[80:83], v1 offset:1024
  ds_read_b128 v[84:87], v1 offset:2048
  ds_read_b128 v[88:91], v1 offset:3072
  ds_read_b128 v[92:95], v1 offset:4096
  ds_read_b128 v[96:99], v1 offset:5120
  v_smfmac_f32_16x16x64_bf16 v[60:63], v[8:11], v[200:207], v3
  v_smfmac_f32_16x16x64_bf16 v[60:63], v[12:15], v[208:215], v3
  s_waitcnt lgkmcnt(4)
  v_smfmac_f32_16x16x64_bf16 v[64:67], v[8:11], v[76:83], v3
  ds_read_b128 v[76:79], v1 offset:6144
  ds_read_b128 v[80:83], v1 offset:7168
  v_smfmac_f32_16x16x64_bf16 v[60:63], v[16:19], v[216:223], v3
  v_smfmac_f32_16x16x64_bf16 v[60:63], v[20:23], v[224:231], v3
  s_waitcnt lgkmcnt(4)
  v_smfmac_f32_16x16x64_bf16 v[64:67], v[12:15], v[84:91], v3
  ds_read_b128 v[84:87], v1 offset:8192
  ds_read_b128 v[88:91], v1 offset:9216
  v_smfmac_f32_16x16x64_bf16 v[60:63], v[24:27], v[232:239], v3
  v_smfmac_f32_16x16x64_bf16 v[60:63], v[28:31], v[240:247], v3
  s_waitcnt lgkmcnt(4)
  v_smfmac_f32_16x16x64_bf16 v[64:67], v[16:19], v[92:99], v3
  ds_read_b128 v[92:95], v1 offset:10240
  ds_read_b128 v[96:99], v1 offset:11264
  v_smfmac_f32_16x16x64_bf16 v[60:63], v[32:35], v[248:255], v3
  v_smfmac_f32_16x16x64_bf16 v[36:39], v[8:11], a[0:7], v3
  s_waitcnt lgkmcnt(4)
  v_smfmac_f32_16x16x64_bf16 v[64:67], v[20:23], v[76:83], v3
  ds_read_b128 v[76:79], v1 offset:12288
  ds_read_b128 v[80:83], v1 offset:13312
  v_smfmac_f32_16x16x64_bf16 v[36:39], v[12:15], a[8:15], v3
  v_add_f32 v60, v60, v61
  v_smfmac_f32_16x16x64_bf16 v[36:39], v[16:19], a[16:23], v3
  v_add_f32 v62, v62, v63
  s_waitcnt lgkmcnt(4)
  v_smfmac_f32_16x16x64_bf16 v[64:67], v[24:27], v[84:91], v3
  v_cvt_pk_bf16_f32 v60, v60, v62
  v_smfmac_f32_16x16x64_bf16 v[36:39], v[20:23], a[24:31], v3
  ds_write_b32 v106, v60
  v_smfmac_f32_16x16x64_bf16 v[36:39], v[24:27], a[32:39], v3
  s_waitcnt lgkmcnt(2)
  v_smfmac_f32_16x16x64_bf16 v[64:67], v[28:31], v[92:99], v3
  v_smfmac_f32_16x16x64_bf16 v[36:39], v[28:31], a[40:47], v3
  v_smfmac_f32_16x16x64_bf16 v[36:39], v[32:35], a[48:55], v3
  s_waitcnt lgkmcnt(0)
  v_smfmac_f32_16x16x64_bf16 v[64:67], v[32:35], v[76:83], v3
  v_smfmac_f32_16x16x64_bf16 v[40:43], v[8:11], a[56:63], v3
  v_smfmac_f32_16x16x64_bf16 v[40:43], v[12:15], a[64:71], v3
  v_add_f32 v36, v36, v37
  v_smfmac_f32_16x16x64_bf16 v[40:43], v[16:19], a[72:79], v3
  v_add_f32 v38, v38, v39
  v_smfmac_f32_16x16x64_bf16 v[40:43], v[20:23], a[80:87], v3
  v_cvt_pk_bf16_f32 v36, v36, v38
  v_smfmac_f32_16x16x64_bf16 v[40:43], v[24:27], a[88:95], v3
  ds_write_b32 v100, v36
  v_smfmac_f32_16x16x64_bf16 v[40:43], v[28:31], a[96:103], v3
  v_add_f32 v64, v64, v65
  v_smfmac_f32_16x16x64_bf16 v[40:43], v[32:35], a[104:111], v3
  v_add_f32 v66, v66, v67
  v_smfmac_f32_16x16x64_bf16 v[44:47], v[8:11], a[112:119], v3
  v_cvt_pk_bf16_f32 v64, v64, v66
  v_smfmac_f32_16x16x64_bf16 v[44:47], v[12:15], a[120:127], v3
  ds_write_b32 v107, v64
  v_smfmac_f32_16x16x64_bf16 v[44:47], v[16:19], a[128:135], v3
  v_add_f32 v40, v40, v41
  v_smfmac_f32_16x16x64_bf16 v[44:47], v[20:23], a[136:143], v3
  v_add_f32 v42, v42, v43
  v_smfmac_f32_16x16x64_bf16 v[44:47], v[24:27], a[144:151], v3
  v_cvt_pk_bf16_f32 v40, v40, v42
  v_smfmac_f32_16x16x64_bf16 v[44:47], v[28:31], a[152:159], v3
  ds_write_b32 v101, v40
  v_smfmac_f32_16x16x64_bf16 v[44:47], v[32:35], a[160:167], v3
  v_smfmac_f32_16x16x64_bf16 v[48:51], v[8:11], a[168:175], v3
  v_smfmac_f32_16x16x64_bf16 v[48:51], v[12:15], a[176:183], v3
  v_smfmac_f32_16x16x64_bf16 v[48:51], v[16:19], a[184:191], v3
  v_add_f32 v44, v44, v45
  v_smfmac_f32_16x16x64_bf16 v[48:51], v[20:23], a[192:199], v3
  v_add_f32 v46, v46, v47
  v_smfmac_f32_16x16x64_bf16 v[48:51], v[24:27], a[200:207], v3
  v_cvt_pk_bf16_f32 v44, v44, v46
  v_smfmac_f32_16x16x64_bf16 v[48:51], v[28:31], a[208:215], v3
  ds_write_b32 v102, v44
  v_smfmac_f32_16x16x64_bf16 v[48:51], v[32:35], a[216:223], v3
  v_smfmac_f32_16x16x64_bf16 v[52:55], v[8:11], a[224:231], v3
  v_smfmac_f32_16x16x64_bf16 v[52:55], v[12:15], a[232:239], v3
  v_smfmac_f32_16x16x64_bf16 v[52:55], v[16:19], a[240:247], v3
  v_add_f32 v48, v48, v49
  v_smfmac_f32_16x16x64_bf16 v[52:55], v[20:23], a[248:255], v3
  v_add_f32 v50, v50, v51
  v_smfmac_f32_16x16x64_bf16 v[52:55], v[24:27], v[120:127], v3
  v_cvt_pk_bf16_f32 v48, v48, v50
  v_smfmac_f32_16x16x64_bf16 v[52:55], v[28:31], v[128:135], v3
  ds_write_b32 v103, v48
  v_smfmac_f32_16x16x64_bf16 v[52:55], v[32:35], v[136:143], v3
  v_smfmac_f32_16x16x64_bf16 v[56:59], v[8:11], v[144:151], v3
  v_smfmac_f32_16x16x64_bf16 v[56:59], v[12:15], v[152:159], v3
  v_smfmac_f32_16x16x64_bf16 v[56:59], v[16:19], v[160:167], v3
  v_add_f32 v52, v52, v53
  v_smfmac_f32_16x16x64_bf16 v[56:59], v[20:23], v[168:175], v3
  v_add_f32 v54, v54, v55
  v_smfmac_f32_16x16x64_bf16 v[56:59], v[24:27], v[176:183], v3
  v_cvt_pk_bf16_f32 v52, v52, v54
  v_smfmac_f32_16x16x64_bf16 v[56:59], v[28:31], v[184:191], v3
  ds_write_b32 v104, v52
  v_smfmac_f32_16x16x64_bf16 v[56:59], v[32:35], v[192:199], v3
  s_nop 7
  v_add_f32 v56, v56, v57
  v_add_f32 v58, v58, v59
  v_cvt_pk_bf16_f32 v56, v56, v58
  ds_write_b32 v105, v56
  s_waitcnt lgkmcnt(0)
  s_barrier
  s_cmp_eq_u32 s19, 62
  s_cbranch_scc1 cA_done
  s_waitcnt vmcnt(0) lgkmcnt(0)
  s_add_u32 s19, s19, 1
  s_mov_b32 s20, s21
  s_branch cA_va2_loop
cA_va2_retry:
  s_waitcnt lgkmcnt(0)
  buffer_load_dwordx4 v[8:11], v2, s[8:11], s20 offen offset:0 sc1
  buffer_load_dwordx4 v[12:15], v2, s[8:11], s20 offen offset:1024 sc1
  buffer_load_dwordx4 v[16:19], v2, s[8:11], s20 offen offset:2048 sc1
  buffer_load_dwordx4 v[20:23], v2, s[8:11], s20 offen offset:3072 sc1
  s_add_u32 s31, s31, 1
  s_add_u32 s30, s30, 1
  s_cmp_lt_u32 s30, 400000
  s_cbranch_scc1 cA_va2_ld
  s_branch cA_abort
cA_va2_last:
  s_waitcnt lgkmcnt(0)
  buffer_store_dwordx4 v[100:103], v2, s[8:11], s24 offen offset:0 sc1
  buffer_store_dwordx4 v[104:107], v2, s[8:11], s24 offen offset:1024 sc1
  buffer_store_dwordx4 v[108:111], v2, s[8:11], s24 offen offset:2048 sc1
  buffer_store_dwordx4 v[4:7], v2, s[8:11], s24 offen offset:3072 sc1
  s_add_u32 s24, s24, 8192
  s_waitcnt vmcnt(0)
  s_mov_b64 exec, 1
  buffer_store_dword v117, v2, s[8:11], s34 offen sc1
  s_mov_b64 exec, -1
  s_add_u32 s34, s34, 8
  s_mov_b64 exec, 1
  buffer_store_dword v117, v2, s[8:11], s34 offen sc1
  s_mov_b64 exec, -1
  s_add_u32 s34, s34, 8
  s_branch cA_done
.p2align 6

cA_va3_loop:
  s_add_u32 s23, s20, 4096
  s_add_u32 s21, s20, 20480
  v_mov_b32 v36, 0
  v_mov_b32 v37, 0
  v_mov_b32 v38, 0
  v_mov_b32 v39, 0
  v_mov_b32 v40, 0
  v_mov_b32 v41, 0
  v_mov_b32 v42, 0
  v_mov_b32 v43, 0
  v_mov_b32 v44, 0
  v_mov_b32 v45, 0
  v_mov_b32 v46, 0
  v_mov_b32 v47, 0
  v_mov_b32 v48, 0
  v_mov_b32 v49, 0
  v_mov_b32 v50, 0
  v_mov_b32 v51, 0
  v_mov_b32 v52, 0
  v_mov_b32 v53, 0
  v_mov_b32 v54, 0
  v_mov_b32 v55, 0
  v_mov_b32 v56, 0
  v_mov_b32 v57, 0
  v_mov_b32 v58, 0
  v_mov_b32 v59, 0
  v_mov_b32 v60, 0
  v_mov_b32 v61, 0
  v_mov_b32 v62, 0
  v_mov_b32 v63, 0
  v_mov_b32 v64, 0
  v_mov_b32 v65, 0
  v_mov_b32 v66, 0
  v_mov_b32 v67, 0
  s_mov_b32 s30, 0
  buffer_load_dword v76, v119, s[8:11], s20 offen sc1
  buffer_load_dword v77, v119, s[8:11], s20 offen sc1
  buffer_load_dword v78, v119, s[8:11], s20 offen sc1
cA_va3_fp_l:
  s_waitcnt vmcnt(2)
  v_cmp_eq_u32 vcc, -1, v76
  s_cbranch_vccz cA_va3_fp_d
  buffer_load_dword v76, v119, s[8:11], s20 offen sc1
  s_waitcnt vmcnt(2)
  v_cmp_eq_u32 vcc, -1, v77
  s_cbranch_vccz cA_va3_fp_d
  buffer_load_dword v77, v119, s[8:11], s20 offen sc1
  s_waitcnt vmcnt(2)
  v_cmp_eq_u32 vcc, -1, v78
  s_cbranch_vccz cA_va3_fp_d
  buffer_load_dword v78, v119, s[8:11], s20 offen sc1
  s_add_u32 s30, s30, 1
  s_cmp_lt_u32 s30, 400000
  s_cbranch_scc1 cA_va3_fp_l
  s_branch cA_abort
cA_va3_fp_d:
  buffer_load_dwordx4 v[24:27], v2, s[8:11], s23 offen offset:0 sc1
  buffer_load_dwordx4 v[28:31], v2, s[8:11], s23 offen offset:1024 sc1
  buffer_load_dwordx4 v[32:35], v2, s[8:11], s23 offen offset:2048 sc1
  s_barrier
cA_va3_ld:
  s_waitcnt vmcnt(0)
  v_max3_u32 v84, v24, v25, v26
  v_max3_u32 v84, v84, v27, v28
  v_max3_u32 v84, v84, v29, v30
  v_max3_u32 v84, v84, v31, v32
  v_max3_u32 v84, v84, v33, v34
  v_max_u32 v84, v84, v35
  v_cmp_eq_u32 vcc, -1, v84
  ds_write_b128 v2, v[24:27] offset:12288
  ds_write_b128 v2, v[28:31] offset:13312
  ds_write_b128 v2, v[32:35] offset:14336
  s_cbranch_vccnz cA_va3_retry
  s_waitcnt lgkmcnt(0)
  s_barrier
  ds_read_b128 v[8:11], v5 offset:8192
  ds_read_b128 v[12:15], v5 offset:9216
  ds_read_b128 v[16:19], v5 offset:10240
  ds_read_b128 v[20:23], v5 offset:11264
  ds_read_b128 v[24:27], v5 offset:12288
  ds_read_b128 v[28:31], v5 offset:13312
  ds_read_b128 v[32:35], v5 offset:14336
  s_waitcnt lgkmcnt(0)
  s_cmp_eq_u32 s19, 63
  s_cbranch_scc1 cA_done
  ds_read_b128 v[76:79], v1 offset:0
  ds_read_b128 v[80:83], v1 offset:1024
  ds_read_b128 v[84:87], v1 offset:2048
  ds_read_b128 v[88:91], v1 offset:3072
  ds_read_b128 v[92:95], v1 offset:4096
  ds_read_b128 v[96:99], v1 offset:5120
  v_smfmac_f32_16x16x64_bf16 v[60:63], v[8:11], v[200:207], v3
  v_smfmac_f32_16x16x64_bf16 v[60:63], v[12:15], v[208:215], v3
  s_waitcnt lgkmcnt(4)
  v_smfmac_f32_16x16x64_bf16 v[64:67], v[8:11], v[76:83], v3
  ds_read_b128 v[76:79], v1 offset:6144
  ds_read_b128 v[80:83], v1 offset:7168
  v_smfmac_f32_16x16x64_bf16 v[60:63], v[16:19], v[216:223], v3
  v_smfmac_f32_16x16x64_bf16 v[60:63], v[20:23], v[224:231], v3
  s_waitcnt lgkmcnt(4)
  v_smfmac_f32_16x16x64_bf16 v[64:67], v[12:15], v[84:91], v3
  ds_read_b128 v[84:87], v1 offset:8192
  ds_read_b128 v[88:91], v1 offset:9216
  v_smfmac_f32_16x16x64_bf16 v[60:63], v[24:27], v[232:239], v3
  v_smfmac_f32_16x16x64_bf16 v[60:63], v[28:31], v[240:247], v3
  s_waitcnt lgkmcnt(4)
  v_smfmac_f32_16x16x64_bf16 v[64:67], v[16:19], v[92:99], v3
  ds_read_b128 v[92:95], v1 offset:10240
  ds_read_b128 v[96:99], v1 offset:11264
  v_smfmac_f32_16x16x64_bf16 v[60:63], v[32:35], v[248:255], v3
  v_smfmac_f32_16x16x64_bf16 v[36:39], v[8:11], a[0:7], v3
  s_waitcnt lgkmcnt(4)
  v_smfmac_f32_16x16x64_bf16 v[64:67], v[20:23], v[76:83], v3
  ds_read_b128 v[76:79], v1 offset:12288
  ds_read_b128 v[80:83], v1 offset:13312
  v_smfmac_f32_16x16x64_bf16 v[36:39], v[12:15], a[8:15], v3
  v_add_f32 v60, v60, v61
  v_smfmac_f32_16x16x64_bf16 v[36:39], v[16:19], a[16:23], v3
  v_add_f32 v62, v62, v63
  s_waitcnt lgkmcnt(4)
  v_smfmac_f32_16x16x64_bf16 v[64:67], v[24:27], v[84:91], v3
  v_cvt_pk_bf16_f32 v60, v60, v62
  v_smfmac_f32_16x16x64_bf16 v[36:39], v[20:23], a[24:31], v3
  ds_write_b32 v106, v60
  v_smfmac_f32_16x16x64_bf16 v[36:39], v[24:27], a[32:39], v3
  s_waitcnt lgkmcnt(2)
  v_smfmac_f32_16x16x64_bf16 v[64:67], v[28:31], v[92:99], v3
  v_smfmac_f32_16x16x64_bf16 v[36:39], v[28:31], a[40:47], v3
  v_smfmac_f32_16x16x64_bf16 v[36:39], v[32:35], a[48:55], v3
  s_waitcnt lgkmcnt(0)
  v_smfmac_f32_16x16x64_bf16 v[64:67], v[32:35], v[76:83], v3
  v_smfmac_f32_16x16x64_bf16 v[40:43], v[8:11], a[56:63], v3
  v_smfmac_f32_16x16x64_bf16 v[40:43], v[12:15], a[64:71], v3
  v_add_f32 v36, v36, v37
  v_smfmac_f32_16x16x64_bf16 v[40:43], v[16:19], a[72:79], v3
  v_add_f32 v38, v38, v39
  v_smfmac_f32_16x16x64_bf16 v[40:43], v[20:23], a[80:87], v3
  v_cvt_pk_bf16_f32 v36, v36, v38
  v_smfmac_f32_16x16x64_bf16 v[40:43], v[24:27], a[88:95], v3
  ds_write_b32 v100, v36
  v_smfmac_f32_16x16x64_bf16 v[40:43], v[28:31], a[96:103], v3
  v_add_f32 v64, v64, v65
  v_smfmac_f32_16x16x64_bf16 v[40:43], v[32:35], a[104:111], v3
  v_add_f32 v66, v66, v67
  v_smfmac_f32_16x16x64_bf16 v[44:47], v[8:11], a[112:119], v3
  v_cvt_pk_bf16_f32 v64, v64, v66
  v_smfmac_f32_16x16x64_bf16 v[44:47], v[12:15], a[120:127], v3
  ds_write_b32 v107, v64
  v_smfmac_f32_16x16x64_bf16 v[44:47], v[16:19], a[128:135], v3
  v_add_f32 v40, v40, v41
  v_smfmac_f32_16x16x64_bf16 v[44:47], v[20:23], a[136:143], v3
  v_add_f32 v42, v42, v43
  v_smfmac_f32_16x16x64_bf16 v[44:47], v[24:27], a[144:151], v3
  v_cvt_pk_bf16_f32 v40, v40, v42
  v_smfmac_f32_16x16x64_bf16 v[44:47], v[28:31], a[152:159], v3
  ds_write_b32 v101, v40
  v_smfmac_f32_16x16x64_bf16 v[44:47], v[32:35], a[160:167], v3
  v_smfmac_f32_16x16x64_bf16 v[48:51], v[8:11], a[168:175], v3
  v_smfmac_f32_16x16x64_bf16 v[48:51], v[12:15], a[176:183], v3
  v_smfmac_f32_16x16x64_bf16 v[48:51], v[16:19], a[184:191], v3
  v_add_f32 v44, v44, v45
  v_smfmac_f32_16x16x64_bf16 v[48:51], v[20:23], a[192:199], v3
  v_add_f32 v46, v46, v47
  v_smfmac_f32_16x16x64_bf16 v[48:51], v[24:27], a[200:207], v3
  v_cvt_pk_bf16_f32 v44, v44, v46
  v_smfmac_f32_16x16x64_bf16 v[48:51], v[28:31], a[208:215], v3
  ds_write_b32 v102, v44
  v_smfmac_f32_16x16x64_bf16 v[48:51], v[32:35], a[216:223], v3
  v_smfmac_f32_16x16x64_bf16 v[52:55], v[8:11], a[224:231], v3
  v_smfmac_f32_16x16x64_bf16 v[52:55], v[12:15], a[232:239], v3
  v_smfmac_f32_16x16x64_bf16 v[52:55], v[16:19], a[240:247], v3
  v_add_f32 v48, v48, v49
  v_smfmac_f32_16x16x64_bf16 v[52:55], v[20:23], a[248:255], v3
  v_add_f32 v50, v50, v51
  v_smfmac_f32_16x16x64_bf16 v[52:55], v[24:27], v[120:127], v3
  v_cvt_pk_bf16_f32 v48, v48, v50
  v_smfmac_f32_16x16x64_bf16 v[52:55], v[28:31], v[128:135], v3
  ds_write_b32 v103, v48
  v_smfmac_f32_16x16x64_bf16 v[52:55], v[32:35], v[136:143], v3
  v_smfmac_f32_16x16x64_bf16 v[56:59], v[8:11], v[144:151], v3
  v_smfmac_f32_16x16x64_bf16 v[56:59], v[12:15], v[152:159], v3
  v_smfmac_f32_16x16x64_bf16 v[56:59], v[16:19], v[160:167], v3
  v_add_f32 v52, v52, v53
  v_smfmac_f32_16x16x64_bf16 v[56:59], v[20:23], v[168:175], v3
  v_add_f32 v54, v54, v55
  v_smfmac_f32_16x16x64_bf16 v[56:59], v[24:27], v[176:183], v3
  v_cvt_pk_bf16_f32 v52, v52, v54
  v_smfmac_f32_16x16x64_bf16 v[56:59], v[28:31], v[184:191], v3
  ds_write_b32 v104, v52
  v_smfmac_f32_16x16x64_bf16 v[56:59], v[32:35], v[192:199], v3
  s_nop 7
  v_add_f32 v56, v56, v57
  v_add_f32 v58, v58, v59
  v_cvt_pk_bf16_f32 v56, v56, v58
  ds_write_b32 v105, v56
  s_waitcnt lgkmcnt(0)
  s_barrier
  s_cmp_eq_u32 s19, 62
  s_cbranch_scc1 cA_done
  s_waitcnt vmcnt(0) lgkmcnt(0)
  s_add_u32 s19, s19, 1
  s_mov_b32 s20, s21
  s_branch cA_va3_loop
cA_va3_retry:
  s_waitcnt lgkmcnt(0)
  buffer_load_dwordx4 v[24:27], v2, s[8:11], s23 offen offset:0 sc1
  buffer_load_dwordx4 v[28:31], v2, s[8:11], s23 offen offset:1024 sc1
  buffer_load_dwordx4 v[32:35], v2, s[8:11], s23 offen offset:2048 sc1
  s_add_u32 s31, s31, 1
  s_add_u32 s30, s30, 1
  s_cmp_lt_u32 s30, 400000
  s_cbranch_scc1 cA_va3_ld
  s_branch cA_abort
cA_va3_last:
  s_waitcnt lgkmcnt(0)
  buffer_store_dwordx4 v[100:103], v2, s[8:11], s24 offen offset:0 sc1
  buffer_store_dwordx4 v[104:107], v2, s[8:11], s24 offen offset:1024 sc1
  buffer_store_dwordx4 v[108:111], v2, s[8:11], s24 offen offset:2048 sc1
  buffer_store_dwordx4 v[4:7], v2, s[8:11], s24 offen offset:3072 sc1
  s_add_u32 s24, s24, 8192
  s_waitcnt vmcnt(0)
  s_mov_b64 exec, 1
  buffer_store_dword v117, v2, s[8:11], s34 offen sc1
  s_mov_b64 exec, -1
  s_add_u32 s34, s34, 8
  s_mov_b64 exec, 1
  buffer_store_dword v117, v2, s[8:11], s34 offen sc1
  s_mov_b64 exec, -1
  s_add_u32 s34, s34, 8
  s_branch cA_done
cA_abort:
  v_mov_b32 v4, 0xdead
  v_mov_b32 v5, 16
  buffer_store_dword v4, v5, s[12:15], 0 offen
  s_branch ch_end
cA_done:
  s_branch ch_end
.p2align 6

cB_sc0_loop:
  s_add_u32 s23, s20, 4096
  s_add_u32 s21, s20, 20480
  v_mov_b32 v48, 0
  v_mov_b32 v49, 0
  v_mov_b32 v50, 0
  v_mov_b32 v51, 0
  v_mov_b32 v52, 0
  v_mov_b32 v53, 0
  v_mov_b32 v54, 0
  v_mov_b32 v55, 0
  v_mov_b32 v56, 0
  v_mov_b32 v57, 0
  v_mov_b32 v58, 0
  v_mov_b32 v59, 0
  v_mov_b32 v60, 0
  v_mov_b32 v61, 0
  v_mov_b32 v62, 0
  v_mov_b32 v63, 0
  v_mov_b32 v88, 0
  v_mov_b32 v89, 0
  v_mov_b32 v90, 0
  v_mov_b32 v91, 0
  v_mov_b32 v92, 0
  v_mov_b32 v93, 0
  v_mov_b32 v94, 0
  v_mov_b32 v95, 0
  v_mov_b32 v66, 0
  v_mov_b32 v67, 0
  s_mov_b32 s30, 0
  s_mov_b32 s62, 0
  buffer_load_dword v68, v0, s[8:11], s20 offen sc1
  s_nop 7
  buffer_load_dword v69, v0, s[8:11], s20 offen sc1
  s_nop 7
  buffer_load_dword v70, v0, s[8:11], s20 offen sc1
  s_nop 7
  buffer_load_dword v71, v0, s[8:11], s20 offen sc1
  s_nop 7
  buffer_load_dword v72, v0, s[8:11], s20 offen sc1
cB_sc0_fp_l:
  s_waitcnt vmcnt(4)
  v_cmp_eq_u32 vcc, -1, v68
  s_cbranch_vccz cB_sc0_fp_d
  buffer_load_dword v68, v0, s[8:11], s20 offen sc1
  s_waitcnt vmcnt(4)
  v_cmp_eq_u32 vcc, -1, v69
  s_cbranch_vccz cB_sc0_fp_d
  buffer_load_dword v69, v0, s[8:11], s20 offen sc1
  s_waitcnt vmcnt(4)
  v_cmp_eq_u32 vcc, -1, v70
  s_cbranch_vccz cB_sc0_fp_d
  buffer_load_dword v70, v0, s[8:11], s20 offen sc1
  s_waitcnt vmcnt(4)
  v_cmp_eq_u32 vcc, -1, v71
  s_cbranch_vccz cB_sc0_fp_d
  buffer_load_dword v71, v0, s[8:11], s20 offen sc1
  s_waitcnt vmcnt(4)
  v_cmp_eq_u32 vcc, -1, v72
  s_cbranch_vccz cB_sc0_fp_d
  buffer_load_dword v72, v0, s[8:11], s20 offen sc1
  s_add_u32 s30, s30, 1
  s_cmp_lt_u32 s30, 400000
  s_cbranch_scc1 cB_sc0_fp_l
  s_branch cB_abort
cB_sc0_fp_d:
  buffer_load_dwordx4 v[8:11], v2, s[8:11], s20 offen offset:0 sc1
  s_barrier
  s_branch cB_sc0_ld1
cB_sc0_ld:
  buffer_load_dwordx4 v[8:11], v2, s[8:11], s20 offen offset:0 sc1
cB_sc0_ld1:
  v_mov_b32 v36, 0
  v_mov_b32 v37, 0
  v_mov_b32 v38, 0
  v_mov_b32 v39, 0
  buffer_load_dwordx4 v[12:15], v2, s[8:11], s20 offen offset:1024 sc1
  v_mov_b32 v40, 0
  v_mov_b32 v41, 0
  v_mov_b32 v42, 0
  v_mov_b32 v43, 0
  buffer_load_dwordx4 v[16:19], v2, s[8:11], s20 offen offset:2048 sc1
  v_mov_b32 v44, 0
  v_mov_b32 v45, 0
  v_mov_b32 v46, 0
  v_mov_b32 v47, 0
  ds_read_b128 v[96:99], v117 offset:0
  ds_read_b128 v[100:103], v117 offset:1024
  ds_read_b128 v[104:107], v117 offset:14336
  ds_read_b128 v[108:111], v117 offset:15360
  s_waitcnt vmcnt(2)
  v_smfmac_f32_16x16x64_bf16 v[36:39], v[8:11], a[0:7], v3
  v_smfmac_f32_16x16x64_bf16 v[40:43], v[8:11], a[56:63], v3
  buffer_load_dwordx4 v[20:23], v2, s[8:11], s20 offen offset:3072 sc1
  v_smfmac_f32_16x16x64_bf16 v[44:47], v[8:11], a[112:119], v3
  v_smfmac_f32_16x16x64_bf16 v[48:51], v[8:11], a[168:175], v3
  v_smfmac_f32_16x16x64_bf16 v[52:55], v[8:11], a[224:231], v3
  buffer_load_dwordx4 v[24:27], v2, s[8:11], s23 offen offset:0 sc1
  v_smfmac_f32_16x16x64_bf16 v[56:59], v[8:11], v[144:151], v3
  v_smfmac_f32_16x16x64_bf16 v[60:63], v[8:11], v[200:207], v3
  s_waitcnt vmcnt(3)
  v_smfmac_f32_16x16x64_bf16 v[36:39], v[12:15], a[8:15], v3
  v_smfmac_f32_16x16x64_bf16 v[40:43], v[12:15], a[64:71], v3
  buffer_load_dwordx4 v[28:31], v2, s[8:11], s23 offen offset:1024 sc1
  v_smfmac_f32_16x16x64_bf16 v[44:47], v[12:15], a[120:127], v3
  v_smfmac_f32_16x16x64_bf16 v[48:51], v[12:15], a[176:183], v3
  v_smfmac_f32_16x16x64_bf16 v[52:55], v[12:15], a[232:239], v3
  buffer_load_dwordx4 v[32:35], v2, s[8:11], s23 offen offset:2048 sc1
  v_smfmac_f32_16x16x64_bf16 v[56:59], v[12:15], v[152:159], v3
  v_smfmac_f32_16x16x64_bf16 v[60:63], v[12:15], v[208:215], v3
  s_xor_b32 s58, s25, 28672
  s_add_u32 s59, s24, 28672
  s_add_u32 m0, s58, 0
  s_waitcnt vmcnt(4)
  v_smfmac_f32_16x16x64_bf16 v[36:39], v[16:19], a[16:23], v3
  buffer_load_dwordx4 v2, s[8:11], s59 offen offset:0 sc1 lds
  v_smfmac_f32_16x16x64_bf16 v[40:43], v[16:19], a[72:79], v3
  v_smfmac_f32_16x16x64_bf16 v[44:47], v[16:19], a[128:135], v3
  v_smfmac_f32_16x16x64_bf16 v[48:51], v[16:19], a[184:191], v3
  v_smfmac_f32_16x16x64_bf16 v[52:55], v[16:19], a[240:247], v3
  buffer_load_dwordx4 v2, s[8:11], s59 offen offset:1024 sc1 lds
  v_smfmac_f32_16x16x64_bf16 v[56:59], v[16:19], v[160:167], v3
  v_smfmac_f32_16x16x64_bf16 v[60:63], v[16:19], v[216:223], v3
  s_waitcnt vmcnt(5)
  v_smfmac_f32_16x16x64_bf16 v[36:39], v[20:23], a[24:31], v3
  v_smfmac_f32_16x16x64_bf16 v[40:43], v[20:23], a[80:87], v3
  buffer_load_dwordx4 v2, s[8:11], s59 offen offset:2048 sc1 lds
  v_smfmac_f32_16x16x64_bf16 v[44:47], v[20:23], a[136:143], v3
  v_smfmac_f32_16x16x64_bf16 v[48:51], v[20:23], a[192:199], v3
  v_smfmac_f32_16x16x64_bf16 v[52:55], v[20:23], a[248:255], v3
  v_smfmac_f32_16x16x64_bf16 v[56:59], v[20:23], v[168:175], v3
  buffer_load_dwordx4 v2, s[8:11], s59 offen offset:3072 sc1 lds
  v_smfmac_f32_16x16x64_bf16 v[60:63], v[20:23], v[224:231], v3
  s_waitcnt vmcnt(4)
cB_sc0_ph2:
  v_smfmac_f32_16x16x64_bf16 v[60:63], v[24:27], v[232:239], v3
  ds_read_b128 v[12:15], v116 offset:0
  ds_read_b128 v[16:19], v116 offset:1024
  v_smfmac_f32_16x16x64_bf16 v[60:63], v[28:31], v[240:247], v3
  v_smfmac_f32_16x16x64_bf16 v[60:63], v[32:35], v[248:255], v3
  v_mov_b32 v80, v24
  v_smfmac_f32_16x16x64_bf16 v[52:55], v[24:27], v[120:127], v3
  v_mov_b32 v81, v25
  v_smfmac_f32_16x16x64_bf16 v[52:55], v[28:31], v[128:135], v3
  v_mov_b32 v82, v32
  v_smfmac_f32_16x16x64_bf16 v[52:55], v[32:35], v[136:143], v3
  v_cvt_pk_bf16_f32 v64, v60, v61
  v_smfmac_f32_16x16x64_bf16 v[56:59], v[24:27], v[176:183], v3
  v_cvt_pk_bf16_f32 v65, v62, v63
  v_smfmac_f32_16x16x64_bf16 v[56:59], v[28:31], v[184:191], v3
  v_mov_b32 v83, v33
  v_mfma_f32_16x16x32_bf16 v[68:71], v[64:67], v[4:7], 0
  v_smfmac_f32_16x16x64_bf16 v[56:59], v[32:35], v[192:199], v3
  v_cvt_pk_bf16_f32 v64, v52, v53
  v_smfmac_f32_16x16x64_bf16 v[36:39], v[24:27], a[32:39], v3
  v_cvt_pk_bf16_f32 v65, v54, v55
  v_smfmac_f32_16x16x64_bf16 v[36:39], v[28:31], a[40:47], v3
  v_cvt_pk_bf16_f32 v78, v68, v69
  v_smfmac_f32_16x16x64_bf16 v[36:39], v[32:35], a[48:55], v3
  v_cvt_pk_bf16_f32 v79, v70, v71
  v_cvt_pk_bf16_f32 v66, v56, v57
  v_smfmac_f32_16x16x64_bf16 v[40:43], v[24:27], a[88:95], v3
  v_cvt_pk_bf16_f32 v67, v58, v59
  v_smfmac_f32_16x16x64_bf16 v[40:43], v[28:31], a[96:103], v3
  v_mfma_f32_16x16x32_bf16 v[72:75], v[64:67], v[4:7], 0
  ds_read_b128 v[52:55], v116 offset:14336
  ds_read_b128 v[56:59], v116 offset:15360
  v_smfmac_f32_16x16x64_bf16 v[40:43], v[32:35], a[104:111], v3
  v_cvt_pk_bf16_f32 v64, v36, v37
  v_smfmac_f32_16x16x64_bf16 v[44:47], v[24:27], a[144:151], v3
  v_cvt_pk_bf16_f32 v65, v38, v39
  v_smfmac_f32_16x16x64_bf16 v[44:47], v[28:31], a[152:159], v3
  v_cvt_pk_bf16_f32 v76, v72, v73
  v_smfmac_f32_16x16x64_bf16 v[44:47], v[32:35], a[160:167], v3
  v_cvt_pk_bf16_f32 v77, v74, v75
  v_cvt_pk_bf16_f32 v66, v40, v41
  v_smfmac_f32_16x16x64_bf16 v[48:51], v[24:27], a[200:207], v3
  v_cvt_pk_bf16_f32 v67, v42, v43
  v_smfmac_f32_16x16x64_bf16 v[48:51], v[28:31], a[208:215], v3
  v_mfma_f32_16x16x32_bf16 v[68:71], v[64:67], v[4:7], 0
  v_smfmac_f32_16x16x64_bf16 v[48:51], v[32:35], a[216:223], v3
  v_cvt_pk_bf16_f32 v64, v44, v45
  v_mfma_f32_16x16x32_bf16 v[84:87], v[80:83], v[76:79], 0
  v_cvt_pk_bf16_f32 v65, v46, v47
  s_waitcnt lgkmcnt(0)
  v_smfmac_f32_16x16x64_bf16 v[88:91], v[76:79], v[96:103], v118
  v_cvt_pk_bf16_f32 v60, v68, v69
  v_cvt_pk_bf16_f32 v61, v70, v71
  v_cvt_pk_bf16_f32 v66, v48, v49
  v_cvt_pk_bf16_f32 v67, v50, v51
  s_nop 1
  v_mfma_f32_16x16x32_bf16 v[72:75], v[64:67], v[4:7], 0
  v_smfmac_f32_16x16x64_bf16 v[92:95], v[76:79], v[104:111], v118
  s_nop 4
  v_cvt_pk_bf16_f32 v62, v72, v73
  v_cvt_pk_bf16_f32 v63, v74, v75
  s_nop 1
  v_mfma_f32_16x16x32_bf16 v[84:87], v[8:11], v[60:63], v[84:87]
  v_smfmac_f32_16x16x64_bf16 v[88:91], v[60:63], v[12:19], v118
  v_smfmac_f32_16x16x64_bf16 v[92:95], v[60:63], v[52:59], v118
  s_nop 1
  v_permlane32_swap_b32 v84, v86
  v_permlane32_swap_b32 v85, v87
  s_nop 0
  v_add_f32 v88, v88, v89
  v_add_f32_dpp v84, v86, v84 quad_perm:[1,0,3,2] row_mask:0xf bank_mask:0xf
  v_add_f32_dpp v85, v87, v85 quad_perm:[1,0,3,2] row_mask:0xf bank_mask:0xf
  v_add_f32 v89, v90, v91
  ds_write2_b32 v113, v84, v85 offset0:0 offset1:4
  ds_write2_b32 v112, v88, v89 offset0:0 offset1:128
  v_add_f32 v90, v92, v93
  v_add_f32 v91, v94, v95
  ds_write2_b32 v112, v90, v91 offset0:64 offset1:192
  v_cmp_u_f32 vcc, v88, v89
  s_cbranch_vccnz cB_sc0_retry
cB_sc0_cont:
  s_waitcnt lgkmcnt(0)
  s_barrier
  ds_read_b128 v[36:39], v114
  ds_read_b128 v[44:47], v115
  s_waitcnt lgkmcnt(0)
  v_add_f32 v36, v36, v38
  v_add_f32 v37, v37, v39
  v_add_f32 v44, v44, v45
  v_add_f32 v46, v46, v47
  v_add_f32 v44, v44, v46
  v_add_f32 v36, v36, v37
  v_exp_f32 v49, v44
  v_exp_f32 v48, v36
  v_add_f32 v50, abs(v36), abs(v44)
  v_fma_f32 v39, v49, s37, v48
  v_cmp_ngt_f32 vcc, s56, v50
  v_cndmask_b32 v41, v48, v49, s[38:39]
  v_add_f32_dpp v39, v39, v39 quad_perm:[1,0,3,2] row_mask:0xf bank_mask:0xf
  v_cndmask_b32 v40, v49, v48, s[38:39]
  v_mov_b32_dpp v46, v41 quad_perm:[1,0,3,2] row_mask:0xf bank_mask:0xf
  v_add_f32_dpp v39, v39, v39 quad_perm:[2,3,0,1] row_mask:0xf bank_mask:0xf
  v_cndmask_b32 v42, v46, v40, s[38:39]
  v_cndmask_b32 v43, v40, v46, s[38:39]
  v_add_f32_dpp v39, v39, v39 row_half_mirror row_mask:0xf bank_mask:0xf
  s_cbranch_vccnz cB_sc0_slow
  s_nop 0
  v_add_f32_dpp v47, v39, v39 row_mirror row_mask:0xf bank_mask:0xf
  v_add_f32_dpp v39, v39, v39 row_mirror row_mask:0xf bank_mask:0xf
  s_nop 1
  v_permlane16_swap_b32 v39, v47
  v_add_f32 v39, v39, v47
  v_rcp_f32 v39, v39
  s_mov_b64 exec, s[28:29]
  v_mul_f32 v42, v42, v39
  v_mul_f32 v43, v43, v39
  v_cvt_pk_bf16_f32 v42, v42, v43
cB_sc0_pst:
  buffer_store_dword v42, v1, s[8:11], s20 offen sc1
  s_mov_b64 exec, -1
  s_barrier
  s_add_u32 s24, s24, 28672
  s_add_u32 s35, s35, 28672
  s_xor_b32 s25, s25, 28672
  s_add_u32 m0, s25, 0
  s_add_u32 m0, s25, 4096
  s_add_u32 s22, s24, 4096
  buffer_load_dwordx4 v2, s[8:11], s22 offen offset:0 sc1 lds
  s_nop 5
  buffer_load_dwordx4 v2, s[8:11], s22 offen offset:1024 sc1 lds
  s_nop 5
  buffer_load_dwordx4 v2, s[8:11], s22 offen offset:2048 sc1 lds
  s_nop 5
  v_xor_b32 v116, 28672, v116
  v_add_u32 v117, s57, v117
  s_sub_u32 s57, 0, s57
  s_add_u32 s19, s19, 1
  s_mov_b32 s20, s21
  s_cmp_lt_u32 s19, 63
  s_cbranch_scc1 cB_sc0_loop
  s_branch cB_done
cB_sc0_slow:
  v_max_f32 v50, v36, v44
  s_nop 1
  v_max_f32_dpp v50, v50, v50 quad_perm:[1,0,3,2] row_mask:0xf bank_mask:0xf
  s_nop 1
  v_max_f32_dpp v50, v50, v50 quad_perm:[2,3,0,1] row_mask:0xf bank_mask:0xf
  s_nop 1
  v_max_f32_dpp v50, v50, v50 row_half_mirror row_mask:0xf bank_mask:0xf
  s_nop 1
  v_max_f32_dpp v50, v50, v50 row_mirror row_mask:0xf bank_mask:0xf
  v_mov_b32 v47, v50
  s_nop 1
  v_permlane16_swap_b32 v50, v47
  v_max_f32 v50, v50, v47
  v_sub_f32 v48, v36, v50
  v_sub_f32 v49, v44, v50
  v_exp_f32 v48, v48
  v_exp_f32 v49, v49
  s_add_u32 s31, s31, 0x100
  v_fma_f32 v39, v49, s37, v48
  v_cndmask_b32 v41, v48, v49, s[38:39]
  s_nop 0
  v_add_f32_dpp v39, v39, v39 quad_perm:[1,0,3,2] row_mask:0xf bank_mask:0xf
  v_cndmask_b32 v40, v49, v48, s[38:39]
  v_mov_b32_dpp v46, v41 quad_perm:[1,0,3,2] row_mask:0xf bank_mask:0xf
  v_add_f32_dpp v39, v39, v39 quad_perm:[2,3,0,1] row_mask:0xf bank_mask:0xf
  v_cndmask_b32 v42, v46, v40, s[38:39]
  v_cndmask_b32 v43, v40, v46, s[38:39]
  v_add_f32_dpp v39, v39, v39 row_half_mirror row_mask:0xf bank_mask:0xf
  s_nop 1
  v_add_f32_dpp v47, v39, v39 row_mirror row_mask:0xf bank_mask:0xf
  v_add_f32_dpp v39, v39, v39 row_mirror row_mask:0xf bank_mask:0xf
  s_nop 1
  v_permlane16_swap_b32 v39, v47
  v_add_f32 v39, v39, v47
  v_rcp_f32 v39, v39
  s_mov_b64 exec, s[28:29]
  v_mul_f32 v42, v42, v39
  v_mul_f32 v43, v43, v39
  v_cvt_pk_bf16_f32 v42, v42, v43
  v_min_u32 v42, -2, v42
  s_branch cB_sc0_pst
cB_sc0_retry:
  s_cmp_lg_u32 s62, 0
  s_cbranch_scc1 cB_sc0_cont
  s_waitcnt vmcnt(0) lgkmcnt(0)
cB_sc0_rv:
  buffer_load_dwordx4 v[8:11], v2, s[8:11], s20 offen offset:0 sc1
  buffer_load_dwordx4 v[12:15], v2, s[8:11], s20 offen offset:1024 sc1
  buffer_load_dwordx4 v[16:19], v2, s[8:11], s20 offen offset:2048 sc1
  buffer_load_dwordx4 v[20:23], v2, s[8:11], s20 offen offset:3072 sc1
  buffer_load_dwordx4 v[24:27], v2, s[8:11], s23 offen offset:0 sc1
  buffer_load_dwordx4 v[28:31], v2, s[8:11], s23 offen offset:1024 sc1
  buffer_load_dwordx4 v[32:35], v2, s[8:11], s23 offen offset:2048 sc1
  s_waitcnt vmcnt(0)
  v_max3_u32 v68, v8, v9, v10
  v_max3_u32 v68, v68, v11, v12
  v_max3_u32 v68, v68, v13, v14
  v_max3_u32 v68, v68, v15, v16
  v_max3_u32 v68, v68, v17, v18
  v_max3_u32 v68, v68, v19, v20
  v_max3_u32 v68, v68, v21, v22
  v_max3_u32 v68, v68, v23, v24
  v_max3_u32 v68, v68, v25, v26
  v_max3_u32 v68, v68, v27, v28
  v_max3_u32 v68, v68, v29, v30
  v_max3_u32 v68, v68, v31, v32
  v_max3_u32 v68, v68, v33, v34
  v_max_u32 v68, v68, v35
  v_cmp_eq_u32 vcc, -1, v68
  s_cbranch_vccz cB_sc0_rk
  s_add_u32 s30, s30, 1
  s_cmp_lt_u32 s30, 400000
  s_cbranch_scc1 cB_sc0_rv
  s_branch cB_abort
cB_sc0_rk:
  s_mov_b32 s62, 1
  v_mov_b32 v36, 0
  v_mov_b32 v37, 0
  v_mov_b32 v38, 0
  v_mov_b32 v39, 0
  v_mov_b32 v40, 0
  v_mov_b32 v41, 0
  v_mov_b32 v42, 0
  v_mov_b32 v43, 0
  v_mov_b32 v44, 0
  v_mov_b32 v45, 0
  v_mov_b32 v46, 0
  v_mov_b32 v47, 0
  v_mov_b32 v48, 0
  v_mov_b32 v49, 0
  v_mov_b32 v50, 0
  v_mov_b32 v51, 0
  v_mov_b32 v52, 0
  v_mov_b32 v53, 0
  v_mov_b32 v54, 0
  v_mov_b32 v55, 0
  v_mov_b32 v56, 0
  v_mov_b32 v57, 0
  v_mov_b32 v58, 0
  v_mov_b32 v59, 0
  v_mov_b32 v60, 0
  v_mov_b32 v61, 0
  v_mov_b32 v62, 0
  v_mov_b32 v63, 0
  v_mov_b32 v88, 0
  v_mov_b32 v89, 0
  v_mov_b32 v90, 0
  v_mov_b32 v91, 0
  v_mov_b32 v92, 0
  v_mov_b32 v93, 0
  v_mov_b32 v94, 0
  v_mov_b32 v95, 0
  v_mov_b32 v66, 0
  v_mov_b32 v67, 0
  s_add_u32 s31, s31, 1
  ds_read_b128 v[96:99], v117 offset:0
  ds_read_b128 v[100:103], v117 offset:1024
  ds_read_b128 v[104:107], v117 offset:14336
  ds_read_b128 v[108:111], v117 offset:15360
  v_smfmac_f32_16x16x64_bf16 v[36:39], v[8:11], a[0:7], v3
  v_smfmac_f32_16x16x64_bf16 v[40:43], v[8:11], a[56:63], v3
  v_smfmac_f32_16x16x64_bf16 v[44:47], v[8:11], a[112:119], v3
  v_smfmac_f32_16x16x64_bf16 v[48:51], v[8:11], a[168:175], v3
  v_smfmac_f32_16x16x64_bf16 v[52:55], v[8:11], a[224:231], v3
  v_smfmac_f32_16x16x64_bf16 v[56:59], v[8:11], v[144:151], v3
  v_smfmac_f32_16x16x64_bf16 v[60:63], v[8:11], v[200:207], v3
  v_smfmac_f32_16x16x64_bf16 v[36:39], v[12:15], a[8:15], v3
  v_smfmac_f32_16x16x64_bf16 v[40:43], v[12:15], a[64:71], v3
  v_smfmac_f32_16x16x64_bf16 v[44:47], v[12:15], a[120:127], v3
  v_smfmac_f32_16x16x64_bf16 v[48:51], v[12:15], a[176:183], v3
  v_smfmac_f32_16x16x64_bf16 v[52:55], v[12:15], a[232:239], v3
  v_smfmac_f32_16x16x64_bf16 v[56:59], v[12:15], v[152:159], v3
  v_smfmac_f32_16x16x64_bf16 v[60:63], v[12:15], v[208:215], v3
  v_smfmac_f32_16x16x64_bf16 v[36:39], v[16:19], a[16:23], v3
  v_smfmac_f32_16x16x64_bf16 v[40:43], v[16:19], a[72:79], v3
  v_smfmac_f32_16x16x64_bf16 v[44:47], v[16:19], a[128:135], v3
  v_smfmac_f32_16x16x64_bf16 v[48:51], v[16:19], a[184:191], v3
  v_smfmac_f32_16x16x64_bf16 v[52:55], v[16:19], a[240:247], v3
  v_smfmac_f32_16x16x64_bf16 v[56:59], v[16:19], v[160:167], v3
  v_smfmac_f32_16x16x64_bf16 v[60:63], v[16:19], v[216:223], v3
  v_smfmac_f32_16x16x64_bf16 v[36:39], v[20:23], a[24:31], v3
  v_smfmac_f32_16x16x64_bf16 v[40:43], v[20:23], a[80:87], v3
  v_smfmac_f32_16x16x64_bf16 v[44:47], v[20:23], a[136:143], v3
  v_smfmac_f32_16x16x64_bf16 v[48:51], v[20:23], a[192:199], v3
  v_smfmac_f32_16x16x64_bf16 v[52:55], v[20:23], a[248:255], v3
  v_smfmac_f32_16x16x64_bf16 v[56:59], v[20:23], v[168:175], v3
  v_smfmac_f32_16x16x64_bf16 v[60:63], v[20:23], v[224:231], v3
  s_xor_b32 s58, s25, 28672
  s_add_u32 s59, s24, 28672
  s_add_u32 m0, s58, 0
  s_branch cB_sc0_ph2
.p2align 6

cB_sc1_loop:
  s_add_u32 s23, s20, 4096
  s_add_u32 s21, s20, 20480
  v_mov_b32 v48, 0
  v_mov_b32 v49, 0
  v_mov_b32 v50, 0
  v_mov_b32 v51, 0
  v_mov_b32 v52, 0
  v_mov_b32 v53, 0
  v_mov_b32 v54, 0
  v_mov_b32 v55, 0
  v_mov_b32 v56, 0
  v_mov_b32 v57, 0
  v_mov_b32 v58, 0
  v_mov_b32 v59, 0
  v_mov_b32 v60, 0
  v_mov_b32 v61, 0
  v_mov_b32 v62, 0
  v_mov_b32 v63, 0
  v_mov_b32 v88, 0
  v_mov_b32 v89, 0
  v_mov_b32 v90, 0
  v_mov_b32 v91, 0
  v_mov_b32 v92, 0
  v_mov_b32 v93, 0
  v_mov_b32 v94, 0
  v_mov_b32 v95, 0
  v_mov_b32 v64, 0
  v_mov_b32 v65, 0
  s_mov_b32 s30, 0
  s_mov_b32 s62, 0
  s_waitcnt vmcnt(0)
  s_barrier
cB_sc1_ld:
  buffer_load_dwordx4 v[8:11], v2, s[8:11], s20 offen offset:0 sc1
  v_mov_b32 v36, 0
  v_mov_b32 v37, 0
  v_mov_b32 v38, 0
  v_mov_b32 v39, 0
  buffer_load_dwordx4 v[12:15], v2, s[8:11], s20 offen offset:1024 sc1
  v_mov_b32 v40, 0
  v_mov_b32 v41, 0
  v_mov_b32 v42, 0
  v_mov_b32 v43, 0
  buffer_load_dwordx4 v[16:19], v2, s[8:11], s20 offen offset:2048 sc1
  v_mov_b32 v44, 0
  v_mov_b32 v45, 0
  v_mov_b32 v46, 0
  v_mov_b32 v47, 0
  ds_read_b128 v[96:99], v117 offset:0
  ds_read_b128 v[100:103], v117 offset:1024
  ds_read_b128 v[104:107], v117 offset:14336
  ds_read_b128 v[108:111], v117 offset:15360
  s_waitcnt vmcnt(2)
  v_smfmac_f32_16x16x64_bf16 v[36:39], v[8:11], a[0:7], v3
  v_smfmac_f32_16x16x64_bf16 v[40:43], v[8:11], a[56:63], v3
  buffer_load_dwordx4 v[20:23], v2, s[8:11], s20 offen offset:3072 sc1
  v_smfmac_f32_16x16x64_bf16 v[44:47], v[8:11], a[112:119], v3
  v_smfmac_f32_16x16x64_bf16 v[48:51], v[8:11], a[168:175], v3
  v_smfmac_f32_16x16x64_bf16 v[52:55], v[8:11], a[224:231], v3
  buffer_load_dwordx4 v[24:27], v2, s[8:11], s23 offen offset:0 sc1
  v_smfmac_f32_16x16x64_bf16 v[56:59], v[8:11], v[144:151], v3
  v_smfmac_f32_16x16x64_bf16 v[60:63], v[8:11], v[200:207], v3
  s_waitcnt vmcnt(3)
  v_smfmac_f32_16x16x64_bf16 v[36:39], v[12:15], a[8:15], v3
  v_smfmac_f32_16x16x64_bf16 v[40:43], v[12:15], a[64:71], v3
  buffer_load_dwordx4 v[28:31], v2, s[8:11], s23 offen offset:1024 sc1
  v_smfmac_f32_16x16x64_bf16 v[44:47], v[12:15], a[120:127], v3
  v_smfmac_f32_16x16x64_bf16 v[48:51], v[12:15], a[176:183], v3
  v_smfmac_f32_16x16x64_bf16 v[52:55], v[12:15], a[232:239], v3
  buffer_load_dwordx4 v[32:35], v2, s[8:11], s23 offen offset:2048 sc1
  v_smfmac_f32_16x16x64_bf16 v[56:59], v[12:15], v[152:159], v3
  v_smfmac_f32_16x16x64_bf16 v[60:63], v[12:15], v[208:215], v3
  s_waitcnt vmcnt(4)
  v_smfmac_f32_16x16x64_bf16 v[36:39], v[16:19], a[16:23], v3
  s_xor_b32 s58, s25, 28672
  s_add_u32 s59, s24, 28672
  s_add_u32 m0, s58, 7168
  v_smfmac_f32_16x16x64_bf16 v[40:43], v[16:19], a[72:79], v3
  buffer_load_dwordx4 v2, s[8:11], s59 offen offset:0 sc1 lds
  v_smfmac_f32_16x16x64_bf16 v[44:47], v[16:19], a[128:135], v3
  v_smfmac_f32_16x16x64_bf16 v[48:51], v[16:19], a[184:191], v3
  v_smfmac_f32_16x16x64_bf16 v[52:55], v[16:19], a[240:247], v3
  v_smfmac_f32_16x16x64_bf16 v[56:59], v[16:19], v[160:167], v3
  buffer_load_dwordx4 v2, s[8:11], s59 offen offset:1024 sc1 lds
  v_smfmac_f32_16x16x64_bf16 v[60:63], v[16:19], v[216:223], v3
  s_waitcnt vmcnt(5)
  v_smfmac_f32_16x16x64_bf16 v[36:39], v[20:23], a[24:31], v3
  v_smfmac_f32_16x16x64_bf16 v[40:43], v[20:23], a[80:87], v3
  v_smfmac_f32_16x16x64_bf16 v[44:47], v[20:23], a[136:143], v3
  buffer_load_dwordx4 v2, s[8:11], s59 offen offset:2048 sc1 lds
  v_smfmac_f32_16x16x64_bf16 v[48:51], v[20:23], a[192:199], v3
  v_smfmac_f32_16x16x64_bf16 v[52:55], v[20:23], a[248:255], v3
  v_smfmac_f32_16x16x64_bf16 v[56:59], v[20:23], v[168:175], v3
  v_smfmac_f32_16x16x64_bf16 v[60:63], v[20:23], v[224:231], v3
  buffer_load_dwordx4 v2, s[8:11], s59 offen offset:3072 sc1 lds
  s_waitcnt vmcnt(4)
cB_sc1_ph2:
  v_smfmac_f32_16x16x64_bf16 v[60:63], v[24:27], v[232:239], v3
  ds_read_b128 v[16:19], v116 offset:2048
  ds_read_b128 v[20:23], v116 offset:3072
  v_smfmac_f32_16x16x64_bf16 v[60:63], v[28:31], v[240:247], v3
  buffer_load_dword v119, v0, s[8:11], s20 offen sc1
  v_smfmac_f32_16x16x64_bf16 v[60:63], v[32:35], v[248:255], v3
  v_mov_b32 v80, v26
  v_smfmac_f32_16x16x64_bf16 v[52:55], v[24:27], v[120:127], v3
  v_mov_b32 v81, v27
  v_smfmac_f32_16x16x64_bf16 v[52:55], v[28:31], v[128:135], v3
  v_mov_b32 v82, v32
  v_smfmac_f32_16x16x64_bf16 v[52:55], v[32:35], v[136:143], v3
  v_cvt_pk_bf16_f32 v66, v60, v61
  v_smfmac_f32_16x16x64_bf16 v[56:59], v[24:27], v[176:183], v3
  v_cvt_pk_bf16_f32 v67, v62, v63
  v_smfmac_f32_16x16x64_bf16 v[56:59], v[28:31], v[184:191], v3
  v_mov_b32 v83, v33
  v_mfma_f32_16x16x32_bf16 v[68:71], v[64:67], v[4:7], 0
  v_smfmac_f32_16x16x64_bf16 v[56:59], v[32:35], v[192:199], v3
  v_cvt_pk_bf16_f32 v64, v52, v53
  v_smfmac_f32_16x16x64_bf16 v[36:39], v[24:27], a[32:39], v3
  v_cvt_pk_bf16_f32 v65, v54, v55
  v_smfmac_f32_16x16x64_bf16 v[36:39], v[28:31], a[40:47], v3
  v_cvt_pk_bf16_f32 v78, v68, v69
  v_smfmac_f32_16x16x64_bf16 v[36:39], v[32:35], a[48:55], v3
  v_cvt_pk_bf16_f32 v79, v70, v71
  v_cvt_pk_bf16_f32 v66, v56, v57
  v_smfmac_f32_16x16x64_bf16 v[40:43], v[24:27], a[88:95], v3
  v_cvt_pk_bf16_f32 v67, v58, v59
  v_smfmac_f32_16x16x64_bf16 v[40:43], v[28:31], a[96:103], v3
  v_mfma_f32_16x16x32_bf16 v[72:75], v[64:67], v[4:7], 0
  ds_read_b128 v[52:55], v116 offset:16384
  ds_read_b128 v[56:59], v116 offset:17408
  v_smfmac_f32_16x16x64_bf16 v[40:43], v[32:35], a[104:111], v3
  v_cvt_pk_bf16_f32 v64, v36, v37
  v_smfmac_f32_16x16x64_bf16 v[44:47], v[24:27], a[144:151], v3
  v_cvt_pk_bf16_f32 v65, v38, v39
  v_smfmac_f32_16x16x64_bf16 v[44:47], v[28:31], a[152:159], v3
  v_cvt_pk_bf16_f32 v76, v72, v73
  v_smfmac_f32_16x16x64_bf16 v[44:47], v[32:35], a[160:167], v3
  v_cvt_pk_bf16_f32 v77, v74, v75
  v_cvt_pk_bf16_f32 v66, v40, v41
  v_smfmac_f32_16x16x64_bf16 v[48:51], v[24:27], a[200:207], v3
  v_cvt_pk_bf16_f32 v67, v42, v43
  v_smfmac_f32_16x16x64_bf16 v[48:51], v[28:31], a[208:215], v3
  v_mfma_f32_16x16x32_bf16 v[68:71], v[64:67], v[4:7], 0
  v_smfmac_f32_16x16x64_bf16 v[48:51], v[32:35], a[216:223], v3
  v_cvt_pk_bf16_f32 v64, v44, v45
  v_mfma_f32_16x16x32_bf16 v[84:87], v[80:83], v[76:79], 0
  v_cvt_pk_bf16_f32 v65, v46, v47
  s_waitcnt lgkmcnt(0)
  v_smfmac_f32_16x16x64_bf16 v[88:91], v[76:79], v[96:103], v118
  v_cvt_pk_bf16_f32 v60, v68, v69
  v_cvt_pk_bf16_f32 v61, v70, v71
  v_cvt_pk_bf16_f32 v66, v48, v49
  v_cvt_pk_bf16_f32 v67, v50, v51
  s_nop 1
  v_mfma_f32_16x16x32_bf16 v[72:75], v[64:67], v[4:7], 0
  v_smfmac_f32_16x16x64_bf16 v[92:95], v[76:79], v[104:111], v118
  s_nop 4
  v_cvt_pk_bf16_f32 v62, v72, v73
  v_cvt_pk_bf16_f32 v63, v74, v75
  s_nop 1
  v_mfma_f32_16x16x32_bf16 v[84:87], v[12:15], v[60:63], v[84:87]
  v_smfmac_f32_16x16x64_bf16 v[88:91], v[60:63], v[16:23], v118
  v_smfmac_f32_16x16x64_bf16 v[92:95], v[60:63], v[52:59], v118
  s_nop 1
  v_permlane32_swap_b32 v84, v86
  v_permlane32_swap_b32 v85, v87
  s_nop 0
  v_add_f32 v88, v88, v89
  v_add_f32_dpp v84, v86, v84 quad_perm:[1,0,3,2] row_mask:0xf bank_mask:0xf
  v_add_f32_dpp v85, v87, v85 quad_perm:[1,0,3,2] row_mask:0xf bank_mask:0xf
  v_add_f32 v89, v90, v91
  ds_write2_b32 v113, v84, v85 offset0:0 offset1:4
  ds_write2_b32 v112, v88, v89 offset0:0 offset1:128
  v_add_f32 v90, v92, v93
  v_add_f32 v91, v94, v95
  ds_write2_b32 v112, v90, v91 offset0:64 offset1:192
  v_cmp_u_f32 vcc, v88, v89
  s_cbranch_vccnz cB_sc1_retry
cB_sc1_cont:
  s_waitcnt lgkmcnt(0)
  s_barrier
  ds_read_b128 v[36:39], v114
  ds_read_b128 v[44:47], v115
  s_waitcnt lgkmcnt(0)
  v_add_f32 v36, v36, v38
  v_add_f32 v37, v37, v39
  v_add_f32 v44, v44, v45
  v_add_f32 v46, v46, v47
  v_add_f32 v44, v44, v46
  v_add_f32 v36, v36, v37
  v_exp_f32 v49, v44
  v_exp_f32 v48, v36
  v_add_f32 v50, abs(v36), abs(v44)
  v_fma_f32 v39, v49, s37, v48
  v_cmp_ngt_f32 vcc, s56, v50
  v_cndmask_b32 v41, v48, v49, s[38:39]
  v_add_f32_dpp v39, v39, v39 quad_perm:[1,0,3,2] row_mask:0xf bank_mask:0xf
  v_cndmask_b32 v40, v49, v48, s[38:39]
  v_mov_b32_dpp v46, v41 quad_perm:[1,0,3,2] row_mask:0xf bank_mask:0xf
  v_add_f32_dpp v39, v39, v39 quad_perm:[2,3,0,1] row_mask:0xf bank_mask:0xf
  v_cndmask_b32 v42, v46, v40, s[38:39]
  v_cndmask_b32 v43, v40, v46, s[38:39]
  v_add_f32_dpp v39, v39, v39 row_half_mirror row_mask:0xf bank_mask:0xf
  s_cbranch_vccnz cB_sc1_slow
  s_nop 0
  v_add_f32_dpp v47, v39, v39 row_mirror row_mask:0xf bank_mask:0xf
  v_add_f32_dpp v39, v39, v39 row_mirror row_mask:0xf bank_mask:0xf
  s_nop 1
  v_permlane16_swap_b32 v39, v47
  v_add_f32 v39, v39, v47
  v_rcp_f32 v39, v39
  s_mov_b64 exec, s[28:29]
  v_mul_f32 v42, v42, v39
  v_mul_f32 v43, v43, v39
  v_cvt_pk_bf16_f32 v42, v42, v43
cB_sc1_pst:
  buffer_store_dword v42, v1, s[8:11], s20 offen sc1
  s_mov_b64 exec, -1
  s_barrier
  s_add_u32 s24, s24, 28672
  s_add_u32 s35, s35, 28672
  s_xor_b32 s25, s25, 28672
  s_add_u32 m0, s25, 7168
  s_add_u32 m0, s25, 11264
  s_add_u32 s22, s24, 4096
  buffer_load_dwordx4 v2, s[8:11], s22 offen offset:0 sc1 lds
  s_nop 5
  buffer_load_dwordx4 v2, s[8:11], s22 offen offset:1024 sc1 lds
  s_nop 5
  buffer_load_dwordx4 v2, s[8:11], s22 offen offset:2048 sc1 lds
  s_nop 5
  v_xor_b32 v116, 28672, v116
  v_add_u32 v117, s57, v117
  s_sub_u32 s57, 0, s57
  s_add_u32 s19, s19, 1
  s_mov_b32 s20, s21
  s_cmp_lt_u32 s19, 63
  s_cbranch_scc1 cB_sc1_loop
  s_branch cB_done
cB_sc1_slow:
  v_max_f32 v50, v36, v44
  s_nop 1
  v_max_f32_dpp v50, v50, v50 quad_perm:[1,0,3,2] row_mask:0xf bank_mask:0xf
  s_nop 1
  v_max_f32_dpp v50, v50, v50 quad_perm:[2,3,0,1] row_mask:0xf bank_mask:0xf
  s_nop 1
  v_max_f32_dpp v50, v50, v50 row_half_mirror row_mask:0xf bank_mask:0xf
  s_nop 1
  v_max_f32_dpp v50, v50, v50 row_mirror row_mask:0xf bank_mask:0xf
  v_mov_b32 v47, v50
  s_nop 1
  v_permlane16_swap_b32 v50, v47
  v_max_f32 v50, v50, v47
  v_sub_f32 v48, v36, v50
  v_sub_f32 v49, v44, v50
  v_exp_f32 v48, v48
  v_exp_f32 v49, v49
  s_add_u32 s31, s31, 0x100
  v_fma_f32 v39, v49, s37, v48
  v_cndmask_b32 v41, v48, v49, s[38:39]
  s_nop 0
  v_add_f32_dpp v39, v39, v39 quad_perm:[1,0,3,2] row_mask:0xf bank_mask:0xf
  v_cndmask_b32 v40, v49, v48, s[38:39]
  v_mov_b32_dpp v46, v41 quad_perm:[1,0,3,2] row_mask:0xf bank_mask:0xf
  v_add_f32_dpp v39, v39, v39 quad_perm:[2,3,0,1] row_mask:0xf bank_mask:0xf
  v_cndmask_b32 v42, v46, v40, s[38:39]
  v_cndmask_b32 v43, v40, v46, s[38:39]
  v_add_f32_dpp v39, v39, v39 row_half_mirror row_mask:0xf bank_mask:0xf
  s_nop 1
  v_add_f32_dpp v47, v39, v39 row_mirror row_mask:0xf bank_mask:0xf
  v_add_f32_dpp v39, v39, v39 row_mirror row_mask:0xf bank_mask:0xf
  s_nop 1
  v_permlane16_swap_b32 v39, v47
  v_add_f32 v39, v39, v47
  v_rcp_f32 v39, v39
  s_mov_b64 exec, s[28:29]
  v_mul_f32 v42, v42, v39
  v_mul_f32 v43, v43, v39
  v_cvt_pk_bf16_f32 v42, v42, v43
  v_min_u32 v42, -2, v42
  s_branch cB_sc1_pst
cB_sc1_retry:
  s_cmp_lg_u32 s62, 0
  s_cbranch_scc1 cB_sc1_cont
  s_waitcnt vmcnt(0) lgkmcnt(0)
cB_sc1_rv:
  buffer_load_dwordx4 v[8:11], v2, s[8:11], s20 offen offset:0 sc1
  buffer_load_dwordx4 v[12:15], v2, s[8:11], s20 offen offset:1024 sc1
  buffer_load_dwordx4 v[16:19], v2, s[8:11], s20 offen offset:2048 sc1
  buffer_load_dwordx4 v[20:23], v2, s[8:11], s20 offen offset:3072 sc1
  buffer_load_dwordx4 v[24:27], v2, s[8:11], s23 offen offset:0 sc1
  buffer_load_dwordx4 v[28:31], v2, s[8:11], s23 offen offset:1024 sc1
  buffer_load_dwordx4 v[32:35], v2, s[8:11], s23 offen offset:2048 sc1
  s_waitcnt vmcnt(0)
  v_max3_u32 v68, v8, v9, v10
  v_max3_u32 v68, v68, v11, v12
  v_max3_u32 v68, v68, v13, v14
  v_max3_u32 v68, v68, v15, v16
  v_max3_u32 v68, v68, v17, v18
  v_max3_u32 v68, v68, v19, v20
  v_max3_u32 v68, v68, v21, v22
  v_max3_u32 v68, v68, v23, v24
  v_max3_u32 v68, v68, v25, v26
  v_max3_u32 v68, v68, v27, v28
  v_max3_u32 v68, v68, v29, v30
  v_max3_u32 v68, v68, v31, v32
  v_max3_u32 v68, v68, v33, v34
  v_max_u32 v68, v68, v35
  v_cmp_eq_u32 vcc, -1, v68
  s_cbranch_vccz cB_sc1_rk
  s_add_u32 s30, s30, 1
  s_cmp_lt_u32 s30, 400000
  s_cbranch_scc1 cB_sc1_rv
  s_branch cB_abort
cB_sc1_rk:
  s_mov_b32 s62, 1
  v_mov_b32 v36, 0
  v_mov_b32 v37, 0
  v_mov_b32 v38, 0
  v_mov_b32 v39, 0
  v_mov_b32 v40, 0
  v_mov_b32 v41, 0
  v_mov_b32 v42, 0
  v_mov_b32 v43, 0
  v_mov_b32 v44, 0
  v_mov_b32 v45, 0
  v_mov_b32 v46, 0
  v_mov_b32 v47, 0
  v_mov_b32 v48, 0
  v_mov_b32 v49, 0
  v_mov_b32 v50, 0
  v_mov_b32 v51, 0
  v_mov_b32 v52, 0
  v_mov_b32 v53, 0
  v_mov_b32 v54, 0
  v_mov_b32 v55, 0
  v_mov_b32 v56, 0
  v_mov_b32 v57, 0
  v_mov_b32 v58, 0
  v_mov_b32 v59, 0
  v_mov_b32 v60, 0
  v_mov_b32 v61, 0
  v_mov_b32 v62, 0
  v_mov_b32 v63, 0
  v_mov_b32 v88, 0
  v_mov_b32 v89, 0
  v_mov_b32 v90, 0
  v_mov_b32 v91, 0
  v_mov_b32 v92, 0
  v_mov_b32 v93, 0
  v_mov_b32 v94, 0
  v_mov_b32 v95, 0
  v_mov_b32 v64, 0
  v_mov_b32 v65, 0
  s_add_u32 s31, s31, 1
  ds_read_b128 v[96:99], v117 offset:0
  ds_read_b128 v[100:103], v117 offset:1024
  ds_read_b128 v[104:107], v117 offset:14336
  ds_read_b128 v[108:111], v117 offset:15360
  v_smfmac_f32_16x16x64_bf16 v[36:39], v[8:11], a[0:7], v3
  v_smfmac_f32_16x16x64_bf16 v[40:43], v[8:11], a[56:63], v3
  v_smfmac_f32_16x16x64_bf16 v[44:47], v[8:11], a[112:119], v3
  v_smfmac_f32_16x16x64_bf16 v[48:51], v[8:11], a[168:175], v3
  v_smfmac_f32_16x16x64_bf16 v[52:55], v[8:11], a[224:231], v3
  v_smfmac_f32_16x16x64_bf16 v[56:59], v[8:11], v[144:151], v3
  v_smfmac_f32_16x16x64_bf16 v[60:63], v[8:11], v[200:207], v3
  v_smfmac_f32_16x16x64_bf16 v[36:39], v[12:15], a[8:15], v3
  v_smfmac_f32_16x16x64_bf16 v[40:43], v[12:15], a[64:71], v3
  v_smfmac_f32_16x16x64_bf16 v[44:47], v[12:15], a[120:127], v3
  v_smfmac_f32_16x16x64_bf16 v[48:51], v[12:15], a[176:183], v3
  v_smfmac_f32_16x16x64_bf16 v[52:55], v[12:15], a[232:239], v3
  v_smfmac_f32_16x16x64_bf16 v[56:59], v[12:15], v[152:159], v3
  v_smfmac_f32_16x16x64_bf16 v[60:63], v[12:15], v[208:215], v3
  v_smfmac_f32_16x16x64_bf16 v[36:39], v[16:19], a[16:23], v3
  v_smfmac_f32_16x16x64_bf16 v[40:43], v[16:19], a[72:79], v3
  v_smfmac_f32_16x16x64_bf16 v[44:47], v[16:19], a[128:135], v3
  v_smfmac_f32_16x16x64_bf16 v[48:51], v[16:19], a[184:191], v3
  v_smfmac_f32_16x16x64_bf16 v[52:55], v[16:19], a[240:247], v3
  v_smfmac_f32_16x16x64_bf16 v[56:59], v[16:19], v[160:167], v3
  v_smfmac_f32_16x16x64_bf16 v[60:63], v[16:19], v[216:223], v3
  v_smfmac_f32_16x16x64_bf16 v[36:39], v[20:23], a[24:31], v3
  v_smfmac_f32_16x16x64_bf16 v[40:43], v[20:23], a[80:87], v3
  v_smfmac_f32_16x16x64_bf16 v[44:47], v[20:23], a[136:143], v3
  v_smfmac_f32_16x16x64_bf16 v[48:51], v[20:23], a[192:199], v3
  v_smfmac_f32_16x16x64_bf16 v[52:55], v[20:23], a[248:255], v3
  v_smfmac_f32_16x16x64_bf16 v[56:59], v[20:23], v[168:175], v3
  v_smfmac_f32_16x16x64_bf16 v[60:63], v[20:23], v[224:231], v3
  s_xor_b32 s58, s25, 28672
  s_add_u32 s59, s24, 28672
  s_add_u32 m0, s58, 7168
  s_branch cB_sc1_ph2
.p2align 6

cB_sc2_loop:
  s_add_u32 s23, s20, 4096
  s_add_u32 s21, s20, 20480
  v_mov_b32 v48, 0
  v_mov_b32 v49, 0
  v_mov_b32 v50, 0
  v_mov_b32 v51, 0
  v_mov_b32 v52, 0
  v_mov_b32 v53, 0
  v_mov_b32 v54, 0
  v_mov_b32 v55, 0
  v_mov_b32 v56, 0
  v_mov_b32 v57, 0
  v_mov_b32 v58, 0
  v_mov_b32 v59, 0
  v_mov_b32 v60, 0
  v_mov_b32 v61, 0
  v_mov_b32 v62, 0
  v_mov_b32 v63, 0
  v_mov_b32 v88, 0
  v_mov_b32 v89, 0
  v_mov_b32 v90, 0
  v_mov_b32 v91, 0
  v_mov_b32 v92, 0
  v_mov_b32 v93, 0
  v_mov_b32 v94, 0
  v_mov_b32 v95, 0
  v_mov_b32 v66, 0
  v_mov_b32 v67, 0
  s_mov_b32 s30, 0
  s_mov_b32 s62, 0
  s_waitcnt vmcnt(0)
  s_barrier
cB_sc2_ld:
  buffer_load_dwordx4 v[8:11], v2, s[8:11], s20 offen offset:0 sc1
  v_mov_b32 v36, 0
  v_mov_b32 v37, 0
  v_mov_b32 v38, 0
  v_mov_b32 v39, 0
  buffer_load_dwordx4 v[12:15], v2, s[8:11], s20 offen offset:1024 sc1
  v_mov_b32 v40, 0
  v_mov_b32 v41, 0
  v_mov_b32 v42, 0
  v_mov_b32 v43, 0
  buffer_load_dwordx4 v[16:19], v2, s[8:11], s20 offen offset:2048 sc1
  v_mov_b32 v44, 0
  v_mov_b32 v45, 0
  v_mov_b32 v46, 0
  v_mov_b32 v47, 0
  ds_read_b128 v[96:99], v117 offset:0
  ds_read_b128 v[100:103], v117 offset:1024
  ds_read_b128 v[104:107], v117 offset:14336
  ds_read_b128 v[108:111], v117 offset:15360
  s_waitcnt vmcnt(2)
  v_smfmac_f32_16x16x64_bf16 v[36:39], v[8:11], a[0:7], v3
  v_smfmac_f32_16x16x64_bf16 v[40:43], v[8:11], a[56:63], v3
  buffer_load_dwordx4 v[20:23], v2, s[8:11], s20 offen offset:3072 sc1
  v_smfmac_f32_16x16x64_bf16 v[44:47], v[8:11], a[112:119], v3
  v_smfmac_f32_16x16x64_bf16 v[48:51], v[8:11], a[168:175], v3
  v_smfmac_f32_16x16x64_bf16 v[52:55], v[8:11], a[224:231], v3
  buffer_load_dwordx4 v[24:27], v2, s[8:11], s23 offen offset:0 sc1
  v_smfmac_f32_16x16x64_bf16 v[56:59], v[8:11], v[144:151], v3
  v_smfmac_f32_16x16x64_bf16 v[60:63], v[8:11], v[200:207], v3
  s_waitcnt vmcnt(3)
  v_smfmac_f32_16x16x64_bf16 v[36:39], v[12:15], a[8:15], v3
  v_smfmac_f32_16x16x64_bf16 v[40:43], v[12:15], a[64:71], v3
  buffer_load_dwordx4 v[28:31], v2, s[8:11], s23 offen offset:1024 sc1
  v_smfmac_f32_16x16x64_bf16 v[44:47], v[12:15], a[120:127], v3
  v_smfmac_f32_16x16x64_bf16 v[48:51], v[12:15], a[176:183], v3
  v_smfmac_f32_16x16x64_bf16 v[52:55], v[12:15], a[232:239], v3
  buffer_load_dwordx4 v[32:35], v2, s[8:11], s23 offen offset:2048 sc1
  v_smfmac_f32_16x16x64_bf16 v[56:59], v[12:15], v[152:159], v3
  v_smfmac_f32_16x16x64_bf16 v[60:63], v[12:15], v[208:215], v3
  s_waitcnt vmcnt(4)
  v_smfmac_f32_16x16x64_bf16 v[36:39], v[16:19], a[16:23], v3
  v_smfmac_f32_16x16x64_bf16 v[40:43], v[16:19], a[72:79], v3
  s_xor_b32 s58, s25, 28672
  s_add_u32 s59, s24, 28672
  s_add_u32 m0, s58, 14336
  v_smfmac_f32_16x16x64_bf16 v[44:47], v[16:19], a[128:135], v3
  buffer_load_dwordx4 v2, s[8:11], s59 offen offset:0 sc1 lds
  v_smfmac_f32_16x16x64_bf16 v[48:51], v[16:19], a[184:191], v3
  v_smfmac_f32_16x16x64_bf16 v[52:55], v[16:19], a[240:247], v3
  v_smfmac_f32_16x16x64_bf16 v[56:59], v[16:19], v[160:167], v3
  v_smfmac_f32_16x16x64_bf16 v[60:63], v[16:19], v[216:223], v3
  buffer_load_dwordx4 v2, s[8:11], s59 offen offset:1024 sc1 lds
  s_waitcnt vmcnt(5)
  v_smfmac_f32_16x16x64_bf16 v[36:39], v[20:23], a[24:31], v3
  v_smfmac_f32_16x16x64_bf16 v[40:43], v[20:23], a[80:87], v3
  v_smfmac_f32_16x16x64_bf16 v[44:47], v[20:23], a[136:143], v3
  v_smfmac_f32_16x16x64_bf16 v[48:51], v[20:23], a[192:199], v3
  buffer_load_dwordx4 v2, s[8:11], s59 offen offset:2048 sc1 lds
  v_smfmac_f32_16x16x64_bf16 v[52:55], v[20:23], a[248:255], v3
  v_smfmac_f32_16x16x64_bf16 v[56:59], v[20:23], v[168:175], v3
  v_smfmac_f32_16x16x64_bf16 v[60:63], v[20:23], v[224:231], v3
  s_waitcnt vmcnt(3)
cB_sc2_ph2:
  v_smfmac_f32_16x16x64_bf16 v[60:63], v[24:27], v[232:239], v3
  buffer_load_dwordx4 v2, s[8:11], s59 offen offset:3072 sc1 lds
  ds_read_b128 v[8:11], v116 offset:4096
  ds_read_b128 v[12:15], v116 offset:5120
  v_smfmac_f32_16x16x64_bf16 v[60:63], v[28:31], v[240:247], v3
  buffer_load_dword v119, v0, s[8:11], s24 offen sc1
  v_smfmac_f32_16x16x64_bf16 v[60:63], v[32:35], v[248:255], v3
  v_mov_b32 v80, v28
  v_smfmac_f32_16x16x64_bf16 v[52:55], v[24:27], v[120:127], v3
  v_mov_b32 v81, v29
  v_smfmac_f32_16x16x64_bf16 v[52:55], v[28:31], v[128:135], v3
  v_mov_b32 v82, v34
  v_smfmac_f32_16x16x64_bf16 v[52:55], v[32:35], v[136:143], v3
  v_cvt_pk_bf16_f32 v64, v60, v61
  v_smfmac_f32_16x16x64_bf16 v[56:59], v[24:27], v[176:183], v3
  v_cvt_pk_bf16_f32 v65, v62, v63
  v_smfmac_f32_16x16x64_bf16 v[56:59], v[28:31], v[184:191], v3
  v_mov_b32 v83, v35
  v_mfma_f32_16x16x32_bf16 v[68:71], v[64:67], v[4:7], 0
  v_smfmac_f32_16x16x64_bf16 v[56:59], v[32:35], v[192:199], v3
  v_cvt_pk_bf16_f32 v64, v52, v53
  v_smfmac_f32_16x16x64_bf16 v[36:39], v[24:27], a[32:39], v3
  v_cvt_pk_bf16_f32 v65, v54, v55
  v_smfmac_f32_16x16x64_bf16 v[36:39], v[28:31], a[40:47], v3
  v_cvt_pk_bf16_f32 v78, v68, v69
  v_smfmac_f32_16x16x64_bf16 v[36:39], v[32:35], a[48:55], v3
  v_cvt_pk_bf16_f32 v79, v70, v71
  v_cvt_pk_bf16_f32 v66, v56, v57
  v_smfmac_f32_16x16x64_bf16 v[40:43], v[24:27], a[88:95], v3
  v_cvt_pk_bf16_f32 v67, v58, v59
  v_smfmac_f32_16x16x64_bf16 v[40:43], v[28:31], a[96:103], v3
  v_mfma_f32_16x16x32_bf16 v[72:75], v[64:67], v[4:7], 0
  ds_read_b128 v[52:55], v116 offset:18432
  ds_read_b128 v[56:59], v116 offset:19456
  v_smfmac_f32_16x16x64_bf16 v[40:43], v[32:35], a[104:111], v3
  v_cvt_pk_bf16_f32 v64, v36, v37
  v_smfmac_f32_16x16x64_bf16 v[44:47], v[24:27], a[144:151], v3
  v_cvt_pk_bf16_f32 v65, v38, v39
  v_smfmac_f32_16x16x64_bf16 v[44:47], v[28:31], a[152:159], v3
  v_cvt_pk_bf16_f32 v76, v72, v73
  v_smfmac_f32_16x16x64_bf16 v[44:47], v[32:35], a[160:167], v3
  v_cvt_pk_bf16_f32 v77, v74, v75
  v_cvt_pk_bf16_f32 v66, v40, v41
  v_smfmac_f32_16x16x64_bf16 v[48:51], v[24:27], a[200:207], v3
  v_cvt_pk_bf16_f32 v67, v42, v43
  v_smfmac_f32_16x16x64_bf16 v[48:51], v[28:31], a[208:215], v3
  v_mfma_f32_16x16x32_bf16 v[68:71], v[64:67], v[4:7], 0
  v_smfmac_f32_16x16x64_bf16 v[48:51], v[32:35], a[216:223], v3
  v_cvt_pk_bf16_f32 v64, v44, v45
  v_mfma_f32_16x16x32_bf16 v[84:87], v[80:83], v[76:79], 0
  v_cvt_pk_bf16_f32 v65, v46, v47
  s_waitcnt lgkmcnt(0)
  v_smfmac_f32_16x16x64_bf16 v[88:91], v[76:79], v[96:103], v118
  v_cvt_pk_bf16_f32 v60, v68, v69
  v_cvt_pk_bf16_f32 v61, v70, v71
  v_cvt_pk_bf16_f32 v66, v48, v49
  v_cvt_pk_bf16_f32 v67, v50, v51
  s_nop 1
  v_mfma_f32_16x16x32_bf16 v[72:75], v[64:67], v[4:7], 0
  v_smfmac_f32_16x16x64_bf16 v[92:95], v[76:79], v[104:111], v118
  s_nop 4
  v_cvt_pk_bf16_f32 v62, v72, v73
  v_cvt_pk_bf16_f32 v63, v74, v75
  s_nop 1
  v_mfma_f32_16x16x32_bf16 v[84:87], v[16:19], v[60:63], v[84:87]
  v_smfmac_f32_16x16x64_bf16 v[88:91], v[60:63], v[8:15], v118
  v_smfmac_f32_16x16x64_bf16 v[92:95], v[60:63], v[52:59], v118
  s_nop 1
  v_permlane32_swap_b32 v84, v86
  v_permlane32_swap_b32 v85, v87
  s_nop 0
  v_add_f32 v88, v88, v89
  v_add_f32_dpp v84, v86, v84 quad_perm:[1,0,3,2] row_mask:0xf bank_mask:0xf
  v_add_f32_dpp v85, v87, v85 quad_perm:[1,0,3,2] row_mask:0xf bank_mask:0xf
  v_add_f32 v89, v90, v91
  ds_write2_b32 v113, v84, v85 offset0:0 offset1:4
  ds_write2_b32 v112, v88, v89 offset0:0 offset1:128
  v_add_f32 v90, v92, v93
  v_add_f32 v91, v94, v95
  ds_write2_b32 v112, v90, v91 offset0:64 offset1:192
  v_cmp_u_f32 vcc, v88, v89
  s_cbranch_vccnz cB_sc2_retry
cB_sc2_cont:
  s_waitcnt lgkmcnt(0)
  s_barrier
  ds_read_b128 v[36:39], v114
  ds_read_b128 v[44:47], v115
  v_lshl_add_u32 v56, v2, 3, s36
  s_waitcnt lgkmcnt(0)
  v_add_f32 v36, v36, v38
  v_add_f32 v37, v37, v39
  v_add_f32 v44, v44, v45
  s_mov_b64 exec, 15
  buffer_store_dword v2, v56, s[8:11], s20 offen sc1
  s_mov_b64 exec, -1
  v_add_f32 v46, v46, v47
  v_add_f32 v44, v44, v46
  v_add_f32 v36, v36, v37
  v_exp_f32 v49, v44
  v_exp_f32 v48, v36
  v_add_f32 v50, abs(v36), abs(v44)
  v_fma_f32 v39, v49, s37, v48
  v_cmp_ngt_f32 vcc, s56, v50
  v_cndmask_b32 v41, v48, v49, s[38:39]
  v_add_f32_dpp v39, v39, v39 quad_perm:[1,0,3,2] row_mask:0xf bank_mask:0xf
  v_cndmask_b32 v40, v49, v48, s[38:39]
  v_mov_b32_dpp v46, v41 quad_perm:[1,0,3,2] row_mask:0xf bank_mask:0xf
  v_add_f32_dpp v39, v39, v39 quad_perm:[2,3,0,1] row_mask:0xf bank_mask:0xf
  v_cndmask_b32 v42, v46, v40, s[38:39]
  v_cndmask_b32 v43, v40, v46, s[38:39]
  v_add_f32_dpp v39, v39, v39 row_half_mirror row_mask:0xf bank_mask:0xf
  s_cbranch_vccnz cB_sc2_slow
  s_nop 0
  v_add_f32_dpp v47, v39, v39 row_mirror row_mask:0xf bank_mask:0xf
  v_add_f32_dpp v39, v39, v39 row_mirror row_mask:0xf bank_mask:0xf
  s_nop 1
  v_permlane16_swap_b32 v39, v47
  v_add_f32 v39, v39, v47
  v_rcp_f32 v39, v39
  s_mov_b64 exec, s[28:29]
  v_mul_f32 v42, v42, v39
  v_mul_f32 v43, v43, v39
  v_cvt_pk_bf16_f32 v42, v42, v43
cB_sc2_pst:
  buffer_store_dword v42, v1, s[8:11], s20 offen sc1
  s_mov_b64 exec, -1
  s_barrier
  s_cmp_lg_u32 s19, 0
  s_cbranch_scc1 cB_sc2_s0
  s_sub_u32 s36, s36, 64
  v_lshl_add_u32 v56, v2, 3, s36
  s_mov_b64 exec, 15
  buffer_store_dword v2, v56, s[8:11], s20 offen sc1
  s_mov_b64 exec, -1
cB_sc2_s0:
  s_add_u32 s24, s24, 28672
  s_add_u32 s35, s35, 28672
  s_xor_b32 s25, s25, 28672
  s_add_u32 m0, s25, 14336
  s_add_u32 m0, s25, 18432
  s_add_u32 s22, s24, 4096
  buffer_load_dwordx4 v2, s[8:11], s22 offen offset:0 sc1 lds
  s_nop 5
  buffer_load_dwordx4 v2, s[8:11], s22 offen offset:1024 sc1 lds
  s_nop 5
  buffer_load_dwordx4 v2, s[8:11], s22 offen offset:2048 sc1 lds
  s_nop 5
  v_xor_b32 v116, 28672, v116
  v_add_u32 v117, s57, v117
  s_sub_u32 s57, 0, s57
  s_add_u32 s19, s19, 1
  s_mov_b32 s20, s21
  s_cmp_lt_u32 s19, 63
  s_cbranch_scc1 cB_sc2_loop
  s_branch cB_done
cB_sc2_slow:
  v_max_f32 v50, v36, v44
  s_nop 1
  v_max_f32_dpp v50, v50, v50 quad_perm:[1,0,3,2] row_mask:0xf bank_mask:0xf
  s_nop 1
  v_max_f32_dpp v50, v50, v50 quad_perm:[2,3,0,1] row_mask:0xf bank_mask:0xf
  s_nop 1
  v_max_f32_dpp v50, v50, v50 row_half_mirror row_mask:0xf bank_mask:0xf
  s_nop 1
  v_max_f32_dpp v50, v50, v50 row_mirror row_mask:0xf bank_mask:0xf
  v_mov_b32 v47, v50
  s_nop 1
  v_permlane16_swap_b32 v50, v47
  v_max_f32 v50, v50, v47
  v_sub_f32 v48, v36, v50
  v_sub_f32 v49, v44, v50
  v_exp_f32 v48, v48
  v_exp_f32 v49, v49
  s_add_u32 s31, s31, 0x100
  v_fma_f32 v39, v49, s37, v48
  v_cndmask_b32 v41, v48, v49, s[38:39]
  s_nop 0
  v_add_f32_dpp v39, v39, v39 quad_perm:[1,0,3,2] row_mask:0xf bank_mask:0xf
  v_cndmask_b32 v40, v49, v48, s[38:39]
  v_mov_b32_dpp v46, v41 quad_perm:[1,0,3,2] row_mask:0xf bank_mask:0xf
  v_add_f32_dpp v39, v39, v39 quad_perm:[2,3,0,1] row_mask:0xf bank_mask:0xf
  v_cndmask_b32 v42, v46, v40, s[38:39]
  v_cndmask_b32 v43, v40, v46, s[38:39]
  v_add_f32_dpp v39, v39, v39 row_half_mirror row_mask:0xf bank_mask:0xf
  s_nop 1
  v_add_f32_dpp v47, v39, v39 row_mirror row_mask:0xf bank_mask:0xf
  v_add_f32_dpp v39, v39, v39 row_mirror row_mask:0xf bank_mask:0xf
  s_nop 1
  v_permlane16_swap_b32 v39, v47
  v_add_f32 v39, v39, v47
  v_rcp_f32 v39, v39
  s_mov_b64 exec, s[28:29]
  v_mul_f32 v42, v42, v39
  v_mul_f32 v43, v43, v39
  v_cvt_pk_bf16_f32 v42, v42, v43
  v_min_u32 v42, -2, v42
  s_branch cB_sc2_pst
cB_sc2_retry:
  s_cmp_lg_u32 s62, 0
  s_cbranch_scc1 cB_sc2_cont
  s_waitcnt vmcnt(0) lgkmcnt(0)
cB_sc2_rv:
  buffer_load_dwordx4 v[8:11], v2, s[8:11], s20 offen offset:0 sc1
  buffer_load_dwordx4 v[12:15], v2, s[8:11], s20 offen offset:1024 sc1
  buffer_load_dwordx4 v[16:19], v2, s[8:11], s20 offen offset:2048 sc1
  buffer_load_dwordx4 v[20:23], v2, s[8:11], s20 offen offset:3072 sc1
  buffer_load_dwordx4 v[24:27], v2, s[8:11], s23 offen offset:0 sc1
  buffer_load_dwordx4 v[28:31], v2, s[8:11], s23 offen offset:1024 sc1
  buffer_load_dwordx4 v[32:35], v2, s[8:11], s23 offen offset:2048 sc1
  s_waitcnt vmcnt(0)
  v_max3_u32 v68, v8, v9, v10
  v_max3_u32 v68, v68, v11, v12
  v_max3_u32 v68, v68, v13, v14
  v_max3_u32 v68, v68, v15, v16
  v_max3_u32 v68, v68, v17, v18
  v_max3_u32 v68, v68, v19, v20
  v_max3_u32 v68, v68, v21, v22
  v_max3_u32 v68, v68, v23, v24
  v_max3_u32 v68, v68, v25, v26
  v_max3_u32 v68, v68, v27, v28
  v_max3_u32 v68, v68, v29, v30
  v_max3_u32 v68, v68, v31, v32
  v_max3_u32 v68, v68, v33, v34
  v_max_u32 v68, v68, v35
  v_cmp_eq_u32 vcc, -1, v68
  s_cbranch_vccz cB_sc2_rk
  s_add_u32 s30, s30, 1
  s_cmp_lt_u32 s30, 400000
  s_cbranch_scc1 cB_sc2_rv
  s_branch cB_abort
cB_sc2_rk:
  s_mov_b32 s62, 1
  v_mov_b32 v36, 0
  v_mov_b32 v37, 0
  v_mov_b32 v38, 0
  v_mov_b32 v39, 0
  v_mov_b32 v40, 0
  v_mov_b32 v41, 0
  v_mov_b32 v42, 0
  v_mov_b32 v43, 0
  v_mov_b32 v44, 0
  v_mov_b32 v45, 0
  v_mov_b32 v46, 0
  v_mov_b32 v47, 0
  v_mov_b32 v48, 0
  v_mov_b32 v49, 0
  v_mov_b32 v50, 0
  v_mov_b32 v51, 0
  v_mov_b32 v52, 0
  v_mov_b32 v53, 0
  v_mov_b32 v54, 0
  v_mov_b32 v55, 0
  v_mov_b32 v56, 0
  v_mov_b32 v57, 0
  v_mov_b32 v58, 0
  v_mov_b32 v59, 0
  v_mov_b32 v60, 0
  v_mov_b32 v61, 0
  v_mov_b32 v62, 0
  v_mov_b32 v63, 0
  v_mov_b32 v88, 0
  v_mov_b32 v89, 0
  v_mov_b32 v90, 0
  v_mov_b32 v91, 0
  v_mov_b32 v92, 0
  v_mov_b32 v93, 0
  v_mov_b32 v94, 0
  v_mov_b32 v95, 0
  v_mov_b32 v66, 0
  v_mov_b32 v67, 0
  s_add_u32 s31, s31, 1
  ds_read_b128 v[96:99], v117 offset:0
  ds_read_b128 v[100:103], v117 offset:1024
  ds_read_b128 v[104:107], v117 offset:14336
  ds_read_b128 v[108:111], v117 offset:15360
  v_smfmac_f32_16x16x64_bf16 v[36:39], v[8:11], a[0:7], v3
  v_smfmac_f32_16x16x64_bf16 v[40:43], v[8:11], a[56:63], v3
  v_smfmac_f32_16x16x64_bf16 v[44:47], v[8:11], a[112:119], v3
  v_smfmac_f32_16x16x64_bf16 v[48:51], v[8:11], a[168:175], v3
  v_smfmac_f32_16x16x64_bf16 v[52:55], v[8:11], a[224:231], v3
  v_smfmac_f32_16x16x64_bf16 v[56:59], v[8:11], v[144:151], v3
  v_smfmac_f32_16x16x64_bf16 v[60:63], v[8:11], v[200:207], v3
  v_smfmac_f32_16x16x64_bf16 v[36:39], v[12:15], a[8:15], v3
  v_smfmac_f32_16x16x64_bf16 v[40:43], v[12:15], a[64:71], v3
  v_smfmac_f32_16x16x64_bf16 v[44:47], v[12:15], a[120:127], v3
  v_smfmac_f32_16x16x64_bf16 v[48:51], v[12:15], a[176:183], v3
  v_smfmac_f32_16x16x64_bf16 v[52:55], v[12:15], a[232:239], v3
  v_smfmac_f32_16x16x64_bf16 v[56:59], v[12:15], v[152:159], v3
  v_smfmac_f32_16x16x64_bf16 v[60:63], v[12:15], v[208:215], v3
  v_smfmac_f32_16x16x64_bf16 v[36:39], v[16:19], a[16:23], v3
  v_smfmac_f32_16x16x64_bf16 v[40:43], v[16:19], a[72:79], v3
  v_smfmac_f32_16x16x64_bf16 v[44:47], v[16:19], a[128:135], v3
  v_smfmac_f32_16x16x64_bf16 v[48:51], v[16:19], a[184:191], v3
  v_smfmac_f32_16x16x64_bf16 v[52:55], v[16:19], a[240:247], v3
  v_smfmac_f32_16x16x64_bf16 v[56:59], v[16:19], v[160:167], v3
  v_smfmac_f32_16x16x64_bf16 v[60:63], v[16:19], v[216:223], v3
  v_smfmac_f32_16x16x64_bf16 v[36:39], v[20:23], a[24:31], v3
  v_smfmac_f32_16x16x64_bf16 v[40:43], v[20:23], a[80:87], v3
  v_smfmac_f32_16x16x64_bf16 v[44:47], v[20:23], a[136:143], v3
  v_smfmac_f32_16x16x64_bf16 v[48:51], v[20:23], a[192:199], v3
  v_smfmac_f32_16x16x64_bf16 v[52:55], v[20:23], a[248:255], v3
  v_smfmac_f32_16x16x64_bf16 v[56:59], v[20:23], v[168:175], v3
  v_smfmac_f32_16x16x64_bf16 v[60:63], v[20:23], v[224:231], v3
  s_xor_b32 s58, s25, 28672
  s_add_u32 s59, s24, 28672
  s_add_u32 m0, s58, 14336
  s_branch cB_sc2_ph2
.p2align 6

cB_sc3_loop:
  s_add_u32 s23, s20, 4096
  s_add_u32 s21, s20, 20480
  v_mov_b32 v48, 0
  v_mov_b32 v49, 0
  v_mov_b32 v50, 0
  v_mov_b32 v51, 0
  v_mov_b32 v52, 0
  v_mov_b32 v53, 0
  v_mov_b32 v54, 0
  v_mov_b32 v55, 0
  v_mov_b32 v56, 0
  v_mov_b32 v57, 0
  v_mov_b32 v58, 0
  v_mov_b32 v59, 0
  v_mov_b32 v60, 0
  v_mov_b32 v61, 0
  v_mov_b32 v62, 0
  v_mov_b32 v63, 0
  v_mov_b32 v88, 0
  v_mov_b32 v89, 0
  v_mov_b32 v90, 0
  v_mov_b32 v91, 0
  v_mov_b32 v92, 0
  v_mov_b32 v93, 0
  v_mov_b32 v94, 0
  v_mov_b32 v95, 0
  v_mov_b32 v64, 0
  v_mov_b32 v65, 0
  s_mov_b32 s30, 0
  s_mov_b32 s62, 0
  s_waitcnt vmcnt(0)
  s_barrier
cB_sc3_ld:
  buffer_load_dwordx4 v[8:11], v2, s[8:11], s20 offen offset:0 sc1
  v_mov_b32 v36, 0
  v_mov_b32 v37, 0
  v_mov_b32 v38, 0
  v_mov_b32 v39, 0
  buffer_load_dwordx4 v[12:15], v2, s[8:11], s20 offen offset:1024 sc1
  v_mov_b32 v40, 0
  v_mov_b32 v41, 0
  v_mov_b32 v42, 0
  v_mov_b32 v43, 0
  buffer_load_dwordx4 v[16:19], v2, s[8:11], s20 offen offset:2048 sc1
  v_mov_b32 v44, 0
  v_mov_b32 v45, 0
  v_mov_b32 v46, 0
  v_mov_b32 v47, 0
  ds_read_b128 v[96:99], v117 offset:0
  ds_read_b128 v[100:103], v117 offset:1024
  ds_read_b128 v[104:107], v117 offset:14336
  ds_read_b128 v[108:111], v117 offset:15360
  s_waitcnt vmcnt(2)
  v_smfmac_f32_16x16x64_bf16 v[36:39], v[8:11], a[0:7], v3
  v_smfmac_f32_16x16x64_bf16 v[40:43], v[8:11], a[56:63], v3
  buffer_load_dwordx4 v[20:23], v2, s[8:11], s20 offen offset:3072 sc1
  v_smfmac_f32_16x16x64_bf16 v[44:47], v[8:11], a[112:119], v3
  v_smfmac_f32_16x16x64_bf16 v[48:51], v[8:11], a[168:175], v3
  v_smfmac_f32_16x16x64_bf16 v[52:55], v[8:11], a[224:231], v3
  buffer_load_dwordx4 v[24:27], v2, s[8:11], s23 offen offset:0 sc1
  v_smfmac_f32_16x16x64_bf16 v[56:59], v[8:11], v[144:151], v3
  v_smfmac_f32_16x16x64_bf16 v[60:63], v[8:11], v[200:207], v3
  s_waitcnt vmcnt(3)
  v_smfmac_f32_16x16x64_bf16 v[36:39], v[12:15], a[8:15], v3
  v_smfmac_f32_16x16x64_bf16 v[40:43], v[12:15], a[64:71], v3
  buffer_load_dwordx4 v[28:31], v2, s[8:11], s23 offen offset:1024 sc1
  v_smfmac_f32_16x16x64_bf16 v[44:47], v[12:15], a[120:127], v3
  v_smfmac_f32_16x16x64_bf16 v[48:51], v[12:15], a[176:183], v3
  v_smfmac_f32_16x16x64_bf16 v[52:55], v[12:15], a[232:239], v3
  buffer_load_dwordx4 v[32:35], v2, s[8:11], s23 offen offset:2048 sc1
  v_smfmac_f32_16x16x64_bf16 v[56:59], v[12:15], v[152:159], v3
  v_smfmac_f32_16x16x64_bf16 v[60:63], v[12:15], v[208:215], v3
  s_waitcnt vmcnt(4)
  v_smfmac_f32_16x16x64_bf16 v[36:39], v[16:19], a[16:23], v3
  v_smfmac_f32_16x16x64_bf16 v[40:43], v[16:19], a[72:79], v3
  v_smfmac_f32_16x16x64_bf16 v[44:47], v[16:19], a[128:135], v3
  s_xor_b32 s58, s25, 28672
  s_add_u32 s59, s24, 28672
  s_add_u32 m0, s58, 21504
  v_smfmac_f32_16x16x64_bf16 v[48:51], v[16:19], a[184:191], v3
  buffer_load_dwordx4 v2, s[8:11], s59 offen offset:0 sc1 lds
  v_smfmac_f32_16x16x64_bf16 v[52:55], v[16:19], a[240:247], v3
  v_smfmac_f32_16x16x64_bf16 v[56:59], v[16:19], v[160:167], v3
  v_smfmac_f32_16x16x64_bf16 v[60:63], v[16:19], v[216:223], v3
  s_waitcnt vmcnt(4)
  v_smfmac_f32_16x16x64_bf16 v[36:39], v[20:23], a[24:31], v3
  buffer_load_dwordx4 v2, s[8:11], s59 offen offset:1024 sc1 lds
  v_smfmac_f32_16x16x64_bf16 v[40:43], v[20:23], a[80:87], v3
  v_smfmac_f32_16x16x64_bf16 v[44:47], v[20:23], a[136:143], v3
  v_smfmac_f32_16x16x64_bf16 v[48:51], v[20:23], a[192:199], v3
  v_smfmac_f32_16x16x64_bf16 v[52:55], v[20:23], a[248:255], v3
  buffer_load_dwordx4 v2, s[8:11], s59 offen offset:2048 sc1 lds
  v_smfmac_f32_16x16x64_bf16 v[56:59], v[20:23], v[168:175], v3
  v_smfmac_f32_16x16x64_bf16 v[60:63], v[20:23], v[224:231], v3
  s_waitcnt vmcnt(3)
cB_sc3_ph2:
  v_smfmac_f32_16x16x64_bf16 v[60:63], v[24:27], v[232:239], v3
  ds_read_b128 v[8:11], v116 offset:6144
  ds_read_b128 v[12:15], v116 offset:7168
  v_smfmac_f32_16x16x64_bf16 v[60:63], v[28:31], v[240:247], v3
  buffer_load_dwordx4 v2, s[8:11], s59 offen offset:3072 sc1 lds
  v_smfmac_f32_16x16x64_bf16 v[60:63], v[32:35], v[248:255], v3
  v_mov_b32 v80, v30
  v_smfmac_f32_16x16x64_bf16 v[52:55], v[24:27], v[120:127], v3
  v_mov_b32 v81, v31
  v_smfmac_f32_16x16x64_bf16 v[52:55], v[28:31], v[128:135], v3
  v_mov_b32 v82, v34
  v_smfmac_f32_16x16x64_bf16 v[52:55], v[32:35], v[136:143], v3
  v_cvt_pk_bf16_f32 v66, v60, v61
  v_smfmac_f32_16x16x64_bf16 v[56:59], v[24:27], v[176:183], v3
  v_cvt_pk_bf16_f32 v67, v62, v63
  v_smfmac_f32_16x16x64_bf16 v[56:59], v[28:31], v[184:191], v3
  v_mov_b32 v83, v35
  v_mfma_f32_16x16x32_bf16 v[68:71], v[64:67], v[4:7], 0
  v_smfmac_f32_16x16x64_bf16 v[56:59], v[32:35], v[192:199], v3
  v_cvt_pk_bf16_f32 v64, v52, v53
  v_smfmac_f32_16x16x64_bf16 v[36:39], v[24:27], a[32:39], v3
  v_cvt_pk_bf16_f32 v65, v54, v55
  v_smfmac_f32_16x16x64_bf16 v[36:39], v[28:31], a[40:47], v3
  v_cvt_pk_bf16_f32 v78, v68, v69
  v_smfmac_f32_16x16x64_bf16 v[36:39], v[32:35], a[48:55], v3
  v_cvt_pk_bf16_f32 v79, v70, v71
  v_cvt_pk_bf16_f32 v66, v56, v57
  v_smfmac_f32_16x16x64_bf16 v[40:43], v[24:27], a[88:95], v3
  v_cvt_pk_bf16_f32 v67, v58, v59
  v_smfmac_f32_16x16x64_bf16 v[40:43], v[28:31], a[96:103], v3
  v_mfma_f32_16x16x32_bf16 v[72:75], v[64:67], v[4:7], 0
  ds_read_b128 v[52:55], v116 offset:20480
  ds_read_b128 v[56:59], v116 offset:21504
  v_smfmac_f32_16x16x64_bf16 v[40:43], v[32:35], a[104:111], v3
  v_cvt_pk_bf16_f32 v64, v36, v37
  v_smfmac_f32_16x16x64_bf16 v[44:47], v[24:27], a[144:151], v3
  v_cvt_pk_bf16_f32 v65, v38, v39
  v_smfmac_f32_16x16x64_bf16 v[44:47], v[28:31], a[152:159], v3
  v_cvt_pk_bf16_f32 v76, v72, v73
  v_smfmac_f32_16x16x64_bf16 v[44:47], v[32:35], a[160:167], v3
  v_cvt_pk_bf16_f32 v77, v74, v75
  v_cvt_pk_bf16_f32 v66, v40, v41
  v_smfmac_f32_16x16x64_bf16 v[48:51], v[24:27], a[200:207], v3
  v_cvt_pk_bf16_f32 v67, v42, v43
  v_smfmac_f32_16x16x64_bf16 v[48:51], v[28:31], a[208:215], v3
  v_mfma_f32_16x16x32_bf16 v[68:71], v[64:67], v[4:7], 0
  v_smfmac_f32_16x16x64_bf16 v[48:51], v[32:35], a[216:223], v3
  v_cvt_pk_bf16_f32 v64, v44, v45
  v_mfma_f32_16x16x32_bf16 v[84:87], v[80:83], v[76:79], 0
  v_cvt_pk_bf16_f32 v65, v46, v47
  s_waitcnt lgkmcnt(0)
  v_smfmac_f32_16x16x64_bf16 v[88:91], v[76:79], v[96:103], v118
  v_cvt_pk_bf16_f32 v60, v68, v69
  v_cvt_pk_bf16_f32 v61, v70, v71
  v_cvt_pk_bf16_f32 v66, v48, v49
  v_cvt_pk_bf16_f32 v67, v50, v51
  s_nop 1
  v_mfma_f32_16x16x32_bf16 v[72:75], v[64:67], v[4:7], 0
  v_smfmac_f32_16x16x64_bf16 v[92:95], v[76:79], v[104:111], v118
  s_nop 4
  v_cvt_pk_bf16_f32 v62, v72, v73
  v_cvt_pk_bf16_f32 v63, v74, v75
  s_nop 1
  v_mfma_f32_16x16x32_bf16 v[84:87], v[20:23], v[60:63], v[84:87]
  v_smfmac_f32_16x16x64_bf16 v[88:91], v[60:63], v[8:15], v118
  v_smfmac_f32_16x16x64_bf16 v[92:95], v[60:63], v[52:59], v118
  s_nop 1
  v_permlane32_swap_b32 v84, v86
  v_permlane32_swap_b32 v85, v87
  s_nop 0
  v_add_f32 v88, v88, v89
  v_add_f32_dpp v84, v86, v84 quad_perm:[1,0,3,2] row_mask:0xf bank_mask:0xf
  v_add_f32_dpp v85, v87, v85 quad_perm:[1,0,3,2] row_mask:0xf bank_mask:0xf
  v_add_f32 v89, v90, v91
  ds_write2_b32 v113, v84, v85 offset0:0 offset1:4
  ds_write2_b32 v112, v88, v89 offset0:0 offset1:128
  v_add_f32 v90, v92, v93
  v_add_f32 v91, v94, v95
  ds_write2_b32 v112, v90, v91 offset0:64 offset1:192
  v_cmp_u_f32 vcc, v88, v89
  s_cbranch_vccnz cB_sc3_retry
cB_sc3_cont:
  s_waitcnt lgkmcnt(0)
  s_barrier
  ds_read_b128 v[36:39], v114
  ds_read_b128 v[44:47], v115
  s_waitcnt lgkmcnt(0)
  v_add_f32 v36, v36, v38
  v_add_f32 v37, v37, v39
  v_add_f32 v44, v44, v45
  v_add_f32 v46, v46, v47
  v_add_f32 v44, v44, v46
  v_add_f32 v36, v36, v37
  v_exp_f32 v49, v44
  v_exp_f32 v48, v36
  v_add_f32 v50, abs(v36), abs(v44)
  v_fma_f32 v39, v49, s37, v48
  v_cmp_ngt_f32 vcc, s56, v50
  v_cndmask_b32 v41, v48, v49, s[38:39]
  v_add_f32_dpp v39, v39, v39 quad_perm:[1,0,3,2] row_mask:0xf bank_mask:0xf
  v_cndmask_b32 v40, v49, v48, s[38:39]
  v_mov_b32_dpp v46, v41 quad_perm:[1,0,3,2] row_mask:0xf bank_mask:0xf
  v_add_f32_dpp v39, v39, v39 quad_perm:[2,3,0,1] row_mask:0xf bank_mask:0xf
  v_cndmask_b32 v42, v46, v40, s[38:39]
  v_cndmask_b32 v43, v40, v46, s[38:39]
  v_add_f32_dpp v39, v39, v39 row_half_mirror row_mask:0xf bank_mask:0xf
  s_cbranch_vccnz cB_sc3_slow
  s_nop 0
  v_add_f32_dpp v47, v39, v39 row_mirror row_mask:0xf bank_mask:0xf
  v_add_f32_dpp v39, v39, v39 row_mirror row_mask:0xf bank_mask:0xf
  s_nop 1
  v_permlane16_swap_b32 v39, v47
  v_add_f32 v39, v39, v47
  v_rcp_f32 v39, v39
  s_mov_b64 exec, s[28:29]
  v_mul_f32 v42, v42, v39
  v_mul_f32 v43, v43, v39
  v_cvt_pk_bf16_f32 v42, v42, v43
cB_sc3_pst:
  buffer_store_dword v42, v1, s[8:11], s20 offen sc1
  s_mov_b64 exec, -1
  s_barrier
  s_add_u32 s24, s24, 28672
  s_add_u32 s35, s35, 28672
  s_xor_b32 s25, s25, 28672
  s_add_u32 m0, s25, 21504
  s_add_u32 m0, s25, 25600
  s_add_u32 s22, s24, 4096
  buffer_load_dwordx4 v2, s[8:11], s22 offen offset:0 sc1 lds
  s_nop 5
  buffer_load_dwordx4 v2, s[8:11], s22 offen offset:1024 sc1 lds
  s_nop 5
  buffer_load_dwordx4 v2, s[8:11], s22 offen offset:2048 sc1 lds
  s_nop 5
  v_xor_b32 v116, 28672, v116
  v_add_u32 v117, s57, v117
  s_sub_u32 s57, 0, s57
  s_add_u32 s19, s19, 1
  s_mov_b32 s20, s21
  s_cmp_lt_u32 s19, 63
  s_cbranch_scc1 cB_sc3_loop
  s_branch cB_done
cB_sc3_slow:
  v_max_f32 v50, v36, v44
  s_nop 1
  v_max_f32_dpp v50, v50, v50 quad_perm:[1,0,3,2] row_mask:0xf bank_mask:0xf
  s_nop 1
  v_max_f32_dpp v50, v50, v50 quad_perm:[2,3,0,1] row_mask:0xf bank_mask:0xf
  s_nop 1
  v_max_f32_dpp v50, v50, v50 row_half_mirror row_mask:0xf bank_mask:0xf
  s_nop 1
  v_max_f32_dpp v50, v50, v50 row_mirror row_mask:0xf bank_mask:0xf
  v_mov_b32 v47, v50
  s_nop 1
  v_permlane16_swap_b32 v50, v47
  v_max_f32 v50, v50, v47
  v_sub_f32 v48, v36, v50
  v_sub_f32 v49, v44, v50
  v_exp_f32 v48, v48
  v_exp_f32 v49, v49
  s_add_u32 s31, s31, 0x100
  v_fma_f32 v39, v49, s37, v48
  v_cndmask_b32 v41, v48, v49, s[38:39]
  s_nop 0
  v_add_f32_dpp v39, v39, v39 quad_perm:[1,0,3,2] row_mask:0xf bank_mask:0xf
  v_cndmask_b32 v40, v49, v48, s[38:39]
  v_mov_b32_dpp v46, v41 quad_perm:[1,0,3,2] row_mask:0xf bank_mask:0xf
  v_add_f32_dpp v39, v39, v39 quad_perm:[2,3,0,1] row_mask:0xf bank_mask:0xf
  v_cndmask_b32 v42, v46, v40, s[38:39]
  v_cndmask_b32 v43, v40, v46, s[38:39]
  v_add_f32_dpp v39, v39, v39 row_half_mirror row_mask:0xf bank_mask:0xf
  s_nop 1
  v_add_f32_dpp v47, v39, v39 row_mirror row_mask:0xf bank_mask:0xf
  v_add_f32_dpp v39, v39, v39 row_mirror row_mask:0xf bank_mask:0xf
  s_nop 1
  v_permlane16_swap_b32 v39, v47
  v_add_f32 v39, v39, v47
  v_rcp_f32 v39, v39
  s_mov_b64 exec, s[28:29]
  v_mul_f32 v42, v42, v39
  v_mul_f32 v43, v43, v39
  v_cvt_pk_bf16_f32 v42, v42, v43
  v_min_u32 v42, -2, v42
  s_branch cB_sc3_pst
cB_sc3_retry:
  s_cmp_lg_u32 s62, 0
  s_cbranch_scc1 cB_sc3_cont
  s_waitcnt vmcnt(0) lgkmcnt(0)
cB_sc3_rv:
  buffer_load_dwordx4 v[8:11], v2, s[8:11], s20 offen offset:0 sc1
  buffer_load_dwordx4 v[12:15], v2, s[8:11], s20 offen offset:1024 sc1
  buffer_load_dwordx4 v[16:19], v2, s[8:11], s20 offen offset:2048 sc1
  buffer_load_dwordx4 v[20:23], v2, s[8:11], s20 offen offset:3072 sc1
  buffer_load_dwordx4 v[24:27], v2, s[8:11], s23 offen offset:0 sc1
  buffer_load_dwordx4 v[28:31], v2, s[8:11], s23 offen offset:1024 sc1
  buffer_load_dwordx4 v[32:35], v2, s[8:11], s23 offen offset:2048 sc1
  s_waitcnt vmcnt(0)
  v_max3_u32 v68, v8, v9, v10
  v_max3_u32 v68, v68, v11, v12
  v_max3_u32 v68, v68, v13, v14
  v_max3_u32 v68, v68, v15, v16
  v_max3_u32 v68, v68, v17, v18
  v_max3_u32 v68, v68, v19, v20
  v_max3_u32 v68, v68, v21, v22
  v_max3_u32 v68, v68, v23, v24
  v_max3_u32 v68, v68, v25, v26
  v_max3_u32 v68, v68, v27, v28
  v_max3_u32 v68, v68, v29, v30
  v_max3_u32 v68, v68, v31, v32
  v_max3_u32 v68, v68, v33, v34
  v_max_u32 v68, v68, v35
  v_cmp_eq_u32 vcc, -1, v68
  s_cbranch_vccz cB_sc3_rk
  s_add_u32 s30, s30, 1
  s_cmp_lt_u32 s30, 400000
  s_cbranch_scc1 cB_sc3_rv
  s_branch cB_abort
cB_sc3_rk:
  s_mov_b32 s62, 1
  v_mov_b32 v36, 0
  v_mov_b32 v37, 0
  v_mov_b32 v38, 0
  v_mov_b32 v39, 0
  v_mov_b32 v40, 0
  v_mov_b32 v41, 0
  v_mov_b32 v42, 0
  v_mov_b32 v43, 0
  v_mov_b32 v44, 0
  v_mov_b32 v45, 0
  v_mov_b32 v46, 0
  v_mov_b32 v47, 0
  v_mov_b32 v48, 0
  v_mov_b32 v49, 0
  v_mov_b32 v50, 0
  v_mov_b32 v51, 0
  v_mov_b32 v52, 0
  v_mov_b32 v53, 0
  v_mov_b32 v54, 0
  v_mov_b32 v55, 0
  v_mov_b32 v56, 0
  v_mov_b32 v57, 0
  v_mov_b32 v58, 0
  v_mov_b32 v59, 0
  v_mov_b32 v60, 0
  v_mov_b32 v61, 0
  v_mov_b32 v62, 0
  v_mov_b32 v63, 0
  v_mov_b32 v88, 0
  v_mov_b32 v89, 0
  v_mov_b32 v90, 0
  v_mov_b32 v91, 0
  v_mov_b32 v92, 0
  v_mov_b32 v93, 0
  v_mov_b32 v94, 0
  v_mov_b32 v95, 0
  v_mov_b32 v64, 0
  v_mov_b32 v65, 0
  s_add_u32 s31, s31, 1
  ds_read_b128 v[96:99], v117 offset:0
  ds_read_b128 v[100:103], v117 offset:1024
  ds_read_b128 v[104:107], v117 offset:14336
  ds_read_b128 v[108:111], v117 offset:15360
  v_smfmac_f32_16x16x64_bf16 v[36:39], v[8:11], a[0:7], v3
  v_smfmac_f32_16x16x64_bf16 v[40:43], v[8:11], a[56:63], v3
  v_smfmac_f32_16x16x64_bf16 v[44:47], v[8:11], a[112:119], v3
  v_smfmac_f32_16x16x64_bf16 v[48:51], v[8:11], a[168:175], v3
  v_smfmac_f32_16x16x64_bf16 v[52:55], v[8:11], a[224:231], v3
  v_smfmac_f32_16x16x64_bf16 v[56:59], v[8:11], v[144:151], v3
  v_smfmac_f32_16x16x64_bf16 v[60:63], v[8:11], v[200:207], v3
  v_smfmac_f32_16x16x64_bf16 v[36:39], v[12:15], a[8:15], v3
  v_smfmac_f32_16x16x64_bf16 v[40:43], v[12:15], a[64:71], v3
  v_smfmac_f32_16x16x64_bf16 v[44:47], v[12:15], a[120:127], v3
  v_smfmac_f32_16x16x64_bf16 v[48:51], v[12:15], a[176:183], v3
  v_smfmac_f32_16x16x64_bf16 v[52:55], v[12:15], a[232:239], v3
  v_smfmac_f32_16x16x64_bf16 v[56:59], v[12:15], v[152:159], v3
  v_smfmac_f32_16x16x64_bf16 v[60:63], v[12:15], v[208:215], v3
  v_smfmac_f32_16x16x64_bf16 v[36:39], v[16:19], a[16:23], v3
  v_smfmac_f32_16x16x64_bf16 v[40:43], v[16:19], a[72:79], v3
  v_smfmac_f32_16x16x64_bf16 v[44:47], v[16:19], a[128:135], v3
  v_smfmac_f32_16x16x64_bf16 v[48:51], v[16:19], a[184:191], v3
  v_smfmac_f32_16x16x64_bf16 v[52:55], v[16:19], a[240:247], v3
  v_smfmac_f32_16x16x64_bf16 v[56:59], v[16:19], v[160:167], v3
  v_smfmac_f32_16x16x64_bf16 v[60:63], v[16:19], v[216:223], v3
  v_smfmac_f32_16x16x64_bf16 v[36:39], v[20:23], a[24:31], v3
  v_smfmac_f32_16x16x64_bf16 v[40:43], v[20:23], a[80:87], v3
  v_smfmac_f32_16x16x64_bf16 v[44:47], v[20:23], a[136:143], v3
  v_smfmac_f32_16x16x64_bf16 v[48:51], v[20:23], a[192:199], v3
  v_smfmac_f32_16x16x64_bf16 v[52:55], v[20:23], a[248:255], v3
  v_smfmac_f32_16x16x64_bf16 v[56:59], v[20:23], v[168:175], v3
  v_smfmac_f32_16x16x64_bf16 v[60:63], v[20:23], v[224:231], v3
  s_xor_b32 s58, s25, 28672
  s_add_u32 s59, s24, 28672
  s_add_u32 m0, s58, 21504
  s_branch cB_sc3_ph2
.p2align 6

cB_va0_loop:
  s_add_u32 s23, s20, 4096
  s_add_u32 s21, s20, 20480
  s_mov_b32 s30, 0
  s_cmp_lg_u32 s19, s38
  s_cbranch_scc1 cB_va0_vok
  s_branch cB_va0_voc
cB_va0_vow:
  s_sub_u32 s22, s39, s35
  v_lshlrev_b32 v63, 7, v2
  v_min_u32 v63, s22, v63
  buffer_load_dword v63, v63, s[8:11], s35 offen sc1
  s_waitcnt vmcnt(0)
cB_va0_voc:
  v_readfirstlane_b32 s22, v63
  s_cmp_eq_u32 s22, 56
  s_cbranch_scc1 cB_va0_vod
  s_sleep 1
  s_add_u32 s30, s30, 1
  s_cmp_lt_u32 s30, 400000
  s_cbranch_scc1 cB_va0_vow
  s_branch cB_abort
cB_va0_vod:
  s_add_u32 s35, s35, 2048
  s_add_u32 s38, s19, 8
  s_and_b32 s38, s38, -8
  s_cmp_eq_u32 s19, 0
  s_cselect_b32 s38, 4, s38
  v_cmp_ne_u32 vcc, 56, v63
  s_nop 3
  s_cmp_eq_u64 vcc, 0
  s_cselect_b32 s38, 99, s38
cB_va0_vok:
  s_cmp_eq_u32 s19, 63
  s_cbranch_scc1 cB_done
  s_barrier
  s_add_u32 s22, s25, 0
  buffer_load_dwordx4 v[80:83], v6, s[8:11], s22 offen offset:0 sc1
  buffer_load_dwordx4 v[84:87], v6, s[8:11], s22 offen offset:1792 sc1
  s_add_u32 s22, s25, 3584
  buffer_load_dwordx4 v[88:91], v6, s[8:11], s22 offen offset:0 sc1
  buffer_load_dwordx4 v[92:95], v6, s[8:11], s22 offen offset:1792 sc1
  s_add_u32 s22, s25, 7168
  buffer_load_dwordx4 v[96:99], v6, s[8:11], s22 offen offset:0 sc1
  buffer_load_dwordx4 v[100:103], v6, s[8:11], s22 offen offset:1792 sc1
  s_add_u32 s22, s25, 10752
  buffer_load_dwordx4 v[104:107], v6, s[8:11], s22 offen offset:0 sc1
  buffer_load_dwordx4 v[108:111], v6, s[8:11], s22 offen offset:1792 sc1
  s_add_u32 s22, s25, 14336
  buffer_load_dwordx4 v[112:115], v6, s[8:11], s22 offen offset:0 sc1
  buffer_load_dwordx4 v[116:119], v6, s[8:11], s22 offen offset:1792 sc1
  s_add_u32 s22, s25, 17920
  buffer_load_dwordx4 v[120:123], v6, s[8:11], s22 offen offset:0 sc1
  buffer_load_dwordx4 v[124:127], v6, s[8:11], s22 offen offset:1792 sc1
  s_add_u32 s22, s19, 1
  s_cmp_lg_u32 s22, s38
  s_cbranch_scc1 cB_va0_nk
  s_sub_u32 s22, s39, s35
  v_lshlrev_b32 v63, 7, v2
  v_min_u32 v63, s22, v63
  buffer_load_dword v63, v63, s[8:11], s35 offen sc1
cB_va0_nk:
  s_barrier
  ds_read_b128 v[8:11], v0 offset:8192
  ds_read_b128 v[12:15], v0 offset:9216
  ds_read_b128 v[16:19], v0 offset:10240
  ds_read_b128 v[20:23], v0 offset:11264
  ds_read_b128 v[24:27], v0 offset:12288
  ds_read_b128 v[28:31], v0 offset:13312
  ds_read_b128 v[32:35], v0 offset:14336
  s_waitcnt lgkmcnt(0)
  v_smfmac_f32_16x16x64_bf16 v[36:39], v[8:11], a[0:7], v3
  s_add_u32 s22, s25, 21504
  buffer_load_dwordx4 v[128:131], v6, s[8:11], s22 offen offset:0 sc1
  v_smfmac_f32_16x16x64_bf16 v[36:39], v[12:15], a[8:15], v3
  v_smfmac_f32_16x16x64_bf16 v[36:39], v[16:19], a[16:23], v3
  s_add_u32 s22, s25, 21504
  buffer_load_dwordx4 v[132:135], v6, s[8:11], s22 offen offset:1792 sc1
  v_smfmac_f32_16x16x64_bf16 v[36:39], v[20:23], a[24:31], v3
  v_smfmac_f32_16x16x64_bf16 v[36:39], v[24:27], a[32:39], v3
  s_add_u32 s22, s25, 25088
  buffer_load_dwordx4 v[136:139], v6, s[8:11], s22 offen offset:0 sc1
  v_smfmac_f32_16x16x64_bf16 v[36:39], v[28:31], a[40:47], v3
  v_smfmac_f32_16x16x64_bf16 v[36:39], v[32:35], a[48:55], v3
  s_add_u32 s22, s25, 25088
  buffer_load_dwordx4 v[140:143], v6, s[8:11], s22 offen offset:1792 sc1
  v_smfmac_f32_16x16x64_bf16 v[40:43], v[8:11], a[56:63], v3
  v_smfmac_f32_16x16x64_bf16 v[40:43], v[12:15], a[64:71], v3
  v_smfmac_f32_16x16x64_bf16 v[40:43], v[16:19], a[72:79], v3
  v_add_f32 v36, v36, v37
  v_smfmac_f32_16x16x64_bf16 v[40:43], v[20:23], a[80:87], v3
  v_add_f32 v38, v38, v39
  v_smfmac_f32_16x16x64_bf16 v[40:43], v[24:27], a[88:95], v3
  v_cvt_pk_bf16_f32 v36, v36, v38
  v_smfmac_f32_16x16x64_bf16 v[40:43], v[28:31], a[96:103], v3
  ds_write_b32 v60, v36
  v_smfmac_f32_16x16x64_bf16 v[40:43], v[32:35], a[104:111], v3
  v_smfmac_f32_16x16x64_bf16 v[44:47], v[8:11], a[112:119], v3
  v_smfmac_f32_16x16x64_bf16 v[44:47], v[12:15], a[120:127], v3
  v_smfmac_f32_16x16x64_bf16 v[44:47], v[16:19], a[128:135], v3
  v_add_f32 v40, v40, v41
  v_smfmac_f32_16x16x64_bf16 v[44:47], v[20:23], a[136:143], v3
  v_add_f32 v42, v42, v43
  v_smfmac_f32_16x16x64_bf16 v[44:47], v[24:27], a[144:151], v3
  v_cvt_pk_bf16_f32 v40, v40, v42
  v_smfmac_f32_16x16x64_bf16 v[44:47], v[28:31], a[152:159], v3
  ds_write_b32 v61, v40
  v_smfmac_f32_16x16x64_bf16 v[44:47], v[32:35], a[160:167], v3
  v_smfmac_f32_16x16x64_bf16 v[48:51], v[8:11], a[168:175], v3
  v_smfmac_f32_16x16x64_bf16 v[48:51], v[12:15], a[176:183], v3
  v_smfmac_f32_16x16x64_bf16 v[48:51], v[16:19], a[184:191], v3
  v_add_f32 v44, v44, v45
  v_smfmac_f32_16x16x64_bf16 v[48:51], v[20:23], a[192:199], v3
  v_add_f32 v46, v46, v47
  v_smfmac_f32_16x16x64_bf16 v[48:51], v[24:27], a[200:207], v3
  v_cvt_pk_bf16_f32 v44, v44, v46
  v_smfmac_f32_16x16x64_bf16 v[48:51], v[28:31], a[208:215], v3
  ds_write_b32 v62, v44
  v_smfmac_f32_16x16x64_bf16 v[48:51], v[32:35], a[216:223], v3
  v_smfmac_f32_16x16x64_bf16 v[52:55], v[8:11], a[224:231], v3
  v_smfmac_f32_16x16x64_bf16 v[52:55], v[12:15], a[232:239], v3
  v_smfmac_f32_16x16x64_bf16 v[52:55], v[16:19], a[240:247], v3
  v_add_f32 v48, v48, v49
  v_smfmac_f32_16x16x64_bf16 v[52:55], v[20:23], a[248:255], v3
  v_add_f32 v50, v50, v51
  v_smfmac_f32_16x16x64_bf16 v[52:55], v[24:27], v[176:183], v3
  v_cvt_pk_bf16_f32 v48, v48, v50
  v_smfmac_f32_16x16x64_bf16 v[52:55], v[28:31], v[184:191], v3
  ds_write_b32 v170, v48
  v_smfmac_f32_16x16x64_bf16 v[52:55], v[32:35], v[192:199], v3
  v_smfmac_f32_16x16x64_bf16 v[56:59], v[8:11], v[200:207], v3
  v_smfmac_f32_16x16x64_bf16 v[56:59], v[12:15], v[208:215], v3
  v_smfmac_f32_16x16x64_bf16 v[56:59], v[16:19], v[216:223], v3
  v_add_f32 v52, v52, v53
  v_smfmac_f32_16x16x64_bf16 v[56:59], v[20:23], v[224:231], v3
  v_add_f32 v54, v54, v55
  v_smfmac_f32_16x16x64_bf16 v[56:59], v[24:27], v[232:239], v3
  v_cvt_pk_bf16_f32 v52, v52, v54
  v_smfmac_f32_16x16x64_bf16 v[56:59], v[28:31], v[240:247], v3
  ds_write_b32 v171, v52
  v_smfmac_f32_16x16x64_bf16 v[56:59], v[32:35], v[248:255], v3
  s_nop 7
  v_add_f32 v56, v56, v57
  v_add_f32 v58, v58, v59
  v_cvt_pk_bf16_f32 v56, v56, v58
  ds_write_b32 v172, v56
  buffer_load_dword v164, v4, s[8:11], s20 offen sc1
  s_waitcnt lgkmcnt(0)
  v_mov_b32 v36, 0
  v_mov_b32 v37, 0
  v_mov_b32 v38, 0
  v_mov_b32 v39, 0
  v_mov_b32 v40, 0
  v_mov_b32 v41, 0
  v_mov_b32 v42, 0
  v_mov_b32 v43, 0
  buffer_load_dword v165, v4, s[8:11], s20 offen sc1
  v_mov_b32 v44, 0
  v_mov_b32 v45, 0
  v_mov_b32 v46, 0
  v_mov_b32 v47, 0
  v_mov_b32 v48, 0
  v_mov_b32 v49, 0
  v_mov_b32 v50, 0
  v_mov_b32 v51, 0
  buffer_load_dword v166, v4, s[8:11], s20 offen sc1
  v_mov_b32 v52, 0
  v_mov_b32 v53, 0
  v_mov_b32 v54, 0
  v_mov_b32 v55, 0
  v_mov_b32 v56, 0
  v_mov_b32 v57, 0
  v_mov_b32 v58, 0
  v_mov_b32 v59, 0
  buffer_load_dword v167, v4, s[8:11], s20 offen sc1
  s_cmp_eq_u32 s19, 63
  s_cbranch_scc1 cB_va0_last
  s_add_u32 s22, s20, 9216
  s_add_u32 s34, s20, 13312
  s_add_u32 s36, s20, 7168
  s_mov_b32 s37, 0
  v_mov_b32 v156, 0
  v_mov_b32 v157, 0
  v_mov_b32 v158, 0
  v_mov_b32 v159, 0
  buffer_load_dword v168, v4, s[8:11], s20 offen sc1
cB_va0_fw_l:
  s_waitcnt vmcnt(4)
  v_cmp_eq_u32 vcc, -1, v164
  s_cbranch_vccz cB_va0_fw_d
  buffer_load_dword v164, v4, s[8:11], s20 offen sc1
  s_waitcnt vmcnt(4)
  v_cmp_eq_u32 vcc, -1, v165
  s_cbranch_vccz cB_va0_fw_d
  buffer_load_dword v165, v4, s[8:11], s20 offen sc1
  s_waitcnt vmcnt(4)
  v_cmp_eq_u32 vcc, -1, v166
  s_cbranch_vccz cB_va0_fw_d
  buffer_load_dword v166, v4, s[8:11], s20 offen sc1
  s_waitcnt vmcnt(4)
  v_cmp_eq_u32 vcc, -1, v167
  s_cbranch_vccz cB_va0_fw_d
  buffer_load_dword v167, v4, s[8:11], s20 offen sc1
  s_waitcnt vmcnt(4)
  v_cmp_eq_u32 vcc, -1, v168
  s_cbranch_vccz cB_va0_fw_d
  buffer_load_dword v168, v4, s[8:11], s20 offen sc1
  s_add_u32 s30, s30, 1
  s_cmp_lt_u32 s30, 400000
  s_cbranch_scc1 cB_va0_fw_l
  s_branch cB_abort
cB_va0_fw_d:
  s_waitcnt lgkmcnt(0)
  buffer_load_dwordx4 v[8:11], v5, s[8:11], s22 offen offset:0 sc1
  buffer_load_dwordx4 v[12:15], v5, s[8:11], s22 offen offset:1024 sc1
  buffer_load_dwordx4 v[16:19], v5, s[8:11], s22 offen offset:2048 sc1
  buffer_load_dwordx4 v[20:23], v5, s[8:11], s22 offen offset:3072 sc1
  buffer_load_dwordx4 v[24:27], v5, s[8:11], s34 offen offset:0 sc1
  buffer_load_dwordx4 v[28:31], v5, s[8:11], s34 offen offset:1024 sc1
  buffer_load_dwordx4 v[32:35], v5, s[8:11], s34 offen offset:2048 sc1
  buffer_load_dwordx4 v[144:147], v5, s[8:11], s34 offen offset:3072 sc1
  buffer_load_dwordx4 v[148:151], v2, s[8:11], s36 offen offset:0 sc1
  buffer_load_dwordx4 v[152:155], v2, s[8:11], s36 offen offset:1024 sc1
  s_barrier
  ds_read_b128 v[64:67], v2 offset:0
  ds_read_b128 v[68:71], v2 offset:1024
  ds_read_b128 v[72:75], v2 offset:2048
  ds_read_b128 v[76:79], v2 offset:3072
  s_waitcnt vmcnt(9)
  v_smfmac_f32_16x16x64_bf16 v[156:159], v[8:11], v[80:87], v3
  s_waitcnt vmcnt(8)
  v_smfmac_f32_16x16x64_bf16 v[156:159], v[12:15], v[88:95], v3
  s_waitcnt vmcnt(7)
  v_smfmac_f32_16x16x64_bf16 v[156:159], v[16:19], v[96:103], v3
  s_waitcnt vmcnt(6)
  v_smfmac_f32_16x16x64_bf16 v[156:159], v[20:23], v[104:111], v3
  s_waitcnt vmcnt(5)
  v_smfmac_f32_16x16x64_bf16 v[156:159], v[24:27], v[112:119], v3
  s_waitcnt vmcnt(4)
  v_smfmac_f32_16x16x64_bf16 v[156:159], v[28:31], v[120:127], v3
  s_waitcnt vmcnt(3)
  v_smfmac_f32_16x16x64_bf16 v[156:159], v[32:35], v[128:135], v3
  s_waitcnt vmcnt(2)
  v_smfmac_f32_16x16x64_bf16 v[156:159], v[144:147], v[136:143], v3
  s_waitcnt vmcnt(1) lgkmcnt(0)
  v_smfmac_f32_16x16x64_bf16 v[156:159], v[148:151], v[64:71], v3
  s_waitcnt vmcnt(0)
  v_smfmac_f32_16x16x64_bf16 v[156:159], v[152:155], v[72:79], v3
cB_va0_ep:
  s_nop 7
  v_add_f32 v160, v156, v157
  v_add_f32 v161, v158, v159
  v_cmp_u_f32 vcc, v160, v161
  v_mov_b32_dpp v162, v160 row_ror:8 row_mask:0xf bank_mask:0xf
  v_mov_b32_dpp v160, v161 row_ror:8 row_mask:0xf bank_mask:0xc
  s_cbranch_vccnz cB_va0_rp
  v_mov_b32_dpp v161, v162 quad_perm:[0,1,2,3] row_mask:0xf bank_mask:0x3
  v_cvt_pk_bf16_f32 v160, v160, v161
cB_va0_pc:
  buffer_store_dword v160, v1, s[8:11], s21 offen sc1
  s_cmp_lg_u32 s19, 62
  s_cbranch_scc1 cB_va0_nl
  s_mov_b32 s22, 88531968
  buffer_store_dword v160, v1, s[8:11], s22 offen sc1
  s_mov_b64 exec, -1
  s_branch cB_done
cB_va0_nl:
  s_mov_b64 exec, -1
  s_add_u32 s25, s25, 28672
  s_add_u32 s19, s19, 1
  s_mov_b32 s20, s21
  s_branch cB_va0_loop
cB_va0_last:
  s_waitcnt lgkmcnt(0)
  s_barrier
  s_branch cB_done
cB_va0_rp:
  s_cmp_eq_u32 s37, 0
  s_cbranch_scc1 cB_va0_rv
  v_mov_b32_dpp v161, v162 quad_perm:[0,1,2,3] row_mask:0xf bank_mask:0x3
  v_cvt_pk_bf16_f32 v160, v160, v161
  v_min_u32 v160, -2, v160
  s_branch cB_va0_pc
cB_va0_rv:
  buffer_load_dwordx4 v[8:11], v5, s[8:11], s22 offen offset:0 sc1
  buffer_load_dwordx4 v[12:15], v5, s[8:11], s22 offen offset:1024 sc1
  buffer_load_dwordx4 v[16:19], v5, s[8:11], s22 offen offset:2048 sc1
  buffer_load_dwordx4 v[20:23], v5, s[8:11], s22 offen offset:3072 sc1
  buffer_load_dwordx4 v[24:27], v5, s[8:11], s34 offen offset:0 sc1
  buffer_load_dwordx4 v[28:31], v5, s[8:11], s34 offen offset:1024 sc1
  buffer_load_dwordx4 v[32:35], v5, s[8:11], s34 offen offset:2048 sc1
  buffer_load_dwordx4 v[144:147], v5, s[8:11], s34 offen offset:3072 sc1
  buffer_load_dwordx4 v[148:151], v2, s[8:11], s36 offen offset:0 sc1
  buffer_load_dwordx4 v[152:155], v2, s[8:11], s36 offen offset:1024 sc1
  s_waitcnt vmcnt(0)
  v_max3_u32 v175, v8, v9, v10
  v_max3_u32 v175, v175, v11, v12
  v_max3_u32 v175, v175, v13, v14
  v_max3_u32 v175, v175, v15, v16
  v_max3_u32 v175, v175, v17, v18
  v_max3_u32 v175, v175, v19, v20
  v_max3_u32 v175, v175, v21, v22
  v_max3_u32 v175, v175, v23, v24
  v_max3_u32 v175, v175, v25, v26
  v_max3_u32 v175, v175, v27, v28
  v_max3_u32 v175, v175, v29, v30
  v_max3_u32 v175, v175, v31, v32
  v_max3_u32 v175, v175, v33, v34
  v_max3_u32 v175, v175, v35, v144
  v_max3_u32 v175, v175, v145, v146
  v_max3_u32 v175, v175, v147, v148
  v_max3_u32 v175, v175, v149, v150
  v_max3_u32 v175, v175, v151, v152
  v_max3_u32 v175, v175, v153, v154
  v_max_u32 v175, v175, v155
  v_cmp_eq_u32 vcc, -1, v175
  s_cbranch_vccz cB_va0_rk
  s_add_u32 s30, s30, 1
  s_cmp_lt_u32 s30, 400000
  s_cbranch_scc1 cB_va0_rv
  s_branch cB_abort
cB_va0_rk:
  s_mov_b32 s37, 1
  s_add_u32 s31, s31, 0x10000
  v_mov_b32 v156, 0
  v_mov_b32 v157, 0
  v_mov_b32 v158, 0
  v_mov_b32 v159, 0
  s_nop 1
  v_smfmac_f32_16x16x64_bf16 v[156:159], v[8:11], v[80:87], v3
  v_smfmac_f32_16x16x64_bf16 v[156:159], v[12:15], v[88:95], v3
  v_smfmac_f32_16x16x64_bf16 v[156:159], v[16:19], v[96:103], v3
  v_smfmac_f32_16x16x64_bf16 v[156:159], v[20:23], v[104:111], v3
  v_smfmac_f32_16x16x64_bf16 v[156:159], v[24:27], v[112:119], v3
  v_smfmac_f32_16x16x64_bf16 v[156:159], v[28:31], v[120:127], v3
  v_smfmac_f32_16x16x64_bf16 v[156:159], v[32:35], v[128:135], v3
  v_smfmac_f32_16x16x64_bf16 v[156:159], v[144:147], v[136:143], v3
  v_smfmac_f32_16x16x64_bf16 v[156:159], v[148:151], v[64:71], v3
  v_smfmac_f32_16x16x64_bf16 v[156:159], v[152:155], v[72:79], v3
  s_nop 7
  s_branch cB_va0_ep
.p2align 6

cB_va1_loop:
  s_add_u32 s23, s20, 4096
  s_add_u32 s21, s20, 20480
  s_mov_b32 s30, 0
  s_cmp_lg_u32 s19, s38
  s_cbranch_scc1 cB_va1_vok
  s_branch cB_va1_voc
cB_va1_vow:
  s_sub_u32 s22, s39, s35
  v_lshlrev_b32 v63, 7, v2
  v_min_u32 v63, s22, v63
  buffer_load_dword v63, v63, s[8:11], s35 offen sc1
  s_waitcnt vmcnt(0)
cB_va1_voc:
  v_readfirstlane_b32 s22, v63
  s_cmp_eq_u32 s22, 56
  s_cbranch_scc1 cB_va1_vod
  s_sleep 1
  s_add_u32 s30, s30, 1
  s_cmp_lt_u32 s30, 400000
  s_cbranch_scc1 cB_va1_vow
  s_branch cB_abort
cB_va1_vod:
  s_add_u32 s35, s35, 2048
  s_add_u32 s38, s19, 8
  s_and_b32 s38, s38, -8
  s_cmp_eq_u32 s19, 0
  s_cselect_b32 s38, 4, s38
  v_cmp_ne_u32 vcc, 56, v63
  s_nop 3
  s_cmp_eq_u64 vcc, 0
  s_cselect_b32 s38, 99, s38
cB_va1_vok:
  s_cmp_eq_u32 s19, 63
  s_cbranch_scc1 cB_done
  s_barrier
  s_add_u32 s22, s25, 0
  buffer_load_dwordx4 v[80:83], v6, s[8:11], s22 offen offset:0 sc1
  buffer_load_dwordx4 v[84:87], v6, s[8:11], s22 offen offset:1792 sc1
  s_add_u32 s22, s25, 3584
  buffer_load_dwordx4 v[88:91], v6, s[8:11], s22 offen offset:0 sc1
  buffer_load_dwordx4 v[92:95], v6, s[8:11], s22 offen offset:1792 sc1
  s_add_u32 s22, s25, 7168
  buffer_load_dwordx4 v[96:99], v6, s[8:11], s22 offen offset:0 sc1
  buffer_load_dwordx4 v[100:103], v6, s[8:11], s22 offen offset:1792 sc1
  s_add_u32 s22, s25, 10752
  buffer_load_dwordx4 v[104:107], v6, s[8:11], s22 offen offset:0 sc1
  buffer_load_dwordx4 v[108:111], v6, s[8:11], s22 offen offset:1792 sc1
  s_add_u32 s22, s25, 14336
  buffer_load_dwordx4 v[112:115], v6, s[8:11], s22 offen offset:0 sc1
  buffer_load_dwordx4 v[116:119], v6, s[8:11], s22 offen offset:1792 sc1
  s_add_u32 s22, s25, 17920
  buffer_load_dwordx4 v[120:123], v6, s[8:11], s22 offen offset:0 sc1
  buffer_load_dwordx4 v[124:127], v6, s[8:11], s22 offen offset:1792 sc1
  s_add_u32 s22, s19, 1
  s_cmp_lg_u32 s22, s38
  s_cbranch_scc1 cB_va1_nk
  s_sub_u32 s22, s39, s35
  v_lshlrev_b32 v63, 7, v2
  v_min_u32 v63, s22, v63
  buffer_load_dword v63, v63, s[8:11], s35 offen sc1
cB_va1_nk:
  s_barrier
  ds_read_b128 v[8:11], v0 offset:8192
  ds_read_b128 v[12:15], v0 offset:9216
  ds_read_b128 v[16:19], v0 offset:10240
  ds_read_b128 v[20:23], v0 offset:11264
  ds_read_b128 v[24:27], v0 offset:12288
  ds_read_b128 v[28:31], v0 offset:13312
  ds_read_b128 v[32:35], v0 offset:14336
  s_waitcnt lgkmcnt(0)
  v_smfmac_f32_16x16x64_bf16 v[36:39], v[8:11], a[0:7], v3
  s_add_u32 s22, s25, 21504
  buffer_load_dwordx4 v[128:131], v6, s[8:11], s22 offen offset:0 sc1
  v_smfmac_f32_16x16x64_bf16 v[36:39], v[12:15], a[8:15], v3
  v_smfmac_f32_16x16x64_bf16 v[36:39], v[16:19], a[16:23], v3
  s_add_u32 s22, s25, 21504
  buffer_load_dwordx4 v[132:135], v6, s[8:11], s22 offen offset:1792 sc1
  v_smfmac_f32_16x16x64_bf16 v[36:39], v[20:23], a[24:31], v3
  v_smfmac_f32_16x16x64_bf16 v[36:39], v[24:27], a[32:39], v3
  s_add_u32 s22, s25, 25088
  buffer_load_dwordx4 v[136:139], v6, s[8:11], s22 offen offset:0 sc1
  v_smfmac_f32_16x16x64_bf16 v[36:39], v[28:31], a[40:47], v3
  v_smfmac_f32_16x16x64_bf16 v[36:39], v[32:35], a[48:55], v3
  s_add_u32 s22, s25, 25088
  buffer_load_dwordx4 v[140:143], v6, s[8:11], s22 offen offset:1792 sc1
  v_smfmac_f32_16x16x64_bf16 v[40:43], v[8:11], a[56:63], v3
  v_smfmac_f32_16x16x64_bf16 v[40:43], v[12:15], a[64:71], v3
  v_smfmac_f32_16x16x64_bf16 v[40:43], v[16:19], a[72:79], v3
  v_add_f32 v36, v36, v37
  v_smfmac_f32_16x16x64_bf16 v[40:43], v[20:23], a[80:87], v3
  v_add_f32 v38, v38, v39
  v_smfmac_f32_16x16x64_bf16 v[40:43], v[24:27], a[88:95], v3
  v_cvt_pk_bf16_f32 v36, v36, v38
  v_smfmac_f32_16x16x64_bf16 v[40:43], v[28:31], a[96:103], v3
  ds_write_b32 v60, v36
  v_smfmac_f32_16x16x64_bf16 v[40:43], v[32:35], a[104:111], v3
  v_smfmac_f32_16x16x64_bf16 v[44:47], v[8:11], a[112:119], v3
  v_smfmac_f32_16x16x64_bf16 v[44:47], v[12:15], a[120:127], v3
  v_smfmac_f32_16x16x64_bf16 v[44:47], v[16:19], a[128:135], v3
  v_add_f32 v40, v40, v41
  v_smfmac_f32_16x16x64_bf16 v[44:47], v[20:23], a[136:143], v3
  v_add_f32 v42, v42, v43
  v_smfmac_f32_16x16x64_bf16 v[44:47], v[24:27], a[144:151], v3
  v_cvt_pk_bf16_f32 v40, v40, v42
  v_smfmac_f32_16x16x64_bf16 v[44:47], v[28:31], a[152:159], v3
  ds_write_b32 v61, v40
  v_smfmac_f32_16x16x64_bf16 v[44:47], v[32:35], a[160:167], v3
  v_smfmac_f32_16x16x64_bf16 v[48:51], v[8:11], a[168:175], v3
  v_smfmac_f32_16x16x64_bf16 v[48:51], v[12:15], a[176:183], v3
  v_smfmac_f32_16x16x64_bf16 v[48:51], v[16:19], a[184:191], v3
  v_add_f32 v44, v44, v45
  v_smfmac_f32_16x16x64_bf16 v[48:51], v[20:23], a[192:199], v3
  v_add_f32 v46, v46, v47
  v_smfmac_f32_16x16x64_bf16 v[48:51], v[24:27], a[200:207], v3
  v_cvt_pk_bf16_f32 v44, v44, v46
  v_smfmac_f32_16x16x64_bf16 v[48:51], v[28:31], a[208:215], v3
  ds_write_b32 v62, v44
  v_smfmac_f32_16x16x64_bf16 v[48:51], v[32:35], a[216:223], v3
  v_smfmac_f32_16x16x64_bf16 v[52:55], v[8:11], a[224:231], v3
  v_smfmac_f32_16x16x64_bf16 v[52:55], v[12:15], a[232:239], v3
  v_smfmac_f32_16x16x64_bf16 v[52:55], v[16:19], a[240:247], v3
  v_add_f32 v48, v48, v49
  v_smfmac_f32_16x16x64_bf16 v[52:55], v[20:23], a[248:255], v3
  v_add_f32 v50, v50, v51
  v_smfmac_f32_16x16x64_bf16 v[52:55], v[24:27], v[176:183], v3
  v_cvt_pk_bf16_f32 v48, v48, v50
  v_smfmac_f32_16x16x64_bf16 v[52:55], v[28:31], v[184:191], v3
  ds_write_b32 v170, v48
  v_smfmac_f32_16x16x64_bf16 v[52:55], v[32:35], v[192:199], v3
  v_smfmac_f32_16x16x64_bf16 v[56:59], v[8:11], v[200:207], v3
  v_smfmac_f32_16x16x64_bf16 v[56:59], v[12:15], v[208:215], v3
  v_smfmac_f32_16x16x64_bf16 v[56:59], v[16:19], v[216:223], v3
  v_add_f32 v52, v52, v53
  v_smfmac_f32_16x16x64_bf16 v[56:59], v[20:23], v[224:231], v3
  v_add_f32 v54, v54, v55
  v_smfmac_f32_16x16x64_bf16 v[56:59], v[24:27], v[232:239], v3
  v_cvt_pk_bf16_f32 v52, v52, v54
  v_smfmac_f32_16x16x64_bf16 v[56:59], v[28:31], v[240:247], v3
  ds_write_b32 v171, v52
  v_smfmac_f32_16x16x64_bf16 v[56:59], v[32:35], v[248:255], v3
  s_nop 7
  v_add_f32 v56, v56, v57
  v_add_f32 v58, v58, v59
  v_cvt_pk_bf16_f32 v56, v56, v58
  ds_write_b32 v172, v56
  s_waitcnt lgkmcnt(0)
  v_mov_b32 v36, 0
  v_mov_b32 v37, 0
  v_mov_b32 v38, 0
  v_mov_b32 v39, 0
  v_mov_b32 v40, 0
  v_mov_b32 v41, 0
  v_mov_b32 v42, 0
  v_mov_b32 v43, 0
  v_mov_b32 v44, 0
  v_mov_b32 v45, 0
  v_mov_b32 v46, 0
  v_mov_b32 v47, 0
  v_mov_b32 v48, 0
  v_mov_b32 v49, 0
  v_mov_b32 v50, 0
  v_mov_b32 v51, 0
  v_mov_b32 v52, 0
  v_mov_b32 v53, 0
  v_mov_b32 v54, 0
  v_mov_b32 v55, 0
  v_mov_b32 v56, 0
  v_mov_b32 v57, 0
  v_mov_b32 v58, 0
  v_mov_b32 v59, 0
  s_cmp_eq_u32 s19, 63
  s_cbranch_scc1 cB_va1_last
  s_add_u32 s22, s20, 9216
  s_add_u32 s34, s20, 13312
  s_add_u32 s36, s20, 7168
  s_mov_b32 s37, 0
  v_mov_b32 v156, 0
  v_mov_b32 v157, 0
  v_mov_b32 v158, 0
  v_mov_b32 v159, 0
  s_barrier
  s_waitcnt lgkmcnt(0)
  buffer_load_dwordx4 v[8:11], v5, s[8:11], s22 offen offset:0 sc1
  buffer_load_dwordx4 v[12:15], v5, s[8:11], s22 offen offset:1024 sc1
  buffer_load_dwordx4 v[16:19], v5, s[8:11], s22 offen offset:2048 sc1
  buffer_load_dwordx4 v[20:23], v5, s[8:11], s22 offen offset:3072 sc1
  buffer_load_dwordx4 v[24:27], v5, s[8:11], s34 offen offset:0 sc1
  buffer_load_dwordx4 v[28:31], v5, s[8:11], s34 offen offset:1024 sc1
  buffer_load_dwordx4 v[32:35], v5, s[8:11], s34 offen offset:2048 sc1
  buffer_load_dwordx4 v[144:147], v5, s[8:11], s34 offen offset:3072 sc1
  s_sub_u32 s23, s21, 4
  s_mov_b64 exec, 65535
  buffer_store_dword v2, v7, s[8:11], s23 offen sc1
  s_mov_b64 exec, -1
  buffer_load_dwordx4 v[148:151], v2, s[8:11], s36 offen offset:0 sc1
  buffer_load_dwordx4 v[152:155], v2, s[8:11], s36 offen offset:1024 sc1
  ds_read_b128 v[64:67], v2 offset:4096
  ds_read_b128 v[68:71], v2 offset:5120
  ds_read_b128 v[72:75], v2 offset:6144
  ds_read_b128 v[76:79], v2 offset:7168
  s_waitcnt vmcnt(10)
  v_smfmac_f32_16x16x64_bf16 v[156:159], v[8:11], v[80:87], v3
  s_waitcnt vmcnt(9)
  v_smfmac_f32_16x16x64_bf16 v[156:159], v[12:15], v[88:95], v3
  s_waitcnt vmcnt(8)
  v_smfmac_f32_16x16x64_bf16 v[156:159], v[16:19], v[96:103], v3
  s_waitcnt vmcnt(7)
  v_smfmac_f32_16x16x64_bf16 v[156:159], v[20:23], v[104:111], v3
  s_waitcnt vmcnt(6)
  v_smfmac_f32_16x16x64_bf16 v[156:159], v[24:27], v[112:119], v3
  s_mov_b64 exec, 65535
  buffer_store_dword v2, v7, s[8:11], s21 offen sc1
  s_mov_b64 exec, -1
  s_waitcnt vmcnt(6)
  v_smfmac_f32_16x16x64_bf16 v[156:159], v[28:31], v[120:127], v3
  s_waitcnt vmcnt(5)
  v_smfmac_f32_16x16x64_bf16 v[156:159], v[32:35], v[128:135], v3
  s_waitcnt vmcnt(4)
  v_smfmac_f32_16x16x64_bf16 v[156:159], v[144:147], v[136:143], v3
  s_waitcnt vmcnt(2) lgkmcnt(0)
  v_smfmac_f32_16x16x64_bf16 v[156:159], v[148:151], v[64:71], v3
  s_waitcnt vmcnt(1)
  v_smfmac_f32_16x16x64_bf16 v[156:159], v[152:155], v[72:79], v3
cB_va1_ep:
  s_nop 7
  v_add_f32 v160, v156, v157
  v_add_f32 v161, v158, v159
  v_cmp_u_f32 vcc, v160, v161
  v_mov_b32_dpp v162, v160 row_ror:8 row_mask:0xf bank_mask:0xf
  v_mov_b32_dpp v160, v161 row_ror:8 row_mask:0xf bank_mask:0xc
  s_cbranch_vccnz cB_va1_rp
  v_mov_b32_dpp v161, v162 quad_perm:[0,1,2,3] row_mask:0xf bank_mask:0x3
  v_cvt_pk_bf16_f32 v160, v160, v161
cB_va1_pc:
  s_mov_b64 exec, s[26:27]
  buffer_store_dword v160, v1, s[8:11], s21 offen sc1
  s_cmp_lg_u32 s19, 62
  s_cbranch_scc1 cB_va1_nl
  s_mov_b32 s22, 88531968
  buffer_store_dword v160, v1, s[8:11], s22 offen sc1
  s_mov_b64 exec, -1
  s_branch cB_done
cB_va1_nl:
  s_mov_b64 exec, -1
  s_cmp_lg_u32 s19, 0
  s_cbranch_scc1 cB_va1_s0
  v_add_u32 v7, 512, v7
  v_lshl_add_u32 v7, v2, 3, v7
  s_mov_b64 exec, 65535
  buffer_store_dword v2, v7, s[8:11], s21 offen sc1
  buffer_store_dword v2, v7, s[8:11], s23 offen sc1
  s_mov_b64 exec, -1
cB_va1_s0:
  s_add_u32 s25, s25, 28672
  s_add_u32 s19, s19, 1
  s_mov_b32 s20, s21
  s_branch cB_va1_loop
cB_va1_last:
  s_waitcnt lgkmcnt(0)
  s_barrier
  s_branch cB_done
cB_va1_rp:
  s_cmp_eq_u32 s37, 0
  s_cbranch_scc1 cB_va1_rv
  v_mov_b32_dpp v161, v162 quad_perm:[0,1,2,3] row_mask:0xf bank_mask:0x3
  v_cvt_pk_bf16_f32 v160, v160, v161
  v_min_u32 v160, -2, v160
  s_branch cB_va1_pc
cB_va1_rv:
  buffer_load_dwordx4 v[8:11], v5, s[8:11], s22 offen offset:0 sc1
  buffer_load_dwordx4 v[12:15], v5, s[8:11], s22 offen offset:1024 sc1
  buffer_load_dwordx4 v[16:19], v5, s[8:11], s22 offen offset:2048 sc1
  buffer_load_dwordx4 v[20:23], v5, s[8:11], s22 offen offset:3072 sc1
  buffer_load_dwordx4 v[24:27], v5, s[8:11], s34 offen offset:0 sc1
  buffer_load_dwordx4 v[28:31], v5, s[8:11], s34 offen offset:1024 sc1
  buffer_load_dwordx4 v[32:35], v5, s[8:11], s34 offen offset:2048 sc1
  buffer_load_dwordx4 v[144:147], v5, s[8:11], s34 offen offset:3072 sc1
  buffer_load_dwordx4 v[148:151], v2, s[8:11], s36 offen offset:0 sc1
  buffer_load_dwordx4 v[152:155], v2, s[8:11], s36 offen offset:1024 sc1
  s_waitcnt vmcnt(0)
  v_max3_u32 v175, v8, v9, v10
  v_max3_u32 v175, v175, v11, v12
  v_max3_u32 v175, v175, v13, v14
  v_max3_u32 v175, v175, v15, v16
  v_max3_u32 v175, v175, v17, v18
  v_max3_u32 v175, v175, v19, v20
  v_max3_u32 v175, v175, v21, v22
  v_max3_u32 v175, v175, v23, v24
  v_max3_u32 v175, v175, v25, v26
  v_max3_u32 v175, v175, v27, v28
  v_max3_u32 v175, v175, v29, v30
  v_max3_u32 v175, v175, v31, v32
  v_max3_u32 v175, v175, v33, v34
  v_max3_u32 v175, v175, v35, v144
  v_max3_u32 v175, v175, v145, v146
  v_max3_u32 v175, v175, v147, v148
  v_max3_u32 v175, v175, v149, v150
  v_max3_u32 v175, v175, v151, v152
  v_max3_u32 v175, v175, v153, v154
  v_max_u32 v175, v175, v155
  v_cmp_eq_u32 vcc, -1, v175
  s_cbranch_vccz cB_va1_rk
  s_add_u32 s30, s30, 1
  s_cmp_lt_u32 s30, 400000
  s_cbranch_scc1 cB_va1_rv
  s_branch cB_abort
cB_va1_rk:
  s_mov_b32 s37, 1
  s_add_u32 s31, s31, 0x10000
  v_mov_b32 v156, 0
  v_mov_b32 v157, 0
  v_mov_b32 v158, 0
  v_mov_b32 v159, 0
  s_nop 1
  v_smfmac_f32_16x16x64_bf16 v[156:159], v[8:11], v[80:87], v3
  v_smfmac_f32_16x16x64_bf16 v[156:159], v[12:15], v[88:95], v3
  v_smfmac_f32_16x16x64_bf16 v[156:159], v[16:19], v[96:103], v3
  v_smfmac_f32_16x16x64_bf16 v[156:159], v[20:23], v[104:111], v3
  v_smfmac_f32_16x16x64_bf16 v[156:159], v[24:27], v[112:119], v3
  v_smfmac_f32_16x16x64_bf16 v[156:159], v[28:31], v[120:127], v3
  v_smfmac_f32_16x16x64_bf16 v[156:159], v[32:35], v[128:135], v3
  v_smfmac_f32_16x16x64_bf16 v[156:159], v[144:147], v[136:143], v3
  v_smfmac_f32_16x16x64_bf16 v[156:159], v[148:151], v[64:71], v3
  v_smfmac_f32_16x16x64_bf16 v[156:159], v[152:155], v[72:79], v3
  s_nop 7
  s_branch cB_va1_ep
.p2align 6

cB_va2_loop:
  s_add_u32 s23, s20, 4096
  s_add_u32 s21, s20, 20480
  v_mov_b32 v36, 0
  v_mov_b32 v37, 0
  v_mov_b32 v38, 0
  v_mov_b32 v39, 0
  v_mov_b32 v40, 0
  v_mov_b32 v41, 0
  v_mov_b32 v42, 0
  v_mov_b32 v43, 0
  v_mov_b32 v44, 0
  v_mov_b32 v45, 0
  v_mov_b32 v46, 0
  v_mov_b32 v47, 0
  v_mov_b32 v48, 0
  v_mov_b32 v49, 0
  v_mov_b32 v50, 0
  v_mov_b32 v51, 0
  v_mov_b32 v52, 0
  v_mov_b32 v53, 0
  v_mov_b32 v54, 0
  v_mov_b32 v55, 0
  v_mov_b32 v56, 0
  v_mov_b32 v57, 0
  v_mov_b32 v58, 0
  v_mov_b32 v59, 0
  v_mov_b32 v60, 0
  v_mov_b32 v61, 0
  v_mov_b32 v62, 0
  v_mov_b32 v63, 0
  v_mov_b32 v64, 0
  v_mov_b32 v65, 0
  v_mov_b32 v66, 0
  v_mov_b32 v67, 0
  s_mov_b32 s30, 0
  buffer_load_dword v76, v119, s[8:11], s20 offen sc1
  buffer_load_dword v77, v119, s[8:11], s20 offen sc1
  buffer_load_dword v78, v119, s[8:11], s20 offen sc1
cB_va2_fp_l:
  s_waitcnt vmcnt(2)
  v_cmp_eq_u32 vcc, -1, v76
  s_cbranch_vccz cB_va2_fp_d
  buffer_load_dword v76, v119, s[8:11], s20 offen sc1
  s_waitcnt vmcnt(2)
  v_cmp_eq_u32 vcc, -1, v77
  s_cbranch_vccz cB_va2_fp_d
  buffer_load_dword v77, v119, s[8:11], s20 offen sc1
  s_waitcnt vmcnt(2)
  v_cmp_eq_u32 vcc, -1, v78
  s_cbranch_vccz cB_va2_fp_d
  buffer_load_dword v78, v119, s[8:11], s20 offen sc1
  s_add_u32 s30, s30, 1
  s_cmp_lt_u32 s30, 400000
  s_cbranch_scc1 cB_va2_fp_l
  s_branch cB_abort
cB_va2_fp_d:
  s_nop 15
  s_nop 3
  buffer_load_dwordx4 v[8:11], v2, s[8:11], s20 offen offset:0 sc1
  buffer_load_dwordx4 v[12:15], v2, s[8:11], s20 offen offset:1024 sc1
  buffer_load_dwordx4 v[16:19], v2, s[8:11], s20 offen offset:2048 sc1
  buffer_load_dwordx4 v[20:23], v2, s[8:11], s20 offen offset:3072 sc1
  s_barrier
cB_va2_ld:
  s_waitcnt vmcnt(0)
  v_max3_u32 v84, v8, v9, v10
  v_max3_u32 v84, v84, v11, v12
  v_max3_u32 v84, v84, v13, v14
  v_max3_u32 v84, v84, v15, v16
  v_max3_u32 v84, v84, v17, v18
  v_max3_u32 v84, v84, v19, v20
  v_max3_u32 v84, v84, v21, v22
  v_max_u32 v84, v84, v23
  v_cmp_eq_u32 vcc, -1, v84
  ds_write_b128 v2, v[8:11] offset:8192
  ds_write_b128 v2, v[12:15] offset:9216
  ds_write_b128 v2, v[16:19] offset:10240
  ds_write_b128 v2, v[20:23] offset:11264
  s_cbranch_vccnz cB_va2_retry
  s_waitcnt lgkmcnt(0)
  s_barrier
  ds_read_b128 v[8:11], v5 offset:8192
  ds_read_b128 v[12:15], v5 offset:9216
  ds_read_b128 v[16:19], v5 offset:10240
  ds_read_b128 v[20:23], v5 offset:11264
  ds_read_b128 v[24:27], v5 offset:12288
  ds_read_b128 v[28:31], v5 offset:13312
  ds_read_b128 v[32:35], v5 offset:14336
  ds_read_b128 v[92:95], v0
  s_waitcnt lgkmcnt(0)
  s_mov_b64 exec, s[26:27]
  buffer_store_dwordx4 v[92:95], v2, s[8:11], s36 offen sc1
  s_mov_b64 exec, -1
  s_add_u32 s36, s36, 7168
  s_cmp_eq_u32 s19, 63
  s_cbranch_scc1 cB_done
  ds_read_b128 v[76:79], v1 offset:0
  ds_read_b128 v[80:83], v1 offset:1024
  ds_read_b128 v[84:87], v1 offset:2048
  ds_read_b128 v[88:91], v1 offset:3072
  ds_read_b128 v[92:95], v1 offset:4096
  ds_read_b128 v[96:99], v1 offset:5120
  v_smfmac_f32_16x16x64_bf16 v[60:63], v[8:11], v[200:207], v3
  v_smfmac_f32_16x16x64_bf16 v[60:63], v[12:15], v[208:215], v3
  s_waitcnt lgkmcnt(4)
  v_smfmac_f32_16x16x64_bf16 v[64:67], v[8:11], v[76:83], v3
  ds_read_b128 v[76:79], v1 offset:6144
  ds_read_b128 v[80:83], v1 offset:7168
  v_smfmac_f32_16x16x64_bf16 v[60:63], v[16:19], v[216:223], v3
  v_smfmac_f32_16x16x64_bf16 v[60:63], v[20:23], v[224:231], v3
  s_waitcnt lgkmcnt(4)
  v_smfmac_f32_16x16x64_bf16 v[64:67], v[12:15], v[84:91], v3
  ds_read_b128 v[84:87], v1 offset:8192
  ds_read_b128 v[88:91], v1 offset:9216
  v_smfmac_f32_16x16x64_bf16 v[60:63], v[24:27], v[232:239], v3
  v_smfmac_f32_16x16x64_bf16 v[60:63], v[28:31], v[240:247], v3
  s_waitcnt lgkmcnt(4)
  v_smfmac_f32_16x16x64_bf16 v[64:67], v[16:19], v[92:99], v3
  ds_read_b128 v[92:95], v1 offset:10240
  ds_read_b128 v[96:99], v1 offset:11264
  v_smfmac_f32_16x16x64_bf16 v[60:63], v[32:35], v[248:255], v3
  v_smfmac_f32_16x16x64_bf16 v[36:39], v[8:11], a[0:7], v3
  s_waitcnt lgkmcnt(4)
  v_smfmac_f32_16x16x64_bf16 v[64:67], v[20:23], v[76:83], v3
  ds_read_b128 v[76:79], v1 offset:12288
  ds_read_b128 v[80:83], v1 offset:13312
  v_smfmac_f32_16x16x64_bf16 v[36:39], v[12:15], a[8:15], v3
  v_add_f32 v60, v60, v61
  v_smfmac_f32_16x16x64_bf16 v[36:39], v[16:19], a[16:23], v3
  v_add_f32 v62, v62, v63
  s_waitcnt lgkmcnt(4)
  v_smfmac_f32_16x16x64_bf16 v[64:67], v[24:27], v[84:91], v3
  v_cvt_pk_bf16_f32 v60, v60, v62
  v_smfmac_f32_16x16x64_bf16 v[36:39], v[20:23], a[24:31], v3
  ds_write_b32 v106, v60
  v_smfmac_f32_16x16x64_bf16 v[36:39], v[24:27], a[32:39], v3
  s_waitcnt lgkmcnt(2)
  v_smfmac_f32_16x16x64_bf16 v[64:67], v[28:31], v[92:99], v3
  v_smfmac_f32_16x16x64_bf16 v[36:39], v[28:31], a[40:47], v3
  v_smfmac_f32_16x16x64_bf16 v[36:39], v[32:35], a[48:55], v3
  s_waitcnt lgkmcnt(0)
  v_smfmac_f32_16x16x64_bf16 v[64:67], v[32:35], v[76:83], v3
  v_smfmac_f32_16x16x64_bf16 v[40:43], v[8:11], a[56:63], v3
  v_smfmac_f32_16x16x64_bf16 v[40:43], v[12:15], a[64:71], v3
  v_add_f32 v36, v36, v37
  v_smfmac_f32_16x16x64_bf16 v[40:43], v[16:19], a[72:79], v3
  v_add_f32 v38, v38, v39
  v_smfmac_f32_16x16x64_bf16 v[40:43], v[20:23], a[80:87], v3
  v_cvt_pk_bf16_f32 v36, v36, v38
  v_smfmac_f32_16x16x64_bf16 v[40:43], v[24:27], a[88:95], v3
  ds_write_b32 v100, v36
  v_smfmac_f32_16x16x64_bf16 v[40:43], v[28:31], a[96:103], v3
  v_add_f32 v64, v64, v65
  v_smfmac_f32_16x16x64_bf16 v[40:43], v[32:35], a[104:111], v3
  v_add_f32 v66, v66, v67
  v_smfmac_f32_16x16x64_bf16 v[44:47], v[8:11], a[112:119], v3
  v_cvt_pk_bf16_f32 v64, v64, v66
  v_smfmac_f32_16x16x64_bf16 v[44:47], v[12:15], a[120:127], v3
  ds_write_b32 v107, v64
  v_smfmac_f32_16x16x64_bf16 v[44:47], v[16:19], a[128:135], v3
  v_add_f32 v40, v40, v41
  v_smfmac_f32_16x16x64_bf16 v[44:47], v[20:23], a[136:143], v3
  v_add_f32 v42, v42, v43
  v_smfmac_f32_16x16x64_bf16 v[44:47], v[24:27], a[144:151], v3
  v_cvt_pk_bf16_f32 v40, v40, v42
  v_smfmac_f32_16x16x64_bf16 v[44:47], v[28:31], a[152:159], v3
  ds_write_b32 v101, v40
  v_smfmac_f32_16x16x64_bf16 v[44:47], v[32:35], a[160:167], v3
  v_smfmac_f32_16x16x64_bf16 v[48:51], v[8:11], a[168:175], v3
  v_smfmac_f32_16x16x64_bf16 v[48:51], v[12:15], a[176:183], v3
  v_smfmac_f32_16x16x64_bf16 v[48:51], v[16:19], a[184:191], v3
  v_add_f32 v44, v44, v45
  v_smfmac_f32_16x16x64_bf16 v[48:51], v[20:23], a[192:199], v3
  v_add_f32 v46, v46, v47
  v_smfmac_f32_16x16x64_bf16 v[48:51], v[24:27], a[200:207], v3
  v_cvt_pk_bf16_f32 v44, v44, v46
  v_smfmac_f32_16x16x64_bf16 v[48:51], v[28:31], a[208:215], v3
  ds_write_b32 v102, v44
  v_smfmac_f32_16x16x64_bf16 v[48:51], v[32:35], a[216:223], v3
  v_smfmac_f32_16x16x64_bf16 v[52:55], v[8:11], a[224:231], v3
  v_smfmac_f32_16x16x64_bf16 v[52:55], v[12:15], a[232:239], v3
  v_smfmac_f32_16x16x64_bf16 v[52:55], v[16:19], a[240:247], v3
  v_add_f32 v48, v48, v49
  v_smfmac_f32_16x16x64_bf16 v[52:55], v[20:23], a[248:255], v3
  v_add_f32 v50, v50, v51
  v_smfmac_f32_16x16x64_bf16 v[52:55], v[24:27], v[120:127], v3
  v_cvt_pk_bf16_f32 v48, v48, v50
  v_smfmac_f32_16x16x64_bf16 v[52:55], v[28:31], v[128:135], v3
  ds_write_b32 v103, v48
  v_smfmac_f32_16x16x64_bf16 v[52:55], v[32:35], v[136:143], v3
  v_smfmac_f32_16x16x64_bf16 v[56:59], v[8:11], v[144:151], v3
  v_smfmac_f32_16x16x64_bf16 v[56:59], v[12:15], v[152:159], v3
  v_smfmac_f32_16x16x64_bf16 v[56:59], v[16:19], v[160:167], v3
  v_add_f32 v52, v52, v53
  v_smfmac_f32_16x16x64_bf16 v[56:59], v[20:23], v[168:175], v3
  v_add_f32 v54, v54, v55
  v_smfmac_f32_16x16x64_bf16 v[56:59], v[24:27], v[176:183], v3
  v_cvt_pk_bf16_f32 v52, v52, v54
  v_smfmac_f32_16x16x64_bf16 v[56:59], v[28:31], v[184:191], v3
  ds_write_b32 v104, v52
  v_smfmac_f32_16x16x64_bf16 v[56:59], v[32:35], v[192:199], v3
  s_nop 7
  v_add_f32 v56, v56, v57
  v_add_f32 v58, v58, v59
  v_cvt_pk_bf16_f32 v56, v56, v58
  ds_write_b32 v105, v56
  s_waitcnt lgkmcnt(0)
  s_barrier
  s_cmp_eq_u32 s19, 62
  s_cbranch_scc1 cB_done
  s_waitcnt vmcnt(0) lgkmcnt(0)
  s_add_u32 s19, s19, 1
  s_mov_b32 s20, s21
  s_branch cB_va2_loop
cB_va2_retry:
  s_waitcnt lgkmcnt(0)
  buffer_load_dwordx4 v[8:11], v2, s[8:11], s20 offen offset:0 sc1
  buffer_load_dwordx4 v[12:15], v2, s[8:11], s20 offen offset:1024 sc1
  buffer_load_dwordx4 v[16:19], v2, s[8:11], s20 offen offset:2048 sc1
  buffer_load_dwordx4 v[20:23], v2, s[8:11], s20 offen offset:3072 sc1
  s_add_u32 s31, s31, 1
  s_add_u32 s30, s30, 1
  s_cmp_lt_u32 s30, 400000
  s_cbranch_scc1 cB_va2_ld
  s_branch cB_abort
cB_va2_last:
  s_waitcnt lgkmcnt(0)
  buffer_store_dwordx4 v[100:103], v2, s[8:11], s24 offen offset:0 sc1
  buffer_store_dwordx4 v[104:107], v2, s[8:11], s24 offen offset:1024 sc1
  buffer_store_dwordx4 v[108:111], v2, s[8:11], s24 offen offset:2048 sc1
  buffer_store_dwordx4 v[4:7], v2, s[8:11], s24 offen offset:3072 sc1
  s_add_u32 s24, s24, 8192
  s_waitcnt vmcnt(0)
  s_mov_b64 exec, 1
  buffer_store_dword v117, v2, s[8:11], s34 offen sc1
  s_mov_b64 exec, -1
  s_add_u32 s34, s34, 8
  s_mov_b64 exec, 1
  buffer_store_dword v117, v2, s[8:11], s34 offen sc1
  s_mov_b64 exec, -1
  s_add_u32 s34, s34, 8
  s_branch cB_done
.p2align 6

cB_va3_loop:
  s_add_u32 s23, s20, 4096
  s_add_u32 s21, s20, 20480
  v_mov_b32 v36, 0
  v_mov_b32 v37, 0
  v_mov_b32 v38, 0
  v_mov_b32 v39, 0
  v_mov_b32 v40, 0
  v_mov_b32 v41, 0
  v_mov_b32 v42, 0
  v_mov_b32 v43, 0
  v_mov_b32 v44, 0
  v_mov_b32 v45, 0
  v_mov_b32 v46, 0
  v_mov_b32 v47, 0
  v_mov_b32 v48, 0
  v_mov_b32 v49, 0
  v_mov_b32 v50, 0
  v_mov_b32 v51, 0
  v_mov_b32 v52, 0
  v_mov_b32 v53, 0
  v_mov_b32 v54, 0
  v_mov_b32 v55, 0
  v_mov_b32 v56, 0
  v_mov_b32 v57, 0
  v_mov_b32 v58, 0
  v_mov_b32 v59, 0
  v_mov_b32 v60, 0
  v_mov_b32 v61, 0
  v_mov_b32 v62, 0
  v_mov_b32 v63, 0
  v_mov_b32 v64, 0
  v_mov_b32 v65, 0
  v_mov_b32 v66, 0
  v_mov_b32 v67, 0
  s_mov_b32 s30, 0
  buffer_load_dword v76, v119, s[8:11], s20 offen sc1
  buffer_load_dword v77, v119, s[8:11], s20 offen sc1
  buffer_load_dword v78, v119, s[8:11], s20 offen sc1
cB_va3_fp_l:
  s_waitcnt vmcnt(2)
  v_cmp_eq_u32 vcc, -1, v76
  s_cbranch_vccz cB_va3_fp_d
  buffer_load_dword v76, v119, s[8:11], s20 offen sc1
  s_waitcnt vmcnt(2)
  v_cmp_eq_u32 vcc, -1, v77
  s_cbranch_vccz cB_va3_fp_d
  buffer_load_dword v77, v119, s[8:11], s20 offen sc1
  s_waitcnt vmcnt(2)
  v_cmp_eq_u32 vcc, -1, v78
  s_cbranch_vccz cB_va3_fp_d
  buffer_load_dword v78, v119, s[8:11], s20 offen sc1
  s_add_u32 s30, s30, 1
  s_cmp_lt_u32 s30, 400000
  s_cbranch_scc1 cB_va3_fp_l
  s_branch cB_abort
cB_va3_fp_d:
  buffer_load_dwordx4 v[24:27], v2, s[8:11], s23 offen offset:0 sc1
  buffer_load_dwordx4 v[28:31], v2, s[8:11], s23 offen offset:1024 sc1
  buffer_load_dwordx4 v[32:35], v2, s[8:11], s23 offen offset:2048 sc1
  s_barrier
cB_va3_ld:
  s_waitcnt vmcnt(0)
  v_max3_u32 v84, v24, v25, v26
  v_max3_u32 v84, v84, v27, v28
  v_max3_u32 v84, v84, v29, v30
  v_max3_u32 v84, v84, v31, v32
  v_max3_u32 v84, v84, v33, v34
  v_max_u32 v84, v84, v35
  v_cmp_eq_u32 vcc, -1, v84
  ds_write_b128 v2, v[24:27] offset:12288
  ds_write_b128 v2, v[28:31] offset:13312
  ds_write_b128 v2, v[32:35] offset:14336
  s_cbranch_vccnz cB_va3_retry
  s_waitcnt lgkmcnt(0)
  s_barrier
  ds_read_b128 v[8:11], v5 offset:8192
  ds_read_b128 v[12:15], v5 offset:9216
  ds_read_b128 v[16:19], v5 offset:10240
  ds_read_b128 v[20:23], v5 offset:11264
  ds_read_b128 v[24:27], v5 offset:12288
  ds_read_b128 v[28:31], v5 offset:13312
  ds_read_b128 v[32:35], v5 offset:14336
  s_waitcnt lgkmcnt(0)
  s_cmp_eq_u32 s19, 63
  s_cbranch_scc1 cB_done
  ds_read_b128 v[76:79], v1 offset:0
  ds_read_b128 v[80:83], v1 offset:1024
  ds_read_b128 v[84:87], v1 offset:2048
  ds_read_b128 v[88:91], v1 offset:3072
  ds_read_b128 v[92:95], v1 offset:4096
  ds_read_b128 v[96:99], v1 offset:5120
  v_smfmac_f32_16x16x64_bf16 v[60:63], v[8:11], v[200:207], v3
  v_smfmac_f32_16x16x64_bf16 v[60:63], v[12:15], v[208:215], v3
  s_waitcnt lgkmcnt(4)
  v_smfmac_f32_16x16x64_bf16 v[64:67], v[8:11], v[76:83], v3
  ds_read_b128 v[76:79], v1 offset:6144
  ds_read_b128 v[80:83], v1 offset:7168
  v_smfmac_f32_16x16x64_bf16 v[60:63], v[16:19], v[216:223], v3
  v_smfmac_f32_16x16x64_bf16 v[60:63], v[20:23], v[224:231], v3
  s_waitcnt lgkmcnt(4)
  v_smfmac_f32_16x16x64_bf16 v[64:67], v[12:15], v[84:91], v3
  ds_read_b128 v[84:87], v1 offset:8192
  ds_read_b128 v[88:91], v1 offset:9216
  v_smfmac_f32_16x16x64_bf16 v[60:63], v[24:27], v[232:239], v3
  v_smfmac_f32_16x16x64_bf16 v[60:63], v[28:31], v[240:247], v3
  s_waitcnt lgkmcnt(4)
  v_smfmac_f32_16x16x64_bf16 v[64:67], v[16:19], v[92:99], v3
  ds_read_b128 v[92:95], v1 offset:10240
  ds_read_b128 v[96:99], v1 offset:11264
  v_smfmac_f32_16x16x64_bf16 v[60:63], v[32:35], v[248:255], v3
  v_smfmac_f32_16x16x64_bf16 v[36:39], v[8:11], a[0:7], v3
  s_waitcnt lgkmcnt(4)
  v_smfmac_f32_16x16x64_bf16 v[64:67], v[20:23], v[76:83], v3
  ds_read_b128 v[76:79], v1 offset:12288
  ds_read_b128 v[80:83], v1 offset:13312
  v_smfmac_f32_16x16x64_bf16 v[36:39], v[12:15], a[8:15], v3
  v_add_f32 v60, v60, v61
  v_smfmac_f32_16x16x64_bf16 v[36:39], v[16:19], a[16:23], v3
  v_add_f32 v62, v62, v63
  s_waitcnt lgkmcnt(4)
  v_smfmac_f32_16x16x64_bf16 v[64:67], v[24:27], v[84:91], v3
  v_cvt_pk_bf16_f32 v60, v60, v62
  v_smfmac_f32_16x16x64_bf16 v[36:39], v[20:23], a[24:31], v3
  ds_write_b32 v106, v60
  v_smfmac_f32_16x16x64_bf16 v[36:39], v[24:27], a[32:39], v3
  s_waitcnt lgkmcnt(2)
  v_smfmac_f32_16x16x64_bf16 v[64:67], v[28:31], v[92:99], v3
  v_smfmac_f32_16x16x64_bf16 v[36:39], v[28:31], a[40:47], v3
  v_smfmac_f32_16x16x64_bf16 v[36:39], v[32:35], a[48:55], v3
  s_waitcnt lgkmcnt(0)
  v_smfmac_f32_16x16x64_bf16 v[64:67], v[32:35], v[76:83], v3
  v_smfmac_f32_16x16x64_bf16 v[40:43], v[8:11], a[56:63], v3
  v_smfmac_f32_16x16x64_bf16 v[40:43], v[12:15], a[64:71], v3
  v_add_f32 v36, v36, v37
  v_smfmac_f32_16x16x64_bf16 v[40:43], v[16:19], a[72:79], v3
  v_add_f32 v38, v38, v39
  v_smfmac_f32_16x16x64_bf16 v[40:43], v[20:23], a[80:87], v3
  v_cvt_pk_bf16_f32 v36, v36, v38
  v_smfmac_f32_16x16x64_bf16 v[40:43], v[24:27], a[88:95], v3
  ds_write_b32 v100, v36
  v_smfmac_f32_16x16x64_bf16 v[40:43], v[28:31], a[96:103], v3
  v_add_f32 v64, v64, v65
  v_smfmac_f32_16x16x64_bf16 v[40:43], v[32:35], a[104:111], v3
  v_add_f32 v66, v66, v67
  v_smfmac_f32_16x16x64_bf16 v[44:47], v[8:11], a[112:119], v3
  v_cvt_pk_bf16_f32 v64, v64, v66
  v_smfmac_f32_16x16x64_bf16 v[44:47], v[12:15], a[120:127], v3
  ds_write_b32 v107, v64
  v_smfmac_f32_16x16x64_bf16 v[44:47], v[16:19], a[128:135], v3
  v_add_f32 v40, v40, v41
  v_smfmac_f32_16x16x64_bf16 v[44:47], v[20:23], a[136:143], v3
  v_add_f32 v42, v42, v43
  v_smfmac_f32_16x16x64_bf16 v[44:47], v[24:27], a[144:151], v3
  v_cvt_pk_bf16_f32 v40, v40, v42
  v_smfmac_f32_16x16x64_bf16 v[44:47], v[28:31], a[152:159], v3
  ds_write_b32 v101, v40
  v_smfmac_f32_16x16x64_bf16 v[44:47], v[32:35], a[160:167], v3
  v_smfmac_f32_16x16x64_bf16 v[48:51], v[8:11], a[168:175], v3
  v_smfmac_f32_16x16x64_bf16 v[48:51], v[12:15], a[176:183], v3
  v_smfmac_f32_16x16x64_bf16 v[48:51], v[16:19], a[184:191], v3
  v_add_f32 v44, v44, v45
  v_smfmac_f32_16x16x64_bf16 v[48:51], v[20:23], a[192:199], v3
  v_add_f32 v46, v46, v47
  v_smfmac_f32_16x16x64_bf16 v[48:51], v[24:27], a[200:207], v3
  v_cvt_pk_bf16_f32 v44, v44, v46
  v_smfmac_f32_16x16x64_bf16 v[48:51], v[28:31], a[208:215], v3
  ds_write_b32 v102, v44
  v_smfmac_f32_16x16x64_bf16 v[48:51], v[32:35], a[216:223], v3
  v_smfmac_f32_16x16x64_bf16 v[52:55], v[8:11], a[224:231], v3
  v_smfmac_f32_16x16x64_bf16 v[52:55], v[12:15], a[232:239], v3
  v_smfmac_f32_16x16x64_bf16 v[52:55], v[16:19], a[240:247], v3
  v_add_f32 v48, v48, v49
  v_smfmac_f32_16x16x64_bf16 v[52:55], v[20:23], a[248:255], v3
  v_add_f32 v50, v50, v51
  v_smfmac_f32_16x16x64_bf16 v[52:55], v[24:27], v[120:127], v3
  v_cvt_pk_bf16_f32 v48, v48, v50
  v_smfmac_f32_16x16x64_bf16 v[52:55], v[28:31], v[128:135], v3
  ds_write_b32 v103, v48
  v_smfmac_f32_16x16x64_bf16 v[52:55], v[32:35], v[136:143], v3
  v_smfmac_f32_16x16x64_bf16 v[56:59], v[8:11], v[144:151], v3
  v_smfmac_f32_16x16x64_bf16 v[56:59], v[12:15], v[152:159], v3
  v_smfmac_f32_16x16x64_bf16 v[56:59], v[16:19], v[160:167], v3
  v_add_f32 v52, v52, v53
  v_smfmac_f32_16x16x64_bf16 v[56:59], v[20:23], v[168:175], v3
  v_add_f32 v54, v54, v55
  v_smfmac_f32_16x16x64_bf16 v[56:59], v[24:27], v[176:183], v3
  v_cvt_pk_bf16_f32 v52, v52, v54
  v_smfmac_f32_16x16x64_bf16 v[56:59], v[28:31], v[184:191], v3
  ds_write_b32 v104, v52
  v_smfmac_f32_16x16x64_bf16 v[56:59], v[32:35], v[192:199], v3
  s_nop 7
  v_add_f32 v56, v56, v57
  v_add_f32 v58, v58, v59
  v_cvt_pk_bf16_f32 v56, v56, v58
  ds_write_b32 v105, v56
  s_waitcnt lgkmcnt(0)
  s_barrier
  s_cmp_eq_u32 s19, 62
  s_cbranch_scc1 cB_done
  s_waitcnt vmcnt(0) lgkmcnt(0)
  s_add_u32 s19, s19, 1
  s_mov_b32 s20, s21
  s_branch cB_va3_loop
cB_va3_retry:
  s_waitcnt lgkmcnt(0)
  buffer_load_dwordx4 v[24:27], v2, s[8:11], s23 offen offset:0 sc1
  buffer_load_dwordx4 v[28:31], v2, s[8:11], s23 offen offset:1024 sc1
  buffer_load_dwordx4 v[32:35], v2, s[8:11], s23 offen offset:2048 sc1
  s_add_u32 s31, s31, 1
  s_add_u32 s30, s30, 1
  s_cmp_lt_u32 s30, 400000
  s_cbranch_scc1 cB_va3_ld
  s_branch cB_abort
cB_va3_last:
  s_waitcnt lgkmcnt(0)
  buffer_store_dwordx4 v[100:103], v2, s[8:11], s24 offen offset:0 sc1
  buffer_store_dwordx4 v[104:107], v2, s[8:11], s24 offen offset:1024 sc1
  buffer_store_dwordx4 v[108:111], v2, s[8:11], s24 offen offset:2048 sc1
  buffer_store_dwordx4 v[4:7], v2, s[8:11], s24 offen offset:3072 sc1
  s_add_u32 s24, s24, 8192
  s_waitcnt vmcnt(0)
  s_mov_b64 exec, 1
  buffer_store_dword v117, v2, s[8:11], s34 offen sc1
  s_mov_b64 exec, -1
  s_add_u32 s34, s34, 8
  s_mov_b64 exec, 1
  buffer_store_dword v117, v2, s[8:11], s34 offen sc1
  s_mov_b64 exec, -1
  s_add_u32 s34, s34, 8
  s_branch cB_done
cB_abort:
  v_mov_b32 v4, 0xdead
  v_mov_b32 v5, 16
  buffer_store_dword v4, v5, s[12:15], 0 offen
  s_branch ch_end
cB_done:
  s_branch ch_end
m_reclaim:
  s_waitcnt vmcnt(0)
  s_lshr_b32 s20, s3, 5
  s_cmp_lg_u32 s16, 0
  s_cbranch_scc1 w0_17
  s_mov_b32 s21, 0
  s_mov_b64 exec, 1
rc_l:
  s_cmp_lg_u32 s70, -1
  s_cbranch_scc1 rc_t
  s_add_u32 s20, s20, 1
  s_cmp_lt_u32 s20, 8
  s_cselect_b32 s20, s20, 0
  s_mov_b32 s70, 0
  s_mov_b32 s3, -1
  s_add_u32 s21, s21, 1
  s_cmp_ge_u32 s21, 9
  s_cbranch_scc1 rc_d
rc_t:
  s_ff0_i32_b32 s22, s70
  s_lshl_b32 s23, 1, s22
  s_and_b32 s71, s20, 4
  s_mul_i32 s71, s71, 12
  s_lshl_b32 s3, s20, 2
  s_add_u32 s3, s3, s71
  v_mov_b32 v242, s23
  v_mov_b32 v243, 32
  buffer_atomic_or v242, v243, s[12:15], s3 offen sc0
  s_waitcnt vmcnt(0)
  v_readfirstlane_b32 s70, v242
  s_lshl_b32 s3, s20, 5
  s_add_u32 s3, s3, s22
  s_bitcmp1_b32 s70, s22
  s_cbranch_scc1 rc_l
rc_d:
  s_mov_b64 exec, -1
  v_mov_b32 v242, s3
w0_17:
  v_mov_b32 v250, 160000
  s_add_u32 s101, s101, 1
  s_barrier
  s_mov_b64 exec, 1
  s_cmp_lg_u32 s16, 0
  s_cbranch_scc1 w0_18
  ds_write_b32 v250, v242 offset:0
  s_waitcnt lgkmcnt(0)
  v_mov_b32 v242, s101
  ds_write_b32 v250, v242 offset:16
  s_waitcnt lgkmcnt(0)
w0_18:
  s_mov_b64 exec, -1
  s_barrier
  ds_read_b32 v242, v250 offset:0
  ds_read_b32 v250, v250 offset:16
  s_waitcnt lgkmcnt(0)
  v_readfirstlane_b32 s3, v242
  v_cmp_ne_u32 vcc, s101, v250
  s_cbranch_vccnz ch_end
  s_cmp_lg_u32 s3, -1
  s_cbranch_scc1 m_start
  v_mov_b32 v250, 0
  s_branch wk_ask
m_bjob:
  v_and_b32 v1, 63, v0
  v_lshlrev_b32 v2, 4, v1
  v_lshrrev_b32 v3, 4, v1
  v_and_b32 v4, 15, v1
  s_sub_u32 s18, s3, 32
  s_mul_i32 s17, s18, 4682
  s_lshr_b32 s17, s17, 16
  s_mul_i32 s20, s17, 14
  s_sub_u32 s19, s18, s20
  s_cmp_ge_u32 s19, 7
  s_cselect_b32 s31, 7, 0
  s_sub_u32 s19, s19, s31
  s_mov_b32 s60, s44
  s_and_b32 s61, s45, 0xffff
  s_mov_b32 s62, 3670016
  s_mov_b32 s63, 0x20000
  s_mov_b32 s56, s46
  s_and_b32 s57, s47, 0xffff
  s_mov_b32 s58, 3670016
  s_mov_b32 s59, 0x20000
  s_lshl_b32 s30, s16, 13
  s_mul_i32 s27, s17, 229376
  s_lshl_b32 s29, s19, 7
  s_add_u32 s27, s27, s29
  v_lshrrev_b32 v7, 3, v1
  v_and_b32 v8, 7, v1
  v_and_b32 v9, 2, v7
  v_xor_b32 v8, v8, v9
  s_lshl_b32 s29, s16, 6
  v_add_u32 v7, s29, v7
  v_mul_u32_u24 v7, 896, v7
  v_lshl_add_u32 v7, v8, 4, v7
  v_xor_b32 v8, 64, v7
  s_add_u32 m0, s30, 0
  s_add_u32 s22, s27, 0
  buffer_load_dwordx4 v7, s[56:59], s22 offen offset:0 lds
  s_add_u32 s22, s27, 6144
  buffer_load_dwordx4 v8, s[56:59], s22 offen offset:1024 lds
  s_add_u32 s22, s27, 12288
  buffer_load_dwordx4 v7, s[56:59], s22 offen offset:2048 lds
  s_add_u32 s22, s27, 18432
  buffer_load_dwordx4 v8, s[56:59], s22 offen offset:3072 lds
  s_add_u32 m0, s30, 4096
  s_add_u32 s22, s27, 28672
  buffer_load_dwordx4 v7, s[56:59], s22 offen offset:0 lds
  s_add_u32 s22, s27, 34816
  buffer_load_dwordx4 v8, s[56:59], s22 offen offset:1024 lds
  s_add_u32 s22, s27, 40960
  buffer_load_dwordx4 v7, s[56:59], s22 offen offset:2048 lds
  s_add_u32 s22, s27, 47104
  buffer_load_dwordx4 v8, s[56:59], s22 offen offset:3072 lds
  v_lshrrev_b32 v5, 5, v1
  v_and_b32 v6, 31, v1
  s_lshl_b32 s25, s16, 15
  s_add_u32 s25, s25, 32768
  s_lshl_b32 s26, s17, 9
  s_add_u32 s28, s19, s16
  s_cmp_ge_u32 s28, 7
  s_cselect_b32 s20, 7, 0
  s_sub_u32 s28, s28, s20
  s_add_u32 s28, s28, s31
  s_add_u32 s29, s19, s16
  s_add_u32 s29, s29, 4
  s_cmp_ge_u32 s29, 7
  s_cselect_b32 s20, 7, 0
  s_sub_u32 s29, s29, s20
  s_add_u32 s29, s29, s31
  s_lshl_b32 s32, s28, 18
  s_add_u32 s32, s32, s26
  s_lshl_b32 s33, s29, 18
  s_add_u32 s33, s33, s26
  v_xor_b32 v8, v6, v5
  v_lshlrev_b32 v8, 4, v8
  v_lshl_add_u32 v8, v5, 13, v8
  v_xor_b32 v12, 0, v8
  v_xor_b32 v13, 32, v8
  v_add_u32 v13, 15360, v13
  v_xor_b32 v14, 0, v8
  v_add_u32 v14, 30720, v14
  v_xor_b32 v15, 32, v8
  v_add_u32 v15, 46080, v15
  s_add_u32 s20, s16, 0
  s_and_b32 s20, s20, 3
  s_mul_i32 s21, s20, 65600
  s_lshl_b32 s20, s20, 12
  s_add_u32 s48, s20, s25
  s_mov_b32 m0, s48
  v_xor_b32 v16, s21, v12
  buffer_load_dwordx4 v16, s[60:63], s32 offen offset:0 lds
  v_xor_b32 v17, s21, v13
  buffer_load_dwordx4 v17, s[60:63], s32 offen offset:1024 lds
  v_xor_b32 v18, s21, v14
  buffer_load_dwordx4 v18, s[60:63], s32 offen offset:2048 lds
  v_xor_b32 v19, s21, v15
  buffer_load_dwordx4 v19, s[60:63], s32 offen offset:3072 lds
  s_add_u32 s20, s16, 1
  s_and_b32 s20, s20, 3
  s_mul_i32 s21, s20, 65600
  s_lshl_b32 s20, s20, 12
  s_add_u32 s49, s20, s25
  s_mov_b32 m0, s49
  v_xor_b32 v20, s21, v12
  buffer_load_dwordx4 v20, s[60:63], s32 offen offset:0 lds
  v_xor_b32 v21, s21, v13
  buffer_load_dwordx4 v21, s[60:63], s32 offen offset:1024 lds
  v_xor_b32 v22, s21, v14
  buffer_load_dwordx4 v22, s[60:63], s32 offen offset:2048 lds
  v_xor_b32 v23, s21, v15
  buffer_load_dwordx4 v23, s[60:63], s32 offen offset:3072 lds
  s_add_u32 s20, s16, 2
  s_and_b32 s20, s20, 3
  s_mul_i32 s21, s20, 65600
  s_lshl_b32 s20, s20, 12
  s_add_u32 s50, s20, s25
  s_mov_b32 m0, s50
  v_xor_b32 v24, s21, v12
  buffer_load_dwordx4 v24, s[60:63], s32 offen offset:0 lds
  v_xor_b32 v25, s21, v13
  buffer_load_dwordx4 v25, s[60:63], s32 offen offset:1024 lds
  v_xor_b32 v26, s21, v14
  buffer_load_dwordx4 v26, s[60:63], s32 offen offset:2048 lds
  v_xor_b32 v27, s21, v15
  buffer_load_dwordx4 v27, s[60:63], s32 offen offset:3072 lds
  s_add_u32 s20, s16, 3
  s_and_b32 s20, s20, 3
  s_mul_i32 s21, s20, 65600
  s_lshl_b32 s20, s20, 12
  s_add_u32 s51, s20, s25
  s_mov_b32 m0, s51
  v_xor_b32 v28, s21, v12
  buffer_load_dwordx4 v28, s[60:63], s32 offen offset:0 lds
  v_xor_b32 v29, s21, v13
  buffer_load_dwordx4 v29, s[60:63], s32 offen offset:1024 lds
  v_xor_b32 v30, s21, v14
  buffer_load_dwordx4 v30, s[60:63], s32 offen offset:2048 lds
  v_xor_b32 v31, s21, v15
  buffer_load_dwordx4 v31, s[60:63], s32 offen offset:3072 lds
  s_cmp_lg_u32 s66, 0
  s_cbranch_scc1 bj_ci
  s_cmp_lg_u32 s16, 0
  s_cbranch_scc1 w0_19
  s_lshr_b32 s70, s3, 5
  s_and_b32 s71, s70, 4
  s_mul_i32 s71, s71, 12
  s_lshl_b32 s70, s70, 2
  s_add_u32 s70, s70, s71
  s_lshl_b32 s71, 1, s3
  v_mov_b32 v44, s71
  v_mov_b32 v45, 32
  s_mov_b64 exec, 1
  buffer_atomic_or v44, v45, s[12:15], s70 offen sc0
  buffer_load_dwordx2 v[46:47], v45, s[12:15], 0 offen offset:96 sc1
  s_mov_b64 exec, -1
w0_19:
bj_ci:
  s_lshl_b32 s30, s19, 6
  s_add_u32 s30, s30, 0
  s_cmp_lt_u32 s19, 4
  s_cselect_b32 s20, 0, 256
  s_sub_u32 s30, s30, s20
  v_add_u32 v8, s30, v4
  s_lshr_b32 s20, s20, 4
  s_cmp_lt_u32 s19, 4
  s_movk_i32 s21, 5462
  s_cselect_b32 s21, 4096, s21
  s_cselect_b32 s30, 16, 12
  v_mul_u32_u24 v10, s21, v8
  v_lshrrev_b32 v10, 16, v10
  v_mul_u32_u24 v11, s30, v10
  v_sub_u32 v32, v8, v11
  v_add_u32 v32, s20, v32
  s_mul_i32 s30, s17, 28
  v_add_u32 v32, s30, v32
  v_lshrrev_b32 v33, 4, v32
  v_and_b32 v32, 15, v32
  s_mov_b32 s30, 401408
  v_mul_lo_u32 v10, v10, s30
  v_mul_u32_u24 v33, 14336, v33
  v_add_u32 v10, v10, v33
  v_lshl_add_u32 v10, v3, 8, v10
  v_lshl_add_u32 v10, v32, 4, v10
  v_add_u32 v12, 6422528, v10
  s_lshl_b32 s30, s19, 6
  s_add_u32 s30, s30, 16
  s_cmp_lt_u32 s19, 4
  s_cselect_b32 s20, 0, 256
  s_sub_u32 s30, s30, s20
  v_add_u32 v8, s30, v4
  s_lshr_b32 s20, s20, 4
  s_cmp_lt_u32 s19, 4
  s_movk_i32 s21, 5462
  s_cselect_b32 s21, 4096, s21
  s_cselect_b32 s30, 16, 12
  v_mul_u32_u24 v10, s21, v8
  v_lshrrev_b32 v10, 16, v10
  v_mul_u32_u24 v11, s30, v10
  v_sub_u32 v32, v8, v11
  v_add_u32 v32, s20, v32
  s_mul_i32 s30, s17, 28
  v_add_u32 v32, s30, v32
  v_lshrrev_b32 v33, 4, v32
  v_and_b32 v32, 15, v32
  s_mov_b32 s30, 401408
  v_mul_lo_u32 v10, v10, s30
  v_mul_u32_u24 v33, 14336, v33
  v_add_u32 v10, v10, v33
  v_lshl_add_u32 v10, v3, 8, v10
  v_lshl_add_u32 v10, v32, 4, v10
  v_add_u32 v13, 6422528, v10
  s_lshl_b32 s30, s19, 6
  s_add_u32 s30, s30, 32
  s_cmp_lt_u32 s19, 4
  s_cselect_b32 s20, 0, 256
  s_sub_u32 s30, s30, s20
  v_add_u32 v8, s30, v4
  s_lshr_b32 s20, s20, 4
  s_cmp_lt_u32 s19, 4
  s_movk_i32 s21, 5462
  s_cselect_b32 s21, 4096, s21
  s_cselect_b32 s30, 16, 12
  v_mul_u32_u24 v10, s21, v8
  v_lshrrev_b32 v10, 16, v10
  v_mul_u32_u24 v11, s30, v10
  v_sub_u32 v32, v8, v11
  v_add_u32 v32, s20, v32
  s_mul_i32 s30, s17, 28
  v_add_u32 v32, s30, v32
  v_lshrrev_b32 v33, 4, v32
  v_and_b32 v32, 15, v32
  s_mov_b32 s30, 401408
  v_mul_lo_u32 v10, v10, s30
  v_mul_u32_u24 v33, 14336, v33
  v_add_u32 v10, v10, v33
  v_lshl_add_u32 v10, v3, 8, v10
  v_lshl_add_u32 v10, v32, 4, v10
  v_add_u32 v14, 6422528, v10
  s_lshl_b32 s30, s19, 6
  s_add_u32 s30, s30, 48
  s_cmp_lt_u32 s19, 4
  s_cselect_b32 s20, 0, 256
  s_sub_u32 s30, s30, s20
  v_add_u32 v8, s30, v4
  s_lshr_b32 s20, s20, 4
  s_cmp_lt_u32 s19, 4
  s_movk_i32 s21, 5462
  s_cselect_b32 s21, 4096, s21
  s_cselect_b32 s30, 16, 12
  v_mul_u32_u24 v10, s21, v8
  v_lshrrev_b32 v10, 16, v10
  v_mul_u32_u24 v11, s30, v10
  v_sub_u32 v32, v8, v11
  v_add_u32 v32, s20, v32
  s_mul_i32 s30, s17, 28
  v_add_u32 v32, s30, v32
  v_lshrrev_b32 v33, 4, v32
  v_and_b32 v32, 15, v32
  s_mov_b32 s30, 401408
  v_mul_lo_u32 v10, v10, s30
  v_mul_u32_u24 v33, 14336, v33
  v_add_u32 v10, v10, v33
  v_lshl_add_u32 v10, v3, 8, v10
  v_lshl_add_u32 v10, v32, 4, v10
  v_add_u32 v15, 6422528, v10
  v_lshrrev_b32 v7, 2, v4
  v_lshlrev_b32 v7, 3, v7
  v_and_b32 v8, 3, v4
  v_add_u32 v7, v7, v8
  v_xor_b32 v10, v3, v4
  v_lshlrev_b32 v10, 4, v10
  v_lshl_add_u32 v10, v7, 9, v10
  v_add_u32 v10, s25, v10
  v_xor_b32 v32, 0, v10
  v_xor_b32 v33, 64, v10
  v_xor_b32 v34, 128, v10
  v_xor_b32 v35, 192, v10
  v_lshrrev_b32 v7, 2, v4
  v_lshl_add_u32 v7, v3, 3, v7
  v_lshlrev_b32 v7, 7, v7
  v_and_b32 v8, 3, v4
  v_lshl_add_u32 v7, v8, 3, v7
  v_lshrrev_b32 v8, 3, v4
  v_lshl_add_u32 v7, v8, 5, v7
  v_and_b32 v8, 1, v3
  v_lshl_add_u32 v7, v8, 6, v7
  s_waitcnt vmcnt(16)
  s_barrier
  s_cmp_eq_u32 s16, 3
  s_cbranch_scc1 bj_np0
  s_add_u32 m0, s48, 16384
  s_nop 0
  buffer_load_dwordx4 v16, s[60:63], s33 offen offset:0 lds
  buffer_load_dwordx4 v17, s[60:63], s33 offen offset:1024 lds
  buffer_load_dwordx4 v18, s[60:63], s33 offen offset:2048 lds
  buffer_load_dwordx4 v19, s[60:63], s33 offen offset:3072 lds
bj_np0:
  v_xor_b32 v9, 0, v7
  ds_read_b64_tr_b16 v[128:129], v9 offset:0
  ds_read_b64_tr_b16 v[130:131], v9 offset:512
  ds_read_b64_tr_b16 v[132:133], v9 offset:4096
  ds_read_b64_tr_b16 v[134:135], v9 offset:4608
  ds_read_b64_tr_b16 v[136:137], v9 offset:8192
  ds_read_b64_tr_b16 v[138:139], v9 offset:8704
  ds_read_b64_tr_b16 v[140:141], v9 offset:12288
  ds_read_b64_tr_b16 v[142:143], v9 offset:12800
  s_waitcnt lgkmcnt(6)
  ds_read_b64_tr_b16 v[144:145], v9 offset:16384
  ds_read_b64_tr_b16 v[146:147], v9 offset:16896
  ds_read_b64_tr_b16 v[148:149], v9 offset:20480
  ds_read_b64_tr_b16 v[150:151], v9 offset:20992
  ds_read_b64_tr_b16 v[152:153], v9 offset:24576
  ds_read_b64_tr_b16 v[154:155], v9 offset:25088
  ds_read_b64_tr_b16 v[156:157], v9 offset:28672
  ds_read_b64_tr_b16 v[158:159], v9 offset:29184
  s_waitcnt lgkmcnt(6)
  s_cmp_eq_u32 s16, 3
  s_cbranch_scc1 bj_np1
  s_add_u32 m0, s49, 16384
  s_nop 0
  buffer_load_dwordx4 v20, s[60:63], s33 offen offset:0 lds
  buffer_load_dwordx4 v21, s[60:63], s33 offen offset:1024 lds
  buffer_load_dwordx4 v22, s[60:63], s33 offen offset:2048 lds
  buffer_load_dwordx4 v23, s[60:63], s33 offen offset:3072 lds
bj_np1:
  v_xor_b32 v9, 32, v7
  ds_read_b64_tr_b16 v[160:161], v9 offset:0
  ds_read_b64_tr_b16 v[162:163], v9 offset:512
  ds_read_b64_tr_b16 v[164:165], v9 offset:4096
  ds_read_b64_tr_b16 v[166:167], v9 offset:4608
  ds_read_b64_tr_b16 v[168:169], v9 offset:8192
  ds_read_b64_tr_b16 v[170:171], v9 offset:8704
  ds_read_b64_tr_b16 v[172:173], v9 offset:12288
  ds_read_b64_tr_b16 v[174:175], v9 offset:12800
  s_waitcnt lgkmcnt(6)
  ds_read_b64_tr_b16 v[176:177], v9 offset:16384
  ds_read_b64_tr_b16 v[178:179], v9 offset:16896
  ds_read_b64_tr_b16 v[180:181], v9 offset:20480
  ds_read_b64_tr_b16 v[182:183], v9 offset:20992
  ds_read_b64_tr_b16 v[184:185], v9 offset:24576
  ds_read_b64_tr_b16 v[186:187], v9 offset:25088
  ds_read_b64_tr_b16 v[188:189], v9 offset:28672
  ds_read_b64_tr_b16 v[190:191], v9 offset:29184
  s_waitcnt lgkmcnt(6)
  s_cmp_eq_u32 s16, 3
  s_cbranch_scc1 bj_np2
  s_add_u32 m0, s50, 16384
  s_nop 0
  buffer_load_dwordx4 v24, s[60:63], s33 offen offset:0 lds
  buffer_load_dwordx4 v25, s[60:63], s33 offen offset:1024 lds
  buffer_load_dwordx4 v26, s[60:63], s33 offen offset:2048 lds
  buffer_load_dwordx4 v27, s[60:63], s33 offen offset:3072 lds
bj_np2:
  v_xor_b32 v9, 64, v7
  ds_read_b64_tr_b16 v[192:193], v9 offset:0
  ds_read_b64_tr_b16 v[194:195], v9 offset:512
  ds_read_b64_tr_b16 v[196:197], v9 offset:4096
  ds_read_b64_tr_b16 v[198:199], v9 offset:4608
  ds_read_b64_tr_b16 v[200:201], v9 offset:8192
  ds_read_b64_tr_b16 v[202:203], v9 offset:8704
  ds_read_b64_tr_b16 v[204:205], v9 offset:12288
  ds_read_b64_tr_b16 v[206:207], v9 offset:12800
  s_waitcnt lgkmcnt(6)
  ds_read_b64_tr_b16 v[208:209], v9 offset:16384
  ds_read_b64_tr_b16 v[210:211], v9 offset:16896
  ds_read_b64_tr_b16 v[212:213], v9 offset:20480
  ds_read_b64_tr_b16 v[214:215], v9 offset:20992
  ds_read_b64_tr_b16 v[216:217], v9 offset:24576
  ds_read_b64_tr_b16 v[218:219], v9 offset:25088
  ds_read_b64_tr_b16 v[220:221], v9 offset:28672
  ds_read_b64_tr_b16 v[222:223], v9 offset:29184
  s_waitcnt lgkmcnt(6)
  s_cmp_eq_u32 s16, 3
  s_cbranch_scc1 bj_np3
  s_add_u32 m0, s51, 16384
  s_nop 0
  buffer_load_dwordx4 v28, s[60:63], s33 offen offset:0 lds
  buffer_load_dwordx4 v29, s[60:63], s33 offen offset:1024 lds
  buffer_load_dwordx4 v30, s[60:63], s33 offen offset:2048 lds
  buffer_load_dwordx4 v31, s[60:63], s33 offen offset:3072 lds
bj_np3:
  v_xor_b32 v9, 96, v7
  ds_read_b64_tr_b16 v[224:225], v9 offset:0
  ds_read_b64_tr_b16 v[226:227], v9 offset:512
  ds_read_b64_tr_b16 v[228:229], v9 offset:4096
  ds_read_b64_tr_b16 v[230:231], v9 offset:4608
  ds_read_b64_tr_b16 v[232:233], v9 offset:8192
  ds_read_b64_tr_b16 v[234:235], v9 offset:8704
  ds_read_b64_tr_b16 v[236:237], v9 offset:12288
  ds_read_b64_tr_b16 v[238:239], v9 offset:12800
  s_waitcnt lgkmcnt(6)
  ds_read_b64_tr_b16 v[240:241], v9 offset:16384
  ds_read_b64_tr_b16 v[242:243], v9 offset:16896
  ds_read_b64_tr_b16 v[244:245], v9 offset:20480
  ds_read_b64_tr_b16 v[246:247], v9 offset:20992
  ds_read_b64_tr_b16 v[248:249], v9 offset:24576
  ds_read_b64_tr_b16 v[250:251], v9 offset:25088
  ds_read_b64_tr_b16 v[252:253], v9 offset:28672
  ds_read_b64_tr_b16 v[254:255], v9 offset:29184
  s_waitcnt lgkmcnt(6)
  s_mov_b32 s52, s36
  s_and_b32 s53, s37, 0xffff
  s_mov_b32 s54, 1835008
  s_mov_b32 s55, 0x20000
  s_lshl_b32 s20, s18, 8
  v_add_u32 v95, s20, v0
  s_mov_b32 s21, 9586981
  v_mul_hi_u32 v6, v95, s21
  v_mul_u32_u24 v7, 448, v6
  v_sub_u32 v7, v95, v7
  v_lshrrev_b32 v8, 4, v7
  v_and_b32 v7, 15, v7
  v_lshl_add_u32 v9, v6, 4, v7
  v_mul_u32_u24 v9, 896, v9
  v_lshl_add_u32 v9, v8, 5, v9
  buffer_load_dwordx4 v[84:87], v9, s[52:55], 0 offen
  buffer_load_dwordx4 v[88:91], v9, s[52:55], 0 offen offset:16
  v_mul_u32_u24 v6, 14336, v6
  v_lshl_add_u32 v6, v7, 4, v6
  v_lshl_add_u32 v92, v8, 9, v6
  v_lshrrev_b32 v7, 2, v8
  v_lshl_add_u32 v6, v7, 11, v6
  v_and_b32 v7, 3, v8
  v_lshl_add_u32 v93, v7, 8, v6
  s_mov_b32 s72, s38
  s_and_b32 s73, s39, 0xffff
  s_mov_b32 s74, 7168
  s_mov_b32 s75, 0x20000
  v_min_u32 v6, 223, v0
  v_lshrrev_b32 v7, 3, v6
  v_and_b32 v6, 7, v6
  v_mul_u32_u24 v9, 896, v6
  v_lshl_add_u32 v9, v7, 5, v9
  buffer_load_dwordx4 v[36:39], v9, s[72:75], 0 offen
  buffer_load_dwordx4 v[40:43], v9, s[72:75], 0 offen offset:16
  v_lshlrev_b32 v7, 8, v7
  v_lshl_add_u32 v94, v6, 4, v7
  s_lshl_b32 s26, s17, 9
  s_waitcnt vmcnt(20) lgkmcnt(0)
  s_cmp_lg_u32 s16, 3
  s_cbranch_scc1 w3_20
  s_waitcnt vmcnt(4)
w3_20:
  ds_read_b128 v[52:55], v32 offset:0
  ds_read_b128 v[56:59], v33 offset:0
  ds_read_b128 v[60:63], v34 offset:0
  ds_read_b128 v[64:67], v35 offset:0
  s_waitcnt lgkmcnt(3)
  v_mfma_f32_16x16x32_bf16 v[96:99], v[52:55], v[128:131], 0
  v_mfma_f32_16x16x32_bf16 v[100:103], v[52:55], v[160:163], 0
  v_mfma_f32_16x16x32_bf16 v[104:107], v[52:55], v[192:195], 0
  v_mfma_f32_16x16x32_bf16 v[108:111], v[52:55], v[224:227], 0
  ds_read_b128 v[52:55], v32 offset:256
  s_waitcnt lgkmcnt(3)
  v_mfma_f32_16x16x32_bf16 v[96:99], v[56:59], v[132:135], v[96:99]
  v_mfma_f32_16x16x32_bf16 v[100:103], v[56:59], v[164:167], v[100:103]
  v_mfma_f32_16x16x32_bf16 v[104:107], v[56:59], v[196:199], v[104:107]
  v_mfma_f32_16x16x32_bf16 v[108:111], v[56:59], v[228:231], v[108:111]
  ds_read_b128 v[56:59], v33 offset:256
  s_waitcnt lgkmcnt(3)
  v_mfma_f32_16x16x32_bf16 v[96:99], v[60:63], v[136:139], v[96:99]
  v_mfma_f32_16x16x32_bf16 v[100:103], v[60:63], v[168:171], v[100:103]
  v_mfma_f32_16x16x32_bf16 v[104:107], v[60:63], v[200:203], v[104:107]
  v_mfma_f32_16x16x32_bf16 v[108:111], v[60:63], v[232:235], v[108:111]
  ds_read_b128 v[60:63], v34 offset:256
  s_waitcnt lgkmcnt(3)
  v_mfma_f32_16x16x32_bf16 v[96:99], v[64:67], v[140:143], v[96:99]
  v_mfma_f32_16x16x32_bf16 v[100:103], v[64:67], v[172:175], v[100:103]
  v_mfma_f32_16x16x32_bf16 v[104:107], v[64:67], v[204:207], v[104:107]
  v_mfma_f32_16x16x32_bf16 v[108:111], v[64:67], v[236:239], v[108:111]
  ds_read_b128 v[64:67], v35 offset:256
  s_waitcnt lgkmcnt(3)
  v_mfma_f32_16x16x32_bf16 v[96:99], v[52:55], v[144:147], v[96:99]
  v_mfma_f32_16x16x32_bf16 v[100:103], v[52:55], v[176:179], v[100:103]
  v_mfma_f32_16x16x32_bf16 v[104:107], v[52:55], v[208:211], v[104:107]
  v_mfma_f32_16x16x32_bf16 v[108:111], v[52:55], v[240:243], v[108:111]
  ds_read_b128 v[52:55], v32 offset:2048
  s_waitcnt lgkmcnt(3)
  v_mfma_f32_16x16x32_bf16 v[96:99], v[56:59], v[148:151], v[96:99]
  v_mfma_f32_16x16x32_bf16 v[100:103], v[56:59], v[180:183], v[100:103]
  v_mfma_f32_16x16x32_bf16 v[104:107], v[56:59], v[212:215], v[104:107]
  v_mfma_f32_16x16x32_bf16 v[108:111], v[56:59], v[244:247], v[108:111]
  ds_read_b128 v[56:59], v33 offset:2048
  s_waitcnt lgkmcnt(3)
  v_mfma_f32_16x16x32_bf16 v[96:99], v[60:63], v[152:155], v[96:99]
  v_mfma_f32_16x16x32_bf16 v[100:103], v[60:63], v[184:187], v[100:103]
  v_mfma_f32_16x16x32_bf16 v[104:107], v[60:63], v[216:219], v[104:107]
  v_mfma_f32_16x16x32_bf16 v[108:111], v[60:63], v[248:251], v[108:111]
  ds_read_b128 v[60:63], v34 offset:2048
  s_waitcnt lgkmcnt(3)
  v_mfma_f32_16x16x32_bf16 v[96:99], v[64:67], v[156:159], v[96:99]
  v_mfma_f32_16x16x32_bf16 v[100:103], v[64:67], v[188:191], v[100:103]
  v_mfma_f32_16x16x32_bf16 v[104:107], v[64:67], v[220:223], v[104:107]
  v_mfma_f32_16x16x32_bf16 v[108:111], v[64:67], v[252:255], v[108:111]
  ds_read_b128 v[64:67], v35 offset:2048
  s_waitcnt lgkmcnt(3)
  v_mfma_f32_16x16x32_bf16 v[112:115], v[52:55], v[128:131], 0
  v_mfma_f32_16x16x32_bf16 v[116:119], v[52:55], v[160:163], 0
  v_mfma_f32_16x16x32_bf16 v[120:123], v[52:55], v[192:195], 0
  v_mfma_f32_16x16x32_bf16 v[124:127], v[52:55], v[224:227], 0
  ds_read_b128 v[52:55], v32 offset:2304
  s_waitcnt lgkmcnt(3)
  v_mfma_f32_16x16x32_bf16 v[112:115], v[56:59], v[132:135], v[112:115]
  v_mfma_f32_16x16x32_bf16 v[116:119], v[56:59], v[164:167], v[116:119]
  v_mfma_f32_16x16x32_bf16 v[120:123], v[56:59], v[196:199], v[120:123]
  v_mfma_f32_16x16x32_bf16 v[124:127], v[56:59], v[228:231], v[124:127]
  ds_read_b128 v[56:59], v33 offset:2304
  s_waitcnt lgkmcnt(3)
  v_mfma_f32_16x16x32_bf16 v[112:115], v[60:63], v[136:139], v[112:115]
  v_mfma_f32_16x16x32_bf16 v[116:119], v[60:63], v[168:171], v[116:119]
  v_mfma_f32_16x16x32_bf16 v[120:123], v[60:63], v[200:203], v[120:123]
  v_mfma_f32_16x16x32_bf16 v[124:127], v[60:63], v[232:235], v[124:127]
  ds_read_b128 v[60:63], v34 offset:2304
  s_waitcnt lgkmcnt(3)
  v_mfma_f32_16x16x32_bf16 v[112:115], v[64:67], v[140:143], v[112:115]
  v_mfma_f32_16x16x32_bf16 v[116:119], v[64:67], v[172:175], v[116:119]
  v_mfma_f32_16x16x32_bf16 v[120:123], v[64:67], v[204:207], v[120:123]
  v_mfma_f32_16x16x32_bf16 v[124:127], v[64:67], v[236:239], v[124:127]
  ds_read_b128 v[64:67], v35 offset:2304
  s_waitcnt lgkmcnt(3)
  v_mfma_f32_16x16x32_bf16 v[112:115], v[52:55], v[144:147], v[112:115]
  v_mfma_f32_16x16x32_bf16 v[116:119], v[52:55], v[176:179], v[116:119]
  v_mfma_f32_16x16x32_bf16 v[120:123], v[52:55], v[208:211], v[120:123]
  v_mfma_f32_16x16x32_bf16 v[124:127], v[52:55], v[240:243], v[124:127]
  s_waitcnt lgkmcnt(2)
  v_mfma_f32_16x16x32_bf16 v[112:115], v[56:59], v[148:151], v[112:115]
  v_mfma_f32_16x16x32_bf16 v[116:119], v[56:59], v[180:183], v[116:119]
  v_mfma_f32_16x16x32_bf16 v[120:123], v[56:59], v[212:215], v[120:123]
  v_mfma_f32_16x16x32_bf16 v[124:127], v[56:59], v[244:247], v[124:127]
  s_waitcnt lgkmcnt(1)
  v_mfma_f32_16x16x32_bf16 v[112:115], v[60:63], v[152:155], v[112:115]
  v_mfma_f32_16x16x32_bf16 v[116:119], v[60:63], v[184:187], v[116:119]
  v_mfma_f32_16x16x32_bf16 v[120:123], v[60:63], v[216:219], v[120:123]
  v_mfma_f32_16x16x32_bf16 v[124:127], v[60:63], v[248:251], v[124:127]
  s_waitcnt lgkmcnt(0)
  v_mfma_f32_16x16x32_bf16 v[112:115], v[64:67], v[156:159], v[112:115]
  v_mfma_f32_16x16x32_bf16 v[116:119], v[64:67], v[188:191], v[116:119]
  v_mfma_f32_16x16x32_bf16 v[120:123], v[64:67], v[220:223], v[120:123]
  v_mfma_f32_16x16x32_bf16 v[124:127], v[64:67], v[252:255], v[124:127]
  s_lshl_b32 s30, s28, 10
  v_cvt_pk_bf16_f32 v68, v96, v97
  v_cvt_pk_bf16_f32 v69, v98, v99
  v_cvt_pk_bf16_f32 v70, v112, v113
  v_cvt_pk_bf16_f32 v71, v114, v115
  buffer_store_dwordx4 v[68:71], v12, s[8:11], s30 offen sc1
  v_cvt_pk_bf16_f32 v72, v100, v101
  v_cvt_pk_bf16_f32 v73, v102, v103
  v_cvt_pk_bf16_f32 v74, v116, v117
  v_cvt_pk_bf16_f32 v75, v118, v119
  buffer_store_dwordx4 v[72:75], v13, s[8:11], s30 offen sc1
  v_cvt_pk_bf16_f32 v76, v104, v105
  v_cvt_pk_bf16_f32 v77, v106, v107
  v_cvt_pk_bf16_f32 v78, v120, v121
  v_cvt_pk_bf16_f32 v79, v122, v123
  buffer_store_dwordx4 v[76:79], v14, s[8:11], s30 offen sc1
  v_cvt_pk_bf16_f32 v80, v108, v109
  v_cvt_pk_bf16_f32 v81, v110, v111
  v_cvt_pk_bf16_f32 v82, v124, v125
  v_cvt_pk_bf16_f32 v83, v126, v127
  buffer_store_dwordx4 v[80:83], v15, s[8:11], s30 offen sc1
  s_cmp_eq_u32 s16, 3
  s_cbranch_scc1 bj_w3
  s_waitcnt vmcnt(8)
  ds_read_b128 v[52:55], v32 offset:16384
  ds_read_b128 v[56:59], v33 offset:16384
  ds_read_b128 v[60:63], v34 offset:16384
  ds_read_b128 v[64:67], v35 offset:16384
  s_waitcnt lgkmcnt(3)
  v_mfma_f32_16x16x32_bf16 v[96:99], v[52:55], v[128:131], 0
  v_mfma_f32_16x16x32_bf16 v[100:103], v[52:55], v[160:163], 0
  v_mfma_f32_16x16x32_bf16 v[104:107], v[52:55], v[192:195], 0
  v_mfma_f32_16x16x32_bf16 v[108:111], v[52:55], v[224:227], 0
  ds_read_b128 v[52:55], v32 offset:16640
  s_waitcnt lgkmcnt(3)
  v_mfma_f32_16x16x32_bf16 v[96:99], v[56:59], v[132:135], v[96:99]
  v_mfma_f32_16x16x32_bf16 v[100:103], v[56:59], v[164:167], v[100:103]
  v_mfma_f32_16x16x32_bf16 v[104:107], v[56:59], v[196:199], v[104:107]
  v_mfma_f32_16x16x32_bf16 v[108:111], v[56:59], v[228:231], v[108:111]
  ds_read_b128 v[56:59], v33 offset:16640
  s_waitcnt lgkmcnt(3)
  v_mfma_f32_16x16x32_bf16 v[96:99], v[60:63], v[136:139], v[96:99]
  v_mfma_f32_16x16x32_bf16 v[100:103], v[60:63], v[168:171], v[100:103]
  v_mfma_f32_16x16x32_bf16 v[104:107], v[60:63], v[200:203], v[104:107]
  v_mfma_f32_16x16x32_bf16 v[108:111], v[60:63], v[232:235], v[108:111]
  ds_read_b128 v[60:63], v34 offset:16640
  s_waitcnt lgkmcnt(3)
  v_mfma_f32_16x16x32_bf16 v[96:99], v[64:67], v[140:143], v[96:99]
  v_mfma_f32_16x16x32_bf16 v[100:103], v[64:67], v[172:175], v[100:103]
  v_mfma_f32_16x16x32_bf16 v[104:107], v[64:67], v[204:207], v[104:107]
  v_mfma_f32_16x16x32_bf16 v[108:111], v[64:67], v[236:239], v[108:111]
  ds_read_b128 v[64:67], v35 offset:16640
  s_waitcnt lgkmcnt(3)
  v_mfma_f32_16x16x32_bf16 v[96:99], v[52:55], v[144:147], v[96:99]
  v_mfma_f32_16x16x32_bf16 v[100:103], v[52:55], v[176:179], v[100:103]
  v_mfma_f32_16x16x32_bf16 v[104:107], v[52:55], v[208:211], v[104:107]
  v_mfma_f32_16x16x32_bf16 v[108:111], v[52:55], v[240:243], v[108:111]
  ds_read_b128 v[52:55], v32 offset:18432
  s_waitcnt lgkmcnt(3)
  v_mfma_f32_16x16x32_bf16 v[96:99], v[56:59], v[148:151], v[96:99]
  v_mfma_f32_16x16x32_bf16 v[100:103], v[56:59], v[180:183], v[100:103]
  v_mfma_f32_16x16x32_bf16 v[104:107], v[56:59], v[212:215], v[104:107]
  v_mfma_f32_16x16x32_bf16 v[108:111], v[56:59], v[244:247], v[108:111]
  ds_read_b128 v[56:59], v33 offset:18432
  s_waitcnt lgkmcnt(3)
  v_mfma_f32_16x16x32_bf16 v[96:99], v[60:63], v[152:155], v[96:99]
  v_mfma_f32_16x16x32_bf16 v[100:103], v[60:63], v[184:187], v[100:103]
  v_mfma_f32_16x16x32_bf16 v[104:107], v[60:63], v[216:219], v[104:107]
  v_mfma_f32_16x16x32_bf16 v[108:111], v[60:63], v[248:251], v[108:111]
  ds_read_b128 v[60:63], v34 offset:18432
  s_waitcnt lgkmcnt(3)
  v_mfma_f32_16x16x32_bf16 v[96:99], v[64:67], v[156:159], v[96:99]
  v_mfma_f32_16x16x32_bf16 v[100:103], v[64:67], v[188:191], v[100:103]
  v_mfma_f32_16x16x32_bf16 v[104:107], v[64:67], v[220:223], v[104:107]
  v_mfma_f32_16x16x32_bf16 v[108:111], v[64:67], v[252:255], v[108:111]
  ds_read_b128 v[64:67], v35 offset:18432
  s_waitcnt lgkmcnt(3)
  v_mfma_f32_16x16x32_bf16 v[112:115], v[52:55], v[128:131], 0
  v_mfma_f32_16x16x32_bf16 v[116:119], v[52:55], v[160:163], 0
  v_mfma_f32_16x16x32_bf16 v[120:123], v[52:55], v[192:195], 0
  v_mfma_f32_16x16x32_bf16 v[124:127], v[52:55], v[224:227], 0
  ds_read_b128 v[52:55], v32 offset:18688
  s_waitcnt lgkmcnt(3)
  v_mfma_f32_16x16x32_bf16 v[112:115], v[56:59], v[132:135], v[112:115]
  v_mfma_f32_16x16x32_bf16 v[116:119], v[56:59], v[164:167], v[116:119]
  v_mfma_f32_16x16x32_bf16 v[120:123], v[56:59], v[196:199], v[120:123]
  v_mfma_f32_16x16x32_bf16 v[124:127], v[56:59], v[228:231], v[124:127]
  ds_read_b128 v[56:59], v33 offset:18688
  s_waitcnt lgkmcnt(3)
  v_mfma_f32_16x16x32_bf16 v[112:115], v[60:63], v[136:139], v[112:115]
  v_mfma_f32_16x16x32_bf16 v[116:119], v[60:63], v[168:171], v[116:119]
  v_mfma_f32_16x16x32_bf16 v[120:123], v[60:63], v[200:203], v[120:123]
  v_mfma_f32_16x16x32_bf16 v[124:127], v[60:63], v[232:235], v[124:127]
  ds_read_b128 v[60:63], v34 offset:18688
  s_waitcnt lgkmcnt(3)
  v_mfma_f32_16x16x32_bf16 v[112:115], v[64:67], v[140:143], v[112:115]
  v_mfma_f32_16x16x32_bf16 v[116:119], v[64:67], v[172:175], v[116:119]
  v_mfma_f32_16x16x32_bf16 v[120:123], v[64:67], v[204:207], v[120:123]
  v_mfma_f32_16x16x32_bf16 v[124:127], v[64:67], v[236:239], v[124:127]
  ds_read_b128 v[64:67], v35 offset:18688
  s_waitcnt lgkmcnt(3)
  v_mfma_f32_16x16x32_bf16 v[112:115], v[52:55], v[144:147], v[112:115]
  v_mfma_f32_16x16x32_bf16 v[116:119], v[52:55], v[176:179], v[116:119]
  v_mfma_f32_16x16x32_bf16 v[120:123], v[52:55], v[208:211], v[120:123]
  v_mfma_f32_16x16x32_bf16 v[124:127], v[52:55], v[240:243], v[124:127]
  s_waitcnt lgkmcnt(2)
  v_mfma_f32_16x16x32_bf16 v[112:115], v[56:59], v[148:151], v[112:115]
  v_mfma_f32_16x16x32_bf16 v[116:119], v[56:59], v[180:183], v[116:119]
  v_mfma_f32_16x16x32_bf16 v[120:123], v[56:59], v[212:215], v[120:123]
  v_mfma_f32_16x16x32_bf16 v[124:127], v[56:59], v[244:247], v[124:127]
  s_waitcnt lgkmcnt(1)
  v_mfma_f32_16x16x32_bf16 v[112:115], v[60:63], v[152:155], v[112:115]
  v_mfma_f32_16x16x32_bf16 v[116:119], v[60:63], v[184:187], v[116:119]
  v_mfma_f32_16x16x32_bf16 v[120:123], v[60:63], v[216:219], v[120:123]
  v_mfma_f32_16x16x32_bf16 v[124:127], v[60:63], v[248:251], v[124:127]
  s_waitcnt lgkmcnt(0)
  v_mfma_f32_16x16x32_bf16 v[112:115], v[64:67], v[156:159], v[112:115]
  v_mfma_f32_16x16x32_bf16 v[116:119], v[64:67], v[188:191], v[116:119]
  v_mfma_f32_16x16x32_bf16 v[120:123], v[64:67], v[220:223], v[120:123]
  v_mfma_f32_16x16x32_bf16 v[124:127], v[64:67], v[252:255], v[124:127]
  s_lshl_b32 s30, s29, 10
  v_cvt_pk_bf16_f32 v68, v96, v97
  v_cvt_pk_bf16_f32 v69, v98, v99
  v_cvt_pk_bf16_f32 v70, v112, v113
  v_cvt_pk_bf16_f32 v71, v114, v115
  buffer_store_dwordx4 v[68:71], v12, s[8:11], s30 offen sc1
  v_cvt_pk_bf16_f32 v72, v100, v101
  v_cvt_pk_bf16_f32 v73, v102, v103
  v_cvt_pk_bf16_f32 v74, v116, v117
  v_cvt_pk_bf16_f32 v75, v118, v119
  buffer_store_dwordx4 v[72:75], v13, s[8:11], s30 offen sc1
  v_cvt_pk_bf16_f32 v76, v104, v105
  v_cvt_pk_bf16_f32 v77, v106, v107
  v_cvt_pk_bf16_f32 v78, v120, v121
  v_cvt_pk_bf16_f32 v79, v122, v123
  buffer_store_dwordx4 v[76:79], v14, s[8:11], s30 offen sc1
  v_cvt_pk_bf16_f32 v80, v108, v109
  v_cvt_pk_bf16_f32 v81, v110, v111
  v_cvt_pk_bf16_f32 v82, v124, v125
  v_cvt_pk_bf16_f32 v83, v126, v127
  buffer_store_dwordx4 v[80:83], v15, s[8:11], s30 offen sc1
bj_w3:
  s_lshl_b32 s77, s19, 8
  s_lshl_b32 s21, s17, 4
  s_add_u32 s77, s77, s21
  s_cmp_lg_u32 s31, 0
  s_cselect_b32 s21, 8, 0
  s_add_u32 s77, s77, s21
  s_add_u32 s77, s77, 88600576
  s_add_u32 s78, s77, 2048
  s_cmp_lg_u32 s66, 0
  s_cbranch_scc1 bj_cf
  s_cmp_lg_u32 s16, 0
  s_cbranch_scc1 w0_21
  s_waitcnt vmcnt(8)
  v_readfirstlane_b32 s70, v46
  s_cmp_lg_u32 s70, 0
  s_cbranch_scc1 bj_nz
  v_mov_b32 v45, 128
  v_mov_b32 v46, s88
  v_mov_b32 v47, s89
  v_mov_b32 v48, 0
  v_mov_b32 v49, 0
  s_mov_b64 exec, 1
  buffer_atomic_cmpswap_x2 v[46:49], v45, s[12:15], 0 offen sc0
  s_mov_b64 exec, -1
  s_waitcnt vmcnt(0)
  v_readfirstlane_b32 s70, v46
  s_cmp_lg_u32 s70, 0
  s_cbranch_scc1 bj_nz
  v_mov_b32 v46, s88
  v_mov_b32 v47, s89
bj_nz:
w0_21:
  v_mov_b32 v45, 160000
  s_add_u32 s101, s101, 1
  s_barrier
  s_mov_b64 exec, 1
  s_cmp_lg_u32 s16, 0
  s_cbranch_scc1 w0_22
  ds_write_b32 v45, v44 offset:0
  ds_write_b32 v45, v46 offset:4
  ds_write_b32 v45, v47 offset:8
  s_waitcnt lgkmcnt(0)
  v_mov_b32 v44, s101
  ds_write_b32 v45, v44 offset:16
  s_waitcnt lgkmcnt(0)
w0_22:
  s_mov_b64 exec, -1
  s_barrier
  ds_read_b32 v44, v45 offset:0
  ds_read_b32 v46, v45 offset:4
  ds_read_b32 v47, v45 offset:8
  ds_read_b32 v45, v45 offset:16
  s_waitcnt lgkmcnt(0)
  v_readfirstlane_b32 s70, v44
  v_readfirstlane_b32 s88, v46
  v_readfirstlane_b32 s89, v47
  v_cmp_ne_u32 vcc, s101, v45
  s_cbranch_vccnz ch_end
  s_mov_b32 s66, 1
  s_bitcmp1_b32 s70, s3
  s_cbranch_scc1 m_reclaim
bj_cf:
  s_barrier
  s_mov_b32 s56, s40
  s_and_b32 s57, s41, 0xffff
  s_mov_b32 s58, 3670016
  s_mov_b32 s59, 0x20000
  s_mov_b32 s60, s42
  s_and_b32 s61, s43, 0xffff
  s_mov_b32 s62, 3670016
  s_mov_b32 s63, 0x20000
  s_add_u32 s28, s31, s19
  v_lshrrev_b32 v5, 5, v1
  v_and_b32 v6, 31, v1
  v_xor_b32 v6, v6, v5
  v_lshlrev_b32 v6, 4, v6
  v_lshl_add_u32 v6, v5, 13, v6
  s_lshl_b32 s20, s16, 6
  v_xor_b32 v7, s20, v6
  s_lshl_b32 s22, s28, 18
  s_lshl_b32 s21, s16, 16
  s_add_u32 s22, s22, s21
  s_add_u32 s22, s22, s26
  s_lshl_b32 m0, s16, 12
  v_xor_b32 v8, 0, v7
  buffer_load_dwordx4 v8, s[56:59], s22 offen offset:0 lds
  v_xor_b32 v8, 32, v7
  v_add_u32 v8, 15360, v8
  buffer_load_dwordx4 v8, s[56:59], s22 offen offset:1024 lds
  v_xor_b32 v8, 0, v7
  v_add_u32 v8, 30720, v8
  buffer_load_dwordx4 v8, s[56:59], s22 offen offset:2048 lds
  v_xor_b32 v8, 32, v7
  v_add_u32 v8, 46080, v8
  buffer_load_dwordx4 v8, s[56:59], s22 offen offset:3072 lds
  v_xor_b32 v16, 0, v6
  v_xor_b32 v17, 32, v6
  v_add_u32 v17, 31744, v17
  v_xor_b32 v18, 64, v6
  v_add_u32 v18, 129024, v18
  v_xor_b32 v19, 96, v6
  v_add_u32 v19, 160768, v19
  v_xor_b32 v20, 128, v6
  v_add_u32 v20, 262144, v20
  v_xor_b32 v21, 160, v6
  v_add_u32 v21, 293888, v21
  v_xor_b32 v22, 192, v6
  v_add_u32 v22, 391168, v22
  v_xor_b32 v23, 224, v6
  v_add_u32 v23, 422912, v23
  s_lshr_b32 s20, s16, 1
  s_lshl_b32 s20, s20, 16
  s_and_b32 s21, s16, 1
  s_lshl_b32 s21, s21, 14
  s_add_u32 s20, s20, s21
  s_add_u32 s29, s20, s26
  s_mul_i32 s25, s16, 24576
  s_add_u32 s25, s25, 16384
  s_add_u32 s22, s29, 2097152
  s_add_u32 m0, s25, 0
  s_nop 0
  buffer_load_dwordx4 v16, s[60:63], s22 offen offset:0 lds
  buffer_load_dwordx4 v17, s[60:63], s22 offen offset:1024 lds
  buffer_load_dwordx4 v18, s[60:63], s22 offen offset:2048 lds
  buffer_load_dwordx4 v19, s[60:63], s22 offen offset:3072 lds
  s_add_u32 m0, s25, 4096
  s_nop 0
  buffer_load_dwordx4 v20, s[60:63], s22 offen offset:0 lds
  buffer_load_dwordx4 v21, s[60:63], s22 offen offset:1024 lds
  buffer_load_dwordx4 v22, s[60:63], s22 offen offset:2048 lds
  buffer_load_dwordx4 v23, s[60:63], s22 offen offset:3072 lds
  s_waitcnt vmcnt(12)
  s_barrier
  s_cmp_lg_u32 s16, 0
  s_cbranch_scc1 pub_23
  v_mul_u32_u24 v50, 2048, v1
  v_mov_b32 v48, s88
  v_mov_b32 v49, s89
  s_mov_b64 exec, 1
  buffer_store_dwordx2 v[48:49], v50, s[8:11], s77 offen sc1
  s_mov_b64 exec, -1
pub_23:
  s_cmp_ge_u32 s18, 70
  s_cbranch_scc1 bk_nm
  s_mov_b32 s20, 71565312
  buffer_store_dwordx4 v[84:87], v92, s[8:11], s20 offen sc1
  buffer_store_dwordx4 v[88:91], v92, s[8:11], s20 offen offset:256 sc1
  s_cmp_lg_u32 s18, 0
  s_cbranch_scc1 bk_nm
  v_min_u32 v104, -2, v36
  v_min_u32 v108, -2, v37
  v_min_u32 v105, -2, v38
  v_min_u32 v109, -2, v39
  v_min_u32 v106, -2, v40
  v_min_u32 v110, -2, v41
  v_min_u32 v107, -2, v42
  v_min_u32 v111, -2, v43
  s_mov_b32 s20, 88653824
  s_mov_b32 s21, 88080384
  buffer_store_dwordx4 v[104:107], v94, s[8:11], s20 offen sc1
  buffer_store_dwordx4 v[108:111], v94, s[8:11], s20 offen offset:128 sc1
  buffer_store_dwordx4 v[104:107], v94, s[8:11], s21 offen sc1
  buffer_store_dwordx4 v[108:111], v94, s[8:11], s21 offen offset:128 sc1
bk_nm:
  s_mov_b32 s23, 88653824
  v_add_u32 v6, 448, v95
  v_subrev_u32 v7, 1152, v6
  v_mov_b32 v52, -1
  v_mov_b32 v9, 0
  v_cmp_gt_u32 vcc, 128, v7
  s_nop 1
  v_cndmask_b32 v52, v52, v9, vcc
  v_mov_b32 v53, v52
  v_mov_b32 v54, v52
  v_mov_b32 v55, v52
  v_lshlrev_b32 v8, 4, v6
  v_mov_b32 v9, 0x10000000
  v_cmp_lt_u32 vcc, 25599, v6
  s_nop 1
  v_cndmask_b32 v8, v8, v9, vcc
  buffer_store_dwordx4 v[52:55], v8, s[8:11], s23 offen sc1
  s_mov_b32 s23, 87957504
  v_add_u32 v6, 448, v95
  v_cmp_gt_u32 vcc, 7680, v95
  s_nop 1
  v_cndmask_b32 v6, v6, v95, vcc
  v_subrev_u32 v7, 36352, v6
  v_mov_b32 v56, -1
  v_mov_b32 v9, 0
  v_cmp_gt_u32 vcc, 1048576, v7
  s_nop 1
  v_cndmask_b32 v56, v56, v9, vcc
  v_mov_b32 v57, v56
  v_mov_b32 v58, v56
  v_mov_b32 v59, v56
  v_lshlrev_b32 v8, 4, v6
  v_mov_b32 v9, 0x10000000
  v_cmp_lt_u32 vcc, 40191, v6
  s_nop 1
  v_cndmask_b32 v8, v8, v9, vcc
  buffer_store_dwordx4 v[56:59], v8, s[8:11], s23 offen sc1
  s_add_u32 s22, s29, 2621440
  s_add_u32 m0, s25, 8192
  s_nop 0
  buffer_load_dwordx4 v16, s[60:63], s22 offen offset:0 lds
  buffer_load_dwordx4 v17, s[60:63], s22 offen offset:1024 lds
  buffer_load_dwordx4 v18, s[60:63], s22 offen offset:2048 lds
  buffer_load_dwordx4 v19, s[60:63], s22 offen offset:3072 lds
  s_add_u32 m0, s25, 12288
  s_nop 0
  buffer_load_dwordx4 v20, s[60:63], s22 offen offset:0 lds
  buffer_load_dwordx4 v21, s[60:63], s22 offen offset:1024 lds
  buffer_load_dwordx4 v22, s[60:63], s22 offen offset:2048 lds
  buffer_load_dwordx4 v23, s[60:63], s22 offen offset:3072 lds
  s_add_u32 s22, s29, 3145728
  s_add_u32 m0, s25, 16384
  s_nop 0
  buffer_load_dwordx4 v16, s[60:63], s22 offen offset:0 lds
  buffer_load_dwordx4 v17, s[60:63], s22 offen offset:1024 lds
  buffer_load_dwordx4 v18, s[60:63], s22 offen offset:2048 lds
  buffer_load_dwordx4 v19, s[60:63], s22 offen offset:3072 lds
  s_add_u32 m0, s25, 20480
  s_nop 0
  buffer_load_dwordx4 v20, s[60:63], s22 offen offset:0 lds
  buffer_load_dwordx4 v21, s[60:63], s22 offen offset:1024 lds
  buffer_load_dwordx4 v22, s[60:63], s22 offen offset:2048 lds
  buffer_load_dwordx4 v23, s[60:63], s22 offen offset:3072 lds
  v_mov_b32 v250, s68
  s_or_b32 s20, s69, s16
  s_cbranch_scc1 bj_ht
  s_cmp_lg_u32 s16, 0
  s_cbranch_scc1 w0_24
  v_mov_b32 v250, 1
  v_mov_b32 v251, 192
  s_mov_b64 exec, 1
  buffer_atomic_add v250, v251, s[12:15], 0 offen sc0
  s_mov_b64 exec, -1
w0_24:
  s_branch bj_h2
bj_ht:
  buffer_load_dword v251, off, s[8:11], s77
bj_h2:
  v_lshrrev_b32 v7, 2, v4
  v_lshlrev_b32 v7, 3, v7
  v_and_b32 v8, 3, v4
  v_add_u32 v7, v7, v8
  v_xor_b32 v10, v3, v4
  v_lshlrev_b32 v10, 4, v10
  v_lshl_add_u32 v11, v4, 9, v10
  v_add_u32 v11, s25, v11
  v_lshl_add_u32 v10, v7, 9, v10
  v_xor_b32 v32, 0, v10
  v_xor_b32 v36, 0, v11
  v_xor_b32 v33, 64, v10
  v_xor_b32 v37, 64, v11
  v_xor_b32 v34, 128, v10
  v_xor_b32 v38, 128, v11
  v_xor_b32 v35, 192, v10
  v_xor_b32 v39, 192, v11
  s_mul_i32 s30, s17, 401408
  s_mul_i32 s20, s16, 14336
  s_add_u32 s30, s30, s20
  s_lshl_b32 s20, s28, 10
  s_add_u32 s30, s30, s20
  s_mov_b32 s24, 1035512379
  s_lshl_b32 s20, s17, 7
  s_lshl_b32 s28, s28, 3
  s_add_u32 s28, s28, s20
  s_add_u32 s28, s28, 88635392
  s_waitcnt vmcnt(1)
  s_barrier
  s_cmp_lg_u32 s16, 0
  s_cbranch_scc1 w0_25
  v_mul_u32_u24 v50, 2048, v1
  v_mov_b32 v48, s88
  v_mov_b32 v49, s89
  s_mov_b64 exec, 511
  buffer_store_dwordx2 v[48:49], v50, s[8:11], s78 offen sc1
  s_mov_b64 exec, -1
w0_25:
  ds_read_b128 v[128:131], v32 offset:0
  ds_read_b128 v[132:135], v32 offset:2048
  ds_read_b128 v[136:139], v36 offset:0
  ds_read_b128 v[140:143], v36 offset:8192
  ds_read_b128 v[144:147], v36 offset:16384
  ds_read_b128 v[148:151], v33 offset:0
  ds_read_b128 v[152:155], v33 offset:2048
  ds_read_b128 v[156:159], v37 offset:0
  ds_read_b128 v[160:163], v37 offset:8192
  ds_read_b128 v[164:167], v37 offset:16384
  ds_read_b128 v[168:171], v34 offset:0
  ds_read_b128 v[172:175], v34 offset:2048
  ds_read_b128 v[176:179], v38 offset:0
  ds_read_b128 v[180:183], v38 offset:8192
  ds_read_b128 v[184:187], v38 offset:16384
  s_waitcnt lgkmcnt(10)
  v_mfma_f32_16x16x32_bf16 v[96:99], v[128:131], v[136:139], 0
  v_mfma_f32_16x16x32_bf16 v[100:103], v[132:135], v[136:139], 0
  v_mfma_f32_16x16x32_bf16 v[104:107], v[128:131], v[140:143], 0
  v_mfma_f32_16x16x32_bf16 v[108:111], v[132:135], v[140:143], 0
  v_mfma_f32_16x16x32_bf16 v[112:115], v[128:131], v[144:147], 0
  v_mfma_f32_16x16x32_bf16 v[116:119], v[132:135], v[144:147], 0
  ds_read_b128 v[128:131], v35 offset:0
  ds_read_b128 v[132:135], v35 offset:2048
  ds_read_b128 v[136:139], v39 offset:0
  ds_read_b128 v[140:143], v39 offset:8192
  ds_read_b128 v[144:147], v39 offset:16384
  s_waitcnt lgkmcnt(10)
  v_mfma_f32_16x16x32_bf16 v[96:99], v[148:151], v[156:159], v[96:99]
  v_mfma_f32_16x16x32_bf16 v[100:103], v[152:155], v[156:159], v[100:103]
  v_mfma_f32_16x16x32_bf16 v[104:107], v[148:151], v[160:163], v[104:107]
  v_mfma_f32_16x16x32_bf16 v[108:111], v[152:155], v[160:163], v[108:111]
  v_mfma_f32_16x16x32_bf16 v[112:115], v[148:151], v[164:167], v[112:115]
  v_mfma_f32_16x16x32_bf16 v[116:119], v[152:155], v[164:167], v[116:119]
  ds_read_b128 v[148:151], v32 offset:256
  ds_read_b128 v[152:155], v32 offset:2304
  ds_read_b128 v[156:159], v36 offset:256
  ds_read_b128 v[160:163], v36 offset:8448
  ds_read_b128 v[164:167], v36 offset:16640
  s_waitcnt lgkmcnt(10)
  v_mfma_f32_16x16x32_bf16 v[96:99], v[168:171], v[176:179], v[96:99]
  v_mfma_f32_16x16x32_bf16 v[100:103], v[172:175], v[176:179], v[100:103]
  v_mfma_f32_16x16x32_bf16 v[104:107], v[168:171], v[180:183], v[104:107]
  v_mfma_f32_16x16x32_bf16 v[108:111], v[172:175], v[180:183], v[108:111]
  v_mfma_f32_16x16x32_bf16 v[112:115], v[168:171], v[184:187], v[112:115]
  v_mfma_f32_16x16x32_bf16 v[116:119], v[172:175], v[184:187], v[116:119]
  ds_read_b128 v[168:171], v33 offset:256
  ds_read_b128 v[172:175], v33 offset:2304
  ds_read_b128 v[176:179], v37 offset:256
  ds_read_b128 v[180:183], v37 offset:8448
  ds_read_b128 v[184:187], v37 offset:16640
  s_waitcnt lgkmcnt(10)
  v_mfma_f32_16x16x32_bf16 v[96:99], v[128:131], v[136:139], v[96:99]
  v_mfma_f32_16x16x32_bf16 v[100:103], v[132:135], v[136:139], v[100:103]
  v_mfma_f32_16x16x32_bf16 v[104:107], v[128:131], v[140:143], v[104:107]
  v_mfma_f32_16x16x32_bf16 v[108:111], v[132:135], v[140:143], v[108:111]
  v_mfma_f32_16x16x32_bf16 v[112:115], v[128:131], v[144:147], v[112:115]
  v_mfma_f32_16x16x32_bf16 v[116:119], v[132:135], v[144:147], v[116:119]
  ds_read_b128 v[128:131], v34 offset:256
  ds_read_b128 v[132:135], v34 offset:2304
  ds_read_b128 v[136:139], v38 offset:256
  ds_read_b128 v[140:143], v38 offset:8448
  ds_read_b128 v[144:147], v38 offset:16640
  s_waitcnt lgkmcnt(10)
  v_mfma_f32_16x16x32_bf16 v[96:99], v[148:151], v[156:159], v[96:99]
  v_mfma_f32_16x16x32_bf16 v[100:103], v[152:155], v[156:159], v[100:103]
  v_mfma_f32_16x16x32_bf16 v[104:107], v[148:151], v[160:163], v[104:107]
  v_mfma_f32_16x16x32_bf16 v[108:111], v[152:155], v[160:163], v[108:111]
  v_mfma_f32_16x16x32_bf16 v[112:115], v[148:151], v[164:167], v[112:115]
  v_mfma_f32_16x16x32_bf16 v[116:119], v[152:155], v[164:167], v[116:119]
  ds_read_b128 v[148:151], v35 offset:256
  ds_read_b128 v[152:155], v35 offset:2304
  ds_read_b128 v[156:159], v39 offset:256
  ds_read_b128 v[160:163], v39 offset:8448
  ds_read_b128 v[164:167], v39 offset:16640
  s_waitcnt lgkmcnt(10)
  v_mfma_f32_16x16x32_bf16 v[96:99], v[168:171], v[176:179], v[96:99]
  v_mfma_f32_16x16x32_bf16 v[100:103], v[172:175], v[176:179], v[100:103]
  v_mfma_f32_16x16x32_bf16 v[104:107], v[168:171], v[180:183], v[104:107]
  v_mfma_f32_16x16x32_bf16 v[108:111], v[172:175], v[180:183], v[108:111]
  v_mfma_f32_16x16x32_bf16 v[112:115], v[168:171], v[184:187], v[112:115]
  v_mfma_f32_16x16x32_bf16 v[116:119], v[172:175], v[184:187], v[116:119]
  s_waitcnt lgkmcnt(5)
  v_mfma_f32_16x16x32_bf16 v[96:99], v[128:131], v[136:139], v[96:99]
  v_mfma_f32_16x16x32_bf16 v[100:103], v[132:135], v[136:139], v[100:103]
  v_mfma_f32_16x16x32_bf16 v[104:107], v[128:131], v[140:143], v[104:107]
  v_mfma_f32_16x16x32_bf16 v[108:111], v[132:135], v[140:143], v[108:111]
  v_mfma_f32_16x16x32_bf16 v[112:115], v[128:131], v[144:147], v[112:115]
  v_mfma_f32_16x16x32_bf16 v[116:119], v[132:135], v[144:147], v[116:119]
  s_waitcnt lgkmcnt(0)
  v_mfma_f32_16x16x32_bf16 v[96:99], v[148:151], v[156:159], v[96:99]
  v_mfma_f32_16x16x32_bf16 v[100:103], v[152:155], v[156:159], v[100:103]
  v_mfma_f32_16x16x32_bf16 v[104:107], v[148:151], v[160:163], v[104:107]
  v_mfma_f32_16x16x32_bf16 v[108:111], v[152:155], v[160:163], v[108:111]
  v_mfma_f32_16x16x32_bf16 v[112:115], v[148:151], v[164:167], v[112:115]
  v_mfma_f32_16x16x32_bf16 v[116:119], v[152:155], v[164:167], v[116:119]
  v_mul_f32 v96, s24, v96
  v_mul_f32 v97, s24, v97
  v_mul_f32 v98, s24, v98
  v_mul_f32 v99, s24, v99
  v_mul_f32 v100, s24, v100
  v_mul_f32 v101, s24, v101
  v_mul_f32 v102, s24, v102
  v_mul_f32 v103, s24, v103
  v_cvt_pk_bf16_f32 v68, v96, v97
  v_cvt_pk_bf16_f32 v69, v98, v99
  v_cvt_pk_bf16_f32 v70, v100, v101
  v_cvt_pk_bf16_f32 v71, v102, v103
  s_add_u32 s20, s30, 229376
  buffer_store_dwordx4 v[68:71], v2, s[8:11], s20 offen sc1
  v_mul_f32 v104, s24, v104
  v_mul_f32 v105, s24, v105
  v_mul_f32 v106, s24, v106
  v_mul_f32 v107, s24, v107
  v_mul_f32 v108, s24, v108
  v_mul_f32 v109, s24, v109
  v_mul_f32 v110, s24, v110
  v_mul_f32 v111, s24, v111
  v_cvt_pk_bf16_f32 v72, v104, v105
  v_cvt_pk_bf16_f32 v73, v106, v107
  v_cvt_pk_bf16_f32 v74, v108, v109
  v_cvt_pk_bf16_f32 v75, v110, v111
  s_add_u32 s20, s30, 286720
  buffer_store_dwordx4 v[72:75], v2, s[8:11], s20 offen sc1
  v_mul_f32 v112, s24, v112
  v_mul_f32 v113, s24, v113
  v_mul_f32 v114, s24, v114
  v_mul_f32 v115, s24, v115
  v_mul_f32 v116, s24, v116
  v_mul_f32 v117, s24, v117
  v_mul_f32 v118, s24, v118
  v_mul_f32 v119, s24, v119
  v_cvt_pk_bf16_f32 v76, v112, v113
  v_cvt_pk_bf16_f32 v77, v114, v115
  v_cvt_pk_bf16_f32 v78, v116, v117
  v_cvt_pk_bf16_f32 v79, v118, v119
  s_add_u32 s20, s30, 344064
  buffer_store_dwordx4 v[76:79], v2, s[8:11], s20 offen sc1
  s_waitcnt vmcnt(0)
  s_barrier
  s_cmp_lg_u32 s16, 0
  s_cbranch_scc1 pub_26
  v_mul_u32_u24 v26, 2048, v1
  v_mov_b32 v24, s88
  v_mov_b32 v25, s89
  s_mov_b64 exec, 1
  buffer_store_dwordx2 v[24:25], v26, s[8:11], s28 offen sc1
  s_mov_b64 exec, -1
pub_26:
  v_mov_b32 v6, 160000
  s_add_u32 s101, s101, 1
  s_barrier
  s_mov_b64 exec, 1
  s_cmp_lg_u32 s16, 0
  s_cbranch_scc1 w0_27
  ds_write_b32 v6, v250 offset:0
  s_waitcnt lgkmcnt(0)
  v_mov_b32 v250, s101
  ds_write_b32 v6, v250 offset:16
  s_waitcnt lgkmcnt(0)
w0_27:
  s_mov_b64 exec, -1
  s_barrier
  ds_read_b32 v250, v6 offset:0
  ds_read_b32 v6, v6 offset:16
  s_waitcnt lgkmcnt(0)
  v_readfirstlane_b32 s3, v250
  v_cmp_ne_u32 vcc, s101, v6
  s_cbranch_vccnz ch_end
  s_branch wk_have
wk_loop:
  s_waitcnt vmcnt(0) lgkmcnt(0)
  s_cmp_eq_u32 s96, 1
  s_cbranch_scc1 wk_ask
  s_mov_b32 s96, 1
  s_cmp_lg_u32 s16, 0
  s_cbranch_scc1 w0_28
  s_mov_b32 s30, 0
  v_mov_b32 v243, 32
sf_l:
  buffer_load_dword v242, v243, s[12:15], 0 offen sc1
  s_waitcnt vmcnt(0)
  v_readfirstlane_b32 s70, v242
  s_cmp_eq_u32 s70, -1
  s_cbranch_scc1 sf_d
  s_sleep 16
  s_add_u32 s30, s30, 1
  s_cmp_lt_u32 s30, 64
  s_cbranch_scc1 sf_l
  s_mov_b32 s20, 0
  s_mov_b32 s21, 0
  s_mov_b64 exec, 1
sf_c_l:
  s_cmp_lg_u32 s70, -1
  s_cbranch_scc1 sf_c_t
  s_add_u32 s20, s20, 1
  s_cmp_lt_u32 s20, 8
  s_cselect_b32 s20, s20, 0
  s_mov_b32 s70, 0
  s_mov_b32 s3, -1
  s_add_u32 s21, s21, 1
  s_cmp_ge_u32 s21, 1
  s_cbranch_scc1 sf_c_d
sf_c_t:
  s_ff0_i32_b32 s22, s70
  s_lshl_b32 s23, 1, s22
  s_and_b32 s71, s20, 4
  s_mul_i32 s71, s71, 12
  s_lshl_b32 s3, s20, 2
  s_add_u32 s3, s3, s71
  v_mov_b32 v242, s23
  v_mov_b32 v243, 32
  buffer_atomic_or v242, v243, s[12:15], s3 offen sc0
  s_waitcnt vmcnt(0)
  v_readfirstlane_b32 s70, v242
  s_lshl_b32 s3, s20, 5
  s_add_u32 s3, s3, s22
  s_bitcmp1_b32 s70, s22
  s_cbranch_scc1 sf_c_l
sf_c_d:
  s_mov_b64 exec, -1
  v_mov_b32 v242, s3
sf_d:
w0_28:
  v_mov_b32 v243, 160000
  s_add_u32 s101, s101, 1
  s_barrier
  s_mov_b64 exec, 1
  s_cmp_lg_u32 s16, 0
  s_cbranch_scc1 w0_29
  ds_write_b32 v243, v242 offset:0
  s_waitcnt lgkmcnt(0)
  v_mov_b32 v242, s101
  ds_write_b32 v243, v242 offset:16
  s_waitcnt lgkmcnt(0)
w0_29:
  s_mov_b64 exec, -1
  s_barrier
  ds_read_b32 v242, v243 offset:0
  ds_read_b32 v243, v243 offset:16
  s_waitcnt lgkmcnt(0)
  v_readfirstlane_b32 s3, v242
  v_cmp_ne_u32 vcc, s101, v243
  s_cbranch_vccnz ch_end
  s_cmp_eq_u32 s3, -1
  s_cbranch_scc1 wk_ask
  s_load_dwordx8 s[36:43], s[0:1], 56
  s_load_dwordx4 s[44:47], s[0:1], 88
  s_getreg_b32 s67, hwreg(HW_REG_XCC_ID)
  s_and_b32 s67, s67, 7
  s_mov_b32 s66, 1
  s_waitcnt lgkmcnt(0)
  s_branch m_start
wk_ask:
  v_readfirstlane_b32 s22, v250
  s_cmp_ge_u32 s22, 1440
  s_cbranch_scc1 wk_next
  s_cmp_lg_u32 s16, 0
  s_cbranch_scc1 w0_30
  v_mov_b32 v250, 1
  v_mov_b32 v251, 192
  s_mov_b64 exec, 1
  buffer_atomic_add v250, v251, s[12:15], 0 offen sc0
  s_mov_b64 exec, -1
w0_30:
wk_next:
  s_waitcnt vmcnt(0)
  v_mov_b32 v6, 160000
  s_add_u32 s101, s101, 1
  s_barrier
  s_mov_b64 exec, 1
  s_cmp_lg_u32 s16, 0
  s_cbranch_scc1 w0_31
  ds_write_b32 v6, v250 offset:0
  s_waitcnt lgkmcnt(0)
  v_mov_b32 v250, s101
  ds_write_b32 v6, v250 offset:16
  s_waitcnt lgkmcnt(0)
w0_31:
  s_mov_b64 exec, -1
  s_barrier
  ds_read_b32 v250, v6 offset:0
  ds_read_b32 v6, v6 offset:16
  s_waitcnt lgkmcnt(0)
  v_readfirstlane_b32 s3, v250
  v_cmp_ne_u32 vcc, s101, v6
  s_cbranch_vccnz ch_end
wk_have:
  s_cmp_ge_u32 s3, 1440
  s_cbranch_scc1 ch_end
  v_mov_b32 v250, 0
  v_mov_b32 v251, 192
  v_and_b32 v1, 63, v0
  v_lshlrev_b32 v2, 4, v1
  v_lshrrev_b32 v3, 4, v1
  v_and_b32 v4, 15, v1
  s_cmp_lg_u32 s97, 0
  s_cbranch_scc1 wk_go
  s_mov_b32 s68, s3
  s_mov_b32 s69, 1
  s_cmp_lg_u32 s16, 0
  s_cbranch_scc1 w0_32
  s_add_u32 s20, s67, 1
  s_lshl_b32 s22, s20, 11
  s_add_u32 s22, s22, 88602624
  v_add_u32 v24, 1024, v2
  v_min_u32 v24, 1776, v24
  s_mov_b32 s30, 0
wk_af:
  buffer_load_dwordx4 v[28:31], v2, s[8:11], s22 offen sc1
  buffer_load_dwordx4 v[32:35], v24, s[8:11], s22 offen sc1
  s_waitcnt vmcnt(0)
  v_cmp_ne_u64 vcc, s[88:89], v[28:29]
  s_cbranch_vccnz wk_af_no
  v_cmp_ne_u64 vcc, s[88:89], v[30:31]
  s_cbranch_vccnz wk_af_no
  v_cmp_ne_u64 vcc, s[88:89], v[32:33]
  s_cbranch_vccnz wk_af_no
  v_cmp_ne_u64 vcc, s[88:89], v[34:35]
  s_cbranch_vccnz wk_af_no
  s_branch wk_af_ok
wk_af_no:
  s_sleep 4
  s_add_u32 s30, s30, 1
  s_and_b32 s20, s30, 63
  s_cbranch_scc1 wk_ns
  s_mov_b32 s20, 1
  s_mov_b32 s70, 0
  s_mov_b32 s21, 0
  s_mov_b64 exec, 1
wk_st_l:
  s_cmp_lg_u32 s70, -1
  s_cbranch_scc1 wk_st_t
  s_add_u32 s20, s20, 1
  s_cmp_lt_u32 s20, 8
  s_cselect_b32 s20, s20, 1
  s_mov_b32 s70, 0
  s_mov_b32 s3, -1
  s_add_u32 s21, s21, 1
  s_cmp_ge_u32 s21, 7
  s_cbranch_scc1 wk_st_d
wk_st_t:
  s_ff0_i32_b32 s22, s70
  s_lshl_b32 s23, 1, s22
  s_and_b32 s71, s20, 4
  s_mul_i32 s71, s71, 12
  s_lshl_b32 s3, s20, 2
  s_add_u32 s3, s3, s71
  v_mov_b32 v242, s23
  v_mov_b32 v243, 32
  buffer_atomic_or v242, v243, s[12:15], s3 offen sc0
  s_waitcnt vmcnt(0)
  v_readfirstlane_b32 s70, v242
  s_lshl_b32 s3, s20, 5
  s_add_u32 s3, s3, s22
  s_bitcmp1_b32 s70, s22
  s_cbranch_scc1 wk_st_l
wk_st_d:
  s_mov_b64 exec, -1
  v_mov_b32 v242, s3
  s_cmp_lg_u32 s3, -1
  s_cbranch_scc1 wk_pd
  s_add_u32 s20, s67, 1
  s_lshl_b32 s22, s20, 11
  s_add_u32 s22, s22, 88602624
wk_ns:
  s_cmp_lt_u32 s30, 50000
  s_cbranch_scc1 wk_af
  s_branch cA_abort
wk_af_ok:
  v_mov_b32 v242, -1
wk_pd:
w0_32:
  v_mov_b32 v243, 160000
  s_add_u32 s101, s101, 1
  s_barrier
  s_mov_b64 exec, 1
  s_cmp_lg_u32 s16, 0
  s_cbranch_scc1 w0_33
  ds_write_b32 v243, v242 offset:0
  s_waitcnt lgkmcnt(0)
  v_mov_b32 v242, s101
  ds_write_b32 v243, v242 offset:16
  s_waitcnt lgkmcnt(0)
w0_33:
  s_mov_b64 exec, -1
  s_barrier
  ds_read_b32 v242, v243 offset:0
  ds_read_b32 v243, v243 offset:16
  s_waitcnt lgkmcnt(0)
  v_readfirstlane_b32 s3, v242
  v_cmp_ne_u32 vcc, s101, v243
  s_cbranch_vccnz ch_end
  s_cmp_lg_u32 s3, -1
  s_cbranch_scc1 m_bjob
  s_mov_b32 s3, s68
  s_mov_b32 s97, 1
wk_go:
  s_cmp_lt_u32 s3, 368
  s_cbranch_scc1 wk_g2
  s_sub_u32 s20, s3, 432
  s_cmp_lt_u32 s20, 128
  s_cbranch_scc1 wk_g2
  s_cmp_eq_u32 s97, 2
  s_cbranch_scc1 wk_g2
  s_getreg_b32 s20, hwreg(HW_REG_XCC_ID)
  s_and_b32 s20, s20, 7
  s_cmp_lg_u32 s16, 0
  s_cbranch_scc1 w0_34
  s_lshl_b32 s22, s20, 11
  s_add_u32 s22, s22, 88637440
  v_add_u32 v24, 1024, v2
  v_min_u32 v24, 1776, v24
  s_mov_b32 s30, 0
wk_i2:
  buffer_load_dwordx4 v[28:31], v2, s[8:11], s22 offen sc1
  buffer_load_dwordx4 v[32:35], v24, s[8:11], s22 offen sc1
  s_waitcnt vmcnt(0)
  v_cmp_ne_u64 vcc, s[88:89], v[28:29]
  s_cbranch_vccnz wk_i2_no
  v_cmp_ne_u64 vcc, s[88:89], v[30:31]
  s_cbranch_vccnz wk_i2_no
  v_cmp_ne_u64 vcc, s[88:89], v[32:33]
  s_cbranch_vccnz wk_i2_no
  v_cmp_ne_u64 vcc, s[88:89], v[34:35]
  s_cbranch_vccnz wk_i2_no
  s_branch wk_i2_ok
wk_i2_no:
  s_sleep 4
  s_add_u32 s30, s30, 1
  s_cmp_lt_u32 s30, 50000
  s_cbranch_scc1 wk_i2
  s_branch cA_abort
wk_i2_ok:
w0_34:
  v_mov_b32 v242, 0
  v_mov_b32 v243, 160000
  s_add_u32 s101, s101, 1
  s_barrier
  s_mov_b64 exec, 1
  s_cmp_lg_u32 s16, 0
  s_cbranch_scc1 w0_35
  ds_write_b32 v243, v242 offset:0
  s_waitcnt lgkmcnt(0)
  v_mov_b32 v242, s101
  ds_write_b32 v243, v242 offset:16
  s_waitcnt lgkmcnt(0)
w0_35:
  s_mov_b64 exec, -1
  s_barrier
  ds_read_b32 v242, v243 offset:0
  ds_read_b32 v243, v243 offset:16
  s_waitcnt lgkmcnt(0)
  v_readfirstlane_b32 s20, v242
  v_cmp_ne_u32 vcc, s101, v243
  s_cbranch_vccnz ch_end
  s_mov_b32 s97, 2
wk_g2:
  s_cmp_ge_u32 s3, 864
  s_cbranch_scc1 wk_tok
  s_cmp_ge_u32 s3, 752
  s_cbranch_scc1 wk_s4d
  s_cmp_ge_u32 s3, 624
  s_cbranch_scc1 wk_f
  s_cmp_ge_u32 s3, 560
  s_cbranch_scc1 wk_vf
  s_cmp_ge_u32 s3, 432
  s_cbranch_scc1 wk_a
  s_cmp_ge_u32 s3, 368
  s_cbranch_scc1 wk_vh
  s_cmp_ge_u32 s3, 256
  s_cbranch_scc1 wk_v7
  s_cmp_ge_u32 s3, 224
  s_cbranch_scc1 wk_srv
  s_sub_u32 s20, s3, 0
  s_cmp_ge_u32 s20, 112
  s_cselect_b32 s18, 1, 0
  s_cselect_b32 s21, 112, 0
  s_sub_u32 s20, s20, s21
  s_and_b32 s17, s20, 15
  s_add_u32 s17, s17, 16
  s_lshr_b32 s34, s20, 4
  s_lshl_b32 s34, s34, 1
  s_add_u32 s35, s34, 2
  s_cmp_eq_u32 s18, 0
  s_cbranch_scc1 wf_nw
  s_and_b32 s20, s3, 3
  s_lshl_b32 s20, s20, 3
  s_add_u32 s20, s20, 8
  s_cmp_eq_u32 s16, 0
  s_cselect_b32 s20, 0, s20
  s_cmp_ge_u32 s16, 2
  s_cselect_b32 s20, 112, s20
  s_load_dwordx2 s[72:73], s[0:1], s20
  s_lshr_b32 s21, s3, 2
  s_lshl_b32 s21, s21, 12
  s_mov_b32 s74, 229376
  s_lshl_b32 s22, s3, 13
  s_cmp_eq_u32 s16, 0
  s_cselect_b32 s21, s22, s21
  s_cselect_b32 s74, 1835008, s74
  s_lshl_b32 s22, s3, 1
  s_add_u32 s22, s22, s16
  s_sub_u32 s22, s22, 2
  s_lshl_b32 s22, s22, 13
  s_cmp_ge_u32 s16, 2
  s_cselect_b32 s21, s22, s21
  s_cselect_b32 s74, 3670016, s74
  v_lshlrev_b32 v6, 3, v2
  s_cmp_lt_u32 s16, 2
  s_cbranch_scc1 lw_36
  s_lshl_b32 s21, s3, 6
  v_add_u32 v6, s21, v1
  v_mul_u32_u24 v7, 37450, v6
  v_lshrrev_b32 v7, 18, v7
  v_add_u32 v7, 1, v7
  v_mul_u32_u24 v7, 7, v7
  v_add_u32 v6, v6, v7
  v_lshlrev_b32 v6, 7, v6
  s_mov_b32 s21, 0
  s_cmp_eq_u32 s16, 3
  s_cselect_b32 s74, 0, s74
lw_36:
  s_cmp_eq_u32 s16, 1
  s_cselect_b32 exec_hi, 0, -1
  s_waitcnt lgkmcnt(0)
  s_and_b32 s73, s73, 0xffff
  s_mov_b32 s75, 0x20000
  buffer_load_dword v7, v6, s[72:75], s21 offen
  s_mov_b64 exec, -1
  s_sub_u32 s3, s3, 112
  s_and_b32 s20, s3, 3
  s_lshl_b32 s20, s20, 3
  s_add_u32 s20, s20, 8
  s_cmp_eq_u32 s16, 0
  s_cselect_b32 s20, 0, s20
  s_cmp_ge_u32 s16, 2
  s_cselect_b32 s20, 112, s20
  s_load_dwordx2 s[72:73], s[0:1], s20
  s_lshr_b32 s21, s3, 2
  s_lshl_b32 s21, s21, 12
  s_mov_b32 s74, 229376
  s_lshl_b32 s22, s3, 13
  s_cmp_eq_u32 s16, 0
  s_cselect_b32 s21, s22, s21
  s_cselect_b32 s74, 1835008, s74
  s_lshl_b32 s22, s3, 1
  s_add_u32 s22, s22, s16
  s_sub_u32 s22, s22, 2
  s_lshl_b32 s22, s22, 13
  s_cmp_ge_u32 s16, 2
  s_cselect_b32 s21, s22, s21
  s_cselect_b32 s74, 3670016, s74
  v_lshlrev_b32 v6, 3, v2
  s_cmp_lt_u32 s16, 2
  s_cbranch_scc1 lw_37
  s_lshl_b32 s21, s3, 6
  v_add_u32 v6, s21, v1
  v_mul_u32_u24 v7, 37450, v6
  v_lshrrev_b32 v7, 18, v7
  v_add_u32 v7, 1, v7
  v_mul_u32_u24 v7, 7, v7
  v_add_u32 v6, v6, v7
  v_lshlrev_b32 v6, 7, v6
  s_mov_b32 s21, 0
  s_cmp_eq_u32 s16, 3
  s_cselect_b32 s74, 0, s74
lw_37:
  s_cmp_eq_u32 s16, 1
  s_cselect_b32 exec_hi, 0, -1
  s_waitcnt lgkmcnt(0)
  s_and_b32 s73, s73, 0xffff
  s_mov_b32 s75, 0x20000
  buffer_load_dword v7, v6, s[72:75], s21 offen
  s_mov_b64 exec, -1
  s_add_u32 s3, s3, 112
wf_nw:
  s_lshl_b32 s20, s18, 3
  s_lshl_b32 s21, s16, 1
  s_add_u32 s20, s20, s21
  s_mul_i32 s21, s20, 14336
  s_add_u32 s21, s21, 71565312
  s_add_u32 s22, s21, 0
  buffer_load_dwordx4 a[0:3], v2, s[8:11], s22 offen offset:0 sc1
  buffer_load_dwordx4 a[4:7], v2, s[8:11], s22 offen offset:1024 sc1
  buffer_load_dwordx4 a[8:11], v2, s[8:11], s22 offen offset:2048 sc1
  buffer_load_dwordx4 a[12:15], v2, s[8:11], s22 offen offset:3072 sc1
  s_add_u32 s22, s21, 4096
  buffer_load_dwordx4 a[16:19], v2, s[8:11], s22 offen offset:0 sc1
  buffer_load_dwordx4 a[20:23], v2, s[8:11], s22 offen offset:1024 sc1
  buffer_load_dwordx4 a[24:27], v2, s[8:11], s22 offen offset:2048 sc1
  buffer_load_dwordx4 a[28:31], v2, s[8:11], s22 offen offset:3072 sc1
  s_add_u32 s22, s21, 8192
  buffer_load_dwordx4 a[32:35], v2, s[8:11], s22 offen offset:0 sc1
  buffer_load_dwordx4 a[36:39], v2, s[8:11], s22 offen offset:1024 sc1
  buffer_load_dwordx4 a[40:43], v2, s[8:11], s22 offen offset:2048 sc1
  buffer_load_dwordx4 a[44:47], v2, s[8:11], s22 offen offset:3072 sc1
  s_add_u32 s22, s21, 12288
  buffer_load_dwordx4 a[48:51], v2, s[8:11], s22 offen offset:0 sc1
  buffer_load_dwordx4 a[52:55], v2, s[8:11], s22 offen offset:1024 sc1
  buffer_load_dwordx4 a[56:59], v2, s[8:11], s22 offen offset:2048 sc1
  buffer_load_dwordx4 a[60:63], v2, s[8:11], s22 offen offset:3072 sc1
  s_add_u32 s22, s21, 16384
  buffer_load_dwordx4 a[64:67], v2, s[8:11], s22 offen offset:0 sc1
  buffer_load_dwordx4 a[68:71], v2, s[8:11], s22 offen offset:1024 sc1
  buffer_load_dwordx4 a[72:75], v2, s[8:11], s22 offen offset:2048 sc1
  buffer_load_dwordx4 a[76:79], v2, s[8:11], s22 offen offset:3072 sc1
  s_add_u32 s22, s21, 20480
  buffer_load_dwordx4 a[80:83], v2, s[8:11], s22 offen offset:0 sc1
  buffer_load_dwordx4 a[84:87], v2, s[8:11], s22 offen offset:1024 sc1
  buffer_load_dwordx4 a[88:91], v2, s[8:11], s22 offen offset:2048 sc1
  buffer_load_dwordx4 a[92:95], v2, s[8:11], s22 offen offset:3072 sc1
  s_add_u32 s22, s21, 24576
  buffer_load_dwordx4 a[96:99], v2, s[8:11], s22 offen offset:0 sc1
  buffer_load_dwordx4 a[100:103], v2, s[8:11], s22 offen offset:1024 sc1
  buffer_load_dwordx4 a[104:107], v2, s[8:11], s22 offen offset:2048 sc1
  buffer_load_dwordx4 a[108:111], v2, s[8:11], s22 offen offset:3072 sc1
  s_waitcnt vmcnt(40)
  s_mul_i32 s23, s17, 401408
  s_and_b32 s22, s16, 1
  s_mul_i32 s22, s22, 7168
  s_add_u32 s23, s23, s22
  s_add_u32 s23, s23, 0
  s_lshr_b32 s22, s16, 1
  s_mul_i32 s22, s22, 14336
  s_add_u32 s23, s23, s22
  s_mul_i32 s27, s16, 7168
  s_lshr_b32 s28, s20, 1
wf_vo:
  s_sub_u32 s29, s17, 16
  s_lshl_b32 s29, s29, 6
  s_add_u32 s29, s29, s28
  s_mul_i32 s29, s29, 28672
  s_add_u32 s29, s29, 42205184
  v_mul_u32_u24 v6, 28, v3
  s_mov_b32 s31, 0
  s_lshl_b32 s24, s34, 1
  s_mul_i32 s24, s24, 14336
  s_add_u32 s24, s24, s23
  s_cmp_lt_u32 s34, s35
  s_cselect_b32 s24, s24, 0x10000000
  s_add_u32 m0, s31, s27
  s_nop 0
  buffer_load_dwordx4 v2, s[8:11], s24 offen offset:0 sc1 lds
  buffer_load_dwordx4 v2, s[8:11], s24 offen offset:1024 sc1 lds
  buffer_load_dwordx4 v2, s[8:11], s24 offen offset:2048 sc1 lds
  buffer_load_dwordx4 v2, s[8:11], s24 offen offset:3072 sc1 lds
  s_add_u32 m0, m0, 4096
  s_add_u32 s24, s24, 4096
  buffer_load_dwordx4 v2, s[8:11], s24 offen offset:0 sc1 lds
  buffer_load_dwordx4 v2, s[8:11], s24 offen offset:1024 sc1 lds
  buffer_load_dwordx4 v2, s[8:11], s24 offen offset:2048 sc1 lds
  s_add_u32 s30, s34, 1
  s_mov_b32 s31, 28672
  s_lshl_b32 s24, s30, 1
  s_mul_i32 s24, s24, 14336
  s_add_u32 s24, s24, s23
  s_cmp_lt_u32 s30, s35
  s_cselect_b32 s24, s24, 0x10000000
  s_add_u32 m0, s31, s27
  s_nop 0
  buffer_load_dwordx4 v2, s[8:11], s24 offen offset:0 sc1 lds
  buffer_load_dwordx4 v2, s[8:11], s24 offen offset:1024 sc1 lds
  buffer_load_dwordx4 v2, s[8:11], s24 offen offset:2048 sc1 lds
  buffer_load_dwordx4 v2, s[8:11], s24 offen offset:3072 sc1 lds
  s_add_u32 m0, m0, 4096
  s_add_u32 s24, s24, 4096
  buffer_load_dwordx4 v2, s[8:11], s24 offen offset:0 sc1 lds
  buffer_load_dwordx4 v2, s[8:11], s24 offen offset:1024 sc1 lds
  buffer_load_dwordx4 v2, s[8:11], s24 offen offset:2048 sc1 lds
  s_mov_b32 s19, s34
  s_mov_b32 s32, 0
  s_mov_b32 s33, 57344
  s_waitcnt vmcnt(7)
  s_branch wf_vo_in
wf_vo_loop:
  s_waitcnt vmcnt(9)
wf_vo_in:
  s_barrier
  s_add_u32 s30, s19, 2
  s_lshl_b32 s24, s30, 1
  s_mul_i32 s24, s24, 14336
  s_add_u32 s24, s24, s23
  s_cmp_lt_u32 s30, s35
  s_cselect_b32 s24, s24, 0x10000000
  s_add_u32 m0, s33, s27
  s_nop 0
  buffer_load_dwordx4 v2, s[8:11], s24 offen offset:0 sc1 lds
  buffer_load_dwordx4 v2, s[8:11], s24 offen offset:1024 sc1 lds
  buffer_load_dwordx4 v2, s[8:11], s24 offen offset:2048 sc1 lds
  buffer_load_dwordx4 v2, s[8:11], s24 offen offset:3072 sc1 lds
  s_add_u32 m0, m0, 4096
  s_add_u32 s24, s24, 4096
  buffer_load_dwordx4 v2, s[8:11], s24 offen offset:0 sc1 lds
  buffer_load_dwordx4 v2, s[8:11], s24 offen offset:1024 sc1 lds
  buffer_load_dwordx4 v2, s[8:11], s24 offen offset:2048 sc1 lds
  v_add_u32 v5, s32, v2
  ds_read_b128 v[8:11], v5 offset:0
  ds_read_b128 v[12:15], v5 offset:14336
  ds_read_b128 v[16:19], v5 offset:1024
  ds_read_b128 v[20:23], v5 offset:15360
  ds_read_b128 v[24:27], v5 offset:2048
  ds_read_b128 v[28:31], v5 offset:16384
  ds_read_b128 v[32:35], v5 offset:3072
  s_waitcnt lgkmcnt(6)
  v_mfma_f32_16x16x32_bf16 v[40:43], a[0:3], v[8:11], 0
  v_mfma_f32_16x16x32_bf16 v[44:47], a[56:59], v[8:11], 0
  ds_read_b128 v[36:39], v5 offset:17408
  s_waitcnt lgkmcnt(6)
  v_mfma_f32_16x16x32_bf16 v[56:59], a[0:3], v[12:15], 0
  v_mfma_f32_16x16x32_bf16 v[60:63], a[56:59], v[12:15], 0
  ds_read_b128 v[8:11], v5 offset:4096
  s_waitcnt lgkmcnt(6)
  v_mfma_f32_16x16x32_bf16 v[40:43], a[4:7], v[16:19], v[40:43]
  v_mfma_f32_16x16x32_bf16 v[44:47], a[60:63], v[16:19], v[44:47]
  ds_read_b128 v[12:15], v5 offset:18432
  s_waitcnt lgkmcnt(6)
  v_mfma_f32_16x16x32_bf16 v[56:59], a[4:7], v[20:23], v[56:59]
  v_mfma_f32_16x16x32_bf16 v[60:63], a[60:63], v[20:23], v[60:63]
  ds_read_b128 v[16:19], v5 offset:5120
  s_waitcnt lgkmcnt(6)
  v_mfma_f32_16x16x32_bf16 v[40:43], a[8:11], v[24:27], v[40:43]
  v_mfma_f32_16x16x32_bf16 v[44:47], a[64:67], v[24:27], v[44:47]
  ds_read_b128 v[20:23], v5 offset:19456
  s_waitcnt lgkmcnt(6)
  v_mfma_f32_16x16x32_bf16 v[56:59], a[8:11], v[28:31], v[56:59]
  v_mfma_f32_16x16x32_bf16 v[60:63], a[64:67], v[28:31], v[60:63]
  ds_read_b128 v[24:27], v5 offset:6144
  s_waitcnt lgkmcnt(6)
  v_mfma_f32_16x16x32_bf16 v[40:43], a[12:15], v[32:35], v[40:43]
  v_mfma_f32_16x16x32_bf16 v[44:47], a[68:71], v[32:35], v[44:47]
  ds_read_b128 v[28:31], v5 offset:20480
  s_waitcnt lgkmcnt(6)
  v_mfma_f32_16x16x32_bf16 v[56:59], a[12:15], v[36:39], v[56:59]
  v_mfma_f32_16x16x32_bf16 v[60:63], a[68:71], v[36:39], v[60:63]
  ds_read_b128 v[32:35], v5 offset:7168
  s_waitcnt lgkmcnt(6)
  v_mfma_f32_16x16x32_bf16 v[40:43], a[16:19], v[8:11], v[40:43]
  v_mfma_f32_16x16x32_bf16 v[44:47], a[72:75], v[8:11], v[44:47]
  ds_read_b128 v[36:39], v5 offset:21504
  s_waitcnt lgkmcnt(6)
  v_mfma_f32_16x16x32_bf16 v[56:59], a[16:19], v[12:15], v[56:59]
  v_mfma_f32_16x16x32_bf16 v[60:63], a[72:75], v[12:15], v[60:63]
  ds_read_b128 v[8:11], v5 offset:8192
  s_waitcnt lgkmcnt(6)
  v_mfma_f32_16x16x32_bf16 v[40:43], a[20:23], v[16:19], v[40:43]
  v_mfma_f32_16x16x32_bf16 v[44:47], a[76:79], v[16:19], v[44:47]
  ds_read_b128 v[12:15], v5 offset:22528
  s_waitcnt lgkmcnt(6)
  v_mfma_f32_16x16x32_bf16 v[56:59], a[20:23], v[20:23], v[56:59]
  v_mfma_f32_16x16x32_bf16 v[60:63], a[76:79], v[20:23], v[60:63]
  ds_read_b128 v[16:19], v5 offset:9216
  s_waitcnt lgkmcnt(6)
  v_mfma_f32_16x16x32_bf16 v[40:43], a[24:27], v[24:27], v[40:43]
  v_mfma_f32_16x16x32_bf16 v[44:47], a[80:83], v[24:27], v[44:47]
  ds_read_b128 v[20:23], v5 offset:23552
  s_waitcnt lgkmcnt(6)
  v_mfma_f32_16x16x32_bf16 v[56:59], a[24:27], v[28:31], v[56:59]
  v_mfma_f32_16x16x32_bf16 v[60:63], a[80:83], v[28:31], v[60:63]
  ds_read_b128 v[24:27], v5 offset:10240
  s_waitcnt lgkmcnt(6)
  v_mfma_f32_16x16x32_bf16 v[40:43], a[28:31], v[32:35], v[40:43]
  v_mfma_f32_16x16x32_bf16 v[44:47], a[84:87], v[32:35], v[44:47]
  ds_read_b128 v[28:31], v5 offset:24576
  s_waitcnt lgkmcnt(6)
  v_mfma_f32_16x16x32_bf16 v[56:59], a[28:31], v[36:39], v[56:59]
  v_mfma_f32_16x16x32_bf16 v[60:63], a[84:87], v[36:39], v[60:63]
  ds_read_b128 v[32:35], v5 offset:11264
  s_waitcnt lgkmcnt(6)
  v_mfma_f32_16x16x32_bf16 v[40:43], a[32:35], v[8:11], v[40:43]
  v_mfma_f32_16x16x32_bf16 v[44:47], a[88:91], v[8:11], v[44:47]
  ds_read_b128 v[36:39], v5 offset:25600
  s_waitcnt lgkmcnt(6)
  v_mfma_f32_16x16x32_bf16 v[56:59], a[32:35], v[12:15], v[56:59]
  v_mfma_f32_16x16x32_bf16 v[60:63], a[88:91], v[12:15], v[60:63]
  ds_read_b128 v[8:11], v5 offset:12288
  s_waitcnt lgkmcnt(6)
  v_mfma_f32_16x16x32_bf16 v[40:43], a[36:39], v[16:19], v[40:43]
  v_mfma_f32_16x16x32_bf16 v[44:47], a[92:95], v[16:19], v[44:47]
  ds_read_b128 v[12:15], v5 offset:26624
  s_waitcnt lgkmcnt(6)
  v_mfma_f32_16x16x32_bf16 v[56:59], a[36:39], v[20:23], v[56:59]
  v_mfma_f32_16x16x32_bf16 v[60:63], a[92:95], v[20:23], v[60:63]
  ds_read_b128 v[16:19], v5 offset:13312
  s_waitcnt lgkmcnt(6)
  v_mfma_f32_16x16x32_bf16 v[40:43], a[40:43], v[24:27], v[40:43]
  v_mfma_f32_16x16x32_bf16 v[44:47], a[96:99], v[24:27], v[44:47]
  ds_read_b128 v[20:23], v5 offset:27648
  s_waitcnt lgkmcnt(6)
  v_mfma_f32_16x16x32_bf16 v[56:59], a[40:43], v[28:31], v[56:59]
  v_mfma_f32_16x16x32_bf16 v[60:63], a[96:99], v[28:31], v[60:63]
  s_waitcnt lgkmcnt(5)
  v_mfma_f32_16x16x32_bf16 v[40:43], a[44:47], v[32:35], v[40:43]
  v_mfma_f32_16x16x32_bf16 v[44:47], a[100:103], v[32:35], v[44:47]
  s_waitcnt lgkmcnt(4)
  v_mfma_f32_16x16x32_bf16 v[56:59], a[44:47], v[36:39], v[56:59]
  v_mfma_f32_16x16x32_bf16 v[60:63], a[100:103], v[36:39], v[60:63]
  s_waitcnt lgkmcnt(3)
  v_mfma_f32_16x16x32_bf16 v[40:43], a[48:51], v[8:11], v[40:43]
  v_mfma_f32_16x16x32_bf16 v[44:47], a[104:107], v[8:11], v[44:47]
  s_waitcnt lgkmcnt(2)
  v_mfma_f32_16x16x32_bf16 v[56:59], a[48:51], v[12:15], v[56:59]
  v_mfma_f32_16x16x32_bf16 v[60:63], a[104:107], v[12:15], v[60:63]
  s_waitcnt lgkmcnt(1)
  v_mfma_f32_16x16x32_bf16 v[40:43], a[52:55], v[16:19], v[40:43]
  v_mfma_f32_16x16x32_bf16 v[44:47], a[108:111], v[16:19], v[44:47]
  s_waitcnt lgkmcnt(0)
  v_mfma_f32_16x16x32_bf16 v[56:59], a[52:55], v[20:23], v[56:59]
  v_mfma_f32_16x16x32_bf16 v[60:63], a[108:111], v[20:23], v[60:63]
  s_add_u32 s25, s29, 28672
  s_lshl_b32 s24, s19, 5
  s_add_u32 s24, s24, 0
  v_add_u32 v88, s24, v4
  v_mul_u32_u24 v89, 2341, v88
  v_lshrrev_b32 v89, 16, v89
  v_mul_u32_u24 v89, 84, v89
  v_add3_u32 v88, v88, v89, v6
  v_lshlrev_b32 v90, 4, v88
  v_cvt_pk_bf16_f32 v72, v40, v41
  v_cvt_pk_bf16_f32 v73, v42, v43
  v_cvt_pk_bf16_f32 v74, v44, v45
  v_cvt_pk_bf16_f32 v75, v46, v47
  buffer_store_dwordx4 v[72:75], v90, s[8:11], s29 offen sc1
  s_lshl_b32 s24, s19, 5
  s_add_u32 s24, s24, 16
  v_add_u32 v88, s24, v4
  v_mul_u32_u24 v89, 2341, v88
  v_lshrrev_b32 v89, 16, v89
  v_mul_u32_u24 v89, 84, v89
  v_add3_u32 v88, v88, v89, v6
  v_lshlrev_b32 v91, 4, v88
  v_cvt_pk_bf16_f32 v80, v56, v57
  v_cvt_pk_bf16_f32 v81, v58, v59
  v_cvt_pk_bf16_f32 v82, v60, v61
  v_cvt_pk_bf16_f32 v83, v62, v63
  buffer_store_dwordx4 v[80:83], v91, s[8:11], s29 offen sc1
  s_mov_b32 s33, s32
  s_add_u32 s32, s32, 28672
  s_cmp_eq_u32 s32, 86016
  s_cselect_b32 s32, 0, s32
  s_add_u32 s19, s19, 1
  s_cmp_lt_u32 s19, s35
  s_cbranch_scc1 wf_vo_loop
  s_branch wf_done
wf_done:
  s_lshr_b32 s20, s18, 1
  s_lshl_b32 s20, s20, 4
  s_and_b32 s21, s17, 15
  s_add_u32 s20, s20, s21
  s_lshl_b32 s20, s20, 7
  s_cmp_lt_u32 s17, 16
  s_cselect_b32 s21, 16384, 0
  s_add_u32 s20, s20, s21
  s_add_u32 s20, s20, 88541184
  s_sub_u32 s21, s35, s34
  s_lshr_b32 s21, s21, 1
  v_mov_b32 v5, s21
  v_mov_b32 v6, 0
  s_waitcnt vmcnt(0)
  s_mov_b64 exec, 1
  s_cmp_lg_u32 s18, 0
  s_cbranch_scc1 wf_h1
  v_mov_b32 v7, 2
  s_sub_u32 s21, s20, 2048
  buffer_atomic_add v7, v6, s[8:11], s21 offen
wf_h1:
  buffer_atomic_add v5, v6, s[8:11], s20 offen
  s_mov_b64 exec, -1
  s_load_dwordx8 s[36:43], s[0:1], 56
  s_load_dwordx4 s[44:47], s[0:1], 88
  s_waitcnt lgkmcnt(0)
  s_mov_b32 s52, s36
  s_and_b32 s53, s37, 0xffff
  s_mov_b32 s54, 1835008
  s_mov_b32 s55, 0x20000
  s_lshl_b32 s20, s3, 8
  v_add_u32 v95, s20, v0
  s_mov_b32 s21, 9586981
  v_mul_hi_u32 v6, v95, s21
  v_mul_u32_u24 v7, 448, v6
  v_sub_u32 v7, v95, v7
  v_lshrrev_b32 v8, 4, v7
  v_and_b32 v7, 15, v7
  v_lshl_add_u32 v9, v6, 4, v7
  v_mul_u32_u24 v9, 896, v9
  v_lshl_add_u32 v9, v8, 5, v9
  buffer_load_dwordx4 v[84:87], v9, s[52:55], 0 offen
  buffer_load_dwordx4 v[88:91], v9, s[52:55], 0 offen offset:16
  v_mul_u32_u24 v6, 14336, v6
  v_lshl_add_u32 v6, v7, 4, v6
  v_lshl_add_u32 v92, v8, 9, v6
  v_lshrrev_b32 v7, 2, v8
  v_lshl_add_u32 v6, v7, 11, v6
  v_and_b32 v7, 3, v8
  v_lshl_add_u32 v93, v7, 8, v6
  v_mov_b32 v52, -1
  v_mov_b32 v53, -1
  v_mov_b32 v54, -1
  v_mov_b32 v55, -1
  s_mov_b32 s23, 89063424
  v_lshlrev_b32 v8, 4, v95
  buffer_store_dwordx4 v[52:55], v8, s[8:11], s23 offen sc1
  v_add_u32 v8, 917504, v8
  v_mov_b32 v9, 0x10000000
  v_cmp_lt_u32 vcc, 1535, v95
  s_nop 1
  v_cndmask_b32 v8, v8, v9, vcc
  buffer_store_dwordx4 v[52:55], v8, s[8:11], s23 offen sc1
  s_waitcnt vmcnt(1)
  v_mov_b32 v96, v84
  v_mov_b32 v100, v85
  v_mov_b32 v97, v86
  v_mov_b32 v101, v87
  v_mov_b32 v98, v88
  v_mov_b32 v102, v89
  v_mov_b32 v99, v90
  v_mov_b32 v103, v91
  s_mov_b32 s20, 71565312
  s_mov_b32 s21, 73400320
  buffer_store_dwordx4 v[96:99], v93, s[8:11], s21 offen sc1
  buffer_store_dwordx4 v[100:103], v93, s[8:11], s21 offen offset:1024 sc1
  s_cmp_lt_u32 s3, 70
  s_cbranch_scc1 i2_nx
  buffer_store_dwordx4 v[84:87], v92, s[8:11], s20 offen sc1
  buffer_store_dwordx4 v[88:91], v92, s[8:11], s20 offen offset:256 sc1
i2_nx:
  s_lshl_b32 s20, s3, 3
  s_add_u32 s20, s20, 88637440
  s_waitcnt vmcnt(0)
  s_barrier
  s_cmp_lg_u32 s16, 0
  s_cbranch_scc1 pub_38
  v_mul_u32_u24 v26, 2048, v1
  v_mov_b32 v24, s88
  v_mov_b32 v25, s89
  s_mov_b64 exec, 255
  buffer_store_dwordx2 v[24:25], v26, s[8:11], s20 offen sc1
  s_mov_b64 exec, -1
pub_38:
  s_branch wk_loop
wk_v7:
  s_sub_u32 s20, s3, 256
  s_mov_b32 s18, 1
  s_and_b32 s17, s20, 15
  s_add_u32 s17, s17, 16
  s_lshr_b32 s34, s20, 4
  s_lshl_b32 s34, s34, 1
  s_add_u32 s35, s34, 2
  s_branch wk_gemm
wk_vh:
  s_sub_u32 s20, s3, 368
  s_and_b32 s17, s20, 15
  s_add_u32 s17, s17, 16
  s_lshr_b32 s18, s20, 5
  s_add_u32 s18, s18, 2
  s_bitcmp1_b32 s20, 4
  s_cselect_b32 s34, 7, 0
  s_add_u32 s35, s34, 7
  s_branch wk_gemm
wk_vf:
  s_sub_u32 s20, s3, 560
  s_and_b32 s17, s20, 15
  s_add_u32 s17, s17, 16
  s_lshr_b32 s18, s20, 4
  s_add_u32 s18, s18, 4
  s_mov_b32 s34, 0
  s_mov_b32 s35, 14
  s_branch wk_gemm
wk_f:
  s_sub_u32 s20, s3, 624
  s_and_b32 s17, s20, 15
  s_lshr_b32 s18, s20, 4
  s_mov_b32 s34, 0
  s_mov_b32 s35, 14
  s_lshl_b32 s22, s17, 7
  s_add_u32 s22, s22, 88633344
  s_add_u32 s23, s22, 2048
  v_min_u32 v24, 48, v2
  v_min_u32 v25, 96, v2
  s_mov_b32 s30, 0
wk_aw:
  buffer_load_dwordx4 v[28:31], v24, s[8:11], s22 offen sc1
  buffer_load_dwordx4 v[32:35], v25, s[8:11], s23 offen sc1
  s_waitcnt vmcnt(0)
  v_cmp_ne_u64 vcc, s[88:89], v[28:29]
  s_cbranch_vccnz wk_aw_no
  v_cmp_ne_u64 vcc, s[88:89], v[30:31]
  s_cbranch_vccnz wk_aw_no
  v_cmp_ne_u64 vcc, s[88:89], v[32:33]
  s_cbranch_vccnz wk_aw_no
  v_cmp_ne_u64 vcc, s[88:89], v[34:35]
  s_cbranch_vccnz wk_aw_no
  s_branch wk_aw_ok
wk_aw_no:
  s_sleep 6
  s_add_u32 s30, s30, 1
  s_cmp_lt_u32 s30, 50000
  s_cbranch_scc1 wk_aw
  s_branch cA_abort
wk_aw_ok:
wk_gemm:
  s_lshl_b32 s20, s18, 4
  s_lshl_b32 s21, s16, 2
  s_add_u32 s20, s20, s21
  s_mul_i32 s21, s20, 14336
  s_add_u32 s21, s21, 71565312
  s_add_u32 s22, s21, 0
  buffer_load_dwordx4 a[0:3], v2, s[8:11], s22 offen offset:0 sc1
  buffer_load_dwordx4 a[4:7], v2, s[8:11], s22 offen offset:1024 sc1
  buffer_load_dwordx4 a[8:11], v2, s[8:11], s22 offen offset:2048 sc1
  buffer_load_dwordx4 a[12:15], v2, s[8:11], s22 offen offset:3072 sc1
  s_add_u32 s22, s21, 4096
  buffer_load_dwordx4 a[16:19], v2, s[8:11], s22 offen offset:0 sc1
  buffer_load_dwordx4 a[20:23], v2, s[8:11], s22 offen offset:1024 sc1
  buffer_load_dwordx4 a[24:27], v2, s[8:11], s22 offen offset:2048 sc1
  buffer_load_dwordx4 a[28:31], v2, s[8:11], s22 offen offset:3072 sc1
  s_add_u32 s22, s21, 8192
  buffer_load_dwordx4 a[32:35], v2, s[8:11], s22 offen offset:0 sc1
  buffer_load_dwordx4 a[36:39], v2, s[8:11], s22 offen offset:1024 sc1
  buffer_load_dwordx4 a[40:43], v2, s[8:11], s22 offen offset:2048 sc1
  buffer_load_dwordx4 a[44:47], v2, s[8:11], s22 offen offset:3072 sc1
  s_add_u32 s22, s21, 12288
  buffer_load_dwordx4 a[48:51], v2, s[8:11], s22 offen offset:0 sc1
  buffer_load_dwordx4 a[52:55], v2, s[8:11], s22 offen offset:1024 sc1
  buffer_load_dwordx4 a[56:59], v2, s[8:11], s22 offen offset:2048 sc1
  buffer_load_dwordx4 a[60:63], v2, s[8:11], s22 offen offset:3072 sc1
  s_add_u32 s22, s21, 16384
  buffer_load_dwordx4 a[64:67], v2, s[8:11], s22 offen offset:0 sc1
  buffer_load_dwordx4 a[68:71], v2, s[8:11], s22 offen offset:1024 sc1
  buffer_load_dwordx4 a[72:75], v2, s[8:11], s22 offen offset:2048 sc1
  buffer_load_dwordx4 a[76:79], v2, s[8:11], s22 offen offset:3072 sc1
  s_add_u32 s22, s21, 20480
  buffer_load_dwordx4 a[80:83], v2, s[8:11], s22 offen offset:0 sc1
  buffer_load_dwordx4 a[84:87], v2, s[8:11], s22 offen offset:1024 sc1
  buffer_load_dwordx4 a[88:91], v2, s[8:11], s22 offen offset:2048 sc1
  buffer_load_dwordx4 a[92:95], v2, s[8:11], s22 offen offset:3072 sc1
  s_add_u32 s22, s21, 24576
  buffer_load_dwordx4 a[96:99], v2, s[8:11], s22 offen offset:0 sc1
  buffer_load_dwordx4 a[100:103], v2, s[8:11], s22 offen offset:1024 sc1
  buffer_load_dwordx4 a[104:107], v2, s[8:11], s22 offen offset:2048 sc1
  buffer_load_dwordx4 a[108:111], v2, s[8:11], s22 offen offset:3072 sc1
  s_add_u32 s22, s21, 28672
  buffer_load_dwordx4 a[112:115], v2, s[8:11], s22 offen offset:0 sc1
  buffer_load_dwordx4 a[116:119], v2, s[8:11], s22 offen offset:1024 sc1
  buffer_load_dwordx4 a[120:123], v2, s[8:11], s22 offen offset:2048 sc1
  buffer_load_dwordx4 a[124:127], v2, s[8:11], s22 offen offset:3072 sc1
  s_add_u32 s22, s21, 32768
  buffer_load_dwordx4 a[128:131], v2, s[8:11], s22 offen offset:0 sc1
  buffer_load_dwordx4 a[132:135], v2, s[8:11], s22 offen offset:1024 sc1
  buffer_load_dwordx4 a[136:139], v2, s[8:11], s22 offen offset:2048 sc1
  buffer_load_dwordx4 a[140:143], v2, s[8:11], s22 offen offset:3072 sc1
  s_add_u32 s22, s21, 36864
  buffer_load_dwordx4 a[144:147], v2, s[8:11], s22 offen offset:0 sc1
  buffer_load_dwordx4 a[148:151], v2, s[8:11], s22 offen offset:1024 sc1
  buffer_load_dwordx4 a[152:155], v2, s[8:11], s22 offen offset:2048 sc1
  buffer_load_dwordx4 a[156:159], v2, s[8:11], s22 offen offset:3072 sc1
  s_add_u32 s22, s21, 40960
  buffer_load_dwordx4 a[160:163], v2, s[8:11], s22 offen offset:0 sc1
  buffer_load_dwordx4 a[164:167], v2, s[8:11], s22 offen offset:1024 sc1
  buffer_load_dwordx4 a[168:171], v2, s[8:11], s22 offen offset:2048 sc1
  buffer_load_dwordx4 a[172:175], v2, s[8:11], s22 offen offset:3072 sc1
  s_add_u32 s22, s21, 45056
  buffer_load_dwordx4 a[176:179], v2, s[8:11], s22 offen offset:0 sc1
  buffer_load_dwordx4 a[180:183], v2, s[8:11], s22 offen offset:1024 sc1
  buffer_load_dwordx4 a[184:187], v2, s[8:11], s22 offen offset:2048 sc1
  buffer_load_dwordx4 a[188:191], v2, s[8:11], s22 offen offset:3072 sc1
  s_add_u32 s22, s21, 49152
  buffer_load_dwordx4 a[192:195], v2, s[8:11], s22 offen offset:0 sc1
  buffer_load_dwordx4 a[196:199], v2, s[8:11], s22 offen offset:1024 sc1
  buffer_load_dwordx4 a[200:203], v2, s[8:11], s22 offen offset:2048 sc1
  buffer_load_dwordx4 a[204:207], v2, s[8:11], s22 offen offset:3072 sc1
  s_add_u32 s22, s21, 53248
  buffer_load_dwordx4 a[208:211], v2, s[8:11], s22 offen offset:0 sc1
  buffer_load_dwordx4 a[212:215], v2, s[8:11], s22 offen offset:1024 sc1
  buffer_load_dwordx4 a[216:219], v2, s[8:11], s22 offen offset:2048 sc1
  buffer_load_dwordx4 a[220:223], v2, s[8:11], s22 offen offset:3072 sc1
  s_waitcnt vmcnt(40)
  s_mul_i32 s23, s17, 401408
  s_and_b32 s22, s16, 1
  s_mul_i32 s22, s22, 7168
  s_add_u32 s23, s23, s22
  s_add_u32 s23, s23, 0
  s_lshr_b32 s22, s16, 1
  s_mul_i32 s22, s22, 14336
  s_add_u32 s23, s23, s22
  s_mul_i32 s27, s16, 7168
  s_lshr_b32 s28, s20, 1
  s_cmp_lt_u32 s17, 16
  s_cbranch_scc0 wg_vo
  s_add_u32 s23, s23, s22
  s_lshl_b32 s29, s28, 4
  s_add_u32 s29, s29, s17
  s_mul_i32 s29, s29, 28672
  s_add_u32 s29, s29, 12845056
  s_mov_b32 s31, 0
  s_lshr_b32 s24, s34, 1
  s_lshl_b32 s24, s24, 2
  s_and_b32 s25, s34, 1
  s_add_u32 s24, s24, s25
  s_mul_i32 s24, s24, 14336
  s_add_u32 s24, s24, s23
  s_cmp_lt_u32 s34, s35
  s_cselect_b32 s24, s24, 0x10000000
  s_add_u32 m0, s31, s27
  s_nop 0
  buffer_load_dwordx4 v2, s[8:11], s24 offen offset:0 sc1 lds
  buffer_load_dwordx4 v2, s[8:11], s24 offen offset:1024 sc1 lds
  buffer_load_dwordx4 v2, s[8:11], s24 offen offset:2048 sc1 lds
  buffer_load_dwordx4 v2, s[8:11], s24 offen offset:3072 sc1 lds
  s_add_u32 m0, m0, 4096
  s_add_u32 s24, s24, 4096
  buffer_load_dwordx4 v2, s[8:11], s24 offen offset:0 sc1 lds
  buffer_load_dwordx4 v2, s[8:11], s24 offen offset:1024 sc1 lds
  buffer_load_dwordx4 v2, s[8:11], s24 offen offset:2048 sc1 lds
  s_add_u32 s30, s34, 1
  s_mov_b32 s31, 28672
  s_lshr_b32 s24, s30, 1
  s_lshl_b32 s24, s24, 2
  s_and_b32 s25, s30, 1
  s_add_u32 s24, s24, s25
  s_mul_i32 s24, s24, 14336
  s_add_u32 s24, s24, s23
  s_cmp_lt_u32 s30, s35
  s_cselect_b32 s24, s24, 0x10000000
  s_add_u32 m0, s31, s27
  s_nop 0
  buffer_load_dwordx4 v2, s[8:11], s24 offen offset:0 sc1 lds
  buffer_load_dwordx4 v2, s[8:11], s24 offen offset:1024 sc1 lds
  buffer_load_dwordx4 v2, s[8:11], s24 offen offset:2048 sc1 lds
  buffer_load_dwordx4 v2, s[8:11], s24 offen offset:3072 sc1 lds
  s_add_u32 m0, m0, 4096
  s_add_u32 s24, s24, 4096
  buffer_load_dwordx4 v2, s[8:11], s24 offen offset:0 sc1 lds
  buffer_load_dwordx4 v2, s[8:11], s24 offen offset:1024 sc1 lds
  buffer_load_dwordx4 v2, s[8:11], s24 offen offset:2048 sc1 lds
  s_mov_b32 s19, s34
  s_mov_b32 s32, 0
  s_mov_b32 s33, 57344
  s_waitcnt vmcnt(7)
  s_branch wg_f_in
wg_f_loop:
  s_waitcnt vmcnt(11)
wg_f_in:
  s_barrier
  s_add_u32 s30, s19, 2
  s_lshr_b32 s24, s30, 1
  s_lshl_b32 s24, s24, 2
  s_and_b32 s25, s30, 1
  s_add_u32 s24, s24, s25
  s_mul_i32 s24, s24, 14336
  s_add_u32 s24, s24, s23
  s_cmp_lt_u32 s30, s35
  s_cselect_b32 s24, s24, 0x10000000
  s_add_u32 m0, s33, s27
  s_nop 0
  buffer_load_dwordx4 v2, s[8:11], s24 offen offset:0 sc1 lds
  buffer_load_dwordx4 v2, s[8:11], s24 offen offset:1024 sc1 lds
  buffer_load_dwordx4 v2, s[8:11], s24 offen offset:2048 sc1 lds
  buffer_load_dwordx4 v2, s[8:11], s24 offen offset:3072 sc1 lds
  s_add_u32 m0, m0, 4096
  s_add_u32 s24, s24, 4096
  buffer_load_dwordx4 v2, s[8:11], s24 offen offset:0 sc1 lds
  buffer_load_dwordx4 v2, s[8:11], s24 offen offset:1024 sc1 lds
  buffer_load_dwordx4 v2, s[8:11], s24 offen offset:2048 sc1 lds
  v_add_u32 v5, s32, v2
  ds_read_b128 v[8:11], v5 offset:0
  ds_read_b128 v[12:15], v5 offset:14336
  ds_read_b128 v[16:19], v5 offset:1024
  ds_read_b128 v[20:23], v5 offset:15360
  ds_read_b128 v[24:27], v5 offset:2048
  ds_read_b128 v[28:31], v5 offset:16384
  ds_read_b128 v[32:35], v5 offset:3072
  s_waitcnt lgkmcnt(6)
  v_mfma_f32_16x16x32_bf16 v[40:43], v[8:11], a[0:3], 0
  v_mfma_f32_16x16x32_bf16 v[44:47], v[8:11], a[56:59], 0
  v_mfma_f32_16x16x32_bf16 v[48:51], v[8:11], a[112:115], 0
  v_mfma_f32_16x16x32_bf16 v[52:55], v[8:11], a[168:171], 0
  ds_read_b128 v[36:39], v5 offset:17408
  s_waitcnt lgkmcnt(6)
  v_mfma_f32_16x16x32_bf16 v[56:59], v[12:15], a[0:3], 0
  v_mfma_f32_16x16x32_bf16 v[60:63], v[12:15], a[56:59], 0
  v_mfma_f32_16x16x32_bf16 v[64:67], v[12:15], a[112:115], 0
  v_mfma_f32_16x16x32_bf16 v[68:71], v[12:15], a[168:171], 0
  ds_read_b128 v[8:11], v5 offset:4096
  s_waitcnt lgkmcnt(6)
  v_mfma_f32_16x16x32_bf16 v[40:43], v[16:19], a[4:7], v[40:43]
  v_mfma_f32_16x16x32_bf16 v[44:47], v[16:19], a[60:63], v[44:47]
  v_mfma_f32_16x16x32_bf16 v[48:51], v[16:19], a[116:119], v[48:51]
  v_mfma_f32_16x16x32_bf16 v[52:55], v[16:19], a[172:175], v[52:55]
  ds_read_b128 v[12:15], v5 offset:18432
  s_waitcnt lgkmcnt(6)
  v_mfma_f32_16x16x32_bf16 v[56:59], v[20:23], a[4:7], v[56:59]
  v_mfma_f32_16x16x32_bf16 v[60:63], v[20:23], a[60:63], v[60:63]
  v_mfma_f32_16x16x32_bf16 v[64:67], v[20:23], a[116:119], v[64:67]
  v_mfma_f32_16x16x32_bf16 v[68:71], v[20:23], a[172:175], v[68:71]
  ds_read_b128 v[16:19], v5 offset:5120
  s_waitcnt lgkmcnt(6)
  v_mfma_f32_16x16x32_bf16 v[40:43], v[24:27], a[8:11], v[40:43]
  v_mfma_f32_16x16x32_bf16 v[44:47], v[24:27], a[64:67], v[44:47]
  v_mfma_f32_16x16x32_bf16 v[48:51], v[24:27], a[120:123], v[48:51]
  v_mfma_f32_16x16x32_bf16 v[52:55], v[24:27], a[176:179], v[52:55]
  ds_read_b128 v[20:23], v5 offset:19456
  s_waitcnt lgkmcnt(6)
  v_mfma_f32_16x16x32_bf16 v[56:59], v[28:31], a[8:11], v[56:59]
  v_mfma_f32_16x16x32_bf16 v[60:63], v[28:31], a[64:67], v[60:63]
  v_mfma_f32_16x16x32_bf16 v[64:67], v[28:31], a[120:123], v[64:67]
  v_mfma_f32_16x16x32_bf16 v[68:71], v[28:31], a[176:179], v[68:71]
  ds_read_b128 v[24:27], v5 offset:6144
  s_waitcnt lgkmcnt(6)
  v_mfma_f32_16x16x32_bf16 v[40:43], v[32:35], a[12:15], v[40:43]
  v_mfma_f32_16x16x32_bf16 v[44:47], v[32:35], a[68:71], v[44:47]
  v_mfma_f32_16x16x32_bf16 v[48:51], v[32:35], a[124:127], v[48:51]
  v_mfma_f32_16x16x32_bf16 v[52:55], v[32:35], a[180:183], v[52:55]
  ds_read_b128 v[28:31], v5 offset:20480
  s_waitcnt lgkmcnt(6)
  v_mfma_f32_16x16x32_bf16 v[56:59], v[36:39], a[12:15], v[56:59]
  v_mfma_f32_16x16x32_bf16 v[60:63], v[36:39], a[68:71], v[60:63]
  v_mfma_f32_16x16x32_bf16 v[64:67], v[36:39], a[124:127], v[64:67]
  v_mfma_f32_16x16x32_bf16 v[68:71], v[36:39], a[180:183], v[68:71]
  ds_read_b128 v[32:35], v5 offset:7168
  s_waitcnt lgkmcnt(6)
  v_mfma_f32_16x16x32_bf16 v[40:43], v[8:11], a[16:19], v[40:43]
  v_mfma_f32_16x16x32_bf16 v[44:47], v[8:11], a[72:75], v[44:47]
  v_mfma_f32_16x16x32_bf16 v[48:51], v[8:11], a[128:131], v[48:51]
  v_mfma_f32_16x16x32_bf16 v[52:55], v[8:11], a[184:187], v[52:55]
  ds_read_b128 v[36:39], v5 offset:21504
  s_waitcnt lgkmcnt(6)
  v_mfma_f32_16x16x32_bf16 v[56:59], v[12:15], a[16:19], v[56:59]
  v_mfma_f32_16x16x32_bf16 v[60:63], v[12:15], a[72:75], v[60:63]
  v_mfma_f32_16x16x32_bf16 v[64:67], v[12:15], a[128:131], v[64:67]
  v_mfma_f32_16x16x32_bf16 v[68:71], v[12:15], a[184:187], v[68:71]
  ds_read_b128 v[8:11], v5 offset:8192
  s_waitcnt lgkmcnt(6)
  v_mfma_f32_16x16x32_bf16 v[40:43], v[16:19], a[20:23], v[40:43]
  v_mfma_f32_16x16x32_bf16 v[44:47], v[16:19], a[76:79], v[44:47]
  v_mfma_f32_16x16x32_bf16 v[48:51], v[16:19], a[132:135], v[48:51]
  v_mfma_f32_16x16x32_bf16 v[52:55], v[16:19], a[188:191], v[52:55]
  ds_read_b128 v[12:15], v5 offset:22528
  s_waitcnt lgkmcnt(6)
  v_mfma_f32_16x16x32_bf16 v[56:59], v[20:23], a[20:23], v[56:59]
  v_mfma_f32_16x16x32_bf16 v[60:63], v[20:23], a[76:79], v[60:63]
  v_mfma_f32_16x16x32_bf16 v[64:67], v[20:23], a[132:135], v[64:67]
  v_mfma_f32_16x16x32_bf16 v[68:71], v[20:23], a[188:191], v[68:71]
  ds_read_b128 v[16:19], v5 offset:9216
  s_waitcnt lgkmcnt(6)
  v_mfma_f32_16x16x32_bf16 v[40:43], v[24:27], a[24:27], v[40:43]
  v_mfma_f32_16x16x32_bf16 v[44:47], v[24:27], a[80:83], v[44:47]
  v_mfma_f32_16x16x32_bf16 v[48:51], v[24:27], a[136:139], v[48:51]
  v_mfma_f32_16x16x32_bf16 v[52:55], v[24:27], a[192:195], v[52:55]
  ds_read_b128 v[20:23], v5 offset:23552
  s_waitcnt lgkmcnt(6)
  v_mfma_f32_16x16x32_bf16 v[56:59], v[28:31], a[24:27], v[56:59]
  v_mfma_f32_16x16x32_bf16 v[60:63], v[28:31], a[80:83], v[60:63]
  v_mfma_f32_16x16x32_bf16 v[64:67], v[28:31], a[136:139], v[64:67]
  v_mfma_f32_16x16x32_bf16 v[68:71], v[28:31], a[192:195], v[68:71]
  ds_read_b128 v[24:27], v5 offset:10240
  s_waitcnt lgkmcnt(6)
  v_mfma_f32_16x16x32_bf16 v[40:43], v[32:35], a[28:31], v[40:43]
  v_mfma_f32_16x16x32_bf16 v[44:47], v[32:35], a[84:87], v[44:47]
  v_mfma_f32_16x16x32_bf16 v[48:51], v[32:35], a[140:143], v[48:51]
  v_mfma_f32_16x16x32_bf16 v[52:55], v[32:35], a[196:199], v[52:55]
  ds_read_b128 v[28:31], v5 offset:24576
  s_waitcnt lgkmcnt(6)
  v_mfma_f32_16x16x32_bf16 v[56:59], v[36:39], a[28:31], v[56:59]
  v_mfma_f32_16x16x32_bf16 v[60:63], v[36:39], a[84:87], v[60:63]
  v_mfma_f32_16x16x32_bf16 v[64:67], v[36:39], a[140:143], v[64:67]
  v_mfma_f32_16x16x32_bf16 v[68:71], v[36:39], a[196:199], v[68:71]
  ds_read_b128 v[32:35], v5 offset:11264
  s_waitcnt lgkmcnt(6)
  v_mfma_f32_16x16x32_bf16 v[40:43], v[8:11], a[32:35], v[40:43]
  v_mfma_f32_16x16x32_bf16 v[44:47], v[8:11], a[88:91], v[44:47]
  v_mfma_f32_16x16x32_bf16 v[48:51], v[8:11], a[144:147], v[48:51]
  v_mfma_f32_16x16x32_bf16 v[52:55], v[8:11], a[200:203], v[52:55]
  ds_read_b128 v[36:39], v5 offset:25600
  s_waitcnt lgkmcnt(6)
  v_mfma_f32_16x16x32_bf16 v[56:59], v[12:15], a[32:35], v[56:59]
  v_mfma_f32_16x16x32_bf16 v[60:63], v[12:15], a[88:91], v[60:63]
  v_mfma_f32_16x16x32_bf16 v[64:67], v[12:15], a[144:147], v[64:67]
  v_mfma_f32_16x16x32_bf16 v[68:71], v[12:15], a[200:203], v[68:71]
  ds_read_b128 v[8:11], v5 offset:12288
  s_waitcnt lgkmcnt(6)
  v_mfma_f32_16x16x32_bf16 v[40:43], v[16:19], a[36:39], v[40:43]
  v_mfma_f32_16x16x32_bf16 v[44:47], v[16:19], a[92:95], v[44:47]
  v_mfma_f32_16x16x32_bf16 v[48:51], v[16:19], a[148:151], v[48:51]
  v_mfma_f32_16x16x32_bf16 v[52:55], v[16:19], a[204:207], v[52:55]
  ds_read_b128 v[12:15], v5 offset:26624
  s_waitcnt lgkmcnt(6)
  v_mfma_f32_16x16x32_bf16 v[56:59], v[20:23], a[36:39], v[56:59]
  v_mfma_f32_16x16x32_bf16 v[60:63], v[20:23], a[92:95], v[60:63]
  v_mfma_f32_16x16x32_bf16 v[64:67], v[20:23], a[148:151], v[64:67]
  v_mfma_f32_16x16x32_bf16 v[68:71], v[20:23], a[204:207], v[68:71]
  ds_read_b128 v[16:19], v5 offset:13312
  s_waitcnt lgkmcnt(6)
  v_mfma_f32_16x16x32_bf16 v[40:43], v[24:27], a[40:43], v[40:43]
  v_mfma_f32_16x16x32_bf16 v[44:47], v[24:27], a[96:99], v[44:47]
  v_mfma_f32_16x16x32_bf16 v[48:51], v[24:27], a[152:155], v[48:51]
  v_mfma_f32_16x16x32_bf16 v[52:55], v[24:27], a[208:211], v[52:55]
  ds_read_b128 v[20:23], v5 offset:27648
  s_waitcnt lgkmcnt(6)
  v_mfma_f32_16x16x32_bf16 v[56:59], v[28:31], a[40:43], v[56:59]
  v_mfma_f32_16x16x32_bf16 v[60:63], v[28:31], a[96:99], v[60:63]
  v_mfma_f32_16x16x32_bf16 v[64:67], v[28:31], a[152:155], v[64:67]
  v_mfma_f32_16x16x32_bf16 v[68:71], v[28:31], a[208:211], v[68:71]
  s_waitcnt lgkmcnt(5)
  v_mfma_f32_16x16x32_bf16 v[40:43], v[32:35], a[44:47], v[40:43]
  v_mfma_f32_16x16x32_bf16 v[44:47], v[32:35], a[100:103], v[44:47]
  v_mfma_f32_16x16x32_bf16 v[48:51], v[32:35], a[156:159], v[48:51]
  v_mfma_f32_16x16x32_bf16 v[52:55], v[32:35], a[212:215], v[52:55]
  s_waitcnt lgkmcnt(4)
  v_mfma_f32_16x16x32_bf16 v[56:59], v[36:39], a[44:47], v[56:59]
  v_mfma_f32_16x16x32_bf16 v[60:63], v[36:39], a[100:103], v[60:63]
  v_mfma_f32_16x16x32_bf16 v[64:67], v[36:39], a[156:159], v[64:67]
  v_mfma_f32_16x16x32_bf16 v[68:71], v[36:39], a[212:215], v[68:71]
  s_waitcnt lgkmcnt(3)
  v_mfma_f32_16x16x32_bf16 v[40:43], v[8:11], a[48:51], v[40:43]
  v_mfma_f32_16x16x32_bf16 v[44:47], v[8:11], a[104:107], v[44:47]
  v_mfma_f32_16x16x32_bf16 v[48:51], v[8:11], a[160:163], v[48:51]
  v_mfma_f32_16x16x32_bf16 v[52:55], v[8:11], a[216:219], v[52:55]
  s_waitcnt lgkmcnt(2)
  v_mfma_f32_16x16x32_bf16 v[56:59], v[12:15], a[48:51], v[56:59]
  v_mfma_f32_16x16x32_bf16 v[60:63], v[12:15], a[104:107], v[60:63]
  v_mfma_f32_16x16x32_bf16 v[64:67], v[12:15], a[160:163], v[64:67]
  v_mfma_f32_16x16x32_bf16 v[68:71], v[12:15], a[216:219], v[68:71]
  s_waitcnt lgkmcnt(1)
  v_mfma_f32_16x16x32_bf16 v[40:43], v[16:19], a[52:55], v[40:43]
  v_mfma_f32_16x16x32_bf16 v[44:47], v[16:19], a[108:111], v[44:47]
  v_mfma_f32_16x16x32_bf16 v[48:51], v[16:19], a[164:167], v[48:51]
  v_mfma_f32_16x16x32_bf16 v[52:55], v[16:19], a[220:223], v[52:55]
  s_waitcnt lgkmcnt(0)
  v_mfma_f32_16x16x32_bf16 v[56:59], v[20:23], a[52:55], v[56:59]
  v_mfma_f32_16x16x32_bf16 v[60:63], v[20:23], a[108:111], v[60:63]
  v_mfma_f32_16x16x32_bf16 v[64:67], v[20:23], a[164:167], v[64:67]
  v_mfma_f32_16x16x32_bf16 v[68:71], v[20:23], a[220:223], v[68:71]
  s_lshl_b32 s24, s19, 10
  s_add_u32 s24, s24, s29
  v_cvt_pk_bf16_f32 v72, v40, v41
  v_cvt_pk_bf16_f32 v73, v42, v43
  v_cvt_pk_bf16_f32 v74, v56, v57
  v_cvt_pk_bf16_f32 v75, v58, v59
  s_add_u32 s25, s24, 0
  buffer_store_dwordx4 v[72:75], v2, s[8:11], s25 offen sc1
  v_cvt_pk_bf16_f32 v76, v44, v45
  v_cvt_pk_bf16_f32 v77, v46, v47
  v_cvt_pk_bf16_f32 v78, v60, v61
  v_cvt_pk_bf16_f32 v79, v62, v63
  s_add_u32 s25, s24, 14336
  buffer_store_dwordx4 v[76:79], v2, s[8:11], s25 offen sc1
  v_cvt_pk_bf16_f32 v80, v48, v49
  v_cvt_pk_bf16_f32 v81, v50, v51
  v_cvt_pk_bf16_f32 v82, v64, v65
  v_cvt_pk_bf16_f32 v83, v66, v67
  s_add_u32 s25, s24, 458752
  buffer_store_dwordx4 v[80:83], v2, s[8:11], s25 offen sc1
  v_cvt_pk_bf16_f32 v84, v52, v53
  v_cvt_pk_bf16_f32 v85, v54, v55
  v_cvt_pk_bf16_f32 v86, v68, v69
  v_cvt_pk_bf16_f32 v87, v70, v71
  s_add_u32 s25, s24, 473088
  buffer_store_dwordx4 v[84:87], v2, s[8:11], s25 offen sc1
  s_mov_b32 s33, s32
  s_add_u32 s32, s32, 28672
  s_cmp_eq_u32 s32, 86016
  s_cselect_b32 s32, 0, s32
  s_add_u32 s19, s19, 1
  s_cmp_lt_u32 s19, s35
  s_cbranch_scc1 wg_f_loop
  s_branch wg_done
wg_vo:
  s_sub_u32 s29, s17, 16
  s_lshl_b32 s29, s29, 6
  s_add_u32 s29, s29, s28
  s_mul_i32 s29, s29, 28672
  s_add_u32 s29, s29, 42205184
  v_mul_u32_u24 v6, 28, v3
  s_mov_b32 s31, 0
  s_lshl_b32 s24, s34, 1
  s_mul_i32 s24, s24, 14336
  s_add_u32 s24, s24, s23
  s_cmp_lt_u32 s34, s35
  s_cselect_b32 s24, s24, 0x10000000
  s_add_u32 m0, s31, s27
  s_nop 0
  buffer_load_dwordx4 v2, s[8:11], s24 offen offset:0 sc1 lds
  buffer_load_dwordx4 v2, s[8:11], s24 offen offset:1024 sc1 lds
  buffer_load_dwordx4 v2, s[8:11], s24 offen offset:2048 sc1 lds
  buffer_load_dwordx4 v2, s[8:11], s24 offen offset:3072 sc1 lds
  s_add_u32 m0, m0, 4096
  s_add_u32 s24, s24, 4096
  buffer_load_dwordx4 v2, s[8:11], s24 offen offset:0 sc1 lds
  buffer_load_dwordx4 v2, s[8:11], s24 offen offset:1024 sc1 lds
  buffer_load_dwordx4 v2, s[8:11], s24 offen offset:2048 sc1 lds
  s_add_u32 s30, s34, 1
  s_mov_b32 s31, 28672
  s_lshl_b32 s24, s30, 1
  s_mul_i32 s24, s24, 14336
  s_add_u32 s24, s24, s23
  s_cmp_lt_u32 s30, s35
  s_cselect_b32 s24, s24, 0x10000000
  s_add_u32 m0, s31, s27
  s_nop 0
  buffer_load_dwordx4 v2, s[8:11], s24 offen offset:0 sc1 lds
  buffer_load_dwordx4 v2, s[8:11], s24 offen offset:1024 sc1 lds
  buffer_load_dwordx4 v2, s[8:11], s24 offen offset:2048 sc1 lds
  buffer_load_dwordx4 v2, s[8:11], s24 offen offset:3072 sc1 lds
  s_add_u32 m0, m0, 4096
  s_add_u32 s24, s24, 4096
  buffer_load_dwordx4 v2, s[8:11], s24 offen offset:0 sc1 lds
  buffer_load_dwordx4 v2, s[8:11], s24 offen offset:1024 sc1 lds
  buffer_load_dwordx4 v2, s[8:11], s24 offen offset:2048 sc1 lds
  s_mov_b32 s19, s34
  s_mov_b32 s32, 0
  s_mov_b32 s33, 57344
  s_waitcnt vmcnt(7)
  s_branch wg_vo_in
wg_vo_loop:
  s_waitcnt vmcnt(11)
wg_vo_in:
  s_barrier
  s_add_u32 s30, s19, 2
  s_lshl_b32 s24, s30, 1
  s_mul_i32 s24, s24, 14336
  s_add_u32 s24, s24, s23
  s_cmp_lt_u32 s30, s35
  s_cselect_b32 s24, s24, 0x10000000
  s_add_u32 m0, s33, s27
  s_nop 0
  buffer_load_dwordx4 v2, s[8:11], s24 offen offset:0 sc1 lds
  buffer_load_dwordx4 v2, s[8:11], s24 offen offset:1024 sc1 lds
  buffer_load_dwordx4 v2, s[8:11], s24 offen offset:2048 sc1 lds
  buffer_load_dwordx4 v2, s[8:11], s24 offen offset:3072 sc1 lds
  s_add_u32 m0, m0, 4096
  s_add_u32 s24, s24, 4096
  buffer_load_dwordx4 v2, s[8:11], s24 offen offset:0 sc1 lds
  buffer_load_dwordx4 v2, s[8:11], s24 offen offset:1024 sc1 lds
  buffer_load_dwordx4 v2, s[8:11], s24 offen offset:2048 sc1 lds
  v_add_u32 v5, s32, v2
  ds_read_b128 v[8:11], v5 offset:0
  ds_read_b128 v[12:15], v5 offset:14336
  ds_read_b128 v[16:19], v5 offset:1024
  ds_read_b128 v[20:23], v5 offset:15360
  ds_read_b128 v[24:27], v5 offset:2048
  ds_read_b128 v[28:31], v5 offset:16384
  ds_read_b128 v[32:35], v5 offset:3072
  s_waitcnt lgkmcnt(6)
  v_mfma_f32_16x16x32_bf16 v[40:43], a[0:3], v[8:11], 0
  v_mfma_f32_16x16x32_bf16 v[44:47], a[56:59], v[8:11], 0
  v_mfma_f32_16x16x32_bf16 v[48:51], a[112:115], v[8:11], 0
  v_mfma_f32_16x16x32_bf16 v[52:55], a[168:171], v[8:11], 0
  ds_read_b128 v[36:39], v5 offset:17408
  s_waitcnt lgkmcnt(6)
  v_mfma_f32_16x16x32_bf16 v[56:59], a[0:3], v[12:15], 0
  v_mfma_f32_16x16x32_bf16 v[60:63], a[56:59], v[12:15], 0
  v_mfma_f32_16x16x32_bf16 v[64:67], a[112:115], v[12:15], 0
  v_mfma_f32_16x16x32_bf16 v[68:71], a[168:171], v[12:15], 0
  ds_read_b128 v[8:11], v5 offset:4096
  s_waitcnt lgkmcnt(6)
  v_mfma_f32_16x16x32_bf16 v[40:43], a[4:7], v[16:19], v[40:43]
  v_mfma_f32_16x16x32_bf16 v[44:47], a[60:63], v[16:19], v[44:47]
  v_mfma_f32_16x16x32_bf16 v[48:51], a[116:119], v[16:19], v[48:51]
  v_mfma_f32_16x16x32_bf16 v[52:55], a[172:175], v[16:19], v[52:55]
  ds_read_b128 v[12:15], v5 offset:18432
  s_waitcnt lgkmcnt(6)
  v_mfma_f32_16x16x32_bf16 v[56:59], a[4:7], v[20:23], v[56:59]
  v_mfma_f32_16x16x32_bf16 v[60:63], a[60:63], v[20:23], v[60:63]
  v_mfma_f32_16x16x32_bf16 v[64:67], a[116:119], v[20:23], v[64:67]
  v_mfma_f32_16x16x32_bf16 v[68:71], a[172:175], v[20:23], v[68:71]
  ds_read_b128 v[16:19], v5 offset:5120
  s_waitcnt lgkmcnt(6)
  v_mfma_f32_16x16x32_bf16 v[40:43], a[8:11], v[24:27], v[40:43]
  v_mfma_f32_16x16x32_bf16 v[44:47], a[64:67], v[24:27], v[44:47]
  v_mfma_f32_16x16x32_bf16 v[48:51], a[120:123], v[24:27], v[48:51]
  v_mfma_f32_16x16x32_bf16 v[52:55], a[176:179], v[24:27], v[52:55]
  ds_read_b128 v[20:23], v5 offset:19456
  s_waitcnt lgkmcnt(6)
  v_mfma_f32_16x16x32_bf16 v[56:59], a[8:11], v[28:31], v[56:59]
  v_mfma_f32_16x16x32_bf16 v[60:63], a[64:67], v[28:31], v[60:63]
  v_mfma_f32_16x16x32_bf16 v[64:67], a[120:123], v[28:31], v[64:67]
  v_mfma_f32_16x16x32_bf16 v[68:71], a[176:179], v[28:31], v[68:71]
  ds_read_b128 v[24:27], v5 offset:6144
  s_waitcnt lgkmcnt(6)
  v_mfma_f32_16x16x32_bf16 v[40:43], a[12:15], v[32:35], v[40:43]
  v_mfma_f32_16x16x32_bf16 v[44:47], a[68:71], v[32:35], v[44:47]
  v_mfma_f32_16x16x32_bf16 v[48:51], a[124:127], v[32:35], v[48:51]
  v_mfma_f32_16x16x32_bf16 v[52:55], a[180:183], v[32:35], v[52:55]
  ds_read_b128 v[28:31], v5 offset:20480
  s_waitcnt lgkmcnt(6)
  v_mfma_f32_16x16x32_bf16 v[56:59], a[12:15], v[36:39], v[56:59]
  v_mfma_f32_16x16x32_bf16 v[60:63], a[68:71], v[36:39], v[60:63]
  v_mfma_f32_16x16x32_bf16 v[64:67], a[124:127], v[36:39], v[64:67]
  v_mfma_f32_16x16x32_bf16 v[68:71], a[180:183], v[36:39], v[68:71]
  ds_read_b128 v[32:35], v5 offset:7168
  s_waitcnt lgkmcnt(6)
  v_mfma_f32_16x16x32_bf16 v[40:43], a[16:19], v[8:11], v[40:43]
  v_mfma_f32_16x16x32_bf16 v[44:47], a[72:75], v[8:11], v[44:47]
  v_mfma_f32_16x16x32_bf16 v[48:51], a[128:131], v[8:11], v[48:51]
  v_mfma_f32_16x16x32_bf16 v[52:55], a[184:187], v[8:11], v[52:55]
  ds_read_b128 v[36:39], v5 offset:21504
  s_waitcnt lgkmcnt(6)
  v_mfma_f32_16x16x32_bf16 v[56:59], a[16:19], v[12:15], v[56:59]
  v_mfma_f32_16x16x32_bf16 v[60:63], a[72:75], v[12:15], v[60:63]
  v_mfma_f32_16x16x32_bf16 v[64:67], a[128:131], v[12:15], v[64:67]
  v_mfma_f32_16x16x32_bf16 v[68:71], a[184:187], v[12:15], v[68:71]
  ds_read_b128 v[8:11], v5 offset:8192
  s_waitcnt lgkmcnt(6)
  v_mfma_f32_16x16x32_bf16 v[40:43], a[20:23], v[16:19], v[40:43]
  v_mfma_f32_16x16x32_bf16 v[44:47], a[76:79], v[16:19], v[44:47]
  v_mfma_f32_16x16x32_bf16 v[48:51], a[132:135], v[16:19], v[48:51]
  v_mfma_f32_16x16x32_bf16 v[52:55], a[188:191], v[16:19], v[52:55]
  ds_read_b128 v[12:15], v5 offset:22528
  s_waitcnt lgkmcnt(6)
  v_mfma_f32_16x16x32_bf16 v[56:59], a[20:23], v[20:23], v[56:59]
  v_mfma_f32_16x16x32_bf16 v[60:63], a[76:79], v[20:23], v[60:63]
  v_mfma_f32_16x16x32_bf16 v[64:67], a[132:135], v[20:23], v[64:67]
  v_mfma_f32_16x16x32_bf16 v[68:71], a[188:191], v[20:23], v[68:71]
  ds_read_b128 v[16:19], v5 offset:9216
  s_waitcnt lgkmcnt(6)
  v_mfma_f32_16x16x32_bf16 v[40:43], a[24:27], v[24:27], v[40:43]
  v_mfma_f32_16x16x32_bf16 v[44:47], a[80:83], v[24:27], v[44:47]
  v_mfma_f32_16x16x32_bf16 v[48:51], a[136:139], v[24:27], v[48:51]
  v_mfma_f32_16x16x32_bf16 v[52:55], a[192:195], v[24:27], v[52:55]
  ds_read_b128 v[20:23], v5 offset:23552
  s_waitcnt lgkmcnt(6)
  v_mfma_f32_16x16x32_bf16 v[56:59], a[24:27], v[28:31], v[56:59]
  v_mfma_f32_16x16x32_bf16 v[60:63], a[80:83], v[28:31], v[60:63]
  v_mfma_f32_16x16x32_bf16 v[64:67], a[136:139], v[28:31], v[64:67]
  v_mfma_f32_16x16x32_bf16 v[68:71], a[192:195], v[28:31], v[68:71]
  ds_read_b128 v[24:27], v5 offset:10240
  s_waitcnt lgkmcnt(6)
  v_mfma_f32_16x16x32_bf16 v[40:43], a[28:31], v[32:35], v[40:43]
  v_mfma_f32_16x16x32_bf16 v[44:47], a[84:87], v[32:35], v[44:47]
  v_mfma_f32_16x16x32_bf16 v[48:51], a[140:143], v[32:35], v[48:51]
  v_mfma_f32_16x16x32_bf16 v[52:55], a[196:199], v[32:35], v[52:55]
  ds_read_b128 v[28:31], v5 offset:24576
  s_waitcnt lgkmcnt(6)
  v_mfma_f32_16x16x32_bf16 v[56:59], a[28:31], v[36:39], v[56:59]
  v_mfma_f32_16x16x32_bf16 v[60:63], a[84:87], v[36:39], v[60:63]
  v_mfma_f32_16x16x32_bf16 v[64:67], a[140:143], v[36:39], v[64:67]
  v_mfma_f32_16x16x32_bf16 v[68:71], a[196:199], v[36:39], v[68:71]
  ds_read_b128 v[32:35], v5 offset:11264
  s_waitcnt lgkmcnt(6)
  v_mfma_f32_16x16x32_bf16 v[40:43], a[32:35], v[8:11], v[40:43]
  v_mfma_f32_16x16x32_bf16 v[44:47], a[88:91], v[8:11], v[44:47]
  v_mfma_f32_16x16x32_bf16 v[48:51], a[144:147], v[8:11], v[48:51]
  v_mfma_f32_16x16x32_bf16 v[52:55], a[200:203], v[8:11], v[52:55]
  ds_read_b128 v[36:39], v5 offset:25600
  s_waitcnt lgkmcnt(6)
  v_mfma_f32_16x16x32_bf16 v[56:59], a[32:35], v[12:15], v[56:59]
  v_mfma_f32_16x16x32_bf16 v[60:63], a[88:91], v[12:15], v[60:63]
  v_mfma_f32_16x16x32_bf16 v[64:67], a[144:147], v[12:15], v[64:67]
  v_mfma_f32_16x16x32_bf16 v[68:71], a[200:203], v[12:15], v[68:71]
  ds_read_b128 v[8:11], v5 offset:12288
  s_waitcnt lgkmcnt(6)
  v_mfma_f32_16x16x32_bf16 v[40:43], a[36:39], v[16:19], v[40:43]
  v_mfma_f32_16x16x32_bf16 v[44:47], a[92:95], v[16:19], v[44:47]
  v_mfma_f32_16x16x32_bf16 v[48:51], a[148:151], v[16:19], v[48:51]
  v_mfma_f32_16x16x32_bf16 v[52:55], a[204:207], v[16:19], v[52:55]
  ds_read_b128 v[12:15], v5 offset:26624
  s_waitcnt lgkmcnt(6)
  v_mfma_f32_16x16x32_bf16 v[56:59], a[36:39], v[20:23], v[56:59]
  v_mfma_f32_16x16x32_bf16 v[60:63], a[92:95], v[20:23], v[60:63]
  v_mfma_f32_16x16x32_bf16 v[64:67], a[148:151], v[20:23], v[64:67]
  v_mfma_f32_16x16x32_bf16 v[68:71], a[204:207], v[20:23], v[68:71]
  ds_read_b128 v[16:19], v5 offset:13312
  s_waitcnt lgkmcnt(6)
  v_mfma_f32_16x16x32_bf16 v[40:43], a[40:43], v[24:27], v[40:43]
  v_mfma_f32_16x16x32_bf16 v[44:47], a[96:99], v[24:27], v[44:47]
  v_mfma_f32_16x16x32_bf16 v[48:51], a[152:155], v[24:27], v[48:51]
  v_mfma_f32_16x16x32_bf16 v[52:55], a[208:211], v[24:27], v[52:55]
  ds_read_b128 v[20:23], v5 offset:27648
  s_waitcnt lgkmcnt(6)
  v_mfma_f32_16x16x32_bf16 v[56:59], a[40:43], v[28:31], v[56:59]
  v_mfma_f32_16x16x32_bf16 v[60:63], a[96:99], v[28:31], v[60:63]
  v_mfma_f32_16x16x32_bf16 v[64:67], a[152:155], v[28:31], v[64:67]
  v_mfma_f32_16x16x32_bf16 v[68:71], a[208:211], v[28:31], v[68:71]
  s_waitcnt lgkmcnt(5)
  v_mfma_f32_16x16x32_bf16 v[40:43], a[44:47], v[32:35], v[40:43]
  v_mfma_f32_16x16x32_bf16 v[44:47], a[100:103], v[32:35], v[44:47]
  v_mfma_f32_16x16x32_bf16 v[48:51], a[156:159], v[32:35], v[48:51]
  v_mfma_f32_16x16x32_bf16 v[52:55], a[212:215], v[32:35], v[52:55]
  s_waitcnt lgkmcnt(4)
  v_mfma_f32_16x16x32_bf16 v[56:59], a[44:47], v[36:39], v[56:59]
  v_mfma_f32_16x16x32_bf16 v[60:63], a[100:103], v[36:39], v[60:63]
  v_mfma_f32_16x16x32_bf16 v[64:67], a[156:159], v[36:39], v[64:67]
  v_mfma_f32_16x16x32_bf16 v[68:71], a[212:215], v[36:39], v[68:71]
  s_waitcnt lgkmcnt(3)
  v_mfma_f32_16x16x32_bf16 v[40:43], a[48:51], v[8:11], v[40:43]
  v_mfma_f32_16x16x32_bf16 v[44:47], a[104:107], v[8:11], v[44:47]
  v_mfma_f32_16x16x32_bf16 v[48:51], a[160:163], v[8:11], v[48:51]
  v_mfma_f32_16x16x32_bf16 v[52:55], a[216:219], v[8:11], v[52:55]
  s_waitcnt lgkmcnt(2)
  v_mfma_f32_16x16x32_bf16 v[56:59], a[48:51], v[12:15], v[56:59]
  v_mfma_f32_16x16x32_bf16 v[60:63], a[104:107], v[12:15], v[60:63]
  v_mfma_f32_16x16x32_bf16 v[64:67], a[160:163], v[12:15], v[64:67]
  v_mfma_f32_16x16x32_bf16 v[68:71], a[216:219], v[12:15], v[68:71]
  s_waitcnt lgkmcnt(1)
  v_mfma_f32_16x16x32_bf16 v[40:43], a[52:55], v[16:19], v[40:43]
  v_mfma_f32_16x16x32_bf16 v[44:47], a[108:111], v[16:19], v[44:47]
  v_mfma_f32_16x16x32_bf16 v[48:51], a[164:167], v[16:19], v[48:51]
  v_mfma_f32_16x16x32_bf16 v[52:55], a[220:223], v[16:19], v[52:55]
  s_waitcnt lgkmcnt(0)
  v_mfma_f32_16x16x32_bf16 v[56:59], a[52:55], v[20:23], v[56:59]
  v_mfma_f32_16x16x32_bf16 v[60:63], a[108:111], v[20:23], v[60:63]
  v_mfma_f32_16x16x32_bf16 v[64:67], a[164:167], v[20:23], v[64:67]
  v_mfma_f32_16x16x32_bf16 v[68:71], a[220:223], v[20:23], v[68:71]
  s_add_u32 s25, s29, 28672
  s_lshl_b32 s24, s19, 5
  s_add_u32 s24, s24, 0
  v_add_u32 v88, s24, v4
  v_mul_u32_u24 v89, 2341, v88
  v_lshrrev_b32 v89, 16, v89
  v_mul_u32_u24 v89, 84, v89
  v_add3_u32 v88, v88, v89, v6
  v_lshlrev_b32 v90, 4, v88
  v_cvt_pk_bf16_f32 v72, v40, v41
  v_cvt_pk_bf16_f32 v73, v42, v43
  v_cvt_pk_bf16_f32 v74, v44, v45
  v_cvt_pk_bf16_f32 v75, v46, v47
  buffer_store_dwordx4 v[72:75], v90, s[8:11], s29 offen sc1
  v_cvt_pk_bf16_f32 v76, v48, v49
  v_cvt_pk_bf16_f32 v77, v50, v51
  v_cvt_pk_bf16_f32 v78, v52, v53
  v_cvt_pk_bf16_f32 v79, v54, v55
  buffer_store_dwordx4 v[76:79], v90, s[8:11], s25 offen sc1
  s_lshl_b32 s24, s19, 5
  s_add_u32 s24, s24, 16
  v_add_u32 v88, s24, v4
  v_mul_u32_u24 v89, 2341, v88
  v_lshrrev_b32 v89, 16, v89
  v_mul_u32_u24 v89, 84, v89
  v_add3_u32 v88, v88, v89, v6
  v_lshlrev_b32 v91, 4, v88
  v_cvt_pk_bf16_f32 v80, v56, v57
  v_cvt_pk_bf16_f32 v81, v58, v59
  v_cvt_pk_bf16_f32 v82, v60, v61
  v_cvt_pk_bf16_f32 v83, v62, v63
  buffer_store_dwordx4 v[80:83], v91, s[8:11], s29 offen sc1
  v_cvt_pk_bf16_f32 v84, v64, v65
  v_cvt_pk_bf16_f32 v85, v66, v67
  v_cvt_pk_bf16_f32 v86, v68, v69
  v_cvt_pk_bf16_f32 v87, v70, v71
  buffer_store_dwordx4 v[84:87], v91, s[8:11], s25 offen sc1
  s_mov_b32 s33, s32
  s_add_u32 s32, s32, 28672
  s_cmp_eq_u32 s32, 86016
  s_cselect_b32 s32, 0, s32
  s_add_u32 s19, s19, 1
  s_cmp_lt_u32 s19, s35
  s_cbranch_scc1 wg_vo_loop
  s_branch wg_done
wg_done:
  s_lshl_b32 s20, s18, 4
  s_and_b32 s21, s17, 15
  s_add_u32 s20, s20, s21
  s_lshl_b32 s20, s20, 7
  s_cmp_lt_u32 s17, 16
  s_cselect_b32 s21, 16384, 0
  s_add_u32 s20, s20, s21
  s_add_u32 s20, s20, 88541184
  s_sub_u32 s21, s35, s34
  v_mov_b32 v5, s21
  v_mov_b32 v6, 0
  s_waitcnt vmcnt(0)
  s_mov_b64 exec, 1
  buffer_atomic_add v5, v6, s[8:11], s20 offen
  s_mov_b64 exec, -1
  s_branch wk_loop
wk_a:
  s_load_dwordx8 s[36:43], s[0:1], 56
  s_load_dwordx4 s[44:47], s[0:1], 88
  s_sub_u32 s3, s3, 432
  s_and_b32 s17, s3, 15
  s_lshr_b32 s19, s3, 5
  s_bitcmp1_b32 s3, 4
  s_cselect_b32 s31, 7, 0
  s_waitcnt lgkmcnt(0)
  s_mov_b32 s60, s40
  s_and_b32 s61, s41, 0xffff
  s_mov_b32 s62, 3670016
  s_mov_b32 s63, 0x20000
  s_mov_b32 s56, s42
  s_and_b32 s57, s43, 0xffff
  s_mov_b32 s58, 3670016
  s_mov_b32 s59, 0x20000
  s_lshl_b32 s30, s16, 13
  s_lshl_b32 s27, s19, 19
  s_lshl_b32 s29, s16, 17
  s_add_u32 s27, s27, s29
  s_lshl_b32 s29, s17, 9
  s_add_u32 s27, s27, s29
  v_lshrrev_b32 v5, 5, v1
  v_and_b32 v6, 31, v1
  v_xor_b32 v6, v6, v5
  v_lshlrev_b32 v6, 4, v6
  v_lshl_add_u32 v6, v5, 13, v6
  s_add_u32 m0, s30, 0
  s_add_u32 s22, s27, 0
  v_xor_b32 v7, 0, v6
  buffer_load_dwordx4 v7, s[56:59], s22 offen offset:0 lds
  s_add_u32 s22, s27, 15360
  v_xor_b32 v7, 32, v6
  buffer_load_dwordx4 v7, s[56:59], s22 offen offset:1024 lds
  s_add_u32 s22, s27, 30720
  v_xor_b32 v7, 64, v6
  buffer_load_dwordx4 v7, s[56:59], s22 offen offset:2048 lds
  s_add_u32 s22, s27, 46080
  v_xor_b32 v7, 96, v6
  buffer_load_dwordx4 v7, s[56:59], s22 offen offset:3072 lds
  s_add_u32 m0, s30, 4096
  s_add_u32 s22, s27, 65536
  v_xor_b32 v7, 128, v6
  buffer_load_dwordx4 v7, s[56:59], s22 offen offset:0 lds
  s_add_u32 s22, s27, 80896
  v_xor_b32 v7, 160, v6
  buffer_load_dwordx4 v7, s[56:59], s22 offen offset:1024 lds
  s_add_u32 s22, s27, 96256
  v_xor_b32 v7, 192, v6
  buffer_load_dwordx4 v7, s[56:59], s22 offen offset:2048 lds
  s_add_u32 s22, s27, 111616
  v_xor_b32 v7, 224, v6
  buffer_load_dwordx4 v7, s[56:59], s22 offen offset:3072 lds
  v_lshrrev_b32 v5, 5, v1
  v_and_b32 v6, 31, v1
  s_lshl_b32 s25, s16, 15
  s_add_u32 s25, s25, 32768
  s_lshl_b32 s26, s17, 9
  s_add_u32 s28, s19, s16
  s_cmp_ge_u32 s28, 7
  s_cselect_b32 s20, 7, 0
  s_sub_u32 s28, s28, s20
  s_add_u32 s28, s28, s31
  s_add_u32 s29, s19, s16
  s_add_u32 s29, s29, 4
  s_cmp_ge_u32 s29, 7
  s_cselect_b32 s20, 7, 0
  s_sub_u32 s29, s29, s20
  s_add_u32 s29, s29, s31
  s_lshl_b32 s32, s28, 18
  s_add_u32 s32, s32, s26
  s_lshl_b32 s33, s29, 18
  s_add_u32 s33, s33, s26
  v_xor_b32 v8, v6, v5
  v_lshlrev_b32 v8, 4, v8
  v_lshl_add_u32 v8, v5, 13, v8
  v_xor_b32 v12, 0, v8
  v_xor_b32 v13, 32, v8
  v_add_u32 v13, 15360, v13
  v_xor_b32 v14, 0, v8
  v_add_u32 v14, 30720, v14
  v_xor_b32 v15, 32, v8
  v_add_u32 v15, 46080, v15
  s_add_u32 s20, s16, 0
  s_and_b32 s20, s20, 3
  s_mul_i32 s21, s20, 65600
  s_lshl_b32 s20, s20, 12
  s_add_u32 s48, s20, s25
  s_mov_b32 m0, s48
  v_xor_b32 v16, s21, v12
  buffer_load_dwordx4 v16, s[60:63], s32 offen offset:0 lds
  v_xor_b32 v17, s21, v13
  buffer_load_dwordx4 v17, s[60:63], s32 offen offset:1024 lds
  v_xor_b32 v18, s21, v14
  buffer_load_dwordx4 v18, s[60:63], s32 offen offset:2048 lds
  v_xor_b32 v19, s21, v15
  buffer_load_dwordx4 v19, s[60:63], s32 offen offset:3072 lds
  s_add_u32 s20, s16, 1
  s_and_b32 s20, s20, 3
  s_mul_i32 s21, s20, 65600
  s_lshl_b32 s20, s20, 12
  s_add_u32 s49, s20, s25
  s_mov_b32 m0, s49
  v_xor_b32 v20, s21, v12
  buffer_load_dwordx4 v20, s[60:63], s32 offen offset:0 lds
  v_xor_b32 v21, s21, v13
  buffer_load_dwordx4 v21, s[60:63], s32 offen offset:1024 lds
  v_xor_b32 v22, s21, v14
  buffer_load_dwordx4 v22, s[60:63], s32 offen offset:2048 lds
  v_xor_b32 v23, s21, v15
  buffer_load_dwordx4 v23, s[60:63], s32 offen offset:3072 lds
  s_add_u32 s20, s16, 2
  s_and_b32 s20, s20, 3
  s_mul_i32 s21, s20, 65600
  s_lshl_b32 s20, s20, 12
  s_add_u32 s50, s20, s25
  s_mov_b32 m0, s50
  v_xor_b32 v24, s21, v12
  buffer_load_dwordx4 v24, s[60:63], s32 offen offset:0 lds
  v_xor_b32 v25, s21, v13
  buffer_load_dwordx4 v25, s[60:63], s32 offen offset:1024 lds
  v_xor_b32 v26, s21, v14
  buffer_load_dwordx4 v26, s[60:63], s32 offen offset:2048 lds
  v_xor_b32 v27, s21, v15
  buffer_load_dwordx4 v27, s[60:63], s32 offen offset:3072 lds
  s_add_u32 s20, s16, 3
  s_and_b32 s20, s20, 3
  s_mul_i32 s21, s20, 65600
  s_lshl_b32 s20, s20, 12
  s_add_u32 s51, s20, s25
  s_mov_b32 m0, s51
  v_xor_b32 v28, s21, v12
  buffer_load_dwordx4 v28, s[60:63], s32 offen offset:0 lds
  v_xor_b32 v29, s21, v13
  buffer_load_dwordx4 v29, s[60:63], s32 offen offset:1024 lds
  v_xor_b32 v30, s21, v14
  buffer_load_dwordx4 v30, s[60:63], s32 offen offset:2048 lds
  v_xor_b32 v31, s21, v15
  buffer_load_dwordx4 v31, s[60:63], s32 offen offset:3072 lds
  s_mul_i32 s30, s17, 401408
  s_mul_i32 s20, s19, 57344
  s_add_u32 s30, s30, s20
  v_add_u32 v12, s30, v2
  v_add_u32 v13, 14336, v12
  v_add_u32 v14, 28672, v12
  v_add_u32 v15, 43008, v12
  v_lshrrev_b32 v7, 2, v4
  v_lshlrev_b32 v7, 3, v7
  v_and_b32 v8, 3, v4
  v_add_u32 v7, v7, v8
  v_xor_b32 v10, v3, v4
  v_lshlrev_b32 v10, 4, v10
  v_lshl_add_u32 v10, v7, 9, v10
  v_add_u32 v10, s25, v10
  v_xor_b32 v32, 0, v10
  v_xor_b32 v33, 64, v10
  v_xor_b32 v34, 128, v10
  v_xor_b32 v35, 192, v10
  v_and_b32 v8, 2, v4
  v_lshlrev_b32 v8, 1, v8
  v_and_b32 v9, 1, v4
  v_add_u32 v8, v8, v9
  v_lshrrev_b32 v7, 2, v4
  v_lshl_add_u32 v7, v7, 4, v8
  v_xor_b32 v8, v8, v3
  v_lshlrev_b32 v8, 4, v8
  v_lshl_add_u32 v7, v7, 9, v8
  s_mov_b32 s24, 1035512379
  s_waitcnt vmcnt(16)
  s_barrier
  s_cmp_eq_u32 s16, 3
  s_cbranch_scc1 aj_np0
  s_add_u32 m0, s48, 16384
  s_nop 0
  buffer_load_dwordx4 v16, s[60:63], s33 offen offset:0 lds
  buffer_load_dwordx4 v17, s[60:63], s33 offen offset:1024 lds
  buffer_load_dwordx4 v18, s[60:63], s33 offen offset:2048 lds
  buffer_load_dwordx4 v19, s[60:63], s33 offen offset:3072 lds
aj_np0:
  v_xor_b32 v8, 0, v7
  ds_read_b128 v[128:131], v8 offset:0
  v_xor_b32 v9, 64, v7
  ds_read_b128 v[132:135], v9 offset:0
  v_xor_b32 v10, 128, v7
  ds_read_b128 v[136:139], v10 offset:0
  v_xor_b32 v11, 192, v7
  ds_read_b128 v[140:143], v11 offset:0
  ds_read_b128 v[144:147], v8 offset:256
  ds_read_b128 v[148:151], v9 offset:256
  ds_read_b128 v[152:155], v10 offset:256
  ds_read_b128 v[156:159], v11 offset:256
  s_waitcnt lgkmcnt(4)
  s_cmp_eq_u32 s16, 3
  s_cbranch_scc1 aj_np1
  s_add_u32 m0, s49, 16384
  s_nop 0
  buffer_load_dwordx4 v20, s[60:63], s33 offen offset:0 lds
  buffer_load_dwordx4 v21, s[60:63], s33 offen offset:1024 lds
  buffer_load_dwordx4 v22, s[60:63], s33 offen offset:2048 lds
  buffer_load_dwordx4 v23, s[60:63], s33 offen offset:3072 lds
aj_np1:
  v_xor_b32 v8, 32, v7
  ds_read_b128 v[160:163], v8 offset:1024
  v_xor_b32 v9, 96, v7
  ds_read_b128 v[164:167], v9 offset:1024
  v_xor_b32 v10, 160, v7
  ds_read_b128 v[168:171], v10 offset:1024
  v_xor_b32 v11, 224, v7
  ds_read_b128 v[172:175], v11 offset:1024
  ds_read_b128 v[176:179], v8 offset:1280
  ds_read_b128 v[180:183], v9 offset:1280
  ds_read_b128 v[184:187], v10 offset:1280
  ds_read_b128 v[188:191], v11 offset:1280
  s_waitcnt lgkmcnt(4)
  s_cmp_eq_u32 s16, 3
  s_cbranch_scc1 aj_np2
  s_add_u32 m0, s50, 16384
  s_nop 0
  buffer_load_dwordx4 v24, s[60:63], s33 offen offset:0 lds
  buffer_load_dwordx4 v25, s[60:63], s33 offen offset:1024 lds
  buffer_load_dwordx4 v26, s[60:63], s33 offen offset:2048 lds
  buffer_load_dwordx4 v27, s[60:63], s33 offen offset:3072 lds
aj_np2:
  v_xor_b32 v8, 128, v7
  ds_read_b128 v[192:195], v8 offset:4096
  v_xor_b32 v9, 192, v7
  ds_read_b128 v[196:199], v9 offset:4096
  v_xor_b32 v10, 0, v7
  ds_read_b128 v[200:203], v10 offset:4096
  v_xor_b32 v11, 64, v7
  ds_read_b128 v[204:207], v11 offset:4096
  ds_read_b128 v[208:211], v8 offset:4352
  ds_read_b128 v[212:215], v9 offset:4352
  ds_read_b128 v[216:219], v10 offset:4352
  ds_read_b128 v[220:223], v11 offset:4352
  s_waitcnt lgkmcnt(4)
  s_cmp_eq_u32 s16, 3
  s_cbranch_scc1 aj_np3
  s_add_u32 m0, s51, 16384
  s_nop 0
  buffer_load_dwordx4 v28, s[60:63], s33 offen offset:0 lds
  buffer_load_dwordx4 v29, s[60:63], s33 offen offset:1024 lds
  buffer_load_dwordx4 v30, s[60:63], s33 offen offset:2048 lds
  buffer_load_dwordx4 v31, s[60:63], s33 offen offset:3072 lds
aj_np3:
  v_xor_b32 v8, 160, v7
  ds_read_b128 v[224:227], v8 offset:5120
  v_xor_b32 v9, 224, v7
  ds_read_b128 v[228:231], v9 offset:5120
  v_xor_b32 v10, 32, v7
  ds_read_b128 v[232:235], v10 offset:5120
  v_xor_b32 v11, 96, v7
  ds_read_b128 v[236:239], v11 offset:5120
  ds_read_b128 v[240:243], v8 offset:5376
  ds_read_b128 v[244:247], v9 offset:5376
  ds_read_b128 v[248:251], v10 offset:5376
  ds_read_b128 v[252:255], v11 offset:5376
  s_waitcnt lgkmcnt(4)
  s_waitcnt vmcnt(16) lgkmcnt(0)
  s_cmp_lg_u32 s16, 3
  s_cbranch_scc1 w3_39
  s_waitcnt vmcnt(0)
w3_39:
  ds_read_b128 v[52:55], v32 offset:0
  ds_read_b128 v[56:59], v33 offset:0
  ds_read_b128 v[60:63], v34 offset:0
  ds_read_b128 v[64:67], v35 offset:0
  s_waitcnt lgkmcnt(3)
  v_mfma_f32_16x16x32_bf16 v[96:99], v[52:55], v[128:131], 0
  v_mfma_f32_16x16x32_bf16 v[100:103], v[52:55], v[160:163], 0
  v_mfma_f32_16x16x32_bf16 v[104:107], v[52:55], v[192:195], 0
  v_mfma_f32_16x16x32_bf16 v[108:111], v[52:55], v[224:227], 0
  ds_read_b128 v[52:55], v32 offset:256
  s_waitcnt lgkmcnt(3)
  v_mfma_f32_16x16x32_bf16 v[96:99], v[56:59], v[132:135], v[96:99]
  v_mfma_f32_16x16x32_bf16 v[100:103], v[56:59], v[164:167], v[100:103]
  v_mfma_f32_16x16x32_bf16 v[104:107], v[56:59], v[196:199], v[104:107]
  v_mfma_f32_16x16x32_bf16 v[108:111], v[56:59], v[228:231], v[108:111]
  ds_read_b128 v[56:59], v33 offset:256
  s_waitcnt lgkmcnt(3)
  v_mfma_f32_16x16x32_bf16 v[96:99], v[60:63], v[136:139], v[96:99]
  v_mfma_f32_16x16x32_bf16 v[100:103], v[60:63], v[168:171], v[100:103]
  v_mfma_f32_16x16x32_bf16 v[104:107], v[60:63], v[200:203], v[104:107]
  v_mfma_f32_16x16x32_bf16 v[108:111], v[60:63], v[232:235], v[108:111]
  ds_read_b128 v[60:63], v34 offset:256
  s_waitcnt lgkmcnt(3)
  v_mfma_f32_16x16x32_bf16 v[96:99], v[64:67], v[140:143], v[96:99]
  v_mfma_f32_16x16x32_bf16 v[100:103], v[64:67], v[172:175], v[100:103]
  v_mfma_f32_16x16x32_bf16 v[104:107], v[64:67], v[204:207], v[104:107]
  v_mfma_f32_16x16x32_bf16 v[108:111], v[64:67], v[236:239], v[108:111]
  ds_read_b128 v[64:67], v35 offset:256
  s_waitcnt lgkmcnt(3)
  v_mfma_f32_16x16x32_bf16 v[96:99], v[52:55], v[144:147], v[96:99]
  v_mfma_f32_16x16x32_bf16 v[100:103], v[52:55], v[176:179], v[100:103]
  v_mfma_f32_16x16x32_bf16 v[104:107], v[52:55], v[208:211], v[104:107]
  v_mfma_f32_16x16x32_bf16 v[108:111], v[52:55], v[240:243], v[108:111]
  ds_read_b128 v[52:55], v32 offset:2048
  s_waitcnt lgkmcnt(3)
  v_mfma_f32_16x16x32_bf16 v[96:99], v[56:59], v[148:151], v[96:99]
  v_mfma_f32_16x16x32_bf16 v[100:103], v[56:59], v[180:183], v[100:103]
  v_mfma_f32_16x16x32_bf16 v[104:107], v[56:59], v[212:215], v[104:107]
  v_mfma_f32_16x16x32_bf16 v[108:111], v[56:59], v[244:247], v[108:111]
  ds_read_b128 v[56:59], v33 offset:2048
  s_waitcnt lgkmcnt(3)
  v_mfma_f32_16x16x32_bf16 v[96:99], v[60:63], v[152:155], v[96:99]
  v_mfma_f32_16x16x32_bf16 v[100:103], v[60:63], v[184:187], v[100:103]
  v_mfma_f32_16x16x32_bf16 v[104:107], v[60:63], v[216:219], v[104:107]
  v_mfma_f32_16x16x32_bf16 v[108:111], v[60:63], v[248:251], v[108:111]
  ds_read_b128 v[60:63], v34 offset:2048
  s_waitcnt lgkmcnt(3)
  v_mfma_f32_16x16x32_bf16 v[96:99], v[64:67], v[156:159], v[96:99]
  v_mfma_f32_16x16x32_bf16 v[100:103], v[64:67], v[188:191], v[100:103]
  v_mfma_f32_16x16x32_bf16 v[104:107], v[64:67], v[220:223], v[104:107]
  v_mfma_f32_16x16x32_bf16 v[108:111], v[64:67], v[252:255], v[108:111]
  ds_read_b128 v[64:67], v35 offset:2048
  s_waitcnt lgkmcnt(3)
  v_mfma_f32_16x16x32_bf16 v[112:115], v[52:55], v[128:131], 0
  v_mfma_f32_16x16x32_bf16 v[116:119], v[52:55], v[160:163], 0
  v_mfma_f32_16x16x32_bf16 v[120:123], v[52:55], v[192:195], 0
  v_mfma_f32_16x16x32_bf16 v[124:127], v[52:55], v[224:227], 0
  ds_read_b128 v[52:55], v32 offset:2304
  s_waitcnt lgkmcnt(3)
  v_mfma_f32_16x16x32_bf16 v[112:115], v[56:59], v[132:135], v[112:115]
  v_mfma_f32_16x16x32_bf16 v[116:119], v[56:59], v[164:167], v[116:119]
  v_mfma_f32_16x16x32_bf16 v[120:123], v[56:59], v[196:199], v[120:123]
  v_mfma_f32_16x16x32_bf16 v[124:127], v[56:59], v[228:231], v[124:127]
  ds_read_b128 v[56:59], v33 offset:2304
  s_waitcnt lgkmcnt(3)
  v_mfma_f32_16x16x32_bf16 v[112:115], v[60:63], v[136:139], v[112:115]
  v_mfma_f32_16x16x32_bf16 v[116:119], v[60:63], v[168:171], v[116:119]
  v_mfma_f32_16x16x32_bf16 v[120:123], v[60:63], v[200:203], v[120:123]
  v_mfma_f32_16x16x32_bf16 v[124:127], v[60:63], v[232:235], v[124:127]
  ds_read_b128 v[60:63], v34 offset:2304
  s_waitcnt lgkmcnt(3)
  v_mfma_f32_16x16x32_bf16 v[112:115], v[64:67], v[140:143], v[112:115]
  v_mfma_f32_16x16x32_bf16 v[116:119], v[64:67], v[172:175], v[116:119]
  v_mfma_f32_16x16x32_bf16 v[120:123], v[64:67], v[204:207], v[120:123]
  v_mfma_f32_16x16x32_bf16 v[124:127], v[64:67], v[236:239], v[124:127]
  ds_read_b128 v[64:67], v35 offset:2304
  s_waitcnt lgkmcnt(3)
  v_mfma_f32_16x16x32_bf16 v[112:115], v[52:55], v[144:147], v[112:115]
  v_mfma_f32_16x16x32_bf16 v[116:119], v[52:55], v[176:179], v[116:119]
  v_mfma_f32_16x16x32_bf16 v[120:123], v[52:55], v[208:211], v[120:123]
  v_mfma_f32_16x16x32_bf16 v[124:127], v[52:55], v[240:243], v[124:127]
  s_waitcnt lgkmcnt(2)
  v_mfma_f32_16x16x32_bf16 v[112:115], v[56:59], v[148:151], v[112:115]
  v_mfma_f32_16x16x32_bf16 v[116:119], v[56:59], v[180:183], v[116:119]
  v_mfma_f32_16x16x32_bf16 v[120:123], v[56:59], v[212:215], v[120:123]
  v_mfma_f32_16x16x32_bf16 v[124:127], v[56:59], v[244:247], v[124:127]
  s_waitcnt lgkmcnt(1)
  v_mfma_f32_16x16x32_bf16 v[112:115], v[60:63], v[152:155], v[112:115]
  v_mfma_f32_16x16x32_bf16 v[116:119], v[60:63], v[184:187], v[116:119]
  v_mfma_f32_16x16x32_bf16 v[120:123], v[60:63], v[216:219], v[120:123]
  v_mfma_f32_16x16x32_bf16 v[124:127], v[60:63], v[248:251], v[124:127]
  s_waitcnt lgkmcnt(0)
  v_mfma_f32_16x16x32_bf16 v[112:115], v[64:67], v[156:159], v[112:115]
  v_mfma_f32_16x16x32_bf16 v[116:119], v[64:67], v[188:191], v[116:119]
  v_mfma_f32_16x16x32_bf16 v[120:123], v[64:67], v[220:223], v[120:123]
  v_mfma_f32_16x16x32_bf16 v[124:127], v[64:67], v[252:255], v[124:127]
  s_lshl_b32 s30, s28, 10
  v_mul_f32 v96, s24, v96
  v_mul_f32 v97, s24, v97
  v_mul_f32 v98, s24, v98
  v_mul_f32 v99, s24, v99
  v_cvt_pk_bf16_f32 v68, v96, v97
  v_cvt_pk_bf16_f32 v69, v98, v99
  v_mul_f32 v112, s24, v112
  v_mul_f32 v113, s24, v113
  v_mul_f32 v114, s24, v114
  v_mul_f32 v115, s24, v115
  v_cvt_pk_bf16_f32 v70, v112, v113
  v_cvt_pk_bf16_f32 v71, v114, v115
  buffer_store_dwordx4 v[68:71], v12, s[8:11], s30 offen sc1
  v_mul_f32 v100, s24, v100
  v_mul_f32 v101, s24, v101
  v_mul_f32 v102, s24, v102
  v_mul_f32 v103, s24, v103
  v_cvt_pk_bf16_f32 v72, v100, v101
  v_cvt_pk_bf16_f32 v73, v102, v103
  v_mul_f32 v116, s24, v116
  v_mul_f32 v117, s24, v117
  v_mul_f32 v118, s24, v118
  v_mul_f32 v119, s24, v119
  v_cvt_pk_bf16_f32 v74, v116, v117
  v_cvt_pk_bf16_f32 v75, v118, v119
  buffer_store_dwordx4 v[72:75], v13, s[8:11], s30 offen sc1
  v_mul_f32 v104, s24, v104
  v_mul_f32 v105, s24, v105
  v_mul_f32 v106, s24, v106
  v_mul_f32 v107, s24, v107
  v_cvt_pk_bf16_f32 v76, v104, v105
  v_cvt_pk_bf16_f32 v77, v106, v107
  v_mul_f32 v120, s24, v120
  v_mul_f32 v121, s24, v121
  v_mul_f32 v122, s24, v122
  v_mul_f32 v123, s24, v123
  v_cvt_pk_bf16_f32 v78, v120, v121
  v_cvt_pk_bf16_f32 v79, v122, v123
  buffer_store_dwordx4 v[76:79], v14, s[8:11], s30 offen sc1
  v_mul_f32 v108, s24, v108
  v_mul_f32 v109, s24, v109
  v_mul_f32 v110, s24, v110
  v_mul_f32 v111, s24, v111
  v_cvt_pk_bf16_f32 v80, v108, v109
  v_cvt_pk_bf16_f32 v81, v110, v111
  v_mul_f32 v124, s24, v124
  v_mul_f32 v125, s24, v125
  v_mul_f32 v126, s24, v126
  v_mul_f32 v127, s24, v127
  v_cvt_pk_bf16_f32 v82, v124, v125
  v_cvt_pk_bf16_f32 v83, v126, v127
  buffer_store_dwordx4 v[80:83], v15, s[8:11], s30 offen sc1
  s_cmp_eq_u32 s16, 3
  s_cbranch_scc1 aj_w3
  s_waitcnt vmcnt(4)
  ds_read_b128 v[52:55], v32 offset:16384
  ds_read_b128 v[56:59], v33 offset:16384
  ds_read_b128 v[60:63], v34 offset:16384
  ds_read_b128 v[64:67], v35 offset:16384
  s_waitcnt lgkmcnt(3)
  v_mfma_f32_16x16x32_bf16 v[96:99], v[52:55], v[128:131], 0
  v_mfma_f32_16x16x32_bf16 v[100:103], v[52:55], v[160:163], 0
  v_mfma_f32_16x16x32_bf16 v[104:107], v[52:55], v[192:195], 0
  v_mfma_f32_16x16x32_bf16 v[108:111], v[52:55], v[224:227], 0
  ds_read_b128 v[52:55], v32 offset:16640
  s_waitcnt lgkmcnt(3)
  v_mfma_f32_16x16x32_bf16 v[96:99], v[56:59], v[132:135], v[96:99]
  v_mfma_f32_16x16x32_bf16 v[100:103], v[56:59], v[164:167], v[100:103]
  v_mfma_f32_16x16x32_bf16 v[104:107], v[56:59], v[196:199], v[104:107]
  v_mfma_f32_16x16x32_bf16 v[108:111], v[56:59], v[228:231], v[108:111]
  ds_read_b128 v[56:59], v33 offset:16640
  s_waitcnt lgkmcnt(3)
  v_mfma_f32_16x16x32_bf16 v[96:99], v[60:63], v[136:139], v[96:99]
  v_mfma_f32_16x16x32_bf16 v[100:103], v[60:63], v[168:171], v[100:103]
  v_mfma_f32_16x16x32_bf16 v[104:107], v[60:63], v[200:203], v[104:107]
  v_mfma_f32_16x16x32_bf16 v[108:111], v[60:63], v[232:235], v[108:111]
  ds_read_b128 v[60:63], v34 offset:16640
  s_waitcnt lgkmcnt(3)
  v_mfma_f32_16x16x32_bf16 v[96:99], v[64:67], v[140:143], v[96:99]
  v_mfma_f32_16x16x32_bf16 v[100:103], v[64:67], v[172:175], v[100:103]
  v_mfma_f32_16x16x32_bf16 v[104:107], v[64:67], v[204:207], v[104:107]
  v_mfma_f32_16x16x32_bf16 v[108:111], v[64:67], v[236:239], v[108:111]
  ds_read_b128 v[64:67], v35 offset:16640
  s_waitcnt lgkmcnt(3)
  v_mfma_f32_16x16x32_bf16 v[96:99], v[52:55], v[144:147], v[96:99]
  v_mfma_f32_16x16x32_bf16 v[100:103], v[52:55], v[176:179], v[100:103]
  v_mfma_f32_16x16x32_bf16 v[104:107], v[52:55], v[208:211], v[104:107]
  v_mfma_f32_16x16x32_bf16 v[108:111], v[52:55], v[240:243], v[108:111]
  ds_read_b128 v[52:55], v32 offset:18432
  s_waitcnt lgkmcnt(3)
  v_mfma_f32_16x16x32_bf16 v[96:99], v[56:59], v[148:151], v[96:99]
  v_mfma_f32_16x16x32_bf16 v[100:103], v[56:59], v[180:183], v[100:103]
  v_mfma_f32_16x16x32_bf16 v[104:107], v[56:59], v[212:215], v[104:107]
  v_mfma_f32_16x16x32_bf16 v[108:111], v[56:59], v[244:247], v[108:111]
  ds_read_b128 v[56:59], v33 offset:18432
  s_waitcnt lgkmcnt(3)
  v_mfma_f32_16x16x32_bf16 v[96:99], v[60:63], v[152:155], v[96:99]
  v_mfma_f32_16x16x32_bf16 v[100:103], v[60:63], v[184:187], v[100:103]
  v_mfma_f32_16x16x32_bf16 v[104:107], v[60:63], v[216:219], v[104:107]
  v_mfma_f32_16x16x32_bf16 v[108:111], v[60:63], v[248:251], v[108:111]
  ds_read_b128 v[60:63], v34 offset:18432
  s_waitcnt lgkmcnt(3)
  v_mfma_f32_16x16x32_bf16 v[96:99], v[64:67], v[156:159], v[96:99]
  v_mfma_f32_16x16x32_bf16 v[100:103], v[64:67], v[188:191], v[100:103]
  v_mfma_f32_16x16x32_bf16 v[104:107], v[64:67], v[220:223], v[104:107]
  v_mfma_f32_16x16x32_bf16 v[108:111], v[64:67], v[252:255], v[108:111]
  ds_read_b128 v[64:67], v35 offset:18432
  s_waitcnt lgkmcnt(3)
  v_mfma_f32_16x16x32_bf16 v[112:115], v[52:55], v[128:131], 0
  v_mfma_f32_16x16x32_bf16 v[116:119], v[52:55], v[160:163], 0
  v_mfma_f32_16x16x32_bf16 v[120:123], v[52:55], v[192:195], 0
  v_mfma_f32_16x16x32_bf16 v[124:127], v[52:55], v[224:227], 0
  ds_read_b128 v[52:55], v32 offset:18688
  s_waitcnt lgkmcnt(3)
  v_mfma_f32_16x16x32_bf16 v[112:115], v[56:59], v[132:135], v[112:115]
  v_mfma_f32_16x16x32_bf16 v[116:119], v[56:59], v[164:167], v[116:119]
  v_mfma_f32_16x16x32_bf16 v[120:123], v[56:59], v[196:199], v[120:123]
  v_mfma_f32_16x16x32_bf16 v[124:127], v[56:59], v[228:231], v[124:127]
  ds_read_b128 v[56:59], v33 offset:18688
  s_waitcnt lgkmcnt(3)
  v_mfma_f32_16x16x32_bf16 v[112:115], v[60:63], v[136:139], v[112:115]
  v_mfma_f32_16x16x32_bf16 v[116:119], v[60:63], v[168:171], v[116:119]
  v_mfma_f32_16x16x32_bf16 v[120:123], v[60:63], v[200:203], v[120:123]
  v_mfma_f32_16x16x32_bf16 v[124:127], v[60:63], v[232:235], v[124:127]
  ds_read_b128 v[60:63], v34 offset:18688
  s_waitcnt lgkmcnt(3)
  v_mfma_f32_16x16x32_bf16 v[112:115], v[64:67], v[140:143], v[112:115]
  v_mfma_f32_16x16x32_bf16 v[116:119], v[64:67], v[172:175], v[116:119]
  v_mfma_f32_16x16x32_bf16 v[120:123], v[64:67], v[204:207], v[120:123]
  v_mfma_f32_16x16x32_bf16 v[124:127], v[64:67], v[236:239], v[124:127]
  ds_read_b128 v[64:67], v35 offset:18688
  s_waitcnt lgkmcnt(3)
  v_mfma_f32_16x16x32_bf16 v[112:115], v[52:55], v[144:147], v[112:115]
  v_mfma_f32_16x16x32_bf16 v[116:119], v[52:55], v[176:179], v[116:119]
  v_mfma_f32_16x16x32_bf16 v[120:123], v[52:55], v[208:211], v[120:123]
  v_mfma_f32_16x16x32_bf16 v[124:127], v[52:55], v[240:243], v[124:127]
  s_waitcnt lgkmcnt(2)
  v_mfma_f32_16x16x32_bf16 v[112:115], v[56:59], v[148:151], v[112:115]
  v_mfma_f32_16x16x32_bf16 v[116:119], v[56:59], v[180:183], v[116:119]
  v_mfma_f32_16x16x32_bf16 v[120:123], v[56:59], v[212:215], v[120:123]
  v_mfma_f32_16x16x32_bf16 v[124:127], v[56:59], v[244:247], v[124:127]
  s_waitcnt lgkmcnt(1)
  v_mfma_f32_16x16x32_bf16 v[112:115], v[60:63], v[152:155], v[112:115]
  v_mfma_f32_16x16x32_bf16 v[116:119], v[60:63], v[184:187], v[116:119]
  v_mfma_f32_16x16x32_bf16 v[120:123], v[60:63], v[216:219], v[120:123]
  v_mfma_f32_16x16x32_bf16 v[124:127], v[60:63], v[248:251], v[124:127]
  s_waitcnt lgkmcnt(0)
  v_mfma_f32_16x16x32_bf16 v[112:115], v[64:67], v[156:159], v[112:115]
  v_mfma_f32_16x16x32_bf16 v[116:119], v[64:67], v[188:191], v[116:119]
  v_mfma_f32_16x16x32_bf16 v[120:123], v[64:67], v[220:223], v[120:123]
  v_mfma_f32_16x16x32_bf16 v[124:127], v[64:67], v[252:255], v[124:127]
  s_lshl_b32 s30, s29, 10
  v_mul_f32 v96, s24, v96
  v_mul_f32 v97, s24, v97
  v_mul_f32 v98, s24, v98
  v_mul_f32 v99, s24, v99
  v_cvt_pk_bf16_f32 v68, v96, v97
  v_cvt_pk_bf16_f32 v69, v98, v99
  v_mul_f32 v112, s24, v112
  v_mul_f32 v113, s24, v113
  v_mul_f32 v114, s24, v114
  v_mul_f32 v115, s24, v115
  v_cvt_pk_bf16_f32 v70, v112, v113
  v_cvt_pk_bf16_f32 v71, v114, v115
  buffer_store_dwordx4 v[68:71], v12, s[8:11], s30 offen sc1
  v_mul_f32 v100, s24, v100
  v_mul_f32 v101, s24, v101
  v_mul_f32 v102, s24, v102
  v_mul_f32 v103, s24, v103
  v_cvt_pk_bf16_f32 v72, v100, v101
  v_cvt_pk_bf16_f32 v73, v102, v103
  v_mul_f32 v116, s24, v116
  v_mul_f32 v117, s24, v117
  v_mul_f32 v118, s24, v118
  v_mul_f32 v119, s24, v119
  v_cvt_pk_bf16_f32 v74, v116, v117
  v_cvt_pk_bf16_f32 v75, v118, v119
  buffer_store_dwordx4 v[72:75], v13, s[8:11], s30 offen sc1
  v_mul_f32 v104, s24, v104
  v_mul_f32 v105, s24, v105
  v_mul_f32 v106, s24, v106
  v_mul_f32 v107, s24, v107
  v_cvt_pk_bf16_f32 v76, v104, v105
  v_cvt_pk_bf16_f32 v77, v106, v107
  v_mul_f32 v120, s24, v120
  v_mul_f32 v121, s24, v121
  v_mul_f32 v122, s24, v122
  v_mul_f32 v123, s24, v123
  v_cvt_pk_bf16_f32 v78, v120, v121
  v_cvt_pk_bf16_f32 v79, v122, v123
  buffer_store_dwordx4 v[76:79], v14, s[8:11], s30 offen sc1
  v_mul_f32 v108, s24, v108
  v_mul_f32 v109, s24, v109
  v_mul_f32 v110, s24, v110
  v_mul_f32 v111, s24, v111
  v_cvt_pk_bf16_f32 v80, v108, v109
  v_cvt_pk_bf16_f32 v81, v110, v111
  v_mul_f32 v124, s24, v124
  v_mul_f32 v125, s24, v125
  v_mul_f32 v126, s24, v126
  v_mul_f32 v127, s24, v127
  v_cvt_pk_bf16_f32 v82, v124, v125
  v_cvt_pk_bf16_f32 v83, v126, v127
  buffer_store_dwordx4 v[80:83], v15, s[8:11], s30 offen sc1
aj_w3:
  s_lshl_b32 s28, s17, 7
  s_lshl_b32 s21, s19, 4
  s_add_u32 s28, s28, s21
  s_cmp_lg_u32 s31, 0
  s_cselect_b32 s21, 8, 0
  s_add_u32 s28, s28, s21
  s_add_u32 s28, s28, 88633344
  s_waitcnt vmcnt(0)
  s_barrier
  s_cmp_lg_u32 s16, 0
  s_cbranch_scc1 pub_40
  v_mul_u32_u24 v26, 2048, v1
  v_mov_b32 v24, s88
  v_mov_b32 v25, s89
  s_mov_b64 exec, 1
  buffer_store_dwordx2 v[24:25], v26, s[8:11], s28 offen sc1
  s_mov_b64 exec, -1
pub_40:
  v_mov_b32 v250, 0
  s_branch wk_loop
wk_srv:
  s_sub_u32 s3, s3, 224
  s_and_b32 s18, s3, 15
  s_lshr_b32 s19, s3, 4
  s_and_b32 s19, s19, 1
  s_mul_i32 s20, s18, 401408
  s_mul_i32 s21, s16, 100352
  s_add_u32 s20, s20, s21
  s_add_u32 s20, s20, 6422528
  s_add_u32 s22, s20, 0
  buffer_load_dwordx4 a[0:3], v2, s[8:11], s22 offen offset:0 sc1
  buffer_load_dwordx4 a[4:7], v2, s[8:11], s22 offen offset:1024 sc1
  buffer_load_dwordx4 a[8:11], v2, s[8:11], s22 offen offset:2048 sc1
  buffer_load_dwordx4 a[12:15], v2, s[8:11], s22 offen offset:3072 sc1
  s_add_u32 s22, s20, 4096
  buffer_load_dwordx4 a[16:19], v2, s[8:11], s22 offen offset:0 sc1
  buffer_load_dwordx4 a[20:23], v2, s[8:11], s22 offen offset:1024 sc1
  buffer_load_dwordx4 a[24:27], v2, s[8:11], s22 offen offset:2048 sc1
  buffer_load_dwordx4 a[28:31], v2, s[8:11], s22 offen offset:3072 sc1
  s_add_u32 s22, s20, 8192
  buffer_load_dwordx4 a[32:35], v2, s[8:11], s22 offen offset:0 sc1
  buffer_load_dwordx4 a[36:39], v2, s[8:11], s22 offen offset:1024 sc1
  buffer_load_dwordx4 a[40:43], v2, s[8:11], s22 offen offset:2048 sc1
  buffer_load_dwordx4 a[44:47], v2, s[8:11], s22 offen offset:3072 sc1
  s_add_u32 s22, s20, 12288
  buffer_load_dwordx4 a[48:51], v2, s[8:11], s22 offen offset:0 sc1
  buffer_load_dwordx4 a[52:55], v2, s[8:11], s22 offen offset:1024 sc1
  buffer_load_dwordx4 a[56:59], v2, s[8:11], s22 offen offset:2048 sc1
  buffer_load_dwordx4 a[60:63], v2, s[8:11], s22 offen offset:3072 sc1
  s_add_u32 s22, s20, 16384
  buffer_load_dwordx4 a[64:67], v2, s[8:11], s22 offen offset:0 sc1
  buffer_load_dwordx4 a[68:71], v2, s[8:11], s22 offen offset:1024 sc1
  buffer_load_dwordx4 a[72:75], v2, s[8:11], s22 offen offset:2048 sc1
  buffer_load_dwordx4 a[76:79], v2, s[8:11], s22 offen offset:3072 sc1
  s_add_u32 s22, s20, 20480
  buffer_load_dwordx4 a[80:83], v2, s[8:11], s22 offen offset:0 sc1
  buffer_load_dwordx4 a[84:87], v2, s[8:11], s22 offen offset:1024 sc1
  buffer_load_dwordx4 a[88:91], v2, s[8:11], s22 offen offset:2048 sc1
  buffer_load_dwordx4 a[92:95], v2, s[8:11], s22 offen offset:3072 sc1
  s_add_u32 s22, s20, 24576
  buffer_load_dwordx4 a[96:99], v2, s[8:11], s22 offen offset:0 sc1
  buffer_load_dwordx4 a[100:103], v2, s[8:11], s22 offen offset:1024 sc1
  buffer_load_dwordx4 a[104:107], v2, s[8:11], s22 offen offset:2048 sc1
  buffer_load_dwordx4 a[108:111], v2, s[8:11], s22 offen offset:3072 sc1
  s_add_u32 s22, s20, 28672
  buffer_load_dwordx4 a[112:115], v2, s[8:11], s22 offen offset:0 sc1
  buffer_load_dwordx4 a[116:119], v2, s[8:11], s22 offen offset:1024 sc1
  buffer_load_dwordx4 a[120:123], v2, s[8:11], s22 offen offset:2048 sc1
  buffer_load_dwordx4 a[124:127], v2, s[8:11], s22 offen offset:3072 sc1
  s_waitcnt vmcnt(24)
  s_add_u32 s22, s20, 32768
  buffer_load_dwordx4 a[128:131], v2, s[8:11], s22 offen offset:0 sc1
  buffer_load_dwordx4 a[132:135], v2, s[8:11], s22 offen offset:1024 sc1
  buffer_load_dwordx4 a[136:139], v2, s[8:11], s22 offen offset:2048 sc1
  buffer_load_dwordx4 a[140:143], v2, s[8:11], s22 offen offset:3072 sc1
  s_add_u32 s22, s20, 36864
  buffer_load_dwordx4 a[144:147], v2, s[8:11], s22 offen offset:0 sc1
  buffer_load_dwordx4 a[148:151], v2, s[8:11], s22 offen offset:1024 sc1
  buffer_load_dwordx4 a[152:155], v2, s[8:11], s22 offen offset:2048 sc1
  buffer_load_dwordx4 a[156:159], v2, s[8:11], s22 offen offset:3072 sc1
  s_add_u32 s22, s20, 40960
  buffer_load_dwordx4 a[160:163], v2, s[8:11], s22 offen offset:0 sc1
  buffer_load_dwordx4 a[164:167], v2, s[8:11], s22 offen offset:1024 sc1
  buffer_load_dwordx4 a[168:171], v2, s[8:11], s22 offen offset:2048 sc1
  buffer_load_dwordx4 a[172:175], v2, s[8:11], s22 offen offset:3072 sc1
  s_add_u32 s22, s20, 45056
  buffer_load_dwordx4 a[176:179], v2, s[8:11], s22 offen offset:0 sc1
  buffer_load_dwordx4 a[180:183], v2, s[8:11], s22 offen offset:1024 sc1
  buffer_load_dwordx4 a[184:187], v2, s[8:11], s22 offen offset:2048 sc1
  buffer_load_dwordx4 a[188:191], v2, s[8:11], s22 offen offset:3072 sc1
  s_add_u32 s22, s20, 49152
  buffer_load_dwordx4 a[192:195], v2, s[8:11], s22 offen offset:0 sc1
  buffer_load_dwordx4 a[196:199], v2, s[8:11], s22 offen offset:1024 sc1
  buffer_load_dwordx4 a[200:203], v2, s[8:11], s22 offen offset:2048 sc1
  buffer_load_dwordx4 a[204:207], v2, s[8:11], s22 offen offset:3072 sc1
  s_add_u32 s22, s20, 53248
  buffer_load_dwordx4 a[208:211], v2, s[8:11], s22 offen offset:0 sc1
  buffer_load_dwordx4 a[212:215], v2, s[8:11], s22 offen offset:1024 sc1
  buffer_load_dwordx4 a[216:219], v2, s[8:11], s22 offen offset:2048 sc1
  buffer_load_dwordx4 a[220:223], v2, s[8:11], s22 offen offset:3072 sc1
  s_add_u32 s22, s20, 57344
  buffer_load_dwordx4 a[224:227], v2, s[8:11], s22 offen offset:0 sc1
  buffer_load_dwordx4 a[228:231], v2, s[8:11], s22 offen offset:1024 sc1
  buffer_load_dwordx4 a[232:235], v2, s[8:11], s22 offen offset:2048 sc1
  buffer_load_dwordx4 a[236:239], v2, s[8:11], s22 offen offset:3072 sc1
  s_add_u32 s22, s20, 61440
  buffer_load_dwordx4 a[240:243], v2, s[8:11], s22 offen offset:0 sc1
  buffer_load_dwordx4 a[244:247], v2, s[8:11], s22 offen offset:1024 sc1
  buffer_load_dwordx4 a[248:251], v2, s[8:11], s22 offen offset:2048 sc1
  buffer_load_dwordx4 a[252:255], v2, s[8:11], s22 offen offset:3072 sc1
  s_waitcnt vmcnt(24)
  s_add_u32 s22, s20, 65536
  buffer_load_dwordx4 v[120:123], v2, s[8:11], s22 offen offset:0 sc1
  buffer_load_dwordx4 v[124:127], v2, s[8:11], s22 offen offset:1024 sc1
  buffer_load_dwordx4 v[128:131], v2, s[8:11], s22 offen offset:2048 sc1
  buffer_load_dwordx4 v[132:135], v2, s[8:11], s22 offen offset:3072 sc1
  s_add_u32 s22, s20, 69632
  buffer_load_dwordx4 v[136:139], v2, s[8:11], s22 offen offset:0 sc1
  buffer_load_dwordx4 v[140:143], v2, s[8:11], s22 offen offset:1024 sc1
  buffer_load_dwordx4 v[144:147], v2, s[8:11], s22 offen offset:2048 sc1
  buffer_load_dwordx4 v[148:151], v2, s[8:11], s22 offen offset:3072 sc1
  s_add_u32 s22, s20, 73728
  buffer_load_dwordx4 v[152:155], v2, s[8:11], s22 offen offset:0 sc1
  buffer_load_dwordx4 v[156:159], v2, s[8:11], s22 offen offset:1024 sc1
  buffer_load_dwordx4 v[160:163], v2, s[8:11], s22 offen offset:2048 sc1
  buffer_load_dwordx4 v[164:167], v2, s[8:11], s22 offen offset:3072 sc1
  s_add_u32 s22, s20, 77824
  buffer_load_dwordx4 v[168:171], v2, s[8:11], s22 offen offset:0 sc1
  buffer_load_dwordx4 v[172:175], v2, s[8:11], s22 offen offset:1024 sc1
  buffer_load_dwordx4 v[176:179], v2, s[8:11], s22 offen offset:2048 sc1
  buffer_load_dwordx4 v[180:183], v2, s[8:11], s22 offen offset:3072 sc1
  s_add_u32 s22, s20, 81920
  buffer_load_dwordx4 v[184:187], v2, s[8:11], s22 offen offset:0 sc1
  buffer_load_dwordx4 v[188:191], v2, s[8:11], s22 offen offset:1024 sc1
  buffer_load_dwordx4 v[192:195], v2, s[8:11], s22 offen offset:2048 sc1
  buffer_load_dwordx4 v[196:199], v2, s[8:11], s22 offen offset:3072 sc1
  s_add_u32 s22, s20, 86016
  buffer_load_dwordx4 v[200:203], v2, s[8:11], s22 offen offset:0 sc1
  buffer_load_dwordx4 v[204:207], v2, s[8:11], s22 offen offset:1024 sc1
  buffer_load_dwordx4 v[208:211], v2, s[8:11], s22 offen offset:2048 sc1
  buffer_load_dwordx4 v[212:215], v2, s[8:11], s22 offen offset:3072 sc1
  s_add_u32 s22, s20, 90112
  buffer_load_dwordx4 v[216:219], v2, s[8:11], s22 offen offset:0 sc1
  buffer_load_dwordx4 v[220:223], v2, s[8:11], s22 offen offset:1024 sc1
  buffer_load_dwordx4 v[224:227], v2, s[8:11], s22 offen offset:2048 sc1
  buffer_load_dwordx4 v[228:231], v2, s[8:11], s22 offen offset:3072 sc1
  s_add_u32 s22, s20, 94208
  buffer_load_dwordx4 v[232:235], v2, s[8:11], s22 offen offset:0 sc1
  buffer_load_dwordx4 v[236:239], v2, s[8:11], s22 offen offset:1024 sc1
  buffer_load_dwordx4 v[240:243], v2, s[8:11], s22 offen offset:2048 sc1
  buffer_load_dwordx4 v[244:247], v2, s[8:11], s22 offen offset:3072 sc1
  s_waitcnt vmcnt(24)
  s_add_u32 s22, s20, 98304
  buffer_load_dwordx4 v[248:251], v2, s[8:11], s22 offen offset:0 sc1
  buffer_load_dwordx4 v[252:255], v2, s[8:11], s22 offen offset:1024 sc1
  v_mov_b32 v5, 0x4444
  v_mov_b32 v6, 0xeeee
  v_cmp_lt_u32 vcc, 7, v4
  s_nop 1
  v_cndmask_b32 v5, v5, v6, vcc
  s_lshl_b32 s23, s16, 11
  v_lshrrev_b32 v80, 1, v3
  v_and_b32 v81, 1, v3
  v_add_u32 v82, 0, v80
  v_lshl_add_u32 v82, v82, 4, v4
  v_mul_u32_u24 v83, 2341, v82
  v_lshrrev_b32 v83, 16, v83
  v_mul_u32_u24 v84, 28, v83
  v_sub_u32 v84, v82, v84
  v_lshrrev_b32 v85, 4, v84
  v_and_b32 v84, 15, v84
  v_lshlrev_b32 v86, 10, v85
  v_lshl_add_u32 v86, v83, 8, v86
  v_lshl_add_u32 v86, v84, 4, v86
  v_lshl_add_u32 v86, v81, 3, v86
  v_add_u32 v72, s23, v86
  v_add_u32 v82, 2, v80
  v_lshl_add_u32 v82, v82, 4, v4
  v_mul_u32_u24 v83, 2341, v82
  v_lshrrev_b32 v83, 16, v83
  v_mul_u32_u24 v84, 28, v83
  v_sub_u32 v84, v82, v84
  v_lshrrev_b32 v85, 4, v84
  v_and_b32 v84, 15, v84
  v_lshlrev_b32 v86, 10, v85
  v_lshl_add_u32 v86, v83, 8, v86
  v_lshl_add_u32 v86, v84, 4, v86
  v_lshl_add_u32 v86, v81, 3, v86
  v_add_u32 v73, s23, v86
  v_add_u32 v82, 4, v80
  v_lshl_add_u32 v82, v82, 4, v4
  v_mul_u32_u24 v83, 2341, v82
  v_lshrrev_b32 v83, 16, v83
  v_mul_u32_u24 v84, 28, v83
  v_sub_u32 v84, v82, v84
  v_lshrrev_b32 v85, 4, v84
  v_and_b32 v84, 15, v84
  v_lshlrev_b32 v86, 10, v85
  v_lshl_add_u32 v86, v83, 8, v86
  v_lshl_add_u32 v86, v84, 4, v86
  v_lshl_add_u32 v86, v81, 3, v86
  v_add_u32 v74, s23, v86
  v_mov_b32 v82, 6
  v_lshl_add_u32 v82, v82, 4, v4
  v_mul_u32_u24 v83, 2341, v82
  v_lshrrev_b32 v83, 16, v83
  v_mul_u32_u24 v84, 28, v83
  v_sub_u32 v84, v82, v84
  v_lshrrev_b32 v85, 4, v84
  v_and_b32 v84, 15, v84
  v_lshlrev_b32 v86, 10, v85
  v_lshl_add_u32 v86, v83, 8, v86
  v_lshl_add_u32 v86, v84, 4, v86
  v_lshl_add_u32 v86, v81, 3, v86
  v_add_u32 v75, s23, v86
  v_add_u32 v76, s23, v2
  s_mul_i32 s27, s18, 448
  v_mov_b32 v77, s27
  v_mov_b32 v78, 1
  s_mov_b32 s17, s19
  s_mul_i32 s24, s19, 7168
  s_add_u32 s24, s24, 88080384
  s_mul_i32 s25, s18, 65
  s_add_u32 s25, s25, s19
  s_lshl_b32 s25, s25, 13
  s_add_u32 s25, s25, s23
  s_add_u32 s25, s25, 76947456
  s_lshl_b32 s26, s18, 6
  s_add_u32 s26, s26, s19
  s_lshl_b32 s26, s26, 4
  s_lshl_b32 s27, s16, 2
  s_add_u32 s26, s26, s27
  s_add_u32 s26, s26, 88582144
  v_mov_b32 v87, -1
ws_loop:
  v_mov_b32 v36, 0
  v_mov_b32 v37, 0
  v_mov_b32 v38, 0
  v_mov_b32 v39, 0
  v_mov_b32 v40, 0
  v_mov_b32 v41, 0
  v_mov_b32 v42, 0
  v_mov_b32 v43, 0
  v_mov_b32 v44, 0
  v_mov_b32 v45, 0
  v_mov_b32 v46, 0
  v_mov_b32 v47, 0
  v_mov_b32 v48, 0
  v_mov_b32 v49, 0
  v_mov_b32 v50, 0
  v_mov_b32 v51, 0
  v_mov_b32 v52, 0
  v_mov_b32 v53, 0
  v_mov_b32 v54, 0
  v_mov_b32 v55, 0
  v_mov_b32 v56, 0
  v_mov_b32 v57, 0
  v_mov_b32 v58, 0
  v_mov_b32 v59, 0
  v_mov_b32 v60, 0
  v_mov_b32 v61, 0
  v_mov_b32 v62, 0
  v_mov_b32 v63, 0
  s_mov_b32 s30, 0
  v_cmp_eq_u32 vcc, -1, v87
  s_cbranch_vccz ws_fl
ws_pm:
  s_cmp_ge_u32 s17, 61
  s_cbranch_scc1 mp_41a
  v_mov_b32 v79, 0
  s_mov_b64 exec, 1
  buffer_atomic_or v79, v77, s[8:11], s24 offen sc0
  s_mov_b64 exec, -1
  s_branch mp_41b
mp_41a:
  buffer_load_dword v79, v77, s[8:11], s24 offen sc1
mp_41b:
  s_waitcnt vmcnt(0)
  v_cmp_eq_u32 vcc, -1, v79
  s_cbranch_vccnz ws_pr
ws_fl:
  s_add_u32 s22, s24, 4096
  buffer_load_dwordx4 v[8:11], v2, s[8:11], s24 offen offset:0 sc1
  buffer_load_dwordx4 v[12:15], v2, s[8:11], s24 offen offset:1024 sc1
  buffer_load_dwordx4 v[16:19], v2, s[8:11], s24 offen offset:2048 sc1
  buffer_load_dwordx4 v[20:23], v2, s[8:11], s24 offen offset:3072 sc1
  buffer_load_dwordx4 v[24:27], v2, s[8:11], s22 offen offset:0 sc1
  buffer_load_dwordx4 v[28:31], v2, s[8:11], s22 offen offset:1024 sc1
  buffer_load_dwordx4 v[32:35], v2, s[8:11], s22 offen offset:2048 sc1
  s_waitcnt vmcnt(0)
  v_max_u32 v79, v8, v9
  v_max3_u32 v79, v79, v10, v11
  v_max3_u32 v79, v79, v12, v13
  v_max3_u32 v79, v79, v14, v15
  v_max3_u32 v79, v79, v16, v17
  v_max3_u32 v79, v79, v18, v19
  v_max3_u32 v79, v79, v20, v21
  v_max3_u32 v79, v79, v22, v23
  v_max3_u32 v79, v79, v24, v25
  v_max3_u32 v79, v79, v26, v27
  v_max3_u32 v79, v79, v28, v29
  v_max3_u32 v79, v79, v30, v31
  v_max3_u32 v79, v79, v32, v33
  v_max3_u32 v79, v79, v34, v35
  v_cmp_eq_u32 vcc, -1, v79
  s_cbranch_vccz ws_pk
ws_pr:
  s_sleep 1
  s_cmp_ge_u32 s17, 61
  s_cbranch_scc1 ws_sh
  s_sleep 6
ws_sh:
  s_add_u32 s30, s30, 1
  s_cmp_lt_u32 s30, 30000
  s_cbranch_scc1 ws_pm
  s_branch cA_abort
ws_pk:
  s_cmp_ge_u32 s17, 62
  s_cbranch_scc1 ws_na
  s_add_u32 s22, s24, 14336
  s_cmp_ge_u32 s17, 61
  s_cbranch_scc1 mp_42a
  v_mov_b32 v87, 0
  s_mov_b64 exec, 1
  buffer_atomic_or v87, v77, s[8:11], s22 offen sc0
  s_mov_b64 exec, -1
  s_branch mp_42b
mp_42a:
  buffer_load_dword v87, v77, s[8:11], s22 offen sc1
mp_42b:
ws_na:
  v_smfmac_f32_16x16x64_bf16 v[36:39], v[8:11], a[0:7], v5
  v_smfmac_f32_16x16x64_bf16 v[36:39], v[12:15], a[8:15], v5
  v_smfmac_f32_16x16x64_bf16 v[36:39], v[16:19], a[16:23], v5
  v_smfmac_f32_16x16x64_bf16 v[36:39], v[20:23], a[24:31], v5
  v_smfmac_f32_16x16x64_bf16 v[36:39], v[24:27], a[32:39], v5
  v_smfmac_f32_16x16x64_bf16 v[36:39], v[28:31], a[40:47], v5
  v_smfmac_f32_16x16x64_bf16 v[36:39], v[32:35], a[48:55], v5
  v_smfmac_f32_16x16x64_bf16 v[40:43], v[8:11], a[56:63], v5
  v_smfmac_f32_16x16x64_bf16 v[40:43], v[12:15], a[64:71], v5
  v_smfmac_f32_16x16x64_bf16 v[40:43], v[16:19], a[72:79], v5
  v_smfmac_f32_16x16x64_bf16 v[40:43], v[20:23], a[80:87], v5
  v_smfmac_f32_16x16x64_bf16 v[40:43], v[24:27], a[88:95], v5
  v_smfmac_f32_16x16x64_bf16 v[40:43], v[28:31], a[96:103], v5
  v_smfmac_f32_16x16x64_bf16 v[40:43], v[32:35], a[104:111], v5
  v_smfmac_f32_16x16x64_bf16 v[44:47], v[8:11], a[112:119], v5
  v_smfmac_f32_16x16x64_bf16 v[44:47], v[12:15], a[120:127], v5
  v_smfmac_f32_16x16x64_bf16 v[44:47], v[16:19], a[128:135], v5
  v_smfmac_f32_16x16x64_bf16 v[44:47], v[20:23], a[136:143], v5
  v_smfmac_f32_16x16x64_bf16 v[44:47], v[24:27], a[144:151], v5
  v_smfmac_f32_16x16x64_bf16 v[44:47], v[28:31], a[152:159], v5
  v_smfmac_f32_16x16x64_bf16 v[44:47], v[32:35], a[160:167], v5
  v_smfmac_f32_16x16x64_bf16 v[48:51], v[8:11], a[168:175], v5
  v_smfmac_f32_16x16x64_bf16 v[48:51], v[12:15], a[176:183], v5
  v_smfmac_f32_16x16x64_bf16 v[48:51], v[16:19], a[184:191], v5
  v_smfmac_f32_16x16x64_bf16 v[48:51], v[20:23], a[192:199], v5
  v_smfmac_f32_16x16x64_bf16 v[48:51], v[24:27], a[200:207], v5
  v_smfmac_f32_16x16x64_bf16 v[48:51], v[28:31], a[208:215], v5
  v_smfmac_f32_16x16x64_bf16 v[48:51], v[32:35], a[216:223], v5
  v_smfmac_f32_16x16x64_bf16 v[52:55], v[8:11], a[224:231], v5
  v_smfmac_f32_16x16x64_bf16 v[52:55], v[12:15], a[232:239], v5
  v_smfmac_f32_16x16x64_bf16 v[52:55], v[16:19], a[240:247], v5
  v_smfmac_f32_16x16x64_bf16 v[52:55], v[20:23], a[248:255], v5
  v_smfmac_f32_16x16x64_bf16 v[52:55], v[24:27], v[120:127], v5
  v_smfmac_f32_16x16x64_bf16 v[52:55], v[28:31], v[128:135], v5
  v_smfmac_f32_16x16x64_bf16 v[52:55], v[32:35], v[136:143], v5
  v_smfmac_f32_16x16x64_bf16 v[56:59], v[8:11], v[144:151], v5
  v_smfmac_f32_16x16x64_bf16 v[56:59], v[12:15], v[152:159], v5
  v_smfmac_f32_16x16x64_bf16 v[56:59], v[16:19], v[160:167], v5
  v_smfmac_f32_16x16x64_bf16 v[56:59], v[20:23], v[168:175], v5
  v_smfmac_f32_16x16x64_bf16 v[56:59], v[24:27], v[176:183], v5
  v_smfmac_f32_16x16x64_bf16 v[56:59], v[28:31], v[184:191], v5
  v_smfmac_f32_16x16x64_bf16 v[56:59], v[32:35], v[192:199], v5
  v_smfmac_f32_16x16x64_bf16 v[60:63], v[8:11], v[200:207], v5
  v_smfmac_f32_16x16x64_bf16 v[60:63], v[12:15], v[208:215], v5
  v_smfmac_f32_16x16x64_bf16 v[60:63], v[16:19], v[216:223], v5
  v_smfmac_f32_16x16x64_bf16 v[60:63], v[20:23], v[224:231], v5
  v_smfmac_f32_16x16x64_bf16 v[60:63], v[24:27], v[232:239], v5
  v_smfmac_f32_16x16x64_bf16 v[60:63], v[28:31], v[240:247], v5
  v_smfmac_f32_16x16x64_bf16 v[60:63], v[32:35], v[248:255], v5
  v_permlane32_swap_b32 v36, v40
  v_permlane32_swap_b32 v37, v41
  v_permlane32_swap_b32 v38, v42
  v_permlane32_swap_b32 v39, v43
  v_add_f32 v36, v36, v40
  v_add_f32 v37, v37, v41
  v_add_f32 v38, v38, v42
  v_add_f32 v39, v39, v43
  v_cvt_pk_bf16_f32 v40, v36, v37
  v_cvt_pk_bf16_f32 v41, v38, v39
  ds_write_b64 v72, v[40:41]
  v_permlane32_swap_b32 v44, v48
  v_permlane32_swap_b32 v45, v49
  v_permlane32_swap_b32 v46, v50
  v_permlane32_swap_b32 v47, v51
  v_add_f32 v44, v44, v48
  v_add_f32 v45, v45, v49
  v_add_f32 v46, v46, v50
  v_add_f32 v47, v47, v51
  v_cvt_pk_bf16_f32 v48, v44, v45
  v_cvt_pk_bf16_f32 v49, v46, v47
  ds_write_b64 v73, v[48:49]
  v_permlane32_swap_b32 v52, v56
  v_permlane32_swap_b32 v53, v57
  v_permlane32_swap_b32 v54, v58
  v_permlane32_swap_b32 v55, v59
  v_add_f32 v52, v52, v56
  v_add_f32 v53, v53, v57
  v_add_f32 v54, v54, v58
  v_add_f32 v55, v55, v59
  v_cvt_pk_bf16_f32 v56, v52, v53
  v_cvt_pk_bf16_f32 v57, v54, v55
  ds_write_b64 v74, v[56:57]
  v_mov_b32 v64, v60
  v_mov_b32 v65, v61
  v_mov_b32 v66, v62
  v_mov_b32 v67, v63
  v_permlane32_swap_b32 v60, v64
  v_permlane32_swap_b32 v61, v65
  v_permlane32_swap_b32 v62, v66
  v_permlane32_swap_b32 v63, v67
  v_add_f32 v60, v60, v64
  v_add_f32 v61, v61, v65
  v_add_f32 v62, v62, v66
  v_add_f32 v63, v63, v67
  v_cvt_pk_bf16_f32 v64, v60, v61
  v_cvt_pk_bf16_f32 v65, v62, v63
  ds_write_b64 v75, v[64:65]
  s_waitcnt lgkmcnt(0)
  ds_read_b128 v[64:67], v76
  ds_read_b128 v[68:71], v76 offset:1024
  s_waitcnt lgkmcnt(0)
  buffer_store_dwordx4 v[64:67], v2, s[8:11], s25 offen sc1
  buffer_store_dwordx4 v[68:71], v2, s[8:11], s25 offen offset:1024 sc1
  s_waitcnt vmcnt(0)
  s_mov_b64 exec, 1
  buffer_store_dword v78, v2, s[8:11], s26 offen sc1
  s_mov_b64 exec, -1
  s_add_u32 s24, s24, 14336
  s_add_u32 s25, s25, 16384
  s_add_u32 s26, s26, 32
  s_add_u32 s17, s17, 2
  s_cmp_lt_u32 s17, 64
  s_cbranch_scc1 ws_loop
  v_mov_b32 v250, 0
  s_branch wk_loop
wk_s4d:
  s_cmp_lg_u32 s16, 0
  s_cbranch_scc1 w0_43
  s_getreg_b32 s20, hwreg(HW_REG_XCC_ID)
  s_sub_u32 s20, s20, 1
  s_and_b32 s20, s20, 7
  s_mov_b64 exec, 1
s4_l:
  s_cmp_ge_u32 s20, 7
  s_cselect_b32 s20, 0, s20
  s_lshl_b32 s21, s20, 7
  s_add_u32 s21, s21, 88598528
  v_mov_b32 v242, 1
  buffer_atomic_add v242, off, s[8:11], s21 sc0
  s_waitcnt vmcnt(0)
  v_readfirstlane_b32 s21, v242
  s_lshl_b32 s22, s20, 4
  s_add_u32 s20, s20, 1
  s_cmp_ge_u32 s21, 16
  s_cbranch_scc1 s4_l
  v_add_u32 v242, s22, v242
  s_mov_b64 exec, -1
w0_43:
  v_mov_b32 v243, 160000
  s_add_u32 s101, s101, 1
  s_barrier
  s_mov_b64 exec, 1
  s_cmp_lg_u32 s16, 0
  s_cbranch_scc1 w0_44
  ds_write_b32 v243, v242 offset:0
  s_waitcnt lgkmcnt(0)
  v_mov_b32 v242, s101
  ds_write_b32 v243, v242 offset:16
  s_waitcnt lgkmcnt(0)
w0_44:
  s_mov_b64 exec, -1
  s_barrier
  ds_read_b32 v242, v243 offset:0
  ds_read_b32 v243, v243 offset:16
  s_waitcnt lgkmcnt(0)
  v_readfirstlane_b32 s3, v242
  v_cmp_ne_u32 vcc, s101, v243
  s_cbranch_vccnz ch_end
  s_load_dwordx8 s[40:47], s[0:1], 0
  s_load_dwordx4 s[48:51], s[0:1], 32
  s_load_dwordx2 s[52:53], s[0:1], 48
  s_load_dwordx2 s[54:55], s[0:1], 112
  v_lshrrev_b32 v1, 6, v0
  s_nop 0
  v_readfirstlane_b32 s16, v1
  v_and_b32 v1, 63, v0
  v_lshrrev_b32 v3, 4, v1
  v_and_b32 v4, 15, v1
  s_mul_i32 s17, s16, 24576
  s_waitcnt lgkmcnt(0)
  s_mov_b32 s60, s40
  s_and_b32 s61, s41, 0xffff
  s_mov_b32 s62, 1835008
  s_mov_b32 s63, 0x20000
  s_mov_b32 s64, s42
  s_and_b32 s65, s43, 0xffff
  s_mov_b32 s66, 229376
  s_mov_b32 s67, 0x20000
  s_mov_b32 s68, s44
  s_and_b32 s69, s45, 0xffff
  s_mov_b32 s70, 229376
  s_mov_b32 s71, 0x20000
  s_mov_b32 s72, s46
  s_and_b32 s73, s47, 0xffff
  s_mov_b32 s74, 229376
  s_mov_b32 s75, 0x20000
  s_mov_b32 s76, s48
  s_and_b32 s77, s49, 0xffff
  s_mov_b32 s78, 229376
  s_mov_b32 s79, 0x20000
  s_mov_b32 s80, s50
  s_and_b32 s81, s51, 0xffff
  s_mov_b32 s82, 896
  s_mov_b32 s83, 0x20000
  s_mov_b32 s84, s52
  s_and_b32 s85, s53, 0xffff
  s_mov_b32 s86, 896
  s_mov_b32 s87, 0x20000
  s_mov_b32 s92, s54
  s_and_b32 s93, s55, 0xffff
  s_mov_b32 s94, 3670016
  s_mov_b32 s95, 0x20000
  v_lshlrev_b32 v5, 5, v1
  v_sub_u32 v5, 2047, v5
  s_add_u32 s18, s17, 13056
  v_subrev_u32 v6, 0, v5
  v_max_i32 v7, 0, v6
  v_cvt_f32_u32 v7, v7
  v_cvt_pk_bf16_f32 v8, v7, v7
  v_and_b32 v7, 0xffff0000, v8
  v_lshrrev_b32 v8, 23, v7
  v_subrev_u32 v8, 134, v8
  v_max_i32 v8, 0, v8
  v_cvt_u32_f32 v7, v7
  v_lshrrev_b32 v7, v8, v7
  v_lshl_add_u32 v7, v8, 8, v7
  v_lshl_add_u32 v200, v7, 2, s18
  v_subrev_u32 v6, 1, v5
  v_max_i32 v7, 0, v6
  v_cvt_f32_u32 v7, v7
  v_cvt_pk_bf16_f32 v8, v7, v7
  v_and_b32 v7, 0xffff0000, v8
  v_lshrrev_b32 v8, 23, v7
  v_subrev_u32 v8, 134, v8
  v_max_i32 v8, 0, v8
  v_cvt_u32_f32 v7, v7
  v_lshrrev_b32 v7, v8, v7
  v_lshl_add_u32 v7, v8, 8, v7
  v_lshl_add_u32 v201, v7, 2, s18
  v_subrev_u32 v6, 2, v5
  v_max_i32 v7, 0, v6
  v_cvt_f32_u32 v7, v7
  v_cvt_pk_bf16_f32 v8, v7, v7
  v_and_b32 v7, 0xffff0000, v8
  v_lshrrev_b32 v8, 23, v7
  v_subrev_u32 v8, 134, v8
  v_max_i32 v8, 0, v8
  v_cvt_u32_f32 v7, v7
  v_lshrrev_b32 v7, v8, v7
  v_lshl_add_u32 v7, v8, 8, v7
  v_lshl_add_u32 v202, v7, 2, s18
  v_subrev_u32 v6, 3, v5
  v_max_i32 v7, 0, v6
  v_cvt_f32_u32 v7, v7
  v_cvt_pk_bf16_f32 v8, v7, v7
  v_and_b32 v7, 0xffff0000, v8
  v_lshrrev_b32 v8, 23, v7
  v_subrev_u32 v8, 134, v8
  v_max_i32 v8, 0, v8
  v_cvt_u32_f32 v7, v7
  v_lshrrev_b32 v7, v8, v7
  v_lshl_add_u32 v7, v8, 8, v7
  v_lshl_add_u32 v203, v7, 2, s18
  v_subrev_u32 v6, 4, v5
  v_max_i32 v7, 0, v6
  v_cvt_f32_u32 v7, v7
  v_cvt_pk_bf16_f32 v8, v7, v7
  v_and_b32 v7, 0xffff0000, v8
  v_lshrrev_b32 v8, 23, v7
  v_subrev_u32 v8, 134, v8
  v_max_i32 v8, 0, v8
  v_cvt_u32_f32 v7, v7
  v_lshrrev_b32 v7, v8, v7
  v_lshl_add_u32 v7, v8, 8, v7
  v_lshl_add_u32 v204, v7, 2, s18
  v_subrev_u32 v6, 5, v5
  v_max_i32 v7, 0, v6
  v_cvt_f32_u32 v7, v7
  v_cvt_pk_bf16_f32 v8, v7, v7
  v_and_b32 v7, 0xffff0000, v8
  v_lshrrev_b32 v8, 23, v7
  v_subrev_u32 v8, 134, v8
  v_max_i32 v8, 0, v8
  v_cvt_u32_f32 v7, v7
  v_lshrrev_b32 v7, v8, v7
  v_lshl_add_u32 v7, v8, 8, v7
  v_lshl_add_u32 v205, v7, 2, s18
  v_subrev_u32 v6, 6, v5
  v_max_i32 v7, 0, v6
  v_cvt_f32_u32 v7, v7
  v_cvt_pk_bf16_f32 v8, v7, v7
  v_and_b32 v7, 0xffff0000, v8
  v_lshrrev_b32 v8, 23, v7
  v_subrev_u32 v8, 134, v8
  v_max_i32 v8, 0, v8
  v_cvt_u32_f32 v7, v7
  v_lshrrev_b32 v7, v8, v7
  v_lshl_add_u32 v7, v8, 8, v7
  v_lshl_add_u32 v206, v7, 2, s18
  v_subrev_u32 v6, 7, v5
  v_max_i32 v7, 0, v6
  v_cvt_f32_u32 v7, v7
  v_cvt_pk_bf16_f32 v8, v7, v7
  v_and_b32 v7, 0xffff0000, v8
  v_lshrrev_b32 v8, 23, v7
  v_subrev_u32 v8, 134, v8
  v_max_i32 v8, 0, v8
  v_cvt_u32_f32 v7, v7
  v_lshrrev_b32 v7, v8, v7
  v_lshl_add_u32 v7, v8, 8, v7
  v_lshl_add_u32 v207, v7, 2, s18
  v_subrev_u32 v6, 8, v5
  v_max_i32 v7, 0, v6
  v_cvt_f32_u32 v7, v7
  v_cvt_pk_bf16_f32 v8, v7, v7
  v_and_b32 v7, 0xffff0000, v8
  v_lshrrev_b32 v8, 23, v7
  v_subrev_u32 v8, 134, v8
  v_max_i32 v8, 0, v8
  v_cvt_u32_f32 v7, v7
  v_lshrrev_b32 v7, v8, v7
  v_lshl_add_u32 v7, v8, 8, v7
  v_lshl_add_u32 v208, v7, 2, s18
  v_subrev_u32 v6, 9, v5
  v_max_i32 v7, 0, v6
  v_cvt_f32_u32 v7, v7
  v_cvt_pk_bf16_f32 v8, v7, v7
  v_and_b32 v7, 0xffff0000, v8
  v_lshrrev_b32 v8, 23, v7
  v_subrev_u32 v8, 134, v8
  v_max_i32 v8, 0, v8
  v_cvt_u32_f32 v7, v7
  v_lshrrev_b32 v7, v8, v7
  v_lshl_add_u32 v7, v8, 8, v7
  v_lshl_add_u32 v209, v7, 2, s18
  v_subrev_u32 v6, 10, v5
  v_max_i32 v7, 0, v6
  v_cvt_f32_u32 v7, v7
  v_cvt_pk_bf16_f32 v8, v7, v7
  v_and_b32 v7, 0xffff0000, v8
  v_lshrrev_b32 v8, 23, v7
  v_subrev_u32 v8, 134, v8
  v_max_i32 v8, 0, v8
  v_cvt_u32_f32 v7, v7
  v_lshrrev_b32 v7, v8, v7
  v_lshl_add_u32 v7, v8, 8, v7
  v_lshl_add_u32 v210, v7, 2, s18
  v_subrev_u32 v6, 11, v5
  v_max_i32 v7, 0, v6
  v_cvt_f32_u32 v7, v7
  v_cvt_pk_bf16_f32 v8, v7, v7
  v_and_b32 v7, 0xffff0000, v8
  v_lshrrev_b32 v8, 23, v7
  v_subrev_u32 v8, 134, v8
  v_max_i32 v8, 0, v8
  v_cvt_u32_f32 v7, v7
  v_lshrrev_b32 v7, v8, v7
  v_lshl_add_u32 v7, v8, 8, v7
  v_lshl_add_u32 v211, v7, 2, s18
  v_subrev_u32 v6, 12, v5
  v_max_i32 v7, 0, v6
  v_cvt_f32_u32 v7, v7
  v_cvt_pk_bf16_f32 v8, v7, v7
  v_and_b32 v7, 0xffff0000, v8
  v_lshrrev_b32 v8, 23, v7
  v_subrev_u32 v8, 134, v8
  v_max_i32 v8, 0, v8
  v_cvt_u32_f32 v7, v7
  v_lshrrev_b32 v7, v8, v7
  v_lshl_add_u32 v7, v8, 8, v7
  v_lshl_add_u32 v212, v7, 2, s18
  v_subrev_u32 v6, 13, v5
  v_max_i32 v7, 0, v6
  v_cvt_f32_u32 v7, v7
  v_cvt_pk_bf16_f32 v8, v7, v7
  v_and_b32 v7, 0xffff0000, v8
  v_lshrrev_b32 v8, 23, v7
  v_subrev_u32 v8, 134, v8
  v_max_i32 v8, 0, v8
  v_cvt_u32_f32 v7, v7
  v_lshrrev_b32 v7, v8, v7
  v_lshl_add_u32 v7, v8, 8, v7
  v_lshl_add_u32 v213, v7, 2, s18
  v_subrev_u32 v6, 14, v5
  v_max_i32 v7, 0, v6
  v_cvt_f32_u32 v7, v7
  v_cvt_pk_bf16_f32 v8, v7, v7
  v_and_b32 v7, 0xffff0000, v8
  v_lshrrev_b32 v8, 23, v7
  v_subrev_u32 v8, 134, v8
  v_max_i32 v8, 0, v8
  v_cvt_u32_f32 v7, v7
  v_lshrrev_b32 v7, v8, v7
  v_lshl_add_u32 v7, v8, 8, v7
  v_lshl_add_u32 v214, v7, 2, s18
  v_subrev_u32 v6, 15, v5
  v_max_i32 v7, 0, v6
  v_cvt_f32_u32 v7, v7
  v_cvt_pk_bf16_f32 v8, v7, v7
  v_and_b32 v7, 0xffff0000, v8
  v_lshrrev_b32 v8, 23, v7
  v_subrev_u32 v8, 134, v8
  v_max_i32 v8, 0, v8
  v_cvt_u32_f32 v7, v7
  v_lshrrev_b32 v7, v8, v7
  v_lshl_add_u32 v7, v8, 8, v7
  v_lshl_add_u32 v215, v7, 2, s18
  v_subrev_u32 v6, 16, v5
  v_max_i32 v7, 0, v6
  v_cvt_f32_u32 v7, v7
  v_cvt_pk_bf16_f32 v8, v7, v7
  v_and_b32 v7, 0xffff0000, v8
  v_lshrrev_b32 v8, 23, v7
  v_subrev_u32 v8, 134, v8
  v_max_i32 v8, 0, v8
  v_cvt_u32_f32 v7, v7
  v_lshrrev_b32 v7, v8, v7
  v_lshl_add_u32 v7, v8, 8, v7
  v_lshl_add_u32 v216, v7, 2, s18
  v_subrev_u32 v6, 17, v5
  v_max_i32 v7, 0, v6
  v_cvt_f32_u32 v7, v7
  v_cvt_pk_bf16_f32 v8, v7, v7
  v_and_b32 v7, 0xffff0000, v8
  v_lshrrev_b32 v8, 23, v7
  v_subrev_u32 v8, 134, v8
  v_max_i32 v8, 0, v8
  v_cvt_u32_f32 v7, v7
  v_lshrrev_b32 v7, v8, v7
  v_lshl_add_u32 v7, v8, 8, v7
  v_lshl_add_u32 v217, v7, 2, s18
  v_subrev_u32 v6, 18, v5
  v_max_i32 v7, 0, v6
  v_cvt_f32_u32 v7, v7
  v_cvt_pk_bf16_f32 v8, v7, v7
  v_and_b32 v7, 0xffff0000, v8
  v_lshrrev_b32 v8, 23, v7
  v_subrev_u32 v8, 134, v8
  v_max_i32 v8, 0, v8
  v_cvt_u32_f32 v7, v7
  v_lshrrev_b32 v7, v8, v7
  v_lshl_add_u32 v7, v8, 8, v7
  v_lshl_add_u32 v218, v7, 2, s18
  v_subrev_u32 v6, 19, v5
  v_max_i32 v7, 0, v6
  v_cvt_f32_u32 v7, v7
  v_cvt_pk_bf16_f32 v8, v7, v7
  v_and_b32 v7, 0xffff0000, v8
  v_lshrrev_b32 v8, 23, v7
  v_subrev_u32 v8, 134, v8
  v_max_i32 v8, 0, v8
  v_cvt_u32_f32 v7, v7
  v_lshrrev_b32 v7, v8, v7
  v_lshl_add_u32 v7, v8, 8, v7
  v_lshl_add_u32 v219, v7, 2, s18
  v_subrev_u32 v6, 20, v5
  v_max_i32 v7, 0, v6
  v_cvt_f32_u32 v7, v7
  v_cvt_pk_bf16_f32 v8, v7, v7
  v_and_b32 v7, 0xffff0000, v8
  v_lshrrev_b32 v8, 23, v7
  v_subrev_u32 v8, 134, v8
  v_max_i32 v8, 0, v8
  v_cvt_u32_f32 v7, v7
  v_lshrrev_b32 v7, v8, v7
  v_lshl_add_u32 v7, v8, 8, v7
  v_lshl_add_u32 v220, v7, 2, s18
  v_subrev_u32 v6, 21, v5
  v_max_i32 v7, 0, v6
  v_cvt_f32_u32 v7, v7
  v_cvt_pk_bf16_f32 v8, v7, v7
  v_and_b32 v7, 0xffff0000, v8
  v_lshrrev_b32 v8, 23, v7
  v_subrev_u32 v8, 134, v8
  v_max_i32 v8, 0, v8
  v_cvt_u32_f32 v7, v7
  v_lshrrev_b32 v7, v8, v7
  v_lshl_add_u32 v7, v8, 8, v7
  v_lshl_add_u32 v221, v7, 2, s18
  v_subrev_u32 v6, 22, v5
  v_max_i32 v7, 0, v6
  v_cvt_f32_u32 v7, v7
  v_cvt_pk_bf16_f32 v8, v7, v7
  v_and_b32 v7, 0xffff0000, v8
  v_lshrrev_b32 v8, 23, v7
  v_subrev_u32 v8, 134, v8
  v_max_i32 v8, 0, v8
  v_cvt_u32_f32 v7, v7
  v_lshrrev_b32 v7, v8, v7
  v_lshl_add_u32 v7, v8, 8, v7
  v_lshl_add_u32 v222, v7, 2, s18
  v_subrev_u32 v6, 23, v5
  v_max_i32 v7, 0, v6
  v_cvt_f32_u32 v7, v7
  v_cvt_pk_bf16_f32 v8, v7, v7
  v_and_b32 v7, 0xffff0000, v8
  v_lshrrev_b32 v8, 23, v7
  v_subrev_u32 v8, 134, v8
  v_max_i32 v8, 0, v8
  v_cvt_u32_f32 v7, v7
  v_lshrrev_b32 v7, v8, v7
  v_lshl_add_u32 v7, v8, 8, v7
  v_lshl_add_u32 v223, v7, 2, s18
  v_subrev_u32 v6, 24, v5
  v_max_i32 v7, 0, v6
  v_cvt_f32_u32 v7, v7
  v_cvt_pk_bf16_f32 v8, v7, v7
  v_and_b32 v7, 0xffff0000, v8
  v_lshrrev_b32 v8, 23, v7
  v_subrev_u32 v8, 134, v8
  v_max_i32 v8, 0, v8
  v_cvt_u32_f32 v7, v7
  v_lshrrev_b32 v7, v8, v7
  v_lshl_add_u32 v7, v8, 8, v7
  v_lshl_add_u32 v224, v7, 2, s18
  v_subrev_u32 v6, 25, v5
  v_max_i32 v7, 0, v6
  v_cvt_f32_u32 v7, v7
  v_cvt_pk_bf16_f32 v8, v7, v7
  v_and_b32 v7, 0xffff0000, v8
  v_lshrrev_b32 v8, 23, v7
  v_subrev_u32 v8, 134, v8
  v_max_i32 v8, 0, v8
  v_cvt_u32_f32 v7, v7
  v_lshrrev_b32 v7, v8, v7
  v_lshl_add_u32 v7, v8, 8, v7
  v_lshl_add_u32 v225, v7, 2, s18
  v_subrev_u32 v6, 26, v5
  v_max_i32 v7, 0, v6
  v_cvt_f32_u32 v7, v7
  v_cvt_pk_bf16_f32 v8, v7, v7
  v_and_b32 v7, 0xffff0000, v8
  v_lshrrev_b32 v8, 23, v7
  v_subrev_u32 v8, 134, v8
  v_max_i32 v8, 0, v8
  v_cvt_u32_f32 v7, v7
  v_lshrrev_b32 v7, v8, v7
  v_lshl_add_u32 v7, v8, 8, v7
  v_lshl_add_u32 v226, v7, 2, s18
  v_subrev_u32 v6, 27, v5
  v_max_i32 v7, 0, v6
  v_cvt_f32_u32 v7, v7
  v_cvt_pk_bf16_f32 v8, v7, v7
  v_and_b32 v7, 0xffff0000, v8
  v_lshrrev_b32 v8, 23, v7
  v_subrev_u32 v8, 134, v8
  v_max_i32 v8, 0, v8
  v_cvt_u32_f32 v7, v7
  v_lshrrev_b32 v7, v8, v7
  v_lshl_add_u32 v7, v8, 8, v7
  v_lshl_add_u32 v227, v7, 2, s18
  v_subrev_u32 v6, 28, v5
  v_max_i32 v7, 0, v6
  v_cvt_f32_u32 v7, v7
  v_cvt_pk_bf16_f32 v8, v7, v7
  v_and_b32 v7, 0xffff0000, v8
  v_lshrrev_b32 v8, 23, v7
  v_subrev_u32 v8, 134, v8
  v_max_i32 v8, 0, v8
  v_cvt_u32_f32 v7, v7
  v_lshrrev_b32 v7, v8, v7
  v_lshl_add_u32 v7, v8, 8, v7
  v_lshl_add_u32 v228, v7, 2, s18
  v_subrev_u32 v6, 29, v5
  v_max_i32 v7, 0, v6
  v_cvt_f32_u32 v7, v7
  v_cvt_pk_bf16_f32 v8, v7, v7
  v_and_b32 v7, 0xffff0000, v8
  v_lshrrev_b32 v8, 23, v7
  v_subrev_u32 v8, 134, v8
  v_max_i32 v8, 0, v8
  v_cvt_u32_f32 v7, v7
  v_lshrrev_b32 v7, v8, v7
  v_lshl_add_u32 v7, v8, 8, v7
  v_lshl_add_u32 v229, v7, 2, s18
  v_subrev_u32 v6, 30, v5
  v_max_i32 v7, 0, v6
  v_cvt_f32_u32 v7, v7
  v_cvt_pk_bf16_f32 v8, v7, v7
  v_and_b32 v7, 0xffff0000, v8
  v_lshrrev_b32 v8, 23, v7
  v_subrev_u32 v8, 134, v8
  v_max_i32 v8, 0, v8
  v_cvt_u32_f32 v7, v7
  v_lshrrev_b32 v7, v8, v7
  v_lshl_add_u32 v7, v8, 8, v7
  v_lshl_add_u32 v230, v7, 2, s18
  v_subrev_u32 v6, 31, v5
  v_max_i32 v7, 0, v6
  v_cvt_f32_u32 v7, v7
  v_cvt_pk_bf16_f32 v8, v7, v7
  v_and_b32 v7, 0xffff0000, v8
  v_lshrrev_b32 v8, 23, v7
  v_subrev_u32 v8, 134, v8
  v_max_i32 v8, 0, v8
  v_cvt_u32_f32 v7, v7
  v_lshrrev_b32 v7, v8, v7
  v_lshl_add_u32 v7, v8, 8, v7
  v_lshl_add_u32 v231, v7, 2, s18
  v_subrev_u32 v6, 32, v5
  v_max_i32 v7, 0, v6
  v_cvt_f32_u32 v7, v7
  v_cvt_pk_bf16_f32 v8, v7, v7
  v_and_b32 v7, 0xffff0000, v8
  v_lshrrev_b32 v8, 23, v7
  v_subrev_u32 v8, 134, v8
  v_max_i32 v8, 0, v8
  v_cvt_u32_f32 v7, v7
  v_lshrrev_b32 v7, v8, v7
  v_lshl_add_u32 v7, v8, 8, v7
  v_mov_b32 v8, 1280
  v_cmp_gt_i32 vcc, 0, v6
  s_nop 1
  v_cndmask_b32 v7, v7, v8, vcc
  v_lshl_add_u32 v232, v7, 2, s18
  v_mov_b32 v8, 0
  v_mov_b32 v9, 0
  v_lshlrev_b32 v5, 3, v1
  v_add_u32 v5, s17, v5
  ds_write_b64 v5, v[8:9]
  v_and_b32 v6, 15, v1
  v_lshlrev_b32 v6, 3, v6
  v_add_u32 v6, s17, v6
  ds_write_b64 v6, v[8:9] offset:8704
  ds_write_b64 v6, v[8:9] offset:12928
  v_mov_b32 v6, s17
  ds_write_b64 v6, v[8:9] offset:18176
  s_lshl_b32 s19, s3, 2
  s_add_u32 s20, s19, s16
  s_lshl_b32 s21, s3, 3
  v_mul_u32_u24 v5, 3584, v0
  v_mul_u32_u24 v141, 1792, v0
  s_lshl_b32 s22, s20, 9
  v_lshlrev_b32 v6, 3, v1
  buffer_load_dwordx2 v[24:25], v6, s[64:67], s22 offen
  buffer_load_dwordx2 v[26:27], v6, s[68:71], s22 offen
  buffer_load_dwordx2 v[28:29], v6, s[72:75], s22 offen
  buffer_load_dwordx2 v[30:31], v6, s[76:79], s22 offen
  s_lshl_b32 s22, s20, 1
  v_mov_b32 v7, 0
  buffer_load_ushort v32, v7, s[80:83], s22 offen
  buffer_load_ushort v33, v7, s[84:87], s22 offen
  s_mov_b32 s24, 0x05040100
  s_mov_b32 s25, 0x07060302
  s_barrier
  s_waitcnt vmcnt(0)
  s_mov_b32 s26, 1069066811
  s_mov_b32 s27, 1042479491
  v_lshlrev_b32 v32, 16, v32
  v_lshlrev_b32 v33, 16, v33
  v_mul_f32 v32, s26, v32
  v_exp_f32 v32, v32
  s_nop 0
  v_cvt_pk_bf16_f32 v34, v32, v32
  v_and_b32 v32, 0xffff0000, v34
  v_lshlrev_b32 v37, 6, v1
  v_add_u32 v37, s17, v37
  v_lshlrev_b32 v40, 16, v24
  v_lshlrev_b32 v41, 16, v26
  v_lshlrev_b32 v42, 16, v28
  v_lshlrev_b32 v43, 16, v30
  v_mul_f32 v40, s26, v40
  v_exp_f32 v40, v40
  s_nop 0
  v_cvt_pk_bf16_f32 v34, v40, v40
  v_and_b32 v40, 0xffff0000, v34
  v_mul_f32 v40, v40, v32
  v_mul_f32 v40, s26, v40
  v_sub_f32 v40, 0, v40
  v_mul_f32 v41, v41, v32
  v_mul_f32 v41, s27, v41
  v_mul_f32 v42, v42, v32
  v_mul_f32 v43, v43, v32
  v_add_f32 v42, v42, v42
  v_add_f32 v43, v43, v43
  ds_write_b128 v37, v[40:43] offset:18240
  v_and_b32 v40, 0xffff0000, v24
  v_and_b32 v41, 0xffff0000, v26
  v_and_b32 v42, 0xffff0000, v28
  v_and_b32 v43, 0xffff0000, v30
  v_mul_f32 v40, s26, v40
  v_exp_f32 v40, v40
  s_nop 0
  v_cvt_pk_bf16_f32 v34, v40, v40
  v_and_b32 v40, 0xffff0000, v34
  v_mul_f32 v40, v40, v32
  v_mul_f32 v40, s26, v40
  v_sub_f32 v40, 0, v40
  v_mul_f32 v41, v41, v32
  v_mul_f32 v41, s27, v41
  v_mul_f32 v42, v42, v32
  v_mul_f32 v43, v43, v32
  v_add_f32 v42, v42, v42
  v_add_f32 v43, v43, v43
  ds_write_b128 v37, v[40:43] offset:18256
  v_lshlrev_b32 v40, 16, v25
  v_lshlrev_b32 v41, 16, v27
  v_lshlrev_b32 v42, 16, v29
  v_lshlrev_b32 v43, 16, v31
  v_mul_f32 v40, s26, v40
  v_exp_f32 v40, v40
  s_nop 0
  v_cvt_pk_bf16_f32 v34, v40, v40
  v_and_b32 v40, 0xffff0000, v34
  v_mul_f32 v40, v40, v32
  v_mul_f32 v40, s26, v40
  v_sub_f32 v40, 0, v40
  v_mul_f32 v41, v41, v32
  v_mul_f32 v41, s27, v41
  v_mul_f32 v42, v42, v32
  v_mul_f32 v43, v43, v32
  v_add_f32 v42, v42, v42
  v_add_f32 v43, v43, v43
  ds_write_b128 v37, v[40:43] offset:18272
  v_and_b32 v40, 0xffff0000, v25
  v_and_b32 v41, 0xffff0000, v27
  v_and_b32 v42, 0xffff0000, v29
  v_and_b32 v43, 0xffff0000, v31
  v_mul_f32 v40, s26, v40
  v_exp_f32 v40, v40
  s_nop 0
  v_cvt_pk_bf16_f32 v34, v40, v40
  v_and_b32 v40, 0xffff0000, v34
  v_mul_f32 v40, v40, v32
  v_mul_f32 v40, s26, v40
  v_sub_f32 v40, 0, v40
  v_mul_f32 v41, v41, v32
  v_mul_f32 v41, s27, v41
  v_mul_f32 v42, v42, v32
  v_mul_f32 v43, v43, v32
  v_add_f32 v42, v42, v42
  v_add_f32 v43, v43, v43
  ds_write_b128 v37, v[40:43] offset:18288
  v_cvt_f32_u32 v44, v4
  v_lshlrev_b32 v45, 4, v4
  v_cvt_f32_u32 v45, v45
  v_lshlrev_b32 v46, 4, v3
  v_add_u32 v46, s17, v46
  v_mov_b32 v48, 0
  v_mov_b32 v49, 0
  v_mov_b32 v50, 0
  v_mov_b32 v51, 0
  v_mov_b32 v52, 0
  v_mov_b32 v53, 0
  v_mov_b32 v54, 0
  v_mov_b32 v55, 0
  v_mov_b32 v56, 0
  v_mov_b32 v57, 0
  v_mov_b32 v58, 0
  v_mov_b32 v59, 0
  v_mov_b32 v60, 0
  v_mov_b32 v61, 0
  v_mov_b32 v62, 0
  v_mov_b32 v63, 0
  v_mov_b32 v64, 0
  v_mov_b32 v65, 0
  v_mov_b32 v66, 0
  v_mov_b32 v67, 0
  s_waitcnt lgkmcnt(0)
  ds_read_b128 v[68:71], v46 offset:18240
  s_add_u32 s22, s21, 0
  buffer_load_dwordx2 v[8:9], v5, s[60:63], s22 offen offset:0
  s_mov_b32 s28, 0
  s_call_b64 s[30:31], wk_kl
  s_mov_b32 s28, 0
  s_call_b64 s[30:31], wk_kl
  s_add_u32 s22, s21, 0
  buffer_load_dwordx2 v[10:11], v5, s[60:63], s22 offen offset:896
  s_mov_b32 s28, 0
  s_call_b64 s[30:31], wk_kl
  s_mov_b32 s28, 0
  s_call_b64 s[30:31], wk_kl
  s_add_u32 s22, s21, 0
  buffer_load_dwordx2 v[12:13], v5, s[60:63], s22 offen offset:1792
  s_mov_b32 s28, 0
  s_call_b64 s[30:31], wk_kl
  s_mov_b32 s28, 0
  s_call_b64 s[30:31], wk_kl
  s_add_u32 s22, s21, 0
  buffer_load_dwordx2 v[14:15], v5, s[60:63], s22 offen offset:2688
  s_mov_b32 s28, 0
  s_call_b64 s[30:31], wk_kl
  s_mov_b32 s28, 0
  s_call_b64 s[30:31], wk_kl
  s_add_u32 s22, s21, 917504
  buffer_load_dwordx2 v[16:17], v5, s[60:63], s22 offen offset:0
  s_mov_b32 s28, 0
  s_call_b64 s[30:31], wk_kl
  s_mov_b32 s28, 0
  s_call_b64 s[30:31], wk_kl
  s_add_u32 s22, s21, 917504
  buffer_load_dwordx2 v[18:19], v5, s[60:63], s22 offen offset:896
  s_mov_b32 s28, 0
  s_call_b64 s[30:31], wk_kl
  s_mov_b32 s28, 0
  s_call_b64 s[30:31], wk_kl
  s_add_u32 s22, s21, 917504
  buffer_load_dwordx2 v[20:21], v5, s[60:63], s22 offen offset:1792
  s_mov_b32 s28, 0
  s_call_b64 s[30:31], wk_kl
  s_mov_b32 s28, 0
  s_call_b64 s[30:31], wk_kl
  s_add_u32 s22, s21, 917504
  buffer_load_dwordx2 v[22:23], v5, s[60:63], s22 offen offset:2688
  s_mov_b32 s28, 0
  s_call_b64 s[30:31], wk_kl
  s_mov_b32 s28, 0
  s_call_b64 s[30:31], wk_kl
  s_branch wk_kd
wk_kl:
  s_waitcnt lgkmcnt(0)
  v_mov_b32 v72, v68
  v_mov_b32 v73, v69
  v_mov_b32 v74, v70
  v_mov_b32 v75, v71
  v_add_u32 v46, 64, v46
  ds_read_b128 v[68:71], v46 offset:18240
  v_mul_f32 v80, v72, v45
  v_mul_f32 v81, v73, v45
  v_exp_f32 v80, v80
  v_fract_f32 v81, v81
  v_cos_f32 v76, v81
  v_sin_f32 v77, v81
  v_mul_f32 v76, v76, v80
  v_mul_f32 v77, v77, v80
  v_mul_f32 v80, v72, v44
  v_mul_f32 v81, v73, v44
  v_exp_f32 v80, v80
  v_fract_f32 v81, v81
  v_cos_f32 v78, v81
  v_sin_f32 v79, v81
  v_mul_f32 v78, v78, v80
  v_mul_f32 v79, v79, v80
  v_mul_f32 v82, v74, v76
  v_mul_f32 v83, v74, v77
  v_fma_f32 v82, -v75, v77, v82
  v_fma_f32 v83, -v75, v76, -v83
  v_mul_f32 v86, v76, v76
  v_mul_f32 v87, v76, v77
  v_fma_f32 v86, -v77, v77, v86
  v_add_f32 v87, v87, v87
  v_mfma_f32_16x16x4_f32 v[48:51], v82, v78, v[48:51]
  v_mul_f32 v88, v78, v78
  v_mul_f32 v89, v78, v79
  v_fma_f32 v88, -v79, v79, v88
  v_add_f32 v89, v89, v89
  v_mfma_f32_16x16x4_f32 v[48:51], v83, v79, v[48:51]
  v_mul_f32 v84, v74, v86
  v_mul_f32 v85, v74, v87
  v_fma_f32 v84, -v75, v87, v84
  v_fma_f32 v85, -v75, v86, -v85
  v_mul_f32 v76, v86, v86
  v_mul_f32 v77, v86, v87
  v_fma_f32 v76, -v87, v87, v76
  v_add_f32 v77, v77, v77
  v_mfma_f32_16x16x4_f32 v[52:55], v84, v88, v[52:55]
  v_mul_f32 v78, v88, v88
  v_mul_f32 v79, v88, v89
  v_fma_f32 v78, -v89, v89, v78
  v_add_f32 v79, v79, v79
  v_mfma_f32_16x16x4_f32 v[52:55], v85, v89, v[52:55]
  v_mul_f32 v82, v74, v76
  v_mul_f32 v83, v74, v77
  v_fma_f32 v82, -v75, v77, v82
  v_fma_f32 v83, -v75, v76, -v83
  v_mul_f32 v86, v76, v76
  v_mul_f32 v87, v76, v77
  v_fma_f32 v86, -v77, v77, v86
  v_add_f32 v87, v87, v87
  v_mfma_f32_16x16x4_f32 v[56:59], v82, v78, v[56:59]
  v_mul_f32 v88, v78, v78
  v_mul_f32 v89, v78, v79
  v_fma_f32 v88, -v79, v79, v88
  v_add_f32 v89, v89, v89
  v_mfma_f32_16x16x4_f32 v[56:59], v83, v79, v[56:59]
  v_mul_f32 v84, v74, v86
  v_mul_f32 v85, v74, v87
  v_fma_f32 v84, -v75, v87, v84
  v_fma_f32 v85, -v75, v86, -v85
  v_mul_f32 v76, v86, v86
  v_mul_f32 v77, v86, v87
  v_fma_f32 v76, -v87, v87, v76
  v_add_f32 v77, v77, v77
  v_mfma_f32_16x16x4_f32 v[60:63], v84, v88, v[60:63]
  v_mfma_f32_16x16x4_f32 v[60:63], v85, v89, v[60:63]
  v_mul_f32 v82, v74, v76
  v_fma_f32 v82, -v75, v77, v82
  s_nop 1
  v_mfma_f32_16x16x4_f32 v[64:67], v82, v88, v[64:67]
  s_add_u32 s28, s28, 1
  s_cmp_lt_u32 s28, 4
  s_cbranch_scc1 wk_kl
  s_setpc_b64 s[30:31]
wk_kd:
  s_nop 15
  s_nop 3
  s_waitcnt vmcnt(0)
  v_lshlrev_b32 v6, 3, v0
  v_perm_b32 v34, v10, v8, s24
  v_perm_b32 v35, v14, v12, s24
  v_add_u32 v36, 512, v6
  ds_write_b64 v36, v[34:35]
  v_perm_b32 v34, v10, v8, s25
  v_perm_b32 v35, v14, v12, s25
  v_add_u32 v36, 25088, v6
  ds_write_b64 v36, v[34:35]
  v_perm_b32 v34, v11, v9, s24
  v_perm_b32 v35, v15, v13, s24
  v_add_u32 v36, 49664, v6
  ds_write_b64 v36, v[34:35]
  v_perm_b32 v34, v11, v9, s25
  v_perm_b32 v35, v15, v13, s25
  v_add_u32 v36, 74240, v6
  ds_write_b64 v36, v[34:35]
  v_perm_b32 v34, v18, v16, s24
  v_perm_b32 v35, v22, v20, s24
  v_add_u32 v36, 2560, v6
  ds_write_b64 v36, v[34:35]
  v_perm_b32 v34, v18, v16, s25
  v_perm_b32 v35, v22, v20, s25
  v_add_u32 v36, 27136, v6
  ds_write_b64 v36, v[34:35]
  v_perm_b32 v34, v19, v17, s24
  v_perm_b32 v35, v23, v21, s24
  v_add_u32 v36, 51712, v6
  ds_write_b64 v36, v[34:35]
  v_perm_b32 v34, v19, v17, s25
  v_perm_b32 v35, v23, v21, s25
  v_add_u32 v36, 76288, v6
  ds_write_b64 v36, v[34:35]
  v_lshlrev_b32 v46, 8, v3
  v_lshl_add_u32 v46, v4, 2, v46
  v_add_u32 v46, s17, v46
  ds_write_b32 v46, v48 offset:13056
  ds_write_b32 v46, v49 offset:13120
  ds_write_b32 v46, v50 offset:13184
  ds_write_b32 v46, v51 offset:13248
  s_waitcnt lgkmcnt(8)
  ds_write_b32 v46, v52 offset:14080
  ds_write_b32 v46, v53 offset:14144
  ds_write_b32 v46, v54 offset:14208
  ds_write_b32 v46, v55 offset:14272
  s_waitcnt lgkmcnt(8)
  ds_write_b32 v46, v56 offset:15104
  ds_write_b32 v46, v57 offset:15168
  ds_write_b32 v46, v58 offset:15232
  ds_write_b32 v46, v59 offset:15296
  s_waitcnt lgkmcnt(8)
  ds_write_b32 v46, v60 offset:16128
  ds_write_b32 v46, v61 offset:16192
  ds_write_b32 v46, v62 offset:16256
  ds_write_b32 v46, v63 offset:16320
  s_waitcnt lgkmcnt(8)
  ds_write_b32 v46, v64 offset:17152
  ds_write_b32 v46, v65 offset:17216
  ds_write_b32 v46, v66 offset:17280
  ds_write_b32 v46, v67 offset:17344
  s_waitcnt lgkmcnt(8)
  s_waitcnt lgkmcnt(0)
  ds_read_b32 v48, v200
  ds_read_b32 v49, v201
  ds_read_b32 v50, v202
  ds_read_b32 v51, v203
  ds_read_b32 v52, v204
  ds_read_b32 v53, v205
  ds_read_b32 v54, v206
  ds_read_b32 v55, v207
  s_waitcnt lgkmcnt(4)
  ds_read_b32 v56, v208
  ds_read_b32 v57, v209
  ds_read_b32 v58, v210
  ds_read_b32 v59, v211
  ds_read_b32 v60, v212
  ds_read_b32 v61, v213
  ds_read_b32 v62, v214
  ds_read_b32 v63, v215
  s_waitcnt lgkmcnt(4)
  ds_read_b32 v64, v216
  ds_read_b32 v65, v217
  ds_read_b32 v66, v218
  ds_read_b32 v67, v219
  ds_read_b32 v68, v220
  ds_read_b32 v69, v221
  ds_read_b32 v70, v222
  ds_read_b32 v71, v223
  s_waitcnt lgkmcnt(4)
  ds_read_b32 v72, v224
  ds_read_b32 v73, v225
  ds_read_b32 v74, v226
  ds_read_b32 v75, v227
  ds_read_b32 v76, v228
  ds_read_b32 v77, v229
  ds_read_b32 v78, v230
  ds_read_b32 v79, v231
  s_waitcnt lgkmcnt(4)
  ds_read_b32 v80, v232
  s_waitcnt lgkmcnt(0)
  v_lshlrev_b32 v46, 6, v1
  v_add_u32 v46, s17, v46
  v_cvt_pk_bf16_f32 v84, v48, v49
  v_cvt_pk_bf16_f32 v88, v49, v50
  v_cvt_pk_bf16_f32 v85, v50, v51
  v_cvt_pk_bf16_f32 v89, v51, v52
  v_cvt_pk_bf16_f32 v86, v52, v53
  v_cvt_pk_bf16_f32 v90, v53, v54
  v_cvt_pk_bf16_f32 v87, v54, v55
  v_cvt_pk_bf16_f32 v91, v55, v56
  ds_write_b128 v46, v[84:87] offset:4608
  ds_write_b128 v46, v[88:91] offset:8832
  s_waitcnt lgkmcnt(0)
  v_cvt_pk_bf16_f32 v84, v56, v57
  v_cvt_pk_bf16_f32 v88, v57, v58
  v_cvt_pk_bf16_f32 v85, v58, v59
  v_cvt_pk_bf16_f32 v89, v59, v60
  v_cvt_pk_bf16_f32 v86, v60, v61
  v_cvt_pk_bf16_f32 v90, v61, v62
  v_cvt_pk_bf16_f32 v87, v62, v63
  v_cvt_pk_bf16_f32 v91, v63, v64
  ds_write_b128 v46, v[84:87] offset:4624
  ds_write_b128 v46, v[88:91] offset:8848
  s_waitcnt lgkmcnt(0)
  v_cvt_pk_bf16_f32 v84, v64, v65
  v_cvt_pk_bf16_f32 v88, v65, v66
  v_cvt_pk_bf16_f32 v85, v66, v67
  v_cvt_pk_bf16_f32 v89, v67, v68
  v_cvt_pk_bf16_f32 v86, v68, v69
  v_cvt_pk_bf16_f32 v90, v69, v70
  v_cvt_pk_bf16_f32 v87, v70, v71
  v_cvt_pk_bf16_f32 v91, v71, v72
  ds_write_b128 v46, v[84:87] offset:4640
  ds_write_b128 v46, v[88:91] offset:8864
  s_waitcnt lgkmcnt(0)
  v_cvt_pk_bf16_f32 v84, v72, v73
  v_cvt_pk_bf16_f32 v88, v73, v74
  v_cvt_pk_bf16_f32 v85, v74, v75
  v_cvt_pk_bf16_f32 v89, v75, v76
  v_cvt_pk_bf16_f32 v86, v76, v77
  v_cvt_pk_bf16_f32 v90, v77, v78
  v_cvt_pk_bf16_f32 v87, v78, v79
  v_cvt_pk_bf16_f32 v91, v79, v80
  ds_write_b128 v46, v[84:87] offset:4656
  ds_write_b128 v46, v[88:91] offset:8880
  s_waitcnt lgkmcnt(0)
  s_barrier
  v_lshrrev_b32 v47, 1, v3
  v_sub_u32 v46, v4, v47
  v_add_u32 v46, 1, v46
  v_lshlrev_b32 v46, 5, v46
  v_and_b32 v48, 1, v3
  v_lshl_add_u32 v46, v48, 4, v46
  v_add_u32 v46, s17, v46
  ds_read_b128 a[0:3], v46 offset:32
  ds_read_b128 a[4:7], v46 offset:96
  ds_read_b128 a[8:11], v46 offset:160
  ds_read_b128 a[12:15], v46 offset:224
  ds_read_b128 a[16:19], v46 offset:288
  ds_read_b128 a[20:23], v46 offset:352
  ds_read_b128 a[24:27], v46 offset:416
  ds_read_b128 a[28:31], v46 offset:480
  s_waitcnt lgkmcnt(4)
  ds_read_b128 a[32:35], v46 offset:544
  ds_read_b128 a[36:39], v46 offset:608
  ds_read_b128 a[40:43], v46 offset:672
  ds_read_b128 a[44:47], v46 offset:736
  ds_read_b128 a[48:51], v46 offset:800
  ds_read_b128 a[52:55], v46 offset:864
  ds_read_b128 a[56:59], v46 offset:928
  ds_read_b128 a[60:63], v46 offset:992
  s_waitcnt lgkmcnt(4)
  ds_read_b128 a[64:67], v46 offset:1056
  ds_read_b128 a[68:71], v46 offset:1120
  ds_read_b128 a[72:75], v46 offset:1184
  ds_read_b128 a[76:79], v46 offset:1248
  ds_read_b128 a[80:83], v46 offset:1312
  ds_read_b128 a[84:87], v46 offset:1376
  ds_read_b128 a[88:91], v46 offset:1440
  ds_read_b128 a[92:95], v46 offset:1504
  s_waitcnt lgkmcnt(4)
  ds_read_b128 a[96:99], v46 offset:1568
  ds_read_b128 a[100:103], v46 offset:1632
  ds_read_b128 a[104:107], v46 offset:1696
  ds_read_b128 a[108:111], v46 offset:1760
  ds_read_b128 a[112:115], v46 offset:1824
  ds_read_b128 a[116:119], v46 offset:1888
  ds_read_b128 a[120:123], v46 offset:1952
  ds_read_b128 a[124:127], v46 offset:2016
  s_waitcnt lgkmcnt(4)
  ds_read_b128 a[128:131], v46 offset:2080
  ds_read_b128 a[132:135], v46 offset:2144
  ds_read_b128 a[136:139], v46 offset:2208
  ds_read_b128 a[140:143], v46 offset:2272
  ds_read_b128 a[144:147], v46 offset:2336
  ds_read_b128 a[148:151], v46 offset:2400
  ds_read_b128 a[152:155], v46 offset:2464
  ds_read_b128 a[156:159], v46 offset:2528
  s_waitcnt lgkmcnt(4)
  ds_read_b128 a[160:163], v46 offset:2592
  ds_read_b128 a[164:167], v46 offset:2656
  ds_read_b128 a[168:171], v46 offset:2720
  ds_read_b128 a[172:175], v46 offset:2784
  ds_read_b128 a[176:179], v46 offset:2848
  ds_read_b128 a[180:183], v46 offset:2912
  ds_read_b128 a[184:187], v46 offset:2976
  ds_read_b128 a[188:191], v46 offset:3040
  s_waitcnt lgkmcnt(4)
  ds_read_b128 a[192:195], v46 offset:3104
  ds_read_b128 a[196:199], v46 offset:3168
  ds_read_b128 a[200:203], v46 offset:3232
  ds_read_b128 a[204:207], v46 offset:3296
  ds_read_b128 a[208:211], v46 offset:3360
  ds_read_b128 a[212:215], v46 offset:3424
  ds_read_b128 a[216:219], v46 offset:3488
  ds_read_b128 a[220:223], v46 offset:3552
  s_waitcnt lgkmcnt(4)
  ds_read_b128 a[224:227], v46 offset:3616
  ds_read_b128 a[228:231], v46 offset:3680
  ds_read_b128 a[232:235], v46 offset:3744
  ds_read_b128 a[236:239], v46 offset:3808
  ds_read_b128 a[240:243], v46 offset:3872
  ds_read_b128 a[244:247], v46 offset:3936
  ds_read_b128 a[248:251], v46 offset:4000
  ds_read_b128 a[252:255], v46 offset:4064
  s_waitcnt lgkmcnt(4)
  v_lshlrev_b32 v49, 4, v47
  v_add_u32 v49, v49, v4
  v_sub_u32 v49, 2047, v49
  v_lshl_add_u32 v49, v48, 3, v49
  v_and_b32 v50, 1, v49
  v_lshrrev_b32 v49, 1, v49
  v_lshlrev_b32 v49, 2, v49
  v_mul_u32_u24 v50, 4224, v50
  v_add3_u32 v49, v49, v50, s17
  v_add_u32 v49, 4608, v49
  v_subrev_u32 v52, 896, v49
  v_subrev_u32 v53, 1856, v49
  v_subrev_u32 v54, 2816, v49
  v_subrev_u32 v55, 3776, v49
  v_subrev_u32 v56, 4736, v49
  s_waitcnt lgkmcnt(0)
  ds_read2_b32 v[92:93], v52 offset0:224 offset1:225
  ds_read2_b32 v[94:95], v52 offset0:226 offset1:227
  ds_read2_b32 v[96:97], v52 offset0:208 offset1:209
  ds_read2_b32 v[98:99], v52 offset0:210 offset1:211
  ds_read2_b32 v[100:101], v52 offset0:192 offset1:193
  ds_read2_b32 v[102:103], v52 offset0:194 offset1:195
  ds_read2_b32 v[104:105], v52 offset0:176 offset1:177
  ds_read2_b32 v[106:107], v52 offset0:178 offset1:179
  s_waitcnt lgkmcnt(6)
  v_mfma_f32_16x16x32_bf16 v[60:63], v[92:95], a[28:31], 0
  v_mfma_f32_16x16x32_bf16 v[64:67], v[92:95], a[60:63], 0
  v_mfma_f32_16x16x32_bf16 v[68:71], v[92:95], a[92:95], 0
  v_mfma_f32_16x16x32_bf16 v[72:75], v[92:95], a[124:127], 0
  v_mfma_f32_16x16x32_bf16 v[76:79], v[92:95], a[156:159], 0
  v_mfma_f32_16x16x32_bf16 v[80:83], v[92:95], a[188:191], 0
  v_mfma_f32_16x16x32_bf16 v[84:87], v[92:95], a[220:223], 0
  v_mfma_f32_16x16x32_bf16 v[88:91], v[92:95], a[252:255], 0
  ds_read2_b32 v[92:93], v52 offset0:160 offset1:161
  ds_read2_b32 v[94:95], v52 offset0:162 offset1:163
  s_waitcnt lgkmcnt(6)
  v_mfma_f32_16x16x32_bf16 v[60:63], v[96:99], a[24:27], v[60:63]
  v_mfma_f32_16x16x32_bf16 v[64:67], v[96:99], a[56:59], v[64:67]
  v_mfma_f32_16x16x32_bf16 v[68:71], v[96:99], a[88:91], v[68:71]
  v_mfma_f32_16x16x32_bf16 v[72:75], v[96:99], a[120:123], v[72:75]
  v_mfma_f32_16x16x32_bf16 v[76:79], v[96:99], a[152:155], v[76:79]
  v_mfma_f32_16x16x32_bf16 v[80:83], v[96:99], a[184:187], v[80:83]
  v_mfma_f32_16x16x32_bf16 v[84:87], v[96:99], a[216:219], v[84:87]
  v_mfma_f32_16x16x32_bf16 v[88:91], v[96:99], a[248:251], v[88:91]
  ds_read2_b32 v[96:97], v52 offset0:144 offset1:145
  ds_read2_b32 v[98:99], v52 offset0:146 offset1:147
  s_waitcnt lgkmcnt(6)
  v_mfma_f32_16x16x32_bf16 v[60:63], v[100:103], a[20:23], v[60:63]
  v_mfma_f32_16x16x32_bf16 v[64:67], v[100:103], a[52:55], v[64:67]
  v_mfma_f32_16x16x32_bf16 v[68:71], v[100:103], a[84:87], v[68:71]
  v_mfma_f32_16x16x32_bf16 v[72:75], v[100:103], a[116:119], v[72:75]
  v_mfma_f32_16x16x32_bf16 v[76:79], v[100:103], a[148:151], v[76:79]
  v_mfma_f32_16x16x32_bf16 v[80:83], v[100:103], a[180:183], v[80:83]
  v_mfma_f32_16x16x32_bf16 v[84:87], v[100:103], a[212:215], v[84:87]
  v_mfma_f32_16x16x32_bf16 v[88:91], v[100:103], a[244:247], v[88:91]
  ds_read2_b32 v[100:101], v52 offset0:128 offset1:129
  ds_read2_b32 v[102:103], v52 offset0:130 offset1:131
  s_waitcnt lgkmcnt(6)
  v_mfma_f32_16x16x32_bf16 v[60:63], v[104:107], a[16:19], v[60:63]
  v_mfma_f32_16x16x32_bf16 v[64:67], v[104:107], a[48:51], v[64:67]
  v_mfma_f32_16x16x32_bf16 v[68:71], v[104:107], a[80:83], v[68:71]
  v_mfma_f32_16x16x32_bf16 v[72:75], v[104:107], a[112:115], v[72:75]
  v_mfma_f32_16x16x32_bf16 v[76:79], v[104:107], a[144:147], v[76:79]
  v_mfma_f32_16x16x32_bf16 v[80:83], v[104:107], a[176:179], v[80:83]
  v_mfma_f32_16x16x32_bf16 v[84:87], v[104:107], a[208:211], v[84:87]
  v_mfma_f32_16x16x32_bf16 v[88:91], v[104:107], a[240:243], v[88:91]
  ds_read2_b32 v[104:105], v52 offset0:112 offset1:113
  ds_read2_b32 v[106:107], v52 offset0:114 offset1:115
  s_waitcnt lgkmcnt(6)
  v_mfma_f32_16x16x32_bf16 v[60:63], v[92:95], a[12:15], v[60:63]
  v_mfma_f32_16x16x32_bf16 v[64:67], v[92:95], a[44:47], v[64:67]
  v_mfma_f32_16x16x32_bf16 v[68:71], v[92:95], a[76:79], v[68:71]
  v_mfma_f32_16x16x32_bf16 v[72:75], v[92:95], a[108:111], v[72:75]
  v_mfma_f32_16x16x32_bf16 v[76:79], v[92:95], a[140:143], v[76:79]
  v_mfma_f32_16x16x32_bf16 v[80:83], v[92:95], a[172:175], v[80:83]
  v_mfma_f32_16x16x32_bf16 v[84:87], v[92:95], a[204:207], v[84:87]
  v_mfma_f32_16x16x32_bf16 v[88:91], v[92:95], a[236:239], v[88:91]
  ds_read2_b32 v[92:93], v52 offset0:96 offset1:97
  ds_read2_b32 v[94:95], v52 offset0:98 offset1:99
  s_waitcnt lgkmcnt(6)
  v_mfma_f32_16x16x32_bf16 v[60:63], v[96:99], a[8:11], v[60:63]
  v_mfma_f32_16x16x32_bf16 v[64:67], v[96:99], a[40:43], v[64:67]
  v_mfma_f32_16x16x32_bf16 v[68:71], v[96:99], a[72:75], v[68:71]
  v_mfma_f32_16x16x32_bf16 v[72:75], v[96:99], a[104:107], v[72:75]
  v_mfma_f32_16x16x32_bf16 v[76:79], v[96:99], a[136:139], v[76:79]
  v_mfma_f32_16x16x32_bf16 v[80:83], v[96:99], a[168:171], v[80:83]
  v_mfma_f32_16x16x32_bf16 v[84:87], v[96:99], a[200:203], v[84:87]
  v_mfma_f32_16x16x32_bf16 v[88:91], v[96:99], a[232:235], v[88:91]
  ds_read2_b32 v[96:97], v52 offset0:80 offset1:81
  ds_read2_b32 v[98:99], v52 offset0:82 offset1:83
  s_waitcnt lgkmcnt(6)
  v_mfma_f32_16x16x32_bf16 v[60:63], v[100:103], a[4:7], v[60:63]
  v_mfma_f32_16x16x32_bf16 v[64:67], v[100:103], a[36:39], v[64:67]
  v_mfma_f32_16x16x32_bf16 v[68:71], v[100:103], a[68:71], v[68:71]
  v_mfma_f32_16x16x32_bf16 v[72:75], v[100:103], a[100:103], v[72:75]
  v_mfma_f32_16x16x32_bf16 v[76:79], v[100:103], a[132:135], v[76:79]
  v_mfma_f32_16x16x32_bf16 v[80:83], v[100:103], a[164:167], v[80:83]
  v_mfma_f32_16x16x32_bf16 v[84:87], v[100:103], a[196:199], v[84:87]
  v_mfma_f32_16x16x32_bf16 v[88:91], v[100:103], a[228:231], v[88:91]
  ds_read2_b32 v[100:101], v52 offset0:64 offset1:65
  ds_read2_b32 v[102:103], v52 offset0:66 offset1:67
  s_waitcnt lgkmcnt(6)
  v_mfma_f32_16x16x32_bf16 v[60:63], v[104:107], a[0:3], v[60:63]
  v_mfma_f32_16x16x32_bf16 v[64:67], v[104:107], a[32:35], v[64:67]
  v_mfma_f32_16x16x32_bf16 v[68:71], v[104:107], a[64:67], v[68:71]
  v_mfma_f32_16x16x32_bf16 v[72:75], v[104:107], a[96:99], v[72:75]
  v_mfma_f32_16x16x32_bf16 v[76:79], v[104:107], a[128:131], v[76:79]
  v_mfma_f32_16x16x32_bf16 v[80:83], v[104:107], a[160:163], v[80:83]
  v_mfma_f32_16x16x32_bf16 v[84:87], v[104:107], a[192:195], v[84:87]
  v_mfma_f32_16x16x32_bf16 v[88:91], v[104:107], a[224:227], v[88:91]
  ds_read2_b32 v[104:105], v52 offset0:48 offset1:49
  ds_read2_b32 v[106:107], v52 offset0:50 offset1:51
  s_waitcnt lgkmcnt(6)
  v_mfma_f32_16x16x32_bf16 v[64:67], v[92:95], a[28:31], v[64:67]
  v_mfma_f32_16x16x32_bf16 v[68:71], v[92:95], a[60:63], v[68:71]
  v_mfma_f32_16x16x32_bf16 v[72:75], v[92:95], a[92:95], v[72:75]
  v_mfma_f32_16x16x32_bf16 v[76:79], v[92:95], a[124:127], v[76:79]
  v_mfma_f32_16x16x32_bf16 v[80:83], v[92:95], a[156:159], v[80:83]
  v_mfma_f32_16x16x32_bf16 v[84:87], v[92:95], a[188:191], v[84:87]
  v_mfma_f32_16x16x32_bf16 v[88:91], v[92:95], a[220:223], v[88:91]
  ds_read2_b32 v[92:93], v52 offset0:32 offset1:33
  ds_read2_b32 v[94:95], v52 offset0:34 offset1:35
  s_waitcnt lgkmcnt(6)
  v_mfma_f32_16x16x32_bf16 v[64:67], v[96:99], a[24:27], v[64:67]
  v_mfma_f32_16x16x32_bf16 v[68:71], v[96:99], a[56:59], v[68:71]
  v_mfma_f32_16x16x32_bf16 v[72:75], v[96:99], a[88:91], v[72:75]
  v_mfma_f32_16x16x32_bf16 v[76:79], v[96:99], a[120:123], v[76:79]
  v_mfma_f32_16x16x32_bf16 v[80:83], v[96:99], a[152:155], v[80:83]
  v_mfma_f32_16x16x32_bf16 v[84:87], v[96:99], a[184:187], v[84:87]
  v_mfma_f32_16x16x32_bf16 v[88:91], v[96:99], a[216:219], v[88:91]
  ds_read2_b32 v[96:97], v52 offset0:16 offset1:17
  ds_read2_b32 v[98:99], v52 offset0:18 offset1:19
  s_waitcnt lgkmcnt(6)
  v_mfma_f32_16x16x32_bf16 v[64:67], v[100:103], a[20:23], v[64:67]
  v_mfma_f32_16x16x32_bf16 v[68:71], v[100:103], a[52:55], v[68:71]
  v_mfma_f32_16x16x32_bf16 v[72:75], v[100:103], a[84:87], v[72:75]
  v_mfma_f32_16x16x32_bf16 v[76:79], v[100:103], a[116:119], v[76:79]
  v_mfma_f32_16x16x32_bf16 v[80:83], v[100:103], a[148:151], v[80:83]
  v_mfma_f32_16x16x32_bf16 v[84:87], v[100:103], a[180:183], v[84:87]
  v_mfma_f32_16x16x32_bf16 v[88:91], v[100:103], a[212:215], v[88:91]
  ds_read2_b32 v[100:101], v52 offset0:0 offset1:1
  ds_read2_b32 v[102:103], v52 offset0:2 offset1:3
  s_waitcnt lgkmcnt(6)
  v_mfma_f32_16x16x32_bf16 v[64:67], v[104:107], a[16:19], v[64:67]
  v_mfma_f32_16x16x32_bf16 v[68:71], v[104:107], a[48:51], v[68:71]
  v_mfma_f32_16x16x32_bf16 v[72:75], v[104:107], a[80:83], v[72:75]
  v_mfma_f32_16x16x32_bf16 v[76:79], v[104:107], a[112:115], v[76:79]
  v_mfma_f32_16x16x32_bf16 v[80:83], v[104:107], a[144:147], v[80:83]
  v_mfma_f32_16x16x32_bf16 v[84:87], v[104:107], a[176:179], v[84:87]
  v_mfma_f32_16x16x32_bf16 v[88:91], v[104:107], a[208:211], v[88:91]
  ds_read2_b32 v[104:105], v53 offset0:224 offset1:225
  ds_read2_b32 v[106:107], v53 offset0:226 offset1:227
  s_waitcnt lgkmcnt(6)
  v_mfma_f32_16x16x32_bf16 v[64:67], v[92:95], a[12:15], v[64:67]
  v_mfma_f32_16x16x32_bf16 v[68:71], v[92:95], a[44:47], v[68:71]
  v_mfma_f32_16x16x32_bf16 v[72:75], v[92:95], a[76:79], v[72:75]
  v_mfma_f32_16x16x32_bf16 v[76:79], v[92:95], a[108:111], v[76:79]
  v_mfma_f32_16x16x32_bf16 v[80:83], v[92:95], a[140:143], v[80:83]
  v_mfma_f32_16x16x32_bf16 v[84:87], v[92:95], a[172:175], v[84:87]
  v_mfma_f32_16x16x32_bf16 v[88:91], v[92:95], a[204:207], v[88:91]
  ds_read2_b32 v[92:93], v53 offset0:208 offset1:209
  ds_read2_b32 v[94:95], v53 offset0:210 offset1:211
  s_waitcnt lgkmcnt(6)
  v_mfma_f32_16x16x32_bf16 v[64:67], v[96:99], a[8:11], v[64:67]
  v_mfma_f32_16x16x32_bf16 v[68:71], v[96:99], a[40:43], v[68:71]
  v_mfma_f32_16x16x32_bf16 v[72:75], v[96:99], a[72:75], v[72:75]
  v_mfma_f32_16x16x32_bf16 v[76:79], v[96:99], a[104:107], v[76:79]
  v_mfma_f32_16x16x32_bf16 v[80:83], v[96:99], a[136:139], v[80:83]
  v_mfma_f32_16x16x32_bf16 v[84:87], v[96:99], a[168:171], v[84:87]
  v_mfma_f32_16x16x32_bf16 v[88:91], v[96:99], a[200:203], v[88:91]
  ds_read2_b32 v[96:97], v53 offset0:192 offset1:193
  ds_read2_b32 v[98:99], v53 offset0:194 offset1:195
  s_waitcnt lgkmcnt(6)
  v_mfma_f32_16x16x32_bf16 v[64:67], v[100:103], a[4:7], v[64:67]
  v_mfma_f32_16x16x32_bf16 v[68:71], v[100:103], a[36:39], v[68:71]
  v_mfma_f32_16x16x32_bf16 v[72:75], v[100:103], a[68:71], v[72:75]
  v_mfma_f32_16x16x32_bf16 v[76:79], v[100:103], a[100:103], v[76:79]
  v_mfma_f32_16x16x32_bf16 v[80:83], v[100:103], a[132:135], v[80:83]
  v_mfma_f32_16x16x32_bf16 v[84:87], v[100:103], a[164:167], v[84:87]
  v_mfma_f32_16x16x32_bf16 v[88:91], v[100:103], a[196:199], v[88:91]
  ds_read2_b32 v[100:101], v53 offset0:176 offset1:177
  ds_read2_b32 v[102:103], v53 offset0:178 offset1:179
  s_waitcnt lgkmcnt(6)
  v_mfma_f32_16x16x32_bf16 v[64:67], v[104:107], a[0:3], v[64:67]
  v_mfma_f32_16x16x32_bf16 v[68:71], v[104:107], a[32:35], v[68:71]
  v_mfma_f32_16x16x32_bf16 v[72:75], v[104:107], a[64:67], v[72:75]
  v_mfma_f32_16x16x32_bf16 v[76:79], v[104:107], a[96:99], v[76:79]
  v_mfma_f32_16x16x32_bf16 v[80:83], v[104:107], a[128:131], v[80:83]
  v_mfma_f32_16x16x32_bf16 v[84:87], v[104:107], a[160:163], v[84:87]
  v_mfma_f32_16x16x32_bf16 v[88:91], v[104:107], a[192:195], v[88:91]
  ds_read2_b32 v[104:105], v53 offset0:160 offset1:161
  ds_read2_b32 v[106:107], v53 offset0:162 offset1:163
  s_waitcnt lgkmcnt(6)
  v_mfma_f32_16x16x32_bf16 v[68:71], v[92:95], a[28:31], v[68:71]
  v_mfma_f32_16x16x32_bf16 v[72:75], v[92:95], a[60:63], v[72:75]
  v_mfma_f32_16x16x32_bf16 v[76:79], v[92:95], a[92:95], v[76:79]
  v_mfma_f32_16x16x32_bf16 v[80:83], v[92:95], a[124:127], v[80:83]
  v_mfma_f32_16x16x32_bf16 v[84:87], v[92:95], a[156:159], v[84:87]
  v_mfma_f32_16x16x32_bf16 v[88:91], v[92:95], a[188:191], v[88:91]
  ds_read2_b32 v[92:93], v53 offset0:144 offset1:145
  ds_read2_b32 v[94:95], v53 offset0:146 offset1:147
  s_waitcnt lgkmcnt(6)
  v_mfma_f32_16x16x32_bf16 v[68:71], v[96:99], a[24:27], v[68:71]
  v_mfma_f32_16x16x32_bf16 v[72:75], v[96:99], a[56:59], v[72:75]
  v_mfma_f32_16x16x32_bf16 v[76:79], v[96:99], a[88:91], v[76:79]
  v_mfma_f32_16x16x32_bf16 v[80:83], v[96:99], a[120:123], v[80:83]
  v_mfma_f32_16x16x32_bf16 v[84:87], v[96:99], a[152:155], v[84:87]
  v_mfma_f32_16x16x32_bf16 v[88:91], v[96:99], a[184:187], v[88:91]
  ds_read2_b32 v[96:97], v53 offset0:128 offset1:129
  ds_read2_b32 v[98:99], v53 offset0:130 offset1:131
  s_waitcnt lgkmcnt(6)
  v_mfma_f32_16x16x32_bf16 v[68:71], v[100:103], a[20:23], v[68:71]
  v_mfma_f32_16x16x32_bf16 v[72:75], v[100:103], a[52:55], v[72:75]
  v_mfma_f32_16x16x32_bf16 v[76:79], v[100:103], a[84:87], v[76:79]
  v_mfma_f32_16x16x32_bf16 v[80:83], v[100:103], a[116:119], v[80:83]
  v_mfma_f32_16x16x32_bf16 v[84:87], v[100:103], a[148:151], v[84:87]
  v_mfma_f32_16x16x32_bf16 v[88:91], v[100:103], a[180:183], v[88:91]
  ds_read2_b32 v[100:101], v53 offset0:112 offset1:113
  ds_read2_b32 v[102:103], v53 offset0:114 offset1:115
  s_waitcnt lgkmcnt(6)
  v_mfma_f32_16x16x32_bf16 v[68:71], v[104:107], a[16:19], v[68:71]
  v_mfma_f32_16x16x32_bf16 v[72:75], v[104:107], a[48:51], v[72:75]
  v_mfma_f32_16x16x32_bf16 v[76:79], v[104:107], a[80:83], v[76:79]
  v_mfma_f32_16x16x32_bf16 v[80:83], v[104:107], a[112:115], v[80:83]
  v_mfma_f32_16x16x32_bf16 v[84:87], v[104:107], a[144:147], v[84:87]
  v_mfma_f32_16x16x32_bf16 v[88:91], v[104:107], a[176:179], v[88:91]
  ds_read2_b32 v[104:105], v53 offset0:96 offset1:97
  ds_read2_b32 v[106:107], v53 offset0:98 offset1:99
  s_waitcnt lgkmcnt(6)
  v_mfma_f32_16x16x32_bf16 v[68:71], v[92:95], a[12:15], v[68:71]
  v_mfma_f32_16x16x32_bf16 v[72:75], v[92:95], a[44:47], v[72:75]
  v_mfma_f32_16x16x32_bf16 v[76:79], v[92:95], a[76:79], v[76:79]
  v_mfma_f32_16x16x32_bf16 v[80:83], v[92:95], a[108:111], v[80:83]
  v_mfma_f32_16x16x32_bf16 v[84:87], v[92:95], a[140:143], v[84:87]
  v_mfma_f32_16x16x32_bf16 v[88:91], v[92:95], a[172:175], v[88:91]
  ds_read2_b32 v[92:93], v53 offset0:80 offset1:81
  ds_read2_b32 v[94:95], v53 offset0:82 offset1:83
  s_waitcnt lgkmcnt(6)
  v_mfma_f32_16x16x32_bf16 v[68:71], v[96:99], a[8:11], v[68:71]
  v_mfma_f32_16x16x32_bf16 v[72:75], v[96:99], a[40:43], v[72:75]
  v_mfma_f32_16x16x32_bf16 v[76:79], v[96:99], a[72:75], v[76:79]
  v_mfma_f32_16x16x32_bf16 v[80:83], v[96:99], a[104:107], v[80:83]
  v_mfma_f32_16x16x32_bf16 v[84:87], v[96:99], a[136:139], v[84:87]
  v_mfma_f32_16x16x32_bf16 v[88:91], v[96:99], a[168:171], v[88:91]
  ds_read2_b32 v[96:97], v53 offset0:64 offset1:65
  ds_read2_b32 v[98:99], v53 offset0:66 offset1:67
  s_waitcnt lgkmcnt(6)
  v_mfma_f32_16x16x32_bf16 v[68:71], v[100:103], a[4:7], v[68:71]
  v_mfma_f32_16x16x32_bf16 v[72:75], v[100:103], a[36:39], v[72:75]
  v_mfma_f32_16x16x32_bf16 v[76:79], v[100:103], a[68:71], v[76:79]
  v_mfma_f32_16x16x32_bf16 v[80:83], v[100:103], a[100:103], v[80:83]
  v_mfma_f32_16x16x32_bf16 v[84:87], v[100:103], a[132:135], v[84:87]
  v_mfma_f32_16x16x32_bf16 v[88:91], v[100:103], a[164:167], v[88:91]
  ds_read2_b32 v[100:101], v53 offset0:48 offset1:49
  ds_read2_b32 v[102:103], v53 offset0:50 offset1:51
  s_waitcnt lgkmcnt(6)
  v_mfma_f32_16x16x32_bf16 v[68:71], v[104:107], a[0:3], v[68:71]
  v_mfma_f32_16x16x32_bf16 v[72:75], v[104:107], a[32:35], v[72:75]
  v_mfma_f32_16x16x32_bf16 v[76:79], v[104:107], a[64:67], v[76:79]
  v_mfma_f32_16x16x32_bf16 v[80:83], v[104:107], a[96:99], v[80:83]
  v_mfma_f32_16x16x32_bf16 v[84:87], v[104:107], a[128:131], v[84:87]
  v_mfma_f32_16x16x32_bf16 v[88:91], v[104:107], a[160:163], v[88:91]
  ds_read2_b32 v[104:105], v53 offset0:32 offset1:33
  ds_read2_b32 v[106:107], v53 offset0:34 offset1:35
  s_waitcnt lgkmcnt(6)
  v_mfma_f32_16x16x32_bf16 v[72:75], v[92:95], a[28:31], v[72:75]
  v_mfma_f32_16x16x32_bf16 v[76:79], v[92:95], a[60:63], v[76:79]
  v_mfma_f32_16x16x32_bf16 v[80:83], v[92:95], a[92:95], v[80:83]
  v_mfma_f32_16x16x32_bf16 v[84:87], v[92:95], a[124:127], v[84:87]
  v_mfma_f32_16x16x32_bf16 v[88:91], v[92:95], a[156:159], v[88:91]
  ds_read2_b32 v[92:93], v53 offset0:16 offset1:17
  ds_read2_b32 v[94:95], v53 offset0:18 offset1:19
  s_waitcnt lgkmcnt(6)
  v_mfma_f32_16x16x32_bf16 v[72:75], v[96:99], a[24:27], v[72:75]
  v_mfma_f32_16x16x32_bf16 v[76:79], v[96:99], a[56:59], v[76:79]
  v_mfma_f32_16x16x32_bf16 v[80:83], v[96:99], a[88:91], v[80:83]
  v_mfma_f32_16x16x32_bf16 v[84:87], v[96:99], a[120:123], v[84:87]
  v_mfma_f32_16x16x32_bf16 v[88:91], v[96:99], a[152:155], v[88:91]
  ds_read2_b32 v[96:97], v53 offset0:0 offset1:1
  ds_read2_b32 v[98:99], v53 offset0:2 offset1:3
  s_waitcnt lgkmcnt(6)
  v_mfma_f32_16x16x32_bf16 v[72:75], v[100:103], a[20:23], v[72:75]
  v_mfma_f32_16x16x32_bf16 v[76:79], v[100:103], a[52:55], v[76:79]
  v_mfma_f32_16x16x32_bf16 v[80:83], v[100:103], a[84:87], v[80:83]
  v_mfma_f32_16x16x32_bf16 v[84:87], v[100:103], a[116:119], v[84:87]
  v_mfma_f32_16x16x32_bf16 v[88:91], v[100:103], a[148:151], v[88:91]
  ds_read2_b32 v[100:101], v54 offset0:224 offset1:225
  ds_read2_b32 v[102:103], v54 offset0:226 offset1:227
  s_waitcnt lgkmcnt(6)
  v_mfma_f32_16x16x32_bf16 v[72:75], v[104:107], a[16:19], v[72:75]
  v_mfma_f32_16x16x32_bf16 v[76:79], v[104:107], a[48:51], v[76:79]
  v_mfma_f32_16x16x32_bf16 v[80:83], v[104:107], a[80:83], v[80:83]
  v_mfma_f32_16x16x32_bf16 v[84:87], v[104:107], a[112:115], v[84:87]
  v_mfma_f32_16x16x32_bf16 v[88:91], v[104:107], a[144:147], v[88:91]
  ds_read2_b32 v[104:105], v54 offset0:208 offset1:209
  ds_read2_b32 v[106:107], v54 offset0:210 offset1:211
  s_waitcnt lgkmcnt(6)
  v_mfma_f32_16x16x32_bf16 v[72:75], v[92:95], a[12:15], v[72:75]
  v_mfma_f32_16x16x32_bf16 v[76:79], v[92:95], a[44:47], v[76:79]
  v_mfma_f32_16x16x32_bf16 v[80:83], v[92:95], a[76:79], v[80:83]
  v_mfma_f32_16x16x32_bf16 v[84:87], v[92:95], a[108:111], v[84:87]
  v_mfma_f32_16x16x32_bf16 v[88:91], v[92:95], a[140:143], v[88:91]
  ds_read2_b32 v[92:93], v54 offset0:192 offset1:193
  ds_read2_b32 v[94:95], v54 offset0:194 offset1:195
  s_waitcnt lgkmcnt(6)
  v_mfma_f32_16x16x32_bf16 v[72:75], v[96:99], a[8:11], v[72:75]
  v_mfma_f32_16x16x32_bf16 v[76:79], v[96:99], a[40:43], v[76:79]
  v_mfma_f32_16x16x32_bf16 v[80:83], v[96:99], a[72:75], v[80:83]
  v_mfma_f32_16x16x32_bf16 v[84:87], v[96:99], a[104:107], v[84:87]
  v_mfma_f32_16x16x32_bf16 v[88:91], v[96:99], a[136:139], v[88:91]
  ds_read2_b32 v[96:97], v54 offset0:176 offset1:177
  ds_read2_b32 v[98:99], v54 offset0:178 offset1:179
  s_waitcnt lgkmcnt(6)
  v_mfma_f32_16x16x32_bf16 v[72:75], v[100:103], a[4:7], v[72:75]
  v_mfma_f32_16x16x32_bf16 v[76:79], v[100:103], a[36:39], v[76:79]
  v_mfma_f32_16x16x32_bf16 v[80:83], v[100:103], a[68:71], v[80:83]
  v_mfma_f32_16x16x32_bf16 v[84:87], v[100:103], a[100:103], v[84:87]
  v_mfma_f32_16x16x32_bf16 v[88:91], v[100:103], a[132:135], v[88:91]
  ds_read2_b32 v[100:101], v54 offset0:160 offset1:161
  ds_read2_b32 v[102:103], v54 offset0:162 offset1:163
  s_waitcnt lgkmcnt(6)
  v_mfma_f32_16x16x32_bf16 v[72:75], v[104:107], a[0:3], v[72:75]
  v_mfma_f32_16x16x32_bf16 v[76:79], v[104:107], a[32:35], v[76:79]
  v_mfma_f32_16x16x32_bf16 v[80:83], v[104:107], a[64:67], v[80:83]
  v_mfma_f32_16x16x32_bf16 v[84:87], v[104:107], a[96:99], v[84:87]
  v_mfma_f32_16x16x32_bf16 v[88:91], v[104:107], a[128:131], v[88:91]
  ds_read2_b32 v[104:105], v54 offset0:144 offset1:145
  ds_read2_b32 v[106:107], v54 offset0:146 offset1:147
  s_waitcnt lgkmcnt(6)
  v_mfma_f32_16x16x32_bf16 v[76:79], v[92:95], a[28:31], v[76:79]
  v_mfma_f32_16x16x32_bf16 v[80:83], v[92:95], a[60:63], v[80:83]
  v_mfma_f32_16x16x32_bf16 v[84:87], v[92:95], a[92:95], v[84:87]
  v_mfma_f32_16x16x32_bf16 v[88:91], v[92:95], a[124:127], v[88:91]
  ds_read2_b32 v[92:93], v54 offset0:128 offset1:129
  ds_read2_b32 v[94:95], v54 offset0:130 offset1:131
  s_waitcnt lgkmcnt(6)
  v_mfma_f32_16x16x32_bf16 v[76:79], v[96:99], a[24:27], v[76:79]
  v_mfma_f32_16x16x32_bf16 v[80:83], v[96:99], a[56:59], v[80:83]
  v_mfma_f32_16x16x32_bf16 v[84:87], v[96:99], a[88:91], v[84:87]
  v_mfma_f32_16x16x32_bf16 v[88:91], v[96:99], a[120:123], v[88:91]
  ds_read2_b32 v[96:97], v54 offset0:112 offset1:113
  ds_read2_b32 v[98:99], v54 offset0:114 offset1:115
  s_waitcnt lgkmcnt(6)
  v_mfma_f32_16x16x32_bf16 v[76:79], v[100:103], a[20:23], v[76:79]
  v_mfma_f32_16x16x32_bf16 v[80:83], v[100:103], a[52:55], v[80:83]
  v_mfma_f32_16x16x32_bf16 v[84:87], v[100:103], a[84:87], v[84:87]
  v_mfma_f32_16x16x32_bf16 v[88:91], v[100:103], a[116:119], v[88:91]
  ds_read2_b32 v[100:101], v54 offset0:96 offset1:97
  ds_read2_b32 v[102:103], v54 offset0:98 offset1:99
  s_waitcnt lgkmcnt(6)
  v_mfma_f32_16x16x32_bf16 v[76:79], v[104:107], a[16:19], v[76:79]
  v_mfma_f32_16x16x32_bf16 v[80:83], v[104:107], a[48:51], v[80:83]
  v_mfma_f32_16x16x32_bf16 v[84:87], v[104:107], a[80:83], v[84:87]
  v_mfma_f32_16x16x32_bf16 v[88:91], v[104:107], a[112:115], v[88:91]
  ds_read2_b32 v[104:105], v54 offset0:80 offset1:81
  ds_read2_b32 v[106:107], v54 offset0:82 offset1:83
  s_waitcnt lgkmcnt(6)
  v_mfma_f32_16x16x32_bf16 v[76:79], v[92:95], a[12:15], v[76:79]
  v_mfma_f32_16x16x32_bf16 v[80:83], v[92:95], a[44:47], v[80:83]
  v_mfma_f32_16x16x32_bf16 v[84:87], v[92:95], a[76:79], v[84:87]
  v_mfma_f32_16x16x32_bf16 v[88:91], v[92:95], a[108:111], v[88:91]
  ds_read2_b32 v[92:93], v54 offset0:64 offset1:65
  ds_read2_b32 v[94:95], v54 offset0:66 offset1:67
  s_waitcnt lgkmcnt(6)
  v_mfma_f32_16x16x32_bf16 v[76:79], v[96:99], a[8:11], v[76:79]
  v_mfma_f32_16x16x32_bf16 v[80:83], v[96:99], a[40:43], v[80:83]
  v_mfma_f32_16x16x32_bf16 v[84:87], v[96:99], a[72:75], v[84:87]
  v_mfma_f32_16x16x32_bf16 v[88:91], v[96:99], a[104:107], v[88:91]
  ds_read2_b32 v[96:97], v54 offset0:48 offset1:49
  ds_read2_b32 v[98:99], v54 offset0:50 offset1:51
  s_waitcnt lgkmcnt(6)
  v_mfma_f32_16x16x32_bf16 v[76:79], v[100:103], a[4:7], v[76:79]
  v_mfma_f32_16x16x32_bf16 v[80:83], v[100:103], a[36:39], v[80:83]
  v_mfma_f32_16x16x32_bf16 v[84:87], v[100:103], a[68:71], v[84:87]
  v_mfma_f32_16x16x32_bf16 v[88:91], v[100:103], a[100:103], v[88:91]
  ds_read2_b32 v[100:101], v54 offset0:32 offset1:33
  ds_read2_b32 v[102:103], v54 offset0:34 offset1:35
  s_waitcnt lgkmcnt(6)
  v_mfma_f32_16x16x32_bf16 v[76:79], v[104:107], a[0:3], v[76:79]
  v_mfma_f32_16x16x32_bf16 v[80:83], v[104:107], a[32:35], v[80:83]
  v_mfma_f32_16x16x32_bf16 v[84:87], v[104:107], a[64:67], v[84:87]
  v_mfma_f32_16x16x32_bf16 v[88:91], v[104:107], a[96:99], v[88:91]
  ds_read2_b32 v[104:105], v54 offset0:16 offset1:17
  ds_read2_b32 v[106:107], v54 offset0:18 offset1:19
  s_waitcnt lgkmcnt(6)
  v_mfma_f32_16x16x32_bf16 v[80:83], v[92:95], a[28:31], v[80:83]
  v_mfma_f32_16x16x32_bf16 v[84:87], v[92:95], a[60:63], v[84:87]
  v_mfma_f32_16x16x32_bf16 v[88:91], v[92:95], a[92:95], v[88:91]
  ds_read2_b32 v[92:93], v54 offset0:0 offset1:1
  ds_read2_b32 v[94:95], v54 offset0:2 offset1:3
  s_waitcnt lgkmcnt(6)
  v_mfma_f32_16x16x32_bf16 v[80:83], v[96:99], a[24:27], v[80:83]
  v_mfma_f32_16x16x32_bf16 v[84:87], v[96:99], a[56:59], v[84:87]
  v_mfma_f32_16x16x32_bf16 v[88:91], v[96:99], a[88:91], v[88:91]
  ds_read2_b32 v[96:97], v55 offset0:224 offset1:225
  ds_read2_b32 v[98:99], v55 offset0:226 offset1:227
  s_waitcnt lgkmcnt(6)
  v_mfma_f32_16x16x32_bf16 v[80:83], v[100:103], a[20:23], v[80:83]
  v_mfma_f32_16x16x32_bf16 v[84:87], v[100:103], a[52:55], v[84:87]
  v_mfma_f32_16x16x32_bf16 v[88:91], v[100:103], a[84:87], v[88:91]
  ds_read2_b32 v[100:101], v55 offset0:208 offset1:209
  ds_read2_b32 v[102:103], v55 offset0:210 offset1:211
  s_waitcnt lgkmcnt(6)
  v_mfma_f32_16x16x32_bf16 v[80:83], v[104:107], a[16:19], v[80:83]
  v_mfma_f32_16x16x32_bf16 v[84:87], v[104:107], a[48:51], v[84:87]
  v_mfma_f32_16x16x32_bf16 v[88:91], v[104:107], a[80:83], v[88:91]
  ds_read2_b32 v[104:105], v55 offset0:192 offset1:193
  ds_read2_b32 v[106:107], v55 offset0:194 offset1:195
  s_waitcnt lgkmcnt(6)
  v_mfma_f32_16x16x32_bf16 v[80:83], v[92:95], a[12:15], v[80:83]
  v_mfma_f32_16x16x32_bf16 v[84:87], v[92:95], a[44:47], v[84:87]
  v_mfma_f32_16x16x32_bf16 v[88:91], v[92:95], a[76:79], v[88:91]
  ds_read2_b32 v[92:93], v55 offset0:176 offset1:177
  ds_read2_b32 v[94:95], v55 offset0:178 offset1:179
  s_waitcnt lgkmcnt(6)
  v_mfma_f32_16x16x32_bf16 v[80:83], v[96:99], a[8:11], v[80:83]
  v_mfma_f32_16x16x32_bf16 v[84:87], v[96:99], a[40:43], v[84:87]
  v_mfma_f32_16x16x32_bf16 v[88:91], v[96:99], a[72:75], v[88:91]
  ds_read2_b32 v[96:97], v55 offset0:160 offset1:161
  ds_read2_b32 v[98:99], v55 offset0:162 offset1:163
  s_waitcnt lgkmcnt(6)
  v_mfma_f32_16x16x32_bf16 v[80:83], v[100:103], a[4:7], v[80:83]
  v_mfma_f32_16x16x32_bf16 v[84:87], v[100:103], a[36:39], v[84:87]
  v_mfma_f32_16x16x32_bf16 v[88:91], v[100:103], a[68:71], v[88:91]
  ds_read2_b32 v[100:101], v55 offset0:144 offset1:145
  ds_read2_b32 v[102:103], v55 offset0:146 offset1:147
  s_waitcnt lgkmcnt(6)
  v_mfma_f32_16x16x32_bf16 v[80:83], v[104:107], a[0:3], v[80:83]
  v_mfma_f32_16x16x32_bf16 v[84:87], v[104:107], a[32:35], v[84:87]
  v_mfma_f32_16x16x32_bf16 v[88:91], v[104:107], a[64:67], v[88:91]
  ds_read2_b32 v[104:105], v55 offset0:128 offset1:129
  ds_read2_b32 v[106:107], v55 offset0:130 offset1:131
  s_waitcnt lgkmcnt(6)
  v_mfma_f32_16x16x32_bf16 v[84:87], v[92:95], a[28:31], v[84:87]
  v_mfma_f32_16x16x32_bf16 v[88:91], v[92:95], a[60:63], v[88:91]
  ds_read2_b32 v[92:93], v55 offset0:112 offset1:113
  ds_read2_b32 v[94:95], v55 offset0:114 offset1:115
  s_waitcnt lgkmcnt(6)
  v_mfma_f32_16x16x32_bf16 v[84:87], v[96:99], a[24:27], v[84:87]
  v_mfma_f32_16x16x32_bf16 v[88:91], v[96:99], a[56:59], v[88:91]
  ds_read2_b32 v[96:97], v55 offset0:96 offset1:97
  ds_read2_b32 v[98:99], v55 offset0:98 offset1:99
  s_waitcnt lgkmcnt(6)
  v_mfma_f32_16x16x32_bf16 v[84:87], v[100:103], a[20:23], v[84:87]
  v_mfma_f32_16x16x32_bf16 v[88:91], v[100:103], a[52:55], v[88:91]
  ds_read2_b32 v[100:101], v55 offset0:80 offset1:81
  ds_read2_b32 v[102:103], v55 offset0:82 offset1:83
  s_waitcnt lgkmcnt(6)
  v_mfma_f32_16x16x32_bf16 v[84:87], v[104:107], a[16:19], v[84:87]
  v_mfma_f32_16x16x32_bf16 v[88:91], v[104:107], a[48:51], v[88:91]
  ds_read2_b32 v[104:105], v55 offset0:64 offset1:65
  ds_read2_b32 v[106:107], v55 offset0:66 offset1:67
  s_waitcnt lgkmcnt(6)
  v_mfma_f32_16x16x32_bf16 v[84:87], v[92:95], a[12:15], v[84:87]
  v_mfma_f32_16x16x32_bf16 v[88:91], v[92:95], a[44:47], v[88:91]
  ds_read2_b32 v[92:93], v55 offset0:48 offset1:49
  ds_read2_b32 v[94:95], v55 offset0:50 offset1:51
  s_waitcnt lgkmcnt(6)
  v_mfma_f32_16x16x32_bf16 v[84:87], v[96:99], a[8:11], v[84:87]
  v_mfma_f32_16x16x32_bf16 v[88:91], v[96:99], a[40:43], v[88:91]
  ds_read2_b32 v[96:97], v55 offset0:32 offset1:33
  ds_read2_b32 v[98:99], v55 offset0:34 offset1:35
  s_waitcnt lgkmcnt(6)
  v_mfma_f32_16x16x32_bf16 v[84:87], v[100:103], a[4:7], v[84:87]
  v_mfma_f32_16x16x32_bf16 v[88:91], v[100:103], a[36:39], v[88:91]
  ds_read2_b32 v[100:101], v55 offset0:16 offset1:17
  ds_read2_b32 v[102:103], v55 offset0:18 offset1:19
  s_waitcnt lgkmcnt(6)
  v_mfma_f32_16x16x32_bf16 v[84:87], v[104:107], a[0:3], v[84:87]
  v_mfma_f32_16x16x32_bf16 v[88:91], v[104:107], a[32:35], v[88:91]
  ds_read2_b32 v[104:105], v55 offset0:0 offset1:1
  ds_read2_b32 v[106:107], v55 offset0:2 offset1:3
  s_waitcnt lgkmcnt(6)
  v_mfma_f32_16x16x32_bf16 v[88:91], v[92:95], a[28:31], v[88:91]
  ds_read2_b32 v[92:93], v56 offset0:224 offset1:225
  ds_read2_b32 v[94:95], v56 offset0:226 offset1:227
  s_waitcnt lgkmcnt(6)
  v_mfma_f32_16x16x32_bf16 v[88:91], v[96:99], a[24:27], v[88:91]
  ds_read2_b32 v[96:97], v56 offset0:208 offset1:209
  ds_read2_b32 v[98:99], v56 offset0:210 offset1:211
  s_waitcnt lgkmcnt(6)
  v_mfma_f32_16x16x32_bf16 v[88:91], v[100:103], a[20:23], v[88:91]
  ds_read2_b32 v[100:101], v56 offset0:192 offset1:193
  ds_read2_b32 v[102:103], v56 offset0:194 offset1:195
  s_waitcnt lgkmcnt(6)
  v_mfma_f32_16x16x32_bf16 v[88:91], v[104:107], a[16:19], v[88:91]
  ds_read2_b32 v[104:105], v56 offset0:176 offset1:177
  ds_read2_b32 v[106:107], v56 offset0:178 offset1:179
  s_waitcnt lgkmcnt(6)
  v_mfma_f32_16x16x32_bf16 v[88:91], v[92:95], a[12:15], v[88:91]
  s_waitcnt lgkmcnt(4)
  v_mfma_f32_16x16x32_bf16 v[88:91], v[96:99], a[8:11], v[88:91]
  s_waitcnt lgkmcnt(2)
  v_mfma_f32_16x16x32_bf16 v[88:91], v[100:103], a[4:7], v[88:91]
  s_waitcnt lgkmcnt(0)
  v_mfma_f32_16x16x32_bf16 v[88:91], v[104:107], a[0:3], v[88:91]
  v_lshlrev_b32 v46, 5, v4
  v_lshl_add_u32 v46, v3, 3, v46
  v_add_u32 v46, s17, v46
  ds_read_b64 v[108:109], v46 offset:512
  ds_read_b64 v[110:111], v46 offset:1024
  ds_read_b64 v[112:113], v46 offset:1536
  ds_read_b64 v[114:115], v46 offset:2048
  ds_read_b64 v[116:117], v46 offset:2560
  ds_read_b64 v[118:119], v46 offset:3072
  ds_read_b64 v[120:121], v46 offset:3584
  ds_read_b64 v[122:123], v46 offset:4096
  s_waitcnt lgkmcnt(0)
  v_lshlrev_b32 v124, 16, v108
  v_and_b32 v125, 0xffff0000, v108
  v_lshlrev_b32 v126, 16, v109
  v_and_b32 v127, 0xffff0000, v109
  v_mul_f32 v124, v124, v33
  v_mul_f32 v125, v125, v33
  v_mul_f32 v126, v126, v33
  v_mul_f32 v127, v127, v33
  v_cvt_pk_bf16_f32 v128, v124, v125
  v_cvt_pk_bf16_f32 v129, v126, v127
  v_cvt_pk_bf16_f32 v130, v60, v61
  v_cvt_pk_bf16_f32 v131, v62, v63
  v_lshlrev_b32 v124, 16, v128
  v_and_b32 v125, 0xffff0000, v128
  v_lshlrev_b32 v132, 16, v130
  v_and_b32 v133, 0xffff0000, v130
  v_lshlrev_b32 v126, 16, v129
  v_and_b32 v127, 0xffff0000, v129
  v_lshlrev_b32 v134, 16, v131
  v_and_b32 v135, 0xffff0000, v131
  v_add_f32 v124, v124, v132
  v_add_f32 v125, v125, v133
  v_add_f32 v126, v126, v134
  v_add_f32 v127, v127, v135
  v_cvt_pk_bf16_f32 v108, v124, v125
  v_cvt_pk_bf16_f32 v109, v126, v127
  ds_write_b64 v46, v[108:109] offset:512
  v_lshlrev_b32 v124, 16, v110
  v_and_b32 v125, 0xffff0000, v110
  v_lshlrev_b32 v126, 16, v111
  v_and_b32 v127, 0xffff0000, v111
  v_mul_f32 v124, v124, v33
  v_mul_f32 v125, v125, v33
  v_mul_f32 v126, v126, v33
  v_mul_f32 v127, v127, v33
  v_cvt_pk_bf16_f32 v128, v124, v125
  v_cvt_pk_bf16_f32 v129, v126, v127
  v_cvt_pk_bf16_f32 v130, v64, v65
  v_cvt_pk_bf16_f32 v131, v66, v67
  v_lshlrev_b32 v124, 16, v128
  v_and_b32 v125, 0xffff0000, v128
  v_lshlrev_b32 v132, 16, v130
  v_and_b32 v133, 0xffff0000, v130
  v_lshlrev_b32 v126, 16, v129
  v_and_b32 v127, 0xffff0000, v129
  v_lshlrev_b32 v134, 16, v131
  v_and_b32 v135, 0xffff0000, v131
  v_add_f32 v124, v124, v132
  v_add_f32 v125, v125, v133
  v_add_f32 v126, v126, v134
  v_add_f32 v127, v127, v135
  v_cvt_pk_bf16_f32 v110, v124, v125
  v_cvt_pk_bf16_f32 v111, v126, v127
  ds_write_b64 v46, v[110:111] offset:1024
  v_lshlrev_b32 v124, 16, v112
  v_and_b32 v125, 0xffff0000, v112
  v_lshlrev_b32 v126, 16, v113
  v_and_b32 v127, 0xffff0000, v113
  v_mul_f32 v124, v124, v33
  v_mul_f32 v125, v125, v33
  v_mul_f32 v126, v126, v33
  v_mul_f32 v127, v127, v33
  v_cvt_pk_bf16_f32 v128, v124, v125
  v_cvt_pk_bf16_f32 v129, v126, v127
  v_cvt_pk_bf16_f32 v130, v68, v69
  v_cvt_pk_bf16_f32 v131, v70, v71
  v_lshlrev_b32 v124, 16, v128
  v_and_b32 v125, 0xffff0000, v128
  v_lshlrev_b32 v132, 16, v130
  v_and_b32 v133, 0xffff0000, v130
  v_lshlrev_b32 v126, 16, v129
  v_and_b32 v127, 0xffff0000, v129
  v_lshlrev_b32 v134, 16, v131
  v_and_b32 v135, 0xffff0000, v131
  v_add_f32 v124, v124, v132
  v_add_f32 v125, v125, v133
  v_add_f32 v126, v126, v134
  v_add_f32 v127, v127, v135
  v_cvt_pk_bf16_f32 v112, v124, v125
  v_cvt_pk_bf16_f32 v113, v126, v127
  ds_write_b64 v46, v[112:113] offset:1536
  v_lshlrev_b32 v124, 16, v114
  v_and_b32 v125, 0xffff0000, v114
  v_lshlrev_b32 v126, 16, v115
  v_and_b32 v127, 0xffff0000, v115
  v_mul_f32 v124, v124, v33
  v_mul_f32 v125, v125, v33
  v_mul_f32 v126, v126, v33
  v_mul_f32 v127, v127, v33
  v_cvt_pk_bf16_f32 v128, v124, v125
  v_cvt_pk_bf16_f32 v129, v126, v127
  v_cvt_pk_bf16_f32 v130, v72, v73
  v_cvt_pk_bf16_f32 v131, v74, v75
  v_lshlrev_b32 v124, 16, v128
  v_and_b32 v125, 0xffff0000, v128
  v_lshlrev_b32 v132, 16, v130
  v_and_b32 v133, 0xffff0000, v130
  v_lshlrev_b32 v126, 16, v129
  v_and_b32 v127, 0xffff0000, v129
  v_lshlrev_b32 v134, 16, v131
  v_and_b32 v135, 0xffff0000, v131
  v_add_f32 v124, v124, v132
  v_add_f32 v125, v125, v133
  v_add_f32 v126, v126, v134
  v_add_f32 v127, v127, v135
  v_cvt_pk_bf16_f32 v114, v124, v125
  v_cvt_pk_bf16_f32 v115, v126, v127
  ds_write_b64 v46, v[114:115] offset:2048
  v_lshlrev_b32 v124, 16, v116
  v_and_b32 v125, 0xffff0000, v116
  v_lshlrev_b32 v126, 16, v117
  v_and_b32 v127, 0xffff0000, v117
  v_mul_f32 v124, v124, v33
  v_mul_f32 v125, v125, v33
  v_mul_f32 v126, v126, v33
  v_mul_f32 v127, v127, v33
  v_cvt_pk_bf16_f32 v128, v124, v125
  v_cvt_pk_bf16_f32 v129, v126, v127
  v_cvt_pk_bf16_f32 v130, v76, v77
  v_cvt_pk_bf16_f32 v131, v78, v79
  v_lshlrev_b32 v124, 16, v128
  v_and_b32 v125, 0xffff0000, v128
  v_lshlrev_b32 v132, 16, v130
  v_and_b32 v133, 0xffff0000, v130
  v_lshlrev_b32 v126, 16, v129
  v_and_b32 v127, 0xffff0000, v129
  v_lshlrev_b32 v134, 16, v131
  v_and_b32 v135, 0xffff0000, v131
  v_add_f32 v124, v124, v132
  v_add_f32 v125, v125, v133
  v_add_f32 v126, v126, v134
  v_add_f32 v127, v127, v135
  v_cvt_pk_bf16_f32 v116, v124, v125
  v_cvt_pk_bf16_f32 v117, v126, v127
  ds_write_b64 v46, v[116:117] offset:2560
  v_lshlrev_b32 v124, 16, v118
  v_and_b32 v125, 0xffff0000, v118
  v_lshlrev_b32 v126, 16, v119
  v_and_b32 v127, 0xffff0000, v119
  v_mul_f32 v124, v124, v33
  v_mul_f32 v125, v125, v33
  v_mul_f32 v126, v126, v33
  v_mul_f32 v127, v127, v33
  v_cvt_pk_bf16_f32 v128, v124, v125
  v_cvt_pk_bf16_f32 v129, v126, v127
  v_cvt_pk_bf16_f32 v130, v80, v81
  v_cvt_pk_bf16_f32 v131, v82, v83
  v_lshlrev_b32 v124, 16, v128
  v_and_b32 v125, 0xffff0000, v128
  v_lshlrev_b32 v132, 16, v130
  v_and_b32 v133, 0xffff0000, v130
  v_lshlrev_b32 v126, 16, v129
  v_and_b32 v127, 0xffff0000, v129
  v_lshlrev_b32 v134, 16, v131
  v_and_b32 v135, 0xffff0000, v131
  v_add_f32 v124, v124, v132
  v_add_f32 v125, v125, v133
  v_add_f32 v126, v126, v134
  v_add_f32 v127, v127, v135
  v_cvt_pk_bf16_f32 v118, v124, v125
  v_cvt_pk_bf16_f32 v119, v126, v127
  ds_write_b64 v46, v[118:119] offset:3072
  v_lshlrev_b32 v124, 16, v120
  v_and_b32 v125, 0xffff0000, v120
  v_lshlrev_b32 v126, 16, v121
  v_and_b32 v127, 0xffff0000, v121
  v_mul_f32 v124, v124, v33
  v_mul_f32 v125, v125, v33
  v_mul_f32 v126, v126, v33
  v_mul_f32 v127, v127, v33
  v_cvt_pk_bf16_f32 v128, v124, v125
  v_cvt_pk_bf16_f32 v129, v126, v127
  v_cvt_pk_bf16_f32 v130, v84, v85
  v_cvt_pk_bf16_f32 v131, v86, v87
  v_lshlrev_b32 v124, 16, v128
  v_and_b32 v125, 0xffff0000, v128
  v_lshlrev_b32 v132, 16, v130
  v_and_b32 v133, 0xffff0000, v130
  v_lshlrev_b32 v126, 16, v129
  v_and_b32 v127, 0xffff0000, v129
  v_lshlrev_b32 v134, 16, v131
  v_and_b32 v135, 0xffff0000, v131
  v_add_f32 v124, v124, v132
  v_add_f32 v125, v125, v133
  v_add_f32 v126, v126, v134
  v_add_f32 v127, v127, v135
  v_cvt_pk_bf16_f32 v120, v124, v125
  v_cvt_pk_bf16_f32 v121, v126, v127
  ds_write_b64 v46, v[120:121] offset:3584
  v_lshlrev_b32 v124, 16, v122
  v_and_b32 v125, 0xffff0000, v122
  v_lshlrev_b32 v126, 16, v123
  v_and_b32 v127, 0xffff0000, v123
  v_mul_f32 v124, v124, v33
  v_mul_f32 v125, v125, v33
  v_mul_f32 v126, v126, v33
  v_mul_f32 v127, v127, v33
  v_cvt_pk_bf16_f32 v128, v124, v125
  v_cvt_pk_bf16_f32 v129, v126, v127
  v_cvt_pk_bf16_f32 v130, v88, v89
  v_cvt_pk_bf16_f32 v131, v90, v91
  v_lshlrev_b32 v124, 16, v128
  v_and_b32 v125, 0xffff0000, v128
  v_lshlrev_b32 v132, 16, v130
  v_and_b32 v133, 0xffff0000, v130
  v_lshlrev_b32 v126, 16, v129
  v_and_b32 v127, 0xffff0000, v129
  v_lshlrev_b32 v134, 16, v131
  v_and_b32 v135, 0xffff0000, v131
  v_add_f32 v124, v124, v132
  v_add_f32 v125, v125, v133
  v_add_f32 v126, v126, v134
  v_add_f32 v127, v127, v135
  v_cvt_pk_bf16_f32 v122, v124, v125
  v_cvt_pk_bf16_f32 v123, v126, v127
  ds_write_b64 v46, v[122:123] offset:4096
  s_waitcnt lgkmcnt(0)
  s_barrier
  v_lshlrev_b32 v6, 3, v0
  v_lshlrev_b32 v5, 4, v0
  v_add_u32 v36, 512, v6
  ds_read_b64 v[8:9], v36
  v_add_u32 v36, 25088, v6
  ds_read_b64 v[10:11], v36
  v_add_u32 v36, 49664, v6
  ds_read_b64 v[12:13], v36
  v_add_u32 v36, 74240, v6
  ds_read_b64 v[14:15], v36
  s_waitcnt lgkmcnt(0)
  s_add_u32 s22, s21, 0
  s_add_u32 s23, s22, 3584
  v_perm_b32 v16, v10, v8, s24
  v_perm_b32 v17, v14, v12, s24
  s_lshl_b32 s22, s21, 11
  s_add_u32 s22, s22, 90177536
  v_perm_b32 v18, v10, v8, s25
  v_perm_b32 v19, v14, v12, s25
  buffer_store_dwordx4 v[16:19], v5, s[8:11], s22 offen sc1
  v_perm_b32 v20, v11, v9, s24
  v_perm_b32 v21, v15, v13, s24
  v_perm_b32 v22, v11, v9, s25
  v_perm_b32 v23, v15, v13, s25
  s_add_u32 s22, s22, 4096
  buffer_store_dwordx4 v[20:23], v5, s[8:11], s22 offen sc1
  v_add_u32 v36, 2560, v6
  ds_read_b64 v[8:9], v36
  v_add_u32 v36, 27136, v6
  ds_read_b64 v[10:11], v36
  v_add_u32 v36, 51712, v6
  ds_read_b64 v[12:13], v36
  v_add_u32 v36, 76288, v6
  ds_read_b64 v[14:15], v36
  s_waitcnt lgkmcnt(0)
  s_add_u32 s22, s21, 1835008
  s_add_u32 s23, s22, 3584
  v_perm_b32 v24, v10, v8, s24
  v_perm_b32 v25, v14, v12, s24
  s_lshl_b32 s22, s21, 11
  s_add_u32 s22, s22, 90185728
  v_perm_b32 v26, v10, v8, s25
  v_perm_b32 v27, v14, v12, s25
  buffer_store_dwordx4 v[24:27], v5, s[8:11], s22 offen sc1
  v_perm_b32 v28, v11, v9, s24
  v_perm_b32 v29, v15, v13, s24
  v_perm_b32 v30, v11, v9, s25
  v_perm_b32 v31, v15, v13, s25
  s_add_u32 s22, s22, 4096
  buffer_store_dwordx4 v[28:31], v5, s[8:11], s22 offen sc1
  s_waitcnt vmcnt(0)
  s_barrier
  s_cmp_lg_u32 s16, 0
  s_cbranch_scc1 wk_nc
  v_mov_b32 v5, 1
  s_mov_b32 s22, 88599424
  s_mov_b64 exec, 1
  buffer_atomic_add v5, off, s[8:11], s22
  s_mov_b64 exec, -1
wk_nc:
  s_branch wk_loop
wk_tok:
  s_sub_u32 s3, s3, 864
  s_cmp_lt_u32 s3, 512
  s_cbranch_scc1 wk_tk
  s_sub_u32 s3, s3, 64
  s_cmp_ge_i32 s3, 512
  s_cbranch_scc1 wk_tk
  s_sub_u32 s18, s3, 448
  s_mov_b32 s20, 88599424
  v_mov_b32 v8, 0
  s_mov_b32 s30, 0
wk_cw:
  buffer_load_dword v9, v8, s[8:11], s20 offen sc1
  s_waitcnt vmcnt(0)
  v_cmp_ne_u32 vcc, 112, v9
  s_cbranch_vccz wk_cw_ok
  s_sleep 32
  s_add_u32 s30, s30, 1
  s_cmp_lt_u32 s30, 50000
  s_cbranch_scc1 wk_cw
  s_branch cA_abort
wk_cw_ok:
  v_lshlrev_b32 v5, 14, v3
  v_and_b32 v6, 1, v4
  v_lshl_add_u32 v5, v6, 12, v5
  v_lshrrev_b32 v6, 1, v4
  v_lshl_add_u32 v5, v6, 4, v5
  s_mul_i32 s20, s16, 458752
  s_lshl_b32 s21, s18, 7
  s_add_u32 s20, s20, s21
  s_and_b32 s21, s18, 32
  s_lshl_b32 s21, s21, 7
  s_add_u32 s20, s20, s21
  s_add_u32 s20, s20, 90177536
  buffer_load_dwordx4 v[8:11], v5, s[8:11], s20 offen sc1
  s_add_u32 s20, s20, 65536
  buffer_load_dwordx4 v[12:15], v5, s[8:11], s20 offen sc1
  s_add_u32 s20, s20, 65536
  buffer_load_dwordx4 v[16:19], v5, s[8:11], s20 offen sc1
  s_add_u32 s20, s20, 65536
  buffer_load_dwordx4 v[20:23], v5, s[8:11], s20 offen sc1
  s_add_u32 s20, s20, 65536
  buffer_load_dwordx4 v[24:27], v5, s[8:11], s20 offen sc1
  s_add_u32 s20, s20, 65536
  buffer_load_dwordx4 v[28:31], v5, s[8:11], s20 offen sc1
  s_add_u32 s20, s20, 65536
  buffer_load_dwordx4 v[32:35], v5, s[8:11], s20 offen sc1
  s_add_u32 s20, s20, 65536
  v_mul_u32_u24 v6, 1824, v4
  v_lshl_add_u32 v6, v3, 3, v6
  s_mul_i32 s20, s16, 224
  v_add_u32 v6, s20, v6
  s_movk_i32 s22, 912
  v_add_u32 v36, 0, v0
  v_mul_u32_u24 v37, 18725, v36
  v_lshrrev_b32 v37, 20, v37
  v_mul_u32_u24 v38, 56, v37
  v_sub_u32 v36, v36, v38
  v_lshlrev_b32 v36, 4, v36
  v_mad_u32_u24 v40, v37, s22, v36
  v_mul_u32_u24 v37, 1792, v37
  v_add_u32 v48, v37, v36
  v_add_u32 v36, 256, v0
  v_mul_u32_u24 v37, 18725, v36
  v_lshrrev_b32 v37, 20, v37
  v_mul_u32_u24 v38, 56, v37
  v_sub_u32 v36, v36, v38
  v_lshlrev_b32 v36, 4, v36
  v_mad_u32_u24 v41, v37, s22, v36
  v_mul_u32_u24 v37, 1792, v37
  v_add_u32 v49, v37, v36
  v_add_u32 v36, 512, v0
  v_mul_u32_u24 v37, 18725, v36
  v_lshrrev_b32 v37, 20, v37
  v_mul_u32_u24 v38, 56, v37
  v_sub_u32 v36, v36, v38
  v_lshlrev_b32 v36, 4, v36
  v_mad_u32_u24 v42, v37, s22, v36
  v_mul_u32_u24 v37, 1792, v37
  v_add_u32 v50, v37, v36
  v_add_u32 v36, 768, v0
  v_mul_u32_u24 v37, 18725, v36
  v_lshrrev_b32 v37, 20, v37
  v_mul_u32_u24 v38, 56, v37
  v_sub_u32 v36, v36, v38
  v_lshlrev_b32 v36, 4, v36
  v_mad_u32_u24 v43, v37, s22, v36
  v_mul_u32_u24 v37, 1792, v37
  v_add_u32 v51, v37, v36
  v_add_u32 v36, 1024, v0
  v_mul_u32_u24 v37, 18725, v36
  v_lshrrev_b32 v37, 20, v37
  v_mul_u32_u24 v38, 56, v37
  v_sub_u32 v36, v36, v38
  v_lshlrev_b32 v36, 4, v36
  v_mad_u32_u24 v44, v37, s22, v36
  v_mul_u32_u24 v37, 1792, v37
  v_add_u32 v52, v37, v36
  v_add_u32 v36, 1280, v0
  v_mul_u32_u24 v37, 18725, v36
  v_lshrrev_b32 v37, 20, v37
  v_mul_u32_u24 v38, 56, v37
  v_sub_u32 v36, v36, v38
  v_lshlrev_b32 v36, 4, v36
  v_mad_u32_u24 v45, v37, s22, v36
  v_mul_u32_u24 v37, 1792, v37
  v_add_u32 v53, v37, v36
  v_add_u32 v36, 1536, v0
  v_mul_u32_u24 v37, 18725, v36
  v_lshrrev_b32 v37, 20, v37
  v_mul_u32_u24 v38, 56, v37
  v_sub_u32 v36, v36, v38
  v_lshlrev_b32 v36, 4, v36
  v_mad_u32_u24 v46, v37, s22, v36
  v_mul_u32_u24 v37, 1792, v37
  v_add_u32 v54, v37, v36
  s_waitcnt vmcnt(6)
  ds_write_b64 v6, v[8:9] offset:0
  ds_write_b64 v6, v[10:11] offset:912
  s_waitcnt vmcnt(5)
  ds_write_b64 v6, v[12:13] offset:32
  ds_write_b64 v6, v[14:15] offset:944
  s_waitcnt vmcnt(4)
  ds_write_b64 v6, v[16:17] offset:64
  ds_write_b64 v6, v[18:19] offset:976
  s_waitcnt vmcnt(3)
  ds_write_b64 v6, v[20:21] offset:96
  ds_write_b64 v6, v[22:23] offset:1008
  s_waitcnt vmcnt(2)
  ds_write_b64 v6, v[24:25] offset:128
  ds_write_b64 v6, v[26:27] offset:1040
  s_waitcnt vmcnt(1)
  ds_write_b64 v6, v[28:29] offset:160
  ds_write_b64 v6, v[30:31] offset:1072
  s_waitcnt vmcnt(0)
  ds_write_b64 v6, v[32:33] offset:192
  ds_write_b64 v6, v[34:35] offset:1104
  s_waitcnt lgkmcnt(0)
  s_barrier
  s_mul_i32 s20, s18, 57344
  ds_read_b128 v[8:11], v40
  ds_read_b128 v[12:15], v41
  ds_read_b128 v[16:19], v42
  ds_read_b128 v[20:23], v43
  ds_read_b128 v[24:27], v44
  ds_read_b128 v[28:31], v45
  ds_read_b128 v[32:35], v46
  s_waitcnt lgkmcnt(6)
  buffer_store_dwordx4 v[8:11], v48, s[92:95], s20 offen
  s_waitcnt lgkmcnt(5)
  buffer_store_dwordx4 v[12:15], v49, s[92:95], s20 offen
  s_waitcnt lgkmcnt(4)
  buffer_store_dwordx4 v[16:19], v50, s[92:95], s20 offen
  s_waitcnt lgkmcnt(3)
  buffer_store_dwordx4 v[20:23], v51, s[92:95], s20 offen
  s_waitcnt lgkmcnt(2)
  buffer_store_dwordx4 v[24:27], v52, s[92:95], s20 offen
  s_waitcnt lgkmcnt(1)
  buffer_store_dwordx4 v[28:31], v53, s[92:95], s20 offen
  s_waitcnt lgkmcnt(0)
  buffer_store_dwordx4 v[32:35], v54, s[92:95], s20 offen
  s_branch wk_loop
wk_tk:
  s_and_b32 s18, s3, 3
  s_lshr_b32 s17, s3, 2
  s_cmp_lt_u32 s17, 8
  s_cbranch_scc1 wk_tokp
  s_sub_u32 s17, s17, 64
  s_cmp_ge_i32 s17, 56
  s_cbranch_scc1 wk_toko
  s_add_u32 s20, s17, 56
  s_lshr_b32 s17, s20, 1
  s_bitcmp0_b32 s20, 0
  s_cbranch_scc1 wk_toko
  s_add_u32 s17, s17, 8
wk_tokp:
  s_lshl_b32 s20, s18, 2
  s_add_u32 s20, s20, s16
  s_lshl_b32 s21, s17, 4
  s_add_u32 s21, s21, s20
  s_mul_i32 s21, s21, 28672
  s_add_u32 s21, s21, 12845056
  s_mul_i32 s23, s17, 28672
  s_add_u32 s23, s23, 73400320
  s_mul_i32 s24, s17, 7168
  s_add_u32 s24, s24, 88080384
  s_lshr_b32 s25, s17, 3
  s_lshl_b32 s25, s25, 4
  s_add_u32 s25, s25, s20
  s_lshl_b32 s25, s25, 7
  s_add_u32 s25, s25, 88557568
  v_mov_b32 v60, 0
  s_mov_b32 s30, 0
wp_wf:
  buffer_load_dword v61, v60, s[8:11], s25 offen sc1
  s_waitcnt vmcnt(0)
  v_cmp_ne_u32 vcc, 56, v61
  s_cbranch_vccz wp_wf_ok
  s_sleep 1
  s_cmp_ge_u32 s17, 61
  s_cbranch_scc1 wp_wf_bo
  s_sleep 4
  s_cmp_ge_u32 s17, 56
  s_cbranch_scc1 wp_wf_bo
  s_sleep 40
wp_wf_bo:
  s_add_u32 s30, s30, 1
  s_cmp_lt_u32 s30, 30000
  s_cbranch_scc1 wp_wf
  s_branch wp_abort
wp_wf_ok:
  s_add_u32 s22, s21, 0
  buffer_load_dwordx4 a[0:3], v2, s[8:11], s22 offen offset:0 sc1
  buffer_load_dwordx4 a[4:7], v2, s[8:11], s22 offen offset:1024 sc1
  buffer_load_dwordx4 a[8:11], v2, s[8:11], s22 offen offset:2048 sc1
  buffer_load_dwordx4 a[12:15], v2, s[8:11], s22 offen offset:3072 sc1
  s_add_u32 s22, s21, 4096
  buffer_load_dwordx4 a[16:19], v2, s[8:11], s22 offen offset:0 sc1
  buffer_load_dwordx4 a[20:23], v2, s[8:11], s22 offen offset:1024 sc1
  buffer_load_dwordx4 a[24:27], v2, s[8:11], s22 offen offset:2048 sc1
  buffer_load_dwordx4 a[28:31], v2, s[8:11], s22 offen offset:3072 sc1
  s_add_u32 s22, s21, 8192
  buffer_load_dwordx4 a[32:35], v2, s[8:11], s22 offen offset:0 sc1
  buffer_load_dwordx4 a[36:39], v2, s[8:11], s22 offen offset:1024 sc1
  buffer_load_dwordx4 a[40:43], v2, s[8:11], s22 offen offset:2048 sc1
  buffer_load_dwordx4 a[44:47], v2, s[8:11], s22 offen offset:3072 sc1
  s_add_u32 s22, s21, 12288
  buffer_load_dwordx4 a[48:51], v2, s[8:11], s22 offen offset:0 sc1
  buffer_load_dwordx4 a[52:55], v2, s[8:11], s22 offen offset:1024 sc1
  buffer_load_dwordx4 a[56:59], v2, s[8:11], s22 offen offset:2048 sc1
  buffer_load_dwordx4 a[60:63], v2, s[8:11], s22 offen offset:3072 sc1
  s_add_u32 s22, s21, 16384
  buffer_load_dwordx4 a[64:67], v2, s[8:11], s22 offen offset:0 sc1
  buffer_load_dwordx4 a[68:71], v2, s[8:11], s22 offen offset:1024 sc1
  buffer_load_dwordx4 a[72:75], v2, s[8:11], s22 offen offset:2048 sc1
  buffer_load_dwordx4 a[76:79], v2, s[8:11], s22 offen offset:3072 sc1
  s_add_u32 s22, s21, 20480
  buffer_load_dwordx4 a[80:83], v2, s[8:11], s22 offen offset:0 sc1
  buffer_load_dwordx4 a[84:87], v2, s[8:11], s22 offen offset:1024 sc1
  buffer_load_dwordx4 a[88:91], v2, s[8:11], s22 offen offset:2048 sc1
  buffer_load_dwordx4 a[92:95], v2, s[8:11], s22 offen offset:3072 sc1
  s_add_u32 s22, s21, 24576
  buffer_load_dwordx4 a[96:99], v2, s[8:11], s22 offen offset:0 sc1
  buffer_load_dwordx4 a[100:103], v2, s[8:11], s22 offen offset:1024 sc1
  buffer_load_dwordx4 a[104:107], v2, s[8:11], s22 offen offset:2048 sc1
  buffer_load_dwordx4 a[108:111], v2, s[8:11], s22 offen offset:3072 sc1
  s_add_u32 s22, s23, 0
  buffer_load_dwordx4 a[112:115], v2, s[8:11], s22 offen offset:0 sc1
  buffer_load_dwordx4 a[116:119], v2, s[8:11], s22 offen offset:1024 sc1
  buffer_load_dwordx4 a[120:123], v2, s[8:11], s22 offen offset:2048 sc1
  buffer_load_dwordx4 a[124:127], v2, s[8:11], s22 offen offset:3072 sc1
  s_add_u32 s22, s23, 4096
  buffer_load_dwordx4 a[128:131], v2, s[8:11], s22 offen offset:0 sc1
  buffer_load_dwordx4 a[132:135], v2, s[8:11], s22 offen offset:1024 sc1
  buffer_load_dwordx4 a[136:139], v2, s[8:11], s22 offen offset:2048 sc1
  buffer_load_dwordx4 a[140:143], v2, s[8:11], s22 offen offset:3072 sc1
  s_add_u32 s22, s23, 8192
  buffer_load_dwordx4 a[144:147], v2, s[8:11], s22 offen offset:0 sc1
  buffer_load_dwordx4 a[148:151], v2, s[8:11], s22 offen offset:1024 sc1
  buffer_load_dwordx4 a[152:155], v2, s[8:11], s22 offen offset:2048 sc1
  buffer_load_dwordx4 a[156:159], v2, s[8:11], s22 offen offset:3072 sc1
  s_add_u32 s22, s23, 12288
  buffer_load_dwordx4 a[160:163], v2, s[8:11], s22 offen offset:0 sc1
  buffer_load_dwordx4 a[164:167], v2, s[8:11], s22 offen offset:1024 sc1
  buffer_load_dwordx4 a[168:171], v2, s[8:11], s22 offen offset:2048 sc1
  buffer_load_dwordx4 a[172:175], v2, s[8:11], s22 offen offset:3072 sc1
  s_add_u32 s22, s23, 16384
  buffer_load_dwordx4 a[176:179], v2, s[8:11], s22 offen offset:0 sc1
  buffer_load_dwordx4 a[180:183], v2, s[8:11], s22 offen offset:1024 sc1
  buffer_load_dwordx4 a[184:187], v2, s[8:11], s22 offen offset:2048 sc1
  buffer_load_dwordx4 a[188:191], v2, s[8:11], s22 offen offset:3072 sc1
  s_add_u32 s22, s23, 20480
  buffer_load_dwordx4 a[192:195], v2, s[8:11], s22 offen offset:0 sc1
  buffer_load_dwordx4 a[196:199], v2, s[8:11], s22 offen offset:1024 sc1
  buffer_load_dwordx4 a[200:203], v2, s[8:11], s22 offen offset:2048 sc1
  buffer_load_dwordx4 a[204:207], v2, s[8:11], s22 offen offset:3072 sc1
  s_add_u32 s22, s23, 24576
  buffer_load_dwordx4 a[208:211], v2, s[8:11], s22 offen offset:0 sc1
  buffer_load_dwordx4 a[212:215], v2, s[8:11], s22 offen offset:1024 sc1
  buffer_load_dwordx4 a[216:219], v2, s[8:11], s22 offen offset:2048 sc1
  buffer_load_dwordx4 a[220:223], v2, s[8:11], s22 offen offset:3072 sc1
  v_lshl_add_u32 v5, v3, 2, 0
  v_cmp_le_u32 s[40:41], v5, v4
  v_lshl_add_u32 v5, v3, 2, 1
  v_cmp_le_u32 s[42:43], v5, v4
  v_lshl_add_u32 v5, v3, 2, 2
  v_cmp_le_u32 s[44:45], v5, v4
  v_lshl_add_u32 v5, v3, 2, 3
  v_cmp_le_u32 s[46:47], v5, v4
  v_cmp_gt_u32 s[48:49], 2, v3
  v_mov_b32 v6, 0xff800000
  s_waitcnt vmcnt(0)
  v_mfma_f32_16x16x32_bf16 v[8:11], a[112:115], a[0:3], 0
  v_mfma_f32_16x16x32_bf16 v[12:15], a[112:115], a[56:59], 0
  v_mfma_f32_16x16x32_bf16 v[16:19], a[168:171], a[56:59], 0
  v_mfma_f32_16x16x32_bf16 v[8:11], a[116:119], a[4:7], v[8:11]
  v_mfma_f32_16x16x32_bf16 v[12:15], a[116:119], a[60:63], v[12:15]
  v_mfma_f32_16x16x32_bf16 v[16:19], a[172:175], a[60:63], v[16:19]
  v_mfma_f32_16x16x32_bf16 v[8:11], a[120:123], a[8:11], v[8:11]
  v_mfma_f32_16x16x32_bf16 v[12:15], a[120:123], a[64:67], v[12:15]
  v_mfma_f32_16x16x32_bf16 v[16:19], a[176:179], a[64:67], v[16:19]
  v_mfma_f32_16x16x32_bf16 v[8:11], a[124:127], a[12:15], v[8:11]
  v_mfma_f32_16x16x32_bf16 v[12:15], a[124:127], a[68:71], v[12:15]
  v_mfma_f32_16x16x32_bf16 v[16:19], a[180:183], a[68:71], v[16:19]
  v_mfma_f32_16x16x32_bf16 v[8:11], a[128:131], a[16:19], v[8:11]
  v_mfma_f32_16x16x32_bf16 v[12:15], a[128:131], a[72:75], v[12:15]
  v_mfma_f32_16x16x32_bf16 v[16:19], a[184:187], a[72:75], v[16:19]
  v_mfma_f32_16x16x32_bf16 v[8:11], a[132:135], a[20:23], v[8:11]
  v_mfma_f32_16x16x32_bf16 v[12:15], a[132:135], a[76:79], v[12:15]
  v_mfma_f32_16x16x32_bf16 v[16:19], a[188:191], a[76:79], v[16:19]
  v_mfma_f32_16x16x32_bf16 v[8:11], a[136:139], a[24:27], v[8:11]
  v_mfma_f32_16x16x32_bf16 v[12:15], a[136:139], a[80:83], v[12:15]
  v_mfma_f32_16x16x32_bf16 v[16:19], a[192:195], a[80:83], v[16:19]
  v_mfma_f32_16x16x32_bf16 v[8:11], a[140:143], a[28:31], v[8:11]
  v_mfma_f32_16x16x32_bf16 v[12:15], a[140:143], a[84:87], v[12:15]
  v_mfma_f32_16x16x32_bf16 v[16:19], a[196:199], a[84:87], v[16:19]
  v_mfma_f32_16x16x32_bf16 v[8:11], a[144:147], a[32:35], v[8:11]
  v_mfma_f32_16x16x32_bf16 v[12:15], a[144:147], a[88:91], v[12:15]
  v_mfma_f32_16x16x32_bf16 v[16:19], a[200:203], a[88:91], v[16:19]
  v_mfma_f32_16x16x32_bf16 v[8:11], a[148:151], a[36:39], v[8:11]
  v_mfma_f32_16x16x32_bf16 v[12:15], a[148:151], a[92:95], v[12:15]
  v_mfma_f32_16x16x32_bf16 v[16:19], a[204:207], a[92:95], v[16:19]
  v_mfma_f32_16x16x32_bf16 v[8:11], a[152:155], a[40:43], v[8:11]
  v_mfma_f32_16x16x32_bf16 v[12:15], a[152:155], a[96:99], v[12:15]
  v_mfma_f32_16x16x32_bf16 v[16:19], a[208:211], a[96:99], v[16:19]
  v_mfma_f32_16x16x32_bf16 v[8:11], a[156:159], a[44:47], v[8:11]
  v_mfma_f32_16x16x32_bf16 v[12:15], a[156:159], a[100:103], v[12:15]
  v_mfma_f32_16x16x32_bf16 v[16:19], a[212:215], a[100:103], v[16:19]
  v_mfma_f32_16x16x32_bf16 v[8:11], a[160:163], a[48:51], v[8:11]
  v_mfma_f32_16x16x32_bf16 v[12:15], a[160:163], a[104:107], v[12:15]
  v_mfma_f32_16x16x32_bf16 v[16:19], a[216:219], a[104:107], v[16:19]
  v_mfma_f32_16x16x32_bf16 v[8:11], a[164:167], a[52:55], v[8:11]
  v_mfma_f32_16x16x32_bf16 v[12:15], a[164:167], a[108:111], v[12:15]
  v_mfma_f32_16x16x32_bf16 v[16:19], a[220:223], a[108:111], v[16:19]
  s_mul_i32 s22, s20, 448
  v_mov_b32 v62, s22
  s_mov_b32 s30, 0
wp_pm:
  s_cmp_ge_u32 s17, 64
  s_cbranch_scc1 wp_pf
  s_cmp_ge_u32 s17, 61
  s_cbranch_scc1 mp_45a
  v_mov_b32 v61, 0
  s_mov_b64 exec, 1
  buffer_atomic_or v61, v62, s[8:11], s24 offen sc0
  s_mov_b64 exec, -1
  s_branch mp_45b
mp_45a:
  buffer_load_dword v61, v62, s[8:11], s24 offen sc1
mp_45b:
  s_waitcnt vmcnt(0)
  v_cmp_eq_u32 vcc, -1, v61
  s_cbranch_vccnz wp_pr
wp_pf:
  s_add_u32 s22, s24, 4096
  buffer_load_dwordx4 v[64:67], v2, s[8:11], s24 offen offset:0 sc1
  buffer_load_dwordx4 v[68:71], v2, s[8:11], s24 offen offset:1024 sc1
  buffer_load_dwordx4 v[72:75], v2, s[8:11], s24 offen offset:2048 sc1
  buffer_load_dwordx4 v[76:79], v2, s[8:11], s24 offen offset:3072 sc1
  buffer_load_dwordx4 v[80:83], v2, s[8:11], s22 offen offset:0 sc1
  buffer_load_dwordx4 v[84:87], v2, s[8:11], s22 offen offset:1024 sc1
  buffer_load_dwordx4 v[88:91], v2, s[8:11], s22 offen offset:2048 sc1
  s_waitcnt vmcnt(0)
  v_max_u32 v61, v64, v65
  v_max3_u32 v61, v61, v66, v67
  v_max3_u32 v61, v61, v68, v69
  v_max3_u32 v61, v61, v70, v71
  v_max3_u32 v61, v61, v72, v73
  v_max3_u32 v61, v61, v74, v75
  v_max3_u32 v61, v61, v76, v77
  v_max3_u32 v61, v61, v78, v79
  v_max3_u32 v61, v61, v80, v81
  v_max3_u32 v61, v61, v82, v83
  v_max3_u32 v61, v61, v84, v85
  v_max3_u32 v61, v61, v86, v87
  v_max3_u32 v61, v61, v88, v89
  v_max3_u32 v61, v61, v90, v91
  v_cmp_eq_u32 vcc, -1, v61
  s_cbranch_vccz wp_pk
wp_pr:
  s_sleep 1
  s_cmp_ge_u32 s17, 61
  s_cbranch_scc1 wp_pm_bo
  s_sleep 4
  s_cmp_ge_u32 s17, 56
  s_cbranch_scc1 wp_pm_bo
  s_sleep 40
wp_pm_bo:
  s_add_u32 s30, s30, 1
  s_cmp_lt_u32 s30, 30000
  s_cbranch_scc1 wp_pm
  s_branch wp_abort
wp_pk:
  s_cmp_lt_u32 s17, 56
  s_cbranch_scc1 pk_46
  buffer_load_dword v250, v251, s[12:15], 0 offen sc1
pk_46:
  v_mfma_f32_16x16x32_bf16 v[20:23], v[64:67], a[0:3], 0
  v_mfma_f32_16x16x32_bf16 v[24:27], v[64:67], a[4:7], 0
  v_mfma_f32_16x16x32_bf16 v[28:31], v[64:67], a[56:59], 0
  v_mfma_f32_16x16x32_bf16 v[32:35], v[64:67], a[60:63], 0
  v_mfma_f32_16x16x32_bf16 v[20:23], v[68:71], a[8:11], v[20:23]
  v_mfma_f32_16x16x32_bf16 v[24:27], v[68:71], a[12:15], v[24:27]
  v_mfma_f32_16x16x32_bf16 v[28:31], v[68:71], a[64:67], v[28:31]
  v_mfma_f32_16x16x32_bf16 v[32:35], v[68:71], a[68:71], v[32:35]
  v_mfma_f32_16x16x32_bf16 v[20:23], v[72:75], a[16:19], v[20:23]
  v_mfma_f32_16x16x32_bf16 v[24:27], v[72:75], a[20:23], v[24:27]
  v_mfma_f32_16x16x32_bf16 v[28:31], v[72:75], a[72:75], v[28:31]
  v_mfma_f32_16x16x32_bf16 v[32:35], v[72:75], a[76:79], v[32:35]
  v_mfma_f32_16x16x32_bf16 v[20:23], v[76:79], a[24:27], v[20:23]
  v_mfma_f32_16x16x32_bf16 v[24:27], v[76:79], a[28:31], v[24:27]
  v_mfma_f32_16x16x32_bf16 v[28:31], v[76:79], a[80:83], v[28:31]
  v_mfma_f32_16x16x32_bf16 v[32:35], v[76:79], a[84:87], v[32:35]
  v_mfma_f32_16x16x32_bf16 v[20:23], v[80:83], a[32:35], v[20:23]
  v_mfma_f32_16x16x32_bf16 v[24:27], v[80:83], a[36:39], v[24:27]
  v_mfma_f32_16x16x32_bf16 v[28:31], v[80:83], a[88:91], v[28:31]
  v_mfma_f32_16x16x32_bf16 v[32:35], v[80:83], a[92:95], v[32:35]
  v_mfma_f32_16x16x32_bf16 v[20:23], v[84:87], a[40:43], v[20:23]
  v_mfma_f32_16x16x32_bf16 v[24:27], v[84:87], a[44:47], v[24:27]
  v_mfma_f32_16x16x32_bf16 v[28:31], v[84:87], a[96:99], v[28:31]
  v_mfma_f32_16x16x32_bf16 v[32:35], v[84:87], a[100:103], v[32:35]
  v_mfma_f32_16x16x32_bf16 v[20:23], v[88:91], a[48:51], v[20:23]
  v_mfma_f32_16x16x32_bf16 v[24:27], v[88:91], a[52:55], v[24:27]
  v_mfma_f32_16x16x32_bf16 v[28:31], v[88:91], a[104:107], v[28:31]
  v_mfma_f32_16x16x32_bf16 v[32:35], v[88:91], a[108:111], v[32:35]
  s_lshl_b32 s25, s17, 1
  s_mul_i32 s25, s25, 20480
  s_add_u32 s25, s25, 85458944
  s_lshl_b32 s26, s20, 10
  s_add_u32 s26, s26, s25
  s_lshl_b32 s27, s18, 10
  s_add_u32 s27, s27, s25
  s_lshr_b32 s28, s16, 1
  s_lshl_b32 s28, s28, 3
  s_add_u32 s27, s27, s28
  s_add_u32 s27, s27, 16384
  s_and_b32 s28, s16, 1
  s_cmp_eq_u32 s28, 0
  s_cselect_b32 s50, -1, 0
  s_cselect_b32 s51, 0, -1
  v_cndmask_b32 v8, v6, v8, s[40:41]
  v_cndmask_b32 v9, v6, v9, s[42:43]
  v_cndmask_b32 v10, v6, v10, s[44:45]
  v_cndmask_b32 v11, v6, v11, s[46:47]
  v_cndmask_b32 v20, v24, v20, s[48:49]
  v_cndmask_b32 v21, v25, v21, s[48:49]
  v_cndmask_b32 v22, v26, v22, s[48:49]
  v_cndmask_b32 v23, v27, v23, s[48:49]
  v_mov_b32 v24, v20
  v_mov_b32 v25, v21
  v_mov_b32 v26, v22
  v_mov_b32 v27, v23
  v_permlane32_swap_b32 v20, v24
  v_permlane32_swap_b32 v21, v25
  v_permlane32_swap_b32 v22, v26
  v_permlane32_swap_b32 v23, v27
  v_add_f32 v20, v20, v24
  v_add_f32 v21, v21, v25
  v_add_f32 v22, v22, v26
  v_add_f32 v23, v23, v27
  v_max3_f32 v40, v8, v9, v10
  v_max3_f32 v40, v40, v11, v20
  v_max3_f32 v40, v40, v21, v22
  v_max_f32 v40, v40, v23
  v_mov_b32 v41, v40
  s_nop 1
  v_permlane16_swap_b32 v40, v41
  v_max_f32 v40, v40, v41
  v_mov_b32 v41, v40
  s_nop 1
  v_permlane32_swap_b32 v40, v41
  v_max_f32 v40, v40, v41
  v_sub_f32 v8, v8, v40
  v_sub_f32 v9, v9, v40
  v_sub_f32 v10, v10, v40
  v_sub_f32 v11, v11, v40
  v_sub_f32 v20, v20, v40
  v_sub_f32 v21, v21, v40
  v_sub_f32 v22, v22, v40
  v_sub_f32 v23, v23, v40
  v_exp_f32 v8, v8
  v_exp_f32 v9, v9
  v_exp_f32 v10, v10
  v_exp_f32 v11, v11
  v_exp_f32 v20, v20
  v_exp_f32 v21, v21
  v_exp_f32 v22, v22
  v_exp_f32 v23, v23
  v_add_f32 v42, v20, v21
  v_add_f32 v43, v22, v23
  v_add_f32 v42, v42, v43
  v_mul_f32 v42, 0.5, v42
  v_add_f32 v42, v42, v8
  v_add_f32 v42, v42, v9
  v_add_f32 v42, v42, v10
  v_add_f32 v42, v42, v11
  v_mov_b32 v41, v42
  s_nop 1
  v_permlane16_swap_b32 v42, v41
  v_add_f32 v42, v42, v41
  v_mov_b32 v41, v42
  s_nop 1
  v_permlane32_swap_b32 v42, v41
  v_add_f32 v42, v42, v41
  v_rcp_f32 v42, v42
  s_nop 0
  v_mul_f32 v8, v8, v42
  v_mul_f32 v9, v9, v42
  v_mul_f32 v10, v10, v42
  v_mul_f32 v11, v11, v42
  v_mul_f32 v20, v20, v42
  v_mul_f32 v21, v21, v42
  v_mul_f32 v22, v22, v42
  v_mul_f32 v23, v23, v42
  v_cvt_pk_bf16_f32 v44, v8, v9
  v_cvt_pk_bf16_f32 v45, v10, v11
  v_mov_b32 v46, 0
  v_mov_b32 v47, 0
  v_cvt_pk_bf16_f32 v48, v20, v21
  v_cvt_pk_bf16_f32 v49, v22, v23
  v_min_u32 v44, -2, v44
  v_min_u32 v45, -2, v45
  v_min_u32 v46, -2, v46
  v_min_u32 v47, -2, v47
  v_min_u32 v48, -2, v48
  v_min_u32 v49, -2, v49
  buffer_store_dwordx4 v[44:47], v2, s[8:11], s26 offen sc1
  s_mov_b64 exec, s[50:51]
  buffer_store_dwordx2 v[48:49], v2, s[8:11], s27 offen sc1
  s_mov_b64 exec, -1
  s_add_u32 s26, s26, 20480
  s_add_u32 s27, s27, 20480
  v_cndmask_b32 v16, v6, v16, s[40:41]
  v_cndmask_b32 v17, v6, v17, s[42:43]
  v_cndmask_b32 v18, v6, v18, s[44:45]
  v_cndmask_b32 v19, v6, v19, s[46:47]
  v_cndmask_b32 v28, v32, v28, s[48:49]
  v_cndmask_b32 v29, v33, v29, s[48:49]
  v_cndmask_b32 v30, v34, v30, s[48:49]
  v_cndmask_b32 v31, v35, v31, s[48:49]
  v_mov_b32 v32, v28
  v_mov_b32 v33, v29
  v_mov_b32 v34, v30
  v_mov_b32 v35, v31
  v_permlane32_swap_b32 v28, v32
  v_permlane32_swap_b32 v29, v33
  v_permlane32_swap_b32 v30, v34
  v_permlane32_swap_b32 v31, v35
  v_add_f32 v28, v28, v32
  v_add_f32 v29, v29, v33
  v_add_f32 v30, v30, v34
  v_add_f32 v31, v31, v35
  v_max3_f32 v40, v12, v13, v14
  v_max3_f32 v40, v40, v15, v16
  v_max3_f32 v40, v40, v17, v18
  v_max3_f32 v40, v40, v19, v28
  v_max3_f32 v40, v40, v29, v30
  v_max_f32 v40, v40, v31
  v_mov_b32 v41, v40
  s_nop 1
  v_permlane16_swap_b32 v40, v41
  v_max_f32 v40, v40, v41
  v_mov_b32 v41, v40
  s_nop 1
  v_permlane32_swap_b32 v40, v41
  v_max_f32 v40, v40, v41
  v_sub_f32 v12, v12, v40
  v_sub_f32 v13, v13, v40
  v_sub_f32 v14, v14, v40
  v_sub_f32 v15, v15, v40
  v_sub_f32 v16, v16, v40
  v_sub_f32 v17, v17, v40
  v_sub_f32 v18, v18, v40
  v_sub_f32 v19, v19, v40
  v_sub_f32 v28, v28, v40
  v_sub_f32 v29, v29, v40
  v_sub_f32 v30, v30, v40
  v_sub_f32 v31, v31, v40
  v_exp_f32 v12, v12
  v_exp_f32 v13, v13
  v_exp_f32 v14, v14
  v_exp_f32 v15, v15
  v_exp_f32 v16, v16
  v_exp_f32 v17, v17
  v_exp_f32 v18, v18
  v_exp_f32 v19, v19
  v_exp_f32 v28, v28
  v_exp_f32 v29, v29
  v_exp_f32 v30, v30
  v_exp_f32 v31, v31
  v_add_f32 v42, v28, v29
  v_add_f32 v43, v30, v31
  v_add_f32 v42, v42, v43
  v_mul_f32 v42, 0.5, v42
  v_add_f32 v42, v42, v12
  v_add_f32 v42, v42, v13
  v_add_f32 v42, v42, v14
  v_add_f32 v42, v42, v15
  v_add_f32 v42, v42, v16
  v_add_f32 v42, v42, v17
  v_add_f32 v42, v42, v18
  v_add_f32 v42, v42, v19
  v_mov_b32 v41, v42
  s_nop 1
  v_permlane16_swap_b32 v42, v41
  v_add_f32 v42, v42, v41
  v_mov_b32 v41, v42
  s_nop 1
  v_permlane32_swap_b32 v42, v41
  v_add_f32 v42, v42, v41
  v_rcp_f32 v42, v42
  s_nop 0
  v_mul_f32 v12, v12, v42
  v_mul_f32 v13, v13, v42
  v_mul_f32 v14, v14, v42
  v_mul_f32 v15, v15, v42
  v_mul_f32 v16, v16, v42
  v_mul_f32 v17, v17, v42
  v_mul_f32 v18, v18, v42
  v_mul_f32 v19, v19, v42
  v_mul_f32 v28, v28, v42
  v_mul_f32 v29, v29, v42
  v_mul_f32 v30, v30, v42
  v_mul_f32 v31, v31, v42
  v_cvt_pk_bf16_f32 v52, v12, v13
  v_cvt_pk_bf16_f32 v53, v14, v15
  v_cvt_pk_bf16_f32 v54, v16, v17
  v_cvt_pk_bf16_f32 v55, v18, v19
  v_cvt_pk_bf16_f32 v56, v28, v29
  v_cvt_pk_bf16_f32 v57, v30, v31
  v_min_u32 v52, -2, v52
  v_min_u32 v53, -2, v53
  v_min_u32 v54, -2, v54
  v_min_u32 v55, -2, v55
  v_min_u32 v56, -2, v56
  v_min_u32 v57, -2, v57
  buffer_store_dwordx4 v[52:55], v2, s[8:11], s26 offen sc1
  s_mov_b64 exec, s[50:51]
  buffer_store_dwordx2 v[56:57], v2, s[8:11], s27 offen sc1
  s_mov_b64 exec, -1
  s_lshl_b32 s25, s17, 7
  s_add_u32 s25, s25, 88573952
  v_mov_b32 v5, 1
  v_mov_b32 v6, 0
  s_waitcnt vmcnt(0)
  s_mov_b64 exec, 1
  buffer_atomic_add v5, v6, s[8:11], s25 offen
  s_mov_b64 exec, -1
  s_branch wk_loop
wk_toko:
  s_lshl_b32 s20, s18, 2
  s_add_u32 s20, s20, s16
  s_mul_i32 s24, s20, 65
  s_add_u32 s24, s24, s17
  s_lshl_b32 s24, s24, 13
  s_add_u32 s24, s24, 76947456
  s_lshl_b32 s21, s20, 6
  s_add_u32 s21, s21, s17
  s_mul_i32 s21, s21, 28672
  s_add_u32 s21, s21, 42205184
  s_lshl_b32 s25, s17, 1
  s_mul_i32 s25, s25, 20480
  s_add_u32 s25, s25, 85458944
  v_lshrrev_b32 v8, 5, v1
  v_and_b32 v9, 31, v1
  v_min_u32 v5, 27, v9
  v_mad_u32_u24 v5, v8, 28, v5
  v_lshlrev_b32 v5, 4, v5
  v_lshrrev_b32 v10, 4, v9
  v_lshlrev_b32 v7, 10, v10
  v_lshl_add_u32 v7, v4, 4, v7
  v_lshl_add_u32 v7, v8, 3, v7
  v_mul_u32_u24 v6, 20480, v10
  v_lshl_add_u32 v6, v8, 8, v6
  v_lshl_add_u32 v6, v4, 4, v6
  s_lshr_b32 s26, s17, 3
  s_lshl_b32 s26, s26, 4
  s_add_u32 s26, s26, s20
  s_lshl_b32 s26, s26, 7
  s_add_u32 s26, s26, 88541184
  v_mov_b32 v60, 0
  s_mov_b32 s30, 0
wo_wv:
  buffer_load_dword v61, v60, s[8:11], s26 offen sc1
  s_waitcnt vmcnt(0)
  v_cmp_ne_u32 vcc, 56, v61
  s_cbranch_vccz wo_wv_ok
  s_sleep 1
  s_cmp_ge_u32 s17, 61
  s_cbranch_scc1 wo_wv_bo
  s_sleep 4
  s_cmp_ge_u32 s17, 56
  s_cbranch_scc1 wo_wv_bo
  s_sleep 40
wo_wv_bo:
  s_add_u32 s30, s30, 1
  s_cmp_lt_u32 s30, 30000
  s_cbranch_scc1 wo_wv
  s_branch wo_abort
wo_wv_ok:
  s_add_u32 s22, s21, 0
  buffer_load_dwordx4 a[0:3], v5, s[8:11], s22 offen offset:0 sc1
  buffer_load_dwordx4 a[4:7], v5, s[8:11], s22 offen offset:896 sc1
  buffer_load_dwordx4 a[8:11], v5, s[8:11], s22 offen offset:1792 sc1
  buffer_load_dwordx4 a[12:15], v5, s[8:11], s22 offen offset:2688 sc1
  s_add_u32 s22, s21, 3584
  buffer_load_dwordx4 a[16:19], v5, s[8:11], s22 offen offset:0 sc1
  buffer_load_dwordx4 a[20:23], v5, s[8:11], s22 offen offset:896 sc1
  buffer_load_dwordx4 a[24:27], v5, s[8:11], s22 offen offset:1792 sc1
  buffer_load_dwordx4 a[28:31], v5, s[8:11], s22 offen offset:2688 sc1
  s_add_u32 s22, s21, 7168
  buffer_load_dwordx4 a[32:35], v5, s[8:11], s22 offen offset:0 sc1
  buffer_load_dwordx4 a[36:39], v5, s[8:11], s22 offen offset:896 sc1
  buffer_load_dwordx4 a[40:43], v5, s[8:11], s22 offen offset:1792 sc1
  buffer_load_dwordx4 a[44:47], v5, s[8:11], s22 offen offset:2688 sc1
  s_add_u32 s22, s21, 10752
  buffer_load_dwordx4 a[48:51], v5, s[8:11], s22 offen offset:0 sc1
  buffer_load_dwordx4 a[52:55], v5, s[8:11], s22 offen offset:896 sc1
  buffer_load_dwordx4 a[56:59], v5, s[8:11], s22 offen offset:1792 sc1
  buffer_load_dwordx4 a[60:63], v5, s[8:11], s22 offen offset:2688 sc1
  s_add_u32 s22, s21, 14336
  buffer_load_dwordx4 a[64:67], v5, s[8:11], s22 offen offset:0 sc1
  buffer_load_dwordx4 a[68:71], v5, s[8:11], s22 offen offset:896 sc1
  buffer_load_dwordx4 a[72:75], v5, s[8:11], s22 offen offset:1792 sc1
  buffer_load_dwordx4 a[76:79], v5, s[8:11], s22 offen offset:2688 sc1
  s_add_u32 s22, s21, 17920
  buffer_load_dwordx4 a[80:83], v5, s[8:11], s22 offen offset:0 sc1
  buffer_load_dwordx4 a[84:87], v5, s[8:11], s22 offen offset:896 sc1
  buffer_load_dwordx4 a[88:91], v5, s[8:11], s22 offen offset:1792 sc1
  buffer_load_dwordx4 a[92:95], v5, s[8:11], s22 offen offset:2688 sc1
  s_add_u32 s22, s21, 21504
  buffer_load_dwordx4 a[96:99], v5, s[8:11], s22 offen offset:0 sc1
  buffer_load_dwordx4 a[100:103], v5, s[8:11], s22 offen offset:896 sc1
  buffer_load_dwordx4 a[104:107], v5, s[8:11], s22 offen offset:1792 sc1
  buffer_load_dwordx4 a[108:111], v5, s[8:11], s22 offen offset:2688 sc1
  s_add_u32 s22, s21, 25088
  buffer_load_dwordx4 a[112:115], v5, s[8:11], s22 offen offset:0 sc1
  buffer_load_dwordx4 a[116:119], v5, s[8:11], s22 offen offset:896 sc1
  buffer_load_dwordx4 a[120:123], v5, s[8:11], s22 offen offset:1792 sc1
  buffer_load_dwordx4 a[124:127], v5, s[8:11], s22 offen offset:2688 sc1
  s_cmp_ge_u32 s17, 61
  s_cbranch_scc1 wo_lm
  s_lshl_b32 s26, s17, 7
  s_add_u32 s26, s26, 88573952
  v_mov_b32 v60, 0
  s_mov_b32 s30, 0
wo_wp:
  buffer_load_dword v61, v60, s[8:11], s26 offen sc1
  s_waitcnt vmcnt(0)
  v_cmp_ne_u32 vcc, 16, v61
  s_cbranch_vccz wo_wp_ok
  s_sleep 2
  s_cmp_ge_u32 s17, 61
  s_cbranch_scc1 wo_wp_bo
  s_sleep 4
  s_cmp_ge_u32 s17, 56
  s_cbranch_scc1 wo_wp_bo
  s_sleep 40
wo_wp_bo:
  s_add_u32 s30, s30, 1
  s_cmp_lt_u32 s30, 30000
  s_cbranch_scc1 wo_wp
  s_branch wo_abort
wo_wp_ok:
  s_branch wo_lp
wo_lm:
  s_mul_i32 s26, s17, 7168
  s_add_u32 s26, s26, 88080384
  v_mov_b32 v60, 0
  s_mov_b32 s30, 0
wo_wm:
  buffer_load_dword v61, v60, s[8:11], s26 offen sc1
  s_waitcnt vmcnt(0)
  v_cmp_eq_u32 vcc, -1, v61
  s_cbranch_vccz wo_wm_ok
  s_sleep 2
  s_cmp_ge_u32 s17, 61
  s_cbranch_scc1 wo_wm_bo
  s_sleep 4
  s_cmp_ge_u32 s17, 56
  s_cbranch_scc1 wo_wm_bo
  s_sleep 40
wo_wm_bo:
  s_add_u32 s30, s30, 1
  s_cmp_lt_u32 s30, 30000
  s_cbranch_scc1 wo_wm
  s_branch wo_abort
wo_wm_ok:
wo_lp:
  s_mul_i32 s26, s16, 10240
  s_add_u32 s27, s25, s26
  v_add_u32 v11, s26, v2
  s_lshl_b32 s26, s20, 6
  s_add_u32 s26, s26, s17
  s_lshl_b32 s26, s26, 4
  s_add_u32 s26, s26, 88582144
  v_lshlrev_b32 v60, 2, v3
  s_mov_b32 s30, 0
wo_pl:
  s_add_u32 s22, s27, 0
  buffer_load_dwordx4 v[128:131], v2, s[8:11], s22 offen offset:0 sc1
  buffer_load_dwordx4 v[132:135], v2, s[8:11], s22 offen offset:1024 sc1
  buffer_load_dwordx4 v[136:139], v2, s[8:11], s22 offen offset:2048 sc1
  buffer_load_dwordx4 v[140:143], v2, s[8:11], s22 offen offset:3072 sc1
  s_add_u32 s22, s27, 4096
  buffer_load_dwordx4 v[144:147], v2, s[8:11], s22 offen offset:0 sc1
  buffer_load_dwordx4 v[148:151], v2, s[8:11], s22 offen offset:1024 sc1
  buffer_load_dwordx4 v[152:155], v2, s[8:11], s22 offen offset:2048 sc1
  buffer_load_dwordx4 v[156:159], v2, s[8:11], s22 offen offset:3072 sc1
  s_add_u32 s22, s27, 8192
  buffer_load_dwordx4 v[160:163], v2, s[8:11], s22 offen offset:0 sc1
  buffer_load_dwordx4 v[164:167], v2, s[8:11], s22 offen offset:1024 sc1
  buffer_load_dword v61, v60, s[8:11], s26 offen sc1
  s_waitcnt vmcnt(1)
  v_max_u32 v62, v128, v129
  v_max3_u32 v62, v62, v130, v131
  v_max3_u32 v62, v62, v132, v133
  v_max3_u32 v62, v62, v134, v135
  v_max3_u32 v62, v62, v136, v137
  v_max3_u32 v62, v62, v138, v139
  v_max3_u32 v62, v62, v140, v141
  v_max3_u32 v62, v62, v142, v143
  v_max3_u32 v62, v62, v144, v145
  v_max3_u32 v62, v62, v146, v147
  v_max3_u32 v62, v62, v148, v149
  v_max3_u32 v62, v62, v150, v151
  v_max3_u32 v62, v62, v152, v153
  v_max3_u32 v62, v62, v154, v155
  v_max3_u32 v62, v62, v156, v157
  v_max3_u32 v62, v62, v158, v159
  v_max3_u32 v62, v62, v160, v161
  v_max3_u32 v62, v62, v162, v163
  v_max3_u32 v62, v62, v164, v165
  v_max3_u32 v62, v62, v166, v167
  v_cmp_eq_u32 vcc, -1, v62
  s_cbranch_vccz wo_pk
  s_add_u32 s30, s30, 1
  s_cmp_lt_u32 s30, 30000
  s_cbranch_scc1 wo_pl
  s_branch wo_abort
wo_pk:
  ds_write_b128 v11, v[128:131] offset:0
  ds_write_b128 v11, v[132:135] offset:1024
  ds_write_b128 v11, v[136:139] offset:2048
  ds_write_b128 v11, v[140:143] offset:3072
  ds_write_b128 v11, v[144:147] offset:4096
  ds_write_b128 v11, v[148:151] offset:5120
  ds_write_b128 v11, v[152:155] offset:6144
  ds_write_b128 v11, v[156:159] offset:7168
  ds_write_b128 v11, v[160:163] offset:8192
  ds_write_b128 v11, v[164:167] offset:9216
  s_waitcnt vmcnt(0)
  v_cmp_ne_u32 vcc, 1, v61
  s_mov_b32 s28, 0
  s_cbranch_vccnz wo_nt
  s_add_u32 s22, s24, 0
  buffer_load_dwordx2 v[28:29], v7, s[8:11], s22 offen offset:0 sc1
  buffer_load_dwordx2 v[30:31], v7, s[8:11], s22 offen offset:512 sc1
  buffer_load_dwordx2 v[32:33], v7, s[8:11], s22 offen offset:256 sc1
  buffer_load_dwordx2 v[34:35], v7, s[8:11], s22 offen offset:768 sc1
  buffer_load_dwordx2 v[36:37], v7, s[8:11], s22 offen offset:2048 sc1
  buffer_load_dwordx2 v[38:39], v7, s[8:11], s22 offen offset:2560 sc1
  buffer_load_dwordx2 v[40:41], v7, s[8:11], s22 offen offset:2304 sc1
  buffer_load_dwordx2 v[42:43], v7, s[8:11], s22 offen offset:2816 sc1
  s_add_u32 s22, s24, 4096
  buffer_load_dwordx2 v[44:45], v7, s[8:11], s22 offen offset:0 sc1
  buffer_load_dwordx2 v[46:47], v7, s[8:11], s22 offen offset:512 sc1
  buffer_load_dwordx2 v[48:49], v7, s[8:11], s22 offen offset:256 sc1
  buffer_load_dwordx2 v[50:51], v7, s[8:11], s22 offen offset:768 sc1
  buffer_load_dwordx2 v[52:53], v7, s[8:11], s22 offen offset:2048 sc1
  buffer_load_dwordx2 v[54:55], v7, s[8:11], s22 offen offset:2560 sc1
  buffer_load_dwordx2 v[56:57], v7, s[8:11], s22 offen offset:2304 sc1
  buffer_load_dwordx2 v[58:59], v7, s[8:11], s22 offen offset:2816 sc1
  s_mov_b32 s28, 1
wo_nt:
  s_cmp_lt_u32 s17, 56
  s_cbranch_scc1 pk_47
  buffer_load_dword v250, v251, s[12:15], 0 offen sc1
pk_47:
  s_waitcnt lgkmcnt(0)
  s_barrier
  buffer_load_dword v61, v60, s[8:11], s26 offen sc1
  ds_read_b128 v[64:67], v6 offset:0
  ds_read_b128 v[68:71], v6 offset:512
  ds_read_b128 v[72:75], v6 offset:1024
  ds_read_b128 v[76:79], v6 offset:1536
  ds_read_b128 v[80:83], v6 offset:2048
  ds_read_b128 v[84:87], v6 offset:2560
  ds_read_b128 v[88:91], v6 offset:3072
  s_waitcnt lgkmcnt(6)
  v_mfma_f32_32x32x16_bf16 v[12:27], a[0:3], v[64:67], 0
  ds_read_b128 v[92:95], v6 offset:3584
  s_waitcnt lgkmcnt(6)
  v_mfma_f32_32x32x16_bf16 v[12:27], a[4:7], v[68:71], v[12:27]
  ds_read_b128 v[64:67], v6 offset:4096
  s_waitcnt lgkmcnt(6)
  v_mfma_f32_32x32x16_bf16 v[12:27], a[8:11], v[72:75], v[12:27]
  ds_read_b128 v[68:71], v6 offset:4608
  s_waitcnt lgkmcnt(6)
  v_mfma_f32_32x32x16_bf16 v[12:27], a[12:15], v[76:79], v[12:27]
  ds_read_b128 v[72:75], v6 offset:5120
  s_waitcnt lgkmcnt(6)
  v_mfma_f32_32x32x16_bf16 v[12:27], a[16:19], v[80:83], v[12:27]
  ds_read_b128 v[76:79], v6 offset:5632
  s_waitcnt lgkmcnt(6)
  v_mfma_f32_32x32x16_bf16 v[12:27], a[20:23], v[84:87], v[12:27]
  ds_read_b128 v[80:83], v6 offset:6144
  s_waitcnt lgkmcnt(6)
  v_mfma_f32_32x32x16_bf16 v[12:27], a[24:27], v[88:91], v[12:27]
  ds_read_b128 v[84:87], v6 offset:6656
  s_waitcnt lgkmcnt(6)
  v_mfma_f32_32x32x16_bf16 v[12:27], a[28:31], v[92:95], v[12:27]
  ds_read_b128 v[88:91], v6 offset:7168
  s_waitcnt lgkmcnt(6)
  v_mfma_f32_32x32x16_bf16 v[12:27], a[32:35], v[64:67], v[12:27]
  ds_read_b128 v[92:95], v6 offset:7680
  s_waitcnt lgkmcnt(6)
  v_mfma_f32_32x32x16_bf16 v[12:27], a[36:39], v[68:71], v[12:27]
  ds_read_b128 v[64:67], v6 offset:8192
  s_waitcnt lgkmcnt(6)
  v_mfma_f32_32x32x16_bf16 v[12:27], a[40:43], v[72:75], v[12:27]
  ds_read_b128 v[68:71], v6 offset:8704
  s_waitcnt lgkmcnt(6)
  v_mfma_f32_32x32x16_bf16 v[12:27], a[44:47], v[76:79], v[12:27]
  ds_read_b128 v[72:75], v6 offset:9216
  s_waitcnt lgkmcnt(6)
  v_mfma_f32_32x32x16_bf16 v[12:27], a[48:51], v[80:83], v[12:27]
  ds_read_b128 v[76:79], v6 offset:9728
  s_waitcnt lgkmcnt(6)
  v_mfma_f32_32x32x16_bf16 v[12:27], a[52:55], v[84:87], v[12:27]
  ds_read_b128 v[80:83], v6 offset:10240
  s_waitcnt lgkmcnt(6)
  v_mfma_f32_32x32x16_bf16 v[12:27], a[56:59], v[88:91], v[12:27]
  ds_read_b128 v[84:87], v6 offset:10752
  s_waitcnt lgkmcnt(6)
  v_mfma_f32_32x32x16_bf16 v[12:27], a[60:63], v[92:95], v[12:27]
  ds_read_b128 v[88:91], v6 offset:11264
  s_waitcnt lgkmcnt(6)
  v_mfma_f32_32x32x16_bf16 v[12:27], a[64:67], v[64:67], v[12:27]
  ds_read_b128 v[92:95], v6 offset:11776
  s_waitcnt lgkmcnt(6)
  v_mfma_f32_32x32x16_bf16 v[12:27], a[68:71], v[68:71], v[12:27]
  ds_read_b128 v[64:67], v6 offset:12288
  s_waitcnt lgkmcnt(6)
  v_mfma_f32_32x32x16_bf16 v[12:27], a[72:75], v[72:75], v[12:27]
  ds_read_b128 v[68:71], v6 offset:12800
  s_waitcnt lgkmcnt(6)
  v_mfma_f32_32x32x16_bf16 v[12:27], a[76:79], v[76:79], v[12:27]
  s_cmp_lg_u32 s28, 0
  s_cbranch_scc1 wo_h2
  s_waitcnt vmcnt(0)
  v_cmp_ne_u32 vcc, 1, v61
  s_cbranch_vccnz wo_h2
  s_add_u32 s22, s24, 0
  buffer_load_dwordx2 v[28:29], v7, s[8:11], s22 offen offset:0 sc1
  buffer_load_dwordx2 v[30:31], v7, s[8:11], s22 offen offset:512 sc1
  buffer_load_dwordx2 v[32:33], v7, s[8:11], s22 offen offset:256 sc1
  buffer_load_dwordx2 v[34:35], v7, s[8:11], s22 offen offset:768 sc1
  buffer_load_dwordx2 v[36:37], v7, s[8:11], s22 offen offset:2048 sc1
  buffer_load_dwordx2 v[38:39], v7, s[8:11], s22 offen offset:2560 sc1
  buffer_load_dwordx2 v[40:41], v7, s[8:11], s22 offen offset:2304 sc1
  buffer_load_dwordx2 v[42:43], v7, s[8:11], s22 offen offset:2816 sc1
  s_add_u32 s22, s24, 4096
  buffer_load_dwordx2 v[44:45], v7, s[8:11], s22 offen offset:0 sc1
  buffer_load_dwordx2 v[46:47], v7, s[8:11], s22 offen offset:512 sc1
  buffer_load_dwordx2 v[48:49], v7, s[8:11], s22 offen offset:256 sc1
  buffer_load_dwordx2 v[50:51], v7, s[8:11], s22 offen offset:768 sc1
  buffer_load_dwordx2 v[52:53], v7, s[8:11], s22 offen offset:2048 sc1
  buffer_load_dwordx2 v[54:55], v7, s[8:11], s22 offen offset:2560 sc1
  buffer_load_dwordx2 v[56:57], v7, s[8:11], s22 offen offset:2304 sc1
  buffer_load_dwordx2 v[58:59], v7, s[8:11], s22 offen offset:2816 sc1
  s_mov_b32 s28, 1
wo_h2:
  ds_read_b128 v[72:75], v6 offset:13312
  s_waitcnt lgkmcnt(6)
  v_mfma_f32_32x32x16_bf16 v[12:27], a[80:83], v[80:83], v[12:27]
  ds_read_b128 v[76:79], v6 offset:13824
  s_waitcnt lgkmcnt(6)
  v_mfma_f32_32x32x16_bf16 v[12:27], a[84:87], v[84:87], v[12:27]
  ds_read_b128 v[80:83], v6 offset:14336
  s_waitcnt lgkmcnt(6)
  v_mfma_f32_32x32x16_bf16 v[12:27], a[88:91], v[88:91], v[12:27]
  ds_read_b128 v[84:87], v6 offset:14848
  s_waitcnt lgkmcnt(6)
  v_mfma_f32_32x32x16_bf16 v[12:27], a[92:95], v[92:95], v[12:27]
  ds_read_b128 v[88:91], v6 offset:15360
  s_waitcnt lgkmcnt(6)
  v_mfma_f32_32x32x16_bf16 v[12:27], a[96:99], v[64:67], v[12:27]
  ds_read_b128 v[92:95], v6 offset:15872
  s_waitcnt lgkmcnt(6)
  v_mfma_f32_32x32x16_bf16 v[12:27], a[100:103], v[68:71], v[12:27]
  ds_read_b128 v[64:67], v6 offset:16384
  s_waitcnt lgkmcnt(6)
  v_mfma_f32_32x32x16_bf16 v[12:27], a[104:107], v[72:75], v[12:27]
  ds_read_b128 v[68:71], v6 offset:16896
  s_waitcnt lgkmcnt(6)
  v_mfma_f32_32x32x16_bf16 v[12:27], a[108:111], v[76:79], v[12:27]
  ds_read_b128 v[72:75], v6 offset:17408
  s_waitcnt lgkmcnt(6)
  v_mfma_f32_32x32x16_bf16 v[12:27], a[112:115], v[80:83], v[12:27]
  ds_read_b128 v[76:79], v6 offset:17920
  s_waitcnt lgkmcnt(6)
  v_mfma_f32_32x32x16_bf16 v[12:27], a[116:119], v[84:87], v[12:27]
  ds_read_b128 v[80:83], v6 offset:18432
  s_waitcnt lgkmcnt(6)
  v_mfma_f32_32x32x16_bf16 v[12:27], a[120:123], v[88:91], v[12:27]
  ds_read_b128 v[84:87], v6 offset:18944
  s_waitcnt lgkmcnt(6)
  v_mfma_f32_32x32x16_bf16 v[12:27], a[124:127], v[92:95], v[12:27]
  s_cmp_lg_u32 s28, 0
  s_cbranch_scc1 wo_ht
  v_lshlrev_b32 v60, 2, v3
  s_mov_b32 s30, 0
wo_wt:
  buffer_load_dword v61, v60, s[8:11], s26 offen sc1
  s_waitcnt vmcnt(0)
  v_cmp_ne_u32 vcc, 1, v61
  s_cbranch_vccz wo_wt_ok
  s_sleep 1
  s_cmp_ge_u32 s17, 61
  s_cbranch_scc1 wo_wt_bo
  s_sleep 4
  s_cmp_ge_u32 s17, 56
  s_cbranch_scc1 wo_wt_bo
  s_sleep 40
wo_wt_bo:
  s_add_u32 s30, s30, 1
  s_cmp_lt_u32 s30, 30000
  s_cbranch_scc1 wo_wt
  s_branch wo_abort
wo_wt_ok:
  s_add_u32 s22, s24, 0
  buffer_load_dwordx2 v[28:29], v7, s[8:11], s22 offen offset:0 sc1
  buffer_load_dwordx2 v[30:31], v7, s[8:11], s22 offen offset:512 sc1
  buffer_load_dwordx2 v[32:33], v7, s[8:11], s22 offen offset:256 sc1
  buffer_load_dwordx2 v[34:35], v7, s[8:11], s22 offen offset:768 sc1
  buffer_load_dwordx2 v[36:37], v7, s[8:11], s22 offen offset:2048 sc1
  buffer_load_dwordx2 v[38:39], v7, s[8:11], s22 offen offset:2560 sc1
  buffer_load_dwordx2 v[40:41], v7, s[8:11], s22 offen offset:2304 sc1
  buffer_load_dwordx2 v[42:43], v7, s[8:11], s22 offen offset:2816 sc1
  s_add_u32 s22, s24, 4096
  buffer_load_dwordx2 v[44:45], v7, s[8:11], s22 offen offset:0 sc1
  buffer_load_dwordx2 v[46:47], v7, s[8:11], s22 offen offset:512 sc1
  buffer_load_dwordx2 v[48:49], v7, s[8:11], s22 offen offset:256 sc1
  buffer_load_dwordx2 v[50:51], v7, s[8:11], s22 offen offset:768 sc1
  buffer_load_dwordx2 v[52:53], v7, s[8:11], s22 offen offset:2048 sc1
  buffer_load_dwordx2 v[54:55], v7, s[8:11], s22 offen offset:2560 sc1
  buffer_load_dwordx2 v[56:57], v7, s[8:11], s22 offen offset:2304 sc1
  buffer_load_dwordx2 v[58:59], v7, s[8:11], s22 offen offset:2816 sc1
wo_ht:
  ds_read_b128 v[88:91], v6 offset:19456
  s_waitcnt lgkmcnt(6) vmcnt(0)
  v_mfma_f32_32x32x16_bf16 v[12:27], v[28:31], v[64:67], v[12:27]
  ds_read_b128 v[92:95], v6 offset:19968
  s_waitcnt lgkmcnt(6)
  v_mfma_f32_32x32x16_bf16 v[12:27], v[32:35], v[68:71], v[12:27]
  s_waitcnt lgkmcnt(5)
  v_mfma_f32_32x32x16_bf16 v[12:27], v[36:39], v[72:75], v[12:27]
  s_waitcnt lgkmcnt(4)
  v_mfma_f32_32x32x16_bf16 v[12:27], v[40:43], v[76:79], v[12:27]
  s_waitcnt lgkmcnt(3)
  v_mfma_f32_32x32x16_bf16 v[12:27], v[44:47], v[80:83], v[12:27]
  s_waitcnt lgkmcnt(2)
  v_mfma_f32_32x32x16_bf16 v[12:27], v[48:51], v[84:87], v[12:27]
  s_waitcnt lgkmcnt(1)
  v_mfma_f32_32x32x16_bf16 v[12:27], v[52:55], v[88:91], v[12:27]
  s_waitcnt lgkmcnt(0)
  v_mfma_f32_32x32x16_bf16 v[12:27], v[56:59], v[92:95], v[12:27]
  v_mul_u32_u24 v9, 240, v9
  s_movk_i32 s23, 240
  v_lshl_add_u32 v8, v8, 3, v9
  s_mul_i32 s22, s16, 24
  v_add_u32 v7, s22, v8
  s_lshl_b32 s22, s16, 5
  v_add_u32 v8, s22, v8
  v_min_u32 v11, 223, v0
  v_mul_u32_u24 v9, 4682, v11
  v_lshrrev_b32 v9, 16, v9
  v_mul_u32_u24 v10, 14, v9
  v_sub_u32 v10, v11, v10
  v_cmp_gt_u32 vcc, 8, v10
  v_lshlrev_b32 v10, 4, v10
  v_mad_u32_u24 v11, v9, s23, v10
  v_mul_u32_u24 v9, 1792, v9
  v_add_u32 v10, v9, v10
  s_lshl_b32 s22, s18, 7
  s_mul_i32 s27, s18, 96
  s_add_u32 s27, s27, 384
  v_mov_b32 v9, s22
  v_mov_b32 v5, s27
  v_cndmask_b32 v9, v5, v9, vcc
  v_add_u32 v10, v9, v10
  s_mul_i32 s26, s17, 57344
  s_add_u32 s26, s26, 896
  s_add_u32 s27, s26, 28672
  v_cvt_pk_bf16_f32 v96, v12, v13
  v_cvt_pk_bf16_f32 v97, v14, v15
  ds_write_b64 v8, v[96:97] offset:49152
  v_cvt_pk_bf16_f32 v98, v16, v17
  v_cvt_pk_bf16_f32 v99, v18, v19
  ds_write_b64 v8, v[98:99] offset:49168
  v_cvt_pk_bf16_f32 v100, v20, v21
  v_cvt_pk_bf16_f32 v101, v22, v23
  ds_write_b64 v7, v[100:101] offset:49280
  v_cvt_pk_bf16_f32 v102, v24, v25
  v_cvt_pk_bf16_f32 v103, v26, v27
  s_mov_b32 exec_hi, 0
  ds_write_b64 v7, v[102:103] offset:49296
  s_mov_b64 exec, -1
  s_waitcnt lgkmcnt(0)
  s_barrier
  ds_read_b128 v[104:107], v11 offset:49152
  ds_read_b128 v[108:111], v11 offset:52992
  s_cmp_lg_u32 s16, 3
  s_cselect_b32 exec_hi, -1, 0
  s_waitcnt lgkmcnt(1)
  buffer_store_dwordx4 v[104:107], v10, s[92:95], s26 offen
  s_waitcnt lgkmcnt(0)
  buffer_store_dwordx4 v[108:111], v10, s[92:95], s27 offen
  s_mov_b64 exec, -1
  v_readfirstlane_b32 s22, v250
  s_cmp_ge_u32 s22, 1440
  s_cbranch_scc1 ch_end
  s_branch wk_loop
wp_abort:
wo_abort:
  s_branch cA_abort
ch_end:
  s_endpgm

.section .rodata,"a"
.p2align 6
.amdhsa_kernel main_kernel
  .amdhsa_next_free_vgpr 512
  .amdhsa_next_free_sgpr 102
  .amdhsa_accum_offset 256
  .amdhsa_group_segment_fixed_size 0
  .amdhsa_kernarg_size 136
  .amdhsa_user_sgpr_count 2
  .amdhsa_user_sgpr_kernarg_segment_ptr 1
  .amdhsa_system_sgpr_workgroup_id_x 1
.end_amdhsa_kernel
```

```asm
; @launch kernel=main_kernel grid=(256,1,1) block=(256,1,1) lds=163840
.amdgcn_target "amdgcn-amd-amdhsa--gfx950"
.text
.globl main_kernel
.p2align 8
.type main_kernel,@function
main_kernel:
  s_cmp_ge_u32 s2, 256
  s_cbranch_scc1 ch_end
  s_load_dwordx4 s[4:7], s[0:1], 120
  s_load_dwordx2 s[92:93], s[0:1], 112
  s_load_dwordx8 s[36:43], s[0:1], 56
  s_load_dwordx4 s[44:47], s[0:1], 88
  s_memrealtime s[88:89]
  s_getpc_b64 s[98:99]
pf_main_kernel_1:
  s_sub_u32 s98, s98, pf_main_kernel_1-main_kernel
  s_subb_u32 s99, s99, 0
  s_lshr_b32 s20, s2, 3
  v_lshl_add_u32 v60, v0, 5, s20
  v_lshlrev_b32 v60, 7, v60
  v_min_u32 v60, ch_end-main_kernel-4, v60
  v_cmp_gt_u32 vcc, 32, v0
  s_and_saveexec_b64 s[22:23], vcc
  s_cbranch_execz pf_main_kernel_1_n
  global_load_dword v62, v60, s[98:99]
pf_main_kernel_1_n:
  s_mov_b64 exec, -1
  s_getreg_b32 s67, hwreg(HW_REG_XCC_ID)
  s_and_b32 s67, s67, 7
  v_lshrrev_b32 v1, 6, v0
  s_nop 0
  v_readfirstlane_b32 s16, v1
  s_mov_b32 s66, 0
  s_mov_b32 s68, 0
  s_mov_b32 s69, 0
  s_mov_b32 s96, 0
  s_mov_b32 s97, 0
  s_mov_b32 s101, 0x5eed0000
  s_sub_u32 s20, s67, 0
  s_lshr_b32 s21, s2, 3
  s_and_b32 s20, s20, 7
  s_lshl_b32 s3, s20, 5
  s_add_u32 s3, s3, s21
  s_waitcnt lgkmcnt(0)
  s_mov_b32 s8, s6
  s_and_b32 s9, s7, 0xffff
  s_mov_b32 s10, 0x10000000
  s_mov_b32 s11, 0x20000
  s_mov_b32 s12, s4
  s_and_b32 s13, s5, 0xffff
  s_mov_b32 s14, 256
  s_mov_b32 s15, 0x20000
  s_or_b32 s88, s88, 1
  s_and_b32 s93, s93, 0xffff
  s_mov_b32 s94, 3670016
  s_mov_b32 s95, 0x20000
m_start:
  s_cmp_ge_u32 s3, 32
  s_cbranch_scc1 m_bjob
  v_and_b32 v1, 63, v0
  v_lshlrev_b32 v2, 4, v1
  v_lshrrev_b32 v116, 4, v1
  v_and_b32 v117, 15, v1
  v_mov_b32 v3, 0x4444
  v_mov_b32 v118, 0xeeee
  v_cmp_lt_u32 vcc, 7, v117
  s_nop 1
  v_cndmask_b32 v3, v3, v118, vcc
  s_and_b32 s17, s3, 15
  s_cmp_ge_u32 s3, 16
  s_cbranch_scc1 m_val
  s_mov_b32 s60, s42
  s_and_b32 s61, s43, 0xffff
  s_mov_b32 s62, 3670016
  s_mov_b32 s63, 0x20000
  v_lshrrev_b32 v24, 5, v1
  v_and_b32 v25, 31, v1
  s_lshl_b32 s26, s17, 9
  s_lshl_b32 s25, s16, 12
  v_xor_b32 v26, v25, v24
  v_lshlrev_b32 v26, 4, v26
  v_lshl_add_u32 v26, v24, 13, v26
  v_xor_b32 v100, 0, v26
  v_xor_b32 v101, 0, v26
  v_add_u32 v101, 15360, v101
  v_xor_b32 v102, 32, v26
  v_add_u32 v102, 30720, v102
  v_xor_b32 v103, 32, v26
  v_add_u32 v103, 46080, v103
  s_lshl_b32 s23, s16, 19
  s_add_u32 s23, s23, s26
  s_add_u32 m0, s25, 16384
  s_nop 0
  buffer_load_dwordx4 v100, s[60:63], s23 offen offset:0 lds
  buffer_load_dwordx4 v101, s[60:63], s23 offen offset:1024 lds
  buffer_load_dwordx4 v102, s[60:63], s23 offen offset:2048 lds
  buffer_load_dwordx4 v103, s[60:63], s23 offen offset:3072 lds
  s_add_u32 m0, s25, 32768
  s_add_u32 s23, s23, 65536
  buffer_load_dwordx4 v100, s[60:63], s23 offen offset:0 lds
  buffer_load_dwordx4 v101, s[60:63], s23 offen offset:1024 lds
  buffer_load_dwordx4 v102, s[60:63], s23 offen offset:2048 lds
  buffer_load_dwordx4 v103, s[60:63], s23 offen offset:3072 lds
  v_xor_b32 v100, 64, v100
  v_xor_b32 v101, 64, v101
  v_xor_b32 v102, 64, v102
  v_xor_b32 v103, 64, v103
  s_add_u32 m0, s25, 49152
  s_add_u32 s23, s23, 65536
  buffer_load_dwordx4 v100, s[60:63], s23 offen offset:0 lds
  buffer_load_dwordx4 v101, s[60:63], s23 offen offset:1024 lds
  buffer_load_dwordx4 v102, s[60:63], s23 offen offset:2048 lds
  buffer_load_dwordx4 v103, s[60:63], s23 offen offset:3072 lds
  s_add_u32 m0, s25, 65536
  s_add_u32 s23, s23, 65536
  buffer_load_dwordx4 v100, s[60:63], s23 offen offset:0 lds
  buffer_load_dwordx4 v101, s[60:63], s23 offen offset:1024 lds
  buffer_load_dwordx4 v102, s[60:63], s23 offen offset:2048 lds
  buffer_load_dwordx4 v103, s[60:63], s23 offen offset:3072 lds
  v_xor_b32 v100, 192, v100
  v_xor_b32 v101, 192, v101
  v_xor_b32 v102, 192, v102
  v_xor_b32 v103, 192, v103
  s_add_u32 m0, s25, 81920
  s_add_u32 s23, s23, 65536
  buffer_load_dwordx4 v100, s[60:63], s23 offen offset:0 lds
  buffer_load_dwordx4 v101, s[60:63], s23 offen offset:1024 lds
  buffer_load_dwordx4 v102, s[60:63], s23 offen offset:2048 lds
  buffer_load_dwordx4 v103, s[60:63], s23 offen offset:3072 lds
  s_add_u32 m0, s25, 98304
  s_add_u32 s23, s23, 65536
  buffer_load_dwordx4 v100, s[60:63], s23 offen offset:0 lds
  buffer_load_dwordx4 v101, s[60:63], s23 offen offset:1024 lds
  buffer_load_dwordx4 v102, s[60:63], s23 offen offset:2048 lds
  buffer_load_dwordx4 v103, s[60:63], s23 offen offset:3072 lds
  v_xor_b32 v100, 64, v100
  v_xor_b32 v101, 64, v101
  v_xor_b32 v102, 64, v102
  v_xor_b32 v103, 64, v103
  s_add_u32 m0, s25, 114688
  s_add_u32 s23, s23, 65536
  buffer_load_dwordx4 v100, s[60:63], s23 offen offset:0 lds
  buffer_load_dwordx4 v101, s[60:63], s23 offen offset:1024 lds
  buffer_load_dwordx4 v102, s[60:63], s23 offen offset:2048 lds
  buffer_load_dwordx4 v103, s[60:63], s23 offen offset:3072 lds
  s_add_u32 m0, s25, 131072
  s_add_u32 s23, s23, 65536
  buffer_load_dwordx4 v100, s[60:63], s23 offen offset:0 lds
  buffer_load_dwordx4 v101, s[60:63], s23 offen offset:1024 lds
  buffer_load_dwordx4 v102, s[60:63], s23 offen offset:2048 lds
  buffer_load_dwordx4 v103, s[60:63], s23 offen offset:3072 lds
  s_mov_b32 s56, s40
  s_and_b32 s57, s41, 0xffff
  s_mov_b32 s58, 3670016
  s_mov_b32 s59, 0x20000
  s_lshl_b32 s21, s16, 16
  s_add_u32 s27, s26, s21
  s_lshr_b32 s20, s16, 1
  s_lshl_b32 s20, s20, 6
  v_xor_b32 v26, s20, v26
  v_xor_b32 v4, 0, v26
  v_xor_b32 v5, 32, v26
  v_add_u32 v5, 15360, v5
  v_xor_b32 v6, 128, v26
  v_add_u32 v6, 30720, v6
  v_xor_b32 v7, 160, v26
  v_add_u32 v7, 46080, v7
  s_add_u32 s22, s27, 0
  s_add_u32 m0, s25, 0
  s_nop 0
  buffer_load_dwordx4 v4, s[56:59], s22 offen offset:0 lds
  buffer_load_dwordx4 v5, s[56:59], s22 offen offset:1024 lds
  buffer_load_dwordx4 v6, s[56:59], s22 offen offset:2048 lds
  buffer_load_dwordx4 v7, s[56:59], s22 offen offset:3072 lds
  s_cmp_lg_u32 s66, 0
  s_cbranch_scc1 sc_ci
  s_cmp_lg_u32 s16, 0
  s_cbranch_scc1 w0_2
  s_lshr_b32 s70, s3, 5
  s_and_b32 s71, s70, 4
  s_mul_i32 s71, s71, 12
  s_lshl_b32 s70, s70, 2
  s_add_u32 s70, s70, s71
  s_lshl_b32 s71, 1, s3
  v_mov_b32 v248, s71
  v_mov_b32 v249, 32
  s_mov_b64 exec, 1
  buffer_atomic_or v248, v249, s[12:15], s70 offen sc0
  buffer_load_dwordx2 v[250:251], v249, s[12:15], 0 offen offset:96 sc1
  s_mov_b64 exec, -1
w0_2:
sc_ci:
  v_and_b32 v26, 15, v25
  v_xor_b32 v27, v26, v24
  v_lshlrev_b32 v27, 4, v27
  v_bfe_u32 v28, v25, 2, 1
  v_lshlrev_b32 v28, 4, v28
  v_lshrrev_b32 v29, 3, v25
  v_lshl_add_u32 v28, v29, 2, v28
  v_and_b32 v29, 3, v25
  v_add_u32 v28, v28, v29
  v_lshl_add_u32 v28, v28, 9, v27
  v_lshrrev_b32 v29, 2, v26
  v_lshlrev_b32 v29, 15, v29
  v_bfe_u32 v30, v26, 1, 1
  v_lshl_add_u32 v29, v30, 11, v29
  v_lshrrev_b32 v30, 4, v25
  v_lshl_add_u32 v29, v30, 10, v29
  v_and_b32 v31, 1, v26
  v_lshl_add_u32 v29, v31, 9, v29
  v_add_u32 v29, v29, v27
  v_add_u32 v29, s25, v29
  v_xor_b32 v8, 0, v28
  v_xor_b32 v104, 0, v29
  v_xor_b32 v9, 32, v28
  v_xor_b32 v105, 32, v29
  v_xor_b32 v10, 64, v28
  v_xor_b32 v106, 64, v29
  v_xor_b32 v11, 96, v28
  v_xor_b32 v107, 96, v29
  v_xor_b32 v12, 128, v28
  v_xor_b32 v108, 128, v29
  v_xor_b32 v13, 160, v28
  v_xor_b32 v109, 160, v29
  v_xor_b32 v14, 192, v28
  v_xor_b32 v110, 192, v29
  v_xor_b32 v15, 224, v28
  v_xor_b32 v111, 224, v29
  s_mov_b32 s52, 1035512379
  s_waitcnt vmcnt(4)
  ds_read_b128 v[120:123], v104 offset:16384
  ds_read_b128 v[124:127], v105 offset:16384
  ds_read_b128 v[128:131], v106 offset:16384
  ds_read_b128 v[132:135], v107 offset:16384
  ds_read_b128 v[136:139], v108 offset:16384
  ds_read_b128 v[140:143], v109 offset:16384
  ds_read_b128 v[144:147], v110 offset:16384
  ds_read_b128 v[148:151], v111 offset:16384
  s_waitcnt lgkmcnt(4)
  ds_read_b128 v[152:155], v104 offset:16640
  ds_read_b128 v[156:159], v105 offset:16640
  ds_read_b128 v[160:163], v106 offset:16640
  ds_read_b128 v[164:167], v107 offset:16640
  ds_read_b128 v[168:171], v108 offset:16640
  ds_read_b128 v[172:175], v109 offset:16640
  ds_read_b128 v[176:179], v110 offset:16640
  ds_read_b128 v[180:183], v111 offset:16640
  s_waitcnt lgkmcnt(4)
  ds_read_b128 v[184:187], v104 offset:32768
  ds_read_b128 v[188:191], v105 offset:32768
  ds_read_b128 v[192:195], v106 offset:32768
  ds_read_b128 v[196:199], v107 offset:32768
  ds_read_b128 v[200:203], v108 offset:32768
  ds_read_b128 v[204:207], v109 offset:32768
  ds_read_b128 v[208:211], v110 offset:32768
  ds_read_b128 v[212:215], v111 offset:32768
  s_waitcnt lgkmcnt(4)
  ds_read_b128 v[216:219], v104 offset:33024
  ds_read_b128 v[220:223], v105 offset:33024
  ds_read_b128 v[224:227], v106 offset:33024
  ds_read_b128 v[228:231], v107 offset:33024
  ds_read_b128 v[232:235], v108 offset:33024
  ds_read_b128 v[236:239], v109 offset:33024
  ds_read_b128 v[240:243], v110 offset:33024
  ds_read_b128 v[244:247], v111 offset:33024
  s_waitcnt lgkmcnt(4)
  s_waitcnt lgkmcnt(0)
  s_add_u32 s22, s27, 262144
  s_add_u32 m0, s25, 16384
  s_nop 0
  buffer_load_dwordx4 v4, s[56:59], s22 offen offset:0 lds
  buffer_load_dwordx4 v5, s[56:59], s22 offen offset:1024 lds
  buffer_load_dwordx4 v6, s[56:59], s22 offen offset:2048 lds
  buffer_load_dwordx4 v7, s[56:59], s22 offen offset:3072 lds
  s_add_u32 s22, s27, 524288
  s_add_u32 m0, s25, 32768
  s_nop 0
  buffer_load_dwordx4 v4, s[56:59], s22 offen offset:0 lds
  buffer_load_dwordx4 v5, s[56:59], s22 offen offset:1024 lds
  buffer_load_dwordx4 v6, s[56:59], s22 offen offset:2048 lds
  buffer_load_dwordx4 v7, s[56:59], s22 offen offset:3072 lds
  s_add_u32 s22, s27, 786432
  s_add_u32 m0, s25, 49152
  s_nop 0
  buffer_load_dwordx4 v4, s[56:59], s22 offen offset:0 lds
  buffer_load_dwordx4 v5, s[56:59], s22 offen offset:1024 lds
  buffer_load_dwordx4 v6, s[56:59], s22 offen offset:2048 lds
  buffer_load_dwordx4 v7, s[56:59], s22 offen offset:3072 lds
  s_cmp_lg_u32 s66, 0
  s_cbranch_scc1 sc_cf
  s_cmp_lg_u32 s16, 0
  s_cbranch_scc1 w0_3
  s_waitcnt vmcnt(12)
  v_readfirstlane_b32 s70, v250
  s_cmp_lg_u32 s70, 0
  s_cbranch_scc1 sc_nz
  v_mov_b32 v249, 128
  v_mov_b32 v250, s88
  v_mov_b32 v251, s89
  v_mov_b32 v252, 0
  v_mov_b32 v253, 0
  s_mov_b64 exec, 1
  buffer_atomic_cmpswap_x2 v[250:253], v249, s[12:15], 0 offen sc0
  s_mov_b64 exec, -1
  s_waitcnt vmcnt(0)
  v_readfirstlane_b32 s70, v250
  s_cmp_lg_u32 s70, 0
  s_cbranch_scc1 sc_nz
  v_mov_b32 v250, s88
  v_mov_b32 v251, s89
sc_nz:
w0_3:
  v_mov_b32 v249, 160000
  s_add_u32 s101, s101, 1
  s_barrier
  s_mov_b64 exec, 1
  s_cmp_lg_u32 s16, 0
  s_cbranch_scc1 w0_4
  ds_write_b32 v249, v248 offset:0
  ds_write_b32 v249, v250 offset:4
  ds_write_b32 v249, v251 offset:8
  s_waitcnt lgkmcnt(0)
  v_mov_b32 v248, s101
  ds_write_b32 v249, v248 offset:16
  s_waitcnt lgkmcnt(0)
w0_4:
  s_mov_b64 exec, -1
  s_barrier
  ds_read_b32 v248, v249 offset:0
  ds_read_b32 v250, v249 offset:4
  ds_read_b32 v251, v249 offset:8
  ds_read_b32 v249, v249 offset:16
  s_waitcnt lgkmcnt(0)
  v_readfirstlane_b32 s70, v248
  v_readfirstlane_b32 s88, v250
  v_readfirstlane_b32 s89, v251
  v_cmp_ne_u32 vcc, s101, v249
  s_cbranch_vccnz ch_end
  s_mov_b32 s66, 1
  s_bitcmp1_b32 s70, s3
  s_cbranch_scc1 m_reclaim
sc_cf:
  s_cmp_lg_u32 s16, 0
  s_cbranch_scc1 w0_5
  s_cmp_eq_u32 s67, 0
  s_cselect_b32 s20, 1, 0x10001
  v_mov_b32 v248, s20
  v_mov_b32 v249, 0
  s_mov_b64 exec, 1
  buffer_atomic_add v248, v249, s[12:15], 0 offen
  s_mov_b64 exec, -1
w0_5:
  s_lshl_b32 s28, s17, 7
  s_add_u32 s28, s28, 88635392
  v_min_u32 v113, 96, v2
  s_mov_b32 s29, 88602624
  v_add_u32 v112, 1024, v2
  v_min_u32 v112, 1776, v112
  s_mul_i32 s32, s17, 401408
  s_mul_i32 s33, s16, 14336
  s_add_u32 s32, s32, s33
  s_add_u32 s33, s32, s33
  s_add_u32 s32, s32, 344064
  s_add_u32 s33, s33, 229376
  s_waitcnt vmcnt(8)
  s_barrier
  ds_read_b128 v[16:19], v8 offset:0
  ds_read_b128 v[20:23], v9 offset:0
  ds_read_b128 v[24:27], v10 offset:0
  ds_read_b128 v[28:31], v11 offset:0
  s_waitcnt lgkmcnt(3)
  v_mfma_f32_32x32x16_bf16 v[32:47], v[16:19], v[120:123], 0
  s_add_u32 s22, s27, 1048576
  s_add_u32 m0, s25, 65536
  s_nop 0
  buffer_load_dwordx4 v4, s[56:59], s22 offen offset:0 lds
  v_mfma_f32_32x32x16_bf16 v[48:63], v[16:19], v[184:187], 0
  ds_read_b128 v[16:19], v12 offset:0
  s_waitcnt lgkmcnt(3)
  v_mfma_f32_32x32x16_bf16 v[32:47], v[20:23], v[124:127], v[32:47]
  buffer_load_dwordx4 v5, s[56:59], s22 offen offset:1024 lds
  v_mfma_f32_32x32x16_bf16 v[48:63], v[20:23], v[188:191], v[48:63]
  ds_read_b128 v[20:23], v13 offset:0
  s_waitcnt lgkmcnt(3)
  v_mfma_f32_32x32x16_bf16 v[32:47], v[24:27], v[128:131], v[32:47]
  buffer_load_dwordx4 v6, s[56:59], s22 offen offset:2048 lds
  v_mfma_f32_32x32x16_bf16 v[48:63], v[24:27], v[192:195], v[48:63]
  ds_read_b128 v[24:27], v14 offset:0
  s_waitcnt lgkmcnt(3)
  v_mfma_f32_32x32x16_bf16 v[32:47], v[28:31], v[132:135], v[32:47]
  buffer_load_dwordx4 v7, s[56:59], s22 offen offset:3072 lds
  v_mfma_f32_32x32x16_bf16 v[48:63], v[28:31], v[196:199], v[48:63]
  ds_read_b128 v[28:31], v15 offset:0
  s_waitcnt lgkmcnt(3)
  v_mfma_f32_32x32x16_bf16 v[32:47], v[16:19], v[136:139], v[32:47]
  s_add_u32 s22, s27, 1310720
  s_add_u32 m0, s25, 81920
  s_nop 0
  buffer_load_dwordx4 v4, s[56:59], s22 offen offset:0 lds
  v_mfma_f32_32x32x16_bf16 v[48:63], v[16:19], v[200:203], v[48:63]
  ds_read_b128 v[16:19], v8 offset:256
  s_waitcnt lgkmcnt(3)
  v_mfma_f32_32x32x16_bf16 v[32:47], v[20:23], v[140:143], v[32:47]
  buffer_load_dwordx4 v5, s[56:59], s22 offen offset:1024 lds
  v_mfma_f32_32x32x16_bf16 v[48:63], v[20:23], v[204:207], v[48:63]
  ds_read_b128 v[20:23], v9 offset:256
  s_waitcnt lgkmcnt(3)
  v_mfma_f32_32x32x16_bf16 v[32:47], v[24:27], v[144:147], v[32:47]
  buffer_load_dwordx4 v6, s[56:59], s22 offen offset:2048 lds
  v_mfma_f32_32x32x16_bf16 v[48:63], v[24:27], v[208:211], v[48:63]
  ds_read_b128 v[24:27], v10 offset:256
  s_waitcnt lgkmcnt(3)
  v_mfma_f32_32x32x16_bf16 v[32:47], v[28:31], v[148:151], v[32:47]
  buffer_load_dwordx4 v7, s[56:59], s22 offen offset:3072 lds
  v_mfma_f32_32x32x16_bf16 v[48:63], v[28:31], v[212:215], v[48:63]
  ds_read_b128 v[28:31], v11 offset:256
  s_waitcnt lgkmcnt(3)
  v_mfma_f32_32x32x16_bf16 v[32:47], v[16:19], v[152:155], v[32:47]
  s_add_u32 s22, s27, 1572864
  s_add_u32 m0, s25, 98304
  s_nop 0
  buffer_load_dwordx4 v4, s[56:59], s22 offen offset:0 lds
  v_mfma_f32_32x32x16_bf16 v[48:63], v[16:19], v[216:219], v[48:63]
  ds_read_b128 v[16:19], v12 offset:256
  s_waitcnt lgkmcnt(3)
  v_mfma_f32_32x32x16_bf16 v[32:47], v[20:23], v[156:159], v[32:47]
  buffer_load_dwordx4 v5, s[56:59], s22 offen offset:1024 lds
  v_mfma_f32_32x32x16_bf16 v[48:63], v[20:23], v[220:223], v[48:63]
  ds_read_b128 v[20:23], v13 offset:256
  s_waitcnt lgkmcnt(3)
  v_mfma_f32_32x32x16_bf16 v[32:47], v[24:27], v[160:163], v[32:47]
  buffer_load_dwordx4 v6, s[56:59], s22 offen offset:2048 lds
  v_mfma_f32_32x32x16_bf16 v[48:63], v[24:27], v[224:227], v[48:63]
  ds_read_b128 v[24:27], v14 offset:256
  s_waitcnt lgkmcnt(3)
  v_mfma_f32_32x32x16_bf16 v[32:47], v[28:31], v[164:167], v[32:47]
  buffer_load_dwordx4 v7, s[56:59], s22 offen offset:3072 lds
  v_mfma_f32_32x32x16_bf16 v[48:63], v[28:31], v[228:231], v[48:63]
  ds_read_b128 v[28:31], v15 offset:256
  s_waitcnt lgkmcnt(3)
  v_mfma_f32_32x32x16_bf16 v[32:47], v[16:19], v[168:171], v[32:47]
  s_add_u32 s22, s27, 1835008
  s_add_u32 m0, s25, 114688
  s_nop 0
  buffer_load_dwordx4 v4, s[56:59], s22 offen offset:0 lds
  v_mfma_f32_32x32x16_bf16 v[48:63], v[16:19], v[232:235], v[48:63]
  ds_read_b128 v[16:19], v8 offset:16384
  s_waitcnt lgkmcnt(3)
  v_mfma_f32_32x32x16_bf16 v[32:47], v[20:23], v[172:175], v[32:47]
  buffer_load_dwordx4 v5, s[56:59], s22 offen offset:1024 lds
  v_mfma_f32_32x32x16_bf16 v[48:63], v[20:23], v[236:239], v[48:63]
  ds_read_b128 v[20:23], v9 offset:16384
  s_waitcnt lgkmcnt(3)
  v_mfma_f32_32x32x16_bf16 v[32:47], v[24:27], v[176:179], v[32:47]
  buffer_load_dwordx4 v6, s[56:59], s22 offen offset:2048 lds
  v_mfma_f32_32x32x16_bf16 v[48:63], v[24:27], v[240:243], v[48:63]
  ds_read_b128 v[24:27], v10 offset:16384
  s_waitcnt lgkmcnt(3)
  v_mfma_f32_32x32x16_bf16 v[32:47], v[28:31], v[180:183], v[32:47]
  buffer_load_dwordx4 v7, s[56:59], s22 offen offset:3072 lds
  v_mfma_f32_32x32x16_bf16 v[48:63], v[28:31], v[244:247], v[48:63]
  s_waitcnt vmcnt(16)
  s_barrier
  ds_read_b128 v[28:31], v11 offset:16384
  s_waitcnt lgkmcnt(3)
  v_mfma_f32_32x32x16_bf16 v[64:79], v[16:19], v[120:123], 0
  s_add_u32 s22, s27, 2097152
  s_add_u32 m0, s25, 131072
  s_nop 0
  buffer_load_dwordx4 v4, s[56:59], s22 offen offset:0 lds
  v_mfma_f32_32x32x16_bf16 v[80:95], v[16:19], v[184:187], 0
  ds_read_b128 v[16:19], v12 offset:16384
  s_waitcnt lgkmcnt(3)
  v_mfma_f32_32x32x16_bf16 v[64:79], v[20:23], v[124:127], v[64:79]
  buffer_load_dwordx4 v5, s[56:59], s22 offen offset:1024 lds
  v_mul_f32 v32, s52, v32
  v_mul_f32 v33, s52, v33
  v_cvt_pk_bf16_f32 v32, v32, v33
  v_mfma_f32_32x32x16_bf16 v[80:95], v[20:23], v[188:191], v[80:95]
  v_mul_f32 v34, s52, v34
  v_mul_f32 v35, s52, v35
  ds_read_b128 v[20:23], v13 offset:16384
  s_waitcnt lgkmcnt(3)
  v_mfma_f32_32x32x16_bf16 v[64:79], v[24:27], v[128:131], v[64:79]
  buffer_load_dwordx4 v6, s[56:59], s22 offen offset:2048 lds
  v_cvt_pk_bf16_f32 v33, v34, v35
  v_mul_f32 v36, s52, v36
  v_mul_f32 v37, s52, v37
  v_mfma_f32_32x32x16_bf16 v[80:95], v[24:27], v[192:195], v[80:95]
  v_cvt_pk_bf16_f32 v34, v36, v37
  v_mul_f32 v38, s52, v38
  ds_read_b128 v[24:27], v14 offset:16384
  s_waitcnt lgkmcnt(3)
  v_mfma_f32_32x32x16_bf16 v[64:79], v[28:31], v[132:135], v[64:79]
  buffer_load_dwordx4 v7, s[56:59], s22 offen offset:3072 lds
  v_mul_f32 v39, s52, v39
  v_cvt_pk_bf16_f32 v35, v38, v39
  v_mul_f32 v40, s52, v40
  v_mfma_f32_32x32x16_bf16 v[80:95], v[28:31], v[196:199], v[80:95]
  v_mul_f32 v41, s52, v41
  v_cvt_pk_bf16_f32 v40, v40, v41
  ds_read_b128 v[28:31], v15 offset:16384
  s_waitcnt lgkmcnt(3)
  v_mfma_f32_32x32x16_bf16 v[64:79], v[16:19], v[136:139], v[64:79]
  s_add_u32 s22, s27, 2359296
  s_add_u32 m0, s25, 0
  s_nop 0
  buffer_load_dwordx4 v4, s[56:59], s22 offen offset:0 lds
  v_mul_f32 v42, s52, v42
  v_mul_f32 v43, s52, v43
  v_cvt_pk_bf16_f32 v41, v42, v43
  v_mfma_f32_32x32x16_bf16 v[80:95], v[16:19], v[200:203], v[80:95]
  v_mul_f32 v44, s52, v44
  v_mul_f32 v45, s52, v45
  ds_read_b128 v[16:19], v8 offset:16640
  s_waitcnt lgkmcnt(3)
  v_mfma_f32_32x32x16_bf16 v[64:79], v[20:23], v[140:143], v[64:79]
  buffer_load_dwordx4 v5, s[56:59], s22 offen offset:1024 lds
  v_cvt_pk_bf16_f32 v42, v44, v45
  v_mul_f32 v46, s52, v46
  v_mul_f32 v47, s52, v47
  v_mfma_f32_32x32x16_bf16 v[80:95], v[20:23], v[204:207], v[80:95]
  v_cvt_pk_bf16_f32 v43, v46, v47
  v_permlane16_swap_b32 v32, v40
  ds_read_b128 v[20:23], v9 offset:16640
  s_waitcnt lgkmcnt(3)
  v_mfma_f32_32x32x16_bf16 v[64:79], v[24:27], v[144:147], v[64:79]
  buffer_load_dwordx4 v6, s[56:59], s22 offen offset:2048 lds
  v_permlane16_swap_b32 v33, v41
  v_permlane16_swap_b32 v34, v42
  v_permlane16_swap_b32 v35, v43
  v_mfma_f32_32x32x16_bf16 v[80:95], v[24:27], v[208:211], v[80:95]
  v_accvgpr_write_b32 a0, v32
  v_accvgpr_write_b32 a1, v33
  ds_read_b128 v[24:27], v10 offset:16640
  s_waitcnt lgkmcnt(3)
  v_mfma_f32_32x32x16_bf16 v[64:79], v[28:31], v[148:151], v[64:79]
  buffer_load_dwordx4 v7, s[56:59], s22 offen offset:3072 lds
  v_accvgpr_write_b32 a2, v34
  v_accvgpr_write_b32 a3, v35
  v_accvgpr_write_b32 a56, v40
  v_mfma_f32_32x32x16_bf16 v[80:95], v[28:31], v[212:215], v[80:95]
  v_accvgpr_write_b32 a57, v41
  v_accvgpr_write_b32 a58, v42
  ds_read_b128 v[28:31], v11 offset:16640
  s_waitcnt lgkmcnt(3)
  v_mfma_f32_32x32x16_bf16 v[64:79], v[16:19], v[152:155], v[64:79]
  v_accvgpr_write_b32 a59, v43
  v_mul_f32 v48, s52, v48
  v_mul_f32 v49, s52, v49
  v_mfma_f32_32x32x16_bf16 v[80:95], v[16:19], v[216:219], v[80:95]
  v_cvt_pk_bf16_f32 v48, v48, v49
  v_mul_f32 v50, s52, v50
  ds_read_b128 v[16:19], v12 offset:16640
  s_waitcnt lgkmcnt(3)
  v_mfma_f32_32x32x16_bf16 v[64:79], v[20:23], v[156:159], v[64:79]
  v_mul_f32 v51, s52, v51
  v_cvt_pk_bf16_f32 v49, v50, v51
  v_mul_f32 v52, s52, v52
  v_mfma_f32_32x32x16_bf16 v[80:95], v[20:23], v[220:223], v[80:95]
  v_mul_f32 v53, s52, v53
  v_cvt_pk_bf16_f32 v50, v52, v53
  ds_read_b128 v[20:23], v13 offset:16640
  s_waitcnt lgkmcnt(3)
  v_mfma_f32_32x32x16_bf16 v[64:79], v[24:27], v[160:163], v[64:79]
  v_mul_f32 v54, s52, v54
  v_mul_f32 v55, s52, v55
  v_cvt_pk_bf16_f32 v51, v54, v55
  v_mfma_f32_32x32x16_bf16 v[80:95], v[24:27], v[224:227], v[80:95]
  v_mul_f32 v56, s52, v56
  v_mul_f32 v57, s52, v57
  ds_read_b128 v[24:27], v14 offset:16640
  s_waitcnt lgkmcnt(3)
  v_mfma_f32_32x32x16_bf16 v[64:79], v[28:31], v[164:167], v[64:79]
  v_cvt_pk_bf16_f32 v56, v56, v57
  v_mul_f32 v58, s52, v58
  v_mul_f32 v59, s52, v59
  v_mfma_f32_32x32x16_bf16 v[80:95], v[28:31], v[228:231], v[80:95]
  v_cvt_pk_bf16_f32 v57, v58, v59
  v_mul_f32 v60, s52, v60
  ds_read_b128 v[28:31], v15 offset:16640
  s_waitcnt lgkmcnt(3)
  v_mfma_f32_32x32x16_bf16 v[64:79], v[16:19], v[168:171], v[64:79]
  v_mul_f32 v61, s52, v61
  v_cvt_pk_bf16_f32 v58, v60, v61
  v_mul_f32 v62, s52, v62
  v_mfma_f32_32x32x16_bf16 v[80:95], v[16:19], v[232:235], v[80:95]
  v_mul_f32 v63, s52, v63
  v_cvt_pk_bf16_f32 v59, v62, v63
  ds_read_b128 v[16:19], v8 offset:32768
  s_waitcnt lgkmcnt(3)
  v_mfma_f32_32x32x16_bf16 v[64:79], v[20:23], v[172:175], v[64:79]
  v_permlane16_swap_b32 v48, v56
  v_permlane16_swap_b32 v49, v57
  v_permlane16_swap_b32 v50, v58
  v_mfma_f32_32x32x16_bf16 v[80:95], v[20:23], v[236:239], v[80:95]
  v_permlane16_swap_b32 v51, v59
  v_accvgpr_write_b32 a112, v48
  ds_read_b128 v[20:23], v9 offset:32768
  s_waitcnt lgkmcnt(3)
  v_mfma_f32_32x32x16_bf16 v[64:79], v[24:27], v[176:179], v[64:79]
  v_accvgpr_write_b32 a113, v49
  v_accvgpr_write_b32 a114, v50
  v_accvgpr_write_b32 a115, v51
  v_mfma_f32_32x32x16_bf16 v[80:95], v[24:27], v[240:243], v[80:95]
  v_accvgpr_write_b32 a168, v56
  v_accvgpr_write_b32 a169, v57
  ds_read_b128 v[24:27], v10 offset:32768
  s_waitcnt lgkmcnt(3)
  v_mfma_f32_32x32x16_bf16 v[64:79], v[28:31], v[180:183], v[64:79]
  v_accvgpr_write_b32 a170, v58
  v_accvgpr_write_b32 a171, v59
  v_mfma_f32_32x32x16_bf16 v[80:95], v[28:31], v[244:247], v[80:95]
  ds_read_b128 v[28:31], v11 offset:32768
  s_waitcnt lgkmcnt(3)
  v_mfma_f32_32x32x16_bf16 v[32:47], v[16:19], v[120:123], 0
  v_mfma_f32_32x32x16_bf16 v[48:63], v[16:19], v[184:187], 0
  ds_read_b128 v[16:19], v12 offset:32768
  s_waitcnt lgkmcnt(3)
  v_mfma_f32_32x32x16_bf16 v[32:47], v[20:23], v[124:127], v[32:47]
  v_mul_f32 v64, s52, v64
  v_mul_f32 v65, s52, v65
  v_cvt_pk_bf16_f32 v64, v64, v65
  v_mfma_f32_32x32x16_bf16 v[48:63], v[20:23], v[188:191], v[48:63]
  v_mul_f32 v66, s52, v66
  v_mul_f32 v67, s52, v67
  ds_read_b128 v[20:23], v13 offset:32768
  s_waitcnt lgkmcnt(3)
  v_mfma_f32_32x32x16_bf16 v[32:47], v[24:27], v[128:131], v[32:47]
  v_cvt_pk_bf16_f32 v65, v66, v67
  v_mul_f32 v68, s52, v68
  v_mul_f32 v69, s52, v69
  v_mfma_f32_32x32x16_bf16 v[48:63], v[24:27], v[192:195], v[48:63]
  v_cvt_pk_bf16_f32 v66, v68, v69
  v_mul_f32 v70, s52, v70
  ds_read_b128 v[24:27], v14 offset:32768
  s_waitcnt lgkmcnt(3)
  v_mfma_f32_32x32x16_bf16 v[32:47], v[28:31], v[132:135], v[32:47]
  v_mul_f32 v71, s52, v71
  v_cvt_pk_bf16_f32 v67, v70, v71
  v_mul_f32 v72, s52, v72
  v_mfma_f32_32x32x16_bf16 v[48:63], v[28:31], v[196:199], v[48:63]
  v_mul_f32 v73, s52, v73
  v_cvt_pk_bf16_f32 v72, v72, v73
  ds_read_b128 v[28:31], v15 offset:32768
  s_waitcnt lgkmcnt(3)
  v_mfma_f32_32x32x16_bf16 v[32:47], v[16:19], v[136:139], v[32:47]
  v_mul_f32 v74, s52, v74
  v_mul_f32 v75, s52, v75
  v_cvt_pk_bf16_f32 v73, v74, v75
  v_mfma_f32_32x32x16_bf16 v[48:63], v[16:19], v[200:203], v[48:63]
  v_mul_f32 v76, s52, v76
  v_mul_f32 v77, s52, v77
  ds_read_b128 v[16:19], v8 offset:33024
  s_waitcnt lgkmcnt(3)
  v_mfma_f32_32x32x16_bf16 v[32:47], v[20:23], v[140:143], v[32:47]
  v_cvt_pk_bf16_f32 v74, v76, v77
  v_mul_f32 v78, s52, v78
  v_mul_f32 v79, s52, v79
  v_mfma_f32_32x32x16_bf16 v[48:63], v[20:23], v[204:207], v[48:63]
  v_cvt_pk_bf16_f32 v75, v78, v79
  v_permlane16_swap_b32 v64, v72
  ds_read_b128 v[20:23], v9 offset:33024
  s_waitcnt lgkmcnt(3)
  v_mfma_f32_32x32x16_bf16 v[32:47], v[24:27], v[144:147], v[32:47]
  v_permlane16_swap_b32 v65, v73
  v_permlane16_swap_b32 v66, v74
  v_permlane16_swap_b32 v67, v75
  v_mfma_f32_32x32x16_bf16 v[48:63], v[24:27], v[208:211], v[48:63]
  v_accvgpr_write_b32 a4, v64
  v_accvgpr_write_b32 a5, v65
  ds_read_b128 v[24:27], v10 offset:33024
  s_waitcnt lgkmcnt(3)
  v_mfma_f32_32x32x16_bf16 v[32:47], v[28:31], v[148:151], v[32:47]
  v_accvgpr_write_b32 a6, v66
  v_accvgpr_write_b32 a7, v67
  v_accvgpr_write_b32 a60, v72
  v_mfma_f32_32x32x16_bf16 v[48:63], v[28:31], v[212:215], v[48:63]
  v_accvgpr_write_b32 a61, v73
  v_accvgpr_write_b32 a62, v74
  ds_read_b128 v[28:31], v11 offset:33024
  s_waitcnt lgkmcnt(3)
  v_mfma_f32_32x32x16_bf16 v[32:47], v[16:19], v[152:155], v[32:47]
  v_accvgpr_write_b32 a63, v75
  v_mul_f32 v80, s52, v80
  v_mul_f32 v81, s52, v81
  v_mfma_f32_32x32x16_bf16 v[48:63], v[16:19], v[216:219], v[48:63]
  v_cvt_pk_bf16_f32 v80, v80, v81
  v_mul_f32 v82, s52, v82
  ds_read_b128 v[16:19], v12 offset:33024
  s_waitcnt lgkmcnt(3)
  v_mfma_f32_32x32x16_bf16 v[32:47], v[20:23], v[156:159], v[32:47]
  v_mul_f32 v83, s52, v83
  v_cvt_pk_bf16_f32 v81, v82, v83
  v_mul_f32 v84, s52, v84
  v_mfma_f32_32x32x16_bf16 v[48:63], v[20:23], v[220:223], v[48:63]
  v_mul_f32 v85, s52, v85
  v_cvt_pk_bf16_f32 v82, v84, v85
  ds_read_b128 v[20:23], v13 offset:33024
  s_waitcnt lgkmcnt(3)
  v_mfma_f32_32x32x16_bf16 v[32:47], v[24:27], v[160:163], v[32:47]
  v_mul_f32 v86, s52, v86
  v_mul_f32 v87, s52, v87
  v_cvt_pk_bf16_f32 v83, v86, v87
  v_mfma_f32_32x32x16_bf16 v[48:63], v[24:27], v[224:227], v[48:63]
  v_mul_f32 v88, s52, v88
  v_mul_f32 v89, s52, v89
  ds_read_b128 v[24:27], v14 offset:33024
  s_waitcnt lgkmcnt(3)
  v_mfma_f32_32x32x16_bf16 v[32:47], v[28:31], v[164:167], v[32:47]
  v_cvt_pk_bf16_f32 v88, v88, v89
  v_mul_f32 v90, s52, v90
  v_mul_f32 v91, s52, v91
  v_mfma_f32_32x32x16_bf16 v[48:63], v[28:31], v[228:231], v[48:63]
  v_cvt_pk_bf16_f32 v89, v90, v91
  v_mul_f32 v92, s52, v92
  ds_read_b128 v[28:31], v15 offset:33024
  s_waitcnt lgkmcnt(3)
  v_mfma_f32_32x32x16_bf16 v[32:47], v[16:19], v[168:171], v[32:47]
  v_mul_f32 v93, s52, v93
  v_cvt_pk_bf16_f32 v90, v92, v93
  v_mul_f32 v94, s52, v94
  v_mfma_f32_32x32x16_bf16 v[48:63], v[16:19], v[232:235], v[48:63]
  v_mul_f32 v95, s52, v95
  v_cvt_pk_bf16_f32 v91, v94, v95
  ds_read_b128 v[16:19], v8 offset:49152
  s_waitcnt lgkmcnt(3)
  v_mfma_f32_32x32x16_bf16 v[32:47], v[20:23], v[172:175], v[32:47]
  v_permlane16_swap_b32 v80, v88
  v_permlane16_swap_b32 v81, v89
  v_permlane16_swap_b32 v82, v90
  v_mfma_f32_32x32x16_bf16 v[48:63], v[20:23], v[236:239], v[48:63]
  v_permlane16_swap_b32 v83, v91
  v_accvgpr_write_b32 a116, v80
  ds_read_b128 v[20:23], v9 offset:49152
  s_waitcnt lgkmcnt(3)
  v_mfma_f32_32x32x16_bf16 v[32:47], v[24:27], v[176:179], v[32:47]
  v_accvgpr_write_b32 a117, v81
  v_accvgpr_write_b32 a118, v82
  v_accvgpr_write_b32 a119, v83
  v_mfma_f32_32x32x16_bf16 v[48:63], v[24:27], v[240:243], v[48:63]
  v_accvgpr_write_b32 a172, v88
  v_accvgpr_write_b32 a173, v89
  ds_read_b128 v[24:27], v10 offset:49152
  s_waitcnt lgkmcnt(3)
  v_mfma_f32_32x32x16_bf16 v[32:47], v[28:31], v[180:183], v[32:47]
  v_accvgpr_write_b32 a174, v90
  v_accvgpr_write_b32 a175, v91
  v_mfma_f32_32x32x16_bf16 v[48:63], v[28:31], v[244:247], v[48:63]
  s_waitcnt vmcnt(16)
  s_barrier
  ds_read_b128 v[28:31], v11 offset:49152
  s_waitcnt lgkmcnt(3)
  v_mfma_f32_32x32x16_bf16 v[64:79], v[16:19], v[120:123], 0
  s_add_u32 s22, s27, 2621440
  s_add_u32 m0, s25, 16384
  s_nop 0
  buffer_load_dwordx4 v4, s[56:59], s22 offen offset:0 lds
  v_mfma_f32_32x32x16_bf16 v[80:95], v[16:19], v[184:187], 0
  ds_read_b128 v[16:19], v12 offset:49152
  s_waitcnt lgkmcnt(3)
  v_mfma_f32_32x32x16_bf16 v[64:79], v[20:23], v[124:127], v[64:79]
  buffer_load_dwordx4 v5, s[56:59], s22 offen offset:1024 lds
  v_mul_f32 v32, s52, v32
  v_mul_f32 v33, s52, v33
  v_cvt_pk_bf16_f32 v32, v32, v33
  v_mfma_f32_32x32x16_bf16 v[80:95], v[20:23], v[188:191], v[80:95]
  v_mul_f32 v34, s52, v34
  v_mul_f32 v35, s52, v35
  ds_read_b128 v[20:23], v13 offset:49152
  s_waitcnt lgkmcnt(3)
  v_mfma_f32_32x32x16_bf16 v[64:79], v[24:27], v[128:131], v[64:79]
  buffer_load_dwordx4 v6, s[56:59], s22 offen offset:2048 lds
  v_cvt_pk_bf16_f32 v33, v34, v35
  v_mul_f32 v36, s52, v36
  v_mul_f32 v37, s52, v37
  v_mfma_f32_32x32x16_bf16 v[80:95], v[24:27], v[192:195], v[80:95]
  v_cvt_pk_bf16_f32 v34, v36, v37
  v_mul_f32 v38, s52, v38
  ds_read_b128 v[24:27], v14 offset:49152
  s_waitcnt lgkmcnt(3)
  v_mfma_f32_32x32x16_bf16 v[64:79], v[28:31], v[132:135], v[64:79]
  buffer_load_dwordx4 v7, s[56:59], s22 offen offset:3072 lds
  v_mul_f32 v39, s52, v39
  v_cvt_pk_bf16_f32 v35, v38, v39
  v_mul_f32 v40, s52, v40
  v_mfma_f32_32x32x16_bf16 v[80:95], v[28:31], v[196:199], v[80:95]
  v_mul_f32 v41, s52, v41
  v_cvt_pk_bf16_f32 v40, v40, v41
  ds_read_b128 v[28:31], v15 offset:49152
  s_waitcnt lgkmcnt(3)
  v_mfma_f32_32x32x16_bf16 v[64:79], v[16:19], v[136:139], v[64:79]
  s_add_u32 s22, s27, 2883584
  s_add_u32 m0, s25, 32768
  s_nop 0
  buffer_load_dwordx4 v4, s[56:59], s22 offen offset:0 lds
  v_mul_f32 v42, s52, v42
  v_mul_f32 v43, s52, v43
  v_cvt_pk_bf16_f32 v41, v42, v43
  v_mfma_f32_32x32x16_bf16 v[80:95], v[16:19], v[200:203], v[80:95]
  v_mul_f32 v44, s52, v44
  v_mul_f32 v45, s52, v45
  ds_read_b128 v[16:19], v8 offset:49408
  s_waitcnt lgkmcnt(3)
  v_mfma_f32_32x32x16_bf16 v[64:79], v[20:23], v[140:143], v[64:79]
  buffer_load_dwordx4 v5, s[56:59], s22 offen offset:1024 lds
  v_cvt_pk_bf16_f32 v42, v44, v45
  v_mul_f32 v46, s52, v46
  v_mul_f32 v47, s52, v47
  v_mfma_f32_32x32x16_bf16 v[80:95], v[20:23], v[204:207], v[80:95]
  v_cvt_pk_bf16_f32 v43, v46, v47
  v_permlane16_swap_b32 v32, v40
  ds_read_b128 v[20:23], v9 offset:49408
  s_waitcnt lgkmcnt(3)
  v_mfma_f32_32x32x16_bf16 v[64:79], v[24:27], v[144:147], v[64:79]
  buffer_load_dwordx4 v6, s[56:59], s22 offen offset:2048 lds
  v_permlane16_swap_b32 v33, v41
  v_permlane16_swap_b32 v34, v42
  v_permlane16_swap_b32 v35, v43
  v_mfma_f32_32x32x16_bf16 v[80:95], v[24:27], v[208:211], v[80:95]
  v_accvgpr_write_b32 a8, v32
  v_accvgpr_write_b32 a9, v33
  ds_read_b128 v[24:27], v10 offset:49408
  s_waitcnt lgkmcnt(3)
  v_mfma_f32_32x32x16_bf16 v[64:79], v[28:31], v[148:151], v[64:79]
  buffer_load_dwordx4 v7, s[56:59], s22 offen offset:3072 lds
  v_accvgpr_write_b32 a10, v34
  v_accvgpr_write_b32 a11, v35
  v_accvgpr_write_b32 a64, v40
  v_mfma_f32_32x32x16_bf16 v[80:95], v[28:31], v[212:215], v[80:95]
  v_accvgpr_write_b32 a65, v41
  v_accvgpr_write_b32 a66, v42
  ds_read_b128 v[28:31], v11 offset:49408
  s_waitcnt lgkmcnt(3)
  v_mfma_f32_32x32x16_bf16 v[64:79], v[16:19], v[152:155], v[64:79]
  v_accvgpr_write_b32 a67, v43
  v_mul_f32 v48, s52, v48
  v_mul_f32 v49, s52, v49
  v_mfma_f32_32x32x16_bf16 v[80:95], v[16:19], v[216:219], v[80:95]
  v_cvt_pk_bf16_f32 v48, v48, v49
  v_mul_f32 v50, s52, v50
  ds_read_b128 v[16:19], v12 offset:49408
  s_waitcnt lgkmcnt(3)
  v_mfma_f32_32x32x16_bf16 v[64:79], v[20:23], v[156:159], v[64:79]
  v_mul_f32 v51, s52, v51
  v_cvt_pk_bf16_f32 v49, v50, v51
  v_mul_f32 v52, s52, v52
  v_mfma_f32_32x32x16_bf16 v[80:95], v[20:23], v[220:223], v[80:95]
  v_mul_f32 v53, s52, v53
  v_cvt_pk_bf16_f32 v50, v52, v53
  ds_read_b128 v[20:23], v13 offset:49408
  s_waitcnt lgkmcnt(3)
  v_mfma_f32_32x32x16_bf16 v[64:79], v[24:27], v[160:163], v[64:79]
  v_mul_f32 v54, s52, v54
  v_mul_f32 v55, s52, v55
  v_cvt_pk_bf16_f32 v51, v54, v55
  v_mfma_f32_32x32x16_bf16 v[80:95], v[24:27], v[224:227], v[80:95]
  v_mul_f32 v56, s52, v56
  v_mul_f32 v57, s52, v57
  ds_read_b128 v[24:27], v14 offset:49408
  s_waitcnt lgkmcnt(3)
  v_mfma_f32_32x32x16_bf16 v[64:79], v[28:31], v[164:167], v[64:79]
  v_cvt_pk_bf16_f32 v56, v56, v57
  v_mul_f32 v58, s52, v58
  v_mul_f32 v59, s52, v59
  v_mfma_f32_32x32x16_bf16 v[80:95], v[28:31], v[228:231], v[80:95]
  v_cvt_pk_bf16_f32 v57, v58, v59
  v_mul_f32 v60, s52, v60
  ds_read_b128 v[28:31], v15 offset:49408
  s_waitcnt lgkmcnt(3)
  v_mfma_f32_32x32x16_bf16 v[64:79], v[16:19], v[168:171], v[64:79]
  v_mul_f32 v61, s52, v61
  v_cvt_pk_bf16_f32 v58, v60, v61
  v_mul_f32 v62, s52, v62
  v_mfma_f32_32x32x16_bf16 v[80:95], v[16:19], v[232:235], v[80:95]
  v_mul_f32 v63, s52, v63
  v_cvt_pk_bf16_f32 v59, v62, v63
  v_xor_b32 v8, 65536, v8
  ds_read_b128 v[16:19], v8 offset:0
  s_waitcnt lgkmcnt(3)
  v_mfma_f32_32x32x16_bf16 v[64:79], v[20:23], v[172:175], v[64:79]
  v_permlane16_swap_b32 v48, v56
  v_permlane16_swap_b32 v49, v57
  v_permlane16_swap_b32 v50, v58
  v_mfma_f32_32x32x16_bf16 v[80:95], v[20:23], v[236:239], v[80:95]
  v_permlane16_swap_b32 v51, v59
  v_accvgpr_write_b32 a120, v48
  v_xor_b32 v9, 65536, v9
  ds_read_b128 v[20:23], v9 offset:0
  s_waitcnt lgkmcnt(3)
  v_mfma_f32_32x32x16_bf16 v[64:79], v[24:27], v[176:179], v[64:79]
  v_accvgpr_write_b32 a121, v49
  v_accvgpr_write_b32 a122, v50
  v_accvgpr_write_b32 a123, v51
  v_mfma_f32_32x32x16_bf16 v[80:95], v[24:27], v[240:243], v[80:95]
  v_accvgpr_write_b32 a176, v56
  v_accvgpr_write_b32 a177, v57
  v_xor_b32 v10, 65536, v10
  ds_read_b128 v[24:27], v10 offset:0
  s_waitcnt lgkmcnt(3)
  v_mfma_f32_32x32x16_bf16 v[64:79], v[28:31], v[180:183], v[64:79]
  v_accvgpr_write_b32 a178, v58
  v_accvgpr_write_b32 a179, v59
  v_mfma_f32_32x32x16_bf16 v[80:95], v[28:31], v[244:247], v[80:95]
  v_xor_b32 v11, 65536, v11
  ds_read_b128 v[28:31], v11 offset:0
  s_waitcnt lgkmcnt(3)
  v_mfma_f32_32x32x16_bf16 v[32:47], v[16:19], v[120:123], 0
  v_mfma_f32_32x32x16_bf16 v[48:63], v[16:19], v[184:187], 0
  v_xor_b32 v12, 65536, v12
  ds_read_b128 v[16:19], v12 offset:0
  s_waitcnt lgkmcnt(3)
  v_mfma_f32_32x32x16_bf16 v[32:47], v[20:23], v[124:127], v[32:47]
  v_mul_f32 v64, s52, v64
  v_mul_f32 v65, s52, v65
  v_cvt_pk_bf16_f32 v64, v64, v65
  v_mfma_f32_32x32x16_bf16 v[48:63], v[20:23], v[188:191], v[48:63]
  v_mul_f32 v66, s52, v66
  v_mul_f32 v67, s52, v67
  v_xor_b32 v13, 65536, v13
  ds_read_b128 v[20:23], v13 offset:0
  s_waitcnt lgkmcnt(3)
  v_mfma_f32_32x32x16_bf16 v[32:47], v[24:27], v[128:131], v[32:47]
  v_cvt_pk_bf16_f32 v65, v66, v67
  v_mul_f32 v68, s52, v68
  v_mul_f32 v69, s52, v69
  v_mfma_f32_32x32x16_bf16 v[48:63], v[24:27], v[192:195], v[48:63]
  v_cvt_pk_bf16_f32 v66, v68, v69
  v_mul_f32 v70, s52, v70
  v_xor_b32 v14, 65536, v14
  ds_read_b128 v[24:27], v14 offset:0
  s_waitcnt lgkmcnt(3)
  v_mfma_f32_32x32x16_bf16 v[32:47], v[28:31], v[132:135], v[32:47]
  v_mul_f32 v71, s52, v71
  v_cvt_pk_bf16_f32 v67, v70, v71
  v_mul_f32 v72, s52, v72
  v_mfma_f32_32x32x16_bf16 v[48:63], v[28:31], v[196:199], v[48:63]
  v_mul_f32 v73, s52, v73
  v_cvt_pk_bf16_f32 v72, v72, v73
  v_xor_b32 v15, 65536, v15
  ds_read_b128 v[28:31], v15 offset:0
  s_waitcnt lgkmcnt(3)
  v_mfma_f32_32x32x16_bf16 v[32:47], v[16:19], v[136:139], v[32:47]
  v_mul_f32 v74, s52, v74
  v_mul_f32 v75, s52, v75
  v_cvt_pk_bf16_f32 v73, v74, v75
  v_mfma_f32_32x32x16_bf16 v[48:63], v[16:19], v[200:203], v[48:63]
  v_mul_f32 v76, s52, v76
  v_mul_f32 v77, s52, v77
  ds_read_b128 v[16:19], v8 offset:256
  s_waitcnt lgkmcnt(3)
  v_mfma_f32_32x32x16_bf16 v[32:47], v[20:23], v[140:143], v[32:47]
  v_cvt_pk_bf16_f32 v74, v76, v77
  v_mul_f32 v78, s52, v78
  v_mul_f32 v79, s52, v79
  v_mfma_f32_32x32x16_bf16 v[48:63], v[20:23], v[204:207], v[48:63]
  v_cvt_pk_bf16_f32 v75, v78, v79
  v_permlane16_swap_b32 v64, v72
  ds_read_b128 v[20:23], v9 offset:256
  s_waitcnt lgkmcnt(3)
  v_mfma_f32_32x32x16_bf16 v[32:47], v[24:27], v[144:147], v[32:47]
  v_permlane16_swap_b32 v65, v73
  v_permlane16_swap_b32 v66, v74
  v_permlane16_swap_b32 v67, v75
  v_mfma_f32_32x32x16_bf16 v[48:63], v[24:27], v[208:211], v[48:63]
  v_accvgpr_write_b32 a12, v64
  v_accvgpr_write_b32 a13, v65
  ds_read_b128 v[24:27], v10 offset:256
  s_waitcnt lgkmcnt(3)
  v_mfma_f32_32x32x16_bf16 v[32:47], v[28:31], v[148:151], v[32:47]
  v_accvgpr_write_b32 a14, v66
  v_accvgpr_write_b32 a15, v67
  v_accvgpr_write_b32 a68, v72
  v_mfma_f32_32x32x16_bf16 v[48:63], v[28:31], v[212:215], v[48:63]
  v_accvgpr_write_b32 a69, v73
  v_accvgpr_write_b32 a70, v74
  ds_read_b128 v[28:31], v11 offset:256
  s_waitcnt lgkmcnt(3)
  v_mfma_f32_32x32x16_bf16 v[32:47], v[16:19], v[152:155], v[32:47]
  v_accvgpr_write_b32 a71, v75
  v_mul_f32 v80, s52, v80
  v_mul_f32 v81, s52, v81
  v_mfma_f32_32x32x16_bf16 v[48:63], v[16:19], v[216:219], v[48:63]
  v_cvt_pk_bf16_f32 v80, v80, v81
  v_mul_f32 v82, s52, v82
  ds_read_b128 v[16:19], v12 offset:256
  s_waitcnt lgkmcnt(3)
  v_mfma_f32_32x32x16_bf16 v[32:47], v[20:23], v[156:159], v[32:47]
  v_mul_f32 v83, s52, v83
  v_cvt_pk_bf16_f32 v81, v82, v83
  v_mul_f32 v84, s52, v84
  v_mfma_f32_32x32x16_bf16 v[48:63], v[20:23], v[220:223], v[48:63]
  v_mul_f32 v85, s52, v85
  v_cvt_pk_bf16_f32 v82, v84, v85
  ds_read_b128 v[20:23], v13 offset:256
  s_waitcnt lgkmcnt(3)
  v_mfma_f32_32x32x16_bf16 v[32:47], v[24:27], v[160:163], v[32:47]
  v_mul_f32 v86, s52, v86
  v_mul_f32 v87, s52, v87
  v_cvt_pk_bf16_f32 v83, v86, v87
  v_mfma_f32_32x32x16_bf16 v[48:63], v[24:27], v[224:227], v[48:63]
  v_mul_f32 v88, s52, v88
  v_mul_f32 v89, s52, v89
  ds_read_b128 v[24:27], v14 offset:256
  s_waitcnt lgkmcnt(3)
  v_mfma_f32_32x32x16_bf16 v[32:47], v[28:31], v[164:167], v[32:47]
  v_cvt_pk_bf16_f32 v88, v88, v89
  v_mul_f32 v90, s52, v90
  v_mul_f32 v91, s52, v91
  v_mfma_f32_32x32x16_bf16 v[48:63], v[28:31], v[228:231], v[48:63]
  v_cvt_pk_bf16_f32 v89, v90, v91
  v_mul_f32 v92, s52, v92
  ds_read_b128 v[28:31], v15 offset:256
  s_waitcnt lgkmcnt(3)
  v_mfma_f32_32x32x16_bf16 v[32:47], v[16:19], v[168:171], v[32:47]
  v_mul_f32 v93, s52, v93
  v_cvt_pk_bf16_f32 v90, v92, v93
  v_mul_f32 v94, s52, v94
  v_mfma_f32_32x32x16_bf16 v[48:63], v[16:19], v[232:235], v[48:63]
  v_mul_f32 v95, s52, v95
  v_cvt_pk_bf16_f32 v91, v94, v95
  ds_read_b128 v[16:19], v8 offset:16384
  s_waitcnt lgkmcnt(3)
  v_mfma_f32_32x32x16_bf16 v[32:47], v[20:23], v[172:175], v[32:47]
  v_permlane16_swap_b32 v80, v88
  v_permlane16_swap_b32 v81, v89
  v_permlane16_swap_b32 v82, v90
  v_mfma_f32_32x32x16_bf16 v[48:63], v[20:23], v[236:239], v[48:63]
  v_permlane16_swap_b32 v83, v91
  v_accvgpr_write_b32 a124, v80
  ds_read_b128 v[20:23], v9 offset:16384
  s_waitcnt lgkmcnt(3)
  v_mfma_f32_32x32x16_bf16 v[32:47], v[24:27], v[176:179], v[32:47]
  v_accvgpr_write_b32 a125, v81
  v_accvgpr_write_b32 a126, v82
  v_accvgpr_write_b32 a127, v83
  v_mfma_f32_32x32x16_bf16 v[48:63], v[24:27], v[240:243], v[48:63]
  v_accvgpr_write_b32 a180, v88
  v_accvgpr_write_b32 a181, v89
  ds_read_b128 v[24:27], v10 offset:16384
  s_waitcnt lgkmcnt(3)
  v_mfma_f32_32x32x16_bf16 v[32:47], v[28:31], v[180:183], v[32:47]
  v_accvgpr_write_b32 a182, v90
  v_accvgpr_write_b32 a183, v91
  v_mfma_f32_32x32x16_bf16 v[48:63], v[28:31], v[244:247], v[48:63]
  s_waitcnt vmcnt(16)
  s_barrier
  ds_read_b128 v[28:31], v11 offset:16384
  s_waitcnt lgkmcnt(3)
  v_mfma_f32_32x32x16_bf16 v[64:79], v[16:19], v[120:123], 0
  s_add_u32 s22, s27, 3145728
  s_add_u32 m0, s25, 49152
  s_nop 0
  buffer_load_dwordx4 v4, s[56:59], s22 offen offset:0 lds
  v_mfma_f32_32x32x16_bf16 v[80:95], v[16:19], v[184:187], 0
  ds_read_b128 v[16:19], v12 offset:16384
  s_waitcnt lgkmcnt(3)
  v_mfma_f32_32x32x16_bf16 v[64:79], v[20:23], v[124:127], v[64:79]
  buffer_load_dwordx4 v5, s[56:59], s22 offen offset:1024 lds
  v_mul_f32 v32, s52, v32
  v_mul_f32 v33, s52, v33
  v_cvt_pk_bf16_f32 v32, v32, v33
  v_mfma_f32_32x32x16_bf16 v[80:95], v[20:23], v[188:191], v[80:95]
  v_mul_f32 v34, s52, v34
  v_mul_f32 v35, s52, v35
  ds_read_b128 v[20:23], v13 offset:16384
  s_waitcnt lgkmcnt(3)
  v_mfma_f32_32x32x16_bf16 v[64:79], v[24:27], v[128:131], v[64:79]
  buffer_load_dwordx4 v6, s[56:59], s22 offen offset:2048 lds
  v_cvt_pk_bf16_f32 v33, v34, v35
  v_mul_f32 v36, s52, v36
  v_mul_f32 v37, s52, v37
  v_mfma_f32_32x32x16_bf16 v[80:95], v[24:27], v[192:195], v[80:95]
  v_cvt_pk_bf16_f32 v34, v36, v37
  v_mul_f32 v38, s52, v38
  ds_read_b128 v[24:27], v14 offset:16384
  s_waitcnt lgkmcnt(3)
  v_mfma_f32_32x32x16_bf16 v[64:79], v[28:31], v[132:135], v[64:79]
  buffer_load_dwordx4 v7, s[56:59], s22 offen offset:3072 lds
  v_mul_f32 v39, s52, v39
  v_cvt_pk_bf16_f32 v35, v38, v39
  v_mul_f32 v40, s52, v40
  v_mfma_f32_32x32x16_bf16 v[80:95], v[28:31], v[196:199], v[80:95]
  v_mul_f32 v41, s52, v41
  v_cvt_pk_bf16_f32 v40, v40, v41
  ds_read_b128 v[28:31], v15 offset:16384
  s_waitcnt lgkmcnt(3)
  v_mfma_f32_32x32x16_bf16 v[64:79], v[16:19], v[136:139], v[64:79]
  s_add_u32 s22, s27, 3407872
  s_add_u32 m0, s25, 65536
  s_nop 0
  buffer_load_dwordx4 v4, s[56:59], s22 offen offset:0 lds
  v_mul_f32 v42, s52, v42
  v_mul_f32 v43, s52, v43
  v_cvt_pk_bf16_f32 v41, v42, v43
  v_mfma_f32_32x32x16_bf16 v[80:95], v[16:19], v[200:203], v[80:95]
  v_mul_f32 v44, s52, v44
  v_mul_f32 v45, s52, v45
  ds_read_b128 v[16:19], v8 offset:16640
  s_waitcnt lgkmcnt(3)
  v_mfma_f32_32x32x16_bf16 v[64:79], v[20:23], v[140:143], v[64:79]
  buffer_load_dwordx4 v5, s[56:59], s22 offen offset:1024 lds
  v_cvt_pk_bf16_f32 v42, v44, v45
  v_mul_f32 v46, s52, v46
  v_mul_f32 v47, s52, v47
  v_mfma_f32_32x32x16_bf16 v[80:95], v[20:23], v[204:207], v[80:95]
  v_cvt_pk_bf16_f32 v43, v46, v47
  v_permlane16_swap_b32 v32, v40
  ds_read_b128 v[20:23], v9 offset:16640
  s_waitcnt lgkmcnt(3)
  v_mfma_f32_32x32x16_bf16 v[64:79], v[24:27], v[144:147], v[64:79]
  buffer_load_dwordx4 v6, s[56:59], s22 offen offset:2048 lds
  v_permlane16_swap_b32 v33, v41
  v_permlane16_swap_b32 v34, v42
  v_permlane16_swap_b32 v35, v43
  v_mfma_f32_32x32x16_bf16 v[80:95], v[24:27], v[208:211], v[80:95]
  v_accvgpr_write_b32 a16, v32
  v_accvgpr_write_b32 a17, v33
  ds_read_b128 v[24:27], v10 offset:16640
  s_waitcnt lgkmcnt(3)
  v_mfma_f32_32x32x16_bf16 v[64:79], v[28:31], v[148:151], v[64:79]
  buffer_load_dwordx4 v7, s[56:59], s22 offen offset:3072 lds
  v_accvgpr_write_b32 a18, v34
  v_accvgpr_write_b32 a19, v35
  v_accvgpr_write_b32 a72, v40
  v_mfma_f32_32x32x16_bf16 v[80:95], v[28:31], v[212:215], v[80:95]
  v_accvgpr_write_b32 a73, v41
  v_accvgpr_write_b32 a74, v42
  ds_read_b128 v[28:31], v11 offset:16640
  s_waitcnt lgkmcnt(3)
  v_mfma_f32_32x32x16_bf16 v[64:79], v[16:19], v[152:155], v[64:79]
  v_accvgpr_write_b32 a75, v43
  v_mul_f32 v48, s52, v48
  v_mul_f32 v49, s52, v49
  v_mfma_f32_32x32x16_bf16 v[80:95], v[16:19], v[216:219], v[80:95]
  v_cvt_pk_bf16_f32 v48, v48, v49
  v_mul_f32 v50, s52, v50
  ds_read_b128 v[16:19], v12 offset:16640
  s_waitcnt lgkmcnt(3)
  v_mfma_f32_32x32x16_bf16 v[64:79], v[20:23], v[156:159], v[64:79]
  v_mul_f32 v51, s52, v51
  v_cvt_pk_bf16_f32 v49, v50, v51
  v_mul_f32 v52, s52, v52
  v_mfma_f32_32x32x16_bf16 v[80:95], v[20:23], v[220:223], v[80:95]
  v_mul_f32 v53, s52, v53
  v_cvt_pk_bf16_f32 v50, v52, v53
  ds_read_b128 v[20:23], v13 offset:16640
  s_waitcnt lgkmcnt(3)
  v_mfma_f32_32x32x16_bf16 v[64:79], v[24:27], v[160:163], v[64:79]
  v_mul_f32 v54, s52, v54
  v_mul_f32 v55, s52, v55
  v_cvt_pk_bf16_f32 v51, v54, v55
  v_mfma_f32_32x32x16_bf16 v[80:95], v[24:27], v[224:227], v[80:95]
  v_mul_f32 v56, s52, v56
  v_mul_f32 v57, s52, v57
  ds_read_b128 v[24:27], v14 offset:16640
  s_waitcnt lgkmcnt(3)
  v_mfma_f32_32x32x16_bf16 v[64:79], v[28:31], v[164:167], v[64:79]
  v_cvt_pk_bf16_f32 v56, v56, v57
  v_mul_f32 v58, s52, v58
  v_mul_f32 v59, s52, v59
  v_mfma_f32_32x32x16_bf16 v[80:95], v[28:31], v[228:231], v[80:95]
  v_cvt_pk_bf16_f32 v57, v58, v59
  v_mul_f32 v60, s52, v60
  ds_read_b128 v[28:31], v15 offset:16640
  s_waitcnt lgkmcnt(3)
  v_mfma_f32_32x32x16_bf16 v[64:79], v[16:19], v[168:171], v[64:79]
  v_mul_f32 v61, s52, v61
  v_cvt_pk_bf16_f32 v58, v60, v61
  v_mul_f32 v62, s52, v62
  v_mfma_f32_32x32x16_bf16 v[80:95], v[16:19], v[232:235], v[80:95]
  v_mul_f32 v63, s52, v63
  v_cvt_pk_bf16_f32 v59, v62, v63
  ds_read_b128 v[16:19], v8 offset:32768
  s_waitcnt lgkmcnt(3)
  v_mfma_f32_32x32x16_bf16 v[64:79], v[20:23], v[172:175], v[64:79]
  v_permlane16_swap_b32 v48, v56
  v_permlane16_swap_b32 v49, v57
  v_permlane16_swap_b32 v50, v58
  v_mfma_f32_32x32x16_bf16 v[80:95], v[20:23], v[236:239], v[80:95]
  v_permlane16_swap_b32 v51, v59
  v_accvgpr_write_b32 a128, v48
  ds_read_b128 v[20:23], v9 offset:32768
  s_waitcnt lgkmcnt(3)
  v_mfma_f32_32x32x16_bf16 v[64:79], v[24:27], v[176:179], v[64:79]
  v_accvgpr_write_b32 a129, v49
  v_accvgpr_write_b32 a130, v50
  v_accvgpr_write_b32 a131, v51
  v_mfma_f32_32x32x16_bf16 v[80:95], v[24:27], v[240:243], v[80:95]
  v_accvgpr_write_b32 a184, v56
  v_accvgpr_write_b32 a185, v57
  ds_read_b128 v[24:27], v10 offset:32768
  s_waitcnt lgkmcnt(3)
  v_mfma_f32_32x32x16_bf16 v[64:79], v[28:31], v[180:183], v[64:79]
  v_accvgpr_write_b32 a186, v58
  v_accvgpr_write_b32 a187, v59
  v_mfma_f32_32x32x16_bf16 v[80:95], v[28:31], v[244:247], v[80:95]
  ds_read_b128 v[28:31], v11 offset:32768
  s_waitcnt lgkmcnt(3)
  v_mfma_f32_32x32x16_bf16 v[32:47], v[16:19], v[120:123], 0
  v_mfma_f32_32x32x16_bf16 v[48:63], v[16:19], v[184:187], 0
  ds_read_b128 v[16:19], v12 offset:32768
  s_waitcnt lgkmcnt(3)
  v_mfma_f32_32x32x16_bf16 v[32:47], v[20:23], v[124:127], v[32:47]
  v_mul_f32 v64, s52, v64
  v_mul_f32 v65, s52, v65
  v_cvt_pk_bf16_f32 v64, v64, v65
  v_mfma_f32_32x32x16_bf16 v[48:63], v[20:23], v[188:191], v[48:63]
  v_mul_f32 v66, s52, v66
  v_mul_f32 v67, s52, v67
  ds_read_b128 v[20:23], v13 offset:32768
  s_waitcnt lgkmcnt(3)
  v_mfma_f32_32x32x16_bf16 v[32:47], v[24:27], v[128:131], v[32:47]
  v_cvt_pk_bf16_f32 v65, v66, v67
  v_mul_f32 v68, s52, v68
  v_mul_f32 v69, s52, v69
  v_mfma_f32_32x32x16_bf16 v[48:63], v[24:27], v[192:195], v[48:63]
  v_cvt_pk_bf16_f32 v66, v68, v69
  v_mul_f32 v70, s52, v70
  ds_read_b128 v[24:27], v14 offset:32768
  s_waitcnt lgkmcnt(3)
  v_mfma_f32_32x32x16_bf16 v[32:47], v[28:31], v[132:135], v[32:47]
  v_mul_f32 v71, s52, v71
  v_cvt_pk_bf16_f32 v67, v70, v71
  v_mul_f32 v72, s52, v72
  v_mfma_f32_32x32x16_bf16 v[48:63], v[28:31], v[196:199], v[48:63]
  v_mul_f32 v73, s52, v73
  v_cvt_pk_bf16_f32 v72, v72, v73
  ds_read_b128 v[28:31], v15 offset:32768
  s_waitcnt lgkmcnt(3)
  v_mfma_f32_32x32x16_bf16 v[32:47], v[16:19], v[136:139], v[32:47]
  v_mul_f32 v74, s52, v74
  v_mul_f32 v75, s52, v75
  v_cvt_pk_bf16_f32 v73, v74, v75
  v_mfma_f32_32x32x16_bf16 v[48:63], v[16:19], v[200:203], v[48:63]
  v_mul_f32 v76, s52, v76
  v_mul_f32 v77, s52, v77
  ds_read_b128 v[16:19], v8 offset:33024
  s_waitcnt lgkmcnt(3)
  v_mfma_f32_32x32x16_bf16 v[32:47], v[20:23], v[140:143], v[32:47]
  v_cvt_pk_bf16_f32 v74, v76, v77
  v_mul_f32 v78, s52, v78
  v_mul_f32 v79, s52, v79
  v_mfma_f32_32x32x16_bf16 v[48:63], v[20:23], v[204:207], v[48:63]
  v_cvt_pk_bf16_f32 v75, v78, v79
  v_permlane16_swap_b32 v64, v72
  ds_read_b128 v[20:23], v9 offset:33024
  s_waitcnt lgkmcnt(3)
  v_mfma_f32_32x32x16_bf16 v[32:47], v[24:27], v[144:147], v[32:47]
  v_permlane16_swap_b32 v65, v73
  v_permlane16_swap_b32 v66, v74
  v_permlane16_swap_b32 v67, v75
  v_mfma_f32_32x32x16_bf16 v[48:63], v[24:27], v[208:211], v[48:63]
  v_accvgpr_write_b32 a20, v64
  v_accvgpr_write_b32 a21, v65
  ds_read_b128 v[24:27], v10 offset:33024
  s_waitcnt lgkmcnt(3)
  v_mfma_f32_32x32x16_bf16 v[32:47], v[28:31], v[148:151], v[32:47]
  v_accvgpr_write_b32 a22, v66
  v_accvgpr_write_b32 a23, v67
  v_accvgpr_write_b32 a76, v72
  v_mfma_f32_32x32x16_bf16 v[48:63], v[28:31], v[212:215], v[48:63]
  v_accvgpr_write_b32 a77, v73
  v_accvgpr_write_b32 a78, v74
  ds_read_b128 v[28:31], v11 offset:33024
  s_waitcnt lgkmcnt(3)
  v_mfma_f32_32x32x16_bf16 v[32:47], v[16:19], v[152:155], v[32:47]
  v_accvgpr_write_b32 a79, v75
  v_mul_f32 v80, s52, v80
  v_mul_f32 v81, s52, v81
  v_mfma_f32_32x32x16_bf16 v[48:63], v[16:19], v[216:219], v[48:63]
  v_cvt_pk_bf16_f32 v80, v80, v81
  v_mul_f32 v82, s52, v82
  ds_read_b128 v[16:19], v12 offset:33024
  s_waitcnt lgkmcnt(3)
  v_mfma_f32_32x32x16_bf16 v[32:47], v[20:23], v[156:159], v[32:47]
  v_mul_f32 v83, s52, v83
  v_cvt_pk_bf16_f32 v81, v82, v83
  v_mul_f32 v84, s52, v84
  v_mfma_f32_32x32x16_bf16 v[48:63], v[20:23], v[220:223], v[48:63]
  v_mul_f32 v85, s52, v85
  v_cvt_pk_bf16_f32 v82, v84, v85
  ds_read_b128 v[20:23], v13 offset:33024
  s_waitcnt lgkmcnt(3)
  v_mfma_f32_32x32x16_bf16 v[32:47], v[24:27], v[160:163], v[32:47]
  v_mul_f32 v86, s52, v86
  v_mul_f32 v87, s52, v87
  v_cvt_pk_bf16_f32 v83, v86, v87
  v_mfma_f32_32x32x16_bf16 v[48:63], v[24:27], v[224:227], v[48:63]
  v_mul_f32 v88, s52, v88
  v_mul_f32 v89, s52, v89
  ds_read_b128 v[24:27], v14 offset:33024
  s_waitcnt lgkmcnt(3)
  v_mfma_f32_32x32x16_bf16 v[32:47], v[28:31], v[164:167], v[32:47]
  v_cvt_pk_bf16_f32 v88, v88, v89
  v_mul_f32 v90, s52, v90
  v_mul_f32 v91, s52, v91
  v_mfma_f32_32x32x16_bf16 v[48:63], v[28:31], v[228:231], v[48:63]
  v_cvt_pk_bf16_f32 v89, v90, v91
  v_mul_f32 v92, s52, v92
  ds_read_b128 v[28:31], v15 offset:33024
  s_waitcnt lgkmcnt(3)
  v_mfma_f32_32x32x16_bf16 v[32:47], v[16:19], v[168:171], v[32:47]
  v_mul_f32 v93, s52, v93
  v_cvt_pk_bf16_f32 v90, v92, v93
  v_mul_f32 v94, s52, v94
  v_mfma_f32_32x32x16_bf16 v[48:63], v[16:19], v[232:235], v[48:63]
  v_mul_f32 v95, s52, v95
  v_cvt_pk_bf16_f32 v91, v94, v95
  ds_read_b128 v[16:19], v8 offset:49152
  s_waitcnt lgkmcnt(3)
  v_mfma_f32_32x32x16_bf16 v[32:47], v[20:23], v[172:175], v[32:47]
  v_permlane16_swap_b32 v80, v88
  v_permlane16_swap_b32 v81, v89
  v_permlane16_swap_b32 v82, v90
  v_mfma_f32_32x32x16_bf16 v[48:63], v[20:23], v[236:239], v[48:63]
  v_permlane16_swap_b32 v83, v91
  v_accvgpr_write_b32 a132, v80
  ds_read_b128 v[20:23], v9 offset:49152
  s_waitcnt lgkmcnt(3)
  v_mfma_f32_32x32x16_bf16 v[32:47], v[24:27], v[176:179], v[32:47]
  v_accvgpr_write_b32 a133, v81
  v_accvgpr_write_b32 a134, v82
  v_accvgpr_write_b32 a135, v83
  v_mfma_f32_32x32x16_bf16 v[48:63], v[24:27], v[240:243], v[48:63]
  v_accvgpr_write_b32 a188, v88
  v_accvgpr_write_b32 a189, v89
  ds_read_b128 v[24:27], v10 offset:49152
  s_waitcnt lgkmcnt(3)
  v_mfma_f32_32x32x16_bf16 v[32:47], v[28:31], v[180:183], v[32:47]
  v_accvgpr_write_b32 a190, v90
  v_accvgpr_write_b32 a191, v91
  v_mfma_f32_32x32x16_bf16 v[48:63], v[28:31], v[244:247], v[48:63]
  s_waitcnt vmcnt(16)
  s_barrier
  ds_read_b128 v[28:31], v11 offset:49152
  s_waitcnt lgkmcnt(3)
  v_mfma_f32_32x32x16_bf16 v[64:79], v[16:19], v[120:123], 0
  v_mfma_f32_32x32x16_bf16 v[80:95], v[16:19], v[184:187], 0
  ds_read_b128 v[16:19], v12 offset:49152
  s_waitcnt lgkmcnt(3)
  v_mfma_f32_32x32x16_bf16 v[64:79], v[20:23], v[124:127], v[64:79]
  v_mul_f32 v32, s52, v32
  v_mul_f32 v33, s52, v33
  v_cvt_pk_bf16_f32 v32, v32, v33
  v_mfma_f32_32x32x16_bf16 v[80:95], v[20:23], v[188:191], v[80:95]
  v_mul_f32 v34, s52, v34
  v_mul_f32 v35, s52, v35
  ds_read_b128 v[20:23], v13 offset:49152
  s_waitcnt lgkmcnt(3)
  v_mfma_f32_32x32x16_bf16 v[64:79], v[24:27], v[128:131], v[64:79]
  v_cvt_pk_bf16_f32 v33, v34, v35
  v_mul_f32 v36, s52, v36
  v_mul_f32 v37, s52, v37
  v_mfma_f32_32x32x16_bf16 v[80:95], v[24:27], v[192:195], v[80:95]
  v_cvt_pk_bf16_f32 v34, v36, v37
  v_mul_f32 v38, s52, v38
  ds_read_b128 v[24:27], v14 offset:49152
  s_waitcnt lgkmcnt(3)
  v_mfma_f32_32x32x16_bf16 v[64:79], v[28:31], v[132:135], v[64:79]
  v_mul_f32 v39, s52, v39
  v_cvt_pk_bf16_f32 v35, v38, v39
  v_mul_f32 v40, s52, v40
  v_mfma_f32_32x32x16_bf16 v[80:95], v[28:31], v[196:199], v[80:95]
  v_mul_f32 v41, s52, v41
  v_cvt_pk_bf16_f32 v40, v40, v41
  ds_read_b128 v[28:31], v15 offset:49152
  s_waitcnt lgkmcnt(3)
  v_mfma_f32_32x32x16_bf16 v[64:79], v[16:19], v[136:139], v[64:79]
  v_mul_f32 v42, s52, v42
  v_mul_f32 v43, s52, v43
  v_cvt_pk_bf16_f32 v41, v42, v43
  v_mfma_f32_32x32x16_bf16 v[80:95], v[16:19], v[200:203], v[80:95]
  v_mul_f32 v44, s52, v44
  v_mul_f32 v45, s52, v45
  ds_read_b128 v[16:19], v8 offset:49408
  s_waitcnt lgkmcnt(3)
  v_mfma_f32_32x32x16_bf16 v[64:79], v[20:23], v[140:143], v[64:79]
  v_cvt_pk_bf16_f32 v42, v44, v45
  v_mul_f32 v46, s52, v46
  v_mul_f32 v47, s52, v47
  v_mfma_f32_32x32x16_bf16 v[80:95], v[20:23], v[204:207], v[80:95]
  v_cvt_pk_bf16_f32 v43, v46, v47
  v_permlane16_swap_b32 v32, v40
  ds_read_b128 v[20:23], v9 offset:49408
  s_waitcnt lgkmcnt(3)
  v_mfma_f32_32x32x16_bf16 v[64:79], v[24:27], v[144:147], v[64:79]
  v_permlane16_swap_b32 v33, v41
  v_permlane16_swap_b32 v34, v42
  v_permlane16_swap_b32 v35, v43
  v_mfma_f32_32x32x16_bf16 v[80:95], v[24:27], v[208:211], v[80:95]
  v_accvgpr_write_b32 a24, v32
  v_accvgpr_write_b32 a25, v33
  ds_read_b128 v[24:27], v10 offset:49408
  s_waitcnt lgkmcnt(3)
  v_mfma_f32_32x32x16_bf16 v[64:79], v[28:31], v[148:151], v[64:79]
  v_accvgpr_write_b32 a26, v34
  v_accvgpr_write_b32 a27, v35
  v_accvgpr_write_b32 a80, v40
  v_mfma_f32_32x32x16_bf16 v[80:95], v[28:31], v[212:215], v[80:95]
  v_accvgpr_write_b32 a81, v41
  v_accvgpr_write_b32 a82, v42
  ds_read_b128 v[28:31], v11 offset:49408
  s_waitcnt lgkmcnt(3)
  v_mfma_f32_32x32x16_bf16 v[64:79], v[16:19], v[152:155], v[64:79]
  v_accvgpr_write_b32 a83, v43
  v_mul_f32 v48, s52, v48
  v_mul_f32 v49, s52, v49
  v_mfma_f32_32x32x16_bf16 v[80:95], v[16:19], v[216:219], v[80:95]
  v_cvt_pk_bf16_f32 v48, v48, v49
  v_mul_f32 v50, s52, v50
  ds_read_b128 v[16:19], v12 offset:49408
  s_waitcnt lgkmcnt(3)
  v_mfma_f32_32x32x16_bf16 v[64:79], v[20:23], v[156:159], v[64:79]
  v_mul_f32 v51, s52, v51
  v_cvt_pk_bf16_f32 v49, v50, v51
  v_mul_f32 v52, s52, v52
  v_mfma_f32_32x32x16_bf16 v[80:95], v[20:23], v[220:223], v[80:95]
  v_mul_f32 v53, s52, v53
  v_cvt_pk_bf16_f32 v50, v52, v53
  ds_read_b128 v[20:23], v13 offset:49408
  s_waitcnt lgkmcnt(3)
  v_mfma_f32_32x32x16_bf16 v[64:79], v[24:27], v[160:163], v[64:79]
  v_mul_f32 v54, s52, v54
  v_mul_f32 v55, s52, v55
  v_cvt_pk_bf16_f32 v51, v54, v55
  v_mfma_f32_32x32x16_bf16 v[80:95], v[24:27], v[224:227], v[80:95]
  v_mul_f32 v56, s52, v56
  v_mul_f32 v57, s52, v57
  ds_read_b128 v[24:27], v14 offset:49408
  s_waitcnt lgkmcnt(3)
  v_mfma_f32_32x32x16_bf16 v[64:79], v[28:31], v[164:167], v[64:79]
  v_cvt_pk_bf16_f32 v56, v56, v57
  v_mul_f32 v58, s52, v58
  v_mul_f32 v59, s52, v59
  v_mfma_f32_32x32x16_bf16 v[80:95], v[28:31], v[228:231], v[80:95]
  v_cvt_pk_bf16_f32 v57, v58, v59
  v_mul_f32 v60, s52, v60
  ds_read_b128 v[28:31], v15 offset:49408
  s_waitcnt lgkmcnt(3)
  v_mfma_f32_32x32x16_bf16 v[64:79], v[16:19], v[168:171], v[64:79]
  v_mul_f32 v61, s52, v61
  v_cvt_pk_bf16_f32 v58, v60, v61
  v_mul_f32 v62, s52, v62
  v_mfma_f32_32x32x16_bf16 v[80:95], v[16:19], v[232:235], v[80:95]
  v_mul_f32 v63, s52, v63
  v_cvt_pk_bf16_f32 v59, v62, v63
  v_xor_b32 v8, 196608, v8
  ds_read_b128 v[16:19], v8 offset:0
  s_waitcnt lgkmcnt(3)
  v_mfma_f32_32x32x16_bf16 v[64:79], v[20:23], v[172:175], v[64:79]
  v_permlane16_swap_b32 v48, v56
  v_permlane16_swap_b32 v49, v57
  v_permlane16_swap_b32 v50, v58
  v_mfma_f32_32x32x16_bf16 v[80:95], v[20:23], v[236:239], v[80:95]
  v_permlane16_swap_b32 v51, v59
  v_accvgpr_write_b32 a136, v48
  v_xor_b32 v9, 196608, v9
  ds_read_b128 v[20:23], v9 offset:0
  s_waitcnt lgkmcnt(3)
  v_mfma_f32_32x32x16_bf16 v[64:79], v[24:27], v[176:179], v[64:79]
  v_accvgpr_write_b32 a137, v49
  v_accvgpr_write_b32 a138, v50
  v_accvgpr_write_b32 a139, v51
  v_mfma_f32_32x32x16_bf16 v[80:95], v[24:27], v[240:243], v[80:95]
  v_accvgpr_write_b32 a192, v56
  v_accvgpr_write_b32 a193, v57
  v_xor_b32 v10, 196608, v10
  ds_read_b128 v[24:27], v10 offset:0
  s_waitcnt lgkmcnt(3)
  v_mfma_f32_32x32x16_bf16 v[64:79], v[28:31], v[180:183], v[64:79]
  v_accvgpr_write_b32 a194, v58
  v_accvgpr_write_b32 a195, v59
  v_mfma_f32_32x32x16_bf16 v[80:95], v[28:31], v[244:247], v[80:95]
  v_xor_b32 v11, 196608, v11
  ds_read_b128 v[28:31], v11 offset:0
  s_waitcnt lgkmcnt(3)
  v_mfma_f32_32x32x16_bf16 v[32:47], v[16:19], v[120:123], 0
  v_mfma_f32_32x32x16_bf16 v[48:63], v[16:19], v[184:187], 0
  v_xor_b32 v12, 196608, v12
  ds_read_b128 v[16:19], v12 offset:0
  s_waitcnt lgkmcnt(3)
  v_mfma_f32_32x32x16_bf16 v[32:47], v[20:23], v[124:127], v[32:47]
  v_mul_f32 v64, s52, v64
  v_mul_f32 v65, s52, v65
  v_cvt_pk_bf16_f32 v64, v64, v65
  v_mfma_f32_32x32x16_bf16 v[48:63], v[20:23], v[188:191], v[48:63]
  v_mul_f32 v66, s52, v66
  v_mul_f32 v67, s52, v67
  v_xor_b32 v13, 196608, v13
  ds_read_b128 v[20:23], v13 offset:0
  s_waitcnt lgkmcnt(3)
  v_mfma_f32_32x32x16_bf16 v[32:47], v[24:27], v[128:131], v[32:47]
  v_cvt_pk_bf16_f32 v65, v66, v67
  v_mul_f32 v68, s52, v68
  v_mul_f32 v69, s52, v69
  v_mfma_f32_32x32x16_bf16 v[48:63], v[24:27], v[192:195], v[48:63]
  v_cvt_pk_bf16_f32 v66, v68, v69
  v_mul_f32 v70, s52, v70
  v_xor_b32 v14, 196608, v14
  ds_read_b128 v[24:27], v14 offset:0
  s_waitcnt lgkmcnt(3)
  v_mfma_f32_32x32x16_bf16 v[32:47], v[28:31], v[132:135], v[32:47]
  v_mul_f32 v71, s52, v71
  v_cvt_pk_bf16_f32 v67, v70, v71
  v_mul_f32 v72, s52, v72
  v_mfma_f32_32x32x16_bf16 v[48:63], v[28:31], v[196:199], v[48:63]
  v_mul_f32 v73, s52, v73
  v_cvt_pk_bf16_f32 v72, v72, v73
  v_xor_b32 v15, 196608, v15
  ds_read_b128 v[28:31], v15 offset:0
  s_waitcnt lgkmcnt(3)
  v_mfma_f32_32x32x16_bf16 v[32:47], v[16:19], v[136:139], v[32:47]
  v_mul_f32 v74, s52, v74
  v_mul_f32 v75, s52, v75
  v_cvt_pk_bf16_f32 v73, v74, v75
  v_mfma_f32_32x32x16_bf16 v[48:63], v[16:19], v[200:203], v[48:63]
  v_mul_f32 v76, s52, v76
  v_mul_f32 v77, s52, v77
  ds_read_b128 v[16:19], v8 offset:256
  s_waitcnt lgkmcnt(3)
  v_mfma_f32_32x32x16_bf16 v[32:47], v[20:23], v[140:143], v[32:47]
  v_cvt_pk_bf16_f32 v74, v76, v77
  v_mul_f32 v78, s52, v78
  v_mul_f32 v79, s52, v79
  v_mfma_f32_32x32x16_bf16 v[48:63], v[20:23], v[204:207], v[48:63]
  v_cvt_pk_bf16_f32 v75, v78, v79
  v_permlane16_swap_b32 v64, v72
  ds_read_b128 v[20:23], v9 offset:256
  s_waitcnt lgkmcnt(3)
  v_mfma_f32_32x32x16_bf16 v[32:47], v[24:27], v[144:147], v[32:47]
  v_permlane16_swap_b32 v65, v73
  v_permlane16_swap_b32 v66, v74
  v_permlane16_swap_b32 v67, v75
  v_mfma_f32_32x32x16_bf16 v[48:63], v[24:27], v[208:211], v[48:63]
  v_accvgpr_write_b32 a28, v64
  v_accvgpr_write_b32 a29, v65
  ds_read_b128 v[24:27], v10 offset:256
  s_waitcnt lgkmcnt(3)
  v_mfma_f32_32x32x16_bf16 v[32:47], v[28:31], v[148:151], v[32:47]
  v_accvgpr_write_b32 a30, v66
  v_accvgpr_write_b32 a31, v67
  v_accvgpr_write_b32 a84, v72
  v_mfma_f32_32x32x16_bf16 v[48:63], v[28:31], v[212:215], v[48:63]
  v_accvgpr_write_b32 a85, v73
  v_accvgpr_write_b32 a86, v74
  ds_read_b128 v[28:31], v11 offset:256
  s_waitcnt lgkmcnt(3)
  v_mfma_f32_32x32x16_bf16 v[32:47], v[16:19], v[152:155], v[32:47]
  v_accvgpr_write_b32 a87, v75
  v_mul_f32 v80, s52, v80
  v_mul_f32 v81, s52, v81
  v_mfma_f32_32x32x16_bf16 v[48:63], v[16:19], v[216:219], v[48:63]
  v_cvt_pk_bf16_f32 v80, v80, v81
  v_mul_f32 v82, s52, v82
  ds_read_b128 v[16:19], v12 offset:256
  s_waitcnt lgkmcnt(3)
  v_mfma_f32_32x32x16_bf16 v[32:47], v[20:23], v[156:159], v[32:47]
  v_mul_f32 v83, s52, v83
  v_cvt_pk_bf16_f32 v81, v82, v83
  v_mul_f32 v84, s52, v84
  v_mfma_f32_32x32x16_bf16 v[48:63], v[20:23], v[220:223], v[48:63]
  v_mul_f32 v85, s52, v85
  v_cvt_pk_bf16_f32 v82, v84, v85
  ds_read_b128 v[20:23], v13 offset:256
  s_waitcnt lgkmcnt(3)
  v_mfma_f32_32x32x16_bf16 v[32:47], v[24:27], v[160:163], v[32:47]
  v_mul_f32 v86, s52, v86
  v_mul_f32 v87, s52, v87
  v_cvt_pk_bf16_f32 v83, v86, v87
  v_mfma_f32_32x32x16_bf16 v[48:63], v[24:27], v[224:227], v[48:63]
  v_mul_f32 v88, s52, v88
  v_mul_f32 v89, s52, v89
  ds_read_b128 v[24:27], v14 offset:256
  s_waitcnt lgkmcnt(3)
  v_mfma_f32_32x32x16_bf16 v[32:47], v[28:31], v[164:167], v[32:47]
  v_cvt_pk_bf16_f32 v88, v88, v89
  v_mul_f32 v90, s52, v90
  v_mul_f32 v91, s52, v91
  v_mfma_f32_32x32x16_bf16 v[48:63], v[28:31], v[228:231], v[48:63]
  v_cvt_pk_bf16_f32 v89, v90, v91
  v_mul_f32 v92, s52, v92
  ds_read_b128 v[28:31], v15 offset:256
  s_waitcnt lgkmcnt(3)
  v_mfma_f32_32x32x16_bf16 v[32:47], v[16:19], v[168:171], v[32:47]
  v_mul_f32 v93, s52, v93
  v_cvt_pk_bf16_f32 v90, v92, v93
  v_mul_f32 v94, s52, v94
  v_mfma_f32_32x32x16_bf16 v[48:63], v[16:19], v[232:235], v[48:63]
  v_mul_f32 v95, s52, v95
  v_cvt_pk_bf16_f32 v91, v94, v95
  v_xor_b32 v8, 131072, v8
  ds_read_b128 v[16:19], v8 offset:0
  s_waitcnt lgkmcnt(3)
  v_mfma_f32_32x32x16_bf16 v[32:47], v[20:23], v[172:175], v[32:47]
  v_permlane16_swap_b32 v80, v88
  v_permlane16_swap_b32 v81, v89
  v_permlane16_swap_b32 v82, v90
  v_mfma_f32_32x32x16_bf16 v[48:63], v[20:23], v[236:239], v[48:63]
  v_permlane16_swap_b32 v83, v91
  v_accvgpr_write_b32 a140, v80
  v_xor_b32 v9, 131072, v9
  ds_read_b128 v[20:23], v9 offset:0
  s_waitcnt lgkmcnt(3)
  v_mfma_f32_32x32x16_bf16 v[32:47], v[24:27], v[176:179], v[32:47]
  v_accvgpr_write_b32 a141, v81
  v_accvgpr_write_b32 a142, v82
  v_accvgpr_write_b32 a143, v83
  v_mfma_f32_32x32x16_bf16 v[48:63], v[24:27], v[240:243], v[48:63]
  v_accvgpr_write_b32 a196, v88
  v_accvgpr_write_b32 a197, v89
  v_xor_b32 v10, 131072, v10
  ds_read_b128 v[24:27], v10 offset:0
  s_waitcnt lgkmcnt(3)
  v_mfma_f32_32x32x16_bf16 v[32:47], v[28:31], v[180:183], v[32:47]
  v_accvgpr_write_b32 a198, v90
  v_accvgpr_write_b32 a199, v91
  v_mfma_f32_32x32x16_bf16 v[48:63], v[28:31], v[244:247], v[48:63]
  s_waitcnt vmcnt(8)
  s_barrier
  v_xor_b32 v11, 131072, v11
  ds_read_b128 v[28:31], v11 offset:0
  s_waitcnt lgkmcnt(3)
  v_mfma_f32_32x32x16_bf16 v[64:79], v[16:19], v[120:123], 0
  v_mfma_f32_32x32x16_bf16 v[80:95], v[16:19], v[184:187], 0
  v_xor_b32 v12, 131072, v12
  ds_read_b128 v[16:19], v12 offset:0
  s_waitcnt lgkmcnt(3)
  v_mfma_f32_32x32x16_bf16 v[64:79], v[20:23], v[124:127], v[64:79]
  v_mul_f32 v32, s52, v32
  v_mul_f32 v33, s52, v33
  v_cvt_pk_bf16_f32 v32, v32, v33
  v_mfma_f32_32x32x16_bf16 v[80:95], v[20:23], v[188:191], v[80:95]
  v_mul_f32 v34, s52, v34
  v_mul_f32 v35, s52, v35
  v_xor_b32 v13, 131072, v13
  ds_read_b128 v[20:23], v13 offset:0
  s_waitcnt lgkmcnt(3)
  v_mfma_f32_32x32x16_bf16 v[64:79], v[24:27], v[128:131], v[64:79]
  v_cvt_pk_bf16_f32 v33, v34, v35
  v_mul_f32 v36, s52, v36
  v_mul_f32 v37, s52, v37
  v_mfma_f32_32x32x16_bf16 v[80:95], v[24:27], v[192:195], v[80:95]
  v_cvt_pk_bf16_f32 v34, v36, v37
  v_mul_f32 v38, s52, v38
  v_xor_b32 v14, 131072, v14
  ds_read_b128 v[24:27], v14 offset:0
  s_waitcnt lgkmcnt(3)
  v_mfma_f32_32x32x16_bf16 v[64:79], v[28:31], v[132:135], v[64:79]
  v_mul_f32 v39, s52, v39
  v_cvt_pk_bf16_f32 v35, v38, v39
  v_mul_f32 v40, s52, v40
  v_mfma_f32_32x32x16_bf16 v[80:95], v[28:31], v[196:199], v[80:95]
  v_mul_f32 v41, s52, v41
  v_cvt_pk_bf16_f32 v40, v40, v41
  v_xor_b32 v15, 131072, v15
  ds_read_b128 v[28:31], v15 offset:0
  s_waitcnt lgkmcnt(3)
  v_mfma_f32_32x32x16_bf16 v[64:79], v[16:19], v[136:139], v[64:79]
  v_mul_f32 v42, s52, v42
  v_mul_f32 v43, s52, v43
  v_cvt_pk_bf16_f32 v41, v42, v43
  v_mfma_f32_32x32x16_bf16 v[80:95], v[16:19], v[200:203], v[80:95]
  v_mul_f32 v44, s52, v44
  v_mul_f32 v45, s52, v45
  ds_read_b128 v[16:19], v8 offset:256
  s_waitcnt lgkmcnt(3)
  v_mfma_f32_32x32x16_bf16 v[64:79], v[20:23], v[140:143], v[64:79]
  v_cvt_pk_bf16_f32 v42, v44, v45
  v_mul_f32 v46, s52, v46
  v_mul_f32 v47, s52, v47
  v_mfma_f32_32x32x16_bf16 v[80:95], v[20:23], v[204:207], v[80:95]
  v_cvt_pk_bf16_f32 v43, v46, v47
  v_permlane16_swap_b32 v32, v40
  ds_read_b128 v[20:23], v9 offset:256
  s_waitcnt lgkmcnt(3)
  v_mfma_f32_32x32x16_bf16 v[64:79], v[24:27], v[144:147], v[64:79]
  v_permlane16_swap_b32 v33, v41
  v_permlane16_swap_b32 v34, v42
  v_permlane16_swap_b32 v35, v43
  v_mfma_f32_32x32x16_bf16 v[80:95], v[24:27], v[208:211], v[80:95]
  v_accvgpr_write_b32 a32, v32
  v_accvgpr_write_b32 a33, v33
  ds_read_b128 v[24:27], v10 offset:256
  s_waitcnt lgkmcnt(3)
  v_mfma_f32_32x32x16_bf16 v[64:79], v[28:31], v[148:151], v[64:79]
  v_accvgpr_write_b32 a34, v34
  v_accvgpr_write_b32 a35, v35
  v_accvgpr_write_b32 a88, v40
  v_mfma_f32_32x32x16_bf16 v[80:95], v[28:31], v[212:215], v[80:95]
  v_accvgpr_write_b32 a89, v41
  v_accvgpr_write_b32 a90, v42
  ds_read_b128 v[28:31], v11 offset:256
  s_waitcnt lgkmcnt(3)
  v_mfma_f32_32x32x16_bf16 v[64:79], v[16:19], v[152:155], v[64:79]
  v_accvgpr_write_b32 a91, v43
  v_mul_f32 v48, s52, v48
  v_mul_f32 v49, s52, v49
  v_mfma_f32_32x32x16_bf16 v[80:95], v[16:19], v[216:219], v[80:95]
  v_cvt_pk_bf16_f32 v48, v48, v49
  v_mul_f32 v50, s52, v50
  ds_read_b128 v[16:19], v12 offset:256
  s_waitcnt lgkmcnt(3)
  v_mfma_f32_32x32x16_bf16 v[64:79], v[20:23], v[156:159], v[64:79]
  v_mul_f32 v51, s52, v51
  v_cvt_pk_bf16_f32 v49, v50, v51
  v_mul_f32 v52, s52, v52
  v_mfma_f32_32x32x16_bf16 v[80:95], v[20:23], v[220:223], v[80:95]
  v_mul_f32 v53, s52, v53
  v_cvt_pk_bf16_f32 v50, v52, v53
  ds_read_b128 v[20:23], v13 offset:256
  s_waitcnt lgkmcnt(3)
  v_mfma_f32_32x32x16_bf16 v[64:79], v[24:27], v[160:163], v[64:79]
  v_mul_f32 v54, s52, v54
  v_mul_f32 v55, s52, v55
  v_cvt_pk_bf16_f32 v51, v54, v55
  v_mfma_f32_32x32x16_bf16 v[80:95], v[24:27], v[224:227], v[80:95]
  v_mul_f32 v56, s52, v56
  v_mul_f32 v57, s52, v57
  ds_read_b128 v[24:27], v14 offset:256
  s_waitcnt lgkmcnt(3)
  v_mfma_f32_32x32x16_bf16 v[64:79], v[28:31], v[164:167], v[64:79]
  v_cvt_pk_bf16_f32 v56, v56, v57
  v_mul_f32 v58, s52, v58
  v_mul_f32 v59, s52, v59
  v_mfma_f32_32x32x16_bf16 v[80:95], v[28:31], v[228:231], v[80:95]
  v_cvt_pk_bf16_f32 v57, v58, v59
  v_mul_f32 v60, s52, v60
  ds_read_b128 v[28:31], v15 offset:256
  s_waitcnt lgkmcnt(3)
  v_mfma_f32_32x32x16_bf16 v[64:79], v[16:19], v[168:171], v[64:79]
  v_mul_f32 v61, s52, v61
  v_cvt_pk_bf16_f32 v58, v60, v61
  v_mul_f32 v62, s52, v62
  v_mfma_f32_32x32x16_bf16 v[80:95], v[16:19], v[232:235], v[80:95]
  v_mul_f32 v63, s52, v63
  v_cvt_pk_bf16_f32 v59, v62, v63
  ds_read_b128 v[16:19], v8 offset:16384
  s_waitcnt lgkmcnt(3)
  v_mfma_f32_32x32x16_bf16 v[64:79], v[20:23], v[172:175], v[64:79]
  v_permlane16_swap_b32 v48, v56
  v_permlane16_swap_b32 v49, v57
  v_permlane16_swap_b32 v50, v58
  v_mfma_f32_32x32x16_bf16 v[80:95], v[20:23], v[236:239], v[80:95]
  v_permlane16_swap_b32 v51, v59
  v_accvgpr_write_b32 a144, v48
  ds_read_b128 v[20:23], v9 offset:16384
  s_waitcnt lgkmcnt(3)
  v_mfma_f32_32x32x16_bf16 v[64:79], v[24:27], v[176:179], v[64:79]
  v_accvgpr_write_b32 a145, v49
  v_accvgpr_write_b32 a146, v50
  v_accvgpr_write_b32 a147, v51
  v_mfma_f32_32x32x16_bf16 v[80:95], v[24:27], v[240:243], v[80:95]
  v_accvgpr_write_b32 a200, v56
  v_accvgpr_write_b32 a201, v57
  ds_read_b128 v[24:27], v10 offset:16384
  s_waitcnt lgkmcnt(3)
  v_mfma_f32_32x32x16_bf16 v[64:79], v[28:31], v[180:183], v[64:79]
  v_accvgpr_write_b32 a202, v58
  v_accvgpr_write_b32 a203, v59
  v_mfma_f32_32x32x16_bf16 v[80:95], v[28:31], v[244:247], v[80:95]
  ds_read_b128 v[28:31], v11 offset:16384
  s_waitcnt lgkmcnt(3)
  v_mfma_f32_32x32x16_bf16 v[32:47], v[16:19], v[120:123], 0
  v_mfma_f32_32x32x16_bf16 v[48:63], v[16:19], v[184:187], 0
  ds_read_b128 v[16:19], v12 offset:16384
  s_waitcnt lgkmcnt(3)
  v_mfma_f32_32x32x16_bf16 v[32:47], v[20:23], v[124:127], v[32:47]
  v_mul_f32 v64, s52, v64
  v_mul_f32 v65, s52, v65
  v_cvt_pk_bf16_f32 v64, v64, v65
  v_mfma_f32_32x32x16_bf16 v[48:63], v[20:23], v[188:191], v[48:63]
  v_mul_f32 v66, s52, v66
  v_mul_f32 v67, s52, v67
  ds_read_b128 v[20:23], v13 offset:16384
  s_waitcnt lgkmcnt(3)
  v_mfma_f32_32x32x16_bf16 v[32:47], v[24:27], v[128:131], v[32:47]
  v_cvt_pk_bf16_f32 v65, v66, v67
  v_mul_f32 v68, s52, v68
  v_mul_f32 v69, s52, v69
  v_mfma_f32_32x32x16_bf16 v[48:63], v[24:27], v[192:195], v[48:63]
  v_cvt_pk_bf16_f32 v66, v68, v69
  v_mul_f32 v70, s52, v70
  ds_read_b128 v[24:27], v14 offset:16384
  s_waitcnt lgkmcnt(3)
  v_mfma_f32_32x32x16_bf16 v[32:47], v[28:31], v[132:135], v[32:47]
  v_mul_f32 v71, s52, v71
  v_cvt_pk_bf16_f32 v67, v70, v71
  v_mul_f32 v72, s52, v72
  v_mfma_f32_32x32x16_bf16 v[48:63], v[28:31], v[196:199], v[48:63]
  v_mul_f32 v73, s52, v73
  v_cvt_pk_bf16_f32 v72, v72, v73
  ds_read_b128 v[28:31], v15 offset:16384
  s_waitcnt lgkmcnt(3)
  v_mfma_f32_32x32x16_bf16 v[32:47], v[16:19], v[136:139], v[32:47]
  buffer_load_dwordx4 v[100:103], v113, s[8:11], s28 offen sc1
  v_mul_f32 v74, s52, v74
  v_mul_f32 v75, s52, v75
  v_cvt_pk_bf16_f32 v73, v74, v75
  v_mfma_f32_32x32x16_bf16 v[48:63], v[16:19], v[200:203], v[48:63]
  v_mul_f32 v76, s52, v76
  v_mul_f32 v77, s52, v77
  ds_read_b128 v[16:19], v8 offset:16640
  s_waitcnt lgkmcnt(3)
  v_mfma_f32_32x32x16_bf16 v[32:47], v[20:23], v[140:143], v[32:47]
  v_cvt_pk_bf16_f32 v74, v76, v77
  v_mul_f32 v78, s52, v78
  v_mul_f32 v79, s52, v79
  v_mfma_f32_32x32x16_bf16 v[48:63], v[20:23], v[204:207], v[48:63]
  v_cvt_pk_bf16_f32 v75, v78, v79
  v_permlane16_swap_b32 v64, v72
  ds_read_b128 v[20:23], v9 offset:16640
  s_waitcnt lgkmcnt(3)
  v_mfma_f32_32x32x16_bf16 v[32:47], v[24:27], v[144:147], v[32:47]
  v_permlane16_swap_b32 v65, v73
  v_permlane16_swap_b32 v66, v74
  v_permlane16_swap_b32 v67, v75
  v_mfma_f32_32x32x16_bf16 v[48:63], v[24:27], v[208:211], v[48:63]
  v_accvgpr_write_b32 a36, v64
  v_accvgpr_write_b32 a37, v65
  ds_read_b128 v[24:27], v10 offset:16640
  s_waitcnt lgkmcnt(3)
  v_mfma_f32_32x32x16_bf16 v[32:47], v[28:31], v[148:151], v[32:47]
  v_accvgpr_write_b32 a38, v66
  v_accvgpr_write_b32 a39, v67
  v_accvgpr_write_b32 a92, v72
  v_mfma_f32_32x32x16_bf16 v[48:63], v[28:31], v[212:215], v[48:63]
  v_accvgpr_write_b32 a93, v73
  v_accvgpr_write_b32 a94, v74
  ds_read_b128 v[28:31], v11 offset:16640
  s_waitcnt lgkmcnt(3)
  v_mfma_f32_32x32x16_bf16 v[32:47], v[16:19], v[152:155], v[32:47]
  v_accvgpr_write_b32 a95, v75
  v_mul_f32 v80, s52, v80
  v_mul_f32 v81, s52, v81
  v_mfma_f32_32x32x16_bf16 v[48:63], v[16:19], v[216:219], v[48:63]
  v_cvt_pk_bf16_f32 v80, v80, v81
  v_mul_f32 v82, s52, v82
  ds_read_b128 v[16:19], v12 offset:16640
  s_waitcnt lgkmcnt(3)
  v_mfma_f32_32x32x16_bf16 v[32:47], v[20:23], v[156:159], v[32:47]
  v_mul_f32 v83, s52, v83
  v_cvt_pk_bf16_f32 v81, v82, v83
  v_mul_f32 v84, s52, v84
  v_mfma_f32_32x32x16_bf16 v[48:63], v[20:23], v[220:223], v[48:63]
  v_mul_f32 v85, s52, v85
  v_cvt_pk_bf16_f32 v82, v84, v85
  ds_read_b128 v[20:23], v13 offset:16640
  s_waitcnt lgkmcnt(3)
  v_mfma_f32_32x32x16_bf16 v[32:47], v[24:27], v[160:163], v[32:47]
  v_mul_f32 v86, s52, v86
  v_mul_f32 v87, s52, v87
  v_cvt_pk_bf16_f32 v83, v86, v87
  v_mfma_f32_32x32x16_bf16 v[48:63], v[24:27], v[224:227], v[48:63]
  v_mul_f32 v88, s52, v88
  v_mul_f32 v89, s52, v89
  ds_read_b128 v[24:27], v14 offset:16640
  s_waitcnt lgkmcnt(3)
  v_mfma_f32_32x32x16_bf16 v[32:47], v[28:31], v[164:167], v[32:47]
  v_cvt_pk_bf16_f32 v88, v88, v89
  v_mul_f32 v90, s52, v90
  v_mul_f32 v91, s52, v91
  v_mfma_f32_32x32x16_bf16 v[48:63], v[28:31], v[228:231], v[48:63]
  v_cvt_pk_bf16_f32 v89, v90, v91
  v_mul_f32 v92, s52, v92
  ds_read_b128 v[28:31], v15 offset:16640
  s_waitcnt lgkmcnt(3)
  v_mfma_f32_32x32x16_bf16 v[32:47], v[16:19], v[168:171], v[32:47]
  v_mul_f32 v93, s52, v93
  v_cvt_pk_bf16_f32 v90, v92, v93
  v_mul_f32 v94, s52, v94
  v_mfma_f32_32x32x16_bf16 v[48:63], v[16:19], v[232:235], v[48:63]
  v_mul_f32 v95, s52, v95
  v_cvt_pk_bf16_f32 v91, v94, v95
  ds_read_b128 v[16:19], v8 offset:32768
  s_waitcnt lgkmcnt(3)
  v_mfma_f32_32x32x16_bf16 v[32:47], v[20:23], v[172:175], v[32:47]
  v_permlane16_swap_b32 v80, v88
  v_permlane16_swap_b32 v81, v89
  v_permlane16_swap_b32 v82, v90
  v_mfma_f32_32x32x16_bf16 v[48:63], v[20:23], v[236:239], v[48:63]
  v_permlane16_swap_b32 v83, v91
  v_accvgpr_write_b32 a148, v80
  ds_read_b128 v[20:23], v9 offset:32768
  s_waitcnt lgkmcnt(3)
  v_mfma_f32_32x32x16_bf16 v[32:47], v[24:27], v[176:179], v[32:47]
  v_accvgpr_write_b32 a149, v81
  v_accvgpr_write_b32 a150, v82
  v_accvgpr_write_b32 a151, v83
  v_mfma_f32_32x32x16_bf16 v[48:63], v[24:27], v[240:243], v[48:63]
  v_accvgpr_write_b32 a204, v88
  v_accvgpr_write_b32 a205, v89
  ds_read_b128 v[24:27], v10 offset:32768
  s_waitcnt lgkmcnt(3)
  v_mfma_f32_32x32x16_bf16 v[32:47], v[28:31], v[180:183], v[32:47]
  v_accvgpr_write_b32 a206, v90
  v_accvgpr_write_b32 a207, v91
  v_mfma_f32_32x32x16_bf16 v[48:63], v[28:31], v[244:247], v[48:63]
  s_waitcnt vmcnt(1)
  s_barrier
  ds_read_b128 v[28:31], v11 offset:32768
  s_waitcnt lgkmcnt(3)
  v_mfma_f32_32x32x16_bf16 v[64:79], v[16:19], v[120:123], 0
  s_waitcnt vmcnt(0)
  v_cmp_ne_u64 vcc, s[88:89], v[100:101]
  v_cmp_ne_u64 s[54:55], s[88:89], v[102:103]
  s_add_u32 s48, s33, 14336
  v_mfma_f32_32x32x16_bf16 v[80:95], v[16:19], v[184:187], 0
  ds_read_b128 v[16:19], v12 offset:32768
  s_waitcnt lgkmcnt(3)
  v_mfma_f32_32x32x16_bf16 v[64:79], v[20:23], v[124:127], v[64:79]
  s_or_b64 vcc, vcc, s[54:55]
  s_cselect_b32 s48, 0x10000000, s48
  s_add_u32 s22, s48, 0
  s_add_u32 m0, s25, 0
  s_nop 0
  buffer_load_dwordx4 v2, s[8:11], s22 offen sc1 lds
  v_mul_f32 v32, s52, v32
  v_mul_f32 v33, s52, v33
  v_cvt_pk_bf16_f32 v32, v32, v33
  v_mfma_f32_32x32x16_bf16 v[80:95], v[20:23], v[188:191], v[80:95]
  v_mul_f32 v34, s52, v34
  v_mul_f32 v35, s52, v35
  ds_read_b128 v[20:23], v13 offset:32768
  s_waitcnt lgkmcnt(3)
  v_mfma_f32_32x32x16_bf16 v[64:79], v[24:27], v[128:131], v[64:79]
  s_add_u32 s22, s48, 1024
  s_add_u32 m0, s25, 1024
  s_nop 0
  buffer_load_dwordx4 v2, s[8:11], s22 offen sc1 lds
  v_cvt_pk_bf16_f32 v33, v34, v35
  v_mul_f32 v36, s52, v36
  v_mul_f32 v37, s52, v37
  v_mfma_f32_32x32x16_bf16 v[80:95], v[24:27], v[192:195], v[80:95]
  v_cvt_pk_bf16_f32 v34, v36, v37
  v_mul_f32 v38, s52, v38
  ds_read_b128 v[24:27], v14 offset:32768
  s_waitcnt lgkmcnt(3)
  v_mfma_f32_32x32x16_bf16 v[64:79], v[28:31], v[132:135], v[64:79]
  s_add_u32 s22, s48, 2048
  s_add_u32 m0, s25, 2048
  s_nop 0
  buffer_load_dwordx4 v2, s[8:11], s22 offen sc1 lds
  v_mul_f32 v39, s52, v39
  v_cvt_pk_bf16_f32 v35, v38, v39
  v_mul_f32 v40, s52, v40
  v_mfma_f32_32x32x16_bf16 v[80:95], v[28:31], v[196:199], v[80:95]
  v_mul_f32 v41, s52, v41
  v_cvt_pk_bf16_f32 v40, v40, v41
  ds_read_b128 v[28:31], v15 offset:32768
  s_waitcnt lgkmcnt(3)
  v_mfma_f32_32x32x16_bf16 v[64:79], v[16:19], v[136:139], v[64:79]
  s_add_u32 s22, s48, 3072
  s_add_u32 m0, s25, 3072
  s_nop 0
  buffer_load_dwordx4 v2, s[8:11], s22 offen sc1 lds
  v_mul_f32 v42, s52, v42
  v_mul_f32 v43, s52, v43
  v_cvt_pk_bf16_f32 v41, v42, v43
  v_mfma_f32_32x32x16_bf16 v[80:95], v[16:19], v[200:203], v[80:95]
  v_mul_f32 v44, s52, v44
  v_mul_f32 v45, s52, v45
  ds_read_b128 v[16:19], v8 offset:33024
  s_waitcnt lgkmcnt(3)
  v_mfma_f32_32x32x16_bf16 v[64:79], v[20:23], v[140:143], v[64:79]
  s_add_u32 s22, s48, 4096
  s_add_u32 m0, s25, 16384
  s_nop 0
  buffer_load_dwordx4 v2, s[8:11], s22 offen sc1 lds
  buffer_load_dwordx4 v[100:103], v113, s[8:11], s28 offen sc1
  v_cvt_pk_bf16_f32 v42, v44, v45
  v_mul_f32 v46, s52, v46
  v_mul_f32 v47, s52, v47
  v_mfma_f32_32x32x16_bf16 v[80:95], v[20:23], v[204:207], v[80:95]
  v_cvt_pk_bf16_f32 v43, v46, v47
  v_permlane16_swap_b32 v32, v40
  ds_read_b128 v[20:23], v9 offset:33024
  s_waitcnt lgkmcnt(3)
  v_mfma_f32_32x32x16_bf16 v[64:79], v[24:27], v[144:147], v[64:79]
  s_add_u32 s22, s48, 5120
  s_add_u32 m0, s25, 17408
  s_nop 0
  buffer_load_dwordx4 v2, s[8:11], s22 offen sc1 lds
  v_permlane16_swap_b32 v33, v41
  v_permlane16_swap_b32 v34, v42
  v_permlane16_swap_b32 v35, v43
  v_mfma_f32_32x32x16_bf16 v[80:95], v[24:27], v[208:211], v[80:95]
  v_accvgpr_write_b32 a40, v32
  v_accvgpr_write_b32 a41, v33
  ds_read_b128 v[24:27], v10 offset:33024
  s_waitcnt lgkmcnt(3)
  v_mfma_f32_32x32x16_bf16 v[64:79], v[28:31], v[148:151], v[64:79]
  s_add_u32 s22, s48, 6144
  s_add_u32 m0, s25, 18432
  s_nop 0
  buffer_load_dwordx4 v2, s[8:11], s22 offen sc1 lds
  v_accvgpr_write_b32 a42, v34
  v_accvgpr_write_b32 a43, v35
  v_accvgpr_write_b32 a96, v40
  v_mfma_f32_32x32x16_bf16 v[80:95], v[28:31], v[212:215], v[80:95]
  v_accvgpr_write_b32 a97, v41
  v_accvgpr_write_b32 a98, v42
  ds_read_b128 v[28:31], v11 offset:33024
  s_waitcnt lgkmcnt(3)
  v_mfma_f32_32x32x16_bf16 v[64:79], v[16:19], v[152:155], v[64:79]
  s_add_u32 s22, s48, 7168
  s_add_u32 m0, s25, 19456
  s_nop 0
  buffer_load_dwordx4 v2, s[8:11], s22 offen sc1 lds
  v_accvgpr_write_b32 a99, v43
  v_mul_f32 v48, s52, v48
  v_mul_f32 v49, s52, v49
  v_mfma_f32_32x32x16_bf16 v[80:95], v[16:19], v[216:219], v[80:95]
  v_cvt_pk_bf16_f32 v48, v48, v49
  v_mul_f32 v50, s52, v50
  ds_read_b128 v[16:19], v12 offset:33024
  s_waitcnt lgkmcnt(3)
  v_mfma_f32_32x32x16_bf16 v[64:79], v[20:23], v[156:159], v[64:79]
  s_add_u32 s22, s48, 8192
  s_add_u32 m0, s25, 81920
  s_nop 0
  buffer_load_dwordx4 v2, s[8:11], s22 offen sc1 lds
  v_mul_f32 v51, s52, v51
  v_cvt_pk_bf16_f32 v49, v50, v51
  v_mul_f32 v52, s52, v52
  v_mfma_f32_32x32x16_bf16 v[80:95], v[20:23], v[220:223], v[80:95]
  v_mul_f32 v53, s52, v53
  v_cvt_pk_bf16_f32 v50, v52, v53
  ds_read_b128 v[20:23], v13 offset:33024
  s_waitcnt lgkmcnt(3)
  v_mfma_f32_32x32x16_bf16 v[64:79], v[24:27], v[160:163], v[64:79]
  s_add_u32 s22, s48, 9216
  s_add_u32 m0, s25, 82944
  s_nop 0
  buffer_load_dwordx4 v2, s[8:11], s22 offen sc1 lds
  v_mul_f32 v54, s52, v54
  v_mul_f32 v55, s52, v55
  v_cvt_pk_bf16_f32 v51, v54, v55
  v_mfma_f32_32x32x16_bf16 v[80:95], v[24:27], v[224:227], v[80:95]
  v_mul_f32 v56, s52, v56
  v_mul_f32 v57, s52, v57
  ds_read_b128 v[24:27], v14 offset:33024
  s_waitcnt lgkmcnt(3)
  v_mfma_f32_32x32x16_bf16 v[64:79], v[28:31], v[164:167], v[64:79]
  s_add_u32 s22, s48, 10240
  s_add_u32 m0, s25, 83968
  s_nop 0
  buffer_load_dwordx4 v2, s[8:11], s22 offen sc1 lds
  v_cvt_pk_bf16_f32 v56, v56, v57
  v_mul_f32 v58, s52, v58
  v_mul_f32 v59, s52, v59
  v_mfma_f32_32x32x16_bf16 v[80:95], v[28:31], v[228:231], v[80:95]
  v_cvt_pk_bf16_f32 v57, v58, v59
  v_mul_f32 v60, s52, v60
  ds_read_b128 v[28:31], v15 offset:33024
  s_waitcnt lgkmcnt(3)
  v_mfma_f32_32x32x16_bf16 v[64:79], v[16:19], v[168:171], v[64:79]
  s_add_u32 s22, s48, 11264
  s_add_u32 m0, s25, 84992
  s_nop 0
  buffer_load_dwordx4 v2, s[8:11], s22 offen sc1 lds
  v_mul_f32 v61, s52, v61
  v_cvt_pk_bf16_f32 v58, v60, v61
  v_mul_f32 v62, s52, v62
  v_mfma_f32_32x32x16_bf16 v[80:95], v[16:19], v[232:235], v[80:95]
  v_mul_f32 v63, s52, v63
  v_cvt_pk_bf16_f32 v59, v62, v63
  ds_read_b128 v[16:19], v8 offset:49152
  s_waitcnt lgkmcnt(3)
  v_mfma_f32_32x32x16_bf16 v[64:79], v[20:23], v[172:175], v[64:79]
  s_add_u32 s22, s48, 12288
  s_add_u32 m0, s25, 98304
  s_nop 0
  buffer_load_dwordx4 v2, s[8:11], s22 offen sc1 lds
  v_permlane16_swap_b32 v48, v56
  v_permlane16_swap_b32 v49, v57
  v_permlane16_swap_b32 v50, v58
  v_mfma_f32_32x32x16_bf16 v[80:95], v[20:23], v[236:239], v[80:95]
  v_permlane16_swap_b32 v51, v59
  v_accvgpr_write_b32 a152, v48
  ds_read_b128 v[20:23], v9 offset:49152
  s_waitcnt lgkmcnt(3)
  v_mfma_f32_32x32x16_bf16 v[64:79], v[24:27], v[176:179], v[64:79]
  s_add_u32 s22, s48, 13312
  s_add_u32 m0, s25, 99328
  s_nop 0
  buffer_load_dwordx4 v2, s[8:11], s22 offen sc1 lds
  v_accvgpr_write_b32 a153, v49
  v_accvgpr_write_b32 a154, v50
  v_accvgpr_write_b32 a155, v51
  v_mfma_f32_32x32x16_bf16 v[80:95], v[24:27], v[240:243], v[80:95]
  v_accvgpr_write_b32 a208, v56
  v_accvgpr_write_b32 a209, v57
  ds_read_b128 v[24:27], v10 offset:49152
  s_waitcnt lgkmcnt(3)
  v_mfma_f32_32x32x16_bf16 v[64:79], v[28:31], v[180:183], v[64:79]
  v_accvgpr_write_b32 a210, v58
  v_accvgpr_write_b32 a211, v59
  v_mfma_f32_32x32x16_bf16 v[80:95], v[28:31], v[244:247], v[80:95]
  ds_read_b128 v[28:31], v11 offset:49152
  s_waitcnt lgkmcnt(3)
  v_mfma_f32_32x32x16_bf16 v[32:47], v[16:19], v[120:123], 0
  s_waitcnt vmcnt(9)
  v_cmp_ne_u64 vcc, s[88:89], v[100:101]
  v_cmp_ne_u64 s[54:55], s[88:89], v[102:103]
  s_add_u32 s49, s32, 0
  v_mfma_f32_32x32x16_bf16 v[48:63], v[16:19], v[184:187], 0
  ds_read_b128 v[16:19], v12 offset:49152
  s_waitcnt lgkmcnt(3)
  v_mfma_f32_32x32x16_bf16 v[32:47], v[20:23], v[124:127], v[32:47]
  s_or_b64 vcc, vcc, s[54:55]
  s_cselect_b32 s49, 0x10000000, s49
  s_add_u32 s22, s49, 0
  s_add_u32 m0, s25, 100352
  s_nop 0
  buffer_load_dwordx4 v2, s[8:11], s22 offen sc1 lds
  v_mul_f32 v64, s52, v64
  v_mul_f32 v65, s52, v65
  v_cvt_pk_bf16_f32 v64, v64, v65
  v_mfma_f32_32x32x16_bf16 v[48:63], v[20:23], v[188:191], v[48:63]
  v_mul_f32 v66, s52, v66
  v_mul_f32 v67, s52, v67
  ds_read_b128 v[20:23], v13 offset:49152
  s_waitcnt lgkmcnt(3)
  v_mfma_f32_32x32x16_bf16 v[32:47], v[24:27], v[128:131], v[32:47]
  s_add_u32 s22, s49, 1024
  s_add_u32 m0, s25, 101376
  s_nop 0
  buffer_load_dwordx4 v2, s[8:11], s22 offen sc1 lds
  v_cvt_pk_bf16_f32 v65, v66, v67
  v_mul_f32 v68, s52, v68
  v_mul_f32 v69, s52, v69
  v_mfma_f32_32x32x16_bf16 v[48:63], v[24:27], v[192:195], v[48:63]
  v_cvt_pk_bf16_f32 v66, v68, v69
  v_mul_f32 v70, s52, v70
  ds_read_b128 v[24:27], v14 offset:49152
  s_waitcnt lgkmcnt(3)
  v_mfma_f32_32x32x16_bf16 v[32:47], v[28:31], v[132:135], v[32:47]
  s_add_u32 s22, s49, 2048
  s_add_u32 m0, s25, 114688
  s_nop 0
  buffer_load_dwordx4 v2, s[8:11], s22 offen sc1 lds
  v_mul_f32 v71, s52, v71
  v_cvt_pk_bf16_f32 v67, v70, v71
  v_mul_f32 v72, s52, v72
  v_mfma_f32_32x32x16_bf16 v[48:63], v[28:31], v[196:199], v[48:63]
  v_mul_f32 v73, s52, v73
  v_cvt_pk_bf16_f32 v72, v72, v73
  ds_read_b128 v[28:31], v15 offset:49152
  s_waitcnt lgkmcnt(3)
  v_mfma_f32_32x32x16_bf16 v[32:47], v[16:19], v[136:139], v[32:47]
  s_add_u32 s22, s49, 3072
  s_add_u32 m0, s25, 115712
  s_nop 0
  buffer_load_dwordx4 v2, s[8:11], s22 offen sc1 lds
  v_mul_f32 v74, s52, v74
  v_mul_f32 v75, s52, v75
  v_cvt_pk_bf16_f32 v73, v74, v75
  v_mfma_f32_32x32x16_bf16 v[48:63], v[16:19], v[200:203], v[48:63]
  v_mul_f32 v76, s52, v76
  v_mul_f32 v77, s52, v77
  ds_read_b128 v[16:19], v8 offset:49408
  s_waitcnt lgkmcnt(3)
  v_mfma_f32_32x32x16_bf16 v[32:47], v[20:23], v[140:143], v[32:47]
  s_add_u32 s22, s49, 4096
  s_add_u32 m0, s25, 116736
  s_nop 0
  buffer_load_dwordx4 v2, s[8:11], s22 offen sc1 lds
  buffer_load_dwordx4 v[100:103], v113, s[8:11], s28 offen sc1
  v_cvt_pk_bf16_f32 v74, v76, v77
  v_mul_f32 v78, s52, v78
  v_mul_f32 v79, s52, v79
  v_mfma_f32_32x32x16_bf16 v[48:63], v[20:23], v[204:207], v[48:63]
  v_cvt_pk_bf16_f32 v75, v78, v79
  v_permlane16_swap_b32 v64, v72
  ds_read_b128 v[20:23], v9 offset:49408
  s_waitcnt lgkmcnt(3)
  v_mfma_f32_32x32x16_bf16 v[32:47], v[24:27], v[144:147], v[32:47]
  s_add_u32 s22, s49, 5120
  s_add_u32 m0, s25, 117760
  s_nop 0
  buffer_load_dwordx4 v2, s[8:11], s22 offen sc1 lds
  v_permlane16_swap_b32 v65, v73
  v_permlane16_swap_b32 v66, v74
  v_permlane16_swap_b32 v67, v75
  v_mfma_f32_32x32x16_bf16 v[48:63], v[24:27], v[208:211], v[48:63]
  v_accvgpr_write_b32 a44, v64
  v_accvgpr_write_b32 a45, v65
  ds_read_b128 v[24:27], v10 offset:49408
  s_waitcnt lgkmcnt(3)
  v_mfma_f32_32x32x16_bf16 v[32:47], v[28:31], v[148:151], v[32:47]
  s_add_u32 s22, s49, 6144
  s_add_u32 m0, s25, 131072
  s_nop 0
  buffer_load_dwordx4 v2, s[8:11], s22 offen sc1 lds
  v_accvgpr_write_b32 a46, v66
  v_accvgpr_write_b32 a47, v67
  v_accvgpr_write_b32 a100, v72
  v_mfma_f32_32x32x16_bf16 v[48:63], v[28:31], v[212:215], v[48:63]
  v_accvgpr_write_b32 a101, v73
  v_accvgpr_write_b32 a102, v74
  ds_read_b128 v[28:31], v11 offset:49408
  s_waitcnt lgkmcnt(3)
  v_mfma_f32_32x32x16_bf16 v[32:47], v[16:19], v[152:155], v[32:47]
  s_add_u32 s22, s49, 7168
  s_add_u32 m0, s25, 132096
  s_nop 0
  buffer_load_dwordx4 v2, s[8:11], s22 offen sc1 lds
  v_accvgpr_write_b32 a103, v75
  v_mul_f32 v80, s52, v80
  v_mul_f32 v81, s52, v81
  v_mfma_f32_32x32x16_bf16 v[48:63], v[16:19], v[216:219], v[48:63]
  v_cvt_pk_bf16_f32 v80, v80, v81
  v_mul_f32 v82, s52, v82
  ds_read_b128 v[16:19], v12 offset:49408
  s_waitcnt lgkmcnt(3)
  v_mfma_f32_32x32x16_bf16 v[32:47], v[20:23], v[156:159], v[32:47]
  s_add_u32 s22, s49, 8192
  s_add_u32 m0, s25, 133120
  s_nop 0
  buffer_load_dwordx4 v2, s[8:11], s22 offen sc1 lds
  v_mul_f32 v83, s52, v83
  v_cvt_pk_bf16_f32 v81, v82, v83
  v_mul_f32 v84, s52, v84
  v_mfma_f32_32x32x16_bf16 v[48:63], v[20:23], v[220:223], v[48:63]
  v_mul_f32 v85, s52, v85
  v_cvt_pk_bf16_f32 v82, v84, v85
  ds_read_b128 v[20:23], v13 offset:49408
  s_waitcnt lgkmcnt(3)
  v_mfma_f32_32x32x16_bf16 v[32:47], v[24:27], v[160:163], v[32:47]
  s_add_u32 s22, s49, 9216
  s_add_u32 m0, s25, 134144
  s_nop 0
  buffer_load_dwordx4 v2, s[8:11], s22 offen sc1 lds
  v_mul_f32 v86, s52, v86
  v_mul_f32 v87, s52, v87
  v_cvt_pk_bf16_f32 v83, v86, v87
  v_mfma_f32_32x32x16_bf16 v[48:63], v[24:27], v[224:227], v[48:63]
  v_mul_f32 v88, s52, v88
  v_mul_f32 v89, s52, v89
  ds_read_b128 v[24:27], v14 offset:49408
  s_waitcnt lgkmcnt(3)
  v_mfma_f32_32x32x16_bf16 v[32:47], v[28:31], v[164:167], v[32:47]
  s_add_u32 s22, s49, 10240
  s_add_u32 m0, s25, 147456
  s_nop 0
  buffer_load_dwordx4 v2, s[8:11], s22 offen sc1 lds
  v_cvt_pk_bf16_f32 v88, v88, v89
  v_mul_f32 v90, s52, v90
  v_mul_f32 v91, s52, v91
  v_mfma_f32_32x32x16_bf16 v[48:63], v[28:31], v[228:231], v[48:63]
  v_cvt_pk_bf16_f32 v89, v90, v91
  v_mul_f32 v92, s52, v92
  ds_read_b128 v[28:31], v15 offset:49408
  s_waitcnt lgkmcnt(3)
  v_mfma_f32_32x32x16_bf16 v[32:47], v[16:19], v[168:171], v[32:47]
  s_add_u32 s22, s49, 11264
  s_add_u32 m0, s25, 148480
  s_nop 0
  buffer_load_dwordx4 v2, s[8:11], s22 offen sc1 lds
  v_mul_f32 v93, s52, v93
  v_cvt_pk_bf16_f32 v90, v92, v93
  v_mul_f32 v94, s52, v94
  v_mfma_f32_32x32x16_bf16 v[48:63], v[16:19], v[232:235], v[48:63]
  v_mul_f32 v95, s52, v95
  v_cvt_pk_bf16_f32 v91, v94, v95
  v_xor_b32 v8, 65536, v8
  ds_read_b128 v[16:19], v8 offset:0
  s_waitcnt lgkmcnt(3)
  v_mfma_f32_32x32x16_bf16 v[32:47], v[20:23], v[172:175], v[32:47]
  s_add_u32 s22, s49, 12288
  s_add_u32 m0, s25, 149504
  s_nop 0
  buffer_load_dwordx4 v2, s[8:11], s22 offen sc1 lds
  v_permlane16_swap_b32 v80, v88
  v_permlane16_swap_b32 v81, v89
  v_permlane16_swap_b32 v82, v90
  v_mfma_f32_32x32x16_bf16 v[48:63], v[20:23], v[236:239], v[48:63]
  v_permlane16_swap_b32 v83, v91
  v_accvgpr_write_b32 a156, v80
  v_xor_b32 v9, 65536, v9
  ds_read_b128 v[20:23], v9 offset:0
  s_waitcnt lgkmcnt(3)
  v_mfma_f32_32x32x16_bf16 v[32:47], v[24:27], v[176:179], v[32:47]
  s_add_u32 s22, s49, 13312
  s_add_u32 m0, s25, 150528
  s_nop 0
  buffer_load_dwordx4 v2, s[8:11], s22 offen sc1 lds
  v_accvgpr_write_b32 a157, v81
  v_accvgpr_write_b32 a158, v82
  v_accvgpr_write_b32 a159, v83
  v_mfma_f32_32x32x16_bf16 v[48:63], v[24:27], v[240:243], v[48:63]
  v_accvgpr_write_b32 a212, v88
  v_accvgpr_write_b32 a213, v89
  v_xor_b32 v10, 65536, v10
  ds_read_b128 v[24:27], v10 offset:0
  s_waitcnt lgkmcnt(3)
  v_mfma_f32_32x32x16_bf16 v[32:47], v[28:31], v[180:183], v[32:47]
  v_accvgpr_write_b32 a214, v90
  v_accvgpr_write_b32 a215, v91
  v_mfma_f32_32x32x16_bf16 v[48:63], v[28:31], v[244:247], v[48:63]
  s_barrier
  v_xor_b32 v11, 65536, v11
  ds_read_b128 v[28:31], v11 offset:0
  s_waitcnt lgkmcnt(3)
  v_mfma_f32_32x32x16_bf16 v[64:79], v[16:19], v[120:123], 0
  s_waitcnt vmcnt(9)
  v_cmp_ne_u64 vcc, s[88:89], v[100:101]
  v_cmp_ne_u64 s[54:55], s[88:89], v[102:103]
  s_add_u32 s50, s33, 0
  v_mfma_f32_32x32x16_bf16 v[80:95], v[16:19], v[184:187], 0
  v_xor_b32 v12, 65536, v12
  ds_read_b128 v[16:19], v12 offset:0
  s_waitcnt lgkmcnt(3)
  v_mfma_f32_32x32x16_bf16 v[64:79], v[20:23], v[124:127], v[64:79]
  s_or_b64 vcc, vcc, s[54:55]
  s_cselect_b32 s50, 0x10000000, s50
  s_add_u32 s22, s50, 0
  buffer_load_dwordx4 a[224:227], v2, s[8:11], s22 offen sc1
  v_mul_f32 v32, s52, v32
  v_mul_f32 v33, s52, v33
  v_cvt_pk_bf16_f32 v32, v32, v33
  v_mfma_f32_32x32x16_bf16 v[80:95], v[20:23], v[188:191], v[80:95]
  v_mul_f32 v34, s52, v34
  v_mul_f32 v35, s52, v35
  v_xor_b32 v13, 65536, v13
  ds_read_b128 v[20:23], v13 offset:0
  s_waitcnt lgkmcnt(3)
  v_mfma_f32_32x32x16_bf16 v[64:79], v[24:27], v[128:131], v[64:79]
  s_add_u32 s22, s50, 1024
  buffer_load_dwordx4 a[228:231], v2, s[8:11], s22 offen sc1
  v_cvt_pk_bf16_f32 v33, v34, v35
  v_mul_f32 v36, s52, v36
  v_mul_f32 v37, s52, v37
  v_mfma_f32_32x32x16_bf16 v[80:95], v[24:27], v[192:195], v[80:95]
  v_cvt_pk_bf16_f32 v34, v36, v37
  v_mul_f32 v38, s52, v38
  v_xor_b32 v14, 65536, v14
  ds_read_b128 v[24:27], v14 offset:0
  s_waitcnt lgkmcnt(3)
  v_mfma_f32_32x32x16_bf16 v[64:79], v[28:31], v[132:135], v[64:79]
  s_add_u32 s22, s50, 2048
  buffer_load_dwordx4 a[232:235], v2, s[8:11], s22 offen sc1
  v_mul_f32 v39, s52, v39
  v_cvt_pk_bf16_f32 v35, v38, v39
  v_mul_f32 v40, s52, v40
  v_mfma_f32_32x32x16_bf16 v[80:95], v[28:31], v[196:199], v[80:95]
  v_mul_f32 v41, s52, v41
  v_cvt_pk_bf16_f32 v40, v40, v41
  v_xor_b32 v15, 65536, v15
  ds_read_b128 v[28:31], v15 offset:0
  s_waitcnt lgkmcnt(3)
  v_mfma_f32_32x32x16_bf16 v[64:79], v[16:19], v[136:139], v[64:79]
  s_add_u32 s22, s50, 3072
  buffer_load_dwordx4 a[236:239], v2, s[8:11], s22 offen sc1
  v_mul_f32 v42, s52, v42
  v_mul_f32 v43, s52, v43
  v_cvt_pk_bf16_f32 v41, v42, v43
  v_mfma_f32_32x32x16_bf16 v[80:95], v[16:19], v[200:203], v[80:95]
  v_mul_f32 v44, s52, v44
  v_mul_f32 v45, s52, v45
  ds_read_b128 v[16:19], v8 offset:256
  s_waitcnt lgkmcnt(3)
  v_mfma_f32_32x32x16_bf16 v[64:79], v[20:23], v[140:143], v[64:79]
  s_add_u32 s22, s50, 4096
  buffer_load_dwordx4 a[240:243], v2, s[8:11], s22 offen sc1
  v_cvt_pk_bf16_f32 v42, v44, v45
  v_mul_f32 v46, s52, v46
  v_mul_f32 v47, s52, v47
  v_mfma_f32_32x32x16_bf16 v[80:95], v[20:23], v[204:207], v[80:95]
  v_cvt_pk_bf16_f32 v43, v46, v47
  v_permlane16_swap_b32 v32, v40
  ds_read_b128 v[20:23], v9 offset:256
  s_waitcnt lgkmcnt(3)
  v_mfma_f32_32x32x16_bf16 v[64:79], v[24:27], v[144:147], v[64:79]
  s_add_u32 s22, s50, 5120
  buffer_load_dwordx4 a[244:247], v2, s[8:11], s22 offen sc1
  v_permlane16_swap_b32 v33, v41
  v_permlane16_swap_b32 v34, v42
  v_permlane16_swap_b32 v35, v43
  v_mfma_f32_32x32x16_bf16 v[80:95], v[24:27], v[208:211], v[80:95]
  v_accvgpr_write_b32 a48, v32
  v_accvgpr_write_b32 a49, v33
  ds_read_b128 v[24:27], v10 offset:256
  s_waitcnt lgkmcnt(3)
  v_mfma_f32_32x32x16_bf16 v[64:79], v[28:31], v[148:151], v[64:79]
  s_add_u32 s22, s50, 6144
  buffer_load_dwordx4 a[248:251], v2, s[8:11], s22 offen sc1
  v_accvgpr_write_b32 a50, v34
  v_accvgpr_write_b32 a51, v35
  v_accvgpr_write_b32 a104, v40
  v_mfma_f32_32x32x16_bf16 v[80:95], v[28:31], v[212:215], v[80:95]
  v_accvgpr_write_b32 a105, v41
  v_accvgpr_write_b32 a106, v42
  ds_read_b128 v[28:31], v11 offset:256
  s_waitcnt lgkmcnt(3)
  v_mfma_f32_32x32x16_bf16 v[64:79], v[16:19], v[152:155], v[64:79]
  s_add_u32 s22, s50, 7168
  buffer_load_dwordx4 a[252:255], v2, s[8:11], s22 offen sc1
  v_accvgpr_write_b32 a107, v43
  v_mul_f32 v48, s52, v48
  v_mul_f32 v49, s52, v49
  v_mfma_f32_32x32x16_bf16 v[80:95], v[16:19], v[216:219], v[80:95]
  v_cvt_pk_bf16_f32 v48, v48, v49
  v_mul_f32 v50, s52, v50
  ds_read_b128 v[16:19], v12 offset:256
  s_waitcnt lgkmcnt(3)
  v_mfma_f32_32x32x16_bf16 v[64:79], v[20:23], v[156:159], v[64:79]
  s_add_u32 s22, s50, 8192
  s_add_u32 m0, s25, 32768
  s_nop 0
  buffer_load_dwordx4 v2, s[8:11], s22 offen sc1 lds
  v_mul_f32 v51, s52, v51
  v_cvt_pk_bf16_f32 v49, v50, v51
  v_mul_f32 v52, s52, v52
  v_mfma_f32_32x32x16_bf16 v[80:95], v[20:23], v[220:223], v[80:95]
  v_mul_f32 v53, s52, v53
  v_cvt_pk_bf16_f32 v50, v52, v53
  ds_read_b128 v[20:23], v13 offset:256
  s_waitcnt lgkmcnt(3)
  v_mfma_f32_32x32x16_bf16 v[64:79], v[24:27], v[160:163], v[64:79]
  s_add_u32 s22, s50, 9216
  s_add_u32 m0, s25, 33792
  s_nop 0
  buffer_load_dwordx4 v2, s[8:11], s22 offen sc1 lds
  v_mul_f32 v54, s52, v54
  v_mul_f32 v55, s52, v55
  v_cvt_pk_bf16_f32 v51, v54, v55
  v_mfma_f32_32x32x16_bf16 v[80:95], v[24:27], v[224:227], v[80:95]
  v_mul_f32 v56, s52, v56
  v_mul_f32 v57, s52, v57
  ds_read_b128 v[24:27], v14 offset:256
  s_waitcnt lgkmcnt(3)
  v_mfma_f32_32x32x16_bf16 v[64:79], v[28:31], v[164:167], v[64:79]
  s_add_u32 s22, s50, 10240
  s_add_u32 m0, s25, 34816
  s_nop 0
  buffer_load_dwordx4 v2, s[8:11], s22 offen sc1 lds
  v_cvt_pk_bf16_f32 v56, v56, v57
  v_mul_f32 v58, s52, v58
  v_mul_f32 v59, s52, v59
  v_mfma_f32_32x32x16_bf16 v[80:95], v[28:31], v[228:231], v[80:95]
  v_cvt_pk_bf16_f32 v57, v58, v59
  v_mul_f32 v60, s52, v60
  ds_read_b128 v[28:31], v15 offset:256
  s_waitcnt lgkmcnt(3)
  v_mfma_f32_32x32x16_bf16 v[64:79], v[16:19], v[168:171], v[64:79]
  s_add_u32 s22, s50, 11264
  s_add_u32 m0, s25, 35840
  s_nop 0
  buffer_load_dwordx4 v2, s[8:11], s22 offen sc1 lds
  v_mul_f32 v61, s52, v61
  v_cvt_pk_bf16_f32 v58, v60, v61
  v_mul_f32 v62, s52, v62
  v_mfma_f32_32x32x16_bf16 v[80:95], v[16:19], v[232:235], v[80:95]
  v_mul_f32 v63, s52, v63
  v_cvt_pk_bf16_f32 v59, v62, v63
  s_waitcnt lgkmcnt(2)
  v_mfma_f32_32x32x16_bf16 v[64:79], v[20:23], v[172:175], v[64:79]
  s_add_u32 s22, s50, 12288
  s_add_u32 m0, s25, 49152
  s_nop 0
  buffer_load_dwordx4 v2, s[8:11], s22 offen sc1 lds
  v_permlane16_swap_b32 v48, v56
  v_permlane16_swap_b32 v49, v57
  v_permlane16_swap_b32 v50, v58
  v_mfma_f32_32x32x16_bf16 v[80:95], v[20:23], v[236:239], v[80:95]
  v_permlane16_swap_b32 v51, v59
  v_accvgpr_write_b32 a160, v48
  s_waitcnt lgkmcnt(1)
  v_mfma_f32_32x32x16_bf16 v[64:79], v[24:27], v[176:179], v[64:79]
  s_add_u32 s22, s50, 13312
  s_add_u32 m0, s25, 50176
  s_nop 0
  buffer_load_dwordx4 v2, s[8:11], s22 offen sc1 lds
  v_accvgpr_write_b32 a161, v49
  v_accvgpr_write_b32 a162, v50
  v_accvgpr_write_b32 a163, v51
  v_mfma_f32_32x32x16_bf16 v[80:95], v[24:27], v[240:243], v[80:95]
  v_accvgpr_write_b32 a216, v56
  v_accvgpr_write_b32 a217, v57
  s_waitcnt lgkmcnt(0)
  v_mfma_f32_32x32x16_bf16 v[64:79], v[28:31], v[180:183], v[64:79]
  buffer_load_dwordx4 v[100:103], v113, s[8:11], s28 offen sc1
  buffer_load_dwordx4 v[104:107], v2, s[8:11], s29 offen sc1
  buffer_load_dwordx4 v[108:111], v112, s[8:11], s29 offen sc1
  v_accvgpr_write_b32 a218, v58
  v_accvgpr_write_b32 a219, v59
  v_mfma_f32_32x32x16_bf16 v[80:95], v[28:31], v[244:247], v[80:95]
  s_nop 4
  v_mul_f32 v64, s52, v64
  v_mul_f32 v65, s52, v65
  v_cvt_pk_bf16_f32 v64, v64, v65
  v_mul_f32 v66, s52, v66
  v_mul_f32 v67, s52, v67
  v_cvt_pk_bf16_f32 v65, v66, v67
  v_mul_f32 v68, s52, v68
  v_mul_f32 v69, s52, v69
  v_cvt_pk_bf16_f32 v66, v68, v69
  v_mul_f32 v70, s52, v70
  v_mul_f32 v71, s52, v71
  v_cvt_pk_bf16_f32 v67, v70, v71
  v_mul_f32 v72, s52, v72
  v_mul_f32 v73, s52, v73
  v_cvt_pk_bf16_f32 v72, v72, v73
  v_mul_f32 v74, s52, v74
  v_mul_f32 v75, s52, v75
  v_cvt_pk_bf16_f32 v73, v74, v75
  v_mul_f32 v76, s52, v76
  v_mul_f32 v77, s52, v77
  v_cvt_pk_bf16_f32 v74, v76, v77
  v_mul_f32 v78, s52, v78
  v_mul_f32 v79, s52, v79
  v_cvt_pk_bf16_f32 v75, v78, v79
  v_permlane16_swap_b32 v64, v72
  v_permlane16_swap_b32 v65, v73
  v_permlane16_swap_b32 v66, v74
  v_permlane16_swap_b32 v67, v75
  v_accvgpr_write_b32 a52, v64
  v_accvgpr_write_b32 a53, v65
  v_accvgpr_write_b32 a54, v66
  v_accvgpr_write_b32 a55, v67
  v_accvgpr_write_b32 a108, v72
  v_accvgpr_write_b32 a109, v73
  v_accvgpr_write_b32 a110, v74
  v_accvgpr_write_b32 a111, v75
  v_mul_f32 v80, s52, v80
  v_mul_f32 v81, s52, v81
  v_cvt_pk_bf16_f32 v80, v80, v81
  v_mul_f32 v82, s52, v82
  v_mul_f32 v83, s52, v83
  v_cvt_pk_bf16_f32 v81, v82, v83
  v_mul_f32 v84, s52, v84
  v_mul_f32 v85, s52, v85
  v_cvt_pk_bf16_f32 v82, v84, v85
  v_mul_f32 v86, s52, v86
  v_mul_f32 v87, s52, v87
  v_cvt_pk_bf16_f32 v83, v86, v87
  v_mul_f32 v88, s52, v88
  v_mul_f32 v89, s52, v89
  v_cvt_pk_bf16_f32 v88, v88, v89
  v_mul_f32 v90, s52, v90
  v_mul_f32 v91, s52, v91
  v_cvt_pk_bf16_f32 v89, v90, v91
  v_mul_f32 v92, s52, v92
  v_mul_f32 v93, s52, v93
  v_cvt_pk_bf16_f32 v90, v92, v93
  v_mul_f32 v94, s52, v94
  v_mul_f32 v95, s52, v95
  v_cvt_pk_bf16_f32 v91, v94, v95
  v_permlane16_swap_b32 v80, v88
  v_permlane16_swap_b32 v81, v89
  v_permlane16_swap_b32 v82, v90
  v_permlane16_swap_b32 v83, v91
  v_accvgpr_write_b32 a164, v80
  v_accvgpr_write_b32 a165, v81
  v_accvgpr_write_b32 a166, v82
  v_accvgpr_write_b32 a167, v83
  v_accvgpr_write_b32 a220, v88
  v_accvgpr_write_b32 a221, v89
  v_accvgpr_write_b32 a222, v90
  v_accvgpr_write_b32 a223, v91
  s_mov_b32 s30, 0
  s_branch sc_aw_w
sc_aw:
  buffer_load_dwordx4 v[100:103], v113, s[8:11], s28 offen sc1
  buffer_load_dwordx4 v[104:107], v2, s[8:11], s29 offen sc1
  buffer_load_dwordx4 v[108:111], v112, s[8:11], s29 offen sc1
sc_aw_w:
  s_waitcnt vmcnt(0)
  v_cmp_ne_u64 vcc, s[88:89], v[100:101]
  s_cbranch_vccnz sc_aw_no
  v_cmp_ne_u64 vcc, s[88:89], v[102:103]
  s_cbranch_vccnz sc_aw_no
  v_cmp_ne_u64 vcc, s[88:89], v[104:105]
  s_cbranch_vccnz sc_aw_no
  v_cmp_ne_u64 vcc, s[88:89], v[106:107]
  s_cbranch_vccnz sc_aw_no
  v_cmp_ne_u64 vcc, s[88:89], v[108:109]
  s_cbranch_vccnz sc_aw_no
  v_cmp_ne_u64 vcc, s[88:89], v[110:111]
  s_cbranch_vccnz sc_aw_no
  s_branch sc_aw_ok
sc_aw_no:
  s_sleep 1
  s_add_u32 s30, s30, 1
  s_cmp_lt_u32 s30, 50000
  s_cbranch_scc1 sc_aw
  s_branch cA_abort
sc_aw_ok:
  v_add_u32 v4, s25, v2
  v_add_u32 v5, 0x10000, v4
  v_add_u32 v6, 0x20000, v4
  s_cmp_eq_u32 s48, 0x10000000
  s_cbranch_scc1 sc_d0
  ds_read_b128 v[144:147], v4 offset:0
  ds_read_b128 v[148:151], v4 offset:1024
  ds_read_b128 v[152:155], v4 offset:2048
  ds_read_b128 v[156:159], v4 offset:3072
  ds_read_b128 v[160:163], v4 offset:16384
  ds_read_b128 v[164:167], v4 offset:17408
  ds_read_b128 v[168:171], v4 offset:18432
  ds_read_b128 v[172:175], v4 offset:19456
  ds_read_b128 v[176:179], v5 offset:16384
  ds_read_b128 v[180:183], v5 offset:17408
  ds_read_b128 v[184:187], v5 offset:18432
  ds_read_b128 v[188:191], v5 offset:19456
  ds_read_b128 v[192:195], v5 offset:32768
  ds_read_b128 v[196:199], v5 offset:33792
  s_waitcnt lgkmcnt(0)
  s_branch sc_e0
sc_d0:
  s_add_u32 s22, s33, 12288
  buffer_load_dwordx4 v[144:147], v2, s[8:11], s22 offen offset:2048 sc1
  buffer_load_dwordx4 v[148:151], v2, s[8:11], s22 offen offset:3072 sc1
  s_add_u32 s22, s33, 16384
  buffer_load_dwordx4 v[152:155], v2, s[8:11], s22 offen offset:0 sc1
  buffer_load_dwordx4 v[156:159], v2, s[8:11], s22 offen offset:1024 sc1
  buffer_load_dwordx4 v[160:163], v2, s[8:11], s22 offen offset:2048 sc1
  buffer_load_dwordx4 v[164:167], v2, s[8:11], s22 offen offset:3072 sc1
  s_add_u32 s22, s33, 20480
  buffer_load_dwordx4 v[168:171], v2, s[8:11], s22 offen offset:0 sc1
  buffer_load_dwordx4 v[172:175], v2, s[8:11], s22 offen offset:1024 sc1
  buffer_load_dwordx4 v[176:179], v2, s[8:11], s22 offen offset:2048 sc1
  buffer_load_dwordx4 v[180:183], v2, s[8:11], s22 offen offset:3072 sc1
  s_add_u32 s22, s33, 24576
  buffer_load_dwordx4 v[184:187], v2, s[8:11], s22 offen offset:0 sc1
  buffer_load_dwordx4 v[188:191], v2, s[8:11], s22 offen offset:1024 sc1
  buffer_load_dwordx4 v[192:195], v2, s[8:11], s22 offen offset:2048 sc1
  buffer_load_dwordx4 v[196:199], v2, s[8:11], s22 offen offset:3072 sc1
sc_e0:
  s_cmp_eq_u32 s49, 0x10000000
  s_cbranch_scc1 sc_d1
  ds_read_b128 v[200:203], v5 offset:34816
  ds_read_b128 v[204:207], v5 offset:35840
  ds_read_b128 v[208:211], v5 offset:49152
  ds_read_b128 v[212:215], v5 offset:50176
  ds_read_b128 v[216:219], v5 offset:51200
  ds_read_b128 v[220:223], v5 offset:52224
  ds_read_b128 v[224:227], v6 offset:0
  ds_read_b128 v[228:231], v6 offset:1024
  ds_read_b128 v[232:235], v6 offset:2048
  ds_read_b128 v[236:239], v6 offset:3072
  ds_read_b128 v[240:243], v6 offset:16384
  ds_read_b128 v[244:247], v6 offset:17408
  ds_read_b128 v[248:251], v6 offset:18432
  ds_read_b128 v[252:255], v6 offset:19456
  s_waitcnt lgkmcnt(0)
  s_branch sc_e1
sc_d1:
  s_add_u32 s22, s32, 0
  buffer_load_dwordx4 v[200:203], v2, s[8:11], s22 offen offset:0 sc1
  buffer_load_dwordx4 v[204:207], v2, s[8:11], s22 offen offset:1024 sc1
  buffer_load_dwordx4 v[208:211], v2, s[8:11], s22 offen offset:2048 sc1
  buffer_load_dwordx4 v[212:215], v2, s[8:11], s22 offen offset:3072 sc1
  s_add_u32 s22, s32, 4096
  buffer_load_dwordx4 v[216:219], v2, s[8:11], s22 offen offset:0 sc1
  buffer_load_dwordx4 v[220:223], v2, s[8:11], s22 offen offset:1024 sc1
  buffer_load_dwordx4 v[224:227], v2, s[8:11], s22 offen offset:2048 sc1
  buffer_load_dwordx4 v[228:231], v2, s[8:11], s22 offen offset:3072 sc1
  s_add_u32 s22, s32, 8192
  buffer_load_dwordx4 v[232:235], v2, s[8:11], s22 offen offset:0 sc1
  buffer_load_dwordx4 v[236:239], v2, s[8:11], s22 offen offset:1024 sc1
  buffer_load_dwordx4 v[240:243], v2, s[8:11], s22 offen offset:2048 sc1
  buffer_load_dwordx4 v[244:247], v2, s[8:11], s22 offen offset:3072 sc1
  s_add_u32 s22, s32, 12288
  buffer_load_dwordx4 v[248:251], v2, s[8:11], s22 offen offset:0 sc1
  buffer_load_dwordx4 v[252:255], v2, s[8:11], s22 offen offset:1024 sc1
sc_e1:
  s_cmp_eq_u32 s50, 0x10000000
  s_cbranch_scc1 sc_d2
  ds_read_b128 v[120:123], v4 offset:32768
  ds_read_b128 v[124:127], v4 offset:33792
  ds_read_b128 v[128:131], v4 offset:34816
  ds_read_b128 v[132:135], v4 offset:35840
  ds_read_b128 v[136:139], v4 offset:49152
  ds_read_b128 v[140:143], v4 offset:50176
  s_waitcnt lgkmcnt(0)
  s_branch sc_e2
sc_d2:
  s_add_u32 s22, s33, 0
  buffer_load_dwordx4 a[224:227], v2, s[8:11], s22 offen offset:0 sc1
  buffer_load_dwordx4 a[228:231], v2, s[8:11], s22 offen offset:1024 sc1
  buffer_load_dwordx4 a[232:235], v2, s[8:11], s22 offen offset:2048 sc1
  buffer_load_dwordx4 a[236:239], v2, s[8:11], s22 offen offset:3072 sc1
  s_add_u32 s22, s33, 4096
  buffer_load_dwordx4 a[240:243], v2, s[8:11], s22 offen offset:0 sc1
  buffer_load_dwordx4 a[244:247], v2, s[8:11], s22 offen offset:1024 sc1
  buffer_load_dwordx4 a[248:251], v2, s[8:11], s22 offen offset:2048 sc1
  buffer_load_dwordx4 a[252:255], v2, s[8:11], s22 offen offset:3072 sc1
  s_add_u32 s22, s33, 8192
  buffer_load_dwordx4 v[120:123], v2, s[8:11], s22 offen offset:0 sc1
  buffer_load_dwordx4 v[124:127], v2, s[8:11], s22 offen offset:1024 sc1
  buffer_load_dwordx4 v[128:131], v2, s[8:11], s22 offen offset:2048 sc1
  buffer_load_dwordx4 v[132:135], v2, s[8:11], s22 offen offset:3072 sc1
  s_add_u32 s22, s33, 12288
  buffer_load_dwordx4 v[136:139], v2, s[8:11], s22 offen offset:0 sc1
  buffer_load_dwordx4 v[140:143], v2, s[8:11], s22 offen offset:1024 sc1
sc_e2:
  s_barrier
  s_branch m_role
m_val:
  s_cmp_lg_u32 s16, 0
  s_cbranch_scc1 w0_6
  v_mov_b32 v233, 128
  v_mov_b32 v234, s88
  v_mov_b32 v235, s89
  v_mov_b32 v236, 0
  v_mov_b32 v237, 0
  s_mov_b64 exec, 1
  buffer_atomic_cmpswap_x2 v[234:237], v233, s[12:15], 0 offen sc0
  s_mov_b64 exec, -1
w0_6:
  s_cmp_lg_u32 s66, 0
  s_cbranch_scc1 va_ci
  s_cmp_lg_u32 s16, 0
  s_cbranch_scc1 w0_7
  s_lshr_b32 s70, s3, 5
  s_and_b32 s71, s70, 4
  s_mul_i32 s71, s71, 12
  s_lshl_b32 s70, s70, 2
  s_add_u32 s70, s70, s71
  s_lshl_b32 s71, 1, s3
  v_mov_b32 v242, s71
  v_mov_b32 v243, 32
  s_mov_b64 exec, 1
  buffer_atomic_or v242, v243, s[12:15], s70 offen sc0
  buffer_load_dwordx2 v[244:245], v243, s[12:15], 0 offen offset:96 sc1
  s_mov_b64 exec, -1
w0_7:
va_ci:
  s_mov_b32 s56, s40
  s_and_b32 s57, s41, 0xffff
  s_mov_b32 s58, 3670016
  s_mov_b32 s59, 0x20000
  v_lshrrev_b32 v24, 5, v1
  v_and_b32 v25, 31, v1
  v_lshlrev_b32 v25, 4, v25
  v_lshl_add_u32 v24, v24, 13, v25
  s_mov_b32 s60, s42
  s_and_b32 s61, s43, 0xffff
  s_mov_b32 s62, 3670016
  s_mov_b32 s63, 0x20000
  s_lshl_b32 s22, s17, 9
  s_lshl_b32 s23, s16, 19
  s_add_u32 s23, s22, s23
  s_add_u32 s21, s23, 262144
  buffer_load_dwordx4 v[28:31], v24, s[60:63], s21 offen
  s_add_u32 s21, s23, 278528
  buffer_load_dwordx4 v[28:31], v24, s[60:63], s21 offen
  s_add_u32 s21, s23, 294912
  buffer_load_dwordx4 v[28:31], v24, s[60:63], s21 offen
  s_add_u32 s21, s23, 311296
  buffer_load_dwordx4 v[28:31], v24, s[60:63], s21 offen
  s_add_u32 s21, s23, 327680
  buffer_load_dwordx4 v[28:31], v24, s[60:63], s21 offen
  s_add_u32 s21, s23, 344064
  buffer_load_dwordx4 v[28:31], v24, s[60:63], s21 offen
  s_add_u32 s21, s23, 360448
  buffer_load_dwordx4 v[28:31], v24, s[60:63], s21 offen
  s_add_u32 s21, s23, 376832
  buffer_load_dwordx4 v[28:31], v24, s[60:63], s21 offen
  s_add_u32 s21, s23, 393216
  buffer_load_dwordx4 v[28:31], v24, s[60:63], s21 offen
  s_add_u32 s21, s23, 409600
  buffer_load_dwordx4 v[28:31], v24, s[60:63], s21 offen
  s_add_u32 s21, s23, 425984
  buffer_load_dwordx4 v[28:31], v24, s[60:63], s21 offen
  s_add_u32 s21, s23, 442368
  buffer_load_dwordx4 v[28:31], v24, s[60:63], s21 offen
  s_add_u32 s21, s23, 458752
  buffer_load_dwordx4 v[28:31], v24, s[60:63], s21 offen
  s_add_u32 s21, s23, 475136
  buffer_load_dwordx4 v[28:31], v24, s[60:63], s21 offen
  s_add_u32 s21, s23, 491520
  buffer_load_dwordx4 v[28:31], v24, s[60:63], s21 offen
  s_add_u32 s21, s23, 507904
  buffer_load_dwordx4 v[28:31], v24, s[60:63], s21 offen
  s_lshl_b32 s23, s16, 14
  s_add_u32 s22, s22, s23
  s_mov_b32 s30, 0
va_pf:
  buffer_load_dwordx4 v[28:31], v24, s[56:59], s22 offen
  s_waitcnt vmcnt(40)
  s_add_u32 s22, s22, 65536
  s_add_u32 s30, s30, 1
  s_cmp_lt_u32 s30, 56
  s_cbranch_scc1 va_pf
  s_cmp_lg_u32 s66, 0
  s_cbranch_scc1 va_cf
  s_cmp_lg_u32 s16, 0
  s_cbranch_scc1 w0_8
  s_waitcnt vmcnt(40)
  v_readfirstlane_b32 s70, v244
  s_cmp_lg_u32 s70, 0
  s_cbranch_scc1 va_nz
  v_mov_b32 v243, 128
  v_mov_b32 v244, s88
  v_mov_b32 v245, s89
  v_mov_b32 v246, 0
  v_mov_b32 v247, 0
  s_mov_b64 exec, 1
  buffer_atomic_cmpswap_x2 v[244:247], v243, s[12:15], 0 offen sc0
  s_mov_b64 exec, -1
  s_waitcnt vmcnt(0)
  v_readfirstlane_b32 s70, v244
  s_cmp_lg_u32 s70, 0
  s_cbranch_scc1 va_nz
  v_mov_b32 v244, s88
  v_mov_b32 v245, s89
va_nz:
w0_8:
  v_mov_b32 v243, 160000
  s_add_u32 s101, s101, 1
  s_barrier
  s_mov_b64 exec, 1
  s_cmp_lg_u32 s16, 0
  s_cbranch_scc1 w0_9
  ds_write_b32 v243, v242 offset:0
  ds_write_b32 v243, v244 offset:4
  ds_write_b32 v243, v245 offset:8
  s_waitcnt lgkmcnt(0)
  v_mov_b32 v242, s101
  ds_write_b32 v243, v242 offset:16
  s_waitcnt lgkmcnt(0)
w0_9:
  s_mov_b64 exec, -1
  s_barrier
  ds_read_b32 v242, v243 offset:0
  ds_read_b32 v244, v243 offset:4
  ds_read_b32 v245, v243 offset:8
  ds_read_b32 v243, v243 offset:16
  s_waitcnt lgkmcnt(0)
  v_readfirstlane_b32 s70, v242
  v_readfirstlane_b32 s88, v244
  v_readfirstlane_b32 s89, v245
  v_cmp_ne_u32 vcc, s101, v243
  s_cbranch_vccnz ch_end
  s_mov_b32 s66, 1
  s_bitcmp1_b32 s70, s3
  s_cbranch_scc1 m_reclaim
va_cf:
  s_cmp_lg_u32 s16, 0
  s_cbranch_scc1 w0_10
  s_cmp_eq_u32 s67, 0
  s_cselect_b32 s20, 1, 0x10001
  v_mov_b32 v242, s20
  v_mov_b32 v243, 0
  s_mov_b64 exec, 1
  buffer_atomic_add v242, v243, s[12:15], 0 offen
  s_mov_b64 exec, -1
w0_10:
m_role:
  s_mov_b32 s17, s3
  v_and_b32 v1, 63, v0
  v_lshlrev_b32 v2, 4, v1
  v_lshrrev_b32 v116, 4, v1
  v_and_b32 v117, 15, v1
  v_mov_b32 v3, 0x4444
  v_mov_b32 v118, 0xeeee
  v_cmp_lt_u32 vcc, 7, v117
  s_nop 1
  v_cndmask_b32 v3, v3, v118, vcc
  s_mov_b32 s19, 0
  s_mov_b32 s20, 88653824
  s_lshr_b32 s22, s17, 4
  s_lshl_b32 s22, s22, 2
  s_add_u32 s22, s22, s16
  s_and_b32 s17, s17, 15
  s_cmp_eq_u32 s22, 0
  s_cbranch_scc1 ch_init0
  s_cmp_eq_u32 s22, 1
  s_cbranch_scc1 ch_init1
  s_cmp_eq_u32 s22, 2
  s_cbranch_scc1 ch_init2
  s_cmp_eq_u32 s22, 3
  s_cbranch_scc1 ch_init3
  s_cmp_eq_u32 s22, 4
  s_cbranch_scc1 ch_init4
  s_cmp_eq_u32 s22, 5
  s_cbranch_scc1 ch_init5
  s_cmp_eq_u32 s22, 6
  s_cbranch_scc1 ch_init6
  s_cmp_eq_u32 s22, 7
  s_cbranch_scc1 ch_init7
  s_branch ch_end
ch_init0:
  s_mul_i32 s31, s17, 401408
  s_add_u32 s31, s31, 0
  s_mov_b32 s24, 71565312
  s_mov_b32 s25, 0
  s_add_u32 m0, s25, 0
  s_nop 0
  buffer_load_dwordx4 v2, s[8:11], s24 offen offset:0 sc1 lds
  buffer_load_dwordx4 v2, s[8:11], s24 offen offset:1024 sc1 lds
  buffer_load_dwordx4 v2, s[8:11], s24 offen offset:2048 sc1 lds
  buffer_load_dwordx4 v2, s[8:11], s24 offen offset:3072 sc1 lds
  s_add_u32 m0, s25, 4096
  s_add_u32 s22, s24, 4096
  buffer_load_dwordx4 v2, s[8:11], s22 offen offset:0 sc1 lds
  buffer_load_dwordx4 v2, s[8:11], s22 offen offset:1024 sc1 lds
  buffer_load_dwordx4 v2, s[8:11], s22 offen offset:2048 sc1 lds
  v_lshrrev_b32 v64, 1, v117
  v_and_b32 v65, 1, v116
  v_lshlrev_b32 v65, 2, v65
  v_sub_u32 v64, v64, v65
  v_and_b32 v65, 1, v117
  v_lshl_add_u32 v66, v65, 2, v64
  v_cmp_gt_u32 vcc, 4, v64
  v_mov_b32 v67, 99
  s_nop 0
  v_cndmask_b32 v66, v67, v66, vcc
  v_mov_b32 v68, 0x3f80
  v_mov_b32 v69, 0x3f800000
  v_mov_b32 v4, 0
  v_cmp_eq_u32 vcc, 0, v66
  s_nop 1
  v_cndmask_b32 v4, v4, v68, vcc
  v_cmp_eq_u32 vcc, 1, v66
  s_nop 1
  v_cndmask_b32 v4, v4, v69, vcc
  v_mov_b32 v5, 0
  v_cmp_eq_u32 vcc, 2, v66
  s_nop 1
  v_cndmask_b32 v5, v5, v68, vcc
  v_cmp_eq_u32 vcc, 3, v66
  s_nop 1
  v_cndmask_b32 v5, v5, v69, vcc
  v_mov_b32 v6, 0
  v_cmp_eq_u32 vcc, 4, v66
  s_nop 1
  v_cndmask_b32 v6, v6, v68, vcc
  v_cmp_eq_u32 vcc, 5, v66
  s_nop 1
  v_cndmask_b32 v6, v6, v69, vcc
  v_mov_b32 v7, 0
  v_cmp_eq_u32 vcc, 6, v66
  s_nop 1
  v_cndmask_b32 v7, v7, v68, vcc
  v_cmp_eq_u32 vcc, 7, v66
  s_nop 1
  v_cndmask_b32 v7, v7, v69, vcc
  v_lshrrev_b32 v64, 1, v116
  v_lshrrev_b32 v65, 3, v117
  v_cmp_eq_u32 s[26:27], v64, v65
  v_and_b32 v66, 1, v116
  v_add_u32 v64, 0, v64
  v_lshrrev_b32 v67, 1, v116
  v_lshlrev_b32 v67, 8, v67
  v_lshl_add_u32 v67, v66, 9, v67
  v_lshl_add_u32 v67, v117, 4, v67
  v_add_u32 v112, 57344, v67
  v_and_b32 v68, 7, v117
  v_lshlrev_b32 v67, 8, v64
  v_lshl_add_u32 v67, v68, 5, v67
  v_lshl_add_u32 v67, v66, 4, v67
  v_add_u32 v113, 65536, v67
  v_lshrrev_b32 v64, 5, v1
  v_and_b32 v65, 31, v1
  v_lshrrev_b32 v66, 3, v65
  v_and_b32 v67, 7, v65
  v_and_b32 v68, 3, v67
  v_lshl_add_u32 v68, v66, 2, v68
  v_lshrrev_b32 v69, 2, v67
  v_lshl_add_u32 v68, v69, 4, v68
  v_lshlrev_b32 v69, 11, v64
  v_lshl_add_u32 v69, v68, 4, v69
  v_add_u32 v114, 57344, v69
  v_add_u32 v70, 0, v64
  v_lshlrev_b32 v69, 9, v66
  v_lshl_add_u32 v69, v70, 5, v69
  v_lshl_add_u32 v69, v67, 2, v69
  v_add_u32 v115, 65536, v69
  v_lshlrev_b32 v69, 4, v68
  v_lshl_add_u32 v69, v64, 9, v69
  v_add_u32 v114, 57344, v69
  v_mul_u32_u24 v69, 144, v70
  v_lshl_add_u32 v69, v67, 4, v69
  v_add_u32 v115, 65536, v69
  v_and_b32 v71, 1, v116
  v_mul_u32_u24 v69, 2048, v71
  v_lshl_add_u32 v69, v64, 8, v69
  v_lshl_add_u32 v69, v117, 4, v69
  v_add_u32 v112, 57344, v69
  v_mul_u32_u24 v69, 144, v117
  v_lshl_add_u32 v69, v71, 6, v69
  v_lshl_add_u32 v69, v64, 5, v69
  v_add_u32 v113, 65536, v69
  v_mul_u32_u24 v69, 1024, v116
  v_lshl_add_u32 v69, v117, 4, v69
  v_and_b32 v72, 8, v117
  v_xor_b32 v72, 0, v72
  v_add_u32 v69, v69, v72
  v_add_u32 v112, 57344, v69
  v_lshrrev_b32 v72, 3, v117
  v_lshl_add_u32 v72, v71, 1, v72
  v_xor_b32 v72, 0, v72
  v_lshlrev_b32 v69, 10, v116
  v_lshl_add_u32 v69, v117, 4, v69
  v_lshl_add_u32 v69, v72, 2, v69
  v_add_u32 v112, 57344, v69
  v_lshrrev_b32 v69, 1, v117
  v_and_b32 v72, 1, v117
  v_lshl_add_u32 v69, v72, 3, v69
  v_mul_u32_u24 v69, 144, v69
  v_lshl_add_u32 v69, v71, 6, v69
  v_lshl_add_u32 v69, v64, 5, v69
  v_lshl_add_u32 v72, v72, 1, v71
  v_xor_b32 v72, 0, v72
  v_lshl_add_u32 v69, v72, 2, v69
  v_add_u32 v113, 65536, v69
  v_and_b32 v71, 1, v1
  v_cmp_eq_u32 s[38:39], 0, v71
  v_cmp_gt_u32 vcc, 8, v65
  s_or_b64 s[28:29], s[38:39], vcc
  v_lshrrev_b32 v72, 1, v67
  v_lshlrev_b32 v72, 2, v72
  v_lshl_add_u32 v72, v70, 4, v72
  s_lshl_b32 s22, s17, 9
  s_add_u32 s22, s22, 9216
  v_lshl_add_u32 v73, v66, 7, v72
  v_add_u32 v73, s22, v73
  s_lshl_b32 s22, s17, 7
  s_add_u32 s22, s22, 7168
  v_add_u32 v74, s22, v72
  v_bfe_u32 v72, v65, 1, 1
  v_lshlrev_b32 v72, 7, v72
  v_lshl_add_u32 v72, v70, 4, v72
  v_bfe_u32 v73, v65, 2, 2
  v_lshl_add_u32 v72, v73, 2, v72
  v_lshrrev_b32 v73, 4, v65
  v_lshl_add_u32 v73, v73, 8, v72
  s_lshl_b32 s22, s17, 9
  s_add_u32 s22, s22, 9216
  v_add_u32 v73, s22, v73
  s_lshr_b32 s22, s17, 1
  s_lshl_b32 s22, s22, 8
  s_and_b32 s34, s17, 1
  s_lshl_b32 s34, s34, 3
  s_add_u32 s22, s22, s34
  s_add_u32 s22, s22, 7168
  v_add_u32 v74, s22, v72
  v_bfe_u32 v72, v65, 1, 1
  v_lshl_add_u32 v72, v64, 1, v72
  v_lshlrev_b32 v72, 4, v72
  v_bfe_u32 v73, v65, 2, 2
  v_lshl_add_u32 v72, v73, 2, v72
  v_lshrrev_b32 v73, 4, v65
  v_lshl_add_u32 v73, v73, 6, v72
  s_lshl_b32 s22, s17, 9
  s_add_u32 s22, s22, 9216
  v_add_u32 v73, s22, v73
  v_lshrrev_b32 v72, 1, v65
  v_lshlrev_b32 v72, 2, v72
  v_lshl_add_u32 v72, v64, 5, v72
  s_lshr_b32 s22, s17, 1
  s_lshl_b32 s22, s22, 8
  s_and_b32 s34, s17, 1
  s_lshl_b32 s34, s34, 4
  s_add_u32 s22, s22, s34
  s_add_u32 s22, s22, 7168
  v_add_u32 v74, s22, v72
  v_lshlrev_b32 v0, 2, v65
  v_and_b32 v0, 120, v0
  s_and_b32 s22, s17, 15
  s_lshl_b32 s22, s22, 7
  s_add_u32 s22, s22, 18432
  v_add_u32 v0, s22, v0
  v_cndmask_b32 v1, v74, v73, s[38:39]
  s_lshl_b32 s36, s17, 2
  s_add_u32 s36, s36, 17472
  s_mov_b32 s37, 0x3e800000
  v_mov_b32 v64, 0
  v_mov_b32 v65, 0
  v_mov_b32 v66, 0
  v_mov_b32 v67, 0
  v_mov_b32 v68, 0
  v_mov_b32 v69, 0
  v_mov_b32 v70, 0
  v_mov_b32 v71, 0
  v_mov_b32 v72, 0
  v_mov_b32 v73, 0
  v_mov_b32 v74, 0
  v_mov_b32 v75, 0
  v_mov_b32 v76, 0
  v_mov_b32 v77, 0
  v_mov_b32 v78, 0
  v_mov_b32 v79, 0
  v_mov_b32 v80, 0
  v_mov_b32 v81, 0
  v_mov_b32 v82, 0
  v_mov_b32 v83, 0
  v_mov_b32 v84, 0
  v_mov_b32 v85, 0
  v_mov_b32 v86, 0
  v_mov_b32 v87, 0
  v_mov_b32 v88, 0
  v_mov_b32 v89, 0
  v_mov_b32 v90, 0
  v_mov_b32 v91, 0
  v_mov_b32 v92, 0
  v_mov_b32 v93, 0
  v_mov_b32 v94, 0
  v_mov_b32 v95, 0
  v_mov_b32 v96, 0
  v_mov_b32 v97, 0
  v_mov_b32 v98, 0
  v_mov_b32 v99, 0
  v_mov_b32 v100, 0
  v_mov_b32 v101, 0
  v_mov_b32 v102, 0
  v_mov_b32 v103, 0
  v_mov_b32 v104, 0
  v_mov_b32 v105, 0
  v_mov_b32 v106, 0
  v_mov_b32 v107, 0
  v_mov_b32 v108, 0
  v_mov_b32 v109, 0
  v_mov_b32 v110, 0
  v_mov_b32 v111, 0
  v_and_b32 v118, 1, v116
  v_cmp_eq_u32 vcc, 0, v118
  v_mov_b32 v118, 12288
  v_mov_b32 v119, 8192
  v_cndmask_b32 v118, v118, v119, vcc
  v_lshrrev_b32 v116, 1, v116
  v_lshl_add_u32 v118, v116, 9, v118
  v_lshl_add_u32 v117, v117, 4, v118
  s_mov_b32 s57, 28672
  v_bfe_u32 v118, v2, 4, 1
  v_mul_u32_u24 v118, 0xaaaa, v118
  v_add_u32 v118, 0x4444, v118
  s_mov_b32 s56, 0x42800000
  v_mov_b32 v116, v2
  s_mul_i32 s35, s17, 1835008
  s_add_u32 s35, s35, 42262528
  s_mov_b32 s30, 0
  v_mov_b32 v36, 0
ch_md0:
  buffer_load_dword v37, v36, s[12:15], 0 offen sc1
  s_waitcnt vmcnt(0)
  v_readfirstlane_b32 s22, v37
  s_and_b32 s31, s22, 0xffff
  s_cmp_ge_u32 s31, 32
  s_cbranch_scc1 ch_go0
  s_sleep 2
  s_add_u32 s30, s30, 1
  s_cmp_lt_u32 s30, 50000
  s_cbranch_scc1 ch_md0
  s_branch ch_end
ch_go0:
  s_mov_b32 s31, 0
  s_lshr_b32 s22, s22, 16
  s_cmp_lg_u32 s22, 0
  s_cbranch_scc1 cB_sc0_loop
  s_branch cA_sc0_loop
ch_init1:
  s_mul_i32 s31, s17, 401408
  s_add_u32 s31, s31, 0
  s_mov_b32 s24, 71572480
  s_mov_b32 s25, 0
  s_add_u32 m0, s25, 7168
  s_nop 0
  buffer_load_dwordx4 v2, s[8:11], s24 offen offset:0 sc1 lds
  buffer_load_dwordx4 v2, s[8:11], s24 offen offset:1024 sc1 lds
  buffer_load_dwordx4 v2, s[8:11], s24 offen offset:2048 sc1 lds
  buffer_load_dwordx4 v2, s[8:11], s24 offen offset:3072 sc1 lds
  s_add_u32 m0, s25, 11264
  s_add_u32 s22, s24, 4096
  buffer_load_dwordx4 v2, s[8:11], s22 offen offset:0 sc1 lds
  buffer_load_dwordx4 v2, s[8:11], s22 offen offset:1024 sc1 lds
  buffer_load_dwordx4 v2, s[8:11], s22 offen offset:2048 sc1 lds
  v_lshrrev_b32 v64, 1, v117
  v_and_b32 v65, 1, v116
  v_lshlrev_b32 v65, 2, v65
  v_sub_u32 v64, v64, v65
  v_and_b32 v65, 1, v117
  v_lshl_add_u32 v66, v65, 2, v64
  v_cmp_gt_u32 vcc, 4, v64
  v_mov_b32 v67, 99
  s_nop 0
  v_cndmask_b32 v66, v67, v66, vcc
  v_mov_b32 v68, 0x3f80
  v_mov_b32 v69, 0x3f800000
  v_mov_b32 v4, 0
  v_cmp_eq_u32 vcc, 0, v66
  s_nop 1
  v_cndmask_b32 v4, v4, v68, vcc
  v_cmp_eq_u32 vcc, 1, v66
  s_nop 1
  v_cndmask_b32 v4, v4, v69, vcc
  v_mov_b32 v5, 0
  v_cmp_eq_u32 vcc, 2, v66
  s_nop 1
  v_cndmask_b32 v5, v5, v68, vcc
  v_cmp_eq_u32 vcc, 3, v66
  s_nop 1
  v_cndmask_b32 v5, v5, v69, vcc
  v_mov_b32 v6, 0
  v_cmp_eq_u32 vcc, 4, v66
  s_nop 1
  v_cndmask_b32 v6, v6, v68, vcc
  v_cmp_eq_u32 vcc, 5, v66
  s_nop 1
  v_cndmask_b32 v6, v6, v69, vcc
  v_mov_b32 v7, 0
  v_cmp_eq_u32 vcc, 6, v66
  s_nop 1
  v_cndmask_b32 v7, v7, v68, vcc
  v_cmp_eq_u32 vcc, 7, v66
  s_nop 1
  v_cndmask_b32 v7, v7, v69, vcc
  v_lshrrev_b32 v64, 1, v116
  v_lshrrev_b32 v65, 3, v117
  v_cmp_eq_u32 s[26:27], v64, v65
  v_and_b32 v66, 1, v116
  v_add_u32 v64, 2, v64
  v_lshrrev_b32 v67, 1, v116
  v_lshlrev_b32 v67, 8, v67
  v_lshl_add_u32 v67, v66, 9, v67
  v_lshl_add_u32 v67, v117, 4, v67
  v_add_u32 v112, 58368, v67
  v_and_b32 v68, 7, v117
  v_lshlrev_b32 v67, 8, v64
  v_lshl_add_u32 v67, v68, 5, v67
  v_lshl_add_u32 v67, v66, 4, v67
  v_add_u32 v113, 65536, v67
  v_lshrrev_b32 v64, 5, v1
  v_and_b32 v65, 31, v1
  v_lshrrev_b32 v66, 3, v65
  v_and_b32 v67, 7, v65
  v_and_b32 v68, 3, v67
  v_lshl_add_u32 v68, v66, 2, v68
  v_lshrrev_b32 v69, 2, v67
  v_lshl_add_u32 v68, v69, 4, v68
  v_lshlrev_b32 v69, 11, v64
  v_lshl_add_u32 v69, v68, 4, v69
  v_add_u32 v114, 57352, v69
  v_add_u32 v70, 2, v64
  v_lshlrev_b32 v69, 9, v66
  v_lshl_add_u32 v69, v70, 5, v69
  v_lshl_add_u32 v69, v67, 2, v69
  v_add_u32 v115, 65536, v69
  v_lshlrev_b32 v69, 4, v68
  v_lshl_add_u32 v69, v64, 9, v69
  v_add_u32 v114, 58368, v69
  v_mul_u32_u24 v69, 144, v70
  v_lshl_add_u32 v69, v67, 4, v69
  v_add_u32 v115, 65536, v69
  v_and_b32 v71, 1, v116
  v_mul_u32_u24 v69, 2048, v71
  v_lshl_add_u32 v69, v64, 8, v69
  v_lshl_add_u32 v69, v117, 4, v69
  v_add_u32 v112, 57352, v69
  v_mul_u32_u24 v69, 144, v117
  v_lshl_add_u32 v69, v71, 6, v69
  v_lshl_add_u32 v69, v64, 5, v69
  v_add_u32 v113, 65540, v69
  v_mul_u32_u24 v69, 1024, v116
  v_lshl_add_u32 v69, v117, 4, v69
  v_and_b32 v72, 8, v117
  v_xor_b32 v72, 8, v72
  v_add_u32 v69, v69, v72
  v_add_u32 v112, 57344, v69
  v_lshrrev_b32 v72, 3, v117
  v_lshl_add_u32 v72, v71, 1, v72
  v_xor_b32 v72, 1, v72
  v_lshlrev_b32 v69, 10, v116
  v_lshl_add_u32 v69, v117, 4, v69
  v_lshl_add_u32 v69, v72, 2, v69
  v_add_u32 v112, 57344, v69
  v_lshrrev_b32 v69, 1, v117
  v_and_b32 v72, 1, v117
  v_lshl_add_u32 v69, v72, 3, v69
  v_mul_u32_u24 v69, 144, v69
  v_lshl_add_u32 v69, v71, 6, v69
  v_lshl_add_u32 v69, v64, 5, v69
  v_lshl_add_u32 v72, v72, 1, v71
  v_xor_b32 v72, 1, v72
  v_lshl_add_u32 v69, v72, 2, v69
  v_add_u32 v113, 65536, v69
  v_and_b32 v71, 1, v1
  v_cmp_eq_u32 s[38:39], 0, v71
  v_cmp_gt_u32 vcc, 8, v65
  s_or_b64 s[28:29], s[38:39], vcc
  v_lshrrev_b32 v72, 1, v67
  v_lshlrev_b32 v72, 2, v72
  v_lshl_add_u32 v72, v70, 4, v72
  s_lshl_b32 s22, s17, 9
  s_add_u32 s22, s22, 9216
  v_lshl_add_u32 v73, v66, 7, v72
  v_add_u32 v73, s22, v73
  s_lshl_b32 s22, s17, 7
  s_add_u32 s22, s22, 7168
  v_add_u32 v74, s22, v72
  v_bfe_u32 v72, v65, 1, 1
  v_lshlrev_b32 v72, 7, v72
  v_lshl_add_u32 v72, v70, 4, v72
  v_bfe_u32 v73, v65, 2, 2
  v_lshl_add_u32 v72, v73, 2, v72
  v_lshrrev_b32 v73, 4, v65
  v_lshl_add_u32 v73, v73, 8, v72
  s_lshl_b32 s22, s17, 9
  s_add_u32 s22, s22, 9216
  v_add_u32 v73, s22, v73
  s_lshr_b32 s22, s17, 1
  s_lshl_b32 s22, s22, 8
  s_and_b32 s34, s17, 1
  s_lshl_b32 s34, s34, 3
  s_add_u32 s22, s22, s34
  s_add_u32 s22, s22, 7168
  v_add_u32 v74, s22, v72
  v_bfe_u32 v72, v65, 1, 1
  v_lshl_add_u32 v72, v64, 1, v72
  v_lshlrev_b32 v72, 4, v72
  v_bfe_u32 v73, v65, 2, 2
  v_lshl_add_u32 v72, v73, 2, v72
  v_lshrrev_b32 v73, 4, v65
  v_lshl_add_u32 v73, v73, 6, v72
  s_lshl_b32 s22, s17, 9
  s_add_u32 s22, s22, 9344
  v_add_u32 v73, s22, v73
  v_lshrrev_b32 v72, 1, v65
  v_lshlrev_b32 v72, 2, v72
  v_lshl_add_u32 v72, v64, 5, v72
  s_lshr_b32 s22, s17, 1
  s_lshl_b32 s22, s22, 8
  s_and_b32 s34, s17, 1
  s_lshl_b32 s34, s34, 4
  s_add_u32 s22, s22, s34
  s_add_u32 s22, s22, 7232
  v_add_u32 v74, s22, v72
  v_lshlrev_b32 v0, 2, v65
  v_and_b32 v0, 120, v0
  s_and_b32 s22, s17, 15
  s_lshl_b32 s22, s22, 7
  s_add_u32 s22, s22, 18432
  v_add_u32 v0, s22, v0
  v_cndmask_b32 v1, v74, v73, s[38:39]
  s_lshl_b32 s36, s17, 2
  s_add_u32 s36, s36, 17472
  s_mov_b32 s37, 0x3e800000
  v_mov_b32 v64, 0
  v_mov_b32 v65, 0
  v_mov_b32 v66, 0
  v_mov_b32 v67, 0
  v_mov_b32 v68, 0
  v_mov_b32 v69, 0
  v_mov_b32 v70, 0
  v_mov_b32 v71, 0
  v_mov_b32 v72, 0
  v_mov_b32 v73, 0
  v_mov_b32 v74, 0
  v_mov_b32 v75, 0
  v_mov_b32 v76, 0
  v_mov_b32 v77, 0
  v_mov_b32 v78, 0
  v_mov_b32 v79, 0
  v_mov_b32 v80, 0
  v_mov_b32 v81, 0
  v_mov_b32 v82, 0
  v_mov_b32 v83, 0
  v_mov_b32 v84, 0
  v_mov_b32 v85, 0
  v_mov_b32 v86, 0
  v_mov_b32 v87, 0
  v_mov_b32 v88, 0
  v_mov_b32 v89, 0
  v_mov_b32 v90, 0
  v_mov_b32 v91, 0
  v_mov_b32 v92, 0
  v_mov_b32 v93, 0
  v_mov_b32 v94, 0
  v_mov_b32 v95, 0
  v_mov_b32 v96, 0
  v_mov_b32 v97, 0
  v_mov_b32 v98, 0
  v_mov_b32 v99, 0
  v_mov_b32 v100, 0
  v_mov_b32 v101, 0
  v_mov_b32 v102, 0
  v_mov_b32 v103, 0
  v_mov_b32 v104, 0
  v_mov_b32 v105, 0
  v_mov_b32 v106, 0
  v_mov_b32 v107, 0
  v_mov_b32 v108, 0
  v_mov_b32 v109, 0
  v_mov_b32 v110, 0
  v_mov_b32 v111, 0
  v_and_b32 v118, 1, v116
  v_cmp_eq_u32 vcc, 0, v118
  v_mov_b32 v118, 12288
  v_mov_b32 v119, 8448
  v_cndmask_b32 v118, v118, v119, vcc
  v_lshrrev_b32 v116, 1, v116
  v_lshl_add_u32 v118, v116, 9, v118
  v_lshl_add_u32 v117, v117, 4, v118
  s_mov_b32 s57, 28672
  v_bfe_u32 v118, v2, 4, 1
  v_mul_u32_u24 v118, 0xaaaa, v118
  v_add_u32 v118, 0x4444, v118
  s_mov_b32 s56, 0x42800000
  v_mov_b32 v116, v2
  v_lshrrev_b32 v0, 4, v2
  v_min_u32 v0, 9, v0
  s_mul_i32 s22, s17, 10
  v_add_u32 v0, s22, v0
  v_lshlrev_b32 v0, 7, v0
  v_add_u32 v0, 40960, v0
  s_mov_b32 s22, 88633344
  buffer_load_dword v119, v0, s[8:11], s22 offen sc1
  s_mov_b32 s22, 88612864
  buffer_load_dword v119, v0, s[8:11], s22 offen sc1
  s_mul_i32 s35, s17, 1835008
  s_add_u32 s35, s35, 42269696
  s_mov_b32 s30, 0
  v_mov_b32 v36, 0
ch_md1:
  buffer_load_dword v37, v36, s[12:15], 0 offen sc1
  s_waitcnt vmcnt(0)
  v_readfirstlane_b32 s22, v37
  s_and_b32 s31, s22, 0xffff
  s_cmp_ge_u32 s31, 32
  s_cbranch_scc1 ch_go1
  s_sleep 2
  s_add_u32 s30, s30, 1
  s_cmp_lt_u32 s30, 50000
  s_cbranch_scc1 ch_md1
  s_branch ch_end
ch_go1:
  s_mov_b32 s31, 0
  s_lshr_b32 s22, s22, 16
  s_cmp_lg_u32 s22, 0
  s_cbranch_scc1 cB_sc1_loop
  s_branch cA_sc1_loop
ch_init2:
  s_mul_i32 s31, s17, 401408
  s_add_u32 s31, s31, 0
  s_mov_b32 s24, 71579648
  s_mov_b32 s25, 0
  s_add_u32 m0, s25, 14336
  s_nop 0
  buffer_load_dwordx4 v2, s[8:11], s24 offen offset:0 sc1 lds
  buffer_load_dwordx4 v2, s[8:11], s24 offen offset:1024 sc1 lds
  buffer_load_dwordx4 v2, s[8:11], s24 offen offset:2048 sc1 lds
  buffer_load_dwordx4 v2, s[8:11], s24 offen offset:3072 sc1 lds
  s_add_u32 m0, s25, 18432
  s_add_u32 s22, s24, 4096
  buffer_load_dwordx4 v2, s[8:11], s22 offen offset:0 sc1 lds
  buffer_load_dwordx4 v2, s[8:11], s22 offen offset:1024 sc1 lds
  buffer_load_dwordx4 v2, s[8:11], s22 offen offset:2048 sc1 lds
  v_lshrrev_b32 v64, 1, v117
  v_and_b32 v65, 1, v116
  v_lshlrev_b32 v65, 2, v65
  v_sub_u32 v64, v64, v65
  v_and_b32 v65, 1, v117
  v_lshl_add_u32 v66, v65, 2, v64
  v_cmp_gt_u32 vcc, 4, v64
  v_mov_b32 v67, 99
  s_nop 0
  v_cndmask_b32 v66, v67, v66, vcc
  v_mov_b32 v68, 0x3f80
  v_mov_b32 v69, 0x3f800000
  v_mov_b32 v4, 0
  v_cmp_eq_u32 vcc, 0, v66
  s_nop 1
  v_cndmask_b32 v4, v4, v68, vcc
  v_cmp_eq_u32 vcc, 1, v66
  s_nop 1
  v_cndmask_b32 v4, v4, v69, vcc
  v_mov_b32 v5, 0
  v_cmp_eq_u32 vcc, 2, v66
  s_nop 1
  v_cndmask_b32 v5, v5, v68, vcc
  v_cmp_eq_u32 vcc, 3, v66
  s_nop 1
  v_cndmask_b32 v5, v5, v69, vcc
  v_mov_b32 v6, 0
  v_cmp_eq_u32 vcc, 4, v66
  s_nop 1
  v_cndmask_b32 v6, v6, v68, vcc
  v_cmp_eq_u32 vcc, 5, v66
  s_nop 1
  v_cndmask_b32 v6, v6, v69, vcc
  v_mov_b32 v7, 0
  v_cmp_eq_u32 vcc, 6, v66
  s_nop 1
  v_cndmask_b32 v7, v7, v68, vcc
  v_cmp_eq_u32 vcc, 7, v66
  s_nop 1
  v_cndmask_b32 v7, v7, v69, vcc
  v_lshrrev_b32 v64, 1, v116
  v_lshrrev_b32 v65, 3, v117
  v_cmp_eq_u32 s[26:27], v64, v65
  v_and_b32 v66, 1, v116
  v_add_u32 v64, 4, v64
  v_lshrrev_b32 v67, 1, v116
  v_lshlrev_b32 v67, 8, v67
  v_lshl_add_u32 v67, v66, 9, v67
  v_lshl_add_u32 v67, v117, 4, v67
  v_add_u32 v112, 59392, v67
  v_and_b32 v68, 7, v117
  v_lshlrev_b32 v67, 8, v64
  v_lshl_add_u32 v67, v68, 5, v67
  v_lshl_add_u32 v67, v66, 4, v67
  v_add_u32 v113, 65536, v67
  v_lshrrev_b32 v64, 5, v1
  v_and_b32 v65, 31, v1
  v_lshrrev_b32 v66, 3, v65
  v_and_b32 v67, 7, v65
  v_and_b32 v68, 3, v67
  v_lshl_add_u32 v68, v66, 2, v68
  v_lshrrev_b32 v69, 2, v67
  v_lshl_add_u32 v68, v69, 4, v68
  v_lshlrev_b32 v69, 11, v64
  v_lshl_add_u32 v69, v68, 4, v69
  v_add_u32 v114, 57856, v69
  v_add_u32 v70, 4, v64
  v_lshlrev_b32 v69, 9, v66
  v_lshl_add_u32 v69, v70, 5, v69
  v_lshl_add_u32 v69, v67, 2, v69
  v_add_u32 v115, 65536, v69
  v_lshlrev_b32 v69, 4, v68
  v_lshl_add_u32 v69, v64, 9, v69
  v_add_u32 v114, 59392, v69
  v_mul_u32_u24 v69, 144, v70
  v_lshl_add_u32 v69, v67, 4, v69
  v_add_u32 v115, 65536, v69
  v_and_b32 v71, 1, v116
  v_mul_u32_u24 v69, 2048, v71
  v_lshl_add_u32 v69, v64, 8, v69
  v_lshl_add_u32 v69, v117, 4, v69
  v_add_u32 v112, 57856, v69
  v_mul_u32_u24 v69, 144, v117
  v_lshl_add_u32 v69, v71, 6, v69
  v_lshl_add_u32 v69, v64, 5, v69
  v_add_u32 v113, 65544, v69
  v_mul_u32_u24 v69, 1024, v116
  v_lshl_add_u32 v69, v117, 4, v69
  v_and_b32 v72, 8, v117
  v_xor_b32 v72, 0, v72
  v_add_u32 v69, v69, v72
  v_add_u32 v112, 57856, v69
  v_lshrrev_b32 v72, 3, v117
  v_lshl_add_u32 v72, v71, 1, v72
  v_xor_b32 v72, 2, v72
  v_lshlrev_b32 v69, 10, v116
  v_lshl_add_u32 v69, v117, 4, v69
  v_lshl_add_u32 v69, v72, 2, v69
  v_add_u32 v112, 57344, v69
  v_lshrrev_b32 v69, 1, v117
  v_and_b32 v72, 1, v117
  v_lshl_add_u32 v69, v72, 3, v69
  v_mul_u32_u24 v69, 144, v69
  v_lshl_add_u32 v69, v71, 6, v69
  v_lshl_add_u32 v69, v64, 5, v69
  v_lshl_add_u32 v72, v72, 1, v71
  v_xor_b32 v72, 2, v72
  v_lshl_add_u32 v69, v72, 2, v69
  v_add_u32 v113, 65536, v69
  v_and_b32 v71, 1, v1
  v_cmp_eq_u32 s[38:39], 0, v71
  v_cmp_gt_u32 vcc, 8, v65
  s_or_b64 s[28:29], s[38:39], vcc
  v_lshrrev_b32 v72, 1, v67
  v_lshlrev_b32 v72, 2, v72
  v_lshl_add_u32 v72, v70, 4, v72
  s_lshl_b32 s22, s17, 9
  s_add_u32 s22, s22, 9216
  v_lshl_add_u32 v73, v66, 7, v72
  v_add_u32 v73, s22, v73
  s_lshl_b32 s22, s17, 7
  s_add_u32 s22, s22, 7168
  v_add_u32 v74, s22, v72
  v_bfe_u32 v72, v65, 1, 1
  v_lshlrev_b32 v72, 7, v72
  v_lshl_add_u32 v72, v70, 4, v72
  v_bfe_u32 v73, v65, 2, 2
  v_lshl_add_u32 v72, v73, 2, v72
  v_lshrrev_b32 v73, 4, v65
  v_lshl_add_u32 v73, v73, 8, v72
  s_lshl_b32 s22, s17, 9
  s_add_u32 s22, s22, 9216
  v_add_u32 v73, s22, v73
  s_lshr_b32 s22, s17, 1
  s_lshl_b32 s22, s22, 8
  s_and_b32 s34, s17, 1
  s_lshl_b32 s34, s34, 3
  s_add_u32 s22, s22, s34
  s_add_u32 s22, s22, 7168
  v_add_u32 v74, s22, v72
  v_bfe_u32 v72, v65, 1, 1
  v_lshl_add_u32 v72, v64, 1, v72
  v_lshlrev_b32 v72, 4, v72
  v_bfe_u32 v73, v65, 2, 2
  v_lshl_add_u32 v72, v73, 2, v72
  v_lshrrev_b32 v73, 4, v65
  v_lshl_add_u32 v73, v73, 6, v72
  s_lshl_b32 s22, s17, 9
  s_add_u32 s22, s22, 9472
  v_add_u32 v73, s22, v73
  v_lshrrev_b32 v72, 1, v65
  v_lshlrev_b32 v72, 2, v72
  v_lshl_add_u32 v72, v64, 5, v72
  s_lshr_b32 s22, s17, 1
  s_lshl_b32 s22, s22, 8
  s_and_b32 s34, s17, 1
  s_lshl_b32 s34, s34, 4
  s_add_u32 s22, s22, s34
  s_add_u32 s22, s22, 7296
  v_add_u32 v74, s22, v72
  v_lshlrev_b32 v0, 2, v65
  v_and_b32 v0, 120, v0
  s_and_b32 s22, s17, 15
  s_lshl_b32 s22, s22, 7
  s_add_u32 s22, s22, 18432
  v_add_u32 v0, s22, v0
  v_cndmask_b32 v1, v74, v73, s[38:39]
  s_lshl_b32 s36, s17, 2
  s_add_u32 s36, s36, 17472
  s_mov_b32 s37, 0x3e800000
  v_mov_b32 v64, 0
  v_mov_b32 v65, 0
  v_mov_b32 v66, 0
  v_mov_b32 v67, 0
  v_mov_b32 v68, 0
  v_mov_b32 v69, 0
  v_mov_b32 v70, 0
  v_mov_b32 v71, 0
  v_mov_b32 v72, 0
  v_mov_b32 v73, 0
  v_mov_b32 v74, 0
  v_mov_b32 v75, 0
  v_mov_b32 v76, 0
  v_mov_b32 v77, 0
  v_mov_b32 v78, 0
  v_mov_b32 v79, 0
  v_mov_b32 v80, 0
  v_mov_b32 v81, 0
  v_mov_b32 v82, 0
  v_mov_b32 v83, 0
  v_mov_b32 v84, 0
  v_mov_b32 v85, 0
  v_mov_b32 v86, 0
  v_mov_b32 v87, 0
  v_mov_b32 v88, 0
  v_mov_b32 v89, 0
  v_mov_b32 v90, 0
  v_mov_b32 v91, 0
  v_mov_b32 v92, 0
  v_mov_b32 v93, 0
  v_mov_b32 v94, 0
  v_mov_b32 v95, 0
  v_mov_b32 v96, 0
  v_mov_b32 v97, 0
  v_mov_b32 v98, 0
  v_mov_b32 v99, 0
  v_mov_b32 v100, 0
  v_mov_b32 v101, 0
  v_mov_b32 v102, 0
  v_mov_b32 v103, 0
  v_mov_b32 v104, 0
  v_mov_b32 v105, 0
  v_mov_b32 v106, 0
  v_mov_b32 v107, 0
  v_mov_b32 v108, 0
  v_mov_b32 v109, 0
  v_mov_b32 v110, 0
  v_mov_b32 v111, 0
  v_and_b32 v118, 1, v116
  v_cmp_eq_u32 vcc, 0, v118
  v_mov_b32 v118, 12544
  v_mov_b32 v119, 10240
  v_cndmask_b32 v118, v118, v119, vcc
  v_lshrrev_b32 v116, 1, v116
  v_lshl_add_u32 v118, v116, 9, v118
  v_lshl_add_u32 v117, v117, 4, v118
  s_mov_b32 s57, 28672
  v_bfe_u32 v118, v2, 4, 1
  v_mul_u32_u24 v118, 0xaaaa, v118
  v_add_u32 v118, 0x4444, v118
  s_mov_b32 s56, 0x42800000
  v_mov_b32 v116, v2
  v_lshrrev_b32 v0, 4, v2
  v_min_u32 v0, 13, v0
  s_mul_i32 s22, s17, 14
  v_add_u32 v0, s22, v0
  v_lshlrev_b32 v0, 7, v0
  v_add_u32 v0, 43008, v0
  s_mov_b32 s22, 71550976
  buffer_load_dword v119, v0, s[8:11], s22 offen sc1
  s_mov_b32 s22, 71522304
  buffer_load_dword v119, v0, s[8:11], s22 offen sc1
  s_mul_i32 s35, s17, 1835008
  s_add_u32 s35, s35, 42276864
  s_mov_b32 s30, 0
  v_mov_b32 v36, 0
ch_md2:
  buffer_load_dword v37, v36, s[12:15], 0 offen sc1
  s_waitcnt vmcnt(0)
  v_readfirstlane_b32 s22, v37
  s_and_b32 s31, s22, 0xffff
  s_cmp_ge_u32 s31, 32
  s_cbranch_scc1 ch_go2
  s_sleep 2
  s_add_u32 s30, s30, 1
  s_cmp_lt_u32 s30, 50000
  s_cbranch_scc1 ch_md2
  s_branch ch_end
ch_go2:
  s_mov_b32 s31, 0
  s_lshr_b32 s22, s22, 16
  s_cmp_lg_u32 s22, 0
  s_cbranch_scc1 cB_sc2_loop
  s_branch cA_sc2_loop
ch_init3:
  s_mul_i32 s31, s17, 401408
  s_add_u32 s31, s31, 0
  s_mov_b32 s24, 71586816
  s_mov_b32 s25, 0
  s_add_u32 m0, s25, 21504
  s_nop 0
  buffer_load_dwordx4 v2, s[8:11], s24 offen offset:0 sc1 lds
  buffer_load_dwordx4 v2, s[8:11], s24 offen offset:1024 sc1 lds
  buffer_load_dwordx4 v2, s[8:11], s24 offen offset:2048 sc1 lds
  buffer_load_dwordx4 v2, s[8:11], s24 offen offset:3072 sc1 lds
  s_add_u32 m0, s25, 25600
  s_add_u32 s22, s24, 4096
  buffer_load_dwordx4 v2, s[8:11], s22 offen offset:0 sc1 lds
  buffer_load_dwordx4 v2, s[8:11], s22 offen offset:1024 sc1 lds
  buffer_load_dwordx4 v2, s[8:11], s22 offen offset:2048 sc1 lds
  v_lshrrev_b32 v64, 1, v117
  v_and_b32 v65, 1, v116
  v_lshlrev_b32 v65, 2, v65
  v_sub_u32 v64, v64, v65
  v_and_b32 v65, 1, v117
  v_lshl_add_u32 v66, v65, 2, v64
  v_cmp_gt_u32 vcc, 4, v64
  v_mov_b32 v67, 99
  s_nop 0
  v_cndmask_b32 v66, v67, v66, vcc
  v_mov_b32 v68, 0x3f80
  v_mov_b32 v69, 0x3f800000
  v_mov_b32 v4, 0
  v_cmp_eq_u32 vcc, 0, v66
  s_nop 1
  v_cndmask_b32 v4, v4, v68, vcc
  v_cmp_eq_u32 vcc, 1, v66
  s_nop 1
  v_cndmask_b32 v4, v4, v69, vcc
  v_mov_b32 v5, 0
  v_cmp_eq_u32 vcc, 2, v66
  s_nop 1
  v_cndmask_b32 v5, v5, v68, vcc
  v_cmp_eq_u32 vcc, 3, v66
  s_nop 1
  v_cndmask_b32 v5, v5, v69, vcc
  v_mov_b32 v6, 0
  v_cmp_eq_u32 vcc, 4, v66
  s_nop 1
  v_cndmask_b32 v6, v6, v68, vcc
  v_cmp_eq_u32 vcc, 5, v66
  s_nop 1
  v_cndmask_b32 v6, v6, v69, vcc
  v_mov_b32 v7, 0
  v_cmp_eq_u32 vcc, 6, v66
  s_nop 1
  v_cndmask_b32 v7, v7, v68, vcc
  v_cmp_eq_u32 vcc, 7, v66
  s_nop 1
  v_cndmask_b32 v7, v7, v69, vcc
  v_lshrrev_b32 v64, 1, v116
  v_lshrrev_b32 v65, 3, v117
  v_cmp_eq_u32 s[26:27], v64, v65
  v_and_b32 v66, 1, v116
  v_add_u32 v64, 6, v64
  v_lshrrev_b32 v67, 1, v116
  v_lshlrev_b32 v67, 8, v67
  v_lshl_add_u32 v67, v66, 9, v67
  v_lshl_add_u32 v67, v117, 4, v67
  v_add_u32 v112, 60416, v67
  v_and_b32 v68, 7, v117
  v_lshlrev_b32 v67, 8, v64
  v_lshl_add_u32 v67, v68, 5, v67
  v_lshl_add_u32 v67, v66, 4, v67
  v_add_u32 v113, 65536, v67
  v_lshrrev_b32 v64, 5, v1
  v_and_b32 v65, 31, v1
  v_lshrrev_b32 v66, 3, v65
  v_and_b32 v67, 7, v65
  v_and_b32 v68, 3, v67
  v_lshl_add_u32 v68, v66, 2, v68
  v_lshrrev_b32 v69, 2, v67
  v_lshl_add_u32 v68, v69, 4, v68
  v_lshlrev_b32 v69, 11, v64
  v_lshl_add_u32 v69, v68, 4, v69
  v_add_u32 v114, 57864, v69
  v_add_u32 v70, 6, v64
  v_lshlrev_b32 v69, 9, v66
  v_lshl_add_u32 v69, v70, 5, v69
  v_lshl_add_u32 v69, v67, 2, v69
  v_add_u32 v115, 65536, v69
  v_lshlrev_b32 v69, 4, v68
  v_lshl_add_u32 v69, v64, 9, v69
  v_add_u32 v114, 60416, v69
  v_mul_u32_u24 v69, 144, v70
  v_lshl_add_u32 v69, v67, 4, v69
  v_add_u32 v115, 65536, v69
  v_and_b32 v71, 1, v116
  v_mul_u32_u24 v69, 2048, v71
  v_lshl_add_u32 v69, v64, 8, v69
  v_lshl_add_u32 v69, v117, 4, v69
  v_add_u32 v112, 57864, v69
  v_mul_u32_u24 v69, 144, v117
  v_lshl_add_u32 v69, v71, 6, v69
  v_lshl_add_u32 v69, v64, 5, v69
  v_add_u32 v113, 65548, v69
  v_mul_u32_u24 v69, 1024, v116
  v_lshl_add_u32 v69, v117, 4, v69
  v_and_b32 v72, 8, v117
  v_xor_b32 v72, 8, v72
  v_add_u32 v69, v69, v72
  v_add_u32 v112, 57856, v69
  v_lshrrev_b32 v72, 3, v117
  v_lshl_add_u32 v72, v71, 1, v72
  v_xor_b32 v72, 3, v72
  v_lshlrev_b32 v69, 10, v116
  v_lshl_add_u32 v69, v117, 4, v69
  v_lshl_add_u32 v69, v72, 2, v69
  v_add_u32 v112, 57344, v69
  v_lshrrev_b32 v69, 1, v117
  v_and_b32 v72, 1, v117
  v_lshl_add_u32 v69, v72, 3, v69
  v_mul_u32_u24 v69, 144, v69
  v_lshl_add_u32 v69, v71, 6, v69
  v_lshl_add_u32 v69, v64, 5, v69
  v_lshl_add_u32 v72, v72, 1, v71
  v_xor_b32 v72, 3, v72
  v_lshl_add_u32 v69, v72, 2, v69
  v_add_u32 v113, 65536, v69
  v_and_b32 v71, 1, v1
  v_cmp_eq_u32 s[38:39], 0, v71
  v_cmp_gt_u32 vcc, 8, v65
  s_or_b64 s[28:29], s[38:39], vcc
  v_lshrrev_b32 v72, 1, v67
  v_lshlrev_b32 v72, 2, v72
  v_lshl_add_u32 v72, v70, 4, v72
  s_lshl_b32 s22, s17, 9
  s_add_u32 s22, s22, 9216
  v_lshl_add_u32 v73, v66, 7, v72
  v_add_u32 v73, s22, v73
  s_lshl_b32 s22, s17, 7
  s_add_u32 s22, s22, 7168
  v_add_u32 v74, s22, v72
  v_bfe_u32 v72, v65, 1, 1
  v_lshlrev_b32 v72, 7, v72
  v_lshl_add_u32 v72, v70, 4, v72
  v_bfe_u32 v73, v65, 2, 2
  v_lshl_add_u32 v72, v73, 2, v72
  v_lshrrev_b32 v73, 4, v65
  v_lshl_add_u32 v73, v73, 8, v72
  s_lshl_b32 s22, s17, 9
  s_add_u32 s22, s22, 9216
  v_add_u32 v73, s22, v73
  s_lshr_b32 s22, s17, 1
  s_lshl_b32 s22, s22, 8
  s_and_b32 s34, s17, 1
  s_lshl_b32 s34, s34, 3
  s_add_u32 s22, s22, s34
  s_add_u32 s22, s22, 7168
  v_add_u32 v74, s22, v72
  v_bfe_u32 v72, v65, 1, 1
  v_lshl_add_u32 v72, v64, 1, v72
  v_lshlrev_b32 v72, 4, v72
  v_bfe_u32 v73, v65, 2, 2
  v_lshl_add_u32 v72, v73, 2, v72
  v_lshrrev_b32 v73, 4, v65
  v_lshl_add_u32 v73, v73, 6, v72
  s_lshl_b32 s22, s17, 9
  s_add_u32 s22, s22, 9600
  v_add_u32 v73, s22, v73
  v_lshrrev_b32 v72, 1, v65
  v_lshlrev_b32 v72, 2, v72
  v_lshl_add_u32 v72, v64, 5, v72
  s_lshr_b32 s22, s17, 1
  s_lshl_b32 s22, s22, 8
  s_and_b32 s34, s17, 1
  s_lshl_b32 s34, s34, 4
  s_add_u32 s22, s22, s34
  s_add_u32 s22, s22, 7360
  v_add_u32 v74, s22, v72
  v_lshlrev_b32 v0, 2, v65
  v_and_b32 v0, 120, v0
  s_and_b32 s22, s17, 15
  s_lshl_b32 s22, s22, 7
  s_add_u32 s22, s22, 18432
  v_add_u32 v0, s22, v0
  v_cndmask_b32 v1, v74, v73, s[38:39]
  s_lshl_b32 s36, s17, 2
  s_add_u32 s36, s36, 17472
  s_mov_b32 s37, 0x3e800000
  v_mov_b32 v64, 0
  v_mov_b32 v65, 0
  v_mov_b32 v66, 0
  v_mov_b32 v67, 0
  v_mov_b32 v68, 0
  v_mov_b32 v69, 0
  v_mov_b32 v70, 0
  v_mov_b32 v71, 0
  v_mov_b32 v72, 0
  v_mov_b32 v73, 0
  v_mov_b32 v74, 0
  v_mov_b32 v75, 0
  v_mov_b32 v76, 0
  v_mov_b32 v77, 0
  v_mov_b32 v78, 0
  v_mov_b32 v79, 0
  v_mov_b32 v80, 0
  v_mov_b32 v81, 0
  v_mov_b32 v82, 0
  v_mov_b32 v83, 0
  v_mov_b32 v84, 0
  v_mov_b32 v85, 0
  v_mov_b32 v86, 0
  v_mov_b32 v87, 0
  v_mov_b32 v88, 0
  v_mov_b32 v89, 0
  v_mov_b32 v90, 0
  v_mov_b32 v91, 0
  v_mov_b32 v92, 0
  v_mov_b32 v93, 0
  v_mov_b32 v94, 0
  v_mov_b32 v95, 0
  v_mov_b32 v96, 0
  v_mov_b32 v97, 0
  v_mov_b32 v98, 0
  v_mov_b32 v99, 0
  v_mov_b32 v100, 0
  v_mov_b32 v101, 0
  v_mov_b32 v102, 0
  v_mov_b32 v103, 0
  v_mov_b32 v104, 0
  v_mov_b32 v105, 0
  v_mov_b32 v106, 0
  v_mov_b32 v107, 0
  v_mov_b32 v108, 0
  v_mov_b32 v109, 0
  v_mov_b32 v110, 0
  v_mov_b32 v111, 0
  v_and_b32 v118, 1, v116
  v_cmp_eq_u32 vcc, 0, v118
  v_mov_b32 v118, 12544
  v_mov_b32 v119, 10496
  v_cndmask_b32 v118, v118, v119, vcc
  v_lshrrev_b32 v116, 1, v116
  v_lshl_add_u32 v118, v116, 9, v118
  v_lshl_add_u32 v117, v117, 4, v118
  s_mov_b32 s57, 28672
  v_bfe_u32 v118, v2, 4, 1
  v_mul_u32_u24 v118, 0xaaaa, v118
  v_add_u32 v118, 0x4444, v118
  s_mov_b32 s56, 0x42800000
  v_mov_b32 v116, v2
  s_mul_i32 s35, s17, 1835008
  s_add_u32 s35, s35, 42284032
  s_mov_b32 s30, 0
  v_mov_b32 v36, 0
ch_md3:
  buffer_load_dword v37, v36, s[12:15], 0 offen sc1
  s_waitcnt vmcnt(0)
  v_readfirstlane_b32 s22, v37
  s_and_b32 s31, s22, 0xffff
  s_cmp_ge_u32 s31, 32
  s_cbranch_scc1 ch_go3
  s_sleep 2
  s_add_u32 s30, s30, 1
  s_cmp_lt_u32 s30, 50000
  s_cbranch_scc1 ch_md3
  s_branch ch_end
ch_go3:
  s_mov_b32 s31, 0
  s_lshr_b32 s22, s22, 16
  s_cmp_lg_u32 s22, 0
  s_cbranch_scc1 cB_sc3_loop
  s_branch cA_sc3_loop
ch_init4:
  s_mul_i32 s31, s17, 401408
  s_add_u32 s31, s31, 6422528
  s_mul_i32 s22, s17, 12
  s_add_u32 s23, s22, 267
  s_add_u32 s22, s22, 256
  v_mov_b32 v36, s23
  v_mov_b32 v37, s22
  v_cmp_eq_u32 vcc, 1, v116
  s_lshl_b32 s22, s17, 4
  s_nop 0
  v_cndmask_b32 v36, v36, v37, vcc
  v_mov_b32 v37, s22
  v_cmp_eq_u32 vcc, 0, v116
  s_nop 1
  v_cndmask_b32 v36, v36, v37, vcc
  v_lshrrev_b32 v36, 6, v36
  v_lshlrev_b32 v36, 8, v36
  v_med3_u32 v37, v117, 0, 3
  v_lshl_add_u32 v36, v37, 4, v36
  s_mov_b32 s22, 88600576
  s_mov_b32 s30, 0
va_bw_11:
  buffer_load_dwordx4 v[40:43], v36, s[8:11], s22 offen sc1
  s_waitcnt vmcnt(0)
  v_cmp_ne_u64 vcc, s[88:89], v[40:41]
  s_cbranch_vccnz va_bw_11_no
  v_cmp_ne_u64 vcc, s[88:89], v[42:43]
  s_cbranch_vccnz va_bw_11_no
  s_branch va_bw_11_ok
va_bw_11_no:
  s_sleep 2
  s_add_u32 s30, s30, 1
  s_cmp_lt_u32 s30, 50000
  s_cbranch_scc1 va_bw_11
  s_branch cA_abort
va_bw_11_ok:
  s_add_u32 s22, s31, 0
  buffer_load_dwordx4 a[0:3], v2, s[8:11], s22 offen offset:0 sc1
  buffer_load_dwordx4 a[4:7], v2, s[8:11], s22 offen offset:1024 sc1
  buffer_load_dwordx4 a[8:11], v2, s[8:11], s22 offen offset:2048 sc1
  buffer_load_dwordx4 a[12:15], v2, s[8:11], s22 offen offset:3072 sc1
  s_add_u32 s22, s31, 4096
  buffer_load_dwordx4 a[16:19], v2, s[8:11], s22 offen offset:0 sc1
  buffer_load_dwordx4 a[20:23], v2, s[8:11], s22 offen offset:1024 sc1
  buffer_load_dwordx4 a[24:27], v2, s[8:11], s22 offen offset:2048 sc1
  buffer_load_dwordx4 a[28:31], v2, s[8:11], s22 offen offset:3072 sc1
  s_add_u32 s22, s31, 8192
  buffer_load_dwordx4 a[32:35], v2, s[8:11], s22 offen offset:0 sc1
  buffer_load_dwordx4 a[36:39], v2, s[8:11], s22 offen offset:1024 sc1
  buffer_load_dwordx4 a[40:43], v2, s[8:11], s22 offen offset:2048 sc1
  buffer_load_dwordx4 a[44:47], v2, s[8:11], s22 offen offset:3072 sc1
  s_add_u32 s22, s31, 12288
  buffer_load_dwordx4 a[48:51], v2, s[8:11], s22 offen offset:0 sc1
  buffer_load_dwordx4 a[52:55], v2, s[8:11], s22 offen offset:1024 sc1
  buffer_load_dwordx4 a[56:59], v2, s[8:11], s22 offen offset:2048 sc1
  buffer_load_dwordx4 a[60:63], v2, s[8:11], s22 offen offset:3072 sc1
  s_add_u32 s22, s31, 16384
  buffer_load_dwordx4 a[64:67], v2, s[8:11], s22 offen offset:0 sc1
  buffer_load_dwordx4 a[68:71], v2, s[8:11], s22 offen offset:1024 sc1
  buffer_load_dwordx4 a[72:75], v2, s[8:11], s22 offen offset:2048 sc1
  buffer_load_dwordx4 a[76:79], v2, s[8:11], s22 offen offset:3072 sc1
  s_add_u32 s22, s31, 20480
  buffer_load_dwordx4 a[80:83], v2, s[8:11], s22 offen offset:0 sc1
  buffer_load_dwordx4 a[84:87], v2, s[8:11], s22 offen offset:1024 sc1
  buffer_load_dwordx4 a[88:91], v2, s[8:11], s22 offen offset:2048 sc1
  buffer_load_dwordx4 a[92:95], v2, s[8:11], s22 offen offset:3072 sc1
  s_add_u32 s22, s31, 24576
  buffer_load_dwordx4 a[96:99], v2, s[8:11], s22 offen offset:0 sc1
  buffer_load_dwordx4 a[100:103], v2, s[8:11], s22 offen offset:1024 sc1
  buffer_load_dwordx4 a[104:107], v2, s[8:11], s22 offen offset:2048 sc1
  buffer_load_dwordx4 a[108:111], v2, s[8:11], s22 offen offset:3072 sc1
  s_add_u32 s22, s31, 28672
  buffer_load_dwordx4 a[112:115], v2, s[8:11], s22 offen offset:0 sc1
  buffer_load_dwordx4 a[116:119], v2, s[8:11], s22 offen offset:1024 sc1
  buffer_load_dwordx4 a[120:123], v2, s[8:11], s22 offen offset:2048 sc1
  buffer_load_dwordx4 a[124:127], v2, s[8:11], s22 offen offset:3072 sc1
  s_waitcnt vmcnt(24)
  s_add_u32 s22, s31, 32768
  buffer_load_dwordx4 a[128:131], v2, s[8:11], s22 offen offset:0 sc1
  buffer_load_dwordx4 a[132:135], v2, s[8:11], s22 offen offset:1024 sc1
  buffer_load_dwordx4 a[136:139], v2, s[8:11], s22 offen offset:2048 sc1
  buffer_load_dwordx4 a[140:143], v2, s[8:11], s22 offen offset:3072 sc1
  s_add_u32 s22, s31, 36864
  buffer_load_dwordx4 a[144:147], v2, s[8:11], s22 offen offset:0 sc1
  buffer_load_dwordx4 a[148:151], v2, s[8:11], s22 offen offset:1024 sc1
  buffer_load_dwordx4 a[152:155], v2, s[8:11], s22 offen offset:2048 sc1
  buffer_load_dwordx4 a[156:159], v2, s[8:11], s22 offen offset:3072 sc1
  s_add_u32 s22, s31, 40960
  buffer_load_dwordx4 a[160:163], v2, s[8:11], s22 offen offset:0 sc1
  buffer_load_dwordx4 a[164:167], v2, s[8:11], s22 offen offset:1024 sc1
  buffer_load_dwordx4 a[168:171], v2, s[8:11], s22 offen offset:2048 sc1
  buffer_load_dwordx4 a[172:175], v2, s[8:11], s22 offen offset:3072 sc1
  s_add_u32 s22, s31, 45056
  buffer_load_dwordx4 a[176:179], v2, s[8:11], s22 offen offset:0 sc1
  buffer_load_dwordx4 a[180:183], v2, s[8:11], s22 offen offset:1024 sc1
  buffer_load_dwordx4 a[184:187], v2, s[8:11], s22 offen offset:2048 sc1
  buffer_load_dwordx4 a[188:191], v2, s[8:11], s22 offen offset:3072 sc1
  s_add_u32 s22, s31, 49152
  buffer_load_dwordx4 a[192:195], v2, s[8:11], s22 offen offset:0 sc1
  buffer_load_dwordx4 a[196:199], v2, s[8:11], s22 offen offset:1024 sc1
  buffer_load_dwordx4 a[200:203], v2, s[8:11], s22 offen offset:2048 sc1
  buffer_load_dwordx4 a[204:207], v2, s[8:11], s22 offen offset:3072 sc1
  s_add_u32 s22, s31, 53248
  buffer_load_dwordx4 a[208:211], v2, s[8:11], s22 offen offset:0 sc1
  buffer_load_dwordx4 a[212:215], v2, s[8:11], s22 offen offset:1024 sc1
  buffer_load_dwordx4 a[216:219], v2, s[8:11], s22 offen offset:2048 sc1
  buffer_load_dwordx4 a[220:223], v2, s[8:11], s22 offen offset:3072 sc1
  s_add_u32 s22, s31, 57344
  buffer_load_dwordx4 a[224:227], v2, s[8:11], s22 offen offset:0 sc1
  buffer_load_dwordx4 a[228:231], v2, s[8:11], s22 offen offset:1024 sc1
  buffer_load_dwordx4 a[232:235], v2, s[8:11], s22 offen offset:2048 sc1
  buffer_load_dwordx4 a[236:239], v2, s[8:11], s22 offen offset:3072 sc1
  s_add_u32 s22, s31, 61440
  buffer_load_dwordx4 a[240:243], v2, s[8:11], s22 offen offset:0 sc1
  buffer_load_dwordx4 a[244:247], v2, s[8:11], s22 offen offset:1024 sc1
  buffer_load_dwordx4 a[248:251], v2, s[8:11], s22 offen offset:2048 sc1
  buffer_load_dwordx4 a[252:255], v2, s[8:11], s22 offen offset:3072 sc1
  s_waitcnt vmcnt(24)
  s_add_u32 s22, s31, 65536
  buffer_load_dwordx4 v[176:179], v2, s[8:11], s22 offen offset:0 sc1
  buffer_load_dwordx4 v[180:183], v2, s[8:11], s22 offen offset:1024 sc1
  buffer_load_dwordx4 v[184:187], v2, s[8:11], s22 offen offset:2048 sc1
  buffer_load_dwordx4 v[188:191], v2, s[8:11], s22 offen offset:3072 sc1
  s_add_u32 s22, s31, 69632
  buffer_load_dwordx4 v[192:195], v2, s[8:11], s22 offen offset:0 sc1
  buffer_load_dwordx4 v[196:199], v2, s[8:11], s22 offen offset:1024 sc1
  buffer_load_dwordx4 v[200:203], v2, s[8:11], s22 offen offset:2048 sc1
  buffer_load_dwordx4 v[204:207], v2, s[8:11], s22 offen offset:3072 sc1
  s_add_u32 s22, s31, 73728
  buffer_load_dwordx4 v[208:211], v2, s[8:11], s22 offen offset:0 sc1
  buffer_load_dwordx4 v[212:215], v2, s[8:11], s22 offen offset:1024 sc1
  buffer_load_dwordx4 v[216:219], v2, s[8:11], s22 offen offset:2048 sc1
  buffer_load_dwordx4 v[220:223], v2, s[8:11], s22 offen offset:3072 sc1
  s_add_u32 s22, s31, 77824
  buffer_load_dwordx4 v[224:227], v2, s[8:11], s22 offen offset:0 sc1
  buffer_load_dwordx4 v[228:231], v2, s[8:11], s22 offen offset:1024 sc1
  buffer_load_dwordx4 v[232:235], v2, s[8:11], s22 offen offset:2048 sc1
  buffer_load_dwordx4 v[236:239], v2, s[8:11], s22 offen offset:3072 sc1
  s_add_u32 s22, s31, 81920
  buffer_load_dwordx4 v[240:243], v2, s[8:11], s22 offen offset:0 sc1
  buffer_load_dwordx4 v[244:247], v2, s[8:11], s22 offen offset:1024 sc1
  buffer_load_dwordx4 v[248:251], v2, s[8:11], s22 offen offset:2048 sc1
  buffer_load_dwordx4 v[252:255], v2, s[8:11], s22 offen offset:3072 sc1
  s_mul_i32 s22, s17, 12
  s_add_u32 s23, s22, 267
  s_add_u32 s22, s22, 256
  v_mov_b32 v36, s23
  v_mov_b32 v37, s22
  v_cmp_eq_u32 vcc, 1, v116
  s_lshl_b32 s22, s17, 4
  s_nop 0
  v_cndmask_b32 v36, v36, v37, vcc
  v_mov_b32 v37, s22
  v_cmp_eq_u32 vcc, 0, v116
  s_nop 1
  v_cndmask_b32 v36, v36, v37, vcc
  v_lshrrev_b32 v36, 6, v36
  v_lshlrev_b32 v36, 8, v36
  v_med3_u32 v37, v117, 10, 11
  v_lshl_add_u32 v36, v37, 4, v36
  s_mov_b32 s22, 88600576
  s_mov_b32 s30, 0
va_bw_12:
  buffer_load_dwordx4 v[40:43], v36, s[8:11], s22 offen sc1
  s_waitcnt vmcnt(0)
  v_cmp_ne_u64 vcc, s[88:89], v[40:41]
  s_cbranch_vccnz va_bw_12_no
  v_cmp_ne_u64 vcc, s[88:89], v[42:43]
  s_cbranch_vccnz va_bw_12_no
  s_branch va_bw_12_ok
va_bw_12_no:
  s_sleep 2
  s_add_u32 s30, s30, 1
  s_cmp_lt_u32 s30, 50000
  s_cbranch_scc1 va_bw_12
  s_branch cA_abort
va_bw_12_ok:
  s_mov_b32 m0, 16384
  s_add_u32 s22, s31, 272384
  buffer_load_dwordx4 v2, s[8:11], s22 offen offset:0 sc1 lds
  buffer_load_dwordx4 v2, s[8:11], s22 offen offset:1024 sc1 lds
  buffer_load_dwordx4 v2, s[8:11], s22 offen offset:2048 sc1 lds
  buffer_load_dwordx4 v2, s[8:11], s22 offen offset:3072 sc1 lds
  s_mov_b32 m0, 20480
  s_add_u32 s22, s31, 276480
  buffer_load_dwordx4 v2, s[8:11], s22 offen offset:0 sc1 lds
  buffer_load_dwordx4 v2, s[8:11], s22 offen offset:1024 sc1 lds
  buffer_load_dwordx4 v2, s[8:11], s22 offen offset:2048 sc1 lds
  buffer_load_dwordx4 v2, s[8:11], s22 offen offset:3072 sc1 lds
  s_mov_b32 m0, 24576
  s_add_u32 s22, s31, 280576
  buffer_load_dwordx4 v2, s[8:11], s22 offen offset:0 sc1 lds
  buffer_load_dwordx4 v2, s[8:11], s22 offen offset:1024 sc1 lds
  buffer_load_dwordx4 v2, s[8:11], s22 offen offset:2048 sc1 lds
  buffer_load_dwordx4 v2, s[8:11], s22 offen offset:3072 sc1 lds
  s_mov_b32 m0, 28672
  s_add_u32 s22, s31, 284672
  buffer_load_dwordx4 v2, s[8:11], s22 offen offset:0 sc1 lds
  buffer_load_dwordx4 v2, s[8:11], s22 offen offset:1024 sc1 lds
  v_mov_b32 v72, v116
  v_mov_b32 v73, v117
  v_lshrrev_b32 v65, 1, v72
  v_and_b32 v66, 1, v72
  v_mov_b32 v67, 0
  v_lshl_add_u32 v67, v67, 4, v73
  v_mul_u32_u24 v68, 2341, v67
  v_lshrrev_b32 v68, 16, v68
  v_mul_u32_u24 v69, 28, v68
  v_sub_u32 v69, v67, v69
  v_lshrrev_b32 v70, 4, v69
  v_and_b32 v69, 15, v69
  v_and_b32 v71, 1, v69
  v_lshrrev_b32 v69, 1, v69
  v_lshl_add_u32 v69, v71, 3, v69
  v_lshlrev_b32 v71, 12, v70
  v_lshrrev_b32 v70, 1, v68
  v_lshl_add_u32 v71, v70, 9, v71
  v_and_b32 v70, 1, v68
  v_lshl_add_u32 v71, v70, 2, v71
  v_lshl_add_u32 v71, v69, 4, v71
  v_lshl_add_u32 v71, v65, 8, v71
  v_lshl_add_u32 v60, v66, 3, v71
  v_mov_b32 v67, 1
  v_lshl_add_u32 v67, v67, 4, v73
  v_mul_u32_u24 v68, 2341, v67
  v_lshrrev_b32 v68, 16, v68
  v_mul_u32_u24 v69, 28, v68
  v_sub_u32 v69, v67, v69
  v_lshrrev_b32 v70, 4, v69
  v_and_b32 v69, 15, v69
  v_and_b32 v71, 1, v69
  v_lshrrev_b32 v69, 1, v69
  v_lshl_add_u32 v69, v71, 3, v69
  v_lshlrev_b32 v71, 12, v70
  v_lshrrev_b32 v70, 1, v68
  v_lshl_add_u32 v71, v70, 9, v71
  v_and_b32 v70, 1, v68
  v_lshl_add_u32 v71, v70, 2, v71
  v_lshl_add_u32 v71, v69, 4, v71
  v_lshl_add_u32 v71, v65, 8, v71
  v_lshl_add_u32 v61, v66, 3, v71
  v_mov_b32 v67, 2
  v_lshl_add_u32 v67, v67, 4, v73
  v_mul_u32_u24 v68, 2341, v67
  v_lshrrev_b32 v68, 16, v68
  v_mul_u32_u24 v69, 28, v68
  v_sub_u32 v69, v67, v69
  v_lshrrev_b32 v70, 4, v69
  v_and_b32 v69, 15, v69
  v_and_b32 v71, 1, v69
  v_lshrrev_b32 v69, 1, v69
  v_lshl_add_u32 v69, v71, 3, v69
  v_lshlrev_b32 v71, 12, v70
  v_lshrrev_b32 v70, 1, v68
  v_lshl_add_u32 v71, v70, 9, v71
  v_and_b32 v70, 1, v68
  v_lshl_add_u32 v71, v70, 2, v71
  v_lshl_add_u32 v71, v69, 4, v71
  v_lshl_add_u32 v71, v65, 8, v71
  v_lshl_add_u32 v62, v66, 3, v71
  v_mov_b32 v67, 3
  v_lshl_add_u32 v67, v67, 4, v73
  v_mul_u32_u24 v68, 2341, v67
  v_lshrrev_b32 v68, 16, v68
  v_mul_u32_u24 v69, 28, v68
  v_sub_u32 v69, v67, v69
  v_lshrrev_b32 v70, 4, v69
  v_and_b32 v69, 15, v69
  v_and_b32 v71, 1, v69
  v_lshrrev_b32 v69, 1, v69
  v_lshl_add_u32 v69, v71, 3, v69
  v_lshlrev_b32 v71, 12, v70
  v_lshrrev_b32 v70, 1, v68
  v_lshl_add_u32 v71, v70, 9, v71
  v_and_b32 v70, 1, v68
  v_lshl_add_u32 v71, v70, 2, v71
  v_lshl_add_u32 v71, v69, 4, v71
  v_lshl_add_u32 v71, v65, 8, v71
  v_lshl_add_u32 v170, v66, 3, v71
  v_mov_b32 v67, 4
  v_lshl_add_u32 v67, v67, 4, v73
  v_mul_u32_u24 v68, 2341, v67
  v_lshrrev_b32 v68, 16, v68
  v_mul_u32_u24 v69, 28, v68
  v_sub_u32 v69, v67, v69
  v_lshrrev_b32 v70, 4, v69
  v_and_b32 v69, 15, v69
  v_and_b32 v71, 1, v69
  v_lshrrev_b32 v69, 1, v69
  v_lshl_add_u32 v69, v71, 3, v69
  v_lshlrev_b32 v71, 12, v70
  v_lshrrev_b32 v70, 1, v68
  v_lshl_add_u32 v71, v70, 9, v71
  v_and_b32 v70, 1, v68
  v_lshl_add_u32 v71, v70, 2, v71
  v_lshl_add_u32 v71, v69, 4, v71
  v_lshl_add_u32 v71, v65, 8, v71
  v_lshl_add_u32 v171, v66, 3, v71
  v_mov_b32 v67, 5
  v_lshl_add_u32 v67, v67, 4, v73
  v_mul_u32_u24 v68, 2341, v67
  v_lshrrev_b32 v68, 16, v68
  v_mul_u32_u24 v69, 28, v68
  v_sub_u32 v69, v67, v69
  v_lshrrev_b32 v70, 4, v69
  v_and_b32 v69, 15, v69
  v_and_b32 v71, 1, v69
  v_lshrrev_b32 v69, 1, v69
  v_lshl_add_u32 v69, v71, 3, v69
  v_lshlrev_b32 v71, 12, v70
  v_lshrrev_b32 v70, 1, v68
  v_lshl_add_u32 v71, v70, 9, v71
  v_and_b32 v70, 1, v68
  v_lshl_add_u32 v71, v70, 2, v71
  v_lshl_add_u32 v71, v69, 4, v71
  v_lshl_add_u32 v71, v65, 8, v71
  v_lshl_add_u32 v172, v66, 3, v71
  v_and_b32 v0, 31, v1
  v_lshlrev_b32 v0, 2, v0
  v_add_u32 v0, 18432, v0
  v_min_u32 v4, 15, v73
  v_lshlrev_b32 v4, 2, v4
  s_and_b32 s22, s17, 3
  s_lshl_b32 s22, s22, 7
  s_add_u32 s22, s22, 17408
  v_add_u32 v4, s22, v4
  v_and_b32 v64, 7, v73
  v_lshlrev_b32 v5, 4, v64
  v_lshl_add_u32 v5, v72, 7, v5
  v_lshrrev_b32 v65, 3, v73
  v_lshl_add_u32 v5, v65, 9, v5
  s_lshl_b32 s22, s17, 3
  s_add_u32 s22, s22, 18432
  v_lshl_add_u32 v7, v2, 3, s22
  v_add_u32 v65, 0, v73
  v_min_u32 v65, 27, v65
  v_mad_u32_u24 v65, v72, 28, v65
  v_lshlrev_b32 v6, 4, v65
  s_lshr_b32 s22, s17, 1
  s_mul_i32 s22, s22, 7
  s_and_b32 s34, s17, 1
  s_lshl_b32 s35, s34, 2
  v_add_u32 v70, s35, v72
  v_mov_b32 v71, s34
  v_mov_b32 v69, 0
  v_cmp_eq_u32 vcc, 3, v72
  s_nop 1
  v_cndmask_b32 v70, v70, v72, vcc
  v_cndmask_b32 v69, v69, v71, vcc
  v_add_u32 v70, s22, v70
  v_lshrrev_b32 v68, 1, v70
  v_lshlrev_b32 v68, 8, v68
  v_lshl_add_u32 v68, v69, 7, v68
  v_and_b32 v69, 1, v70
  v_lshl_add_u32 v68, v69, 3, v68
  v_lshl_add_u32 v1, v64, 4, v68
  v_cmp_gt_u32 s[26:27], 8, v73
  v_lshrrev_b32 v65, 3, v73
  v_min_u32 v66, 7, v64
  v_lshl_add_u32 v66, v66, 1, v65
  v_mad_u32_u24 v66, v72, 16, v66
  v_lshlrev_b32 v66, 4, v66
  v_add_u32 v6, 0, v66
  s_mul_i32 s22, s17, 16
  s_add_u32 s22, s22, 0
  v_lshl_add_u32 v70, v64, 1, s22
  v_lshrrev_b32 v68, 4, v70
  v_lshlrev_b32 v68, 8, v68
  v_bfe_u32 v69, v70, 1, 1
  v_lshl_add_u32 v68, v69, 7, v68
  v_bfe_u32 v69, v70, 2, 2
  v_lshl_add_u32 v68, v69, 2, v68
  v_and_b32 v69, 1, v72
  v_lshl_add_u32 v65, v69, 2, v65
  v_lshrrev_b32 v69, 1, v72
  v_lshl_add_u32 v65, v69, 1, v65
  v_lshrrev_b32 v65, 3, v73
  v_lshl_add_u32 v65, v72, 1, v65
  v_lshrrev_b32 v5, 1, v72
  v_lshlrev_b32 v5, 9, v5
  v_lshrrev_b32 v69, 2, v73
  v_lshl_add_u32 v5, v69, 7, v5
  v_and_b32 v69, 1, v72
  v_lshl_add_u32 v5, v69, 6, v5
  v_and_b32 v69, 3, v73
  v_lshl_add_u32 v5, v69, 4, v5
  v_and_b32 v69, 1, v73
  v_mul_u32_u24 v69, 0xaaaa, v69
  v_add_u32 v0, 0x4444, v69
  v_lshl_add_u32 v1, v65, 4, v68
  v_cmp_gt_u32 s[26:27], 6, v64
  v_mov_b32 v156, 0
  v_mov_b32 v157, 0
  v_mov_b32 v158, 0
  v_mov_b32 v159, 0
  ds_write_b128 v2, v[156:159] offset:0
  ds_write_b128 v2, v[156:159] offset:1024
  ds_write_b128 v2, v[156:159] offset:2048
  ds_write_b128 v2, v[156:159] offset:3072
  s_mul_i32 s22, s17, 1835008
  s_add_u32 s25, s22, 42205184
  s_lshl_b32 s35, s17, 7
  s_add_u32 s35, s35, 88539136
  s_add_u32 s39, s35, 16384
  s_mov_b32 s38, 0
  v_mov_b32 v63, 0
  v_bfe_u32 v8, v2, 4, 1
  v_mul_u32_u24 v3, 0xaaaa, v8
  v_add_u32 v3, 0x4444, v3
  v_bfe_u32 v9, v2, 5, 3
  v_lshl_add_u32 v8, v8, 3, v9
  v_and_b32 v9, 0x300, v2
  v_lshl_add_u32 v0, v8, 4, v9
  s_lshl_b32 s22, 0, 11
  s_add_u32 s22, s22, 88602624
  v_add_u32 v36, 1024, v2
  v_min_u32 v36, 1776, v36
  s_mov_b32 s30, 0
va_iw4:
  buffer_load_dwordx4 v[40:43], v2, s[8:11], s22 offen sc1
  buffer_load_dwordx4 v[44:47], v36, s[8:11], s22 offen sc1
  s_waitcnt vmcnt(0)
  v_cmp_ne_u64 vcc, s[88:89], v[40:41]
  s_cbranch_vccnz va_iw4_no
  v_cmp_ne_u64 vcc, s[88:89], v[42:43]
  s_cbranch_vccnz va_iw4_no
  v_cmp_ne_u64 vcc, s[88:89], v[44:45]
  s_cbranch_vccnz va_iw4_no
  v_cmp_ne_u64 vcc, s[88:89], v[46:47]
  s_cbranch_vccnz va_iw4_no
  s_branch va_iw4_ok
va_iw4_no:
  s_sleep 2
  s_add_u32 s30, s30, 1
  s_cmp_lt_u32 s30, 50000
  s_cbranch_scc1 va_iw4
  s_branch cA_abort
va_iw4_ok:
  s_mov_b32 s30, 0
  v_mov_b32 v36, 0
ch_md4:
  buffer_load_dword v37, v36, s[12:15], 0 offen sc1
  s_waitcnt vmcnt(0)
  v_readfirstlane_b32 s22, v37
  s_and_b32 s31, s22, 0xffff
  s_cmp_ge_u32 s31, 32
  s_cbranch_scc1 ch_go4
  s_sleep 2
  s_add_u32 s30, s30, 1
  s_cmp_lt_u32 s30, 50000
  s_cbranch_scc1 ch_md4
  s_branch ch_end
ch_go4:
  s_mov_b32 s31, 0
  v_mov_b32 v36, 0
  v_mov_b32 v37, 0
  v_mov_b32 v38, 0
  v_mov_b32 v39, 0
  v_mov_b32 v40, 0
  v_mov_b32 v41, 0
  v_mov_b32 v42, 0
  v_mov_b32 v43, 0
  v_mov_b32 v44, 0
  v_mov_b32 v45, 0
  v_mov_b32 v46, 0
  v_mov_b32 v47, 0
  v_mov_b32 v48, 0
  v_mov_b32 v49, 0
  v_mov_b32 v50, 0
  v_mov_b32 v51, 0
  v_mov_b32 v52, 0
  v_mov_b32 v53, 0
  v_mov_b32 v54, 0
  v_mov_b32 v55, 0
  v_mov_b32 v56, 0
  v_mov_b32 v57, 0
  v_mov_b32 v58, 0
  v_mov_b32 v59, 0
  s_lshr_b32 s22, s22, 16
  s_cmp_lg_u32 s22, 0
  s_cbranch_scc1 cB_va0_loop
  s_branch cA_va0_loop
ch_init5:
  s_mul_i32 s31, s17, 401408
  s_add_u32 s31, s31, 6422528
  s_mul_i32 s22, s17, 12
  s_add_u32 s23, s22, 267
  s_add_u32 s22, s22, 256
  v_mov_b32 v36, s23
  v_mov_b32 v37, s22
  v_cmp_eq_u32 vcc, 1, v116
  s_lshl_b32 s22, s17, 4
  s_nop 0
  v_cndmask_b32 v36, v36, v37, vcc
  v_mov_b32 v37, s22
  v_cmp_eq_u32 vcc, 0, v116
  s_nop 1
  v_cndmask_b32 v36, v36, v37, vcc
  v_lshrrev_b32 v36, 6, v36
  v_lshlrev_b32 v36, 8, v36
  v_med3_u32 v37, v117, 3, 6
  v_lshl_add_u32 v36, v37, 4, v36
  s_mov_b32 s22, 88600576
  s_mov_b32 s30, 0
va_bw_13:
  buffer_load_dwordx4 v[40:43], v36, s[8:11], s22 offen sc1
  s_waitcnt vmcnt(0)
  v_cmp_ne_u64 vcc, s[88:89], v[40:41]
  s_cbranch_vccnz va_bw_13_no
  v_cmp_ne_u64 vcc, s[88:89], v[42:43]
  s_cbranch_vccnz va_bw_13_no
  s_branch va_bw_13_ok
va_bw_13_no:
  s_sleep 2
  s_add_u32 s30, s30, 1
  s_cmp_lt_u32 s30, 50000
  s_cbranch_scc1 va_bw_13
  s_branch cA_abort
va_bw_13_ok:
  s_add_u32 s22, s31, 86016
  buffer_load_dwordx4 a[0:3], v2, s[8:11], s22 offen offset:0 sc1
  buffer_load_dwordx4 a[4:7], v2, s[8:11], s22 offen offset:1024 sc1
  buffer_load_dwordx4 a[8:11], v2, s[8:11], s22 offen offset:2048 sc1
  buffer_load_dwordx4 a[12:15], v2, s[8:11], s22 offen offset:3072 sc1
  s_add_u32 s22, s31, 90112
  buffer_load_dwordx4 a[16:19], v2, s[8:11], s22 offen offset:0 sc1
  buffer_load_dwordx4 a[20:23], v2, s[8:11], s22 offen offset:1024 sc1
  buffer_load_dwordx4 a[24:27], v2, s[8:11], s22 offen offset:2048 sc1
  buffer_load_dwordx4 a[28:31], v2, s[8:11], s22 offen offset:3072 sc1
  s_add_u32 s22, s31, 94208
  buffer_load_dwordx4 a[32:35], v2, s[8:11], s22 offen offset:0 sc1
  buffer_load_dwordx4 a[36:39], v2, s[8:11], s22 offen offset:1024 sc1
  buffer_load_dwordx4 a[40:43], v2, s[8:11], s22 offen offset:2048 sc1
  buffer_load_dwordx4 a[44:47], v2, s[8:11], s22 offen offset:3072 sc1
  s_add_u32 s22, s31, 98304
  buffer_load_dwordx4 a[48:51], v2, s[8:11], s22 offen offset:0 sc1
  buffer_load_dwordx4 a[52:55], v2, s[8:11], s22 offen offset:1024 sc1
  buffer_load_dwordx4 a[56:59], v2, s[8:11], s22 offen offset:2048 sc1
  buffer_load_dwordx4 a[60:63], v2, s[8:11], s22 offen offset:3072 sc1
  s_add_u32 s22, s31, 102400
  buffer_load_dwordx4 a[64:67], v2, s[8:11], s22 offen offset:0 sc1
  buffer_load_dwordx4 a[68:71], v2, s[8:11], s22 offen offset:1024 sc1
  buffer_load_dwordx4 a[72:75], v2, s[8:11], s22 offen offset:2048 sc1
  buffer_load_dwordx4 a[76:79], v2, s[8:11], s22 offen offset:3072 sc1
  s_add_u32 s22, s31, 106496
  buffer_load_dwordx4 a[80:83], v2, s[8:11], s22 offen offset:0 sc1
  buffer_load_dwordx4 a[84:87], v2, s[8:11], s22 offen offset:1024 sc1
  buffer_load_dwordx4 a[88:91], v2, s[8:11], s22 offen offset:2048 sc1
  buffer_load_dwordx4 a[92:95], v2, s[8:11], s22 offen offset:3072 sc1
  s_add_u32 s22, s31, 110592
  buffer_load_dwordx4 a[96:99], v2, s[8:11], s22 offen offset:0 sc1
  buffer_load_dwordx4 a[100:103], v2, s[8:11], s22 offen offset:1024 sc1
  buffer_load_dwordx4 a[104:107], v2, s[8:11], s22 offen offset:2048 sc1
  buffer_load_dwordx4 a[108:111], v2, s[8:11], s22 offen offset:3072 sc1
  s_add_u32 s22, s31, 114688
  buffer_load_dwordx4 a[112:115], v2, s[8:11], s22 offen offset:0 sc1
  buffer_load_dwordx4 a[116:119], v2, s[8:11], s22 offen offset:1024 sc1
  buffer_load_dwordx4 a[120:123], v2, s[8:11], s22 offen offset:2048 sc1
  buffer_load_dwordx4 a[124:127], v2, s[8:11], s22 offen offset:3072 sc1
  s_waitcnt vmcnt(24)
  s_add_u32 s22, s31, 118784
  buffer_load_dwordx4 a[128:131], v2, s[8:11], s22 offen offset:0 sc1
  buffer_load_dwordx4 a[132:135], v2, s[8:11], s22 offen offset:1024 sc1
  buffer_load_dwordx4 a[136:139], v2, s[8:11], s22 offen offset:2048 sc1
  buffer_load_dwordx4 a[140:143], v2, s[8:11], s22 offen offset:3072 sc1
  s_add_u32 s22, s31, 122880
  buffer_load_dwordx4 a[144:147], v2, s[8:11], s22 offen offset:0 sc1
  buffer_load_dwordx4 a[148:151], v2, s[8:11], s22 offen offset:1024 sc1
  buffer_load_dwordx4 a[152:155], v2, s[8:11], s22 offen offset:2048 sc1
  buffer_load_dwordx4 a[156:159], v2, s[8:11], s22 offen offset:3072 sc1
  s_add_u32 s22, s31, 126976
  buffer_load_dwordx4 a[160:163], v2, s[8:11], s22 offen offset:0 sc1
  buffer_load_dwordx4 a[164:167], v2, s[8:11], s22 offen offset:1024 sc1
  buffer_load_dwordx4 a[168:171], v2, s[8:11], s22 offen offset:2048 sc1
  buffer_load_dwordx4 a[172:175], v2, s[8:11], s22 offen offset:3072 sc1
  s_add_u32 s22, s31, 131072
  buffer_load_dwordx4 a[176:179], v2, s[8:11], s22 offen offset:0 sc1
  buffer_load_dwordx4 a[180:183], v2, s[8:11], s22 offen offset:1024 sc1
  buffer_load_dwordx4 a[184:187], v2, s[8:11], s22 offen offset:2048 sc1
  buffer_load_dwordx4 a[188:191], v2, s[8:11], s22 offen offset:3072 sc1
  s_add_u32 s22, s31, 135168
  buffer_load_dwordx4 a[192:195], v2, s[8:11], s22 offen offset:0 sc1
  buffer_load_dwordx4 a[196:199], v2, s[8:11], s22 offen offset:1024 sc1
  buffer_load_dwordx4 a[200:203], v2, s[8:11], s22 offen offset:2048 sc1
  buffer_load_dwordx4 a[204:207], v2, s[8:11], s22 offen offset:3072 sc1
  s_add_u32 s22, s31, 139264
  buffer_load_dwordx4 a[208:211], v2, s[8:11], s22 offen offset:0 sc1
  buffer_load_dwordx4 a[212:215], v2, s[8:11], s22 offen offset:1024 sc1
  buffer_load_dwordx4 a[216:219], v2, s[8:11], s22 offen offset:2048 sc1
  buffer_load_dwordx4 a[220:223], v2, s[8:11], s22 offen offset:3072 sc1
  s_add_u32 s22, s31, 143360
  buffer_load_dwordx4 a[224:227], v2, s[8:11], s22 offen offset:0 sc1
  buffer_load_dwordx4 a[228:231], v2, s[8:11], s22 offen offset:1024 sc1
  buffer_load_dwordx4 a[232:235], v2, s[8:11], s22 offen offset:2048 sc1
  buffer_load_dwordx4 a[236:239], v2, s[8:11], s22 offen offset:3072 sc1
  s_add_u32 s22, s31, 147456
  buffer_load_dwordx4 a[240:243], v2, s[8:11], s22 offen offset:0 sc1
  buffer_load_dwordx4 a[244:247], v2, s[8:11], s22 offen offset:1024 sc1
  buffer_load_dwordx4 a[248:251], v2, s[8:11], s22 offen offset:2048 sc1
  buffer_load_dwordx4 a[252:255], v2, s[8:11], s22 offen offset:3072 sc1
  s_waitcnt vmcnt(24)
  s_add_u32 s22, s31, 151552
  buffer_load_dwordx4 v[176:179], v2, s[8:11], s22 offen offset:0 sc1
  buffer_load_dwordx4 v[180:183], v2, s[8:11], s22 offen offset:1024 sc1
  buffer_load_dwordx4 v[184:187], v2, s[8:11], s22 offen offset:2048 sc1
  buffer_load_dwordx4 v[188:191], v2, s[8:11], s22 offen offset:3072 sc1
  s_add_u32 s22, s31, 155648
  buffer_load_dwordx4 v[192:195], v2, s[8:11], s22 offen offset:0 sc1
  buffer_load_dwordx4 v[196:199], v2, s[8:11], s22 offen offset:1024 sc1
  buffer_load_dwordx4 v[200:203], v2, s[8:11], s22 offen offset:2048 sc1
  buffer_load_dwordx4 v[204:207], v2, s[8:11], s22 offen offset:3072 sc1
  s_add_u32 s22, s31, 159744
  buffer_load_dwordx4 v[208:211], v2, s[8:11], s22 offen offset:0 sc1
  buffer_load_dwordx4 v[212:215], v2, s[8:11], s22 offen offset:1024 sc1
  buffer_load_dwordx4 v[216:219], v2, s[8:11], s22 offen offset:2048 sc1
  buffer_load_dwordx4 v[220:223], v2, s[8:11], s22 offen offset:3072 sc1
  s_add_u32 s22, s31, 163840
  buffer_load_dwordx4 v[224:227], v2, s[8:11], s22 offen offset:0 sc1
  buffer_load_dwordx4 v[228:231], v2, s[8:11], s22 offen offset:1024 sc1
  buffer_load_dwordx4 v[232:235], v2, s[8:11], s22 offen offset:2048 sc1
  buffer_load_dwordx4 v[236:239], v2, s[8:11], s22 offen offset:3072 sc1
  s_add_u32 s22, s31, 167936
  buffer_load_dwordx4 v[240:243], v2, s[8:11], s22 offen offset:0 sc1
  buffer_load_dwordx4 v[244:247], v2, s[8:11], s22 offen offset:1024 sc1
  buffer_load_dwordx4 v[248:251], v2, s[8:11], s22 offen offset:2048 sc1
  buffer_load_dwordx4 v[252:255], v2, s[8:11], s22 offen offset:3072 sc1
  s_mul_i32 s22, s17, 12
  s_add_u32 s23, s22, 267
  s_add_u32 s22, s22, 256
  v_mov_b32 v36, s23
  v_mov_b32 v37, s22
  v_cmp_eq_u32 vcc, 1, v116
  s_lshl_b32 s22, s17, 4
  s_nop 0
  v_cndmask_b32 v36, v36, v37, vcc
  v_mov_b32 v37, s22
  v_cmp_eq_u32 vcc, 0, v116
  s_nop 1
  v_cndmask_b32 v36, v36, v37, vcc
  v_lshrrev_b32 v36, 6, v36
  v_lshlrev_b32 v36, 8, v36
  v_med3_u32 v37, v117, 15, 15
  v_lshl_add_u32 v36, v37, 4, v36
  s_mov_b32 s22, 88600576
  s_mov_b32 s30, 0
va_bw_14:
  buffer_load_dwordx4 v[40:43], v36, s[8:11], s22 offen sc1
  s_waitcnt vmcnt(0)
  v_cmp_ne_u64 vcc, s[88:89], v[40:41]
  s_cbranch_vccnz va_bw_14_no
  v_cmp_ne_u64 vcc, s[88:89], v[42:43]
  s_cbranch_vccnz va_bw_14_no
  s_branch va_bw_14_ok
va_bw_14_no:
  s_sleep 2
  s_add_u32 s30, s30, 1
  s_cmp_lt_u32 s30, 50000
  s_cbranch_scc1 va_bw_14
  s_branch cA_abort
va_bw_14_ok:
  s_mov_b32 m0, 59392
  s_add_u32 s22, s31, 387072
  buffer_load_dwordx4 v2, s[8:11], s22 offen offset:0 sc1 lds
  buffer_load_dwordx4 v2, s[8:11], s22 offen offset:1024 sc1 lds
  buffer_load_dwordx4 v2, s[8:11], s22 offen offset:2048 sc1 lds
  buffer_load_dwordx4 v2, s[8:11], s22 offen offset:3072 sc1 lds
  s_mov_b32 m0, 63488
  s_add_u32 s22, s31, 391168
  buffer_load_dwordx4 v2, s[8:11], s22 offen offset:0 sc1 lds
  buffer_load_dwordx4 v2, s[8:11], s22 offen offset:1024 sc1 lds
  buffer_load_dwordx4 v2, s[8:11], s22 offen offset:2048 sc1 lds
  buffer_load_dwordx4 v2, s[8:11], s22 offen offset:3072 sc1 lds
  s_mov_b32 m0, 67584
  s_add_u32 s22, s31, 395264
  buffer_load_dwordx4 v2, s[8:11], s22 offen offset:0 sc1 lds
  buffer_load_dwordx4 v2, s[8:11], s22 offen offset:1024 sc1 lds
  buffer_load_dwordx4 v2, s[8:11], s22 offen offset:2048 sc1 lds
  buffer_load_dwordx4 v2, s[8:11], s22 offen offset:3072 sc1 lds
  s_mov_b32 m0, 71680
  s_add_u32 s22, s31, 399360
  buffer_load_dwordx4 v2, s[8:11], s22 offen offset:0 sc1 lds
  buffer_load_dwordx4 v2, s[8:11], s22 offen offset:1024 sc1 lds
  v_mov_b32 v72, v116
  v_mov_b32 v73, v117
  v_lshrrev_b32 v65, 1, v72
  v_and_b32 v66, 1, v72
  v_mov_b32 v67, 6
  v_lshl_add_u32 v67, v67, 4, v73
  v_mul_u32_u24 v68, 2341, v67
  v_lshrrev_b32 v68, 16, v68
  v_mul_u32_u24 v69, 28, v68
  v_sub_u32 v69, v67, v69
  v_lshrrev_b32 v70, 4, v69
  v_and_b32 v69, 15, v69
  v_and_b32 v71, 1, v69
  v_lshrrev_b32 v69, 1, v69
  v_lshl_add_u32 v69, v71, 3, v69
  v_lshlrev_b32 v71, 12, v70
  v_lshrrev_b32 v70, 1, v68
  v_lshl_add_u32 v71, v70, 9, v71
  v_and_b32 v70, 1, v68
  v_lshl_add_u32 v71, v70, 2, v71
  v_lshl_add_u32 v71, v69, 4, v71
  v_lshl_add_u32 v71, v65, 8, v71
  v_lshl_add_u32 v60, v66, 3, v71
  v_mov_b32 v67, 7
  v_lshl_add_u32 v67, v67, 4, v73
  v_mul_u32_u24 v68, 2341, v67
  v_lshrrev_b32 v68, 16, v68
  v_mul_u32_u24 v69, 28, v68
  v_sub_u32 v69, v67, v69
  v_lshrrev_b32 v70, 4, v69
  v_and_b32 v69, 15, v69
  v_and_b32 v71, 1, v69
  v_lshrrev_b32 v69, 1, v69
  v_lshl_add_u32 v69, v71, 3, v69
  v_lshlrev_b32 v71, 12, v70
  v_lshrrev_b32 v70, 1, v68
  v_lshl_add_u32 v71, v70, 9, v71
  v_and_b32 v70, 1, v68
  v_lshl_add_u32 v71, v70, 2, v71
  v_lshl_add_u32 v71, v69, 4, v71
  v_lshl_add_u32 v71, v65, 8, v71
  v_lshl_add_u32 v61, v66, 3, v71
  v_mov_b32 v67, 8
  v_lshl_add_u32 v67, v67, 4, v73
  v_mul_u32_u24 v68, 2341, v67
  v_lshrrev_b32 v68, 16, v68
  v_mul_u32_u24 v69, 28, v68
  v_sub_u32 v69, v67, v69
  v_lshrrev_b32 v70, 4, v69
  v_and_b32 v69, 15, v69
  v_and_b32 v71, 1, v69
  v_lshrrev_b32 v69, 1, v69
  v_lshl_add_u32 v69, v71, 3, v69
  v_lshlrev_b32 v71, 12, v70
  v_lshrrev_b32 v70, 1, v68
  v_lshl_add_u32 v71, v70, 9, v71
  v_and_b32 v70, 1, v68
  v_lshl_add_u32 v71, v70, 2, v71
  v_lshl_add_u32 v71, v69, 4, v71
  v_lshl_add_u32 v71, v65, 8, v71
  v_lshl_add_u32 v62, v66, 3, v71
  v_mov_b32 v67, 9
  v_lshl_add_u32 v67, v67, 4, v73
  v_mul_u32_u24 v68, 2341, v67
  v_lshrrev_b32 v68, 16, v68
  v_mul_u32_u24 v69, 28, v68
  v_sub_u32 v69, v67, v69
  v_lshrrev_b32 v70, 4, v69
  v_and_b32 v69, 15, v69
  v_and_b32 v71, 1, v69
  v_lshrrev_b32 v69, 1, v69
  v_lshl_add_u32 v69, v71, 3, v69
  v_lshlrev_b32 v71, 12, v70
  v_lshrrev_b32 v70, 1, v68
  v_lshl_add_u32 v71, v70, 9, v71
  v_and_b32 v70, 1, v68
  v_lshl_add_u32 v71, v70, 2, v71
  v_lshl_add_u32 v71, v69, 4, v71
  v_lshl_add_u32 v71, v65, 8, v71
  v_lshl_add_u32 v170, v66, 3, v71
  v_mov_b32 v67, 10
  v_lshl_add_u32 v67, v67, 4, v73
  v_mul_u32_u24 v68, 2341, v67
  v_lshrrev_b32 v68, 16, v68
  v_mul_u32_u24 v69, 28, v68
  v_sub_u32 v69, v67, v69
  v_lshrrev_b32 v70, 4, v69
  v_and_b32 v69, 15, v69
  v_and_b32 v71, 1, v69
  v_lshrrev_b32 v69, 1, v69
  v_lshl_add_u32 v69, v71, 3, v69
  v_lshlrev_b32 v71, 12, v70
  v_lshrrev_b32 v70, 1, v68
  v_lshl_add_u32 v71, v70, 9, v71
  v_and_b32 v70, 1, v68
  v_lshl_add_u32 v71, v70, 2, v71
  v_lshl_add_u32 v71, v69, 4, v71
  v_lshl_add_u32 v71, v65, 8, v71
  v_lshl_add_u32 v171, v66, 3, v71
  v_mov_b32 v67, 11
  v_lshl_add_u32 v67, v67, 4, v73
  v_mul_u32_u24 v68, 2341, v67
  v_lshrrev_b32 v68, 16, v68
  v_mul_u32_u24 v69, 28, v68
  v_sub_u32 v69, v67, v69
  v_lshrrev_b32 v70, 4, v69
  v_and_b32 v69, 15, v69
  v_and_b32 v71, 1, v69
  v_lshrrev_b32 v69, 1, v69
  v_lshl_add_u32 v69, v71, 3, v69
  v_lshlrev_b32 v71, 12, v70
  v_lshrrev_b32 v70, 1, v68
  v_lshl_add_u32 v71, v70, 9, v71
  v_and_b32 v70, 1, v68
  v_lshl_add_u32 v71, v70, 2, v71
  v_lshl_add_u32 v71, v69, 4, v71
  v_lshl_add_u32 v71, v65, 8, v71
  v_lshl_add_u32 v172, v66, 3, v71
  v_and_b32 v0, 31, v1
  v_lshlrev_b32 v0, 2, v0
  v_add_u32 v0, 18432, v0
  v_min_u32 v4, 15, v73
  v_lshlrev_b32 v4, 2, v4
  s_and_b32 s22, s17, 3
  s_lshl_b32 s22, s22, 7
  s_add_u32 s22, s22, 17408
  v_add_u32 v4, s22, v4
  v_and_b32 v64, 7, v73
  v_lshlrev_b32 v5, 4, v64
  v_lshl_add_u32 v5, v72, 7, v5
  v_lshrrev_b32 v65, 3, v73
  v_lshl_add_u32 v5, v65, 9, v5
  s_lshl_b32 s22, s17, 3
  s_add_u32 s22, s22, 17924
  v_mov_b32 v7, s22
  v_add_u32 v65, 16, v73
  v_min_u32 v65, 27, v65
  v_mad_u32_u24 v65, v72, 28, v65
  v_lshlrev_b32 v6, 4, v65
  s_lshr_b32 s22, s17, 1
  s_mul_i32 s22, s22, 7
  s_and_b32 s34, s17, 1
  s_lshl_b32 s35, s34, 2
  v_add_u32 v70, s35, v72
  v_mov_b32 v71, s34
  v_mov_b32 v69, 1
  v_cmp_eq_u32 vcc, 3, v72
  s_nop 1
  v_cndmask_b32 v70, v70, v72, vcc
  v_cndmask_b32 v69, v69, v71, vcc
  v_add_u32 v70, s22, v70
  v_lshrrev_b32 v68, 1, v70
  v_lshlrev_b32 v68, 8, v68
  v_lshl_add_u32 v68, v69, 7, v68
  v_and_b32 v69, 1, v70
  v_lshl_add_u32 v68, v69, 3, v68
  v_lshl_add_u32 v1, v64, 4, v68
  v_cmp_gt_u32 s[26:27], 8, v73
  v_cmp_gt_u32 vcc, 3, v72
  s_and_b64 s[26:27], s[26:27], vcc
  v_lshrrev_b32 v65, 3, v73
  v_min_u32 v66, 5, v64
  v_lshl_add_u32 v66, v66, 1, v65
  v_mad_u32_u24 v66, v72, 12, v66
  v_lshlrev_b32 v66, 4, v66
  v_add_u32 v6, 1024, v66
  s_mul_i32 s22, s17, 12
  s_add_u32 s22, s22, 256
  v_lshl_add_u32 v70, v64, 1, s22
  v_lshrrev_b32 v68, 4, v70
  v_lshlrev_b32 v68, 8, v68
  v_bfe_u32 v69, v70, 1, 1
  v_lshl_add_u32 v68, v69, 7, v68
  v_bfe_u32 v69, v70, 2, 2
  v_lshl_add_u32 v68, v69, 2, v68
  v_and_b32 v69, 1, v72
  v_lshl_add_u32 v65, v69, 2, v65
  v_lshrrev_b32 v69, 1, v72
  v_lshl_add_u32 v65, v69, 1, v65
  v_lshrrev_b32 v65, 3, v73
  v_lshl_add_u32 v65, v72, 1, v65
  v_lshrrev_b32 v5, 1, v72
  v_lshlrev_b32 v5, 9, v5
  v_lshrrev_b32 v69, 2, v73
  v_lshl_add_u32 v5, v69, 7, v5
  v_and_b32 v69, 1, v72
  v_lshl_add_u32 v5, v69, 6, v5
  v_and_b32 v69, 3, v73
  v_lshl_add_u32 v5, v69, 4, v5
  v_and_b32 v69, 1, v73
  v_mul_u32_u24 v69, 0xaaaa, v69
  v_add_u32 v0, 0x4444, v69
  v_lshl_add_u32 v1, v65, 4, v68
  v_cmp_gt_u32 s[26:27], 6, v64
  v_mov_b32 v156, 0
  v_mov_b32 v157, 0
  v_mov_b32 v158, 0
  v_mov_b32 v159, 0
  ds_write_b128 v2, v[156:159] offset:4096
  ds_write_b128 v2, v[156:159] offset:5120
  ds_write_b128 v2, v[156:159] offset:6144
  ds_write_b128 v2, v[156:159] offset:7168
  s_mul_i32 s22, s17, 1835008
  s_add_u32 s25, s22, 42205184
  s_lshl_b32 s35, s17, 7
  s_add_u32 s35, s35, 88539136
  s_add_u32 s39, s35, 16384
  s_mov_b32 s38, 0
  v_mov_b32 v63, 0
  v_bfe_u32 v8, v2, 4, 1
  v_mul_u32_u24 v3, 0xaaaa, v8
  v_add_u32 v3, 0x4444, v3
  v_bfe_u32 v9, v2, 5, 3
  v_lshl_add_u32 v8, v8, 3, v9
  v_and_b32 v9, 0x300, v2
  v_lshl_add_u32 v0, v8, 4, v9
  s_lshl_b32 s22, 0, 11
  s_add_u32 s22, s22, 88602624
  v_add_u32 v36, 1024, v2
  v_min_u32 v36, 1776, v36
  s_mov_b32 s30, 0
va_iw5:
  buffer_load_dwordx4 v[40:43], v2, s[8:11], s22 offen sc1
  buffer_load_dwordx4 v[44:47], v36, s[8:11], s22 offen sc1
  s_waitcnt vmcnt(0)
  v_cmp_ne_u64 vcc, s[88:89], v[40:41]
  s_cbranch_vccnz va_iw5_no
  v_cmp_ne_u64 vcc, s[88:89], v[42:43]
  s_cbranch_vccnz va_iw5_no
  v_cmp_ne_u64 vcc, s[88:89], v[44:45]
  s_cbranch_vccnz va_iw5_no
  v_cmp_ne_u64 vcc, s[88:89], v[46:47]
  s_cbranch_vccnz va_iw5_no
  s_branch va_iw5_ok
va_iw5_no:
  s_sleep 2
  s_add_u32 s30, s30, 1
  s_cmp_lt_u32 s30, 50000
  s_cbranch_scc1 va_iw5
  s_branch cA_abort
va_iw5_ok:
  s_mov_b32 s30, 0
  v_mov_b32 v36, 0
ch_md5:
  buffer_load_dword v37, v36, s[12:15], 0 offen sc1
  s_waitcnt vmcnt(0)
  v_readfirstlane_b32 s22, v37
  s_and_b32 s31, s22, 0xffff
  s_cmp_ge_u32 s31, 32
  s_cbranch_scc1 ch_go5
  s_sleep 2
  s_add_u32 s30, s30, 1
  s_cmp_lt_u32 s30, 50000
  s_cbranch_scc1 ch_md5
  s_branch ch_end
ch_go5:
  s_mov_b32 s31, 0
  v_mov_b32 v36, 0
  v_mov_b32 v37, 0
  v_mov_b32 v38, 0
  v_mov_b32 v39, 0
  v_mov_b32 v40, 0
  v_mov_b32 v41, 0
  v_mov_b32 v42, 0
  v_mov_b32 v43, 0
  v_mov_b32 v44, 0
  v_mov_b32 v45, 0
  v_mov_b32 v46, 0
  v_mov_b32 v47, 0
  v_mov_b32 v48, 0
  v_mov_b32 v49, 0
  v_mov_b32 v50, 0
  v_mov_b32 v51, 0
  v_mov_b32 v52, 0
  v_mov_b32 v53, 0
  v_mov_b32 v54, 0
  v_mov_b32 v55, 0
  v_mov_b32 v56, 0
  v_mov_b32 v57, 0
  v_mov_b32 v58, 0
  v_mov_b32 v59, 0
  s_lshr_b32 s22, s22, 16
  s_cmp_lg_u32 s22, 0
  s_cbranch_scc1 cB_va1_loop
  s_branch cA_va1_loop
ch_init6:
  s_mul_i32 s31, s17, 401408
  s_add_u32 s31, s31, 6422528
  s_mul_i32 s22, s17, 12
  s_add_u32 s23, s22, 267
  s_add_u32 s22, s22, 256
  v_mov_b32 v36, s23
  v_mov_b32 v37, s22
  v_cmp_eq_u32 vcc, 1, v116
  s_lshl_b32 s22, s17, 4
  s_nop 0
  v_cndmask_b32 v36, v36, v37, vcc
  v_mov_b32 v37, s22
  v_cmp_eq_u32 vcc, 0, v116
  s_nop 1
  v_cndmask_b32 v36, v36, v37, vcc
  v_lshrrev_b32 v36, 6, v36
  v_lshlrev_b32 v36, 8, v36
  v_med3_u32 v37, v117, 6, 10
  v_lshl_add_u32 v36, v37, 4, v36
  s_mov_b32 s22, 88600576
  s_mov_b32 s30, 0
va_bw_15:
  buffer_load_dwordx4 v[40:43], v36, s[8:11], s22 offen sc1
  s_waitcnt vmcnt(0)
  v_cmp_ne_u64 vcc, s[88:89], v[40:41]
  s_cbranch_vccnz va_bw_15_no
  v_cmp_ne_u64 vcc, s[88:89], v[42:43]
  s_cbranch_vccnz va_bw_15_no
  s_branch va_bw_15_ok
va_bw_15_no:
  s_sleep 2
  s_add_u32 s30, s30, 1
  s_cmp_lt_u32 s30, 50000
  s_cbranch_scc1 va_bw_15
  s_branch cA_abort
va_bw_15_ok:
  s_add_u32 s22, s31, 172032
  buffer_load_dwordx4 a[0:3], v2, s[8:11], s22 offen offset:0 sc1
  buffer_load_dwordx4 a[4:7], v2, s[8:11], s22 offen offset:1024 sc1
  buffer_load_dwordx4 a[8:11], v2, s[8:11], s22 offen offset:2048 sc1
  buffer_load_dwordx4 a[12:15], v2, s[8:11], s22 offen offset:3072 sc1
  s_add_u32 s22, s31, 176128
  buffer_load_dwordx4 a[16:19], v2, s[8:11], s22 offen offset:0 sc1
  buffer_load_dwordx4 a[20:23], v2, s[8:11], s22 offen offset:1024 sc1
  buffer_load_dwordx4 a[24:27], v2, s[8:11], s22 offen offset:2048 sc1
  buffer_load_dwordx4 a[28:31], v2, s[8:11], s22 offen offset:3072 sc1
  s_add_u32 s22, s31, 180224
  buffer_load_dwordx4 a[32:35], v2, s[8:11], s22 offen offset:0 sc1
  buffer_load_dwordx4 a[36:39], v2, s[8:11], s22 offen offset:1024 sc1
  buffer_load_dwordx4 a[40:43], v2, s[8:11], s22 offen offset:2048 sc1
  buffer_load_dwordx4 a[44:47], v2, s[8:11], s22 offen offset:3072 sc1
  s_add_u32 s22, s31, 184320
  buffer_load_dwordx4 a[48:51], v2, s[8:11], s22 offen offset:0 sc1
  buffer_load_dwordx4 a[52:55], v2, s[8:11], s22 offen offset:1024 sc1
  buffer_load_dwordx4 a[56:59], v2, s[8:11], s22 offen offset:2048 sc1
  buffer_load_dwordx4 a[60:63], v2, s[8:11], s22 offen offset:3072 sc1
  s_add_u32 s22, s31, 188416
  buffer_load_dwordx4 a[64:67], v2, s[8:11], s22 offen offset:0 sc1
  buffer_load_dwordx4 a[68:71], v2, s[8:11], s22 offen offset:1024 sc1
  buffer_load_dwordx4 a[72:75], v2, s[8:11], s22 offen offset:2048 sc1
  buffer_load_dwordx4 a[76:79], v2, s[8:11], s22 offen offset:3072 sc1
  s_add_u32 s22, s31, 192512
  buffer_load_dwordx4 a[80:83], v2, s[8:11], s22 offen offset:0 sc1
  buffer_load_dwordx4 a[84:87], v2, s[8:11], s22 offen offset:1024 sc1
  buffer_load_dwordx4 a[88:91], v2, s[8:11], s22 offen offset:2048 sc1
  buffer_load_dwordx4 a[92:95], v2, s[8:11], s22 offen offset:3072 sc1
  s_add_u32 s22, s31, 196608
  buffer_load_dwordx4 a[96:99], v2, s[8:11], s22 offen offset:0 sc1
  buffer_load_dwordx4 a[100:103], v2, s[8:11], s22 offen offset:1024 sc1
  buffer_load_dwordx4 a[104:107], v2, s[8:11], s22 offen offset:2048 sc1
  buffer_load_dwordx4 a[108:111], v2, s[8:11], s22 offen offset:3072 sc1
  s_add_u32 s22, s31, 200704
  buffer_load_dwordx4 a[112:115], v2, s[8:11], s22 offen offset:0 sc1
  buffer_load_dwordx4 a[116:119], v2, s[8:11], s22 offen offset:1024 sc1
  buffer_load_dwordx4 a[120:123], v2, s[8:11], s22 offen offset:2048 sc1
  buffer_load_dwordx4 a[124:127], v2, s[8:11], s22 offen offset:3072 sc1
  s_waitcnt vmcnt(24)
  s_add_u32 s22, s31, 204800
  buffer_load_dwordx4 a[128:131], v2, s[8:11], s22 offen offset:0 sc1
  buffer_load_dwordx4 a[132:135], v2, s[8:11], s22 offen offset:1024 sc1
  buffer_load_dwordx4 a[136:139], v2, s[8:11], s22 offen offset:2048 sc1
  buffer_load_dwordx4 a[140:143], v2, s[8:11], s22 offen offset:3072 sc1
  s_add_u32 s22, s31, 208896
  buffer_load_dwordx4 a[144:147], v2, s[8:11], s22 offen offset:0 sc1
  buffer_load_dwordx4 a[148:151], v2, s[8:11], s22 offen offset:1024 sc1
  buffer_load_dwordx4 a[152:155], v2, s[8:11], s22 offen offset:2048 sc1
  buffer_load_dwordx4 a[156:159], v2, s[8:11], s22 offen offset:3072 sc1
  s_add_u32 s22, s31, 212992
  buffer_load_dwordx4 a[160:163], v2, s[8:11], s22 offen offset:0 sc1
  buffer_load_dwordx4 a[164:167], v2, s[8:11], s22 offen offset:1024 sc1
  buffer_load_dwordx4 a[168:171], v2, s[8:11], s22 offen offset:2048 sc1
  buffer_load_dwordx4 a[172:175], v2, s[8:11], s22 offen offset:3072 sc1
  s_add_u32 s22, s31, 217088
  buffer_load_dwordx4 a[176:179], v2, s[8:11], s22 offen offset:0 sc1
  buffer_load_dwordx4 a[180:183], v2, s[8:11], s22 offen offset:1024 sc1
  buffer_load_dwordx4 a[184:187], v2, s[8:11], s22 offen offset:2048 sc1
  buffer_load_dwordx4 a[188:191], v2, s[8:11], s22 offen offset:3072 sc1
  s_add_u32 s22, s31, 221184
  buffer_load_dwordx4 a[192:195], v2, s[8:11], s22 offen offset:0 sc1
  buffer_load_dwordx4 a[196:199], v2, s[8:11], s22 offen offset:1024 sc1
  buffer_load_dwordx4 a[200:203], v2, s[8:11], s22 offen offset:2048 sc1
  buffer_load_dwordx4 a[204:207], v2, s[8:11], s22 offen offset:3072 sc1
  s_add_u32 s22, s31, 225280
  buffer_load_dwordx4 a[208:211], v2, s[8:11], s22 offen offset:0 sc1
  buffer_load_dwordx4 a[212:215], v2, s[8:11], s22 offen offset:1024 sc1
  buffer_load_dwordx4 a[216:219], v2, s[8:11], s22 offen offset:2048 sc1
  buffer_load_dwordx4 a[220:223], v2, s[8:11], s22 offen offset:3072 sc1
  s_add_u32 s22, s31, 229376
  buffer_load_dwordx4 a[224:227], v2, s[8:11], s22 offen offset:0 sc1
  buffer_load_dwordx4 a[228:231], v2, s[8:11], s22 offen offset:1024 sc1
  buffer_load_dwordx4 a[232:235], v2, s[8:11], s22 offen offset:2048 sc1
  buffer_load_dwordx4 a[236:239], v2, s[8:11], s22 offen offset:3072 sc1
  s_add_u32 s22, s31, 233472
  buffer_load_dwordx4 a[240:243], v2, s[8:11], s22 offen offset:0 sc1
  buffer_load_dwordx4 a[244:247], v2, s[8:11], s22 offen offset:1024 sc1
  buffer_load_dwordx4 a[248:251], v2, s[8:11], s22 offen offset:2048 sc1
  buffer_load_dwordx4 a[252:255], v2, s[8:11], s22 offen offset:3072 sc1
  s_waitcnt vmcnt(24)
  s_add_u32 s22, s31, 237568
  buffer_load_dwordx4 v[120:123], v2, s[8:11], s22 offen offset:0 sc1
  buffer_load_dwordx4 v[124:127], v2, s[8:11], s22 offen offset:1024 sc1
  buffer_load_dwordx4 v[128:131], v2, s[8:11], s22 offen offset:2048 sc1
  buffer_load_dwordx4 v[132:135], v2, s[8:11], s22 offen offset:3072 sc1
  s_add_u32 s22, s31, 241664
  buffer_load_dwordx4 v[136:139], v2, s[8:11], s22 offen offset:0 sc1
  buffer_load_dwordx4 v[140:143], v2, s[8:11], s22 offen offset:1024 sc1
  buffer_load_dwordx4 v[144:147], v2, s[8:11], s22 offen offset:2048 sc1
  buffer_load_dwordx4 v[148:151], v2, s[8:11], s22 offen offset:3072 sc1
  s_add_u32 s22, s31, 245760
  buffer_load_dwordx4 v[152:155], v2, s[8:11], s22 offen offset:0 sc1
  buffer_load_dwordx4 v[156:159], v2, s[8:11], s22 offen offset:1024 sc1
  buffer_load_dwordx4 v[160:163], v2, s[8:11], s22 offen offset:2048 sc1
  buffer_load_dwordx4 v[164:167], v2, s[8:11], s22 offen offset:3072 sc1
  s_add_u32 s22, s31, 249856
  buffer_load_dwordx4 v[168:171], v2, s[8:11], s22 offen offset:0 sc1
  buffer_load_dwordx4 v[172:175], v2, s[8:11], s22 offen offset:1024 sc1
  buffer_load_dwordx4 v[176:179], v2, s[8:11], s22 offen offset:2048 sc1
  buffer_load_dwordx4 v[180:183], v2, s[8:11], s22 offen offset:3072 sc1
  s_add_u32 s22, s31, 253952
  buffer_load_dwordx4 v[184:187], v2, s[8:11], s22 offen offset:0 sc1
  buffer_load_dwordx4 v[188:191], v2, s[8:11], s22 offen offset:1024 sc1
  buffer_load_dwordx4 v[192:195], v2, s[8:11], s22 offen offset:2048 sc1
  buffer_load_dwordx4 v[196:199], v2, s[8:11], s22 offen offset:3072 sc1
  s_add_u32 s22, s31, 258048
  buffer_load_dwordx4 v[200:203], v2, s[8:11], s22 offen offset:0 sc1
  buffer_load_dwordx4 v[204:207], v2, s[8:11], s22 offen offset:1024 sc1
  buffer_load_dwordx4 v[208:211], v2, s[8:11], s22 offen offset:2048 sc1
  buffer_load_dwordx4 v[212:215], v2, s[8:11], s22 offen offset:3072 sc1
  s_add_u32 s22, s31, 262144
  buffer_load_dwordx4 v[216:219], v2, s[8:11], s22 offen offset:0 sc1
  buffer_load_dwordx4 v[220:223], v2, s[8:11], s22 offen offset:1024 sc1
  buffer_load_dwordx4 v[224:227], v2, s[8:11], s22 offen offset:2048 sc1
  buffer_load_dwordx4 v[228:231], v2, s[8:11], s22 offen offset:3072 sc1
  s_add_u32 s22, s31, 266240
  buffer_load_dwordx4 v[232:235], v2, s[8:11], s22 offen offset:0 sc1
  buffer_load_dwordx4 v[236:239], v2, s[8:11], s22 offen offset:1024 sc1
  buffer_load_dwordx4 v[240:243], v2, s[8:11], s22 offen offset:2048 sc1
  buffer_load_dwordx4 v[244:247], v2, s[8:11], s22 offen offset:3072 sc1
  s_waitcnt vmcnt(24)
  s_add_u32 s22, s31, 270336
  buffer_load_dwordx4 v[248:251], v2, s[8:11], s22 offen offset:0 sc1
  buffer_load_dwordx4 v[252:255], v2, s[8:11], s22 offen offset:1024 sc1
  v_mov_b32 v72, v116
  v_mov_b32 v73, v117
  v_lshrrev_b32 v65, 1, v72
  v_and_b32 v66, 1, v72
  v_mov_b32 v67, 12
  v_lshl_add_u32 v67, v67, 4, v73
  v_mul_u32_u24 v68, 2341, v67
  v_lshrrev_b32 v68, 16, v68
  v_mul_u32_u24 v69, 28, v68
  v_sub_u32 v69, v67, v69
  v_lshrrev_b32 v70, 4, v69
  v_and_b32 v69, 15, v69
  v_and_b32 v71, 1, v69
  v_lshrrev_b32 v69, 1, v69
  v_lshl_add_u32 v69, v71, 3, v69
  v_lshlrev_b32 v71, 12, v70
  v_lshrrev_b32 v70, 1, v68
  v_lshl_add_u32 v71, v70, 9, v71
  v_and_b32 v70, 1, v68
  v_lshl_add_u32 v71, v70, 2, v71
  v_lshl_add_u32 v71, v69, 4, v71
  v_lshl_add_u32 v71, v65, 8, v71
  v_lshl_add_u32 v100, v66, 3, v71
  v_mov_b32 v67, 13
  v_lshl_add_u32 v67, v67, 4, v73
  v_mul_u32_u24 v68, 2341, v67
  v_lshrrev_b32 v68, 16, v68
  v_mul_u32_u24 v69, 28, v68
  v_sub_u32 v69, v67, v69
  v_lshrrev_b32 v70, 4, v69
  v_and_b32 v69, 15, v69
  v_and_b32 v71, 1, v69
  v_lshrrev_b32 v69, 1, v69
  v_lshl_add_u32 v69, v71, 3, v69
  v_lshlrev_b32 v71, 12, v70
  v_lshrrev_b32 v70, 1, v68
  v_lshl_add_u32 v71, v70, 9, v71
  v_and_b32 v70, 1, v68
  v_lshl_add_u32 v71, v70, 2, v71
  v_lshl_add_u32 v71, v69, 4, v71
  v_lshl_add_u32 v71, v65, 8, v71
  v_lshl_add_u32 v101, v66, 3, v71
  v_mov_b32 v67, 14
  v_lshl_add_u32 v67, v67, 4, v73
  v_mul_u32_u24 v68, 2341, v67
  v_lshrrev_b32 v68, 16, v68
  v_mul_u32_u24 v69, 28, v68
  v_sub_u32 v69, v67, v69
  v_lshrrev_b32 v70, 4, v69
  v_and_b32 v69, 15, v69
  v_and_b32 v71, 1, v69
  v_lshrrev_b32 v69, 1, v69
  v_lshl_add_u32 v69, v71, 3, v69
  v_lshlrev_b32 v71, 12, v70
  v_lshrrev_b32 v70, 1, v68
  v_lshl_add_u32 v71, v70, 9, v71
  v_and_b32 v70, 1, v68
  v_lshl_add_u32 v71, v70, 2, v71
  v_lshl_add_u32 v71, v69, 4, v71
  v_lshl_add_u32 v71, v65, 8, v71
  v_lshl_add_u32 v102, v66, 3, v71
  v_mov_b32 v67, 15
  v_lshl_add_u32 v67, v67, 4, v73
  v_mul_u32_u24 v68, 2341, v67
  v_lshrrev_b32 v68, 16, v68
  v_mul_u32_u24 v69, 28, v68
  v_sub_u32 v69, v67, v69
  v_lshrrev_b32 v70, 4, v69
  v_and_b32 v69, 15, v69
  v_and_b32 v71, 1, v69
  v_lshrrev_b32 v69, 1, v69
  v_lshl_add_u32 v69, v71, 3, v69
  v_lshlrev_b32 v71, 12, v70
  v_lshrrev_b32 v70, 1, v68
  v_lshl_add_u32 v71, v70, 9, v71
  v_and_b32 v70, 1, v68
  v_lshl_add_u32 v71, v70, 2, v71
  v_lshl_add_u32 v71, v69, 4, v71
  v_lshl_add_u32 v71, v65, 8, v71
  v_lshl_add_u32 v103, v66, 3, v71
  v_mov_b32 v67, 16
  v_lshl_add_u32 v67, v67, 4, v73
  v_mul_u32_u24 v68, 2341, v67
  v_lshrrev_b32 v68, 16, v68
  v_mul_u32_u24 v69, 28, v68
  v_sub_u32 v69, v67, v69
  v_lshrrev_b32 v70, 4, v69
  v_and_b32 v69, 15, v69
  v_and_b32 v71, 1, v69
  v_lshrrev_b32 v69, 1, v69
  v_lshl_add_u32 v69, v71, 3, v69
  v_lshlrev_b32 v71, 12, v70
  v_lshrrev_b32 v70, 1, v68
  v_lshl_add_u32 v71, v70, 9, v71
  v_and_b32 v70, 1, v68
  v_lshl_add_u32 v71, v70, 2, v71
  v_lshl_add_u32 v71, v69, 4, v71
  v_lshl_add_u32 v71, v65, 8, v71
  v_lshl_add_u32 v104, v66, 3, v71
  v_mov_b32 v67, 17
  v_lshl_add_u32 v67, v67, 4, v73
  v_mul_u32_u24 v68, 2341, v67
  v_lshrrev_b32 v68, 16, v68
  v_mul_u32_u24 v69, 28, v68
  v_sub_u32 v69, v67, v69
  v_lshrrev_b32 v70, 4, v69
  v_and_b32 v69, 15, v69
  v_and_b32 v71, 1, v69
  v_lshrrev_b32 v69, 1, v69
  v_lshl_add_u32 v69, v71, 3, v69
  v_lshlrev_b32 v71, 12, v70
  v_lshrrev_b32 v70, 1, v68
  v_lshl_add_u32 v71, v70, 9, v71
  v_and_b32 v70, 1, v68
  v_lshl_add_u32 v71, v70, 2, v71
  v_lshl_add_u32 v71, v69, 4, v71
  v_lshl_add_u32 v71, v65, 8, v71
  v_lshl_add_u32 v105, v66, 3, v71
  v_mov_b32 v67, 18
  v_lshl_add_u32 v67, v67, 4, v73
  v_mul_u32_u24 v68, 2341, v67
  v_lshrrev_b32 v68, 16, v68
  v_mul_u32_u24 v69, 28, v68
  v_sub_u32 v69, v67, v69
  v_lshrrev_b32 v70, 4, v69
  v_and_b32 v69, 15, v69
  v_and_b32 v71, 1, v69
  v_lshrrev_b32 v69, 1, v69
  v_lshl_add_u32 v69, v71, 3, v69
  v_lshlrev_b32 v71, 12, v70
  v_lshrrev_b32 v70, 1, v68
  v_lshl_add_u32 v71, v70, 9, v71
  v_and_b32 v70, 1, v68
  v_lshl_add_u32 v71, v70, 2, v71
  v_lshl_add_u32 v71, v69, 4, v71
  v_lshl_add_u32 v71, v65, 8, v71
  v_lshl_add_u32 v106, v66, 3, v71
  v_mov_b32 v67, 19
  v_lshl_add_u32 v67, v67, 4, v73
  v_mul_u32_u24 v68, 2341, v67
  v_lshrrev_b32 v68, 16, v68
  v_mul_u32_u24 v69, 28, v68
  v_sub_u32 v69, v67, v69
  v_lshrrev_b32 v70, 4, v69
  v_and_b32 v69, 15, v69
  v_and_b32 v71, 1, v69
  v_lshrrev_b32 v69, 1, v69
  v_lshl_add_u32 v69, v71, 3, v69
  v_lshlrev_b32 v71, 12, v70
  v_lshrrev_b32 v70, 1, v68
  v_lshl_add_u32 v71, v70, 9, v71
  v_and_b32 v70, 1, v68
  v_lshl_add_u32 v71, v70, 2, v71
  v_lshl_add_u32 v71, v69, 4, v71
  v_lshl_add_u32 v71, v65, 8, v71
  v_lshl_add_u32 v107, v66, 3, v71
  s_mul_i32 s24, s17, 532480
  s_add_u32 s24, s24, 76939264
  s_mul_i32 s34, s17, 640
  s_add_u32 s34, s34, 88582144
  s_mul_i32 s36, s17, 448
  v_add_u32 v0, s36, v2
  v_add_u32 v0, 8192, v0
  s_add_u32 s36, s36, 88080384
  s_mov_b32 s37, 76939264
  v_cmp_gt_u32 s[26:27], 28, v1
  v_and_b32 v119, 31, v1
  v_lshlrev_b32 v119, 2, v119
  v_and_b32 v119, 0x78, v119
  v_or_b32 v119, 0, v119
  s_add_u32 s22, s17, 16
  s_and_b32 s22, s22, 15
  s_lshl_b32 s22, s22, 7
  s_add_u32 s22, s22, 18432
  v_add_u32 v119, s22, v119
  v_min_u32 v118, 9, v1
  s_mul_i32 s22, s17, 10
  v_add_u32 v118, s22, v118
  v_lshlrev_b32 v118, 7, v118
  v_add_u32 v118, 40960, v118
  s_mov_b32 s39, 71565312
  v_add_u32 v1, 16384, v2
  v_mov_b32 v117, 1
  s_mul_i32 s38, s17, 1104
  s_add_u32 s38, s38, 20480
  v_bfe_u32 v8, v2, 4, 1
  v_mul_u32_u24 v3, 0xaaaa, v8
  v_add_u32 v3, 0x4444, v3
  v_bfe_u32 v9, v2, 5, 3
  v_lshl_add_u32 v8, v8, 3, v9
  v_and_b32 v9, 0x300, v2
  v_lshl_add_u32 v5, v8, 4, v9
  s_lshl_b32 s22, 0, 11
  s_add_u32 s22, s22, 88602624
  v_add_u32 v36, 1024, v2
  v_min_u32 v36, 1776, v36
  s_mov_b32 s30, 0
va_iw6:
  buffer_load_dwordx4 v[40:43], v2, s[8:11], s22 offen sc1
  buffer_load_dwordx4 v[44:47], v36, s[8:11], s22 offen sc1
  s_waitcnt vmcnt(0)
  v_cmp_ne_u64 vcc, s[88:89], v[40:41]
  s_cbranch_vccnz va_iw6_no
  v_cmp_ne_u64 vcc, s[88:89], v[42:43]
  s_cbranch_vccnz va_iw6_no
  v_cmp_ne_u64 vcc, s[88:89], v[44:45]
  s_cbranch_vccnz va_iw6_no
  v_cmp_ne_u64 vcc, s[88:89], v[46:47]
  s_cbranch_vccnz va_iw6_no
  s_branch va_iw6_ok
va_iw6_no:
  s_sleep 2
  s_add_u32 s30, s30, 1
  s_cmp_lt_u32 s30, 50000
  s_cbranch_scc1 va_iw6
  s_branch cA_abort
va_iw6_ok:
  s_mov_b32 s30, 0
  v_mov_b32 v36, 0
ch_md6:
  buffer_load_dword v37, v36, s[12:15], 0 offen sc1
  s_waitcnt vmcnt(0)
  v_readfirstlane_b32 s22, v37
  s_and_b32 s31, s22, 0xffff
  s_cmp_ge_u32 s31, 32
  s_cbranch_scc1 ch_go6
  s_sleep 2
  s_add_u32 s30, s30, 1
  s_cmp_lt_u32 s30, 50000
  s_cbranch_scc1 ch_md6
  s_branch ch_end
ch_go6:
  s_mov_b32 s31, 0
  s_lshr_b32 s22, s22, 16
  s_cmp_lg_u32 s22, 0
  s_cbranch_scc1 cB_va2_loop
  s_branch cA_va2_loop
ch_init7:
  s_mul_i32 s31, s17, 401408
  s_add_u32 s31, s31, 6422528
  s_mul_i32 s22, s17, 12
  s_add_u32 s23, s22, 267
  s_add_u32 s22, s22, 256
  v_mov_b32 v36, s23
  v_mov_b32 v37, s22
  v_cmp_eq_u32 vcc, 1, v116
  s_lshl_b32 s22, s17, 4
  s_nop 0
  v_cndmask_b32 v36, v36, v37, vcc
  v_mov_b32 v37, s22
  v_cmp_eq_u32 vcc, 0, v116
  s_nop 1
  v_cndmask_b32 v36, v36, v37, vcc
  v_lshrrev_b32 v36, 6, v36
  v_lshlrev_b32 v36, 8, v36
  v_med3_u32 v37, v117, 11, 15
  v_lshl_add_u32 v36, v37, 4, v36
  s_mov_b32 s22, 88600576
  s_mov_b32 s30, 0
va_bw_16:
  buffer_load_dwordx4 v[40:43], v36, s[8:11], s22 offen sc1
  s_waitcnt vmcnt(0)
  v_cmp_ne_u64 vcc, s[88:89], v[40:41]
  s_cbranch_vccnz va_bw_16_no
  v_cmp_ne_u64 vcc, s[88:89], v[42:43]
  s_cbranch_vccnz va_bw_16_no
  s_branch va_bw_16_ok
va_bw_16_no:
  s_sleep 2
  s_add_u32 s30, s30, 1
  s_cmp_lt_u32 s30, 50000
  s_cbranch_scc1 va_bw_16
  s_branch cA_abort
va_bw_16_ok:
  s_add_u32 s22, s31, 286720
  buffer_load_dwordx4 a[0:3], v2, s[8:11], s22 offen offset:0 sc1
  buffer_load_dwordx4 a[4:7], v2, s[8:11], s22 offen offset:1024 sc1
  buffer_load_dwordx4 a[8:11], v2, s[8:11], s22 offen offset:2048 sc1
  buffer_load_dwordx4 a[12:15], v2, s[8:11], s22 offen offset:3072 sc1
  s_add_u32 s22, s31, 290816
  buffer_load_dwordx4 a[16:19], v2, s[8:11], s22 offen offset:0 sc1
  buffer_load_dwordx4 a[20:23], v2, s[8:11], s22 offen offset:1024 sc1
  buffer_load_dwordx4 a[24:27], v2, s[8:11], s22 offen offset:2048 sc1
  buffer_load_dwordx4 a[28:31], v2, s[8:11], s22 offen offset:3072 sc1
  s_add_u32 s22, s31, 294912
  buffer_load_dwordx4 a[32:35], v2, s[8:11], s22 offen offset:0 sc1
  buffer_load_dwordx4 a[36:39], v2, s[8:11], s22 offen offset:1024 sc1
  buffer_load_dwordx4 a[40:43], v2, s[8:11], s22 offen offset:2048 sc1
  buffer_load_dwordx4 a[44:47], v2, s[8:11], s22 offen offset:3072 sc1
  s_add_u32 s22, s31, 299008
  buffer_load_dwordx4 a[48:51], v2, s[8:11], s22 offen offset:0 sc1
  buffer_load_dwordx4 a[52:55], v2, s[8:11], s22 offen offset:1024 sc1
  buffer_load_dwordx4 a[56:59], v2, s[8:11], s22 offen offset:2048 sc1
  buffer_load_dwordx4 a[60:63], v2, s[8:11], s22 offen offset:3072 sc1
  s_add_u32 s22, s31, 303104
  buffer_load_dwordx4 a[64:67], v2, s[8:11], s22 offen offset:0 sc1
  buffer_load_dwordx4 a[68:71], v2, s[8:11], s22 offen offset:1024 sc1
  buffer_load_dwordx4 a[72:75], v2, s[8:11], s22 offen offset:2048 sc1
  buffer_load_dwordx4 a[76:79], v2, s[8:11], s22 offen offset:3072 sc1
  s_add_u32 s22, s31, 307200
  buffer_load_dwordx4 a[80:83], v2, s[8:11], s22 offen offset:0 sc1
  buffer_load_dwordx4 a[84:87], v2, s[8:11], s22 offen offset:1024 sc1
  buffer_load_dwordx4 a[88:91], v2, s[8:11], s22 offen offset:2048 sc1
  buffer_load_dwordx4 a[92:95], v2, s[8:11], s22 offen offset:3072 sc1
  s_add_u32 s22, s31, 311296
  buffer_load_dwordx4 a[96:99], v2, s[8:11], s22 offen offset:0 sc1
  buffer_load_dwordx4 a[100:103], v2, s[8:11], s22 offen offset:1024 sc1
  buffer_load_dwordx4 a[104:107], v2, s[8:11], s22 offen offset:2048 sc1
  buffer_load_dwordx4 a[108:111], v2, s[8:11], s22 offen offset:3072 sc1
  s_add_u32 s22, s31, 315392
  buffer_load_dwordx4 a[112:115], v2, s[8:11], s22 offen offset:0 sc1
  buffer_load_dwordx4 a[116:119], v2, s[8:11], s22 offen offset:1024 sc1
  buffer_load_dwordx4 a[120:123], v2, s[8:11], s22 offen offset:2048 sc1
  buffer_load_dwordx4 a[124:127], v2, s[8:11], s22 offen offset:3072 sc1
  s_waitcnt vmcnt(24)
  s_add_u32 s22, s31, 319488
  buffer_load_dwordx4 a[128:131], v2, s[8:11], s22 offen offset:0 sc1
  buffer_load_dwordx4 a[132:135], v2, s[8:11], s22 offen offset:1024 sc1
  buffer_load_dwordx4 a[136:139], v2, s[8:11], s22 offen offset:2048 sc1
  buffer_load_dwordx4 a[140:143], v2, s[8:11], s22 offen offset:3072 sc1
  s_add_u32 s22, s31, 323584
  buffer_load_dwordx4 a[144:147], v2, s[8:11], s22 offen offset:0 sc1
  buffer_load_dwordx4 a[148:151], v2, s[8:11], s22 offen offset:1024 sc1
  buffer_load_dwordx4 a[152:155], v2, s[8:11], s22 offen offset:2048 sc1
  buffer_load_dwordx4 a[156:159], v2, s[8:11], s22 offen offset:3072 sc1
  s_add_u32 s22, s31, 327680
  buffer_load_dwordx4 a[160:163], v2, s[8:11], s22 offen offset:0 sc1
  buffer_load_dwordx4 a[164:167], v2, s[8:11], s22 offen offset:1024 sc1
  buffer_load_dwordx4 a[168:171], v2, s[8:11], s22 offen offset:2048 sc1
  buffer_load_dwordx4 a[172:175], v2, s[8:11], s22 offen offset:3072 sc1
  s_add_u32 s22, s31, 331776
  buffer_load_dwordx4 a[176:179], v2, s[8:11], s22 offen offset:0 sc1
  buffer_load_dwordx4 a[180:183], v2, s[8:11], s22 offen offset:1024 sc1
  buffer_load_dwordx4 a[184:187], v2, s[8:11], s22 offen offset:2048 sc1
  buffer_load_dwordx4 a[188:191], v2, s[8:11], s22 offen offset:3072 sc1
  s_add_u32 s22, s31, 335872
  buffer_load_dwordx4 a[192:195], v2, s[8:11], s22 offen offset:0 sc1
  buffer_load_dwordx4 a[196:199], v2, s[8:11], s22 offen offset:1024 sc1
  buffer_load_dwordx4 a[200:203], v2, s[8:11], s22 offen offset:2048 sc1
  buffer_load_dwordx4 a[204:207], v2, s[8:11], s22 offen offset:3072 sc1
  s_add_u32 s22, s31, 339968
  buffer_load_dwordx4 a[208:211], v2, s[8:11], s22 offen offset:0 sc1
  buffer_load_dwordx4 a[212:215], v2, s[8:11], s22 offen offset:1024 sc1
  buffer_load_dwordx4 a[216:219], v2, s[8:11], s22 offen offset:2048 sc1
  buffer_load_dwordx4 a[220:223], v2, s[8:11], s22 offen offset:3072 sc1
  s_add_u32 s22, s31, 344064
  buffer_load_dwordx4 a[224:227], v2, s[8:11], s22 offen offset:0 sc1
  buffer_load_dwordx4 a[228:231], v2, s[8:11], s22 offen offset:1024 sc1
  buffer_load_dwordx4 a[232:235], v2, s[8:11], s22 offen offset:2048 sc1
  buffer_load_dwordx4 a[236:239], v2, s[8:11], s22 offen offset:3072 sc1
  s_add_u32 s22, s31, 348160
  buffer_load_dwordx4 a[240:243], v2, s[8:11], s22 offen offset:0 sc1
  buffer_load_dwordx4 a[244:247], v2, s[8:11], s22 offen offset:1024 sc1
  buffer_load_dwordx4 a[248:251], v2, s[8:11], s22 offen offset:2048 sc1
  buffer_load_dwordx4 a[252:255], v2, s[8:11], s22 offen offset:3072 sc1
  s_waitcnt vmcnt(24)
  s_add_u32 s22, s31, 352256
  buffer_load_dwordx4 v[120:123], v2, s[8:11], s22 offen offset:0 sc1
  buffer_load_dwordx4 v[124:127], v2, s[8:11], s22 offen offset:1024 sc1
  buffer_load_dwordx4 v[128:131], v2, s[8:11], s22 offen offset:2048 sc1
  buffer_load_dwordx4 v[132:135], v2, s[8:11], s22 offen offset:3072 sc1
  s_add_u32 s22, s31, 356352
  buffer_load_dwordx4 v[136:139], v2, s[8:11], s22 offen offset:0 sc1
  buffer_load_dwordx4 v[140:143], v2, s[8:11], s22 offen offset:1024 sc1
  buffer_load_dwordx4 v[144:147], v2, s[8:11], s22 offen offset:2048 sc1
  buffer_load_dwordx4 v[148:151], v2, s[8:11], s22 offen offset:3072 sc1
  s_add_u32 s22, s31, 360448
  buffer_load_dwordx4 v[152:155], v2, s[8:11], s22 offen offset:0 sc1
  buffer_load_dwordx4 v[156:159], v2, s[8:11], s22 offen offset:1024 sc1
  buffer_load_dwordx4 v[160:163], v2, s[8:11], s22 offen offset:2048 sc1
  buffer_load_dwordx4 v[164:167], v2, s[8:11], s22 offen offset:3072 sc1
  s_add_u32 s22, s31, 364544
  buffer_load_dwordx4 v[168:171], v2, s[8:11], s22 offen offset:0 sc1
  buffer_load_dwordx4 v[172:175], v2, s[8:11], s22 offen offset:1024 sc1
  buffer_load_dwordx4 v[176:179], v2, s[8:11], s22 offen offset:2048 sc1
  buffer_load_dwordx4 v[180:183], v2, s[8:11], s22 offen offset:3072 sc1
  s_add_u32 s22, s31, 368640
  buffer_load_dwordx4 v[184:187], v2, s[8:11], s22 offen offset:0 sc1
  buffer_load_dwordx4 v[188:191], v2, s[8:11], s22 offen offset:1024 sc1
  buffer_load_dwordx4 v[192:195], v2, s[8:11], s22 offen offset:2048 sc1
  buffer_load_dwordx4 v[196:199], v2, s[8:11], s22 offen offset:3072 sc1
  s_add_u32 s22, s31, 372736
  buffer_load_dwordx4 v[200:203], v2, s[8:11], s22 offen offset:0 sc1
  buffer_load_dwordx4 v[204:207], v2, s[8:11], s22 offen offset:1024 sc1
  buffer_load_dwordx4 v[208:211], v2, s[8:11], s22 offen offset:2048 sc1
  buffer_load_dwordx4 v[212:215], v2, s[8:11], s22 offen offset:3072 sc1
  s_add_u32 s22, s31, 376832
  buffer_load_dwordx4 v[216:219], v2, s[8:11], s22 offen offset:0 sc1
  buffer_load_dwordx4 v[220:223], v2, s[8:11], s22 offen offset:1024 sc1
  buffer_load_dwordx4 v[224:227], v2, s[8:11], s22 offen offset:2048 sc1
  buffer_load_dwordx4 v[228:231], v2, s[8:11], s22 offen offset:3072 sc1
  s_add_u32 s22, s31, 380928
  buffer_load_dwordx4 v[232:235], v2, s[8:11], s22 offen offset:0 sc1
  buffer_load_dwordx4 v[236:239], v2, s[8:11], s22 offen offset:1024 sc1
  buffer_load_dwordx4 v[240:243], v2, s[8:11], s22 offen offset:2048 sc1
  buffer_load_dwordx4 v[244:247], v2, s[8:11], s22 offen offset:3072 sc1
  s_waitcnt vmcnt(24)
  s_add_u32 s22, s31, 385024
  buffer_load_dwordx4 v[248:251], v2, s[8:11], s22 offen offset:0 sc1
  buffer_load_dwordx4 v[252:255], v2, s[8:11], s22 offen offset:1024 sc1
  v_mov_b32 v72, v116
  v_mov_b32 v73, v117
  v_lshrrev_b32 v65, 1, v72
  v_and_b32 v66, 1, v72
  v_mov_b32 v67, 20
  v_lshl_add_u32 v67, v67, 4, v73
  v_mul_u32_u24 v68, 2341, v67
  v_lshrrev_b32 v68, 16, v68
  v_mul_u32_u24 v69, 28, v68
  v_sub_u32 v69, v67, v69
  v_lshrrev_b32 v70, 4, v69
  v_and_b32 v69, 15, v69
  v_and_b32 v71, 1, v69
  v_lshrrev_b32 v69, 1, v69
  v_lshl_add_u32 v69, v71, 3, v69
  v_lshlrev_b32 v71, 12, v70
  v_lshrrev_b32 v70, 1, v68
  v_lshl_add_u32 v71, v70, 9, v71
  v_and_b32 v70, 1, v68
  v_lshl_add_u32 v71, v70, 2, v71
  v_lshl_add_u32 v71, v69, 4, v71
  v_lshl_add_u32 v71, v65, 8, v71
  v_lshl_add_u32 v100, v66, 3, v71
  v_mov_b32 v67, 21
  v_lshl_add_u32 v67, v67, 4, v73
  v_mul_u32_u24 v68, 2341, v67
  v_lshrrev_b32 v68, 16, v68
  v_mul_u32_u24 v69, 28, v68
  v_sub_u32 v69, v67, v69
  v_lshrrev_b32 v70, 4, v69
  v_and_b32 v69, 15, v69
  v_and_b32 v71, 1, v69
  v_lshrrev_b32 v69, 1, v69
  v_lshl_add_u32 v69, v71, 3, v69
  v_lshlrev_b32 v71, 12, v70
  v_lshrrev_b32 v70, 1, v68
  v_lshl_add_u32 v71, v70, 9, v71
  v_and_b32 v70, 1, v68
  v_lshl_add_u32 v71, v70, 2, v71
  v_lshl_add_u32 v71, v69, 4, v71
  v_lshl_add_u32 v71, v65, 8, v71
  v_lshl_add_u32 v101, v66, 3, v71
  v_mov_b32 v67, 22
  v_lshl_add_u32 v67, v67, 4, v73
  v_mul_u32_u24 v68, 2341, v67
  v_lshrrev_b32 v68, 16, v68
  v_mul_u32_u24 v69, 28, v68
  v_sub_u32 v69, v67, v69
  v_lshrrev_b32 v70, 4, v69
  v_and_b32 v69, 15, v69
  v_and_b32 v71, 1, v69
  v_lshrrev_b32 v69, 1, v69
  v_lshl_add_u32 v69, v71, 3, v69
  v_lshlrev_b32 v71, 12, v70
  v_lshrrev_b32 v70, 1, v68
  v_lshl_add_u32 v71, v70, 9, v71
  v_and_b32 v70, 1, v68
  v_lshl_add_u32 v71, v70, 2, v71
  v_lshl_add_u32 v71, v69, 4, v71
  v_lshl_add_u32 v71, v65, 8, v71
  v_lshl_add_u32 v102, v66, 3, v71
  v_mov_b32 v67, 23
  v_lshl_add_u32 v67, v67, 4, v73
  v_mul_u32_u24 v68, 2341, v67
  v_lshrrev_b32 v68, 16, v68
  v_mul_u32_u24 v69, 28, v68
  v_sub_u32 v69, v67, v69
  v_lshrrev_b32 v70, 4, v69
  v_and_b32 v69, 15, v69
  v_and_b32 v71, 1, v69
  v_lshrrev_b32 v69, 1, v69
  v_lshl_add_u32 v69, v71, 3, v69
  v_lshlrev_b32 v71, 12, v70
  v_lshrrev_b32 v70, 1, v68
  v_lshl_add_u32 v71, v70, 9, v71
  v_and_b32 v70, 1, v68
  v_lshl_add_u32 v71, v70, 2, v71
  v_lshl_add_u32 v71, v69, 4, v71
  v_lshl_add_u32 v71, v65, 8, v71
  v_lshl_add_u32 v103, v66, 3, v71
  v_mov_b32 v67, 24
  v_lshl_add_u32 v67, v67, 4, v73
  v_mul_u32_u24 v68, 2341, v67
  v_lshrrev_b32 v68, 16, v68
  v_mul_u32_u24 v69, 28, v68
  v_sub_u32 v69, v67, v69
  v_lshrrev_b32 v70, 4, v69
  v_and_b32 v69, 15, v69
  v_and_b32 v71, 1, v69
  v_lshrrev_b32 v69, 1, v69
  v_lshl_add_u32 v69, v71, 3, v69
  v_lshlrev_b32 v71, 12, v70
  v_lshrrev_b32 v70, 1, v68
  v_lshl_add_u32 v71, v70, 9, v71
  v_and_b32 v70, 1, v68
  v_lshl_add_u32 v71, v70, 2, v71
  v_lshl_add_u32 v71, v69, 4, v71
  v_lshl_add_u32 v71, v65, 8, v71
  v_lshl_add_u32 v104, v66, 3, v71
  v_mov_b32 v67, 25
  v_lshl_add_u32 v67, v67, 4, v73
  v_mul_u32_u24 v68, 2341, v67
  v_lshrrev_b32 v68, 16, v68
  v_mul_u32_u24 v69, 28, v68
  v_sub_u32 v69, v67, v69
  v_lshrrev_b32 v70, 4, v69
  v_and_b32 v69, 15, v69
  v_and_b32 v71, 1, v69
  v_lshrrev_b32 v69, 1, v69
  v_lshl_add_u32 v69, v71, 3, v69
  v_lshlrev_b32 v71, 12, v70
  v_lshrrev_b32 v70, 1, v68
  v_lshl_add_u32 v71, v70, 9, v71
  v_and_b32 v70, 1, v68
  v_lshl_add_u32 v71, v70, 2, v71
  v_lshl_add_u32 v71, v69, 4, v71
  v_lshl_add_u32 v71, v65, 8, v71
  v_lshl_add_u32 v105, v66, 3, v71
  v_mov_b32 v67, 26
  v_lshl_add_u32 v67, v67, 4, v73
  v_mul_u32_u24 v68, 2341, v67
  v_lshrrev_b32 v68, 16, v68
  v_mul_u32_u24 v69, 28, v68
  v_sub_u32 v69, v67, v69
  v_lshrrev_b32 v70, 4, v69
  v_and_b32 v69, 15, v69
  v_and_b32 v71, 1, v69
  v_lshrrev_b32 v69, 1, v69
  v_lshl_add_u32 v69, v71, 3, v69
  v_lshlrev_b32 v71, 12, v70
  v_lshrrev_b32 v70, 1, v68
  v_lshl_add_u32 v71, v70, 9, v71
  v_and_b32 v70, 1, v68
  v_lshl_add_u32 v71, v70, 2, v71
  v_lshl_add_u32 v71, v69, 4, v71
  v_lshl_add_u32 v71, v65, 8, v71
  v_lshl_add_u32 v106, v66, 3, v71
  v_mov_b32 v67, 27
  v_lshl_add_u32 v67, v67, 4, v73
  v_mul_u32_u24 v68, 2341, v67
  v_lshrrev_b32 v68, 16, v68
  v_mul_u32_u24 v69, 28, v68
  v_sub_u32 v69, v67, v69
  v_lshrrev_b32 v70, 4, v69
  v_and_b32 v69, 15, v69
  v_and_b32 v71, 1, v69
  v_lshrrev_b32 v69, 1, v69
  v_lshl_add_u32 v69, v71, 3, v69
  v_lshlrev_b32 v71, 12, v70
  v_lshrrev_b32 v70, 1, v68
  v_lshl_add_u32 v71, v70, 9, v71
  v_and_b32 v70, 1, v68
  v_lshl_add_u32 v71, v70, 2, v71
  v_lshl_add_u32 v71, v69, 4, v71
  v_lshl_add_u32 v71, v65, 8, v71
  v_lshl_add_u32 v107, v66, 3, v71
  s_mul_i32 s24, s17, 532480
  s_add_u32 s24, s24, 76943360
  s_mul_i32 s34, s17, 640
  s_add_u32 s34, s34, 88582148
  s_mul_i32 s36, s17, 448
  v_add_u32 v0, s36, v2
  v_add_u32 v0, 8192, v0
  s_add_u32 s36, s36, 88080384
  s_mov_b32 s37, 76939264
  v_cmp_gt_u32 s[26:27], 28, v1
  v_and_b32 v119, 31, v1
  v_lshlrev_b32 v119, 2, v119
  v_and_b32 v119, 0x78, v119
  v_or_b32 v119, 4, v119
  s_add_u32 s22, s17, 16
  s_and_b32 s22, s22, 15
  s_lshl_b32 s22, s22, 7
  s_add_u32 s22, s22, 18432
  v_add_u32 v119, s22, v119
  v_min_u32 v118, 13, v1
  s_mul_i32 s22, s17, 14
  v_add_u32 v118, s22, v118
  v_lshlrev_b32 v118, 7, v118
  v_add_u32 v118, 57344, v118
  s_mov_b32 s39, 71565312
  v_add_u32 v1, 59392, v2
  v_mov_b32 v117, 1
  s_mul_i32 s38, s17, 1104
  s_add_u32 s38, s38, 21504
  v_bfe_u32 v8, v2, 4, 1
  v_mul_u32_u24 v3, 0xaaaa, v8
  v_add_u32 v3, 0x4444, v3
  v_bfe_u32 v9, v2, 5, 3
  v_lshl_add_u32 v8, v8, 3, v9
  v_and_b32 v9, 0x300, v2
  v_lshl_add_u32 v5, v8, 4, v9
  s_lshl_b32 s22, 0, 11
  s_add_u32 s22, s22, 88602624
  v_add_u32 v36, 1024, v2
  v_min_u32 v36, 1776, v36
  s_mov_b32 s30, 0
va_iw7:
  buffer_load_dwordx4 v[40:43], v2, s[8:11], s22 offen sc1
  buffer_load_dwordx4 v[44:47], v36, s[8:11], s22 offen sc1
  s_waitcnt vmcnt(0)
  v_cmp_ne_u64 vcc, s[88:89], v[40:41]
  s_cbranch_vccnz va_iw7_no
  v_cmp_ne_u64 vcc, s[88:89], v[42:43]
  s_cbranch_vccnz va_iw7_no
  v_cmp_ne_u64 vcc, s[88:89], v[44:45]
  s_cbranch_vccnz va_iw7_no
  v_cmp_ne_u64 vcc, s[88:89], v[46:47]
  s_cbranch_vccnz va_iw7_no
  s_branch va_iw7_ok
va_iw7_no:
  s_sleep 2
  s_add_u32 s30, s30, 1
  s_cmp_lt_u32 s30, 50000
  s_cbranch_scc1 va_iw7
  s_branch cA_abort
va_iw7_ok:
  s_mov_b32 s30, 0
  v_mov_b32 v36, 0
ch_md7:
  buffer_load_dword v37, v36, s[12:15], 0 offen sc1
  s_waitcnt vmcnt(0)
  v_readfirstlane_b32 s22, v37
  s_and_b32 s31, s22, 0xffff
  s_cmp_ge_u32 s31, 32
  s_cbranch_scc1 ch_go7
  s_sleep 2
  s_add_u32 s30, s30, 1
  s_cmp_lt_u32 s30, 50000
  s_cbranch_scc1 ch_md7
  s_branch ch_end
ch_go7:
  s_mov_b32 s31, 0
  s_lshr_b32 s22, s22, 16
  s_cmp_lg_u32 s22, 0
  s_cbranch_scc1 cB_va3_loop
  s_branch cA_va3_loop
.p2align 6

cA_sc0_loop:
  s_add_u32 s23, s20, 4096
  s_add_u32 s21, s20, 20480
  v_mov_b32 v48, 0
  v_mov_b32 v49, 0
  v_mov_b32 v50, 0
  v_mov_b32 v51, 0
  v_mov_b32 v52, 0
  v_mov_b32 v53, 0
  v_mov_b32 v54, 0
  v_mov_b32 v55, 0
  v_mov_b32 v56, 0
  v_mov_b32 v57, 0
  v_mov_b32 v58, 0
  v_mov_b32 v59, 0
  v_mov_b32 v60, 0
  v_mov_b32 v61, 0
  v_mov_b32 v62, 0
  v_mov_b32 v63, 0
  v_mov_b32 v88, 0
  v_mov_b32 v89, 0
  v_mov_b32 v90, 0
  v_mov_b32 v91, 0
  v_mov_b32 v92, 0
  v_mov_b32 v93, 0
  v_mov_b32 v94, 0
  v_mov_b32 v95, 0
  v_mov_b32 v66, 0
  v_mov_b32 v67, 0
  s_mov_b32 s30, 0
  s_mov_b32 s62, 0
  buffer_load_dword v68, v0, s[8:11], s20 offen sc1
  s_nop 7
  buffer_load_dword v69, v0, s[8:11], s20 offen sc1
  s_nop 7
  buffer_load_dword v70, v0, s[8:11], s20 offen sc1
  s_nop 7
  buffer_load_dword v71, v0, s[8:11], s20 offen sc1
  s_nop 7
  buffer_load_dword v72, v0, s[8:11], s20 offen sc1
cA_sc0_fp_l:
  s_waitcnt vmcnt(4)
  v_cmp_eq_u32 vcc, -1, v68
  s_cbranch_vccz cA_sc0_fp_d
  buffer_load_dword v68, v0, s[8:11], s20 offen sc1
  s_waitcnt vmcnt(4)
  v_cmp_eq_u32 vcc, -1, v69
  s_cbranch_vccz cA_sc0_fp_d
  buffer_load_dword v69, v0, s[8:11], s20 offen sc1
  s_waitcnt vmcnt(4)
  v_cmp_eq_u32 vcc, -1, v70
  s_cbranch_vccz cA_sc0_fp_d
  buffer_load_dword v70, v0, s[8:11], s20 offen sc1
  s_waitcnt vmcnt(4)
  v_cmp_eq_u32 vcc, -1, v71
  s_cbranch_vccz cA_sc0_fp_d
  buffer_load_dword v71, v0, s[8:11], s20 offen sc1
  s_waitcnt vmcnt(4)
  v_cmp_eq_u32 vcc, -1, v72
  s_cbranch_vccz cA_sc0_fp_d
  buffer_load_dword v72, v0, s[8:11], s20 offen sc1
  s_add_u32 s30, s30, 1
  s_cmp_lt_u32 s30, 400000
  s_cbranch_scc1 cA_sc0_fp_l
  s_branch cA_abort
cA_sc0_fp_d:
  buffer_load_dwordx4 v[8:11], v2, s[8:11], s20 offen offset:0
  s_barrier
  s_branch cA_sc0_ld1
cA_sc0_ld:
  buffer_load_dwordx4 v[8:11], v2, s[8:11], s20 offen offset:0
cA_sc0_ld1:
  v_mov_b32 v36, 0
  v_mov_b32 v37, 0
  v_mov_b32 v38, 0
  v_mov_b32 v39, 0
  buffer_load_dwordx4 v[12:15], v2, s[8:11], s20 offen offset:1024
  v_mov_b32 v40, 0
  v_mov_b32 v41, 0
  v_mov_b32 v42, 0
  v_mov_b32 v43, 0
  buffer_load_dwordx4 v[16:19], v2, s[8:11], s20 offen offset:2048
  v_mov_b32 v44, 0
  v_mov_b32 v45, 0
  v_mov_b32 v46, 0
  v_mov_b32 v47, 0
  ds_read_b128 v[96:99], v117 offset:0
  ds_read_b128 v[100:103], v117 offset:1024
  ds_read_b128 v[104:107], v117 offset:14336
  ds_read_b128 v[108:111], v117 offset:15360
  s_waitcnt vmcnt(2)
  v_smfmac_f32_16x16x64_bf16 v[36:39], v[8:11], a[0:7], v3
  v_smfmac_f32_16x16x64_bf16 v[40:43], v[8:11], a[56:63], v3
  buffer_load_dwordx4 v[20:23], v2, s[8:11], s20 offen offset:3072
  v_smfmac_f32_16x16x64_bf16 v[44:47], v[8:11], a[112:119], v3
  v_smfmac_f32_16x16x64_bf16 v[48:51], v[8:11], a[168:175], v3
  v_smfmac_f32_16x16x64_bf16 v[52:55], v[8:11], a[224:231], v3
  buffer_load_dwordx4 v[24:27], v2, s[8:11], s23 offen offset:0
  v_smfmac_f32_16x16x64_bf16 v[56:59], v[8:11], v[144:151], v3
  v_smfmac_f32_16x16x64_bf16 v[60:63], v[8:11], v[200:207], v3
  s_waitcnt vmcnt(3)
  v_smfmac_f32_16x16x64_bf16 v[36:39], v[12:15], a[8:15], v3
  v_smfmac_f32_16x16x64_bf16 v[40:43], v[12:15], a[64:71], v3
  buffer_load_dwordx4 v[28:31], v2, s[8:11], s23 offen offset:1024
  v_smfmac_f32_16x16x64_bf16 v[44:47], v[12:15], a[120:127], v3
  v_smfmac_f32_16x16x64_bf16 v[48:51], v[12:15], a[176:183], v3
  v_smfmac_f32_16x16x64_bf16 v[52:55], v[12:15], a[232:239], v3
  buffer_load_dwordx4 v[32:35], v2, s[8:11], s23 offen offset:2048
  v_smfmac_f32_16x16x64_bf16 v[56:59], v[12:15], v[152:159], v3
  v_smfmac_f32_16x16x64_bf16 v[60:63], v[12:15], v[208:215], v3
  s_xor_b32 s58, s25, 28672
  s_add_u32 s59, s24, 28672
  s_add_u32 m0, s58, 0
  s_waitcnt vmcnt(4)
  v_smfmac_f32_16x16x64_bf16 v[36:39], v[16:19], a[16:23], v3
  buffer_load_dwordx4 v2, s[8:11], s59 offen offset:0 sc1 lds
  v_smfmac_f32_16x16x64_bf16 v[40:43], v[16:19], a[72:79], v3
  v_smfmac_f32_16x16x64_bf16 v[44:47], v[16:19], a[128:135], v3
  v_smfmac_f32_16x16x64_bf16 v[48:51], v[16:19], a[184:191], v3
  v_smfmac_f32_16x16x64_bf16 v[52:55], v[16:19], a[240:247], v3
  buffer_load_dwordx4 v2, s[8:11], s59 offen offset:1024 sc1 lds
  v_smfmac_f32_16x16x64_bf16 v[56:59], v[16:19], v[160:167], v3
  v_smfmac_f32_16x16x64_bf16 v[60:63], v[16:19], v[216:223], v3
  s_waitcnt vmcnt(5)
  v_smfmac_f32_16x16x64_bf16 v[36:39], v[20:23], a[24:31], v3
  v_smfmac_f32_16x16x64_bf16 v[40:43], v[20:23], a[80:87], v3
  buffer_load_dwordx4 v2, s[8:11], s59 offen offset:2048 sc1 lds
  v_smfmac_f32_16x16x64_bf16 v[44:47], v[20:23], a[136:143], v3
  v_smfmac_f32_16x16x64_bf16 v[48:51], v[20:23], a[192:199], v3
  v_smfmac_f32_16x16x64_bf16 v[52:55], v[20:23], a[248:255], v3
  v_smfmac_f32_16x16x64_bf16 v[56:59], v[20:23], v[168:175], v3
  buffer_load_dwordx4 v2, s[8:11], s59 offen offset:3072 sc1 lds
  v_smfmac_f32_16x16x64_bf16 v[60:63], v[20:23], v[224:231], v3
  s_waitcnt vmcnt(4)
cA_sc0_ph2:
  v_smfmac_f32_16x16x64_bf16 v[60:63], v[24:27], v[232:239], v3
  ds_read_b128 v[12:15], v116 offset:0
  ds_read_b128 v[16:19], v116 offset:1024
  v_smfmac_f32_16x16x64_bf16 v[60:63], v[28:31], v[240:247], v3
  v_smfmac_f32_16x16x64_bf16 v[60:63], v[32:35], v[248:255], v3
  v_mov_b32 v80, v24
  v_smfmac_f32_16x16x64_bf16 v[52:55], v[24:27], v[120:127], v3
  v_mov_b32 v81, v25
  v_smfmac_f32_16x16x64_bf16 v[52:55], v[28:31], v[128:135], v3
  v_mov_b32 v82, v32
  v_smfmac_f32_16x16x64_bf16 v[52:55], v[32:35], v[136:143], v3
  v_cvt_pk_bf16_f32 v64, v60, v61
  v_smfmac_f32_16x16x64_bf16 v[56:59], v[24:27], v[176:183], v3
  v_cvt_pk_bf16_f32 v65, v62, v63
  v_smfmac_f32_16x16x64_bf16 v[56:59], v[28:31], v[184:191], v3
  v_mov_b32 v83, v33
  v_mfma_f32_16x16x32_bf16 v[68:71], v[64:67], v[4:7], 0
  v_smfmac_f32_16x16x64_bf16 v[56:59], v[32:35], v[192:199], v3
  v_cvt_pk_bf16_f32 v64, v52, v53
  v_smfmac_f32_16x16x64_bf16 v[36:39], v[24:27], a[32:39], v3
  v_cvt_pk_bf16_f32 v65, v54, v55
  v_smfmac_f32_16x16x64_bf16 v[36:39], v[28:31], a[40:47], v3
  v_cvt_pk_bf16_f32 v78, v68, v69
  v_smfmac_f32_16x16x64_bf16 v[36:39], v[32:35], a[48:55], v3
  v_cvt_pk_bf16_f32 v79, v70, v71
  v_cvt_pk_bf16_f32 v66, v56, v57
  v_smfmac_f32_16x16x64_bf16 v[40:43], v[24:27], a[88:95], v3
  v_cvt_pk_bf16_f32 v67, v58, v59
  v_smfmac_f32_16x16x64_bf16 v[40:43], v[28:31], a[96:103], v3
  v_mfma_f32_16x16x32_bf16 v[72:75], v[64:67], v[4:7], 0
  ds_read_b128 v[52:55], v116 offset:14336
  ds_read_b128 v[56:59], v116 offset:15360
  v_smfmac_f32_16x16x64_bf16 v[40:43], v[32:35], a[104:111], v3
  v_cvt_pk_bf16_f32 v64, v36, v37
  v_smfmac_f32_16x16x64_bf16 v[44:47], v[24:27], a[144:151], v3
  v_cvt_pk_bf16_f32 v65, v38, v39
  v_smfmac_f32_16x16x64_bf16 v[44:47], v[28:31], a[152:159], v3
  v_cvt_pk_bf16_f32 v76, v72, v73
  v_smfmac_f32_16x16x64_bf16 v[44:47], v[32:35], a[160:167], v3
  v_cvt_pk_bf16_f32 v77, v74, v75
  v_cvt_pk_bf16_f32 v66, v40, v41
  v_smfmac_f32_16x16x64_bf16 v[48:51], v[24:27], a[200:207], v3
  v_cvt_pk_bf16_f32 v67, v42, v43
  v_smfmac_f32_16x16x64_bf16 v[48:51], v[28:31], a[208:215], v3
  v_mfma_f32_16x16x32_bf16 v[68:71], v[64:67], v[4:7], 0
  v_smfmac_f32_16x16x64_bf16 v[48:51], v[32:35], a[216:223], v3
  v_cvt_pk_bf16_f32 v64, v44, v45
  v_mfma_f32_16x16x32_bf16 v[84:87], v[80:83], v[76:79], 0
  v_cvt_pk_bf16_f32 v65, v46, v47
  s_waitcnt lgkmcnt(0)
  v_smfmac_f32_16x16x64_bf16 v[88:91], v[76:79], v[96:103], v118
  v_cvt_pk_bf16_f32 v60, v68, v69
  v_cvt_pk_bf16_f32 v61, v70, v71
  v_cvt_pk_bf16_f32 v66, v48, v49
  v_cvt_pk_bf16_f32 v67, v50, v51
  s_nop 1
  v_mfma_f32_16x16x32_bf16 v[72:75], v[64:67], v[4:7], 0
  v_smfmac_f32_16x16x64_bf16 v[92:95], v[76:79], v[104:111], v118
  s_nop 4
  v_cvt_pk_bf16_f32 v62, v72, v73
  v_cvt_pk_bf16_f32 v63, v74, v75
  s_nop 1
  v_mfma_f32_16x16x32_bf16 v[84:87], v[8:11], v[60:63], v[84:87]
  v_smfmac_f32_16x16x64_bf16 v[88:91], v[60:63], v[12:19], v118
  v_smfmac_f32_16x16x64_bf16 v[92:95], v[60:63], v[52:59], v118
  s_nop 1
  v_permlane32_swap_b32 v84, v86
  v_permlane32_swap_b32 v85, v87
  s_nop 0
  v_add_f32 v88, v88, v89
  v_add_f32_dpp v84, v86, v84 quad_perm:[1,0,3,2] row_mask:0xf bank_mask:0xf
  v_add_f32_dpp v85, v87, v85 quad_perm:[1,0,3,2] row_mask:0xf bank_mask:0xf
  v_add_f32 v89, v90, v91
  ds_write2_b32 v113, v84, v85 offset0:0 offset1:4
  ds_write2_b32 v112, v88, v89 offset0:0 offset1:128
  v_add_f32 v90, v92, v93
  v_add_f32 v91, v94, v95
  ds_write2_b32 v112, v90, v91 offset0:64 offset1:192
  v_cmp_u_f32 vcc, v88, v89
  s_cbranch_vccnz cA_sc0_retry
cA_sc0_cont:
  s_waitcnt lgkmcnt(0)
  s_barrier
  ds_read_b128 v[36:39], v114
  ds_read_b128 v[44:47], v115
  s_waitcnt lgkmcnt(0)
  v_add_f32 v36, v36, v38
  v_add_f32 v37, v37, v39
  v_add_f32 v44, v44, v45
  v_add_f32 v46, v46, v47
  v_add_f32 v44, v44, v46
  v_add_f32 v36, v36, v37
  v_exp_f32 v49, v44
  v_exp_f32 v48, v36
  v_add_f32 v50, abs(v36), abs(v44)
  v_fma_f32 v39, v49, s37, v48
  v_cmp_ngt_f32 vcc, s56, v50
  v_cndmask_b32 v41, v48, v49, s[38:39]
  v_add_f32_dpp v39, v39, v39 quad_perm:[1,0,3,2] row_mask:0xf bank_mask:0xf
  v_cndmask_b32 v40, v49, v48, s[38:39]
  v_mov_b32_dpp v46, v41 quad_perm:[1,0,3,2] row_mask:0xf bank_mask:0xf
  v_add_f32_dpp v39, v39, v39 quad_perm:[2,3,0,1] row_mask:0xf bank_mask:0xf
  v_cndmask_b32 v42, v46, v40, s[38:39]
  v_cndmask_b32 v43, v40, v46, s[38:39]
  v_add_f32_dpp v39, v39, v39 row_half_mirror row_mask:0xf bank_mask:0xf
  s_cbranch_vccnz cA_sc0_slow
  s_nop 0
  v_add_f32_dpp v47, v39, v39 row_mirror row_mask:0xf bank_mask:0xf
  v_add_f32_dpp v39, v39, v39 row_mirror row_mask:0xf bank_mask:0xf
  s_nop 1
  v_permlane16_swap_b32 v39, v47
  v_add_f32 v39, v39, v47
  v_rcp_f32 v39, v39
  s_mov_b64 exec, s[28:29]
  v_mul_f32 v42, v42, v39
  v_mul_f32 v43, v43, v39
  v_cvt_pk_bf16_f32 v42, v42, v43
cA_sc0_pst:
  buffer_store_dword v42, v1, s[8:11], s20 offen
  s_mov_b64 exec, -1
  s_barrier
  s_add_u32 s24, s24, 28672
  s_add_u32 s35, s35, 28672
  s_xor_b32 s25, s25, 28672
  s_add_u32 m0, s25, 0
  s_add_u32 m0, s25, 4096
  s_add_u32 s22, s24, 4096
  buffer_load_dwordx4 v2, s[8:11], s22 offen offset:0 sc1 lds
  s_nop 5
  buffer_load_dwordx4 v2, s[8:11], s22 offen offset:1024 sc1 lds
  s_nop 5
  buffer_load_dwordx4 v2, s[8:11], s22 offen offset:2048 sc1 lds
  s_nop 5
  v_xor_b32 v116, 28672, v116
  v_add_u32 v117, s57, v117
  s_sub_u32 s57, 0, s57
  s_add_u32 s19, s19, 1
  s_mov_b32 s20, s21
  s_cmp_lt_u32 s19, 63
  s_cbranch_scc1 cA_sc0_loop
  s_branch cA_done
cA_sc0_slow:
  v_max_f32 v50, v36, v44
  s_nop 1
  v_max_f32_dpp v50, v50, v50 quad_perm:[1,0,3,2] row_mask:0xf bank_mask:0xf
  s_nop 1
  v_max_f32_dpp v50, v50, v50 quad_perm:[2,3,0,1] row_mask:0xf bank_mask:0xf
  s_nop 1
  v_max_f32_dpp v50, v50, v50 row_half_mirror row_mask:0xf bank_mask:0xf
  s_nop 1
  v_max_f32_dpp v50, v50, v50 row_mirror row_mask:0xf bank_mask:0xf
  v_mov_b32 v47, v50
  s_nop 1
  v_permlane16_swap_b32 v50, v47
  v_max_f32 v50, v50, v47
  v_sub_f32 v48, v36, v50
  v_sub_f32 v49, v44, v50
  v_exp_f32 v48, v48
  v_exp_f32 v49, v49
  s_add_u32 s31, s31, 0x100
  v_fma_f32 v39, v49, s37, v48
  v_cndmask_b32 v41, v48, v49, s[38:39]
  s_nop 0
  v_add_f32_dpp v39, v39, v39 quad_perm:[1,0,3,2] row_mask:0xf bank_mask:0xf
  v_cndmask_b32 v40, v49, v48, s[38:39]
  v_mov_b32_dpp v46, v41 quad_perm:[1,0,3,2] row_mask:0xf bank_mask:0xf
  v_add_f32_dpp v39, v39, v39 quad_perm:[2,3,0,1] row_mask:0xf bank_mask:0xf
  v_cndmask_b32 v42, v46, v40, s[38:39]
  v_cndmask_b32 v43, v40, v46, s[38:39]
  v_add_f32_dpp v39, v39, v39 row_half_mirror row_mask:0xf bank_mask:0xf
  s_nop 1
  v_add_f32_dpp v47, v39, v39 row_mirror row_mask:0xf bank_mask:0xf
  v_add_f32_dpp v39, v39, v39 row_mirror row_mask:0xf bank_mask:0xf
  s_nop 1
  v_permlane16_swap_b32 v39, v47
  v_add_f32 v39, v39, v47
  v_rcp_f32 v39, v39
  s_mov_b64 exec, s[28:29]
  v_mul_f32 v42, v42, v39
  v_mul_f32 v43, v43, v39
  v_cvt_pk_bf16_f32 v42, v42, v43
  v_min_u32 v42, -2, v42
  s_branch cA_sc0_pst
cA_sc0_retry:
  s_cmp_lg_u32 s62, 0
  s_cbranch_scc1 cA_sc0_cont
  s_waitcnt vmcnt(0) lgkmcnt(0)
cA_sc0_rv:
  buffer_load_dwordx4 v[8:11], v2, s[8:11], s20 offen offset:0 sc1
  buffer_load_dwordx4 v[12:15], v2, s[8:11], s20 offen offset:1024 sc1
  buffer_load_dwordx4 v[16:19], v2, s[8:11], s20 offen offset:2048 sc1
  buffer_load_dwordx4 v[20:23], v2, s[8:11], s20 offen offset:3072 sc1
  buffer_load_dwordx4 v[24:27], v2, s[8:11], s23 offen offset:0 sc1
  buffer_load_dwordx4 v[28:31], v2, s[8:11], s23 offen offset:1024 sc1
  buffer_load_dwordx4 v[32:35], v2, s[8:11], s23 offen offset:2048 sc1
  s_waitcnt vmcnt(0)
  v_max3_u32 v68, v8, v9, v10
  v_max3_u32 v68, v68, v11, v12
  v_max3_u32 v68, v68, v13, v14
  v_max3_u32 v68, v68, v15, v16
  v_max3_u32 v68, v68, v17, v18
  v_max3_u32 v68, v68, v19, v20
  v_max3_u32 v68, v68, v21, v22
  v_max3_u32 v68, v68, v23, v24
  v_max3_u32 v68, v68, v25, v26
  v_max3_u32 v68, v68, v27, v28
  v_max3_u32 v68, v68, v29, v30
  v_max3_u32 v68, v68, v31, v32
  v_max3_u32 v68, v68, v33, v34
  v_max_u32 v68, v68, v35
  v_cmp_eq_u32 vcc, -1, v68
  s_cbranch_vccz cA_sc0_rk
  s_add_u32 s30, s30, 1
  s_cmp_lt_u32 s30, 400000
  s_cbranch_scc1 cA_sc0_rv
  s_branch cA_abort
cA_sc0_rk:
  s_mov_b32 s62, 1
  v_mov_b32 v36, 0
  v_mov_b32 v37, 0
  v_mov_b32 v38, 0
  v_mov_b32 v39, 0
  v_mov_b32 v40, 0
  v_mov_b32 v41, 0
  v_mov_b32 v42, 0
  v_mov_b32 v43, 0
  v_mov_b32 v44, 0
  v_mov_b32 v45, 0
  v_mov_b32 v46, 0
  v_mov_b32 v47, 0
  v_mov_b32 v48, 0
  v_mov_b32 v49, 0
  v_mov_b32 v50, 0
  v_mov_b32 v51, 0
  v_mov_b32 v52, 0
  v_mov_b32 v53, 0
  v_mov_b32 v54, 0
  v_mov_b32 v55, 0
  v_mov_b32 v56, 0
  v_mov_b32 v57, 0
  v_mov_b32 v58, 0
  v_mov_b32 v59, 0
  v_mov_b32 v60, 0
  v_mov_b32 v61, 0
  v_mov_b32 v62, 0
  v_mov_b32 v63, 0
  v_mov_b32 v88, 0
  v_mov_b32 v89, 0
  v_mov_b32 v90, 0
  v_mov_b32 v91, 0
  v_mov_b32 v92, 0
  v_mov_b32 v93, 0
  v_mov_b32 v94, 0
  v_mov_b32 v95, 0
  v_mov_b32 v66, 0
  v_mov_b32 v67, 0
  s_add_u32 s31, s31, 1
  ds_read_b128 v[96:99], v117 offset:0
  ds_read_b128 v[100:103], v117 offset:1024
  ds_read_b128 v[104:107], v117 offset:14336
  ds_read_b128 v[108:111], v117 offset:15360
  v_smfmac_f32_16x16x64_bf16 v[36:39], v[8:11], a[0:7], v3
  v_smfmac_f32_16x16x64_bf16 v[40:43], v[8:11], a[56:63], v3
  v_smfmac_f32_16x16x64_bf16 v[44:47], v[8:11], a[112:119], v3
  v_smfmac_f32_16x16x64_bf16 v[48:51], v[8:11], a[168:175], v3
  v_smfmac_f32_16x16x64_bf16 v[52:55], v[8:11], a[224:231], v3
  v_smfmac_f32_16x16x64_bf16 v[56:59], v[8:11], v[144:151], v3
  v_smfmac_f32_16x16x64_bf16 v[60:63], v[8:11], v[200:207], v3
  v_smfmac_f32_16x16x64_bf16 v[36:39], v[12:15], a[8:15], v3
  v_smfmac_f32_16x16x64_bf16 v[40:43], v[12:15], a[64:71], v3
  v_smfmac_f32_16x16x64_bf16 v[44:47], v[12:15], a[120:127], v3
  v_smfmac_f32_16x16x64_bf16 v[48:51], v[12:15], a[176:183], v3
  v_smfmac_f32_16x16x64_bf16 v[52:55], v[12:15], a[232:239], v3
  v_smfmac_f32_16x16x64_bf16 v[56:59], v[12:15], v[152:159], v3
  v_smfmac_f32_16x16x64_bf16 v[60:63], v[12:15], v[208:215], v3
  v_smfmac_f32_16x16x64_bf16 v[36:39], v[16:19], a[16:23], v3
  v_smfmac_f32_16x16x64_bf16 v[40:43], v[16:19], a[72:79], v3
  v_smfmac_f32_16x16x64_bf16 v[44:47], v[16:19], a[128:135], v3
  v_smfmac_f32_16x16x64_bf16 v[48:51], v[16:19], a[184:191], v3
  v_smfmac_f32_16x16x64_bf16 v[52:55], v[16:19], a[240:247], v3
  v_smfmac_f32_16x16x64_bf16 v[56:59], v[16:19], v[160:167], v3
  v_smfmac_f32_16x16x64_bf16 v[60:63], v[16:19], v[216:223], v3
  v_smfmac_f32_16x16x64_bf16 v[36:39], v[20:23], a[24:31], v3
  v_smfmac_f32_16x16x64_bf16 v[40:43], v[20:23], a[80:87], v3
  v_smfmac_f32_16x16x64_bf16 v[44:47], v[20:23], a[136:143], v3
  v_smfmac_f32_16x16x64_bf16 v[48:51], v[20:23], a[192:199], v3
  v_smfmac_f32_16x16x64_bf16 v[52:55], v[20:23], a[248:255], v3
  v_smfmac_f32_16x16x64_bf16 v[56:59], v[20:23], v[168:175], v3
  v_smfmac_f32_16x16x64_bf16 v[60:63], v[20:23], v[224:231], v3
  s_xor_b32 s58, s25, 28672
  s_add_u32 s59, s24, 28672
  s_add_u32 m0, s58, 0
  s_branch cA_sc0_ph2
.p2align 6

cA_sc1_loop:
  s_add_u32 s23, s20, 4096
  s_add_u32 s21, s20, 20480
  v_mov_b32 v48, 0
  v_mov_b32 v49, 0
  v_mov_b32 v50, 0
  v_mov_b32 v51, 0
  v_mov_b32 v52, 0
  v_mov_b32 v53, 0
  v_mov_b32 v54, 0
  v_mov_b32 v55, 0
  v_mov_b32 v56, 0
  v_mov_b32 v57, 0
  v_mov_b32 v58, 0
  v_mov_b32 v59, 0
  v_mov_b32 v60, 0
  v_mov_b32 v61, 0
  v_mov_b32 v62, 0
  v_mov_b32 v63, 0
  v_mov_b32 v88, 0
  v_mov_b32 v89, 0
  v_mov_b32 v90, 0
  v_mov_b32 v91, 0
  v_mov_b32 v92, 0
  v_mov_b32 v93, 0
  v_mov_b32 v94, 0
  v_mov_b32 v95, 0
  v_mov_b32 v64, 0
  v_mov_b32 v65, 0
  s_mov_b32 s30, 0
  s_mov_b32 s62, 0
  s_waitcnt vmcnt(0)
  s_barrier
cA_sc1_ld:
  buffer_load_dwordx4 v[8:11], v2, s[8:11], s20 offen offset:0
  v_mov_b32 v36, 0
  v_mov_b32 v37, 0
  v_mov_b32 v38, 0
  v_mov_b32 v39, 0
  buffer_load_dwordx4 v[12:15], v2, s[8:11], s20 offen offset:1024
  v_mov_b32 v40, 0
  v_mov_b32 v41, 0
  v_mov_b32 v42, 0
  v_mov_b32 v43, 0
  buffer_load_dwordx4 v[16:19], v2, s[8:11], s20 offen offset:2048
  v_mov_b32 v44, 0
  v_mov_b32 v45, 0
  v_mov_b32 v46, 0
  v_mov_b32 v47, 0
  ds_read_b128 v[96:99], v117 offset:0
  ds_read_b128 v[100:103], v117 offset:1024
  ds_read_b128 v[104:107], v117 offset:14336
  ds_read_b128 v[108:111], v117 offset:15360
  s_waitcnt vmcnt(2)
  v_smfmac_f32_16x16x64_bf16 v[36:39], v[8:11], a[0:7], v3
  v_smfmac_f32_16x16x64_bf16 v[40:43], v[8:11], a[56:63], v3
  buffer_load_dwordx4 v[20:23], v2, s[8:11], s20 offen offset:3072
  v_smfmac_f32_16x16x64_bf16 v[44:47], v[8:11], a[112:119], v3
  v_smfmac_f32_16x16x64_bf16 v[48:51], v[8:11], a[168:175], v3
  v_smfmac_f32_16x16x64_bf16 v[52:55], v[8:11], a[224:231], v3
  buffer_load_dwordx4 v[24:27], v2, s[8:11], s23 offen offset:0
  v_smfmac_f32_16x16x64_bf16 v[56:59], v[8:11], v[144:151], v3
  v_smfmac_f32_16x16x64_bf16 v[60:63], v[8:11], v[200:207], v3
  s_waitcnt vmcnt(3)
  v_smfmac_f32_16x16x64_bf16 v[36:39], v[12:15], a[8:15], v3
  v_smfmac_f32_16x16x64_bf16 v[40:43], v[12:15], a[64:71], v3
  buffer_load_dwordx4 v[28:31], v2, s[8:11], s23 offen offset:1024
  v_smfmac_f32_16x16x64_bf16 v[44:47], v[12:15], a[120:127], v3
  v_smfmac_f32_16x16x64_bf16 v[48:51], v[12:15], a[176:183], v3
  v_smfmac_f32_16x16x64_bf16 v[52:55], v[12:15], a[232:239], v3
  buffer_load_dwordx4 v[32:35], v2, s[8:11], s23 offen offset:2048
  v_smfmac_f32_16x16x64_bf16 v[56:59], v[12:15], v[152:159], v3
  v_smfmac_f32_16x16x64_bf16 v[60:63], v[12:15], v[208:215], v3
  s_waitcnt vmcnt(4)
  v_smfmac_f32_16x16x64_bf16 v[36:39], v[16:19], a[16:23], v3
  s_xor_b32 s58, s25, 28672
  s_add_u32 s59, s24, 28672
  s_add_u32 m0, s58, 7168
  v_smfmac_f32_16x16x64_bf16 v[40:43], v[16:19], a[72:79], v3
  buffer_load_dwordx4 v2, s[8:11], s59 offen offset:0 sc1 lds
  v_smfmac_f32_16x16x64_bf16 v[44:47], v[16:19], a[128:135], v3
  v_smfmac_f32_16x16x64_bf16 v[48:51], v[16:19], a[184:191], v3
  v_smfmac_f32_16x16x64_bf16 v[52:55], v[16:19], a[240:247], v3
  v_smfmac_f32_16x16x64_bf16 v[56:59], v[16:19], v[160:167], v3
  buffer_load_dwordx4 v2, s[8:11], s59 offen offset:1024 sc1 lds
  v_smfmac_f32_16x16x64_bf16 v[60:63], v[16:19], v[216:223], v3
  s_waitcnt vmcnt(5)
  v_smfmac_f32_16x16x64_bf16 v[36:39], v[20:23], a[24:31], v3
  v_smfmac_f32_16x16x64_bf16 v[40:43], v[20:23], a[80:87], v3
  v_smfmac_f32_16x16x64_bf16 v[44:47], v[20:23], a[136:143], v3
  buffer_load_dwordx4 v2, s[8:11], s59 offen offset:2048 sc1 lds
  v_smfmac_f32_16x16x64_bf16 v[48:51], v[20:23], a[192:199], v3
  v_smfmac_f32_16x16x64_bf16 v[52:55], v[20:23], a[248:255], v3
  v_smfmac_f32_16x16x64_bf16 v[56:59], v[20:23], v[168:175], v3
  v_smfmac_f32_16x16x64_bf16 v[60:63], v[20:23], v[224:231], v3
  buffer_load_dwordx4 v2, s[8:11], s59 offen offset:3072 sc1 lds
  s_waitcnt vmcnt(4)
cA_sc1_ph2:
  v_smfmac_f32_16x16x64_bf16 v[60:63], v[24:27], v[232:239], v3
  ds_read_b128 v[16:19], v116 offset:2048
  ds_read_b128 v[20:23], v116 offset:3072
  v_smfmac_f32_16x16x64_bf16 v[60:63], v[28:31], v[240:247], v3
  buffer_load_dword v119, v0, s[8:11], s20 offen sc1
  v_smfmac_f32_16x16x64_bf16 v[60:63], v[32:35], v[248:255], v3
  v_mov_b32 v80, v26
  v_smfmac_f32_16x16x64_bf16 v[52:55], v[24:27], v[120:127], v3
  v_mov_b32 v81, v27
  v_smfmac_f32_16x16x64_bf16 v[52:55], v[28:31], v[128:135], v3
  v_mov_b32 v82, v32
  v_smfmac_f32_16x16x64_bf16 v[52:55], v[32:35], v[136:143], v3
  v_cvt_pk_bf16_f32 v66, v60, v61
  v_smfmac_f32_16x16x64_bf16 v[56:59], v[24:27], v[176:183], v3
  v_cvt_pk_bf16_f32 v67, v62, v63
  v_smfmac_f32_16x16x64_bf16 v[56:59], v[28:31], v[184:191], v3
  v_mov_b32 v83, v33
  v_mfma_f32_16x16x32_bf16 v[68:71], v[64:67], v[4:7], 0
  v_smfmac_f32_16x16x64_bf16 v[56:59], v[32:35], v[192:199], v3
  v_cvt_pk_bf16_f32 v64, v52, v53
  v_smfmac_f32_16x16x64_bf16 v[36:39], v[24:27], a[32:39], v3
  v_cvt_pk_bf16_f32 v65, v54, v55
  v_smfmac_f32_16x16x64_bf16 v[36:39], v[28:31], a[40:47], v3
  v_cvt_pk_bf16_f32 v78, v68, v69
  v_smfmac_f32_16x16x64_bf16 v[36:39], v[32:35], a[48:55], v3
  v_cvt_pk_bf16_f32 v79, v70, v71
  v_cvt_pk_bf16_f32 v66, v56, v57
  v_smfmac_f32_16x16x64_bf16 v[40:43], v[24:27], a[88:95], v3
  v_cvt_pk_bf16_f32 v67, v58, v59
  v_smfmac_f32_16x16x64_bf16 v[40:43], v[28:31], a[96:103], v3
  v_mfma_f32_16x16x32_bf16 v[72:75], v[64:67], v[4:7], 0
  ds_read_b128 v[52:55], v116 offset:16384
  ds_read_b128 v[56:59], v116 offset:17408
  v_smfmac_f32_16x16x64_bf16 v[40:43], v[32:35], a[104:111], v3
  v_cvt_pk_bf16_f32 v64, v36, v37
  v_smfmac_f32_16x16x64_bf16 v[44:47], v[24:27], a[144:151], v3
  v_cvt_pk_bf16_f32 v65, v38, v39
  v_smfmac_f32_16x16x64_bf16 v[44:47], v[28:31], a[152:159], v3
  v_cvt_pk_bf16_f32 v76, v72, v73
  v_smfmac_f32_16x16x64_bf16 v[44:47], v[32:35], a[160:167], v3
  v_cvt_pk_bf16_f32 v77, v74, v75
  v_cvt_pk_bf16_f32 v66, v40, v41
  v_smfmac_f32_16x16x64_bf16 v[48:51], v[24:27], a[200:207], v3
  v_cvt_pk_bf16_f32 v67, v42, v43
  v_smfmac_f32_16x16x64_bf16 v[48:51], v[28:31], a[208:215], v3
  v_mfma_f32_16x16x32_bf16 v[68:71], v[64:67], v[4:7], 0
  v_smfmac_f32_16x16x64_bf16 v[48:51], v[32:35], a[216:223], v3
  v_cvt_pk_bf16_f32 v64, v44, v45
  v_mfma_f32_16x16x32_bf16 v[84:87], v[80:83], v[76:79], 0
  v_cvt_pk_bf16_f32 v65, v46, v47
  s_waitcnt lgkmcnt(0)
  v_smfmac_f32_16x16x64_bf16 v[88:91], v[76:79], v[96:103], v118
  v_cvt_pk_bf16_f32 v60, v68, v69
  v_cvt_pk_bf16_f32 v61, v70, v71
  v_cvt_pk_bf16_f32 v66, v48, v49
  v_cvt_pk_bf16_f32 v67, v50, v51
  s_nop 1
  v_mfma_f32_16x16x32_bf16 v[72:75], v[64:67], v[4:7], 0
  v_smfmac_f32_16x16x64_bf16 v[92:95], v[76:79], v[104:111], v118
  s_nop 4
  v_cvt_pk_bf16_f32 v62, v72, v73
  v_cvt_pk_bf16_f32 v63, v74, v75
  s_nop 1
  v_mfma_f32_16x16x32_bf16 v[84:87], v[12:15], v[60:63], v[84:87]
  v_smfmac_f32_16x16x64_bf16 v[88:91], v[60:63], v[16:23], v118
  v_smfmac_f32_16x16x64_bf16 v[92:95], v[60:63], v[52:59], v118
  s_nop 1
  v_permlane32_swap_b32 v84, v86
  v_permlane32_swap_b32 v85, v87
  s_nop 0
  v_add_f32 v88, v88, v89
  v_add_f32_dpp v84, v86, v84 quad_perm:[1,0,3,2] row_mask:0xf bank_mask:0xf
  v_add_f32_dpp v85, v87, v85 quad_perm:[1,0,3,2] row_mask:0xf bank_mask:0xf
  v_add_f32 v89, v90, v91
  ds_write2_b32 v113, v84, v85 offset0:0 offset1:4
  ds_write2_b32 v112, v88, v89 offset0:0 offset1:128
  v_add_f32 v90, v92, v93
  v_add_f32 v91, v94, v95
  ds_write2_b32 v112, v90, v91 offset0:64 offset1:192
  v_cmp_u_f32 vcc, v88, v89
  s_cbranch_vccnz cA_sc1_retry
cA_sc1_cont:
  s_waitcnt lgkmcnt(0)
  s_barrier
  ds_read_b128 v[36:39], v114
  ds_read_b128 v[44:47], v115
  s_waitcnt lgkmcnt(0)
  v_add_f32 v36, v36, v38
  v_add_f32 v37, v37, v39
  v_add_f32 v44, v44, v45
  v_add_f32 v46, v46, v47
  v_add_f32 v44, v44, v46
  v_add_f32 v36, v36, v37
  v_exp_f32 v49, v44
  v_exp_f32 v48, v36
  v_add_f32 v50, abs(v36), abs(v44)
  v_fma_f32 v39, v49, s37, v48
  v_cmp_ngt_f32 vcc, s56, v50
  v_cndmask_b32 v41, v48, v49, s[38:39]
  v_add_f32_dpp v39, v39, v39 quad_perm:[1,0,3,2] row_mask:0xf bank_mask:0xf
  v_cndmask_b32 v40, v49, v48, s[38:39]
  v_mov_b32_dpp v46, v41 quad_perm:[1,0,3,2] row_mask:0xf bank_mask:0xf
  v_add_f32_dpp v39, v39, v39 quad_perm:[2,3,0,1] row_mask:0xf bank_mask:0xf
  v_cndmask_b32 v42, v46, v40, s[38:39]
  v_cndmask_b32 v43, v40, v46, s[38:39]
  v_add_f32_dpp v39, v39, v39 row_half_mirror row_mask:0xf bank_mask:0xf
  s_cbranch_vccnz cA_sc1_slow
  s_nop 0
  v_add_f32_dpp v47, v39, v39 row_mirror row_mask:0xf bank_mask:0xf
  v_add_f32_dpp v39, v39, v39 row_mirror row_mask:0xf bank_mask:0xf
  s_nop 1
  v_permlane16_swap_b32 v39, v47
  v_add_f32 v39, v39, v47
  v_rcp_f32 v39, v39
  s_mov_b64 exec, s[28:29]
  v_mul_f32 v42, v42, v39
  v_mul_f32 v43, v43, v39
  v_cvt_pk_bf16_f32 v42, v42, v43
cA_sc1_pst:
  buffer_store_dword v42, v1, s[8:11], s20 offen
  s_mov_b64 exec, -1
  s_barrier
  s_add_u32 s24, s24, 28672
  s_add_u32 s35, s35, 28672
  s_xor_b32 s25, s25, 28672
  s_add_u32 m0, s25, 7168
  s_add_u32 m0, s25, 11264
  s_add_u32 s22, s24, 4096
  buffer_load_dwordx4 v2, s[8:11], s22 offen offset:0 sc1 lds
  s_nop 5
  buffer_load_dwordx4 v2, s[8:11], s22 offen offset:1024 sc1 lds
  s_nop 5
  buffer_load_dwordx4 v2, s[8:11], s22 offen offset:2048 sc1 lds
  s_nop 5
  v_xor_b32 v116, 28672, v116
  v_add_u32 v117, s57, v117
  s_sub_u32 s57, 0, s57
  s_add_u32 s19, s19, 1
  s_mov_b32 s20, s21
  s_cmp_lt_u32 s19, 63
  s_cbranch_scc1 cA_sc1_loop
  s_branch cA_done
cA_sc1_slow:
  v_max_f32 v50, v36, v44
  s_nop 1
  v_max_f32_dpp v50, v50, v50 quad_perm:[1,0,3,2] row_mask:0xf bank_mask:0xf
  s_nop 1
  v_max_f32_dpp v50, v50, v50 quad_perm:[2,3,0,1] row_mask:0xf bank_mask:0xf
  s_nop 1
  v_max_f32_dpp v50, v50, v50 row_half_mirror row_mask:0xf bank_mask:0xf
  s_nop 1
  v_max_f32_dpp v50, v50, v50 row_mirror row_mask:0xf bank_mask:0xf
  v_mov_b32 v47, v50
  s_nop 1
  v_permlane16_swap_b32 v50, v47
  v_max_f32 v50, v50, v47
  v_sub_f32 v48, v36, v50
  v_sub_f32 v49, v44, v50
  v_exp_f32 v48, v48
  v_exp_f32 v49, v49
  s_add_u32 s31, s31, 0x100
  v_fma_f32 v39, v49, s37, v48
  v_cndmask_b32 v41, v48, v49, s[38:39]
  s_nop 0
  v_add_f32_dpp v39, v39, v39 quad_perm:[1,0,3,2] row_mask:0xf bank_mask:0xf
  v_cndmask_b32 v40, v49, v48, s[38:39]
  v_mov_b32_dpp v46, v41 quad_perm:[1,0,3,2] row_mask:0xf bank_mask:0xf
  v_add_f32_dpp v39, v39, v39 quad_perm:[2,3,0,1] row_mask:0xf bank_mask:0xf
  v_cndmask_b32 v42, v46, v40, s[38:39]
  v_cndmask_b32 v43, v40, v46, s[38:39]
  v_add_f32_dpp v39, v39, v39 row_half_mirror row_mask:0xf bank_mask:0xf
  s_nop 1
  v_add_f32_dpp v47, v39, v39 row_mirror row_mask:0xf bank_mask:0xf
  v_add_f32_dpp v39, v39, v39 row_mirror row_mask:0xf bank_mask:0xf
  s_nop 1
  v_permlane16_swap_b32 v39, v47
  v_add_f32 v39, v39, v47
  v_rcp_f32 v39, v39
  s_mov_b64 exec, s[28:29]
  v_mul_f32 v42, v42, v39
  v_mul_f32 v43, v43, v39
  v_cvt_pk_bf16_f32 v42, v42, v43
  v_min_u32 v42, -2, v42
  s_branch cA_sc1_pst
cA_sc1_retry:
  s_cmp_lg_u32 s62, 0
  s_cbranch_scc1 cA_sc1_cont
  s_waitcnt vmcnt(0) lgkmcnt(0)
cA_sc1_rv:
  buffer_load_dwordx4 v[8:11], v2, s[8:11], s20 offen offset:0 sc1
  buffer_load_dwordx4 v[12:15], v2, s[8:11], s20 offen offset:1024 sc1
  buffer_load_dwordx4 v[16:19], v2, s[8:11], s20 offen offset:2048 sc1
  buffer_load_dwordx4 v[20:23], v2, s[8:11], s20 offen offset:3072 sc1
  buffer_load_dwordx4 v[24:27], v2, s[8:11], s23 offen offset:0 sc1
  buffer_load_dwordx4 v[28:31], v2, s[8:11], s23 offen offset:1024 sc1
  buffer_load_dwordx4 v[32:35], v2, s[8:11], s23 offen offset:2048 sc1
  s_waitcnt vmcnt(0)
  v_max3_u32 v68, v8, v9, v10
  v_max3_u32 v68, v68, v11, v12
  v_max3_u32 v68, v68, v13, v14
  v_max3_u32 v68, v68, v15, v16
  v_max3_u32 v68, v68, v17, v18
  v_max3_u32 v68, v68, v19, v20
  v_max3_u32 v68, v68, v21, v22
  v_max3_u32 v68, v68, v23, v24
  v_max3_u32 v68, v68, v25, v26
  v_max3_u32 v68, v68, v27, v28
  v_max3_u32 v68, v68, v29, v30
  v_max3_u32 v68, v68, v31, v32
  v_max3_u32 v68, v68, v33, v34
  v_max_u32 v68, v68, v35
  v_cmp_eq_u32 vcc, -1, v68
  s_cbranch_vccz cA_sc1_rk
  s_add_u32 s30, s30, 1
  s_cmp_lt_u32 s30, 400000
  s_cbranch_scc1 cA_sc1_rv
  s_branch cA_abort
cA_sc1_rk:
  s_mov_b32 s62, 1
  v_mov_b32 v36, 0
  v_mov_b32 v37, 0
  v_mov_b32 v38, 0
  v_mov_b32 v39, 0
  v_mov_b32 v40, 0
  v_mov_b32 v41, 0
  v_mov_b32 v42, 0
  v_mov_b32 v43, 0
  v_mov_b32 v44, 0
  v_mov_b32 v45, 0
  v_mov_b32 v46, 0
  v_mov_b32 v47, 0
  v_mov_b32 v48, 0
  v_mov_b32 v49, 0
  v_mov_b32 v50, 0
  v_mov_b32 v51, 0
  v_mov_b32 v52, 0
  v_mov_b32 v53, 0
  v_mov_b32 v54, 0
  v_mov_b32 v55, 0
  v_mov_b32 v56, 0
  v_mov_b32 v57, 0
  v_mov_b32 v58, 0
  v_mov_b32 v59, 0
  v_mov_b32 v60, 0
  v_mov_b32 v61, 0
  v_mov_b32 v62, 0
  v_mov_b32 v63, 0
  v_mov_b32 v88, 0
  v_mov_b32 v89, 0
  v_mov_b32 v90, 0
  v_mov_b32 v91, 0
  v_mov_b32 v92, 0
  v_mov_b32 v93, 0
  v_mov_b32 v94, 0
  v_mov_b32 v95, 0
  v_mov_b32 v64, 0
  v_mov_b32 v65, 0
  s_add_u32 s31, s31, 1
  ds_read_b128 v[96:99], v117 offset:0
  ds_read_b128 v[100:103], v117 offset:1024
  ds_read_b128 v[104:107], v117 offset:14336
  ds_read_b128 v[108:111], v117 offset:15360
  v_smfmac_f32_16x16x64_bf16 v[36:39], v[8:11], a[0:7], v3
  v_smfmac_f32_16x16x64_bf16 v[40:43], v[8:11], a[56:63], v3
  v_smfmac_f32_16x16x64_bf16 v[44:47], v[8:11], a[112:119], v3
  v_smfmac_f32_16x16x64_bf16 v[48:51], v[8:11], a[168:175], v3
  v_smfmac_f32_16x16x64_bf16 v[52:55], v[8:11], a[224:231], v3
  v_smfmac_f32_16x16x64_bf16 v[56:59], v[8:11], v[144:151], v3
  v_smfmac_f32_16x16x64_bf16 v[60:63], v[8:11], v[200:207], v3
  v_smfmac_f32_16x16x64_bf16 v[36:39], v[12:15], a[8:15], v3
  v_smfmac_f32_16x16x64_bf16 v[40:43], v[12:15], a[64:71], v3
  v_smfmac_f32_16x16x64_bf16 v[44:47], v[12:15], a[120:127], v3
  v_smfmac_f32_16x16x64_bf16 v[48:51], v[12:15], a[176:183], v3
  v_smfmac_f32_16x16x64_bf16 v[52:55], v[12:15], a[232:239], v3
  v_smfmac_f32_16x16x64_bf16 v[56:59], v[12:15], v[152:159], v3
  v_smfmac_f32_16x16x64_bf16 v[60:63], v[12:15], v[208:215], v3
  v_smfmac_f32_16x16x64_bf16 v[36:39], v[16:19], a[16:23], v3
  v_smfmac_f32_16x16x64_bf16 v[40:43], v[16:19], a[72:79], v3
  v_smfmac_f32_16x16x64_bf16 v[44:47], v[16:19], a[128:135], v3
  v_smfmac_f32_16x16x64_bf16 v[48:51], v[16:19], a[184:191], v3
  v_smfmac_f32_16x16x64_bf16 v[52:55], v[16:19], a[240:247], v3
  v_smfmac_f32_16x16x64_bf16 v[56:59], v[16:19], v[160:167], v3
  v_smfmac_f32_16x16x64_bf16 v[60:63], v[16:19], v[216:223], v3
  v_smfmac_f32_16x16x64_bf16 v[36:39], v[20:23], a[24:31], v3
  v_smfmac_f32_16x16x64_bf16 v[40:43], v[20:23], a[80:87], v3
  v_smfmac_f32_16x16x64_bf16 v[44:47], v[20:23], a[136:143], v3
  v_smfmac_f32_16x16x64_bf16 v[48:51], v[20:23], a[192:199], v3
  v_smfmac_f32_16x16x64_bf16 v[52:55], v[20:23], a[248:255], v3
  v_smfmac_f32_16x16x64_bf16 v[56:59], v[20:23], v[168:175], v3
  v_smfmac_f32_16x16x64_bf16 v[60:63], v[20:23], v[224:231], v3
  s_xor_b32 s58, s25, 28672
  s_add_u32 s59, s24, 28672
  s_add_u32 m0, s58, 7168
  s_branch cA_sc1_ph2
.p2align 6

cA_sc2_loop:
  s_add_u32 s23, s20, 4096
  s_add_u32 s21, s20, 20480
  v_mov_b32 v48, 0
  v_mov_b32 v49, 0
  v_mov_b32 v50, 0
  v_mov_b32 v51, 0
  v_mov_b32 v52, 0
  v_mov_b32 v53, 0
  v_mov_b32 v54, 0
  v_mov_b32 v55, 0
  v_mov_b32 v56, 0
  v_mov_b32 v57, 0
  v_mov_b32 v58, 0
  v_mov_b32 v59, 0
  v_mov_b32 v60, 0
  v_mov_b32 v61, 0
  v_mov_b32 v62, 0
  v_mov_b32 v63, 0
  v_mov_b32 v88, 0
  v_mov_b32 v89, 0
  v_mov_b32 v90, 0
  v_mov_b32 v91, 0
  v_mov_b32 v92, 0
  v_mov_b32 v93, 0
  v_mov_b32 v94, 0
  v_mov_b32 v95, 0
  v_mov_b32 v66, 0
  v_mov_b32 v67, 0
  s_mov_b32 s30, 0
  s_mov_b32 s62, 0
  s_waitcnt vmcnt(0)
  s_barrier
cA_sc2_ld:
  buffer_load_dwordx4 v[8:11], v2, s[8:11], s20 offen offset:0
  v_mov_b32 v36, 0
  v_mov_b32 v37, 0
  v_mov_b32 v38, 0
  v_mov_b32 v39, 0
  buffer_load_dwordx4 v[12:15], v2, s[8:11], s20 offen offset:1024
  v_mov_b32 v40, 0
  v_mov_b32 v41, 0
  v_mov_b32 v42, 0
  v_mov_b32 v43, 0
  buffer_load_dwordx4 v[16:19], v2, s[8:11], s20 offen offset:2048
  v_mov_b32 v44, 0
  v_mov_b32 v45, 0
  v_mov_b32 v46, 0
  v_mov_b32 v47, 0
  ds_read_b128 v[96:99], v117 offset:0
  ds_read_b128 v[100:103], v117 offset:1024
  ds_read_b128 v[104:107], v117 offset:14336
  ds_read_b128 v[108:111], v117 offset:15360
  s_waitcnt vmcnt(2)
  v_smfmac_f32_16x16x64_bf16 v[36:39], v[8:11], a[0:7], v3
  v_smfmac_f32_16x16x64_bf16 v[40:43], v[8:11], a[56:63], v3
  buffer_load_dwordx4 v[20:23], v2, s[8:11], s20 offen offset:3072
  v_smfmac_f32_16x16x64_bf16 v[44:47], v[8:11], a[112:119], v3
  v_smfmac_f32_16x16x64_bf16 v[48:51], v[8:11], a[168:175], v3
  v_smfmac_f32_16x16x64_bf16 v[52:55], v[8:11], a[224:231], v3
  buffer_load_dwordx4 v[24:27], v2, s[8:11], s23 offen offset:0
  v_smfmac_f32_16x16x64_bf16 v[56:59], v[8:11], v[144:151], v3
  v_smfmac_f32_16x16x64_bf16 v[60:63], v[8:11], v[200:207], v3
  s_waitcnt vmcnt(3)
  v_smfmac_f32_16x16x64_bf16 v[36:39], v[12:15], a[8:15], v3
  v_smfmac_f32_16x16x64_bf16 v[40:43], v[12:15], a[64:71], v3
  buffer_load_dwordx4 v[28:31], v2, s[8:11], s23 offen offset:1024
  v_smfmac_f32_16x16x64_bf16 v[44:47], v[12:15], a[120:127], v3
  v_smfmac_f32_16x16x64_bf16 v[48:51], v[12:15], a[176:183], v3
  v_smfmac_f32_16x16x64_bf16 v[52:55], v[12:15], a[232:239], v3
  buffer_load_dwordx4 v[32:35], v2, s[8:11], s23 offen offset:2048
  v_smfmac_f32_16x16x64_bf16 v[56:59], v[12:15], v[152:159], v3
  v_smfmac_f32_16x16x64_bf16 v[60:63], v[12:15], v[208:215], v3
  s_waitcnt vmcnt(4)
  v_smfmac_f32_16x16x64_bf16 v[36:39], v[16:19], a[16:23], v3
  v_smfmac_f32_16x16x64_bf16 v[40:43], v[16:19], a[72:79], v3
  s_xor_b32 s58, s25, 28672
  s_add_u32 s59, s24, 28672
  s_add_u32 m0, s58, 14336
  v_smfmac_f32_16x16x64_bf16 v[44:47], v[16:19], a[128:135], v3
  buffer_load_dwordx4 v2, s[8:11], s59 offen offset:0 sc1 lds
  v_smfmac_f32_16x16x64_bf16 v[48:51], v[16:19], a[184:191], v3
  v_smfmac_f32_16x16x64_bf16 v[52:55], v[16:19], a[240:247], v3
  v_smfmac_f32_16x16x64_bf16 v[56:59], v[16:19], v[160:167], v3
  v_smfmac_f32_16x16x64_bf16 v[60:63], v[16:19], v[216:223], v3
  buffer_load_dwordx4 v2, s[8:11], s59 offen offset:1024 sc1 lds
  s_waitcnt vmcnt(5)
  v_smfmac_f32_16x16x64_bf16 v[36:39], v[20:23], a[24:31], v3
  v_smfmac_f32_16x16x64_bf16 v[40:43], v[20:23], a[80:87], v3
  v_smfmac_f32_16x16x64_bf16 v[44:47], v[20:23], a[136:143], v3
  v_smfmac_f32_16x16x64_bf16 v[48:51], v[20:23], a[192:199], v3
  buffer_load_dwordx4 v2, s[8:11], s59 offen offset:2048 sc1 lds
  v_smfmac_f32_16x16x64_bf16 v[52:55], v[20:23], a[248:255], v3
  v_smfmac_f32_16x16x64_bf16 v[56:59], v[20:23], v[168:175], v3
  v_smfmac_f32_16x16x64_bf16 v[60:63], v[20:23], v[224:231], v3
  s_waitcnt vmcnt(3)
cA_sc2_ph2:
  v_smfmac_f32_16x16x64_bf16 v[60:63], v[24:27], v[232:239], v3
  buffer_load_dwordx4 v2, s[8:11], s59 offen offset:3072 sc1 lds
  ds_read_b128 v[8:11], v116 offset:4096
  ds_read_b128 v[12:15], v116 offset:5120
  v_smfmac_f32_16x16x64_bf16 v[60:63], v[28:31], v[240:247], v3
  buffer_load_dword v119, v0, s[8:11], s24 offen sc1
  v_smfmac_f32_16x16x64_bf16 v[60:63], v[32:35], v[248:255], v3
  v_mov_b32 v80, v28
  v_smfmac_f32_16x16x64_bf16 v[52:55], v[24:27], v[120:127], v3
  v_mov_b32 v81, v29
  v_smfmac_f32_16x16x64_bf16 v[52:55], v[28:31], v[128:135], v3
  v_mov_b32 v82, v34
  v_smfmac_f32_16x16x64_bf16 v[52:55], v[32:35], v[136:143], v3
  v_cvt_pk_bf16_f32 v64, v60, v61
  v_smfmac_f32_16x16x64_bf16 v[56:59], v[24:27], v[176:183], v3
  v_cvt_pk_bf16_f32 v65, v62, v63
  v_smfmac_f32_16x16x64_bf16 v[56:59], v[28:31], v[184:191], v3
  v_mov_b32 v83, v35
  v_mfma_f32_16x16x32_bf16 v[68:71], v[64:67], v[4:7], 0
  v_smfmac_f32_16x16x64_bf16 v[56:59], v[32:35], v[192:199], v3
  v_cvt_pk_bf16_f32 v64, v52, v53
  v_smfmac_f32_16x16x64_bf16 v[36:39], v[24:27], a[32:39], v3
  v_cvt_pk_bf16_f32 v65, v54, v55
  v_smfmac_f32_16x16x64_bf16 v[36:39], v[28:31], a[40:47], v3
  v_cvt_pk_bf16_f32 v78, v68, v69
  v_smfmac_f32_16x16x64_bf16 v[36:39], v[32:35], a[48:55], v3
  v_cvt_pk_bf16_f32 v79, v70, v71
  v_cvt_pk_bf16_f32 v66, v56, v57
  v_smfmac_f32_16x16x64_bf16 v[40:43], v[24:27], a[88:95], v3
  v_cvt_pk_bf16_f32 v67, v58, v59
  v_smfmac_f32_16x16x64_bf16 v[40:43], v[28:31], a[96:103], v3
  v_mfma_f32_16x16x32_bf16 v[72:75], v[64:67], v[4:7], 0
  ds_read_b128 v[52:55], v116 offset:18432
  ds_read_b128 v[56:59], v116 offset:19456
  v_smfmac_f32_16x16x64_bf16 v[40:43], v[32:35], a[104:111], v3
  v_cvt_pk_bf16_f32 v64, v36, v37
  v_smfmac_f32_16x16x64_bf16 v[44:47], v[24:27], a[144:151], v3
  v_cvt_pk_bf16_f32 v65, v38, v39
  v_smfmac_f32_16x16x64_bf16 v[44:47], v[28:31], a[152:159], v3
  v_cvt_pk_bf16_f32 v76, v72, v73
  v_smfmac_f32_16x16x64_bf16 v[44:47], v[32:35], a[160:167], v3
  v_cvt_pk_bf16_f32 v77, v74, v75
  v_cvt_pk_bf16_f32 v66, v40, v41
  v_smfmac_f32_16x16x64_bf16 v[48:51], v[24:27], a[200:207], v3
  v_cvt_pk_bf16_f32 v67, v42, v43
  v_smfmac_f32_16x16x64_bf16 v[48:51], v[28:31], a[208:215], v3
  v_mfma_f32_16x16x32_bf16 v[68:71], v[64:67], v[4:7], 0
  v_smfmac_f32_16x16x64_bf16 v[48:51], v[32:35], a[216:223], v3
  v_cvt_pk_bf16_f32 v64, v44, v45
  v_mfma_f32_16x16x32_bf16 v[84:87], v[80:83], v[76:79], 0
  v_cvt_pk_bf16_f32 v65, v46, v47
  s_waitcnt lgkmcnt(0)
  v_smfmac_f32_16x16x64_bf16 v[88:91], v[76:79], v[96:103], v118
  v_cvt_pk_bf16_f32 v60, v68, v69
  v_cvt_pk_bf16_f32 v61, v70, v71
  v_cvt_pk_bf16_f32 v66, v48, v49
  v_cvt_pk_bf16_f32 v67, v50, v51
  s_nop 1
  v_mfma_f32_16x16x32_bf16 v[72:75], v[64:67], v[4:7], 0
  v_smfmac_f32_16x16x64_bf16 v[92:95], v[76:79], v[104:111], v118
  s_nop 4
  v_cvt_pk_bf16_f32 v62, v72, v73
  v_cvt_pk_bf16_f32 v63, v74, v75
  s_nop 1
  v_mfma_f32_16x16x32_bf16 v[84:87], v[16:19], v[60:63], v[84:87]
  v_smfmac_f32_16x16x64_bf16 v[88:91], v[60:63], v[8:15], v118
  v_smfmac_f32_16x16x64_bf16 v[92:95], v[60:63], v[52:59], v118
  s_nop 1
  v_permlane32_swap_b32 v84, v86
  v_permlane32_swap_b32 v85, v87
  s_nop 0
  v_add_f32 v88, v88, v89
  v_add_f32_dpp v84, v86, v84 quad_perm:[1,0,3,2] row_mask:0xf bank_mask:0xf
  v_add_f32_dpp v85, v87, v85 quad_perm:[1,0,3,2] row_mask:0xf bank_mask:0xf
  v_add_f32 v89, v90, v91
  ds_write2_b32 v113, v84, v85 offset0:0 offset1:4
  ds_write2_b32 v112, v88, v89 offset0:0 offset1:128
  v_add_f32 v90, v92, v93
  v_add_f32 v91, v94, v95
  ds_write2_b32 v112, v90, v91 offset0:64 offset1:192
  v_cmp_u_f32 vcc, v88, v89
  s_cbranch_vccnz cA_sc2_retry
cA_sc2_cont:
  s_waitcnt lgkmcnt(0)
  s_barrier
  ds_read_b128 v[36:39], v114
  ds_read_b128 v[44:47], v115
  v_lshl_add_u32 v56, v2, 3, s36
  s_waitcnt lgkmcnt(0)
  v_add_f32 v36, v36, v38
  v_add_f32 v37, v37, v39
  v_add_f32 v44, v44, v45
  s_mov_b64 exec, 15
  buffer_store_dword v2, v56, s[8:11], s20 offen
  s_mov_b64 exec, -1
  v_add_f32 v46, v46, v47
  v_add_f32 v44, v44, v46
  v_add_f32 v36, v36, v37
  v_exp_f32 v49, v44
  v_exp_f32 v48, v36
  v_add_f32 v50, abs(v36), abs(v44)
  v_fma_f32 v39, v49, s37, v48
  v_cmp_ngt_f32 vcc, s56, v50
  v_cndmask_b32 v41, v48, v49, s[38:39]
  v_add_f32_dpp v39, v39, v39 quad_perm:[1,0,3,2] row_mask:0xf bank_mask:0xf
  v_cndmask_b32 v40, v49, v48, s[38:39]
  v_mov_b32_dpp v46, v41 quad_perm:[1,0,3,2] row_mask:0xf bank_mask:0xf
  v_add_f32_dpp v39, v39, v39 quad_perm:[2,3,0,1] row_mask:0xf bank_mask:0xf
  v_cndmask_b32 v42, v46, v40, s[38:39]
  v_cndmask_b32 v43, v40, v46, s[38:39]
  v_add_f32_dpp v39, v39, v39 row_half_mirror row_mask:0xf bank_mask:0xf
  s_cbranch_vccnz cA_sc2_slow
  s_nop 0
  v_add_f32_dpp v47, v39, v39 row_mirror row_mask:0xf bank_mask:0xf
  v_add_f32_dpp v39, v39, v39 row_mirror row_mask:0xf bank_mask:0xf
  s_nop 1
  v_permlane16_swap_b32 v39, v47
  v_add_f32 v39, v39, v47
  v_rcp_f32 v39, v39
  s_mov_b64 exec, s[28:29]
  v_mul_f32 v42, v42, v39
  v_mul_f32 v43, v43, v39
  v_cvt_pk_bf16_f32 v42, v42, v43
cA_sc2_pst:
  buffer_store_dword v42, v1, s[8:11], s20 offen
  s_mov_b64 exec, -1
  s_barrier
  s_cmp_lg_u32 s19, 0
  s_cbranch_scc1 cA_sc2_s0
  s_sub_u32 s36, s36, 64
  v_lshl_add_u32 v56, v2, 3, s36
  s_mov_b64 exec, 15
  buffer_store_dword v2, v56, s[8:11], s20 offen
  s_mov_b64 exec, -1
cA_sc2_s0:
  s_add_u32 s24, s24, 28672
  s_add_u32 s35, s35, 28672
  s_xor_b32 s25, s25, 28672
  s_add_u32 m0, s25, 14336
  s_add_u32 m0, s25, 18432
  s_add_u32 s22, s24, 4096
  buffer_load_dwordx4 v2, s[8:11], s22 offen offset:0 sc1 lds
  s_nop 5
  buffer_load_dwordx4 v2, s[8:11], s22 offen offset:1024 sc1 lds
  s_nop 5
  buffer_load_dwordx4 v2, s[8:11], s22 offen offset:2048 sc1 lds
  s_nop 5
  v_xor_b32 v116, 28672, v116
  v_add_u32 v117, s57, v117
  s_sub_u32 s57, 0, s57
  s_add_u32 s19, s19, 1
  s_mov_b32 s20, s21
  s_cmp_lt_u32 s19, 63
  s_cbranch_scc1 cA_sc2_loop
  s_branch cA_done
cA_sc2_slow:
  v_max_f32 v50, v36, v44
  s_nop 1
  v_max_f32_dpp v50, v50, v50 quad_perm:[1,0,3,2] row_mask:0xf bank_mask:0xf
  s_nop 1
  v_max_f32_dpp v50, v50, v50 quad_perm:[2,3,0,1] row_mask:0xf bank_mask:0xf
  s_nop 1
  v_max_f32_dpp v50, v50, v50 row_half_mirror row_mask:0xf bank_mask:0xf
  s_nop 1
  v_max_f32_dpp v50, v50, v50 row_mirror row_mask:0xf bank_mask:0xf
  v_mov_b32 v47, v50
  s_nop 1
  v_permlane16_swap_b32 v50, v47
  v_max_f32 v50, v50, v47
  v_sub_f32 v48, v36, v50
  v_sub_f32 v49, v44, v50
  v_exp_f32 v48, v48
  v_exp_f32 v49, v49
  s_add_u32 s31, s31, 0x100
  v_fma_f32 v39, v49, s37, v48
  v_cndmask_b32 v41, v48, v49, s[38:39]
  s_nop 0
  v_add_f32_dpp v39, v39, v39 quad_perm:[1,0,3,2] row_mask:0xf bank_mask:0xf
  v_cndmask_b32 v40, v49, v48, s[38:39]
  v_mov_b32_dpp v46, v41 quad_perm:[1,0,3,2] row_mask:0xf bank_mask:0xf
  v_add_f32_dpp v39, v39, v39 quad_perm:[2,3,0,1] row_mask:0xf bank_mask:0xf
  v_cndmask_b32 v42, v46, v40, s[38:39]
  v_cndmask_b32 v43, v40, v46, s[38:39]
  v_add_f32_dpp v39, v39, v39 row_half_mirror row_mask:0xf bank_mask:0xf
  s_nop 1
  v_add_f32_dpp v47, v39, v39 row_mirror row_mask:0xf bank_mask:0xf
  v_add_f32_dpp v39, v39, v39 row_mirror row_mask:0xf bank_mask:0xf
  s_nop 1
  v_permlane16_swap_b32 v39, v47
  v_add_f32 v39, v39, v47
  v_rcp_f32 v39, v39
  s_mov_b64 exec, s[28:29]
  v_mul_f32 v42, v42, v39
  v_mul_f32 v43, v43, v39
  v_cvt_pk_bf16_f32 v42, v42, v43
  v_min_u32 v42, -2, v42
  s_branch cA_sc2_pst
cA_sc2_retry:
  s_cmp_lg_u32 s62, 0
  s_cbranch_scc1 cA_sc2_cont
  s_waitcnt vmcnt(0) lgkmcnt(0)
cA_sc2_rv:
  buffer_load_dwordx4 v[8:11], v2, s[8:11], s20 offen offset:0 sc1
  buffer_load_dwordx4 v[12:15], v2, s[8:11], s20 offen offset:1024 sc1
  buffer_load_dwordx4 v[16:19], v2, s[8:11], s20 offen offset:2048 sc1
  buffer_load_dwordx4 v[20:23], v2, s[8:11], s20 offen offset:3072 sc1
  buffer_load_dwordx4 v[24:27], v2, s[8:11], s23 offen offset:0 sc1
  buffer_load_dwordx4 v[28:31], v2, s[8:11], s23 offen offset:1024 sc1
  buffer_load_dwordx4 v[32:35], v2, s[8:11], s23 offen offset:2048 sc1
  s_waitcnt vmcnt(0)
  v_max3_u32 v68, v8, v9, v10
  v_max3_u32 v68, v68, v11, v12
  v_max3_u32 v68, v68, v13, v14
  v_max3_u32 v68, v68, v15, v16
  v_max3_u32 v68, v68, v17, v18
  v_max3_u32 v68, v68, v19, v20
  v_max3_u32 v68, v68, v21, v22
  v_max3_u32 v68, v68, v23, v24
  v_max3_u32 v68, v68, v25, v26
  v_max3_u32 v68, v68, v27, v28
  v_max3_u32 v68, v68, v29, v30
  v_max3_u32 v68, v68, v31, v32
  v_max3_u32 v68, v68, v33, v34
  v_max_u32 v68, v68, v35
  v_cmp_eq_u32 vcc, -1, v68
  s_cbranch_vccz cA_sc2_rk
  s_add_u32 s30, s30, 1
  s_cmp_lt_u32 s30, 400000
  s_cbranch_scc1 cA_sc2_rv
  s_branch cA_abort
cA_sc2_rk:
  s_mov_b32 s62, 1
  v_mov_b32 v36, 0
  v_mov_b32 v37, 0
  v_mov_b32 v38, 0
  v_mov_b32 v39, 0
  v_mov_b32 v40, 0
  v_mov_b32 v41, 0
  v_mov_b32 v42, 0
  v_mov_b32 v43, 0
  v_mov_b32 v44, 0
  v_mov_b32 v45, 0
  v_mov_b32 v46, 0
  v_mov_b32 v47, 0
  v_mov_b32 v48, 0
  v_mov_b32 v49, 0
  v_mov_b32 v50, 0
  v_mov_b32 v51, 0
  v_mov_b32 v52, 0
  v_mov_b32 v53, 0
  v_mov_b32 v54, 0
  v_mov_b32 v55, 0
  v_mov_b32 v56, 0
  v_mov_b32 v57, 0
  v_mov_b32 v58, 0
  v_mov_b32 v59, 0
  v_mov_b32 v60, 0
  v_mov_b32 v61, 0
  v_mov_b32 v62, 0
  v_mov_b32 v63, 0
  v_mov_b32 v88, 0
  v_mov_b32 v89, 0
  v_mov_b32 v90, 0
  v_mov_b32 v91, 0
  v_mov_b32 v92, 0
  v_mov_b32 v93, 0
  v_mov_b32 v94, 0
  v_mov_b32 v95, 0
  v_mov_b32 v66, 0
  v_mov_b32 v67, 0
  s_add_u32 s31, s31, 1
  ds_read_b128 v[96:99], v117 offset:0
  ds_read_b128 v[100:103], v117 offset:1024
  ds_read_b128 v[104:107], v117 offset:14336
  ds_read_b128 v[108:111], v117 offset:15360
  v_smfmac_f32_16x16x64_bf16 v[36:39], v[8:11], a[0:7], v3
  v_smfmac_f32_16x16x64_bf16 v[40:43], v[8:11], a[56:63], v3
  v_smfmac_f32_16x16x64_bf16 v[44:47], v[8:11], a[112:119], v3
  v_smfmac_f32_16x16x64_bf16 v[48:51], v[8:11], a[168:175], v3
  v_smfmac_f32_16x16x64_bf16 v[52:55], v[8:11], a[224:231], v3
  v_smfmac_f32_16x16x64_bf16 v[56:59], v[8:11], v[144:151], v3
  v_smfmac_f32_16x16x64_bf16 v[60:63], v[8:11], v[200:207], v3
  v_smfmac_f32_16x16x64_bf16 v[36:39], v[12:15], a[8:15], v3
  v_smfmac_f32_16x16x64_bf16 v[40:43], v[12:15], a[64:71], v3
  v_smfmac_f32_16x16x64_bf16 v[44:47], v[12:15], a[120:127], v3
  v_smfmac_f32_16x16x64_bf16 v[48:51], v[12:15], a[176:183], v3
  v_smfmac_f32_16x16x64_bf16 v[52:55], v[12:15], a[232:239], v3
  v_smfmac_f32_16x16x64_bf16 v[56:59], v[12:15], v[152:159], v3
  v_smfmac_f32_16x16x64_bf16 v[60:63], v[12:15], v[208:215], v3
  v_smfmac_f32_16x16x64_bf16 v[36:39], v[16:19], a[16:23], v3
  v_smfmac_f32_16x16x64_bf16 v[40:43], v[16:19], a[72:79], v3
  v_smfmac_f32_16x16x64_bf16 v[44:47], v[16:19], a[128:135], v3
  v_smfmac_f32_16x16x64_bf16 v[48:51], v[16:19], a[184:191], v3
  v_smfmac_f32_16x16x64_bf16 v[52:55], v[16:19], a[240:247], v3
  v_smfmac_f32_16x16x64_bf16 v[56:59], v[16:19], v[160:167], v3
  v_smfmac_f32_16x16x64_bf16 v[60:63], v[16:19], v[216:223], v3
  v_smfmac_f32_16x16x64_bf16 v[36:39], v[20:23], a[24:31], v3
  v_smfmac_f32_16x16x64_bf16 v[40:43], v[20:23], a[80:87], v3
  v_smfmac_f32_16x16x64_bf16 v[44:47], v[20:23], a[136:143], v3
  v_smfmac_f32_16x16x64_bf16 v[48:51], v[20:23], a[192:199], v3
  v_smfmac_f32_16x16x64_bf16 v[52:55], v[20:23], a[248:255], v3
  v_smfmac_f32_16x16x64_bf16 v[56:59], v[20:23], v[168:175], v3
  v_smfmac_f32_16x16x64_bf16 v[60:63], v[20:23], v[224:231], v3
  s_xor_b32 s58, s25, 28672
  s_add_u32 s59, s24, 28672
  s_add_u32 m0, s58, 14336
  s_branch cA_sc2_ph2
.p2align 6

cA_sc3_loop:
  s_add_u32 s23, s20, 4096
  s_add_u32 s21, s20, 20480
  v_mov_b32 v48, 0
  v_mov_b32 v49, 0
  v_mov_b32 v50, 0
  v_mov_b32 v51, 0
  v_mov_b32 v52, 0
  v_mov_b32 v53, 0
  v_mov_b32 v54, 0
  v_mov_b32 v55, 0
  v_mov_b32 v56, 0
  v_mov_b32 v57, 0
  v_mov_b32 v58, 0
  v_mov_b32 v59, 0
  v_mov_b32 v60, 0
  v_mov_b32 v61, 0
  v_mov_b32 v62, 0
  v_mov_b32 v63, 0
  v_mov_b32 v88, 0
  v_mov_b32 v89, 0
  v_mov_b32 v90, 0
  v_mov_b32 v91, 0
  v_mov_b32 v92, 0
  v_mov_b32 v93, 0
  v_mov_b32 v94, 0
  v_mov_b32 v95, 0
  v_mov_b32 v64, 0
  v_mov_b32 v65, 0
  s_mov_b32 s30, 0
  s_mov_b32 s62, 0
  s_waitcnt vmcnt(0)
  s_barrier
cA_sc3_ld:
  buffer_load_dwordx4 v[8:11], v2, s[8:11], s20 offen offset:0
  v_mov_b32 v36, 0
  v_mov_b32 v37, 0
  v_mov_b32 v38, 0
  v_mov_b32 v39, 0
  buffer_load_dwordx4 v[12:15], v2, s[8:11], s20 offen offset:1024
  v_mov_b32 v40, 0
  v_mov_b32 v41, 0
  v_mov_b32 v42, 0
  v_mov_b32 v43, 0
  buffer_load_dwordx4 v[16:19], v2, s[8:11], s20 offen offset:2048
  v_mov_b32 v44, 0
  v_mov_b32 v45, 0
  v_mov_b32 v46, 0
  v_mov_b32 v47, 0
  ds_read_b128 v[96:99], v117 offset:0
  ds_read_b128 v[100:103], v117 offset:1024
  ds_read_b128 v[104:107], v117 offset:14336
  ds_read_b128 v[108:111], v117 offset:15360
  s_waitcnt vmcnt(2)
  v_smfmac_f32_16x16x64_bf16 v[36:39], v[8:11], a[0:7], v3
  v_smfmac_f32_16x16x64_bf16 v[40:43], v[8:11], a[56:63], v3
  buffer_load_dwordx4 v[20:23], v2, s[8:11], s20 offen offset:3072
  v_smfmac_f32_16x16x64_bf16 v[44:47], v[8:11], a[112:119], v3
  v_smfmac_f32_16x16x64_bf16 v[48:51], v[8:11], a[168:175], v3
  v_smfmac_f32_16x16x64_bf16 v[52:55], v[8:11], a[224:231], v3
  buffer_load_dwordx4 v[24:27], v2, s[8:11], s23 offen offset:0
  v_smfmac_f32_16x16x64_bf16 v[56:59], v[8:11], v[144:151], v3
  v_smfmac_f32_16x16x64_bf16 v[60:63], v[8:11], v[200:207], v3
  s_waitcnt vmcnt(3)
  v_smfmac_f32_16x16x64_bf16 v[36:39], v[12:15], a[8:15], v3
  v_smfmac_f32_16x16x64_bf16 v[40:43], v[12:15], a[64:71], v3
  buffer_load_dwordx4 v[28:31], v2, s[8:11], s23 offen offset:1024
  v_smfmac_f32_16x16x64_bf16 v[44:47], v[12:15], a[120:127], v3
  v_smfmac_f32_16x16x64_bf16 v[48:51], v[12:15], a[176:183], v3
  v_smfmac_f32_16x16x64_bf16 v[52:55], v[12:15], a[232:239], v3
  buffer_load_dwordx4 v[32:35], v2, s[8:11], s23 offen offset:2048
  v_smfmac_f32_16x16x64_bf16 v[56:59], v[12:15], v[152:159], v3
  v_smfmac_f32_16x16x64_bf16 v[60:63], v[12:15], v[208:215], v3
  s_waitcnt vmcnt(4)
  v_smfmac_f32_16x16x64_bf16 v[36:39], v[16:19], a[16:23], v3
  v_smfmac_f32_16x16x64_bf16 v[40:43], v[16:19], a[72:79], v3
  v_smfmac_f32_16x16x64_bf16 v[44:47], v[16:19], a[128:135], v3
  s_xor_b32 s58, s25, 28672
  s_add_u32 s59, s24, 28672
  s_add_u32 m0, s58, 21504
  v_smfmac_f32_16x16x64_bf16 v[48:51], v[16:19], a[184:191], v3
  buffer_load_dwordx4 v2, s[8:11], s59 offen offset:0 sc1 lds
  v_smfmac_f32_16x16x64_bf16 v[52:55], v[16:19], a[240:247], v3
  v_smfmac_f32_16x16x64_bf16 v[56:59], v[16:19], v[160:167], v3
  v_smfmac_f32_16x16x64_bf16 v[60:63], v[16:19], v[216:223], v3
  s_waitcnt vmcnt(4)
  v_smfmac_f32_16x16x64_bf16 v[36:39], v[20:23], a[24:31], v3
  buffer_load_dwordx4 v2, s[8:11], s59 offen offset:1024 sc1 lds
  v_smfmac_f32_16x16x64_bf16 v[40:43], v[20:23], a[80:87], v3
  v_smfmac_f32_16x16x64_bf16 v[44:47], v[20:23], a[136:143], v3
  v_smfmac_f32_16x16x64_bf16 v[48:51], v[20:23], a[192:199], v3
  v_smfmac_f32_16x16x64_bf16 v[52:55], v[20:23], a[248:255], v3
  buffer_load_dwordx4 v2, s[8:11], s59 offen offset:2048 sc1 lds
  v_smfmac_f32_16x16x64_bf16 v[56:59], v[20:23], v[168:175], v3
  v_smfmac_f32_16x16x64_bf16 v[60:63], v[20:23], v[224:231], v3
  s_waitcnt vmcnt(3)
cA_sc3_ph2:
  v_smfmac_f32_16x16x64_bf16 v[60:63], v[24:27], v[232:239], v3
  ds_read_b128 v[8:11], v116 offset:6144
  ds_read_b128 v[12:15], v116 offset:7168
  v_smfmac_f32_16x16x64_bf16 v[60:63], v[28:31], v[240:247], v3
  buffer_load_dwordx4 v2, s[8:11], s59 offen offset:3072 sc1 lds
  v_smfmac_f32_16x16x64_bf16 v[60:63], v[32:35], v[248:255], v3
  v_mov_b32 v80, v30
  v_smfmac_f32_16x16x64_bf16 v[52:55], v[24:27], v[120:127], v3
  v_mov_b32 v81, v31
  v_smfmac_f32_16x16x64_bf16 v[52:55], v[28:31], v[128:135], v3
  v_mov_b32 v82, v34
  v_smfmac_f32_16x16x64_bf16 v[52:55], v[32:35], v[136:143], v3
  v_cvt_pk_bf16_f32 v66, v60, v61
  v_smfmac_f32_16x16x64_bf16 v[56:59], v[24:27], v[176:183], v3
  v_cvt_pk_bf16_f32 v67, v62, v63
  v_smfmac_f32_16x16x64_bf16 v[56:59], v[28:31], v[184:191], v3
  v_mov_b32 v83, v35
  v_mfma_f32_16x16x32_bf16 v[68:71], v[64:67], v[4:7], 0
  v_smfmac_f32_16x16x64_bf16 v[56:59], v[32:35], v[192:199], v3
  v_cvt_pk_bf16_f32 v64, v52, v53
  v_smfmac_f32_16x16x64_bf16 v[36:39], v[24:27], a[32:39], v3
  v_cvt_pk_bf16_f32 v65, v54, v55
  v_smfmac_f32_16x16x64_bf16 v[36:39], v[28:31], a[40:47], v3
  v_cvt_pk_bf16_f32 v78, v68, v69
  v_smfmac_f32_16x16x64_bf16 v[36:39], v[32:35], a[48:55], v3
  v_cvt_pk_bf16_f32 v79, v70, v71
  v_cvt_pk_bf16_f32 v66, v56, v57
  v_smfmac_f32_16x16x64_bf16 v[40:43], v[24:27], a[88:95], v3
  v_cvt_pk_bf16_f32 v67, v58, v59
  v_smfmac_f32_16x16x64_bf16 v[40:43], v[28:31], a[96:103], v3
  v_mfma_f32_16x16x32_bf16 v[72:75], v[64:67], v[4:7], 0
  ds_read_b128 v[52:55], v116 offset:20480
  ds_read_b128 v[56:59], v116 offset:21504
  v_smfmac_f32_16x16x64_bf16 v[40:43], v[32:35], a[104:111], v3
  v_cvt_pk_bf16_f32 v64, v36, v37
  v_smfmac_f32_16x16x64_bf16 v[44:47], v[24:27], a[144:151], v3
  v_cvt_pk_bf16_f32 v65, v38, v39
  v_smfmac_f32_16x16x64_bf16 v[44:47], v[28:31], a[152:159], v3
  v_cvt_pk_bf16_f32 v76, v72, v73
  v_smfmac_f32_16x16x64_bf16 v[44:47], v[32:35], a[160:167], v3
  v_cvt_pk_bf16_f32 v77, v74, v75
  v_cvt_pk_bf16_f32 v66, v40, v41
  v_smfmac_f32_16x16x64_bf16 v[48:51], v[24:27], a[200:207], v3
  v_cvt_pk_bf16_f32 v67, v42, v43
  v_smfmac_f32_16x16x64_bf16 v[48:51], v[28:31], a[208:215], v3
  v_mfma_f32_16x16x32_bf16 v[68:71], v[64:67], v[4:7], 0
  v_smfmac_f32_16x16x64_bf16 v[48:51], v[32:35], a[216:223], v3
  v_cvt_pk_bf16_f32 v64, v44, v45
  v_mfma_f32_16x16x32_bf16 v[84:87], v[80:83], v[76:79], 0
  v_cvt_pk_bf16_f32 v65, v46, v47
  s_waitcnt lgkmcnt(0)
  v_smfmac_f32_16x16x64_bf16 v[88:91], v[76:79], v[96:103], v118
  v_cvt_pk_bf16_f32 v60, v68, v69
  v_cvt_pk_bf16_f32 v61, v70, v71
  v_cvt_pk_bf16_f32 v66, v48, v49
  v_cvt_pk_bf16_f32 v67, v50, v51
  s_nop 1
  v_mfma_f32_16x16x32_bf16 v[72:75], v[64:67], v[4:7], 0
  v_smfmac_f32_16x16x64_bf16 v[92:95], v[76:79], v[104:111], v118
  s_nop 4
  v_cvt_pk_bf16_f32 v62, v72, v73
  v_cvt_pk_bf16_f32 v63, v74, v75
  s_nop 1
  v_mfma_f32_16x16x32_bf16 v[84:87], v[20:23], v[60:63], v[84:87]
  v_smfmac_f32_16x16x64_bf16 v[88:91], v[60:63], v[8:15], v118
  v_smfmac_f32_16x16x64_bf16 v[92:95], v[60:63], v[52:59], v118
  s_nop 1
  v_permlane32_swap_b32 v84, v86
  v_permlane32_swap_b32 v85, v87
  s_nop 0
  v_add_f32 v88, v88, v89
  v_add_f32_dpp v84, v86, v84 quad_perm:[1,0,3,2] row_mask:0xf bank_mask:0xf
  v_add_f32_dpp v85, v87, v85 quad_perm:[1,0,3,2] row_mask:0xf bank_mask:0xf
  v_add_f32 v89, v90, v91
  ds_write2_b32 v113, v84, v85 offset0:0 offset1:4
  ds_write2_b32 v112, v88, v89 offset0:0 offset1:128
  v_add_f32 v90, v92, v93
  v_add_f32 v91, v94, v95
  ds_write2_b32 v112, v90, v91 offset0:64 offset1:192
  v_cmp_u_f32 vcc, v88, v89
  s_cbranch_vccnz cA_sc3_retry
cA_sc3_cont:
  s_waitcnt lgkmcnt(0)
  s_barrier
  ds_read_b128 v[36:39], v114
  ds_read_b128 v[44:47], v115
  s_waitcnt lgkmcnt(0)
  v_add_f32 v36, v36, v38
  v_add_f32 v37, v37, v39
  v_add_f32 v44, v44, v45
  v_add_f32 v46, v46, v47
  v_add_f32 v44, v44, v46
  v_add_f32 v36, v36, v37
  v_exp_f32 v49, v44
  v_exp_f32 v48, v36
  v_add_f32 v50, abs(v36), abs(v44)
  v_fma_f32 v39, v49, s37, v48
  v_cmp_ngt_f32 vcc, s56, v50
  v_cndmask_b32 v41, v48, v49, s[38:39]
  v_add_f32_dpp v39, v39, v39 quad_perm:[1,0,3,2] row_mask:0xf bank_mask:0xf
  v_cndmask_b32 v40, v49, v48, s[38:39]
  v_mov_b32_dpp v46, v41 quad_perm:[1,0,3,2] row_mask:0xf bank_mask:0xf
  v_add_f32_dpp v39, v39, v39 quad_perm:[2,3,0,1] row_mask:0xf bank_mask:0xf
  v_cndmask_b32 v42, v46, v40, s[38:39]
  v_cndmask_b32 v43, v40, v46, s[38:39]
  v_add_f32_dpp v39, v39, v39 row_half_mirror row_mask:0xf bank_mask:0xf
  s_cbranch_vccnz cA_sc3_slow
  s_nop 0
  v_add_f32_dpp v47, v39, v39 row_mirror row_mask:0xf bank_mask:0xf
  v_add_f32_dpp v39, v39, v39 row_mirror row_mask:0xf bank_mask:0xf
  s_nop 1
  v_permlane16_swap_b32 v39, v47
  v_add_f32 v39, v39, v47
  v_rcp_f32 v39, v39
  s_mov_b64 exec, s[28:29]
  v_mul_f32 v42, v42, v39
  v_mul_f32 v43, v43, v39
  v_cvt_pk_bf16_f32 v42, v42, v43
cA_sc3_pst:
  buffer_store_dword v42, v1, s[8:11], s20 offen
  s_mov_b64 exec, -1
  s_barrier
  s_add_u32 s24, s24, 28672
  s_add_u32 s35, s35, 28672
  s_xor_b32 s25, s25, 28672
  s_add_u32 m0, s25, 21504
  s_add_u32 m0, s25, 25600
  s_add_u32 s22, s24, 4096
  buffer_load_dwordx4 v2, s[8:11], s22 offen offset:0 sc1 lds
  s_nop 5
  buffer_load_dwordx4 v2, s[8:11], s22 offen offset:1024 sc1 lds
  s_nop 5
  buffer_load_dwordx4 v2, s[8:11], s22 offen offset:2048 sc1 lds
  s_nop 5
  v_xor_b32 v116, 28672, v116
  v_add_u32 v117, s57, v117
  s_sub_u32 s57, 0, s57
  s_add_u32 s19, s19, 1
  s_mov_b32 s20, s21
  s_cmp_lt_u32 s19, 63
  s_cbranch_scc1 cA_sc3_loop
  s_branch cA_done
cA_sc3_slow:
  v_max_f32 v50, v36, v44
  s_nop 1
  v_max_f32_dpp v50, v50, v50 quad_perm:[1,0,3,2] row_mask:0xf bank_mask:0xf
  s_nop 1
  v_max_f32_dpp v50, v50, v50 quad_perm:[2,3,0,1] row_mask:0xf bank_mask:0xf
  s_nop 1
  v_max_f32_dpp v50, v50, v50 row_half_mirror row_mask:0xf bank_mask:0xf
  s_nop 1
  v_max_f32_dpp v50, v50, v50 row_mirror row_mask:0xf bank_mask:0xf
  v_mov_b32 v47, v50
  s_nop 1
  v_permlane16_swap_b32 v50, v47
  v_max_f32 v50, v50, v47
  v_sub_f32 v48, v36, v50
  v_sub_f32 v49, v44, v50
  v_exp_f32 v48, v48
  v_exp_f32 v49, v49
  s_add_u32 s31, s31, 0x100
  v_fma_f32 v39, v49, s37, v48
  v_cndmask_b32 v41, v48, v49, s[38:39]
  s_nop 0
  v_add_f32_dpp v39, v39, v39 quad_perm:[1,0,3,2] row_mask:0xf bank_mask:0xf
  v_cndmask_b32 v40, v49, v48, s[38:39]
  v_mov_b32_dpp v46, v41 quad_perm:[1,0,3,2] row_mask:0xf bank_mask:0xf
  v_add_f32_dpp v39, v39, v39 quad_perm:[2,3,0,1] row_mask:0xf bank_mask:0xf
  v_cndmask_b32 v42, v46, v40, s[38:39]
  v_cndmask_b32 v43, v40, v46, s[38:39]
  v_add_f32_dpp v39, v39, v39 row_half_mirror row_mask:0xf bank_mask:0xf
  s_nop 1
  v_add_f32_dpp v47, v39, v39 row_mirror row_mask:0xf bank_mask:0xf
  v_add_f32_dpp v39, v39, v39 row_mirror row_mask:0xf bank_mask:0xf
  s_nop 1
  v_permlane16_swap_b32 v39, v47
  v_add_f32 v39, v39, v47
  v_rcp_f32 v39, v39
  s_mov_b64 exec, s[28:29]
  v_mul_f32 v42, v42, v39
  v_mul_f32 v43, v43, v39
  v_cvt_pk_bf16_f32 v42, v42, v43
  v_min_u32 v42, -2, v42
  s_branch cA_sc3_pst
cA_sc3_retry:
  s_cmp_lg_u32 s62, 0
  s_cbranch_scc1 cA_sc3_cont
  s_waitcnt vmcnt(0) lgkmcnt(0)
cA_sc3_rv:
  buffer_load_dwordx4 v[8:11], v2, s[8:11], s20 offen offset:0 sc1
  buffer_load_dwordx4 v[12:15], v2, s[8:11], s20 offen offset:1024 sc1
  buffer_load_dwordx4 v[16:19], v2, s[8:11], s20 offen offset:2048 sc1
  buffer_load_dwordx4 v[20:23], v2, s[8:11], s20 offen offset:3072 sc1
  buffer_load_dwordx4 v[24:27], v2, s[8:11], s23 offen offset:0 sc1
  buffer_load_dwordx4 v[28:31], v2, s[8:11], s23 offen offset:1024 sc1
  buffer_load_dwordx4 v[32:35], v2, s[8:11], s23 offen offset:2048 sc1
  s_waitcnt vmcnt(0)
  v_max3_u32 v68, v8, v9, v10
  v_max3_u32 v68, v68, v11, v12
  v_max3_u32 v68, v68, v13, v14
  v_max3_u32 v68, v68, v15, v16
  v_max3_u32 v68, v68, v17, v18
  v_max3_u32 v68, v68, v19, v20
  v_max3_u32 v68, v68, v21, v22
  v_max3_u32 v68, v68, v23, v24
  v_max3_u32 v68, v68, v25, v26
  v_max3_u32 v68, v68, v27, v28
  v_max3_u32 v68, v68, v29, v30
  v_max3_u32 v68, v68, v31, v32
  v_max3_u32 v68, v68, v33, v34
  v_max_u32 v68, v68, v35
  v_cmp_eq_u32 vcc, -1, v68
  s_cbranch_vccz cA_sc3_rk
  s_add_u32 s30, s30, 1
  s_cmp_lt_u32 s30, 400000
  s_cbranch_scc1 cA_sc3_rv
  s_branch cA_abort
cA_sc3_rk:
  s_mov_b32 s62, 1
  v_mov_b32 v36, 0
  v_mov_b32 v37, 0
  v_mov_b32 v38, 0
  v_mov_b32 v39, 0
  v_mov_b32 v40, 0
  v_mov_b32 v41, 0
  v_mov_b32 v42, 0
  v_mov_b32 v43, 0
  v_mov_b32 v44, 0
  v_mov_b32 v45, 0
  v_mov_b32 v46, 0
  v_mov_b32 v47, 0
  v_mov_b32 v48, 0
  v_mov_b32 v49, 0
  v_mov_b32 v50, 0
  v_mov_b32 v51, 0
  v_mov_b32 v52, 0
  v_mov_b32 v53, 0
  v_mov_b32 v54, 0
  v_mov_b32 v55, 0
  v_mov_b32 v56, 0
  v_mov_b32 v57, 0
  v_mov_b32 v58, 0
  v_mov_b32 v59, 0
  v_mov_b32 v60, 0
  v_mov_b32 v61, 0
  v_mov_b32 v62, 0
  v_mov_b32 v63, 0
  v_mov_b32 v88, 0
  v_mov_b32 v89, 0
  v_mov_b32 v90, 0
  v_mov_b32 v91, 0
  v_mov_b32 v92, 0
  v_mov_b32 v93, 0
  v_mov_b32 v94, 0
  v_mov_b32 v95, 0
  v_mov_b32 v64, 0
  v_mov_b32 v65, 0
  s_add_u32 s31, s31, 1
  ds_read_b128 v[96:99], v117 offset:0
  ds_read_b128 v[100:103], v117 offset:1024
  ds_read_b128 v[104:107], v117 offset:14336
  ds_read_b128 v[108:111], v117 offset:15360
  v_smfmac_f32_16x16x64_bf16 v[36:39], v[8:11], a[0:7], v3
  v_smfmac_f32_16x16x64_bf16 v[40:43], v[8:11], a[56:63], v3
  v_smfmac_f32_16x16x64_bf16 v[44:47], v[8:11], a[112:119], v3
  v_smfmac_f32_16x16x64_bf16 v[48:51], v[8:11], a[168:175], v3
  v_smfmac_f32_16x16x64_bf16 v[52:55], v[8:11], a[224:231], v3
  v_smfmac_f32_16x16x64_bf16 v[56:59], v[8:11], v[144:151], v3
  v_smfmac_f32_16x16x64_bf16 v[60:63], v[8:11], v[200:207], v3
  v_smfmac_f32_16x16x64_bf16 v[36:39], v[12:15], a[8:15], v3
  v_smfmac_f32_16x16x64_bf16 v[40:43], v[12:15], a[64:71], v3
  v_smfmac_f32_16x16x64_bf16 v[44:47], v[12:15], a[120:127], v3
  v_smfmac_f32_16x16x64_bf16 v[48:51], v[12:15], a[176:183], v3
  v_smfmac_f32_16x16x64_bf16 v[52:55], v[12:15], a[232:239], v3
  v_smfmac_f32_16x16x64_bf16 v[56:59], v[12:15], v[152:159], v3
  v_smfmac_f32_16x16x64_bf16 v[60:63], v[12:15], v[208:215], v3
  v_smfmac_f32_16x16x64_bf16 v[36:39], v[16:19], a[16:23], v3
  v_smfmac_f32_16x16x64_bf16 v[40:43], v[16:19], a[72:79], v3
  v_smfmac_f32_16x16x64_bf16 v[44:47], v[16:19], a[128:135], v3
  v_smfmac_f32_16x16x64_bf16 v[48:51], v[16:19], a[184:191], v3
  v_smfmac_f32_16x16x64_bf16 v[52:55], v[16:19], a[240:247], v3
  v_smfmac_f32_16x16x64_bf16 v[56:59], v[16:19], v[160:167], v3
  v_smfmac_f32_16x16x64_bf16 v[60:63], v[16:19], v[216:223], v3
  v_smfmac_f32_16x16x64_bf16 v[36:39], v[20:23], a[24:31], v3
  v_smfmac_f32_16x16x64_bf16 v[40:43], v[20:23], a[80:87], v3
  v_smfmac_f32_16x16x64_bf16 v[44:47], v[20:23], a[136:143], v3
  v_smfmac_f32_16x16x64_bf16 v[48:51], v[20:23], a[192:199], v3
  v_smfmac_f32_16x16x64_bf16 v[52:55], v[20:23], a[248:255], v3
  v_smfmac_f32_16x16x64_bf16 v[56:59], v[20:23], v[168:175], v3
  v_smfmac_f32_16x16x64_bf16 v[60:63], v[20:23], v[224:231], v3
  s_xor_b32 s58, s25, 28672
  s_add_u32 s59, s24, 28672
  s_add_u32 m0, s58, 21504
  s_branch cA_sc3_ph2
.p2align 6

cA_va0_loop:
  s_add_u32 s23, s20, 4096
  s_add_u32 s21, s20, 20480
  s_mov_b32 s30, 0
  s_cmp_lg_u32 s19, s38
  s_cbranch_scc1 cA_va0_vok
  s_branch cA_va0_voc
cA_va0_vow:
  s_sub_u32 s22, s39, s35
  v_lshlrev_b32 v63, 7, v2
  v_min_u32 v63, s22, v63
  buffer_load_dword v63, v63, s[8:11], s35 offen sc1
  s_waitcnt vmcnt(0)
cA_va0_voc:
  v_readfirstlane_b32 s22, v63
  s_cmp_eq_u32 s22, 56
  s_cbranch_scc1 cA_va0_vod
  s_sleep 1
  s_add_u32 s30, s30, 1
  s_cmp_lt_u32 s30, 400000
  s_cbranch_scc1 cA_va0_vow
  s_branch cA_abort
cA_va0_vod:
  s_add_u32 s35, s35, 2048
  s_add_u32 s38, s19, 8
  s_and_b32 s38, s38, -8
  s_cmp_eq_u32 s19, 0
  s_cselect_b32 s38, 4, s38
  v_cmp_ne_u32 vcc, 56, v63
  s_nop 3
  s_cmp_eq_u64 vcc, 0
  s_cselect_b32 s38, 99, s38
cA_va0_vok:
  s_cmp_eq_u32 s19, 63
  s_cbranch_scc1 cA_done
  s_barrier
  s_add_u32 s22, s25, 0
  buffer_load_dwordx4 v[80:83], v6, s[8:11], s22 offen offset:0 sc1
  buffer_load_dwordx4 v[84:87], v6, s[8:11], s22 offen offset:1792 sc1
  s_add_u32 s22, s25, 3584
  buffer_load_dwordx4 v[88:91], v6, s[8:11], s22 offen offset:0 sc1
  buffer_load_dwordx4 v[92:95], v6, s[8:11], s22 offen offset:1792 sc1
  s_add_u32 s22, s25, 7168
  buffer_load_dwordx4 v[96:99], v6, s[8:11], s22 offen offset:0 sc1
  buffer_load_dwordx4 v[100:103], v6, s[8:11], s22 offen offset:1792 sc1
  s_add_u32 s22, s25, 10752
  buffer_load_dwordx4 v[104:107], v6, s[8:11], s22 offen offset:0 sc1
  buffer_load_dwordx4 v[108:111], v6, s[8:11], s22 offen offset:1792 sc1
  s_add_u32 s22, s25, 14336
  buffer_load_dwordx4 v[112:115], v6, s[8:11], s22 offen offset:0 sc1
  buffer_load_dwordx4 v[116:119], v6, s[8:11], s22 offen offset:1792 sc1
  s_add_u32 s22, s25, 17920
  buffer_load_dwordx4 v[120:123], v6, s[8:11], s22 offen offset:0 sc1
  buffer_load_dwordx4 v[124:127], v6, s[8:11], s22 offen offset:1792 sc1
  s_add_u32 s22, s19, 1
  s_cmp_lg_u32 s22, s38
  s_cbranch_scc1 cA_va0_nk
  s_sub_u32 s22, s39, s35
  v_lshlrev_b32 v63, 7, v2
  v_min_u32 v63, s22, v63
  buffer_load_dword v63, v63, s[8:11], s35 offen sc1
cA_va0_nk:
  s_barrier
  ds_read_b128 v[8:11], v0 offset:8192
  ds_read_b128 v[12:15], v0 offset:9216
  ds_read_b128 v[16:19], v0 offset:10240
  ds_read_b128 v[20:23], v0 offset:11264
  ds_read_b128 v[24:27], v0 offset:12288
  ds_read_b128 v[28:31], v0 offset:13312
  ds_read_b128 v[32:35], v0 offset:14336
  s_waitcnt lgkmcnt(0)
  v_smfmac_f32_16x16x64_bf16 v[36:39], v[8:11], a[0:7], v3
  s_add_u32 s22, s25, 21504
  buffer_load_dwordx4 v[128:131], v6, s[8:11], s22 offen offset:0 sc1
  v_smfmac_f32_16x16x64_bf16 v[36:39], v[12:15], a[8:15], v3
  v_smfmac_f32_16x16x64_bf16 v[36:39], v[16:19], a[16:23], v3
  s_add_u32 s22, s25, 21504
  buffer_load_dwordx4 v[132:135], v6, s[8:11], s22 offen offset:1792 sc1
  v_smfmac_f32_16x16x64_bf16 v[36:39], v[20:23], a[24:31], v3
  v_smfmac_f32_16x16x64_bf16 v[36:39], v[24:27], a[32:39], v3
  s_add_u32 s22, s25, 25088
  buffer_load_dwordx4 v[136:139], v6, s[8:11], s22 offen offset:0 sc1
  v_smfmac_f32_16x16x64_bf16 v[36:39], v[28:31], a[40:47], v3
  v_smfmac_f32_16x16x64_bf16 v[36:39], v[32:35], a[48:55], v3
  s_add_u32 s22, s25, 25088
  buffer_load_dwordx4 v[140:143], v6, s[8:11], s22 offen offset:1792 sc1
  v_smfmac_f32_16x16x64_bf16 v[40:43], v[8:11], a[56:63], v3
  v_smfmac_f32_16x16x64_bf16 v[40:43], v[12:15], a[64:71], v3
  v_smfmac_f32_16x16x64_bf16 v[40:43], v[16:19], a[72:79], v3
  v_add_f32 v36, v36, v37
  v_smfmac_f32_16x16x64_bf16 v[40:43], v[20:23], a[80:87], v3
  v_add_f32 v38, v38, v39
  v_smfmac_f32_16x16x64_bf16 v[40:43], v[24:27], a[88:95], v3
  v_cvt_pk_bf16_f32 v36, v36, v38
  v_smfmac_f32_16x16x64_bf16 v[40:43], v[28:31], a[96:103], v3
  ds_write_b32 v60, v36
  v_smfmac_f32_16x16x64_bf16 v[40:43], v[32:35], a[104:111], v3
  v_smfmac_f32_16x16x64_bf16 v[44:47], v[8:11], a[112:119], v3
  v_smfmac_f32_16x16x64_bf16 v[44:47], v[12:15], a[120:127], v3
  v_smfmac_f32_16x16x64_bf16 v[44:47], v[16:19], a[128:135], v3
  v_add_f32 v40, v40, v41
  v_smfmac_f32_16x16x64_bf16 v[44:47], v[20:23], a[136:143], v3
  v_add_f32 v42, v42, v43
  v_smfmac_f32_16x16x64_bf16 v[44:47], v[24:27], a[144:151], v3
  v_cvt_pk_bf16_f32 v40, v40, v42
  v_smfmac_f32_16x16x64_bf16 v[44:47], v[28:31], a[152:159], v3
  ds_write_b32 v61, v40
  v_smfmac_f32_16x16x64_bf16 v[44:47], v[32:35], a[160:167], v3
  v_smfmac_f32_16x16x64_bf16 v[48:51], v[8:11], a[168:175], v3
  v_smfmac_f32_16x16x64_bf16 v[48:51], v[12:15], a[176:183], v3
  v_smfmac_f32_16x16x64_bf16 v[48:51], v[16:19], a[184:191], v3
  v_add_f32 v44, v44, v45
  v_smfmac_f32_16x16x64_bf16 v[48:51], v[20:23], a[192:199], v3
  v_add_f32 v46, v46, v47
  v_smfmac_f32_16x16x64_bf16 v[48:51], v[24:27], a[200:207], v3
  v_cvt_pk_bf16_f32 v44, v44, v46
  v_smfmac_f32_16x16x64_bf16 v[48:51], v[28:31], a[208:215], v3
  ds_write_b32 v62, v44
  v_smfmac_f32_16x16x64_bf16 v[48:51], v[32:35], a[216:223], v3
  v_smfmac_f32_16x16x64_bf16 v[52:55], v[8:11], a[224:231], v3
  v_smfmac_f32_16x16x64_bf16 v[52:55], v[12:15], a[232:239], v3
  v_smfmac_f32_16x16x64_bf16 v[52:55], v[16:19], a[240:247], v3
  v_add_f32 v48, v48, v49
  v_smfmac_f32_16x16x64_bf16 v[52:55], v[20:23], a[248:255], v3
  v_add_f32 v50, v50, v51
  v_smfmac_f32_16x16x64_bf16 v[52:55], v[24:27], v[176:183], v3
  v_cvt_pk_bf16_f32 v48, v48, v50
  v_smfmac_f32_16x16x64_bf16 v[52:55], v[28:31], v[184:191], v3
  ds_write_b32 v170, v48
  v_smfmac_f32_16x16x64_bf16 v[52:55], v[32:35], v[192:199], v3
  v_smfmac_f32_16x16x64_bf16 v[56:59], v[8:11], v[200:207], v3
  v_smfmac_f32_16x16x64_bf16 v[56:59], v[12:15], v[208:215], v3
  v_smfmac_f32_16x16x64_bf16 v[56:59], v[16:19], v[216:223], v3
  v_add_f32 v52, v52, v53
  v_smfmac_f32_16x16x64_bf16 v[56:59], v[20:23], v[224:231], v3
  v_add_f32 v54, v54, v55
  v_smfmac_f32_16x16x64_bf16 v[56:59], v[24:27], v[232:239], v3
  v_cvt_pk_bf16_f32 v52, v52, v54
  v_smfmac_f32_16x16x64_bf16 v[56:59], v[28:31], v[240:247], v3
  ds_write_b32 v171, v52
  v_smfmac_f32_16x16x64_bf16 v[56:59], v[32:35], v[248:255], v3
  s_nop 7
  v_add_f32 v56, v56, v57
  v_add_f32 v58, v58, v59
  v_cvt_pk_bf16_f32 v56, v56, v58
  ds_write_b32 v172, v56
  buffer_load_dword v164, v4, s[8:11], s20 offen sc1
  s_waitcnt lgkmcnt(0)
  v_mov_b32 v36, 0
  v_mov_b32 v37, 0
  v_mov_b32 v38, 0
  v_mov_b32 v39, 0
  v_mov_b32 v40, 0
  v_mov_b32 v41, 0
  v_mov_b32 v42, 0
  v_mov_b32 v43, 0
  buffer_load_dword v165, v4, s[8:11], s20 offen sc1
  v_mov_b32 v44, 0
  v_mov_b32 v45, 0
  v_mov_b32 v46, 0
  v_mov_b32 v47, 0
  v_mov_b32 v48, 0
  v_mov_b32 v49, 0
  v_mov_b32 v50, 0
  v_mov_b32 v51, 0
  buffer_load_dword v166, v4, s[8:11], s20 offen sc1
  v_mov_b32 v52, 0
  v_mov_b32 v53, 0
  v_mov_b32 v54, 0
  v_mov_b32 v55, 0
  v_mov_b32 v56, 0
  v_mov_b32 v57, 0
  v_mov_b32 v58, 0
  v_mov_b32 v59, 0
  buffer_load_dword v167, v4, s[8:11], s20 offen sc1
  s_cmp_eq_u32 s19, 63
  s_cbranch_scc1 cA_va0_last
  s_add_u32 s22, s20, 9216
  s_add_u32 s34, s20, 13312
  s_add_u32 s36, s20, 7168
  s_mov_b32 s37, 0
  v_mov_b32 v156, 0
  v_mov_b32 v157, 0
  v_mov_b32 v158, 0
  v_mov_b32 v159, 0
  buffer_load_dword v168, v4, s[8:11], s20 offen sc1
cA_va0_fw_l:
  s_waitcnt vmcnt(4)
  v_cmp_eq_u32 vcc, -1, v164
  s_cbranch_vccz cA_va0_fw_d
  buffer_load_dword v164, v4, s[8:11], s20 offen sc1
  s_waitcnt vmcnt(4)
  v_cmp_eq_u32 vcc, -1, v165
  s_cbranch_vccz cA_va0_fw_d
  buffer_load_dword v165, v4, s[8:11], s20 offen sc1
  s_waitcnt vmcnt(4)
  v_cmp_eq_u32 vcc, -1, v166
  s_cbranch_vccz cA_va0_fw_d
  buffer_load_dword v166, v4, s[8:11], s20 offen sc1
  s_waitcnt vmcnt(4)
  v_cmp_eq_u32 vcc, -1, v167
  s_cbranch_vccz cA_va0_fw_d
  buffer_load_dword v167, v4, s[8:11], s20 offen sc1
  s_waitcnt vmcnt(4)
  v_cmp_eq_u32 vcc, -1, v168
  s_cbranch_vccz cA_va0_fw_d
  buffer_load_dword v168, v4, s[8:11], s20 offen sc1
  s_add_u32 s30, s30, 1
  s_cmp_lt_u32 s30, 400000
  s_cbranch_scc1 cA_va0_fw_l
  s_branch cA_abort
cA_va0_fw_d:
  s_waitcnt lgkmcnt(0)
  buffer_load_dwordx4 v[8:11], v5, s[8:11], s22 offen offset:0
  buffer_load_dwordx4 v[12:15], v5, s[8:11], s22 offen offset:1024
  buffer_load_dwordx4 v[16:19], v5, s[8:11], s22 offen offset:2048
  buffer_load_dwordx4 v[20:23], v5, s[8:11], s22 offen offset:3072
  buffer_load_dwordx4 v[24:27], v5, s[8:11], s34 offen offset:0
  buffer_load_dwordx4 v[28:31], v5, s[8:11], s34 offen offset:1024
  buffer_load_dwordx4 v[32:35], v5, s[8:11], s34 offen offset:2048
  buffer_load_dwordx4 v[144:147], v5, s[8:11], s34 offen offset:3072
  buffer_load_dwordx4 v[148:151], v2, s[8:11], s36 offen offset:0
  buffer_load_dwordx4 v[152:155], v2, s[8:11], s36 offen offset:1024
  s_barrier
  ds_read_b128 v[64:67], v2 offset:0
  ds_read_b128 v[68:71], v2 offset:1024
  ds_read_b128 v[72:75], v2 offset:2048
  ds_read_b128 v[76:79], v2 offset:3072
  s_waitcnt vmcnt(9)
  v_smfmac_f32_16x16x64_bf16 v[156:159], v[8:11], v[80:87], v3
  s_waitcnt vmcnt(8)
  v_smfmac_f32_16x16x64_bf16 v[156:159], v[12:15], v[88:95], v3
  s_waitcnt vmcnt(7)
  v_smfmac_f32_16x16x64_bf16 v[156:159], v[16:19], v[96:103], v3
  s_waitcnt vmcnt(6)
  v_smfmac_f32_16x16x64_bf16 v[156:159], v[20:23], v[104:111], v3
  s_waitcnt vmcnt(5)
  v_smfmac_f32_16x16x64_bf16 v[156:159], v[24:27], v[112:119], v3
  s_waitcnt vmcnt(4)
  v_smfmac_f32_16x16x64_bf16 v[156:159], v[28:31], v[120:127], v3
  s_waitcnt vmcnt(3)
  v_smfmac_f32_16x16x64_bf16 v[156:159], v[32:35], v[128:135], v3
  s_waitcnt vmcnt(2)
  v_smfmac_f32_16x16x64_bf16 v[156:159], v[144:147], v[136:143], v3
  s_waitcnt vmcnt(1) lgkmcnt(0)
  v_smfmac_f32_16x16x64_bf16 v[156:159], v[148:151], v[64:71], v3
  s_waitcnt vmcnt(0)
  v_smfmac_f32_16x16x64_bf16 v[156:159], v[152:155], v[72:79], v3
cA_va0_ep:
  s_nop 7
  v_add_f32 v160, v156, v157
  v_add_f32 v161, v158, v159
  v_cmp_u_f32 vcc, v160, v161
  v_mov_b32_dpp v162, v160 row_ror:8 row_mask:0xf bank_mask:0xf
  v_mov_b32_dpp v160, v161 row_ror:8 row_mask:0xf bank_mask:0xc
  s_cbranch_vccnz cA_va0_rp
  v_mov_b32_dpp v161, v162 quad_perm:[0,1,2,3] row_mask:0xf bank_mask:0x3
  v_cvt_pk_bf16_f32 v160, v160, v161
cA_va0_pc:
  buffer_store_dword v160, v1, s[8:11], s21 offen
  s_cmp_lg_u32 s19, 62
  s_cbranch_scc1 cA_va0_nl
  s_mov_b32 s22, 88531968
  buffer_store_dword v160, v1, s[8:11], s22 offen sc1
  s_mov_b64 exec, -1
  s_branch cA_done
cA_va0_nl:
  s_mov_b64 exec, -1
  s_add_u32 s25, s25, 28672
  s_add_u32 s19, s19, 1
  s_mov_b32 s20, s21
  s_branch cA_va0_loop
cA_va0_last:
  s_waitcnt lgkmcnt(0)
  s_barrier
  s_branch cA_done
cA_va0_rp:
  s_cmp_eq_u32 s37, 0
  s_cbranch_scc1 cA_va0_rv
  v_mov_b32_dpp v161, v162 quad_perm:[0,1,2,3] row_mask:0xf bank_mask:0x3
  v_cvt_pk_bf16_f32 v160, v160, v161
  v_min_u32 v160, -2, v160
  s_branch cA_va0_pc
cA_va0_rv:
  buffer_load_dwordx4 v[8:11], v5, s[8:11], s22 offen offset:0 sc1
  buffer_load_dwordx4 v[12:15], v5, s[8:11], s22 offen offset:1024 sc1
  buffer_load_dwordx4 v[16:19], v5, s[8:11], s22 offen offset:2048 sc1
  buffer_load_dwordx4 v[20:23], v5, s[8:11], s22 offen offset:3072 sc1
  buffer_load_dwordx4 v[24:27], v5, s[8:11], s34 offen offset:0 sc1
  buffer_load_dwordx4 v[28:31], v5, s[8:11], s34 offen offset:1024 sc1
  buffer_load_dwordx4 v[32:35], v5, s[8:11], s34 offen offset:2048 sc1
  buffer_load_dwordx4 v[144:147], v5, s[8:11], s34 offen offset:3072 sc1
  buffer_load_dwordx4 v[148:151], v2, s[8:11], s36 offen offset:0 sc1
  buffer_load_dwordx4 v[152:155], v2, s[8:11], s36 offen offset:1024 sc1
  s_waitcnt vmcnt(0)
  v_max3_u32 v175, v8, v9, v10
  v_max3_u32 v175, v175, v11, v12
  v_max3_u32 v175, v175, v13, v14
  v_max3_u32 v175, v175, v15, v16
  v_max3_u32 v175, v175, v17, v18
  v_max3_u32 v175, v175, v19, v20
  v_max3_u32 v175, v175, v21, v22
  v_max3_u32 v175, v175, v23, v24
  v_max3_u32 v175, v175, v25, v26
  v_max3_u32 v175, v175, v27, v28
  v_max3_u32 v175, v175, v29, v30
  v_max3_u32 v175, v175, v31, v32
  v_max3_u32 v175, v175, v33, v34
  v_max3_u32 v175, v175, v35, v144
  v_max3_u32 v175, v175, v145, v146
  v_max3_u32 v175, v175, v147, v148
  v_max3_u32 v175, v175, v149, v150
  v_max3_u32 v175, v175, v151, v152
  v_max3_u32 v175, v175, v153, v154
  v_max_u32 v175, v175, v155
  v_cmp_eq_u32 vcc, -1, v175
  s_cbranch_vccz cA_va0_rk
  s_add_u32 s30, s30, 1
  s_cmp_lt_u32 s30, 400000
  s_cbranch_scc1 cA_va0_rv
  s_branch cA_abort
cA_va0_rk:
  s_mov_b32 s37, 1
  s_add_u32 s31, s31, 0x10000
  v_mov_b32 v156, 0
  v_mov_b32 v157, 0
  v_mov_b32 v158, 0
  v_mov_b32 v159, 0
  s_nop 1
  v_smfmac_f32_16x16x64_bf16 v[156:159], v[8:11], v[80:87], v3
  v_smfmac_f32_16x16x64_bf16 v[156:159], v[12:15], v[88:95], v3
  v_smfmac_f32_16x16x64_bf16 v[156:159], v[16:19], v[96:103], v3
  v_smfmac_f32_16x16x64_bf16 v[156:159], v[20:23], v[104:111], v3
  v_smfmac_f32_16x16x64_bf16 v[156:159], v[24:27], v[112:119], v3
  v_smfmac_f32_16x16x64_bf16 v[156:159], v[28:31], v[120:127], v3
  v_smfmac_f32_16x16x64_bf16 v[156:159], v[32:35], v[128:135], v3
  v_smfmac_f32_16x16x64_bf16 v[156:159], v[144:147], v[136:143], v3
  v_smfmac_f32_16x16x64_bf16 v[156:159], v[148:151], v[64:71], v3
  v_smfmac_f32_16x16x64_bf16 v[156:159], v[152:155], v[72:79], v3
  s_nop 7
  s_branch cA_va0_ep
.p2align 6

cA_va1_loop:
  s_add_u32 s23, s20, 4096
  s_add_u32 s21, s20, 20480
  s_mov_b32 s30, 0
  s_cmp_lg_u32 s19, s38
  s_cbranch_scc1 cA_va1_vok
  s_branch cA_va1_voc
cA_va1_vow:
  s_sub_u32 s22, s39, s35
  v_lshlrev_b32 v63, 7, v2
  v_min_u32 v63, s22, v63
  buffer_load_dword v63, v63, s[8:11], s35 offen sc1
  s_waitcnt vmcnt(0)
cA_va1_voc:
  v_readfirstlane_b32 s22, v63
  s_cmp_eq_u32 s22, 56
  s_cbranch_scc1 cA_va1_vod
  s_sleep 1
  s_add_u32 s30, s30, 1
  s_cmp_lt_u32 s30, 400000
  s_cbranch_scc1 cA_va1_vow
  s_branch cA_abort
cA_va1_vod:
  s_add_u32 s35, s35, 2048
  s_add_u32 s38, s19, 8
  s_and_b32 s38, s38, -8
  s_cmp_eq_u32 s19, 0
  s_cselect_b32 s38, 4, s38
  v_cmp_ne_u32 vcc, 56, v63
  s_nop 3
  s_cmp_eq_u64 vcc, 0
  s_cselect_b32 s38, 99, s38
cA_va1_vok:
  s_cmp_eq_u32 s19, 63
  s_cbranch_scc1 cA_done
  s_barrier
  s_add_u32 s22, s25, 0
  buffer_load_dwordx4 v[80:83], v6, s[8:11], s22 offen offset:0 sc1
  buffer_load_dwordx4 v[84:87], v6, s[8:11], s22 offen offset:1792 sc1
  s_add_u32 s22, s25, 3584
  buffer_load_dwordx4 v[88:91], v6, s[8:11], s22 offen offset:0 sc1
  buffer_load_dwordx4 v[92:95], v6, s[8:11], s22 offen offset:1792 sc1
  s_add_u32 s22, s25, 7168
  buffer_load_dwordx4 v[96:99], v6, s[8:11], s22 offen offset:0 sc1
  buffer_load_dwordx4 v[100:103], v6, s[8:11], s22 offen offset:1792 sc1
  s_add_u32 s22, s25, 10752
  buffer_load_dwordx4 v[104:107], v6, s[8:11], s22 offen offset:0 sc1
  buffer_load_dwordx4 v[108:111], v6, s[8:11], s22 offen offset:1792 sc1
  s_add_u32 s22, s25, 14336
  buffer_load_dwordx4 v[112:115], v6, s[8:11], s22 offen offset:0 sc1
  buffer_load_dwordx4 v[116:119], v6, s[8:11], s22 offen offset:1792 sc1
  s_add_u32 s22, s25, 17920
  buffer_load_dwordx4 v[120:123], v6, s[8:11], s22 offen offset:0 sc1
  buffer_load_dwordx4 v[124:127], v6, s[8:11], s22 offen offset:1792 sc1
  s_add_u32 s22, s19, 1
  s_cmp_lg_u32 s22, s38
  s_cbranch_scc1 cA_va1_nk
  s_sub_u32 s22, s39, s35
  v_lshlrev_b32 v63, 7, v2
  v_min_u32 v63, s22, v63
  buffer_load_dword v63, v63, s[8:11], s35 offen sc1
cA_va1_nk:
  s_barrier
  ds_read_b128 v[8:11], v0 offset:8192
  ds_read_b128 v[12:15], v0 offset:9216
  ds_read_b128 v[16:19], v0 offset:10240
  ds_read_b128 v[20:23], v0 offset:11264
  ds_read_b128 v[24:27], v0 offset:12288
  ds_read_b128 v[28:31], v0 offset:13312
  ds_read_b128 v[32:35], v0 offset:14336
  s_waitcnt lgkmcnt(0)
  v_smfmac_f32_16x16x64_bf16 v[36:39], v[8:11], a[0:7], v3
  s_add_u32 s22, s25, 21504
  buffer_load_dwordx4 v[128:131], v6, s[8:11], s22 offen offset:0 sc1
  v_smfmac_f32_16x16x64_bf16 v[36:39], v[12:15], a[8:15], v3
  v_smfmac_f32_16x16x64_bf16 v[36:39], v[16:19], a[16:23], v3
  s_add_u32 s22, s25, 21504
  buffer_load_dwordx4 v[132:135], v6, s[8:11], s22 offen offset:1792 sc1
  v_smfmac_f32_16x16x64_bf16 v[36:39], v[20:23], a[24:31], v3
  v_smfmac_f32_16x16x64_bf16 v[36:39], v[24:27], a[32:39], v3
  s_add_u32 s22, s25, 25088
  buffer_load_dwordx4 v[136:139], v6, s[8:11], s22 offen offset:0 sc1
  v_smfmac_f32_16x16x64_bf16 v[36:39], v[28:31], a[40:47], v3
  v_smfmac_f32_16x16x64_bf16 v[36:39], v[32:35], a[48:55], v3
  s_add_u32 s22, s25, 25088
  buffer_load_dwordx4 v[140:143], v6, s[8:11], s22 offen offset:1792 sc1
  v_smfmac_f32_16x16x64_bf16 v[40:43], v[8:11], a[56:63], v3
  v_smfmac_f32_16x16x64_bf16 v[40:43], v[12:15], a[64:71], v3
  v_smfmac_f32_16x16x64_bf16 v[40:43], v[16:19], a[72:79], v3
  v_add_f32 v36, v36, v37
  v_smfmac_f32_16x16x64_bf16 v[40:43], v[20:23], a[80:87], v3
  v_add_f32 v38, v38, v39
  v_smfmac_f32_16x16x64_bf16 v[40:43], v[24:27], a[88:95], v3
  v_cvt_pk_bf16_f32 v36, v36, v38
  v_smfmac_f32_16x16x64_bf16 v[40:43], v[28:31], a[96:103], v3
  ds_write_b32 v60, v36
  v_smfmac_f32_16x16x64_bf16 v[40:43], v[32:35], a[104:111], v3
  v_smfmac_f32_16x16x64_bf16 v[44:47], v[8:11], a[112:119], v3
  v_smfmac_f32_16x16x64_bf16 v[44:47], v[12:15], a[120:127], v3
  v_smfmac_f32_16x16x64_bf16 v[44:47], v[16:19], a[128:135], v3
  v_add_f32 v40, v40, v41
  v_smfmac_f32_16x16x64_bf16 v[44:47], v[20:23], a[136:143], v3
  v_add_f32 v42, v42, v43
  v_smfmac_f32_16x16x64_bf16 v[44:47], v[24:27], a[144:151], v3
  v_cvt_pk_bf16_f32 v40, v40, v42
  v_smfmac_f32_16x16x64_bf16 v[44:47], v[28:31], a[152:159], v3
  ds_write_b32 v61, v40
  v_smfmac_f32_16x16x64_bf16 v[44:47], v[32:35], a[160:167], v3
  v_smfmac_f32_16x16x64_bf16 v[48:51], v[8:11], a[168:175], v3
  v_smfmac_f32_16x16x64_bf16 v[48:51], v[12:15], a[176:183], v3
  v_smfmac_f32_16x16x64_bf16 v[48:51], v[16:19], a[184:191], v3
  v_add_f32 v44, v44, v45
  v_smfmac_f32_16x16x64_bf16 v[48:51], v[20:23], a[192:199], v3
  v_add_f32 v46, v46, v47
  v_smfmac_f32_16x16x64_bf16 v[48:51], v[24:27], a[200:207], v3
  v_cvt_pk_bf16_f32 v44, v44, v46
  v_smfmac_f32_16x16x64_bf16 v[48:51], v[28:31], a[208:215], v3
  ds_write_b32 v62, v44
  v_smfmac_f32_16x16x64_bf16 v[48:51], v[32:35], a[216:223], v3
  v_smfmac_f32_16x16x64_bf16 v[52:55], v[8:11], a[224:231], v3
  v_smfmac_f32_16x16x64_bf16 v[52:55], v[12:15], a[232:239], v3
  v_smfmac_f32_16x16x64_bf16 v[52:55], v[16:19], a[240:247], v3
  v_add_f32 v48, v48, v49
  v_smfmac_f32_16x16x64_bf16 v[52:55], v[20:23], a[248:255], v3
  v_add_f32 v50, v50, v51
  v_smfmac_f32_16x16x64_bf16 v[52:55], v[24:27], v[176:183], v3
  v_cvt_pk_bf16_f32 v48, v48, v50
  v_smfmac_f32_16x16x64_bf16 v[52:55], v[28:31], v[184:191], v3
  ds_write_b32 v170, v48
  v_smfmac_f32_16x16x64_bf16 v[52:55], v[32:35], v[192:199], v3
  v_smfmac_f32_16x16x64_bf16 v[56:59], v[8:11], v[200:207], v3
  v_smfmac_f32_16x16x64_bf16 v[56:59], v[12:15], v[208:215], v3
  v_smfmac_f32_16x16x64_bf16 v[56:59], v[16:19], v[216:223], v3
  v_add_f32 v52, v52, v53
  v_smfmac_f32_16x16x64_bf16 v[56:59], v[20:23], v[224:231], v3
  v_add_f32 v54, v54, v55
  v_smfmac_f32_16x16x64_bf16 v[56:59], v[24:27], v[232:239], v3
  v_cvt_pk_bf16_f32 v52, v52, v54
  v_smfmac_f32_16x16x64_bf16 v[56:59], v[28:31], v[240:247], v3
  ds_write_b32 v171, v52
  v_smfmac_f32_16x16x64_bf16 v[56:59], v[32:35], v[248:255], v3
  s_nop 7
  v_add_f32 v56, v56, v57
  v_add_f32 v58, v58, v59
  v_cvt_pk_bf16_f32 v56, v56, v58
  ds_write_b32 v172, v56
  s_waitcnt lgkmcnt(0)
  v_mov_b32 v36, 0
  v_mov_b32 v37, 0
  v_mov_b32 v38, 0
  v_mov_b32 v39, 0
  v_mov_b32 v40, 0
  v_mov_b32 v41, 0
  v_mov_b32 v42, 0
  v_mov_b32 v43, 0
  v_mov_b32 v44, 0
  v_mov_b32 v45, 0
  v_mov_b32 v46, 0
  v_mov_b32 v47, 0
  v_mov_b32 v48, 0
  v_mov_b32 v49, 0
  v_mov_b32 v50, 0
  v_mov_b32 v51, 0
  v_mov_b32 v52, 0
  v_mov_b32 v53, 0
  v_mov_b32 v54, 0
  v_mov_b32 v55, 0
  v_mov_b32 v56, 0
  v_mov_b32 v57, 0
  v_mov_b32 v58, 0
  v_mov_b32 v59, 0
  s_cmp_eq_u32 s19, 63
  s_cbranch_scc1 cA_va1_last
  s_add_u32 s22, s20, 9216
  s_add_u32 s34, s20, 13312
  s_add_u32 s36, s20, 7168
  s_mov_b32 s37, 0
  v_mov_b32 v156, 0
  v_mov_b32 v157, 0
  v_mov_b32 v158, 0
  v_mov_b32 v159, 0
  s_barrier
  s_waitcnt lgkmcnt(0)
  buffer_load_dwordx4 v[8:11], v5, s[8:11], s22 offen offset:0
  buffer_load_dwordx4 v[12:15], v5, s[8:11], s22 offen offset:1024
  buffer_load_dwordx4 v[16:19], v5, s[8:11], s22 offen offset:2048
  buffer_load_dwordx4 v[20:23], v5, s[8:11], s22 offen offset:3072
  buffer_load_dwordx4 v[24:27], v5, s[8:11], s34 offen offset:0
  buffer_load_dwordx4 v[28:31], v5, s[8:11], s34 offen offset:1024
  buffer_load_dwordx4 v[32:35], v5, s[8:11], s34 offen offset:2048
  buffer_load_dwordx4 v[144:147], v5, s[8:11], s34 offen offset:3072
  s_sub_u32 s23, s21, 4
  s_mov_b64 exec, 65535
  buffer_store_dword v2, v7, s[8:11], s23 offen
  s_mov_b64 exec, -1
  buffer_load_dwordx4 v[148:151], v2, s[8:11], s36 offen offset:0
  buffer_load_dwordx4 v[152:155], v2, s[8:11], s36 offen offset:1024
  ds_read_b128 v[64:67], v2 offset:4096
  ds_read_b128 v[68:71], v2 offset:5120
  ds_read_b128 v[72:75], v2 offset:6144
  ds_read_b128 v[76:79], v2 offset:7168
  s_waitcnt vmcnt(10)
  v_smfmac_f32_16x16x64_bf16 v[156:159], v[8:11], v[80:87], v3
  s_waitcnt vmcnt(9)
  v_smfmac_f32_16x16x64_bf16 v[156:159], v[12:15], v[88:95], v3
  s_waitcnt vmcnt(8)
  v_smfmac_f32_16x16x64_bf16 v[156:159], v[16:19], v[96:103], v3
  s_waitcnt vmcnt(7)
  v_smfmac_f32_16x16x64_bf16 v[156:159], v[20:23], v[104:111], v3
  s_waitcnt vmcnt(6)
  v_smfmac_f32_16x16x64_bf16 v[156:159], v[24:27], v[112:119], v3
  s_mov_b64 exec, 65535
  buffer_store_dword v2, v7, s[8:11], s21 offen
  s_mov_b64 exec, -1
  s_waitcnt vmcnt(6)
  v_smfmac_f32_16x16x64_bf16 v[156:159], v[28:31], v[120:127], v3
  s_waitcnt vmcnt(5)
  v_smfmac_f32_16x16x64_bf16 v[156:159], v[32:35], v[128:135], v3
  s_waitcnt vmcnt(4)
  v_smfmac_f32_16x16x64_bf16 v[156:159], v[144:147], v[136:143], v3
  s_waitcnt vmcnt(2) lgkmcnt(0)
  v_smfmac_f32_16x16x64_bf16 v[156:159], v[148:151], v[64:71], v3
  s_waitcnt vmcnt(1)
  v_smfmac_f32_16x16x64_bf16 v[156:159], v[152:155], v[72:79], v3
cA_va1_ep:
  s_nop 7
  v_add_f32 v160, v156, v157
  v_add_f32 v161, v158, v159
  v_cmp_u_f32 vcc, v160, v161
  v_mov_b32_dpp v162, v160 row_ror:8 row_mask:0xf bank_mask:0xf
  v_mov_b32_dpp v160, v161 row_ror:8 row_mask:0xf bank_mask:0xc
  s_cbranch_vccnz cA_va1_rp
  v_mov_b32_dpp v161, v162 quad_perm:[0,1,2,3] row_mask:0xf bank_mask:0x3
  v_cvt_pk_bf16_f32 v160, v160, v161
cA_va1_pc:
  s_mov_b64 exec, s[26:27]
  buffer_store_dword v160, v1, s[8:11], s21 offen
  s_cmp_lg_u32 s19, 62
  s_cbranch_scc1 cA_va1_nl
  s_mov_b32 s22, 88531968
  buffer_store_dword v160, v1, s[8:11], s22 offen sc1
  s_mov_b64 exec, -1
  s_branch cA_done
cA_va1_nl:
  s_mov_b64 exec, -1
  s_cmp_lg_u32 s19, 0
  s_cbranch_scc1 cA_va1_s0
  v_add_u32 v7, 512, v7
  v_lshl_add_u32 v7, v2, 3, v7
  s_mov_b64 exec, 65535
  buffer_store_dword v2, v7, s[8:11], s21 offen
  buffer_store_dword v2, v7, s[8:11], s23 offen
  s_mov_b64 exec, -1
cA_va1_s0:
  s_add_u32 s25, s25, 28672
  s_add_u32 s19, s19, 1
  s_mov_b32 s20, s21
  s_branch cA_va1_loop
cA_va1_last:
  s_waitcnt lgkmcnt(0)
  s_barrier
  s_branch cA_done
cA_va1_rp:
  s_cmp_eq_u32 s37, 0
  s_cbranch_scc1 cA_va1_rv
  v_mov_b32_dpp v161, v162 quad_perm:[0,1,2,3] row_mask:0xf bank_mask:0x3
  v_cvt_pk_bf16_f32 v160, v160, v161
  v_min_u32 v160, -2, v160
  s_branch cA_va1_pc
cA_va1_rv:
  buffer_load_dwordx4 v[8:11], v5, s[8:11], s22 offen offset:0 sc1
  buffer_load_dwordx4 v[12:15], v5, s[8:11], s22 offen offset:1024 sc1
  buffer_load_dwordx4 v[16:19], v5, s[8:11], s22 offen offset:2048 sc1
  buffer_load_dwordx4 v[20:23], v5, s[8:11], s22 offen offset:3072 sc1
  buffer_load_dwordx4 v[24:27], v5, s[8:11], s34 offen offset:0 sc1
  buffer_load_dwordx4 v[28:31], v5, s[8:11], s34 offen offset:1024 sc1
  buffer_load_dwordx4 v[32:35], v5, s[8:11], s34 offen offset:2048 sc1
  buffer_load_dwordx4 v[144:147], v5, s[8:11], s34 offen offset:3072 sc1
  buffer_load_dwordx4 v[148:151], v2, s[8:11], s36 offen offset:0 sc1
  buffer_load_dwordx4 v[152:155], v2, s[8:11], s36 offen offset:1024 sc1
  s_waitcnt vmcnt(0)
  v_max3_u32 v175, v8, v9, v10
  v_max3_u32 v175, v175, v11, v12
  v_max3_u32 v175, v175, v13, v14
  v_max3_u32 v175, v175, v15, v16
  v_max3_u32 v175, v175, v17, v18
  v_max3_u32 v175, v175, v19, v20
  v_max3_u32 v175, v175, v21, v22
  v_max3_u32 v175, v175, v23, v24
  v_max3_u32 v175, v175, v25, v26
  v_max3_u32 v175, v175, v27, v28
  v_max3_u32 v175, v175, v29, v30
  v_max3_u32 v175, v175, v31, v32
  v_max3_u32 v175, v175, v33, v34
  v_max3_u32 v175, v175, v35, v144
  v_max3_u32 v175, v175, v145, v146
  v_max3_u32 v175, v175, v147, v148
  v_max3_u32 v175, v175, v149, v150
  v_max3_u32 v175, v175, v151, v152
  v_max3_u32 v175, v175, v153, v154
  v_max_u32 v175, v175, v155
  v_cmp_eq_u32 vcc, -1, v175
  s_cbranch_vccz cA_va1_rk
  s_add_u32 s30, s30, 1
  s_cmp_lt_u32 s30, 400000
  s_cbranch_scc1 cA_va1_rv
  s_branch cA_abort
cA_va1_rk:
  s_mov_b32 s37, 1
  s_add_u32 s31, s31, 0x10000
  v_mov_b32 v156, 0
  v_mov_b32 v157, 0
  v_mov_b32 v158, 0
  v_mov_b32 v159, 0
  s_nop 1
  v_smfmac_f32_16x16x64_bf16 v[156:159], v[8:11], v[80:87], v3
  v_smfmac_f32_16x16x64_bf16 v[156:159], v[12:15], v[88:95], v3
  v_smfmac_f32_16x16x64_bf16 v[156:159], v[16:19], v[96:103], v3
  v_smfmac_f32_16x16x64_bf16 v[156:159], v[20:23], v[104:111], v3
  v_smfmac_f32_16x16x64_bf16 v[156:159], v[24:27], v[112:119], v3
  v_smfmac_f32_16x16x64_bf16 v[156:159], v[28:31], v[120:127], v3
  v_smfmac_f32_16x16x64_bf16 v[156:159], v[32:35], v[128:135], v3
  v_smfmac_f32_16x16x64_bf16 v[156:159], v[144:147], v[136:143], v3
  v_smfmac_f32_16x16x64_bf16 v[156:159], v[148:151], v[64:71], v3
  v_smfmac_f32_16x16x64_bf16 v[156:159], v[152:155], v[72:79], v3
  s_nop 7
  s_branch cA_va1_ep
.p2align 6

cA_va2_loop:
  s_add_u32 s23, s20, 4096
  s_add_u32 s21, s20, 20480
  v_mov_b32 v36, 0
  v_mov_b32 v37, 0
  v_mov_b32 v38, 0
  v_mov_b32 v39, 0
  v_mov_b32 v40, 0
  v_mov_b32 v41, 0
  v_mov_b32 v42, 0
  v_mov_b32 v43, 0
  v_mov_b32 v44, 0
  v_mov_b32 v45, 0
  v_mov_b32 v46, 0
  v_mov_b32 v47, 0
  v_mov_b32 v48, 0
  v_mov_b32 v49, 0
  v_mov_b32 v50, 0
  v_mov_b32 v51, 0
  v_mov_b32 v52, 0
  v_mov_b32 v53, 0
  v_mov_b32 v54, 0
  v_mov_b32 v55, 0
  v_mov_b32 v56, 0
  v_mov_b32 v57, 0
  v_mov_b32 v58, 0
  v_mov_b32 v59, 0
  v_mov_b32 v60, 0
  v_mov_b32 v61, 0
  v_mov_b32 v62, 0
  v_mov_b32 v63, 0
  v_mov_b32 v64, 0
  v_mov_b32 v65, 0
  v_mov_b32 v66, 0
  v_mov_b32 v67, 0
  s_mov_b32 s30, 0
  buffer_load_dword v76, v119, s[8:11], s20 offen sc1
  buffer_load_dword v77, v119, s[8:11], s20 offen sc1
  buffer_load_dword v78, v119, s[8:11], s20 offen sc1
cA_va2_fp_l:
  s_waitcnt vmcnt(2)
  v_cmp_eq_u32 vcc, -1, v76
  s_cbranch_vccz cA_va2_fp_d
  buffer_load_dword v76, v119, s[8:11], s20 offen sc1
  s_waitcnt vmcnt(2)
  v_cmp_eq_u32 vcc, -1, v77
  s_cbranch_vccz cA_va2_fp_d
  buffer_load_dword v77, v119, s[8:11], s20 offen sc1
  s_waitcnt vmcnt(2)
  v_cmp_eq_u32 vcc, -1, v78
  s_cbranch_vccz cA_va2_fp_d
  buffer_load_dword v78, v119, s[8:11], s20 offen sc1
  s_add_u32 s30, s30, 1
  s_cmp_lt_u32 s30, 400000
  s_cbranch_scc1 cA_va2_fp_l
  s_branch cA_abort
cA_va2_fp_d:
  s_nop 15
  s_nop 3
  buffer_load_dwordx4 v[8:11], v2, s[8:11], s20 offen offset:0 sc1
  buffer_load_dwordx4 v[12:15], v2, s[8:11], s20 offen offset:1024 sc1
  buffer_load_dwordx4 v[16:19], v2, s[8:11], s20 offen offset:2048 sc1
  buffer_load_dwordx4 v[20:23], v2, s[8:11], s20 offen offset:3072 sc1
  s_barrier
cA_va2_ld:
  s_waitcnt vmcnt(0)
  v_max3_u32 v84, v8, v9, v10
  v_max3_u32 v84, v84, v11, v12
  v_max3_u32 v84, v84, v13, v14
  v_max3_u32 v84, v84, v15, v16
  v_max3_u32 v84, v84, v17, v18
  v_max3_u32 v84, v84, v19, v20
  v_max3_u32 v84, v84, v21, v22
  v_max_u32 v84, v84, v23
  v_cmp_eq_u32 vcc, -1, v84
  ds_write_b128 v2, v[8:11] offset:8192
  ds_write_b128 v2, v[12:15] offset:9216
  ds_write_b128 v2, v[16:19] offset:10240
  ds_write_b128 v2, v[20:23] offset:11264
  s_cbranch_vccnz cA_va2_retry
  s_waitcnt lgkmcnt(0)
  s_barrier
  ds_read_b128 v[8:11], v5 offset:8192
  ds_read_b128 v[12:15], v5 offset:9216
  ds_read_b128 v[16:19], v5 offset:10240
  ds_read_b128 v[20:23], v5 offset:11264
  ds_read_b128 v[24:27], v5 offset:12288
  ds_read_b128 v[28:31], v5 offset:13312
  ds_read_b128 v[32:35], v5 offset:14336
  ds_read_b128 v[92:95], v0
  s_waitcnt lgkmcnt(0)
  s_mov_b64 exec, s[26:27]
  buffer_store_dwordx4 v[92:95], v2, s[8:11], s36 offen sc1
  s_mov_b64 exec, -1
  s_add_u32 s36, s36, 7168
  s_cmp_eq_u32 s19, 63
  s_cbranch_scc1 cA_done
  ds_read_b128 v[76:79], v1 offset:0
  ds_read_b128 v[80:83], v1 offset:1024
  ds_read_b128 v[84:87], v1 offset:2048
  ds_read_b128 v[88:91], v1 offset:3072
  ds_read_b128 v[92:95], v1 offset:4096
  ds_read_b128 v[96:99], v1 offset:5120
  v_smfmac_f32_16x16x64_bf16 v[60:63], v[8:11], v[200:207], v3
  v_smfmac_f32_16x16x64_bf16 v[60:63], v[12:15], v[208:215], v3
  s_waitcnt lgkmcnt(4)
  v_smfmac_f32_16x16x64_bf16 v[64:67], v[8:11], v[76:83], v3
  ds_read_b128 v[76:79], v1 offset:6144
  ds_read_b128 v[80:83], v1 offset:7168
  v_smfmac_f32_16x16x64_bf16 v[60:63], v[16:19], v[216:223], v3
  v_smfmac_f32_16x16x64_bf16 v[60:63], v[20:23], v[224:231], v3
  s_waitcnt lgkmcnt(4)
  v_smfmac_f32_16x16x64_bf16 v[64:67], v[12:15], v[84:91], v3
  ds_read_b128 v[84:87], v1 offset:8192
  ds_read_b128 v[88:91], v1 offset:9216
  v_smfmac_f32_16x16x64_bf16 v[60:63], v[24:27], v[232:239], v3
  v_smfmac_f32_16x16x64_bf16 v[60:63], v[28:31], v[240:247], v3
  s_waitcnt lgkmcnt(4)
  v_smfmac_f32_16x16x64_bf16 v[64:67], v[16:19], v[92:99], v3
  ds_read_b128 v[92:95], v1 offset:10240
  ds_read_b128 v[96:99], v1 offset:11264
  v_smfmac_f32_16x16x64_bf16 v[60:63], v[32:35], v[248:255], v3
  v_smfmac_f32_16x16x64_bf16 v[36:39], v[8:11], a[0:7], v3
  s_waitcnt lgkmcnt(4)
  v_smfmac_f32_16x16x64_bf16 v[64:67], v[20:23], v[76:83], v3
  ds_read_b128 v[76:79], v1 offset:12288
  ds_read_b128 v[80:83], v1 offset:13312
  v_smfmac_f32_16x16x64_bf16 v[36:39], v[12:15], a[8:15], v3
  v_add_f32 v60, v60, v61
  v_smfmac_f32_16x16x64_bf16 v[36:39], v[16:19], a[16:23], v3
  v_add_f32 v62, v62, v63
  s_waitcnt lgkmcnt(4)
  v_smfmac_f32_16x16x64_bf16 v[64:67], v[24:27], v[84:91], v3
  v_cvt_pk_bf16_f32 v60, v60, v62
  v_smfmac_f32_16x16x64_bf16 v[36:39], v[20:23], a[24:31], v3
  ds_write_b32 v106, v60
  v_smfmac_f32_16x16x64_bf16 v[36:39], v[24:27], a[32:39], v3
  s_waitcnt lgkmcnt(2)
  v_smfmac_f32_16x16x64_bf16 v[64:67], v[28:31], v[92:99], v3
  v_smfmac_f32_16x16x64_bf16 v[36:39], v[28:31], a[40:47], v3
  v_smfmac_f32_16x16x64_bf16 v[36:39], v[32:35], a[48:55], v3
  s_waitcnt lgkmcnt(0)
  v_smfmac_f32_16x16x64_bf16 v[64:67], v[32:35], v[76:83], v3
  v_smfmac_f32_16x16x64_bf16 v[40:43], v[8:11], a[56:63], v3
  v_smfmac_f32_16x16x64_bf16 v[40:43], v[12:15], a[64:71], v3
  v_add_f32 v36, v36, v37
  v_smfmac_f32_16x16x64_bf16 v[40:43], v[16:19], a[72:79], v3
  v_add_f32 v38, v38, v39
  v_smfmac_f32_16x16x64_bf16 v[40:43], v[20:23], a[80:87], v3
  v_cvt_pk_bf16_f32 v36, v36, v38
  v_smfmac_f32_16x16x64_bf16 v[40:43], v[24:27], a[88:95], v3
  ds_write_b32 v100, v36
  v_smfmac_f32_16x16x64_bf16 v[40:43], v[28:31], a[96:103], v3
  v_add_f32 v64, v64, v65
  v_smfmac_f32_16x16x64_bf16 v[40:43], v[32:35], a[104:111], v3
  v_add_f32 v66, v66, v67
  v_smfmac_f32_16x16x64_bf16 v[44:47], v[8:11], a[112:119], v3
  v_cvt_pk_bf16_f32 v64, v64, v66
  v_smfmac_f32_16x16x64_bf16 v[44:47], v[12:15], a[120:127], v3
  ds_write_b32 v107, v64
  v_smfmac_f32_16x16x64_bf16 v[44:47], v[16:19], a[128:135], v3
  v_add_f32 v40, v40, v41
  v_smfmac_f32_16x16x64_bf16 v[44:47], v[20:23], a[136:143], v3
  v_add_f32 v42, v42, v43
  v_smfmac_f32_16x16x64_bf16 v[44:47], v[24:27], a[144:151], v3
  v_cvt_pk_bf16_f32 v40, v40, v42
  v_smfmac_f32_16x16x64_bf16 v[44:47], v[28:31], a[152:159], v3
  ds_write_b32 v101, v40
  v_smfmac_f32_16x16x64_bf16 v[44:47], v[32:35], a[160:167], v3
  v_smfmac_f32_16x16x64_bf16 v[48:51], v[8:11], a[168:175], v3
  v_smfmac_f32_16x16x64_bf16 v[48:51], v[12:15], a[176:183], v3
  v_smfmac_f32_16x16x64_bf16 v[48:51], v[16:19], a[184:191], v3
  v_add_f32 v44, v44, v45
  v_smfmac_f32_16x16x64_bf16 v[48:51], v[20:23], a[192:199], v3
  v_add_f32 v46, v46, v47
  v_smfmac_f32_16x16x64_bf16 v[48:51], v[24:27], a[200:207], v3
  v_cvt_pk_bf16_f32 v44, v44, v46
  v_smfmac_f32_16x16x64_bf16 v[48:51], v[28:31], a[208:215], v3
  ds_write_b32 v102, v44
  v_smfmac_f32_16x16x64_bf16 v[48:51], v[32:35], a[216:223], v3
  v_smfmac_f32_16x16x64_bf16 v[52:55], v[8:11], a[224:231], v3
  v_smfmac_f32_16x16x64_bf16 v[52:55], v[12:15], a[232:239], v3
  v_smfmac_f32_16x16x64_bf16 v[52:55], v[16:19], a[240:247], v3
  v_add_f32 v48, v48, v49
  v_smfmac_f32_16x16x64_bf16 v[52:55], v[20:23], a[248:255], v3
  v_add_f32 v50, v50, v51
  v_smfmac_f32_16x16x64_bf16 v[52:55], v[24:27], v[120:127], v3
  v_cvt_pk_bf16_f32 v48, v48, v50
  v_smfmac_f32_16x16x64_bf16 v[52:55], v[28:31], v[128:135], v3
  ds_write_b32 v103, v48
  v_smfmac_f32_16x16x64_bf16 v[52:55], v[32:35], v[136:143], v3
  v_smfmac_f32_16x16x64_bf16 v[56:59], v[8:11], v[144:151], v3
  v_smfmac_f32_16x16x64_bf16 v[56:59], v[12:15], v[152:159], v3
  v_smfmac_f32_16x16x64_bf16 v[56:59], v[16:19], v[160:167], v3
  v_add_f32 v52, v52, v53
  v_smfmac_f32_16x16x64_bf16 v[56:59], v[20:23], v[168:175], v3
  v_add_f32 v54, v54, v55
  v_smfmac_f32_16x16x64_bf16 v[56:59], v[24:27], v[176:183], v3
  v_cvt_pk_bf16_f32 v52, v52, v54
  v_smfmac_f32_16x16x64_bf16 v[56:59], v[28:31], v[184:191], v3
  ds_write_b32 v104, v52
  v_smfmac_f32_16x16x64_bf16 v[56:59], v[32:35], v[192:199], v3
  s_nop 7
  v_add_f32 v56, v56, v57
  v_add_f32 v58, v58, v59
  v_cvt_pk_bf16_f32 v56, v56, v58
  ds_write_b32 v105, v56
  s_waitcnt lgkmcnt(0)
  s_barrier
  s_cmp_eq_u32 s19, 62
  s_cbranch_scc1 cA_done
  s_waitcnt vmcnt(0) lgkmcnt(0)
  s_add_u32 s19, s19, 1
  s_mov_b32 s20, s21
  s_branch cA_va2_loop
cA_va2_retry:
  s_waitcnt lgkmcnt(0)
  buffer_load_dwordx4 v[8:11], v2, s[8:11], s20 offen offset:0 sc1
  buffer_load_dwordx4 v[12:15], v2, s[8:11], s20 offen offset:1024 sc1
  buffer_load_dwordx4 v[16:19], v2, s[8:11], s20 offen offset:2048 sc1
  buffer_load_dwordx4 v[20:23], v2, s[8:11], s20 offen offset:3072 sc1
  s_add_u32 s31, s31, 1
  s_add_u32 s30, s30, 1
  s_cmp_lt_u32 s30, 400000
  s_cbranch_scc1 cA_va2_ld
  s_branch cA_abort
cA_va2_last:
  s_waitcnt lgkmcnt(0)
  buffer_store_dwordx4 v[100:103], v2, s[8:11], s24 offen offset:0 sc1
  buffer_store_dwordx4 v[104:107], v2, s[8:11], s24 offen offset:1024 sc1
  buffer_store_dwordx4 v[108:111], v2, s[8:11], s24 offen offset:2048 sc1
  buffer_store_dwordx4 v[4:7], v2, s[8:11], s24 offen offset:3072 sc1
  s_add_u32 s24, s24, 8192
  s_waitcnt vmcnt(0)
  s_mov_b64 exec, 1
  buffer_store_dword v117, v2, s[8:11], s34 offen sc1
  s_mov_b64 exec, -1
  s_add_u32 s34, s34, 8
  s_mov_b64 exec, 1
  buffer_store_dword v117, v2, s[8:11], s34 offen sc1
  s_mov_b64 exec, -1
  s_add_u32 s34, s34, 8
  s_branch cA_done
.p2align 6

cA_va3_loop:
  s_add_u32 s23, s20, 4096
  s_add_u32 s21, s20, 20480
  v_mov_b32 v36, 0
  v_mov_b32 v37, 0
  v_mov_b32 v38, 0
  v_mov_b32 v39, 0
  v_mov_b32 v40, 0
  v_mov_b32 v41, 0
  v_mov_b32 v42, 0
  v_mov_b32 v43, 0
  v_mov_b32 v44, 0
  v_mov_b32 v45, 0
  v_mov_b32 v46, 0
  v_mov_b32 v47, 0
  v_mov_b32 v48, 0
  v_mov_b32 v49, 0
  v_mov_b32 v50, 0
  v_mov_b32 v51, 0
  v_mov_b32 v52, 0
  v_mov_b32 v53, 0
  v_mov_b32 v54, 0
  v_mov_b32 v55, 0
  v_mov_b32 v56, 0
  v_mov_b32 v57, 0
  v_mov_b32 v58, 0
  v_mov_b32 v59, 0
  v_mov_b32 v60, 0
  v_mov_b32 v61, 0
  v_mov_b32 v62, 0
  v_mov_b32 v63, 0
  v_mov_b32 v64, 0
  v_mov_b32 v65, 0
  v_mov_b32 v66, 0
  v_mov_b32 v67, 0
  s_mov_b32 s30, 0
  buffer_load_dword v76, v119, s[8:11], s20 offen sc1
  buffer_load_dword v77, v119, s[8:11], s20 offen sc1
  buffer_load_dword v78, v119, s[8:11], s20 offen sc1
cA_va3_fp_l:
  s_waitcnt vmcnt(2)
  v_cmp_eq_u32 vcc, -1, v76
  s_cbranch_vccz cA_va3_fp_d
  buffer_load_dword v76, v119, s[8:11], s20 offen sc1
  s_waitcnt vmcnt(2)
  v_cmp_eq_u32 vcc, -1, v77
  s_cbranch_vccz cA_va3_fp_d
  buffer_load_dword v77, v119, s[8:11], s20 offen sc1
  s_waitcnt vmcnt(2)
  v_cmp_eq_u32 vcc, -1, v78
  s_cbranch_vccz cA_va3_fp_d
  buffer_load_dword v78, v119, s[8:11], s20 offen sc1
  s_add_u32 s30, s30, 1
  s_cmp_lt_u32 s30, 400000
  s_cbranch_scc1 cA_va3_fp_l
  s_branch cA_abort
cA_va3_fp_d:
  buffer_load_dwordx4 v[24:27], v2, s[8:11], s23 offen offset:0 sc1
  buffer_load_dwordx4 v[28:31], v2, s[8:11], s23 offen offset:1024 sc1
  buffer_load_dwordx4 v[32:35], v2, s[8:11], s23 offen offset:2048 sc1
  s_barrier
cA_va3_ld:
  s_waitcnt vmcnt(0)
  v_max3_u32 v84, v24, v25, v26
  v_max3_u32 v84, v84, v27, v28
  v_max3_u32 v84, v84, v29, v30
  v_max3_u32 v84, v84, v31, v32
  v_max3_u32 v84, v84, v33, v34
  v_max_u32 v84, v84, v35
  v_cmp_eq_u32 vcc, -1, v84
  ds_write_b128 v2, v[24:27] offset:12288
  ds_write_b128 v2, v[28:31] offset:13312
  ds_write_b128 v2, v[32:35] offset:14336
  s_cbranch_vccnz cA_va3_retry
  s_waitcnt lgkmcnt(0)
  s_barrier
  ds_read_b128 v[8:11], v5 offset:8192
  ds_read_b128 v[12:15], v5 offset:9216
  ds_read_b128 v[16:19], v5 offset:10240
  ds_read_b128 v[20:23], v5 offset:11264
  ds_read_b128 v[24:27], v5 offset:12288
  ds_read_b128 v[28:31], v5 offset:13312
  ds_read_b128 v[32:35], v5 offset:14336
  s_waitcnt lgkmcnt(0)
  s_cmp_eq_u32 s19, 63
  s_cbranch_scc1 cA_done
  ds_read_b128 v[76:79], v1 offset:0
  ds_read_b128 v[80:83], v1 offset:1024
  ds_read_b128 v[84:87], v1 offset:2048
  ds_read_b128 v[88:91], v1 offset:3072
  ds_read_b128 v[92:95], v1 offset:4096
  ds_read_b128 v[96:99], v1 offset:5120
  v_smfmac_f32_16x16x64_bf16 v[60:63], v[8:11], v[200:207], v3
  v_smfmac_f32_16x16x64_bf16 v[60:63], v[12:15], v[208:215], v3
  s_waitcnt lgkmcnt(4)
  v_smfmac_f32_16x16x64_bf16 v[64:67], v[8:11], v[76:83], v3
  ds_read_b128 v[76:79], v1 offset:6144
  ds_read_b128 v[80:83], v1 offset:7168
  v_smfmac_f32_16x16x64_bf16 v[60:63], v[16:19], v[216:223], v3
  v_smfmac_f32_16x16x64_bf16 v[60:63], v[20:23], v[224:231], v3
  s_waitcnt lgkmcnt(4)
  v_smfmac_f32_16x16x64_bf16 v[64:67], v[12:15], v[84:91], v3
  ds_read_b128 v[84:87], v1 offset:8192
  ds_read_b128 v[88:91], v1 offset:9216
  v_smfmac_f32_16x16x64_bf16 v[60:63], v[24:27], v[232:239], v3
  v_smfmac_f32_16x16x64_bf16 v[60:63], v[28:31], v[240:247], v3
  s_waitcnt lgkmcnt(4)
  v_smfmac_f32_16x16x64_bf16 v[64:67], v[16:19], v[92:99], v3
  ds_read_b128 v[92:95], v1 offset:10240
  ds_read_b128 v[96:99], v1 offset:11264
  v_smfmac_f32_16x16x64_bf16 v[60:63], v[32:35], v[248:255], v3
  v_smfmac_f32_16x16x64_bf16 v[36:39], v[8:11], a[0:7], v3
  s_waitcnt lgkmcnt(4)
  v_smfmac_f32_16x16x64_bf16 v[64:67], v[20:23], v[76:83], v3
  ds_read_b128 v[76:79], v1 offset:12288
  ds_read_b128 v[80:83], v1 offset:13312
  v_smfmac_f32_16x16x64_bf16 v[36:39], v[12:15], a[8:15], v3
  v_add_f32 v60, v60, v61
  v_smfmac_f32_16x16x64_bf16 v[36:39], v[16:19], a[16:23], v3
  v_add_f32 v62, v62, v63
  s_waitcnt lgkmcnt(4)
  v_smfmac_f32_16x16x64_bf16 v[64:67], v[24:27], v[84:91], v3
  v_cvt_pk_bf16_f32 v60, v60, v62
  v_smfmac_f32_16x16x64_bf16 v[36:39], v[20:23], a[24:31], v3
  ds_write_b32 v106, v60
  v_smfmac_f32_16x16x64_bf16 v[36:39], v[24:27], a[32:39], v3
  s_waitcnt lgkmcnt(2)
  v_smfmac_f32_16x16x64_bf16 v[64:67], v[28:31], v[92:99], v3
  v_smfmac_f32_16x16x64_bf16 v[36:39], v[28:31], a[40:47], v3
  v_smfmac_f32_16x16x64_bf16 v[36:39], v[32:35], a[48:55], v3
  s_waitcnt lgkmcnt(0)
  v_smfmac_f32_16x16x64_bf16 v[64:67], v[32:35], v[76:83], v3
  v_smfmac_f32_16x16x64_bf16 v[40:43], v[8:11], a[56:63], v3
  v_smfmac_f32_16x16x64_bf16 v[40:43], v[12:15], a[64:71], v3
  v_add_f32 v36, v36, v37
  v_smfmac_f32_16x16x64_bf16 v[40:43], v[16:19], a[72:79], v3
  v_add_f32 v38, v38, v39
  v_smfmac_f32_16x16x64_bf16 v[40:43], v[20:23], a[80:87], v3
  v_cvt_pk_bf16_f32 v36, v36, v38
  v_smfmac_f32_16x16x64_bf16 v[40:43], v[24:27], a[88:95], v3
  ds_write_b32 v100, v36
  v_smfmac_f32_16x16x64_bf16 v[40:43], v[28:31], a[96:103], v3
  v_add_f32 v64, v64, v65
  v_smfmac_f32_16x16x64_bf16 v[40:43], v[32:35], a[104:111], v3
  v_add_f32 v66, v66, v67
  v_smfmac_f32_16x16x64_bf16 v[44:47], v[8:11], a[112:119], v3
  v_cvt_pk_bf16_f32 v64, v64, v66
  v_smfmac_f32_16x16x64_bf16 v[44:47], v[12:15], a[120:127], v3
  ds_write_b32 v107, v64
  v_smfmac_f32_16x16x64_bf16 v[44:47], v[16:19], a[128:135], v3
  v_add_f32 v40, v40, v41
  v_smfmac_f32_16x16x64_bf16 v[44:47], v[20:23], a[136:143], v3
  v_add_f32 v42, v42, v43
  v_smfmac_f32_16x16x64_bf16 v[44:47], v[24:27], a[144:151], v3
  v_cvt_pk_bf16_f32 v40, v40, v42
  v_smfmac_f32_16x16x64_bf16 v[44:47], v[28:31], a[152:159], v3
  ds_write_b32 v101, v40
  v_smfmac_f32_16x16x64_bf16 v[44:47], v[32:35], a[160:167], v3
  v_smfmac_f32_16x16x64_bf16 v[48:51], v[8:11], a[168:175], v3
  v_smfmac_f32_16x16x64_bf16 v[48:51], v[12:15], a[176:183], v3
  v_smfmac_f32_16x16x64_bf16 v[48:51], v[16:19], a[184:191], v3
  v_add_f32 v44, v44, v45
  v_smfmac_f32_16x16x64_bf16 v[48:51], v[20:23], a[192:199], v3
  v_add_f32 v46, v46, v47
  v_smfmac_f32_16x16x64_bf16 v[48:51], v[24:27], a[200:207], v3
  v_cvt_pk_bf16_f32 v44, v44, v46
  v_smfmac_f32_16x16x64_bf16 v[48:51], v[28:31], a[208:215], v3
  ds_write_b32 v102, v44
  v_smfmac_f32_16x16x64_bf16 v[48:51], v[32:35], a[216:223], v3
  v_smfmac_f32_16x16x64_bf16 v[52:55], v[8:11], a[224:231], v3
  v_smfmac_f32_16x16x64_bf16 v[52:55], v[12:15], a[232:239], v3
  v_smfmac_f32_16x16x64_bf16 v[52:55], v[16:19], a[240:247], v3
  v_add_f32 v48, v48, v49
  v_smfmac_f32_16x16x64_bf16 v[52:55], v[20:23], a[248:255], v3
  v_add_f32 v50, v50, v51
  v_smfmac_f32_16x16x64_bf16 v[52:55], v[24:27], v[120:127], v3
  v_cvt_pk_bf16_f32 v48, v48, v50
  v_smfmac_f32_16x16x64_bf16 v[52:55], v[28:31], v[128:135], v3
  ds_write_b32 v103, v48
  v_smfmac_f32_16x16x64_bf16 v[52:55], v[32:35], v[136:143], v3
  v_smfmac_f32_16x16x64_bf16 v[56:59], v[8:11], v[144:151], v3
  v_smfmac_f32_16x16x64_bf16 v[56:59], v[12:15], v[152:159], v3
  v_smfmac_f32_16x16x64_bf16 v[56:59], v[16:19], v[160:167], v3
  v_add_f32 v52, v52, v53
  v_smfmac_f32_16x16x64_bf16 v[56:59], v[20:23], v[168:175], v3
  v_add_f32 v54, v54, v55
  v_smfmac_f32_16x16x64_bf16 v[56:59], v[24:27], v[176:183], v3
  v_cvt_pk_bf16_f32 v52, v52, v54
  v_smfmac_f32_16x16x64_bf16 v[56:59], v[28:31], v[184:191], v3
  ds_write_b32 v104, v52
  v_smfmac_f32_16x16x64_bf16 v[56:59], v[32:35], v[192:199], v3
  s_nop 7
  v_add_f32 v56, v56, v57
  v_add_f32 v58, v58, v59
  v_cvt_pk_bf16_f32 v56, v56, v58
  ds_write_b32 v105, v56
  s_waitcnt lgkmcnt(0)
  s_barrier
  s_cmp_eq_u32 s19, 62
  s_cbranch_scc1 cA_done
  s_waitcnt vmcnt(0) lgkmcnt(0)
  s_add_u32 s19, s19, 1
  s_mov_b32 s20, s21
  s_branch cA_va3_loop
cA_va3_retry:
  s_waitcnt lgkmcnt(0)
  buffer_load_dwordx4 v[24:27], v2, s[8:11], s23 offen offset:0 sc1
  buffer_load_dwordx4 v[28:31], v2, s[8:11], s23 offen offset:1024 sc1
  buffer_load_dwordx4 v[32:35], v2, s[8:11], s23 offen offset:2048 sc1
  s_add_u32 s31, s31, 1
  s_add_u32 s30, s30, 1
  s_cmp_lt_u32 s30, 400000
  s_cbranch_scc1 cA_va3_ld
  s_branch cA_abort
cA_va3_last:
  s_waitcnt lgkmcnt(0)
  buffer_store_dwordx4 v[100:103], v2, s[8:11], s24 offen offset:0 sc1
  buffer_store_dwordx4 v[104:107], v2, s[8:11], s24 offen offset:1024 sc1
  buffer_store_dwordx4 v[108:111], v2, s[8:11], s24 offen offset:2048 sc1
  buffer_store_dwordx4 v[4:7], v2, s[8:11], s24 offen offset:3072 sc1
  s_add_u32 s24, s24, 8192
  s_waitcnt vmcnt(0)
  s_mov_b64 exec, 1
  buffer_store_dword v117, v2, s[8:11], s34 offen sc1
  s_mov_b64 exec, -1
  s_add_u32 s34, s34, 8
  s_mov_b64 exec, 1
  buffer_store_dword v117, v2, s[8:11], s34 offen sc1
  s_mov_b64 exec, -1
  s_add_u32 s34, s34, 8
  s_branch cA_done
cA_abort:
  v_mov_b32 v4, 0xdead
  v_mov_b32 v5, 16
  buffer_store_dword v4, v5, s[12:15], 0 offen
  s_branch ch_end
cA_done:
  s_branch ch_end
.p2align 6

cB_sc0_loop:
  s_add_u32 s23, s20, 4096
  s_add_u32 s21, s20, 20480
  v_mov_b32 v48, 0
  v_mov_b32 v49, 0
  v_mov_b32 v50, 0
  v_mov_b32 v51, 0
  v_mov_b32 v52, 0
  v_mov_b32 v53, 0
  v_mov_b32 v54, 0
  v_mov_b32 v55, 0
  v_mov_b32 v56, 0
  v_mov_b32 v57, 0
  v_mov_b32 v58, 0
  v_mov_b32 v59, 0
  v_mov_b32 v60, 0
  v_mov_b32 v61, 0
  v_mov_b32 v62, 0
  v_mov_b32 v63, 0
  v_mov_b32 v88, 0
  v_mov_b32 v89, 0
  v_mov_b32 v90, 0
  v_mov_b32 v91, 0
  v_mov_b32 v92, 0
  v_mov_b32 v93, 0
  v_mov_b32 v94, 0
  v_mov_b32 v95, 0
  v_mov_b32 v66, 0
  v_mov_b32 v67, 0
  s_mov_b32 s30, 0
  s_mov_b32 s62, 0
  buffer_load_dword v68, v0, s[8:11], s20 offen sc1
  s_nop 7
  buffer_load_dword v69, v0, s[8:11], s20 offen sc1
  s_nop 7
  buffer_load_dword v70, v0, s[8:11], s20 offen sc1
  s_nop 7
  buffer_load_dword v71, v0, s[8:11], s20 offen sc1
  s_nop 7
  buffer_load_dword v72, v0, s[8:11], s20 offen sc1
cB_sc0_fp_l:
  s_waitcnt vmcnt(4)
  v_cmp_eq_u32 vcc, -1, v68
  s_cbranch_vccz cB_sc0_fp_d
  buffer_load_dword v68, v0, s[8:11], s20 offen sc1
  s_waitcnt vmcnt(4)
  v_cmp_eq_u32 vcc, -1, v69
  s_cbranch_vccz cB_sc0_fp_d
  buffer_load_dword v69, v0, s[8:11], s20 offen sc1
  s_waitcnt vmcnt(4)
  v_cmp_eq_u32 vcc, -1, v70
  s_cbranch_vccz cB_sc0_fp_d
  buffer_load_dword v70, v0, s[8:11], s20 offen sc1
  s_waitcnt vmcnt(4)
  v_cmp_eq_u32 vcc, -1, v71
  s_cbranch_vccz cB_sc0_fp_d
  buffer_load_dword v71, v0, s[8:11], s20 offen sc1
  s_waitcnt vmcnt(4)
  v_cmp_eq_u32 vcc, -1, v72
  s_cbranch_vccz cB_sc0_fp_d
  buffer_load_dword v72, v0, s[8:11], s20 offen sc1
  s_add_u32 s30, s30, 1
  s_cmp_lt_u32 s30, 400000
  s_cbranch_scc1 cB_sc0_fp_l
  s_branch cB_abort
cB_sc0_fp_d:
  buffer_load_dwordx4 v[8:11], v2, s[8:11], s20 offen offset:0 sc1
  s_barrier
  s_branch cB_sc0_ld1
cB_sc0_ld:
  buffer_load_dwordx4 v[8:11], v2, s[8:11], s20 offen offset:0 sc1
cB_sc0_ld1:
  v_mov_b32 v36, 0
  v_mov_b32 v37, 0
  v_mov_b32 v38, 0
  v_mov_b32 v39, 0
  buffer_load_dwordx4 v[12:15], v2, s[8:11], s20 offen offset:1024 sc1
  v_mov_b32 v40, 0
  v_mov_b32 v41, 0
  v_mov_b32 v42, 0
  v_mov_b32 v43, 0
  buffer_load_dwordx4 v[16:19], v2, s[8:11], s20 offen offset:2048 sc1
  v_mov_b32 v44, 0
  v_mov_b32 v45, 0
  v_mov_b32 v46, 0
  v_mov_b32 v47, 0
  ds_read_b128 v[96:99], v117 offset:0
  ds_read_b128 v[100:103], v117 offset:1024
  ds_read_b128 v[104:107], v117 offset:14336
  ds_read_b128 v[108:111], v117 offset:15360
  s_waitcnt vmcnt(2)
  v_smfmac_f32_16x16x64_bf16 v[36:39], v[8:11], a[0:7], v3
  v_smfmac_f32_16x16x64_bf16 v[40:43], v[8:11], a[56:63], v3
  buffer_load_dwordx4 v[20:23], v2, s[8:11], s20 offen offset:3072 sc1
  v_smfmac_f32_16x16x64_bf16 v[44:47], v[8:11], a[112:119], v3
  v_smfmac_f32_16x16x64_bf16 v[48:51], v[8:11], a[168:175], v3
  v_smfmac_f32_16x16x64_bf16 v[52:55], v[8:11], a[224:231], v3
  buffer_load_dwordx4 v[24:27], v2, s[8:11], s23 offen offset:0 sc1
  v_smfmac_f32_16x16x64_bf16 v[56:59], v[8:11], v[144:151], v3
  v_smfmac_f32_16x16x64_bf16 v[60:63], v[8:11], v[200:207], v3
  s_waitcnt vmcnt(3)
  v_smfmac_f32_16x16x64_bf16 v[36:39], v[12:15], a[8:15], v3
  v_smfmac_f32_16x16x64_bf16 v[40:43], v[12:15], a[64:71], v3
  buffer_load_dwordx4 v[28:31], v2, s[8:11], s23 offen offset:1024 sc1
  v_smfmac_f32_16x16x64_bf16 v[44:47], v[12:15], a[120:127], v3
  v_smfmac_f32_16x16x64_bf16 v[48:51], v[12:15], a[176:183], v3
  v_smfmac_f32_16x16x64_bf16 v[52:55], v[12:15], a[232:239], v3
  buffer_load_dwordx4 v[32:35], v2, s[8:11], s23 offen offset:2048 sc1
  v_smfmac_f32_16x16x64_bf16 v[56:59], v[12:15], v[152:159], v3
  v_smfmac_f32_16x16x64_bf16 v[60:63], v[12:15], v[208:215], v3
  s_xor_b32 s58, s25, 28672
  s_add_u32 s59, s24, 28672
  s_add_u32 m0, s58, 0
  s_waitcnt vmcnt(4)
  v_smfmac_f32_16x16x64_bf16 v[36:39], v[16:19], a[16:23], v3
  buffer_load_dwordx4 v2, s[8:11], s59 offen offset:0 sc1 lds
  v_smfmac_f32_16x16x64_bf16 v[40:43], v[16:19], a[72:79], v3
  v_smfmac_f32_16x16x64_bf16 v[44:47], v[16:19], a[128:135], v3
  v_smfmac_f32_16x16x64_bf16 v[48:51], v[16:19], a[184:191], v3
  v_smfmac_f32_16x16x64_bf16 v[52:55], v[16:19], a[240:247], v3
  buffer_load_dwordx4 v2, s[8:11], s59 offen offset:1024 sc1 lds
  v_smfmac_f32_16x16x64_bf16 v[56:59], v[16:19], v[160:167], v3
  v_smfmac_f32_16x16x64_bf16 v[60:63], v[16:19], v[216:223], v3
  s_waitcnt vmcnt(5)
  v_smfmac_f32_16x16x64_bf16 v[36:39], v[20:23], a[24:31], v3
  v_smfmac_f32_16x16x64_bf16 v[40:43], v[20:23], a[80:87], v3
  buffer_load_dwordx4 v2, s[8:11], s59 offen offset:2048 sc1 lds
  v_smfmac_f32_16x16x64_bf16 v[44:47], v[20:23], a[136:143], v3
  v_smfmac_f32_16x16x64_bf16 v[48:51], v[20:23], a[192:199], v3
  v_smfmac_f32_16x16x64_bf16 v[52:55], v[20:23], a[248:255], v3
  v_smfmac_f32_16x16x64_bf16 v[56:59], v[20:23], v[168:175], v3
  buffer_load_dwordx4 v2, s[8:11], s59 offen offset:3072 sc1 lds
  v_smfmac_f32_16x16x64_bf16 v[60:63], v[20:23], v[224:231], v3
  s_waitcnt vmcnt(4)
cB_sc0_ph2:
  v_smfmac_f32_16x16x64_bf16 v[60:63], v[24:27], v[232:239], v3
  ds_read_b128 v[12:15], v116 offset:0
  ds_read_b128 v[16:19], v116 offset:1024
  v_smfmac_f32_16x16x64_bf16 v[60:63], v[28:31], v[240:247], v3
  v_smfmac_f32_16x16x64_bf16 v[60:63], v[32:35], v[248:255], v3
  v_mov_b32 v80, v24
  v_smfmac_f32_16x16x64_bf16 v[52:55], v[24:27], v[120:127], v3
  v_mov_b32 v81, v25
  v_smfmac_f32_16x16x64_bf16 v[52:55], v[28:31], v[128:135], v3
  v_mov_b32 v82, v32
  v_smfmac_f32_16x16x64_bf16 v[52:55], v[32:35], v[136:143], v3
  v_cvt_pk_bf16_f32 v64, v60, v61
  v_smfmac_f32_16x16x64_bf16 v[56:59], v[24:27], v[176:183], v3
  v_cvt_pk_bf16_f32 v65, v62, v63
  v_smfmac_f32_16x16x64_bf16 v[56:59], v[28:31], v[184:191], v3
  v_mov_b32 v83, v33
  v_mfma_f32_16x16x32_bf16 v[68:71], v[64:67], v[4:7], 0
  v_smfmac_f32_16x16x64_bf16 v[56:59], v[32:35], v[192:199], v3
  v_cvt_pk_bf16_f32 v64, v52, v53
  v_smfmac_f32_16x16x64_bf16 v[36:39], v[24:27], a[32:39], v3
  v_cvt_pk_bf16_f32 v65, v54, v55
  v_smfmac_f32_16x16x64_bf16 v[36:39], v[28:31], a[40:47], v3
  v_cvt_pk_bf16_f32 v78, v68, v69
  v_smfmac_f32_16x16x64_bf16 v[36:39], v[32:35], a[48:55], v3
  v_cvt_pk_bf16_f32 v79, v70, v71
  v_cvt_pk_bf16_f32 v66, v56, v57
  v_smfmac_f32_16x16x64_bf16 v[40:43], v[24:27], a[88:95], v3
  v_cvt_pk_bf16_f32 v67, v58, v59
  v_smfmac_f32_16x16x64_bf16 v[40:43], v[28:31], a[96:103], v3
  v_mfma_f32_16x16x32_bf16 v[72:75], v[64:67], v[4:7], 0
  ds_read_b128 v[52:55], v116 offset:14336
  ds_read_b128 v[56:59], v116 offset:15360
  v_smfmac_f32_16x16x64_bf16 v[40:43], v[32:35], a[104:111], v3
  v_cvt_pk_bf16_f32 v64, v36, v37
  v_smfmac_f32_16x16x64_bf16 v[44:47], v[24:27], a[144:151], v3
  v_cvt_pk_bf16_f32 v65, v38, v39
  v_smfmac_f32_16x16x64_bf16 v[44:47], v[28:31], a[152:159], v3
  v_cvt_pk_bf16_f32 v76, v72, v73
  v_smfmac_f32_16x16x64_bf16 v[44:47], v[32:35], a[160:167], v3
  v_cvt_pk_bf16_f32 v77, v74, v75
  v_cvt_pk_bf16_f32 v66, v40, v41
  v_smfmac_f32_16x16x64_bf16 v[48:51], v[24:27], a[200:207], v3
  v_cvt_pk_bf16_f32 v67, v42, v43
  v_smfmac_f32_16x16x64_bf16 v[48:51], v[28:31], a[208:215], v3
  v_mfma_f32_16x16x32_bf16 v[68:71], v[64:67], v[4:7], 0
  v_smfmac_f32_16x16x64_bf16 v[48:51], v[32:35], a[216:223], v3
  v_cvt_pk_bf16_f32 v64, v44, v45
  v_mfma_f32_16x16x32_bf16 v[84:87], v[80:83], v[76:79], 0
  v_cvt_pk_bf16_f32 v65, v46, v47
  s_waitcnt lgkmcnt(0)
  v_smfmac_f32_16x16x64_bf16 v[88:91], v[76:79], v[96:103], v118
  v_cvt_pk_bf16_f32 v60, v68, v69
  v_cvt_pk_bf16_f32 v61, v70, v71
  v_cvt_pk_bf16_f32 v66, v48, v49
  v_cvt_pk_bf16_f32 v67, v50, v51
  s_nop 1
  v_mfma_f32_16x16x32_bf16 v[72:75], v[64:67], v[4:7], 0
  v_smfmac_f32_16x16x64_bf16 v[92:95], v[76:79], v[104:111], v118
  s_nop 4
  v_cvt_pk_bf16_f32 v62, v72, v73
  v_cvt_pk_bf16_f32 v63, v74, v75
  s_nop 1
  v_mfma_f32_16x16x32_bf16 v[84:87], v[8:11], v[60:63], v[84:87]
  v_smfmac_f32_16x16x64_bf16 v[88:91], v[60:63], v[12:19], v118
  v_smfmac_f32_16x16x64_bf16 v[92:95], v[60:63], v[52:59], v118
  s_nop 1
  v_permlane32_swap_b32 v84, v86
  v_permlane32_swap_b32 v85, v87
  s_nop 0
  v_add_f32 v88, v88, v89
  v_add_f32_dpp v84, v86, v84 quad_perm:[1,0,3,2] row_mask:0xf bank_mask:0xf
  v_add_f32_dpp v85, v87, v85 quad_perm:[1,0,3,2] row_mask:0xf bank_mask:0xf
  v_add_f32 v89, v90, v91
  ds_write2_b32 v113, v84, v85 offset0:0 offset1:4
  ds_write2_b32 v112, v88, v89 offset0:0 offset1:128
  v_add_f32 v90, v92, v93
  v_add_f32 v91, v94, v95
  ds_write2_b32 v112, v90, v91 offset0:64 offset1:192
  v_cmp_u_f32 vcc, v88, v89
  s_cbranch_vccnz cB_sc0_retry
cB_sc0_cont:
  s_waitcnt lgkmcnt(0)
  s_barrier
  ds_read_b128 v[36:39], v114
  ds_read_b128 v[44:47], v115
  s_waitcnt lgkmcnt(0)
  v_add_f32 v36, v36, v38
  v_add_f32 v37, v37, v39
  v_add_f32 v44, v44, v45
  v_add_f32 v46, v46, v47
  v_add_f32 v44, v44, v46
  v_add_f32 v36, v36, v37
  v_exp_f32 v49, v44
  v_exp_f32 v48, v36
  v_add_f32 v50, abs(v36), abs(v44)
  v_fma_f32 v39, v49, s37, v48
  v_cmp_ngt_f32 vcc, s56, v50
  v_cndmask_b32 v41, v48, v49, s[38:39]
  v_add_f32_dpp v39, v39, v39 quad_perm:[1,0,3,2] row_mask:0xf bank_mask:0xf
  v_cndmask_b32 v40, v49, v48, s[38:39]
  v_mov_b32_dpp v46, v41 quad_perm:[1,0,3,2] row_mask:0xf bank_mask:0xf
  v_add_f32_dpp v39, v39, v39 quad_perm:[2,3,0,1] row_mask:0xf bank_mask:0xf
  v_cndmask_b32 v42, v46, v40, s[38:39]
  v_cndmask_b32 v43, v40, v46, s[38:39]
  v_add_f32_dpp v39, v39, v39 row_half_mirror row_mask:0xf bank_mask:0xf
  s_cbranch_vccnz cB_sc0_slow
  s_nop 0
  v_add_f32_dpp v47, v39, v39 row_mirror row_mask:0xf bank_mask:0xf
  v_add_f32_dpp v39, v39, v39 row_mirror row_mask:0xf bank_mask:0xf
  s_nop 1
  v_permlane16_swap_b32 v39, v47
  v_add_f32 v39, v39, v47
  v_rcp_f32 v39, v39
  s_mov_b64 exec, s[28:29]
  v_mul_f32 v42, v42, v39
  v_mul_f32 v43, v43, v39
  v_cvt_pk_bf16_f32 v42, v42, v43
cB_sc0_pst:
  buffer_store_dword v42, v1, s[8:11], s20 offen sc1
  s_mov_b64 exec, -1
  s_barrier
  s_add_u32 s24, s24, 28672
  s_add_u32 s35, s35, 28672
  s_xor_b32 s25, s25, 28672
  s_add_u32 m0, s25, 0
  s_add_u32 m0, s25, 4096
  s_add_u32 s22, s24, 4096
  buffer_load_dwordx4 v2, s[8:11], s22 offen offset:0 sc1 lds
  s_nop 5
  buffer_load_dwordx4 v2, s[8:11], s22 offen offset:1024 sc1 lds
  s_nop 5
  buffer_load_dwordx4 v2, s[8:11], s22 offen offset:2048 sc1 lds
  s_nop 5
  v_xor_b32 v116, 28672, v116
  v_add_u32 v117, s57, v117
  s_sub_u32 s57, 0, s57
  s_add_u32 s19, s19, 1
  s_mov_b32 s20, s21
  s_cmp_lt_u32 s19, 63
  s_cbranch_scc1 cB_sc0_loop
  s_branch cB_done
cB_sc0_slow:
  v_max_f32 v50, v36, v44
  s_nop 1
  v_max_f32_dpp v50, v50, v50 quad_perm:[1,0,3,2] row_mask:0xf bank_mask:0xf
  s_nop 1
  v_max_f32_dpp v50, v50, v50 quad_perm:[2,3,0,1] row_mask:0xf bank_mask:0xf
  s_nop 1
  v_max_f32_dpp v50, v50, v50 row_half_mirror row_mask:0xf bank_mask:0xf
  s_nop 1
  v_max_f32_dpp v50, v50, v50 row_mirror row_mask:0xf bank_mask:0xf
  v_mov_b32 v47, v50
  s_nop 1
  v_permlane16_swap_b32 v50, v47
  v_max_f32 v50, v50, v47
  v_sub_f32 v48, v36, v50
  v_sub_f32 v49, v44, v50
  v_exp_f32 v48, v48
  v_exp_f32 v49, v49
  s_add_u32 s31, s31, 0x100
  v_fma_f32 v39, v49, s37, v48
  v_cndmask_b32 v41, v48, v49, s[38:39]
  s_nop 0
  v_add_f32_dpp v39, v39, v39 quad_perm:[1,0,3,2] row_mask:0xf bank_mask:0xf
  v_cndmask_b32 v40, v49, v48, s[38:39]
  v_mov_b32_dpp v46, v41 quad_perm:[1,0,3,2] row_mask:0xf bank_mask:0xf
  v_add_f32_dpp v39, v39, v39 quad_perm:[2,3,0,1] row_mask:0xf bank_mask:0xf
  v_cndmask_b32 v42, v46, v40, s[38:39]
  v_cndmask_b32 v43, v40, v46, s[38:39]
  v_add_f32_dpp v39, v39, v39 row_half_mirror row_mask:0xf bank_mask:0xf
  s_nop 1
  v_add_f32_dpp v47, v39, v39 row_mirror row_mask:0xf bank_mask:0xf
  v_add_f32_dpp v39, v39, v39 row_mirror row_mask:0xf bank_mask:0xf
  s_nop 1
  v_permlane16_swap_b32 v39, v47
  v_add_f32 v39, v39, v47
  v_rcp_f32 v39, v39
  s_mov_b64 exec, s[28:29]
  v_mul_f32 v42, v42, v39
  v_mul_f32 v43, v43, v39
  v_cvt_pk_bf16_f32 v42, v42, v43
  v_min_u32 v42, -2, v42
  s_branch cB_sc0_pst
cB_sc0_retry:
  s_cmp_lg_u32 s62, 0
  s_cbranch_scc1 cB_sc0_cont
  s_waitcnt vmcnt(0) lgkmcnt(0)
cB_sc0_rv:
  buffer_load_dwordx4 v[8:11], v2, s[8:11], s20 offen offset:0 sc1
  buffer_load_dwordx4 v[12:15], v2, s[8:11], s20 offen offset:1024 sc1
  buffer_load_dwordx4 v[16:19], v2, s[8:11], s20 offen offset:2048 sc1
  buffer_load_dwordx4 v[20:23], v2, s[8:11], s20 offen offset:3072 sc1
  buffer_load_dwordx4 v[24:27], v2, s[8:11], s23 offen offset:0 sc1
  buffer_load_dwordx4 v[28:31], v2, s[8:11], s23 offen offset:1024 sc1
  buffer_load_dwordx4 v[32:35], v2, s[8:11], s23 offen offset:2048 sc1
  s_waitcnt vmcnt(0)
  v_max3_u32 v68, v8, v9, v10
  v_max3_u32 v68, v68, v11, v12
  v_max3_u32 v68, v68, v13, v14
  v_max3_u32 v68, v68, v15, v16
  v_max3_u32 v68, v68, v17, v18
  v_max3_u32 v68, v68, v19, v20
  v_max3_u32 v68, v68, v21, v22
  v_max3_u32 v68, v68, v23, v24
  v_max3_u32 v68, v68, v25, v26
  v_max3_u32 v68, v68, v27, v28
  v_max3_u32 v68, v68, v29, v30
  v_max3_u32 v68, v68, v31, v32
  v_max3_u32 v68, v68, v33, v34
  v_max_u32 v68, v68, v35
  v_cmp_eq_u32 vcc, -1, v68
  s_cbranch_vccz cB_sc0_rk
  s_add_u32 s30, s30, 1
  s_cmp_lt_u32 s30, 400000
  s_cbranch_scc1 cB_sc0_rv
  s_branch cB_abort
cB_sc0_rk:
  s_mov_b32 s62, 1
  v_mov_b32 v36, 0
  v_mov_b32 v37, 0
  v_mov_b32 v38, 0
  v_mov_b32 v39, 0
  v_mov_b32 v40, 0
  v_mov_b32 v41, 0
  v_mov_b32 v42, 0
  v_mov_b32 v43, 0
  v_mov_b32 v44, 0
  v_mov_b32 v45, 0
  v_mov_b32 v46, 0
  v_mov_b32 v47, 0
  v_mov_b32 v48, 0
  v_mov_b32 v49, 0
  v_mov_b32 v50, 0
  v_mov_b32 v51, 0
  v_mov_b32 v52, 0
  v_mov_b32 v53, 0
  v_mov_b32 v54, 0
  v_mov_b32 v55, 0
  v_mov_b32 v56, 0
  v_mov_b32 v57, 0
  v_mov_b32 v58, 0
  v_mov_b32 v59, 0
  v_mov_b32 v60, 0
  v_mov_b32 v61, 0
  v_mov_b32 v62, 0
  v_mov_b32 v63, 0
  v_mov_b32 v88, 0
  v_mov_b32 v89, 0
  v_mov_b32 v90, 0
  v_mov_b32 v91, 0
  v_mov_b32 v92, 0
  v_mov_b32 v93, 0
  v_mov_b32 v94, 0
  v_mov_b32 v95, 0
  v_mov_b32 v66, 0
  v_mov_b32 v67, 0
  s_add_u32 s31, s31, 1
  ds_read_b128 v[96:99], v117 offset:0
  ds_read_b128 v[100:103], v117 offset:1024
  ds_read_b128 v[104:107], v117 offset:14336
  ds_read_b128 v[108:111], v117 offset:15360
  v_smfmac_f32_16x16x64_bf16 v[36:39], v[8:11], a[0:7], v3
  v_smfmac_f32_16x16x64_bf16 v[40:43], v[8:11], a[56:63], v3
  v_smfmac_f32_16x16x64_bf16 v[44:47], v[8:11], a[112:119], v3
  v_smfmac_f32_16x16x64_bf16 v[48:51], v[8:11], a[168:175], v3
  v_smfmac_f32_16x16x64_bf16 v[52:55], v[8:11], a[224:231], v3
  v_smfmac_f32_16x16x64_bf16 v[56:59], v[8:11], v[144:151], v3
  v_smfmac_f32_16x16x64_bf16 v[60:63], v[8:11], v[200:207], v3
  v_smfmac_f32_16x16x64_bf16 v[36:39], v[12:15], a[8:15], v3
  v_smfmac_f32_16x16x64_bf16 v[40:43], v[12:15], a[64:71], v3
  v_smfmac_f32_16x16x64_bf16 v[44:47], v[12:15], a[120:127], v3
  v_smfmac_f32_16x16x64_bf16 v[48:51], v[12:15], a[176:183], v3
  v_smfmac_f32_16x16x64_bf16 v[52:55], v[12:15], a[232:239], v3
  v_smfmac_f32_16x16x64_bf16 v[56:59], v[12:15], v[152:159], v3
  v_smfmac_f32_16x16x64_bf16 v[60:63], v[12:15], v[208:215], v3
  v_smfmac_f32_16x16x64_bf16 v[36:39], v[16:19], a[16:23], v3
  v_smfmac_f32_16x16x64_bf16 v[40:43], v[16:19], a[72:79], v3
  v_smfmac_f32_16x16x64_bf16 v[44:47], v[16:19], a[128:135], v3
  v_smfmac_f32_16x16x64_bf16 v[48:51], v[16:19], a[184:191], v3
  v_smfmac_f32_16x16x64_bf16 v[52:55], v[16:19], a[240:247], v3
  v_smfmac_f32_16x16x64_bf16 v[56:59], v[16:19], v[160:167], v3
  v_smfmac_f32_16x16x64_bf16 v[60:63], v[16:19], v[216:223], v3
  v_smfmac_f32_16x16x64_bf16 v[36:39], v[20:23], a[24:31], v3
  v_smfmac_f32_16x16x64_bf16 v[40:43], v[20:23], a[80:87], v3
  v_smfmac_f32_16x16x64_bf16 v[44:47], v[20:23], a[136:143], v3
  v_smfmac_f32_16x16x64_bf16 v[48:51], v[20:23], a[192:199], v3
  v_smfmac_f32_16x16x64_bf16 v[52:55], v[20:23], a[248:255], v3
  v_smfmac_f32_16x16x64_bf16 v[56:59], v[20:23], v[168:175], v3
  v_smfmac_f32_16x16x64_bf16 v[60:63], v[20:23], v[224:231], v3
  s_xor_b32 s58, s25, 28672
  s_add_u32 s59, s24, 28672
  s_add_u32 m0, s58, 0
  s_branch cB_sc0_ph2
.p2align 6

cB_sc1_loop:
  s_add_u32 s23, s20, 4096
  s_add_u32 s21, s20, 20480
  v_mov_b32 v48, 0
  v_mov_b32 v49, 0
  v_mov_b32 v50, 0
  v_mov_b32 v51, 0
  v_mov_b32 v52, 0
  v_mov_b32 v53, 0
  v_mov_b32 v54, 0
  v_mov_b32 v55, 0
  v_mov_b32 v56, 0
  v_mov_b32 v57, 0
  v_mov_b32 v58, 0
  v_mov_b32 v59, 0
  v_mov_b32 v60, 0
  v_mov_b32 v61, 0
  v_mov_b32 v62, 0
  v_mov_b32 v63, 0
  v_mov_b32 v88, 0
  v_mov_b32 v89, 0
  v_mov_b32 v90, 0
  v_mov_b32 v91, 0
  v_mov_b32 v92, 0
  v_mov_b32 v93, 0
  v_mov_b32 v94, 0
  v_mov_b32 v95, 0
  v_mov_b32 v64, 0
  v_mov_b32 v65, 0
  s_mov_b32 s30, 0
  s_mov_b32 s62, 0
  s_waitcnt vmcnt(0)
  s_barrier
cB_sc1_ld:
  buffer_load_dwordx4 v[8:11], v2, s[8:11], s20 offen offset:0 sc1
  v_mov_b32 v36, 0
  v_mov_b32 v37, 0
  v_mov_b32 v38, 0
  v_mov_b32 v39, 0
  buffer_load_dwordx4 v[12:15], v2, s[8:11], s20 offen offset:1024 sc1
  v_mov_b32 v40, 0
  v_mov_b32 v41, 0
  v_mov_b32 v42, 0
  v_mov_b32 v43, 0
  buffer_load_dwordx4 v[16:19], v2, s[8:11], s20 offen offset:2048 sc1
  v_mov_b32 v44, 0
  v_mov_b32 v45, 0
  v_mov_b32 v46, 0
  v_mov_b32 v47, 0
  ds_read_b128 v[96:99], v117 offset:0
  ds_read_b128 v[100:103], v117 offset:1024
  ds_read_b128 v[104:107], v117 offset:14336
  ds_read_b128 v[108:111], v117 offset:15360
  s_waitcnt vmcnt(2)
  v_smfmac_f32_16x16x64_bf16 v[36:39], v[8:11], a[0:7], v3
  v_smfmac_f32_16x16x64_bf16 v[40:43], v[8:11], a[56:63], v3
  buffer_load_dwordx4 v[20:23], v2, s[8:11], s20 offen offset:3072 sc1
  v_smfmac_f32_16x16x64_bf16 v[44:47], v[8:11], a[112:119], v3
  v_smfmac_f32_16x16x64_bf16 v[48:51], v[8:11], a[168:175], v3
  v_smfmac_f32_16x16x64_bf16 v[52:55], v[8:11], a[224:231], v3
  buffer_load_dwordx4 v[24:27], v2, s[8:11], s23 offen offset:0 sc1
  v_smfmac_f32_16x16x64_bf16 v[56:59], v[8:11], v[144:151], v3
  v_smfmac_f32_16x16x64_bf16 v[60:63], v[8:11], v[200:207], v3
  s_waitcnt vmcnt(3)
  v_smfmac_f32_16x16x64_bf16 v[36:39], v[12:15], a[8:15], v3
  v_smfmac_f32_16x16x64_bf16 v[40:43], v[12:15], a[64:71], v3
  buffer_load_dwordx4 v[28:31], v2, s[8:11], s23 offen offset:1024 sc1
  v_smfmac_f32_16x16x64_bf16 v[44:47], v[12:15], a[120:127], v3
  v_smfmac_f32_16x16x64_bf16 v[48:51], v[12:15], a[176:183], v3
  v_smfmac_f32_16x16x64_bf16 v[52:55], v[12:15], a[232:239], v3
  buffer_load_dwordx4 v[32:35], v2, s[8:11], s23 offen offset:2048 sc1
  v_smfmac_f32_16x16x64_bf16 v[56:59], v[12:15], v[152:159], v3
  v_smfmac_f32_16x16x64_bf16 v[60:63], v[12:15], v[208:215], v3
  s_waitcnt vmcnt(4)
  v_smfmac_f32_16x16x64_bf16 v[36:39], v[16:19], a[16:23], v3
  s_xor_b32 s58, s25, 28672
  s_add_u32 s59, s24, 28672
  s_add_u32 m0, s58, 7168
  v_smfmac_f32_16x16x64_bf16 v[40:43], v[16:19], a[72:79], v3
  buffer_load_dwordx4 v2, s[8:11], s59 offen offset:0 sc1 lds
  v_smfmac_f32_16x16x64_bf16 v[44:47], v[16:19], a[128:135], v3
  v_smfmac_f32_16x16x64_bf16 v[48:51], v[16:19], a[184:191], v3
  v_smfmac_f32_16x16x64_bf16 v[52:55], v[16:19], a[240:247], v3
  v_smfmac_f32_16x16x64_bf16 v[56:59], v[16:19], v[160:167], v3
  buffer_load_dwordx4 v2, s[8:11], s59 offen offset:1024 sc1 lds
  v_smfmac_f32_16x16x64_bf16 v[60:63], v[16:19], v[216:223], v3
  s_waitcnt vmcnt(5)
  v_smfmac_f32_16x16x64_bf16 v[36:39], v[20:23], a[24:31], v3
  v_smfmac_f32_16x16x64_bf16 v[40:43], v[20:23], a[80:87], v3
  v_smfmac_f32_16x16x64_bf16 v[44:47], v[20:23], a[136:143], v3
  buffer_load_dwordx4 v2, s[8:11], s59 offen offset:2048 sc1 lds
  v_smfmac_f32_16x16x64_bf16 v[48:51], v[20:23], a[192:199], v3
  v_smfmac_f32_16x16x64_bf16 v[52:55], v[20:23], a[248:255], v3
  v_smfmac_f32_16x16x64_bf16 v[56:59], v[20:23], v[168:175], v3
  v_smfmac_f32_16x16x64_bf16 v[60:63], v[20:23], v[224:231], v3
  buffer_load_dwordx4 v2, s[8:11], s59 offen offset:3072 sc1 lds
  s_waitcnt vmcnt(4)
cB_sc1_ph2:
  v_smfmac_f32_16x16x64_bf16 v[60:63], v[24:27], v[232:239], v3
  ds_read_b128 v[16:19], v116 offset:2048
  ds_read_b128 v[20:23], v116 offset:3072
  v_smfmac_f32_16x16x64_bf16 v[60:63], v[28:31], v[240:247], v3
  buffer_load_dword v119, v0, s[8:11], s20 offen sc1
  v_smfmac_f32_16x16x64_bf16 v[60:63], v[32:35], v[248:255], v3
  v_mov_b32 v80, v26
  v_smfmac_f32_16x16x64_bf16 v[52:55], v[24:27], v[120:127], v3
  v_mov_b32 v81, v27
  v_smfmac_f32_16x16x64_bf16 v[52:55], v[28:31], v[128:135], v3
  v_mov_b32 v82, v32
  v_smfmac_f32_16x16x64_bf16 v[52:55], v[32:35], v[136:143], v3
  v_cvt_pk_bf16_f32 v66, v60, v61
  v_smfmac_f32_16x16x64_bf16 v[56:59], v[24:27], v[176:183], v3
  v_cvt_pk_bf16_f32 v67, v62, v63
  v_smfmac_f32_16x16x64_bf16 v[56:59], v[28:31], v[184:191], v3
  v_mov_b32 v83, v33
  v_mfma_f32_16x16x32_bf16 v[68:71], v[64:67], v[4:7], 0
  v_smfmac_f32_16x16x64_bf16 v[56:59], v[32:35], v[192:199], v3
  v_cvt_pk_bf16_f32 v64, v52, v53
  v_smfmac_f32_16x16x64_bf16 v[36:39], v[24:27], a[32:39], v3
  v_cvt_pk_bf16_f32 v65, v54, v55
  v_smfmac_f32_16x16x64_bf16 v[36:39], v[28:31], a[40:47], v3
  v_cvt_pk_bf16_f32 v78, v68, v69
  v_smfmac_f32_16x16x64_bf16 v[36:39], v[32:35], a[48:55], v3
  v_cvt_pk_bf16_f32 v79, v70, v71
  v_cvt_pk_bf16_f32 v66, v56, v57
  v_smfmac_f32_16x16x64_bf16 v[40:43], v[24:27], a[88:95], v3
  v_cvt_pk_bf16_f32 v67, v58, v59
  v_smfmac_f32_16x16x64_bf16 v[40:43], v[28:31], a[96:103], v3
  v_mfma_f32_16x16x32_bf16 v[72:75], v[64:67], v[4:7], 0
  ds_read_b128 v[52:55], v116 offset:16384
  ds_read_b128 v[56:59], v116 offset:17408
  v_smfmac_f32_16x16x64_bf16 v[40:43], v[32:35], a[104:111], v3
  v_cvt_pk_bf16_f32 v64, v36, v37
  v_smfmac_f32_16x16x64_bf16 v[44:47], v[24:27], a[144:151], v3
  v_cvt_pk_bf16_f32 v65, v38, v39
  v_smfmac_f32_16x16x64_bf16 v[44:47], v[28:31], a[152:159], v3
  v_cvt_pk_bf16_f32 v76, v72, v73
  v_smfmac_f32_16x16x64_bf16 v[44:47], v[32:35], a[160:167], v3
  v_cvt_pk_bf16_f32 v77, v74, v75
  v_cvt_pk_bf16_f32 v66, v40, v41
  v_smfmac_f32_16x16x64_bf16 v[48:51], v[24:27], a[200:207], v3
  v_cvt_pk_bf16_f32 v67, v42, v43
  v_smfmac_f32_16x16x64_bf16 v[48:51], v[28:31], a[208:215], v3
  v_mfma_f32_16x16x32_bf16 v[68:71], v[64:67], v[4:7], 0
  v_smfmac_f32_16x16x64_bf16 v[48:51], v[32:35], a[216:223], v3
  v_cvt_pk_bf16_f32 v64, v44, v45
  v_mfma_f32_16x16x32_bf16 v[84:87], v[80:83], v[76:79], 0
  v_cvt_pk_bf16_f32 v65, v46, v47
  s_waitcnt lgkmcnt(0)
  v_smfmac_f32_16x16x64_bf16 v[88:91], v[76:79], v[96:103], v118
  v_cvt_pk_bf16_f32 v60, v68, v69
  v_cvt_pk_bf16_f32 v61, v70, v71
  v_cvt_pk_bf16_f32 v66, v48, v49
  v_cvt_pk_bf16_f32 v67, v50, v51
  s_nop 1
  v_mfma_f32_16x16x32_bf16 v[72:75], v[64:67], v[4:7], 0
  v_smfmac_f32_16x16x64_bf16 v[92:95], v[76:79], v[104:111], v118
  s_nop 4
  v_cvt_pk_bf16_f32 v62, v72, v73
  v_cvt_pk_bf16_f32 v63, v74, v75
  s_nop 1
  v_mfma_f32_16x16x32_bf16 v[84:87], v[12:15], v[60:63], v[84:87]
  v_smfmac_f32_16x16x64_bf16 v[88:91], v[60:63], v[16:23], v118
  v_smfmac_f32_16x16x64_bf16 v[92:95], v[60:63], v[52:59], v118
  s_nop 1
  v_permlane32_swap_b32 v84, v86
  v_permlane32_swap_b32 v85, v87
  s_nop 0
  v_add_f32 v88, v88, v89
  v_add_f32_dpp v84, v86, v84 quad_perm:[1,0,3,2] row_mask:0xf bank_mask:0xf
  v_add_f32_dpp v85, v87, v85 quad_perm:[1,0,3,2] row_mask:0xf bank_mask:0xf
  v_add_f32 v89, v90, v91
  ds_write2_b32 v113, v84, v85 offset0:0 offset1:4
  ds_write2_b32 v112, v88, v89 offset0:0 offset1:128
  v_add_f32 v90, v92, v93
  v_add_f32 v91, v94, v95
  ds_write2_b32 v112, v90, v91 offset0:64 offset1:192
  v_cmp_u_f32 vcc, v88, v89
  s_cbranch_vccnz cB_sc1_retry
cB_sc1_cont:
  s_waitcnt lgkmcnt(0)
  s_barrier
  ds_read_b128 v[36:39], v114
  ds_read_b128 v[44:47], v115
  s_waitcnt lgkmcnt(0)
  v_add_f32 v36, v36, v38
  v_add_f32 v37, v37, v39
  v_add_f32 v44, v44, v45
  v_add_f32 v46, v46, v47
  v_add_f32 v44, v44, v46
  v_add_f32 v36, v36, v37
  v_exp_f32 v49, v44
  v_exp_f32 v48, v36
  v_add_f32 v50, abs(v36), abs(v44)
  v_fma_f32 v39, v49, s37, v48
  v_cmp_ngt_f32 vcc, s56, v50
  v_cndmask_b32 v41, v48, v49, s[38:39]
  v_add_f32_dpp v39, v39, v39 quad_perm:[1,0,3,2] row_mask:0xf bank_mask:0xf
  v_cndmask_b32 v40, v49, v48, s[38:39]
  v_mov_b32_dpp v46, v41 quad_perm:[1,0,3,2] row_mask:0xf bank_mask:0xf
  v_add_f32_dpp v39, v39, v39 quad_perm:[2,3,0,1] row_mask:0xf bank_mask:0xf
  v_cndmask_b32 v42, v46, v40, s[38:39]
  v_cndmask_b32 v43, v40, v46, s[38:39]
  v_add_f32_dpp v39, v39, v39 row_half_mirror row_mask:0xf bank_mask:0xf
  s_cbranch_vccnz cB_sc1_slow
  s_nop 0
  v_add_f32_dpp v47, v39, v39 row_mirror row_mask:0xf bank_mask:0xf
  v_add_f32_dpp v39, v39, v39 row_mirror row_mask:0xf bank_mask:0xf
  s_nop 1
  v_permlane16_swap_b32 v39, v47
  v_add_f32 v39, v39, v47
  v_rcp_f32 v39, v39
  s_mov_b64 exec, s[28:29]
  v_mul_f32 v42, v42, v39
  v_mul_f32 v43, v43, v39
  v_cvt_pk_bf16_f32 v42, v42, v43
cB_sc1_pst:
  buffer_store_dword v42, v1, s[8:11], s20 offen sc1
  s_mov_b64 exec, -1
  s_barrier
  s_add_u32 s24, s24, 28672
  s_add_u32 s35, s35, 28672
  s_xor_b32 s25, s25, 28672
  s_add_u32 m0, s25, 7168
  s_add_u32 m0, s25, 11264
  s_add_u32 s22, s24, 4096
  buffer_load_dwordx4 v2, s[8:11], s22 offen offset:0 sc1 lds
  s_nop 5
  buffer_load_dwordx4 v2, s[8:11], s22 offen offset:1024 sc1 lds
  s_nop 5
  buffer_load_dwordx4 v2, s[8:11], s22 offen offset:2048 sc1 lds
  s_nop 5
  v_xor_b32 v116, 28672, v116
  v_add_u32 v117, s57, v117
  s_sub_u32 s57, 0, s57
  s_add_u32 s19, s19, 1
  s_mov_b32 s20, s21
  s_cmp_lt_u32 s19, 63
  s_cbranch_scc1 cB_sc1_loop
  s_branch cB_done
cB_sc1_slow:
  v_max_f32 v50, v36, v44
  s_nop 1
  v_max_f32_dpp v50, v50, v50 quad_perm:[1,0,3,2] row_mask:0xf bank_mask:0xf
  s_nop 1
  v_max_f32_dpp v50, v50, v50 quad_perm:[2,3,0,1] row_mask:0xf bank_mask:0xf
  s_nop 1
  v_max_f32_dpp v50, v50, v50 row_half_mirror row_mask:0xf bank_mask:0xf
  s_nop 1
  v_max_f32_dpp v50, v50, v50 row_mirror row_mask:0xf bank_mask:0xf
  v_mov_b32 v47, v50
  s_nop 1
  v_permlane16_swap_b32 v50, v47
  v_max_f32 v50, v50, v47
  v_sub_f32 v48, v36, v50
  v_sub_f32 v49, v44, v50
  v_exp_f32 v48, v48
  v_exp_f32 v49, v49
  s_add_u32 s31, s31, 0x100
  v_fma_f32 v39, v49, s37, v48
  v_cndmask_b32 v41, v48, v49, s[38:39]
  s_nop 0
  v_add_f32_dpp v39, v39, v39 quad_perm:[1,0,3,2] row_mask:0xf bank_mask:0xf
  v_cndmask_b32 v40, v49, v48, s[38:39]
  v_mov_b32_dpp v46, v41 quad_perm:[1,0,3,2] row_mask:0xf bank_mask:0xf
  v_add_f32_dpp v39, v39, v39 quad_perm:[2,3,0,1] row_mask:0xf bank_mask:0xf
  v_cndmask_b32 v42, v46, v40, s[38:39]
  v_cndmask_b32 v43, v40, v46, s[38:39]
  v_add_f32_dpp v39, v39, v39 row_half_mirror row_mask:0xf bank_mask:0xf
  s_nop 1
  v_add_f32_dpp v47, v39, v39 row_mirror row_mask:0xf bank_mask:0xf
  v_add_f32_dpp v39, v39, v39 row_mirror row_mask:0xf bank_mask:0xf
  s_nop 1
  v_permlane16_swap_b32 v39, v47
  v_add_f32 v39, v39, v47
  v_rcp_f32 v39, v39
  s_mov_b64 exec, s[28:29]
  v_mul_f32 v42, v42, v39
  v_mul_f32 v43, v43, v39
  v_cvt_pk_bf16_f32 v42, v42, v43
  v_min_u32 v42, -2, v42
  s_branch cB_sc1_pst
cB_sc1_retry:
  s_cmp_lg_u32 s62, 0
  s_cbranch_scc1 cB_sc1_cont
  s_waitcnt vmcnt(0) lgkmcnt(0)
cB_sc1_rv:
  buffer_load_dwordx4 v[8:11], v2, s[8:11], s20 offen offset:0 sc1
  buffer_load_dwordx4 v[12:15], v2, s[8:11], s20 offen offset:1024 sc1
  buffer_load_dwordx4 v[16:19], v2, s[8:11], s20 offen offset:2048 sc1
  buffer_load_dwordx4 v[20:23], v2, s[8:11], s20 offen offset:3072 sc1
  buffer_load_dwordx4 v[24:27], v2, s[8:11], s23 offen offset:0 sc1
  buffer_load_dwordx4 v[28:31], v2, s[8:11], s23 offen offset:1024 sc1
  buffer_load_dwordx4 v[32:35], v2, s[8:11], s23 offen offset:2048 sc1
  s_waitcnt vmcnt(0)
  v_max3_u32 v68, v8, v9, v10
  v_max3_u32 v68, v68, v11, v12
  v_max3_u32 v68, v68, v13, v14
  v_max3_u32 v68, v68, v15, v16
  v_max3_u32 v68, v68, v17, v18
  v_max3_u32 v68, v68, v19, v20
  v_max3_u32 v68, v68, v21, v22
  v_max3_u32 v68, v68, v23, v24
  v_max3_u32 v68, v68, v25, v26
  v_max3_u32 v68, v68, v27, v28
  v_max3_u32 v68, v68, v29, v30
  v_max3_u32 v68, v68, v31, v32
  v_max3_u32 v68, v68, v33, v34
  v_max_u32 v68, v68, v35
  v_cmp_eq_u32 vcc, -1, v68
  s_cbranch_vccz cB_sc1_rk
  s_add_u32 s30, s30, 1
  s_cmp_lt_u32 s30, 400000
  s_cbranch_scc1 cB_sc1_rv
  s_branch cB_abort
cB_sc1_rk:
  s_mov_b32 s62, 1
  v_mov_b32 v36, 0
  v_mov_b32 v37, 0
  v_mov_b32 v38, 0
  v_mov_b32 v39, 0
  v_mov_b32 v40, 0
  v_mov_b32 v41, 0
  v_mov_b32 v42, 0
  v_mov_b32 v43, 0
  v_mov_b32 v44, 0
  v_mov_b32 v45, 0
  v_mov_b32 v46, 0
  v_mov_b32 v47, 0
  v_mov_b32 v48, 0
  v_mov_b32 v49, 0
  v_mov_b32 v50, 0
  v_mov_b32 v51, 0
  v_mov_b32 v52, 0
  v_mov_b32 v53, 0
  v_mov_b32 v54, 0
  v_mov_b32 v55, 0
  v_mov_b32 v56, 0
  v_mov_b32 v57, 0
  v_mov_b32 v58, 0
  v_mov_b32 v59, 0
  v_mov_b32 v60, 0
  v_mov_b32 v61, 0
  v_mov_b32 v62, 0
  v_mov_b32 v63, 0
  v_mov_b32 v88, 0
  v_mov_b32 v89, 0
  v_mov_b32 v90, 0
  v_mov_b32 v91, 0
  v_mov_b32 v92, 0
  v_mov_b32 v93, 0
  v_mov_b32 v94, 0
  v_mov_b32 v95, 0
  v_mov_b32 v64, 0
  v_mov_b32 v65, 0
  s_add_u32 s31, s31, 1
  ds_read_b128 v[96:99], v117 offset:0
  ds_read_b128 v[100:103], v117 offset:1024
  ds_read_b128 v[104:107], v117 offset:14336
  ds_read_b128 v[108:111], v117 offset:15360
  v_smfmac_f32_16x16x64_bf16 v[36:39], v[8:11], a[0:7], v3
  v_smfmac_f32_16x16x64_bf16 v[40:43], v[8:11], a[56:63], v3
  v_smfmac_f32_16x16x64_bf16 v[44:47], v[8:11], a[112:119], v3
  v_smfmac_f32_16x16x64_bf16 v[48:51], v[8:11], a[168:175], v3
  v_smfmac_f32_16x16x64_bf16 v[52:55], v[8:11], a[224:231], v3
  v_smfmac_f32_16x16x64_bf16 v[56:59], v[8:11], v[144:151], v3
  v_smfmac_f32_16x16x64_bf16 v[60:63], v[8:11], v[200:207], v3
  v_smfmac_f32_16x16x64_bf16 v[36:39], v[12:15], a[8:15], v3
  v_smfmac_f32_16x16x64_bf16 v[40:43], v[12:15], a[64:71], v3
  v_smfmac_f32_16x16x64_bf16 v[44:47], v[12:15], a[120:127], v3
  v_smfmac_f32_16x16x64_bf16 v[48:51], v[12:15], a[176:183], v3
  v_smfmac_f32_16x16x64_bf16 v[52:55], v[12:15], a[232:239], v3
  v_smfmac_f32_16x16x64_bf16 v[56:59], v[12:15], v[152:159], v3
  v_smfmac_f32_16x16x64_bf16 v[60:63], v[12:15], v[208:215], v3
  v_smfmac_f32_16x16x64_bf16 v[36:39], v[16:19], a[16:23], v3
  v_smfmac_f32_16x16x64_bf16 v[40:43], v[16:19], a[72:79], v3
  v_smfmac_f32_16x16x64_bf16 v[44:47], v[16:19], a[128:135], v3
  v_smfmac_f32_16x16x64_bf16 v[48:51], v[16:19], a[184:191], v3
  v_smfmac_f32_16x16x64_bf16 v[52:55], v[16:19], a[240:247], v3
  v_smfmac_f32_16x16x64_bf16 v[56:59], v[16:19], v[160:167], v3
  v_smfmac_f32_16x16x64_bf16 v[60:63], v[16:19], v[216:223], v3
  v_smfmac_f32_16x16x64_bf16 v[36:39], v[20:23], a[24:31], v3
  v_smfmac_f32_16x16x64_bf16 v[40:43], v[20:23], a[80:87], v3
  v_smfmac_f32_16x16x64_bf16 v[44:47], v[20:23], a[136:143], v3
  v_smfmac_f32_16x16x64_bf16 v[48:51], v[20:23], a[192:199], v3
  v_smfmac_f32_16x16x64_bf16 v[52:55], v[20:23], a[248:255], v3
  v_smfmac_f32_16x16x64_bf16 v[56:59], v[20:23], v[168:175], v3
  v_smfmac_f32_16x16x64_bf16 v[60:63], v[20:23], v[224:231], v3
  s_xor_b32 s58, s25, 28672
  s_add_u32 s59, s24, 28672
  s_add_u32 m0, s58, 7168
  s_branch cB_sc1_ph2
.p2align 6

cB_sc2_loop:
  s_add_u32 s23, s20, 4096
  s_add_u32 s21, s20, 20480
  v_mov_b32 v48, 0
  v_mov_b32 v49, 0
  v_mov_b32 v50, 0
  v_mov_b32 v51, 0
  v_mov_b32 v52, 0
  v_mov_b32 v53, 0
  v_mov_b32 v54, 0
  v_mov_b32 v55, 0
  v_mov_b32 v56, 0
  v_mov_b32 v57, 0
  v_mov_b32 v58, 0
  v_mov_b32 v59, 0
  v_mov_b32 v60, 0
  v_mov_b32 v61, 0
  v_mov_b32 v62, 0
  v_mov_b32 v63, 0
  v_mov_b32 v88, 0
  v_mov_b32 v89, 0
  v_mov_b32 v90, 0
  v_mov_b32 v91, 0
  v_mov_b32 v92, 0
  v_mov_b32 v93, 0
  v_mov_b32 v94, 0
  v_mov_b32 v95, 0
  v_mov_b32 v66, 0
  v_mov_b32 v67, 0
  s_mov_b32 s30, 0
  s_mov_b32 s62, 0
  s_waitcnt vmcnt(0)
  s_barrier
cB_sc2_ld:
  buffer_load_dwordx4 v[8:11], v2, s[8:11], s20 offen offset:0 sc1
  v_mov_b32 v36, 0
  v_mov_b32 v37, 0
  v_mov_b32 v38, 0
  v_mov_b32 v39, 0
  buffer_load_dwordx4 v[12:15], v2, s[8:11], s20 offen offset:1024 sc1
  v_mov_b32 v40, 0
  v_mov_b32 v41, 0
  v_mov_b32 v42, 0
  v_mov_b32 v43, 0
  buffer_load_dwordx4 v[16:19], v2, s[8:11], s20 offen offset:2048 sc1
  v_mov_b32 v44, 0
  v_mov_b32 v45, 0
  v_mov_b32 v46, 0
  v_mov_b32 v47, 0
  ds_read_b128 v[96:99], v117 offset:0
  ds_read_b128 v[100:103], v117 offset:1024
  ds_read_b128 v[104:107], v117 offset:14336
  ds_read_b128 v[108:111], v117 offset:15360
  s_waitcnt vmcnt(2)
  v_smfmac_f32_16x16x64_bf16 v[36:39], v[8:11], a[0:7], v3
  v_smfmac_f32_16x16x64_bf16 v[40:43], v[8:11], a[56:63], v3
  buffer_load_dwordx4 v[20:23], v2, s[8:11], s20 offen offset:3072 sc1
  v_smfmac_f32_16x16x64_bf16 v[44:47], v[8:11], a[112:119], v3
  v_smfmac_f32_16x16x64_bf16 v[48:51], v[8:11], a[168:175], v3
  v_smfmac_f32_16x16x64_bf16 v[52:55], v[8:11], a[224:231], v3
  buffer_load_dwordx4 v[24:27], v2, s[8:11], s23 offen offset:0 sc1
  v_smfmac_f32_16x16x64_bf16 v[56:59], v[8:11], v[144:151], v3
  v_smfmac_f32_16x16x64_bf16 v[60:63], v[8:11], v[200:207], v3
  s_waitcnt vmcnt(3)
  v_smfmac_f32_16x16x64_bf16 v[36:39], v[12:15], a[8:15], v3
  v_smfmac_f32_16x16x64_bf16 v[40:43], v[12:15], a[64:71], v3
  buffer_load_dwordx4 v[28:31], v2, s[8:11], s23 offen offset:1024 sc1
  v_smfmac_f32_16x16x64_bf16 v[44:47], v[12:15], a[120:127], v3
  v_smfmac_f32_16x16x64_bf16 v[48:51], v[12:15], a[176:183], v3
  v_smfmac_f32_16x16x64_bf16 v[52:55], v[12:15], a[232:239], v3
  buffer_load_dwordx4 v[32:35], v2, s[8:11], s23 offen offset:2048 sc1
  v_smfmac_f32_16x16x64_bf16 v[56:59], v[12:15], v[152:159], v3
  v_smfmac_f32_16x16x64_bf16 v[60:63], v[12:15], v[208:215], v3
  s_waitcnt vmcnt(4)
  v_smfmac_f32_16x16x64_bf16 v[36:39], v[16:19], a[16:23], v3
  v_smfmac_f32_16x16x64_bf16 v[40:43], v[16:19], a[72:79], v3
  s_xor_b32 s58, s25, 28672
  s_add_u32 s59, s24, 28672
  s_add_u32 m0, s58, 14336
  v_smfmac_f32_16x16x64_bf16 v[44:47], v[16:19], a[128:135], v3
  buffer_load_dwordx4 v2, s[8:11], s59 offen offset:0 sc1 lds
  v_smfmac_f32_16x16x64_bf16 v[48:51], v[16:19], a[184:191], v3
  v_smfmac_f32_16x16x64_bf16 v[52:55], v[16:19], a[240:247], v3
  v_smfmac_f32_16x16x64_bf16 v[56:59], v[16:19], v[160:167], v3
  v_smfmac_f32_16x16x64_bf16 v[60:63], v[16:19], v[216:223], v3
  buffer_load_dwordx4 v2, s[8:11], s59 offen offset:1024 sc1 lds
  s_waitcnt vmcnt(5)
  v_smfmac_f32_16x16x64_bf16 v[36:39], v[20:23], a[24:31], v3
  v_smfmac_f32_16x16x64_bf16 v[40:43], v[20:23], a[80:87], v3
  v_smfmac_f32_16x16x64_bf16 v[44:47], v[20:23], a[136:143], v3
  v_smfmac_f32_16x16x64_bf16 v[48:51], v[20:23], a[192:199], v3
  buffer_load_dwordx4 v2, s[8:11], s59 offen offset:2048 sc1 lds
  v_smfmac_f32_16x16x64_bf16 v[52:55], v[20:23], a[248:255], v3
  v_smfmac_f32_16x16x64_bf16 v[56:59], v[20:23], v[168:175], v3
  v_smfmac_f32_16x16x64_bf16 v[60:63], v[20:23], v[224:231], v3
  s_waitcnt vmcnt(3)
cB_sc2_ph2:
  v_smfmac_f32_16x16x64_bf16 v[60:63], v[24:27], v[232:239], v3
  buffer_load_dwordx4 v2, s[8:11], s59 offen offset:3072 sc1 lds
  ds_read_b128 v[8:11], v116 offset:4096
  ds_read_b128 v[12:15], v116 offset:5120
  v_smfmac_f32_16x16x64_bf16 v[60:63], v[28:31], v[240:247], v3
  buffer_load_dword v119, v0, s[8:11], s24 offen sc1
  v_smfmac_f32_16x16x64_bf16 v[60:63], v[32:35], v[248:255], v3
  v_mov_b32 v80, v28
  v_smfmac_f32_16x16x64_bf16 v[52:55], v[24:27], v[120:127], v3
  v_mov_b32 v81, v29
  v_smfmac_f32_16x16x64_bf16 v[52:55], v[28:31], v[128:135], v3
  v_mov_b32 v82, v34
  v_smfmac_f32_16x16x64_bf16 v[52:55], v[32:35], v[136:143], v3
  v_cvt_pk_bf16_f32 v64, v60, v61
  v_smfmac_f32_16x16x64_bf16 v[56:59], v[24:27], v[176:183], v3
  v_cvt_pk_bf16_f32 v65, v62, v63
  v_smfmac_f32_16x16x64_bf16 v[56:59], v[28:31], v[184:191], v3
  v_mov_b32 v83, v35
  v_mfma_f32_16x16x32_bf16 v[68:71], v[64:67], v[4:7], 0
  v_smfmac_f32_16x16x64_bf16 v[56:59], v[32:35], v[192:199], v3
  v_cvt_pk_bf16_f32 v64, v52, v53
  v_smfmac_f32_16x16x64_bf16 v[36:39], v[24:27], a[32:39], v3
  v_cvt_pk_bf16_f32 v65, v54, v55
  v_smfmac_f32_16x16x64_bf16 v[36:39], v[28:31], a[40:47], v3
  v_cvt_pk_bf16_f32 v78, v68, v69
  v_smfmac_f32_16x16x64_bf16 v[36:39], v[32:35], a[48:55], v3
  v_cvt_pk_bf16_f32 v79, v70, v71
  v_cvt_pk_bf16_f32 v66, v56, v57
  v_smfmac_f32_16x16x64_bf16 v[40:43], v[24:27], a[88:95], v3
  v_cvt_pk_bf16_f32 v67, v58, v59
  v_smfmac_f32_16x16x64_bf16 v[40:43], v[28:31], a[96:103], v3
  v_mfma_f32_16x16x32_bf16 v[72:75], v[64:67], v[4:7], 0
  ds_read_b128 v[52:55], v116 offset:18432
  ds_read_b128 v[56:59], v116 offset:19456
  v_smfmac_f32_16x16x64_bf16 v[40:43], v[32:35], a[104:111], v3
  v_cvt_pk_bf16_f32 v64, v36, v37
  v_smfmac_f32_16x16x64_bf16 v[44:47], v[24:27], a[144:151], v3
  v_cvt_pk_bf16_f32 v65, v38, v39
  v_smfmac_f32_16x16x64_bf16 v[44:47], v[28:31], a[152:159], v3
  v_cvt_pk_bf16_f32 v76, v72, v73
  v_smfmac_f32_16x16x64_bf16 v[44:47], v[32:35], a[160:167], v3
  v_cvt_pk_bf16_f32 v77, v74, v75
  v_cvt_pk_bf16_f32 v66, v40, v41
  v_smfmac_f32_16x16x64_bf16 v[48:51], v[24:27], a[200:207], v3
  v_cvt_pk_bf16_f32 v67, v42, v43
  v_smfmac_f32_16x16x64_bf16 v[48:51], v[28:31], a[208:215], v3
  v_mfma_f32_16x16x32_bf16 v[68:71], v[64:67], v[4:7], 0
  v_smfmac_f32_16x16x64_bf16 v[48:51], v[32:35], a[216:223], v3
  v_cvt_pk_bf16_f32 v64, v44, v45
  v_mfma_f32_16x16x32_bf16 v[84:87], v[80:83], v[76:79], 0
  v_cvt_pk_bf16_f32 v65, v46, v47
  s_waitcnt lgkmcnt(0)
  v_smfmac_f32_16x16x64_bf16 v[88:91], v[76:79], v[96:103], v118
  v_cvt_pk_bf16_f32 v60, v68, v69
  v_cvt_pk_bf16_f32 v61, v70, v71
  v_cvt_pk_bf16_f32 v66, v48, v49
  v_cvt_pk_bf16_f32 v67, v50, v51
  s_nop 1
  v_mfma_f32_16x16x32_bf16 v[72:75], v[64:67], v[4:7], 0
  v_smfmac_f32_16x16x64_bf16 v[92:95], v[76:79], v[104:111], v118
  s_nop 4
  v_cvt_pk_bf16_f32 v62, v72, v73
  v_cvt_pk_bf16_f32 v63, v74, v75
  s_nop 1
  v_mfma_f32_16x16x32_bf16 v[84:87], v[16:19], v[60:63], v[84:87]
  v_smfmac_f32_16x16x64_bf16 v[88:91], v[60:63], v[8:15], v118
  v_smfmac_f32_16x16x64_bf16 v[92:95], v[60:63], v[52:59], v118
  s_nop 1
  v_permlane32_swap_b32 v84, v86
  v_permlane32_swap_b32 v85, v87
  s_nop 0
  v_add_f32 v88, v88, v89
  v_add_f32_dpp v84, v86, v84 quad_perm:[1,0,3,2] row_mask:0xf bank_mask:0xf
  v_add_f32_dpp v85, v87, v85 quad_perm:[1,0,3,2] row_mask:0xf bank_mask:0xf
  v_add_f32 v89, v90, v91
  ds_write2_b32 v113, v84, v85 offset0:0 offset1:4
  ds_write2_b32 v112, v88, v89 offset0:0 offset1:128
  v_add_f32 v90, v92, v93
  v_add_f32 v91, v94, v95
  ds_write2_b32 v112, v90, v91 offset0:64 offset1:192
  v_cmp_u_f32 vcc, v88, v89
  s_cbranch_vccnz cB_sc2_retry
cB_sc2_cont:
  s_waitcnt lgkmcnt(0)
  s_barrier
  ds_read_b128 v[36:39], v114
  ds_read_b128 v[44:47], v115
  v_lshl_add_u32 v56, v2, 3, s36
  s_waitcnt lgkmcnt(0)
  v_add_f32 v36, v36, v38
  v_add_f32 v37, v37, v39
  v_add_f32 v44, v44, v45
  s_mov_b64 exec, 15
  buffer_store_dword v2, v56, s[8:11], s20 offen sc1
  s_mov_b64 exec, -1
  v_add_f32 v46, v46, v47
  v_add_f32 v44, v44, v46
  v_add_f32 v36, v36, v37
  v_exp_f32 v49, v44
  v_exp_f32 v48, v36
  v_add_f32 v50, abs(v36), abs(v44)
  v_fma_f32 v39, v49, s37, v48
  v_cmp_ngt_f32 vcc, s56, v50
  v_cndmask_b32 v41, v48, v49, s[38:39]
  v_add_f32_dpp v39, v39, v39 quad_perm:[1,0,3,2] row_mask:0xf bank_mask:0xf
  v_cndmask_b32 v40, v49, v48, s[38:39]
  v_mov_b32_dpp v46, v41 quad_perm:[1,0,3,2] row_mask:0xf bank_mask:0xf
  v_add_f32_dpp v39, v39, v39 quad_perm:[2,3,0,1] row_mask:0xf bank_mask:0xf
  v_cndmask_b32 v42, v46, v40, s[38:39]
  v_cndmask_b32 v43, v40, v46, s[38:39]
  v_add_f32_dpp v39, v39, v39 row_half_mirror row_mask:0xf bank_mask:0xf
  s_cbranch_vccnz cB_sc2_slow
  s_nop 0
  v_add_f32_dpp v47, v39, v39 row_mirror row_mask:0xf bank_mask:0xf
  v_add_f32_dpp v39, v39, v39 row_mirror row_mask:0xf bank_mask:0xf
  s_nop 1
  v_permlane16_swap_b32 v39, v47
  v_add_f32 v39, v39, v47
  v_rcp_f32 v39, v39
  s_mov_b64 exec, s[28:29]
  v_mul_f32 v42, v42, v39
  v_mul_f32 v43, v43, v39
  v_cvt_pk_bf16_f32 v42, v42, v43
cB_sc2_pst:
  buffer_store_dword v42, v1, s[8:11], s20 offen sc1
  s_mov_b64 exec, -1
  s_barrier
  s_cmp_lg_u32 s19, 0
  s_cbranch_scc1 cB_sc2_s0
  s_sub_u32 s36, s36, 64
  v_lshl_add_u32 v56, v2, 3, s36
  s_mov_b64 exec, 15
  buffer_store_dword v2, v56, s[8:11], s20 offen sc1
  s_mov_b64 exec, -1
cB_sc2_s0:
  s_add_u32 s24, s24, 28672
  s_add_u32 s35, s35, 28672
  s_xor_b32 s25, s25, 28672
  s_add_u32 m0, s25, 14336
  s_add_u32 m0, s25, 18432
  s_add_u32 s22, s24, 4096
  buffer_load_dwordx4 v2, s[8:11], s22 offen offset:0 sc1 lds
  s_nop 5
  buffer_load_dwordx4 v2, s[8:11], s22 offen offset:1024 sc1 lds
  s_nop 5
  buffer_load_dwordx4 v2, s[8:11], s22 offen offset:2048 sc1 lds
  s_nop 5
  v_xor_b32 v116, 28672, v116
  v_add_u32 v117, s57, v117
  s_sub_u32 s57, 0, s57
  s_add_u32 s19, s19, 1
  s_mov_b32 s20, s21
  s_cmp_lt_u32 s19, 63
  s_cbranch_scc1 cB_sc2_loop
  s_branch cB_done
cB_sc2_slow:
  v_max_f32 v50, v36, v44
  s_nop 1
  v_max_f32_dpp v50, v50, v50 quad_perm:[1,0,3,2] row_mask:0xf bank_mask:0xf
  s_nop 1
  v_max_f32_dpp v50, v50, v50 quad_perm:[2,3,0,1] row_mask:0xf bank_mask:0xf
  s_nop 1
  v_max_f32_dpp v50, v50, v50 row_half_mirror row_mask:0xf bank_mask:0xf
  s_nop 1
  v_max_f32_dpp v50, v50, v50 row_mirror row_mask:0xf bank_mask:0xf
  v_mov_b32 v47, v50
  s_nop 1
  v_permlane16_swap_b32 v50, v47
  v_max_f32 v50, v50, v47
  v_sub_f32 v48, v36, v50
  v_sub_f32 v49, v44, v50
  v_exp_f32 v48, v48
  v_exp_f32 v49, v49
  s_add_u32 s31, s31, 0x100
  v_fma_f32 v39, v49, s37, v48
  v_cndmask_b32 v41, v48, v49, s[38:39]
  s_nop 0
  v_add_f32_dpp v39, v39, v39 quad_perm:[1,0,3,2] row_mask:0xf bank_mask:0xf
  v_cndmask_b32 v40, v49, v48, s[38:39]
  v_mov_b32_dpp v46, v41 quad_perm:[1,0,3,2] row_mask:0xf bank_mask:0xf
  v_add_f32_dpp v39, v39, v39 quad_perm:[2,3,0,1] row_mask:0xf bank_mask:0xf
  v_cndmask_b32 v42, v46, v40, s[38:39]
  v_cndmask_b32 v43, v40, v46, s[38:39]
  v_add_f32_dpp v39, v39, v39 row_half_mirror row_mask:0xf bank_mask:0xf
  s_nop 1
  v_add_f32_dpp v47, v39, v39 row_mirror row_mask:0xf bank_mask:0xf
  v_add_f32_dpp v39, v39, v39 row_mirror row_mask:0xf bank_mask:0xf
  s_nop 1
  v_permlane16_swap_b32 v39, v47
  v_add_f32 v39, v39, v47
  v_rcp_f32 v39, v39
  s_mov_b64 exec, s[28:29]
  v_mul_f32 v42, v42, v39
  v_mul_f32 v43, v43, v39
  v_cvt_pk_bf16_f32 v42, v42, v43
  v_min_u32 v42, -2, v42
  s_branch cB_sc2_pst
cB_sc2_retry:
  s_cmp_lg_u32 s62, 0
  s_cbranch_scc1 cB_sc2_cont
  s_waitcnt vmcnt(0) lgkmcnt(0)
cB_sc2_rv:
  buffer_load_dwordx4 v[8:11], v2, s[8:11], s20 offen offset:0 sc1
  buffer_load_dwordx4 v[12:15], v2, s[8:11], s20 offen offset:1024 sc1
  buffer_load_dwordx4 v[16:19], v2, s[8:11], s20 offen offset:2048 sc1
  buffer_load_dwordx4 v[20:23], v2, s[8:11], s20 offen offset:3072 sc1
  buffer_load_dwordx4 v[24:27], v2, s[8:11], s23 offen offset:0 sc1
  buffer_load_dwordx4 v[28:31], v2, s[8:11], s23 offen offset:1024 sc1
  buffer_load_dwordx4 v[32:35], v2, s[8:11], s23 offen offset:2048 sc1
  s_waitcnt vmcnt(0)
  v_max3_u32 v68, v8, v9, v10
  v_max3_u32 v68, v68, v11, v12
  v_max3_u32 v68, v68, v13, v14
  v_max3_u32 v68, v68, v15, v16
  v_max3_u32 v68, v68, v17, v18
  v_max3_u32 v68, v68, v19, v20
  v_max3_u32 v68, v68, v21, v22
  v_max3_u32 v68, v68, v23, v24
  v_max3_u32 v68, v68, v25, v26
  v_max3_u32 v68, v68, v27, v28
  v_max3_u32 v68, v68, v29, v30
  v_max3_u32 v68, v68, v31, v32
  v_max3_u32 v68, v68, v33, v34
  v_max_u32 v68, v68, v35
  v_cmp_eq_u32 vcc, -1, v68
  s_cbranch_vccz cB_sc2_rk
  s_add_u32 s30, s30, 1
  s_cmp_lt_u32 s30, 400000
  s_cbranch_scc1 cB_sc2_rv
  s_branch cB_abort
cB_sc2_rk:
  s_mov_b32 s62, 1
  v_mov_b32 v36, 0
  v_mov_b32 v37, 0
  v_mov_b32 v38, 0
  v_mov_b32 v39, 0
  v_mov_b32 v40, 0
  v_mov_b32 v41, 0
  v_mov_b32 v42, 0
  v_mov_b32 v43, 0
  v_mov_b32 v44, 0
  v_mov_b32 v45, 0
  v_mov_b32 v46, 0
  v_mov_b32 v47, 0
  v_mov_b32 v48, 0
  v_mov_b32 v49, 0
  v_mov_b32 v50, 0
  v_mov_b32 v51, 0
  v_mov_b32 v52, 0
  v_mov_b32 v53, 0
  v_mov_b32 v54, 0
  v_mov_b32 v55, 0
  v_mov_b32 v56, 0
  v_mov_b32 v57, 0
  v_mov_b32 v58, 0
  v_mov_b32 v59, 0
  v_mov_b32 v60, 0
  v_mov_b32 v61, 0
  v_mov_b32 v62, 0
  v_mov_b32 v63, 0
  v_mov_b32 v88, 0
  v_mov_b32 v89, 0
  v_mov_b32 v90, 0
  v_mov_b32 v91, 0
  v_mov_b32 v92, 0
  v_mov_b32 v93, 0
  v_mov_b32 v94, 0
  v_mov_b32 v95, 0
  v_mov_b32 v66, 0
  v_mov_b32 v67, 0
  s_add_u32 s31, s31, 1
  ds_read_b128 v[96:99], v117 offset:0
  ds_read_b128 v[100:103], v117 offset:1024
  ds_read_b128 v[104:107], v117 offset:14336
  ds_read_b128 v[108:111], v117 offset:15360
  v_smfmac_f32_16x16x64_bf16 v[36:39], v[8:11], a[0:7], v3
  v_smfmac_f32_16x16x64_bf16 v[40:43], v[8:11], a[56:63], v3
  v_smfmac_f32_16x16x64_bf16 v[44:47], v[8:11], a[112:119], v3
  v_smfmac_f32_16x16x64_bf16 v[48:51], v[8:11], a[168:175], v3
  v_smfmac_f32_16x16x64_bf16 v[52:55], v[8:11], a[224:231], v3
  v_smfmac_f32_16x16x64_bf16 v[56:59], v[8:11], v[144:151], v3
  v_smfmac_f32_16x16x64_bf16 v[60:63], v[8:11], v[200:207], v3
  v_smfmac_f32_16x16x64_bf16 v[36:39], v[12:15], a[8:15], v3
  v_smfmac_f32_16x16x64_bf16 v[40:43], v[12:15], a[64:71], v3
  v_smfmac_f32_16x16x64_bf16 v[44:47], v[12:15], a[120:127], v3
  v_smfmac_f32_16x16x64_bf16 v[48:51], v[12:15], a[176:183], v3
  v_smfmac_f32_16x16x64_bf16 v[52:55], v[12:15], a[232:239], v3
  v_smfmac_f32_16x16x64_bf16 v[56:59], v[12:15], v[152:159], v3
  v_smfmac_f32_16x16x64_bf16 v[60:63], v[12:15], v[208:215], v3
  v_smfmac_f32_16x16x64_bf16 v[36:39], v[16:19], a[16:23], v3
  v_smfmac_f32_16x16x64_bf16 v[40:43], v[16:19], a[72:79], v3
  v_smfmac_f32_16x16x64_bf16 v[44:47], v[16:19], a[128:135], v3
  v_smfmac_f32_16x16x64_bf16 v[48:51], v[16:19], a[184:191], v3
  v_smfmac_f32_16x16x64_bf16 v[52:55], v[16:19], a[240:247], v3
  v_smfmac_f32_16x16x64_bf16 v[56:59], v[16:19], v[160:167], v3
  v_smfmac_f32_16x16x64_bf16 v[60:63], v[16:19], v[216:223], v3
  v_smfmac_f32_16x16x64_bf16 v[36:39], v[20:23], a[24:31], v3
  v_smfmac_f32_16x16x64_bf16 v[40:43], v[20:23], a[80:87], v3
  v_smfmac_f32_16x16x64_bf16 v[44:47], v[20:23], a[136:143], v3
  v_smfmac_f32_16x16x64_bf16 v[48:51], v[20:23], a[192:199], v3
  v_smfmac_f32_16x16x64_bf16 v[52:55], v[20:23], a[248:255], v3
  v_smfmac_f32_16x16x64_bf16 v[56:59], v[20:23], v[168:175], v3
  v_smfmac_f32_16x16x64_bf16 v[60:63], v[20:23], v[224:231], v3
  s_xor_b32 s58, s25, 28672
  s_add_u32 s59, s24, 28672
  s_add_u32 m0, s58, 14336
  s_branch cB_sc2_ph2
.p2align 6

cB_sc3_loop:
  s_add_u32 s23, s20, 4096
  s_add_u32 s21, s20, 20480
  v_mov_b32 v48, 0
  v_mov_b32 v49, 0
  v_mov_b32 v50, 0
  v_mov_b32 v51, 0
  v_mov_b32 v52, 0
  v_mov_b32 v53, 0
  v_mov_b32 v54, 0
  v_mov_b32 v55, 0
  v_mov_b32 v56, 0
  v_mov_b32 v57, 0
  v_mov_b32 v58, 0
  v_mov_b32 v59, 0
  v_mov_b32 v60, 0
  v_mov_b32 v61, 0
  v_mov_b32 v62, 0
  v_mov_b32 v63, 0
  v_mov_b32 v88, 0
  v_mov_b32 v89, 0
  v_mov_b32 v90, 0
  v_mov_b32 v91, 0
  v_mov_b32 v92, 0
  v_mov_b32 v93, 0
  v_mov_b32 v94, 0
  v_mov_b32 v95, 0
  v_mov_b32 v64, 0
  v_mov_b32 v65, 0
  s_mov_b32 s30, 0
  s_mov_b32 s62, 0
  s_waitcnt vmcnt(0)
  s_barrier
cB_sc3_ld:
  buffer_load_dwordx4 v[8:11], v2, s[8:11], s20 offen offset:0 sc1
  v_mov_b32 v36, 0
  v_mov_b32 v37, 0
  v_mov_b32 v38, 0
  v_mov_b32 v39, 0
  buffer_load_dwordx4 v[12:15], v2, s[8:11], s20 offen offset:1024 sc1
  v_mov_b32 v40, 0
  v_mov_b32 v41, 0
  v_mov_b32 v42, 0
  v_mov_b32 v43, 0
  buffer_load_dwordx4 v[16:19], v2, s[8:11], s20 offen offset:2048 sc1
  v_mov_b32 v44, 0
  v_mov_b32 v45, 0
  v_mov_b32 v46, 0
  v_mov_b32 v47, 0
  ds_read_b128 v[96:99], v117 offset:0
  ds_read_b128 v[100:103], v117 offset:1024
  ds_read_b128 v[104:107], v117 offset:14336
  ds_read_b128 v[108:111], v117 offset:15360
  s_waitcnt vmcnt(2)
  v_smfmac_f32_16x16x64_bf16 v[36:39], v[8:11], a[0:7], v3
  v_smfmac_f32_16x16x64_bf16 v[40:43], v[8:11], a[56:63], v3
  buffer_load_dwordx4 v[20:23], v2, s[8:11], s20 offen offset:3072 sc1
  v_smfmac_f32_16x16x64_bf16 v[44:47], v[8:11], a[112:119], v3
  v_smfmac_f32_16x16x64_bf16 v[48:51], v[8:11], a[168:175], v3
  v_smfmac_f32_16x16x64_bf16 v[52:55], v[8:11], a[224:231], v3
  buffer_load_dwordx4 v[24:27], v2, s[8:11], s23 offen offset:0 sc1
  v_smfmac_f32_16x16x64_bf16 v[56:59], v[8:11], v[144:151], v3
  v_smfmac_f32_16x16x64_bf16 v[60:63], v[8:11], v[200:207], v3
  s_waitcnt vmcnt(3)
  v_smfmac_f32_16x16x64_bf16 v[36:39], v[12:15], a[8:15], v3
  v_smfmac_f32_16x16x64_bf16 v[40:43], v[12:15], a[64:71], v3
  buffer_load_dwordx4 v[28:31], v2, s[8:11], s23 offen offset:1024 sc1
  v_smfmac_f32_16x16x64_bf16 v[44:47], v[12:15], a[120:127], v3
  v_smfmac_f32_16x16x64_bf16 v[48:51], v[12:15], a[176:183], v3
  v_smfmac_f32_16x16x64_bf16 v[52:55], v[12:15], a[232:239], v3
  buffer_load_dwordx4 v[32:35], v2, s[8:11], s23 offen offset:2048 sc1
  v_smfmac_f32_16x16x64_bf16 v[56:59], v[12:15], v[152:159], v3
  v_smfmac_f32_16x16x64_bf16 v[60:63], v[12:15], v[208:215], v3
  s_waitcnt vmcnt(4)
  v_smfmac_f32_16x16x64_bf16 v[36:39], v[16:19], a[16:23], v3
  v_smfmac_f32_16x16x64_bf16 v[40:43], v[16:19], a[72:79], v3
  v_smfmac_f32_16x16x64_bf16 v[44:47], v[16:19], a[128:135], v3
  s_xor_b32 s58, s25, 28672
  s_add_u32 s59, s24, 28672
  s_add_u32 m0, s58, 21504
  v_smfmac_f32_16x16x64_bf16 v[48:51], v[16:19], a[184:191], v3
  buffer_load_dwordx4 v2, s[8:11], s59 offen offset:0 sc1 lds
  v_smfmac_f32_16x16x64_bf16 v[52:55], v[16:19], a[240:247], v3
  v_smfmac_f32_16x16x64_bf16 v[56:59], v[16:19], v[160:167], v3
  v_smfmac_f32_16x16x64_bf16 v[60:63], v[16:19], v[216:223], v3
  s_waitcnt vmcnt(4)
  v_smfmac_f32_16x16x64_bf16 v[36:39], v[20:23], a[24:31], v3
  buffer_load_dwordx4 v2, s[8:11], s59 offen offset:1024 sc1 lds
  v_smfmac_f32_16x16x64_bf16 v[40:43], v[20:23], a[80:87], v3
  v_smfmac_f32_16x16x64_bf16 v[44:47], v[20:23], a[136:143], v3
  v_smfmac_f32_16x16x64_bf16 v[48:51], v[20:23], a[192:199], v3
  v_smfmac_f32_16x16x64_bf16 v[52:55], v[20:23], a[248:255], v3
  buffer_load_dwordx4 v2, s[8:11], s59 offen offset:2048 sc1 lds
  v_smfmac_f32_16x16x64_bf16 v[56:59], v[20:23], v[168:175], v3
  v_smfmac_f32_16x16x64_bf16 v[60:63], v[20:23], v[224:231], v3
  s_waitcnt vmcnt(3)
cB_sc3_ph2:
  v_smfmac_f32_16x16x64_bf16 v[60:63], v[24:27], v[232:239], v3
  ds_read_b128 v[8:11], v116 offset:6144
  ds_read_b128 v[12:15], v116 offset:7168
  v_smfmac_f32_16x16x64_bf16 v[60:63], v[28:31], v[240:247], v3
  buffer_load_dwordx4 v2, s[8:11], s59 offen offset:3072 sc1 lds
  v_smfmac_f32_16x16x64_bf16 v[60:63], v[32:35], v[248:255], v3
  v_mov_b32 v80, v30
  v_smfmac_f32_16x16x64_bf16 v[52:55], v[24:27], v[120:127], v3
  v_mov_b32 v81, v31
  v_smfmac_f32_16x16x64_bf16 v[52:55], v[28:31], v[128:135], v3
  v_mov_b32 v82, v34
  v_smfmac_f32_16x16x64_bf16 v[52:55], v[32:35], v[136:143], v3
  v_cvt_pk_bf16_f32 v66, v60, v61
  v_smfmac_f32_16x16x64_bf16 v[56:59], v[24:27], v[176:183], v3
  v_cvt_pk_bf16_f32 v67, v62, v63
  v_smfmac_f32_16x16x64_bf16 v[56:59], v[28:31], v[184:191], v3
  v_mov_b32 v83, v35
  v_mfma_f32_16x16x32_bf16 v[68:71], v[64:67], v[4:7], 0
  v_smfmac_f32_16x16x64_bf16 v[56:59], v[32:35], v[192:199], v3
  v_cvt_pk_bf16_f32 v64, v52, v53
  v_smfmac_f32_16x16x64_bf16 v[36:39], v[24:27], a[32:39], v3
  v_cvt_pk_bf16_f32 v65, v54, v55
  v_smfmac_f32_16x16x64_bf16 v[36:39], v[28:31], a[40:47], v3
  v_cvt_pk_bf16_f32 v78, v68, v69
  v_smfmac_f32_16x16x64_bf16 v[36:39], v[32:35], a[48:55], v3
  v_cvt_pk_bf16_f32 v79, v70, v71
  v_cvt_pk_bf16_f32 v66, v56, v57
  v_smfmac_f32_16x16x64_bf16 v[40:43], v[24:27], a[88:95], v3
  v_cvt_pk_bf16_f32 v67, v58, v59
  v_smfmac_f32_16x16x64_bf16 v[40:43], v[28:31], a[96:103], v3
  v_mfma_f32_16x16x32_bf16 v[72:75], v[64:67], v[4:7], 0
  ds_read_b128 v[52:55], v116 offset:20480
  ds_read_b128 v[56:59], v116 offset:21504
  v_smfmac_f32_16x16x64_bf16 v[40:43], v[32:35], a[104:111], v3
  v_cvt_pk_bf16_f32 v64, v36, v37
  v_smfmac_f32_16x16x64_bf16 v[44:47], v[24:27], a[144:151], v3
  v_cvt_pk_bf16_f32 v65, v38, v39
  v_smfmac_f32_16x16x64_bf16 v[44:47], v[28:31], a[152:159], v3
  v_cvt_pk_bf16_f32 v76, v72, v73
  v_smfmac_f32_16x16x64_bf16 v[44:47], v[32:35], a[160:167], v3
  v_cvt_pk_bf16_f32 v77, v74, v75
  v_cvt_pk_bf16_f32 v66, v40, v41
  v_smfmac_f32_16x16x64_bf16 v[48:51], v[24:27], a[200:207], v3
  v_cvt_pk_bf16_f32 v67, v42, v43
  v_smfmac_f32_16x16x64_bf16 v[48:51], v[28:31], a[208:215], v3
  v_mfma_f32_16x16x32_bf16 v[68:71], v[64:67], v[4:7], 0
  v_smfmac_f32_16x16x64_bf16 v[48:51], v[32:35], a[216:223], v3
  v_cvt_pk_bf16_f32 v64, v44, v45
  v_mfma_f32_16x16x32_bf16 v[84:87], v[80:83], v[76:79], 0
  v_cvt_pk_bf16_f32 v65, v46, v47
  s_waitcnt lgkmcnt(0)
  v_smfmac_f32_16x16x64_bf16 v[88:91], v[76:79], v[96:103], v118
  v_cvt_pk_bf16_f32 v60, v68, v69
  v_cvt_pk_bf16_f32 v61, v70, v71
  v_cvt_pk_bf16_f32 v66, v48, v49
  v_cvt_pk_bf16_f32 v67, v50, v51
  s_nop 1
  v_mfma_f32_16x16x32_bf16 v[72:75], v[64:67], v[4:7], 0
  v_smfmac_f32_16x16x64_bf16 v[92:95], v[76:79], v[104:111], v118
  s_nop 4
  v_cvt_pk_bf16_f32 v62, v72, v73
  v_cvt_pk_bf16_f32 v63, v74, v75
  s_nop 1
  v_mfma_f32_16x16x32_bf16 v[84:87], v[20:23], v[60:63], v[84:87]
  v_smfmac_f32_16x16x64_bf16 v[88:91], v[60:63], v[8:15], v118
  v_smfmac_f32_16x16x64_bf16 v[92:95], v[60:63], v[52:59], v118
  s_nop 1
  v_permlane32_swap_b32 v84, v86
  v_permlane32_swap_b32 v85, v87
  s_nop 0
  v_add_f32 v88, v88, v89
  v_add_f32_dpp v84, v86, v84 quad_perm:[1,0,3,2] row_mask:0xf bank_mask:0xf
  v_add_f32_dpp v85, v87, v85 quad_perm:[1,0,3,2] row_mask:0xf bank_mask:0xf
  v_add_f32 v89, v90, v91
  ds_write2_b32 v113, v84, v85 offset0:0 offset1:4
  ds_write2_b32 v112, v88, v89 offset0:0 offset1:128
  v_add_f32 v90, v92, v93
  v_add_f32 v91, v94, v95
  ds_write2_b32 v112, v90, v91 offset0:64 offset1:192
  v_cmp_u_f32 vcc, v88, v89
  s_cbranch_vccnz cB_sc3_retry
cB_sc3_cont:
  s_waitcnt lgkmcnt(0)
  s_barrier
  ds_read_b128 v[36:39], v114
  ds_read_b128 v[44:47], v115
  s_waitcnt lgkmcnt(0)
  v_add_f32 v36, v36, v38
  v_add_f32 v37, v37, v39
  v_add_f32 v44, v44, v45
  v_add_f32 v46, v46, v47
  v_add_f32 v44, v44, v46
  v_add_f32 v36, v36, v37
  v_exp_f32 v49, v44
  v_exp_f32 v48, v36
  v_add_f32 v50, abs(v36), abs(v44)
  v_fma_f32 v39, v49, s37, v48
  v_cmp_ngt_f32 vcc, s56, v50
  v_cndmask_b32 v41, v48, v49, s[38:39]
  v_add_f32_dpp v39, v39, v39 quad_perm:[1,0,3,2] row_mask:0xf bank_mask:0xf
  v_cndmask_b32 v40, v49, v48, s[38:39]
  v_mov_b32_dpp v46, v41 quad_perm:[1,0,3,2] row_mask:0xf bank_mask:0xf
  v_add_f32_dpp v39, v39, v39 quad_perm:[2,3,0,1] row_mask:0xf bank_mask:0xf
  v_cndmask_b32 v42, v46, v40, s[38:39]
  v_cndmask_b32 v43, v40, v46, s[38:39]
  v_add_f32_dpp v39, v39, v39 row_half_mirror row_mask:0xf bank_mask:0xf
  s_cbranch_vccnz cB_sc3_slow
  s_nop 0
  v_add_f32_dpp v47, v39, v39 row_mirror row_mask:0xf bank_mask:0xf
  v_add_f32_dpp v39, v39, v39 row_mirror row_mask:0xf bank_mask:0xf
  s_nop 1
  v_permlane16_swap_b32 v39, v47
  v_add_f32 v39, v39, v47
  v_rcp_f32 v39, v39
  s_mov_b64 exec, s[28:29]
  v_mul_f32 v42, v42, v39
  v_mul_f32 v43, v43, v39
  v_cvt_pk_bf16_f32 v42, v42, v43
cB_sc3_pst:
  buffer_store_dword v42, v1, s[8:11], s20 offen sc1
  s_mov_b64 exec, -1
  s_barrier
  s_add_u32 s24, s24, 28672
  s_add_u32 s35, s35, 28672
  s_xor_b32 s25, s25, 28672
  s_add_u32 m0, s25, 21504
  s_add_u32 m0, s25, 25600
  s_add_u32 s22, s24, 4096
  buffer_load_dwordx4 v2, s[8:11], s22 offen offset:0 sc1 lds
  s_nop 5
  buffer_load_dwordx4 v2, s[8:11], s22 offen offset:1024 sc1 lds
  s_nop 5
  buffer_load_dwordx4 v2, s[8:11], s22 offen offset:2048 sc1 lds
  s_nop 5
  v_xor_b32 v116, 28672, v116
  v_add_u32 v117, s57, v117
  s_sub_u32 s57, 0, s57
  s_add_u32 s19, s19, 1
  s_mov_b32 s20, s21
  s_cmp_lt_u32 s19, 63
  s_cbranch_scc1 cB_sc3_loop
  s_branch cB_done
cB_sc3_slow:
  v_max_f32 v50, v36, v44
  s_nop 1
  v_max_f32_dpp v50, v50, v50 quad_perm:[1,0,3,2] row_mask:0xf bank_mask:0xf
  s_nop 1
  v_max_f32_dpp v50, v50, v50 quad_perm:[2,3,0,1] row_mask:0xf bank_mask:0xf
  s_nop 1
  v_max_f32_dpp v50, v50, v50 row_half_mirror row_mask:0xf bank_mask:0xf
  s_nop 1
  v_max_f32_dpp v50, v50, v50 row_mirror row_mask:0xf bank_mask:0xf
  v_mov_b32 v47, v50
  s_nop 1
  v_permlane16_swap_b32 v50, v47
  v_max_f32 v50, v50, v47
  v_sub_f32 v48, v36, v50
  v_sub_f32 v49, v44, v50
  v_exp_f32 v48, v48
  v_exp_f32 v49, v49
  s_add_u32 s31, s31, 0x100
  v_fma_f32 v39, v49, s37, v48
  v_cndmask_b32 v41, v48, v49, s[38:39]
  s_nop 0
  v_add_f32_dpp v39, v39, v39 quad_perm:[1,0,3,2] row_mask:0xf bank_mask:0xf
  v_cndmask_b32 v40, v49, v48, s[38:39]
  v_mov_b32_dpp v46, v41 quad_perm:[1,0,3,2] row_mask:0xf bank_mask:0xf
  v_add_f32_dpp v39, v39, v39 quad_perm:[2,3,0,1] row_mask:0xf bank_mask:0xf
  v_cndmask_b32 v42, v46, v40, s[38:39]
  v_cndmask_b32 v43, v40, v46, s[38:39]
  v_add_f32_dpp v39, v39, v39 row_half_mirror row_mask:0xf bank_mask:0xf
  s_nop 1
  v_add_f32_dpp v47, v39, v39 row_mirror row_mask:0xf bank_mask:0xf
  v_add_f32_dpp v39, v39, v39 row_mirror row_mask:0xf bank_mask:0xf
  s_nop 1
  v_permlane16_swap_b32 v39, v47
  v_add_f32 v39, v39, v47
  v_rcp_f32 v39, v39
  s_mov_b64 exec, s[28:29]
  v_mul_f32 v42, v42, v39
  v_mul_f32 v43, v43, v39
  v_cvt_pk_bf16_f32 v42, v42, v43
  v_min_u32 v42, -2, v42
  s_branch cB_sc3_pst
cB_sc3_retry:
  s_cmp_lg_u32 s62, 0
  s_cbranch_scc1 cB_sc3_cont
  s_waitcnt vmcnt(0) lgkmcnt(0)
cB_sc3_rv:
  buffer_load_dwordx4 v[8:11], v2, s[8:11], s20 offen offset:0 sc1
  buffer_load_dwordx4 v[12:15], v2, s[8:11], s20 offen offset:1024 sc1
  buffer_load_dwordx4 v[16:19], v2, s[8:11], s20 offen offset:2048 sc1
  buffer_load_dwordx4 v[20:23], v2, s[8:11], s20 offen offset:3072 sc1
  buffer_load_dwordx4 v[24:27], v2, s[8:11], s23 offen offset:0 sc1
  buffer_load_dwordx4 v[28:31], v2, s[8:11], s23 offen offset:1024 sc1
  buffer_load_dwordx4 v[32:35], v2, s[8:11], s23 offen offset:2048 sc1
  s_waitcnt vmcnt(0)
  v_max3_u32 v68, v8, v9, v10
  v_max3_u32 v68, v68, v11, v12
  v_max3_u32 v68, v68, v13, v14
  v_max3_u32 v68, v68, v15, v16
  v_max3_u32 v68, v68, v17, v18
  v_max3_u32 v68, v68, v19, v20
  v_max3_u32 v68, v68, v21, v22
  v_max3_u32 v68, v68, v23, v24
  v_max3_u32 v68, v68, v25, v26
  v_max3_u32 v68, v68, v27, v28
  v_max3_u32 v68, v68, v29, v30
  v_max3_u32 v68, v68, v31, v32
  v_max3_u32 v68, v68, v33, v34
  v_max_u32 v68, v68, v35
  v_cmp_eq_u32 vcc, -1, v68
  s_cbranch_vccz cB_sc3_rk
  s_add_u32 s30, s30, 1
  s_cmp_lt_u32 s30, 400000
  s_cbranch_scc1 cB_sc3_rv
  s_branch cB_abort
cB_sc3_rk:
  s_mov_b32 s62, 1
  v_mov_b32 v36, 0
  v_mov_b32 v37, 0
  v_mov_b32 v38, 0
  v_mov_b32 v39, 0
  v_mov_b32 v40, 0
  v_mov_b32 v41, 0
  v_mov_b32 v42, 0
  v_mov_b32 v43, 0
  v_mov_b32 v44, 0
  v_mov_b32 v45, 0
  v_mov_b32 v46, 0
  v_mov_b32 v47, 0
  v_mov_b32 v48, 0
  v_mov_b32 v49, 0
  v_mov_b32 v50, 0
  v_mov_b32 v51, 0
  v_mov_b32 v52, 0
  v_mov_b32 v53, 0
  v_mov_b32 v54, 0
  v_mov_b32 v55, 0
  v_mov_b32 v56, 0
  v_mov_b32 v57, 0
  v_mov_b32 v58, 0
  v_mov_b32 v59, 0
  v_mov_b32 v60, 0
  v_mov_b32 v61, 0
  v_mov_b32 v62, 0
  v_mov_b32 v63, 0
  v_mov_b32 v88, 0
  v_mov_b32 v89, 0
  v_mov_b32 v90, 0
  v_mov_b32 v91, 0
  v_mov_b32 v92, 0
  v_mov_b32 v93, 0
  v_mov_b32 v94, 0
  v_mov_b32 v95, 0
  v_mov_b32 v64, 0
  v_mov_b32 v65, 0
  s_add_u32 s31, s31, 1
  ds_read_b128 v[96:99], v117 offset:0
  ds_read_b128 v[100:103], v117 offset:1024
  ds_read_b128 v[104:107], v117 offset:14336
  ds_read_b128 v[108:111], v117 offset:15360
  v_smfmac_f32_16x16x64_bf16 v[36:39], v[8:11], a[0:7], v3
  v_smfmac_f32_16x16x64_bf16 v[40:43], v[8:11], a[56:63], v3
  v_smfmac_f32_16x16x64_bf16 v[44:47], v[8:11], a[112:119], v3
  v_smfmac_f32_16x16x64_bf16 v[48:51], v[8:11], a[168:175], v3
  v_smfmac_f32_16x16x64_bf16 v[52:55], v[8:11], a[224:231], v3
  v_smfmac_f32_16x16x64_bf16 v[56:59], v[8:11], v[144:151], v3
  v_smfmac_f32_16x16x64_bf16 v[60:63], v[8:11], v[200:207], v3
  v_smfmac_f32_16x16x64_bf16 v[36:39], v[12:15], a[8:15], v3
  v_smfmac_f32_16x16x64_bf16 v[40:43], v[12:15], a[64:71], v3
  v_smfmac_f32_16x16x64_bf16 v[44:47], v[12:15], a[120:127], v3
  v_smfmac_f32_16x16x64_bf16 v[48:51], v[12:15], a[176:183], v3
  v_smfmac_f32_16x16x64_bf16 v[52:55], v[12:15], a[232:239], v3
  v_smfmac_f32_16x16x64_bf16 v[56:59], v[12:15], v[152:159], v3
  v_smfmac_f32_16x16x64_bf16 v[60:63], v[12:15], v[208:215], v3
  v_smfmac_f32_16x16x64_bf16 v[36:39], v[16:19], a[16:23], v3
  v_smfmac_f32_16x16x64_bf16 v[40:43], v[16:19], a[72:79], v3
  v_smfmac_f32_16x16x64_bf16 v[44:47], v[16:19], a[128:135], v3
  v_smfmac_f32_16x16x64_bf16 v[48:51], v[16:19], a[184:191], v3
  v_smfmac_f32_16x16x64_bf16 v[52:55], v[16:19], a[240:247], v3
  v_smfmac_f32_16x16x64_bf16 v[56:59], v[16:19], v[160:167], v3
  v_smfmac_f32_16x16x64_bf16 v[60:63], v[16:19], v[216:223], v3
  v_smfmac_f32_16x16x64_bf16 v[36:39], v[20:23], a[24:31], v3
  v_smfmac_f32_16x16x64_bf16 v[40:43], v[20:23], a[80:87], v3
  v_smfmac_f32_16x16x64_bf16 v[44:47], v[20:23], a[136:143], v3
  v_smfmac_f32_16x16x64_bf16 v[48:51], v[20:23], a[192:199], v3
  v_smfmac_f32_16x16x64_bf16 v[52:55], v[20:23], a[248:255], v3
  v_smfmac_f32_16x16x64_bf16 v[56:59], v[20:23], v[168:175], v3
  v_smfmac_f32_16x16x64_bf16 v[60:63], v[20:23], v[224:231], v3
  s_xor_b32 s58, s25, 28672
  s_add_u32 s59, s24, 28672
  s_add_u32 m0, s58, 21504
  s_branch cB_sc3_ph2
.p2align 6

cB_va0_loop:
  s_add_u32 s23, s20, 4096
  s_add_u32 s21, s20, 20480
  s_mov_b32 s30, 0
  s_cmp_lg_u32 s19, s38
  s_cbranch_scc1 cB_va0_vok
  s_branch cB_va0_voc
cB_va0_vow:
  s_sub_u32 s22, s39, s35
  v_lshlrev_b32 v63, 7, v2
  v_min_u32 v63, s22, v63
  buffer_load_dword v63, v63, s[8:11], s35 offen sc1
  s_waitcnt vmcnt(0)
cB_va0_voc:
  v_readfirstlane_b32 s22, v63
  s_cmp_eq_u32 s22, 56
  s_cbranch_scc1 cB_va0_vod
  s_sleep 1
  s_add_u32 s30, s30, 1
  s_cmp_lt_u32 s30, 400000
  s_cbranch_scc1 cB_va0_vow
  s_branch cB_abort
cB_va0_vod:
  s_add_u32 s35, s35, 2048
  s_add_u32 s38, s19, 8
  s_and_b32 s38, s38, -8
  s_cmp_eq_u32 s19, 0
  s_cselect_b32 s38, 4, s38
  v_cmp_ne_u32 vcc, 56, v63
  s_nop 3
  s_cmp_eq_u64 vcc, 0
  s_cselect_b32 s38, 99, s38
cB_va0_vok:
  s_cmp_eq_u32 s19, 63
  s_cbranch_scc1 cB_done
  s_barrier
  s_add_u32 s22, s25, 0
  buffer_load_dwordx4 v[80:83], v6, s[8:11], s22 offen offset:0 sc1
  buffer_load_dwordx4 v[84:87], v6, s[8:11], s22 offen offset:1792 sc1
  s_add_u32 s22, s25, 3584
  buffer_load_dwordx4 v[88:91], v6, s[8:11], s22 offen offset:0 sc1
  buffer_load_dwordx4 v[92:95], v6, s[8:11], s22 offen offset:1792 sc1
  s_add_u32 s22, s25, 7168
  buffer_load_dwordx4 v[96:99], v6, s[8:11], s22 offen offset:0 sc1
  buffer_load_dwordx4 v[100:103], v6, s[8:11], s22 offen offset:1792 sc1
  s_add_u32 s22, s25, 10752
  buffer_load_dwordx4 v[104:107], v6, s[8:11], s22 offen offset:0 sc1
  buffer_load_dwordx4 v[108:111], v6, s[8:11], s22 offen offset:1792 sc1
  s_add_u32 s22, s25, 14336
  buffer_load_dwordx4 v[112:115], v6, s[8:11], s22 offen offset:0 sc1
  buffer_load_dwordx4 v[116:119], v6, s[8:11], s22 offen offset:1792 sc1
  s_add_u32 s22, s25, 17920
  buffer_load_dwordx4 v[120:123], v6, s[8:11], s22 offen offset:0 sc1
  buffer_load_dwordx4 v[124:127], v6, s[8:11], s22 offen offset:1792 sc1
  s_add_u32 s22, s19, 1
  s_cmp_lg_u32 s22, s38
  s_cbranch_scc1 cB_va0_nk
  s_sub_u32 s22, s39, s35
  v_lshlrev_b32 v63, 7, v2
  v_min_u32 v63, s22, v63
  buffer_load_dword v63, v63, s[8:11], s35 offen sc1
cB_va0_nk:
  s_barrier
  ds_read_b128 v[8:11], v0 offset:8192
  ds_read_b128 v[12:15], v0 offset:9216
  ds_read_b128 v[16:19], v0 offset:10240
  ds_read_b128 v[20:23], v0 offset:11264
  ds_read_b128 v[24:27], v0 offset:12288
  ds_read_b128 v[28:31], v0 offset:13312
  ds_read_b128 v[32:35], v0 offset:14336
  s_waitcnt lgkmcnt(0)
  v_smfmac_f32_16x16x64_bf16 v[36:39], v[8:11], a[0:7], v3
  s_add_u32 s22, s25, 21504
  buffer_load_dwordx4 v[128:131], v6, s[8:11], s22 offen offset:0 sc1
  v_smfmac_f32_16x16x64_bf16 v[36:39], v[12:15], a[8:15], v3
  v_smfmac_f32_16x16x64_bf16 v[36:39], v[16:19], a[16:23], v3
  s_add_u32 s22, s25, 21504
  buffer_load_dwordx4 v[132:135], v6, s[8:11], s22 offen offset:1792 sc1
  v_smfmac_f32_16x16x64_bf16 v[36:39], v[20:23], a[24:31], v3
  v_smfmac_f32_16x16x64_bf16 v[36:39], v[24:27], a[32:39], v3
  s_add_u32 s22, s25, 25088
  buffer_load_dwordx4 v[136:139], v6, s[8:11], s22 offen offset:0 sc1
  v_smfmac_f32_16x16x64_bf16 v[36:39], v[28:31], a[40:47], v3
  v_smfmac_f32_16x16x64_bf16 v[36:39], v[32:35], a[48:55], v3
  s_add_u32 s22, s25, 25088
  buffer_load_dwordx4 v[140:143], v6, s[8:11], s22 offen offset:1792 sc1
  v_smfmac_f32_16x16x64_bf16 v[40:43], v[8:11], a[56:63], v3
  v_smfmac_f32_16x16x64_bf16 v[40:43], v[12:15], a[64:71], v3
  v_smfmac_f32_16x16x64_bf16 v[40:43], v[16:19], a[72:79], v3
  v_add_f32 v36, v36, v37
  v_smfmac_f32_16x16x64_bf16 v[40:43], v[20:23], a[80:87], v3
  v_add_f32 v38, v38, v39
  v_smfmac_f32_16x16x64_bf16 v[40:43], v[24:27], a[88:95], v3
  v_cvt_pk_bf16_f32 v36, v36, v38
  v_smfmac_f32_16x16x64_bf16 v[40:43], v[28:31], a[96:103], v3
  ds_write_b32 v60, v36
  v_smfmac_f32_16x16x64_bf16 v[40:43], v[32:35], a[104:111], v3
  v_smfmac_f32_16x16x64_bf16 v[44:47], v[8:11], a[112:119], v3
  v_smfmac_f32_16x16x64_bf16 v[44:47], v[12:15], a[120:127], v3
  v_smfmac_f32_16x16x64_bf16 v[44:47], v[16:19], a[128:135], v3
  v_add_f32 v40, v40, v41
  v_smfmac_f32_16x16x64_bf16 v[44:47], v[20:23], a[136:143], v3
  v_add_f32 v42, v42, v43
  v_smfmac_f32_16x16x64_bf16 v[44:47], v[24:27], a[144:151], v3
  v_cvt_pk_bf16_f32 v40, v40, v42
  v_smfmac_f32_16x16x64_bf16 v[44:47], v[28:31], a[152:159], v3
  ds_write_b32 v61, v40
  v_smfmac_f32_16x16x64_bf16 v[44:47], v[32:35], a[160:167], v3
  v_smfmac_f32_16x16x64_bf16 v[48:51], v[8:11], a[168:175], v3
  v_smfmac_f32_16x16x64_bf16 v[48:51], v[12:15], a[176:183], v3
  v_smfmac_f32_16x16x64_bf16 v[48:51], v[16:19], a[184:191], v3
  v_add_f32 v44, v44, v45
  v_smfmac_f32_16x16x64_bf16 v[48:51], v[20:23], a[192:199], v3
  v_add_f32 v46, v46, v47
  v_smfmac_f32_16x16x64_bf16 v[48:51], v[24:27], a[200:207], v3
  v_cvt_pk_bf16_f32 v44, v44, v46
  v_smfmac_f32_16x16x64_bf16 v[48:51], v[28:31], a[208:215], v3
  ds_write_b32 v62, v44
  v_smfmac_f32_16x16x64_bf16 v[48:51], v[32:35], a[216:223], v3
  v_smfmac_f32_16x16x64_bf16 v[52:55], v[8:11], a[224:231], v3
  v_smfmac_f32_16x16x64_bf16 v[52:55], v[12:15], a[232:239], v3
  v_smfmac_f32_16x16x64_bf16 v[52:55], v[16:19], a[240:247], v3
  v_add_f32 v48, v48, v49
  v_smfmac_f32_16x16x64_bf16 v[52:55], v[20:23], a[248:255], v3
  v_add_f32 v50, v50, v51
  v_smfmac_f32_16x16x64_bf16 v[52:55], v[24:27], v[176:183], v3
  v_cvt_pk_bf16_f32 v48, v48, v50
  v_smfmac_f32_16x16x64_bf16 v[52:55], v[28:31], v[184:191], v3
  ds_write_b32 v170, v48
  v_smfmac_f32_16x16x64_bf16 v[52:55], v[32:35], v[192:199], v3
  v_smfmac_f32_16x16x64_bf16 v[56:59], v[8:11], v[200:207], v3
  v_smfmac_f32_16x16x64_bf16 v[56:59], v[12:15], v[208:215], v3
  v_smfmac_f32_16x16x64_bf16 v[56:59], v[16:19], v[216:223], v3
  v_add_f32 v52, v52, v53
  v_smfmac_f32_16x16x64_bf16 v[56:59], v[20:23], v[224:231], v3
  v_add_f32 v54, v54, v55
  v_smfmac_f32_16x16x64_bf16 v[56:59], v[24:27], v[232:239], v3
  v_cvt_pk_bf16_f32 v52, v52, v54
  v_smfmac_f32_16x16x64_bf16 v[56:59], v[28:31], v[240:247], v3
  ds_write_b32 v171, v52
  v_smfmac_f32_16x16x64_bf16 v[56:59], v[32:35], v[248:255], v3
  s_nop 7
  v_add_f32 v56, v56, v57
  v_add_f32 v58, v58, v59
  v_cvt_pk_bf16_f32 v56, v56, v58
  ds_write_b32 v172, v56
  buffer_load_dword v164, v4, s[8:11], s20 offen sc1
  s_waitcnt lgkmcnt(0)
  v_mov_b32 v36, 0
  v_mov_b32 v37, 0
  v_mov_b32 v38, 0
  v_mov_b32 v39, 0
  v_mov_b32 v40, 0
  v_mov_b32 v41, 0
  v_mov_b32 v42, 0
  v_mov_b32 v43, 0
  buffer_load_dword v165, v4, s[8:11], s20 offen sc1
  v_mov_b32 v44, 0
  v_mov_b32 v45, 0
  v_mov_b32 v46, 0
  v_mov_b32 v47, 0
  v_mov_b32 v48, 0
  v_mov_b32 v49, 0
  v_mov_b32 v50, 0
  v_mov_b32 v51, 0
  buffer_load_dword v166, v4, s[8:11], s20 offen sc1
  v_mov_b32 v52, 0
  v_mov_b32 v53, 0
  v_mov_b32 v54, 0
  v_mov_b32 v55, 0
  v_mov_b32 v56, 0
  v_mov_b32 v57, 0
  v_mov_b32 v58, 0
  v_mov_b32 v59, 0
  buffer_load_dword v167, v4, s[8:11], s20 offen sc1
  s_cmp_eq_u32 s19, 63
  s_cbranch_scc1 cB_va0_last
  s_add_u32 s22, s20, 9216
  s_add_u32 s34, s20, 13312
  s_add_u32 s36, s20, 7168
  s_mov_b32 s37, 0
  v_mov_b32 v156, 0
  v_mov_b32 v157, 0
  v_mov_b32 v158, 0
  v_mov_b32 v159, 0
  buffer_load_dword v168, v4, s[8:11], s20 offen sc1
cB_va0_fw_l:
  s_waitcnt vmcnt(4)
  v_cmp_eq_u32 vcc, -1, v164
  s_cbranch_vccz cB_va0_fw_d
  buffer_load_dword v164, v4, s[8:11], s20 offen sc1
  s_waitcnt vmcnt(4)
  v_cmp_eq_u32 vcc, -1, v165
  s_cbranch_vccz cB_va0_fw_d
  buffer_load_dword v165, v4, s[8:11], s20 offen sc1
  s_waitcnt vmcnt(4)
  v_cmp_eq_u32 vcc, -1, v166
  s_cbranch_vccz cB_va0_fw_d
  buffer_load_dword v166, v4, s[8:11], s20 offen sc1
  s_waitcnt vmcnt(4)
  v_cmp_eq_u32 vcc, -1, v167
  s_cbranch_vccz cB_va0_fw_d
  buffer_load_dword v167, v4, s[8:11], s20 offen sc1
  s_waitcnt vmcnt(4)
  v_cmp_eq_u32 vcc, -1, v168
  s_cbranch_vccz cB_va0_fw_d
  buffer_load_dword v168, v4, s[8:11], s20 offen sc1
  s_add_u32 s30, s30, 1
  s_cmp_lt_u32 s30, 400000
  s_cbranch_scc1 cB_va0_fw_l
  s_branch cB_abort
cB_va0_fw_d:
  s_waitcnt lgkmcnt(0)
  buffer_load_dwordx4 v[8:11], v5, s[8:11], s22 offen offset:0 sc1
  buffer_load_dwordx4 v[12:15], v5, s[8:11], s22 offen offset:1024 sc1
  buffer_load_dwordx4 v[16:19], v5, s[8:11], s22 offen offset:2048 sc1
  buffer_load_dwordx4 v[20:23], v5, s[8:11], s22 offen offset:3072 sc1
  buffer_load_dwordx4 v[24:27], v5, s[8:11], s34 offen offset:0 sc1
  buffer_load_dwordx4 v[28:31], v5, s[8:11], s34 offen offset:1024 sc1
  buffer_load_dwordx4 v[32:35], v5, s[8:11], s34 offen offset:2048 sc1
  buffer_load_dwordx4 v[144:147], v5, s[8:11], s34 offen offset:3072 sc1
  buffer_load_dwordx4 v[148:151], v2, s[8:11], s36 offen offset:0 sc1
  buffer_load_dwordx4 v[152:155], v2, s[8:11], s36 offen offset:1024 sc1
  s_barrier
  ds_read_b128 v[64:67], v2 offset:0
  ds_read_b128 v[68:71], v2 offset:1024
  ds_read_b128 v[72:75], v2 offset:2048
  ds_read_b128 v[76:79], v2 offset:3072
  s_waitcnt vmcnt(9)
  v_smfmac_f32_16x16x64_bf16 v[156:159], v[8:11], v[80:87], v3
  s_waitcnt vmcnt(8)
  v_smfmac_f32_16x16x64_bf16 v[156:159], v[12:15], v[88:95], v3
  s_waitcnt vmcnt(7)
  v_smfmac_f32_16x16x64_bf16 v[156:159], v[16:19], v[96:103], v3
  s_waitcnt vmcnt(6)
  v_smfmac_f32_16x16x64_bf16 v[156:159], v[20:23], v[104:111], v3
  s_waitcnt vmcnt(5)
  v_smfmac_f32_16x16x64_bf16 v[156:159], v[24:27], v[112:119], v3
  s_waitcnt vmcnt(4)
  v_smfmac_f32_16x16x64_bf16 v[156:159], v[28:31], v[120:127], v3
  s_waitcnt vmcnt(3)
  v_smfmac_f32_16x16x64_bf16 v[156:159], v[32:35], v[128:135], v3
  s_waitcnt vmcnt(2)
  v_smfmac_f32_16x16x64_bf16 v[156:159], v[144:147], v[136:143], v3
  s_waitcnt vmcnt(1) lgkmcnt(0)
  v_smfmac_f32_16x16x64_bf16 v[156:159], v[148:151], v[64:71], v3
  s_waitcnt vmcnt(0)
  v_smfmac_f32_16x16x64_bf16 v[156:159], v[152:155], v[72:79], v3
cB_va0_ep:
  s_nop 7
  v_add_f32 v160, v156, v157
  v_add_f32 v161, v158, v159
  v_cmp_u_f32 vcc, v160, v161
  v_mov_b32_dpp v162, v160 row_ror:8 row_mask:0xf bank_mask:0xf
  v_mov_b32_dpp v160, v161 row_ror:8 row_mask:0xf bank_mask:0xc
  s_cbranch_vccnz cB_va0_rp
  v_mov_b32_dpp v161, v162 quad_perm:[0,1,2,3] row_mask:0xf bank_mask:0x3
  v_cvt_pk_bf16_f32 v160, v160, v161
cB_va0_pc:
  buffer_store_dword v160, v1, s[8:11], s21 offen sc1
  s_cmp_lg_u32 s19, 62
  s_cbranch_scc1 cB_va0_nl
  s_mov_b32 s22, 88531968
  buffer_store_dword v160, v1, s[8:11], s22 offen sc1
  s_mov_b64 exec, -1
  s_branch cB_done
cB_va0_nl:
  s_mov_b64 exec, -1
  s_add_u32 s25, s25, 28672
  s_add_u32 s19, s19, 1
  s_mov_b32 s20, s21
  s_branch cB_va0_loop
cB_va0_last:
  s_waitcnt lgkmcnt(0)
  s_barrier
  s_branch cB_done
cB_va0_rp:
  s_cmp_eq_u32 s37, 0
  s_cbranch_scc1 cB_va0_rv
  v_mov_b32_dpp v161, v162 quad_perm:[0,1,2,3] row_mask:0xf bank_mask:0x3
  v_cvt_pk_bf16_f32 v160, v160, v161
  v_min_u32 v160, -2, v160
  s_branch cB_va0_pc
cB_va0_rv:
  buffer_load_dwordx4 v[8:11], v5, s[8:11], s22 offen offset:0 sc1
  buffer_load_dwordx4 v[12:15], v5, s[8:11], s22 offen offset:1024 sc1
  buffer_load_dwordx4 v[16:19], v5, s[8:11], s22 offen offset:2048 sc1
  buffer_load_dwordx4 v[20:23], v5, s[8:11], s22 offen offset:3072 sc1
  buffer_load_dwordx4 v[24:27], v5, s[8:11], s34 offen offset:0 sc1
  buffer_load_dwordx4 v[28:31], v5, s[8:11], s34 offen offset:1024 sc1
  buffer_load_dwordx4 v[32:35], v5, s[8:11], s34 offen offset:2048 sc1
  buffer_load_dwordx4 v[144:147], v5, s[8:11], s34 offen offset:3072 sc1
  buffer_load_dwordx4 v[148:151], v2, s[8:11], s36 offen offset:0 sc1
  buffer_load_dwordx4 v[152:155], v2, s[8:11], s36 offen offset:1024 sc1
  s_waitcnt vmcnt(0)
  v_max3_u32 v175, v8, v9, v10
  v_max3_u32 v175, v175, v11, v12
  v_max3_u32 v175, v175, v13, v14
  v_max3_u32 v175, v175, v15, v16
  v_max3_u32 v175, v175, v17, v18
  v_max3_u32 v175, v175, v19, v20
  v_max3_u32 v175, v175, v21, v22
  v_max3_u32 v175, v175, v23, v24
  v_max3_u32 v175, v175, v25, v26
  v_max3_u32 v175, v175, v27, v28
  v_max3_u32 v175, v175, v29, v30
  v_max3_u32 v175, v175, v31, v32
  v_max3_u32 v175, v175, v33, v34
  v_max3_u32 v175, v175, v35, v144
  v_max3_u32 v175, v175, v145, v146
  v_max3_u32 v175, v175, v147, v148
  v_max3_u32 v175, v175, v149, v150
  v_max3_u32 v175, v175, v151, v152
  v_max3_u32 v175, v175, v153, v154
  v_max_u32 v175, v175, v155
  v_cmp_eq_u32 vcc, -1, v175
  s_cbranch_vccz cB_va0_rk
  s_add_u32 s30, s30, 1
  s_cmp_lt_u32 s30, 400000
  s_cbranch_scc1 cB_va0_rv
  s_branch cB_abort
cB_va0_rk:
  s_mov_b32 s37, 1
  s_add_u32 s31, s31, 0x10000
  v_mov_b32 v156, 0
  v_mov_b32 v157, 0
  v_mov_b32 v158, 0
  v_mov_b32 v159, 0
  s_nop 1
  v_smfmac_f32_16x16x64_bf16 v[156:159], v[8:11], v[80:87], v3
  v_smfmac_f32_16x16x64_bf16 v[156:159], v[12:15], v[88:95], v3
  v_smfmac_f32_16x16x64_bf16 v[156:159], v[16:19], v[96:103], v3
  v_smfmac_f32_16x16x64_bf16 v[156:159], v[20:23], v[104:111], v3
  v_smfmac_f32_16x16x64_bf16 v[156:159], v[24:27], v[112:119], v3
  v_smfmac_f32_16x16x64_bf16 v[156:159], v[28:31], v[120:127], v3
  v_smfmac_f32_16x16x64_bf16 v[156:159], v[32:35], v[128:135], v3
  v_smfmac_f32_16x16x64_bf16 v[156:159], v[144:147], v[136:143], v3
  v_smfmac_f32_16x16x64_bf16 v[156:159], v[148:151], v[64:71], v3
  v_smfmac_f32_16x16x64_bf16 v[156:159], v[152:155], v[72:79], v3
  s_nop 7
  s_branch cB_va0_ep
.p2align 6

cB_va1_loop:
  s_add_u32 s23, s20, 4096
  s_add_u32 s21, s20, 20480
  s_mov_b32 s30, 0
  s_cmp_lg_u32 s19, s38
  s_cbranch_scc1 cB_va1_vok
  s_branch cB_va1_voc
cB_va1_vow:
  s_sub_u32 s22, s39, s35
  v_lshlrev_b32 v63, 7, v2
  v_min_u32 v63, s22, v63
  buffer_load_dword v63, v63, s[8:11], s35 offen sc1
  s_waitcnt vmcnt(0)
cB_va1_voc:
  v_readfirstlane_b32 s22, v63
  s_cmp_eq_u32 s22, 56
  s_cbranch_scc1 cB_va1_vod
  s_sleep 1
  s_add_u32 s30, s30, 1
  s_cmp_lt_u32 s30, 400000
  s_cbranch_scc1 cB_va1_vow
  s_branch cB_abort
cB_va1_vod:
  s_add_u32 s35, s35, 2048
  s_add_u32 s38, s19, 8
  s_and_b32 s38, s38, -8
  s_cmp_eq_u32 s19, 0
  s_cselect_b32 s38, 4, s38
  v_cmp_ne_u32 vcc, 56, v63
  s_nop 3
  s_cmp_eq_u64 vcc, 0
  s_cselect_b32 s38, 99, s38
cB_va1_vok:
  s_cmp_eq_u32 s19, 63
  s_cbranch_scc1 cB_done
  s_barrier
  s_add_u32 s22, s25, 0
  buffer_load_dwordx4 v[80:83], v6, s[8:11], s22 offen offset:0 sc1
  buffer_load_dwordx4 v[84:87], v6, s[8:11], s22 offen offset:1792 sc1
  s_add_u32 s22, s25, 3584
  buffer_load_dwordx4 v[88:91], v6, s[8:11], s22 offen offset:0 sc1
  buffer_load_dwordx4 v[92:95], v6, s[8:11], s22 offen offset:1792 sc1
  s_add_u32 s22, s25, 7168
  buffer_load_dwordx4 v[96:99], v6, s[8:11], s22 offen offset:0 sc1
  buffer_load_dwordx4 v[100:103], v6, s[8:11], s22 offen offset:1792 sc1
  s_add_u32 s22, s25, 10752
  buffer_load_dwordx4 v[104:107], v6, s[8:11], s22 offen offset:0 sc1
  buffer_load_dwordx4 v[108:111], v6, s[8:11], s22 offen offset:1792 sc1
  s_add_u32 s22, s25, 14336
  buffer_load_dwordx4 v[112:115], v6, s[8:11], s22 offen offset:0 sc1
  buffer_load_dwordx4 v[116:119], v6, s[8:11], s22 offen offset:1792 sc1
  s_add_u32 s22, s25, 17920
  buffer_load_dwordx4 v[120:123], v6, s[8:11], s22 offen offset:0 sc1
  buffer_load_dwordx4 v[124:127], v6, s[8:11], s22 offen offset:1792 sc1
  s_add_u32 s22, s19, 1
  s_cmp_lg_u32 s22, s38
  s_cbranch_scc1 cB_va1_nk
  s_sub_u32 s22, s39, s35
  v_lshlrev_b32 v63, 7, v2
  v_min_u32 v63, s22, v63
  buffer_load_dword v63, v63, s[8:11], s35 offen sc1
cB_va1_nk:
  s_barrier
  ds_read_b128 v[8:11], v0 offset:8192
  ds_read_b128 v[12:15], v0 offset:9216
  ds_read_b128 v[16:19], v0 offset:10240
  ds_read_b128 v[20:23], v0 offset:11264
  ds_read_b128 v[24:27], v0 offset:12288
  ds_read_b128 v[28:31], v0 offset:13312
  ds_read_b128 v[32:35], v0 offset:14336
  s_waitcnt lgkmcnt(0)
  v_smfmac_f32_16x16x64_bf16 v[36:39], v[8:11], a[0:7], v3
  s_add_u32 s22, s25, 21504
  buffer_load_dwordx4 v[128:131], v6, s[8:11], s22 offen offset:0 sc1
  v_smfmac_f32_16x16x64_bf16 v[36:39], v[12:15], a[8:15], v3
  v_smfmac_f32_16x16x64_bf16 v[36:39], v[16:19], a[16:23], v3
  s_add_u32 s22, s25, 21504
  buffer_load_dwordx4 v[132:135], v6, s[8:11], s22 offen offset:1792 sc1
  v_smfmac_f32_16x16x64_bf16 v[36:39], v[20:23], a[24:31], v3
  v_smfmac_f32_16x16x64_bf16 v[36:39], v[24:27], a[32:39], v3
  s_add_u32 s22, s25, 25088
  buffer_load_dwordx4 v[136:139], v6, s[8:11], s22 offen offset:0 sc1
  v_smfmac_f32_16x16x64_bf16 v[36:39], v[28:31], a[40:47], v3
  v_smfmac_f32_16x16x64_bf16 v[36:39], v[32:35], a[48:55], v3
  s_add_u32 s22, s25, 25088
  buffer_load_dwordx4 v[140:143], v6, s[8:11], s22 offen offset:1792 sc1
  v_smfmac_f32_16x16x64_bf16 v[40:43], v[8:11], a[56:63], v3
  v_smfmac_f32_16x16x64_bf16 v[40:43], v[12:15], a[64:71], v3
  v_smfmac_f32_16x16x64_bf16 v[40:43], v[16:19], a[72:79], v3
  v_add_f32 v36, v36, v37
  v_smfmac_f32_16x16x64_bf16 v[40:43], v[20:23], a[80:87], v3
  v_add_f32 v38, v38, v39
  v_smfmac_f32_16x16x64_bf16 v[40:43], v[24:27], a[88:95], v3
  v_cvt_pk_bf16_f32 v36, v36, v38
  v_smfmac_f32_16x16x64_bf16 v[40:43], v[28:31], a[96:103], v3
  ds_write_b32 v60, v36
  v_smfmac_f32_16x16x64_bf16 v[40:43], v[32:35], a[104:111], v3
  v_smfmac_f32_16x16x64_bf16 v[44:47], v[8:11], a[112:119], v3
  v_smfmac_f32_16x16x64_bf16 v[44:47], v[12:15], a[120:127], v3
  v_smfmac_f32_16x16x64_bf16 v[44:47], v[16:19], a[128:135], v3
  v_add_f32 v40, v40, v41
  v_smfmac_f32_16x16x64_bf16 v[44:47], v[20:23], a[136:143], v3
  v_add_f32 v42, v42, v43
  v_smfmac_f32_16x16x64_bf16 v[44:47], v[24:27], a[144:151], v3
  v_cvt_pk_bf16_f32 v40, v40, v42
  v_smfmac_f32_16x16x64_bf16 v[44:47], v[28:31], a[152:159], v3
  ds_write_b32 v61, v40
  v_smfmac_f32_16x16x64_bf16 v[44:47], v[32:35], a[160:167], v3
  v_smfmac_f32_16x16x64_bf16 v[48:51], v[8:11], a[168:175], v3
  v_smfmac_f32_16x16x64_bf16 v[48:51], v[12:15], a[176:183], v3
  v_smfmac_f32_16x16x64_bf16 v[48:51], v[16:19], a[184:191], v3
  v_add_f32 v44, v44, v45
  v_smfmac_f32_16x16x64_bf16 v[48:51], v[20:23], a[192:199], v3
  v_add_f32 v46, v46, v47
  v_smfmac_f32_16x16x64_bf16 v[48:51], v[24:27], a[200:207], v3
  v_cvt_pk_bf16_f32 v44, v44, v46
  v_smfmac_f32_16x16x64_bf16 v[48:51], v[28:31], a[208:215], v3
  ds_write_b32 v62, v44
  v_smfmac_f32_16x16x64_bf16 v[48:51], v[32:35], a[216:223], v3
  v_smfmac_f32_16x16x64_bf16 v[52:55], v[8:11], a[224:231], v3
  v_smfmac_f32_16x16x64_bf16 v[52:55], v[12:15], a[232:239], v3
  v_smfmac_f32_16x16x64_bf16 v[52:55], v[16:19], a[240:247], v3
  v_add_f32 v48, v48, v49
  v_smfmac_f32_16x16x64_bf16 v[52:55], v[20:23], a[248:255], v3
  v_add_f32 v50, v50, v51
  v_smfmac_f32_16x16x64_bf16 v[52:55], v[24:27], v[176:183], v3
  v_cvt_pk_bf16_f32 v48, v48, v50
  v_smfmac_f32_16x16x64_bf16 v[52:55], v[28:31], v[184:191], v3
  ds_write_b32 v170, v48
  v_smfmac_f32_16x16x64_bf16 v[52:55], v[32:35], v[192:199], v3
  v_smfmac_f32_16x16x64_bf16 v[56:59], v[8:11], v[200:207], v3
  v_smfmac_f32_16x16x64_bf16 v[56:59], v[12:15], v[208:215], v3
  v_smfmac_f32_16x16x64_bf16 v[56:59], v[16:19], v[216:223], v3
  v_add_f32 v52, v52, v53
  v_smfmac_f32_16x16x64_bf16 v[56:59], v[20:23], v[224:231], v3
  v_add_f32 v54, v54, v55
  v_smfmac_f32_16x16x64_bf16 v[56:59], v[24:27], v[232:239], v3
  v_cvt_pk_bf16_f32 v52, v52, v54
  v_smfmac_f32_16x16x64_bf16 v[56:59], v[28:31], v[240:247], v3
  ds_write_b32 v171, v52
  v_smfmac_f32_16x16x64_bf16 v[56:59], v[32:35], v[248:255], v3
  s_nop 7
  v_add_f32 v56, v56, v57
  v_add_f32 v58, v58, v59
  v_cvt_pk_bf16_f32 v56, v56, v58
  ds_write_b32 v172, v56
  s_waitcnt lgkmcnt(0)
  v_mov_b32 v36, 0
  v_mov_b32 v37, 0
  v_mov_b32 v38, 0
  v_mov_b32 v39, 0
  v_mov_b32 v40, 0
  v_mov_b32 v41, 0
  v_mov_b32 v42, 0
  v_mov_b32 v43, 0
  v_mov_b32 v44, 0
  v_mov_b32 v45, 0
  v_mov_b32 v46, 0
  v_mov_b32 v47, 0
  v_mov_b32 v48, 0
  v_mov_b32 v49, 0
  v_mov_b32 v50, 0
  v_mov_b32 v51, 0
  v_mov_b32 v52, 0
  v_mov_b32 v53, 0
  v_mov_b32 v54, 0
  v_mov_b32 v55, 0
  v_mov_b32 v56, 0
  v_mov_b32 v57, 0
  v_mov_b32 v58, 0
  v_mov_b32 v59, 0
  s_cmp_eq_u32 s19, 63
  s_cbranch_scc1 cB_va1_last
  s_add_u32 s22, s20, 9216
  s_add_u32 s34, s20, 13312
  s_add_u32 s36, s20, 7168
  s_mov_b32 s37, 0
  v_mov_b32 v156, 0
  v_mov_b32 v157, 0
  v_mov_b32 v158, 0
  v_mov_b32 v159, 0
  s_barrier
  s_waitcnt lgkmcnt(0)
  buffer_load_dwordx4 v[8:11], v5, s[8:11], s22 offen offset:0 sc1
  buffer_load_dwordx4 v[12:15], v5, s[8:11], s22 offen offset:1024 sc1
  buffer_load_dwordx4 v[16:19], v5, s[8:11], s22 offen offset:2048 sc1
  buffer_load_dwordx4 v[20:23], v5, s[8:11], s22 offen offset:3072 sc1
  buffer_load_dwordx4 v[24:27], v5, s[8:11], s34 offen offset:0 sc1
  buffer_load_dwordx4 v[28:31], v5, s[8:11], s34 offen offset:1024 sc1
  buffer_load_dwordx4 v[32:35], v5, s[8:11], s34 offen offset:2048 sc1
  buffer_load_dwordx4 v[144:147], v5, s[8:11], s34 offen offset:3072 sc1
  s_sub_u32 s23, s21, 4
  s_mov_b64 exec, 65535
  buffer_store_dword v2, v7, s[8:11], s23 offen sc1
  s_mov_b64 exec, -1
  buffer_load_dwordx4 v[148:151], v2, s[8:11], s36 offen offset:0 sc1
  buffer_load_dwordx4 v[152:155], v2, s[8:11], s36 offen offset:1024 sc1
  ds_read_b128 v[64:67], v2 offset:4096
  ds_read_b128 v[68:71], v2 offset:5120
  ds_read_b128 v[72:75], v2 offset:6144
  ds_read_b128 v[76:79], v2 offset:7168
  s_waitcnt vmcnt(10)
  v_smfmac_f32_16x16x64_bf16 v[156:159], v[8:11], v[80:87], v3
  s_waitcnt vmcnt(9)
  v_smfmac_f32_16x16x64_bf16 v[156:159], v[12:15], v[88:95], v3
  s_waitcnt vmcnt(8)
  v_smfmac_f32_16x16x64_bf16 v[156:159], v[16:19], v[96:103], v3
  s_waitcnt vmcnt(7)
  v_smfmac_f32_16x16x64_bf16 v[156:159], v[20:23], v[104:111], v3
  s_waitcnt vmcnt(6)
  v_smfmac_f32_16x16x64_bf16 v[156:159], v[24:27], v[112:119], v3
  s_mov_b64 exec, 65535
  buffer_store_dword v2, v7, s[8:11], s21 offen sc1
  s_mov_b64 exec, -1
  s_waitcnt vmcnt(6)
  v_smfmac_f32_16x16x64_bf16 v[156:159], v[28:31], v[120:127], v3
  s_waitcnt vmcnt(5)
  v_smfmac_f32_16x16x64_bf16 v[156:159], v[32:35], v[128:135], v3
  s_waitcnt vmcnt(4)
  v_smfmac_f32_16x16x64_bf16 v[156:159], v[144:147], v[136:143], v3
  s_waitcnt vmcnt(2) lgkmcnt(0)
  v_smfmac_f32_16x16x64_bf16 v[156:159], v[148:151], v[64:71], v3
  s_waitcnt vmcnt(1)
  v_smfmac_f32_16x16x64_bf16 v[156:159], v[152:155], v[72:79], v3
cB_va1_ep:
  s_nop 7
  v_add_f32 v160, v156, v157
  v_add_f32 v161, v158, v159
  v_cmp_u_f32 vcc, v160, v161
  v_mov_b32_dpp v162, v160 row_ror:8 row_mask:0xf bank_mask:0xf
  v_mov_b32_dpp v160, v161 row_ror:8 row_mask:0xf bank_mask:0xc
  s_cbranch_vccnz cB_va1_rp
  v_mov_b32_dpp v161, v162 quad_perm:[0,1,2,3] row_mask:0xf bank_mask:0x3
  v_cvt_pk_bf16_f32 v160, v160, v161
cB_va1_pc:
  s_mov_b64 exec, s[26:27]
  buffer_store_dword v160, v1, s[8:11], s21 offen sc1
  s_cmp_lg_u32 s19, 62
  s_cbranch_scc1 cB_va1_nl
  s_mov_b32 s22, 88531968
  buffer_store_dword v160, v1, s[8:11], s22 offen sc1
  s_mov_b64 exec, -1
  s_branch cB_done
cB_va1_nl:
  s_mov_b64 exec, -1
  s_cmp_lg_u32 s19, 0
  s_cbranch_scc1 cB_va1_s0
  v_add_u32 v7, 512, v7
  v_lshl_add_u32 v7, v2, 3, v7
  s_mov_b64 exec, 65535
  buffer_store_dword v2, v7, s[8:11], s21 offen sc1
  buffer_store_dword v2, v7, s[8:11], s23 offen sc1
  s_mov_b64 exec, -1
cB_va1_s0:
  s_add_u32 s25, s25, 28672
  s_add_u32 s19, s19, 1
  s_mov_b32 s20, s21
  s_branch cB_va1_loop
cB_va1_last:
  s_waitcnt lgkmcnt(0)
  s_barrier
  s_branch cB_done
cB_va1_rp:
  s_cmp_eq_u32 s37, 0
  s_cbranch_scc1 cB_va1_rv
  v_mov_b32_dpp v161, v162 quad_perm:[0,1,2,3] row_mask:0xf bank_mask:0x3
  v_cvt_pk_bf16_f32 v160, v160, v161
  v_min_u32 v160, -2, v160
  s_branch cB_va1_pc
cB_va1_rv:
  buffer_load_dwordx4 v[8:11], v5, s[8:11], s22 offen offset:0 sc1
  buffer_load_dwordx4 v[12:15], v5, s[8:11], s22 offen offset:1024 sc1
  buffer_load_dwordx4 v[16:19], v5, s[8:11], s22 offen offset:2048 sc1
  buffer_load_dwordx4 v[20:23], v5, s[8:11], s22 offen offset:3072 sc1
  buffer_load_dwordx4 v[24:27], v5, s[8:11], s34 offen offset:0 sc1
  buffer_load_dwordx4 v[28:31], v5, s[8:11], s34 offen offset:1024 sc1
  buffer_load_dwordx4 v[32:35], v5, s[8:11], s34 offen offset:2048 sc1
  buffer_load_dwordx4 v[144:147], v5, s[8:11], s34 offen offset:3072 sc1
  buffer_load_dwordx4 v[148:151], v2, s[8:11], s36 offen offset:0 sc1
  buffer_load_dwordx4 v[152:155], v2, s[8:11], s36 offen offset:1024 sc1
  s_waitcnt vmcnt(0)
  v_max3_u32 v175, v8, v9, v10
  v_max3_u32 v175, v175, v11, v12
  v_max3_u32 v175, v175, v13, v14
  v_max3_u32 v175, v175, v15, v16
  v_max3_u32 v175, v175, v17, v18
  v_max3_u32 v175, v175, v19, v20
  v_max3_u32 v175, v175, v21, v22
  v_max3_u32 v175, v175, v23, v24
  v_max3_u32 v175, v175, v25, v26
  v_max3_u32 v175, v175, v27, v28
  v_max3_u32 v175, v175, v29, v30
  v_max3_u32 v175, v175, v31, v32
  v_max3_u32 v175, v175, v33, v34
  v_max3_u32 v175, v175, v35, v144
  v_max3_u32 v175, v175, v145, v146
  v_max3_u32 v175, v175, v147, v148
  v_max3_u32 v175, v175, v149, v150
  v_max3_u32 v175, v175, v151, v152
  v_max3_u32 v175, v175, v153, v154
  v_max_u32 v175, v175, v155
  v_cmp_eq_u32 vcc, -1, v175
  s_cbranch_vccz cB_va1_rk
  s_add_u32 s30, s30, 1
  s_cmp_lt_u32 s30, 400000
  s_cbranch_scc1 cB_va1_rv
  s_branch cB_abort
cB_va1_rk:
  s_mov_b32 s37, 1
  s_add_u32 s31, s31, 0x10000
  v_mov_b32 v156, 0
  v_mov_b32 v157, 0
  v_mov_b32 v158, 0
  v_mov_b32 v159, 0
  s_nop 1
  v_smfmac_f32_16x16x64_bf16 v[156:159], v[8:11], v[80:87], v3
  v_smfmac_f32_16x16x64_bf16 v[156:159], v[12:15], v[88:95], v3
  v_smfmac_f32_16x16x64_bf16 v[156:159], v[16:19], v[96:103], v3
  v_smfmac_f32_16x16x64_bf16 v[156:159], v[20:23], v[104:111], v3
  v_smfmac_f32_16x16x64_bf16 v[156:159], v[24:27], v[112:119], v3
  v_smfmac_f32_16x16x64_bf16 v[156:159], v[28:31], v[120:127], v3
  v_smfmac_f32_16x16x64_bf16 v[156:159], v[32:35], v[128:135], v3
  v_smfmac_f32_16x16x64_bf16 v[156:159], v[144:147], v[136:143], v3
  v_smfmac_f32_16x16x64_bf16 v[156:159], v[148:151], v[64:71], v3
  v_smfmac_f32_16x16x64_bf16 v[156:159], v[152:155], v[72:79], v3
  s_nop 7
  s_branch cB_va1_ep
.p2align 6

cB_va2_loop:
  s_add_u32 s23, s20, 4096
  s_add_u32 s21, s20, 20480
  v_mov_b32 v36, 0
  v_mov_b32 v37, 0
  v_mov_b32 v38, 0
  v_mov_b32 v39, 0
  v_mov_b32 v40, 0
  v_mov_b32 v41, 0
  v_mov_b32 v42, 0
  v_mov_b32 v43, 0
  v_mov_b32 v44, 0
  v_mov_b32 v45, 0
  v_mov_b32 v46, 0
  v_mov_b32 v47, 0
  v_mov_b32 v48, 0
  v_mov_b32 v49, 0
  v_mov_b32 v50, 0
  v_mov_b32 v51, 0
  v_mov_b32 v52, 0
  v_mov_b32 v53, 0
  v_mov_b32 v54, 0
  v_mov_b32 v55, 0
  v_mov_b32 v56, 0
  v_mov_b32 v57, 0
  v_mov_b32 v58, 0
  v_mov_b32 v59, 0
  v_mov_b32 v60, 0
  v_mov_b32 v61, 0
  v_mov_b32 v62, 0
  v_mov_b32 v63, 0
  v_mov_b32 v64, 0
  v_mov_b32 v65, 0
  v_mov_b32 v66, 0
  v_mov_b32 v67, 0
  s_mov_b32 s30, 0
  buffer_load_dword v76, v119, s[8:11], s20 offen sc1
  buffer_load_dword v77, v119, s[8:11], s20 offen sc1
  buffer_load_dword v78, v119, s[8:11], s20 offen sc1
cB_va2_fp_l:
  s_waitcnt vmcnt(2)
  v_cmp_eq_u32 vcc, -1, v76
  s_cbranch_vccz cB_va2_fp_d
  buffer_load_dword v76, v119, s[8:11], s20 offen sc1
  s_waitcnt vmcnt(2)
  v_cmp_eq_u32 vcc, -1, v77
  s_cbranch_vccz cB_va2_fp_d
  buffer_load_dword v77, v119, s[8:11], s20 offen sc1
  s_waitcnt vmcnt(2)
  v_cmp_eq_u32 vcc, -1, v78
  s_cbranch_vccz cB_va2_fp_d
  buffer_load_dword v78, v119, s[8:11], s20 offen sc1
  s_add_u32 s30, s30, 1
  s_cmp_lt_u32 s30, 400000
  s_cbranch_scc1 cB_va2_fp_l
  s_branch cB_abort
cB_va2_fp_d:
  s_nop 15
  s_nop 3
  buffer_load_dwordx4 v[8:11], v2, s[8:11], s20 offen offset:0 sc1
  buffer_load_dwordx4 v[12:15], v2, s[8:11], s20 offen offset:1024 sc1
  buffer_load_dwordx4 v[16:19], v2, s[8:11], s20 offen offset:2048 sc1
  buffer_load_dwordx4 v[20:23], v2, s[8:11], s20 offen offset:3072 sc1
  s_barrier
cB_va2_ld:
  s_waitcnt vmcnt(0)
  v_max3_u32 v84, v8, v9, v10
  v_max3_u32 v84, v84, v11, v12
  v_max3_u32 v84, v84, v13, v14
  v_max3_u32 v84, v84, v15, v16
  v_max3_u32 v84, v84, v17, v18
  v_max3_u32 v84, v84, v19, v20
  v_max3_u32 v84, v84, v21, v22
  v_max_u32 v84, v84, v23
  v_cmp_eq_u32 vcc, -1, v84
  ds_write_b128 v2, v[8:11] offset:8192
  ds_write_b128 v2, v[12:15] offset:9216
  ds_write_b128 v2, v[16:19] offset:10240
  ds_write_b128 v2, v[20:23] offset:11264
  s_cbranch_vccnz cB_va2_retry
  s_waitcnt lgkmcnt(0)
  s_barrier
  ds_read_b128 v[8:11], v5 offset:8192
  ds_read_b128 v[12:15], v5 offset:9216
  ds_read_b128 v[16:19], v5 offset:10240
  ds_read_b128 v[20:23], v5 offset:11264
  ds_read_b128 v[24:27], v5 offset:12288
  ds_read_b128 v[28:31], v5 offset:13312
  ds_read_b128 v[32:35], v5 offset:14336
  ds_read_b128 v[92:95], v0
  s_waitcnt lgkmcnt(0)
  s_mov_b64 exec, s[26:27]
  buffer_store_dwordx4 v[92:95], v2, s[8:11], s36 offen sc1
  s_mov_b64 exec, -1
  s_add_u32 s36, s36, 7168
  s_cmp_eq_u32 s19, 63
  s_cbranch_scc1 cB_done
  ds_read_b128 v[76:79], v1 offset:0
  ds_read_b128 v[80:83], v1 offset:1024
  ds_read_b128 v[84:87], v1 offset:2048
  ds_read_b128 v[88:91], v1 offset:3072
  ds_read_b128 v[92:95], v1 offset:4096
  ds_read_b128 v[96:99], v1 offset:5120
  v_smfmac_f32_16x16x64_bf16 v[60:63], v[8:11], v[200:207], v3
  v_smfmac_f32_16x16x64_bf16 v[60:63], v[12:15], v[208:215], v3
  s_waitcnt lgkmcnt(4)
  v_smfmac_f32_16x16x64_bf16 v[64:67], v[8:11], v[76:83], v3
  ds_read_b128 v[76:79], v1 offset:6144
  ds_read_b128 v[80:83], v1 offset:7168
  v_smfmac_f32_16x16x64_bf16 v[60:63], v[16:19], v[216:223], v3
  v_smfmac_f32_16x16x64_bf16 v[60:63], v[20:23], v[224:231], v3
  s_waitcnt lgkmcnt(4)
  v_smfmac_f32_16x16x64_bf16 v[64:67], v[12:15], v[84:91], v3
  ds_read_b128 v[84:87], v1 offset:8192
  ds_read_b128 v[88:91], v1 offset:9216
  v_smfmac_f32_16x16x64_bf16 v[60:63], v[24:27], v[232:239], v3
  v_smfmac_f32_16x16x64_bf16 v[60:63], v[28:31], v[240:247], v3
  s_waitcnt lgkmcnt(4)
  v_smfmac_f32_16x16x64_bf16 v[64:67], v[16:19], v[92:99], v3
  ds_read_b128 v[92:95], v1 offset:10240
  ds_read_b128 v[96:99], v1 offset:11264
  v_smfmac_f32_16x16x64_bf16 v[60:63], v[32:35], v[248:255], v3
  v_smfmac_f32_16x16x64_bf16 v[36:39], v[8:11], a[0:7], v3
  s_waitcnt lgkmcnt(4)
  v_smfmac_f32_16x16x64_bf16 v[64:67], v[20:23], v[76:83], v3
  ds_read_b128 v[76:79], v1 offset:12288
  ds_read_b128 v[80:83], v1 offset:13312
  v_smfmac_f32_16x16x64_bf16 v[36:39], v[12:15], a[8:15], v3
  v_add_f32 v60, v60, v61
  v_smfmac_f32_16x16x64_bf16 v[36:39], v[16:19], a[16:23], v3
  v_add_f32 v62, v62, v63
  s_waitcnt lgkmcnt(4)
  v_smfmac_f32_16x16x64_bf16 v[64:67], v[24:27], v[84:91], v3
  v_cvt_pk_bf16_f32 v60, v60, v62
  v_smfmac_f32_16x16x64_bf16 v[36:39], v[20:23], a[24:31], v3
  ds_write_b32 v106, v60
  v_smfmac_f32_16x16x64_bf16 v[36:39], v[24:27], a[32:39], v3
  s_waitcnt lgkmcnt(2)
  v_smfmac_f32_16x16x64_bf16 v[64:67], v[28:31], v[92:99], v3
  v_smfmac_f32_16x16x64_bf16 v[36:39], v[28:31], a[40:47], v3
  v_smfmac_f32_16x16x64_bf16 v[36:39], v[32:35], a[48:55], v3
  s_waitcnt lgkmcnt(0)
  v_smfmac_f32_16x16x64_bf16 v[64:67], v[32:35], v[76:83], v3
  v_smfmac_f32_16x16x64_bf16 v[40:43], v[8:11], a[56:63], v3
  v_smfmac_f32_16x16x64_bf16 v[40:43], v[12:15], a[64:71], v3
  v_add_f32 v36, v36, v37
  v_smfmac_f32_16x16x64_bf16 v[40:43], v[16:19], a[72:79], v3
  v_add_f32 v38, v38, v39
  v_smfmac_f32_16x16x64_bf16 v[40:43], v[20:23], a[80:87], v3
  v_cvt_pk_bf16_f32 v36, v36, v38
  v_smfmac_f32_16x16x64_bf16 v[40:43], v[24:27], a[88:95], v3
  ds_write_b32 v100, v36
  v_smfmac_f32_16x16x64_bf16 v[40:43], v[28:31], a[96:103], v3
  v_add_f32 v64, v64, v65
  v_smfmac_f32_16x16x64_bf16 v[40:43], v[32:35], a[104:111], v3
  v_add_f32 v66, v66, v67
  v_smfmac_f32_16x16x64_bf16 v[44:47], v[8:11], a[112:119], v3
  v_cvt_pk_bf16_f32 v64, v64, v66
  v_smfmac_f32_16x16x64_bf16 v[44:47], v[12:15], a[120:127], v3
  ds_write_b32 v107, v64
  v_smfmac_f32_16x16x64_bf16 v[44:47], v[16:19], a[128:135], v3
  v_add_f32 v40, v40, v41
  v_smfmac_f32_16x16x64_bf16 v[44:47], v[20:23], a[136:143], v3
  v_add_f32 v42, v42, v43
  v_smfmac_f32_16x16x64_bf16 v[44:47], v[24:27], a[144:151], v3
  v_cvt_pk_bf16_f32 v40, v40, v42
  v_smfmac_f32_16x16x64_bf16 v[44:47], v[28:31], a[152:159], v3
  ds_write_b32 v101, v40
  v_smfmac_f32_16x16x64_bf16 v[44:47], v[32:35], a[160:167], v3
  v_smfmac_f32_16x16x64_bf16 v[48:51], v[8:11], a[168:175], v3
  v_smfmac_f32_16x16x64_bf16 v[48:51], v[12:15], a[176:183], v3
  v_smfmac_f32_16x16x64_bf16 v[48:51], v[16:19], a[184:191], v3
  v_add_f32 v44, v44, v45
  v_smfmac_f32_16x16x64_bf16 v[48:51], v[20:23], a[192:199], v3
  v_add_f32 v46, v46, v47
  v_smfmac_f32_16x16x64_bf16 v[48:51], v[24:27], a[200:207], v3
  v_cvt_pk_bf16_f32 v44, v44, v46
  v_smfmac_f32_16x16x64_bf16 v[48:51], v[28:31], a[208:215], v3
  ds_write_b32 v102, v44
  v_smfmac_f32_16x16x64_bf16 v[48:51], v[32:35], a[216:223], v3
  v_smfmac_f32_16x16x64_bf16 v[52:55], v[8:11], a[224:231], v3
  v_smfmac_f32_16x16x64_bf16 v[52:55], v[12:15], a[232:239], v3
  v_smfmac_f32_16x16x64_bf16 v[52:55], v[16:19], a[240:247], v3
  v_add_f32 v48, v48, v49
  v_smfmac_f32_16x16x64_bf16 v[52:55], v[20:23], a[248:255], v3
  v_add_f32 v50, v50, v51
  v_smfmac_f32_16x16x64_bf16 v[52:55], v[24:27], v[120:127], v3
  v_cvt_pk_bf16_f32 v48, v48, v50
  v_smfmac_f32_16x16x64_bf16 v[52:55], v[28:31], v[128:135], v3
  ds_write_b32 v103, v48
  v_smfmac_f32_16x16x64_bf16 v[52:55], v[32:35], v[136:143], v3
  v_smfmac_f32_16x16x64_bf16 v[56:59], v[8:11], v[144:151], v3
  v_smfmac_f32_16x16x64_bf16 v[56:59], v[12:15], v[152:159], v3
  v_smfmac_f32_16x16x64_bf16 v[56:59], v[16:19], v[160:167], v3
  v_add_f32 v52, v52, v53
  v_smfmac_f32_16x16x64_bf16 v[56:59], v[20:23], v[168:175], v3
  v_add_f32 v54, v54, v55
  v_smfmac_f32_16x16x64_bf16 v[56:59], v[24:27], v[176:183], v3
  v_cvt_pk_bf16_f32 v52, v52, v54
  v_smfmac_f32_16x16x64_bf16 v[56:59], v[28:31], v[184:191], v3
  ds_write_b32 v104, v52
  v_smfmac_f32_16x16x64_bf16 v[56:59], v[32:35], v[192:199], v3
  s_nop 7
  v_add_f32 v56, v56, v57
  v_add_f32 v58, v58, v59
  v_cvt_pk_bf16_f32 v56, v56, v58
  ds_write_b32 v105, v56
  s_waitcnt lgkmcnt(0)
  s_barrier
  s_cmp_eq_u32 s19, 62
  s_cbranch_scc1 cB_done
  s_waitcnt vmcnt(0) lgkmcnt(0)
  s_add_u32 s19, s19, 1
  s_mov_b32 s20, s21
  s_branch cB_va2_loop
cB_va2_retry:
  s_waitcnt lgkmcnt(0)
  buffer_load_dwordx4 v[8:11], v2, s[8:11], s20 offen offset:0 sc1
  buffer_load_dwordx4 v[12:15], v2, s[8:11], s20 offen offset:1024 sc1
  buffer_load_dwordx4 v[16:19], v2, s[8:11], s20 offen offset:2048 sc1
  buffer_load_dwordx4 v[20:23], v2, s[8:11], s20 offen offset:3072 sc1
  s_add_u32 s31, s31, 1
  s_add_u32 s30, s30, 1
  s_cmp_lt_u32 s30, 400000
  s_cbranch_scc1 cB_va2_ld
  s_branch cB_abort
cB_va2_last:
  s_waitcnt lgkmcnt(0)
  buffer_store_dwordx4 v[100:103], v2, s[8:11], s24 offen offset:0 sc1
  buffer_store_dwordx4 v[104:107], v2, s[8:11], s24 offen offset:1024 sc1
  buffer_store_dwordx4 v[108:111], v2, s[8:11], s24 offen offset:2048 sc1
  buffer_store_dwordx4 v[4:7], v2, s[8:11], s24 offen offset:3072 sc1
  s_add_u32 s24, s24, 8192
  s_waitcnt vmcnt(0)
  s_mov_b64 exec, 1
  buffer_store_dword v117, v2, s[8:11], s34 offen sc1
  s_mov_b64 exec, -1
  s_add_u32 s34, s34, 8
  s_mov_b64 exec, 1
  buffer_store_dword v117, v2, s[8:11], s34 offen sc1
  s_mov_b64 exec, -1
  s_add_u32 s34, s34, 8
  s_branch cB_done
.p2align 6

cB_va3_loop:
  s_add_u32 s23, s20, 4096
  s_add_u32 s21, s20, 20480
  v_mov_b32 v36, 0
  v_mov_b32 v37, 0
  v_mov_b32 v38, 0
  v_mov_b32 v39, 0
  v_mov_b32 v40, 0
  v_mov_b32 v41, 0
  v_mov_b32 v42, 0
  v_mov_b32 v43, 0
  v_mov_b32 v44, 0
  v_mov_b32 v45, 0
  v_mov_b32 v46, 0
  v_mov_b32 v47, 0
  v_mov_b32 v48, 0
  v_mov_b32 v49, 0
  v_mov_b32 v50, 0
  v_mov_b32 v51, 0
  v_mov_b32 v52, 0
  v_mov_b32 v53, 0
  v_mov_b32 v54, 0
  v_mov_b32 v55, 0
  v_mov_b32 v56, 0
  v_mov_b32 v57, 0
  v_mov_b32 v58, 0
  v_mov_b32 v59, 0
  v_mov_b32 v60, 0
  v_mov_b32 v61, 0
  v_mov_b32 v62, 0
  v_mov_b32 v63, 0
  v_mov_b32 v64, 0
  v_mov_b32 v65, 0
  v_mov_b32 v66, 0
  v_mov_b32 v67, 0
  s_mov_b32 s30, 0
  buffer_load_dword v76, v119, s[8:11], s20 offen sc1
  buffer_load_dword v77, v119, s[8:11], s20 offen sc1
  buffer_load_dword v78, v119, s[8:11], s20 offen sc1
cB_va3_fp_l:
  s_waitcnt vmcnt(2)
  v_cmp_eq_u32 vcc, -1, v76
  s_cbranch_vccz cB_va3_fp_d
  buffer_load_dword v76, v119, s[8:11], s20 offen sc1
  s_waitcnt vmcnt(2)
  v_cmp_eq_u32 vcc, -1, v77
  s_cbranch_vccz cB_va3_fp_d
  buffer_load_dword v77, v119, s[8:11], s20 offen sc1
  s_waitcnt vmcnt(2)
  v_cmp_eq_u32 vcc, -1, v78
  s_cbranch_vccz cB_va3_fp_d
  buffer_load_dword v78, v119, s[8:11], s20 offen sc1
  s_add_u32 s30, s30, 1
  s_cmp_lt_u32 s30, 400000
  s_cbranch_scc1 cB_va3_fp_l
  s_branch cB_abort
cB_va3_fp_d:
  buffer_load_dwordx4 v[24:27], v2, s[8:11], s23 offen offset:0 sc1
  buffer_load_dwordx4 v[28:31], v2, s[8:11], s23 offen offset:1024 sc1
  buffer_load_dwordx4 v[32:35], v2, s[8:11], s23 offen offset:2048 sc1
  s_barrier
cB_va3_ld:
  s_waitcnt vmcnt(0)
  v_max3_u32 v84, v24, v25, v26
  v_max3_u32 v84, v84, v27, v28
  v_max3_u32 v84, v84, v29, v30
  v_max3_u32 v84, v84, v31, v32
  v_max3_u32 v84, v84, v33, v34
  v_max_u32 v84, v84, v35
  v_cmp_eq_u32 vcc, -1, v84
  ds_write_b128 v2, v[24:27] offset:12288
  ds_write_b128 v2, v[28:31] offset:13312
  ds_write_b128 v2, v[32:35] offset:14336
  s_cbranch_vccnz cB_va3_retry
  s_waitcnt lgkmcnt(0)
  s_barrier
  ds_read_b128 v[8:11], v5 offset:8192
  ds_read_b128 v[12:15], v5 offset:9216
  ds_read_b128 v[16:19], v5 offset:10240
  ds_read_b128 v[20:23], v5 offset:11264
  ds_read_b128 v[24:27], v5 offset:12288
  ds_read_b128 v[28:31], v5 offset:13312
  ds_read_b128 v[32:35], v5 offset:14336
  s_waitcnt lgkmcnt(0)
  s_cmp_eq_u32 s19, 63
  s_cbranch_scc1 cB_done
  ds_read_b128 v[76:79], v1 offset:0
  ds_read_b128 v[80:83], v1 offset:1024
  ds_read_b128 v[84:87], v1 offset:2048
  ds_read_b128 v[88:91], v1 offset:3072
  ds_read_b128 v[92:95], v1 offset:4096
  ds_read_b128 v[96:99], v1 offset:5120
  v_smfmac_f32_16x16x64_bf16 v[60:63], v[8:11], v[200:207], v3
  v_smfmac_f32_16x16x64_bf16 v[60:63], v[12:15], v[208:215], v3
  s_waitcnt lgkmcnt(4)
  v_smfmac_f32_16x16x64_bf16 v[64:67], v[8:11], v[76:83], v3
  ds_read_b128 v[76:79], v1 offset:6144
  ds_read_b128 v[80:83], v1 offset:7168
  v_smfmac_f32_16x16x64_bf16 v[60:63], v[16:19], v[216:223], v3
  v_smfmac_f32_16x16x64_bf16 v[60:63], v[20:23], v[224:231], v3
  s_waitcnt lgkmcnt(4)
  v_smfmac_f32_16x16x64_bf16 v[64:67], v[12:15], v[84:91], v3
  ds_read_b128 v[84:87], v1 offset:8192
  ds_read_b128 v[88:91], v1 offset:9216
  v_smfmac_f32_16x16x64_bf16 v[60:63], v[24:27], v[232:239], v3
  v_smfmac_f32_16x16x64_bf16 v[60:63], v[28:31], v[240:247], v3
  s_waitcnt lgkmcnt(4)
  v_smfmac_f32_16x16x64_bf16 v[64:67], v[16:19], v[92:99], v3
  ds_read_b128 v[92:95], v1 offset:10240
  ds_read_b128 v[96:99], v1 offset:11264
  v_smfmac_f32_16x16x64_bf16 v[60:63], v[32:35], v[248:255], v3
  v_smfmac_f32_16x16x64_bf16 v[36:39], v[8:11], a[0:7], v3
  s_waitcnt lgkmcnt(4)
  v_smfmac_f32_16x16x64_bf16 v[64:67], v[20:23], v[76:83], v3
  ds_read_b128 v[76:79], v1 offset:12288
  ds_read_b128 v[80:83], v1 offset:13312
  v_smfmac_f32_16x16x64_bf16 v[36:39], v[12:15], a[8:15], v3
  v_add_f32 v60, v60, v61
  v_smfmac_f32_16x16x64_bf16 v[36:39], v[16:19], a[16:23], v3
  v_add_f32 v62, v62, v63
  s_waitcnt lgkmcnt(4)
  v_smfmac_f32_16x16x64_bf16 v[64:67], v[24:27], v[84:91], v3
  v_cvt_pk_bf16_f32 v60, v60, v62
  v_smfmac_f32_16x16x64_bf16 v[36:39], v[20:23], a[24:31], v3
  ds_write_b32 v106, v60
  v_smfmac_f32_16x16x64_bf16 v[36:39], v[24:27], a[32:39], v3
  s_waitcnt lgkmcnt(2)
  v_smfmac_f32_16x16x64_bf16 v[64:67], v[28:31], v[92:99], v3
  v_smfmac_f32_16x16x64_bf16 v[36:39], v[28:31], a[40:47], v3
  v_smfmac_f32_16x16x64_bf16 v[36:39], v[32:35], a[48:55], v3
  s_waitcnt lgkmcnt(0)
  v_smfmac_f32_16x16x64_bf16 v[64:67], v[32:35], v[76:83], v3
  v_smfmac_f32_16x16x64_bf16 v[40:43], v[8:11], a[56:63], v3
  v_smfmac_f32_16x16x64_bf16 v[40:43], v[12:15], a[64:71], v3
  v_add_f32 v36, v36, v37
  v_smfmac_f32_16x16x64_bf16 v[40:43], v[16:19], a[72:79], v3
  v_add_f32 v38, v38, v39
  v_smfmac_f32_16x16x64_bf16 v[40:43], v[20:23], a[80:87], v3
  v_cvt_pk_bf16_f32 v36, v36, v38
  v_smfmac_f32_16x16x64_bf16 v[40:43], v[24:27], a[88:95], v3
  ds_write_b32 v100, v36
  v_smfmac_f32_16x16x64_bf16 v[40:43], v[28:31], a[96:103], v3
  v_add_f32 v64, v64, v65
  v_smfmac_f32_16x16x64_bf16 v[40:43], v[32:35], a[104:111], v3
  v_add_f32 v66, v66, v67
  v_smfmac_f32_16x16x64_bf16 v[44:47], v[8:11], a[112:119], v3
  v_cvt_pk_bf16_f32 v64, v64, v66
  v_smfmac_f32_16x16x64_bf16 v[44:47], v[12:15], a[120:127], v3
  ds_write_b32 v107, v64
  v_smfmac_f32_16x16x64_bf16 v[44:47], v[16:19], a[128:135], v3
  v_add_f32 v40, v40, v41
  v_smfmac_f32_16x16x64_bf16 v[44:47], v[20:23], a[136:143], v3
  v_add_f32 v42, v42, v43
  v_smfmac_f32_16x16x64_bf16 v[44:47], v[24:27], a[144:151], v3
  v_cvt_pk_bf16_f32 v40, v40, v42
  v_smfmac_f32_16x16x64_bf16 v[44:47], v[28:31], a[152:159], v3
  ds_write_b32 v101, v40
  v_smfmac_f32_16x16x64_bf16 v[44:47], v[32:35], a[160:167], v3
  v_smfmac_f32_16x16x64_bf16 v[48:51], v[8:11], a[168:175], v3
  v_smfmac_f32_16x16x64_bf16 v[48:51], v[12:15], a[176:183], v3
  v_smfmac_f32_16x16x64_bf16 v[48:51], v[16:19], a[184:191], v3
  v_add_f32 v44, v44, v45
  v_smfmac_f32_16x16x64_bf16 v[48:51], v[20:23], a[192:199], v3
  v_add_f32 v46, v46, v47
  v_smfmac_f32_16x16x64_bf16 v[48:51], v[24:27], a[200:207], v3
  v_cvt_pk_bf16_f32 v44, v44, v46
  v_smfmac_f32_16x16x64_bf16 v[48:51], v[28:31], a[208:215], v3
  ds_write_b32 v102, v44
  v_smfmac_f32_16x16x64_bf16 v[48:51], v[32:35], a[216:223], v3
  v_smfmac_f32_16x16x64_bf16 v[52:55], v[8:11], a[224:231], v3
  v_smfmac_f32_16x16x64_bf16 v[52:55], v[12:15], a[232:239], v3
  v_smfmac_f32_16x16x64_bf16 v[52:55], v[16:19], a[240:247], v3
  v_add_f32 v48, v48, v49
  v_smfmac_f32_16x16x64_bf16 v[52:55], v[20:23], a[248:255], v3
  v_add_f32 v50, v50, v51
  v_smfmac_f32_16x16x64_bf16 v[52:55], v[24:27], v[120:127], v3
  v_cvt_pk_bf16_f32 v48, v48, v50
  v_smfmac_f32_16x16x64_bf16 v[52:55], v[28:31], v[128:135], v3
  ds_write_b32 v103, v48
  v_smfmac_f32_16x16x64_bf16 v[52:55], v[32:35], v[136:143], v3
  v_smfmac_f32_16x16x64_bf16 v[56:59], v[8:11], v[144:151], v3
  v_smfmac_f32_16x16x64_bf16 v[56:59], v[12:15], v[152:159], v3
  v_smfmac_f32_16x16x64_bf16 v[56:59], v[16:19], v[160:167], v3
  v_add_f32 v52, v52, v53
  v_smfmac_f32_16x16x64_bf16 v[56:59], v[20:23], v[168:175], v3
  v_add_f32 v54, v54, v55
  v_smfmac_f32_16x16x64_bf16 v[56:59], v[24:27], v[176:183], v3
  v_cvt_pk_bf16_f32 v52, v52, v54
  v_smfmac_f32_16x16x64_bf16 v[56:59], v[28:31], v[184:191], v3
  ds_write_b32 v104, v52
  v_smfmac_f32_16x16x64_bf16 v[56:59], v[32:35], v[192:199], v3
  s_nop 7
  v_add_f32 v56, v56, v57
  v_add_f32 v58, v58, v59
  v_cvt_pk_bf16_f32 v56, v56, v58
  ds_write_b32 v105, v56
  s_waitcnt lgkmcnt(0)
  s_barrier
  s_cmp_eq_u32 s19, 62
  s_cbranch_scc1 cB_done
  s_waitcnt vmcnt(0) lgkmcnt(0)
  s_add_u32 s19, s19, 1
  s_mov_b32 s20, s21
  s_branch cB_va3_loop
cB_va3_retry:
  s_waitcnt lgkmcnt(0)
  buffer_load_dwordx4 v[24:27], v2, s[8:11], s23 offen offset:0 sc1
  buffer_load_dwordx4 v[28:31], v2, s[8:11], s23 offen offset:1024 sc1
  buffer_load_dwordx4 v[32:35], v2, s[8:11], s23 offen offset:2048 sc1
  s_add_u32 s31, s31, 1
  s_add_u32 s30, s30, 1
  s_cmp_lt_u32 s30, 400000
  s_cbranch_scc1 cB_va3_ld
  s_branch cB_abort
cB_va3_last:
  s_waitcnt lgkmcnt(0)
  buffer_store_dwordx4 v[100:103], v2, s[8:11], s24 offen offset:0 sc1
  buffer_store_dwordx4 v[104:107], v2, s[8:11], s24 offen offset:1024 sc1
  buffer_store_dwordx4 v[108:111], v2, s[8:11], s24 offen offset:2048 sc1
  buffer_store_dwordx4 v[4:7], v2, s[8:11], s24 offen offset:3072 sc1
  s_add_u32 s24, s24, 8192
  s_waitcnt vmcnt(0)
  s_mov_b64 exec, 1
  buffer_store_dword v117, v2, s[8:11], s34 offen sc1
  s_mov_b64 exec, -1
  s_add_u32 s34, s34, 8
  s_mov_b64 exec, 1
  buffer_store_dword v117, v2, s[8:11], s34 offen sc1
  s_mov_b64 exec, -1
  s_add_u32 s34, s34, 8
  s_branch cB_done
cB_abort:
  v_mov_b32 v4, 0xdead
  v_mov_b32 v5, 16
  buffer_store_dword v4, v5, s[12:15], 0 offen
  s_branch ch_end
cB_done:
  s_branch ch_end
m_reclaim:
  s_waitcnt vmcnt(0)
  s_lshr_b32 s20, s3, 5
  s_cmp_lg_u32 s16, 0
  s_cbranch_scc1 w0_17
  s_mov_b32 s21, 0
  s_mov_b64 exec, 1
rc_l:
  s_cmp_lg_u32 s70, -1
  s_cbranch_scc1 rc_t
  s_add_u32 s20, s20, 1
  s_cmp_lt_u32 s20, 8
  s_cselect_b32 s20, s20, 0
  s_mov_b32 s70, 0
  s_mov_b32 s3, -1
  s_add_u32 s21, s21, 1
  s_cmp_ge_u32 s21, 9
  s_cbranch_scc1 rc_d
rc_t:
  s_ff0_i32_b32 s22, s70
  s_lshl_b32 s23, 1, s22
  s_and_b32 s71, s20, 4
  s_mul_i32 s71, s71, 12
  s_lshl_b32 s3, s20, 2
  s_add_u32 s3, s3, s71
  v_mov_b32 v242, s23
  v_mov_b32 v243, 32
  buffer_atomic_or v242, v243, s[12:15], s3 offen sc0
  s_waitcnt vmcnt(0)
  v_readfirstlane_b32 s70, v242
  s_lshl_b32 s3, s20, 5
  s_add_u32 s3, s3, s22
  s_bitcmp1_b32 s70, s22
  s_cbranch_scc1 rc_l
rc_d:
  s_mov_b64 exec, -1
  v_mov_b32 v242, s3
w0_17:
  v_mov_b32 v250, 160000
  s_add_u32 s101, s101, 1
  s_barrier
  s_mov_b64 exec, 1
  s_cmp_lg_u32 s16, 0
  s_cbranch_scc1 w0_18
  ds_write_b32 v250, v242 offset:0
  s_waitcnt lgkmcnt(0)
  v_mov_b32 v242, s101
  ds_write_b32 v250, v242 offset:16
  s_waitcnt lgkmcnt(0)
w0_18:
  s_mov_b64 exec, -1
  s_barrier
  ds_read_b32 v242, v250 offset:0
  ds_read_b32 v250, v250 offset:16
  s_waitcnt lgkmcnt(0)
  v_readfirstlane_b32 s3, v242
  v_cmp_ne_u32 vcc, s101, v250
  s_cbranch_vccnz ch_end
  s_cmp_lg_u32 s3, -1
  s_cbranch_scc1 m_start
  v_mov_b32 v250, 0
  s_branch wk_ask
m_bjob:
  v_and_b32 v1, 63, v0
  v_lshlrev_b32 v2, 4, v1
  v_lshrrev_b32 v3, 4, v1
  v_and_b32 v4, 15, v1
  s_sub_u32 s18, s3, 32
  s_mul_i32 s17, s18, 4682
  s_lshr_b32 s17, s17, 16
  s_mul_i32 s20, s17, 14
  s_sub_u32 s19, s18, s20
  s_cmp_ge_u32 s19, 7
  s_cselect_b32 s31, 7, 0
  s_sub_u32 s19, s19, s31
  s_mov_b32 s60, s44
  s_and_b32 s61, s45, 0xffff
  s_mov_b32 s62, 3670016
  s_mov_b32 s63, 0x20000
  s_mov_b32 s56, s46
  s_and_b32 s57, s47, 0xffff
  s_mov_b32 s58, 3670016
  s_mov_b32 s59, 0x20000
  s_lshl_b32 s30, s16, 13
  s_mul_i32 s27, s17, 229376
  s_lshl_b32 s29, s19, 7
  s_add_u32 s27, s27, s29
  v_lshrrev_b32 v7, 3, v1
  v_and_b32 v8, 7, v1
  v_and_b32 v9, 2, v7
  v_xor_b32 v8, v8, v9
  s_lshl_b32 s29, s16, 6
  v_add_u32 v7, s29, v7
  v_mul_u32_u24 v7, 896, v7
  v_lshl_add_u32 v7, v8, 4, v7
  v_xor_b32 v8, 64, v7
  s_add_u32 m0, s30, 0
  s_add_u32 s22, s27, 0
  buffer_load_dwordx4 v7, s[56:59], s22 offen offset:0 lds
  s_add_u32 s22, s27, 6144
  buffer_load_dwordx4 v8, s[56:59], s22 offen offset:1024 lds
  s_add_u32 s22, s27, 12288
  buffer_load_dwordx4 v7, s[56:59], s22 offen offset:2048 lds
  s_add_u32 s22, s27, 18432
  buffer_load_dwordx4 v8, s[56:59], s22 offen offset:3072 lds
  s_add_u32 m0, s30, 4096
  s_add_u32 s22, s27, 28672
  buffer_load_dwordx4 v7, s[56:59], s22 offen offset:0 lds
  s_add_u32 s22, s27, 34816
  buffer_load_dwordx4 v8, s[56:59], s22 offen offset:1024 lds
  s_add_u32 s22, s27, 40960
  buffer_load_dwordx4 v7, s[56:59], s22 offen offset:2048 lds
  s_add_u32 s22, s27, 47104
  buffer_load_dwordx4 v8, s[56:59], s22 offen offset:3072 lds
  v_lshrrev_b32 v5, 5, v1
  v_and_b32 v6, 31, v1
  s_lshl_b32 s25, s16, 15
  s_add_u32 s25, s25, 32768
  s_lshl_b32 s26, s17, 9
  s_add_u32 s28, s19, s16
  s_cmp_ge_u32 s28, 7
  s_cselect_b32 s20, 7, 0
  s_sub_u32 s28, s28, s20
  s_add_u32 s28, s28, s31
  s_add_u32 s29, s19, s16
  s_add_u32 s29, s29, 4
  s_cmp_ge_u32 s29, 7
  s_cselect_b32 s20, 7, 0
  s_sub_u32 s29, s29, s20
  s_add_u32 s29, s29, s31
  s_lshl_b32 s32, s28, 18
  s_add_u32 s32, s32, s26
  s_lshl_b32 s33, s29, 18
  s_add_u32 s33, s33, s26
  v_xor_b32 v8, v6, v5
  v_lshlrev_b32 v8, 4, v8
  v_lshl_add_u32 v8, v5, 13, v8
  v_xor_b32 v12, 0, v8
  v_xor_b32 v13, 32, v8
  v_add_u32 v13, 15360, v13
  v_xor_b32 v14, 0, v8
  v_add_u32 v14, 30720, v14
  v_xor_b32 v15, 32, v8
  v_add_u32 v15, 46080, v15
  s_add_u32 s20, s16, 0
  s_and_b32 s20, s20, 3
  s_mul_i32 s21, s20, 65600
  s_lshl_b32 s20, s20, 12
  s_add_u32 s48, s20, s25
  s_mov_b32 m0, s48
  v_xor_b32 v16, s21, v12
  buffer_load_dwordx4 v16, s[60:63], s32 offen offset:0 lds
  v_xor_b32 v17, s21, v13
  buffer_load_dwordx4 v17, s[60:63], s32 offen offset:1024 lds
  v_xor_b32 v18, s21, v14
  buffer_load_dwordx4 v18, s[60:63], s32 offen offset:2048 lds
  v_xor_b32 v19, s21, v15
  buffer_load_dwordx4 v19, s[60:63], s32 offen offset:3072 lds
  s_add_u32 s20, s16, 1
  s_and_b32 s20, s20, 3
  s_mul_i32 s21, s20, 65600
  s_lshl_b32 s20, s20, 12
  s_add_u32 s49, s20, s25
  s_mov_b32 m0, s49
  v_xor_b32 v20, s21, v12
  buffer_load_dwordx4 v20, s[60:63], s32 offen offset:0 lds
  v_xor_b32 v21, s21, v13
  buffer_load_dwordx4 v21, s[60:63], s32 offen offset:1024 lds
  v_xor_b32 v22, s21, v14
  buffer_load_dwordx4 v22, s[60:63], s32 offen offset:2048 lds
  v_xor_b32 v23, s21, v15
  buffer_load_dwordx4 v23, s[60:63], s32 offen offset:3072 lds
  s_add_u32 s20, s16, 2
  s_and_b32 s20, s20, 3
  s_mul_i32 s21, s20, 65600
  s_lshl_b32 s20, s20, 12
  s_add_u32 s50, s20, s25
  s_mov_b32 m0, s50
  v_xor_b32 v24, s21, v12
  buffer_load_dwordx4 v24, s[60:63], s32 offen offset:0 lds
  v_xor_b32 v25, s21, v13
  buffer_load_dwordx4 v25, s[60:63], s32 offen offset:1024 lds
  v_xor_b32 v26, s21, v14
  buffer_load_dwordx4 v26, s[60:63], s32 offen offset:2048 lds
  v_xor_b32 v27, s21, v15
  buffer_load_dwordx4 v27, s[60:63], s32 offen offset:3072 lds
  s_add_u32 s20, s16, 3
  s_and_b32 s20, s20, 3
  s_mul_i32 s21, s20, 65600
  s_lshl_b32 s20, s20, 12
  s_add_u32 s51, s20, s25
  s_mov_b32 m0, s51
  v_xor_b32 v28, s21, v12
  buffer_load_dwordx4 v28, s[60:63], s32 offen offset:0 lds
  v_xor_b32 v29, s21, v13
  buffer_load_dwordx4 v29, s[60:63], s32 offen offset:1024 lds
  v_xor_b32 v30, s21, v14
  buffer_load_dwordx4 v30, s[60:63], s32 offen offset:2048 lds
  v_xor_b32 v31, s21, v15
  buffer_load_dwordx4 v31, s[60:63], s32 offen offset:3072 lds
  s_cmp_lg_u32 s66, 0
  s_cbranch_scc1 bj_ci
  s_cmp_lg_u32 s16, 0
  s_cbranch_scc1 w0_19
  s_lshr_b32 s70, s3, 5
  s_and_b32 s71, s70, 4
  s_mul_i32 s71, s71, 12
  s_lshl_b32 s70, s70, 2
  s_add_u32 s70, s70, s71
  s_lshl_b32 s71, 1, s3
  v_mov_b32 v44, s71
  v_mov_b32 v45, 32
  s_mov_b64 exec, 1
  buffer_atomic_or v44, v45, s[12:15], s70 offen sc0
  buffer_load_dwordx2 v[46:47], v45, s[12:15], 0 offen offset:96 sc1
  s_mov_b64 exec, -1
w0_19:
bj_ci:
  s_lshl_b32 s30, s19, 6
  s_add_u32 s30, s30, 0
  s_cmp_lt_u32 s19, 4
  s_cselect_b32 s20, 0, 256
  s_sub_u32 s30, s30, s20
  v_add_u32 v8, s30, v4
  s_lshr_b32 s20, s20, 4
  s_cmp_lt_u32 s19, 4
  s_movk_i32 s21, 5462
  s_cselect_b32 s21, 4096, s21
  s_cselect_b32 s30, 16, 12
  v_mul_u32_u24 v10, s21, v8
  v_lshrrev_b32 v10, 16, v10
  v_mul_u32_u24 v11, s30, v10
  v_sub_u32 v32, v8, v11
  v_add_u32 v32, s20, v32
  s_mul_i32 s30, s17, 28
  v_add_u32 v32, s30, v32
  v_lshrrev_b32 v33, 4, v32
  v_and_b32 v32, 15, v32
  s_mov_b32 s30, 401408
  v_mul_lo_u32 v10, v10, s30
  v_mul_u32_u24 v33, 14336, v33
  v_add_u32 v10, v10, v33
  v_lshl_add_u32 v10, v3, 8, v10
  v_lshl_add_u32 v10, v32, 4, v10
  v_add_u32 v12, 6422528, v10
  s_lshl_b32 s30, s19, 6
  s_add_u32 s30, s30, 16
  s_cmp_lt_u32 s19, 4
  s_cselect_b32 s20, 0, 256
  s_sub_u32 s30, s30, s20
  v_add_u32 v8, s30, v4
  s_lshr_b32 s20, s20, 4
  s_cmp_lt_u32 s19, 4
  s_movk_i32 s21, 5462
  s_cselect_b32 s21, 4096, s21
  s_cselect_b32 s30, 16, 12
  v_mul_u32_u24 v10, s21, v8
  v_lshrrev_b32 v10, 16, v10
  v_mul_u32_u24 v11, s30, v10
  v_sub_u32 v32, v8, v11
  v_add_u32 v32, s20, v32
  s_mul_i32 s30, s17, 28
  v_add_u32 v32, s30, v32
  v_lshrrev_b32 v33, 4, v32
  v_and_b32 v32, 15, v32
  s_mov_b32 s30, 401408
  v_mul_lo_u32 v10, v10, s30
  v_mul_u32_u24 v33, 14336, v33
  v_add_u32 v10, v10, v33
  v_lshl_add_u32 v10, v3, 8, v10
  v_lshl_add_u32 v10, v32, 4, v10
  v_add_u32 v13, 6422528, v10
  s_lshl_b32 s30, s19, 6
  s_add_u32 s30, s30, 32
  s_cmp_lt_u32 s19, 4
  s_cselect_b32 s20, 0, 256
  s_sub_u32 s30, s30, s20
  v_add_u32 v8, s30, v4
  s_lshr_b32 s20, s20, 4
  s_cmp_lt_u32 s19, 4
  s_movk_i32 s21, 5462
  s_cselect_b32 s21, 4096, s21
  s_cselect_b32 s30, 16, 12
  v_mul_u32_u24 v10, s21, v8
  v_lshrrev_b32 v10, 16, v10
  v_mul_u32_u24 v11, s30, v10
  v_sub_u32 v32, v8, v11
  v_add_u32 v32, s20, v32
  s_mul_i32 s30, s17, 28
  v_add_u32 v32, s30, v32
  v_lshrrev_b32 v33, 4, v32
  v_and_b32 v32, 15, v32
  s_mov_b32 s30, 401408
  v_mul_lo_u32 v10, v10, s30
  v_mul_u32_u24 v33, 14336, v33
  v_add_u32 v10, v10, v33
  v_lshl_add_u32 v10, v3, 8, v10
  v_lshl_add_u32 v10, v32, 4, v10
  v_add_u32 v14, 6422528, v10
  s_lshl_b32 s30, s19, 6
  s_add_u32 s30, s30, 48
  s_cmp_lt_u32 s19, 4
  s_cselect_b32 s20, 0, 256
  s_sub_u32 s30, s30, s20
  v_add_u32 v8, s30, v4
  s_lshr_b32 s20, s20, 4
  s_cmp_lt_u32 s19, 4
  s_movk_i32 s21, 5462
  s_cselect_b32 s21, 4096, s21
  s_cselect_b32 s30, 16, 12
  v_mul_u32_u24 v10, s21, v8
  v_lshrrev_b32 v10, 16, v10
  v_mul_u32_u24 v11, s30, v10
  v_sub_u32 v32, v8, v11
  v_add_u32 v32, s20, v32
  s_mul_i32 s30, s17, 28
  v_add_u32 v32, s30, v32
  v_lshrrev_b32 v33, 4, v32
  v_and_b32 v32, 15, v32
  s_mov_b32 s30, 401408
  v_mul_lo_u32 v10, v10, s30
  v_mul_u32_u24 v33, 14336, v33
  v_add_u32 v10, v10, v33
  v_lshl_add_u32 v10, v3, 8, v10
  v_lshl_add_u32 v10, v32, 4, v10
  v_add_u32 v15, 6422528, v10
  v_lshrrev_b32 v7, 2, v4
  v_lshlrev_b32 v7, 3, v7
  v_and_b32 v8, 3, v4
  v_add_u32 v7, v7, v8
  v_xor_b32 v10, v3, v4
  v_lshlrev_b32 v10, 4, v10
  v_lshl_add_u32 v10, v7, 9, v10
  v_add_u32 v10, s25, v10
  v_xor_b32 v32, 0, v10
  v_xor_b32 v33, 64, v10
  v_xor_b32 v34, 128, v10
  v_xor_b32 v35, 192, v10
  v_lshrrev_b32 v7, 2, v4
  v_lshl_add_u32 v7, v3, 3, v7
  v_lshlrev_b32 v7, 7, v7
  v_and_b32 v8, 3, v4
  v_lshl_add_u32 v7, v8, 3, v7
  v_lshrrev_b32 v8, 3, v4
  v_lshl_add_u32 v7, v8, 5, v7
  v_and_b32 v8, 1, v3
  v_lshl_add_u32 v7, v8, 6, v7
  s_waitcnt vmcnt(16)
  s_barrier
  s_cmp_eq_u32 s16, 3
  s_cbranch_scc1 bj_np0
  s_add_u32 m0, s48, 16384
  s_nop 0
  buffer_load_dwordx4 v16, s[60:63], s33 offen offset:0 lds
  buffer_load_dwordx4 v17, s[60:63], s33 offen offset:1024 lds
  buffer_load_dwordx4 v18, s[60:63], s33 offen offset:2048 lds
  buffer_load_dwordx4 v19, s[60:63], s33 offen offset:3072 lds
bj_np0:
  v_xor_b32 v9, 0, v7
  ds_read_b64_tr_b16 v[128:129], v9 offset:0
  ds_read_b64_tr_b16 v[130:131], v9 offset:512
  ds_read_b64_tr_b16 v[132:133], v9 offset:4096
  ds_read_b64_tr_b16 v[134:135], v9 offset:4608
  ds_read_b64_tr_b16 v[136:137], v9 offset:8192
  ds_read_b64_tr_b16 v[138:139], v9 offset:8704
  ds_read_b64_tr_b16 v[140:141], v9 offset:12288
  ds_read_b64_tr_b16 v[142:143], v9 offset:12800
  s_waitcnt lgkmcnt(6)
  ds_read_b64_tr_b16 v[144:145], v9 offset:16384
  ds_read_b64_tr_b16 v[146:147], v9 offset:16896
  ds_read_b64_tr_b16 v[148:149], v9 offset:20480
  ds_read_b64_tr_b16 v[150:151], v9 offset:20992
  ds_read_b64_tr_b16 v[152:153], v9 offset:24576
  ds_read_b64_tr_b16 v[154:155], v9 offset:25088
  ds_read_b64_tr_b16 v[156:157], v9 offset:28672
  ds_read_b64_tr_b16 v[158:159], v9 offset:29184
  s_waitcnt lgkmcnt(6)
  s_cmp_eq_u32 s16, 3
  s_cbranch_scc1 bj_np1
  s_add_u32 m0, s49, 16384
  s_nop 0
  buffer_load_dwordx4 v20, s[60:63], s33 offen offset:0 lds
  buffer_load_dwordx4 v21, s[60:63], s33 offen offset:1024 lds
  buffer_load_dwordx4 v22, s[60:63], s33 offen offset:2048 lds
  buffer_load_dwordx4 v23, s[60:63], s33 offen offset:3072 lds
bj_np1:
  v_xor_b32 v9, 32, v7
  ds_read_b64_tr_b16 v[160:161], v9 offset:0
  ds_read_b64_tr_b16 v[162:163], v9 offset:512
  ds_read_b64_tr_b16 v[164:165], v9 offset:4096
  ds_read_b64_tr_b16 v[166:167], v9 offset:4608
  ds_read_b64_tr_b16 v[168:169], v9 offset:8192
  ds_read_b64_tr_b16 v[170:171], v9 offset:8704
  ds_read_b64_tr_b16 v[172:173], v9 offset:12288
  ds_read_b64_tr_b16 v[174:175], v9 offset:12800
  s_waitcnt lgkmcnt(6)
  ds_read_b64_tr_b16 v[176:177], v9 offset:16384
  ds_read_b64_tr_b16 v[178:179], v9 offset:16896
  ds_read_b64_tr_b16 v[180:181], v9 offset:20480
  ds_read_b64_tr_b16 v[182:183], v9 offset:20992
  ds_read_b64_tr_b16 v[184:185], v9 offset:24576
  ds_read_b64_tr_b16 v[186:187], v9 offset:25088
  ds_read_b64_tr_b16 v[188:189], v9 offset:28672
  ds_read_b64_tr_b16 v[190:191], v9 offset:29184
  s_waitcnt lgkmcnt(6)
  s_cmp_eq_u32 s16, 3
  s_cbranch_scc1 bj_np2
  s_add_u32 m0, s50, 16384
  s_nop 0
  buffer_load_dwordx4 v24, s[60:63], s33 offen offset:0 lds
  buffer_load_dwordx4 v25, s[60:63], s33 offen offset:1024 lds
  buffer_load_dwordx4 v26, s[60:63], s33 offen offset:2048 lds
  buffer_load_dwordx4 v27, s[60:63], s33 offen offset:3072 lds
bj_np2:
  v_xor_b32 v9, 64, v7
  ds_read_b64_tr_b16 v[192:193], v9 offset:0
  ds_read_b64_tr_b16 v[194:195], v9 offset:512
  ds_read_b64_tr_b16 v[196:197], v9 offset:4096
  ds_read_b64_tr_b16 v[198:199], v9 offset:4608
  ds_read_b64_tr_b16 v[200:201], v9 offset:8192
  ds_read_b64_tr_b16 v[202:203], v9 offset:8704
  ds_read_b64_tr_b16 v[204:205], v9 offset:12288
  ds_read_b64_tr_b16 v[206:207], v9 offset:12800
  s_waitcnt lgkmcnt(6)
  ds_read_b64_tr_b16 v[208:209], v9 offset:16384
  ds_read_b64_tr_b16 v[210:211], v9 offset:16896
  ds_read_b64_tr_b16 v[212:213], v9 offset:20480
  ds_read_b64_tr_b16 v[214:215], v9 offset:20992
  ds_read_b64_tr_b16 v[216:217], v9 offset:24576
  ds_read_b64_tr_b16 v[218:219], v9 offset:25088
  ds_read_b64_tr_b16 v[220:221], v9 offset:28672
  ds_read_b64_tr_b16 v[222:223], v9 offset:29184
  s_waitcnt lgkmcnt(6)
  s_cmp_eq_u32 s16, 3
  s_cbranch_scc1 bj_np3
  s_add_u32 m0, s51, 16384
  s_nop 0
  buffer_load_dwordx4 v28, s[60:63], s33 offen offset:0 lds
  buffer_load_dwordx4 v29, s[60:63], s33 offen offset:1024 lds
  buffer_load_dwordx4 v30, s[60:63], s33 offen offset:2048 lds
  buffer_load_dwordx4 v31, s[60:63], s33 offen offset:3072 lds
bj_np3:
  v_xor_b32 v9, 96, v7
  ds_read_b64_tr_b16 v[224:225], v9 offset:0
  ds_read_b64_tr_b16 v[226:227], v9 offset:512
  ds_read_b64_tr_b16 v[228:229], v9 offset:4096
  ds_read_b64_tr_b16 v[230:231], v9 offset:4608
  ds_read_b64_tr_b16 v[232:233], v9 offset:8192
  ds_read_b64_tr_b16 v[234:235], v9 offset:8704
  ds_read_b64_tr_b16 v[236:237], v9 offset:12288
  ds_read_b64_tr_b16 v[238:239], v9 offset:12800
  s_waitcnt lgkmcnt(6)
  ds_read_b64_tr_b16 v[240:241], v9 offset:16384
  ds_read_b64_tr_b16 v[242:243], v9 offset:16896
  ds_read_b64_tr_b16 v[244:245], v9 offset:20480
  ds_read_b64_tr_b16 v[246:247], v9 offset:20992
  ds_read_b64_tr_b16 v[248:249], v9 offset:24576
  ds_read_b64_tr_b16 v[250:251], v9 offset:25088
  ds_read_b64_tr_b16 v[252:253], v9 offset:28672
  ds_read_b64_tr_b16 v[254:255], v9 offset:29184
  s_waitcnt lgkmcnt(6)
  s_mov_b32 s52, s36
  s_and_b32 s53, s37, 0xffff
  s_mov_b32 s54, 1835008
  s_mov_b32 s55, 0x20000
  s_lshl_b32 s20, s18, 8
  v_add_u32 v95, s20, v0
  s_mov_b32 s21, 9586981
  v_mul_hi_u32 v6, v95, s21
  v_mul_u32_u24 v7, 448, v6
  v_sub_u32 v7, v95, v7
  v_lshrrev_b32 v8, 4, v7
  v_and_b32 v7, 15, v7
  v_lshl_add_u32 v9, v6, 4, v7
  v_mul_u32_u24 v9, 896, v9
  v_lshl_add_u32 v9, v8, 5, v9
  buffer_load_dwordx4 v[84:87], v9, s[52:55], 0 offen
  buffer_load_dwordx4 v[88:91], v9, s[52:55], 0 offen offset:16
  v_mul_u32_u24 v6, 14336, v6
  v_lshl_add_u32 v6, v7, 4, v6
  v_lshl_add_u32 v92, v8, 9, v6
  v_lshrrev_b32 v7, 2, v8
  v_lshl_add_u32 v6, v7, 11, v6
  v_and_b32 v7, 3, v8
  v_lshl_add_u32 v93, v7, 8, v6
  s_mov_b32 s72, s38
  s_and_b32 s73, s39, 0xffff
  s_mov_b32 s74, 7168
  s_mov_b32 s75, 0x20000
  v_min_u32 v6, 223, v0
  v_lshrrev_b32 v7, 3, v6
  v_and_b32 v6, 7, v6
  v_mul_u32_u24 v9, 896, v6
  v_lshl_add_u32 v9, v7, 5, v9
  buffer_load_dwordx4 v[36:39], v9, s[72:75], 0 offen
  buffer_load_dwordx4 v[40:43], v9, s[72:75], 0 offen offset:16
  v_lshlrev_b32 v7, 8, v7
  v_lshl_add_u32 v94, v6, 4, v7
  s_lshl_b32 s26, s17, 9
  s_waitcnt vmcnt(20) lgkmcnt(0)
  s_cmp_lg_u32 s16, 3
  s_cbranch_scc1 w3_20
  s_waitcnt vmcnt(4)
w3_20:
  ds_read_b128 v[52:55], v32 offset:0
  ds_read_b128 v[56:59], v33 offset:0
  ds_read_b128 v[60:63], v34 offset:0
  ds_read_b128 v[64:67], v35 offset:0
  s_waitcnt lgkmcnt(3)
  v_mfma_f32_16x16x32_bf16 v[96:99], v[52:55], v[128:131], 0
  v_mfma_f32_16x16x32_bf16 v[100:103], v[52:55], v[160:163], 0
  v_mfma_f32_16x16x32_bf16 v[104:107], v[52:55], v[192:195], 0
  v_mfma_f32_16x16x32_bf16 v[108:111], v[52:55], v[224:227], 0
  ds_read_b128 v[52:55], v32 offset:256
  s_waitcnt lgkmcnt(3)
  v_mfma_f32_16x16x32_bf16 v[96:99], v[56:59], v[132:135], v[96:99]
  v_mfma_f32_16x16x32_bf16 v[100:103], v[56:59], v[164:167], v[100:103]
  v_mfma_f32_16x16x32_bf16 v[104:107], v[56:59], v[196:199], v[104:107]
  v_mfma_f32_16x16x32_bf16 v[108:111], v[56:59], v[228:231], v[108:111]
  ds_read_b128 v[56:59], v33 offset:256
  s_waitcnt lgkmcnt(3)
  v_mfma_f32_16x16x32_bf16 v[96:99], v[60:63], v[136:139], v[96:99]
  v_mfma_f32_16x16x32_bf16 v[100:103], v[60:63], v[168:171], v[100:103]
  v_mfma_f32_16x16x32_bf16 v[104:107], v[60:63], v[200:203], v[104:107]
  v_mfma_f32_16x16x32_bf16 v[108:111], v[60:63], v[232:235], v[108:111]
  ds_read_b128 v[60:63], v34 offset:256
  s_waitcnt lgkmcnt(3)
  v_mfma_f32_16x16x32_bf16 v[96:99], v[64:67], v[140:143], v[96:99]
  v_mfma_f32_16x16x32_bf16 v[100:103], v[64:67], v[172:175], v[100:103]
  v_mfma_f32_16x16x32_bf16 v[104:107], v[64:67], v[204:207], v[104:107]
  v_mfma_f32_16x16x32_bf16 v[108:111], v[64:67], v[236:239], v[108:111]
  ds_read_b128 v[64:67], v35 offset:256
  s_waitcnt lgkmcnt(3)
  v_mfma_f32_16x16x32_bf16 v[96:99], v[52:55], v[144:147], v[96:99]
  v_mfma_f32_16x16x32_bf16 v[100:103], v[52:55], v[176:179], v[100:103]
  v_mfma_f32_16x16x32_bf16 v[104:107], v[52:55], v[208:211], v[104:107]
  v_mfma_f32_16x16x32_bf16 v[108:111], v[52:55], v[240:243], v[108:111]
  ds_read_b128 v[52:55], v32 offset:2048
  s_waitcnt lgkmcnt(3)
  v_mfma_f32_16x16x32_bf16 v[96:99], v[56:59], v[148:151], v[96:99]
  v_mfma_f32_16x16x32_bf16 v[100:103], v[56:59], v[180:183], v[100:103]
  v_mfma_f32_16x16x32_bf16 v[104:107], v[56:59], v[212:215], v[104:107]
  v_mfma_f32_16x16x32_bf16 v[108:111], v[56:59], v[244:247], v[108:111]
  ds_read_b128 v[56:59], v33 offset:2048
  s_waitcnt lgkmcnt(3)
  v_mfma_f32_16x16x32_bf16 v[96:99], v[60:63], v[152:155], v[96:99]
  v_mfma_f32_16x16x32_bf16 v[100:103], v[60:63], v[184:187], v[100:103]
  v_mfma_f32_16x16x32_bf16 v[104:107], v[60:63], v[216:219], v[104:107]
  v_mfma_f32_16x16x32_bf16 v[108:111], v[60:63], v[248:251], v[108:111]
  ds_read_b128 v[60:63], v34 offset:2048
  s_waitcnt lgkmcnt(3)
  v_mfma_f32_16x16x32_bf16 v[96:99], v[64:67], v[156:159], v[96:99]
  v_mfma_f32_16x16x32_bf16 v[100:103], v[64:67], v[188:191], v[100:103]
  v_mfma_f32_16x16x32_bf16 v[104:107], v[64:67], v[220:223], v[104:107]
  v_mfma_f32_16x16x32_bf16 v[108:111], v[64:67], v[252:255], v[108:111]
  ds_read_b128 v[64:67], v35 offset:2048
  s_waitcnt lgkmcnt(3)
  v_mfma_f32_16x16x32_bf16 v[112:115], v[52:55], v[128:131], 0
  v_mfma_f32_16x16x32_bf16 v[116:119], v[52:55], v[160:163], 0
  v_mfma_f32_16x16x32_bf16 v[120:123], v[52:55], v[192:195], 0
  v_mfma_f32_16x16x32_bf16 v[124:127], v[52:55], v[224:227], 0
  ds_read_b128 v[52:55], v32 offset:2304
  s_waitcnt lgkmcnt(3)
  v_mfma_f32_16x16x32_bf16 v[112:115], v[56:59], v[132:135], v[112:115]
  v_mfma_f32_16x16x32_bf16 v[116:119], v[56:59], v[164:167], v[116:119]
  v_mfma_f32_16x16x32_bf16 v[120:123], v[56:59], v[196:199], v[120:123]
  v_mfma_f32_16x16x32_bf16 v[124:127], v[56:59], v[228:231], v[124:127]
  ds_read_b128 v[56:59], v33 offset:2304
  s_waitcnt lgkmcnt(3)
  v_mfma_f32_16x16x32_bf16 v[112:115], v[60:63], v[136:139], v[112:115]
  v_mfma_f32_16x16x32_bf16 v[116:119], v[60:63], v[168:171], v[116:119]
  v_mfma_f32_16x16x32_bf16 v[120:123], v[60:63], v[200:203], v[120:123]
  v_mfma_f32_16x16x32_bf16 v[124:127], v[60:63], v[232:235], v[124:127]
  ds_read_b128 v[60:63], v34 offset:2304
  s_waitcnt lgkmcnt(3)
  v_mfma_f32_16x16x32_bf16 v[112:115], v[64:67], v[140:143], v[112:115]
  v_mfma_f32_16x16x32_bf16 v[116:119], v[64:67], v[172:175], v[116:119]
  v_mfma_f32_16x16x32_bf16 v[120:123], v[64:67], v[204:207], v[120:123]
  v_mfma_f32_16x16x32_bf16 v[124:127], v[64:67], v[236:239], v[124:127]
  ds_read_b128 v[64:67], v35 offset:2304
  s_waitcnt lgkmcnt(3)
  v_mfma_f32_16x16x32_bf16 v[112:115], v[52:55], v[144:147], v[112:115]
  v_mfma_f32_16x16x32_bf16 v[116:119], v[52:55], v[176:179], v[116:119]
  v_mfma_f32_16x16x32_bf16 v[120:123], v[52:55], v[208:211], v[120:123]
  v_mfma_f32_16x16x32_bf16 v[124:127], v[52:55], v[240:243], v[124:127]
  s_waitcnt lgkmcnt(2)
  v_mfma_f32_16x16x32_bf16 v[112:115], v[56:59], v[148:151], v[112:115]
  v_mfma_f32_16x16x32_bf16 v[116:119], v[56:59], v[180:183], v[116:119]
  v_mfma_f32_16x16x32_bf16 v[120:123], v[56:59], v[212:215], v[120:123]
  v_mfma_f32_16x16x32_bf16 v[124:127], v[56:59], v[244:247], v[124:127]
  s_waitcnt lgkmcnt(1)
  v_mfma_f32_16x16x32_bf16 v[112:115], v[60:63], v[152:155], v[112:115]
  v_mfma_f32_16x16x32_bf16 v[116:119], v[60:63], v[184:187], v[116:119]
  v_mfma_f32_16x16x32_bf16 v[120:123], v[60:63], v[216:219], v[120:123]
  v_mfma_f32_16x16x32_bf16 v[124:127], v[60:63], v[248:251], v[124:127]
  s_waitcnt lgkmcnt(0)
  v_mfma_f32_16x16x32_bf16 v[112:115], v[64:67], v[156:159], v[112:115]
  v_mfma_f32_16x16x32_bf16 v[116:119], v[64:67], v[188:191], v[116:119]
  v_mfma_f32_16x16x32_bf16 v[120:123], v[64:67], v[220:223], v[120:123]
  v_mfma_f32_16x16x32_bf16 v[124:127], v[64:67], v[252:255], v[124:127]
  s_lshl_b32 s30, s28, 10
  v_cvt_pk_bf16_f32 v68, v96, v97
  v_cvt_pk_bf16_f32 v69, v98, v99
  v_cvt_pk_bf16_f32 v70, v112, v113
  v_cvt_pk_bf16_f32 v71, v114, v115
  buffer_store_dwordx4 v[68:71], v12, s[8:11], s30 offen sc1
  v_cvt_pk_bf16_f32 v72, v100, v101
  v_cvt_pk_bf16_f32 v73, v102, v103
  v_cvt_pk_bf16_f32 v74, v116, v117
  v_cvt_pk_bf16_f32 v75, v118, v119
  buffer_store_dwordx4 v[72:75], v13, s[8:11], s30 offen sc1
  v_cvt_pk_bf16_f32 v76, v104, v105
  v_cvt_pk_bf16_f32 v77, v106, v107
  v_cvt_pk_bf16_f32 v78, v120, v121
  v_cvt_pk_bf16_f32 v79, v122, v123
  buffer_store_dwordx4 v[76:79], v14, s[8:11], s30 offen sc1
  v_cvt_pk_bf16_f32 v80, v108, v109
  v_cvt_pk_bf16_f32 v81, v110, v111
  v_cvt_pk_bf16_f32 v82, v124, v125
  v_cvt_pk_bf16_f32 v83, v126, v127
  buffer_store_dwordx4 v[80:83], v15, s[8:11], s30 offen sc1
  s_cmp_eq_u32 s16, 3
  s_cbranch_scc1 bj_w3
  s_waitcnt vmcnt(8)
  ds_read_b128 v[52:55], v32 offset:16384
  ds_read_b128 v[56:59], v33 offset:16384
  ds_read_b128 v[60:63], v34 offset:16384
  ds_read_b128 v[64:67], v35 offset:16384
  s_waitcnt lgkmcnt(3)
  v_mfma_f32_16x16x32_bf16 v[96:99], v[52:55], v[128:131], 0
  v_mfma_f32_16x16x32_bf16 v[100:103], v[52:55], v[160:163], 0
  v_mfma_f32_16x16x32_bf16 v[104:107], v[52:55], v[192:195], 0
  v_mfma_f32_16x16x32_bf16 v[108:111], v[52:55], v[224:227], 0
  ds_read_b128 v[52:55], v32 offset:16640
  s_waitcnt lgkmcnt(3)
  v_mfma_f32_16x16x32_bf16 v[96:99], v[56:59], v[132:135], v[96:99]
  v_mfma_f32_16x16x32_bf16 v[100:103], v[56:59], v[164:167], v[100:103]
  v_mfma_f32_16x16x32_bf16 v[104:107], v[56:59], v[196:199], v[104:107]
  v_mfma_f32_16x16x32_bf16 v[108:111], v[56:59], v[228:231], v[108:111]
  ds_read_b128 v[56:59], v33 offset:16640
  s_waitcnt lgkmcnt(3)
  v_mfma_f32_16x16x32_bf16 v[96:99], v[60:63], v[136:139], v[96:99]
  v_mfma_f32_16x16x32_bf16 v[100:103], v[60:63], v[168:171], v[100:103]
  v_mfma_f32_16x16x32_bf16 v[104:107], v[60:63], v[200:203], v[104:107]
  v_mfma_f32_16x16x32_bf16 v[108:111], v[60:63], v[232:235], v[108:111]
  ds_read_b128 v[60:63], v34 offset:16640
  s_waitcnt lgkmcnt(3)
  v_mfma_f32_16x16x32_bf16 v[96:99], v[64:67], v[140:143], v[96:99]
  v_mfma_f32_16x16x32_bf16 v[100:103], v[64:67], v[172:175], v[100:103]
  v_mfma_f32_16x16x32_bf16 v[104:107], v[64:67], v[204:207], v[104:107]
  v_mfma_f32_16x16x32_bf16 v[108:111], v[64:67], v[236:239], v[108:111]
  ds_read_b128 v[64:67], v35 offset:16640
  s_waitcnt lgkmcnt(3)
  v_mfma_f32_16x16x32_bf16 v[96:99], v[52:55], v[144:147], v[96:99]
  v_mfma_f32_16x16x32_bf16 v[100:103], v[52:55], v[176:179], v[100:103]
  v_mfma_f32_16x16x32_bf16 v[104:107], v[52:55], v[208:211], v[104:107]
  v_mfma_f32_16x16x32_bf16 v[108:111], v[52:55], v[240:243], v[108:111]
  ds_read_b128 v[52:55], v32 offset:18432
  s_waitcnt lgkmcnt(3)
  v_mfma_f32_16x16x32_bf16 v[96:99], v[56:59], v[148:151], v[96:99]
  v_mfma_f32_16x16x32_bf16 v[100:103], v[56:59], v[180:183], v[100:103]
  v_mfma_f32_16x16x32_bf16 v[104:107], v[56:59], v[212:215], v[104:107]
  v_mfma_f32_16x16x32_bf16 v[108:111], v[56:59], v[244:247], v[108:111]
  ds_read_b128 v[56:59], v33 offset:18432
  s_waitcnt lgkmcnt(3)
  v_mfma_f32_16x16x32_bf16 v[96:99], v[60:63], v[152:155], v[96:99]
  v_mfma_f32_16x16x32_bf16 v[100:103], v[60:63], v[184:187], v[100:103]
  v_mfma_f32_16x16x32_bf16 v[104:107], v[60:63], v[216:219], v[104:107]
  v_mfma_f32_16x16x32_bf16 v[108:111], v[60:63], v[248:251], v[108:111]
  ds_read_b128 v[60:63], v34 offset:18432
  s_waitcnt lgkmcnt(3)
  v_mfma_f32_16x16x32_bf16 v[96:99], v[64:67], v[156:159], v[96:99]
  v_mfma_f32_16x16x32_bf16 v[100:103], v[64:67], v[188:191], v[100:103]
  v_mfma_f32_16x16x32_bf16 v[104:107], v[64:67], v[220:223], v[104:107]
  v_mfma_f32_16x16x32_bf16 v[108:111], v[64:67], v[252:255], v[108:111]
  ds_read_b128 v[64:67], v35 offset:18432
  s_waitcnt lgkmcnt(3)
  v_mfma_f32_16x16x32_bf16 v[112:115], v[52:55], v[128:131], 0
  v_mfma_f32_16x16x32_bf16 v[116:119], v[52:55], v[160:163], 0
  v_mfma_f32_16x16x32_bf16 v[120:123], v[52:55], v[192:195], 0
  v_mfma_f32_16x16x32_bf16 v[124:127], v[52:55], v[224:227], 0
  ds_read_b128 v[52:55], v32 offset:18688
  s_waitcnt lgkmcnt(3)
  v_mfma_f32_16x16x32_bf16 v[112:115], v[56:59], v[132:135], v[112:115]
  v_mfma_f32_16x16x32_bf16 v[116:119], v[56:59], v[164:167], v[116:119]
  v_mfma_f32_16x16x32_bf16 v[120:123], v[56:59], v[196:199], v[120:123]
  v_mfma_f32_16x16x32_bf16 v[124:127], v[56:59], v[228:231], v[124:127]
  ds_read_b128 v[56:59], v33 offset:18688
  s_waitcnt lgkmcnt(3)
  v_mfma_f32_16x16x32_bf16 v[112:115], v[60:63], v[136:139], v[112:115]
  v_mfma_f32_16x16x32_bf16 v[116:119], v[60:63], v[168:171], v[116:119]
  v_mfma_f32_16x16x32_bf16 v[120:123], v[60:63], v[200:203], v[120:123]
  v_mfma_f32_16x16x32_bf16 v[124:127], v[60:63], v[232:235], v[124:127]
  ds_read_b128 v[60:63], v34 offset:18688
  s_waitcnt lgkmcnt(3)
  v_mfma_f32_16x16x32_bf16 v[112:115], v[64:67], v[140:143], v[112:115]
  v_mfma_f32_16x16x32_bf16 v[116:119], v[64:67], v[172:175], v[116:119]
  v_mfma_f32_16x16x32_bf16 v[120:123], v[64:67], v[204:207], v[120:123]
  v_mfma_f32_16x16x32_bf16 v[124:127], v[64:67], v[236:239], v[124:127]
  ds_read_b128 v[64:67], v35 offset:18688
  s_waitcnt lgkmcnt(3)
  v_mfma_f32_16x16x32_bf16 v[112:115], v[52:55], v[144:147], v[112:115]
  v_mfma_f32_16x16x32_bf16 v[116:119], v[52:55], v[176:179], v[116:119]
  v_mfma_f32_16x16x32_bf16 v[120:123], v[52:55], v[208:211], v[120:123]
  v_mfma_f32_16x16x32_bf16 v[124:127], v[52:55], v[240:243], v[124:127]
  s_waitcnt lgkmcnt(2)
  v_mfma_f32_16x16x32_bf16 v[112:115], v[56:59], v[148:151], v[112:115]
  v_mfma_f32_16x16x32_bf16 v[116:119], v[56:59], v[180:183], v[116:119]
  v_mfma_f32_16x16x32_bf16 v[120:123], v[56:59], v[212:215], v[120:123]
  v_mfma_f32_16x16x32_bf16 v[124:127], v[56:59], v[244:247], v[124:127]
  s_waitcnt lgkmcnt(1)
  v_mfma_f32_16x16x32_bf16 v[112:115], v[60:63], v[152:155], v[112:115]
  v_mfma_f32_16x16x32_bf16 v[116:119], v[60:63], v[184:187], v[116:119]
  v_mfma_f32_16x16x32_bf16 v[120:123], v[60:63], v[216:219], v[120:123]
  v_mfma_f32_16x16x32_bf16 v[124:127], v[60:63], v[248:251], v[124:127]
  s_waitcnt lgkmcnt(0)
  v_mfma_f32_16x16x32_bf16 v[112:115], v[64:67], v[156:159], v[112:115]
  v_mfma_f32_16x16x32_bf16 v[116:119], v[64:67], v[188:191], v[116:119]
  v_mfma_f32_16x16x32_bf16 v[120:123], v[64:67], v[220:223], v[120:123]
  v_mfma_f32_16x16x32_bf16 v[124:127], v[64:67], v[252:255], v[124:127]
  s_lshl_b32 s30, s29, 10
  v_cvt_pk_bf16_f32 v68, v96, v97
  v_cvt_pk_bf16_f32 v69, v98, v99
  v_cvt_pk_bf16_f32 v70, v112, v113
  v_cvt_pk_bf16_f32 v71, v114, v115
  buffer_store_dwordx4 v[68:71], v12, s[8:11], s30 offen sc1
  v_cvt_pk_bf16_f32 v72, v100, v101
  v_cvt_pk_bf16_f32 v73, v102, v103
  v_cvt_pk_bf16_f32 v74, v116, v117
  v_cvt_pk_bf16_f32 v75, v118, v119
  buffer_store_dwordx4 v[72:75], v13, s[8:11], s30 offen sc1
  v_cvt_pk_bf16_f32 v76, v104, v105
  v_cvt_pk_bf16_f32 v77, v106, v107
  v_cvt_pk_bf16_f32 v78, v120, v121
  v_cvt_pk_bf16_f32 v79, v122, v123
  buffer_store_dwordx4 v[76:79], v14, s[8:11], s30 offen sc1
  v_cvt_pk_bf16_f32 v80, v108, v109
  v_cvt_pk_bf16_f32 v81, v110, v111
  v_cvt_pk_bf16_f32 v82, v124, v125
  v_cvt_pk_bf16_f32 v83, v126, v127
  buffer_store_dwordx4 v[80:83], v15, s[8:11], s30 offen sc1
bj_w3:
  s_lshl_b32 s77, s19, 8
  s_lshl_b32 s21, s17, 4
  s_add_u32 s77, s77, s21
  s_cmp_lg_u32 s31, 0
  s_cselect_b32 s21, 8, 0
  s_add_u32 s77, s77, s21
  s_add_u32 s77, s77, 88600576
  s_add_u32 s78, s77, 2048
  s_cmp_lg_u32 s66, 0
  s_cbranch_scc1 bj_cf
  s_cmp_lg_u32 s16, 0
  s_cbranch_scc1 w0_21
  s_waitcnt vmcnt(8)
  v_readfirstlane_b32 s70, v46
  s_cmp_lg_u32 s70, 0
  s_cbranch_scc1 bj_nz
  v_mov_b32 v45, 128
  v_mov_b32 v46, s88
  v_mov_b32 v47, s89
  v_mov_b32 v48, 0
  v_mov_b32 v49, 0
  s_mov_b64 exec, 1
  buffer_atomic_cmpswap_x2 v[46:49], v45, s[12:15], 0 offen sc0
  s_mov_b64 exec, -1
  s_waitcnt vmcnt(0)
  v_readfirstlane_b32 s70, v46
  s_cmp_lg_u32 s70, 0
  s_cbranch_scc1 bj_nz
  v_mov_b32 v46, s88
  v_mov_b32 v47, s89
bj_nz:
w0_21:
  v_mov_b32 v45, 160000
  s_add_u32 s101, s101, 1
  s_barrier
  s_mov_b64 exec, 1
  s_cmp_lg_u32 s16, 0
  s_cbranch_scc1 w0_22
  ds_write_b32 v45, v44 offset:0
  ds_write_b32 v45, v46 offset:4
  ds_write_b32 v45, v47 offset:8
  s_waitcnt lgkmcnt(0)
  v_mov_b32 v44, s101
  ds_write_b32 v45, v44 offset:16
  s_waitcnt lgkmcnt(0)
w0_22:
  s_mov_b64 exec, -1
  s_barrier
  ds_read_b32 v44, v45 offset:0
  ds_read_b32 v46, v45 offset:4
  ds_read_b32 v47, v45 offset:8
  ds_read_b32 v45, v45 offset:16
  s_waitcnt lgkmcnt(0)
  v_readfirstlane_b32 s70, v44
  v_readfirstlane_b32 s88, v46
  v_readfirstlane_b32 s89, v47
  v_cmp_ne_u32 vcc, s101, v45
  s_cbranch_vccnz ch_end
  s_mov_b32 s66, 1
  s_bitcmp1_b32 s70, s3
  s_cbranch_scc1 m_reclaim
bj_cf:
  s_barrier
  s_mov_b32 s56, s40
  s_and_b32 s57, s41, 0xffff
  s_mov_b32 s58, 3670016
  s_mov_b32 s59, 0x20000
  s_mov_b32 s60, s42
  s_and_b32 s61, s43, 0xffff
  s_mov_b32 s62, 3670016
  s_mov_b32 s63, 0x20000
  s_add_u32 s28, s31, s19
  v_lshrrev_b32 v5, 5, v1
  v_and_b32 v6, 31, v1
  v_xor_b32 v6, v6, v5
  v_lshlrev_b32 v6, 4, v6
  v_lshl_add_u32 v6, v5, 13, v6
  s_lshl_b32 s20, s16, 6
  v_xor_b32 v7, s20, v6
  s_lshl_b32 s22, s28, 18
  s_lshl_b32 s21, s16, 16
  s_add_u32 s22, s22, s21
  s_add_u32 s22, s22, s26
  s_lshl_b32 m0, s16, 12
  v_xor_b32 v8, 0, v7
  buffer_load_dwordx4 v8, s[56:59], s22 offen offset:0 lds
  v_xor_b32 v8, 32, v7
  v_add_u32 v8, 15360, v8
  buffer_load_dwordx4 v8, s[56:59], s22 offen offset:1024 lds
  v_xor_b32 v8, 0, v7
  v_add_u32 v8, 30720, v8
  buffer_load_dwordx4 v8, s[56:59], s22 offen offset:2048 lds
  v_xor_b32 v8, 32, v7
  v_add_u32 v8, 46080, v8
  buffer_load_dwordx4 v8, s[56:59], s22 offen offset:3072 lds
  v_xor_b32 v16, 0, v6
  v_xor_b32 v17, 32, v6
  v_add_u32 v17, 31744, v17
  v_xor_b32 v18, 64, v6
  v_add_u32 v18, 129024, v18
  v_xor_b32 v19, 96, v6
  v_add_u32 v19, 160768, v19
  v_xor_b32 v20, 128, v6
  v_add_u32 v20, 262144, v20
  v_xor_b32 v21, 160, v6
  v_add_u32 v21, 293888, v21
  v_xor_b32 v22, 192, v6
  v_add_u32 v22, 391168, v22
  v_xor_b32 v23, 224, v6
  v_add_u32 v23, 422912, v23
  s_lshr_b32 s20, s16, 1
  s_lshl_b32 s20, s20, 16
  s_and_b32 s21, s16, 1
  s_lshl_b32 s21, s21, 14
  s_add_u32 s20, s20, s21
  s_add_u32 s29, s20, s26
  s_mul_i32 s25, s16, 24576
  s_add_u32 s25, s25, 16384
  s_add_u32 s22, s29, 2097152
  s_add_u32 m0, s25, 0
  s_nop 0
  buffer_load_dwordx4 v16, s[60:63], s22 offen offset:0 lds
  buffer_load_dwordx4 v17, s[60:63], s22 offen offset:1024 lds
  buffer_load_dwordx4 v18, s[60:63], s22 offen offset:2048 lds
  buffer_load_dwordx4 v19, s[60:63], s22 offen offset:3072 lds
  s_add_u32 m0, s25, 4096
  s_nop 0
  buffer_load_dwordx4 v20, s[60:63], s22 offen offset:0 lds
  buffer_load_dwordx4 v21, s[60:63], s22 offen offset:1024 lds
  buffer_load_dwordx4 v22, s[60:63], s22 offen offset:2048 lds
  buffer_load_dwordx4 v23, s[60:63], s22 offen offset:3072 lds
  s_waitcnt vmcnt(12)
  s_barrier
  s_cmp_lg_u32 s16, 0
  s_cbranch_scc1 pub_23
  v_mul_u32_u24 v50, 2048, v1
  v_mov_b32 v48, s88
  v_mov_b32 v49, s89
  s_mov_b64 exec, 1
  buffer_store_dwordx2 v[48:49], v50, s[8:11], s77 offen sc1
  s_mov_b64 exec, -1
pub_23:
  s_cmp_ge_u32 s18, 70
  s_cbranch_scc1 bk_nm
  s_mov_b32 s20, 71565312
  buffer_store_dwordx4 v[84:87], v92, s[8:11], s20 offen sc1
  buffer_store_dwordx4 v[88:91], v92, s[8:11], s20 offen offset:256 sc1
  s_cmp_lg_u32 s18, 0
  s_cbranch_scc1 bk_nm
  v_min_u32 v104, -2, v36
  v_min_u32 v108, -2, v37
  v_min_u32 v105, -2, v38
  v_min_u32 v109, -2, v39
  v_min_u32 v106, -2, v40
  v_min_u32 v110, -2, v41
  v_min_u32 v107, -2, v42
  v_min_u32 v111, -2, v43
  s_mov_b32 s20, 88653824
  s_mov_b32 s21, 88080384
  buffer_store_dwordx4 v[104:107], v94, s[8:11], s20 offen sc1
  buffer_store_dwordx4 v[108:111], v94, s[8:11], s20 offen offset:128 sc1
  buffer_store_dwordx4 v[104:107], v94, s[8:11], s21 offen sc1
  buffer_store_dwordx4 v[108:111], v94, s[8:11], s21 offen offset:128 sc1
bk_nm:
  s_mov_b32 s23, 88653824
  v_add_u32 v6, 448, v95
  v_subrev_u32 v7, 1152, v6
  v_mov_b32 v52, -1
  v_mov_b32 v9, 0
  v_cmp_gt_u32 vcc, 128, v7
  s_nop 1
  v_cndmask_b32 v52, v52, v9, vcc
  v_mov_b32 v53, v52
  v_mov_b32 v54, v52
  v_mov_b32 v55, v52
  v_lshlrev_b32 v8, 4, v6
  v_mov_b32 v9, 0x10000000
  v_cmp_lt_u32 vcc, 25599, v6
  s_nop 1
  v_cndmask_b32 v8, v8, v9, vcc
  buffer_store_dwordx4 v[52:55], v8, s[8:11], s23 offen sc1
  s_mov_b32 s23, 87957504
  v_add_u32 v6, 448, v95
  v_cmp_gt_u32 vcc, 7680, v95
  s_nop 1
  v_cndmask_b32 v6, v6, v95, vcc
  v_subrev_u32 v7, 36352, v6
  v_mov_b32 v56, -1
  v_mov_b32 v9, 0
  v_cmp_gt_u32 vcc, 1048576, v7
  s_nop 1
  v_cndmask_b32 v56, v56, v9, vcc
  v_mov_b32 v57, v56
  v_mov_b32 v58, v56
  v_mov_b32 v59, v56
  v_lshlrev_b32 v8, 4, v6
  v_mov_b32 v9, 0x10000000
  v_cmp_lt_u32 vcc, 40191, v6
  s_nop 1
  v_cndmask_b32 v8, v8, v9, vcc
  buffer_store_dwordx4 v[56:59], v8, s[8:11], s23 offen sc1
  s_add_u32 s22, s29, 2621440
  s_add_u32 m0, s25, 8192
  s_nop 0
  buffer_load_dwordx4 v16, s[60:63], s22 offen offset:0 lds
  buffer_load_dwordx4 v17, s[60:63], s22 offen offset:1024 lds
  buffer_load_dwordx4 v18, s[60:63], s22 offen offset:2048 lds
  buffer_load_dwordx4 v19, s[60:63], s22 offen offset:3072 lds
  s_add_u32 m0, s25, 12288
  s_nop 0
  buffer_load_dwordx4 v20, s[60:63], s22 offen offset:0 lds
  buffer_load_dwordx4 v21, s[60:63], s22 offen offset:1024 lds
  buffer_load_dwordx4 v22, s[60:63], s22 offen offset:2048 lds
  buffer_load_dwordx4 v23, s[60:63], s22 offen offset:3072 lds
  s_add_u32 s22, s29, 3145728
  s_add_u32 m0, s25, 16384
  s_nop 0
  buffer_load_dwordx4 v16, s[60:63], s22 offen offset:0 lds
  buffer_load_dwordx4 v17, s[60:63], s22 offen offset:1024 lds
  buffer_load_dwordx4 v18, s[60:63], s22 offen offset:2048 lds
  buffer_load_dwordx4 v19, s[60:63], s22 offen offset:3072 lds
  s_add_u32 m0, s25, 20480
  s_nop 0
  buffer_load_dwordx4 v20, s[60:63], s22 offen offset:0 lds
  buffer_load_dwordx4 v21, s[60:63], s22 offen offset:1024 lds
  buffer_load_dwordx4 v22, s[60:63], s22 offen offset:2048 lds
  buffer_load_dwordx4 v23, s[60:63], s22 offen offset:3072 lds
  v_mov_b32 v250, s68
  s_or_b32 s20, s69, s16
  s_cbranch_scc1 bj_ht
  s_cmp_lg_u32 s16, 0
  s_cbranch_scc1 w0_24
  v_mov_b32 v250, 1
  v_mov_b32 v251, 192
  s_mov_b64 exec, 1
  buffer_atomic_add v250, v251, s[12:15], 0 offen sc0
  s_mov_b64 exec, -1
w0_24:
  s_branch bj_h2
bj_ht:
  buffer_load_dword v251, off, s[8:11], s77
bj_h2:
  v_lshrrev_b32 v7, 2, v4
  v_lshlrev_b32 v7, 3, v7
  v_and_b32 v8, 3, v4
  v_add_u32 v7, v7, v8
  v_xor_b32 v10, v3, v4
  v_lshlrev_b32 v10, 4, v10
  v_lshl_add_u32 v11, v4, 9, v10
  v_add_u32 v11, s25, v11
  v_lshl_add_u32 v10, v7, 9, v10
  v_xor_b32 v32, 0, v10
  v_xor_b32 v36, 0, v11
  v_xor_b32 v33, 64, v10
  v_xor_b32 v37, 64, v11
  v_xor_b32 v34, 128, v10
  v_xor_b32 v38, 128, v11
  v_xor_b32 v35, 192, v10
  v_xor_b32 v39, 192, v11
  s_mul_i32 s30, s17, 401408
  s_mul_i32 s20, s16, 14336
  s_add_u32 s30, s30, s20
  s_lshl_b32 s20, s28, 10
  s_add_u32 s30, s30, s20
  s_mov_b32 s24, 1035512379
  s_lshl_b32 s20, s17, 7
  s_lshl_b32 s28, s28, 3
  s_add_u32 s28, s28, s20
  s_add_u32 s28, s28, 88635392
  s_waitcnt vmcnt(1)
  s_barrier
  s_cmp_lg_u32 s16, 0
  s_cbranch_scc1 w0_25
  v_mul_u32_u24 v50, 2048, v1
  v_mov_b32 v48, s88
  v_mov_b32 v49, s89
  s_mov_b64 exec, 511
  buffer_store_dwordx2 v[48:49], v50, s[8:11], s78 offen sc1
  s_mov_b64 exec, -1
w0_25:
  ds_read_b128 v[128:131], v32 offset:0
  ds_read_b128 v[132:135], v32 offset:2048
  ds_read_b128 v[136:139], v36 offset:0
  ds_read_b128 v[140:143], v36 offset:8192
  ds_read_b128 v[144:147], v36 offset:16384
  ds_read_b128 v[148:151], v33 offset:0
  ds_read_b128 v[152:155], v33 offset:2048
  ds_read_b128 v[156:159], v37 offset:0
  ds_read_b128 v[160:163], v37 offset:8192
  ds_read_b128 v[164:167], v37 offset:16384
  ds_read_b128 v[168:171], v34 offset:0
  ds_read_b128 v[172:175], v34 offset:2048
  ds_read_b128 v[176:179], v38 offset:0
  ds_read_b128 v[180:183], v38 offset:8192
  ds_read_b128 v[184:187], v38 offset:16384
  s_waitcnt lgkmcnt(10)
  v_mfma_f32_16x16x32_bf16 v[96:99], v[128:131], v[136:139], 0
  v_mfma_f32_16x16x32_bf16 v[100:103], v[132:135], v[136:139], 0
  v_mfma_f32_16x16x32_bf16 v[104:107], v[128:131], v[140:143], 0
  v_mfma_f32_16x16x32_bf16 v[108:111], v[132:135], v[140:143], 0
  v_mfma_f32_16x16x32_bf16 v[112:115], v[128:131], v[144:147], 0
  v_mfma_f32_16x16x32_bf16 v[116:119], v[132:135], v[144:147], 0
  ds_read_b128 v[128:131], v35 offset:0
  ds_read_b128 v[132:135], v35 offset:2048
  ds_read_b128 v[136:139], v39 offset:0
  ds_read_b128 v[140:143], v39 offset:8192
  ds_read_b128 v[144:147], v39 offset:16384
  s_waitcnt lgkmcnt(10)
  v_mfma_f32_16x16x32_bf16 v[96:99], v[148:151], v[156:159], v[96:99]
  v_mfma_f32_16x16x32_bf16 v[100:103], v[152:155], v[156:159], v[100:103]
  v_mfma_f32_16x16x32_bf16 v[104:107], v[148:151], v[160:163], v[104:107]
  v_mfma_f32_16x16x32_bf16 v[108:111], v[152:155], v[160:163], v[108:111]
  v_mfma_f32_16x16x32_bf16 v[112:115], v[148:151], v[164:167], v[112:115]
  v_mfma_f32_16x16x32_bf16 v[116:119], v[152:155], v[164:167], v[116:119]
  ds_read_b128 v[148:151], v32 offset:256
  ds_read_b128 v[152:155], v32 offset:2304
  ds_read_b128 v[156:159], v36 offset:256
  ds_read_b128 v[160:163], v36 offset:8448
  ds_read_b128 v[164:167], v36 offset:16640
  s_waitcnt lgkmcnt(10)
  v_mfma_f32_16x16x32_bf16 v[96:99], v[168:171], v[176:179], v[96:99]
  v_mfma_f32_16x16x32_bf16 v[100:103], v[172:175], v[176:179], v[100:103]
  v_mfma_f32_16x16x32_bf16 v[104:107], v[168:171], v[180:183], v[104:107]
  v_mfma_f32_16x16x32_bf16 v[108:111], v[172:175], v[180:183], v[108:111]
  v_mfma_f32_16x16x32_bf16 v[112:115], v[168:171], v[184:187], v[112:115]
  v_mfma_f32_16x16x32_bf16 v[116:119], v[172:175], v[184:187], v[116:119]
  ds_read_b128 v[168:171], v33 offset:256
  ds_read_b128 v[172:175], v33 offset:2304
  ds_read_b128 v[176:179], v37 offset:256
  ds_read_b128 v[180:183], v37 offset:8448
  ds_read_b128 v[184:187], v37 offset:16640
  s_waitcnt lgkmcnt(10)
  v_mfma_f32_16x16x32_bf16 v[96:99], v[128:131], v[136:139], v[96:99]
  v_mfma_f32_16x16x32_bf16 v[100:103], v[132:135], v[136:139], v[100:103]
  v_mfma_f32_16x16x32_bf16 v[104:107], v[128:131], v[140:143], v[104:107]
  v_mfma_f32_16x16x32_bf16 v[108:111], v[132:135], v[140:143], v[108:111]
  v_mfma_f32_16x16x32_bf16 v[112:115], v[128:131], v[144:147], v[112:115]
  v_mfma_f32_16x16x32_bf16 v[116:119], v[132:135], v[144:147], v[116:119]
  ds_read_b128 v[128:131], v34 offset:256
  ds_read_b128 v[132:135], v34 offset:2304
  ds_read_b128 v[136:139], v38 offset:256
  ds_read_b128 v[140:143], v38 offset:8448
  ds_read_b128 v[144:147], v38 offset:16640
  s_waitcnt lgkmcnt(10)
  v_mfma_f32_16x16x32_bf16 v[96:99], v[148:151], v[156:159], v[96:99]
  v_mfma_f32_16x16x32_bf16 v[100:103], v[152:155], v[156:159], v[100:103]
  v_mfma_f32_16x16x32_bf16 v[104:107], v[148:151], v[160:163], v[104:107]
  v_mfma_f32_16x16x32_bf16 v[108:111], v[152:155], v[160:163], v[108:111]
  v_mfma_f32_16x16x32_bf16 v[112:115], v[148:151], v[164:167], v[112:115]
  v_mfma_f32_16x16x32_bf16 v[116:119], v[152:155], v[164:167], v[116:119]
  ds_read_b128 v[148:151], v35 offset:256
  ds_read_b128 v[152:155], v35 offset:2304
  ds_read_b128 v[156:159], v39 offset:256
  ds_read_b128 v[160:163], v39 offset:8448
  ds_read_b128 v[164:167], v39 offset:16640
  s_waitcnt lgkmcnt(10)
  v_mfma_f32_16x16x32_bf16 v[96:99], v[168:171], v[176:179], v[96:99]
  v_mfma_f32_16x16x32_bf16 v[100:103], v[172:175], v[176:179], v[100:103]
  v_mfma_f32_16x16x32_bf16 v[104:107], v[168:171], v[180:183], v[104:107]
  v_mfma_f32_16x16x32_bf16 v[108:111], v[172:175], v[180:183], v[108:111]
  v_mfma_f32_16x16x32_bf16 v[112:115], v[168:171], v[184:187], v[112:115]
  v_mfma_f32_16x16x32_bf16 v[116:119], v[172:175], v[184:187], v[116:119]
  s_waitcnt lgkmcnt(5)
  v_mfma_f32_16x16x32_bf16 v[96:99], v[128:131], v[136:139], v[96:99]
  v_mfma_f32_16x16x32_bf16 v[100:103], v[132:135], v[136:139], v[100:103]
  v_mfma_f32_16x16x32_bf16 v[104:107], v[128:131], v[140:143], v[104:107]
  v_mfma_f32_16x16x32_bf16 v[108:111], v[132:135], v[140:143], v[108:111]
  v_mfma_f32_16x16x32_bf16 v[112:115], v[128:131], v[144:147], v[112:115]
  v_mfma_f32_16x16x32_bf16 v[116:119], v[132:135], v[144:147], v[116:119]
  s_waitcnt lgkmcnt(0)
  v_mfma_f32_16x16x32_bf16 v[96:99], v[148:151], v[156:159], v[96:99]
  v_mfma_f32_16x16x32_bf16 v[100:103], v[152:155], v[156:159], v[100:103]
  v_mfma_f32_16x16x32_bf16 v[104:107], v[148:151], v[160:163], v[104:107]
  v_mfma_f32_16x16x32_bf16 v[108:111], v[152:155], v[160:163], v[108:111]
  v_mfma_f32_16x16x32_bf16 v[112:115], v[148:151], v[164:167], v[112:115]
  v_mfma_f32_16x16x32_bf16 v[116:119], v[152:155], v[164:167], v[116:119]
  v_mul_f32 v96, s24, v96
  v_mul_f32 v97, s24, v97
  v_mul_f32 v98, s24, v98
  v_mul_f32 v99, s24, v99
  v_mul_f32 v100, s24, v100
  v_mul_f32 v101, s24, v101
  v_mul_f32 v102, s24, v102
  v_mul_f32 v103, s24, v103
  v_cvt_pk_bf16_f32 v68, v96, v97
  v_cvt_pk_bf16_f32 v69, v98, v99
  v_cvt_pk_bf16_f32 v70, v100, v101
  v_cvt_pk_bf16_f32 v71, v102, v103
  s_add_u32 s20, s30, 229376
  buffer_store_dwordx4 v[68:71], v2, s[8:11], s20 offen sc1
  v_mul_f32 v104, s24, v104
  v_mul_f32 v105, s24, v105
  v_mul_f32 v106, s24, v106
  v_mul_f32 v107, s24, v107
  v_mul_f32 v108, s24, v108
  v_mul_f32 v109, s24, v109
  v_mul_f32 v110, s24, v110
  v_mul_f32 v111, s24, v111
  v_cvt_pk_bf16_f32 v72, v104, v105
  v_cvt_pk_bf16_f32 v73, v106, v107
  v_cvt_pk_bf16_f32 v74, v108, v109
  v_cvt_pk_bf16_f32 v75, v110, v111
  s_add_u32 s20, s30, 286720
  buffer_store_dwordx4 v[72:75], v2, s[8:11], s20 offen sc1
  v_mul_f32 v112, s24, v112
  v_mul_f32 v113, s24, v113
  v_mul_f32 v114, s24, v114
  v_mul_f32 v115, s24, v115
  v_mul_f32 v116, s24, v116
  v_mul_f32 v117, s24, v117
  v_mul_f32 v118, s24, v118
  v_mul_f32 v119, s24, v119
  v_cvt_pk_bf16_f32 v76, v112, v113
  v_cvt_pk_bf16_f32 v77, v114, v115
  v_cvt_pk_bf16_f32 v78, v116, v117
  v_cvt_pk_bf16_f32 v79, v118, v119
  s_add_u32 s20, s30, 344064
  buffer_store_dwordx4 v[76:79], v2, s[8:11], s20 offen sc1
  s_waitcnt vmcnt(0)
  s_barrier
  s_cmp_lg_u32 s16, 0
  s_cbranch_scc1 pub_26
  v_mul_u32_u24 v26, 2048, v1
  v_mov_b32 v24, s88
  v_mov_b32 v25, s89
  s_mov_b64 exec, 1
  buffer_store_dwordx2 v[24:25], v26, s[8:11], s28 offen sc1
  s_mov_b64 exec, -1
pub_26:
  v_mov_b32 v6, 160000
  s_add_u32 s101, s101, 1
  s_barrier
  s_mov_b64 exec, 1
  s_cmp_lg_u32 s16, 0
  s_cbranch_scc1 w0_27
  ds_write_b32 v6, v250 offset:0
  s_waitcnt lgkmcnt(0)
  v_mov_b32 v250, s101
  ds_write_b32 v6, v250 offset:16
  s_waitcnt lgkmcnt(0)
w0_27:
  s_mov_b64 exec, -1
  s_barrier
  ds_read_b32 v250, v6 offset:0
  ds_read_b32 v6, v6 offset:16
  s_waitcnt lgkmcnt(0)
  v_readfirstlane_b32 s3, v250
  v_cmp_ne_u32 vcc, s101, v6
  s_cbranch_vccnz ch_end
  s_branch wk_have
wk_loop:
  s_waitcnt vmcnt(0) lgkmcnt(0)
  s_cmp_eq_u32 s96, 1
  s_cbranch_scc1 wk_ask
  s_mov_b32 s96, 1
  s_cmp_lg_u32 s16, 0
  s_cbranch_scc1 w0_28
  s_mov_b32 s30, 0
  v_mov_b32 v243, 32
sf_l:
  buffer_load_dword v242, v243, s[12:15], 0 offen sc1
  s_waitcnt vmcnt(0)
  v_readfirstlane_b32 s70, v242
  s_cmp_eq_u32 s70, -1
  s_cbranch_scc1 sf_d
  s_sleep 16
  s_add_u32 s30, s30, 1
  s_cmp_lt_u32 s30, 64
  s_cbranch_scc1 sf_l
  s_mov_b32 s20, 0
  s_mov_b32 s21, 0
  s_mov_b64 exec, 1
sf_c_l:
  s_cmp_lg_u32 s70, -1
  s_cbranch_scc1 sf_c_t
  s_add_u32 s20, s20, 1
  s_cmp_lt_u32 s20, 8
  s_cselect_b32 s20, s20, 0
  s_mov_b32 s70, 0
  s_mov_b32 s3, -1
  s_add_u32 s21, s21, 1
  s_cmp_ge_u32 s21, 1
  s_cbranch_scc1 sf_c_d
sf_c_t:
  s_ff0_i32_b32 s22, s70
  s_lshl_b32 s23, 1, s22
  s_and_b32 s71, s20, 4
  s_mul_i32 s71, s71, 12
  s_lshl_b32 s3, s20, 2
  s_add_u32 s3, s3, s71
  v_mov_b32 v242, s23
  v_mov_b32 v243, 32
  buffer_atomic_or v242, v243, s[12:15], s3 offen sc0
  s_waitcnt vmcnt(0)
  v_readfirstlane_b32 s70, v242
  s_lshl_b32 s3, s20, 5
  s_add_u32 s3, s3, s22
  s_bitcmp1_b32 s70, s22
  s_cbranch_scc1 sf_c_l
sf_c_d:
  s_mov_b64 exec, -1
  v_mov_b32 v242, s3
sf_d:
w0_28:
  v_mov_b32 v243, 160000
  s_add_u32 s101, s101, 1
  s_barrier
  s_mov_b64 exec, 1
  s_cmp_lg_u32 s16, 0
  s_cbranch_scc1 w0_29
  ds_write_b32 v243, v242 offset:0
  s_waitcnt lgkmcnt(0)
  v_mov_b32 v242, s101
  ds_write_b32 v243, v242 offset:16
  s_waitcnt lgkmcnt(0)
w0_29:
  s_mov_b64 exec, -1
  s_barrier
  ds_read_b32 v242, v243 offset:0
  ds_read_b32 v243, v243 offset:16
  s_waitcnt lgkmcnt(0)
  v_readfirstlane_b32 s3, v242
  v_cmp_ne_u32 vcc, s101, v243
  s_cbranch_vccnz ch_end
  s_cmp_eq_u32 s3, -1
  s_cbranch_scc1 wk_ask
  s_load_dwordx8 s[36:43], s[0:1], 56
  s_load_dwordx4 s[44:47], s[0:1], 88
  s_getreg_b32 s67, hwreg(HW_REG_XCC_ID)
  s_and_b32 s67, s67, 7
  s_mov_b32 s66, 1
  s_waitcnt lgkmcnt(0)
  s_branch m_start
wk_ask:
  v_readfirstlane_b32 s22, v250
  s_cmp_ge_u32 s22, 1440
  s_cbranch_scc1 wk_next
  s_cmp_lg_u32 s16, 0
  s_cbranch_scc1 w0_30
  v_mov_b32 v250, 1
  v_mov_b32 v251, 192
  s_mov_b64 exec, 1
  buffer_atomic_add v250, v251, s[12:15], 0 offen sc0
  s_mov_b64 exec, -1
w0_30:
wk_next:
  s_waitcnt vmcnt(0)
  v_mov_b32 v6, 160000
  s_add_u32 s101, s101, 1
  s_barrier
  s_mov_b64 exec, 1
  s_cmp_lg_u32 s16, 0
  s_cbranch_scc1 w0_31
  ds_write_b32 v6, v250 offset:0
  s_waitcnt lgkmcnt(0)
  v_mov_b32 v250, s101
  ds_write_b32 v6, v250 offset:16
  s_waitcnt lgkmcnt(0)
w0_31:
  s_mov_b64 exec, -1
  s_barrier
  ds_read_b32 v250, v6 offset:0
  ds_read_b32 v6, v6 offset:16
  s_waitcnt lgkmcnt(0)
  v_readfirstlane_b32 s3, v250
  v_cmp_ne_u32 vcc, s101, v6
  s_cbranch_vccnz ch_end
wk_have:
  s_cmp_ge_u32 s3, 1440
  s_cbranch_scc1 ch_end
  v_mov_b32 v250, 0
  v_mov_b32 v251, 192
  v_and_b32 v1, 63, v0
  v_lshlrev_b32 v2, 4, v1
  v_lshrrev_b32 v3, 4, v1
  v_and_b32 v4, 15, v1
  s_cmp_lg_u32 s97, 0
  s_cbranch_scc1 wk_go
  s_mov_b32 s68, s3
  s_mov_b32 s69, 1
  s_cmp_lg_u32 s16, 0
  s_cbranch_scc1 w0_32
  s_add_u32 s20, s67, 1
  s_lshl_b32 s22, s20, 11
  s_add_u32 s22, s22, 88602624
  v_add_u32 v24, 1024, v2
  v_min_u32 v24, 1776, v24
  s_mov_b32 s30, 0
wk_af:
  buffer_load_dwordx4 v[28:31], v2, s[8:11], s22 offen sc1
  buffer_load_dwordx4 v[32:35], v24, s[8:11], s22 offen sc1
  s_waitcnt vmcnt(0)
  v_cmp_ne_u64 vcc, s[88:89], v[28:29]
  s_cbranch_vccnz wk_af_no
  v_cmp_ne_u64 vcc, s[88:89], v[30:31]
  s_cbranch_vccnz wk_af_no
  v_cmp_ne_u64 vcc, s[88:89], v[32:33]
  s_cbranch_vccnz wk_af_no
  v_cmp_ne_u64 vcc, s[88:89], v[34:35]
  s_cbranch_vccnz wk_af_no
  s_branch wk_af_ok
wk_af_no:
  s_sleep 4
  s_add_u32 s30, s30, 1
  s_and_b32 s20, s30, 63
  s_cbranch_scc1 wk_ns
  s_mov_b32 s20, 1
  s_mov_b32 s70, 0
  s_mov_b32 s21, 0
  s_mov_b64 exec, 1
wk_st_l:
  s_cmp_lg_u32 s70, -1
  s_cbranch_scc1 wk_st_t
  s_add_u32 s20, s20, 1
  s_cmp_lt_u32 s20, 8
  s_cselect_b32 s20, s20, 1
  s_mov_b32 s70, 0
  s_mov_b32 s3, -1
  s_add_u32 s21, s21, 1
  s_cmp_ge_u32 s21, 7
  s_cbranch_scc1 wk_st_d
wk_st_t:
  s_ff0_i32_b32 s22, s70
  s_lshl_b32 s23, 1, s22
  s_and_b32 s71, s20, 4
  s_mul_i32 s71, s71, 12
  s_lshl_b32 s3, s20, 2
  s_add_u32 s3, s3, s71
  v_mov_b32 v242, s23
  v_mov_b32 v243, 32
  buffer_atomic_or v242, v243, s[12:15], s3 offen sc0
  s_waitcnt vmcnt(0)
  v_readfirstlane_b32 s70, v242
  s_lshl_b32 s3, s20, 5
  s_add_u32 s3, s3, s22
  s_bitcmp1_b32 s70, s22
  s_cbranch_scc1 wk_st_l
wk_st_d:
  s_mov_b64 exec, -1
  v_mov_b32 v242, s3
  s_cmp_lg_u32 s3, -1
  s_cbranch_scc1 wk_pd
  s_add_u32 s20, s67, 1
  s_lshl_b32 s22, s20, 11
  s_add_u32 s22, s22, 88602624
wk_ns:
  s_cmp_lt_u32 s30, 50000
  s_cbranch_scc1 wk_af
  s_branch cA_abort
wk_af_ok:
  v_mov_b32 v242, -1
wk_pd:
w0_32:
  v_mov_b32 v243, 160000
  s_add_u32 s101, s101, 1
  s_barrier
  s_mov_b64 exec, 1
  s_cmp_lg_u32 s16, 0
  s_cbranch_scc1 w0_33
  ds_write_b32 v243, v242 offset:0
  s_waitcnt lgkmcnt(0)
  v_mov_b32 v242, s101
  ds_write_b32 v243, v242 offset:16
  s_waitcnt lgkmcnt(0)
w0_33:
  s_mov_b64 exec, -1
  s_barrier
  ds_read_b32 v242, v243 offset:0
  ds_read_b32 v243, v243 offset:16
  s_waitcnt lgkmcnt(0)
  v_readfirstlane_b32 s3, v242
  v_cmp_ne_u32 vcc, s101, v243
  s_cbranch_vccnz ch_end
  s_cmp_lg_u32 s3, -1
  s_cbranch_scc1 m_bjob
  s_mov_b32 s3, s68
  s_mov_b32 s97, 1
wk_go:
  s_cmp_lt_u32 s3, 368
  s_cbranch_scc1 wk_g2
  s_sub_u32 s20, s3, 432
  s_cmp_lt_u32 s20, 128
  s_cbranch_scc1 wk_g2
  s_cmp_eq_u32 s97, 2
  s_cbranch_scc1 wk_g2
  s_getreg_b32 s20, hwreg(HW_REG_XCC_ID)
  s_and_b32 s20, s20, 7
  s_cmp_lg_u32 s16, 0
  s_cbranch_scc1 w0_34
  s_lshl_b32 s22, s20, 11
  s_add_u32 s22, s22, 88637440
  v_add_u32 v24, 1024, v2
  v_min_u32 v24, 1776, v24
  s_mov_b32 s30, 0
wk_i2:
  buffer_load_dwordx4 v[28:31], v2, s[8:11], s22 offen sc1
  buffer_load_dwordx4 v[32:35], v24, s[8:11], s22 offen sc1
  s_waitcnt vmcnt(0)
  v_cmp_ne_u64 vcc, s[88:89], v[28:29]
  s_cbranch_vccnz wk_i2_no
  v_cmp_ne_u64 vcc, s[88:89], v[30:31]
  s_cbranch_vccnz wk_i2_no
  v_cmp_ne_u64 vcc, s[88:89], v[32:33]
  s_cbranch_vccnz wk_i2_no
  v_cmp_ne_u64 vcc, s[88:89], v[34:35]
  s_cbranch_vccnz wk_i2_no
  s_branch wk_i2_ok
wk_i2_no:
  s_sleep 4
  s_add_u32 s30, s30, 1
  s_cmp_lt_u32 s30, 50000
  s_cbranch_scc1 wk_i2
  s_branch cA_abort
wk_i2_ok:
w0_34:
  v_mov_b32 v242, 0
  v_mov_b32 v243, 160000
  s_add_u32 s101, s101, 1
  s_barrier
  s_mov_b64 exec, 1
  s_cmp_lg_u32 s16, 0
  s_cbranch_scc1 w0_35
  ds_write_b32 v243, v242 offset:0
  s_waitcnt lgkmcnt(0)
  v_mov_b32 v242, s101
  ds_write_b32 v243, v242 offset:16
  s_waitcnt lgkmcnt(0)
w0_35:
  s_mov_b64 exec, -1
  s_barrier
  ds_read_b32 v242, v243 offset:0
  ds_read_b32 v243, v243 offset:16
  s_waitcnt lgkmcnt(0)
  v_readfirstlane_b32 s20, v242
  v_cmp_ne_u32 vcc, s101, v243
  s_cbranch_vccnz ch_end
  s_mov_b32 s97, 2
wk_g2:
  s_cmp_ge_u32 s3, 864
  s_cbranch_scc1 wk_tok
  s_cmp_ge_u32 s3, 752
  s_cbranch_scc1 wk_s4d
  s_cmp_ge_u32 s3, 624
  s_cbranch_scc1 wk_f
  s_cmp_ge_u32 s3, 560
  s_cbranch_scc1 wk_vf
  s_cmp_ge_u32 s3, 432
  s_cbranch_scc1 wk_a
  s_cmp_ge_u32 s3, 368
  s_cbranch_scc1 wk_vh
  s_cmp_ge_u32 s3, 256
  s_cbranch_scc1 wk_v7
  s_cmp_ge_u32 s3, 224
  s_cbranch_scc1 wk_srv
  s_sub_u32 s20, s3, 0
  s_cmp_ge_u32 s20, 112
  s_cselect_b32 s18, 1, 0
  s_cselect_b32 s21, 112, 0
  s_sub_u32 s20, s20, s21
  s_and_b32 s17, s20, 15
  s_add_u32 s17, s17, 16
  s_lshr_b32 s34, s20, 4
  s_lshl_b32 s34, s34, 1
  s_add_u32 s35, s34, 2
  s_cmp_eq_u32 s18, 0
  s_cbranch_scc1 wf_nw
  s_and_b32 s20, s3, 3
  s_lshl_b32 s20, s20, 3
  s_add_u32 s20, s20, 8
  s_cmp_eq_u32 s16, 0
  s_cselect_b32 s20, 0, s20
  s_cmp_ge_u32 s16, 2
  s_cselect_b32 s20, 112, s20
  s_load_dwordx2 s[72:73], s[0:1], s20
  s_lshr_b32 s21, s3, 2
  s_lshl_b32 s21, s21, 12
  s_mov_b32 s74, 229376
  s_lshl_b32 s22, s3, 13
  s_cmp_eq_u32 s16, 0
  s_cselect_b32 s21, s22, s21
  s_cselect_b32 s74, 1835008, s74
  s_lshl_b32 s22, s3, 1
  s_add_u32 s22, s22, s16
  s_sub_u32 s22, s22, 2
  s_lshl_b32 s22, s22, 13
  s_cmp_ge_u32 s16, 2
  s_cselect_b32 s21, s22, s21
  s_cselect_b32 s74, 3670016, s74
  v_lshlrev_b32 v6, 3, v2
  s_cmp_lt_u32 s16, 2
  s_cbranch_scc1 lw_36
  s_lshl_b32 s21, s3, 6
  v_add_u32 v6, s21, v1
  v_mul_u32_u24 v7, 37450, v6
  v_lshrrev_b32 v7, 18, v7
  v_add_u32 v7, 1, v7
  v_mul_u32_u24 v7, 7, v7
  v_add_u32 v6, v6, v7
  v_lshlrev_b32 v6, 7, v6
  s_mov_b32 s21, 0
  s_cmp_eq_u32 s16, 3
  s_cselect_b32 s74, 0, s74
lw_36:
  s_cmp_eq_u32 s16, 1
  s_cselect_b32 exec_hi, 0, -1
  s_waitcnt lgkmcnt(0)
  s_and_b32 s73, s73, 0xffff
  s_mov_b32 s75, 0x20000
  buffer_load_dword v7, v6, s[72:75], s21 offen
  s_mov_b64 exec, -1
  s_sub_u32 s3, s3, 112
  s_and_b32 s20, s3, 3
  s_lshl_b32 s20, s20, 3
  s_add_u32 s20, s20, 8
  s_cmp_eq_u32 s16, 0
  s_cselect_b32 s20, 0, s20
  s_cmp_ge_u32 s16, 2
  s_cselect_b32 s20, 112, s20
  s_load_dwordx2 s[72:73], s[0:1], s20
  s_lshr_b32 s21, s3, 2
  s_lshl_b32 s21, s21, 12
  s_mov_b32 s74, 229376
  s_lshl_b32 s22, s3, 13
  s_cmp_eq_u32 s16, 0
  s_cselect_b32 s21, s22, s21
  s_cselect_b32 s74, 1835008, s74
  s_lshl_b32 s22, s3, 1
  s_add_u32 s22, s22, s16
  s_sub_u32 s22, s22, 2
  s_lshl_b32 s22, s22, 13
  s_cmp_ge_u32 s16, 2
  s_cselect_b32 s21, s22, s21
  s_cselect_b32 s74, 3670016, s74
  v_lshlrev_b32 v6, 3, v2
  s_cmp_lt_u32 s16, 2
  s_cbranch_scc1 lw_37
  s_lshl_b32 s21, s3, 6
  v_add_u32 v6, s21, v1
  v_mul_u32_u24 v7, 37450, v6
  v_lshrrev_b32 v7, 18, v7
  v_add_u32 v7, 1, v7
  v_mul_u32_u24 v7, 7, v7
  v_add_u32 v6, v6, v7
  v_lshlrev_b32 v6, 7, v6
  s_mov_b32 s21, 0
  s_cmp_eq_u32 s16, 3
  s_cselect_b32 s74, 0, s74
lw_37:
  s_cmp_eq_u32 s16, 1
  s_cselect_b32 exec_hi, 0, -1
  s_waitcnt lgkmcnt(0)
  s_and_b32 s73, s73, 0xffff
  s_mov_b32 s75, 0x20000
  buffer_load_dword v7, v6, s[72:75], s21 offen
  s_mov_b64 exec, -1
  s_add_u32 s3, s3, 112
wf_nw:
  s_lshl_b32 s20, s18, 3
  s_lshl_b32 s21, s16, 1
  s_add_u32 s20, s20, s21
  s_mul_i32 s21, s20, 14336
  s_add_u32 s21, s21, 71565312
  s_add_u32 s22, s21, 0
  buffer_load_dwordx4 a[0:3], v2, s[8:11], s22 offen offset:0 sc1
  buffer_load_dwordx4 a[4:7], v2, s[8:11], s22 offen offset:1024 sc1
  buffer_load_dwordx4 a[8:11], v2, s[8:11], s22 offen offset:2048 sc1
  buffer_load_dwordx4 a[12:15], v2, s[8:11], s22 offen offset:3072 sc1
  s_add_u32 s22, s21, 4096
  buffer_load_dwordx4 a[16:19], v2, s[8:11], s22 offen offset:0 sc1
  buffer_load_dwordx4 a[20:23], v2, s[8:11], s22 offen offset:1024 sc1
  buffer_load_dwordx4 a[24:27], v2, s[8:11], s22 offen offset:2048 sc1
  buffer_load_dwordx4 a[28:31], v2, s[8:11], s22 offen offset:3072 sc1
  s_add_u32 s22, s21, 8192
  buffer_load_dwordx4 a[32:35], v2, s[8:11], s22 offen offset:0 sc1
  buffer_load_dwordx4 a[36:39], v2, s[8:11], s22 offen offset:1024 sc1
  buffer_load_dwordx4 a[40:43], v2, s[8:11], s22 offen offset:2048 sc1
  buffer_load_dwordx4 a[44:47], v2, s[8:11], s22 offen offset:3072 sc1
  s_add_u32 s22, s21, 12288
  buffer_load_dwordx4 a[48:51], v2, s[8:11], s22 offen offset:0 sc1
  buffer_load_dwordx4 a[52:55], v2, s[8:11], s22 offen offset:1024 sc1
  buffer_load_dwordx4 a[56:59], v2, s[8:11], s22 offen offset:2048 sc1
  buffer_load_dwordx4 a[60:63], v2, s[8:11], s22 offen offset:3072 sc1
  s_add_u32 s22, s21, 16384
  buffer_load_dwordx4 a[64:67], v2, s[8:11], s22 offen offset:0 sc1
  buffer_load_dwordx4 a[68:71], v2, s[8:11], s22 offen offset:1024 sc1
  buffer_load_dwordx4 a[72:75], v2, s[8:11], s22 offen offset:2048 sc1
  buffer_load_dwordx4 a[76:79], v2, s[8:11], s22 offen offset:3072 sc1
  s_add_u32 s22, s21, 20480
  buffer_load_dwordx4 a[80:83], v2, s[8:11], s22 offen offset:0 sc1
  buffer_load_dwordx4 a[84:87], v2, s[8:11], s22 offen offset:1024 sc1
  buffer_load_dwordx4 a[88:91], v2, s[8:11], s22 offen offset:2048 sc1
  buffer_load_dwordx4 a[92:95], v2, s[8:11], s22 offen offset:3072 sc1
  s_add_u32 s22, s21, 24576
  buffer_load_dwordx4 a[96:99], v2, s[8:11], s22 offen offset:0 sc1
  buffer_load_dwordx4 a[100:103], v2, s[8:11], s22 offen offset:1024 sc1
  buffer_load_dwordx4 a[104:107], v2, s[8:11], s22 offen offset:2048 sc1
  buffer_load_dwordx4 a[108:111], v2, s[8:11], s22 offen offset:3072 sc1
  s_waitcnt vmcnt(40)
  s_mul_i32 s23, s17, 401408
  s_and_b32 s22, s16, 1
  s_mul_i32 s22, s22, 7168
  s_add_u32 s23, s23, s22
  s_add_u32 s23, s23, 0
  s_lshr_b32 s22, s16, 1
  s_mul_i32 s22, s22, 14336
  s_add_u32 s23, s23, s22
  s_mul_i32 s27, s16, 7168
  s_lshr_b32 s28, s20, 1
wf_vo:
  s_sub_u32 s29, s17, 16
  s_lshl_b32 s29, s29, 6
  s_add_u32 s29, s29, s28
  s_mul_i32 s29, s29, 28672
  s_add_u32 s29, s29, 42205184
  v_lshlrev_b32 v6, 4, v3
  v_mad_u32_u24 v7, v3, 12, 48
  s_mov_b32 s31, 0
  s_lshl_b32 s24, s34, 1
  s_mul_i32 s24, s24, 14336
  s_add_u32 s24, s24, s23
  s_cmp_lt_u32 s34, s35
  s_cselect_b32 s24, s24, 0x10000000
  s_add_u32 m0, s31, s27
  s_nop 0
  buffer_load_dwordx4 v2, s[8:11], s24 offen offset:0 sc1 lds
  buffer_load_dwordx4 v2, s[8:11], s24 offen offset:1024 sc1 lds
  buffer_load_dwordx4 v2, s[8:11], s24 offen offset:2048 sc1 lds
  buffer_load_dwordx4 v2, s[8:11], s24 offen offset:3072 sc1 lds
  s_add_u32 m0, m0, 4096
  s_add_u32 s24, s24, 4096
  buffer_load_dwordx4 v2, s[8:11], s24 offen offset:0 sc1 lds
  buffer_load_dwordx4 v2, s[8:11], s24 offen offset:1024 sc1 lds
  buffer_load_dwordx4 v2, s[8:11], s24 offen offset:2048 sc1 lds
  s_add_u32 s30, s34, 1
  s_mov_b32 s31, 28672
  s_lshl_b32 s24, s30, 1
  s_mul_i32 s24, s24, 14336
  s_add_u32 s24, s24, s23
  s_cmp_lt_u32 s30, s35
  s_cselect_b32 s24, s24, 0x10000000
  s_add_u32 m0, s31, s27
  s_nop 0
  buffer_load_dwordx4 v2, s[8:11], s24 offen offset:0 sc1 lds
  buffer_load_dwordx4 v2, s[8:11], s24 offen offset:1024 sc1 lds
  buffer_load_dwordx4 v2, s[8:11], s24 offen offset:2048 sc1 lds
  buffer_load_dwordx4 v2, s[8:11], s24 offen offset:3072 sc1 lds
  s_add_u32 m0, m0, 4096
  s_add_u32 s24, s24, 4096
  buffer_load_dwordx4 v2, s[8:11], s24 offen offset:0 sc1 lds
  buffer_load_dwordx4 v2, s[8:11], s24 offen offset:1024 sc1 lds
  buffer_load_dwordx4 v2, s[8:11], s24 offen offset:2048 sc1 lds
  s_mov_b32 s19, s34
  s_mov_b32 s32, 0
  s_mov_b32 s33, 57344
  s_waitcnt vmcnt(7)
  s_branch wf_vo_in
wf_vo_loop:
  s_waitcnt vmcnt(9)
wf_vo_in:
  s_barrier
  s_add_u32 s30, s19, 2
  s_lshl_b32 s24, s30, 1
  s_mul_i32 s24, s24, 14336
  s_add_u32 s24, s24, s23
  s_cmp_lt_u32 s30, s35
  s_cselect_b32 s24, s24, 0x10000000
  s_add_u32 m0, s33, s27
  s_nop 0
  buffer_load_dwordx4 v2, s[8:11], s24 offen offset:0 sc1 lds
  buffer_load_dwordx4 v2, s[8:11], s24 offen offset:1024 sc1 lds
  buffer_load_dwordx4 v2, s[8:11], s24 offen offset:2048 sc1 lds
  buffer_load_dwordx4 v2, s[8:11], s24 offen offset:3072 sc1 lds
  s_add_u32 m0, m0, 4096
  s_add_u32 s24, s24, 4096
  buffer_load_dwordx4 v2, s[8:11], s24 offen offset:0 sc1 lds
  buffer_load_dwordx4 v2, s[8:11], s24 offen offset:1024 sc1 lds
  buffer_load_dwordx4 v2, s[8:11], s24 offen offset:2048 sc1 lds
  v_add_u32 v5, s32, v2
  ds_read_b128 v[8:11], v5 offset:0
  ds_read_b128 v[12:15], v5 offset:14336
  ds_read_b128 v[16:19], v5 offset:1024
  ds_read_b128 v[20:23], v5 offset:15360
  ds_read_b128 v[24:27], v5 offset:2048
  ds_read_b128 v[28:31], v5 offset:16384
  ds_read_b128 v[32:35], v5 offset:3072
  s_waitcnt lgkmcnt(6)
  v_mfma_f32_16x16x32_bf16 v[40:43], a[0:3], v[8:11], 0
  v_mfma_f32_16x16x32_bf16 v[44:47], a[56:59], v[8:11], 0
  ds_read_b128 v[36:39], v5 offset:17408
  s_waitcnt lgkmcnt(6)
  v_mfma_f32_16x16x32_bf16 v[56:59], a[0:3], v[12:15], 0
  v_mfma_f32_16x16x32_bf16 v[60:63], a[56:59], v[12:15], 0
  ds_read_b128 v[8:11], v5 offset:4096
  s_waitcnt lgkmcnt(6)
  v_mfma_f32_16x16x32_bf16 v[40:43], a[4:7], v[16:19], v[40:43]
  v_mfma_f32_16x16x32_bf16 v[44:47], a[60:63], v[16:19], v[44:47]
  ds_read_b128 v[12:15], v5 offset:18432
  s_waitcnt lgkmcnt(6)
  v_mfma_f32_16x16x32_bf16 v[56:59], a[4:7], v[20:23], v[56:59]
  v_mfma_f32_16x16x32_bf16 v[60:63], a[60:63], v[20:23], v[60:63]
  ds_read_b128 v[16:19], v5 offset:5120
  s_waitcnt lgkmcnt(6)
  v_mfma_f32_16x16x32_bf16 v[40:43], a[8:11], v[24:27], v[40:43]
  v_mfma_f32_16x16x32_bf16 v[44:47], a[64:67], v[24:27], v[44:47]
  ds_read_b128 v[20:23], v5 offset:19456
  s_waitcnt lgkmcnt(6)
  v_mfma_f32_16x16x32_bf16 v[56:59], a[8:11], v[28:31], v[56:59]
  v_mfma_f32_16x16x32_bf16 v[60:63], a[64:67], v[28:31], v[60:63]
  ds_read_b128 v[24:27], v5 offset:6144
  s_waitcnt lgkmcnt(6)
  v_mfma_f32_16x16x32_bf16 v[40:43], a[12:15], v[32:35], v[40:43]
  v_mfma_f32_16x16x32_bf16 v[44:47], a[68:71], v[32:35], v[44:47]
  ds_read_b128 v[28:31], v5 offset:20480
  s_waitcnt lgkmcnt(6)
  v_mfma_f32_16x16x32_bf16 v[56:59], a[12:15], v[36:39], v[56:59]
  v_mfma_f32_16x16x32_bf16 v[60:63], a[68:71], v[36:39], v[60:63]
  ds_read_b128 v[32:35], v5 offset:7168
  s_waitcnt lgkmcnt(6)
  v_mfma_f32_16x16x32_bf16 v[40:43], a[16:19], v[8:11], v[40:43]
  v_mfma_f32_16x16x32_bf16 v[44:47], a[72:75], v[8:11], v[44:47]
  ds_read_b128 v[36:39], v5 offset:21504
  s_waitcnt lgkmcnt(6)
  v_mfma_f32_16x16x32_bf16 v[56:59], a[16:19], v[12:15], v[56:59]
  v_mfma_f32_16x16x32_bf16 v[60:63], a[72:75], v[12:15], v[60:63]
  ds_read_b128 v[8:11], v5 offset:8192
  s_waitcnt lgkmcnt(6)
  v_mfma_f32_16x16x32_bf16 v[40:43], a[20:23], v[16:19], v[40:43]
  v_mfma_f32_16x16x32_bf16 v[44:47], a[76:79], v[16:19], v[44:47]
  ds_read_b128 v[12:15], v5 offset:22528
  s_waitcnt lgkmcnt(6)
  v_mfma_f32_16x16x32_bf16 v[56:59], a[20:23], v[20:23], v[56:59]
  v_mfma_f32_16x16x32_bf16 v[60:63], a[76:79], v[20:23], v[60:63]
  ds_read_b128 v[16:19], v5 offset:9216
  s_waitcnt lgkmcnt(6)
  v_mfma_f32_16x16x32_bf16 v[40:43], a[24:27], v[24:27], v[40:43]
  v_mfma_f32_16x16x32_bf16 v[44:47], a[80:83], v[24:27], v[44:47]
  ds_read_b128 v[20:23], v5 offset:23552
  s_waitcnt lgkmcnt(6)
  v_mfma_f32_16x16x32_bf16 v[56:59], a[24:27], v[28:31], v[56:59]
  v_mfma_f32_16x16x32_bf16 v[60:63], a[80:83], v[28:31], v[60:63]
  ds_read_b128 v[24:27], v5 offset:10240
  s_waitcnt lgkmcnt(6)
  v_mfma_f32_16x16x32_bf16 v[40:43], a[28:31], v[32:35], v[40:43]
  v_mfma_f32_16x16x32_bf16 v[44:47], a[84:87], v[32:35], v[44:47]
  ds_read_b128 v[28:31], v5 offset:24576
  s_waitcnt lgkmcnt(6)
  v_mfma_f32_16x16x32_bf16 v[56:59], a[28:31], v[36:39], v[56:59]
  v_mfma_f32_16x16x32_bf16 v[60:63], a[84:87], v[36:39], v[60:63]
  ds_read_b128 v[32:35], v5 offset:11264
  s_waitcnt lgkmcnt(6)
  v_mfma_f32_16x16x32_bf16 v[40:43], a[32:35], v[8:11], v[40:43]
  v_mfma_f32_16x16x32_bf16 v[44:47], a[88:91], v[8:11], v[44:47]
  ds_read_b128 v[36:39], v5 offset:25600
  s_waitcnt lgkmcnt(6)
  v_mfma_f32_16x16x32_bf16 v[56:59], a[32:35], v[12:15], v[56:59]
  v_mfma_f32_16x16x32_bf16 v[60:63], a[88:91], v[12:15], v[60:63]
  ds_read_b128 v[8:11], v5 offset:12288
  s_waitcnt lgkmcnt(6)
  v_mfma_f32_16x16x32_bf16 v[40:43], a[36:39], v[16:19], v[40:43]
  v_mfma_f32_16x16x32_bf16 v[44:47], a[92:95], v[16:19], v[44:47]
  ds_read_b128 v[12:15], v5 offset:26624
  s_waitcnt lgkmcnt(6)
  v_mfma_f32_16x16x32_bf16 v[56:59], a[36:39], v[20:23], v[56:59]
  v_mfma_f32_16x16x32_bf16 v[60:63], a[92:95], v[20:23], v[60:63]
  ds_read_b128 v[16:19], v5 offset:13312
  s_waitcnt lgkmcnt(6)
  v_mfma_f32_16x16x32_bf16 v[40:43], a[40:43], v[24:27], v[40:43]
  v_mfma_f32_16x16x32_bf16 v[44:47], a[96:99], v[24:27], v[44:47]
  ds_read_b128 v[20:23], v5 offset:27648
  s_waitcnt lgkmcnt(6)
  v_mfma_f32_16x16x32_bf16 v[56:59], a[40:43], v[28:31], v[56:59]
  v_mfma_f32_16x16x32_bf16 v[60:63], a[96:99], v[28:31], v[60:63]
  s_waitcnt lgkmcnt(5)
  v_mfma_f32_16x16x32_bf16 v[40:43], a[44:47], v[32:35], v[40:43]
  v_mfma_f32_16x16x32_bf16 v[44:47], a[100:103], v[32:35], v[44:47]
  s_waitcnt lgkmcnt(4)
  v_mfma_f32_16x16x32_bf16 v[56:59], a[44:47], v[36:39], v[56:59]
  v_mfma_f32_16x16x32_bf16 v[60:63], a[100:103], v[36:39], v[60:63]
  s_waitcnt lgkmcnt(3)
  v_mfma_f32_16x16x32_bf16 v[40:43], a[48:51], v[8:11], v[40:43]
  v_mfma_f32_16x16x32_bf16 v[44:47], a[104:107], v[8:11], v[44:47]
  s_waitcnt lgkmcnt(2)
  v_mfma_f32_16x16x32_bf16 v[56:59], a[48:51], v[12:15], v[56:59]
  v_mfma_f32_16x16x32_bf16 v[60:63], a[104:107], v[12:15], v[60:63]
  s_waitcnt lgkmcnt(1)
  v_mfma_f32_16x16x32_bf16 v[40:43], a[52:55], v[16:19], v[40:43]
  v_mfma_f32_16x16x32_bf16 v[44:47], a[108:111], v[16:19], v[44:47]
  s_waitcnt lgkmcnt(0)
  v_mfma_f32_16x16x32_bf16 v[56:59], a[52:55], v[20:23], v[56:59]
  v_mfma_f32_16x16x32_bf16 v[60:63], a[108:111], v[20:23], v[60:63]
  s_add_u32 s25, s29, 28672
  s_lshl_b32 s24, s19, 5
  s_add_u32 s24, s24, 0
  v_add_u32 v88, s24, v4
  v_mul_u32_u24 v89, 2341, v88
  v_lshrrev_b32 v89, 16, v89
  v_mul_u32_u24 v92, 28, v89
  v_sub_u32 v92, v88, v92
  v_cmp_gt_u32 vcc, 16, v92
  v_mul_u32_u24 v89, 84, v89
  s_nop 0
  v_cndmask_b32 v92, v7, v6, vcc
  v_add3_u32 v88, v88, v89, v92
  v_lshlrev_b32 v90, 4, v88
  v_cvt_pk_bf16_f32 v72, v40, v41
  v_cvt_pk_bf16_f32 v73, v42, v43
  v_cvt_pk_bf16_f32 v74, v44, v45
  v_cvt_pk_bf16_f32 v75, v46, v47
  buffer_store_dwordx4 v[72:75], v90, s[8:11], s29 offen sc1
  s_lshl_b32 s24, s19, 5
  s_add_u32 s24, s24, 16
  v_add_u32 v88, s24, v4
  v_mul_u32_u24 v89, 2341, v88
  v_lshrrev_b32 v89, 16, v89
  v_mul_u32_u24 v92, 28, v89
  v_sub_u32 v92, v88, v92
  v_cmp_gt_u32 vcc, 16, v92
  v_mul_u32_u24 v89, 84, v89
  s_nop 0
  v_cndmask_b32 v92, v7, v6, vcc
  v_add3_u32 v88, v88, v89, v92
  v_lshlrev_b32 v91, 4, v88
  v_cvt_pk_bf16_f32 v80, v56, v57
  v_cvt_pk_bf16_f32 v81, v58, v59
  v_cvt_pk_bf16_f32 v82, v60, v61
  v_cvt_pk_bf16_f32 v83, v62, v63
  buffer_store_dwordx4 v[80:83], v91, s[8:11], s29 offen sc1
  s_mov_b32 s33, s32
  s_add_u32 s32, s32, 28672
  s_cmp_eq_u32 s32, 86016
  s_cselect_b32 s32, 0, s32
  s_add_u32 s19, s19, 1
  s_cmp_lt_u32 s19, s35
  s_cbranch_scc1 wf_vo_loop
  s_branch wf_done
wf_done:
  s_lshr_b32 s20, s18, 1
  s_lshl_b32 s20, s20, 4
  s_and_b32 s21, s17, 15
  s_add_u32 s20, s20, s21
  s_lshl_b32 s20, s20, 7
  s_cmp_lt_u32 s17, 16
  s_cselect_b32 s21, 16384, 0
  s_add_u32 s20, s20, s21
  s_add_u32 s20, s20, 88541184
  s_sub_u32 s21, s35, s34
  s_lshr_b32 s21, s21, 1
  v_mov_b32 v5, s21
  v_mov_b32 v6, 0
  s_waitcnt vmcnt(0)
  s_mov_b64 exec, 1
  s_cmp_lg_u32 s18, 0
  s_cbranch_scc1 wf_h1
  v_mov_b32 v7, 2
  s_sub_u32 s21, s20, 2048
  buffer_atomic_add v7, v6, s[8:11], s21 offen
wf_h1:
  buffer_atomic_add v5, v6, s[8:11], s20 offen
  s_mov_b64 exec, -1
  s_load_dwordx8 s[36:43], s[0:1], 56
  s_load_dwordx4 s[44:47], s[0:1], 88
  s_waitcnt lgkmcnt(0)
  s_mov_b32 s52, s36
  s_and_b32 s53, s37, 0xffff
  s_mov_b32 s54, 1835008
  s_mov_b32 s55, 0x20000
  s_lshl_b32 s20, s3, 8
  v_add_u32 v95, s20, v0
  s_mov_b32 s21, 9586981
  v_mul_hi_u32 v6, v95, s21
  v_mul_u32_u24 v7, 448, v6
  v_sub_u32 v7, v95, v7
  v_lshrrev_b32 v8, 4, v7
  v_and_b32 v7, 15, v7
  v_lshl_add_u32 v9, v6, 4, v7
  v_mul_u32_u24 v9, 896, v9
  v_lshl_add_u32 v9, v8, 5, v9
  buffer_load_dwordx4 v[84:87], v9, s[52:55], 0 offen
  buffer_load_dwordx4 v[88:91], v9, s[52:55], 0 offen offset:16
  v_mul_u32_u24 v6, 14336, v6
  v_lshl_add_u32 v6, v7, 4, v6
  v_lshl_add_u32 v92, v8, 9, v6
  v_lshrrev_b32 v7, 2, v8
  v_lshl_add_u32 v6, v7, 11, v6
  v_and_b32 v7, 3, v8
  v_lshl_add_u32 v93, v7, 8, v6
  v_mov_b32 v52, -1
  v_mov_b32 v53, -1
  v_mov_b32 v54, -1
  v_mov_b32 v55, -1
  s_mov_b32 s23, 89063424
  v_lshlrev_b32 v8, 4, v95
  buffer_store_dwordx4 v[52:55], v8, s[8:11], s23 offen sc1
  v_add_u32 v8, 917504, v8
  v_mov_b32 v9, 0x10000000
  v_cmp_lt_u32 vcc, 1535, v95
  s_nop 1
  v_cndmask_b32 v8, v8, v9, vcc
  buffer_store_dwordx4 v[52:55], v8, s[8:11], s23 offen sc1
  s_waitcnt vmcnt(1)
  v_mov_b32 v96, v84
  v_mov_b32 v100, v85
  v_mov_b32 v97, v86
  v_mov_b32 v101, v87
  v_mov_b32 v98, v88
  v_mov_b32 v102, v89
  v_mov_b32 v99, v90
  v_mov_b32 v103, v91
  s_mov_b32 s20, 71565312
  s_mov_b32 s21, 73400320
  buffer_store_dwordx4 v[96:99], v93, s[8:11], s21 offen sc1
  buffer_store_dwordx4 v[100:103], v93, s[8:11], s21 offen offset:1024 sc1
  s_cmp_lt_u32 s3, 70
  s_cbranch_scc1 i2_nx
  buffer_store_dwordx4 v[84:87], v92, s[8:11], s20 offen sc1
  buffer_store_dwordx4 v[88:91], v92, s[8:11], s20 offen offset:256 sc1
i2_nx:
  s_lshl_b32 s20, s3, 3
  s_add_u32 s20, s20, 88637440
  s_waitcnt vmcnt(0)
  s_barrier
  s_cmp_lg_u32 s16, 0
  s_cbranch_scc1 pub_38
  v_mul_u32_u24 v26, 2048, v1
  v_mov_b32 v24, s88
  v_mov_b32 v25, s89
  s_mov_b64 exec, 255
  buffer_store_dwordx2 v[24:25], v26, s[8:11], s20 offen sc1
  s_mov_b64 exec, -1
pub_38:
  s_branch wk_loop
wk_v7:
  s_sub_u32 s20, s3, 256
  s_mov_b32 s18, 1
  s_and_b32 s17, s20, 15
  s_add_u32 s17, s17, 16
  s_lshr_b32 s34, s20, 4
  s_lshl_b32 s34, s34, 1
  s_add_u32 s35, s34, 2
  s_branch wk_gemm
wk_vh:
  s_sub_u32 s20, s3, 368
  s_and_b32 s17, s20, 15
  s_add_u32 s17, s17, 16
  s_lshr_b32 s18, s20, 5
  s_add_u32 s18, s18, 2
  s_bitcmp1_b32 s20, 4
  s_cselect_b32 s34, 7, 0
  s_add_u32 s35, s34, 7
  s_branch wk_gemm
wk_vf:
  s_sub_u32 s20, s3, 560
  s_and_b32 s17, s20, 15
  s_add_u32 s17, s17, 16
  s_lshr_b32 s18, s20, 4
  s_add_u32 s18, s18, 4
  s_mov_b32 s34, 0
  s_mov_b32 s35, 14
  s_branch wk_gemm
wk_f:
  s_sub_u32 s20, s3, 624
  s_and_b32 s17, s20, 15
  s_lshr_b32 s18, s20, 4
  s_mov_b32 s34, 0
  s_mov_b32 s35, 14
  s_lshl_b32 s22, s17, 7
  s_add_u32 s22, s22, 88633344
  s_add_u32 s23, s22, 2048
  v_min_u32 v24, 48, v2
  v_min_u32 v25, 96, v2
  s_mov_b32 s30, 0
wk_aw:
  buffer_load_dwordx4 v[28:31], v24, s[8:11], s22 offen sc1
  buffer_load_dwordx4 v[32:35], v25, s[8:11], s23 offen sc1
  s_waitcnt vmcnt(0)
  v_cmp_ne_u64 vcc, s[88:89], v[28:29]
  s_cbranch_vccnz wk_aw_no
  v_cmp_ne_u64 vcc, s[88:89], v[30:31]
  s_cbranch_vccnz wk_aw_no
  v_cmp_ne_u64 vcc, s[88:89], v[32:33]
  s_cbranch_vccnz wk_aw_no
  v_cmp_ne_u64 vcc, s[88:89], v[34:35]
  s_cbranch_vccnz wk_aw_no
  s_branch wk_aw_ok
wk_aw_no:
  s_sleep 6
  s_add_u32 s30, s30, 1
  s_cmp_lt_u32 s30, 50000
  s_cbranch_scc1 wk_aw
  s_branch cA_abort
wk_aw_ok:
wk_gemm:
  s_lshl_b32 s20, s18, 4
  s_lshl_b32 s21, s16, 2
  s_add_u32 s20, s20, s21
  s_mul_i32 s21, s20, 14336
  s_add_u32 s21, s21, 71565312
  s_add_u32 s22, s21, 0
  buffer_load_dwordx4 a[0:3], v2, s[8:11], s22 offen offset:0 sc1
  buffer_load_dwordx4 a[4:7], v2, s[8:11], s22 offen offset:1024 sc1
  buffer_load_dwordx4 a[8:11], v2, s[8:11], s22 offen offset:2048 sc1
  buffer_load_dwordx4 a[12:15], v2, s[8:11], s22 offen offset:3072 sc1
  s_add_u32 s22, s21, 4096
  buffer_load_dwordx4 a[16:19], v2, s[8:11], s22 offen offset:0 sc1
  buffer_load_dwordx4 a[20:23], v2, s[8:11], s22 offen offset:1024 sc1
  buffer_load_dwordx4 a[24:27], v2, s[8:11], s22 offen offset:2048 sc1
  buffer_load_dwordx4 a[28:31], v2, s[8:11], s22 offen offset:3072 sc1
  s_add_u32 s22, s21, 8192
  buffer_load_dwordx4 a[32:35], v2, s[8:11], s22 offen offset:0 sc1
  buffer_load_dwordx4 a[36:39], v2, s[8:11], s22 offen offset:1024 sc1
  buffer_load_dwordx4 a[40:43], v2, s[8:11], s22 offen offset:2048 sc1
  buffer_load_dwordx4 a[44:47], v2, s[8:11], s22 offen offset:3072 sc1
  s_add_u32 s22, s21, 12288
  buffer_load_dwordx4 a[48:51], v2, s[8:11], s22 offen offset:0 sc1
  buffer_load_dwordx4 a[52:55], v2, s[8:11], s22 offen offset:1024 sc1
  buffer_load_dwordx4 a[56:59], v2, s[8:11], s22 offen offset:2048 sc1
  buffer_load_dwordx4 a[60:63], v2, s[8:11], s22 offen offset:3072 sc1
  s_add_u32 s22, s21, 16384
  buffer_load_dwordx4 a[64:67], v2, s[8:11], s22 offen offset:0 sc1
  buffer_load_dwordx4 a[68:71], v2, s[8:11], s22 offen offset:1024 sc1
  buffer_load_dwordx4 a[72:75], v2, s[8:11], s22 offen offset:2048 sc1
  buffer_load_dwordx4 a[76:79], v2, s[8:11], s22 offen offset:3072 sc1
  s_add_u32 s22, s21, 20480
  buffer_load_dwordx4 a[80:83], v2, s[8:11], s22 offen offset:0 sc1
  buffer_load_dwordx4 a[84:87], v2, s[8:11], s22 offen offset:1024 sc1
  buffer_load_dwordx4 a[88:91], v2, s[8:11], s22 offen offset:2048 sc1
  buffer_load_dwordx4 a[92:95], v2, s[8:11], s22 offen offset:3072 sc1
  s_add_u32 s22, s21, 24576
  buffer_load_dwordx4 a[96:99], v2, s[8:11], s22 offen offset:0 sc1
  buffer_load_dwordx4 a[100:103], v2, s[8:11], s22 offen offset:1024 sc1
  buffer_load_dwordx4 a[104:107], v2, s[8:11], s22 offen offset:2048 sc1
  buffer_load_dwordx4 a[108:111], v2, s[8:11], s22 offen offset:3072 sc1
  s_add_u32 s22, s21, 28672
  buffer_load_dwordx4 a[112:115], v2, s[8:11], s22 offen offset:0 sc1
  buffer_load_dwordx4 a[116:119], v2, s[8:11], s22 offen offset:1024 sc1
  buffer_load_dwordx4 a[120:123], v2, s[8:11], s22 offen offset:2048 sc1
  buffer_load_dwordx4 a[124:127], v2, s[8:11], s22 offen offset:3072 sc1
  s_add_u32 s22, s21, 32768
  buffer_load_dwordx4 a[128:131], v2, s[8:11], s22 offen offset:0 sc1
  buffer_load_dwordx4 a[132:135], v2, s[8:11], s22 offen offset:1024 sc1
  buffer_load_dwordx4 a[136:139], v2, s[8:11], s22 offen offset:2048 sc1
  buffer_load_dwordx4 a[140:143], v2, s[8:11], s22 offen offset:3072 sc1
  s_add_u32 s22, s21, 36864
  buffer_load_dwordx4 a[144:147], v2, s[8:11], s22 offen offset:0 sc1
  buffer_load_dwordx4 a[148:151], v2, s[8:11], s22 offen offset:1024 sc1
  buffer_load_dwordx4 a[152:155], v2, s[8:11], s22 offen offset:2048 sc1
  buffer_load_dwordx4 a[156:159], v2, s[8:11], s22 offen offset:3072 sc1
  s_add_u32 s22, s21, 40960
  buffer_load_dwordx4 a[160:163], v2, s[8:11], s22 offen offset:0 sc1
  buffer_load_dwordx4 a[164:167], v2, s[8:11], s22 offen offset:1024 sc1
  buffer_load_dwordx4 a[168:171], v2, s[8:11], s22 offen offset:2048 sc1
  buffer_load_dwordx4 a[172:175], v2, s[8:11], s22 offen offset:3072 sc1
  s_add_u32 s22, s21, 45056
  buffer_load_dwordx4 a[176:179], v2, s[8:11], s22 offen offset:0 sc1
  buffer_load_dwordx4 a[180:183], v2, s[8:11], s22 offen offset:1024 sc1
  buffer_load_dwordx4 a[184:187], v2, s[8:11], s22 offen offset:2048 sc1
  buffer_load_dwordx4 a[188:191], v2, s[8:11], s22 offen offset:3072 sc1
  s_add_u32 s22, s21, 49152
  buffer_load_dwordx4 a[192:195], v2, s[8:11], s22 offen offset:0 sc1
  buffer_load_dwordx4 a[196:199], v2, s[8:11], s22 offen offset:1024 sc1
  buffer_load_dwordx4 a[200:203], v2, s[8:11], s22 offen offset:2048 sc1
  buffer_load_dwordx4 a[204:207], v2, s[8:11], s22 offen offset:3072 sc1
  s_add_u32 s22, s21, 53248
  buffer_load_dwordx4 a[208:211], v2, s[8:11], s22 offen offset:0 sc1
  buffer_load_dwordx4 a[212:215], v2, s[8:11], s22 offen offset:1024 sc1
  buffer_load_dwordx4 a[216:219], v2, s[8:11], s22 offen offset:2048 sc1
  buffer_load_dwordx4 a[220:223], v2, s[8:11], s22 offen offset:3072 sc1
  s_waitcnt vmcnt(40)
  s_mul_i32 s23, s17, 401408
  s_and_b32 s22, s16, 1
  s_mul_i32 s22, s22, 7168
  s_add_u32 s23, s23, s22
  s_add_u32 s23, s23, 0
  s_lshr_b32 s22, s16, 1
  s_mul_i32 s22, s22, 14336
  s_add_u32 s23, s23, s22
  s_mul_i32 s27, s16, 7168
  s_lshr_b32 s28, s20, 1
  s_cmp_lt_u32 s17, 16
  s_cbranch_scc0 wg_vo
  s_add_u32 s23, s23, s22
  s_lshl_b32 s29, s28, 4
  s_add_u32 s29, s29, s17
  s_mul_i32 s29, s29, 28672
  s_add_u32 s29, s29, 12845056
  s_mov_b32 s31, 0
  s_lshr_b32 s24, s34, 1
  s_lshl_b32 s24, s24, 2
  s_and_b32 s25, s34, 1
  s_add_u32 s24, s24, s25
  s_mul_i32 s24, s24, 14336
  s_add_u32 s24, s24, s23
  s_cmp_lt_u32 s34, s35
  s_cselect_b32 s24, s24, 0x10000000
  s_add_u32 m0, s31, s27
  s_nop 0
  buffer_load_dwordx4 v2, s[8:11], s24 offen offset:0 sc1 lds
  buffer_load_dwordx4 v2, s[8:11], s24 offen offset:1024 sc1 lds
  buffer_load_dwordx4 v2, s[8:11], s24 offen offset:2048 sc1 lds
  buffer_load_dwordx4 v2, s[8:11], s24 offen offset:3072 sc1 lds
  s_add_u32 m0, m0, 4096
  s_add_u32 s24, s24, 4096
  buffer_load_dwordx4 v2, s[8:11], s24 offen offset:0 sc1 lds
  buffer_load_dwordx4 v2, s[8:11], s24 offen offset:1024 sc1 lds
  buffer_load_dwordx4 v2, s[8:11], s24 offen offset:2048 sc1 lds
  s_add_u32 s30, s34, 1
  s_mov_b32 s31, 28672
  s_lshr_b32 s24, s30, 1
  s_lshl_b32 s24, s24, 2
  s_and_b32 s25, s30, 1
  s_add_u32 s24, s24, s25
  s_mul_i32 s24, s24, 14336
  s_add_u32 s24, s24, s23
  s_cmp_lt_u32 s30, s35
  s_cselect_b32 s24, s24, 0x10000000
  s_add_u32 m0, s31, s27
  s_nop 0
  buffer_load_dwordx4 v2, s[8:11], s24 offen offset:0 sc1 lds
  buffer_load_dwordx4 v2, s[8:11], s24 offen offset:1024 sc1 lds
  buffer_load_dwordx4 v2, s[8:11], s24 offen offset:2048 sc1 lds
  buffer_load_dwordx4 v2, s[8:11], s24 offen offset:3072 sc1 lds
  s_add_u32 m0, m0, 4096
  s_add_u32 s24, s24, 4096
  buffer_load_dwordx4 v2, s[8:11], s24 offen offset:0 sc1 lds
  buffer_load_dwordx4 v2, s[8:11], s24 offen offset:1024 sc1 lds
  buffer_load_dwordx4 v2, s[8:11], s24 offen offset:2048 sc1 lds
  s_mov_b32 s19, s34
  s_mov_b32 s32, 0
  s_mov_b32 s33, 57344
  s_waitcnt vmcnt(7)
  s_branch wg_f_in
wg_f_loop:
  s_waitcnt vmcnt(11)
wg_f_in:
  s_barrier
  s_add_u32 s30, s19, 2
  s_lshr_b32 s24, s30, 1
  s_lshl_b32 s24, s24, 2
  s_and_b32 s25, s30, 1
  s_add_u32 s24, s24, s25
  s_mul_i32 s24, s24, 14336
  s_add_u32 s24, s24, s23
  s_cmp_lt_u32 s30, s35
  s_cselect_b32 s24, s24, 0x10000000
  s_add_u32 m0, s33, s27
  s_nop 0
  buffer_load_dwordx4 v2, s[8:11], s24 offen offset:0 sc1 lds
  buffer_load_dwordx4 v2, s[8:11], s24 offen offset:1024 sc1 lds
  buffer_load_dwordx4 v2, s[8:11], s24 offen offset:2048 sc1 lds
  buffer_load_dwordx4 v2, s[8:11], s24 offen offset:3072 sc1 lds
  s_add_u32 m0, m0, 4096
  s_add_u32 s24, s24, 4096
  buffer_load_dwordx4 v2, s[8:11], s24 offen offset:0 sc1 lds
  buffer_load_dwordx4 v2, s[8:11], s24 offen offset:1024 sc1 lds
  buffer_load_dwordx4 v2, s[8:11], s24 offen offset:2048 sc1 lds
  v_add_u32 v5, s32, v2
  ds_read_b128 v[8:11], v5 offset:0
  ds_read_b128 v[12:15], v5 offset:14336
  ds_read_b128 v[16:19], v5 offset:1024
  ds_read_b128 v[20:23], v5 offset:15360
  ds_read_b128 v[24:27], v5 offset:2048
  ds_read_b128 v[28:31], v5 offset:16384
  ds_read_b128 v[32:35], v5 offset:3072
  s_waitcnt lgkmcnt(6)
  v_mfma_f32_16x16x32_bf16 v[40:43], v[8:11], a[0:3], 0
  v_mfma_f32_16x16x32_bf16 v[44:47], v[8:11], a[56:59], 0
  v_mfma_f32_16x16x32_bf16 v[48:51], v[8:11], a[112:115], 0
  v_mfma_f32_16x16x32_bf16 v[52:55], v[8:11], a[168:171], 0
  ds_read_b128 v[36:39], v5 offset:17408
  s_waitcnt lgkmcnt(6)
  v_mfma_f32_16x16x32_bf16 v[56:59], v[12:15], a[0:3], 0
  v_mfma_f32_16x16x32_bf16 v[60:63], v[12:15], a[56:59], 0
  v_mfma_f32_16x16x32_bf16 v[64:67], v[12:15], a[112:115], 0
  v_mfma_f32_16x16x32_bf16 v[68:71], v[12:15], a[168:171], 0
  ds_read_b128 v[8:11], v5 offset:4096
  s_waitcnt lgkmcnt(6)
  v_mfma_f32_16x16x32_bf16 v[40:43], v[16:19], a[4:7], v[40:43]
  v_mfma_f32_16x16x32_bf16 v[44:47], v[16:19], a[60:63], v[44:47]
  v_mfma_f32_16x16x32_bf16 v[48:51], v[16:19], a[116:119], v[48:51]
  v_mfma_f32_16x16x32_bf16 v[52:55], v[16:19], a[172:175], v[52:55]
  ds_read_b128 v[12:15], v5 offset:18432
  s_waitcnt lgkmcnt(6)
  v_mfma_f32_16x16x32_bf16 v[56:59], v[20:23], a[4:7], v[56:59]
  v_mfma_f32_16x16x32_bf16 v[60:63], v[20:23], a[60:63], v[60:63]
  v_mfma_f32_16x16x32_bf16 v[64:67], v[20:23], a[116:119], v[64:67]
  v_mfma_f32_16x16x32_bf16 v[68:71], v[20:23], a[172:175], v[68:71]
  ds_read_b128 v[16:19], v5 offset:5120
  s_waitcnt lgkmcnt(6)
  v_mfma_f32_16x16x32_bf16 v[40:43], v[24:27], a[8:11], v[40:43]
  v_mfma_f32_16x16x32_bf16 v[44:47], v[24:27], a[64:67], v[44:47]
  v_mfma_f32_16x16x32_bf16 v[48:51], v[24:27], a[120:123], v[48:51]
  v_mfma_f32_16x16x32_bf16 v[52:55], v[24:27], a[176:179], v[52:55]
  ds_read_b128 v[20:23], v5 offset:19456
  s_waitcnt lgkmcnt(6)
  v_mfma_f32_16x16x32_bf16 v[56:59], v[28:31], a[8:11], v[56:59]
  v_mfma_f32_16x16x32_bf16 v[60:63], v[28:31], a[64:67], v[60:63]
  v_mfma_f32_16x16x32_bf16 v[64:67], v[28:31], a[120:123], v[64:67]
  v_mfma_f32_16x16x32_bf16 v[68:71], v[28:31], a[176:179], v[68:71]
  ds_read_b128 v[24:27], v5 offset:6144
  s_waitcnt lgkmcnt(6)
  v_mfma_f32_16x16x32_bf16 v[40:43], v[32:35], a[12:15], v[40:43]
  v_mfma_f32_16x16x32_bf16 v[44:47], v[32:35], a[68:71], v[44:47]
  v_mfma_f32_16x16x32_bf16 v[48:51], v[32:35], a[124:127], v[48:51]
  v_mfma_f32_16x16x32_bf16 v[52:55], v[32:35], a[180:183], v[52:55]
  ds_read_b128 v[28:31], v5 offset:20480
  s_waitcnt lgkmcnt(6)
  v_mfma_f32_16x16x32_bf16 v[56:59], v[36:39], a[12:15], v[56:59]
  v_mfma_f32_16x16x32_bf16 v[60:63], v[36:39], a[68:71], v[60:63]
  v_mfma_f32_16x16x32_bf16 v[64:67], v[36:39], a[124:127], v[64:67]
  v_mfma_f32_16x16x32_bf16 v[68:71], v[36:39], a[180:183], v[68:71]
  ds_read_b128 v[32:35], v5 offset:7168
  s_waitcnt lgkmcnt(6)
  v_mfma_f32_16x16x32_bf16 v[40:43], v[8:11], a[16:19], v[40:43]
  v_mfma_f32_16x16x32_bf16 v[44:47], v[8:11], a[72:75], v[44:47]
  v_mfma_f32_16x16x32_bf16 v[48:51], v[8:11], a[128:131], v[48:51]
  v_mfma_f32_16x16x32_bf16 v[52:55], v[8:11], a[184:187], v[52:55]
  ds_read_b128 v[36:39], v5 offset:21504
  s_waitcnt lgkmcnt(6)
  v_mfma_f32_16x16x32_bf16 v[56:59], v[12:15], a[16:19], v[56:59]
  v_mfma_f32_16x16x32_bf16 v[60:63], v[12:15], a[72:75], v[60:63]
  v_mfma_f32_16x16x32_bf16 v[64:67], v[12:15], a[128:131], v[64:67]
  v_mfma_f32_16x16x32_bf16 v[68:71], v[12:15], a[184:187], v[68:71]
  ds_read_b128 v[8:11], v5 offset:8192
  s_waitcnt lgkmcnt(6)
  v_mfma_f32_16x16x32_bf16 v[40:43], v[16:19], a[20:23], v[40:43]
  v_mfma_f32_16x16x32_bf16 v[44:47], v[16:19], a[76:79], v[44:47]
  v_mfma_f32_16x16x32_bf16 v[48:51], v[16:19], a[132:135], v[48:51]
  v_mfma_f32_16x16x32_bf16 v[52:55], v[16:19], a[188:191], v[52:55]
  ds_read_b128 v[12:15], v5 offset:22528
  s_waitcnt lgkmcnt(6)
  v_mfma_f32_16x16x32_bf16 v[56:59], v[20:23], a[20:23], v[56:59]
  v_mfma_f32_16x16x32_bf16 v[60:63], v[20:23], a[76:79], v[60:63]
  v_mfma_f32_16x16x32_bf16 v[64:67], v[20:23], a[132:135], v[64:67]
  v_mfma_f32_16x16x32_bf16 v[68:71], v[20:23], a[188:191], v[68:71]
  ds_read_b128 v[16:19], v5 offset:9216
  s_waitcnt lgkmcnt(6)
  v_mfma_f32_16x16x32_bf16 v[40:43], v[24:27], a[24:27], v[40:43]
  v_mfma_f32_16x16x32_bf16 v[44:47], v[24:27], a[80:83], v[44:47]
  v_mfma_f32_16x16x32_bf16 v[48:51], v[24:27], a[136:139], v[48:51]
  v_mfma_f32_16x16x32_bf16 v[52:55], v[24:27], a[192:195], v[52:55]
  ds_read_b128 v[20:23], v5 offset:23552
  s_waitcnt lgkmcnt(6)
  v_mfma_f32_16x16x32_bf16 v[56:59], v[28:31], a[24:27], v[56:59]
  v_mfma_f32_16x16x32_bf16 v[60:63], v[28:31], a[80:83], v[60:63]
  v_mfma_f32_16x16x32_bf16 v[64:67], v[28:31], a[136:139], v[64:67]
  v_mfma_f32_16x16x32_bf16 v[68:71], v[28:31], a[192:195], v[68:71]
  ds_read_b128 v[24:27], v5 offset:10240
  s_waitcnt lgkmcnt(6)
  v_mfma_f32_16x16x32_bf16 v[40:43], v[32:35], a[28:31], v[40:43]
  v_mfma_f32_16x16x32_bf16 v[44:47], v[32:35], a[84:87], v[44:47]
  v_mfma_f32_16x16x32_bf16 v[48:51], v[32:35], a[140:143], v[48:51]
  v_mfma_f32_16x16x32_bf16 v[52:55], v[32:35], a[196:199], v[52:55]
  ds_read_b128 v[28:31], v5 offset:24576
  s_waitcnt lgkmcnt(6)
  v_mfma_f32_16x16x32_bf16 v[56:59], v[36:39], a[28:31], v[56:59]
  v_mfma_f32_16x16x32_bf16 v[60:63], v[36:39], a[84:87], v[60:63]
  v_mfma_f32_16x16x32_bf16 v[64:67], v[36:39], a[140:143], v[64:67]
  v_mfma_f32_16x16x32_bf16 v[68:71], v[36:39], a[196:199], v[68:71]
  ds_read_b128 v[32:35], v5 offset:11264
  s_waitcnt lgkmcnt(6)
  v_mfma_f32_16x16x32_bf16 v[40:43], v[8:11], a[32:35], v[40:43]
  v_mfma_f32_16x16x32_bf16 v[44:47], v[8:11], a[88:91], v[44:47]
  v_mfma_f32_16x16x32_bf16 v[48:51], v[8:11], a[144:147], v[48:51]
  v_mfma_f32_16x16x32_bf16 v[52:55], v[8:11], a[200:203], v[52:55]
  ds_read_b128 v[36:39], v5 offset:25600
  s_waitcnt lgkmcnt(6)
  v_mfma_f32_16x16x32_bf16 v[56:59], v[12:15], a[32:35], v[56:59]
  v_mfma_f32_16x16x32_bf16 v[60:63], v[12:15], a[88:91], v[60:63]
  v_mfma_f32_16x16x32_bf16 v[64:67], v[12:15], a[144:147], v[64:67]
  v_mfma_f32_16x16x32_bf16 v[68:71], v[12:15], a[200:203], v[68:71]
  ds_read_b128 v[8:11], v5 offset:12288
  s_waitcnt lgkmcnt(6)
  v_mfma_f32_16x16x32_bf16 v[40:43], v[16:19], a[36:39], v[40:43]
  v_mfma_f32_16x16x32_bf16 v[44:47], v[16:19], a[92:95], v[44:47]
  v_mfma_f32_16x16x32_bf16 v[48:51], v[16:19], a[148:151], v[48:51]
  v_mfma_f32_16x16x32_bf16 v[52:55], v[16:19], a[204:207], v[52:55]
  ds_read_b128 v[12:15], v5 offset:26624
  s_waitcnt lgkmcnt(6)
  v_mfma_f32_16x16x32_bf16 v[56:59], v[20:23], a[36:39], v[56:59]
  v_mfma_f32_16x16x32_bf16 v[60:63], v[20:23], a[92:95], v[60:63]
  v_mfma_f32_16x16x32_bf16 v[64:67], v[20:23], a[148:151], v[64:67]
  v_mfma_f32_16x16x32_bf16 v[68:71], v[20:23], a[204:207], v[68:71]
  ds_read_b128 v[16:19], v5 offset:13312
  s_waitcnt lgkmcnt(6)
  v_mfma_f32_16x16x32_bf16 v[40:43], v[24:27], a[40:43], v[40:43]
  v_mfma_f32_16x16x32_bf16 v[44:47], v[24:27], a[96:99], v[44:47]
  v_mfma_f32_16x16x32_bf16 v[48:51], v[24:27], a[152:155], v[48:51]
  v_mfma_f32_16x16x32_bf16 v[52:55], v[24:27], a[208:211], v[52:55]
  ds_read_b128 v[20:23], v5 offset:27648
  s_waitcnt lgkmcnt(6)
  v_mfma_f32_16x16x32_bf16 v[56:59], v[28:31], a[40:43], v[56:59]
  v_mfma_f32_16x16x32_bf16 v[60:63], v[28:31], a[96:99], v[60:63]
  v_mfma_f32_16x16x32_bf16 v[64:67], v[28:31], a[152:155], v[64:67]
  v_mfma_f32_16x16x32_bf16 v[68:71], v[28:31], a[208:211], v[68:71]
  s_waitcnt lgkmcnt(5)
  v_mfma_f32_16x16x32_bf16 v[40:43], v[32:35], a[44:47], v[40:43]
  v_mfma_f32_16x16x32_bf16 v[44:47], v[32:35], a[100:103], v[44:47]
  v_mfma_f32_16x16x32_bf16 v[48:51], v[32:35], a[156:159], v[48:51]
  v_mfma_f32_16x16x32_bf16 v[52:55], v[32:35], a[212:215], v[52:55]
  s_waitcnt lgkmcnt(4)
  v_mfma_f32_16x16x32_bf16 v[56:59], v[36:39], a[44:47], v[56:59]
  v_mfma_f32_16x16x32_bf16 v[60:63], v[36:39], a[100:103], v[60:63]
  v_mfma_f32_16x16x32_bf16 v[64:67], v[36:39], a[156:159], v[64:67]
  v_mfma_f32_16x16x32_bf16 v[68:71], v[36:39], a[212:215], v[68:71]
  s_waitcnt lgkmcnt(3)
  v_mfma_f32_16x16x32_bf16 v[40:43], v[8:11], a[48:51], v[40:43]
  v_mfma_f32_16x16x32_bf16 v[44:47], v[8:11], a[104:107], v[44:47]
  v_mfma_f32_16x16x32_bf16 v[48:51], v[8:11], a[160:163], v[48:51]
  v_mfma_f32_16x16x32_bf16 v[52:55], v[8:11], a[216:219], v[52:55]
  s_waitcnt lgkmcnt(2)
  v_mfma_f32_16x16x32_bf16 v[56:59], v[12:15], a[48:51], v[56:59]
  v_mfma_f32_16x16x32_bf16 v[60:63], v[12:15], a[104:107], v[60:63]
  v_mfma_f32_16x16x32_bf16 v[64:67], v[12:15], a[160:163], v[64:67]
  v_mfma_f32_16x16x32_bf16 v[68:71], v[12:15], a[216:219], v[68:71]
  s_waitcnt lgkmcnt(1)
  v_mfma_f32_16x16x32_bf16 v[40:43], v[16:19], a[52:55], v[40:43]
  v_mfma_f32_16x16x32_bf16 v[44:47], v[16:19], a[108:111], v[44:47]
  v_mfma_f32_16x16x32_bf16 v[48:51], v[16:19], a[164:167], v[48:51]
  v_mfma_f32_16x16x32_bf16 v[52:55], v[16:19], a[220:223], v[52:55]
  s_waitcnt lgkmcnt(0)
  v_mfma_f32_16x16x32_bf16 v[56:59], v[20:23], a[52:55], v[56:59]
  v_mfma_f32_16x16x32_bf16 v[60:63], v[20:23], a[108:111], v[60:63]
  v_mfma_f32_16x16x32_bf16 v[64:67], v[20:23], a[164:167], v[64:67]
  v_mfma_f32_16x16x32_bf16 v[68:71], v[20:23], a[220:223], v[68:71]
  s_lshl_b32 s24, s19, 10
  s_add_u32 s24, s24, s29
  v_cvt_pk_bf16_f32 v72, v40, v41
  v_cvt_pk_bf16_f32 v73, v42, v43
  v_cvt_pk_bf16_f32 v74, v56, v57
  v_cvt_pk_bf16_f32 v75, v58, v59
  s_add_u32 s25, s24, 0
  buffer_store_dwordx4 v[72:75], v2, s[8:11], s25 offen sc1
  v_cvt_pk_bf16_f32 v76, v44, v45
  v_cvt_pk_bf16_f32 v77, v46, v47
  v_cvt_pk_bf16_f32 v78, v60, v61
  v_cvt_pk_bf16_f32 v79, v62, v63
  s_add_u32 s25, s24, 14336
  buffer_store_dwordx4 v[76:79], v2, s[8:11], s25 offen sc1
  v_cvt_pk_bf16_f32 v80, v48, v49
  v_cvt_pk_bf16_f32 v81, v50, v51
  v_cvt_pk_bf16_f32 v82, v64, v65
  v_cvt_pk_bf16_f32 v83, v66, v67
  s_add_u32 s25, s24, 458752
  buffer_store_dwordx4 v[80:83], v2, s[8:11], s25 offen sc1
  v_cvt_pk_bf16_f32 v84, v52, v53
  v_cvt_pk_bf16_f32 v85, v54, v55
  v_cvt_pk_bf16_f32 v86, v68, v69
  v_cvt_pk_bf16_f32 v87, v70, v71
  s_add_u32 s25, s24, 473088
  buffer_store_dwordx4 v[84:87], v2, s[8:11], s25 offen sc1
  s_mov_b32 s33, s32
  s_add_u32 s32, s32, 28672
  s_cmp_eq_u32 s32, 86016
  s_cselect_b32 s32, 0, s32
  s_add_u32 s19, s19, 1
  s_cmp_lt_u32 s19, s35
  s_cbranch_scc1 wg_f_loop
  s_branch wg_done
wg_vo:
  s_sub_u32 s29, s17, 16
  s_lshl_b32 s29, s29, 6
  s_add_u32 s29, s29, s28
  s_mul_i32 s29, s29, 28672
  s_add_u32 s29, s29, 42205184
  v_lshlrev_b32 v6, 4, v3
  v_mad_u32_u24 v7, v3, 12, 48
  s_mov_b32 s31, 0
  s_lshl_b32 s24, s34, 1
  s_mul_i32 s24, s24, 14336
  s_add_u32 s24, s24, s23
  s_cmp_lt_u32 s34, s35
  s_cselect_b32 s24, s24, 0x10000000
  s_add_u32 m0, s31, s27
  s_nop 0
  buffer_load_dwordx4 v2, s[8:11], s24 offen offset:0 sc1 lds
  buffer_load_dwordx4 v2, s[8:11], s24 offen offset:1024 sc1 lds
  buffer_load_dwordx4 v2, s[8:11], s24 offen offset:2048 sc1 lds
  buffer_load_dwordx4 v2, s[8:11], s24 offen offset:3072 sc1 lds
  s_add_u32 m0, m0, 4096
  s_add_u32 s24, s24, 4096
  buffer_load_dwordx4 v2, s[8:11], s24 offen offset:0 sc1 lds
  buffer_load_dwordx4 v2, s[8:11], s24 offen offset:1024 sc1 lds
  buffer_load_dwordx4 v2, s[8:11], s24 offen offset:2048 sc1 lds
  s_add_u32 s30, s34, 1
  s_mov_b32 s31, 28672
  s_lshl_b32 s24, s30, 1
  s_mul_i32 s24, s24, 14336
  s_add_u32 s24, s24, s23
  s_cmp_lt_u32 s30, s35
  s_cselect_b32 s24, s24, 0x10000000
  s_add_u32 m0, s31, s27
  s_nop 0
  buffer_load_dwordx4 v2, s[8:11], s24 offen offset:0 sc1 lds
  buffer_load_dwordx4 v2, s[8:11], s24 offen offset:1024 sc1 lds
  buffer_load_dwordx4 v2, s[8:11], s24 offen offset:2048 sc1 lds
  buffer_load_dwordx4 v2, s[8:11], s24 offen offset:3072 sc1 lds
  s_add_u32 m0, m0, 4096
  s_add_u32 s24, s24, 4096
  buffer_load_dwordx4 v2, s[8:11], s24 offen offset:0 sc1 lds
  buffer_load_dwordx4 v2, s[8:11], s24 offen offset:1024 sc1 lds
  buffer_load_dwordx4 v2, s[8:11], s24 offen offset:2048 sc1 lds
  s_mov_b32 s19, s34
  s_mov_b32 s32, 0
  s_mov_b32 s33, 57344
  s_waitcnt vmcnt(7)
  s_branch wg_vo_in
wg_vo_loop:
  s_waitcnt vmcnt(11)
wg_vo_in:
  s_barrier
  s_add_u32 s30, s19, 2
  s_lshl_b32 s24, s30, 1
  s_mul_i32 s24, s24, 14336
  s_add_u32 s24, s24, s23
  s_cmp_lt_u32 s30, s35
  s_cselect_b32 s24, s24, 0x10000000
  s_add_u32 m0, s33, s27
  s_nop 0
  buffer_load_dwordx4 v2, s[8:11], s24 offen offset:0 sc1 lds
  buffer_load_dwordx4 v2, s[8:11], s24 offen offset:1024 sc1 lds
  buffer_load_dwordx4 v2, s[8:11], s24 offen offset:2048 sc1 lds
  buffer_load_dwordx4 v2, s[8:11], s24 offen offset:3072 sc1 lds
  s_add_u32 m0, m0, 4096
  s_add_u32 s24, s24, 4096
  buffer_load_dwordx4 v2, s[8:11], s24 offen offset:0 sc1 lds
  buffer_load_dwordx4 v2, s[8:11], s24 offen offset:1024 sc1 lds
  buffer_load_dwordx4 v2, s[8:11], s24 offen offset:2048 sc1 lds
  v_add_u32 v5, s32, v2
  ds_read_b128 v[8:11], v5 offset:0
  ds_read_b128 v[12:15], v5 offset:14336
  ds_read_b128 v[16:19], v5 offset:1024
  ds_read_b128 v[20:23], v5 offset:15360
  ds_read_b128 v[24:27], v5 offset:2048
  ds_read_b128 v[28:31], v5 offset:16384
  ds_read_b128 v[32:35], v5 offset:3072
  s_waitcnt lgkmcnt(6)
  v_mfma_f32_16x16x32_bf16 v[40:43], a[0:3], v[8:11], 0
  v_mfma_f32_16x16x32_bf16 v[44:47], a[56:59], v[8:11], 0
  v_mfma_f32_16x16x32_bf16 v[48:51], a[112:115], v[8:11], 0
  v_mfma_f32_16x16x32_bf16 v[52:55], a[168:171], v[8:11], 0
  ds_read_b128 v[36:39], v5 offset:17408
  s_waitcnt lgkmcnt(6)
  v_mfma_f32_16x16x32_bf16 v[56:59], a[0:3], v[12:15], 0
  v_mfma_f32_16x16x32_bf16 v[60:63], a[56:59], v[12:15], 0
  v_mfma_f32_16x16x32_bf16 v[64:67], a[112:115], v[12:15], 0
  v_mfma_f32_16x16x32_bf16 v[68:71], a[168:171], v[12:15], 0
  ds_read_b128 v[8:11], v5 offset:4096
  s_waitcnt lgkmcnt(6)
  v_mfma_f32_16x16x32_bf16 v[40:43], a[4:7], v[16:19], v[40:43]
  v_mfma_f32_16x16x32_bf16 v[44:47], a[60:63], v[16:19], v[44:47]
  v_mfma_f32_16x16x32_bf16 v[48:51], a[116:119], v[16:19], v[48:51]
  v_mfma_f32_16x16x32_bf16 v[52:55], a[172:175], v[16:19], v[52:55]
  ds_read_b128 v[12:15], v5 offset:18432
  s_waitcnt lgkmcnt(6)
  v_mfma_f32_16x16x32_bf16 v[56:59], a[4:7], v[20:23], v[56:59]
  v_mfma_f32_16x16x32_bf16 v[60:63], a[60:63], v[20:23], v[60:63]
  v_mfma_f32_16x16x32_bf16 v[64:67], a[116:119], v[20:23], v[64:67]
  v_mfma_f32_16x16x32_bf16 v[68:71], a[172:175], v[20:23], v[68:71]
  ds_read_b128 v[16:19], v5 offset:5120
  s_waitcnt lgkmcnt(6)
  v_mfma_f32_16x16x32_bf16 v[40:43], a[8:11], v[24:27], v[40:43]
  v_mfma_f32_16x16x32_bf16 v[44:47], a[64:67], v[24:27], v[44:47]
  v_mfma_f32_16x16x32_bf16 v[48:51], a[120:123], v[24:27], v[48:51]
  v_mfma_f32_16x16x32_bf16 v[52:55], a[176:179], v[24:27], v[52:55]
  ds_read_b128 v[20:23], v5 offset:19456
  s_waitcnt lgkmcnt(6)
  v_mfma_f32_16x16x32_bf16 v[56:59], a[8:11], v[28:31], v[56:59]
  v_mfma_f32_16x16x32_bf16 v[60:63], a[64:67], v[28:31], v[60:63]
  v_mfma_f32_16x16x32_bf16 v[64:67], a[120:123], v[28:31], v[64:67]
  v_mfma_f32_16x16x32_bf16 v[68:71], a[176:179], v[28:31], v[68:71]
  ds_read_b128 v[24:27], v5 offset:6144
  s_waitcnt lgkmcnt(6)
  v_mfma_f32_16x16x32_bf16 v[40:43], a[12:15], v[32:35], v[40:43]
  v_mfma_f32_16x16x32_bf16 v[44:47], a[68:71], v[32:35], v[44:47]
  v_mfma_f32_16x16x32_bf16 v[48:51], a[124:127], v[32:35], v[48:51]
  v_mfma_f32_16x16x32_bf16 v[52:55], a[180:183], v[32:35], v[52:55]
  ds_read_b128 v[28:31], v5 offset:20480
  s_waitcnt lgkmcnt(6)
  v_mfma_f32_16x16x32_bf16 v[56:59], a[12:15], v[36:39], v[56:59]
  v_mfma_f32_16x16x32_bf16 v[60:63], a[68:71], v[36:39], v[60:63]
  v_mfma_f32_16x16x32_bf16 v[64:67], a[124:127], v[36:39], v[64:67]
  v_mfma_f32_16x16x32_bf16 v[68:71], a[180:183], v[36:39], v[68:71]
  ds_read_b128 v[32:35], v5 offset:7168
  s_waitcnt lgkmcnt(6)
  v_mfma_f32_16x16x32_bf16 v[40:43], a[16:19], v[8:11], v[40:43]
  v_mfma_f32_16x16x32_bf16 v[44:47], a[72:75], v[8:11], v[44:47]
  v_mfma_f32_16x16x32_bf16 v[48:51], a[128:131], v[8:11], v[48:51]
  v_mfma_f32_16x16x32_bf16 v[52:55], a[184:187], v[8:11], v[52:55]
  ds_read_b128 v[36:39], v5 offset:21504
  s_waitcnt lgkmcnt(6)
  v_mfma_f32_16x16x32_bf16 v[56:59], a[16:19], v[12:15], v[56:59]
  v_mfma_f32_16x16x32_bf16 v[60:63], a[72:75], v[12:15], v[60:63]
  v_mfma_f32_16x16x32_bf16 v[64:67], a[128:131], v[12:15], v[64:67]
  v_mfma_f32_16x16x32_bf16 v[68:71], a[184:187], v[12:15], v[68:71]
  ds_read_b128 v[8:11], v5 offset:8192
  s_waitcnt lgkmcnt(6)
  v_mfma_f32_16x16x32_bf16 v[40:43], a[20:23], v[16:19], v[40:43]
  v_mfma_f32_16x16x32_bf16 v[44:47], a[76:79], v[16:19], v[44:47]
  v_mfma_f32_16x16x32_bf16 v[48:51], a[132:135], v[16:19], v[48:51]
  v_mfma_f32_16x16x32_bf16 v[52:55], a[188:191], v[16:19], v[52:55]
  ds_read_b128 v[12:15], v5 offset:22528
  s_waitcnt lgkmcnt(6)
  v_mfma_f32_16x16x32_bf16 v[56:59], a[20:23], v[20:23], v[56:59]
  v_mfma_f32_16x16x32_bf16 v[60:63], a[76:79], v[20:23], v[60:63]
  v_mfma_f32_16x16x32_bf16 v[64:67], a[132:135], v[20:23], v[64:67]
  v_mfma_f32_16x16x32_bf16 v[68:71], a[188:191], v[20:23], v[68:71]
  ds_read_b128 v[16:19], v5 offset:9216
  s_waitcnt lgkmcnt(6)
  v_mfma_f32_16x16x32_bf16 v[40:43], a[24:27], v[24:27], v[40:43]
  v_mfma_f32_16x16x32_bf16 v[44:47], a[80:83], v[24:27], v[44:47]
  v_mfma_f32_16x16x32_bf16 v[48:51], a[136:139], v[24:27], v[48:51]
  v_mfma_f32_16x16x32_bf16 v[52:55], a[192:195], v[24:27], v[52:55]
  ds_read_b128 v[20:23], v5 offset:23552
  s_waitcnt lgkmcnt(6)
  v_mfma_f32_16x16x32_bf16 v[56:59], a[24:27], v[28:31], v[56:59]
  v_mfma_f32_16x16x32_bf16 v[60:63], a[80:83], v[28:31], v[60:63]
  v_mfma_f32_16x16x32_bf16 v[64:67], a[136:139], v[28:31], v[64:67]
  v_mfma_f32_16x16x32_bf16 v[68:71], a[192:195], v[28:31], v[68:71]
  ds_read_b128 v[24:27], v5 offset:10240
  s_waitcnt lgkmcnt(6)
  v_mfma_f32_16x16x32_bf16 v[40:43], a[28:31], v[32:35], v[40:43]
  v_mfma_f32_16x16x32_bf16 v[44:47], a[84:87], v[32:35], v[44:47]
  v_mfma_f32_16x16x32_bf16 v[48:51], a[140:143], v[32:35], v[48:51]
  v_mfma_f32_16x16x32_bf16 v[52:55], a[196:199], v[32:35], v[52:55]
  ds_read_b128 v[28:31], v5 offset:24576
  s_waitcnt lgkmcnt(6)
  v_mfma_f32_16x16x32_bf16 v[56:59], a[28:31], v[36:39], v[56:59]
  v_mfma_f32_16x16x32_bf16 v[60:63], a[84:87], v[36:39], v[60:63]
  v_mfma_f32_16x16x32_bf16 v[64:67], a[140:143], v[36:39], v[64:67]
  v_mfma_f32_16x16x32_bf16 v[68:71], a[196:199], v[36:39], v[68:71]
  ds_read_b128 v[32:35], v5 offset:11264
  s_waitcnt lgkmcnt(6)
  v_mfma_f32_16x16x32_bf16 v[40:43], a[32:35], v[8:11], v[40:43]
  v_mfma_f32_16x16x32_bf16 v[44:47], a[88:91], v[8:11], v[44:47]
  v_mfma_f32_16x16x32_bf16 v[48:51], a[144:147], v[8:11], v[48:51]
  v_mfma_f32_16x16x32_bf16 v[52:55], a[200:203], v[8:11], v[52:55]
  ds_read_b128 v[36:39], v5 offset:25600
  s_waitcnt lgkmcnt(6)
  v_mfma_f32_16x16x32_bf16 v[56:59], a[32:35], v[12:15], v[56:59]
  v_mfma_f32_16x16x32_bf16 v[60:63], a[88:91], v[12:15], v[60:63]
  v_mfma_f32_16x16x32_bf16 v[64:67], a[144:147], v[12:15], v[64:67]
  v_mfma_f32_16x16x32_bf16 v[68:71], a[200:203], v[12:15], v[68:71]
  ds_read_b128 v[8:11], v5 offset:12288
  s_waitcnt lgkmcnt(6)
  v_mfma_f32_16x16x32_bf16 v[40:43], a[36:39], v[16:19], v[40:43]
  v_mfma_f32_16x16x32_bf16 v[44:47], a[92:95], v[16:19], v[44:47]
  v_mfma_f32_16x16x32_bf16 v[48:51], a[148:151], v[16:19], v[48:51]
  v_mfma_f32_16x16x32_bf16 v[52:55], a[204:207], v[16:19], v[52:55]
  ds_read_b128 v[12:15], v5 offset:26624
  s_waitcnt lgkmcnt(6)
  v_mfma_f32_16x16x32_bf16 v[56:59], a[36:39], v[20:23], v[56:59]
  v_mfma_f32_16x16x32_bf16 v[60:63], a[92:95], v[20:23], v[60:63]
  v_mfma_f32_16x16x32_bf16 v[64:67], a[148:151], v[20:23], v[64:67]
  v_mfma_f32_16x16x32_bf16 v[68:71], a[204:207], v[20:23], v[68:71]
  ds_read_b128 v[16:19], v5 offset:13312
  s_waitcnt lgkmcnt(6)
  v_mfma_f32_16x16x32_bf16 v[40:43], a[40:43], v[24:27], v[40:43]
  v_mfma_f32_16x16x32_bf16 v[44:47], a[96:99], v[24:27], v[44:47]
  v_mfma_f32_16x16x32_bf16 v[48:51], a[152:155], v[24:27], v[48:51]
  v_mfma_f32_16x16x32_bf16 v[52:55], a[208:211], v[24:27], v[52:55]
  ds_read_b128 v[20:23], v5 offset:27648
  s_waitcnt lgkmcnt(6)
  v_mfma_f32_16x16x32_bf16 v[56:59], a[40:43], v[28:31], v[56:59]
  v_mfma_f32_16x16x32_bf16 v[60:63], a[96:99], v[28:31], v[60:63]
  v_mfma_f32_16x16x32_bf16 v[64:67], a[152:155], v[28:31], v[64:67]
  v_mfma_f32_16x16x32_bf16 v[68:71], a[208:211], v[28:31], v[68:71]
  s_waitcnt lgkmcnt(5)
  v_mfma_f32_16x16x32_bf16 v[40:43], a[44:47], v[32:35], v[40:43]
  v_mfma_f32_16x16x32_bf16 v[44:47], a[100:103], v[32:35], v[44:47]
  v_mfma_f32_16x16x32_bf16 v[48:51], a[156:159], v[32:35], v[48:51]
  v_mfma_f32_16x16x32_bf16 v[52:55], a[212:215], v[32:35], v[52:55]
  s_waitcnt lgkmcnt(4)
  v_mfma_f32_16x16x32_bf16 v[56:59], a[44:47], v[36:39], v[56:59]
  v_mfma_f32_16x16x32_bf16 v[60:63], a[100:103], v[36:39], v[60:63]
  v_mfma_f32_16x16x32_bf16 v[64:67], a[156:159], v[36:39], v[64:67]
  v_mfma_f32_16x16x32_bf16 v[68:71], a[212:215], v[36:39], v[68:71]
  s_waitcnt lgkmcnt(3)
  v_mfma_f32_16x16x32_bf16 v[40:43], a[48:51], v[8:11], v[40:43]
  v_mfma_f32_16x16x32_bf16 v[44:47], a[104:107], v[8:11], v[44:47]
  v_mfma_f32_16x16x32_bf16 v[48:51], a[160:163], v[8:11], v[48:51]
  v_mfma_f32_16x16x32_bf16 v[52:55], a[216:219], v[8:11], v[52:55]
  s_waitcnt lgkmcnt(2)
  v_mfma_f32_16x16x32_bf16 v[56:59], a[48:51], v[12:15], v[56:59]
  v_mfma_f32_16x16x32_bf16 v[60:63], a[104:107], v[12:15], v[60:63]
  v_mfma_f32_16x16x32_bf16 v[64:67], a[160:163], v[12:15], v[64:67]
  v_mfma_f32_16x16x32_bf16 v[68:71], a[216:219], v[12:15], v[68:71]
  s_waitcnt lgkmcnt(1)
  v_mfma_f32_16x16x32_bf16 v[40:43], a[52:55], v[16:19], v[40:43]
  v_mfma_f32_16x16x32_bf16 v[44:47], a[108:111], v[16:19], v[44:47]
  v_mfma_f32_16x16x32_bf16 v[48:51], a[164:167], v[16:19], v[48:51]
  v_mfma_f32_16x16x32_bf16 v[52:55], a[220:223], v[16:19], v[52:55]
  s_waitcnt lgkmcnt(0)
  v_mfma_f32_16x16x32_bf16 v[56:59], a[52:55], v[20:23], v[56:59]
  v_mfma_f32_16x16x32_bf16 v[60:63], a[108:111], v[20:23], v[60:63]
  v_mfma_f32_16x16x32_bf16 v[64:67], a[164:167], v[20:23], v[64:67]
  v_mfma_f32_16x16x32_bf16 v[68:71], a[220:223], v[20:23], v[68:71]
  s_add_u32 s25, s29, 28672
  s_lshl_b32 s24, s19, 5
  s_add_u32 s24, s24, 0
  v_add_u32 v88, s24, v4
  v_mul_u32_u24 v89, 2341, v88
  v_lshrrev_b32 v89, 16, v89
  v_mul_u32_u24 v92, 28, v89
  v_sub_u32 v92, v88, v92
  v_cmp_gt_u32 vcc, 16, v92
  v_mul_u32_u24 v89, 84, v89
  s_nop 0
  v_cndmask_b32 v92, v7, v6, vcc
  v_add3_u32 v88, v88, v89, v92
  v_lshlrev_b32 v90, 4, v88
  v_cvt_pk_bf16_f32 v72, v40, v41
  v_cvt_pk_bf16_f32 v73, v42, v43
  v_cvt_pk_bf16_f32 v74, v44, v45
  v_cvt_pk_bf16_f32 v75, v46, v47
  buffer_store_dwordx4 v[72:75], v90, s[8:11], s29 offen sc1
  v_cvt_pk_bf16_f32 v76, v48, v49
  v_cvt_pk_bf16_f32 v77, v50, v51
  v_cvt_pk_bf16_f32 v78, v52, v53
  v_cvt_pk_bf16_f32 v79, v54, v55
  buffer_store_dwordx4 v[76:79], v90, s[8:11], s25 offen sc1
  s_lshl_b32 s24, s19, 5
  s_add_u32 s24, s24, 16
  v_add_u32 v88, s24, v4
  v_mul_u32_u24 v89, 2341, v88
  v_lshrrev_b32 v89, 16, v89
  v_mul_u32_u24 v92, 28, v89
  v_sub_u32 v92, v88, v92
  v_cmp_gt_u32 vcc, 16, v92
  v_mul_u32_u24 v89, 84, v89
  s_nop 0
  v_cndmask_b32 v92, v7, v6, vcc
  v_add3_u32 v88, v88, v89, v92
  v_lshlrev_b32 v91, 4, v88
  v_cvt_pk_bf16_f32 v80, v56, v57
  v_cvt_pk_bf16_f32 v81, v58, v59
  v_cvt_pk_bf16_f32 v82, v60, v61
  v_cvt_pk_bf16_f32 v83, v62, v63
  buffer_store_dwordx4 v[80:83], v91, s[8:11], s29 offen sc1
  v_cvt_pk_bf16_f32 v84, v64, v65
  v_cvt_pk_bf16_f32 v85, v66, v67
  v_cvt_pk_bf16_f32 v86, v68, v69
  v_cvt_pk_bf16_f32 v87, v70, v71
  buffer_store_dwordx4 v[84:87], v91, s[8:11], s25 offen sc1
  s_mov_b32 s33, s32
  s_add_u32 s32, s32, 28672
  s_cmp_eq_u32 s32, 86016
  s_cselect_b32 s32, 0, s32
  s_add_u32 s19, s19, 1
  s_cmp_lt_u32 s19, s35
  s_cbranch_scc1 wg_vo_loop
  s_branch wg_done
wg_done:
  s_lshl_b32 s20, s18, 4
  s_and_b32 s21, s17, 15
  s_add_u32 s20, s20, s21
  s_lshl_b32 s20, s20, 7
  s_cmp_lt_u32 s17, 16
  s_cselect_b32 s21, 16384, 0
  s_add_u32 s20, s20, s21
  s_add_u32 s20, s20, 88541184
  s_sub_u32 s21, s35, s34
  v_mov_b32 v5, s21
  v_mov_b32 v6, 0
  s_waitcnt vmcnt(0)
  s_mov_b64 exec, 1
  buffer_atomic_add v5, v6, s[8:11], s20 offen
  s_mov_b64 exec, -1
  s_branch wk_loop
wk_a:
  s_load_dwordx8 s[36:43], s[0:1], 56
  s_load_dwordx4 s[44:47], s[0:1], 88
  s_sub_u32 s3, s3, 432
  s_and_b32 s17, s3, 15
  s_lshr_b32 s19, s3, 5
  s_bitcmp1_b32 s3, 4
  s_cselect_b32 s31, 7, 0
  s_waitcnt lgkmcnt(0)
  s_mov_b32 s60, s40
  s_and_b32 s61, s41, 0xffff
  s_mov_b32 s62, 3670016
  s_mov_b32 s63, 0x20000
  s_mov_b32 s56, s42
  s_and_b32 s57, s43, 0xffff
  s_mov_b32 s58, 3670016
  s_mov_b32 s59, 0x20000
  s_lshl_b32 s30, s16, 13
  s_lshl_b32 s27, s19, 19
  s_lshl_b32 s29, s16, 17
  s_add_u32 s27, s27, s29
  s_lshl_b32 s29, s17, 9
  s_add_u32 s27, s27, s29
  v_lshrrev_b32 v5, 5, v1
  v_and_b32 v6, 31, v1
  v_xor_b32 v6, v6, v5
  v_lshlrev_b32 v6, 4, v6
  v_lshl_add_u32 v6, v5, 13, v6
  s_add_u32 m0, s30, 0
  s_add_u32 s22, s27, 0
  v_xor_b32 v7, 0, v6
  buffer_load_dwordx4 v7, s[56:59], s22 offen offset:0 lds
  s_add_u32 s22, s27, 15360
  v_xor_b32 v7, 32, v6
  buffer_load_dwordx4 v7, s[56:59], s22 offen offset:1024 lds
  s_add_u32 s22, s27, 30720
  v_xor_b32 v7, 64, v6
  buffer_load_dwordx4 v7, s[56:59], s22 offen offset:2048 lds
  s_add_u32 s22, s27, 46080
  v_xor_b32 v7, 96, v6
  buffer_load_dwordx4 v7, s[56:59], s22 offen offset:3072 lds
  s_add_u32 m0, s30, 4096
  s_add_u32 s22, s27, 65536
  v_xor_b32 v7, 128, v6
  buffer_load_dwordx4 v7, s[56:59], s22 offen offset:0 lds
  s_add_u32 s22, s27, 80896
  v_xor_b32 v7, 160, v6
  buffer_load_dwordx4 v7, s[56:59], s22 offen offset:1024 lds
  s_add_u32 s22, s27, 96256
  v_xor_b32 v7, 192, v6
  buffer_load_dwordx4 v7, s[56:59], s22 offen offset:2048 lds
  s_add_u32 s22, s27, 111616
  v_xor_b32 v7, 224, v6
  buffer_load_dwordx4 v7, s[56:59], s22 offen offset:3072 lds
  v_lshrrev_b32 v5, 5, v1
  v_and_b32 v6, 31, v1
  s_lshl_b32 s25, s16, 15
  s_add_u32 s25, s25, 32768
  s_lshl_b32 s26, s17, 9
  s_add_u32 s28, s19, s16
  s_cmp_ge_u32 s28, 7
  s_cselect_b32 s20, 7, 0
  s_sub_u32 s28, s28, s20
  s_add_u32 s28, s28, s31
  s_add_u32 s29, s19, s16
  s_add_u32 s29, s29, 4
  s_cmp_ge_u32 s29, 7
  s_cselect_b32 s20, 7, 0
  s_sub_u32 s29, s29, s20
  s_add_u32 s29, s29, s31
  s_lshl_b32 s32, s28, 18
  s_add_u32 s32, s32, s26
  s_lshl_b32 s33, s29, 18
  s_add_u32 s33, s33, s26
  v_xor_b32 v8, v6, v5
  v_lshlrev_b32 v8, 4, v8
  v_lshl_add_u32 v8, v5, 13, v8
  v_xor_b32 v12, 0, v8
  v_xor_b32 v13, 32, v8
  v_add_u32 v13, 15360, v13
  v_xor_b32 v14, 0, v8
  v_add_u32 v14, 30720, v14
  v_xor_b32 v15, 32, v8
  v_add_u32 v15, 46080, v15
  s_add_u32 s20, s16, 0
  s_and_b32 s20, s20, 3
  s_mul_i32 s21, s20, 65600
  s_lshl_b32 s20, s20, 12
  s_add_u32 s48, s20, s25
  s_mov_b32 m0, s48
  v_xor_b32 v16, s21, v12
  buffer_load_dwordx4 v16, s[60:63], s32 offen offset:0 lds
  v_xor_b32 v17, s21, v13
  buffer_load_dwordx4 v17, s[60:63], s32 offen offset:1024 lds
  v_xor_b32 v18, s21, v14
  buffer_load_dwordx4 v18, s[60:63], s32 offen offset:2048 lds
  v_xor_b32 v19, s21, v15
  buffer_load_dwordx4 v19, s[60:63], s32 offen offset:3072 lds
  s_add_u32 s20, s16, 1
  s_and_b32 s20, s20, 3
  s_mul_i32 s21, s20, 65600
  s_lshl_b32 s20, s20, 12
  s_add_u32 s49, s20, s25
  s_mov_b32 m0, s49
  v_xor_b32 v20, s21, v12
  buffer_load_dwordx4 v20, s[60:63], s32 offen offset:0 lds
  v_xor_b32 v21, s21, v13
  buffer_load_dwordx4 v21, s[60:63], s32 offen offset:1024 lds
  v_xor_b32 v22, s21, v14
  buffer_load_dwordx4 v22, s[60:63], s32 offen offset:2048 lds
  v_xor_b32 v23, s21, v15
  buffer_load_dwordx4 v23, s[60:63], s32 offen offset:3072 lds
  s_add_u32 s20, s16, 2
  s_and_b32 s20, s20, 3
  s_mul_i32 s21, s20, 65600
  s_lshl_b32 s20, s20, 12
  s_add_u32 s50, s20, s25
  s_mov_b32 m0, s50
  v_xor_b32 v24, s21, v12
  buffer_load_dwordx4 v24, s[60:63], s32 offen offset:0 lds
  v_xor_b32 v25, s21, v13
  buffer_load_dwordx4 v25, s[60:63], s32 offen offset:1024 lds
  v_xor_b32 v26, s21, v14
  buffer_load_dwordx4 v26, s[60:63], s32 offen offset:2048 lds
  v_xor_b32 v27, s21, v15
  buffer_load_dwordx4 v27, s[60:63], s32 offen offset:3072 lds
  s_add_u32 s20, s16, 3
  s_and_b32 s20, s20, 3
  s_mul_i32 s21, s20, 65600
  s_lshl_b32 s20, s20, 12
  s_add_u32 s51, s20, s25
  s_mov_b32 m0, s51
  v_xor_b32 v28, s21, v12
  buffer_load_dwordx4 v28, s[60:63], s32 offen offset:0 lds
  v_xor_b32 v29, s21, v13
  buffer_load_dwordx4 v29, s[60:63], s32 offen offset:1024 lds
  v_xor_b32 v30, s21, v14
  buffer_load_dwordx4 v30, s[60:63], s32 offen offset:2048 lds
  v_xor_b32 v31, s21, v15
  buffer_load_dwordx4 v31, s[60:63], s32 offen offset:3072 lds
  s_mul_i32 s30, s17, 401408
  s_mul_i32 s20, s19, 57344
  s_add_u32 s30, s30, s20
  v_add_u32 v12, s30, v2
  v_add_u32 v13, 14336, v12
  v_add_u32 v14, 28672, v12
  v_add_u32 v15, 43008, v12
  v_lshrrev_b32 v7, 2, v4
  v_lshlrev_b32 v7, 3, v7
  v_and_b32 v8, 3, v4
  v_add_u32 v7, v7, v8
  v_xor_b32 v10, v3, v4
  v_lshlrev_b32 v10, 4, v10
  v_lshl_add_u32 v10, v7, 9, v10
  v_add_u32 v10, s25, v10
  v_xor_b32 v32, 0, v10
  v_xor_b32 v33, 64, v10
  v_xor_b32 v34, 128, v10
  v_xor_b32 v35, 192, v10
  v_and_b32 v8, 2, v4
  v_lshlrev_b32 v8, 1, v8
  v_and_b32 v9, 1, v4
  v_add_u32 v8, v8, v9
  v_lshrrev_b32 v7, 2, v4
  v_lshl_add_u32 v7, v7, 4, v8
  v_xor_b32 v8, v8, v3
  v_lshlrev_b32 v8, 4, v8
  v_lshl_add_u32 v7, v7, 9, v8
  s_mov_b32 s24, 1035512379
  s_waitcnt vmcnt(16)
  s_barrier
  s_cmp_eq_u32 s16, 3
  s_cbranch_scc1 aj_np0
  s_add_u32 m0, s48, 16384
  s_nop 0
  buffer_load_dwordx4 v16, s[60:63], s33 offen offset:0 lds
  buffer_load_dwordx4 v17, s[60:63], s33 offen offset:1024 lds
  buffer_load_dwordx4 v18, s[60:63], s33 offen offset:2048 lds
  buffer_load_dwordx4 v19, s[60:63], s33 offen offset:3072 lds
aj_np0:
  v_xor_b32 v8, 0, v7
  ds_read_b128 v[128:131], v8 offset:0
  v_xor_b32 v9, 64, v7
  ds_read_b128 v[132:135], v9 offset:0
  v_xor_b32 v10, 128, v7
  ds_read_b128 v[136:139], v10 offset:0
  v_xor_b32 v11, 192, v7
  ds_read_b128 v[140:143], v11 offset:0
  ds_read_b128 v[144:147], v8 offset:256
  ds_read_b128 v[148:151], v9 offset:256
  ds_read_b128 v[152:155], v10 offset:256
  ds_read_b128 v[156:159], v11 offset:256
  s_waitcnt lgkmcnt(4)
  s_cmp_eq_u32 s16, 3
  s_cbranch_scc1 aj_np1
  s_add_u32 m0, s49, 16384
  s_nop 0
  buffer_load_dwordx4 v20, s[60:63], s33 offen offset:0 lds
  buffer_load_dwordx4 v21, s[60:63], s33 offen offset:1024 lds
  buffer_load_dwordx4 v22, s[60:63], s33 offen offset:2048 lds
  buffer_load_dwordx4 v23, s[60:63], s33 offen offset:3072 lds
aj_np1:
  v_xor_b32 v8, 32, v7
  ds_read_b128 v[160:163], v8 offset:1024
  v_xor_b32 v9, 96, v7
  ds_read_b128 v[164:167], v9 offset:1024
  v_xor_b32 v10, 160, v7
  ds_read_b128 v[168:171], v10 offset:1024
  v_xor_b32 v11, 224, v7
  ds_read_b128 v[172:175], v11 offset:1024
  ds_read_b128 v[176:179], v8 offset:1280
  ds_read_b128 v[180:183], v9 offset:1280
  ds_read_b128 v[184:187], v10 offset:1280
  ds_read_b128 v[188:191], v11 offset:1280
  s_waitcnt lgkmcnt(4)
  s_cmp_eq_u32 s16, 3
  s_cbranch_scc1 aj_np2
  s_add_u32 m0, s50, 16384
  s_nop 0
  buffer_load_dwordx4 v24, s[60:63], s33 offen offset:0 lds
  buffer_load_dwordx4 v25, s[60:63], s33 offen offset:1024 lds
  buffer_load_dwordx4 v26, s[60:63], s33 offen offset:2048 lds
  buffer_load_dwordx4 v27, s[60:63], s33 offen offset:3072 lds
aj_np2:
  v_xor_b32 v8, 128, v7
  ds_read_b128 v[192:195], v8 offset:4096
  v_xor_b32 v9, 192, v7
  ds_read_b128 v[196:199], v9 offset:4096
  v_xor_b32 v10, 0, v7
  ds_read_b128 v[200:203], v10 offset:4096
  v_xor_b32 v11, 64, v7
  ds_read_b128 v[204:207], v11 offset:4096
  ds_read_b128 v[208:211], v8 offset:4352
  ds_read_b128 v[212:215], v9 offset:4352
  ds_read_b128 v[216:219], v10 offset:4352
  ds_read_b128 v[220:223], v11 offset:4352
  s_waitcnt lgkmcnt(4)
  s_cmp_eq_u32 s16, 3
  s_cbranch_scc1 aj_np3
  s_add_u32 m0, s51, 16384
  s_nop 0
  buffer_load_dwordx4 v28, s[60:63], s33 offen offset:0 lds
  buffer_load_dwordx4 v29, s[60:63], s33 offen offset:1024 lds
  buffer_load_dwordx4 v30, s[60:63], s33 offen offset:2048 lds
  buffer_load_dwordx4 v31, s[60:63], s33 offen offset:3072 lds
aj_np3:
  v_xor_b32 v8, 160, v7
  ds_read_b128 v[224:227], v8 offset:5120
  v_xor_b32 v9, 224, v7
  ds_read_b128 v[228:231], v9 offset:5120
  v_xor_b32 v10, 32, v7
  ds_read_b128 v[232:235], v10 offset:5120
  v_xor_b32 v11, 96, v7
  ds_read_b128 v[236:239], v11 offset:5120
  ds_read_b128 v[240:243], v8 offset:5376
  ds_read_b128 v[244:247], v9 offset:5376
  ds_read_b128 v[248:251], v10 offset:5376
  ds_read_b128 v[252:255], v11 offset:5376
  s_waitcnt lgkmcnt(4)
  s_waitcnt vmcnt(16) lgkmcnt(0)
  s_cmp_lg_u32 s16, 3
  s_cbranch_scc1 w3_39
  s_waitcnt vmcnt(0)
w3_39:
  ds_read_b128 v[52:55], v32 offset:0
  ds_read_b128 v[56:59], v33 offset:0
  ds_read_b128 v[60:63], v34 offset:0
  ds_read_b128 v[64:67], v35 offset:0
  s_waitcnt lgkmcnt(3)
  v_mfma_f32_16x16x32_bf16 v[96:99], v[52:55], v[128:131], 0
  v_mfma_f32_16x16x32_bf16 v[100:103], v[52:55], v[160:163], 0
  v_mfma_f32_16x16x32_bf16 v[104:107], v[52:55], v[192:195], 0
  v_mfma_f32_16x16x32_bf16 v[108:111], v[52:55], v[224:227], 0
  ds_read_b128 v[52:55], v32 offset:256
  s_waitcnt lgkmcnt(3)
  v_mfma_f32_16x16x32_bf16 v[96:99], v[56:59], v[132:135], v[96:99]
  v_mfma_f32_16x16x32_bf16 v[100:103], v[56:59], v[164:167], v[100:103]
  v_mfma_f32_16x16x32_bf16 v[104:107], v[56:59], v[196:199], v[104:107]
  v_mfma_f32_16x16x32_bf16 v[108:111], v[56:59], v[228:231], v[108:111]
  ds_read_b128 v[56:59], v33 offset:256
  s_waitcnt lgkmcnt(3)
  v_mfma_f32_16x16x32_bf16 v[96:99], v[60:63], v[136:139], v[96:99]
  v_mfma_f32_16x16x32_bf16 v[100:103], v[60:63], v[168:171], v[100:103]
  v_mfma_f32_16x16x32_bf16 v[104:107], v[60:63], v[200:203], v[104:107]
  v_mfma_f32_16x16x32_bf16 v[108:111], v[60:63], v[232:235], v[108:111]
  ds_read_b128 v[60:63], v34 offset:256
  s_waitcnt lgkmcnt(3)
  v_mfma_f32_16x16x32_bf16 v[96:99], v[64:67], v[140:143], v[96:99]
  v_mfma_f32_16x16x32_bf16 v[100:103], v[64:67], v[172:175], v[100:103]
  v_mfma_f32_16x16x32_bf16 v[104:107], v[64:67], v[204:207], v[104:107]
  v_mfma_f32_16x16x32_bf16 v[108:111], v[64:67], v[236:239], v[108:111]
  ds_read_b128 v[64:67], v35 offset:256
  s_waitcnt lgkmcnt(3)
  v_mfma_f32_16x16x32_bf16 v[96:99], v[52:55], v[144:147], v[96:99]
  v_mfma_f32_16x16x32_bf16 v[100:103], v[52:55], v[176:179], v[100:103]
  v_mfma_f32_16x16x32_bf16 v[104:107], v[52:55], v[208:211], v[104:107]
  v_mfma_f32_16x16x32_bf16 v[108:111], v[52:55], v[240:243], v[108:111]
  ds_read_b128 v[52:55], v32 offset:2048
  s_waitcnt lgkmcnt(3)
  v_mfma_f32_16x16x32_bf16 v[96:99], v[56:59], v[148:151], v[96:99]
  v_mfma_f32_16x16x32_bf16 v[100:103], v[56:59], v[180:183], v[100:103]
  v_mfma_f32_16x16x32_bf16 v[104:107], v[56:59], v[212:215], v[104:107]
  v_mfma_f32_16x16x32_bf16 v[108:111], v[56:59], v[244:247], v[108:111]
  ds_read_b128 v[56:59], v33 offset:2048
  s_waitcnt lgkmcnt(3)
  v_mfma_f32_16x16x32_bf16 v[96:99], v[60:63], v[152:155], v[96:99]
  v_mfma_f32_16x16x32_bf16 v[100:103], v[60:63], v[184:187], v[100:103]
  v_mfma_f32_16x16x32_bf16 v[104:107], v[60:63], v[216:219], v[104:107]
  v_mfma_f32_16x16x32_bf16 v[108:111], v[60:63], v[248:251], v[108:111]
  ds_read_b128 v[60:63], v34 offset:2048
  s_waitcnt lgkmcnt(3)
  v_mfma_f32_16x16x32_bf16 v[96:99], v[64:67], v[156:159], v[96:99]
  v_mfma_f32_16x16x32_bf16 v[100:103], v[64:67], v[188:191], v[100:103]
  v_mfma_f32_16x16x32_bf16 v[104:107], v[64:67], v[220:223], v[104:107]
  v_mfma_f32_16x16x32_bf16 v[108:111], v[64:67], v[252:255], v[108:111]
  ds_read_b128 v[64:67], v35 offset:2048
  s_waitcnt lgkmcnt(3)
  v_mfma_f32_16x16x32_bf16 v[112:115], v[52:55], v[128:131], 0
  v_mfma_f32_16x16x32_bf16 v[116:119], v[52:55], v[160:163], 0
  v_mfma_f32_16x16x32_bf16 v[120:123], v[52:55], v[192:195], 0
  v_mfma_f32_16x16x32_bf16 v[124:127], v[52:55], v[224:227], 0
  ds_read_b128 v[52:55], v32 offset:2304
  s_waitcnt lgkmcnt(3)
  v_mfma_f32_16x16x32_bf16 v[112:115], v[56:59], v[132:135], v[112:115]
  v_mfma_f32_16x16x32_bf16 v[116:119], v[56:59], v[164:167], v[116:119]
  v_mfma_f32_16x16x32_bf16 v[120:123], v[56:59], v[196:199], v[120:123]
  v_mfma_f32_16x16x32_bf16 v[124:127], v[56:59], v[228:231], v[124:127]
  ds_read_b128 v[56:59], v33 offset:2304
  s_waitcnt lgkmcnt(3)
  v_mfma_f32_16x16x32_bf16 v[112:115], v[60:63], v[136:139], v[112:115]
  v_mfma_f32_16x16x32_bf16 v[116:119], v[60:63], v[168:171], v[116:119]
  v_mfma_f32_16x16x32_bf16 v[120:123], v[60:63], v[200:203], v[120:123]
  v_mfma_f32_16x16x32_bf16 v[124:127], v[60:63], v[232:235], v[124:127]
  ds_read_b128 v[60:63], v34 offset:2304
  s_waitcnt lgkmcnt(3)
  v_mfma_f32_16x16x32_bf16 v[112:115], v[64:67], v[140:143], v[112:115]
  v_mfma_f32_16x16x32_bf16 v[116:119], v[64:67], v[172:175], v[116:119]
  v_mfma_f32_16x16x32_bf16 v[120:123], v[64:67], v[204:207], v[120:123]
  v_mfma_f32_16x16x32_bf16 v[124:127], v[64:67], v[236:239], v[124:127]
  ds_read_b128 v[64:67], v35 offset:2304
  s_waitcnt lgkmcnt(3)
  v_mfma_f32_16x16x32_bf16 v[112:115], v[52:55], v[144:147], v[112:115]
  v_mfma_f32_16x16x32_bf16 v[116:119], v[52:55], v[176:179], v[116:119]
  v_mfma_f32_16x16x32_bf16 v[120:123], v[52:55], v[208:211], v[120:123]
  v_mfma_f32_16x16x32_bf16 v[124:127], v[52:55], v[240:243], v[124:127]
  s_waitcnt lgkmcnt(2)
  v_mfma_f32_16x16x32_bf16 v[112:115], v[56:59], v[148:151], v[112:115]
  v_mfma_f32_16x16x32_bf16 v[116:119], v[56:59], v[180:183], v[116:119]
  v_mfma_f32_16x16x32_bf16 v[120:123], v[56:59], v[212:215], v[120:123]
  v_mfma_f32_16x16x32_bf16 v[124:127], v[56:59], v[244:247], v[124:127]
  s_waitcnt lgkmcnt(1)
  v_mfma_f32_16x16x32_bf16 v[112:115], v[60:63], v[152:155], v[112:115]
  v_mfma_f32_16x16x32_bf16 v[116:119], v[60:63], v[184:187], v[116:119]
  v_mfma_f32_16x16x32_bf16 v[120:123], v[60:63], v[216:219], v[120:123]
  v_mfma_f32_16x16x32_bf16 v[124:127], v[60:63], v[248:251], v[124:127]
  s_waitcnt lgkmcnt(0)
  v_mfma_f32_16x16x32_bf16 v[112:115], v[64:67], v[156:159], v[112:115]
  v_mfma_f32_16x16x32_bf16 v[116:119], v[64:67], v[188:191], v[116:119]
  v_mfma_f32_16x16x32_bf16 v[120:123], v[64:67], v[220:223], v[120:123]
  v_mfma_f32_16x16x32_bf16 v[124:127], v[64:67], v[252:255], v[124:127]
  s_lshl_b32 s30, s28, 10
  v_mul_f32 v96, s24, v96
  v_mul_f32 v97, s24, v97
  v_mul_f32 v98, s24, v98
  v_mul_f32 v99, s24, v99
  v_cvt_pk_bf16_f32 v68, v96, v97
  v_cvt_pk_bf16_f32 v69, v98, v99
  v_mul_f32 v112, s24, v112
  v_mul_f32 v113, s24, v113
  v_mul_f32 v114, s24, v114
  v_mul_f32 v115, s24, v115
  v_cvt_pk_bf16_f32 v70, v112, v113
  v_cvt_pk_bf16_f32 v71, v114, v115
  buffer_store_dwordx4 v[68:71], v12, s[8:11], s30 offen sc1
  v_mul_f32 v100, s24, v100
  v_mul_f32 v101, s24, v101
  v_mul_f32 v102, s24, v102
  v_mul_f32 v103, s24, v103
  v_cvt_pk_bf16_f32 v72, v100, v101
  v_cvt_pk_bf16_f32 v73, v102, v103
  v_mul_f32 v116, s24, v116
  v_mul_f32 v117, s24, v117
  v_mul_f32 v118, s24, v118
  v_mul_f32 v119, s24, v119
  v_cvt_pk_bf16_f32 v74, v116, v117
  v_cvt_pk_bf16_f32 v75, v118, v119
  buffer_store_dwordx4 v[72:75], v13, s[8:11], s30 offen sc1
  v_mul_f32 v104, s24, v104
  v_mul_f32 v105, s24, v105
  v_mul_f32 v106, s24, v106
  v_mul_f32 v107, s24, v107
  v_cvt_pk_bf16_f32 v76, v104, v105
  v_cvt_pk_bf16_f32 v77, v106, v107
  v_mul_f32 v120, s24, v120
  v_mul_f32 v121, s24, v121
  v_mul_f32 v122, s24, v122
  v_mul_f32 v123, s24, v123
  v_cvt_pk_bf16_f32 v78, v120, v121
  v_cvt_pk_bf16_f32 v79, v122, v123
  buffer_store_dwordx4 v[76:79], v14, s[8:11], s30 offen sc1
  v_mul_f32 v108, s24, v108
  v_mul_f32 v109, s24, v109
  v_mul_f32 v110, s24, v110
  v_mul_f32 v111, s24, v111
  v_cvt_pk_bf16_f32 v80, v108, v109
  v_cvt_pk_bf16_f32 v81, v110, v111
  v_mul_f32 v124, s24, v124
  v_mul_f32 v125, s24, v125
  v_mul_f32 v126, s24, v126
  v_mul_f32 v127, s24, v127
  v_cvt_pk_bf16_f32 v82, v124, v125
  v_cvt_pk_bf16_f32 v83, v126, v127
  buffer_store_dwordx4 v[80:83], v15, s[8:11], s30 offen sc1
  s_cmp_eq_u32 s16, 3
  s_cbranch_scc1 aj_w3
  s_waitcnt vmcnt(4)
  ds_read_b128 v[52:55], v32 offset:16384
  ds_read_b128 v[56:59], v33 offset:16384
  ds_read_b128 v[60:63], v34 offset:16384
  ds_read_b128 v[64:67], v35 offset:16384
  s_waitcnt lgkmcnt(3)
  v_mfma_f32_16x16x32_bf16 v[96:99], v[52:55], v[128:131], 0
  v_mfma_f32_16x16x32_bf16 v[100:103], v[52:55], v[160:163], 0
  v_mfma_f32_16x16x32_bf16 v[104:107], v[52:55], v[192:195], 0
  v_mfma_f32_16x16x32_bf16 v[108:111], v[52:55], v[224:227], 0
  ds_read_b128 v[52:55], v32 offset:16640
  s_waitcnt lgkmcnt(3)
  v_mfma_f32_16x16x32_bf16 v[96:99], v[56:59], v[132:135], v[96:99]
  v_mfma_f32_16x16x32_bf16 v[100:103], v[56:59], v[164:167], v[100:103]
  v_mfma_f32_16x16x32_bf16 v[104:107], v[56:59], v[196:199], v[104:107]
  v_mfma_f32_16x16x32_bf16 v[108:111], v[56:59], v[228:231], v[108:111]
  ds_read_b128 v[56:59], v33 offset:16640
  s_waitcnt lgkmcnt(3)
  v_mfma_f32_16x16x32_bf16 v[96:99], v[60:63], v[136:139], v[96:99]
  v_mfma_f32_16x16x32_bf16 v[100:103], v[60:63], v[168:171], v[100:103]
  v_mfma_f32_16x16x32_bf16 v[104:107], v[60:63], v[200:203], v[104:107]
  v_mfma_f32_16x16x32_bf16 v[108:111], v[60:63], v[232:235], v[108:111]
  ds_read_b128 v[60:63], v34 offset:16640
  s_waitcnt lgkmcnt(3)
  v_mfma_f32_16x16x32_bf16 v[96:99], v[64:67], v[140:143], v[96:99]
  v_mfma_f32_16x16x32_bf16 v[100:103], v[64:67], v[172:175], v[100:103]
  v_mfma_f32_16x16x32_bf16 v[104:107], v[64:67], v[204:207], v[104:107]
  v_mfma_f32_16x16x32_bf16 v[108:111], v[64:67], v[236:239], v[108:111]
  ds_read_b128 v[64:67], v35 offset:16640
  s_waitcnt lgkmcnt(3)
  v_mfma_f32_16x16x32_bf16 v[96:99], v[52:55], v[144:147], v[96:99]
  v_mfma_f32_16x16x32_bf16 v[100:103], v[52:55], v[176:179], v[100:103]
  v_mfma_f32_16x16x32_bf16 v[104:107], v[52:55], v[208:211], v[104:107]
  v_mfma_f32_16x16x32_bf16 v[108:111], v[52:55], v[240:243], v[108:111]
  ds_read_b128 v[52:55], v32 offset:18432
  s_waitcnt lgkmcnt(3)
  v_mfma_f32_16x16x32_bf16 v[96:99], v[56:59], v[148:151], v[96:99]
  v_mfma_f32_16x16x32_bf16 v[100:103], v[56:59], v[180:183], v[100:103]
  v_mfma_f32_16x16x32_bf16 v[104:107], v[56:59], v[212:215], v[104:107]
  v_mfma_f32_16x16x32_bf16 v[108:111], v[56:59], v[244:247], v[108:111]
  ds_read_b128 v[56:59], v33 offset:18432
  s_waitcnt lgkmcnt(3)
  v_mfma_f32_16x16x32_bf16 v[96:99], v[60:63], v[152:155], v[96:99]
  v_mfma_f32_16x16x32_bf16 v[100:103], v[60:63], v[184:187], v[100:103]
  v_mfma_f32_16x16x32_bf16 v[104:107], v[60:63], v[216:219], v[104:107]
  v_mfma_f32_16x16x32_bf16 v[108:111], v[60:63], v[248:251], v[108:111]
  ds_read_b128 v[60:63], v34 offset:18432
  s_waitcnt lgkmcnt(3)
  v_mfma_f32_16x16x32_bf16 v[96:99], v[64:67], v[156:159], v[96:99]
  v_mfma_f32_16x16x32_bf16 v[100:103], v[64:67], v[188:191], v[100:103]
  v_mfma_f32_16x16x32_bf16 v[104:107], v[64:67], v[220:223], v[104:107]
  v_mfma_f32_16x16x32_bf16 v[108:111], v[64:67], v[252:255], v[108:111]
  ds_read_b128 v[64:67], v35 offset:18432
  s_waitcnt lgkmcnt(3)
  v_mfma_f32_16x16x32_bf16 v[112:115], v[52:55], v[128:131], 0
  v_mfma_f32_16x16x32_bf16 v[116:119], v[52:55], v[160:163], 0
  v_mfma_f32_16x16x32_bf16 v[120:123], v[52:55], v[192:195], 0
  v_mfma_f32_16x16x32_bf16 v[124:127], v[52:55], v[224:227], 0
  ds_read_b128 v[52:55], v32 offset:18688
  s_waitcnt lgkmcnt(3)
  v_mfma_f32_16x16x32_bf16 v[112:115], v[56:59], v[132:135], v[112:115]
  v_mfma_f32_16x16x32_bf16 v[116:119], v[56:59], v[164:167], v[116:119]
  v_mfma_f32_16x16x32_bf16 v[120:123], v[56:59], v[196:199], v[120:123]
  v_mfma_f32_16x16x32_bf16 v[124:127], v[56:59], v[228:231], v[124:127]
  ds_read_b128 v[56:59], v33 offset:18688
  s_waitcnt lgkmcnt(3)
  v_mfma_f32_16x16x32_bf16 v[112:115], v[60:63], v[136:139], v[112:115]
  v_mfma_f32_16x16x32_bf16 v[116:119], v[60:63], v[168:171], v[116:119]
  v_mfma_f32_16x16x32_bf16 v[120:123], v[60:63], v[200:203], v[120:123]
  v_mfma_f32_16x16x32_bf16 v[124:127], v[60:63], v[232:235], v[124:127]
  ds_read_b128 v[60:63], v34 offset:18688
  s_waitcnt lgkmcnt(3)
  v_mfma_f32_16x16x32_bf16 v[112:115], v[64:67], v[140:143], v[112:115]
  v_mfma_f32_16x16x32_bf16 v[116:119], v[64:67], v[172:175], v[116:119]
  v_mfma_f32_16x16x32_bf16 v[120:123], v[64:67], v[204:207], v[120:123]
  v_mfma_f32_16x16x32_bf16 v[124:127], v[64:67], v[236:239], v[124:127]
  ds_read_b128 v[64:67], v35 offset:18688
  s_waitcnt lgkmcnt(3)
  v_mfma_f32_16x16x32_bf16 v[112:115], v[52:55], v[144:147], v[112:115]
  v_mfma_f32_16x16x32_bf16 v[116:119], v[52:55], v[176:179], v[116:119]
  v_mfma_f32_16x16x32_bf16 v[120:123], v[52:55], v[208:211], v[120:123]
  v_mfma_f32_16x16x32_bf16 v[124:127], v[52:55], v[240:243], v[124:127]
  s_waitcnt lgkmcnt(2)
  v_mfma_f32_16x16x32_bf16 v[112:115], v[56:59], v[148:151], v[112:115]
  v_mfma_f32_16x16x32_bf16 v[116:119], v[56:59], v[180:183], v[116:119]
  v_mfma_f32_16x16x32_bf16 v[120:123], v[56:59], v[212:215], v[120:123]
  v_mfma_f32_16x16x32_bf16 v[124:127], v[56:59], v[244:247], v[124:127]
  s_waitcnt lgkmcnt(1)
  v_mfma_f32_16x16x32_bf16 v[112:115], v[60:63], v[152:155], v[112:115]
  v_mfma_f32_16x16x32_bf16 v[116:119], v[60:63], v[184:187], v[116:119]
  v_mfma_f32_16x16x32_bf16 v[120:123], v[60:63], v[216:219], v[120:123]
  v_mfma_f32_16x16x32_bf16 v[124:127], v[60:63], v[248:251], v[124:127]
  s_waitcnt lgkmcnt(0)
  v_mfma_f32_16x16x32_bf16 v[112:115], v[64:67], v[156:159], v[112:115]
  v_mfma_f32_16x16x32_bf16 v[116:119], v[64:67], v[188:191], v[116:119]
  v_mfma_f32_16x16x32_bf16 v[120:123], v[64:67], v[220:223], v[120:123]
  v_mfma_f32_16x16x32_bf16 v[124:127], v[64:67], v[252:255], v[124:127]
  s_lshl_b32 s30, s29, 10
  v_mul_f32 v96, s24, v96
  v_mul_f32 v97, s24, v97
  v_mul_f32 v98, s24, v98
  v_mul_f32 v99, s24, v99
  v_cvt_pk_bf16_f32 v68, v96, v97
  v_cvt_pk_bf16_f32 v69, v98, v99
  v_mul_f32 v112, s24, v112
  v_mul_f32 v113, s24, v113
  v_mul_f32 v114, s24, v114
  v_mul_f32 v115, s24, v115
  v_cvt_pk_bf16_f32 v70, v112, v113
  v_cvt_pk_bf16_f32 v71, v114, v115
  buffer_store_dwordx4 v[68:71], v12, s[8:11], s30 offen sc1
  v_mul_f32 v100, s24, v100
  v_mul_f32 v101, s24, v101
  v_mul_f32 v102, s24, v102
  v_mul_f32 v103, s24, v103
  v_cvt_pk_bf16_f32 v72, v100, v101
  v_cvt_pk_bf16_f32 v73, v102, v103
  v_mul_f32 v116, s24, v116
  v_mul_f32 v117, s24, v117
  v_mul_f32 v118, s24, v118
  v_mul_f32 v119, s24, v119
  v_cvt_pk_bf16_f32 v74, v116, v117
  v_cvt_pk_bf16_f32 v75, v118, v119
  buffer_store_dwordx4 v[72:75], v13, s[8:11], s30 offen sc1
  v_mul_f32 v104, s24, v104
  v_mul_f32 v105, s24, v105
  v_mul_f32 v106, s24, v106
  v_mul_f32 v107, s24, v107
  v_cvt_pk_bf16_f32 v76, v104, v105
  v_cvt_pk_bf16_f32 v77, v106, v107
  v_mul_f32 v120, s24, v120
  v_mul_f32 v121, s24, v121
  v_mul_f32 v122, s24, v122
  v_mul_f32 v123, s24, v123
  v_cvt_pk_bf16_f32 v78, v120, v121
  v_cvt_pk_bf16_f32 v79, v122, v123
  buffer_store_dwordx4 v[76:79], v14, s[8:11], s30 offen sc1
  v_mul_f32 v108, s24, v108
  v_mul_f32 v109, s24, v109
  v_mul_f32 v110, s24, v110
  v_mul_f32 v111, s24, v111
  v_cvt_pk_bf16_f32 v80, v108, v109
  v_cvt_pk_bf16_f32 v81, v110, v111
  v_mul_f32 v124, s24, v124
  v_mul_f32 v125, s24, v125
  v_mul_f32 v126, s24, v126
  v_mul_f32 v127, s24, v127
  v_cvt_pk_bf16_f32 v82, v124, v125
  v_cvt_pk_bf16_f32 v83, v126, v127
  buffer_store_dwordx4 v[80:83], v15, s[8:11], s30 offen sc1
aj_w3:
  s_lshl_b32 s28, s17, 7
  s_lshl_b32 s21, s19, 4
  s_add_u32 s28, s28, s21
  s_cmp_lg_u32 s31, 0
  s_cselect_b32 s21, 8, 0
  s_add_u32 s28, s28, s21
  s_add_u32 s28, s28, 88633344
  s_waitcnt vmcnt(0)
  s_barrier
  s_cmp_lg_u32 s16, 0
  s_cbranch_scc1 pub_40
  v_mul_u32_u24 v26, 2048, v1
  v_mov_b32 v24, s88
  v_mov_b32 v25, s89
  s_mov_b64 exec, 1
  buffer_store_dwordx2 v[24:25], v26, s[8:11], s28 offen sc1
  s_mov_b64 exec, -1
pub_40:
  v_mov_b32 v250, 0
  s_branch wk_loop
wk_srv:
  s_sub_u32 s3, s3, 224
  s_and_b32 s18, s3, 15
  s_lshr_b32 s19, s3, 4
  s_and_b32 s19, s19, 1
  s_mul_i32 s20, s18, 401408
  s_mul_i32 s21, s16, 100352
  s_add_u32 s20, s20, s21
  s_add_u32 s20, s20, 6422528
  s_add_u32 s22, s20, 0
  buffer_load_dwordx4 a[0:3], v2, s[8:11], s22 offen offset:0 sc1
  buffer_load_dwordx4 a[4:7], v2, s[8:11], s22 offen offset:1024 sc1
  buffer_load_dwordx4 a[8:11], v2, s[8:11], s22 offen offset:2048 sc1
  buffer_load_dwordx4 a[12:15], v2, s[8:11], s22 offen offset:3072 sc1
  s_add_u32 s22, s20, 4096
  buffer_load_dwordx4 a[16:19], v2, s[8:11], s22 offen offset:0 sc1
  buffer_load_dwordx4 a[20:23], v2, s[8:11], s22 offen offset:1024 sc1
  buffer_load_dwordx4 a[24:27], v2, s[8:11], s22 offen offset:2048 sc1
  buffer_load_dwordx4 a[28:31], v2, s[8:11], s22 offen offset:3072 sc1
  s_add_u32 s22, s20, 8192
  buffer_load_dwordx4 a[32:35], v2, s[8:11], s22 offen offset:0 sc1
  buffer_load_dwordx4 a[36:39], v2, s[8:11], s22 offen offset:1024 sc1
  buffer_load_dwordx4 a[40:43], v2, s[8:11], s22 offen offset:2048 sc1
  buffer_load_dwordx4 a[44:47], v2, s[8:11], s22 offen offset:3072 sc1
  s_add_u32 s22, s20, 12288
  buffer_load_dwordx4 a[48:51], v2, s[8:11], s22 offen offset:0 sc1
  buffer_load_dwordx4 a[52:55], v2, s[8:11], s22 offen offset:1024 sc1
  buffer_load_dwordx4 a[56:59], v2, s[8:11], s22 offen offset:2048 sc1
  buffer_load_dwordx4 a[60:63], v2, s[8:11], s22 offen offset:3072 sc1
  s_add_u32 s22, s20, 16384
  buffer_load_dwordx4 a[64:67], v2, s[8:11], s22 offen offset:0 sc1
  buffer_load_dwordx4 a[68:71], v2, s[8:11], s22 offen offset:1024 sc1
  buffer_load_dwordx4 a[72:75], v2, s[8:11], s22 offen offset:2048 sc1
  buffer_load_dwordx4 a[76:79], v2, s[8:11], s22 offen offset:3072 sc1
  s_add_u32 s22, s20, 20480
  buffer_load_dwordx4 a[80:83], v2, s[8:11], s22 offen offset:0 sc1
  buffer_load_dwordx4 a[84:87], v2, s[8:11], s22 offen offset:1024 sc1
  buffer_load_dwordx4 a[88:91], v2, s[8:11], s22 offen offset:2048 sc1
  buffer_load_dwordx4 a[92:95], v2, s[8:11], s22 offen offset:3072 sc1
  s_add_u32 s22, s20, 24576
  buffer_load_dwordx4 a[96:99], v2, s[8:11], s22 offen offset:0 sc1
  buffer_load_dwordx4 a[100:103], v2, s[8:11], s22 offen offset:1024 sc1
  buffer_load_dwordx4 a[104:107], v2, s[8:11], s22 offen offset:2048 sc1
  buffer_load_dwordx4 a[108:111], v2, s[8:11], s22 offen offset:3072 sc1
  s_add_u32 s22, s20, 28672
  buffer_load_dwordx4 a[112:115], v2, s[8:11], s22 offen offset:0 sc1
  buffer_load_dwordx4 a[116:119], v2, s[8:11], s22 offen offset:1024 sc1
  buffer_load_dwordx4 a[120:123], v2, s[8:11], s22 offen offset:2048 sc1
  buffer_load_dwordx4 a[124:127], v2, s[8:11], s22 offen offset:3072 sc1
  s_waitcnt vmcnt(24)
  s_add_u32 s22, s20, 32768
  buffer_load_dwordx4 a[128:131], v2, s[8:11], s22 offen offset:0 sc1
  buffer_load_dwordx4 a[132:135], v2, s[8:11], s22 offen offset:1024 sc1
  buffer_load_dwordx4 a[136:139], v2, s[8:11], s22 offen offset:2048 sc1
  buffer_load_dwordx4 a[140:143], v2, s[8:11], s22 offen offset:3072 sc1
  s_add_u32 s22, s20, 36864
  buffer_load_dwordx4 a[144:147], v2, s[8:11], s22 offen offset:0 sc1
  buffer_load_dwordx4 a[148:151], v2, s[8:11], s22 offen offset:1024 sc1
  buffer_load_dwordx4 a[152:155], v2, s[8:11], s22 offen offset:2048 sc1
  buffer_load_dwordx4 a[156:159], v2, s[8:11], s22 offen offset:3072 sc1
  s_add_u32 s22, s20, 40960
  buffer_load_dwordx4 a[160:163], v2, s[8:11], s22 offen offset:0 sc1
  buffer_load_dwordx4 a[164:167], v2, s[8:11], s22 offen offset:1024 sc1
  buffer_load_dwordx4 a[168:171], v2, s[8:11], s22 offen offset:2048 sc1
  buffer_load_dwordx4 a[172:175], v2, s[8:11], s22 offen offset:3072 sc1
  s_add_u32 s22, s20, 45056
  buffer_load_dwordx4 a[176:179], v2, s[8:11], s22 offen offset:0 sc1
  buffer_load_dwordx4 a[180:183], v2, s[8:11], s22 offen offset:1024 sc1
  buffer_load_dwordx4 a[184:187], v2, s[8:11], s22 offen offset:2048 sc1
  buffer_load_dwordx4 a[188:191], v2, s[8:11], s22 offen offset:3072 sc1
  s_add_u32 s22, s20, 49152
  buffer_load_dwordx4 a[192:195], v2, s[8:11], s22 offen offset:0 sc1
  buffer_load_dwordx4 a[196:199], v2, s[8:11], s22 offen offset:1024 sc1
  buffer_load_dwordx4 a[200:203], v2, s[8:11], s22 offen offset:2048 sc1
  buffer_load_dwordx4 a[204:207], v2, s[8:11], s22 offen offset:3072 sc1
  s_add_u32 s22, s20, 53248
  buffer_load_dwordx4 a[208:211], v2, s[8:11], s22 offen offset:0 sc1
  buffer_load_dwordx4 a[212:215], v2, s[8:11], s22 offen offset:1024 sc1
  buffer_load_dwordx4 a[216:219], v2, s[8:11], s22 offen offset:2048 sc1
  buffer_load_dwordx4 a[220:223], v2, s[8:11], s22 offen offset:3072 sc1
  s_add_u32 s22, s20, 57344
  buffer_load_dwordx4 a[224:227], v2, s[8:11], s22 offen offset:0 sc1
  buffer_load_dwordx4 a[228:231], v2, s[8:11], s22 offen offset:1024 sc1
  buffer_load_dwordx4 a[232:235], v2, s[8:11], s22 offen offset:2048 sc1
  buffer_load_dwordx4 a[236:239], v2, s[8:11], s22 offen offset:3072 sc1
  s_add_u32 s22, s20, 61440
  buffer_load_dwordx4 a[240:243], v2, s[8:11], s22 offen offset:0 sc1
  buffer_load_dwordx4 a[244:247], v2, s[8:11], s22 offen offset:1024 sc1
  buffer_load_dwordx4 a[248:251], v2, s[8:11], s22 offen offset:2048 sc1
  buffer_load_dwordx4 a[252:255], v2, s[8:11], s22 offen offset:3072 sc1
  s_waitcnt vmcnt(24)
  s_add_u32 s22, s20, 65536
  buffer_load_dwordx4 v[120:123], v2, s[8:11], s22 offen offset:0 sc1
  buffer_load_dwordx4 v[124:127], v2, s[8:11], s22 offen offset:1024 sc1
  buffer_load_dwordx4 v[128:131], v2, s[8:11], s22 offen offset:2048 sc1
  buffer_load_dwordx4 v[132:135], v2, s[8:11], s22 offen offset:3072 sc1
  s_add_u32 s22, s20, 69632
  buffer_load_dwordx4 v[136:139], v2, s[8:11], s22 offen offset:0 sc1
  buffer_load_dwordx4 v[140:143], v2, s[8:11], s22 offen offset:1024 sc1
  buffer_load_dwordx4 v[144:147], v2, s[8:11], s22 offen offset:2048 sc1
  buffer_load_dwordx4 v[148:151], v2, s[8:11], s22 offen offset:3072 sc1
  s_add_u32 s22, s20, 73728
  buffer_load_dwordx4 v[152:155], v2, s[8:11], s22 offen offset:0 sc1
  buffer_load_dwordx4 v[156:159], v2, s[8:11], s22 offen offset:1024 sc1
  buffer_load_dwordx4 v[160:163], v2, s[8:11], s22 offen offset:2048 sc1
  buffer_load_dwordx4 v[164:167], v2, s[8:11], s22 offen offset:3072 sc1
  s_add_u32 s22, s20, 77824
  buffer_load_dwordx4 v[168:171], v2, s[8:11], s22 offen offset:0 sc1
  buffer_load_dwordx4 v[172:175], v2, s[8:11], s22 offen offset:1024 sc1
  buffer_load_dwordx4 v[176:179], v2, s[8:11], s22 offen offset:2048 sc1
  buffer_load_dwordx4 v[180:183], v2, s[8:11], s22 offen offset:3072 sc1
  s_add_u32 s22, s20, 81920
  buffer_load_dwordx4 v[184:187], v2, s[8:11], s22 offen offset:0 sc1
  buffer_load_dwordx4 v[188:191], v2, s[8:11], s22 offen offset:1024 sc1
  buffer_load_dwordx4 v[192:195], v2, s[8:11], s22 offen offset:2048 sc1
  buffer_load_dwordx4 v[196:199], v2, s[8:11], s22 offen offset:3072 sc1
  s_add_u32 s22, s20, 86016
  buffer_load_dwordx4 v[200:203], v2, s[8:11], s22 offen offset:0 sc1
  buffer_load_dwordx4 v[204:207], v2, s[8:11], s22 offen offset:1024 sc1
  buffer_load_dwordx4 v[208:211], v2, s[8:11], s22 offen offset:2048 sc1
  buffer_load_dwordx4 v[212:215], v2, s[8:11], s22 offen offset:3072 sc1
  s_add_u32 s22, s20, 90112
  buffer_load_dwordx4 v[216:219], v2, s[8:11], s22 offen offset:0 sc1
  buffer_load_dwordx4 v[220:223], v2, s[8:11], s22 offen offset:1024 sc1
  buffer_load_dwordx4 v[224:227], v2, s[8:11], s22 offen offset:2048 sc1
  buffer_load_dwordx4 v[228:231], v2, s[8:11], s22 offen offset:3072 sc1
  s_add_u32 s22, s20, 94208
  buffer_load_dwordx4 v[232:235], v2, s[8:11], s22 offen offset:0 sc1
  buffer_load_dwordx4 v[236:239], v2, s[8:11], s22 offen offset:1024 sc1
  buffer_load_dwordx4 v[240:243], v2, s[8:11], s22 offen offset:2048 sc1
  buffer_load_dwordx4 v[244:247], v2, s[8:11], s22 offen offset:3072 sc1
  s_waitcnt vmcnt(24)
  s_add_u32 s22, s20, 98304
  buffer_load_dwordx4 v[248:251], v2, s[8:11], s22 offen offset:0 sc1
  buffer_load_dwordx4 v[252:255], v2, s[8:11], s22 offen offset:1024 sc1
  v_mov_b32 v5, 0x4444
  v_mov_b32 v6, 0xeeee
  v_cmp_lt_u32 vcc, 7, v4
  s_nop 1
  v_cndmask_b32 v5, v5, v6, vcc
  s_lshl_b32 s23, s16, 11
  v_lshrrev_b32 v80, 1, v3
  v_and_b32 v81, 1, v3
  v_add_u32 v82, 0, v80
  v_lshl_add_u32 v82, v82, 4, v4
  v_mul_u32_u24 v83, 2341, v82
  v_lshrrev_b32 v83, 16, v83
  v_mul_u32_u24 v84, 28, v83
  v_sub_u32 v84, v82, v84
  v_lshrrev_b32 v85, 4, v84
  v_and_b32 v84, 15, v84
  v_lshlrev_b32 v86, 10, v85
  v_lshl_add_u32 v86, v83, 8, v86
  v_lshl_add_u32 v86, v84, 4, v86
  v_lshl_add_u32 v86, v81, 3, v86
  v_add_u32 v72, s23, v86
  v_add_u32 v82, 2, v80
  v_lshl_add_u32 v82, v82, 4, v4
  v_mul_u32_u24 v83, 2341, v82
  v_lshrrev_b32 v83, 16, v83
  v_mul_u32_u24 v84, 28, v83
  v_sub_u32 v84, v82, v84
  v_lshrrev_b32 v85, 4, v84
  v_and_b32 v84, 15, v84
  v_lshlrev_b32 v86, 10, v85
  v_lshl_add_u32 v86, v83, 8, v86
  v_lshl_add_u32 v86, v84, 4, v86
  v_lshl_add_u32 v86, v81, 3, v86
  v_add_u32 v73, s23, v86
  v_add_u32 v82, 4, v80
  v_lshl_add_u32 v82, v82, 4, v4
  v_mul_u32_u24 v83, 2341, v82
  v_lshrrev_b32 v83, 16, v83
  v_mul_u32_u24 v84, 28, v83
  v_sub_u32 v84, v82, v84
  v_lshrrev_b32 v85, 4, v84
  v_and_b32 v84, 15, v84
  v_lshlrev_b32 v86, 10, v85
  v_lshl_add_u32 v86, v83, 8, v86
  v_lshl_add_u32 v86, v84, 4, v86
  v_lshl_add_u32 v86, v81, 3, v86
  v_add_u32 v74, s23, v86
  v_mov_b32 v82, 6
  v_lshl_add_u32 v82, v82, 4, v4
  v_mul_u32_u24 v83, 2341, v82
  v_lshrrev_b32 v83, 16, v83
  v_mul_u32_u24 v84, 28, v83
  v_sub_u32 v84, v82, v84
  v_lshrrev_b32 v85, 4, v84
  v_and_b32 v84, 15, v84
  v_lshlrev_b32 v86, 10, v85
  v_lshl_add_u32 v86, v83, 8, v86
  v_lshl_add_u32 v86, v84, 4, v86
  v_lshl_add_u32 v86, v81, 3, v86
  v_add_u32 v75, s23, v86
  v_add_u32 v76, s23, v2
  s_mul_i32 s27, s18, 448
  v_mov_b32 v77, s27
  v_mov_b32 v78, 1
  s_mov_b32 s17, s19
  s_mul_i32 s24, s19, 7168
  s_add_u32 s24, s24, 88080384
  s_mul_i32 s25, s18, 65
  s_add_u32 s25, s25, s19
  s_lshl_b32 s25, s25, 13
  s_add_u32 s25, s25, s23
  s_add_u32 s25, s25, 76947456
  s_lshl_b32 s26, s18, 6
  s_add_u32 s26, s26, s19
  s_lshl_b32 s26, s26, 4
  s_lshl_b32 s27, s16, 2
  s_add_u32 s26, s26, s27
  s_add_u32 s26, s26, 88582144
  v_mov_b32 v87, -1
ws_loop:
  v_mov_b32 v36, 0
  v_mov_b32 v37, 0
  v_mov_b32 v38, 0
  v_mov_b32 v39, 0
  v_mov_b32 v40, 0
  v_mov_b32 v41, 0
  v_mov_b32 v42, 0
  v_mov_b32 v43, 0
  v_mov_b32 v44, 0
  v_mov_b32 v45, 0
  v_mov_b32 v46, 0
  v_mov_b32 v47, 0
  v_mov_b32 v48, 0
  v_mov_b32 v49, 0
  v_mov_b32 v50, 0
  v_mov_b32 v51, 0
  v_mov_b32 v52, 0
  v_mov_b32 v53, 0
  v_mov_b32 v54, 0
  v_mov_b32 v55, 0
  v_mov_b32 v56, 0
  v_mov_b32 v57, 0
  v_mov_b32 v58, 0
  v_mov_b32 v59, 0
  v_mov_b32 v60, 0
  v_mov_b32 v61, 0
  v_mov_b32 v62, 0
  v_mov_b32 v63, 0
  s_mov_b32 s30, 0
  v_cmp_eq_u32 vcc, -1, v87
  s_cbranch_vccz ws_fl
ws_pm:
  s_cmp_ge_u32 s17, 61
  s_cbranch_scc1 mp_41a
  v_mov_b32 v79, 0
  s_mov_b64 exec, 1
  buffer_atomic_or v79, v77, s[8:11], s24 offen sc0
  s_mov_b64 exec, -1
  s_branch mp_41b
mp_41a:
  buffer_load_dword v79, v77, s[8:11], s24 offen sc1
mp_41b:
  s_waitcnt vmcnt(0)
  v_cmp_eq_u32 vcc, -1, v79
  s_cbranch_vccnz ws_pr
ws_fl:
  s_add_u32 s22, s24, 4096
  buffer_load_dwordx4 v[8:11], v2, s[8:11], s24 offen offset:0 sc1
  buffer_load_dwordx4 v[12:15], v2, s[8:11], s24 offen offset:1024 sc1
  buffer_load_dwordx4 v[16:19], v2, s[8:11], s24 offen offset:2048 sc1
  buffer_load_dwordx4 v[20:23], v2, s[8:11], s24 offen offset:3072 sc1
  buffer_load_dwordx4 v[24:27], v2, s[8:11], s22 offen offset:0 sc1
  buffer_load_dwordx4 v[28:31], v2, s[8:11], s22 offen offset:1024 sc1
  buffer_load_dwordx4 v[32:35], v2, s[8:11], s22 offen offset:2048 sc1
  s_waitcnt vmcnt(0)
  v_max_u32 v79, v8, v9
  v_max3_u32 v79, v79, v10, v11
  v_max3_u32 v79, v79, v12, v13
  v_max3_u32 v79, v79, v14, v15
  v_max3_u32 v79, v79, v16, v17
  v_max3_u32 v79, v79, v18, v19
  v_max3_u32 v79, v79, v20, v21
  v_max3_u32 v79, v79, v22, v23
  v_max3_u32 v79, v79, v24, v25
  v_max3_u32 v79, v79, v26, v27
  v_max3_u32 v79, v79, v28, v29
  v_max3_u32 v79, v79, v30, v31
  v_max3_u32 v79, v79, v32, v33
  v_max3_u32 v79, v79, v34, v35
  v_cmp_eq_u32 vcc, -1, v79
  s_cbranch_vccz ws_pk
ws_pr:
  s_sleep 1
  s_cmp_ge_u32 s17, 61
  s_cbranch_scc1 ws_sh
  s_sleep 6
ws_sh:
  s_add_u32 s30, s30, 1
  s_cmp_lt_u32 s30, 30000
  s_cbranch_scc1 ws_pm
  s_branch cA_abort
ws_pk:
  s_cmp_ge_u32 s17, 62
  s_cbranch_scc1 ws_na
  s_add_u32 s22, s24, 14336
  s_cmp_ge_u32 s17, 61
  s_cbranch_scc1 mp_42a
  v_mov_b32 v87, 0
  s_mov_b64 exec, 1
  buffer_atomic_or v87, v77, s[8:11], s22 offen sc0
  s_mov_b64 exec, -1
  s_branch mp_42b
mp_42a:
  buffer_load_dword v87, v77, s[8:11], s22 offen sc1
mp_42b:
ws_na:
  v_smfmac_f32_16x16x64_bf16 v[36:39], v[8:11], a[0:7], v5
  v_smfmac_f32_16x16x64_bf16 v[36:39], v[12:15], a[8:15], v5
  v_smfmac_f32_16x16x64_bf16 v[36:39], v[16:19], a[16:23], v5
  v_smfmac_f32_16x16x64_bf16 v[36:39], v[20:23], a[24:31], v5
  v_smfmac_f32_16x16x64_bf16 v[36:39], v[24:27], a[32:39], v5
  v_smfmac_f32_16x16x64_bf16 v[36:39], v[28:31], a[40:47], v5
  v_smfmac_f32_16x16x64_bf16 v[36:39], v[32:35], a[48:55], v5
  v_smfmac_f32_16x16x64_bf16 v[40:43], v[8:11], a[56:63], v5
  v_smfmac_f32_16x16x64_bf16 v[40:43], v[12:15], a[64:71], v5
  v_smfmac_f32_16x16x64_bf16 v[40:43], v[16:19], a[72:79], v5
  v_smfmac_f32_16x16x64_bf16 v[40:43], v[20:23], a[80:87], v5
  v_smfmac_f32_16x16x64_bf16 v[40:43], v[24:27], a[88:95], v5
  v_smfmac_f32_16x16x64_bf16 v[40:43], v[28:31], a[96:103], v5
  v_smfmac_f32_16x16x64_bf16 v[40:43], v[32:35], a[104:111], v5
  v_smfmac_f32_16x16x64_bf16 v[44:47], v[8:11], a[112:119], v5
  v_smfmac_f32_16x16x64_bf16 v[44:47], v[12:15], a[120:127], v5
  v_smfmac_f32_16x16x64_bf16 v[44:47], v[16:19], a[128:135], v5
  v_smfmac_f32_16x16x64_bf16 v[44:47], v[20:23], a[136:143], v5
  v_smfmac_f32_16x16x64_bf16 v[44:47], v[24:27], a[144:151], v5
  v_smfmac_f32_16x16x64_bf16 v[44:47], v[28:31], a[152:159], v5
  v_smfmac_f32_16x16x64_bf16 v[44:47], v[32:35], a[160:167], v5
  v_smfmac_f32_16x16x64_bf16 v[48:51], v[8:11], a[168:175], v5
  v_smfmac_f32_16x16x64_bf16 v[48:51], v[12:15], a[176:183], v5
  v_smfmac_f32_16x16x64_bf16 v[48:51], v[16:19], a[184:191], v5
  v_smfmac_f32_16x16x64_bf16 v[48:51], v[20:23], a[192:199], v5
  v_smfmac_f32_16x16x64_bf16 v[48:51], v[24:27], a[200:207], v5
  v_smfmac_f32_16x16x64_bf16 v[48:51], v[28:31], a[208:215], v5
  v_smfmac_f32_16x16x64_bf16 v[48:51], v[32:35], a[216:223], v5
  v_smfmac_f32_16x16x64_bf16 v[52:55], v[8:11], a[224:231], v5
  v_smfmac_f32_16x16x64_bf16 v[52:55], v[12:15], a[232:239], v5
  v_smfmac_f32_16x16x64_bf16 v[52:55], v[16:19], a[240:247], v5
  v_smfmac_f32_16x16x64_bf16 v[52:55], v[20:23], a[248:255], v5
  v_smfmac_f32_16x16x64_bf16 v[52:55], v[24:27], v[120:127], v5
  v_smfmac_f32_16x16x64_bf16 v[52:55], v[28:31], v[128:135], v5
  v_smfmac_f32_16x16x64_bf16 v[52:55], v[32:35], v[136:143], v5
  v_smfmac_f32_16x16x64_bf16 v[56:59], v[8:11], v[144:151], v5
  v_smfmac_f32_16x16x64_bf16 v[56:59], v[12:15], v[152:159], v5
  v_smfmac_f32_16x16x64_bf16 v[56:59], v[16:19], v[160:167], v5
  v_smfmac_f32_16x16x64_bf16 v[56:59], v[20:23], v[168:175], v5
  v_smfmac_f32_16x16x64_bf16 v[56:59], v[24:27], v[176:183], v5
  v_smfmac_f32_16x16x64_bf16 v[56:59], v[28:31], v[184:191], v5
  v_smfmac_f32_16x16x64_bf16 v[56:59], v[32:35], v[192:199], v5
  v_smfmac_f32_16x16x64_bf16 v[60:63], v[8:11], v[200:207], v5
  v_smfmac_f32_16x16x64_bf16 v[60:63], v[12:15], v[208:215], v5
  v_smfmac_f32_16x16x64_bf16 v[60:63], v[16:19], v[216:223], v5
  v_smfmac_f32_16x16x64_bf16 v[60:63], v[20:23], v[224:231], v5
  v_smfmac_f32_16x16x64_bf16 v[60:63], v[24:27], v[232:239], v5
  v_smfmac_f32_16x16x64_bf16 v[60:63], v[28:31], v[240:247], v5
  v_smfmac_f32_16x16x64_bf16 v[60:63], v[32:35], v[248:255], v5
  v_permlane32_swap_b32 v36, v40
  v_permlane32_swap_b32 v37, v41
  v_permlane32_swap_b32 v38, v42
  v_permlane32_swap_b32 v39, v43
  v_add_f32 v36, v36, v40
  v_add_f32 v37, v37, v41
  v_add_f32 v38, v38, v42
  v_add_f32 v39, v39, v43
  v_cvt_pk_bf16_f32 v40, v36, v37
  v_cvt_pk_bf16_f32 v41, v38, v39
  ds_write_b64 v72, v[40:41]
  v_permlane32_swap_b32 v44, v48
  v_permlane32_swap_b32 v45, v49
  v_permlane32_swap_b32 v46, v50
  v_permlane32_swap_b32 v47, v51
  v_add_f32 v44, v44, v48
  v_add_f32 v45, v45, v49
  v_add_f32 v46, v46, v50
  v_add_f32 v47, v47, v51
  v_cvt_pk_bf16_f32 v48, v44, v45
  v_cvt_pk_bf16_f32 v49, v46, v47
  ds_write_b64 v73, v[48:49]
  v_permlane32_swap_b32 v52, v56
  v_permlane32_swap_b32 v53, v57
  v_permlane32_swap_b32 v54, v58
  v_permlane32_swap_b32 v55, v59
  v_add_f32 v52, v52, v56
  v_add_f32 v53, v53, v57
  v_add_f32 v54, v54, v58
  v_add_f32 v55, v55, v59
  v_cvt_pk_bf16_f32 v56, v52, v53
  v_cvt_pk_bf16_f32 v57, v54, v55
  ds_write_b64 v74, v[56:57]
  v_mov_b32 v64, v60
  v_mov_b32 v65, v61
  v_mov_b32 v66, v62
  v_mov_b32 v67, v63
  v_permlane32_swap_b32 v60, v64
  v_permlane32_swap_b32 v61, v65
  v_permlane32_swap_b32 v62, v66
  v_permlane32_swap_b32 v63, v67
  v_add_f32 v60, v60, v64
  v_add_f32 v61, v61, v65
  v_add_f32 v62, v62, v66
  v_add_f32 v63, v63, v67
  v_cvt_pk_bf16_f32 v64, v60, v61
  v_cvt_pk_bf16_f32 v65, v62, v63
  ds_write_b64 v75, v[64:65]
  s_waitcnt lgkmcnt(0)
  ds_read_b128 v[64:67], v76
  ds_read_b128 v[68:71], v76 offset:1024
  s_waitcnt lgkmcnt(0)
  buffer_store_dwordx4 v[64:67], v2, s[8:11], s25 offen sc1
  buffer_store_dwordx4 v[68:71], v2, s[8:11], s25 offen offset:1024 sc1
  s_waitcnt vmcnt(0)
  s_mov_b64 exec, 1
  buffer_store_dword v78, v2, s[8:11], s26 offen sc1
  s_mov_b64 exec, -1
  s_add_u32 s24, s24, 14336
  s_add_u32 s25, s25, 16384
  s_add_u32 s26, s26, 32
  s_add_u32 s17, s17, 2
  s_cmp_lt_u32 s17, 64
  s_cbranch_scc1 ws_loop
  v_mov_b32 v250, 0
  s_branch wk_loop
wk_s4d:
  s_cmp_lg_u32 s16, 0
  s_cbranch_scc1 w0_43
  s_getreg_b32 s20, hwreg(HW_REG_XCC_ID)
  s_sub_u32 s20, s20, 1
  s_and_b32 s20, s20, 7
  s_mov_b64 exec, 1
s4_l:
  s_cmp_ge_u32 s20, 7
  s_cselect_b32 s20, 0, s20
  s_lshl_b32 s21, s20, 7
  s_add_u32 s21, s21, 88598528
  v_mov_b32 v242, 1
  buffer_atomic_add v242, off, s[8:11], s21 sc0
  s_waitcnt vmcnt(0)
  v_readfirstlane_b32 s21, v242
  s_lshl_b32 s22, s20, 4
  s_add_u32 s20, s20, 1
  s_cmp_ge_u32 s21, 16
  s_cbranch_scc1 s4_l
  v_add_u32 v242, s22, v242
  s_mov_b64 exec, -1
w0_43:
  v_mov_b32 v243, 160000
  s_add_u32 s101, s101, 1
  s_barrier
  s_mov_b64 exec, 1
  s_cmp_lg_u32 s16, 0
  s_cbranch_scc1 w0_44
  ds_write_b32 v243, v242 offset:0
  s_waitcnt lgkmcnt(0)
  v_mov_b32 v242, s101
  ds_write_b32 v243, v242 offset:16
  s_waitcnt lgkmcnt(0)
w0_44:
  s_mov_b64 exec, -1
  s_barrier
  ds_read_b32 v242, v243 offset:0
  ds_read_b32 v243, v243 offset:16
  s_waitcnt lgkmcnt(0)
  v_readfirstlane_b32 s3, v242
  v_cmp_ne_u32 vcc, s101, v243
  s_cbranch_vccnz ch_end
  s_load_dwordx8 s[40:47], s[0:1], 0
  s_load_dwordx4 s[48:51], s[0:1], 32
  s_load_dwordx2 s[52:53], s[0:1], 48
  s_load_dwordx2 s[54:55], s[0:1], 112
  v_lshrrev_b32 v1, 6, v0
  s_nop 0
  v_readfirstlane_b32 s16, v1
  v_and_b32 v1, 63, v0
  v_lshrrev_b32 v3, 4, v1
  v_and_b32 v4, 15, v1
  s_mul_i32 s17, s16, 24576
  s_waitcnt lgkmcnt(0)
  s_mov_b32 s60, s40
  s_and_b32 s61, s41, 0xffff
  s_mov_b32 s62, 1835008
  s_mov_b32 s63, 0x20000
  s_mov_b32 s64, s42
  s_and_b32 s65, s43, 0xffff
  s_mov_b32 s66, 229376
  s_mov_b32 s67, 0x20000
  s_mov_b32 s68, s44
  s_and_b32 s69, s45, 0xffff
  s_mov_b32 s70, 229376
  s_mov_b32 s71, 0x20000
  s_mov_b32 s72, s46
  s_and_b32 s73, s47, 0xffff
  s_mov_b32 s74, 229376
  s_mov_b32 s75, 0x20000
  s_mov_b32 s76, s48
  s_and_b32 s77, s49, 0xffff
  s_mov_b32 s78, 229376
  s_mov_b32 s79, 0x20000
  s_mov_b32 s80, s50
  s_and_b32 s81, s51, 0xffff
  s_mov_b32 s82, 896
  s_mov_b32 s83, 0x20000
  s_mov_b32 s84, s52
  s_and_b32 s85, s53, 0xffff
  s_mov_b32 s86, 896
  s_mov_b32 s87, 0x20000
  s_mov_b32 s92, s54
  s_and_b32 s93, s55, 0xffff
  s_mov_b32 s94, 3670016
  s_mov_b32 s95, 0x20000
  v_lshlrev_b32 v5, 5, v1
  v_sub_u32 v5, 2047, v5
  s_add_u32 s18, s17, 13056
  v_subrev_u32 v6, 0, v5
  v_max_i32 v7, 0, v6
  v_cvt_f32_u32 v7, v7
  v_cvt_pk_bf16_f32 v8, v7, v7
  v_and_b32 v7, 0xffff0000, v8
  v_lshrrev_b32 v8, 23, v7
  v_subrev_u32 v8, 134, v8
  v_max_i32 v8, 0, v8
  v_cvt_u32_f32 v7, v7
  v_lshrrev_b32 v7, v8, v7
  v_lshl_add_u32 v7, v8, 8, v7
  v_lshl_add_u32 v200, v7, 2, s18
  v_subrev_u32 v6, 1, v5
  v_max_i32 v7, 0, v6
  v_cvt_f32_u32 v7, v7
  v_cvt_pk_bf16_f32 v8, v7, v7
  v_and_b32 v7, 0xffff0000, v8
  v_lshrrev_b32 v8, 23, v7
  v_subrev_u32 v8, 134, v8
  v_max_i32 v8, 0, v8
  v_cvt_u32_f32 v7, v7
  v_lshrrev_b32 v7, v8, v7
  v_lshl_add_u32 v7, v8, 8, v7
  v_lshl_add_u32 v201, v7, 2, s18
  v_subrev_u32 v6, 2, v5
  v_max_i32 v7, 0, v6
  v_cvt_f32_u32 v7, v7
  v_cvt_pk_bf16_f32 v8, v7, v7
  v_and_b32 v7, 0xffff0000, v8
  v_lshrrev_b32 v8, 23, v7
  v_subrev_u32 v8, 134, v8
  v_max_i32 v8, 0, v8
  v_cvt_u32_f32 v7, v7
  v_lshrrev_b32 v7, v8, v7
  v_lshl_add_u32 v7, v8, 8, v7
  v_lshl_add_u32 v202, v7, 2, s18
  v_subrev_u32 v6, 3, v5
  v_max_i32 v7, 0, v6
  v_cvt_f32_u32 v7, v7
  v_cvt_pk_bf16_f32 v8, v7, v7
  v_and_b32 v7, 0xffff0000, v8
  v_lshrrev_b32 v8, 23, v7
  v_subrev_u32 v8, 134, v8
  v_max_i32 v8, 0, v8
  v_cvt_u32_f32 v7, v7
  v_lshrrev_b32 v7, v8, v7
  v_lshl_add_u32 v7, v8, 8, v7
  v_lshl_add_u32 v203, v7, 2, s18
  v_subrev_u32 v6, 4, v5
  v_max_i32 v7, 0, v6
  v_cvt_f32_u32 v7, v7
  v_cvt_pk_bf16_f32 v8, v7, v7
  v_and_b32 v7, 0xffff0000, v8
  v_lshrrev_b32 v8, 23, v7
  v_subrev_u32 v8, 134, v8
  v_max_i32 v8, 0, v8
  v_cvt_u32_f32 v7, v7
  v_lshrrev_b32 v7, v8, v7
  v_lshl_add_u32 v7, v8, 8, v7
  v_lshl_add_u32 v204, v7, 2, s18
  v_subrev_u32 v6, 5, v5
  v_max_i32 v7, 0, v6
  v_cvt_f32_u32 v7, v7
  v_cvt_pk_bf16_f32 v8, v7, v7
  v_and_b32 v7, 0xffff0000, v8
  v_lshrrev_b32 v8, 23, v7
  v_subrev_u32 v8, 134, v8
  v_max_i32 v8, 0, v8
  v_cvt_u32_f32 v7, v7
  v_lshrrev_b32 v7, v8, v7
  v_lshl_add_u32 v7, v8, 8, v7
  v_lshl_add_u32 v205, v7, 2, s18
  v_subrev_u32 v6, 6, v5
  v_max_i32 v7, 0, v6
  v_cvt_f32_u32 v7, v7
  v_cvt_pk_bf16_f32 v8, v7, v7
  v_and_b32 v7, 0xffff0000, v8
  v_lshrrev_b32 v8, 23, v7
  v_subrev_u32 v8, 134, v8
  v_max_i32 v8, 0, v8
  v_cvt_u32_f32 v7, v7
  v_lshrrev_b32 v7, v8, v7
  v_lshl_add_u32 v7, v8, 8, v7
  v_lshl_add_u32 v206, v7, 2, s18
  v_subrev_u32 v6, 7, v5
  v_max_i32 v7, 0, v6
  v_cvt_f32_u32 v7, v7
  v_cvt_pk_bf16_f32 v8, v7, v7
  v_and_b32 v7, 0xffff0000, v8
  v_lshrrev_b32 v8, 23, v7
  v_subrev_u32 v8, 134, v8
  v_max_i32 v8, 0, v8
  v_cvt_u32_f32 v7, v7
  v_lshrrev_b32 v7, v8, v7
  v_lshl_add_u32 v7, v8, 8, v7
  v_lshl_add_u32 v207, v7, 2, s18
  v_subrev_u32 v6, 8, v5
  v_max_i32 v7, 0, v6
  v_cvt_f32_u32 v7, v7
  v_cvt_pk_bf16_f32 v8, v7, v7
  v_and_b32 v7, 0xffff0000, v8
  v_lshrrev_b32 v8, 23, v7
  v_subrev_u32 v8, 134, v8
  v_max_i32 v8, 0, v8
  v_cvt_u32_f32 v7, v7
  v_lshrrev_b32 v7, v8, v7
  v_lshl_add_u32 v7, v8, 8, v7
  v_lshl_add_u32 v208, v7, 2, s18
  v_subrev_u32 v6, 9, v5
  v_max_i32 v7, 0, v6
  v_cvt_f32_u32 v7, v7
  v_cvt_pk_bf16_f32 v8, v7, v7
  v_and_b32 v7, 0xffff0000, v8
  v_lshrrev_b32 v8, 23, v7
  v_subrev_u32 v8, 134, v8
  v_max_i32 v8, 0, v8
  v_cvt_u32_f32 v7, v7
  v_lshrrev_b32 v7, v8, v7
  v_lshl_add_u32 v7, v8, 8, v7
  v_lshl_add_u32 v209, v7, 2, s18
  v_subrev_u32 v6, 10, v5
  v_max_i32 v7, 0, v6
  v_cvt_f32_u32 v7, v7
  v_cvt_pk_bf16_f32 v8, v7, v7
  v_and_b32 v7, 0xffff0000, v8
  v_lshrrev_b32 v8, 23, v7
  v_subrev_u32 v8, 134, v8
  v_max_i32 v8, 0, v8
  v_cvt_u32_f32 v7, v7
  v_lshrrev_b32 v7, v8, v7
  v_lshl_add_u32 v7, v8, 8, v7
  v_lshl_add_u32 v210, v7, 2, s18
  v_subrev_u32 v6, 11, v5
  v_max_i32 v7, 0, v6
  v_cvt_f32_u32 v7, v7
  v_cvt_pk_bf16_f32 v8, v7, v7
  v_and_b32 v7, 0xffff0000, v8
  v_lshrrev_b32 v8, 23, v7
  v_subrev_u32 v8, 134, v8
  v_max_i32 v8, 0, v8
  v_cvt_u32_f32 v7, v7
  v_lshrrev_b32 v7, v8, v7
  v_lshl_add_u32 v7, v8, 8, v7
  v_lshl_add_u32 v211, v7, 2, s18
  v_subrev_u32 v6, 12, v5
  v_max_i32 v7, 0, v6
  v_cvt_f32_u32 v7, v7
  v_cvt_pk_bf16_f32 v8, v7, v7
  v_and_b32 v7, 0xffff0000, v8
  v_lshrrev_b32 v8, 23, v7
  v_subrev_u32 v8, 134, v8
  v_max_i32 v8, 0, v8
  v_cvt_u32_f32 v7, v7
  v_lshrrev_b32 v7, v8, v7
  v_lshl_add_u32 v7, v8, 8, v7
  v_lshl_add_u32 v212, v7, 2, s18
  v_subrev_u32 v6, 13, v5
  v_max_i32 v7, 0, v6
  v_cvt_f32_u32 v7, v7
  v_cvt_pk_bf16_f32 v8, v7, v7
  v_and_b32 v7, 0xffff0000, v8
  v_lshrrev_b32 v8, 23, v7
  v_subrev_u32 v8, 134, v8
  v_max_i32 v8, 0, v8
  v_cvt_u32_f32 v7, v7
  v_lshrrev_b32 v7, v8, v7
  v_lshl_add_u32 v7, v8, 8, v7
  v_lshl_add_u32 v213, v7, 2, s18
  v_subrev_u32 v6, 14, v5
  v_max_i32 v7, 0, v6
  v_cvt_f32_u32 v7, v7
  v_cvt_pk_bf16_f32 v8, v7, v7
  v_and_b32 v7, 0xffff0000, v8
  v_lshrrev_b32 v8, 23, v7
  v_subrev_u32 v8, 134, v8
  v_max_i32 v8, 0, v8
  v_cvt_u32_f32 v7, v7
  v_lshrrev_b32 v7, v8, v7
  v_lshl_add_u32 v7, v8, 8, v7
  v_lshl_add_u32 v214, v7, 2, s18
  v_subrev_u32 v6, 15, v5
  v_max_i32 v7, 0, v6
  v_cvt_f32_u32 v7, v7
  v_cvt_pk_bf16_f32 v8, v7, v7
  v_and_b32 v7, 0xffff0000, v8
  v_lshrrev_b32 v8, 23, v7
  v_subrev_u32 v8, 134, v8
  v_max_i32 v8, 0, v8
  v_cvt_u32_f32 v7, v7
  v_lshrrev_b32 v7, v8, v7
  v_lshl_add_u32 v7, v8, 8, v7
  v_lshl_add_u32 v215, v7, 2, s18
  v_subrev_u32 v6, 16, v5
  v_max_i32 v7, 0, v6
  v_cvt_f32_u32 v7, v7
  v_cvt_pk_bf16_f32 v8, v7, v7
  v_and_b32 v7, 0xffff0000, v8
  v_lshrrev_b32 v8, 23, v7
  v_subrev_u32 v8, 134, v8
  v_max_i32 v8, 0, v8
  v_cvt_u32_f32 v7, v7
  v_lshrrev_b32 v7, v8, v7
  v_lshl_add_u32 v7, v8, 8, v7
  v_lshl_add_u32 v216, v7, 2, s18
  v_subrev_u32 v6, 17, v5
  v_max_i32 v7, 0, v6
  v_cvt_f32_u32 v7, v7
  v_cvt_pk_bf16_f32 v8, v7, v7
  v_and_b32 v7, 0xffff0000, v8
  v_lshrrev_b32 v8, 23, v7
  v_subrev_u32 v8, 134, v8
  v_max_i32 v8, 0, v8
  v_cvt_u32_f32 v7, v7
  v_lshrrev_b32 v7, v8, v7
  v_lshl_add_u32 v7, v8, 8, v7
  v_lshl_add_u32 v217, v7, 2, s18
  v_subrev_u32 v6, 18, v5
  v_max_i32 v7, 0, v6
  v_cvt_f32_u32 v7, v7
  v_cvt_pk_bf16_f32 v8, v7, v7
  v_and_b32 v7, 0xffff0000, v8
  v_lshrrev_b32 v8, 23, v7
  v_subrev_u32 v8, 134, v8
  v_max_i32 v8, 0, v8
  v_cvt_u32_f32 v7, v7
  v_lshrrev_b32 v7, v8, v7
  v_lshl_add_u32 v7, v8, 8, v7
  v_lshl_add_u32 v218, v7, 2, s18
  v_subrev_u32 v6, 19, v5
  v_max_i32 v7, 0, v6
  v_cvt_f32_u32 v7, v7
  v_cvt_pk_bf16_f32 v8, v7, v7
  v_and_b32 v7, 0xffff0000, v8
  v_lshrrev_b32 v8, 23, v7
  v_subrev_u32 v8, 134, v8
  v_max_i32 v8, 0, v8
  v_cvt_u32_f32 v7, v7
  v_lshrrev_b32 v7, v8, v7
  v_lshl_add_u32 v7, v8, 8, v7
  v_lshl_add_u32 v219, v7, 2, s18
  v_subrev_u32 v6, 20, v5
  v_max_i32 v7, 0, v6
  v_cvt_f32_u32 v7, v7
  v_cvt_pk_bf16_f32 v8, v7, v7
  v_and_b32 v7, 0xffff0000, v8
  v_lshrrev_b32 v8, 23, v7
  v_subrev_u32 v8, 134, v8
  v_max_i32 v8, 0, v8
  v_cvt_u32_f32 v7, v7
  v_lshrrev_b32 v7, v8, v7
  v_lshl_add_u32 v7, v8, 8, v7
  v_lshl_add_u32 v220, v7, 2, s18
  v_subrev_u32 v6, 21, v5
  v_max_i32 v7, 0, v6
  v_cvt_f32_u32 v7, v7
  v_cvt_pk_bf16_f32 v8, v7, v7
  v_and_b32 v7, 0xffff0000, v8
  v_lshrrev_b32 v8, 23, v7
  v_subrev_u32 v8, 134, v8
  v_max_i32 v8, 0, v8
  v_cvt_u32_f32 v7, v7
  v_lshrrev_b32 v7, v8, v7
  v_lshl_add_u32 v7, v8, 8, v7
  v_lshl_add_u32 v221, v7, 2, s18
  v_subrev_u32 v6, 22, v5
  v_max_i32 v7, 0, v6
  v_cvt_f32_u32 v7, v7
  v_cvt_pk_bf16_f32 v8, v7, v7
  v_and_b32 v7, 0xffff0000, v8
  v_lshrrev_b32 v8, 23, v7
  v_subrev_u32 v8, 134, v8
  v_max_i32 v8, 0, v8
  v_cvt_u32_f32 v7, v7
  v_lshrrev_b32 v7, v8, v7
  v_lshl_add_u32 v7, v8, 8, v7
  v_lshl_add_u32 v222, v7, 2, s18
  v_subrev_u32 v6, 23, v5
  v_max_i32 v7, 0, v6
  v_cvt_f32_u32 v7, v7
  v_cvt_pk_bf16_f32 v8, v7, v7
  v_and_b32 v7, 0xffff0000, v8
  v_lshrrev_b32 v8, 23, v7
  v_subrev_u32 v8, 134, v8
  v_max_i32 v8, 0, v8
  v_cvt_u32_f32 v7, v7
  v_lshrrev_b32 v7, v8, v7
  v_lshl_add_u32 v7, v8, 8, v7
  v_lshl_add_u32 v223, v7, 2, s18
  v_subrev_u32 v6, 24, v5
  v_max_i32 v7, 0, v6
  v_cvt_f32_u32 v7, v7
  v_cvt_pk_bf16_f32 v8, v7, v7
  v_and_b32 v7, 0xffff0000, v8
  v_lshrrev_b32 v8, 23, v7
  v_subrev_u32 v8, 134, v8
  v_max_i32 v8, 0, v8
  v_cvt_u32_f32 v7, v7
  v_lshrrev_b32 v7, v8, v7
  v_lshl_add_u32 v7, v8, 8, v7
  v_lshl_add_u32 v224, v7, 2, s18
  v_subrev_u32 v6, 25, v5
  v_max_i32 v7, 0, v6
  v_cvt_f32_u32 v7, v7
  v_cvt_pk_bf16_f32 v8, v7, v7
  v_and_b32 v7, 0xffff0000, v8
  v_lshrrev_b32 v8, 23, v7
  v_subrev_u32 v8, 134, v8
  v_max_i32 v8, 0, v8
  v_cvt_u32_f32 v7, v7
  v_lshrrev_b32 v7, v8, v7
  v_lshl_add_u32 v7, v8, 8, v7
  v_lshl_add_u32 v225, v7, 2, s18
  v_subrev_u32 v6, 26, v5
  v_max_i32 v7, 0, v6
  v_cvt_f32_u32 v7, v7
  v_cvt_pk_bf16_f32 v8, v7, v7
  v_and_b32 v7, 0xffff0000, v8
  v_lshrrev_b32 v8, 23, v7
  v_subrev_u32 v8, 134, v8
  v_max_i32 v8, 0, v8
  v_cvt_u32_f32 v7, v7
  v_lshrrev_b32 v7, v8, v7
  v_lshl_add_u32 v7, v8, 8, v7
  v_lshl_add_u32 v226, v7, 2, s18
  v_subrev_u32 v6, 27, v5
  v_max_i32 v7, 0, v6
  v_cvt_f32_u32 v7, v7
  v_cvt_pk_bf16_f32 v8, v7, v7
  v_and_b32 v7, 0xffff0000, v8
  v_lshrrev_b32 v8, 23, v7
  v_subrev_u32 v8, 134, v8
  v_max_i32 v8, 0, v8
  v_cvt_u32_f32 v7, v7
  v_lshrrev_b32 v7, v8, v7
  v_lshl_add_u32 v7, v8, 8, v7
  v_lshl_add_u32 v227, v7, 2, s18
  v_subrev_u32 v6, 28, v5
  v_max_i32 v7, 0, v6
  v_cvt_f32_u32 v7, v7
  v_cvt_pk_bf16_f32 v8, v7, v7
  v_and_b32 v7, 0xffff0000, v8
  v_lshrrev_b32 v8, 23, v7
  v_subrev_u32 v8, 134, v8
  v_max_i32 v8, 0, v8
  v_cvt_u32_f32 v7, v7
  v_lshrrev_b32 v7, v8, v7
  v_lshl_add_u32 v7, v8, 8, v7
  v_lshl_add_u32 v228, v7, 2, s18
  v_subrev_u32 v6, 29, v5
  v_max_i32 v7, 0, v6
  v_cvt_f32_u32 v7, v7
  v_cvt_pk_bf16_f32 v8, v7, v7
  v_and_b32 v7, 0xffff0000, v8
  v_lshrrev_b32 v8, 23, v7
  v_subrev_u32 v8, 134, v8
  v_max_i32 v8, 0, v8
  v_cvt_u32_f32 v7, v7
  v_lshrrev_b32 v7, v8, v7
  v_lshl_add_u32 v7, v8, 8, v7
  v_lshl_add_u32 v229, v7, 2, s18
  v_subrev_u32 v6, 30, v5
  v_max_i32 v7, 0, v6
  v_cvt_f32_u32 v7, v7
  v_cvt_pk_bf16_f32 v8, v7, v7
  v_and_b32 v7, 0xffff0000, v8
  v_lshrrev_b32 v8, 23, v7
  v_subrev_u32 v8, 134, v8
  v_max_i32 v8, 0, v8
  v_cvt_u32_f32 v7, v7
  v_lshrrev_b32 v7, v8, v7
  v_lshl_add_u32 v7, v8, 8, v7
  v_lshl_add_u32 v230, v7, 2, s18
  v_subrev_u32 v6, 31, v5
  v_max_i32 v7, 0, v6
  v_cvt_f32_u32 v7, v7
  v_cvt_pk_bf16_f32 v8, v7, v7
  v_and_b32 v7, 0xffff0000, v8
  v_lshrrev_b32 v8, 23, v7
  v_subrev_u32 v8, 134, v8
  v_max_i32 v8, 0, v8
  v_cvt_u32_f32 v7, v7
  v_lshrrev_b32 v7, v8, v7
  v_lshl_add_u32 v7, v8, 8, v7
  v_lshl_add_u32 v231, v7, 2, s18
  v_subrev_u32 v6, 32, v5
  v_max_i32 v7, 0, v6
  v_cvt_f32_u32 v7, v7
  v_cvt_pk_bf16_f32 v8, v7, v7
  v_and_b32 v7, 0xffff0000, v8
  v_lshrrev_b32 v8, 23, v7
  v_subrev_u32 v8, 134, v8
  v_max_i32 v8, 0, v8
  v_cvt_u32_f32 v7, v7
  v_lshrrev_b32 v7, v8, v7
  v_lshl_add_u32 v7, v8, 8, v7
  v_mov_b32 v8, 1280
  v_cmp_gt_i32 vcc, 0, v6
  s_nop 1
  v_cndmask_b32 v7, v7, v8, vcc
  v_lshl_add_u32 v232, v7, 2, s18
  v_mov_b32 v8, 0
  v_mov_b32 v9, 0
  v_lshlrev_b32 v5, 3, v1
  v_add_u32 v5, s17, v5
  ds_write_b64 v5, v[8:9]
  v_and_b32 v6, 15, v1
  v_lshlrev_b32 v6, 3, v6
  v_add_u32 v6, s17, v6
  ds_write_b64 v6, v[8:9] offset:8704
  ds_write_b64 v6, v[8:9] offset:12928
  v_mov_b32 v6, s17
  ds_write_b64 v6, v[8:9] offset:18176
  s_lshl_b32 s19, s3, 2
  s_add_u32 s20, s19, s16
  s_lshl_b32 s21, s3, 3
  v_mul_u32_u24 v5, 3584, v0
  v_mul_u32_u24 v141, 1792, v0
  s_lshl_b32 s22, s20, 9
  v_lshlrev_b32 v6, 3, v1
  buffer_load_dwordx2 v[24:25], v6, s[64:67], s22 offen
  buffer_load_dwordx2 v[26:27], v6, s[68:71], s22 offen
  buffer_load_dwordx2 v[28:29], v6, s[72:75], s22 offen
  buffer_load_dwordx2 v[30:31], v6, s[76:79], s22 offen
  s_lshl_b32 s22, s20, 1
  v_mov_b32 v7, 0
  buffer_load_ushort v32, v7, s[80:83], s22 offen
  buffer_load_ushort v33, v7, s[84:87], s22 offen
  s_mov_b32 s24, 0x05040100
  s_mov_b32 s25, 0x07060302
  s_barrier
  s_waitcnt vmcnt(0)
  s_mov_b32 s26, 1069066811
  s_mov_b32 s27, 1042479491
  v_lshlrev_b32 v32, 16, v32
  v_lshlrev_b32 v33, 16, v33
  v_mul_f32 v32, s26, v32
  v_exp_f32 v32, v32
  s_nop 0
  v_cvt_pk_bf16_f32 v34, v32, v32
  v_and_b32 v32, 0xffff0000, v34
  v_lshlrev_b32 v37, 6, v1
  v_add_u32 v37, s17, v37
  v_lshlrev_b32 v40, 16, v24
  v_lshlrev_b32 v41, 16, v26
  v_lshlrev_b32 v42, 16, v28
  v_lshlrev_b32 v43, 16, v30
  v_mul_f32 v40, s26, v40
  v_exp_f32 v40, v40
  s_nop 0
  v_cvt_pk_bf16_f32 v34, v40, v40
  v_and_b32 v40, 0xffff0000, v34
  v_mul_f32 v40, v40, v32
  v_mul_f32 v40, s26, v40
  v_sub_f32 v40, 0, v40
  v_mul_f32 v41, v41, v32
  v_mul_f32 v41, s27, v41
  v_mul_f32 v42, v42, v32
  v_mul_f32 v43, v43, v32
  v_add_f32 v42, v42, v42
  v_add_f32 v43, v43, v43
  ds_write_b128 v37, v[40:43] offset:18240
  v_and_b32 v40, 0xffff0000, v24
  v_and_b32 v41, 0xffff0000, v26
  v_and_b32 v42, 0xffff0000, v28
  v_and_b32 v43, 0xffff0000, v30
  v_mul_f32 v40, s26, v40
  v_exp_f32 v40, v40
  s_nop 0
  v_cvt_pk_bf16_f32 v34, v40, v40
  v_and_b32 v40, 0xffff0000, v34
  v_mul_f32 v40, v40, v32
  v_mul_f32 v40, s26, v40
  v_sub_f32 v40, 0, v40
  v_mul_f32 v41, v41, v32
  v_mul_f32 v41, s27, v41
  v_mul_f32 v42, v42, v32
  v_mul_f32 v43, v43, v32
  v_add_f32 v42, v42, v42
  v_add_f32 v43, v43, v43
  ds_write_b128 v37, v[40:43] offset:18256
  v_lshlrev_b32 v40, 16, v25
  v_lshlrev_b32 v41, 16, v27
  v_lshlrev_b32 v42, 16, v29
  v_lshlrev_b32 v43, 16, v31
  v_mul_f32 v40, s26, v40
  v_exp_f32 v40, v40
  s_nop 0
  v_cvt_pk_bf16_f32 v34, v40, v40
  v_and_b32 v40, 0xffff0000, v34
  v_mul_f32 v40, v40, v32
  v_mul_f32 v40, s26, v40
  v_sub_f32 v40, 0, v40
  v_mul_f32 v41, v41, v32
  v_mul_f32 v41, s27, v41
  v_mul_f32 v42, v42, v32
  v_mul_f32 v43, v43, v32
  v_add_f32 v42, v42, v42
  v_add_f32 v43, v43, v43
  ds_write_b128 v37, v[40:43] offset:18272
  v_and_b32 v40, 0xffff0000, v25
  v_and_b32 v41, 0xffff0000, v27
  v_and_b32 v42, 0xffff0000, v29
  v_and_b32 v43, 0xffff0000, v31
  v_mul_f32 v40, s26, v40
  v_exp_f32 v40, v40
  s_nop 0
  v_cvt_pk_bf16_f32 v34, v40, v40
  v_and_b32 v40, 0xffff0000, v34
  v_mul_f32 v40, v40, v32
  v_mul_f32 v40, s26, v40
  v_sub_f32 v40, 0, v40
  v_mul_f32 v41, v41, v32
  v_mul_f32 v41, s27, v41
  v_mul_f32 v42, v42, v32
  v_mul_f32 v43, v43, v32
  v_add_f32 v42, v42, v42
  v_add_f32 v43, v43, v43
  ds_write_b128 v37, v[40:43] offset:18288
  v_cvt_f32_u32 v44, v4
  v_lshlrev_b32 v45, 4, v4
  v_cvt_f32_u32 v45, v45
  v_lshlrev_b32 v46, 4, v3
  v_add_u32 v46, s17, v46
  v_mov_b32 v48, 0
  v_mov_b32 v49, 0
  v_mov_b32 v50, 0
  v_mov_b32 v51, 0
  v_mov_b32 v52, 0
  v_mov_b32 v53, 0
  v_mov_b32 v54, 0
  v_mov_b32 v55, 0
  v_mov_b32 v56, 0
  v_mov_b32 v57, 0
  v_mov_b32 v58, 0
  v_mov_b32 v59, 0
  v_mov_b32 v60, 0
  v_mov_b32 v61, 0
  v_mov_b32 v62, 0
  v_mov_b32 v63, 0
  v_mov_b32 v64, 0
  v_mov_b32 v65, 0
  v_mov_b32 v66, 0
  v_mov_b32 v67, 0
  s_waitcnt lgkmcnt(0)
  ds_read_b128 v[68:71], v46 offset:18240
  s_add_u32 s22, s21, 0
  buffer_load_dwordx2 v[8:9], v5, s[60:63], s22 offen offset:0
  s_mov_b32 s28, 0
  s_call_b64 s[30:31], wk_kl
  s_mov_b32 s28, 0
  s_call_b64 s[30:31], wk_kl
  s_add_u32 s22, s21, 0
  buffer_load_dwordx2 v[10:11], v5, s[60:63], s22 offen offset:896
  s_mov_b32 s28, 0
  s_call_b64 s[30:31], wk_kl
  s_mov_b32 s28, 0
  s_call_b64 s[30:31], wk_kl
  s_add_u32 s22, s21, 0
  buffer_load_dwordx2 v[12:13], v5, s[60:63], s22 offen offset:1792
  s_mov_b32 s28, 0
  s_call_b64 s[30:31], wk_kl
  s_mov_b32 s28, 0
  s_call_b64 s[30:31], wk_kl
  s_add_u32 s22, s21, 0
  buffer_load_dwordx2 v[14:15], v5, s[60:63], s22 offen offset:2688
  s_mov_b32 s28, 0
  s_call_b64 s[30:31], wk_kl
  s_mov_b32 s28, 0
  s_call_b64 s[30:31], wk_kl
  s_add_u32 s22, s21, 917504
  buffer_load_dwordx2 v[16:17], v5, s[60:63], s22 offen offset:0
  s_mov_b32 s28, 0
  s_call_b64 s[30:31], wk_kl
  s_mov_b32 s28, 0
  s_call_b64 s[30:31], wk_kl
  s_add_u32 s22, s21, 917504
  buffer_load_dwordx2 v[18:19], v5, s[60:63], s22 offen offset:896
  s_mov_b32 s28, 0
  s_call_b64 s[30:31], wk_kl
  s_mov_b32 s28, 0
  s_call_b64 s[30:31], wk_kl
  s_add_u32 s22, s21, 917504
  buffer_load_dwordx2 v[20:21], v5, s[60:63], s22 offen offset:1792
  s_mov_b32 s28, 0
  s_call_b64 s[30:31], wk_kl
  s_mov_b32 s28, 0
  s_call_b64 s[30:31], wk_kl
  s_add_u32 s22, s21, 917504
  buffer_load_dwordx2 v[22:23], v5, s[60:63], s22 offen offset:2688
  s_mov_b32 s28, 0
  s_call_b64 s[30:31], wk_kl
  s_mov_b32 s28, 0
  s_call_b64 s[30:31], wk_kl
  s_branch wk_kd
wk_kl:
  s_waitcnt lgkmcnt(0)
  v_mov_b32 v72, v68
  v_mov_b32 v73, v69
  v_mov_b32 v74, v70
  v_mov_b32 v75, v71
  v_add_u32 v46, 64, v46
  ds_read_b128 v[68:71], v46 offset:18240
  v_mul_f32 v80, v72, v45
  v_mul_f32 v81, v73, v45
  v_exp_f32 v80, v80
  v_fract_f32 v81, v81
  v_cos_f32 v76, v81
  v_sin_f32 v77, v81
  v_mul_f32 v76, v76, v80
  v_mul_f32 v77, v77, v80
  v_mul_f32 v80, v72, v44
  v_mul_f32 v81, v73, v44
  v_exp_f32 v80, v80
  v_fract_f32 v81, v81
  v_cos_f32 v78, v81
  v_sin_f32 v79, v81
  v_mul_f32 v78, v78, v80
  v_mul_f32 v79, v79, v80
  v_mul_f32 v82, v74, v76
  v_mul_f32 v83, v74, v77
  v_fma_f32 v82, -v75, v77, v82
  v_fma_f32 v83, -v75, v76, -v83
  v_mul_f32 v86, v76, v76
  v_mul_f32 v87, v76, v77
  v_fma_f32 v86, -v77, v77, v86
  v_add_f32 v87, v87, v87
  v_mfma_f32_16x16x4_f32 v[48:51], v82, v78, v[48:51]
  v_mul_f32 v88, v78, v78
  v_mul_f32 v89, v78, v79
  v_fma_f32 v88, -v79, v79, v88
  v_add_f32 v89, v89, v89
  v_mfma_f32_16x16x4_f32 v[48:51], v83, v79, v[48:51]
  v_mul_f32 v84, v74, v86
  v_mul_f32 v85, v74, v87
  v_fma_f32 v84, -v75, v87, v84
  v_fma_f32 v85, -v75, v86, -v85
  v_mul_f32 v76, v86, v86
  v_mul_f32 v77, v86, v87
  v_fma_f32 v76, -v87, v87, v76
  v_add_f32 v77, v77, v77
  v_mfma_f32_16x16x4_f32 v[52:55], v84, v88, v[52:55]
  v_mul_f32 v78, v88, v88
  v_mul_f32 v79, v88, v89
  v_fma_f32 v78, -v89, v89, v78
  v_add_f32 v79, v79, v79
  v_mfma_f32_16x16x4_f32 v[52:55], v85, v89, v[52:55]
  v_mul_f32 v82, v74, v76
  v_mul_f32 v83, v74, v77
  v_fma_f32 v82, -v75, v77, v82
  v_fma_f32 v83, -v75, v76, -v83
  v_mul_f32 v86, v76, v76
  v_mul_f32 v87, v76, v77
  v_fma_f32 v86, -v77, v77, v86
  v_add_f32 v87, v87, v87
  v_mfma_f32_16x16x4_f32 v[56:59], v82, v78, v[56:59]
  v_mul_f32 v88, v78, v78
  v_mul_f32 v89, v78, v79
  v_fma_f32 v88, -v79, v79, v88
  v_add_f32 v89, v89, v89
  v_mfma_f32_16x16x4_f32 v[56:59], v83, v79, v[56:59]
  v_mul_f32 v84, v74, v86
  v_mul_f32 v85, v74, v87
  v_fma_f32 v84, -v75, v87, v84
  v_fma_f32 v85, -v75, v86, -v85
  v_mul_f32 v76, v86, v86
  v_mul_f32 v77, v86, v87
  v_fma_f32 v76, -v87, v87, v76
  v_add_f32 v77, v77, v77
  v_mfma_f32_16x16x4_f32 v[60:63], v84, v88, v[60:63]
  v_mfma_f32_16x16x4_f32 v[60:63], v85, v89, v[60:63]
  v_mul_f32 v82, v74, v76
  v_fma_f32 v82, -v75, v77, v82
  s_nop 1
  v_mfma_f32_16x16x4_f32 v[64:67], v82, v88, v[64:67]
  s_add_u32 s28, s28, 1
  s_cmp_lt_u32 s28, 4
  s_cbranch_scc1 wk_kl
  s_setpc_b64 s[30:31]
wk_kd:
  s_nop 15
  s_nop 3
  s_waitcnt vmcnt(0)
  v_lshlrev_b32 v6, 3, v0
  v_perm_b32 v34, v10, v8, s24
  v_perm_b32 v35, v14, v12, s24
  v_add_u32 v36, 512, v6
  ds_write_b64 v36, v[34:35]
  v_perm_b32 v34, v10, v8, s25
  v_perm_b32 v35, v14, v12, s25
  v_add_u32 v36, 25088, v6
  ds_write_b64 v36, v[34:35]
  v_perm_b32 v34, v11, v9, s24
  v_perm_b32 v35, v15, v13, s24
  v_add_u32 v36, 49664, v6
  ds_write_b64 v36, v[34:35]
  v_perm_b32 v34, v11, v9, s25
  v_perm_b32 v35, v15, v13, s25
  v_add_u32 v36, 74240, v6
  ds_write_b64 v36, v[34:35]
  v_perm_b32 v34, v18, v16, s24
  v_perm_b32 v35, v22, v20, s24
  v_add_u32 v36, 2560, v6
  ds_write_b64 v36, v[34:35]
  v_perm_b32 v34, v18, v16, s25
  v_perm_b32 v35, v22, v20, s25
  v_add_u32 v36, 27136, v6
  ds_write_b64 v36, v[34:35]
  v_perm_b32 v34, v19, v17, s24
  v_perm_b32 v35, v23, v21, s24
  v_add_u32 v36, 51712, v6
  ds_write_b64 v36, v[34:35]
  v_perm_b32 v34, v19, v17, s25
  v_perm_b32 v35, v23, v21, s25
  v_add_u32 v36, 76288, v6
  ds_write_b64 v36, v[34:35]
  v_lshlrev_b32 v46, 8, v3
  v_lshl_add_u32 v46, v4, 2, v46
  v_add_u32 v46, s17, v46
  ds_write_b32 v46, v48 offset:13056
  ds_write_b32 v46, v49 offset:13120
  ds_write_b32 v46, v50 offset:13184
  ds_write_b32 v46, v51 offset:13248
  s_waitcnt lgkmcnt(8)
  ds_write_b32 v46, v52 offset:14080
  ds_write_b32 v46, v53 offset:14144
  ds_write_b32 v46, v54 offset:14208
  ds_write_b32 v46, v55 offset:14272
  s_waitcnt lgkmcnt(8)
  ds_write_b32 v46, v56 offset:15104
  ds_write_b32 v46, v57 offset:15168
  ds_write_b32 v46, v58 offset:15232
  ds_write_b32 v46, v59 offset:15296
  s_waitcnt lgkmcnt(8)
  ds_write_b32 v46, v60 offset:16128
  ds_write_b32 v46, v61 offset:16192
  ds_write_b32 v46, v62 offset:16256
  ds_write_b32 v46, v63 offset:16320
  s_waitcnt lgkmcnt(8)
  ds_write_b32 v46, v64 offset:17152
  ds_write_b32 v46, v65 offset:17216
  ds_write_b32 v46, v66 offset:17280
  ds_write_b32 v46, v67 offset:17344
  s_waitcnt lgkmcnt(8)
  s_waitcnt lgkmcnt(0)
  ds_read_b32 v48, v200
  ds_read_b32 v49, v201
  ds_read_b32 v50, v202
  ds_read_b32 v51, v203
  ds_read_b32 v52, v204
  ds_read_b32 v53, v205
  ds_read_b32 v54, v206
  ds_read_b32 v55, v207
  s_waitcnt lgkmcnt(4)
  ds_read_b32 v56, v208
  ds_read_b32 v57, v209
  ds_read_b32 v58, v210
  ds_read_b32 v59, v211
  ds_read_b32 v60, v212
  ds_read_b32 v61, v213
  ds_read_b32 v62, v214
  ds_read_b32 v63, v215
  s_waitcnt lgkmcnt(4)
  ds_read_b32 v64, v216
  ds_read_b32 v65, v217
  ds_read_b32 v66, v218
  ds_read_b32 v67, v219
  ds_read_b32 v68, v220
  ds_read_b32 v69, v221
  ds_read_b32 v70, v222
  ds_read_b32 v71, v223
  s_waitcnt lgkmcnt(4)
  ds_read_b32 v72, v224
  ds_read_b32 v73, v225
  ds_read_b32 v74, v226
  ds_read_b32 v75, v227
  ds_read_b32 v76, v228
  ds_read_b32 v77, v229
  ds_read_b32 v78, v230
  ds_read_b32 v79, v231
  s_waitcnt lgkmcnt(4)
  ds_read_b32 v80, v232
  s_waitcnt lgkmcnt(0)
  v_lshlrev_b32 v46, 6, v1
  v_add_u32 v46, s17, v46
  v_cvt_pk_bf16_f32 v84, v48, v49
  v_cvt_pk_bf16_f32 v88, v49, v50
  v_cvt_pk_bf16_f32 v85, v50, v51
  v_cvt_pk_bf16_f32 v89, v51, v52
  v_cvt_pk_bf16_f32 v86, v52, v53
  v_cvt_pk_bf16_f32 v90, v53, v54
  v_cvt_pk_bf16_f32 v87, v54, v55
  v_cvt_pk_bf16_f32 v91, v55, v56
  ds_write_b128 v46, v[84:87] offset:4608
  ds_write_b128 v46, v[88:91] offset:8832
  s_waitcnt lgkmcnt(0)
  v_cvt_pk_bf16_f32 v84, v56, v57
  v_cvt_pk_bf16_f32 v88, v57, v58
  v_cvt_pk_bf16_f32 v85, v58, v59
  v_cvt_pk_bf16_f32 v89, v59, v60
  v_cvt_pk_bf16_f32 v86, v60, v61
  v_cvt_pk_bf16_f32 v90, v61, v62
  v_cvt_pk_bf16_f32 v87, v62, v63
  v_cvt_pk_bf16_f32 v91, v63, v64
  ds_write_b128 v46, v[84:87] offset:4624
  ds_write_b128 v46, v[88:91] offset:8848
  s_waitcnt lgkmcnt(0)
  v_cvt_pk_bf16_f32 v84, v64, v65
  v_cvt_pk_bf16_f32 v88, v65, v66
  v_cvt_pk_bf16_f32 v85, v66, v67
  v_cvt_pk_bf16_f32 v89, v67, v68
  v_cvt_pk_bf16_f32 v86, v68, v69
  v_cvt_pk_bf16_f32 v90, v69, v70
  v_cvt_pk_bf16_f32 v87, v70, v71
  v_cvt_pk_bf16_f32 v91, v71, v72
  ds_write_b128 v46, v[84:87] offset:4640
  ds_write_b128 v46, v[88:91] offset:8864
  s_waitcnt lgkmcnt(0)
  v_cvt_pk_bf16_f32 v84, v72, v73
  v_cvt_pk_bf16_f32 v88, v73, v74
  v_cvt_pk_bf16_f32 v85, v74, v75
  v_cvt_pk_bf16_f32 v89, v75, v76
  v_cvt_pk_bf16_f32 v86, v76, v77
  v_cvt_pk_bf16_f32 v90, v77, v78
  v_cvt_pk_bf16_f32 v87, v78, v79
  v_cvt_pk_bf16_f32 v91, v79, v80
  ds_write_b128 v46, v[84:87] offset:4656
  ds_write_b128 v46, v[88:91] offset:8880
  s_waitcnt lgkmcnt(0)
  s_barrier
  v_lshrrev_b32 v47, 1, v3
  v_sub_u32 v46, v4, v47
  v_add_u32 v46, 1, v46
  v_lshlrev_b32 v46, 5, v46
  v_and_b32 v48, 1, v3
  v_lshl_add_u32 v46, v48, 4, v46
  v_add_u32 v46, s17, v46
  ds_read_b128 a[0:3], v46 offset:32
  ds_read_b128 a[4:7], v46 offset:96
  ds_read_b128 a[8:11], v46 offset:160
  ds_read_b128 a[12:15], v46 offset:224
  ds_read_b128 a[16:19], v46 offset:288
  ds_read_b128 a[20:23], v46 offset:352
  ds_read_b128 a[24:27], v46 offset:416
  ds_read_b128 a[28:31], v46 offset:480
  s_waitcnt lgkmcnt(4)
  ds_read_b128 a[32:35], v46 offset:544
  ds_read_b128 a[36:39], v46 offset:608
  ds_read_b128 a[40:43], v46 offset:672
  ds_read_b128 a[44:47], v46 offset:736
  ds_read_b128 a[48:51], v46 offset:800
  ds_read_b128 a[52:55], v46 offset:864
  ds_read_b128 a[56:59], v46 offset:928
  ds_read_b128 a[60:63], v46 offset:992
  s_waitcnt lgkmcnt(4)
  ds_read_b128 a[64:67], v46 offset:1056
  ds_read_b128 a[68:71], v46 offset:1120
  ds_read_b128 a[72:75], v46 offset:1184
  ds_read_b128 a[76:79], v46 offset:1248
  ds_read_b128 a[80:83], v46 offset:1312
  ds_read_b128 a[84:87], v46 offset:1376
  ds_read_b128 a[88:91], v46 offset:1440
  ds_read_b128 a[92:95], v46 offset:1504
  s_waitcnt lgkmcnt(4)
  ds_read_b128 a[96:99], v46 offset:1568
  ds_read_b128 a[100:103], v46 offset:1632
  ds_read_b128 a[104:107], v46 offset:1696
  ds_read_b128 a[108:111], v46 offset:1760
  ds_read_b128 a[112:115], v46 offset:1824
  ds_read_b128 a[116:119], v46 offset:1888
  ds_read_b128 a[120:123], v46 offset:1952
  ds_read_b128 a[124:127], v46 offset:2016
  s_waitcnt lgkmcnt(4)
  ds_read_b128 a[128:131], v46 offset:2080
  ds_read_b128 a[132:135], v46 offset:2144
  ds_read_b128 a[136:139], v46 offset:2208
  ds_read_b128 a[140:143], v46 offset:2272
  ds_read_b128 a[144:147], v46 offset:2336
  ds_read_b128 a[148:151], v46 offset:2400
  ds_read_b128 a[152:155], v46 offset:2464
  ds_read_b128 a[156:159], v46 offset:2528
  s_waitcnt lgkmcnt(4)
  ds_read_b128 a[160:163], v46 offset:2592
  ds_read_b128 a[164:167], v46 offset:2656
  ds_read_b128 a[168:171], v46 offset:2720
  ds_read_b128 a[172:175], v46 offset:2784
  ds_read_b128 a[176:179], v46 offset:2848
  ds_read_b128 a[180:183], v46 offset:2912
  ds_read_b128 a[184:187], v46 offset:2976
  ds_read_b128 a[188:191], v46 offset:3040
  s_waitcnt lgkmcnt(4)
  ds_read_b128 a[192:195], v46 offset:3104
  ds_read_b128 a[196:199], v46 offset:3168
  ds_read_b128 a[200:203], v46 offset:3232
  ds_read_b128 a[204:207], v46 offset:3296
  ds_read_b128 a[208:211], v46 offset:3360
  ds_read_b128 a[212:215], v46 offset:3424
  ds_read_b128 a[216:219], v46 offset:3488
  ds_read_b128 a[220:223], v46 offset:3552
  s_waitcnt lgkmcnt(4)
  ds_read_b128 a[224:227], v46 offset:3616
  ds_read_b128 a[228:231], v46 offset:3680
  ds_read_b128 a[232:235], v46 offset:3744
  ds_read_b128 a[236:239], v46 offset:3808
  ds_read_b128 a[240:243], v46 offset:3872
  ds_read_b128 a[244:247], v46 offset:3936
  ds_read_b128 a[248:251], v46 offset:4000
  ds_read_b128 a[252:255], v46 offset:4064
  s_waitcnt lgkmcnt(4)
  v_lshlrev_b32 v49, 4, v47
  v_add_u32 v49, v49, v4
  v_sub_u32 v49, 2047, v49
  v_lshl_add_u32 v49, v48, 3, v49
  v_and_b32 v50, 1, v49
  v_lshrrev_b32 v49, 1, v49
  v_lshlrev_b32 v49, 2, v49
  v_mul_u32_u24 v50, 4224, v50
  v_add3_u32 v49, v49, v50, s17
  v_add_u32 v49, 4608, v49
  v_subrev_u32 v52, 896, v49
  v_subrev_u32 v53, 1856, v49
  v_subrev_u32 v54, 2816, v49
  v_subrev_u32 v55, 3776, v49
  v_subrev_u32 v56, 4736, v49
  s_waitcnt lgkmcnt(0)
  ds_read2_b32 v[92:93], v52 offset0:224 offset1:225
  ds_read2_b32 v[94:95], v52 offset0:226 offset1:227
  ds_read2_b32 v[96:97], v52 offset0:208 offset1:209
  ds_read2_b32 v[98:99], v52 offset0:210 offset1:211
  ds_read2_b32 v[100:101], v52 offset0:192 offset1:193
  ds_read2_b32 v[102:103], v52 offset0:194 offset1:195
  ds_read2_b32 v[104:105], v52 offset0:176 offset1:177
  ds_read2_b32 v[106:107], v52 offset0:178 offset1:179
  s_waitcnt lgkmcnt(6)
  v_mfma_f32_16x16x32_bf16 v[60:63], v[92:95], a[28:31], 0
  v_mfma_f32_16x16x32_bf16 v[64:67], v[92:95], a[60:63], 0
  v_mfma_f32_16x16x32_bf16 v[68:71], v[92:95], a[92:95], 0
  v_mfma_f32_16x16x32_bf16 v[72:75], v[92:95], a[124:127], 0
  v_mfma_f32_16x16x32_bf16 v[76:79], v[92:95], a[156:159], 0
  v_mfma_f32_16x16x32_bf16 v[80:83], v[92:95], a[188:191], 0
  v_mfma_f32_16x16x32_bf16 v[84:87], v[92:95], a[220:223], 0
  v_mfma_f32_16x16x32_bf16 v[88:91], v[92:95], a[252:255], 0
  ds_read2_b32 v[92:93], v52 offset0:160 offset1:161
  ds_read2_b32 v[94:95], v52 offset0:162 offset1:163
  s_waitcnt lgkmcnt(6)
  v_mfma_f32_16x16x32_bf16 v[60:63], v[96:99], a[24:27], v[60:63]
  v_mfma_f32_16x16x32_bf16 v[64:67], v[96:99], a[56:59], v[64:67]
  v_mfma_f32_16x16x32_bf16 v[68:71], v[96:99], a[88:91], v[68:71]
  v_mfma_f32_16x16x32_bf16 v[72:75], v[96:99], a[120:123], v[72:75]
  v_mfma_f32_16x16x32_bf16 v[76:79], v[96:99], a[152:155], v[76:79]
  v_mfma_f32_16x16x32_bf16 v[80:83], v[96:99], a[184:187], v[80:83]
  v_mfma_f32_16x16x32_bf16 v[84:87], v[96:99], a[216:219], v[84:87]
  v_mfma_f32_16x16x32_bf16 v[88:91], v[96:99], a[248:251], v[88:91]
  ds_read2_b32 v[96:97], v52 offset0:144 offset1:145
  ds_read2_b32 v[98:99], v52 offset0:146 offset1:147
  s_waitcnt lgkmcnt(6)
  v_mfma_f32_16x16x32_bf16 v[60:63], v[100:103], a[20:23], v[60:63]
  v_mfma_f32_16x16x32_bf16 v[64:67], v[100:103], a[52:55], v[64:67]
  v_mfma_f32_16x16x32_bf16 v[68:71], v[100:103], a[84:87], v[68:71]
  v_mfma_f32_16x16x32_bf16 v[72:75], v[100:103], a[116:119], v[72:75]
  v_mfma_f32_16x16x32_bf16 v[76:79], v[100:103], a[148:151], v[76:79]
  v_mfma_f32_16x16x32_bf16 v[80:83], v[100:103], a[180:183], v[80:83]
  v_mfma_f32_16x16x32_bf16 v[84:87], v[100:103], a[212:215], v[84:87]
  v_mfma_f32_16x16x32_bf16 v[88:91], v[100:103], a[244:247], v[88:91]
  ds_read2_b32 v[100:101], v52 offset0:128 offset1:129
  ds_read2_b32 v[102:103], v52 offset0:130 offset1:131
  s_waitcnt lgkmcnt(6)
  v_mfma_f32_16x16x32_bf16 v[60:63], v[104:107], a[16:19], v[60:63]
  v_mfma_f32_16x16x32_bf16 v[64:67], v[104:107], a[48:51], v[64:67]
  v_mfma_f32_16x16x32_bf16 v[68:71], v[104:107], a[80:83], v[68:71]
  v_mfma_f32_16x16x32_bf16 v[72:75], v[104:107], a[112:115], v[72:75]
  v_mfma_f32_16x16x32_bf16 v[76:79], v[104:107], a[144:147], v[76:79]
  v_mfma_f32_16x16x32_bf16 v[80:83], v[104:107], a[176:179], v[80:83]
  v_mfma_f32_16x16x32_bf16 v[84:87], v[104:107], a[208:211], v[84:87]
  v_mfma_f32_16x16x32_bf16 v[88:91], v[104:107], a[240:243], v[88:91]
  ds_read2_b32 v[104:105], v52 offset0:112 offset1:113
  ds_read2_b32 v[106:107], v52 offset0:114 offset1:115
  s_waitcnt lgkmcnt(6)
  v_mfma_f32_16x16x32_bf16 v[60:63], v[92:95], a[12:15], v[60:63]
  v_mfma_f32_16x16x32_bf16 v[64:67], v[92:95], a[44:47], v[64:67]
  v_mfma_f32_16x16x32_bf16 v[68:71], v[92:95], a[76:79], v[68:71]
  v_mfma_f32_16x16x32_bf16 v[72:75], v[92:95], a[108:111], v[72:75]
  v_mfma_f32_16x16x32_bf16 v[76:79], v[92:95], a[140:143], v[76:79]
  v_mfma_f32_16x16x32_bf16 v[80:83], v[92:95], a[172:175], v[80:83]
  v_mfma_f32_16x16x32_bf16 v[84:87], v[92:95], a[204:207], v[84:87]
  v_mfma_f32_16x16x32_bf16 v[88:91], v[92:95], a[236:239], v[88:91]
  ds_read2_b32 v[92:93], v52 offset0:96 offset1:97
  ds_read2_b32 v[94:95], v52 offset0:98 offset1:99
  s_waitcnt lgkmcnt(6)
  v_mfma_f32_16x16x32_bf16 v[60:63], v[96:99], a[8:11], v[60:63]
  v_mfma_f32_16x16x32_bf16 v[64:67], v[96:99], a[40:43], v[64:67]
  v_mfma_f32_16x16x32_bf16 v[68:71], v[96:99], a[72:75], v[68:71]
  v_mfma_f32_16x16x32_bf16 v[72:75], v[96:99], a[104:107], v[72:75]
  v_mfma_f32_16x16x32_bf16 v[76:79], v[96:99], a[136:139], v[76:79]
  v_mfma_f32_16x16x32_bf16 v[80:83], v[96:99], a[168:171], v[80:83]
  v_mfma_f32_16x16x32_bf16 v[84:87], v[96:99], a[200:203], v[84:87]
  v_mfma_f32_16x16x32_bf16 v[88:91], v[96:99], a[232:235], v[88:91]
  ds_read2_b32 v[96:97], v52 offset0:80 offset1:81
  ds_read2_b32 v[98:99], v52 offset0:82 offset1:83
  s_waitcnt lgkmcnt(6)
  v_mfma_f32_16x16x32_bf16 v[60:63], v[100:103], a[4:7], v[60:63]
  v_mfma_f32_16x16x32_bf16 v[64:67], v[100:103], a[36:39], v[64:67]
  v_mfma_f32_16x16x32_bf16 v[68:71], v[100:103], a[68:71], v[68:71]
  v_mfma_f32_16x16x32_bf16 v[72:75], v[100:103], a[100:103], v[72:75]
  v_mfma_f32_16x16x32_bf16 v[76:79], v[100:103], a[132:135], v[76:79]
  v_mfma_f32_16x16x32_bf16 v[80:83], v[100:103], a[164:167], v[80:83]
  v_mfma_f32_16x16x32_bf16 v[84:87], v[100:103], a[196:199], v[84:87]
  v_mfma_f32_16x16x32_bf16 v[88:91], v[100:103], a[228:231], v[88:91]
  ds_read2_b32 v[100:101], v52 offset0:64 offset1:65
  ds_read2_b32 v[102:103], v52 offset0:66 offset1:67
  s_waitcnt lgkmcnt(6)
  v_mfma_f32_16x16x32_bf16 v[60:63], v[104:107], a[0:3], v[60:63]
  v_mfma_f32_16x16x32_bf16 v[64:67], v[104:107], a[32:35], v[64:67]
  v_mfma_f32_16x16x32_bf16 v[68:71], v[104:107], a[64:67], v[68:71]
  v_mfma_f32_16x16x32_bf16 v[72:75], v[104:107], a[96:99], v[72:75]
  v_mfma_f32_16x16x32_bf16 v[76:79], v[104:107], a[128:131], v[76:79]
  v_mfma_f32_16x16x32_bf16 v[80:83], v[104:107], a[160:163], v[80:83]
  v_mfma_f32_16x16x32_bf16 v[84:87], v[104:107], a[192:195], v[84:87]
  v_mfma_f32_16x16x32_bf16 v[88:91], v[104:107], a[224:227], v[88:91]
  ds_read2_b32 v[104:105], v52 offset0:48 offset1:49
  ds_read2_b32 v[106:107], v52 offset0:50 offset1:51
  s_waitcnt lgkmcnt(6)
  v_mfma_f32_16x16x32_bf16 v[64:67], v[92:95], a[28:31], v[64:67]
  v_mfma_f32_16x16x32_bf16 v[68:71], v[92:95], a[60:63], v[68:71]
  v_mfma_f32_16x16x32_bf16 v[72:75], v[92:95], a[92:95], v[72:75]
  v_mfma_f32_16x16x32_bf16 v[76:79], v[92:95], a[124:127], v[76:79]
  v_mfma_f32_16x16x32_bf16 v[80:83], v[92:95], a[156:159], v[80:83]
  v_mfma_f32_16x16x32_bf16 v[84:87], v[92:95], a[188:191], v[84:87]
  v_mfma_f32_16x16x32_bf16 v[88:91], v[92:95], a[220:223], v[88:91]
  ds_read2_b32 v[92:93], v52 offset0:32 offset1:33
  ds_read2_b32 v[94:95], v52 offset0:34 offset1:35
  s_waitcnt lgkmcnt(6)
  v_mfma_f32_16x16x32_bf16 v[64:67], v[96:99], a[24:27], v[64:67]
  v_mfma_f32_16x16x32_bf16 v[68:71], v[96:99], a[56:59], v[68:71]
  v_mfma_f32_16x16x32_bf16 v[72:75], v[96:99], a[88:91], v[72:75]
  v_mfma_f32_16x16x32_bf16 v[76:79], v[96:99], a[120:123], v[76:79]
  v_mfma_f32_16x16x32_bf16 v[80:83], v[96:99], a[152:155], v[80:83]
  v_mfma_f32_16x16x32_bf16 v[84:87], v[96:99], a[184:187], v[84:87]
  v_mfma_f32_16x16x32_bf16 v[88:91], v[96:99], a[216:219], v[88:91]
  ds_read2_b32 v[96:97], v52 offset0:16 offset1:17
  ds_read2_b32 v[98:99], v52 offset0:18 offset1:19
  s_waitcnt lgkmcnt(6)
  v_mfma_f32_16x16x32_bf16 v[64:67], v[100:103], a[20:23], v[64:67]
  v_mfma_f32_16x16x32_bf16 v[68:71], v[100:103], a[52:55], v[68:71]
  v_mfma_f32_16x16x32_bf16 v[72:75], v[100:103], a[84:87], v[72:75]
  v_mfma_f32_16x16x32_bf16 v[76:79], v[100:103], a[116:119], v[76:79]
  v_mfma_f32_16x16x32_bf16 v[80:83], v[100:103], a[148:151], v[80:83]
  v_mfma_f32_16x16x32_bf16 v[84:87], v[100:103], a[180:183], v[84:87]
  v_mfma_f32_16x16x32_bf16 v[88:91], v[100:103], a[212:215], v[88:91]
  ds_read2_b32 v[100:101], v52 offset0:0 offset1:1
  ds_read2_b32 v[102:103], v52 offset0:2 offset1:3
  s_waitcnt lgkmcnt(6)
  v_mfma_f32_16x16x32_bf16 v[64:67], v[104:107], a[16:19], v[64:67]
  v_mfma_f32_16x16x32_bf16 v[68:71], v[104:107], a[48:51], v[68:71]
  v_mfma_f32_16x16x32_bf16 v[72:75], v[104:107], a[80:83], v[72:75]
  v_mfma_f32_16x16x32_bf16 v[76:79], v[104:107], a[112:115], v[76:79]
  v_mfma_f32_16x16x32_bf16 v[80:83], v[104:107], a[144:147], v[80:83]
  v_mfma_f32_16x16x32_bf16 v[84:87], v[104:107], a[176:179], v[84:87]
  v_mfma_f32_16x16x32_bf16 v[88:91], v[104:107], a[208:211], v[88:91]
  ds_read2_b32 v[104:105], v53 offset0:224 offset1:225
  ds_read2_b32 v[106:107], v53 offset0:226 offset1:227
  s_waitcnt lgkmcnt(6)
  v_mfma_f32_16x16x32_bf16 v[64:67], v[92:95], a[12:15], v[64:67]
  v_mfma_f32_16x16x32_bf16 v[68:71], v[92:95], a[44:47], v[68:71]
  v_mfma_f32_16x16x32_bf16 v[72:75], v[92:95], a[76:79], v[72:75]
  v_mfma_f32_16x16x32_bf16 v[76:79], v[92:95], a[108:111], v[76:79]
  v_mfma_f32_16x16x32_bf16 v[80:83], v[92:95], a[140:143], v[80:83]
  v_mfma_f32_16x16x32_bf16 v[84:87], v[92:95], a[172:175], v[84:87]
  v_mfma_f32_16x16x32_bf16 v[88:91], v[92:95], a[204:207], v[88:91]
  ds_read2_b32 v[92:93], v53 offset0:208 offset1:209
  ds_read2_b32 v[94:95], v53 offset0:210 offset1:211
  s_waitcnt lgkmcnt(6)
  v_mfma_f32_16x16x32_bf16 v[64:67], v[96:99], a[8:11], v[64:67]
  v_mfma_f32_16x16x32_bf16 v[68:71], v[96:99], a[40:43], v[68:71]
  v_mfma_f32_16x16x32_bf16 v[72:75], v[96:99], a[72:75], v[72:75]
  v_mfma_f32_16x16x32_bf16 v[76:79], v[96:99], a[104:107], v[76:79]
  v_mfma_f32_16x16x32_bf16 v[80:83], v[96:99], a[136:139], v[80:83]
  v_mfma_f32_16x16x32_bf16 v[84:87], v[96:99], a[168:171], v[84:87]
  v_mfma_f32_16x16x32_bf16 v[88:91], v[96:99], a[200:203], v[88:91]
  ds_read2_b32 v[96:97], v53 offset0:192 offset1:193
  ds_read2_b32 v[98:99], v53 offset0:194 offset1:195
  s_waitcnt lgkmcnt(6)
  v_mfma_f32_16x16x32_bf16 v[64:67], v[100:103], a[4:7], v[64:67]
  v_mfma_f32_16x16x32_bf16 v[68:71], v[100:103], a[36:39], v[68:71]
  v_mfma_f32_16x16x32_bf16 v[72:75], v[100:103], a[68:71], v[72:75]
  v_mfma_f32_16x16x32_bf16 v[76:79], v[100:103], a[100:103], v[76:79]
  v_mfma_f32_16x16x32_bf16 v[80:83], v[100:103], a[132:135], v[80:83]
  v_mfma_f32_16x16x32_bf16 v[84:87], v[100:103], a[164:167], v[84:87]
  v_mfma_f32_16x16x32_bf16 v[88:91], v[100:103], a[196:199], v[88:91]
  ds_read2_b32 v[100:101], v53 offset0:176 offset1:177
  ds_read2_b32 v[102:103], v53 offset0:178 offset1:179
  s_waitcnt lgkmcnt(6)
  v_mfma_f32_16x16x32_bf16 v[64:67], v[104:107], a[0:3], v[64:67]
  v_mfma_f32_16x16x32_bf16 v[68:71], v[104:107], a[32:35], v[68:71]
  v_mfma_f32_16x16x32_bf16 v[72:75], v[104:107], a[64:67], v[72:75]
  v_mfma_f32_16x16x32_bf16 v[76:79], v[104:107], a[96:99], v[76:79]
  v_mfma_f32_16x16x32_bf16 v[80:83], v[104:107], a[128:131], v[80:83]
  v_mfma_f32_16x16x32_bf16 v[84:87], v[104:107], a[160:163], v[84:87]
  v_mfma_f32_16x16x32_bf16 v[88:91], v[104:107], a[192:195], v[88:91]
  ds_read2_b32 v[104:105], v53 offset0:160 offset1:161
  ds_read2_b32 v[106:107], v53 offset0:162 offset1:163
  s_waitcnt lgkmcnt(6)
  v_mfma_f32_16x16x32_bf16 v[68:71], v[92:95], a[28:31], v[68:71]
  v_mfma_f32_16x16x32_bf16 v[72:75], v[92:95], a[60:63], v[72:75]
  v_mfma_f32_16x16x32_bf16 v[76:79], v[92:95], a[92:95], v[76:79]
  v_mfma_f32_16x16x32_bf16 v[80:83], v[92:95], a[124:127], v[80:83]
  v_mfma_f32_16x16x32_bf16 v[84:87], v[92:95], a[156:159], v[84:87]
  v_mfma_f32_16x16x32_bf16 v[88:91], v[92:95], a[188:191], v[88:91]
  ds_read2_b32 v[92:93], v53 offset0:144 offset1:145
  ds_read2_b32 v[94:95], v53 offset0:146 offset1:147
  s_waitcnt lgkmcnt(6)
  v_mfma_f32_16x16x32_bf16 v[68:71], v[96:99], a[24:27], v[68:71]
  v_mfma_f32_16x16x32_bf16 v[72:75], v[96:99], a[56:59], v[72:75]
  v_mfma_f32_16x16x32_bf16 v[76:79], v[96:99], a[88:91], v[76:79]
  v_mfma_f32_16x16x32_bf16 v[80:83], v[96:99], a[120:123], v[80:83]
  v_mfma_f32_16x16x32_bf16 v[84:87], v[96:99], a[152:155], v[84:87]
  v_mfma_f32_16x16x32_bf16 v[88:91], v[96:99], a[184:187], v[88:91]
  ds_read2_b32 v[96:97], v53 offset0:128 offset1:129
  ds_read2_b32 v[98:99], v53 offset0:130 offset1:131
  s_waitcnt lgkmcnt(6)
  v_mfma_f32_16x16x32_bf16 v[68:71], v[100:103], a[20:23], v[68:71]
  v_mfma_f32_16x16x32_bf16 v[72:75], v[100:103], a[52:55], v[72:75]
  v_mfma_f32_16x16x32_bf16 v[76:79], v[100:103], a[84:87], v[76:79]
  v_mfma_f32_16x16x32_bf16 v[80:83], v[100:103], a[116:119], v[80:83]
  v_mfma_f32_16x16x32_bf16 v[84:87], v[100:103], a[148:151], v[84:87]
  v_mfma_f32_16x16x32_bf16 v[88:91], v[100:103], a[180:183], v[88:91]
  ds_read2_b32 v[100:101], v53 offset0:112 offset1:113
  ds_read2_b32 v[102:103], v53 offset0:114 offset1:115
  s_waitcnt lgkmcnt(6)
  v_mfma_f32_16x16x32_bf16 v[68:71], v[104:107], a[16:19], v[68:71]
  v_mfma_f32_16x16x32_bf16 v[72:75], v[104:107], a[48:51], v[72:75]
  v_mfma_f32_16x16x32_bf16 v[76:79], v[104:107], a[80:83], v[76:79]
  v_mfma_f32_16x16x32_bf16 v[80:83], v[104:107], a[112:115], v[80:83]
  v_mfma_f32_16x16x32_bf16 v[84:87], v[104:107], a[144:147], v[84:87]
  v_mfma_f32_16x16x32_bf16 v[88:91], v[104:107], a[176:179], v[88:91]
  ds_read2_b32 v[104:105], v53 offset0:96 offset1:97
  ds_read2_b32 v[106:107], v53 offset0:98 offset1:99
  s_waitcnt lgkmcnt(6)
  v_mfma_f32_16x16x32_bf16 v[68:71], v[92:95], a[12:15], v[68:71]
  v_mfma_f32_16x16x32_bf16 v[72:75], v[92:95], a[44:47], v[72:75]
  v_mfma_f32_16x16x32_bf16 v[76:79], v[92:95], a[76:79], v[76:79]
  v_mfma_f32_16x16x32_bf16 v[80:83], v[92:95], a[108:111], v[80:83]
  v_mfma_f32_16x16x32_bf16 v[84:87], v[92:95], a[140:143], v[84:87]
  v_mfma_f32_16x16x32_bf16 v[88:91], v[92:95], a[172:175], v[88:91]
  ds_read2_b32 v[92:93], v53 offset0:80 offset1:81
  ds_read2_b32 v[94:95], v53 offset0:82 offset1:83
  s_waitcnt lgkmcnt(6)
  v_mfma_f32_16x16x32_bf16 v[68:71], v[96:99], a[8:11], v[68:71]
  v_mfma_f32_16x16x32_bf16 v[72:75], v[96:99], a[40:43], v[72:75]
  v_mfma_f32_16x16x32_bf16 v[76:79], v[96:99], a[72:75], v[76:79]
  v_mfma_f32_16x16x32_bf16 v[80:83], v[96:99], a[104:107], v[80:83]
  v_mfma_f32_16x16x32_bf16 v[84:87], v[96:99], a[136:139], v[84:87]
  v_mfma_f32_16x16x32_bf16 v[88:91], v[96:99], a[168:171], v[88:91]
  ds_read2_b32 v[96:97], v53 offset0:64 offset1:65
  ds_read2_b32 v[98:99], v53 offset0:66 offset1:67
  s_waitcnt lgkmcnt(6)
  v_mfma_f32_16x16x32_bf16 v[68:71], v[100:103], a[4:7], v[68:71]
  v_mfma_f32_16x16x32_bf16 v[72:75], v[100:103], a[36:39], v[72:75]
  v_mfma_f32_16x16x32_bf16 v[76:79], v[100:103], a[68:71], v[76:79]
  v_mfma_f32_16x16x32_bf16 v[80:83], v[100:103], a[100:103], v[80:83]
  v_mfma_f32_16x16x32_bf16 v[84:87], v[100:103], a[132:135], v[84:87]
  v_mfma_f32_16x16x32_bf16 v[88:91], v[100:103], a[164:167], v[88:91]
  ds_read2_b32 v[100:101], v53 offset0:48 offset1:49
  ds_read2_b32 v[102:103], v53 offset0:50 offset1:51
  s_waitcnt lgkmcnt(6)
  v_mfma_f32_16x16x32_bf16 v[68:71], v[104:107], a[0:3], v[68:71]
  v_mfma_f32_16x16x32_bf16 v[72:75], v[104:107], a[32:35], v[72:75]
  v_mfma_f32_16x16x32_bf16 v[76:79], v[104:107], a[64:67], v[76:79]
  v_mfma_f32_16x16x32_bf16 v[80:83], v[104:107], a[96:99], v[80:83]
  v_mfma_f32_16x16x32_bf16 v[84:87], v[104:107], a[128:131], v[84:87]
  v_mfma_f32_16x16x32_bf16 v[88:91], v[104:107], a[160:163], v[88:91]
  ds_read2_b32 v[104:105], v53 offset0:32 offset1:33
  ds_read2_b32 v[106:107], v53 offset0:34 offset1:35
  s_waitcnt lgkmcnt(6)
  v_mfma_f32_16x16x32_bf16 v[72:75], v[92:95], a[28:31], v[72:75]
  v_mfma_f32_16x16x32_bf16 v[76:79], v[92:95], a[60:63], v[76:79]
  v_mfma_f32_16x16x32_bf16 v[80:83], v[92:95], a[92:95], v[80:83]
  v_mfma_f32_16x16x32_bf16 v[84:87], v[92:95], a[124:127], v[84:87]
  v_mfma_f32_16x16x32_bf16 v[88:91], v[92:95], a[156:159], v[88:91]
  ds_read2_b32 v[92:93], v53 offset0:16 offset1:17
  ds_read2_b32 v[94:95], v53 offset0:18 offset1:19
  s_waitcnt lgkmcnt(6)
  v_mfma_f32_16x16x32_bf16 v[72:75], v[96:99], a[24:27], v[72:75]
  v_mfma_f32_16x16x32_bf16 v[76:79], v[96:99], a[56:59], v[76:79]
  v_mfma_f32_16x16x32_bf16 v[80:83], v[96:99], a[88:91], v[80:83]
  v_mfma_f32_16x16x32_bf16 v[84:87], v[96:99], a[120:123], v[84:87]
  v_mfma_f32_16x16x32_bf16 v[88:91], v[96:99], a[152:155], v[88:91]
  ds_read2_b32 v[96:97], v53 offset0:0 offset1:1
  ds_read2_b32 v[98:99], v53 offset0:2 offset1:3
  s_waitcnt lgkmcnt(6)
  v_mfma_f32_16x16x32_bf16 v[72:75], v[100:103], a[20:23], v[72:75]
  v_mfma_f32_16x16x32_bf16 v[76:79], v[100:103], a[52:55], v[76:79]
  v_mfma_f32_16x16x32_bf16 v[80:83], v[100:103], a[84:87], v[80:83]
  v_mfma_f32_16x16x32_bf16 v[84:87], v[100:103], a[116:119], v[84:87]
  v_mfma_f32_16x16x32_bf16 v[88:91], v[100:103], a[148:151], v[88:91]
  ds_read2_b32 v[100:101], v54 offset0:224 offset1:225
  ds_read2_b32 v[102:103], v54 offset0:226 offset1:227
  s_waitcnt lgkmcnt(6)
  v_mfma_f32_16x16x32_bf16 v[72:75], v[104:107], a[16:19], v[72:75]
  v_mfma_f32_16x16x32_bf16 v[76:79], v[104:107], a[48:51], v[76:79]
  v_mfma_f32_16x16x32_bf16 v[80:83], v[104:107], a[80:83], v[80:83]
  v_mfma_f32_16x16x32_bf16 v[84:87], v[104:107], a[112:115], v[84:87]
  v_mfma_f32_16x16x32_bf16 v[88:91], v[104:107], a[144:147], v[88:91]
  ds_read2_b32 v[104:105], v54 offset0:208 offset1:209
  ds_read2_b32 v[106:107], v54 offset0:210 offset1:211
  s_waitcnt lgkmcnt(6)
  v_mfma_f32_16x16x32_bf16 v[72:75], v[92:95], a[12:15], v[72:75]
  v_mfma_f32_16x16x32_bf16 v[76:79], v[92:95], a[44:47], v[76:79]
  v_mfma_f32_16x16x32_bf16 v[80:83], v[92:95], a[76:79], v[80:83]
  v_mfma_f32_16x16x32_bf16 v[84:87], v[92:95], a[108:111], v[84:87]
  v_mfma_f32_16x16x32_bf16 v[88:91], v[92:95], a[140:143], v[88:91]
  ds_read2_b32 v[92:93], v54 offset0:192 offset1:193
  ds_read2_b32 v[94:95], v54 offset0:194 offset1:195
  s_waitcnt lgkmcnt(6)
  v_mfma_f32_16x16x32_bf16 v[72:75], v[96:99], a[8:11], v[72:75]
  v_mfma_f32_16x16x32_bf16 v[76:79], v[96:99], a[40:43], v[76:79]
  v_mfma_f32_16x16x32_bf16 v[80:83], v[96:99], a[72:75], v[80:83]
  v_mfma_f32_16x16x32_bf16 v[84:87], v[96:99], a[104:107], v[84:87]
  v_mfma_f32_16x16x32_bf16 v[88:91], v[96:99], a[136:139], v[88:91]
  ds_read2_b32 v[96:97], v54 offset0:176 offset1:177
  ds_read2_b32 v[98:99], v54 offset0:178 offset1:179
  s_waitcnt lgkmcnt(6)
  v_mfma_f32_16x16x32_bf16 v[72:75], v[100:103], a[4:7], v[72:75]
  v_mfma_f32_16x16x32_bf16 v[76:79], v[100:103], a[36:39], v[76:79]
  v_mfma_f32_16x16x32_bf16 v[80:83], v[100:103], a[68:71], v[80:83]
  v_mfma_f32_16x16x32_bf16 v[84:87], v[100:103], a[100:103], v[84:87]
  v_mfma_f32_16x16x32_bf16 v[88:91], v[100:103], a[132:135], v[88:91]
  ds_read2_b32 v[100:101], v54 offset0:160 offset1:161
  ds_read2_b32 v[102:103], v54 offset0:162 offset1:163
  s_waitcnt lgkmcnt(6)
  v_mfma_f32_16x16x32_bf16 v[72:75], v[104:107], a[0:3], v[72:75]
  v_mfma_f32_16x16x32_bf16 v[76:79], v[104:107], a[32:35], v[76:79]
  v_mfma_f32_16x16x32_bf16 v[80:83], v[104:107], a[64:67], v[80:83]
  v_mfma_f32_16x16x32_bf16 v[84:87], v[104:107], a[96:99], v[84:87]
  v_mfma_f32_16x16x32_bf16 v[88:91], v[104:107], a[128:131], v[88:91]
  ds_read2_b32 v[104:105], v54 offset0:144 offset1:145
  ds_read2_b32 v[106:107], v54 offset0:146 offset1:147
  s_waitcnt lgkmcnt(6)
  v_mfma_f32_16x16x32_bf16 v[76:79], v[92:95], a[28:31], v[76:79]
  v_mfma_f32_16x16x32_bf16 v[80:83], v[92:95], a[60:63], v[80:83]
  v_mfma_f32_16x16x32_bf16 v[84:87], v[92:95], a[92:95], v[84:87]
  v_mfma_f32_16x16x32_bf16 v[88:91], v[92:95], a[124:127], v[88:91]
  ds_read2_b32 v[92:93], v54 offset0:128 offset1:129
  ds_read2_b32 v[94:95], v54 offset0:130 offset1:131
  s_waitcnt lgkmcnt(6)
  v_mfma_f32_16x16x32_bf16 v[76:79], v[96:99], a[24:27], v[76:79]
  v_mfma_f32_16x16x32_bf16 v[80:83], v[96:99], a[56:59], v[80:83]
  v_mfma_f32_16x16x32_bf16 v[84:87], v[96:99], a[88:91], v[84:87]
  v_mfma_f32_16x16x32_bf16 v[88:91], v[96:99], a[120:123], v[88:91]
  ds_read2_b32 v[96:97], v54 offset0:112 offset1:113
  ds_read2_b32 v[98:99], v54 offset0:114 offset1:115
  s_waitcnt lgkmcnt(6)
  v_mfma_f32_16x16x32_bf16 v[76:79], v[100:103], a[20:23], v[76:79]
  v_mfma_f32_16x16x32_bf16 v[80:83], v[100:103], a[52:55], v[80:83]
  v_mfma_f32_16x16x32_bf16 v[84:87], v[100:103], a[84:87], v[84:87]
  v_mfma_f32_16x16x32_bf16 v[88:91], v[100:103], a[116:119], v[88:91]
  ds_read2_b32 v[100:101], v54 offset0:96 offset1:97
  ds_read2_b32 v[102:103], v54 offset0:98 offset1:99
  s_waitcnt lgkmcnt(6)
  v_mfma_f32_16x16x32_bf16 v[76:79], v[104:107], a[16:19], v[76:79]
  v_mfma_f32_16x16x32_bf16 v[80:83], v[104:107], a[48:51], v[80:83]
  v_mfma_f32_16x16x32_bf16 v[84:87], v[104:107], a[80:83], v[84:87]
  v_mfma_f32_16x16x32_bf16 v[88:91], v[104:107], a[112:115], v[88:91]
  ds_read2_b32 v[104:105], v54 offset0:80 offset1:81
  ds_read2_b32 v[106:107], v54 offset0:82 offset1:83
  s_waitcnt lgkmcnt(6)
  v_mfma_f32_16x16x32_bf16 v[76:79], v[92:95], a[12:15], v[76:79]
  v_mfma_f32_16x16x32_bf16 v[80:83], v[92:95], a[44:47], v[80:83]
  v_mfma_f32_16x16x32_bf16 v[84:87], v[92:95], a[76:79], v[84:87]
  v_mfma_f32_16x16x32_bf16 v[88:91], v[92:95], a[108:111], v[88:91]
  ds_read2_b32 v[92:93], v54 offset0:64 offset1:65
  ds_read2_b32 v[94:95], v54 offset0:66 offset1:67
  s_waitcnt lgkmcnt(6)
  v_mfma_f32_16x16x32_bf16 v[76:79], v[96:99], a[8:11], v[76:79]
  v_mfma_f32_16x16x32_bf16 v[80:83], v[96:99], a[40:43], v[80:83]
  v_mfma_f32_16x16x32_bf16 v[84:87], v[96:99], a[72:75], v[84:87]
  v_mfma_f32_16x16x32_bf16 v[88:91], v[96:99], a[104:107], v[88:91]
  ds_read2_b32 v[96:97], v54 offset0:48 offset1:49
  ds_read2_b32 v[98:99], v54 offset0:50 offset1:51
  s_waitcnt lgkmcnt(6)
  v_mfma_f32_16x16x32_bf16 v[76:79], v[100:103], a[4:7], v[76:79]
  v_mfma_f32_16x16x32_bf16 v[80:83], v[100:103], a[36:39], v[80:83]
  v_mfma_f32_16x16x32_bf16 v[84:87], v[100:103], a[68:71], v[84:87]
  v_mfma_f32_16x16x32_bf16 v[88:91], v[100:103], a[100:103], v[88:91]
  ds_read2_b32 v[100:101], v54 offset0:32 offset1:33
  ds_read2_b32 v[102:103], v54 offset0:34 offset1:35
  s_waitcnt lgkmcnt(6)
  v_mfma_f32_16x16x32_bf16 v[76:79], v[104:107], a[0:3], v[76:79]
  v_mfma_f32_16x16x32_bf16 v[80:83], v[104:107], a[32:35], v[80:83]
  v_mfma_f32_16x16x32_bf16 v[84:87], v[104:107], a[64:67], v[84:87]
  v_mfma_f32_16x16x32_bf16 v[88:91], v[104:107], a[96:99], v[88:91]
  ds_read2_b32 v[104:105], v54 offset0:16 offset1:17
  ds_read2_b32 v[106:107], v54 offset0:18 offset1:19
  s_waitcnt lgkmcnt(6)
  v_mfma_f32_16x16x32_bf16 v[80:83], v[92:95], a[28:31], v[80:83]
  v_mfma_f32_16x16x32_bf16 v[84:87], v[92:95], a[60:63], v[84:87]
  v_mfma_f32_16x16x32_bf16 v[88:91], v[92:95], a[92:95], v[88:91]
  ds_read2_b32 v[92:93], v54 offset0:0 offset1:1
  ds_read2_b32 v[94:95], v54 offset0:2 offset1:3
  s_waitcnt lgkmcnt(6)
  v_mfma_f32_16x16x32_bf16 v[80:83], v[96:99], a[24:27], v[80:83]
  v_mfma_f32_16x16x32_bf16 v[84:87], v[96:99], a[56:59], v[84:87]
  v_mfma_f32_16x16x32_bf16 v[88:91], v[96:99], a[88:91], v[88:91]
  ds_read2_b32 v[96:97], v55 offset0:224 offset1:225
  ds_read2_b32 v[98:99], v55 offset0:226 offset1:227
  s_waitcnt lgkmcnt(6)
  v_mfma_f32_16x16x32_bf16 v[80:83], v[100:103], a[20:23], v[80:83]
  v_mfma_f32_16x16x32_bf16 v[84:87], v[100:103], a[52:55], v[84:87]
  v_mfma_f32_16x16x32_bf16 v[88:91], v[100:103], a[84:87], v[88:91]
  ds_read2_b32 v[100:101], v55 offset0:208 offset1:209
  ds_read2_b32 v[102:103], v55 offset0:210 offset1:211
  s_waitcnt lgkmcnt(6)
  v_mfma_f32_16x16x32_bf16 v[80:83], v[104:107], a[16:19], v[80:83]
  v_mfma_f32_16x16x32_bf16 v[84:87], v[104:107], a[48:51], v[84:87]
  v_mfma_f32_16x16x32_bf16 v[88:91], v[104:107], a[80:83], v[88:91]
  ds_read2_b32 v[104:105], v55 offset0:192 offset1:193
  ds_read2_b32 v[106:107], v55 offset0:194 offset1:195
  s_waitcnt lgkmcnt(6)
  v_mfma_f32_16x16x32_bf16 v[80:83], v[92:95], a[12:15], v[80:83]
  v_mfma_f32_16x16x32_bf16 v[84:87], v[92:95], a[44:47], v[84:87]
  v_mfma_f32_16x16x32_bf16 v[88:91], v[92:95], a[76:79], v[88:91]
  ds_read2_b32 v[92:93], v55 offset0:176 offset1:177
  ds_read2_b32 v[94:95], v55 offset0:178 offset1:179
  s_waitcnt lgkmcnt(6)
  v_mfma_f32_16x16x32_bf16 v[80:83], v[96:99], a[8:11], v[80:83]
  v_mfma_f32_16x16x32_bf16 v[84:87], v[96:99], a[40:43], v[84:87]
  v_mfma_f32_16x16x32_bf16 v[88:91], v[96:99], a[72:75], v[88:91]
  ds_read2_b32 v[96:97], v55 offset0:160 offset1:161
  ds_read2_b32 v[98:99], v55 offset0:162 offset1:163
  s_waitcnt lgkmcnt(6)
  v_mfma_f32_16x16x32_bf16 v[80:83], v[100:103], a[4:7], v[80:83]
  v_mfma_f32_16x16x32_bf16 v[84:87], v[100:103], a[36:39], v[84:87]
  v_mfma_f32_16x16x32_bf16 v[88:91], v[100:103], a[68:71], v[88:91]
  ds_read2_b32 v[100:101], v55 offset0:144 offset1:145
  ds_read2_b32 v[102:103], v55 offset0:146 offset1:147
  s_waitcnt lgkmcnt(6)
  v_mfma_f32_16x16x32_bf16 v[80:83], v[104:107], a[0:3], v[80:83]
  v_mfma_f32_16x16x32_bf16 v[84:87], v[104:107], a[32:35], v[84:87]
  v_mfma_f32_16x16x32_bf16 v[88:91], v[104:107], a[64:67], v[88:91]
  ds_read2_b32 v[104:105], v55 offset0:128 offset1:129
  ds_read2_b32 v[106:107], v55 offset0:130 offset1:131
  s_waitcnt lgkmcnt(6)
  v_mfma_f32_16x16x32_bf16 v[84:87], v[92:95], a[28:31], v[84:87]
  v_mfma_f32_16x16x32_bf16 v[88:91], v[92:95], a[60:63], v[88:91]
  ds_read2_b32 v[92:93], v55 offset0:112 offset1:113
  ds_read2_b32 v[94:95], v55 offset0:114 offset1:115
  s_waitcnt lgkmcnt(6)
  v_mfma_f32_16x16x32_bf16 v[84:87], v[96:99], a[24:27], v[84:87]
  v_mfma_f32_16x16x32_bf16 v[88:91], v[96:99], a[56:59], v[88:91]
  ds_read2_b32 v[96:97], v55 offset0:96 offset1:97
  ds_read2_b32 v[98:99], v55 offset0:98 offset1:99
  s_waitcnt lgkmcnt(6)
  v_mfma_f32_16x16x32_bf16 v[84:87], v[100:103], a[20:23], v[84:87]
  v_mfma_f32_16x16x32_bf16 v[88:91], v[100:103], a[52:55], v[88:91]
  ds_read2_b32 v[100:101], v55 offset0:80 offset1:81
  ds_read2_b32 v[102:103], v55 offset0:82 offset1:83
  s_waitcnt lgkmcnt(6)
  v_mfma_f32_16x16x32_bf16 v[84:87], v[104:107], a[16:19], v[84:87]
  v_mfma_f32_16x16x32_bf16 v[88:91], v[104:107], a[48:51], v[88:91]
  ds_read2_b32 v[104:105], v55 offset0:64 offset1:65
  ds_read2_b32 v[106:107], v55 offset0:66 offset1:67
  s_waitcnt lgkmcnt(6)
  v_mfma_f32_16x16x32_bf16 v[84:87], v[92:95], a[12:15], v[84:87]
  v_mfma_f32_16x16x32_bf16 v[88:91], v[92:95], a[44:47], v[88:91]
  ds_read2_b32 v[92:93], v55 offset0:48 offset1:49
  ds_read2_b32 v[94:95], v55 offset0:50 offset1:51
  s_waitcnt lgkmcnt(6)
  v_mfma_f32_16x16x32_bf16 v[84:87], v[96:99], a[8:11], v[84:87]
  v_mfma_f32_16x16x32_bf16 v[88:91], v[96:99], a[40:43], v[88:91]
  ds_read2_b32 v[96:97], v55 offset0:32 offset1:33
  ds_read2_b32 v[98:99], v55 offset0:34 offset1:35
  s_waitcnt lgkmcnt(6)
  v_mfma_f32_16x16x32_bf16 v[84:87], v[100:103], a[4:7], v[84:87]
  v_mfma_f32_16x16x32_bf16 v[88:91], v[100:103], a[36:39], v[88:91]
  ds_read2_b32 v[100:101], v55 offset0:16 offset1:17
  ds_read2_b32 v[102:103], v55 offset0:18 offset1:19
  s_waitcnt lgkmcnt(6)
  v_mfma_f32_16x16x32_bf16 v[84:87], v[104:107], a[0:3], v[84:87]
  v_mfma_f32_16x16x32_bf16 v[88:91], v[104:107], a[32:35], v[88:91]
  ds_read2_b32 v[104:105], v55 offset0:0 offset1:1
  ds_read2_b32 v[106:107], v55 offset0:2 offset1:3
  s_waitcnt lgkmcnt(6)
  v_mfma_f32_16x16x32_bf16 v[88:91], v[92:95], a[28:31], v[88:91]
  ds_read2_b32 v[92:93], v56 offset0:224 offset1:225
  ds_read2_b32 v[94:95], v56 offset0:226 offset1:227
  s_waitcnt lgkmcnt(6)
  v_mfma_f32_16x16x32_bf16 v[88:91], v[96:99], a[24:27], v[88:91]
  ds_read2_b32 v[96:97], v56 offset0:208 offset1:209
  ds_read2_b32 v[98:99], v56 offset0:210 offset1:211
  s_waitcnt lgkmcnt(6)
  v_mfma_f32_16x16x32_bf16 v[88:91], v[100:103], a[20:23], v[88:91]
  ds_read2_b32 v[100:101], v56 offset0:192 offset1:193
  ds_read2_b32 v[102:103], v56 offset0:194 offset1:195
  s_waitcnt lgkmcnt(6)
  v_mfma_f32_16x16x32_bf16 v[88:91], v[104:107], a[16:19], v[88:91]
  ds_read2_b32 v[104:105], v56 offset0:176 offset1:177
  ds_read2_b32 v[106:107], v56 offset0:178 offset1:179
  s_waitcnt lgkmcnt(6)
  v_mfma_f32_16x16x32_bf16 v[88:91], v[92:95], a[12:15], v[88:91]
  s_waitcnt lgkmcnt(4)
  v_mfma_f32_16x16x32_bf16 v[88:91], v[96:99], a[8:11], v[88:91]
  s_waitcnt lgkmcnt(2)
  v_mfma_f32_16x16x32_bf16 v[88:91], v[100:103], a[4:7], v[88:91]
  s_waitcnt lgkmcnt(0)
  v_mfma_f32_16x16x32_bf16 v[88:91], v[104:107], a[0:3], v[88:91]
  v_lshlrev_b32 v46, 5, v4
  v_lshl_add_u32 v46, v3, 3, v46
  v_add_u32 v46, s17, v46
  ds_read_b64 v[108:109], v46 offset:512
  ds_read_b64 v[110:111], v46 offset:1024
  ds_read_b64 v[112:113], v46 offset:1536
  ds_read_b64 v[114:115], v46 offset:2048
  ds_read_b64 v[116:117], v46 offset:2560
  ds_read_b64 v[118:119], v46 offset:3072
  ds_read_b64 v[120:121], v46 offset:3584
  ds_read_b64 v[122:123], v46 offset:4096
  s_waitcnt lgkmcnt(0)
  v_lshlrev_b32 v124, 16, v108
  v_and_b32 v125, 0xffff0000, v108
  v_lshlrev_b32 v126, 16, v109
  v_and_b32 v127, 0xffff0000, v109
  v_mul_f32 v124, v124, v33
  v_mul_f32 v125, v125, v33
  v_mul_f32 v126, v126, v33
  v_mul_f32 v127, v127, v33
  v_cvt_pk_bf16_f32 v128, v124, v125
  v_cvt_pk_bf16_f32 v129, v126, v127
  v_cvt_pk_bf16_f32 v130, v60, v61
  v_cvt_pk_bf16_f32 v131, v62, v63
  v_lshlrev_b32 v124, 16, v128
  v_and_b32 v125, 0xffff0000, v128
  v_lshlrev_b32 v132, 16, v130
  v_and_b32 v133, 0xffff0000, v130
  v_lshlrev_b32 v126, 16, v129
  v_and_b32 v127, 0xffff0000, v129
  v_lshlrev_b32 v134, 16, v131
  v_and_b32 v135, 0xffff0000, v131
  v_add_f32 v124, v124, v132
  v_add_f32 v125, v125, v133
  v_add_f32 v126, v126, v134
  v_add_f32 v127, v127, v135
  v_cvt_pk_bf16_f32 v108, v124, v125
  v_cvt_pk_bf16_f32 v109, v126, v127
  ds_write_b64 v46, v[108:109] offset:512
  v_lshlrev_b32 v124, 16, v110
  v_and_b32 v125, 0xffff0000, v110
  v_lshlrev_b32 v126, 16, v111
  v_and_b32 v127, 0xffff0000, v111
  v_mul_f32 v124, v124, v33
  v_mul_f32 v125, v125, v33
  v_mul_f32 v126, v126, v33
  v_mul_f32 v127, v127, v33
  v_cvt_pk_bf16_f32 v128, v124, v125
  v_cvt_pk_bf16_f32 v129, v126, v127
  v_cvt_pk_bf16_f32 v130, v64, v65
  v_cvt_pk_bf16_f32 v131, v66, v67
  v_lshlrev_b32 v124, 16, v128
  v_and_b32 v125, 0xffff0000, v128
  v_lshlrev_b32 v132, 16, v130
  v_and_b32 v133, 0xffff0000, v130
  v_lshlrev_b32 v126, 16, v129
  v_and_b32 v127, 0xffff0000, v129
  v_lshlrev_b32 v134, 16, v131
  v_and_b32 v135, 0xffff0000, v131
  v_add_f32 v124, v124, v132
  v_add_f32 v125, v125, v133
  v_add_f32 v126, v126, v134
  v_add_f32 v127, v127, v135
  v_cvt_pk_bf16_f32 v110, v124, v125
  v_cvt_pk_bf16_f32 v111, v126, v127
  ds_write_b64 v46, v[110:111] offset:1024
  v_lshlrev_b32 v124, 16, v112
  v_and_b32 v125, 0xffff0000, v112
  v_lshlrev_b32 v126, 16, v113
  v_and_b32 v127, 0xffff0000, v113
  v_mul_f32 v124, v124, v33
  v_mul_f32 v125, v125, v33
  v_mul_f32 v126, v126, v33
  v_mul_f32 v127, v127, v33
  v_cvt_pk_bf16_f32 v128, v124, v125
  v_cvt_pk_bf16_f32 v129, v126, v127
  v_cvt_pk_bf16_f32 v130, v68, v69
  v_cvt_pk_bf16_f32 v131, v70, v71
  v_lshlrev_b32 v124, 16, v128
  v_and_b32 v125, 0xffff0000, v128
  v_lshlrev_b32 v132, 16, v130
  v_and_b32 v133, 0xffff0000, v130
  v_lshlrev_b32 v126, 16, v129
  v_and_b32 v127, 0xffff0000, v129
  v_lshlrev_b32 v134, 16, v131
  v_and_b32 v135, 0xffff0000, v131
  v_add_f32 v124, v124, v132
  v_add_f32 v125, v125, v133
  v_add_f32 v126, v126, v134
  v_add_f32 v127, v127, v135
  v_cvt_pk_bf16_f32 v112, v124, v125
  v_cvt_pk_bf16_f32 v113, v126, v127
  ds_write_b64 v46, v[112:113] offset:1536
  v_lshlrev_b32 v124, 16, v114
  v_and_b32 v125, 0xffff0000, v114
  v_lshlrev_b32 v126, 16, v115
  v_and_b32 v127, 0xffff0000, v115
  v_mul_f32 v124, v124, v33
  v_mul_f32 v125, v125, v33
  v_mul_f32 v126, v126, v33
  v_mul_f32 v127, v127, v33
  v_cvt_pk_bf16_f32 v128, v124, v125
  v_cvt_pk_bf16_f32 v129, v126, v127
  v_cvt_pk_bf16_f32 v130, v72, v73
  v_cvt_pk_bf16_f32 v131, v74, v75
  v_lshlrev_b32 v124, 16, v128
  v_and_b32 v125, 0xffff0000, v128
  v_lshlrev_b32 v132, 16, v130
  v_and_b32 v133, 0xffff0000, v130
  v_lshlrev_b32 v126, 16, v129
  v_and_b32 v127, 0xffff0000, v129
  v_lshlrev_b32 v134, 16, v131
  v_and_b32 v135, 0xffff0000, v131
  v_add_f32 v124, v124, v132
  v_add_f32 v125, v125, v133
  v_add_f32 v126, v126, v134
  v_add_f32 v127, v127, v135
  v_cvt_pk_bf16_f32 v114, v124, v125
  v_cvt_pk_bf16_f32 v115, v126, v127
  ds_write_b64 v46, v[114:115] offset:2048
  v_lshlrev_b32 v124, 16, v116
  v_and_b32 v125, 0xffff0000, v116
  v_lshlrev_b32 v126, 16, v117
  v_and_b32 v127, 0xffff0000, v117
  v_mul_f32 v124, v124, v33
  v_mul_f32 v125, v125, v33
  v_mul_f32 v126, v126, v33
  v_mul_f32 v127, v127, v33
  v_cvt_pk_bf16_f32 v128, v124, v125
  v_cvt_pk_bf16_f32 v129, v126, v127
  v_cvt_pk_bf16_f32 v130, v76, v77
  v_cvt_pk_bf16_f32 v131, v78, v79
  v_lshlrev_b32 v124, 16, v128
  v_and_b32 v125, 0xffff0000, v128
  v_lshlrev_b32 v132, 16, v130
  v_and_b32 v133, 0xffff0000, v130
  v_lshlrev_b32 v126, 16, v129
  v_and_b32 v127, 0xffff0000, v129
  v_lshlrev_b32 v134, 16, v131
  v_and_b32 v135, 0xffff0000, v131
  v_add_f32 v124, v124, v132
  v_add_f32 v125, v125, v133
  v_add_f32 v126, v126, v134
  v_add_f32 v127, v127, v135
  v_cvt_pk_bf16_f32 v116, v124, v125
  v_cvt_pk_bf16_f32 v117, v126, v127
  ds_write_b64 v46, v[116:117] offset:2560
  v_lshlrev_b32 v124, 16, v118
  v_and_b32 v125, 0xffff0000, v118
  v_lshlrev_b32 v126, 16, v119
  v_and_b32 v127, 0xffff0000, v119
  v_mul_f32 v124, v124, v33
  v_mul_f32 v125, v125, v33
  v_mul_f32 v126, v126, v33
  v_mul_f32 v127, v127, v33
  v_cvt_pk_bf16_f32 v128, v124, v125
  v_cvt_pk_bf16_f32 v129, v126, v127
  v_cvt_pk_bf16_f32 v130, v80, v81
  v_cvt_pk_bf16_f32 v131, v82, v83
  v_lshlrev_b32 v124, 16, v128
  v_and_b32 v125, 0xffff0000, v128
  v_lshlrev_b32 v132, 16, v130
  v_and_b32 v133, 0xffff0000, v130
  v_lshlrev_b32 v126, 16, v129
  v_and_b32 v127, 0xffff0000, v129
  v_lshlrev_b32 v134, 16, v131
  v_and_b32 v135, 0xffff0000, v131
  v_add_f32 v124, v124, v132
  v_add_f32 v125, v125, v133
  v_add_f32 v126, v126, v134
  v_add_f32 v127, v127, v135
  v_cvt_pk_bf16_f32 v118, v124, v125
  v_cvt_pk_bf16_f32 v119, v126, v127
  ds_write_b64 v46, v[118:119] offset:3072
  v_lshlrev_b32 v124, 16, v120
  v_and_b32 v125, 0xffff0000, v120
  v_lshlrev_b32 v126, 16, v121
  v_and_b32 v127, 0xffff0000, v121
  v_mul_f32 v124, v124, v33
  v_mul_f32 v125, v125, v33
  v_mul_f32 v126, v126, v33
  v_mul_f32 v127, v127, v33
  v_cvt_pk_bf16_f32 v128, v124, v125
  v_cvt_pk_bf16_f32 v129, v126, v127
  v_cvt_pk_bf16_f32 v130, v84, v85
  v_cvt_pk_bf16_f32 v131, v86, v87
  v_lshlrev_b32 v124, 16, v128
  v_and_b32 v125, 0xffff0000, v128
  v_lshlrev_b32 v132, 16, v130
  v_and_b32 v133, 0xffff0000, v130
  v_lshlrev_b32 v126, 16, v129
  v_and_b32 v127, 0xffff0000, v129
  v_lshlrev_b32 v134, 16, v131
  v_and_b32 v135, 0xffff0000, v131
  v_add_f32 v124, v124, v132
  v_add_f32 v125, v125, v133
  v_add_f32 v126, v126, v134
  v_add_f32 v127, v127, v135
  v_cvt_pk_bf16_f32 v120, v124, v125
  v_cvt_pk_bf16_f32 v121, v126, v127
  ds_write_b64 v46, v[120:121] offset:3584
  v_lshlrev_b32 v124, 16, v122
  v_and_b32 v125, 0xffff0000, v122
  v_lshlrev_b32 v126, 16, v123
  v_and_b32 v127, 0xffff0000, v123
  v_mul_f32 v124, v124, v33
  v_mul_f32 v125, v125, v33
  v_mul_f32 v126, v126, v33
  v_mul_f32 v127, v127, v33
  v_cvt_pk_bf16_f32 v128, v124, v125
  v_cvt_pk_bf16_f32 v129, v126, v127
  v_cvt_pk_bf16_f32 v130, v88, v89
  v_cvt_pk_bf16_f32 v131, v90, v91
  v_lshlrev_b32 v124, 16, v128
  v_and_b32 v125, 0xffff0000, v128
  v_lshlrev_b32 v132, 16, v130
  v_and_b32 v133, 0xffff0000, v130
  v_lshlrev_b32 v126, 16, v129
  v_and_b32 v127, 0xffff0000, v129
  v_lshlrev_b32 v134, 16, v131
  v_and_b32 v135, 0xffff0000, v131
  v_add_f32 v124, v124, v132
  v_add_f32 v125, v125, v133
  v_add_f32 v126, v126, v134
  v_add_f32 v127, v127, v135
  v_cvt_pk_bf16_f32 v122, v124, v125
  v_cvt_pk_bf16_f32 v123, v126, v127
  ds_write_b64 v46, v[122:123] offset:4096
  s_waitcnt lgkmcnt(0)
  s_barrier
  v_lshlrev_b32 v6, 3, v0
  v_lshlrev_b32 v5, 4, v0
  v_add_u32 v36, 512, v6
  ds_read_b64 v[8:9], v36
  v_add_u32 v36, 25088, v6
  ds_read_b64 v[10:11], v36
  v_add_u32 v36, 49664, v6
  ds_read_b64 v[12:13], v36
  v_add_u32 v36, 74240, v6
  ds_read_b64 v[14:15], v36
  s_waitcnt lgkmcnt(0)
  s_add_u32 s22, s21, 0
  s_add_u32 s23, s22, 3584
  v_perm_b32 v16, v10, v8, s24
  v_perm_b32 v17, v14, v12, s24
  s_lshl_b32 s22, s21, 11
  s_add_u32 s22, s22, 90177536
  v_perm_b32 v18, v10, v8, s25
  v_perm_b32 v19, v14, v12, s25
  buffer_store_dwordx4 v[16:19], v5, s[8:11], s22 offen sc1
  v_perm_b32 v20, v11, v9, s24
  v_perm_b32 v21, v15, v13, s24
  v_perm_b32 v22, v11, v9, s25
  v_perm_b32 v23, v15, v13, s25
  s_add_u32 s22, s22, 4096
  buffer_store_dwordx4 v[20:23], v5, s[8:11], s22 offen sc1
  v_add_u32 v36, 2560, v6
  ds_read_b64 v[8:9], v36
  v_add_u32 v36, 27136, v6
  ds_read_b64 v[10:11], v36
  v_add_u32 v36, 51712, v6
  ds_read_b64 v[12:13], v36
  v_add_u32 v36, 76288, v6
  ds_read_b64 v[14:15], v36
  s_waitcnt lgkmcnt(0)
  s_add_u32 s22, s21, 1835008
  s_add_u32 s23, s22, 3584
  v_perm_b32 v24, v10, v8, s24
  v_perm_b32 v25, v14, v12, s24
  s_lshl_b32 s22, s21, 11
  s_add_u32 s22, s22, 90185728
  v_perm_b32 v26, v10, v8, s25
  v_perm_b32 v27, v14, v12, s25
  buffer_store_dwordx4 v[24:27], v5, s[8:11], s22 offen sc1
  v_perm_b32 v28, v11, v9, s24
  v_perm_b32 v29, v15, v13, s24
  v_perm_b32 v30, v11, v9, s25
  v_perm_b32 v31, v15, v13, s25
  s_add_u32 s22, s22, 4096
  buffer_store_dwordx4 v[28:31], v5, s[8:11], s22 offen sc1
  s_waitcnt vmcnt(0)
  s_barrier
  s_cmp_lg_u32 s16, 0
  s_cbranch_scc1 wk_nc
  v_mov_b32 v5, 1
  s_mov_b32 s22, 88599424
  s_mov_b64 exec, 1
  buffer_atomic_add v5, off, s[8:11], s22
  s_mov_b64 exec, -1
wk_nc:
  s_branch wk_loop
wk_tok:
  s_sub_u32 s3, s3, 864
  s_cmp_lt_u32 s3, 512
  s_cbranch_scc1 wk_tk
  s_sub_u32 s3, s3, 64
  s_cmp_ge_i32 s3, 512
  s_cbranch_scc1 wk_tk
  s_sub_u32 s18, s3, 448
  s_mov_b32 s20, 88599424
  v_mov_b32 v8, 0
  s_mov_b32 s30, 0
wk_cw:
  buffer_load_dword v9, v8, s[8:11], s20 offen sc1
  s_waitcnt vmcnt(0)
  v_cmp_ne_u32 vcc, 112, v9
  s_cbranch_vccz wk_cw_ok
  s_sleep 32
  s_add_u32 s30, s30, 1
  s_cmp_lt_u32 s30, 50000
  s_cbranch_scc1 wk_cw
  s_branch cA_abort
wk_cw_ok:
  v_lshlrev_b32 v5, 14, v3
  v_and_b32 v6, 1, v4
  v_lshl_add_u32 v5, v6, 12, v5
  v_lshrrev_b32 v6, 1, v4
  v_lshl_add_u32 v5, v6, 4, v5
  s_mul_i32 s20, s16, 458752
  s_lshl_b32 s21, s18, 7
  s_add_u32 s20, s20, s21
  s_and_b32 s21, s18, 32
  s_lshl_b32 s21, s21, 7
  s_add_u32 s20, s20, s21
  s_add_u32 s20, s20, 90177536
  buffer_load_dwordx4 v[8:11], v5, s[8:11], s20 offen sc1
  s_add_u32 s20, s20, 65536
  buffer_load_dwordx4 v[12:15], v5, s[8:11], s20 offen sc1
  s_add_u32 s20, s20, 65536
  buffer_load_dwordx4 v[16:19], v5, s[8:11], s20 offen sc1
  s_add_u32 s20, s20, 65536
  buffer_load_dwordx4 v[20:23], v5, s[8:11], s20 offen sc1
  s_add_u32 s20, s20, 65536
  buffer_load_dwordx4 v[24:27], v5, s[8:11], s20 offen sc1
  s_add_u32 s20, s20, 65536
  buffer_load_dwordx4 v[28:31], v5, s[8:11], s20 offen sc1
  s_add_u32 s20, s20, 65536
  buffer_load_dwordx4 v[32:35], v5, s[8:11], s20 offen sc1
  s_add_u32 s20, s20, 65536
  v_mul_u32_u24 v6, 1824, v4
  v_lshl_add_u32 v6, v3, 3, v6
  s_mul_i32 s20, s16, 224
  v_add_u32 v6, s20, v6
  s_movk_i32 s22, 912
  v_add_u32 v36, 0, v0
  v_mul_u32_u24 v37, 18725, v36
  v_lshrrev_b32 v37, 20, v37
  v_mul_u32_u24 v38, 56, v37
  v_sub_u32 v36, v36, v38
  v_lshlrev_b32 v36, 4, v36
  v_mad_u32_u24 v40, v37, s22, v36
  v_mul_u32_u24 v37, 1792, v37
  v_add_u32 v48, v37, v36
  v_add_u32 v36, 256, v0
  v_mul_u32_u24 v37, 18725, v36
  v_lshrrev_b32 v37, 20, v37
  v_mul_u32_u24 v38, 56, v37
  v_sub_u32 v36, v36, v38
  v_lshlrev_b32 v36, 4, v36
  v_mad_u32_u24 v41, v37, s22, v36
  v_mul_u32_u24 v37, 1792, v37
  v_add_u32 v49, v37, v36
  v_add_u32 v36, 512, v0
  v_mul_u32_u24 v37, 18725, v36
  v_lshrrev_b32 v37, 20, v37
  v_mul_u32_u24 v38, 56, v37
  v_sub_u32 v36, v36, v38
  v_lshlrev_b32 v36, 4, v36
  v_mad_u32_u24 v42, v37, s22, v36
  v_mul_u32_u24 v37, 1792, v37
  v_add_u32 v50, v37, v36
  v_add_u32 v36, 768, v0
  v_mul_u32_u24 v37, 18725, v36
  v_lshrrev_b32 v37, 20, v37
  v_mul_u32_u24 v38, 56, v37
  v_sub_u32 v36, v36, v38
  v_lshlrev_b32 v36, 4, v36
  v_mad_u32_u24 v43, v37, s22, v36
  v_mul_u32_u24 v37, 1792, v37
  v_add_u32 v51, v37, v36
  v_add_u32 v36, 1024, v0
  v_mul_u32_u24 v37, 18725, v36
  v_lshrrev_b32 v37, 20, v37
  v_mul_u32_u24 v38, 56, v37
  v_sub_u32 v36, v36, v38
  v_lshlrev_b32 v36, 4, v36
  v_mad_u32_u24 v44, v37, s22, v36
  v_mul_u32_u24 v37, 1792, v37
  v_add_u32 v52, v37, v36
  v_add_u32 v36, 1280, v0
  v_mul_u32_u24 v37, 18725, v36
  v_lshrrev_b32 v37, 20, v37
  v_mul_u32_u24 v38, 56, v37
  v_sub_u32 v36, v36, v38
  v_lshlrev_b32 v36, 4, v36
  v_mad_u32_u24 v45, v37, s22, v36
  v_mul_u32_u24 v37, 1792, v37
  v_add_u32 v53, v37, v36
  v_add_u32 v36, 1536, v0
  v_mul_u32_u24 v37, 18725, v36
  v_lshrrev_b32 v37, 20, v37
  v_mul_u32_u24 v38, 56, v37
  v_sub_u32 v36, v36, v38
  v_lshlrev_b32 v36, 4, v36
  v_mad_u32_u24 v46, v37, s22, v36
  v_mul_u32_u24 v37, 1792, v37
  v_add_u32 v54, v37, v36
  s_waitcnt vmcnt(6)
  ds_write_b64 v6, v[8:9] offset:0
  ds_write_b64 v6, v[10:11] offset:912
  s_waitcnt vmcnt(5)
  ds_write_b64 v6, v[12:13] offset:32
  ds_write_b64 v6, v[14:15] offset:944
  s_waitcnt vmcnt(4)
  ds_write_b64 v6, v[16:17] offset:64
  ds_write_b64 v6, v[18:19] offset:976
  s_waitcnt vmcnt(3)
  ds_write_b64 v6, v[20:21] offset:96
  ds_write_b64 v6, v[22:23] offset:1008
  s_waitcnt vmcnt(2)
  ds_write_b64 v6, v[24:25] offset:128
  ds_write_b64 v6, v[26:27] offset:1040
  s_waitcnt vmcnt(1)
  ds_write_b64 v6, v[28:29] offset:160
  ds_write_b64 v6, v[30:31] offset:1072
  s_waitcnt vmcnt(0)
  ds_write_b64 v6, v[32:33] offset:192
  ds_write_b64 v6, v[34:35] offset:1104
  s_waitcnt lgkmcnt(0)
  s_barrier
  s_mul_i32 s20, s18, 57344
  ds_read_b128 v[8:11], v40
  ds_read_b128 v[12:15], v41
  ds_read_b128 v[16:19], v42
  ds_read_b128 v[20:23], v43
  ds_read_b128 v[24:27], v44
  ds_read_b128 v[28:31], v45
  ds_read_b128 v[32:35], v46
  s_waitcnt lgkmcnt(6)
  buffer_store_dwordx4 v[8:11], v48, s[92:95], s20 offen
  s_waitcnt lgkmcnt(5)
  buffer_store_dwordx4 v[12:15], v49, s[92:95], s20 offen
  s_waitcnt lgkmcnt(4)
  buffer_store_dwordx4 v[16:19], v50, s[92:95], s20 offen
  s_waitcnt lgkmcnt(3)
  buffer_store_dwordx4 v[20:23], v51, s[92:95], s20 offen
  s_waitcnt lgkmcnt(2)
  buffer_store_dwordx4 v[24:27], v52, s[92:95], s20 offen
  s_waitcnt lgkmcnt(1)
  buffer_store_dwordx4 v[28:31], v53, s[92:95], s20 offen
  s_waitcnt lgkmcnt(0)
  buffer_store_dwordx4 v[32:35], v54, s[92:95], s20 offen
  s_branch wk_loop
wk_tk:
  s_and_b32 s18, s3, 3
  s_lshr_b32 s17, s3, 2
  s_cmp_lt_u32 s17, 8
  s_cbranch_scc1 wk_tokp
  s_sub_u32 s17, s17, 64
  s_cmp_ge_i32 s17, 56
  s_cbranch_scc1 wk_toko
  s_add_u32 s20, s17, 56
  s_lshr_b32 s17, s20, 1
  s_bitcmp0_b32 s20, 0
  s_cbranch_scc1 wk_toko
  s_add_u32 s17, s17, 8
wk_tokp:
  s_lshl_b32 s20, s18, 2
  s_add_u32 s20, s20, s16
  s_lshl_b32 s21, s17, 4
  s_add_u32 s21, s21, s20
  s_mul_i32 s21, s21, 28672
  s_add_u32 s21, s21, 12845056
  s_mul_i32 s23, s17, 28672
  s_add_u32 s23, s23, 73400320
  s_mul_i32 s24, s17, 7168
  s_add_u32 s24, s24, 88080384
  s_lshr_b32 s25, s17, 3
  s_lshl_b32 s25, s25, 4
  s_add_u32 s25, s25, s20
  s_lshl_b32 s25, s25, 7
  s_add_u32 s25, s25, 88557568
  v_mov_b32 v60, 0
  s_mov_b32 s30, 0
wp_wf:
  buffer_load_dword v61, v60, s[8:11], s25 offen sc1
  s_waitcnt vmcnt(0)
  v_cmp_ne_u32 vcc, 56, v61
  s_cbranch_vccz wp_wf_ok
  s_sleep 1
  s_cmp_ge_u32 s17, 61
  s_cbranch_scc1 wp_wf_bo
  s_sleep 4
  s_cmp_ge_u32 s17, 56
  s_cbranch_scc1 wp_wf_bo
  s_sleep 40
wp_wf_bo:
  s_add_u32 s30, s30, 1
  s_cmp_lt_u32 s30, 30000
  s_cbranch_scc1 wp_wf
  s_branch wp_abort
wp_wf_ok:
  s_add_u32 s22, s21, 0
  buffer_load_dwordx4 a[0:3], v2, s[8:11], s22 offen offset:0 sc1
  buffer_load_dwordx4 a[4:7], v2, s[8:11], s22 offen offset:1024 sc1
  buffer_load_dwordx4 a[8:11], v2, s[8:11], s22 offen offset:2048 sc1
  buffer_load_dwordx4 a[12:15], v2, s[8:11], s22 offen offset:3072 sc1
  s_add_u32 s22, s21, 4096
  buffer_load_dwordx4 a[16:19], v2, s[8:11], s22 offen offset:0 sc1
  buffer_load_dwordx4 a[20:23], v2, s[8:11], s22 offen offset:1024 sc1
  buffer_load_dwordx4 a[24:27], v2, s[8:11], s22 offen offset:2048 sc1
  buffer_load_dwordx4 a[28:31], v2, s[8:11], s22 offen offset:3072 sc1
  s_add_u32 s22, s21, 8192
  buffer_load_dwordx4 a[32:35], v2, s[8:11], s22 offen offset:0 sc1
  buffer_load_dwordx4 a[36:39], v2, s[8:11], s22 offen offset:1024 sc1
  buffer_load_dwordx4 a[40:43], v2, s[8:11], s22 offen offset:2048 sc1
  buffer_load_dwordx4 a[44:47], v2, s[8:11], s22 offen offset:3072 sc1
  s_add_u32 s22, s21, 12288
  buffer_load_dwordx4 a[48:51], v2, s[8:11], s22 offen offset:0 sc1
  buffer_load_dwordx4 a[52:55], v2, s[8:11], s22 offen offset:1024 sc1
  buffer_load_dwordx4 a[56:59], v2, s[8:11], s22 offen offset:2048 sc1
  buffer_load_dwordx4 a[60:63], v2, s[8:11], s22 offen offset:3072 sc1
  s_add_u32 s22, s21, 16384
  buffer_load_dwordx4 a[64:67], v2, s[8:11], s22 offen offset:0 sc1
  buffer_load_dwordx4 a[68:71], v2, s[8:11], s22 offen offset:1024 sc1
  buffer_load_dwordx4 a[72:75], v2, s[8:11], s22 offen offset:2048 sc1
  buffer_load_dwordx4 a[76:79], v2, s[8:11], s22 offen offset:3072 sc1
  s_add_u32 s22, s21, 20480
  buffer_load_dwordx4 a[80:83], v2, s[8:11], s22 offen offset:0 sc1
  buffer_load_dwordx4 a[84:87], v2, s[8:11], s22 offen offset:1024 sc1
  buffer_load_dwordx4 a[88:91], v2, s[8:11], s22 offen offset:2048 sc1
  buffer_load_dwordx4 a[92:95], v2, s[8:11], s22 offen offset:3072 sc1
  s_add_u32 s22, s21, 24576
  buffer_load_dwordx4 a[96:99], v2, s[8:11], s22 offen offset:0 sc1
  buffer_load_dwordx4 a[100:103], v2, s[8:11], s22 offen offset:1024 sc1
  buffer_load_dwordx4 a[104:107], v2, s[8:11], s22 offen offset:2048 sc1
  buffer_load_dwordx4 a[108:111], v2, s[8:11], s22 offen offset:3072 sc1
  s_add_u32 s22, s23, 0
  buffer_load_dwordx4 a[112:115], v2, s[8:11], s22 offen offset:0 sc1
  buffer_load_dwordx4 a[116:119], v2, s[8:11], s22 offen offset:1024 sc1
  buffer_load_dwordx4 a[120:123], v2, s[8:11], s22 offen offset:2048 sc1
  buffer_load_dwordx4 a[124:127], v2, s[8:11], s22 offen offset:3072 sc1
  s_add_u32 s22, s23, 4096
  buffer_load_dwordx4 a[128:131], v2, s[8:11], s22 offen offset:0 sc1
  buffer_load_dwordx4 a[132:135], v2, s[8:11], s22 offen offset:1024 sc1
  buffer_load_dwordx4 a[136:139], v2, s[8:11], s22 offen offset:2048 sc1
  buffer_load_dwordx4 a[140:143], v2, s[8:11], s22 offen offset:3072 sc1
  s_add_u32 s22, s23, 8192
  buffer_load_dwordx4 a[144:147], v2, s[8:11], s22 offen offset:0 sc1
  buffer_load_dwordx4 a[148:151], v2, s[8:11], s22 offen offset:1024 sc1
  buffer_load_dwordx4 a[152:155], v2, s[8:11], s22 offen offset:2048 sc1
  buffer_load_dwordx4 a[156:159], v2, s[8:11], s22 offen offset:3072 sc1
  s_add_u32 s22, s23, 12288
  buffer_load_dwordx4 a[160:163], v2, s[8:11], s22 offen offset:0 sc1
  buffer_load_dwordx4 a[164:167], v2, s[8:11], s22 offen offset:1024 sc1
  buffer_load_dwordx4 a[168:171], v2, s[8:11], s22 offen offset:2048 sc1
  buffer_load_dwordx4 a[172:175], v2, s[8:11], s22 offen offset:3072 sc1
  s_add_u32 s22, s23, 16384
  buffer_load_dwordx4 a[176:179], v2, s[8:11], s22 offen offset:0 sc1
  buffer_load_dwordx4 a[180:183], v2, s[8:11], s22 offen offset:1024 sc1
  buffer_load_dwordx4 a[184:187], v2, s[8:11], s22 offen offset:2048 sc1
  buffer_load_dwordx4 a[188:191], v2, s[8:11], s22 offen offset:3072 sc1
  s_add_u32 s22, s23, 20480
  buffer_load_dwordx4 a[192:195], v2, s[8:11], s22 offen offset:0 sc1
  buffer_load_dwordx4 a[196:199], v2, s[8:11], s22 offen offset:1024 sc1
  buffer_load_dwordx4 a[200:203], v2, s[8:11], s22 offen offset:2048 sc1
  buffer_load_dwordx4 a[204:207], v2, s[8:11], s22 offen offset:3072 sc1
  s_add_u32 s22, s23, 24576
  buffer_load_dwordx4 a[208:211], v2, s[8:11], s22 offen offset:0 sc1
  buffer_load_dwordx4 a[212:215], v2, s[8:11], s22 offen offset:1024 sc1
  buffer_load_dwordx4 a[216:219], v2, s[8:11], s22 offen offset:2048 sc1
  buffer_load_dwordx4 a[220:223], v2, s[8:11], s22 offen offset:3072 sc1
  v_lshl_add_u32 v5, v3, 2, 0
  v_cmp_le_u32 s[40:41], v5, v4
  v_lshl_add_u32 v5, v3, 2, 1
  v_cmp_le_u32 s[42:43], v5, v4
  v_lshl_add_u32 v5, v3, 2, 2
  v_cmp_le_u32 s[44:45], v5, v4
  v_lshl_add_u32 v5, v3, 2, 3
  v_cmp_le_u32 s[46:47], v5, v4
  v_cmp_gt_u32 s[48:49], 2, v3
  v_mov_b32 v6, 0xff800000
  s_waitcnt vmcnt(0)
  v_mfma_f32_16x16x32_bf16 v[8:11], a[112:115], a[0:3], 0
  v_mfma_f32_16x16x32_bf16 v[12:15], a[112:115], a[56:59], 0
  v_mfma_f32_16x16x32_bf16 v[16:19], a[168:171], a[56:59], 0
  v_mfma_f32_16x16x32_bf16 v[8:11], a[116:119], a[4:7], v[8:11]
  v_mfma_f32_16x16x32_bf16 v[12:15], a[116:119], a[60:63], v[12:15]
  v_mfma_f32_16x16x32_bf16 v[16:19], a[172:175], a[60:63], v[16:19]
  v_mfma_f32_16x16x32_bf16 v[8:11], a[120:123], a[8:11], v[8:11]
  v_mfma_f32_16x16x32_bf16 v[12:15], a[120:123], a[64:67], v[12:15]
  v_mfma_f32_16x16x32_bf16 v[16:19], a[176:179], a[64:67], v[16:19]
  v_mfma_f32_16x16x32_bf16 v[8:11], a[124:127], a[12:15], v[8:11]
  v_mfma_f32_16x16x32_bf16 v[12:15], a[124:127], a[68:71], v[12:15]
  v_mfma_f32_16x16x32_bf16 v[16:19], a[180:183], a[68:71], v[16:19]
  v_mfma_f32_16x16x32_bf16 v[8:11], a[128:131], a[16:19], v[8:11]
  v_mfma_f32_16x16x32_bf16 v[12:15], a[128:131], a[72:75], v[12:15]
  v_mfma_f32_16x16x32_bf16 v[16:19], a[184:187], a[72:75], v[16:19]
  v_mfma_f32_16x16x32_bf16 v[8:11], a[132:135], a[20:23], v[8:11]
  v_mfma_f32_16x16x32_bf16 v[12:15], a[132:135], a[76:79], v[12:15]
  v_mfma_f32_16x16x32_bf16 v[16:19], a[188:191], a[76:79], v[16:19]
  v_mfma_f32_16x16x32_bf16 v[8:11], a[136:139], a[24:27], v[8:11]
  v_mfma_f32_16x16x32_bf16 v[12:15], a[136:139], a[80:83], v[12:15]
  v_mfma_f32_16x16x32_bf16 v[16:19], a[192:195], a[80:83], v[16:19]
  v_mfma_f32_16x16x32_bf16 v[8:11], a[140:143], a[28:31], v[8:11]
  v_mfma_f32_16x16x32_bf16 v[12:15], a[140:143], a[84:87], v[12:15]
  v_mfma_f32_16x16x32_bf16 v[16:19], a[196:199], a[84:87], v[16:19]
  v_mfma_f32_16x16x32_bf16 v[8:11], a[144:147], a[32:35], v[8:11]
  v_mfma_f32_16x16x32_bf16 v[12:15], a[144:147], a[88:91], v[12:15]
  v_mfma_f32_16x16x32_bf16 v[16:19], a[200:203], a[88:91], v[16:19]
  v_mfma_f32_16x16x32_bf16 v[8:11], a[148:151], a[36:39], v[8:11]
  v_mfma_f32_16x16x32_bf16 v[12:15], a[148:151], a[92:95], v[12:15]
  v_mfma_f32_16x16x32_bf16 v[16:19], a[204:207], a[92:95], v[16:19]
  v_mfma_f32_16x16x32_bf16 v[8:11], a[152:155], a[40:43], v[8:11]
  v_mfma_f32_16x16x32_bf16 v[12:15], a[152:155], a[96:99], v[12:15]
  v_mfma_f32_16x16x32_bf16 v[16:19], a[208:211], a[96:99], v[16:19]
  v_mfma_f32_16x16x32_bf16 v[8:11], a[156:159], a[44:47], v[8:11]
  v_mfma_f32_16x16x32_bf16 v[12:15], a[156:159], a[100:103], v[12:15]
  v_mfma_f32_16x16x32_bf16 v[16:19], a[212:215], a[100:103], v[16:19]
  v_mfma_f32_16x16x32_bf16 v[8:11], a[160:163], a[48:51], v[8:11]
  v_mfma_f32_16x16x32_bf16 v[12:15], a[160:163], a[104:107], v[12:15]
  v_mfma_f32_16x16x32_bf16 v[16:19], a[216:219], a[104:107], v[16:19]
  v_mfma_f32_16x16x32_bf16 v[8:11], a[164:167], a[52:55], v[8:11]
  v_mfma_f32_16x16x32_bf16 v[12:15], a[164:167], a[108:111], v[12:15]
  v_mfma_f32_16x16x32_bf16 v[16:19], a[220:223], a[108:111], v[16:19]
  s_mul_i32 s22, s20, 448
  v_mov_b32 v62, s22
  s_mov_b32 s30, 0
wp_pm:
  s_cmp_ge_u32 s17, 64
  s_cbranch_scc1 wp_pf
  s_cmp_ge_u32 s17, 61
  s_cbranch_scc1 mp_45a
  v_mov_b32 v61, 0
  s_mov_b64 exec, 1
  buffer_atomic_or v61, v62, s[8:11], s24 offen sc0
  s_mov_b64 exec, -1
  s_branch mp_45b
mp_45a:
  buffer_load_dword v61, v62, s[8:11], s24 offen sc1
mp_45b:
  s_waitcnt vmcnt(0)
  v_cmp_eq_u32 vcc, -1, v61
  s_cbranch_vccnz wp_pr
wp_pf:
  s_add_u32 s22, s24, 4096
  buffer_load_dwordx4 v[64:67], v2, s[8:11], s24 offen offset:0 sc1
  buffer_load_dwordx4 v[68:71], v2, s[8:11], s24 offen offset:1024 sc1
  buffer_load_dwordx4 v[72:75], v2, s[8:11], s24 offen offset:2048 sc1
  buffer_load_dwordx4 v[76:79], v2, s[8:11], s24 offen offset:3072 sc1
  buffer_load_dwordx4 v[80:83], v2, s[8:11], s22 offen offset:0 sc1
  buffer_load_dwordx4 v[84:87], v2, s[8:11], s22 offen offset:1024 sc1
  buffer_load_dwordx4 v[88:91], v2, s[8:11], s22 offen offset:2048 sc1
  s_waitcnt vmcnt(0)
  v_max_u32 v61, v64, v65
  v_max3_u32 v61, v61, v66, v67
  v_max3_u32 v61, v61, v68, v69
  v_max3_u32 v61, v61, v70, v71
  v_max3_u32 v61, v61, v72, v73
  v_max3_u32 v61, v61, v74, v75
  v_max3_u32 v61, v61, v76, v77
  v_max3_u32 v61, v61, v78, v79
  v_max3_u32 v61, v61, v80, v81
  v_max3_u32 v61, v61, v82, v83
  v_max3_u32 v61, v61, v84, v85
  v_max3_u32 v61, v61, v86, v87
  v_max3_u32 v61, v61, v88, v89
  v_max3_u32 v61, v61, v90, v91
  v_cmp_eq_u32 vcc, -1, v61
  s_cbranch_vccz wp_pk
wp_pr:
  s_sleep 1
  s_cmp_ge_u32 s17, 61
  s_cbranch_scc1 wp_pm_bo
  s_sleep 4
  s_cmp_ge_u32 s17, 56
  s_cbranch_scc1 wp_pm_bo
  s_sleep 40
wp_pm_bo:
  s_add_u32 s30, s30, 1
  s_cmp_lt_u32 s30, 30000
  s_cbranch_scc1 wp_pm
  s_branch wp_abort
wp_pk:
  s_cmp_lt_u32 s17, 56
  s_cbranch_scc1 pk_46
  buffer_load_dword v250, v251, s[12:15], 0 offen sc1
pk_46:
  v_mfma_f32_16x16x32_bf16 v[20:23], v[64:67], a[0:3], 0
  v_mfma_f32_16x16x32_bf16 v[24:27], v[64:67], a[4:7], 0
  v_mfma_f32_16x16x32_bf16 v[28:31], v[64:67], a[56:59], 0
  v_mfma_f32_16x16x32_bf16 v[32:35], v[64:67], a[60:63], 0
  v_mfma_f32_16x16x32_bf16 v[20:23], v[68:71], a[8:11], v[20:23]
  v_mfma_f32_16x16x32_bf16 v[24:27], v[68:71], a[12:15], v[24:27]
  v_mfma_f32_16x16x32_bf16 v[28:31], v[68:71], a[64:67], v[28:31]
  v_mfma_f32_16x16x32_bf16 v[32:35], v[68:71], a[68:71], v[32:35]
  v_mfma_f32_16x16x32_bf16 v[20:23], v[72:75], a[16:19], v[20:23]
  v_mfma_f32_16x16x32_bf16 v[24:27], v[72:75], a[20:23], v[24:27]
  v_mfma_f32_16x16x32_bf16 v[28:31], v[72:75], a[72:75], v[28:31]
  v_mfma_f32_16x16x32_bf16 v[32:35], v[72:75], a[76:79], v[32:35]
  v_mfma_f32_16x16x32_bf16 v[20:23], v[76:79], a[24:27], v[20:23]
  v_mfma_f32_16x16x32_bf16 v[24:27], v[76:79], a[28:31], v[24:27]
  v_mfma_f32_16x16x32_bf16 v[28:31], v[76:79], a[80:83], v[28:31]
  v_mfma_f32_16x16x32_bf16 v[32:35], v[76:79], a[84:87], v[32:35]
  v_mfma_f32_16x16x32_bf16 v[20:23], v[80:83], a[32:35], v[20:23]
  v_mfma_f32_16x16x32_bf16 v[24:27], v[80:83], a[36:39], v[24:27]
  v_mfma_f32_16x16x32_bf16 v[28:31], v[80:83], a[88:91], v[28:31]
  v_mfma_f32_16x16x32_bf16 v[32:35], v[80:83], a[92:95], v[32:35]
  v_mfma_f32_16x16x32_bf16 v[20:23], v[84:87], a[40:43], v[20:23]
  v_mfma_f32_16x16x32_bf16 v[24:27], v[84:87], a[44:47], v[24:27]
  v_mfma_f32_16x16x32_bf16 v[28:31], v[84:87], a[96:99], v[28:31]
  v_mfma_f32_16x16x32_bf16 v[32:35], v[84:87], a[100:103], v[32:35]
  v_mfma_f32_16x16x32_bf16 v[20:23], v[88:91], a[48:51], v[20:23]
  v_mfma_f32_16x16x32_bf16 v[24:27], v[88:91], a[52:55], v[24:27]
  v_mfma_f32_16x16x32_bf16 v[28:31], v[88:91], a[104:107], v[28:31]
  v_mfma_f32_16x16x32_bf16 v[32:35], v[88:91], a[108:111], v[32:35]
  s_lshl_b32 s25, s17, 1
  s_mul_i32 s25, s25, 20480
  s_add_u32 s25, s25, 85458944
  s_lshl_b32 s26, s20, 10
  s_add_u32 s26, s26, s25
  s_lshl_b32 s27, s18, 10
  s_add_u32 s27, s27, s25
  s_lshr_b32 s28, s16, 1
  s_lshl_b32 s28, s28, 3
  s_add_u32 s27, s27, s28
  s_add_u32 s27, s27, 16384
  s_and_b32 s28, s16, 1
  s_cmp_eq_u32 s28, 0
  s_cselect_b32 s50, -1, 0
  s_cselect_b32 s51, 0, -1
  v_cndmask_b32 v8, v6, v8, s[40:41]
  v_cndmask_b32 v9, v6, v9, s[42:43]
  v_cndmask_b32 v10, v6, v10, s[44:45]
  v_cndmask_b32 v11, v6, v11, s[46:47]
  v_cndmask_b32 v20, v24, v20, s[48:49]
  v_cndmask_b32 v21, v25, v21, s[48:49]
  v_cndmask_b32 v22, v26, v22, s[48:49]
  v_cndmask_b32 v23, v27, v23, s[48:49]
  v_mov_b32 v24, v20
  v_mov_b32 v25, v21
  v_mov_b32 v26, v22
  v_mov_b32 v27, v23
  v_permlane32_swap_b32 v20, v24
  v_permlane32_swap_b32 v21, v25
  v_permlane32_swap_b32 v22, v26
  v_permlane32_swap_b32 v23, v27
  v_add_f32 v20, v20, v24
  v_add_f32 v21, v21, v25
  v_add_f32 v22, v22, v26
  v_add_f32 v23, v23, v27
  v_max3_f32 v40, v8, v9, v10
  v_max3_f32 v40, v40, v11, v20
  v_max3_f32 v40, v40, v21, v22
  v_max_f32 v40, v40, v23
  v_mov_b32 v41, v40
  s_nop 1
  v_permlane16_swap_b32 v40, v41
  v_max_f32 v40, v40, v41
  v_mov_b32 v41, v40
  s_nop 1
  v_permlane32_swap_b32 v40, v41
  v_max_f32 v40, v40, v41
  v_sub_f32 v8, v8, v40
  v_sub_f32 v9, v9, v40
  v_sub_f32 v10, v10, v40
  v_sub_f32 v11, v11, v40
  v_sub_f32 v20, v20, v40
  v_sub_f32 v21, v21, v40
  v_sub_f32 v22, v22, v40
  v_sub_f32 v23, v23, v40
  v_exp_f32 v8, v8
  v_exp_f32 v9, v9
  v_exp_f32 v10, v10
  v_exp_f32 v11, v11
  v_exp_f32 v20, v20
  v_exp_f32 v21, v21
  v_exp_f32 v22, v22
  v_exp_f32 v23, v23
  v_add_f32 v42, v20, v21
  v_add_f32 v43, v22, v23
  v_add_f32 v42, v42, v43
  v_mul_f32 v42, 0.5, v42
  v_add_f32 v42, v42, v8
  v_add_f32 v42, v42, v9
  v_add_f32 v42, v42, v10
  v_add_f32 v42, v42, v11
  v_mov_b32 v41, v42
  s_nop 1
  v_permlane16_swap_b32 v42, v41
  v_add_f32 v42, v42, v41
  v_mov_b32 v41, v42
  s_nop 1
  v_permlane32_swap_b32 v42, v41
  v_add_f32 v42, v42, v41
  v_rcp_f32 v42, v42
  s_nop 0
  v_mul_f32 v8, v8, v42
  v_mul_f32 v9, v9, v42
  v_mul_f32 v10, v10, v42
  v_mul_f32 v11, v11, v42
  v_mul_f32 v20, v20, v42
  v_mul_f32 v21, v21, v42
  v_mul_f32 v22, v22, v42
  v_mul_f32 v23, v23, v42
  v_cvt_pk_bf16_f32 v44, v8, v9
  v_cvt_pk_bf16_f32 v45, v10, v11
  v_mov_b32 v46, 0
  v_mov_b32 v47, 0
  v_cvt_pk_bf16_f32 v48, v20, v21
  v_cvt_pk_bf16_f32 v49, v22, v23
  v_min_u32 v44, -2, v44
  v_min_u32 v45, -2, v45
  v_min_u32 v46, -2, v46
  v_min_u32 v47, -2, v47
  v_min_u32 v48, -2, v48
  v_min_u32 v49, -2, v49
  buffer_store_dwordx4 v[44:47], v2, s[8:11], s26 offen sc1
  s_mov_b64 exec, s[50:51]
  buffer_store_dwordx2 v[48:49], v2, s[8:11], s27 offen sc1
  s_mov_b64 exec, -1
  s_add_u32 s26, s26, 20480
  s_add_u32 s27, s27, 20480
  v_cndmask_b32 v16, v6, v16, s[40:41]
  v_cndmask_b32 v17, v6, v17, s[42:43]
  v_cndmask_b32 v18, v6, v18, s[44:45]
  v_cndmask_b32 v19, v6, v19, s[46:47]
  v_cndmask_b32 v28, v32, v28, s[48:49]
  v_cndmask_b32 v29, v33, v29, s[48:49]
  v_cndmask_b32 v30, v34, v30, s[48:49]
  v_cndmask_b32 v31, v35, v31, s[48:49]
  v_mov_b32 v32, v28
  v_mov_b32 v33, v29
  v_mov_b32 v34, v30
  v_mov_b32 v35, v31
  v_permlane32_swap_b32 v28, v32
  v_permlane32_swap_b32 v29, v33
  v_permlane32_swap_b32 v30, v34
  v_permlane32_swap_b32 v31, v35
  v_add_f32 v28, v28, v32
  v_add_f32 v29, v29, v33
  v_add_f32 v30, v30, v34
  v_add_f32 v31, v31, v35
  v_max3_f32 v40, v12, v13, v14
  v_max3_f32 v40, v40, v15, v16
  v_max3_f32 v40, v40, v17, v18
  v_max3_f32 v40, v40, v19, v28
  v_max3_f32 v40, v40, v29, v30
  v_max_f32 v40, v40, v31
  v_mov_b32 v41, v40
  s_nop 1
  v_permlane16_swap_b32 v40, v41
  v_max_f32 v40, v40, v41
  v_mov_b32 v41, v40
  s_nop 1
  v_permlane32_swap_b32 v40, v41
  v_max_f32 v40, v40, v41
  v_sub_f32 v12, v12, v40
  v_sub_f32 v13, v13, v40
  v_sub_f32 v14, v14, v40
  v_sub_f32 v15, v15, v40
  v_sub_f32 v16, v16, v40
  v_sub_f32 v17, v17, v40
  v_sub_f32 v18, v18, v40
  v_sub_f32 v19, v19, v40
  v_sub_f32 v28, v28, v40
  v_sub_f32 v29, v29, v40
  v_sub_f32 v30, v30, v40
  v_sub_f32 v31, v31, v40
  v_exp_f32 v12, v12
  v_exp_f32 v13, v13
  v_exp_f32 v14, v14
  v_exp_f32 v15, v15
  v_exp_f32 v16, v16
  v_exp_f32 v17, v17
  v_exp_f32 v18, v18
  v_exp_f32 v19, v19
  v_exp_f32 v28, v28
  v_exp_f32 v29, v29
  v_exp_f32 v30, v30
  v_exp_f32 v31, v31
  v_add_f32 v42, v28, v29
  v_add_f32 v43, v30, v31
  v_add_f32 v42, v42, v43
  v_mul_f32 v42, 0.5, v42
  v_add_f32 v42, v42, v12
  v_add_f32 v42, v42, v13
  v_add_f32 v42, v42, v14
  v_add_f32 v42, v42, v15
  v_add_f32 v42, v42, v16
  v_add_f32 v42, v42, v17
  v_add_f32 v42, v42, v18
  v_add_f32 v42, v42, v19
  v_mov_b32 v41, v42
  s_nop 1
  v_permlane16_swap_b32 v42, v41
  v_add_f32 v42, v42, v41
  v_mov_b32 v41, v42
  s_nop 1
  v_permlane32_swap_b32 v42, v41
  v_add_f32 v42, v42, v41
  v_rcp_f32 v42, v42
  s_nop 0
  v_mul_f32 v12, v12, v42
  v_mul_f32 v13, v13, v42
  v_mul_f32 v14, v14, v42
  v_mul_f32 v15, v15, v42
  v_mul_f32 v16, v16, v42
  v_mul_f32 v17, v17, v42
  v_mul_f32 v18, v18, v42
  v_mul_f32 v19, v19, v42
  v_mul_f32 v28, v28, v42
  v_mul_f32 v29, v29, v42
  v_mul_f32 v30, v30, v42
  v_mul_f32 v31, v31, v42
  v_cvt_pk_bf16_f32 v52, v12, v13
  v_cvt_pk_bf16_f32 v53, v14, v15
  v_cvt_pk_bf16_f32 v54, v16, v17
  v_cvt_pk_bf16_f32 v55, v18, v19
  v_cvt_pk_bf16_f32 v56, v28, v29
  v_cvt_pk_bf16_f32 v57, v30, v31
  v_min_u32 v52, -2, v52
  v_min_u32 v53, -2, v53
  v_min_u32 v54, -2, v54
  v_min_u32 v55, -2, v55
  v_min_u32 v56, -2, v56
  v_min_u32 v57, -2, v57
  buffer_store_dwordx4 v[52:55], v2, s[8:11], s26 offen sc1
  s_mov_b64 exec, s[50:51]
  buffer_store_dwordx2 v[56:57], v2, s[8:11], s27 offen sc1
  s_mov_b64 exec, -1
  s_lshl_b32 s25, s17, 7
  s_add_u32 s25, s25, 88573952
  v_mov_b32 v5, 1
  v_mov_b32 v6, 0
  s_waitcnt vmcnt(0)
  s_mov_b64 exec, 1
  buffer_atomic_add v5, v6, s[8:11], s25 offen
  s_mov_b64 exec, -1
  s_branch wk_loop
wk_toko:
  s_lshl_b32 s20, s18, 2
  s_add_u32 s20, s20, s16
  s_mul_i32 s24, s20, 65
  s_add_u32 s24, s24, s17
  s_lshl_b32 s24, s24, 13
  s_add_u32 s24, s24, 76947456
  s_lshl_b32 s21, s20, 6
  s_add_u32 s21, s21, s17
  s_mul_i32 s21, s21, 28672
  s_add_u32 s21, s21, 42205184
  s_lshl_b32 s25, s17, 1
  s_mul_i32 s25, s25, 20480
  s_add_u32 s25, s25, 85458944
  v_lshrrev_b32 v8, 5, v1
  v_and_b32 v9, 31, v1
  v_lshrrev_b32 v10, 4, v9
  v_min_u32 v5, 27, v9
  v_and_b32 v5, 15, v5
  v_lshlrev_b32 v6, 1, v10
  v_sub_u32 v6, 8, v6
  v_lshlrev_b32 v7, 10, v10
  v_lshl_add_u32 v7, v5, 4, v7
  v_lshlrev_b32 v6, 5, v6
  v_mad_u32_u24 v5, v8, v6, v7
  v_lshl_add_u32 v63, v6, 1, v5
  v_lshl_add_u32 v7, v8, 3, v7
  v_mul_u32_u24 v6, 20480, v10
  v_lshl_add_u32 v6, v8, 8, v6
  v_lshl_add_u32 v6, v4, 4, v6
  s_lshr_b32 s26, s17, 3
  s_lshl_b32 s26, s26, 4
  s_add_u32 s26, s26, s20
  s_lshl_b32 s26, s26, 7
  s_add_u32 s26, s26, 88541184
  v_mov_b32 v60, 0
  s_mov_b32 s30, 0
wo_wv:
  buffer_load_dword v61, v60, s[8:11], s26 offen sc1
  s_waitcnt vmcnt(0)
  v_cmp_ne_u32 vcc, 56, v61
  s_cbranch_vccz wo_wv_ok
  s_sleep 1
  s_cmp_ge_u32 s17, 61
  s_cbranch_scc1 wo_wv_bo
  s_sleep 4
  s_cmp_ge_u32 s17, 56
  s_cbranch_scc1 wo_wv_bo
  s_sleep 40
wo_wv_bo:
  s_add_u32 s30, s30, 1
  s_cmp_lt_u32 s30, 30000
  s_cbranch_scc1 wo_wv
  s_branch wo_abort
wo_wv_ok:
  s_add_u32 s22, s21, 0
  buffer_load_dwordx4 a[0:3], v5, s[8:11], s22 offen offset:0 sc1
  buffer_load_dwordx4 a[4:7], v63, s[8:11], s22 offen offset:0 sc1
  buffer_load_dwordx4 a[8:11], v5, s[8:11], s22 offen offset:1792 sc1
  buffer_load_dwordx4 a[12:15], v63, s[8:11], s22 offen offset:1792 sc1
  s_add_u32 s22, s21, 3584
  buffer_load_dwordx4 a[16:19], v5, s[8:11], s22 offen offset:0 sc1
  buffer_load_dwordx4 a[20:23], v63, s[8:11], s22 offen offset:0 sc1
  buffer_load_dwordx4 a[24:27], v5, s[8:11], s22 offen offset:1792 sc1
  buffer_load_dwordx4 a[28:31], v63, s[8:11], s22 offen offset:1792 sc1
  s_add_u32 s22, s21, 7168
  buffer_load_dwordx4 a[32:35], v5, s[8:11], s22 offen offset:0 sc1
  buffer_load_dwordx4 a[36:39], v63, s[8:11], s22 offen offset:0 sc1
  buffer_load_dwordx4 a[40:43], v5, s[8:11], s22 offen offset:1792 sc1
  buffer_load_dwordx4 a[44:47], v63, s[8:11], s22 offen offset:1792 sc1
  s_add_u32 s22, s21, 10752
  buffer_load_dwordx4 a[48:51], v5, s[8:11], s22 offen offset:0 sc1
  buffer_load_dwordx4 a[52:55], v63, s[8:11], s22 offen offset:0 sc1
  buffer_load_dwordx4 a[56:59], v5, s[8:11], s22 offen offset:1792 sc1
  buffer_load_dwordx4 a[60:63], v63, s[8:11], s22 offen offset:1792 sc1
  s_add_u32 s22, s21, 14336
  buffer_load_dwordx4 a[64:67], v5, s[8:11], s22 offen offset:0 sc1
  buffer_load_dwordx4 a[68:71], v63, s[8:11], s22 offen offset:0 sc1
  buffer_load_dwordx4 a[72:75], v5, s[8:11], s22 offen offset:1792 sc1
  buffer_load_dwordx4 a[76:79], v63, s[8:11], s22 offen offset:1792 sc1
  s_add_u32 s22, s21, 17920
  buffer_load_dwordx4 a[80:83], v5, s[8:11], s22 offen offset:0 sc1
  buffer_load_dwordx4 a[84:87], v63, s[8:11], s22 offen offset:0 sc1
  buffer_load_dwordx4 a[88:91], v5, s[8:11], s22 offen offset:1792 sc1
  buffer_load_dwordx4 a[92:95], v63, s[8:11], s22 offen offset:1792 sc1
  s_add_u32 s22, s21, 21504
  buffer_load_dwordx4 a[96:99], v5, s[8:11], s22 offen offset:0 sc1
  buffer_load_dwordx4 a[100:103], v63, s[8:11], s22 offen offset:0 sc1
  buffer_load_dwordx4 a[104:107], v5, s[8:11], s22 offen offset:1792 sc1
  buffer_load_dwordx4 a[108:111], v63, s[8:11], s22 offen offset:1792 sc1
  s_add_u32 s22, s21, 25088
  buffer_load_dwordx4 a[112:115], v5, s[8:11], s22 offen offset:0 sc1
  buffer_load_dwordx4 a[116:119], v63, s[8:11], s22 offen offset:0 sc1
  buffer_load_dwordx4 a[120:123], v5, s[8:11], s22 offen offset:1792 sc1
  buffer_load_dwordx4 a[124:127], v63, s[8:11], s22 offen offset:1792 sc1
  s_cmp_ge_u32 s17, 61
  s_cbranch_scc1 wo_lm
  s_lshl_b32 s26, s17, 7
  s_add_u32 s26, s26, 88573952
  v_mov_b32 v60, 0
  s_mov_b32 s30, 0
wo_wp:
  buffer_load_dword v61, v60, s[8:11], s26 offen sc1
  s_waitcnt vmcnt(0)
  v_cmp_ne_u32 vcc, 16, v61
  s_cbranch_vccz wo_wp_ok
  s_sleep 2
  s_cmp_ge_u32 s17, 61
  s_cbranch_scc1 wo_wp_bo
  s_sleep 4
  s_cmp_ge_u32 s17, 56
  s_cbranch_scc1 wo_wp_bo
  s_sleep 40
wo_wp_bo:
  s_add_u32 s30, s30, 1
  s_cmp_lt_u32 s30, 30000
  s_cbranch_scc1 wo_wp
  s_branch wo_abort
wo_wp_ok:
  s_branch wo_lp
wo_lm:
  s_mul_i32 s26, s17, 7168
  s_add_u32 s26, s26, 88080384
  v_mov_b32 v60, 0
  s_mov_b32 s30, 0
wo_wm:
  buffer_load_dword v61, v60, s[8:11], s26 offen sc1
  s_waitcnt vmcnt(0)
  v_cmp_eq_u32 vcc, -1, v61
  s_cbranch_vccz wo_wm_ok
  s_sleep 2
  s_cmp_ge_u32 s17, 61
  s_cbranch_scc1 wo_wm_bo
  s_sleep 4
  s_cmp_ge_u32 s17, 56
  s_cbranch_scc1 wo_wm_bo
  s_sleep 40
wo_wm_bo:
  s_add_u32 s30, s30, 1
  s_cmp_lt_u32 s30, 30000
  s_cbranch_scc1 wo_wm
  s_branch wo_abort
wo_wm_ok:
wo_lp:
  s_mul_i32 s26, s16, 10240
  s_add_u32 s27, s25, s26
  v_add_u32 v11, s26, v2
  s_lshl_b32 s26, s20, 6
  s_add_u32 s26, s26, s17
  s_lshl_b32 s26, s26, 4
  s_add_u32 s26, s26, 88582144
  v_lshlrev_b32 v60, 2, v3
  s_mov_b32 s30, 0
wo_pl:
  s_add_u32 s22, s27, 0
  buffer_load_dwordx4 v[128:131], v2, s[8:11], s22 offen offset:0 sc1
  buffer_load_dwordx4 v[132:135], v2, s[8:11], s22 offen offset:1024 sc1
  buffer_load_dwordx4 v[136:139], v2, s[8:11], s22 offen offset:2048 sc1
  buffer_load_dwordx4 v[140:143], v2, s[8:11], s22 offen offset:3072 sc1
  s_add_u32 s22, s27, 4096
  buffer_load_dwordx4 v[144:147], v2, s[8:11], s22 offen offset:0 sc1
  buffer_load_dwordx4 v[148:151], v2, s[8:11], s22 offen offset:1024 sc1
  buffer_load_dwordx4 v[152:155], v2, s[8:11], s22 offen offset:2048 sc1
  buffer_load_dwordx4 v[156:159], v2, s[8:11], s22 offen offset:3072 sc1
  s_add_u32 s22, s27, 8192
  buffer_load_dwordx4 v[160:163], v2, s[8:11], s22 offen offset:0 sc1
  buffer_load_dwordx4 v[164:167], v2, s[8:11], s22 offen offset:1024 sc1
  buffer_load_dword v61, v60, s[8:11], s26 offen sc1
  s_waitcnt vmcnt(1)
  v_max_u32 v62, v128, v129
  v_max3_u32 v62, v62, v130, v131
  v_max3_u32 v62, v62, v132, v133
  v_max3_u32 v62, v62, v134, v135
  v_max3_u32 v62, v62, v136, v137
  v_max3_u32 v62, v62, v138, v139
  v_max3_u32 v62, v62, v140, v141
  v_max3_u32 v62, v62, v142, v143
  v_max3_u32 v62, v62, v144, v145
  v_max3_u32 v62, v62, v146, v147
  v_max3_u32 v62, v62, v148, v149
  v_max3_u32 v62, v62, v150, v151
  v_max3_u32 v62, v62, v152, v153
  v_max3_u32 v62, v62, v154, v155
  v_max3_u32 v62, v62, v156, v157
  v_max3_u32 v62, v62, v158, v159
  v_max3_u32 v62, v62, v160, v161
  v_max3_u32 v62, v62, v162, v163
  v_max3_u32 v62, v62, v164, v165
  v_max3_u32 v62, v62, v166, v167
  v_cmp_eq_u32 vcc, -1, v62
  s_cbranch_vccz wo_pk
  s_add_u32 s30, s30, 1
  s_cmp_lt_u32 s30, 30000
  s_cbranch_scc1 wo_pl
  s_branch wo_abort
wo_pk:
  ds_write_b128 v11, v[128:131] offset:0
  ds_write_b128 v11, v[132:135] offset:1024
  ds_write_b128 v11, v[136:139] offset:2048
  ds_write_b128 v11, v[140:143] offset:3072
  ds_write_b128 v11, v[144:147] offset:4096
  ds_write_b128 v11, v[148:151] offset:5120
  ds_write_b128 v11, v[152:155] offset:6144
  ds_write_b128 v11, v[156:159] offset:7168
  ds_write_b128 v11, v[160:163] offset:8192
  ds_write_b128 v11, v[164:167] offset:9216
  s_waitcnt vmcnt(0)
  v_cmp_ne_u32 vcc, 1, v61
  s_mov_b32 s28, 0
  s_cbranch_vccnz wo_nt
  s_add_u32 s22, s24, 0
  buffer_load_dwordx2 v[28:29], v7, s[8:11], s22 offen offset:0 sc1
  buffer_load_dwordx2 v[30:31], v7, s[8:11], s22 offen offset:512 sc1
  buffer_load_dwordx2 v[32:33], v7, s[8:11], s22 offen offset:256 sc1
  buffer_load_dwordx2 v[34:35], v7, s[8:11], s22 offen offset:768 sc1
  buffer_load_dwordx2 v[36:37], v7, s[8:11], s22 offen offset:2048 sc1
  buffer_load_dwordx2 v[38:39], v7, s[8:11], s22 offen offset:2560 sc1
  buffer_load_dwordx2 v[40:41], v7, s[8:11], s22 offen offset:2304 sc1
  buffer_load_dwordx2 v[42:43], v7, s[8:11], s22 offen offset:2816 sc1
  s_add_u32 s22, s24, 4096
  buffer_load_dwordx2 v[44:45], v7, s[8:11], s22 offen offset:0 sc1
  buffer_load_dwordx2 v[46:47], v7, s[8:11], s22 offen offset:512 sc1
  buffer_load_dwordx2 v[48:49], v7, s[8:11], s22 offen offset:256 sc1
  buffer_load_dwordx2 v[50:51], v7, s[8:11], s22 offen offset:768 sc1
  buffer_load_dwordx2 v[52:53], v7, s[8:11], s22 offen offset:2048 sc1
  buffer_load_dwordx2 v[54:55], v7, s[8:11], s22 offen offset:2560 sc1
  buffer_load_dwordx2 v[56:57], v7, s[8:11], s22 offen offset:2304 sc1
  buffer_load_dwordx2 v[58:59], v7, s[8:11], s22 offen offset:2816 sc1
  s_mov_b32 s28, 1
wo_nt:
  s_cmp_lt_u32 s17, 56
  s_cbranch_scc1 pk_47
  buffer_load_dword v250, v251, s[12:15], 0 offen sc1
pk_47:
  s_waitcnt lgkmcnt(0)
  s_barrier
  buffer_load_dword v61, v60, s[8:11], s26 offen sc1
  ds_read_b128 v[64:67], v6 offset:0
  ds_read_b128 v[68:71], v6 offset:512
  ds_read_b128 v[72:75], v6 offset:1024
  ds_read_b128 v[76:79], v6 offset:1536
  ds_read_b128 v[80:83], v6 offset:2048
  ds_read_b128 v[84:87], v6 offset:2560
  ds_read_b128 v[88:91], v6 offset:3072
  s_waitcnt lgkmcnt(6)
  v_mfma_f32_32x32x16_bf16 v[12:27], a[0:3], v[64:67], 0
  ds_read_b128 v[92:95], v6 offset:3584
  s_waitcnt lgkmcnt(6)
  v_mfma_f32_32x32x16_bf16 v[12:27], a[4:7], v[68:71], v[12:27]
  ds_read_b128 v[64:67], v6 offset:4096
  s_waitcnt lgkmcnt(6)
  v_mfma_f32_32x32x16_bf16 v[12:27], a[8:11], v[72:75], v[12:27]
  ds_read_b128 v[68:71], v6 offset:4608
  s_waitcnt lgkmcnt(6)
  v_mfma_f32_32x32x16_bf16 v[12:27], a[12:15], v[76:79], v[12:27]
  ds_read_b128 v[72:75], v6 offset:5120
  s_waitcnt lgkmcnt(6)
  v_mfma_f32_32x32x16_bf16 v[12:27], a[16:19], v[80:83], v[12:27]
  ds_read_b128 v[76:79], v6 offset:5632
  s_waitcnt lgkmcnt(6)
  v_mfma_f32_32x32x16_bf16 v[12:27], a[20:23], v[84:87], v[12:27]
  ds_read_b128 v[80:83], v6 offset:6144
  s_waitcnt lgkmcnt(6)
  v_mfma_f32_32x32x16_bf16 v[12:27], a[24:27], v[88:91], v[12:27]
  ds_read_b128 v[84:87], v6 offset:6656
  s_waitcnt lgkmcnt(6)
  v_mfma_f32_32x32x16_bf16 v[12:27], a[28:31], v[92:95], v[12:27]
  ds_read_b128 v[88:91], v6 offset:7168
  s_waitcnt lgkmcnt(6)
  v_mfma_f32_32x32x16_bf16 v[12:27], a[32:35], v[64:67], v[12:27]
  ds_read_b128 v[92:95], v6 offset:7680
  s_waitcnt lgkmcnt(6)
  v_mfma_f32_32x32x16_bf16 v[12:27], a[36:39], v[68:71], v[12:27]
  ds_read_b128 v[64:67], v6 offset:8192
  s_waitcnt lgkmcnt(6)
  v_mfma_f32_32x32x16_bf16 v[12:27], a[40:43], v[72:75], v[12:27]
  ds_read_b128 v[68:71], v6 offset:8704
  s_waitcnt lgkmcnt(6)
  v_mfma_f32_32x32x16_bf16 v[12:27], a[44:47], v[76:79], v[12:27]
  ds_read_b128 v[72:75], v6 offset:9216
  s_waitcnt lgkmcnt(6)
  v_mfma_f32_32x32x16_bf16 v[12:27], a[48:51], v[80:83], v[12:27]
  ds_read_b128 v[76:79], v6 offset:9728
  s_waitcnt lgkmcnt(6)
  v_mfma_f32_32x32x16_bf16 v[12:27], a[52:55], v[84:87], v[12:27]
  ds_read_b128 v[80:83], v6 offset:10240
  s_waitcnt lgkmcnt(6)
  v_mfma_f32_32x32x16_bf16 v[12:27], a[56:59], v[88:91], v[12:27]
  ds_read_b128 v[84:87], v6 offset:10752
  s_waitcnt lgkmcnt(6)
  v_mfma_f32_32x32x16_bf16 v[12:27], a[60:63], v[92:95], v[12:27]
  ds_read_b128 v[88:91], v6 offset:11264
  s_waitcnt lgkmcnt(6)
  v_mfma_f32_32x32x16_bf16 v[12:27], a[64:67], v[64:67], v[12:27]
  ds_read_b128 v[92:95], v6 offset:11776
  s_waitcnt lgkmcnt(6)
  v_mfma_f32_32x32x16_bf16 v[12:27], a[68:71], v[68:71], v[12:27]
  ds_read_b128 v[64:67], v6 offset:12288
  s_waitcnt lgkmcnt(6)
  v_mfma_f32_32x32x16_bf16 v[12:27], a[72:75], v[72:75], v[12:27]
  ds_read_b128 v[68:71], v6 offset:12800
  s_waitcnt lgkmcnt(6)
  v_mfma_f32_32x32x16_bf16 v[12:27], a[76:79], v[76:79], v[12:27]
  s_cmp_lg_u32 s28, 0
  s_cbranch_scc1 wo_h2
  s_waitcnt vmcnt(0)
  v_cmp_ne_u32 vcc, 1, v61
  s_cbranch_vccnz wo_h2
  s_add_u32 s22, s24, 0
  buffer_load_dwordx2 v[28:29], v7, s[8:11], s22 offen offset:0 sc1
  buffer_load_dwordx2 v[30:31], v7, s[8:11], s22 offen offset:512 sc1
  buffer_load_dwordx2 v[32:33], v7, s[8:11], s22 offen offset:256 sc1
  buffer_load_dwordx2 v[34:35], v7, s[8:11], s22 offen offset:768 sc1
  buffer_load_dwordx2 v[36:37], v7, s[8:11], s22 offen offset:2048 sc1
  buffer_load_dwordx2 v[38:39], v7, s[8:11], s22 offen offset:2560 sc1
  buffer_load_dwordx2 v[40:41], v7, s[8:11], s22 offen offset:2304 sc1
  buffer_load_dwordx2 v[42:43], v7, s[8:11], s22 offen offset:2816 sc1
  s_add_u32 s22, s24, 4096
  buffer_load_dwordx2 v[44:45], v7, s[8:11], s22 offen offset:0 sc1
  buffer_load_dwordx2 v[46:47], v7, s[8:11], s22 offen offset:512 sc1
  buffer_load_dwordx2 v[48:49], v7, s[8:11], s22 offen offset:256 sc1
  buffer_load_dwordx2 v[50:51], v7, s[8:11], s22 offen offset:768 sc1
  buffer_load_dwordx2 v[52:53], v7, s[8:11], s22 offen offset:2048 sc1
  buffer_load_dwordx2 v[54:55], v7, s[8:11], s22 offen offset:2560 sc1
  buffer_load_dwordx2 v[56:57], v7, s[8:11], s22 offen offset:2304 sc1
  buffer_load_dwordx2 v[58:59], v7, s[8:11], s22 offen offset:2816 sc1
  s_mov_b32 s28, 1
wo_h2:
  ds_read_b128 v[72:75], v6 offset:13312
  s_waitcnt lgkmcnt(6)
  v_mfma_f32_32x32x16_bf16 v[12:27], a[80:83], v[80:83], v[12:27]
  ds_read_b128 v[76:79], v6 offset:13824
  s_waitcnt lgkmcnt(6)
  v_mfma_f32_32x32x16_bf16 v[12:27], a[84:87], v[84:87], v[12:27]
  ds_read_b128 v[80:83], v6 offset:14336
  s_waitcnt lgkmcnt(6)
  v_mfma_f32_32x32x16_bf16 v[12:27], a[88:91], v[88:91], v[12:27]
  ds_read_b128 v[84:87], v6 offset:14848
  s_waitcnt lgkmcnt(6)
  v_mfma_f32_32x32x16_bf16 v[12:27], a[92:95], v[92:95], v[12:27]
  ds_read_b128 v[88:91], v6 offset:15360
  s_waitcnt lgkmcnt(6)
  v_mfma_f32_32x32x16_bf16 v[12:27], a[96:99], v[64:67], v[12:27]
  ds_read_b128 v[92:95], v6 offset:15872
  s_waitcnt lgkmcnt(6)
  v_mfma_f32_32x32x16_bf16 v[12:27], a[100:103], v[68:71], v[12:27]
  ds_read_b128 v[64:67], v6 offset:16384
  s_waitcnt lgkmcnt(6)
  v_mfma_f32_32x32x16_bf16 v[12:27], a[104:107], v[72:75], v[12:27]
  ds_read_b128 v[68:71], v6 offset:16896
  s_waitcnt lgkmcnt(6)
  v_mfma_f32_32x32x16_bf16 v[12:27], a[108:111], v[76:79], v[12:27]
  ds_read_b128 v[72:75], v6 offset:17408
  s_waitcnt lgkmcnt(6)
  v_mfma_f32_32x32x16_bf16 v[12:27], a[112:115], v[80:83], v[12:27]
  ds_read_b128 v[76:79], v6 offset:17920
  s_waitcnt lgkmcnt(6)
  v_mfma_f32_32x32x16_bf16 v[12:27], a[116:119], v[84:87], v[12:27]
  ds_read_b128 v[80:83], v6 offset:18432
  s_waitcnt lgkmcnt(6)
  v_mfma_f32_32x32x16_bf16 v[12:27], a[120:123], v[88:91], v[12:27]
  ds_read_b128 v[84:87], v6 offset:18944
  s_waitcnt lgkmcnt(6)
  v_mfma_f32_32x32x16_bf16 v[12:27], a[124:127], v[92:95], v[12:27]
  s_cmp_lg_u32 s28, 0
  s_cbranch_scc1 wo_ht
  v_lshlrev_b32 v60, 2, v3
  s_mov_b32 s30, 0
wo_wt:
  buffer_load_dword v61, v60, s[8:11], s26 offen sc1
  s_waitcnt vmcnt(0)
  v_cmp_ne_u32 vcc, 1, v61
  s_cbranch_vccz wo_wt_ok
  s_sleep 1
  s_cmp_ge_u32 s17, 61
  s_cbranch_scc1 wo_wt_bo
  s_sleep 4
  s_cmp_ge_u32 s17, 56
  s_cbranch_scc1 wo_wt_bo
  s_sleep 40
wo_wt_bo:
  s_add_u32 s30, s30, 1
  s_cmp_lt_u32 s30, 30000
  s_cbranch_scc1 wo_wt
  s_branch wo_abort
wo_wt_ok:
  s_add_u32 s22, s24, 0
  buffer_load_dwordx2 v[28:29], v7, s[8:11], s22 offen offset:0 sc1
  buffer_load_dwordx2 v[30:31], v7, s[8:11], s22 offen offset:512 sc1
  buffer_load_dwordx2 v[32:33], v7, s[8:11], s22 offen offset:256 sc1
  buffer_load_dwordx2 v[34:35], v7, s[8:11], s22 offen offset:768 sc1
  buffer_load_dwordx2 v[36:37], v7, s[8:11], s22 offen offset:2048 sc1
  buffer_load_dwordx2 v[38:39], v7, s[8:11], s22 offen offset:2560 sc1
  buffer_load_dwordx2 v[40:41], v7, s[8:11], s22 offen offset:2304 sc1
  buffer_load_dwordx2 v[42:43], v7, s[8:11], s22 offen offset:2816 sc1
  s_add_u32 s22, s24, 4096
  buffer_load_dwordx2 v[44:45], v7, s[8:11], s22 offen offset:0 sc1
  buffer_load_dwordx2 v[46:47], v7, s[8:11], s22 offen offset:512 sc1
  buffer_load_dwordx2 v[48:49], v7, s[8:11], s22 offen offset:256 sc1
  buffer_load_dwordx2 v[50:51], v7, s[8:11], s22 offen offset:768 sc1
  buffer_load_dwordx2 v[52:53], v7, s[8:11], s22 offen offset:2048 sc1
  buffer_load_dwordx2 v[54:55], v7, s[8:11], s22 offen offset:2560 sc1
  buffer_load_dwordx2 v[56:57], v7, s[8:11], s22 offen offset:2304 sc1
  buffer_load_dwordx2 v[58:59], v7, s[8:11], s22 offen offset:2816 sc1
wo_ht:
  ds_read_b128 v[88:91], v6 offset:19456
  s_waitcnt lgkmcnt(6) vmcnt(0)
  v_mfma_f32_32x32x16_bf16 v[12:27], v[28:31], v[64:67], v[12:27]
  ds_read_b128 v[92:95], v6 offset:19968
  s_waitcnt lgkmcnt(6)
  v_mfma_f32_32x32x16_bf16 v[12:27], v[32:35], v[68:71], v[12:27]
  s_waitcnt lgkmcnt(5)
  v_mfma_f32_32x32x16_bf16 v[12:27], v[36:39], v[72:75], v[12:27]
  s_waitcnt lgkmcnt(4)
  v_mfma_f32_32x32x16_bf16 v[12:27], v[40:43], v[76:79], v[12:27]
  s_waitcnt lgkmcnt(3)
  v_mfma_f32_32x32x16_bf16 v[12:27], v[44:47], v[80:83], v[12:27]
  s_waitcnt lgkmcnt(2)
  v_mfma_f32_32x32x16_bf16 v[12:27], v[48:51], v[84:87], v[12:27]
  s_waitcnt lgkmcnt(1)
  v_mfma_f32_32x32x16_bf16 v[12:27], v[52:55], v[88:91], v[12:27]
  s_waitcnt lgkmcnt(0)
  v_mfma_f32_32x32x16_bf16 v[12:27], v[56:59], v[92:95], v[12:27]
  v_mul_u32_u24 v9, 240, v9
  s_movk_i32 s23, 240
  v_lshl_add_u32 v8, v8, 3, v9
  s_mul_i32 s22, s16, 24
  v_add_u32 v7, s22, v8
  s_lshl_b32 s22, s16, 5
  v_add_u32 v8, s22, v8
  v_min_u32 v11, 223, v0
  v_mul_u32_u24 v9, 4682, v11
  v_lshrrev_b32 v9, 16, v9
  v_mul_u32_u24 v10, 14, v9
  v_sub_u32 v10, v11, v10
  v_cmp_gt_u32 vcc, 8, v10
  v_lshlrev_b32 v10, 4, v10
  v_mad_u32_u24 v11, v9, s23, v10
  v_mul_u32_u24 v9, 1792, v9
  v_add_u32 v10, v9, v10
  s_lshl_b32 s22, s18, 7
  s_mul_i32 s27, s18, 96
  s_add_u32 s27, s27, 384
  v_mov_b32 v9, s22
  v_mov_b32 v5, s27
  v_cndmask_b32 v9, v5, v9, vcc
  v_add_u32 v10, v9, v10
  s_mul_i32 s26, s17, 57344
  s_add_u32 s26, s26, 896
  s_add_u32 s27, s26, 28672
  v_cvt_pk_bf16_f32 v96, v12, v13
  v_cvt_pk_bf16_f32 v97, v14, v15
  ds_write_b64 v8, v[96:97] offset:49152
  v_cvt_pk_bf16_f32 v98, v16, v17
  v_cvt_pk_bf16_f32 v99, v18, v19
  ds_write_b64 v8, v[98:99] offset:49168
  v_cvt_pk_bf16_f32 v100, v20, v21
  v_cvt_pk_bf16_f32 v101, v22, v23
  ds_write_b64 v7, v[100:101] offset:49280
  v_cvt_pk_bf16_f32 v102, v24, v25
  v_cvt_pk_bf16_f32 v103, v26, v27
  s_mov_b32 exec_hi, 0
  ds_write_b64 v7, v[102:103] offset:49296
  s_mov_b64 exec, -1
  s_waitcnt lgkmcnt(0)
  s_barrier
  ds_read_b128 v[104:107], v11 offset:49152
  ds_read_b128 v[108:111], v11 offset:52992
  s_cmp_lg_u32 s16, 3
  s_cselect_b32 exec_hi, -1, 0
  s_waitcnt lgkmcnt(1)
  buffer_store_dwordx4 v[104:107], v10, s[92:95], s26 offen
  s_waitcnt lgkmcnt(0)
  buffer_store_dwordx4 v[108:111], v10, s[92:95], s27 offen
  s_mov_b64 exec, -1
  v_readfirstlane_b32 s22, v250
  s_cmp_ge_u32 s22, 1440
  s_cbranch_scc1 ch_end
  s_branch wk_loop
wp_abort:
wo_abort:
  s_branch cA_abort
ch_end:
  s_endpgm

.section .rodata,"a"
.p2align 6
.amdhsa_kernel main_kernel
  .amdhsa_next_free_vgpr 512
  .amdhsa_next_free_sgpr 102
  .amdhsa_accum_offset 256
  .amdhsa_group_segment_fixed_size 0
  .amdhsa_kernarg_size 136
  .amdhsa_user_sgpr_count 2
  .amdhsa_user_sgpr_kernarg_segment_ptr 1
  .amdhsa_system_sgpr_workgroup_id_x 1
.end_amdhsa_kernel
```

```asm
; @launch kernel=main_kernel grid=(256,1,1) block=(256,1,1) lds=163840
.amdgcn_target "amdgcn-amd-amdhsa--gfx950"
.text
.globl main_kernel
.p2align 8
.type main_kernel,@function
main_kernel:
  s_cmp_ge_u32 s2, 256
  s_cbranch_scc1 ch_end
  s_load_dwordx4 s[4:7], s[0:1], 120
  s_load_dwordx2 s[92:93], s[0:1], 112
  s_load_dwordx8 s[36:43], s[0:1], 56
  s_load_dwordx4 s[44:47], s[0:1], 88
  s_memrealtime s[88:89]
  s_getpc_b64 s[98:99]
pf_main_kernel_1:
  s_sub_u32 s98, s98, pf_main_kernel_1-main_kernel
  s_subb_u32 s99, s99, 0
  s_lshr_b32 s20, s2, 3
  v_lshl_add_u32 v60, v0, 5, s20
  v_lshlrev_b32 v60, 7, v60
  v_min_u32 v60, ch_end-main_kernel-4, v60
  v_cmp_gt_u32 vcc, 32, v0
  s_and_saveexec_b64 s[22:23], vcc
  s_cbranch_execz pf_main_kernel_1_n
  global_load_dword v62, v60, s[98:99]
pf_main_kernel_1_n:
  s_mov_b64 exec, -1
  s_getreg_b32 s67, hwreg(HW_REG_XCC_ID)
  s_and_b32 s67, s67, 7
  v_lshrrev_b32 v1, 6, v0
  s_nop 0
  v_readfirstlane_b32 s16, v1
  s_mov_b32 s66, 0
  s_mov_b32 s68, 0
  s_mov_b32 s69, 0
  s_mov_b32 s96, 0
  s_mov_b32 s97, 0
  s_mov_b32 s101, 0x5eed0000
  s_sub_u32 s20, s67, 0
  s_lshr_b32 s21, s2, 3
  s_and_b32 s20, s20, 7
  s_lshl_b32 s3, s20, 5
  s_add_u32 s3, s3, s21
  s_waitcnt lgkmcnt(0)
  s_mov_b32 s8, s6
  s_and_b32 s9, s7, 0xffff
  s_mov_b32 s10, 0x10000000
  s_mov_b32 s11, 0x20000
  s_mov_b32 s12, s4
  s_and_b32 s13, s5, 0xffff
  s_mov_b32 s14, 256
  s_mov_b32 s15, 0x20000
  s_or_b32 s88, s88, 1
  s_and_b32 s93, s93, 0xffff
  s_mov_b32 s94, 3670016
  s_mov_b32 s95, 0x20000
m_start:
  s_cmp_ge_u32 s3, 32
  s_cbranch_scc1 m_bjob
  v_and_b32 v1, 63, v0
  v_lshlrev_b32 v2, 4, v1
  v_lshrrev_b32 v116, 4, v1
  v_and_b32 v117, 15, v1
  v_mov_b32 v3, 0x4444
  v_mov_b32 v118, 0xeeee
  v_cmp_lt_u32 vcc, 7, v117
  s_nop 1
  v_cndmask_b32 v3, v3, v118, vcc
  s_and_b32 s17, s3, 15
  s_cmp_ge_u32 s3, 16
  s_cbranch_scc1 m_val
  s_mov_b32 s60, s42
  s_and_b32 s61, s43, 0xffff
  s_mov_b32 s62, 3670016
  s_mov_b32 s63, 0x20000
  v_lshrrev_b32 v24, 5, v1
  v_and_b32 v25, 31, v1
  s_lshl_b32 s26, s17, 9
  s_lshl_b32 s25, s16, 12
  v_xor_b32 v26, v25, v24
  v_lshlrev_b32 v26, 4, v26
  v_lshl_add_u32 v26, v24, 13, v26
  v_xor_b32 v100, 0, v26
  v_xor_b32 v101, 0, v26
  v_add_u32 v101, 15360, v101
  v_xor_b32 v102, 32, v26
  v_add_u32 v102, 30720, v102
  v_xor_b32 v103, 32, v26
  v_add_u32 v103, 46080, v103
  s_lshl_b32 s23, s16, 19
  s_add_u32 s23, s23, s26
  s_add_u32 m0, s25, 16384
  s_nop 0
  buffer_load_dwordx4 v100, s[60:63], s23 offen offset:0 lds
  buffer_load_dwordx4 v101, s[60:63], s23 offen offset:1024 lds
  buffer_load_dwordx4 v102, s[60:63], s23 offen offset:2048 lds
  buffer_load_dwordx4 v103, s[60:63], s23 offen offset:3072 lds
  s_add_u32 m0, s25, 32768
  s_add_u32 s23, s23, 65536
  buffer_load_dwordx4 v100, s[60:63], s23 offen offset:0 lds
  buffer_load_dwordx4 v101, s[60:63], s23 offen offset:1024 lds
  buffer_load_dwordx4 v102, s[60:63], s23 offen offset:2048 lds
  buffer_load_dwordx4 v103, s[60:63], s23 offen offset:3072 lds
  v_xor_b32 v100, 64, v100
  v_xor_b32 v101, 64, v101
  v_xor_b32 v102, 64, v102
  v_xor_b32 v103, 64, v103
  s_add_u32 m0, s25, 49152
  s_add_u32 s23, s23, 65536
  buffer_load_dwordx4 v100, s[60:63], s23 offen offset:0 lds
  buffer_load_dwordx4 v101, s[60:63], s23 offen offset:1024 lds
  buffer_load_dwordx4 v102, s[60:63], s23 offen offset:2048 lds
  buffer_load_dwordx4 v103, s[60:63], s23 offen offset:3072 lds
  s_add_u32 m0, s25, 65536
  s_add_u32 s23, s23, 65536
  buffer_load_dwordx4 v100, s[60:63], s23 offen offset:0 lds
  buffer_load_dwordx4 v101, s[60:63], s23 offen offset:1024 lds
  buffer_load_dwordx4 v102, s[60:63], s23 offen offset:2048 lds
  buffer_load_dwordx4 v103, s[60:63], s23 offen offset:3072 lds
  v_xor_b32 v100, 192, v100
  v_xor_b32 v101, 192, v101
  v_xor_b32 v102, 192, v102
  v_xor_b32 v103, 192, v103
  s_add_u32 m0, s25, 81920
  s_add_u32 s23, s23, 65536
  buffer_load_dwordx4 v100, s[60:63], s23 offen offset:0 lds
  buffer_load_dwordx4 v101, s[60:63], s23 offen offset:1024 lds
  buffer_load_dwordx4 v102, s[60:63], s23 offen offset:2048 lds
  buffer_load_dwordx4 v103, s[60:63], s23 offen offset:3072 lds
  s_add_u32 m0, s25, 98304
  s_add_u32 s23, s23, 65536
  buffer_load_dwordx4 v100, s[60:63], s23 offen offset:0 lds
  buffer_load_dwordx4 v101, s[60:63], s23 offen offset:1024 lds
  buffer_load_dwordx4 v102, s[60:63], s23 offen offset:2048 lds
  buffer_load_dwordx4 v103, s[60:63], s23 offen offset:3072 lds
  v_xor_b32 v100, 64, v100
  v_xor_b32 v101, 64, v101
  v_xor_b32 v102, 64, v102
  v_xor_b32 v103, 64, v103
  s_add_u32 m0, s25, 114688
  s_add_u32 s23, s23, 65536
  buffer_load_dwordx4 v100, s[60:63], s23 offen offset:0 lds
  buffer_load_dwordx4 v101, s[60:63], s23 offen offset:1024 lds
  buffer_load_dwordx4 v102, s[60:63], s23 offen offset:2048 lds
  buffer_load_dwordx4 v103, s[60:63], s23 offen offset:3072 lds
  s_add_u32 m0, s25, 131072
  s_add_u32 s23, s23, 65536
  buffer_load_dwordx4 v100, s[60:63], s23 offen offset:0 lds
  buffer_load_dwordx4 v101, s[60:63], s23 offen offset:1024 lds
  buffer_load_dwordx4 v102, s[60:63], s23 offen offset:2048 lds
  buffer_load_dwordx4 v103, s[60:63], s23 offen offset:3072 lds
  s_mov_b32 s56, s40
  s_and_b32 s57, s41, 0xffff
  s_mov_b32 s58, 3670016
  s_mov_b32 s59, 0x20000
  s_lshl_b32 s21, s16, 16
  s_add_u32 s27, s26, s21
  s_lshr_b32 s20, s16, 1
  s_lshl_b32 s20, s20, 6
  v_xor_b32 v26, s20, v26
  v_xor_b32 v4, 0, v26
  v_xor_b32 v5, 32, v26
  v_add_u32 v5, 15360, v5
  v_xor_b32 v6, 128, v26
  v_add_u32 v6, 30720, v6
  v_xor_b32 v7, 160, v26
  v_add_u32 v7, 46080, v7
  s_add_u32 s22, s27, 0
  s_add_u32 m0, s25, 0
  s_nop 0
  buffer_load_dwordx4 v4, s[56:59], s22 offen offset:0 lds
  buffer_load_dwordx4 v5, s[56:59], s22 offen offset:1024 lds
  buffer_load_dwordx4 v6, s[56:59], s22 offen offset:2048 lds
  buffer_load_dwordx4 v7, s[56:59], s22 offen offset:3072 lds
  s_cmp_lg_u32 s66, 0
  s_cbranch_scc1 sc_ci
  s_cmp_lg_u32 s16, 0
  s_cbranch_scc1 w0_2
  s_lshr_b32 s70, s3, 5
  s_and_b32 s71, s70, 4
  s_mul_i32 s71, s71, 12
  s_lshl_b32 s70, s70, 2
  s_add_u32 s70, s70, s71
  s_lshl_b32 s71, 1, s3
  v_mov_b32 v248, s71
  v_mov_b32 v249, 32
  s_mov_b64 exec, 1
  buffer_atomic_or v248, v249, s[12:15], s70 offen sc0
  buffer_load_dwordx2 v[250:251], v249, s[12:15], 0 offen offset:96 sc1
  s_mov_b64 exec, -1
w0_2:
sc_ci:
  v_and_b32 v26, 15, v25
  v_xor_b32 v27, v26, v24
  v_lshlrev_b32 v27, 4, v27
  v_bfe_u32 v28, v25, 2, 1
  v_lshlrev_b32 v28, 4, v28
  v_lshrrev_b32 v29, 3, v25
  v_lshl_add_u32 v28, v29, 2, v28
  v_and_b32 v29, 3, v25
  v_add_u32 v28, v28, v29
  v_lshl_add_u32 v28, v28, 9, v27
  v_lshrrev_b32 v29, 2, v26
  v_lshlrev_b32 v29, 15, v29
  v_bfe_u32 v30, v26, 1, 1
  v_lshl_add_u32 v29, v30, 11, v29
  v_lshrrev_b32 v30, 4, v25
  v_lshl_add_u32 v29, v30, 10, v29
  v_and_b32 v31, 1, v26
  v_lshl_add_u32 v29, v31, 9, v29
  v_add_u32 v29, v29, v27
  v_add_u32 v29, s25, v29
  v_xor_b32 v8, 0, v28
  v_xor_b32 v104, 0, v29
  v_xor_b32 v9, 32, v28
  v_xor_b32 v105, 32, v29
  v_xor_b32 v10, 64, v28
  v_xor_b32 v106, 64, v29
  v_xor_b32 v11, 96, v28
  v_xor_b32 v107, 96, v29
  v_xor_b32 v12, 128, v28
  v_xor_b32 v108, 128, v29
  v_xor_b32 v13, 160, v28
  v_xor_b32 v109, 160, v29
  v_xor_b32 v14, 192, v28
  v_xor_b32 v110, 192, v29
  v_xor_b32 v15, 224, v28
  v_xor_b32 v111, 224, v29
  s_mov_b32 s52, 1035512379
  s_waitcnt vmcnt(4)
  ds_read_b128 v[120:123], v104 offset:16384
  ds_read_b128 v[124:127], v105 offset:16384
  ds_read_b128 v[128:131], v106 offset:16384
  ds_read_b128 v[132:135], v107 offset:16384
  ds_read_b128 v[136:139], v108 offset:16384
  ds_read_b128 v[140:143], v109 offset:16384
  ds_read_b128 v[144:147], v110 offset:16384
  ds_read_b128 v[148:151], v111 offset:16384
  s_waitcnt lgkmcnt(4)
  ds_read_b128 v[152:155], v104 offset:16640
  ds_read_b128 v[156:159], v105 offset:16640
  ds_read_b128 v[160:163], v106 offset:16640
  ds_read_b128 v[164:167], v107 offset:16640
  ds_read_b128 v[168:171], v108 offset:16640
  ds_read_b128 v[172:175], v109 offset:16640
  ds_read_b128 v[176:179], v110 offset:16640
  ds_read_b128 v[180:183], v111 offset:16640
  s_waitcnt lgkmcnt(4)
  ds_read_b128 v[184:187], v104 offset:32768
  ds_read_b128 v[188:191], v105 offset:32768
  ds_read_b128 v[192:195], v106 offset:32768
  ds_read_b128 v[196:199], v107 offset:32768
  ds_read_b128 v[200:203], v108 offset:32768
  ds_read_b128 v[204:207], v109 offset:32768
  ds_read_b128 v[208:211], v110 offset:32768
  ds_read_b128 v[212:215], v111 offset:32768
  s_waitcnt lgkmcnt(4)
  ds_read_b128 v[216:219], v104 offset:33024
  ds_read_b128 v[220:223], v105 offset:33024
  ds_read_b128 v[224:227], v106 offset:33024
  ds_read_b128 v[228:231], v107 offset:33024
  ds_read_b128 v[232:235], v108 offset:33024
  ds_read_b128 v[236:239], v109 offset:33024
  ds_read_b128 v[240:243], v110 offset:33024
  ds_read_b128 v[244:247], v111 offset:33024
  s_waitcnt lgkmcnt(4)
  s_waitcnt lgkmcnt(0)
  s_add_u32 s22, s27, 262144
  s_add_u32 m0, s25, 16384
  s_nop 0
  buffer_load_dwordx4 v4, s[56:59], s22 offen offset:0 lds
  buffer_load_dwordx4 v5, s[56:59], s22 offen offset:1024 lds
  buffer_load_dwordx4 v6, s[56:59], s22 offen offset:2048 lds
  buffer_load_dwordx4 v7, s[56:59], s22 offen offset:3072 lds
  s_add_u32 s22, s27, 524288
  s_add_u32 m0, s25, 32768
  s_nop 0
  buffer_load_dwordx4 v4, s[56:59], s22 offen offset:0 lds
  buffer_load_dwordx4 v5, s[56:59], s22 offen offset:1024 lds
  buffer_load_dwordx4 v6, s[56:59], s22 offen offset:2048 lds
  buffer_load_dwordx4 v7, s[56:59], s22 offen offset:3072 lds
  s_add_u32 s22, s27, 786432
  s_add_u32 m0, s25, 49152
  s_nop 0
  buffer_load_dwordx4 v4, s[56:59], s22 offen offset:0 lds
  buffer_load_dwordx4 v5, s[56:59], s22 offen offset:1024 lds
  buffer_load_dwordx4 v6, s[56:59], s22 offen offset:2048 lds
  buffer_load_dwordx4 v7, s[56:59], s22 offen offset:3072 lds
  s_cmp_lg_u32 s66, 0
  s_cbranch_scc1 sc_cf
  s_cmp_lg_u32 s16, 0
  s_cbranch_scc1 w0_3
  s_waitcnt vmcnt(12)
  v_readfirstlane_b32 s70, v250
  s_cmp_lg_u32 s70, 0
  s_cbranch_scc1 sc_nz
  v_mov_b32 v249, 128
  v_mov_b32 v250, s88
  v_mov_b32 v251, s89
  v_mov_b32 v252, 0
  v_mov_b32 v253, 0
  s_mov_b64 exec, 1
  buffer_atomic_cmpswap_x2 v[250:253], v249, s[12:15], 0 offen sc0
  s_mov_b64 exec, -1
  s_waitcnt vmcnt(0)
  v_readfirstlane_b32 s70, v250
  s_cmp_lg_u32 s70, 0
  s_cbranch_scc1 sc_nz
  v_mov_b32 v250, s88
  v_mov_b32 v251, s89
sc_nz:
w0_3:
  v_mov_b32 v249, 160000
  s_add_u32 s101, s101, 1
  s_barrier
  s_mov_b64 exec, 1
  s_cmp_lg_u32 s16, 0
  s_cbranch_scc1 w0_4
  ds_write_b32 v249, v248 offset:0
  ds_write_b32 v249, v250 offset:4
  ds_write_b32 v249, v251 offset:8
  s_waitcnt lgkmcnt(0)
  v_mov_b32 v248, s101
  ds_write_b32 v249, v248 offset:16
  s_waitcnt lgkmcnt(0)
w0_4:
  s_mov_b64 exec, -1
  s_barrier
  ds_read_b32 v248, v249 offset:0
  ds_read_b32 v250, v249 offset:4
  ds_read_b32 v251, v249 offset:8
  ds_read_b32 v249, v249 offset:16
  s_waitcnt lgkmcnt(0)
  v_readfirstlane_b32 s70, v248
  v_readfirstlane_b32 s88, v250
  v_readfirstlane_b32 s89, v251
  v_cmp_ne_u32 vcc, s101, v249
  s_cbranch_vccnz ch_end
  s_mov_b32 s66, 1
  s_bitcmp1_b32 s70, s3
  s_cbranch_scc1 m_reclaim
sc_cf:
  s_cmp_lg_u32 s16, 0
  s_cbranch_scc1 w0_5
  s_cmp_eq_u32 s67, 0
  s_cselect_b32 s20, 1, 0x10001
  v_mov_b32 v248, s20
  v_mov_b32 v249, 0
  s_mov_b64 exec, 1
  buffer_atomic_add v248, v249, s[12:15], 0 offen
  s_mov_b64 exec, -1
w0_5:
  s_lshl_b32 s28, s17, 7
  s_add_u32 s28, s28, 88635392
  v_min_u32 v113, 96, v2
  s_mov_b32 s29, 88602624
  v_add_u32 v112, 1024, v2
  v_min_u32 v112, 1776, v112
  s_mul_i32 s32, s17, 401408
  s_mul_i32 s33, s16, 14336
  s_add_u32 s32, s32, s33
  s_add_u32 s33, s32, s33
  s_add_u32 s32, s32, 344064
  s_add_u32 s33, s33, 229376
  s_waitcnt vmcnt(8)
  s_barrier
  ds_read_b128 v[16:19], v8 offset:0
  ds_read_b128 v[20:23], v9 offset:0
  ds_read_b128 v[24:27], v10 offset:0
  ds_read_b128 v[28:31], v11 offset:0
  s_waitcnt lgkmcnt(3)
  v_mfma_f32_32x32x16_bf16 v[32:47], v[16:19], v[120:123], 0
  s_add_u32 s22, s27, 1048576
  s_add_u32 m0, s25, 65536
  s_nop 0
  buffer_load_dwordx4 v4, s[56:59], s22 offen offset:0 lds
  v_mfma_f32_32x32x16_bf16 v[48:63], v[16:19], v[184:187], 0
  ds_read_b128 v[16:19], v12 offset:0
  s_waitcnt lgkmcnt(3)
  v_mfma_f32_32x32x16_bf16 v[32:47], v[20:23], v[124:127], v[32:47]
  buffer_load_dwordx4 v5, s[56:59], s22 offen offset:1024 lds
  v_mfma_f32_32x32x16_bf16 v[48:63], v[20:23], v[188:191], v[48:63]
  ds_read_b128 v[20:23], v13 offset:0
  s_waitcnt lgkmcnt(3)
  v_mfma_f32_32x32x16_bf16 v[32:47], v[24:27], v[128:131], v[32:47]
  buffer_load_dwordx4 v6, s[56:59], s22 offen offset:2048 lds
  v_mfma_f32_32x32x16_bf16 v[48:63], v[24:27], v[192:195], v[48:63]
  ds_read_b128 v[24:27], v14 offset:0
  s_waitcnt lgkmcnt(3)
  v_mfma_f32_32x32x16_bf16 v[32:47], v[28:31], v[132:135], v[32:47]
  buffer_load_dwordx4 v7, s[56:59], s22 offen offset:3072 lds
  v_mfma_f32_32x32x16_bf16 v[48:63], v[28:31], v[196:199], v[48:63]
  ds_read_b128 v[28:31], v15 offset:0
  s_waitcnt lgkmcnt(3)
  v_mfma_f32_32x32x16_bf16 v[32:47], v[16:19], v[136:139], v[32:47]
  s_add_u32 s22, s27, 1310720
  s_add_u32 m0, s25, 81920
  s_nop 0
  buffer_load_dwordx4 v4, s[56:59], s22 offen offset:0 lds
  v_mfma_f32_32x32x16_bf16 v[48:63], v[16:19], v[200:203], v[48:63]
  ds_read_b128 v[16:19], v8 offset:256
  s_waitcnt lgkmcnt(3)
  v_mfma_f32_32x32x16_bf16 v[32:47], v[20:23], v[140:143], v[32:47]
  buffer_load_dwordx4 v5, s[56:59], s22 offen offset:1024 lds
  v_mfma_f32_32x32x16_bf16 v[48:63], v[20:23], v[204:207], v[48:63]
  ds_read_b128 v[20:23], v9 offset:256
  s_waitcnt lgkmcnt(3)
  v_mfma_f32_32x32x16_bf16 v[32:47], v[24:27], v[144:147], v[32:47]
  buffer_load_dwordx4 v6, s[56:59], s22 offen offset:2048 lds
  v_mfma_f32_32x32x16_bf16 v[48:63], v[24:27], v[208:211], v[48:63]
  ds_read_b128 v[24:27], v10 offset:256
  s_waitcnt lgkmcnt(3)
  v_mfma_f32_32x32x16_bf16 v[32:47], v[28:31], v[148:151], v[32:47]
  buffer_load_dwordx4 v7, s[56:59], s22 offen offset:3072 lds
  v_mfma_f32_32x32x16_bf16 v[48:63], v[28:31], v[212:215], v[48:63]
  ds_read_b128 v[28:31], v11 offset:256
  s_waitcnt lgkmcnt(3)
  v_mfma_f32_32x32x16_bf16 v[32:47], v[16:19], v[152:155], v[32:47]
  s_add_u32 s22, s27, 1572864
  s_add_u32 m0, s25, 98304
  s_nop 0
  buffer_load_dwordx4 v4, s[56:59], s22 offen offset:0 lds
  v_mfma_f32_32x32x16_bf16 v[48:63], v[16:19], v[216:219], v[48:63]
  ds_read_b128 v[16:19], v12 offset:256
  s_waitcnt lgkmcnt(3)
  v_mfma_f32_32x32x16_bf16 v[32:47], v[20:23], v[156:159], v[32:47]
  buffer_load_dwordx4 v5, s[56:59], s22 offen offset:1024 lds
  v_mfma_f32_32x32x16_bf16 v[48:63], v[20:23], v[220:223], v[48:63]
  ds_read_b128 v[20:23], v13 offset:256
  s_waitcnt lgkmcnt(3)
  v_mfma_f32_32x32x16_bf16 v[32:47], v[24:27], v[160:163], v[32:47]
  buffer_load_dwordx4 v6, s[56:59], s22 offen offset:2048 lds
  v_mfma_f32_32x32x16_bf16 v[48:63], v[24:27], v[224:227], v[48:63]
  ds_read_b128 v[24:27], v14 offset:256
  s_waitcnt lgkmcnt(3)
  v_mfma_f32_32x32x16_bf16 v[32:47], v[28:31], v[164:167], v[32:47]
  buffer_load_dwordx4 v7, s[56:59], s22 offen offset:3072 lds
  v_mfma_f32_32x32x16_bf16 v[48:63], v[28:31], v[228:231], v[48:63]
  ds_read_b128 v[28:31], v15 offset:256
  s_waitcnt lgkmcnt(3)
  v_mfma_f32_32x32x16_bf16 v[32:47], v[16:19], v[168:171], v[32:47]
  s_add_u32 s22, s27, 1835008
  s_add_u32 m0, s25, 114688
  s_nop 0
  buffer_load_dwordx4 v4, s[56:59], s22 offen offset:0 lds
  v_mfma_f32_32x32x16_bf16 v[48:63], v[16:19], v[232:235], v[48:63]
  ds_read_b128 v[16:19], v8 offset:16384
  s_waitcnt lgkmcnt(3)
  v_mfma_f32_32x32x16_bf16 v[32:47], v[20:23], v[172:175], v[32:47]
  buffer_load_dwordx4 v5, s[56:59], s22 offen offset:1024 lds
  v_mfma_f32_32x32x16_bf16 v[48:63], v[20:23], v[236:239], v[48:63]
  ds_read_b128 v[20:23], v9 offset:16384
  s_waitcnt lgkmcnt(3)
  v_mfma_f32_32x32x16_bf16 v[32:47], v[24:27], v[176:179], v[32:47]
  buffer_load_dwordx4 v6, s[56:59], s22 offen offset:2048 lds
  v_mfma_f32_32x32x16_bf16 v[48:63], v[24:27], v[240:243], v[48:63]
  ds_read_b128 v[24:27], v10 offset:16384
  s_waitcnt lgkmcnt(3)
  v_mfma_f32_32x32x16_bf16 v[32:47], v[28:31], v[180:183], v[32:47]
  buffer_load_dwordx4 v7, s[56:59], s22 offen offset:3072 lds
  v_mfma_f32_32x32x16_bf16 v[48:63], v[28:31], v[244:247], v[48:63]
  s_waitcnt vmcnt(16)
  s_barrier
  ds_read_b128 v[28:31], v11 offset:16384
  s_waitcnt lgkmcnt(3)
  v_mfma_f32_32x32x16_bf16 v[64:79], v[16:19], v[120:123], 0
  s_add_u32 s22, s27, 2097152
  s_add_u32 m0, s25, 131072
  s_nop 0
  buffer_load_dwordx4 v4, s[56:59], s22 offen offset:0 lds
  v_mfma_f32_32x32x16_bf16 v[80:95], v[16:19], v[184:187], 0
  ds_read_b128 v[16:19], v12 offset:16384
  s_waitcnt lgkmcnt(3)
  v_mfma_f32_32x32x16_bf16 v[64:79], v[20:23], v[124:127], v[64:79]
  buffer_load_dwordx4 v5, s[56:59], s22 offen offset:1024 lds
  v_mul_f32 v32, s52, v32
  v_mul_f32 v33, s52, v33
  v_cvt_pk_bf16_f32 v32, v32, v33
  v_mfma_f32_32x32x16_bf16 v[80:95], v[20:23], v[188:191], v[80:95]
  v_mul_f32 v34, s52, v34
  v_mul_f32 v35, s52, v35
  ds_read_b128 v[20:23], v13 offset:16384
  s_waitcnt lgkmcnt(3)
  v_mfma_f32_32x32x16_bf16 v[64:79], v[24:27], v[128:131], v[64:79]
  buffer_load_dwordx4 v6, s[56:59], s22 offen offset:2048 lds
  v_cvt_pk_bf16_f32 v33, v34, v35
  v_mul_f32 v36, s52, v36
  v_mul_f32 v37, s52, v37
  v_mfma_f32_32x32x16_bf16 v[80:95], v[24:27], v[192:195], v[80:95]
  v_cvt_pk_bf16_f32 v34, v36, v37
  v_mul_f32 v38, s52, v38
  ds_read_b128 v[24:27], v14 offset:16384
  s_waitcnt lgkmcnt(3)
  v_mfma_f32_32x32x16_bf16 v[64:79], v[28:31], v[132:135], v[64:79]
  buffer_load_dwordx4 v7, s[56:59], s22 offen offset:3072 lds
  v_mul_f32 v39, s52, v39
  v_cvt_pk_bf16_f32 v35, v38, v39
  v_mul_f32 v40, s52, v40
  v_mfma_f32_32x32x16_bf16 v[80:95], v[28:31], v[196:199], v[80:95]
  v_mul_f32 v41, s52, v41
  v_cvt_pk_bf16_f32 v40, v40, v41
  ds_read_b128 v[28:31], v15 offset:16384
  s_waitcnt lgkmcnt(3)
  v_mfma_f32_32x32x16_bf16 v[64:79], v[16:19], v[136:139], v[64:79]
  s_add_u32 s22, s27, 2359296
  s_add_u32 m0, s25, 0
  s_nop 0
  buffer_load_dwordx4 v4, s[56:59], s22 offen offset:0 lds
  v_mul_f32 v42, s52, v42
  v_mul_f32 v43, s52, v43
  v_cvt_pk_bf16_f32 v41, v42, v43
  v_mfma_f32_32x32x16_bf16 v[80:95], v[16:19], v[200:203], v[80:95]
  v_mul_f32 v44, s52, v44
  v_mul_f32 v45, s52, v45
  ds_read_b128 v[16:19], v8 offset:16640
  s_waitcnt lgkmcnt(3)
  v_mfma_f32_32x32x16_bf16 v[64:79], v[20:23], v[140:143], v[64:79]
  buffer_load_dwordx4 v5, s[56:59], s22 offen offset:1024 lds
  v_cvt_pk_bf16_f32 v42, v44, v45
  v_mul_f32 v46, s52, v46
  v_mul_f32 v47, s52, v47
  v_mfma_f32_32x32x16_bf16 v[80:95], v[20:23], v[204:207], v[80:95]
  v_cvt_pk_bf16_f32 v43, v46, v47
  v_permlane16_swap_b32 v32, v40
  ds_read_b128 v[20:23], v9 offset:16640
  s_waitcnt lgkmcnt(3)
  v_mfma_f32_32x32x16_bf16 v[64:79], v[24:27], v[144:147], v[64:79]
  buffer_load_dwordx4 v6, s[56:59], s22 offen offset:2048 lds
  v_permlane16_swap_b32 v33, v41
  v_permlane16_swap_b32 v34, v42
  v_permlane16_swap_b32 v35, v43
  v_mfma_f32_32x32x16_bf16 v[80:95], v[24:27], v[208:211], v[80:95]
  v_accvgpr_write_b32 a0, v32
  v_accvgpr_write_b32 a1, v33
  ds_read_b128 v[24:27], v10 offset:16640
  s_waitcnt lgkmcnt(3)
  v_mfma_f32_32x32x16_bf16 v[64:79], v[28:31], v[148:151], v[64:79]
  buffer_load_dwordx4 v7, s[56:59], s22 offen offset:3072 lds
  v_accvgpr_write_b32 a2, v34
  v_accvgpr_write_b32 a3, v35
  v_accvgpr_write_b32 a56, v40
  v_mfma_f32_32x32x16_bf16 v[80:95], v[28:31], v[212:215], v[80:95]
  v_accvgpr_write_b32 a57, v41
  v_accvgpr_write_b32 a58, v42
  ds_read_b128 v[28:31], v11 offset:16640
  s_waitcnt lgkmcnt(3)
  v_mfma_f32_32x32x16_bf16 v[64:79], v[16:19], v[152:155], v[64:79]
  v_accvgpr_write_b32 a59, v43
  v_mul_f32 v48, s52, v48
  v_mul_f32 v49, s52, v49
  v_mfma_f32_32x32x16_bf16 v[80:95], v[16:19], v[216:219], v[80:95]
  v_cvt_pk_bf16_f32 v48, v48, v49
  v_mul_f32 v50, s52, v50
  ds_read_b128 v[16:19], v12 offset:16640
  s_waitcnt lgkmcnt(3)
  v_mfma_f32_32x32x16_bf16 v[64:79], v[20:23], v[156:159], v[64:79]
  v_mul_f32 v51, s52, v51
  v_cvt_pk_bf16_f32 v49, v50, v51
  v_mul_f32 v52, s52, v52
  v_mfma_f32_32x32x16_bf16 v[80:95], v[20:23], v[220:223], v[80:95]
  v_mul_f32 v53, s52, v53
  v_cvt_pk_bf16_f32 v50, v52, v53
  ds_read_b128 v[20:23], v13 offset:16640
  s_waitcnt lgkmcnt(3)
  v_mfma_f32_32x32x16_bf16 v[64:79], v[24:27], v[160:163], v[64:79]
  v_mul_f32 v54, s52, v54
  v_mul_f32 v55, s52, v55
  v_cvt_pk_bf16_f32 v51, v54, v55
  v_mfma_f32_32x32x16_bf16 v[80:95], v[24:27], v[224:227], v[80:95]
  v_mul_f32 v56, s52, v56
  v_mul_f32 v57, s52, v57
  ds_read_b128 v[24:27], v14 offset:16640
  s_waitcnt lgkmcnt(3)
  v_mfma_f32_32x32x16_bf16 v[64:79], v[28:31], v[164:167], v[64:79]
  v_cvt_pk_bf16_f32 v56, v56, v57
  v_mul_f32 v58, s52, v58
  v_mul_f32 v59, s52, v59
  v_mfma_f32_32x32x16_bf16 v[80:95], v[28:31], v[228:231], v[80:95]
  v_cvt_pk_bf16_f32 v57, v58, v59
  v_mul_f32 v60, s52, v60
  ds_read_b128 v[28:31], v15 offset:16640
  s_waitcnt lgkmcnt(3)
  v_mfma_f32_32x32x16_bf16 v[64:79], v[16:19], v[168:171], v[64:79]
  v_mul_f32 v61, s52, v61
  v_cvt_pk_bf16_f32 v58, v60, v61
  v_mul_f32 v62, s52, v62
  v_mfma_f32_32x32x16_bf16 v[80:95], v[16:19], v[232:235], v[80:95]
  v_mul_f32 v63, s52, v63
  v_cvt_pk_bf16_f32 v59, v62, v63
  ds_read_b128 v[16:19], v8 offset:32768
  s_waitcnt lgkmcnt(3)
  v_mfma_f32_32x32x16_bf16 v[64:79], v[20:23], v[172:175], v[64:79]
  v_permlane16_swap_b32 v48, v56
  v_permlane16_swap_b32 v49, v57
  v_permlane16_swap_b32 v50, v58
  v_mfma_f32_32x32x16_bf16 v[80:95], v[20:23], v[236:239], v[80:95]
  v_permlane16_swap_b32 v51, v59
  v_accvgpr_write_b32 a112, v48
  ds_read_b128 v[20:23], v9 offset:32768
  s_waitcnt lgkmcnt(3)
  v_mfma_f32_32x32x16_bf16 v[64:79], v[24:27], v[176:179], v[64:79]
  v_accvgpr_write_b32 a113, v49
  v_accvgpr_write_b32 a114, v50
  v_accvgpr_write_b32 a115, v51
  v_mfma_f32_32x32x16_bf16 v[80:95], v[24:27], v[240:243], v[80:95]
  v_accvgpr_write_b32 a168, v56
  v_accvgpr_write_b32 a169, v57
  ds_read_b128 v[24:27], v10 offset:32768
  s_waitcnt lgkmcnt(3)
  v_mfma_f32_32x32x16_bf16 v[64:79], v[28:31], v[180:183], v[64:79]
  v_accvgpr_write_b32 a170, v58
  v_accvgpr_write_b32 a171, v59
  v_mfma_f32_32x32x16_bf16 v[80:95], v[28:31], v[244:247], v[80:95]
  ds_read_b128 v[28:31], v11 offset:32768
  s_waitcnt lgkmcnt(3)
  v_mfma_f32_32x32x16_bf16 v[32:47], v[16:19], v[120:123], 0
  v_mfma_f32_32x32x16_bf16 v[48:63], v[16:19], v[184:187], 0
  ds_read_b128 v[16:19], v12 offset:32768
  s_waitcnt lgkmcnt(3)
  v_mfma_f32_32x32x16_bf16 v[32:47], v[20:23], v[124:127], v[32:47]
  v_mul_f32 v64, s52, v64
  v_mul_f32 v65, s52, v65
  v_cvt_pk_bf16_f32 v64, v64, v65
  v_mfma_f32_32x32x16_bf16 v[48:63], v[20:23], v[188:191], v[48:63]
  v_mul_f32 v66, s52, v66
  v_mul_f32 v67, s52, v67
  ds_read_b128 v[20:23], v13 offset:32768
  s_waitcnt lgkmcnt(3)
  v_mfma_f32_32x32x16_bf16 v[32:47], v[24:27], v[128:131], v[32:47]
  v_cvt_pk_bf16_f32 v65, v66, v67
  v_mul_f32 v68, s52, v68
  v_mul_f32 v69, s52, v69
  v_mfma_f32_32x32x16_bf16 v[48:63], v[24:27], v[192:195], v[48:63]
  v_cvt_pk_bf16_f32 v66, v68, v69
  v_mul_f32 v70, s52, v70
  ds_read_b128 v[24:27], v14 offset:32768
  s_waitcnt lgkmcnt(3)
  v_mfma_f32_32x32x16_bf16 v[32:47], v[28:31], v[132:135], v[32:47]
  v_mul_f32 v71, s52, v71
  v_cvt_pk_bf16_f32 v67, v70, v71
  v_mul_f32 v72, s52, v72
  v_mfma_f32_32x32x16_bf16 v[48:63], v[28:31], v[196:199], v[48:63]
  v_mul_f32 v73, s52, v73
  v_cvt_pk_bf16_f32 v72, v72, v73
  ds_read_b128 v[28:31], v15 offset:32768
  s_waitcnt lgkmcnt(3)
  v_mfma_f32_32x32x16_bf16 v[32:47], v[16:19], v[136:139], v[32:47]
  v_mul_f32 v74, s52, v74
  v_mul_f32 v75, s52, v75
  v_cvt_pk_bf16_f32 v73, v74, v75
  v_mfma_f32_32x32x16_bf16 v[48:63], v[16:19], v[200:203], v[48:63]
  v_mul_f32 v76, s52, v76
  v_mul_f32 v77, s52, v77
  ds_read_b128 v[16:19], v8 offset:33024
  s_waitcnt lgkmcnt(3)
  v_mfma_f32_32x32x16_bf16 v[32:47], v[20:23], v[140:143], v[32:47]
  v_cvt_pk_bf16_f32 v74, v76, v77
  v_mul_f32 v78, s52, v78
  v_mul_f32 v79, s52, v79
  v_mfma_f32_32x32x16_bf16 v[48:63], v[20:23], v[204:207], v[48:63]
  v_cvt_pk_bf16_f32 v75, v78, v79
  v_permlane16_swap_b32 v64, v72
  ds_read_b128 v[20:23], v9 offset:33024
  s_waitcnt lgkmcnt(3)
  v_mfma_f32_32x32x16_bf16 v[32:47], v[24:27], v[144:147], v[32:47]
  v_permlane16_swap_b32 v65, v73
  v_permlane16_swap_b32 v66, v74
  v_permlane16_swap_b32 v67, v75
  v_mfma_f32_32x32x16_bf16 v[48:63], v[24:27], v[208:211], v[48:63]
  v_accvgpr_write_b32 a4, v64
  v_accvgpr_write_b32 a5, v65
  ds_read_b128 v[24:27], v10 offset:33024
  s_waitcnt lgkmcnt(3)
  v_mfma_f32_32x32x16_bf16 v[32:47], v[28:31], v[148:151], v[32:47]
  v_accvgpr_write_b32 a6, v66
  v_accvgpr_write_b32 a7, v67
  v_accvgpr_write_b32 a60, v72
  v_mfma_f32_32x32x16_bf16 v[48:63], v[28:31], v[212:215], v[48:63]
  v_accvgpr_write_b32 a61, v73
  v_accvgpr_write_b32 a62, v74
  ds_read_b128 v[28:31], v11 offset:33024
  s_waitcnt lgkmcnt(3)
  v_mfma_f32_32x32x16_bf16 v[32:47], v[16:19], v[152:155], v[32:47]
  v_accvgpr_write_b32 a63, v75
  v_mul_f32 v80, s52, v80
  v_mul_f32 v81, s52, v81
  v_mfma_f32_32x32x16_bf16 v[48:63], v[16:19], v[216:219], v[48:63]
  v_cvt_pk_bf16_f32 v80, v80, v81
  v_mul_f32 v82, s52, v82
  ds_read_b128 v[16:19], v12 offset:33024
  s_waitcnt lgkmcnt(3)
  v_mfma_f32_32x32x16_bf16 v[32:47], v[20:23], v[156:159], v[32:47]
  v_mul_f32 v83, s52, v83
  v_cvt_pk_bf16_f32 v81, v82, v83
  v_mul_f32 v84, s52, v84
  v_mfma_f32_32x32x16_bf16 v[48:63], v[20:23], v[220:223], v[48:63]
  v_mul_f32 v85, s52, v85
  v_cvt_pk_bf16_f32 v82, v84, v85
  ds_read_b128 v[20:23], v13 offset:33024
  s_waitcnt lgkmcnt(3)
  v_mfma_f32_32x32x16_bf16 v[32:47], v[24:27], v[160:163], v[32:47]
  v_mul_f32 v86, s52, v86
  v_mul_f32 v87, s52, v87
  v_cvt_pk_bf16_f32 v83, v86, v87
  v_mfma_f32_32x32x16_bf16 v[48:63], v[24:27], v[224:227], v[48:63]
  v_mul_f32 v88, s52, v88
  v_mul_f32 v89, s52, v89
  ds_read_b128 v[24:27], v14 offset:33024
  s_waitcnt lgkmcnt(3)
  v_mfma_f32_32x32x16_bf16 v[32:47], v[28:31], v[164:167], v[32:47]
  v_cvt_pk_bf16_f32 v88, v88, v89
  v_mul_f32 v90, s52, v90
  v_mul_f32 v91, s52, v91
  v_mfma_f32_32x32x16_bf16 v[48:63], v[28:31], v[228:231], v[48:63]
  v_cvt_pk_bf16_f32 v89, v90, v91
  v_mul_f32 v92, s52, v92
  ds_read_b128 v[28:31], v15 offset:33024
  s_waitcnt lgkmcnt(3)
  v_mfma_f32_32x32x16_bf16 v[32:47], v[16:19], v[168:171], v[32:47]
  v_mul_f32 v93, s52, v93
  v_cvt_pk_bf16_f32 v90, v92, v93
  v_mul_f32 v94, s52, v94
  v_mfma_f32_32x32x16_bf16 v[48:63], v[16:19], v[232:235], v[48:63]
  v_mul_f32 v95, s52, v95
  v_cvt_pk_bf16_f32 v91, v94, v95
  ds_read_b128 v[16:19], v8 offset:49152
  s_waitcnt lgkmcnt(3)
  v_mfma_f32_32x32x16_bf16 v[32:47], v[20:23], v[172:175], v[32:47]
  v_permlane16_swap_b32 v80, v88
  v_permlane16_swap_b32 v81, v89
  v_permlane16_swap_b32 v82, v90
  v_mfma_f32_32x32x16_bf16 v[48:63], v[20:23], v[236:239], v[48:63]
  v_permlane16_swap_b32 v83, v91
  v_accvgpr_write_b32 a116, v80
  ds_read_b128 v[20:23], v9 offset:49152
  s_waitcnt lgkmcnt(3)
  v_mfma_f32_32x32x16_bf16 v[32:47], v[24:27], v[176:179], v[32:47]
  v_accvgpr_write_b32 a117, v81
  v_accvgpr_write_b32 a118, v82
  v_accvgpr_write_b32 a119, v83
  v_mfma_f32_32x32x16_bf16 v[48:63], v[24:27], v[240:243], v[48:63]
  v_accvgpr_write_b32 a172, v88
  v_accvgpr_write_b32 a173, v89
  ds_read_b128 v[24:27], v10 offset:49152
  s_waitcnt lgkmcnt(3)
  v_mfma_f32_32x32x16_bf16 v[32:47], v[28:31], v[180:183], v[32:47]
  v_accvgpr_write_b32 a174, v90
  v_accvgpr_write_b32 a175, v91
  v_mfma_f32_32x32x16_bf16 v[48:63], v[28:31], v[244:247], v[48:63]
  s_waitcnt vmcnt(16)
  s_barrier
  ds_read_b128 v[28:31], v11 offset:49152
  s_waitcnt lgkmcnt(3)
  v_mfma_f32_32x32x16_bf16 v[64:79], v[16:19], v[120:123], 0
  s_add_u32 s22, s27, 2621440
  s_add_u32 m0, s25, 16384
  s_nop 0
  buffer_load_dwordx4 v4, s[56:59], s22 offen offset:0 lds
  v_mfma_f32_32x32x16_bf16 v[80:95], v[16:19], v[184:187], 0
  ds_read_b128 v[16:19], v12 offset:49152
  s_waitcnt lgkmcnt(3)
  v_mfma_f32_32x32x16_bf16 v[64:79], v[20:23], v[124:127], v[64:79]
  buffer_load_dwordx4 v5, s[56:59], s22 offen offset:1024 lds
  v_mul_f32 v32, s52, v32
  v_mul_f32 v33, s52, v33
  v_cvt_pk_bf16_f32 v32, v32, v33
  v_mfma_f32_32x32x16_bf16 v[80:95], v[20:23], v[188:191], v[80:95]
  v_mul_f32 v34, s52, v34
  v_mul_f32 v35, s52, v35
  ds_read_b128 v[20:23], v13 offset:49152
  s_waitcnt lgkmcnt(3)
  v_mfma_f32_32x32x16_bf16 v[64:79], v[24:27], v[128:131], v[64:79]
  buffer_load_dwordx4 v6, s[56:59], s22 offen offset:2048 lds
  v_cvt_pk_bf16_f32 v33, v34, v35
  v_mul_f32 v36, s52, v36
  v_mul_f32 v37, s52, v37
  v_mfma_f32_32x32x16_bf16 v[80:95], v[24:27], v[192:195], v[80:95]
  v_cvt_pk_bf16_f32 v34, v36, v37
  v_mul_f32 v38, s52, v38
  ds_read_b128 v[24:27], v14 offset:49152
  s_waitcnt lgkmcnt(3)
  v_mfma_f32_32x32x16_bf16 v[64:79], v[28:31], v[132:135], v[64:79]
  buffer_load_dwordx4 v7, s[56:59], s22 offen offset:3072 lds
  v_mul_f32 v39, s52, v39
  v_cvt_pk_bf16_f32 v35, v38, v39
  v_mul_f32 v40, s52, v40
  v_mfma_f32_32x32x16_bf16 v[80:95], v[28:31], v[196:199], v[80:95]
  v_mul_f32 v41, s52, v41
  v_cvt_pk_bf16_f32 v40, v40, v41
  ds_read_b128 v[28:31], v15 offset:49152
  s_waitcnt lgkmcnt(3)
  v_mfma_f32_32x32x16_bf16 v[64:79], v[16:19], v[136:139], v[64:79]
  s_add_u32 s22, s27, 2883584
  s_add_u32 m0, s25, 32768
  s_nop 0
  buffer_load_dwordx4 v4, s[56:59], s22 offen offset:0 lds
  v_mul_f32 v42, s52, v42
  v_mul_f32 v43, s52, v43
  v_cvt_pk_bf16_f32 v41, v42, v43
  v_mfma_f32_32x32x16_bf16 v[80:95], v[16:19], v[200:203], v[80:95]
  v_mul_f32 v44, s52, v44
  v_mul_f32 v45, s52, v45
  ds_read_b128 v[16:19], v8 offset:49408
  s_waitcnt lgkmcnt(3)
  v_mfma_f32_32x32x16_bf16 v[64:79], v[20:23], v[140:143], v[64:79]
  buffer_load_dwordx4 v5, s[56:59], s22 offen offset:1024 lds
  v_cvt_pk_bf16_f32 v42, v44, v45
  v_mul_f32 v46, s52, v46
  v_mul_f32 v47, s52, v47
  v_mfma_f32_32x32x16_bf16 v[80:95], v[20:23], v[204:207], v[80:95]
  v_cvt_pk_bf16_f32 v43, v46, v47
  v_permlane16_swap_b32 v32, v40
  ds_read_b128 v[20:23], v9 offset:49408
  s_waitcnt lgkmcnt(3)
  v_mfma_f32_32x32x16_bf16 v[64:79], v[24:27], v[144:147], v[64:79]
  buffer_load_dwordx4 v6, s[56:59], s22 offen offset:2048 lds
  v_permlane16_swap_b32 v33, v41
  v_permlane16_swap_b32 v34, v42
  v_permlane16_swap_b32 v35, v43
  v_mfma_f32_32x32x16_bf16 v[80:95], v[24:27], v[208:211], v[80:95]
  v_accvgpr_write_b32 a8, v32
  v_accvgpr_write_b32 a9, v33
  ds_read_b128 v[24:27], v10 offset:49408
  s_waitcnt lgkmcnt(3)
  v_mfma_f32_32x32x16_bf16 v[64:79], v[28:31], v[148:151], v[64:79]
  buffer_load_dwordx4 v7, s[56:59], s22 offen offset:3072 lds
  v_accvgpr_write_b32 a10, v34
  v_accvgpr_write_b32 a11, v35
  v_accvgpr_write_b32 a64, v40
  v_mfma_f32_32x32x16_bf16 v[80:95], v[28:31], v[212:215], v[80:95]
  v_accvgpr_write_b32 a65, v41
  v_accvgpr_write_b32 a66, v42
  ds_read_b128 v[28:31], v11 offset:49408
  s_waitcnt lgkmcnt(3)
  v_mfma_f32_32x32x16_bf16 v[64:79], v[16:19], v[152:155], v[64:79]
  v_accvgpr_write_b32 a67, v43
  v_mul_f32 v48, s52, v48
  v_mul_f32 v49, s52, v49
  v_mfma_f32_32x32x16_bf16 v[80:95], v[16:19], v[216:219], v[80:95]
  v_cvt_pk_bf16_f32 v48, v48, v49
  v_mul_f32 v50, s52, v50
  ds_read_b128 v[16:19], v12 offset:49408
  s_waitcnt lgkmcnt(3)
  v_mfma_f32_32x32x16_bf16 v[64:79], v[20:23], v[156:159], v[64:79]
  v_mul_f32 v51, s52, v51
  v_cvt_pk_bf16_f32 v49, v50, v51
  v_mul_f32 v52, s52, v52
  v_mfma_f32_32x32x16_bf16 v[80:95], v[20:23], v[220:223], v[80:95]
  v_mul_f32 v53, s52, v53
  v_cvt_pk_bf16_f32 v50, v52, v53
  ds_read_b128 v[20:23], v13 offset:49408
  s_waitcnt lgkmcnt(3)
  v_mfma_f32_32x32x16_bf16 v[64:79], v[24:27], v[160:163], v[64:79]
  v_mul_f32 v54, s52, v54
  v_mul_f32 v55, s52, v55
  v_cvt_pk_bf16_f32 v51, v54, v55
  v_mfma_f32_32x32x16_bf16 v[80:95], v[24:27], v[224:227], v[80:95]
  v_mul_f32 v56, s52, v56
  v_mul_f32 v57, s52, v57
  ds_read_b128 v[24:27], v14 offset:49408
  s_waitcnt lgkmcnt(3)
  v_mfma_f32_32x32x16_bf16 v[64:79], v[28:31], v[164:167], v[64:79]
  v_cvt_pk_bf16_f32 v56, v56, v57
  v_mul_f32 v58, s52, v58
  v_mul_f32 v59, s52, v59
  v_mfma_f32_32x32x16_bf16 v[80:95], v[28:31], v[228:231], v[80:95]
  v_cvt_pk_bf16_f32 v57, v58, v59
  v_mul_f32 v60, s52, v60
  ds_read_b128 v[28:31], v15 offset:49408
  s_waitcnt lgkmcnt(3)
  v_mfma_f32_32x32x16_bf16 v[64:79], v[16:19], v[168:171], v[64:79]
  v_mul_f32 v61, s52, v61
  v_cvt_pk_bf16_f32 v58, v60, v61
  v_mul_f32 v62, s52, v62
  v_mfma_f32_32x32x16_bf16 v[80:95], v[16:19], v[232:235], v[80:95]
  v_mul_f32 v63, s52, v63
  v_cvt_pk_bf16_f32 v59, v62, v63
  v_xor_b32 v8, 65536, v8
  ds_read_b128 v[16:19], v8 offset:0
  s_waitcnt lgkmcnt(3)
  v_mfma_f32_32x32x16_bf16 v[64:79], v[20:23], v[172:175], v[64:79]
  v_permlane16_swap_b32 v48, v56
  v_permlane16_swap_b32 v49, v57
  v_permlane16_swap_b32 v50, v58
  v_mfma_f32_32x32x16_bf16 v[80:95], v[20:23], v[236:239], v[80:95]
  v_permlane16_swap_b32 v51, v59
  v_accvgpr_write_b32 a120, v48
  v_xor_b32 v9, 65536, v9
  ds_read_b128 v[20:23], v9 offset:0
  s_waitcnt lgkmcnt(3)
  v_mfma_f32_32x32x16_bf16 v[64:79], v[24:27], v[176:179], v[64:79]
  v_accvgpr_write_b32 a121, v49
  v_accvgpr_write_b32 a122, v50
  v_accvgpr_write_b32 a123, v51
  v_mfma_f32_32x32x16_bf16 v[80:95], v[24:27], v[240:243], v[80:95]
  v_accvgpr_write_b32 a176, v56
  v_accvgpr_write_b32 a177, v57
  v_xor_b32 v10, 65536, v10
  ds_read_b128 v[24:27], v10 offset:0
  s_waitcnt lgkmcnt(3)
  v_mfma_f32_32x32x16_bf16 v[64:79], v[28:31], v[180:183], v[64:79]
  v_accvgpr_write_b32 a178, v58
  v_accvgpr_write_b32 a179, v59
  v_mfma_f32_32x32x16_bf16 v[80:95], v[28:31], v[244:247], v[80:95]
  v_xor_b32 v11, 65536, v11
  ds_read_b128 v[28:31], v11 offset:0
  s_waitcnt lgkmcnt(3)
  v_mfma_f32_32x32x16_bf16 v[32:47], v[16:19], v[120:123], 0
  v_mfma_f32_32x32x16_bf16 v[48:63], v[16:19], v[184:187], 0
  v_xor_b32 v12, 65536, v12
  ds_read_b128 v[16:19], v12 offset:0
  s_waitcnt lgkmcnt(3)
  v_mfma_f32_32x32x16_bf16 v[32:47], v[20:23], v[124:127], v[32:47]
  v_mul_f32 v64, s52, v64
  v_mul_f32 v65, s52, v65
  v_cvt_pk_bf16_f32 v64, v64, v65
  v_mfma_f32_32x32x16_bf16 v[48:63], v[20:23], v[188:191], v[48:63]
  v_mul_f32 v66, s52, v66
  v_mul_f32 v67, s52, v67
  v_xor_b32 v13, 65536, v13
  ds_read_b128 v[20:23], v13 offset:0
  s_waitcnt lgkmcnt(3)
  v_mfma_f32_32x32x16_bf16 v[32:47], v[24:27], v[128:131], v[32:47]
  v_cvt_pk_bf16_f32 v65, v66, v67
  v_mul_f32 v68, s52, v68
  v_mul_f32 v69, s52, v69
  v_mfma_f32_32x32x16_bf16 v[48:63], v[24:27], v[192:195], v[48:63]
  v_cvt_pk_bf16_f32 v66, v68, v69
  v_mul_f32 v70, s52, v70
  v_xor_b32 v14, 65536, v14
  ds_read_b128 v[24:27], v14 offset:0
  s_waitcnt lgkmcnt(3)
  v_mfma_f32_32x32x16_bf16 v[32:47], v[28:31], v[132:135], v[32:47]
  v_mul_f32 v71, s52, v71
  v_cvt_pk_bf16_f32 v67, v70, v71
  v_mul_f32 v72, s52, v72
  v_mfma_f32_32x32x16_bf16 v[48:63], v[28:31], v[196:199], v[48:63]
  v_mul_f32 v73, s52, v73
  v_cvt_pk_bf16_f32 v72, v72, v73
  v_xor_b32 v15, 65536, v15
  ds_read_b128 v[28:31], v15 offset:0
  s_waitcnt lgkmcnt(3)
  v_mfma_f32_32x32x16_bf16 v[32:47], v[16:19], v[136:139], v[32:47]
  v_mul_f32 v74, s52, v74
  v_mul_f32 v75, s52, v75
  v_cvt_pk_bf16_f32 v73, v74, v75
  v_mfma_f32_32x32x16_bf16 v[48:63], v[16:19], v[200:203], v[48:63]
  v_mul_f32 v76, s52, v76
  v_mul_f32 v77, s52, v77
  ds_read_b128 v[16:19], v8 offset:256
  s_waitcnt lgkmcnt(3)
  v_mfma_f32_32x32x16_bf16 v[32:47], v[20:23], v[140:143], v[32:47]
  v_cvt_pk_bf16_f32 v74, v76, v77
  v_mul_f32 v78, s52, v78
  v_mul_f32 v79, s52, v79
  v_mfma_f32_32x32x16_bf16 v[48:63], v[20:23], v[204:207], v[48:63]
  v_cvt_pk_bf16_f32 v75, v78, v79
  v_permlane16_swap_b32 v64, v72
  ds_read_b128 v[20:23], v9 offset:256
  s_waitcnt lgkmcnt(3)
  v_mfma_f32_32x32x16_bf16 v[32:47], v[24:27], v[144:147], v[32:47]
  v_permlane16_swap_b32 v65, v73
  v_permlane16_swap_b32 v66, v74
  v_permlane16_swap_b32 v67, v75
  v_mfma_f32_32x32x16_bf16 v[48:63], v[24:27], v[208:211], v[48:63]
  v_accvgpr_write_b32 a12, v64
  v_accvgpr_write_b32 a13, v65
  ds_read_b128 v[24:27], v10 offset:256
  s_waitcnt lgkmcnt(3)
  v_mfma_f32_32x32x16_bf16 v[32:47], v[28:31], v[148:151], v[32:47]
  v_accvgpr_write_b32 a14, v66
  v_accvgpr_write_b32 a15, v67
  v_accvgpr_write_b32 a68, v72
  v_mfma_f32_32x32x16_bf16 v[48:63], v[28:31], v[212:215], v[48:63]
  v_accvgpr_write_b32 a69, v73
  v_accvgpr_write_b32 a70, v74
  ds_read_b128 v[28:31], v11 offset:256
  s_waitcnt lgkmcnt(3)
  v_mfma_f32_32x32x16_bf16 v[32:47], v[16:19], v[152:155], v[32:47]
  v_accvgpr_write_b32 a71, v75
  v_mul_f32 v80, s52, v80
  v_mul_f32 v81, s52, v81
  v_mfma_f32_32x32x16_bf16 v[48:63], v[16:19], v[216:219], v[48:63]
  v_cvt_pk_bf16_f32 v80, v80, v81
  v_mul_f32 v82, s52, v82
  ds_read_b128 v[16:19], v12 offset:256
  s_waitcnt lgkmcnt(3)
  v_mfma_f32_32x32x16_bf16 v[32:47], v[20:23], v[156:159], v[32:47]
  v_mul_f32 v83, s52, v83
  v_cvt_pk_bf16_f32 v81, v82, v83
  v_mul_f32 v84, s52, v84
  v_mfma_f32_32x32x16_bf16 v[48:63], v[20:23], v[220:223], v[48:63]
  v_mul_f32 v85, s52, v85
  v_cvt_pk_bf16_f32 v82, v84, v85
  ds_read_b128 v[20:23], v13 offset:256
  s_waitcnt lgkmcnt(3)
  v_mfma_f32_32x32x16_bf16 v[32:47], v[24:27], v[160:163], v[32:47]
  v_mul_f32 v86, s52, v86
  v_mul_f32 v87, s52, v87
  v_cvt_pk_bf16_f32 v83, v86, v87
  v_mfma_f32_32x32x16_bf16 v[48:63], v[24:27], v[224:227], v[48:63]
  v_mul_f32 v88, s52, v88
  v_mul_f32 v89, s52, v89
  ds_read_b128 v[24:27], v14 offset:256
  s_waitcnt lgkmcnt(3)
  v_mfma_f32_32x32x16_bf16 v[32:47], v[28:31], v[164:167], v[32:47]
  v_cvt_pk_bf16_f32 v88, v88, v89
  v_mul_f32 v90, s52, v90
  v_mul_f32 v91, s52, v91
  v_mfma_f32_32x32x16_bf16 v[48:63], v[28:31], v[228:231], v[48:63]
  v_cvt_pk_bf16_f32 v89, v90, v91
  v_mul_f32 v92, s52, v92
  ds_read_b128 v[28:31], v15 offset:256
  s_waitcnt lgkmcnt(3)
  v_mfma_f32_32x32x16_bf16 v[32:47], v[16:19], v[168:171], v[32:47]
  v_mul_f32 v93, s52, v93
  v_cvt_pk_bf16_f32 v90, v92, v93
  v_mul_f32 v94, s52, v94
  v_mfma_f32_32x32x16_bf16 v[48:63], v[16:19], v[232:235], v[48:63]
  v_mul_f32 v95, s52, v95
  v_cvt_pk_bf16_f32 v91, v94, v95
  ds_read_b128 v[16:19], v8 offset:16384
  s_waitcnt lgkmcnt(3)
  v_mfma_f32_32x32x16_bf16 v[32:47], v[20:23], v[172:175], v[32:47]
  v_permlane16_swap_b32 v80, v88
  v_permlane16_swap_b32 v81, v89
  v_permlane16_swap_b32 v82, v90
  v_mfma_f32_32x32x16_bf16 v[48:63], v[20:23], v[236:239], v[48:63]
  v_permlane16_swap_b32 v83, v91
  v_accvgpr_write_b32 a124, v80
  ds_read_b128 v[20:23], v9 offset:16384
  s_waitcnt lgkmcnt(3)
  v_mfma_f32_32x32x16_bf16 v[32:47], v[24:27], v[176:179], v[32:47]
  v_accvgpr_write_b32 a125, v81
  v_accvgpr_write_b32 a126, v82
  v_accvgpr_write_b32 a127, v83
  v_mfma_f32_32x32x16_bf16 v[48:63], v[24:27], v[240:243], v[48:63]
  v_accvgpr_write_b32 a180, v88
  v_accvgpr_write_b32 a181, v89
  ds_read_b128 v[24:27], v10 offset:16384
  s_waitcnt lgkmcnt(3)
  v_mfma_f32_32x32x16_bf16 v[32:47], v[28:31], v[180:183], v[32:47]
  v_accvgpr_write_b32 a182, v90
  v_accvgpr_write_b32 a183, v91
  v_mfma_f32_32x32x16_bf16 v[48:63], v[28:31], v[244:247], v[48:63]
  s_waitcnt vmcnt(16)
  s_barrier
  ds_read_b128 v[28:31], v11 offset:16384
  s_waitcnt lgkmcnt(3)
  v_mfma_f32_32x32x16_bf16 v[64:79], v[16:19], v[120:123], 0
  s_add_u32 s22, s27, 3145728
  s_add_u32 m0, s25, 49152
  s_nop 0
  buffer_load_dwordx4 v4, s[56:59], s22 offen offset:0 lds
  v_mfma_f32_32x32x16_bf16 v[80:95], v[16:19], v[184:187], 0
  ds_read_b128 v[16:19], v12 offset:16384
  s_waitcnt lgkmcnt(3)
  v_mfma_f32_32x32x16_bf16 v[64:79], v[20:23], v[124:127], v[64:79]
  buffer_load_dwordx4 v5, s[56:59], s22 offen offset:1024 lds
  v_mul_f32 v32, s52, v32
  v_mul_f32 v33, s52, v33
  v_cvt_pk_bf16_f32 v32, v32, v33
  v_mfma_f32_32x32x16_bf16 v[80:95], v[20:23], v[188:191], v[80:95]
  v_mul_f32 v34, s52, v34
  v_mul_f32 v35, s52, v35
  ds_read_b128 v[20:23], v13 offset:16384
  s_waitcnt lgkmcnt(3)
  v_mfma_f32_32x32x16_bf16 v[64:79], v[24:27], v[128:131], v[64:79]
  buffer_load_dwordx4 v6, s[56:59], s22 offen offset:2048 lds
  v_cvt_pk_bf16_f32 v33, v34, v35
  v_mul_f32 v36, s52, v36
  v_mul_f32 v37, s52, v37
  v_mfma_f32_32x32x16_bf16 v[80:95], v[24:27], v[192:195], v[80:95]
  v_cvt_pk_bf16_f32 v34, v36, v37
  v_mul_f32 v38, s52, v38
  ds_read_b128 v[24:27], v14 offset:16384
  s_waitcnt lgkmcnt(3)
  v_mfma_f32_32x32x16_bf16 v[64:79], v[28:31], v[132:135], v[64:79]
  buffer_load_dwordx4 v7, s[56:59], s22 offen offset:3072 lds
  v_mul_f32 v39, s52, v39
  v_cvt_pk_bf16_f32 v35, v38, v39
  v_mul_f32 v40, s52, v40
  v_mfma_f32_32x32x16_bf16 v[80:95], v[28:31], v[196:199], v[80:95]
  v_mul_f32 v41, s52, v41
  v_cvt_pk_bf16_f32 v40, v40, v41
  ds_read_b128 v[28:31], v15 offset:16384
  s_waitcnt lgkmcnt(3)
  v_mfma_f32_32x32x16_bf16 v[64:79], v[16:19], v[136:139], v[64:79]
  s_add_u32 s22, s27, 3407872
  s_add_u32 m0, s25, 65536
  s_nop 0
  buffer_load_dwordx4 v4, s[56:59], s22 offen offset:0 lds
  v_mul_f32 v42, s52, v42
  v_mul_f32 v43, s52, v43
  v_cvt_pk_bf16_f32 v41, v42, v43
  v_mfma_f32_32x32x16_bf16 v[80:95], v[16:19], v[200:203], v[80:95]
  v_mul_f32 v44, s52, v44
  v_mul_f32 v45, s52, v45
  ds_read_b128 v[16:19], v8 offset:16640
  s_waitcnt lgkmcnt(3)
  v_mfma_f32_32x32x16_bf16 v[64:79], v[20:23], v[140:143], v[64:79]
  buffer_load_dwordx4 v5, s[56:59], s22 offen offset:1024 lds
  v_cvt_pk_bf16_f32 v42, v44, v45
  v_mul_f32 v46, s52, v46
  v_mul_f32 v47, s52, v47
  v_mfma_f32_32x32x16_bf16 v[80:95], v[20:23], v[204:207], v[80:95]
  v_cvt_pk_bf16_f32 v43, v46, v47
  v_permlane16_swap_b32 v32, v40
  ds_read_b128 v[20:23], v9 offset:16640
  s_waitcnt lgkmcnt(3)
  v_mfma_f32_32x32x16_bf16 v[64:79], v[24:27], v[144:147], v[64:79]
  buffer_load_dwordx4 v6, s[56:59], s22 offen offset:2048 lds
  v_permlane16_swap_b32 v33, v41
  v_permlane16_swap_b32 v34, v42
  v_permlane16_swap_b32 v35, v43
  v_mfma_f32_32x32x16_bf16 v[80:95], v[24:27], v[208:211], v[80:95]
  v_accvgpr_write_b32 a16, v32
  v_accvgpr_write_b32 a17, v33
  ds_read_b128 v[24:27], v10 offset:16640
  s_waitcnt lgkmcnt(3)
  v_mfma_f32_32x32x16_bf16 v[64:79], v[28:31], v[148:151], v[64:79]
  buffer_load_dwordx4 v7, s[56:59], s22 offen offset:3072 lds
  v_accvgpr_write_b32 a18, v34
  v_accvgpr_write_b32 a19, v35
  v_accvgpr_write_b32 a72, v40
  v_mfma_f32_32x32x16_bf16 v[80:95], v[28:31], v[212:215], v[80:95]
  v_accvgpr_write_b32 a73, v41
  v_accvgpr_write_b32 a74, v42
  ds_read_b128 v[28:31], v11 offset:16640
  s_waitcnt lgkmcnt(3)
  v_mfma_f32_32x32x16_bf16 v[64:79], v[16:19], v[152:155], v[64:79]
  v_accvgpr_write_b32 a75, v43
  v_mul_f32 v48, s52, v48
  v_mul_f32 v49, s52, v49
  v_mfma_f32_32x32x16_bf16 v[80:95], v[16:19], v[216:219], v[80:95]
  v_cvt_pk_bf16_f32 v48, v48, v49
  v_mul_f32 v50, s52, v50
  ds_read_b128 v[16:19], v12 offset:16640
  s_waitcnt lgkmcnt(3)
  v_mfma_f32_32x32x16_bf16 v[64:79], v[20:23], v[156:159], v[64:79]
  v_mul_f32 v51, s52, v51
  v_cvt_pk_bf16_f32 v49, v50, v51
  v_mul_f32 v52, s52, v52
  v_mfma_f32_32x32x16_bf16 v[80:95], v[20:23], v[220:223], v[80:95]
  v_mul_f32 v53, s52, v53
  v_cvt_pk_bf16_f32 v50, v52, v53
  ds_read_b128 v[20:23], v13 offset:16640
  s_waitcnt lgkmcnt(3)
  v_mfma_f32_32x32x16_bf16 v[64:79], v[24:27], v[160:163], v[64:79]
  v_mul_f32 v54, s52, v54
  v_mul_f32 v55, s52, v55
  v_cvt_pk_bf16_f32 v51, v54, v55
  v_mfma_f32_32x32x16_bf16 v[80:95], v[24:27], v[224:227], v[80:95]
  v_mul_f32 v56, s52, v56
  v_mul_f32 v57, s52, v57
  ds_read_b128 v[24:27], v14 offset:16640
  s_waitcnt lgkmcnt(3)
  v_mfma_f32_32x32x16_bf16 v[64:79], v[28:31], v[164:167], v[64:79]
  v_cvt_pk_bf16_f32 v56, v56, v57
  v_mul_f32 v58, s52, v58
  v_mul_f32 v59, s52, v59
  v_mfma_f32_32x32x16_bf16 v[80:95], v[28:31], v[228:231], v[80:95]
  v_cvt_pk_bf16_f32 v57, v58, v59
  v_mul_f32 v60, s52, v60
  ds_read_b128 v[28:31], v15 offset:16640
  s_waitcnt lgkmcnt(3)
  v_mfma_f32_32x32x16_bf16 v[64:79], v[16:19], v[168:171], v[64:79]
  v_mul_f32 v61, s52, v61
  v_cvt_pk_bf16_f32 v58, v60, v61
  v_mul_f32 v62, s52, v62
  v_mfma_f32_32x32x16_bf16 v[80:95], v[16:19], v[232:235], v[80:95]
  v_mul_f32 v63, s52, v63
  v_cvt_pk_bf16_f32 v59, v62, v63
  ds_read_b128 v[16:19], v8 offset:32768
  s_waitcnt lgkmcnt(3)
  v_mfma_f32_32x32x16_bf16 v[64:79], v[20:23], v[172:175], v[64:79]
  v_permlane16_swap_b32 v48, v56
  v_permlane16_swap_b32 v49, v57
  v_permlane16_swap_b32 v50, v58
  v_mfma_f32_32x32x16_bf16 v[80:95], v[20:23], v[236:239], v[80:95]
  v_permlane16_swap_b32 v51, v59
  v_accvgpr_write_b32 a128, v48
  ds_read_b128 v[20:23], v9 offset:32768
  s_waitcnt lgkmcnt(3)
  v_mfma_f32_32x32x16_bf16 v[64:79], v[24:27], v[176:179], v[64:79]
  v_accvgpr_write_b32 a129, v49
  v_accvgpr_write_b32 a130, v50
  v_accvgpr_write_b32 a131, v51
  v_mfma_f32_32x32x16_bf16 v[80:95], v[24:27], v[240:243], v[80:95]
  v_accvgpr_write_b32 a184, v56
  v_accvgpr_write_b32 a185, v57
  ds_read_b128 v[24:27], v10 offset:32768
  s_waitcnt lgkmcnt(3)
  v_mfma_f32_32x32x16_bf16 v[64:79], v[28:31], v[180:183], v[64:79]
  v_accvgpr_write_b32 a186, v58
  v_accvgpr_write_b32 a187, v59
  v_mfma_f32_32x32x16_bf16 v[80:95], v[28:31], v[244:247], v[80:95]
  ds_read_b128 v[28:31], v11 offset:32768
  s_waitcnt lgkmcnt(3)
  v_mfma_f32_32x32x16_bf16 v[32:47], v[16:19], v[120:123], 0
  v_mfma_f32_32x32x16_bf16 v[48:63], v[16:19], v[184:187], 0
  ds_read_b128 v[16:19], v12 offset:32768
  s_waitcnt lgkmcnt(3)
  v_mfma_f32_32x32x16_bf16 v[32:47], v[20:23], v[124:127], v[32:47]
  v_mul_f32 v64, s52, v64
  v_mul_f32 v65, s52, v65
  v_cvt_pk_bf16_f32 v64, v64, v65
  v_mfma_f32_32x32x16_bf16 v[48:63], v[20:23], v[188:191], v[48:63]
  v_mul_f32 v66, s52, v66
  v_mul_f32 v67, s52, v67
  ds_read_b128 v[20:23], v13 offset:32768
  s_waitcnt lgkmcnt(3)
  v_mfma_f32_32x32x16_bf16 v[32:47], v[24:27], v[128:131], v[32:47]
  v_cvt_pk_bf16_f32 v65, v66, v67
  v_mul_f32 v68, s52, v68
  v_mul_f32 v69, s52, v69
  v_mfma_f32_32x32x16_bf16 v[48:63], v[24:27], v[192:195], v[48:63]
  v_cvt_pk_bf16_f32 v66, v68, v69
  v_mul_f32 v70, s52, v70
  ds_read_b128 v[24:27], v14 offset:32768
  s_waitcnt lgkmcnt(3)
  v_mfma_f32_32x32x16_bf16 v[32:47], v[28:31], v[132:135], v[32:47]
  v_mul_f32 v71, s52, v71
  v_cvt_pk_bf16_f32 v67, v70, v71
  v_mul_f32 v72, s52, v72
  v_mfma_f32_32x32x16_bf16 v[48:63], v[28:31], v[196:199], v[48:63]
  v_mul_f32 v73, s52, v73
  v_cvt_pk_bf16_f32 v72, v72, v73
  ds_read_b128 v[28:31], v15 offset:32768
  s_waitcnt lgkmcnt(3)
  v_mfma_f32_32x32x16_bf16 v[32:47], v[16:19], v[136:139], v[32:47]
  v_mul_f32 v74, s52, v74
  v_mul_f32 v75, s52, v75
  v_cvt_pk_bf16_f32 v73, v74, v75
  v_mfma_f32_32x32x16_bf16 v[48:63], v[16:19], v[200:203], v[48:63]
  v_mul_f32 v76, s52, v76
  v_mul_f32 v77, s52, v77
  ds_read_b128 v[16:19], v8 offset:33024
  s_waitcnt lgkmcnt(3)
  v_mfma_f32_32x32x16_bf16 v[32:47], v[20:23], v[140:143], v[32:47]
  v_cvt_pk_bf16_f32 v74, v76, v77
  v_mul_f32 v78, s52, v78
  v_mul_f32 v79, s52, v79
  v_mfma_f32_32x32x16_bf16 v[48:63], v[20:23], v[204:207], v[48:63]
  v_cvt_pk_bf16_f32 v75, v78, v79
  v_permlane16_swap_b32 v64, v72
  ds_read_b128 v[20:23], v9 offset:33024
  s_waitcnt lgkmcnt(3)
  v_mfma_f32_32x32x16_bf16 v[32:47], v[24:27], v[144:147], v[32:47]
  v_permlane16_swap_b32 v65, v73
  v_permlane16_swap_b32 v66, v74
  v_permlane16_swap_b32 v67, v75
  v_mfma_f32_32x32x16_bf16 v[48:63], v[24:27], v[208:211], v[48:63]
  v_accvgpr_write_b32 a20, v64
  v_accvgpr_write_b32 a21, v65
  ds_read_b128 v[24:27], v10 offset:33024
  s_waitcnt lgkmcnt(3)
  v_mfma_f32_32x32x16_bf16 v[32:47], v[28:31], v[148:151], v[32:47]
  v_accvgpr_write_b32 a22, v66
  v_accvgpr_write_b32 a23, v67
  v_accvgpr_write_b32 a76, v72
  v_mfma_f32_32x32x16_bf16 v[48:63], v[28:31], v[212:215], v[48:63]
  v_accvgpr_write_b32 a77, v73
  v_accvgpr_write_b32 a78, v74
  ds_read_b128 v[28:31], v11 offset:33024
  s_waitcnt lgkmcnt(3)
  v_mfma_f32_32x32x16_bf16 v[32:47], v[16:19], v[152:155], v[32:47]
  v_accvgpr_write_b32 a79, v75
  v_mul_f32 v80, s52, v80
  v_mul_f32 v81, s52, v81
  v_mfma_f32_32x32x16_bf16 v[48:63], v[16:19], v[216:219], v[48:63]
  v_cvt_pk_bf16_f32 v80, v80, v81
  v_mul_f32 v82, s52, v82
  ds_read_b128 v[16:19], v12 offset:33024
  s_waitcnt lgkmcnt(3)
  v_mfma_f32_32x32x16_bf16 v[32:47], v[20:23], v[156:159], v[32:47]
  v_mul_f32 v83, s52, v83
  v_cvt_pk_bf16_f32 v81, v82, v83
  v_mul_f32 v84, s52, v84
  v_mfma_f32_32x32x16_bf16 v[48:63], v[20:23], v[220:223], v[48:63]
  v_mul_f32 v85, s52, v85
  v_cvt_pk_bf16_f32 v82, v84, v85
  ds_read_b128 v[20:23], v13 offset:33024
  s_waitcnt lgkmcnt(3)
  v_mfma_f32_32x32x16_bf16 v[32:47], v[24:27], v[160:163], v[32:47]
  v_mul_f32 v86, s52, v86
  v_mul_f32 v87, s52, v87
  v_cvt_pk_bf16_f32 v83, v86, v87
  v_mfma_f32_32x32x16_bf16 v[48:63], v[24:27], v[224:227], v[48:63]
  v_mul_f32 v88, s52, v88
  v_mul_f32 v89, s52, v89
  ds_read_b128 v[24:27], v14 offset:33024
  s_waitcnt lgkmcnt(3)
  v_mfma_f32_32x32x16_bf16 v[32:47], v[28:31], v[164:167], v[32:47]
  v_cvt_pk_bf16_f32 v88, v88, v89
  v_mul_f32 v90, s52, v90
  v_mul_f32 v91, s52, v91
  v_mfma_f32_32x32x16_bf16 v[48:63], v[28:31], v[228:231], v[48:63]
  v_cvt_pk_bf16_f32 v89, v90, v91
  v_mul_f32 v92, s52, v92
  ds_read_b128 v[28:31], v15 offset:33024
  s_waitcnt lgkmcnt(3)
  v_mfma_f32_32x32x16_bf16 v[32:47], v[16:19], v[168:171], v[32:47]
  v_mul_f32 v93, s52, v93
  v_cvt_pk_bf16_f32 v90, v92, v93
  v_mul_f32 v94, s52, v94
  v_mfma_f32_32x32x16_bf16 v[48:63], v[16:19], v[232:235], v[48:63]
  v_mul_f32 v95, s52, v95
  v_cvt_pk_bf16_f32 v91, v94, v95
  ds_read_b128 v[16:19], v8 offset:49152
  s_waitcnt lgkmcnt(3)
  v_mfma_f32_32x32x16_bf16 v[32:47], v[20:23], v[172:175], v[32:47]
  v_permlane16_swap_b32 v80, v88
  v_permlane16_swap_b32 v81, v89
  v_permlane16_swap_b32 v82, v90
  v_mfma_f32_32x32x16_bf16 v[48:63], v[20:23], v[236:239], v[48:63]
  v_permlane16_swap_b32 v83, v91
  v_accvgpr_write_b32 a132, v80
  ds_read_b128 v[20:23], v9 offset:49152
  s_waitcnt lgkmcnt(3)
  v_mfma_f32_32x32x16_bf16 v[32:47], v[24:27], v[176:179], v[32:47]
  v_accvgpr_write_b32 a133, v81
  v_accvgpr_write_b32 a134, v82
  v_accvgpr_write_b32 a135, v83
  v_mfma_f32_32x32x16_bf16 v[48:63], v[24:27], v[240:243], v[48:63]
  v_accvgpr_write_b32 a188, v88
  v_accvgpr_write_b32 a189, v89
  ds_read_b128 v[24:27], v10 offset:49152
  s_waitcnt lgkmcnt(3)
  v_mfma_f32_32x32x16_bf16 v[32:47], v[28:31], v[180:183], v[32:47]
  v_accvgpr_write_b32 a190, v90
  v_accvgpr_write_b32 a191, v91
  v_mfma_f32_32x32x16_bf16 v[48:63], v[28:31], v[244:247], v[48:63]
  s_waitcnt vmcnt(16)
  s_barrier
  ds_read_b128 v[28:31], v11 offset:49152
  s_waitcnt lgkmcnt(3)
  v_mfma_f32_32x32x16_bf16 v[64:79], v[16:19], v[120:123], 0
  v_mfma_f32_32x32x16_bf16 v[80:95], v[16:19], v[184:187], 0
  ds_read_b128 v[16:19], v12 offset:49152
  s_waitcnt lgkmcnt(3)
  v_mfma_f32_32x32x16_bf16 v[64:79], v[20:23], v[124:127], v[64:79]
  v_mul_f32 v32, s52, v32
  v_mul_f32 v33, s52, v33
  v_cvt_pk_bf16_f32 v32, v32, v33
  v_mfma_f32_32x32x16_bf16 v[80:95], v[20:23], v[188:191], v[80:95]
  v_mul_f32 v34, s52, v34
  v_mul_f32 v35, s52, v35
  ds_read_b128 v[20:23], v13 offset:49152
  s_waitcnt lgkmcnt(3)
  v_mfma_f32_32x32x16_bf16 v[64:79], v[24:27], v[128:131], v[64:79]
  v_cvt_pk_bf16_f32 v33, v34, v35
  v_mul_f32 v36, s52, v36
  v_mul_f32 v37, s52, v37
  v_mfma_f32_32x32x16_bf16 v[80:95], v[24:27], v[192:195], v[80:95]
  v_cvt_pk_bf16_f32 v34, v36, v37
  v_mul_f32 v38, s52, v38
  ds_read_b128 v[24:27], v14 offset:49152
  s_waitcnt lgkmcnt(3)
  v_mfma_f32_32x32x16_bf16 v[64:79], v[28:31], v[132:135], v[64:79]
  v_mul_f32 v39, s52, v39
  v_cvt_pk_bf16_f32 v35, v38, v39
  v_mul_f32 v40, s52, v40
  v_mfma_f32_32x32x16_bf16 v[80:95], v[28:31], v[196:199], v[80:95]
  v_mul_f32 v41, s52, v41
  v_cvt_pk_bf16_f32 v40, v40, v41
  ds_read_b128 v[28:31], v15 offset:49152
  s_waitcnt lgkmcnt(3)
  v_mfma_f32_32x32x16_bf16 v[64:79], v[16:19], v[136:139], v[64:79]
  buffer_load_dwordx4 v[100:103], v113, s[8:11], s28 offen sc1
  v_mul_f32 v42, s52, v42
  v_mul_f32 v43, s52, v43
  v_cvt_pk_bf16_f32 v41, v42, v43
  v_mfma_f32_32x32x16_bf16 v[80:95], v[16:19], v[200:203], v[80:95]
  v_mul_f32 v44, s52, v44
  v_mul_f32 v45, s52, v45
  ds_read_b128 v[16:19], v8 offset:49408
  s_waitcnt lgkmcnt(3)
  v_mfma_f32_32x32x16_bf16 v[64:79], v[20:23], v[140:143], v[64:79]
  v_cvt_pk_bf16_f32 v42, v44, v45
  v_mul_f32 v46, s52, v46
  v_mul_f32 v47, s52, v47
  v_mfma_f32_32x32x16_bf16 v[80:95], v[20:23], v[204:207], v[80:95]
  v_cvt_pk_bf16_f32 v43, v46, v47
  v_permlane16_swap_b32 v32, v40
  ds_read_b128 v[20:23], v9 offset:49408
  s_waitcnt lgkmcnt(3)
  v_mfma_f32_32x32x16_bf16 v[64:79], v[24:27], v[144:147], v[64:79]
  v_permlane16_swap_b32 v33, v41
  v_permlane16_swap_b32 v34, v42
  v_permlane16_swap_b32 v35, v43
  v_mfma_f32_32x32x16_bf16 v[80:95], v[24:27], v[208:211], v[80:95]
  v_accvgpr_write_b32 a24, v32
  v_accvgpr_write_b32 a25, v33
  ds_read_b128 v[24:27], v10 offset:49408
  s_waitcnt lgkmcnt(3)
  v_mfma_f32_32x32x16_bf16 v[64:79], v[28:31], v[148:151], v[64:79]
  v_accvgpr_write_b32 a26, v34
  v_accvgpr_write_b32 a27, v35
  v_accvgpr_write_b32 a80, v40
  v_mfma_f32_32x32x16_bf16 v[80:95], v[28:31], v[212:215], v[80:95]
  v_accvgpr_write_b32 a81, v41
  v_accvgpr_write_b32 a82, v42
  ds_read_b128 v[28:31], v11 offset:49408
  s_waitcnt lgkmcnt(3)
  v_mfma_f32_32x32x16_bf16 v[64:79], v[16:19], v[152:155], v[64:79]
  v_accvgpr_write_b32 a83, v43
  v_mul_f32 v48, s52, v48
  v_mul_f32 v49, s52, v49
  v_mfma_f32_32x32x16_bf16 v[80:95], v[16:19], v[216:219], v[80:95]
  v_cvt_pk_bf16_f32 v48, v48, v49
  v_mul_f32 v50, s52, v50
  ds_read_b128 v[16:19], v12 offset:49408
  s_waitcnt lgkmcnt(3)
  v_mfma_f32_32x32x16_bf16 v[64:79], v[20:23], v[156:159], v[64:79]
  v_mul_f32 v51, s52, v51
  v_cvt_pk_bf16_f32 v49, v50, v51
  v_mul_f32 v52, s52, v52
  v_mfma_f32_32x32x16_bf16 v[80:95], v[20:23], v[220:223], v[80:95]
  v_mul_f32 v53, s52, v53
  v_cvt_pk_bf16_f32 v50, v52, v53
  ds_read_b128 v[20:23], v13 offset:49408
  s_waitcnt lgkmcnt(3)
  v_mfma_f32_32x32x16_bf16 v[64:79], v[24:27], v[160:163], v[64:79]
  v_mul_f32 v54, s52, v54
  v_mul_f32 v55, s52, v55
  v_cvt_pk_bf16_f32 v51, v54, v55
  v_mfma_f32_32x32x16_bf16 v[80:95], v[24:27], v[224:227], v[80:95]
  v_mul_f32 v56, s52, v56
  v_mul_f32 v57, s52, v57
  ds_read_b128 v[24:27], v14 offset:49408
  s_waitcnt lgkmcnt(3)
  v_mfma_f32_32x32x16_bf16 v[64:79], v[28:31], v[164:167], v[64:79]
  v_cvt_pk_bf16_f32 v56, v56, v57
  v_mul_f32 v58, s52, v58
  v_mul_f32 v59, s52, v59
  v_mfma_f32_32x32x16_bf16 v[80:95], v[28:31], v[228:231], v[80:95]
  v_cvt_pk_bf16_f32 v57, v58, v59
  v_mul_f32 v60, s52, v60
  ds_read_b128 v[28:31], v15 offset:49408
  s_waitcnt lgkmcnt(3)
  v_mfma_f32_32x32x16_bf16 v[64:79], v[16:19], v[168:171], v[64:79]
  v_mul_f32 v61, s52, v61
  v_cvt_pk_bf16_f32 v58, v60, v61
  v_mul_f32 v62, s52, v62
  v_mfma_f32_32x32x16_bf16 v[80:95], v[16:19], v[232:235], v[80:95]
  v_mul_f32 v63, s52, v63
  v_cvt_pk_bf16_f32 v59, v62, v63
  v_xor_b32 v8, 196608, v8
  ds_read_b128 v[16:19], v8 offset:0
  s_waitcnt lgkmcnt(3)
  v_mfma_f32_32x32x16_bf16 v[64:79], v[20:23], v[172:175], v[64:79]
  v_permlane16_swap_b32 v48, v56
  v_permlane16_swap_b32 v49, v57
  v_permlane16_swap_b32 v50, v58
  v_mfma_f32_32x32x16_bf16 v[80:95], v[20:23], v[236:239], v[80:95]
  v_permlane16_swap_b32 v51, v59
  v_accvgpr_write_b32 a136, v48
  v_xor_b32 v9, 196608, v9
  ds_read_b128 v[20:23], v9 offset:0
  s_waitcnt lgkmcnt(3)
  v_mfma_f32_32x32x16_bf16 v[64:79], v[24:27], v[176:179], v[64:79]
  v_accvgpr_write_b32 a137, v49
  v_accvgpr_write_b32 a138, v50
  v_accvgpr_write_b32 a139, v51
  v_mfma_f32_32x32x16_bf16 v[80:95], v[24:27], v[240:243], v[80:95]
  v_accvgpr_write_b32 a192, v56
  v_accvgpr_write_b32 a193, v57
  v_xor_b32 v10, 196608, v10
  ds_read_b128 v[24:27], v10 offset:0
  s_waitcnt lgkmcnt(3)
  v_mfma_f32_32x32x16_bf16 v[64:79], v[28:31], v[180:183], v[64:79]
  v_accvgpr_write_b32 a194, v58
  v_accvgpr_write_b32 a195, v59
  v_mfma_f32_32x32x16_bf16 v[80:95], v[28:31], v[244:247], v[80:95]
  v_xor_b32 v11, 196608, v11
  ds_read_b128 v[28:31], v11 offset:0
  s_waitcnt lgkmcnt(3)
  v_mfma_f32_32x32x16_bf16 v[32:47], v[16:19], v[120:123], 0
  s_waitcnt vmcnt(0)
  v_cmp_ne_u64 vcc, s[88:89], v[100:101]
  v_cmp_ne_u64 s[54:55], s[88:89], v[102:103]
  s_add_u32 s48, s33, 0
  v_mfma_f32_32x32x16_bf16 v[48:63], v[16:19], v[184:187], 0
  v_xor_b32 v12, 196608, v12
  ds_read_b128 v[16:19], v12 offset:0
  s_waitcnt lgkmcnt(3)
  v_mfma_f32_32x32x16_bf16 v[32:47], v[20:23], v[124:127], v[32:47]
  s_or_b64 vcc, vcc, s[54:55]
  s_cselect_b32 s48, 0x10000000, s48
  s_add_u32 s22, s48, 0
  buffer_load_dwordx4 a[224:227], v2, s[8:11], s22 offen sc1
  v_mul_f32 v64, s52, v64
  v_mul_f32 v65, s52, v65
  v_cvt_pk_bf16_f32 v64, v64, v65
  v_mfma_f32_32x32x16_bf16 v[48:63], v[20:23], v[188:191], v[48:63]
  v_mul_f32 v66, s52, v66
  v_mul_f32 v67, s52, v67
  v_xor_b32 v13, 196608, v13
  ds_read_b128 v[20:23], v13 offset:0
  s_waitcnt lgkmcnt(3)
  v_mfma_f32_32x32x16_bf16 v[32:47], v[24:27], v[128:131], v[32:47]
  v_cvt_pk_bf16_f32 v65, v66, v67
  v_mul_f32 v68, s52, v68
  v_mul_f32 v69, s52, v69
  v_mfma_f32_32x32x16_bf16 v[48:63], v[24:27], v[192:195], v[48:63]
  v_cvt_pk_bf16_f32 v66, v68, v69
  v_mul_f32 v70, s52, v70
  v_xor_b32 v14, 196608, v14
  ds_read_b128 v[24:27], v14 offset:0
  s_waitcnt lgkmcnt(3)
  v_mfma_f32_32x32x16_bf16 v[32:47], v[28:31], v[132:135], v[32:47]
  s_add_u32 s22, s48, 1024
  buffer_load_dwordx4 a[228:231], v2, s[8:11], s22 offen sc1
  v_mul_f32 v71, s52, v71
  v_cvt_pk_bf16_f32 v67, v70, v71
  v_mul_f32 v72, s52, v72
  v_mfma_f32_32x32x16_bf16 v[48:63], v[28:31], v[196:199], v[48:63]
  v_mul_f32 v73, s52, v73
  v_cvt_pk_bf16_f32 v72, v72, v73
  v_xor_b32 v15, 196608, v15
  ds_read_b128 v[28:31], v15 offset:0
  s_waitcnt lgkmcnt(3)
  v_mfma_f32_32x32x16_bf16 v[32:47], v[16:19], v[136:139], v[32:47]
  v_mul_f32 v74, s52, v74
  v_mul_f32 v75, s52, v75
  v_cvt_pk_bf16_f32 v73, v74, v75
  v_mfma_f32_32x32x16_bf16 v[48:63], v[16:19], v[200:203], v[48:63]
  v_mul_f32 v76, s52, v76
  v_mul_f32 v77, s52, v77
  ds_read_b128 v[16:19], v8 offset:256
  s_waitcnt lgkmcnt(3)
  v_mfma_f32_32x32x16_bf16 v[32:47], v[20:23], v[140:143], v[32:47]
  s_add_u32 s22, s48, 2048
  buffer_load_dwordx4 a[232:235], v2, s[8:11], s22 offen sc1
  v_cvt_pk_bf16_f32 v74, v76, v77
  v_mul_f32 v78, s52, v78
  v_mul_f32 v79, s52, v79
  v_mfma_f32_32x32x16_bf16 v[48:63], v[20:23], v[204:207], v[48:63]
  v_cvt_pk_bf16_f32 v75, v78, v79
  v_permlane16_swap_b32 v64, v72
  ds_read_b128 v[20:23], v9 offset:256
  s_waitcnt lgkmcnt(3)
  v_mfma_f32_32x32x16_bf16 v[32:47], v[24:27], v[144:147], v[32:47]
  v_permlane16_swap_b32 v65, v73
  v_permlane16_swap_b32 v66, v74
  v_permlane16_swap_b32 v67, v75
  v_mfma_f32_32x32x16_bf16 v[48:63], v[24:27], v[208:211], v[48:63]
  v_accvgpr_write_b32 a28, v64
  v_accvgpr_write_b32 a29, v65
  ds_read_b128 v[24:27], v10 offset:256
  s_waitcnt lgkmcnt(3)
  v_mfma_f32_32x32x16_bf16 v[32:47], v[28:31], v[148:151], v[32:47]
  s_add_u32 s22, s48, 3072
  buffer_load_dwordx4 a[236:239], v2, s[8:11], s22 offen sc1
  v_accvgpr_write_b32 a30, v66
  v_accvgpr_write_b32 a31, v67
  v_accvgpr_write_b32 a84, v72
  v_mfma_f32_32x32x16_bf16 v[48:63], v[28:31], v[212:215], v[48:63]
  v_accvgpr_write_b32 a85, v73
  v_accvgpr_write_b32 a86, v74
  ds_read_b128 v[28:31], v11 offset:256
  s_waitcnt lgkmcnt(3)
  v_mfma_f32_32x32x16_bf16 v[32:47], v[16:19], v[152:155], v[32:47]
  v_accvgpr_write_b32 a87, v75
  v_mul_f32 v80, s52, v80
  v_mul_f32 v81, s52, v81
  v_mfma_f32_32x32x16_bf16 v[48:63], v[16:19], v[216:219], v[48:63]
  v_cvt_pk_bf16_f32 v80, v80, v81
  v_mul_f32 v82, s52, v82
  ds_read_b128 v[16:19], v12 offset:256
  s_waitcnt lgkmcnt(3)
  v_mfma_f32_32x32x16_bf16 v[32:47], v[20:23], v[156:159], v[32:47]
  s_add_u32 s22, s48, 4096
  buffer_load_dwordx4 a[240:243], v2, s[8:11], s22 offen sc1
  v_mul_f32 v83, s52, v83
  v_cvt_pk_bf16_f32 v81, v82, v83
  v_mul_f32 v84, s52, v84
  v_mfma_f32_32x32x16_bf16 v[48:63], v[20:23], v[220:223], v[48:63]
  v_mul_f32 v85, s52, v85
  v_cvt_pk_bf16_f32 v82, v84, v85
  ds_read_b128 v[20:23], v13 offset:256
  s_waitcnt lgkmcnt(3)
  v_mfma_f32_32x32x16_bf16 v[32:47], v[24:27], v[160:163], v[32:47]
  v_mul_f32 v86, s52, v86
  v_mul_f32 v87, s52, v87
  v_cvt_pk_bf16_f32 v83, v86, v87
  v_mfma_f32_32x32x16_bf16 v[48:63], v[24:27], v[224:227], v[48:63]
  v_mul_f32 v88, s52, v88
  v_mul_f32 v89, s52, v89
  ds_read_b128 v[24:27], v14 offset:256
  s_waitcnt lgkmcnt(3)
  v_mfma_f32_32x32x16_bf16 v[32:47], v[28:31], v[164:167], v[32:47]
  s_add_u32 s22, s48, 5120
  buffer_load_dwordx4 a[244:247], v2, s[8:11], s22 offen sc1
  v_cvt_pk_bf16_f32 v88, v88, v89
  v_mul_f32 v90, s52, v90
  v_mul_f32 v91, s52, v91
  v_mfma_f32_32x32x16_bf16 v[48:63], v[28:31], v[228:231], v[48:63]
  v_cvt_pk_bf16_f32 v89, v90, v91
  v_mul_f32 v92, s52, v92
  ds_read_b128 v[28:31], v15 offset:256
  s_waitcnt lgkmcnt(3)
  v_mfma_f32_32x32x16_bf16 v[32:47], v[16:19], v[168:171], v[32:47]
  v_mul_f32 v93, s52, v93
  v_cvt_pk_bf16_f32 v90, v92, v93
  v_mul_f32 v94, s52, v94
  v_mfma_f32_32x32x16_bf16 v[48:63], v[16:19], v[232:235], v[48:63]
  v_mul_f32 v95, s52, v95
  v_cvt_pk_bf16_f32 v91, v94, v95
  v_xor_b32 v8, 131072, v8
  ds_read_b128 v[16:19], v8 offset:0
  s_waitcnt lgkmcnt(3)
  v_mfma_f32_32x32x16_bf16 v[32:47], v[20:23], v[172:175], v[32:47]
  s_add_u32 s22, s48, 6144
  buffer_load_dwordx4 a[248:251], v2, s[8:11], s22 offen sc1
  v_permlane16_swap_b32 v80, v88
  v_permlane16_swap_b32 v81, v89
  v_permlane16_swap_b32 v82, v90
  v_mfma_f32_32x32x16_bf16 v[48:63], v[20:23], v[236:239], v[48:63]
  v_permlane16_swap_b32 v83, v91
  v_accvgpr_write_b32 a140, v80
  v_xor_b32 v9, 131072, v9
  ds_read_b128 v[20:23], v9 offset:0
  s_waitcnt lgkmcnt(3)
  v_mfma_f32_32x32x16_bf16 v[32:47], v[24:27], v[176:179], v[32:47]
  v_accvgpr_write_b32 a141, v81
  v_accvgpr_write_b32 a142, v82
  v_accvgpr_write_b32 a143, v83
  v_mfma_f32_32x32x16_bf16 v[48:63], v[24:27], v[240:243], v[48:63]
  v_accvgpr_write_b32 a196, v88
  v_accvgpr_write_b32 a197, v89
  v_xor_b32 v10, 131072, v10
  ds_read_b128 v[24:27], v10 offset:0
  s_waitcnt lgkmcnt(3)
  v_mfma_f32_32x32x16_bf16 v[32:47], v[28:31], v[180:183], v[32:47]
  s_add_u32 s22, s48, 7168
  buffer_load_dwordx4 a[252:255], v2, s[8:11], s22 offen sc1
  v_accvgpr_write_b32 a198, v90
  v_accvgpr_write_b32 a199, v91
  v_mfma_f32_32x32x16_bf16 v[48:63], v[28:31], v[244:247], v[48:63]
  s_barrier
  v_xor_b32 v11, 131072, v11
  ds_read_b128 v[28:31], v11 offset:0
  s_waitcnt lgkmcnt(3)
  v_mfma_f32_32x32x16_bf16 v[64:79], v[16:19], v[120:123], 0
  v_mfma_f32_32x32x16_bf16 v[80:95], v[16:19], v[184:187], 0
  v_xor_b32 v12, 131072, v12
  ds_read_b128 v[16:19], v12 offset:0
  s_waitcnt lgkmcnt(3)
  v_mfma_f32_32x32x16_bf16 v[64:79], v[20:23], v[124:127], v[64:79]
  s_add_u32 s22, s48, 8192
  s_add_u32 m0, s25, 81920
  s_nop 0
  buffer_load_dwordx4 v2, s[8:11], s22 offen sc1 lds
  v_mul_f32 v32, s52, v32
  v_mul_f32 v33, s52, v33
  v_cvt_pk_bf16_f32 v32, v32, v33
  v_mfma_f32_32x32x16_bf16 v[80:95], v[20:23], v[188:191], v[80:95]
  v_mul_f32 v34, s52, v34
  v_mul_f32 v35, s52, v35
  v_xor_b32 v13, 131072, v13
  ds_read_b128 v[20:23], v13 offset:0
  s_waitcnt lgkmcnt(3)
  v_mfma_f32_32x32x16_bf16 v[64:79], v[24:27], v[128:131], v[64:79]
  v_cvt_pk_bf16_f32 v33, v34, v35
  v_mul_f32 v36, s52, v36
  v_mul_f32 v37, s52, v37
  v_mfma_f32_32x32x16_bf16 v[80:95], v[24:27], v[192:195], v[80:95]
  v_cvt_pk_bf16_f32 v34, v36, v37
  v_mul_f32 v38, s52, v38
  v_xor_b32 v14, 131072, v14
  ds_read_b128 v[24:27], v14 offset:0
  s_waitcnt lgkmcnt(3)
  v_mfma_f32_32x32x16_bf16 v[64:79], v[28:31], v[132:135], v[64:79]
  s_add_u32 s22, s48, 9216
  s_add_u32 m0, s25, 82944
  s_nop 0
  buffer_load_dwordx4 v2, s[8:11], s22 offen sc1 lds
  v_mul_f32 v39, s52, v39
  v_cvt_pk_bf16_f32 v35, v38, v39
  v_mul_f32 v40, s52, v40
  v_mfma_f32_32x32x16_bf16 v[80:95], v[28:31], v[196:199], v[80:95]
  v_mul_f32 v41, s52, v41
  v_cvt_pk_bf16_f32 v40, v40, v41
  v_xor_b32 v15, 131072, v15
  ds_read_b128 v[28:31], v15 offset:0
  s_waitcnt lgkmcnt(3)
  v_mfma_f32_32x32x16_bf16 v[64:79], v[16:19], v[136:139], v[64:79]
  buffer_load_dwordx4 v[100:103], v113, s[8:11], s28 offen sc1
  v_mul_f32 v42, s52, v42
  v_mul_f32 v43, s52, v43
  v_cvt_pk_bf16_f32 v41, v42, v43
  v_mfma_f32_32x32x16_bf16 v[80:95], v[16:19], v[200:203], v[80:95]
  v_mul_f32 v44, s52, v44
  v_mul_f32 v45, s52, v45
  ds_read_b128 v[16:19], v8 offset:256
  s_waitcnt lgkmcnt(3)
  v_mfma_f32_32x32x16_bf16 v[64:79], v[20:23], v[140:143], v[64:79]
  s_add_u32 s22, s48, 10240
  s_add_u32 m0, s25, 83968
  s_nop 0
  buffer_load_dwordx4 v2, s[8:11], s22 offen sc1 lds
  v_cvt_pk_bf16_f32 v42, v44, v45
  v_mul_f32 v46, s52, v46
  v_mul_f32 v47, s52, v47
  v_mfma_f32_32x32x16_bf16 v[80:95], v[20:23], v[204:207], v[80:95]
  v_cvt_pk_bf16_f32 v43, v46, v47
  v_permlane16_swap_b32 v32, v40
  ds_read_b128 v[20:23], v9 offset:256
  s_waitcnt lgkmcnt(3)
  v_mfma_f32_32x32x16_bf16 v[64:79], v[24:27], v[144:147], v[64:79]
  v_permlane16_swap_b32 v33, v41
  v_permlane16_swap_b32 v34, v42
  v_permlane16_swap_b32 v35, v43
  v_mfma_f32_32x32x16_bf16 v[80:95], v[24:27], v[208:211], v[80:95]
  v_accvgpr_write_b32 a32, v32
  v_accvgpr_write_b32 a33, v33
  ds_read_b128 v[24:27], v10 offset:256
  s_waitcnt lgkmcnt(3)
  v_mfma_f32_32x32x16_bf16 v[64:79], v[28:31], v[148:151], v[64:79]
  s_add_u32 s22, s48, 11264
  s_add_u32 m0, s25, 84992
  s_nop 0
  buffer_load_dwordx4 v2, s[8:11], s22 offen sc1 lds
  v_accvgpr_write_b32 a34, v34
  v_accvgpr_write_b32 a35, v35
  v_accvgpr_write_b32 a88, v40
  v_mfma_f32_32x32x16_bf16 v[80:95], v[28:31], v[212:215], v[80:95]
  v_accvgpr_write_b32 a89, v41
  v_accvgpr_write_b32 a90, v42
  ds_read_b128 v[28:31], v11 offset:256
  s_waitcnt lgkmcnt(3)
  v_mfma_f32_32x32x16_bf16 v[64:79], v[16:19], v[152:155], v[64:79]
  v_accvgpr_write_b32 a91, v43
  v_mul_f32 v48, s52, v48
  v_mul_f32 v49, s52, v49
  v_mfma_f32_32x32x16_bf16 v[80:95], v[16:19], v[216:219], v[80:95]
  v_cvt_pk_bf16_f32 v48, v48, v49
  v_mul_f32 v50, s52, v50
  ds_read_b128 v[16:19], v12 offset:256
  s_waitcnt lgkmcnt(3)
  v_mfma_f32_32x32x16_bf16 v[64:79], v[20:23], v[156:159], v[64:79]
  s_add_u32 s22, s48, 12288
  s_add_u32 m0, s25, 98304
  s_nop 0
  buffer_load_dwordx4 v2, s[8:11], s22 offen sc1 lds
  v_mul_f32 v51, s52, v51
  v_cvt_pk_bf16_f32 v49, v50, v51
  v_mul_f32 v52, s52, v52
  v_mfma_f32_32x32x16_bf16 v[80:95], v[20:23], v[220:223], v[80:95]
  v_mul_f32 v53, s52, v53
  v_cvt_pk_bf16_f32 v50, v52, v53
  ds_read_b128 v[20:23], v13 offset:256
  s_waitcnt lgkmcnt(3)
  v_mfma_f32_32x32x16_bf16 v[64:79], v[24:27], v[160:163], v[64:79]
  v_mul_f32 v54, s52, v54
  v_mul_f32 v55, s52, v55
  v_cvt_pk_bf16_f32 v51, v54, v55
  v_mfma_f32_32x32x16_bf16 v[80:95], v[24:27], v[224:227], v[80:95]
  v_mul_f32 v56, s52, v56
  v_mul_f32 v57, s52, v57
  ds_read_b128 v[24:27], v14 offset:256
  s_waitcnt lgkmcnt(3)
  v_mfma_f32_32x32x16_bf16 v[64:79], v[28:31], v[164:167], v[64:79]
  s_add_u32 s22, s48, 13312
  s_add_u32 m0, s25, 99328
  s_nop 0
  buffer_load_dwordx4 v2, s[8:11], s22 offen sc1 lds
  v_cvt_pk_bf16_f32 v56, v56, v57
  v_mul_f32 v58, s52, v58
  v_mul_f32 v59, s52, v59
  v_mfma_f32_32x32x16_bf16 v[80:95], v[28:31], v[228:231], v[80:95]
  v_cvt_pk_bf16_f32 v57, v58, v59
  v_mul_f32 v60, s52, v60
  ds_read_b128 v[28:31], v15 offset:256
  s_waitcnt lgkmcnt(3)
  v_mfma_f32_32x32x16_bf16 v[64:79], v[16:19], v[168:171], v[64:79]
  v_mul_f32 v61, s52, v61
  v_cvt_pk_bf16_f32 v58, v60, v61
  v_mul_f32 v62, s52, v62
  v_mfma_f32_32x32x16_bf16 v[80:95], v[16:19], v[232:235], v[80:95]
  v_mul_f32 v63, s52, v63
  v_cvt_pk_bf16_f32 v59, v62, v63
  ds_read_b128 v[16:19], v8 offset:16384
  s_waitcnt lgkmcnt(3)
  v_mfma_f32_32x32x16_bf16 v[64:79], v[20:23], v[172:175], v[64:79]
  v_permlane16_swap_b32 v48, v56
  v_permlane16_swap_b32 v49, v57
  v_permlane16_swap_b32 v50, v58
  v_mfma_f32_32x32x16_bf16 v[80:95], v[20:23], v[236:239], v[80:95]
  v_permlane16_swap_b32 v51, v59
  v_accvgpr_write_b32 a144, v48
  ds_read_b128 v[20:23], v9 offset:16384
  s_waitcnt lgkmcnt(3)
  v_mfma_f32_32x32x16_bf16 v[64:79], v[24:27], v[176:179], v[64:79]
  v_accvgpr_write_b32 a145, v49
  v_accvgpr_write_b32 a146, v50
  v_accvgpr_write_b32 a147, v51
  v_mfma_f32_32x32x16_bf16 v[80:95], v[24:27], v[240:243], v[80:95]
  v_accvgpr_write_b32 a200, v56
  v_accvgpr_write_b32 a201, v57
  ds_read_b128 v[24:27], v10 offset:16384
  s_waitcnt lgkmcnt(3)
  v_mfma_f32_32x32x16_bf16 v[64:79], v[28:31], v[180:183], v[64:79]
  v_accvgpr_write_b32 a202, v58
  v_accvgpr_write_b32 a203, v59
  v_mfma_f32_32x32x16_bf16 v[80:95], v[28:31], v[244:247], v[80:95]
  ds_read_b128 v[28:31], v11 offset:16384
  s_waitcnt lgkmcnt(3)
  v_mfma_f32_32x32x16_bf16 v[32:47], v[16:19], v[120:123], 0
  s_waitcnt vmcnt(4)
  v_cmp_ne_u64 vcc, s[88:89], v[100:101]
  v_cmp_ne_u64 s[54:55], s[88:89], v[102:103]
  s_add_u32 s49, s33, 14336
  v_mfma_f32_32x32x16_bf16 v[48:63], v[16:19], v[184:187], 0
  ds_read_b128 v[16:19], v12 offset:16384
  s_waitcnt lgkmcnt(3)
  v_mfma_f32_32x32x16_bf16 v[32:47], v[20:23], v[124:127], v[32:47]
  s_or_b64 vcc, vcc, s[54:55]
  s_cselect_b32 s49, 0x10000000, s49
  s_add_u32 s22, s49, 0
  s_add_u32 m0, s25, 100352
  s_nop 0
  buffer_load_dwordx4 v2, s[8:11], s22 offen sc1 lds
  v_mul_f32 v64, s52, v64
  v_mul_f32 v65, s52, v65
  v_cvt_pk_bf16_f32 v64, v64, v65
  v_mfma_f32_32x32x16_bf16 v[48:63], v[20:23], v[188:191], v[48:63]
  v_mul_f32 v66, s52, v66
  v_mul_f32 v67, s52, v67
  ds_read_b128 v[20:23], v13 offset:16384
  s_waitcnt lgkmcnt(3)
  v_mfma_f32_32x32x16_bf16 v[32:47], v[24:27], v[128:131], v[32:47]
  v_cvt_pk_bf16_f32 v65, v66, v67
  v_mul_f32 v68, s52, v68
  v_mul_f32 v69, s52, v69
  v_mfma_f32_32x32x16_bf16 v[48:63], v[24:27], v[192:195], v[48:63]
  v_cvt_pk_bf16_f32 v66, v68, v69
  v_mul_f32 v70, s52, v70
  ds_read_b128 v[24:27], v14 offset:16384
  s_waitcnt lgkmcnt(3)
  v_mfma_f32_32x32x16_bf16 v[32:47], v[28:31], v[132:135], v[32:47]
  s_add_u32 s22, s49, 1024
  s_add_u32 m0, s25, 101376
  s_nop 0
  buffer_load_dwordx4 v2, s[8:11], s22 offen sc1 lds
  v_mul_f32 v71, s52, v71
  v_cvt_pk_bf16_f32 v67, v70, v71
  v_mul_f32 v72, s52, v72
  v_mfma_f32_32x32x16_bf16 v[48:63], v[28:31], v[196:199], v[48:63]
  v_mul_f32 v73, s52, v73
  v_cvt_pk_bf16_f32 v72, v72, v73
  ds_read_b128 v[28:31], v15 offset:16384
  s_waitcnt lgkmcnt(3)
  v_mfma_f32_32x32x16_bf16 v[32:47], v[16:19], v[136:139], v[32:47]
  v_mul_f32 v74, s52, v74
  v_mul_f32 v75, s52, v75
  v_cvt_pk_bf16_f32 v73, v74, v75
  v_mfma_f32_32x32x16_bf16 v[48:63], v[16:19], v[200:203], v[48:63]
  v_mul_f32 v76, s52, v76
  v_mul_f32 v77, s52, v77
  ds_read_b128 v[16:19], v8 offset:16640
  s_waitcnt lgkmcnt(3)
  v_mfma_f32_32x32x16_bf16 v[32:47], v[20:23], v[140:143], v[32:47]
  s_add_u32 s22, s49, 2048
  s_add_u32 m0, s25, 147456
  s_nop 0
  buffer_load_dwordx4 v2, s[8:11], s22 offen sc1 lds
  v_cvt_pk_bf16_f32 v74, v76, v77
  v_mul_f32 v78, s52, v78
  v_mul_f32 v79, s52, v79
  v_mfma_f32_32x32x16_bf16 v[48:63], v[20:23], v[204:207], v[48:63]
  v_cvt_pk_bf16_f32 v75, v78, v79
  v_permlane16_swap_b32 v64, v72
  ds_read_b128 v[20:23], v9 offset:16640
  s_waitcnt lgkmcnt(3)
  v_mfma_f32_32x32x16_bf16 v[32:47], v[24:27], v[144:147], v[32:47]
  v_permlane16_swap_b32 v65, v73
  v_permlane16_swap_b32 v66, v74
  v_permlane16_swap_b32 v67, v75
  v_mfma_f32_32x32x16_bf16 v[48:63], v[24:27], v[208:211], v[48:63]
  v_accvgpr_write_b32 a36, v64
  v_accvgpr_write_b32 a37, v65
  ds_read_b128 v[24:27], v10 offset:16640
  s_waitcnt lgkmcnt(3)
  v_mfma_f32_32x32x16_bf16 v[32:47], v[28:31], v[148:151], v[32:47]
  s_add_u32 s22, s49, 3072
  s_add_u32 m0, s25, 148480
  s_nop 0
  buffer_load_dwordx4 v2, s[8:11], s22 offen sc1 lds
  v_accvgpr_write_b32 a38, v66
  v_accvgpr_write_b32 a39, v67
  v_accvgpr_write_b32 a92, v72
  v_mfma_f32_32x32x16_bf16 v[48:63], v[28:31], v[212:215], v[48:63]
  v_accvgpr_write_b32 a93, v73
  v_accvgpr_write_b32 a94, v74
  ds_read_b128 v[28:31], v11 offset:16640
  s_waitcnt lgkmcnt(3)
  v_mfma_f32_32x32x16_bf16 v[32:47], v[16:19], v[152:155], v[32:47]
  v_accvgpr_write_b32 a95, v75
  v_mul_f32 v80, s52, v80
  v_mul_f32 v81, s52, v81
  v_mfma_f32_32x32x16_bf16 v[48:63], v[16:19], v[216:219], v[48:63]
  v_cvt_pk_bf16_f32 v80, v80, v81
  v_mul_f32 v82, s52, v82
  ds_read_b128 v[16:19], v12 offset:16640
  s_waitcnt lgkmcnt(3)
  v_mfma_f32_32x32x16_bf16 v[32:47], v[20:23], v[156:159], v[32:47]
  s_add_u32 s22, s49, 4096
  s_add_u32 m0, s25, 149504
  s_nop 0
  buffer_load_dwordx4 v2, s[8:11], s22 offen sc1 lds
  v_mul_f32 v83, s52, v83
  v_cvt_pk_bf16_f32 v81, v82, v83
  v_mul_f32 v84, s52, v84
  v_mfma_f32_32x32x16_bf16 v[48:63], v[20:23], v[220:223], v[48:63]
  v_mul_f32 v85, s52, v85
  v_cvt_pk_bf16_f32 v82, v84, v85
  ds_read_b128 v[20:23], v13 offset:16640
  s_waitcnt lgkmcnt(3)
  v_mfma_f32_32x32x16_bf16 v[32:47], v[24:27], v[160:163], v[32:47]
  v_mul_f32 v86, s52, v86
  v_mul_f32 v87, s52, v87
  v_cvt_pk_bf16_f32 v83, v86, v87
  v_mfma_f32_32x32x16_bf16 v[48:63], v[24:27], v[224:227], v[48:63]
  v_mul_f32 v88, s52, v88
  v_mul_f32 v89, s52, v89
  ds_read_b128 v[24:27], v14 offset:16640
  s_waitcnt lgkmcnt(3)
  v_mfma_f32_32x32x16_bf16 v[32:47], v[28:31], v[164:167], v[32:47]
  s_add_u32 s22, s49, 5120
  s_add_u32 m0, s25, 150528
  s_nop 0
  buffer_load_dwordx4 v2, s[8:11], s22 offen sc1 lds
  v_cvt_pk_bf16_f32 v88, v88, v89
  v_mul_f32 v90, s52, v90
  v_mul_f32 v91, s52, v91
  v_mfma_f32_32x32x16_bf16 v[48:63], v[28:31], v[228:231], v[48:63]
  v_cvt_pk_bf16_f32 v89, v90, v91
  v_mul_f32 v92, s52, v92
  ds_read_b128 v[28:31], v15 offset:16640
  s_waitcnt lgkmcnt(3)
  v_mfma_f32_32x32x16_bf16 v[32:47], v[16:19], v[168:171], v[32:47]
  v_mul_f32 v93, s52, v93
  v_cvt_pk_bf16_f32 v90, v92, v93
  v_mul_f32 v94, s52, v94
  v_mfma_f32_32x32x16_bf16 v[48:63], v[16:19], v[232:235], v[48:63]
  v_mul_f32 v95, s52, v95
  v_cvt_pk_bf16_f32 v91, v94, v95
  ds_read_b128 v[16:19], v8 offset:32768
  s_waitcnt lgkmcnt(3)
  v_mfma_f32_32x32x16_bf16 v[32:47], v[20:23], v[172:175], v[32:47]
  s_add_u32 s22, s49, 6144
  s_add_u32 m0, s25, 114688
  s_nop 0
  buffer_load_dwordx4 v2, s[8:11], s22 offen sc1 lds
  v_permlane16_swap_b32 v80, v88
  v_permlane16_swap_b32 v81, v89
  v_permlane16_swap_b32 v82, v90
  v_mfma_f32_32x32x16_bf16 v[48:63], v[20:23], v[236:239], v[48:63]
  v_permlane16_swap_b32 v83, v91
  v_accvgpr_write_b32 a148, v80
  ds_read_b128 v[20:23], v9 offset:32768
  s_waitcnt lgkmcnt(3)
  v_mfma_f32_32x32x16_bf16 v[32:47], v[24:27], v[176:179], v[32:47]
  v_accvgpr_write_b32 a149, v81
  v_accvgpr_write_b32 a150, v82
  v_accvgpr_write_b32 a151, v83
  v_mfma_f32_32x32x16_bf16 v[48:63], v[24:27], v[240:243], v[48:63]
  v_accvgpr_write_b32 a204, v88
  v_accvgpr_write_b32 a205, v89
  ds_read_b128 v[24:27], v10 offset:32768
  s_waitcnt lgkmcnt(3)
  v_mfma_f32_32x32x16_bf16 v[32:47], v[28:31], v[180:183], v[32:47]
  s_add_u32 s22, s49, 7168
  s_add_u32 m0, s25, 115712
  s_nop 0
  buffer_load_dwordx4 v2, s[8:11], s22 offen sc1 lds
  v_accvgpr_write_b32 a206, v90
  v_accvgpr_write_b32 a207, v91
  v_mfma_f32_32x32x16_bf16 v[48:63], v[28:31], v[244:247], v[48:63]
  s_barrier
  ds_read_b128 v[28:31], v11 offset:32768
  s_waitcnt lgkmcnt(3)
  v_mfma_f32_32x32x16_bf16 v[64:79], v[16:19], v[120:123], 0
  v_mfma_f32_32x32x16_bf16 v[80:95], v[16:19], v[184:187], 0
  ds_read_b128 v[16:19], v12 offset:32768
  s_waitcnt lgkmcnt(3)
  v_mfma_f32_32x32x16_bf16 v[64:79], v[20:23], v[124:127], v[64:79]
  s_add_u32 s22, s49, 8192
  s_add_u32 m0, s25, 116736
  s_nop 0
  buffer_load_dwordx4 v2, s[8:11], s22 offen sc1 lds
  v_mul_f32 v32, s52, v32
  v_mul_f32 v33, s52, v33
  v_cvt_pk_bf16_f32 v32, v32, v33
  v_mfma_f32_32x32x16_bf16 v[80:95], v[20:23], v[188:191], v[80:95]
  v_mul_f32 v34, s52, v34
  v_mul_f32 v35, s52, v35
  ds_read_b128 v[20:23], v13 offset:32768
  s_waitcnt lgkmcnt(3)
  v_mfma_f32_32x32x16_bf16 v[64:79], v[24:27], v[128:131], v[64:79]
  v_cvt_pk_bf16_f32 v33, v34, v35
  v_mul_f32 v36, s52, v36
  v_mul_f32 v37, s52, v37
  v_mfma_f32_32x32x16_bf16 v[80:95], v[24:27], v[192:195], v[80:95]
  v_cvt_pk_bf16_f32 v34, v36, v37
  v_mul_f32 v38, s52, v38
  ds_read_b128 v[24:27], v14 offset:32768
  s_waitcnt lgkmcnt(3)
  v_mfma_f32_32x32x16_bf16 v[64:79], v[28:31], v[132:135], v[64:79]
  s_add_u32 s22, s49, 9216
  s_add_u32 m0, s25, 117760
  s_nop 0
  buffer_load_dwordx4 v2, s[8:11], s22 offen sc1 lds
  v_mul_f32 v39, s52, v39
  v_cvt_pk_bf16_f32 v35, v38, v39
  v_mul_f32 v40, s52, v40
  v_mfma_f32_32x32x16_bf16 v[80:95], v[28:31], v[196:199], v[80:95]
  v_mul_f32 v41, s52, v41
  v_cvt_pk_bf16_f32 v40, v40, v41
  ds_read_b128 v[28:31], v15 offset:32768
  s_waitcnt lgkmcnt(3)
  v_mfma_f32_32x32x16_bf16 v[64:79], v[16:19], v[136:139], v[64:79]
  buffer_load_dwordx4 v[100:103], v113, s[8:11], s28 offen sc1
  v_mul_f32 v42, s52, v42
  v_mul_f32 v43, s52, v43
  v_cvt_pk_bf16_f32 v41, v42, v43
  v_mfma_f32_32x32x16_bf16 v[80:95], v[16:19], v[200:203], v[80:95]
  v_mul_f32 v44, s52, v44
  v_mul_f32 v45, s52, v45
  ds_read_b128 v[16:19], v8 offset:33024
  s_waitcnt lgkmcnt(3)
  v_mfma_f32_32x32x16_bf16 v[64:79], v[20:23], v[140:143], v[64:79]
  s_add_u32 s22, s49, 10240
  s_add_u32 m0, s25, 131072
  s_nop 0
  buffer_load_dwordx4 v2, s[8:11], s22 offen sc1 lds
  v_cvt_pk_bf16_f32 v42, v44, v45
  v_mul_f32 v46, s52, v46
  v_mul_f32 v47, s52, v47
  v_mfma_f32_32x32x16_bf16 v[80:95], v[20:23], v[204:207], v[80:95]
  v_cvt_pk_bf16_f32 v43, v46, v47
  v_permlane16_swap_b32 v32, v40
  ds_read_b128 v[20:23], v9 offset:33024
  s_waitcnt lgkmcnt(3)
  v_mfma_f32_32x32x16_bf16 v[64:79], v[24:27], v[144:147], v[64:79]
  v_permlane16_swap_b32 v33, v41
  v_permlane16_swap_b32 v34, v42
  v_permlane16_swap_b32 v35, v43
  v_mfma_f32_32x32x16_bf16 v[80:95], v[24:27], v[208:211], v[80:95]
  v_accvgpr_write_b32 a40, v32
  v_accvgpr_write_b32 a41, v33
  ds_read_b128 v[24:27], v10 offset:33024
  s_waitcnt lgkmcnt(3)
  v_mfma_f32_32x32x16_bf16 v[64:79], v[28:31], v[148:151], v[64:79]
  s_add_u32 s22, s49, 11264
  s_add_u32 m0, s25, 132096
  s_nop 0
  buffer_load_dwordx4 v2, s[8:11], s22 offen sc1 lds
  v_accvgpr_write_b32 a42, v34
  v_accvgpr_write_b32 a43, v35
  v_accvgpr_write_b32 a96, v40
  v_mfma_f32_32x32x16_bf16 v[80:95], v[28:31], v[212:215], v[80:95]
  v_accvgpr_write_b32 a97, v41
  v_accvgpr_write_b32 a98, v42
  ds_read_b128 v[28:31], v11 offset:33024
  s_waitcnt lgkmcnt(3)
  v_mfma_f32_32x32x16_bf16 v[64:79], v[16:19], v[152:155], v[64:79]
  v_accvgpr_write_b32 a99, v43
  v_mul_f32 v48, s52, v48
  v_mul_f32 v49, s52, v49
  v_mfma_f32_32x32x16_bf16 v[80:95], v[16:19], v[216:219], v[80:95]
  v_cvt_pk_bf16_f32 v48, v48, v49
  v_mul_f32 v50, s52, v50
  ds_read_b128 v[16:19], v12 offset:33024
  s_waitcnt lgkmcnt(3)
  v_mfma_f32_32x32x16_bf16 v[64:79], v[20:23], v[156:159], v[64:79]
  s_add_u32 s22, s49, 12288
  s_add_u32 m0, s25, 133120
  s_nop 0
  buffer_load_dwordx4 v2, s[8:11], s22 offen sc1 lds
  v_mul_f32 v51, s52, v51
  v_cvt_pk_bf16_f32 v49, v50, v51
  v_mul_f32 v52, s52, v52
  v_mfma_f32_32x32x16_bf16 v[80:95], v[20:23], v[220:223], v[80:95]
  v_mul_f32 v53, s52, v53
  v_cvt_pk_bf16_f32 v50, v52, v53
  ds_read_b128 v[20:23], v13 offset:33024
  s_waitcnt lgkmcnt(3)
  v_mfma_f32_32x32x16_bf16 v[64:79], v[24:27], v[160:163], v[64:79]
  v_mul_f32 v54, s52, v54
  v_mul_f32 v55, s52, v55
  v_cvt_pk_bf16_f32 v51, v54, v55
  v_mfma_f32_32x32x16_bf16 v[80:95], v[24:27], v[224:227], v[80:95]
  v_mul_f32 v56, s52, v56
  v_mul_f32 v57, s52, v57
  ds_read_b128 v[24:27], v14 offset:33024
  s_waitcnt lgkmcnt(3)
  v_mfma_f32_32x32x16_bf16 v[64:79], v[28:31], v[164:167], v[64:79]
  s_add_u32 s22, s49, 13312
  s_add_u32 m0, s25, 134144
  s_nop 0
  buffer_load_dwordx4 v2, s[8:11], s22 offen sc1 lds
  v_cvt_pk_bf16_f32 v56, v56, v57
  v_mul_f32 v58, s52, v58
  v_mul_f32 v59, s52, v59
  v_mfma_f32_32x32x16_bf16 v[80:95], v[28:31], v[228:231], v[80:95]
  v_cvt_pk_bf16_f32 v57, v58, v59
  v_mul_f32 v60, s52, v60
  ds_read_b128 v[28:31], v15 offset:33024
  s_waitcnt lgkmcnt(3)
  v_mfma_f32_32x32x16_bf16 v[64:79], v[16:19], v[168:171], v[64:79]
  v_mul_f32 v61, s52, v61
  v_cvt_pk_bf16_f32 v58, v60, v61
  v_mul_f32 v62, s52, v62
  v_mfma_f32_32x32x16_bf16 v[80:95], v[16:19], v[232:235], v[80:95]
  v_mul_f32 v63, s52, v63
  v_cvt_pk_bf16_f32 v59, v62, v63
  ds_read_b128 v[16:19], v8 offset:49152
  s_waitcnt lgkmcnt(3)
  v_mfma_f32_32x32x16_bf16 v[64:79], v[20:23], v[172:175], v[64:79]
  v_permlane16_swap_b32 v48, v56
  v_permlane16_swap_b32 v49, v57
  v_permlane16_swap_b32 v50, v58
  v_mfma_f32_32x32x16_bf16 v[80:95], v[20:23], v[236:239], v[80:95]
  v_permlane16_swap_b32 v51, v59
  v_accvgpr_write_b32 a152, v48
  ds_read_b128 v[20:23], v9 offset:49152
  s_waitcnt lgkmcnt(3)
  v_mfma_f32_32x32x16_bf16 v[64:79], v[24:27], v[176:179], v[64:79]
  v_accvgpr_write_b32 a153, v49
  v_accvgpr_write_b32 a154, v50
  v_accvgpr_write_b32 a155, v51
  v_mfma_f32_32x32x16_bf16 v[80:95], v[24:27], v[240:243], v[80:95]
  v_accvgpr_write_b32 a208, v56
  v_accvgpr_write_b32 a209, v57
  ds_read_b128 v[24:27], v10 offset:49152
  s_waitcnt lgkmcnt(3)
  v_mfma_f32_32x32x16_bf16 v[64:79], v[28:31], v[180:183], v[64:79]
  v_accvgpr_write_b32 a210, v58
  v_accvgpr_write_b32 a211, v59
  v_mfma_f32_32x32x16_bf16 v[80:95], v[28:31], v[244:247], v[80:95]
  ds_read_b128 v[28:31], v11 offset:49152
  s_waitcnt lgkmcnt(3)
  v_mfma_f32_32x32x16_bf16 v[32:47], v[16:19], v[120:123], 0
  s_waitcnt vmcnt(4)
  v_cmp_ne_u64 vcc, s[88:89], v[100:101]
  v_cmp_ne_u64 s[54:55], s[88:89], v[102:103]
  s_add_u32 s50, s32, 0
  v_mfma_f32_32x32x16_bf16 v[48:63], v[16:19], v[184:187], 0
  ds_read_b128 v[16:19], v12 offset:49152
  s_waitcnt lgkmcnt(3)
  v_mfma_f32_32x32x16_bf16 v[32:47], v[20:23], v[124:127], v[32:47]
  s_or_b64 vcc, vcc, s[54:55]
  s_cselect_b32 s50, 0x10000000, s50
  s_add_u32 s22, s50, 12288
  buffer_load_dwordx4 v[248:251], v2, s[8:11], s22 offen sc1
  v_mul_f32 v64, s52, v64
  v_mul_f32 v65, s52, v65
  v_cvt_pk_bf16_f32 v64, v64, v65
  v_mfma_f32_32x32x16_bf16 v[48:63], v[20:23], v[188:191], v[48:63]
  v_mul_f32 v66, s52, v66
  v_mul_f32 v67, s52, v67
  ds_read_b128 v[20:23], v13 offset:49152
  s_waitcnt lgkmcnt(3)
  v_mfma_f32_32x32x16_bf16 v[32:47], v[24:27], v[128:131], v[32:47]
  s_add_u32 s22, s50, 13312
  buffer_load_dwordx4 v[252:255], v2, s[8:11], s22 offen sc1
  v_cvt_pk_bf16_f32 v65, v66, v67
  v_mul_f32 v68, s52, v68
  v_mul_f32 v69, s52, v69
  v_mfma_f32_32x32x16_bf16 v[48:63], v[24:27], v[192:195], v[48:63]
  v_cvt_pk_bf16_f32 v66, v68, v69
  v_mul_f32 v70, s52, v70
  ds_read_b128 v[24:27], v14 offset:49152
  s_waitcnt lgkmcnt(3)
  v_mfma_f32_32x32x16_bf16 v[32:47], v[28:31], v[132:135], v[32:47]
  s_add_u32 s22, s50, 0
  s_add_u32 m0, s25, 0
  s_nop 0
  buffer_load_dwordx4 v2, s[8:11], s22 offen sc1 lds
  v_mul_f32 v71, s52, v71
  v_cvt_pk_bf16_f32 v67, v70, v71
  v_mul_f32 v72, s52, v72
  v_mfma_f32_32x32x16_bf16 v[48:63], v[28:31], v[196:199], v[48:63]
  v_mul_f32 v73, s52, v73
  v_cvt_pk_bf16_f32 v72, v72, v73
  ds_read_b128 v[28:31], v15 offset:49152
  s_waitcnt lgkmcnt(3)
  v_mfma_f32_32x32x16_bf16 v[32:47], v[16:19], v[136:139], v[32:47]
  s_add_u32 s22, s50, 1024
  s_add_u32 m0, s25, 1024
  s_nop 0
  buffer_load_dwordx4 v2, s[8:11], s22 offen sc1 lds
  v_mul_f32 v74, s52, v74
  v_mul_f32 v75, s52, v75
  v_cvt_pk_bf16_f32 v73, v74, v75
  v_mfma_f32_32x32x16_bf16 v[48:63], v[16:19], v[200:203], v[48:63]
  v_mul_f32 v76, s52, v76
  v_mul_f32 v77, s52, v77
  ds_read_b128 v[16:19], v8 offset:49408
  s_waitcnt lgkmcnt(3)
  v_mfma_f32_32x32x16_bf16 v[32:47], v[20:23], v[140:143], v[32:47]
  s_add_u32 s22, s50, 2048
  s_add_u32 m0, s25, 2048
  s_nop 0
  buffer_load_dwordx4 v2, s[8:11], s22 offen sc1 lds
  v_cvt_pk_bf16_f32 v74, v76, v77
  v_mul_f32 v78, s52, v78
  v_mul_f32 v79, s52, v79
  v_mfma_f32_32x32x16_bf16 v[48:63], v[20:23], v[204:207], v[48:63]
  v_cvt_pk_bf16_f32 v75, v78, v79
  v_permlane16_swap_b32 v64, v72
  ds_read_b128 v[20:23], v9 offset:49408
  s_waitcnt lgkmcnt(3)
  v_mfma_f32_32x32x16_bf16 v[32:47], v[24:27], v[144:147], v[32:47]
  s_add_u32 s22, s50, 3072
  s_add_u32 m0, s25, 3072
  s_nop 0
  buffer_load_dwordx4 v2, s[8:11], s22 offen sc1 lds
  v_permlane16_swap_b32 v65, v73
  v_permlane16_swap_b32 v66, v74
  v_permlane16_swap_b32 v67, v75
  v_mfma_f32_32x32x16_bf16 v[48:63], v[24:27], v[208:211], v[48:63]
  v_accvgpr_write_b32 a44, v64
  v_accvgpr_write_b32 a45, v65
  ds_read_b128 v[24:27], v10 offset:49408
  s_waitcnt lgkmcnt(3)
  v_mfma_f32_32x32x16_bf16 v[32:47], v[28:31], v[148:151], v[32:47]
  s_add_u32 s22, s50, 4096
  s_add_u32 m0, s25, 16384
  s_nop 0
  buffer_load_dwordx4 v2, s[8:11], s22 offen sc1 lds
  v_accvgpr_write_b32 a46, v66
  v_accvgpr_write_b32 a47, v67
  v_accvgpr_write_b32 a100, v72
  v_mfma_f32_32x32x16_bf16 v[48:63], v[28:31], v[212:215], v[48:63]
  v_accvgpr_write_b32 a101, v73
  v_accvgpr_write_b32 a102, v74
  ds_read_b128 v[28:31], v11 offset:49408
  s_waitcnt lgkmcnt(3)
  v_mfma_f32_32x32x16_bf16 v[32:47], v[16:19], v[152:155], v[32:47]
  s_add_u32 s22, s50, 5120
  s_add_u32 m0, s25, 17408
  s_nop 0
  buffer_load_dwordx4 v2, s[8:11], s22 offen sc1 lds
  v_accvgpr_write_b32 a103, v75
  v_mul_f32 v80, s52, v80
  v_mul_f32 v81, s52, v81
  v_mfma_f32_32x32x16_bf16 v[48:63], v[16:19], v[216:219], v[48:63]
  v_cvt_pk_bf16_f32 v80, v80, v81
  v_mul_f32 v82, s52, v82
  ds_read_b128 v[16:19], v12 offset:49408
  s_waitcnt lgkmcnt(3)
  v_mfma_f32_32x32x16_bf16 v[32:47], v[20:23], v[156:159], v[32:47]
  s_add_u32 s22, s50, 6144
  s_add_u32 m0, s25, 18432
  s_nop 0
  buffer_load_dwordx4 v2, s[8:11], s22 offen sc1 lds
  v_mul_f32 v83, s52, v83
  v_cvt_pk_bf16_f32 v81, v82, v83
  v_mul_f32 v84, s52, v84
  v_mfma_f32_32x32x16_bf16 v[48:63], v[20:23], v[220:223], v[48:63]
  v_mul_f32 v85, s52, v85
  v_cvt_pk_bf16_f32 v82, v84, v85
  ds_read_b128 v[20:23], v13 offset:49408
  s_waitcnt lgkmcnt(3)
  v_mfma_f32_32x32x16_bf16 v[32:47], v[24:27], v[160:163], v[32:47]
  s_add_u32 s22, s50, 7168
  s_add_u32 m0, s25, 19456
  s_nop 0
  buffer_load_dwordx4 v2, s[8:11], s22 offen sc1 lds
  v_mul_f32 v86, s52, v86
  v_mul_f32 v87, s52, v87
  v_cvt_pk_bf16_f32 v83, v86, v87
  v_mfma_f32_32x32x16_bf16 v[48:63], v[24:27], v[224:227], v[48:63]
  v_mul_f32 v88, s52, v88
  v_mul_f32 v89, s52, v89
  ds_read_b128 v[24:27], v14 offset:49408
  s_waitcnt lgkmcnt(3)
  v_mfma_f32_32x32x16_bf16 v[32:47], v[28:31], v[164:167], v[32:47]
  v_cvt_pk_bf16_f32 v88, v88, v89
  v_mul_f32 v90, s52, v90
  v_mul_f32 v91, s52, v91
  v_mfma_f32_32x32x16_bf16 v[48:63], v[28:31], v[228:231], v[48:63]
  v_cvt_pk_bf16_f32 v89, v90, v91
  v_mul_f32 v92, s52, v92
  ds_read_b128 v[28:31], v15 offset:49408
  s_waitcnt lgkmcnt(3)
  v_mfma_f32_32x32x16_bf16 v[32:47], v[16:19], v[168:171], v[32:47]
  v_mul_f32 v93, s52, v93
  v_cvt_pk_bf16_f32 v90, v92, v93
  v_mul_f32 v94, s52, v94
  v_mfma_f32_32x32x16_bf16 v[48:63], v[16:19], v[232:235], v[48:63]
  v_mul_f32 v95, s52, v95
  v_cvt_pk_bf16_f32 v91, v94, v95
  v_xor_b32 v8, 65536, v8
  ds_read_b128 v[16:19], v8 offset:0
  s_waitcnt lgkmcnt(3)
  v_mfma_f32_32x32x16_bf16 v[32:47], v[20:23], v[172:175], v[32:47]
  v_permlane16_swap_b32 v80, v88
  v_permlane16_swap_b32 v81, v89
  v_permlane16_swap_b32 v82, v90
  v_mfma_f32_32x32x16_bf16 v[48:63], v[20:23], v[236:239], v[48:63]
  v_permlane16_swap_b32 v83, v91
  v_accvgpr_write_b32 a156, v80
  v_xor_b32 v9, 65536, v9
  ds_read_b128 v[20:23], v9 offset:0
  s_waitcnt lgkmcnt(3)
  v_mfma_f32_32x32x16_bf16 v[32:47], v[24:27], v[176:179], v[32:47]
  v_accvgpr_write_b32 a157, v81
  v_accvgpr_write_b32 a158, v82
  v_accvgpr_write_b32 a159, v83
  v_mfma_f32_32x32x16_bf16 v[48:63], v[24:27], v[240:243], v[48:63]
  v_accvgpr_write_b32 a212, v88
  v_accvgpr_write_b32 a213, v89
  v_xor_b32 v10, 65536, v10
  ds_read_b128 v[24:27], v10 offset:0
  s_waitcnt lgkmcnt(3)
  v_mfma_f32_32x32x16_bf16 v[32:47], v[28:31], v[180:183], v[32:47]
  v_accvgpr_write_b32 a214, v90
  v_accvgpr_write_b32 a215, v91
  v_mfma_f32_32x32x16_bf16 v[48:63], v[28:31], v[244:247], v[48:63]
  s_barrier
  v_xor_b32 v11, 65536, v11
  ds_read_b128 v[28:31], v11 offset:0
  s_waitcnt lgkmcnt(3)
  v_mfma_f32_32x32x16_bf16 v[64:79], v[16:19], v[120:123], 0
  s_add_u32 s22, s50, 8192
  s_add_u32 m0, s25, 32768
  s_nop 0
  buffer_load_dwordx4 v2, s[8:11], s22 offen sc1 lds
  v_mfma_f32_32x32x16_bf16 v[80:95], v[16:19], v[184:187], 0
  v_xor_b32 v12, 65536, v12
  ds_read_b128 v[16:19], v12 offset:0
  s_waitcnt lgkmcnt(3)
  v_mfma_f32_32x32x16_bf16 v[64:79], v[20:23], v[124:127], v[64:79]
  s_add_u32 s22, s50, 9216
  s_add_u32 m0, s25, 33792
  s_nop 0
  buffer_load_dwordx4 v2, s[8:11], s22 offen sc1 lds
  v_mul_f32 v32, s52, v32
  v_mul_f32 v33, s52, v33
  v_cvt_pk_bf16_f32 v32, v32, v33
  v_mfma_f32_32x32x16_bf16 v[80:95], v[20:23], v[188:191], v[80:95]
  v_mul_f32 v34, s52, v34
  v_mul_f32 v35, s52, v35
  v_xor_b32 v13, 65536, v13
  ds_read_b128 v[20:23], v13 offset:0
  s_waitcnt lgkmcnt(3)
  v_mfma_f32_32x32x16_bf16 v[64:79], v[24:27], v[128:131], v[64:79]
  s_add_u32 s22, s50, 10240
  s_add_u32 m0, s25, 34816
  s_nop 0
  buffer_load_dwordx4 v2, s[8:11], s22 offen sc1 lds
  v_cvt_pk_bf16_f32 v33, v34, v35
  v_mul_f32 v36, s52, v36
  v_mul_f32 v37, s52, v37
  v_mfma_f32_32x32x16_bf16 v[80:95], v[24:27], v[192:195], v[80:95]
  v_cvt_pk_bf16_f32 v34, v36, v37
  v_mul_f32 v38, s52, v38
  v_xor_b32 v14, 65536, v14
  ds_read_b128 v[24:27], v14 offset:0
  s_waitcnt lgkmcnt(3)
  v_mfma_f32_32x32x16_bf16 v[64:79], v[28:31], v[132:135], v[64:79]
  s_add_u32 s22, s50, 11264
  s_add_u32 m0, s25, 35840
  s_nop 0
  buffer_load_dwordx4 v2, s[8:11], s22 offen sc1 lds
  v_mul_f32 v39, s52, v39
  v_cvt_pk_bf16_f32 v35, v38, v39
  v_mul_f32 v40, s52, v40
  v_mfma_f32_32x32x16_bf16 v[80:95], v[28:31], v[196:199], v[80:95]
  v_mul_f32 v41, s52, v41
  v_cvt_pk_bf16_f32 v40, v40, v41
  v_xor_b32 v15, 65536, v15
  ds_read_b128 v[28:31], v15 offset:0
  s_waitcnt lgkmcnt(3)
  v_mfma_f32_32x32x16_bf16 v[64:79], v[16:19], v[136:139], v[64:79]
  buffer_load_dwordx4 v[100:103], v113, s[8:11], s28 offen sc1
  buffer_load_dwordx4 v[104:107], v2, s[8:11], s29 offen sc1
  buffer_load_dwordx4 v[108:111], v112, s[8:11], s29 offen sc1
  v_mul_f32 v42, s52, v42
  v_mul_f32 v43, s52, v43
  v_cvt_pk_bf16_f32 v41, v42, v43
  v_mfma_f32_32x32x16_bf16 v[80:95], v[16:19], v[200:203], v[80:95]
  v_mul_f32 v44, s52, v44
  v_mul_f32 v45, s52, v45
  ds_read_b128 v[16:19], v8 offset:256
  s_waitcnt lgkmcnt(3)
  v_mfma_f32_32x32x16_bf16 v[64:79], v[20:23], v[140:143], v[64:79]
  v_cvt_pk_bf16_f32 v42, v44, v45
  v_mul_f32 v46, s52, v46
  v_mul_f32 v47, s52, v47
  v_mfma_f32_32x32x16_bf16 v[80:95], v[20:23], v[204:207], v[80:95]
  v_cvt_pk_bf16_f32 v43, v46, v47
  v_permlane16_swap_b32 v32, v40
  ds_read_b128 v[20:23], v9 offset:256
  s_waitcnt lgkmcnt(3)
  v_mfma_f32_32x32x16_bf16 v[64:79], v[24:27], v[144:147], v[64:79]
  v_permlane16_swap_b32 v33, v41
  v_permlane16_swap_b32 v34, v42
  v_permlane16_swap_b32 v35, v43
  v_mfma_f32_32x32x16_bf16 v[80:95], v[24:27], v[208:211], v[80:95]
  v_accvgpr_write_b32 a48, v32
  v_accvgpr_write_b32 a49, v33
  ds_read_b128 v[24:27], v10 offset:256
  s_waitcnt lgkmcnt(3)
  v_mfma_f32_32x32x16_bf16 v[64:79], v[28:31], v[148:151], v[64:79]
  v_accvgpr_write_b32 a50, v34
  v_accvgpr_write_b32 a51, v35
  v_accvgpr_write_b32 a104, v40
  v_mfma_f32_32x32x16_bf16 v[80:95], v[28:31], v[212:215], v[80:95]
  v_accvgpr_write_b32 a105, v41
  v_accvgpr_write_b32 a106, v42
  ds_read_b128 v[28:31], v11 offset:256
  s_waitcnt lgkmcnt(3)
  v_mfma_f32_32x32x16_bf16 v[64:79], v[16:19], v[152:155], v[64:79]
  v_accvgpr_write_b32 a107, v43
  v_mul_f32 v48, s52, v48
  v_mul_f32 v49, s52, v49
  v_mfma_f32_32x32x16_bf16 v[80:95], v[16:19], v[216:219], v[80:95]
  v_cvt_pk_bf16_f32 v48, v48, v49
  v_mul_f32 v50, s52, v50
  ds_read_b128 v[16:19], v12 offset:256
  s_waitcnt lgkmcnt(3)
  v_mfma_f32_32x32x16_bf16 v[64:79], v[20:23], v[156:159], v[64:79]
  v_mul_f32 v51, s52, v51
  v_cvt_pk_bf16_f32 v49, v50, v51
  v_mul_f32 v52, s52, v52
  v_mfma_f32_32x32x16_bf16 v[80:95], v[20:23], v[220:223], v[80:95]
  v_mul_f32 v53, s52, v53
  v_cvt_pk_bf16_f32 v50, v52, v53
  ds_read_b128 v[20:23], v13 offset:256
  s_waitcnt lgkmcnt(3)
  v_mfma_f32_32x32x16_bf16 v[64:79], v[24:27], v[160:163], v[64:79]
  v_mul_f32 v54, s52, v54
  v_mul_f32 v55, s52, v55
  v_cvt_pk_bf16_f32 v51, v54, v55
  v_mfma_f32_32x32x16_bf16 v[80:95], v[24:27], v[224:227], v[80:95]
  v_mul_f32 v56, s52, v56
  v_mul_f32 v57, s52, v57
  ds_read_b128 v[24:27], v14 offset:256
  s_waitcnt lgkmcnt(3)
  v_mfma_f32_32x32x16_bf16 v[64:79], v[28:31], v[164:167], v[64:79]
  v_cvt_pk_bf16_f32 v56, v56, v57
  v_mul_f32 v58, s52, v58
  v_mul_f32 v59, s52, v59
  v_mfma_f32_32x32x16_bf16 v[80:95], v[28:31], v[228:231], v[80:95]
  v_cvt_pk_bf16_f32 v57, v58, v59
  v_mul_f32 v60, s52, v60
  ds_read_b128 v[28:31], v15 offset:256
  s_waitcnt lgkmcnt(3)
  v_mfma_f32_32x32x16_bf16 v[64:79], v[16:19], v[168:171], v[64:79]
  v_mul_f32 v61, s52, v61
  v_cvt_pk_bf16_f32 v58, v60, v61
  v_mul_f32 v62, s52, v62
  v_mfma_f32_32x32x16_bf16 v[80:95], v[16:19], v[232:235], v[80:95]
  v_mul_f32 v63, s52, v63
  v_cvt_pk_bf16_f32 v59, v62, v63
  s_waitcnt lgkmcnt(2)
  v_mfma_f32_32x32x16_bf16 v[64:79], v[20:23], v[172:175], v[64:79]
  v_permlane16_swap_b32 v48, v56
  v_permlane16_swap_b32 v49, v57
  v_permlane16_swap_b32 v50, v58
  v_mfma_f32_32x32x16_bf16 v[80:95], v[20:23], v[236:239], v[80:95]
  v_permlane16_swap_b32 v51, v59
  v_accvgpr_write_b32 a160, v48
  s_waitcnt lgkmcnt(1)
  v_mfma_f32_32x32x16_bf16 v[64:79], v[24:27], v[176:179], v[64:79]
  v_accvgpr_write_b32 a161, v49
  v_accvgpr_write_b32 a162, v50
  v_accvgpr_write_b32 a163, v51
  v_mfma_f32_32x32x16_bf16 v[80:95], v[24:27], v[240:243], v[80:95]
  v_accvgpr_write_b32 a216, v56
  v_accvgpr_write_b32 a217, v57
  s_waitcnt lgkmcnt(0)
  v_mfma_f32_32x32x16_bf16 v[64:79], v[28:31], v[180:183], v[64:79]
  v_accvgpr_write_b32 a218, v58
  v_accvgpr_write_b32 a219, v59
  v_mfma_f32_32x32x16_bf16 v[80:95], v[28:31], v[244:247], v[80:95]
  s_nop 4
  v_mul_f32 v64, s52, v64
  v_mul_f32 v65, s52, v65
  v_cvt_pk_bf16_f32 v64, v64, v65
  v_mul_f32 v66, s52, v66
  v_mul_f32 v67, s52, v67
  v_cvt_pk_bf16_f32 v65, v66, v67
  v_mul_f32 v68, s52, v68
  v_mul_f32 v69, s52, v69
  v_cvt_pk_bf16_f32 v66, v68, v69
  v_mul_f32 v70, s52, v70
  v_mul_f32 v71, s52, v71
  v_cvt_pk_bf16_f32 v67, v70, v71
  v_mul_f32 v72, s52, v72
  v_mul_f32 v73, s52, v73
  v_cvt_pk_bf16_f32 v72, v72, v73
  v_mul_f32 v74, s52, v74
  v_mul_f32 v75, s52, v75
  v_cvt_pk_bf16_f32 v73, v74, v75
  v_mul_f32 v76, s52, v76
  v_mul_f32 v77, s52, v77
  v_cvt_pk_bf16_f32 v74, v76, v77
  v_mul_f32 v78, s52, v78
  v_mul_f32 v79, s52, v79
  v_cvt_pk_bf16_f32 v75, v78, v79
  v_permlane16_swap_b32 v64, v72
  v_permlane16_swap_b32 v65, v73
  v_permlane16_swap_b32 v66, v74
  v_permlane16_swap_b32 v67, v75
  v_accvgpr_write_b32 a52, v64
  v_accvgpr_write_b32 a53, v65
  v_accvgpr_write_b32 a54, v66
  v_accvgpr_write_b32 a55, v67
  v_accvgpr_write_b32 a108, v72
  v_accvgpr_write_b32 a109, v73
  v_accvgpr_write_b32 a110, v74
  v_accvgpr_write_b32 a111, v75
  v_mul_f32 v80, s52, v80
  v_mul_f32 v81, s52, v81
  v_cvt_pk_bf16_f32 v80, v80, v81
  v_mul_f32 v82, s52, v82
  v_mul_f32 v83, s52, v83
  v_cvt_pk_bf16_f32 v81, v82, v83
  v_mul_f32 v84, s52, v84
  v_mul_f32 v85, s52, v85
  v_cvt_pk_bf16_f32 v82, v84, v85
  v_mul_f32 v86, s52, v86
  v_mul_f32 v87, s52, v87
  v_cvt_pk_bf16_f32 v83, v86, v87
  v_mul_f32 v88, s52, v88
  v_mul_f32 v89, s52, v89
  v_cvt_pk_bf16_f32 v88, v88, v89
  v_mul_f32 v90, s52, v90
  v_mul_f32 v91, s52, v91
  v_cvt_pk_bf16_f32 v89, v90, v91
  v_mul_f32 v92, s52, v92
  v_mul_f32 v93, s52, v93
  v_cvt_pk_bf16_f32 v90, v92, v93
  v_mul_f32 v94, s52, v94
  v_mul_f32 v95, s52, v95
  v_cvt_pk_bf16_f32 v91, v94, v95
  v_permlane16_swap_b32 v80, v88
  v_permlane16_swap_b32 v81, v89
  v_permlane16_swap_b32 v82, v90
  v_permlane16_swap_b32 v83, v91
  v_accvgpr_write_b32 a164, v80
  v_accvgpr_write_b32 a165, v81
  v_accvgpr_write_b32 a166, v82
  v_accvgpr_write_b32 a167, v83
  v_accvgpr_write_b32 a220, v88
  v_accvgpr_write_b32 a221, v89
  v_accvgpr_write_b32 a222, v90
  v_accvgpr_write_b32 a223, v91
  s_mov_b32 s30, 0
  s_branch sc_aw_w
sc_aw:
  buffer_load_dwordx4 v[100:103], v113, s[8:11], s28 offen sc1
  buffer_load_dwordx4 v[104:107], v2, s[8:11], s29 offen sc1
  buffer_load_dwordx4 v[108:111], v112, s[8:11], s29 offen sc1
sc_aw_w:
  s_waitcnt vmcnt(0)
  v_cmp_ne_u64 vcc, s[88:89], v[100:101]
  s_cbranch_vccnz sc_aw_no
  v_cmp_ne_u64 vcc, s[88:89], v[102:103]
  s_cbranch_vccnz sc_aw_no
  v_cmp_ne_u64 vcc, s[88:89], v[104:105]
  s_cbranch_vccnz sc_aw_no
  v_cmp_ne_u64 vcc, s[88:89], v[106:107]
  s_cbranch_vccnz sc_aw_no
  v_cmp_ne_u64 vcc, s[88:89], v[108:109]
  s_cbranch_vccnz sc_aw_no
  v_cmp_ne_u64 vcc, s[88:89], v[110:111]
  s_cbranch_vccnz sc_aw_no
  s_branch sc_aw_ok
sc_aw_no:
  s_sleep 1
  s_add_u32 s30, s30, 1
  s_cmp_lt_u32 s30, 50000
  s_cbranch_scc1 sc_aw
  s_branch cA_abort
sc_aw_ok:
  v_add_u32 v4, s25, v2
  v_add_u32 v5, 0x10000, v4
  v_add_u32 v6, 0x20000, v4
  s_cmp_eq_u32 s48, 0x10000000
  s_cbranch_scc1 sc_d0
  ds_read_b128 v[120:123], v5 offset:16384
  ds_read_b128 v[124:127], v5 offset:17408
  ds_read_b128 v[128:131], v5 offset:18432
  ds_read_b128 v[132:135], v5 offset:19456
  ds_read_b128 v[136:139], v5 offset:32768
  ds_read_b128 v[140:143], v5 offset:33792
  s_waitcnt lgkmcnt(0)
  s_branch sc_e0
sc_d0:
  s_add_u32 s22, s33, 0
  buffer_load_dwordx4 a[224:227], v2, s[8:11], s22 offen offset:0 sc1
  buffer_load_dwordx4 a[228:231], v2, s[8:11], s22 offen offset:1024 sc1
  buffer_load_dwordx4 a[232:235], v2, s[8:11], s22 offen offset:2048 sc1
  buffer_load_dwordx4 a[236:239], v2, s[8:11], s22 offen offset:3072 sc1
  s_add_u32 s22, s33, 4096
  buffer_load_dwordx4 a[240:243], v2, s[8:11], s22 offen offset:0 sc1
  buffer_load_dwordx4 a[244:247], v2, s[8:11], s22 offen offset:1024 sc1
  buffer_load_dwordx4 a[248:251], v2, s[8:11], s22 offen offset:2048 sc1
  buffer_load_dwordx4 a[252:255], v2, s[8:11], s22 offen offset:3072 sc1
  s_add_u32 s22, s33, 8192
  buffer_load_dwordx4 v[120:123], v2, s[8:11], s22 offen offset:0 sc1
  buffer_load_dwordx4 v[124:127], v2, s[8:11], s22 offen offset:1024 sc1
  buffer_load_dwordx4 v[128:131], v2, s[8:11], s22 offen offset:2048 sc1
  buffer_load_dwordx4 v[132:135], v2, s[8:11], s22 offen offset:3072 sc1
  s_add_u32 s22, s33, 12288
  buffer_load_dwordx4 v[136:139], v2, s[8:11], s22 offen offset:0 sc1
  buffer_load_dwordx4 v[140:143], v2, s[8:11], s22 offen offset:1024 sc1
sc_e0:
  s_cmp_eq_u32 s49, 0x10000000
  s_cbranch_scc1 sc_d1
  ds_read_b128 v[144:147], v5 offset:34816
  ds_read_b128 v[148:151], v5 offset:35840
  ds_read_b128 v[152:155], v6 offset:16384
  ds_read_b128 v[156:159], v6 offset:17408
  ds_read_b128 v[160:163], v6 offset:18432
  ds_read_b128 v[164:167], v6 offset:19456
  ds_read_b128 v[168:171], v5 offset:49152
  ds_read_b128 v[172:175], v5 offset:50176
  ds_read_b128 v[176:179], v5 offset:51200
  ds_read_b128 v[180:183], v5 offset:52224
  ds_read_b128 v[184:187], v6 offset:0
  ds_read_b128 v[188:191], v6 offset:1024
  ds_read_b128 v[192:195], v6 offset:2048
  ds_read_b128 v[196:199], v6 offset:3072
  s_waitcnt lgkmcnt(0)
  s_branch sc_e1
sc_d1:
  s_add_u32 s22, s33, 12288
  buffer_load_dwordx4 v[144:147], v2, s[8:11], s22 offen offset:2048 sc1
  buffer_load_dwordx4 v[148:151], v2, s[8:11], s22 offen offset:3072 sc1
  s_add_u32 s22, s33, 16384
  buffer_load_dwordx4 v[152:155], v2, s[8:11], s22 offen offset:0 sc1
  buffer_load_dwordx4 v[156:159], v2, s[8:11], s22 offen offset:1024 sc1
  buffer_load_dwordx4 v[160:163], v2, s[8:11], s22 offen offset:2048 sc1
  buffer_load_dwordx4 v[164:167], v2, s[8:11], s22 offen offset:3072 sc1
  s_add_u32 s22, s33, 20480
  buffer_load_dwordx4 v[168:171], v2, s[8:11], s22 offen offset:0 sc1
  buffer_load_dwordx4 v[172:175], v2, s[8:11], s22 offen offset:1024 sc1
  buffer_load_dwordx4 v[176:179], v2, s[8:11], s22 offen offset:2048 sc1
  buffer_load_dwordx4 v[180:183], v2, s[8:11], s22 offen offset:3072 sc1
  s_add_u32 s22, s33, 24576
  buffer_load_dwordx4 v[184:187], v2, s[8:11], s22 offen offset:0 sc1
  buffer_load_dwordx4 v[188:191], v2, s[8:11], s22 offen offset:1024 sc1
  buffer_load_dwordx4 v[192:195], v2, s[8:11], s22 offen offset:2048 sc1
  buffer_load_dwordx4 v[196:199], v2, s[8:11], s22 offen offset:3072 sc1
sc_e1:
  s_cmp_eq_u32 s50, 0x10000000
  s_cbranch_scc1 sc_d2
  ds_read_b128 v[200:203], v4 offset:0
  ds_read_b128 v[204:207], v4 offset:1024
  ds_read_b128 v[208:211], v4 offset:2048
  ds_read_b128 v[212:215], v4 offset:3072
  ds_read_b128 v[216:219], v4 offset:16384
  ds_read_b128 v[220:223], v4 offset:17408
  ds_read_b128 v[224:227], v4 offset:18432
  ds_read_b128 v[228:231], v4 offset:19456
  ds_read_b128 v[232:235], v4 offset:32768
  ds_read_b128 v[236:239], v4 offset:33792
  ds_read_b128 v[240:243], v4 offset:34816
  ds_read_b128 v[244:247], v4 offset:35840
  s_waitcnt lgkmcnt(0)
  s_branch sc_e2
sc_d2:
  s_add_u32 s22, s32, 0
  buffer_load_dwordx4 v[200:203], v2, s[8:11], s22 offen offset:0 sc1
  buffer_load_dwordx4 v[204:207], v2, s[8:11], s22 offen offset:1024 sc1
  buffer_load_dwordx4 v[208:211], v2, s[8:11], s22 offen offset:2048 sc1
  buffer_load_dwordx4 v[212:215], v2, s[8:11], s22 offen offset:3072 sc1
  s_add_u32 s22, s32, 4096
  buffer_load_dwordx4 v[216:219], v2, s[8:11], s22 offen offset:0 sc1
  buffer_load_dwordx4 v[220:223], v2, s[8:11], s22 offen offset:1024 sc1
  buffer_load_dwordx4 v[224:227], v2, s[8:11], s22 offen offset:2048 sc1
  buffer_load_dwordx4 v[228:231], v2, s[8:11], s22 offen offset:3072 sc1
  s_add_u32 s22, s32, 8192
  buffer_load_dwordx4 v[232:235], v2, s[8:11], s22 offen offset:0 sc1
  buffer_load_dwordx4 v[236:239], v2, s[8:11], s22 offen offset:1024 sc1
  buffer_load_dwordx4 v[240:243], v2, s[8:11], s22 offen offset:2048 sc1
  buffer_load_dwordx4 v[244:247], v2, s[8:11], s22 offen offset:3072 sc1
  s_add_u32 s22, s32, 12288
  buffer_load_dwordx4 v[248:251], v2, s[8:11], s22 offen offset:0 sc1
  buffer_load_dwordx4 v[252:255], v2, s[8:11], s22 offen offset:1024 sc1
sc_e2:
  s_barrier
  s_branch m_role
m_val:
  s_cmp_lg_u32 s16, 0
  s_cbranch_scc1 w0_6
  v_mov_b32 v233, 128
  v_mov_b32 v234, s88
  v_mov_b32 v235, s89
  v_mov_b32 v236, 0
  v_mov_b32 v237, 0
  s_mov_b64 exec, 1
  buffer_atomic_cmpswap_x2 v[234:237], v233, s[12:15], 0 offen sc0
  s_mov_b64 exec, -1
w0_6:
  s_cmp_lg_u32 s66, 0
  s_cbranch_scc1 va_ci
  s_cmp_lg_u32 s16, 0
  s_cbranch_scc1 w0_7
  s_lshr_b32 s70, s3, 5
  s_and_b32 s71, s70, 4
  s_mul_i32 s71, s71, 12
  s_lshl_b32 s70, s70, 2
  s_add_u32 s70, s70, s71
  s_lshl_b32 s71, 1, s3
  v_mov_b32 v242, s71
  v_mov_b32 v243, 32
  s_mov_b64 exec, 1
  buffer_atomic_or v242, v243, s[12:15], s70 offen sc0
  buffer_load_dwordx2 v[244:245], v243, s[12:15], 0 offen offset:96 sc1
  s_mov_b64 exec, -1
w0_7:
va_ci:
  s_mov_b32 s56, s40
  s_and_b32 s57, s41, 0xffff
  s_mov_b32 s58, 3670016
  s_mov_b32 s59, 0x20000
  v_lshrrev_b32 v24, 5, v1
  v_and_b32 v25, 31, v1
  v_lshlrev_b32 v25, 4, v25
  v_lshl_add_u32 v24, v24, 13, v25
  s_mov_b32 s60, s42
  s_and_b32 s61, s43, 0xffff
  s_mov_b32 s62, 3670016
  s_mov_b32 s63, 0x20000
  s_lshl_b32 s22, s17, 9
  s_lshl_b32 s23, s16, 19
  s_add_u32 s23, s22, s23
  s_add_u32 s21, s23, 262144
  buffer_load_dwordx4 v[28:31], v24, s[60:63], s21 offen
  s_add_u32 s21, s23, 278528
  buffer_load_dwordx4 v[28:31], v24, s[60:63], s21 offen
  s_add_u32 s21, s23, 294912
  buffer_load_dwordx4 v[28:31], v24, s[60:63], s21 offen
  s_add_u32 s21, s23, 311296
  buffer_load_dwordx4 v[28:31], v24, s[60:63], s21 offen
  s_add_u32 s21, s23, 327680
  buffer_load_dwordx4 v[28:31], v24, s[60:63], s21 offen
  s_add_u32 s21, s23, 344064
  buffer_load_dwordx4 v[28:31], v24, s[60:63], s21 offen
  s_add_u32 s21, s23, 360448
  buffer_load_dwordx4 v[28:31], v24, s[60:63], s21 offen
  s_add_u32 s21, s23, 376832
  buffer_load_dwordx4 v[28:31], v24, s[60:63], s21 offen
  s_add_u32 s21, s23, 393216
  buffer_load_dwordx4 v[28:31], v24, s[60:63], s21 offen
  s_add_u32 s21, s23, 409600
  buffer_load_dwordx4 v[28:31], v24, s[60:63], s21 offen
  s_add_u32 s21, s23, 425984
  buffer_load_dwordx4 v[28:31], v24, s[60:63], s21 offen
  s_add_u32 s21, s23, 442368
  buffer_load_dwordx4 v[28:31], v24, s[60:63], s21 offen
  s_add_u32 s21, s23, 458752
  buffer_load_dwordx4 v[28:31], v24, s[60:63], s21 offen
  s_add_u32 s21, s23, 475136
  buffer_load_dwordx4 v[28:31], v24, s[60:63], s21 offen
  s_add_u32 s21, s23, 491520
  buffer_load_dwordx4 v[28:31], v24, s[60:63], s21 offen
  s_add_u32 s21, s23, 507904
  buffer_load_dwordx4 v[28:31], v24, s[60:63], s21 offen
  s_lshl_b32 s23, s16, 14
  s_add_u32 s22, s22, s23
  s_mov_b32 s30, 0
va_pf:
  buffer_load_dwordx4 v[28:31], v24, s[56:59], s22 offen
  s_waitcnt vmcnt(40)
  s_add_u32 s22, s22, 65536
  s_add_u32 s30, s30, 1
  s_cmp_lt_u32 s30, 56
  s_cbranch_scc1 va_pf
  s_cmp_lg_u32 s66, 0
  s_cbranch_scc1 va_cf
  s_cmp_lg_u32 s16, 0
  s_cbranch_scc1 w0_8
  s_waitcnt vmcnt(40)
  v_readfirstlane_b32 s70, v244
  s_cmp_lg_u32 s70, 0
  s_cbranch_scc1 va_nz
  v_mov_b32 v243, 128
  v_mov_b32 v244, s88
  v_mov_b32 v245, s89
  v_mov_b32 v246, 0
  v_mov_b32 v247, 0
  s_mov_b64 exec, 1
  buffer_atomic_cmpswap_x2 v[244:247], v243, s[12:15], 0 offen sc0
  s_mov_b64 exec, -1
  s_waitcnt vmcnt(0)
  v_readfirstlane_b32 s70, v244
  s_cmp_lg_u32 s70, 0
  s_cbranch_scc1 va_nz
  v_mov_b32 v244, s88
  v_mov_b32 v245, s89
va_nz:
w0_8:
  v_mov_b32 v243, 160000
  s_add_u32 s101, s101, 1
  s_barrier
  s_mov_b64 exec, 1
  s_cmp_lg_u32 s16, 0
  s_cbranch_scc1 w0_9
  ds_write_b32 v243, v242 offset:0
  ds_write_b32 v243, v244 offset:4
  ds_write_b32 v243, v245 offset:8
  s_waitcnt lgkmcnt(0)
  v_mov_b32 v242, s101
  ds_write_b32 v243, v242 offset:16
  s_waitcnt lgkmcnt(0)
w0_9:
  s_mov_b64 exec, -1
  s_barrier
  ds_read_b32 v242, v243 offset:0
  ds_read_b32 v244, v243 offset:4
  ds_read_b32 v245, v243 offset:8
  ds_read_b32 v243, v243 offset:16
  s_waitcnt lgkmcnt(0)
  v_readfirstlane_b32 s70, v242
  v_readfirstlane_b32 s88, v244
  v_readfirstlane_b32 s89, v245
  v_cmp_ne_u32 vcc, s101, v243
  s_cbranch_vccnz ch_end
  s_mov_b32 s66, 1
  s_bitcmp1_b32 s70, s3
  s_cbranch_scc1 m_reclaim
va_cf:
  s_cmp_lg_u32 s16, 0
  s_cbranch_scc1 w0_10
  s_cmp_eq_u32 s67, 0
  s_cselect_b32 s20, 1, 0x10001
  v_mov_b32 v242, s20
  v_mov_b32 v243, 0
  s_mov_b64 exec, 1
  buffer_atomic_add v242, v243, s[12:15], 0 offen
  s_mov_b64 exec, -1
w0_10:
m_role:
  s_mov_b32 s17, s3
  v_and_b32 v1, 63, v0
  v_lshlrev_b32 v2, 4, v1
  v_lshrrev_b32 v116, 4, v1
  v_and_b32 v117, 15, v1
  v_mov_b32 v3, 0x4444
  v_mov_b32 v118, 0xeeee
  v_cmp_lt_u32 vcc, 7, v117
  s_nop 1
  v_cndmask_b32 v3, v3, v118, vcc
  s_mov_b32 s19, 0
  s_mov_b32 s20, 88653824
  s_lshr_b32 s22, s17, 4
  s_lshl_b32 s22, s22, 2
  s_add_u32 s22, s22, s16
  s_and_b32 s17, s17, 15
  s_cmp_eq_u32 s22, 0
  s_cbranch_scc1 ch_init0
  s_cmp_eq_u32 s22, 1
  s_cbranch_scc1 ch_init1
  s_cmp_eq_u32 s22, 2
  s_cbranch_scc1 ch_init2
  s_cmp_eq_u32 s22, 3
  s_cbranch_scc1 ch_init3
  s_cmp_eq_u32 s22, 4
  s_cbranch_scc1 ch_init4
  s_cmp_eq_u32 s22, 5
  s_cbranch_scc1 ch_init5
  s_cmp_eq_u32 s22, 6
  s_cbranch_scc1 ch_init6
  s_cmp_eq_u32 s22, 7
  s_cbranch_scc1 ch_init7
  s_branch ch_end
ch_init0:
  s_mul_i32 s31, s17, 401408
  s_add_u32 s31, s31, 0
  s_mov_b32 s24, 71565312
  s_mov_b32 s25, 0
  s_add_u32 m0, s25, 0
  s_nop 0
  buffer_load_dwordx4 v2, s[8:11], s24 offen offset:0 sc1 lds
  buffer_load_dwordx4 v2, s[8:11], s24 offen offset:1024 sc1 lds
  buffer_load_dwordx4 v2, s[8:11], s24 offen offset:2048 sc1 lds
  buffer_load_dwordx4 v2, s[8:11], s24 offen offset:3072 sc1 lds
  s_add_u32 m0, s25, 4096
  s_add_u32 s22, s24, 4096
  buffer_load_dwordx4 v2, s[8:11], s22 offen offset:0 sc1 lds
  buffer_load_dwordx4 v2, s[8:11], s22 offen offset:1024 sc1 lds
  buffer_load_dwordx4 v2, s[8:11], s22 offen offset:2048 sc1 lds
  v_lshrrev_b32 v64, 1, v117
  v_and_b32 v65, 1, v116
  v_lshlrev_b32 v65, 2, v65
  v_sub_u32 v64, v64, v65
  v_and_b32 v65, 1, v117
  v_lshl_add_u32 v66, v65, 2, v64
  v_cmp_gt_u32 vcc, 4, v64
  v_mov_b32 v67, 99
  s_nop 0
  v_cndmask_b32 v66, v67, v66, vcc
  v_mov_b32 v68, 0x3f80
  v_mov_b32 v69, 0x3f800000
  v_mov_b32 v4, 0
  v_cmp_eq_u32 vcc, 0, v66
  s_nop 1
  v_cndmask_b32 v4, v4, v68, vcc
  v_cmp_eq_u32 vcc, 1, v66
  s_nop 1
  v_cndmask_b32 v4, v4, v69, vcc
  v_mov_b32 v5, 0
  v_cmp_eq_u32 vcc, 2, v66
  s_nop 1
  v_cndmask_b32 v5, v5, v68, vcc
  v_cmp_eq_u32 vcc, 3, v66
  s_nop 1
  v_cndmask_b32 v5, v5, v69, vcc
  v_mov_b32 v6, 0
  v_cmp_eq_u32 vcc, 4, v66
  s_nop 1
  v_cndmask_b32 v6, v6, v68, vcc
  v_cmp_eq_u32 vcc, 5, v66
  s_nop 1
  v_cndmask_b32 v6, v6, v69, vcc
  v_mov_b32 v7, 0
  v_cmp_eq_u32 vcc, 6, v66
  s_nop 1
  v_cndmask_b32 v7, v7, v68, vcc
  v_cmp_eq_u32 vcc, 7, v66
  s_nop 1
  v_cndmask_b32 v7, v7, v69, vcc
  v_lshrrev_b32 v64, 1, v116
  v_lshrrev_b32 v65, 3, v117
  v_cmp_eq_u32 s[26:27], v64, v65
  v_and_b32 v66, 1, v116
  v_add_u32 v64, 0, v64
  v_lshrrev_b32 v67, 1, v116
  v_lshlrev_b32 v67, 8, v67
  v_lshl_add_u32 v67, v66, 9, v67
  v_lshl_add_u32 v67, v117, 4, v67
  v_add_u32 v112, 57344, v67
  v_and_b32 v68, 7, v117
  v_lshlrev_b32 v67, 8, v64
  v_lshl_add_u32 v67, v68, 5, v67
  v_lshl_add_u32 v67, v66, 4, v67
  v_add_u32 v113, 65536, v67
  v_lshrrev_b32 v64, 5, v1
  v_and_b32 v65, 31, v1
  v_lshrrev_b32 v66, 3, v65
  v_and_b32 v67, 7, v65
  v_and_b32 v68, 3, v67
  v_lshl_add_u32 v68, v66, 2, v68
  v_lshrrev_b32 v69, 2, v67
  v_lshl_add_u32 v68, v69, 4, v68
  v_lshlrev_b32 v69, 11, v64
  v_lshl_add_u32 v69, v68, 4, v69
  v_add_u32 v114, 57344, v69
  v_add_u32 v70, 0, v64
  v_lshlrev_b32 v69, 9, v66
  v_lshl_add_u32 v69, v70, 5, v69
  v_lshl_add_u32 v69, v67, 2, v69
  v_add_u32 v115, 65536, v69
  v_lshlrev_b32 v69, 4, v68
  v_lshl_add_u32 v69, v64, 9, v69
  v_add_u32 v114, 57344, v69
  v_mul_u32_u24 v69, 144, v70
  v_lshl_add_u32 v69, v67, 4, v69
  v_add_u32 v115, 65536, v69
  v_and_b32 v71, 1, v116
  v_mul_u32_u24 v69, 2048, v71
  v_lshl_add_u32 v69, v64, 8, v69
  v_lshl_add_u32 v69, v117, 4, v69
  v_add_u32 v112, 57344, v69
  v_mul_u32_u24 v69, 144, v117
  v_lshl_add_u32 v69, v71, 6, v69
  v_lshl_add_u32 v69, v64, 5, v69
  v_add_u32 v113, 65536, v69
  v_mul_u32_u24 v69, 1024, v116
  v_lshl_add_u32 v69, v117, 4, v69
  v_and_b32 v72, 8, v117
  v_xor_b32 v72, 0, v72
  v_add_u32 v69, v69, v72
  v_add_u32 v112, 57344, v69
  v_lshrrev_b32 v72, 3, v117
  v_lshl_add_u32 v72, v71, 1, v72
  v_xor_b32 v72, 0, v72
  v_lshlrev_b32 v69, 10, v116
  v_lshl_add_u32 v69, v117, 4, v69
  v_lshl_add_u32 v69, v72, 2, v69
  v_add_u32 v112, 57344, v69
  v_lshrrev_b32 v69, 1, v117
  v_and_b32 v72, 1, v117
  v_lshl_add_u32 v69, v72, 3, v69
  v_mul_u32_u24 v69, 144, v69
  v_lshl_add_u32 v69, v71, 6, v69
  v_lshl_add_u32 v69, v64, 5, v69
  v_lshl_add_u32 v72, v72, 1, v71
  v_xor_b32 v72, 0, v72
  v_lshl_add_u32 v69, v72, 2, v69
  v_add_u32 v113, 65536, v69
  v_and_b32 v71, 1, v1
  v_cmp_eq_u32 s[38:39], 0, v71
  v_cmp_gt_u32 vcc, 8, v65
  s_or_b64 s[28:29], s[38:39], vcc
  v_lshrrev_b32 v72, 1, v67
  v_lshlrev_b32 v72, 2, v72
  v_lshl_add_u32 v72, v70, 4, v72
  s_lshl_b32 s22, s17, 9
  s_add_u32 s22, s22, 9216
  v_lshl_add_u32 v73, v66, 7, v72
  v_add_u32 v73, s22, v73
  s_lshl_b32 s22, s17, 7
  s_add_u32 s22, s22, 7168
  v_add_u32 v74, s22, v72
  v_bfe_u32 v72, v65, 1, 1
  v_lshlrev_b32 v72, 7, v72
  v_lshl_add_u32 v72, v70, 4, v72
  v_bfe_u32 v73, v65, 2, 2
  v_lshl_add_u32 v72, v73, 2, v72
  v_lshrrev_b32 v73, 4, v65
  v_lshl_add_u32 v73, v73, 8, v72
  s_lshl_b32 s22, s17, 9
  s_add_u32 s22, s22, 9216
  v_add_u32 v73, s22, v73
  s_lshr_b32 s22, s17, 1
  s_lshl_b32 s22, s22, 8
  s_and_b32 s34, s17, 1
  s_lshl_b32 s34, s34, 3
  s_add_u32 s22, s22, s34
  s_add_u32 s22, s22, 7168
  v_add_u32 v74, s22, v72
  v_bfe_u32 v72, v65, 1, 1
  v_lshl_add_u32 v72, v64, 1, v72
  v_lshlrev_b32 v72, 4, v72
  v_bfe_u32 v73, v65, 2, 2
  v_lshl_add_u32 v72, v73, 2, v72
  v_lshrrev_b32 v73, 4, v65
  v_lshl_add_u32 v73, v73, 6, v72
  s_lshl_b32 s22, s17, 9
  s_add_u32 s22, s22, 9216
  v_add_u32 v73, s22, v73
  v_lshrrev_b32 v72, 1, v65
  v_lshlrev_b32 v72, 2, v72
  v_lshl_add_u32 v72, v64, 5, v72
  s_lshr_b32 s22, s17, 1
  s_lshl_b32 s22, s22, 8
  s_and_b32 s34, s17, 1
  s_lshl_b32 s34, s34, 4
  s_add_u32 s22, s22, s34
  s_add_u32 s22, s22, 7168
  v_add_u32 v74, s22, v72
  v_lshlrev_b32 v0, 2, v65
  v_and_b32 v0, 120, v0
  s_and_b32 s22, s17, 15
  s_lshl_b32 s22, s22, 7
  s_add_u32 s22, s22, 18432
  v_add_u32 v0, s22, v0
  v_cndmask_b32 v1, v74, v73, s[38:39]
  s_lshl_b32 s36, s17, 2
  s_add_u32 s36, s36, 17472
  s_mov_b32 s37, 0x3e800000
  v_mov_b32 v64, 0
  v_mov_b32 v65, 0
  v_mov_b32 v66, 0
  v_mov_b32 v67, 0
  v_mov_b32 v68, 0
  v_mov_b32 v69, 0
  v_mov_b32 v70, 0
  v_mov_b32 v71, 0
  v_mov_b32 v72, 0
  v_mov_b32 v73, 0
  v_mov_b32 v74, 0
  v_mov_b32 v75, 0
  v_mov_b32 v76, 0
  v_mov_b32 v77, 0
  v_mov_b32 v78, 0
  v_mov_b32 v79, 0
  v_mov_b32 v80, 0
  v_mov_b32 v81, 0
  v_mov_b32 v82, 0
  v_mov_b32 v83, 0
  v_mov_b32 v84, 0
  v_mov_b32 v85, 0
  v_mov_b32 v86, 0
  v_mov_b32 v87, 0
  v_mov_b32 v88, 0
  v_mov_b32 v89, 0
  v_mov_b32 v90, 0
  v_mov_b32 v91, 0
  v_mov_b32 v92, 0
  v_mov_b32 v93, 0
  v_mov_b32 v94, 0
  v_mov_b32 v95, 0
  v_mov_b32 v96, 0
  v_mov_b32 v97, 0
  v_mov_b32 v98, 0
  v_mov_b32 v99, 0
  v_mov_b32 v100, 0
  v_mov_b32 v101, 0
  v_mov_b32 v102, 0
  v_mov_b32 v103, 0
  v_mov_b32 v104, 0
  v_mov_b32 v105, 0
  v_mov_b32 v106, 0
  v_mov_b32 v107, 0
  v_mov_b32 v108, 0
  v_mov_b32 v109, 0
  v_mov_b32 v110, 0
  v_mov_b32 v111, 0
  v_and_b32 v118, 1, v116
  v_cmp_eq_u32 vcc, 0, v118
  v_mov_b32 v118, 12288
  v_mov_b32 v119, 8192
  v_cndmask_b32 v118, v118, v119, vcc
  v_lshrrev_b32 v116, 1, v116
  v_lshl_add_u32 v118, v116, 9, v118
  v_lshl_add_u32 v117, v117, 4, v118
  s_mov_b32 s57, 28672
  v_bfe_u32 v118, v2, 4, 1
  v_mul_u32_u24 v118, 0xaaaa, v118
  v_add_u32 v118, 0x4444, v118
  s_mov_b32 s56, 0x42800000
  v_mov_b32 v116, v2
  s_mul_i32 s35, s17, 1835008
  s_add_u32 s35, s35, 42262528
  s_mov_b32 s30, 0
  v_mov_b32 v36, 0
ch_md0:
  buffer_load_dword v37, v36, s[12:15], 0 offen sc1
  s_waitcnt vmcnt(0)
  v_readfirstlane_b32 s22, v37
  s_and_b32 s31, s22, 0xffff
  s_cmp_ge_u32 s31, 32
  s_cbranch_scc1 ch_go0
  s_sleep 2
  s_add_u32 s30, s30, 1
  s_cmp_lt_u32 s30, 50000
  s_cbranch_scc1 ch_md0
  s_branch ch_end
ch_go0:
  s_mov_b32 s31, 0
  s_lshr_b32 s22, s22, 16
  s_cmp_lg_u32 s22, 0
  s_cbranch_scc1 cB_sc0_loop
  s_branch cA_sc0_loop
ch_init1:
  s_mul_i32 s31, s17, 401408
  s_add_u32 s31, s31, 0
  s_mov_b32 s24, 71572480
  s_mov_b32 s25, 0
  s_add_u32 m0, s25, 7168
  s_nop 0
  buffer_load_dwordx4 v2, s[8:11], s24 offen offset:0 sc1 lds
  buffer_load_dwordx4 v2, s[8:11], s24 offen offset:1024 sc1 lds
  buffer_load_dwordx4 v2, s[8:11], s24 offen offset:2048 sc1 lds
  buffer_load_dwordx4 v2, s[8:11], s24 offen offset:3072 sc1 lds
  s_add_u32 m0, s25, 11264
  s_add_u32 s22, s24, 4096
  buffer_load_dwordx4 v2, s[8:11], s22 offen offset:0 sc1 lds
  buffer_load_dwordx4 v2, s[8:11], s22 offen offset:1024 sc1 lds
  buffer_load_dwordx4 v2, s[8:11], s22 offen offset:2048 sc1 lds
  v_lshrrev_b32 v64, 1, v117
  v_and_b32 v65, 1, v116
  v_lshlrev_b32 v65, 2, v65
  v_sub_u32 v64, v64, v65
  v_and_b32 v65, 1, v117
  v_lshl_add_u32 v66, v65, 2, v64
  v_cmp_gt_u32 vcc, 4, v64
  v_mov_b32 v67, 99
  s_nop 0
  v_cndmask_b32 v66, v67, v66, vcc
  v_mov_b32 v68, 0x3f80
  v_mov_b32 v69, 0x3f800000
  v_mov_b32 v4, 0
  v_cmp_eq_u32 vcc, 0, v66
  s_nop 1
  v_cndmask_b32 v4, v4, v68, vcc
  v_cmp_eq_u32 vcc, 1, v66
  s_nop 1
  v_cndmask_b32 v4, v4, v69, vcc
  v_mov_b32 v5, 0
  v_cmp_eq_u32 vcc, 2, v66
  s_nop 1
  v_cndmask_b32 v5, v5, v68, vcc
  v_cmp_eq_u32 vcc, 3, v66
  s_nop 1
  v_cndmask_b32 v5, v5, v69, vcc
  v_mov_b32 v6, 0
  v_cmp_eq_u32 vcc, 4, v66
  s_nop 1
  v_cndmask_b32 v6, v6, v68, vcc
  v_cmp_eq_u32 vcc, 5, v66
  s_nop 1
  v_cndmask_b32 v6, v6, v69, vcc
  v_mov_b32 v7, 0
  v_cmp_eq_u32 vcc, 6, v66
  s_nop 1
  v_cndmask_b32 v7, v7, v68, vcc
  v_cmp_eq_u32 vcc, 7, v66
  s_nop 1
  v_cndmask_b32 v7, v7, v69, vcc
  v_lshrrev_b32 v64, 1, v116
  v_lshrrev_b32 v65, 3, v117
  v_cmp_eq_u32 s[26:27], v64, v65
  v_and_b32 v66, 1, v116
  v_add_u32 v64, 2, v64
  v_lshrrev_b32 v67, 1, v116
  v_lshlrev_b32 v67, 8, v67
  v_lshl_add_u32 v67, v66, 9, v67
  v_lshl_add_u32 v67, v117, 4, v67
  v_add_u32 v112, 58368, v67
  v_and_b32 v68, 7, v117
  v_lshlrev_b32 v67, 8, v64
  v_lshl_add_u32 v67, v68, 5, v67
  v_lshl_add_u32 v67, v66, 4, v67
  v_add_u32 v113, 65536, v67
  v_lshrrev_b32 v64, 5, v1
  v_and_b32 v65, 31, v1
  v_lshrrev_b32 v66, 3, v65
  v_and_b32 v67, 7, v65
  v_and_b32 v68, 3, v67
  v_lshl_add_u32 v68, v66, 2, v68
  v_lshrrev_b32 v69, 2, v67
  v_lshl_add_u32 v68, v69, 4, v68
  v_lshlrev_b32 v69, 11, v64
  v_lshl_add_u32 v69, v68, 4, v69
  v_add_u32 v114, 57352, v69
  v_add_u32 v70, 2, v64
  v_lshlrev_b32 v69, 9, v66
  v_lshl_add_u32 v69, v70, 5, v69
  v_lshl_add_u32 v69, v67, 2, v69
  v_add_u32 v115, 65536, v69
  v_lshlrev_b32 v69, 4, v68
  v_lshl_add_u32 v69, v64, 9, v69
  v_add_u32 v114, 58368, v69
  v_mul_u32_u24 v69, 144, v70
  v_lshl_add_u32 v69, v67, 4, v69
  v_add_u32 v115, 65536, v69
  v_and_b32 v71, 1, v116
  v_mul_u32_u24 v69, 2048, v71
  v_lshl_add_u32 v69, v64, 8, v69
  v_lshl_add_u32 v69, v117, 4, v69
  v_add_u32 v112, 57352, v69
  v_mul_u32_u24 v69, 144, v117
  v_lshl_add_u32 v69, v71, 6, v69
  v_lshl_add_u32 v69, v64, 5, v69
  v_add_u32 v113, 65540, v69
  v_mul_u32_u24 v69, 1024, v116
  v_lshl_add_u32 v69, v117, 4, v69
  v_and_b32 v72, 8, v117
  v_xor_b32 v72, 8, v72
  v_add_u32 v69, v69, v72
  v_add_u32 v112, 57344, v69
  v_lshrrev_b32 v72, 3, v117
  v_lshl_add_u32 v72, v71, 1, v72
  v_xor_b32 v72, 1, v72
  v_lshlrev_b32 v69, 10, v116
  v_lshl_add_u32 v69, v117, 4, v69
  v_lshl_add_u32 v69, v72, 2, v69
  v_add_u32 v112, 57344, v69
  v_lshrrev_b32 v69, 1, v117
  v_and_b32 v72, 1, v117
  v_lshl_add_u32 v69, v72, 3, v69
  v_mul_u32_u24 v69, 144, v69
  v_lshl_add_u32 v69, v71, 6, v69
  v_lshl_add_u32 v69, v64, 5, v69
  v_lshl_add_u32 v72, v72, 1, v71
  v_xor_b32 v72, 1, v72
  v_lshl_add_u32 v69, v72, 2, v69
  v_add_u32 v113, 65536, v69
  v_and_b32 v71, 1, v1
  v_cmp_eq_u32 s[38:39], 0, v71
  v_cmp_gt_u32 vcc, 8, v65
  s_or_b64 s[28:29], s[38:39], vcc
  v_lshrrev_b32 v72, 1, v67
  v_lshlrev_b32 v72, 2, v72
  v_lshl_add_u32 v72, v70, 4, v72
  s_lshl_b32 s22, s17, 9
  s_add_u32 s22, s22, 9216
  v_lshl_add_u32 v73, v66, 7, v72
  v_add_u32 v73, s22, v73
  s_lshl_b32 s22, s17, 7
  s_add_u32 s22, s22, 7168
  v_add_u32 v74, s22, v72
  v_bfe_u32 v72, v65, 1, 1
  v_lshlrev_b32 v72, 7, v72
  v_lshl_add_u32 v72, v70, 4, v72
  v_bfe_u32 v73, v65, 2, 2
  v_lshl_add_u32 v72, v73, 2, v72
  v_lshrrev_b32 v73, 4, v65
  v_lshl_add_u32 v73, v73, 8, v72
  s_lshl_b32 s22, s17, 9
  s_add_u32 s22, s22, 9216
  v_add_u32 v73, s22, v73
  s_lshr_b32 s22, s17, 1
  s_lshl_b32 s22, s22, 8
  s_and_b32 s34, s17, 1
  s_lshl_b32 s34, s34, 3
  s_add_u32 s22, s22, s34
  s_add_u32 s22, s22, 7168
  v_add_u32 v74, s22, v72
  v_bfe_u32 v72, v65, 1, 1
  v_lshl_add_u32 v72, v64, 1, v72
  v_lshlrev_b32 v72, 4, v72
  v_bfe_u32 v73, v65, 2, 2
  v_lshl_add_u32 v72, v73, 2, v72
  v_lshrrev_b32 v73, 4, v65
  v_lshl_add_u32 v73, v73, 6, v72
  s_lshl_b32 s22, s17, 9
  s_add_u32 s22, s22, 9344
  v_add_u32 v73, s22, v73
  v_lshrrev_b32 v72, 1, v65
  v_lshlrev_b32 v72, 2, v72
  v_lshl_add_u32 v72, v64, 5, v72
  s_lshr_b32 s22, s17, 1
  s_lshl_b32 s22, s22, 8
  s_and_b32 s34, s17, 1
  s_lshl_b32 s34, s34, 4
  s_add_u32 s22, s22, s34
  s_add_u32 s22, s22, 7232
  v_add_u32 v74, s22, v72
  v_lshlrev_b32 v0, 2, v65
  v_and_b32 v0, 120, v0
  s_and_b32 s22, s17, 15
  s_lshl_b32 s22, s22, 7
  s_add_u32 s22, s22, 18432
  v_add_u32 v0, s22, v0
  v_cndmask_b32 v1, v74, v73, s[38:39]
  s_lshl_b32 s36, s17, 2
  s_add_u32 s36, s36, 17472
  s_mov_b32 s37, 0x3e800000
  v_mov_b32 v64, 0
  v_mov_b32 v65, 0
  v_mov_b32 v66, 0
  v_mov_b32 v67, 0
  v_mov_b32 v68, 0
  v_mov_b32 v69, 0
  v_mov_b32 v70, 0
  v_mov_b32 v71, 0
  v_mov_b32 v72, 0
  v_mov_b32 v73, 0
  v_mov_b32 v74, 0
  v_mov_b32 v75, 0
  v_mov_b32 v76, 0
  v_mov_b32 v77, 0
  v_mov_b32 v78, 0
  v_mov_b32 v79, 0
  v_mov_b32 v80, 0
  v_mov_b32 v81, 0
  v_mov_b32 v82, 0
  v_mov_b32 v83, 0
  v_mov_b32 v84, 0
  v_mov_b32 v85, 0
  v_mov_b32 v86, 0
  v_mov_b32 v87, 0
  v_mov_b32 v88, 0
  v_mov_b32 v89, 0
  v_mov_b32 v90, 0
  v_mov_b32 v91, 0
  v_mov_b32 v92, 0
  v_mov_b32 v93, 0
  v_mov_b32 v94, 0
  v_mov_b32 v95, 0
  v_mov_b32 v96, 0
  v_mov_b32 v97, 0
  v_mov_b32 v98, 0
  v_mov_b32 v99, 0
  v_mov_b32 v100, 0
  v_mov_b32 v101, 0
  v_mov_b32 v102, 0
  v_mov_b32 v103, 0
  v_mov_b32 v104, 0
  v_mov_b32 v105, 0
  v_mov_b32 v106, 0
  v_mov_b32 v107, 0
  v_mov_b32 v108, 0
  v_mov_b32 v109, 0
  v_mov_b32 v110, 0
  v_mov_b32 v111, 0
  v_and_b32 v118, 1, v116
  v_cmp_eq_u32 vcc, 0, v118
  v_mov_b32 v118, 12288
  v_mov_b32 v119, 8448
  v_cndmask_b32 v118, v118, v119, vcc
  v_lshrrev_b32 v116, 1, v116
  v_lshl_add_u32 v118, v116, 9, v118
  v_lshl_add_u32 v117, v117, 4, v118
  s_mov_b32 s57, 28672
  v_bfe_u32 v118, v2, 4, 1
  v_mul_u32_u24 v118, 0xaaaa, v118
  v_add_u32 v118, 0x4444, v118
  s_mov_b32 s56, 0x42800000
  v_mov_b32 v116, v2
  v_lshrrev_b32 v0, 4, v2
  v_min_u32 v0, 9, v0
  s_mul_i32 s22, s17, 10
  v_add_u32 v0, s22, v0
  v_lshlrev_b32 v0, 7, v0
  v_add_u32 v0, 40960, v0
  s_mov_b32 s22, 88633344
  buffer_load_dword v119, v0, s[8:11], s22 offen sc1
  s_mov_b32 s22, 88612864
  buffer_load_dword v119, v0, s[8:11], s22 offen sc1
  s_mul_i32 s35, s17, 1835008
  s_add_u32 s35, s35, 42269696
  s_mov_b32 s30, 0
  v_mov_b32 v36, 0
ch_md1:
  buffer_load_dword v37, v36, s[12:15], 0 offen sc1
  s_waitcnt vmcnt(0)
  v_readfirstlane_b32 s22, v37
  s_and_b32 s31, s22, 0xffff
  s_cmp_ge_u32 s31, 32
  s_cbranch_scc1 ch_go1
  s_sleep 2
  s_add_u32 s30, s30, 1
  s_cmp_lt_u32 s30, 50000
  s_cbranch_scc1 ch_md1
  s_branch ch_end
ch_go1:
  s_mov_b32 s31, 0
  s_lshr_b32 s22, s22, 16
  s_cmp_lg_u32 s22, 0
  s_cbranch_scc1 cB_sc1_loop
  s_branch cA_sc1_loop
ch_init2:
  s_mul_i32 s31, s17, 401408
  s_add_u32 s31, s31, 0
  s_mov_b32 s24, 71579648
  s_mov_b32 s25, 0
  s_add_u32 m0, s25, 14336
  s_nop 0
  buffer_load_dwordx4 v2, s[8:11], s24 offen offset:0 sc1 lds
  buffer_load_dwordx4 v2, s[8:11], s24 offen offset:1024 sc1 lds
  buffer_load_dwordx4 v2, s[8:11], s24 offen offset:2048 sc1 lds
  buffer_load_dwordx4 v2, s[8:11], s24 offen offset:3072 sc1 lds
  s_add_u32 m0, s25, 18432
  s_add_u32 s22, s24, 4096
  buffer_load_dwordx4 v2, s[8:11], s22 offen offset:0 sc1 lds
  buffer_load_dwordx4 v2, s[8:11], s22 offen offset:1024 sc1 lds
  buffer_load_dwordx4 v2, s[8:11], s22 offen offset:2048 sc1 lds
  v_lshrrev_b32 v64, 1, v117
  v_and_b32 v65, 1, v116
  v_lshlrev_b32 v65, 2, v65
  v_sub_u32 v64, v64, v65
  v_and_b32 v65, 1, v117
  v_lshl_add_u32 v66, v65, 2, v64
  v_cmp_gt_u32 vcc, 4, v64
  v_mov_b32 v67, 99
  s_nop 0
  v_cndmask_b32 v66, v67, v66, vcc
  v_mov_b32 v68, 0x3f80
  v_mov_b32 v69, 0x3f800000
  v_mov_b32 v4, 0
  v_cmp_eq_u32 vcc, 0, v66
  s_nop 1
  v_cndmask_b32 v4, v4, v68, vcc
  v_cmp_eq_u32 vcc, 1, v66
  s_nop 1
  v_cndmask_b32 v4, v4, v69, vcc
  v_mov_b32 v5, 0
  v_cmp_eq_u32 vcc, 2, v66
  s_nop 1
  v_cndmask_b32 v5, v5, v68, vcc
  v_cmp_eq_u32 vcc, 3, v66
  s_nop 1
  v_cndmask_b32 v5, v5, v69, vcc
  v_mov_b32 v6, 0
  v_cmp_eq_u32 vcc, 4, v66
  s_nop 1
  v_cndmask_b32 v6, v6, v68, vcc
  v_cmp_eq_u32 vcc, 5, v66
  s_nop 1
  v_cndmask_b32 v6, v6, v69, vcc
  v_mov_b32 v7, 0
  v_cmp_eq_u32 vcc, 6, v66
  s_nop 1
  v_cndmask_b32 v7, v7, v68, vcc
  v_cmp_eq_u32 vcc, 7, v66
  s_nop 1
  v_cndmask_b32 v7, v7, v69, vcc
  v_lshrrev_b32 v64, 1, v116
  v_lshrrev_b32 v65, 3, v117
  v_cmp_eq_u32 s[26:27], v64, v65
  v_and_b32 v66, 1, v116
  v_add_u32 v64, 4, v64
  v_lshrrev_b32 v67, 1, v116
  v_lshlrev_b32 v67, 8, v67
  v_lshl_add_u32 v67, v66, 9, v67
  v_lshl_add_u32 v67, v117, 4, v67
  v_add_u32 v112, 59392, v67
  v_and_b32 v68, 7, v117
  v_lshlrev_b32 v67, 8, v64
  v_lshl_add_u32 v67, v68, 5, v67
  v_lshl_add_u32 v67, v66, 4, v67
  v_add_u32 v113, 65536, v67
  v_lshrrev_b32 v64, 5, v1
  v_and_b32 v65, 31, v1
  v_lshrrev_b32 v66, 3, v65
  v_and_b32 v67, 7, v65
  v_and_b32 v68, 3, v67
  v_lshl_add_u32 v68, v66, 2, v68
  v_lshrrev_b32 v69, 2, v67
  v_lshl_add_u32 v68, v69, 4, v68
  v_lshlrev_b32 v69, 11, v64
  v_lshl_add_u32 v69, v68, 4, v69
  v_add_u32 v114, 57856, v69
  v_add_u32 v70, 4, v64
  v_lshlrev_b32 v69, 9, v66
  v_lshl_add_u32 v69, v70, 5, v69
  v_lshl_add_u32 v69, v67, 2, v69
  v_add_u32 v115, 65536, v69
  v_lshlrev_b32 v69, 4, v68
  v_lshl_add_u32 v69, v64, 9, v69
  v_add_u32 v114, 59392, v69
  v_mul_u32_u24 v69, 144, v70
  v_lshl_add_u32 v69, v67, 4, v69
  v_add_u32 v115, 65536, v69
  v_and_b32 v71, 1, v116
  v_mul_u32_u24 v69, 2048, v71
  v_lshl_add_u32 v69, v64, 8, v69
  v_lshl_add_u32 v69, v117, 4, v69
  v_add_u32 v112, 57856, v69
  v_mul_u32_u24 v69, 144, v117
  v_lshl_add_u32 v69, v71, 6, v69
  v_lshl_add_u32 v69, v64, 5, v69
  v_add_u32 v113, 65544, v69
  v_mul_u32_u24 v69, 1024, v116
  v_lshl_add_u32 v69, v117, 4, v69
  v_and_b32 v72, 8, v117
  v_xor_b32 v72, 0, v72
  v_add_u32 v69, v69, v72
  v_add_u32 v112, 57856, v69
  v_lshrrev_b32 v72, 3, v117
  v_lshl_add_u32 v72, v71, 1, v72
  v_xor_b32 v72, 2, v72
  v_lshlrev_b32 v69, 10, v116
  v_lshl_add_u32 v69, v117, 4, v69
  v_lshl_add_u32 v69, v72, 2, v69
  v_add_u32 v112, 57344, v69
  v_lshrrev_b32 v69, 1, v117
  v_and_b32 v72, 1, v117
  v_lshl_add_u32 v69, v72, 3, v69
  v_mul_u32_u24 v69, 144, v69
  v_lshl_add_u32 v69, v71, 6, v69
  v_lshl_add_u32 v69, v64, 5, v69
  v_lshl_add_u32 v72, v72, 1, v71
  v_xor_b32 v72, 2, v72
  v_lshl_add_u32 v69, v72, 2, v69
  v_add_u32 v113, 65536, v69
  v_and_b32 v71, 1, v1
  v_cmp_eq_u32 s[38:39], 0, v71
  v_cmp_gt_u32 vcc, 8, v65
  s_or_b64 s[28:29], s[38:39], vcc
  v_lshrrev_b32 v72, 1, v67
  v_lshlrev_b32 v72, 2, v72
  v_lshl_add_u32 v72, v70, 4, v72
  s_lshl_b32 s22, s17, 9
  s_add_u32 s22, s22, 9216
  v_lshl_add_u32 v73, v66, 7, v72
  v_add_u32 v73, s22, v73
  s_lshl_b32 s22, s17, 7
  s_add_u32 s22, s22, 7168
  v_add_u32 v74, s22, v72
  v_bfe_u32 v72, v65, 1, 1
  v_lshlrev_b32 v72, 7, v72
  v_lshl_add_u32 v72, v70, 4, v72
  v_bfe_u32 v73, v65, 2, 2
  v_lshl_add_u32 v72, v73, 2, v72
  v_lshrrev_b32 v73, 4, v65
  v_lshl_add_u32 v73, v73, 8, v72
  s_lshl_b32 s22, s17, 9
  s_add_u32 s22, s22, 9216
  v_add_u32 v73, s22, v73
  s_lshr_b32 s22, s17, 1
  s_lshl_b32 s22, s22, 8
  s_and_b32 s34, s17, 1
  s_lshl_b32 s34, s34, 3
  s_add_u32 s22, s22, s34
  s_add_u32 s22, s22, 7168
  v_add_u32 v74, s22, v72
  v_bfe_u32 v72, v65, 1, 1
  v_lshl_add_u32 v72, v64, 1, v72
  v_lshlrev_b32 v72, 4, v72
  v_bfe_u32 v73, v65, 2, 2
  v_lshl_add_u32 v72, v73, 2, v72
  v_lshrrev_b32 v73, 4, v65
  v_lshl_add_u32 v73, v73, 6, v72
  s_lshl_b32 s22, s17, 9
  s_add_u32 s22, s22, 9472
  v_add_u32 v73, s22, v73
  v_lshrrev_b32 v72, 1, v65
  v_lshlrev_b32 v72, 2, v72
  v_lshl_add_u32 v72, v64, 5, v72
  s_lshr_b32 s22, s17, 1
  s_lshl_b32 s22, s22, 8
  s_and_b32 s34, s17, 1
  s_lshl_b32 s34, s34, 4
  s_add_u32 s22, s22, s34
  s_add_u32 s22, s22, 7296
  v_add_u32 v74, s22, v72
  v_lshlrev_b32 v0, 2, v65
  v_and_b32 v0, 120, v0
  s_and_b32 s22, s17, 15
  s_lshl_b32 s22, s22, 7
  s_add_u32 s22, s22, 18432
  v_add_u32 v0, s22, v0
  v_cndmask_b32 v1, v74, v73, s[38:39]
  s_lshl_b32 s36, s17, 2
  s_add_u32 s36, s36, 17472
  s_mov_b32 s37, 0x3e800000
  v_mov_b32 v64, 0
  v_mov_b32 v65, 0
  v_mov_b32 v66, 0
  v_mov_b32 v67, 0
  v_mov_b32 v68, 0
  v_mov_b32 v69, 0
  v_mov_b32 v70, 0
  v_mov_b32 v71, 0
  v_mov_b32 v72, 0
  v_mov_b32 v73, 0
  v_mov_b32 v74, 0
  v_mov_b32 v75, 0
  v_mov_b32 v76, 0
  v_mov_b32 v77, 0
  v_mov_b32 v78, 0
  v_mov_b32 v79, 0
  v_mov_b32 v80, 0
  v_mov_b32 v81, 0
  v_mov_b32 v82, 0
  v_mov_b32 v83, 0
  v_mov_b32 v84, 0
  v_mov_b32 v85, 0
  v_mov_b32 v86, 0
  v_mov_b32 v87, 0
  v_mov_b32 v88, 0
  v_mov_b32 v89, 0
  v_mov_b32 v90, 0
  v_mov_b32 v91, 0
  v_mov_b32 v92, 0
  v_mov_b32 v93, 0
  v_mov_b32 v94, 0
  v_mov_b32 v95, 0
  v_mov_b32 v96, 0
  v_mov_b32 v97, 0
  v_mov_b32 v98, 0
  v_mov_b32 v99, 0
  v_mov_b32 v100, 0
  v_mov_b32 v101, 0
  v_mov_b32 v102, 0
  v_mov_b32 v103, 0
  v_mov_b32 v104, 0
  v_mov_b32 v105, 0
  v_mov_b32 v106, 0
  v_mov_b32 v107, 0
  v_mov_b32 v108, 0
  v_mov_b32 v109, 0
  v_mov_b32 v110, 0
  v_mov_b32 v111, 0
  v_and_b32 v118, 1, v116
  v_cmp_eq_u32 vcc, 0, v118
  v_mov_b32 v118, 12544
  v_mov_b32 v119, 10240
  v_cndmask_b32 v118, v118, v119, vcc
  v_lshrrev_b32 v116, 1, v116
  v_lshl_add_u32 v118, v116, 9, v118
  v_lshl_add_u32 v117, v117, 4, v118
  s_mov_b32 s57, 28672
  v_bfe_u32 v118, v2, 4, 1
  v_mul_u32_u24 v118, 0xaaaa, v118
  v_add_u32 v118, 0x4444, v118
  s_mov_b32 s56, 0x42800000
  v_mov_b32 v116, v2
  v_lshrrev_b32 v0, 4, v2
  v_min_u32 v0, 13, v0
  s_mul_i32 s22, s17, 14
  v_add_u32 v0, s22, v0
  v_lshlrev_b32 v0, 7, v0
  v_add_u32 v0, 43008, v0
  s_mov_b32 s22, 71550976
  buffer_load_dword v119, v0, s[8:11], s22 offen sc1
  s_mov_b32 s22, 71522304
  buffer_load_dword v119, v0, s[8:11], s22 offen sc1
  s_mul_i32 s35, s17, 1835008
  s_add_u32 s35, s35, 42276864
  s_mov_b32 s30, 0
  v_mov_b32 v36, 0
ch_md2:
  buffer_load_dword v37, v36, s[12:15], 0 offen sc1
  s_waitcnt vmcnt(0)
  v_readfirstlane_b32 s22, v37
  s_and_b32 s31, s22, 0xffff
  s_cmp_ge_u32 s31, 32
  s_cbranch_scc1 ch_go2
  s_sleep 2
  s_add_u32 s30, s30, 1
  s_cmp_lt_u32 s30, 50000
  s_cbranch_scc1 ch_md2
  s_branch ch_end
ch_go2:
  s_mov_b32 s31, 0
  s_lshr_b32 s22, s22, 16
  s_cmp_lg_u32 s22, 0
  s_cbranch_scc1 cB_sc2_loop
  s_branch cA_sc2_loop
ch_init3:
  s_mul_i32 s31, s17, 401408
  s_add_u32 s31, s31, 0
  s_mov_b32 s24, 71586816
  s_mov_b32 s25, 0
  s_add_u32 m0, s25, 21504
  s_nop 0
  buffer_load_dwordx4 v2, s[8:11], s24 offen offset:0 sc1 lds
  buffer_load_dwordx4 v2, s[8:11], s24 offen offset:1024 sc1 lds
  buffer_load_dwordx4 v2, s[8:11], s24 offen offset:2048 sc1 lds
  buffer_load_dwordx4 v2, s[8:11], s24 offen offset:3072 sc1 lds
  s_add_u32 m0, s25, 25600
  s_add_u32 s22, s24, 4096
  buffer_load_dwordx4 v2, s[8:11], s22 offen offset:0 sc1 lds
  buffer_load_dwordx4 v2, s[8:11], s22 offen offset:1024 sc1 lds
  buffer_load_dwordx4 v2, s[8:11], s22 offen offset:2048 sc1 lds
  v_lshrrev_b32 v64, 1, v117
  v_and_b32 v65, 1, v116
  v_lshlrev_b32 v65, 2, v65
  v_sub_u32 v64, v64, v65
  v_and_b32 v65, 1, v117
  v_lshl_add_u32 v66, v65, 2, v64
  v_cmp_gt_u32 vcc, 4, v64
  v_mov_b32 v67, 99
  s_nop 0
  v_cndmask_b32 v66, v67, v66, vcc
  v_mov_b32 v68, 0x3f80
  v_mov_b32 v69, 0x3f800000
  v_mov_b32 v4, 0
  v_cmp_eq_u32 vcc, 0, v66
  s_nop 1
  v_cndmask_b32 v4, v4, v68, vcc
  v_cmp_eq_u32 vcc, 1, v66
  s_nop 1
  v_cndmask_b32 v4, v4, v69, vcc
  v_mov_b32 v5, 0
  v_cmp_eq_u32 vcc, 2, v66
  s_nop 1
  v_cndmask_b32 v5, v5, v68, vcc
  v_cmp_eq_u32 vcc, 3, v66
  s_nop 1
  v_cndmask_b32 v5, v5, v69, vcc
  v_mov_b32 v6, 0
  v_cmp_eq_u32 vcc, 4, v66
  s_nop 1
  v_cndmask_b32 v6, v6, v68, vcc
  v_cmp_eq_u32 vcc, 5, v66
  s_nop 1
  v_cndmask_b32 v6, v6, v69, vcc
  v_mov_b32 v7, 0
  v_cmp_eq_u32 vcc, 6, v66
  s_nop 1
  v_cndmask_b32 v7, v7, v68, vcc
  v_cmp_eq_u32 vcc, 7, v66
  s_nop 1
  v_cndmask_b32 v7, v7, v69, vcc
  v_lshrrev_b32 v64, 1, v116
  v_lshrrev_b32 v65, 3, v117
  v_cmp_eq_u32 s[26:27], v64, v65
  v_and_b32 v66, 1, v116
  v_add_u32 v64, 6, v64
  v_lshrrev_b32 v67, 1, v116
  v_lshlrev_b32 v67, 8, v67
  v_lshl_add_u32 v67, v66, 9, v67
  v_lshl_add_u32 v67, v117, 4, v67
  v_add_u32 v112, 60416, v67
  v_and_b32 v68, 7, v117
  v_lshlrev_b32 v67, 8, v64
  v_lshl_add_u32 v67, v68, 5, v67
  v_lshl_add_u32 v67, v66, 4, v67
  v_add_u32 v113, 65536, v67
  v_lshrrev_b32 v64, 5, v1
  v_and_b32 v65, 31, v1
  v_lshrrev_b32 v66, 3, v65
  v_and_b32 v67, 7, v65
  v_and_b32 v68, 3, v67
  v_lshl_add_u32 v68, v66, 2, v68
  v_lshrrev_b32 v69, 2, v67
  v_lshl_add_u32 v68, v69, 4, v68
  v_lshlrev_b32 v69, 11, v64
  v_lshl_add_u32 v69, v68, 4, v69
  v_add_u32 v114, 57864, v69
  v_add_u32 v70, 6, v64
  v_lshlrev_b32 v69, 9, v66
  v_lshl_add_u32 v69, v70, 5, v69
  v_lshl_add_u32 v69, v67, 2, v69
  v_add_u32 v115, 65536, v69
  v_lshlrev_b32 v69, 4, v68
  v_lshl_add_u32 v69, v64, 9, v69
  v_add_u32 v114, 60416, v69
  v_mul_u32_u24 v69, 144, v70
  v_lshl_add_u32 v69, v67, 4, v69
  v_add_u32 v115, 65536, v69
  v_and_b32 v71, 1, v116
  v_mul_u32_u24 v69, 2048, v71
  v_lshl_add_u32 v69, v64, 8, v69
  v_lshl_add_u32 v69, v117, 4, v69
  v_add_u32 v112, 57864, v69
  v_mul_u32_u24 v69, 144, v117
  v_lshl_add_u32 v69, v71, 6, v69
  v_lshl_add_u32 v69, v64, 5, v69
  v_add_u32 v113, 65548, v69
  v_mul_u32_u24 v69, 1024, v116
  v_lshl_add_u32 v69, v117, 4, v69
  v_and_b32 v72, 8, v117
  v_xor_b32 v72, 8, v72
  v_add_u32 v69, v69, v72
  v_add_u32 v112, 57856, v69
  v_lshrrev_b32 v72, 3, v117
  v_lshl_add_u32 v72, v71, 1, v72
  v_xor_b32 v72, 3, v72
  v_lshlrev_b32 v69, 10, v116
  v_lshl_add_u32 v69, v117, 4, v69
  v_lshl_add_u32 v69, v72, 2, v69
  v_add_u32 v112, 57344, v69
  v_lshrrev_b32 v69, 1, v117
  v_and_b32 v72, 1, v117
  v_lshl_add_u32 v69, v72, 3, v69
  v_mul_u32_u24 v69, 144, v69
  v_lshl_add_u32 v69, v71, 6, v69
  v_lshl_add_u32 v69, v64, 5, v69
  v_lshl_add_u32 v72, v72, 1, v71
  v_xor_b32 v72, 3, v72
  v_lshl_add_u32 v69, v72, 2, v69
  v_add_u32 v113, 65536, v69
  v_and_b32 v71, 1, v1
  v_cmp_eq_u32 s[38:39], 0, v71
  v_cmp_gt_u32 vcc, 8, v65
  s_or_b64 s[28:29], s[38:39], vcc
  v_lshrrev_b32 v72, 1, v67
  v_lshlrev_b32 v72, 2, v72
  v_lshl_add_u32 v72, v70, 4, v72
  s_lshl_b32 s22, s17, 9
  s_add_u32 s22, s22, 9216
  v_lshl_add_u32 v73, v66, 7, v72
  v_add_u32 v73, s22, v73
  s_lshl_b32 s22, s17, 7
  s_add_u32 s22, s22, 7168
  v_add_u32 v74, s22, v72
  v_bfe_u32 v72, v65, 1, 1
  v_lshlrev_b32 v72, 7, v72
  v_lshl_add_u32 v72, v70, 4, v72
  v_bfe_u32 v73, v65, 2, 2
  v_lshl_add_u32 v72, v73, 2, v72
  v_lshrrev_b32 v73, 4, v65
  v_lshl_add_u32 v73, v73, 8, v72
  s_lshl_b32 s22, s17, 9
  s_add_u32 s22, s22, 9216
  v_add_u32 v73, s22, v73
  s_lshr_b32 s22, s17, 1
  s_lshl_b32 s22, s22, 8
  s_and_b32 s34, s17, 1
  s_lshl_b32 s34, s34, 3
  s_add_u32 s22, s22, s34
  s_add_u32 s22, s22, 7168
  v_add_u32 v74, s22, v72
  v_bfe_u32 v72, v65, 1, 1
  v_lshl_add_u32 v72, v64, 1, v72
  v_lshlrev_b32 v72, 4, v72
  v_bfe_u32 v73, v65, 2, 2
  v_lshl_add_u32 v72, v73, 2, v72
  v_lshrrev_b32 v73, 4, v65
  v_lshl_add_u32 v73, v73, 6, v72
  s_lshl_b32 s22, s17, 9
  s_add_u32 s22, s22, 9600
  v_add_u32 v73, s22, v73
  v_lshrrev_b32 v72, 1, v65
  v_lshlrev_b32 v72, 2, v72
  v_lshl_add_u32 v72, v64, 5, v72
  s_lshr_b32 s22, s17, 1
  s_lshl_b32 s22, s22, 8
  s_and_b32 s34, s17, 1
  s_lshl_b32 s34, s34, 4
  s_add_u32 s22, s22, s34
  s_add_u32 s22, s22, 7360
  v_add_u32 v74, s22, v72
  v_lshlrev_b32 v0, 2, v65
  v_and_b32 v0, 120, v0
  s_and_b32 s22, s17, 15
  s_lshl_b32 s22, s22, 7
  s_add_u32 s22, s22, 18432
  v_add_u32 v0, s22, v0
  v_cndmask_b32 v1, v74, v73, s[38:39]
  s_lshl_b32 s36, s17, 2
  s_add_u32 s36, s36, 17472
  s_mov_b32 s37, 0x3e800000
  v_mov_b32 v64, 0
  v_mov_b32 v65, 0
  v_mov_b32 v66, 0
  v_mov_b32 v67, 0
  v_mov_b32 v68, 0
  v_mov_b32 v69, 0
  v_mov_b32 v70, 0
  v_mov_b32 v71, 0
  v_mov_b32 v72, 0
  v_mov_b32 v73, 0
  v_mov_b32 v74, 0
  v_mov_b32 v75, 0
  v_mov_b32 v76, 0
  v_mov_b32 v77, 0
  v_mov_b32 v78, 0
  v_mov_b32 v79, 0
  v_mov_b32 v80, 0
  v_mov_b32 v81, 0
  v_mov_b32 v82, 0
  v_mov_b32 v83, 0
  v_mov_b32 v84, 0
  v_mov_b32 v85, 0
  v_mov_b32 v86, 0
  v_mov_b32 v87, 0
  v_mov_b32 v88, 0
  v_mov_b32 v89, 0
  v_mov_b32 v90, 0
  v_mov_b32 v91, 0
  v_mov_b32 v92, 0
  v_mov_b32 v93, 0
  v_mov_b32 v94, 0
  v_mov_b32 v95, 0
  v_mov_b32 v96, 0
  v_mov_b32 v97, 0
  v_mov_b32 v98, 0
  v_mov_b32 v99, 0
  v_mov_b32 v100, 0
  v_mov_b32 v101, 0
  v_mov_b32 v102, 0
  v_mov_b32 v103, 0
  v_mov_b32 v104, 0
  v_mov_b32 v105, 0
  v_mov_b32 v106, 0
  v_mov_b32 v107, 0
  v_mov_b32 v108, 0
  v_mov_b32 v109, 0
  v_mov_b32 v110, 0
  v_mov_b32 v111, 0
  v_and_b32 v118, 1, v116
  v_cmp_eq_u32 vcc, 0, v118
  v_mov_b32 v118, 12544
  v_mov_b32 v119, 10496
  v_cndmask_b32 v118, v118, v119, vcc
  v_lshrrev_b32 v116, 1, v116
  v_lshl_add_u32 v118, v116, 9, v118
  v_lshl_add_u32 v117, v117, 4, v118
  s_mov_b32 s57, 28672
  v_bfe_u32 v118, v2, 4, 1
  v_mul_u32_u24 v118, 0xaaaa, v118
  v_add_u32 v118, 0x4444, v118
  s_mov_b32 s56, 0x42800000
  v_mov_b32 v116, v2
  s_mul_i32 s35, s17, 1835008
  s_add_u32 s35, s35, 42284032
  s_mov_b32 s30, 0
  v_mov_b32 v36, 0
ch_md3:
  buffer_load_dword v37, v36, s[12:15], 0 offen sc1
  s_waitcnt vmcnt(0)
  v_readfirstlane_b32 s22, v37
  s_and_b32 s31, s22, 0xffff
  s_cmp_ge_u32 s31, 32
  s_cbranch_scc1 ch_go3
  s_sleep 2
  s_add_u32 s30, s30, 1
  s_cmp_lt_u32 s30, 50000
  s_cbranch_scc1 ch_md3
  s_branch ch_end
ch_go3:
  s_mov_b32 s31, 0
  s_lshr_b32 s22, s22, 16
  s_cmp_lg_u32 s22, 0
  s_cbranch_scc1 cB_sc3_loop
  s_branch cA_sc3_loop
ch_init4:
  s_mul_i32 s31, s17, 401408
  s_add_u32 s31, s31, 6422528
  s_lshl_b32 s22, s17, 4
  v_mov_b32 v38, s22
  v_mov_b32 v36, v38
  v_med3_u32 v37, v117, 0, 5
  v_lshrrev_b32 v36, 6, v36
  v_lshlrev_b32 v36, 8, v36
  v_lshl_add_u32 v36, v37, 4, v36
  s_mov_b32 s22, 88600576
  s_mov_b32 s30, 0
va_bw_11:
  buffer_load_dwordx4 v[40:43], v36, s[8:11], s22 offen sc1
  s_waitcnt vmcnt(0)
  v_cmp_ne_u64 vcc, s[88:89], v[40:41]
  s_cbranch_vccnz va_bw_11_no
  v_cmp_ne_u64 vcc, s[88:89], v[42:43]
  s_cbranch_vccnz va_bw_11_no
  s_branch va_bw_11_ok
va_bw_11_no:
  s_sleep 2
  s_add_u32 s30, s30, 1
  s_cmp_lt_u32 s30, 50000
  s_cbranch_scc1 va_bw_11
  s_branch cA_abort
va_bw_11_ok:
  s_add_u32 s22, s31, 0
  buffer_load_dwordx4 a[0:3], v2, s[8:11], s22 offen offset:0 sc1
  buffer_load_dwordx4 a[4:7], v2, s[8:11], s22 offen offset:1024 sc1
  buffer_load_dwordx4 a[8:11], v2, s[8:11], s22 offen offset:2048 sc1
  buffer_load_dwordx4 a[12:15], v2, s[8:11], s22 offen offset:3072 sc1
  s_add_u32 s22, s31, 4096
  buffer_load_dwordx4 a[16:19], v2, s[8:11], s22 offen offset:0 sc1
  buffer_load_dwordx4 a[20:23], v2, s[8:11], s22 offen offset:1024 sc1
  buffer_load_dwordx4 a[24:27], v2, s[8:11], s22 offen offset:2048 sc1
  buffer_load_dwordx4 a[28:31], v2, s[8:11], s22 offen offset:3072 sc1
  s_add_u32 s22, s31, 8192
  buffer_load_dwordx4 a[32:35], v2, s[8:11], s22 offen offset:0 sc1
  buffer_load_dwordx4 a[36:39], v2, s[8:11], s22 offen offset:1024 sc1
  buffer_load_dwordx4 a[40:43], v2, s[8:11], s22 offen offset:2048 sc1
  buffer_load_dwordx4 a[44:47], v2, s[8:11], s22 offen offset:3072 sc1
  s_add_u32 s22, s31, 12288
  buffer_load_dwordx4 a[48:51], v2, s[8:11], s22 offen offset:0 sc1
  buffer_load_dwordx4 a[52:55], v2, s[8:11], s22 offen offset:1024 sc1
  buffer_load_dwordx4 a[56:59], v2, s[8:11], s22 offen offset:2048 sc1
  buffer_load_dwordx4 a[60:63], v2, s[8:11], s22 offen offset:3072 sc1
  s_add_u32 s22, s31, 16384
  buffer_load_dwordx4 a[64:67], v2, s[8:11], s22 offen offset:0 sc1
  buffer_load_dwordx4 a[68:71], v2, s[8:11], s22 offen offset:1024 sc1
  buffer_load_dwordx4 a[72:75], v2, s[8:11], s22 offen offset:2048 sc1
  buffer_load_dwordx4 a[76:79], v2, s[8:11], s22 offen offset:3072 sc1
  s_add_u32 s22, s31, 20480
  buffer_load_dwordx4 a[80:83], v2, s[8:11], s22 offen offset:0 sc1
  buffer_load_dwordx4 a[84:87], v2, s[8:11], s22 offen offset:1024 sc1
  buffer_load_dwordx4 a[88:91], v2, s[8:11], s22 offen offset:2048 sc1
  buffer_load_dwordx4 a[92:95], v2, s[8:11], s22 offen offset:3072 sc1
  s_add_u32 s22, s31, 24576
  buffer_load_dwordx4 a[96:99], v2, s[8:11], s22 offen offset:0 sc1
  buffer_load_dwordx4 a[100:103], v2, s[8:11], s22 offen offset:1024 sc1
  buffer_load_dwordx4 a[104:107], v2, s[8:11], s22 offen offset:2048 sc1
  buffer_load_dwordx4 a[108:111], v2, s[8:11], s22 offen offset:3072 sc1
  s_add_u32 s22, s31, 28672
  buffer_load_dwordx4 a[112:115], v2, s[8:11], s22 offen offset:0 sc1
  buffer_load_dwordx4 a[116:119], v2, s[8:11], s22 offen offset:1024 sc1
  buffer_load_dwordx4 a[120:123], v2, s[8:11], s22 offen offset:2048 sc1
  buffer_load_dwordx4 a[124:127], v2, s[8:11], s22 offen offset:3072 sc1
  s_waitcnt vmcnt(24)
  s_add_u32 s22, s31, 32768
  buffer_load_dwordx4 a[128:131], v2, s[8:11], s22 offen offset:0 sc1
  buffer_load_dwordx4 a[132:135], v2, s[8:11], s22 offen offset:1024 sc1
  buffer_load_dwordx4 a[136:139], v2, s[8:11], s22 offen offset:2048 sc1
  buffer_load_dwordx4 a[140:143], v2, s[8:11], s22 offen offset:3072 sc1
  s_add_u32 s22, s31, 36864
  buffer_load_dwordx4 a[144:147], v2, s[8:11], s22 offen offset:0 sc1
  buffer_load_dwordx4 a[148:151], v2, s[8:11], s22 offen offset:1024 sc1
  buffer_load_dwordx4 a[152:155], v2, s[8:11], s22 offen offset:2048 sc1
  buffer_load_dwordx4 a[156:159], v2, s[8:11], s22 offen offset:3072 sc1
  s_add_u32 s22, s31, 40960
  buffer_load_dwordx4 a[160:163], v2, s[8:11], s22 offen offset:0 sc1
  buffer_load_dwordx4 a[164:167], v2, s[8:11], s22 offen offset:1024 sc1
  buffer_load_dwordx4 a[168:171], v2, s[8:11], s22 offen offset:2048 sc1
  buffer_load_dwordx4 a[172:175], v2, s[8:11], s22 offen offset:3072 sc1
  s_add_u32 s22, s31, 45056
  buffer_load_dwordx4 a[176:179], v2, s[8:11], s22 offen offset:0 sc1
  buffer_load_dwordx4 a[180:183], v2, s[8:11], s22 offen offset:1024 sc1
  buffer_load_dwordx4 a[184:187], v2, s[8:11], s22 offen offset:2048 sc1
  buffer_load_dwordx4 a[188:191], v2, s[8:11], s22 offen offset:3072 sc1
  s_add_u32 s22, s31, 49152
  buffer_load_dwordx4 a[192:195], v2, s[8:11], s22 offen offset:0 sc1
  buffer_load_dwordx4 a[196:199], v2, s[8:11], s22 offen offset:1024 sc1
  buffer_load_dwordx4 a[200:203], v2, s[8:11], s22 offen offset:2048 sc1
  buffer_load_dwordx4 a[204:207], v2, s[8:11], s22 offen offset:3072 sc1
  s_add_u32 s22, s31, 53248
  buffer_load_dwordx4 a[208:211], v2, s[8:11], s22 offen offset:0 sc1
  buffer_load_dwordx4 a[212:215], v2, s[8:11], s22 offen offset:1024 sc1
  buffer_load_dwordx4 a[216:219], v2, s[8:11], s22 offen offset:2048 sc1
  buffer_load_dwordx4 a[220:223], v2, s[8:11], s22 offen offset:3072 sc1
  s_add_u32 s22, s31, 57344
  buffer_load_dwordx4 a[224:227], v2, s[8:11], s22 offen offset:0 sc1
  buffer_load_dwordx4 a[228:231], v2, s[8:11], s22 offen offset:1024 sc1
  buffer_load_dwordx4 a[232:235], v2, s[8:11], s22 offen offset:2048 sc1
  buffer_load_dwordx4 a[236:239], v2, s[8:11], s22 offen offset:3072 sc1
  s_add_u32 s22, s31, 61440
  buffer_load_dwordx4 a[240:243], v2, s[8:11], s22 offen offset:0 sc1
  buffer_load_dwordx4 a[244:247], v2, s[8:11], s22 offen offset:1024 sc1
  buffer_load_dwordx4 a[248:251], v2, s[8:11], s22 offen offset:2048 sc1
  buffer_load_dwordx4 a[252:255], v2, s[8:11], s22 offen offset:3072 sc1
  s_waitcnt vmcnt(24)
  s_add_u32 s22, s31, 65536
  buffer_load_dwordx4 v[176:179], v2, s[8:11], s22 offen offset:0 sc1
  buffer_load_dwordx4 v[180:183], v2, s[8:11], s22 offen offset:1024 sc1
  buffer_load_dwordx4 v[184:187], v2, s[8:11], s22 offen offset:2048 sc1
  buffer_load_dwordx4 v[188:191], v2, s[8:11], s22 offen offset:3072 sc1
  s_add_u32 s22, s31, 69632
  buffer_load_dwordx4 v[192:195], v2, s[8:11], s22 offen offset:0 sc1
  buffer_load_dwordx4 v[196:199], v2, s[8:11], s22 offen offset:1024 sc1
  buffer_load_dwordx4 v[200:203], v2, s[8:11], s22 offen offset:2048 sc1
  buffer_load_dwordx4 v[204:207], v2, s[8:11], s22 offen offset:3072 sc1
  s_add_u32 s22, s31, 73728
  buffer_load_dwordx4 v[208:211], v2, s[8:11], s22 offen offset:0 sc1
  buffer_load_dwordx4 v[212:215], v2, s[8:11], s22 offen offset:1024 sc1
  buffer_load_dwordx4 v[216:219], v2, s[8:11], s22 offen offset:2048 sc1
  buffer_load_dwordx4 v[220:223], v2, s[8:11], s22 offen offset:3072 sc1
  s_add_u32 s22, s31, 77824
  buffer_load_dwordx4 v[224:227], v2, s[8:11], s22 offen offset:0 sc1
  buffer_load_dwordx4 v[228:231], v2, s[8:11], s22 offen offset:1024 sc1
  buffer_load_dwordx4 v[232:235], v2, s[8:11], s22 offen offset:2048 sc1
  buffer_load_dwordx4 v[236:239], v2, s[8:11], s22 offen offset:3072 sc1
  s_add_u32 s22, s31, 81920
  buffer_load_dwordx4 v[240:243], v2, s[8:11], s22 offen offset:0 sc1
  buffer_load_dwordx4 v[244:247], v2, s[8:11], s22 offen offset:1024 sc1
  buffer_load_dwordx4 v[248:251], v2, s[8:11], s22 offen offset:2048 sc1
  buffer_load_dwordx4 v[252:255], v2, s[8:11], s22 offen offset:3072 sc1
  s_lshl_b32 s22, s17, 4
  v_mov_b32 v38, s22
  s_mul_i32 s22, s17, 12
  s_add_u32 s23, s22, 267
  s_add_u32 s22, s22, 256
  v_mov_b32 v36, s23
  v_mov_b32 v37, s22
  v_cmp_eq_u32 vcc, 1, v116
  s_nop 1
  v_cndmask_b32 v36, v36, v37, vcc
  v_med3_u32 v37, v117, 4, 5
  v_lshrrev_b32 v36, 6, v36
  v_lshlrev_b32 v36, 8, v36
  v_lshl_add_u32 v36, v37, 4, v36
  s_mov_b32 s22, 88600576
  s_mov_b32 s30, 0
va_bw_12:
  buffer_load_dwordx4 v[40:43], v36, s[8:11], s22 offen sc1
  s_waitcnt vmcnt(0)
  v_cmp_ne_u64 vcc, s[88:89], v[40:41]
  s_cbranch_vccnz va_bw_12_no
  v_cmp_ne_u64 vcc, s[88:89], v[42:43]
  s_cbranch_vccnz va_bw_12_no
  s_branch va_bw_12_ok
va_bw_12_no:
  s_sleep 2
  s_add_u32 s30, s30, 1
  s_cmp_lt_u32 s30, 50000
  s_cbranch_scc1 va_bw_12
  s_branch cA_abort
va_bw_12_ok:
  s_mov_b32 m0, 16384
  s_add_u32 s22, s31, 272384
  buffer_load_dwordx4 v2, s[8:11], s22 offen offset:0 sc1 lds
  buffer_load_dwordx4 v2, s[8:11], s22 offen offset:1024 sc1 lds
  buffer_load_dwordx4 v2, s[8:11], s22 offen offset:2048 sc1 lds
  buffer_load_dwordx4 v2, s[8:11], s22 offen offset:3072 sc1 lds
  s_mov_b32 m0, 20480
  s_add_u32 s22, s31, 276480
  buffer_load_dwordx4 v2, s[8:11], s22 offen offset:0 sc1 lds
  buffer_load_dwordx4 v2, s[8:11], s22 offen offset:1024 sc1 lds
  buffer_load_dwordx4 v2, s[8:11], s22 offen offset:2048 sc1 lds
  buffer_load_dwordx4 v2, s[8:11], s22 offen offset:3072 sc1 lds
  s_mov_b32 m0, 24576
  s_add_u32 s22, s31, 280576
  buffer_load_dwordx4 v2, s[8:11], s22 offen offset:0 sc1 lds
  buffer_load_dwordx4 v2, s[8:11], s22 offen offset:1024 sc1 lds
  buffer_load_dwordx4 v2, s[8:11], s22 offen offset:2048 sc1 lds
  buffer_load_dwordx4 v2, s[8:11], s22 offen offset:3072 sc1 lds
  s_mov_b32 m0, 28672
  s_add_u32 s22, s31, 284672
  buffer_load_dwordx4 v2, s[8:11], s22 offen offset:0 sc1 lds
  buffer_load_dwordx4 v2, s[8:11], s22 offen offset:1024 sc1 lds
  v_mov_b32 v72, v116
  v_mov_b32 v73, v117
  v_lshrrev_b32 v65, 1, v72
  v_and_b32 v66, 1, v72
  v_mov_b32 v68, 0
  v_mov_b32 v69, v73
  v_mov_b32 v70, 0
  v_and_b32 v71, 1, v69
  v_lshrrev_b32 v69, 1, v69
  v_lshl_add_u32 v69, v71, 3, v69
  v_lshlrev_b32 v71, 12, v70
  v_lshrrev_b32 v70, 1, v68
  v_lshl_add_u32 v71, v70, 9, v71
  v_and_b32 v70, 1, v68
  v_lshl_add_u32 v71, v70, 2, v71
  v_lshl_add_u32 v71, v69, 4, v71
  v_lshl_add_u32 v71, v65, 8, v71
  v_lshl_add_u32 v60, v66, 3, v71
  v_mov_b32 v68, 1
  v_mov_b32 v69, v73
  v_mov_b32 v70, 0
  v_and_b32 v71, 1, v69
  v_lshrrev_b32 v69, 1, v69
  v_lshl_add_u32 v69, v71, 3, v69
  v_lshlrev_b32 v71, 12, v70
  v_lshrrev_b32 v70, 1, v68
  v_lshl_add_u32 v71, v70, 9, v71
  v_and_b32 v70, 1, v68
  v_lshl_add_u32 v71, v70, 2, v71
  v_lshl_add_u32 v71, v69, 4, v71
  v_lshl_add_u32 v71, v65, 8, v71
  v_lshl_add_u32 v61, v66, 3, v71
  v_mov_b32 v68, 2
  v_mov_b32 v69, v73
  v_mov_b32 v70, 0
  v_and_b32 v71, 1, v69
  v_lshrrev_b32 v69, 1, v69
  v_lshl_add_u32 v69, v71, 3, v69
  v_lshlrev_b32 v71, 12, v70
  v_lshrrev_b32 v70, 1, v68
  v_lshl_add_u32 v71, v70, 9, v71
  v_and_b32 v70, 1, v68
  v_lshl_add_u32 v71, v70, 2, v71
  v_lshl_add_u32 v71, v69, 4, v71
  v_lshl_add_u32 v71, v65, 8, v71
  v_lshl_add_u32 v62, v66, 3, v71
  v_mov_b32 v68, 3
  v_mov_b32 v69, v73
  v_mov_b32 v70, 0
  v_and_b32 v71, 1, v69
  v_lshrrev_b32 v69, 1, v69
  v_lshl_add_u32 v69, v71, 3, v69
  v_lshlrev_b32 v71, 12, v70
  v_lshrrev_b32 v70, 1, v68
  v_lshl_add_u32 v71, v70, 9, v71
  v_and_b32 v70, 1, v68
  v_lshl_add_u32 v71, v70, 2, v71
  v_lshl_add_u32 v71, v69, 4, v71
  v_lshl_add_u32 v71, v65, 8, v71
  v_lshl_add_u32 v170, v66, 3, v71
  v_mov_b32 v68, 4
  v_mov_b32 v69, v73
  v_mov_b32 v70, 0
  v_and_b32 v71, 1, v69
  v_lshrrev_b32 v69, 1, v69
  v_lshl_add_u32 v69, v71, 3, v69
  v_lshlrev_b32 v71, 12, v70
  v_lshrrev_b32 v70, 1, v68
  v_lshl_add_u32 v71, v70, 9, v71
  v_and_b32 v70, 1, v68
  v_lshl_add_u32 v71, v70, 2, v71
  v_lshl_add_u32 v71, v69, 4, v71
  v_lshl_add_u32 v71, v65, 8, v71
  v_lshl_add_u32 v171, v66, 3, v71
  v_mov_b32 v68, 5
  v_mov_b32 v69, v73
  v_mov_b32 v70, 0
  v_and_b32 v71, 1, v69
  v_lshrrev_b32 v69, 1, v69
  v_lshl_add_u32 v69, v71, 3, v69
  v_lshlrev_b32 v71, 12, v70
  v_lshrrev_b32 v70, 1, v68
  v_lshl_add_u32 v71, v70, 9, v71
  v_and_b32 v70, 1, v68
  v_lshl_add_u32 v71, v70, 2, v71
  v_lshl_add_u32 v71, v69, 4, v71
  v_lshl_add_u32 v71, v65, 8, v71
  v_lshl_add_u32 v172, v66, 3, v71
  v_and_b32 v0, 31, v1
  v_lshlrev_b32 v0, 2, v0
  v_add_u32 v0, 18432, v0
  v_min_u32 v4, 15, v73
  v_lshlrev_b32 v4, 2, v4
  s_and_b32 s22, s17, 3
  s_lshl_b32 s22, s22, 7
  s_add_u32 s22, s22, 17408
  v_add_u32 v4, s22, v4
  v_and_b32 v64, 7, v73
  v_lshlrev_b32 v5, 4, v64
  v_lshl_add_u32 v5, v72, 7, v5
  v_lshrrev_b32 v65, 3, v73
  v_lshl_add_u32 v5, v65, 9, v5
  s_lshl_b32 s22, s17, 3
  s_add_u32 s22, s22, 18432
  v_lshl_add_u32 v7, v2, 3, s22
  v_add_u32 v65, 0, v73
  v_min_u32 v65, 27, v65
  v_mad_u32_u24 v65, v72, 28, v65
  v_lshlrev_b32 v6, 4, v65
  s_lshr_b32 s22, s17, 1
  s_mul_i32 s22, s22, 7
  s_and_b32 s34, s17, 1
  s_lshl_b32 s35, s34, 2
  v_add_u32 v70, s35, v72
  v_mov_b32 v71, s34
  v_mov_b32 v69, 0
  v_cmp_eq_u32 vcc, 3, v72
  s_nop 1
  v_cndmask_b32 v70, v70, v72, vcc
  v_cndmask_b32 v69, v69, v71, vcc
  v_add_u32 v70, s22, v70
  v_lshrrev_b32 v68, 1, v70
  v_lshlrev_b32 v68, 8, v68
  v_lshl_add_u32 v68, v69, 7, v68
  v_and_b32 v69, 1, v70
  v_lshl_add_u32 v68, v69, 3, v68
  v_lshl_add_u32 v1, v64, 4, v68
  v_cmp_gt_u32 s[26:27], 8, v73
  v_lshrrev_b32 v65, 3, v73
  v_min_u32 v66, 7, v64
  v_lshl_add_u32 v66, v66, 1, v65
  v_mad_u32_u24 v66, v72, 16, v66
  v_lshlrev_b32 v66, 4, v66
  v_add_u32 v6, 0, v66
  s_mul_i32 s22, s17, 16
  s_add_u32 s22, s22, 0
  v_lshl_add_u32 v70, v64, 1, s22
  v_lshrrev_b32 v68, 4, v70
  v_lshlrev_b32 v68, 8, v68
  v_bfe_u32 v69, v70, 1, 1
  v_lshl_add_u32 v68, v69, 7, v68
  v_bfe_u32 v69, v70, 2, 2
  v_lshl_add_u32 v68, v69, 2, v68
  v_and_b32 v69, 1, v72
  v_lshl_add_u32 v65, v69, 2, v65
  v_lshrrev_b32 v69, 1, v72
  v_lshl_add_u32 v65, v69, 1, v65
  v_lshrrev_b32 v65, 3, v73
  v_lshl_add_u32 v65, v72, 1, v65
  v_lshrrev_b32 v5, 1, v72
  v_lshlrev_b32 v5, 9, v5
  v_lshrrev_b32 v69, 2, v73
  v_lshl_add_u32 v5, v69, 7, v5
  v_and_b32 v69, 1, v72
  v_lshl_add_u32 v5, v69, 6, v5
  v_and_b32 v69, 3, v73
  v_lshl_add_u32 v5, v69, 4, v5
  v_and_b32 v69, 1, v73
  v_mul_u32_u24 v69, 0xaaaa, v69
  v_add_u32 v0, 0x4444, v69
  v_lshl_add_u32 v1, v65, 4, v68
  v_cmp_gt_u32 s[26:27], 6, v64
  v_mov_b32 v156, 0
  v_mov_b32 v157, 0
  v_mov_b32 v158, 0
  v_mov_b32 v159, 0
  ds_write_b128 v2, v[156:159] offset:0
  ds_write_b128 v2, v[156:159] offset:1024
  ds_write_b128 v2, v[156:159] offset:2048
  ds_write_b128 v2, v[156:159] offset:3072
  s_mul_i32 s22, s17, 1835008
  s_add_u32 s25, s22, 42205184
  s_lshl_b32 s35, s17, 7
  s_add_u32 s35, s35, 88539136
  s_add_u32 s39, s35, 16384
  s_mov_b32 s38, 0
  v_mov_b32 v63, 0
  v_bfe_u32 v8, v2, 4, 1
  v_mul_u32_u24 v3, 0xaaaa, v8
  v_add_u32 v3, 0x4444, v3
  v_bfe_u32 v9, v2, 5, 3
  v_lshl_add_u32 v8, v8, 3, v9
  v_and_b32 v9, 0x300, v2
  v_lshl_add_u32 v0, v8, 4, v9
  s_lshl_b32 s22, 0, 11
  s_add_u32 s22, s22, 88602624
  v_add_u32 v36, 1024, v2
  v_min_u32 v36, 1776, v36
  s_mov_b32 s30, 0
va_iw4:
  buffer_load_dwordx4 v[40:43], v2, s[8:11], s22 offen sc1
  buffer_load_dwordx4 v[44:47], v36, s[8:11], s22 offen sc1
  s_waitcnt vmcnt(0)
  v_cmp_ne_u64 vcc, s[88:89], v[40:41]
  s_cbranch_vccnz va_iw4_no
  v_cmp_ne_u64 vcc, s[88:89], v[42:43]
  s_cbranch_vccnz va_iw4_no
  v_cmp_ne_u64 vcc, s[88:89], v[44:45]
  s_cbranch_vccnz va_iw4_no
  v_cmp_ne_u64 vcc, s[88:89], v[46:47]
  s_cbranch_vccnz va_iw4_no
  s_branch va_iw4_ok
va_iw4_no:
  s_sleep 2
  s_add_u32 s30, s30, 1
  s_cmp_lt_u32 s30, 50000
  s_cbranch_scc1 va_iw4
  s_branch cA_abort
va_iw4_ok:
  s_mov_b32 s30, 0
  v_mov_b32 v36, 0
ch_md4:
  buffer_load_dword v37, v36, s[12:15], 0 offen sc1
  s_waitcnt vmcnt(0)
  v_readfirstlane_b32 s22, v37
  s_and_b32 s31, s22, 0xffff
  s_cmp_ge_u32 s31, 32
  s_cbranch_scc1 ch_go4
  s_sleep 2
  s_add_u32 s30, s30, 1
  s_cmp_lt_u32 s30, 50000
  s_cbranch_scc1 ch_md4
  s_branch ch_end
ch_go4:
  s_mov_b32 s31, 0
  v_mov_b32 v36, 0
  v_mov_b32 v37, 0
  v_mov_b32 v38, 0
  v_mov_b32 v39, 0
  v_mov_b32 v40, 0
  v_mov_b32 v41, 0
  v_mov_b32 v42, 0
  v_mov_b32 v43, 0
  v_mov_b32 v44, 0
  v_mov_b32 v45, 0
  v_mov_b32 v46, 0
  v_mov_b32 v47, 0
  v_mov_b32 v48, 0
  v_mov_b32 v49, 0
  v_mov_b32 v50, 0
  v_mov_b32 v51, 0
  v_mov_b32 v52, 0
  v_mov_b32 v53, 0
  v_mov_b32 v54, 0
  v_mov_b32 v55, 0
  v_mov_b32 v56, 0
  v_mov_b32 v57, 0
  v_mov_b32 v58, 0
  v_mov_b32 v59, 0
  s_lshr_b32 s22, s22, 16
  s_cmp_lg_u32 s22, 0
  s_cbranch_scc1 cB_va0_loop
  s_branch cA_va0_loop
ch_init5:
  s_mul_i32 s31, s17, 401408
  s_add_u32 s31, s31, 6422528
  s_lshl_b32 s22, s17, 4
  v_mov_b32 v38, s22
  v_mov_b32 v36, v38
  v_med3_u32 v37, v117, 6, 11
  v_lshrrev_b32 v36, 6, v36
  v_lshlrev_b32 v36, 8, v36
  v_lshl_add_u32 v36, v37, 4, v36
  s_mov_b32 s22, 88600576
  s_mov_b32 s30, 0
va_bw_13:
  buffer_load_dwordx4 v[40:43], v36, s[8:11], s22 offen sc1
  s_waitcnt vmcnt(0)
  v_cmp_ne_u64 vcc, s[88:89], v[40:41]
  s_cbranch_vccnz va_bw_13_no
  v_cmp_ne_u64 vcc, s[88:89], v[42:43]
  s_cbranch_vccnz va_bw_13_no
  s_branch va_bw_13_ok
va_bw_13_no:
  s_sleep 2
  s_add_u32 s30, s30, 1
  s_cmp_lt_u32 s30, 50000
  s_cbranch_scc1 va_bw_13
  s_branch cA_abort
va_bw_13_ok:
  s_add_u32 s22, s31, 86016
  buffer_load_dwordx4 a[0:3], v2, s[8:11], s22 offen offset:0 sc1
  buffer_load_dwordx4 a[4:7], v2, s[8:11], s22 offen offset:1024 sc1
  buffer_load_dwordx4 a[8:11], v2, s[8:11], s22 offen offset:2048 sc1
  buffer_load_dwordx4 a[12:15], v2, s[8:11], s22 offen offset:3072 sc1
  s_add_u32 s22, s31, 90112
  buffer_load_dwordx4 a[16:19], v2, s[8:11], s22 offen offset:0 sc1
  buffer_load_dwordx4 a[20:23], v2, s[8:11], s22 offen offset:1024 sc1
  buffer_load_dwordx4 a[24:27], v2, s[8:11], s22 offen offset:2048 sc1
  buffer_load_dwordx4 a[28:31], v2, s[8:11], s22 offen offset:3072 sc1
  s_add_u32 s22, s31, 94208
  buffer_load_dwordx4 a[32:35], v2, s[8:11], s22 offen offset:0 sc1
  buffer_load_dwordx4 a[36:39], v2, s[8:11], s22 offen offset:1024 sc1
  buffer_load_dwordx4 a[40:43], v2, s[8:11], s22 offen offset:2048 sc1
  buffer_load_dwordx4 a[44:47], v2, s[8:11], s22 offen offset:3072 sc1
  s_add_u32 s22, s31, 98304
  buffer_load_dwordx4 a[48:51], v2, s[8:11], s22 offen offset:0 sc1
  buffer_load_dwordx4 a[52:55], v2, s[8:11], s22 offen offset:1024 sc1
  buffer_load_dwordx4 a[56:59], v2, s[8:11], s22 offen offset:2048 sc1
  buffer_load_dwordx4 a[60:63], v2, s[8:11], s22 offen offset:3072 sc1
  s_add_u32 s22, s31, 102400
  buffer_load_dwordx4 a[64:67], v2, s[8:11], s22 offen offset:0 sc1
  buffer_load_dwordx4 a[68:71], v2, s[8:11], s22 offen offset:1024 sc1
  buffer_load_dwordx4 a[72:75], v2, s[8:11], s22 offen offset:2048 sc1
  buffer_load_dwordx4 a[76:79], v2, s[8:11], s22 offen offset:3072 sc1
  s_add_u32 s22, s31, 106496
  buffer_load_dwordx4 a[80:83], v2, s[8:11], s22 offen offset:0 sc1
  buffer_load_dwordx4 a[84:87], v2, s[8:11], s22 offen offset:1024 sc1
  buffer_load_dwordx4 a[88:91], v2, s[8:11], s22 offen offset:2048 sc1
  buffer_load_dwordx4 a[92:95], v2, s[8:11], s22 offen offset:3072 sc1
  s_add_u32 s22, s31, 110592
  buffer_load_dwordx4 a[96:99], v2, s[8:11], s22 offen offset:0 sc1
  buffer_load_dwordx4 a[100:103], v2, s[8:11], s22 offen offset:1024 sc1
  buffer_load_dwordx4 a[104:107], v2, s[8:11], s22 offen offset:2048 sc1
  buffer_load_dwordx4 a[108:111], v2, s[8:11], s22 offen offset:3072 sc1
  s_add_u32 s22, s31, 114688
  buffer_load_dwordx4 a[112:115], v2, s[8:11], s22 offen offset:0 sc1
  buffer_load_dwordx4 a[116:119], v2, s[8:11], s22 offen offset:1024 sc1
  buffer_load_dwordx4 a[120:123], v2, s[8:11], s22 offen offset:2048 sc1
  buffer_load_dwordx4 a[124:127], v2, s[8:11], s22 offen offset:3072 sc1
  s_waitcnt vmcnt(24)
  s_add_u32 s22, s31, 118784
  buffer_load_dwordx4 a[128:131], v2, s[8:11], s22 offen offset:0 sc1
  buffer_load_dwordx4 a[132:135], v2, s[8:11], s22 offen offset:1024 sc1
  buffer_load_dwordx4 a[136:139], v2, s[8:11], s22 offen offset:2048 sc1
  buffer_load_dwordx4 a[140:143], v2, s[8:11], s22 offen offset:3072 sc1
  s_add_u32 s22, s31, 122880
  buffer_load_dwordx4 a[144:147], v2, s[8:11], s22 offen offset:0 sc1
  buffer_load_dwordx4 a[148:151], v2, s[8:11], s22 offen offset:1024 sc1
  buffer_load_dwordx4 a[152:155], v2, s[8:11], s22 offen offset:2048 sc1
  buffer_load_dwordx4 a[156:159], v2, s[8:11], s22 offen offset:3072 sc1
  s_add_u32 s22, s31, 126976
  buffer_load_dwordx4 a[160:163], v2, s[8:11], s22 offen offset:0 sc1
  buffer_load_dwordx4 a[164:167], v2, s[8:11], s22 offen offset:1024 sc1
  buffer_load_dwordx4 a[168:171], v2, s[8:11], s22 offen offset:2048 sc1
  buffer_load_dwordx4 a[172:175], v2, s[8:11], s22 offen offset:3072 sc1
  s_add_u32 s22, s31, 131072
  buffer_load_dwordx4 a[176:179], v2, s[8:11], s22 offen offset:0 sc1
  buffer_load_dwordx4 a[180:183], v2, s[8:11], s22 offen offset:1024 sc1
  buffer_load_dwordx4 a[184:187], v2, s[8:11], s22 offen offset:2048 sc1
  buffer_load_dwordx4 a[188:191], v2, s[8:11], s22 offen offset:3072 sc1
  s_add_u32 s22, s31, 135168
  buffer_load_dwordx4 a[192:195], v2, s[8:11], s22 offen offset:0 sc1
  buffer_load_dwordx4 a[196:199], v2, s[8:11], s22 offen offset:1024 sc1
  buffer_load_dwordx4 a[200:203], v2, s[8:11], s22 offen offset:2048 sc1
  buffer_load_dwordx4 a[204:207], v2, s[8:11], s22 offen offset:3072 sc1
  s_add_u32 s22, s31, 139264
  buffer_load_dwordx4 a[208:211], v2, s[8:11], s22 offen offset:0 sc1
  buffer_load_dwordx4 a[212:215], v2, s[8:11], s22 offen offset:1024 sc1
  buffer_load_dwordx4 a[216:219], v2, s[8:11], s22 offen offset:2048 sc1
  buffer_load_dwordx4 a[220:223], v2, s[8:11], s22 offen offset:3072 sc1
  s_add_u32 s22, s31, 143360
  buffer_load_dwordx4 a[224:227], v2, s[8:11], s22 offen offset:0 sc1
  buffer_load_dwordx4 a[228:231], v2, s[8:11], s22 offen offset:1024 sc1
  buffer_load_dwordx4 a[232:235], v2, s[8:11], s22 offen offset:2048 sc1
  buffer_load_dwordx4 a[236:239], v2, s[8:11], s22 offen offset:3072 sc1
  s_add_u32 s22, s31, 147456
  buffer_load_dwordx4 a[240:243], v2, s[8:11], s22 offen offset:0 sc1
  buffer_load_dwordx4 a[244:247], v2, s[8:11], s22 offen offset:1024 sc1
  buffer_load_dwordx4 a[248:251], v2, s[8:11], s22 offen offset:2048 sc1
  buffer_load_dwordx4 a[252:255], v2, s[8:11], s22 offen offset:3072 sc1
  s_waitcnt vmcnt(24)
  s_add_u32 s22, s31, 151552
  buffer_load_dwordx4 v[176:179], v2, s[8:11], s22 offen offset:0 sc1
  buffer_load_dwordx4 v[180:183], v2, s[8:11], s22 offen offset:1024 sc1
  buffer_load_dwordx4 v[184:187], v2, s[8:11], s22 offen offset:2048 sc1
  buffer_load_dwordx4 v[188:191], v2, s[8:11], s22 offen offset:3072 sc1
  s_add_u32 s22, s31, 155648
  buffer_load_dwordx4 v[192:195], v2, s[8:11], s22 offen offset:0 sc1
  buffer_load_dwordx4 v[196:199], v2, s[8:11], s22 offen offset:1024 sc1
  buffer_load_dwordx4 v[200:203], v2, s[8:11], s22 offen offset:2048 sc1
  buffer_load_dwordx4 v[204:207], v2, s[8:11], s22 offen offset:3072 sc1
  s_add_u32 s22, s31, 159744
  buffer_load_dwordx4 v[208:211], v2, s[8:11], s22 offen offset:0 sc1
  buffer_load_dwordx4 v[212:215], v2, s[8:11], s22 offen offset:1024 sc1
  buffer_load_dwordx4 v[216:219], v2, s[8:11], s22 offen offset:2048 sc1
  buffer_load_dwordx4 v[220:223], v2, s[8:11], s22 offen offset:3072 sc1
  s_add_u32 s22, s31, 163840
  buffer_load_dwordx4 v[224:227], v2, s[8:11], s22 offen offset:0 sc1
  buffer_load_dwordx4 v[228:231], v2, s[8:11], s22 offen offset:1024 sc1
  buffer_load_dwordx4 v[232:235], v2, s[8:11], s22 offen offset:2048 sc1
  buffer_load_dwordx4 v[236:239], v2, s[8:11], s22 offen offset:3072 sc1
  s_add_u32 s22, s31, 167936
  buffer_load_dwordx4 v[240:243], v2, s[8:11], s22 offen offset:0 sc1
  buffer_load_dwordx4 v[244:247], v2, s[8:11], s22 offen offset:1024 sc1
  buffer_load_dwordx4 v[248:251], v2, s[8:11], s22 offen offset:2048 sc1
  buffer_load_dwordx4 v[252:255], v2, s[8:11], s22 offen offset:3072 sc1
  s_lshl_b32 s22, s17, 4
  v_mov_b32 v38, s22
  s_mul_i32 s22, s17, 12
  s_add_u32 s23, s22, 267
  s_add_u32 s22, s22, 256
  v_mov_b32 v36, s23
  v_mov_b32 v37, s22
  v_cmp_eq_u32 vcc, 1, v116
  s_nop 1
  v_cndmask_b32 v36, v36, v37, vcc
  v_med3_u32 v37, v117, 14, 15
  v_lshrrev_b32 v36, 6, v36
  v_lshlrev_b32 v36, 8, v36
  v_lshl_add_u32 v36, v37, 4, v36
  s_mov_b32 s22, 88600576
  s_mov_b32 s30, 0
va_bw_14:
  buffer_load_dwordx4 v[40:43], v36, s[8:11], s22 offen sc1
  s_waitcnt vmcnt(0)
  v_cmp_ne_u64 vcc, s[88:89], v[40:41]
  s_cbranch_vccnz va_bw_14_no
  v_cmp_ne_u64 vcc, s[88:89], v[42:43]
  s_cbranch_vccnz va_bw_14_no
  s_branch va_bw_14_ok
va_bw_14_no:
  s_sleep 2
  s_add_u32 s30, s30, 1
  s_cmp_lt_u32 s30, 50000
  s_cbranch_scc1 va_bw_14
  s_branch cA_abort
va_bw_14_ok:
  s_mov_b32 m0, 59392
  s_add_u32 s22, s31, 387072
  buffer_load_dwordx4 v2, s[8:11], s22 offen offset:0 sc1 lds
  buffer_load_dwordx4 v2, s[8:11], s22 offen offset:1024 sc1 lds
  buffer_load_dwordx4 v2, s[8:11], s22 offen offset:2048 sc1 lds
  buffer_load_dwordx4 v2, s[8:11], s22 offen offset:3072 sc1 lds
  s_mov_b32 m0, 63488
  s_add_u32 s22, s31, 391168
  buffer_load_dwordx4 v2, s[8:11], s22 offen offset:0 sc1 lds
  buffer_load_dwordx4 v2, s[8:11], s22 offen offset:1024 sc1 lds
  buffer_load_dwordx4 v2, s[8:11], s22 offen offset:2048 sc1 lds
  buffer_load_dwordx4 v2, s[8:11], s22 offen offset:3072 sc1 lds
  s_mov_b32 m0, 67584
  s_add_u32 s22, s31, 395264
  buffer_load_dwordx4 v2, s[8:11], s22 offen offset:0 sc1 lds
  buffer_load_dwordx4 v2, s[8:11], s22 offen offset:1024 sc1 lds
  buffer_load_dwordx4 v2, s[8:11], s22 offen offset:2048 sc1 lds
  buffer_load_dwordx4 v2, s[8:11], s22 offen offset:3072 sc1 lds
  s_mov_b32 m0, 71680
  s_add_u32 s22, s31, 399360
  buffer_load_dwordx4 v2, s[8:11], s22 offen offset:0 sc1 lds
  buffer_load_dwordx4 v2, s[8:11], s22 offen offset:1024 sc1 lds
  v_mov_b32 v72, v116
  v_mov_b32 v73, v117
  v_lshrrev_b32 v65, 1, v72
  v_and_b32 v66, 1, v72
  v_mov_b32 v68, 6
  v_mov_b32 v69, v73
  v_mov_b32 v70, 0
  v_and_b32 v71, 1, v69
  v_lshrrev_b32 v69, 1, v69
  v_lshl_add_u32 v69, v71, 3, v69
  v_lshlrev_b32 v71, 12, v70
  v_lshrrev_b32 v70, 1, v68
  v_lshl_add_u32 v71, v70, 9, v71
  v_and_b32 v70, 1, v68
  v_lshl_add_u32 v71, v70, 2, v71
  v_lshl_add_u32 v71, v69, 4, v71
  v_lshl_add_u32 v71, v65, 8, v71
  v_lshl_add_u32 v60, v66, 3, v71
  v_mov_b32 v68, 7
  v_mov_b32 v69, v73
  v_mov_b32 v70, 0
  v_and_b32 v71, 1, v69
  v_lshrrev_b32 v69, 1, v69
  v_lshl_add_u32 v69, v71, 3, v69
  v_lshlrev_b32 v71, 12, v70
  v_lshrrev_b32 v70, 1, v68
  v_lshl_add_u32 v71, v70, 9, v71
  v_and_b32 v70, 1, v68
  v_lshl_add_u32 v71, v70, 2, v71
  v_lshl_add_u32 v71, v69, 4, v71
  v_lshl_add_u32 v71, v65, 8, v71
  v_lshl_add_u32 v61, v66, 3, v71
  v_mov_b32 v68, 8
  v_mov_b32 v69, v73
  v_mov_b32 v70, 0
  v_and_b32 v71, 1, v69
  v_lshrrev_b32 v69, 1, v69
  v_lshl_add_u32 v69, v71, 3, v69
  v_lshlrev_b32 v71, 12, v70
  v_lshrrev_b32 v70, 1, v68
  v_lshl_add_u32 v71, v70, 9, v71
  v_and_b32 v70, 1, v68
  v_lshl_add_u32 v71, v70, 2, v71
  v_lshl_add_u32 v71, v69, 4, v71
  v_lshl_add_u32 v71, v65, 8, v71
  v_lshl_add_u32 v62, v66, 3, v71
  v_mov_b32 v68, 9
  v_mov_b32 v69, v73
  v_mov_b32 v70, 0
  v_and_b32 v71, 1, v69
  v_lshrrev_b32 v69, 1, v69
  v_lshl_add_u32 v69, v71, 3, v69
  v_lshlrev_b32 v71, 12, v70
  v_lshrrev_b32 v70, 1, v68
  v_lshl_add_u32 v71, v70, 9, v71
  v_and_b32 v70, 1, v68
  v_lshl_add_u32 v71, v70, 2, v71
  v_lshl_add_u32 v71, v69, 4, v71
  v_lshl_add_u32 v71, v65, 8, v71
  v_lshl_add_u32 v170, v66, 3, v71
  v_mov_b32 v68, 10
  v_mov_b32 v69, v73
  v_mov_b32 v70, 0
  v_and_b32 v71, 1, v69
  v_lshrrev_b32 v69, 1, v69
  v_lshl_add_u32 v69, v71, 3, v69
  v_lshlrev_b32 v71, 12, v70
  v_lshrrev_b32 v70, 1, v68
  v_lshl_add_u32 v71, v70, 9, v71
  v_and_b32 v70, 1, v68
  v_lshl_add_u32 v71, v70, 2, v71
  v_lshl_add_u32 v71, v69, 4, v71
  v_lshl_add_u32 v71, v65, 8, v71
  v_lshl_add_u32 v171, v66, 3, v71
  v_mov_b32 v68, 11
  v_mov_b32 v69, v73
  v_mov_b32 v70, 0
  v_and_b32 v71, 1, v69
  v_lshrrev_b32 v69, 1, v69
  v_lshl_add_u32 v69, v71, 3, v69
  v_lshlrev_b32 v71, 12, v70
  v_lshrrev_b32 v70, 1, v68
  v_lshl_add_u32 v71, v70, 9, v71
  v_and_b32 v70, 1, v68
  v_lshl_add_u32 v71, v70, 2, v71
  v_lshl_add_u32 v71, v69, 4, v71
  v_lshl_add_u32 v71, v65, 8, v71
  v_lshl_add_u32 v172, v66, 3, v71
  v_and_b32 v0, 31, v1
  v_lshlrev_b32 v0, 2, v0
  v_add_u32 v0, 18432, v0
  v_min_u32 v4, 15, v73
  v_lshlrev_b32 v4, 2, v4
  s_and_b32 s22, s17, 3
  s_lshl_b32 s22, s22, 7
  s_add_u32 s22, s22, 17408
  v_add_u32 v4, s22, v4
  v_and_b32 v64, 7, v73
  v_lshlrev_b32 v5, 4, v64
  v_lshl_add_u32 v5, v72, 7, v5
  v_lshrrev_b32 v65, 3, v73
  v_lshl_add_u32 v5, v65, 9, v5
  s_lshl_b32 s22, s17, 3
  s_add_u32 s22, s22, 17924
  v_mov_b32 v7, s22
  v_add_u32 v65, 16, v73
  v_min_u32 v65, 27, v65
  v_mad_u32_u24 v65, v72, 28, v65
  v_lshlrev_b32 v6, 4, v65
  s_lshr_b32 s22, s17, 1
  s_mul_i32 s22, s22, 7
  s_and_b32 s34, s17, 1
  s_lshl_b32 s35, s34, 2
  v_add_u32 v70, s35, v72
  v_mov_b32 v71, s34
  v_mov_b32 v69, 1
  v_cmp_eq_u32 vcc, 3, v72
  s_nop 1
  v_cndmask_b32 v70, v70, v72, vcc
  v_cndmask_b32 v69, v69, v71, vcc
  v_add_u32 v70, s22, v70
  v_lshrrev_b32 v68, 1, v70
  v_lshlrev_b32 v68, 8, v68
  v_lshl_add_u32 v68, v69, 7, v68
  v_and_b32 v69, 1, v70
  v_lshl_add_u32 v68, v69, 3, v68
  v_lshl_add_u32 v1, v64, 4, v68
  v_cmp_gt_u32 s[26:27], 8, v73
  v_cmp_gt_u32 vcc, 3, v72
  s_and_b64 s[26:27], s[26:27], vcc
  v_lshrrev_b32 v65, 3, v73
  v_min_u32 v66, 5, v64
  v_lshl_add_u32 v66, v66, 1, v65
  v_mad_u32_u24 v66, v72, 12, v66
  v_lshlrev_b32 v66, 4, v66
  v_add_u32 v6, 1024, v66
  s_mul_i32 s22, s17, 12
  s_add_u32 s22, s22, 256
  v_lshl_add_u32 v70, v64, 1, s22
  v_lshrrev_b32 v68, 4, v70
  v_lshlrev_b32 v68, 8, v68
  v_bfe_u32 v69, v70, 1, 1
  v_lshl_add_u32 v68, v69, 7, v68
  v_bfe_u32 v69, v70, 2, 2
  v_lshl_add_u32 v68, v69, 2, v68
  v_and_b32 v69, 1, v72
  v_lshl_add_u32 v65, v69, 2, v65
  v_lshrrev_b32 v69, 1, v72
  v_lshl_add_u32 v65, v69, 1, v65
  v_lshrrev_b32 v65, 3, v73
  v_lshl_add_u32 v65, v72, 1, v65
  v_lshrrev_b32 v5, 1, v72
  v_lshlrev_b32 v5, 9, v5
  v_lshrrev_b32 v69, 2, v73
  v_lshl_add_u32 v5, v69, 7, v5
  v_and_b32 v69, 1, v72
  v_lshl_add_u32 v5, v69, 6, v5
  v_and_b32 v69, 3, v73
  v_lshl_add_u32 v5, v69, 4, v5
  v_and_b32 v69, 1, v73
  v_mul_u32_u24 v69, 0xaaaa, v69
  v_add_u32 v0, 0x4444, v69
  v_lshl_add_u32 v1, v65, 4, v68
  v_cmp_gt_u32 s[26:27], 6, v64
  v_mov_b32 v156, 0
  v_mov_b32 v157, 0
  v_mov_b32 v158, 0
  v_mov_b32 v159, 0
  ds_write_b128 v2, v[156:159] offset:4096
  ds_write_b128 v2, v[156:159] offset:5120
  ds_write_b128 v2, v[156:159] offset:6144
  ds_write_b128 v2, v[156:159] offset:7168
  s_mul_i32 s22, s17, 1835008
  s_add_u32 s25, s22, 42205184
  s_lshl_b32 s35, s17, 7
  s_add_u32 s35, s35, 88539136
  s_add_u32 s39, s35, 16384
  s_mov_b32 s38, 0
  v_mov_b32 v63, 0
  v_bfe_u32 v8, v2, 4, 1
  v_mul_u32_u24 v3, 0xaaaa, v8
  v_add_u32 v3, 0x4444, v3
  v_bfe_u32 v9, v2, 5, 3
  v_lshl_add_u32 v8, v8, 3, v9
  v_and_b32 v9, 0x300, v2
  v_lshl_add_u32 v0, v8, 4, v9
  s_lshl_b32 s22, 0, 11
  s_add_u32 s22, s22, 88602624
  v_add_u32 v36, 1024, v2
  v_min_u32 v36, 1776, v36
  s_mov_b32 s30, 0
va_iw5:
  buffer_load_dwordx4 v[40:43], v2, s[8:11], s22 offen sc1
  buffer_load_dwordx4 v[44:47], v36, s[8:11], s22 offen sc1
  s_waitcnt vmcnt(0)
  v_cmp_ne_u64 vcc, s[88:89], v[40:41]
  s_cbranch_vccnz va_iw5_no
  v_cmp_ne_u64 vcc, s[88:89], v[42:43]
  s_cbranch_vccnz va_iw5_no
  v_cmp_ne_u64 vcc, s[88:89], v[44:45]
  s_cbranch_vccnz va_iw5_no
  v_cmp_ne_u64 vcc, s[88:89], v[46:47]
  s_cbranch_vccnz va_iw5_no
  s_branch va_iw5_ok
va_iw5_no:
  s_sleep 2
  s_add_u32 s30, s30, 1
  s_cmp_lt_u32 s30, 50000
  s_cbranch_scc1 va_iw5
  s_branch cA_abort
va_iw5_ok:
  s_mov_b32 s30, 0
  v_mov_b32 v36, 0
ch_md5:
  buffer_load_dword v37, v36, s[12:15], 0 offen sc1
  s_waitcnt vmcnt(0)
  v_readfirstlane_b32 s22, v37
  s_and_b32 s31, s22, 0xffff
  s_cmp_ge_u32 s31, 32
  s_cbranch_scc1 ch_go5
  s_sleep 2
  s_add_u32 s30, s30, 1
  s_cmp_lt_u32 s30, 50000
  s_cbranch_scc1 ch_md5
  s_branch ch_end
ch_go5:
  s_mov_b32 s31, 0
  v_mov_b32 v36, 0
  v_mov_b32 v37, 0
  v_mov_b32 v38, 0
  v_mov_b32 v39, 0
  v_mov_b32 v40, 0
  v_mov_b32 v41, 0
  v_mov_b32 v42, 0
  v_mov_b32 v43, 0
  v_mov_b32 v44, 0
  v_mov_b32 v45, 0
  v_mov_b32 v46, 0
  v_mov_b32 v47, 0
  v_mov_b32 v48, 0
  v_mov_b32 v49, 0
  v_mov_b32 v50, 0
  v_mov_b32 v51, 0
  v_mov_b32 v52, 0
  v_mov_b32 v53, 0
  v_mov_b32 v54, 0
  v_mov_b32 v55, 0
  v_mov_b32 v56, 0
  v_mov_b32 v57, 0
  v_mov_b32 v58, 0
  v_mov_b32 v59, 0
  s_lshr_b32 s22, s22, 16
  s_cmp_lg_u32 s22, 0
  s_cbranch_scc1 cB_va1_loop
  s_branch cA_va1_loop
ch_init6:
  s_mul_i32 s31, s17, 401408
  s_add_u32 s31, s31, 6422528
  s_lshl_b32 s22, s17, 4
  v_mov_b32 v38, s22
  s_mul_i32 s22, s17, 12
  s_add_u32 s23, s22, 267
  s_add_u32 s22, s22, 256
  v_mov_b32 v36, s23
  v_mov_b32 v37, s22
  v_cmp_eq_u32 vcc, 1, v116
  s_nop 1
  v_cndmask_b32 v36, v36, v37, vcc
  v_med3_u32 v37, v117, 0, 3
  v_med3_u32 v39, v117, 12, 15
  v_cmp_eq_u32 vcc, 0, v116
  s_nop 1
  v_cndmask_b32 v36, v36, v38, vcc
  v_cndmask_b32 v37, v37, v39, vcc
  v_lshrrev_b32 v36, 6, v36
  v_lshlrev_b32 v36, 8, v36
  v_lshl_add_u32 v36, v37, 4, v36
  s_mov_b32 s22, 88600576
  s_mov_b32 s30, 0
va_bw_15:
  buffer_load_dwordx4 v[40:43], v36, s[8:11], s22 offen sc1
  s_waitcnt vmcnt(0)
  v_cmp_ne_u64 vcc, s[88:89], v[40:41]
  s_cbranch_vccnz va_bw_15_no
  v_cmp_ne_u64 vcc, s[88:89], v[42:43]
  s_cbranch_vccnz va_bw_15_no
  s_branch va_bw_15_ok
va_bw_15_no:
  s_sleep 2
  s_add_u32 s30, s30, 1
  s_cmp_lt_u32 s30, 50000
  s_cbranch_scc1 va_bw_15
  s_branch cA_abort
va_bw_15_ok:
  s_add_u32 s22, s31, 172032
  buffer_load_dwordx4 a[0:3], v2, s[8:11], s22 offen offset:0 sc1
  buffer_load_dwordx4 a[4:7], v2, s[8:11], s22 offen offset:1024 sc1
  buffer_load_dwordx4 a[8:11], v2, s[8:11], s22 offen offset:2048 sc1
  buffer_load_dwordx4 a[12:15], v2, s[8:11], s22 offen offset:3072 sc1
  s_add_u32 s22, s31, 176128
  buffer_load_dwordx4 a[16:19], v2, s[8:11], s22 offen offset:0 sc1
  buffer_load_dwordx4 a[20:23], v2, s[8:11], s22 offen offset:1024 sc1
  buffer_load_dwordx4 a[24:27], v2, s[8:11], s22 offen offset:2048 sc1
  buffer_load_dwordx4 a[28:31], v2, s[8:11], s22 offen offset:3072 sc1
  s_add_u32 s22, s31, 180224
  buffer_load_dwordx4 a[32:35], v2, s[8:11], s22 offen offset:0 sc1
  buffer_load_dwordx4 a[36:39], v2, s[8:11], s22 offen offset:1024 sc1
  buffer_load_dwordx4 a[40:43], v2, s[8:11], s22 offen offset:2048 sc1
  buffer_load_dwordx4 a[44:47], v2, s[8:11], s22 offen offset:3072 sc1
  s_add_u32 s22, s31, 184320
  buffer_load_dwordx4 a[48:51], v2, s[8:11], s22 offen offset:0 sc1
  buffer_load_dwordx4 a[52:55], v2, s[8:11], s22 offen offset:1024 sc1
  buffer_load_dwordx4 a[56:59], v2, s[8:11], s22 offen offset:2048 sc1
  buffer_load_dwordx4 a[60:63], v2, s[8:11], s22 offen offset:3072 sc1
  s_add_u32 s22, s31, 188416
  buffer_load_dwordx4 a[64:67], v2, s[8:11], s22 offen offset:0 sc1
  buffer_load_dwordx4 a[68:71], v2, s[8:11], s22 offen offset:1024 sc1
  buffer_load_dwordx4 a[72:75], v2, s[8:11], s22 offen offset:2048 sc1
  buffer_load_dwordx4 a[76:79], v2, s[8:11], s22 offen offset:3072 sc1
  s_add_u32 s22, s31, 192512
  buffer_load_dwordx4 a[80:83], v2, s[8:11], s22 offen offset:0 sc1
  buffer_load_dwordx4 a[84:87], v2, s[8:11], s22 offen offset:1024 sc1
  buffer_load_dwordx4 a[88:91], v2, s[8:11], s22 offen offset:2048 sc1
  buffer_load_dwordx4 a[92:95], v2, s[8:11], s22 offen offset:3072 sc1
  s_add_u32 s22, s31, 196608
  buffer_load_dwordx4 a[96:99], v2, s[8:11], s22 offen offset:0 sc1
  buffer_load_dwordx4 a[100:103], v2, s[8:11], s22 offen offset:1024 sc1
  buffer_load_dwordx4 a[104:107], v2, s[8:11], s22 offen offset:2048 sc1
  buffer_load_dwordx4 a[108:111], v2, s[8:11], s22 offen offset:3072 sc1
  s_add_u32 s22, s31, 200704
  buffer_load_dwordx4 a[112:115], v2, s[8:11], s22 offen offset:0 sc1
  buffer_load_dwordx4 a[116:119], v2, s[8:11], s22 offen offset:1024 sc1
  buffer_load_dwordx4 a[120:123], v2, s[8:11], s22 offen offset:2048 sc1
  buffer_load_dwordx4 a[124:127], v2, s[8:11], s22 offen offset:3072 sc1
  s_waitcnt vmcnt(24)
  s_add_u32 s22, s31, 204800
  buffer_load_dwordx4 a[128:131], v2, s[8:11], s22 offen offset:0 sc1
  buffer_load_dwordx4 a[132:135], v2, s[8:11], s22 offen offset:1024 sc1
  buffer_load_dwordx4 a[136:139], v2, s[8:11], s22 offen offset:2048 sc1
  buffer_load_dwordx4 a[140:143], v2, s[8:11], s22 offen offset:3072 sc1
  s_add_u32 s22, s31, 208896
  buffer_load_dwordx4 a[144:147], v2, s[8:11], s22 offen offset:0 sc1
  buffer_load_dwordx4 a[148:151], v2, s[8:11], s22 offen offset:1024 sc1
  buffer_load_dwordx4 a[152:155], v2, s[8:11], s22 offen offset:2048 sc1
  buffer_load_dwordx4 a[156:159], v2, s[8:11], s22 offen offset:3072 sc1
  s_add_u32 s22, s31, 212992
  buffer_load_dwordx4 a[160:163], v2, s[8:11], s22 offen offset:0 sc1
  buffer_load_dwordx4 a[164:167], v2, s[8:11], s22 offen offset:1024 sc1
  buffer_load_dwordx4 a[168:171], v2, s[8:11], s22 offen offset:2048 sc1
  buffer_load_dwordx4 a[172:175], v2, s[8:11], s22 offen offset:3072 sc1
  s_add_u32 s22, s31, 217088
  buffer_load_dwordx4 a[176:179], v2, s[8:11], s22 offen offset:0 sc1
  buffer_load_dwordx4 a[180:183], v2, s[8:11], s22 offen offset:1024 sc1
  buffer_load_dwordx4 a[184:187], v2, s[8:11], s22 offen offset:2048 sc1
  buffer_load_dwordx4 a[188:191], v2, s[8:11], s22 offen offset:3072 sc1
  s_add_u32 s22, s31, 221184
  buffer_load_dwordx4 a[192:195], v2, s[8:11], s22 offen offset:0 sc1
  buffer_load_dwordx4 a[196:199], v2, s[8:11], s22 offen offset:1024 sc1
  buffer_load_dwordx4 a[200:203], v2, s[8:11], s22 offen offset:2048 sc1
  buffer_load_dwordx4 a[204:207], v2, s[8:11], s22 offen offset:3072 sc1
  s_add_u32 s22, s31, 225280
  buffer_load_dwordx4 a[208:211], v2, s[8:11], s22 offen offset:0 sc1
  buffer_load_dwordx4 a[212:215], v2, s[8:11], s22 offen offset:1024 sc1
  buffer_load_dwordx4 a[216:219], v2, s[8:11], s22 offen offset:2048 sc1
  buffer_load_dwordx4 a[220:223], v2, s[8:11], s22 offen offset:3072 sc1
  s_add_u32 s22, s31, 229376
  buffer_load_dwordx4 a[224:227], v2, s[8:11], s22 offen offset:0 sc1
  buffer_load_dwordx4 a[228:231], v2, s[8:11], s22 offen offset:1024 sc1
  buffer_load_dwordx4 a[232:235], v2, s[8:11], s22 offen offset:2048 sc1
  buffer_load_dwordx4 a[236:239], v2, s[8:11], s22 offen offset:3072 sc1
  s_add_u32 s22, s31, 233472
  buffer_load_dwordx4 a[240:243], v2, s[8:11], s22 offen offset:0 sc1
  buffer_load_dwordx4 a[244:247], v2, s[8:11], s22 offen offset:1024 sc1
  buffer_load_dwordx4 a[248:251], v2, s[8:11], s22 offen offset:2048 sc1
  buffer_load_dwordx4 a[252:255], v2, s[8:11], s22 offen offset:3072 sc1
  s_waitcnt vmcnt(24)
  s_add_u32 s22, s31, 237568
  buffer_load_dwordx4 v[120:123], v2, s[8:11], s22 offen offset:0 sc1
  buffer_load_dwordx4 v[124:127], v2, s[8:11], s22 offen offset:1024 sc1
  buffer_load_dwordx4 v[128:131], v2, s[8:11], s22 offen offset:2048 sc1
  buffer_load_dwordx4 v[132:135], v2, s[8:11], s22 offen offset:3072 sc1
  s_add_u32 s22, s31, 241664
  buffer_load_dwordx4 v[136:139], v2, s[8:11], s22 offen offset:0 sc1
  buffer_load_dwordx4 v[140:143], v2, s[8:11], s22 offen offset:1024 sc1
  buffer_load_dwordx4 v[144:147], v2, s[8:11], s22 offen offset:2048 sc1
  buffer_load_dwordx4 v[148:151], v2, s[8:11], s22 offen offset:3072 sc1
  s_add_u32 s22, s31, 245760
  buffer_load_dwordx4 v[152:155], v2, s[8:11], s22 offen offset:0 sc1
  buffer_load_dwordx4 v[156:159], v2, s[8:11], s22 offen offset:1024 sc1
  buffer_load_dwordx4 v[160:163], v2, s[8:11], s22 offen offset:2048 sc1
  buffer_load_dwordx4 v[164:167], v2, s[8:11], s22 offen offset:3072 sc1
  s_add_u32 s22, s31, 249856
  buffer_load_dwordx4 v[168:171], v2, s[8:11], s22 offen offset:0 sc1
  buffer_load_dwordx4 v[172:175], v2, s[8:11], s22 offen offset:1024 sc1
  buffer_load_dwordx4 v[176:179], v2, s[8:11], s22 offen offset:2048 sc1
  buffer_load_dwordx4 v[180:183], v2, s[8:11], s22 offen offset:3072 sc1
  s_add_u32 s22, s31, 253952
  buffer_load_dwordx4 v[184:187], v2, s[8:11], s22 offen offset:0 sc1
  buffer_load_dwordx4 v[188:191], v2, s[8:11], s22 offen offset:1024 sc1
  buffer_load_dwordx4 v[192:195], v2, s[8:11], s22 offen offset:2048 sc1
  buffer_load_dwordx4 v[196:199], v2, s[8:11], s22 offen offset:3072 sc1
  s_add_u32 s22, s31, 258048
  buffer_load_dwordx4 v[200:203], v2, s[8:11], s22 offen offset:0 sc1
  buffer_load_dwordx4 v[204:207], v2, s[8:11], s22 offen offset:1024 sc1
  buffer_load_dwordx4 v[208:211], v2, s[8:11], s22 offen offset:2048 sc1
  buffer_load_dwordx4 v[212:215], v2, s[8:11], s22 offen offset:3072 sc1
  s_add_u32 s22, s31, 262144
  buffer_load_dwordx4 v[216:219], v2, s[8:11], s22 offen offset:0 sc1
  buffer_load_dwordx4 v[220:223], v2, s[8:11], s22 offen offset:1024 sc1
  buffer_load_dwordx4 v[224:227], v2, s[8:11], s22 offen offset:2048 sc1
  buffer_load_dwordx4 v[228:231], v2, s[8:11], s22 offen offset:3072 sc1
  s_add_u32 s22, s31, 266240
  buffer_load_dwordx4 v[232:235], v2, s[8:11], s22 offen offset:0 sc1
  buffer_load_dwordx4 v[236:239], v2, s[8:11], s22 offen offset:1024 sc1
  buffer_load_dwordx4 v[240:243], v2, s[8:11], s22 offen offset:2048 sc1
  buffer_load_dwordx4 v[244:247], v2, s[8:11], s22 offen offset:3072 sc1
  s_waitcnt vmcnt(24)
  s_add_u32 s22, s31, 270336
  buffer_load_dwordx4 v[248:251], v2, s[8:11], s22 offen offset:0 sc1
  buffer_load_dwordx4 v[252:255], v2, s[8:11], s22 offen offset:1024 sc1
  v_mov_b32 v72, v116
  v_mov_b32 v73, v117
  v_lshrrev_b32 v65, 1, v72
  v_and_b32 v66, 1, v72
  v_mov_b32 v68, 12
  v_mov_b32 v69, v73
  v_mov_b32 v70, 0
  v_and_b32 v71, 1, v69
  v_lshrrev_b32 v69, 1, v69
  v_lshl_add_u32 v69, v71, 3, v69
  v_lshlrev_b32 v71, 12, v70
  v_lshrrev_b32 v70, 1, v68
  v_lshl_add_u32 v71, v70, 9, v71
  v_and_b32 v70, 1, v68
  v_lshl_add_u32 v71, v70, 2, v71
  v_lshl_add_u32 v71, v69, 4, v71
  v_lshl_add_u32 v71, v65, 8, v71
  v_lshl_add_u32 v100, v66, 3, v71
  v_mov_b32 v68, 13
  v_mov_b32 v69, v73
  v_mov_b32 v70, 0
  v_and_b32 v71, 1, v69
  v_lshrrev_b32 v69, 1, v69
  v_lshl_add_u32 v69, v71, 3, v69
  v_lshlrev_b32 v71, 12, v70
  v_lshrrev_b32 v70, 1, v68
  v_lshl_add_u32 v71, v70, 9, v71
  v_and_b32 v70, 1, v68
  v_lshl_add_u32 v71, v70, 2, v71
  v_lshl_add_u32 v71, v69, 4, v71
  v_lshl_add_u32 v71, v65, 8, v71
  v_lshl_add_u32 v101, v66, 3, v71
  v_mov_b32 v68, 14
  v_mov_b32 v69, v73
  v_mov_b32 v70, 0
  v_and_b32 v71, 1, v69
  v_lshrrev_b32 v69, 1, v69
  v_lshl_add_u32 v69, v71, 3, v69
  v_lshlrev_b32 v71, 12, v70
  v_lshrrev_b32 v70, 1, v68
  v_lshl_add_u32 v71, v70, 9, v71
  v_and_b32 v70, 1, v68
  v_lshl_add_u32 v71, v70, 2, v71
  v_lshl_add_u32 v71, v69, 4, v71
  v_lshl_add_u32 v71, v65, 8, v71
  v_lshl_add_u32 v102, v66, 3, v71
  v_mov_b32 v68, 15
  v_mov_b32 v69, v73
  v_mov_b32 v70, 0
  v_and_b32 v71, 1, v69
  v_lshrrev_b32 v69, 1, v69
  v_lshl_add_u32 v69, v71, 3, v69
  v_lshlrev_b32 v71, 12, v70
  v_lshrrev_b32 v70, 1, v68
  v_lshl_add_u32 v71, v70, 9, v71
  v_and_b32 v70, 1, v68
  v_lshl_add_u32 v71, v70, 2, v71
  v_lshl_add_u32 v71, v69, 4, v71
  v_lshl_add_u32 v71, v65, 8, v71
  v_lshl_add_u32 v103, v66, 3, v71
  v_add_u32 v67, 0, v73
  v_mul_u32_u24 v68, 5462, v67
  v_lshrrev_b32 v68, 16, v68
  v_mul_u32_u24 v69, 12, v68
  v_sub_u32 v69, v67, v69
  v_mov_b32 v70, 1
  v_and_b32 v71, 1, v69
  v_lshrrev_b32 v69, 1, v69
  v_lshl_add_u32 v69, v71, 3, v69
  v_lshlrev_b32 v71, 12, v70
  v_lshrrev_b32 v70, 1, v68
  v_lshl_add_u32 v71, v70, 9, v71
  v_and_b32 v70, 1, v68
  v_lshl_add_u32 v71, v70, 2, v71
  v_lshl_add_u32 v71, v69, 4, v71
  v_lshl_add_u32 v71, v65, 8, v71
  v_lshl_add_u32 v104, v66, 3, v71
  v_add_u32 v67, 16, v73
  v_mul_u32_u24 v68, 5462, v67
  v_lshrrev_b32 v68, 16, v68
  v_mul_u32_u24 v69, 12, v68
  v_sub_u32 v69, v67, v69
  v_mov_b32 v70, 1
  v_and_b32 v71, 1, v69
  v_lshrrev_b32 v69, 1, v69
  v_lshl_add_u32 v69, v71, 3, v69
  v_lshlrev_b32 v71, 12, v70
  v_lshrrev_b32 v70, 1, v68
  v_lshl_add_u32 v71, v70, 9, v71
  v_and_b32 v70, 1, v68
  v_lshl_add_u32 v71, v70, 2, v71
  v_lshl_add_u32 v71, v69, 4, v71
  v_lshl_add_u32 v71, v65, 8, v71
  v_lshl_add_u32 v105, v66, 3, v71
  v_add_u32 v67, 32, v73
  v_mul_u32_u24 v68, 5462, v67
  v_lshrrev_b32 v68, 16, v68
  v_mul_u32_u24 v69, 12, v68
  v_sub_u32 v69, v67, v69
  v_mov_b32 v70, 1
  v_and_b32 v71, 1, v69
  v_lshrrev_b32 v69, 1, v69
  v_lshl_add_u32 v69, v71, 3, v69
  v_lshlrev_b32 v71, 12, v70
  v_lshrrev_b32 v70, 1, v68
  v_lshl_add_u32 v71, v70, 9, v71
  v_and_b32 v70, 1, v68
  v_lshl_add_u32 v71, v70, 2, v71
  v_lshl_add_u32 v71, v69, 4, v71
  v_lshl_add_u32 v71, v65, 8, v71
  v_lshl_add_u32 v106, v66, 3, v71
  v_add_u32 v67, 48, v73
  v_mul_u32_u24 v68, 5462, v67
  v_lshrrev_b32 v68, 16, v68
  v_mul_u32_u24 v69, 12, v68
  v_sub_u32 v69, v67, v69
  v_mov_b32 v70, 1
  v_and_b32 v71, 1, v69
  v_lshrrev_b32 v69, 1, v69
  v_lshl_add_u32 v69, v71, 3, v69
  v_lshlrev_b32 v71, 12, v70
  v_lshrrev_b32 v70, 1, v68
  v_lshl_add_u32 v71, v70, 9, v71
  v_and_b32 v70, 1, v68
  v_lshl_add_u32 v71, v70, 2, v71
  v_lshl_add_u32 v71, v69, 4, v71
  v_lshl_add_u32 v71, v65, 8, v71
  v_lshl_add_u32 v107, v66, 3, v71
  s_mul_i32 s24, s17, 532480
  s_add_u32 s24, s24, 76939264
  s_mul_i32 s34, s17, 640
  s_add_u32 s34, s34, 88582144
  s_mul_i32 s36, s17, 448
  v_add_u32 v0, s36, v2
  v_add_u32 v0, 8192, v0
  s_add_u32 s36, s36, 88080384
  s_mov_b32 s37, 76939264
  v_cmp_gt_u32 s[26:27], 28, v1
  v_and_b32 v119, 31, v1
  v_lshlrev_b32 v119, 2, v119
  v_and_b32 v119, 0x78, v119
  v_or_b32 v119, 0, v119
  s_add_u32 s22, s17, 16
  s_and_b32 s22, s22, 15
  s_lshl_b32 s22, s22, 7
  s_add_u32 s22, s22, 18432
  v_add_u32 v119, s22, v119
  v_min_u32 v118, 9, v1
  s_mul_i32 s22, s17, 10
  v_add_u32 v118, s22, v118
  v_lshlrev_b32 v118, 7, v118
  v_add_u32 v118, 40960, v118
  s_mov_b32 s39, 71565312
  v_add_u32 v1, 16384, v2
  v_mov_b32 v117, 1
  s_mul_i32 s38, s17, 1104
  s_add_u32 s38, s38, 20480
  v_bfe_u32 v8, v2, 4, 1
  v_mul_u32_u24 v3, 0xaaaa, v8
  v_add_u32 v3, 0x4444, v3
  v_bfe_u32 v9, v2, 5, 3
  v_lshl_add_u32 v8, v8, 3, v9
  v_and_b32 v9, 0x300, v2
  v_lshl_add_u32 v5, v8, 4, v9
  s_lshl_b32 s22, 0, 11
  s_add_u32 s22, s22, 88602624
  v_add_u32 v36, 1024, v2
  v_min_u32 v36, 1776, v36
  s_mov_b32 s30, 0
va_iw6:
  buffer_load_dwordx4 v[40:43], v2, s[8:11], s22 offen sc1
  buffer_load_dwordx4 v[44:47], v36, s[8:11], s22 offen sc1
  s_waitcnt vmcnt(0)
  v_cmp_ne_u64 vcc, s[88:89], v[40:41]
  s_cbranch_vccnz va_iw6_no
  v_cmp_ne_u64 vcc, s[88:89], v[42:43]
  s_cbranch_vccnz va_iw6_no
  v_cmp_ne_u64 vcc, s[88:89], v[44:45]
  s_cbranch_vccnz va_iw6_no
  v_cmp_ne_u64 vcc, s[88:89], v[46:47]
  s_cbranch_vccnz va_iw6_no
  s_branch va_iw6_ok
va_iw6_no:
  s_sleep 2
  s_add_u32 s30, s30, 1
  s_cmp_lt_u32 s30, 50000
  s_cbranch_scc1 va_iw6
  s_branch cA_abort
va_iw6_ok:
  s_mov_b32 s30, 0
  v_mov_b32 v36, 0
ch_md6:
  buffer_load_dword v37, v36, s[12:15], 0 offen sc1
  s_waitcnt vmcnt(0)
  v_readfirstlane_b32 s22, v37
  s_and_b32 s31, s22, 0xffff
  s_cmp_ge_u32 s31, 32
  s_cbranch_scc1 ch_go6
  s_sleep 2
  s_add_u32 s30, s30, 1
  s_cmp_lt_u32 s30, 50000
  s_cbranch_scc1 ch_md6
  s_branch ch_end
ch_go6:
  s_mov_b32 s31, 0
  s_lshr_b32 s22, s22, 16
  s_cmp_lg_u32 s22, 0
  s_cbranch_scc1 cB_va2_loop
  s_branch cA_va2_loop
ch_init7:
  s_mul_i32 s31, s17, 401408
  s_add_u32 s31, s31, 6422528
  s_lshl_b32 s22, s17, 4
  v_mov_b32 v38, s22
  s_mul_i32 s22, s17, 12
  s_add_u32 s23, s22, 267
  s_add_u32 s22, s22, 256
  v_mov_b32 v36, s23
  v_mov_b32 v37, s22
  v_cmp_eq_u32 vcc, 1, v116
  s_nop 1
  v_cndmask_b32 v36, v36, v37, vcc
  v_med3_u32 v37, v117, 5, 14
  v_lshrrev_b32 v36, 6, v36
  v_lshlrev_b32 v36, 8, v36
  v_lshl_add_u32 v36, v37, 4, v36
  s_mov_b32 s22, 88600576
  s_mov_b32 s30, 0
va_bw_16:
  buffer_load_dwordx4 v[40:43], v36, s[8:11], s22 offen sc1
  s_waitcnt vmcnt(0)
  v_cmp_ne_u64 vcc, s[88:89], v[40:41]
  s_cbranch_vccnz va_bw_16_no
  v_cmp_ne_u64 vcc, s[88:89], v[42:43]
  s_cbranch_vccnz va_bw_16_no
  s_branch va_bw_16_ok
va_bw_16_no:
  s_sleep 2
  s_add_u32 s30, s30, 1
  s_cmp_lt_u32 s30, 50000
  s_cbranch_scc1 va_bw_16
  s_branch cA_abort
va_bw_16_ok:
  s_add_u32 s22, s31, 286720
  buffer_load_dwordx4 a[0:3], v2, s[8:11], s22 offen offset:0 sc1
  buffer_load_dwordx4 a[4:7], v2, s[8:11], s22 offen offset:1024 sc1
  buffer_load_dwordx4 a[8:11], v2, s[8:11], s22 offen offset:2048 sc1
  buffer_load_dwordx4 a[12:15], v2, s[8:11], s22 offen offset:3072 sc1
  s_add_u32 s22, s31, 290816
  buffer_load_dwordx4 a[16:19], v2, s[8:11], s22 offen offset:0 sc1
  buffer_load_dwordx4 a[20:23], v2, s[8:11], s22 offen offset:1024 sc1
  buffer_load_dwordx4 a[24:27], v2, s[8:11], s22 offen offset:2048 sc1
  buffer_load_dwordx4 a[28:31], v2, s[8:11], s22 offen offset:3072 sc1
  s_add_u32 s22, s31, 294912
  buffer_load_dwordx4 a[32:35], v2, s[8:11], s22 offen offset:0 sc1
  buffer_load_dwordx4 a[36:39], v2, s[8:11], s22 offen offset:1024 sc1
  buffer_load_dwordx4 a[40:43], v2, s[8:11], s22 offen offset:2048 sc1
  buffer_load_dwordx4 a[44:47], v2, s[8:11], s22 offen offset:3072 sc1
  s_add_u32 s22, s31, 299008
  buffer_load_dwordx4 a[48:51], v2, s[8:11], s22 offen offset:0 sc1
  buffer_load_dwordx4 a[52:55], v2, s[8:11], s22 offen offset:1024 sc1
  buffer_load_dwordx4 a[56:59], v2, s[8:11], s22 offen offset:2048 sc1
  buffer_load_dwordx4 a[60:63], v2, s[8:11], s22 offen offset:3072 sc1
  s_add_u32 s22, s31, 303104
  buffer_load_dwordx4 a[64:67], v2, s[8:11], s22 offen offset:0 sc1
  buffer_load_dwordx4 a[68:71], v2, s[8:11], s22 offen offset:1024 sc1
  buffer_load_dwordx4 a[72:75], v2, s[8:11], s22 offen offset:2048 sc1
  buffer_load_dwordx4 a[76:79], v2, s[8:11], s22 offen offset:3072 sc1
  s_add_u32 s22, s31, 307200
  buffer_load_dwordx4 a[80:83], v2, s[8:11], s22 offen offset:0 sc1
  buffer_load_dwordx4 a[84:87], v2, s[8:11], s22 offen offset:1024 sc1
  buffer_load_dwordx4 a[88:91], v2, s[8:11], s22 offen offset:2048 sc1
  buffer_load_dwordx4 a[92:95], v2, s[8:11], s22 offen offset:3072 sc1
  s_add_u32 s22, s31, 311296
  buffer_load_dwordx4 a[96:99], v2, s[8:11], s22 offen offset:0 sc1
  buffer_load_dwordx4 a[100:103], v2, s[8:11], s22 offen offset:1024 sc1
  buffer_load_dwordx4 a[104:107], v2, s[8:11], s22 offen offset:2048 sc1
  buffer_load_dwordx4 a[108:111], v2, s[8:11], s22 offen offset:3072 sc1
  s_add_u32 s22, s31, 315392
  buffer_load_dwordx4 a[112:115], v2, s[8:11], s22 offen offset:0 sc1
  buffer_load_dwordx4 a[116:119], v2, s[8:11], s22 offen offset:1024 sc1
  buffer_load_dwordx4 a[120:123], v2, s[8:11], s22 offen offset:2048 sc1
  buffer_load_dwordx4 a[124:127], v2, s[8:11], s22 offen offset:3072 sc1
  s_waitcnt vmcnt(24)
  s_add_u32 s22, s31, 319488
  buffer_load_dwordx4 a[128:131], v2, s[8:11], s22 offen offset:0 sc1
  buffer_load_dwordx4 a[132:135], v2, s[8:11], s22 offen offset:1024 sc1
  buffer_load_dwordx4 a[136:139], v2, s[8:11], s22 offen offset:2048 sc1
  buffer_load_dwordx4 a[140:143], v2, s[8:11], s22 offen offset:3072 sc1
  s_add_u32 s22, s31, 323584
  buffer_load_dwordx4 a[144:147], v2, s[8:11], s22 offen offset:0 sc1
  buffer_load_dwordx4 a[148:151], v2, s[8:11], s22 offen offset:1024 sc1
  buffer_load_dwordx4 a[152:155], v2, s[8:11], s22 offen offset:2048 sc1
  buffer_load_dwordx4 a[156:159], v2, s[8:11], s22 offen offset:3072 sc1
  s_add_u32 s22, s31, 327680
  buffer_load_dwordx4 a[160:163], v2, s[8:11], s22 offen offset:0 sc1
  buffer_load_dwordx4 a[164:167], v2, s[8:11], s22 offen offset:1024 sc1
  buffer_load_dwordx4 a[168:171], v2, s[8:11], s22 offen offset:2048 sc1
  buffer_load_dwordx4 a[172:175], v2, s[8:11], s22 offen offset:3072 sc1
  s_add_u32 s22, s31, 331776
  buffer_load_dwordx4 a[176:179], v2, s[8:11], s22 offen offset:0 sc1
  buffer_load_dwordx4 a[180:183], v2, s[8:11], s22 offen offset:1024 sc1
  buffer_load_dwordx4 a[184:187], v2, s[8:11], s22 offen offset:2048 sc1
  buffer_load_dwordx4 a[188:191], v2, s[8:11], s22 offen offset:3072 sc1
  s_add_u32 s22, s31, 335872
  buffer_load_dwordx4 a[192:195], v2, s[8:11], s22 offen offset:0 sc1
  buffer_load_dwordx4 a[196:199], v2, s[8:11], s22 offen offset:1024 sc1
  buffer_load_dwordx4 a[200:203], v2, s[8:11], s22 offen offset:2048 sc1
  buffer_load_dwordx4 a[204:207], v2, s[8:11], s22 offen offset:3072 sc1
  s_add_u32 s22, s31, 339968
  buffer_load_dwordx4 a[208:211], v2, s[8:11], s22 offen offset:0 sc1
  buffer_load_dwordx4 a[212:215], v2, s[8:11], s22 offen offset:1024 sc1
  buffer_load_dwordx4 a[216:219], v2, s[8:11], s22 offen offset:2048 sc1
  buffer_load_dwordx4 a[220:223], v2, s[8:11], s22 offen offset:3072 sc1
  s_add_u32 s22, s31, 344064
  buffer_load_dwordx4 a[224:227], v2, s[8:11], s22 offen offset:0 sc1
  buffer_load_dwordx4 a[228:231], v2, s[8:11], s22 offen offset:1024 sc1
  buffer_load_dwordx4 a[232:235], v2, s[8:11], s22 offen offset:2048 sc1
  buffer_load_dwordx4 a[236:239], v2, s[8:11], s22 offen offset:3072 sc1
  s_add_u32 s22, s31, 348160
  buffer_load_dwordx4 a[240:243], v2, s[8:11], s22 offen offset:0 sc1
  buffer_load_dwordx4 a[244:247], v2, s[8:11], s22 offen offset:1024 sc1
  buffer_load_dwordx4 a[248:251], v2, s[8:11], s22 offen offset:2048 sc1
  buffer_load_dwordx4 a[252:255], v2, s[8:11], s22 offen offset:3072 sc1
  s_waitcnt vmcnt(24)
  s_add_u32 s22, s31, 352256
  buffer_load_dwordx4 v[120:123], v2, s[8:11], s22 offen offset:0 sc1
  buffer_load_dwordx4 v[124:127], v2, s[8:11], s22 offen offset:1024 sc1
  buffer_load_dwordx4 v[128:131], v2, s[8:11], s22 offen offset:2048 sc1
  buffer_load_dwordx4 v[132:135], v2, s[8:11], s22 offen offset:3072 sc1
  s_add_u32 s22, s31, 356352
  buffer_load_dwordx4 v[136:139], v2, s[8:11], s22 offen offset:0 sc1
  buffer_load_dwordx4 v[140:143], v2, s[8:11], s22 offen offset:1024 sc1
  buffer_load_dwordx4 v[144:147], v2, s[8:11], s22 offen offset:2048 sc1
  buffer_load_dwordx4 v[148:151], v2, s[8:11], s22 offen offset:3072 sc1
  s_add_u32 s22, s31, 360448
  buffer_load_dwordx4 v[152:155], v2, s[8:11], s22 offen offset:0 sc1
  buffer_load_dwordx4 v[156:159], v2, s[8:11], s22 offen offset:1024 sc1
  buffer_load_dwordx4 v[160:163], v2, s[8:11], s22 offen offset:2048 sc1
  buffer_load_dwordx4 v[164:167], v2, s[8:11], s22 offen offset:3072 sc1
  s_add_u32 s22, s31, 364544
  buffer_load_dwordx4 v[168:171], v2, s[8:11], s22 offen offset:0 sc1
  buffer_load_dwordx4 v[172:175], v2, s[8:11], s22 offen offset:1024 sc1
  buffer_load_dwordx4 v[176:179], v2, s[8:11], s22 offen offset:2048 sc1
  buffer_load_dwordx4 v[180:183], v2, s[8:11], s22 offen offset:3072 sc1
  s_add_u32 s22, s31, 368640
  buffer_load_dwordx4 v[184:187], v2, s[8:11], s22 offen offset:0 sc1
  buffer_load_dwordx4 v[188:191], v2, s[8:11], s22 offen offset:1024 sc1
  buffer_load_dwordx4 v[192:195], v2, s[8:11], s22 offen offset:2048 sc1
  buffer_load_dwordx4 v[196:199], v2, s[8:11], s22 offen offset:3072 sc1
  s_add_u32 s22, s31, 372736
  buffer_load_dwordx4 v[200:203], v2, s[8:11], s22 offen offset:0 sc1
  buffer_load_dwordx4 v[204:207], v2, s[8:11], s22 offen offset:1024 sc1
  buffer_load_dwordx4 v[208:211], v2, s[8:11], s22 offen offset:2048 sc1
  buffer_load_dwordx4 v[212:215], v2, s[8:11], s22 offen offset:3072 sc1
  s_add_u32 s22, s31, 376832
  buffer_load_dwordx4 v[216:219], v2, s[8:11], s22 offen offset:0 sc1
  buffer_load_dwordx4 v[220:223], v2, s[8:11], s22 offen offset:1024 sc1
  buffer_load_dwordx4 v[224:227], v2, s[8:11], s22 offen offset:2048 sc1
  buffer_load_dwordx4 v[228:231], v2, s[8:11], s22 offen offset:3072 sc1
  s_add_u32 s22, s31, 380928
  buffer_load_dwordx4 v[232:235], v2, s[8:11], s22 offen offset:0 sc1
  buffer_load_dwordx4 v[236:239], v2, s[8:11], s22 offen offset:1024 sc1
  buffer_load_dwordx4 v[240:243], v2, s[8:11], s22 offen offset:2048 sc1
  buffer_load_dwordx4 v[244:247], v2, s[8:11], s22 offen offset:3072 sc1
  s_waitcnt vmcnt(24)
  s_add_u32 s22, s31, 385024
  buffer_load_dwordx4 v[248:251], v2, s[8:11], s22 offen offset:0 sc1
  buffer_load_dwordx4 v[252:255], v2, s[8:11], s22 offen offset:1024 sc1
  v_mov_b32 v72, v116
  v_mov_b32 v73, v117
  v_lshrrev_b32 v65, 1, v72
  v_and_b32 v66, 1, v72
  v_add_u32 v67, 64, v73
  v_mul_u32_u24 v68, 5462, v67
  v_lshrrev_b32 v68, 16, v68
  v_mul_u32_u24 v69, 12, v68
  v_sub_u32 v69, v67, v69
  v_mov_b32 v70, 1
  v_and_b32 v71, 1, v69
  v_lshrrev_b32 v69, 1, v69
  v_lshl_add_u32 v69, v71, 3, v69
  v_lshlrev_b32 v71, 12, v70
  v_lshrrev_b32 v70, 1, v68
  v_lshl_add_u32 v71, v70, 9, v71
  v_and_b32 v70, 1, v68
  v_lshl_add_u32 v71, v70, 2, v71
  v_lshl_add_u32 v71, v69, 4, v71
  v_lshl_add_u32 v71, v65, 8, v71
  v_lshl_add_u32 v100, v66, 3, v71
  v_add_u32 v67, 80, v73
  v_mul_u32_u24 v68, 5462, v67
  v_lshrrev_b32 v68, 16, v68
  v_mul_u32_u24 v69, 12, v68
  v_sub_u32 v69, v67, v69
  v_mov_b32 v70, 1
  v_and_b32 v71, 1, v69
  v_lshrrev_b32 v69, 1, v69
  v_lshl_add_u32 v69, v71, 3, v69
  v_lshlrev_b32 v71, 12, v70
  v_lshrrev_b32 v70, 1, v68
  v_lshl_add_u32 v71, v70, 9, v71
  v_and_b32 v70, 1, v68
  v_lshl_add_u32 v71, v70, 2, v71
  v_lshl_add_u32 v71, v69, 4, v71
  v_lshl_add_u32 v71, v65, 8, v71
  v_lshl_add_u32 v101, v66, 3, v71
  v_add_u32 v67, 96, v73
  v_mul_u32_u24 v68, 5462, v67
  v_lshrrev_b32 v68, 16, v68
  v_mul_u32_u24 v69, 12, v68
  v_sub_u32 v69, v67, v69
  v_mov_b32 v70, 1
  v_and_b32 v71, 1, v69
  v_lshrrev_b32 v69, 1, v69
  v_lshl_add_u32 v69, v71, 3, v69
  v_lshlrev_b32 v71, 12, v70
  v_lshrrev_b32 v70, 1, v68
  v_lshl_add_u32 v71, v70, 9, v71
  v_and_b32 v70, 1, v68
  v_lshl_add_u32 v71, v70, 2, v71
  v_lshl_add_u32 v71, v69, 4, v71
  v_lshl_add_u32 v71, v65, 8, v71
  v_lshl_add_u32 v102, v66, 3, v71
  v_add_u32 v67, 112, v73
  v_mul_u32_u24 v68, 5462, v67
  v_lshrrev_b32 v68, 16, v68
  v_mul_u32_u24 v69, 12, v68
  v_sub_u32 v69, v67, v69
  v_mov_b32 v70, 1
  v_and_b32 v71, 1, v69
  v_lshrrev_b32 v69, 1, v69
  v_lshl_add_u32 v69, v71, 3, v69
  v_lshlrev_b32 v71, 12, v70
  v_lshrrev_b32 v70, 1, v68
  v_lshl_add_u32 v71, v70, 9, v71
  v_and_b32 v70, 1, v68
  v_lshl_add_u32 v71, v70, 2, v71
  v_lshl_add_u32 v71, v69, 4, v71
  v_lshl_add_u32 v71, v65, 8, v71
  v_lshl_add_u32 v103, v66, 3, v71
  v_add_u32 v67, 128, v73
  v_mul_u32_u24 v68, 5462, v67
  v_lshrrev_b32 v68, 16, v68
  v_mul_u32_u24 v69, 12, v68
  v_sub_u32 v69, v67, v69
  v_mov_b32 v70, 1
  v_and_b32 v71, 1, v69
  v_lshrrev_b32 v69, 1, v69
  v_lshl_add_u32 v69, v71, 3, v69
  v_lshlrev_b32 v71, 12, v70
  v_lshrrev_b32 v70, 1, v68
  v_lshl_add_u32 v71, v70, 9, v71
  v_and_b32 v70, 1, v68
  v_lshl_add_u32 v71, v70, 2, v71
  v_lshl_add_u32 v71, v69, 4, v71
  v_lshl_add_u32 v71, v65, 8, v71
  v_lshl_add_u32 v104, v66, 3, v71
  v_add_u32 v67, 144, v73
  v_mul_u32_u24 v68, 5462, v67
  v_lshrrev_b32 v68, 16, v68
  v_mul_u32_u24 v69, 12, v68
  v_sub_u32 v69, v67, v69
  v_mov_b32 v70, 1
  v_and_b32 v71, 1, v69
  v_lshrrev_b32 v69, 1, v69
  v_lshl_add_u32 v69, v71, 3, v69
  v_lshlrev_b32 v71, 12, v70
  v_lshrrev_b32 v70, 1, v68
  v_lshl_add_u32 v71, v70, 9, v71
  v_and_b32 v70, 1, v68
  v_lshl_add_u32 v71, v70, 2, v71
  v_lshl_add_u32 v71, v69, 4, v71
  v_lshl_add_u32 v71, v65, 8, v71
  v_lshl_add_u32 v105, v66, 3, v71
  v_add_u32 v67, 160, v73
  v_mul_u32_u24 v68, 5462, v67
  v_lshrrev_b32 v68, 16, v68
  v_mul_u32_u24 v69, 12, v68
  v_sub_u32 v69, v67, v69
  v_mov_b32 v70, 1
  v_and_b32 v71, 1, v69
  v_lshrrev_b32 v69, 1, v69
  v_lshl_add_u32 v69, v71, 3, v69
  v_lshlrev_b32 v71, 12, v70
  v_lshrrev_b32 v70, 1, v68
  v_lshl_add_u32 v71, v70, 9, v71
  v_and_b32 v70, 1, v68
  v_lshl_add_u32 v71, v70, 2, v71
  v_lshl_add_u32 v71, v69, 4, v71
  v_lshl_add_u32 v71, v65, 8, v71
  v_lshl_add_u32 v106, v66, 3, v71
  v_add_u32 v67, 176, v73
  v_mul_u32_u24 v68, 5462, v67
  v_lshrrev_b32 v68, 16, v68
  v_mul_u32_u24 v69, 12, v68
  v_sub_u32 v69, v67, v69
  v_mov_b32 v70, 1
  v_and_b32 v71, 1, v69
  v_lshrrev_b32 v69, 1, v69
  v_lshl_add_u32 v69, v71, 3, v69
  v_lshlrev_b32 v71, 12, v70
  v_lshrrev_b32 v70, 1, v68
  v_lshl_add_u32 v71, v70, 9, v71
  v_and_b32 v70, 1, v68
  v_lshl_add_u32 v71, v70, 2, v71
  v_lshl_add_u32 v71, v69, 4, v71
  v_lshl_add_u32 v71, v65, 8, v71
  v_lshl_add_u32 v107, v66, 3, v71
  s_mul_i32 s24, s17, 532480
  s_add_u32 s24, s24, 76943360
  s_mul_i32 s34, s17, 640
  s_add_u32 s34, s34, 88582148
  s_mul_i32 s36, s17, 448
  v_add_u32 v0, s36, v2
  v_add_u32 v0, 8192, v0
  s_add_u32 s36, s36, 88080384
  s_mov_b32 s37, 76939264
  v_cmp_gt_u32 s[26:27], 28, v1
  v_and_b32 v119, 31, v1
  v_lshlrev_b32 v119, 2, v119
  v_and_b32 v119, 0x78, v119
  v_or_b32 v119, 4, v119
  s_add_u32 s22, s17, 16
  s_and_b32 s22, s22, 15
  s_lshl_b32 s22, s22, 7
  s_add_u32 s22, s22, 18432
  v_add_u32 v119, s22, v119
  v_min_u32 v118, 13, v1
  s_mul_i32 s22, s17, 14
  v_add_u32 v118, s22, v118
  v_lshlrev_b32 v118, 7, v118
  v_add_u32 v118, 57344, v118
  s_mov_b32 s39, 71565312
  v_add_u32 v1, 59392, v2
  v_mov_b32 v117, 1
  s_mul_i32 s38, s17, 1104
  s_add_u32 s38, s38, 21504
  v_bfe_u32 v8, v2, 4, 1
  v_mul_u32_u24 v3, 0xaaaa, v8
  v_add_u32 v3, 0x4444, v3
  v_bfe_u32 v9, v2, 5, 3
  v_lshl_add_u32 v8, v8, 3, v9
  v_and_b32 v9, 0x300, v2
  v_lshl_add_u32 v5, v8, 4, v9
  s_lshl_b32 s22, 0, 11
  s_add_u32 s22, s22, 88602624
  v_add_u32 v36, 1024, v2
  v_min_u32 v36, 1776, v36
  s_mov_b32 s30, 0
va_iw7:
  buffer_load_dwordx4 v[40:43], v2, s[8:11], s22 offen sc1
  buffer_load_dwordx4 v[44:47], v36, s[8:11], s22 offen sc1
  s_waitcnt vmcnt(0)
  v_cmp_ne_u64 vcc, s[88:89], v[40:41]
  s_cbranch_vccnz va_iw7_no
  v_cmp_ne_u64 vcc, s[88:89], v[42:43]
  s_cbranch_vccnz va_iw7_no
  v_cmp_ne_u64 vcc, s[88:89], v[44:45]
  s_cbranch_vccnz va_iw7_no
  v_cmp_ne_u64 vcc, s[88:89], v[46:47]
  s_cbranch_vccnz va_iw7_no
  s_branch va_iw7_ok
va_iw7_no:
  s_sleep 2
  s_add_u32 s30, s30, 1
  s_cmp_lt_u32 s30, 50000
  s_cbranch_scc1 va_iw7
  s_branch cA_abort
va_iw7_ok:
  s_mov_b32 s30, 0
  v_mov_b32 v36, 0
ch_md7:
  buffer_load_dword v37, v36, s[12:15], 0 offen sc1
  s_waitcnt vmcnt(0)
  v_readfirstlane_b32 s22, v37
  s_and_b32 s31, s22, 0xffff
  s_cmp_ge_u32 s31, 32
  s_cbranch_scc1 ch_go7
  s_sleep 2
  s_add_u32 s30, s30, 1
  s_cmp_lt_u32 s30, 50000
  s_cbranch_scc1 ch_md7
  s_branch ch_end
ch_go7:
  s_mov_b32 s31, 0
  s_lshr_b32 s22, s22, 16
  s_cmp_lg_u32 s22, 0
  s_cbranch_scc1 cB_va3_loop
  s_branch cA_va3_loop
.p2align 6

cA_sc0_loop:
  s_add_u32 s23, s20, 4096
  s_add_u32 s21, s20, 20480
  v_mov_b32 v48, 0
  v_mov_b32 v49, 0
  v_mov_b32 v50, 0
  v_mov_b32 v51, 0
  v_mov_b32 v52, 0
  v_mov_b32 v53, 0
  v_mov_b32 v54, 0
  v_mov_b32 v55, 0
  v_mov_b32 v56, 0
  v_mov_b32 v57, 0
  v_mov_b32 v58, 0
  v_mov_b32 v59, 0
  v_mov_b32 v60, 0
  v_mov_b32 v61, 0
  v_mov_b32 v62, 0
  v_mov_b32 v63, 0
  v_mov_b32 v88, 0
  v_mov_b32 v89, 0
  v_mov_b32 v90, 0
  v_mov_b32 v91, 0
  v_mov_b32 v92, 0
  v_mov_b32 v93, 0
  v_mov_b32 v94, 0
  v_mov_b32 v95, 0
  v_mov_b32 v66, 0
  v_mov_b32 v67, 0
  s_mov_b32 s30, 0
  s_mov_b32 s62, 0
  buffer_load_dword v68, v0, s[8:11], s20 offen sc1
  s_nop 7
  buffer_load_dword v69, v0, s[8:11], s20 offen sc1
  s_nop 7
  buffer_load_dword v70, v0, s[8:11], s20 offen sc1
  s_nop 7
  buffer_load_dword v71, v0, s[8:11], s20 offen sc1
  s_nop 7
  buffer_load_dword v72, v0, s[8:11], s20 offen sc1
cA_sc0_fp_l:
  s_waitcnt vmcnt(4)
  v_cmp_eq_u32 vcc, -1, v68
  s_cbranch_vccz cA_sc0_fp_d
  buffer_load_dword v68, v0, s[8:11], s20 offen sc1
  s_waitcnt vmcnt(4)
  v_cmp_eq_u32 vcc, -1, v69
  s_cbranch_vccz cA_sc0_fp_d
  buffer_load_dword v69, v0, s[8:11], s20 offen sc1
  s_waitcnt vmcnt(4)
  v_cmp_eq_u32 vcc, -1, v70
  s_cbranch_vccz cA_sc0_fp_d
  buffer_load_dword v70, v0, s[8:11], s20 offen sc1
  s_waitcnt vmcnt(4)
  v_cmp_eq_u32 vcc, -1, v71
  s_cbranch_vccz cA_sc0_fp_d
  buffer_load_dword v71, v0, s[8:11], s20 offen sc1
  s_waitcnt vmcnt(4)
  v_cmp_eq_u32 vcc, -1, v72
  s_cbranch_vccz cA_sc0_fp_d
  buffer_load_dword v72, v0, s[8:11], s20 offen sc1
  s_add_u32 s30, s30, 1
  s_cmp_lt_u32 s30, 400000
  s_cbranch_scc1 cA_sc0_fp_l
  s_branch cA_abort
cA_sc0_fp_d:
  buffer_load_dwordx4 v[8:11], v2, s[8:11], s20 offen offset:0
  s_barrier
  s_branch cA_sc0_ld1
cA_sc0_ld:
  buffer_load_dwordx4 v[8:11], v2, s[8:11], s20 offen offset:0
cA_sc0_ld1:
  v_mov_b32 v36, 0
  v_mov_b32 v37, 0
  v_mov_b32 v38, 0
  v_mov_b32 v39, 0
  buffer_load_dwordx4 v[12:15], v2, s[8:11], s20 offen offset:1024
  v_mov_b32 v40, 0
  v_mov_b32 v41, 0
  v_mov_b32 v42, 0
  v_mov_b32 v43, 0
  buffer_load_dwordx4 v[16:19], v2, s[8:11], s20 offen offset:2048
  v_mov_b32 v44, 0
  v_mov_b32 v45, 0
  v_mov_b32 v46, 0
  v_mov_b32 v47, 0
  ds_read_b128 v[96:99], v117 offset:0
  ds_read_b128 v[100:103], v117 offset:1024
  ds_read_b128 v[104:107], v117 offset:14336
  ds_read_b128 v[108:111], v117 offset:15360
  s_waitcnt vmcnt(2)
  v_smfmac_f32_16x16x64_bf16 v[36:39], v[8:11], a[0:7], v3
  v_smfmac_f32_16x16x64_bf16 v[40:43], v[8:11], a[56:63], v3
  buffer_load_dwordx4 v[20:23], v2, s[8:11], s20 offen offset:3072
  v_smfmac_f32_16x16x64_bf16 v[44:47], v[8:11], a[112:119], v3
  v_smfmac_f32_16x16x64_bf16 v[48:51], v[8:11], a[168:175], v3
  v_smfmac_f32_16x16x64_bf16 v[52:55], v[8:11], a[224:231], v3
  buffer_load_dwordx4 v[24:27], v2, s[8:11], s23 offen offset:0
  v_smfmac_f32_16x16x64_bf16 v[56:59], v[8:11], v[144:151], v3
  v_smfmac_f32_16x16x64_bf16 v[60:63], v[8:11], v[200:207], v3
  s_waitcnt vmcnt(3)
  v_smfmac_f32_16x16x64_bf16 v[36:39], v[12:15], a[8:15], v3
  v_smfmac_f32_16x16x64_bf16 v[40:43], v[12:15], a[64:71], v3
  buffer_load_dwordx4 v[28:31], v2, s[8:11], s23 offen offset:1024
  v_smfmac_f32_16x16x64_bf16 v[44:47], v[12:15], a[120:127], v3
  v_smfmac_f32_16x16x64_bf16 v[48:51], v[12:15], a[176:183], v3
  v_smfmac_f32_16x16x64_bf16 v[52:55], v[12:15], a[232:239], v3
  buffer_load_dwordx4 v[32:35], v2, s[8:11], s23 offen offset:2048
  v_smfmac_f32_16x16x64_bf16 v[56:59], v[12:15], v[152:159], v3
  v_smfmac_f32_16x16x64_bf16 v[60:63], v[12:15], v[208:215], v3
  s_xor_b32 s58, s25, 28672
  s_add_u32 s59, s24, 28672
  s_add_u32 m0, s58, 0
  s_waitcnt vmcnt(4)
  v_smfmac_f32_16x16x64_bf16 v[36:39], v[16:19], a[16:23], v3
  buffer_load_dwordx4 v2, s[8:11], s59 offen offset:0 sc1 lds
  v_smfmac_f32_16x16x64_bf16 v[40:43], v[16:19], a[72:79], v3
  v_smfmac_f32_16x16x64_bf16 v[44:47], v[16:19], a[128:135], v3
  v_smfmac_f32_16x16x64_bf16 v[48:51], v[16:19], a[184:191], v3
  v_smfmac_f32_16x16x64_bf16 v[52:55], v[16:19], a[240:247], v3
  buffer_load_dwordx4 v2, s[8:11], s59 offen offset:1024 sc1 lds
  v_smfmac_f32_16x16x64_bf16 v[56:59], v[16:19], v[160:167], v3
  v_smfmac_f32_16x16x64_bf16 v[60:63], v[16:19], v[216:223], v3
  s_waitcnt vmcnt(5)
  v_smfmac_f32_16x16x64_bf16 v[36:39], v[20:23], a[24:31], v3
  v_smfmac_f32_16x16x64_bf16 v[40:43], v[20:23], a[80:87], v3
  buffer_load_dwordx4 v2, s[8:11], s59 offen offset:2048 sc1 lds
  v_smfmac_f32_16x16x64_bf16 v[44:47], v[20:23], a[136:143], v3
  v_smfmac_f32_16x16x64_bf16 v[48:51], v[20:23], a[192:199], v3
  v_smfmac_f32_16x16x64_bf16 v[52:55], v[20:23], a[248:255], v3
  v_smfmac_f32_16x16x64_bf16 v[56:59], v[20:23], v[168:175], v3
  buffer_load_dwordx4 v2, s[8:11], s59 offen offset:3072 sc1 lds
  v_smfmac_f32_16x16x64_bf16 v[60:63], v[20:23], v[224:231], v3
  s_waitcnt vmcnt(4)
cA_sc0_ph2:
  v_smfmac_f32_16x16x64_bf16 v[60:63], v[24:27], v[232:239], v3
  ds_read_b128 v[12:15], v116 offset:0
  ds_read_b128 v[16:19], v116 offset:1024
  v_smfmac_f32_16x16x64_bf16 v[60:63], v[28:31], v[240:247], v3
  v_smfmac_f32_16x16x64_bf16 v[60:63], v[32:35], v[248:255], v3
  v_mov_b32 v80, v24
  v_smfmac_f32_16x16x64_bf16 v[52:55], v[24:27], v[120:127], v3
  v_mov_b32 v81, v25
  v_smfmac_f32_16x16x64_bf16 v[52:55], v[28:31], v[128:135], v3
  v_mov_b32 v82, v32
  v_smfmac_f32_16x16x64_bf16 v[52:55], v[32:35], v[136:143], v3
  v_cvt_pk_bf16_f32 v64, v60, v61
  v_smfmac_f32_16x16x64_bf16 v[56:59], v[24:27], v[176:183], v3
  v_cvt_pk_bf16_f32 v65, v62, v63
  v_smfmac_f32_16x16x64_bf16 v[56:59], v[28:31], v[184:191], v3
  v_mov_b32 v83, v33
  v_mfma_f32_16x16x32_bf16 v[68:71], v[64:67], v[4:7], 0
  v_smfmac_f32_16x16x64_bf16 v[56:59], v[32:35], v[192:199], v3
  v_cvt_pk_bf16_f32 v64, v52, v53
  v_smfmac_f32_16x16x64_bf16 v[36:39], v[24:27], a[32:39], v3
  v_cvt_pk_bf16_f32 v65, v54, v55
  v_smfmac_f32_16x16x64_bf16 v[36:39], v[28:31], a[40:47], v3
  v_cvt_pk_bf16_f32 v78, v68, v69
  v_smfmac_f32_16x16x64_bf16 v[36:39], v[32:35], a[48:55], v3
  v_cvt_pk_bf16_f32 v79, v70, v71
  v_cvt_pk_bf16_f32 v66, v56, v57
  v_smfmac_f32_16x16x64_bf16 v[40:43], v[24:27], a[88:95], v3
  v_cvt_pk_bf16_f32 v67, v58, v59
  v_smfmac_f32_16x16x64_bf16 v[40:43], v[28:31], a[96:103], v3
  v_mfma_f32_16x16x32_bf16 v[72:75], v[64:67], v[4:7], 0
  ds_read_b128 v[52:55], v116 offset:14336
  ds_read_b128 v[56:59], v116 offset:15360
  v_smfmac_f32_16x16x64_bf16 v[40:43], v[32:35], a[104:111], v3
  v_cvt_pk_bf16_f32 v64, v36, v37
  v_smfmac_f32_16x16x64_bf16 v[44:47], v[24:27], a[144:151], v3
  v_cvt_pk_bf16_f32 v65, v38, v39
  v_smfmac_f32_16x16x64_bf16 v[44:47], v[28:31], a[152:159], v3
  v_cvt_pk_bf16_f32 v76, v72, v73
  v_smfmac_f32_16x16x64_bf16 v[44:47], v[32:35], a[160:167], v3
  v_cvt_pk_bf16_f32 v77, v74, v75
  v_cvt_pk_bf16_f32 v66, v40, v41
  v_smfmac_f32_16x16x64_bf16 v[48:51], v[24:27], a[200:207], v3
  v_cvt_pk_bf16_f32 v67, v42, v43
  v_smfmac_f32_16x16x64_bf16 v[48:51], v[28:31], a[208:215], v3
  v_mfma_f32_16x16x32_bf16 v[68:71], v[64:67], v[4:7], 0
  v_smfmac_f32_16x16x64_bf16 v[48:51], v[32:35], a[216:223], v3
  v_cvt_pk_bf16_f32 v64, v44, v45
  v_mfma_f32_16x16x32_bf16 v[84:87], v[80:83], v[76:79], 0
  v_cvt_pk_bf16_f32 v65, v46, v47
  s_waitcnt lgkmcnt(0)
  v_smfmac_f32_16x16x64_bf16 v[88:91], v[76:79], v[96:103], v118
  v_cvt_pk_bf16_f32 v60, v68, v69
  v_cvt_pk_bf16_f32 v61, v70, v71
  v_cvt_pk_bf16_f32 v66, v48, v49
  v_cvt_pk_bf16_f32 v67, v50, v51
  s_nop 1
  v_mfma_f32_16x16x32_bf16 v[72:75], v[64:67], v[4:7], 0
  v_smfmac_f32_16x16x64_bf16 v[92:95], v[76:79], v[104:111], v118
  s_nop 4
  v_cvt_pk_bf16_f32 v62, v72, v73
  v_cvt_pk_bf16_f32 v63, v74, v75
  s_nop 1
  v_mfma_f32_16x16x32_bf16 v[84:87], v[8:11], v[60:63], v[84:87]
  v_smfmac_f32_16x16x64_bf16 v[88:91], v[60:63], v[12:19], v118
  v_smfmac_f32_16x16x64_bf16 v[92:95], v[60:63], v[52:59], v118
  s_nop 1
  v_permlane32_swap_b32 v84, v86
  v_permlane32_swap_b32 v85, v87
  s_nop 0
  v_add_f32 v88, v88, v89
  v_add_f32_dpp v84, v86, v84 quad_perm:[1,0,3,2] row_mask:0xf bank_mask:0xf
  v_add_f32_dpp v85, v87, v85 quad_perm:[1,0,3,2] row_mask:0xf bank_mask:0xf
  v_add_f32 v89, v90, v91
  ds_write2_b32 v113, v84, v85 offset0:0 offset1:4
  ds_write2_b32 v112, v88, v89 offset0:0 offset1:128
  v_add_f32 v90, v92, v93
  v_add_f32 v91, v94, v95
  ds_write2_b32 v112, v90, v91 offset0:64 offset1:192
  v_cmp_u_f32 vcc, v88, v89
  s_cbranch_vccnz cA_sc0_retry
cA_sc0_cont:
  s_waitcnt lgkmcnt(0)
  s_barrier
  ds_read_b128 v[36:39], v114
  ds_read_b128 v[44:47], v115
  s_waitcnt lgkmcnt(0)
  v_add_f32 v36, v36, v38
  v_add_f32 v37, v37, v39
  v_add_f32 v44, v44, v45
  v_add_f32 v46, v46, v47
  v_add_f32 v44, v44, v46
  v_add_f32 v36, v36, v37
  v_exp_f32 v49, v44
  v_exp_f32 v48, v36
  v_add_f32 v50, abs(v36), abs(v44)
  v_fma_f32 v39, v49, s37, v48
  v_cmp_ngt_f32 vcc, s56, v50
  v_cndmask_b32 v41, v48, v49, s[38:39]
  v_add_f32_dpp v39, v39, v39 quad_perm:[1,0,3,2] row_mask:0xf bank_mask:0xf
  v_cndmask_b32 v40, v49, v48, s[38:39]
  v_mov_b32_dpp v46, v41 quad_perm:[1,0,3,2] row_mask:0xf bank_mask:0xf
  v_add_f32_dpp v39, v39, v39 quad_perm:[2,3,0,1] row_mask:0xf bank_mask:0xf
  v_cndmask_b32 v42, v46, v40, s[38:39]
  v_cndmask_b32 v43, v40, v46, s[38:39]
  v_add_f32_dpp v39, v39, v39 row_half_mirror row_mask:0xf bank_mask:0xf
  s_cbranch_vccnz cA_sc0_slow
  s_nop 0
  v_add_f32_dpp v47, v39, v39 row_mirror row_mask:0xf bank_mask:0xf
  v_add_f32_dpp v39, v39, v39 row_mirror row_mask:0xf bank_mask:0xf
  s_nop 1
  v_permlane16_swap_b32 v39, v47
  v_add_f32 v39, v39, v47
  v_rcp_f32 v39, v39
  s_mov_b64 exec, s[28:29]
  v_mul_f32 v42, v42, v39
  v_mul_f32 v43, v43, v39
  v_cvt_pk_bf16_f32 v42, v42, v43
cA_sc0_pst:
  buffer_store_dword v42, v1, s[8:11], s20 offen
  s_mov_b64 exec, -1
  s_barrier
  s_add_u32 s24, s24, 28672
  s_add_u32 s35, s35, 28672
  s_xor_b32 s25, s25, 28672
  s_add_u32 m0, s25, 0
  s_add_u32 m0, s25, 4096
  s_add_u32 s22, s24, 4096
  buffer_load_dwordx4 v2, s[8:11], s22 offen offset:0 sc1 lds
  s_nop 5
  buffer_load_dwordx4 v2, s[8:11], s22 offen offset:1024 sc1 lds
  s_nop 5
  buffer_load_dwordx4 v2, s[8:11], s22 offen offset:2048 sc1 lds
  s_nop 5
  v_xor_b32 v116, 28672, v116
  v_add_u32 v117, s57, v117
  s_sub_u32 s57, 0, s57
  s_add_u32 s19, s19, 1
  s_mov_b32 s20, s21
  s_cmp_lt_u32 s19, 63
  s_cbranch_scc1 cA_sc0_loop
  s_branch cA_done
cA_sc0_slow:
  v_max_f32 v50, v36, v44
  s_nop 1
  v_max_f32_dpp v50, v50, v50 quad_perm:[1,0,3,2] row_mask:0xf bank_mask:0xf
  s_nop 1
  v_max_f32_dpp v50, v50, v50 quad_perm:[2,3,0,1] row_mask:0xf bank_mask:0xf
  s_nop 1
  v_max_f32_dpp v50, v50, v50 row_half_mirror row_mask:0xf bank_mask:0xf
  s_nop 1
  v_max_f32_dpp v50, v50, v50 row_mirror row_mask:0xf bank_mask:0xf
  v_mov_b32 v47, v50
  s_nop 1
  v_permlane16_swap_b32 v50, v47
  v_max_f32 v50, v50, v47
  v_sub_f32 v48, v36, v50
  v_sub_f32 v49, v44, v50
  v_exp_f32 v48, v48
  v_exp_f32 v49, v49
  s_add_u32 s31, s31, 0x100
  v_fma_f32 v39, v49, s37, v48
  v_cndmask_b32 v41, v48, v49, s[38:39]
  s_nop 0
  v_add_f32_dpp v39, v39, v39 quad_perm:[1,0,3,2] row_mask:0xf bank_mask:0xf
  v_cndmask_b32 v40, v49, v48, s[38:39]
  v_mov_b32_dpp v46, v41 quad_perm:[1,0,3,2] row_mask:0xf bank_mask:0xf
  v_add_f32_dpp v39, v39, v39 quad_perm:[2,3,0,1] row_mask:0xf bank_mask:0xf
  v_cndmask_b32 v42, v46, v40, s[38:39]
  v_cndmask_b32 v43, v40, v46, s[38:39]
  v_add_f32_dpp v39, v39, v39 row_half_mirror row_mask:0xf bank_mask:0xf
  s_nop 1
  v_add_f32_dpp v47, v39, v39 row_mirror row_mask:0xf bank_mask:0xf
  v_add_f32_dpp v39, v39, v39 row_mirror row_mask:0xf bank_mask:0xf
  s_nop 1
  v_permlane16_swap_b32 v39, v47
  v_add_f32 v39, v39, v47
  v_rcp_f32 v39, v39
  s_mov_b64 exec, s[28:29]
  v_mul_f32 v42, v42, v39
  v_mul_f32 v43, v43, v39
  v_cvt_pk_bf16_f32 v42, v42, v43
  v_min_u32 v42, -2, v42
  s_branch cA_sc0_pst
cA_sc0_retry:
  s_cmp_lg_u32 s62, 0
  s_cbranch_scc1 cA_sc0_cont
  s_waitcnt vmcnt(0) lgkmcnt(0)
cA_sc0_rv:
  buffer_load_dwordx4 v[8:11], v2, s[8:11], s20 offen offset:0 sc1
  buffer_load_dwordx4 v[12:15], v2, s[8:11], s20 offen offset:1024 sc1
  buffer_load_dwordx4 v[16:19], v2, s[8:11], s20 offen offset:2048 sc1
  buffer_load_dwordx4 v[20:23], v2, s[8:11], s20 offen offset:3072 sc1
  buffer_load_dwordx4 v[24:27], v2, s[8:11], s23 offen offset:0 sc1
  buffer_load_dwordx4 v[28:31], v2, s[8:11], s23 offen offset:1024 sc1
  buffer_load_dwordx4 v[32:35], v2, s[8:11], s23 offen offset:2048 sc1
  s_waitcnt vmcnt(0)
  v_max3_u32 v68, v8, v9, v10
  v_max3_u32 v68, v68, v11, v12
  v_max3_u32 v68, v68, v13, v14
  v_max3_u32 v68, v68, v15, v16
  v_max3_u32 v68, v68, v17, v18
  v_max3_u32 v68, v68, v19, v20
  v_max3_u32 v68, v68, v21, v22
  v_max3_u32 v68, v68, v23, v24
  v_max3_u32 v68, v68, v25, v26
  v_max3_u32 v68, v68, v27, v28
  v_max3_u32 v68, v68, v29, v30
  v_max3_u32 v68, v68, v31, v32
  v_max3_u32 v68, v68, v33, v34
  v_max_u32 v68, v68, v35
  v_cmp_eq_u32 vcc, -1, v68
  s_cbranch_vccz cA_sc0_rk
  s_add_u32 s30, s30, 1
  s_cmp_lt_u32 s30, 400000
  s_cbranch_scc1 cA_sc0_rv
  s_branch cA_abort
cA_sc0_rk:
  s_mov_b32 s62, 1
  v_mov_b32 v36, 0
  v_mov_b32 v37, 0
  v_mov_b32 v38, 0
  v_mov_b32 v39, 0
  v_mov_b32 v40, 0
  v_mov_b32 v41, 0
  v_mov_b32 v42, 0
  v_mov_b32 v43, 0
  v_mov_b32 v44, 0
  v_mov_b32 v45, 0
  v_mov_b32 v46, 0
  v_mov_b32 v47, 0
  v_mov_b32 v48, 0
  v_mov_b32 v49, 0
  v_mov_b32 v50, 0
  v_mov_b32 v51, 0
  v_mov_b32 v52, 0
  v_mov_b32 v53, 0
  v_mov_b32 v54, 0
  v_mov_b32 v55, 0
  v_mov_b32 v56, 0
  v_mov_b32 v57, 0
  v_mov_b32 v58, 0
  v_mov_b32 v59, 0
  v_mov_b32 v60, 0
  v_mov_b32 v61, 0
  v_mov_b32 v62, 0
  v_mov_b32 v63, 0
  v_mov_b32 v88, 0
  v_mov_b32 v89, 0
  v_mov_b32 v90, 0
  v_mov_b32 v91, 0
  v_mov_b32 v92, 0
  v_mov_b32 v93, 0
  v_mov_b32 v94, 0
  v_mov_b32 v95, 0
  v_mov_b32 v66, 0
  v_mov_b32 v67, 0
  s_add_u32 s31, s31, 1
  ds_read_b128 v[96:99], v117 offset:0
  ds_read_b128 v[100:103], v117 offset:1024
  ds_read_b128 v[104:107], v117 offset:14336
  ds_read_b128 v[108:111], v117 offset:15360
  v_smfmac_f32_16x16x64_bf16 v[36:39], v[8:11], a[0:7], v3
  v_smfmac_f32_16x16x64_bf16 v[40:43], v[8:11], a[56:63], v3
  v_smfmac_f32_16x16x64_bf16 v[44:47], v[8:11], a[112:119], v3
  v_smfmac_f32_16x16x64_bf16 v[48:51], v[8:11], a[168:175], v3
  v_smfmac_f32_16x16x64_bf16 v[52:55], v[8:11], a[224:231], v3
  v_smfmac_f32_16x16x64_bf16 v[56:59], v[8:11], v[144:151], v3
  v_smfmac_f32_16x16x64_bf16 v[60:63], v[8:11], v[200:207], v3
  v_smfmac_f32_16x16x64_bf16 v[36:39], v[12:15], a[8:15], v3
  v_smfmac_f32_16x16x64_bf16 v[40:43], v[12:15], a[64:71], v3
  v_smfmac_f32_16x16x64_bf16 v[44:47], v[12:15], a[120:127], v3
  v_smfmac_f32_16x16x64_bf16 v[48:51], v[12:15], a[176:183], v3
  v_smfmac_f32_16x16x64_bf16 v[52:55], v[12:15], a[232:239], v3
  v_smfmac_f32_16x16x64_bf16 v[56:59], v[12:15], v[152:159], v3
  v_smfmac_f32_16x16x64_bf16 v[60:63], v[12:15], v[208:215], v3
  v_smfmac_f32_16x16x64_bf16 v[36:39], v[16:19], a[16:23], v3
  v_smfmac_f32_16x16x64_bf16 v[40:43], v[16:19], a[72:79], v3
  v_smfmac_f32_16x16x64_bf16 v[44:47], v[16:19], a[128:135], v3
  v_smfmac_f32_16x16x64_bf16 v[48:51], v[16:19], a[184:191], v3
  v_smfmac_f32_16x16x64_bf16 v[52:55], v[16:19], a[240:247], v3
  v_smfmac_f32_16x16x64_bf16 v[56:59], v[16:19], v[160:167], v3
  v_smfmac_f32_16x16x64_bf16 v[60:63], v[16:19], v[216:223], v3
  v_smfmac_f32_16x16x64_bf16 v[36:39], v[20:23], a[24:31], v3
  v_smfmac_f32_16x16x64_bf16 v[40:43], v[20:23], a[80:87], v3
  v_smfmac_f32_16x16x64_bf16 v[44:47], v[20:23], a[136:143], v3
  v_smfmac_f32_16x16x64_bf16 v[48:51], v[20:23], a[192:199], v3
  v_smfmac_f32_16x16x64_bf16 v[52:55], v[20:23], a[248:255], v3
  v_smfmac_f32_16x16x64_bf16 v[56:59], v[20:23], v[168:175], v3
  v_smfmac_f32_16x16x64_bf16 v[60:63], v[20:23], v[224:231], v3
  s_xor_b32 s58, s25, 28672
  s_add_u32 s59, s24, 28672
  s_add_u32 m0, s58, 0
  s_branch cA_sc0_ph2
.p2align 6

cA_sc1_loop:
  s_add_u32 s23, s20, 4096
  s_add_u32 s21, s20, 20480
  v_mov_b32 v48, 0
  v_mov_b32 v49, 0
  v_mov_b32 v50, 0
  v_mov_b32 v51, 0
  v_mov_b32 v52, 0
  v_mov_b32 v53, 0
  v_mov_b32 v54, 0
  v_mov_b32 v55, 0
  v_mov_b32 v56, 0
  v_mov_b32 v57, 0
  v_mov_b32 v58, 0
  v_mov_b32 v59, 0
  v_mov_b32 v60, 0
  v_mov_b32 v61, 0
  v_mov_b32 v62, 0
  v_mov_b32 v63, 0
  v_mov_b32 v88, 0
  v_mov_b32 v89, 0
  v_mov_b32 v90, 0
  v_mov_b32 v91, 0
  v_mov_b32 v92, 0
  v_mov_b32 v93, 0
  v_mov_b32 v94, 0
  v_mov_b32 v95, 0
  v_mov_b32 v64, 0
  v_mov_b32 v65, 0
  s_mov_b32 s30, 0
  s_mov_b32 s62, 0
  s_waitcnt vmcnt(0)
  s_barrier
cA_sc1_ld:
  buffer_load_dwordx4 v[8:11], v2, s[8:11], s20 offen offset:0
  v_mov_b32 v36, 0
  v_mov_b32 v37, 0
  v_mov_b32 v38, 0
  v_mov_b32 v39, 0
  buffer_load_dwordx4 v[12:15], v2, s[8:11], s20 offen offset:1024
  v_mov_b32 v40, 0
  v_mov_b32 v41, 0
  v_mov_b32 v42, 0
  v_mov_b32 v43, 0
  buffer_load_dwordx4 v[16:19], v2, s[8:11], s20 offen offset:2048
  v_mov_b32 v44, 0
  v_mov_b32 v45, 0
  v_mov_b32 v46, 0
  v_mov_b32 v47, 0
  ds_read_b128 v[96:99], v117 offset:0
  ds_read_b128 v[100:103], v117 offset:1024
  ds_read_b128 v[104:107], v117 offset:14336
  ds_read_b128 v[108:111], v117 offset:15360
  s_waitcnt vmcnt(2)
  v_smfmac_f32_16x16x64_bf16 v[36:39], v[8:11], a[0:7], v3
  v_smfmac_f32_16x16x64_bf16 v[40:43], v[8:11], a[56:63], v3
  buffer_load_dwordx4 v[20:23], v2, s[8:11], s20 offen offset:3072
  v_smfmac_f32_16x16x64_bf16 v[44:47], v[8:11], a[112:119], v3
  v_smfmac_f32_16x16x64_bf16 v[48:51], v[8:11], a[168:175], v3
  v_smfmac_f32_16x16x64_bf16 v[52:55], v[8:11], a[224:231], v3
  buffer_load_dwordx4 v[24:27], v2, s[8:11], s23 offen offset:0
  v_smfmac_f32_16x16x64_bf16 v[56:59], v[8:11], v[144:151], v3
  v_smfmac_f32_16x16x64_bf16 v[60:63], v[8:11], v[200:207], v3
  s_waitcnt vmcnt(3)
  v_smfmac_f32_16x16x64_bf16 v[36:39], v[12:15], a[8:15], v3
  v_smfmac_f32_16x16x64_bf16 v[40:43], v[12:15], a[64:71], v3
  buffer_load_dwordx4 v[28:31], v2, s[8:11], s23 offen offset:1024
  v_smfmac_f32_16x16x64_bf16 v[44:47], v[12:15], a[120:127], v3
  v_smfmac_f32_16x16x64_bf16 v[48:51], v[12:15], a[176:183], v3
  v_smfmac_f32_16x16x64_bf16 v[52:55], v[12:15], a[232:239], v3
  buffer_load_dwordx4 v[32:35], v2, s[8:11], s23 offen offset:2048
  v_smfmac_f32_16x16x64_bf16 v[56:59], v[12:15], v[152:159], v3
  v_smfmac_f32_16x16x64_bf16 v[60:63], v[12:15], v[208:215], v3
  s_waitcnt vmcnt(4)
  v_smfmac_f32_16x16x64_bf16 v[36:39], v[16:19], a[16:23], v3
  s_xor_b32 s58, s25, 28672
  s_add_u32 s59, s24, 28672
  s_add_u32 m0, s58, 7168
  v_smfmac_f32_16x16x64_bf16 v[40:43], v[16:19], a[72:79], v3
  buffer_load_dwordx4 v2, s[8:11], s59 offen offset:0 sc1 lds
  v_smfmac_f32_16x16x64_bf16 v[44:47], v[16:19], a[128:135], v3
  v_smfmac_f32_16x16x64_bf16 v[48:51], v[16:19], a[184:191], v3
  v_smfmac_f32_16x16x64_bf16 v[52:55], v[16:19], a[240:247], v3
  v_smfmac_f32_16x16x64_bf16 v[56:59], v[16:19], v[160:167], v3
  buffer_load_dwordx4 v2, s[8:11], s59 offen offset:1024 sc1 lds
  v_smfmac_f32_16x16x64_bf16 v[60:63], v[16:19], v[216:223], v3
  s_waitcnt vmcnt(5)
  v_smfmac_f32_16x16x64_bf16 v[36:39], v[20:23], a[24:31], v3
  v_smfmac_f32_16x16x64_bf16 v[40:43], v[20:23], a[80:87], v3
  v_smfmac_f32_16x16x64_bf16 v[44:47], v[20:23], a[136:143], v3
  buffer_load_dwordx4 v2, s[8:11], s59 offen offset:2048 sc1 lds
  v_smfmac_f32_16x16x64_bf16 v[48:51], v[20:23], a[192:199], v3
  v_smfmac_f32_16x16x64_bf16 v[52:55], v[20:23], a[248:255], v3
  v_smfmac_f32_16x16x64_bf16 v[56:59], v[20:23], v[168:175], v3
  v_smfmac_f32_16x16x64_bf16 v[60:63], v[20:23], v[224:231], v3
  buffer_load_dwordx4 v2, s[8:11], s59 offen offset:3072 sc1 lds
  s_waitcnt vmcnt(4)
cA_sc1_ph2:
  v_smfmac_f32_16x16x64_bf16 v[60:63], v[24:27], v[232:239], v3
  ds_read_b128 v[16:19], v116 offset:2048
  ds_read_b128 v[20:23], v116 offset:3072
  v_smfmac_f32_16x16x64_bf16 v[60:63], v[28:31], v[240:247], v3
  buffer_load_dword v119, v0, s[8:11], s20 offen sc1
  v_smfmac_f32_16x16x64_bf16 v[60:63], v[32:35], v[248:255], v3
  v_mov_b32 v80, v26
  v_smfmac_f32_16x16x64_bf16 v[52:55], v[24:27], v[120:127], v3
  v_mov_b32 v81, v27
  v_smfmac_f32_16x16x64_bf16 v[52:55], v[28:31], v[128:135], v3
  v_mov_b32 v82, v32
  v_smfmac_f32_16x16x64_bf16 v[52:55], v[32:35], v[136:143], v3
  v_cvt_pk_bf16_f32 v66, v60, v61
  v_smfmac_f32_16x16x64_bf16 v[56:59], v[24:27], v[176:183], v3
  v_cvt_pk_bf16_f32 v67, v62, v63
  v_smfmac_f32_16x16x64_bf16 v[56:59], v[28:31], v[184:191], v3
  v_mov_b32 v83, v33
  v_mfma_f32_16x16x32_bf16 v[68:71], v[64:67], v[4:7], 0
  v_smfmac_f32_16x16x64_bf16 v[56:59], v[32:35], v[192:199], v3
  v_cvt_pk_bf16_f32 v64, v52, v53
  v_smfmac_f32_16x16x64_bf16 v[36:39], v[24:27], a[32:39], v3
  v_cvt_pk_bf16_f32 v65, v54, v55
  v_smfmac_f32_16x16x64_bf16 v[36:39], v[28:31], a[40:47], v3
  v_cvt_pk_bf16_f32 v78, v68, v69
  v_smfmac_f32_16x16x64_bf16 v[36:39], v[32:35], a[48:55], v3
  v_cvt_pk_bf16_f32 v79, v70, v71
  v_cvt_pk_bf16_f32 v66, v56, v57
  v_smfmac_f32_16x16x64_bf16 v[40:43], v[24:27], a[88:95], v3
  v_cvt_pk_bf16_f32 v67, v58, v59
  v_smfmac_f32_16x16x64_bf16 v[40:43], v[28:31], a[96:103], v3
  v_mfma_f32_16x16x32_bf16 v[72:75], v[64:67], v[4:7], 0
  ds_read_b128 v[52:55], v116 offset:16384
  ds_read_b128 v[56:59], v116 offset:17408
  v_smfmac_f32_16x16x64_bf16 v[40:43], v[32:35], a[104:111], v3
  v_cvt_pk_bf16_f32 v64, v36, v37
  v_smfmac_f32_16x16x64_bf16 v[44:47], v[24:27], a[144:151], v3
  v_cvt_pk_bf16_f32 v65, v38, v39
  v_smfmac_f32_16x16x64_bf16 v[44:47], v[28:31], a[152:159], v3
  v_cvt_pk_bf16_f32 v76, v72, v73
  v_smfmac_f32_16x16x64_bf16 v[44:47], v[32:35], a[160:167], v3
  v_cvt_pk_bf16_f32 v77, v74, v75
  v_cvt_pk_bf16_f32 v66, v40, v41
  v_smfmac_f32_16x16x64_bf16 v[48:51], v[24:27], a[200:207], v3
  v_cvt_pk_bf16_f32 v67, v42, v43
  v_smfmac_f32_16x16x64_bf16 v[48:51], v[28:31], a[208:215], v3
  v_mfma_f32_16x16x32_bf16 v[68:71], v[64:67], v[4:7], 0
  v_smfmac_f32_16x16x64_bf16 v[48:51], v[32:35], a[216:223], v3
  v_cvt_pk_bf16_f32 v64, v44, v45
  v_mfma_f32_16x16x32_bf16 v[84:87], v[80:83], v[76:79], 0
  v_cvt_pk_bf16_f32 v65, v46, v47
  s_waitcnt lgkmcnt(0)
  v_smfmac_f32_16x16x64_bf16 v[88:91], v[76:79], v[96:103], v118
  v_cvt_pk_bf16_f32 v60, v68, v69
  v_cvt_pk_bf16_f32 v61, v70, v71
  v_cvt_pk_bf16_f32 v66, v48, v49
  v_cvt_pk_bf16_f32 v67, v50, v51
  s_nop 1
  v_mfma_f32_16x16x32_bf16 v[72:75], v[64:67], v[4:7], 0
  v_smfmac_f32_16x16x64_bf16 v[92:95], v[76:79], v[104:111], v118
  s_nop 4
  v_cvt_pk_bf16_f32 v62, v72, v73
  v_cvt_pk_bf16_f32 v63, v74, v75
  s_nop 1
  v_mfma_f32_16x16x32_bf16 v[84:87], v[12:15], v[60:63], v[84:87]
  v_smfmac_f32_16x16x64_bf16 v[88:91], v[60:63], v[16:23], v118
  v_smfmac_f32_16x16x64_bf16 v[92:95], v[60:63], v[52:59], v118
  s_nop 1
  v_permlane32_swap_b32 v84, v86
  v_permlane32_swap_b32 v85, v87
  s_nop 0
  v_add_f32 v88, v88, v89
  v_add_f32_dpp v84, v86, v84 quad_perm:[1,0,3,2] row_mask:0xf bank_mask:0xf
  v_add_f32_dpp v85, v87, v85 quad_perm:[1,0,3,2] row_mask:0xf bank_mask:0xf
  v_add_f32 v89, v90, v91
  ds_write2_b32 v113, v84, v85 offset0:0 offset1:4
  ds_write2_b32 v112, v88, v89 offset0:0 offset1:128
  v_add_f32 v90, v92, v93
  v_add_f32 v91, v94, v95
  ds_write2_b32 v112, v90, v91 offset0:64 offset1:192
  v_cmp_u_f32 vcc, v88, v89
  s_cbranch_vccnz cA_sc1_retry
cA_sc1_cont:
  s_waitcnt lgkmcnt(0)
  s_barrier
  ds_read_b128 v[36:39], v114
  ds_read_b128 v[44:47], v115
  s_waitcnt lgkmcnt(0)
  v_add_f32 v36, v36, v38
  v_add_f32 v37, v37, v39
  v_add_f32 v44, v44, v45
  v_add_f32 v46, v46, v47
  v_add_f32 v44, v44, v46
  v_add_f32 v36, v36, v37
  v_exp_f32 v49, v44
  v_exp_f32 v48, v36
  v_add_f32 v50, abs(v36), abs(v44)
  v_fma_f32 v39, v49, s37, v48
  v_cmp_ngt_f32 vcc, s56, v50
  v_cndmask_b32 v41, v48, v49, s[38:39]
  v_add_f32_dpp v39, v39, v39 quad_perm:[1,0,3,2] row_mask:0xf bank_mask:0xf
  v_cndmask_b32 v40, v49, v48, s[38:39]
  v_mov_b32_dpp v46, v41 quad_perm:[1,0,3,2] row_mask:0xf bank_mask:0xf
  v_add_f32_dpp v39, v39, v39 quad_perm:[2,3,0,1] row_mask:0xf bank_mask:0xf
  v_cndmask_b32 v42, v46, v40, s[38:39]
  v_cndmask_b32 v43, v40, v46, s[38:39]
  v_add_f32_dpp v39, v39, v39 row_half_mirror row_mask:0xf bank_mask:0xf
  s_cbranch_vccnz cA_sc1_slow
  s_nop 0
  v_add_f32_dpp v47, v39, v39 row_mirror row_mask:0xf bank_mask:0xf
  v_add_f32_dpp v39, v39, v39 row_mirror row_mask:0xf bank_mask:0xf
  s_nop 1
  v_permlane16_swap_b32 v39, v47
  v_add_f32 v39, v39, v47
  v_rcp_f32 v39, v39
  s_mov_b64 exec, s[28:29]
  v_mul_f32 v42, v42, v39
  v_mul_f32 v43, v43, v39
  v_cvt_pk_bf16_f32 v42, v42, v43
cA_sc1_pst:
  buffer_store_dword v42, v1, s[8:11], s20 offen
  s_mov_b64 exec, -1
  s_barrier
  s_add_u32 s24, s24, 28672
  s_add_u32 s35, s35, 28672
  s_xor_b32 s25, s25, 28672
  s_add_u32 m0, s25, 7168
  s_add_u32 m0, s25, 11264
  s_add_u32 s22, s24, 4096
  buffer_load_dwordx4 v2, s[8:11], s22 offen offset:0 sc1 lds
  s_nop 5
  buffer_load_dwordx4 v2, s[8:11], s22 offen offset:1024 sc1 lds
  s_nop 5
  buffer_load_dwordx4 v2, s[8:11], s22 offen offset:2048 sc1 lds
  s_nop 5
  v_xor_b32 v116, 28672, v116
  v_add_u32 v117, s57, v117
  s_sub_u32 s57, 0, s57
  s_add_u32 s19, s19, 1
  s_mov_b32 s20, s21
  s_cmp_lt_u32 s19, 63
  s_cbranch_scc1 cA_sc1_loop
  s_branch cA_done
cA_sc1_slow:
  v_max_f32 v50, v36, v44
  s_nop 1
  v_max_f32_dpp v50, v50, v50 quad_perm:[1,0,3,2] row_mask:0xf bank_mask:0xf
  s_nop 1
  v_max_f32_dpp v50, v50, v50 quad_perm:[2,3,0,1] row_mask:0xf bank_mask:0xf
  s_nop 1
  v_max_f32_dpp v50, v50, v50 row_half_mirror row_mask:0xf bank_mask:0xf
  s_nop 1
  v_max_f32_dpp v50, v50, v50 row_mirror row_mask:0xf bank_mask:0xf
  v_mov_b32 v47, v50
  s_nop 1
  v_permlane16_swap_b32 v50, v47
  v_max_f32 v50, v50, v47
  v_sub_f32 v48, v36, v50
  v_sub_f32 v49, v44, v50
  v_exp_f32 v48, v48
  v_exp_f32 v49, v49
  s_add_u32 s31, s31, 0x100
  v_fma_f32 v39, v49, s37, v48
  v_cndmask_b32 v41, v48, v49, s[38:39]
  s_nop 0
  v_add_f32_dpp v39, v39, v39 quad_perm:[1,0,3,2] row_mask:0xf bank_mask:0xf
  v_cndmask_b32 v40, v49, v48, s[38:39]
  v_mov_b32_dpp v46, v41 quad_perm:[1,0,3,2] row_mask:0xf bank_mask:0xf
  v_add_f32_dpp v39, v39, v39 quad_perm:[2,3,0,1] row_mask:0xf bank_mask:0xf
  v_cndmask_b32 v42, v46, v40, s[38:39]
  v_cndmask_b32 v43, v40, v46, s[38:39]
  v_add_f32_dpp v39, v39, v39 row_half_mirror row_mask:0xf bank_mask:0xf
  s_nop 1
  v_add_f32_dpp v47, v39, v39 row_mirror row_mask:0xf bank_mask:0xf
  v_add_f32_dpp v39, v39, v39 row_mirror row_mask:0xf bank_mask:0xf
  s_nop 1
  v_permlane16_swap_b32 v39, v47
  v_add_f32 v39, v39, v47
  v_rcp_f32 v39, v39
  s_mov_b64 exec, s[28:29]
  v_mul_f32 v42, v42, v39
  v_mul_f32 v43, v43, v39
  v_cvt_pk_bf16_f32 v42, v42, v43
  v_min_u32 v42, -2, v42
  s_branch cA_sc1_pst
cA_sc1_retry:
  s_cmp_lg_u32 s62, 0
  s_cbranch_scc1 cA_sc1_cont
  s_waitcnt vmcnt(0) lgkmcnt(0)
cA_sc1_rv:
  buffer_load_dwordx4 v[8:11], v2, s[8:11], s20 offen offset:0 sc1
  buffer_load_dwordx4 v[12:15], v2, s[8:11], s20 offen offset:1024 sc1
  buffer_load_dwordx4 v[16:19], v2, s[8:11], s20 offen offset:2048 sc1
  buffer_load_dwordx4 v[20:23], v2, s[8:11], s20 offen offset:3072 sc1
  buffer_load_dwordx4 v[24:27], v2, s[8:11], s23 offen offset:0 sc1
  buffer_load_dwordx4 v[28:31], v2, s[8:11], s23 offen offset:1024 sc1
  buffer_load_dwordx4 v[32:35], v2, s[8:11], s23 offen offset:2048 sc1
  s_waitcnt vmcnt(0)
  v_max3_u32 v68, v8, v9, v10
  v_max3_u32 v68, v68, v11, v12
  v_max3_u32 v68, v68, v13, v14
  v_max3_u32 v68, v68, v15, v16
  v_max3_u32 v68, v68, v17, v18
  v_max3_u32 v68, v68, v19, v20
  v_max3_u32 v68, v68, v21, v22
  v_max3_u32 v68, v68, v23, v24
  v_max3_u32 v68, v68, v25, v26
  v_max3_u32 v68, v68, v27, v28
  v_max3_u32 v68, v68, v29, v30
  v_max3_u32 v68, v68, v31, v32
  v_max3_u32 v68, v68, v33, v34
  v_max_u32 v68, v68, v35
  v_cmp_eq_u32 vcc, -1, v68
  s_cbranch_vccz cA_sc1_rk
  s_add_u32 s30, s30, 1
  s_cmp_lt_u32 s30, 400000
  s_cbranch_scc1 cA_sc1_rv
  s_branch cA_abort
cA_sc1_rk:
  s_mov_b32 s62, 1
  v_mov_b32 v36, 0
  v_mov_b32 v37, 0
  v_mov_b32 v38, 0
  v_mov_b32 v39, 0
  v_mov_b32 v40, 0
  v_mov_b32 v41, 0
  v_mov_b32 v42, 0
  v_mov_b32 v43, 0
  v_mov_b32 v44, 0
  v_mov_b32 v45, 0
  v_mov_b32 v46, 0
  v_mov_b32 v47, 0
  v_mov_b32 v48, 0
  v_mov_b32 v49, 0
  v_mov_b32 v50, 0
  v_mov_b32 v51, 0
  v_mov_b32 v52, 0
  v_mov_b32 v53, 0
  v_mov_b32 v54, 0
  v_mov_b32 v55, 0
  v_mov_b32 v56, 0
  v_mov_b32 v57, 0
  v_mov_b32 v58, 0
  v_mov_b32 v59, 0
  v_mov_b32 v60, 0
  v_mov_b32 v61, 0
  v_mov_b32 v62, 0
  v_mov_b32 v63, 0
  v_mov_b32 v88, 0
  v_mov_b32 v89, 0
  v_mov_b32 v90, 0
  v_mov_b32 v91, 0
  v_mov_b32 v92, 0
  v_mov_b32 v93, 0
  v_mov_b32 v94, 0
  v_mov_b32 v95, 0
  v_mov_b32 v64, 0
  v_mov_b32 v65, 0
  s_add_u32 s31, s31, 1
  ds_read_b128 v[96:99], v117 offset:0
  ds_read_b128 v[100:103], v117 offset:1024
  ds_read_b128 v[104:107], v117 offset:14336
  ds_read_b128 v[108:111], v117 offset:15360
  v_smfmac_f32_16x16x64_bf16 v[36:39], v[8:11], a[0:7], v3
  v_smfmac_f32_16x16x64_bf16 v[40:43], v[8:11], a[56:63], v3
  v_smfmac_f32_16x16x64_bf16 v[44:47], v[8:11], a[112:119], v3
  v_smfmac_f32_16x16x64_bf16 v[48:51], v[8:11], a[168:175], v3
  v_smfmac_f32_16x16x64_bf16 v[52:55], v[8:11], a[224:231], v3
  v_smfmac_f32_16x16x64_bf16 v[56:59], v[8:11], v[144:151], v3
  v_smfmac_f32_16x16x64_bf16 v[60:63], v[8:11], v[200:207], v3
  v_smfmac_f32_16x16x64_bf16 v[36:39], v[12:15], a[8:15], v3
  v_smfmac_f32_16x16x64_bf16 v[40:43], v[12:15], a[64:71], v3
  v_smfmac_f32_16x16x64_bf16 v[44:47], v[12:15], a[120:127], v3
  v_smfmac_f32_16x16x64_bf16 v[48:51], v[12:15], a[176:183], v3
  v_smfmac_f32_16x16x64_bf16 v[52:55], v[12:15], a[232:239], v3
  v_smfmac_f32_16x16x64_bf16 v[56:59], v[12:15], v[152:159], v3
  v_smfmac_f32_16x16x64_bf16 v[60:63], v[12:15], v[208:215], v3
  v_smfmac_f32_16x16x64_bf16 v[36:39], v[16:19], a[16:23], v3
  v_smfmac_f32_16x16x64_bf16 v[40:43], v[16:19], a[72:79], v3
  v_smfmac_f32_16x16x64_bf16 v[44:47], v[16:19], a[128:135], v3
  v_smfmac_f32_16x16x64_bf16 v[48:51], v[16:19], a[184:191], v3
  v_smfmac_f32_16x16x64_bf16 v[52:55], v[16:19], a[240:247], v3
  v_smfmac_f32_16x16x64_bf16 v[56:59], v[16:19], v[160:167], v3
  v_smfmac_f32_16x16x64_bf16 v[60:63], v[16:19], v[216:223], v3
  v_smfmac_f32_16x16x64_bf16 v[36:39], v[20:23], a[24:31], v3
  v_smfmac_f32_16x16x64_bf16 v[40:43], v[20:23], a[80:87], v3
  v_smfmac_f32_16x16x64_bf16 v[44:47], v[20:23], a[136:143], v3
  v_smfmac_f32_16x16x64_bf16 v[48:51], v[20:23], a[192:199], v3
  v_smfmac_f32_16x16x64_bf16 v[52:55], v[20:23], a[248:255], v3
  v_smfmac_f32_16x16x64_bf16 v[56:59], v[20:23], v[168:175], v3
  v_smfmac_f32_16x16x64_bf16 v[60:63], v[20:23], v[224:231], v3
  s_xor_b32 s58, s25, 28672
  s_add_u32 s59, s24, 28672
  s_add_u32 m0, s58, 7168
  s_branch cA_sc1_ph2
.p2align 6

cA_sc2_loop:
  s_add_u32 s23, s20, 4096
  s_add_u32 s21, s20, 20480
  v_mov_b32 v48, 0
  v_mov_b32 v49, 0
  v_mov_b32 v50, 0
  v_mov_b32 v51, 0
  v_mov_b32 v52, 0
  v_mov_b32 v53, 0
  v_mov_b32 v54, 0
  v_mov_b32 v55, 0
  v_mov_b32 v56, 0
  v_mov_b32 v57, 0
  v_mov_b32 v58, 0
  v_mov_b32 v59, 0
  v_mov_b32 v60, 0
  v_mov_b32 v61, 0
  v_mov_b32 v62, 0
  v_mov_b32 v63, 0
  v_mov_b32 v88, 0
  v_mov_b32 v89, 0
  v_mov_b32 v90, 0
  v_mov_b32 v91, 0
  v_mov_b32 v92, 0
  v_mov_b32 v93, 0
  v_mov_b32 v94, 0
  v_mov_b32 v95, 0
  v_mov_b32 v66, 0
  v_mov_b32 v67, 0
  s_mov_b32 s30, 0
  s_mov_b32 s62, 0
  s_waitcnt vmcnt(0)
  s_barrier
cA_sc2_ld:
  buffer_load_dwordx4 v[8:11], v2, s[8:11], s20 offen offset:0
  v_mov_b32 v36, 0
  v_mov_b32 v37, 0
  v_mov_b32 v38, 0
  v_mov_b32 v39, 0
  buffer_load_dwordx4 v[12:15], v2, s[8:11], s20 offen offset:1024
  v_mov_b32 v40, 0
  v_mov_b32 v41, 0
  v_mov_b32 v42, 0
  v_mov_b32 v43, 0
  buffer_load_dwordx4 v[16:19], v2, s[8:11], s20 offen offset:2048
  v_mov_b32 v44, 0
  v_mov_b32 v45, 0
  v_mov_b32 v46, 0
  v_mov_b32 v47, 0
  ds_read_b128 v[96:99], v117 offset:0
  ds_read_b128 v[100:103], v117 offset:1024
  ds_read_b128 v[104:107], v117 offset:14336
  ds_read_b128 v[108:111], v117 offset:15360
  s_waitcnt vmcnt(2)
  v_smfmac_f32_16x16x64_bf16 v[36:39], v[8:11], a[0:7], v3
  v_smfmac_f32_16x16x64_bf16 v[40:43], v[8:11], a[56:63], v3
  buffer_load_dwordx4 v[20:23], v2, s[8:11], s20 offen offset:3072
  v_smfmac_f32_16x16x64_bf16 v[44:47], v[8:11], a[112:119], v3
  v_smfmac_f32_16x16x64_bf16 v[48:51], v[8:11], a[168:175], v3
  v_smfmac_f32_16x16x64_bf16 v[52:55], v[8:11], a[224:231], v3
  buffer_load_dwordx4 v[24:27], v2, s[8:11], s23 offen offset:0
  v_smfmac_f32_16x16x64_bf16 v[56:59], v[8:11], v[144:151], v3
  v_smfmac_f32_16x16x64_bf16 v[60:63], v[8:11], v[200:207], v3
  s_waitcnt vmcnt(3)
  v_smfmac_f32_16x16x64_bf16 v[36:39], v[12:15], a[8:15], v3
  v_smfmac_f32_16x16x64_bf16 v[40:43], v[12:15], a[64:71], v3
  buffer_load_dwordx4 v[28:31], v2, s[8:11], s23 offen offset:1024
  v_smfmac_f32_16x16x64_bf16 v[44:47], v[12:15], a[120:127], v3
  v_smfmac_f32_16x16x64_bf16 v[48:51], v[12:15], a[176:183], v3
  v_smfmac_f32_16x16x64_bf16 v[52:55], v[12:15], a[232:239], v3
  buffer_load_dwordx4 v[32:35], v2, s[8:11], s23 offen offset:2048
  v_smfmac_f32_16x16x64_bf16 v[56:59], v[12:15], v[152:159], v3
  v_smfmac_f32_16x16x64_bf16 v[60:63], v[12:15], v[208:215], v3
  s_waitcnt vmcnt(4)
  v_smfmac_f32_16x16x64_bf16 v[36:39], v[16:19], a[16:23], v3
  v_smfmac_f32_16x16x64_bf16 v[40:43], v[16:19], a[72:79], v3
  s_xor_b32 s58, s25, 28672
  s_add_u32 s59, s24, 28672
  s_add_u32 m0, s58, 14336
  v_smfmac_f32_16x16x64_bf16 v[44:47], v[16:19], a[128:135], v3
  buffer_load_dwordx4 v2, s[8:11], s59 offen offset:0 sc1 lds
  v_smfmac_f32_16x16x64_bf16 v[48:51], v[16:19], a[184:191], v3
  v_smfmac_f32_16x16x64_bf16 v[52:55], v[16:19], a[240:247], v3
  v_smfmac_f32_16x16x64_bf16 v[56:59], v[16:19], v[160:167], v3
  v_smfmac_f32_16x16x64_bf16 v[60:63], v[16:19], v[216:223], v3
  buffer_load_dwordx4 v2, s[8:11], s59 offen offset:1024 sc1 lds
  s_waitcnt vmcnt(5)
  v_smfmac_f32_16x16x64_bf16 v[36:39], v[20:23], a[24:31], v3
  v_smfmac_f32_16x16x64_bf16 v[40:43], v[20:23], a[80:87], v3
  v_smfmac_f32_16x16x64_bf16 v[44:47], v[20:23], a[136:143], v3
  v_smfmac_f32_16x16x64_bf16 v[48:51], v[20:23], a[192:199], v3
  buffer_load_dwordx4 v2, s[8:11], s59 offen offset:2048 sc1 lds
  v_smfmac_f32_16x16x64_bf16 v[52:55], v[20:23], a[248:255], v3
  v_smfmac_f32_16x16x64_bf16 v[56:59], v[20:23], v[168:175], v3
  v_smfmac_f32_16x16x64_bf16 v[60:63], v[20:23], v[224:231], v3
  s_waitcnt vmcnt(3)
cA_sc2_ph2:
  v_smfmac_f32_16x16x64_bf16 v[60:63], v[24:27], v[232:239], v3
  buffer_load_dwordx4 v2, s[8:11], s59 offen offset:3072 sc1 lds
  ds_read_b128 v[8:11], v116 offset:4096
  ds_read_b128 v[12:15], v116 offset:5120
  v_smfmac_f32_16x16x64_bf16 v[60:63], v[28:31], v[240:247], v3
  buffer_load_dword v119, v0, s[8:11], s24 offen sc1
  v_smfmac_f32_16x16x64_bf16 v[60:63], v[32:35], v[248:255], v3
  v_mov_b32 v80, v28
  v_smfmac_f32_16x16x64_bf16 v[52:55], v[24:27], v[120:127], v3
  v_mov_b32 v81, v29
  v_smfmac_f32_16x16x64_bf16 v[52:55], v[28:31], v[128:135], v3
  v_mov_b32 v82, v34
  v_smfmac_f32_16x16x64_bf16 v[52:55], v[32:35], v[136:143], v3
  v_cvt_pk_bf16_f32 v64, v60, v61
  v_smfmac_f32_16x16x64_bf16 v[56:59], v[24:27], v[176:183], v3
  v_cvt_pk_bf16_f32 v65, v62, v63
  v_smfmac_f32_16x16x64_bf16 v[56:59], v[28:31], v[184:191], v3
  v_mov_b32 v83, v35
  v_mfma_f32_16x16x32_bf16 v[68:71], v[64:67], v[4:7], 0
  v_smfmac_f32_16x16x64_bf16 v[56:59], v[32:35], v[192:199], v3
  v_cvt_pk_bf16_f32 v64, v52, v53
  v_smfmac_f32_16x16x64_bf16 v[36:39], v[24:27], a[32:39], v3
  v_cvt_pk_bf16_f32 v65, v54, v55
  v_smfmac_f32_16x16x64_bf16 v[36:39], v[28:31], a[40:47], v3
  v_cvt_pk_bf16_f32 v78, v68, v69
  v_smfmac_f32_16x16x64_bf16 v[36:39], v[32:35], a[48:55], v3
  v_cvt_pk_bf16_f32 v79, v70, v71
  v_cvt_pk_bf16_f32 v66, v56, v57
  v_smfmac_f32_16x16x64_bf16 v[40:43], v[24:27], a[88:95], v3
  v_cvt_pk_bf16_f32 v67, v58, v59
  v_smfmac_f32_16x16x64_bf16 v[40:43], v[28:31], a[96:103], v3
  v_mfma_f32_16x16x32_bf16 v[72:75], v[64:67], v[4:7], 0
  ds_read_b128 v[52:55], v116 offset:18432
  ds_read_b128 v[56:59], v116 offset:19456
  v_smfmac_f32_16x16x64_bf16 v[40:43], v[32:35], a[104:111], v3
  v_cvt_pk_bf16_f32 v64, v36, v37
  v_smfmac_f32_16x16x64_bf16 v[44:47], v[24:27], a[144:151], v3
  v_cvt_pk_bf16_f32 v65, v38, v39
  v_smfmac_f32_16x16x64_bf16 v[44:47], v[28:31], a[152:159], v3
  v_cvt_pk_bf16_f32 v76, v72, v73
  v_smfmac_f32_16x16x64_bf16 v[44:47], v[32:35], a[160:167], v3
  v_cvt_pk_bf16_f32 v77, v74, v75
  v_cvt_pk_bf16_f32 v66, v40, v41
  v_smfmac_f32_16x16x64_bf16 v[48:51], v[24:27], a[200:207], v3
  v_cvt_pk_bf16_f32 v67, v42, v43
  v_smfmac_f32_16x16x64_bf16 v[48:51], v[28:31], a[208:215], v3
  v_mfma_f32_16x16x32_bf16 v[68:71], v[64:67], v[4:7], 0
  v_smfmac_f32_16x16x64_bf16 v[48:51], v[32:35], a[216:223], v3
  v_cvt_pk_bf16_f32 v64, v44, v45
  v_mfma_f32_16x16x32_bf16 v[84:87], v[80:83], v[76:79], 0
  v_cvt_pk_bf16_f32 v65, v46, v47
  s_waitcnt lgkmcnt(0)
  v_smfmac_f32_16x16x64_bf16 v[88:91], v[76:79], v[96:103], v118
  v_cvt_pk_bf16_f32 v60, v68, v69
  v_cvt_pk_bf16_f32 v61, v70, v71
  v_cvt_pk_bf16_f32 v66, v48, v49
  v_cvt_pk_bf16_f32 v67, v50, v51
  s_nop 1
  v_mfma_f32_16x16x32_bf16 v[72:75], v[64:67], v[4:7], 0
  v_smfmac_f32_16x16x64_bf16 v[92:95], v[76:79], v[104:111], v118
  s_nop 4
  v_cvt_pk_bf16_f32 v62, v72, v73
  v_cvt_pk_bf16_f32 v63, v74, v75
  s_nop 1
  v_mfma_f32_16x16x32_bf16 v[84:87], v[16:19], v[60:63], v[84:87]
  v_smfmac_f32_16x16x64_bf16 v[88:91], v[60:63], v[8:15], v118
  v_smfmac_f32_16x16x64_bf16 v[92:95], v[60:63], v[52:59], v118
  s_nop 1
  v_permlane32_swap_b32 v84, v86
  v_permlane32_swap_b32 v85, v87
  s_nop 0
  v_add_f32 v88, v88, v89
  v_add_f32_dpp v84, v86, v84 quad_perm:[1,0,3,2] row_mask:0xf bank_mask:0xf
  v_add_f32_dpp v85, v87, v85 quad_perm:[1,0,3,2] row_mask:0xf bank_mask:0xf
  v_add_f32 v89, v90, v91
  ds_write2_b32 v113, v84, v85 offset0:0 offset1:4
  ds_write2_b32 v112, v88, v89 offset0:0 offset1:128
  v_add_f32 v90, v92, v93
  v_add_f32 v91, v94, v95
  ds_write2_b32 v112, v90, v91 offset0:64 offset1:192
  v_cmp_u_f32 vcc, v88, v89
  s_cbranch_vccnz cA_sc2_retry
cA_sc2_cont:
  s_waitcnt lgkmcnt(0)
  s_barrier
  ds_read_b128 v[36:39], v114
  ds_read_b128 v[44:47], v115
  v_lshl_add_u32 v56, v2, 3, s36
  s_waitcnt lgkmcnt(0)
  v_add_f32 v36, v36, v38
  v_add_f32 v37, v37, v39
  v_add_f32 v44, v44, v45
  s_mov_b64 exec, 15
  buffer_store_dword v2, v56, s[8:11], s20 offen
  s_mov_b64 exec, -1
  v_add_f32 v46, v46, v47
  v_add_f32 v44, v44, v46
  v_add_f32 v36, v36, v37
  v_exp_f32 v49, v44
  v_exp_f32 v48, v36
  v_add_f32 v50, abs(v36), abs(v44)
  v_fma_f32 v39, v49, s37, v48
  v_cmp_ngt_f32 vcc, s56, v50
  v_cndmask_b32 v41, v48, v49, s[38:39]
  v_add_f32_dpp v39, v39, v39 quad_perm:[1,0,3,2] row_mask:0xf bank_mask:0xf
  v_cndmask_b32 v40, v49, v48, s[38:39]
  v_mov_b32_dpp v46, v41 quad_perm:[1,0,3,2] row_mask:0xf bank_mask:0xf
  v_add_f32_dpp v39, v39, v39 quad_perm:[2,3,0,1] row_mask:0xf bank_mask:0xf
  v_cndmask_b32 v42, v46, v40, s[38:39]
  v_cndmask_b32 v43, v40, v46, s[38:39]
  v_add_f32_dpp v39, v39, v39 row_half_mirror row_mask:0xf bank_mask:0xf
  s_cbranch_vccnz cA_sc2_slow
  s_nop 0
  v_add_f32_dpp v47, v39, v39 row_mirror row_mask:0xf bank_mask:0xf
  v_add_f32_dpp v39, v39, v39 row_mirror row_mask:0xf bank_mask:0xf
  s_nop 1
  v_permlane16_swap_b32 v39, v47
  v_add_f32 v39, v39, v47
  v_rcp_f32 v39, v39
  s_mov_b64 exec, s[28:29]
  v_mul_f32 v42, v42, v39
  v_mul_f32 v43, v43, v39
  v_cvt_pk_bf16_f32 v42, v42, v43
cA_sc2_pst:
  buffer_store_dword v42, v1, s[8:11], s20 offen
  s_mov_b64 exec, -1
  s_barrier
  s_cmp_lg_u32 s19, 0
  s_cbranch_scc1 cA_sc2_s0
  s_sub_u32 s36, s36, 64
  v_lshl_add_u32 v56, v2, 3, s36
  s_mov_b64 exec, 15
  buffer_store_dword v2, v56, s[8:11], s20 offen
  s_mov_b64 exec, -1
cA_sc2_s0:
  s_add_u32 s24, s24, 28672
  s_add_u32 s35, s35, 28672
  s_xor_b32 s25, s25, 28672
  s_add_u32 m0, s25, 14336
  s_add_u32 m0, s25, 18432
  s_add_u32 s22, s24, 4096
  buffer_load_dwordx4 v2, s[8:11], s22 offen offset:0 sc1 lds
  s_nop 5
  buffer_load_dwordx4 v2, s[8:11], s22 offen offset:1024 sc1 lds
  s_nop 5
  buffer_load_dwordx4 v2, s[8:11], s22 offen offset:2048 sc1 lds
  s_nop 5
  v_xor_b32 v116, 28672, v116
  v_add_u32 v117, s57, v117
  s_sub_u32 s57, 0, s57
  s_add_u32 s19, s19, 1
  s_mov_b32 s20, s21
  s_cmp_lt_u32 s19, 63
  s_cbranch_scc1 cA_sc2_loop
  s_branch cA_done
cA_sc2_slow:
  v_max_f32 v50, v36, v44
  s_nop 1
  v_max_f32_dpp v50, v50, v50 quad_perm:[1,0,3,2] row_mask:0xf bank_mask:0xf
  s_nop 1
  v_max_f32_dpp v50, v50, v50 quad_perm:[2,3,0,1] row_mask:0xf bank_mask:0xf
  s_nop 1
  v_max_f32_dpp v50, v50, v50 row_half_mirror row_mask:0xf bank_mask:0xf
  s_nop 1
  v_max_f32_dpp v50, v50, v50 row_mirror row_mask:0xf bank_mask:0xf
  v_mov_b32 v47, v50
  s_nop 1
  v_permlane16_swap_b32 v50, v47
  v_max_f32 v50, v50, v47
  v_sub_f32 v48, v36, v50
  v_sub_f32 v49, v44, v50
  v_exp_f32 v48, v48
  v_exp_f32 v49, v49
  s_add_u32 s31, s31, 0x100
  v_fma_f32 v39, v49, s37, v48
  v_cndmask_b32 v41, v48, v49, s[38:39]
  s_nop 0
  v_add_f32_dpp v39, v39, v39 quad_perm:[1,0,3,2] row_mask:0xf bank_mask:0xf
  v_cndmask_b32 v40, v49, v48, s[38:39]
  v_mov_b32_dpp v46, v41 quad_perm:[1,0,3,2] row_mask:0xf bank_mask:0xf
  v_add_f32_dpp v39, v39, v39 quad_perm:[2,3,0,1] row_mask:0xf bank_mask:0xf
  v_cndmask_b32 v42, v46, v40, s[38:39]
  v_cndmask_b32 v43, v40, v46, s[38:39]
  v_add_f32_dpp v39, v39, v39 row_half_mirror row_mask:0xf bank_mask:0xf
  s_nop 1
  v_add_f32_dpp v47, v39, v39 row_mirror row_mask:0xf bank_mask:0xf
  v_add_f32_dpp v39, v39, v39 row_mirror row_mask:0xf bank_mask:0xf
  s_nop 1
  v_permlane16_swap_b32 v39, v47
  v_add_f32 v39, v39, v47
  v_rcp_f32 v39, v39
  s_mov_b64 exec, s[28:29]
  v_mul_f32 v42, v42, v39
  v_mul_f32 v43, v43, v39
  v_cvt_pk_bf16_f32 v42, v42, v43
  v_min_u32 v42, -2, v42
  s_branch cA_sc2_pst
cA_sc2_retry:
  s_cmp_lg_u32 s62, 0
  s_cbranch_scc1 cA_sc2_cont
  s_waitcnt vmcnt(0) lgkmcnt(0)
cA_sc2_rv:
  buffer_load_dwordx4 v[8:11], v2, s[8:11], s20 offen offset:0 sc1
  buffer_load_dwordx4 v[12:15], v2, s[8:11], s20 offen offset:1024 sc1
  buffer_load_dwordx4 v[16:19], v2, s[8:11], s20 offen offset:2048 sc1
  buffer_load_dwordx4 v[20:23], v2, s[8:11], s20 offen offset:3072 sc1
  buffer_load_dwordx4 v[24:27], v2, s[8:11], s23 offen offset:0 sc1
  buffer_load_dwordx4 v[28:31], v2, s[8:11], s23 offen offset:1024 sc1
  buffer_load_dwordx4 v[32:35], v2, s[8:11], s23 offen offset:2048 sc1
  s_waitcnt vmcnt(0)
  v_max3_u32 v68, v8, v9, v10
  v_max3_u32 v68, v68, v11, v12
  v_max3_u32 v68, v68, v13, v14
  v_max3_u32 v68, v68, v15, v16
  v_max3_u32 v68, v68, v17, v18
  v_max3_u32 v68, v68, v19, v20
  v_max3_u32 v68, v68, v21, v22
  v_max3_u32 v68, v68, v23, v24
  v_max3_u32 v68, v68, v25, v26
  v_max3_u32 v68, v68, v27, v28
  v_max3_u32 v68, v68, v29, v30
  v_max3_u32 v68, v68, v31, v32
  v_max3_u32 v68, v68, v33, v34
  v_max_u32 v68, v68, v35
  v_cmp_eq_u32 vcc, -1, v68
  s_cbranch_vccz cA_sc2_rk
  s_add_u32 s30, s30, 1
  s_cmp_lt_u32 s30, 400000
  s_cbranch_scc1 cA_sc2_rv
  s_branch cA_abort
cA_sc2_rk:
  s_mov_b32 s62, 1
  v_mov_b32 v36, 0
  v_mov_b32 v37, 0
  v_mov_b32 v38, 0
  v_mov_b32 v39, 0
  v_mov_b32 v40, 0
  v_mov_b32 v41, 0
  v_mov_b32 v42, 0
  v_mov_b32 v43, 0
  v_mov_b32 v44, 0
  v_mov_b32 v45, 0
  v_mov_b32 v46, 0
  v_mov_b32 v47, 0
  v_mov_b32 v48, 0
  v_mov_b32 v49, 0
  v_mov_b32 v50, 0
  v_mov_b32 v51, 0
  v_mov_b32 v52, 0
  v_mov_b32 v53, 0
  v_mov_b32 v54, 0
  v_mov_b32 v55, 0
  v_mov_b32 v56, 0
  v_mov_b32 v57, 0
  v_mov_b32 v58, 0
  v_mov_b32 v59, 0
  v_mov_b32 v60, 0
  v_mov_b32 v61, 0
  v_mov_b32 v62, 0
  v_mov_b32 v63, 0
  v_mov_b32 v88, 0
  v_mov_b32 v89, 0
  v_mov_b32 v90, 0
  v_mov_b32 v91, 0
  v_mov_b32 v92, 0
  v_mov_b32 v93, 0
  v_mov_b32 v94, 0
  v_mov_b32 v95, 0
  v_mov_b32 v66, 0
  v_mov_b32 v67, 0
  s_add_u32 s31, s31, 1
  ds_read_b128 v[96:99], v117 offset:0
  ds_read_b128 v[100:103], v117 offset:1024
  ds_read_b128 v[104:107], v117 offset:14336
  ds_read_b128 v[108:111], v117 offset:15360
  v_smfmac_f32_16x16x64_bf16 v[36:39], v[8:11], a[0:7], v3
  v_smfmac_f32_16x16x64_bf16 v[40:43], v[8:11], a[56:63], v3
  v_smfmac_f32_16x16x64_bf16 v[44:47], v[8:11], a[112:119], v3
  v_smfmac_f32_16x16x64_bf16 v[48:51], v[8:11], a[168:175], v3
  v_smfmac_f32_16x16x64_bf16 v[52:55], v[8:11], a[224:231], v3
  v_smfmac_f32_16x16x64_bf16 v[56:59], v[8:11], v[144:151], v3
  v_smfmac_f32_16x16x64_bf16 v[60:63], v[8:11], v[200:207], v3
  v_smfmac_f32_16x16x64_bf16 v[36:39], v[12:15], a[8:15], v3
  v_smfmac_f32_16x16x64_bf16 v[40:43], v[12:15], a[64:71], v3
  v_smfmac_f32_16x16x64_bf16 v[44:47], v[12:15], a[120:127], v3
  v_smfmac_f32_16x16x64_bf16 v[48:51], v[12:15], a[176:183], v3
  v_smfmac_f32_16x16x64_bf16 v[52:55], v[12:15], a[232:239], v3
  v_smfmac_f32_16x16x64_bf16 v[56:59], v[12:15], v[152:159], v3
  v_smfmac_f32_16x16x64_bf16 v[60:63], v[12:15], v[208:215], v3
  v_smfmac_f32_16x16x64_bf16 v[36:39], v[16:19], a[16:23], v3
  v_smfmac_f32_16x16x64_bf16 v[40:43], v[16:19], a[72:79], v3
  v_smfmac_f32_16x16x64_bf16 v[44:47], v[16:19], a[128:135], v3
  v_smfmac_f32_16x16x64_bf16 v[48:51], v[16:19], a[184:191], v3
  v_smfmac_f32_16x16x64_bf16 v[52:55], v[16:19], a[240:247], v3
  v_smfmac_f32_16x16x64_bf16 v[56:59], v[16:19], v[160:167], v3
  v_smfmac_f32_16x16x64_bf16 v[60:63], v[16:19], v[216:223], v3
  v_smfmac_f32_16x16x64_bf16 v[36:39], v[20:23], a[24:31], v3
  v_smfmac_f32_16x16x64_bf16 v[40:43], v[20:23], a[80:87], v3
  v_smfmac_f32_16x16x64_bf16 v[44:47], v[20:23], a[136:143], v3
  v_smfmac_f32_16x16x64_bf16 v[48:51], v[20:23], a[192:199], v3
  v_smfmac_f32_16x16x64_bf16 v[52:55], v[20:23], a[248:255], v3
  v_smfmac_f32_16x16x64_bf16 v[56:59], v[20:23], v[168:175], v3
  v_smfmac_f32_16x16x64_bf16 v[60:63], v[20:23], v[224:231], v3
  s_xor_b32 s58, s25, 28672
  s_add_u32 s59, s24, 28672
  s_add_u32 m0, s58, 14336
  s_branch cA_sc2_ph2
.p2align 6

cA_sc3_loop:
  s_add_u32 s23, s20, 4096
  s_add_u32 s21, s20, 20480
  v_mov_b32 v48, 0
  v_mov_b32 v49, 0
  v_mov_b32 v50, 0
  v_mov_b32 v51, 0
  v_mov_b32 v52, 0
  v_mov_b32 v53, 0
  v_mov_b32 v54, 0
  v_mov_b32 v55, 0
  v_mov_b32 v56, 0
  v_mov_b32 v57, 0
  v_mov_b32 v58, 0
  v_mov_b32 v59, 0
  v_mov_b32 v60, 0
  v_mov_b32 v61, 0
  v_mov_b32 v62, 0
  v_mov_b32 v63, 0
  v_mov_b32 v88, 0
  v_mov_b32 v89, 0
  v_mov_b32 v90, 0
  v_mov_b32 v91, 0
  v_mov_b32 v92, 0
  v_mov_b32 v93, 0
  v_mov_b32 v94, 0
  v_mov_b32 v95, 0
  v_mov_b32 v64, 0
  v_mov_b32 v65, 0
  s_mov_b32 s30, 0
  s_mov_b32 s62, 0
  s_waitcnt vmcnt(0)
  s_barrier
cA_sc3_ld:
  buffer_load_dwordx4 v[8:11], v2, s[8:11], s20 offen offset:0
  v_mov_b32 v36, 0
  v_mov_b32 v37, 0
  v_mov_b32 v38, 0
  v_mov_b32 v39, 0
  buffer_load_dwordx4 v[12:15], v2, s[8:11], s20 offen offset:1024
  v_mov_b32 v40, 0
  v_mov_b32 v41, 0
  v_mov_b32 v42, 0
  v_mov_b32 v43, 0
  buffer_load_dwordx4 v[16:19], v2, s[8:11], s20 offen offset:2048
  v_mov_b32 v44, 0
  v_mov_b32 v45, 0
  v_mov_b32 v46, 0
  v_mov_b32 v47, 0
  ds_read_b128 v[96:99], v117 offset:0
  ds_read_b128 v[100:103], v117 offset:1024
  ds_read_b128 v[104:107], v117 offset:14336
  ds_read_b128 v[108:111], v117 offset:15360
  s_waitcnt vmcnt(2)
  v_smfmac_f32_16x16x64_bf16 v[36:39], v[8:11], a[0:7], v3
  v_smfmac_f32_16x16x64_bf16 v[40:43], v[8:11], a[56:63], v3
  buffer_load_dwordx4 v[20:23], v2, s[8:11], s20 offen offset:3072
  v_smfmac_f32_16x16x64_bf16 v[44:47], v[8:11], a[112:119], v3
  v_smfmac_f32_16x16x64_bf16 v[48:51], v[8:11], a[168:175], v3
  v_smfmac_f32_16x16x64_bf16 v[52:55], v[8:11], a[224:231], v3
  buffer_load_dwordx4 v[24:27], v2, s[8:11], s23 offen offset:0
  v_smfmac_f32_16x16x64_bf16 v[56:59], v[8:11], v[144:151], v3
  v_smfmac_f32_16x16x64_bf16 v[60:63], v[8:11], v[200:207], v3
  s_waitcnt vmcnt(3)
  v_smfmac_f32_16x16x64_bf16 v[36:39], v[12:15], a[8:15], v3
  v_smfmac_f32_16x16x64_bf16 v[40:43], v[12:15], a[64:71], v3
  buffer_load_dwordx4 v[28:31], v2, s[8:11], s23 offen offset:1024
  v_smfmac_f32_16x16x64_bf16 v[44:47], v[12:15], a[120:127], v3
  v_smfmac_f32_16x16x64_bf16 v[48:51], v[12:15], a[176:183], v3
  v_smfmac_f32_16x16x64_bf16 v[52:55], v[12:15], a[232:239], v3
  buffer_load_dwordx4 v[32:35], v2, s[8:11], s23 offen offset:2048
  v_smfmac_f32_16x16x64_bf16 v[56:59], v[12:15], v[152:159], v3
  v_smfmac_f32_16x16x64_bf16 v[60:63], v[12:15], v[208:215], v3
  s_waitcnt vmcnt(4)
  v_smfmac_f32_16x16x64_bf16 v[36:39], v[16:19], a[16:23], v3
  v_smfmac_f32_16x16x64_bf16 v[40:43], v[16:19], a[72:79], v3
  v_smfmac_f32_16x16x64_bf16 v[44:47], v[16:19], a[128:135], v3
  s_xor_b32 s58, s25, 28672
  s_add_u32 s59, s24, 28672
  s_add_u32 m0, s58, 21504
  v_smfmac_f32_16x16x64_bf16 v[48:51], v[16:19], a[184:191], v3
  buffer_load_dwordx4 v2, s[8:11], s59 offen offset:0 sc1 lds
  v_smfmac_f32_16x16x64_bf16 v[52:55], v[16:19], a[240:247], v3
  v_smfmac_f32_16x16x64_bf16 v[56:59], v[16:19], v[160:167], v3
  v_smfmac_f32_16x16x64_bf16 v[60:63], v[16:19], v[216:223], v3
  s_waitcnt vmcnt(4)
  v_smfmac_f32_16x16x64_bf16 v[36:39], v[20:23], a[24:31], v3
  buffer_load_dwordx4 v2, s[8:11], s59 offen offset:1024 sc1 lds
  v_smfmac_f32_16x16x64_bf16 v[40:43], v[20:23], a[80:87], v3
  v_smfmac_f32_16x16x64_bf16 v[44:47], v[20:23], a[136:143], v3
  v_smfmac_f32_16x16x64_bf16 v[48:51], v[20:23], a[192:199], v3
  v_smfmac_f32_16x16x64_bf16 v[52:55], v[20:23], a[248:255], v3
  buffer_load_dwordx4 v2, s[8:11], s59 offen offset:2048 sc1 lds
  v_smfmac_f32_16x16x64_bf16 v[56:59], v[20:23], v[168:175], v3
  v_smfmac_f32_16x16x64_bf16 v[60:63], v[20:23], v[224:231], v3
  s_waitcnt vmcnt(3)
cA_sc3_ph2:
  v_smfmac_f32_16x16x64_bf16 v[60:63], v[24:27], v[232:239], v3
  ds_read_b128 v[8:11], v116 offset:6144
  ds_read_b128 v[12:15], v116 offset:7168
  v_smfmac_f32_16x16x64_bf16 v[60:63], v[28:31], v[240:247], v3
  buffer_load_dwordx4 v2, s[8:11], s59 offen offset:3072 sc1 lds
  v_smfmac_f32_16x16x64_bf16 v[60:63], v[32:35], v[248:255], v3
  v_mov_b32 v80, v30
  v_smfmac_f32_16x16x64_bf16 v[52:55], v[24:27], v[120:127], v3
  v_mov_b32 v81, v31
  v_smfmac_f32_16x16x64_bf16 v[52:55], v[28:31], v[128:135], v3
  v_mov_b32 v82, v34
  v_smfmac_f32_16x16x64_bf16 v[52:55], v[32:35], v[136:143], v3
  v_cvt_pk_bf16_f32 v66, v60, v61
  v_smfmac_f32_16x16x64_bf16 v[56:59], v[24:27], v[176:183], v3
  v_cvt_pk_bf16_f32 v67, v62, v63
  v_smfmac_f32_16x16x64_bf16 v[56:59], v[28:31], v[184:191], v3
  v_mov_b32 v83, v35
  v_mfma_f32_16x16x32_bf16 v[68:71], v[64:67], v[4:7], 0
  v_smfmac_f32_16x16x64_bf16 v[56:59], v[32:35], v[192:199], v3
  v_cvt_pk_bf16_f32 v64, v52, v53
  v_smfmac_f32_16x16x64_bf16 v[36:39], v[24:27], a[32:39], v3
  v_cvt_pk_bf16_f32 v65, v54, v55
  v_smfmac_f32_16x16x64_bf16 v[36:39], v[28:31], a[40:47], v3
  v_cvt_pk_bf16_f32 v78, v68, v69
  v_smfmac_f32_16x16x64_bf16 v[36:39], v[32:35], a[48:55], v3
  v_cvt_pk_bf16_f32 v79, v70, v71
  v_cvt_pk_bf16_f32 v66, v56, v57
  v_smfmac_f32_16x16x64_bf16 v[40:43], v[24:27], a[88:95], v3
  v_cvt_pk_bf16_f32 v67, v58, v59
  v_smfmac_f32_16x16x64_bf16 v[40:43], v[28:31], a[96:103], v3
  v_mfma_f32_16x16x32_bf16 v[72:75], v[64:67], v[4:7], 0
  ds_read_b128 v[52:55], v116 offset:20480
  ds_read_b128 v[56:59], v116 offset:21504
  v_smfmac_f32_16x16x64_bf16 v[40:43], v[32:35], a[104:111], v3
  v_cvt_pk_bf16_f32 v64, v36, v37
  v_smfmac_f32_16x16x64_bf16 v[44:47], v[24:27], a[144:151], v3
  v_cvt_pk_bf16_f32 v65, v38, v39
  v_smfmac_f32_16x16x64_bf16 v[44:47], v[28:31], a[152:159], v3
  v_cvt_pk_bf16_f32 v76, v72, v73
  v_smfmac_f32_16x16x64_bf16 v[44:47], v[32:35], a[160:167], v3
  v_cvt_pk_bf16_f32 v77, v74, v75
  v_cvt_pk_bf16_f32 v66, v40, v41
  v_smfmac_f32_16x16x64_bf16 v[48:51], v[24:27], a[200:207], v3
  v_cvt_pk_bf16_f32 v67, v42, v43
  v_smfmac_f32_16x16x64_bf16 v[48:51], v[28:31], a[208:215], v3
  v_mfma_f32_16x16x32_bf16 v[68:71], v[64:67], v[4:7], 0
  v_smfmac_f32_16x16x64_bf16 v[48:51], v[32:35], a[216:223], v3
  v_cvt_pk_bf16_f32 v64, v44, v45
  v_mfma_f32_16x16x32_bf16 v[84:87], v[80:83], v[76:79], 0
  v_cvt_pk_bf16_f32 v65, v46, v47
  s_waitcnt lgkmcnt(0)
  v_smfmac_f32_16x16x64_bf16 v[88:91], v[76:79], v[96:103], v118
  v_cvt_pk_bf16_f32 v60, v68, v69
  v_cvt_pk_bf16_f32 v61, v70, v71
  v_cvt_pk_bf16_f32 v66, v48, v49
  v_cvt_pk_bf16_f32 v67, v50, v51
  s_nop 1
  v_mfma_f32_16x16x32_bf16 v[72:75], v[64:67], v[4:7], 0
  v_smfmac_f32_16x16x64_bf16 v[92:95], v[76:79], v[104:111], v118
  s_nop 4
  v_cvt_pk_bf16_f32 v62, v72, v73
  v_cvt_pk_bf16_f32 v63, v74, v75
  s_nop 1
  v_mfma_f32_16x16x32_bf16 v[84:87], v[20:23], v[60:63], v[84:87]
  v_smfmac_f32_16x16x64_bf16 v[88:91], v[60:63], v[8:15], v118
  v_smfmac_f32_16x16x64_bf16 v[92:95], v[60:63], v[52:59], v118
  s_nop 1
  v_permlane32_swap_b32 v84, v86
  v_permlane32_swap_b32 v85, v87
  s_nop 0
  v_add_f32 v88, v88, v89
  v_add_f32_dpp v84, v86, v84 quad_perm:[1,0,3,2] row_mask:0xf bank_mask:0xf
  v_add_f32_dpp v85, v87, v85 quad_perm:[1,0,3,2] row_mask:0xf bank_mask:0xf
  v_add_f32 v89, v90, v91
  ds_write2_b32 v113, v84, v85 offset0:0 offset1:4
  ds_write2_b32 v112, v88, v89 offset0:0 offset1:128
  v_add_f32 v90, v92, v93
  v_add_f32 v91, v94, v95
  ds_write2_b32 v112, v90, v91 offset0:64 offset1:192
  v_cmp_u_f32 vcc, v88, v89
  s_cbranch_vccnz cA_sc3_retry
cA_sc3_cont:
  s_waitcnt lgkmcnt(0)
  s_barrier
  ds_read_b128 v[36:39], v114
  ds_read_b128 v[44:47], v115
  s_waitcnt lgkmcnt(0)
  v_add_f32 v36, v36, v38
  v_add_f32 v37, v37, v39
  v_add_f32 v44, v44, v45
  v_add_f32 v46, v46, v47
  v_add_f32 v44, v44, v46
  v_add_f32 v36, v36, v37
  v_exp_f32 v49, v44
  v_exp_f32 v48, v36
  v_add_f32 v50, abs(v36), abs(v44)
  v_fma_f32 v39, v49, s37, v48
  v_cmp_ngt_f32 vcc, s56, v50
  v_cndmask_b32 v41, v48, v49, s[38:39]
  v_add_f32_dpp v39, v39, v39 quad_perm:[1,0,3,2] row_mask:0xf bank_mask:0xf
  v_cndmask_b32 v40, v49, v48, s[38:39]
  v_mov_b32_dpp v46, v41 quad_perm:[1,0,3,2] row_mask:0xf bank_mask:0xf
  v_add_f32_dpp v39, v39, v39 quad_perm:[2,3,0,1] row_mask:0xf bank_mask:0xf
  v_cndmask_b32 v42, v46, v40, s[38:39]
  v_cndmask_b32 v43, v40, v46, s[38:39]
  v_add_f32_dpp v39, v39, v39 row_half_mirror row_mask:0xf bank_mask:0xf
  s_cbranch_vccnz cA_sc3_slow
  s_nop 0
  v_add_f32_dpp v47, v39, v39 row_mirror row_mask:0xf bank_mask:0xf
  v_add_f32_dpp v39, v39, v39 row_mirror row_mask:0xf bank_mask:0xf
  s_nop 1
  v_permlane16_swap_b32 v39, v47
  v_add_f32 v39, v39, v47
  v_rcp_f32 v39, v39
  s_mov_b64 exec, s[28:29]
  v_mul_f32 v42, v42, v39
  v_mul_f32 v43, v43, v39
  v_cvt_pk_bf16_f32 v42, v42, v43
cA_sc3_pst:
  buffer_store_dword v42, v1, s[8:11], s20 offen
  s_mov_b64 exec, -1
  s_barrier
  s_add_u32 s24, s24, 28672
  s_add_u32 s35, s35, 28672
  s_xor_b32 s25, s25, 28672
  s_add_u32 m0, s25, 21504
  s_add_u32 m0, s25, 25600
  s_add_u32 s22, s24, 4096
  buffer_load_dwordx4 v2, s[8:11], s22 offen offset:0 sc1 lds
  s_nop 5
  buffer_load_dwordx4 v2, s[8:11], s22 offen offset:1024 sc1 lds
  s_nop 5
  buffer_load_dwordx4 v2, s[8:11], s22 offen offset:2048 sc1 lds
  s_nop 5
  v_xor_b32 v116, 28672, v116
  v_add_u32 v117, s57, v117
  s_sub_u32 s57, 0, s57
  s_add_u32 s19, s19, 1
  s_mov_b32 s20, s21
  s_cmp_lt_u32 s19, 63
  s_cbranch_scc1 cA_sc3_loop
  s_branch cA_done
cA_sc3_slow:
  v_max_f32 v50, v36, v44
  s_nop 1
  v_max_f32_dpp v50, v50, v50 quad_perm:[1,0,3,2] row_mask:0xf bank_mask:0xf
  s_nop 1
  v_max_f32_dpp v50, v50, v50 quad_perm:[2,3,0,1] row_mask:0xf bank_mask:0xf
  s_nop 1
  v_max_f32_dpp v50, v50, v50 row_half_mirror row_mask:0xf bank_mask:0xf
  s_nop 1
  v_max_f32_dpp v50, v50, v50 row_mirror row_mask:0xf bank_mask:0xf
  v_mov_b32 v47, v50
  s_nop 1
  v_permlane16_swap_b32 v50, v47
  v_max_f32 v50, v50, v47
  v_sub_f32 v48, v36, v50
  v_sub_f32 v49, v44, v50
  v_exp_f32 v48, v48
  v_exp_f32 v49, v49
  s_add_u32 s31, s31, 0x100
  v_fma_f32 v39, v49, s37, v48
  v_cndmask_b32 v41, v48, v49, s[38:39]
  s_nop 0
  v_add_f32_dpp v39, v39, v39 quad_perm:[1,0,3,2] row_mask:0xf bank_mask:0xf
  v_cndmask_b32 v40, v49, v48, s[38:39]
  v_mov_b32_dpp v46, v41 quad_perm:[1,0,3,2] row_mask:0xf bank_mask:0xf
  v_add_f32_dpp v39, v39, v39 quad_perm:[2,3,0,1] row_mask:0xf bank_mask:0xf
  v_cndmask_b32 v42, v46, v40, s[38:39]
  v_cndmask_b32 v43, v40, v46, s[38:39]
  v_add_f32_dpp v39, v39, v39 row_half_mirror row_mask:0xf bank_mask:0xf
  s_nop 1
  v_add_f32_dpp v47, v39, v39 row_mirror row_mask:0xf bank_mask:0xf
  v_add_f32_dpp v39, v39, v39 row_mirror row_mask:0xf bank_mask:0xf
  s_nop 1
  v_permlane16_swap_b32 v39, v47
  v_add_f32 v39, v39, v47
  v_rcp_f32 v39, v39
  s_mov_b64 exec, s[28:29]
  v_mul_f32 v42, v42, v39
  v_mul_f32 v43, v43, v39
  v_cvt_pk_bf16_f32 v42, v42, v43
  v_min_u32 v42, -2, v42
  s_branch cA_sc3_pst
cA_sc3_retry:
  s_cmp_lg_u32 s62, 0
  s_cbranch_scc1 cA_sc3_cont
  s_waitcnt vmcnt(0) lgkmcnt(0)
cA_sc3_rv:
  buffer_load_dwordx4 v[8:11], v2, s[8:11], s20 offen offset:0 sc1
  buffer_load_dwordx4 v[12:15], v2, s[8:11], s20 offen offset:1024 sc1
  buffer_load_dwordx4 v[16:19], v2, s[8:11], s20 offen offset:2048 sc1
  buffer_load_dwordx4 v[20:23], v2, s[8:11], s20 offen offset:3072 sc1
  buffer_load_dwordx4 v[24:27], v2, s[8:11], s23 offen offset:0 sc1
  buffer_load_dwordx4 v[28:31], v2, s[8:11], s23 offen offset:1024 sc1
  buffer_load_dwordx4 v[32:35], v2, s[8:11], s23 offen offset:2048 sc1
  s_waitcnt vmcnt(0)
  v_max3_u32 v68, v8, v9, v10
  v_max3_u32 v68, v68, v11, v12
  v_max3_u32 v68, v68, v13, v14
  v_max3_u32 v68, v68, v15, v16
  v_max3_u32 v68, v68, v17, v18
  v_max3_u32 v68, v68, v19, v20
  v_max3_u32 v68, v68, v21, v22
  v_max3_u32 v68, v68, v23, v24
  v_max3_u32 v68, v68, v25, v26
  v_max3_u32 v68, v68, v27, v28
  v_max3_u32 v68, v68, v29, v30
  v_max3_u32 v68, v68, v31, v32
  v_max3_u32 v68, v68, v33, v34
  v_max_u32 v68, v68, v35
  v_cmp_eq_u32 vcc, -1, v68
  s_cbranch_vccz cA_sc3_rk
  s_add_u32 s30, s30, 1
  s_cmp_lt_u32 s30, 400000
  s_cbranch_scc1 cA_sc3_rv
  s_branch cA_abort
cA_sc3_rk:
  s_mov_b32 s62, 1
  v_mov_b32 v36, 0
  v_mov_b32 v37, 0
  v_mov_b32 v38, 0
  v_mov_b32 v39, 0
  v_mov_b32 v40, 0
  v_mov_b32 v41, 0
  v_mov_b32 v42, 0
  v_mov_b32 v43, 0
  v_mov_b32 v44, 0
  v_mov_b32 v45, 0
  v_mov_b32 v46, 0
  v_mov_b32 v47, 0
  v_mov_b32 v48, 0
  v_mov_b32 v49, 0
  v_mov_b32 v50, 0
  v_mov_b32 v51, 0
  v_mov_b32 v52, 0
  v_mov_b32 v53, 0
  v_mov_b32 v54, 0
  v_mov_b32 v55, 0
  v_mov_b32 v56, 0
  v_mov_b32 v57, 0
  v_mov_b32 v58, 0
  v_mov_b32 v59, 0
  v_mov_b32 v60, 0
  v_mov_b32 v61, 0
  v_mov_b32 v62, 0
  v_mov_b32 v63, 0
  v_mov_b32 v88, 0
  v_mov_b32 v89, 0
  v_mov_b32 v90, 0
  v_mov_b32 v91, 0
  v_mov_b32 v92, 0
  v_mov_b32 v93, 0
  v_mov_b32 v94, 0
  v_mov_b32 v95, 0
  v_mov_b32 v64, 0
  v_mov_b32 v65, 0
  s_add_u32 s31, s31, 1
  ds_read_b128 v[96:99], v117 offset:0
  ds_read_b128 v[100:103], v117 offset:1024
  ds_read_b128 v[104:107], v117 offset:14336
  ds_read_b128 v[108:111], v117 offset:15360
  v_smfmac_f32_16x16x64_bf16 v[36:39], v[8:11], a[0:7], v3
  v_smfmac_f32_16x16x64_bf16 v[40:43], v[8:11], a[56:63], v3
  v_smfmac_f32_16x16x64_bf16 v[44:47], v[8:11], a[112:119], v3
  v_smfmac_f32_16x16x64_bf16 v[48:51], v[8:11], a[168:175], v3
  v_smfmac_f32_16x16x64_bf16 v[52:55], v[8:11], a[224:231], v3
  v_smfmac_f32_16x16x64_bf16 v[56:59], v[8:11], v[144:151], v3
  v_smfmac_f32_16x16x64_bf16 v[60:63], v[8:11], v[200:207], v3
  v_smfmac_f32_16x16x64_bf16 v[36:39], v[12:15], a[8:15], v3
  v_smfmac_f32_16x16x64_bf16 v[40:43], v[12:15], a[64:71], v3
  v_smfmac_f32_16x16x64_bf16 v[44:47], v[12:15], a[120:127], v3
  v_smfmac_f32_16x16x64_bf16 v[48:51], v[12:15], a[176:183], v3
  v_smfmac_f32_16x16x64_bf16 v[52:55], v[12:15], a[232:239], v3
  v_smfmac_f32_16x16x64_bf16 v[56:59], v[12:15], v[152:159], v3
  v_smfmac_f32_16x16x64_bf16 v[60:63], v[12:15], v[208:215], v3
  v_smfmac_f32_16x16x64_bf16 v[36:39], v[16:19], a[16:23], v3
  v_smfmac_f32_16x16x64_bf16 v[40:43], v[16:19], a[72:79], v3
  v_smfmac_f32_16x16x64_bf16 v[44:47], v[16:19], a[128:135], v3
  v_smfmac_f32_16x16x64_bf16 v[48:51], v[16:19], a[184:191], v3
  v_smfmac_f32_16x16x64_bf16 v[52:55], v[16:19], a[240:247], v3
  v_smfmac_f32_16x16x64_bf16 v[56:59], v[16:19], v[160:167], v3
  v_smfmac_f32_16x16x64_bf16 v[60:63], v[16:19], v[216:223], v3
  v_smfmac_f32_16x16x64_bf16 v[36:39], v[20:23], a[24:31], v3
  v_smfmac_f32_16x16x64_bf16 v[40:43], v[20:23], a[80:87], v3
  v_smfmac_f32_16x16x64_bf16 v[44:47], v[20:23], a[136:143], v3
  v_smfmac_f32_16x16x64_bf16 v[48:51], v[20:23], a[192:199], v3
  v_smfmac_f32_16x16x64_bf16 v[52:55], v[20:23], a[248:255], v3
  v_smfmac_f32_16x16x64_bf16 v[56:59], v[20:23], v[168:175], v3
  v_smfmac_f32_16x16x64_bf16 v[60:63], v[20:23], v[224:231], v3
  s_xor_b32 s58, s25, 28672
  s_add_u32 s59, s24, 28672
  s_add_u32 m0, s58, 21504
  s_branch cA_sc3_ph2
.p2align 6

cA_va0_loop:
  s_add_u32 s23, s20, 4096
  s_add_u32 s21, s20, 20480
  s_mov_b32 s30, 0
  s_cmp_lg_u32 s19, s38
  s_cbranch_scc1 cA_va0_vok
  s_branch cA_va0_voc
cA_va0_vow:
  s_sub_u32 s22, s39, s35
  v_lshlrev_b32 v63, 7, v2
  v_min_u32 v63, s22, v63
  buffer_load_dword v63, v63, s[8:11], s35 offen sc1
  s_waitcnt vmcnt(0)
cA_va0_voc:
  v_readfirstlane_b32 s22, v63
  s_cmp_eq_u32 s22, 56
  s_cbranch_scc1 cA_va0_vod
  s_sleep 1
  s_add_u32 s30, s30, 1
  s_cmp_lt_u32 s30, 400000
  s_cbranch_scc1 cA_va0_vow
  s_branch cA_abort
cA_va0_vod:
  s_add_u32 s35, s35, 2048
  s_add_u32 s38, s19, 8
  s_and_b32 s38, s38, -8
  s_cmp_eq_u32 s19, 0
  s_cselect_b32 s38, 4, s38
  v_cmp_ne_u32 vcc, 56, v63
  s_nop 3
  s_cmp_eq_u64 vcc, 0
  s_cselect_b32 s38, 99, s38
cA_va0_vok:
  s_cmp_eq_u32 s19, 63
  s_cbranch_scc1 cA_done
  s_barrier
  s_add_u32 s22, s25, 0
  buffer_load_dwordx4 v[80:83], v6, s[8:11], s22 offen offset:0 sc1
  buffer_load_dwordx4 v[84:87], v6, s[8:11], s22 offen offset:1792 sc1
  s_add_u32 s22, s25, 3584
  buffer_load_dwordx4 v[88:91], v6, s[8:11], s22 offen offset:0 sc1
  buffer_load_dwordx4 v[92:95], v6, s[8:11], s22 offen offset:1792 sc1
  s_add_u32 s22, s25, 7168
  buffer_load_dwordx4 v[96:99], v6, s[8:11], s22 offen offset:0 sc1
  buffer_load_dwordx4 v[100:103], v6, s[8:11], s22 offen offset:1792 sc1
  s_add_u32 s22, s25, 10752
  buffer_load_dwordx4 v[104:107], v6, s[8:11], s22 offen offset:0 sc1
  buffer_load_dwordx4 v[108:111], v6, s[8:11], s22 offen offset:1792 sc1
  s_add_u32 s22, s25, 14336
  buffer_load_dwordx4 v[112:115], v6, s[8:11], s22 offen offset:0 sc1
  buffer_load_dwordx4 v[116:119], v6, s[8:11], s22 offen offset:1792 sc1
  s_add_u32 s22, s25, 17920
  buffer_load_dwordx4 v[120:123], v6, s[8:11], s22 offen offset:0 sc1
  buffer_load_dwordx4 v[124:127], v6, s[8:11], s22 offen offset:1792 sc1
  s_add_u32 s22, s19, 1
  s_cmp_lg_u32 s22, s38
  s_cbranch_scc1 cA_va0_nk
  s_sub_u32 s22, s39, s35
  v_lshlrev_b32 v63, 7, v2
  v_min_u32 v63, s22, v63
  buffer_load_dword v63, v63, s[8:11], s35 offen sc1
cA_va0_nk:
  s_barrier
  ds_read_b128 v[8:11], v0 offset:8192
  ds_read_b128 v[12:15], v0 offset:9216
  ds_read_b128 v[16:19], v0 offset:10240
  ds_read_b128 v[20:23], v0 offset:11264
  ds_read_b128 v[24:27], v0 offset:12288
  ds_read_b128 v[28:31], v0 offset:13312
  ds_read_b128 v[32:35], v0 offset:14336
  s_waitcnt lgkmcnt(0)
  v_smfmac_f32_16x16x64_bf16 v[36:39], v[8:11], a[0:7], v3
  s_add_u32 s22, s25, 21504
  buffer_load_dwordx4 v[128:131], v6, s[8:11], s22 offen offset:0 sc1
  v_smfmac_f32_16x16x64_bf16 v[36:39], v[12:15], a[8:15], v3
  v_smfmac_f32_16x16x64_bf16 v[36:39], v[16:19], a[16:23], v3
  s_add_u32 s22, s25, 21504
  buffer_load_dwordx4 v[132:135], v6, s[8:11], s22 offen offset:1792 sc1
  v_smfmac_f32_16x16x64_bf16 v[36:39], v[20:23], a[24:31], v3
  v_smfmac_f32_16x16x64_bf16 v[36:39], v[24:27], a[32:39], v3
  s_add_u32 s22, s25, 25088
  buffer_load_dwordx4 v[136:139], v6, s[8:11], s22 offen offset:0 sc1
  v_smfmac_f32_16x16x64_bf16 v[36:39], v[28:31], a[40:47], v3
  v_smfmac_f32_16x16x64_bf16 v[36:39], v[32:35], a[48:55], v3
  s_add_u32 s22, s25, 25088
  buffer_load_dwordx4 v[140:143], v6, s[8:11], s22 offen offset:1792 sc1
  v_smfmac_f32_16x16x64_bf16 v[40:43], v[8:11], a[56:63], v3
  v_smfmac_f32_16x16x64_bf16 v[40:43], v[12:15], a[64:71], v3
  v_smfmac_f32_16x16x64_bf16 v[40:43], v[16:19], a[72:79], v3
  v_add_f32 v36, v36, v37
  v_smfmac_f32_16x16x64_bf16 v[40:43], v[20:23], a[80:87], v3
  v_add_f32 v38, v38, v39
  v_smfmac_f32_16x16x64_bf16 v[40:43], v[24:27], a[88:95], v3
  v_cvt_pk_bf16_f32 v36, v36, v38
  v_smfmac_f32_16x16x64_bf16 v[40:43], v[28:31], a[96:103], v3
  ds_write_b32 v60, v36
  v_smfmac_f32_16x16x64_bf16 v[40:43], v[32:35], a[104:111], v3
  v_smfmac_f32_16x16x64_bf16 v[44:47], v[8:11], a[112:119], v3
  v_smfmac_f32_16x16x64_bf16 v[44:47], v[12:15], a[120:127], v3
  v_smfmac_f32_16x16x64_bf16 v[44:47], v[16:19], a[128:135], v3
  v_add_f32 v40, v40, v41
  v_smfmac_f32_16x16x64_bf16 v[44:47], v[20:23], a[136:143], v3
  v_add_f32 v42, v42, v43
  v_smfmac_f32_16x16x64_bf16 v[44:47], v[24:27], a[144:151], v3
  v_cvt_pk_bf16_f32 v40, v40, v42
  v_smfmac_f32_16x16x64_bf16 v[44:47], v[28:31], a[152:159], v3
  ds_write_b32 v61, v40
  v_smfmac_f32_16x16x64_bf16 v[44:47], v[32:35], a[160:167], v3
  v_smfmac_f32_16x16x64_bf16 v[48:51], v[8:11], a[168:175], v3
  v_smfmac_f32_16x16x64_bf16 v[48:51], v[12:15], a[176:183], v3
  v_smfmac_f32_16x16x64_bf16 v[48:51], v[16:19], a[184:191], v3
  v_add_f32 v44, v44, v45
  v_smfmac_f32_16x16x64_bf16 v[48:51], v[20:23], a[192:199], v3
  v_add_f32 v46, v46, v47
  v_smfmac_f32_16x16x64_bf16 v[48:51], v[24:27], a[200:207], v3
  v_cvt_pk_bf16_f32 v44, v44, v46
  v_smfmac_f32_16x16x64_bf16 v[48:51], v[28:31], a[208:215], v3
  ds_write_b32 v62, v44
  v_smfmac_f32_16x16x64_bf16 v[48:51], v[32:35], a[216:223], v3
  v_smfmac_f32_16x16x64_bf16 v[52:55], v[8:11], a[224:231], v3
  v_smfmac_f32_16x16x64_bf16 v[52:55], v[12:15], a[232:239], v3
  v_smfmac_f32_16x16x64_bf16 v[52:55], v[16:19], a[240:247], v3
  v_add_f32 v48, v48, v49
  v_smfmac_f32_16x16x64_bf16 v[52:55], v[20:23], a[248:255], v3
  v_add_f32 v50, v50, v51
  v_smfmac_f32_16x16x64_bf16 v[52:55], v[24:27], v[176:183], v3
  v_cvt_pk_bf16_f32 v48, v48, v50
  v_smfmac_f32_16x16x64_bf16 v[52:55], v[28:31], v[184:191], v3
  ds_write_b32 v170, v48
  v_smfmac_f32_16x16x64_bf16 v[52:55], v[32:35], v[192:199], v3
  v_smfmac_f32_16x16x64_bf16 v[56:59], v[8:11], v[200:207], v3
  v_smfmac_f32_16x16x64_bf16 v[56:59], v[12:15], v[208:215], v3
  v_smfmac_f32_16x16x64_bf16 v[56:59], v[16:19], v[216:223], v3
  v_add_f32 v52, v52, v53
  v_smfmac_f32_16x16x64_bf16 v[56:59], v[20:23], v[224:231], v3
  v_add_f32 v54, v54, v55
  v_smfmac_f32_16x16x64_bf16 v[56:59], v[24:27], v[232:239], v3
  v_cvt_pk_bf16_f32 v52, v52, v54
  v_smfmac_f32_16x16x64_bf16 v[56:59], v[28:31], v[240:247], v3
  ds_write_b32 v171, v52
  v_smfmac_f32_16x16x64_bf16 v[56:59], v[32:35], v[248:255], v3
  s_nop 7
  v_add_f32 v56, v56, v57
  v_add_f32 v58, v58, v59
  v_cvt_pk_bf16_f32 v56, v56, v58
  ds_write_b32 v172, v56
  buffer_load_dword v164, v4, s[8:11], s20 offen sc1
  s_waitcnt lgkmcnt(0)
  v_mov_b32 v36, 0
  v_mov_b32 v37, 0
  v_mov_b32 v38, 0
  v_mov_b32 v39, 0
  v_mov_b32 v40, 0
  v_mov_b32 v41, 0
  v_mov_b32 v42, 0
  v_mov_b32 v43, 0
  buffer_load_dword v165, v4, s[8:11], s20 offen sc1
  v_mov_b32 v44, 0
  v_mov_b32 v45, 0
  v_mov_b32 v46, 0
  v_mov_b32 v47, 0
  v_mov_b32 v48, 0
  v_mov_b32 v49, 0
  v_mov_b32 v50, 0
  v_mov_b32 v51, 0
  buffer_load_dword v166, v4, s[8:11], s20 offen sc1
  v_mov_b32 v52, 0
  v_mov_b32 v53, 0
  v_mov_b32 v54, 0
  v_mov_b32 v55, 0
  v_mov_b32 v56, 0
  v_mov_b32 v57, 0
  v_mov_b32 v58, 0
  v_mov_b32 v59, 0
  buffer_load_dword v167, v4, s[8:11], s20 offen sc1
  s_cmp_eq_u32 s19, 63
  s_cbranch_scc1 cA_va0_last
  s_add_u32 s22, s20, 9216
  s_add_u32 s34, s20, 13312
  s_add_u32 s36, s20, 7168
  s_mov_b32 s37, 0
  v_mov_b32 v156, 0
  v_mov_b32 v157, 0
  v_mov_b32 v158, 0
  v_mov_b32 v159, 0
  buffer_load_dword v168, v4, s[8:11], s20 offen sc1
cA_va0_fw_l:
  s_waitcnt vmcnt(4)
  v_cmp_eq_u32 vcc, -1, v164
  s_cbranch_vccz cA_va0_fw_d
  buffer_load_dword v164, v4, s[8:11], s20 offen sc1
  s_waitcnt vmcnt(4)
  v_cmp_eq_u32 vcc, -1, v165
  s_cbranch_vccz cA_va0_fw_d
  buffer_load_dword v165, v4, s[8:11], s20 offen sc1
  s_waitcnt vmcnt(4)
  v_cmp_eq_u32 vcc, -1, v166
  s_cbranch_vccz cA_va0_fw_d
  buffer_load_dword v166, v4, s[8:11], s20 offen sc1
  s_waitcnt vmcnt(4)
  v_cmp_eq_u32 vcc, -1, v167
  s_cbranch_vccz cA_va0_fw_d
  buffer_load_dword v167, v4, s[8:11], s20 offen sc1
  s_waitcnt vmcnt(4)
  v_cmp_eq_u32 vcc, -1, v168
  s_cbranch_vccz cA_va0_fw_d
  buffer_load_dword v168, v4, s[8:11], s20 offen sc1
  s_add_u32 s30, s30, 1
  s_cmp_lt_u32 s30, 400000
  s_cbranch_scc1 cA_va0_fw_l
  s_branch cA_abort
cA_va0_fw_d:
  s_waitcnt lgkmcnt(0)
  buffer_load_dwordx4 v[8:11], v5, s[8:11], s22 offen offset:0
  buffer_load_dwordx4 v[12:15], v5, s[8:11], s22 offen offset:1024
  buffer_load_dwordx4 v[16:19], v5, s[8:11], s22 offen offset:2048
  buffer_load_dwordx4 v[20:23], v5, s[8:11], s22 offen offset:3072
  buffer_load_dwordx4 v[24:27], v5, s[8:11], s34 offen offset:0
  buffer_load_dwordx4 v[28:31], v5, s[8:11], s34 offen offset:1024
  buffer_load_dwordx4 v[32:35], v5, s[8:11], s34 offen offset:2048
  buffer_load_dwordx4 v[144:147], v5, s[8:11], s34 offen offset:3072
  buffer_load_dwordx4 v[148:151], v2, s[8:11], s36 offen offset:0
  buffer_load_dwordx4 v[152:155], v2, s[8:11], s36 offen offset:1024
  s_barrier
  ds_read_b128 v[64:67], v2 offset:0
  ds_read_b128 v[68:71], v2 offset:1024
  ds_read_b128 v[72:75], v2 offset:2048
  ds_read_b128 v[76:79], v2 offset:3072
  s_waitcnt vmcnt(9)
  v_smfmac_f32_16x16x64_bf16 v[156:159], v[8:11], v[80:87], v3
  s_waitcnt vmcnt(8)
  v_smfmac_f32_16x16x64_bf16 v[156:159], v[12:15], v[88:95], v3
  s_waitcnt vmcnt(7)
  v_smfmac_f32_16x16x64_bf16 v[156:159], v[16:19], v[96:103], v3
  s_waitcnt vmcnt(6)
  v_smfmac_f32_16x16x64_bf16 v[156:159], v[20:23], v[104:111], v3
  s_waitcnt vmcnt(5)
  v_smfmac_f32_16x16x64_bf16 v[156:159], v[24:27], v[112:119], v3
  s_waitcnt vmcnt(4)
  v_smfmac_f32_16x16x64_bf16 v[156:159], v[28:31], v[120:127], v3
  s_waitcnt vmcnt(3)
  v_smfmac_f32_16x16x64_bf16 v[156:159], v[32:35], v[128:135], v3
  s_waitcnt vmcnt(2)
  v_smfmac_f32_16x16x64_bf16 v[156:159], v[144:147], v[136:143], v3
  s_waitcnt vmcnt(1) lgkmcnt(0)
  v_smfmac_f32_16x16x64_bf16 v[156:159], v[148:151], v[64:71], v3
  s_waitcnt vmcnt(0)
  v_smfmac_f32_16x16x64_bf16 v[156:159], v[152:155], v[72:79], v3
cA_va0_ep:
  s_nop 7
  v_add_f32 v160, v156, v157
  v_add_f32 v161, v158, v159
  v_cmp_u_f32 vcc, v160, v161
  v_mov_b32_dpp v162, v160 row_ror:8 row_mask:0xf bank_mask:0xf
  v_mov_b32_dpp v160, v161 row_ror:8 row_mask:0xf bank_mask:0xc
  s_cbranch_vccnz cA_va0_rp
  v_mov_b32_dpp v161, v162 quad_perm:[0,1,2,3] row_mask:0xf bank_mask:0x3
  v_cvt_pk_bf16_f32 v160, v160, v161
cA_va0_pc:
  buffer_store_dword v160, v1, s[8:11], s21 offen
  s_cmp_lg_u32 s19, 62
  s_cbranch_scc1 cA_va0_nl
  s_mov_b32 s22, 88531968
  buffer_store_dword v160, v1, s[8:11], s22 offen sc1
  s_mov_b64 exec, -1
  s_branch cA_done
cA_va0_nl:
  s_mov_b64 exec, -1
  s_add_u32 s25, s25, 28672
  s_add_u32 s19, s19, 1
  s_mov_b32 s20, s21
  s_branch cA_va0_loop
cA_va0_last:
  s_waitcnt lgkmcnt(0)
  s_barrier
  s_branch cA_done
cA_va0_rp:
  s_cmp_eq_u32 s37, 0
  s_cbranch_scc1 cA_va0_rv
  v_mov_b32_dpp v161, v162 quad_perm:[0,1,2,3] row_mask:0xf bank_mask:0x3
  v_cvt_pk_bf16_f32 v160, v160, v161
  v_min_u32 v160, -2, v160
  s_branch cA_va0_pc
cA_va0_rv:
  buffer_load_dwordx4 v[8:11], v5, s[8:11], s22 offen offset:0 sc1
  buffer_load_dwordx4 v[12:15], v5, s[8:11], s22 offen offset:1024 sc1
  buffer_load_dwordx4 v[16:19], v5, s[8:11], s22 offen offset:2048 sc1
  buffer_load_dwordx4 v[20:23], v5, s[8:11], s22 offen offset:3072 sc1
  buffer_load_dwordx4 v[24:27], v5, s[8:11], s34 offen offset:0 sc1
  buffer_load_dwordx4 v[28:31], v5, s[8:11], s34 offen offset:1024 sc1
  buffer_load_dwordx4 v[32:35], v5, s[8:11], s34 offen offset:2048 sc1
  buffer_load_dwordx4 v[144:147], v5, s[8:11], s34 offen offset:3072 sc1
  buffer_load_dwordx4 v[148:151], v2, s[8:11], s36 offen offset:0 sc1
  buffer_load_dwordx4 v[152:155], v2, s[8:11], s36 offen offset:1024 sc1
  s_waitcnt vmcnt(0)
  v_max3_u32 v175, v8, v9, v10
  v_max3_u32 v175, v175, v11, v12
  v_max3_u32 v175, v175, v13, v14
  v_max3_u32 v175, v175, v15, v16
  v_max3_u32 v175, v175, v17, v18
  v_max3_u32 v175, v175, v19, v20
  v_max3_u32 v175, v175, v21, v22
  v_max3_u32 v175, v175, v23, v24
  v_max3_u32 v175, v175, v25, v26
  v_max3_u32 v175, v175, v27, v28
  v_max3_u32 v175, v175, v29, v30
  v_max3_u32 v175, v175, v31, v32
  v_max3_u32 v175, v175, v33, v34
  v_max3_u32 v175, v175, v35, v144
  v_max3_u32 v175, v175, v145, v146
  v_max3_u32 v175, v175, v147, v148
  v_max3_u32 v175, v175, v149, v150
  v_max3_u32 v175, v175, v151, v152
  v_max3_u32 v175, v175, v153, v154
  v_max_u32 v175, v175, v155
  v_cmp_eq_u32 vcc, -1, v175
  s_cbranch_vccz cA_va0_rk
  s_add_u32 s30, s30, 1
  s_cmp_lt_u32 s30, 400000
  s_cbranch_scc1 cA_va0_rv
  s_branch cA_abort
cA_va0_rk:
  s_mov_b32 s37, 1
  s_add_u32 s31, s31, 0x10000
  v_mov_b32 v156, 0
  v_mov_b32 v157, 0
  v_mov_b32 v158, 0
  v_mov_b32 v159, 0
  s_nop 1
  v_smfmac_f32_16x16x64_bf16 v[156:159], v[8:11], v[80:87], v3
  v_smfmac_f32_16x16x64_bf16 v[156:159], v[12:15], v[88:95], v3
  v_smfmac_f32_16x16x64_bf16 v[156:159], v[16:19], v[96:103], v3
  v_smfmac_f32_16x16x64_bf16 v[156:159], v[20:23], v[104:111], v3
  v_smfmac_f32_16x16x64_bf16 v[156:159], v[24:27], v[112:119], v3
  v_smfmac_f32_16x16x64_bf16 v[156:159], v[28:31], v[120:127], v3
  v_smfmac_f32_16x16x64_bf16 v[156:159], v[32:35], v[128:135], v3
  v_smfmac_f32_16x16x64_bf16 v[156:159], v[144:147], v[136:143], v3
  v_smfmac_f32_16x16x64_bf16 v[156:159], v[148:151], v[64:71], v3
  v_smfmac_f32_16x16x64_bf16 v[156:159], v[152:155], v[72:79], v3
  s_nop 7
  s_branch cA_va0_ep
.p2align 6

cA_va1_loop:
  s_add_u32 s23, s20, 4096
  s_add_u32 s21, s20, 20480
  s_mov_b32 s30, 0
  s_cmp_lg_u32 s19, s38
  s_cbranch_scc1 cA_va1_vok
  s_branch cA_va1_voc
cA_va1_vow:
  s_sub_u32 s22, s39, s35
  v_lshlrev_b32 v63, 7, v2
  v_min_u32 v63, s22, v63
  buffer_load_dword v63, v63, s[8:11], s35 offen sc1
  s_waitcnt vmcnt(0)
cA_va1_voc:
  v_readfirstlane_b32 s22, v63
  s_cmp_eq_u32 s22, 56
  s_cbranch_scc1 cA_va1_vod
  s_sleep 1
  s_add_u32 s30, s30, 1
  s_cmp_lt_u32 s30, 400000
  s_cbranch_scc1 cA_va1_vow
  s_branch cA_abort
cA_va1_vod:
  s_add_u32 s35, s35, 2048
  s_add_u32 s38, s19, 8
  s_and_b32 s38, s38, -8
  s_cmp_eq_u32 s19, 0
  s_cselect_b32 s38, 4, s38
  v_cmp_ne_u32 vcc, 56, v63
  s_nop 3
  s_cmp_eq_u64 vcc, 0
  s_cselect_b32 s38, 99, s38
cA_va1_vok:
  s_cmp_eq_u32 s19, 63
  s_cbranch_scc1 cA_done
  s_barrier
  s_add_u32 s22, s25, 0
  buffer_load_dwordx4 v[80:83], v6, s[8:11], s22 offen offset:0 sc1
  buffer_load_dwordx4 v[84:87], v6, s[8:11], s22 offen offset:1792 sc1
  s_add_u32 s22, s25, 3584
  buffer_load_dwordx4 v[88:91], v6, s[8:11], s22 offen offset:0 sc1
  buffer_load_dwordx4 v[92:95], v6, s[8:11], s22 offen offset:1792 sc1
  s_add_u32 s22, s25, 7168
  buffer_load_dwordx4 v[96:99], v6, s[8:11], s22 offen offset:0 sc1
  buffer_load_dwordx4 v[100:103], v6, s[8:11], s22 offen offset:1792 sc1
  s_add_u32 s22, s25, 10752
  buffer_load_dwordx4 v[104:107], v6, s[8:11], s22 offen offset:0 sc1
  buffer_load_dwordx4 v[108:111], v6, s[8:11], s22 offen offset:1792 sc1
  s_add_u32 s22, s25, 14336
  buffer_load_dwordx4 v[112:115], v6, s[8:11], s22 offen offset:0 sc1
  buffer_load_dwordx4 v[116:119], v6, s[8:11], s22 offen offset:1792 sc1
  s_add_u32 s22, s25, 17920
  buffer_load_dwordx4 v[120:123], v6, s[8:11], s22 offen offset:0 sc1
  buffer_load_dwordx4 v[124:127], v6, s[8:11], s22 offen offset:1792 sc1
  s_add_u32 s22, s19, 1
  s_cmp_lg_u32 s22, s38
  s_cbranch_scc1 cA_va1_nk
  s_sub_u32 s22, s39, s35
  v_lshlrev_b32 v63, 7, v2
  v_min_u32 v63, s22, v63
  buffer_load_dword v63, v63, s[8:11], s35 offen sc1
cA_va1_nk:
  s_barrier
  ds_read_b128 v[8:11], v0 offset:8192
  ds_read_b128 v[12:15], v0 offset:9216
  ds_read_b128 v[16:19], v0 offset:10240
  ds_read_b128 v[20:23], v0 offset:11264
  ds_read_b128 v[24:27], v0 offset:12288
  ds_read_b128 v[28:31], v0 offset:13312
  ds_read_b128 v[32:35], v0 offset:14336
  s_waitcnt lgkmcnt(0)
  v_smfmac_f32_16x16x64_bf16 v[36:39], v[8:11], a[0:7], v3
  s_add_u32 s22, s25, 21504
  buffer_load_dwordx4 v[128:131], v6, s[8:11], s22 offen offset:0 sc1
  v_smfmac_f32_16x16x64_bf16 v[36:39], v[12:15], a[8:15], v3
  v_smfmac_f32_16x16x64_bf16 v[36:39], v[16:19], a[16:23], v3
  s_add_u32 s22, s25, 21504
  buffer_load_dwordx4 v[132:135], v6, s[8:11], s22 offen offset:1792 sc1
  v_smfmac_f32_16x16x64_bf16 v[36:39], v[20:23], a[24:31], v3
  v_smfmac_f32_16x16x64_bf16 v[36:39], v[24:27], a[32:39], v3
  s_add_u32 s22, s25, 25088
  buffer_load_dwordx4 v[136:139], v6, s[8:11], s22 offen offset:0 sc1
  v_smfmac_f32_16x16x64_bf16 v[36:39], v[28:31], a[40:47], v3
  v_smfmac_f32_16x16x64_bf16 v[36:39], v[32:35], a[48:55], v3
  s_add_u32 s22, s25, 25088
  buffer_load_dwordx4 v[140:143], v6, s[8:11], s22 offen offset:1792 sc1
  v_smfmac_f32_16x16x64_bf16 v[40:43], v[8:11], a[56:63], v3
  v_smfmac_f32_16x16x64_bf16 v[40:43], v[12:15], a[64:71], v3
  v_smfmac_f32_16x16x64_bf16 v[40:43], v[16:19], a[72:79], v3
  v_add_f32 v36, v36, v37
  v_smfmac_f32_16x16x64_bf16 v[40:43], v[20:23], a[80:87], v3
  v_add_f32 v38, v38, v39
  v_smfmac_f32_16x16x64_bf16 v[40:43], v[24:27], a[88:95], v3
  v_cvt_pk_bf16_f32 v36, v36, v38
  v_smfmac_f32_16x16x64_bf16 v[40:43], v[28:31], a[96:103], v3
  ds_write_b32 v60, v36
  v_smfmac_f32_16x16x64_bf16 v[40:43], v[32:35], a[104:111], v3
  v_smfmac_f32_16x16x64_bf16 v[44:47], v[8:11], a[112:119], v3
  v_smfmac_f32_16x16x64_bf16 v[44:47], v[12:15], a[120:127], v3
  v_smfmac_f32_16x16x64_bf16 v[44:47], v[16:19], a[128:135], v3
  v_add_f32 v40, v40, v41
  v_smfmac_f32_16x16x64_bf16 v[44:47], v[20:23], a[136:143], v3
  v_add_f32 v42, v42, v43
  v_smfmac_f32_16x16x64_bf16 v[44:47], v[24:27], a[144:151], v3
  v_cvt_pk_bf16_f32 v40, v40, v42
  v_smfmac_f32_16x16x64_bf16 v[44:47], v[28:31], a[152:159], v3
  ds_write_b32 v61, v40
  v_smfmac_f32_16x16x64_bf16 v[44:47], v[32:35], a[160:167], v3
  v_smfmac_f32_16x16x64_bf16 v[48:51], v[8:11], a[168:175], v3
  v_smfmac_f32_16x16x64_bf16 v[48:51], v[12:15], a[176:183], v3
  v_smfmac_f32_16x16x64_bf16 v[48:51], v[16:19], a[184:191], v3
  v_add_f32 v44, v44, v45
  v_smfmac_f32_16x16x64_bf16 v[48:51], v[20:23], a[192:199], v3
  v_add_f32 v46, v46, v47
  v_smfmac_f32_16x16x64_bf16 v[48:51], v[24:27], a[200:207], v3
  v_cvt_pk_bf16_f32 v44, v44, v46
  v_smfmac_f32_16x16x64_bf16 v[48:51], v[28:31], a[208:215], v3
  ds_write_b32 v62, v44
  v_smfmac_f32_16x16x64_bf16 v[48:51], v[32:35], a[216:223], v3
  v_smfmac_f32_16x16x64_bf16 v[52:55], v[8:11], a[224:231], v3
  v_smfmac_f32_16x16x64_bf16 v[52:55], v[12:15], a[232:239], v3
  v_smfmac_f32_16x16x64_bf16 v[52:55], v[16:19], a[240:247], v3
  v_add_f32 v48, v48, v49
  v_smfmac_f32_16x16x64_bf16 v[52:55], v[20:23], a[248:255], v3
  v_add_f32 v50, v50, v51
  v_smfmac_f32_16x16x64_bf16 v[52:55], v[24:27], v[176:183], v3
  v_cvt_pk_bf16_f32 v48, v48, v50
  v_smfmac_f32_16x16x64_bf16 v[52:55], v[28:31], v[184:191], v3
  ds_write_b32 v170, v48
  v_smfmac_f32_16x16x64_bf16 v[52:55], v[32:35], v[192:199], v3
  v_smfmac_f32_16x16x64_bf16 v[56:59], v[8:11], v[200:207], v3
  v_smfmac_f32_16x16x64_bf16 v[56:59], v[12:15], v[208:215], v3
  v_smfmac_f32_16x16x64_bf16 v[56:59], v[16:19], v[216:223], v3
  v_add_f32 v52, v52, v53
  v_smfmac_f32_16x16x64_bf16 v[56:59], v[20:23], v[224:231], v3
  v_add_f32 v54, v54, v55
  v_smfmac_f32_16x16x64_bf16 v[56:59], v[24:27], v[232:239], v3
  v_cvt_pk_bf16_f32 v52, v52, v54
  v_smfmac_f32_16x16x64_bf16 v[56:59], v[28:31], v[240:247], v3
  ds_write_b32 v171, v52
  v_smfmac_f32_16x16x64_bf16 v[56:59], v[32:35], v[248:255], v3
  s_nop 7
  v_add_f32 v56, v56, v57
  v_add_f32 v58, v58, v59
  v_cvt_pk_bf16_f32 v56, v56, v58
  ds_write_b32 v172, v56
  s_waitcnt lgkmcnt(0)
  v_mov_b32 v36, 0
  v_mov_b32 v37, 0
  v_mov_b32 v38, 0
  v_mov_b32 v39, 0
  v_mov_b32 v40, 0
  v_mov_b32 v41, 0
  v_mov_b32 v42, 0
  v_mov_b32 v43, 0
  v_mov_b32 v44, 0
  v_mov_b32 v45, 0
  v_mov_b32 v46, 0
  v_mov_b32 v47, 0
  v_mov_b32 v48, 0
  v_mov_b32 v49, 0
  v_mov_b32 v50, 0
  v_mov_b32 v51, 0
  v_mov_b32 v52, 0
  v_mov_b32 v53, 0
  v_mov_b32 v54, 0
  v_mov_b32 v55, 0
  v_mov_b32 v56, 0
  v_mov_b32 v57, 0
  v_mov_b32 v58, 0
  v_mov_b32 v59, 0
  s_cmp_eq_u32 s19, 63
  s_cbranch_scc1 cA_va1_last
  s_add_u32 s22, s20, 9216
  s_add_u32 s34, s20, 13312
  s_add_u32 s36, s20, 7168
  s_mov_b32 s37, 0
  v_mov_b32 v156, 0
  v_mov_b32 v157, 0
  v_mov_b32 v158, 0
  v_mov_b32 v159, 0
  s_barrier
  s_waitcnt lgkmcnt(0)
  buffer_load_dwordx4 v[8:11], v5, s[8:11], s22 offen offset:0
  buffer_load_dwordx4 v[12:15], v5, s[8:11], s22 offen offset:1024
  buffer_load_dwordx4 v[16:19], v5, s[8:11], s22 offen offset:2048
  buffer_load_dwordx4 v[20:23], v5, s[8:11], s22 offen offset:3072
  buffer_load_dwordx4 v[24:27], v5, s[8:11], s34 offen offset:0
  buffer_load_dwordx4 v[28:31], v5, s[8:11], s34 offen offset:1024
  buffer_load_dwordx4 v[32:35], v5, s[8:11], s34 offen offset:2048
  buffer_load_dwordx4 v[144:147], v5, s[8:11], s34 offen offset:3072
  s_sub_u32 s23, s21, 4
  s_mov_b64 exec, 65535
  buffer_store_dword v2, v7, s[8:11], s23 offen
  s_mov_b64 exec, -1
  buffer_load_dwordx4 v[148:151], v2, s[8:11], s36 offen offset:0
  buffer_load_dwordx4 v[152:155], v2, s[8:11], s36 offen offset:1024
  ds_read_b128 v[64:67], v2 offset:4096
  ds_read_b128 v[68:71], v2 offset:5120
  ds_read_b128 v[72:75], v2 offset:6144
  ds_read_b128 v[76:79], v2 offset:7168
  s_waitcnt vmcnt(10)
  v_smfmac_f32_16x16x64_bf16 v[156:159], v[8:11], v[80:87], v3
  s_waitcnt vmcnt(9)
  v_smfmac_f32_16x16x64_bf16 v[156:159], v[12:15], v[88:95], v3
  s_waitcnt vmcnt(8)
  v_smfmac_f32_16x16x64_bf16 v[156:159], v[16:19], v[96:103], v3
  s_waitcnt vmcnt(7)
  v_smfmac_f32_16x16x64_bf16 v[156:159], v[20:23], v[104:111], v3
  s_waitcnt vmcnt(6)
  v_smfmac_f32_16x16x64_bf16 v[156:159], v[24:27], v[112:119], v3
  s_mov_b64 exec, 65535
  buffer_store_dword v2, v7, s[8:11], s21 offen
  s_mov_b64 exec, -1
  s_waitcnt vmcnt(6)
  v_smfmac_f32_16x16x64_bf16 v[156:159], v[28:31], v[120:127], v3
  s_waitcnt vmcnt(5)
  v_smfmac_f32_16x16x64_bf16 v[156:159], v[32:35], v[128:135], v3
  s_waitcnt vmcnt(4)
  v_smfmac_f32_16x16x64_bf16 v[156:159], v[144:147], v[136:143], v3
  s_waitcnt vmcnt(2) lgkmcnt(0)
  v_smfmac_f32_16x16x64_bf16 v[156:159], v[148:151], v[64:71], v3
  s_waitcnt vmcnt(1)
  v_smfmac_f32_16x16x64_bf16 v[156:159], v[152:155], v[72:79], v3
cA_va1_ep:
  s_nop 7
  v_add_f32 v160, v156, v157
  v_add_f32 v161, v158, v159
  v_cmp_u_f32 vcc, v160, v161
  v_mov_b32_dpp v162, v160 row_ror:8 row_mask:0xf bank_mask:0xf
  v_mov_b32_dpp v160, v161 row_ror:8 row_mask:0xf bank_mask:0xc
  s_cbranch_vccnz cA_va1_rp
  v_mov_b32_dpp v161, v162 quad_perm:[0,1,2,3] row_mask:0xf bank_mask:0x3
  v_cvt_pk_bf16_f32 v160, v160, v161
cA_va1_pc:
  s_mov_b64 exec, s[26:27]
  buffer_store_dword v160, v1, s[8:11], s21 offen
  s_cmp_lg_u32 s19, 62
  s_cbranch_scc1 cA_va1_nl
  s_mov_b32 s22, 88531968
  buffer_store_dword v160, v1, s[8:11], s22 offen sc1
  s_mov_b64 exec, -1
  s_branch cA_done
cA_va1_nl:
  s_mov_b64 exec, -1
  s_cmp_lg_u32 s19, 0
  s_cbranch_scc1 cA_va1_s0
  v_add_u32 v7, 512, v7
  v_lshl_add_u32 v7, v2, 3, v7
  s_mov_b64 exec, 65535
  buffer_store_dword v2, v7, s[8:11], s21 offen
  buffer_store_dword v2, v7, s[8:11], s23 offen
  s_mov_b64 exec, -1
cA_va1_s0:
  s_add_u32 s25, s25, 28672
  s_add_u32 s19, s19, 1
  s_mov_b32 s20, s21
  s_branch cA_va1_loop
cA_va1_last:
  s_waitcnt lgkmcnt(0)
  s_barrier
  s_branch cA_done
cA_va1_rp:
  s_cmp_eq_u32 s37, 0
  s_cbranch_scc1 cA_va1_rv
  v_mov_b32_dpp v161, v162 quad_perm:[0,1,2,3] row_mask:0xf bank_mask:0x3
  v_cvt_pk_bf16_f32 v160, v160, v161
  v_min_u32 v160, -2, v160
  s_branch cA_va1_pc
cA_va1_rv:
  buffer_load_dwordx4 v[8:11], v5, s[8:11], s22 offen offset:0 sc1
  buffer_load_dwordx4 v[12:15], v5, s[8:11], s22 offen offset:1024 sc1
  buffer_load_dwordx4 v[16:19], v5, s[8:11], s22 offen offset:2048 sc1
  buffer_load_dwordx4 v[20:23], v5, s[8:11], s22 offen offset:3072 sc1
  buffer_load_dwordx4 v[24:27], v5, s[8:11], s34 offen offset:0 sc1
  buffer_load_dwordx4 v[28:31], v5, s[8:11], s34 offen offset:1024 sc1
  buffer_load_dwordx4 v[32:35], v5, s[8:11], s34 offen offset:2048 sc1
  buffer_load_dwordx4 v[144:147], v5, s[8:11], s34 offen offset:3072 sc1
  buffer_load_dwordx4 v[148:151], v2, s[8:11], s36 offen offset:0 sc1
  buffer_load_dwordx4 v[152:155], v2, s[8:11], s36 offen offset:1024 sc1
  s_waitcnt vmcnt(0)
  v_max3_u32 v175, v8, v9, v10
  v_max3_u32 v175, v175, v11, v12
  v_max3_u32 v175, v175, v13, v14
  v_max3_u32 v175, v175, v15, v16
  v_max3_u32 v175, v175, v17, v18
  v_max3_u32 v175, v175, v19, v20
  v_max3_u32 v175, v175, v21, v22
  v_max3_u32 v175, v175, v23, v24
  v_max3_u32 v175, v175, v25, v26
  v_max3_u32 v175, v175, v27, v28
  v_max3_u32 v175, v175, v29, v30
  v_max3_u32 v175, v175, v31, v32
  v_max3_u32 v175, v175, v33, v34
  v_max3_u32 v175, v175, v35, v144
  v_max3_u32 v175, v175, v145, v146
  v_max3_u32 v175, v175, v147, v148
  v_max3_u32 v175, v175, v149, v150
  v_max3_u32 v175, v175, v151, v152
  v_max3_u32 v175, v175, v153, v154
  v_max_u32 v175, v175, v155
  v_cmp_eq_u32 vcc, -1, v175
  s_cbranch_vccz cA_va1_rk
  s_add_u32 s30, s30, 1
  s_cmp_lt_u32 s30, 400000
  s_cbranch_scc1 cA_va1_rv
  s_branch cA_abort
cA_va1_rk:
  s_mov_b32 s37, 1
  s_add_u32 s31, s31, 0x10000
  v_mov_b32 v156, 0
  v_mov_b32 v157, 0
  v_mov_b32 v158, 0
  v_mov_b32 v159, 0
  s_nop 1
  v_smfmac_f32_16x16x64_bf16 v[156:159], v[8:11], v[80:87], v3
  v_smfmac_f32_16x16x64_bf16 v[156:159], v[12:15], v[88:95], v3
  v_smfmac_f32_16x16x64_bf16 v[156:159], v[16:19], v[96:103], v3
  v_smfmac_f32_16x16x64_bf16 v[156:159], v[20:23], v[104:111], v3
  v_smfmac_f32_16x16x64_bf16 v[156:159], v[24:27], v[112:119], v3
  v_smfmac_f32_16x16x64_bf16 v[156:159], v[28:31], v[120:127], v3
  v_smfmac_f32_16x16x64_bf16 v[156:159], v[32:35], v[128:135], v3
  v_smfmac_f32_16x16x64_bf16 v[156:159], v[144:147], v[136:143], v3
  v_smfmac_f32_16x16x64_bf16 v[156:159], v[148:151], v[64:71], v3
  v_smfmac_f32_16x16x64_bf16 v[156:159], v[152:155], v[72:79], v3
  s_nop 7
  s_branch cA_va1_ep
.p2align 6

cA_va2_loop:
  s_add_u32 s23, s20, 4096
  s_add_u32 s21, s20, 20480
  v_mov_b32 v36, 0
  v_mov_b32 v37, 0
  v_mov_b32 v38, 0
  v_mov_b32 v39, 0
  v_mov_b32 v40, 0
  v_mov_b32 v41, 0
  v_mov_b32 v42, 0
  v_mov_b32 v43, 0
  v_mov_b32 v44, 0
  v_mov_b32 v45, 0
  v_mov_b32 v46, 0
  v_mov_b32 v47, 0
  v_mov_b32 v48, 0
  v_mov_b32 v49, 0
  v_mov_b32 v50, 0
  v_mov_b32 v51, 0
  v_mov_b32 v52, 0
  v_mov_b32 v53, 0
  v_mov_b32 v54, 0
  v_mov_b32 v55, 0
  v_mov_b32 v56, 0
  v_mov_b32 v57, 0
  v_mov_b32 v58, 0
  v_mov_b32 v59, 0
  v_mov_b32 v60, 0
  v_mov_b32 v61, 0
  v_mov_b32 v62, 0
  v_mov_b32 v63, 0
  v_mov_b32 v64, 0
  v_mov_b32 v65, 0
  v_mov_b32 v66, 0
  v_mov_b32 v67, 0
  s_mov_b32 s30, 0
  buffer_load_dword v76, v119, s[8:11], s20 offen sc1
  buffer_load_dword v77, v119, s[8:11], s20 offen sc1
  buffer_load_dword v78, v119, s[8:11], s20 offen sc1
cA_va2_fp_l:
  s_waitcnt vmcnt(2)
  v_cmp_eq_u32 vcc, -1, v76
  s_cbranch_vccz cA_va2_fp_d
  buffer_load_dword v76, v119, s[8:11], s20 offen sc1
  s_waitcnt vmcnt(2)
  v_cmp_eq_u32 vcc, -1, v77
  s_cbranch_vccz cA_va2_fp_d
  buffer_load_dword v77, v119, s[8:11], s20 offen sc1
  s_waitcnt vmcnt(2)
  v_cmp_eq_u32 vcc, -1, v78
  s_cbranch_vccz cA_va2_fp_d
  buffer_load_dword v78, v119, s[8:11], s20 offen sc1
  s_add_u32 s30, s30, 1
  s_cmp_lt_u32 s30, 400000
  s_cbranch_scc1 cA_va2_fp_l
  s_branch cA_abort
cA_va2_fp_d:
  s_nop 15
  s_nop 3
  buffer_load_dwordx4 v[8:11], v2, s[8:11], s20 offen offset:0 sc1
  buffer_load_dwordx4 v[12:15], v2, s[8:11], s20 offen offset:1024 sc1
  buffer_load_dwordx4 v[16:19], v2, s[8:11], s20 offen offset:2048 sc1
  buffer_load_dwordx4 v[20:23], v2, s[8:11], s20 offen offset:3072 sc1
  s_barrier
cA_va2_ld:
  s_waitcnt vmcnt(0)
  v_max3_u32 v84, v8, v9, v10
  v_max3_u32 v84, v84, v11, v12
  v_max3_u32 v84, v84, v13, v14
  v_max3_u32 v84, v84, v15, v16
  v_max3_u32 v84, v84, v17, v18
  v_max3_u32 v84, v84, v19, v20
  v_max3_u32 v84, v84, v21, v22
  v_max_u32 v84, v84, v23
  v_cmp_eq_u32 vcc, -1, v84
  ds_write_b128 v2, v[8:11] offset:8192
  ds_write_b128 v2, v[12:15] offset:9216
  ds_write_b128 v2, v[16:19] offset:10240
  ds_write_b128 v2, v[20:23] offset:11264
  s_cbranch_vccnz cA_va2_retry
  s_waitcnt lgkmcnt(0)
  s_barrier
  ds_read_b128 v[8:11], v5 offset:8192
  ds_read_b128 v[12:15], v5 offset:9216
  ds_read_b128 v[16:19], v5 offset:10240
  ds_read_b128 v[20:23], v5 offset:11264
  ds_read_b128 v[24:27], v5 offset:12288
  ds_read_b128 v[28:31], v5 offset:13312
  ds_read_b128 v[32:35], v5 offset:14336
  ds_read_b128 v[92:95], v0
  s_waitcnt lgkmcnt(0)
  s_mov_b64 exec, s[26:27]
  buffer_store_dwordx4 v[92:95], v2, s[8:11], s36 offen sc1
  s_mov_b64 exec, -1
  s_add_u32 s36, s36, 7168
  s_cmp_eq_u32 s19, 63
  s_cbranch_scc1 cA_done
  ds_read_b128 v[76:79], v1 offset:0
  ds_read_b128 v[80:83], v1 offset:1024
  ds_read_b128 v[84:87], v1 offset:2048
  ds_read_b128 v[88:91], v1 offset:3072
  ds_read_b128 v[92:95], v1 offset:4096
  ds_read_b128 v[96:99], v1 offset:5120
  v_smfmac_f32_16x16x64_bf16 v[60:63], v[8:11], v[200:207], v3
  v_smfmac_f32_16x16x64_bf16 v[60:63], v[12:15], v[208:215], v3
  s_waitcnt lgkmcnt(4)
  v_smfmac_f32_16x16x64_bf16 v[64:67], v[8:11], v[76:83], v3
  ds_read_b128 v[76:79], v1 offset:6144
  ds_read_b128 v[80:83], v1 offset:7168
  v_smfmac_f32_16x16x64_bf16 v[60:63], v[16:19], v[216:223], v3
  v_smfmac_f32_16x16x64_bf16 v[60:63], v[20:23], v[224:231], v3
  s_waitcnt lgkmcnt(4)
  v_smfmac_f32_16x16x64_bf16 v[64:67], v[12:15], v[84:91], v3
  ds_read_b128 v[84:87], v1 offset:8192
  ds_read_b128 v[88:91], v1 offset:9216
  v_smfmac_f32_16x16x64_bf16 v[60:63], v[24:27], v[232:239], v3
  v_smfmac_f32_16x16x64_bf16 v[60:63], v[28:31], v[240:247], v3
  s_waitcnt lgkmcnt(4)
  v_smfmac_f32_16x16x64_bf16 v[64:67], v[16:19], v[92:99], v3
  ds_read_b128 v[92:95], v1 offset:10240
  ds_read_b128 v[96:99], v1 offset:11264
  v_smfmac_f32_16x16x64_bf16 v[60:63], v[32:35], v[248:255], v3
  v_smfmac_f32_16x16x64_bf16 v[36:39], v[8:11], a[0:7], v3
  s_waitcnt lgkmcnt(4)
  v_smfmac_f32_16x16x64_bf16 v[64:67], v[20:23], v[76:83], v3
  ds_read_b128 v[76:79], v1 offset:12288
  ds_read_b128 v[80:83], v1 offset:13312
  v_smfmac_f32_16x16x64_bf16 v[36:39], v[12:15], a[8:15], v3
  v_add_f32 v60, v60, v61
  v_smfmac_f32_16x16x64_bf16 v[36:39], v[16:19], a[16:23], v3
  v_add_f32 v62, v62, v63
  s_waitcnt lgkmcnt(4)
  v_smfmac_f32_16x16x64_bf16 v[64:67], v[24:27], v[84:91], v3
  v_cvt_pk_bf16_f32 v60, v60, v62
  v_smfmac_f32_16x16x64_bf16 v[36:39], v[20:23], a[24:31], v3
  ds_write_b32 v106, v60
  v_smfmac_f32_16x16x64_bf16 v[36:39], v[24:27], a[32:39], v3
  s_waitcnt lgkmcnt(2)
  v_smfmac_f32_16x16x64_bf16 v[64:67], v[28:31], v[92:99], v3
  v_smfmac_f32_16x16x64_bf16 v[36:39], v[28:31], a[40:47], v3
  v_smfmac_f32_16x16x64_bf16 v[36:39], v[32:35], a[48:55], v3
  s_waitcnt lgkmcnt(0)
  v_smfmac_f32_16x16x64_bf16 v[64:67], v[32:35], v[76:83], v3
  v_smfmac_f32_16x16x64_bf16 v[40:43], v[8:11], a[56:63], v3
  v_smfmac_f32_16x16x64_bf16 v[40:43], v[12:15], a[64:71], v3
  v_add_f32 v36, v36, v37
  v_smfmac_f32_16x16x64_bf16 v[40:43], v[16:19], a[72:79], v3
  v_add_f32 v38, v38, v39
  v_smfmac_f32_16x16x64_bf16 v[40:43], v[20:23], a[80:87], v3
  v_cvt_pk_bf16_f32 v36, v36, v38
  v_smfmac_f32_16x16x64_bf16 v[40:43], v[24:27], a[88:95], v3
  ds_write_b32 v100, v36
  v_smfmac_f32_16x16x64_bf16 v[40:43], v[28:31], a[96:103], v3
  v_add_f32 v64, v64, v65
  v_smfmac_f32_16x16x64_bf16 v[40:43], v[32:35], a[104:111], v3
  v_add_f32 v66, v66, v67
  v_smfmac_f32_16x16x64_bf16 v[44:47], v[8:11], a[112:119], v3
  v_cvt_pk_bf16_f32 v64, v64, v66
  v_smfmac_f32_16x16x64_bf16 v[44:47], v[12:15], a[120:127], v3
  ds_write_b32 v107, v64
  v_smfmac_f32_16x16x64_bf16 v[44:47], v[16:19], a[128:135], v3
  v_add_f32 v40, v40, v41
  v_smfmac_f32_16x16x64_bf16 v[44:47], v[20:23], a[136:143], v3
  v_add_f32 v42, v42, v43
  v_smfmac_f32_16x16x64_bf16 v[44:47], v[24:27], a[144:151], v3
  v_cvt_pk_bf16_f32 v40, v40, v42
  v_smfmac_f32_16x16x64_bf16 v[44:47], v[28:31], a[152:159], v3
  ds_write_b32 v101, v40
  v_smfmac_f32_16x16x64_bf16 v[44:47], v[32:35], a[160:167], v3
  v_smfmac_f32_16x16x64_bf16 v[48:51], v[8:11], a[168:175], v3
  v_smfmac_f32_16x16x64_bf16 v[48:51], v[12:15], a[176:183], v3
  v_smfmac_f32_16x16x64_bf16 v[48:51], v[16:19], a[184:191], v3
  v_add_f32 v44, v44, v45
  v_smfmac_f32_16x16x64_bf16 v[48:51], v[20:23], a[192:199], v3
  v_add_f32 v46, v46, v47
  v_smfmac_f32_16x16x64_bf16 v[48:51], v[24:27], a[200:207], v3
  v_cvt_pk_bf16_f32 v44, v44, v46
  v_smfmac_f32_16x16x64_bf16 v[48:51], v[28:31], a[208:215], v3
  ds_write_b32 v102, v44
  v_smfmac_f32_16x16x64_bf16 v[48:51], v[32:35], a[216:223], v3
  v_smfmac_f32_16x16x64_bf16 v[52:55], v[8:11], a[224:231], v3
  v_smfmac_f32_16x16x64_bf16 v[52:55], v[12:15], a[232:239], v3
  v_smfmac_f32_16x16x64_bf16 v[52:55], v[16:19], a[240:247], v3
  v_add_f32 v48, v48, v49
  v_smfmac_f32_16x16x64_bf16 v[52:55], v[20:23], a[248:255], v3
  v_add_f32 v50, v50, v51
  v_smfmac_f32_16x16x64_bf16 v[52:55], v[24:27], v[120:127], v3
  v_cvt_pk_bf16_f32 v48, v48, v50
  v_smfmac_f32_16x16x64_bf16 v[52:55], v[28:31], v[128:135], v3
  ds_write_b32 v103, v48
  v_smfmac_f32_16x16x64_bf16 v[52:55], v[32:35], v[136:143], v3
  v_smfmac_f32_16x16x64_bf16 v[56:59], v[8:11], v[144:151], v3
  v_smfmac_f32_16x16x64_bf16 v[56:59], v[12:15], v[152:159], v3
  v_smfmac_f32_16x16x64_bf16 v[56:59], v[16:19], v[160:167], v3
  v_add_f32 v52, v52, v53
  v_smfmac_f32_16x16x64_bf16 v[56:59], v[20:23], v[168:175], v3
  v_add_f32 v54, v54, v55
  v_smfmac_f32_16x16x64_bf16 v[56:59], v[24:27], v[176:183], v3
  v_cvt_pk_bf16_f32 v52, v52, v54
  v_smfmac_f32_16x16x64_bf16 v[56:59], v[28:31], v[184:191], v3
  ds_write_b32 v104, v52
  v_smfmac_f32_16x16x64_bf16 v[56:59], v[32:35], v[192:199], v3
  s_nop 7
  v_add_f32 v56, v56, v57
  v_add_f32 v58, v58, v59
  v_cvt_pk_bf16_f32 v56, v56, v58
  ds_write_b32 v105, v56
  s_waitcnt lgkmcnt(0)
  s_barrier
  s_cmp_eq_u32 s19, 62
  s_cbranch_scc1 cA_done
  s_waitcnt vmcnt(0) lgkmcnt(0)
  s_add_u32 s19, s19, 1
  s_mov_b32 s20, s21
  s_branch cA_va2_loop
cA_va2_retry:
  s_waitcnt lgkmcnt(0)
  buffer_load_dwordx4 v[8:11], v2, s[8:11], s20 offen offset:0 sc1
  buffer_load_dwordx4 v[12:15], v2, s[8:11], s20 offen offset:1024 sc1
  buffer_load_dwordx4 v[16:19], v2, s[8:11], s20 offen offset:2048 sc1
  buffer_load_dwordx4 v[20:23], v2, s[8:11], s20 offen offset:3072 sc1
  s_add_u32 s31, s31, 1
  s_add_u32 s30, s30, 1
  s_cmp_lt_u32 s30, 400000
  s_cbranch_scc1 cA_va2_ld
  s_branch cA_abort
cA_va2_last:
  s_waitcnt lgkmcnt(0)
  buffer_store_dwordx4 v[100:103], v2, s[8:11], s24 offen offset:0 sc1
  buffer_store_dwordx4 v[104:107], v2, s[8:11], s24 offen offset:1024 sc1
  buffer_store_dwordx4 v[108:111], v2, s[8:11], s24 offen offset:2048 sc1
  buffer_store_dwordx4 v[4:7], v2, s[8:11], s24 offen offset:3072 sc1
  s_add_u32 s24, s24, 8192
  s_waitcnt vmcnt(0)
  s_mov_b64 exec, 1
  buffer_store_dword v117, v2, s[8:11], s34 offen sc1
  s_mov_b64 exec, -1
  s_add_u32 s34, s34, 8
  s_mov_b64 exec, 1
  buffer_store_dword v117, v2, s[8:11], s34 offen sc1
  s_mov_b64 exec, -1
  s_add_u32 s34, s34, 8
  s_branch cA_done
.p2align 6

cA_va3_loop:
  s_add_u32 s23, s20, 4096
  s_add_u32 s21, s20, 20480
  v_mov_b32 v36, 0
  v_mov_b32 v37, 0
  v_mov_b32 v38, 0
  v_mov_b32 v39, 0
  v_mov_b32 v40, 0
  v_mov_b32 v41, 0
  v_mov_b32 v42, 0
  v_mov_b32 v43, 0
  v_mov_b32 v44, 0
  v_mov_b32 v45, 0
  v_mov_b32 v46, 0
  v_mov_b32 v47, 0
  v_mov_b32 v48, 0
  v_mov_b32 v49, 0
  v_mov_b32 v50, 0
  v_mov_b32 v51, 0
  v_mov_b32 v52, 0
  v_mov_b32 v53, 0
  v_mov_b32 v54, 0
  v_mov_b32 v55, 0
  v_mov_b32 v56, 0
  v_mov_b32 v57, 0
  v_mov_b32 v58, 0
  v_mov_b32 v59, 0
  v_mov_b32 v60, 0
  v_mov_b32 v61, 0
  v_mov_b32 v62, 0
  v_mov_b32 v63, 0
  v_mov_b32 v64, 0
  v_mov_b32 v65, 0
  v_mov_b32 v66, 0
  v_mov_b32 v67, 0
  s_mov_b32 s30, 0
  buffer_load_dword v76, v119, s[8:11], s20 offen sc1
  buffer_load_dword v77, v119, s[8:11], s20 offen sc1
  buffer_load_dword v78, v119, s[8:11], s20 offen sc1
cA_va3_fp_l:
  s_waitcnt vmcnt(2)
  v_cmp_eq_u32 vcc, -1, v76
  s_cbranch_vccz cA_va3_fp_d
  buffer_load_dword v76, v119, s[8:11], s20 offen sc1
  s_waitcnt vmcnt(2)
  v_cmp_eq_u32 vcc, -1, v77
  s_cbranch_vccz cA_va3_fp_d
  buffer_load_dword v77, v119, s[8:11], s20 offen sc1
  s_waitcnt vmcnt(2)
  v_cmp_eq_u32 vcc, -1, v78
  s_cbranch_vccz cA_va3_fp_d
  buffer_load_dword v78, v119, s[8:11], s20 offen sc1
  s_add_u32 s30, s30, 1
  s_cmp_lt_u32 s30, 400000
  s_cbranch_scc1 cA_va3_fp_l
  s_branch cA_abort
cA_va3_fp_d:
  buffer_load_dwordx4 v[24:27], v2, s[8:11], s23 offen offset:0 sc1
  buffer_load_dwordx4 v[28:31], v2, s[8:11], s23 offen offset:1024 sc1
  buffer_load_dwordx4 v[32:35], v2, s[8:11], s23 offen offset:2048 sc1
  s_barrier
cA_va3_ld:
  s_waitcnt vmcnt(0)
  v_max3_u32 v84, v24, v25, v26
  v_max3_u32 v84, v84, v27, v28
  v_max3_u32 v84, v84, v29, v30
  v_max3_u32 v84, v84, v31, v32
  v_max3_u32 v84, v84, v33, v34
  v_max_u32 v84, v84, v35
  v_cmp_eq_u32 vcc, -1, v84
  ds_write_b128 v2, v[24:27] offset:12288
  ds_write_b128 v2, v[28:31] offset:13312
  ds_write_b128 v2, v[32:35] offset:14336
  s_cbranch_vccnz cA_va3_retry
  s_waitcnt lgkmcnt(0)
  s_barrier
  ds_read_b128 v[8:11], v5 offset:8192
  ds_read_b128 v[12:15], v5 offset:9216
  ds_read_b128 v[16:19], v5 offset:10240
  ds_read_b128 v[20:23], v5 offset:11264
  ds_read_b128 v[24:27], v5 offset:12288
  ds_read_b128 v[28:31], v5 offset:13312
  ds_read_b128 v[32:35], v5 offset:14336
  s_waitcnt lgkmcnt(0)
  s_cmp_eq_u32 s19, 63
  s_cbranch_scc1 cA_done
  ds_read_b128 v[76:79], v1 offset:0
  ds_read_b128 v[80:83], v1 offset:1024
  ds_read_b128 v[84:87], v1 offset:2048
  ds_read_b128 v[88:91], v1 offset:3072
  ds_read_b128 v[92:95], v1 offset:4096
  ds_read_b128 v[96:99], v1 offset:5120
  v_smfmac_f32_16x16x64_bf16 v[60:63], v[8:11], v[200:207], v3
  v_smfmac_f32_16x16x64_bf16 v[60:63], v[12:15], v[208:215], v3
  s_waitcnt lgkmcnt(4)
  v_smfmac_f32_16x16x64_bf16 v[64:67], v[8:11], v[76:83], v3
  ds_read_b128 v[76:79], v1 offset:6144
  ds_read_b128 v[80:83], v1 offset:7168
  v_smfmac_f32_16x16x64_bf16 v[60:63], v[16:19], v[216:223], v3
  v_smfmac_f32_16x16x64_bf16 v[60:63], v[20:23], v[224:231], v3
  s_waitcnt lgkmcnt(4)
  v_smfmac_f32_16x16x64_bf16 v[64:67], v[12:15], v[84:91], v3
  ds_read_b128 v[84:87], v1 offset:8192
  ds_read_b128 v[88:91], v1 offset:9216
  v_smfmac_f32_16x16x64_bf16 v[60:63], v[24:27], v[232:239], v3
  v_smfmac_f32_16x16x64_bf16 v[60:63], v[28:31], v[240:247], v3
  s_waitcnt lgkmcnt(4)
  v_smfmac_f32_16x16x64_bf16 v[64:67], v[16:19], v[92:99], v3
  ds_read_b128 v[92:95], v1 offset:10240
  ds_read_b128 v[96:99], v1 offset:11264
  v_smfmac_f32_16x16x64_bf16 v[60:63], v[32:35], v[248:255], v3
  v_smfmac_f32_16x16x64_bf16 v[36:39], v[8:11], a[0:7], v3
  s_waitcnt lgkmcnt(4)
  v_smfmac_f32_16x16x64_bf16 v[64:67], v[20:23], v[76:83], v3
  ds_read_b128 v[76:79], v1 offset:12288
  ds_read_b128 v[80:83], v1 offset:13312
  v_smfmac_f32_16x16x64_bf16 v[36:39], v[12:15], a[8:15], v3
  v_add_f32 v60, v60, v61
  v_smfmac_f32_16x16x64_bf16 v[36:39], v[16:19], a[16:23], v3
  v_add_f32 v62, v62, v63
  s_waitcnt lgkmcnt(4)
  v_smfmac_f32_16x16x64_bf16 v[64:67], v[24:27], v[84:91], v3
  v_cvt_pk_bf16_f32 v60, v60, v62
  v_smfmac_f32_16x16x64_bf16 v[36:39], v[20:23], a[24:31], v3
  ds_write_b32 v106, v60
  v_smfmac_f32_16x16x64_bf16 v[36:39], v[24:27], a[32:39], v3
  s_waitcnt lgkmcnt(2)
  v_smfmac_f32_16x16x64_bf16 v[64:67], v[28:31], v[92:99], v3
  v_smfmac_f32_16x16x64_bf16 v[36:39], v[28:31], a[40:47], v3
  v_smfmac_f32_16x16x64_bf16 v[36:39], v[32:35], a[48:55], v3
  s_waitcnt lgkmcnt(0)
  v_smfmac_f32_16x16x64_bf16 v[64:67], v[32:35], v[76:83], v3
  v_smfmac_f32_16x16x64_bf16 v[40:43], v[8:11], a[56:63], v3
  v_smfmac_f32_16x16x64_bf16 v[40:43], v[12:15], a[64:71], v3
  v_add_f32 v36, v36, v37
  v_smfmac_f32_16x16x64_bf16 v[40:43], v[16:19], a[72:79], v3
  v_add_f32 v38, v38, v39
  v_smfmac_f32_16x16x64_bf16 v[40:43], v[20:23], a[80:87], v3
  v_cvt_pk_bf16_f32 v36, v36, v38
  v_smfmac_f32_16x16x64_bf16 v[40:43], v[24:27], a[88:95], v3
  ds_write_b32 v100, v36
  v_smfmac_f32_16x16x64_bf16 v[40:43], v[28:31], a[96:103], v3
  v_add_f32 v64, v64, v65
  v_smfmac_f32_16x16x64_bf16 v[40:43], v[32:35], a[104:111], v3
  v_add_f32 v66, v66, v67
  v_smfmac_f32_16x16x64_bf16 v[44:47], v[8:11], a[112:119], v3
  v_cvt_pk_bf16_f32 v64, v64, v66
  v_smfmac_f32_16x16x64_bf16 v[44:47], v[12:15], a[120:127], v3
  ds_write_b32 v107, v64
  v_smfmac_f32_16x16x64_bf16 v[44:47], v[16:19], a[128:135], v3
  v_add_f32 v40, v40, v41
  v_smfmac_f32_16x16x64_bf16 v[44:47], v[20:23], a[136:143], v3
  v_add_f32 v42, v42, v43
  v_smfmac_f32_16x16x64_bf16 v[44:47], v[24:27], a[144:151], v3
  v_cvt_pk_bf16_f32 v40, v40, v42
  v_smfmac_f32_16x16x64_bf16 v[44:47], v[28:31], a[152:159], v3
  ds_write_b32 v101, v40
  v_smfmac_f32_16x16x64_bf16 v[44:47], v[32:35], a[160:167], v3
  v_smfmac_f32_16x16x64_bf16 v[48:51], v[8:11], a[168:175], v3
  v_smfmac_f32_16x16x64_bf16 v[48:51], v[12:15], a[176:183], v3
  v_smfmac_f32_16x16x64_bf16 v[48:51], v[16:19], a[184:191], v3
  v_add_f32 v44, v44, v45
  v_smfmac_f32_16x16x64_bf16 v[48:51], v[20:23], a[192:199], v3
  v_add_f32 v46, v46, v47
  v_smfmac_f32_16x16x64_bf16 v[48:51], v[24:27], a[200:207], v3
  v_cvt_pk_bf16_f32 v44, v44, v46
  v_smfmac_f32_16x16x64_bf16 v[48:51], v[28:31], a[208:215], v3
  ds_write_b32 v102, v44
  v_smfmac_f32_16x16x64_bf16 v[48:51], v[32:35], a[216:223], v3
  v_smfmac_f32_16x16x64_bf16 v[52:55], v[8:11], a[224:231], v3
  v_smfmac_f32_16x16x64_bf16 v[52:55], v[12:15], a[232:239], v3
  v_smfmac_f32_16x16x64_bf16 v[52:55], v[16:19], a[240:247], v3
  v_add_f32 v48, v48, v49
  v_smfmac_f32_16x16x64_bf16 v[52:55], v[20:23], a[248:255], v3
  v_add_f32 v50, v50, v51
  v_smfmac_f32_16x16x64_bf16 v[52:55], v[24:27], v[120:127], v3
  v_cvt_pk_bf16_f32 v48, v48, v50
  v_smfmac_f32_16x16x64_bf16 v[52:55], v[28:31], v[128:135], v3
  ds_write_b32 v103, v48
  v_smfmac_f32_16x16x64_bf16 v[52:55], v[32:35], v[136:143], v3
  v_smfmac_f32_16x16x64_bf16 v[56:59], v[8:11], v[144:151], v3
  v_smfmac_f32_16x16x64_bf16 v[56:59], v[12:15], v[152:159], v3
  v_smfmac_f32_16x16x64_bf16 v[56:59], v[16:19], v[160:167], v3
  v_add_f32 v52, v52, v53
  v_smfmac_f32_16x16x64_bf16 v[56:59], v[20:23], v[168:175], v3
  v_add_f32 v54, v54, v55
  v_smfmac_f32_16x16x64_bf16 v[56:59], v[24:27], v[176:183], v3
  v_cvt_pk_bf16_f32 v52, v52, v54
  v_smfmac_f32_16x16x64_bf16 v[56:59], v[28:31], v[184:191], v3
  ds_write_b32 v104, v52
  v_smfmac_f32_16x16x64_bf16 v[56:59], v[32:35], v[192:199], v3
  s_nop 7
  v_add_f32 v56, v56, v57
  v_add_f32 v58, v58, v59
  v_cvt_pk_bf16_f32 v56, v56, v58
  ds_write_b32 v105, v56
  s_waitcnt lgkmcnt(0)
  s_barrier
  s_cmp_eq_u32 s19, 62
  s_cbranch_scc1 cA_done
  s_waitcnt vmcnt(0) lgkmcnt(0)
  s_add_u32 s19, s19, 1
  s_mov_b32 s20, s21
  s_branch cA_va3_loop
cA_va3_retry:
  s_waitcnt lgkmcnt(0)
  buffer_load_dwordx4 v[24:27], v2, s[8:11], s23 offen offset:0 sc1
  buffer_load_dwordx4 v[28:31], v2, s[8:11], s23 offen offset:1024 sc1
  buffer_load_dwordx4 v[32:35], v2, s[8:11], s23 offen offset:2048 sc1
  s_add_u32 s31, s31, 1
  s_add_u32 s30, s30, 1
  s_cmp_lt_u32 s30, 400000
  s_cbranch_scc1 cA_va3_ld
  s_branch cA_abort
cA_va3_last:
  s_waitcnt lgkmcnt(0)
  buffer_store_dwordx4 v[100:103], v2, s[8:11], s24 offen offset:0 sc1
  buffer_store_dwordx4 v[104:107], v2, s[8:11], s24 offen offset:1024 sc1
  buffer_store_dwordx4 v[108:111], v2, s[8:11], s24 offen offset:2048 sc1
  buffer_store_dwordx4 v[4:7], v2, s[8:11], s24 offen offset:3072 sc1
  s_add_u32 s24, s24, 8192
  s_waitcnt vmcnt(0)
  s_mov_b64 exec, 1
  buffer_store_dword v117, v2, s[8:11], s34 offen sc1
  s_mov_b64 exec, -1
  s_add_u32 s34, s34, 8
  s_mov_b64 exec, 1
  buffer_store_dword v117, v2, s[8:11], s34 offen sc1
  s_mov_b64 exec, -1
  s_add_u32 s34, s34, 8
  s_branch cA_done
cA_abort:
  v_mov_b32 v4, 0xdead
  v_mov_b32 v5, 16
  buffer_store_dword v4, v5, s[12:15], 0 offen
  s_branch ch_end
cA_done:
  s_branch ch_end
.p2align 6

cB_sc0_loop:
  s_add_u32 s23, s20, 4096
  s_add_u32 s21, s20, 20480
  v_mov_b32 v48, 0
  v_mov_b32 v49, 0
  v_mov_b32 v50, 0
  v_mov_b32 v51, 0
  v_mov_b32 v52, 0
  v_mov_b32 v53, 0
  v_mov_b32 v54, 0
  v_mov_b32 v55, 0
  v_mov_b32 v56, 0
  v_mov_b32 v57, 0
  v_mov_b32 v58, 0
  v_mov_b32 v59, 0
  v_mov_b32 v60, 0
  v_mov_b32 v61, 0
  v_mov_b32 v62, 0
  v_mov_b32 v63, 0
  v_mov_b32 v88, 0
  v_mov_b32 v89, 0
  v_mov_b32 v90, 0
  v_mov_b32 v91, 0
  v_mov_b32 v92, 0
  v_mov_b32 v93, 0
  v_mov_b32 v94, 0
  v_mov_b32 v95, 0
  v_mov_b32 v66, 0
  v_mov_b32 v67, 0
  s_mov_b32 s30, 0
  s_mov_b32 s62, 0
  buffer_load_dword v68, v0, s[8:11], s20 offen sc1
  s_nop 7
  buffer_load_dword v69, v0, s[8:11], s20 offen sc1
  s_nop 7
  buffer_load_dword v70, v0, s[8:11], s20 offen sc1
  s_nop 7
  buffer_load_dword v71, v0, s[8:11], s20 offen sc1
  s_nop 7
  buffer_load_dword v72, v0, s[8:11], s20 offen sc1
cB_sc0_fp_l:
  s_waitcnt vmcnt(4)
  v_cmp_eq_u32 vcc, -1, v68
  s_cbranch_vccz cB_sc0_fp_d
  buffer_load_dword v68, v0, s[8:11], s20 offen sc1
  s_waitcnt vmcnt(4)
  v_cmp_eq_u32 vcc, -1, v69
  s_cbranch_vccz cB_sc0_fp_d
  buffer_load_dword v69, v0, s[8:11], s20 offen sc1
  s_waitcnt vmcnt(4)
  v_cmp_eq_u32 vcc, -1, v70
  s_cbranch_vccz cB_sc0_fp_d
  buffer_load_dword v70, v0, s[8:11], s20 offen sc1
  s_waitcnt vmcnt(4)
  v_cmp_eq_u32 vcc, -1, v71
  s_cbranch_vccz cB_sc0_fp_d
  buffer_load_dword v71, v0, s[8:11], s20 offen sc1
  s_waitcnt vmcnt(4)
  v_cmp_eq_u32 vcc, -1, v72
  s_cbranch_vccz cB_sc0_fp_d
  buffer_load_dword v72, v0, s[8:11], s20 offen sc1
  s_add_u32 s30, s30, 1
  s_cmp_lt_u32 s30, 400000
  s_cbranch_scc1 cB_sc0_fp_l
  s_branch cB_abort
cB_sc0_fp_d:
  buffer_load_dwordx4 v[8:11], v2, s[8:11], s20 offen offset:0 sc1
  s_barrier
  s_branch cB_sc0_ld1
cB_sc0_ld:
  buffer_load_dwordx4 v[8:11], v2, s[8:11], s20 offen offset:0 sc1
cB_sc0_ld1:
  v_mov_b32 v36, 0
  v_mov_b32 v37, 0
  v_mov_b32 v38, 0
  v_mov_b32 v39, 0
  buffer_load_dwordx4 v[12:15], v2, s[8:11], s20 offen offset:1024 sc1
  v_mov_b32 v40, 0
  v_mov_b32 v41, 0
  v_mov_b32 v42, 0
  v_mov_b32 v43, 0
  buffer_load_dwordx4 v[16:19], v2, s[8:11], s20 offen offset:2048 sc1
  v_mov_b32 v44, 0
  v_mov_b32 v45, 0
  v_mov_b32 v46, 0
  v_mov_b32 v47, 0
  ds_read_b128 v[96:99], v117 offset:0
  ds_read_b128 v[100:103], v117 offset:1024
  ds_read_b128 v[104:107], v117 offset:14336
  ds_read_b128 v[108:111], v117 offset:15360
  s_waitcnt vmcnt(2)
  v_smfmac_f32_16x16x64_bf16 v[36:39], v[8:11], a[0:7], v3
  v_smfmac_f32_16x16x64_bf16 v[40:43], v[8:11], a[56:63], v3
  buffer_load_dwordx4 v[20:23], v2, s[8:11], s20 offen offset:3072 sc1
  v_smfmac_f32_16x16x64_bf16 v[44:47], v[8:11], a[112:119], v3
  v_smfmac_f32_16x16x64_bf16 v[48:51], v[8:11], a[168:175], v3
  v_smfmac_f32_16x16x64_bf16 v[52:55], v[8:11], a[224:231], v3
  buffer_load_dwordx4 v[24:27], v2, s[8:11], s23 offen offset:0 sc1
  v_smfmac_f32_16x16x64_bf16 v[56:59], v[8:11], v[144:151], v3
  v_smfmac_f32_16x16x64_bf16 v[60:63], v[8:11], v[200:207], v3
  s_waitcnt vmcnt(3)
  v_smfmac_f32_16x16x64_bf16 v[36:39], v[12:15], a[8:15], v3
  v_smfmac_f32_16x16x64_bf16 v[40:43], v[12:15], a[64:71], v3
  buffer_load_dwordx4 v[28:31], v2, s[8:11], s23 offen offset:1024 sc1
  v_smfmac_f32_16x16x64_bf16 v[44:47], v[12:15], a[120:127], v3
  v_smfmac_f32_16x16x64_bf16 v[48:51], v[12:15], a[176:183], v3
  v_smfmac_f32_16x16x64_bf16 v[52:55], v[12:15], a[232:239], v3
  buffer_load_dwordx4 v[32:35], v2, s[8:11], s23 offen offset:2048 sc1
  v_smfmac_f32_16x16x64_bf16 v[56:59], v[12:15], v[152:159], v3
  v_smfmac_f32_16x16x64_bf16 v[60:63], v[12:15], v[208:215], v3
  s_xor_b32 s58, s25, 28672
  s_add_u32 s59, s24, 28672
  s_add_u32 m0, s58, 0
  s_waitcnt vmcnt(4)
  v_smfmac_f32_16x16x64_bf16 v[36:39], v[16:19], a[16:23], v3
  buffer_load_dwordx4 v2, s[8:11], s59 offen offset:0 sc1 lds
  v_smfmac_f32_16x16x64_bf16 v[40:43], v[16:19], a[72:79], v3
  v_smfmac_f32_16x16x64_bf16 v[44:47], v[16:19], a[128:135], v3
  v_smfmac_f32_16x16x64_bf16 v[48:51], v[16:19], a[184:191], v3
  v_smfmac_f32_16x16x64_bf16 v[52:55], v[16:19], a[240:247], v3
  buffer_load_dwordx4 v2, s[8:11], s59 offen offset:1024 sc1 lds
  v_smfmac_f32_16x16x64_bf16 v[56:59], v[16:19], v[160:167], v3
  v_smfmac_f32_16x16x64_bf16 v[60:63], v[16:19], v[216:223], v3
  s_waitcnt vmcnt(5)
  v_smfmac_f32_16x16x64_bf16 v[36:39], v[20:23], a[24:31], v3
  v_smfmac_f32_16x16x64_bf16 v[40:43], v[20:23], a[80:87], v3
  buffer_load_dwordx4 v2, s[8:11], s59 offen offset:2048 sc1 lds
  v_smfmac_f32_16x16x64_bf16 v[44:47], v[20:23], a[136:143], v3
  v_smfmac_f32_16x16x64_bf16 v[48:51], v[20:23], a[192:199], v3
  v_smfmac_f32_16x16x64_bf16 v[52:55], v[20:23], a[248:255], v3
  v_smfmac_f32_16x16x64_bf16 v[56:59], v[20:23], v[168:175], v3
  buffer_load_dwordx4 v2, s[8:11], s59 offen offset:3072 sc1 lds
  v_smfmac_f32_16x16x64_bf16 v[60:63], v[20:23], v[224:231], v3
  s_waitcnt vmcnt(4)
cB_sc0_ph2:
  v_smfmac_f32_16x16x64_bf16 v[60:63], v[24:27], v[232:239], v3
  ds_read_b128 v[12:15], v116 offset:0
  ds_read_b128 v[16:19], v116 offset:1024
  v_smfmac_f32_16x16x64_bf16 v[60:63], v[28:31], v[240:247], v3
  v_smfmac_f32_16x16x64_bf16 v[60:63], v[32:35], v[248:255], v3
  v_mov_b32 v80, v24
  v_smfmac_f32_16x16x64_bf16 v[52:55], v[24:27], v[120:127], v3
  v_mov_b32 v81, v25
  v_smfmac_f32_16x16x64_bf16 v[52:55], v[28:31], v[128:135], v3
  v_mov_b32 v82, v32
  v_smfmac_f32_16x16x64_bf16 v[52:55], v[32:35], v[136:143], v3
  v_cvt_pk_bf16_f32 v64, v60, v61
  v_smfmac_f32_16x16x64_bf16 v[56:59], v[24:27], v[176:183], v3
  v_cvt_pk_bf16_f32 v65, v62, v63
  v_smfmac_f32_16x16x64_bf16 v[56:59], v[28:31], v[184:191], v3
  v_mov_b32 v83, v33
  v_mfma_f32_16x16x32_bf16 v[68:71], v[64:67], v[4:7], 0
  v_smfmac_f32_16x16x64_bf16 v[56:59], v[32:35], v[192:199], v3
  v_cvt_pk_bf16_f32 v64, v52, v53
  v_smfmac_f32_16x16x64_bf16 v[36:39], v[24:27], a[32:39], v3
  v_cvt_pk_bf16_f32 v65, v54, v55
  v_smfmac_f32_16x16x64_bf16 v[36:39], v[28:31], a[40:47], v3
  v_cvt_pk_bf16_f32 v78, v68, v69
  v_smfmac_f32_16x16x64_bf16 v[36:39], v[32:35], a[48:55], v3
  v_cvt_pk_bf16_f32 v79, v70, v71
  v_cvt_pk_bf16_f32 v66, v56, v57
  v_smfmac_f32_16x16x64_bf16 v[40:43], v[24:27], a[88:95], v3
  v_cvt_pk_bf16_f32 v67, v58, v59
  v_smfmac_f32_16x16x64_bf16 v[40:43], v[28:31], a[96:103], v3
  v_mfma_f32_16x16x32_bf16 v[72:75], v[64:67], v[4:7], 0
  ds_read_b128 v[52:55], v116 offset:14336
  ds_read_b128 v[56:59], v116 offset:15360
  v_smfmac_f32_16x16x64_bf16 v[40:43], v[32:35], a[104:111], v3
  v_cvt_pk_bf16_f32 v64, v36, v37
  v_smfmac_f32_16x16x64_bf16 v[44:47], v[24:27], a[144:151], v3
  v_cvt_pk_bf16_f32 v65, v38, v39
  v_smfmac_f32_16x16x64_bf16 v[44:47], v[28:31], a[152:159], v3
  v_cvt_pk_bf16_f32 v76, v72, v73
  v_smfmac_f32_16x16x64_bf16 v[44:47], v[32:35], a[160:167], v3
  v_cvt_pk_bf16_f32 v77, v74, v75
  v_cvt_pk_bf16_f32 v66, v40, v41
  v_smfmac_f32_16x16x64_bf16 v[48:51], v[24:27], a[200:207], v3
  v_cvt_pk_bf16_f32 v67, v42, v43
  v_smfmac_f32_16x16x64_bf16 v[48:51], v[28:31], a[208:215], v3
  v_mfma_f32_16x16x32_bf16 v[68:71], v[64:67], v[4:7], 0
  v_smfmac_f32_16x16x64_bf16 v[48:51], v[32:35], a[216:223], v3
  v_cvt_pk_bf16_f32 v64, v44, v45
  v_mfma_f32_16x16x32_bf16 v[84:87], v[80:83], v[76:79], 0
  v_cvt_pk_bf16_f32 v65, v46, v47
  s_waitcnt lgkmcnt(0)
  v_smfmac_f32_16x16x64_bf16 v[88:91], v[76:79], v[96:103], v118
  v_cvt_pk_bf16_f32 v60, v68, v69
  v_cvt_pk_bf16_f32 v61, v70, v71
  v_cvt_pk_bf16_f32 v66, v48, v49
  v_cvt_pk_bf16_f32 v67, v50, v51
  s_nop 1
  v_mfma_f32_16x16x32_bf16 v[72:75], v[64:67], v[4:7], 0
  v_smfmac_f32_16x16x64_bf16 v[92:95], v[76:79], v[104:111], v118
  s_nop 4
  v_cvt_pk_bf16_f32 v62, v72, v73
  v_cvt_pk_bf16_f32 v63, v74, v75
  s_nop 1
  v_mfma_f32_16x16x32_bf16 v[84:87], v[8:11], v[60:63], v[84:87]
  v_smfmac_f32_16x16x64_bf16 v[88:91], v[60:63], v[12:19], v118
  v_smfmac_f32_16x16x64_bf16 v[92:95], v[60:63], v[52:59], v118
  s_nop 1
  v_permlane32_swap_b32 v84, v86
  v_permlane32_swap_b32 v85, v87
  s_nop 0
  v_add_f32 v88, v88, v89
  v_add_f32_dpp v84, v86, v84 quad_perm:[1,0,3,2] row_mask:0xf bank_mask:0xf
  v_add_f32_dpp v85, v87, v85 quad_perm:[1,0,3,2] row_mask:0xf bank_mask:0xf
  v_add_f32 v89, v90, v91
  ds_write2_b32 v113, v84, v85 offset0:0 offset1:4
  ds_write2_b32 v112, v88, v89 offset0:0 offset1:128
  v_add_f32 v90, v92, v93
  v_add_f32 v91, v94, v95
  ds_write2_b32 v112, v90, v91 offset0:64 offset1:192
  v_cmp_u_f32 vcc, v88, v89
  s_cbranch_vccnz cB_sc0_retry
cB_sc0_cont:
  s_waitcnt lgkmcnt(0)
  s_barrier
  ds_read_b128 v[36:39], v114
  ds_read_b128 v[44:47], v115
  s_waitcnt lgkmcnt(0)
  v_add_f32 v36, v36, v38
  v_add_f32 v37, v37, v39
  v_add_f32 v44, v44, v45
  v_add_f32 v46, v46, v47
  v_add_f32 v44, v44, v46
  v_add_f32 v36, v36, v37
  v_exp_f32 v49, v44
  v_exp_f32 v48, v36
  v_add_f32 v50, abs(v36), abs(v44)
  v_fma_f32 v39, v49, s37, v48
  v_cmp_ngt_f32 vcc, s56, v50
  v_cndmask_b32 v41, v48, v49, s[38:39]
  v_add_f32_dpp v39, v39, v39 quad_perm:[1,0,3,2] row_mask:0xf bank_mask:0xf
  v_cndmask_b32 v40, v49, v48, s[38:39]
  v_mov_b32_dpp v46, v41 quad_perm:[1,0,3,2] row_mask:0xf bank_mask:0xf
  v_add_f32_dpp v39, v39, v39 quad_perm:[2,3,0,1] row_mask:0xf bank_mask:0xf
  v_cndmask_b32 v42, v46, v40, s[38:39]
  v_cndmask_b32 v43, v40, v46, s[38:39]
  v_add_f32_dpp v39, v39, v39 row_half_mirror row_mask:0xf bank_mask:0xf
  s_cbranch_vccnz cB_sc0_slow
  s_nop 0
  v_add_f32_dpp v47, v39, v39 row_mirror row_mask:0xf bank_mask:0xf
  v_add_f32_dpp v39, v39, v39 row_mirror row_mask:0xf bank_mask:0xf
  s_nop 1
  v_permlane16_swap_b32 v39, v47
  v_add_f32 v39, v39, v47
  v_rcp_f32 v39, v39
  s_mov_b64 exec, s[28:29]
  v_mul_f32 v42, v42, v39
  v_mul_f32 v43, v43, v39
  v_cvt_pk_bf16_f32 v42, v42, v43
cB_sc0_pst:
  buffer_store_dword v42, v1, s[8:11], s20 offen sc1
  s_mov_b64 exec, -1
  s_barrier
  s_add_u32 s24, s24, 28672
  s_add_u32 s35, s35, 28672
  s_xor_b32 s25, s25, 28672
  s_add_u32 m0, s25, 0
  s_add_u32 m0, s25, 4096
  s_add_u32 s22, s24, 4096
  buffer_load_dwordx4 v2, s[8:11], s22 offen offset:0 sc1 lds
  s_nop 5
  buffer_load_dwordx4 v2, s[8:11], s22 offen offset:1024 sc1 lds
  s_nop 5
  buffer_load_dwordx4 v2, s[8:11], s22 offen offset:2048 sc1 lds
  s_nop 5
  v_xor_b32 v116, 28672, v116
  v_add_u32 v117, s57, v117
  s_sub_u32 s57, 0, s57
  s_add_u32 s19, s19, 1
  s_mov_b32 s20, s21
  s_cmp_lt_u32 s19, 63
  s_cbranch_scc1 cB_sc0_loop
  s_branch cB_done
cB_sc0_slow:
  v_max_f32 v50, v36, v44
  s_nop 1
  v_max_f32_dpp v50, v50, v50 quad_perm:[1,0,3,2] row_mask:0xf bank_mask:0xf
  s_nop 1
  v_max_f32_dpp v50, v50, v50 quad_perm:[2,3,0,1] row_mask:0xf bank_mask:0xf
  s_nop 1
  v_max_f32_dpp v50, v50, v50 row_half_mirror row_mask:0xf bank_mask:0xf
  s_nop 1
  v_max_f32_dpp v50, v50, v50 row_mirror row_mask:0xf bank_mask:0xf
  v_mov_b32 v47, v50
  s_nop 1
  v_permlane16_swap_b32 v50, v47
  v_max_f32 v50, v50, v47
  v_sub_f32 v48, v36, v50
  v_sub_f32 v49, v44, v50
  v_exp_f32 v48, v48
  v_exp_f32 v49, v49
  s_add_u32 s31, s31, 0x100
  v_fma_f32 v39, v49, s37, v48
  v_cndmask_b32 v41, v48, v49, s[38:39]
  s_nop 0
  v_add_f32_dpp v39, v39, v39 quad_perm:[1,0,3,2] row_mask:0xf bank_mask:0xf
  v_cndmask_b32 v40, v49, v48, s[38:39]
  v_mov_b32_dpp v46, v41 quad_perm:[1,0,3,2] row_mask:0xf bank_mask:0xf
  v_add_f32_dpp v39, v39, v39 quad_perm:[2,3,0,1] row_mask:0xf bank_mask:0xf
  v_cndmask_b32 v42, v46, v40, s[38:39]
  v_cndmask_b32 v43, v40, v46, s[38:39]
  v_add_f32_dpp v39, v39, v39 row_half_mirror row_mask:0xf bank_mask:0xf
  s_nop 1
  v_add_f32_dpp v47, v39, v39 row_mirror row_mask:0xf bank_mask:0xf
  v_add_f32_dpp v39, v39, v39 row_mirror row_mask:0xf bank_mask:0xf
  s_nop 1
  v_permlane16_swap_b32 v39, v47
  v_add_f32 v39, v39, v47
  v_rcp_f32 v39, v39
  s_mov_b64 exec, s[28:29]
  v_mul_f32 v42, v42, v39
  v_mul_f32 v43, v43, v39
  v_cvt_pk_bf16_f32 v42, v42, v43
  v_min_u32 v42, -2, v42
  s_branch cB_sc0_pst
cB_sc0_retry:
  s_cmp_lg_u32 s62, 0
  s_cbranch_scc1 cB_sc0_cont
  s_waitcnt vmcnt(0) lgkmcnt(0)
cB_sc0_rv:
  buffer_load_dwordx4 v[8:11], v2, s[8:11], s20 offen offset:0 sc1
  buffer_load_dwordx4 v[12:15], v2, s[8:11], s20 offen offset:1024 sc1
  buffer_load_dwordx4 v[16:19], v2, s[8:11], s20 offen offset:2048 sc1
  buffer_load_dwordx4 v[20:23], v2, s[8:11], s20 offen offset:3072 sc1
  buffer_load_dwordx4 v[24:27], v2, s[8:11], s23 offen offset:0 sc1
  buffer_load_dwordx4 v[28:31], v2, s[8:11], s23 offen offset:1024 sc1
  buffer_load_dwordx4 v[32:35], v2, s[8:11], s23 offen offset:2048 sc1
  s_waitcnt vmcnt(0)
  v_max3_u32 v68, v8, v9, v10
  v_max3_u32 v68, v68, v11, v12
  v_max3_u32 v68, v68, v13, v14
  v_max3_u32 v68, v68, v15, v16
  v_max3_u32 v68, v68, v17, v18
  v_max3_u32 v68, v68, v19, v20
  v_max3_u32 v68, v68, v21, v22
  v_max3_u32 v68, v68, v23, v24
  v_max3_u32 v68, v68, v25, v26
  v_max3_u32 v68, v68, v27, v28
  v_max3_u32 v68, v68, v29, v30
  v_max3_u32 v68, v68, v31, v32
  v_max3_u32 v68, v68, v33, v34
  v_max_u32 v68, v68, v35
  v_cmp_eq_u32 vcc, -1, v68
  s_cbranch_vccz cB_sc0_rk
  s_add_u32 s30, s30, 1
  s_cmp_lt_u32 s30, 400000
  s_cbranch_scc1 cB_sc0_rv
  s_branch cB_abort
cB_sc0_rk:
  s_mov_b32 s62, 1
  v_mov_b32 v36, 0
  v_mov_b32 v37, 0
  v_mov_b32 v38, 0
  v_mov_b32 v39, 0
  v_mov_b32 v40, 0
  v_mov_b32 v41, 0
  v_mov_b32 v42, 0
  v_mov_b32 v43, 0
  v_mov_b32 v44, 0
  v_mov_b32 v45, 0
  v_mov_b32 v46, 0
  v_mov_b32 v47, 0
  v_mov_b32 v48, 0
  v_mov_b32 v49, 0
  v_mov_b32 v50, 0
  v_mov_b32 v51, 0
  v_mov_b32 v52, 0
  v_mov_b32 v53, 0
  v_mov_b32 v54, 0
  v_mov_b32 v55, 0
  v_mov_b32 v56, 0
  v_mov_b32 v57, 0
  v_mov_b32 v58, 0
  v_mov_b32 v59, 0
  v_mov_b32 v60, 0
  v_mov_b32 v61, 0
  v_mov_b32 v62, 0
  v_mov_b32 v63, 0
  v_mov_b32 v88, 0
  v_mov_b32 v89, 0
  v_mov_b32 v90, 0
  v_mov_b32 v91, 0
  v_mov_b32 v92, 0
  v_mov_b32 v93, 0
  v_mov_b32 v94, 0
  v_mov_b32 v95, 0
  v_mov_b32 v66, 0
  v_mov_b32 v67, 0
  s_add_u32 s31, s31, 1
  ds_read_b128 v[96:99], v117 offset:0
  ds_read_b128 v[100:103], v117 offset:1024
  ds_read_b128 v[104:107], v117 offset:14336
  ds_read_b128 v[108:111], v117 offset:15360
  v_smfmac_f32_16x16x64_bf16 v[36:39], v[8:11], a[0:7], v3
  v_smfmac_f32_16x16x64_bf16 v[40:43], v[8:11], a[56:63], v3
  v_smfmac_f32_16x16x64_bf16 v[44:47], v[8:11], a[112:119], v3
  v_smfmac_f32_16x16x64_bf16 v[48:51], v[8:11], a[168:175], v3
  v_smfmac_f32_16x16x64_bf16 v[52:55], v[8:11], a[224:231], v3
  v_smfmac_f32_16x16x64_bf16 v[56:59], v[8:11], v[144:151], v3
  v_smfmac_f32_16x16x64_bf16 v[60:63], v[8:11], v[200:207], v3
  v_smfmac_f32_16x16x64_bf16 v[36:39], v[12:15], a[8:15], v3
  v_smfmac_f32_16x16x64_bf16 v[40:43], v[12:15], a[64:71], v3
  v_smfmac_f32_16x16x64_bf16 v[44:47], v[12:15], a[120:127], v3
  v_smfmac_f32_16x16x64_bf16 v[48:51], v[12:15], a[176:183], v3
  v_smfmac_f32_16x16x64_bf16 v[52:55], v[12:15], a[232:239], v3
  v_smfmac_f32_16x16x64_bf16 v[56:59], v[12:15], v[152:159], v3
  v_smfmac_f32_16x16x64_bf16 v[60:63], v[12:15], v[208:215], v3
  v_smfmac_f32_16x16x64_bf16 v[36:39], v[16:19], a[16:23], v3
  v_smfmac_f32_16x16x64_bf16 v[40:43], v[16:19], a[72:79], v3
  v_smfmac_f32_16x16x64_bf16 v[44:47], v[16:19], a[128:135], v3
  v_smfmac_f32_16x16x64_bf16 v[48:51], v[16:19], a[184:191], v3
  v_smfmac_f32_16x16x64_bf16 v[52:55], v[16:19], a[240:247], v3
  v_smfmac_f32_16x16x64_bf16 v[56:59], v[16:19], v[160:167], v3
  v_smfmac_f32_16x16x64_bf16 v[60:63], v[16:19], v[216:223], v3
  v_smfmac_f32_16x16x64_bf16 v[36:39], v[20:23], a[24:31], v3
  v_smfmac_f32_16x16x64_bf16 v[40:43], v[20:23], a[80:87], v3
  v_smfmac_f32_16x16x64_bf16 v[44:47], v[20:23], a[136:143], v3
  v_smfmac_f32_16x16x64_bf16 v[48:51], v[20:23], a[192:199], v3
  v_smfmac_f32_16x16x64_bf16 v[52:55], v[20:23], a[248:255], v3
  v_smfmac_f32_16x16x64_bf16 v[56:59], v[20:23], v[168:175], v3
  v_smfmac_f32_16x16x64_bf16 v[60:63], v[20:23], v[224:231], v3
  s_xor_b32 s58, s25, 28672
  s_add_u32 s59, s24, 28672
  s_add_u32 m0, s58, 0
  s_branch cB_sc0_ph2
.p2align 6

cB_sc1_loop:
  s_add_u32 s23, s20, 4096
  s_add_u32 s21, s20, 20480
  v_mov_b32 v48, 0
  v_mov_b32 v49, 0
  v_mov_b32 v50, 0
  v_mov_b32 v51, 0
  v_mov_b32 v52, 0
  v_mov_b32 v53, 0
  v_mov_b32 v54, 0
  v_mov_b32 v55, 0
  v_mov_b32 v56, 0
  v_mov_b32 v57, 0
  v_mov_b32 v58, 0
  v_mov_b32 v59, 0
  v_mov_b32 v60, 0
  v_mov_b32 v61, 0
  v_mov_b32 v62, 0
  v_mov_b32 v63, 0
  v_mov_b32 v88, 0
  v_mov_b32 v89, 0
  v_mov_b32 v90, 0
  v_mov_b32 v91, 0
  v_mov_b32 v92, 0
  v_mov_b32 v93, 0
  v_mov_b32 v94, 0
  v_mov_b32 v95, 0
  v_mov_b32 v64, 0
  v_mov_b32 v65, 0
  s_mov_b32 s30, 0
  s_mov_b32 s62, 0
  s_waitcnt vmcnt(0)
  s_barrier
cB_sc1_ld:
  buffer_load_dwordx4 v[8:11], v2, s[8:11], s20 offen offset:0 sc1
  v_mov_b32 v36, 0
  v_mov_b32 v37, 0
  v_mov_b32 v38, 0
  v_mov_b32 v39, 0
  buffer_load_dwordx4 v[12:15], v2, s[8:11], s20 offen offset:1024 sc1
  v_mov_b32 v40, 0
  v_mov_b32 v41, 0
  v_mov_b32 v42, 0
  v_mov_b32 v43, 0
  buffer_load_dwordx4 v[16:19], v2, s[8:11], s20 offen offset:2048 sc1
  v_mov_b32 v44, 0
  v_mov_b32 v45, 0
  v_mov_b32 v46, 0
  v_mov_b32 v47, 0
  ds_read_b128 v[96:99], v117 offset:0
  ds_read_b128 v[100:103], v117 offset:1024
  ds_read_b128 v[104:107], v117 offset:14336
  ds_read_b128 v[108:111], v117 offset:15360
  s_waitcnt vmcnt(2)
  v_smfmac_f32_16x16x64_bf16 v[36:39], v[8:11], a[0:7], v3
  v_smfmac_f32_16x16x64_bf16 v[40:43], v[8:11], a[56:63], v3
  buffer_load_dwordx4 v[20:23], v2, s[8:11], s20 offen offset:3072 sc1
  v_smfmac_f32_16x16x64_bf16 v[44:47], v[8:11], a[112:119], v3
  v_smfmac_f32_16x16x64_bf16 v[48:51], v[8:11], a[168:175], v3
  v_smfmac_f32_16x16x64_bf16 v[52:55], v[8:11], a[224:231], v3
  buffer_load_dwordx4 v[24:27], v2, s[8:11], s23 offen offset:0 sc1
  v_smfmac_f32_16x16x64_bf16 v[56:59], v[8:11], v[144:151], v3
  v_smfmac_f32_16x16x64_bf16 v[60:63], v[8:11], v[200:207], v3
  s_waitcnt vmcnt(3)
  v_smfmac_f32_16x16x64_bf16 v[36:39], v[12:15], a[8:15], v3
  v_smfmac_f32_16x16x64_bf16 v[40:43], v[12:15], a[64:71], v3
  buffer_load_dwordx4 v[28:31], v2, s[8:11], s23 offen offset:1024 sc1
  v_smfmac_f32_16x16x64_bf16 v[44:47], v[12:15], a[120:127], v3
  v_smfmac_f32_16x16x64_bf16 v[48:51], v[12:15], a[176:183], v3
  v_smfmac_f32_16x16x64_bf16 v[52:55], v[12:15], a[232:239], v3
  buffer_load_dwordx4 v[32:35], v2, s[8:11], s23 offen offset:2048 sc1
  v_smfmac_f32_16x16x64_bf16 v[56:59], v[12:15], v[152:159], v3
  v_smfmac_f32_16x16x64_bf16 v[60:63], v[12:15], v[208:215], v3
  s_waitcnt vmcnt(4)
  v_smfmac_f32_16x16x64_bf16 v[36:39], v[16:19], a[16:23], v3
  s_xor_b32 s58, s25, 28672
  s_add_u32 s59, s24, 28672
  s_add_u32 m0, s58, 7168
  v_smfmac_f32_16x16x64_bf16 v[40:43], v[16:19], a[72:79], v3
  buffer_load_dwordx4 v2, s[8:11], s59 offen offset:0 sc1 lds
  v_smfmac_f32_16x16x64_bf16 v[44:47], v[16:19], a[128:135], v3
  v_smfmac_f32_16x16x64_bf16 v[48:51], v[16:19], a[184:191], v3
  v_smfmac_f32_16x16x64_bf16 v[52:55], v[16:19], a[240:247], v3
  v_smfmac_f32_16x16x64_bf16 v[56:59], v[16:19], v[160:167], v3
  buffer_load_dwordx4 v2, s[8:11], s59 offen offset:1024 sc1 lds
  v_smfmac_f32_16x16x64_bf16 v[60:63], v[16:19], v[216:223], v3
  s_waitcnt vmcnt(5)
  v_smfmac_f32_16x16x64_bf16 v[36:39], v[20:23], a[24:31], v3
  v_smfmac_f32_16x16x64_bf16 v[40:43], v[20:23], a[80:87], v3
  v_smfmac_f32_16x16x64_bf16 v[44:47], v[20:23], a[136:143], v3
  buffer_load_dwordx4 v2, s[8:11], s59 offen offset:2048 sc1 lds
  v_smfmac_f32_16x16x64_bf16 v[48:51], v[20:23], a[192:199], v3
  v_smfmac_f32_16x16x64_bf16 v[52:55], v[20:23], a[248:255], v3
  v_smfmac_f32_16x16x64_bf16 v[56:59], v[20:23], v[168:175], v3
  v_smfmac_f32_16x16x64_bf16 v[60:63], v[20:23], v[224:231], v3
  buffer_load_dwordx4 v2, s[8:11], s59 offen offset:3072 sc1 lds
  s_waitcnt vmcnt(4)
cB_sc1_ph2:
  v_smfmac_f32_16x16x64_bf16 v[60:63], v[24:27], v[232:239], v3
  ds_read_b128 v[16:19], v116 offset:2048
  ds_read_b128 v[20:23], v116 offset:3072
  v_smfmac_f32_16x16x64_bf16 v[60:63], v[28:31], v[240:247], v3
  buffer_load_dword v119, v0, s[8:11], s20 offen sc1
  v_smfmac_f32_16x16x64_bf16 v[60:63], v[32:35], v[248:255], v3
  v_mov_b32 v80, v26
  v_smfmac_f32_16x16x64_bf16 v[52:55], v[24:27], v[120:127], v3
  v_mov_b32 v81, v27
  v_smfmac_f32_16x16x64_bf16 v[52:55], v[28:31], v[128:135], v3
  v_mov_b32 v82, v32
  v_smfmac_f32_16x16x64_bf16 v[52:55], v[32:35], v[136:143], v3
  v_cvt_pk_bf16_f32 v66, v60, v61
  v_smfmac_f32_16x16x64_bf16 v[56:59], v[24:27], v[176:183], v3
  v_cvt_pk_bf16_f32 v67, v62, v63
  v_smfmac_f32_16x16x64_bf16 v[56:59], v[28:31], v[184:191], v3
  v_mov_b32 v83, v33
  v_mfma_f32_16x16x32_bf16 v[68:71], v[64:67], v[4:7], 0
  v_smfmac_f32_16x16x64_bf16 v[56:59], v[32:35], v[192:199], v3
  v_cvt_pk_bf16_f32 v64, v52, v53
  v_smfmac_f32_16x16x64_bf16 v[36:39], v[24:27], a[32:39], v3
  v_cvt_pk_bf16_f32 v65, v54, v55
  v_smfmac_f32_16x16x64_bf16 v[36:39], v[28:31], a[40:47], v3
  v_cvt_pk_bf16_f32 v78, v68, v69
  v_smfmac_f32_16x16x64_bf16 v[36:39], v[32:35], a[48:55], v3
  v_cvt_pk_bf16_f32 v79, v70, v71
  v_cvt_pk_bf16_f32 v66, v56, v57
  v_smfmac_f32_16x16x64_bf16 v[40:43], v[24:27], a[88:95], v3
  v_cvt_pk_bf16_f32 v67, v58, v59
  v_smfmac_f32_16x16x64_bf16 v[40:43], v[28:31], a[96:103], v3
  v_mfma_f32_16x16x32_bf16 v[72:75], v[64:67], v[4:7], 0
  ds_read_b128 v[52:55], v116 offset:16384
  ds_read_b128 v[56:59], v116 offset:17408
  v_smfmac_f32_16x16x64_bf16 v[40:43], v[32:35], a[104:111], v3
  v_cvt_pk_bf16_f32 v64, v36, v37
  v_smfmac_f32_16x16x64_bf16 v[44:47], v[24:27], a[144:151], v3
  v_cvt_pk_bf16_f32 v65, v38, v39
  v_smfmac_f32_16x16x64_bf16 v[44:47], v[28:31], a[152:159], v3
  v_cvt_pk_bf16_f32 v76, v72, v73
  v_smfmac_f32_16x16x64_bf16 v[44:47], v[32:35], a[160:167], v3
  v_cvt_pk_bf16_f32 v77, v74, v75
  v_cvt_pk_bf16_f32 v66, v40, v41
  v_smfmac_f32_16x16x64_bf16 v[48:51], v[24:27], a[200:207], v3
  v_cvt_pk_bf16_f32 v67, v42, v43
  v_smfmac_f32_16x16x64_bf16 v[48:51], v[28:31], a[208:215], v3
  v_mfma_f32_16x16x32_bf16 v[68:71], v[64:67], v[4:7], 0
  v_smfmac_f32_16x16x64_bf16 v[48:51], v[32:35], a[216:223], v3
  v_cvt_pk_bf16_f32 v64, v44, v45
  v_mfma_f32_16x16x32_bf16 v[84:87], v[80:83], v[76:79], 0
  v_cvt_pk_bf16_f32 v65, v46, v47
  s_waitcnt lgkmcnt(0)
  v_smfmac_f32_16x16x64_bf16 v[88:91], v[76:79], v[96:103], v118
  v_cvt_pk_bf16_f32 v60, v68, v69
  v_cvt_pk_bf16_f32 v61, v70, v71
  v_cvt_pk_bf16_f32 v66, v48, v49
  v_cvt_pk_bf16_f32 v67, v50, v51
  s_nop 1
  v_mfma_f32_16x16x32_bf16 v[72:75], v[64:67], v[4:7], 0
  v_smfmac_f32_16x16x64_bf16 v[92:95], v[76:79], v[104:111], v118
  s_nop 4
  v_cvt_pk_bf16_f32 v62, v72, v73
  v_cvt_pk_bf16_f32 v63, v74, v75
  s_nop 1
  v_mfma_f32_16x16x32_bf16 v[84:87], v[12:15], v[60:63], v[84:87]
  v_smfmac_f32_16x16x64_bf16 v[88:91], v[60:63], v[16:23], v118
  v_smfmac_f32_16x16x64_bf16 v[92:95], v[60:63], v[52:59], v118
  s_nop 1
  v_permlane32_swap_b32 v84, v86
  v_permlane32_swap_b32 v85, v87
  s_nop 0
  v_add_f32 v88, v88, v89
  v_add_f32_dpp v84, v86, v84 quad_perm:[1,0,3,2] row_mask:0xf bank_mask:0xf
  v_add_f32_dpp v85, v87, v85 quad_perm:[1,0,3,2] row_mask:0xf bank_mask:0xf
  v_add_f32 v89, v90, v91
  ds_write2_b32 v113, v84, v85 offset0:0 offset1:4
  ds_write2_b32 v112, v88, v89 offset0:0 offset1:128
  v_add_f32 v90, v92, v93
  v_add_f32 v91, v94, v95
  ds_write2_b32 v112, v90, v91 offset0:64 offset1:192
  v_cmp_u_f32 vcc, v88, v89
  s_cbranch_vccnz cB_sc1_retry
cB_sc1_cont:
  s_waitcnt lgkmcnt(0)
  s_barrier
  ds_read_b128 v[36:39], v114
  ds_read_b128 v[44:47], v115
  s_waitcnt lgkmcnt(0)
  v_add_f32 v36, v36, v38
  v_add_f32 v37, v37, v39
  v_add_f32 v44, v44, v45
  v_add_f32 v46, v46, v47
  v_add_f32 v44, v44, v46
  v_add_f32 v36, v36, v37
  v_exp_f32 v49, v44
  v_exp_f32 v48, v36
  v_add_f32 v50, abs(v36), abs(v44)
  v_fma_f32 v39, v49, s37, v48
  v_cmp_ngt_f32 vcc, s56, v50
  v_cndmask_b32 v41, v48, v49, s[38:39]
  v_add_f32_dpp v39, v39, v39 quad_perm:[1,0,3,2] row_mask:0xf bank_mask:0xf
  v_cndmask_b32 v40, v49, v48, s[38:39]
  v_mov_b32_dpp v46, v41 quad_perm:[1,0,3,2] row_mask:0xf bank_mask:0xf
  v_add_f32_dpp v39, v39, v39 quad_perm:[2,3,0,1] row_mask:0xf bank_mask:0xf
  v_cndmask_b32 v42, v46, v40, s[38:39]
  v_cndmask_b32 v43, v40, v46, s[38:39]
  v_add_f32_dpp v39, v39, v39 row_half_mirror row_mask:0xf bank_mask:0xf
  s_cbranch_vccnz cB_sc1_slow
  s_nop 0
  v_add_f32_dpp v47, v39, v39 row_mirror row_mask:0xf bank_mask:0xf
  v_add_f32_dpp v39, v39, v39 row_mirror row_mask:0xf bank_mask:0xf
  s_nop 1
  v_permlane16_swap_b32 v39, v47
  v_add_f32 v39, v39, v47
  v_rcp_f32 v39, v39
  s_mov_b64 exec, s[28:29]
  v_mul_f32 v42, v42, v39
  v_mul_f32 v43, v43, v39
  v_cvt_pk_bf16_f32 v42, v42, v43
cB_sc1_pst:
  buffer_store_dword v42, v1, s[8:11], s20 offen sc1
  s_mov_b64 exec, -1
  s_barrier
  s_add_u32 s24, s24, 28672
  s_add_u32 s35, s35, 28672
  s_xor_b32 s25, s25, 28672
  s_add_u32 m0, s25, 7168
  s_add_u32 m0, s25, 11264
  s_add_u32 s22, s24, 4096
  buffer_load_dwordx4 v2, s[8:11], s22 offen offset:0 sc1 lds
  s_nop 5
  buffer_load_dwordx4 v2, s[8:11], s22 offen offset:1024 sc1 lds
  s_nop 5
  buffer_load_dwordx4 v2, s[8:11], s22 offen offset:2048 sc1 lds
  s_nop 5
  v_xor_b32 v116, 28672, v116
  v_add_u32 v117, s57, v117
  s_sub_u32 s57, 0, s57
  s_add_u32 s19, s19, 1
  s_mov_b32 s20, s21
  s_cmp_lt_u32 s19, 63
  s_cbranch_scc1 cB_sc1_loop
  s_branch cB_done
cB_sc1_slow:
  v_max_f32 v50, v36, v44
  s_nop 1
  v_max_f32_dpp v50, v50, v50 quad_perm:[1,0,3,2] row_mask:0xf bank_mask:0xf
  s_nop 1
  v_max_f32_dpp v50, v50, v50 quad_perm:[2,3,0,1] row_mask:0xf bank_mask:0xf
  s_nop 1
  v_max_f32_dpp v50, v50, v50 row_half_mirror row_mask:0xf bank_mask:0xf
  s_nop 1
  v_max_f32_dpp v50, v50, v50 row_mirror row_mask:0xf bank_mask:0xf
  v_mov_b32 v47, v50
  s_nop 1
  v_permlane16_swap_b32 v50, v47
  v_max_f32 v50, v50, v47
  v_sub_f32 v48, v36, v50
  v_sub_f32 v49, v44, v50
  v_exp_f32 v48, v48
  v_exp_f32 v49, v49
  s_add_u32 s31, s31, 0x100
  v_fma_f32 v39, v49, s37, v48
  v_cndmask_b32 v41, v48, v49, s[38:39]
  s_nop 0
  v_add_f32_dpp v39, v39, v39 quad_perm:[1,0,3,2] row_mask:0xf bank_mask:0xf
  v_cndmask_b32 v40, v49, v48, s[38:39]
  v_mov_b32_dpp v46, v41 quad_perm:[1,0,3,2] row_mask:0xf bank_mask:0xf
  v_add_f32_dpp v39, v39, v39 quad_perm:[2,3,0,1] row_mask:0xf bank_mask:0xf
  v_cndmask_b32 v42, v46, v40, s[38:39]
  v_cndmask_b32 v43, v40, v46, s[38:39]
  v_add_f32_dpp v39, v39, v39 row_half_mirror row_mask:0xf bank_mask:0xf
  s_nop 1
  v_add_f32_dpp v47, v39, v39 row_mirror row_mask:0xf bank_mask:0xf
  v_add_f32_dpp v39, v39, v39 row_mirror row_mask:0xf bank_mask:0xf
  s_nop 1
  v_permlane16_swap_b32 v39, v47
  v_add_f32 v39, v39, v47
  v_rcp_f32 v39, v39
  s_mov_b64 exec, s[28:29]
  v_mul_f32 v42, v42, v39
  v_mul_f32 v43, v43, v39
  v_cvt_pk_bf16_f32 v42, v42, v43
  v_min_u32 v42, -2, v42
  s_branch cB_sc1_pst
cB_sc1_retry:
  s_cmp_lg_u32 s62, 0
  s_cbranch_scc1 cB_sc1_cont
  s_waitcnt vmcnt(0) lgkmcnt(0)
cB_sc1_rv:
  buffer_load_dwordx4 v[8:11], v2, s[8:11], s20 offen offset:0 sc1
  buffer_load_dwordx4 v[12:15], v2, s[8:11], s20 offen offset:1024 sc1
  buffer_load_dwordx4 v[16:19], v2, s[8:11], s20 offen offset:2048 sc1
  buffer_load_dwordx4 v[20:23], v2, s[8:11], s20 offen offset:3072 sc1
  buffer_load_dwordx4 v[24:27], v2, s[8:11], s23 offen offset:0 sc1
  buffer_load_dwordx4 v[28:31], v2, s[8:11], s23 offen offset:1024 sc1
  buffer_load_dwordx4 v[32:35], v2, s[8:11], s23 offen offset:2048 sc1
  s_waitcnt vmcnt(0)
  v_max3_u32 v68, v8, v9, v10
  v_max3_u32 v68, v68, v11, v12
  v_max3_u32 v68, v68, v13, v14
  v_max3_u32 v68, v68, v15, v16
  v_max3_u32 v68, v68, v17, v18
  v_max3_u32 v68, v68, v19, v20
  v_max3_u32 v68, v68, v21, v22
  v_max3_u32 v68, v68, v23, v24
  v_max3_u32 v68, v68, v25, v26
  v_max3_u32 v68, v68, v27, v28
  v_max3_u32 v68, v68, v29, v30
  v_max3_u32 v68, v68, v31, v32
  v_max3_u32 v68, v68, v33, v34
  v_max_u32 v68, v68, v35
  v_cmp_eq_u32 vcc, -1, v68
  s_cbranch_vccz cB_sc1_rk
  s_add_u32 s30, s30, 1
  s_cmp_lt_u32 s30, 400000
  s_cbranch_scc1 cB_sc1_rv
  s_branch cB_abort
cB_sc1_rk:
  s_mov_b32 s62, 1
  v_mov_b32 v36, 0
  v_mov_b32 v37, 0
  v_mov_b32 v38, 0
  v_mov_b32 v39, 0
  v_mov_b32 v40, 0
  v_mov_b32 v41, 0
  v_mov_b32 v42, 0
  v_mov_b32 v43, 0
  v_mov_b32 v44, 0
  v_mov_b32 v45, 0
  v_mov_b32 v46, 0
  v_mov_b32 v47, 0
  v_mov_b32 v48, 0
  v_mov_b32 v49, 0
  v_mov_b32 v50, 0
  v_mov_b32 v51, 0
  v_mov_b32 v52, 0
  v_mov_b32 v53, 0
  v_mov_b32 v54, 0
  v_mov_b32 v55, 0
  v_mov_b32 v56, 0
  v_mov_b32 v57, 0
  v_mov_b32 v58, 0
  v_mov_b32 v59, 0
  v_mov_b32 v60, 0
  v_mov_b32 v61, 0
  v_mov_b32 v62, 0
  v_mov_b32 v63, 0
  v_mov_b32 v88, 0
  v_mov_b32 v89, 0
  v_mov_b32 v90, 0
  v_mov_b32 v91, 0
  v_mov_b32 v92, 0
  v_mov_b32 v93, 0
  v_mov_b32 v94, 0
  v_mov_b32 v95, 0
  v_mov_b32 v64, 0
  v_mov_b32 v65, 0
  s_add_u32 s31, s31, 1
  ds_read_b128 v[96:99], v117 offset:0
  ds_read_b128 v[100:103], v117 offset:1024
  ds_read_b128 v[104:107], v117 offset:14336
  ds_read_b128 v[108:111], v117 offset:15360
  v_smfmac_f32_16x16x64_bf16 v[36:39], v[8:11], a[0:7], v3
  v_smfmac_f32_16x16x64_bf16 v[40:43], v[8:11], a[56:63], v3
  v_smfmac_f32_16x16x64_bf16 v[44:47], v[8:11], a[112:119], v3
  v_smfmac_f32_16x16x64_bf16 v[48:51], v[8:11], a[168:175], v3
  v_smfmac_f32_16x16x64_bf16 v[52:55], v[8:11], a[224:231], v3
  v_smfmac_f32_16x16x64_bf16 v[56:59], v[8:11], v[144:151], v3
  v_smfmac_f32_16x16x64_bf16 v[60:63], v[8:11], v[200:207], v3
  v_smfmac_f32_16x16x64_bf16 v[36:39], v[12:15], a[8:15], v3
  v_smfmac_f32_16x16x64_bf16 v[40:43], v[12:15], a[64:71], v3
  v_smfmac_f32_16x16x64_bf16 v[44:47], v[12:15], a[120:127], v3
  v_smfmac_f32_16x16x64_bf16 v[48:51], v[12:15], a[176:183], v3
  v_smfmac_f32_16x16x64_bf16 v[52:55], v[12:15], a[232:239], v3
  v_smfmac_f32_16x16x64_bf16 v[56:59], v[12:15], v[152:159], v3
  v_smfmac_f32_16x16x64_bf16 v[60:63], v[12:15], v[208:215], v3
  v_smfmac_f32_16x16x64_bf16 v[36:39], v[16:19], a[16:23], v3
  v_smfmac_f32_16x16x64_bf16 v[40:43], v[16:19], a[72:79], v3
  v_smfmac_f32_16x16x64_bf16 v[44:47], v[16:19], a[128:135], v3
  v_smfmac_f32_16x16x64_bf16 v[48:51], v[16:19], a[184:191], v3
  v_smfmac_f32_16x16x64_bf16 v[52:55], v[16:19], a[240:247], v3
  v_smfmac_f32_16x16x64_bf16 v[56:59], v[16:19], v[160:167], v3
  v_smfmac_f32_16x16x64_bf16 v[60:63], v[16:19], v[216:223], v3
  v_smfmac_f32_16x16x64_bf16 v[36:39], v[20:23], a[24:31], v3
  v_smfmac_f32_16x16x64_bf16 v[40:43], v[20:23], a[80:87], v3
  v_smfmac_f32_16x16x64_bf16 v[44:47], v[20:23], a[136:143], v3
  v_smfmac_f32_16x16x64_bf16 v[48:51], v[20:23], a[192:199], v3
  v_smfmac_f32_16x16x64_bf16 v[52:55], v[20:23], a[248:255], v3
  v_smfmac_f32_16x16x64_bf16 v[56:59], v[20:23], v[168:175], v3
  v_smfmac_f32_16x16x64_bf16 v[60:63], v[20:23], v[224:231], v3
  s_xor_b32 s58, s25, 28672
  s_add_u32 s59, s24, 28672
  s_add_u32 m0, s58, 7168
  s_branch cB_sc1_ph2
.p2align 6

cB_sc2_loop:
  s_add_u32 s23, s20, 4096
  s_add_u32 s21, s20, 20480
  v_mov_b32 v48, 0
  v_mov_b32 v49, 0
  v_mov_b32 v50, 0
  v_mov_b32 v51, 0
  v_mov_b32 v52, 0
  v_mov_b32 v53, 0
  v_mov_b32 v54, 0
  v_mov_b32 v55, 0
  v_mov_b32 v56, 0
  v_mov_b32 v57, 0
  v_mov_b32 v58, 0
  v_mov_b32 v59, 0
  v_mov_b32 v60, 0
  v_mov_b32 v61, 0
  v_mov_b32 v62, 0
  v_mov_b32 v63, 0
  v_mov_b32 v88, 0
  v_mov_b32 v89, 0
  v_mov_b32 v90, 0
  v_mov_b32 v91, 0
  v_mov_b32 v92, 0
  v_mov_b32 v93, 0
  v_mov_b32 v94, 0
  v_mov_b32 v95, 0
  v_mov_b32 v66, 0
  v_mov_b32 v67, 0
  s_mov_b32 s30, 0
  s_mov_b32 s62, 0
  s_waitcnt vmcnt(0)
  s_barrier
cB_sc2_ld:
  buffer_load_dwordx4 v[8:11], v2, s[8:11], s20 offen offset:0 sc1
  v_mov_b32 v36, 0
  v_mov_b32 v37, 0
  v_mov_b32 v38, 0
  v_mov_b32 v39, 0
  buffer_load_dwordx4 v[12:15], v2, s[8:11], s20 offen offset:1024 sc1
  v_mov_b32 v40, 0
  v_mov_b32 v41, 0
  v_mov_b32 v42, 0
  v_mov_b32 v43, 0
  buffer_load_dwordx4 v[16:19], v2, s[8:11], s20 offen offset:2048 sc1
  v_mov_b32 v44, 0
  v_mov_b32 v45, 0
  v_mov_b32 v46, 0
  v_mov_b32 v47, 0
  ds_read_b128 v[96:99], v117 offset:0
  ds_read_b128 v[100:103], v117 offset:1024
  ds_read_b128 v[104:107], v117 offset:14336
  ds_read_b128 v[108:111], v117 offset:15360
  s_waitcnt vmcnt(2)
  v_smfmac_f32_16x16x64_bf16 v[36:39], v[8:11], a[0:7], v3
  v_smfmac_f32_16x16x64_bf16 v[40:43], v[8:11], a[56:63], v3
  buffer_load_dwordx4 v[20:23], v2, s[8:11], s20 offen offset:3072 sc1
  v_smfmac_f32_16x16x64_bf16 v[44:47], v[8:11], a[112:119], v3
  v_smfmac_f32_16x16x64_bf16 v[48:51], v[8:11], a[168:175], v3
  v_smfmac_f32_16x16x64_bf16 v[52:55], v[8:11], a[224:231], v3
  buffer_load_dwordx4 v[24:27], v2, s[8:11], s23 offen offset:0 sc1
  v_smfmac_f32_16x16x64_bf16 v[56:59], v[8:11], v[144:151], v3
  v_smfmac_f32_16x16x64_bf16 v[60:63], v[8:11], v[200:207], v3
  s_waitcnt vmcnt(3)
  v_smfmac_f32_16x16x64_bf16 v[36:39], v[12:15], a[8:15], v3
  v_smfmac_f32_16x16x64_bf16 v[40:43], v[12:15], a[64:71], v3
  buffer_load_dwordx4 v[28:31], v2, s[8:11], s23 offen offset:1024 sc1
  v_smfmac_f32_16x16x64_bf16 v[44:47], v[12:15], a[120:127], v3
  v_smfmac_f32_16x16x64_bf16 v[48:51], v[12:15], a[176:183], v3
  v_smfmac_f32_16x16x64_bf16 v[52:55], v[12:15], a[232:239], v3
  buffer_load_dwordx4 v[32:35], v2, s[8:11], s23 offen offset:2048 sc1
  v_smfmac_f32_16x16x64_bf16 v[56:59], v[12:15], v[152:159], v3
  v_smfmac_f32_16x16x64_bf16 v[60:63], v[12:15], v[208:215], v3
  s_waitcnt vmcnt(4)
  v_smfmac_f32_16x16x64_bf16 v[36:39], v[16:19], a[16:23], v3
  v_smfmac_f32_16x16x64_bf16 v[40:43], v[16:19], a[72:79], v3
  s_xor_b32 s58, s25, 28672
  s_add_u32 s59, s24, 28672
  s_add_u32 m0, s58, 14336
  v_smfmac_f32_16x16x64_bf16 v[44:47], v[16:19], a[128:135], v3
  buffer_load_dwordx4 v2, s[8:11], s59 offen offset:0 sc1 lds
  v_smfmac_f32_16x16x64_bf16 v[48:51], v[16:19], a[184:191], v3
  v_smfmac_f32_16x16x64_bf16 v[52:55], v[16:19], a[240:247], v3
  v_smfmac_f32_16x16x64_bf16 v[56:59], v[16:19], v[160:167], v3
  v_smfmac_f32_16x16x64_bf16 v[60:63], v[16:19], v[216:223], v3
  buffer_load_dwordx4 v2, s[8:11], s59 offen offset:1024 sc1 lds
  s_waitcnt vmcnt(5)
  v_smfmac_f32_16x16x64_bf16 v[36:39], v[20:23], a[24:31], v3
  v_smfmac_f32_16x16x64_bf16 v[40:43], v[20:23], a[80:87], v3
  v_smfmac_f32_16x16x64_bf16 v[44:47], v[20:23], a[136:143], v3
  v_smfmac_f32_16x16x64_bf16 v[48:51], v[20:23], a[192:199], v3
  buffer_load_dwordx4 v2, s[8:11], s59 offen offset:2048 sc1 lds
  v_smfmac_f32_16x16x64_bf16 v[52:55], v[20:23], a[248:255], v3
  v_smfmac_f32_16x16x64_bf16 v[56:59], v[20:23], v[168:175], v3
  v_smfmac_f32_16x16x64_bf16 v[60:63], v[20:23], v[224:231], v3
  s_waitcnt vmcnt(3)
cB_sc2_ph2:
  v_smfmac_f32_16x16x64_bf16 v[60:63], v[24:27], v[232:239], v3
  buffer_load_dwordx4 v2, s[8:11], s59 offen offset:3072 sc1 lds
  ds_read_b128 v[8:11], v116 offset:4096
  ds_read_b128 v[12:15], v116 offset:5120
  v_smfmac_f32_16x16x64_bf16 v[60:63], v[28:31], v[240:247], v3
  buffer_load_dword v119, v0, s[8:11], s24 offen sc1
  v_smfmac_f32_16x16x64_bf16 v[60:63], v[32:35], v[248:255], v3
  v_mov_b32 v80, v28
  v_smfmac_f32_16x16x64_bf16 v[52:55], v[24:27], v[120:127], v3
  v_mov_b32 v81, v29
  v_smfmac_f32_16x16x64_bf16 v[52:55], v[28:31], v[128:135], v3
  v_mov_b32 v82, v34
  v_smfmac_f32_16x16x64_bf16 v[52:55], v[32:35], v[136:143], v3
  v_cvt_pk_bf16_f32 v64, v60, v61
  v_smfmac_f32_16x16x64_bf16 v[56:59], v[24:27], v[176:183], v3
  v_cvt_pk_bf16_f32 v65, v62, v63
  v_smfmac_f32_16x16x64_bf16 v[56:59], v[28:31], v[184:191], v3
  v_mov_b32 v83, v35
  v_mfma_f32_16x16x32_bf16 v[68:71], v[64:67], v[4:7], 0
  v_smfmac_f32_16x16x64_bf16 v[56:59], v[32:35], v[192:199], v3
  v_cvt_pk_bf16_f32 v64, v52, v53
  v_smfmac_f32_16x16x64_bf16 v[36:39], v[24:27], a[32:39], v3
  v_cvt_pk_bf16_f32 v65, v54, v55
  v_smfmac_f32_16x16x64_bf16 v[36:39], v[28:31], a[40:47], v3
  v_cvt_pk_bf16_f32 v78, v68, v69
  v_smfmac_f32_16x16x64_bf16 v[36:39], v[32:35], a[48:55], v3
  v_cvt_pk_bf16_f32 v79, v70, v71
  v_cvt_pk_bf16_f32 v66, v56, v57
  v_smfmac_f32_16x16x64_bf16 v[40:43], v[24:27], a[88:95], v3
  v_cvt_pk_bf16_f32 v67, v58, v59
  v_smfmac_f32_16x16x64_bf16 v[40:43], v[28:31], a[96:103], v3
  v_mfma_f32_16x16x32_bf16 v[72:75], v[64:67], v[4:7], 0
  ds_read_b128 v[52:55], v116 offset:18432
  ds_read_b128 v[56:59], v116 offset:19456
  v_smfmac_f32_16x16x64_bf16 v[40:43], v[32:35], a[104:111], v3
  v_cvt_pk_bf16_f32 v64, v36, v37
  v_smfmac_f32_16x16x64_bf16 v[44:47], v[24:27], a[144:151], v3
  v_cvt_pk_bf16_f32 v65, v38, v39
  v_smfmac_f32_16x16x64_bf16 v[44:47], v[28:31], a[152:159], v3
  v_cvt_pk_bf16_f32 v76, v72, v73
  v_smfmac_f32_16x16x64_bf16 v[44:47], v[32:35], a[160:167], v3
  v_cvt_pk_bf16_f32 v77, v74, v75
  v_cvt_pk_bf16_f32 v66, v40, v41
  v_smfmac_f32_16x16x64_bf16 v[48:51], v[24:27], a[200:207], v3
  v_cvt_pk_bf16_f32 v67, v42, v43
  v_smfmac_f32_16x16x64_bf16 v[48:51], v[28:31], a[208:215], v3
  v_mfma_f32_16x16x32_bf16 v[68:71], v[64:67], v[4:7], 0
  v_smfmac_f32_16x16x64_bf16 v[48:51], v[32:35], a[216:223], v3
  v_cvt_pk_bf16_f32 v64, v44, v45
  v_mfma_f32_16x16x32_bf16 v[84:87], v[80:83], v[76:79], 0
  v_cvt_pk_bf16_f32 v65, v46, v47
  s_waitcnt lgkmcnt(0)
  v_smfmac_f32_16x16x64_bf16 v[88:91], v[76:79], v[96:103], v118
  v_cvt_pk_bf16_f32 v60, v68, v69
  v_cvt_pk_bf16_f32 v61, v70, v71
  v_cvt_pk_bf16_f32 v66, v48, v49
  v_cvt_pk_bf16_f32 v67, v50, v51
  s_nop 1
  v_mfma_f32_16x16x32_bf16 v[72:75], v[64:67], v[4:7], 0
  v_smfmac_f32_16x16x64_bf16 v[92:95], v[76:79], v[104:111], v118
  s_nop 4
  v_cvt_pk_bf16_f32 v62, v72, v73
  v_cvt_pk_bf16_f32 v63, v74, v75
  s_nop 1
  v_mfma_f32_16x16x32_bf16 v[84:87], v[16:19], v[60:63], v[84:87]
  v_smfmac_f32_16x16x64_bf16 v[88:91], v[60:63], v[8:15], v118
  v_smfmac_f32_16x16x64_bf16 v[92:95], v[60:63], v[52:59], v118
  s_nop 1
  v_permlane32_swap_b32 v84, v86
  v_permlane32_swap_b32 v85, v87
  s_nop 0
  v_add_f32 v88, v88, v89
  v_add_f32_dpp v84, v86, v84 quad_perm:[1,0,3,2] row_mask:0xf bank_mask:0xf
  v_add_f32_dpp v85, v87, v85 quad_perm:[1,0,3,2] row_mask:0xf bank_mask:0xf
  v_add_f32 v89, v90, v91
  ds_write2_b32 v113, v84, v85 offset0:0 offset1:4
  ds_write2_b32 v112, v88, v89 offset0:0 offset1:128
  v_add_f32 v90, v92, v93
  v_add_f32 v91, v94, v95
  ds_write2_b32 v112, v90, v91 offset0:64 offset1:192
  v_cmp_u_f32 vcc, v88, v89
  s_cbranch_vccnz cB_sc2_retry
cB_sc2_cont:
  s_waitcnt lgkmcnt(0)
  s_barrier
  ds_read_b128 v[36:39], v114
  ds_read_b128 v[44:47], v115
  v_lshl_add_u32 v56, v2, 3, s36
  s_waitcnt lgkmcnt(0)
  v_add_f32 v36, v36, v38
  v_add_f32 v37, v37, v39
  v_add_f32 v44, v44, v45
  s_mov_b64 exec, 15
  buffer_store_dword v2, v56, s[8:11], s20 offen sc1
  s_mov_b64 exec, -1
  v_add_f32 v46, v46, v47
  v_add_f32 v44, v44, v46
  v_add_f32 v36, v36, v37
  v_exp_f32 v49, v44
  v_exp_f32 v48, v36
  v_add_f32 v50, abs(v36), abs(v44)
  v_fma_f32 v39, v49, s37, v48
  v_cmp_ngt_f32 vcc, s56, v50
  v_cndmask_b32 v41, v48, v49, s[38:39]
  v_add_f32_dpp v39, v39, v39 quad_perm:[1,0,3,2] row_mask:0xf bank_mask:0xf
  v_cndmask_b32 v40, v49, v48, s[38:39]
  v_mov_b32_dpp v46, v41 quad_perm:[1,0,3,2] row_mask:0xf bank_mask:0xf
  v_add_f32_dpp v39, v39, v39 quad_perm:[2,3,0,1] row_mask:0xf bank_mask:0xf
  v_cndmask_b32 v42, v46, v40, s[38:39]
  v_cndmask_b32 v43, v40, v46, s[38:39]
  v_add_f32_dpp v39, v39, v39 row_half_mirror row_mask:0xf bank_mask:0xf
  s_cbranch_vccnz cB_sc2_slow
  s_nop 0
  v_add_f32_dpp v47, v39, v39 row_mirror row_mask:0xf bank_mask:0xf
  v_add_f32_dpp v39, v39, v39 row_mirror row_mask:0xf bank_mask:0xf
  s_nop 1
  v_permlane16_swap_b32 v39, v47
  v_add_f32 v39, v39, v47
  v_rcp_f32 v39, v39
  s_mov_b64 exec, s[28:29]
  v_mul_f32 v42, v42, v39
  v_mul_f32 v43, v43, v39
  v_cvt_pk_bf16_f32 v42, v42, v43
cB_sc2_pst:
  buffer_store_dword v42, v1, s[8:11], s20 offen sc1
  s_mov_b64 exec, -1
  s_barrier
  s_cmp_lg_u32 s19, 0
  s_cbranch_scc1 cB_sc2_s0
  s_sub_u32 s36, s36, 64
  v_lshl_add_u32 v56, v2, 3, s36
  s_mov_b64 exec, 15
  buffer_store_dword v2, v56, s[8:11], s20 offen sc1
  s_mov_b64 exec, -1
cB_sc2_s0:
  s_add_u32 s24, s24, 28672
  s_add_u32 s35, s35, 28672
  s_xor_b32 s25, s25, 28672
  s_add_u32 m0, s25, 14336
  s_add_u32 m0, s25, 18432
  s_add_u32 s22, s24, 4096
  buffer_load_dwordx4 v2, s[8:11], s22 offen offset:0 sc1 lds
  s_nop 5
  buffer_load_dwordx4 v2, s[8:11], s22 offen offset:1024 sc1 lds
  s_nop 5
  buffer_load_dwordx4 v2, s[8:11], s22 offen offset:2048 sc1 lds
  s_nop 5
  v_xor_b32 v116, 28672, v116
  v_add_u32 v117, s57, v117
  s_sub_u32 s57, 0, s57
  s_add_u32 s19, s19, 1
  s_mov_b32 s20, s21
  s_cmp_lt_u32 s19, 63
  s_cbranch_scc1 cB_sc2_loop
  s_branch cB_done
cB_sc2_slow:
  v_max_f32 v50, v36, v44
  s_nop 1
  v_max_f32_dpp v50, v50, v50 quad_perm:[1,0,3,2] row_mask:0xf bank_mask:0xf
  s_nop 1
  v_max_f32_dpp v50, v50, v50 quad_perm:[2,3,0,1] row_mask:0xf bank_mask:0xf
  s_nop 1
  v_max_f32_dpp v50, v50, v50 row_half_mirror row_mask:0xf bank_mask:0xf
  s_nop 1
  v_max_f32_dpp v50, v50, v50 row_mirror row_mask:0xf bank_mask:0xf
  v_mov_b32 v47, v50
  s_nop 1
  v_permlane16_swap_b32 v50, v47
  v_max_f32 v50, v50, v47
  v_sub_f32 v48, v36, v50
  v_sub_f32 v49, v44, v50
  v_exp_f32 v48, v48
  v_exp_f32 v49, v49
  s_add_u32 s31, s31, 0x100
  v_fma_f32 v39, v49, s37, v48
  v_cndmask_b32 v41, v48, v49, s[38:39]
  s_nop 0
  v_add_f32_dpp v39, v39, v39 quad_perm:[1,0,3,2] row_mask:0xf bank_mask:0xf
  v_cndmask_b32 v40, v49, v48, s[38:39]
  v_mov_b32_dpp v46, v41 quad_perm:[1,0,3,2] row_mask:0xf bank_mask:0xf
  v_add_f32_dpp v39, v39, v39 quad_perm:[2,3,0,1] row_mask:0xf bank_mask:0xf
  v_cndmask_b32 v42, v46, v40, s[38:39]
  v_cndmask_b32 v43, v40, v46, s[38:39]
  v_add_f32_dpp v39, v39, v39 row_half_mirror row_mask:0xf bank_mask:0xf
  s_nop 1
  v_add_f32_dpp v47, v39, v39 row_mirror row_mask:0xf bank_mask:0xf
  v_add_f32_dpp v39, v39, v39 row_mirror row_mask:0xf bank_mask:0xf
  s_nop 1
  v_permlane16_swap_b32 v39, v47
  v_add_f32 v39, v39, v47
  v_rcp_f32 v39, v39
  s_mov_b64 exec, s[28:29]
  v_mul_f32 v42, v42, v39
  v_mul_f32 v43, v43, v39
  v_cvt_pk_bf16_f32 v42, v42, v43
  v_min_u32 v42, -2, v42
  s_branch cB_sc2_pst
cB_sc2_retry:
  s_cmp_lg_u32 s62, 0
  s_cbranch_scc1 cB_sc2_cont
  s_waitcnt vmcnt(0) lgkmcnt(0)
cB_sc2_rv:
  buffer_load_dwordx4 v[8:11], v2, s[8:11], s20 offen offset:0 sc1
  buffer_load_dwordx4 v[12:15], v2, s[8:11], s20 offen offset:1024 sc1
  buffer_load_dwordx4 v[16:19], v2, s[8:11], s20 offen offset:2048 sc1
  buffer_load_dwordx4 v[20:23], v2, s[8:11], s20 offen offset:3072 sc1
  buffer_load_dwordx4 v[24:27], v2, s[8:11], s23 offen offset:0 sc1
  buffer_load_dwordx4 v[28:31], v2, s[8:11], s23 offen offset:1024 sc1
  buffer_load_dwordx4 v[32:35], v2, s[8:11], s23 offen offset:2048 sc1
  s_waitcnt vmcnt(0)
  v_max3_u32 v68, v8, v9, v10
  v_max3_u32 v68, v68, v11, v12
  v_max3_u32 v68, v68, v13, v14
  v_max3_u32 v68, v68, v15, v16
  v_max3_u32 v68, v68, v17, v18
  v_max3_u32 v68, v68, v19, v20
  v_max3_u32 v68, v68, v21, v22
  v_max3_u32 v68, v68, v23, v24
  v_max3_u32 v68, v68, v25, v26
  v_max3_u32 v68, v68, v27, v28
  v_max3_u32 v68, v68, v29, v30
  v_max3_u32 v68, v68, v31, v32
  v_max3_u32 v68, v68, v33, v34
  v_max_u32 v68, v68, v35
  v_cmp_eq_u32 vcc, -1, v68
  s_cbranch_vccz cB_sc2_rk
  s_add_u32 s30, s30, 1
  s_cmp_lt_u32 s30, 400000
  s_cbranch_scc1 cB_sc2_rv
  s_branch cB_abort
cB_sc2_rk:
  s_mov_b32 s62, 1
  v_mov_b32 v36, 0
  v_mov_b32 v37, 0
  v_mov_b32 v38, 0
  v_mov_b32 v39, 0
  v_mov_b32 v40, 0
  v_mov_b32 v41, 0
  v_mov_b32 v42, 0
  v_mov_b32 v43, 0
  v_mov_b32 v44, 0
  v_mov_b32 v45, 0
  v_mov_b32 v46, 0
  v_mov_b32 v47, 0
  v_mov_b32 v48, 0
  v_mov_b32 v49, 0
  v_mov_b32 v50, 0
  v_mov_b32 v51, 0
  v_mov_b32 v52, 0
  v_mov_b32 v53, 0
  v_mov_b32 v54, 0
  v_mov_b32 v55, 0
  v_mov_b32 v56, 0
  v_mov_b32 v57, 0
  v_mov_b32 v58, 0
  v_mov_b32 v59, 0
  v_mov_b32 v60, 0
  v_mov_b32 v61, 0
  v_mov_b32 v62, 0
  v_mov_b32 v63, 0
  v_mov_b32 v88, 0
  v_mov_b32 v89, 0
  v_mov_b32 v90, 0
  v_mov_b32 v91, 0
  v_mov_b32 v92, 0
  v_mov_b32 v93, 0
  v_mov_b32 v94, 0
  v_mov_b32 v95, 0
  v_mov_b32 v66, 0
  v_mov_b32 v67, 0
  s_add_u32 s31, s31, 1
  ds_read_b128 v[96:99], v117 offset:0
  ds_read_b128 v[100:103], v117 offset:1024
  ds_read_b128 v[104:107], v117 offset:14336
  ds_read_b128 v[108:111], v117 offset:15360
  v_smfmac_f32_16x16x64_bf16 v[36:39], v[8:11], a[0:7], v3
  v_smfmac_f32_16x16x64_bf16 v[40:43], v[8:11], a[56:63], v3
  v_smfmac_f32_16x16x64_bf16 v[44:47], v[8:11], a[112:119], v3
  v_smfmac_f32_16x16x64_bf16 v[48:51], v[8:11], a[168:175], v3
  v_smfmac_f32_16x16x64_bf16 v[52:55], v[8:11], a[224:231], v3
  v_smfmac_f32_16x16x64_bf16 v[56:59], v[8:11], v[144:151], v3
  v_smfmac_f32_16x16x64_bf16 v[60:63], v[8:11], v[200:207], v3
  v_smfmac_f32_16x16x64_bf16 v[36:39], v[12:15], a[8:15], v3
  v_smfmac_f32_16x16x64_bf16 v[40:43], v[12:15], a[64:71], v3
  v_smfmac_f32_16x16x64_bf16 v[44:47], v[12:15], a[120:127], v3
  v_smfmac_f32_16x16x64_bf16 v[48:51], v[12:15], a[176:183], v3
  v_smfmac_f32_16x16x64_bf16 v[52:55], v[12:15], a[232:239], v3
  v_smfmac_f32_16x16x64_bf16 v[56:59], v[12:15], v[152:159], v3
  v_smfmac_f32_16x16x64_bf16 v[60:63], v[12:15], v[208:215], v3
  v_smfmac_f32_16x16x64_bf16 v[36:39], v[16:19], a[16:23], v3
  v_smfmac_f32_16x16x64_bf16 v[40:43], v[16:19], a[72:79], v3
  v_smfmac_f32_16x16x64_bf16 v[44:47], v[16:19], a[128:135], v3
  v_smfmac_f32_16x16x64_bf16 v[48:51], v[16:19], a[184:191], v3
  v_smfmac_f32_16x16x64_bf16 v[52:55], v[16:19], a[240:247], v3
  v_smfmac_f32_16x16x64_bf16 v[56:59], v[16:19], v[160:167], v3
  v_smfmac_f32_16x16x64_bf16 v[60:63], v[16:19], v[216:223], v3
  v_smfmac_f32_16x16x64_bf16 v[36:39], v[20:23], a[24:31], v3
  v_smfmac_f32_16x16x64_bf16 v[40:43], v[20:23], a[80:87], v3
  v_smfmac_f32_16x16x64_bf16 v[44:47], v[20:23], a[136:143], v3
  v_smfmac_f32_16x16x64_bf16 v[48:51], v[20:23], a[192:199], v3
  v_smfmac_f32_16x16x64_bf16 v[52:55], v[20:23], a[248:255], v3
  v_smfmac_f32_16x16x64_bf16 v[56:59], v[20:23], v[168:175], v3
  v_smfmac_f32_16x16x64_bf16 v[60:63], v[20:23], v[224:231], v3
  s_xor_b32 s58, s25, 28672
  s_add_u32 s59, s24, 28672
  s_add_u32 m0, s58, 14336
  s_branch cB_sc2_ph2
.p2align 6

cB_sc3_loop:
  s_add_u32 s23, s20, 4096
  s_add_u32 s21, s20, 20480
  v_mov_b32 v48, 0
  v_mov_b32 v49, 0
  v_mov_b32 v50, 0
  v_mov_b32 v51, 0
  v_mov_b32 v52, 0
  v_mov_b32 v53, 0
  v_mov_b32 v54, 0
  v_mov_b32 v55, 0
  v_mov_b32 v56, 0
  v_mov_b32 v57, 0
  v_mov_b32 v58, 0
  v_mov_b32 v59, 0
  v_mov_b32 v60, 0
  v_mov_b32 v61, 0
  v_mov_b32 v62, 0
  v_mov_b32 v63, 0
  v_mov_b32 v88, 0
  v_mov_b32 v89, 0
  v_mov_b32 v90, 0
  v_mov_b32 v91, 0
  v_mov_b32 v92, 0
  v_mov_b32 v93, 0
  v_mov_b32 v94, 0
  v_mov_b32 v95, 0
  v_mov_b32 v64, 0
  v_mov_b32 v65, 0
  s_mov_b32 s30, 0
  s_mov_b32 s62, 0
  s_waitcnt vmcnt(0)
  s_barrier
cB_sc3_ld:
  buffer_load_dwordx4 v[8:11], v2, s[8:11], s20 offen offset:0 sc1
  v_mov_b32 v36, 0
  v_mov_b32 v37, 0
  v_mov_b32 v38, 0
  v_mov_b32 v39, 0
  buffer_load_dwordx4 v[12:15], v2, s[8:11], s20 offen offset:1024 sc1
  v_mov_b32 v40, 0
  v_mov_b32 v41, 0
  v_mov_b32 v42, 0
  v_mov_b32 v43, 0
  buffer_load_dwordx4 v[16:19], v2, s[8:11], s20 offen offset:2048 sc1
  v_mov_b32 v44, 0
  v_mov_b32 v45, 0
  v_mov_b32 v46, 0
  v_mov_b32 v47, 0
  ds_read_b128 v[96:99], v117 offset:0
  ds_read_b128 v[100:103], v117 offset:1024
  ds_read_b128 v[104:107], v117 offset:14336
  ds_read_b128 v[108:111], v117 offset:15360
  s_waitcnt vmcnt(2)
  v_smfmac_f32_16x16x64_bf16 v[36:39], v[8:11], a[0:7], v3
  v_smfmac_f32_16x16x64_bf16 v[40:43], v[8:11], a[56:63], v3
  buffer_load_dwordx4 v[20:23], v2, s[8:11], s20 offen offset:3072 sc1
  v_smfmac_f32_16x16x64_bf16 v[44:47], v[8:11], a[112:119], v3
  v_smfmac_f32_16x16x64_bf16 v[48:51], v[8:11], a[168:175], v3
  v_smfmac_f32_16x16x64_bf16 v[52:55], v[8:11], a[224:231], v3
  buffer_load_dwordx4 v[24:27], v2, s[8:11], s23 offen offset:0 sc1
  v_smfmac_f32_16x16x64_bf16 v[56:59], v[8:11], v[144:151], v3
  v_smfmac_f32_16x16x64_bf16 v[60:63], v[8:11], v[200:207], v3
  s_waitcnt vmcnt(3)
  v_smfmac_f32_16x16x64_bf16 v[36:39], v[12:15], a[8:15], v3
  v_smfmac_f32_16x16x64_bf16 v[40:43], v[12:15], a[64:71], v3
  buffer_load_dwordx4 v[28:31], v2, s[8:11], s23 offen offset:1024 sc1
  v_smfmac_f32_16x16x64_bf16 v[44:47], v[12:15], a[120:127], v3
  v_smfmac_f32_16x16x64_bf16 v[48:51], v[12:15], a[176:183], v3
  v_smfmac_f32_16x16x64_bf16 v[52:55], v[12:15], a[232:239], v3
  buffer_load_dwordx4 v[32:35], v2, s[8:11], s23 offen offset:2048 sc1
  v_smfmac_f32_16x16x64_bf16 v[56:59], v[12:15], v[152:159], v3
  v_smfmac_f32_16x16x64_bf16 v[60:63], v[12:15], v[208:215], v3
  s_waitcnt vmcnt(4)
  v_smfmac_f32_16x16x64_bf16 v[36:39], v[16:19], a[16:23], v3
  v_smfmac_f32_16x16x64_bf16 v[40:43], v[16:19], a[72:79], v3
  v_smfmac_f32_16x16x64_bf16 v[44:47], v[16:19], a[128:135], v3
  s_xor_b32 s58, s25, 28672
  s_add_u32 s59, s24, 28672
  s_add_u32 m0, s58, 21504
  v_smfmac_f32_16x16x64_bf16 v[48:51], v[16:19], a[184:191], v3
  buffer_load_dwordx4 v2, s[8:11], s59 offen offset:0 sc1 lds
  v_smfmac_f32_16x16x64_bf16 v[52:55], v[16:19], a[240:247], v3
  v_smfmac_f32_16x16x64_bf16 v[56:59], v[16:19], v[160:167], v3
  v_smfmac_f32_16x16x64_bf16 v[60:63], v[16:19], v[216:223], v3
  s_waitcnt vmcnt(4)
  v_smfmac_f32_16x16x64_bf16 v[36:39], v[20:23], a[24:31], v3
  buffer_load_dwordx4 v2, s[8:11], s59 offen offset:1024 sc1 lds
  v_smfmac_f32_16x16x64_bf16 v[40:43], v[20:23], a[80:87], v3
  v_smfmac_f32_16x16x64_bf16 v[44:47], v[20:23], a[136:143], v3
  v_smfmac_f32_16x16x64_bf16 v[48:51], v[20:23], a[192:199], v3
  v_smfmac_f32_16x16x64_bf16 v[52:55], v[20:23], a[248:255], v3
  buffer_load_dwordx4 v2, s[8:11], s59 offen offset:2048 sc1 lds
  v_smfmac_f32_16x16x64_bf16 v[56:59], v[20:23], v[168:175], v3
  v_smfmac_f32_16x16x64_bf16 v[60:63], v[20:23], v[224:231], v3
  s_waitcnt vmcnt(3)
cB_sc3_ph2:
  v_smfmac_f32_16x16x64_bf16 v[60:63], v[24:27], v[232:239], v3
  ds_read_b128 v[8:11], v116 offset:6144
  ds_read_b128 v[12:15], v116 offset:7168
  v_smfmac_f32_16x16x64_bf16 v[60:63], v[28:31], v[240:247], v3
  buffer_load_dwordx4 v2, s[8:11], s59 offen offset:3072 sc1 lds
  v_smfmac_f32_16x16x64_bf16 v[60:63], v[32:35], v[248:255], v3
  v_mov_b32 v80, v30
  v_smfmac_f32_16x16x64_bf16 v[52:55], v[24:27], v[120:127], v3
  v_mov_b32 v81, v31
  v_smfmac_f32_16x16x64_bf16 v[52:55], v[28:31], v[128:135], v3
  v_mov_b32 v82, v34
  v_smfmac_f32_16x16x64_bf16 v[52:55], v[32:35], v[136:143], v3
  v_cvt_pk_bf16_f32 v66, v60, v61
  v_smfmac_f32_16x16x64_bf16 v[56:59], v[24:27], v[176:183], v3
  v_cvt_pk_bf16_f32 v67, v62, v63
  v_smfmac_f32_16x16x64_bf16 v[56:59], v[28:31], v[184:191], v3
  v_mov_b32 v83, v35
  v_mfma_f32_16x16x32_bf16 v[68:71], v[64:67], v[4:7], 0
  v_smfmac_f32_16x16x64_bf16 v[56:59], v[32:35], v[192:199], v3
  v_cvt_pk_bf16_f32 v64, v52, v53
  v_smfmac_f32_16x16x64_bf16 v[36:39], v[24:27], a[32:39], v3
  v_cvt_pk_bf16_f32 v65, v54, v55
  v_smfmac_f32_16x16x64_bf16 v[36:39], v[28:31], a[40:47], v3
  v_cvt_pk_bf16_f32 v78, v68, v69
  v_smfmac_f32_16x16x64_bf16 v[36:39], v[32:35], a[48:55], v3
  v_cvt_pk_bf16_f32 v79, v70, v71
  v_cvt_pk_bf16_f32 v66, v56, v57
  v_smfmac_f32_16x16x64_bf16 v[40:43], v[24:27], a[88:95], v3
  v_cvt_pk_bf16_f32 v67, v58, v59
  v_smfmac_f32_16x16x64_bf16 v[40:43], v[28:31], a[96:103], v3
  v_mfma_f32_16x16x32_bf16 v[72:75], v[64:67], v[4:7], 0
  ds_read_b128 v[52:55], v116 offset:20480
  ds_read_b128 v[56:59], v116 offset:21504
  v_smfmac_f32_16x16x64_bf16 v[40:43], v[32:35], a[104:111], v3
  v_cvt_pk_bf16_f32 v64, v36, v37
  v_smfmac_f32_16x16x64_bf16 v[44:47], v[24:27], a[144:151], v3
  v_cvt_pk_bf16_f32 v65, v38, v39
  v_smfmac_f32_16x16x64_bf16 v[44:47], v[28:31], a[152:159], v3
  v_cvt_pk_bf16_f32 v76, v72, v73
  v_smfmac_f32_16x16x64_bf16 v[44:47], v[32:35], a[160:167], v3
  v_cvt_pk_bf16_f32 v77, v74, v75
  v_cvt_pk_bf16_f32 v66, v40, v41
  v_smfmac_f32_16x16x64_bf16 v[48:51], v[24:27], a[200:207], v3
  v_cvt_pk_bf16_f32 v67, v42, v43
  v_smfmac_f32_16x16x64_bf16 v[48:51], v[28:31], a[208:215], v3
  v_mfma_f32_16x16x32_bf16 v[68:71], v[64:67], v[4:7], 0
  v_smfmac_f32_16x16x64_bf16 v[48:51], v[32:35], a[216:223], v3
  v_cvt_pk_bf16_f32 v64, v44, v45
  v_mfma_f32_16x16x32_bf16 v[84:87], v[80:83], v[76:79], 0
  v_cvt_pk_bf16_f32 v65, v46, v47
  s_waitcnt lgkmcnt(0)
  v_smfmac_f32_16x16x64_bf16 v[88:91], v[76:79], v[96:103], v118
  v_cvt_pk_bf16_f32 v60, v68, v69
  v_cvt_pk_bf16_f32 v61, v70, v71
  v_cvt_pk_bf16_f32 v66, v48, v49
  v_cvt_pk_bf16_f32 v67, v50, v51
  s_nop 1
  v_mfma_f32_16x16x32_bf16 v[72:75], v[64:67], v[4:7], 0
  v_smfmac_f32_16x16x64_bf16 v[92:95], v[76:79], v[104:111], v118
  s_nop 4
  v_cvt_pk_bf16_f32 v62, v72, v73
  v_cvt_pk_bf16_f32 v63, v74, v75
  s_nop 1
  v_mfma_f32_16x16x32_bf16 v[84:87], v[20:23], v[60:63], v[84:87]
  v_smfmac_f32_16x16x64_bf16 v[88:91], v[60:63], v[8:15], v118
  v_smfmac_f32_16x16x64_bf16 v[92:95], v[60:63], v[52:59], v118
  s_nop 1
  v_permlane32_swap_b32 v84, v86
  v_permlane32_swap_b32 v85, v87
  s_nop 0
  v_add_f32 v88, v88, v89
  v_add_f32_dpp v84, v86, v84 quad_perm:[1,0,3,2] row_mask:0xf bank_mask:0xf
  v_add_f32_dpp v85, v87, v85 quad_perm:[1,0,3,2] row_mask:0xf bank_mask:0xf
  v_add_f32 v89, v90, v91
  ds_write2_b32 v113, v84, v85 offset0:0 offset1:4
  ds_write2_b32 v112, v88, v89 offset0:0 offset1:128
  v_add_f32 v90, v92, v93
  v_add_f32 v91, v94, v95
  ds_write2_b32 v112, v90, v91 offset0:64 offset1:192
  v_cmp_u_f32 vcc, v88, v89
  s_cbranch_vccnz cB_sc3_retry
cB_sc3_cont:
  s_waitcnt lgkmcnt(0)
  s_barrier
  ds_read_b128 v[36:39], v114
  ds_read_b128 v[44:47], v115
  s_waitcnt lgkmcnt(0)
  v_add_f32 v36, v36, v38
  v_add_f32 v37, v37, v39
  v_add_f32 v44, v44, v45
  v_add_f32 v46, v46, v47
  v_add_f32 v44, v44, v46
  v_add_f32 v36, v36, v37
  v_exp_f32 v49, v44
  v_exp_f32 v48, v36
  v_add_f32 v50, abs(v36), abs(v44)
  v_fma_f32 v39, v49, s37, v48
  v_cmp_ngt_f32 vcc, s56, v50
  v_cndmask_b32 v41, v48, v49, s[38:39]
  v_add_f32_dpp v39, v39, v39 quad_perm:[1,0,3,2] row_mask:0xf bank_mask:0xf
  v_cndmask_b32 v40, v49, v48, s[38:39]
  v_mov_b32_dpp v46, v41 quad_perm:[1,0,3,2] row_mask:0xf bank_mask:0xf
  v_add_f32_dpp v39, v39, v39 quad_perm:[2,3,0,1] row_mask:0xf bank_mask:0xf
  v_cndmask_b32 v42, v46, v40, s[38:39]
  v_cndmask_b32 v43, v40, v46, s[38:39]
  v_add_f32_dpp v39, v39, v39 row_half_mirror row_mask:0xf bank_mask:0xf
  s_cbranch_vccnz cB_sc3_slow
  s_nop 0
  v_add_f32_dpp v47, v39, v39 row_mirror row_mask:0xf bank_mask:0xf
  v_add_f32_dpp v39, v39, v39 row_mirror row_mask:0xf bank_mask:0xf
  s_nop 1
  v_permlane16_swap_b32 v39, v47
  v_add_f32 v39, v39, v47
  v_rcp_f32 v39, v39
  s_mov_b64 exec, s[28:29]
  v_mul_f32 v42, v42, v39
  v_mul_f32 v43, v43, v39
  v_cvt_pk_bf16_f32 v42, v42, v43
cB_sc3_pst:
  buffer_store_dword v42, v1, s[8:11], s20 offen sc1
  s_mov_b64 exec, -1
  s_barrier
  s_add_u32 s24, s24, 28672
  s_add_u32 s35, s35, 28672
  s_xor_b32 s25, s25, 28672
  s_add_u32 m0, s25, 21504
  s_add_u32 m0, s25, 25600
  s_add_u32 s22, s24, 4096
  buffer_load_dwordx4 v2, s[8:11], s22 offen offset:0 sc1 lds
  s_nop 5
  buffer_load_dwordx4 v2, s[8:11], s22 offen offset:1024 sc1 lds
  s_nop 5
  buffer_load_dwordx4 v2, s[8:11], s22 offen offset:2048 sc1 lds
  s_nop 5
  v_xor_b32 v116, 28672, v116
  v_add_u32 v117, s57, v117
  s_sub_u32 s57, 0, s57
  s_add_u32 s19, s19, 1
  s_mov_b32 s20, s21
  s_cmp_lt_u32 s19, 63
  s_cbranch_scc1 cB_sc3_loop
  s_branch cB_done
cB_sc3_slow:
  v_max_f32 v50, v36, v44
  s_nop 1
  v_max_f32_dpp v50, v50, v50 quad_perm:[1,0,3,2] row_mask:0xf bank_mask:0xf
  s_nop 1
  v_max_f32_dpp v50, v50, v50 quad_perm:[2,3,0,1] row_mask:0xf bank_mask:0xf
  s_nop 1
  v_max_f32_dpp v50, v50, v50 row_half_mirror row_mask:0xf bank_mask:0xf
  s_nop 1
  v_max_f32_dpp v50, v50, v50 row_mirror row_mask:0xf bank_mask:0xf
  v_mov_b32 v47, v50
  s_nop 1
  v_permlane16_swap_b32 v50, v47
  v_max_f32 v50, v50, v47
  v_sub_f32 v48, v36, v50
  v_sub_f32 v49, v44, v50
  v_exp_f32 v48, v48
  v_exp_f32 v49, v49
  s_add_u32 s31, s31, 0x100
  v_fma_f32 v39, v49, s37, v48
  v_cndmask_b32 v41, v48, v49, s[38:39]
  s_nop 0
  v_add_f32_dpp v39, v39, v39 quad_perm:[1,0,3,2] row_mask:0xf bank_mask:0xf
  v_cndmask_b32 v40, v49, v48, s[38:39]
  v_mov_b32_dpp v46, v41 quad_perm:[1,0,3,2] row_mask:0xf bank_mask:0xf
  v_add_f32_dpp v39, v39, v39 quad_perm:[2,3,0,1] row_mask:0xf bank_mask:0xf
  v_cndmask_b32 v42, v46, v40, s[38:39]
  v_cndmask_b32 v43, v40, v46, s[38:39]
  v_add_f32_dpp v39, v39, v39 row_half_mirror row_mask:0xf bank_mask:0xf
  s_nop 1
  v_add_f32_dpp v47, v39, v39 row_mirror row_mask:0xf bank_mask:0xf
  v_add_f32_dpp v39, v39, v39 row_mirror row_mask:0xf bank_mask:0xf
  s_nop 1
  v_permlane16_swap_b32 v39, v47
  v_add_f32 v39, v39, v47
  v_rcp_f32 v39, v39
  s_mov_b64 exec, s[28:29]
  v_mul_f32 v42, v42, v39
  v_mul_f32 v43, v43, v39
  v_cvt_pk_bf16_f32 v42, v42, v43
  v_min_u32 v42, -2, v42
  s_branch cB_sc3_pst
cB_sc3_retry:
  s_cmp_lg_u32 s62, 0
  s_cbranch_scc1 cB_sc3_cont
  s_waitcnt vmcnt(0) lgkmcnt(0)
cB_sc3_rv:
  buffer_load_dwordx4 v[8:11], v2, s[8:11], s20 offen offset:0 sc1
  buffer_load_dwordx4 v[12:15], v2, s[8:11], s20 offen offset:1024 sc1
  buffer_load_dwordx4 v[16:19], v2, s[8:11], s20 offen offset:2048 sc1
  buffer_load_dwordx4 v[20:23], v2, s[8:11], s20 offen offset:3072 sc1
  buffer_load_dwordx4 v[24:27], v2, s[8:11], s23 offen offset:0 sc1
  buffer_load_dwordx4 v[28:31], v2, s[8:11], s23 offen offset:1024 sc1
  buffer_load_dwordx4 v[32:35], v2, s[8:11], s23 offen offset:2048 sc1
  s_waitcnt vmcnt(0)
  v_max3_u32 v68, v8, v9, v10
  v_max3_u32 v68, v68, v11, v12
  v_max3_u32 v68, v68, v13, v14
  v_max3_u32 v68, v68, v15, v16
  v_max3_u32 v68, v68, v17, v18
  v_max3_u32 v68, v68, v19, v20
  v_max3_u32 v68, v68, v21, v22
  v_max3_u32 v68, v68, v23, v24
  v_max3_u32 v68, v68, v25, v26
  v_max3_u32 v68, v68, v27, v28
  v_max3_u32 v68, v68, v29, v30
  v_max3_u32 v68, v68, v31, v32
  v_max3_u32 v68, v68, v33, v34
  v_max_u32 v68, v68, v35
  v_cmp_eq_u32 vcc, -1, v68
  s_cbranch_vccz cB_sc3_rk
  s_add_u32 s30, s30, 1
  s_cmp_lt_u32 s30, 400000
  s_cbranch_scc1 cB_sc3_rv
  s_branch cB_abort
cB_sc3_rk:
  s_mov_b32 s62, 1
  v_mov_b32 v36, 0
  v_mov_b32 v37, 0
  v_mov_b32 v38, 0
  v_mov_b32 v39, 0
  v_mov_b32 v40, 0
  v_mov_b32 v41, 0
  v_mov_b32 v42, 0
  v_mov_b32 v43, 0
  v_mov_b32 v44, 0
  v_mov_b32 v45, 0
  v_mov_b32 v46, 0
  v_mov_b32 v47, 0
  v_mov_b32 v48, 0
  v_mov_b32 v49, 0
  v_mov_b32 v50, 0
  v_mov_b32 v51, 0
  v_mov_b32 v52, 0
  v_mov_b32 v53, 0
  v_mov_b32 v54, 0
  v_mov_b32 v55, 0
  v_mov_b32 v56, 0
  v_mov_b32 v57, 0
  v_mov_b32 v58, 0
  v_mov_b32 v59, 0
  v_mov_b32 v60, 0
  v_mov_b32 v61, 0
  v_mov_b32 v62, 0
  v_mov_b32 v63, 0
  v_mov_b32 v88, 0
  v_mov_b32 v89, 0
  v_mov_b32 v90, 0
  v_mov_b32 v91, 0
  v_mov_b32 v92, 0
  v_mov_b32 v93, 0
  v_mov_b32 v94, 0
  v_mov_b32 v95, 0
  v_mov_b32 v64, 0
  v_mov_b32 v65, 0
  s_add_u32 s31, s31, 1
  ds_read_b128 v[96:99], v117 offset:0
  ds_read_b128 v[100:103], v117 offset:1024
  ds_read_b128 v[104:107], v117 offset:14336
  ds_read_b128 v[108:111], v117 offset:15360
  v_smfmac_f32_16x16x64_bf16 v[36:39], v[8:11], a[0:7], v3
  v_smfmac_f32_16x16x64_bf16 v[40:43], v[8:11], a[56:63], v3
  v_smfmac_f32_16x16x64_bf16 v[44:47], v[8:11], a[112:119], v3
  v_smfmac_f32_16x16x64_bf16 v[48:51], v[8:11], a[168:175], v3
  v_smfmac_f32_16x16x64_bf16 v[52:55], v[8:11], a[224:231], v3
  v_smfmac_f32_16x16x64_bf16 v[56:59], v[8:11], v[144:151], v3
  v_smfmac_f32_16x16x64_bf16 v[60:63], v[8:11], v[200:207], v3
  v_smfmac_f32_16x16x64_bf16 v[36:39], v[12:15], a[8:15], v3
  v_smfmac_f32_16x16x64_bf16 v[40:43], v[12:15], a[64:71], v3
  v_smfmac_f32_16x16x64_bf16 v[44:47], v[12:15], a[120:127], v3
  v_smfmac_f32_16x16x64_bf16 v[48:51], v[12:15], a[176:183], v3
  v_smfmac_f32_16x16x64_bf16 v[52:55], v[12:15], a[232:239], v3
  v_smfmac_f32_16x16x64_bf16 v[56:59], v[12:15], v[152:159], v3
  v_smfmac_f32_16x16x64_bf16 v[60:63], v[12:15], v[208:215], v3
  v_smfmac_f32_16x16x64_bf16 v[36:39], v[16:19], a[16:23], v3
  v_smfmac_f32_16x16x64_bf16 v[40:43], v[16:19], a[72:79], v3
  v_smfmac_f32_16x16x64_bf16 v[44:47], v[16:19], a[128:135], v3
  v_smfmac_f32_16x16x64_bf16 v[48:51], v[16:19], a[184:191], v3
  v_smfmac_f32_16x16x64_bf16 v[52:55], v[16:19], a[240:247], v3
  v_smfmac_f32_16x16x64_bf16 v[56:59], v[16:19], v[160:167], v3
  v_smfmac_f32_16x16x64_bf16 v[60:63], v[16:19], v[216:223], v3
  v_smfmac_f32_16x16x64_bf16 v[36:39], v[20:23], a[24:31], v3
  v_smfmac_f32_16x16x64_bf16 v[40:43], v[20:23], a[80:87], v3
  v_smfmac_f32_16x16x64_bf16 v[44:47], v[20:23], a[136:143], v3
  v_smfmac_f32_16x16x64_bf16 v[48:51], v[20:23], a[192:199], v3
  v_smfmac_f32_16x16x64_bf16 v[52:55], v[20:23], a[248:255], v3
  v_smfmac_f32_16x16x64_bf16 v[56:59], v[20:23], v[168:175], v3
  v_smfmac_f32_16x16x64_bf16 v[60:63], v[20:23], v[224:231], v3
  s_xor_b32 s58, s25, 28672
  s_add_u32 s59, s24, 28672
  s_add_u32 m0, s58, 21504
  s_branch cB_sc3_ph2
.p2align 6

cB_va0_loop:
  s_add_u32 s23, s20, 4096
  s_add_u32 s21, s20, 20480
  s_mov_b32 s30, 0
  s_cmp_lg_u32 s19, s38
  s_cbranch_scc1 cB_va0_vok
  s_branch cB_va0_voc
cB_va0_vow:
  s_sub_u32 s22, s39, s35
  v_lshlrev_b32 v63, 7, v2
  v_min_u32 v63, s22, v63
  buffer_load_dword v63, v63, s[8:11], s35 offen sc1
  s_waitcnt vmcnt(0)
cB_va0_voc:
  v_readfirstlane_b32 s22, v63
  s_cmp_eq_u32 s22, 56
  s_cbranch_scc1 cB_va0_vod
  s_sleep 1
  s_add_u32 s30, s30, 1
  s_cmp_lt_u32 s30, 400000
  s_cbranch_scc1 cB_va0_vow
  s_branch cB_abort
cB_va0_vod:
  s_add_u32 s35, s35, 2048
  s_add_u32 s38, s19, 8
  s_and_b32 s38, s38, -8
  s_cmp_eq_u32 s19, 0
  s_cselect_b32 s38, 4, s38
  v_cmp_ne_u32 vcc, 56, v63
  s_nop 3
  s_cmp_eq_u64 vcc, 0
  s_cselect_b32 s38, 99, s38
cB_va0_vok:
  s_cmp_eq_u32 s19, 63
  s_cbranch_scc1 cB_done
  s_barrier
  s_add_u32 s22, s25, 0
  buffer_load_dwordx4 v[80:83], v6, s[8:11], s22 offen offset:0 sc1
  buffer_load_dwordx4 v[84:87], v6, s[8:11], s22 offen offset:1792 sc1
  s_add_u32 s22, s25, 3584
  buffer_load_dwordx4 v[88:91], v6, s[8:11], s22 offen offset:0 sc1
  buffer_load_dwordx4 v[92:95], v6, s[8:11], s22 offen offset:1792 sc1
  s_add_u32 s22, s25, 7168
  buffer_load_dwordx4 v[96:99], v6, s[8:11], s22 offen offset:0 sc1
  buffer_load_dwordx4 v[100:103], v6, s[8:11], s22 offen offset:1792 sc1
  s_add_u32 s22, s25, 10752
  buffer_load_dwordx4 v[104:107], v6, s[8:11], s22 offen offset:0 sc1
  buffer_load_dwordx4 v[108:111], v6, s[8:11], s22 offen offset:1792 sc1
  s_add_u32 s22, s25, 14336
  buffer_load_dwordx4 v[112:115], v6, s[8:11], s22 offen offset:0 sc1
  buffer_load_dwordx4 v[116:119], v6, s[8:11], s22 offen offset:1792 sc1
  s_add_u32 s22, s25, 17920
  buffer_load_dwordx4 v[120:123], v6, s[8:11], s22 offen offset:0 sc1
  buffer_load_dwordx4 v[124:127], v6, s[8:11], s22 offen offset:1792 sc1
  s_add_u32 s22, s19, 1
  s_cmp_lg_u32 s22, s38
  s_cbranch_scc1 cB_va0_nk
  s_sub_u32 s22, s39, s35
  v_lshlrev_b32 v63, 7, v2
  v_min_u32 v63, s22, v63
  buffer_load_dword v63, v63, s[8:11], s35 offen sc1
cB_va0_nk:
  s_barrier
  ds_read_b128 v[8:11], v0 offset:8192
  ds_read_b128 v[12:15], v0 offset:9216
  ds_read_b128 v[16:19], v0 offset:10240
  ds_read_b128 v[20:23], v0 offset:11264
  ds_read_b128 v[24:27], v0 offset:12288
  ds_read_b128 v[28:31], v0 offset:13312
  ds_read_b128 v[32:35], v0 offset:14336
  s_waitcnt lgkmcnt(0)
  v_smfmac_f32_16x16x64_bf16 v[36:39], v[8:11], a[0:7], v3
  s_add_u32 s22, s25, 21504
  buffer_load_dwordx4 v[128:131], v6, s[8:11], s22 offen offset:0 sc1
  v_smfmac_f32_16x16x64_bf16 v[36:39], v[12:15], a[8:15], v3
  v_smfmac_f32_16x16x64_bf16 v[36:39], v[16:19], a[16:23], v3
  s_add_u32 s22, s25, 21504
  buffer_load_dwordx4 v[132:135], v6, s[8:11], s22 offen offset:1792 sc1
  v_smfmac_f32_16x16x64_bf16 v[36:39], v[20:23], a[24:31], v3
  v_smfmac_f32_16x16x64_bf16 v[36:39], v[24:27], a[32:39], v3
  s_add_u32 s22, s25, 25088
  buffer_load_dwordx4 v[136:139], v6, s[8:11], s22 offen offset:0 sc1
  v_smfmac_f32_16x16x64_bf16 v[36:39], v[28:31], a[40:47], v3
  v_smfmac_f32_16x16x64_bf16 v[36:39], v[32:35], a[48:55], v3
  s_add_u32 s22, s25, 25088
  buffer_load_dwordx4 v[140:143], v6, s[8:11], s22 offen offset:1792 sc1
  v_smfmac_f32_16x16x64_bf16 v[40:43], v[8:11], a[56:63], v3
  v_smfmac_f32_16x16x64_bf16 v[40:43], v[12:15], a[64:71], v3
  v_smfmac_f32_16x16x64_bf16 v[40:43], v[16:19], a[72:79], v3
  v_add_f32 v36, v36, v37
  v_smfmac_f32_16x16x64_bf16 v[40:43], v[20:23], a[80:87], v3
  v_add_f32 v38, v38, v39
  v_smfmac_f32_16x16x64_bf16 v[40:43], v[24:27], a[88:95], v3
  v_cvt_pk_bf16_f32 v36, v36, v38
  v_smfmac_f32_16x16x64_bf16 v[40:43], v[28:31], a[96:103], v3
  ds_write_b32 v60, v36
  v_smfmac_f32_16x16x64_bf16 v[40:43], v[32:35], a[104:111], v3
  v_smfmac_f32_16x16x64_bf16 v[44:47], v[8:11], a[112:119], v3
  v_smfmac_f32_16x16x64_bf16 v[44:47], v[12:15], a[120:127], v3
  v_smfmac_f32_16x16x64_bf16 v[44:47], v[16:19], a[128:135], v3
  v_add_f32 v40, v40, v41
  v_smfmac_f32_16x16x64_bf16 v[44:47], v[20:23], a[136:143], v3
  v_add_f32 v42, v42, v43
  v_smfmac_f32_16x16x64_bf16 v[44:47], v[24:27], a[144:151], v3
  v_cvt_pk_bf16_f32 v40, v40, v42
  v_smfmac_f32_16x16x64_bf16 v[44:47], v[28:31], a[152:159], v3
  ds_write_b32 v61, v40
  v_smfmac_f32_16x16x64_bf16 v[44:47], v[32:35], a[160:167], v3
  v_smfmac_f32_16x16x64_bf16 v[48:51], v[8:11], a[168:175], v3
  v_smfmac_f32_16x16x64_bf16 v[48:51], v[12:15], a[176:183], v3
  v_smfmac_f32_16x16x64_bf16 v[48:51], v[16:19], a[184:191], v3
  v_add_f32 v44, v44, v45
  v_smfmac_f32_16x16x64_bf16 v[48:51], v[20:23], a[192:199], v3
  v_add_f32 v46, v46, v47
  v_smfmac_f32_16x16x64_bf16 v[48:51], v[24:27], a[200:207], v3
  v_cvt_pk_bf16_f32 v44, v44, v46
  v_smfmac_f32_16x16x64_bf16 v[48:51], v[28:31], a[208:215], v3
  ds_write_b32 v62, v44
  v_smfmac_f32_16x16x64_bf16 v[48:51], v[32:35], a[216:223], v3
  v_smfmac_f32_16x16x64_bf16 v[52:55], v[8:11], a[224:231], v3
  v_smfmac_f32_16x16x64_bf16 v[52:55], v[12:15], a[232:239], v3
  v_smfmac_f32_16x16x64_bf16 v[52:55], v[16:19], a[240:247], v3
  v_add_f32 v48, v48, v49
  v_smfmac_f32_16x16x64_bf16 v[52:55], v[20:23], a[248:255], v3
  v_add_f32 v50, v50, v51
  v_smfmac_f32_16x16x64_bf16 v[52:55], v[24:27], v[176:183], v3
  v_cvt_pk_bf16_f32 v48, v48, v50
  v_smfmac_f32_16x16x64_bf16 v[52:55], v[28:31], v[184:191], v3
  ds_write_b32 v170, v48
  v_smfmac_f32_16x16x64_bf16 v[52:55], v[32:35], v[192:199], v3
  v_smfmac_f32_16x16x64_bf16 v[56:59], v[8:11], v[200:207], v3
  v_smfmac_f32_16x16x64_bf16 v[56:59], v[12:15], v[208:215], v3
  v_smfmac_f32_16x16x64_bf16 v[56:59], v[16:19], v[216:223], v3
  v_add_f32 v52, v52, v53
  v_smfmac_f32_16x16x64_bf16 v[56:59], v[20:23], v[224:231], v3
  v_add_f32 v54, v54, v55
  v_smfmac_f32_16x16x64_bf16 v[56:59], v[24:27], v[232:239], v3
  v_cvt_pk_bf16_f32 v52, v52, v54
  v_smfmac_f32_16x16x64_bf16 v[56:59], v[28:31], v[240:247], v3
  ds_write_b32 v171, v52
  v_smfmac_f32_16x16x64_bf16 v[56:59], v[32:35], v[248:255], v3
  s_nop 7
  v_add_f32 v56, v56, v57
  v_add_f32 v58, v58, v59
  v_cvt_pk_bf16_f32 v56, v56, v58
  ds_write_b32 v172, v56
  buffer_load_dword v164, v4, s[8:11], s20 offen sc1
  s_waitcnt lgkmcnt(0)
  v_mov_b32 v36, 0
  v_mov_b32 v37, 0
  v_mov_b32 v38, 0
  v_mov_b32 v39, 0
  v_mov_b32 v40, 0
  v_mov_b32 v41, 0
  v_mov_b32 v42, 0
  v_mov_b32 v43, 0
  buffer_load_dword v165, v4, s[8:11], s20 offen sc1
  v_mov_b32 v44, 0
  v_mov_b32 v45, 0
  v_mov_b32 v46, 0
  v_mov_b32 v47, 0
  v_mov_b32 v48, 0
  v_mov_b32 v49, 0
  v_mov_b32 v50, 0
  v_mov_b32 v51, 0
  buffer_load_dword v166, v4, s[8:11], s20 offen sc1
  v_mov_b32 v52, 0
  v_mov_b32 v53, 0
  v_mov_b32 v54, 0
  v_mov_b32 v55, 0
  v_mov_b32 v56, 0
  v_mov_b32 v57, 0
  v_mov_b32 v58, 0
  v_mov_b32 v59, 0
  buffer_load_dword v167, v4, s[8:11], s20 offen sc1
  s_cmp_eq_u32 s19, 63
  s_cbranch_scc1 cB_va0_last
  s_add_u32 s22, s20, 9216
  s_add_u32 s34, s20, 13312
  s_add_u32 s36, s20, 7168
  s_mov_b32 s37, 0
  v_mov_b32 v156, 0
  v_mov_b32 v157, 0
  v_mov_b32 v158, 0
  v_mov_b32 v159, 0
  buffer_load_dword v168, v4, s[8:11], s20 offen sc1
cB_va0_fw_l:
  s_waitcnt vmcnt(4)
  v_cmp_eq_u32 vcc, -1, v164
  s_cbranch_vccz cB_va0_fw_d
  buffer_load_dword v164, v4, s[8:11], s20 offen sc1
  s_waitcnt vmcnt(4)
  v_cmp_eq_u32 vcc, -1, v165
  s_cbranch_vccz cB_va0_fw_d
  buffer_load_dword v165, v4, s[8:11], s20 offen sc1
  s_waitcnt vmcnt(4)
  v_cmp_eq_u32 vcc, -1, v166
  s_cbranch_vccz cB_va0_fw_d
  buffer_load_dword v166, v4, s[8:11], s20 offen sc1
  s_waitcnt vmcnt(4)
  v_cmp_eq_u32 vcc, -1, v167
  s_cbranch_vccz cB_va0_fw_d
  buffer_load_dword v167, v4, s[8:11], s20 offen sc1
  s_waitcnt vmcnt(4)
  v_cmp_eq_u32 vcc, -1, v168
  s_cbranch_vccz cB_va0_fw_d
  buffer_load_dword v168, v4, s[8:11], s20 offen sc1
  s_add_u32 s30, s30, 1
  s_cmp_lt_u32 s30, 400000
  s_cbranch_scc1 cB_va0_fw_l
  s_branch cB_abort
cB_va0_fw_d:
  s_waitcnt lgkmcnt(0)
  buffer_load_dwordx4 v[8:11], v5, s[8:11], s22 offen offset:0 sc1
  buffer_load_dwordx4 v[12:15], v5, s[8:11], s22 offen offset:1024 sc1
  buffer_load_dwordx4 v[16:19], v5, s[8:11], s22 offen offset:2048 sc1
  buffer_load_dwordx4 v[20:23], v5, s[8:11], s22 offen offset:3072 sc1
  buffer_load_dwordx4 v[24:27], v5, s[8:11], s34 offen offset:0 sc1
  buffer_load_dwordx4 v[28:31], v5, s[8:11], s34 offen offset:1024 sc1
  buffer_load_dwordx4 v[32:35], v5, s[8:11], s34 offen offset:2048 sc1
  buffer_load_dwordx4 v[144:147], v5, s[8:11], s34 offen offset:3072 sc1
  buffer_load_dwordx4 v[148:151], v2, s[8:11], s36 offen offset:0 sc1
  buffer_load_dwordx4 v[152:155], v2, s[8:11], s36 offen offset:1024 sc1
  s_barrier
  ds_read_b128 v[64:67], v2 offset:0
  ds_read_b128 v[68:71], v2 offset:1024
  ds_read_b128 v[72:75], v2 offset:2048
  ds_read_b128 v[76:79], v2 offset:3072
  s_waitcnt vmcnt(9)
  v_smfmac_f32_16x16x64_bf16 v[156:159], v[8:11], v[80:87], v3
  s_waitcnt vmcnt(8)
  v_smfmac_f32_16x16x64_bf16 v[156:159], v[12:15], v[88:95], v3
  s_waitcnt vmcnt(7)
  v_smfmac_f32_16x16x64_bf16 v[156:159], v[16:19], v[96:103], v3
  s_waitcnt vmcnt(6)
  v_smfmac_f32_16x16x64_bf16 v[156:159], v[20:23], v[104:111], v3
  s_waitcnt vmcnt(5)
  v_smfmac_f32_16x16x64_bf16 v[156:159], v[24:27], v[112:119], v3
  s_waitcnt vmcnt(4)
  v_smfmac_f32_16x16x64_bf16 v[156:159], v[28:31], v[120:127], v3
  s_waitcnt vmcnt(3)
  v_smfmac_f32_16x16x64_bf16 v[156:159], v[32:35], v[128:135], v3
  s_waitcnt vmcnt(2)
  v_smfmac_f32_16x16x64_bf16 v[156:159], v[144:147], v[136:143], v3
  s_waitcnt vmcnt(1) lgkmcnt(0)
  v_smfmac_f32_16x16x64_bf16 v[156:159], v[148:151], v[64:71], v3
  s_waitcnt vmcnt(0)
  v_smfmac_f32_16x16x64_bf16 v[156:159], v[152:155], v[72:79], v3
cB_va0_ep:
  s_nop 7
  v_add_f32 v160, v156, v157
  v_add_f32 v161, v158, v159
  v_cmp_u_f32 vcc, v160, v161
  v_mov_b32_dpp v162, v160 row_ror:8 row_mask:0xf bank_mask:0xf
  v_mov_b32_dpp v160, v161 row_ror:8 row_mask:0xf bank_mask:0xc
  s_cbranch_vccnz cB_va0_rp
  v_mov_b32_dpp v161, v162 quad_perm:[0,1,2,3] row_mask:0xf bank_mask:0x3
  v_cvt_pk_bf16_f32 v160, v160, v161
cB_va0_pc:
  buffer_store_dword v160, v1, s[8:11], s21 offen sc1
  s_cmp_lg_u32 s19, 62
  s_cbranch_scc1 cB_va0_nl
  s_mov_b32 s22, 88531968
  buffer_store_dword v160, v1, s[8:11], s22 offen sc1
  s_mov_b64 exec, -1
  s_branch cB_done
cB_va0_nl:
  s_mov_b64 exec, -1
  s_add_u32 s25, s25, 28672
  s_add_u32 s19, s19, 1
  s_mov_b32 s20, s21
  s_branch cB_va0_loop
cB_va0_last:
  s_waitcnt lgkmcnt(0)
  s_barrier
  s_branch cB_done
cB_va0_rp:
  s_cmp_eq_u32 s37, 0
  s_cbranch_scc1 cB_va0_rv
  v_mov_b32_dpp v161, v162 quad_perm:[0,1,2,3] row_mask:0xf bank_mask:0x3
  v_cvt_pk_bf16_f32 v160, v160, v161
  v_min_u32 v160, -2, v160
  s_branch cB_va0_pc
cB_va0_rv:
  buffer_load_dwordx4 v[8:11], v5, s[8:11], s22 offen offset:0 sc1
  buffer_load_dwordx4 v[12:15], v5, s[8:11], s22 offen offset:1024 sc1
  buffer_load_dwordx4 v[16:19], v5, s[8:11], s22 offen offset:2048 sc1
  buffer_load_dwordx4 v[20:23], v5, s[8:11], s22 offen offset:3072 sc1
  buffer_load_dwordx4 v[24:27], v5, s[8:11], s34 offen offset:0 sc1
  buffer_load_dwordx4 v[28:31], v5, s[8:11], s34 offen offset:1024 sc1
  buffer_load_dwordx4 v[32:35], v5, s[8:11], s34 offen offset:2048 sc1
  buffer_load_dwordx4 v[144:147], v5, s[8:11], s34 offen offset:3072 sc1
  buffer_load_dwordx4 v[148:151], v2, s[8:11], s36 offen offset:0 sc1
  buffer_load_dwordx4 v[152:155], v2, s[8:11], s36 offen offset:1024 sc1
  s_waitcnt vmcnt(0)
  v_max3_u32 v175, v8, v9, v10
  v_max3_u32 v175, v175, v11, v12
  v_max3_u32 v175, v175, v13, v14
  v_max3_u32 v175, v175, v15, v16
  v_max3_u32 v175, v175, v17, v18
  v_max3_u32 v175, v175, v19, v20
  v_max3_u32 v175, v175, v21, v22
  v_max3_u32 v175, v175, v23, v24
  v_max3_u32 v175, v175, v25, v26
  v_max3_u32 v175, v175, v27, v28
  v_max3_u32 v175, v175, v29, v30
  v_max3_u32 v175, v175, v31, v32
  v_max3_u32 v175, v175, v33, v34
  v_max3_u32 v175, v175, v35, v144
  v_max3_u32 v175, v175, v145, v146
  v_max3_u32 v175, v175, v147, v148
  v_max3_u32 v175, v175, v149, v150
  v_max3_u32 v175, v175, v151, v152
  v_max3_u32 v175, v175, v153, v154
  v_max_u32 v175, v175, v155
  v_cmp_eq_u32 vcc, -1, v175
  s_cbranch_vccz cB_va0_rk
  s_add_u32 s30, s30, 1
  s_cmp_lt_u32 s30, 400000
  s_cbranch_scc1 cB_va0_rv
  s_branch cB_abort
cB_va0_rk:
  s_mov_b32 s37, 1
  s_add_u32 s31, s31, 0x10000
  v_mov_b32 v156, 0
  v_mov_b32 v157, 0
  v_mov_b32 v158, 0
  v_mov_b32 v159, 0
  s_nop 1
  v_smfmac_f32_16x16x64_bf16 v[156:159], v[8:11], v[80:87], v3
  v_smfmac_f32_16x16x64_bf16 v[156:159], v[12:15], v[88:95], v3
  v_smfmac_f32_16x16x64_bf16 v[156:159], v[16:19], v[96:103], v3
  v_smfmac_f32_16x16x64_bf16 v[156:159], v[20:23], v[104:111], v3
  v_smfmac_f32_16x16x64_bf16 v[156:159], v[24:27], v[112:119], v3
  v_smfmac_f32_16x16x64_bf16 v[156:159], v[28:31], v[120:127], v3
  v_smfmac_f32_16x16x64_bf16 v[156:159], v[32:35], v[128:135], v3
  v_smfmac_f32_16x16x64_bf16 v[156:159], v[144:147], v[136:143], v3
  v_smfmac_f32_16x16x64_bf16 v[156:159], v[148:151], v[64:71], v3
  v_smfmac_f32_16x16x64_bf16 v[156:159], v[152:155], v[72:79], v3
  s_nop 7
  s_branch cB_va0_ep
.p2align 6

cB_va1_loop:
  s_add_u32 s23, s20, 4096
  s_add_u32 s21, s20, 20480
  s_mov_b32 s30, 0
  s_cmp_lg_u32 s19, s38
  s_cbranch_scc1 cB_va1_vok
  s_branch cB_va1_voc
cB_va1_vow:
  s_sub_u32 s22, s39, s35
  v_lshlrev_b32 v63, 7, v2
  v_min_u32 v63, s22, v63
  buffer_load_dword v63, v63, s[8:11], s35 offen sc1
  s_waitcnt vmcnt(0)
cB_va1_voc:
  v_readfirstlane_b32 s22, v63
  s_cmp_eq_u32 s22, 56
  s_cbranch_scc1 cB_va1_vod
  s_sleep 1
  s_add_u32 s30, s30, 1
  s_cmp_lt_u32 s30, 400000
  s_cbranch_scc1 cB_va1_vow
  s_branch cB_abort
cB_va1_vod:
  s_add_u32 s35, s35, 2048
  s_add_u32 s38, s19, 8
  s_and_b32 s38, s38, -8
  s_cmp_eq_u32 s19, 0
  s_cselect_b32 s38, 4, s38
  v_cmp_ne_u32 vcc, 56, v63
  s_nop 3
  s_cmp_eq_u64 vcc, 0
  s_cselect_b32 s38, 99, s38
cB_va1_vok:
  s_cmp_eq_u32 s19, 63
  s_cbranch_scc1 cB_done
  s_barrier
  s_add_u32 s22, s25, 0
  buffer_load_dwordx4 v[80:83], v6, s[8:11], s22 offen offset:0 sc1
  buffer_load_dwordx4 v[84:87], v6, s[8:11], s22 offen offset:1792 sc1
  s_add_u32 s22, s25, 3584
  buffer_load_dwordx4 v[88:91], v6, s[8:11], s22 offen offset:0 sc1
  buffer_load_dwordx4 v[92:95], v6, s[8:11], s22 offen offset:1792 sc1
  s_add_u32 s22, s25, 7168
  buffer_load_dwordx4 v[96:99], v6, s[8:11], s22 offen offset:0 sc1
  buffer_load_dwordx4 v[100:103], v6, s[8:11], s22 offen offset:1792 sc1
  s_add_u32 s22, s25, 10752
  buffer_load_dwordx4 v[104:107], v6, s[8:11], s22 offen offset:0 sc1
  buffer_load_dwordx4 v[108:111], v6, s[8:11], s22 offen offset:1792 sc1
  s_add_u32 s22, s25, 14336
  buffer_load_dwordx4 v[112:115], v6, s[8:11], s22 offen offset:0 sc1
  buffer_load_dwordx4 v[116:119], v6, s[8:11], s22 offen offset:1792 sc1
  s_add_u32 s22, s25, 17920
  buffer_load_dwordx4 v[120:123], v6, s[8:11], s22 offen offset:0 sc1
  buffer_load_dwordx4 v[124:127], v6, s[8:11], s22 offen offset:1792 sc1
  s_add_u32 s22, s19, 1
  s_cmp_lg_u32 s22, s38
  s_cbranch_scc1 cB_va1_nk
  s_sub_u32 s22, s39, s35
  v_lshlrev_b32 v63, 7, v2
  v_min_u32 v63, s22, v63
  buffer_load_dword v63, v63, s[8:11], s35 offen sc1
cB_va1_nk:
  s_barrier
  ds_read_b128 v[8:11], v0 offset:8192
  ds_read_b128 v[12:15], v0 offset:9216
  ds_read_b128 v[16:19], v0 offset:10240
  ds_read_b128 v[20:23], v0 offset:11264
  ds_read_b128 v[24:27], v0 offset:12288
  ds_read_b128 v[28:31], v0 offset:13312
  ds_read_b128 v[32:35], v0 offset:14336
  s_waitcnt lgkmcnt(0)
  v_smfmac_f32_16x16x64_bf16 v[36:39], v[8:11], a[0:7], v3
  s_add_u32 s22, s25, 21504
  buffer_load_dwordx4 v[128:131], v6, s[8:11], s22 offen offset:0 sc1
  v_smfmac_f32_16x16x64_bf16 v[36:39], v[12:15], a[8:15], v3
  v_smfmac_f32_16x16x64_bf16 v[36:39], v[16:19], a[16:23], v3
  s_add_u32 s22, s25, 21504
  buffer_load_dwordx4 v[132:135], v6, s[8:11], s22 offen offset:1792 sc1
  v_smfmac_f32_16x16x64_bf16 v[36:39], v[20:23], a[24:31], v3
  v_smfmac_f32_16x16x64_bf16 v[36:39], v[24:27], a[32:39], v3
  s_add_u32 s22, s25, 25088
  buffer_load_dwordx4 v[136:139], v6, s[8:11], s22 offen offset:0 sc1
  v_smfmac_f32_16x16x64_bf16 v[36:39], v[28:31], a[40:47], v3
  v_smfmac_f32_16x16x64_bf16 v[36:39], v[32:35], a[48:55], v3
  s_add_u32 s22, s25, 25088
  buffer_load_dwordx4 v[140:143], v6, s[8:11], s22 offen offset:1792 sc1
  v_smfmac_f32_16x16x64_bf16 v[40:43], v[8:11], a[56:63], v3
  v_smfmac_f32_16x16x64_bf16 v[40:43], v[12:15], a[64:71], v3
  v_smfmac_f32_16x16x64_bf16 v[40:43], v[16:19], a[72:79], v3
  v_add_f32 v36, v36, v37
  v_smfmac_f32_16x16x64_bf16 v[40:43], v[20:23], a[80:87], v3
  v_add_f32 v38, v38, v39
  v_smfmac_f32_16x16x64_bf16 v[40:43], v[24:27], a[88:95], v3
  v_cvt_pk_bf16_f32 v36, v36, v38
  v_smfmac_f32_16x16x64_bf16 v[40:43], v[28:31], a[96:103], v3
  ds_write_b32 v60, v36
  v_smfmac_f32_16x16x64_bf16 v[40:43], v[32:35], a[104:111], v3
  v_smfmac_f32_16x16x64_bf16 v[44:47], v[8:11], a[112:119], v3
  v_smfmac_f32_16x16x64_bf16 v[44:47], v[12:15], a[120:127], v3
  v_smfmac_f32_16x16x64_bf16 v[44:47], v[16:19], a[128:135], v3
  v_add_f32 v40, v40, v41
  v_smfmac_f32_16x16x64_bf16 v[44:47], v[20:23], a[136:143], v3
  v_add_f32 v42, v42, v43
  v_smfmac_f32_16x16x64_bf16 v[44:47], v[24:27], a[144:151], v3
  v_cvt_pk_bf16_f32 v40, v40, v42
  v_smfmac_f32_16x16x64_bf16 v[44:47], v[28:31], a[152:159], v3
  ds_write_b32 v61, v40
  v_smfmac_f32_16x16x64_bf16 v[44:47], v[32:35], a[160:167], v3
  v_smfmac_f32_16x16x64_bf16 v[48:51], v[8:11], a[168:175], v3
  v_smfmac_f32_16x16x64_bf16 v[48:51], v[12:15], a[176:183], v3
  v_smfmac_f32_16x16x64_bf16 v[48:51], v[16:19], a[184:191], v3
  v_add_f32 v44, v44, v45
  v_smfmac_f32_16x16x64_bf16 v[48:51], v[20:23], a[192:199], v3
  v_add_f32 v46, v46, v47
  v_smfmac_f32_16x16x64_bf16 v[48:51], v[24:27], a[200:207], v3
  v_cvt_pk_bf16_f32 v44, v44, v46
  v_smfmac_f32_16x16x64_bf16 v[48:51], v[28:31], a[208:215], v3
  ds_write_b32 v62, v44
  v_smfmac_f32_16x16x64_bf16 v[48:51], v[32:35], a[216:223], v3
  v_smfmac_f32_16x16x64_bf16 v[52:55], v[8:11], a[224:231], v3
  v_smfmac_f32_16x16x64_bf16 v[52:55], v[12:15], a[232:239], v3
  v_smfmac_f32_16x16x64_bf16 v[52:55], v[16:19], a[240:247], v3
  v_add_f32 v48, v48, v49
  v_smfmac_f32_16x16x64_bf16 v[52:55], v[20:23], a[248:255], v3
  v_add_f32 v50, v50, v51
  v_smfmac_f32_16x16x64_bf16 v[52:55], v[24:27], v[176:183], v3
  v_cvt_pk_bf16_f32 v48, v48, v50
  v_smfmac_f32_16x16x64_bf16 v[52:55], v[28:31], v[184:191], v3
  ds_write_b32 v170, v48
  v_smfmac_f32_16x16x64_bf16 v[52:55], v[32:35], v[192:199], v3
  v_smfmac_f32_16x16x64_bf16 v[56:59], v[8:11], v[200:207], v3
  v_smfmac_f32_16x16x64_bf16 v[56:59], v[12:15], v[208:215], v3
  v_smfmac_f32_16x16x64_bf16 v[56:59], v[16:19], v[216:223], v3
  v_add_f32 v52, v52, v53
  v_smfmac_f32_16x16x64_bf16 v[56:59], v[20:23], v[224:231], v3
  v_add_f32 v54, v54, v55
  v_smfmac_f32_16x16x64_bf16 v[56:59], v[24:27], v[232:239], v3
  v_cvt_pk_bf16_f32 v52, v52, v54
  v_smfmac_f32_16x16x64_bf16 v[56:59], v[28:31], v[240:247], v3
  ds_write_b32 v171, v52
  v_smfmac_f32_16x16x64_bf16 v[56:59], v[32:35], v[248:255], v3
  s_nop 7
  v_add_f32 v56, v56, v57
  v_add_f32 v58, v58, v59
  v_cvt_pk_bf16_f32 v56, v56, v58
  ds_write_b32 v172, v56
  s_waitcnt lgkmcnt(0)
  v_mov_b32 v36, 0
  v_mov_b32 v37, 0
  v_mov_b32 v38, 0
  v_mov_b32 v39, 0
  v_mov_b32 v40, 0
  v_mov_b32 v41, 0
  v_mov_b32 v42, 0
  v_mov_b32 v43, 0
  v_mov_b32 v44, 0
  v_mov_b32 v45, 0
  v_mov_b32 v46, 0
  v_mov_b32 v47, 0
  v_mov_b32 v48, 0
  v_mov_b32 v49, 0
  v_mov_b32 v50, 0
  v_mov_b32 v51, 0
  v_mov_b32 v52, 0
  v_mov_b32 v53, 0
  v_mov_b32 v54, 0
  v_mov_b32 v55, 0
  v_mov_b32 v56, 0
  v_mov_b32 v57, 0
  v_mov_b32 v58, 0
  v_mov_b32 v59, 0
  s_cmp_eq_u32 s19, 63
  s_cbranch_scc1 cB_va1_last
  s_add_u32 s22, s20, 9216
  s_add_u32 s34, s20, 13312
  s_add_u32 s36, s20, 7168
  s_mov_b32 s37, 0
  v_mov_b32 v156, 0
  v_mov_b32 v157, 0
  v_mov_b32 v158, 0
  v_mov_b32 v159, 0
  s_barrier
  s_waitcnt lgkmcnt(0)
  buffer_load_dwordx4 v[8:11], v5, s[8:11], s22 offen offset:0 sc1
  buffer_load_dwordx4 v[12:15], v5, s[8:11], s22 offen offset:1024 sc1
  buffer_load_dwordx4 v[16:19], v5, s[8:11], s22 offen offset:2048 sc1
  buffer_load_dwordx4 v[20:23], v5, s[8:11], s22 offen offset:3072 sc1
  buffer_load_dwordx4 v[24:27], v5, s[8:11], s34 offen offset:0 sc1
  buffer_load_dwordx4 v[28:31], v5, s[8:11], s34 offen offset:1024 sc1
  buffer_load_dwordx4 v[32:35], v5, s[8:11], s34 offen offset:2048 sc1
  buffer_load_dwordx4 v[144:147], v5, s[8:11], s34 offen offset:3072 sc1
  s_sub_u32 s23, s21, 4
  s_mov_b64 exec, 65535
  buffer_store_dword v2, v7, s[8:11], s23 offen sc1
  s_mov_b64 exec, -1
  buffer_load_dwordx4 v[148:151], v2, s[8:11], s36 offen offset:0 sc1
  buffer_load_dwordx4 v[152:155], v2, s[8:11], s36 offen offset:1024 sc1
  ds_read_b128 v[64:67], v2 offset:4096
  ds_read_b128 v[68:71], v2 offset:5120
  ds_read_b128 v[72:75], v2 offset:6144
  ds_read_b128 v[76:79], v2 offset:7168
  s_waitcnt vmcnt(10)
  v_smfmac_f32_16x16x64_bf16 v[156:159], v[8:11], v[80:87], v3
  s_waitcnt vmcnt(9)
  v_smfmac_f32_16x16x64_bf16 v[156:159], v[12:15], v[88:95], v3
  s_waitcnt vmcnt(8)
  v_smfmac_f32_16x16x64_bf16 v[156:159], v[16:19], v[96:103], v3
  s_waitcnt vmcnt(7)
  v_smfmac_f32_16x16x64_bf16 v[156:159], v[20:23], v[104:111], v3
  s_waitcnt vmcnt(6)
  v_smfmac_f32_16x16x64_bf16 v[156:159], v[24:27], v[112:119], v3
  s_mov_b64 exec, 65535
  buffer_store_dword v2, v7, s[8:11], s21 offen sc1
  s_mov_b64 exec, -1
  s_waitcnt vmcnt(6)
  v_smfmac_f32_16x16x64_bf16 v[156:159], v[28:31], v[120:127], v3
  s_waitcnt vmcnt(5)
  v_smfmac_f32_16x16x64_bf16 v[156:159], v[32:35], v[128:135], v3
  s_waitcnt vmcnt(4)
  v_smfmac_f32_16x16x64_bf16 v[156:159], v[144:147], v[136:143], v3
  s_waitcnt vmcnt(2) lgkmcnt(0)
  v_smfmac_f32_16x16x64_bf16 v[156:159], v[148:151], v[64:71], v3
  s_waitcnt vmcnt(1)
  v_smfmac_f32_16x16x64_bf16 v[156:159], v[152:155], v[72:79], v3
cB_va1_ep:
  s_nop 7
  v_add_f32 v160, v156, v157
  v_add_f32 v161, v158, v159
  v_cmp_u_f32 vcc, v160, v161
  v_mov_b32_dpp v162, v160 row_ror:8 row_mask:0xf bank_mask:0xf
  v_mov_b32_dpp v160, v161 row_ror:8 row_mask:0xf bank_mask:0xc
  s_cbranch_vccnz cB_va1_rp
  v_mov_b32_dpp v161, v162 quad_perm:[0,1,2,3] row_mask:0xf bank_mask:0x3
  v_cvt_pk_bf16_f32 v160, v160, v161
cB_va1_pc:
  s_mov_b64 exec, s[26:27]
  buffer_store_dword v160, v1, s[8:11], s21 offen sc1
  s_cmp_lg_u32 s19, 62
  s_cbranch_scc1 cB_va1_nl
  s_mov_b32 s22, 88531968
  buffer_store_dword v160, v1, s[8:11], s22 offen sc1
  s_mov_b64 exec, -1
  s_branch cB_done
cB_va1_nl:
  s_mov_b64 exec, -1
  s_cmp_lg_u32 s19, 0
  s_cbranch_scc1 cB_va1_s0
  v_add_u32 v7, 512, v7
  v_lshl_add_u32 v7, v2, 3, v7
  s_mov_b64 exec, 65535
  buffer_store_dword v2, v7, s[8:11], s21 offen sc1
  buffer_store_dword v2, v7, s[8:11], s23 offen sc1
  s_mov_b64 exec, -1
cB_va1_s0:
  s_add_u32 s25, s25, 28672
  s_add_u32 s19, s19, 1
  s_mov_b32 s20, s21
  s_branch cB_va1_loop
cB_va1_last:
  s_waitcnt lgkmcnt(0)
  s_barrier
  s_branch cB_done
cB_va1_rp:
  s_cmp_eq_u32 s37, 0
  s_cbranch_scc1 cB_va1_rv
  v_mov_b32_dpp v161, v162 quad_perm:[0,1,2,3] row_mask:0xf bank_mask:0x3
  v_cvt_pk_bf16_f32 v160, v160, v161
  v_min_u32 v160, -2, v160
  s_branch cB_va1_pc
cB_va1_rv:
  buffer_load_dwordx4 v[8:11], v5, s[8:11], s22 offen offset:0 sc1
  buffer_load_dwordx4 v[12:15], v5, s[8:11], s22 offen offset:1024 sc1
  buffer_load_dwordx4 v[16:19], v5, s[8:11], s22 offen offset:2048 sc1
  buffer_load_dwordx4 v[20:23], v5, s[8:11], s22 offen offset:3072 sc1
  buffer_load_dwordx4 v[24:27], v5, s[8:11], s34 offen offset:0 sc1
  buffer_load_dwordx4 v[28:31], v5, s[8:11], s34 offen offset:1024 sc1
  buffer_load_dwordx4 v[32:35], v5, s[8:11], s34 offen offset:2048 sc1
  buffer_load_dwordx4 v[144:147], v5, s[8:11], s34 offen offset:3072 sc1
  buffer_load_dwordx4 v[148:151], v2, s[8:11], s36 offen offset:0 sc1
  buffer_load_dwordx4 v[152:155], v2, s[8:11], s36 offen offset:1024 sc1
  s_waitcnt vmcnt(0)
  v_max3_u32 v175, v8, v9, v10
  v_max3_u32 v175, v175, v11, v12
  v_max3_u32 v175, v175, v13, v14
  v_max3_u32 v175, v175, v15, v16
  v_max3_u32 v175, v175, v17, v18
  v_max3_u32 v175, v175, v19, v20
  v_max3_u32 v175, v175, v21, v22
  v_max3_u32 v175, v175, v23, v24
  v_max3_u32 v175, v175, v25, v26
  v_max3_u32 v175, v175, v27, v28
  v_max3_u32 v175, v175, v29, v30
  v_max3_u32 v175, v175, v31, v32
  v_max3_u32 v175, v175, v33, v34
  v_max3_u32 v175, v175, v35, v144
  v_max3_u32 v175, v175, v145, v146
  v_max3_u32 v175, v175, v147, v148
  v_max3_u32 v175, v175, v149, v150
  v_max3_u32 v175, v175, v151, v152
  v_max3_u32 v175, v175, v153, v154
  v_max_u32 v175, v175, v155
  v_cmp_eq_u32 vcc, -1, v175
  s_cbranch_vccz cB_va1_rk
  s_add_u32 s30, s30, 1
  s_cmp_lt_u32 s30, 400000
  s_cbranch_scc1 cB_va1_rv
  s_branch cB_abort
cB_va1_rk:
  s_mov_b32 s37, 1
  s_add_u32 s31, s31, 0x10000
  v_mov_b32 v156, 0
  v_mov_b32 v157, 0
  v_mov_b32 v158, 0
  v_mov_b32 v159, 0
  s_nop 1
  v_smfmac_f32_16x16x64_bf16 v[156:159], v[8:11], v[80:87], v3
  v_smfmac_f32_16x16x64_bf16 v[156:159], v[12:15], v[88:95], v3
  v_smfmac_f32_16x16x64_bf16 v[156:159], v[16:19], v[96:103], v3
  v_smfmac_f32_16x16x64_bf16 v[156:159], v[20:23], v[104:111], v3
  v_smfmac_f32_16x16x64_bf16 v[156:159], v[24:27], v[112:119], v3
  v_smfmac_f32_16x16x64_bf16 v[156:159], v[28:31], v[120:127], v3
  v_smfmac_f32_16x16x64_bf16 v[156:159], v[32:35], v[128:135], v3
  v_smfmac_f32_16x16x64_bf16 v[156:159], v[144:147], v[136:143], v3
  v_smfmac_f32_16x16x64_bf16 v[156:159], v[148:151], v[64:71], v3
  v_smfmac_f32_16x16x64_bf16 v[156:159], v[152:155], v[72:79], v3
  s_nop 7
  s_branch cB_va1_ep
.p2align 6

cB_va2_loop:
  s_add_u32 s23, s20, 4096
  s_add_u32 s21, s20, 20480
  v_mov_b32 v36, 0
  v_mov_b32 v37, 0
  v_mov_b32 v38, 0
  v_mov_b32 v39, 0
  v_mov_b32 v40, 0
  v_mov_b32 v41, 0
  v_mov_b32 v42, 0
  v_mov_b32 v43, 0
  v_mov_b32 v44, 0
  v_mov_b32 v45, 0
  v_mov_b32 v46, 0
  v_mov_b32 v47, 0
  v_mov_b32 v48, 0
  v_mov_b32 v49, 0
  v_mov_b32 v50, 0
  v_mov_b32 v51, 0
  v_mov_b32 v52, 0
  v_mov_b32 v53, 0
  v_mov_b32 v54, 0
  v_mov_b32 v55, 0
  v_mov_b32 v56, 0
  v_mov_b32 v57, 0
  v_mov_b32 v58, 0
  v_mov_b32 v59, 0
  v_mov_b32 v60, 0
  v_mov_b32 v61, 0
  v_mov_b32 v62, 0
  v_mov_b32 v63, 0
  v_mov_b32 v64, 0
  v_mov_b32 v65, 0
  v_mov_b32 v66, 0
  v_mov_b32 v67, 0
  s_mov_b32 s30, 0
  buffer_load_dword v76, v119, s[8:11], s20 offen sc1
  buffer_load_dword v77, v119, s[8:11], s20 offen sc1
  buffer_load_dword v78, v119, s[8:11], s20 offen sc1
cB_va2_fp_l:
  s_waitcnt vmcnt(2)
  v_cmp_eq_u32 vcc, -1, v76
  s_cbranch_vccz cB_va2_fp_d
  buffer_load_dword v76, v119, s[8:11], s20 offen sc1
  s_waitcnt vmcnt(2)
  v_cmp_eq_u32 vcc, -1, v77
  s_cbranch_vccz cB_va2_fp_d
  buffer_load_dword v77, v119, s[8:11], s20 offen sc1
  s_waitcnt vmcnt(2)
  v_cmp_eq_u32 vcc, -1, v78
  s_cbranch_vccz cB_va2_fp_d
  buffer_load_dword v78, v119, s[8:11], s20 offen sc1
  s_add_u32 s30, s30, 1
  s_cmp_lt_u32 s30, 400000
  s_cbranch_scc1 cB_va2_fp_l
  s_branch cB_abort
cB_va2_fp_d:
  s_nop 15
  s_nop 3
  buffer_load_dwordx4 v[8:11], v2, s[8:11], s20 offen offset:0 sc1
  buffer_load_dwordx4 v[12:15], v2, s[8:11], s20 offen offset:1024 sc1
  buffer_load_dwordx4 v[16:19], v2, s[8:11], s20 offen offset:2048 sc1
  buffer_load_dwordx4 v[20:23], v2, s[8:11], s20 offen offset:3072 sc1
  s_barrier
cB_va2_ld:
  s_waitcnt vmcnt(0)
  v_max3_u32 v84, v8, v9, v10
  v_max3_u32 v84, v84, v11, v12
  v_max3_u32 v84, v84, v13, v14
  v_max3_u32 v84, v84, v15, v16
  v_max3_u32 v84, v84, v17, v18
  v_max3_u32 v84, v84, v19, v20
  v_max3_u32 v84, v84, v21, v22
  v_max_u32 v84, v84, v23
  v_cmp_eq_u32 vcc, -1, v84
  ds_write_b128 v2, v[8:11] offset:8192
  ds_write_b128 v2, v[12:15] offset:9216
  ds_write_b128 v2, v[16:19] offset:10240
  ds_write_b128 v2, v[20:23] offset:11264
  s_cbranch_vccnz cB_va2_retry
  s_waitcnt lgkmcnt(0)
  s_barrier
  ds_read_b128 v[8:11], v5 offset:8192
  ds_read_b128 v[12:15], v5 offset:9216
  ds_read_b128 v[16:19], v5 offset:10240
  ds_read_b128 v[20:23], v5 offset:11264
  ds_read_b128 v[24:27], v5 offset:12288
  ds_read_b128 v[28:31], v5 offset:13312
  ds_read_b128 v[32:35], v5 offset:14336
  ds_read_b128 v[92:95], v0
  s_waitcnt lgkmcnt(0)
  s_mov_b64 exec, s[26:27]
  buffer_store_dwordx4 v[92:95], v2, s[8:11], s36 offen sc1
  s_mov_b64 exec, -1
  s_add_u32 s36, s36, 7168
  s_cmp_eq_u32 s19, 63
  s_cbranch_scc1 cB_done
  ds_read_b128 v[76:79], v1 offset:0
  ds_read_b128 v[80:83], v1 offset:1024
  ds_read_b128 v[84:87], v1 offset:2048
  ds_read_b128 v[88:91], v1 offset:3072
  ds_read_b128 v[92:95], v1 offset:4096
  ds_read_b128 v[96:99], v1 offset:5120
  v_smfmac_f32_16x16x64_bf16 v[60:63], v[8:11], v[200:207], v3
  v_smfmac_f32_16x16x64_bf16 v[60:63], v[12:15], v[208:215], v3
  s_waitcnt lgkmcnt(4)
  v_smfmac_f32_16x16x64_bf16 v[64:67], v[8:11], v[76:83], v3
  ds_read_b128 v[76:79], v1 offset:6144
  ds_read_b128 v[80:83], v1 offset:7168
  v_smfmac_f32_16x16x64_bf16 v[60:63], v[16:19], v[216:223], v3
  v_smfmac_f32_16x16x64_bf16 v[60:63], v[20:23], v[224:231], v3
  s_waitcnt lgkmcnt(4)
  v_smfmac_f32_16x16x64_bf16 v[64:67], v[12:15], v[84:91], v3
  ds_read_b128 v[84:87], v1 offset:8192
  ds_read_b128 v[88:91], v1 offset:9216
  v_smfmac_f32_16x16x64_bf16 v[60:63], v[24:27], v[232:239], v3
  v_smfmac_f32_16x16x64_bf16 v[60:63], v[28:31], v[240:247], v3
  s_waitcnt lgkmcnt(4)
  v_smfmac_f32_16x16x64_bf16 v[64:67], v[16:19], v[92:99], v3
  ds_read_b128 v[92:95], v1 offset:10240
  ds_read_b128 v[96:99], v1 offset:11264
  v_smfmac_f32_16x16x64_bf16 v[60:63], v[32:35], v[248:255], v3
  v_smfmac_f32_16x16x64_bf16 v[36:39], v[8:11], a[0:7], v3
  s_waitcnt lgkmcnt(4)
  v_smfmac_f32_16x16x64_bf16 v[64:67], v[20:23], v[76:83], v3
  ds_read_b128 v[76:79], v1 offset:12288
  ds_read_b128 v[80:83], v1 offset:13312
  v_smfmac_f32_16x16x64_bf16 v[36:39], v[12:15], a[8:15], v3
  v_add_f32 v60, v60, v61
  v_smfmac_f32_16x16x64_bf16 v[36:39], v[16:19], a[16:23], v3
  v_add_f32 v62, v62, v63
  s_waitcnt lgkmcnt(4)
  v_smfmac_f32_16x16x64_bf16 v[64:67], v[24:27], v[84:91], v3
  v_cvt_pk_bf16_f32 v60, v60, v62
  v_smfmac_f32_16x16x64_bf16 v[36:39], v[20:23], a[24:31], v3
  ds_write_b32 v106, v60
  v_smfmac_f32_16x16x64_bf16 v[36:39], v[24:27], a[32:39], v3
  s_waitcnt lgkmcnt(2)
  v_smfmac_f32_16x16x64_bf16 v[64:67], v[28:31], v[92:99], v3
  v_smfmac_f32_16x16x64_bf16 v[36:39], v[28:31], a[40:47], v3
  v_smfmac_f32_16x16x64_bf16 v[36:39], v[32:35], a[48:55], v3
  s_waitcnt lgkmcnt(0)
  v_smfmac_f32_16x16x64_bf16 v[64:67], v[32:35], v[76:83], v3
  v_smfmac_f32_16x16x64_bf16 v[40:43], v[8:11], a[56:63], v3
  v_smfmac_f32_16x16x64_bf16 v[40:43], v[12:15], a[64:71], v3
  v_add_f32 v36, v36, v37
  v_smfmac_f32_16x16x64_bf16 v[40:43], v[16:19], a[72:79], v3
  v_add_f32 v38, v38, v39
  v_smfmac_f32_16x16x64_bf16 v[40:43], v[20:23], a[80:87], v3
  v_cvt_pk_bf16_f32 v36, v36, v38
  v_smfmac_f32_16x16x64_bf16 v[40:43], v[24:27], a[88:95], v3
  ds_write_b32 v100, v36
  v_smfmac_f32_16x16x64_bf16 v[40:43], v[28:31], a[96:103], v3
  v_add_f32 v64, v64, v65
  v_smfmac_f32_16x16x64_bf16 v[40:43], v[32:35], a[104:111], v3
  v_add_f32 v66, v66, v67
  v_smfmac_f32_16x16x64_bf16 v[44:47], v[8:11], a[112:119], v3
  v_cvt_pk_bf16_f32 v64, v64, v66
  v_smfmac_f32_16x16x64_bf16 v[44:47], v[12:15], a[120:127], v3
  ds_write_b32 v107, v64
  v_smfmac_f32_16x16x64_bf16 v[44:47], v[16:19], a[128:135], v3
  v_add_f32 v40, v40, v41
  v_smfmac_f32_16x16x64_bf16 v[44:47], v[20:23], a[136:143], v3
  v_add_f32 v42, v42, v43
  v_smfmac_f32_16x16x64_bf16 v[44:47], v[24:27], a[144:151], v3
  v_cvt_pk_bf16_f32 v40, v40, v42
  v_smfmac_f32_16x16x64_bf16 v[44:47], v[28:31], a[152:159], v3
  ds_write_b32 v101, v40
  v_smfmac_f32_16x16x64_bf16 v[44:47], v[32:35], a[160:167], v3
  v_smfmac_f32_16x16x64_bf16 v[48:51], v[8:11], a[168:175], v3
  v_smfmac_f32_16x16x64_bf16 v[48:51], v[12:15], a[176:183], v3
  v_smfmac_f32_16x16x64_bf16 v[48:51], v[16:19], a[184:191], v3
  v_add_f32 v44, v44, v45
  v_smfmac_f32_16x16x64_bf16 v[48:51], v[20:23], a[192:199], v3
  v_add_f32 v46, v46, v47
  v_smfmac_f32_16x16x64_bf16 v[48:51], v[24:27], a[200:207], v3
  v_cvt_pk_bf16_f32 v44, v44, v46
  v_smfmac_f32_16x16x64_bf16 v[48:51], v[28:31], a[208:215], v3
  ds_write_b32 v102, v44
  v_smfmac_f32_16x16x64_bf16 v[48:51], v[32:35], a[216:223], v3
  v_smfmac_f32_16x16x64_bf16 v[52:55], v[8:11], a[224:231], v3
  v_smfmac_f32_16x16x64_bf16 v[52:55], v[12:15], a[232:239], v3
  v_smfmac_f32_16x16x64_bf16 v[52:55], v[16:19], a[240:247], v3
  v_add_f32 v48, v48, v49
  v_smfmac_f32_16x16x64_bf16 v[52:55], v[20:23], a[248:255], v3
  v_add_f32 v50, v50, v51
  v_smfmac_f32_16x16x64_bf16 v[52:55], v[24:27], v[120:127], v3
  v_cvt_pk_bf16_f32 v48, v48, v50
  v_smfmac_f32_16x16x64_bf16 v[52:55], v[28:31], v[128:135], v3
  ds_write_b32 v103, v48
  v_smfmac_f32_16x16x64_bf16 v[52:55], v[32:35], v[136:143], v3
  v_smfmac_f32_16x16x64_bf16 v[56:59], v[8:11], v[144:151], v3
  v_smfmac_f32_16x16x64_bf16 v[56:59], v[12:15], v[152:159], v3
  v_smfmac_f32_16x16x64_bf16 v[56:59], v[16:19], v[160:167], v3
  v_add_f32 v52, v52, v53
  v_smfmac_f32_16x16x64_bf16 v[56:59], v[20:23], v[168:175], v3
  v_add_f32 v54, v54, v55
  v_smfmac_f32_16x16x64_bf16 v[56:59], v[24:27], v[176:183], v3
  v_cvt_pk_bf16_f32 v52, v52, v54
  v_smfmac_f32_16x16x64_bf16 v[56:59], v[28:31], v[184:191], v3
  ds_write_b32 v104, v52
  v_smfmac_f32_16x16x64_bf16 v[56:59], v[32:35], v[192:199], v3
  s_nop 7
  v_add_f32 v56, v56, v57
  v_add_f32 v58, v58, v59
  v_cvt_pk_bf16_f32 v56, v56, v58
  ds_write_b32 v105, v56
  s_waitcnt lgkmcnt(0)
  s_barrier
  s_cmp_eq_u32 s19, 62
  s_cbranch_scc1 cB_done
  s_waitcnt vmcnt(0) lgkmcnt(0)
  s_add_u32 s19, s19, 1
  s_mov_b32 s20, s21
  s_branch cB_va2_loop
cB_va2_retry:
  s_waitcnt lgkmcnt(0)
  buffer_load_dwordx4 v[8:11], v2, s[8:11], s20 offen offset:0 sc1
  buffer_load_dwordx4 v[12:15], v2, s[8:11], s20 offen offset:1024 sc1
  buffer_load_dwordx4 v[16:19], v2, s[8:11], s20 offen offset:2048 sc1
  buffer_load_dwordx4 v[20:23], v2, s[8:11], s20 offen offset:3072 sc1
  s_add_u32 s31, s31, 1
  s_add_u32 s30, s30, 1
  s_cmp_lt_u32 s30, 400000
  s_cbranch_scc1 cB_va2_ld
  s_branch cB_abort
cB_va2_last:
  s_waitcnt lgkmcnt(0)
  buffer_store_dwordx4 v[100:103], v2, s[8:11], s24 offen offset:0 sc1
  buffer_store_dwordx4 v[104:107], v2, s[8:11], s24 offen offset:1024 sc1
  buffer_store_dwordx4 v[108:111], v2, s[8:11], s24 offen offset:2048 sc1
  buffer_store_dwordx4 v[4:7], v2, s[8:11], s24 offen offset:3072 sc1
  s_add_u32 s24, s24, 8192
  s_waitcnt vmcnt(0)
  s_mov_b64 exec, 1
  buffer_store_dword v117, v2, s[8:11], s34 offen sc1
  s_mov_b64 exec, -1
  s_add_u32 s34, s34, 8
  s_mov_b64 exec, 1
  buffer_store_dword v117, v2, s[8:11], s34 offen sc1
  s_mov_b64 exec, -1
  s_add_u32 s34, s34, 8
  s_branch cB_done
.p2align 6

cB_va3_loop:
  s_add_u32 s23, s20, 4096
  s_add_u32 s21, s20, 20480
  v_mov_b32 v36, 0
  v_mov_b32 v37, 0
  v_mov_b32 v38, 0
  v_mov_b32 v39, 0
  v_mov_b32 v40, 0
  v_mov_b32 v41, 0
  v_mov_b32 v42, 0
  v_mov_b32 v43, 0
  v_mov_b32 v44, 0
  v_mov_b32 v45, 0
  v_mov_b32 v46, 0
  v_mov_b32 v47, 0
  v_mov_b32 v48, 0
  v_mov_b32 v49, 0
  v_mov_b32 v50, 0
  v_mov_b32 v51, 0
  v_mov_b32 v52, 0
  v_mov_b32 v53, 0
  v_mov_b32 v54, 0
  v_mov_b32 v55, 0
  v_mov_b32 v56, 0
  v_mov_b32 v57, 0
  v_mov_b32 v58, 0
  v_mov_b32 v59, 0
  v_mov_b32 v60, 0
  v_mov_b32 v61, 0
  v_mov_b32 v62, 0
  v_mov_b32 v63, 0
  v_mov_b32 v64, 0
  v_mov_b32 v65, 0
  v_mov_b32 v66, 0
  v_mov_b32 v67, 0
  s_mov_b32 s30, 0
  buffer_load_dword v76, v119, s[8:11], s20 offen sc1
  buffer_load_dword v77, v119, s[8:11], s20 offen sc1
  buffer_load_dword v78, v119, s[8:11], s20 offen sc1
cB_va3_fp_l:
  s_waitcnt vmcnt(2)
  v_cmp_eq_u32 vcc, -1, v76
  s_cbranch_vccz cB_va3_fp_d
  buffer_load_dword v76, v119, s[8:11], s20 offen sc1
  s_waitcnt vmcnt(2)
  v_cmp_eq_u32 vcc, -1, v77
  s_cbranch_vccz cB_va3_fp_d
  buffer_load_dword v77, v119, s[8:11], s20 offen sc1
  s_waitcnt vmcnt(2)
  v_cmp_eq_u32 vcc, -1, v78
  s_cbranch_vccz cB_va3_fp_d
  buffer_load_dword v78, v119, s[8:11], s20 offen sc1
  s_add_u32 s30, s30, 1
  s_cmp_lt_u32 s30, 400000
  s_cbranch_scc1 cB_va3_fp_l
  s_branch cB_abort
cB_va3_fp_d:
  buffer_load_dwordx4 v[24:27], v2, s[8:11], s23 offen offset:0 sc1
  buffer_load_dwordx4 v[28:31], v2, s[8:11], s23 offen offset:1024 sc1
  buffer_load_dwordx4 v[32:35], v2, s[8:11], s23 offen offset:2048 sc1
  s_barrier
cB_va3_ld:
  s_waitcnt vmcnt(0)
  v_max3_u32 v84, v24, v25, v26
  v_max3_u32 v84, v84, v27, v28
  v_max3_u32 v84, v84, v29, v30
  v_max3_u32 v84, v84, v31, v32
  v_max3_u32 v84, v84, v33, v34
  v_max_u32 v84, v84, v35
  v_cmp_eq_u32 vcc, -1, v84
  ds_write_b128 v2, v[24:27] offset:12288
  ds_write_b128 v2, v[28:31] offset:13312
  ds_write_b128 v2, v[32:35] offset:14336
  s_cbranch_vccnz cB_va3_retry
  s_waitcnt lgkmcnt(0)
  s_barrier
  ds_read_b128 v[8:11], v5 offset:8192
  ds_read_b128 v[12:15], v5 offset:9216
  ds_read_b128 v[16:19], v5 offset:10240
  ds_read_b128 v[20:23], v5 offset:11264
  ds_read_b128 v[24:27], v5 offset:12288
  ds_read_b128 v[28:31], v5 offset:13312
  ds_read_b128 v[32:35], v5 offset:14336
  s_waitcnt lgkmcnt(0)
  s_cmp_eq_u32 s19, 63
  s_cbranch_scc1 cB_done
  ds_read_b128 v[76:79], v1 offset:0
  ds_read_b128 v[80:83], v1 offset:1024
  ds_read_b128 v[84:87], v1 offset:2048
  ds_read_b128 v[88:91], v1 offset:3072
  ds_read_b128 v[92:95], v1 offset:4096
  ds_read_b128 v[96:99], v1 offset:5120
  v_smfmac_f32_16x16x64_bf16 v[60:63], v[8:11], v[200:207], v3
  v_smfmac_f32_16x16x64_bf16 v[60:63], v[12:15], v[208:215], v3
  s_waitcnt lgkmcnt(4)
  v_smfmac_f32_16x16x64_bf16 v[64:67], v[8:11], v[76:83], v3
  ds_read_b128 v[76:79], v1 offset:6144
  ds_read_b128 v[80:83], v1 offset:7168
  v_smfmac_f32_16x16x64_bf16 v[60:63], v[16:19], v[216:223], v3
  v_smfmac_f32_16x16x64_bf16 v[60:63], v[20:23], v[224:231], v3
  s_waitcnt lgkmcnt(4)
  v_smfmac_f32_16x16x64_bf16 v[64:67], v[12:15], v[84:91], v3
  ds_read_b128 v[84:87], v1 offset:8192
  ds_read_b128 v[88:91], v1 offset:9216
  v_smfmac_f32_16x16x64_bf16 v[60:63], v[24:27], v[232:239], v3
  v_smfmac_f32_16x16x64_bf16 v[60:63], v[28:31], v[240:247], v3
  s_waitcnt lgkmcnt(4)
  v_smfmac_f32_16x16x64_bf16 v[64:67], v[16:19], v[92:99], v3
  ds_read_b128 v[92:95], v1 offset:10240
  ds_read_b128 v[96:99], v1 offset:11264
  v_smfmac_f32_16x16x64_bf16 v[60:63], v[32:35], v[248:255], v3
  v_smfmac_f32_16x16x64_bf16 v[36:39], v[8:11], a[0:7], v3
  s_waitcnt lgkmcnt(4)
  v_smfmac_f32_16x16x64_bf16 v[64:67], v[20:23], v[76:83], v3
  ds_read_b128 v[76:79], v1 offset:12288
  ds_read_b128 v[80:83], v1 offset:13312
  v_smfmac_f32_16x16x64_bf16 v[36:39], v[12:15], a[8:15], v3
  v_add_f32 v60, v60, v61
  v_smfmac_f32_16x16x64_bf16 v[36:39], v[16:19], a[16:23], v3
  v_add_f32 v62, v62, v63
  s_waitcnt lgkmcnt(4)
  v_smfmac_f32_16x16x64_bf16 v[64:67], v[24:27], v[84:91], v3
  v_cvt_pk_bf16_f32 v60, v60, v62
  v_smfmac_f32_16x16x64_bf16 v[36:39], v[20:23], a[24:31], v3
  ds_write_b32 v106, v60
  v_smfmac_f32_16x16x64_bf16 v[36:39], v[24:27], a[32:39], v3
  s_waitcnt lgkmcnt(2)
  v_smfmac_f32_16x16x64_bf16 v[64:67], v[28:31], v[92:99], v3
  v_smfmac_f32_16x16x64_bf16 v[36:39], v[28:31], a[40:47], v3
  v_smfmac_f32_16x16x64_bf16 v[36:39], v[32:35], a[48:55], v3
  s_waitcnt lgkmcnt(0)
  v_smfmac_f32_16x16x64_bf16 v[64:67], v[32:35], v[76:83], v3
  v_smfmac_f32_16x16x64_bf16 v[40:43], v[8:11], a[56:63], v3
  v_smfmac_f32_16x16x64_bf16 v[40:43], v[12:15], a[64:71], v3
  v_add_f32 v36, v36, v37
  v_smfmac_f32_16x16x64_bf16 v[40:43], v[16:19], a[72:79], v3
  v_add_f32 v38, v38, v39
  v_smfmac_f32_16x16x64_bf16 v[40:43], v[20:23], a[80:87], v3
  v_cvt_pk_bf16_f32 v36, v36, v38
  v_smfmac_f32_16x16x64_bf16 v[40:43], v[24:27], a[88:95], v3
  ds_write_b32 v100, v36
  v_smfmac_f32_16x16x64_bf16 v[40:43], v[28:31], a[96:103], v3
  v_add_f32 v64, v64, v65
  v_smfmac_f32_16x16x64_bf16 v[40:43], v[32:35], a[104:111], v3
  v_add_f32 v66, v66, v67
  v_smfmac_f32_16x16x64_bf16 v[44:47], v[8:11], a[112:119], v3
  v_cvt_pk_bf16_f32 v64, v64, v66
  v_smfmac_f32_16x16x64_bf16 v[44:47], v[12:15], a[120:127], v3
  ds_write_b32 v107, v64
  v_smfmac_f32_16x16x64_bf16 v[44:47], v[16:19], a[128:135], v3
  v_add_f32 v40, v40, v41
  v_smfmac_f32_16x16x64_bf16 v[44:47], v[20:23], a[136:143], v3
  v_add_f32 v42, v42, v43
  v_smfmac_f32_16x16x64_bf16 v[44:47], v[24:27], a[144:151], v3
  v_cvt_pk_bf16_f32 v40, v40, v42
  v_smfmac_f32_16x16x64_bf16 v[44:47], v[28:31], a[152:159], v3
  ds_write_b32 v101, v40
  v_smfmac_f32_16x16x64_bf16 v[44:47], v[32:35], a[160:167], v3
  v_smfmac_f32_16x16x64_bf16 v[48:51], v[8:11], a[168:175], v3
  v_smfmac_f32_16x16x64_bf16 v[48:51], v[12:15], a[176:183], v3
  v_smfmac_f32_16x16x64_bf16 v[48:51], v[16:19], a[184:191], v3
  v_add_f32 v44, v44, v45
  v_smfmac_f32_16x16x64_bf16 v[48:51], v[20:23], a[192:199], v3
  v_add_f32 v46, v46, v47
  v_smfmac_f32_16x16x64_bf16 v[48:51], v[24:27], a[200:207], v3
  v_cvt_pk_bf16_f32 v44, v44, v46
  v_smfmac_f32_16x16x64_bf16 v[48:51], v[28:31], a[208:215], v3
  ds_write_b32 v102, v44
  v_smfmac_f32_16x16x64_bf16 v[48:51], v[32:35], a[216:223], v3
  v_smfmac_f32_16x16x64_bf16 v[52:55], v[8:11], a[224:231], v3
  v_smfmac_f32_16x16x64_bf16 v[52:55], v[12:15], a[232:239], v3
  v_smfmac_f32_16x16x64_bf16 v[52:55], v[16:19], a[240:247], v3
  v_add_f32 v48, v48, v49
  v_smfmac_f32_16x16x64_bf16 v[52:55], v[20:23], a[248:255], v3
  v_add_f32 v50, v50, v51
  v_smfmac_f32_16x16x64_bf16 v[52:55], v[24:27], v[120:127], v3
  v_cvt_pk_bf16_f32 v48, v48, v50
  v_smfmac_f32_16x16x64_bf16 v[52:55], v[28:31], v[128:135], v3
  ds_write_b32 v103, v48
  v_smfmac_f32_16x16x64_bf16 v[52:55], v[32:35], v[136:143], v3
  v_smfmac_f32_16x16x64_bf16 v[56:59], v[8:11], v[144:151], v3
  v_smfmac_f32_16x16x64_bf16 v[56:59], v[12:15], v[152:159], v3
  v_smfmac_f32_16x16x64_bf16 v[56:59], v[16:19], v[160:167], v3
  v_add_f32 v52, v52, v53
  v_smfmac_f32_16x16x64_bf16 v[56:59], v[20:23], v[168:175], v3
  v_add_f32 v54, v54, v55
  v_smfmac_f32_16x16x64_bf16 v[56:59], v[24:27], v[176:183], v3
  v_cvt_pk_bf16_f32 v52, v52, v54
  v_smfmac_f32_16x16x64_bf16 v[56:59], v[28:31], v[184:191], v3
  ds_write_b32 v104, v52
  v_smfmac_f32_16x16x64_bf16 v[56:59], v[32:35], v[192:199], v3
  s_nop 7
  v_add_f32 v56, v56, v57
  v_add_f32 v58, v58, v59
  v_cvt_pk_bf16_f32 v56, v56, v58
  ds_write_b32 v105, v56
  s_waitcnt lgkmcnt(0)
  s_barrier
  s_cmp_eq_u32 s19, 62
  s_cbranch_scc1 cB_done
  s_waitcnt vmcnt(0) lgkmcnt(0)
  s_add_u32 s19, s19, 1
  s_mov_b32 s20, s21
  s_branch cB_va3_loop
cB_va3_retry:
  s_waitcnt lgkmcnt(0)
  buffer_load_dwordx4 v[24:27], v2, s[8:11], s23 offen offset:0 sc1
  buffer_load_dwordx4 v[28:31], v2, s[8:11], s23 offen offset:1024 sc1
  buffer_load_dwordx4 v[32:35], v2, s[8:11], s23 offen offset:2048 sc1
  s_add_u32 s31, s31, 1
  s_add_u32 s30, s30, 1
  s_cmp_lt_u32 s30, 400000
  s_cbranch_scc1 cB_va3_ld
  s_branch cB_abort
cB_va3_last:
  s_waitcnt lgkmcnt(0)
  buffer_store_dwordx4 v[100:103], v2, s[8:11], s24 offen offset:0 sc1
  buffer_store_dwordx4 v[104:107], v2, s[8:11], s24 offen offset:1024 sc1
  buffer_store_dwordx4 v[108:111], v2, s[8:11], s24 offen offset:2048 sc1
  buffer_store_dwordx4 v[4:7], v2, s[8:11], s24 offen offset:3072 sc1
  s_add_u32 s24, s24, 8192
  s_waitcnt vmcnt(0)
  s_mov_b64 exec, 1
  buffer_store_dword v117, v2, s[8:11], s34 offen sc1
  s_mov_b64 exec, -1
  s_add_u32 s34, s34, 8
  s_mov_b64 exec, 1
  buffer_store_dword v117, v2, s[8:11], s34 offen sc1
  s_mov_b64 exec, -1
  s_add_u32 s34, s34, 8
  s_branch cB_done
cB_abort:
  v_mov_b32 v4, 0xdead
  v_mov_b32 v5, 16
  buffer_store_dword v4, v5, s[12:15], 0 offen
  s_branch ch_end
cB_done:
  s_branch ch_end
m_reclaim:
  s_waitcnt vmcnt(0)
  s_lshr_b32 s20, s3, 5
  s_cmp_lg_u32 s16, 0
  s_cbranch_scc1 w0_17
  s_mov_b32 s21, 0
  s_mov_b64 exec, 1
rc_l:
  s_cmp_lg_u32 s70, -1
  s_cbranch_scc1 rc_t
  s_add_u32 s20, s20, 1
  s_cmp_lt_u32 s20, 8
  s_cselect_b32 s20, s20, 0
  s_mov_b32 s70, 0
  s_mov_b32 s3, -1
  s_add_u32 s21, s21, 1
  s_cmp_ge_u32 s21, 9
  s_cbranch_scc1 rc_d
rc_t:
  s_ff0_i32_b32 s22, s70
  s_lshl_b32 s23, 1, s22
  s_and_b32 s71, s20, 4
  s_mul_i32 s71, s71, 12
  s_lshl_b32 s3, s20, 2
  s_add_u32 s3, s3, s71
  v_mov_b32 v242, s23
  v_mov_b32 v243, 32
  buffer_atomic_or v242, v243, s[12:15], s3 offen sc0
  s_waitcnt vmcnt(0)
  v_readfirstlane_b32 s70, v242
  s_lshl_b32 s3, s20, 5
  s_add_u32 s3, s3, s22
  s_bitcmp1_b32 s70, s22
  s_cbranch_scc1 rc_l
rc_d:
  s_mov_b64 exec, -1
  v_mov_b32 v242, s3
w0_17:
  v_mov_b32 v250, 160000
  s_add_u32 s101, s101, 1
  s_barrier
  s_mov_b64 exec, 1
  s_cmp_lg_u32 s16, 0
  s_cbranch_scc1 w0_18
  ds_write_b32 v250, v242 offset:0
  s_waitcnt lgkmcnt(0)
  v_mov_b32 v242, s101
  ds_write_b32 v250, v242 offset:16
  s_waitcnt lgkmcnt(0)
w0_18:
  s_mov_b64 exec, -1
  s_barrier
  ds_read_b32 v242, v250 offset:0
  ds_read_b32 v250, v250 offset:16
  s_waitcnt lgkmcnt(0)
  v_readfirstlane_b32 s3, v242
  v_cmp_ne_u32 vcc, s101, v250
  s_cbranch_vccnz ch_end
  s_cmp_lg_u32 s3, -1
  s_cbranch_scc1 m_start
  v_mov_b32 v250, 0
  s_branch wk_ask
m_bjob:
  v_and_b32 v1, 63, v0
  v_lshlrev_b32 v2, 4, v1
  v_lshrrev_b32 v3, 4, v1
  v_and_b32 v4, 15, v1
  s_sub_u32 s18, s3, 32
  s_mul_i32 s17, s18, 4682
  s_lshr_b32 s17, s17, 16
  s_mul_i32 s20, s17, 14
  s_sub_u32 s19, s18, s20
  s_cmp_ge_u32 s19, 7
  s_cselect_b32 s31, 7, 0
  s_sub_u32 s19, s19, s31
  s_mov_b32 s60, s44
  s_and_b32 s61, s45, 0xffff
  s_mov_b32 s62, 3670016
  s_mov_b32 s63, 0x20000
  s_mov_b32 s56, s46
  s_and_b32 s57, s47, 0xffff
  s_mov_b32 s58, 3670016
  s_mov_b32 s59, 0x20000
  s_lshl_b32 s30, s16, 13
  s_mul_i32 s27, s17, 229376
  s_lshl_b32 s29, s19, 7
  s_add_u32 s27, s27, s29
  v_lshrrev_b32 v7, 3, v1
  v_and_b32 v8, 7, v1
  v_and_b32 v9, 2, v7
  v_xor_b32 v8, v8, v9
  s_lshl_b32 s29, s16, 6
  v_add_u32 v7, s29, v7
  v_mul_u32_u24 v7, 896, v7
  v_lshl_add_u32 v7, v8, 4, v7
  v_xor_b32 v8, 64, v7
  s_add_u32 m0, s30, 0
  s_add_u32 s22, s27, 0
  buffer_load_dwordx4 v7, s[56:59], s22 offen offset:0 lds
  s_add_u32 s22, s27, 6144
  buffer_load_dwordx4 v8, s[56:59], s22 offen offset:1024 lds
  s_add_u32 s22, s27, 12288
  buffer_load_dwordx4 v7, s[56:59], s22 offen offset:2048 lds
  s_add_u32 s22, s27, 18432
  buffer_load_dwordx4 v8, s[56:59], s22 offen offset:3072 lds
  s_add_u32 m0, s30, 4096
  s_add_u32 s22, s27, 28672
  buffer_load_dwordx4 v7, s[56:59], s22 offen offset:0 lds
  s_add_u32 s22, s27, 34816
  buffer_load_dwordx4 v8, s[56:59], s22 offen offset:1024 lds
  s_add_u32 s22, s27, 40960
  buffer_load_dwordx4 v7, s[56:59], s22 offen offset:2048 lds
  s_add_u32 s22, s27, 47104
  buffer_load_dwordx4 v8, s[56:59], s22 offen offset:3072 lds
  v_lshrrev_b32 v5, 5, v1
  v_and_b32 v6, 31, v1
  s_lshl_b32 s25, s16, 15
  s_add_u32 s25, s25, 32768
  s_lshl_b32 s26, s17, 9
  s_add_u32 s28, s19, s16
  s_cmp_ge_u32 s28, 7
  s_cselect_b32 s20, 7, 0
  s_sub_u32 s28, s28, s20
  s_add_u32 s28, s28, s31
  s_add_u32 s29, s19, s16
  s_add_u32 s29, s29, 4
  s_cmp_ge_u32 s29, 7
  s_cselect_b32 s20, 7, 0
  s_sub_u32 s29, s29, s20
  s_add_u32 s29, s29, s31
  s_lshl_b32 s32, s28, 18
  s_add_u32 s32, s32, s26
  s_lshl_b32 s33, s29, 18
  s_add_u32 s33, s33, s26
  v_xor_b32 v8, v6, v5
  v_lshlrev_b32 v8, 4, v8
  v_lshl_add_u32 v8, v5, 13, v8
  v_xor_b32 v12, 0, v8
  v_xor_b32 v13, 32, v8
  v_add_u32 v13, 15360, v13
  v_xor_b32 v14, 0, v8
  v_add_u32 v14, 30720, v14
  v_xor_b32 v15, 32, v8
  v_add_u32 v15, 46080, v15
  s_add_u32 s20, s16, 0
  s_and_b32 s20, s20, 3
  s_mul_i32 s21, s20, 65600
  s_lshl_b32 s20, s20, 12
  s_add_u32 s48, s20, s25
  s_mov_b32 m0, s48
  v_xor_b32 v16, s21, v12
  buffer_load_dwordx4 v16, s[60:63], s32 offen offset:0 lds
  v_xor_b32 v17, s21, v13
  buffer_load_dwordx4 v17, s[60:63], s32 offen offset:1024 lds
  v_xor_b32 v18, s21, v14
  buffer_load_dwordx4 v18, s[60:63], s32 offen offset:2048 lds
  v_xor_b32 v19, s21, v15
  buffer_load_dwordx4 v19, s[60:63], s32 offen offset:3072 lds
  s_add_u32 s20, s16, 1
  s_and_b32 s20, s20, 3
  s_mul_i32 s21, s20, 65600
  s_lshl_b32 s20, s20, 12
  s_add_u32 s49, s20, s25
  s_mov_b32 m0, s49
  v_xor_b32 v20, s21, v12
  buffer_load_dwordx4 v20, s[60:63], s32 offen offset:0 lds
  v_xor_b32 v21, s21, v13
  buffer_load_dwordx4 v21, s[60:63], s32 offen offset:1024 lds
  v_xor_b32 v22, s21, v14
  buffer_load_dwordx4 v22, s[60:63], s32 offen offset:2048 lds
  v_xor_b32 v23, s21, v15
  buffer_load_dwordx4 v23, s[60:63], s32 offen offset:3072 lds
  s_add_u32 s20, s16, 2
  s_and_b32 s20, s20, 3
  s_mul_i32 s21, s20, 65600
  s_lshl_b32 s20, s20, 12
  s_add_u32 s50, s20, s25
  s_mov_b32 m0, s50
  v_xor_b32 v24, s21, v12
  buffer_load_dwordx4 v24, s[60:63], s32 offen offset:0 lds
  v_xor_b32 v25, s21, v13
  buffer_load_dwordx4 v25, s[60:63], s32 offen offset:1024 lds
  v_xor_b32 v26, s21, v14
  buffer_load_dwordx4 v26, s[60:63], s32 offen offset:2048 lds
  v_xor_b32 v27, s21, v15
  buffer_load_dwordx4 v27, s[60:63], s32 offen offset:3072 lds
  s_add_u32 s20, s16, 3
  s_and_b32 s20, s20, 3
  s_mul_i32 s21, s20, 65600
  s_lshl_b32 s20, s20, 12
  s_add_u32 s51, s20, s25
  s_mov_b32 m0, s51
  v_xor_b32 v28, s21, v12
  buffer_load_dwordx4 v28, s[60:63], s32 offen offset:0 lds
  v_xor_b32 v29, s21, v13
  buffer_load_dwordx4 v29, s[60:63], s32 offen offset:1024 lds
  v_xor_b32 v30, s21, v14
  buffer_load_dwordx4 v30, s[60:63], s32 offen offset:2048 lds
  v_xor_b32 v31, s21, v15
  buffer_load_dwordx4 v31, s[60:63], s32 offen offset:3072 lds
  s_cmp_lg_u32 s66, 0
  s_cbranch_scc1 bj_ci
  s_cmp_lg_u32 s16, 0
  s_cbranch_scc1 w0_19
  s_lshr_b32 s70, s3, 5
  s_and_b32 s71, s70, 4
  s_mul_i32 s71, s71, 12
  s_lshl_b32 s70, s70, 2
  s_add_u32 s70, s70, s71
  s_lshl_b32 s71, 1, s3
  v_mov_b32 v44, s71
  v_mov_b32 v45, 32
  s_mov_b64 exec, 1
  buffer_atomic_or v44, v45, s[12:15], s70 offen sc0
  buffer_load_dwordx2 v[46:47], v45, s[12:15], 0 offen offset:96 sc1
  s_mov_b64 exec, -1
w0_19:
bj_ci:
  s_lshl_b32 s30, s19, 6
  s_add_u32 s30, s30, 0
  s_cmp_lt_u32 s19, 4
  s_cselect_b32 s20, 0, 256
  s_sub_u32 s30, s30, s20
  v_add_u32 v8, s30, v4
  s_lshr_b32 s20, s20, 4
  s_cmp_lt_u32 s19, 4
  s_movk_i32 s21, 5462
  s_cselect_b32 s21, 4096, s21
  s_cselect_b32 s30, 16, 12
  v_mul_u32_u24 v10, s21, v8
  v_lshrrev_b32 v10, 16, v10
  v_mul_u32_u24 v11, s30, v10
  v_sub_u32 v32, v8, v11
  v_add_u32 v32, s20, v32
  s_lshl_b32 s30, s17, 4
  s_mul_i32 s20, s17, 12
  s_add_u32 s20, s20, 240
  s_cmp_lt_u32 s19, 4
  s_cselect_b32 s30, s30, s20
  v_add_u32 v32, s30, v32
  v_lshrrev_b32 v33, 4, v32
  v_and_b32 v32, 15, v32
  s_mov_b32 s30, 401408
  v_mul_lo_u32 v10, v10, s30
  v_mul_u32_u24 v33, 14336, v33
  v_add_u32 v10, v10, v33
  v_lshl_add_u32 v10, v3, 8, v10
  v_lshl_add_u32 v10, v32, 4, v10
  v_add_u32 v12, 6422528, v10
  s_lshl_b32 s30, s19, 6
  s_add_u32 s30, s30, 16
  s_cmp_lt_u32 s19, 4
  s_cselect_b32 s20, 0, 256
  s_sub_u32 s30, s30, s20
  v_add_u32 v8, s30, v4
  s_lshr_b32 s20, s20, 4
  s_cmp_lt_u32 s19, 4
  s_movk_i32 s21, 5462
  s_cselect_b32 s21, 4096, s21
  s_cselect_b32 s30, 16, 12
  v_mul_u32_u24 v10, s21, v8
  v_lshrrev_b32 v10, 16, v10
  v_mul_u32_u24 v11, s30, v10
  v_sub_u32 v32, v8, v11
  v_add_u32 v32, s20, v32
  s_lshl_b32 s30, s17, 4
  s_mul_i32 s20, s17, 12
  s_add_u32 s20, s20, 240
  s_cmp_lt_u32 s19, 4
  s_cselect_b32 s30, s30, s20
  v_add_u32 v32, s30, v32
  v_lshrrev_b32 v33, 4, v32
  v_and_b32 v32, 15, v32
  s_mov_b32 s30, 401408
  v_mul_lo_u32 v10, v10, s30
  v_mul_u32_u24 v33, 14336, v33
  v_add_u32 v10, v10, v33
  v_lshl_add_u32 v10, v3, 8, v10
  v_lshl_add_u32 v10, v32, 4, v10
  v_add_u32 v13, 6422528, v10
  s_lshl_b32 s30, s19, 6
  s_add_u32 s30, s30, 32
  s_cmp_lt_u32 s19, 4
  s_cselect_b32 s20, 0, 256
  s_sub_u32 s30, s30, s20
  v_add_u32 v8, s30, v4
  s_lshr_b32 s20, s20, 4
  s_cmp_lt_u32 s19, 4
  s_movk_i32 s21, 5462
  s_cselect_b32 s21, 4096, s21
  s_cselect_b32 s30, 16, 12
  v_mul_u32_u24 v10, s21, v8
  v_lshrrev_b32 v10, 16, v10
  v_mul_u32_u24 v11, s30, v10
  v_sub_u32 v32, v8, v11
  v_add_u32 v32, s20, v32
  s_lshl_b32 s30, s17, 4
  s_mul_i32 s20, s17, 12
  s_add_u32 s20, s20, 240
  s_cmp_lt_u32 s19, 4
  s_cselect_b32 s30, s30, s20
  v_add_u32 v32, s30, v32
  v_lshrrev_b32 v33, 4, v32
  v_and_b32 v32, 15, v32
  s_mov_b32 s30, 401408
  v_mul_lo_u32 v10, v10, s30
  v_mul_u32_u24 v33, 14336, v33
  v_add_u32 v10, v10, v33
  v_lshl_add_u32 v10, v3, 8, v10
  v_lshl_add_u32 v10, v32, 4, v10
  v_add_u32 v14, 6422528, v10
  s_lshl_b32 s30, s19, 6
  s_add_u32 s30, s30, 48
  s_cmp_lt_u32 s19, 4
  s_cselect_b32 s20, 0, 256
  s_sub_u32 s30, s30, s20
  v_add_u32 v8, s30, v4
  s_lshr_b32 s20, s20, 4
  s_cmp_lt_u32 s19, 4
  s_movk_i32 s21, 5462
  s_cselect_b32 s21, 4096, s21
  s_cselect_b32 s30, 16, 12
  v_mul_u32_u24 v10, s21, v8
  v_lshrrev_b32 v10, 16, v10
  v_mul_u32_u24 v11, s30, v10
  v_sub_u32 v32, v8, v11
  v_add_u32 v32, s20, v32
  s_lshl_b32 s30, s17, 4
  s_mul_i32 s20, s17, 12
  s_add_u32 s20, s20, 240
  s_cmp_lt_u32 s19, 4
  s_cselect_b32 s30, s30, s20
  v_add_u32 v32, s30, v32
  v_lshrrev_b32 v33, 4, v32
  v_and_b32 v32, 15, v32
  s_mov_b32 s30, 401408
  v_mul_lo_u32 v10, v10, s30
  v_mul_u32_u24 v33, 14336, v33
  v_add_u32 v10, v10, v33
  v_lshl_add_u32 v10, v3, 8, v10
  v_lshl_add_u32 v10, v32, 4, v10
  v_add_u32 v15, 6422528, v10
  v_lshrrev_b32 v7, 2, v4
  v_lshlrev_b32 v7, 3, v7
  v_and_b32 v8, 3, v4
  v_add_u32 v7, v7, v8
  v_xor_b32 v10, v3, v4
  v_lshlrev_b32 v10, 4, v10
  v_lshl_add_u32 v10, v7, 9, v10
  v_add_u32 v10, s25, v10
  v_xor_b32 v32, 0, v10
  v_xor_b32 v33, 64, v10
  v_xor_b32 v34, 128, v10
  v_xor_b32 v35, 192, v10
  v_lshrrev_b32 v7, 2, v4
  v_lshl_add_u32 v7, v3, 3, v7
  v_lshlrev_b32 v7, 7, v7
  v_and_b32 v8, 3, v4
  v_lshl_add_u32 v7, v8, 3, v7
  v_lshrrev_b32 v8, 3, v4
  v_lshl_add_u32 v7, v8, 5, v7
  v_and_b32 v8, 1, v3
  v_lshl_add_u32 v7, v8, 6, v7
  s_waitcnt vmcnt(16)
  s_barrier
  s_cmp_eq_u32 s16, 3
  s_cbranch_scc1 bj_np0
  s_add_u32 m0, s48, 16384
  s_nop 0
  buffer_load_dwordx4 v16, s[60:63], s33 offen offset:0 lds
  buffer_load_dwordx4 v17, s[60:63], s33 offen offset:1024 lds
  buffer_load_dwordx4 v18, s[60:63], s33 offen offset:2048 lds
  buffer_load_dwordx4 v19, s[60:63], s33 offen offset:3072 lds
bj_np0:
  v_xor_b32 v9, 0, v7
  ds_read_b64_tr_b16 v[128:129], v9 offset:0
  ds_read_b64_tr_b16 v[130:131], v9 offset:512
  ds_read_b64_tr_b16 v[132:133], v9 offset:4096
  ds_read_b64_tr_b16 v[134:135], v9 offset:4608
  ds_read_b64_tr_b16 v[136:137], v9 offset:8192
  ds_read_b64_tr_b16 v[138:139], v9 offset:8704
  ds_read_b64_tr_b16 v[140:141], v9 offset:12288
  ds_read_b64_tr_b16 v[142:143], v9 offset:12800
  s_waitcnt lgkmcnt(6)
  ds_read_b64_tr_b16 v[144:145], v9 offset:16384
  ds_read_b64_tr_b16 v[146:147], v9 offset:16896
  ds_read_b64_tr_b16 v[148:149], v9 offset:20480
  ds_read_b64_tr_b16 v[150:151], v9 offset:20992
  ds_read_b64_tr_b16 v[152:153], v9 offset:24576
  ds_read_b64_tr_b16 v[154:155], v9 offset:25088
  ds_read_b64_tr_b16 v[156:157], v9 offset:28672
  ds_read_b64_tr_b16 v[158:159], v9 offset:29184
  s_waitcnt lgkmcnt(6)
  s_cmp_eq_u32 s16, 3
  s_cbranch_scc1 bj_np1
  s_add_u32 m0, s49, 16384
  s_nop 0
  buffer_load_dwordx4 v20, s[60:63], s33 offen offset:0 lds
  buffer_load_dwordx4 v21, s[60:63], s33 offen offset:1024 lds
  buffer_load_dwordx4 v22, s[60:63], s33 offen offset:2048 lds
  buffer_load_dwordx4 v23, s[60:63], s33 offen offset:3072 lds
bj_np1:
  v_xor_b32 v9, 32, v7
  ds_read_b64_tr_b16 v[160:161], v9 offset:0
  ds_read_b64_tr_b16 v[162:163], v9 offset:512
  ds_read_b64_tr_b16 v[164:165], v9 offset:4096
  ds_read_b64_tr_b16 v[166:167], v9 offset:4608
  ds_read_b64_tr_b16 v[168:169], v9 offset:8192
  ds_read_b64_tr_b16 v[170:171], v9 offset:8704
  ds_read_b64_tr_b16 v[172:173], v9 offset:12288
  ds_read_b64_tr_b16 v[174:175], v9 offset:12800
  s_waitcnt lgkmcnt(6)
  ds_read_b64_tr_b16 v[176:177], v9 offset:16384
  ds_read_b64_tr_b16 v[178:179], v9 offset:16896
  ds_read_b64_tr_b16 v[180:181], v9 offset:20480
  ds_read_b64_tr_b16 v[182:183], v9 offset:20992
  ds_read_b64_tr_b16 v[184:185], v9 offset:24576
  ds_read_b64_tr_b16 v[186:187], v9 offset:25088
  ds_read_b64_tr_b16 v[188:189], v9 offset:28672
  ds_read_b64_tr_b16 v[190:191], v9 offset:29184
  s_waitcnt lgkmcnt(6)
  s_cmp_eq_u32 s16, 3
  s_cbranch_scc1 bj_np2
  s_add_u32 m0, s50, 16384
  s_nop 0
  buffer_load_dwordx4 v24, s[60:63], s33 offen offset:0 lds
  buffer_load_dwordx4 v25, s[60:63], s33 offen offset:1024 lds
  buffer_load_dwordx4 v26, s[60:63], s33 offen offset:2048 lds
  buffer_load_dwordx4 v27, s[60:63], s33 offen offset:3072 lds
bj_np2:
  v_xor_b32 v9, 64, v7
  ds_read_b64_tr_b16 v[192:193], v9 offset:0
  ds_read_b64_tr_b16 v[194:195], v9 offset:512
  ds_read_b64_tr_b16 v[196:197], v9 offset:4096
  ds_read_b64_tr_b16 v[198:199], v9 offset:4608
  ds_read_b64_tr_b16 v[200:201], v9 offset:8192
  ds_read_b64_tr_b16 v[202:203], v9 offset:8704
  ds_read_b64_tr_b16 v[204:205], v9 offset:12288
  ds_read_b64_tr_b16 v[206:207], v9 offset:12800
  s_waitcnt lgkmcnt(6)
  ds_read_b64_tr_b16 v[208:209], v9 offset:16384
  ds_read_b64_tr_b16 v[210:211], v9 offset:16896
  ds_read_b64_tr_b16 v[212:213], v9 offset:20480
  ds_read_b64_tr_b16 v[214:215], v9 offset:20992
  ds_read_b64_tr_b16 v[216:217], v9 offset:24576
  ds_read_b64_tr_b16 v[218:219], v9 offset:25088
  ds_read_b64_tr_b16 v[220:221], v9 offset:28672
  ds_read_b64_tr_b16 v[222:223], v9 offset:29184
  s_waitcnt lgkmcnt(6)
  s_cmp_eq_u32 s16, 3
  s_cbranch_scc1 bj_np3
  s_add_u32 m0, s51, 16384
  s_nop 0
  buffer_load_dwordx4 v28, s[60:63], s33 offen offset:0 lds
  buffer_load_dwordx4 v29, s[60:63], s33 offen offset:1024 lds
  buffer_load_dwordx4 v30, s[60:63], s33 offen offset:2048 lds
  buffer_load_dwordx4 v31, s[60:63], s33 offen offset:3072 lds
bj_np3:
  v_xor_b32 v9, 96, v7
  ds_read_b64_tr_b16 v[224:225], v9 offset:0
  ds_read_b64_tr_b16 v[226:227], v9 offset:512
  ds_read_b64_tr_b16 v[228:229], v9 offset:4096
  ds_read_b64_tr_b16 v[230:231], v9 offset:4608
  ds_read_b64_tr_b16 v[232:233], v9 offset:8192
  ds_read_b64_tr_b16 v[234:235], v9 offset:8704
  ds_read_b64_tr_b16 v[236:237], v9 offset:12288
  ds_read_b64_tr_b16 v[238:239], v9 offset:12800
  s_waitcnt lgkmcnt(6)
  ds_read_b64_tr_b16 v[240:241], v9 offset:16384
  ds_read_b64_tr_b16 v[242:243], v9 offset:16896
  ds_read_b64_tr_b16 v[244:245], v9 offset:20480
  ds_read_b64_tr_b16 v[246:247], v9 offset:20992
  ds_read_b64_tr_b16 v[248:249], v9 offset:24576
  ds_read_b64_tr_b16 v[250:251], v9 offset:25088
  ds_read_b64_tr_b16 v[252:253], v9 offset:28672
  ds_read_b64_tr_b16 v[254:255], v9 offset:29184
  s_waitcnt lgkmcnt(6)
  s_mov_b32 s52, s36
  s_and_b32 s53, s37, 0xffff
  s_mov_b32 s54, 1835008
  s_mov_b32 s55, 0x20000
  s_lshl_b32 s20, s18, 8
  v_add_u32 v95, s20, v0
  s_mov_b32 s21, 9586981
  v_mul_hi_u32 v6, v95, s21
  v_mul_u32_u24 v7, 448, v6
  v_sub_u32 v7, v95, v7
  v_lshrrev_b32 v8, 4, v7
  v_and_b32 v7, 15, v7
  v_lshl_add_u32 v9, v6, 4, v7
  v_mul_u32_u24 v9, 896, v9
  v_lshl_add_u32 v9, v8, 5, v9
  buffer_load_dwordx4 v[84:87], v9, s[52:55], 0 offen
  buffer_load_dwordx4 v[88:91], v9, s[52:55], 0 offen offset:16
  v_mul_u32_u24 v6, 14336, v6
  v_lshl_add_u32 v6, v7, 4, v6
  v_lshl_add_u32 v92, v8, 9, v6
  v_lshrrev_b32 v7, 2, v8
  v_lshl_add_u32 v6, v7, 11, v6
  v_and_b32 v7, 3, v8
  v_lshl_add_u32 v93, v7, 8, v6
  s_mov_b32 s72, s38
  s_and_b32 s73, s39, 0xffff
  s_mov_b32 s74, 7168
  s_mov_b32 s75, 0x20000
  v_min_u32 v6, 223, v0
  v_lshrrev_b32 v7, 3, v6
  v_and_b32 v6, 7, v6
  v_mul_u32_u24 v9, 896, v6
  v_lshl_add_u32 v9, v7, 5, v9
  buffer_load_dwordx4 v[36:39], v9, s[72:75], 0 offen
  buffer_load_dwordx4 v[40:43], v9, s[72:75], 0 offen offset:16
  v_lshlrev_b32 v7, 8, v7
  v_lshl_add_u32 v94, v6, 4, v7
  s_lshl_b32 s26, s17, 9
  s_waitcnt vmcnt(20) lgkmcnt(0)
  s_cmp_lg_u32 s16, 3
  s_cbranch_scc1 w3_20
  s_waitcnt vmcnt(4)
w3_20:
  ds_read_b128 v[52:55], v32 offset:0
  ds_read_b128 v[56:59], v33 offset:0
  ds_read_b128 v[60:63], v34 offset:0
  ds_read_b128 v[64:67], v35 offset:0
  s_waitcnt lgkmcnt(3)
  v_mfma_f32_16x16x32_bf16 v[96:99], v[52:55], v[128:131], 0
  v_mfma_f32_16x16x32_bf16 v[100:103], v[52:55], v[160:163], 0
  v_mfma_f32_16x16x32_bf16 v[104:107], v[52:55], v[192:195], 0
  v_mfma_f32_16x16x32_bf16 v[108:111], v[52:55], v[224:227], 0
  ds_read_b128 v[52:55], v32 offset:256
  s_waitcnt lgkmcnt(3)
  v_mfma_f32_16x16x32_bf16 v[96:99], v[56:59], v[132:135], v[96:99]
  v_mfma_f32_16x16x32_bf16 v[100:103], v[56:59], v[164:167], v[100:103]
  v_mfma_f32_16x16x32_bf16 v[104:107], v[56:59], v[196:199], v[104:107]
  v_mfma_f32_16x16x32_bf16 v[108:111], v[56:59], v[228:231], v[108:111]
  ds_read_b128 v[56:59], v33 offset:256
  s_waitcnt lgkmcnt(3)
  v_mfma_f32_16x16x32_bf16 v[96:99], v[60:63], v[136:139], v[96:99]
  v_mfma_f32_16x16x32_bf16 v[100:103], v[60:63], v[168:171], v[100:103]
  v_mfma_f32_16x16x32_bf16 v[104:107], v[60:63], v[200:203], v[104:107]
  v_mfma_f32_16x16x32_bf16 v[108:111], v[60:63], v[232:235], v[108:111]
  ds_read_b128 v[60:63], v34 offset:256
  s_waitcnt lgkmcnt(3)
  v_mfma_f32_16x16x32_bf16 v[96:99], v[64:67], v[140:143], v[96:99]
  v_mfma_f32_16x16x32_bf16 v[100:103], v[64:67], v[172:175], v[100:103]
  v_mfma_f32_16x16x32_bf16 v[104:107], v[64:67], v[204:207], v[104:107]
  v_mfma_f32_16x16x32_bf16 v[108:111], v[64:67], v[236:239], v[108:111]
  ds_read_b128 v[64:67], v35 offset:256
  s_waitcnt lgkmcnt(3)
  v_mfma_f32_16x16x32_bf16 v[96:99], v[52:55], v[144:147], v[96:99]
  v_mfma_f32_16x16x32_bf16 v[100:103], v[52:55], v[176:179], v[100:103]
  v_mfma_f32_16x16x32_bf16 v[104:107], v[52:55], v[208:211], v[104:107]
  v_mfma_f32_16x16x32_bf16 v[108:111], v[52:55], v[240:243], v[108:111]
  ds_read_b128 v[52:55], v32 offset:2048
  s_waitcnt lgkmcnt(3)
  v_mfma_f32_16x16x32_bf16 v[96:99], v[56:59], v[148:151], v[96:99]
  v_mfma_f32_16x16x32_bf16 v[100:103], v[56:59], v[180:183], v[100:103]
  v_mfma_f32_16x16x32_bf16 v[104:107], v[56:59], v[212:215], v[104:107]
  v_mfma_f32_16x16x32_bf16 v[108:111], v[56:59], v[244:247], v[108:111]
  ds_read_b128 v[56:59], v33 offset:2048
  s_waitcnt lgkmcnt(3)
  v_mfma_f32_16x16x32_bf16 v[96:99], v[60:63], v[152:155], v[96:99]
  v_mfma_f32_16x16x32_bf16 v[100:103], v[60:63], v[184:187], v[100:103]
  v_mfma_f32_16x16x32_bf16 v[104:107], v[60:63], v[216:219], v[104:107]
  v_mfma_f32_16x16x32_bf16 v[108:111], v[60:63], v[248:251], v[108:111]
  ds_read_b128 v[60:63], v34 offset:2048
  s_waitcnt lgkmcnt(3)
  v_mfma_f32_16x16x32_bf16 v[96:99], v[64:67], v[156:159], v[96:99]
  v_mfma_f32_16x16x32_bf16 v[100:103], v[64:67], v[188:191], v[100:103]
  v_mfma_f32_16x16x32_bf16 v[104:107], v[64:67], v[220:223], v[104:107]
  v_mfma_f32_16x16x32_bf16 v[108:111], v[64:67], v[252:255], v[108:111]
  ds_read_b128 v[64:67], v35 offset:2048
  s_waitcnt lgkmcnt(3)
  v_mfma_f32_16x16x32_bf16 v[112:115], v[52:55], v[128:131], 0
  v_mfma_f32_16x16x32_bf16 v[116:119], v[52:55], v[160:163], 0
  v_mfma_f32_16x16x32_bf16 v[120:123], v[52:55], v[192:195], 0
  v_mfma_f32_16x16x32_bf16 v[124:127], v[52:55], v[224:227], 0
  ds_read_b128 v[52:55], v32 offset:2304
  s_waitcnt lgkmcnt(3)
  v_mfma_f32_16x16x32_bf16 v[112:115], v[56:59], v[132:135], v[112:115]
  v_mfma_f32_16x16x32_bf16 v[116:119], v[56:59], v[164:167], v[116:119]
  v_mfma_f32_16x16x32_bf16 v[120:123], v[56:59], v[196:199], v[120:123]
  v_mfma_f32_16x16x32_bf16 v[124:127], v[56:59], v[228:231], v[124:127]
  ds_read_b128 v[56:59], v33 offset:2304
  s_waitcnt lgkmcnt(3)
  v_mfma_f32_16x16x32_bf16 v[112:115], v[60:63], v[136:139], v[112:115]
  v_mfma_f32_16x16x32_bf16 v[116:119], v[60:63], v[168:171], v[116:119]
  v_mfma_f32_16x16x32_bf16 v[120:123], v[60:63], v[200:203], v[120:123]
  v_mfma_f32_16x16x32_bf16 v[124:127], v[60:63], v[232:235], v[124:127]
  ds_read_b128 v[60:63], v34 offset:2304
  s_waitcnt lgkmcnt(3)
  v_mfma_f32_16x16x32_bf16 v[112:115], v[64:67], v[140:143], v[112:115]
  v_mfma_f32_16x16x32_bf16 v[116:119], v[64:67], v[172:175], v[116:119]
  v_mfma_f32_16x16x32_bf16 v[120:123], v[64:67], v[204:207], v[120:123]
  v_mfma_f32_16x16x32_bf16 v[124:127], v[64:67], v[236:239], v[124:127]
  ds_read_b128 v[64:67], v35 offset:2304
  s_waitcnt lgkmcnt(3)
  v_mfma_f32_16x16x32_bf16 v[112:115], v[52:55], v[144:147], v[112:115]
  v_mfma_f32_16x16x32_bf16 v[116:119], v[52:55], v[176:179], v[116:119]
  v_mfma_f32_16x16x32_bf16 v[120:123], v[52:55], v[208:211], v[120:123]
  v_mfma_f32_16x16x32_bf16 v[124:127], v[52:55], v[240:243], v[124:127]
  s_waitcnt lgkmcnt(2)
  v_mfma_f32_16x16x32_bf16 v[112:115], v[56:59], v[148:151], v[112:115]
  v_mfma_f32_16x16x32_bf16 v[116:119], v[56:59], v[180:183], v[116:119]
  v_mfma_f32_16x16x32_bf16 v[120:123], v[56:59], v[212:215], v[120:123]
  v_mfma_f32_16x16x32_bf16 v[124:127], v[56:59], v[244:247], v[124:127]
  s_waitcnt lgkmcnt(1)
  v_mfma_f32_16x16x32_bf16 v[112:115], v[60:63], v[152:155], v[112:115]
  v_mfma_f32_16x16x32_bf16 v[116:119], v[60:63], v[184:187], v[116:119]
  v_mfma_f32_16x16x32_bf16 v[120:123], v[60:63], v[216:219], v[120:123]
  v_mfma_f32_16x16x32_bf16 v[124:127], v[60:63], v[248:251], v[124:127]
  s_waitcnt lgkmcnt(0)
  v_mfma_f32_16x16x32_bf16 v[112:115], v[64:67], v[156:159], v[112:115]
  v_mfma_f32_16x16x32_bf16 v[116:119], v[64:67], v[188:191], v[116:119]
  v_mfma_f32_16x16x32_bf16 v[120:123], v[64:67], v[220:223], v[120:123]
  v_mfma_f32_16x16x32_bf16 v[124:127], v[64:67], v[252:255], v[124:127]
  s_lshl_b32 s30, s28, 10
  v_cvt_pk_bf16_f32 v68, v96, v97
  v_cvt_pk_bf16_f32 v69, v98, v99
  v_cvt_pk_bf16_f32 v70, v112, v113
  v_cvt_pk_bf16_f32 v71, v114, v115
  buffer_store_dwordx4 v[68:71], v12, s[8:11], s30 offen sc1
  v_cvt_pk_bf16_f32 v72, v100, v101
  v_cvt_pk_bf16_f32 v73, v102, v103
  v_cvt_pk_bf16_f32 v74, v116, v117
  v_cvt_pk_bf16_f32 v75, v118, v119
  buffer_store_dwordx4 v[72:75], v13, s[8:11], s30 offen sc1
  v_cvt_pk_bf16_f32 v76, v104, v105
  v_cvt_pk_bf16_f32 v77, v106, v107
  v_cvt_pk_bf16_f32 v78, v120, v121
  v_cvt_pk_bf16_f32 v79, v122, v123
  buffer_store_dwordx4 v[76:79], v14, s[8:11], s30 offen sc1
  v_cvt_pk_bf16_f32 v80, v108, v109
  v_cvt_pk_bf16_f32 v81, v110, v111
  v_cvt_pk_bf16_f32 v82, v124, v125
  v_cvt_pk_bf16_f32 v83, v126, v127
  buffer_store_dwordx4 v[80:83], v15, s[8:11], s30 offen sc1
  s_cmp_eq_u32 s16, 3
  s_cbranch_scc1 bj_w3
  s_waitcnt vmcnt(8)
  ds_read_b128 v[52:55], v32 offset:16384
  ds_read_b128 v[56:59], v33 offset:16384
  ds_read_b128 v[60:63], v34 offset:16384
  ds_read_b128 v[64:67], v35 offset:16384
  s_waitcnt lgkmcnt(3)
  v_mfma_f32_16x16x32_bf16 v[96:99], v[52:55], v[128:131], 0
  v_mfma_f32_16x16x32_bf16 v[100:103], v[52:55], v[160:163], 0
  v_mfma_f32_16x16x32_bf16 v[104:107], v[52:55], v[192:195], 0
  v_mfma_f32_16x16x32_bf16 v[108:111], v[52:55], v[224:227], 0
  ds_read_b128 v[52:55], v32 offset:16640
  s_waitcnt lgkmcnt(3)
  v_mfma_f32_16x16x32_bf16 v[96:99], v[56:59], v[132:135], v[96:99]
  v_mfma_f32_16x16x32_bf16 v[100:103], v[56:59], v[164:167], v[100:103]
  v_mfma_f32_16x16x32_bf16 v[104:107], v[56:59], v[196:199], v[104:107]
  v_mfma_f32_16x16x32_bf16 v[108:111], v[56:59], v[228:231], v[108:111]
  ds_read_b128 v[56:59], v33 offset:16640
  s_waitcnt lgkmcnt(3)
  v_mfma_f32_16x16x32_bf16 v[96:99], v[60:63], v[136:139], v[96:99]
  v_mfma_f32_16x16x32_bf16 v[100:103], v[60:63], v[168:171], v[100:103]
  v_mfma_f32_16x16x32_bf16 v[104:107], v[60:63], v[200:203], v[104:107]
  v_mfma_f32_16x16x32_bf16 v[108:111], v[60:63], v[232:235], v[108:111]
  ds_read_b128 v[60:63], v34 offset:16640
  s_waitcnt lgkmcnt(3)
  v_mfma_f32_16x16x32_bf16 v[96:99], v[64:67], v[140:143], v[96:99]
  v_mfma_f32_16x16x32_bf16 v[100:103], v[64:67], v[172:175], v[100:103]
  v_mfma_f32_16x16x32_bf16 v[104:107], v[64:67], v[204:207], v[104:107]
  v_mfma_f32_16x16x32_bf16 v[108:111], v[64:67], v[236:239], v[108:111]
  ds_read_b128 v[64:67], v35 offset:16640
  s_waitcnt lgkmcnt(3)
  v_mfma_f32_16x16x32_bf16 v[96:99], v[52:55], v[144:147], v[96:99]
  v_mfma_f32_16x16x32_bf16 v[100:103], v[52:55], v[176:179], v[100:103]
  v_mfma_f32_16x16x32_bf16 v[104:107], v[52:55], v[208:211], v[104:107]
  v_mfma_f32_16x16x32_bf16 v[108:111], v[52:55], v[240:243], v[108:111]
  ds_read_b128 v[52:55], v32 offset:18432
  s_waitcnt lgkmcnt(3)
  v_mfma_f32_16x16x32_bf16 v[96:99], v[56:59], v[148:151], v[96:99]
  v_mfma_f32_16x16x32_bf16 v[100:103], v[56:59], v[180:183], v[100:103]
  v_mfma_f32_16x16x32_bf16 v[104:107], v[56:59], v[212:215], v[104:107]
  v_mfma_f32_16x16x32_bf16 v[108:111], v[56:59], v[244:247], v[108:111]
  ds_read_b128 v[56:59], v33 offset:18432
  s_waitcnt lgkmcnt(3)
  v_mfma_f32_16x16x32_bf16 v[96:99], v[60:63], v[152:155], v[96:99]
  v_mfma_f32_16x16x32_bf16 v[100:103], v[60:63], v[184:187], v[100:103]
  v_mfma_f32_16x16x32_bf16 v[104:107], v[60:63], v[216:219], v[104:107]
  v_mfma_f32_16x16x32_bf16 v[108:111], v[60:63], v[248:251], v[108:111]
  ds_read_b128 v[60:63], v34 offset:18432
  s_waitcnt lgkmcnt(3)
  v_mfma_f32_16x16x32_bf16 v[96:99], v[64:67], v[156:159], v[96:99]
  v_mfma_f32_16x16x32_bf16 v[100:103], v[64:67], v[188:191], v[100:103]
  v_mfma_f32_16x16x32_bf16 v[104:107], v[64:67], v[220:223], v[104:107]
  v_mfma_f32_16x16x32_bf16 v[108:111], v[64:67], v[252:255], v[108:111]
  ds_read_b128 v[64:67], v35 offset:18432
  s_waitcnt lgkmcnt(3)
  v_mfma_f32_16x16x32_bf16 v[112:115], v[52:55], v[128:131], 0
  v_mfma_f32_16x16x32_bf16 v[116:119], v[52:55], v[160:163], 0
  v_mfma_f32_16x16x32_bf16 v[120:123], v[52:55], v[192:195], 0
  v_mfma_f32_16x16x32_bf16 v[124:127], v[52:55], v[224:227], 0
  ds_read_b128 v[52:55], v32 offset:18688
  s_waitcnt lgkmcnt(3)
  v_mfma_f32_16x16x32_bf16 v[112:115], v[56:59], v[132:135], v[112:115]
  v_mfma_f32_16x16x32_bf16 v[116:119], v[56:59], v[164:167], v[116:119]
  v_mfma_f32_16x16x32_bf16 v[120:123], v[56:59], v[196:199], v[120:123]
  v_mfma_f32_16x16x32_bf16 v[124:127], v[56:59], v[228:231], v[124:127]
  ds_read_b128 v[56:59], v33 offset:18688
  s_waitcnt lgkmcnt(3)
  v_mfma_f32_16x16x32_bf16 v[112:115], v[60:63], v[136:139], v[112:115]
  v_mfma_f32_16x16x32_bf16 v[116:119], v[60:63], v[168:171], v[116:119]
  v_mfma_f32_16x16x32_bf16 v[120:123], v[60:63], v[200:203], v[120:123]
  v_mfma_f32_16x16x32_bf16 v[124:127], v[60:63], v[232:235], v[124:127]
  ds_read_b128 v[60:63], v34 offset:18688
  s_waitcnt lgkmcnt(3)
  v_mfma_f32_16x16x32_bf16 v[112:115], v[64:67], v[140:143], v[112:115]
  v_mfma_f32_16x16x32_bf16 v[116:119], v[64:67], v[172:175], v[116:119]
  v_mfma_f32_16x16x32_bf16 v[120:123], v[64:67], v[204:207], v[120:123]
  v_mfma_f32_16x16x32_bf16 v[124:127], v[64:67], v[236:239], v[124:127]
  ds_read_b128 v[64:67], v35 offset:18688
  s_waitcnt lgkmcnt(3)
  v_mfma_f32_16x16x32_bf16 v[112:115], v[52:55], v[144:147], v[112:115]
  v_mfma_f32_16x16x32_bf16 v[116:119], v[52:55], v[176:179], v[116:119]
  v_mfma_f32_16x16x32_bf16 v[120:123], v[52:55], v[208:211], v[120:123]
  v_mfma_f32_16x16x32_bf16 v[124:127], v[52:55], v[240:243], v[124:127]
  s_waitcnt lgkmcnt(2)
  v_mfma_f32_16x16x32_bf16 v[112:115], v[56:59], v[148:151], v[112:115]
  v_mfma_f32_16x16x32_bf16 v[116:119], v[56:59], v[180:183], v[116:119]
  v_mfma_f32_16x16x32_bf16 v[120:123], v[56:59], v[212:215], v[120:123]
  v_mfma_f32_16x16x32_bf16 v[124:127], v[56:59], v[244:247], v[124:127]
  s_waitcnt lgkmcnt(1)
  v_mfma_f32_16x16x32_bf16 v[112:115], v[60:63], v[152:155], v[112:115]
  v_mfma_f32_16x16x32_bf16 v[116:119], v[60:63], v[184:187], v[116:119]
  v_mfma_f32_16x16x32_bf16 v[120:123], v[60:63], v[216:219], v[120:123]
  v_mfma_f32_16x16x32_bf16 v[124:127], v[60:63], v[248:251], v[124:127]
  s_waitcnt lgkmcnt(0)
  v_mfma_f32_16x16x32_bf16 v[112:115], v[64:67], v[156:159], v[112:115]
  v_mfma_f32_16x16x32_bf16 v[116:119], v[64:67], v[188:191], v[116:119]
  v_mfma_f32_16x16x32_bf16 v[120:123], v[64:67], v[220:223], v[120:123]
  v_mfma_f32_16x16x32_bf16 v[124:127], v[64:67], v[252:255], v[124:127]
  s_lshl_b32 s30, s29, 10
  v_cvt_pk_bf16_f32 v68, v96, v97
  v_cvt_pk_bf16_f32 v69, v98, v99
  v_cvt_pk_bf16_f32 v70, v112, v113
  v_cvt_pk_bf16_f32 v71, v114, v115
  buffer_store_dwordx4 v[68:71], v12, s[8:11], s30 offen sc1
  v_cvt_pk_bf16_f32 v72, v100, v101
  v_cvt_pk_bf16_f32 v73, v102, v103
  v_cvt_pk_bf16_f32 v74, v116, v117
  v_cvt_pk_bf16_f32 v75, v118, v119
  buffer_store_dwordx4 v[72:75], v13, s[8:11], s30 offen sc1
  v_cvt_pk_bf16_f32 v76, v104, v105
  v_cvt_pk_bf16_f32 v77, v106, v107
  v_cvt_pk_bf16_f32 v78, v120, v121
  v_cvt_pk_bf16_f32 v79, v122, v123
  buffer_store_dwordx4 v[76:79], v14, s[8:11], s30 offen sc1
  v_cvt_pk_bf16_f32 v80, v108, v109
  v_cvt_pk_bf16_f32 v81, v110, v111
  v_cvt_pk_bf16_f32 v82, v124, v125
  v_cvt_pk_bf16_f32 v83, v126, v127
  buffer_store_dwordx4 v[80:83], v15, s[8:11], s30 offen sc1
bj_w3:
  s_lshl_b32 s77, s19, 8
  s_lshl_b32 s21, s17, 4
  s_add_u32 s77, s77, s21
  s_cmp_lg_u32 s31, 0
  s_cselect_b32 s21, 8, 0
  s_add_u32 s77, s77, s21
  s_add_u32 s77, s77, 88600576
  s_add_u32 s78, s77, 2048
  s_cmp_lg_u32 s66, 0
  s_cbranch_scc1 bj_cf
  s_cmp_lg_u32 s16, 0
  s_cbranch_scc1 w0_21
  s_waitcnt vmcnt(8)
  v_readfirstlane_b32 s70, v46
  s_cmp_lg_u32 s70, 0
  s_cbranch_scc1 bj_nz
  v_mov_b32 v45, 128
  v_mov_b32 v46, s88
  v_mov_b32 v47, s89
  v_mov_b32 v48, 0
  v_mov_b32 v49, 0
  s_mov_b64 exec, 1
  buffer_atomic_cmpswap_x2 v[46:49], v45, s[12:15], 0 offen sc0
  s_mov_b64 exec, -1
  s_waitcnt vmcnt(0)
  v_readfirstlane_b32 s70, v46
  s_cmp_lg_u32 s70, 0
  s_cbranch_scc1 bj_nz
  v_mov_b32 v46, s88
  v_mov_b32 v47, s89
bj_nz:
w0_21:
  v_mov_b32 v45, 160000
  s_add_u32 s101, s101, 1
  s_barrier
  s_mov_b64 exec, 1
  s_cmp_lg_u32 s16, 0
  s_cbranch_scc1 w0_22
  ds_write_b32 v45, v44 offset:0
  ds_write_b32 v45, v46 offset:4
  ds_write_b32 v45, v47 offset:8
  s_waitcnt lgkmcnt(0)
  v_mov_b32 v44, s101
  ds_write_b32 v45, v44 offset:16
  s_waitcnt lgkmcnt(0)
w0_22:
  s_mov_b64 exec, -1
  s_barrier
  ds_read_b32 v44, v45 offset:0
  ds_read_b32 v46, v45 offset:4
  ds_read_b32 v47, v45 offset:8
  ds_read_b32 v45, v45 offset:16
  s_waitcnt lgkmcnt(0)
  v_readfirstlane_b32 s70, v44
  v_readfirstlane_b32 s88, v46
  v_readfirstlane_b32 s89, v47
  v_cmp_ne_u32 vcc, s101, v45
  s_cbranch_vccnz ch_end
  s_mov_b32 s66, 1
  s_bitcmp1_b32 s70, s3
  s_cbranch_scc1 m_reclaim
bj_cf:
  s_barrier
  s_mov_b32 s56, s40
  s_and_b32 s57, s41, 0xffff
  s_mov_b32 s58, 3670016
  s_mov_b32 s59, 0x20000
  s_mov_b32 s60, s42
  s_and_b32 s61, s43, 0xffff
  s_mov_b32 s62, 3670016
  s_mov_b32 s63, 0x20000
  s_add_u32 s28, s31, s19
  v_lshrrev_b32 v5, 5, v1
  v_and_b32 v6, 31, v1
  v_xor_b32 v6, v6, v5
  v_lshlrev_b32 v6, 4, v6
  v_lshl_add_u32 v6, v5, 13, v6
  s_lshl_b32 s20, s16, 6
  v_xor_b32 v7, s20, v6
  s_lshl_b32 s22, s28, 18
  s_lshl_b32 s21, s16, 16
  s_add_u32 s22, s22, s21
  s_add_u32 s22, s22, s26
  s_lshl_b32 m0, s16, 12
  v_xor_b32 v8, 0, v7
  buffer_load_dwordx4 v8, s[56:59], s22 offen offset:0 lds
  v_xor_b32 v8, 32, v7
  v_add_u32 v8, 15360, v8
  buffer_load_dwordx4 v8, s[56:59], s22 offen offset:1024 lds
  v_xor_b32 v8, 0, v7
  v_add_u32 v8, 30720, v8
  buffer_load_dwordx4 v8, s[56:59], s22 offen offset:2048 lds
  v_xor_b32 v8, 32, v7
  v_add_u32 v8, 46080, v8
  buffer_load_dwordx4 v8, s[56:59], s22 offen offset:3072 lds
  v_xor_b32 v16, 0, v6
  v_xor_b32 v17, 32, v6
  v_add_u32 v17, 31744, v17
  v_xor_b32 v18, 64, v6
  v_add_u32 v18, 129024, v18
  v_xor_b32 v19, 96, v6
  v_add_u32 v19, 160768, v19
  v_xor_b32 v20, 128, v6
  v_add_u32 v20, 262144, v20
  v_xor_b32 v21, 160, v6
  v_add_u32 v21, 293888, v21
  v_xor_b32 v22, 192, v6
  v_add_u32 v22, 391168, v22
  v_xor_b32 v23, 224, v6
  v_add_u32 v23, 422912, v23
  s_lshr_b32 s20, s16, 1
  s_lshl_b32 s20, s20, 16
  s_and_b32 s21, s16, 1
  s_lshl_b32 s21, s21, 14
  s_add_u32 s20, s20, s21
  s_add_u32 s29, s20, s26
  s_mul_i32 s25, s16, 24576
  s_add_u32 s25, s25, 16384
  s_add_u32 s22, s29, 2097152
  s_add_u32 m0, s25, 0
  s_nop 0
  buffer_load_dwordx4 v16, s[60:63], s22 offen offset:0 lds
  buffer_load_dwordx4 v17, s[60:63], s22 offen offset:1024 lds
  buffer_load_dwordx4 v18, s[60:63], s22 offen offset:2048 lds
  buffer_load_dwordx4 v19, s[60:63], s22 offen offset:3072 lds
  s_add_u32 m0, s25, 4096
  s_nop 0
  buffer_load_dwordx4 v20, s[60:63], s22 offen offset:0 lds
  buffer_load_dwordx4 v21, s[60:63], s22 offen offset:1024 lds
  buffer_load_dwordx4 v22, s[60:63], s22 offen offset:2048 lds
  buffer_load_dwordx4 v23, s[60:63], s22 offen offset:3072 lds
  s_waitcnt vmcnt(12)
  s_barrier
  s_cmp_lg_u32 s16, 0
  s_cbranch_scc1 pub_23
  v_mul_u32_u24 v50, 2048, v1
  v_mov_b32 v48, s88
  v_mov_b32 v49, s89
  s_mov_b64 exec, 1
  buffer_store_dwordx2 v[48:49], v50, s[8:11], s77 offen sc1
  s_mov_b64 exec, -1
pub_23:
  s_cmp_ge_u32 s18, 70
  s_cbranch_scc1 bk_nm
  s_mov_b32 s20, 71565312
  buffer_store_dwordx4 v[84:87], v92, s[8:11], s20 offen sc1
  buffer_store_dwordx4 v[88:91], v92, s[8:11], s20 offen offset:256 sc1
  s_cmp_lg_u32 s18, 0
  s_cbranch_scc1 bk_nm
  v_min_u32 v104, -2, v36
  v_min_u32 v108, -2, v37
  v_min_u32 v105, -2, v38
  v_min_u32 v109, -2, v39
  v_min_u32 v106, -2, v40
  v_min_u32 v110, -2, v41
  v_min_u32 v107, -2, v42
  v_min_u32 v111, -2, v43
  s_mov_b32 s20, 88653824
  s_mov_b32 s21, 88080384
  buffer_store_dwordx4 v[104:107], v94, s[8:11], s20 offen sc1
  buffer_store_dwordx4 v[108:111], v94, s[8:11], s20 offen offset:128 sc1
  buffer_store_dwordx4 v[104:107], v94, s[8:11], s21 offen sc1
  buffer_store_dwordx4 v[108:111], v94, s[8:11], s21 offen offset:128 sc1
bk_nm:
  s_mov_b32 s23, 88653824
  v_add_u32 v6, 448, v95
  v_subrev_u32 v7, 1152, v6
  v_mov_b32 v52, -1
  v_mov_b32 v9, 0
  v_cmp_gt_u32 vcc, 128, v7
  s_nop 1
  v_cndmask_b32 v52, v52, v9, vcc
  v_mov_b32 v53, v52
  v_mov_b32 v54, v52
  v_mov_b32 v55, v52
  v_lshlrev_b32 v8, 4, v6
  v_mov_b32 v9, 0x10000000
  v_cmp_lt_u32 vcc, 25599, v6
  s_nop 1
  v_cndmask_b32 v8, v8, v9, vcc
  buffer_store_dwordx4 v[52:55], v8, s[8:11], s23 offen sc1
  s_mov_b32 s23, 87957504
  v_add_u32 v6, 448, v95
  v_cmp_gt_u32 vcc, 7680, v95
  s_nop 1
  v_cndmask_b32 v6, v6, v95, vcc
  v_subrev_u32 v7, 36352, v6
  v_mov_b32 v56, -1
  v_mov_b32 v9, 0
  v_cmp_gt_u32 vcc, 1048576, v7
  s_nop 1
  v_cndmask_b32 v56, v56, v9, vcc
  v_mov_b32 v57, v56
  v_mov_b32 v58, v56
  v_mov_b32 v59, v56
  v_lshlrev_b32 v8, 4, v6
  v_mov_b32 v9, 0x10000000
  v_cmp_lt_u32 vcc, 40191, v6
  s_nop 1
  v_cndmask_b32 v8, v8, v9, vcc
  buffer_store_dwordx4 v[56:59], v8, s[8:11], s23 offen sc1
  s_add_u32 s22, s29, 2621440
  s_add_u32 m0, s25, 8192
  s_nop 0
  buffer_load_dwordx4 v16, s[60:63], s22 offen offset:0 lds
  buffer_load_dwordx4 v17, s[60:63], s22 offen offset:1024 lds
  buffer_load_dwordx4 v18, s[60:63], s22 offen offset:2048 lds
  buffer_load_dwordx4 v19, s[60:63], s22 offen offset:3072 lds
  s_add_u32 m0, s25, 12288
  s_nop 0
  buffer_load_dwordx4 v20, s[60:63], s22 offen offset:0 lds
  buffer_load_dwordx4 v21, s[60:63], s22 offen offset:1024 lds
  buffer_load_dwordx4 v22, s[60:63], s22 offen offset:2048 lds
  buffer_load_dwordx4 v23, s[60:63], s22 offen offset:3072 lds
  s_add_u32 s22, s29, 3145728
  s_add_u32 m0, s25, 16384
  s_nop 0
  buffer_load_dwordx4 v16, s[60:63], s22 offen offset:0 lds
  buffer_load_dwordx4 v17, s[60:63], s22 offen offset:1024 lds
  buffer_load_dwordx4 v18, s[60:63], s22 offen offset:2048 lds
  buffer_load_dwordx4 v19, s[60:63], s22 offen offset:3072 lds
  s_add_u32 m0, s25, 20480
  s_nop 0
  buffer_load_dwordx4 v20, s[60:63], s22 offen offset:0 lds
  buffer_load_dwordx4 v21, s[60:63], s22 offen offset:1024 lds
  buffer_load_dwordx4 v22, s[60:63], s22 offen offset:2048 lds
  buffer_load_dwordx4 v23, s[60:63], s22 offen offset:3072 lds
  v_mov_b32 v250, s68
  s_or_b32 s20, s69, s16
  s_cbranch_scc1 bj_ht
  s_cmp_lg_u32 s16, 0
  s_cbranch_scc1 w0_24
  v_mov_b32 v250, 1
  v_mov_b32 v251, 192
  s_mov_b64 exec, 1
  buffer_atomic_add v250, v251, s[12:15], 0 offen sc0
  s_mov_b64 exec, -1
w0_24:
  s_branch bj_h2
bj_ht:
  buffer_load_dword v251, off, s[8:11], s77
bj_h2:
  v_lshrrev_b32 v7, 2, v4
  v_lshlrev_b32 v7, 3, v7
  v_and_b32 v8, 3, v4
  v_add_u32 v7, v7, v8
  v_xor_b32 v10, v3, v4
  v_lshlrev_b32 v10, 4, v10
  v_lshl_add_u32 v11, v4, 9, v10
  v_add_u32 v11, s25, v11
  v_lshl_add_u32 v10, v7, 9, v10
  v_xor_b32 v32, 0, v10
  v_xor_b32 v36, 0, v11
  v_xor_b32 v33, 64, v10
  v_xor_b32 v37, 64, v11
  v_xor_b32 v34, 128, v10
  v_xor_b32 v38, 128, v11
  v_xor_b32 v35, 192, v10
  v_xor_b32 v39, 192, v11
  s_mul_i32 s30, s17, 401408
  s_mul_i32 s20, s16, 14336
  s_add_u32 s30, s30, s20
  s_lshl_b32 s20, s28, 10
  s_add_u32 s30, s30, s20
  s_mov_b32 s24, 1035512379
  s_lshl_b32 s20, s17, 7
  s_lshl_b32 s28, s28, 3
  s_add_u32 s28, s28, s20
  s_add_u32 s28, s28, 88635392
  s_waitcnt vmcnt(1)
  s_barrier
  s_cmp_lg_u32 s16, 0
  s_cbranch_scc1 w0_25
  v_mul_u32_u24 v50, 2048, v1
  v_mov_b32 v48, s88
  v_mov_b32 v49, s89
  s_mov_b64 exec, 511
  buffer_store_dwordx2 v[48:49], v50, s[8:11], s78 offen sc1
  s_mov_b64 exec, -1
w0_25:
  ds_read_b128 v[128:131], v32 offset:0
  ds_read_b128 v[132:135], v32 offset:2048
  ds_read_b128 v[136:139], v36 offset:0
  ds_read_b128 v[140:143], v36 offset:8192
  ds_read_b128 v[144:147], v36 offset:16384
  ds_read_b128 v[148:151], v33 offset:0
  ds_read_b128 v[152:155], v33 offset:2048
  ds_read_b128 v[156:159], v37 offset:0
  ds_read_b128 v[160:163], v37 offset:8192
  ds_read_b128 v[164:167], v37 offset:16384
  ds_read_b128 v[168:171], v34 offset:0
  ds_read_b128 v[172:175], v34 offset:2048
  ds_read_b128 v[176:179], v38 offset:0
  ds_read_b128 v[180:183], v38 offset:8192
  ds_read_b128 v[184:187], v38 offset:16384
  s_waitcnt lgkmcnt(10)
  v_mfma_f32_16x16x32_bf16 v[96:99], v[128:131], v[136:139], 0
  v_mfma_f32_16x16x32_bf16 v[100:103], v[132:135], v[136:139], 0
  v_mfma_f32_16x16x32_bf16 v[104:107], v[128:131], v[140:143], 0
  v_mfma_f32_16x16x32_bf16 v[108:111], v[132:135], v[140:143], 0
  v_mfma_f32_16x16x32_bf16 v[112:115], v[128:131], v[144:147], 0
  v_mfma_f32_16x16x32_bf16 v[116:119], v[132:135], v[144:147], 0
  ds_read_b128 v[128:131], v35 offset:0
  ds_read_b128 v[132:135], v35 offset:2048
  ds_read_b128 v[136:139], v39 offset:0
  ds_read_b128 v[140:143], v39 offset:8192
  ds_read_b128 v[144:147], v39 offset:16384
  s_waitcnt lgkmcnt(10)
  v_mfma_f32_16x16x32_bf16 v[96:99], v[148:151], v[156:159], v[96:99]
  v_mfma_f32_16x16x32_bf16 v[100:103], v[152:155], v[156:159], v[100:103]
  v_mfma_f32_16x16x32_bf16 v[104:107], v[148:151], v[160:163], v[104:107]
  v_mfma_f32_16x16x32_bf16 v[108:111], v[152:155], v[160:163], v[108:111]
  v_mfma_f32_16x16x32_bf16 v[112:115], v[148:151], v[164:167], v[112:115]
  v_mfma_f32_16x16x32_bf16 v[116:119], v[152:155], v[164:167], v[116:119]
  ds_read_b128 v[148:151], v32 offset:256
  ds_read_b128 v[152:155], v32 offset:2304
  ds_read_b128 v[156:159], v36 offset:256
  ds_read_b128 v[160:163], v36 offset:8448
  ds_read_b128 v[164:167], v36 offset:16640
  s_waitcnt lgkmcnt(10)
  v_mfma_f32_16x16x32_bf16 v[96:99], v[168:171], v[176:179], v[96:99]
  v_mfma_f32_16x16x32_bf16 v[100:103], v[172:175], v[176:179], v[100:103]
  v_mfma_f32_16x16x32_bf16 v[104:107], v[168:171], v[180:183], v[104:107]
  v_mfma_f32_16x16x32_bf16 v[108:111], v[172:175], v[180:183], v[108:111]
  v_mfma_f32_16x16x32_bf16 v[112:115], v[168:171], v[184:187], v[112:115]
  v_mfma_f32_16x16x32_bf16 v[116:119], v[172:175], v[184:187], v[116:119]
  ds_read_b128 v[168:171], v33 offset:256
  ds_read_b128 v[172:175], v33 offset:2304
  ds_read_b128 v[176:179], v37 offset:256
  ds_read_b128 v[180:183], v37 offset:8448
  ds_read_b128 v[184:187], v37 offset:16640
  s_waitcnt lgkmcnt(10)
  v_mfma_f32_16x16x32_bf16 v[96:99], v[128:131], v[136:139], v[96:99]
  v_mfma_f32_16x16x32_bf16 v[100:103], v[132:135], v[136:139], v[100:103]
  v_mfma_f32_16x16x32_bf16 v[104:107], v[128:131], v[140:143], v[104:107]
  v_mfma_f32_16x16x32_bf16 v[108:111], v[132:135], v[140:143], v[108:111]
  v_mfma_f32_16x16x32_bf16 v[112:115], v[128:131], v[144:147], v[112:115]
  v_mfma_f32_16x16x32_bf16 v[116:119], v[132:135], v[144:147], v[116:119]
  ds_read_b128 v[128:131], v34 offset:256
  ds_read_b128 v[132:135], v34 offset:2304
  ds_read_b128 v[136:139], v38 offset:256
  ds_read_b128 v[140:143], v38 offset:8448
  ds_read_b128 v[144:147], v38 offset:16640
  s_waitcnt lgkmcnt(10)
  v_mfma_f32_16x16x32_bf16 v[96:99], v[148:151], v[156:159], v[96:99]
  v_mfma_f32_16x16x32_bf16 v[100:103], v[152:155], v[156:159], v[100:103]
  v_mfma_f32_16x16x32_bf16 v[104:107], v[148:151], v[160:163], v[104:107]
  v_mfma_f32_16x16x32_bf16 v[108:111], v[152:155], v[160:163], v[108:111]
  v_mfma_f32_16x16x32_bf16 v[112:115], v[148:151], v[164:167], v[112:115]
  v_mfma_f32_16x16x32_bf16 v[116:119], v[152:155], v[164:167], v[116:119]
  ds_read_b128 v[148:151], v35 offset:256
  ds_read_b128 v[152:155], v35 offset:2304
  ds_read_b128 v[156:159], v39 offset:256
  ds_read_b128 v[160:163], v39 offset:8448
  ds_read_b128 v[164:167], v39 offset:16640
  s_waitcnt lgkmcnt(10)
  v_mfma_f32_16x16x32_bf16 v[96:99], v[168:171], v[176:179], v[96:99]
  v_mfma_f32_16x16x32_bf16 v[100:103], v[172:175], v[176:179], v[100:103]
  v_mfma_f32_16x16x32_bf16 v[104:107], v[168:171], v[180:183], v[104:107]
  v_mfma_f32_16x16x32_bf16 v[108:111], v[172:175], v[180:183], v[108:111]
  v_mfma_f32_16x16x32_bf16 v[112:115], v[168:171], v[184:187], v[112:115]
  v_mfma_f32_16x16x32_bf16 v[116:119], v[172:175], v[184:187], v[116:119]
  s_waitcnt lgkmcnt(5)
  v_mfma_f32_16x16x32_bf16 v[96:99], v[128:131], v[136:139], v[96:99]
  v_mfma_f32_16x16x32_bf16 v[100:103], v[132:135], v[136:139], v[100:103]
  v_mfma_f32_16x16x32_bf16 v[104:107], v[128:131], v[140:143], v[104:107]
  v_mfma_f32_16x16x32_bf16 v[108:111], v[132:135], v[140:143], v[108:111]
  v_mfma_f32_16x16x32_bf16 v[112:115], v[128:131], v[144:147], v[112:115]
  v_mfma_f32_16x16x32_bf16 v[116:119], v[132:135], v[144:147], v[116:119]
  s_waitcnt lgkmcnt(0)
  v_mfma_f32_16x16x32_bf16 v[96:99], v[148:151], v[156:159], v[96:99]
  v_mfma_f32_16x16x32_bf16 v[100:103], v[152:155], v[156:159], v[100:103]
  v_mfma_f32_16x16x32_bf16 v[104:107], v[148:151], v[160:163], v[104:107]
  v_mfma_f32_16x16x32_bf16 v[108:111], v[152:155], v[160:163], v[108:111]
  v_mfma_f32_16x16x32_bf16 v[112:115], v[148:151], v[164:167], v[112:115]
  v_mfma_f32_16x16x32_bf16 v[116:119], v[152:155], v[164:167], v[116:119]
  v_mul_f32 v96, s24, v96
  v_mul_f32 v97, s24, v97
  v_mul_f32 v98, s24, v98
  v_mul_f32 v99, s24, v99
  v_mul_f32 v100, s24, v100
  v_mul_f32 v101, s24, v101
  v_mul_f32 v102, s24, v102
  v_mul_f32 v103, s24, v103
  v_cvt_pk_bf16_f32 v68, v96, v97
  v_cvt_pk_bf16_f32 v69, v98, v99
  v_cvt_pk_bf16_f32 v70, v100, v101
  v_cvt_pk_bf16_f32 v71, v102, v103
  s_add_u32 s20, s30, 229376
  buffer_store_dwordx4 v[68:71], v2, s[8:11], s20 offen sc1
  v_mul_f32 v104, s24, v104
  v_mul_f32 v105, s24, v105
  v_mul_f32 v106, s24, v106
  v_mul_f32 v107, s24, v107
  v_mul_f32 v108, s24, v108
  v_mul_f32 v109, s24, v109
  v_mul_f32 v110, s24, v110
  v_mul_f32 v111, s24, v111
  v_cvt_pk_bf16_f32 v72, v104, v105
  v_cvt_pk_bf16_f32 v73, v106, v107
  v_cvt_pk_bf16_f32 v74, v108, v109
  v_cvt_pk_bf16_f32 v75, v110, v111
  s_add_u32 s20, s30, 286720
  buffer_store_dwordx4 v[72:75], v2, s[8:11], s20 offen sc1
  v_mul_f32 v112, s24, v112
  v_mul_f32 v113, s24, v113
  v_mul_f32 v114, s24, v114
  v_mul_f32 v115, s24, v115
  v_mul_f32 v116, s24, v116
  v_mul_f32 v117, s24, v117
  v_mul_f32 v118, s24, v118
  v_mul_f32 v119, s24, v119
  v_cvt_pk_bf16_f32 v76, v112, v113
  v_cvt_pk_bf16_f32 v77, v114, v115
  v_cvt_pk_bf16_f32 v78, v116, v117
  v_cvt_pk_bf16_f32 v79, v118, v119
  s_add_u32 s20, s30, 344064
  buffer_store_dwordx4 v[76:79], v2, s[8:11], s20 offen sc1
  s_waitcnt vmcnt(0)
  s_barrier
  s_cmp_lg_u32 s16, 0
  s_cbranch_scc1 pub_26
  v_mul_u32_u24 v26, 2048, v1
  v_mov_b32 v24, s88
  v_mov_b32 v25, s89
  s_mov_b64 exec, 1
  buffer_store_dwordx2 v[24:25], v26, s[8:11], s28 offen sc1
  s_mov_b64 exec, -1
pub_26:
  v_mov_b32 v6, 160000
  s_add_u32 s101, s101, 1
  s_barrier
  s_mov_b64 exec, 1
  s_cmp_lg_u32 s16, 0
  s_cbranch_scc1 w0_27
  ds_write_b32 v6, v250 offset:0
  s_waitcnt lgkmcnt(0)
  v_mov_b32 v250, s101
  ds_write_b32 v6, v250 offset:16
  s_waitcnt lgkmcnt(0)
w0_27:
  s_mov_b64 exec, -1
  s_barrier
  ds_read_b32 v250, v6 offset:0
  ds_read_b32 v6, v6 offset:16
  s_waitcnt lgkmcnt(0)
  v_readfirstlane_b32 s3, v250
  v_cmp_ne_u32 vcc, s101, v6
  s_cbranch_vccnz ch_end
  s_branch wk_have
wk_loop:
  s_waitcnt vmcnt(0) lgkmcnt(0)
  s_cmp_eq_u32 s96, 1
  s_cbranch_scc1 wk_ask
  s_mov_b32 s96, 1
  s_cmp_lg_u32 s16, 0
  s_cbranch_scc1 w0_28
  s_mov_b32 s30, 0
  v_mov_b32 v243, 32
sf_l:
  buffer_load_dword v242, v243, s[12:15], 0 offen sc1
  s_waitcnt vmcnt(0)
  v_readfirstlane_b32 s70, v242
  s_cmp_eq_u32 s70, -1
  s_cbranch_scc1 sf_d
  s_sleep 16
  s_add_u32 s30, s30, 1
  s_cmp_lt_u32 s30, 64
  s_cbranch_scc1 sf_l
  s_mov_b32 s20, 0
  s_mov_b32 s21, 0
  s_mov_b64 exec, 1
sf_c_l:
  s_cmp_lg_u32 s70, -1
  s_cbranch_scc1 sf_c_t
  s_add_u32 s20, s20, 1
  s_cmp_lt_u32 s20, 8
  s_cselect_b32 s20, s20, 0
  s_mov_b32 s70, 0
  s_mov_b32 s3, -1
  s_add_u32 s21, s21, 1
  s_cmp_ge_u32 s21, 1
  s_cbranch_scc1 sf_c_d
sf_c_t:
  s_ff0_i32_b32 s22, s70
  s_lshl_b32 s23, 1, s22
  s_and_b32 s71, s20, 4
  s_mul_i32 s71, s71, 12
  s_lshl_b32 s3, s20, 2
  s_add_u32 s3, s3, s71
  v_mov_b32 v242, s23
  v_mov_b32 v243, 32
  buffer_atomic_or v242, v243, s[12:15], s3 offen sc0
  s_waitcnt vmcnt(0)
  v_readfirstlane_b32 s70, v242
  s_lshl_b32 s3, s20, 5
  s_add_u32 s3, s3, s22
  s_bitcmp1_b32 s70, s22
  s_cbranch_scc1 sf_c_l
sf_c_d:
  s_mov_b64 exec, -1
  v_mov_b32 v242, s3
sf_d:
w0_28:
  v_mov_b32 v243, 160000
  s_add_u32 s101, s101, 1
  s_barrier
  s_mov_b64 exec, 1
  s_cmp_lg_u32 s16, 0
  s_cbranch_scc1 w0_29
  ds_write_b32 v243, v242 offset:0
  s_waitcnt lgkmcnt(0)
  v_mov_b32 v242, s101
  ds_write_b32 v243, v242 offset:16
  s_waitcnt lgkmcnt(0)
w0_29:
  s_mov_b64 exec, -1
  s_barrier
  ds_read_b32 v242, v243 offset:0
  ds_read_b32 v243, v243 offset:16
  s_waitcnt lgkmcnt(0)
  v_readfirstlane_b32 s3, v242
  v_cmp_ne_u32 vcc, s101, v243
  s_cbranch_vccnz ch_end
  s_cmp_eq_u32 s3, -1
  s_cbranch_scc1 wk_ask
  s_load_dwordx8 s[36:43], s[0:1], 56
  s_load_dwordx4 s[44:47], s[0:1], 88
  s_getreg_b32 s67, hwreg(HW_REG_XCC_ID)
  s_and_b32 s67, s67, 7
  s_mov_b32 s66, 1
  s_waitcnt lgkmcnt(0)
  s_branch m_start
wk_ask:
  v_readfirstlane_b32 s22, v250
  s_cmp_ge_u32 s22, 1440
  s_cbranch_scc1 wk_next
  s_cmp_lg_u32 s16, 0
  s_cbranch_scc1 w0_30
  v_mov_b32 v250, 1
  v_mov_b32 v251, 192
  s_mov_b64 exec, 1
  buffer_atomic_add v250, v251, s[12:15], 0 offen sc0
  s_mov_b64 exec, -1
w0_30:
wk_next:
  s_waitcnt vmcnt(0)
  v_mov_b32 v6, 160000
  s_add_u32 s101, s101, 1
  s_barrier
  s_mov_b64 exec, 1
  s_cmp_lg_u32 s16, 0
  s_cbranch_scc1 w0_31
  ds_write_b32 v6, v250 offset:0
  s_waitcnt lgkmcnt(0)
  v_mov_b32 v250, s101
  ds_write_b32 v6, v250 offset:16
  s_waitcnt lgkmcnt(0)
w0_31:
  s_mov_b64 exec, -1
  s_barrier
  ds_read_b32 v250, v6 offset:0
  ds_read_b32 v6, v6 offset:16
  s_waitcnt lgkmcnt(0)
  v_readfirstlane_b32 s3, v250
  v_cmp_ne_u32 vcc, s101, v6
  s_cbranch_vccnz ch_end
wk_have:
  s_cmp_ge_u32 s3, 1440
  s_cbranch_scc1 ch_end
  v_mov_b32 v250, 0
  v_mov_b32 v251, 192
  v_and_b32 v1, 63, v0
  v_lshlrev_b32 v2, 4, v1
  v_lshrrev_b32 v3, 4, v1
  v_and_b32 v4, 15, v1
  s_cmp_lg_u32 s97, 0
  s_cbranch_scc1 wk_go
  s_mov_b32 s68, s3
  s_mov_b32 s69, 1
  s_cmp_lg_u32 s16, 0
  s_cbranch_scc1 w0_32
  s_add_u32 s20, s67, 1
  s_lshl_b32 s22, s20, 11
  s_add_u32 s22, s22, 88602624
  v_add_u32 v24, 1024, v2
  v_min_u32 v24, 1776, v24
  s_mov_b32 s30, 0
wk_af:
  buffer_load_dwordx4 v[28:31], v2, s[8:11], s22 offen sc1
  buffer_load_dwordx4 v[32:35], v24, s[8:11], s22 offen sc1
  s_waitcnt vmcnt(0)
  v_cmp_ne_u64 vcc, s[88:89], v[28:29]
  s_cbranch_vccnz wk_af_no
  v_cmp_ne_u64 vcc, s[88:89], v[30:31]
  s_cbranch_vccnz wk_af_no
  v_cmp_ne_u64 vcc, s[88:89], v[32:33]
  s_cbranch_vccnz wk_af_no
  v_cmp_ne_u64 vcc, s[88:89], v[34:35]
  s_cbranch_vccnz wk_af_no
  s_branch wk_af_ok
wk_af_no:
  s_sleep 4
  s_add_u32 s30, s30, 1
  s_and_b32 s20, s30, 63
  s_cbranch_scc1 wk_ns
  s_mov_b32 s20, 1
  s_mov_b32 s70, 0
  s_mov_b32 s21, 0
  s_mov_b64 exec, 1
wk_st_l:
  s_cmp_lg_u32 s70, -1
  s_cbranch_scc1 wk_st_t
  s_add_u32 s20, s20, 1
  s_cmp_lt_u32 s20, 8
  s_cselect_b32 s20, s20, 1
  s_mov_b32 s70, 0
  s_mov_b32 s3, -1
  s_add_u32 s21, s21, 1
  s_cmp_ge_u32 s21, 7
  s_cbranch_scc1 wk_st_d
wk_st_t:
  s_ff0_i32_b32 s22, s70
  s_lshl_b32 s23, 1, s22
  s_and_b32 s71, s20, 4
  s_mul_i32 s71, s71, 12
  s_lshl_b32 s3, s20, 2
  s_add_u32 s3, s3, s71
  v_mov_b32 v242, s23
  v_mov_b32 v243, 32
  buffer_atomic_or v242, v243, s[12:15], s3 offen sc0
  s_waitcnt vmcnt(0)
  v_readfirstlane_b32 s70, v242
  s_lshl_b32 s3, s20, 5
  s_add_u32 s3, s3, s22
  s_bitcmp1_b32 s70, s22
  s_cbranch_scc1 wk_st_l
wk_st_d:
  s_mov_b64 exec, -1
  v_mov_b32 v242, s3
  s_cmp_lg_u32 s3, -1
  s_cbranch_scc1 wk_pd
  s_add_u32 s20, s67, 1
  s_lshl_b32 s22, s20, 11
  s_add_u32 s22, s22, 88602624
wk_ns:
  s_cmp_lt_u32 s30, 50000
  s_cbranch_scc1 wk_af
  s_branch cA_abort
wk_af_ok:
  v_mov_b32 v242, -1
wk_pd:
w0_32:
  v_mov_b32 v243, 160000
  s_add_u32 s101, s101, 1
  s_barrier
  s_mov_b64 exec, 1
  s_cmp_lg_u32 s16, 0
  s_cbranch_scc1 w0_33
  ds_write_b32 v243, v242 offset:0
  s_waitcnt lgkmcnt(0)
  v_mov_b32 v242, s101
  ds_write_b32 v243, v242 offset:16
  s_waitcnt lgkmcnt(0)
w0_33:
  s_mov_b64 exec, -1
  s_barrier
  ds_read_b32 v242, v243 offset:0
  ds_read_b32 v243, v243 offset:16
  s_waitcnt lgkmcnt(0)
  v_readfirstlane_b32 s3, v242
  v_cmp_ne_u32 vcc, s101, v243
  s_cbranch_vccnz ch_end
  s_cmp_lg_u32 s3, -1
  s_cbranch_scc1 m_bjob
  s_mov_b32 s3, s68
  s_mov_b32 s97, 1
wk_go:
  s_cmp_lt_u32 s3, 368
  s_cbranch_scc1 wk_g2
  s_sub_u32 s20, s3, 432
  s_cmp_lt_u32 s20, 128
  s_cbranch_scc1 wk_g2
  s_cmp_eq_u32 s97, 2
  s_cbranch_scc1 wk_g2
  s_getreg_b32 s20, hwreg(HW_REG_XCC_ID)
  s_and_b32 s20, s20, 7
  s_cmp_lg_u32 s16, 0
  s_cbranch_scc1 w0_34
  s_lshl_b32 s22, s20, 11
  s_add_u32 s22, s22, 88637440
  v_add_u32 v24, 1024, v2
  v_min_u32 v24, 1776, v24
  s_mov_b32 s30, 0
wk_i2:
  buffer_load_dwordx4 v[28:31], v2, s[8:11], s22 offen sc1
  buffer_load_dwordx4 v[32:35], v24, s[8:11], s22 offen sc1
  s_waitcnt vmcnt(0)
  v_cmp_ne_u64 vcc, s[88:89], v[28:29]
  s_cbranch_vccnz wk_i2_no
  v_cmp_ne_u64 vcc, s[88:89], v[30:31]
  s_cbranch_vccnz wk_i2_no
  v_cmp_ne_u64 vcc, s[88:89], v[32:33]
  s_cbranch_vccnz wk_i2_no
  v_cmp_ne_u64 vcc, s[88:89], v[34:35]
  s_cbranch_vccnz wk_i2_no
  s_branch wk_i2_ok
wk_i2_no:
  s_sleep 4
  s_add_u32 s30, s30, 1
  s_cmp_lt_u32 s30, 50000
  s_cbranch_scc1 wk_i2
  s_branch cA_abort
wk_i2_ok:
w0_34:
  v_mov_b32 v242, 0
  v_mov_b32 v243, 160000
  s_add_u32 s101, s101, 1
  s_barrier
  s_mov_b64 exec, 1
  s_cmp_lg_u32 s16, 0
  s_cbranch_scc1 w0_35
  ds_write_b32 v243, v242 offset:0
  s_waitcnt lgkmcnt(0)
  v_mov_b32 v242, s101
  ds_write_b32 v243, v242 offset:16
  s_waitcnt lgkmcnt(0)
w0_35:
  s_mov_b64 exec, -1
  s_barrier
  ds_read_b32 v242, v243 offset:0
  ds_read_b32 v243, v243 offset:16
  s_waitcnt lgkmcnt(0)
  v_readfirstlane_b32 s20, v242
  v_cmp_ne_u32 vcc, s101, v243
  s_cbranch_vccnz ch_end
  s_mov_b32 s97, 2
wk_g2:
  s_cmp_ge_u32 s3, 864
  s_cbranch_scc1 wk_tok
  s_cmp_ge_u32 s3, 752
  s_cbranch_scc1 wk_s4d
  s_cmp_ge_u32 s3, 624
  s_cbranch_scc1 wk_f
  s_cmp_ge_u32 s3, 560
  s_cbranch_scc1 wk_vf
  s_cmp_ge_u32 s3, 432
  s_cbranch_scc1 wk_a
  s_cmp_ge_u32 s3, 368
  s_cbranch_scc1 wk_vh
  s_cmp_ge_u32 s3, 256
  s_cbranch_scc1 wk_v7
  s_cmp_ge_u32 s3, 224
  s_cbranch_scc1 wk_srv
  s_sub_u32 s20, s3, 0
  s_cmp_ge_u32 s20, 112
  s_cselect_b32 s18, 1, 0
  s_cselect_b32 s21, 112, 0
  s_sub_u32 s20, s20, s21
  s_and_b32 s17, s20, 15
  s_add_u32 s17, s17, 16
  s_lshr_b32 s34, s20, 4
  s_lshl_b32 s34, s34, 1
  s_add_u32 s35, s34, 2
  s_cmp_eq_u32 s18, 0
  s_cbranch_scc1 wf_nw
  s_and_b32 s20, s3, 3
  s_lshl_b32 s20, s20, 3
  s_add_u32 s20, s20, 8
  s_cmp_eq_u32 s16, 0
  s_cselect_b32 s20, 0, s20
  s_cmp_ge_u32 s16, 2
  s_cselect_b32 s20, 112, s20
  s_load_dwordx2 s[72:73], s[0:1], s20
  s_lshr_b32 s21, s3, 2
  s_lshl_b32 s21, s21, 12
  s_mov_b32 s74, 229376
  s_lshl_b32 s22, s3, 13
  s_cmp_eq_u32 s16, 0
  s_cselect_b32 s21, s22, s21
  s_cselect_b32 s74, 1835008, s74
  s_lshl_b32 s22, s3, 1
  s_add_u32 s22, s22, s16
  s_sub_u32 s22, s22, 2
  s_lshl_b32 s22, s22, 13
  s_cmp_ge_u32 s16, 2
  s_cselect_b32 s21, s22, s21
  s_cselect_b32 s74, 3670016, s74
  v_lshlrev_b32 v6, 3, v2
  s_cmp_lt_u32 s16, 2
  s_cbranch_scc1 lw_36
  s_lshl_b32 s21, s3, 6
  v_add_u32 v6, s21, v1
  v_mul_u32_u24 v7, 37450, v6
  v_lshrrev_b32 v7, 18, v7
  v_add_u32 v7, 1, v7
  v_mul_u32_u24 v7, 7, v7
  v_add_u32 v6, v6, v7
  v_lshlrev_b32 v6, 7, v6
  s_mov_b32 s21, 0
  s_cmp_eq_u32 s16, 3
  s_cselect_b32 s74, 0, s74
lw_36:
  s_cmp_eq_u32 s16, 1
  s_cselect_b32 exec_hi, 0, -1
  s_waitcnt lgkmcnt(0)
  s_and_b32 s73, s73, 0xffff
  s_mov_b32 s75, 0x20000
  buffer_load_dword v7, v6, s[72:75], s21 offen
  s_mov_b64 exec, -1
  s_sub_u32 s3, s3, 112
  s_and_b32 s20, s3, 3
  s_lshl_b32 s20, s20, 3
  s_add_u32 s20, s20, 8
  s_cmp_eq_u32 s16, 0
  s_cselect_b32 s20, 0, s20
  s_cmp_ge_u32 s16, 2
  s_cselect_b32 s20, 112, s20
  s_load_dwordx2 s[72:73], s[0:1], s20
  s_lshr_b32 s21, s3, 2
  s_lshl_b32 s21, s21, 12
  s_mov_b32 s74, 229376
  s_lshl_b32 s22, s3, 13
  s_cmp_eq_u32 s16, 0
  s_cselect_b32 s21, s22, s21
  s_cselect_b32 s74, 1835008, s74
  s_lshl_b32 s22, s3, 1
  s_add_u32 s22, s22, s16
  s_sub_u32 s22, s22, 2
  s_lshl_b32 s22, s22, 13
  s_cmp_ge_u32 s16, 2
  s_cselect_b32 s21, s22, s21
  s_cselect_b32 s74, 3670016, s74
  v_lshlrev_b32 v6, 3, v2
  s_cmp_lt_u32 s16, 2
  s_cbranch_scc1 lw_37
  s_lshl_b32 s21, s3, 6
  v_add_u32 v6, s21, v1
  v_mul_u32_u24 v7, 37450, v6
  v_lshrrev_b32 v7, 18, v7
  v_add_u32 v7, 1, v7
  v_mul_u32_u24 v7, 7, v7
  v_add_u32 v6, v6, v7
  v_lshlrev_b32 v6, 7, v6
  s_mov_b32 s21, 0
  s_cmp_eq_u32 s16, 3
  s_cselect_b32 s74, 0, s74
lw_37:
  s_cmp_eq_u32 s16, 1
  s_cselect_b32 exec_hi, 0, -1
  s_waitcnt lgkmcnt(0)
  s_and_b32 s73, s73, 0xffff
  s_mov_b32 s75, 0x20000
  buffer_load_dword v7, v6, s[72:75], s21 offen
  s_mov_b64 exec, -1
  s_add_u32 s3, s3, 112
wf_nw:
  s_lshl_b32 s20, s18, 3
  s_lshl_b32 s21, s16, 1
  s_add_u32 s20, s20, s21
  s_mul_i32 s21, s20, 14336
  s_add_u32 s21, s21, 71565312
  s_add_u32 s22, s21, 0
  buffer_load_dwordx4 a[0:3], v2, s[8:11], s22 offen offset:0 sc1
  buffer_load_dwordx4 a[4:7], v2, s[8:11], s22 offen offset:1024 sc1
  buffer_load_dwordx4 a[8:11], v2, s[8:11], s22 offen offset:2048 sc1
  buffer_load_dwordx4 a[12:15], v2, s[8:11], s22 offen offset:3072 sc1
  s_add_u32 s22, s21, 4096
  buffer_load_dwordx4 a[16:19], v2, s[8:11], s22 offen offset:0 sc1
  buffer_load_dwordx4 a[20:23], v2, s[8:11], s22 offen offset:1024 sc1
  buffer_load_dwordx4 a[24:27], v2, s[8:11], s22 offen offset:2048 sc1
  buffer_load_dwordx4 a[28:31], v2, s[8:11], s22 offen offset:3072 sc1
  s_add_u32 s22, s21, 8192
  buffer_load_dwordx4 a[32:35], v2, s[8:11], s22 offen offset:0 sc1
  buffer_load_dwordx4 a[36:39], v2, s[8:11], s22 offen offset:1024 sc1
  buffer_load_dwordx4 a[40:43], v2, s[8:11], s22 offen offset:2048 sc1
  buffer_load_dwordx4 a[44:47], v2, s[8:11], s22 offen offset:3072 sc1
  s_add_u32 s22, s21, 12288
  buffer_load_dwordx4 a[48:51], v2, s[8:11], s22 offen offset:0 sc1
  buffer_load_dwordx4 a[52:55], v2, s[8:11], s22 offen offset:1024 sc1
  buffer_load_dwordx4 a[56:59], v2, s[8:11], s22 offen offset:2048 sc1
  buffer_load_dwordx4 a[60:63], v2, s[8:11], s22 offen offset:3072 sc1
  s_add_u32 s22, s21, 16384
  buffer_load_dwordx4 a[64:67], v2, s[8:11], s22 offen offset:0 sc1
  buffer_load_dwordx4 a[68:71], v2, s[8:11], s22 offen offset:1024 sc1
  buffer_load_dwordx4 a[72:75], v2, s[8:11], s22 offen offset:2048 sc1
  buffer_load_dwordx4 a[76:79], v2, s[8:11], s22 offen offset:3072 sc1
  s_add_u32 s22, s21, 20480
  buffer_load_dwordx4 a[80:83], v2, s[8:11], s22 offen offset:0 sc1
  buffer_load_dwordx4 a[84:87], v2, s[8:11], s22 offen offset:1024 sc1
  buffer_load_dwordx4 a[88:91], v2, s[8:11], s22 offen offset:2048 sc1
  buffer_load_dwordx4 a[92:95], v2, s[8:11], s22 offen offset:3072 sc1
  s_add_u32 s22, s21, 24576
  buffer_load_dwordx4 a[96:99], v2, s[8:11], s22 offen offset:0 sc1
  buffer_load_dwordx4 a[100:103], v2, s[8:11], s22 offen offset:1024 sc1
  buffer_load_dwordx4 a[104:107], v2, s[8:11], s22 offen offset:2048 sc1
  buffer_load_dwordx4 a[108:111], v2, s[8:11], s22 offen offset:3072 sc1
  s_waitcnt vmcnt(40)
  s_mul_i32 s23, s17, 401408
  s_and_b32 s22, s16, 1
  s_mul_i32 s22, s22, 7168
  s_add_u32 s23, s23, s22
  s_add_u32 s23, s23, 0
  s_lshr_b32 s22, s16, 1
  s_mul_i32 s22, s22, 14336
  s_add_u32 s23, s23, s22
  s_mul_i32 s27, s16, 7168
  s_lshr_b32 s28, s20, 1
wf_vo:
  s_sub_u32 s29, s17, 16
  s_lshl_b32 s29, s29, 6
  s_add_u32 s29, s29, s28
  s_mul_i32 s29, s29, 28672
  s_add_u32 s29, s29, 42205184
  v_lshlrev_b32 v6, 4, v3
  v_mad_u32_u24 v7, v3, 12, 64
  s_mov_b32 s31, 0
  s_lshl_b32 s24, s34, 1
  s_mul_i32 s24, s24, 14336
  s_add_u32 s24, s24, s23
  s_cmp_lt_u32 s34, s35
  s_cselect_b32 s24, s24, 0x10000000
  s_add_u32 m0, s31, s27
  s_nop 0
  buffer_load_dwordx4 v2, s[8:11], s24 offen offset:0 sc1 lds
  buffer_load_dwordx4 v2, s[8:11], s24 offen offset:1024 sc1 lds
  buffer_load_dwordx4 v2, s[8:11], s24 offen offset:2048 sc1 lds
  buffer_load_dwordx4 v2, s[8:11], s24 offen offset:3072 sc1 lds
  s_add_u32 m0, m0, 4096
  s_add_u32 s24, s24, 4096
  buffer_load_dwordx4 v2, s[8:11], s24 offen offset:0 sc1 lds
  buffer_load_dwordx4 v2, s[8:11], s24 offen offset:1024 sc1 lds
  buffer_load_dwordx4 v2, s[8:11], s24 offen offset:2048 sc1 lds
  s_add_u32 s30, s34, 1
  s_mov_b32 s31, 28672
  s_lshl_b32 s24, s30, 1
  s_mul_i32 s24, s24, 14336
  s_add_u32 s24, s24, s23
  s_cmp_lt_u32 s30, s35
  s_cselect_b32 s24, s24, 0x10000000
  s_add_u32 m0, s31, s27
  s_nop 0
  buffer_load_dwordx4 v2, s[8:11], s24 offen offset:0 sc1 lds
  buffer_load_dwordx4 v2, s[8:11], s24 offen offset:1024 sc1 lds
  buffer_load_dwordx4 v2, s[8:11], s24 offen offset:2048 sc1 lds
  buffer_load_dwordx4 v2, s[8:11], s24 offen offset:3072 sc1 lds
  s_add_u32 m0, m0, 4096
  s_add_u32 s24, s24, 4096
  buffer_load_dwordx4 v2, s[8:11], s24 offen offset:0 sc1 lds
  buffer_load_dwordx4 v2, s[8:11], s24 offen offset:1024 sc1 lds
  buffer_load_dwordx4 v2, s[8:11], s24 offen offset:2048 sc1 lds
  s_mov_b32 s19, s34
  s_mov_b32 s32, 0
  s_mov_b32 s33, 57344
  s_waitcnt vmcnt(7)
  s_branch wf_vo_in
wf_vo_loop:
  s_waitcnt vmcnt(9)
wf_vo_in:
  s_barrier
  s_add_u32 s30, s19, 2
  s_lshl_b32 s24, s30, 1
  s_mul_i32 s24, s24, 14336
  s_add_u32 s24, s24, s23
  s_cmp_lt_u32 s30, s35
  s_cselect_b32 s24, s24, 0x10000000
  s_add_u32 m0, s33, s27
  s_nop 0
  buffer_load_dwordx4 v2, s[8:11], s24 offen offset:0 sc1 lds
  buffer_load_dwordx4 v2, s[8:11], s24 offen offset:1024 sc1 lds
  buffer_load_dwordx4 v2, s[8:11], s24 offen offset:2048 sc1 lds
  buffer_load_dwordx4 v2, s[8:11], s24 offen offset:3072 sc1 lds
  s_add_u32 m0, m0, 4096
  s_add_u32 s24, s24, 4096
  buffer_load_dwordx4 v2, s[8:11], s24 offen offset:0 sc1 lds
  buffer_load_dwordx4 v2, s[8:11], s24 offen offset:1024 sc1 lds
  buffer_load_dwordx4 v2, s[8:11], s24 offen offset:2048 sc1 lds
  v_add_u32 v5, s32, v2
  ds_read_b128 v[8:11], v5 offset:0
  ds_read_b128 v[12:15], v5 offset:14336
  ds_read_b128 v[16:19], v5 offset:1024
  ds_read_b128 v[20:23], v5 offset:15360
  ds_read_b128 v[24:27], v5 offset:2048
  ds_read_b128 v[28:31], v5 offset:16384
  ds_read_b128 v[32:35], v5 offset:3072
  s_waitcnt lgkmcnt(6)
  v_mfma_f32_16x16x32_bf16 v[40:43], a[0:3], v[8:11], 0
  v_mfma_f32_16x16x32_bf16 v[44:47], a[56:59], v[8:11], 0
  ds_read_b128 v[36:39], v5 offset:17408
  s_waitcnt lgkmcnt(6)
  v_mfma_f32_16x16x32_bf16 v[56:59], a[0:3], v[12:15], 0
  v_mfma_f32_16x16x32_bf16 v[60:63], a[56:59], v[12:15], 0
  ds_read_b128 v[8:11], v5 offset:4096
  s_waitcnt lgkmcnt(6)
  v_mfma_f32_16x16x32_bf16 v[40:43], a[4:7], v[16:19], v[40:43]
  v_mfma_f32_16x16x32_bf16 v[44:47], a[60:63], v[16:19], v[44:47]
  ds_read_b128 v[12:15], v5 offset:18432
  s_waitcnt lgkmcnt(6)
  v_mfma_f32_16x16x32_bf16 v[56:59], a[4:7], v[20:23], v[56:59]
  v_mfma_f32_16x16x32_bf16 v[60:63], a[60:63], v[20:23], v[60:63]
  ds_read_b128 v[16:19], v5 offset:5120
  s_waitcnt lgkmcnt(6)
  v_mfma_f32_16x16x32_bf16 v[40:43], a[8:11], v[24:27], v[40:43]
  v_mfma_f32_16x16x32_bf16 v[44:47], a[64:67], v[24:27], v[44:47]
  ds_read_b128 v[20:23], v5 offset:19456
  s_waitcnt lgkmcnt(6)
  v_mfma_f32_16x16x32_bf16 v[56:59], a[8:11], v[28:31], v[56:59]
  v_mfma_f32_16x16x32_bf16 v[60:63], a[64:67], v[28:31], v[60:63]
  ds_read_b128 v[24:27], v5 offset:6144
  s_waitcnt lgkmcnt(6)
  v_mfma_f32_16x16x32_bf16 v[40:43], a[12:15], v[32:35], v[40:43]
  v_mfma_f32_16x16x32_bf16 v[44:47], a[68:71], v[32:35], v[44:47]
  ds_read_b128 v[28:31], v5 offset:20480
  s_waitcnt lgkmcnt(6)
  v_mfma_f32_16x16x32_bf16 v[56:59], a[12:15], v[36:39], v[56:59]
  v_mfma_f32_16x16x32_bf16 v[60:63], a[68:71], v[36:39], v[60:63]
  ds_read_b128 v[32:35], v5 offset:7168
  s_waitcnt lgkmcnt(6)
  v_mfma_f32_16x16x32_bf16 v[40:43], a[16:19], v[8:11], v[40:43]
  v_mfma_f32_16x16x32_bf16 v[44:47], a[72:75], v[8:11], v[44:47]
  ds_read_b128 v[36:39], v5 offset:21504
  s_waitcnt lgkmcnt(6)
  v_mfma_f32_16x16x32_bf16 v[56:59], a[16:19], v[12:15], v[56:59]
  v_mfma_f32_16x16x32_bf16 v[60:63], a[72:75], v[12:15], v[60:63]
  ds_read_b128 v[8:11], v5 offset:8192
  s_waitcnt lgkmcnt(6)
  v_mfma_f32_16x16x32_bf16 v[40:43], a[20:23], v[16:19], v[40:43]
  v_mfma_f32_16x16x32_bf16 v[44:47], a[76:79], v[16:19], v[44:47]
  ds_read_b128 v[12:15], v5 offset:22528
  s_waitcnt lgkmcnt(6)
  v_mfma_f32_16x16x32_bf16 v[56:59], a[20:23], v[20:23], v[56:59]
  v_mfma_f32_16x16x32_bf16 v[60:63], a[76:79], v[20:23], v[60:63]
  ds_read_b128 v[16:19], v5 offset:9216
  s_waitcnt lgkmcnt(6)
  v_mfma_f32_16x16x32_bf16 v[40:43], a[24:27], v[24:27], v[40:43]
  v_mfma_f32_16x16x32_bf16 v[44:47], a[80:83], v[24:27], v[44:47]
  ds_read_b128 v[20:23], v5 offset:23552
  s_waitcnt lgkmcnt(6)
  v_mfma_f32_16x16x32_bf16 v[56:59], a[24:27], v[28:31], v[56:59]
  v_mfma_f32_16x16x32_bf16 v[60:63], a[80:83], v[28:31], v[60:63]
  ds_read_b128 v[24:27], v5 offset:10240
  s_waitcnt lgkmcnt(6)
  v_mfma_f32_16x16x32_bf16 v[40:43], a[28:31], v[32:35], v[40:43]
  v_mfma_f32_16x16x32_bf16 v[44:47], a[84:87], v[32:35], v[44:47]
  ds_read_b128 v[28:31], v5 offset:24576
  s_waitcnt lgkmcnt(6)
  v_mfma_f32_16x16x32_bf16 v[56:59], a[28:31], v[36:39], v[56:59]
  v_mfma_f32_16x16x32_bf16 v[60:63], a[84:87], v[36:39], v[60:63]
  ds_read_b128 v[32:35], v5 offset:11264
  s_waitcnt lgkmcnt(6)
  v_mfma_f32_16x16x32_bf16 v[40:43], a[32:35], v[8:11], v[40:43]
  v_mfma_f32_16x16x32_bf16 v[44:47], a[88:91], v[8:11], v[44:47]
  ds_read_b128 v[36:39], v5 offset:25600
  s_waitcnt lgkmcnt(6)
  v_mfma_f32_16x16x32_bf16 v[56:59], a[32:35], v[12:15], v[56:59]
  v_mfma_f32_16x16x32_bf16 v[60:63], a[88:91], v[12:15], v[60:63]
  ds_read_b128 v[8:11], v5 offset:12288
  s_waitcnt lgkmcnt(6)
  v_mfma_f32_16x16x32_bf16 v[40:43], a[36:39], v[16:19], v[40:43]
  v_mfma_f32_16x16x32_bf16 v[44:47], a[92:95], v[16:19], v[44:47]
  ds_read_b128 v[12:15], v5 offset:26624
  s_waitcnt lgkmcnt(6)
  v_mfma_f32_16x16x32_bf16 v[56:59], a[36:39], v[20:23], v[56:59]
  v_mfma_f32_16x16x32_bf16 v[60:63], a[92:95], v[20:23], v[60:63]
  ds_read_b128 v[16:19], v5 offset:13312
  s_waitcnt lgkmcnt(6)
  v_mfma_f32_16x16x32_bf16 v[40:43], a[40:43], v[24:27], v[40:43]
  v_mfma_f32_16x16x32_bf16 v[44:47], a[96:99], v[24:27], v[44:47]
  ds_read_b128 v[20:23], v5 offset:27648
  s_waitcnt lgkmcnt(6)
  v_mfma_f32_16x16x32_bf16 v[56:59], a[40:43], v[28:31], v[56:59]
  v_mfma_f32_16x16x32_bf16 v[60:63], a[96:99], v[28:31], v[60:63]
  s_waitcnt lgkmcnt(5)
  v_mfma_f32_16x16x32_bf16 v[40:43], a[44:47], v[32:35], v[40:43]
  v_mfma_f32_16x16x32_bf16 v[44:47], a[100:103], v[32:35], v[44:47]
  s_waitcnt lgkmcnt(4)
  v_mfma_f32_16x16x32_bf16 v[56:59], a[44:47], v[36:39], v[56:59]
  v_mfma_f32_16x16x32_bf16 v[60:63], a[100:103], v[36:39], v[60:63]
  s_waitcnt lgkmcnt(3)
  v_mfma_f32_16x16x32_bf16 v[40:43], a[48:51], v[8:11], v[40:43]
  v_mfma_f32_16x16x32_bf16 v[44:47], a[104:107], v[8:11], v[44:47]
  s_waitcnt lgkmcnt(2)
  v_mfma_f32_16x16x32_bf16 v[56:59], a[48:51], v[12:15], v[56:59]
  v_mfma_f32_16x16x32_bf16 v[60:63], a[104:107], v[12:15], v[60:63]
  s_waitcnt lgkmcnt(1)
  v_mfma_f32_16x16x32_bf16 v[40:43], a[52:55], v[16:19], v[40:43]
  v_mfma_f32_16x16x32_bf16 v[44:47], a[108:111], v[16:19], v[44:47]
  s_waitcnt lgkmcnt(0)
  v_mfma_f32_16x16x32_bf16 v[56:59], a[52:55], v[20:23], v[56:59]
  v_mfma_f32_16x16x32_bf16 v[60:63], a[108:111], v[20:23], v[60:63]
  s_add_u32 s25, s29, 28672
  s_lshl_b32 s24, s19, 5
  s_add_u32 s24, s24, 0
  v_add_u32 v88, s24, v4
  s_cmp_lt_u32 s19, 8
  s_cselect_b64 vcc, -1, 0
  s_cselect_b32 s24, 0, 256
  v_subrev_u32 v88, s24, v88
  s_movk_i32 s24, 5462
  s_cselect_b32 s24, 4096, s24
  v_mul_u32_u24 v89, s24, v88
  v_lshrrev_b32 v89, 16, v89
  s_movk_i32 s24, 100
  s_cselect_b32 s24, 96, s24
  v_mul_u32_u24 v89, s24, v89
  v_cndmask_b32 v92, v7, v6, vcc
  v_add3_u32 v88, v88, v89, v92
  v_lshlrev_b32 v90, 4, v88
  v_cvt_pk_bf16_f32 v72, v40, v41
  v_cvt_pk_bf16_f32 v73, v42, v43
  v_cvt_pk_bf16_f32 v74, v44, v45
  v_cvt_pk_bf16_f32 v75, v46, v47
  buffer_store_dwordx4 v[72:75], v90, s[8:11], s29 offen sc1
  s_lshl_b32 s24, s19, 5
  s_add_u32 s24, s24, 16
  v_add_u32 v88, s24, v4
  s_cmp_lt_u32 s19, 8
  s_cselect_b64 vcc, -1, 0
  s_cselect_b32 s24, 0, 256
  v_subrev_u32 v88, s24, v88
  s_movk_i32 s24, 5462
  s_cselect_b32 s24, 4096, s24
  v_mul_u32_u24 v89, s24, v88
  v_lshrrev_b32 v89, 16, v89
  s_movk_i32 s24, 100
  s_cselect_b32 s24, 96, s24
  v_mul_u32_u24 v89, s24, v89
  v_cndmask_b32 v92, v7, v6, vcc
  v_add3_u32 v88, v88, v89, v92
  v_lshlrev_b32 v91, 4, v88
  v_cvt_pk_bf16_f32 v80, v56, v57
  v_cvt_pk_bf16_f32 v81, v58, v59
  v_cvt_pk_bf16_f32 v82, v60, v61
  v_cvt_pk_bf16_f32 v83, v62, v63
  buffer_store_dwordx4 v[80:83], v91, s[8:11], s29 offen sc1
  s_mov_b32 s33, s32
  s_add_u32 s32, s32, 28672
  s_cmp_eq_u32 s32, 86016
  s_cselect_b32 s32, 0, s32
  s_add_u32 s19, s19, 1
  s_cmp_lt_u32 s19, s35
  s_cbranch_scc1 wf_vo_loop
  s_branch wf_done
wf_done:
  s_lshr_b32 s20, s18, 1
  s_lshl_b32 s20, s20, 4
  s_and_b32 s21, s17, 15
  s_add_u32 s20, s20, s21
  s_lshl_b32 s20, s20, 7
  s_cmp_lt_u32 s17, 16
  s_cselect_b32 s21, 16384, 0
  s_add_u32 s20, s20, s21
  s_add_u32 s20, s20, 88541184
  s_sub_u32 s21, s35, s34
  s_lshr_b32 s21, s21, 1
  v_mov_b32 v5, s21
  v_mov_b32 v6, 0
  s_waitcnt vmcnt(0)
  s_mov_b64 exec, 1
  s_cmp_lg_u32 s18, 0
  s_cbranch_scc1 wf_h1
  v_mov_b32 v7, 2
  s_sub_u32 s21, s20, 2048
  buffer_atomic_add v7, v6, s[8:11], s21 offen
wf_h1:
  buffer_atomic_add v5, v6, s[8:11], s20 offen
  s_mov_b64 exec, -1
  s_load_dwordx8 s[36:43], s[0:1], 56
  s_load_dwordx4 s[44:47], s[0:1], 88
  s_waitcnt lgkmcnt(0)
  s_mov_b32 s52, s36
  s_and_b32 s53, s37, 0xffff
  s_mov_b32 s54, 1835008
  s_mov_b32 s55, 0x20000
  s_lshl_b32 s20, s3, 8
  v_add_u32 v95, s20, v0
  s_mov_b32 s21, 9586981
  v_mul_hi_u32 v6, v95, s21
  v_mul_u32_u24 v7, 448, v6
  v_sub_u32 v7, v95, v7
  v_lshrrev_b32 v8, 4, v7
  v_and_b32 v7, 15, v7
  v_lshl_add_u32 v9, v6, 4, v7
  v_mul_u32_u24 v9, 896, v9
  v_lshl_add_u32 v9, v8, 5, v9
  buffer_load_dwordx4 v[84:87], v9, s[52:55], 0 offen
  buffer_load_dwordx4 v[88:91], v9, s[52:55], 0 offen offset:16
  v_mul_u32_u24 v6, 14336, v6
  v_lshl_add_u32 v6, v7, 4, v6
  v_lshl_add_u32 v92, v8, 9, v6
  v_lshrrev_b32 v7, 2, v8
  v_lshl_add_u32 v6, v7, 11, v6
  v_and_b32 v7, 3, v8
  v_lshl_add_u32 v93, v7, 8, v6
  v_mov_b32 v52, -1
  v_mov_b32 v53, -1
  v_mov_b32 v54, -1
  v_mov_b32 v55, -1
  s_mov_b32 s23, 89063424
  v_lshlrev_b32 v8, 4, v95
  buffer_store_dwordx4 v[52:55], v8, s[8:11], s23 offen sc1
  v_add_u32 v8, 917504, v8
  v_mov_b32 v9, 0x10000000
  v_cmp_lt_u32 vcc, 1535, v95
  s_nop 1
  v_cndmask_b32 v8, v8, v9, vcc
  buffer_store_dwordx4 v[52:55], v8, s[8:11], s23 offen sc1
  s_waitcnt vmcnt(1)
  v_mov_b32 v96, v84
  v_mov_b32 v100, v85
  v_mov_b32 v97, v86
  v_mov_b32 v101, v87
  v_mov_b32 v98, v88
  v_mov_b32 v102, v89
  v_mov_b32 v99, v90
  v_mov_b32 v103, v91
  s_mov_b32 s20, 71565312
  s_mov_b32 s21, 73400320
  buffer_store_dwordx4 v[96:99], v93, s[8:11], s21 offen sc1
  buffer_store_dwordx4 v[100:103], v93, s[8:11], s21 offen offset:1024 sc1
  s_cmp_lt_u32 s3, 70
  s_cbranch_scc1 i2_nx
  buffer_store_dwordx4 v[84:87], v92, s[8:11], s20 offen sc1
  buffer_store_dwordx4 v[88:91], v92, s[8:11], s20 offen offset:256 sc1
i2_nx:
  s_lshl_b32 s20, s3, 3
  s_add_u32 s20, s20, 88637440
  s_waitcnt vmcnt(0)
  s_barrier
  s_cmp_lg_u32 s16, 0
  s_cbranch_scc1 pub_38
  v_mul_u32_u24 v26, 2048, v1
  v_mov_b32 v24, s88
  v_mov_b32 v25, s89
  s_mov_b64 exec, 255
  buffer_store_dwordx2 v[24:25], v26, s[8:11], s20 offen sc1
  s_mov_b64 exec, -1
pub_38:
  s_branch wk_loop
wk_v7:
  s_sub_u32 s20, s3, 256
  s_mov_b32 s18, 1
  s_and_b32 s17, s20, 15
  s_add_u32 s17, s17, 16
  s_lshr_b32 s34, s20, 4
  s_lshl_b32 s34, s34, 1
  s_add_u32 s35, s34, 2
  s_branch wk_gemm
wk_vh:
  s_sub_u32 s20, s3, 368
  s_and_b32 s17, s20, 15
  s_add_u32 s17, s17, 16
  s_lshr_b32 s18, s20, 5
  s_add_u32 s18, s18, 2
  s_bitcmp1_b32 s20, 4
  s_cselect_b32 s34, 7, 0
  s_add_u32 s35, s34, 7
  s_branch wk_gemm
wk_vf:
  s_sub_u32 s20, s3, 560
  s_and_b32 s17, s20, 15
  s_add_u32 s17, s17, 16
  s_lshr_b32 s18, s20, 4
  s_add_u32 s18, s18, 4
  s_mov_b32 s34, 0
  s_mov_b32 s35, 14
  s_branch wk_gemm
wk_f:
  s_sub_u32 s20, s3, 624
  s_and_b32 s17, s20, 15
  s_lshr_b32 s18, s20, 4
  s_mov_b32 s34, 0
  s_mov_b32 s35, 14
  s_lshl_b32 s22, s17, 7
  s_add_u32 s22, s22, 88633344
  s_add_u32 s23, s22, 2048
  v_min_u32 v24, 48, v2
  v_min_u32 v25, 96, v2
  s_mov_b32 s30, 0
wk_aw:
  buffer_load_dwordx4 v[28:31], v24, s[8:11], s22 offen sc1
  buffer_load_dwordx4 v[32:35], v25, s[8:11], s23 offen sc1
  s_waitcnt vmcnt(0)
  v_cmp_ne_u64 vcc, s[88:89], v[28:29]
  s_cbranch_vccnz wk_aw_no
  v_cmp_ne_u64 vcc, s[88:89], v[30:31]
  s_cbranch_vccnz wk_aw_no
  v_cmp_ne_u64 vcc, s[88:89], v[32:33]
  s_cbranch_vccnz wk_aw_no
  v_cmp_ne_u64 vcc, s[88:89], v[34:35]
  s_cbranch_vccnz wk_aw_no
  s_branch wk_aw_ok
wk_aw_no:
  s_sleep 6
  s_add_u32 s30, s30, 1
  s_cmp_lt_u32 s30, 50000
  s_cbranch_scc1 wk_aw
  s_branch cA_abort
wk_aw_ok:
wk_gemm:
  s_lshl_b32 s20, s18, 4
  s_lshl_b32 s21, s16, 2
  s_add_u32 s20, s20, s21
  s_mul_i32 s21, s20, 14336
  s_add_u32 s21, s21, 71565312
  s_add_u32 s22, s21, 0
  buffer_load_dwordx4 a[0:3], v2, s[8:11], s22 offen offset:0 sc1
  buffer_load_dwordx4 a[4:7], v2, s[8:11], s22 offen offset:1024 sc1
  buffer_load_dwordx4 a[8:11], v2, s[8:11], s22 offen offset:2048 sc1
  buffer_load_dwordx4 a[12:15], v2, s[8:11], s22 offen offset:3072 sc1
  s_add_u32 s22, s21, 4096
  buffer_load_dwordx4 a[16:19], v2, s[8:11], s22 offen offset:0 sc1
  buffer_load_dwordx4 a[20:23], v2, s[8:11], s22 offen offset:1024 sc1
  buffer_load_dwordx4 a[24:27], v2, s[8:11], s22 offen offset:2048 sc1
  buffer_load_dwordx4 a[28:31], v2, s[8:11], s22 offen offset:3072 sc1
  s_add_u32 s22, s21, 8192
  buffer_load_dwordx4 a[32:35], v2, s[8:11], s22 offen offset:0 sc1
  buffer_load_dwordx4 a[36:39], v2, s[8:11], s22 offen offset:1024 sc1
  buffer_load_dwordx4 a[40:43], v2, s[8:11], s22 offen offset:2048 sc1
  buffer_load_dwordx4 a[44:47], v2, s[8:11], s22 offen offset:3072 sc1
  s_add_u32 s22, s21, 12288
  buffer_load_dwordx4 a[48:51], v2, s[8:11], s22 offen offset:0 sc1
  buffer_load_dwordx4 a[52:55], v2, s[8:11], s22 offen offset:1024 sc1
  buffer_load_dwordx4 a[56:59], v2, s[8:11], s22 offen offset:2048 sc1
  buffer_load_dwordx4 a[60:63], v2, s[8:11], s22 offen offset:3072 sc1
  s_add_u32 s22, s21, 16384
  buffer_load_dwordx4 a[64:67], v2, s[8:11], s22 offen offset:0 sc1
  buffer_load_dwordx4 a[68:71], v2, s[8:11], s22 offen offset:1024 sc1
  buffer_load_dwordx4 a[72:75], v2, s[8:11], s22 offen offset:2048 sc1
  buffer_load_dwordx4 a[76:79], v2, s[8:11], s22 offen offset:3072 sc1
  s_add_u32 s22, s21, 20480
  buffer_load_dwordx4 a[80:83], v2, s[8:11], s22 offen offset:0 sc1
  buffer_load_dwordx4 a[84:87], v2, s[8:11], s22 offen offset:1024 sc1
  buffer_load_dwordx4 a[88:91], v2, s[8:11], s22 offen offset:2048 sc1
  buffer_load_dwordx4 a[92:95], v2, s[8:11], s22 offen offset:3072 sc1
  s_add_u32 s22, s21, 24576
  buffer_load_dwordx4 a[96:99], v2, s[8:11], s22 offen offset:0 sc1
  buffer_load_dwordx4 a[100:103], v2, s[8:11], s22 offen offset:1024 sc1
  buffer_load_dwordx4 a[104:107], v2, s[8:11], s22 offen offset:2048 sc1
  buffer_load_dwordx4 a[108:111], v2, s[8:11], s22 offen offset:3072 sc1
  s_add_u32 s22, s21, 28672
  buffer_load_dwordx4 a[112:115], v2, s[8:11], s22 offen offset:0 sc1
  buffer_load_dwordx4 a[116:119], v2, s[8:11], s22 offen offset:1024 sc1
  buffer_load_dwordx4 a[120:123], v2, s[8:11], s22 offen offset:2048 sc1
  buffer_load_dwordx4 a[124:127], v2, s[8:11], s22 offen offset:3072 sc1
  s_add_u32 s22, s21, 32768
  buffer_load_dwordx4 a[128:131], v2, s[8:11], s22 offen offset:0 sc1
  buffer_load_dwordx4 a[132:135], v2, s[8:11], s22 offen offset:1024 sc1
  buffer_load_dwordx4 a[136:139], v2, s[8:11], s22 offen offset:2048 sc1
  buffer_load_dwordx4 a[140:143], v2, s[8:11], s22 offen offset:3072 sc1
  s_add_u32 s22, s21, 36864
  buffer_load_dwordx4 a[144:147], v2, s[8:11], s22 offen offset:0 sc1
  buffer_load_dwordx4 a[148:151], v2, s[8:11], s22 offen offset:1024 sc1
  buffer_load_dwordx4 a[152:155], v2, s[8:11], s22 offen offset:2048 sc1
  buffer_load_dwordx4 a[156:159], v2, s[8:11], s22 offen offset:3072 sc1
  s_add_u32 s22, s21, 40960
  buffer_load_dwordx4 a[160:163], v2, s[8:11], s22 offen offset:0 sc1
  buffer_load_dwordx4 a[164:167], v2, s[8:11], s22 offen offset:1024 sc1
  buffer_load_dwordx4 a[168:171], v2, s[8:11], s22 offen offset:2048 sc1
  buffer_load_dwordx4 a[172:175], v2, s[8:11], s22 offen offset:3072 sc1
  s_add_u32 s22, s21, 45056
  buffer_load_dwordx4 a[176:179], v2, s[8:11], s22 offen offset:0 sc1
  buffer_load_dwordx4 a[180:183], v2, s[8:11], s22 offen offset:1024 sc1
  buffer_load_dwordx4 a[184:187], v2, s[8:11], s22 offen offset:2048 sc1
  buffer_load_dwordx4 a[188:191], v2, s[8:11], s22 offen offset:3072 sc1
  s_add_u32 s22, s21, 49152
  buffer_load_dwordx4 a[192:195], v2, s[8:11], s22 offen offset:0 sc1
  buffer_load_dwordx4 a[196:199], v2, s[8:11], s22 offen offset:1024 sc1
  buffer_load_dwordx4 a[200:203], v2, s[8:11], s22 offen offset:2048 sc1
  buffer_load_dwordx4 a[204:207], v2, s[8:11], s22 offen offset:3072 sc1
  s_add_u32 s22, s21, 53248
  buffer_load_dwordx4 a[208:211], v2, s[8:11], s22 offen offset:0 sc1
  buffer_load_dwordx4 a[212:215], v2, s[8:11], s22 offen offset:1024 sc1
  buffer_load_dwordx4 a[216:219], v2, s[8:11], s22 offen offset:2048 sc1
  buffer_load_dwordx4 a[220:223], v2, s[8:11], s22 offen offset:3072 sc1
  s_waitcnt vmcnt(40)
  s_mul_i32 s23, s17, 401408
  s_and_b32 s22, s16, 1
  s_mul_i32 s22, s22, 7168
  s_add_u32 s23, s23, s22
  s_add_u32 s23, s23, 0
  s_lshr_b32 s22, s16, 1
  s_mul_i32 s22, s22, 14336
  s_add_u32 s23, s23, s22
  s_mul_i32 s27, s16, 7168
  s_lshr_b32 s28, s20, 1
  s_cmp_lt_u32 s17, 16
  s_cbranch_scc0 wg_vo
  s_add_u32 s23, s23, s22
  s_lshl_b32 s29, s28, 4
  s_add_u32 s29, s29, s17
  s_mul_i32 s29, s29, 28672
  s_add_u32 s29, s29, 12845056
  s_mov_b32 s31, 0
  s_lshr_b32 s24, s34, 1
  s_lshl_b32 s24, s24, 2
  s_and_b32 s25, s34, 1
  s_add_u32 s24, s24, s25
  s_mul_i32 s24, s24, 14336
  s_add_u32 s24, s24, s23
  s_cmp_lt_u32 s34, s35
  s_cselect_b32 s24, s24, 0x10000000
  s_add_u32 m0, s31, s27
  s_nop 0
  buffer_load_dwordx4 v2, s[8:11], s24 offen offset:0 sc1 lds
  buffer_load_dwordx4 v2, s[8:11], s24 offen offset:1024 sc1 lds
  buffer_load_dwordx4 v2, s[8:11], s24 offen offset:2048 sc1 lds
  buffer_load_dwordx4 v2, s[8:11], s24 offen offset:3072 sc1 lds
  s_add_u32 m0, m0, 4096
  s_add_u32 s24, s24, 4096
  buffer_load_dwordx4 v2, s[8:11], s24 offen offset:0 sc1 lds
  buffer_load_dwordx4 v2, s[8:11], s24 offen offset:1024 sc1 lds
  buffer_load_dwordx4 v2, s[8:11], s24 offen offset:2048 sc1 lds
  s_add_u32 s30, s34, 1
  s_mov_b32 s31, 28672
  s_lshr_b32 s24, s30, 1
  s_lshl_b32 s24, s24, 2
  s_and_b32 s25, s30, 1
  s_add_u32 s24, s24, s25
  s_mul_i32 s24, s24, 14336
  s_add_u32 s24, s24, s23
  s_cmp_lt_u32 s30, s35
  s_cselect_b32 s24, s24, 0x10000000
  s_add_u32 m0, s31, s27
  s_nop 0
  buffer_load_dwordx4 v2, s[8:11], s24 offen offset:0 sc1 lds
  buffer_load_dwordx4 v2, s[8:11], s24 offen offset:1024 sc1 lds
  buffer_load_dwordx4 v2, s[8:11], s24 offen offset:2048 sc1 lds
  buffer_load_dwordx4 v2, s[8:11], s24 offen offset:3072 sc1 lds
  s_add_u32 m0, m0, 4096
  s_add_u32 s24, s24, 4096
  buffer_load_dwordx4 v2, s[8:11], s24 offen offset:0 sc1 lds
  buffer_load_dwordx4 v2, s[8:11], s24 offen offset:1024 sc1 lds
  buffer_load_dwordx4 v2, s[8:11], s24 offen offset:2048 sc1 lds
  s_mov_b32 s19, s34
  s_mov_b32 s32, 0
  s_mov_b32 s33, 57344
  s_waitcnt vmcnt(7)
  s_branch wg_f_in
wg_f_loop:
  s_waitcnt vmcnt(11)
wg_f_in:
  s_barrier
  s_add_u32 s30, s19, 2
  s_lshr_b32 s24, s30, 1
  s_lshl_b32 s24, s24, 2
  s_and_b32 s25, s30, 1
  s_add_u32 s24, s24, s25
  s_mul_i32 s24, s24, 14336
  s_add_u32 s24, s24, s23
  s_cmp_lt_u32 s30, s35
  s_cselect_b32 s24, s24, 0x10000000
  s_add_u32 m0, s33, s27
  s_nop 0
  buffer_load_dwordx4 v2, s[8:11], s24 offen offset:0 sc1 lds
  buffer_load_dwordx4 v2, s[8:11], s24 offen offset:1024 sc1 lds
  buffer_load_dwordx4 v2, s[8:11], s24 offen offset:2048 sc1 lds
  buffer_load_dwordx4 v2, s[8:11], s24 offen offset:3072 sc1 lds
  s_add_u32 m0, m0, 4096
  s_add_u32 s24, s24, 4096
  buffer_load_dwordx4 v2, s[8:11], s24 offen offset:0 sc1 lds
  buffer_load_dwordx4 v2, s[8:11], s24 offen offset:1024 sc1 lds
  buffer_load_dwordx4 v2, s[8:11], s24 offen offset:2048 sc1 lds
  v_add_u32 v5, s32, v2
  ds_read_b128 v[8:11], v5 offset:0
  ds_read_b128 v[12:15], v5 offset:14336
  ds_read_b128 v[16:19], v5 offset:1024
  ds_read_b128 v[20:23], v5 offset:15360
  ds_read_b128 v[24:27], v5 offset:2048
  ds_read_b128 v[28:31], v5 offset:16384
  ds_read_b128 v[32:35], v5 offset:3072
  s_waitcnt lgkmcnt(6)
  v_mfma_f32_16x16x32_bf16 v[40:43], v[8:11], a[0:3], 0
  v_mfma_f32_16x16x32_bf16 v[44:47], v[8:11], a[56:59], 0
  v_mfma_f32_16x16x32_bf16 v[48:51], v[8:11], a[112:115], 0
  v_mfma_f32_16x16x32_bf16 v[52:55], v[8:11], a[168:171], 0
  ds_read_b128 v[36:39], v5 offset:17408
  s_waitcnt lgkmcnt(6)
  v_mfma_f32_16x16x32_bf16 v[56:59], v[12:15], a[0:3], 0
  v_mfma_f32_16x16x32_bf16 v[60:63], v[12:15], a[56:59], 0
  v_mfma_f32_16x16x32_bf16 v[64:67], v[12:15], a[112:115], 0
  v_mfma_f32_16x16x32_bf16 v[68:71], v[12:15], a[168:171], 0
  ds_read_b128 v[8:11], v5 offset:4096
  s_waitcnt lgkmcnt(6)
  v_mfma_f32_16x16x32_bf16 v[40:43], v[16:19], a[4:7], v[40:43]
  v_mfma_f32_16x16x32_bf16 v[44:47], v[16:19], a[60:63], v[44:47]
  v_mfma_f32_16x16x32_bf16 v[48:51], v[16:19], a[116:119], v[48:51]
  v_mfma_f32_16x16x32_bf16 v[52:55], v[16:19], a[172:175], v[52:55]
  ds_read_b128 v[12:15], v5 offset:18432
  s_waitcnt lgkmcnt(6)
  v_mfma_f32_16x16x32_bf16 v[56:59], v[20:23], a[4:7], v[56:59]
  v_mfma_f32_16x16x32_bf16 v[60:63], v[20:23], a[60:63], v[60:63]
  v_mfma_f32_16x16x32_bf16 v[64:67], v[20:23], a[116:119], v[64:67]
  v_mfma_f32_16x16x32_bf16 v[68:71], v[20:23], a[172:175], v[68:71]
  ds_read_b128 v[16:19], v5 offset:5120
  s_waitcnt lgkmcnt(6)
  v_mfma_f32_16x16x32_bf16 v[40:43], v[24:27], a[8:11], v[40:43]
  v_mfma_f32_16x16x32_bf16 v[44:47], v[24:27], a[64:67], v[44:47]
  v_mfma_f32_16x16x32_bf16 v[48:51], v[24:27], a[120:123], v[48:51]
  v_mfma_f32_16x16x32_bf16 v[52:55], v[24:27], a[176:179], v[52:55]
  ds_read_b128 v[20:23], v5 offset:19456
  s_waitcnt lgkmcnt(6)
  v_mfma_f32_16x16x32_bf16 v[56:59], v[28:31], a[8:11], v[56:59]
  v_mfma_f32_16x16x32_bf16 v[60:63], v[28:31], a[64:67], v[60:63]
  v_mfma_f32_16x16x32_bf16 v[64:67], v[28:31], a[120:123], v[64:67]
  v_mfma_f32_16x16x32_bf16 v[68:71], v[28:31], a[176:179], v[68:71]
  ds_read_b128 v[24:27], v5 offset:6144
  s_waitcnt lgkmcnt(6)
  v_mfma_f32_16x16x32_bf16 v[40:43], v[32:35], a[12:15], v[40:43]
  v_mfma_f32_16x16x32_bf16 v[44:47], v[32:35], a[68:71], v[44:47]
  v_mfma_f32_16x16x32_bf16 v[48:51], v[32:35], a[124:127], v[48:51]
  v_mfma_f32_16x16x32_bf16 v[52:55], v[32:35], a[180:183], v[52:55]
  ds_read_b128 v[28:31], v5 offset:20480
  s_waitcnt lgkmcnt(6)
  v_mfma_f32_16x16x32_bf16 v[56:59], v[36:39], a[12:15], v[56:59]
  v_mfma_f32_16x16x32_bf16 v[60:63], v[36:39], a[68:71], v[60:63]
  v_mfma_f32_16x16x32_bf16 v[64:67], v[36:39], a[124:127], v[64:67]
  v_mfma_f32_16x16x32_bf16 v[68:71], v[36:39], a[180:183], v[68:71]
  ds_read_b128 v[32:35], v5 offset:7168
  s_waitcnt lgkmcnt(6)
  v_mfma_f32_16x16x32_bf16 v[40:43], v[8:11], a[16:19], v[40:43]
  v_mfma_f32_16x16x32_bf16 v[44:47], v[8:11], a[72:75], v[44:47]
  v_mfma_f32_16x16x32_bf16 v[48:51], v[8:11], a[128:131], v[48:51]
  v_mfma_f32_16x16x32_bf16 v[52:55], v[8:11], a[184:187], v[52:55]
  ds_read_b128 v[36:39], v5 offset:21504
  s_waitcnt lgkmcnt(6)
  v_mfma_f32_16x16x32_bf16 v[56:59], v[12:15], a[16:19], v[56:59]
  v_mfma_f32_16x16x32_bf16 v[60:63], v[12:15], a[72:75], v[60:63]
  v_mfma_f32_16x16x32_bf16 v[64:67], v[12:15], a[128:131], v[64:67]
  v_mfma_f32_16x16x32_bf16 v[68:71], v[12:15], a[184:187], v[68:71]
  ds_read_b128 v[8:11], v5 offset:8192
  s_waitcnt lgkmcnt(6)
  v_mfma_f32_16x16x32_bf16 v[40:43], v[16:19], a[20:23], v[40:43]
  v_mfma_f32_16x16x32_bf16 v[44:47], v[16:19], a[76:79], v[44:47]
  v_mfma_f32_16x16x32_bf16 v[48:51], v[16:19], a[132:135], v[48:51]
  v_mfma_f32_16x16x32_bf16 v[52:55], v[16:19], a[188:191], v[52:55]
  ds_read_b128 v[12:15], v5 offset:22528
  s_waitcnt lgkmcnt(6)
  v_mfma_f32_16x16x32_bf16 v[56:59], v[20:23], a[20:23], v[56:59]
  v_mfma_f32_16x16x32_bf16 v[60:63], v[20:23], a[76:79], v[60:63]
  v_mfma_f32_16x16x32_bf16 v[64:67], v[20:23], a[132:135], v[64:67]
  v_mfma_f32_16x16x32_bf16 v[68:71], v[20:23], a[188:191], v[68:71]
  ds_read_b128 v[16:19], v5 offset:9216
  s_waitcnt lgkmcnt(6)
  v_mfma_f32_16x16x32_bf16 v[40:43], v[24:27], a[24:27], v[40:43]
  v_mfma_f32_16x16x32_bf16 v[44:47], v[24:27], a[80:83], v[44:47]
  v_mfma_f32_16x16x32_bf16 v[48:51], v[24:27], a[136:139], v[48:51]
  v_mfma_f32_16x16x32_bf16 v[52:55], v[24:27], a[192:195], v[52:55]
  ds_read_b128 v[20:23], v5 offset:23552
  s_waitcnt lgkmcnt(6)
  v_mfma_f32_16x16x32_bf16 v[56:59], v[28:31], a[24:27], v[56:59]
  v_mfma_f32_16x16x32_bf16 v[60:63], v[28:31], a[80:83], v[60:63]
  v_mfma_f32_16x16x32_bf16 v[64:67], v[28:31], a[136:139], v[64:67]
  v_mfma_f32_16x16x32_bf16 v[68:71], v[28:31], a[192:195], v[68:71]
  ds_read_b128 v[24:27], v5 offset:10240
  s_waitcnt lgkmcnt(6)
  v_mfma_f32_16x16x32_bf16 v[40:43], v[32:35], a[28:31], v[40:43]
  v_mfma_f32_16x16x32_bf16 v[44:47], v[32:35], a[84:87], v[44:47]
  v_mfma_f32_16x16x32_bf16 v[48:51], v[32:35], a[140:143], v[48:51]
  v_mfma_f32_16x16x32_bf16 v[52:55], v[32:35], a[196:199], v[52:55]
  ds_read_b128 v[28:31], v5 offset:24576
  s_waitcnt lgkmcnt(6)
  v_mfma_f32_16x16x32_bf16 v[56:59], v[36:39], a[28:31], v[56:59]
  v_mfma_f32_16x16x32_bf16 v[60:63], v[36:39], a[84:87], v[60:63]
  v_mfma_f32_16x16x32_bf16 v[64:67], v[36:39], a[140:143], v[64:67]
  v_mfma_f32_16x16x32_bf16 v[68:71], v[36:39], a[196:199], v[68:71]
  ds_read_b128 v[32:35], v5 offset:11264
  s_waitcnt lgkmcnt(6)
  v_mfma_f32_16x16x32_bf16 v[40:43], v[8:11], a[32:35], v[40:43]
  v_mfma_f32_16x16x32_bf16 v[44:47], v[8:11], a[88:91], v[44:47]
  v_mfma_f32_16x16x32_bf16 v[48:51], v[8:11], a[144:147], v[48:51]
  v_mfma_f32_16x16x32_bf16 v[52:55], v[8:11], a[200:203], v[52:55]
  ds_read_b128 v[36:39], v5 offset:25600
  s_waitcnt lgkmcnt(6)
  v_mfma_f32_16x16x32_bf16 v[56:59], v[12:15], a[32:35], v[56:59]
  v_mfma_f32_16x16x32_bf16 v[60:63], v[12:15], a[88:91], v[60:63]
  v_mfma_f32_16x16x32_bf16 v[64:67], v[12:15], a[144:147], v[64:67]
  v_mfma_f32_16x16x32_bf16 v[68:71], v[12:15], a[200:203], v[68:71]
  ds_read_b128 v[8:11], v5 offset:12288
  s_waitcnt lgkmcnt(6)
  v_mfma_f32_16x16x32_bf16 v[40:43], v[16:19], a[36:39], v[40:43]
  v_mfma_f32_16x16x32_bf16 v[44:47], v[16:19], a[92:95], v[44:47]
  v_mfma_f32_16x16x32_bf16 v[48:51], v[16:19], a[148:151], v[48:51]
  v_mfma_f32_16x16x32_bf16 v[52:55], v[16:19], a[204:207], v[52:55]
  ds_read_b128 v[12:15], v5 offset:26624
  s_waitcnt lgkmcnt(6)
  v_mfma_f32_16x16x32_bf16 v[56:59], v[20:23], a[36:39], v[56:59]
  v_mfma_f32_16x16x32_bf16 v[60:63], v[20:23], a[92:95], v[60:63]
  v_mfma_f32_16x16x32_bf16 v[64:67], v[20:23], a[148:151], v[64:67]
  v_mfma_f32_16x16x32_bf16 v[68:71], v[20:23], a[204:207], v[68:71]
  ds_read_b128 v[16:19], v5 offset:13312
  s_waitcnt lgkmcnt(6)
  v_mfma_f32_16x16x32_bf16 v[40:43], v[24:27], a[40:43], v[40:43]
  v_mfma_f32_16x16x32_bf16 v[44:47], v[24:27], a[96:99], v[44:47]
  v_mfma_f32_16x16x32_bf16 v[48:51], v[24:27], a[152:155], v[48:51]
  v_mfma_f32_16x16x32_bf16 v[52:55], v[24:27], a[208:211], v[52:55]
  ds_read_b128 v[20:23], v5 offset:27648
  s_waitcnt lgkmcnt(6)
  v_mfma_f32_16x16x32_bf16 v[56:59], v[28:31], a[40:43], v[56:59]
  v_mfma_f32_16x16x32_bf16 v[60:63], v[28:31], a[96:99], v[60:63]
  v_mfma_f32_16x16x32_bf16 v[64:67], v[28:31], a[152:155], v[64:67]
  v_mfma_f32_16x16x32_bf16 v[68:71], v[28:31], a[208:211], v[68:71]
  s_waitcnt lgkmcnt(5)
  v_mfma_f32_16x16x32_bf16 v[40:43], v[32:35], a[44:47], v[40:43]
  v_mfma_f32_16x16x32_bf16 v[44:47], v[32:35], a[100:103], v[44:47]
  v_mfma_f32_16x16x32_bf16 v[48:51], v[32:35], a[156:159], v[48:51]
  v_mfma_f32_16x16x32_bf16 v[52:55], v[32:35], a[212:215], v[52:55]
  s_waitcnt lgkmcnt(4)
  v_mfma_f32_16x16x32_bf16 v[56:59], v[36:39], a[44:47], v[56:59]
  v_mfma_f32_16x16x32_bf16 v[60:63], v[36:39], a[100:103], v[60:63]
  v_mfma_f32_16x16x32_bf16 v[64:67], v[36:39], a[156:159], v[64:67]
  v_mfma_f32_16x16x32_bf16 v[68:71], v[36:39], a[212:215], v[68:71]
  s_waitcnt lgkmcnt(3)
  v_mfma_f32_16x16x32_bf16 v[40:43], v[8:11], a[48:51], v[40:43]
  v_mfma_f32_16x16x32_bf16 v[44:47], v[8:11], a[104:107], v[44:47]
  v_mfma_f32_16x16x32_bf16 v[48:51], v[8:11], a[160:163], v[48:51]
  v_mfma_f32_16x16x32_bf16 v[52:55], v[8:11], a[216:219], v[52:55]
  s_waitcnt lgkmcnt(2)
  v_mfma_f32_16x16x32_bf16 v[56:59], v[12:15], a[48:51], v[56:59]
  v_mfma_f32_16x16x32_bf16 v[60:63], v[12:15], a[104:107], v[60:63]
  v_mfma_f32_16x16x32_bf16 v[64:67], v[12:15], a[160:163], v[64:67]
  v_mfma_f32_16x16x32_bf16 v[68:71], v[12:15], a[216:219], v[68:71]
  s_waitcnt lgkmcnt(1)
  v_mfma_f32_16x16x32_bf16 v[40:43], v[16:19], a[52:55], v[40:43]
  v_mfma_f32_16x16x32_bf16 v[44:47], v[16:19], a[108:111], v[44:47]
  v_mfma_f32_16x16x32_bf16 v[48:51], v[16:19], a[164:167], v[48:51]
  v_mfma_f32_16x16x32_bf16 v[52:55], v[16:19], a[220:223], v[52:55]
  s_waitcnt lgkmcnt(0)
  v_mfma_f32_16x16x32_bf16 v[56:59], v[20:23], a[52:55], v[56:59]
  v_mfma_f32_16x16x32_bf16 v[60:63], v[20:23], a[108:111], v[60:63]
  v_mfma_f32_16x16x32_bf16 v[64:67], v[20:23], a[164:167], v[64:67]
  v_mfma_f32_16x16x32_bf16 v[68:71], v[20:23], a[220:223], v[68:71]
  s_lshl_b32 s24, s19, 10
  s_add_u32 s24, s24, s29
  v_cvt_pk_bf16_f32 v72, v40, v41
  v_cvt_pk_bf16_f32 v73, v42, v43
  v_cvt_pk_bf16_f32 v74, v56, v57
  v_cvt_pk_bf16_f32 v75, v58, v59
  s_add_u32 s25, s24, 0
  buffer_store_dwordx4 v[72:75], v2, s[8:11], s25 offen sc1
  v_cvt_pk_bf16_f32 v76, v44, v45
  v_cvt_pk_bf16_f32 v77, v46, v47
  v_cvt_pk_bf16_f32 v78, v60, v61
  v_cvt_pk_bf16_f32 v79, v62, v63
  s_add_u32 s25, s24, 14336
  buffer_store_dwordx4 v[76:79], v2, s[8:11], s25 offen sc1
  v_cvt_pk_bf16_f32 v80, v48, v49
  v_cvt_pk_bf16_f32 v81, v50, v51
  v_cvt_pk_bf16_f32 v82, v64, v65
  v_cvt_pk_bf16_f32 v83, v66, v67
  s_add_u32 s25, s24, 458752
  buffer_store_dwordx4 v[80:83], v2, s[8:11], s25 offen sc1
  v_cvt_pk_bf16_f32 v84, v52, v53
  v_cvt_pk_bf16_f32 v85, v54, v55
  v_cvt_pk_bf16_f32 v86, v68, v69
  v_cvt_pk_bf16_f32 v87, v70, v71
  s_add_u32 s25, s24, 473088
  buffer_store_dwordx4 v[84:87], v2, s[8:11], s25 offen sc1
  s_mov_b32 s33, s32
  s_add_u32 s32, s32, 28672
  s_cmp_eq_u32 s32, 86016
  s_cselect_b32 s32, 0, s32
  s_add_u32 s19, s19, 1
  s_cmp_lt_u32 s19, s35
  s_cbranch_scc1 wg_f_loop
  s_branch wg_done
wg_vo:
  s_sub_u32 s29, s17, 16
  s_lshl_b32 s29, s29, 6
  s_add_u32 s29, s29, s28
  s_mul_i32 s29, s29, 28672
  s_add_u32 s29, s29, 42205184
  v_lshlrev_b32 v6, 4, v3
  v_mad_u32_u24 v7, v3, 12, 64
  s_mov_b32 s31, 0
  s_lshl_b32 s24, s34, 1
  s_mul_i32 s24, s24, 14336
  s_add_u32 s24, s24, s23
  s_cmp_lt_u32 s34, s35
  s_cselect_b32 s24, s24, 0x10000000
  s_add_u32 m0, s31, s27
  s_nop 0
  buffer_load_dwordx4 v2, s[8:11], s24 offen offset:0 sc1 lds
  buffer_load_dwordx4 v2, s[8:11], s24 offen offset:1024 sc1 lds
  buffer_load_dwordx4 v2, s[8:11], s24 offen offset:2048 sc1 lds
  buffer_load_dwordx4 v2, s[8:11], s24 offen offset:3072 sc1 lds
  s_add_u32 m0, m0, 4096
  s_add_u32 s24, s24, 4096
  buffer_load_dwordx4 v2, s[8:11], s24 offen offset:0 sc1 lds
  buffer_load_dwordx4 v2, s[8:11], s24 offen offset:1024 sc1 lds
  buffer_load_dwordx4 v2, s[8:11], s24 offen offset:2048 sc1 lds
  s_add_u32 s30, s34, 1
  s_mov_b32 s31, 28672
  s_lshl_b32 s24, s30, 1
  s_mul_i32 s24, s24, 14336
  s_add_u32 s24, s24, s23
  s_cmp_lt_u32 s30, s35
  s_cselect_b32 s24, s24, 0x10000000
  s_add_u32 m0, s31, s27
  s_nop 0
  buffer_load_dwordx4 v2, s[8:11], s24 offen offset:0 sc1 lds
  buffer_load_dwordx4 v2, s[8:11], s24 offen offset:1024 sc1 lds
  buffer_load_dwordx4 v2, s[8:11], s24 offen offset:2048 sc1 lds
  buffer_load_dwordx4 v2, s[8:11], s24 offen offset:3072 sc1 lds
  s_add_u32 m0, m0, 4096
  s_add_u32 s24, s24, 4096
  buffer_load_dwordx4 v2, s[8:11], s24 offen offset:0 sc1 lds
  buffer_load_dwordx4 v2, s[8:11], s24 offen offset:1024 sc1 lds
  buffer_load_dwordx4 v2, s[8:11], s24 offen offset:2048 sc1 lds
  s_mov_b32 s19, s34
  s_mov_b32 s32, 0
  s_mov_b32 s33, 57344
  s_waitcnt vmcnt(7)
  s_branch wg_vo_in
wg_vo_loop:
  s_waitcnt vmcnt(11)
wg_vo_in:
  s_barrier
  s_add_u32 s30, s19, 2
  s_lshl_b32 s24, s30, 1
  s_mul_i32 s24, s24, 14336
  s_add_u32 s24, s24, s23
  s_cmp_lt_u32 s30, s35
  s_cselect_b32 s24, s24, 0x10000000
  s_add_u32 m0, s33, s27
  s_nop 0
  buffer_load_dwordx4 v2, s[8:11], s24 offen offset:0 sc1 lds
  buffer_load_dwordx4 v2, s[8:11], s24 offen offset:1024 sc1 lds
  buffer_load_dwordx4 v2, s[8:11], s24 offen offset:2048 sc1 lds
  buffer_load_dwordx4 v2, s[8:11], s24 offen offset:3072 sc1 lds
  s_add_u32 m0, m0, 4096
  s_add_u32 s24, s24, 4096
  buffer_load_dwordx4 v2, s[8:11], s24 offen offset:0 sc1 lds
  buffer_load_dwordx4 v2, s[8:11], s24 offen offset:1024 sc1 lds
  buffer_load_dwordx4 v2, s[8:11], s24 offen offset:2048 sc1 lds
  v_add_u32 v5, s32, v2
  ds_read_b128 v[8:11], v5 offset:0
  ds_read_b128 v[12:15], v5 offset:14336
  ds_read_b128 v[16:19], v5 offset:1024
  ds_read_b128 v[20:23], v5 offset:15360
  ds_read_b128 v[24:27], v5 offset:2048
  ds_read_b128 v[28:31], v5 offset:16384
  ds_read_b128 v[32:35], v5 offset:3072
  s_waitcnt lgkmcnt(6)
  v_mfma_f32_16x16x32_bf16 v[40:43], a[0:3], v[8:11], 0
  v_mfma_f32_16x16x32_bf16 v[44:47], a[56:59], v[8:11], 0
  v_mfma_f32_16x16x32_bf16 v[48:51], a[112:115], v[8:11], 0
  v_mfma_f32_16x16x32_bf16 v[52:55], a[168:171], v[8:11], 0
  ds_read_b128 v[36:39], v5 offset:17408
  s_waitcnt lgkmcnt(6)
  v_mfma_f32_16x16x32_bf16 v[56:59], a[0:3], v[12:15], 0
  v_mfma_f32_16x16x32_bf16 v[60:63], a[56:59], v[12:15], 0
  v_mfma_f32_16x16x32_bf16 v[64:67], a[112:115], v[12:15], 0
  v_mfma_f32_16x16x32_bf16 v[68:71], a[168:171], v[12:15], 0
  ds_read_b128 v[8:11], v5 offset:4096
  s_waitcnt lgkmcnt(6)
  v_mfma_f32_16x16x32_bf16 v[40:43], a[4:7], v[16:19], v[40:43]
  v_mfma_f32_16x16x32_bf16 v[44:47], a[60:63], v[16:19], v[44:47]
  v_mfma_f32_16x16x32_bf16 v[48:51], a[116:119], v[16:19], v[48:51]
  v_mfma_f32_16x16x32_bf16 v[52:55], a[172:175], v[16:19], v[52:55]
  ds_read_b128 v[12:15], v5 offset:18432
  s_waitcnt lgkmcnt(6)
  v_mfma_f32_16x16x32_bf16 v[56:59], a[4:7], v[20:23], v[56:59]
  v_mfma_f32_16x16x32_bf16 v[60:63], a[60:63], v[20:23], v[60:63]
  v_mfma_f32_16x16x32_bf16 v[64:67], a[116:119], v[20:23], v[64:67]
  v_mfma_f32_16x16x32_bf16 v[68:71], a[172:175], v[20:23], v[68:71]
  ds_read_b128 v[16:19], v5 offset:5120
  s_waitcnt lgkmcnt(6)
  v_mfma_f32_16x16x32_bf16 v[40:43], a[8:11], v[24:27], v[40:43]
  v_mfma_f32_16x16x32_bf16 v[44:47], a[64:67], v[24:27], v[44:47]
  v_mfma_f32_16x16x32_bf16 v[48:51], a[120:123], v[24:27], v[48:51]
  v_mfma_f32_16x16x32_bf16 v[52:55], a[176:179], v[24:27], v[52:55]
  ds_read_b128 v[20:23], v5 offset:19456
  s_waitcnt lgkmcnt(6)
  v_mfma_f32_16x16x32_bf16 v[56:59], a[8:11], v[28:31], v[56:59]
  v_mfma_f32_16x16x32_bf16 v[60:63], a[64:67], v[28:31], v[60:63]
  v_mfma_f32_16x16x32_bf16 v[64:67], a[120:123], v[28:31], v[64:67]
  v_mfma_f32_16x16x32_bf16 v[68:71], a[176:179], v[28:31], v[68:71]
  ds_read_b128 v[24:27], v5 offset:6144
  s_waitcnt lgkmcnt(6)
  v_mfma_f32_16x16x32_bf16 v[40:43], a[12:15], v[32:35], v[40:43]
  v_mfma_f32_16x16x32_bf16 v[44:47], a[68:71], v[32:35], v[44:47]
  v_mfma_f32_16x16x32_bf16 v[48:51], a[124:127], v[32:35], v[48:51]
  v_mfma_f32_16x16x32_bf16 v[52:55], a[180:183], v[32:35], v[52:55]
  ds_read_b128 v[28:31], v5 offset:20480
  s_waitcnt lgkmcnt(6)
  v_mfma_f32_16x16x32_bf16 v[56:59], a[12:15], v[36:39], v[56:59]
  v_mfma_f32_16x16x32_bf16 v[60:63], a[68:71], v[36:39], v[60:63]
  v_mfma_f32_16x16x32_bf16 v[64:67], a[124:127], v[36:39], v[64:67]
  v_mfma_f32_16x16x32_bf16 v[68:71], a[180:183], v[36:39], v[68:71]
  ds_read_b128 v[32:35], v5 offset:7168
  s_waitcnt lgkmcnt(6)
  v_mfma_f32_16x16x32_bf16 v[40:43], a[16:19], v[8:11], v[40:43]
  v_mfma_f32_16x16x32_bf16 v[44:47], a[72:75], v[8:11], v[44:47]
  v_mfma_f32_16x16x32_bf16 v[48:51], a[128:131], v[8:11], v[48:51]
  v_mfma_f32_16x16x32_bf16 v[52:55], a[184:187], v[8:11], v[52:55]
  ds_read_b128 v[36:39], v5 offset:21504
  s_waitcnt lgkmcnt(6)
  v_mfma_f32_16x16x32_bf16 v[56:59], a[16:19], v[12:15], v[56:59]
  v_mfma_f32_16x16x32_bf16 v[60:63], a[72:75], v[12:15], v[60:63]
  v_mfma_f32_16x16x32_bf16 v[64:67], a[128:131], v[12:15], v[64:67]
  v_mfma_f32_16x16x32_bf16 v[68:71], a[184:187], v[12:15], v[68:71]
  ds_read_b128 v[8:11], v5 offset:8192
  s_waitcnt lgkmcnt(6)
  v_mfma_f32_16x16x32_bf16 v[40:43], a[20:23], v[16:19], v[40:43]
  v_mfma_f32_16x16x32_bf16 v[44:47], a[76:79], v[16:19], v[44:47]
  v_mfma_f32_16x16x32_bf16 v[48:51], a[132:135], v[16:19], v[48:51]
  v_mfma_f32_16x16x32_bf16 v[52:55], a[188:191], v[16:19], v[52:55]
  ds_read_b128 v[12:15], v5 offset:22528
  s_waitcnt lgkmcnt(6)
  v_mfma_f32_16x16x32_bf16 v[56:59], a[20:23], v[20:23], v[56:59]
  v_mfma_f32_16x16x32_bf16 v[60:63], a[76:79], v[20:23], v[60:63]
  v_mfma_f32_16x16x32_bf16 v[64:67], a[132:135], v[20:23], v[64:67]
  v_mfma_f32_16x16x32_bf16 v[68:71], a[188:191], v[20:23], v[68:71]
  ds_read_b128 v[16:19], v5 offset:9216
  s_waitcnt lgkmcnt(6)
  v_mfma_f32_16x16x32_bf16 v[40:43], a[24:27], v[24:27], v[40:43]
  v_mfma_f32_16x16x32_bf16 v[44:47], a[80:83], v[24:27], v[44:47]
  v_mfma_f32_16x16x32_bf16 v[48:51], a[136:139], v[24:27], v[48:51]
  v_mfma_f32_16x16x32_bf16 v[52:55], a[192:195], v[24:27], v[52:55]
  ds_read_b128 v[20:23], v5 offset:23552
  s_waitcnt lgkmcnt(6)
  v_mfma_f32_16x16x32_bf16 v[56:59], a[24:27], v[28:31], v[56:59]
  v_mfma_f32_16x16x32_bf16 v[60:63], a[80:83], v[28:31], v[60:63]
  v_mfma_f32_16x16x32_bf16 v[64:67], a[136:139], v[28:31], v[64:67]
  v_mfma_f32_16x16x32_bf16 v[68:71], a[192:195], v[28:31], v[68:71]
  ds_read_b128 v[24:27], v5 offset:10240
  s_waitcnt lgkmcnt(6)
  v_mfma_f32_16x16x32_bf16 v[40:43], a[28:31], v[32:35], v[40:43]
  v_mfma_f32_16x16x32_bf16 v[44:47], a[84:87], v[32:35], v[44:47]
  v_mfma_f32_16x16x32_bf16 v[48:51], a[140:143], v[32:35], v[48:51]
  v_mfma_f32_16x16x32_bf16 v[52:55], a[196:199], v[32:35], v[52:55]
  ds_read_b128 v[28:31], v5 offset:24576
  s_waitcnt lgkmcnt(6)
  v_mfma_f32_16x16x32_bf16 v[56:59], a[28:31], v[36:39], v[56:59]
  v_mfma_f32_16x16x32_bf16 v[60:63], a[84:87], v[36:39], v[60:63]
  v_mfma_f32_16x16x32_bf16 v[64:67], a[140:143], v[36:39], v[64:67]
  v_mfma_f32_16x16x32_bf16 v[68:71], a[196:199], v[36:39], v[68:71]
  ds_read_b128 v[32:35], v5 offset:11264
  s_waitcnt lgkmcnt(6)
  v_mfma_f32_16x16x32_bf16 v[40:43], a[32:35], v[8:11], v[40:43]
  v_mfma_f32_16x16x32_bf16 v[44:47], a[88:91], v[8:11], v[44:47]
  v_mfma_f32_16x16x32_bf16 v[48:51], a[144:147], v[8:11], v[48:51]
  v_mfma_f32_16x16x32_bf16 v[52:55], a[200:203], v[8:11], v[52:55]
  ds_read_b128 v[36:39], v5 offset:25600
  s_waitcnt lgkmcnt(6)
  v_mfma_f32_16x16x32_bf16 v[56:59], a[32:35], v[12:15], v[56:59]
  v_mfma_f32_16x16x32_bf16 v[60:63], a[88:91], v[12:15], v[60:63]
  v_mfma_f32_16x16x32_bf16 v[64:67], a[144:147], v[12:15], v[64:67]
  v_mfma_f32_16x16x32_bf16 v[68:71], a[200:203], v[12:15], v[68:71]
  ds_read_b128 v[8:11], v5 offset:12288
  s_waitcnt lgkmcnt(6)
  v_mfma_f32_16x16x32_bf16 v[40:43], a[36:39], v[16:19], v[40:43]
  v_mfma_f32_16x16x32_bf16 v[44:47], a[92:95], v[16:19], v[44:47]
  v_mfma_f32_16x16x32_bf16 v[48:51], a[148:151], v[16:19], v[48:51]
  v_mfma_f32_16x16x32_bf16 v[52:55], a[204:207], v[16:19], v[52:55]
  ds_read_b128 v[12:15], v5 offset:26624
  s_waitcnt lgkmcnt(6)
  v_mfma_f32_16x16x32_bf16 v[56:59], a[36:39], v[20:23], v[56:59]
  v_mfma_f32_16x16x32_bf16 v[60:63], a[92:95], v[20:23], v[60:63]
  v_mfma_f32_16x16x32_bf16 v[64:67], a[148:151], v[20:23], v[64:67]
  v_mfma_f32_16x16x32_bf16 v[68:71], a[204:207], v[20:23], v[68:71]
  ds_read_b128 v[16:19], v5 offset:13312
  s_waitcnt lgkmcnt(6)
  v_mfma_f32_16x16x32_bf16 v[40:43], a[40:43], v[24:27], v[40:43]
  v_mfma_f32_16x16x32_bf16 v[44:47], a[96:99], v[24:27], v[44:47]
  v_mfma_f32_16x16x32_bf16 v[48:51], a[152:155], v[24:27], v[48:51]
  v_mfma_f32_16x16x32_bf16 v[52:55], a[208:211], v[24:27], v[52:55]
  ds_read_b128 v[20:23], v5 offset:27648
  s_waitcnt lgkmcnt(6)
  v_mfma_f32_16x16x32_bf16 v[56:59], a[40:43], v[28:31], v[56:59]
  v_mfma_f32_16x16x32_bf16 v[60:63], a[96:99], v[28:31], v[60:63]
  v_mfma_f32_16x16x32_bf16 v[64:67], a[152:155], v[28:31], v[64:67]
  v_mfma_f32_16x16x32_bf16 v[68:71], a[208:211], v[28:31], v[68:71]
  s_waitcnt lgkmcnt(5)
  v_mfma_f32_16x16x32_bf16 v[40:43], a[44:47], v[32:35], v[40:43]
  v_mfma_f32_16x16x32_bf16 v[44:47], a[100:103], v[32:35], v[44:47]
  v_mfma_f32_16x16x32_bf16 v[48:51], a[156:159], v[32:35], v[48:51]
  v_mfma_f32_16x16x32_bf16 v[52:55], a[212:215], v[32:35], v[52:55]
  s_waitcnt lgkmcnt(4)
  v_mfma_f32_16x16x32_bf16 v[56:59], a[44:47], v[36:39], v[56:59]
  v_mfma_f32_16x16x32_bf16 v[60:63], a[100:103], v[36:39], v[60:63]
  v_mfma_f32_16x16x32_bf16 v[64:67], a[156:159], v[36:39], v[64:67]
  v_mfma_f32_16x16x32_bf16 v[68:71], a[212:215], v[36:39], v[68:71]
  s_waitcnt lgkmcnt(3)
  v_mfma_f32_16x16x32_bf16 v[40:43], a[48:51], v[8:11], v[40:43]
  v_mfma_f32_16x16x32_bf16 v[44:47], a[104:107], v[8:11], v[44:47]
  v_mfma_f32_16x16x32_bf16 v[48:51], a[160:163], v[8:11], v[48:51]
  v_mfma_f32_16x16x32_bf16 v[52:55], a[216:219], v[8:11], v[52:55]
  s_waitcnt lgkmcnt(2)
  v_mfma_f32_16x16x32_bf16 v[56:59], a[48:51], v[12:15], v[56:59]
  v_mfma_f32_16x16x32_bf16 v[60:63], a[104:107], v[12:15], v[60:63]
  v_mfma_f32_16x16x32_bf16 v[64:67], a[160:163], v[12:15], v[64:67]
  v_mfma_f32_16x16x32_bf16 v[68:71], a[216:219], v[12:15], v[68:71]
  s_waitcnt lgkmcnt(1)
  v_mfma_f32_16x16x32_bf16 v[40:43], a[52:55], v[16:19], v[40:43]
  v_mfma_f32_16x16x32_bf16 v[44:47], a[108:111], v[16:19], v[44:47]
  v_mfma_f32_16x16x32_bf16 v[48:51], a[164:167], v[16:19], v[48:51]
  v_mfma_f32_16x16x32_bf16 v[52:55], a[220:223], v[16:19], v[52:55]
  s_waitcnt lgkmcnt(0)
  v_mfma_f32_16x16x32_bf16 v[56:59], a[52:55], v[20:23], v[56:59]
  v_mfma_f32_16x16x32_bf16 v[60:63], a[108:111], v[20:23], v[60:63]
  v_mfma_f32_16x16x32_bf16 v[64:67], a[164:167], v[20:23], v[64:67]
  v_mfma_f32_16x16x32_bf16 v[68:71], a[220:223], v[20:23], v[68:71]
  s_add_u32 s25, s29, 28672
  s_lshl_b32 s24, s19, 5
  s_add_u32 s24, s24, 0
  v_add_u32 v88, s24, v4
  s_cmp_lt_u32 s19, 8
  s_cselect_b64 vcc, -1, 0
  s_cselect_b32 s24, 0, 256
  v_subrev_u32 v88, s24, v88
  s_movk_i32 s24, 5462
  s_cselect_b32 s24, 4096, s24
  v_mul_u32_u24 v89, s24, v88
  v_lshrrev_b32 v89, 16, v89
  s_movk_i32 s24, 100
  s_cselect_b32 s24, 96, s24
  v_mul_u32_u24 v89, s24, v89
  v_cndmask_b32 v92, v7, v6, vcc
  v_add3_u32 v88, v88, v89, v92
  v_lshlrev_b32 v90, 4, v88
  v_cvt_pk_bf16_f32 v72, v40, v41
  v_cvt_pk_bf16_f32 v73, v42, v43
  v_cvt_pk_bf16_f32 v74, v44, v45
  v_cvt_pk_bf16_f32 v75, v46, v47
  buffer_store_dwordx4 v[72:75], v90, s[8:11], s29 offen sc1
  v_cvt_pk_bf16_f32 v76, v48, v49
  v_cvt_pk_bf16_f32 v77, v50, v51
  v_cvt_pk_bf16_f32 v78, v52, v53
  v_cvt_pk_bf16_f32 v79, v54, v55
  buffer_store_dwordx4 v[76:79], v90, s[8:11], s25 offen sc1
  s_lshl_b32 s24, s19, 5
  s_add_u32 s24, s24, 16
  v_add_u32 v88, s24, v4
  s_cmp_lt_u32 s19, 8
  s_cselect_b64 vcc, -1, 0
  s_cselect_b32 s24, 0, 256
  v_subrev_u32 v88, s24, v88
  s_movk_i32 s24, 5462
  s_cselect_b32 s24, 4096, s24
  v_mul_u32_u24 v89, s24, v88
  v_lshrrev_b32 v89, 16, v89
  s_movk_i32 s24, 100
  s_cselect_b32 s24, 96, s24
  v_mul_u32_u24 v89, s24, v89
  v_cndmask_b32 v92, v7, v6, vcc
  v_add3_u32 v88, v88, v89, v92
  v_lshlrev_b32 v91, 4, v88
  v_cvt_pk_bf16_f32 v80, v56, v57
  v_cvt_pk_bf16_f32 v81, v58, v59
  v_cvt_pk_bf16_f32 v82, v60, v61
  v_cvt_pk_bf16_f32 v83, v62, v63
  buffer_store_dwordx4 v[80:83], v91, s[8:11], s29 offen sc1
  v_cvt_pk_bf16_f32 v84, v64, v65
  v_cvt_pk_bf16_f32 v85, v66, v67
  v_cvt_pk_bf16_f32 v86, v68, v69
  v_cvt_pk_bf16_f32 v87, v70, v71
  buffer_store_dwordx4 v[84:87], v91, s[8:11], s25 offen sc1
  s_mov_b32 s33, s32
  s_add_u32 s32, s32, 28672
  s_cmp_eq_u32 s32, 86016
  s_cselect_b32 s32, 0, s32
  s_add_u32 s19, s19, 1
  s_cmp_lt_u32 s19, s35
  s_cbranch_scc1 wg_vo_loop
  s_branch wg_done
wg_done:
  s_lshl_b32 s20, s18, 4
  s_and_b32 s21, s17, 15
  s_add_u32 s20, s20, s21
  s_lshl_b32 s20, s20, 7
  s_cmp_lt_u32 s17, 16
  s_cselect_b32 s21, 16384, 0
  s_add_u32 s20, s20, s21
  s_add_u32 s20, s20, 88541184
  s_sub_u32 s21, s35, s34
  v_mov_b32 v5, s21
  v_mov_b32 v6, 0
  s_waitcnt vmcnt(0)
  s_mov_b64 exec, 1
  buffer_atomic_add v5, v6, s[8:11], s20 offen
  s_mov_b64 exec, -1
  s_branch wk_loop
wk_a:
  s_load_dwordx8 s[36:43], s[0:1], 56
  s_load_dwordx4 s[44:47], s[0:1], 88
  s_sub_u32 s3, s3, 432
  s_and_b32 s17, s3, 15
  s_lshr_b32 s19, s3, 5
  s_bitcmp1_b32 s3, 4
  s_cselect_b32 s31, 7, 0
  s_waitcnt lgkmcnt(0)
  s_mov_b32 s60, s40
  s_and_b32 s61, s41, 0xffff
  s_mov_b32 s62, 3670016
  s_mov_b32 s63, 0x20000
  s_mov_b32 s56, s42
  s_and_b32 s57, s43, 0xffff
  s_mov_b32 s58, 3670016
  s_mov_b32 s59, 0x20000
  s_lshl_b32 s30, s16, 13
  s_lshl_b32 s27, s19, 19
  s_lshl_b32 s29, s16, 17
  s_add_u32 s27, s27, s29
  s_lshl_b32 s29, s17, 9
  s_add_u32 s27, s27, s29
  v_lshrrev_b32 v5, 5, v1
  v_and_b32 v6, 31, v1
  v_xor_b32 v6, v6, v5
  v_lshlrev_b32 v6, 4, v6
  v_lshl_add_u32 v6, v5, 13, v6
  s_add_u32 m0, s30, 0
  s_add_u32 s22, s27, 0
  v_xor_b32 v7, 0, v6
  buffer_load_dwordx4 v7, s[56:59], s22 offen offset:0 lds
  s_add_u32 s22, s27, 15360
  v_xor_b32 v7, 32, v6
  buffer_load_dwordx4 v7, s[56:59], s22 offen offset:1024 lds
  s_add_u32 s22, s27, 30720
  v_xor_b32 v7, 64, v6
  buffer_load_dwordx4 v7, s[56:59], s22 offen offset:2048 lds
  s_add_u32 s22, s27, 46080
  v_xor_b32 v7, 96, v6
  buffer_load_dwordx4 v7, s[56:59], s22 offen offset:3072 lds
  s_add_u32 m0, s30, 4096
  s_add_u32 s22, s27, 65536
  v_xor_b32 v7, 128, v6
  buffer_load_dwordx4 v7, s[56:59], s22 offen offset:0 lds
  s_add_u32 s22, s27, 80896
  v_xor_b32 v7, 160, v6
  buffer_load_dwordx4 v7, s[56:59], s22 offen offset:1024 lds
  s_add_u32 s22, s27, 96256
  v_xor_b32 v7, 192, v6
  buffer_load_dwordx4 v7, s[56:59], s22 offen offset:2048 lds
  s_add_u32 s22, s27, 111616
  v_xor_b32 v7, 224, v6
  buffer_load_dwordx4 v7, s[56:59], s22 offen offset:3072 lds
  v_lshrrev_b32 v5, 5, v1
  v_and_b32 v6, 31, v1
  s_lshl_b32 s25, s16, 15
  s_add_u32 s25, s25, 32768
  s_lshl_b32 s26, s17, 9
  s_add_u32 s28, s19, s16
  s_cmp_ge_u32 s28, 7
  s_cselect_b32 s20, 7, 0
  s_sub_u32 s28, s28, s20
  s_add_u32 s28, s28, s31
  s_add_u32 s29, s19, s16
  s_add_u32 s29, s29, 4
  s_cmp_ge_u32 s29, 7
  s_cselect_b32 s20, 7, 0
  s_sub_u32 s29, s29, s20
  s_add_u32 s29, s29, s31
  s_lshl_b32 s32, s28, 18
  s_add_u32 s32, s32, s26
  s_lshl_b32 s33, s29, 18
  s_add_u32 s33, s33, s26
  v_xor_b32 v8, v6, v5
  v_lshlrev_b32 v8, 4, v8
  v_lshl_add_u32 v8, v5, 13, v8
  v_xor_b32 v12, 0, v8
  v_xor_b32 v13, 32, v8
  v_add_u32 v13, 15360, v13
  v_xor_b32 v14, 0, v8
  v_add_u32 v14, 30720, v14
  v_xor_b32 v15, 32, v8
  v_add_u32 v15, 46080, v15
  s_add_u32 s20, s16, 0
  s_and_b32 s20, s20, 3
  s_mul_i32 s21, s20, 65600
  s_lshl_b32 s20, s20, 12
  s_add_u32 s48, s20, s25
  s_mov_b32 m0, s48
  v_xor_b32 v16, s21, v12
  buffer_load_dwordx4 v16, s[60:63], s32 offen offset:0 lds
  v_xor_b32 v17, s21, v13
  buffer_load_dwordx4 v17, s[60:63], s32 offen offset:1024 lds
  v_xor_b32 v18, s21, v14
  buffer_load_dwordx4 v18, s[60:63], s32 offen offset:2048 lds
  v_xor_b32 v19, s21, v15
  buffer_load_dwordx4 v19, s[60:63], s32 offen offset:3072 lds
  s_add_u32 s20, s16, 1
  s_and_b32 s20, s20, 3
  s_mul_i32 s21, s20, 65600
  s_lshl_b32 s20, s20, 12
  s_add_u32 s49, s20, s25
  s_mov_b32 m0, s49
  v_xor_b32 v20, s21, v12
  buffer_load_dwordx4 v20, s[60:63], s32 offen offset:0 lds
  v_xor_b32 v21, s21, v13
  buffer_load_dwordx4 v21, s[60:63], s32 offen offset:1024 lds
  v_xor_b32 v22, s21, v14
  buffer_load_dwordx4 v22, s[60:63], s32 offen offset:2048 lds
  v_xor_b32 v23, s21, v15
  buffer_load_dwordx4 v23, s[60:63], s32 offen offset:3072 lds
  s_add_u32 s20, s16, 2
  s_and_b32 s20, s20, 3
  s_mul_i32 s21, s20, 65600
  s_lshl_b32 s20, s20, 12
  s_add_u32 s50, s20, s25
  s_mov_b32 m0, s50
  v_xor_b32 v24, s21, v12
  buffer_load_dwordx4 v24, s[60:63], s32 offen offset:0 lds
  v_xor_b32 v25, s21, v13
  buffer_load_dwordx4 v25, s[60:63], s32 offen offset:1024 lds
  v_xor_b32 v26, s21, v14
  buffer_load_dwordx4 v26, s[60:63], s32 offen offset:2048 lds
  v_xor_b32 v27, s21, v15
  buffer_load_dwordx4 v27, s[60:63], s32 offen offset:3072 lds
  s_add_u32 s20, s16, 3
  s_and_b32 s20, s20, 3
  s_mul_i32 s21, s20, 65600
  s_lshl_b32 s20, s20, 12
  s_add_u32 s51, s20, s25
  s_mov_b32 m0, s51
  v_xor_b32 v28, s21, v12
  buffer_load_dwordx4 v28, s[60:63], s32 offen offset:0 lds
  v_xor_b32 v29, s21, v13
  buffer_load_dwordx4 v29, s[60:63], s32 offen offset:1024 lds
  v_xor_b32 v30, s21, v14
  buffer_load_dwordx4 v30, s[60:63], s32 offen offset:2048 lds
  v_xor_b32 v31, s21, v15
  buffer_load_dwordx4 v31, s[60:63], s32 offen offset:3072 lds
  s_mul_i32 s30, s17, 401408
  s_mul_i32 s20, s19, 57344
  s_add_u32 s30, s30, s20
  v_add_u32 v12, s30, v2
  v_add_u32 v13, 14336, v12
  v_add_u32 v14, 28672, v12
  v_add_u32 v15, 43008, v12
  v_lshrrev_b32 v7, 2, v4
  v_lshlrev_b32 v7, 3, v7
  v_and_b32 v8, 3, v4
  v_add_u32 v7, v7, v8
  v_xor_b32 v10, v3, v4
  v_lshlrev_b32 v10, 4, v10
  v_lshl_add_u32 v10, v7, 9, v10
  v_add_u32 v10, s25, v10
  v_xor_b32 v32, 0, v10
  v_xor_b32 v33, 64, v10
  v_xor_b32 v34, 128, v10
  v_xor_b32 v35, 192, v10
  v_and_b32 v8, 2, v4
  v_lshlrev_b32 v8, 1, v8
  v_and_b32 v9, 1, v4
  v_add_u32 v8, v8, v9
  v_lshrrev_b32 v7, 2, v4
  v_lshl_add_u32 v7, v7, 4, v8
  v_xor_b32 v8, v8, v3
  v_lshlrev_b32 v8, 4, v8
  v_lshl_add_u32 v7, v7, 9, v8
  s_mov_b32 s24, 1035512379
  s_waitcnt vmcnt(16)
  s_barrier
  s_cmp_eq_u32 s16, 3
  s_cbranch_scc1 aj_np0
  s_add_u32 m0, s48, 16384
  s_nop 0
  buffer_load_dwordx4 v16, s[60:63], s33 offen offset:0 lds
  buffer_load_dwordx4 v17, s[60:63], s33 offen offset:1024 lds
  buffer_load_dwordx4 v18, s[60:63], s33 offen offset:2048 lds
  buffer_load_dwordx4 v19, s[60:63], s33 offen offset:3072 lds
aj_np0:
  v_xor_b32 v8, 0, v7
  ds_read_b128 v[128:131], v8 offset:0
  v_xor_b32 v9, 64, v7
  ds_read_b128 v[132:135], v9 offset:0
  v_xor_b32 v10, 128, v7
  ds_read_b128 v[136:139], v10 offset:0
  v_xor_b32 v11, 192, v7
  ds_read_b128 v[140:143], v11 offset:0
  ds_read_b128 v[144:147], v8 offset:256
  ds_read_b128 v[148:151], v9 offset:256
  ds_read_b128 v[152:155], v10 offset:256
  ds_read_b128 v[156:159], v11 offset:256
  s_waitcnt lgkmcnt(4)
  s_cmp_eq_u32 s16, 3
  s_cbranch_scc1 aj_np1
  s_add_u32 m0, s49, 16384
  s_nop 0
  buffer_load_dwordx4 v20, s[60:63], s33 offen offset:0 lds
  buffer_load_dwordx4 v21, s[60:63], s33 offen offset:1024 lds
  buffer_load_dwordx4 v22, s[60:63], s33 offen offset:2048 lds
  buffer_load_dwordx4 v23, s[60:63], s33 offen offset:3072 lds
aj_np1:
  v_xor_b32 v8, 32, v7
  ds_read_b128 v[160:163], v8 offset:1024
  v_xor_b32 v9, 96, v7
  ds_read_b128 v[164:167], v9 offset:1024
  v_xor_b32 v10, 160, v7
  ds_read_b128 v[168:171], v10 offset:1024
  v_xor_b32 v11, 224, v7
  ds_read_b128 v[172:175], v11 offset:1024
  ds_read_b128 v[176:179], v8 offset:1280
  ds_read_b128 v[180:183], v9 offset:1280
  ds_read_b128 v[184:187], v10 offset:1280
  ds_read_b128 v[188:191], v11 offset:1280
  s_waitcnt lgkmcnt(4)
  s_cmp_eq_u32 s16, 3
  s_cbranch_scc1 aj_np2
  s_add_u32 m0, s50, 16384
  s_nop 0
  buffer_load_dwordx4 v24, s[60:63], s33 offen offset:0 lds
  buffer_load_dwordx4 v25, s[60:63], s33 offen offset:1024 lds
  buffer_load_dwordx4 v26, s[60:63], s33 offen offset:2048 lds
  buffer_load_dwordx4 v27, s[60:63], s33 offen offset:3072 lds
aj_np2:
  v_xor_b32 v8, 128, v7
  ds_read_b128 v[192:195], v8 offset:4096
  v_xor_b32 v9, 192, v7
  ds_read_b128 v[196:199], v9 offset:4096
  v_xor_b32 v10, 0, v7
  ds_read_b128 v[200:203], v10 offset:4096
  v_xor_b32 v11, 64, v7
  ds_read_b128 v[204:207], v11 offset:4096
  ds_read_b128 v[208:211], v8 offset:4352
  ds_read_b128 v[212:215], v9 offset:4352
  ds_read_b128 v[216:219], v10 offset:4352
  ds_read_b128 v[220:223], v11 offset:4352
  s_waitcnt lgkmcnt(4)
  s_cmp_eq_u32 s16, 3
  s_cbranch_scc1 aj_np3
  s_add_u32 m0, s51, 16384
  s_nop 0
  buffer_load_dwordx4 v28, s[60:63], s33 offen offset:0 lds
  buffer_load_dwordx4 v29, s[60:63], s33 offen offset:1024 lds
  buffer_load_dwordx4 v30, s[60:63], s33 offen offset:2048 lds
  buffer_load_dwordx4 v31, s[60:63], s33 offen offset:3072 lds
aj_np3:
  v_xor_b32 v8, 160, v7
  ds_read_b128 v[224:227], v8 offset:5120
  v_xor_b32 v9, 224, v7
  ds_read_b128 v[228:231], v9 offset:5120
  v_xor_b32 v10, 32, v7
  ds_read_b128 v[232:235], v10 offset:5120
  v_xor_b32 v11, 96, v7
  ds_read_b128 v[236:239], v11 offset:5120
  ds_read_b128 v[240:243], v8 offset:5376
  ds_read_b128 v[244:247], v9 offset:5376
  ds_read_b128 v[248:251], v10 offset:5376
  ds_read_b128 v[252:255], v11 offset:5376
  s_waitcnt lgkmcnt(4)
  s_waitcnt vmcnt(16) lgkmcnt(0)
  s_cmp_lg_u32 s16, 3
  s_cbranch_scc1 w3_39
  s_waitcnt vmcnt(0)
w3_39:
  ds_read_b128 v[52:55], v32 offset:0
  ds_read_b128 v[56:59], v33 offset:0
  ds_read_b128 v[60:63], v34 offset:0
  ds_read_b128 v[64:67], v35 offset:0
  s_waitcnt lgkmcnt(3)
  v_mfma_f32_16x16x32_bf16 v[96:99], v[52:55], v[128:131], 0
  v_mfma_f32_16x16x32_bf16 v[100:103], v[52:55], v[160:163], 0
  v_mfma_f32_16x16x32_bf16 v[104:107], v[52:55], v[192:195], 0
  v_mfma_f32_16x16x32_bf16 v[108:111], v[52:55], v[224:227], 0
  ds_read_b128 v[52:55], v32 offset:256
  s_waitcnt lgkmcnt(3)
  v_mfma_f32_16x16x32_bf16 v[96:99], v[56:59], v[132:135], v[96:99]
  v_mfma_f32_16x16x32_bf16 v[100:103], v[56:59], v[164:167], v[100:103]
  v_mfma_f32_16x16x32_bf16 v[104:107], v[56:59], v[196:199], v[104:107]
  v_mfma_f32_16x16x32_bf16 v[108:111], v[56:59], v[228:231], v[108:111]
  ds_read_b128 v[56:59], v33 offset:256
  s_waitcnt lgkmcnt(3)
  v_mfma_f32_16x16x32_bf16 v[96:99], v[60:63], v[136:139], v[96:99]
  v_mfma_f32_16x16x32_bf16 v[100:103], v[60:63], v[168:171], v[100:103]
  v_mfma_f32_16x16x32_bf16 v[104:107], v[60:63], v[200:203], v[104:107]
  v_mfma_f32_16x16x32_bf16 v[108:111], v[60:63], v[232:235], v[108:111]
  ds_read_b128 v[60:63], v34 offset:256
  s_waitcnt lgkmcnt(3)
  v_mfma_f32_16x16x32_bf16 v[96:99], v[64:67], v[140:143], v[96:99]
  v_mfma_f32_16x16x32_bf16 v[100:103], v[64:67], v[172:175], v[100:103]
  v_mfma_f32_16x16x32_bf16 v[104:107], v[64:67], v[204:207], v[104:107]
  v_mfma_f32_16x16x32_bf16 v[108:111], v[64:67], v[236:239], v[108:111]
  ds_read_b128 v[64:67], v35 offset:256
  s_waitcnt lgkmcnt(3)
  v_mfma_f32_16x16x32_bf16 v[96:99], v[52:55], v[144:147], v[96:99]
  v_mfma_f32_16x16x32_bf16 v[100:103], v[52:55], v[176:179], v[100:103]
  v_mfma_f32_16x16x32_bf16 v[104:107], v[52:55], v[208:211], v[104:107]
  v_mfma_f32_16x16x32_bf16 v[108:111], v[52:55], v[240:243], v[108:111]
  ds_read_b128 v[52:55], v32 offset:2048
  s_waitcnt lgkmcnt(3)
  v_mfma_f32_16x16x32_bf16 v[96:99], v[56:59], v[148:151], v[96:99]
  v_mfma_f32_16x16x32_bf16 v[100:103], v[56:59], v[180:183], v[100:103]
  v_mfma_f32_16x16x32_bf16 v[104:107], v[56:59], v[212:215], v[104:107]
  v_mfma_f32_16x16x32_bf16 v[108:111], v[56:59], v[244:247], v[108:111]
  ds_read_b128 v[56:59], v33 offset:2048
  s_waitcnt lgkmcnt(3)
  v_mfma_f32_16x16x32_bf16 v[96:99], v[60:63], v[152:155], v[96:99]
  v_mfma_f32_16x16x32_bf16 v[100:103], v[60:63], v[184:187], v[100:103]
  v_mfma_f32_16x16x32_bf16 v[104:107], v[60:63], v[216:219], v[104:107]
  v_mfma_f32_16x16x32_bf16 v[108:111], v[60:63], v[248:251], v[108:111]
  ds_read_b128 v[60:63], v34 offset:2048
  s_waitcnt lgkmcnt(3)
  v_mfma_f32_16x16x32_bf16 v[96:99], v[64:67], v[156:159], v[96:99]
  v_mfma_f32_16x16x32_bf16 v[100:103], v[64:67], v[188:191], v[100:103]
  v_mfma_f32_16x16x32_bf16 v[104:107], v[64:67], v[220:223], v[104:107]
  v_mfma_f32_16x16x32_bf16 v[108:111], v[64:67], v[252:255], v[108:111]
  ds_read_b128 v[64:67], v35 offset:2048
  s_waitcnt lgkmcnt(3)
  v_mfma_f32_16x16x32_bf16 v[112:115], v[52:55], v[128:131], 0
  v_mfma_f32_16x16x32_bf16 v[116:119], v[52:55], v[160:163], 0
  v_mfma_f32_16x16x32_bf16 v[120:123], v[52:55], v[192:195], 0
  v_mfma_f32_16x16x32_bf16 v[124:127], v[52:55], v[224:227], 0
  ds_read_b128 v[52:55], v32 offset:2304
  s_waitcnt lgkmcnt(3)
  v_mfma_f32_16x16x32_bf16 v[112:115], v[56:59], v[132:135], v[112:115]
  v_mfma_f32_16x16x32_bf16 v[116:119], v[56:59], v[164:167], v[116:119]
  v_mfma_f32_16x16x32_bf16 v[120:123], v[56:59], v[196:199], v[120:123]
  v_mfma_f32_16x16x32_bf16 v[124:127], v[56:59], v[228:231], v[124:127]
  ds_read_b128 v[56:59], v33 offset:2304
  s_waitcnt lgkmcnt(3)
  v_mfma_f32_16x16x32_bf16 v[112:115], v[60:63], v[136:139], v[112:115]
  v_mfma_f32_16x16x32_bf16 v[116:119], v[60:63], v[168:171], v[116:119]
  v_mfma_f32_16x16x32_bf16 v[120:123], v[60:63], v[200:203], v[120:123]
  v_mfma_f32_16x16x32_bf16 v[124:127], v[60:63], v[232:235], v[124:127]
  ds_read_b128 v[60:63], v34 offset:2304
  s_waitcnt lgkmcnt(3)
  v_mfma_f32_16x16x32_bf16 v[112:115], v[64:67], v[140:143], v[112:115]
  v_mfma_f32_16x16x32_bf16 v[116:119], v[64:67], v[172:175], v[116:119]
  v_mfma_f32_16x16x32_bf16 v[120:123], v[64:67], v[204:207], v[120:123]
  v_mfma_f32_16x16x32_bf16 v[124:127], v[64:67], v[236:239], v[124:127]
  ds_read_b128 v[64:67], v35 offset:2304
  s_waitcnt lgkmcnt(3)
  v_mfma_f32_16x16x32_bf16 v[112:115], v[52:55], v[144:147], v[112:115]
  v_mfma_f32_16x16x32_bf16 v[116:119], v[52:55], v[176:179], v[116:119]
  v_mfma_f32_16x16x32_bf16 v[120:123], v[52:55], v[208:211], v[120:123]
  v_mfma_f32_16x16x32_bf16 v[124:127], v[52:55], v[240:243], v[124:127]
  s_waitcnt lgkmcnt(2)
  v_mfma_f32_16x16x32_bf16 v[112:115], v[56:59], v[148:151], v[112:115]
  v_mfma_f32_16x16x32_bf16 v[116:119], v[56:59], v[180:183], v[116:119]
  v_mfma_f32_16x16x32_bf16 v[120:123], v[56:59], v[212:215], v[120:123]
  v_mfma_f32_16x16x32_bf16 v[124:127], v[56:59], v[244:247], v[124:127]
  s_waitcnt lgkmcnt(1)
  v_mfma_f32_16x16x32_bf16 v[112:115], v[60:63], v[152:155], v[112:115]
  v_mfma_f32_16x16x32_bf16 v[116:119], v[60:63], v[184:187], v[116:119]
  v_mfma_f32_16x16x32_bf16 v[120:123], v[60:63], v[216:219], v[120:123]
  v_mfma_f32_16x16x32_bf16 v[124:127], v[60:63], v[248:251], v[124:127]
  s_waitcnt lgkmcnt(0)
  v_mfma_f32_16x16x32_bf16 v[112:115], v[64:67], v[156:159], v[112:115]
  v_mfma_f32_16x16x32_bf16 v[116:119], v[64:67], v[188:191], v[116:119]
  v_mfma_f32_16x16x32_bf16 v[120:123], v[64:67], v[220:223], v[120:123]
  v_mfma_f32_16x16x32_bf16 v[124:127], v[64:67], v[252:255], v[124:127]
  s_lshl_b32 s30, s28, 10
  v_mul_f32 v96, s24, v96
  v_mul_f32 v97, s24, v97
  v_mul_f32 v98, s24, v98
  v_mul_f32 v99, s24, v99
  v_cvt_pk_bf16_f32 v68, v96, v97
  v_cvt_pk_bf16_f32 v69, v98, v99
  v_mul_f32 v112, s24, v112
  v_mul_f32 v113, s24, v113
  v_mul_f32 v114, s24, v114
  v_mul_f32 v115, s24, v115
  v_cvt_pk_bf16_f32 v70, v112, v113
  v_cvt_pk_bf16_f32 v71, v114, v115
  buffer_store_dwordx4 v[68:71], v12, s[8:11], s30 offen sc1
  v_mul_f32 v100, s24, v100
  v_mul_f32 v101, s24, v101
  v_mul_f32 v102, s24, v102
  v_mul_f32 v103, s24, v103
  v_cvt_pk_bf16_f32 v72, v100, v101
  v_cvt_pk_bf16_f32 v73, v102, v103
  v_mul_f32 v116, s24, v116
  v_mul_f32 v117, s24, v117
  v_mul_f32 v118, s24, v118
  v_mul_f32 v119, s24, v119
  v_cvt_pk_bf16_f32 v74, v116, v117
  v_cvt_pk_bf16_f32 v75, v118, v119
  buffer_store_dwordx4 v[72:75], v13, s[8:11], s30 offen sc1
  v_mul_f32 v104, s24, v104
  v_mul_f32 v105, s24, v105
  v_mul_f32 v106, s24, v106
  v_mul_f32 v107, s24, v107
  v_cvt_pk_bf16_f32 v76, v104, v105
  v_cvt_pk_bf16_f32 v77, v106, v107
  v_mul_f32 v120, s24, v120
  v_mul_f32 v121, s24, v121
  v_mul_f32 v122, s24, v122
  v_mul_f32 v123, s24, v123
  v_cvt_pk_bf16_f32 v78, v120, v121
  v_cvt_pk_bf16_f32 v79, v122, v123
  buffer_store_dwordx4 v[76:79], v14, s[8:11], s30 offen sc1
  v_mul_f32 v108, s24, v108
  v_mul_f32 v109, s24, v109
  v_mul_f32 v110, s24, v110
  v_mul_f32 v111, s24, v111
  v_cvt_pk_bf16_f32 v80, v108, v109
  v_cvt_pk_bf16_f32 v81, v110, v111
  v_mul_f32 v124, s24, v124
  v_mul_f32 v125, s24, v125
  v_mul_f32 v126, s24, v126
  v_mul_f32 v127, s24, v127
  v_cvt_pk_bf16_f32 v82, v124, v125
  v_cvt_pk_bf16_f32 v83, v126, v127
  buffer_store_dwordx4 v[80:83], v15, s[8:11], s30 offen sc1
  s_cmp_eq_u32 s16, 3
  s_cbranch_scc1 aj_w3
  s_waitcnt vmcnt(4)
  ds_read_b128 v[52:55], v32 offset:16384
  ds_read_b128 v[56:59], v33 offset:16384
  ds_read_b128 v[60:63], v34 offset:16384
  ds_read_b128 v[64:67], v35 offset:16384
  s_waitcnt lgkmcnt(3)
  v_mfma_f32_16x16x32_bf16 v[96:99], v[52:55], v[128:131], 0
  v_mfma_f32_16x16x32_bf16 v[100:103], v[52:55], v[160:163], 0
  v_mfma_f32_16x16x32_bf16 v[104:107], v[52:55], v[192:195], 0
  v_mfma_f32_16x16x32_bf16 v[108:111], v[52:55], v[224:227], 0
  ds_read_b128 v[52:55], v32 offset:16640
  s_waitcnt lgkmcnt(3)
  v_mfma_f32_16x16x32_bf16 v[96:99], v[56:59], v[132:135], v[96:99]
  v_mfma_f32_16x16x32_bf16 v[100:103], v[56:59], v[164:167], v[100:103]
  v_mfma_f32_16x16x32_bf16 v[104:107], v[56:59], v[196:199], v[104:107]
  v_mfma_f32_16x16x32_bf16 v[108:111], v[56:59], v[228:231], v[108:111]
  ds_read_b128 v[56:59], v33 offset:16640
  s_waitcnt lgkmcnt(3)
  v_mfma_f32_16x16x32_bf16 v[96:99], v[60:63], v[136:139], v[96:99]
  v_mfma_f32_16x16x32_bf16 v[100:103], v[60:63], v[168:171], v[100:103]
  v_mfma_f32_16x16x32_bf16 v[104:107], v[60:63], v[200:203], v[104:107]
  v_mfma_f32_16x16x32_bf16 v[108:111], v[60:63], v[232:235], v[108:111]
  ds_read_b128 v[60:63], v34 offset:16640
  s_waitcnt lgkmcnt(3)
  v_mfma_f32_16x16x32_bf16 v[96:99], v[64:67], v[140:143], v[96:99]
  v_mfma_f32_16x16x32_bf16 v[100:103], v[64:67], v[172:175], v[100:103]
  v_mfma_f32_16x16x32_bf16 v[104:107], v[64:67], v[204:207], v[104:107]
  v_mfma_f32_16x16x32_bf16 v[108:111], v[64:67], v[236:239], v[108:111]
  ds_read_b128 v[64:67], v35 offset:16640
  s_waitcnt lgkmcnt(3)
  v_mfma_f32_16x16x32_bf16 v[96:99], v[52:55], v[144:147], v[96:99]
  v_mfma_f32_16x16x32_bf16 v[100:103], v[52:55], v[176:179], v[100:103]
  v_mfma_f32_16x16x32_bf16 v[104:107], v[52:55], v[208:211], v[104:107]
  v_mfma_f32_16x16x32_bf16 v[108:111], v[52:55], v[240:243], v[108:111]
  ds_read_b128 v[52:55], v32 offset:18432
  s_waitcnt lgkmcnt(3)
  v_mfma_f32_16x16x32_bf16 v[96:99], v[56:59], v[148:151], v[96:99]
  v_mfma_f32_16x16x32_bf16 v[100:103], v[56:59], v[180:183], v[100:103]
  v_mfma_f32_16x16x32_bf16 v[104:107], v[56:59], v[212:215], v[104:107]
  v_mfma_f32_16x16x32_bf16 v[108:111], v[56:59], v[244:247], v[108:111]
  ds_read_b128 v[56:59], v33 offset:18432
  s_waitcnt lgkmcnt(3)
  v_mfma_f32_16x16x32_bf16 v[96:99], v[60:63], v[152:155], v[96:99]
  v_mfma_f32_16x16x32_bf16 v[100:103], v[60:63], v[184:187], v[100:103]
  v_mfma_f32_16x16x32_bf16 v[104:107], v[60:63], v[216:219], v[104:107]
  v_mfma_f32_16x16x32_bf16 v[108:111], v[60:63], v[248:251], v[108:111]
  ds_read_b128 v[60:63], v34 offset:18432
  s_waitcnt lgkmcnt(3)
  v_mfma_f32_16x16x32_bf16 v[96:99], v[64:67], v[156:159], v[96:99]
  v_mfma_f32_16x16x32_bf16 v[100:103], v[64:67], v[188:191], v[100:103]
  v_mfma_f32_16x16x32_bf16 v[104:107], v[64:67], v[220:223], v[104:107]
  v_mfma_f32_16x16x32_bf16 v[108:111], v[64:67], v[252:255], v[108:111]
  ds_read_b128 v[64:67], v35 offset:18432
  s_waitcnt lgkmcnt(3)
  v_mfma_f32_16x16x32_bf16 v[112:115], v[52:55], v[128:131], 0
  v_mfma_f32_16x16x32_bf16 v[116:119], v[52:55], v[160:163], 0
  v_mfma_f32_16x16x32_bf16 v[120:123], v[52:55], v[192:195], 0
  v_mfma_f32_16x16x32_bf16 v[124:127], v[52:55], v[224:227], 0
  ds_read_b128 v[52:55], v32 offset:18688
  s_waitcnt lgkmcnt(3)
  v_mfma_f32_16x16x32_bf16 v[112:115], v[56:59], v[132:135], v[112:115]
  v_mfma_f32_16x16x32_bf16 v[116:119], v[56:59], v[164:167], v[116:119]
  v_mfma_f32_16x16x32_bf16 v[120:123], v[56:59], v[196:199], v[120:123]
  v_mfma_f32_16x16x32_bf16 v[124:127], v[56:59], v[228:231], v[124:127]
  ds_read_b128 v[56:59], v33 offset:18688
  s_waitcnt lgkmcnt(3)
  v_mfma_f32_16x16x32_bf16 v[112:115], v[60:63], v[136:139], v[112:115]
  v_mfma_f32_16x16x32_bf16 v[116:119], v[60:63], v[168:171], v[116:119]
  v_mfma_f32_16x16x32_bf16 v[120:123], v[60:63], v[200:203], v[120:123]
  v_mfma_f32_16x16x32_bf16 v[124:127], v[60:63], v[232:235], v[124:127]
  ds_read_b128 v[60:63], v34 offset:18688
  s_waitcnt lgkmcnt(3)
  v_mfma_f32_16x16x32_bf16 v[112:115], v[64:67], v[140:143], v[112:115]
  v_mfma_f32_16x16x32_bf16 v[116:119], v[64:67], v[172:175], v[116:119]
  v_mfma_f32_16x16x32_bf16 v[120:123], v[64:67], v[204:207], v[120:123]
  v_mfma_f32_16x16x32_bf16 v[124:127], v[64:67], v[236:239], v[124:127]
  ds_read_b128 v[64:67], v35 offset:18688
  s_waitcnt lgkmcnt(3)
  v_mfma_f32_16x16x32_bf16 v[112:115], v[52:55], v[144:147], v[112:115]
  v_mfma_f32_16x16x32_bf16 v[116:119], v[52:55], v[176:179], v[116:119]
  v_mfma_f32_16x16x32_bf16 v[120:123], v[52:55], v[208:211], v[120:123]
  v_mfma_f32_16x16x32_bf16 v[124:127], v[52:55], v[240:243], v[124:127]
  s_waitcnt lgkmcnt(2)
  v_mfma_f32_16x16x32_bf16 v[112:115], v[56:59], v[148:151], v[112:115]
  v_mfma_f32_16x16x32_bf16 v[116:119], v[56:59], v[180:183], v[116:119]
  v_mfma_f32_16x16x32_bf16 v[120:123], v[56:59], v[212:215], v[120:123]
  v_mfma_f32_16x16x32_bf16 v[124:127], v[56:59], v[244:247], v[124:127]
  s_waitcnt lgkmcnt(1)
  v_mfma_f32_16x16x32_bf16 v[112:115], v[60:63], v[152:155], v[112:115]
  v_mfma_f32_16x16x32_bf16 v[116:119], v[60:63], v[184:187], v[116:119]
  v_mfma_f32_16x16x32_bf16 v[120:123], v[60:63], v[216:219], v[120:123]
  v_mfma_f32_16x16x32_bf16 v[124:127], v[60:63], v[248:251], v[124:127]
  s_waitcnt lgkmcnt(0)
  v_mfma_f32_16x16x32_bf16 v[112:115], v[64:67], v[156:159], v[112:115]
  v_mfma_f32_16x16x32_bf16 v[116:119], v[64:67], v[188:191], v[116:119]
  v_mfma_f32_16x16x32_bf16 v[120:123], v[64:67], v[220:223], v[120:123]
  v_mfma_f32_16x16x32_bf16 v[124:127], v[64:67], v[252:255], v[124:127]
  s_lshl_b32 s30, s29, 10
  v_mul_f32 v96, s24, v96
  v_mul_f32 v97, s24, v97
  v_mul_f32 v98, s24, v98
  v_mul_f32 v99, s24, v99
  v_cvt_pk_bf16_f32 v68, v96, v97
  v_cvt_pk_bf16_f32 v69, v98, v99
  v_mul_f32 v112, s24, v112
  v_mul_f32 v113, s24, v113
  v_mul_f32 v114, s24, v114
  v_mul_f32 v115, s24, v115
  v_cvt_pk_bf16_f32 v70, v112, v113
  v_cvt_pk_bf16_f32 v71, v114, v115
  buffer_store_dwordx4 v[68:71], v12, s[8:11], s30 offen sc1
  v_mul_f32 v100, s24, v100
  v_mul_f32 v101, s24, v101
  v_mul_f32 v102, s24, v102
  v_mul_f32 v103, s24, v103
  v_cvt_pk_bf16_f32 v72, v100, v101
  v_cvt_pk_bf16_f32 v73, v102, v103
  v_mul_f32 v116, s24, v116
  v_mul_f32 v117, s24, v117
  v_mul_f32 v118, s24, v118
  v_mul_f32 v119, s24, v119
  v_cvt_pk_bf16_f32 v74, v116, v117
  v_cvt_pk_bf16_f32 v75, v118, v119
  buffer_store_dwordx4 v[72:75], v13, s[8:11], s30 offen sc1
  v_mul_f32 v104, s24, v104
  v_mul_f32 v105, s24, v105
  v_mul_f32 v106, s24, v106
  v_mul_f32 v107, s24, v107
  v_cvt_pk_bf16_f32 v76, v104, v105
  v_cvt_pk_bf16_f32 v77, v106, v107
  v_mul_f32 v120, s24, v120
  v_mul_f32 v121, s24, v121
  v_mul_f32 v122, s24, v122
  v_mul_f32 v123, s24, v123
  v_cvt_pk_bf16_f32 v78, v120, v121
  v_cvt_pk_bf16_f32 v79, v122, v123
  buffer_store_dwordx4 v[76:79], v14, s[8:11], s30 offen sc1
  v_mul_f32 v108, s24, v108
  v_mul_f32 v109, s24, v109
  v_mul_f32 v110, s24, v110
  v_mul_f32 v111, s24, v111
  v_cvt_pk_bf16_f32 v80, v108, v109
  v_cvt_pk_bf16_f32 v81, v110, v111
  v_mul_f32 v124, s24, v124
  v_mul_f32 v125, s24, v125
  v_mul_f32 v126, s24, v126
  v_mul_f32 v127, s24, v127
  v_cvt_pk_bf16_f32 v82, v124, v125
  v_cvt_pk_bf16_f32 v83, v126, v127
  buffer_store_dwordx4 v[80:83], v15, s[8:11], s30 offen sc1
aj_w3:
  s_lshl_b32 s28, s17, 7
  s_lshl_b32 s21, s19, 4
  s_add_u32 s28, s28, s21
  s_cmp_lg_u32 s31, 0
  s_cselect_b32 s21, 8, 0
  s_add_u32 s28, s28, s21
  s_add_u32 s28, s28, 88633344
  s_waitcnt vmcnt(0)
  s_barrier
  s_cmp_lg_u32 s16, 0
  s_cbranch_scc1 pub_40
  v_mul_u32_u24 v26, 2048, v1
  v_mov_b32 v24, s88
  v_mov_b32 v25, s89
  s_mov_b64 exec, 1
  buffer_store_dwordx2 v[24:25], v26, s[8:11], s28 offen sc1
  s_mov_b64 exec, -1
pub_40:
  v_mov_b32 v250, 0
  s_branch wk_loop
wk_srv:
  s_sub_u32 s3, s3, 224
  s_and_b32 s18, s3, 15
  s_lshr_b32 s19, s3, 4
  s_and_b32 s19, s19, 1
  s_mul_i32 s20, s18, 401408
  s_add_u32 s20, s20, 6422528
  s_mul_i32 s21, s16, 43008
  s_add_u32 s21, s21, s20
  s_mul_i32 s22, s16, 57344
  s_add_u32 s20, s20, s22
  s_add_u32 s22, s20, 0
  buffer_load_dwordx4 a[0:3], v2, s[8:11], s22 offen offset:0 sc1
  buffer_load_dwordx4 a[4:7], v2, s[8:11], s22 offen offset:1024 sc1
  buffer_load_dwordx4 a[8:11], v2, s[8:11], s22 offen offset:2048 sc1
  buffer_load_dwordx4 a[12:15], v2, s[8:11], s22 offen offset:3072 sc1
  s_add_u32 s22, s20, 4096
  buffer_load_dwordx4 a[16:19], v2, s[8:11], s22 offen offset:0 sc1
  buffer_load_dwordx4 a[20:23], v2, s[8:11], s22 offen offset:1024 sc1
  buffer_load_dwordx4 a[24:27], v2, s[8:11], s22 offen offset:2048 sc1
  buffer_load_dwordx4 a[28:31], v2, s[8:11], s22 offen offset:3072 sc1
  s_add_u32 s22, s20, 8192
  buffer_load_dwordx4 a[32:35], v2, s[8:11], s22 offen offset:0 sc1
  buffer_load_dwordx4 a[36:39], v2, s[8:11], s22 offen offset:1024 sc1
  buffer_load_dwordx4 a[40:43], v2, s[8:11], s22 offen offset:2048 sc1
  buffer_load_dwordx4 a[44:47], v2, s[8:11], s22 offen offset:3072 sc1
  s_add_u32 s22, s20, 12288
  buffer_load_dwordx4 a[48:51], v2, s[8:11], s22 offen offset:0 sc1
  buffer_load_dwordx4 a[52:55], v2, s[8:11], s22 offen offset:1024 sc1
  buffer_load_dwordx4 a[56:59], v2, s[8:11], s22 offen offset:2048 sc1
  buffer_load_dwordx4 a[60:63], v2, s[8:11], s22 offen offset:3072 sc1
  s_add_u32 s22, s20, 16384
  buffer_load_dwordx4 a[64:67], v2, s[8:11], s22 offen offset:0 sc1
  buffer_load_dwordx4 a[68:71], v2, s[8:11], s22 offen offset:1024 sc1
  buffer_load_dwordx4 a[72:75], v2, s[8:11], s22 offen offset:2048 sc1
  buffer_load_dwordx4 a[76:79], v2, s[8:11], s22 offen offset:3072 sc1
  s_add_u32 s22, s20, 20480
  buffer_load_dwordx4 a[80:83], v2, s[8:11], s22 offen offset:0 sc1
  buffer_load_dwordx4 a[84:87], v2, s[8:11], s22 offen offset:1024 sc1
  buffer_load_dwordx4 a[88:91], v2, s[8:11], s22 offen offset:2048 sc1
  buffer_load_dwordx4 a[92:95], v2, s[8:11], s22 offen offset:3072 sc1
  s_add_u32 s22, s20, 24576
  buffer_load_dwordx4 a[96:99], v2, s[8:11], s22 offen offset:0 sc1
  buffer_load_dwordx4 a[100:103], v2, s[8:11], s22 offen offset:1024 sc1
  buffer_load_dwordx4 a[104:107], v2, s[8:11], s22 offen offset:2048 sc1
  buffer_load_dwordx4 a[108:111], v2, s[8:11], s22 offen offset:3072 sc1
  s_add_u32 s22, s20, 28672
  buffer_load_dwordx4 a[112:115], v2, s[8:11], s22 offen offset:0 sc1
  buffer_load_dwordx4 a[116:119], v2, s[8:11], s22 offen offset:1024 sc1
  buffer_load_dwordx4 a[120:123], v2, s[8:11], s22 offen offset:2048 sc1
  buffer_load_dwordx4 a[124:127], v2, s[8:11], s22 offen offset:3072 sc1
  s_waitcnt vmcnt(24)
  s_add_u32 s22, s20, 32768
  buffer_load_dwordx4 a[128:131], v2, s[8:11], s22 offen offset:0 sc1
  buffer_load_dwordx4 a[132:135], v2, s[8:11], s22 offen offset:1024 sc1
  buffer_load_dwordx4 a[136:139], v2, s[8:11], s22 offen offset:2048 sc1
  buffer_load_dwordx4 a[140:143], v2, s[8:11], s22 offen offset:3072 sc1
  s_add_u32 s22, s20, 36864
  buffer_load_dwordx4 a[144:147], v2, s[8:11], s22 offen offset:0 sc1
  buffer_load_dwordx4 a[148:151], v2, s[8:11], s22 offen offset:1024 sc1
  buffer_load_dwordx4 a[152:155], v2, s[8:11], s22 offen offset:2048 sc1
  buffer_load_dwordx4 a[156:159], v2, s[8:11], s22 offen offset:3072 sc1
  s_add_u32 s22, s20, 40960
  buffer_load_dwordx4 a[160:163], v2, s[8:11], s22 offen offset:0 sc1
  buffer_load_dwordx4 a[164:167], v2, s[8:11], s22 offen offset:1024 sc1
  buffer_load_dwordx4 a[168:171], v2, s[8:11], s22 offen offset:2048 sc1
  buffer_load_dwordx4 a[172:175], v2, s[8:11], s22 offen offset:3072 sc1
  s_add_u32 s22, s20, 45056
  buffer_load_dwordx4 a[176:179], v2, s[8:11], s22 offen offset:0 sc1
  buffer_load_dwordx4 a[180:183], v2, s[8:11], s22 offen offset:1024 sc1
  buffer_load_dwordx4 a[184:187], v2, s[8:11], s22 offen offset:2048 sc1
  buffer_load_dwordx4 a[188:191], v2, s[8:11], s22 offen offset:3072 sc1
  s_add_u32 s22, s20, 49152
  buffer_load_dwordx4 a[192:195], v2, s[8:11], s22 offen offset:0 sc1
  buffer_load_dwordx4 a[196:199], v2, s[8:11], s22 offen offset:1024 sc1
  buffer_load_dwordx4 a[200:203], v2, s[8:11], s22 offen offset:2048 sc1
  buffer_load_dwordx4 a[204:207], v2, s[8:11], s22 offen offset:3072 sc1
  s_add_u32 s22, s20, 53248
  buffer_load_dwordx4 a[208:211], v2, s[8:11], s22 offen offset:0 sc1
  buffer_load_dwordx4 a[212:215], v2, s[8:11], s22 offen offset:1024 sc1
  buffer_load_dwordx4 a[216:219], v2, s[8:11], s22 offen offset:2048 sc1
  buffer_load_dwordx4 a[220:223], v2, s[8:11], s22 offen offset:3072 sc1
  s_add_u32 s22, s21, 229376
  buffer_load_dwordx4 a[224:227], v2, s[8:11], s22 offen offset:0 sc1
  buffer_load_dwordx4 a[228:231], v2, s[8:11], s22 offen offset:1024 sc1
  buffer_load_dwordx4 a[232:235], v2, s[8:11], s22 offen offset:2048 sc1
  buffer_load_dwordx4 a[236:239], v2, s[8:11], s22 offen offset:3072 sc1
  s_add_u32 s22, s21, 233472
  buffer_load_dwordx4 a[240:243], v2, s[8:11], s22 offen offset:0 sc1
  buffer_load_dwordx4 a[244:247], v2, s[8:11], s22 offen offset:1024 sc1
  buffer_load_dwordx4 a[248:251], v2, s[8:11], s22 offen offset:2048 sc1
  buffer_load_dwordx4 a[252:255], v2, s[8:11], s22 offen offset:3072 sc1
  s_waitcnt vmcnt(24)
  s_add_u32 s22, s21, 237568
  buffer_load_dwordx4 v[120:123], v2, s[8:11], s22 offen offset:0 sc1
  buffer_load_dwordx4 v[124:127], v2, s[8:11], s22 offen offset:1024 sc1
  buffer_load_dwordx4 v[128:131], v2, s[8:11], s22 offen offset:2048 sc1
  buffer_load_dwordx4 v[132:135], v2, s[8:11], s22 offen offset:3072 sc1
  s_add_u32 s22, s21, 241664
  buffer_load_dwordx4 v[136:139], v2, s[8:11], s22 offen offset:0 sc1
  buffer_load_dwordx4 v[140:143], v2, s[8:11], s22 offen offset:1024 sc1
  buffer_load_dwordx4 v[144:147], v2, s[8:11], s22 offen offset:2048 sc1
  buffer_load_dwordx4 v[148:151], v2, s[8:11], s22 offen offset:3072 sc1
  s_add_u32 s22, s21, 245760
  buffer_load_dwordx4 v[152:155], v2, s[8:11], s22 offen offset:0 sc1
  buffer_load_dwordx4 v[156:159], v2, s[8:11], s22 offen offset:1024 sc1
  buffer_load_dwordx4 v[160:163], v2, s[8:11], s22 offen offset:2048 sc1
  buffer_load_dwordx4 v[164:167], v2, s[8:11], s22 offen offset:3072 sc1
  s_add_u32 s22, s21, 249856
  buffer_load_dwordx4 v[168:171], v2, s[8:11], s22 offen offset:0 sc1
  buffer_load_dwordx4 v[172:175], v2, s[8:11], s22 offen offset:1024 sc1
  buffer_load_dwordx4 v[176:179], v2, s[8:11], s22 offen offset:2048 sc1
  buffer_load_dwordx4 v[180:183], v2, s[8:11], s22 offen offset:3072 sc1
  s_add_u32 s22, s21, 253952
  buffer_load_dwordx4 v[184:187], v2, s[8:11], s22 offen offset:0 sc1
  buffer_load_dwordx4 v[188:191], v2, s[8:11], s22 offen offset:1024 sc1
  buffer_load_dwordx4 v[192:195], v2, s[8:11], s22 offen offset:2048 sc1
  buffer_load_dwordx4 v[196:199], v2, s[8:11], s22 offen offset:3072 sc1
  s_add_u32 s22, s21, 258048
  buffer_load_dwordx4 v[200:203], v2, s[8:11], s22 offen offset:0 sc1
  buffer_load_dwordx4 v[204:207], v2, s[8:11], s22 offen offset:1024 sc1
  buffer_load_dwordx4 v[208:211], v2, s[8:11], s22 offen offset:2048 sc1
  buffer_load_dwordx4 v[212:215], v2, s[8:11], s22 offen offset:3072 sc1
  s_add_u32 s22, s21, 262144
  buffer_load_dwordx4 v[216:219], v2, s[8:11], s22 offen offset:0 sc1
  buffer_load_dwordx4 v[220:223], v2, s[8:11], s22 offen offset:1024 sc1
  buffer_load_dwordx4 v[224:227], v2, s[8:11], s22 offen offset:2048 sc1
  buffer_load_dwordx4 v[228:231], v2, s[8:11], s22 offen offset:3072 sc1
  s_add_u32 s22, s21, 266240
  buffer_load_dwordx4 v[232:235], v2, s[8:11], s22 offen offset:0 sc1
  buffer_load_dwordx4 v[236:239], v2, s[8:11], s22 offen offset:1024 sc1
  buffer_load_dwordx4 v[240:243], v2, s[8:11], s22 offen offset:2048 sc1
  buffer_load_dwordx4 v[244:247], v2, s[8:11], s22 offen offset:3072 sc1
  s_waitcnt vmcnt(24)
  s_add_u32 s22, s21, 270336
  buffer_load_dwordx4 v[248:251], v2, s[8:11], s22 offen offset:0 sc1
  buffer_load_dwordx4 v[252:255], v2, s[8:11], s22 offen offset:1024 sc1
  v_mov_b32 v5, 0x4444
  v_mov_b32 v6, 0xeeee
  v_cmp_lt_u32 vcc, 7, v4
  s_nop 1
  v_cndmask_b32 v5, v5, v6, vcc
  s_lshl_b32 s23, s16, 11
  v_lshrrev_b32 v80, 1, v3
  v_and_b32 v81, 1, v3
  v_add_u32 v83, 0, v80
  v_mov_b32 v84, v4
  v_mov_b32 v86, 0
  v_lshl_add_u32 v86, v83, 8, v86
  v_lshl_add_u32 v86, v84, 4, v86
  v_lshl_add_u32 v86, v81, 3, v86
  v_add_u32 v72, s23, v86
  v_add_u32 v83, 2, v80
  v_mov_b32 v84, v4
  v_mov_b32 v86, 0
  v_lshl_add_u32 v86, v83, 8, v86
  v_lshl_add_u32 v86, v84, 4, v86
  v_lshl_add_u32 v86, v81, 3, v86
  v_add_u32 v73, s23, v86
  v_lshl_add_u32 v82, v80, 4, v4
  v_mul_u32_u24 v83, 5462, v82
  v_lshrrev_b32 v83, 16, v83
  v_mul_u32_u24 v84, 12, v83
  v_sub_u32 v84, v82, v84
  v_mov_b32 v86, 1024
  v_lshl_add_u32 v86, v83, 8, v86
  v_lshl_add_u32 v86, v84, 4, v86
  v_lshl_add_u32 v86, v81, 3, v86
  v_add_u32 v74, s23, v86
  v_add_u32 v82, 32, v4
  v_mul_u32_u24 v83, 5462, v82
  v_lshrrev_b32 v83, 16, v83
  v_mul_u32_u24 v84, 12, v83
  v_sub_u32 v84, v82, v84
  v_mov_b32 v86, 1024
  v_lshl_add_u32 v86, v83, 8, v86
  v_lshl_add_u32 v86, v84, 4, v86
  v_lshl_add_u32 v86, v81, 3, v86
  v_add_u32 v75, s23, v86
  v_add_u32 v76, s23, v2
  s_mul_i32 s27, s18, 448
  v_mov_b32 v77, s27
  v_mov_b32 v78, 1
  s_mov_b32 s17, s19
  s_mul_i32 s24, s19, 7168
  s_add_u32 s24, s24, 88080384
  s_mul_i32 s25, s18, 65
  s_add_u32 s25, s25, s19
  s_lshl_b32 s25, s25, 13
  s_add_u32 s25, s25, s23
  s_add_u32 s25, s25, 76947456
  s_lshl_b32 s26, s18, 6
  s_add_u32 s26, s26, s19
  s_lshl_b32 s26, s26, 4
  s_lshl_b32 s27, s16, 2
  s_add_u32 s26, s26, s27
  s_add_u32 s26, s26, 88582144
  v_mov_b32 v87, -1
ws_loop:
  v_mov_b32 v36, 0
  v_mov_b32 v37, 0
  v_mov_b32 v38, 0
  v_mov_b32 v39, 0
  v_mov_b32 v40, 0
  v_mov_b32 v41, 0
  v_mov_b32 v42, 0
  v_mov_b32 v43, 0
  v_mov_b32 v44, 0
  v_mov_b32 v45, 0
  v_mov_b32 v46, 0
  v_mov_b32 v47, 0
  v_mov_b32 v48, 0
  v_mov_b32 v49, 0
  v_mov_b32 v50, 0
  v_mov_b32 v51, 0
  v_mov_b32 v52, 0
  v_mov_b32 v53, 0
  v_mov_b32 v54, 0
  v_mov_b32 v55, 0
  v_mov_b32 v56, 0
  v_mov_b32 v57, 0
  v_mov_b32 v58, 0
  v_mov_b32 v59, 0
  v_mov_b32 v60, 0
  v_mov_b32 v61, 0
  v_mov_b32 v62, 0
  v_mov_b32 v63, 0
  s_mov_b32 s30, 0
  v_cmp_eq_u32 vcc, -1, v87
  s_cbranch_vccz ws_fl
ws_pm:
  s_cmp_ge_u32 s17, 61
  s_cbranch_scc1 mp_41a
  v_mov_b32 v79, 0
  s_mov_b64 exec, 1
  buffer_atomic_or v79, v77, s[8:11], s24 offen sc0
  s_mov_b64 exec, -1
  s_branch mp_41b
mp_41a:
  buffer_load_dword v79, v77, s[8:11], s24 offen sc1
mp_41b:
  s_waitcnt vmcnt(0)
  v_cmp_eq_u32 vcc, -1, v79
  s_cbranch_vccnz ws_pr
ws_fl:
  s_add_u32 s22, s24, 4096
  buffer_load_dwordx4 v[8:11], v2, s[8:11], s24 offen offset:0 sc1
  buffer_load_dwordx4 v[12:15], v2, s[8:11], s24 offen offset:1024 sc1
  buffer_load_dwordx4 v[16:19], v2, s[8:11], s24 offen offset:2048 sc1
  buffer_load_dwordx4 v[20:23], v2, s[8:11], s24 offen offset:3072 sc1
  buffer_load_dwordx4 v[24:27], v2, s[8:11], s22 offen offset:0 sc1
  buffer_load_dwordx4 v[28:31], v2, s[8:11], s22 offen offset:1024 sc1
  buffer_load_dwordx4 v[32:35], v2, s[8:11], s22 offen offset:2048 sc1
  s_waitcnt vmcnt(0)
  v_max_u32 v79, v8, v9
  v_max3_u32 v79, v79, v10, v11
  v_max3_u32 v79, v79, v12, v13
  v_max3_u32 v79, v79, v14, v15
  v_max3_u32 v79, v79, v16, v17
  v_max3_u32 v79, v79, v18, v19
  v_max3_u32 v79, v79, v20, v21
  v_max3_u32 v79, v79, v22, v23
  v_max3_u32 v79, v79, v24, v25
  v_max3_u32 v79, v79, v26, v27
  v_max3_u32 v79, v79, v28, v29
  v_max3_u32 v79, v79, v30, v31
  v_max3_u32 v79, v79, v32, v33
  v_max3_u32 v79, v79, v34, v35
  v_cmp_eq_u32 vcc, -1, v79
  s_cbranch_vccz ws_pk
ws_pr:
  s_sleep 1
  s_cmp_ge_u32 s17, 61
  s_cbranch_scc1 ws_sh
  s_sleep 6
ws_sh:
  s_add_u32 s30, s30, 1
  s_cmp_lt_u32 s30, 30000
  s_cbranch_scc1 ws_pm
  s_branch cA_abort
ws_pk:
  s_cmp_ge_u32 s17, 62
  s_cbranch_scc1 ws_na
  s_add_u32 s22, s24, 14336
  s_cmp_ge_u32 s17, 61
  s_cbranch_scc1 mp_42a
  v_mov_b32 v87, 0
  s_mov_b64 exec, 1
  buffer_atomic_or v87, v77, s[8:11], s22 offen sc0
  s_mov_b64 exec, -1
  s_branch mp_42b
mp_42a:
  buffer_load_dword v87, v77, s[8:11], s22 offen sc1
mp_42b:
ws_na:
  v_smfmac_f32_16x16x64_bf16 v[36:39], v[8:11], a[0:7], v5
  v_smfmac_f32_16x16x64_bf16 v[36:39], v[12:15], a[8:15], v5
  v_smfmac_f32_16x16x64_bf16 v[36:39], v[16:19], a[16:23], v5
  v_smfmac_f32_16x16x64_bf16 v[36:39], v[20:23], a[24:31], v5
  v_smfmac_f32_16x16x64_bf16 v[36:39], v[24:27], a[32:39], v5
  v_smfmac_f32_16x16x64_bf16 v[36:39], v[28:31], a[40:47], v5
  v_smfmac_f32_16x16x64_bf16 v[36:39], v[32:35], a[48:55], v5
  v_smfmac_f32_16x16x64_bf16 v[40:43], v[8:11], a[56:63], v5
  v_smfmac_f32_16x16x64_bf16 v[40:43], v[12:15], a[64:71], v5
  v_smfmac_f32_16x16x64_bf16 v[40:43], v[16:19], a[72:79], v5
  v_smfmac_f32_16x16x64_bf16 v[40:43], v[20:23], a[80:87], v5
  v_smfmac_f32_16x16x64_bf16 v[40:43], v[24:27], a[88:95], v5
  v_smfmac_f32_16x16x64_bf16 v[40:43], v[28:31], a[96:103], v5
  v_smfmac_f32_16x16x64_bf16 v[40:43], v[32:35], a[104:111], v5
  v_smfmac_f32_16x16x64_bf16 v[44:47], v[8:11], a[112:119], v5
  v_smfmac_f32_16x16x64_bf16 v[44:47], v[12:15], a[120:127], v5
  v_smfmac_f32_16x16x64_bf16 v[44:47], v[16:19], a[128:135], v5
  v_smfmac_f32_16x16x64_bf16 v[44:47], v[20:23], a[136:143], v5
  v_smfmac_f32_16x16x64_bf16 v[44:47], v[24:27], a[144:151], v5
  v_smfmac_f32_16x16x64_bf16 v[44:47], v[28:31], a[152:159], v5
  v_smfmac_f32_16x16x64_bf16 v[44:47], v[32:35], a[160:167], v5
  v_smfmac_f32_16x16x64_bf16 v[48:51], v[8:11], a[168:175], v5
  v_smfmac_f32_16x16x64_bf16 v[48:51], v[12:15], a[176:183], v5
  v_smfmac_f32_16x16x64_bf16 v[48:51], v[16:19], a[184:191], v5
  v_smfmac_f32_16x16x64_bf16 v[48:51], v[20:23], a[192:199], v5
  v_smfmac_f32_16x16x64_bf16 v[48:51], v[24:27], a[200:207], v5
  v_smfmac_f32_16x16x64_bf16 v[48:51], v[28:31], a[208:215], v5
  v_smfmac_f32_16x16x64_bf16 v[48:51], v[32:35], a[216:223], v5
  v_smfmac_f32_16x16x64_bf16 v[52:55], v[8:11], a[224:231], v5
  v_smfmac_f32_16x16x64_bf16 v[52:55], v[12:15], a[232:239], v5
  v_smfmac_f32_16x16x64_bf16 v[52:55], v[16:19], a[240:247], v5
  v_smfmac_f32_16x16x64_bf16 v[52:55], v[20:23], a[248:255], v5
  v_smfmac_f32_16x16x64_bf16 v[52:55], v[24:27], v[120:127], v5
  v_smfmac_f32_16x16x64_bf16 v[52:55], v[28:31], v[128:135], v5
  v_smfmac_f32_16x16x64_bf16 v[52:55], v[32:35], v[136:143], v5
  v_smfmac_f32_16x16x64_bf16 v[56:59], v[8:11], v[144:151], v5
  v_smfmac_f32_16x16x64_bf16 v[56:59], v[12:15], v[152:159], v5
  v_smfmac_f32_16x16x64_bf16 v[56:59], v[16:19], v[160:167], v5
  v_smfmac_f32_16x16x64_bf16 v[56:59], v[20:23], v[168:175], v5
  v_smfmac_f32_16x16x64_bf16 v[56:59], v[24:27], v[176:183], v5
  v_smfmac_f32_16x16x64_bf16 v[56:59], v[28:31], v[184:191], v5
  v_smfmac_f32_16x16x64_bf16 v[56:59], v[32:35], v[192:199], v5
  v_smfmac_f32_16x16x64_bf16 v[60:63], v[8:11], v[200:207], v5
  v_smfmac_f32_16x16x64_bf16 v[60:63], v[12:15], v[208:215], v5
  v_smfmac_f32_16x16x64_bf16 v[60:63], v[16:19], v[216:223], v5
  v_smfmac_f32_16x16x64_bf16 v[60:63], v[20:23], v[224:231], v5
  v_smfmac_f32_16x16x64_bf16 v[60:63], v[24:27], v[232:239], v5
  v_smfmac_f32_16x16x64_bf16 v[60:63], v[28:31], v[240:247], v5
  v_smfmac_f32_16x16x64_bf16 v[60:63], v[32:35], v[248:255], v5
  v_permlane32_swap_b32 v36, v40
  v_permlane32_swap_b32 v37, v41
  v_permlane32_swap_b32 v38, v42
  v_permlane32_swap_b32 v39, v43
  v_add_f32 v36, v36, v40
  v_add_f32 v37, v37, v41
  v_add_f32 v38, v38, v42
  v_add_f32 v39, v39, v43
  v_cvt_pk_bf16_f32 v40, v36, v37
  v_cvt_pk_bf16_f32 v41, v38, v39
  ds_write_b64 v72, v[40:41]
  v_permlane32_swap_b32 v44, v48
  v_permlane32_swap_b32 v45, v49
  v_permlane32_swap_b32 v46, v50
  v_permlane32_swap_b32 v47, v51
  v_add_f32 v44, v44, v48
  v_add_f32 v45, v45, v49
  v_add_f32 v46, v46, v50
  v_add_f32 v47, v47, v51
  v_cvt_pk_bf16_f32 v48, v44, v45
  v_cvt_pk_bf16_f32 v49, v46, v47
  ds_write_b64 v73, v[48:49]
  v_permlane32_swap_b32 v52, v56
  v_permlane32_swap_b32 v53, v57
  v_permlane32_swap_b32 v54, v58
  v_permlane32_swap_b32 v55, v59
  v_add_f32 v52, v52, v56
  v_add_f32 v53, v53, v57
  v_add_f32 v54, v54, v58
  v_add_f32 v55, v55, v59
  v_cvt_pk_bf16_f32 v56, v52, v53
  v_cvt_pk_bf16_f32 v57, v54, v55
  ds_write_b64 v74, v[56:57]
  v_mov_b32 v64, v60
  v_mov_b32 v65, v61
  v_mov_b32 v66, v62
  v_mov_b32 v67, v63
  v_permlane32_swap_b32 v60, v64
  v_permlane32_swap_b32 v61, v65
  v_permlane32_swap_b32 v62, v66
  v_permlane32_swap_b32 v63, v67
  v_add_f32 v60, v60, v64
  v_add_f32 v61, v61, v65
  v_add_f32 v62, v62, v66
  v_add_f32 v63, v63, v67
  v_cvt_pk_bf16_f32 v64, v60, v61
  v_cvt_pk_bf16_f32 v65, v62, v63
  ds_write_b64 v75, v[64:65]
  s_waitcnt lgkmcnt(0)
  ds_read_b128 v[64:67], v76
  ds_read_b128 v[68:71], v76 offset:1024
  s_waitcnt lgkmcnt(0)
  buffer_store_dwordx4 v[64:67], v2, s[8:11], s25 offen sc1
  buffer_store_dwordx4 v[68:71], v2, s[8:11], s25 offen offset:1024 sc1
  s_waitcnt vmcnt(0)
  s_mov_b64 exec, 1
  buffer_store_dword v78, v2, s[8:11], s26 offen sc1
  s_mov_b64 exec, -1
  s_add_u32 s24, s24, 14336
  s_add_u32 s25, s25, 16384
  s_add_u32 s26, s26, 32
  s_add_u32 s17, s17, 2
  s_cmp_lt_u32 s17, 64
  s_cbranch_scc1 ws_loop
  v_mov_b32 v250, 0
  s_branch wk_loop
wk_s4d:
  s_cmp_lg_u32 s16, 0
  s_cbranch_scc1 w0_43
  s_getreg_b32 s20, hwreg(HW_REG_XCC_ID)
  s_sub_u32 s20, s20, 1
  s_and_b32 s20, s20, 7
  s_mov_b64 exec, 1
s4_l:
  s_cmp_ge_u32 s20, 7
  s_cselect_b32 s20, 0, s20
  s_lshl_b32 s21, s20, 7
  s_add_u32 s21, s21, 88598528
  v_mov_b32 v242, 1
  buffer_atomic_add v242, off, s[8:11], s21 sc0
  s_waitcnt vmcnt(0)
  v_readfirstlane_b32 s21, v242
  s_lshl_b32 s22, s20, 4
  s_add_u32 s20, s20, 1
  s_cmp_ge_u32 s21, 16
  s_cbranch_scc1 s4_l
  v_add_u32 v242, s22, v242
  s_mov_b64 exec, -1
w0_43:
  v_mov_b32 v243, 160000
  s_add_u32 s101, s101, 1
  s_barrier
  s_mov_b64 exec, 1
  s_cmp_lg_u32 s16, 0
  s_cbranch_scc1 w0_44
  ds_write_b32 v243, v242 offset:0
  s_waitcnt lgkmcnt(0)
  v_mov_b32 v242, s101
  ds_write_b32 v243, v242 offset:16
  s_waitcnt lgkmcnt(0)
w0_44:
  s_mov_b64 exec, -1
  s_barrier
  ds_read_b32 v242, v243 offset:0
  ds_read_b32 v243, v243 offset:16
  s_waitcnt lgkmcnt(0)
  v_readfirstlane_b32 s3, v242
  v_cmp_ne_u32 vcc, s101, v243
  s_cbranch_vccnz ch_end
  s_load_dwordx8 s[40:47], s[0:1], 0
  s_load_dwordx4 s[48:51], s[0:1], 32
  s_load_dwordx2 s[52:53], s[0:1], 48
  s_load_dwordx2 s[54:55], s[0:1], 112
  v_lshrrev_b32 v1, 6, v0
  s_nop 0
  v_readfirstlane_b32 s16, v1
  v_and_b32 v1, 63, v0
  v_lshrrev_b32 v3, 4, v1
  v_and_b32 v4, 15, v1
  s_mul_i32 s17, s16, 24576
  s_waitcnt lgkmcnt(0)
  s_mov_b32 s60, s40
  s_and_b32 s61, s41, 0xffff
  s_mov_b32 s62, 1835008
  s_mov_b32 s63, 0x20000
  s_mov_b32 s64, s42
  s_and_b32 s65, s43, 0xffff
  s_mov_b32 s66, 229376
  s_mov_b32 s67, 0x20000
  s_mov_b32 s68, s44
  s_and_b32 s69, s45, 0xffff
  s_mov_b32 s70, 229376
  s_mov_b32 s71, 0x20000
  s_mov_b32 s72, s46
  s_and_b32 s73, s47, 0xffff
  s_mov_b32 s74, 229376
  s_mov_b32 s75, 0x20000
  s_mov_b32 s76, s48
  s_and_b32 s77, s49, 0xffff
  s_mov_b32 s78, 229376
  s_mov_b32 s79, 0x20000
  s_mov_b32 s80, s50
  s_and_b32 s81, s51, 0xffff
  s_mov_b32 s82, 896
  s_mov_b32 s83, 0x20000
  s_mov_b32 s84, s52
  s_and_b32 s85, s53, 0xffff
  s_mov_b32 s86, 896
  s_mov_b32 s87, 0x20000
  s_mov_b32 s92, s54
  s_and_b32 s93, s55, 0xffff
  s_mov_b32 s94, 3670016
  s_mov_b32 s95, 0x20000
  v_lshlrev_b32 v5, 5, v1
  v_sub_u32 v5, 2047, v5
  s_add_u32 s18, s17, 13056
  v_subrev_u32 v6, 0, v5
  v_max_i32 v7, 0, v6
  v_cvt_f32_u32 v7, v7
  v_cvt_pk_bf16_f32 v8, v7, v7
  v_and_b32 v7, 0xffff0000, v8
  v_lshrrev_b32 v8, 23, v7
  v_subrev_u32 v8, 134, v8
  v_max_i32 v8, 0, v8
  v_cvt_u32_f32 v7, v7
  v_lshrrev_b32 v7, v8, v7
  v_lshl_add_u32 v7, v8, 8, v7
  v_lshl_add_u32 v200, v7, 2, s18
  v_subrev_u32 v6, 1, v5
  v_max_i32 v7, 0, v6
  v_cvt_f32_u32 v7, v7
  v_cvt_pk_bf16_f32 v8, v7, v7
  v_and_b32 v7, 0xffff0000, v8
  v_lshrrev_b32 v8, 23, v7
  v_subrev_u32 v8, 134, v8
  v_max_i32 v8, 0, v8
  v_cvt_u32_f32 v7, v7
  v_lshrrev_b32 v7, v8, v7
  v_lshl_add_u32 v7, v8, 8, v7
  v_lshl_add_u32 v201, v7, 2, s18
  v_subrev_u32 v6, 2, v5
  v_max_i32 v7, 0, v6
  v_cvt_f32_u32 v7, v7
  v_cvt_pk_bf16_f32 v8, v7, v7
  v_and_b32 v7, 0xffff0000, v8
  v_lshrrev_b32 v8, 23, v7
  v_subrev_u32 v8, 134, v8
  v_max_i32 v8, 0, v8
  v_cvt_u32_f32 v7, v7
  v_lshrrev_b32 v7, v8, v7
  v_lshl_add_u32 v7, v8, 8, v7
  v_lshl_add_u32 v202, v7, 2, s18
  v_subrev_u32 v6, 3, v5
  v_max_i32 v7, 0, v6
  v_cvt_f32_u32 v7, v7
  v_cvt_pk_bf16_f32 v8, v7, v7
  v_and_b32 v7, 0xffff0000, v8
  v_lshrrev_b32 v8, 23, v7
  v_subrev_u32 v8, 134, v8
  v_max_i32 v8, 0, v8
  v_cvt_u32_f32 v7, v7
  v_lshrrev_b32 v7, v8, v7
  v_lshl_add_u32 v7, v8, 8, v7
  v_lshl_add_u32 v203, v7, 2, s18
  v_subrev_u32 v6, 4, v5
  v_max_i32 v7, 0, v6
  v_cvt_f32_u32 v7, v7
  v_cvt_pk_bf16_f32 v8, v7, v7
  v_and_b32 v7, 0xffff0000, v8
  v_lshrrev_b32 v8, 23, v7
  v_subrev_u32 v8, 134, v8
  v_max_i32 v8, 0, v8
  v_cvt_u32_f32 v7, v7
  v_lshrrev_b32 v7, v8, v7
  v_lshl_add_u32 v7, v8, 8, v7
  v_lshl_add_u32 v204, v7, 2, s18
  v_subrev_u32 v6, 5, v5
  v_max_i32 v7, 0, v6
  v_cvt_f32_u32 v7, v7
  v_cvt_pk_bf16_f32 v8, v7, v7
  v_and_b32 v7, 0xffff0000, v8
  v_lshrrev_b32 v8, 23, v7
  v_subrev_u32 v8, 134, v8
  v_max_i32 v8, 0, v8
  v_cvt_u32_f32 v7, v7
  v_lshrrev_b32 v7, v8, v7
  v_lshl_add_u32 v7, v8, 8, v7
  v_lshl_add_u32 v205, v7, 2, s18
  v_subrev_u32 v6, 6, v5
  v_max_i32 v7, 0, v6
  v_cvt_f32_u32 v7, v7
  v_cvt_pk_bf16_f32 v8, v7, v7
  v_and_b32 v7, 0xffff0000, v8
  v_lshrrev_b32 v8, 23, v7
  v_subrev_u32 v8, 134, v8
  v_max_i32 v8, 0, v8
  v_cvt_u32_f32 v7, v7
  v_lshrrev_b32 v7, v8, v7
  v_lshl_add_u32 v7, v8, 8, v7
  v_lshl_add_u32 v206, v7, 2, s18
  v_subrev_u32 v6, 7, v5
  v_max_i32 v7, 0, v6
  v_cvt_f32_u32 v7, v7
  v_cvt_pk_bf16_f32 v8, v7, v7
  v_and_b32 v7, 0xffff0000, v8
  v_lshrrev_b32 v8, 23, v7
  v_subrev_u32 v8, 134, v8
  v_max_i32 v8, 0, v8
  v_cvt_u32_f32 v7, v7
  v_lshrrev_b32 v7, v8, v7
  v_lshl_add_u32 v7, v8, 8, v7
  v_lshl_add_u32 v207, v7, 2, s18
  v_subrev_u32 v6, 8, v5
  v_max_i32 v7, 0, v6
  v_cvt_f32_u32 v7, v7
  v_cvt_pk_bf16_f32 v8, v7, v7
  v_and_b32 v7, 0xffff0000, v8
  v_lshrrev_b32 v8, 23, v7
  v_subrev_u32 v8, 134, v8
  v_max_i32 v8, 0, v8
  v_cvt_u32_f32 v7, v7
  v_lshrrev_b32 v7, v8, v7
  v_lshl_add_u32 v7, v8, 8, v7
  v_lshl_add_u32 v208, v7, 2, s18
  v_subrev_u32 v6, 9, v5
  v_max_i32 v7, 0, v6
  v_cvt_f32_u32 v7, v7
  v_cvt_pk_bf16_f32 v8, v7, v7
  v_and_b32 v7, 0xffff0000, v8
  v_lshrrev_b32 v8, 23, v7
  v_subrev_u32 v8, 134, v8
  v_max_i32 v8, 0, v8
  v_cvt_u32_f32 v7, v7
  v_lshrrev_b32 v7, v8, v7
  v_lshl_add_u32 v7, v8, 8, v7
  v_lshl_add_u32 v209, v7, 2, s18
  v_subrev_u32 v6, 10, v5
  v_max_i32 v7, 0, v6
  v_cvt_f32_u32 v7, v7
  v_cvt_pk_bf16_f32 v8, v7, v7
  v_and_b32 v7, 0xffff0000, v8
  v_lshrrev_b32 v8, 23, v7
  v_subrev_u32 v8, 134, v8
  v_max_i32 v8, 0, v8
  v_cvt_u32_f32 v7, v7
  v_lshrrev_b32 v7, v8, v7
  v_lshl_add_u32 v7, v8, 8, v7
  v_lshl_add_u32 v210, v7, 2, s18
  v_subrev_u32 v6, 11, v5
  v_max_i32 v7, 0, v6
  v_cvt_f32_u32 v7, v7
  v_cvt_pk_bf16_f32 v8, v7, v7
  v_and_b32 v7, 0xffff0000, v8
  v_lshrrev_b32 v8, 23, v7
  v_subrev_u32 v8, 134, v8
  v_max_i32 v8, 0, v8
  v_cvt_u32_f32 v7, v7
  v_lshrrev_b32 v7, v8, v7
  v_lshl_add_u32 v7, v8, 8, v7
  v_lshl_add_u32 v211, v7, 2, s18
  v_subrev_u32 v6, 12, v5
  v_max_i32 v7, 0, v6
  v_cvt_f32_u32 v7, v7
  v_cvt_pk_bf16_f32 v8, v7, v7
  v_and_b32 v7, 0xffff0000, v8
  v_lshrrev_b32 v8, 23, v7
  v_subrev_u32 v8, 134, v8
  v_max_i32 v8, 0, v8
  v_cvt_u32_f32 v7, v7
  v_lshrrev_b32 v7, v8, v7
  v_lshl_add_u32 v7, v8, 8, v7
  v_lshl_add_u32 v212, v7, 2, s18
  v_subrev_u32 v6, 13, v5
  v_max_i32 v7, 0, v6
  v_cvt_f32_u32 v7, v7
  v_cvt_pk_bf16_f32 v8, v7, v7
  v_and_b32 v7, 0xffff0000, v8
  v_lshrrev_b32 v8, 23, v7
  v_subrev_u32 v8, 134, v8
  v_max_i32 v8, 0, v8
  v_cvt_u32_f32 v7, v7
  v_lshrrev_b32 v7, v8, v7
  v_lshl_add_u32 v7, v8, 8, v7
  v_lshl_add_u32 v213, v7, 2, s18
  v_subrev_u32 v6, 14, v5
  v_max_i32 v7, 0, v6
  v_cvt_f32_u32 v7, v7
  v_cvt_pk_bf16_f32 v8, v7, v7
  v_and_b32 v7, 0xffff0000, v8
  v_lshrrev_b32 v8, 23, v7
  v_subrev_u32 v8, 134, v8
  v_max_i32 v8, 0, v8
  v_cvt_u32_f32 v7, v7
  v_lshrrev_b32 v7, v8, v7
  v_lshl_add_u32 v7, v8, 8, v7
  v_lshl_add_u32 v214, v7, 2, s18
  v_subrev_u32 v6, 15, v5
  v_max_i32 v7, 0, v6
  v_cvt_f32_u32 v7, v7
  v_cvt_pk_bf16_f32 v8, v7, v7
  v_and_b32 v7, 0xffff0000, v8
  v_lshrrev_b32 v8, 23, v7
  v_subrev_u32 v8, 134, v8
  v_max_i32 v8, 0, v8
  v_cvt_u32_f32 v7, v7
  v_lshrrev_b32 v7, v8, v7
  v_lshl_add_u32 v7, v8, 8, v7
  v_lshl_add_u32 v215, v7, 2, s18
  v_subrev_u32 v6, 16, v5
  v_max_i32 v7, 0, v6
  v_cvt_f32_u32 v7, v7
  v_cvt_pk_bf16_f32 v8, v7, v7
  v_and_b32 v7, 0xffff0000, v8
  v_lshrrev_b32 v8, 23, v7
  v_subrev_u32 v8, 134, v8
  v_max_i32 v8, 0, v8
  v_cvt_u32_f32 v7, v7
  v_lshrrev_b32 v7, v8, v7
  v_lshl_add_u32 v7, v8, 8, v7
  v_lshl_add_u32 v216, v7, 2, s18
  v_subrev_u32 v6, 17, v5
  v_max_i32 v7, 0, v6
  v_cvt_f32_u32 v7, v7
  v_cvt_pk_bf16_f32 v8, v7, v7
  v_and_b32 v7, 0xffff0000, v8
  v_lshrrev_b32 v8, 23, v7
  v_subrev_u32 v8, 134, v8
  v_max_i32 v8, 0, v8
  v_cvt_u32_f32 v7, v7
  v_lshrrev_b32 v7, v8, v7
  v_lshl_add_u32 v7, v8, 8, v7
  v_lshl_add_u32 v217, v7, 2, s18
  v_subrev_u32 v6, 18, v5
  v_max_i32 v7, 0, v6
  v_cvt_f32_u32 v7, v7
  v_cvt_pk_bf16_f32 v8, v7, v7
  v_and_b32 v7, 0xffff0000, v8
  v_lshrrev_b32 v8, 23, v7
  v_subrev_u32 v8, 134, v8
  v_max_i32 v8, 0, v8
  v_cvt_u32_f32 v7, v7
  v_lshrrev_b32 v7, v8, v7
  v_lshl_add_u32 v7, v8, 8, v7
  v_lshl_add_u32 v218, v7, 2, s18
  v_subrev_u32 v6, 19, v5
  v_max_i32 v7, 0, v6
  v_cvt_f32_u32 v7, v7
  v_cvt_pk_bf16_f32 v8, v7, v7
  v_and_b32 v7, 0xffff0000, v8
  v_lshrrev_b32 v8, 23, v7
  v_subrev_u32 v8, 134, v8
  v_max_i32 v8, 0, v8
  v_cvt_u32_f32 v7, v7
  v_lshrrev_b32 v7, v8, v7
  v_lshl_add_u32 v7, v8, 8, v7
  v_lshl_add_u32 v219, v7, 2, s18
  v_subrev_u32 v6, 20, v5
  v_max_i32 v7, 0, v6
  v_cvt_f32_u32 v7, v7
  v_cvt_pk_bf16_f32 v8, v7, v7
  v_and_b32 v7, 0xffff0000, v8
  v_lshrrev_b32 v8, 23, v7
  v_subrev_u32 v8, 134, v8
  v_max_i32 v8, 0, v8
  v_cvt_u32_f32 v7, v7
  v_lshrrev_b32 v7, v8, v7
  v_lshl_add_u32 v7, v8, 8, v7
  v_lshl_add_u32 v220, v7, 2, s18
  v_subrev_u32 v6, 21, v5
  v_max_i32 v7, 0, v6
  v_cvt_f32_u32 v7, v7
  v_cvt_pk_bf16_f32 v8, v7, v7
  v_and_b32 v7, 0xffff0000, v8
  v_lshrrev_b32 v8, 23, v7
  v_subrev_u32 v8, 134, v8
  v_max_i32 v8, 0, v8
  v_cvt_u32_f32 v7, v7
  v_lshrrev_b32 v7, v8, v7
  v_lshl_add_u32 v7, v8, 8, v7
  v_lshl_add_u32 v221, v7, 2, s18
  v_subrev_u32 v6, 22, v5
  v_max_i32 v7, 0, v6
  v_cvt_f32_u32 v7, v7
  v_cvt_pk_bf16_f32 v8, v7, v7
  v_and_b32 v7, 0xffff0000, v8
  v_lshrrev_b32 v8, 23, v7
  v_subrev_u32 v8, 134, v8
  v_max_i32 v8, 0, v8
  v_cvt_u32_f32 v7, v7
  v_lshrrev_b32 v7, v8, v7
  v_lshl_add_u32 v7, v8, 8, v7
  v_lshl_add_u32 v222, v7, 2, s18
  v_subrev_u32 v6, 23, v5
  v_max_i32 v7, 0, v6
  v_cvt_f32_u32 v7, v7
  v_cvt_pk_bf16_f32 v8, v7, v7
  v_and_b32 v7, 0xffff0000, v8
  v_lshrrev_b32 v8, 23, v7
  v_subrev_u32 v8, 134, v8
  v_max_i32 v8, 0, v8
  v_cvt_u32_f32 v7, v7
  v_lshrrev_b32 v7, v8, v7
  v_lshl_add_u32 v7, v8, 8, v7
  v_lshl_add_u32 v223, v7, 2, s18
  v_subrev_u32 v6, 24, v5
  v_max_i32 v7, 0, v6
  v_cvt_f32_u32 v7, v7
  v_cvt_pk_bf16_f32 v8, v7, v7
  v_and_b32 v7, 0xffff0000, v8
  v_lshrrev_b32 v8, 23, v7
  v_subrev_u32 v8, 134, v8
  v_max_i32 v8, 0, v8
  v_cvt_u32_f32 v7, v7
  v_lshrrev_b32 v7, v8, v7
  v_lshl_add_u32 v7, v8, 8, v7
  v_lshl_add_u32 v224, v7, 2, s18
  v_subrev_u32 v6, 25, v5
  v_max_i32 v7, 0, v6
  v_cvt_f32_u32 v7, v7
  v_cvt_pk_bf16_f32 v8, v7, v7
  v_and_b32 v7, 0xffff0000, v8
  v_lshrrev_b32 v8, 23, v7
  v_subrev_u32 v8, 134, v8
  v_max_i32 v8, 0, v8
  v_cvt_u32_f32 v7, v7
  v_lshrrev_b32 v7, v8, v7
  v_lshl_add_u32 v7, v8, 8, v7
  v_lshl_add_u32 v225, v7, 2, s18
  v_subrev_u32 v6, 26, v5
  v_max_i32 v7, 0, v6
  v_cvt_f32_u32 v7, v7
  v_cvt_pk_bf16_f32 v8, v7, v7
  v_and_b32 v7, 0xffff0000, v8
  v_lshrrev_b32 v8, 23, v7
  v_subrev_u32 v8, 134, v8
  v_max_i32 v8, 0, v8
  v_cvt_u32_f32 v7, v7
  v_lshrrev_b32 v7, v8, v7
  v_lshl_add_u32 v7, v8, 8, v7
  v_lshl_add_u32 v226, v7, 2, s18
  v_subrev_u32 v6, 27, v5
  v_max_i32 v7, 0, v6
  v_cvt_f32_u32 v7, v7
  v_cvt_pk_bf16_f32 v8, v7, v7
  v_and_b32 v7, 0xffff0000, v8
  v_lshrrev_b32 v8, 23, v7
  v_subrev_u32 v8, 134, v8
  v_max_i32 v8, 0, v8
  v_cvt_u32_f32 v7, v7
  v_lshrrev_b32 v7, v8, v7
  v_lshl_add_u32 v7, v8, 8, v7
  v_lshl_add_u32 v227, v7, 2, s18
  v_subrev_u32 v6, 28, v5
  v_max_i32 v7, 0, v6
  v_cvt_f32_u32 v7, v7
  v_cvt_pk_bf16_f32 v8, v7, v7
  v_and_b32 v7, 0xffff0000, v8
  v_lshrrev_b32 v8, 23, v7
  v_subrev_u32 v8, 134, v8
  v_max_i32 v8, 0, v8
  v_cvt_u32_f32 v7, v7
  v_lshrrev_b32 v7, v8, v7
  v_lshl_add_u32 v7, v8, 8, v7
  v_lshl_add_u32 v228, v7, 2, s18
  v_subrev_u32 v6, 29, v5
  v_max_i32 v7, 0, v6
  v_cvt_f32_u32 v7, v7
  v_cvt_pk_bf16_f32 v8, v7, v7
  v_and_b32 v7, 0xffff0000, v8
  v_lshrrev_b32 v8, 23, v7
  v_subrev_u32 v8, 134, v8
  v_max_i32 v8, 0, v8
  v_cvt_u32_f32 v7, v7
  v_lshrrev_b32 v7, v8, v7
  v_lshl_add_u32 v7, v8, 8, v7
  v_lshl_add_u32 v229, v7, 2, s18
  v_subrev_u32 v6, 30, v5
  v_max_i32 v7, 0, v6
  v_cvt_f32_u32 v7, v7
  v_cvt_pk_bf16_f32 v8, v7, v7
  v_and_b32 v7, 0xffff0000, v8
  v_lshrrev_b32 v8, 23, v7
  v_subrev_u32 v8, 134, v8
  v_max_i32 v8, 0, v8
  v_cvt_u32_f32 v7, v7
  v_lshrrev_b32 v7, v8, v7
  v_lshl_add_u32 v7, v8, 8, v7
  v_lshl_add_u32 v230, v7, 2, s18
  v_subrev_u32 v6, 31, v5
  v_max_i32 v7, 0, v6
  v_cvt_f32_u32 v7, v7
  v_cvt_pk_bf16_f32 v8, v7, v7
  v_and_b32 v7, 0xffff0000, v8
  v_lshrrev_b32 v8, 23, v7
  v_subrev_u32 v8, 134, v8
  v_max_i32 v8, 0, v8
  v_cvt_u32_f32 v7, v7
  v_lshrrev_b32 v7, v8, v7
  v_lshl_add_u32 v7, v8, 8, v7
  v_lshl_add_u32 v231, v7, 2, s18
  v_subrev_u32 v6, 32, v5
  v_max_i32 v7, 0, v6
  v_cvt_f32_u32 v7, v7
  v_cvt_pk_bf16_f32 v8, v7, v7
  v_and_b32 v7, 0xffff0000, v8
  v_lshrrev_b32 v8, 23, v7
  v_subrev_u32 v8, 134, v8
  v_max_i32 v8, 0, v8
  v_cvt_u32_f32 v7, v7
  v_lshrrev_b32 v7, v8, v7
  v_lshl_add_u32 v7, v8, 8, v7
  v_mov_b32 v8, 1280
  v_cmp_gt_i32 vcc, 0, v6
  s_nop 1
  v_cndmask_b32 v7, v7, v8, vcc
  v_lshl_add_u32 v232, v7, 2, s18
  v_mov_b32 v8, 0
  v_mov_b32 v9, 0
  v_lshlrev_b32 v5, 3, v1
  v_add_u32 v5, s17, v5
  ds_write_b64 v5, v[8:9]
  v_and_b32 v6, 15, v1
  v_lshlrev_b32 v6, 3, v6
  v_add_u32 v6, s17, v6
  ds_write_b64 v6, v[8:9] offset:8704
  ds_write_b64 v6, v[8:9] offset:12928
  v_mov_b32 v6, s17
  ds_write_b64 v6, v[8:9] offset:18176
  s_lshl_b32 s19, s3, 2
  s_add_u32 s20, s19, s16
  s_lshl_b32 s21, s3, 3
  v_mul_u32_u24 v5, 3584, v0
  v_mul_u32_u24 v141, 1792, v0
  s_lshl_b32 s22, s20, 9
  v_lshlrev_b32 v6, 3, v1
  buffer_load_dwordx2 v[24:25], v6, s[64:67], s22 offen
  buffer_load_dwordx2 v[26:27], v6, s[68:71], s22 offen
  buffer_load_dwordx2 v[28:29], v6, s[72:75], s22 offen
  buffer_load_dwordx2 v[30:31], v6, s[76:79], s22 offen
  s_lshl_b32 s22, s20, 1
  v_mov_b32 v7, 0
  buffer_load_ushort v32, v7, s[80:83], s22 offen
  buffer_load_ushort v33, v7, s[84:87], s22 offen
  s_mov_b32 s24, 0x05040100
  s_mov_b32 s25, 0x07060302
  s_barrier
  s_waitcnt vmcnt(0)
  s_mov_b32 s26, 1069066811
  s_mov_b32 s27, 1042479491
  v_lshlrev_b32 v32, 16, v32
  v_lshlrev_b32 v33, 16, v33
  v_mul_f32 v32, s26, v32
  v_exp_f32 v32, v32
  s_nop 0
  v_cvt_pk_bf16_f32 v34, v32, v32
  v_and_b32 v32, 0xffff0000, v34
  v_lshlrev_b32 v37, 6, v1
  v_add_u32 v37, s17, v37
  v_lshlrev_b32 v40, 16, v24
  v_lshlrev_b32 v41, 16, v26
  v_lshlrev_b32 v42, 16, v28
  v_lshlrev_b32 v43, 16, v30
  v_mul_f32 v40, s26, v40
  v_exp_f32 v40, v40
  s_nop 0
  v_cvt_pk_bf16_f32 v34, v40, v40
  v_and_b32 v40, 0xffff0000, v34
  v_mul_f32 v40, v40, v32
  v_mul_f32 v40, s26, v40
  v_sub_f32 v40, 0, v40
  v_mul_f32 v41, v41, v32
  v_mul_f32 v41, s27, v41
  v_mul_f32 v42, v42, v32
  v_mul_f32 v43, v43, v32
  v_add_f32 v42, v42, v42
  v_add_f32 v43, v43, v43
  ds_write_b128 v37, v[40:43] offset:18240
  v_and_b32 v40, 0xffff0000, v24
  v_and_b32 v41, 0xffff0000, v26
  v_and_b32 v42, 0xffff0000, v28
  v_and_b32 v43, 0xffff0000, v30
  v_mul_f32 v40, s26, v40
  v_exp_f32 v40, v40
  s_nop 0
  v_cvt_pk_bf16_f32 v34, v40, v40
  v_and_b32 v40, 0xffff0000, v34
  v_mul_f32 v40, v40, v32
  v_mul_f32 v40, s26, v40
  v_sub_f32 v40, 0, v40
  v_mul_f32 v41, v41, v32
  v_mul_f32 v41, s27, v41
  v_mul_f32 v42, v42, v32
  v_mul_f32 v43, v43, v32
  v_add_f32 v42, v42, v42
  v_add_f32 v43, v43, v43
  ds_write_b128 v37, v[40:43] offset:18256
  v_lshlrev_b32 v40, 16, v25
  v_lshlrev_b32 v41, 16, v27
  v_lshlrev_b32 v42, 16, v29
  v_lshlrev_b32 v43, 16, v31
  v_mul_f32 v40, s26, v40
  v_exp_f32 v40, v40
  s_nop 0
  v_cvt_pk_bf16_f32 v34, v40, v40
  v_and_b32 v40, 0xffff0000, v34
  v_mul_f32 v40, v40, v32
  v_mul_f32 v40, s26, v40
  v_sub_f32 v40, 0, v40
  v_mul_f32 v41, v41, v32
  v_mul_f32 v41, s27, v41
  v_mul_f32 v42, v42, v32
  v_mul_f32 v43, v43, v32
  v_add_f32 v42, v42, v42
  v_add_f32 v43, v43, v43
  ds_write_b128 v37, v[40:43] offset:18272
  v_and_b32 v40, 0xffff0000, v25
  v_and_b32 v41, 0xffff0000, v27
  v_and_b32 v42, 0xffff0000, v29
  v_and_b32 v43, 0xffff0000, v31
  v_mul_f32 v40, s26, v40
  v_exp_f32 v40, v40
  s_nop 0
  v_cvt_pk_bf16_f32 v34, v40, v40
  v_and_b32 v40, 0xffff0000, v34
  v_mul_f32 v40, v40, v32
  v_mul_f32 v40, s26, v40
  v_sub_f32 v40, 0, v40
  v_mul_f32 v41, v41, v32
  v_mul_f32 v41, s27, v41
  v_mul_f32 v42, v42, v32
  v_mul_f32 v43, v43, v32
  v_add_f32 v42, v42, v42
  v_add_f32 v43, v43, v43
  ds_write_b128 v37, v[40:43] offset:18288
  v_cvt_f32_u32 v44, v4
  v_lshlrev_b32 v45, 4, v4
  v_cvt_f32_u32 v45, v45
  v_lshlrev_b32 v46, 4, v3
  v_add_u32 v46, s17, v46
  v_mov_b32 v48, 0
  v_mov_b32 v49, 0
  v_mov_b32 v50, 0
  v_mov_b32 v51, 0
  v_mov_b32 v52, 0
  v_mov_b32 v53, 0
  v_mov_b32 v54, 0
  v_mov_b32 v55, 0
  v_mov_b32 v56, 0
  v_mov_b32 v57, 0
  v_mov_b32 v58, 0
  v_mov_b32 v59, 0
  v_mov_b32 v60, 0
  v_mov_b32 v61, 0
  v_mov_b32 v62, 0
  v_mov_b32 v63, 0
  v_mov_b32 v64, 0
  v_mov_b32 v65, 0
  v_mov_b32 v66, 0
  v_mov_b32 v67, 0
  s_waitcnt lgkmcnt(0)
  ds_read_b128 v[68:71], v46 offset:18240
  s_add_u32 s22, s21, 0
  buffer_load_dwordx2 v[8:9], v5, s[60:63], s22 offen offset:0
  s_mov_b32 s28, 0
  s_call_b64 s[30:31], wk_kl
  s_mov_b32 s28, 0
  s_call_b64 s[30:31], wk_kl
  s_add_u32 s22, s21, 0
  buffer_load_dwordx2 v[10:11], v5, s[60:63], s22 offen offset:896
  s_mov_b32 s28, 0
  s_call_b64 s[30:31], wk_kl
  s_mov_b32 s28, 0
  s_call_b64 s[30:31], wk_kl
  s_add_u32 s22, s21, 0
  buffer_load_dwordx2 v[12:13], v5, s[60:63], s22 offen offset:1792
  s_mov_b32 s28, 0
  s_call_b64 s[30:31], wk_kl
  s_mov_b32 s28, 0
  s_call_b64 s[30:31], wk_kl
  s_add_u32 s22, s21, 0
  buffer_load_dwordx2 v[14:15], v5, s[60:63], s22 offen offset:2688
  s_mov_b32 s28, 0
  s_call_b64 s[30:31], wk_kl
  s_mov_b32 s28, 0
  s_call_b64 s[30:31], wk_kl
  s_add_u32 s22, s21, 917504
  buffer_load_dwordx2 v[16:17], v5, s[60:63], s22 offen offset:0
  s_mov_b32 s28, 0
  s_call_b64 s[30:31], wk_kl
  s_mov_b32 s28, 0
  s_call_b64 s[30:31], wk_kl
  s_add_u32 s22, s21, 917504
  buffer_load_dwordx2 v[18:19], v5, s[60:63], s22 offen offset:896
  s_mov_b32 s28, 0
  s_call_b64 s[30:31], wk_kl
  s_mov_b32 s28, 0
  s_call_b64 s[30:31], wk_kl
  s_add_u32 s22, s21, 917504
  buffer_load_dwordx2 v[20:21], v5, s[60:63], s22 offen offset:1792
  s_mov_b32 s28, 0
  s_call_b64 s[30:31], wk_kl
  s_mov_b32 s28, 0
  s_call_b64 s[30:31], wk_kl
  s_add_u32 s22, s21, 917504
  buffer_load_dwordx2 v[22:23], v5, s[60:63], s22 offen offset:2688
  s_mov_b32 s28, 0
  s_call_b64 s[30:31], wk_kl
  s_mov_b32 s28, 0
  s_call_b64 s[30:31], wk_kl
  s_branch wk_kd
wk_kl:
  s_waitcnt lgkmcnt(0)
  v_mov_b32 v72, v68
  v_mov_b32 v73, v69
  v_mov_b32 v74, v70
  v_mov_b32 v75, v71
  v_add_u32 v46, 64, v46
  ds_read_b128 v[68:71], v46 offset:18240
  v_mul_f32 v80, v72, v45
  v_mul_f32 v81, v73, v45
  v_exp_f32 v80, v80
  v_fract_f32 v81, v81
  v_cos_f32 v76, v81
  v_sin_f32 v77, v81
  v_mul_f32 v76, v76, v80
  v_mul_f32 v77, v77, v80
  v_mul_f32 v80, v72, v44
  v_mul_f32 v81, v73, v44
  v_exp_f32 v80, v80
  v_fract_f32 v81, v81
  v_cos_f32 v78, v81
  v_sin_f32 v79, v81
  v_mul_f32 v78, v78, v80
  v_mul_f32 v79, v79, v80
  v_mul_f32 v82, v74, v76
  v_mul_f32 v83, v74, v77
  v_fma_f32 v82, -v75, v77, v82
  v_fma_f32 v83, -v75, v76, -v83
  v_mul_f32 v86, v76, v76
  v_mul_f32 v87, v76, v77
  v_fma_f32 v86, -v77, v77, v86
  v_add_f32 v87, v87, v87
  v_mfma_f32_16x16x4_f32 v[48:51], v82, v78, v[48:51]
  v_mul_f32 v88, v78, v78
  v_mul_f32 v89, v78, v79
  v_fma_f32 v88, -v79, v79, v88
  v_add_f32 v89, v89, v89
  v_mfma_f32_16x16x4_f32 v[48:51], v83, v79, v[48:51]
  v_mul_f32 v84, v74, v86
  v_mul_f32 v85, v74, v87
  v_fma_f32 v84, -v75, v87, v84
  v_fma_f32 v85, -v75, v86, -v85
  v_mul_f32 v76, v86, v86
  v_mul_f32 v77, v86, v87
  v_fma_f32 v76, -v87, v87, v76
  v_add_f32 v77, v77, v77
  v_mfma_f32_16x16x4_f32 v[52:55], v84, v88, v[52:55]
  v_mul_f32 v78, v88, v88
  v_mul_f32 v79, v88, v89
  v_fma_f32 v78, -v89, v89, v78
  v_add_f32 v79, v79, v79
  v_mfma_f32_16x16x4_f32 v[52:55], v85, v89, v[52:55]
  v_mul_f32 v82, v74, v76
  v_mul_f32 v83, v74, v77
  v_fma_f32 v82, -v75, v77, v82
  v_fma_f32 v83, -v75, v76, -v83
  v_mul_f32 v86, v76, v76
  v_mul_f32 v87, v76, v77
  v_fma_f32 v86, -v77, v77, v86
  v_add_f32 v87, v87, v87
  v_mfma_f32_16x16x4_f32 v[56:59], v82, v78, v[56:59]
  v_mul_f32 v88, v78, v78
  v_mul_f32 v89, v78, v79
  v_fma_f32 v88, -v79, v79, v88
  v_add_f32 v89, v89, v89
  v_mfma_f32_16x16x4_f32 v[56:59], v83, v79, v[56:59]
  v_mul_f32 v84, v74, v86
  v_mul_f32 v85, v74, v87
  v_fma_f32 v84, -v75, v87, v84
  v_fma_f32 v85, -v75, v86, -v85
  v_mul_f32 v76, v86, v86
  v_mul_f32 v77, v86, v87
  v_fma_f32 v76, -v87, v87, v76
  v_add_f32 v77, v77, v77
  v_mfma_f32_16x16x4_f32 v[60:63], v84, v88, v[60:63]
  v_mfma_f32_16x16x4_f32 v[60:63], v85, v89, v[60:63]
  v_mul_f32 v82, v74, v76
  v_fma_f32 v82, -v75, v77, v82
  s_nop 1
  v_mfma_f32_16x16x4_f32 v[64:67], v82, v88, v[64:67]
  s_add_u32 s28, s28, 1
  s_cmp_lt_u32 s28, 4
  s_cbranch_scc1 wk_kl
  s_setpc_b64 s[30:31]
wk_kd:
  s_nop 15
  s_nop 3
  s_waitcnt vmcnt(0)
  v_lshlrev_b32 v6, 3, v0
  v_perm_b32 v34, v10, v8, s24
  v_perm_b32 v35, v14, v12, s24
  v_add_u32 v36, 512, v6
  ds_write_b64 v36, v[34:35]
  v_perm_b32 v34, v10, v8, s25
  v_perm_b32 v35, v14, v12, s25
  v_add_u32 v36, 25088, v6
  ds_write_b64 v36, v[34:35]
  v_perm_b32 v34, v11, v9, s24
  v_perm_b32 v35, v15, v13, s24
  v_add_u32 v36, 49664, v6
  ds_write_b64 v36, v[34:35]
  v_perm_b32 v34, v11, v9, s25
  v_perm_b32 v35, v15, v13, s25
  v_add_u32 v36, 74240, v6
  ds_write_b64 v36, v[34:35]
  v_perm_b32 v34, v18, v16, s24
  v_perm_b32 v35, v22, v20, s24
  v_add_u32 v36, 2560, v6
  ds_write_b64 v36, v[34:35]
  v_perm_b32 v34, v18, v16, s25
  v_perm_b32 v35, v22, v20, s25
  v_add_u32 v36, 27136, v6
  ds_write_b64 v36, v[34:35]
  v_perm_b32 v34, v19, v17, s24
  v_perm_b32 v35, v23, v21, s24
  v_add_u32 v36, 51712, v6
  ds_write_b64 v36, v[34:35]
  v_perm_b32 v34, v19, v17, s25
  v_perm_b32 v35, v23, v21, s25
  v_add_u32 v36, 76288, v6
  ds_write_b64 v36, v[34:35]
  v_lshlrev_b32 v46, 8, v3
  v_lshl_add_u32 v46, v4, 2, v46
  v_add_u32 v46, s17, v46
  ds_write_b32 v46, v48 offset:13056
  ds_write_b32 v46, v49 offset:13120
  ds_write_b32 v46, v50 offset:13184
  ds_write_b32 v46, v51 offset:13248
  s_waitcnt lgkmcnt(8)
  ds_write_b32 v46, v52 offset:14080
  ds_write_b32 v46, v53 offset:14144
  ds_write_b32 v46, v54 offset:14208
  ds_write_b32 v46, v55 offset:14272
  s_waitcnt lgkmcnt(8)
  ds_write_b32 v46, v56 offset:15104
  ds_write_b32 v46, v57 offset:15168
  ds_write_b32 v46, v58 offset:15232
  ds_write_b32 v46, v59 offset:15296
  s_waitcnt lgkmcnt(8)
  ds_write_b32 v46, v60 offset:16128
  ds_write_b32 v46, v61 offset:16192
  ds_write_b32 v46, v62 offset:16256
  ds_write_b32 v46, v63 offset:16320
  s_waitcnt lgkmcnt(8)
  ds_write_b32 v46, v64 offset:17152
  ds_write_b32 v46, v65 offset:17216
  ds_write_b32 v46, v66 offset:17280
  ds_write_b32 v46, v67 offset:17344
  s_waitcnt lgkmcnt(8)
  s_waitcnt lgkmcnt(0)
  ds_read_b32 v48, v200
  ds_read_b32 v49, v201
  ds_read_b32 v50, v202
  ds_read_b32 v51, v203
  ds_read_b32 v52, v204
  ds_read_b32 v53, v205
  ds_read_b32 v54, v206
  ds_read_b32 v55, v207
  s_waitcnt lgkmcnt(4)
  ds_read_b32 v56, v208
  ds_read_b32 v57, v209
  ds_read_b32 v58, v210
  ds_read_b32 v59, v211
  ds_read_b32 v60, v212
  ds_read_b32 v61, v213
  ds_read_b32 v62, v214
  ds_read_b32 v63, v215
  s_waitcnt lgkmcnt(4)
  ds_read_b32 v64, v216
  ds_read_b32 v65, v217
  ds_read_b32 v66, v218
  ds_read_b32 v67, v219
  ds_read_b32 v68, v220
  ds_read_b32 v69, v221
  ds_read_b32 v70, v222
  ds_read_b32 v71, v223
  s_waitcnt lgkmcnt(4)
  ds_read_b32 v72, v224
  ds_read_b32 v73, v225
  ds_read_b32 v74, v226
  ds_read_b32 v75, v227
  ds_read_b32 v76, v228
  ds_read_b32 v77, v229
  ds_read_b32 v78, v230
  ds_read_b32 v79, v231
  s_waitcnt lgkmcnt(4)
  ds_read_b32 v80, v232
  s_waitcnt lgkmcnt(0)
  v_lshlrev_b32 v46, 6, v1
  v_add_u32 v46, s17, v46
  v_cvt_pk_bf16_f32 v84, v48, v49
  v_cvt_pk_bf16_f32 v88, v49, v50
  v_cvt_pk_bf16_f32 v85, v50, v51
  v_cvt_pk_bf16_f32 v89, v51, v52
  v_cvt_pk_bf16_f32 v86, v52, v53
  v_cvt_pk_bf16_f32 v90, v53, v54
  v_cvt_pk_bf16_f32 v87, v54, v55
  v_cvt_pk_bf16_f32 v91, v55, v56
  ds_write_b128 v46, v[84:87] offset:4608
  ds_write_b128 v46, v[88:91] offset:8832
  s_waitcnt lgkmcnt(0)
  v_cvt_pk_bf16_f32 v84, v56, v57
  v_cvt_pk_bf16_f32 v88, v57, v58
  v_cvt_pk_bf16_f32 v85, v58, v59
  v_cvt_pk_bf16_f32 v89, v59, v60
  v_cvt_pk_bf16_f32 v86, v60, v61
  v_cvt_pk_bf16_f32 v90, v61, v62
  v_cvt_pk_bf16_f32 v87, v62, v63
  v_cvt_pk_bf16_f32 v91, v63, v64
  ds_write_b128 v46, v[84:87] offset:4624
  ds_write_b128 v46, v[88:91] offset:8848
  s_waitcnt lgkmcnt(0)
  v_cvt_pk_bf16_f32 v84, v64, v65
  v_cvt_pk_bf16_f32 v88, v65, v66
  v_cvt_pk_bf16_f32 v85, v66, v67
  v_cvt_pk_bf16_f32 v89, v67, v68
  v_cvt_pk_bf16_f32 v86, v68, v69
  v_cvt_pk_bf16_f32 v90, v69, v70
  v_cvt_pk_bf16_f32 v87, v70, v71
  v_cvt_pk_bf16_f32 v91, v71, v72
  ds_write_b128 v46, v[84:87] offset:4640
  ds_write_b128 v46, v[88:91] offset:8864
  s_waitcnt lgkmcnt(0)
  v_cvt_pk_bf16_f32 v84, v72, v73
  v_cvt_pk_bf16_f32 v88, v73, v74
  v_cvt_pk_bf16_f32 v85, v74, v75
  v_cvt_pk_bf16_f32 v89, v75, v76
  v_cvt_pk_bf16_f32 v86, v76, v77
  v_cvt_pk_bf16_f32 v90, v77, v78
  v_cvt_pk_bf16_f32 v87, v78, v79
  v_cvt_pk_bf16_f32 v91, v79, v80
  ds_write_b128 v46, v[84:87] offset:4656
  ds_write_b128 v46, v[88:91] offset:8880
  s_waitcnt lgkmcnt(0)
  s_barrier
  v_lshrrev_b32 v47, 1, v3
  v_sub_u32 v46, v4, v47
  v_add_u32 v46, 1, v46
  v_lshlrev_b32 v46, 5, v46
  v_and_b32 v48, 1, v3
  v_lshl_add_u32 v46, v48, 4, v46
  v_add_u32 v46, s17, v46
  ds_read_b128 a[0:3], v46 offset:32
  ds_read_b128 a[4:7], v46 offset:96
  ds_read_b128 a[8:11], v46 offset:160
  ds_read_b128 a[12:15], v46 offset:224
  ds_read_b128 a[16:19], v46 offset:288
  ds_read_b128 a[20:23], v46 offset:352
  ds_read_b128 a[24:27], v46 offset:416
  ds_read_b128 a[28:31], v46 offset:480
  s_waitcnt lgkmcnt(4)
  ds_read_b128 a[32:35], v46 offset:544
  ds_read_b128 a[36:39], v46 offset:608
  ds_read_b128 a[40:43], v46 offset:672
  ds_read_b128 a[44:47], v46 offset:736
  ds_read_b128 a[48:51], v46 offset:800
  ds_read_b128 a[52:55], v46 offset:864
  ds_read_b128 a[56:59], v46 offset:928
  ds_read_b128 a[60:63], v46 offset:992
  s_waitcnt lgkmcnt(4)
  ds_read_b128 a[64:67], v46 offset:1056
  ds_read_b128 a[68:71], v46 offset:1120
  ds_read_b128 a[72:75], v46 offset:1184
  ds_read_b128 a[76:79], v46 offset:1248
  ds_read_b128 a[80:83], v46 offset:1312
  ds_read_b128 a[84:87], v46 offset:1376
  ds_read_b128 a[88:91], v46 offset:1440
  ds_read_b128 a[92:95], v46 offset:1504
  s_waitcnt lgkmcnt(4)
  ds_read_b128 a[96:99], v46 offset:1568
  ds_read_b128 a[100:103], v46 offset:1632
  ds_read_b128 a[104:107], v46 offset:1696
  ds_read_b128 a[108:111], v46 offset:1760
  ds_read_b128 a[112:115], v46 offset:1824
  ds_read_b128 a[116:119], v46 offset:1888
  ds_read_b128 a[120:123], v46 offset:1952
  ds_read_b128 a[124:127], v46 offset:2016
  s_waitcnt lgkmcnt(4)
  ds_read_b128 a[128:131], v46 offset:2080
  ds_read_b128 a[132:135], v46 offset:2144
  ds_read_b128 a[136:139], v46 offset:2208
  ds_read_b128 a[140:143], v46 offset:2272
  ds_read_b128 a[144:147], v46 offset:2336
  ds_read_b128 a[148:151], v46 offset:2400
  ds_read_b128 a[152:155], v46 offset:2464
  ds_read_b128 a[156:159], v46 offset:2528
  s_waitcnt lgkmcnt(4)
  ds_read_b128 a[160:163], v46 offset:2592
  ds_read_b128 a[164:167], v46 offset:2656
  ds_read_b128 a[168:171], v46 offset:2720
  ds_read_b128 a[172:175], v46 offset:2784
  ds_read_b128 a[176:179], v46 offset:2848
  ds_read_b128 a[180:183], v46 offset:2912
  ds_read_b128 a[184:187], v46 offset:2976
  ds_read_b128 a[188:191], v46 offset:3040
  s_waitcnt lgkmcnt(4)
  ds_read_b128 a[192:195], v46 offset:3104
  ds_read_b128 a[196:199], v46 offset:3168
  ds_read_b128 a[200:203], v46 offset:3232
  ds_read_b128 a[204:207], v46 offset:3296
  ds_read_b128 a[208:211], v46 offset:3360
  ds_read_b128 a[212:215], v46 offset:3424
  ds_read_b128 a[216:219], v46 offset:3488
  ds_read_b128 a[220:223], v46 offset:3552
  s_waitcnt lgkmcnt(4)
  ds_read_b128 a[224:227], v46 offset:3616
  ds_read_b128 a[228:231], v46 offset:3680
  ds_read_b128 a[232:235], v46 offset:3744
  ds_read_b128 a[236:239], v46 offset:3808
  ds_read_b128 a[240:243], v46 offset:3872
  ds_read_b128 a[244:247], v46 offset:3936
  ds_read_b128 a[248:251], v46 offset:4000
  ds_read_b128 a[252:255], v46 offset:4064
  s_waitcnt lgkmcnt(4)
  v_lshlrev_b32 v49, 4, v47
  v_add_u32 v49, v49, v4
  v_sub_u32 v49, 2047, v49
  v_lshl_add_u32 v49, v48, 3, v49
  v_and_b32 v50, 1, v49
  v_lshrrev_b32 v49, 1, v49
  v_lshlrev_b32 v49, 2, v49
  v_mul_u32_u24 v50, 4224, v50
  v_add3_u32 v49, v49, v50, s17
  v_add_u32 v49, 4608, v49
  v_subrev_u32 v52, 896, v49
  v_subrev_u32 v53, 1856, v49
  v_subrev_u32 v54, 2816, v49
  v_subrev_u32 v55, 3776, v49
  v_subrev_u32 v56, 4736, v49
  s_waitcnt lgkmcnt(0)
  ds_read2_b32 v[92:93], v52 offset0:224 offset1:225
  ds_read2_b32 v[94:95], v52 offset0:226 offset1:227
  ds_read2_b32 v[96:97], v52 offset0:208 offset1:209
  ds_read2_b32 v[98:99], v52 offset0:210 offset1:211
  ds_read2_b32 v[100:101], v52 offset0:192 offset1:193
  ds_read2_b32 v[102:103], v52 offset0:194 offset1:195
  ds_read2_b32 v[104:105], v52 offset0:176 offset1:177
  ds_read2_b32 v[106:107], v52 offset0:178 offset1:179
  s_waitcnt lgkmcnt(6)
  v_mfma_f32_16x16x32_bf16 v[60:63], v[92:95], a[28:31], 0
  v_mfma_f32_16x16x32_bf16 v[64:67], v[92:95], a[60:63], 0
  v_mfma_f32_16x16x32_bf16 v[68:71], v[92:95], a[92:95], 0
  v_mfma_f32_16x16x32_bf16 v[72:75], v[92:95], a[124:127], 0
  v_mfma_f32_16x16x32_bf16 v[76:79], v[92:95], a[156:159], 0
  v_mfma_f32_16x16x32_bf16 v[80:83], v[92:95], a[188:191], 0
  v_mfma_f32_16x16x32_bf16 v[84:87], v[92:95], a[220:223], 0
  v_mfma_f32_16x16x32_bf16 v[88:91], v[92:95], a[252:255], 0
  ds_read2_b32 v[92:93], v52 offset0:160 offset1:161
  ds_read2_b32 v[94:95], v52 offset0:162 offset1:163
  s_waitcnt lgkmcnt(6)
  v_mfma_f32_16x16x32_bf16 v[60:63], v[96:99], a[24:27], v[60:63]
  v_mfma_f32_16x16x32_bf16 v[64:67], v[96:99], a[56:59], v[64:67]
  v_mfma_f32_16x16x32_bf16 v[68:71], v[96:99], a[88:91], v[68:71]
  v_mfma_f32_16x16x32_bf16 v[72:75], v[96:99], a[120:123], v[72:75]
  v_mfma_f32_16x16x32_bf16 v[76:79], v[96:99], a[152:155], v[76:79]
  v_mfma_f32_16x16x32_bf16 v[80:83], v[96:99], a[184:187], v[80:83]
  v_mfma_f32_16x16x32_bf16 v[84:87], v[96:99], a[216:219], v[84:87]
  v_mfma_f32_16x16x32_bf16 v[88:91], v[96:99], a[248:251], v[88:91]
  ds_read2_b32 v[96:97], v52 offset0:144 offset1:145
  ds_read2_b32 v[98:99], v52 offset0:146 offset1:147
  s_waitcnt lgkmcnt(6)
  v_mfma_f32_16x16x32_bf16 v[60:63], v[100:103], a[20:23], v[60:63]
  v_mfma_f32_16x16x32_bf16 v[64:67], v[100:103], a[52:55], v[64:67]
  v_mfma_f32_16x16x32_bf16 v[68:71], v[100:103], a[84:87], v[68:71]
  v_mfma_f32_16x16x32_bf16 v[72:75], v[100:103], a[116:119], v[72:75]
  v_mfma_f32_16x16x32_bf16 v[76:79], v[100:103], a[148:151], v[76:79]
  v_mfma_f32_16x16x32_bf16 v[80:83], v[100:103], a[180:183], v[80:83]
  v_mfma_f32_16x16x32_bf16 v[84:87], v[100:103], a[212:215], v[84:87]
  v_mfma_f32_16x16x32_bf16 v[88:91], v[100:103], a[244:247], v[88:91]
  ds_read2_b32 v[100:101], v52 offset0:128 offset1:129
  ds_read2_b32 v[102:103], v52 offset0:130 offset1:131
  s_waitcnt lgkmcnt(6)
  v_mfma_f32_16x16x32_bf16 v[60:63], v[104:107], a[16:19], v[60:63]
  v_mfma_f32_16x16x32_bf16 v[64:67], v[104:107], a[48:51], v[64:67]
  v_mfma_f32_16x16x32_bf16 v[68:71], v[104:107], a[80:83], v[68:71]
  v_mfma_f32_16x16x32_bf16 v[72:75], v[104:107], a[112:115], v[72:75]
  v_mfma_f32_16x16x32_bf16 v[76:79], v[104:107], a[144:147], v[76:79]
  v_mfma_f32_16x16x32_bf16 v[80:83], v[104:107], a[176:179], v[80:83]
  v_mfma_f32_16x16x32_bf16 v[84:87], v[104:107], a[208:211], v[84:87]
  v_mfma_f32_16x16x32_bf16 v[88:91], v[104:107], a[240:243], v[88:91]
  ds_read2_b32 v[104:105], v52 offset0:112 offset1:113
  ds_read2_b32 v[106:107], v52 offset0:114 offset1:115
  s_waitcnt lgkmcnt(6)
  v_mfma_f32_16x16x32_bf16 v[60:63], v[92:95], a[12:15], v[60:63]
  v_mfma_f32_16x16x32_bf16 v[64:67], v[92:95], a[44:47], v[64:67]
  v_mfma_f32_16x16x32_bf16 v[68:71], v[92:95], a[76:79], v[68:71]
  v_mfma_f32_16x16x32_bf16 v[72:75], v[92:95], a[108:111], v[72:75]
  v_mfma_f32_16x16x32_bf16 v[76:79], v[92:95], a[140:143], v[76:79]
  v_mfma_f32_16x16x32_bf16 v[80:83], v[92:95], a[172:175], v[80:83]
  v_mfma_f32_16x16x32_bf16 v[84:87], v[92:95], a[204:207], v[84:87]
  v_mfma_f32_16x16x32_bf16 v[88:91], v[92:95], a[236:239], v[88:91]
  ds_read2_b32 v[92:93], v52 offset0:96 offset1:97
  ds_read2_b32 v[94:95], v52 offset0:98 offset1:99
  s_waitcnt lgkmcnt(6)
  v_mfma_f32_16x16x32_bf16 v[60:63], v[96:99], a[8:11], v[60:63]
  v_mfma_f32_16x16x32_bf16 v[64:67], v[96:99], a[40:43], v[64:67]
  v_mfma_f32_16x16x32_bf16 v[68:71], v[96:99], a[72:75], v[68:71]
  v_mfma_f32_16x16x32_bf16 v[72:75], v[96:99], a[104:107], v[72:75]
  v_mfma_f32_16x16x32_bf16 v[76:79], v[96:99], a[136:139], v[76:79]
  v_mfma_f32_16x16x32_bf16 v[80:83], v[96:99], a[168:171], v[80:83]
  v_mfma_f32_16x16x32_bf16 v[84:87], v[96:99], a[200:203], v[84:87]
  v_mfma_f32_16x16x32_bf16 v[88:91], v[96:99], a[232:235], v[88:91]
  ds_read2_b32 v[96:97], v52 offset0:80 offset1:81
  ds_read2_b32 v[98:99], v52 offset0:82 offset1:83
  s_waitcnt lgkmcnt(6)
  v_mfma_f32_16x16x32_bf16 v[60:63], v[100:103], a[4:7], v[60:63]
  v_mfma_f32_16x16x32_bf16 v[64:67], v[100:103], a[36:39], v[64:67]
  v_mfma_f32_16x16x32_bf16 v[68:71], v[100:103], a[68:71], v[68:71]
  v_mfma_f32_16x16x32_bf16 v[72:75], v[100:103], a[100:103], v[72:75]
  v_mfma_f32_16x16x32_bf16 v[76:79], v[100:103], a[132:135], v[76:79]
  v_mfma_f32_16x16x32_bf16 v[80:83], v[100:103], a[164:167], v[80:83]
  v_mfma_f32_16x16x32_bf16 v[84:87], v[100:103], a[196:199], v[84:87]
  v_mfma_f32_16x16x32_bf16 v[88:91], v[100:103], a[228:231], v[88:91]
  ds_read2_b32 v[100:101], v52 offset0:64 offset1:65
  ds_read2_b32 v[102:103], v52 offset0:66 offset1:67
  s_waitcnt lgkmcnt(6)
  v_mfma_f32_16x16x32_bf16 v[60:63], v[104:107], a[0:3], v[60:63]
  v_mfma_f32_16x16x32_bf16 v[64:67], v[104:107], a[32:35], v[64:67]
  v_mfma_f32_16x16x32_bf16 v[68:71], v[104:107], a[64:67], v[68:71]
  v_mfma_f32_16x16x32_bf16 v[72:75], v[104:107], a[96:99], v[72:75]
  v_mfma_f32_16x16x32_bf16 v[76:79], v[104:107], a[128:131], v[76:79]
  v_mfma_f32_16x16x32_bf16 v[80:83], v[104:107], a[160:163], v[80:83]
  v_mfma_f32_16x16x32_bf16 v[84:87], v[104:107], a[192:195], v[84:87]
  v_mfma_f32_16x16x32_bf16 v[88:91], v[104:107], a[224:227], v[88:91]
  ds_read2_b32 v[104:105], v52 offset0:48 offset1:49
  ds_read2_b32 v[106:107], v52 offset0:50 offset1:51
  s_waitcnt lgkmcnt(6)
  v_mfma_f32_16x16x32_bf16 v[64:67], v[92:95], a[28:31], v[64:67]
  v_mfma_f32_16x16x32_bf16 v[68:71], v[92:95], a[60:63], v[68:71]
  v_mfma_f32_16x16x32_bf16 v[72:75], v[92:95], a[92:95], v[72:75]
  v_mfma_f32_16x16x32_bf16 v[76:79], v[92:95], a[124:127], v[76:79]
  v_mfma_f32_16x16x32_bf16 v[80:83], v[92:95], a[156:159], v[80:83]
  v_mfma_f32_16x16x32_bf16 v[84:87], v[92:95], a[188:191], v[84:87]
  v_mfma_f32_16x16x32_bf16 v[88:91], v[92:95], a[220:223], v[88:91]
  ds_read2_b32 v[92:93], v52 offset0:32 offset1:33
  ds_read2_b32 v[94:95], v52 offset0:34 offset1:35
  s_waitcnt lgkmcnt(6)
  v_mfma_f32_16x16x32_bf16 v[64:67], v[96:99], a[24:27], v[64:67]
  v_mfma_f32_16x16x32_bf16 v[68:71], v[96:99], a[56:59], v[68:71]
  v_mfma_f32_16x16x32_bf16 v[72:75], v[96:99], a[88:91], v[72:75]
  v_mfma_f32_16x16x32_bf16 v[76:79], v[96:99], a[120:123], v[76:79]
  v_mfma_f32_16x16x32_bf16 v[80:83], v[96:99], a[152:155], v[80:83]
  v_mfma_f32_16x16x32_bf16 v[84:87], v[96:99], a[184:187], v[84:87]
  v_mfma_f32_16x16x32_bf16 v[88:91], v[96:99], a[216:219], v[88:91]
  ds_read2_b32 v[96:97], v52 offset0:16 offset1:17
  ds_read2_b32 v[98:99], v52 offset0:18 offset1:19
  s_waitcnt lgkmcnt(6)
  v_mfma_f32_16x16x32_bf16 v[64:67], v[100:103], a[20:23], v[64:67]
  v_mfma_f32_16x16x32_bf16 v[68:71], v[100:103], a[52:55], v[68:71]
  v_mfma_f32_16x16x32_bf16 v[72:75], v[100:103], a[84:87], v[72:75]
  v_mfma_f32_16x16x32_bf16 v[76:79], v[100:103], a[116:119], v[76:79]
  v_mfma_f32_16x16x32_bf16 v[80:83], v[100:103], a[148:151], v[80:83]
  v_mfma_f32_16x16x32_bf16 v[84:87], v[100:103], a[180:183], v[84:87]
  v_mfma_f32_16x16x32_bf16 v[88:91], v[100:103], a[212:215], v[88:91]
  ds_read2_b32 v[100:101], v52 offset0:0 offset1:1
  ds_read2_b32 v[102:103], v52 offset0:2 offset1:3
  s_waitcnt lgkmcnt(6)
  v_mfma_f32_16x16x32_bf16 v[64:67], v[104:107], a[16:19], v[64:67]
  v_mfma_f32_16x16x32_bf16 v[68:71], v[104:107], a[48:51], v[68:71]
  v_mfma_f32_16x16x32_bf16 v[72:75], v[104:107], a[80:83], v[72:75]
  v_mfma_f32_16x16x32_bf16 v[76:79], v[104:107], a[112:115], v[76:79]
  v_mfma_f32_16x16x32_bf16 v[80:83], v[104:107], a[144:147], v[80:83]
  v_mfma_f32_16x16x32_bf16 v[84:87], v[104:107], a[176:179], v[84:87]
  v_mfma_f32_16x16x32_bf16 v[88:91], v[104:107], a[208:211], v[88:91]
  ds_read2_b32 v[104:105], v53 offset0:224 offset1:225
  ds_read2_b32 v[106:107], v53 offset0:226 offset1:227
  s_waitcnt lgkmcnt(6)
  v_mfma_f32_16x16x32_bf16 v[64:67], v[92:95], a[12:15], v[64:67]
  v_mfma_f32_16x16x32_bf16 v[68:71], v[92:95], a[44:47], v[68:71]
  v_mfma_f32_16x16x32_bf16 v[72:75], v[92:95], a[76:79], v[72:75]
  v_mfma_f32_16x16x32_bf16 v[76:79], v[92:95], a[108:111], v[76:79]
  v_mfma_f32_16x16x32_bf16 v[80:83], v[92:95], a[140:143], v[80:83]
  v_mfma_f32_16x16x32_bf16 v[84:87], v[92:95], a[172:175], v[84:87]
  v_mfma_f32_16x16x32_bf16 v[88:91], v[92:95], a[204:207], v[88:91]
  ds_read2_b32 v[92:93], v53 offset0:208 offset1:209
  ds_read2_b32 v[94:95], v53 offset0:210 offset1:211
  s_waitcnt lgkmcnt(6)
  v_mfma_f32_16x16x32_bf16 v[64:67], v[96:99], a[8:11], v[64:67]
  v_mfma_f32_16x16x32_bf16 v[68:71], v[96:99], a[40:43], v[68:71]
  v_mfma_f32_16x16x32_bf16 v[72:75], v[96:99], a[72:75], v[72:75]
  v_mfma_f32_16x16x32_bf16 v[76:79], v[96:99], a[104:107], v[76:79]
  v_mfma_f32_16x16x32_bf16 v[80:83], v[96:99], a[136:139], v[80:83]
  v_mfma_f32_16x16x32_bf16 v[84:87], v[96:99], a[168:171], v[84:87]
  v_mfma_f32_16x16x32_bf16 v[88:91], v[96:99], a[200:203], v[88:91]
  ds_read2_b32 v[96:97], v53 offset0:192 offset1:193
  ds_read2_b32 v[98:99], v53 offset0:194 offset1:195
  s_waitcnt lgkmcnt(6)
  v_mfma_f32_16x16x32_bf16 v[64:67], v[100:103], a[4:7], v[64:67]
  v_mfma_f32_16x16x32_bf16 v[68:71], v[100:103], a[36:39], v[68:71]
  v_mfma_f32_16x16x32_bf16 v[72:75], v[100:103], a[68:71], v[72:75]
  v_mfma_f32_16x16x32_bf16 v[76:79], v[100:103], a[100:103], v[76:79]
  v_mfma_f32_16x16x32_bf16 v[80:83], v[100:103], a[132:135], v[80:83]
  v_mfma_f32_16x16x32_bf16 v[84:87], v[100:103], a[164:167], v[84:87]
  v_mfma_f32_16x16x32_bf16 v[88:91], v[100:103], a[196:199], v[88:91]
  ds_read2_b32 v[100:101], v53 offset0:176 offset1:177
  ds_read2_b32 v[102:103], v53 offset0:178 offset1:179
  s_waitcnt lgkmcnt(6)
  v_mfma_f32_16x16x32_bf16 v[64:67], v[104:107], a[0:3], v[64:67]
  v_mfma_f32_16x16x32_bf16 v[68:71], v[104:107], a[32:35], v[68:71]
  v_mfma_f32_16x16x32_bf16 v[72:75], v[104:107], a[64:67], v[72:75]
  v_mfma_f32_16x16x32_bf16 v[76:79], v[104:107], a[96:99], v[76:79]
  v_mfma_f32_16x16x32_bf16 v[80:83], v[104:107], a[128:131], v[80:83]
  v_mfma_f32_16x16x32_bf16 v[84:87], v[104:107], a[160:163], v[84:87]
  v_mfma_f32_16x16x32_bf16 v[88:91], v[104:107], a[192:195], v[88:91]
  ds_read2_b32 v[104:105], v53 offset0:160 offset1:161
  ds_read2_b32 v[106:107], v53 offset0:162 offset1:163
  s_waitcnt lgkmcnt(6)
  v_mfma_f32_16x16x32_bf16 v[68:71], v[92:95], a[28:31], v[68:71]
  v_mfma_f32_16x16x32_bf16 v[72:75], v[92:95], a[60:63], v[72:75]
  v_mfma_f32_16x16x32_bf16 v[76:79], v[92:95], a[92:95], v[76:79]
  v_mfma_f32_16x16x32_bf16 v[80:83], v[92:95], a[124:127], v[80:83]
  v_mfma_f32_16x16x32_bf16 v[84:87], v[92:95], a[156:159], v[84:87]
  v_mfma_f32_16x16x32_bf16 v[88:91], v[92:95], a[188:191], v[88:91]
  ds_read2_b32 v[92:93], v53 offset0:144 offset1:145
  ds_read2_b32 v[94:95], v53 offset0:146 offset1:147
  s_waitcnt lgkmcnt(6)
  v_mfma_f32_16x16x32_bf16 v[68:71], v[96:99], a[24:27], v[68:71]
  v_mfma_f32_16x16x32_bf16 v[72:75], v[96:99], a[56:59], v[72:75]
  v_mfma_f32_16x16x32_bf16 v[76:79], v[96:99], a[88:91], v[76:79]
  v_mfma_f32_16x16x32_bf16 v[80:83], v[96:99], a[120:123], v[80:83]
  v_mfma_f32_16x16x32_bf16 v[84:87], v[96:99], a[152:155], v[84:87]
  v_mfma_f32_16x16x32_bf16 v[88:91], v[96:99], a[184:187], v[88:91]
  ds_read2_b32 v[96:97], v53 offset0:128 offset1:129
  ds_read2_b32 v[98:99], v53 offset0:130 offset1:131
  s_waitcnt lgkmcnt(6)
  v_mfma_f32_16x16x32_bf16 v[68:71], v[100:103], a[20:23], v[68:71]
  v_mfma_f32_16x16x32_bf16 v[72:75], v[100:103], a[52:55], v[72:75]
  v_mfma_f32_16x16x32_bf16 v[76:79], v[100:103], a[84:87], v[76:79]
  v_mfma_f32_16x16x32_bf16 v[80:83], v[100:103], a[116:119], v[80:83]
  v_mfma_f32_16x16x32_bf16 v[84:87], v[100:103], a[148:151], v[84:87]
  v_mfma_f32_16x16x32_bf16 v[88:91], v[100:103], a[180:183], v[88:91]
  ds_read2_b32 v[100:101], v53 offset0:112 offset1:113
  ds_read2_b32 v[102:103], v53 offset0:114 offset1:115
  s_waitcnt lgkmcnt(6)
  v_mfma_f32_16x16x32_bf16 v[68:71], v[104:107], a[16:19], v[68:71]
  v_mfma_f32_16x16x32_bf16 v[72:75], v[104:107], a[48:51], v[72:75]
  v_mfma_f32_16x16x32_bf16 v[76:79], v[104:107], a[80:83], v[76:79]
  v_mfma_f32_16x16x32_bf16 v[80:83], v[104:107], a[112:115], v[80:83]
  v_mfma_f32_16x16x32_bf16 v[84:87], v[104:107], a[144:147], v[84:87]
  v_mfma_f32_16x16x32_bf16 v[88:91], v[104:107], a[176:179], v[88:91]
  ds_read2_b32 v[104:105], v53 offset0:96 offset1:97
  ds_read2_b32 v[106:107], v53 offset0:98 offset1:99
  s_waitcnt lgkmcnt(6)
  v_mfma_f32_16x16x32_bf16 v[68:71], v[92:95], a[12:15], v[68:71]
  v_mfma_f32_16x16x32_bf16 v[72:75], v[92:95], a[44:47], v[72:75]
  v_mfma_f32_16x16x32_bf16 v[76:79], v[92:95], a[76:79], v[76:79]
  v_mfma_f32_16x16x32_bf16 v[80:83], v[92:95], a[108:111], v[80:83]
  v_mfma_f32_16x16x32_bf16 v[84:87], v[92:95], a[140:143], v[84:87]
  v_mfma_f32_16x16x32_bf16 v[88:91], v[92:95], a[172:175], v[88:91]
  ds_read2_b32 v[92:93], v53 offset0:80 offset1:81
  ds_read2_b32 v[94:95], v53 offset0:82 offset1:83
  s_waitcnt lgkmcnt(6)
  v_mfma_f32_16x16x32_bf16 v[68:71], v[96:99], a[8:11], v[68:71]
  v_mfma_f32_16x16x32_bf16 v[72:75], v[96:99], a[40:43], v[72:75]
  v_mfma_f32_16x16x32_bf16 v[76:79], v[96:99], a[72:75], v[76:79]
  v_mfma_f32_16x16x32_bf16 v[80:83], v[96:99], a[104:107], v[80:83]
  v_mfma_f32_16x16x32_bf16 v[84:87], v[96:99], a[136:139], v[84:87]
  v_mfma_f32_16x16x32_bf16 v[88:91], v[96:99], a[168:171], v[88:91]
  ds_read2_b32 v[96:97], v53 offset0:64 offset1:65
  ds_read2_b32 v[98:99], v53 offset0:66 offset1:67
  s_waitcnt lgkmcnt(6)
  v_mfma_f32_16x16x32_bf16 v[68:71], v[100:103], a[4:7], v[68:71]
  v_mfma_f32_16x16x32_bf16 v[72:75], v[100:103], a[36:39], v[72:75]
  v_mfma_f32_16x16x32_bf16 v[76:79], v[100:103], a[68:71], v[76:79]
  v_mfma_f32_16x16x32_bf16 v[80:83], v[100:103], a[100:103], v[80:83]
  v_mfma_f32_16x16x32_bf16 v[84:87], v[100:103], a[132:135], v[84:87]
  v_mfma_f32_16x16x32_bf16 v[88:91], v[100:103], a[164:167], v[88:91]
  ds_read2_b32 v[100:101], v53 offset0:48 offset1:49
  ds_read2_b32 v[102:103], v53 offset0:50 offset1:51
  s_waitcnt lgkmcnt(6)
  v_mfma_f32_16x16x32_bf16 v[68:71], v[104:107], a[0:3], v[68:71]
  v_mfma_f32_16x16x32_bf16 v[72:75], v[104:107], a[32:35], v[72:75]
  v_mfma_f32_16x16x32_bf16 v[76:79], v[104:107], a[64:67], v[76:79]
  v_mfma_f32_16x16x32_bf16 v[80:83], v[104:107], a[96:99], v[80:83]
  v_mfma_f32_16x16x32_bf16 v[84:87], v[104:107], a[128:131], v[84:87]
  v_mfma_f32_16x16x32_bf16 v[88:91], v[104:107], a[160:163], v[88:91]
  ds_read2_b32 v[104:105], v53 offset0:32 offset1:33
  ds_read2_b32 v[106:107], v53 offset0:34 offset1:35
  s_waitcnt lgkmcnt(6)
  v_mfma_f32_16x16x32_bf16 v[72:75], v[92:95], a[28:31], v[72:75]
  v_mfma_f32_16x16x32_bf16 v[76:79], v[92:95], a[60:63], v[76:79]
  v_mfma_f32_16x16x32_bf16 v[80:83], v[92:95], a[92:95], v[80:83]
  v_mfma_f32_16x16x32_bf16 v[84:87], v[92:95], a[124:127], v[84:87]
  v_mfma_f32_16x16x32_bf16 v[88:91], v[92:95], a[156:159], v[88:91]
  ds_read2_b32 v[92:93], v53 offset0:16 offset1:17
  ds_read2_b32 v[94:95], v53 offset0:18 offset1:19
  s_waitcnt lgkmcnt(6)
  v_mfma_f32_16x16x32_bf16 v[72:75], v[96:99], a[24:27], v[72:75]
  v_mfma_f32_16x16x32_bf16 v[76:79], v[96:99], a[56:59], v[76:79]
  v_mfma_f32_16x16x32_bf16 v[80:83], v[96:99], a[88:91], v[80:83]
  v_mfma_f32_16x16x32_bf16 v[84:87], v[96:99], a[120:123], v[84:87]
  v_mfma_f32_16x16x32_bf16 v[88:91], v[96:99], a[152:155], v[88:91]
  ds_read2_b32 v[96:97], v53 offset0:0 offset1:1
  ds_read2_b32 v[98:99], v53 offset0:2 offset1:3
  s_waitcnt lgkmcnt(6)
  v_mfma_f32_16x16x32_bf16 v[72:75], v[100:103], a[20:23], v[72:75]
  v_mfma_f32_16x16x32_bf16 v[76:79], v[100:103], a[52:55], v[76:79]
  v_mfma_f32_16x16x32_bf16 v[80:83], v[100:103], a[84:87], v[80:83]
  v_mfma_f32_16x16x32_bf16 v[84:87], v[100:103], a[116:119], v[84:87]
  v_mfma_f32_16x16x32_bf16 v[88:91], v[100:103], a[148:151], v[88:91]
  ds_read2_b32 v[100:101], v54 offset0:224 offset1:225
  ds_read2_b32 v[102:103], v54 offset0:226 offset1:227
  s_waitcnt lgkmcnt(6)
  v_mfma_f32_16x16x32_bf16 v[72:75], v[104:107], a[16:19], v[72:75]
  v_mfma_f32_16x16x32_bf16 v[76:79], v[104:107], a[48:51], v[76:79]
  v_mfma_f32_16x16x32_bf16 v[80:83], v[104:107], a[80:83], v[80:83]
  v_mfma_f32_16x16x32_bf16 v[84:87], v[104:107], a[112:115], v[84:87]
  v_mfma_f32_16x16x32_bf16 v[88:91], v[104:107], a[144:147], v[88:91]
  ds_read2_b32 v[104:105], v54 offset0:208 offset1:209
  ds_read2_b32 v[106:107], v54 offset0:210 offset1:211
  s_waitcnt lgkmcnt(6)
  v_mfma_f32_16x16x32_bf16 v[72:75], v[92:95], a[12:15], v[72:75]
  v_mfma_f32_16x16x32_bf16 v[76:79], v[92:95], a[44:47], v[76:79]
  v_mfma_f32_16x16x32_bf16 v[80:83], v[92:95], a[76:79], v[80:83]
  v_mfma_f32_16x16x32_bf16 v[84:87], v[92:95], a[108:111], v[84:87]
  v_mfma_f32_16x16x32_bf16 v[88:91], v[92:95], a[140:143], v[88:91]
  ds_read2_b32 v[92:93], v54 offset0:192 offset1:193
  ds_read2_b32 v[94:95], v54 offset0:194 offset1:195
  s_waitcnt lgkmcnt(6)
  v_mfma_f32_16x16x32_bf16 v[72:75], v[96:99], a[8:11], v[72:75]
  v_mfma_f32_16x16x32_bf16 v[76:79], v[96:99], a[40:43], v[76:79]
  v_mfma_f32_16x16x32_bf16 v[80:83], v[96:99], a[72:75], v[80:83]
  v_mfma_f32_16x16x32_bf16 v[84:87], v[96:99], a[104:107], v[84:87]
  v_mfma_f32_16x16x32_bf16 v[88:91], v[96:99], a[136:139], v[88:91]
  ds_read2_b32 v[96:97], v54 offset0:176 offset1:177
  ds_read2_b32 v[98:99], v54 offset0:178 offset1:179
  s_waitcnt lgkmcnt(6)
  v_mfma_f32_16x16x32_bf16 v[72:75], v[100:103], a[4:7], v[72:75]
  v_mfma_f32_16x16x32_bf16 v[76:79], v[100:103], a[36:39], v[76:79]
  v_mfma_f32_16x16x32_bf16 v[80:83], v[100:103], a[68:71], v[80:83]
  v_mfma_f32_16x16x32_bf16 v[84:87], v[100:103], a[100:103], v[84:87]
  v_mfma_f32_16x16x32_bf16 v[88:91], v[100:103], a[132:135], v[88:91]
  ds_read2_b32 v[100:101], v54 offset0:160 offset1:161
  ds_read2_b32 v[102:103], v54 offset0:162 offset1:163
  s_waitcnt lgkmcnt(6)
  v_mfma_f32_16x16x32_bf16 v[72:75], v[104:107], a[0:3], v[72:75]
  v_mfma_f32_16x16x32_bf16 v[76:79], v[104:107], a[32:35], v[76:79]
  v_mfma_f32_16x16x32_bf16 v[80:83], v[104:107], a[64:67], v[80:83]
  v_mfma_f32_16x16x32_bf16 v[84:87], v[104:107], a[96:99], v[84:87]
  v_mfma_f32_16x16x32_bf16 v[88:91], v[104:107], a[128:131], v[88:91]
  ds_read2_b32 v[104:105], v54 offset0:144 offset1:145
  ds_read2_b32 v[106:107], v54 offset0:146 offset1:147
  s_waitcnt lgkmcnt(6)
  v_mfma_f32_16x16x32_bf16 v[76:79], v[92:95], a[28:31], v[76:79]
  v_mfma_f32_16x16x32_bf16 v[80:83], v[92:95], a[60:63], v[80:83]
  v_mfma_f32_16x16x32_bf16 v[84:87], v[92:95], a[92:95], v[84:87]
  v_mfma_f32_16x16x32_bf16 v[88:91], v[92:95], a[124:127], v[88:91]
  ds_read2_b32 v[92:93], v54 offset0:128 offset1:129
  ds_read2_b32 v[94:95], v54 offset0:130 offset1:131
  s_waitcnt lgkmcnt(6)
  v_mfma_f32_16x16x32_bf16 v[76:79], v[96:99], a[24:27], v[76:79]
  v_mfma_f32_16x16x32_bf16 v[80:83], v[96:99], a[56:59], v[80:83]
  v_mfma_f32_16x16x32_bf16 v[84:87], v[96:99], a[88:91], v[84:87]
  v_mfma_f32_16x16x32_bf16 v[88:91], v[96:99], a[120:123], v[88:91]
  ds_read2_b32 v[96:97], v54 offset0:112 offset1:113
  ds_read2_b32 v[98:99], v54 offset0:114 offset1:115
  s_waitcnt lgkmcnt(6)
  v_mfma_f32_16x16x32_bf16 v[76:79], v[100:103], a[20:23], v[76:79]
  v_mfma_f32_16x16x32_bf16 v[80:83], v[100:103], a[52:55], v[80:83]
  v_mfma_f32_16x16x32_bf16 v[84:87], v[100:103], a[84:87], v[84:87]
  v_mfma_f32_16x16x32_bf16 v[88:91], v[100:103], a[116:119], v[88:91]
  ds_read2_b32 v[100:101], v54 offset0:96 offset1:97
  ds_read2_b32 v[102:103], v54 offset0:98 offset1:99
  s_waitcnt lgkmcnt(6)
  v_mfma_f32_16x16x32_bf16 v[76:79], v[104:107], a[16:19], v[76:79]
  v_mfma_f32_16x16x32_bf16 v[80:83], v[104:107], a[48:51], v[80:83]
  v_mfma_f32_16x16x32_bf16 v[84:87], v[104:107], a[80:83], v[84:87]
  v_mfma_f32_16x16x32_bf16 v[88:91], v[104:107], a[112:115], v[88:91]
  ds_read2_b32 v[104:105], v54 offset0:80 offset1:81
  ds_read2_b32 v[106:107], v54 offset0:82 offset1:83
  s_waitcnt lgkmcnt(6)
  v_mfma_f32_16x16x32_bf16 v[76:79], v[92:95], a[12:15], v[76:79]
  v_mfma_f32_16x16x32_bf16 v[80:83], v[92:95], a[44:47], v[80:83]
  v_mfma_f32_16x16x32_bf16 v[84:87], v[92:95], a[76:79], v[84:87]
  v_mfma_f32_16x16x32_bf16 v[88:91], v[92:95], a[108:111], v[88:91]
  ds_read2_b32 v[92:93], v54 offset0:64 offset1:65
  ds_read2_b32 v[94:95], v54 offset0:66 offset1:67
  s_waitcnt lgkmcnt(6)
  v_mfma_f32_16x16x32_bf16 v[76:79], v[96:99], a[8:11], v[76:79]
  v_mfma_f32_16x16x32_bf16 v[80:83], v[96:99], a[40:43], v[80:83]
  v_mfma_f32_16x16x32_bf16 v[84:87], v[96:99], a[72:75], v[84:87]
  v_mfma_f32_16x16x32_bf16 v[88:91], v[96:99], a[104:107], v[88:91]
  ds_read2_b32 v[96:97], v54 offset0:48 offset1:49
  ds_read2_b32 v[98:99], v54 offset0:50 offset1:51
  s_waitcnt lgkmcnt(6)
  v_mfma_f32_16x16x32_bf16 v[76:79], v[100:103], a[4:7], v[76:79]
  v_mfma_f32_16x16x32_bf16 v[80:83], v[100:103], a[36:39], v[80:83]
  v_mfma_f32_16x16x32_bf16 v[84:87], v[100:103], a[68:71], v[84:87]
  v_mfma_f32_16x16x32_bf16 v[88:91], v[100:103], a[100:103], v[88:91]
  ds_read2_b32 v[100:101], v54 offset0:32 offset1:33
  ds_read2_b32 v[102:103], v54 offset0:34 offset1:35
  s_waitcnt lgkmcnt(6)
  v_mfma_f32_16x16x32_bf16 v[76:79], v[104:107], a[0:3], v[76:79]
  v_mfma_f32_16x16x32_bf16 v[80:83], v[104:107], a[32:35], v[80:83]
  v_mfma_f32_16x16x32_bf16 v[84:87], v[104:107], a[64:67], v[84:87]
  v_mfma_f32_16x16x32_bf16 v[88:91], v[104:107], a[96:99], v[88:91]
  ds_read2_b32 v[104:105], v54 offset0:16 offset1:17
  ds_read2_b32 v[106:107], v54 offset0:18 offset1:19
  s_waitcnt lgkmcnt(6)
  v_mfma_f32_16x16x32_bf16 v[80:83], v[92:95], a[28:31], v[80:83]
  v_mfma_f32_16x16x32_bf16 v[84:87], v[92:95], a[60:63], v[84:87]
  v_mfma_f32_16x16x32_bf16 v[88:91], v[92:95], a[92:95], v[88:91]
  ds_read2_b32 v[92:93], v54 offset0:0 offset1:1
  ds_read2_b32 v[94:95], v54 offset0:2 offset1:3
  s_waitcnt lgkmcnt(6)
  v_mfma_f32_16x16x32_bf16 v[80:83], v[96:99], a[24:27], v[80:83]
  v_mfma_f32_16x16x32_bf16 v[84:87], v[96:99], a[56:59], v[84:87]
  v_mfma_f32_16x16x32_bf16 v[88:91], v[96:99], a[88:91], v[88:91]
  ds_read2_b32 v[96:97], v55 offset0:224 offset1:225
  ds_read2_b32 v[98:99], v55 offset0:226 offset1:227
  s_waitcnt lgkmcnt(6)
  v_mfma_f32_16x16x32_bf16 v[80:83], v[100:103], a[20:23], v[80:83]
  v_mfma_f32_16x16x32_bf16 v[84:87], v[100:103], a[52:55], v[84:87]
  v_mfma_f32_16x16x32_bf16 v[88:91], v[100:103], a[84:87], v[88:91]
  ds_read2_b32 v[100:101], v55 offset0:208 offset1:209
  ds_read2_b32 v[102:103], v55 offset0:210 offset1:211
  s_waitcnt lgkmcnt(6)
  v_mfma_f32_16x16x32_bf16 v[80:83], v[104:107], a[16:19], v[80:83]
  v_mfma_f32_16x16x32_bf16 v[84:87], v[104:107], a[48:51], v[84:87]
  v_mfma_f32_16x16x32_bf16 v[88:91], v[104:107], a[80:83], v[88:91]
  ds_read2_b32 v[104:105], v55 offset0:192 offset1:193
  ds_read2_b32 v[106:107], v55 offset0:194 offset1:195
  s_waitcnt lgkmcnt(6)
  v_mfma_f32_16x16x32_bf16 v[80:83], v[92:95], a[12:15], v[80:83]
  v_mfma_f32_16x16x32_bf16 v[84:87], v[92:95], a[44:47], v[84:87]
  v_mfma_f32_16x16x32_bf16 v[88:91], v[92:95], a[76:79], v[88:91]
  ds_read2_b32 v[92:93], v55 offset0:176 offset1:177
  ds_read2_b32 v[94:95], v55 offset0:178 offset1:179
  s_waitcnt lgkmcnt(6)
  v_mfma_f32_16x16x32_bf16 v[80:83], v[96:99], a[8:11], v[80:83]
  v_mfma_f32_16x16x32_bf16 v[84:87], v[96:99], a[40:43], v[84:87]
  v_mfma_f32_16x16x32_bf16 v[88:91], v[96:99], a[72:75], v[88:91]
  ds_read2_b32 v[96:97], v55 offset0:160 offset1:161
  ds_read2_b32 v[98:99], v55 offset0:162 offset1:163
  s_waitcnt lgkmcnt(6)
  v_mfma_f32_16x16x32_bf16 v[80:83], v[100:103], a[4:7], v[80:83]
  v_mfma_f32_16x16x32_bf16 v[84:87], v[100:103], a[36:39], v[84:87]
  v_mfma_f32_16x16x32_bf16 v[88:91], v[100:103], a[68:71], v[88:91]
  ds_read2_b32 v[100:101], v55 offset0:144 offset1:145
  ds_read2_b32 v[102:103], v55 offset0:146 offset1:147
  s_waitcnt lgkmcnt(6)
  v_mfma_f32_16x16x32_bf16 v[80:83], v[104:107], a[0:3], v[80:83]
  v_mfma_f32_16x16x32_bf16 v[84:87], v[104:107], a[32:35], v[84:87]
  v_mfma_f32_16x16x32_bf16 v[88:91], v[104:107], a[64:67], v[88:91]
  ds_read2_b32 v[104:105], v55 offset0:128 offset1:129
  ds_read2_b32 v[106:107], v55 offset0:130 offset1:131
  s_waitcnt lgkmcnt(6)
  v_mfma_f32_16x16x32_bf16 v[84:87], v[92:95], a[28:31], v[84:87]
  v_mfma_f32_16x16x32_bf16 v[88:91], v[92:95], a[60:63], v[88:91]
  ds_read2_b32 v[92:93], v55 offset0:112 offset1:113
  ds_read2_b32 v[94:95], v55 offset0:114 offset1:115
  s_waitcnt lgkmcnt(6)
  v_mfma_f32_16x16x32_bf16 v[84:87], v[96:99], a[24:27], v[84:87]
  v_mfma_f32_16x16x32_bf16 v[88:91], v[96:99], a[56:59], v[88:91]
  ds_read2_b32 v[96:97], v55 offset0:96 offset1:97
  ds_read2_b32 v[98:99], v55 offset0:98 offset1:99
  s_waitcnt lgkmcnt(6)
  v_mfma_f32_16x16x32_bf16 v[84:87], v[100:103], a[20:23], v[84:87]
  v_mfma_f32_16x16x32_bf16 v[88:91], v[100:103], a[52:55], v[88:91]
  ds_read2_b32 v[100:101], v55 offset0:80 offset1:81
  ds_read2_b32 v[102:103], v55 offset0:82 offset1:83
  s_waitcnt lgkmcnt(6)
  v_mfma_f32_16x16x32_bf16 v[84:87], v[104:107], a[16:19], v[84:87]
  v_mfma_f32_16x16x32_bf16 v[88:91], v[104:107], a[48:51], v[88:91]
  ds_read2_b32 v[104:105], v55 offset0:64 offset1:65
  ds_read2_b32 v[106:107], v55 offset0:66 offset1:67
  s_waitcnt lgkmcnt(6)
  v_mfma_f32_16x16x32_bf16 v[84:87], v[92:95], a[12:15], v[84:87]
  v_mfma_f32_16x16x32_bf16 v[88:91], v[92:95], a[44:47], v[88:91]
  ds_read2_b32 v[92:93], v55 offset0:48 offset1:49
  ds_read2_b32 v[94:95], v55 offset0:50 offset1:51
  s_waitcnt lgkmcnt(6)
  v_mfma_f32_16x16x32_bf16 v[84:87], v[96:99], a[8:11], v[84:87]
  v_mfma_f32_16x16x32_bf16 v[88:91], v[96:99], a[40:43], v[88:91]
  ds_read2_b32 v[96:97], v55 offset0:32 offset1:33
  ds_read2_b32 v[98:99], v55 offset0:34 offset1:35
  s_waitcnt lgkmcnt(6)
  v_mfma_f32_16x16x32_bf16 v[84:87], v[100:103], a[4:7], v[84:87]
  v_mfma_f32_16x16x32_bf16 v[88:91], v[100:103], a[36:39], v[88:91]
  ds_read2_b32 v[100:101], v55 offset0:16 offset1:17
  ds_read2_b32 v[102:103], v55 offset0:18 offset1:19
  s_waitcnt lgkmcnt(6)
  v_mfma_f32_16x16x32_bf16 v[84:87], v[104:107], a[0:3], v[84:87]
  v_mfma_f32_16x16x32_bf16 v[88:91], v[104:107], a[32:35], v[88:91]
  ds_read2_b32 v[104:105], v55 offset0:0 offset1:1
  ds_read2_b32 v[106:107], v55 offset0:2 offset1:3
  s_waitcnt lgkmcnt(6)
  v_mfma_f32_16x16x32_bf16 v[88:91], v[92:95], a[28:31], v[88:91]
  ds_read2_b32 v[92:93], v56 offset0:224 offset1:225
  ds_read2_b32 v[94:95], v56 offset0:226 offset1:227
  s_waitcnt lgkmcnt(6)
  v_mfma_f32_16x16x32_bf16 v[88:91], v[96:99], a[24:27], v[88:91]
  ds_read2_b32 v[96:97], v56 offset0:208 offset1:209
  ds_read2_b32 v[98:99], v56 offset0:210 offset1:211
  s_waitcnt lgkmcnt(6)
  v_mfma_f32_16x16x32_bf16 v[88:91], v[100:103], a[20:23], v[88:91]
  ds_read2_b32 v[100:101], v56 offset0:192 offset1:193
  ds_read2_b32 v[102:103], v56 offset0:194 offset1:195
  s_waitcnt lgkmcnt(6)
  v_mfma_f32_16x16x32_bf16 v[88:91], v[104:107], a[16:19], v[88:91]
  ds_read2_b32 v[104:105], v56 offset0:176 offset1:177
  ds_read2_b32 v[106:107], v56 offset0:178 offset1:179
  s_waitcnt lgkmcnt(6)
  v_mfma_f32_16x16x32_bf16 v[88:91], v[92:95], a[12:15], v[88:91]
  s_waitcnt lgkmcnt(4)
  v_mfma_f32_16x16x32_bf16 v[88:91], v[96:99], a[8:11], v[88:91]
  s_waitcnt lgkmcnt(2)
  v_mfma_f32_16x16x32_bf16 v[88:91], v[100:103], a[4:7], v[88:91]
  s_waitcnt lgkmcnt(0)
  v_mfma_f32_16x16x32_bf16 v[88:91], v[104:107], a[0:3], v[88:91]
  v_lshlrev_b32 v46, 5, v4
  v_lshl_add_u32 v46, v3, 3, v46
  v_add_u32 v46, s17, v46
  ds_read_b64 v[108:109], v46 offset:512
  ds_read_b64 v[110:111], v46 offset:1024
  ds_read_b64 v[112:113], v46 offset:1536
  ds_read_b64 v[114:115], v46 offset:2048
  ds_read_b64 v[116:117], v46 offset:2560
  ds_read_b64 v[118:119], v46 offset:3072
  ds_read_b64 v[120:121], v46 offset:3584
  ds_read_b64 v[122:123], v46 offset:4096
  s_waitcnt lgkmcnt(0)
  v_lshlrev_b32 v124, 16, v108
  v_and_b32 v125, 0xffff0000, v108
  v_lshlrev_b32 v126, 16, v109
  v_and_b32 v127, 0xffff0000, v109
  v_mul_f32 v124, v124, v33
  v_mul_f32 v125, v125, v33
  v_mul_f32 v126, v126, v33
  v_mul_f32 v127, v127, v33
  v_cvt_pk_bf16_f32 v128, v124, v125
  v_cvt_pk_bf16_f32 v129, v126, v127
  v_cvt_pk_bf16_f32 v130, v60, v61
  v_cvt_pk_bf16_f32 v131, v62, v63
  v_lshlrev_b32 v124, 16, v128
  v_and_b32 v125, 0xffff0000, v128
  v_lshlrev_b32 v132, 16, v130
  v_and_b32 v133, 0xffff0000, v130
  v_lshlrev_b32 v126, 16, v129
  v_and_b32 v127, 0xffff0000, v129
  v_lshlrev_b32 v134, 16, v131
  v_and_b32 v135, 0xffff0000, v131
  v_add_f32 v124, v124, v132
  v_add_f32 v125, v125, v133
  v_add_f32 v126, v126, v134
  v_add_f32 v127, v127, v135
  v_cvt_pk_bf16_f32 v108, v124, v125
  v_cvt_pk_bf16_f32 v109, v126, v127
  ds_write_b64 v46, v[108:109] offset:512
  v_lshlrev_b32 v124, 16, v110
  v_and_b32 v125, 0xffff0000, v110
  v_lshlrev_b32 v126, 16, v111
  v_and_b32 v127, 0xffff0000, v111
  v_mul_f32 v124, v124, v33
  v_mul_f32 v125, v125, v33
  v_mul_f32 v126, v126, v33
  v_mul_f32 v127, v127, v33
  v_cvt_pk_bf16_f32 v128, v124, v125
  v_cvt_pk_bf16_f32 v129, v126, v127
  v_cvt_pk_bf16_f32 v130, v64, v65
  v_cvt_pk_bf16_f32 v131, v66, v67
  v_lshlrev_b32 v124, 16, v128
  v_and_b32 v125, 0xffff0000, v128
  v_lshlrev_b32 v132, 16, v130
  v_and_b32 v133, 0xffff0000, v130
  v_lshlrev_b32 v126, 16, v129
  v_and_b32 v127, 0xffff0000, v129
  v_lshlrev_b32 v134, 16, v131
  v_and_b32 v135, 0xffff0000, v131
  v_add_f32 v124, v124, v132
  v_add_f32 v125, v125, v133
  v_add_f32 v126, v126, v134
  v_add_f32 v127, v127, v135
  v_cvt_pk_bf16_f32 v110, v124, v125
  v_cvt_pk_bf16_f32 v111, v126, v127
  ds_write_b64 v46, v[110:111] offset:1024
  v_lshlrev_b32 v124, 16, v112
  v_and_b32 v125, 0xffff0000, v112
  v_lshlrev_b32 v126, 16, v113
  v_and_b32 v127, 0xffff0000, v113
  v_mul_f32 v124, v124, v33
  v_mul_f32 v125, v125, v33
  v_mul_f32 v126, v126, v33
  v_mul_f32 v127, v127, v33
  v_cvt_pk_bf16_f32 v128, v124, v125
  v_cvt_pk_bf16_f32 v129, v126, v127
  v_cvt_pk_bf16_f32 v130, v68, v69
  v_cvt_pk_bf16_f32 v131, v70, v71
  v_lshlrev_b32 v124, 16, v128
  v_and_b32 v125, 0xffff0000, v128
  v_lshlrev_b32 v132, 16, v130
  v_and_b32 v133, 0xffff0000, v130
  v_lshlrev_b32 v126, 16, v129
  v_and_b32 v127, 0xffff0000, v129
  v_lshlrev_b32 v134, 16, v131
  v_and_b32 v135, 0xffff0000, v131
  v_add_f32 v124, v124, v132
  v_add_f32 v125, v125, v133
  v_add_f32 v126, v126, v134
  v_add_f32 v127, v127, v135
  v_cvt_pk_bf16_f32 v112, v124, v125
  v_cvt_pk_bf16_f32 v113, v126, v127
  ds_write_b64 v46, v[112:113] offset:1536
  v_lshlrev_b32 v124, 16, v114
  v_and_b32 v125, 0xffff0000, v114
  v_lshlrev_b32 v126, 16, v115
  v_and_b32 v127, 0xffff0000, v115
  v_mul_f32 v124, v124, v33
  v_mul_f32 v125, v125, v33
  v_mul_f32 v126, v126, v33
  v_mul_f32 v127, v127, v33
  v_cvt_pk_bf16_f32 v128, v124, v125
  v_cvt_pk_bf16_f32 v129, v126, v127
  v_cvt_pk_bf16_f32 v130, v72, v73
  v_cvt_pk_bf16_f32 v131, v74, v75
  v_lshlrev_b32 v124, 16, v128
  v_and_b32 v125, 0xffff0000, v128
  v_lshlrev_b32 v132, 16, v130
  v_and_b32 v133, 0xffff0000, v130
  v_lshlrev_b32 v126, 16, v129
  v_and_b32 v127, 0xffff0000, v129
  v_lshlrev_b32 v134, 16, v131
  v_and_b32 v135, 0xffff0000, v131
  v_add_f32 v124, v124, v132
  v_add_f32 v125, v125, v133
  v_add_f32 v126, v126, v134
  v_add_f32 v127, v127, v135
  v_cvt_pk_bf16_f32 v114, v124, v125
  v_cvt_pk_bf16_f32 v115, v126, v127
  ds_write_b64 v46, v[114:115] offset:2048
  v_lshlrev_b32 v124, 16, v116
  v_and_b32 v125, 0xffff0000, v116
  v_lshlrev_b32 v126, 16, v117
  v_and_b32 v127, 0xffff0000, v117
  v_mul_f32 v124, v124, v33
  v_mul_f32 v125, v125, v33
  v_mul_f32 v126, v126, v33
  v_mul_f32 v127, v127, v33
  v_cvt_pk_bf16_f32 v128, v124, v125
  v_cvt_pk_bf16_f32 v129, v126, v127
  v_cvt_pk_bf16_f32 v130, v76, v77
  v_cvt_pk_bf16_f32 v131, v78, v79
  v_lshlrev_b32 v124, 16, v128
  v_and_b32 v125, 0xffff0000, v128
  v_lshlrev_b32 v132, 16, v130
  v_and_b32 v133, 0xffff0000, v130
  v_lshlrev_b32 v126, 16, v129
  v_and_b32 v127, 0xffff0000, v129
  v_lshlrev_b32 v134, 16, v131
  v_and_b32 v135, 0xffff0000, v131
  v_add_f32 v124, v124, v132
  v_add_f32 v125, v125, v133
  v_add_f32 v126, v126, v134
  v_add_f32 v127, v127, v135
  v_cvt_pk_bf16_f32 v116, v124, v125
  v_cvt_pk_bf16_f32 v117, v126, v127
  ds_write_b64 v46, v[116:117] offset:2560
  v_lshlrev_b32 v124, 16, v118
  v_and_b32 v125, 0xffff0000, v118
  v_lshlrev_b32 v126, 16, v119
  v_and_b32 v127, 0xffff0000, v119
  v_mul_f32 v124, v124, v33
  v_mul_f32 v125, v125, v33
  v_mul_f32 v126, v126, v33
  v_mul_f32 v127, v127, v33
  v_cvt_pk_bf16_f32 v128, v124, v125
  v_cvt_pk_bf16_f32 v129, v126, v127
  v_cvt_pk_bf16_f32 v130, v80, v81
  v_cvt_pk_bf16_f32 v131, v82, v83
  v_lshlrev_b32 v124, 16, v128
  v_and_b32 v125, 0xffff0000, v128
  v_lshlrev_b32 v132, 16, v130
  v_and_b32 v133, 0xffff0000, v130
  v_lshlrev_b32 v126, 16, v129
  v_and_b32 v127, 0xffff0000, v129
  v_lshlrev_b32 v134, 16, v131
  v_and_b32 v135, 0xffff0000, v131
  v_add_f32 v124, v124, v132
  v_add_f32 v125, v125, v133
  v_add_f32 v126, v126, v134
  v_add_f32 v127, v127, v135
  v_cvt_pk_bf16_f32 v118, v124, v125
  v_cvt_pk_bf16_f32 v119, v126, v127
  ds_write_b64 v46, v[118:119] offset:3072
  v_lshlrev_b32 v124, 16, v120
  v_and_b32 v125, 0xffff0000, v120
  v_lshlrev_b32 v126, 16, v121
  v_and_b32 v127, 0xffff0000, v121
  v_mul_f32 v124, v124, v33
  v_mul_f32 v125, v125, v33
  v_mul_f32 v126, v126, v33
  v_mul_f32 v127, v127, v33
  v_cvt_pk_bf16_f32 v128, v124, v125
  v_cvt_pk_bf16_f32 v129, v126, v127
  v_cvt_pk_bf16_f32 v130, v84, v85
  v_cvt_pk_bf16_f32 v131, v86, v87
  v_lshlrev_b32 v124, 16, v128
  v_and_b32 v125, 0xffff0000, v128
  v_lshlrev_b32 v132, 16, v130
  v_and_b32 v133, 0xffff0000, v130
  v_lshlrev_b32 v126, 16, v129
  v_and_b32 v127, 0xffff0000, v129
  v_lshlrev_b32 v134, 16, v131
  v_and_b32 v135, 0xffff0000, v131
  v_add_f32 v124, v124, v132
  v_add_f32 v125, v125, v133
  v_add_f32 v126, v126, v134
  v_add_f32 v127, v127, v135
  v_cvt_pk_bf16_f32 v120, v124, v125
  v_cvt_pk_bf16_f32 v121, v126, v127
  ds_write_b64 v46, v[120:121] offset:3584
  v_lshlrev_b32 v124, 16, v122
  v_and_b32 v125, 0xffff0000, v122
  v_lshlrev_b32 v126, 16, v123
  v_and_b32 v127, 0xffff0000, v123
  v_mul_f32 v124, v124, v33
  v_mul_f32 v125, v125, v33
  v_mul_f32 v126, v126, v33
  v_mul_f32 v127, v127, v33
  v_cvt_pk_bf16_f32 v128, v124, v125
  v_cvt_pk_bf16_f32 v129, v126, v127
  v_cvt_pk_bf16_f32 v130, v88, v89
  v_cvt_pk_bf16_f32 v131, v90, v91
  v_lshlrev_b32 v124, 16, v128
  v_and_b32 v125, 0xffff0000, v128
  v_lshlrev_b32 v132, 16, v130
  v_and_b32 v133, 0xffff0000, v130
  v_lshlrev_b32 v126, 16, v129
  v_and_b32 v127, 0xffff0000, v129
  v_lshlrev_b32 v134, 16, v131
  v_and_b32 v135, 0xffff0000, v131
  v_add_f32 v124, v124, v132
  v_add_f32 v125, v125, v133
  v_add_f32 v126, v126, v134
  v_add_f32 v127, v127, v135
  v_cvt_pk_bf16_f32 v122, v124, v125
  v_cvt_pk_bf16_f32 v123, v126, v127
  ds_write_b64 v46, v[122:123] offset:4096
  s_waitcnt lgkmcnt(0)
  s_barrier
  v_lshlrev_b32 v6, 3, v0
  v_lshlrev_b32 v5, 4, v0
  v_add_u32 v36, 512, v6
  ds_read_b64 v[8:9], v36
  v_add_u32 v36, 25088, v6
  ds_read_b64 v[10:11], v36
  v_add_u32 v36, 49664, v6
  ds_read_b64 v[12:13], v36
  v_add_u32 v36, 74240, v6
  ds_read_b64 v[14:15], v36
  s_waitcnt lgkmcnt(0)
  s_add_u32 s22, s21, 0
  s_add_u32 s23, s22, 3584
  v_perm_b32 v16, v10, v8, s24
  v_perm_b32 v17, v14, v12, s24
  s_lshl_b32 s22, s21, 11
  s_add_u32 s22, s22, 90177536
  v_perm_b32 v18, v10, v8, s25
  v_perm_b32 v19, v14, v12, s25
  buffer_store_dwordx4 v[16:19], v5, s[8:11], s22 offen sc1
  v_perm_b32 v20, v11, v9, s24
  v_perm_b32 v21, v15, v13, s24
  v_perm_b32 v22, v11, v9, s25
  v_perm_b32 v23, v15, v13, s25
  s_add_u32 s22, s22, 4096
  buffer_store_dwordx4 v[20:23], v5, s[8:11], s22 offen sc1
  v_add_u32 v36, 2560, v6
  ds_read_b64 v[8:9], v36
  v_add_u32 v36, 27136, v6
  ds_read_b64 v[10:11], v36
  v_add_u32 v36, 51712, v6
  ds_read_b64 v[12:13], v36
  v_add_u32 v36, 76288, v6
  ds_read_b64 v[14:15], v36
  s_waitcnt lgkmcnt(0)
  s_add_u32 s22, s21, 1835008
  s_add_u32 s23, s22, 3584
  v_perm_b32 v24, v10, v8, s24
  v_perm_b32 v25, v14, v12, s24
  s_lshl_b32 s22, s21, 11
  s_add_u32 s22, s22, 90185728
  v_perm_b32 v26, v10, v8, s25
  v_perm_b32 v27, v14, v12, s25
  buffer_store_dwordx4 v[24:27], v5, s[8:11], s22 offen sc1
  v_perm_b32 v28, v11, v9, s24
  v_perm_b32 v29, v15, v13, s24
  v_perm_b32 v30, v11, v9, s25
  v_perm_b32 v31, v15, v13, s25
  s_add_u32 s22, s22, 4096
  buffer_store_dwordx4 v[28:31], v5, s[8:11], s22 offen sc1
  s_waitcnt vmcnt(0)
  s_barrier
  s_cmp_lg_u32 s16, 0
  s_cbranch_scc1 wk_nc
  v_mov_b32 v5, 1
  s_mov_b32 s22, 88599424
  s_mov_b64 exec, 1
  buffer_atomic_add v5, off, s[8:11], s22
  s_mov_b64 exec, -1
wk_nc:
  s_branch wk_loop
wk_tok:
  s_sub_u32 s3, s3, 864
  s_cmp_lt_u32 s3, 512
  s_cbranch_scc1 wk_tk
  s_sub_u32 s3, s3, 64
  s_cmp_ge_i32 s3, 512
  s_cbranch_scc1 wk_tk
  s_sub_u32 s18, s3, 448
  s_mov_b32 s20, 88599424
  v_mov_b32 v8, 0
  s_mov_b32 s30, 0
wk_cw:
  buffer_load_dword v9, v8, s[8:11], s20 offen sc1
  s_waitcnt vmcnt(0)
  v_cmp_ne_u32 vcc, 112, v9
  s_cbranch_vccz wk_cw_ok
  s_sleep 32
  s_add_u32 s30, s30, 1
  s_cmp_lt_u32 s30, 50000
  s_cbranch_scc1 wk_cw
  s_branch cA_abort
wk_cw_ok:
  v_lshlrev_b32 v5, 14, v3
  v_and_b32 v6, 1, v4
  v_lshl_add_u32 v5, v6, 12, v5
  v_lshrrev_b32 v6, 1, v4
  v_lshl_add_u32 v5, v6, 4, v5
  s_mul_i32 s20, s16, 458752
  s_lshl_b32 s21, s18, 7
  s_add_u32 s20, s20, s21
  s_and_b32 s21, s18, 32
  s_lshl_b32 s21, s21, 7
  s_add_u32 s20, s20, s21
  s_add_u32 s20, s20, 90177536
  buffer_load_dwordx4 v[8:11], v5, s[8:11], s20 offen sc1
  s_add_u32 s20, s20, 65536
  buffer_load_dwordx4 v[12:15], v5, s[8:11], s20 offen sc1
  s_add_u32 s20, s20, 65536
  buffer_load_dwordx4 v[16:19], v5, s[8:11], s20 offen sc1
  s_add_u32 s20, s20, 65536
  buffer_load_dwordx4 v[20:23], v5, s[8:11], s20 offen sc1
  s_add_u32 s20, s20, 65536
  buffer_load_dwordx4 v[24:27], v5, s[8:11], s20 offen sc1
  s_add_u32 s20, s20, 65536
  buffer_load_dwordx4 v[28:31], v5, s[8:11], s20 offen sc1
  s_add_u32 s20, s20, 65536
  buffer_load_dwordx4 v[32:35], v5, s[8:11], s20 offen sc1
  s_add_u32 s20, s20, 65536
  v_mul_u32_u24 v6, 1824, v4
  v_lshl_add_u32 v6, v3, 3, v6
  s_mul_i32 s20, s16, 224
  v_add_u32 v6, s20, v6
  s_movk_i32 s22, 912
  v_add_u32 v36, 0, v0
  v_mul_u32_u24 v37, 18725, v36
  v_lshrrev_b32 v37, 20, v37
  v_mul_u32_u24 v38, 56, v37
  v_sub_u32 v36, v36, v38
  v_lshlrev_b32 v36, 4, v36
  v_mad_u32_u24 v40, v37, s22, v36
  v_mul_u32_u24 v37, 1792, v37
  v_add_u32 v48, v37, v36
  v_add_u32 v36, 256, v0
  v_mul_u32_u24 v37, 18725, v36
  v_lshrrev_b32 v37, 20, v37
  v_mul_u32_u24 v38, 56, v37
  v_sub_u32 v36, v36, v38
  v_lshlrev_b32 v36, 4, v36
  v_mad_u32_u24 v41, v37, s22, v36
  v_mul_u32_u24 v37, 1792, v37
  v_add_u32 v49, v37, v36
  v_add_u32 v36, 512, v0
  v_mul_u32_u24 v37, 18725, v36
  v_lshrrev_b32 v37, 20, v37
  v_mul_u32_u24 v38, 56, v37
  v_sub_u32 v36, v36, v38
  v_lshlrev_b32 v36, 4, v36
  v_mad_u32_u24 v42, v37, s22, v36
  v_mul_u32_u24 v37, 1792, v37
  v_add_u32 v50, v37, v36
  v_add_u32 v36, 768, v0
  v_mul_u32_u24 v37, 18725, v36
  v_lshrrev_b32 v37, 20, v37
  v_mul_u32_u24 v38, 56, v37
  v_sub_u32 v36, v36, v38
  v_lshlrev_b32 v36, 4, v36
  v_mad_u32_u24 v43, v37, s22, v36
  v_mul_u32_u24 v37, 1792, v37
  v_add_u32 v51, v37, v36
  v_add_u32 v36, 1024, v0
  v_mul_u32_u24 v37, 18725, v36
  v_lshrrev_b32 v37, 20, v37
  v_mul_u32_u24 v38, 56, v37
  v_sub_u32 v36, v36, v38
  v_lshlrev_b32 v36, 4, v36
  v_mad_u32_u24 v44, v37, s22, v36
  v_mul_u32_u24 v37, 1792, v37
  v_add_u32 v52, v37, v36
  v_add_u32 v36, 1280, v0
  v_mul_u32_u24 v37, 18725, v36
  v_lshrrev_b32 v37, 20, v37
  v_mul_u32_u24 v38, 56, v37
  v_sub_u32 v36, v36, v38
  v_lshlrev_b32 v36, 4, v36
  v_mad_u32_u24 v45, v37, s22, v36
  v_mul_u32_u24 v37, 1792, v37
  v_add_u32 v53, v37, v36
  v_add_u32 v36, 1536, v0
  v_mul_u32_u24 v37, 18725, v36
  v_lshrrev_b32 v37, 20, v37
  v_mul_u32_u24 v38, 56, v37
  v_sub_u32 v36, v36, v38
  v_lshlrev_b32 v36, 4, v36
  v_mad_u32_u24 v46, v37, s22, v36
  v_mul_u32_u24 v37, 1792, v37
  v_add_u32 v54, v37, v36
  s_waitcnt vmcnt(6)
  ds_write_b64 v6, v[8:9] offset:0
  ds_write_b64 v6, v[10:11] offset:912
  s_waitcnt vmcnt(5)
  ds_write_b64 v6, v[12:13] offset:32
  ds_write_b64 v6, v[14:15] offset:944
  s_waitcnt vmcnt(4)
  ds_write_b64 v6, v[16:17] offset:64
  ds_write_b64 v6, v[18:19] offset:976
  s_waitcnt vmcnt(3)
  ds_write_b64 v6, v[20:21] offset:96
  ds_write_b64 v6, v[22:23] offset:1008
  s_waitcnt vmcnt(2)
  ds_write_b64 v6, v[24:25] offset:128
  ds_write_b64 v6, v[26:27] offset:1040
  s_waitcnt vmcnt(1)
  ds_write_b64 v6, v[28:29] offset:160
  ds_write_b64 v6, v[30:31] offset:1072
  s_waitcnt vmcnt(0)
  ds_write_b64 v6, v[32:33] offset:192
  ds_write_b64 v6, v[34:35] offset:1104
  s_waitcnt lgkmcnt(0)
  s_barrier
  s_mul_i32 s20, s18, 57344
  ds_read_b128 v[8:11], v40
  ds_read_b128 v[12:15], v41
  ds_read_b128 v[16:19], v42
  ds_read_b128 v[20:23], v43
  ds_read_b128 v[24:27], v44
  ds_read_b128 v[28:31], v45
  ds_read_b128 v[32:35], v46
  s_waitcnt lgkmcnt(6)
  buffer_store_dwordx4 v[8:11], v48, s[92:95], s20 offen
  s_waitcnt lgkmcnt(5)
  buffer_store_dwordx4 v[12:15], v49, s[92:95], s20 offen
  s_waitcnt lgkmcnt(4)
  buffer_store_dwordx4 v[16:19], v50, s[92:95], s20 offen
  s_waitcnt lgkmcnt(3)
  buffer_store_dwordx4 v[20:23], v51, s[92:95], s20 offen
  s_waitcnt lgkmcnt(2)
  buffer_store_dwordx4 v[24:27], v52, s[92:95], s20 offen
  s_waitcnt lgkmcnt(1)
  buffer_store_dwordx4 v[28:31], v53, s[92:95], s20 offen
  s_waitcnt lgkmcnt(0)
  buffer_store_dwordx4 v[32:35], v54, s[92:95], s20 offen
  s_branch wk_loop
wk_tk:
  s_and_b32 s18, s3, 3
  s_lshr_b32 s17, s3, 2
  s_cmp_lt_u32 s17, 8
  s_cbranch_scc1 wk_tokp
  s_sub_u32 s17, s17, 64
  s_cmp_ge_i32 s17, 56
  s_cbranch_scc1 wk_toko
  s_add_u32 s20, s17, 56
  s_lshr_b32 s17, s20, 1
  s_bitcmp0_b32 s20, 0
  s_cbranch_scc1 wk_toko
  s_add_u32 s17, s17, 8
wk_tokp:
  s_lshl_b32 s20, s18, 2
  s_add_u32 s20, s20, s16
  s_lshl_b32 s21, s17, 4
  s_add_u32 s21, s21, s20
  s_mul_i32 s21, s21, 28672
  s_add_u32 s21, s21, 12845056
  s_mul_i32 s23, s17, 28672
  s_add_u32 s23, s23, 73400320
  s_mul_i32 s24, s17, 7168
  s_add_u32 s24, s24, 88080384
  s_lshr_b32 s25, s17, 3
  s_lshl_b32 s25, s25, 4
  s_add_u32 s25, s25, s20
  s_lshl_b32 s25, s25, 7
  s_add_u32 s25, s25, 88557568
  v_mov_b32 v60, 0
  s_mov_b32 s30, 0
wp_wf:
  buffer_load_dword v61, v60, s[8:11], s25 offen sc1
  s_waitcnt vmcnt(0)
  v_cmp_ne_u32 vcc, 56, v61
  s_cbranch_vccz wp_wf_ok
  s_sleep 1
  s_cmp_ge_u32 s17, 61
  s_cbranch_scc1 wp_wf_bo
  s_sleep 4
  s_cmp_ge_u32 s17, 56
  s_cbranch_scc1 wp_wf_bo
  s_sleep 40
wp_wf_bo:
  s_add_u32 s30, s30, 1
  s_cmp_lt_u32 s30, 30000
  s_cbranch_scc1 wp_wf
  s_branch wp_abort
wp_wf_ok:
  s_add_u32 s22, s21, 0
  buffer_load_dwordx4 a[0:3], v2, s[8:11], s22 offen offset:0 sc1
  buffer_load_dwordx4 a[4:7], v2, s[8:11], s22 offen offset:1024 sc1
  buffer_load_dwordx4 a[8:11], v2, s[8:11], s22 offen offset:2048 sc1
  buffer_load_dwordx4 a[12:15], v2, s[8:11], s22 offen offset:3072 sc1
  s_add_u32 s22, s21, 4096
  buffer_load_dwordx4 a[16:19], v2, s[8:11], s22 offen offset:0 sc1
  buffer_load_dwordx4 a[20:23], v2, s[8:11], s22 offen offset:1024 sc1
  buffer_load_dwordx4 a[24:27], v2, s[8:11], s22 offen offset:2048 sc1
  buffer_load_dwordx4 a[28:31], v2, s[8:11], s22 offen offset:3072 sc1
  s_add_u32 s22, s21, 8192
  buffer_load_dwordx4 a[32:35], v2, s[8:11], s22 offen offset:0 sc1
  buffer_load_dwordx4 a[36:39], v2, s[8:11], s22 offen offset:1024 sc1
  buffer_load_dwordx4 a[40:43], v2, s[8:11], s22 offen offset:2048 sc1
  buffer_load_dwordx4 a[44:47], v2, s[8:11], s22 offen offset:3072 sc1
  s_add_u32 s22, s21, 12288
  buffer_load_dwordx4 a[48:51], v2, s[8:11], s22 offen offset:0 sc1
  buffer_load_dwordx4 a[52:55], v2, s[8:11], s22 offen offset:1024 sc1
  buffer_load_dwordx4 a[56:59], v2, s[8:11], s22 offen offset:2048 sc1
  buffer_load_dwordx4 a[60:63], v2, s[8:11], s22 offen offset:3072 sc1
  s_add_u32 s22, s21, 16384
  buffer_load_dwordx4 a[64:67], v2, s[8:11], s22 offen offset:0 sc1
  buffer_load_dwordx4 a[68:71], v2, s[8:11], s22 offen offset:1024 sc1
  buffer_load_dwordx4 a[72:75], v2, s[8:11], s22 offen offset:2048 sc1
  buffer_load_dwordx4 a[76:79], v2, s[8:11], s22 offen offset:3072 sc1
  s_add_u32 s22, s21, 20480
  buffer_load_dwordx4 a[80:83], v2, s[8:11], s22 offen offset:0 sc1
  buffer_load_dwordx4 a[84:87], v2, s[8:11], s22 offen offset:1024 sc1
  buffer_load_dwordx4 a[88:91], v2, s[8:11], s22 offen offset:2048 sc1
  buffer_load_dwordx4 a[92:95], v2, s[8:11], s22 offen offset:3072 sc1
  s_add_u32 s22, s21, 24576
  buffer_load_dwordx4 a[96:99], v2, s[8:11], s22 offen offset:0 sc1
  buffer_load_dwordx4 a[100:103], v2, s[8:11], s22 offen offset:1024 sc1
  buffer_load_dwordx4 a[104:107], v2, s[8:11], s22 offen offset:2048 sc1
  buffer_load_dwordx4 a[108:111], v2, s[8:11], s22 offen offset:3072 sc1
  s_add_u32 s22, s23, 0
  buffer_load_dwordx4 a[112:115], v2, s[8:11], s22 offen offset:0 sc1
  buffer_load_dwordx4 a[116:119], v2, s[8:11], s22 offen offset:1024 sc1
  buffer_load_dwordx4 a[120:123], v2, s[8:11], s22 offen offset:2048 sc1
  buffer_load_dwordx4 a[124:127], v2, s[8:11], s22 offen offset:3072 sc1
  s_add_u32 s22, s23, 4096
  buffer_load_dwordx4 a[128:131], v2, s[8:11], s22 offen offset:0 sc1
  buffer_load_dwordx4 a[132:135], v2, s[8:11], s22 offen offset:1024 sc1
  buffer_load_dwordx4 a[136:139], v2, s[8:11], s22 offen offset:2048 sc1
  buffer_load_dwordx4 a[140:143], v2, s[8:11], s22 offen offset:3072 sc1
  s_add_u32 s22, s23, 8192
  buffer_load_dwordx4 a[144:147], v2, s[8:11], s22 offen offset:0 sc1
  buffer_load_dwordx4 a[148:151], v2, s[8:11], s22 offen offset:1024 sc1
  buffer_load_dwordx4 a[152:155], v2, s[8:11], s22 offen offset:2048 sc1
  buffer_load_dwordx4 a[156:159], v2, s[8:11], s22 offen offset:3072 sc1
  s_add_u32 s22, s23, 12288
  buffer_load_dwordx4 a[160:163], v2, s[8:11], s22 offen offset:0 sc1
  buffer_load_dwordx4 a[164:167], v2, s[8:11], s22 offen offset:1024 sc1
  buffer_load_dwordx4 a[168:171], v2, s[8:11], s22 offen offset:2048 sc1
  buffer_load_dwordx4 a[172:175], v2, s[8:11], s22 offen offset:3072 sc1
  s_add_u32 s22, s23, 16384
  buffer_load_dwordx4 a[176:179], v2, s[8:11], s22 offen offset:0 sc1
  buffer_load_dwordx4 a[180:183], v2, s[8:11], s22 offen offset:1024 sc1
  buffer_load_dwordx4 a[184:187], v2, s[8:11], s22 offen offset:2048 sc1
  buffer_load_dwordx4 a[188:191], v2, s[8:11], s22 offen offset:3072 sc1
  s_add_u32 s22, s23, 20480
  buffer_load_dwordx4 a[192:195], v2, s[8:11], s22 offen offset:0 sc1
  buffer_load_dwordx4 a[196:199], v2, s[8:11], s22 offen offset:1024 sc1
  buffer_load_dwordx4 a[200:203], v2, s[8:11], s22 offen offset:2048 sc1
  buffer_load_dwordx4 a[204:207], v2, s[8:11], s22 offen offset:3072 sc1
  s_add_u32 s22, s23, 24576
  buffer_load_dwordx4 a[208:211], v2, s[8:11], s22 offen offset:0 sc1
  buffer_load_dwordx4 a[212:215], v2, s[8:11], s22 offen offset:1024 sc1
  buffer_load_dwordx4 a[216:219], v2, s[8:11], s22 offen offset:2048 sc1
  buffer_load_dwordx4 a[220:223], v2, s[8:11], s22 offen offset:3072 sc1
  v_lshl_add_u32 v5, v3, 2, 0
  v_cmp_le_u32 s[40:41], v5, v4
  v_lshl_add_u32 v5, v3, 2, 1
  v_cmp_le_u32 s[42:43], v5, v4
  v_lshl_add_u32 v5, v3, 2, 2
  v_cmp_le_u32 s[44:45], v5, v4
  v_lshl_add_u32 v5, v3, 2, 3
  v_cmp_le_u32 s[46:47], v5, v4
  v_cmp_gt_u32 s[48:49], 2, v3
  v_mov_b32 v6, 0xff800000
  s_waitcnt vmcnt(0)
  v_mfma_f32_16x16x32_bf16 v[8:11], a[112:115], a[0:3], 0
  v_mfma_f32_16x16x32_bf16 v[12:15], a[112:115], a[56:59], 0
  v_mfma_f32_16x16x32_bf16 v[16:19], a[168:171], a[56:59], 0
  v_mfma_f32_16x16x32_bf16 v[8:11], a[116:119], a[4:7], v[8:11]
  v_mfma_f32_16x16x32_bf16 v[12:15], a[116:119], a[60:63], v[12:15]
  v_mfma_f32_16x16x32_bf16 v[16:19], a[172:175], a[60:63], v[16:19]
  v_mfma_f32_16x16x32_bf16 v[8:11], a[120:123], a[8:11], v[8:11]
  v_mfma_f32_16x16x32_bf16 v[12:15], a[120:123], a[64:67], v[12:15]
  v_mfma_f32_16x16x32_bf16 v[16:19], a[176:179], a[64:67], v[16:19]
  v_mfma_f32_16x16x32_bf16 v[8:11], a[124:127], a[12:15], v[8:11]
  v_mfma_f32_16x16x32_bf16 v[12:15], a[124:127], a[68:71], v[12:15]
  v_mfma_f32_16x16x32_bf16 v[16:19], a[180:183], a[68:71], v[16:19]
  v_mfma_f32_16x16x32_bf16 v[8:11], a[128:131], a[16:19], v[8:11]
  v_mfma_f32_16x16x32_bf16 v[12:15], a[128:131], a[72:75], v[12:15]
  v_mfma_f32_16x16x32_bf16 v[16:19], a[184:187], a[72:75], v[16:19]
  v_mfma_f32_16x16x32_bf16 v[8:11], a[132:135], a[20:23], v[8:11]
  v_mfma_f32_16x16x32_bf16 v[12:15], a[132:135], a[76:79], v[12:15]
  v_mfma_f32_16x16x32_bf16 v[16:19], a[188:191], a[76:79], v[16:19]
  v_mfma_f32_16x16x32_bf16 v[8:11], a[136:139], a[24:27], v[8:11]
  v_mfma_f32_16x16x32_bf16 v[12:15], a[136:139], a[80:83], v[12:15]
  v_mfma_f32_16x16x32_bf16 v[16:19], a[192:195], a[80:83], v[16:19]
  v_mfma_f32_16x16x32_bf16 v[8:11], a[140:143], a[28:31], v[8:11]
  v_mfma_f32_16x16x32_bf16 v[12:15], a[140:143], a[84:87], v[12:15]
  v_mfma_f32_16x16x32_bf16 v[16:19], a[196:199], a[84:87], v[16:19]
  v_mfma_f32_16x16x32_bf16 v[8:11], a[144:147], a[32:35], v[8:11]
  v_mfma_f32_16x16x32_bf16 v[12:15], a[144:147], a[88:91], v[12:15]
  v_mfma_f32_16x16x32_bf16 v[16:19], a[200:203], a[88:91], v[16:19]
  v_mfma_f32_16x16x32_bf16 v[8:11], a[148:151], a[36:39], v[8:11]
  v_mfma_f32_16x16x32_bf16 v[12:15], a[148:151], a[92:95], v[12:15]
  v_mfma_f32_16x16x32_bf16 v[16:19], a[204:207], a[92:95], v[16:19]
  v_mfma_f32_16x16x32_bf16 v[8:11], a[152:155], a[40:43], v[8:11]
  v_mfma_f32_16x16x32_bf16 v[12:15], a[152:155], a[96:99], v[12:15]
  v_mfma_f32_16x16x32_bf16 v[16:19], a[208:211], a[96:99], v[16:19]
  v_mfma_f32_16x16x32_bf16 v[8:11], a[156:159], a[44:47], v[8:11]
  v_mfma_f32_16x16x32_bf16 v[12:15], a[156:159], a[100:103], v[12:15]
  v_mfma_f32_16x16x32_bf16 v[16:19], a[212:215], a[100:103], v[16:19]
  v_mfma_f32_16x16x32_bf16 v[8:11], a[160:163], a[48:51], v[8:11]
  v_mfma_f32_16x16x32_bf16 v[12:15], a[160:163], a[104:107], v[12:15]
  v_mfma_f32_16x16x32_bf16 v[16:19], a[216:219], a[104:107], v[16:19]
  v_mfma_f32_16x16x32_bf16 v[8:11], a[164:167], a[52:55], v[8:11]
  v_mfma_f32_16x16x32_bf16 v[12:15], a[164:167], a[108:111], v[12:15]
  v_mfma_f32_16x16x32_bf16 v[16:19], a[220:223], a[108:111], v[16:19]
  s_mul_i32 s22, s20, 448
  v_mov_b32 v62, s22
  s_mov_b32 s30, 0
wp_pm:
  s_cmp_ge_u32 s17, 64
  s_cbranch_scc1 wp_pf
  s_cmp_ge_u32 s17, 61
  s_cbranch_scc1 mp_45a
  v_mov_b32 v61, 0
  s_mov_b64 exec, 1
  buffer_atomic_or v61, v62, s[8:11], s24 offen sc0
  s_mov_b64 exec, -1
  s_branch mp_45b
mp_45a:
  buffer_load_dword v61, v62, s[8:11], s24 offen sc1
mp_45b:
  s_waitcnt vmcnt(0)
  v_cmp_eq_u32 vcc, -1, v61
  s_cbranch_vccnz wp_pr
wp_pf:
  s_add_u32 s22, s24, 4096
  buffer_load_dwordx4 v[64:67], v2, s[8:11], s24 offen offset:0 sc1
  buffer_load_dwordx4 v[68:71], v2, s[8:11], s24 offen offset:1024 sc1
  buffer_load_dwordx4 v[72:75], v2, s[8:11], s24 offen offset:2048 sc1
  buffer_load_dwordx4 v[76:79], v2, s[8:11], s24 offen offset:3072 sc1
  buffer_load_dwordx4 v[80:83], v2, s[8:11], s22 offen offset:0 sc1
  buffer_load_dwordx4 v[84:87], v2, s[8:11], s22 offen offset:1024 sc1
  buffer_load_dwordx4 v[88:91], v2, s[8:11], s22 offen offset:2048 sc1
  s_waitcnt vmcnt(0)
  v_max_u32 v61, v64, v65
  v_max3_u32 v61, v61, v66, v67
  v_max3_u32 v61, v61, v68, v69
  v_max3_u32 v61, v61, v70, v71
  v_max3_u32 v61, v61, v72, v73
  v_max3_u32 v61, v61, v74, v75
  v_max3_u32 v61, v61, v76, v77
  v_max3_u32 v61, v61, v78, v79
  v_max3_u32 v61, v61, v80, v81
  v_max3_u32 v61, v61, v82, v83
  v_max3_u32 v61, v61, v84, v85
  v_max3_u32 v61, v61, v86, v87
  v_max3_u32 v61, v61, v88, v89
  v_max3_u32 v61, v61, v90, v91
  v_cmp_eq_u32 vcc, -1, v61
  s_cbranch_vccz wp_pk
wp_pr:
  s_sleep 1
  s_cmp_ge_u32 s17, 61
  s_cbranch_scc1 wp_pm_bo
  s_sleep 4
  s_cmp_ge_u32 s17, 56
  s_cbranch_scc1 wp_pm_bo
  s_sleep 40
wp_pm_bo:
  s_add_u32 s30, s30, 1
  s_cmp_lt_u32 s30, 30000
  s_cbranch_scc1 wp_pm
  s_branch wp_abort
wp_pk:
  s_cmp_lt_u32 s17, 56
  s_cbranch_scc1 pk_46
  buffer_load_dword v250, v251, s[12:15], 0 offen sc1
pk_46:
  v_mfma_f32_16x16x32_bf16 v[20:23], v[64:67], a[0:3], 0
  v_mfma_f32_16x16x32_bf16 v[24:27], v[64:67], a[4:7], 0
  v_mfma_f32_16x16x32_bf16 v[28:31], v[64:67], a[56:59], 0
  v_mfma_f32_16x16x32_bf16 v[32:35], v[64:67], a[60:63], 0
  v_mfma_f32_16x16x32_bf16 v[20:23], v[68:71], a[8:11], v[20:23]
  v_mfma_f32_16x16x32_bf16 v[24:27], v[68:71], a[12:15], v[24:27]
  v_mfma_f32_16x16x32_bf16 v[28:31], v[68:71], a[64:67], v[28:31]
  v_mfma_f32_16x16x32_bf16 v[32:35], v[68:71], a[68:71], v[32:35]
  v_mfma_f32_16x16x32_bf16 v[20:23], v[72:75], a[16:19], v[20:23]
  v_mfma_f32_16x16x32_bf16 v[24:27], v[72:75], a[20:23], v[24:27]
  v_mfma_f32_16x16x32_bf16 v[28:31], v[72:75], a[72:75], v[28:31]
  v_mfma_f32_16x16x32_bf16 v[32:35], v[72:75], a[76:79], v[32:35]
  v_mfma_f32_16x16x32_bf16 v[20:23], v[76:79], a[24:27], v[20:23]
  v_mfma_f32_16x16x32_bf16 v[24:27], v[76:79], a[28:31], v[24:27]
  v_mfma_f32_16x16x32_bf16 v[28:31], v[76:79], a[80:83], v[28:31]
  v_mfma_f32_16x16x32_bf16 v[32:35], v[76:79], a[84:87], v[32:35]
  v_mfma_f32_16x16x32_bf16 v[20:23], v[80:83], a[32:35], v[20:23]
  v_mfma_f32_16x16x32_bf16 v[24:27], v[80:83], a[36:39], v[24:27]
  v_mfma_f32_16x16x32_bf16 v[28:31], v[80:83], a[88:91], v[28:31]
  v_mfma_f32_16x16x32_bf16 v[32:35], v[80:83], a[92:95], v[32:35]
  v_mfma_f32_16x16x32_bf16 v[20:23], v[84:87], a[40:43], v[20:23]
  v_mfma_f32_16x16x32_bf16 v[24:27], v[84:87], a[44:47], v[24:27]
  v_mfma_f32_16x16x32_bf16 v[28:31], v[84:87], a[96:99], v[28:31]
  v_mfma_f32_16x16x32_bf16 v[32:35], v[84:87], a[100:103], v[32:35]
  v_mfma_f32_16x16x32_bf16 v[20:23], v[88:91], a[48:51], v[20:23]
  v_mfma_f32_16x16x32_bf16 v[24:27], v[88:91], a[52:55], v[24:27]
  v_mfma_f32_16x16x32_bf16 v[28:31], v[88:91], a[104:107], v[28:31]
  v_mfma_f32_16x16x32_bf16 v[32:35], v[88:91], a[108:111], v[32:35]
  s_lshl_b32 s25, s17, 1
  s_mul_i32 s25, s25, 20480
  s_add_u32 s25, s25, 85458944
  s_lshl_b32 s26, s20, 10
  s_add_u32 s26, s26, s25
  s_lshl_b32 s27, s18, 10
  s_add_u32 s27, s27, s25
  s_lshr_b32 s28, s16, 1
  s_lshl_b32 s28, s28, 3
  s_add_u32 s27, s27, s28
  s_add_u32 s27, s27, 16384
  s_and_b32 s28, s16, 1
  s_cmp_eq_u32 s28, 0
  s_cselect_b32 s50, -1, 0
  s_cselect_b32 s51, 0, -1
  v_cndmask_b32 v8, v6, v8, s[40:41]
  v_cndmask_b32 v9, v6, v9, s[42:43]
  v_cndmask_b32 v10, v6, v10, s[44:45]
  v_cndmask_b32 v11, v6, v11, s[46:47]
  v_cndmask_b32 v20, v24, v20, s[48:49]
  v_cndmask_b32 v21, v25, v21, s[48:49]
  v_cndmask_b32 v22, v26, v22, s[48:49]
  v_cndmask_b32 v23, v27, v23, s[48:49]
  v_mov_b32 v24, v20
  v_mov_b32 v25, v21
  v_mov_b32 v26, v22
  v_mov_b32 v27, v23
  v_permlane32_swap_b32 v20, v24
  v_permlane32_swap_b32 v21, v25
  v_permlane32_swap_b32 v22, v26
  v_permlane32_swap_b32 v23, v27
  v_add_f32 v20, v20, v24
  v_add_f32 v21, v21, v25
  v_add_f32 v22, v22, v26
  v_add_f32 v23, v23, v27
  v_max3_f32 v40, v8, v9, v10
  v_max3_f32 v40, v40, v11, v20
  v_max3_f32 v40, v40, v21, v22
  v_max_f32 v40, v40, v23
  v_mov_b32 v41, v40
  s_nop 1
  v_permlane16_swap_b32 v40, v41
  v_max_f32 v40, v40, v41
  v_mov_b32 v41, v40
  s_nop 1
  v_permlane32_swap_b32 v40, v41
  v_max_f32 v40, v40, v41
  v_sub_f32 v8, v8, v40
  v_sub_f32 v9, v9, v40
  v_sub_f32 v10, v10, v40
  v_sub_f32 v11, v11, v40
  v_sub_f32 v20, v20, v40
  v_sub_f32 v21, v21, v40
  v_sub_f32 v22, v22, v40
  v_sub_f32 v23, v23, v40
  v_exp_f32 v8, v8
  v_exp_f32 v9, v9
  v_exp_f32 v10, v10
  v_exp_f32 v11, v11
  v_exp_f32 v20, v20
  v_exp_f32 v21, v21
  v_exp_f32 v22, v22
  v_exp_f32 v23, v23
  v_add_f32 v42, v20, v21
  v_add_f32 v43, v22, v23
  v_add_f32 v42, v42, v43
  v_mul_f32 v42, 0.5, v42
  v_add_f32 v42, v42, v8
  v_add_f32 v42, v42, v9
  v_add_f32 v42, v42, v10
  v_add_f32 v42, v42, v11
  v_mov_b32 v41, v42
  s_nop 1
  v_permlane16_swap_b32 v42, v41
  v_add_f32 v42, v42, v41
  v_mov_b32 v41, v42
  s_nop 1
  v_permlane32_swap_b32 v42, v41
  v_add_f32 v42, v42, v41
  v_rcp_f32 v42, v42
  s_nop 0
  v_mul_f32 v8, v8, v42
  v_mul_f32 v9, v9, v42
  v_mul_f32 v10, v10, v42
  v_mul_f32 v11, v11, v42
  v_mul_f32 v20, v20, v42
  v_mul_f32 v21, v21, v42
  v_mul_f32 v22, v22, v42
  v_mul_f32 v23, v23, v42
  v_cvt_pk_bf16_f32 v44, v8, v9
  v_cvt_pk_bf16_f32 v45, v10, v11
  v_mov_b32 v46, 0
  v_mov_b32 v47, 0
  v_cvt_pk_bf16_f32 v48, v20, v21
  v_cvt_pk_bf16_f32 v49, v22, v23
  v_min_u32 v44, -2, v44
  v_min_u32 v45, -2, v45
  v_min_u32 v46, -2, v46
  v_min_u32 v47, -2, v47
  v_min_u32 v48, -2, v48
  v_min_u32 v49, -2, v49
  buffer_store_dwordx4 v[44:47], v2, s[8:11], s26 offen sc1
  s_mov_b64 exec, s[50:51]
  buffer_store_dwordx2 v[48:49], v2, s[8:11], s27 offen sc1
  s_mov_b64 exec, -1
  s_add_u32 s26, s26, 20480
  s_add_u32 s27, s27, 20480
  v_cndmask_b32 v16, v6, v16, s[40:41]
  v_cndmask_b32 v17, v6, v17, s[42:43]
  v_cndmask_b32 v18, v6, v18, s[44:45]
  v_cndmask_b32 v19, v6, v19, s[46:47]
  v_cndmask_b32 v28, v32, v28, s[48:49]
  v_cndmask_b32 v29, v33, v29, s[48:49]
  v_cndmask_b32 v30, v34, v30, s[48:49]
  v_cndmask_b32 v31, v35, v31, s[48:49]
  v_mov_b32 v32, v28
  v_mov_b32 v33, v29
  v_mov_b32 v34, v30
  v_mov_b32 v35, v31
  v_permlane32_swap_b32 v28, v32
  v_permlane32_swap_b32 v29, v33
  v_permlane32_swap_b32 v30, v34
  v_permlane32_swap_b32 v31, v35
  v_add_f32 v28, v28, v32
  v_add_f32 v29, v29, v33
  v_add_f32 v30, v30, v34
  v_add_f32 v31, v31, v35
  v_max3_f32 v40, v12, v13, v14
  v_max3_f32 v40, v40, v15, v16
  v_max3_f32 v40, v40, v17, v18
  v_max3_f32 v40, v40, v19, v28
  v_max3_f32 v40, v40, v29, v30
  v_max_f32 v40, v40, v31
  v_mov_b32 v41, v40
  s_nop 1
  v_permlane16_swap_b32 v40, v41
  v_max_f32 v40, v40, v41
  v_mov_b32 v41, v40
  s_nop 1
  v_permlane32_swap_b32 v40, v41
  v_max_f32 v40, v40, v41
  v_sub_f32 v12, v12, v40
  v_sub_f32 v13, v13, v40
  v_sub_f32 v14, v14, v40
  v_sub_f32 v15, v15, v40
  v_sub_f32 v16, v16, v40
  v_sub_f32 v17, v17, v40
  v_sub_f32 v18, v18, v40
  v_sub_f32 v19, v19, v40
  v_sub_f32 v28, v28, v40
  v_sub_f32 v29, v29, v40
  v_sub_f32 v30, v30, v40
  v_sub_f32 v31, v31, v40
  v_exp_f32 v12, v12
  v_exp_f32 v13, v13
  v_exp_f32 v14, v14
  v_exp_f32 v15, v15
  v_exp_f32 v16, v16
  v_exp_f32 v17, v17
  v_exp_f32 v18, v18
  v_exp_f32 v19, v19
  v_exp_f32 v28, v28
  v_exp_f32 v29, v29
  v_exp_f32 v30, v30
  v_exp_f32 v31, v31
  v_add_f32 v42, v28, v29
  v_add_f32 v43, v30, v31
  v_add_f32 v42, v42, v43
  v_mul_f32 v42, 0.5, v42
  v_add_f32 v42, v42, v12
  v_add_f32 v42, v42, v13
  v_add_f32 v42, v42, v14
  v_add_f32 v42, v42, v15
  v_add_f32 v42, v42, v16
  v_add_f32 v42, v42, v17
  v_add_f32 v42, v42, v18
  v_add_f32 v42, v42, v19
  v_mov_b32 v41, v42
  s_nop 1
  v_permlane16_swap_b32 v42, v41
  v_add_f32 v42, v42, v41
  v_mov_b32 v41, v42
  s_nop 1
  v_permlane32_swap_b32 v42, v41
  v_add_f32 v42, v42, v41
  v_rcp_f32 v42, v42
  s_nop 0
  v_mul_f32 v12, v12, v42
  v_mul_f32 v13, v13, v42
  v_mul_f32 v14, v14, v42
  v_mul_f32 v15, v15, v42
  v_mul_f32 v16, v16, v42
  v_mul_f32 v17, v17, v42
  v_mul_f32 v18, v18, v42
  v_mul_f32 v19, v19, v42
  v_mul_f32 v28, v28, v42
  v_mul_f32 v29, v29, v42
  v_mul_f32 v30, v30, v42
  v_mul_f32 v31, v31, v42
  v_cvt_pk_bf16_f32 v52, v12, v13
  v_cvt_pk_bf16_f32 v53, v14, v15
  v_cvt_pk_bf16_f32 v54, v16, v17
  v_cvt_pk_bf16_f32 v55, v18, v19
  v_cvt_pk_bf16_f32 v56, v28, v29
  v_cvt_pk_bf16_f32 v57, v30, v31
  v_min_u32 v52, -2, v52
  v_min_u32 v53, -2, v53
  v_min_u32 v54, -2, v54
  v_min_u32 v55, -2, v55
  v_min_u32 v56, -2, v56
  v_min_u32 v57, -2, v57
  buffer_store_dwordx4 v[52:55], v2, s[8:11], s26 offen sc1
  s_mov_b64 exec, s[50:51]
  buffer_store_dwordx2 v[56:57], v2, s[8:11], s27 offen sc1
  s_mov_b64 exec, -1
  s_lshl_b32 s25, s17, 7
  s_add_u32 s25, s25, 88573952
  v_mov_b32 v5, 1
  v_mov_b32 v6, 0
  s_waitcnt vmcnt(0)
  s_mov_b64 exec, 1
  buffer_atomic_add v5, v6, s[8:11], s25 offen
  s_mov_b64 exec, -1
  s_branch wk_loop
wk_toko:
  s_lshl_b32 s20, s18, 2
  s_add_u32 s20, s20, s16
  s_mul_i32 s24, s20, 65
  s_add_u32 s24, s24, s17
  s_lshl_b32 s24, s24, 13
  s_add_u32 s24, s24, 76947456
  s_lshl_b32 s21, s20, 6
  s_add_u32 s21, s21, s17
  s_mul_i32 s21, s21, 28672
  s_add_u32 s21, s21, 42205184
  s_lshl_b32 s25, s17, 1
  s_mul_i32 s25, s25, 20480
  s_add_u32 s25, s25, 85458944
  v_lshrrev_b32 v8, 5, v1
  v_and_b32 v9, 31, v1
  v_lshrrev_b32 v10, 4, v9
  v_min_u32 v5, 27, v9
  v_and_b32 v5, 15, v5
  v_lshlrev_b32 v6, 1, v10
  v_sub_u32 v6, 8, v6
  v_lshlrev_b32 v7, 10, v10
  v_lshl_add_u32 v7, v5, 4, v7
  v_lshlrev_b32 v6, 5, v6
  v_mad_u32_u24 v5, v8, v6, v7
  v_lshl_add_u32 v63, v6, 1, v5
  v_lshl_add_u32 v7, v8, 3, v7
  v_mul_u32_u24 v6, 20480, v10
  v_lshl_add_u32 v6, v8, 8, v6
  v_lshl_add_u32 v6, v4, 4, v6
  s_lshr_b32 s26, s17, 3
  s_lshl_b32 s26, s26, 4
  s_add_u32 s26, s26, s20
  s_lshl_b32 s26, s26, 7
  s_add_u32 s26, s26, 88541184
  v_mov_b32 v60, 0
  s_mov_b32 s30, 0
wo_wv:
  buffer_load_dword v61, v60, s[8:11], s26 offen sc1
  s_waitcnt vmcnt(0)
  v_cmp_ne_u32 vcc, 56, v61
  s_cbranch_vccz wo_wv_ok
  s_sleep 1
  s_cmp_ge_u32 s17, 61
  s_cbranch_scc1 wo_wv_bo
  s_sleep 4
  s_cmp_ge_u32 s17, 56
  s_cbranch_scc1 wo_wv_bo
  s_sleep 40
wo_wv_bo:
  s_add_u32 s30, s30, 1
  s_cmp_lt_u32 s30, 30000
  s_cbranch_scc1 wo_wv
  s_branch wo_abort
wo_wv_ok:
  s_add_u32 s22, s21, 0
  buffer_load_dwordx4 a[0:3], v5, s[8:11], s22 offen offset:0 sc1
  buffer_load_dwordx4 a[4:7], v63, s[8:11], s22 offen offset:0 sc1
  buffer_load_dwordx4 a[8:11], v5, s[8:11], s22 offen offset:1792 sc1
  buffer_load_dwordx4 a[12:15], v63, s[8:11], s22 offen offset:1792 sc1
  s_add_u32 s22, s21, 3584
  buffer_load_dwordx4 a[16:19], v5, s[8:11], s22 offen offset:0 sc1
  buffer_load_dwordx4 a[20:23], v63, s[8:11], s22 offen offset:0 sc1
  buffer_load_dwordx4 a[24:27], v5, s[8:11], s22 offen offset:1792 sc1
  buffer_load_dwordx4 a[28:31], v63, s[8:11], s22 offen offset:1792 sc1
  s_add_u32 s22, s21, 7168
  buffer_load_dwordx4 a[32:35], v5, s[8:11], s22 offen offset:0 sc1
  buffer_load_dwordx4 a[36:39], v63, s[8:11], s22 offen offset:0 sc1
  buffer_load_dwordx4 a[40:43], v5, s[8:11], s22 offen offset:1792 sc1
  buffer_load_dwordx4 a[44:47], v63, s[8:11], s22 offen offset:1792 sc1
  s_add_u32 s22, s21, 10752
  buffer_load_dwordx4 a[48:51], v5, s[8:11], s22 offen offset:0 sc1
  buffer_load_dwordx4 a[52:55], v63, s[8:11], s22 offen offset:0 sc1
  buffer_load_dwordx4 a[56:59], v5, s[8:11], s22 offen offset:1792 sc1
  buffer_load_dwordx4 a[60:63], v63, s[8:11], s22 offen offset:1792 sc1
  s_add_u32 s22, s21, 14336
  buffer_load_dwordx4 a[64:67], v5, s[8:11], s22 offen offset:0 sc1
  buffer_load_dwordx4 a[68:71], v63, s[8:11], s22 offen offset:0 sc1
  buffer_load_dwordx4 a[72:75], v5, s[8:11], s22 offen offset:1792 sc1
  buffer_load_dwordx4 a[76:79], v63, s[8:11], s22 offen offset:1792 sc1
  s_add_u32 s22, s21, 17920
  buffer_load_dwordx4 a[80:83], v5, s[8:11], s22 offen offset:0 sc1
  buffer_load_dwordx4 a[84:87], v63, s[8:11], s22 offen offset:0 sc1
  buffer_load_dwordx4 a[88:91], v5, s[8:11], s22 offen offset:1792 sc1
  buffer_load_dwordx4 a[92:95], v63, s[8:11], s22 offen offset:1792 sc1
  s_add_u32 s22, s21, 21504
  buffer_load_dwordx4 a[96:99], v5, s[8:11], s22 offen offset:0 sc1
  buffer_load_dwordx4 a[100:103], v63, s[8:11], s22 offen offset:0 sc1
  buffer_load_dwordx4 a[104:107], v5, s[8:11], s22 offen offset:1792 sc1
  buffer_load_dwordx4 a[108:111], v63, s[8:11], s22 offen offset:1792 sc1
  s_add_u32 s22, s21, 25088
  buffer_load_dwordx4 a[112:115], v5, s[8:11], s22 offen offset:0 sc1
  buffer_load_dwordx4 a[116:119], v63, s[8:11], s22 offen offset:0 sc1
  buffer_load_dwordx4 a[120:123], v5, s[8:11], s22 offen offset:1792 sc1
  buffer_load_dwordx4 a[124:127], v63, s[8:11], s22 offen offset:1792 sc1
  s_cmp_ge_u32 s17, 61
  s_cbranch_scc1 wo_lm
  s_lshl_b32 s26, s17, 7
  s_add_u32 s26, s26, 88573952
  v_mov_b32 v60, 0
  s_mov_b32 s30, 0
wo_wp:
  buffer_load_dword v61, v60, s[8:11], s26 offen sc1
  s_waitcnt vmcnt(0)
  v_cmp_ne_u32 vcc, 16, v61
  s_cbranch_vccz wo_wp_ok
  s_sleep 2
  s_cmp_ge_u32 s17, 61
  s_cbranch_scc1 wo_wp_bo
  s_sleep 4
  s_cmp_ge_u32 s17, 56
  s_cbranch_scc1 wo_wp_bo
  s_sleep 40
wo_wp_bo:
  s_add_u32 s30, s30, 1
  s_cmp_lt_u32 s30, 30000
  s_cbranch_scc1 wo_wp
  s_branch wo_abort
wo_wp_ok:
  s_branch wo_lp
wo_lm:
  s_mul_i32 s26, s17, 7168
  s_add_u32 s26, s26, 88080384
  v_mov_b32 v60, 0
  s_mov_b32 s30, 0
wo_wm:
  buffer_load_dword v61, v60, s[8:11], s26 offen sc1
  s_waitcnt vmcnt(0)
  v_cmp_eq_u32 vcc, -1, v61
  s_cbranch_vccz wo_wm_ok
  s_sleep 2
  s_cmp_ge_u32 s17, 61
  s_cbranch_scc1 wo_wm_bo
  s_sleep 4
  s_cmp_ge_u32 s17, 56
  s_cbranch_scc1 wo_wm_bo
  s_sleep 40
wo_wm_bo:
  s_add_u32 s30, s30, 1
  s_cmp_lt_u32 s30, 30000
  s_cbranch_scc1 wo_wm
  s_branch wo_abort
wo_wm_ok:
wo_lp:
  s_mul_i32 s26, s16, 10240
  s_add_u32 s27, s25, s26
  v_add_u32 v11, s26, v2
  s_lshl_b32 s26, s20, 6
  s_add_u32 s26, s26, s17
  s_lshl_b32 s26, s26, 4
  s_add_u32 s26, s26, 88582144
  v_lshlrev_b32 v60, 2, v3
  s_mov_b32 s30, 0
wo_pl:
  s_add_u32 s22, s27, 0
  buffer_load_dwordx4 v[128:131], v2, s[8:11], s22 offen offset:0 sc1
  buffer_load_dwordx4 v[132:135], v2, s[8:11], s22 offen offset:1024 sc1
  buffer_load_dwordx4 v[136:139], v2, s[8:11], s22 offen offset:2048 sc1
  buffer_load_dwordx4 v[140:143], v2, s[8:11], s22 offen offset:3072 sc1
  s_add_u32 s22, s27, 4096
  buffer_load_dwordx4 v[144:147], v2, s[8:11], s22 offen offset:0 sc1
  buffer_load_dwordx4 v[148:151], v2, s[8:11], s22 offen offset:1024 sc1
  buffer_load_dwordx4 v[152:155], v2, s[8:11], s22 offen offset:2048 sc1
  buffer_load_dwordx4 v[156:159], v2, s[8:11], s22 offen offset:3072 sc1
  s_add_u32 s22, s27, 8192
  buffer_load_dwordx4 v[160:163], v2, s[8:11], s22 offen offset:0 sc1
  buffer_load_dwordx4 v[164:167], v2, s[8:11], s22 offen offset:1024 sc1
  buffer_load_dword v61, v60, s[8:11], s26 offen sc1
  s_waitcnt vmcnt(1)
  v_max_u32 v62, v128, v129
  v_max3_u32 v62, v62, v130, v131
  v_max3_u32 v62, v62, v132, v133
  v_max3_u32 v62, v62, v134, v135
  v_max3_u32 v62, v62, v136, v137
  v_max3_u32 v62, v62, v138, v139
  v_max3_u32 v62, v62, v140, v141
  v_max3_u32 v62, v62, v142, v143
  v_max3_u32 v62, v62, v144, v145
  v_max3_u32 v62, v62, v146, v147
  v_max3_u32 v62, v62, v148, v149
  v_max3_u32 v62, v62, v150, v151
  v_max3_u32 v62, v62, v152, v153
  v_max3_u32 v62, v62, v154, v155
  v_max3_u32 v62, v62, v156, v157
  v_max3_u32 v62, v62, v158, v159
  v_max3_u32 v62, v62, v160, v161
  v_max3_u32 v62, v62, v162, v163
  v_max3_u32 v62, v62, v164, v165
  v_max3_u32 v62, v62, v166, v167
  v_cmp_eq_u32 vcc, -1, v62
  s_cbranch_vccz wo_pk
  s_add_u32 s30, s30, 1
  s_cmp_lt_u32 s30, 30000
  s_cbranch_scc1 wo_pl
  s_branch wo_abort
wo_pk:
  ds_write_b128 v11, v[128:131] offset:0
  ds_write_b128 v11, v[132:135] offset:1024
  ds_write_b128 v11, v[136:139] offset:2048
  ds_write_b128 v11, v[140:143] offset:3072
  ds_write_b128 v11, v[144:147] offset:4096
  ds_write_b128 v11, v[148:151] offset:5120
  ds_write_b128 v11, v[152:155] offset:6144
  ds_write_b128 v11, v[156:159] offset:7168
  ds_write_b128 v11, v[160:163] offset:8192
  ds_write_b128 v11, v[164:167] offset:9216
  s_waitcnt vmcnt(0)
  v_cmp_ne_u32 vcc, 1, v61
  s_mov_b32 s28, 0
  s_cbranch_vccnz wo_nt
  s_add_u32 s22, s24, 0
  buffer_load_dwordx2 v[28:29], v7, s[8:11], s22 offen offset:0 sc1
  buffer_load_dwordx2 v[30:31], v7, s[8:11], s22 offen offset:512 sc1
  buffer_load_dwordx2 v[32:33], v7, s[8:11], s22 offen offset:256 sc1
  buffer_load_dwordx2 v[34:35], v7, s[8:11], s22 offen offset:768 sc1
  buffer_load_dwordx2 v[36:37], v7, s[8:11], s22 offen offset:2048 sc1
  buffer_load_dwordx2 v[38:39], v7, s[8:11], s22 offen offset:2560 sc1
  buffer_load_dwordx2 v[40:41], v7, s[8:11], s22 offen offset:2304 sc1
  buffer_load_dwordx2 v[42:43], v7, s[8:11], s22 offen offset:2816 sc1
  s_add_u32 s22, s24, 4096
  buffer_load_dwordx2 v[44:45], v7, s[8:11], s22 offen offset:0 sc1
  buffer_load_dwordx2 v[46:47], v7, s[8:11], s22 offen offset:512 sc1
  buffer_load_dwordx2 v[48:49], v7, s[8:11], s22 offen offset:256 sc1
  buffer_load_dwordx2 v[50:51], v7, s[8:11], s22 offen offset:768 sc1
  buffer_load_dwordx2 v[52:53], v7, s[8:11], s22 offen offset:2048 sc1
  buffer_load_dwordx2 v[54:55], v7, s[8:11], s22 offen offset:2560 sc1
  buffer_load_dwordx2 v[56:57], v7, s[8:11], s22 offen offset:2304 sc1
  buffer_load_dwordx2 v[58:59], v7, s[8:11], s22 offen offset:2816 sc1
  s_mov_b32 s28, 1
wo_nt:
  s_cmp_lt_u32 s17, 56
  s_cbranch_scc1 pk_47
  buffer_load_dword v250, v251, s[12:15], 0 offen sc1
pk_47:
  s_waitcnt lgkmcnt(0)
  s_barrier
  buffer_load_dword v61, v60, s[8:11], s26 offen sc1
  ds_read_b128 v[64:67], v6 offset:0
  ds_read_b128 v[68:71], v6 offset:512
  ds_read_b128 v[72:75], v6 offset:1024
  ds_read_b128 v[76:79], v6 offset:1536
  ds_read_b128 v[80:83], v6 offset:2048
  ds_read_b128 v[84:87], v6 offset:2560
  ds_read_b128 v[88:91], v6 offset:3072
  s_waitcnt lgkmcnt(6)
  v_mfma_f32_32x32x16_bf16 v[12:27], a[0:3], v[64:67], 0
  ds_read_b128 v[92:95], v6 offset:3584
  s_waitcnt lgkmcnt(6)
  v_mfma_f32_32x32x16_bf16 v[12:27], a[4:7], v[68:71], v[12:27]
  ds_read_b128 v[64:67], v6 offset:4096
  s_waitcnt lgkmcnt(6)
  v_mfma_f32_32x32x16_bf16 v[12:27], a[8:11], v[72:75], v[12:27]
  ds_read_b128 v[68:71], v6 offset:4608
  s_waitcnt lgkmcnt(6)
  v_mfma_f32_32x32x16_bf16 v[12:27], a[12:15], v[76:79], v[12:27]
  ds_read_b128 v[72:75], v6 offset:5120
  s_waitcnt lgkmcnt(6)
  v_mfma_f32_32x32x16_bf16 v[12:27], a[16:19], v[80:83], v[12:27]
  ds_read_b128 v[76:79], v6 offset:5632
  s_waitcnt lgkmcnt(6)
  v_mfma_f32_32x32x16_bf16 v[12:27], a[20:23], v[84:87], v[12:27]
  ds_read_b128 v[80:83], v6 offset:6144
  s_waitcnt lgkmcnt(6)
  v_mfma_f32_32x32x16_bf16 v[12:27], a[24:27], v[88:91], v[12:27]
  ds_read_b128 v[84:87], v6 offset:6656
  s_waitcnt lgkmcnt(6)
  v_mfma_f32_32x32x16_bf16 v[12:27], a[28:31], v[92:95], v[12:27]
  ds_read_b128 v[88:91], v6 offset:7168
  s_waitcnt lgkmcnt(6)
  v_mfma_f32_32x32x16_bf16 v[12:27], a[32:35], v[64:67], v[12:27]
  ds_read_b128 v[92:95], v6 offset:7680
  s_waitcnt lgkmcnt(6)
  v_mfma_f32_32x32x16_bf16 v[12:27], a[36:39], v[68:71], v[12:27]
  ds_read_b128 v[64:67], v6 offset:8192
  s_waitcnt lgkmcnt(6)
  v_mfma_f32_32x32x16_bf16 v[12:27], a[40:43], v[72:75], v[12:27]
  ds_read_b128 v[68:71], v6 offset:8704
  s_waitcnt lgkmcnt(6)
  v_mfma_f32_32x32x16_bf16 v[12:27], a[44:47], v[76:79], v[12:27]
  ds_read_b128 v[72:75], v6 offset:9216
  s_waitcnt lgkmcnt(6)
  v_mfma_f32_32x32x16_bf16 v[12:27], a[48:51], v[80:83], v[12:27]
  ds_read_b128 v[76:79], v6 offset:9728
  s_waitcnt lgkmcnt(6)
  v_mfma_f32_32x32x16_bf16 v[12:27], a[52:55], v[84:87], v[12:27]
  ds_read_b128 v[80:83], v6 offset:10240
  s_waitcnt lgkmcnt(6)
  v_mfma_f32_32x32x16_bf16 v[12:27], a[56:59], v[88:91], v[12:27]
  ds_read_b128 v[84:87], v6 offset:10752
  s_waitcnt lgkmcnt(6)
  v_mfma_f32_32x32x16_bf16 v[12:27], a[60:63], v[92:95], v[12:27]
  ds_read_b128 v[88:91], v6 offset:11264
  s_waitcnt lgkmcnt(6)
  v_mfma_f32_32x32x16_bf16 v[12:27], a[64:67], v[64:67], v[12:27]
  ds_read_b128 v[92:95], v6 offset:11776
  s_waitcnt lgkmcnt(6)
  v_mfma_f32_32x32x16_bf16 v[12:27], a[68:71], v[68:71], v[12:27]
  ds_read_b128 v[64:67], v6 offset:12288
  s_waitcnt lgkmcnt(6)
  v_mfma_f32_32x32x16_bf16 v[12:27], a[72:75], v[72:75], v[12:27]
  ds_read_b128 v[68:71], v6 offset:12800
  s_waitcnt lgkmcnt(6)
  v_mfma_f32_32x32x16_bf16 v[12:27], a[76:79], v[76:79], v[12:27]
  s_cmp_lg_u32 s28, 0
  s_cbranch_scc1 wo_h2
  s_waitcnt vmcnt(0)
  v_cmp_ne_u32 vcc, 1, v61
  s_cbranch_vccnz wo_h2
  s_add_u32 s22, s24, 0
  buffer_load_dwordx2 v[28:29], v7, s[8:11], s22 offen offset:0 sc1
  buffer_load_dwordx2 v[30:31], v7, s[8:11], s22 offen offset:512 sc1
  buffer_load_dwordx2 v[32:33], v7, s[8:11], s22 offen offset:256 sc1
  buffer_load_dwordx2 v[34:35], v7, s[8:11], s22 offen offset:768 sc1
  buffer_load_dwordx2 v[36:37], v7, s[8:11], s22 offen offset:2048 sc1
  buffer_load_dwordx2 v[38:39], v7, s[8:11], s22 offen offset:2560 sc1
  buffer_load_dwordx2 v[40:41], v7, s[8:11], s22 offen offset:2304 sc1
  buffer_load_dwordx2 v[42:43], v7, s[8:11], s22 offen offset:2816 sc1
  s_add_u32 s22, s24, 4096
  buffer_load_dwordx2 v[44:45], v7, s[8:11], s22 offen offset:0 sc1
  buffer_load_dwordx2 v[46:47], v7, s[8:11], s22 offen offset:512 sc1
  buffer_load_dwordx2 v[48:49], v7, s[8:11], s22 offen offset:256 sc1
  buffer_load_dwordx2 v[50:51], v7, s[8:11], s22 offen offset:768 sc1
  buffer_load_dwordx2 v[52:53], v7, s[8:11], s22 offen offset:2048 sc1
  buffer_load_dwordx2 v[54:55], v7, s[8:11], s22 offen offset:2560 sc1
  buffer_load_dwordx2 v[56:57], v7, s[8:11], s22 offen offset:2304 sc1
  buffer_load_dwordx2 v[58:59], v7, s[8:11], s22 offen offset:2816 sc1
  s_mov_b32 s28, 1
wo_h2:
  ds_read_b128 v[72:75], v6 offset:13312
  s_waitcnt lgkmcnt(6)
  v_mfma_f32_32x32x16_bf16 v[12:27], a[80:83], v[80:83], v[12:27]
  ds_read_b128 v[76:79], v6 offset:13824
  s_waitcnt lgkmcnt(6)
  v_mfma_f32_32x32x16_bf16 v[12:27], a[84:87], v[84:87], v[12:27]
  ds_read_b128 v[80:83], v6 offset:14336
  s_waitcnt lgkmcnt(6)
  v_mfma_f32_32x32x16_bf16 v[12:27], a[88:91], v[88:91], v[12:27]
  ds_read_b128 v[84:87], v6 offset:14848
  s_waitcnt lgkmcnt(6)
  v_mfma_f32_32x32x16_bf16 v[12:27], a[92:95], v[92:95], v[12:27]
  ds_read_b128 v[88:91], v6 offset:15360
  s_waitcnt lgkmcnt(6)
  v_mfma_f32_32x32x16_bf16 v[12:27], a[96:99], v[64:67], v[12:27]
  ds_read_b128 v[92:95], v6 offset:15872
  s_waitcnt lgkmcnt(6)
  v_mfma_f32_32x32x16_bf16 v[12:27], a[100:103], v[68:71], v[12:27]
  ds_read_b128 v[64:67], v6 offset:16384
  s_waitcnt lgkmcnt(6)
  v_mfma_f32_32x32x16_bf16 v[12:27], a[104:107], v[72:75], v[12:27]
  ds_read_b128 v[68:71], v6 offset:16896
  s_waitcnt lgkmcnt(6)
  v_mfma_f32_32x32x16_bf16 v[12:27], a[108:111], v[76:79], v[12:27]
  ds_read_b128 v[72:75], v6 offset:17408
  s_waitcnt lgkmcnt(6)
  v_mfma_f32_32x32x16_bf16 v[12:27], a[112:115], v[80:83], v[12:27]
  ds_read_b128 v[76:79], v6 offset:17920
  s_waitcnt lgkmcnt(6)
  v_mfma_f32_32x32x16_bf16 v[12:27], a[116:119], v[84:87], v[12:27]
  ds_read_b128 v[80:83], v6 offset:18432
  s_waitcnt lgkmcnt(6)
  v_mfma_f32_32x32x16_bf16 v[12:27], a[120:123], v[88:91], v[12:27]
  ds_read_b128 v[84:87], v6 offset:18944
  s_waitcnt lgkmcnt(6)
  v_mfma_f32_32x32x16_bf16 v[12:27], a[124:127], v[92:95], v[12:27]
  s_cmp_lg_u32 s28, 0
  s_cbranch_scc1 wo_ht
  v_lshlrev_b32 v60, 2, v3
  s_mov_b32 s30, 0
wo_wt:
  buffer_load_dword v61, v60, s[8:11], s26 offen sc1
  s_waitcnt vmcnt(0)
  v_cmp_ne_u32 vcc, 1, v61
  s_cbranch_vccz wo_wt_ok
  s_sleep 1
  s_cmp_ge_u32 s17, 61
  s_cbranch_scc1 wo_wt_bo
  s_sleep 4
  s_cmp_ge_u32 s17, 56
  s_cbranch_scc1 wo_wt_bo
  s_sleep 40
wo_wt_bo:
  s_add_u32 s30, s30, 1
  s_cmp_lt_u32 s30, 30000
  s_cbranch_scc1 wo_wt
  s_branch wo_abort
wo_wt_ok:
  s_add_u32 s22, s24, 0
  buffer_load_dwordx2 v[28:29], v7, s[8:11], s22 offen offset:0 sc1
  buffer_load_dwordx2 v[30:31], v7, s[8:11], s22 offen offset:512 sc1
  buffer_load_dwordx2 v[32:33], v7, s[8:11], s22 offen offset:256 sc1
  buffer_load_dwordx2 v[34:35], v7, s[8:11], s22 offen offset:768 sc1
  buffer_load_dwordx2 v[36:37], v7, s[8:11], s22 offen offset:2048 sc1
  buffer_load_dwordx2 v[38:39], v7, s[8:11], s22 offen offset:2560 sc1
  buffer_load_dwordx2 v[40:41], v7, s[8:11], s22 offen offset:2304 sc1
  buffer_load_dwordx2 v[42:43], v7, s[8:11], s22 offen offset:2816 sc1
  s_add_u32 s22, s24, 4096
  buffer_load_dwordx2 v[44:45], v7, s[8:11], s22 offen offset:0 sc1
  buffer_load_dwordx2 v[46:47], v7, s[8:11], s22 offen offset:512 sc1
  buffer_load_dwordx2 v[48:49], v7, s[8:11], s22 offen offset:256 sc1
  buffer_load_dwordx2 v[50:51], v7, s[8:11], s22 offen offset:768 sc1
  buffer_load_dwordx2 v[52:53], v7, s[8:11], s22 offen offset:2048 sc1
  buffer_load_dwordx2 v[54:55], v7, s[8:11], s22 offen offset:2560 sc1
  buffer_load_dwordx2 v[56:57], v7, s[8:11], s22 offen offset:2304 sc1
  buffer_load_dwordx2 v[58:59], v7, s[8:11], s22 offen offset:2816 sc1
wo_ht:
  ds_read_b128 v[88:91], v6 offset:19456
  s_waitcnt lgkmcnt(6) vmcnt(0)
  v_mfma_f32_32x32x16_bf16 v[12:27], v[28:31], v[64:67], v[12:27]
  ds_read_b128 v[92:95], v6 offset:19968
  s_waitcnt lgkmcnt(6)
  v_mfma_f32_32x32x16_bf16 v[12:27], v[32:35], v[68:71], v[12:27]
  s_waitcnt lgkmcnt(5)
  v_mfma_f32_32x32x16_bf16 v[12:27], v[36:39], v[72:75], v[12:27]
  s_waitcnt lgkmcnt(4)
  v_mfma_f32_32x32x16_bf16 v[12:27], v[40:43], v[76:79], v[12:27]
  s_waitcnt lgkmcnt(3)
  v_mfma_f32_32x32x16_bf16 v[12:27], v[44:47], v[80:83], v[12:27]
  s_waitcnt lgkmcnt(2)
  v_mfma_f32_32x32x16_bf16 v[12:27], v[48:51], v[84:87], v[12:27]
  s_waitcnt lgkmcnt(1)
  v_mfma_f32_32x32x16_bf16 v[12:27], v[52:55], v[88:91], v[12:27]
  s_waitcnt lgkmcnt(0)
  v_mfma_f32_32x32x16_bf16 v[12:27], v[56:59], v[92:95], v[12:27]
  v_mul_u32_u24 v9, 240, v9
  s_movk_i32 s23, 240
  v_lshl_add_u32 v8, v8, 3, v9
  s_mul_i32 s22, s16, 24
  v_add_u32 v7, s22, v8
  s_lshl_b32 s22, s16, 5
  v_add_u32 v8, s22, v8
  v_min_u32 v11, 223, v0
  v_mul_u32_u24 v9, 4682, v11
  v_lshrrev_b32 v9, 16, v9
  v_mul_u32_u24 v10, 14, v9
  v_sub_u32 v10, v11, v10
  v_cmp_gt_u32 vcc, 8, v10
  v_lshlrev_b32 v10, 4, v10
  v_mad_u32_u24 v11, v9, s23, v10
  v_mul_u32_u24 v9, 1792, v9
  v_add_u32 v10, v9, v10
  s_lshl_b32 s22, s18, 7
  s_mul_i32 s27, s18, 96
  s_add_u32 s27, s27, 384
  v_mov_b32 v9, s22
  v_mov_b32 v5, s27
  v_cndmask_b32 v9, v5, v9, vcc
  v_add_u32 v10, v9, v10
  s_mul_i32 s26, s17, 57344
  s_add_u32 s26, s26, 896
  s_add_u32 s27, s26, 28672
  v_cvt_pk_bf16_f32 v96, v12, v13
  v_cvt_pk_bf16_f32 v97, v14, v15
  ds_write_b64 v8, v[96:97] offset:49152
  v_cvt_pk_bf16_f32 v98, v16, v17
  v_cvt_pk_bf16_f32 v99, v18, v19
  ds_write_b64 v8, v[98:99] offset:49168
  v_cvt_pk_bf16_f32 v100, v20, v21
  v_cvt_pk_bf16_f32 v101, v22, v23
  ds_write_b64 v7, v[100:101] offset:49280
  v_cvt_pk_bf16_f32 v102, v24, v25
  v_cvt_pk_bf16_f32 v103, v26, v27
  s_mov_b32 exec_hi, 0
  ds_write_b64 v7, v[102:103] offset:49296
  s_mov_b64 exec, -1
  s_waitcnt lgkmcnt(0)
  s_barrier
  ds_read_b128 v[104:107], v11 offset:49152
  ds_read_b128 v[108:111], v11 offset:52992
  s_cmp_lg_u32 s16, 3
  s_cselect_b32 exec_hi, -1, 0
  s_waitcnt lgkmcnt(1)
  buffer_store_dwordx4 v[104:107], v10, s[92:95], s26 offen
  s_waitcnt lgkmcnt(0)
  buffer_store_dwordx4 v[108:111], v10, s[92:95], s27 offen
  s_mov_b64 exec, -1
  v_readfirstlane_b32 s22, v250
  s_cmp_ge_u32 s22, 1440
  s_cbranch_scc1 ch_end
  s_branch wk_loop
wp_abort:
wo_abort:
  s_branch cA_abort
ch_end:
  s_endpgm

.section .rodata,"a"
.p2align 6
.amdhsa_kernel main_kernel
  .amdhsa_next_free_vgpr 512
  .amdhsa_next_free_sgpr 102
  .amdhsa_accum_offset 256
  .amdhsa_group_segment_fixed_size 0
  .amdhsa_kernarg_size 136
  .amdhsa_user_sgpr_count 2
  .amdhsa_user_sgpr_kernarg_segment_ptr 1
  .amdhsa_system_sgpr_workgroup_id_x 1
.end_amdhsa_kernel
```

```asm
; @launch kernel=main_kernel grid=(256,1,1) block=(256,1,1) lds=163840
.amdgcn_target "amdgcn-amd-amdhsa--gfx950"
.text
.globl main_kernel
.p2align 8
.type main_kernel,@function
main_kernel:
  s_cmp_ge_u32 s2, 256
  s_cbranch_scc1 ch_end
  s_load_dwordx4 s[4:7], s[0:1], 120
  s_load_dwordx2 s[92:93], s[0:1], 112
  s_load_dwordx8 s[36:43], s[0:1], 56
  s_load_dwordx4 s[44:47], s[0:1], 88
  s_memrealtime s[88:89]
  s_getpc_b64 s[98:99]
pf_main_kernel_1:
  s_sub_u32 s98, s98, pf_main_kernel_1-main_kernel
  s_subb_u32 s99, s99, 0
  s_lshr_b32 s20, s2, 3
  v_lshl_add_u32 v60, v0, 5, s20
  v_lshlrev_b32 v60, 7, v60
  v_min_u32 v60, ch_end-main_kernel-4, v60
  v_cmp_gt_u32 vcc, 32, v0
  s_and_saveexec_b64 s[22:23], vcc
  s_cbranch_execz pf_main_kernel_1_n
  global_load_dword v62, v60, s[98:99]
pf_main_kernel_1_n:
  s_mov_b64 exec, -1
  s_getreg_b32 s67, hwreg(HW_REG_XCC_ID)
  s_and_b32 s67, s67, 7
  v_lshrrev_b32 v1, 6, v0
  s_nop 0
  v_readfirstlane_b32 s16, v1
  s_mov_b32 s66, 0
  s_mov_b32 s68, 0
  s_mov_b32 s69, 0
  s_mov_b32 s96, 0
  s_mov_b32 s97, 0
  s_mov_b32 s101, 0x5eed0000
  s_sub_u32 s20, s67, 0
  s_lshr_b32 s21, s2, 3
  s_and_b32 s20, s20, 7
  s_lshl_b32 s3, s20, 5
  s_add_u32 s3, s3, s21
  s_waitcnt lgkmcnt(0)
  s_mov_b32 s8, s6
  s_and_b32 s9, s7, 0xffff
  s_mov_b32 s10, 0x10000000
  s_mov_b32 s11, 0x20000
  s_mov_b32 s12, s4
  s_and_b32 s13, s5, 0xffff
  s_mov_b32 s14, 256
  s_mov_b32 s15, 0x20000
  s_or_b32 s88, s88, 1
  s_and_b32 s93, s93, 0xffff
  s_mov_b32 s94, 3670016
  s_mov_b32 s95, 0x20000
m_start:
  s_cmp_ge_u32 s3, 32
  s_cbranch_scc1 m_bjob
  v_and_b32 v1, 63, v0
  v_lshlrev_b32 v2, 4, v1
  v_lshrrev_b32 v116, 4, v1
  v_and_b32 v117, 15, v1
  v_mov_b32 v3, 0x4444
  v_mov_b32 v118, 0xeeee
  v_cmp_lt_u32 vcc, 7, v117
  s_nop 1
  v_cndmask_b32 v3, v3, v118, vcc
  s_and_b32 s17, s3, 15
  s_cmp_ge_u32 s3, 16
  s_cbranch_scc1 m_val
  s_mov_b32 s60, s42
  s_and_b32 s61, s43, 0xffff
  s_mov_b32 s62, 3670016
  s_mov_b32 s63, 0x20000
  v_lshrrev_b32 v24, 5, v1
  v_and_b32 v25, 31, v1
  s_lshl_b32 s26, s17, 9
  s_lshl_b32 s25, s16, 12
  v_xor_b32 v26, v25, v24
  v_lshlrev_b32 v26, 4, v26
  v_lshl_add_u32 v26, v24, 13, v26
  v_xor_b32 v100, 0, v26
  v_xor_b32 v101, 0, v26
  v_add_u32 v101, 15360, v101
  v_xor_b32 v102, 32, v26
  v_add_u32 v102, 30720, v102
  v_xor_b32 v103, 32, v26
  v_add_u32 v103, 46080, v103
  s_lshl_b32 s23, s16, 19
  s_add_u32 s23, s23, s26
  s_add_u32 m0, s25, 16384
  s_nop 0
  buffer_load_dwordx4 v100, s[60:63], s23 offen offset:0 lds
  buffer_load_dwordx4 v101, s[60:63], s23 offen offset:1024 lds
  buffer_load_dwordx4 v102, s[60:63], s23 offen offset:2048 lds
  buffer_load_dwordx4 v103, s[60:63], s23 offen offset:3072 lds
  s_add_u32 m0, s25, 32768
  s_add_u32 s23, s23, 65536
  buffer_load_dwordx4 v100, s[60:63], s23 offen offset:0 lds
  buffer_load_dwordx4 v101, s[60:63], s23 offen offset:1024 lds
  buffer_load_dwordx4 v102, s[60:63], s23 offen offset:2048 lds
  buffer_load_dwordx4 v103, s[60:63], s23 offen offset:3072 lds
  v_xor_b32 v100, 64, v100
  v_xor_b32 v101, 64, v101
  v_xor_b32 v102, 64, v102
  v_xor_b32 v103, 64, v103
  s_add_u32 m0, s25, 49152
  s_add_u32 s23, s23, 65536
  buffer_load_dwordx4 v100, s[60:63], s23 offen offset:0 lds
  buffer_load_dwordx4 v101, s[60:63], s23 offen offset:1024 lds
  buffer_load_dwordx4 v102, s[60:63], s23 offen offset:2048 lds
  buffer_load_dwordx4 v103, s[60:63], s23 offen offset:3072 lds
  s_add_u32 m0, s25, 65536
  s_add_u32 s23, s23, 65536
  buffer_load_dwordx4 v100, s[60:63], s23 offen offset:0 lds
  buffer_load_dwordx4 v101, s[60:63], s23 offen offset:1024 lds
  buffer_load_dwordx4 v102, s[60:63], s23 offen offset:2048 lds
  buffer_load_dwordx4 v103, s[60:63], s23 offen offset:3072 lds
  v_xor_b32 v100, 192, v100
  v_xor_b32 v101, 192, v101
  v_xor_b32 v102, 192, v102
  v_xor_b32 v103, 192, v103
  s_add_u32 m0, s25, 81920
  s_add_u32 s23, s23, 65536
  buffer_load_dwordx4 v100, s[60:63], s23 offen offset:0 lds
  buffer_load_dwordx4 v101, s[60:63], s23 offen offset:1024 lds
  buffer_load_dwordx4 v102, s[60:63], s23 offen offset:2048 lds
  buffer_load_dwordx4 v103, s[60:63], s23 offen offset:3072 lds
  s_add_u32 m0, s25, 98304
  s_add_u32 s23, s23, 65536
  buffer_load_dwordx4 v100, s[60:63], s23 offen offset:0 lds
  buffer_load_dwordx4 v101, s[60:63], s23 offen offset:1024 lds
  buffer_load_dwordx4 v102, s[60:63], s23 offen offset:2048 lds
  buffer_load_dwordx4 v103, s[60:63], s23 offen offset:3072 lds
  v_xor_b32 v100, 64, v100
  v_xor_b32 v101, 64, v101
  v_xor_b32 v102, 64, v102
  v_xor_b32 v103, 64, v103
  s_add_u32 m0, s25, 114688
  s_add_u32 s23, s23, 65536
  buffer_load_dwordx4 v100, s[60:63], s23 offen offset:0 lds
  buffer_load_dwordx4 v101, s[60:63], s23 offen offset:1024 lds
  buffer_load_dwordx4 v102, s[60:63], s23 offen offset:2048 lds
  buffer_load_dwordx4 v103, s[60:63], s23 offen offset:3072 lds
  s_add_u32 m0, s25, 131072
  s_add_u32 s23, s23, 65536
  buffer_load_dwordx4 v100, s[60:63], s23 offen offset:0 lds
  buffer_load_dwordx4 v101, s[60:63], s23 offen offset:1024 lds
  buffer_load_dwordx4 v102, s[60:63], s23 offen offset:2048 lds
  buffer_load_dwordx4 v103, s[60:63], s23 offen offset:3072 lds
  s_mov_b32 s56, s40
  s_and_b32 s57, s41, 0xffff
  s_mov_b32 s58, 3670016
  s_mov_b32 s59, 0x20000
  s_lshl_b32 s21, s16, 16
  s_add_u32 s27, s26, s21
  s_lshr_b32 s20, s16, 1
  s_lshl_b32 s20, s20, 6
  v_xor_b32 v26, s20, v26
  v_xor_b32 v4, 0, v26
  v_xor_b32 v5, 32, v26
  v_add_u32 v5, 15360, v5
  v_xor_b32 v6, 128, v26
  v_add_u32 v6, 30720, v6
  v_xor_b32 v7, 160, v26
  v_add_u32 v7, 46080, v7
  s_add_u32 s22, s27, 0
  s_add_u32 m0, s25, 0
  s_nop 0
  buffer_load_dwordx4 v4, s[56:59], s22 offen offset:0 lds
  buffer_load_dwordx4 v5, s[56:59], s22 offen offset:1024 lds
  buffer_load_dwordx4 v6, s[56:59], s22 offen offset:2048 lds
  buffer_load_dwordx4 v7, s[56:59], s22 offen offset:3072 lds
  s_cmp_lg_u32 s66, 0
  s_cbranch_scc1 sc_ci
  s_cmp_lg_u32 s16, 0
  s_cbranch_scc1 w0_2
  s_lshr_b32 s70, s3, 5
  s_and_b32 s71, s70, 4
  s_mul_i32 s71, s71, 12
  s_lshl_b32 s70, s70, 2
  s_add_u32 s70, s70, s71
  s_lshl_b32 s71, 1, s3
  v_mov_b32 v248, s71
  v_mov_b32 v249, 32
  s_mov_b64 exec, 1
  buffer_atomic_or v248, v249, s[12:15], s70 offen sc0
  buffer_load_dwordx2 v[250:251], v249, s[12:15], 0 offen offset:96 sc1
  s_mov_b64 exec, -1
w0_2:
sc_ci:
  v_and_b32 v26, 15, v25
  v_xor_b32 v27, v26, v24
  v_lshlrev_b32 v27, 4, v27
  v_bfe_u32 v28, v25, 2, 1
  v_lshlrev_b32 v28, 4, v28
  v_lshrrev_b32 v29, 3, v25
  v_lshl_add_u32 v28, v29, 2, v28
  v_and_b32 v29, 3, v25
  v_add_u32 v28, v28, v29
  v_lshl_add_u32 v28, v28, 9, v27
  v_lshrrev_b32 v29, 2, v26
  v_lshlrev_b32 v29, 15, v29
  v_bfe_u32 v30, v26, 1, 1
  v_lshl_add_u32 v29, v30, 11, v29
  v_lshrrev_b32 v30, 4, v25
  v_lshl_add_u32 v29, v30, 10, v29
  v_and_b32 v31, 1, v26
  v_lshl_add_u32 v29, v31, 9, v29
  v_add_u32 v29, v29, v27
  v_add_u32 v29, s25, v29
  v_xor_b32 v8, 0, v28
  v_xor_b32 v104, 0, v29
  v_xor_b32 v9, 32, v28
  v_xor_b32 v105, 32, v29
  v_xor_b32 v10, 64, v28
  v_xor_b32 v106, 64, v29
  v_xor_b32 v11, 96, v28
  v_xor_b32 v107, 96, v29
  v_xor_b32 v12, 128, v28
  v_xor_b32 v108, 128, v29
  v_xor_b32 v13, 160, v28
  v_xor_b32 v109, 160, v29
  v_xor_b32 v14, 192, v28
  v_xor_b32 v110, 192, v29
  v_xor_b32 v15, 224, v28
  v_xor_b32 v111, 224, v29
  s_mov_b32 s52, 1035512379
  s_waitcnt vmcnt(4)
  ds_read_b128 v[120:123], v104 offset:16384
  ds_read_b128 v[124:127], v105 offset:16384
  ds_read_b128 v[128:131], v106 offset:16384
  ds_read_b128 v[132:135], v107 offset:16384
  ds_read_b128 v[136:139], v108 offset:16384
  ds_read_b128 v[140:143], v109 offset:16384
  ds_read_b128 v[144:147], v110 offset:16384
  ds_read_b128 v[148:151], v111 offset:16384
  s_waitcnt lgkmcnt(4)
  ds_read_b128 v[152:155], v104 offset:16640
  ds_read_b128 v[156:159], v105 offset:16640
  ds_read_b128 v[160:163], v106 offset:16640
  ds_read_b128 v[164:167], v107 offset:16640
  ds_read_b128 v[168:171], v108 offset:16640
  ds_read_b128 v[172:175], v109 offset:16640
  ds_read_b128 v[176:179], v110 offset:16640
  ds_read_b128 v[180:183], v111 offset:16640
  s_waitcnt lgkmcnt(4)
  ds_read_b128 v[184:187], v104 offset:32768
  ds_read_b128 v[188:191], v105 offset:32768
  ds_read_b128 v[192:195], v106 offset:32768
  ds_read_b128 v[196:199], v107 offset:32768
  ds_read_b128 v[200:203], v108 offset:32768
  ds_read_b128 v[204:207], v109 offset:32768
  ds_read_b128 v[208:211], v110 offset:32768
  ds_read_b128 v[212:215], v111 offset:32768
  s_waitcnt lgkmcnt(4)
  ds_read_b128 v[216:219], v104 offset:33024
  ds_read_b128 v[220:223], v105 offset:33024
  ds_read_b128 v[224:227], v106 offset:33024
  ds_read_b128 v[228:231], v107 offset:33024
  ds_read_b128 v[232:235], v108 offset:33024
  ds_read_b128 v[236:239], v109 offset:33024
  ds_read_b128 v[240:243], v110 offset:33024
  ds_read_b128 v[244:247], v111 offset:33024
  s_waitcnt lgkmcnt(4)
  s_waitcnt lgkmcnt(0)
  s_add_u32 s22, s27, 262144
  s_add_u32 m0, s25, 16384
  s_nop 0
  buffer_load_dwordx4 v4, s[56:59], s22 offen offset:0 lds
  buffer_load_dwordx4 v5, s[56:59], s22 offen offset:1024 lds
  buffer_load_dwordx4 v6, s[56:59], s22 offen offset:2048 lds
  buffer_load_dwordx4 v7, s[56:59], s22 offen offset:3072 lds
  s_add_u32 s22, s27, 524288
  s_add_u32 m0, s25, 32768
  s_nop 0
  buffer_load_dwordx4 v4, s[56:59], s22 offen offset:0 lds
  buffer_load_dwordx4 v5, s[56:59], s22 offen offset:1024 lds
  buffer_load_dwordx4 v6, s[56:59], s22 offen offset:2048 lds
  buffer_load_dwordx4 v7, s[56:59], s22 offen offset:3072 lds
  s_add_u32 s22, s27, 786432
  s_add_u32 m0, s25, 49152
  s_nop 0
  buffer_load_dwordx4 v4, s[56:59], s22 offen offset:0 lds
  buffer_load_dwordx4 v5, s[56:59], s22 offen offset:1024 lds
  buffer_load_dwordx4 v6, s[56:59], s22 offen offset:2048 lds
  buffer_load_dwordx4 v7, s[56:59], s22 offen offset:3072 lds
  s_cmp_lg_u32 s66, 0
  s_cbranch_scc1 sc_cf
  s_cmp_lg_u32 s16, 0
  s_cbranch_scc1 w0_3
  s_waitcnt vmcnt(12)
  v_readfirstlane_b32 s70, v250
  s_cmp_lg_u32 s70, 0
  s_cbranch_scc1 sc_nz
  v_mov_b32 v249, 128
  v_mov_b32 v250, s88
  v_mov_b32 v251, s89
  v_mov_b32 v252, 0
  v_mov_b32 v253, 0
  s_mov_b64 exec, 1
  buffer_atomic_cmpswap_x2 v[250:253], v249, s[12:15], 0 offen sc0
  s_mov_b64 exec, -1
  s_waitcnt vmcnt(0)
  v_readfirstlane_b32 s70, v250
  s_cmp_lg_u32 s70, 0
  s_cbranch_scc1 sc_nz
  v_mov_b32 v250, s88
  v_mov_b32 v251, s89
sc_nz:
w0_3:
  v_mov_b32 v249, 160000
  s_add_u32 s101, s101, 1
  s_barrier
  s_mov_b64 exec, 1
  s_cmp_lg_u32 s16, 0
  s_cbranch_scc1 w0_4
  ds_write_b32 v249, v248 offset:0
  ds_write_b32 v249, v250 offset:4
  ds_write_b32 v249, v251 offset:8
  s_waitcnt lgkmcnt(0)
  v_mov_b32 v248, s101
  ds_write_b32 v249, v248 offset:16
  s_waitcnt lgkmcnt(0)
w0_4:
  s_mov_b64 exec, -1
  s_barrier
  ds_read_b32 v248, v249 offset:0
  ds_read_b32 v250, v249 offset:4
  ds_read_b32 v251, v249 offset:8
  ds_read_b32 v249, v249 offset:16
  s_waitcnt lgkmcnt(0)
  v_readfirstlane_b32 s70, v248
  v_readfirstlane_b32 s88, v250
  v_readfirstlane_b32 s89, v251
  v_cmp_ne_u32 vcc, s101, v249
  s_cbranch_vccnz ch_end
  s_mov_b32 s66, 1
  s_bitcmp1_b32 s70, s3
  s_cbranch_scc1 m_reclaim
sc_cf:
  s_cmp_lg_u32 s16, 0
  s_cbranch_scc1 w0_5
  s_cmp_eq_u32 s67, 0
  s_cselect_b32 s20, 1, 0x10001
  v_mov_b32 v248, s20
  v_mov_b32 v249, 0
  s_mov_b64 exec, 1
  buffer_atomic_add v248, v249, s[12:15], 0 offen
  s_mov_b64 exec, -1
w0_5:
  s_lshl_b32 s28, s17, 7
  s_add_u32 s28, s28, 88635392
  v_min_u32 v113, 96, v2
  s_mov_b32 s29, 88602624
  v_add_u32 v112, 1024, v2
  v_min_u32 v112, 1776, v112
  s_mul_i32 s32, s17, 401408
  s_mul_i32 s33, s16, 14336
  s_add_u32 s32, s32, s33
  s_add_u32 s33, s32, s33
  s_add_u32 s32, s32, 344064
  s_add_u32 s33, s33, 229376
  s_waitcnt vmcnt(8)
  s_barrier
  ds_read_b128 v[16:19], v8 offset:0
  ds_read_b128 v[20:23], v9 offset:0
  ds_read_b128 v[24:27], v10 offset:0
  ds_read_b128 v[28:31], v11 offset:0
  s_waitcnt lgkmcnt(3)
  v_mfma_f32_32x32x16_bf16 v[32:47], v[16:19], v[120:123], 0
  s_add_u32 s22, s27, 1048576
  s_add_u32 m0, s25, 65536
  s_nop 0
  buffer_load_dwordx4 v4, s[56:59], s22 offen offset:0 lds
  v_mfma_f32_32x32x16_bf16 v[48:63], v[16:19], v[184:187], 0
  ds_read_b128 v[16:19], v12 offset:0
  s_waitcnt lgkmcnt(3)
  v_mfma_f32_32x32x16_bf16 v[32:47], v[20:23], v[124:127], v[32:47]
  buffer_load_dwordx4 v5, s[56:59], s22 offen offset:1024 lds
  v_mfma_f32_32x32x16_bf16 v[48:63], v[20:23], v[188:191], v[48:63]
  ds_read_b128 v[20:23], v13 offset:0
  s_waitcnt lgkmcnt(3)
  v_mfma_f32_32x32x16_bf16 v[32:47], v[24:27], v[128:131], v[32:47]
  buffer_load_dwordx4 v6, s[56:59], s22 offen offset:2048 lds
  v_mfma_f32_32x32x16_bf16 v[48:63], v[24:27], v[192:195], v[48:63]
  ds_read_b128 v[24:27], v14 offset:0
  s_waitcnt lgkmcnt(3)
  v_mfma_f32_32x32x16_bf16 v[32:47], v[28:31], v[132:135], v[32:47]
  buffer_load_dwordx4 v7, s[56:59], s22 offen offset:3072 lds
  v_mfma_f32_32x32x16_bf16 v[48:63], v[28:31], v[196:199], v[48:63]
  ds_read_b128 v[28:31], v15 offset:0
  s_waitcnt lgkmcnt(3)
  v_mfma_f32_32x32x16_bf16 v[32:47], v[16:19], v[136:139], v[32:47]
  s_add_u32 s22, s27, 1310720
  s_add_u32 m0, s25, 81920
  s_nop 0
  buffer_load_dwordx4 v4, s[56:59], s22 offen offset:0 lds
  v_mfma_f32_32x32x16_bf16 v[48:63], v[16:19], v[200:203], v[48:63]
  ds_read_b128 v[16:19], v8 offset:256
  s_waitcnt lgkmcnt(3)
  v_mfma_f32_32x32x16_bf16 v[32:47], v[20:23], v[140:143], v[32:47]
  buffer_load_dwordx4 v5, s[56:59], s22 offen offset:1024 lds
  v_mfma_f32_32x32x16_bf16 v[48:63], v[20:23], v[204:207], v[48:63]
  ds_read_b128 v[20:23], v9 offset:256
  s_waitcnt lgkmcnt(3)
  v_mfma_f32_32x32x16_bf16 v[32:47], v[24:27], v[144:147], v[32:47]
  buffer_load_dwordx4 v6, s[56:59], s22 offen offset:2048 lds
  v_mfma_f32_32x32x16_bf16 v[48:63], v[24:27], v[208:211], v[48:63]
  ds_read_b128 v[24:27], v10 offset:256
  s_waitcnt lgkmcnt(3)
  v_mfma_f32_32x32x16_bf16 v[32:47], v[28:31], v[148:151], v[32:47]
  buffer_load_dwordx4 v7, s[56:59], s22 offen offset:3072 lds
  v_mfma_f32_32x32x16_bf16 v[48:63], v[28:31], v[212:215], v[48:63]
  ds_read_b128 v[28:31], v11 offset:256
  s_waitcnt lgkmcnt(3)
  v_mfma_f32_32x32x16_bf16 v[32:47], v[16:19], v[152:155], v[32:47]
  s_add_u32 s22, s27, 1572864
  s_add_u32 m0, s25, 98304
  s_nop 0
  buffer_load_dwordx4 v4, s[56:59], s22 offen offset:0 lds
  v_mfma_f32_32x32x16_bf16 v[48:63], v[16:19], v[216:219], v[48:63]
  ds_read_b128 v[16:19], v12 offset:256
  s_waitcnt lgkmcnt(3)
  v_mfma_f32_32x32x16_bf16 v[32:47], v[20:23], v[156:159], v[32:47]
  buffer_load_dwordx4 v5, s[56:59], s22 offen offset:1024 lds
  v_mfma_f32_32x32x16_bf16 v[48:63], v[20:23], v[220:223], v[48:63]
  ds_read_b128 v[20:23], v13 offset:256
  s_waitcnt lgkmcnt(3)
  v_mfma_f32_32x32x16_bf16 v[32:47], v[24:27], v[160:163], v[32:47]
  buffer_load_dwordx4 v6, s[56:59], s22 offen offset:2048 lds
  v_mfma_f32_32x32x16_bf16 v[48:63], v[24:27], v[224:227], v[48:63]
  ds_read_b128 v[24:27], v14 offset:256
  s_waitcnt lgkmcnt(3)
  v_mfma_f32_32x32x16_bf16 v[32:47], v[28:31], v[164:167], v[32:47]
  buffer_load_dwordx4 v7, s[56:59], s22 offen offset:3072 lds
  v_mfma_f32_32x32x16_bf16 v[48:63], v[28:31], v[228:231], v[48:63]
  ds_read_b128 v[28:31], v15 offset:256
  s_waitcnt lgkmcnt(3)
  v_mfma_f32_32x32x16_bf16 v[32:47], v[16:19], v[168:171], v[32:47]
  s_add_u32 s22, s27, 1835008
  s_add_u32 m0, s25, 114688
  s_nop 0
  buffer_load_dwordx4 v4, s[56:59], s22 offen offset:0 lds
  v_mfma_f32_32x32x16_bf16 v[48:63], v[16:19], v[232:235], v[48:63]
  ds_read_b128 v[16:19], v8 offset:16384
  s_waitcnt lgkmcnt(3)
  v_mfma_f32_32x32x16_bf16 v[32:47], v[20:23], v[172:175], v[32:47]
  buffer_load_dwordx4 v5, s[56:59], s22 offen offset:1024 lds
  v_mfma_f32_32x32x16_bf16 v[48:63], v[20:23], v[236:239], v[48:63]
  ds_read_b128 v[20:23], v9 offset:16384
  s_waitcnt lgkmcnt(3)
  v_mfma_f32_32x32x16_bf16 v[32:47], v[24:27], v[176:179], v[32:47]
  buffer_load_dwordx4 v6, s[56:59], s22 offen offset:2048 lds
  v_mfma_f32_32x32x16_bf16 v[48:63], v[24:27], v[240:243], v[48:63]
  ds_read_b128 v[24:27], v10 offset:16384
  s_waitcnt lgkmcnt(3)
  v_mfma_f32_32x32x16_bf16 v[32:47], v[28:31], v[180:183], v[32:47]
  buffer_load_dwordx4 v7, s[56:59], s22 offen offset:3072 lds
  v_mfma_f32_32x32x16_bf16 v[48:63], v[28:31], v[244:247], v[48:63]
  s_waitcnt vmcnt(16)
  s_barrier
  ds_read_b128 v[28:31], v11 offset:16384
  s_waitcnt lgkmcnt(3)
  v_mfma_f32_32x32x16_bf16 v[64:79], v[16:19], v[120:123], 0
  s_add_u32 s22, s27, 2097152
  s_add_u32 m0, s25, 131072
  s_nop 0
  buffer_load_dwordx4 v4, s[56:59], s22 offen offset:0 lds
  v_mfma_f32_32x32x16_bf16 v[80:95], v[16:19], v[184:187], 0
  ds_read_b128 v[16:19], v12 offset:16384
  s_waitcnt lgkmcnt(3)
  v_mfma_f32_32x32x16_bf16 v[64:79], v[20:23], v[124:127], v[64:79]
  buffer_load_dwordx4 v5, s[56:59], s22 offen offset:1024 lds
  v_mul_f32 v32, s52, v32
  v_mul_f32 v33, s52, v33
  v_cvt_pk_bf16_f32 v32, v32, v33
  v_mfma_f32_32x32x16_bf16 v[80:95], v[20:23], v[188:191], v[80:95]
  v_mul_f32 v34, s52, v34
  v_mul_f32 v35, s52, v35
  ds_read_b128 v[20:23], v13 offset:16384
  s_waitcnt lgkmcnt(3)
  v_mfma_f32_32x32x16_bf16 v[64:79], v[24:27], v[128:131], v[64:79]
  buffer_load_dwordx4 v6, s[56:59], s22 offen offset:2048 lds
  v_cvt_pk_bf16_f32 v33, v34, v35
  v_mul_f32 v36, s52, v36
  v_mul_f32 v37, s52, v37
  v_mfma_f32_32x32x16_bf16 v[80:95], v[24:27], v[192:195], v[80:95]
  v_cvt_pk_bf16_f32 v34, v36, v37
  v_mul_f32 v38, s52, v38
  ds_read_b128 v[24:27], v14 offset:16384
  s_waitcnt lgkmcnt(3)
  v_mfma_f32_32x32x16_bf16 v[64:79], v[28:31], v[132:135], v[64:79]
  buffer_load_dwordx4 v7, s[56:59], s22 offen offset:3072 lds
  v_mul_f32 v39, s52, v39
  v_cvt_pk_bf16_f32 v35, v38, v39
  v_mul_f32 v40, s52, v40
  v_mfma_f32_32x32x16_bf16 v[80:95], v[28:31], v[196:199], v[80:95]
  v_mul_f32 v41, s52, v41
  v_cvt_pk_bf16_f32 v40, v40, v41
  ds_read_b128 v[28:31], v15 offset:16384
  s_waitcnt lgkmcnt(3)
  v_mfma_f32_32x32x16_bf16 v[64:79], v[16:19], v[136:139], v[64:79]
  s_add_u32 s22, s27, 2359296
  s_add_u32 m0, s25, 0
  s_nop 0
  buffer_load_dwordx4 v4, s[56:59], s22 offen offset:0 lds
  v_mul_f32 v42, s52, v42
  v_mul_f32 v43, s52, v43
  v_cvt_pk_bf16_f32 v41, v42, v43
  v_mfma_f32_32x32x16_bf16 v[80:95], v[16:19], v[200:203], v[80:95]
  v_mul_f32 v44, s52, v44
  v_mul_f32 v45, s52, v45
  ds_read_b128 v[16:19], v8 offset:16640
  s_waitcnt lgkmcnt(3)
  v_mfma_f32_32x32x16_bf16 v[64:79], v[20:23], v[140:143], v[64:79]
  buffer_load_dwordx4 v5, s[56:59], s22 offen offset:1024 lds
  v_cvt_pk_bf16_f32 v42, v44, v45
  v_mul_f32 v46, s52, v46
  v_mul_f32 v47, s52, v47
  v_mfma_f32_32x32x16_bf16 v[80:95], v[20:23], v[204:207], v[80:95]
  v_cvt_pk_bf16_f32 v43, v46, v47
  v_permlane16_swap_b32 v32, v40
  ds_read_b128 v[20:23], v9 offset:16640
  s_waitcnt lgkmcnt(3)
  v_mfma_f32_32x32x16_bf16 v[64:79], v[24:27], v[144:147], v[64:79]
  buffer_load_dwordx4 v6, s[56:59], s22 offen offset:2048 lds
  v_permlane16_swap_b32 v33, v41
  v_permlane16_swap_b32 v34, v42
  v_permlane16_swap_b32 v35, v43
  v_mfma_f32_32x32x16_bf16 v[80:95], v[24:27], v[208:211], v[80:95]
  v_accvgpr_write_b32 a0, v32
  v_accvgpr_write_b32 a1, v33
  ds_read_b128 v[24:27], v10 offset:16640
  s_waitcnt lgkmcnt(3)
  v_mfma_f32_32x32x16_bf16 v[64:79], v[28:31], v[148:151], v[64:79]
  buffer_load_dwordx4 v7, s[56:59], s22 offen offset:3072 lds
  v_accvgpr_write_b32 a2, v34
  v_accvgpr_write_b32 a3, v35
  v_accvgpr_write_b32 a56, v40
  v_mfma_f32_32x32x16_bf16 v[80:95], v[28:31], v[212:215], v[80:95]
  v_accvgpr_write_b32 a57, v41
  v_accvgpr_write_b32 a58, v42
  ds_read_b128 v[28:31], v11 offset:16640
  s_waitcnt lgkmcnt(3)
  v_mfma_f32_32x32x16_bf16 v[64:79], v[16:19], v[152:155], v[64:79]
  v_accvgpr_write_b32 a59, v43
  v_mul_f32 v48, s52, v48
  v_mul_f32 v49, s52, v49
  v_mfma_f32_32x32x16_bf16 v[80:95], v[16:19], v[216:219], v[80:95]
  v_cvt_pk_bf16_f32 v48, v48, v49
  v_mul_f32 v50, s52, v50
  ds_read_b128 v[16:19], v12 offset:16640
  s_waitcnt lgkmcnt(3)
  v_mfma_f32_32x32x16_bf16 v[64:79], v[20:23], v[156:159], v[64:79]
  v_mul_f32 v51, s52, v51
  v_cvt_pk_bf16_f32 v49, v50, v51
  v_mul_f32 v52, s52, v52
  v_mfma_f32_32x32x16_bf16 v[80:95], v[20:23], v[220:223], v[80:95]
  v_mul_f32 v53, s52, v53
  v_cvt_pk_bf16_f32 v50, v52, v53
  ds_read_b128 v[20:23], v13 offset:16640
  s_waitcnt lgkmcnt(3)
  v_mfma_f32_32x32x16_bf16 v[64:79], v[24:27], v[160:163], v[64:79]
  v_mul_f32 v54, s52, v54
  v_mul_f32 v55, s52, v55
  v_cvt_pk_bf16_f32 v51, v54, v55
  v_mfma_f32_32x32x16_bf16 v[80:95], v[24:27], v[224:227], v[80:95]
  v_mul_f32 v56, s52, v56
  v_mul_f32 v57, s52, v57
  ds_read_b128 v[24:27], v14 offset:16640
  s_waitcnt lgkmcnt(3)
  v_mfma_f32_32x32x16_bf16 v[64:79], v[28:31], v[164:167], v[64:79]
  v_cvt_pk_bf16_f32 v56, v56, v57
  v_mul_f32 v58, s52, v58
  v_mul_f32 v59, s52, v59
  v_mfma_f32_32x32x16_bf16 v[80:95], v[28:31], v[228:231], v[80:95]
  v_cvt_pk_bf16_f32 v57, v58, v59
  v_mul_f32 v60, s52, v60
  ds_read_b128 v[28:31], v15 offset:16640
  s_waitcnt lgkmcnt(3)
  v_mfma_f32_32x32x16_bf16 v[64:79], v[16:19], v[168:171], v[64:79]
  v_mul_f32 v61, s52, v61
  v_cvt_pk_bf16_f32 v58, v60, v61
  v_mul_f32 v62, s52, v62
  v_mfma_f32_32x32x16_bf16 v[80:95], v[16:19], v[232:235], v[80:95]
  v_mul_f32 v63, s52, v63
  v_cvt_pk_bf16_f32 v59, v62, v63
  ds_read_b128 v[16:19], v8 offset:32768
  s_waitcnt lgkmcnt(3)
  v_mfma_f32_32x32x16_bf16 v[64:79], v[20:23], v[172:175], v[64:79]
  v_permlane16_swap_b32 v48, v56
  v_permlane16_swap_b32 v49, v57
  v_permlane16_swap_b32 v50, v58
  v_mfma_f32_32x32x16_bf16 v[80:95], v[20:23], v[236:239], v[80:95]
  v_permlane16_swap_b32 v51, v59
  v_accvgpr_write_b32 a112, v48
  ds_read_b128 v[20:23], v9 offset:32768
  s_waitcnt lgkmcnt(3)
  v_mfma_f32_32x32x16_bf16 v[64:79], v[24:27], v[176:179], v[64:79]
  v_accvgpr_write_b32 a113, v49
  v_accvgpr_write_b32 a114, v50
  v_accvgpr_write_b32 a115, v51
  v_mfma_f32_32x32x16_bf16 v[80:95], v[24:27], v[240:243], v[80:95]
  v_accvgpr_write_b32 a168, v56
  v_accvgpr_write_b32 a169, v57
  ds_read_b128 v[24:27], v10 offset:32768
  s_waitcnt lgkmcnt(3)
  v_mfma_f32_32x32x16_bf16 v[64:79], v[28:31], v[180:183], v[64:79]
  v_accvgpr_write_b32 a170, v58
  v_accvgpr_write_b32 a171, v59
  v_mfma_f32_32x32x16_bf16 v[80:95], v[28:31], v[244:247], v[80:95]
  ds_read_b128 v[28:31], v11 offset:32768
  s_waitcnt lgkmcnt(3)
  v_mfma_f32_32x32x16_bf16 v[32:47], v[16:19], v[120:123], 0
  v_mfma_f32_32x32x16_bf16 v[48:63], v[16:19], v[184:187], 0
  ds_read_b128 v[16:19], v12 offset:32768
  s_waitcnt lgkmcnt(3)
  v_mfma_f32_32x32x16_bf16 v[32:47], v[20:23], v[124:127], v[32:47]
  v_mul_f32 v64, s52, v64
  v_mul_f32 v65, s52, v65
  v_cvt_pk_bf16_f32 v64, v64, v65
  v_mfma_f32_32x32x16_bf16 v[48:63], v[20:23], v[188:191], v[48:63]
  v_mul_f32 v66, s52, v66
  v_mul_f32 v67, s52, v67
  ds_read_b128 v[20:23], v13 offset:32768
  s_waitcnt lgkmcnt(3)
  v_mfma_f32_32x32x16_bf16 v[32:47], v[24:27], v[128:131], v[32:47]
  v_cvt_pk_bf16_f32 v65, v66, v67
  v_mul_f32 v68, s52, v68
  v_mul_f32 v69, s52, v69
  v_mfma_f32_32x32x16_bf16 v[48:63], v[24:27], v[192:195], v[48:63]
  v_cvt_pk_bf16_f32 v66, v68, v69
  v_mul_f32 v70, s52, v70
  ds_read_b128 v[24:27], v14 offset:32768
  s_waitcnt lgkmcnt(3)
  v_mfma_f32_32x32x16_bf16 v[32:47], v[28:31], v[132:135], v[32:47]
  v_mul_f32 v71, s52, v71
  v_cvt_pk_bf16_f32 v67, v70, v71
  v_mul_f32 v72, s52, v72
  v_mfma_f32_32x32x16_bf16 v[48:63], v[28:31], v[196:199], v[48:63]
  v_mul_f32 v73, s52, v73
  v_cvt_pk_bf16_f32 v72, v72, v73
  ds_read_b128 v[28:31], v15 offset:32768
  s_waitcnt lgkmcnt(3)
  v_mfma_f32_32x32x16_bf16 v[32:47], v[16:19], v[136:139], v[32:47]
  v_mul_f32 v74, s52, v74
  v_mul_f32 v75, s52, v75
  v_cvt_pk_bf16_f32 v73, v74, v75
  v_mfma_f32_32x32x16_bf16 v[48:63], v[16:19], v[200:203], v[48:63]
  v_mul_f32 v76, s52, v76
  v_mul_f32 v77, s52, v77
  ds_read_b128 v[16:19], v8 offset:33024
  s_waitcnt lgkmcnt(3)
  v_mfma_f32_32x32x16_bf16 v[32:47], v[20:23], v[140:143], v[32:47]
  v_cvt_pk_bf16_f32 v74, v76, v77
  v_mul_f32 v78, s52, v78
  v_mul_f32 v79, s52, v79
  v_mfma_f32_32x32x16_bf16 v[48:63], v[20:23], v[204:207], v[48:63]
  v_cvt_pk_bf16_f32 v75, v78, v79
  v_permlane16_swap_b32 v64, v72
  ds_read_b128 v[20:23], v9 offset:33024
  s_waitcnt lgkmcnt(3)
  v_mfma_f32_32x32x16_bf16 v[32:47], v[24:27], v[144:147], v[32:47]
  v_permlane16_swap_b32 v65, v73
  v_permlane16_swap_b32 v66, v74
  v_permlane16_swap_b32 v67, v75
  v_mfma_f32_32x32x16_bf16 v[48:63], v[24:27], v[208:211], v[48:63]
  v_accvgpr_write_b32 a4, v64
  v_accvgpr_write_b32 a5, v65
  ds_read_b128 v[24:27], v10 offset:33024
  s_waitcnt lgkmcnt(3)
  v_mfma_f32_32x32x16_bf16 v[32:47], v[28:31], v[148:151], v[32:47]
  v_accvgpr_write_b32 a6, v66
  v_accvgpr_write_b32 a7, v67
  v_accvgpr_write_b32 a60, v72
  v_mfma_f32_32x32x16_bf16 v[48:63], v[28:31], v[212:215], v[48:63]
  v_accvgpr_write_b32 a61, v73
  v_accvgpr_write_b32 a62, v74
  ds_read_b128 v[28:31], v11 offset:33024
  s_waitcnt lgkmcnt(3)
  v_mfma_f32_32x32x16_bf16 v[32:47], v[16:19], v[152:155], v[32:47]
  v_accvgpr_write_b32 a63, v75
  v_mul_f32 v80, s52, v80
  v_mul_f32 v81, s52, v81
  v_mfma_f32_32x32x16_bf16 v[48:63], v[16:19], v[216:219], v[48:63]
  v_cvt_pk_bf16_f32 v80, v80, v81
  v_mul_f32 v82, s52, v82
  ds_read_b128 v[16:19], v12 offset:33024
  s_waitcnt lgkmcnt(3)
  v_mfma_f32_32x32x16_bf16 v[32:47], v[20:23], v[156:159], v[32:47]
  v_mul_f32 v83, s52, v83
  v_cvt_pk_bf16_f32 v81, v82, v83
  v_mul_f32 v84, s52, v84
  v_mfma_f32_32x32x16_bf16 v[48:63], v[20:23], v[220:223], v[48:63]
  v_mul_f32 v85, s52, v85
  v_cvt_pk_bf16_f32 v82, v84, v85
  ds_read_b128 v[20:23], v13 offset:33024
  s_waitcnt lgkmcnt(3)
  v_mfma_f32_32x32x16_bf16 v[32:47], v[24:27], v[160:163], v[32:47]
  v_mul_f32 v86, s52, v86
  v_mul_f32 v87, s52, v87
  v_cvt_pk_bf16_f32 v83, v86, v87
  v_mfma_f32_32x32x16_bf16 v[48:63], v[24:27], v[224:227], v[48:63]
  v_mul_f32 v88, s52, v88
  v_mul_f32 v89, s52, v89
  ds_read_b128 v[24:27], v14 offset:33024
  s_waitcnt lgkmcnt(3)
  v_mfma_f32_32x32x16_bf16 v[32:47], v[28:31], v[164:167], v[32:47]
  v_cvt_pk_bf16_f32 v88, v88, v89
  v_mul_f32 v90, s52, v90
  v_mul_f32 v91, s52, v91
  v_mfma_f32_32x32x16_bf16 v[48:63], v[28:31], v[228:231], v[48:63]
  v_cvt_pk_bf16_f32 v89, v90, v91
  v_mul_f32 v92, s52, v92
  ds_read_b128 v[28:31], v15 offset:33024
  s_waitcnt lgkmcnt(3)
  v_mfma_f32_32x32x16_bf16 v[32:47], v[16:19], v[168:171], v[32:47]
  v_mul_f32 v93, s52, v93
  v_cvt_pk_bf16_f32 v90, v92, v93
  v_mul_f32 v94, s52, v94
  v_mfma_f32_32x32x16_bf16 v[48:63], v[16:19], v[232:235], v[48:63]
  v_mul_f32 v95, s52, v95
  v_cvt_pk_bf16_f32 v91, v94, v95
  ds_read_b128 v[16:19], v8 offset:49152
  s_waitcnt lgkmcnt(3)
  v_mfma_f32_32x32x16_bf16 v[32:47], v[20:23], v[172:175], v[32:47]
  v_permlane16_swap_b32 v80, v88
  v_permlane16_swap_b32 v81, v89
  v_permlane16_swap_b32 v82, v90
  v_mfma_f32_32x32x16_bf16 v[48:63], v[20:23], v[236:239], v[48:63]
  v_permlane16_swap_b32 v83, v91
  v_accvgpr_write_b32 a116, v80
  ds_read_b128 v[20:23], v9 offset:49152
  s_waitcnt lgkmcnt(3)
  v_mfma_f32_32x32x16_bf16 v[32:47], v[24:27], v[176:179], v[32:47]
  v_accvgpr_write_b32 a117, v81
  v_accvgpr_write_b32 a118, v82
  v_accvgpr_write_b32 a119, v83
  v_mfma_f32_32x32x16_bf16 v[48:63], v[24:27], v[240:243], v[48:63]
  v_accvgpr_write_b32 a172, v88
  v_accvgpr_write_b32 a173, v89
  ds_read_b128 v[24:27], v10 offset:49152
  s_waitcnt lgkmcnt(3)
  v_mfma_f32_32x32x16_bf16 v[32:47], v[28:31], v[180:183], v[32:47]
  v_accvgpr_write_b32 a174, v90
  v_accvgpr_write_b32 a175, v91
  v_mfma_f32_32x32x16_bf16 v[48:63], v[28:31], v[244:247], v[48:63]
  s_waitcnt vmcnt(16)
  s_barrier
  ds_read_b128 v[28:31], v11 offset:49152
  s_waitcnt lgkmcnt(3)
  v_mfma_f32_32x32x16_bf16 v[64:79], v[16:19], v[120:123], 0
  s_add_u32 s22, s27, 2621440
  s_add_u32 m0, s25, 16384
  s_nop 0
  buffer_load_dwordx4 v4, s[56:59], s22 offen offset:0 lds
  v_mfma_f32_32x32x16_bf16 v[80:95], v[16:19], v[184:187], 0
  ds_read_b128 v[16:19], v12 offset:49152
  s_waitcnt lgkmcnt(3)
  v_mfma_f32_32x32x16_bf16 v[64:79], v[20:23], v[124:127], v[64:79]
  buffer_load_dwordx4 v5, s[56:59], s22 offen offset:1024 lds
  v_mul_f32 v32, s52, v32
  v_mul_f32 v33, s52, v33
  v_cvt_pk_bf16_f32 v32, v32, v33
  v_mfma_f32_32x32x16_bf16 v[80:95], v[20:23], v[188:191], v[80:95]
  v_mul_f32 v34, s52, v34
  v_mul_f32 v35, s52, v35
  ds_read_b128 v[20:23], v13 offset:49152
  s_waitcnt lgkmcnt(3)
  v_mfma_f32_32x32x16_bf16 v[64:79], v[24:27], v[128:131], v[64:79]
  buffer_load_dwordx4 v6, s[56:59], s22 offen offset:2048 lds
  v_cvt_pk_bf16_f32 v33, v34, v35
  v_mul_f32 v36, s52, v36
  v_mul_f32 v37, s52, v37
  v_mfma_f32_32x32x16_bf16 v[80:95], v[24:27], v[192:195], v[80:95]
  v_cvt_pk_bf16_f32 v34, v36, v37
  v_mul_f32 v38, s52, v38
  ds_read_b128 v[24:27], v14 offset:49152
  s_waitcnt lgkmcnt(3)
  v_mfma_f32_32x32x16_bf16 v[64:79], v[28:31], v[132:135], v[64:79]
  buffer_load_dwordx4 v7, s[56:59], s22 offen offset:3072 lds
  v_mul_f32 v39, s52, v39
  v_cvt_pk_bf16_f32 v35, v38, v39
  v_mul_f32 v40, s52, v40
  v_mfma_f32_32x32x16_bf16 v[80:95], v[28:31], v[196:199], v[80:95]
  v_mul_f32 v41, s52, v41
  v_cvt_pk_bf16_f32 v40, v40, v41
  ds_read_b128 v[28:31], v15 offset:49152
  s_waitcnt lgkmcnt(3)
  v_mfma_f32_32x32x16_bf16 v[64:79], v[16:19], v[136:139], v[64:79]
  s_add_u32 s22, s27, 2883584
  s_add_u32 m0, s25, 32768
  s_nop 0
  buffer_load_dwordx4 v4, s[56:59], s22 offen offset:0 lds
  v_mul_f32 v42, s52, v42
  v_mul_f32 v43, s52, v43
  v_cvt_pk_bf16_f32 v41, v42, v43
  v_mfma_f32_32x32x16_bf16 v[80:95], v[16:19], v[200:203], v[80:95]
  v_mul_f32 v44, s52, v44
  v_mul_f32 v45, s52, v45
  ds_read_b128 v[16:19], v8 offset:49408
  s_waitcnt lgkmcnt(3)
  v_mfma_f32_32x32x16_bf16 v[64:79], v[20:23], v[140:143], v[64:79]
  buffer_load_dwordx4 v5, s[56:59], s22 offen offset:1024 lds
  v_cvt_pk_bf16_f32 v42, v44, v45
  v_mul_f32 v46, s52, v46
  v_mul_f32 v47, s52, v47
  v_mfma_f32_32x32x16_bf16 v[80:95], v[20:23], v[204:207], v[80:95]
  v_cvt_pk_bf16_f32 v43, v46, v47
  v_permlane16_swap_b32 v32, v40
  ds_read_b128 v[20:23], v9 offset:49408
  s_waitcnt lgkmcnt(3)
  v_mfma_f32_32x32x16_bf16 v[64:79], v[24:27], v[144:147], v[64:79]
  buffer_load_dwordx4 v6, s[56:59], s22 offen offset:2048 lds
  v_permlane16_swap_b32 v33, v41
  v_permlane16_swap_b32 v34, v42
  v_permlane16_swap_b32 v35, v43
  v_mfma_f32_32x32x16_bf16 v[80:95], v[24:27], v[208:211], v[80:95]
  v_accvgpr_write_b32 a8, v32
  v_accvgpr_write_b32 a9, v33
  ds_read_b128 v[24:27], v10 offset:49408
  s_waitcnt lgkmcnt(3)
  v_mfma_f32_32x32x16_bf16 v[64:79], v[28:31], v[148:151], v[64:79]
  buffer_load_dwordx4 v7, s[56:59], s22 offen offset:3072 lds
  v_accvgpr_write_b32 a10, v34
  v_accvgpr_write_b32 a11, v35
  v_accvgpr_write_b32 a64, v40
  v_mfma_f32_32x32x16_bf16 v[80:95], v[28:31], v[212:215], v[80:95]
  v_accvgpr_write_b32 a65, v41
  v_accvgpr_write_b32 a66, v42
  ds_read_b128 v[28:31], v11 offset:49408
  s_waitcnt lgkmcnt(3)
  v_mfma_f32_32x32x16_bf16 v[64:79], v[16:19], v[152:155], v[64:79]
  v_accvgpr_write_b32 a67, v43
  v_mul_f32 v48, s52, v48
  v_mul_f32 v49, s52, v49
  v_mfma_f32_32x32x16_bf16 v[80:95], v[16:19], v[216:219], v[80:95]
  v_cvt_pk_bf16_f32 v48, v48, v49
  v_mul_f32 v50, s52, v50
  ds_read_b128 v[16:19], v12 offset:49408
  s_waitcnt lgkmcnt(3)
  v_mfma_f32_32x32x16_bf16 v[64:79], v[20:23], v[156:159], v[64:79]
  v_mul_f32 v51, s52, v51
  v_cvt_pk_bf16_f32 v49, v50, v51
  v_mul_f32 v52, s52, v52
  v_mfma_f32_32x32x16_bf16 v[80:95], v[20:23], v[220:223], v[80:95]
  v_mul_f32 v53, s52, v53
  v_cvt_pk_bf16_f32 v50, v52, v53
  ds_read_b128 v[20:23], v13 offset:49408
  s_waitcnt lgkmcnt(3)
  v_mfma_f32_32x32x16_bf16 v[64:79], v[24:27], v[160:163], v[64:79]
  v_mul_f32 v54, s52, v54
  v_mul_f32 v55, s52, v55
  v_cvt_pk_bf16_f32 v51, v54, v55
  v_mfma_f32_32x32x16_bf16 v[80:95], v[24:27], v[224:227], v[80:95]
  v_mul_f32 v56, s52, v56
  v_mul_f32 v57, s52, v57
  ds_read_b128 v[24:27], v14 offset:49408
  s_waitcnt lgkmcnt(3)
  v_mfma_f32_32x32x16_bf16 v[64:79], v[28:31], v[164:167], v[64:79]
  v_cvt_pk_bf16_f32 v56, v56, v57
  v_mul_f32 v58, s52, v58
  v_mul_f32 v59, s52, v59
  v_mfma_f32_32x32x16_bf16 v[80:95], v[28:31], v[228:231], v[80:95]
  v_cvt_pk_bf16_f32 v57, v58, v59
  v_mul_f32 v60, s52, v60
  ds_read_b128 v[28:31], v15 offset:49408
  s_waitcnt lgkmcnt(3)
  v_mfma_f32_32x32x16_bf16 v[64:79], v[16:19], v[168:171], v[64:79]
  v_mul_f32 v61, s52, v61
  v_cvt_pk_bf16_f32 v58, v60, v61
  v_mul_f32 v62, s52, v62
  v_mfma_f32_32x32x16_bf16 v[80:95], v[16:19], v[232:235], v[80:95]
  v_mul_f32 v63, s52, v63
  v_cvt_pk_bf16_f32 v59, v62, v63
  v_xor_b32 v8, 65536, v8
  ds_read_b128 v[16:19], v8 offset:0
  s_waitcnt lgkmcnt(3)
  v_mfma_f32_32x32x16_bf16 v[64:79], v[20:23], v[172:175], v[64:79]
  v_permlane16_swap_b32 v48, v56
  v_permlane16_swap_b32 v49, v57
  v_permlane16_swap_b32 v50, v58
  v_mfma_f32_32x32x16_bf16 v[80:95], v[20:23], v[236:239], v[80:95]
  v_permlane16_swap_b32 v51, v59
  v_accvgpr_write_b32 a120, v48
  v_xor_b32 v9, 65536, v9
  ds_read_b128 v[20:23], v9 offset:0
  s_waitcnt lgkmcnt(3)
  v_mfma_f32_32x32x16_bf16 v[64:79], v[24:27], v[176:179], v[64:79]
  v_accvgpr_write_b32 a121, v49
  v_accvgpr_write_b32 a122, v50
  v_accvgpr_write_b32 a123, v51
  v_mfma_f32_32x32x16_bf16 v[80:95], v[24:27], v[240:243], v[80:95]
  v_accvgpr_write_b32 a176, v56
  v_accvgpr_write_b32 a177, v57
  v_xor_b32 v10, 65536, v10
  ds_read_b128 v[24:27], v10 offset:0
  s_waitcnt lgkmcnt(3)
  v_mfma_f32_32x32x16_bf16 v[64:79], v[28:31], v[180:183], v[64:79]
  v_accvgpr_write_b32 a178, v58
  v_accvgpr_write_b32 a179, v59
  v_mfma_f32_32x32x16_bf16 v[80:95], v[28:31], v[244:247], v[80:95]
  v_xor_b32 v11, 65536, v11
  ds_read_b128 v[28:31], v11 offset:0
  s_waitcnt lgkmcnt(3)
  v_mfma_f32_32x32x16_bf16 v[32:47], v[16:19], v[120:123], 0
  v_mfma_f32_32x32x16_bf16 v[48:63], v[16:19], v[184:187], 0
  v_xor_b32 v12, 65536, v12
  ds_read_b128 v[16:19], v12 offset:0
  s_waitcnt lgkmcnt(3)
  v_mfma_f32_32x32x16_bf16 v[32:47], v[20:23], v[124:127], v[32:47]
  v_mul_f32 v64, s52, v64
  v_mul_f32 v65, s52, v65
  v_cvt_pk_bf16_f32 v64, v64, v65
  v_mfma_f32_32x32x16_bf16 v[48:63], v[20:23], v[188:191], v[48:63]
  v_mul_f32 v66, s52, v66
  v_mul_f32 v67, s52, v67
  v_xor_b32 v13, 65536, v13
  ds_read_b128 v[20:23], v13 offset:0
  s_waitcnt lgkmcnt(3)
  v_mfma_f32_32x32x16_bf16 v[32:47], v[24:27], v[128:131], v[32:47]
  v_cvt_pk_bf16_f32 v65, v66, v67
  v_mul_f32 v68, s52, v68
  v_mul_f32 v69, s52, v69
  v_mfma_f32_32x32x16_bf16 v[48:63], v[24:27], v[192:195], v[48:63]
  v_cvt_pk_bf16_f32 v66, v68, v69
  v_mul_f32 v70, s52, v70
  v_xor_b32 v14, 65536, v14
  ds_read_b128 v[24:27], v14 offset:0
  s_waitcnt lgkmcnt(3)
  v_mfma_f32_32x32x16_bf16 v[32:47], v[28:31], v[132:135], v[32:47]
  v_mul_f32 v71, s52, v71
  v_cvt_pk_bf16_f32 v67, v70, v71
  v_mul_f32 v72, s52, v72
  v_mfma_f32_32x32x16_bf16 v[48:63], v[28:31], v[196:199], v[48:63]
  v_mul_f32 v73, s52, v73
  v_cvt_pk_bf16_f32 v72, v72, v73
  v_xor_b32 v15, 65536, v15
  ds_read_b128 v[28:31], v15 offset:0
  s_waitcnt lgkmcnt(3)
  v_mfma_f32_32x32x16_bf16 v[32:47], v[16:19], v[136:139], v[32:47]
  v_mul_f32 v74, s52, v74
  v_mul_f32 v75, s52, v75
  v_cvt_pk_bf16_f32 v73, v74, v75
  v_mfma_f32_32x32x16_bf16 v[48:63], v[16:19], v[200:203], v[48:63]
  v_mul_f32 v76, s52, v76
  v_mul_f32 v77, s52, v77
  ds_read_b128 v[16:19], v8 offset:256
  s_waitcnt lgkmcnt(3)
  v_mfma_f32_32x32x16_bf16 v[32:47], v[20:23], v[140:143], v[32:47]
  v_cvt_pk_bf16_f32 v74, v76, v77
  v_mul_f32 v78, s52, v78
  v_mul_f32 v79, s52, v79
  v_mfma_f32_32x32x16_bf16 v[48:63], v[20:23], v[204:207], v[48:63]
  v_cvt_pk_bf16_f32 v75, v78, v79
  v_permlane16_swap_b32 v64, v72
  ds_read_b128 v[20:23], v9 offset:256
  s_waitcnt lgkmcnt(3)
  v_mfma_f32_32x32x16_bf16 v[32:47], v[24:27], v[144:147], v[32:47]
  v_permlane16_swap_b32 v65, v73
  v_permlane16_swap_b32 v66, v74
  v_permlane16_swap_b32 v67, v75
  v_mfma_f32_32x32x16_bf16 v[48:63], v[24:27], v[208:211], v[48:63]
  v_accvgpr_write_b32 a12, v64
  v_accvgpr_write_b32 a13, v65
  ds_read_b128 v[24:27], v10 offset:256
  s_waitcnt lgkmcnt(3)
  v_mfma_f32_32x32x16_bf16 v[32:47], v[28:31], v[148:151], v[32:47]
  v_accvgpr_write_b32 a14, v66
  v_accvgpr_write_b32 a15, v67
  v_accvgpr_write_b32 a68, v72
  v_mfma_f32_32x32x16_bf16 v[48:63], v[28:31], v[212:215], v[48:63]
  v_accvgpr_write_b32 a69, v73
  v_accvgpr_write_b32 a70, v74
  ds_read_b128 v[28:31], v11 offset:256
  s_waitcnt lgkmcnt(3)
  v_mfma_f32_32x32x16_bf16 v[32:47], v[16:19], v[152:155], v[32:47]
  v_accvgpr_write_b32 a71, v75
  v_mul_f32 v80, s52, v80
  v_mul_f32 v81, s52, v81
  v_mfma_f32_32x32x16_bf16 v[48:63], v[16:19], v[216:219], v[48:63]
  v_cvt_pk_bf16_f32 v80, v80, v81
  v_mul_f32 v82, s52, v82
  ds_read_b128 v[16:19], v12 offset:256
  s_waitcnt lgkmcnt(3)
  v_mfma_f32_32x32x16_bf16 v[32:47], v[20:23], v[156:159], v[32:47]
  v_mul_f32 v83, s52, v83
  v_cvt_pk_bf16_f32 v81, v82, v83
  v_mul_f32 v84, s52, v84
  v_mfma_f32_32x32x16_bf16 v[48:63], v[20:23], v[220:223], v[48:63]
  v_mul_f32 v85, s52, v85
  v_cvt_pk_bf16_f32 v82, v84, v85
  ds_read_b128 v[20:23], v13 offset:256
  s_waitcnt lgkmcnt(3)
  v_mfma_f32_32x32x16_bf16 v[32:47], v[24:27], v[160:163], v[32:47]
  v_mul_f32 v86, s52, v86
  v_mul_f32 v87, s52, v87
  v_cvt_pk_bf16_f32 v83, v86, v87
  v_mfma_f32_32x32x16_bf16 v[48:63], v[24:27], v[224:227], v[48:63]
  v_mul_f32 v88, s52, v88
  v_mul_f32 v89, s52, v89
  ds_read_b128 v[24:27], v14 offset:256
  s_waitcnt lgkmcnt(3)
  v_mfma_f32_32x32x16_bf16 v[32:47], v[28:31], v[164:167], v[32:47]
  v_cvt_pk_bf16_f32 v88, v88, v89
  v_mul_f32 v90, s52, v90
  v_mul_f32 v91, s52, v91
  v_mfma_f32_32x32x16_bf16 v[48:63], v[28:31], v[228:231], v[48:63]
  v_cvt_pk_bf16_f32 v89, v90, v91
  v_mul_f32 v92, s52, v92
  ds_read_b128 v[28:31], v15 offset:256
  s_waitcnt lgkmcnt(3)
  v_mfma_f32_32x32x16_bf16 v[32:47], v[16:19], v[168:171], v[32:47]
  v_mul_f32 v93, s52, v93
  v_cvt_pk_bf16_f32 v90, v92, v93
  v_mul_f32 v94, s52, v94
  v_mfma_f32_32x32x16_bf16 v[48:63], v[16:19], v[232:235], v[48:63]
  v_mul_f32 v95, s52, v95
  v_cvt_pk_bf16_f32 v91, v94, v95
  ds_read_b128 v[16:19], v8 offset:16384
  s_waitcnt lgkmcnt(3)
  v_mfma_f32_32x32x16_bf16 v[32:47], v[20:23], v[172:175], v[32:47]
  v_permlane16_swap_b32 v80, v88
  v_permlane16_swap_b32 v81, v89
  v_permlane16_swap_b32 v82, v90
  v_mfma_f32_32x32x16_bf16 v[48:63], v[20:23], v[236:239], v[48:63]
  v_permlane16_swap_b32 v83, v91
  v_accvgpr_write_b32 a124, v80
  ds_read_b128 v[20:23], v9 offset:16384
  s_waitcnt lgkmcnt(3)
  v_mfma_f32_32x32x16_bf16 v[32:47], v[24:27], v[176:179], v[32:47]
  v_accvgpr_write_b32 a125, v81
  v_accvgpr_write_b32 a126, v82
  v_accvgpr_write_b32 a127, v83
  v_mfma_f32_32x32x16_bf16 v[48:63], v[24:27], v[240:243], v[48:63]
  v_accvgpr_write_b32 a180, v88
  v_accvgpr_write_b32 a181, v89
  ds_read_b128 v[24:27], v10 offset:16384
  s_waitcnt lgkmcnt(3)
  v_mfma_f32_32x32x16_bf16 v[32:47], v[28:31], v[180:183], v[32:47]
  v_accvgpr_write_b32 a182, v90
  v_accvgpr_write_b32 a183, v91
  v_mfma_f32_32x32x16_bf16 v[48:63], v[28:31], v[244:247], v[48:63]
  s_waitcnt vmcnt(16)
  s_barrier
  ds_read_b128 v[28:31], v11 offset:16384
  s_waitcnt lgkmcnt(3)
  v_mfma_f32_32x32x16_bf16 v[64:79], v[16:19], v[120:123], 0
  s_add_u32 s22, s27, 3145728
  s_add_u32 m0, s25, 49152
  s_nop 0
  buffer_load_dwordx4 v4, s[56:59], s22 offen offset:0 lds
  v_mfma_f32_32x32x16_bf16 v[80:95], v[16:19], v[184:187], 0
  ds_read_b128 v[16:19], v12 offset:16384
  s_waitcnt lgkmcnt(3)
  v_mfma_f32_32x32x16_bf16 v[64:79], v[20:23], v[124:127], v[64:79]
  buffer_load_dwordx4 v5, s[56:59], s22 offen offset:1024 lds
  v_mul_f32 v32, s52, v32
  v_mul_f32 v33, s52, v33
  v_cvt_pk_bf16_f32 v32, v32, v33
  v_mfma_f32_32x32x16_bf16 v[80:95], v[20:23], v[188:191], v[80:95]
  v_mul_f32 v34, s52, v34
  v_mul_f32 v35, s52, v35
  ds_read_b128 v[20:23], v13 offset:16384
  s_waitcnt lgkmcnt(3)
  v_mfma_f32_32x32x16_bf16 v[64:79], v[24:27], v[128:131], v[64:79]
  buffer_load_dwordx4 v6, s[56:59], s22 offen offset:2048 lds
  v_cvt_pk_bf16_f32 v33, v34, v35
  v_mul_f32 v36, s52, v36
  v_mul_f32 v37, s52, v37
  v_mfma_f32_32x32x16_bf16 v[80:95], v[24:27], v[192:195], v[80:95]
  v_cvt_pk_bf16_f32 v34, v36, v37
  v_mul_f32 v38, s52, v38
  ds_read_b128 v[24:27], v14 offset:16384
  s_waitcnt lgkmcnt(3)
  v_mfma_f32_32x32x16_bf16 v[64:79], v[28:31], v[132:135], v[64:79]
  buffer_load_dwordx4 v7, s[56:59], s22 offen offset:3072 lds
  v_mul_f32 v39, s52, v39
  v_cvt_pk_bf16_f32 v35, v38, v39
  v_mul_f32 v40, s52, v40
  v_mfma_f32_32x32x16_bf16 v[80:95], v[28:31], v[196:199], v[80:95]
  v_mul_f32 v41, s52, v41
  v_cvt_pk_bf16_f32 v40, v40, v41
  ds_read_b128 v[28:31], v15 offset:16384
  s_waitcnt lgkmcnt(3)
  v_mfma_f32_32x32x16_bf16 v[64:79], v[16:19], v[136:139], v[64:79]
  s_add_u32 s22, s27, 3407872
  s_add_u32 m0, s25, 65536
  s_nop 0
  buffer_load_dwordx4 v4, s[56:59], s22 offen offset:0 lds
  v_mul_f32 v42, s52, v42
  v_mul_f32 v43, s52, v43
  v_cvt_pk_bf16_f32 v41, v42, v43
  v_mfma_f32_32x32x16_bf16 v[80:95], v[16:19], v[200:203], v[80:95]
  v_mul_f32 v44, s52, v44
  v_mul_f32 v45, s52, v45
  ds_read_b128 v[16:19], v8 offset:16640
  s_waitcnt lgkmcnt(3)
  v_mfma_f32_32x32x16_bf16 v[64:79], v[20:23], v[140:143], v[64:79]
  buffer_load_dwordx4 v5, s[56:59], s22 offen offset:1024 lds
  v_cvt_pk_bf16_f32 v42, v44, v45
  v_mul_f32 v46, s52, v46
  v_mul_f32 v47, s52, v47
  v_mfma_f32_32x32x16_bf16 v[80:95], v[20:23], v[204:207], v[80:95]
  v_cvt_pk_bf16_f32 v43, v46, v47
  v_permlane16_swap_b32 v32, v40
  ds_read_b128 v[20:23], v9 offset:16640
  s_waitcnt lgkmcnt(3)
  v_mfma_f32_32x32x16_bf16 v[64:79], v[24:27], v[144:147], v[64:79]
  buffer_load_dwordx4 v6, s[56:59], s22 offen offset:2048 lds
  v_permlane16_swap_b32 v33, v41
  v_permlane16_swap_b32 v34, v42
  v_permlane16_swap_b32 v35, v43
  v_mfma_f32_32x32x16_bf16 v[80:95], v[24:27], v[208:211], v[80:95]
  v_accvgpr_write_b32 a16, v32
  v_accvgpr_write_b32 a17, v33
  ds_read_b128 v[24:27], v10 offset:16640
  s_waitcnt lgkmcnt(3)
  v_mfma_f32_32x32x16_bf16 v[64:79], v[28:31], v[148:151], v[64:79]
  buffer_load_dwordx4 v7, s[56:59], s22 offen offset:3072 lds
  v_accvgpr_write_b32 a18, v34
  v_accvgpr_write_b32 a19, v35
  v_accvgpr_write_b32 a72, v40
  v_mfma_f32_32x32x16_bf16 v[80:95], v[28:31], v[212:215], v[80:95]
  v_accvgpr_write_b32 a73, v41
  v_accvgpr_write_b32 a74, v42
  ds_read_b128 v[28:31], v11 offset:16640
  s_waitcnt lgkmcnt(3)
  v_mfma_f32_32x32x16_bf16 v[64:79], v[16:19], v[152:155], v[64:79]
  v_accvgpr_write_b32 a75, v43
  v_mul_f32 v48, s52, v48
  v_mul_f32 v49, s52, v49
  v_mfma_f32_32x32x16_bf16 v[80:95], v[16:19], v[216:219], v[80:95]
  v_cvt_pk_bf16_f32 v48, v48, v49
  v_mul_f32 v50, s52, v50
  ds_read_b128 v[16:19], v12 offset:16640
  s_waitcnt lgkmcnt(3)
  v_mfma_f32_32x32x16_bf16 v[64:79], v[20:23], v[156:159], v[64:79]
  v_mul_f32 v51, s52, v51
  v_cvt_pk_bf16_f32 v49, v50, v51
  v_mul_f32 v52, s52, v52
  v_mfma_f32_32x32x16_bf16 v[80:95], v[20:23], v[220:223], v[80:95]
  v_mul_f32 v53, s52, v53
  v_cvt_pk_bf16_f32 v50, v52, v53
  ds_read_b128 v[20:23], v13 offset:16640
  s_waitcnt lgkmcnt(3)
  v_mfma_f32_32x32x16_bf16 v[64:79], v[24:27], v[160:163], v[64:79]
  v_mul_f32 v54, s52, v54
  v_mul_f32 v55, s52, v55
  v_cvt_pk_bf16_f32 v51, v54, v55
  v_mfma_f32_32x32x16_bf16 v[80:95], v[24:27], v[224:227], v[80:95]
  v_mul_f32 v56, s52, v56
  v_mul_f32 v57, s52, v57
  ds_read_b128 v[24:27], v14 offset:16640
  s_waitcnt lgkmcnt(3)
  v_mfma_f32_32x32x16_bf16 v[64:79], v[28:31], v[164:167], v[64:79]
  v_cvt_pk_bf16_f32 v56, v56, v57
  v_mul_f32 v58, s52, v58
  v_mul_f32 v59, s52, v59
  v_mfma_f32_32x32x16_bf16 v[80:95], v[28:31], v[228:231], v[80:95]
  v_cvt_pk_bf16_f32 v57, v58, v59
  v_mul_f32 v60, s52, v60
  ds_read_b128 v[28:31], v15 offset:16640
  s_waitcnt lgkmcnt(3)
  v_mfma_f32_32x32x16_bf16 v[64:79], v[16:19], v[168:171], v[64:79]
  v_mul_f32 v61, s52, v61
  v_cvt_pk_bf16_f32 v58, v60, v61
  v_mul_f32 v62, s52, v62
  v_mfma_f32_32x32x16_bf16 v[80:95], v[16:19], v[232:235], v[80:95]
  v_mul_f32 v63, s52, v63
  v_cvt_pk_bf16_f32 v59, v62, v63
  ds_read_b128 v[16:19], v8 offset:32768
  s_waitcnt lgkmcnt(3)
  v_mfma_f32_32x32x16_bf16 v[64:79], v[20:23], v[172:175], v[64:79]
  v_permlane16_swap_b32 v48, v56
  v_permlane16_swap_b32 v49, v57
  v_permlane16_swap_b32 v50, v58
  v_mfma_f32_32x32x16_bf16 v[80:95], v[20:23], v[236:239], v[80:95]
  v_permlane16_swap_b32 v51, v59
  v_accvgpr_write_b32 a128, v48
  ds_read_b128 v[20:23], v9 offset:32768
  s_waitcnt lgkmcnt(3)
  v_mfma_f32_32x32x16_bf16 v[64:79], v[24:27], v[176:179], v[64:79]
  v_accvgpr_write_b32 a129, v49
  v_accvgpr_write_b32 a130, v50
  v_accvgpr_write_b32 a131, v51
  v_mfma_f32_32x32x16_bf16 v[80:95], v[24:27], v[240:243], v[80:95]
  v_accvgpr_write_b32 a184, v56
  v_accvgpr_write_b32 a185, v57
  ds_read_b128 v[24:27], v10 offset:32768
  s_waitcnt lgkmcnt(3)
  v_mfma_f32_32x32x16_bf16 v[64:79], v[28:31], v[180:183], v[64:79]
  v_accvgpr_write_b32 a186, v58
  v_accvgpr_write_b32 a187, v59
  v_mfma_f32_32x32x16_bf16 v[80:95], v[28:31], v[244:247], v[80:95]
  ds_read_b128 v[28:31], v11 offset:32768
  s_waitcnt lgkmcnt(3)
  v_mfma_f32_32x32x16_bf16 v[32:47], v[16:19], v[120:123], 0
  v_mfma_f32_32x32x16_bf16 v[48:63], v[16:19], v[184:187], 0
  ds_read_b128 v[16:19], v12 offset:32768
  s_waitcnt lgkmcnt(3)
  v_mfma_f32_32x32x16_bf16 v[32:47], v[20:23], v[124:127], v[32:47]
  v_mul_f32 v64, s52, v64
  v_mul_f32 v65, s52, v65
  v_cvt_pk_bf16_f32 v64, v64, v65
  v_mfma_f32_32x32x16_bf16 v[48:63], v[20:23], v[188:191], v[48:63]
  v_mul_f32 v66, s52, v66
  v_mul_f32 v67, s52, v67
  ds_read_b128 v[20:23], v13 offset:32768
  s_waitcnt lgkmcnt(3)
  v_mfma_f32_32x32x16_bf16 v[32:47], v[24:27], v[128:131], v[32:47]
  v_cvt_pk_bf16_f32 v65, v66, v67
  v_mul_f32 v68, s52, v68
  v_mul_f32 v69, s52, v69
  v_mfma_f32_32x32x16_bf16 v[48:63], v[24:27], v[192:195], v[48:63]
  v_cvt_pk_bf16_f32 v66, v68, v69
  v_mul_f32 v70, s52, v70
  ds_read_b128 v[24:27], v14 offset:32768
  s_waitcnt lgkmcnt(3)
  v_mfma_f32_32x32x16_bf16 v[32:47], v[28:31], v[132:135], v[32:47]
  v_mul_f32 v71, s52, v71
  v_cvt_pk_bf16_f32 v67, v70, v71
  v_mul_f32 v72, s52, v72
  v_mfma_f32_32x32x16_bf16 v[48:63], v[28:31], v[196:199], v[48:63]
  v_mul_f32 v73, s52, v73
  v_cvt_pk_bf16_f32 v72, v72, v73
  ds_read_b128 v[28:31], v15 offset:32768
  s_waitcnt lgkmcnt(3)
  v_mfma_f32_32x32x16_bf16 v[32:47], v[16:19], v[136:139], v[32:47]
  v_mul_f32 v74, s52, v74
  v_mul_f32 v75, s52, v75
  v_cvt_pk_bf16_f32 v73, v74, v75
  v_mfma_f32_32x32x16_bf16 v[48:63], v[16:19], v[200:203], v[48:63]
  v_mul_f32 v76, s52, v76
  v_mul_f32 v77, s52, v77
  ds_read_b128 v[16:19], v8 offset:33024
  s_waitcnt lgkmcnt(3)
  v_mfma_f32_32x32x16_bf16 v[32:47], v[20:23], v[140:143], v[32:47]
  v_cvt_pk_bf16_f32 v74, v76, v77
  v_mul_f32 v78, s52, v78
  v_mul_f32 v79, s52, v79
  v_mfma_f32_32x32x16_bf16 v[48:63], v[20:23], v[204:207], v[48:63]
  v_cvt_pk_bf16_f32 v75, v78, v79
  v_permlane16_swap_b32 v64, v72
  ds_read_b128 v[20:23], v9 offset:33024
  s_waitcnt lgkmcnt(3)
  v_mfma_f32_32x32x16_bf16 v[32:47], v[24:27], v[144:147], v[32:47]
  v_permlane16_swap_b32 v65, v73
  v_permlane16_swap_b32 v66, v74
  v_permlane16_swap_b32 v67, v75
  v_mfma_f32_32x32x16_bf16 v[48:63], v[24:27], v[208:211], v[48:63]
  v_accvgpr_write_b32 a20, v64
  v_accvgpr_write_b32 a21, v65
  ds_read_b128 v[24:27], v10 offset:33024
  s_waitcnt lgkmcnt(3)
  v_mfma_f32_32x32x16_bf16 v[32:47], v[28:31], v[148:151], v[32:47]
  v_accvgpr_write_b32 a22, v66
  v_accvgpr_write_b32 a23, v67
  v_accvgpr_write_b32 a76, v72
  v_mfma_f32_32x32x16_bf16 v[48:63], v[28:31], v[212:215], v[48:63]
  v_accvgpr_write_b32 a77, v73
  v_accvgpr_write_b32 a78, v74
  ds_read_b128 v[28:31], v11 offset:33024
  s_waitcnt lgkmcnt(3)
  v_mfma_f32_32x32x16_bf16 v[32:47], v[16:19], v[152:155], v[32:47]
  v_accvgpr_write_b32 a79, v75
  v_mul_f32 v80, s52, v80
  v_mul_f32 v81, s52, v81
  v_mfma_f32_32x32x16_bf16 v[48:63], v[16:19], v[216:219], v[48:63]
  v_cvt_pk_bf16_f32 v80, v80, v81
  v_mul_f32 v82, s52, v82
  ds_read_b128 v[16:19], v12 offset:33024
  s_waitcnt lgkmcnt(3)
  v_mfma_f32_32x32x16_bf16 v[32:47], v[20:23], v[156:159], v[32:47]
  v_mul_f32 v83, s52, v83
  v_cvt_pk_bf16_f32 v81, v82, v83
  v_mul_f32 v84, s52, v84
  v_mfma_f32_32x32x16_bf16 v[48:63], v[20:23], v[220:223], v[48:63]
  v_mul_f32 v85, s52, v85
  v_cvt_pk_bf16_f32 v82, v84, v85
  ds_read_b128 v[20:23], v13 offset:33024
  s_waitcnt lgkmcnt(3)
  v_mfma_f32_32x32x16_bf16 v[32:47], v[24:27], v[160:163], v[32:47]
  v_mul_f32 v86, s52, v86
  v_mul_f32 v87, s52, v87
  v_cvt_pk_bf16_f32 v83, v86, v87
  v_mfma_f32_32x32x16_bf16 v[48:63], v[24:27], v[224:227], v[48:63]
  v_mul_f32 v88, s52, v88
  v_mul_f32 v89, s52, v89
  ds_read_b128 v[24:27], v14 offset:33024
  s_waitcnt lgkmcnt(3)
  v_mfma_f32_32x32x16_bf16 v[32:47], v[28:31], v[164:167], v[32:47]
  v_cvt_pk_bf16_f32 v88, v88, v89
  v_mul_f32 v90, s52, v90
  v_mul_f32 v91, s52, v91
  v_mfma_f32_32x32x16_bf16 v[48:63], v[28:31], v[228:231], v[48:63]
  v_cvt_pk_bf16_f32 v89, v90, v91
  v_mul_f32 v92, s52, v92
  ds_read_b128 v[28:31], v15 offset:33024
  s_waitcnt lgkmcnt(3)
  v_mfma_f32_32x32x16_bf16 v[32:47], v[16:19], v[168:171], v[32:47]
  v_mul_f32 v93, s52, v93
  v_cvt_pk_bf16_f32 v90, v92, v93
  v_mul_f32 v94, s52, v94
  v_mfma_f32_32x32x16_bf16 v[48:63], v[16:19], v[232:235], v[48:63]
  v_mul_f32 v95, s52, v95
  v_cvt_pk_bf16_f32 v91, v94, v95
  ds_read_b128 v[16:19], v8 offset:49152
  s_waitcnt lgkmcnt(3)
  v_mfma_f32_32x32x16_bf16 v[32:47], v[20:23], v[172:175], v[32:47]
  v_permlane16_swap_b32 v80, v88
  v_permlane16_swap_b32 v81, v89
  v_permlane16_swap_b32 v82, v90
  v_mfma_f32_32x32x16_bf16 v[48:63], v[20:23], v[236:239], v[48:63]
  v_permlane16_swap_b32 v83, v91
  v_accvgpr_write_b32 a132, v80
  ds_read_b128 v[20:23], v9 offset:49152
  s_waitcnt lgkmcnt(3)
  v_mfma_f32_32x32x16_bf16 v[32:47], v[24:27], v[176:179], v[32:47]
  v_accvgpr_write_b32 a133, v81
  v_accvgpr_write_b32 a134, v82
  v_accvgpr_write_b32 a135, v83
  v_mfma_f32_32x32x16_bf16 v[48:63], v[24:27], v[240:243], v[48:63]
  v_accvgpr_write_b32 a188, v88
  v_accvgpr_write_b32 a189, v89
  ds_read_b128 v[24:27], v10 offset:49152
  s_waitcnt lgkmcnt(3)
  v_mfma_f32_32x32x16_bf16 v[32:47], v[28:31], v[180:183], v[32:47]
  v_accvgpr_write_b32 a190, v90
  v_accvgpr_write_b32 a191, v91
  v_mfma_f32_32x32x16_bf16 v[48:63], v[28:31], v[244:247], v[48:63]
  s_waitcnt vmcnt(16)
  s_barrier
  ds_read_b128 v[28:31], v11 offset:49152
  s_waitcnt lgkmcnt(3)
  v_mfma_f32_32x32x16_bf16 v[64:79], v[16:19], v[120:123], 0
  v_mfma_f32_32x32x16_bf16 v[80:95], v[16:19], v[184:187], 0
  ds_read_b128 v[16:19], v12 offset:49152
  s_waitcnt lgkmcnt(3)
  v_mfma_f32_32x32x16_bf16 v[64:79], v[20:23], v[124:127], v[64:79]
  v_mul_f32 v32, s52, v32
  v_mul_f32 v33, s52, v33
  v_cvt_pk_bf16_f32 v32, v32, v33
  v_mfma_f32_32x32x16_bf16 v[80:95], v[20:23], v[188:191], v[80:95]
  v_mul_f32 v34, s52, v34
  v_mul_f32 v35, s52, v35
  ds_read_b128 v[20:23], v13 offset:49152
  s_waitcnt lgkmcnt(3)
  v_mfma_f32_32x32x16_bf16 v[64:79], v[24:27], v[128:131], v[64:79]
  v_cvt_pk_bf16_f32 v33, v34, v35
  v_mul_f32 v36, s52, v36
  v_mul_f32 v37, s52, v37
  v_mfma_f32_32x32x16_bf16 v[80:95], v[24:27], v[192:195], v[80:95]
  v_cvt_pk_bf16_f32 v34, v36, v37
  v_mul_f32 v38, s52, v38
  ds_read_b128 v[24:27], v14 offset:49152
  s_waitcnt lgkmcnt(3)
  v_mfma_f32_32x32x16_bf16 v[64:79], v[28:31], v[132:135], v[64:79]
  v_mul_f32 v39, s52, v39
  v_cvt_pk_bf16_f32 v35, v38, v39
  v_mul_f32 v40, s52, v40
  v_mfma_f32_32x32x16_bf16 v[80:95], v[28:31], v[196:199], v[80:95]
  v_mul_f32 v41, s52, v41
  v_cvt_pk_bf16_f32 v40, v40, v41
  ds_read_b128 v[28:31], v15 offset:49152
  s_waitcnt lgkmcnt(3)
  v_mfma_f32_32x32x16_bf16 v[64:79], v[16:19], v[136:139], v[64:79]
  buffer_load_dwordx4 v[100:103], v113, s[8:11], s28 offen sc1
  v_mul_f32 v42, s52, v42
  v_mul_f32 v43, s52, v43
  v_cvt_pk_bf16_f32 v41, v42, v43
  v_mfma_f32_32x32x16_bf16 v[80:95], v[16:19], v[200:203], v[80:95]
  v_mul_f32 v44, s52, v44
  v_mul_f32 v45, s52, v45
  ds_read_b128 v[16:19], v8 offset:49408
  s_waitcnt lgkmcnt(3)
  v_mfma_f32_32x32x16_bf16 v[64:79], v[20:23], v[140:143], v[64:79]
  v_cvt_pk_bf16_f32 v42, v44, v45
  v_mul_f32 v46, s52, v46
  v_mul_f32 v47, s52, v47
  v_mfma_f32_32x32x16_bf16 v[80:95], v[20:23], v[204:207], v[80:95]
  v_cvt_pk_bf16_f32 v43, v46, v47
  v_permlane16_swap_b32 v32, v40
  ds_read_b128 v[20:23], v9 offset:49408
  s_waitcnt lgkmcnt(3)
  v_mfma_f32_32x32x16_bf16 v[64:79], v[24:27], v[144:147], v[64:79]
  v_permlane16_swap_b32 v33, v41
  v_permlane16_swap_b32 v34, v42
  v_permlane16_swap_b32 v35, v43
  v_mfma_f32_32x32x16_bf16 v[80:95], v[24:27], v[208:211], v[80:95]
  v_accvgpr_write_b32 a24, v32
  v_accvgpr_write_b32 a25, v33
  ds_read_b128 v[24:27], v10 offset:49408
  s_waitcnt lgkmcnt(3)
  v_mfma_f32_32x32x16_bf16 v[64:79], v[28:31], v[148:151], v[64:79]
  v_accvgpr_write_b32 a26, v34
  v_accvgpr_write_b32 a27, v35
  v_accvgpr_write_b32 a80, v40
  v_mfma_f32_32x32x16_bf16 v[80:95], v[28:31], v[212:215], v[80:95]
  v_accvgpr_write_b32 a81, v41
  v_accvgpr_write_b32 a82, v42
  ds_read_b128 v[28:31], v11 offset:49408
  s_waitcnt lgkmcnt(3)
  v_mfma_f32_32x32x16_bf16 v[64:79], v[16:19], v[152:155], v[64:79]
  v_accvgpr_write_b32 a83, v43
  v_mul_f32 v48, s52, v48
  v_mul_f32 v49, s52, v49
  v_mfma_f32_32x32x16_bf16 v[80:95], v[16:19], v[216:219], v[80:95]
  v_cvt_pk_bf16_f32 v48, v48, v49
  v_mul_f32 v50, s52, v50
  ds_read_b128 v[16:19], v12 offset:49408
  s_waitcnt lgkmcnt(3)
  v_mfma_f32_32x32x16_bf16 v[64:79], v[20:23], v[156:159], v[64:79]
  v_mul_f32 v51, s52, v51
  v_cvt_pk_bf16_f32 v49, v50, v51
  v_mul_f32 v52, s52, v52
  v_mfma_f32_32x32x16_bf16 v[80:95], v[20:23], v[220:223], v[80:95]
  v_mul_f32 v53, s52, v53
  v_cvt_pk_bf16_f32 v50, v52, v53
  ds_read_b128 v[20:23], v13 offset:49408
  s_waitcnt lgkmcnt(3)
  v_mfma_f32_32x32x16_bf16 v[64:79], v[24:27], v[160:163], v[64:79]
  v_mul_f32 v54, s52, v54
  v_mul_f32 v55, s52, v55
  v_cvt_pk_bf16_f32 v51, v54, v55
  v_mfma_f32_32x32x16_bf16 v[80:95], v[24:27], v[224:227], v[80:95]
  v_mul_f32 v56, s52, v56
  v_mul_f32 v57, s52, v57
  ds_read_b128 v[24:27], v14 offset:49408
  s_waitcnt lgkmcnt(3)
  v_mfma_f32_32x32x16_bf16 v[64:79], v[28:31], v[164:167], v[64:79]
  v_cvt_pk_bf16_f32 v56, v56, v57
  v_mul_f32 v58, s52, v58
  v_mul_f32 v59, s52, v59
  v_mfma_f32_32x32x16_bf16 v[80:95], v[28:31], v[228:231], v[80:95]
  v_cvt_pk_bf16_f32 v57, v58, v59
  v_mul_f32 v60, s52, v60
  ds_read_b128 v[28:31], v15 offset:49408
  s_waitcnt lgkmcnt(3)
  v_mfma_f32_32x32x16_bf16 v[64:79], v[16:19], v[168:171], v[64:79]
  v_mul_f32 v61, s52, v61
  v_cvt_pk_bf16_f32 v58, v60, v61
  v_mul_f32 v62, s52, v62
  v_mfma_f32_32x32x16_bf16 v[80:95], v[16:19], v[232:235], v[80:95]
  v_mul_f32 v63, s52, v63
  v_cvt_pk_bf16_f32 v59, v62, v63
  v_xor_b32 v8, 196608, v8
  ds_read_b128 v[16:19], v8 offset:0
  s_waitcnt lgkmcnt(3)
  v_mfma_f32_32x32x16_bf16 v[64:79], v[20:23], v[172:175], v[64:79]
  v_permlane16_swap_b32 v48, v56
  v_permlane16_swap_b32 v49, v57
  v_permlane16_swap_b32 v50, v58
  v_mfma_f32_32x32x16_bf16 v[80:95], v[20:23], v[236:239], v[80:95]
  v_permlane16_swap_b32 v51, v59
  v_accvgpr_write_b32 a136, v48
  v_xor_b32 v9, 196608, v9
  ds_read_b128 v[20:23], v9 offset:0
  s_waitcnt lgkmcnt(3)
  v_mfma_f32_32x32x16_bf16 v[64:79], v[24:27], v[176:179], v[64:79]
  v_accvgpr_write_b32 a137, v49
  v_accvgpr_write_b32 a138, v50
  v_accvgpr_write_b32 a139, v51
  v_mfma_f32_32x32x16_bf16 v[80:95], v[24:27], v[240:243], v[80:95]
  v_accvgpr_write_b32 a192, v56
  v_accvgpr_write_b32 a193, v57
  v_xor_b32 v10, 196608, v10
  ds_read_b128 v[24:27], v10 offset:0
  s_waitcnt lgkmcnt(3)
  v_mfma_f32_32x32x16_bf16 v[64:79], v[28:31], v[180:183], v[64:79]
  v_accvgpr_write_b32 a194, v58
  v_accvgpr_write_b32 a195, v59
  v_mfma_f32_32x32x16_bf16 v[80:95], v[28:31], v[244:247], v[80:95]
  v_xor_b32 v11, 196608, v11
  ds_read_b128 v[28:31], v11 offset:0
  s_waitcnt lgkmcnt(3)
  v_mfma_f32_32x32x16_bf16 v[32:47], v[16:19], v[120:123], 0
  s_waitcnt vmcnt(0)
  v_cmp_ne_u64 vcc, s[88:89], v[100:101]
  v_cmp_ne_u64 s[54:55], s[88:89], v[102:103]
  s_add_u32 s48, s33, 0
  v_mfma_f32_32x32x16_bf16 v[48:63], v[16:19], v[184:187], 0
  v_xor_b32 v12, 196608, v12
  ds_read_b128 v[16:19], v12 offset:0
  s_waitcnt lgkmcnt(3)
  v_mfma_f32_32x32x16_bf16 v[32:47], v[20:23], v[124:127], v[32:47]
  s_or_b64 vcc, vcc, s[54:55]
  s_cselect_b32 s48, 0x10000000, s48
  s_add_u32 s22, s48, 0
  buffer_load_dwordx4 a[224:227], v2, s[8:11], s22 offen sc1
  v_mul_f32 v64, s52, v64
  v_mul_f32 v65, s52, v65
  v_cvt_pk_bf16_f32 v64, v64, v65
  v_mfma_f32_32x32x16_bf16 v[48:63], v[20:23], v[188:191], v[48:63]
  v_mul_f32 v66, s52, v66
  v_mul_f32 v67, s52, v67
  v_xor_b32 v13, 196608, v13
  ds_read_b128 v[20:23], v13 offset:0
  s_waitcnt lgkmcnt(3)
  v_mfma_f32_32x32x16_bf16 v[32:47], v[24:27], v[128:131], v[32:47]
  v_cvt_pk_bf16_f32 v65, v66, v67
  v_mul_f32 v68, s52, v68
  v_mul_f32 v69, s52, v69
  v_mfma_f32_32x32x16_bf16 v[48:63], v[24:27], v[192:195], v[48:63]
  v_cvt_pk_bf16_f32 v66, v68, v69
  v_mul_f32 v70, s52, v70
  v_xor_b32 v14, 196608, v14
  ds_read_b128 v[24:27], v14 offset:0
  s_waitcnt lgkmcnt(3)
  v_mfma_f32_32x32x16_bf16 v[32:47], v[28:31], v[132:135], v[32:47]
  s_add_u32 s22, s48, 1024
  buffer_load_dwordx4 a[228:231], v2, s[8:11], s22 offen sc1
  v_mul_f32 v71, s52, v71
  v_cvt_pk_bf16_f32 v67, v70, v71
  v_mul_f32 v72, s52, v72
  v_mfma_f32_32x32x16_bf16 v[48:63], v[28:31], v[196:199], v[48:63]
  v_mul_f32 v73, s52, v73
  v_cvt_pk_bf16_f32 v72, v72, v73
  v_xor_b32 v15, 196608, v15
  ds_read_b128 v[28:31], v15 offset:0
  s_waitcnt lgkmcnt(3)
  v_mfma_f32_32x32x16_bf16 v[32:47], v[16:19], v[136:139], v[32:47]
  v_mul_f32 v74, s52, v74
  v_mul_f32 v75, s52, v75
  v_cvt_pk_bf16_f32 v73, v74, v75
  v_mfma_f32_32x32x16_bf16 v[48:63], v[16:19], v[200:203], v[48:63]
  v_mul_f32 v76, s52, v76
  v_mul_f32 v77, s52, v77
  ds_read_b128 v[16:19], v8 offset:256
  s_waitcnt lgkmcnt(3)
  v_mfma_f32_32x32x16_bf16 v[32:47], v[20:23], v[140:143], v[32:47]
  s_add_u32 s22, s48, 2048
  buffer_load_dwordx4 a[232:235], v2, s[8:11], s22 offen sc1
  v_cvt_pk_bf16_f32 v74, v76, v77
  v_mul_f32 v78, s52, v78
  v_mul_f32 v79, s52, v79
  v_mfma_f32_32x32x16_bf16 v[48:63], v[20:23], v[204:207], v[48:63]
  v_cvt_pk_bf16_f32 v75, v78, v79
  v_permlane16_swap_b32 v64, v72
  ds_read_b128 v[20:23], v9 offset:256
  s_waitcnt lgkmcnt(3)
  v_mfma_f32_32x32x16_bf16 v[32:47], v[24:27], v[144:147], v[32:47]
  v_permlane16_swap_b32 v65, v73
  v_permlane16_swap_b32 v66, v74
  v_permlane16_swap_b32 v67, v75
  v_mfma_f32_32x32x16_bf16 v[48:63], v[24:27], v[208:211], v[48:63]
  v_accvgpr_write_b32 a28, v64
  v_accvgpr_write_b32 a29, v65
  ds_read_b128 v[24:27], v10 offset:256
  s_waitcnt lgkmcnt(3)
  v_mfma_f32_32x32x16_bf16 v[32:47], v[28:31], v[148:151], v[32:47]
  s_add_u32 s22, s48, 3072
  buffer_load_dwordx4 a[236:239], v2, s[8:11], s22 offen sc1
  v_accvgpr_write_b32 a30, v66
  v_accvgpr_write_b32 a31, v67
  v_accvgpr_write_b32 a84, v72
  v_mfma_f32_32x32x16_bf16 v[48:63], v[28:31], v[212:215], v[48:63]
  v_accvgpr_write_b32 a85, v73
  v_accvgpr_write_b32 a86, v74
  ds_read_b128 v[28:31], v11 offset:256
  s_waitcnt lgkmcnt(3)
  v_mfma_f32_32x32x16_bf16 v[32:47], v[16:19], v[152:155], v[32:47]
  v_accvgpr_write_b32 a87, v75
  v_mul_f32 v80, s52, v80
  v_mul_f32 v81, s52, v81
  v_mfma_f32_32x32x16_bf16 v[48:63], v[16:19], v[216:219], v[48:63]
  v_cvt_pk_bf16_f32 v80, v80, v81
  v_mul_f32 v82, s52, v82
  ds_read_b128 v[16:19], v12 offset:256
  s_waitcnt lgkmcnt(3)
  v_mfma_f32_32x32x16_bf16 v[32:47], v[20:23], v[156:159], v[32:47]
  s_add_u32 s22, s48, 4096
  buffer_load_dwordx4 a[240:243], v2, s[8:11], s22 offen sc1
  v_mul_f32 v83, s52, v83
  v_cvt_pk_bf16_f32 v81, v82, v83
  v_mul_f32 v84, s52, v84
  v_mfma_f32_32x32x16_bf16 v[48:63], v[20:23], v[220:223], v[48:63]
  v_mul_f32 v85, s52, v85
  v_cvt_pk_bf16_f32 v82, v84, v85
  ds_read_b128 v[20:23], v13 offset:256
  s_waitcnt lgkmcnt(3)
  v_mfma_f32_32x32x16_bf16 v[32:47], v[24:27], v[160:163], v[32:47]
  v_mul_f32 v86, s52, v86
  v_mul_f32 v87, s52, v87
  v_cvt_pk_bf16_f32 v83, v86, v87
  v_mfma_f32_32x32x16_bf16 v[48:63], v[24:27], v[224:227], v[48:63]
  v_mul_f32 v88, s52, v88
  v_mul_f32 v89, s52, v89
  ds_read_b128 v[24:27], v14 offset:256
  s_waitcnt lgkmcnt(3)
  v_mfma_f32_32x32x16_bf16 v[32:47], v[28:31], v[164:167], v[32:47]
  s_add_u32 s22, s48, 5120
  buffer_load_dwordx4 a[244:247], v2, s[8:11], s22 offen sc1
  v_cvt_pk_bf16_f32 v88, v88, v89
  v_mul_f32 v90, s52, v90
  v_mul_f32 v91, s52, v91
  v_mfma_f32_32x32x16_bf16 v[48:63], v[28:31], v[228:231], v[48:63]
  v_cvt_pk_bf16_f32 v89, v90, v91
  v_mul_f32 v92, s52, v92
  ds_read_b128 v[28:31], v15 offset:256
  s_waitcnt lgkmcnt(3)
  v_mfma_f32_32x32x16_bf16 v[32:47], v[16:19], v[168:171], v[32:47]
  v_mul_f32 v93, s52, v93
  v_cvt_pk_bf16_f32 v90, v92, v93
  v_mul_f32 v94, s52, v94
  v_mfma_f32_32x32x16_bf16 v[48:63], v[16:19], v[232:235], v[48:63]
  v_mul_f32 v95, s52, v95
  v_cvt_pk_bf16_f32 v91, v94, v95
  v_xor_b32 v8, 131072, v8
  ds_read_b128 v[16:19], v8 offset:0
  s_waitcnt lgkmcnt(3)
  v_mfma_f32_32x32x16_bf16 v[32:47], v[20:23], v[172:175], v[32:47]
  s_add_u32 s22, s48, 6144
  buffer_load_dwordx4 a[248:251], v2, s[8:11], s22 offen sc1
  v_permlane16_swap_b32 v80, v88
  v_permlane16_swap_b32 v81, v89
  v_permlane16_swap_b32 v82, v90
  v_mfma_f32_32x32x16_bf16 v[48:63], v[20:23], v[236:239], v[48:63]
  v_permlane16_swap_b32 v83, v91
  v_accvgpr_write_b32 a140, v80
  v_xor_b32 v9, 131072, v9
  ds_read_b128 v[20:23], v9 offset:0
  s_waitcnt lgkmcnt(3)
  v_mfma_f32_32x32x16_bf16 v[32:47], v[24:27], v[176:179], v[32:47]
  v_accvgpr_write_b32 a141, v81
  v_accvgpr_write_b32 a142, v82
  v_accvgpr_write_b32 a143, v83
  v_mfma_f32_32x32x16_bf16 v[48:63], v[24:27], v[240:243], v[48:63]
  v_accvgpr_write_b32 a196, v88
  v_accvgpr_write_b32 a197, v89
  v_xor_b32 v10, 131072, v10
  ds_read_b128 v[24:27], v10 offset:0
  s_waitcnt lgkmcnt(3)
  v_mfma_f32_32x32x16_bf16 v[32:47], v[28:31], v[180:183], v[32:47]
  s_add_u32 s22, s48, 7168
  buffer_load_dwordx4 a[252:255], v2, s[8:11], s22 offen sc1
  v_accvgpr_write_b32 a198, v90
  v_accvgpr_write_b32 a199, v91
  v_mfma_f32_32x32x16_bf16 v[48:63], v[28:31], v[244:247], v[48:63]
  s_barrier
  v_xor_b32 v11, 131072, v11
  ds_read_b128 v[28:31], v11 offset:0
  s_waitcnt lgkmcnt(3)
  v_mfma_f32_32x32x16_bf16 v[64:79], v[16:19], v[120:123], 0
  v_mfma_f32_32x32x16_bf16 v[80:95], v[16:19], v[184:187], 0
  v_xor_b32 v12, 131072, v12
  ds_read_b128 v[16:19], v12 offset:0
  s_waitcnt lgkmcnt(3)
  v_mfma_f32_32x32x16_bf16 v[64:79], v[20:23], v[124:127], v[64:79]
  s_add_u32 s22, s48, 8192
  s_add_u32 m0, s25, 81920
  s_nop 0
  buffer_load_dwordx4 v2, s[8:11], s22 offen sc1 lds
  v_mul_f32 v32, s52, v32
  v_mul_f32 v33, s52, v33
  v_cvt_pk_bf16_f32 v32, v32, v33
  v_mfma_f32_32x32x16_bf16 v[80:95], v[20:23], v[188:191], v[80:95]
  v_mul_f32 v34, s52, v34
  v_mul_f32 v35, s52, v35
  v_xor_b32 v13, 131072, v13
  ds_read_b128 v[20:23], v13 offset:0
  s_waitcnt lgkmcnt(3)
  v_mfma_f32_32x32x16_bf16 v[64:79], v[24:27], v[128:131], v[64:79]
  v_cvt_pk_bf16_f32 v33, v34, v35
  v_mul_f32 v36, s52, v36
  v_mul_f32 v37, s52, v37
  v_mfma_f32_32x32x16_bf16 v[80:95], v[24:27], v[192:195], v[80:95]
  v_cvt_pk_bf16_f32 v34, v36, v37
  v_mul_f32 v38, s52, v38
  v_xor_b32 v14, 131072, v14
  ds_read_b128 v[24:27], v14 offset:0
  s_waitcnt lgkmcnt(3)
  v_mfma_f32_32x32x16_bf16 v[64:79], v[28:31], v[132:135], v[64:79]
  s_add_u32 s22, s48, 9216
  s_add_u32 m0, s25, 82944
  s_nop 0
  buffer_load_dwordx4 v2, s[8:11], s22 offen sc1 lds
  v_mul_f32 v39, s52, v39
  v_cvt_pk_bf16_f32 v35, v38, v39
  v_mul_f32 v40, s52, v40
  v_mfma_f32_32x32x16_bf16 v[80:95], v[28:31], v[196:199], v[80:95]
  v_mul_f32 v41, s52, v41
  v_cvt_pk_bf16_f32 v40, v40, v41
  v_xor_b32 v15, 131072, v15
  ds_read_b128 v[28:31], v15 offset:0
  s_waitcnt lgkmcnt(3)
  v_mfma_f32_32x32x16_bf16 v[64:79], v[16:19], v[136:139], v[64:79]
  buffer_load_dwordx4 v[100:103], v113, s[8:11], s28 offen sc1
  v_mul_f32 v42, s52, v42
  v_mul_f32 v43, s52, v43
  v_cvt_pk_bf16_f32 v41, v42, v43
  v_mfma_f32_32x32x16_bf16 v[80:95], v[16:19], v[200:203], v[80:95]
  v_mul_f32 v44, s52, v44
  v_mul_f32 v45, s52, v45
  ds_read_b128 v[16:19], v8 offset:256
  s_waitcnt lgkmcnt(3)
  v_mfma_f32_32x32x16_bf16 v[64:79], v[20:23], v[140:143], v[64:79]
  s_add_u32 s22, s48, 10240
  s_add_u32 m0, s25, 83968
  s_nop 0
  buffer_load_dwordx4 v2, s[8:11], s22 offen sc1 lds
  v_cvt_pk_bf16_f32 v42, v44, v45
  v_mul_f32 v46, s52, v46
  v_mul_f32 v47, s52, v47
  v_mfma_f32_32x32x16_bf16 v[80:95], v[20:23], v[204:207], v[80:95]
  v_cvt_pk_bf16_f32 v43, v46, v47
  v_permlane16_swap_b32 v32, v40
  ds_read_b128 v[20:23], v9 offset:256
  s_waitcnt lgkmcnt(3)
  v_mfma_f32_32x32x16_bf16 v[64:79], v[24:27], v[144:147], v[64:79]
  v_permlane16_swap_b32 v33, v41
  v_permlane16_swap_b32 v34, v42
  v_permlane16_swap_b32 v35, v43
  v_mfma_f32_32x32x16_bf16 v[80:95], v[24:27], v[208:211], v[80:95]
  v_accvgpr_write_b32 a32, v32
  v_accvgpr_write_b32 a33, v33
  ds_read_b128 v[24:27], v10 offset:256
  s_waitcnt lgkmcnt(3)
  v_mfma_f32_32x32x16_bf16 v[64:79], v[28:31], v[148:151], v[64:79]
  s_add_u32 s22, s48, 11264
  s_add_u32 m0, s25, 84992
  s_nop 0
  buffer_load_dwordx4 v2, s[8:11], s22 offen sc1 lds
  v_accvgpr_write_b32 a34, v34
  v_accvgpr_write_b32 a35, v35
  v_accvgpr_write_b32 a88, v40
  v_mfma_f32_32x32x16_bf16 v[80:95], v[28:31], v[212:215], v[80:95]
  v_accvgpr_write_b32 a89, v41
  v_accvgpr_write_b32 a90, v42
  ds_read_b128 v[28:31], v11 offset:256
  s_waitcnt lgkmcnt(3)
  v_mfma_f32_32x32x16_bf16 v[64:79], v[16:19], v[152:155], v[64:79]
  v_accvgpr_write_b32 a91, v43
  v_mul_f32 v48, s52, v48
  v_mul_f32 v49, s52, v49
  v_mfma_f32_32x32x16_bf16 v[80:95], v[16:19], v[216:219], v[80:95]
  v_cvt_pk_bf16_f32 v48, v48, v49
  v_mul_f32 v50, s52, v50
  ds_read_b128 v[16:19], v12 offset:256
  s_waitcnt lgkmcnt(3)
  v_mfma_f32_32x32x16_bf16 v[64:79], v[20:23], v[156:159], v[64:79]
  s_add_u32 s22, s48, 12288
  s_add_u32 m0, s25, 98304
  s_nop 0
  buffer_load_dwordx4 v2, s[8:11], s22 offen sc1 lds
  v_mul_f32 v51, s52, v51
  v_cvt_pk_bf16_f32 v49, v50, v51
  v_mul_f32 v52, s52, v52
  v_mfma_f32_32x32x16_bf16 v[80:95], v[20:23], v[220:223], v[80:95]
  v_mul_f32 v53, s52, v53
  v_cvt_pk_bf16_f32 v50, v52, v53
  ds_read_b128 v[20:23], v13 offset:256
  s_waitcnt lgkmcnt(3)
  v_mfma_f32_32x32x16_bf16 v[64:79], v[24:27], v[160:163], v[64:79]
  v_mul_f32 v54, s52, v54
  v_mul_f32 v55, s52, v55
  v_cvt_pk_bf16_f32 v51, v54, v55
  v_mfma_f32_32x32x16_bf16 v[80:95], v[24:27], v[224:227], v[80:95]
  v_mul_f32 v56, s52, v56
  v_mul_f32 v57, s52, v57
  ds_read_b128 v[24:27], v14 offset:256
  s_waitcnt lgkmcnt(3)
  v_mfma_f32_32x32x16_bf16 v[64:79], v[28:31], v[164:167], v[64:79]
  s_add_u32 s22, s48, 13312
  s_add_u32 m0, s25, 99328
  s_nop 0
  buffer_load_dwordx4 v2, s[8:11], s22 offen sc1 lds
  v_cvt_pk_bf16_f32 v56, v56, v57
  v_mul_f32 v58, s52, v58
  v_mul_f32 v59, s52, v59
  v_mfma_f32_32x32x16_bf16 v[80:95], v[28:31], v[228:231], v[80:95]
  v_cvt_pk_bf16_f32 v57, v58, v59
  v_mul_f32 v60, s52, v60
  ds_read_b128 v[28:31], v15 offset:256
  s_waitcnt lgkmcnt(3)
  v_mfma_f32_32x32x16_bf16 v[64:79], v[16:19], v[168:171], v[64:79]
  v_mul_f32 v61, s52, v61
  v_cvt_pk_bf16_f32 v58, v60, v61
  v_mul_f32 v62, s52, v62
  v_mfma_f32_32x32x16_bf16 v[80:95], v[16:19], v[232:235], v[80:95]
  v_mul_f32 v63, s52, v63
  v_cvt_pk_bf16_f32 v59, v62, v63
  ds_read_b128 v[16:19], v8 offset:16384
  s_waitcnt lgkmcnt(3)
  v_mfma_f32_32x32x16_bf16 v[64:79], v[20:23], v[172:175], v[64:79]
  v_permlane16_swap_b32 v48, v56
  v_permlane16_swap_b32 v49, v57
  v_permlane16_swap_b32 v50, v58
  v_mfma_f32_32x32x16_bf16 v[80:95], v[20:23], v[236:239], v[80:95]
  v_permlane16_swap_b32 v51, v59
  v_accvgpr_write_b32 a144, v48
  ds_read_b128 v[20:23], v9 offset:16384
  s_waitcnt lgkmcnt(3)
  v_mfma_f32_32x32x16_bf16 v[64:79], v[24:27], v[176:179], v[64:79]
  v_accvgpr_write_b32 a145, v49
  v_accvgpr_write_b32 a146, v50
  v_accvgpr_write_b32 a147, v51
  v_mfma_f32_32x32x16_bf16 v[80:95], v[24:27], v[240:243], v[80:95]
  v_accvgpr_write_b32 a200, v56
  v_accvgpr_write_b32 a201, v57
  ds_read_b128 v[24:27], v10 offset:16384
  s_waitcnt lgkmcnt(3)
  v_mfma_f32_32x32x16_bf16 v[64:79], v[28:31], v[180:183], v[64:79]
  v_accvgpr_write_b32 a202, v58
  v_accvgpr_write_b32 a203, v59
  v_mfma_f32_32x32x16_bf16 v[80:95], v[28:31], v[244:247], v[80:95]
  ds_read_b128 v[28:31], v11 offset:16384
  s_waitcnt lgkmcnt(3)
  v_mfma_f32_32x32x16_bf16 v[32:47], v[16:19], v[120:123], 0
  s_waitcnt vmcnt(4)
  v_cmp_ne_u64 vcc, s[88:89], v[100:101]
  v_cmp_ne_u64 s[54:55], s[88:89], v[102:103]
  s_add_u32 s49, s33, 14336
  v_mfma_f32_32x32x16_bf16 v[48:63], v[16:19], v[184:187], 0
  ds_read_b128 v[16:19], v12 offset:16384
  s_waitcnt lgkmcnt(3)
  v_mfma_f32_32x32x16_bf16 v[32:47], v[20:23], v[124:127], v[32:47]
  s_or_b64 vcc, vcc, s[54:55]
  s_cselect_b32 s49, 0x10000000, s49
  s_add_u32 s22, s49, 0
  s_add_u32 m0, s25, 100352
  s_nop 0
  buffer_load_dwordx4 v2, s[8:11], s22 offen sc1 lds
  v_mul_f32 v64, s52, v64
  v_mul_f32 v65, s52, v65
  v_cvt_pk_bf16_f32 v64, v64, v65
  v_mfma_f32_32x32x16_bf16 v[48:63], v[20:23], v[188:191], v[48:63]
  v_mul_f32 v66, s52, v66
  v_mul_f32 v67, s52, v67
  ds_read_b128 v[20:23], v13 offset:16384
  s_waitcnt lgkmcnt(3)
  v_mfma_f32_32x32x16_bf16 v[32:47], v[24:27], v[128:131], v[32:47]
  v_cvt_pk_bf16_f32 v65, v66, v67
  v_mul_f32 v68, s52, v68
  v_mul_f32 v69, s52, v69
  v_mfma_f32_32x32x16_bf16 v[48:63], v[24:27], v[192:195], v[48:63]
  v_cvt_pk_bf16_f32 v66, v68, v69
  v_mul_f32 v70, s52, v70
  ds_read_b128 v[24:27], v14 offset:16384
  s_waitcnt lgkmcnt(3)
  v_mfma_f32_32x32x16_bf16 v[32:47], v[28:31], v[132:135], v[32:47]
  s_add_u32 s22, s49, 1024
  s_add_u32 m0, s25, 101376
  s_nop 0
  buffer_load_dwordx4 v2, s[8:11], s22 offen sc1 lds
  v_mul_f32 v71, s52, v71
  v_cvt_pk_bf16_f32 v67, v70, v71
  v_mul_f32 v72, s52, v72
  v_mfma_f32_32x32x16_bf16 v[48:63], v[28:31], v[196:199], v[48:63]
  v_mul_f32 v73, s52, v73
  v_cvt_pk_bf16_f32 v72, v72, v73
  ds_read_b128 v[28:31], v15 offset:16384
  s_waitcnt lgkmcnt(3)
  v_mfma_f32_32x32x16_bf16 v[32:47], v[16:19], v[136:139], v[32:47]
  v_mul_f32 v74, s52, v74
  v_mul_f32 v75, s52, v75
  v_cvt_pk_bf16_f32 v73, v74, v75
  v_mfma_f32_32x32x16_bf16 v[48:63], v[16:19], v[200:203], v[48:63]
  v_mul_f32 v76, s52, v76
  v_mul_f32 v77, s52, v77
  ds_read_b128 v[16:19], v8 offset:16640
  s_waitcnt lgkmcnt(3)
  v_mfma_f32_32x32x16_bf16 v[32:47], v[20:23], v[140:143], v[32:47]
  s_add_u32 s22, s49, 2048
  s_add_u32 m0, s25, 147456
  s_nop 0
  buffer_load_dwordx4 v2, s[8:11], s22 offen sc1 lds
  v_cvt_pk_bf16_f32 v74, v76, v77
  v_mul_f32 v78, s52, v78
  v_mul_f32 v79, s52, v79
  v_mfma_f32_32x32x16_bf16 v[48:63], v[20:23], v[204:207], v[48:63]
  v_cvt_pk_bf16_f32 v75, v78, v79
  v_permlane16_swap_b32 v64, v72
  ds_read_b128 v[20:23], v9 offset:16640
  s_waitcnt lgkmcnt(3)
  v_mfma_f32_32x32x16_bf16 v[32:47], v[24:27], v[144:147], v[32:47]
  v_permlane16_swap_b32 v65, v73
  v_permlane16_swap_b32 v66, v74
  v_permlane16_swap_b32 v67, v75
  v_mfma_f32_32x32x16_bf16 v[48:63], v[24:27], v[208:211], v[48:63]
  v_accvgpr_write_b32 a36, v64
  v_accvgpr_write_b32 a37, v65
  ds_read_b128 v[24:27], v10 offset:16640
  s_waitcnt lgkmcnt(3)
  v_mfma_f32_32x32x16_bf16 v[32:47], v[28:31], v[148:151], v[32:47]
  s_add_u32 s22, s49, 3072
  s_add_u32 m0, s25, 148480
  s_nop 0
  buffer_load_dwordx4 v2, s[8:11], s22 offen sc1 lds
  v_accvgpr_write_b32 a38, v66
  v_accvgpr_write_b32 a39, v67
  v_accvgpr_write_b32 a92, v72
  v_mfma_f32_32x32x16_bf16 v[48:63], v[28:31], v[212:215], v[48:63]
  v_accvgpr_write_b32 a93, v73
  v_accvgpr_write_b32 a94, v74
  ds_read_b128 v[28:31], v11 offset:16640
  s_waitcnt lgkmcnt(3)
  v_mfma_f32_32x32x16_bf16 v[32:47], v[16:19], v[152:155], v[32:47]
  v_accvgpr_write_b32 a95, v75
  v_mul_f32 v80, s52, v80
  v_mul_f32 v81, s52, v81
  v_mfma_f32_32x32x16_bf16 v[48:63], v[16:19], v[216:219], v[48:63]
  v_cvt_pk_bf16_f32 v80, v80, v81
  v_mul_f32 v82, s52, v82
  ds_read_b128 v[16:19], v12 offset:16640
  s_waitcnt lgkmcnt(3)
  v_mfma_f32_32x32x16_bf16 v[32:47], v[20:23], v[156:159], v[32:47]
  s_add_u32 s22, s49, 4096
  s_add_u32 m0, s25, 149504
  s_nop 0
  buffer_load_dwordx4 v2, s[8:11], s22 offen sc1 lds
  v_mul_f32 v83, s52, v83
  v_cvt_pk_bf16_f32 v81, v82, v83
  v_mul_f32 v84, s52, v84
  v_mfma_f32_32x32x16_bf16 v[48:63], v[20:23], v[220:223], v[48:63]
  v_mul_f32 v85, s52, v85
  v_cvt_pk_bf16_f32 v82, v84, v85
  ds_read_b128 v[20:23], v13 offset:16640
  s_waitcnt lgkmcnt(3)
  v_mfma_f32_32x32x16_bf16 v[32:47], v[24:27], v[160:163], v[32:47]
  v_mul_f32 v86, s52, v86
  v_mul_f32 v87, s52, v87
  v_cvt_pk_bf16_f32 v83, v86, v87
  v_mfma_f32_32x32x16_bf16 v[48:63], v[24:27], v[224:227], v[48:63]
  v_mul_f32 v88, s52, v88
  v_mul_f32 v89, s52, v89
  ds_read_b128 v[24:27], v14 offset:16640
  s_waitcnt lgkmcnt(3)
  v_mfma_f32_32x32x16_bf16 v[32:47], v[28:31], v[164:167], v[32:47]
  s_add_u32 s22, s49, 5120
  s_add_u32 m0, s25, 150528
  s_nop 0
  buffer_load_dwordx4 v2, s[8:11], s22 offen sc1 lds
  v_cvt_pk_bf16_f32 v88, v88, v89
  v_mul_f32 v90, s52, v90
  v_mul_f32 v91, s52, v91
  v_mfma_f32_32x32x16_bf16 v[48:63], v[28:31], v[228:231], v[48:63]
  v_cvt_pk_bf16_f32 v89, v90, v91
  v_mul_f32 v92, s52, v92
  ds_read_b128 v[28:31], v15 offset:16640
  s_waitcnt lgkmcnt(3)
  v_mfma_f32_32x32x16_bf16 v[32:47], v[16:19], v[168:171], v[32:47]
  v_mul_f32 v93, s52, v93
  v_cvt_pk_bf16_f32 v90, v92, v93
  v_mul_f32 v94, s52, v94
  v_mfma_f32_32x32x16_bf16 v[48:63], v[16:19], v[232:235], v[48:63]
  v_mul_f32 v95, s52, v95
  v_cvt_pk_bf16_f32 v91, v94, v95
  ds_read_b128 v[16:19], v8 offset:32768
  s_waitcnt lgkmcnt(3)
  v_mfma_f32_32x32x16_bf16 v[32:47], v[20:23], v[172:175], v[32:47]
  s_add_u32 s22, s49, 6144
  s_add_u32 m0, s25, 114688
  s_nop 0
  buffer_load_dwordx4 v2, s[8:11], s22 offen sc1 lds
  v_permlane16_swap_b32 v80, v88
  v_permlane16_swap_b32 v81, v89
  v_permlane16_swap_b32 v82, v90
  v_mfma_f32_32x32x16_bf16 v[48:63], v[20:23], v[236:239], v[48:63]
  v_permlane16_swap_b32 v83, v91
  v_accvgpr_write_b32 a148, v80
  ds_read_b128 v[20:23], v9 offset:32768
  s_waitcnt lgkmcnt(3)
  v_mfma_f32_32x32x16_bf16 v[32:47], v[24:27], v[176:179], v[32:47]
  v_accvgpr_write_b32 a149, v81
  v_accvgpr_write_b32 a150, v82
  v_accvgpr_write_b32 a151, v83
  v_mfma_f32_32x32x16_bf16 v[48:63], v[24:27], v[240:243], v[48:63]
  v_accvgpr_write_b32 a204, v88
  v_accvgpr_write_b32 a205, v89
  ds_read_b128 v[24:27], v10 offset:32768
  s_waitcnt lgkmcnt(3)
  v_mfma_f32_32x32x16_bf16 v[32:47], v[28:31], v[180:183], v[32:47]
  s_add_u32 s22, s49, 7168
  s_add_u32 m0, s25, 115712
  s_nop 0
  buffer_load_dwordx4 v2, s[8:11], s22 offen sc1 lds
  v_accvgpr_write_b32 a206, v90
  v_accvgpr_write_b32 a207, v91
  v_mfma_f32_32x32x16_bf16 v[48:63], v[28:31], v[244:247], v[48:63]
  s_barrier
  ds_read_b128 v[28:31], v11 offset:32768
  s_waitcnt lgkmcnt(3)
  v_mfma_f32_32x32x16_bf16 v[64:79], v[16:19], v[120:123], 0
  v_mfma_f32_32x32x16_bf16 v[80:95], v[16:19], v[184:187], 0
  ds_read_b128 v[16:19], v12 offset:32768
  s_waitcnt lgkmcnt(3)
  v_mfma_f32_32x32x16_bf16 v[64:79], v[20:23], v[124:127], v[64:79]
  s_add_u32 s22, s49, 8192
  s_add_u32 m0, s25, 116736
  s_nop 0
  buffer_load_dwordx4 v2, s[8:11], s22 offen sc1 lds
  v_mul_f32 v32, s52, v32
  v_mul_f32 v33, s52, v33
  v_cvt_pk_bf16_f32 v32, v32, v33
  v_mfma_f32_32x32x16_bf16 v[80:95], v[20:23], v[188:191], v[80:95]
  v_mul_f32 v34, s52, v34
  v_mul_f32 v35, s52, v35
  ds_read_b128 v[20:23], v13 offset:32768
  s_waitcnt lgkmcnt(3)
  v_mfma_f32_32x32x16_bf16 v[64:79], v[24:27], v[128:131], v[64:79]
  v_cvt_pk_bf16_f32 v33, v34, v35
  v_mul_f32 v36, s52, v36
  v_mul_f32 v37, s52, v37
  v_mfma_f32_32x32x16_bf16 v[80:95], v[24:27], v[192:195], v[80:95]
  v_cvt_pk_bf16_f32 v34, v36, v37
  v_mul_f32 v38, s52, v38
  ds_read_b128 v[24:27], v14 offset:32768
  s_waitcnt lgkmcnt(3)
  v_mfma_f32_32x32x16_bf16 v[64:79], v[28:31], v[132:135], v[64:79]
  s_add_u32 s22, s49, 9216
  s_add_u32 m0, s25, 117760
  s_nop 0
  buffer_load_dwordx4 v2, s[8:11], s22 offen sc1 lds
  v_mul_f32 v39, s52, v39
  v_cvt_pk_bf16_f32 v35, v38, v39
  v_mul_f32 v40, s52, v40
  v_mfma_f32_32x32x16_bf16 v[80:95], v[28:31], v[196:199], v[80:95]
  v_mul_f32 v41, s52, v41
  v_cvt_pk_bf16_f32 v40, v40, v41
  ds_read_b128 v[28:31], v15 offset:32768
  s_waitcnt lgkmcnt(3)
  v_mfma_f32_32x32x16_bf16 v[64:79], v[16:19], v[136:139], v[64:79]
  buffer_load_dwordx4 v[100:103], v113, s[8:11], s28 offen sc1
  v_mul_f32 v42, s52, v42
  v_mul_f32 v43, s52, v43
  v_cvt_pk_bf16_f32 v41, v42, v43
  v_mfma_f32_32x32x16_bf16 v[80:95], v[16:19], v[200:203], v[80:95]
  v_mul_f32 v44, s52, v44
  v_mul_f32 v45, s52, v45
  ds_read_b128 v[16:19], v8 offset:33024
  s_waitcnt lgkmcnt(3)
  v_mfma_f32_32x32x16_bf16 v[64:79], v[20:23], v[140:143], v[64:79]
  s_add_u32 s22, s49, 10240
  s_add_u32 m0, s25, 131072
  s_nop 0
  buffer_load_dwordx4 v2, s[8:11], s22 offen sc1 lds
  v_cvt_pk_bf16_f32 v42, v44, v45
  v_mul_f32 v46, s52, v46
  v_mul_f32 v47, s52, v47
  v_mfma_f32_32x32x16_bf16 v[80:95], v[20:23], v[204:207], v[80:95]
  v_cvt_pk_bf16_f32 v43, v46, v47
  v_permlane16_swap_b32 v32, v40
  ds_read_b128 v[20:23], v9 offset:33024
  s_waitcnt lgkmcnt(3)
  v_mfma_f32_32x32x16_bf16 v[64:79], v[24:27], v[144:147], v[64:79]
  v_permlane16_swap_b32 v33, v41
  v_permlane16_swap_b32 v34, v42
  v_permlane16_swap_b32 v35, v43
  v_mfma_f32_32x32x16_bf16 v[80:95], v[24:27], v[208:211], v[80:95]
  v_accvgpr_write_b32 a40, v32
  v_accvgpr_write_b32 a41, v33
  ds_read_b128 v[24:27], v10 offset:33024
  s_waitcnt lgkmcnt(3)
  v_mfma_f32_32x32x16_bf16 v[64:79], v[28:31], v[148:151], v[64:79]
  s_add_u32 s22, s49, 11264
  s_add_u32 m0, s25, 132096
  s_nop 0
  buffer_load_dwordx4 v2, s[8:11], s22 offen sc1 lds
  v_accvgpr_write_b32 a42, v34
  v_accvgpr_write_b32 a43, v35
  v_accvgpr_write_b32 a96, v40
  v_mfma_f32_32x32x16_bf16 v[80:95], v[28:31], v[212:215], v[80:95]
  v_accvgpr_write_b32 a97, v41
  v_accvgpr_write_b32 a98, v42
  ds_read_b128 v[28:31], v11 offset:33024
  s_waitcnt lgkmcnt(3)
  v_mfma_f32_32x32x16_bf16 v[64:79], v[16:19], v[152:155], v[64:79]
  v_accvgpr_write_b32 a99, v43
  v_mul_f32 v48, s52, v48
  v_mul_f32 v49, s52, v49
  v_mfma_f32_32x32x16_bf16 v[80:95], v[16:19], v[216:219], v[80:95]
  v_cvt_pk_bf16_f32 v48, v48, v49
  v_mul_f32 v50, s52, v50
  ds_read_b128 v[16:19], v12 offset:33024
  s_waitcnt lgkmcnt(3)
  v_mfma_f32_32x32x16_bf16 v[64:79], v[20:23], v[156:159], v[64:79]
  s_add_u32 s22, s49, 12288
  s_add_u32 m0, s25, 133120
  s_nop 0
  buffer_load_dwordx4 v2, s[8:11], s22 offen sc1 lds
  v_mul_f32 v51, s52, v51
  v_cvt_pk_bf16_f32 v49, v50, v51
  v_mul_f32 v52, s52, v52
  v_mfma_f32_32x32x16_bf16 v[80:95], v[20:23], v[220:223], v[80:95]
  v_mul_f32 v53, s52, v53
  v_cvt_pk_bf16_f32 v50, v52, v53
  ds_read_b128 v[20:23], v13 offset:33024
  s_waitcnt lgkmcnt(3)
  v_mfma_f32_32x32x16_bf16 v[64:79], v[24:27], v[160:163], v[64:79]
  v_mul_f32 v54, s52, v54
  v_mul_f32 v55, s52, v55
  v_cvt_pk_bf16_f32 v51, v54, v55
  v_mfma_f32_32x32x16_bf16 v[80:95], v[24:27], v[224:227], v[80:95]
  v_mul_f32 v56, s52, v56
  v_mul_f32 v57, s52, v57
  ds_read_b128 v[24:27], v14 offset:33024
  s_waitcnt lgkmcnt(3)
  v_mfma_f32_32x32x16_bf16 v[64:79], v[28:31], v[164:167], v[64:79]
  s_add_u32 s22, s49, 13312
  s_add_u32 m0, s25, 134144
  s_nop 0
  buffer_load_dwordx4 v2, s[8:11], s22 offen sc1 lds
  v_cvt_pk_bf16_f32 v56, v56, v57
  v_mul_f32 v58, s52, v58
  v_mul_f32 v59, s52, v59
  v_mfma_f32_32x32x16_bf16 v[80:95], v[28:31], v[228:231], v[80:95]
  v_cvt_pk_bf16_f32 v57, v58, v59
  v_mul_f32 v60, s52, v60
  ds_read_b128 v[28:31], v15 offset:33024
  s_waitcnt lgkmcnt(3)
  v_mfma_f32_32x32x16_bf16 v[64:79], v[16:19], v[168:171], v[64:79]
  v_mul_f32 v61, s52, v61
  v_cvt_pk_bf16_f32 v58, v60, v61
  v_mul_f32 v62, s52, v62
  v_mfma_f32_32x32x16_bf16 v[80:95], v[16:19], v[232:235], v[80:95]
  v_mul_f32 v63, s52, v63
  v_cvt_pk_bf16_f32 v59, v62, v63
  ds_read_b128 v[16:19], v8 offset:49152
  s_waitcnt lgkmcnt(3)
  v_mfma_f32_32x32x16_bf16 v[64:79], v[20:23], v[172:175], v[64:79]
  v_permlane16_swap_b32 v48, v56
  v_permlane16_swap_b32 v49, v57
  v_permlane16_swap_b32 v50, v58
  v_mfma_f32_32x32x16_bf16 v[80:95], v[20:23], v[236:239], v[80:95]
  v_permlane16_swap_b32 v51, v59
  v_accvgpr_write_b32 a152, v48
  ds_read_b128 v[20:23], v9 offset:49152
  s_waitcnt lgkmcnt(3)
  v_mfma_f32_32x32x16_bf16 v[64:79], v[24:27], v[176:179], v[64:79]
  v_accvgpr_write_b32 a153, v49
  v_accvgpr_write_b32 a154, v50
  v_accvgpr_write_b32 a155, v51
  v_mfma_f32_32x32x16_bf16 v[80:95], v[24:27], v[240:243], v[80:95]
  v_accvgpr_write_b32 a208, v56
  v_accvgpr_write_b32 a209, v57
  ds_read_b128 v[24:27], v10 offset:49152
  s_waitcnt lgkmcnt(3)
  v_mfma_f32_32x32x16_bf16 v[64:79], v[28:31], v[180:183], v[64:79]
  v_accvgpr_write_b32 a210, v58
  v_accvgpr_write_b32 a211, v59
  v_mfma_f32_32x32x16_bf16 v[80:95], v[28:31], v[244:247], v[80:95]
  ds_read_b128 v[28:31], v11 offset:49152
  s_waitcnt lgkmcnt(3)
  v_mfma_f32_32x32x16_bf16 v[32:47], v[16:19], v[120:123], 0
  s_waitcnt vmcnt(4)
  v_cmp_ne_u64 vcc, s[88:89], v[100:101]
  v_cmp_ne_u64 s[54:55], s[88:89], v[102:103]
  s_add_u32 s50, s32, 0
  v_mfma_f32_32x32x16_bf16 v[48:63], v[16:19], v[184:187], 0
  ds_read_b128 v[16:19], v12 offset:49152
  s_waitcnt lgkmcnt(3)
  v_mfma_f32_32x32x16_bf16 v[32:47], v[20:23], v[124:127], v[32:47]
  s_or_b64 vcc, vcc, s[54:55]
  s_cselect_b32 s50, 0x10000000, s50
  s_add_u32 s22, s50, 12288
  buffer_load_dwordx4 v[248:251], v2, s[8:11], s22 offen sc1
  v_mul_f32 v64, s52, v64
  v_mul_f32 v65, s52, v65
  v_cvt_pk_bf16_f32 v64, v64, v65
  v_mfma_f32_32x32x16_bf16 v[48:63], v[20:23], v[188:191], v[48:63]
  v_mul_f32 v66, s52, v66
  v_mul_f32 v67, s52, v67
  ds_read_b128 v[20:23], v13 offset:49152
  s_waitcnt lgkmcnt(3)
  v_mfma_f32_32x32x16_bf16 v[32:47], v[24:27], v[128:131], v[32:47]
  s_add_u32 s22, s50, 13312
  buffer_load_dwordx4 v[252:255], v2, s[8:11], s22 offen sc1
  v_cvt_pk_bf16_f32 v65, v66, v67
  v_mul_f32 v68, s52, v68
  v_mul_f32 v69, s52, v69
  v_mfma_f32_32x32x16_bf16 v[48:63], v[24:27], v[192:195], v[48:63]
  v_cvt_pk_bf16_f32 v66, v68, v69
  v_mul_f32 v70, s52, v70
  ds_read_b128 v[24:27], v14 offset:49152
  s_waitcnt lgkmcnt(3)
  v_mfma_f32_32x32x16_bf16 v[32:47], v[28:31], v[132:135], v[32:47]
  s_add_u32 s22, s50, 0
  s_add_u32 m0, s25, 0
  s_nop 0
  buffer_load_dwordx4 v2, s[8:11], s22 offen sc1 lds
  v_mul_f32 v71, s52, v71
  v_cvt_pk_bf16_f32 v67, v70, v71
  v_mul_f32 v72, s52, v72
  v_mfma_f32_32x32x16_bf16 v[48:63], v[28:31], v[196:199], v[48:63]
  v_mul_f32 v73, s52, v73
  v_cvt_pk_bf16_f32 v72, v72, v73
  ds_read_b128 v[28:31], v15 offset:49152
  s_waitcnt lgkmcnt(3)
  v_mfma_f32_32x32x16_bf16 v[32:47], v[16:19], v[136:139], v[32:47]
  s_add_u32 s22, s50, 1024
  s_add_u32 m0, s25, 1024
  s_nop 0
  buffer_load_dwordx4 v2, s[8:11], s22 offen sc1 lds
  v_mul_f32 v74, s52, v74
  v_mul_f32 v75, s52, v75
  v_cvt_pk_bf16_f32 v73, v74, v75
  v_mfma_f32_32x32x16_bf16 v[48:63], v[16:19], v[200:203], v[48:63]
  v_mul_f32 v76, s52, v76
  v_mul_f32 v77, s52, v77
  ds_read_b128 v[16:19], v8 offset:49408
  s_waitcnt lgkmcnt(3)
  v_mfma_f32_32x32x16_bf16 v[32:47], v[20:23], v[140:143], v[32:47]
  s_add_u32 s22, s50, 2048
  s_add_u32 m0, s25, 2048
  s_nop 0
  buffer_load_dwordx4 v2, s[8:11], s22 offen sc1 lds
  v_cvt_pk_bf16_f32 v74, v76, v77
  v_mul_f32 v78, s52, v78
  v_mul_f32 v79, s52, v79
  v_mfma_f32_32x32x16_bf16 v[48:63], v[20:23], v[204:207], v[48:63]
  v_cvt_pk_bf16_f32 v75, v78, v79
  v_permlane16_swap_b32 v64, v72
  ds_read_b128 v[20:23], v9 offset:49408
  s_waitcnt lgkmcnt(3)
  v_mfma_f32_32x32x16_bf16 v[32:47], v[24:27], v[144:147], v[32:47]
  s_add_u32 s22, s50, 3072
  s_add_u32 m0, s25, 3072
  s_nop 0
  buffer_load_dwordx4 v2, s[8:11], s22 offen sc1 lds
  v_permlane16_swap_b32 v65, v73
  v_permlane16_swap_b32 v66, v74
  v_permlane16_swap_b32 v67, v75
  v_mfma_f32_32x32x16_bf16 v[48:63], v[24:27], v[208:211], v[48:63]
  v_accvgpr_write_b32 a44, v64
  v_accvgpr_write_b32 a45, v65
  ds_read_b128 v[24:27], v10 offset:49408
  s_waitcnt lgkmcnt(3)
  v_mfma_f32_32x32x16_bf16 v[32:47], v[28:31], v[148:151], v[32:47]
  s_add_u32 s22, s50, 4096
  s_add_u32 m0, s25, 16384
  s_nop 0
  buffer_load_dwordx4 v2, s[8:11], s22 offen sc1 lds
  v_accvgpr_write_b32 a46, v66
  v_accvgpr_write_b32 a47, v67
  v_accvgpr_write_b32 a100, v72
  v_mfma_f32_32x32x16_bf16 v[48:63], v[28:31], v[212:215], v[48:63]
  v_accvgpr_write_b32 a101, v73
  v_accvgpr_write_b32 a102, v74
  ds_read_b128 v[28:31], v11 offset:49408
  s_waitcnt lgkmcnt(3)
  v_mfma_f32_32x32x16_bf16 v[32:47], v[16:19], v[152:155], v[32:47]
  s_add_u32 s22, s50, 5120
  s_add_u32 m0, s25, 17408
  s_nop 0
  buffer_load_dwordx4 v2, s[8:11], s22 offen sc1 lds
  v_accvgpr_write_b32 a103, v75
  v_mul_f32 v80, s52, v80
  v_mul_f32 v81, s52, v81
  v_mfma_f32_32x32x16_bf16 v[48:63], v[16:19], v[216:219], v[48:63]
  v_cvt_pk_bf16_f32 v80, v80, v81
  v_mul_f32 v82, s52, v82
  ds_read_b128 v[16:19], v12 offset:49408
  s_waitcnt lgkmcnt(3)
  v_mfma_f32_32x32x16_bf16 v[32:47], v[20:23], v[156:159], v[32:47]
  s_add_u32 s22, s50, 6144
  s_add_u32 m0, s25, 18432
  s_nop 0
  buffer_load_dwordx4 v2, s[8:11], s22 offen sc1 lds
  v_mul_f32 v83, s52, v83
  v_cvt_pk_bf16_f32 v81, v82, v83
  v_mul_f32 v84, s52, v84
  v_mfma_f32_32x32x16_bf16 v[48:63], v[20:23], v[220:223], v[48:63]
  v_mul_f32 v85, s52, v85
  v_cvt_pk_bf16_f32 v82, v84, v85
  ds_read_b128 v[20:23], v13 offset:49408
  s_waitcnt lgkmcnt(3)
  v_mfma_f32_32x32x16_bf16 v[32:47], v[24:27], v[160:163], v[32:47]
  s_add_u32 s22, s50, 7168
  s_add_u32 m0, s25, 19456
  s_nop 0
  buffer_load_dwordx4 v2, s[8:11], s22 offen sc1 lds
  v_mul_f32 v86, s52, v86
  v_mul_f32 v87, s52, v87
  v_cvt_pk_bf16_f32 v83, v86, v87
  v_mfma_f32_32x32x16_bf16 v[48:63], v[24:27], v[224:227], v[48:63]
  v_mul_f32 v88, s52, v88
  v_mul_f32 v89, s52, v89
  ds_read_b128 v[24:27], v14 offset:49408
  s_waitcnt lgkmcnt(3)
  v_mfma_f32_32x32x16_bf16 v[32:47], v[28:31], v[164:167], v[32:47]
  v_cvt_pk_bf16_f32 v88, v88, v89
  v_mul_f32 v90, s52, v90
  v_mul_f32 v91, s52, v91
  v_mfma_f32_32x32x16_bf16 v[48:63], v[28:31], v[228:231], v[48:63]
  v_cvt_pk_bf16_f32 v89, v90, v91
  v_mul_f32 v92, s52, v92
  ds_read_b128 v[28:31], v15 offset:49408
  s_waitcnt lgkmcnt(3)
  v_mfma_f32_32x32x16_bf16 v[32:47], v[16:19], v[168:171], v[32:47]
  v_mul_f32 v93, s52, v93
  v_cvt_pk_bf16_f32 v90, v92, v93
  v_mul_f32 v94, s52, v94
  v_mfma_f32_32x32x16_bf16 v[48:63], v[16:19], v[232:235], v[48:63]
  v_mul_f32 v95, s52, v95
  v_cvt_pk_bf16_f32 v91, v94, v95
  v_xor_b32 v8, 65536, v8
  ds_read_b128 v[16:19], v8 offset:0
  s_waitcnt lgkmcnt(3)
  v_mfma_f32_32x32x16_bf16 v[32:47], v[20:23], v[172:175], v[32:47]
  v_permlane16_swap_b32 v80, v88
  v_permlane16_swap_b32 v81, v89
  v_permlane16_swap_b32 v82, v90
  v_mfma_f32_32x32x16_bf16 v[48:63], v[20:23], v[236:239], v[48:63]
  v_permlane16_swap_b32 v83, v91
  v_accvgpr_write_b32 a156, v80
  v_xor_b32 v9, 65536, v9
  ds_read_b128 v[20:23], v9 offset:0
  s_waitcnt lgkmcnt(3)
  v_mfma_f32_32x32x16_bf16 v[32:47], v[24:27], v[176:179], v[32:47]
  v_accvgpr_write_b32 a157, v81
  v_accvgpr_write_b32 a158, v82
  v_accvgpr_write_b32 a159, v83
  v_mfma_f32_32x32x16_bf16 v[48:63], v[24:27], v[240:243], v[48:63]
  v_accvgpr_write_b32 a212, v88
  v_accvgpr_write_b32 a213, v89
  v_xor_b32 v10, 65536, v10
  ds_read_b128 v[24:27], v10 offset:0
  s_waitcnt lgkmcnt(3)
  v_mfma_f32_32x32x16_bf16 v[32:47], v[28:31], v[180:183], v[32:47]
  v_accvgpr_write_b32 a214, v90
  v_accvgpr_write_b32 a215, v91
  v_mfma_f32_32x32x16_bf16 v[48:63], v[28:31], v[244:247], v[48:63]
  s_barrier
  v_xor_b32 v11, 65536, v11
  ds_read_b128 v[28:31], v11 offset:0
  s_waitcnt lgkmcnt(3)
  v_mfma_f32_32x32x16_bf16 v[64:79], v[16:19], v[120:123], 0
  s_add_u32 s22, s50, 8192
  s_add_u32 m0, s25, 32768
  s_nop 0
  buffer_load_dwordx4 v2, s[8:11], s22 offen sc1 lds
  v_mfma_f32_32x32x16_bf16 v[80:95], v[16:19], v[184:187], 0
  v_xor_b32 v12, 65536, v12
  ds_read_b128 v[16:19], v12 offset:0
  s_waitcnt lgkmcnt(3)
  v_mfma_f32_32x32x16_bf16 v[64:79], v[20:23], v[124:127], v[64:79]
  s_add_u32 s22, s50, 9216
  s_add_u32 m0, s25, 33792
  s_nop 0
  buffer_load_dwordx4 v2, s[8:11], s22 offen sc1 lds
  v_mul_f32 v32, s52, v32
  v_mul_f32 v33, s52, v33
  v_cvt_pk_bf16_f32 v32, v32, v33
  v_mfma_f32_32x32x16_bf16 v[80:95], v[20:23], v[188:191], v[80:95]
  v_mul_f32 v34, s52, v34
  v_mul_f32 v35, s52, v35
  v_xor_b32 v13, 65536, v13
  ds_read_b128 v[20:23], v13 offset:0
  s_waitcnt lgkmcnt(3)
  v_mfma_f32_32x32x16_bf16 v[64:79], v[24:27], v[128:131], v[64:79]
  s_add_u32 s22, s50, 10240
  s_add_u32 m0, s25, 34816
  s_nop 0
  buffer_load_dwordx4 v2, s[8:11], s22 offen sc1 lds
  v_cvt_pk_bf16_f32 v33, v34, v35
  v_mul_f32 v36, s52, v36
  v_mul_f32 v37, s52, v37
  v_mfma_f32_32x32x16_bf16 v[80:95], v[24:27], v[192:195], v[80:95]
  v_cvt_pk_bf16_f32 v34, v36, v37
  v_mul_f32 v38, s52, v38
  v_xor_b32 v14, 65536, v14
  ds_read_b128 v[24:27], v14 offset:0
  s_waitcnt lgkmcnt(3)
  v_mfma_f32_32x32x16_bf16 v[64:79], v[28:31], v[132:135], v[64:79]
  s_add_u32 s22, s50, 11264
  s_add_u32 m0, s25, 35840
  s_nop 0
  buffer_load_dwordx4 v2, s[8:11], s22 offen sc1 lds
  v_mul_f32 v39, s52, v39
  v_cvt_pk_bf16_f32 v35, v38, v39
  v_mul_f32 v40, s52, v40
  v_mfma_f32_32x32x16_bf16 v[80:95], v[28:31], v[196:199], v[80:95]
  v_mul_f32 v41, s52, v41
  v_cvt_pk_bf16_f32 v40, v40, v41
  v_xor_b32 v15, 65536, v15
  ds_read_b128 v[28:31], v15 offset:0
  s_waitcnt lgkmcnt(3)
  v_mfma_f32_32x32x16_bf16 v[64:79], v[16:19], v[136:139], v[64:79]
  buffer_load_dwordx4 v[100:103], v113, s[8:11], s28 offen sc1
  buffer_load_dwordx4 v[104:107], v2, s[8:11], s29 offen sc1
  buffer_load_dwordx4 v[108:111], v112, s[8:11], s29 offen sc1
  v_mul_f32 v42, s52, v42
  v_mul_f32 v43, s52, v43
  v_cvt_pk_bf16_f32 v41, v42, v43
  v_mfma_f32_32x32x16_bf16 v[80:95], v[16:19], v[200:203], v[80:95]
  v_mul_f32 v44, s52, v44
  v_mul_f32 v45, s52, v45
  ds_read_b128 v[16:19], v8 offset:256
  s_waitcnt lgkmcnt(3)
  v_mfma_f32_32x32x16_bf16 v[64:79], v[20:23], v[140:143], v[64:79]
  v_cvt_pk_bf16_f32 v42, v44, v45
  v_mul_f32 v46, s52, v46
  v_mul_f32 v47, s52, v47
  v_mfma_f32_32x32x16_bf16 v[80:95], v[20:23], v[204:207], v[80:95]
  v_cvt_pk_bf16_f32 v43, v46, v47
  v_permlane16_swap_b32 v32, v40
  ds_read_b128 v[20:23], v9 offset:256
  s_waitcnt lgkmcnt(3)
  v_mfma_f32_32x32x16_bf16 v[64:79], v[24:27], v[144:147], v[64:79]
  v_permlane16_swap_b32 v33, v41
  v_permlane16_swap_b32 v34, v42
  v_permlane16_swap_b32 v35, v43
  v_mfma_f32_32x32x16_bf16 v[80:95], v[24:27], v[208:211], v[80:95]
  v_accvgpr_write_b32 a48, v32
  v_accvgpr_write_b32 a49, v33
  ds_read_b128 v[24:27], v10 offset:256
  s_waitcnt lgkmcnt(3)
  v_mfma_f32_32x32x16_bf16 v[64:79], v[28:31], v[148:151], v[64:79]
  v_accvgpr_write_b32 a50, v34
  v_accvgpr_write_b32 a51, v35
  v_accvgpr_write_b32 a104, v40
  v_mfma_f32_32x32x16_bf16 v[80:95], v[28:31], v[212:215], v[80:95]
  v_accvgpr_write_b32 a105, v41
  v_accvgpr_write_b32 a106, v42
  ds_read_b128 v[28:31], v11 offset:256
  s_waitcnt lgkmcnt(3)
  v_mfma_f32_32x32x16_bf16 v[64:79], v[16:19], v[152:155], v[64:79]
  v_accvgpr_write_b32 a107, v43
  v_mul_f32 v48, s52, v48
  v_mul_f32 v49, s52, v49
  v_mfma_f32_32x32x16_bf16 v[80:95], v[16:19], v[216:219], v[80:95]
  v_cvt_pk_bf16_f32 v48, v48, v49
  v_mul_f32 v50, s52, v50
  ds_read_b128 v[16:19], v12 offset:256
  s_waitcnt lgkmcnt(3)
  v_mfma_f32_32x32x16_bf16 v[64:79], v[20:23], v[156:159], v[64:79]
  v_mul_f32 v51, s52, v51
  v_cvt_pk_bf16_f32 v49, v50, v51
  v_mul_f32 v52, s52, v52
  v_mfma_f32_32x32x16_bf16 v[80:95], v[20:23], v[220:223], v[80:95]
  v_mul_f32 v53, s52, v53
  v_cvt_pk_bf16_f32 v50, v52, v53
  ds_read_b128 v[20:23], v13 offset:256
  s_waitcnt lgkmcnt(3)
  v_mfma_f32_32x32x16_bf16 v[64:79], v[24:27], v[160:163], v[64:79]
  v_mul_f32 v54, s52, v54
  v_mul_f32 v55, s52, v55
  v_cvt_pk_bf16_f32 v51, v54, v55
  v_mfma_f32_32x32x16_bf16 v[80:95], v[24:27], v[224:227], v[80:95]
  v_mul_f32 v56, s52, v56
  v_mul_f32 v57, s52, v57
  ds_read_b128 v[24:27], v14 offset:256
  s_waitcnt lgkmcnt(3)
  v_mfma_f32_32x32x16_bf16 v[64:79], v[28:31], v[164:167], v[64:79]
  v_cvt_pk_bf16_f32 v56, v56, v57
  v_mul_f32 v58, s52, v58
  v_mul_f32 v59, s52, v59
  v_mfma_f32_32x32x16_bf16 v[80:95], v[28:31], v[228:231], v[80:95]
  v_cvt_pk_bf16_f32 v57, v58, v59
  v_mul_f32 v60, s52, v60
  ds_read_b128 v[28:31], v15 offset:256
  s_waitcnt lgkmcnt(3)
  v_mfma_f32_32x32x16_bf16 v[64:79], v[16:19], v[168:171], v[64:79]
  v_mul_f32 v61, s52, v61
  v_cvt_pk_bf16_f32 v58, v60, v61
  v_mul_f32 v62, s52, v62
  v_mfma_f32_32x32x16_bf16 v[80:95], v[16:19], v[232:235], v[80:95]
  v_mul_f32 v63, s52, v63
  v_cvt_pk_bf16_f32 v59, v62, v63
  s_waitcnt lgkmcnt(2)
  v_mfma_f32_32x32x16_bf16 v[64:79], v[20:23], v[172:175], v[64:79]
  v_permlane16_swap_b32 v48, v56
  v_permlane16_swap_b32 v49, v57
  v_permlane16_swap_b32 v50, v58
  v_mfma_f32_32x32x16_bf16 v[80:95], v[20:23], v[236:239], v[80:95]
  v_permlane16_swap_b32 v51, v59
  v_accvgpr_write_b32 a160, v48
  s_waitcnt lgkmcnt(1)
  v_mfma_f32_32x32x16_bf16 v[64:79], v[24:27], v[176:179], v[64:79]
  v_accvgpr_write_b32 a161, v49
  v_accvgpr_write_b32 a162, v50
  v_accvgpr_write_b32 a163, v51
  v_mfma_f32_32x32x16_bf16 v[80:95], v[24:27], v[240:243], v[80:95]
  v_accvgpr_write_b32 a216, v56
  v_accvgpr_write_b32 a217, v57
  s_waitcnt lgkmcnt(0)
  v_mfma_f32_32x32x16_bf16 v[64:79], v[28:31], v[180:183], v[64:79]
  v_accvgpr_write_b32 a218, v58
  v_accvgpr_write_b32 a219, v59
  v_mfma_f32_32x32x16_bf16 v[80:95], v[28:31], v[244:247], v[80:95]
  s_nop 4
  v_mul_f32 v64, s52, v64
  v_mul_f32 v65, s52, v65
  v_cvt_pk_bf16_f32 v64, v64, v65
  v_mul_f32 v66, s52, v66
  v_mul_f32 v67, s52, v67
  v_cvt_pk_bf16_f32 v65, v66, v67
  v_mul_f32 v68, s52, v68
  v_mul_f32 v69, s52, v69
  v_cvt_pk_bf16_f32 v66, v68, v69
  v_mul_f32 v70, s52, v70
  v_mul_f32 v71, s52, v71
  v_cvt_pk_bf16_f32 v67, v70, v71
  v_mul_f32 v72, s52, v72
  v_mul_f32 v73, s52, v73
  v_cvt_pk_bf16_f32 v72, v72, v73
  v_mul_f32 v74, s52, v74
  v_mul_f32 v75, s52, v75
  v_cvt_pk_bf16_f32 v73, v74, v75
  v_mul_f32 v76, s52, v76
  v_mul_f32 v77, s52, v77
  v_cvt_pk_bf16_f32 v74, v76, v77
  v_mul_f32 v78, s52, v78
  v_mul_f32 v79, s52, v79
  v_cvt_pk_bf16_f32 v75, v78, v79
  v_permlane16_swap_b32 v64, v72
  v_permlane16_swap_b32 v65, v73
  v_permlane16_swap_b32 v66, v74
  v_permlane16_swap_b32 v67, v75
  v_accvgpr_write_b32 a52, v64
  v_accvgpr_write_b32 a53, v65
  v_accvgpr_write_b32 a54, v66
  v_accvgpr_write_b32 a55, v67
  v_accvgpr_write_b32 a108, v72
  v_accvgpr_write_b32 a109, v73
  v_accvgpr_write_b32 a110, v74
  v_accvgpr_write_b32 a111, v75
  v_mul_f32 v80, s52, v80
  v_mul_f32 v81, s52, v81
  v_cvt_pk_bf16_f32 v80, v80, v81
  v_mul_f32 v82, s52, v82
  v_mul_f32 v83, s52, v83
  v_cvt_pk_bf16_f32 v81, v82, v83
  v_mul_f32 v84, s52, v84
  v_mul_f32 v85, s52, v85
  v_cvt_pk_bf16_f32 v82, v84, v85
  v_mul_f32 v86, s52, v86
  v_mul_f32 v87, s52, v87
  v_cvt_pk_bf16_f32 v83, v86, v87
  v_mul_f32 v88, s52, v88
  v_mul_f32 v89, s52, v89
  v_cvt_pk_bf16_f32 v88, v88, v89
  v_mul_f32 v90, s52, v90
  v_mul_f32 v91, s52, v91
  v_cvt_pk_bf16_f32 v89, v90, v91
  v_mul_f32 v92, s52, v92
  v_mul_f32 v93, s52, v93
  v_cvt_pk_bf16_f32 v90, v92, v93
  v_mul_f32 v94, s52, v94
  v_mul_f32 v95, s52, v95
  v_cvt_pk_bf16_f32 v91, v94, v95
  v_permlane16_swap_b32 v80, v88
  v_permlane16_swap_b32 v81, v89
  v_permlane16_swap_b32 v82, v90
  v_permlane16_swap_b32 v83, v91
  v_accvgpr_write_b32 a164, v80
  v_accvgpr_write_b32 a165, v81
  v_accvgpr_write_b32 a166, v82
  v_accvgpr_write_b32 a167, v83
  v_accvgpr_write_b32 a220, v88
  v_accvgpr_write_b32 a221, v89
  v_accvgpr_write_b32 a222, v90
  v_accvgpr_write_b32 a223, v91
  s_mov_b32 s30, 0
  s_branch sc_aw_w
sc_aw:
  buffer_load_dwordx4 v[100:103], v113, s[8:11], s28 offen sc1
  buffer_load_dwordx4 v[104:107], v2, s[8:11], s29 offen sc1
  buffer_load_dwordx4 v[108:111], v112, s[8:11], s29 offen sc1
sc_aw_w:
  s_waitcnt vmcnt(0)
  v_cmp_ne_u64 vcc, s[88:89], v[100:101]
  s_cbranch_vccnz sc_aw_no
  v_cmp_ne_u64 vcc, s[88:89], v[102:103]
  s_cbranch_vccnz sc_aw_no
  v_cmp_ne_u64 vcc, s[88:89], v[104:105]
  s_cbranch_vccnz sc_aw_no
  v_cmp_ne_u64 vcc, s[88:89], v[106:107]
  s_cbranch_vccnz sc_aw_no
  v_cmp_ne_u64 vcc, s[88:89], v[108:109]
  s_cbranch_vccnz sc_aw_no
  v_cmp_ne_u64 vcc, s[88:89], v[110:111]
  s_cbranch_vccnz sc_aw_no
  s_branch sc_aw_ok
sc_aw_no:
  s_sleep 1
  s_add_u32 s30, s30, 1
  s_cmp_lt_u32 s30, 50000
  s_cbranch_scc1 sc_aw
  s_branch cA_abort
sc_aw_ok:
  v_add_u32 v4, s25, v2
  v_add_u32 v5, 0x10000, v4
  v_add_u32 v6, 0x20000, v4
  s_cmp_eq_u32 s48, 0x10000000
  s_cbranch_scc1 sc_d0
  ds_read_b128 v[120:123], v5 offset:16384
  ds_read_b128 v[124:127], v5 offset:17408
  ds_read_b128 v[128:131], v5 offset:18432
  ds_read_b128 v[132:135], v5 offset:19456
  ds_read_b128 v[136:139], v5 offset:32768
  ds_read_b128 v[140:143], v5 offset:33792
  s_waitcnt lgkmcnt(0)
  s_branch sc_e0
sc_d0:
  s_add_u32 s22, s33, 0
  buffer_load_dwordx4 a[224:227], v2, s[8:11], s22 offen offset:0 sc1
  buffer_load_dwordx4 a[228:231], v2, s[8:11], s22 offen offset:1024 sc1
  buffer_load_dwordx4 a[232:235], v2, s[8:11], s22 offen offset:2048 sc1
  buffer_load_dwordx4 a[236:239], v2, s[8:11], s22 offen offset:3072 sc1
  s_add_u32 s22, s33, 4096
  buffer_load_dwordx4 a[240:243], v2, s[8:11], s22 offen offset:0 sc1
  buffer_load_dwordx4 a[244:247], v2, s[8:11], s22 offen offset:1024 sc1
  buffer_load_dwordx4 a[248:251], v2, s[8:11], s22 offen offset:2048 sc1
  buffer_load_dwordx4 a[252:255], v2, s[8:11], s22 offen offset:3072 sc1
  s_add_u32 s22, s33, 8192
  buffer_load_dwordx4 v[120:123], v2, s[8:11], s22 offen offset:0 sc1
  buffer_load_dwordx4 v[124:127], v2, s[8:11], s22 offen offset:1024 sc1
  buffer_load_dwordx4 v[128:131], v2, s[8:11], s22 offen offset:2048 sc1
  buffer_load_dwordx4 v[132:135], v2, s[8:11], s22 offen offset:3072 sc1
  s_add_u32 s22, s33, 12288
  buffer_load_dwordx4 v[136:139], v2, s[8:11], s22 offen offset:0 sc1
  buffer_load_dwordx4 v[140:143], v2, s[8:11], s22 offen offset:1024 sc1
sc_e0:
  s_cmp_eq_u32 s49, 0x10000000
  s_cbranch_scc1 sc_d1
  ds_read_b128 v[144:147], v5 offset:34816
  ds_read_b128 v[148:151], v5 offset:35840
  ds_read_b128 v[152:155], v6 offset:16384
  ds_read_b128 v[156:159], v6 offset:17408
  ds_read_b128 v[160:163], v6 offset:18432
  ds_read_b128 v[164:167], v6 offset:19456
  ds_read_b128 v[168:171], v5 offset:49152
  ds_read_b128 v[172:175], v5 offset:50176
  ds_read_b128 v[176:179], v5 offset:51200
  ds_read_b128 v[180:183], v5 offset:52224
  ds_read_b128 v[184:187], v6 offset:0
  ds_read_b128 v[188:191], v6 offset:1024
  ds_read_b128 v[192:195], v6 offset:2048
  ds_read_b128 v[196:199], v6 offset:3072
  s_waitcnt lgkmcnt(0)
  s_branch sc_e1
sc_d1:
  s_add_u32 s22, s33, 12288
  buffer_load_dwordx4 v[144:147], v2, s[8:11], s22 offen offset:2048 sc1
  buffer_load_dwordx4 v[148:151], v2, s[8:11], s22 offen offset:3072 sc1
  s_add_u32 s22, s33, 16384
  buffer_load_dwordx4 v[152:155], v2, s[8:11], s22 offen offset:0 sc1
  buffer_load_dwordx4 v[156:159], v2, s[8:11], s22 offen offset:1024 sc1
  buffer_load_dwordx4 v[160:163], v2, s[8:11], s22 offen offset:2048 sc1
  buffer_load_dwordx4 v[164:167], v2, s[8:11], s22 offen offset:3072 sc1
  s_add_u32 s22, s33, 20480
  buffer_load_dwordx4 v[168:171], v2, s[8:11], s22 offen offset:0 sc1
  buffer_load_dwordx4 v[172:175], v2, s[8:11], s22 offen offset:1024 sc1
  buffer_load_dwordx4 v[176:179], v2, s[8:11], s22 offen offset:2048 sc1
  buffer_load_dwordx4 v[180:183], v2, s[8:11], s22 offen offset:3072 sc1
  s_add_u32 s22, s33, 24576
  buffer_load_dwordx4 v[184:187], v2, s[8:11], s22 offen offset:0 sc1
  buffer_load_dwordx4 v[188:191], v2, s[8:11], s22 offen offset:1024 sc1
  buffer_load_dwordx4 v[192:195], v2, s[8:11], s22 offen offset:2048 sc1
  buffer_load_dwordx4 v[196:199], v2, s[8:11], s22 offen offset:3072 sc1
sc_e1:
  s_cmp_eq_u32 s50, 0x10000000
  s_cbranch_scc1 sc_d2
  ds_read_b128 v[200:203], v4 offset:0
  ds_read_b128 v[204:207], v4 offset:1024
  ds_read_b128 v[208:211], v4 offset:2048
  ds_read_b128 v[212:215], v4 offset:3072
  ds_read_b128 v[216:219], v4 offset:16384
  ds_read_b128 v[220:223], v4 offset:17408
  ds_read_b128 v[224:227], v4 offset:18432
  ds_read_b128 v[228:231], v4 offset:19456
  ds_read_b128 v[232:235], v4 offset:32768
  ds_read_b128 v[236:239], v4 offset:33792
  ds_read_b128 v[240:243], v4 offset:34816
  ds_read_b128 v[244:247], v4 offset:35840
  s_waitcnt lgkmcnt(0)
  s_branch sc_e2
sc_d2:
  s_add_u32 s22, s32, 0
  buffer_load_dwordx4 v[200:203], v2, s[8:11], s22 offen offset:0 sc1
  buffer_load_dwordx4 v[204:207], v2, s[8:11], s22 offen offset:1024 sc1
  buffer_load_dwordx4 v[208:211], v2, s[8:11], s22 offen offset:2048 sc1
  buffer_load_dwordx4 v[212:215], v2, s[8:11], s22 offen offset:3072 sc1
  s_add_u32 s22, s32, 4096
  buffer_load_dwordx4 v[216:219], v2, s[8:11], s22 offen offset:0 sc1
  buffer_load_dwordx4 v[220:223], v2, s[8:11], s22 offen offset:1024 sc1
  buffer_load_dwordx4 v[224:227], v2, s[8:11], s22 offen offset:2048 sc1
  buffer_load_dwordx4 v[228:231], v2, s[8:11], s22 offen offset:3072 sc1
  s_add_u32 s22, s32, 8192
  buffer_load_dwordx4 v[232:235], v2, s[8:11], s22 offen offset:0 sc1
  buffer_load_dwordx4 v[236:239], v2, s[8:11], s22 offen offset:1024 sc1
  buffer_load_dwordx4 v[240:243], v2, s[8:11], s22 offen offset:2048 sc1
  buffer_load_dwordx4 v[244:247], v2, s[8:11], s22 offen offset:3072 sc1
  s_add_u32 s22, s32, 12288
  buffer_load_dwordx4 v[248:251], v2, s[8:11], s22 offen offset:0 sc1
  buffer_load_dwordx4 v[252:255], v2, s[8:11], s22 offen offset:1024 sc1
sc_e2:
  s_barrier
  s_branch m_role
m_val:
  s_cmp_lg_u32 s16, 0
  s_cbranch_scc1 w0_6
  v_mov_b32 v233, 128
  v_mov_b32 v234, s88
  v_mov_b32 v235, s89
  v_mov_b32 v236, 0
  v_mov_b32 v237, 0
  s_mov_b64 exec, 1
  buffer_atomic_cmpswap_x2 v[234:237], v233, s[12:15], 0 offen sc0
  s_mov_b64 exec, -1
w0_6:
  s_cmp_lg_u32 s66, 0
  s_cbranch_scc1 va_ci
  s_cmp_lg_u32 s16, 0
  s_cbranch_scc1 w0_7
  s_lshr_b32 s70, s3, 5
  s_and_b32 s71, s70, 4
  s_mul_i32 s71, s71, 12
  s_lshl_b32 s70, s70, 2
  s_add_u32 s70, s70, s71
  s_lshl_b32 s71, 1, s3
  v_mov_b32 v242, s71
  v_mov_b32 v243, 32
  s_mov_b64 exec, 1
  buffer_atomic_or v242, v243, s[12:15], s70 offen sc0
  buffer_load_dwordx2 v[244:245], v243, s[12:15], 0 offen offset:96 sc1
  s_mov_b64 exec, -1
w0_7:
va_ci:
  s_mov_b32 s56, s40
  s_and_b32 s57, s41, 0xffff
  s_mov_b32 s58, 3670016
  s_mov_b32 s59, 0x20000
  v_lshrrev_b32 v24, 5, v1
  v_and_b32 v25, 31, v1
  v_lshlrev_b32 v25, 4, v25
  v_lshl_add_u32 v24, v24, 13, v25
  s_mov_b32 s60, s42
  s_and_b32 s61, s43, 0xffff
  s_mov_b32 s62, 3670016
  s_mov_b32 s63, 0x20000
  s_lshl_b32 s22, s17, 9
  s_lshl_b32 s23, s16, 19
  s_add_u32 s23, s22, s23
  s_add_u32 s21, s23, 262144
  buffer_load_dwordx4 v[28:31], v24, s[60:63], s21 offen
  s_add_u32 s21, s23, 278528
  buffer_load_dwordx4 v[28:31], v24, s[60:63], s21 offen
  s_add_u32 s21, s23, 294912
  buffer_load_dwordx4 v[28:31], v24, s[60:63], s21 offen
  s_add_u32 s21, s23, 311296
  buffer_load_dwordx4 v[28:31], v24, s[60:63], s21 offen
  s_add_u32 s21, s23, 327680
  buffer_load_dwordx4 v[28:31], v24, s[60:63], s21 offen
  s_add_u32 s21, s23, 344064
  buffer_load_dwordx4 v[28:31], v24, s[60:63], s21 offen
  s_add_u32 s21, s23, 360448
  buffer_load_dwordx4 v[28:31], v24, s[60:63], s21 offen
  s_add_u32 s21, s23, 376832
  buffer_load_dwordx4 v[28:31], v24, s[60:63], s21 offen
  s_add_u32 s21, s23, 393216
  buffer_load_dwordx4 v[28:31], v24, s[60:63], s21 offen
  s_add_u32 s21, s23, 409600
  buffer_load_dwordx4 v[28:31], v24, s[60:63], s21 offen
  s_add_u32 s21, s23, 425984
  buffer_load_dwordx4 v[28:31], v24, s[60:63], s21 offen
  s_add_u32 s21, s23, 442368
  buffer_load_dwordx4 v[28:31], v24, s[60:63], s21 offen
  s_add_u32 s21, s23, 458752
  buffer_load_dwordx4 v[28:31], v24, s[60:63], s21 offen
  s_add_u32 s21, s23, 475136
  buffer_load_dwordx4 v[28:31], v24, s[60:63], s21 offen
  s_add_u32 s21, s23, 491520
  buffer_load_dwordx4 v[28:31], v24, s[60:63], s21 offen
  s_add_u32 s21, s23, 507904
  buffer_load_dwordx4 v[28:31], v24, s[60:63], s21 offen
  s_lshl_b32 s23, s16, 14
  s_add_u32 s22, s22, s23
  s_mov_b32 s30, 0
va_pf:
  buffer_load_dwordx4 v[28:31], v24, s[56:59], s22 offen
  s_waitcnt vmcnt(40)
  s_add_u32 s22, s22, 65536
  s_add_u32 s30, s30, 1
  s_cmp_lt_u32 s30, 56
  s_cbranch_scc1 va_pf
  s_cmp_lg_u32 s66, 0
  s_cbranch_scc1 va_cf
  s_cmp_lg_u32 s16, 0
  s_cbranch_scc1 w0_8
  s_waitcnt vmcnt(40)
  v_readfirstlane_b32 s70, v244
  s_cmp_lg_u32 s70, 0
  s_cbranch_scc1 va_nz
  v_mov_b32 v243, 128
  v_mov_b32 v244, s88
  v_mov_b32 v245, s89
  v_mov_b32 v246, 0
  v_mov_b32 v247, 0
  s_mov_b64 exec, 1
  buffer_atomic_cmpswap_x2 v[244:247], v243, s[12:15], 0 offen sc0
  s_mov_b64 exec, -1
  s_waitcnt vmcnt(0)
  v_readfirstlane_b32 s70, v244
  s_cmp_lg_u32 s70, 0
  s_cbranch_scc1 va_nz
  v_mov_b32 v244, s88
  v_mov_b32 v245, s89
va_nz:
w0_8:
  v_mov_b32 v243, 160000
  s_add_u32 s101, s101, 1
  s_barrier
  s_mov_b64 exec, 1
  s_cmp_lg_u32 s16, 0
  s_cbranch_scc1 w0_9
  ds_write_b32 v243, v242 offset:0
  ds_write_b32 v243, v244 offset:4
  ds_write_b32 v243, v245 offset:8
  s_waitcnt lgkmcnt(0)
  v_mov_b32 v242, s101
  ds_write_b32 v243, v242 offset:16
  s_waitcnt lgkmcnt(0)
w0_9:
  s_mov_b64 exec, -1
  s_barrier
  ds_read_b32 v242, v243 offset:0
  ds_read_b32 v244, v243 offset:4
  ds_read_b32 v245, v243 offset:8
  ds_read_b32 v243, v243 offset:16
  s_waitcnt lgkmcnt(0)
  v_readfirstlane_b32 s70, v242
  v_readfirstlane_b32 s88, v244
  v_readfirstlane_b32 s89, v245
  v_cmp_ne_u32 vcc, s101, v243
  s_cbranch_vccnz ch_end
  s_mov_b32 s66, 1
  s_bitcmp1_b32 s70, s3
  s_cbranch_scc1 m_reclaim
va_cf:
  s_cmp_lg_u32 s16, 0
  s_cbranch_scc1 w0_10
  s_cmp_eq_u32 s67, 0
  s_cselect_b32 s20, 1, 0x10001
  v_mov_b32 v242, s20
  v_mov_b32 v243, 0
  s_mov_b64 exec, 1
  buffer_atomic_add v242, v243, s[12:15], 0 offen
  s_mov_b64 exec, -1
w0_10:
m_role:
  s_mov_b32 s17, s3
  v_and_b32 v1, 63, v0
  v_lshlrev_b32 v2, 4, v1
  v_lshrrev_b32 v116, 4, v1
  v_and_b32 v117, 15, v1
  v_mov_b32 v3, 0x4444
  v_mov_b32 v118, 0xeeee
  v_cmp_lt_u32 vcc, 7, v117
  s_nop 1
  v_cndmask_b32 v3, v3, v118, vcc
  s_mov_b32 s19, 0
  s_mov_b32 s20, 88653824
  s_lshr_b32 s22, s17, 4
  s_lshl_b32 s22, s22, 2
  s_add_u32 s22, s22, s16
  s_and_b32 s17, s17, 15
  s_cmp_eq_u32 s22, 0
  s_cbranch_scc1 ch_init0
  s_cmp_eq_u32 s22, 1
  s_cbranch_scc1 ch_init1
  s_cmp_eq_u32 s22, 2
  s_cbranch_scc1 ch_init2
  s_cmp_eq_u32 s22, 3
  s_cbranch_scc1 ch_init3
  s_cmp_eq_u32 s22, 4
  s_cbranch_scc1 ch_init4
  s_cmp_eq_u32 s22, 5
  s_cbranch_scc1 ch_init5
  s_cmp_eq_u32 s22, 6
  s_cbranch_scc1 ch_init6
  s_cmp_eq_u32 s22, 7
  s_cbranch_scc1 ch_init7
  s_branch ch_end
ch_init0:
  s_mul_i32 s31, s17, 401408
  s_add_u32 s31, s31, 0
  s_mov_b32 s24, 71565312
  s_mov_b32 s25, 0
  s_add_u32 m0, s25, 0
  s_nop 0
  buffer_load_dwordx4 v2, s[8:11], s24 offen offset:0 sc1 lds
  buffer_load_dwordx4 v2, s[8:11], s24 offen offset:1024 sc1 lds
  buffer_load_dwordx4 v2, s[8:11], s24 offen offset:2048 sc1 lds
  buffer_load_dwordx4 v2, s[8:11], s24 offen offset:3072 sc1 lds
  s_add_u32 m0, s25, 4096
  s_add_u32 s22, s24, 4096
  buffer_load_dwordx4 v2, s[8:11], s22 offen offset:0 sc1 lds
  buffer_load_dwordx4 v2, s[8:11], s22 offen offset:1024 sc1 lds
  buffer_load_dwordx4 v2, s[8:11], s22 offen offset:2048 sc1 lds
  v_lshrrev_b32 v64, 1, v117
  v_and_b32 v65, 1, v116
  v_lshlrev_b32 v65, 2, v65
  v_sub_u32 v64, v64, v65
  v_and_b32 v65, 1, v117
  v_lshl_add_u32 v66, v65, 2, v64
  v_cmp_gt_u32 vcc, 4, v64
  v_mov_b32 v67, 99
  s_nop 0
  v_cndmask_b32 v66, v67, v66, vcc
  v_mov_b32 v68, 0x3f80
  v_mov_b32 v69, 0x3f800000
  v_mov_b32 v4, 0
  v_cmp_eq_u32 vcc, 0, v66
  s_nop 1
  v_cndmask_b32 v4, v4, v68, vcc
  v_cmp_eq_u32 vcc, 1, v66
  s_nop 1
  v_cndmask_b32 v4, v4, v69, vcc
  v_mov_b32 v5, 0
  v_cmp_eq_u32 vcc, 2, v66
  s_nop 1
  v_cndmask_b32 v5, v5, v68, vcc
  v_cmp_eq_u32 vcc, 3, v66
  s_nop 1
  v_cndmask_b32 v5, v5, v69, vcc
  v_mov_b32 v6, 0
  v_cmp_eq_u32 vcc, 4, v66
  s_nop 1
  v_cndmask_b32 v6, v6, v68, vcc
  v_cmp_eq_u32 vcc, 5, v66
  s_nop 1
  v_cndmask_b32 v6, v6, v69, vcc
  v_mov_b32 v7, 0
  v_cmp_eq_u32 vcc, 6, v66
  s_nop 1
  v_cndmask_b32 v7, v7, v68, vcc
  v_cmp_eq_u32 vcc, 7, v66
  s_nop 1
  v_cndmask_b32 v7, v7, v69, vcc
  v_lshrrev_b32 v64, 1, v116
  v_lshrrev_b32 v65, 3, v117
  v_cmp_eq_u32 s[26:27], v64, v65
  v_and_b32 v66, 1, v116
  v_add_u32 v64, 0, v64
  v_lshrrev_b32 v67, 1, v116
  v_lshlrev_b32 v67, 8, v67
  v_lshl_add_u32 v67, v66, 9, v67
  v_lshl_add_u32 v67, v117, 4, v67
  v_add_u32 v112, 57344, v67
  v_and_b32 v68, 7, v117
  v_lshlrev_b32 v67, 8, v64
  v_lshl_add_u32 v67, v68, 5, v67
  v_lshl_add_u32 v67, v66, 4, v67
  v_add_u32 v113, 65536, v67
  v_lshrrev_b32 v64, 5, v1
  v_and_b32 v65, 31, v1
  v_lshrrev_b32 v66, 3, v65
  v_and_b32 v67, 7, v65
  v_and_b32 v68, 3, v67
  v_lshl_add_u32 v68, v66, 2, v68
  v_lshrrev_b32 v69, 2, v67
  v_lshl_add_u32 v68, v69, 4, v68
  v_lshlrev_b32 v69, 11, v64
  v_lshl_add_u32 v69, v68, 4, v69
  v_add_u32 v114, 57344, v69
  v_add_u32 v70, 0, v64
  v_lshlrev_b32 v69, 9, v66
  v_lshl_add_u32 v69, v70, 5, v69
  v_lshl_add_u32 v69, v67, 2, v69
  v_add_u32 v115, 65536, v69
  v_lshlrev_b32 v69, 4, v68
  v_lshl_add_u32 v69, v64, 9, v69
  v_add_u32 v114, 57344, v69
  v_mul_u32_u24 v69, 144, v70
  v_lshl_add_u32 v69, v67, 4, v69
  v_add_u32 v115, 65536, v69
  v_and_b32 v71, 1, v116
  v_mul_u32_u24 v69, 2048, v71
  v_lshl_add_u32 v69, v64, 8, v69
  v_lshl_add_u32 v69, v117, 4, v69
  v_add_u32 v112, 57344, v69
  v_mul_u32_u24 v69, 144, v117
  v_lshl_add_u32 v69, v71, 6, v69
  v_lshl_add_u32 v69, v64, 5, v69
  v_add_u32 v113, 65536, v69
  v_mul_u32_u24 v69, 1024, v116
  v_lshl_add_u32 v69, v117, 4, v69
  v_and_b32 v72, 8, v117
  v_xor_b32 v72, 0, v72
  v_add_u32 v69, v69, v72
  v_add_u32 v112, 57344, v69
  v_lshrrev_b32 v72, 3, v117
  v_lshl_add_u32 v72, v71, 1, v72
  v_xor_b32 v72, 0, v72
  v_lshlrev_b32 v69, 10, v116
  v_lshl_add_u32 v69, v117, 4, v69
  v_lshl_add_u32 v69, v72, 2, v69
  v_add_u32 v112, 57344, v69
  v_lshrrev_b32 v69, 1, v117
  v_and_b32 v72, 1, v117
  v_lshl_add_u32 v69, v72, 3, v69
  v_mul_u32_u24 v69, 144, v69
  v_lshl_add_u32 v69, v71, 6, v69
  v_lshl_add_u32 v69, v64, 5, v69
  v_lshl_add_u32 v72, v72, 1, v71
  v_xor_b32 v72, 0, v72
  v_lshl_add_u32 v69, v72, 2, v69
  v_add_u32 v113, 65536, v69
  v_and_b32 v71, 1, v1
  v_cmp_eq_u32 s[38:39], 0, v71
  v_cmp_gt_u32 vcc, 8, v65
  s_or_b64 s[28:29], s[38:39], vcc
  v_lshrrev_b32 v72, 1, v67
  v_lshlrev_b32 v72, 2, v72
  v_lshl_add_u32 v72, v70, 4, v72
  s_lshl_b32 s22, s17, 9
  s_add_u32 s22, s22, 9216
  v_lshl_add_u32 v73, v66, 7, v72
  v_add_u32 v73, s22, v73
  s_lshl_b32 s22, s17, 7
  s_add_u32 s22, s22, 7168
  v_add_u32 v74, s22, v72
  v_bfe_u32 v72, v65, 1, 1
  v_lshlrev_b32 v72, 7, v72
  v_lshl_add_u32 v72, v70, 4, v72
  v_bfe_u32 v73, v65, 2, 2
  v_lshl_add_u32 v72, v73, 2, v72
  v_lshrrev_b32 v73, 4, v65
  v_lshl_add_u32 v73, v73, 8, v72
  s_lshl_b32 s22, s17, 9
  s_add_u32 s22, s22, 9216
  v_add_u32 v73, s22, v73
  s_lshr_b32 s22, s17, 1
  s_lshl_b32 s22, s22, 8
  s_and_b32 s34, s17, 1
  s_lshl_b32 s34, s34, 3
  s_add_u32 s22, s22, s34
  s_add_u32 s22, s22, 7168
  v_add_u32 v74, s22, v72
  v_bfe_u32 v72, v65, 1, 1
  v_lshl_add_u32 v72, v64, 1, v72
  v_lshlrev_b32 v72, 4, v72
  v_bfe_u32 v73, v65, 2, 2
  v_lshl_add_u32 v72, v73, 2, v72
  v_lshrrev_b32 v73, 4, v65
  v_lshl_add_u32 v73, v73, 6, v72
  s_lshl_b32 s22, s17, 9
  s_add_u32 s22, s22, 9216
  v_add_u32 v73, s22, v73
  v_lshrrev_b32 v72, 1, v65
  v_lshlrev_b32 v72, 2, v72
  v_lshl_add_u32 v72, v64, 5, v72
  s_lshr_b32 s22, s17, 1
  s_lshl_b32 s22, s22, 8
  s_and_b32 s34, s17, 1
  s_lshl_b32 s34, s34, 4
  s_add_u32 s22, s22, s34
  s_add_u32 s22, s22, 7168
  v_add_u32 v74, s22, v72
  v_lshlrev_b32 v0, 2, v65
  v_and_b32 v0, 120, v0
  s_and_b32 s22, s17, 15
  s_lshl_b32 s22, s22, 7
  s_add_u32 s22, s22, 18432
  v_add_u32 v0, s22, v0
  v_cndmask_b32 v1, v74, v73, s[38:39]
  s_lshl_b32 s36, s17, 2
  s_add_u32 s36, s36, 17472
  s_mov_b32 s37, 0x3e800000
  v_mov_b32 v64, 0
  v_mov_b32 v65, 0
  v_mov_b32 v66, 0
  v_mov_b32 v67, 0
  v_mov_b32 v68, 0
  v_mov_b32 v69, 0
  v_mov_b32 v70, 0
  v_mov_b32 v71, 0
  v_mov_b32 v72, 0
  v_mov_b32 v73, 0
  v_mov_b32 v74, 0
  v_mov_b32 v75, 0
  v_mov_b32 v76, 0
  v_mov_b32 v77, 0
  v_mov_b32 v78, 0
  v_mov_b32 v79, 0
  v_mov_b32 v80, 0
  v_mov_b32 v81, 0
  v_mov_b32 v82, 0
  v_mov_b32 v83, 0
  v_mov_b32 v84, 0
  v_mov_b32 v85, 0
  v_mov_b32 v86, 0
  v_mov_b32 v87, 0
  v_mov_b32 v88, 0
  v_mov_b32 v89, 0
  v_mov_b32 v90, 0
  v_mov_b32 v91, 0
  v_mov_b32 v92, 0
  v_mov_b32 v93, 0
  v_mov_b32 v94, 0
  v_mov_b32 v95, 0
  v_mov_b32 v96, 0
  v_mov_b32 v97, 0
  v_mov_b32 v98, 0
  v_mov_b32 v99, 0
  v_mov_b32 v100, 0
  v_mov_b32 v101, 0
  v_mov_b32 v102, 0
  v_mov_b32 v103, 0
  v_mov_b32 v104, 0
  v_mov_b32 v105, 0
  v_mov_b32 v106, 0
  v_mov_b32 v107, 0
  v_mov_b32 v108, 0
  v_mov_b32 v109, 0
  v_mov_b32 v110, 0
  v_mov_b32 v111, 0
  v_and_b32 v118, 1, v116
  v_cmp_eq_u32 vcc, 0, v118
  v_mov_b32 v118, 12288
  v_mov_b32 v119, 8192
  v_cndmask_b32 v118, v118, v119, vcc
  v_lshrrev_b32 v116, 1, v116
  v_lshl_add_u32 v118, v116, 9, v118
  v_lshl_add_u32 v117, v117, 4, v118
  s_mov_b32 s57, 28672
  v_bfe_u32 v118, v2, 4, 1
  v_mul_u32_u24 v118, 0xaaaa, v118
  v_add_u32 v118, 0x4444, v118
  s_mov_b32 s56, 0x42800000
  v_mov_b32 v116, v2
  s_mul_i32 s35, s17, 1835008
  s_add_u32 s35, s35, 42262528
  v_lshl_add_u32 v119, v2, 3, s36
  v_mov_b32 v8, 0x20000000
  v_cmp_gt_u32 vcc, 64, v2
  s_nop 1
  v_cndmask_b32 v119, v8, v119, vcc
  s_mov_b32 s30, 0
  v_mov_b32 v36, 0
ch_md0:
  buffer_load_dword v37, v36, s[12:15], 0 offen sc1
  s_waitcnt vmcnt(0)
  v_readfirstlane_b32 s22, v37
  s_and_b32 s31, s22, 0xffff
  s_cmp_ge_u32 s31, 32
  s_cbranch_scc1 ch_go0
  s_sleep 2
  s_add_u32 s30, s30, 1
  s_cmp_lt_u32 s30, 50000
  s_cbranch_scc1 ch_md0
  s_branch ch_end
ch_go0:
  s_mov_b32 s31, 0
  s_lshr_b32 s22, s22, 16
  s_cmp_lg_u32 s22, 0
  s_cbranch_scc1 cB_sc0_loop
  s_branch cA_sc0_loop
ch_init1:
  s_mul_i32 s31, s17, 401408
  s_add_u32 s31, s31, 0
  s_mov_b32 s24, 71572480
  s_mov_b32 s25, 0
  s_add_u32 m0, s25, 7168
  s_nop 0
  buffer_load_dwordx4 v2, s[8:11], s24 offen offset:0 sc1 lds
  buffer_load_dwordx4 v2, s[8:11], s24 offen offset:1024 sc1 lds
  buffer_load_dwordx4 v2, s[8:11], s24 offen offset:2048 sc1 lds
  buffer_load_dwordx4 v2, s[8:11], s24 offen offset:3072 sc1 lds
  s_add_u32 m0, s25, 11264
  s_add_u32 s22, s24, 4096
  buffer_load_dwordx4 v2, s[8:11], s22 offen offset:0 sc1 lds
  buffer_load_dwordx4 v2, s[8:11], s22 offen offset:1024 sc1 lds
  buffer_load_dwordx4 v2, s[8:11], s22 offen offset:2048 sc1 lds
  v_lshrrev_b32 v64, 1, v117
  v_and_b32 v65, 1, v116
  v_lshlrev_b32 v65, 2, v65
  v_sub_u32 v64, v64, v65
  v_and_b32 v65, 1, v117
  v_lshl_add_u32 v66, v65, 2, v64
  v_cmp_gt_u32 vcc, 4, v64
  v_mov_b32 v67, 99
  s_nop 0
  v_cndmask_b32 v66, v67, v66, vcc
  v_mov_b32 v68, 0x3f80
  v_mov_b32 v69, 0x3f800000
  v_mov_b32 v4, 0
  v_cmp_eq_u32 vcc, 0, v66
  s_nop 1
  v_cndmask_b32 v4, v4, v68, vcc
  v_cmp_eq_u32 vcc, 1, v66
  s_nop 1
  v_cndmask_b32 v4, v4, v69, vcc
  v_mov_b32 v5, 0
  v_cmp_eq_u32 vcc, 2, v66
  s_nop 1
  v_cndmask_b32 v5, v5, v68, vcc
  v_cmp_eq_u32 vcc, 3, v66
  s_nop 1
  v_cndmask_b32 v5, v5, v69, vcc
  v_mov_b32 v6, 0
  v_cmp_eq_u32 vcc, 4, v66
  s_nop 1
  v_cndmask_b32 v6, v6, v68, vcc
  v_cmp_eq_u32 vcc, 5, v66
  s_nop 1
  v_cndmask_b32 v6, v6, v69, vcc
  v_mov_b32 v7, 0
  v_cmp_eq_u32 vcc, 6, v66
  s_nop 1
  v_cndmask_b32 v7, v7, v68, vcc
  v_cmp_eq_u32 vcc, 7, v66
  s_nop 1
  v_cndmask_b32 v7, v7, v69, vcc
  v_lshrrev_b32 v64, 1, v116
  v_lshrrev_b32 v65, 3, v117
  v_cmp_eq_u32 s[26:27], v64, v65
  v_and_b32 v66, 1, v116
  v_add_u32 v64, 2, v64
  v_lshrrev_b32 v67, 1, v116
  v_lshlrev_b32 v67, 8, v67
  v_lshl_add_u32 v67, v66, 9, v67
  v_lshl_add_u32 v67, v117, 4, v67
  v_add_u32 v112, 58368, v67
  v_and_b32 v68, 7, v117
  v_lshlrev_b32 v67, 8, v64
  v_lshl_add_u32 v67, v68, 5, v67
  v_lshl_add_u32 v67, v66, 4, v67
  v_add_u32 v113, 65536, v67
  v_lshrrev_b32 v64, 5, v1
  v_and_b32 v65, 31, v1
  v_lshrrev_b32 v66, 3, v65
  v_and_b32 v67, 7, v65
  v_and_b32 v68, 3, v67
  v_lshl_add_u32 v68, v66, 2, v68
  v_lshrrev_b32 v69, 2, v67
  v_lshl_add_u32 v68, v69, 4, v68
  v_lshlrev_b32 v69, 11, v64
  v_lshl_add_u32 v69, v68, 4, v69
  v_add_u32 v114, 57352, v69
  v_add_u32 v70, 2, v64
  v_lshlrev_b32 v69, 9, v66
  v_lshl_add_u32 v69, v70, 5, v69
  v_lshl_add_u32 v69, v67, 2, v69
  v_add_u32 v115, 65536, v69
  v_lshlrev_b32 v69, 4, v68
  v_lshl_add_u32 v69, v64, 9, v69
  v_add_u32 v114, 58368, v69
  v_mul_u32_u24 v69, 144, v70
  v_lshl_add_u32 v69, v67, 4, v69
  v_add_u32 v115, 65536, v69
  v_and_b32 v71, 1, v116
  v_mul_u32_u24 v69, 2048, v71
  v_lshl_add_u32 v69, v64, 8, v69
  v_lshl_add_u32 v69, v117, 4, v69
  v_add_u32 v112, 57352, v69
  v_mul_u32_u24 v69, 144, v117
  v_lshl_add_u32 v69, v71, 6, v69
  v_lshl_add_u32 v69, v64, 5, v69
  v_add_u32 v113, 65540, v69
  v_mul_u32_u24 v69, 1024, v116
  v_lshl_add_u32 v69, v117, 4, v69
  v_and_b32 v72, 8, v117
  v_xor_b32 v72, 8, v72
  v_add_u32 v69, v69, v72
  v_add_u32 v112, 57344, v69
  v_lshrrev_b32 v72, 3, v117
  v_lshl_add_u32 v72, v71, 1, v72
  v_xor_b32 v72, 1, v72
  v_lshlrev_b32 v69, 10, v116
  v_lshl_add_u32 v69, v117, 4, v69
  v_lshl_add_u32 v69, v72, 2, v69
  v_add_u32 v112, 57344, v69
  v_lshrrev_b32 v69, 1, v117
  v_and_b32 v72, 1, v117
  v_lshl_add_u32 v69, v72, 3, v69
  v_mul_u32_u24 v69, 144, v69
  v_lshl_add_u32 v69, v71, 6, v69
  v_lshl_add_u32 v69, v64, 5, v69
  v_lshl_add_u32 v72, v72, 1, v71
  v_xor_b32 v72, 1, v72
  v_lshl_add_u32 v69, v72, 2, v69
  v_add_u32 v113, 65536, v69
  v_and_b32 v71, 1, v1
  v_cmp_eq_u32 s[38:39], 0, v71
  v_cmp_gt_u32 vcc, 8, v65
  s_or_b64 s[28:29], s[38:39], vcc
  v_lshrrev_b32 v72, 1, v67
  v_lshlrev_b32 v72, 2, v72
  v_lshl_add_u32 v72, v70, 4, v72
  s_lshl_b32 s22, s17, 9
  s_add_u32 s22, s22, 9216
  v_lshl_add_u32 v73, v66, 7, v72
  v_add_u32 v73, s22, v73
  s_lshl_b32 s22, s17, 7
  s_add_u32 s22, s22, 7168
  v_add_u32 v74, s22, v72
  v_bfe_u32 v72, v65, 1, 1
  v_lshlrev_b32 v72, 7, v72
  v_lshl_add_u32 v72, v70, 4, v72
  v_bfe_u32 v73, v65, 2, 2
  v_lshl_add_u32 v72, v73, 2, v72
  v_lshrrev_b32 v73, 4, v65
  v_lshl_add_u32 v73, v73, 8, v72
  s_lshl_b32 s22, s17, 9
  s_add_u32 s22, s22, 9216
  v_add_u32 v73, s22, v73
  s_lshr_b32 s22, s17, 1
  s_lshl_b32 s22, s22, 8
  s_and_b32 s34, s17, 1
  s_lshl_b32 s34, s34, 3
  s_add_u32 s22, s22, s34
  s_add_u32 s22, s22, 7168
  v_add_u32 v74, s22, v72
  v_bfe_u32 v72, v65, 1, 1
  v_lshl_add_u32 v72, v64, 1, v72
  v_lshlrev_b32 v72, 4, v72
  v_bfe_u32 v73, v65, 2, 2
  v_lshl_add_u32 v72, v73, 2, v72
  v_lshrrev_b32 v73, 4, v65
  v_lshl_add_u32 v73, v73, 6, v72
  s_lshl_b32 s22, s17, 9
  s_add_u32 s22, s22, 9344
  v_add_u32 v73, s22, v73
  v_lshrrev_b32 v72, 1, v65
  v_lshlrev_b32 v72, 2, v72
  v_lshl_add_u32 v72, v64, 5, v72
  s_lshr_b32 s22, s17, 1
  s_lshl_b32 s22, s22, 8
  s_and_b32 s34, s17, 1
  s_lshl_b32 s34, s34, 4
  s_add_u32 s22, s22, s34
  s_add_u32 s22, s22, 7232
  v_add_u32 v74, s22, v72
  v_lshlrev_b32 v0, 2, v65
  v_and_b32 v0, 120, v0
  s_and_b32 s22, s17, 15
  s_lshl_b32 s22, s22, 7
  s_add_u32 s22, s22, 18432
  v_add_u32 v0, s22, v0
  v_cndmask_b32 v1, v74, v73, s[38:39]
  s_lshl_b32 s36, s17, 2
  s_add_u32 s36, s36, 17472
  s_mov_b32 s37, 0x3e800000
  v_mov_b32 v64, 0
  v_mov_b32 v65, 0
  v_mov_b32 v66, 0
  v_mov_b32 v67, 0
  v_mov_b32 v68, 0
  v_mov_b32 v69, 0
  v_mov_b32 v70, 0
  v_mov_b32 v71, 0
  v_mov_b32 v72, 0
  v_mov_b32 v73, 0
  v_mov_b32 v74, 0
  v_mov_b32 v75, 0
  v_mov_b32 v76, 0
  v_mov_b32 v77, 0
  v_mov_b32 v78, 0
  v_mov_b32 v79, 0
  v_mov_b32 v80, 0
  v_mov_b32 v81, 0
  v_mov_b32 v82, 0
  v_mov_b32 v83, 0
  v_mov_b32 v84, 0
  v_mov_b32 v85, 0
  v_mov_b32 v86, 0
  v_mov_b32 v87, 0
  v_mov_b32 v88, 0
  v_mov_b32 v89, 0
  v_mov_b32 v90, 0
  v_mov_b32 v91, 0
  v_mov_b32 v92, 0
  v_mov_b32 v93, 0
  v_mov_b32 v94, 0
  v_mov_b32 v95, 0
  v_mov_b32 v96, 0
  v_mov_b32 v97, 0
  v_mov_b32 v98, 0
  v_mov_b32 v99, 0
  v_mov_b32 v100, 0
  v_mov_b32 v101, 0
  v_mov_b32 v102, 0
  v_mov_b32 v103, 0
  v_mov_b32 v104, 0
  v_mov_b32 v105, 0
  v_mov_b32 v106, 0
  v_mov_b32 v107, 0
  v_mov_b32 v108, 0
  v_mov_b32 v109, 0
  v_mov_b32 v110, 0
  v_mov_b32 v111, 0
  v_and_b32 v118, 1, v116
  v_cmp_eq_u32 vcc, 0, v118
  v_mov_b32 v118, 12288
  v_mov_b32 v119, 8448
  v_cndmask_b32 v118, v118, v119, vcc
  v_lshrrev_b32 v116, 1, v116
  v_lshl_add_u32 v118, v116, 9, v118
  v_lshl_add_u32 v117, v117, 4, v118
  s_mov_b32 s57, 28672
  v_bfe_u32 v118, v2, 4, 1
  v_mul_u32_u24 v118, 0xaaaa, v118
  v_add_u32 v118, 0x4444, v118
  s_mov_b32 s56, 0x42800000
  v_mov_b32 v116, v2
  v_lshrrev_b32 v0, 4, v2
  v_min_u32 v0, 9, v0
  s_mul_i32 s22, s17, 10
  v_add_u32 v0, s22, v0
  v_lshlrev_b32 v0, 7, v0
  v_add_u32 v0, 40960, v0
  s_mov_b32 s22, 88633344
  buffer_load_dword v119, v0, s[8:11], s22 offen sc1
  s_mov_b32 s22, 88612864
  buffer_load_dword v119, v0, s[8:11], s22 offen sc1
  s_mul_i32 s35, s17, 1835008
  s_add_u32 s35, s35, 42269696
  s_mov_b32 s30, 0
  v_mov_b32 v36, 0
ch_md1:
  buffer_load_dword v37, v36, s[12:15], 0 offen sc1
  s_waitcnt vmcnt(0)
  v_readfirstlane_b32 s22, v37
  s_and_b32 s31, s22, 0xffff
  s_cmp_ge_u32 s31, 32
  s_cbranch_scc1 ch_go1
  s_sleep 2
  s_add_u32 s30, s30, 1
  s_cmp_lt_u32 s30, 50000
  s_cbranch_scc1 ch_md1
  s_branch ch_end
ch_go1:
  s_mov_b32 s31, 0
  s_lshr_b32 s22, s22, 16
  s_cmp_lg_u32 s22, 0
  s_cbranch_scc1 cB_sc1_loop
  s_branch cA_sc1_loop
ch_init2:
  s_mul_i32 s31, s17, 401408
  s_add_u32 s31, s31, 0
  s_mov_b32 s24, 71579648
  s_mov_b32 s25, 0
  s_add_u32 m0, s25, 14336
  s_nop 0
  buffer_load_dwordx4 v2, s[8:11], s24 offen offset:0 sc1 lds
  buffer_load_dwordx4 v2, s[8:11], s24 offen offset:1024 sc1 lds
  buffer_load_dwordx4 v2, s[8:11], s24 offen offset:2048 sc1 lds
  buffer_load_dwordx4 v2, s[8:11], s24 offen offset:3072 sc1 lds
  s_add_u32 m0, s25, 18432
  s_add_u32 s22, s24, 4096
  buffer_load_dwordx4 v2, s[8:11], s22 offen offset:0 sc1 lds
  buffer_load_dwordx4 v2, s[8:11], s22 offen offset:1024 sc1 lds
  buffer_load_dwordx4 v2, s[8:11], s22 offen offset:2048 sc1 lds
  v_lshrrev_b32 v64, 1, v117
  v_and_b32 v65, 1, v116
  v_lshlrev_b32 v65, 2, v65
  v_sub_u32 v64, v64, v65
  v_and_b32 v65, 1, v117
  v_lshl_add_u32 v66, v65, 2, v64
  v_cmp_gt_u32 vcc, 4, v64
  v_mov_b32 v67, 99
  s_nop 0
  v_cndmask_b32 v66, v67, v66, vcc
  v_mov_b32 v68, 0x3f80
  v_mov_b32 v69, 0x3f800000
  v_mov_b32 v4, 0
  v_cmp_eq_u32 vcc, 0, v66
  s_nop 1
  v_cndmask_b32 v4, v4, v68, vcc
  v_cmp_eq_u32 vcc, 1, v66
  s_nop 1
  v_cndmask_b32 v4, v4, v69, vcc
  v_mov_b32 v5, 0
  v_cmp_eq_u32 vcc, 2, v66
  s_nop 1
  v_cndmask_b32 v5, v5, v68, vcc
  v_cmp_eq_u32 vcc, 3, v66
  s_nop 1
  v_cndmask_b32 v5, v5, v69, vcc
  v_mov_b32 v6, 0
  v_cmp_eq_u32 vcc, 4, v66
  s_nop 1
  v_cndmask_b32 v6, v6, v68, vcc
  v_cmp_eq_u32 vcc, 5, v66
  s_nop 1
  v_cndmask_b32 v6, v6, v69, vcc
  v_mov_b32 v7, 0
  v_cmp_eq_u32 vcc, 6, v66
  s_nop 1
  v_cndmask_b32 v7, v7, v68, vcc
  v_cmp_eq_u32 vcc, 7, v66
  s_nop 1
  v_cndmask_b32 v7, v7, v69, vcc
  v_lshrrev_b32 v64, 1, v116
  v_lshrrev_b32 v65, 3, v117
  v_cmp_eq_u32 s[26:27], v64, v65
  v_and_b32 v66, 1, v116
  v_add_u32 v64, 4, v64
  v_lshrrev_b32 v67, 1, v116
  v_lshlrev_b32 v67, 8, v67
  v_lshl_add_u32 v67, v66, 9, v67
  v_lshl_add_u32 v67, v117, 4, v67
  v_add_u32 v112, 59392, v67
  v_and_b32 v68, 7, v117
  v_lshlrev_b32 v67, 8, v64
  v_lshl_add_u32 v67, v68, 5, v67
  v_lshl_add_u32 v67, v66, 4, v67
  v_add_u32 v113, 65536, v67
  v_lshrrev_b32 v64, 5, v1
  v_and_b32 v65, 31, v1
  v_lshrrev_b32 v66, 3, v65
  v_and_b32 v67, 7, v65
  v_and_b32 v68, 3, v67
  v_lshl_add_u32 v68, v66, 2, v68
  v_lshrrev_b32 v69, 2, v67
  v_lshl_add_u32 v68, v69, 4, v68
  v_lshlrev_b32 v69, 11, v64
  v_lshl_add_u32 v69, v68, 4, v69
  v_add_u32 v114, 57856, v69
  v_add_u32 v70, 4, v64
  v_lshlrev_b32 v69, 9, v66
  v_lshl_add_u32 v69, v70, 5, v69
  v_lshl_add_u32 v69, v67, 2, v69
  v_add_u32 v115, 65536, v69
  v_lshlrev_b32 v69, 4, v68
  v_lshl_add_u32 v69, v64, 9, v69
  v_add_u32 v114, 59392, v69
  v_mul_u32_u24 v69, 144, v70
  v_lshl_add_u32 v69, v67, 4, v69
  v_add_u32 v115, 65536, v69
  v_and_b32 v71, 1, v116
  v_mul_u32_u24 v69, 2048, v71
  v_lshl_add_u32 v69, v64, 8, v69
  v_lshl_add_u32 v69, v117, 4, v69
  v_add_u32 v112, 57856, v69
  v_mul_u32_u24 v69, 144, v117
  v_lshl_add_u32 v69, v71, 6, v69
  v_lshl_add_u32 v69, v64, 5, v69
  v_add_u32 v113, 65544, v69
  v_mul_u32_u24 v69, 1024, v116
  v_lshl_add_u32 v69, v117, 4, v69
  v_and_b32 v72, 8, v117
  v_xor_b32 v72, 0, v72
  v_add_u32 v69, v69, v72
  v_add_u32 v112, 57856, v69
  v_lshrrev_b32 v72, 3, v117
  v_lshl_add_u32 v72, v71, 1, v72
  v_xor_b32 v72, 2, v72
  v_lshlrev_b32 v69, 10, v116
  v_lshl_add_u32 v69, v117, 4, v69
  v_lshl_add_u32 v69, v72, 2, v69
  v_add_u32 v112, 57344, v69
  v_lshrrev_b32 v69, 1, v117
  v_and_b32 v72, 1, v117
  v_lshl_add_u32 v69, v72, 3, v69
  v_mul_u32_u24 v69, 144, v69
  v_lshl_add_u32 v69, v71, 6, v69
  v_lshl_add_u32 v69, v64, 5, v69
  v_lshl_add_u32 v72, v72, 1, v71
  v_xor_b32 v72, 2, v72
  v_lshl_add_u32 v69, v72, 2, v69
  v_add_u32 v113, 65536, v69
  v_and_b32 v71, 1, v1
  v_cmp_eq_u32 s[38:39], 0, v71
  v_cmp_gt_u32 vcc, 8, v65
  s_or_b64 s[28:29], s[38:39], vcc
  v_lshrrev_b32 v72, 1, v67
  v_lshlrev_b32 v72, 2, v72
  v_lshl_add_u32 v72, v70, 4, v72
  s_lshl_b32 s22, s17, 9
  s_add_u32 s22, s22, 9216
  v_lshl_add_u32 v73, v66, 7, v72
  v_add_u32 v73, s22, v73
  s_lshl_b32 s22, s17, 7
  s_add_u32 s22, s22, 7168
  v_add_u32 v74, s22, v72
  v_bfe_u32 v72, v65, 1, 1
  v_lshlrev_b32 v72, 7, v72
  v_lshl_add_u32 v72, v70, 4, v72
  v_bfe_u32 v73, v65, 2, 2
  v_lshl_add_u32 v72, v73, 2, v72
  v_lshrrev_b32 v73, 4, v65
  v_lshl_add_u32 v73, v73, 8, v72
  s_lshl_b32 s22, s17, 9
  s_add_u32 s22, s22, 9216
  v_add_u32 v73, s22, v73
  s_lshr_b32 s22, s17, 1
  s_lshl_b32 s22, s22, 8
  s_and_b32 s34, s17, 1
  s_lshl_b32 s34, s34, 3
  s_add_u32 s22, s22, s34
  s_add_u32 s22, s22, 7168
  v_add_u32 v74, s22, v72
  v_bfe_u32 v72, v65, 1, 1
  v_lshl_add_u32 v72, v64, 1, v72
  v_lshlrev_b32 v72, 4, v72
  v_bfe_u32 v73, v65, 2, 2
  v_lshl_add_u32 v72, v73, 2, v72
  v_lshrrev_b32 v73, 4, v65
  v_lshl_add_u32 v73, v73, 6, v72
  s_lshl_b32 s22, s17, 9
  s_add_u32 s22, s22, 9472
  v_add_u32 v73, s22, v73
  v_lshrrev_b32 v72, 1, v65
  v_lshlrev_b32 v72, 2, v72
  v_lshl_add_u32 v72, v64, 5, v72
  s_lshr_b32 s22, s17, 1
  s_lshl_b32 s22, s22, 8
  s_and_b32 s34, s17, 1
  s_lshl_b32 s34, s34, 4
  s_add_u32 s22, s22, s34
  s_add_u32 s22, s22, 7296
  v_add_u32 v74, s22, v72
  v_lshlrev_b32 v0, 2, v65
  v_and_b32 v0, 120, v0
  s_and_b32 s22, s17, 15
  s_lshl_b32 s22, s22, 7
  s_add_u32 s22, s22, 18432
  v_add_u32 v0, s22, v0
  v_cndmask_b32 v1, v74, v73, s[38:39]
  s_lshl_b32 s36, s17, 2
  s_add_u32 s36, s36, 17472
  s_mov_b32 s37, 0x3e800000
  v_mov_b32 v64, 0
  v_mov_b32 v65, 0
  v_mov_b32 v66, 0
  v_mov_b32 v67, 0
  v_mov_b32 v68, 0
  v_mov_b32 v69, 0
  v_mov_b32 v70, 0
  v_mov_b32 v71, 0
  v_mov_b32 v72, 0
  v_mov_b32 v73, 0
  v_mov_b32 v74, 0
  v_mov_b32 v75, 0
  v_mov_b32 v76, 0
  v_mov_b32 v77, 0
  v_mov_b32 v78, 0
  v_mov_b32 v79, 0
  v_mov_b32 v80, 0
  v_mov_b32 v81, 0
  v_mov_b32 v82, 0
  v_mov_b32 v83, 0
  v_mov_b32 v84, 0
  v_mov_b32 v85, 0
  v_mov_b32 v86, 0
  v_mov_b32 v87, 0
  v_mov_b32 v88, 0
  v_mov_b32 v89, 0
  v_mov_b32 v90, 0
  v_mov_b32 v91, 0
  v_mov_b32 v92, 0
  v_mov_b32 v93, 0
  v_mov_b32 v94, 0
  v_mov_b32 v95, 0
  v_mov_b32 v96, 0
  v_mov_b32 v97, 0
  v_mov_b32 v98, 0
  v_mov_b32 v99, 0
  v_mov_b32 v100, 0
  v_mov_b32 v101, 0
  v_mov_b32 v102, 0
  v_mov_b32 v103, 0
  v_mov_b32 v104, 0
  v_mov_b32 v105, 0
  v_mov_b32 v106, 0
  v_mov_b32 v107, 0
  v_mov_b32 v108, 0
  v_mov_b32 v109, 0
  v_mov_b32 v110, 0
  v_mov_b32 v111, 0
  v_and_b32 v118, 1, v116
  v_cmp_eq_u32 vcc, 0, v118
  v_mov_b32 v118, 12544
  v_mov_b32 v119, 10240
  v_cndmask_b32 v118, v118, v119, vcc
  v_lshrrev_b32 v116, 1, v116
  v_lshl_add_u32 v118, v116, 9, v118
  v_lshl_add_u32 v117, v117, 4, v118
  s_mov_b32 s57, 28672
  v_bfe_u32 v118, v2, 4, 1
  v_mul_u32_u24 v118, 0xaaaa, v118
  v_add_u32 v118, 0x4444, v118
  s_mov_b32 s56, 0x42800000
  v_mov_b32 v116, v2
  v_lshrrev_b32 v0, 4, v2
  v_min_u32 v0, 13, v0
  s_mul_i32 s22, s17, 14
  v_add_u32 v0, s22, v0
  v_lshlrev_b32 v0, 7, v0
  v_add_u32 v0, 43008, v0
  s_mov_b32 s22, 71550976
  buffer_load_dword v119, v0, s[8:11], s22 offen sc1
  s_mov_b32 s22, 71522304
  buffer_load_dword v119, v0, s[8:11], s22 offen sc1
  s_mul_i32 s35, s17, 1835008
  s_add_u32 s35, s35, 42276864
  s_mov_b32 s30, 0
  v_mov_b32 v36, 0
ch_md2:
  buffer_load_dword v37, v36, s[12:15], 0 offen sc1
  s_waitcnt vmcnt(0)
  v_readfirstlane_b32 s22, v37
  s_and_b32 s31, s22, 0xffff
  s_cmp_ge_u32 s31, 32
  s_cbranch_scc1 ch_go2
  s_sleep 2
  s_add_u32 s30, s30, 1
  s_cmp_lt_u32 s30, 50000
  s_cbranch_scc1 ch_md2
  s_branch ch_end
ch_go2:
  s_mov_b32 s31, 0
  s_lshr_b32 s22, s22, 16
  s_cmp_lg_u32 s22, 0
  s_cbranch_scc1 cB_sc2_loop
  s_branch cA_sc2_loop
ch_init3:
  s_mul_i32 s31, s17, 401408
  s_add_u32 s31, s31, 0
  s_mov_b32 s24, 71586816
  s_mov_b32 s25, 0
  s_add_u32 m0, s25, 21504
  s_nop 0
  buffer_load_dwordx4 v2, s[8:11], s24 offen offset:0 sc1 lds
  buffer_load_dwordx4 v2, s[8:11], s24 offen offset:1024 sc1 lds
  buffer_load_dwordx4 v2, s[8:11], s24 offen offset:2048 sc1 lds
  buffer_load_dwordx4 v2, s[8:11], s24 offen offset:3072 sc1 lds
  s_add_u32 m0, s25, 25600
  s_add_u32 s22, s24, 4096
  buffer_load_dwordx4 v2, s[8:11], s22 offen offset:0 sc1 lds
  buffer_load_dwordx4 v2, s[8:11], s22 offen offset:1024 sc1 lds
  buffer_load_dwordx4 v2, s[8:11], s22 offen offset:2048 sc1 lds
  v_lshrrev_b32 v64, 1, v117
  v_and_b32 v65, 1, v116
  v_lshlrev_b32 v65, 2, v65
  v_sub_u32 v64, v64, v65
  v_and_b32 v65, 1, v117
  v_lshl_add_u32 v66, v65, 2, v64
  v_cmp_gt_u32 vcc, 4, v64
  v_mov_b32 v67, 99
  s_nop 0
  v_cndmask_b32 v66, v67, v66, vcc
  v_mov_b32 v68, 0x3f80
  v_mov_b32 v69, 0x3f800000
  v_mov_b32 v4, 0
  v_cmp_eq_u32 vcc, 0, v66
  s_nop 1
  v_cndmask_b32 v4, v4, v68, vcc
  v_cmp_eq_u32 vcc, 1, v66
  s_nop 1
  v_cndmask_b32 v4, v4, v69, vcc
  v_mov_b32 v5, 0
  v_cmp_eq_u32 vcc, 2, v66
  s_nop 1
  v_cndmask_b32 v5, v5, v68, vcc
  v_cmp_eq_u32 vcc, 3, v66
  s_nop 1
  v_cndmask_b32 v5, v5, v69, vcc
  v_mov_b32 v6, 0
  v_cmp_eq_u32 vcc, 4, v66
  s_nop 1
  v_cndmask_b32 v6, v6, v68, vcc
  v_cmp_eq_u32 vcc, 5, v66
  s_nop 1
  v_cndmask_b32 v6, v6, v69, vcc
  v_mov_b32 v7, 0
  v_cmp_eq_u32 vcc, 6, v66
  s_nop 1
  v_cndmask_b32 v7, v7, v68, vcc
  v_cmp_eq_u32 vcc, 7, v66
  s_nop 1
  v_cndmask_b32 v7, v7, v69, vcc
  v_lshrrev_b32 v64, 1, v116
  v_lshrrev_b32 v65, 3, v117
  v_cmp_eq_u32 s[26:27], v64, v65
  v_and_b32 v66, 1, v116
  v_add_u32 v64, 6, v64
  v_lshrrev_b32 v67, 1, v116
  v_lshlrev_b32 v67, 8, v67
  v_lshl_add_u32 v67, v66, 9, v67
  v_lshl_add_u32 v67, v117, 4, v67
  v_add_u32 v112, 60416, v67
  v_and_b32 v68, 7, v117
  v_lshlrev_b32 v67, 8, v64
  v_lshl_add_u32 v67, v68, 5, v67
  v_lshl_add_u32 v67, v66, 4, v67
  v_add_u32 v113, 65536, v67
  v_lshrrev_b32 v64, 5, v1
  v_and_b32 v65, 31, v1
  v_lshrrev_b32 v66, 3, v65
  v_and_b32 v67, 7, v65
  v_and_b32 v68, 3, v67
  v_lshl_add_u32 v68, v66, 2, v68
  v_lshrrev_b32 v69, 2, v67
  v_lshl_add_u32 v68, v69, 4, v68
  v_lshlrev_b32 v69, 11, v64
  v_lshl_add_u32 v69, v68, 4, v69
  v_add_u32 v114, 57864, v69
  v_add_u32 v70, 6, v64
  v_lshlrev_b32 v69, 9, v66
  v_lshl_add_u32 v69, v70, 5, v69
  v_lshl_add_u32 v69, v67, 2, v69
  v_add_u32 v115, 65536, v69
  v_lshlrev_b32 v69, 4, v68
  v_lshl_add_u32 v69, v64, 9, v69
  v_add_u32 v114, 60416, v69
  v_mul_u32_u24 v69, 144, v70
  v_lshl_add_u32 v69, v67, 4, v69
  v_add_u32 v115, 65536, v69
  v_and_b32 v71, 1, v116
  v_mul_u32_u24 v69, 2048, v71
  v_lshl_add_u32 v69, v64, 8, v69
  v_lshl_add_u32 v69, v117, 4, v69
  v_add_u32 v112, 57864, v69
  v_mul_u32_u24 v69, 144, v117
  v_lshl_add_u32 v69, v71, 6, v69
  v_lshl_add_u32 v69, v64, 5, v69
  v_add_u32 v113, 65548, v69
  v_mul_u32_u24 v69, 1024, v116
  v_lshl_add_u32 v69, v117, 4, v69
  v_and_b32 v72, 8, v117
  v_xor_b32 v72, 8, v72
  v_add_u32 v69, v69, v72
  v_add_u32 v112, 57856, v69
  v_lshrrev_b32 v72, 3, v117
  v_lshl_add_u32 v72, v71, 1, v72
  v_xor_b32 v72, 3, v72
  v_lshlrev_b32 v69, 10, v116
  v_lshl_add_u32 v69, v117, 4, v69
  v_lshl_add_u32 v69, v72, 2, v69
  v_add_u32 v112, 57344, v69
  v_lshrrev_b32 v69, 1, v117
  v_and_b32 v72, 1, v117
  v_lshl_add_u32 v69, v72, 3, v69
  v_mul_u32_u24 v69, 144, v69
  v_lshl_add_u32 v69, v71, 6, v69
  v_lshl_add_u32 v69, v64, 5, v69
  v_lshl_add_u32 v72, v72, 1, v71
  v_xor_b32 v72, 3, v72
  v_lshl_add_u32 v69, v72, 2, v69
  v_add_u32 v113, 65536, v69
  v_and_b32 v71, 1, v1
  v_cmp_eq_u32 s[38:39], 0, v71
  v_cmp_gt_u32 vcc, 8, v65
  s_or_b64 s[28:29], s[38:39], vcc
  v_lshrrev_b32 v72, 1, v67
  v_lshlrev_b32 v72, 2, v72
  v_lshl_add_u32 v72, v70, 4, v72
  s_lshl_b32 s22, s17, 9
  s_add_u32 s22, s22, 9216
  v_lshl_add_u32 v73, v66, 7, v72
  v_add_u32 v73, s22, v73
  s_lshl_b32 s22, s17, 7
  s_add_u32 s22, s22, 7168
  v_add_u32 v74, s22, v72
  v_bfe_u32 v72, v65, 1, 1
  v_lshlrev_b32 v72, 7, v72
  v_lshl_add_u32 v72, v70, 4, v72
  v_bfe_u32 v73, v65, 2, 2
  v_lshl_add_u32 v72, v73, 2, v72
  v_lshrrev_b32 v73, 4, v65
  v_lshl_add_u32 v73, v73, 8, v72
  s_lshl_b32 s22, s17, 9
  s_add_u32 s22, s22, 9216
  v_add_u32 v73, s22, v73
  s_lshr_b32 s22, s17, 1
  s_lshl_b32 s22, s22, 8
  s_and_b32 s34, s17, 1
  s_lshl_b32 s34, s34, 3
  s_add_u32 s22, s22, s34
  s_add_u32 s22, s22, 7168
  v_add_u32 v74, s22, v72
  v_bfe_u32 v72, v65, 1, 1
  v_lshl_add_u32 v72, v64, 1, v72
  v_lshlrev_b32 v72, 4, v72
  v_bfe_u32 v73, v65, 2, 2
  v_lshl_add_u32 v72, v73, 2, v72
  v_lshrrev_b32 v73, 4, v65
  v_lshl_add_u32 v73, v73, 6, v72
  s_lshl_b32 s22, s17, 9
  s_add_u32 s22, s22, 9600
  v_add_u32 v73, s22, v73
  v_lshrrev_b32 v72, 1, v65
  v_lshlrev_b32 v72, 2, v72
  v_lshl_add_u32 v72, v64, 5, v72
  s_lshr_b32 s22, s17, 1
  s_lshl_b32 s22, s22, 8
  s_and_b32 s34, s17, 1
  s_lshl_b32 s34, s34, 4
  s_add_u32 s22, s22, s34
  s_add_u32 s22, s22, 7360
  v_add_u32 v74, s22, v72
  v_lshlrev_b32 v0, 2, v65
  v_and_b32 v0, 120, v0
  s_and_b32 s22, s17, 15
  s_lshl_b32 s22, s22, 7
  s_add_u32 s22, s22, 18432
  v_add_u32 v0, s22, v0
  v_cndmask_b32 v1, v74, v73, s[38:39]
  s_lshl_b32 s36, s17, 2
  s_add_u32 s36, s36, 17472
  s_mov_b32 s37, 0x3e800000
  v_mov_b32 v64, 0
  v_mov_b32 v65, 0
  v_mov_b32 v66, 0
  v_mov_b32 v67, 0
  v_mov_b32 v68, 0
  v_mov_b32 v69, 0
  v_mov_b32 v70, 0
  v_mov_b32 v71, 0
  v_mov_b32 v72, 0
  v_mov_b32 v73, 0
  v_mov_b32 v74, 0
  v_mov_b32 v75, 0
  v_mov_b32 v76, 0
  v_mov_b32 v77, 0
  v_mov_b32 v78, 0
  v_mov_b32 v79, 0
  v_mov_b32 v80, 0
  v_mov_b32 v81, 0
  v_mov_b32 v82, 0
  v_mov_b32 v83, 0
  v_mov_b32 v84, 0
  v_mov_b32 v85, 0
  v_mov_b32 v86, 0
  v_mov_b32 v87, 0
  v_mov_b32 v88, 0
  v_mov_b32 v89, 0
  v_mov_b32 v90, 0
  v_mov_b32 v91, 0
  v_mov_b32 v92, 0
  v_mov_b32 v93, 0
  v_mov_b32 v94, 0
  v_mov_b32 v95, 0
  v_mov_b32 v96, 0
  v_mov_b32 v97, 0
  v_mov_b32 v98, 0
  v_mov_b32 v99, 0
  v_mov_b32 v100, 0
  v_mov_b32 v101, 0
  v_mov_b32 v102, 0
  v_mov_b32 v103, 0
  v_mov_b32 v104, 0
  v_mov_b32 v105, 0
  v_mov_b32 v106, 0
  v_mov_b32 v107, 0
  v_mov_b32 v108, 0
  v_mov_b32 v109, 0
  v_mov_b32 v110, 0
  v_mov_b32 v111, 0
  v_and_b32 v118, 1, v116
  v_cmp_eq_u32 vcc, 0, v118
  v_mov_b32 v118, 12544
  v_mov_b32 v119, 10496
  v_cndmask_b32 v118, v118, v119, vcc
  v_lshrrev_b32 v116, 1, v116
  v_lshl_add_u32 v118, v116, 9, v118
  v_lshl_add_u32 v117, v117, 4, v118
  s_mov_b32 s57, 28672
  v_bfe_u32 v118, v2, 4, 1
  v_mul_u32_u24 v118, 0xaaaa, v118
  v_add_u32 v118, 0x4444, v118
  s_mov_b32 s56, 0x42800000
  v_mov_b32 v116, v2
  s_mul_i32 s35, s17, 1835008
  s_add_u32 s35, s35, 42284032
  s_mov_b32 s30, 0
  v_mov_b32 v36, 0
ch_md3:
  buffer_load_dword v37, v36, s[12:15], 0 offen sc1
  s_waitcnt vmcnt(0)
  v_readfirstlane_b32 s22, v37
  s_and_b32 s31, s22, 0xffff
  s_cmp_ge_u32 s31, 32
  s_cbranch_scc1 ch_go3
  s_sleep 2
  s_add_u32 s30, s30, 1
  s_cmp_lt_u32 s30, 50000
  s_cbranch_scc1 ch_md3
  s_branch ch_end
ch_go3:
  s_mov_b32 s31, 0
  s_lshr_b32 s22, s22, 16
  s_cmp_lg_u32 s22, 0
  s_cbranch_scc1 cB_sc3_loop
  s_branch cA_sc3_loop
ch_init4:
  s_mul_i32 s31, s17, 401408
  s_add_u32 s31, s31, 6422528
  s_lshl_b32 s22, s17, 4
  v_mov_b32 v38, s22
  v_mov_b32 v36, v38
  v_med3_u32 v37, v117, 0, 5
  v_lshrrev_b32 v36, 6, v36
  v_lshlrev_b32 v36, 8, v36
  v_lshl_add_u32 v36, v37, 4, v36
  s_mov_b32 s22, 88600576
  s_mov_b32 s30, 0
va_bw_11:
  buffer_load_dwordx4 v[40:43], v36, s[8:11], s22 offen sc1
  s_waitcnt vmcnt(0)
  v_cmp_ne_u64 vcc, s[88:89], v[40:41]
  s_cbranch_vccnz va_bw_11_no
  v_cmp_ne_u64 vcc, s[88:89], v[42:43]
  s_cbranch_vccnz va_bw_11_no
  s_branch va_bw_11_ok
va_bw_11_no:
  s_sleep 2
  s_add_u32 s30, s30, 1
  s_cmp_lt_u32 s30, 50000
  s_cbranch_scc1 va_bw_11
  s_branch cA_abort
va_bw_11_ok:
  s_add_u32 s22, s31, 0
  buffer_load_dwordx4 a[0:3], v2, s[8:11], s22 offen offset:0 sc1
  buffer_load_dwordx4 a[4:7], v2, s[8:11], s22 offen offset:1024 sc1
  buffer_load_dwordx4 a[8:11], v2, s[8:11], s22 offen offset:2048 sc1
  buffer_load_dwordx4 a[12:15], v2, s[8:11], s22 offen offset:3072 sc1
  s_add_u32 s22, s31, 4096
  buffer_load_dwordx4 a[16:19], v2, s[8:11], s22 offen offset:0 sc1
  buffer_load_dwordx4 a[20:23], v2, s[8:11], s22 offen offset:1024 sc1
  buffer_load_dwordx4 a[24:27], v2, s[8:11], s22 offen offset:2048 sc1
  buffer_load_dwordx4 a[28:31], v2, s[8:11], s22 offen offset:3072 sc1
  s_add_u32 s22, s31, 8192
  buffer_load_dwordx4 a[32:35], v2, s[8:11], s22 offen offset:0 sc1
  buffer_load_dwordx4 a[36:39], v2, s[8:11], s22 offen offset:1024 sc1
  buffer_load_dwordx4 a[40:43], v2, s[8:11], s22 offen offset:2048 sc1
  buffer_load_dwordx4 a[44:47], v2, s[8:11], s22 offen offset:3072 sc1
  s_add_u32 s22, s31, 12288
  buffer_load_dwordx4 a[48:51], v2, s[8:11], s22 offen offset:0 sc1
  buffer_load_dwordx4 a[52:55], v2, s[8:11], s22 offen offset:1024 sc1
  buffer_load_dwordx4 a[56:59], v2, s[8:11], s22 offen offset:2048 sc1
  buffer_load_dwordx4 a[60:63], v2, s[8:11], s22 offen offset:3072 sc1
  s_add_u32 s22, s31, 16384
  buffer_load_dwordx4 a[64:67], v2, s[8:11], s22 offen offset:0 sc1
  buffer_load_dwordx4 a[68:71], v2, s[8:11], s22 offen offset:1024 sc1
  buffer_load_dwordx4 a[72:75], v2, s[8:11], s22 offen offset:2048 sc1
  buffer_load_dwordx4 a[76:79], v2, s[8:11], s22 offen offset:3072 sc1
  s_add_u32 s22, s31, 20480
  buffer_load_dwordx4 a[80:83], v2, s[8:11], s22 offen offset:0 sc1
  buffer_load_dwordx4 a[84:87], v2, s[8:11], s22 offen offset:1024 sc1
  buffer_load_dwordx4 a[88:91], v2, s[8:11], s22 offen offset:2048 sc1
  buffer_load_dwordx4 a[92:95], v2, s[8:11], s22 offen offset:3072 sc1
  s_add_u32 s22, s31, 24576
  buffer_load_dwordx4 a[96:99], v2, s[8:11], s22 offen offset:0 sc1
  buffer_load_dwordx4 a[100:103], v2, s[8:11], s22 offen offset:1024 sc1
  buffer_load_dwordx4 a[104:107], v2, s[8:11], s22 offen offset:2048 sc1
  buffer_load_dwordx4 a[108:111], v2, s[8:11], s22 offen offset:3072 sc1
  s_add_u32 s22, s31, 28672
  buffer_load_dwordx4 a[112:115], v2, s[8:11], s22 offen offset:0 sc1
  buffer_load_dwordx4 a[116:119], v2, s[8:11], s22 offen offset:1024 sc1
  buffer_load_dwordx4 a[120:123], v2, s[8:11], s22 offen offset:2048 sc1
  buffer_load_dwordx4 a[124:127], v2, s[8:11], s22 offen offset:3072 sc1
  s_waitcnt vmcnt(24)
  s_add_u32 s22, s31, 32768
  buffer_load_dwordx4 a[128:131], v2, s[8:11], s22 offen offset:0 sc1
  buffer_load_dwordx4 a[132:135], v2, s[8:11], s22 offen offset:1024 sc1
  buffer_load_dwordx4 a[136:139], v2, s[8:11], s22 offen offset:2048 sc1
  buffer_load_dwordx4 a[140:143], v2, s[8:11], s22 offen offset:3072 sc1
  s_add_u32 s22, s31, 36864
  buffer_load_dwordx4 a[144:147], v2, s[8:11], s22 offen offset:0 sc1
  buffer_load_dwordx4 a[148:151], v2, s[8:11], s22 offen offset:1024 sc1
  buffer_load_dwordx4 a[152:155], v2, s[8:11], s22 offen offset:2048 sc1
  buffer_load_dwordx4 a[156:159], v2, s[8:11], s22 offen offset:3072 sc1
  s_add_u32 s22, s31, 40960
  buffer_load_dwordx4 a[160:163], v2, s[8:11], s22 offen offset:0 sc1
  buffer_load_dwordx4 a[164:167], v2, s[8:11], s22 offen offset:1024 sc1
  buffer_load_dwordx4 a[168:171], v2, s[8:11], s22 offen offset:2048 sc1
  buffer_load_dwordx4 a[172:175], v2, s[8:11], s22 offen offset:3072 sc1
  s_add_u32 s22, s31, 45056
  buffer_load_dwordx4 a[176:179], v2, s[8:11], s22 offen offset:0 sc1
  buffer_load_dwordx4 a[180:183], v2, s[8:11], s22 offen offset:1024 sc1
  buffer_load_dwordx4 a[184:187], v2, s[8:11], s22 offen offset:2048 sc1
  buffer_load_dwordx4 a[188:191], v2, s[8:11], s22 offen offset:3072 sc1
  s_add_u32 s22, s31, 49152
  buffer_load_dwordx4 a[192:195], v2, s[8:11], s22 offen offset:0 sc1
  buffer_load_dwordx4 a[196:199], v2, s[8:11], s22 offen offset:1024 sc1
  buffer_load_dwordx4 a[200:203], v2, s[8:11], s22 offen offset:2048 sc1
  buffer_load_dwordx4 a[204:207], v2, s[8:11], s22 offen offset:3072 sc1
  s_add_u32 s22, s31, 53248
  buffer_load_dwordx4 a[208:211], v2, s[8:11], s22 offen offset:0 sc1
  buffer_load_dwordx4 a[212:215], v2, s[8:11], s22 offen offset:1024 sc1
  buffer_load_dwordx4 a[216:219], v2, s[8:11], s22 offen offset:2048 sc1
  buffer_load_dwordx4 a[220:223], v2, s[8:11], s22 offen offset:3072 sc1
  s_add_u32 s22, s31, 57344
  buffer_load_dwordx4 a[224:227], v2, s[8:11], s22 offen offset:0 sc1
  buffer_load_dwordx4 a[228:231], v2, s[8:11], s22 offen offset:1024 sc1
  buffer_load_dwordx4 a[232:235], v2, s[8:11], s22 offen offset:2048 sc1
  buffer_load_dwordx4 a[236:239], v2, s[8:11], s22 offen offset:3072 sc1
  s_add_u32 s22, s31, 61440
  buffer_load_dwordx4 a[240:243], v2, s[8:11], s22 offen offset:0 sc1
  buffer_load_dwordx4 a[244:247], v2, s[8:11], s22 offen offset:1024 sc1
  buffer_load_dwordx4 a[248:251], v2, s[8:11], s22 offen offset:2048 sc1
  buffer_load_dwordx4 a[252:255], v2, s[8:11], s22 offen offset:3072 sc1
  s_waitcnt vmcnt(24)
  s_add_u32 s22, s31, 65536
  buffer_load_dwordx4 v[176:179], v2, s[8:11], s22 offen offset:0 sc1
  buffer_load_dwordx4 v[180:183], v2, s[8:11], s22 offen offset:1024 sc1
  buffer_load_dwordx4 v[184:187], v2, s[8:11], s22 offen offset:2048 sc1
  buffer_load_dwordx4 v[188:191], v2, s[8:11], s22 offen offset:3072 sc1
  s_add_u32 s22, s31, 69632
  buffer_load_dwordx4 v[192:195], v2, s[8:11], s22 offen offset:0 sc1
  buffer_load_dwordx4 v[196:199], v2, s[8:11], s22 offen offset:1024 sc1
  buffer_load_dwordx4 v[200:203], v2, s[8:11], s22 offen offset:2048 sc1
  buffer_load_dwordx4 v[204:207], v2, s[8:11], s22 offen offset:3072 sc1
  s_add_u32 s22, s31, 73728
  buffer_load_dwordx4 v[208:211], v2, s[8:11], s22 offen offset:0 sc1
  buffer_load_dwordx4 v[212:215], v2, s[8:11], s22 offen offset:1024 sc1
  buffer_load_dwordx4 v[216:219], v2, s[8:11], s22 offen offset:2048 sc1
  buffer_load_dwordx4 v[220:223], v2, s[8:11], s22 offen offset:3072 sc1
  s_add_u32 s22, s31, 77824
  buffer_load_dwordx4 v[224:227], v2, s[8:11], s22 offen offset:0 sc1
  buffer_load_dwordx4 v[228:231], v2, s[8:11], s22 offen offset:1024 sc1
  buffer_load_dwordx4 v[232:235], v2, s[8:11], s22 offen offset:2048 sc1
  buffer_load_dwordx4 v[236:239], v2, s[8:11], s22 offen offset:3072 sc1
  s_add_u32 s22, s31, 81920
  buffer_load_dwordx4 v[240:243], v2, s[8:11], s22 offen offset:0 sc1
  buffer_load_dwordx4 v[244:247], v2, s[8:11], s22 offen offset:1024 sc1
  buffer_load_dwordx4 v[248:251], v2, s[8:11], s22 offen offset:2048 sc1
  buffer_load_dwordx4 v[252:255], v2, s[8:11], s22 offen offset:3072 sc1
  s_lshl_b32 s22, s17, 4
  v_mov_b32 v38, s22
  s_mul_i32 s22, s17, 12
  s_add_u32 s23, s22, 267
  s_add_u32 s22, s22, 256
  v_mov_b32 v36, s23
  v_mov_b32 v37, s22
  v_cmp_eq_u32 vcc, 1, v116
  s_nop 1
  v_cndmask_b32 v36, v36, v37, vcc
  v_med3_u32 v37, v117, 4, 5
  v_lshrrev_b32 v36, 6, v36
  v_lshlrev_b32 v36, 8, v36
  v_lshl_add_u32 v36, v37, 4, v36
  s_mov_b32 s22, 88600576
  s_mov_b32 s30, 0
va_bw_12:
  buffer_load_dwordx4 v[40:43], v36, s[8:11], s22 offen sc1
  s_waitcnt vmcnt(0)
  v_cmp_ne_u64 vcc, s[88:89], v[40:41]
  s_cbranch_vccnz va_bw_12_no
  v_cmp_ne_u64 vcc, s[88:89], v[42:43]
  s_cbranch_vccnz va_bw_12_no
  s_branch va_bw_12_ok
va_bw_12_no:
  s_sleep 2
  s_add_u32 s30, s30, 1
  s_cmp_lt_u32 s30, 50000
  s_cbranch_scc1 va_bw_12
  s_branch cA_abort
va_bw_12_ok:
  s_mov_b32 m0, 16384
  s_add_u32 s22, s31, 272384
  buffer_load_dwordx4 v2, s[8:11], s22 offen offset:0 sc1 lds
  buffer_load_dwordx4 v2, s[8:11], s22 offen offset:1024 sc1 lds
  buffer_load_dwordx4 v2, s[8:11], s22 offen offset:2048 sc1 lds
  buffer_load_dwordx4 v2, s[8:11], s22 offen offset:3072 sc1 lds
  s_mov_b32 m0, 20480
  s_add_u32 s22, s31, 276480
  buffer_load_dwordx4 v2, s[8:11], s22 offen offset:0 sc1 lds
  buffer_load_dwordx4 v2, s[8:11], s22 offen offset:1024 sc1 lds
  buffer_load_dwordx4 v2, s[8:11], s22 offen offset:2048 sc1 lds
  buffer_load_dwordx4 v2, s[8:11], s22 offen offset:3072 sc1 lds
  s_mov_b32 m0, 24576
  s_add_u32 s22, s31, 280576
  buffer_load_dwordx4 v2, s[8:11], s22 offen offset:0 sc1 lds
  buffer_load_dwordx4 v2, s[8:11], s22 offen offset:1024 sc1 lds
  buffer_load_dwordx4 v2, s[8:11], s22 offen offset:2048 sc1 lds
  buffer_load_dwordx4 v2, s[8:11], s22 offen offset:3072 sc1 lds
  s_mov_b32 m0, 28672
  s_add_u32 s22, s31, 284672
  buffer_load_dwordx4 v2, s[8:11], s22 offen offset:0 sc1 lds
  buffer_load_dwordx4 v2, s[8:11], s22 offen offset:1024 sc1 lds
  v_mov_b32 v72, v116
  v_mov_b32 v73, v117
  v_lshrrev_b32 v65, 1, v72
  v_and_b32 v66, 1, v72
  v_mov_b32 v68, 0
  v_mov_b32 v69, v73
  v_mov_b32 v70, 0
  v_and_b32 v71, 1, v69
  v_lshrrev_b32 v69, 1, v69
  v_lshl_add_u32 v69, v71, 3, v69
  v_lshlrev_b32 v71, 12, v70
  v_lshrrev_b32 v70, 1, v68
  v_lshl_add_u32 v71, v70, 9, v71
  v_and_b32 v70, 1, v68
  v_lshl_add_u32 v71, v70, 2, v71
  v_lshl_add_u32 v71, v69, 4, v71
  v_lshl_add_u32 v71, v65, 8, v71
  v_lshl_add_u32 v60, v66, 3, v71
  v_mov_b32 v68, 1
  v_mov_b32 v69, v73
  v_mov_b32 v70, 0
  v_and_b32 v71, 1, v69
  v_lshrrev_b32 v69, 1, v69
  v_lshl_add_u32 v69, v71, 3, v69
  v_lshlrev_b32 v71, 12, v70
  v_lshrrev_b32 v70, 1, v68
  v_lshl_add_u32 v71, v70, 9, v71
  v_and_b32 v70, 1, v68
  v_lshl_add_u32 v71, v70, 2, v71
  v_lshl_add_u32 v71, v69, 4, v71
  v_lshl_add_u32 v71, v65, 8, v71
  v_lshl_add_u32 v61, v66, 3, v71
  v_mov_b32 v68, 2
  v_mov_b32 v69, v73
  v_mov_b32 v70, 0
  v_and_b32 v71, 1, v69
  v_lshrrev_b32 v69, 1, v69
  v_lshl_add_u32 v69, v71, 3, v69
  v_lshlrev_b32 v71, 12, v70
  v_lshrrev_b32 v70, 1, v68
  v_lshl_add_u32 v71, v70, 9, v71
  v_and_b32 v70, 1, v68
  v_lshl_add_u32 v71, v70, 2, v71
  v_lshl_add_u32 v71, v69, 4, v71
  v_lshl_add_u32 v71, v65, 8, v71
  v_lshl_add_u32 v62, v66, 3, v71
  v_mov_b32 v68, 3
  v_mov_b32 v69, v73
  v_mov_b32 v70, 0
  v_and_b32 v71, 1, v69
  v_lshrrev_b32 v69, 1, v69
  v_lshl_add_u32 v69, v71, 3, v69
  v_lshlrev_b32 v71, 12, v70
  v_lshrrev_b32 v70, 1, v68
  v_lshl_add_u32 v71, v70, 9, v71
  v_and_b32 v70, 1, v68
  v_lshl_add_u32 v71, v70, 2, v71
  v_lshl_add_u32 v71, v69, 4, v71
  v_lshl_add_u32 v71, v65, 8, v71
  v_lshl_add_u32 v170, v66, 3, v71
  v_mov_b32 v68, 4
  v_mov_b32 v69, v73
  v_mov_b32 v70, 0
  v_and_b32 v71, 1, v69
  v_lshrrev_b32 v69, 1, v69
  v_lshl_add_u32 v69, v71, 3, v69
  v_lshlrev_b32 v71, 12, v70
  v_lshrrev_b32 v70, 1, v68
  v_lshl_add_u32 v71, v70, 9, v71
  v_and_b32 v70, 1, v68
  v_lshl_add_u32 v71, v70, 2, v71
  v_lshl_add_u32 v71, v69, 4, v71
  v_lshl_add_u32 v71, v65, 8, v71
  v_lshl_add_u32 v171, v66, 3, v71
  v_mov_b32 v68, 5
  v_mov_b32 v69, v73
  v_mov_b32 v70, 0
  v_and_b32 v71, 1, v69
  v_lshrrev_b32 v69, 1, v69
  v_lshl_add_u32 v69, v71, 3, v69
  v_lshlrev_b32 v71, 12, v70
  v_lshrrev_b32 v70, 1, v68
  v_lshl_add_u32 v71, v70, 9, v71
  v_and_b32 v70, 1, v68
  v_lshl_add_u32 v71, v70, 2, v71
  v_lshl_add_u32 v71, v69, 4, v71
  v_lshl_add_u32 v71, v65, 8, v71
  v_lshl_add_u32 v172, v66, 3, v71
  v_and_b32 v0, 31, v1
  v_lshlrev_b32 v0, 2, v0
  v_add_u32 v0, 18432, v0
  v_min_u32 v4, 15, v73
  v_lshlrev_b32 v4, 2, v4
  s_and_b32 s22, s17, 3
  s_lshl_b32 s22, s22, 7
  s_add_u32 s22, s22, 17408
  v_add_u32 v4, s22, v4
  v_and_b32 v64, 7, v73
  v_lshlrev_b32 v5, 4, v64
  v_lshl_add_u32 v5, v72, 7, v5
  v_lshrrev_b32 v65, 3, v73
  v_lshl_add_u32 v5, v65, 9, v5
  s_lshl_b32 s22, s17, 3
  s_add_u32 s22, s22, 18432
  v_lshl_add_u32 v7, v2, 3, s22
  v_add_u32 v65, 0, v73
  v_min_u32 v65, 27, v65
  v_mad_u32_u24 v65, v72, 28, v65
  v_lshlrev_b32 v6, 4, v65
  s_lshr_b32 s22, s17, 1
  s_mul_i32 s22, s22, 7
  s_and_b32 s34, s17, 1
  s_lshl_b32 s35, s34, 2
  v_add_u32 v70, s35, v72
  v_mov_b32 v71, s34
  v_mov_b32 v69, 0
  v_cmp_eq_u32 vcc, 3, v72
  s_nop 1
  v_cndmask_b32 v70, v70, v72, vcc
  v_cndmask_b32 v69, v69, v71, vcc
  v_add_u32 v70, s22, v70
  v_lshrrev_b32 v68, 1, v70
  v_lshlrev_b32 v68, 8, v68
  v_lshl_add_u32 v68, v69, 7, v68
  v_and_b32 v69, 1, v70
  v_lshl_add_u32 v68, v69, 3, v68
  v_lshl_add_u32 v1, v64, 4, v68
  v_cmp_gt_u32 s[26:27], 8, v73
  v_lshrrev_b32 v65, 3, v73
  v_min_u32 v66, 7, v64
  v_lshl_add_u32 v66, v66, 1, v65
  v_mad_u32_u24 v66, v72, 16, v66
  v_lshlrev_b32 v66, 4, v66
  v_add_u32 v6, 0, v66
  s_mul_i32 s22, s17, 16
  s_add_u32 s22, s22, 0
  v_lshl_add_u32 v70, v64, 1, s22
  v_lshrrev_b32 v68, 4, v70
  v_lshlrev_b32 v68, 8, v68
  v_bfe_u32 v69, v70, 1, 1
  v_lshl_add_u32 v68, v69, 7, v68
  v_bfe_u32 v69, v70, 2, 2
  v_lshl_add_u32 v68, v69, 2, v68
  v_and_b32 v69, 1, v72
  v_lshl_add_u32 v65, v69, 2, v65
  v_lshrrev_b32 v69, 1, v72
  v_lshl_add_u32 v65, v69, 1, v65
  v_lshrrev_b32 v65, 3, v73
  v_lshl_add_u32 v65, v72, 1, v65
  v_lshrrev_b32 v5, 1, v72
  v_lshlrev_b32 v5, 9, v5
  v_lshrrev_b32 v69, 2, v73
  v_lshl_add_u32 v5, v69, 7, v5
  v_and_b32 v69, 1, v72
  v_lshl_add_u32 v5, v69, 6, v5
  v_and_b32 v69, 3, v73
  v_lshl_add_u32 v5, v69, 4, v5
  v_and_b32 v69, 1, v73
  v_mul_u32_u24 v69, 0xaaaa, v69
  v_add_u32 v0, 0x4444, v69
  v_lshl_add_u32 v1, v65, 4, v68
  v_cmp_gt_u32 s[26:27], 6, v64
  v_mov_b32 v156, 0
  v_mov_b32 v157, 0
  v_mov_b32 v158, 0
  v_mov_b32 v159, 0
  ds_write_b128 v2, v[156:159] offset:0
  ds_write_b128 v2, v[156:159] offset:1024
  ds_write_b128 v2, v[156:159] offset:2048
  ds_write_b128 v2, v[156:159] offset:3072
  s_mul_i32 s22, s17, 1835008
  s_add_u32 s25, s22, 42205184
  s_lshl_b32 s35, s17, 7
  s_add_u32 s35, s35, 88539136
  s_add_u32 s39, s35, 16384
  s_mov_b32 s38, 0
  v_mov_b32 v63, 0
  v_bfe_u32 v8, v2, 4, 1
  v_mul_u32_u24 v3, 0xaaaa, v8
  v_add_u32 v3, 0x4444, v3
  v_bfe_u32 v9, v2, 5, 3
  v_lshl_add_u32 v8, v8, 3, v9
  v_and_b32 v9, 0x300, v2
  v_lshl_add_u32 v0, v8, 4, v9
  s_lshl_b32 s22, 0, 11
  s_add_u32 s22, s22, 88602624
  v_add_u32 v36, 1024, v2
  v_min_u32 v36, 1776, v36
  s_mov_b32 s30, 0
va_iw4:
  buffer_load_dwordx4 v[40:43], v2, s[8:11], s22 offen sc1
  buffer_load_dwordx4 v[44:47], v36, s[8:11], s22 offen sc1
  s_waitcnt vmcnt(0)
  v_cmp_ne_u64 vcc, s[88:89], v[40:41]
  s_cbranch_vccnz va_iw4_no
  v_cmp_ne_u64 vcc, s[88:89], v[42:43]
  s_cbranch_vccnz va_iw4_no
  v_cmp_ne_u64 vcc, s[88:89], v[44:45]
  s_cbranch_vccnz va_iw4_no
  v_cmp_ne_u64 vcc, s[88:89], v[46:47]
  s_cbranch_vccnz va_iw4_no
  s_branch va_iw4_ok
va_iw4_no:
  s_sleep 2
  s_add_u32 s30, s30, 1
  s_cmp_lt_u32 s30, 50000
  s_cbranch_scc1 va_iw4
  s_branch cA_abort
va_iw4_ok:
  s_mov_b32 s30, 0
  v_mov_b32 v36, 0
ch_md4:
  buffer_load_dword v37, v36, s[12:15], 0 offen sc1
  s_waitcnt vmcnt(0)
  v_readfirstlane_b32 s22, v37
  s_and_b32 s31, s22, 0xffff
  s_cmp_ge_u32 s31, 32
  s_cbranch_scc1 ch_go4
  s_sleep 2
  s_add_u32 s30, s30, 1
  s_cmp_lt_u32 s30, 50000
  s_cbranch_scc1 ch_md4
  s_branch ch_end
ch_go4:
  s_mov_b32 s31, 0
  v_mov_b32 v36, 0
  v_mov_b32 v37, 0
  v_mov_b32 v38, 0
  v_mov_b32 v39, 0
  v_mov_b32 v40, 0
  v_mov_b32 v41, 0
  v_mov_b32 v42, 0
  v_mov_b32 v43, 0
  v_mov_b32 v44, 0
  v_mov_b32 v45, 0
  v_mov_b32 v46, 0
  v_mov_b32 v47, 0
  v_mov_b32 v48, 0
  v_mov_b32 v49, 0
  v_mov_b32 v50, 0
  v_mov_b32 v51, 0
  v_mov_b32 v52, 0
  v_mov_b32 v53, 0
  v_mov_b32 v54, 0
  v_mov_b32 v55, 0
  v_mov_b32 v56, 0
  v_mov_b32 v57, 0
  v_mov_b32 v58, 0
  v_mov_b32 v59, 0
  s_lshr_b32 s22, s22, 16
  s_cmp_lg_u32 s22, 0
  s_cbranch_scc1 cB_va0_loop
  s_branch cA_va0_loop
ch_init5:
  s_mul_i32 s31, s17, 401408
  s_add_u32 s31, s31, 6422528
  s_lshl_b32 s22, s17, 4
  v_mov_b32 v38, s22
  v_mov_b32 v36, v38
  v_med3_u32 v37, v117, 6, 11
  v_lshrrev_b32 v36, 6, v36
  v_lshlrev_b32 v36, 8, v36
  v_lshl_add_u32 v36, v37, 4, v36
  s_mov_b32 s22, 88600576
  s_mov_b32 s30, 0
va_bw_13:
  buffer_load_dwordx4 v[40:43], v36, s[8:11], s22 offen sc1
  s_waitcnt vmcnt(0)
  v_cmp_ne_u64 vcc, s[88:89], v[40:41]
  s_cbranch_vccnz va_bw_13_no
  v_cmp_ne_u64 vcc, s[88:89], v[42:43]
  s_cbranch_vccnz va_bw_13_no
  s_branch va_bw_13_ok
va_bw_13_no:
  s_sleep 2
  s_add_u32 s30, s30, 1
  s_cmp_lt_u32 s30, 50000
  s_cbranch_scc1 va_bw_13
  s_branch cA_abort
va_bw_13_ok:
  s_add_u32 s22, s31, 86016
  buffer_load_dwordx4 a[0:3], v2, s[8:11], s22 offen offset:0 sc1
  buffer_load_dwordx4 a[4:7], v2, s[8:11], s22 offen offset:1024 sc1
  buffer_load_dwordx4 a[8:11], v2, s[8:11], s22 offen offset:2048 sc1
  buffer_load_dwordx4 a[12:15], v2, s[8:11], s22 offen offset:3072 sc1
  s_add_u32 s22, s31, 90112
  buffer_load_dwordx4 a[16:19], v2, s[8:11], s22 offen offset:0 sc1
  buffer_load_dwordx4 a[20:23], v2, s[8:11], s22 offen offset:1024 sc1
  buffer_load_dwordx4 a[24:27], v2, s[8:11], s22 offen offset:2048 sc1
  buffer_load_dwordx4 a[28:31], v2, s[8:11], s22 offen offset:3072 sc1
  s_add_u32 s22, s31, 94208
  buffer_load_dwordx4 a[32:35], v2, s[8:11], s22 offen offset:0 sc1
  buffer_load_dwordx4 a[36:39], v2, s[8:11], s22 offen offset:1024 sc1
  buffer_load_dwordx4 a[40:43], v2, s[8:11], s22 offen offset:2048 sc1
  buffer_load_dwordx4 a[44:47], v2, s[8:11], s22 offen offset:3072 sc1
  s_add_u32 s22, s31, 98304
  buffer_load_dwordx4 a[48:51], v2, s[8:11], s22 offen offset:0 sc1
  buffer_load_dwordx4 a[52:55], v2, s[8:11], s22 offen offset:1024 sc1
  buffer_load_dwordx4 a[56:59], v2, s[8:11], s22 offen offset:2048 sc1
  buffer_load_dwordx4 a[60:63], v2, s[8:11], s22 offen offset:3072 sc1
  s_add_u32 s22, s31, 102400
  buffer_load_dwordx4 a[64:67], v2, s[8:11], s22 offen offset:0 sc1
  buffer_load_dwordx4 a[68:71], v2, s[8:11], s22 offen offset:1024 sc1
  buffer_load_dwordx4 a[72:75], v2, s[8:11], s22 offen offset:2048 sc1
  buffer_load_dwordx4 a[76:79], v2, s[8:11], s22 offen offset:3072 sc1
  s_add_u32 s22, s31, 106496
  buffer_load_dwordx4 a[80:83], v2, s[8:11], s22 offen offset:0 sc1
  buffer_load_dwordx4 a[84:87], v2, s[8:11], s22 offen offset:1024 sc1
  buffer_load_dwordx4 a[88:91], v2, s[8:11], s22 offen offset:2048 sc1
  buffer_load_dwordx4 a[92:95], v2, s[8:11], s22 offen offset:3072 sc1
  s_add_u32 s22, s31, 110592
  buffer_load_dwordx4 a[96:99], v2, s[8:11], s22 offen offset:0 sc1
  buffer_load_dwordx4 a[100:103], v2, s[8:11], s22 offen offset:1024 sc1
  buffer_load_dwordx4 a[104:107], v2, s[8:11], s22 offen offset:2048 sc1
  buffer_load_dwordx4 a[108:111], v2, s[8:11], s22 offen offset:3072 sc1
  s_add_u32 s22, s31, 114688
  buffer_load_dwordx4 a[112:115], v2, s[8:11], s22 offen offset:0 sc1
  buffer_load_dwordx4 a[116:119], v2, s[8:11], s22 offen offset:1024 sc1
  buffer_load_dwordx4 a[120:123], v2, s[8:11], s22 offen offset:2048 sc1
  buffer_load_dwordx4 a[124:127], v2, s[8:11], s22 offen offset:3072 sc1
  s_waitcnt vmcnt(24)
  s_add_u32 s22, s31, 118784
  buffer_load_dwordx4 a[128:131], v2, s[8:11], s22 offen offset:0 sc1
  buffer_load_dwordx4 a[132:135], v2, s[8:11], s22 offen offset:1024 sc1
  buffer_load_dwordx4 a[136:139], v2, s[8:11], s22 offen offset:2048 sc1
  buffer_load_dwordx4 a[140:143], v2, s[8:11], s22 offen offset:3072 sc1
  s_add_u32 s22, s31, 122880
  buffer_load_dwordx4 a[144:147], v2, s[8:11], s22 offen offset:0 sc1
  buffer_load_dwordx4 a[148:151], v2, s[8:11], s22 offen offset:1024 sc1
  buffer_load_dwordx4 a[152:155], v2, s[8:11], s22 offen offset:2048 sc1
  buffer_load_dwordx4 a[156:159], v2, s[8:11], s22 offen offset:3072 sc1
  s_add_u32 s22, s31, 126976
  buffer_load_dwordx4 a[160:163], v2, s[8:11], s22 offen offset:0 sc1
  buffer_load_dwordx4 a[164:167], v2, s[8:11], s22 offen offset:1024 sc1
  buffer_load_dwordx4 a[168:171], v2, s[8:11], s22 offen offset:2048 sc1
  buffer_load_dwordx4 a[172:175], v2, s[8:11], s22 offen offset:3072 sc1
  s_add_u32 s22, s31, 131072
  buffer_load_dwordx4 a[176:179], v2, s[8:11], s22 offen offset:0 sc1
  buffer_load_dwordx4 a[180:183], v2, s[8:11], s22 offen offset:1024 sc1
  buffer_load_dwordx4 a[184:187], v2, s[8:11], s22 offen offset:2048 sc1
  buffer_load_dwordx4 a[188:191], v2, s[8:11], s22 offen offset:3072 sc1
  s_add_u32 s22, s31, 135168
  buffer_load_dwordx4 a[192:195], v2, s[8:11], s22 offen offset:0 sc1
  buffer_load_dwordx4 a[196:199], v2, s[8:11], s22 offen offset:1024 sc1
  buffer_load_dwordx4 a[200:203], v2, s[8:11], s22 offen offset:2048 sc1
  buffer_load_dwordx4 a[204:207], v2, s[8:11], s22 offen offset:3072 sc1
  s_add_u32 s22, s31, 139264
  buffer_load_dwordx4 a[208:211], v2, s[8:11], s22 offen offset:0 sc1
  buffer_load_dwordx4 a[212:215], v2, s[8:11], s22 offen offset:1024 sc1
  buffer_load_dwordx4 a[216:219], v2, s[8:11], s22 offen offset:2048 sc1
  buffer_load_dwordx4 a[220:223], v2, s[8:11], s22 offen offset:3072 sc1
  s_add_u32 s22, s31, 143360
  buffer_load_dwordx4 a[224:227], v2, s[8:11], s22 offen offset:0 sc1
  buffer_load_dwordx4 a[228:231], v2, s[8:11], s22 offen offset:1024 sc1
  buffer_load_dwordx4 a[232:235], v2, s[8:11], s22 offen offset:2048 sc1
  buffer_load_dwordx4 a[236:239], v2, s[8:11], s22 offen offset:3072 sc1
  s_add_u32 s22, s31, 147456
  buffer_load_dwordx4 a[240:243], v2, s[8:11], s22 offen offset:0 sc1
  buffer_load_dwordx4 a[244:247], v2, s[8:11], s22 offen offset:1024 sc1
  buffer_load_dwordx4 a[248:251], v2, s[8:11], s22 offen offset:2048 sc1
  buffer_load_dwordx4 a[252:255], v2, s[8:11], s22 offen offset:3072 sc1
  s_waitcnt vmcnt(24)
  s_add_u32 s22, s31, 151552
  buffer_load_dwordx4 v[176:179], v2, s[8:11], s22 offen offset:0 sc1
  buffer_load_dwordx4 v[180:183], v2, s[8:11], s22 offen offset:1024 sc1
  buffer_load_dwordx4 v[184:187], v2, s[8:11], s22 offen offset:2048 sc1
  buffer_load_dwordx4 v[188:191], v2, s[8:11], s22 offen offset:3072 sc1
  s_add_u32 s22, s31, 155648
  buffer_load_dwordx4 v[192:195], v2, s[8:11], s22 offen offset:0 sc1
  buffer_load_dwordx4 v[196:199], v2, s[8:11], s22 offen offset:1024 sc1
  buffer_load_dwordx4 v[200:203], v2, s[8:11], s22 offen offset:2048 sc1
  buffer_load_dwordx4 v[204:207], v2, s[8:11], s22 offen offset:3072 sc1
  s_add_u32 s22, s31, 159744
  buffer_load_dwordx4 v[208:211], v2, s[8:11], s22 offen offset:0 sc1
  buffer_load_dwordx4 v[212:215], v2, s[8:11], s22 offen offset:1024 sc1
  buffer_load_dwordx4 v[216:219], v2, s[8:11], s22 offen offset:2048 sc1
  buffer_load_dwordx4 v[220:223], v2, s[8:11], s22 offen offset:3072 sc1
  s_add_u32 s22, s31, 163840
  buffer_load_dwordx4 v[224:227], v2, s[8:11], s22 offen offset:0 sc1
  buffer_load_dwordx4 v[228:231], v2, s[8:11], s22 offen offset:1024 sc1
  buffer_load_dwordx4 v[232:235], v2, s[8:11], s22 offen offset:2048 sc1
  buffer_load_dwordx4 v[236:239], v2, s[8:11], s22 offen offset:3072 sc1
  s_add_u32 s22, s31, 167936
  buffer_load_dwordx4 v[240:243], v2, s[8:11], s22 offen offset:0 sc1
  buffer_load_dwordx4 v[244:247], v2, s[8:11], s22 offen offset:1024 sc1
  buffer_load_dwordx4 v[248:251], v2, s[8:11], s22 offen offset:2048 sc1
  buffer_load_dwordx4 v[252:255], v2, s[8:11], s22 offen offset:3072 sc1
  s_lshl_b32 s22, s17, 4
  v_mov_b32 v38, s22
  s_mul_i32 s22, s17, 12
  s_add_u32 s23, s22, 267
  s_add_u32 s22, s22, 256
  v_mov_b32 v36, s23
  v_mov_b32 v37, s22
  v_cmp_eq_u32 vcc, 1, v116
  s_nop 1
  v_cndmask_b32 v36, v36, v37, vcc
  v_med3_u32 v37, v117, 14, 15
  v_lshrrev_b32 v36, 6, v36
  v_lshlrev_b32 v36, 8, v36
  v_lshl_add_u32 v36, v37, 4, v36
  s_mov_b32 s22, 88600576
  s_mov_b32 s30, 0
va_bw_14:
  buffer_load_dwordx4 v[40:43], v36, s[8:11], s22 offen sc1
  s_waitcnt vmcnt(0)
  v_cmp_ne_u64 vcc, s[88:89], v[40:41]
  s_cbranch_vccnz va_bw_14_no
  v_cmp_ne_u64 vcc, s[88:89], v[42:43]
  s_cbranch_vccnz va_bw_14_no
  s_branch va_bw_14_ok
va_bw_14_no:
  s_sleep 2
  s_add_u32 s30, s30, 1
  s_cmp_lt_u32 s30, 50000
  s_cbranch_scc1 va_bw_14
  s_branch cA_abort
va_bw_14_ok:
  s_mov_b32 m0, 59392
  s_add_u32 s22, s31, 387072
  buffer_load_dwordx4 v2, s[8:11], s22 offen offset:0 sc1 lds
  buffer_load_dwordx4 v2, s[8:11], s22 offen offset:1024 sc1 lds
  buffer_load_dwordx4 v2, s[8:11], s22 offen offset:2048 sc1 lds
  buffer_load_dwordx4 v2, s[8:11], s22 offen offset:3072 sc1 lds
  s_mov_b32 m0, 63488
  s_add_u32 s22, s31, 391168
  buffer_load_dwordx4 v2, s[8:11], s22 offen offset:0 sc1 lds
  buffer_load_dwordx4 v2, s[8:11], s22 offen offset:1024 sc1 lds
  buffer_load_dwordx4 v2, s[8:11], s22 offen offset:2048 sc1 lds
  buffer_load_dwordx4 v2, s[8:11], s22 offen offset:3072 sc1 lds
  s_mov_b32 m0, 67584
  s_add_u32 s22, s31, 395264
  buffer_load_dwordx4 v2, s[8:11], s22 offen offset:0 sc1 lds
  buffer_load_dwordx4 v2, s[8:11], s22 offen offset:1024 sc1 lds
  buffer_load_dwordx4 v2, s[8:11], s22 offen offset:2048 sc1 lds
  buffer_load_dwordx4 v2, s[8:11], s22 offen offset:3072 sc1 lds
  s_mov_b32 m0, 71680
  s_add_u32 s22, s31, 399360
  buffer_load_dwordx4 v2, s[8:11], s22 offen offset:0 sc1 lds
  buffer_load_dwordx4 v2, s[8:11], s22 offen offset:1024 sc1 lds
  v_mov_b32 v72, v116
  v_mov_b32 v73, v117
  v_lshrrev_b32 v65, 1, v72
  v_and_b32 v66, 1, v72
  v_mov_b32 v68, 6
  v_mov_b32 v69, v73
  v_mov_b32 v70, 0
  v_and_b32 v71, 1, v69
  v_lshrrev_b32 v69, 1, v69
  v_lshl_add_u32 v69, v71, 3, v69
  v_lshlrev_b32 v71, 12, v70
  v_lshrrev_b32 v70, 1, v68
  v_lshl_add_u32 v71, v70, 9, v71
  v_and_b32 v70, 1, v68
  v_lshl_add_u32 v71, v70, 2, v71
  v_lshl_add_u32 v71, v69, 4, v71
  v_lshl_add_u32 v71, v65, 8, v71
  v_lshl_add_u32 v60, v66, 3, v71
  v_mov_b32 v68, 7
  v_mov_b32 v69, v73
  v_mov_b32 v70, 0
  v_and_b32 v71, 1, v69
  v_lshrrev_b32 v69, 1, v69
  v_lshl_add_u32 v69, v71, 3, v69
  v_lshlrev_b32 v71, 12, v70
  v_lshrrev_b32 v70, 1, v68
  v_lshl_add_u32 v71, v70, 9, v71
  v_and_b32 v70, 1, v68
  v_lshl_add_u32 v71, v70, 2, v71
  v_lshl_add_u32 v71, v69, 4, v71
  v_lshl_add_u32 v71, v65, 8, v71
  v_lshl_add_u32 v61, v66, 3, v71
  v_mov_b32 v68, 8
  v_mov_b32 v69, v73
  v_mov_b32 v70, 0
  v_and_b32 v71, 1, v69
  v_lshrrev_b32 v69, 1, v69
  v_lshl_add_u32 v69, v71, 3, v69
  v_lshlrev_b32 v71, 12, v70
  v_lshrrev_b32 v70, 1, v68
  v_lshl_add_u32 v71, v70, 9, v71
  v_and_b32 v70, 1, v68
  v_lshl_add_u32 v71, v70, 2, v71
  v_lshl_add_u32 v71, v69, 4, v71
  v_lshl_add_u32 v71, v65, 8, v71
  v_lshl_add_u32 v62, v66, 3, v71
  v_mov_b32 v68, 9
  v_mov_b32 v69, v73
  v_mov_b32 v70, 0
  v_and_b32 v71, 1, v69
  v_lshrrev_b32 v69, 1, v69
  v_lshl_add_u32 v69, v71, 3, v69
  v_lshlrev_b32 v71, 12, v70
  v_lshrrev_b32 v70, 1, v68
  v_lshl_add_u32 v71, v70, 9, v71
  v_and_b32 v70, 1, v68
  v_lshl_add_u32 v71, v70, 2, v71
  v_lshl_add_u32 v71, v69, 4, v71
  v_lshl_add_u32 v71, v65, 8, v71
  v_lshl_add_u32 v170, v66, 3, v71
  v_mov_b32 v68, 10
  v_mov_b32 v69, v73
  v_mov_b32 v70, 0
  v_and_b32 v71, 1, v69
  v_lshrrev_b32 v69, 1, v69
  v_lshl_add_u32 v69, v71, 3, v69
  v_lshlrev_b32 v71, 12, v70
  v_lshrrev_b32 v70, 1, v68
  v_lshl_add_u32 v71, v70, 9, v71
  v_and_b32 v70, 1, v68
  v_lshl_add_u32 v71, v70, 2, v71
  v_lshl_add_u32 v71, v69, 4, v71
  v_lshl_add_u32 v71, v65, 8, v71
  v_lshl_add_u32 v171, v66, 3, v71
  v_mov_b32 v68, 11
  v_mov_b32 v69, v73
  v_mov_b32 v70, 0
  v_and_b32 v71, 1, v69
  v_lshrrev_b32 v69, 1, v69
  v_lshl_add_u32 v69, v71, 3, v69
  v_lshlrev_b32 v71, 12, v70
  v_lshrrev_b32 v70, 1, v68
  v_lshl_add_u32 v71, v70, 9, v71
  v_and_b32 v70, 1, v68
  v_lshl_add_u32 v71, v70, 2, v71
  v_lshl_add_u32 v71, v69, 4, v71
  v_lshl_add_u32 v71, v65, 8, v71
  v_lshl_add_u32 v172, v66, 3, v71
  v_and_b32 v0, 31, v1
  v_lshlrev_b32 v0, 2, v0
  v_add_u32 v0, 18432, v0
  v_min_u32 v4, 15, v73
  v_lshlrev_b32 v4, 2, v4
  s_and_b32 s22, s17, 3
  s_lshl_b32 s22, s22, 7
  s_add_u32 s22, s22, 17408
  v_add_u32 v4, s22, v4
  v_and_b32 v64, 7, v73
  v_lshlrev_b32 v5, 4, v64
  v_lshl_add_u32 v5, v72, 7, v5
  v_lshrrev_b32 v65, 3, v73
  v_lshl_add_u32 v5, v65, 9, v5
  s_lshl_b32 s22, s17, 3
  s_add_u32 s22, s22, 17924
  v_mov_b32 v7, s22
  v_add_u32 v65, 16, v73
  v_min_u32 v65, 27, v65
  v_mad_u32_u24 v65, v72, 28, v65
  v_lshlrev_b32 v6, 4, v65
  s_lshr_b32 s22, s17, 1
  s_mul_i32 s22, s22, 7
  s_and_b32 s34, s17, 1
  s_lshl_b32 s35, s34, 2
  v_add_u32 v70, s35, v72
  v_mov_b32 v71, s34
  v_mov_b32 v69, 1
  v_cmp_eq_u32 vcc, 3, v72
  s_nop 1
  v_cndmask_b32 v70, v70, v72, vcc
  v_cndmask_b32 v69, v69, v71, vcc
  v_add_u32 v70, s22, v70
  v_lshrrev_b32 v68, 1, v70
  v_lshlrev_b32 v68, 8, v68
  v_lshl_add_u32 v68, v69, 7, v68
  v_and_b32 v69, 1, v70
  v_lshl_add_u32 v68, v69, 3, v68
  v_lshl_add_u32 v1, v64, 4, v68
  v_cmp_gt_u32 s[26:27], 8, v73
  v_cmp_gt_u32 vcc, 3, v72
  s_and_b64 s[26:27], s[26:27], vcc
  v_lshrrev_b32 v65, 3, v73
  v_min_u32 v66, 5, v64
  v_lshl_add_u32 v66, v66, 1, v65
  v_mad_u32_u24 v66, v72, 12, v66
  v_lshlrev_b32 v66, 4, v66
  v_add_u32 v6, 1024, v66
  s_mul_i32 s22, s17, 12
  s_add_u32 s22, s22, 256
  v_lshl_add_u32 v70, v64, 1, s22
  v_lshrrev_b32 v68, 4, v70
  v_lshlrev_b32 v68, 8, v68
  v_bfe_u32 v69, v70, 1, 1
  v_lshl_add_u32 v68, v69, 7, v68
  v_bfe_u32 v69, v70, 2, 2
  v_lshl_add_u32 v68, v69, 2, v68
  v_and_b32 v69, 1, v72
  v_lshl_add_u32 v65, v69, 2, v65
  v_lshrrev_b32 v69, 1, v72
  v_lshl_add_u32 v65, v69, 1, v65
  v_lshrrev_b32 v65, 3, v73
  v_lshl_add_u32 v65, v72, 1, v65
  v_lshrrev_b32 v5, 1, v72
  v_lshlrev_b32 v5, 9, v5
  v_lshrrev_b32 v69, 2, v73
  v_lshl_add_u32 v5, v69, 7, v5
  v_and_b32 v69, 1, v72
  v_lshl_add_u32 v5, v69, 6, v5
  v_and_b32 v69, 3, v73
  v_lshl_add_u32 v5, v69, 4, v5
  v_and_b32 v69, 1, v73
  v_mul_u32_u24 v69, 0xaaaa, v69
  v_add_u32 v0, 0x4444, v69
  v_lshl_add_u32 v1, v65, 4, v68
  v_cmp_gt_u32 s[26:27], 6, v64
  v_mov_b32 v156, 0
  v_mov_b32 v157, 0
  v_mov_b32 v158, 0
  v_mov_b32 v159, 0
  ds_write_b128 v2, v[156:159] offset:4096
  ds_write_b128 v2, v[156:159] offset:5120
  ds_write_b128 v2, v[156:159] offset:6144
  ds_write_b128 v2, v[156:159] offset:7168
  s_mul_i32 s22, s17, 1835008
  s_add_u32 s25, s22, 42205184
  s_lshl_b32 s35, s17, 7
  s_add_u32 s35, s35, 88539136
  s_add_u32 s39, s35, 16384
  s_mov_b32 s38, 0
  v_mov_b32 v63, 0
  v_bfe_u32 v8, v2, 4, 1
  v_mul_u32_u24 v3, 0xaaaa, v8
  v_add_u32 v3, 0x4444, v3
  v_bfe_u32 v9, v2, 5, 3
  v_lshl_add_u32 v8, v8, 3, v9
  v_and_b32 v9, 0x300, v2
  v_lshl_add_u32 v0, v8, 4, v9
  s_lshl_b32 s22, 0, 11
  s_add_u32 s22, s22, 88602624
  v_add_u32 v36, 1024, v2
  v_min_u32 v36, 1776, v36
  s_mov_b32 s30, 0
va_iw5:
  buffer_load_dwordx4 v[40:43], v2, s[8:11], s22 offen sc1
  buffer_load_dwordx4 v[44:47], v36, s[8:11], s22 offen sc1
  s_waitcnt vmcnt(0)
  v_cmp_ne_u64 vcc, s[88:89], v[40:41]
  s_cbranch_vccnz va_iw5_no
  v_cmp_ne_u64 vcc, s[88:89], v[42:43]
  s_cbranch_vccnz va_iw5_no
  v_cmp_ne_u64 vcc, s[88:89], v[44:45]
  s_cbranch_vccnz va_iw5_no
  v_cmp_ne_u64 vcc, s[88:89], v[46:47]
  s_cbranch_vccnz va_iw5_no
  s_branch va_iw5_ok
va_iw5_no:
  s_sleep 2
  s_add_u32 s30, s30, 1
  s_cmp_lt_u32 s30, 50000
  s_cbranch_scc1 va_iw5
  s_branch cA_abort
va_iw5_ok:
  s_mov_b32 s30, 0
  v_mov_b32 v36, 0
ch_md5:
  buffer_load_dword v37, v36, s[12:15], 0 offen sc1
  s_waitcnt vmcnt(0)
  v_readfirstlane_b32 s22, v37
  s_and_b32 s31, s22, 0xffff
  s_cmp_ge_u32 s31, 32
  s_cbranch_scc1 ch_go5
  s_sleep 2
  s_add_u32 s30, s30, 1
  s_cmp_lt_u32 s30, 50000
  s_cbranch_scc1 ch_md5
  s_branch ch_end
ch_go5:
  s_mov_b32 s31, 0
  v_mov_b32 v36, 0
  v_mov_b32 v37, 0
  v_mov_b32 v38, 0
  v_mov_b32 v39, 0
  v_mov_b32 v40, 0
  v_mov_b32 v41, 0
  v_mov_b32 v42, 0
  v_mov_b32 v43, 0
  v_mov_b32 v44, 0
  v_mov_b32 v45, 0
  v_mov_b32 v46, 0
  v_mov_b32 v47, 0
  v_mov_b32 v48, 0
  v_mov_b32 v49, 0
  v_mov_b32 v50, 0
  v_mov_b32 v51, 0
  v_mov_b32 v52, 0
  v_mov_b32 v53, 0
  v_mov_b32 v54, 0
  v_mov_b32 v55, 0
  v_mov_b32 v56, 0
  v_mov_b32 v57, 0
  v_mov_b32 v58, 0
  v_mov_b32 v59, 0
  s_lshr_b32 s22, s22, 16
  s_cmp_lg_u32 s22, 0
  s_cbranch_scc1 cB_va1_loop
  s_branch cA_va1_loop
ch_init6:
  s_mul_i32 s31, s17, 401408
  s_add_u32 s31, s31, 6422528
  s_lshl_b32 s22, s17, 4
  v_mov_b32 v38, s22
  s_mul_i32 s22, s17, 12
  s_add_u32 s23, s22, 267
  s_add_u32 s22, s22, 256
  v_mov_b32 v36, s23
  v_mov_b32 v37, s22
  v_cmp_eq_u32 vcc, 1, v116
  s_nop 1
  v_cndmask_b32 v36, v36, v37, vcc
  v_med3_u32 v37, v117, 0, 3
  v_med3_u32 v39, v117, 12, 15
  v_cmp_eq_u32 vcc, 0, v116
  s_nop 1
  v_cndmask_b32 v36, v36, v38, vcc
  v_cndmask_b32 v37, v37, v39, vcc
  v_lshrrev_b32 v36, 6, v36
  v_lshlrev_b32 v36, 8, v36
  v_lshl_add_u32 v36, v37, 4, v36
  s_mov_b32 s22, 88600576
  s_mov_b32 s30, 0
va_bw_15:
  buffer_load_dwordx4 v[40:43], v36, s[8:11], s22 offen sc1
  s_waitcnt vmcnt(0)
  v_cmp_ne_u64 vcc, s[88:89], v[40:41]
  s_cbranch_vccnz va_bw_15_no
  v_cmp_ne_u64 vcc, s[88:89], v[42:43]
  s_cbranch_vccnz va_bw_15_no
  s_branch va_bw_15_ok
va_bw_15_no:
  s_sleep 2
  s_add_u32 s30, s30, 1
  s_cmp_lt_u32 s30, 50000
  s_cbranch_scc1 va_bw_15
  s_branch cA_abort
va_bw_15_ok:
  s_add_u32 s22, s31, 172032
  buffer_load_dwordx4 a[0:3], v2, s[8:11], s22 offen offset:0 sc1
  buffer_load_dwordx4 a[4:7], v2, s[8:11], s22 offen offset:1024 sc1
  buffer_load_dwordx4 a[8:11], v2, s[8:11], s22 offen offset:2048 sc1
  buffer_load_dwordx4 a[12:15], v2, s[8:11], s22 offen offset:3072 sc1
  s_add_u32 s22, s31, 176128
  buffer_load_dwordx4 a[16:19], v2, s[8:11], s22 offen offset:0 sc1
  buffer_load_dwordx4 a[20:23], v2, s[8:11], s22 offen offset:1024 sc1
  buffer_load_dwordx4 a[24:27], v2, s[8:11], s22 offen offset:2048 sc1
  buffer_load_dwordx4 a[28:31], v2, s[8:11], s22 offen offset:3072 sc1
  s_add_u32 s22, s31, 180224
  buffer_load_dwordx4 a[32:35], v2, s[8:11], s22 offen offset:0 sc1
  buffer_load_dwordx4 a[36:39], v2, s[8:11], s22 offen offset:1024 sc1
  buffer_load_dwordx4 a[40:43], v2, s[8:11], s22 offen offset:2048 sc1
  buffer_load_dwordx4 a[44:47], v2, s[8:11], s22 offen offset:3072 sc1
  s_add_u32 s22, s31, 184320
  buffer_load_dwordx4 a[48:51], v2, s[8:11], s22 offen offset:0 sc1
  buffer_load_dwordx4 a[52:55], v2, s[8:11], s22 offen offset:1024 sc1
  buffer_load_dwordx4 a[56:59], v2, s[8:11], s22 offen offset:2048 sc1
  buffer_load_dwordx4 a[60:63], v2, s[8:11], s22 offen offset:3072 sc1
  s_add_u32 s22, s31, 188416
  buffer_load_dwordx4 a[64:67], v2, s[8:11], s22 offen offset:0 sc1
  buffer_load_dwordx4 a[68:71], v2, s[8:11], s22 offen offset:1024 sc1
  buffer_load_dwordx4 a[72:75], v2, s[8:11], s22 offen offset:2048 sc1
  buffer_load_dwordx4 a[76:79], v2, s[8:11], s22 offen offset:3072 sc1
  s_add_u32 s22, s31, 192512
  buffer_load_dwordx4 a[80:83], v2, s[8:11], s22 offen offset:0 sc1
  buffer_load_dwordx4 a[84:87], v2, s[8:11], s22 offen offset:1024 sc1
  buffer_load_dwordx4 a[88:91], v2, s[8:11], s22 offen offset:2048 sc1
  buffer_load_dwordx4 a[92:95], v2, s[8:11], s22 offen offset:3072 sc1
  s_add_u32 s22, s31, 196608
  buffer_load_dwordx4 a[96:99], v2, s[8:11], s22 offen offset:0 sc1
  buffer_load_dwordx4 a[100:103], v2, s[8:11], s22 offen offset:1024 sc1
  buffer_load_dwordx4 a[104:107], v2, s[8:11], s22 offen offset:2048 sc1
  buffer_load_dwordx4 a[108:111], v2, s[8:11], s22 offen offset:3072 sc1
  s_add_u32 s22, s31, 200704
  buffer_load_dwordx4 a[112:115], v2, s[8:11], s22 offen offset:0 sc1
  buffer_load_dwordx4 a[116:119], v2, s[8:11], s22 offen offset:1024 sc1
  buffer_load_dwordx4 a[120:123], v2, s[8:11], s22 offen offset:2048 sc1
  buffer_load_dwordx4 a[124:127], v2, s[8:11], s22 offen offset:3072 sc1
  s_waitcnt vmcnt(24)
  s_add_u32 s22, s31, 204800
  buffer_load_dwordx4 a[128:131], v2, s[8:11], s22 offen offset:0 sc1
  buffer_load_dwordx4 a[132:135], v2, s[8:11], s22 offen offset:1024 sc1
  buffer_load_dwordx4 a[136:139], v2, s[8:11], s22 offen offset:2048 sc1
  buffer_load_dwordx4 a[140:143], v2, s[8:11], s22 offen offset:3072 sc1
  s_add_u32 s22, s31, 208896
  buffer_load_dwordx4 a[144:147], v2, s[8:11], s22 offen offset:0 sc1
  buffer_load_dwordx4 a[148:151], v2, s[8:11], s22 offen offset:1024 sc1
  buffer_load_dwordx4 a[152:155], v2, s[8:11], s22 offen offset:2048 sc1
  buffer_load_dwordx4 a[156:159], v2, s[8:11], s22 offen offset:3072 sc1
  s_add_u32 s22, s31, 212992
  buffer_load_dwordx4 a[160:163], v2, s[8:11], s22 offen offset:0 sc1
  buffer_load_dwordx4 a[164:167], v2, s[8:11], s22 offen offset:1024 sc1
  buffer_load_dwordx4 a[168:171], v2, s[8:11], s22 offen offset:2048 sc1
  buffer_load_dwordx4 a[172:175], v2, s[8:11], s22 offen offset:3072 sc1
  s_add_u32 s22, s31, 217088
  buffer_load_dwordx4 a[176:179], v2, s[8:11], s22 offen offset:0 sc1
  buffer_load_dwordx4 a[180:183], v2, s[8:11], s22 offen offset:1024 sc1
  buffer_load_dwordx4 a[184:187], v2, s[8:11], s22 offen offset:2048 sc1
  buffer_load_dwordx4 a[188:191], v2, s[8:11], s22 offen offset:3072 sc1
  s_add_u32 s22, s31, 221184
  buffer_load_dwordx4 a[192:195], v2, s[8:11], s22 offen offset:0 sc1
  buffer_load_dwordx4 a[196:199], v2, s[8:11], s22 offen offset:1024 sc1
  buffer_load_dwordx4 a[200:203], v2, s[8:11], s22 offen offset:2048 sc1
  buffer_load_dwordx4 a[204:207], v2, s[8:11], s22 offen offset:3072 sc1
  s_add_u32 s22, s31, 225280
  buffer_load_dwordx4 a[208:211], v2, s[8:11], s22 offen offset:0 sc1
  buffer_load_dwordx4 a[212:215], v2, s[8:11], s22 offen offset:1024 sc1
  buffer_load_dwordx4 a[216:219], v2, s[8:11], s22 offen offset:2048 sc1
  buffer_load_dwordx4 a[220:223], v2, s[8:11], s22 offen offset:3072 sc1
  s_add_u32 s22, s31, 229376
  buffer_load_dwordx4 a[224:227], v2, s[8:11], s22 offen offset:0 sc1
  buffer_load_dwordx4 a[228:231], v2, s[8:11], s22 offen offset:1024 sc1
  buffer_load_dwordx4 a[232:235], v2, s[8:11], s22 offen offset:2048 sc1
  buffer_load_dwordx4 a[236:239], v2, s[8:11], s22 offen offset:3072 sc1
  s_add_u32 s22, s31, 233472
  buffer_load_dwordx4 a[240:243], v2, s[8:11], s22 offen offset:0 sc1
  buffer_load_dwordx4 a[244:247], v2, s[8:11], s22 offen offset:1024 sc1
  buffer_load_dwordx4 a[248:251], v2, s[8:11], s22 offen offset:2048 sc1
  buffer_load_dwordx4 a[252:255], v2, s[8:11], s22 offen offset:3072 sc1
  s_waitcnt vmcnt(24)
  s_add_u32 s22, s31, 237568
  buffer_load_dwordx4 v[120:123], v2, s[8:11], s22 offen offset:0 sc1
  buffer_load_dwordx4 v[124:127], v2, s[8:11], s22 offen offset:1024 sc1
  buffer_load_dwordx4 v[128:131], v2, s[8:11], s22 offen offset:2048 sc1
  buffer_load_dwordx4 v[132:135], v2, s[8:11], s22 offen offset:3072 sc1
  s_add_u32 s22, s31, 241664
  buffer_load_dwordx4 v[136:139], v2, s[8:11], s22 offen offset:0 sc1
  buffer_load_dwordx4 v[140:143], v2, s[8:11], s22 offen offset:1024 sc1
  buffer_load_dwordx4 v[144:147], v2, s[8:11], s22 offen offset:2048 sc1
  buffer_load_dwordx4 v[148:151], v2, s[8:11], s22 offen offset:3072 sc1
  s_add_u32 s22, s31, 245760
  buffer_load_dwordx4 v[152:155], v2, s[8:11], s22 offen offset:0 sc1
  buffer_load_dwordx4 v[156:159], v2, s[8:11], s22 offen offset:1024 sc1
  buffer_load_dwordx4 v[160:163], v2, s[8:11], s22 offen offset:2048 sc1
  buffer_load_dwordx4 v[164:167], v2, s[8:11], s22 offen offset:3072 sc1
  s_add_u32 s22, s31, 249856
  buffer_load_dwordx4 v[168:171], v2, s[8:11], s22 offen offset:0 sc1
  buffer_load_dwordx4 v[172:175], v2, s[8:11], s22 offen offset:1024 sc1
  buffer_load_dwordx4 v[176:179], v2, s[8:11], s22 offen offset:2048 sc1
  buffer_load_dwordx4 v[180:183], v2, s[8:11], s22 offen offset:3072 sc1
  s_add_u32 s22, s31, 253952
  buffer_load_dwordx4 v[184:187], v2, s[8:11], s22 offen offset:0 sc1
  buffer_load_dwordx4 v[188:191], v2, s[8:11], s22 offen offset:1024 sc1
  buffer_load_dwordx4 v[192:195], v2, s[8:11], s22 offen offset:2048 sc1
  buffer_load_dwordx4 v[196:199], v2, s[8:11], s22 offen offset:3072 sc1
  s_add_u32 s22, s31, 258048
  buffer_load_dwordx4 v[200:203], v2, s[8:11], s22 offen offset:0 sc1
  buffer_load_dwordx4 v[204:207], v2, s[8:11], s22 offen offset:1024 sc1
  buffer_load_dwordx4 v[208:211], v2, s[8:11], s22 offen offset:2048 sc1
  buffer_load_dwordx4 v[212:215], v2, s[8:11], s22 offen offset:3072 sc1
  s_add_u32 s22, s31, 262144
  buffer_load_dwordx4 v[216:219], v2, s[8:11], s22 offen offset:0 sc1
  buffer_load_dwordx4 v[220:223], v2, s[8:11], s22 offen offset:1024 sc1
  buffer_load_dwordx4 v[224:227], v2, s[8:11], s22 offen offset:2048 sc1
  buffer_load_dwordx4 v[228:231], v2, s[8:11], s22 offen offset:3072 sc1
  s_add_u32 s22, s31, 266240
  buffer_load_dwordx4 v[232:235], v2, s[8:11], s22 offen offset:0 sc1
  buffer_load_dwordx4 v[236:239], v2, s[8:11], s22 offen offset:1024 sc1
  buffer_load_dwordx4 v[240:243], v2, s[8:11], s22 offen offset:2048 sc1
  buffer_load_dwordx4 v[244:247], v2, s[8:11], s22 offen offset:3072 sc1
  s_waitcnt vmcnt(24)
  s_add_u32 s22, s31, 270336
  buffer_load_dwordx4 v[248:251], v2, s[8:11], s22 offen offset:0 sc1
  buffer_load_dwordx4 v[252:255], v2, s[8:11], s22 offen offset:1024 sc1
  v_mov_b32 v72, v116
  v_mov_b32 v73, v117
  v_lshrrev_b32 v65, 1, v72
  v_and_b32 v66, 1, v72
  v_mov_b32 v68, 12
  v_mov_b32 v69, v73
  v_mov_b32 v70, 0
  v_and_b32 v71, 1, v69
  v_lshrrev_b32 v69, 1, v69
  v_lshl_add_u32 v69, v71, 3, v69
  v_lshlrev_b32 v71, 12, v70
  v_lshrrev_b32 v70, 1, v68
  v_lshl_add_u32 v71, v70, 9, v71
  v_and_b32 v70, 1, v68
  v_lshl_add_u32 v71, v70, 2, v71
  v_lshl_add_u32 v71, v69, 4, v71
  v_lshl_add_u32 v71, v65, 8, v71
  v_lshl_add_u32 v100, v66, 3, v71
  v_mov_b32 v68, 13
  v_mov_b32 v69, v73
  v_mov_b32 v70, 0
  v_and_b32 v71, 1, v69
  v_lshrrev_b32 v69, 1, v69
  v_lshl_add_u32 v69, v71, 3, v69
  v_lshlrev_b32 v71, 12, v70
  v_lshrrev_b32 v70, 1, v68
  v_lshl_add_u32 v71, v70, 9, v71
  v_and_b32 v70, 1, v68
  v_lshl_add_u32 v71, v70, 2, v71
  v_lshl_add_u32 v71, v69, 4, v71
  v_lshl_add_u32 v71, v65, 8, v71
  v_lshl_add_u32 v101, v66, 3, v71
  v_mov_b32 v68, 14
  v_mov_b32 v69, v73
  v_mov_b32 v70, 0
  v_and_b32 v71, 1, v69
  v_lshrrev_b32 v69, 1, v69
  v_lshl_add_u32 v69, v71, 3, v69
  v_lshlrev_b32 v71, 12, v70
  v_lshrrev_b32 v70, 1, v68
  v_lshl_add_u32 v71, v70, 9, v71
  v_and_b32 v70, 1, v68
  v_lshl_add_u32 v71, v70, 2, v71
  v_lshl_add_u32 v71, v69, 4, v71
  v_lshl_add_u32 v71, v65, 8, v71
  v_lshl_add_u32 v102, v66, 3, v71
  v_mov_b32 v68, 15
  v_mov_b32 v69, v73
  v_mov_b32 v70, 0
  v_and_b32 v71, 1, v69
  v_lshrrev_b32 v69, 1, v69
  v_lshl_add_u32 v69, v71, 3, v69
  v_lshlrev_b32 v71, 12, v70
  v_lshrrev_b32 v70, 1, v68
  v_lshl_add_u32 v71, v70, 9, v71
  v_and_b32 v70, 1, v68
  v_lshl_add_u32 v71, v70, 2, v71
  v_lshl_add_u32 v71, v69, 4, v71
  v_lshl_add_u32 v71, v65, 8, v71
  v_lshl_add_u32 v103, v66, 3, v71
  v_add_u32 v67, 0, v73
  v_mul_u32_u24 v68, 5462, v67
  v_lshrrev_b32 v68, 16, v68
  v_mul_u32_u24 v69, 12, v68
  v_sub_u32 v69, v67, v69
  v_mov_b32 v70, 1
  v_and_b32 v71, 1, v69
  v_lshrrev_b32 v69, 1, v69
  v_lshl_add_u32 v69, v71, 3, v69
  v_lshlrev_b32 v71, 12, v70
  v_lshrrev_b32 v70, 1, v68
  v_lshl_add_u32 v71, v70, 9, v71
  v_and_b32 v70, 1, v68
  v_lshl_add_u32 v71, v70, 2, v71
  v_lshl_add_u32 v71, v69, 4, v71
  v_lshl_add_u32 v71, v65, 8, v71
  v_lshl_add_u32 v104, v66, 3, v71
  v_add_u32 v67, 16, v73
  v_mul_u32_u24 v68, 5462, v67
  v_lshrrev_b32 v68, 16, v68
  v_mul_u32_u24 v69, 12, v68
  v_sub_u32 v69, v67, v69
  v_mov_b32 v70, 1
  v_and_b32 v71, 1, v69
  v_lshrrev_b32 v69, 1, v69
  v_lshl_add_u32 v69, v71, 3, v69
  v_lshlrev_b32 v71, 12, v70
  v_lshrrev_b32 v70, 1, v68
  v_lshl_add_u32 v71, v70, 9, v71
  v_and_b32 v70, 1, v68
  v_lshl_add_u32 v71, v70, 2, v71
  v_lshl_add_u32 v71, v69, 4, v71
  v_lshl_add_u32 v71, v65, 8, v71
  v_lshl_add_u32 v105, v66, 3, v71
  v_add_u32 v67, 32, v73
  v_mul_u32_u24 v68, 5462, v67
  v_lshrrev_b32 v68, 16, v68
  v_mul_u32_u24 v69, 12, v68
  v_sub_u32 v69, v67, v69
  v_mov_b32 v70, 1
  v_and_b32 v71, 1, v69
  v_lshrrev_b32 v69, 1, v69
  v_lshl_add_u32 v69, v71, 3, v69
  v_lshlrev_b32 v71, 12, v70
  v_lshrrev_b32 v70, 1, v68
  v_lshl_add_u32 v71, v70, 9, v71
  v_and_b32 v70, 1, v68
  v_lshl_add_u32 v71, v70, 2, v71
  v_lshl_add_u32 v71, v69, 4, v71
  v_lshl_add_u32 v71, v65, 8, v71
  v_lshl_add_u32 v106, v66, 3, v71
  v_add_u32 v67, 48, v73
  v_mul_u32_u24 v68, 5462, v67
  v_lshrrev_b32 v68, 16, v68
  v_mul_u32_u24 v69, 12, v68
  v_sub_u32 v69, v67, v69
  v_mov_b32 v70, 1
  v_and_b32 v71, 1, v69
  v_lshrrev_b32 v69, 1, v69
  v_lshl_add_u32 v69, v71, 3, v69
  v_lshlrev_b32 v71, 12, v70
  v_lshrrev_b32 v70, 1, v68
  v_lshl_add_u32 v71, v70, 9, v71
  v_and_b32 v70, 1, v68
  v_lshl_add_u32 v71, v70, 2, v71
  v_lshl_add_u32 v71, v69, 4, v71
  v_lshl_add_u32 v71, v65, 8, v71
  v_lshl_add_u32 v107, v66, 3, v71
  s_mul_i32 s24, s17, 532480
  s_add_u32 s24, s24, 76939264
  s_mul_i32 s34, s17, 640
  s_add_u32 s34, s34, 88582144
  s_mul_i32 s36, s17, 448
  v_add_u32 v0, s36, v2
  v_add_u32 v0, 8192, v0
  s_add_u32 s36, s36, 88080384
  s_mov_b32 s37, 76939264
  v_cmp_gt_u32 s[26:27], 28, v1
  v_and_b32 v119, 31, v1
  v_lshlrev_b32 v119, 2, v119
  v_and_b32 v119, 0x78, v119
  v_or_b32 v119, 0, v119
  s_add_u32 s22, s17, 16
  s_and_b32 s22, s22, 15
  s_lshl_b32 s22, s22, 7
  s_add_u32 s22, s22, 18432
  v_add_u32 v119, s22, v119
  v_min_u32 v118, 9, v1
  s_mul_i32 s22, s17, 10
  v_add_u32 v118, s22, v118
  v_lshlrev_b32 v118, 7, v118
  v_add_u32 v118, 40960, v118
  s_mov_b32 s39, 71565312
  v_add_u32 v1, 16384, v2
  v_mov_b32 v117, 1
  s_mul_i32 s38, s17, 1104
  s_add_u32 s38, s38, 20480
  v_bfe_u32 v8, v2, 4, 1
  v_mul_u32_u24 v3, 0xaaaa, v8
  v_add_u32 v3, 0x4444, v3
  v_bfe_u32 v9, v2, 5, 3
  v_lshl_add_u32 v8, v8, 3, v9
  v_and_b32 v9, 0x300, v2
  v_lshl_add_u32 v5, v8, 4, v9
  s_lshl_b32 s22, 0, 11
  s_add_u32 s22, s22, 88602624
  v_add_u32 v36, 1024, v2
  v_min_u32 v36, 1776, v36
  s_mov_b32 s30, 0
va_iw6:
  buffer_load_dwordx4 v[40:43], v2, s[8:11], s22 offen sc1
  buffer_load_dwordx4 v[44:47], v36, s[8:11], s22 offen sc1
  s_waitcnt vmcnt(0)
  v_cmp_ne_u64 vcc, s[88:89], v[40:41]
  s_cbranch_vccnz va_iw6_no
  v_cmp_ne_u64 vcc, s[88:89], v[42:43]
  s_cbranch_vccnz va_iw6_no
  v_cmp_ne_u64 vcc, s[88:89], v[44:45]
  s_cbranch_vccnz va_iw6_no
  v_cmp_ne_u64 vcc, s[88:89], v[46:47]
  s_cbranch_vccnz va_iw6_no
  s_branch va_iw6_ok
va_iw6_no:
  s_sleep 2
  s_add_u32 s30, s30, 1
  s_cmp_lt_u32 s30, 50000
  s_cbranch_scc1 va_iw6
  s_branch cA_abort
va_iw6_ok:
  s_mov_b32 s30, 0
  v_mov_b32 v36, 0
ch_md6:
  buffer_load_dword v37, v36, s[12:15], 0 offen sc1
  s_waitcnt vmcnt(0)
  v_readfirstlane_b32 s22, v37
  s_and_b32 s31, s22, 0xffff
  s_cmp_ge_u32 s31, 32
  s_cbranch_scc1 ch_go6
  s_sleep 2
  s_add_u32 s30, s30, 1
  s_cmp_lt_u32 s30, 50000
  s_cbranch_scc1 ch_md6
  s_branch ch_end
ch_go6:
  s_mov_b32 s31, 0
  s_lshr_b32 s22, s22, 16
  s_cmp_lg_u32 s22, 0
  s_cbranch_scc1 cB_va2_loop
  s_branch cA_va2_loop
ch_init7:
  s_mul_i32 s31, s17, 401408
  s_add_u32 s31, s31, 6422528
  s_lshl_b32 s22, s17, 4
  v_mov_b32 v38, s22
  s_mul_i32 s22, s17, 12
  s_add_u32 s23, s22, 267
  s_add_u32 s22, s22, 256
  v_mov_b32 v36, s23
  v_mov_b32 v37, s22
  v_cmp_eq_u32 vcc, 1, v116
  s_nop 1
  v_cndmask_b32 v36, v36, v37, vcc
  v_med3_u32 v37, v117, 5, 14
  v_lshrrev_b32 v36, 6, v36
  v_lshlrev_b32 v36, 8, v36
  v_lshl_add_u32 v36, v37, 4, v36
  s_mov_b32 s22, 88600576
  s_mov_b32 s30, 0
va_bw_16:
  buffer_load_dwordx4 v[40:43], v36, s[8:11], s22 offen sc1
  s_waitcnt vmcnt(0)
  v_cmp_ne_u64 vcc, s[88:89], v[40:41]
  s_cbranch_vccnz va_bw_16_no
  v_cmp_ne_u64 vcc, s[88:89], v[42:43]
  s_cbranch_vccnz va_bw_16_no
  s_branch va_bw_16_ok
va_bw_16_no:
  s_sleep 2
  s_add_u32 s30, s30, 1
  s_cmp_lt_u32 s30, 50000
  s_cbranch_scc1 va_bw_16
  s_branch cA_abort
va_bw_16_ok:
  s_add_u32 s22, s31, 286720
  buffer_load_dwordx4 a[0:3], v2, s[8:11], s22 offen offset:0 sc1
  buffer_load_dwordx4 a[4:7], v2, s[8:11], s22 offen offset:1024 sc1
  buffer_load_dwordx4 a[8:11], v2, s[8:11], s22 offen offset:2048 sc1
  buffer_load_dwordx4 a[12:15], v2, s[8:11], s22 offen offset:3072 sc1
  s_add_u32 s22, s31, 290816
  buffer_load_dwordx4 a[16:19], v2, s[8:11], s22 offen offset:0 sc1
  buffer_load_dwordx4 a[20:23], v2, s[8:11], s22 offen offset:1024 sc1
  buffer_load_dwordx4 a[24:27], v2, s[8:11], s22 offen offset:2048 sc1
  buffer_load_dwordx4 a[28:31], v2, s[8:11], s22 offen offset:3072 sc1
  s_add_u32 s22, s31, 294912
  buffer_load_dwordx4 a[32:35], v2, s[8:11], s22 offen offset:0 sc1
  buffer_load_dwordx4 a[36:39], v2, s[8:11], s22 offen offset:1024 sc1
  buffer_load_dwordx4 a[40:43], v2, s[8:11], s22 offen offset:2048 sc1
  buffer_load_dwordx4 a[44:47], v2, s[8:11], s22 offen offset:3072 sc1
  s_add_u32 s22, s31, 299008
  buffer_load_dwordx4 a[48:51], v2, s[8:11], s22 offen offset:0 sc1
  buffer_load_dwordx4 a[52:55], v2, s[8:11], s22 offen offset:1024 sc1
  buffer_load_dwordx4 a[56:59], v2, s[8:11], s22 offen offset:2048 sc1
  buffer_load_dwordx4 a[60:63], v2, s[8:11], s22 offen offset:3072 sc1
  s_add_u32 s22, s31, 303104
  buffer_load_dwordx4 a[64:67], v2, s[8:11], s22 offen offset:0 sc1
  buffer_load_dwordx4 a[68:71], v2, s[8:11], s22 offen offset:1024 sc1
  buffer_load_dwordx4 a[72:75], v2, s[8:11], s22 offen offset:2048 sc1
  buffer_load_dwordx4 a[76:79], v2, s[8:11], s22 offen offset:3072 sc1
  s_add_u32 s22, s31, 307200
  buffer_load_dwordx4 a[80:83], v2, s[8:11], s22 offen offset:0 sc1
  buffer_load_dwordx4 a[84:87], v2, s[8:11], s22 offen offset:1024 sc1
  buffer_load_dwordx4 a[88:91], v2, s[8:11], s22 offen offset:2048 sc1
  buffer_load_dwordx4 a[92:95], v2, s[8:11], s22 offen offset:3072 sc1
  s_add_u32 s22, s31, 311296
  buffer_load_dwordx4 a[96:99], v2, s[8:11], s22 offen offset:0 sc1
  buffer_load_dwordx4 a[100:103], v2, s[8:11], s22 offen offset:1024 sc1
  buffer_load_dwordx4 a[104:107], v2, s[8:11], s22 offen offset:2048 sc1
  buffer_load_dwordx4 a[108:111], v2, s[8:11], s22 offen offset:3072 sc1
  s_add_u32 s22, s31, 315392
  buffer_load_dwordx4 a[112:115], v2, s[8:11], s22 offen offset:0 sc1
  buffer_load_dwordx4 a[116:119], v2, s[8:11], s22 offen offset:1024 sc1
  buffer_load_dwordx4 a[120:123], v2, s[8:11], s22 offen offset:2048 sc1
  buffer_load_dwordx4 a[124:127], v2, s[8:11], s22 offen offset:3072 sc1
  s_waitcnt vmcnt(24)
  s_add_u32 s22, s31, 319488
  buffer_load_dwordx4 a[128:131], v2, s[8:11], s22 offen offset:0 sc1
  buffer_load_dwordx4 a[132:135], v2, s[8:11], s22 offen offset:1024 sc1
  buffer_load_dwordx4 a[136:139], v2, s[8:11], s22 offen offset:2048 sc1
  buffer_load_dwordx4 a[140:143], v2, s[8:11], s22 offen offset:3072 sc1
  s_add_u32 s22, s31, 323584
  buffer_load_dwordx4 a[144:147], v2, s[8:11], s22 offen offset:0 sc1
  buffer_load_dwordx4 a[148:151], v2, s[8:11], s22 offen offset:1024 sc1
  buffer_load_dwordx4 a[152:155], v2, s[8:11], s22 offen offset:2048 sc1
  buffer_load_dwordx4 a[156:159], v2, s[8:11], s22 offen offset:3072 sc1
  s_add_u32 s22, s31, 327680
  buffer_load_dwordx4 a[160:163], v2, s[8:11], s22 offen offset:0 sc1
  buffer_load_dwordx4 a[164:167], v2, s[8:11], s22 offen offset:1024 sc1
  buffer_load_dwordx4 a[168:171], v2, s[8:11], s22 offen offset:2048 sc1
  buffer_load_dwordx4 a[172:175], v2, s[8:11], s22 offen offset:3072 sc1
  s_add_u32 s22, s31, 331776
  buffer_load_dwordx4 a[176:179], v2, s[8:11], s22 offen offset:0 sc1
  buffer_load_dwordx4 a[180:183], v2, s[8:11], s22 offen offset:1024 sc1
  buffer_load_dwordx4 a[184:187], v2, s[8:11], s22 offen offset:2048 sc1
  buffer_load_dwordx4 a[188:191], v2, s[8:11], s22 offen offset:3072 sc1
  s_add_u32 s22, s31, 335872
  buffer_load_dwordx4 a[192:195], v2, s[8:11], s22 offen offset:0 sc1
  buffer_load_dwordx4 a[196:199], v2, s[8:11], s22 offen offset:1024 sc1
  buffer_load_dwordx4 a[200:203], v2, s[8:11], s22 offen offset:2048 sc1
  buffer_load_dwordx4 a[204:207], v2, s[8:11], s22 offen offset:3072 sc1
  s_add_u32 s22, s31, 339968
  buffer_load_dwordx4 a[208:211], v2, s[8:11], s22 offen offset:0 sc1
  buffer_load_dwordx4 a[212:215], v2, s[8:11], s22 offen offset:1024 sc1
  buffer_load_dwordx4 a[216:219], v2, s[8:11], s22 offen offset:2048 sc1
  buffer_load_dwordx4 a[220:223], v2, s[8:11], s22 offen offset:3072 sc1
  s_add_u32 s22, s31, 344064
  buffer_load_dwordx4 a[224:227], v2, s[8:11], s22 offen offset:0 sc1
  buffer_load_dwordx4 a[228:231], v2, s[8:11], s22 offen offset:1024 sc1
  buffer_load_dwordx4 a[232:235], v2, s[8:11], s22 offen offset:2048 sc1
  buffer_load_dwordx4 a[236:239], v2, s[8:11], s22 offen offset:3072 sc1
  s_add_u32 s22, s31, 348160
  buffer_load_dwordx4 a[240:243], v2, s[8:11], s22 offen offset:0 sc1
  buffer_load_dwordx4 a[244:247], v2, s[8:11], s22 offen offset:1024 sc1
  buffer_load_dwordx4 a[248:251], v2, s[8:11], s22 offen offset:2048 sc1
  buffer_load_dwordx4 a[252:255], v2, s[8:11], s22 offen offset:3072 sc1
  s_waitcnt vmcnt(24)
  s_add_u32 s22, s31, 352256
  buffer_load_dwordx4 v[120:123], v2, s[8:11], s22 offen offset:0 sc1
  buffer_load_dwordx4 v[124:127], v2, s[8:11], s22 offen offset:1024 sc1
  buffer_load_dwordx4 v[128:131], v2, s[8:11], s22 offen offset:2048 sc1
  buffer_load_dwordx4 v[132:135], v2, s[8:11], s22 offen offset:3072 sc1
  s_add_u32 s22, s31, 356352
  buffer_load_dwordx4 v[136:139], v2, s[8:11], s22 offen offset:0 sc1
  buffer_load_dwordx4 v[140:143], v2, s[8:11], s22 offen offset:1024 sc1
  buffer_load_dwordx4 v[144:147], v2, s[8:11], s22 offen offset:2048 sc1
  buffer_load_dwordx4 v[148:151], v2, s[8:11], s22 offen offset:3072 sc1
  s_add_u32 s22, s31, 360448
  buffer_load_dwordx4 v[152:155], v2, s[8:11], s22 offen offset:0 sc1
  buffer_load_dwordx4 v[156:159], v2, s[8:11], s22 offen offset:1024 sc1
  buffer_load_dwordx4 v[160:163], v2, s[8:11], s22 offen offset:2048 sc1
  buffer_load_dwordx4 v[164:167], v2, s[8:11], s22 offen offset:3072 sc1
  s_add_u32 s22, s31, 364544
  buffer_load_dwordx4 v[168:171], v2, s[8:11], s22 offen offset:0 sc1
  buffer_load_dwordx4 v[172:175], v2, s[8:11], s22 offen offset:1024 sc1
  buffer_load_dwordx4 v[176:179], v2, s[8:11], s22 offen offset:2048 sc1
  buffer_load_dwordx4 v[180:183], v2, s[8:11], s22 offen offset:3072 sc1
  s_add_u32 s22, s31, 368640
  buffer_load_dwordx4 v[184:187], v2, s[8:11], s22 offen offset:0 sc1
  buffer_load_dwordx4 v[188:191], v2, s[8:11], s22 offen offset:1024 sc1
  buffer_load_dwordx4 v[192:195], v2, s[8:11], s22 offen offset:2048 sc1
  buffer_load_dwordx4 v[196:199], v2, s[8:11], s22 offen offset:3072 sc1
  s_add_u32 s22, s31, 372736
  buffer_load_dwordx4 v[200:203], v2, s[8:11], s22 offen offset:0 sc1
  buffer_load_dwordx4 v[204:207], v2, s[8:11], s22 offen offset:1024 sc1
  buffer_load_dwordx4 v[208:211], v2, s[8:11], s22 offen offset:2048 sc1
  buffer_load_dwordx4 v[212:215], v2, s[8:11], s22 offen offset:3072 sc1
  s_add_u32 s22, s31, 376832
  buffer_load_dwordx4 v[216:219], v2, s[8:11], s22 offen offset:0 sc1
  buffer_load_dwordx4 v[220:223], v2, s[8:11], s22 offen offset:1024 sc1
  buffer_load_dwordx4 v[224:227], v2, s[8:11], s22 offen offset:2048 sc1
  buffer_load_dwordx4 v[228:231], v2, s[8:11], s22 offen offset:3072 sc1
  s_add_u32 s22, s31, 380928
  buffer_load_dwordx4 v[232:235], v2, s[8:11], s22 offen offset:0 sc1
  buffer_load_dwordx4 v[236:239], v2, s[8:11], s22 offen offset:1024 sc1
  buffer_load_dwordx4 v[240:243], v2, s[8:11], s22 offen offset:2048 sc1
  buffer_load_dwordx4 v[244:247], v2, s[8:11], s22 offen offset:3072 sc1
  s_waitcnt vmcnt(24)
  s_add_u32 s22, s31, 385024
  buffer_load_dwordx4 v[248:251], v2, s[8:11], s22 offen offset:0 sc1
  buffer_load_dwordx4 v[252:255], v2, s[8:11], s22 offen offset:1024 sc1
  v_mov_b32 v72, v116
  v_mov_b32 v73, v117
  v_lshrrev_b32 v65, 1, v72
  v_and_b32 v66, 1, v72
  v_add_u32 v67, 64, v73
  v_mul_u32_u24 v68, 5462, v67
  v_lshrrev_b32 v68, 16, v68
  v_mul_u32_u24 v69, 12, v68
  v_sub_u32 v69, v67, v69
  v_mov_b32 v70, 1
  v_and_b32 v71, 1, v69
  v_lshrrev_b32 v69, 1, v69
  v_lshl_add_u32 v69, v71, 3, v69
  v_lshlrev_b32 v71, 12, v70
  v_lshrrev_b32 v70, 1, v68
  v_lshl_add_u32 v71, v70, 9, v71
  v_and_b32 v70, 1, v68
  v_lshl_add_u32 v71, v70, 2, v71
  v_lshl_add_u32 v71, v69, 4, v71
  v_lshl_add_u32 v71, v65, 8, v71
  v_lshl_add_u32 v100, v66, 3, v71
  v_add_u32 v67, 80, v73
  v_mul_u32_u24 v68, 5462, v67
  v_lshrrev_b32 v68, 16, v68
  v_mul_u32_u24 v69, 12, v68
  v_sub_u32 v69, v67, v69
  v_mov_b32 v70, 1
  v_and_b32 v71, 1, v69
  v_lshrrev_b32 v69, 1, v69
  v_lshl_add_u32 v69, v71, 3, v69
  v_lshlrev_b32 v71, 12, v70
  v_lshrrev_b32 v70, 1, v68
  v_lshl_add_u32 v71, v70, 9, v71
  v_and_b32 v70, 1, v68
  v_lshl_add_u32 v71, v70, 2, v71
  v_lshl_add_u32 v71, v69, 4, v71
  v_lshl_add_u32 v71, v65, 8, v71
  v_lshl_add_u32 v101, v66, 3, v71
  v_add_u32 v67, 96, v73
  v_mul_u32_u24 v68, 5462, v67
  v_lshrrev_b32 v68, 16, v68
  v_mul_u32_u24 v69, 12, v68
  v_sub_u32 v69, v67, v69
  v_mov_b32 v70, 1
  v_and_b32 v71, 1, v69
  v_lshrrev_b32 v69, 1, v69
  v_lshl_add_u32 v69, v71, 3, v69
  v_lshlrev_b32 v71, 12, v70
  v_lshrrev_b32 v70, 1, v68
  v_lshl_add_u32 v71, v70, 9, v71
  v_and_b32 v70, 1, v68
  v_lshl_add_u32 v71, v70, 2, v71
  v_lshl_add_u32 v71, v69, 4, v71
  v_lshl_add_u32 v71, v65, 8, v71
  v_lshl_add_u32 v102, v66, 3, v71
  v_add_u32 v67, 112, v73
  v_mul_u32_u24 v68, 5462, v67
  v_lshrrev_b32 v68, 16, v68
  v_mul_u32_u24 v69, 12, v68
  v_sub_u32 v69, v67, v69
  v_mov_b32 v70, 1
  v_and_b32 v71, 1, v69
  v_lshrrev_b32 v69, 1, v69
  v_lshl_add_u32 v69, v71, 3, v69
  v_lshlrev_b32 v71, 12, v70
  v_lshrrev_b32 v70, 1, v68
  v_lshl_add_u32 v71, v70, 9, v71
  v_and_b32 v70, 1, v68
  v_lshl_add_u32 v71, v70, 2, v71
  v_lshl_add_u32 v71, v69, 4, v71
  v_lshl_add_u32 v71, v65, 8, v71
  v_lshl_add_u32 v103, v66, 3, v71
  v_add_u32 v67, 128, v73
  v_mul_u32_u24 v68, 5462, v67
  v_lshrrev_b32 v68, 16, v68
  v_mul_u32_u24 v69, 12, v68
  v_sub_u32 v69, v67, v69
  v_mov_b32 v70, 1
  v_and_b32 v71, 1, v69
  v_lshrrev_b32 v69, 1, v69
  v_lshl_add_u32 v69, v71, 3, v69
  v_lshlrev_b32 v71, 12, v70
  v_lshrrev_b32 v70, 1, v68
  v_lshl_add_u32 v71, v70, 9, v71
  v_and_b32 v70, 1, v68
  v_lshl_add_u32 v71, v70, 2, v71
  v_lshl_add_u32 v71, v69, 4, v71
  v_lshl_add_u32 v71, v65, 8, v71
  v_lshl_add_u32 v104, v66, 3, v71
  v_add_u32 v67, 144, v73
  v_mul_u32_u24 v68, 5462, v67
  v_lshrrev_b32 v68, 16, v68
  v_mul_u32_u24 v69, 12, v68
  v_sub_u32 v69, v67, v69
  v_mov_b32 v70, 1
  v_and_b32 v71, 1, v69
  v_lshrrev_b32 v69, 1, v69
  v_lshl_add_u32 v69, v71, 3, v69
  v_lshlrev_b32 v71, 12, v70
  v_lshrrev_b32 v70, 1, v68
  v_lshl_add_u32 v71, v70, 9, v71
  v_and_b32 v70, 1, v68
  v_lshl_add_u32 v71, v70, 2, v71
  v_lshl_add_u32 v71, v69, 4, v71
  v_lshl_add_u32 v71, v65, 8, v71
  v_lshl_add_u32 v105, v66, 3, v71
  v_add_u32 v67, 160, v73
  v_mul_u32_u24 v68, 5462, v67
  v_lshrrev_b32 v68, 16, v68
  v_mul_u32_u24 v69, 12, v68
  v_sub_u32 v69, v67, v69
  v_mov_b32 v70, 1
  v_and_b32 v71, 1, v69
  v_lshrrev_b32 v69, 1, v69
  v_lshl_add_u32 v69, v71, 3, v69
  v_lshlrev_b32 v71, 12, v70
  v_lshrrev_b32 v70, 1, v68
  v_lshl_add_u32 v71, v70, 9, v71
  v_and_b32 v70, 1, v68
  v_lshl_add_u32 v71, v70, 2, v71
  v_lshl_add_u32 v71, v69, 4, v71
  v_lshl_add_u32 v71, v65, 8, v71
  v_lshl_add_u32 v106, v66, 3, v71
  v_add_u32 v67, 176, v73
  v_mul_u32_u24 v68, 5462, v67
  v_lshrrev_b32 v68, 16, v68
  v_mul_u32_u24 v69, 12, v68
  v_sub_u32 v69, v67, v69
  v_mov_b32 v70, 1
  v_and_b32 v71, 1, v69
  v_lshrrev_b32 v69, 1, v69
  v_lshl_add_u32 v69, v71, 3, v69
  v_lshlrev_b32 v71, 12, v70
  v_lshrrev_b32 v70, 1, v68
  v_lshl_add_u32 v71, v70, 9, v71
  v_and_b32 v70, 1, v68
  v_lshl_add_u32 v71, v70, 2, v71
  v_lshl_add_u32 v71, v69, 4, v71
  v_lshl_add_u32 v71, v65, 8, v71
  v_lshl_add_u32 v107, v66, 3, v71
  s_mul_i32 s24, s17, 532480
  s_add_u32 s24, s24, 76943360
  s_mul_i32 s34, s17, 640
  s_add_u32 s34, s34, 88582148
  s_mul_i32 s36, s17, 448
  v_add_u32 v0, s36, v2
  v_add_u32 v0, 8192, v0
  s_add_u32 s36, s36, 88080384
  s_mov_b32 s37, 76939264
  v_cmp_gt_u32 s[26:27], 28, v1
  v_and_b32 v119, 31, v1
  v_lshlrev_b32 v119, 2, v119
  v_and_b32 v119, 0x78, v119
  v_or_b32 v119, 4, v119
  s_add_u32 s22, s17, 16
  s_and_b32 s22, s22, 15
  s_lshl_b32 s22, s22, 7
  s_add_u32 s22, s22, 18432
  v_add_u32 v119, s22, v119
  v_min_u32 v118, 13, v1
  s_mul_i32 s22, s17, 14
  v_add_u32 v118, s22, v118
  v_lshlrev_b32 v118, 7, v118
  v_add_u32 v118, 57344, v118
  s_mov_b32 s39, 71565312
  v_add_u32 v1, 59392, v2
  v_mov_b32 v117, 1
  s_mul_i32 s38, s17, 1104
  s_add_u32 s38, s38, 21504
  v_bfe_u32 v8, v2, 4, 1
  v_mul_u32_u24 v3, 0xaaaa, v8
  v_add_u32 v3, 0x4444, v3
  v_bfe_u32 v9, v2, 5, 3
  v_lshl_add_u32 v8, v8, 3, v9
  v_and_b32 v9, 0x300, v2
  v_lshl_add_u32 v5, v8, 4, v9
  s_lshl_b32 s22, 0, 11
  s_add_u32 s22, s22, 88602624
  v_add_u32 v36, 1024, v2
  v_min_u32 v36, 1776, v36
  s_mov_b32 s30, 0
va_iw7:
  buffer_load_dwordx4 v[40:43], v2, s[8:11], s22 offen sc1
  buffer_load_dwordx4 v[44:47], v36, s[8:11], s22 offen sc1
  s_waitcnt vmcnt(0)
  v_cmp_ne_u64 vcc, s[88:89], v[40:41]
  s_cbranch_vccnz va_iw7_no
  v_cmp_ne_u64 vcc, s[88:89], v[42:43]
  s_cbranch_vccnz va_iw7_no
  v_cmp_ne_u64 vcc, s[88:89], v[44:45]
  s_cbranch_vccnz va_iw7_no
  v_cmp_ne_u64 vcc, s[88:89], v[46:47]
  s_cbranch_vccnz va_iw7_no
  s_branch va_iw7_ok
va_iw7_no:
  s_sleep 2
  s_add_u32 s30, s30, 1
  s_cmp_lt_u32 s30, 50000
  s_cbranch_scc1 va_iw7
  s_branch cA_abort
va_iw7_ok:
  s_mov_b32 s30, 0
  v_mov_b32 v36, 0
ch_md7:
  buffer_load_dword v37, v36, s[12:15], 0 offen sc1
  s_waitcnt vmcnt(0)
  v_readfirstlane_b32 s22, v37
  s_and_b32 s31, s22, 0xffff
  s_cmp_ge_u32 s31, 32
  s_cbranch_scc1 ch_go7
  s_sleep 2
  s_add_u32 s30, s30, 1
  s_cmp_lt_u32 s30, 50000
  s_cbranch_scc1 ch_md7
  s_branch ch_end
ch_go7:
  s_mov_b32 s31, 0
  s_lshr_b32 s22, s22, 16
  s_cmp_lg_u32 s22, 0
  s_cbranch_scc1 cB_va3_loop
  s_branch cA_va3_loop
.p2align 6

cA_sc0_loop:
  s_add_u32 s23, s20, 4096
  s_add_u32 s21, s20, 20480
  v_mov_b32 v48, 0
  v_mov_b32 v49, 0
  v_mov_b32 v50, 0
  v_mov_b32 v51, 0
  v_mov_b32 v52, 0
  v_mov_b32 v53, 0
  v_mov_b32 v54, 0
  v_mov_b32 v55, 0
  v_mov_b32 v56, 0
  v_mov_b32 v57, 0
  v_mov_b32 v58, 0
  v_mov_b32 v59, 0
  v_mov_b32 v60, 0
  v_mov_b32 v61, 0
  v_mov_b32 v62, 0
  v_mov_b32 v63, 0
  v_mov_b32 v88, 0
  v_mov_b32 v89, 0
  v_mov_b32 v90, 0
  v_mov_b32 v91, 0
  v_mov_b32 v92, 0
  v_mov_b32 v93, 0
  v_mov_b32 v94, 0
  v_mov_b32 v95, 0
  v_mov_b32 v66, 0
  v_mov_b32 v67, 0
  s_mov_b32 s30, 0
  s_mov_b32 s62, 0
  buffer_load_dword v68, v0, s[8:11], s20 offen sc1
  s_nop 7
  buffer_load_dword v69, v0, s[8:11], s20 offen sc1
  s_nop 7
  buffer_load_dword v70, v0, s[8:11], s20 offen sc1
  s_nop 7
  buffer_load_dword v71, v0, s[8:11], s20 offen sc1
  s_nop 7
  buffer_load_dword v72, v0, s[8:11], s20 offen sc1
cA_sc0_fp_l:
  s_waitcnt vmcnt(4)
  v_cmp_eq_u32 vcc, -1, v68
  s_cbranch_vccz cA_sc0_fp_d
  buffer_load_dword v68, v0, s[8:11], s20 offen sc1
  s_waitcnt vmcnt(4)
  v_cmp_eq_u32 vcc, -1, v69
  s_cbranch_vccz cA_sc0_fp_d
  buffer_load_dword v69, v0, s[8:11], s20 offen sc1
  s_waitcnt vmcnt(4)
  v_cmp_eq_u32 vcc, -1, v70
  s_cbranch_vccz cA_sc0_fp_d
  buffer_load_dword v70, v0, s[8:11], s20 offen sc1
  s_waitcnt vmcnt(4)
  v_cmp_eq_u32 vcc, -1, v71
  s_cbranch_vccz cA_sc0_fp_d
  buffer_load_dword v71, v0, s[8:11], s20 offen sc1
  s_waitcnt vmcnt(4)
  v_cmp_eq_u32 vcc, -1, v72
  s_cbranch_vccz cA_sc0_fp_d
  buffer_load_dword v72, v0, s[8:11], s20 offen sc1
  s_add_u32 s30, s30, 1
  s_cmp_lt_u32 s30, 400000
  s_cbranch_scc1 cA_sc0_fp_l
  s_branch cA_abort
cA_sc0_fp_d:
  buffer_load_dwordx4 v[8:11], v2, s[8:11], s20 offen offset:0
  s_barrier
  s_branch cA_sc0_ld1
cA_sc0_ld:
  buffer_load_dwordx4 v[8:11], v2, s[8:11], s20 offen offset:0
cA_sc0_ld1:
  v_mov_b32 v36, 0
  v_mov_b32 v37, 0
  v_mov_b32 v38, 0
  v_mov_b32 v39, 0
  buffer_load_dwordx4 v[12:15], v2, s[8:11], s20 offen offset:1024
  v_mov_b32 v40, 0
  v_mov_b32 v41, 0
  v_mov_b32 v42, 0
  v_mov_b32 v43, 0
  buffer_load_dwordx4 v[16:19], v2, s[8:11], s20 offen offset:2048
  v_mov_b32 v44, 0
  v_mov_b32 v45, 0
  v_mov_b32 v46, 0
  v_mov_b32 v47, 0
  ds_read_b128 v[96:99], v117 offset:0
  ds_read_b128 v[100:103], v117 offset:1024
  ds_read_b128 v[104:107], v117 offset:14336
  ds_read_b128 v[108:111], v117 offset:15360
  s_waitcnt vmcnt(2)
  v_smfmac_f32_16x16x64_bf16 v[36:39], v[8:11], a[0:7], v3
  v_smfmac_f32_16x16x64_bf16 v[40:43], v[8:11], a[56:63], v3
  buffer_load_dwordx4 v[20:23], v2, s[8:11], s20 offen offset:3072
  v_smfmac_f32_16x16x64_bf16 v[44:47], v[8:11], a[112:119], v3
  v_smfmac_f32_16x16x64_bf16 v[48:51], v[8:11], a[168:175], v3
  v_smfmac_f32_16x16x64_bf16 v[52:55], v[8:11], a[224:231], v3
  buffer_load_dwordx4 v[24:27], v2, s[8:11], s23 offen offset:0
  v_smfmac_f32_16x16x64_bf16 v[56:59], v[8:11], v[144:151], v3
  v_smfmac_f32_16x16x64_bf16 v[60:63], v[8:11], v[200:207], v3
  s_waitcnt vmcnt(3)
  v_smfmac_f32_16x16x64_bf16 v[36:39], v[12:15], a[8:15], v3
  v_smfmac_f32_16x16x64_bf16 v[40:43], v[12:15], a[64:71], v3
  buffer_load_dwordx4 v[28:31], v2, s[8:11], s23 offen offset:1024
  v_smfmac_f32_16x16x64_bf16 v[44:47], v[12:15], a[120:127], v3
  v_smfmac_f32_16x16x64_bf16 v[48:51], v[12:15], a[176:183], v3
  v_smfmac_f32_16x16x64_bf16 v[52:55], v[12:15], a[232:239], v3
  buffer_load_dwordx4 v[32:35], v2, s[8:11], s23 offen offset:2048
  v_smfmac_f32_16x16x64_bf16 v[56:59], v[12:15], v[152:159], v3
  v_smfmac_f32_16x16x64_bf16 v[60:63], v[12:15], v[208:215], v3
  s_xor_b32 s58, s25, 28672
  s_add_u32 s59, s24, 28672
  s_add_u32 m0, s58, 0
  s_waitcnt vmcnt(4)
  v_smfmac_f32_16x16x64_bf16 v[36:39], v[16:19], a[16:23], v3
  buffer_load_dwordx4 v2, s[8:11], s59 offen offset:0 sc1 lds
  v_smfmac_f32_16x16x64_bf16 v[40:43], v[16:19], a[72:79], v3
  v_smfmac_f32_16x16x64_bf16 v[44:47], v[16:19], a[128:135], v3
  v_smfmac_f32_16x16x64_bf16 v[48:51], v[16:19], a[184:191], v3
  v_smfmac_f32_16x16x64_bf16 v[52:55], v[16:19], a[240:247], v3
  buffer_load_dwordx4 v2, s[8:11], s59 offen offset:1024 sc1 lds
  v_smfmac_f32_16x16x64_bf16 v[56:59], v[16:19], v[160:167], v3
  v_smfmac_f32_16x16x64_bf16 v[60:63], v[16:19], v[216:223], v3
  s_waitcnt vmcnt(5)
  v_smfmac_f32_16x16x64_bf16 v[36:39], v[20:23], a[24:31], v3
  v_smfmac_f32_16x16x64_bf16 v[40:43], v[20:23], a[80:87], v3
  buffer_load_dwordx4 v2, s[8:11], s59 offen offset:2048 sc1 lds
  v_smfmac_f32_16x16x64_bf16 v[44:47], v[20:23], a[136:143], v3
  v_smfmac_f32_16x16x64_bf16 v[48:51], v[20:23], a[192:199], v3
  v_smfmac_f32_16x16x64_bf16 v[52:55], v[20:23], a[248:255], v3
  v_smfmac_f32_16x16x64_bf16 v[56:59], v[20:23], v[168:175], v3
  buffer_load_dwordx4 v2, s[8:11], s59 offen offset:3072 sc1 lds
  v_smfmac_f32_16x16x64_bf16 v[60:63], v[20:23], v[224:231], v3
  s_waitcnt vmcnt(4)
cA_sc0_ph2:
  v_smfmac_f32_16x16x64_bf16 v[60:63], v[24:27], v[232:239], v3
  ds_read_b128 v[12:15], v116 offset:0
  ds_read_b128 v[16:19], v116 offset:1024
  v_smfmac_f32_16x16x64_bf16 v[60:63], v[28:31], v[240:247], v3
  v_smfmac_f32_16x16x64_bf16 v[60:63], v[32:35], v[248:255], v3
  v_mov_b32 v80, v24
  v_smfmac_f32_16x16x64_bf16 v[52:55], v[24:27], v[120:127], v3
  v_mov_b32 v81, v25
  v_smfmac_f32_16x16x64_bf16 v[52:55], v[28:31], v[128:135], v3
  v_mov_b32 v82, v32
  v_smfmac_f32_16x16x64_bf16 v[52:55], v[32:35], v[136:143], v3
  v_cvt_pk_bf16_f32 v64, v60, v61
  v_smfmac_f32_16x16x64_bf16 v[56:59], v[24:27], v[176:183], v3
  v_cvt_pk_bf16_f32 v65, v62, v63
  v_smfmac_f32_16x16x64_bf16 v[56:59], v[28:31], v[184:191], v3
  v_mov_b32 v83, v33
  v_mfma_f32_16x16x32_bf16 v[68:71], v[64:67], v[4:7], 0
  v_smfmac_f32_16x16x64_bf16 v[56:59], v[32:35], v[192:199], v3
  v_cvt_pk_bf16_f32 v64, v52, v53
  v_smfmac_f32_16x16x64_bf16 v[36:39], v[24:27], a[32:39], v3
  v_cvt_pk_bf16_f32 v65, v54, v55
  v_smfmac_f32_16x16x64_bf16 v[36:39], v[28:31], a[40:47], v3
  v_cvt_pk_bf16_f32 v78, v68, v69
  v_smfmac_f32_16x16x64_bf16 v[36:39], v[32:35], a[48:55], v3
  v_cvt_pk_bf16_f32 v79, v70, v71
  v_cvt_pk_bf16_f32 v66, v56, v57
  v_smfmac_f32_16x16x64_bf16 v[40:43], v[24:27], a[88:95], v3
  v_cvt_pk_bf16_f32 v67, v58, v59
  v_smfmac_f32_16x16x64_bf16 v[40:43], v[28:31], a[96:103], v3
  v_mfma_f32_16x16x32_bf16 v[72:75], v[64:67], v[4:7], 0
  ds_read_b128 v[52:55], v116 offset:14336
  ds_read_b128 v[56:59], v116 offset:15360
  v_smfmac_f32_16x16x64_bf16 v[40:43], v[32:35], a[104:111], v3
  v_cvt_pk_bf16_f32 v64, v36, v37
  v_smfmac_f32_16x16x64_bf16 v[44:47], v[24:27], a[144:151], v3
  v_cvt_pk_bf16_f32 v65, v38, v39
  v_smfmac_f32_16x16x64_bf16 v[44:47], v[28:31], a[152:159], v3
  v_cvt_pk_bf16_f32 v76, v72, v73
  v_smfmac_f32_16x16x64_bf16 v[44:47], v[32:35], a[160:167], v3
  v_cvt_pk_bf16_f32 v77, v74, v75
  v_cvt_pk_bf16_f32 v66, v40, v41
  v_smfmac_f32_16x16x64_bf16 v[48:51], v[24:27], a[200:207], v3
  v_cvt_pk_bf16_f32 v67, v42, v43
  v_smfmac_f32_16x16x64_bf16 v[48:51], v[28:31], a[208:215], v3
  v_mfma_f32_16x16x32_bf16 v[68:71], v[64:67], v[4:7], 0
  v_smfmac_f32_16x16x64_bf16 v[48:51], v[32:35], a[216:223], v3
  v_cvt_pk_bf16_f32 v64, v44, v45
  v_mfma_f32_16x16x32_bf16 v[84:87], v[80:83], v[76:79], 0
  v_cvt_pk_bf16_f32 v65, v46, v47
  s_waitcnt lgkmcnt(0)
  v_smfmac_f32_16x16x64_bf16 v[88:91], v[76:79], v[96:103], v118
  v_cvt_pk_bf16_f32 v60, v68, v69
  v_cvt_pk_bf16_f32 v61, v70, v71
  v_cvt_pk_bf16_f32 v66, v48, v49
  v_cvt_pk_bf16_f32 v67, v50, v51
  s_nop 1
  v_mfma_f32_16x16x32_bf16 v[72:75], v[64:67], v[4:7], 0
  v_smfmac_f32_16x16x64_bf16 v[92:95], v[76:79], v[104:111], v118
  s_nop 4
  v_cvt_pk_bf16_f32 v62, v72, v73
  v_cvt_pk_bf16_f32 v63, v74, v75
  s_nop 1
  v_mfma_f32_16x16x32_bf16 v[84:87], v[8:11], v[60:63], v[84:87]
  v_smfmac_f32_16x16x64_bf16 v[88:91], v[60:63], v[12:19], v118
  v_smfmac_f32_16x16x64_bf16 v[92:95], v[60:63], v[52:59], v118
  s_nop 1
  v_permlane32_swap_b32 v84, v86
  v_permlane32_swap_b32 v85, v87
  s_nop 0
  v_add_f32 v88, v88, v89
  v_add_f32_dpp v84, v86, v84 quad_perm:[1,0,3,2] row_mask:0xf bank_mask:0xf
  v_add_f32_dpp v85, v87, v85 quad_perm:[1,0,3,2] row_mask:0xf bank_mask:0xf
  v_add_f32 v89, v90, v91
  ds_write2_b32 v113, v84, v85 offset0:0 offset1:4
  ds_write2_b32 v112, v88, v89 offset0:0 offset1:128
  v_add_f32 v90, v92, v93
  v_add_f32 v91, v94, v95
  ds_write2_b32 v112, v90, v91 offset0:64 offset1:192
  v_cmp_u_f32 vcc, v88, v89
  s_cbranch_vccnz cA_sc0_retry
cA_sc0_cont:
  s_waitcnt lgkmcnt(0)
  s_barrier
  ds_read_b128 v[36:39], v114
  ds_read_b128 v[44:47], v115
  s_waitcnt lgkmcnt(0)
  v_add_f32 v36, v36, v38
  v_add_f32 v37, v37, v39
  v_add_f32 v44, v44, v45
  buffer_store_dword v2, v119, s[8:11], s20 offen
  v_add_f32 v46, v46, v47
  v_add_f32 v44, v44, v46
  v_add_f32 v36, v36, v37
  v_exp_f32 v49, v44
  v_exp_f32 v48, v36
  v_add_f32 v50, abs(v36), abs(v44)
  v_fma_f32 v39, v49, s37, v48
  v_cmp_ngt_f32 vcc, s56, v50
  v_cndmask_b32 v41, v48, v49, s[38:39]
  v_add_f32_dpp v39, v39, v39 quad_perm:[1,0,3,2] row_mask:0xf bank_mask:0xf
  v_cndmask_b32 v40, v49, v48, s[38:39]
  v_mov_b32_dpp v46, v41 quad_perm:[1,0,3,2] row_mask:0xf bank_mask:0xf
  v_add_f32_dpp v39, v39, v39 quad_perm:[2,3,0,1] row_mask:0xf bank_mask:0xf
  v_cndmask_b32 v42, v46, v40, s[38:39]
  v_cndmask_b32 v43, v40, v46, s[38:39]
  v_add_f32_dpp v39, v39, v39 row_half_mirror row_mask:0xf bank_mask:0xf
  s_cbranch_vccnz cA_sc0_slow
  s_nop 0
  v_add_f32_dpp v47, v39, v39 row_mirror row_mask:0xf bank_mask:0xf
  v_add_f32_dpp v39, v39, v39 row_mirror row_mask:0xf bank_mask:0xf
  s_nop 1
  v_permlane16_swap_b32 v39, v47
  v_add_f32 v39, v39, v47
  v_rcp_f32 v39, v39
  s_mov_b64 exec, s[28:29]
  v_mul_f32 v42, v42, v39
  v_mul_f32 v43, v43, v39
  v_cvt_pk_bf16_f32 v42, v42, v43
cA_sc0_pst:
  buffer_store_dword v42, v1, s[8:11], s20 offen
  s_mov_b64 exec, -1
  s_barrier
  s_cmp_lg_u32 s19, 0
  s_cbranch_scc1 cA_sc0_s0
  s_sub_u32 s36, s36, 64
  v_subrev_u32 v119, 64, v119
  v_lshl_add_u32 v56, v2, 3, s36
  s_mov_b64 exec, 15
  buffer_store_dword v2, v56, s[8:11], s20 offen
  s_mov_b64 exec, -1
cA_sc0_s0:
  s_add_u32 s24, s24, 28672
  s_add_u32 s35, s35, 28672
  s_xor_b32 s25, s25, 28672
  s_add_u32 m0, s25, 0
  s_add_u32 m0, s25, 4096
  s_add_u32 s22, s24, 4096
  buffer_load_dwordx4 v2, s[8:11], s22 offen offset:0 sc1 lds
  s_nop 5
  buffer_load_dwordx4 v2, s[8:11], s22 offen offset:1024 sc1 lds
  s_nop 5
  buffer_load_dwordx4 v2, s[8:11], s22 offen offset:2048 sc1 lds
  s_nop 5
  v_xor_b32 v116, 28672, v116
  v_add_u32 v117, s57, v117
  s_sub_u32 s57, 0, s57
  s_add_u32 s19, s19, 1
  s_mov_b32 s20, s21
  s_cmp_lt_u32 s19, 63
  s_cbranch_scc1 cA_sc0_loop
  s_branch cA_done
cA_sc0_slow:
  v_max_f32 v50, v36, v44
  s_nop 1
  v_max_f32_dpp v50, v50, v50 quad_perm:[1,0,3,2] row_mask:0xf bank_mask:0xf
  s_nop 1
  v_max_f32_dpp v50, v50, v50 quad_perm:[2,3,0,1] row_mask:0xf bank_mask:0xf
  s_nop 1
  v_max_f32_dpp v50, v50, v50 row_half_mirror row_mask:0xf bank_mask:0xf
  s_nop 1
  v_max_f32_dpp v50, v50, v50 row_mirror row_mask:0xf bank_mask:0xf
  v_mov_b32 v47, v50
  s_nop 1
  v_permlane16_swap_b32 v50, v47
  v_max_f32 v50, v50, v47
  v_sub_f32 v48, v36, v50
  v_sub_f32 v49, v44, v50
  v_exp_f32 v48, v48
  v_exp_f32 v49, v49
  s_add_u32 s31, s31, 0x100
  v_fma_f32 v39, v49, s37, v48
  v_cndmask_b32 v41, v48, v49, s[38:39]
  s_nop 0
  v_add_f32_dpp v39, v39, v39 quad_perm:[1,0,3,2] row_mask:0xf bank_mask:0xf
  v_cndmask_b32 v40, v49, v48, s[38:39]
  v_mov_b32_dpp v46, v41 quad_perm:[1,0,3,2] row_mask:0xf bank_mask:0xf
  v_add_f32_dpp v39, v39, v39 quad_perm:[2,3,0,1] row_mask:0xf bank_mask:0xf
  v_cndmask_b32 v42, v46, v40, s[38:39]
  v_cndmask_b32 v43, v40, v46, s[38:39]
  v_add_f32_dpp v39, v39, v39 row_half_mirror row_mask:0xf bank_mask:0xf
  s_nop 1
  v_add_f32_dpp v47, v39, v39 row_mirror row_mask:0xf bank_mask:0xf
  v_add_f32_dpp v39, v39, v39 row_mirror row_mask:0xf bank_mask:0xf
  s_nop 1
  v_permlane16_swap_b32 v39, v47
  v_add_f32 v39, v39, v47
  v_rcp_f32 v39, v39
  s_mov_b64 exec, s[28:29]
  v_mul_f32 v42, v42, v39
  v_mul_f32 v43, v43, v39
  v_cvt_pk_bf16_f32 v42, v42, v43
  v_min_u32 v42, -2, v42
  s_branch cA_sc0_pst
cA_sc0_retry:
  s_cmp_lg_u32 s62, 0
  s_cbranch_scc1 cA_sc0_cont
  s_waitcnt vmcnt(0) lgkmcnt(0)
cA_sc0_rv:
  buffer_load_dwordx4 v[8:11], v2, s[8:11], s20 offen offset:0 sc1
  buffer_load_dwordx4 v[12:15], v2, s[8:11], s20 offen offset:1024 sc1
  buffer_load_dwordx4 v[16:19], v2, s[8:11], s20 offen offset:2048 sc1
  buffer_load_dwordx4 v[20:23], v2, s[8:11], s20 offen offset:3072 sc1
  buffer_load_dwordx4 v[24:27], v2, s[8:11], s23 offen offset:0 sc1
  buffer_load_dwordx4 v[28:31], v2, s[8:11], s23 offen offset:1024 sc1
  buffer_load_dwordx4 v[32:35], v2, s[8:11], s23 offen offset:2048 sc1
  s_waitcnt vmcnt(0)
  v_max3_u32 v68, v8, v9, v10
  v_max3_u32 v68, v68, v11, v12
  v_max3_u32 v68, v68, v13, v14
  v_max3_u32 v68, v68, v15, v16
  v_max3_u32 v68, v68, v17, v18
  v_max3_u32 v68, v68, v19, v20
  v_max3_u32 v68, v68, v21, v22
  v_max3_u32 v68, v68, v23, v24
  v_max3_u32 v68, v68, v25, v26
  v_max3_u32 v68, v68, v27, v28
  v_max3_u32 v68, v68, v29, v30
  v_max3_u32 v68, v68, v31, v32
  v_max3_u32 v68, v68, v33, v34
  v_max_u32 v68, v68, v35
  v_cmp_eq_u32 vcc, -1, v68
  s_cbranch_vccz cA_sc0_rk
  s_add_u32 s30, s30, 1
  s_cmp_lt_u32 s30, 400000
  s_cbranch_scc1 cA_sc0_rv
  s_branch cA_abort
cA_sc0_rk:
  s_mov_b32 s62, 1
  v_mov_b32 v36, 0
  v_mov_b32 v37, 0
  v_mov_b32 v38, 0
  v_mov_b32 v39, 0
  v_mov_b32 v40, 0
  v_mov_b32 v41, 0
  v_mov_b32 v42, 0
  v_mov_b32 v43, 0
  v_mov_b32 v44, 0
  v_mov_b32 v45, 0
  v_mov_b32 v46, 0
  v_mov_b32 v47, 0
  v_mov_b32 v48, 0
  v_mov_b32 v49, 0
  v_mov_b32 v50, 0
  v_mov_b32 v51, 0
  v_mov_b32 v52, 0
  v_mov_b32 v53, 0
  v_mov_b32 v54, 0
  v_mov_b32 v55, 0
  v_mov_b32 v56, 0
  v_mov_b32 v57, 0
  v_mov_b32 v58, 0
  v_mov_b32 v59, 0
  v_mov_b32 v60, 0
  v_mov_b32 v61, 0
  v_mov_b32 v62, 0
  v_mov_b32 v63, 0
  v_mov_b32 v88, 0
  v_mov_b32 v89, 0
  v_mov_b32 v90, 0
  v_mov_b32 v91, 0
  v_mov_b32 v92, 0
  v_mov_b32 v93, 0
  v_mov_b32 v94, 0
  v_mov_b32 v95, 0
  v_mov_b32 v66, 0
  v_mov_b32 v67, 0
  s_add_u32 s31, s31, 1
  ds_read_b128 v[96:99], v117 offset:0
  ds_read_b128 v[100:103], v117 offset:1024
  ds_read_b128 v[104:107], v117 offset:14336
  ds_read_b128 v[108:111], v117 offset:15360
  v_smfmac_f32_16x16x64_bf16 v[36:39], v[8:11], a[0:7], v3
  v_smfmac_f32_16x16x64_bf16 v[40:43], v[8:11], a[56:63], v3
  v_smfmac_f32_16x16x64_bf16 v[44:47], v[8:11], a[112:119], v3
  v_smfmac_f32_16x16x64_bf16 v[48:51], v[8:11], a[168:175], v3
  v_smfmac_f32_16x16x64_bf16 v[52:55], v[8:11], a[224:231], v3
  v_smfmac_f32_16x16x64_bf16 v[56:59], v[8:11], v[144:151], v3
  v_smfmac_f32_16x16x64_bf16 v[60:63], v[8:11], v[200:207], v3
  v_smfmac_f32_16x16x64_bf16 v[36:39], v[12:15], a[8:15], v3
  v_smfmac_f32_16x16x64_bf16 v[40:43], v[12:15], a[64:71], v3
  v_smfmac_f32_16x16x64_bf16 v[44:47], v[12:15], a[120:127], v3
  v_smfmac_f32_16x16x64_bf16 v[48:51], v[12:15], a[176:183], v3
  v_smfmac_f32_16x16x64_bf16 v[52:55], v[12:15], a[232:239], v3
  v_smfmac_f32_16x16x64_bf16 v[56:59], v[12:15], v[152:159], v3
  v_smfmac_f32_16x16x64_bf16 v[60:63], v[12:15], v[208:215], v3
  v_smfmac_f32_16x16x64_bf16 v[36:39], v[16:19], a[16:23], v3
  v_smfmac_f32_16x16x64_bf16 v[40:43], v[16:19], a[72:79], v3
  v_smfmac_f32_16x16x64_bf16 v[44:47], v[16:19], a[128:135], v3
  v_smfmac_f32_16x16x64_bf16 v[48:51], v[16:19], a[184:191], v3
  v_smfmac_f32_16x16x64_bf16 v[52:55], v[16:19], a[240:247], v3
  v_smfmac_f32_16x16x64_bf16 v[56:59], v[16:19], v[160:167], v3
  v_smfmac_f32_16x16x64_bf16 v[60:63], v[16:19], v[216:223], v3
  v_smfmac_f32_16x16x64_bf16 v[36:39], v[20:23], a[24:31], v3
  v_smfmac_f32_16x16x64_bf16 v[40:43], v[20:23], a[80:87], v3
  v_smfmac_f32_16x16x64_bf16 v[44:47], v[20:23], a[136:143], v3
  v_smfmac_f32_16x16x64_bf16 v[48:51], v[20:23], a[192:199], v3
  v_smfmac_f32_16x16x64_bf16 v[52:55], v[20:23], a[248:255], v3
  v_smfmac_f32_16x16x64_bf16 v[56:59], v[20:23], v[168:175], v3
  v_smfmac_f32_16x16x64_bf16 v[60:63], v[20:23], v[224:231], v3
  s_xor_b32 s58, s25, 28672
  s_add_u32 s59, s24, 28672
  s_add_u32 m0, s58, 0
  s_branch cA_sc0_ph2
.p2align 6

cA_sc1_loop:
  s_add_u32 s23, s20, 4096
  s_add_u32 s21, s20, 20480
  v_mov_b32 v48, 0
  v_mov_b32 v49, 0
  v_mov_b32 v50, 0
  v_mov_b32 v51, 0
  v_mov_b32 v52, 0
  v_mov_b32 v53, 0
  v_mov_b32 v54, 0
  v_mov_b32 v55, 0
  v_mov_b32 v56, 0
  v_mov_b32 v57, 0
  v_mov_b32 v58, 0
  v_mov_b32 v59, 0
  v_mov_b32 v60, 0
  v_mov_b32 v61, 0
  v_mov_b32 v62, 0
  v_mov_b32 v63, 0
  v_mov_b32 v88, 0
  v_mov_b32 v89, 0
  v_mov_b32 v90, 0
  v_mov_b32 v91, 0
  v_mov_b32 v92, 0
  v_mov_b32 v93, 0
  v_mov_b32 v94, 0
  v_mov_b32 v95, 0
  v_mov_b32 v64, 0
  v_mov_b32 v65, 0
  s_mov_b32 s30, 0
  s_mov_b32 s62, 0
  s_waitcnt vmcnt(0)
  s_barrier
cA_sc1_ld:
  buffer_load_dwordx4 v[8:11], v2, s[8:11], s20 offen offset:0
  v_mov_b32 v36, 0
  v_mov_b32 v37, 0
  v_mov_b32 v38, 0
  v_mov_b32 v39, 0
  buffer_load_dwordx4 v[12:15], v2, s[8:11], s20 offen offset:1024
  v_mov_b32 v40, 0
  v_mov_b32 v41, 0
  v_mov_b32 v42, 0
  v_mov_b32 v43, 0
  buffer_load_dwordx4 v[16:19], v2, s[8:11], s20 offen offset:2048
  v_mov_b32 v44, 0
  v_mov_b32 v45, 0
  v_mov_b32 v46, 0
  v_mov_b32 v47, 0
  ds_read_b128 v[96:99], v117 offset:0
  ds_read_b128 v[100:103], v117 offset:1024
  ds_read_b128 v[104:107], v117 offset:14336
  ds_read_b128 v[108:111], v117 offset:15360
  s_waitcnt vmcnt(2)
  v_smfmac_f32_16x16x64_bf16 v[36:39], v[8:11], a[0:7], v3
  v_smfmac_f32_16x16x64_bf16 v[40:43], v[8:11], a[56:63], v3
  buffer_load_dwordx4 v[20:23], v2, s[8:11], s20 offen offset:3072
  v_smfmac_f32_16x16x64_bf16 v[44:47], v[8:11], a[112:119], v3
  v_smfmac_f32_16x16x64_bf16 v[48:51], v[8:11], a[168:175], v3
  v_smfmac_f32_16x16x64_bf16 v[52:55], v[8:11], a[224:231], v3
  buffer_load_dwordx4 v[24:27], v2, s[8:11], s23 offen offset:0
  v_smfmac_f32_16x16x64_bf16 v[56:59], v[8:11], v[144:151], v3
  v_smfmac_f32_16x16x64_bf16 v[60:63], v[8:11], v[200:207], v3
  s_waitcnt vmcnt(3)
  v_smfmac_f32_16x16x64_bf16 v[36:39], v[12:15], a[8:15], v3
  v_smfmac_f32_16x16x64_bf16 v[40:43], v[12:15], a[64:71], v3
  buffer_load_dwordx4 v[28:31], v2, s[8:11], s23 offen offset:1024
  v_smfmac_f32_16x16x64_bf16 v[44:47], v[12:15], a[120:127], v3
  v_smfmac_f32_16x16x64_bf16 v[48:51], v[12:15], a[176:183], v3
  v_smfmac_f32_16x16x64_bf16 v[52:55], v[12:15], a[232:239], v3
  buffer_load_dwordx4 v[32:35], v2, s[8:11], s23 offen offset:2048
  v_smfmac_f32_16x16x64_bf16 v[56:59], v[12:15], v[152:159], v3
  v_smfmac_f32_16x16x64_bf16 v[60:63], v[12:15], v[208:215], v3
  s_waitcnt vmcnt(4)
  v_smfmac_f32_16x16x64_bf16 v[36:39], v[16:19], a[16:23], v3
  s_xor_b32 s58, s25, 28672
  s_add_u32 s59, s24, 28672
  s_add_u32 m0, s58, 7168
  v_smfmac_f32_16x16x64_bf16 v[40:43], v[16:19], a[72:79], v3
  buffer_load_dwordx4 v2, s[8:11], s59 offen offset:0 sc1 lds
  v_smfmac_f32_16x16x64_bf16 v[44:47], v[16:19], a[128:135], v3
  v_smfmac_f32_16x16x64_bf16 v[48:51], v[16:19], a[184:191], v3
  v_smfmac_f32_16x16x64_bf16 v[52:55], v[16:19], a[240:247], v3
  v_smfmac_f32_16x16x64_bf16 v[56:59], v[16:19], v[160:167], v3
  buffer_load_dwordx4 v2, s[8:11], s59 offen offset:1024 sc1 lds
  v_smfmac_f32_16x16x64_bf16 v[60:63], v[16:19], v[216:223], v3
  s_waitcnt vmcnt(5)
  v_smfmac_f32_16x16x64_bf16 v[36:39], v[20:23], a[24:31], v3
  v_smfmac_f32_16x16x64_bf16 v[40:43], v[20:23], a[80:87], v3
  v_smfmac_f32_16x16x64_bf16 v[44:47], v[20:23], a[136:143], v3
  buffer_load_dwordx4 v2, s[8:11], s59 offen offset:2048 sc1 lds
  v_smfmac_f32_16x16x64_bf16 v[48:51], v[20:23], a[192:199], v3
  v_smfmac_f32_16x16x64_bf16 v[52:55], v[20:23], a[248:255], v3
  v_smfmac_f32_16x16x64_bf16 v[56:59], v[20:23], v[168:175], v3
  v_smfmac_f32_16x16x64_bf16 v[60:63], v[20:23], v[224:231], v3
  buffer_load_dwordx4 v2, s[8:11], s59 offen offset:3072 sc1 lds
  s_waitcnt vmcnt(4)
cA_sc1_ph2:
  v_smfmac_f32_16x16x64_bf16 v[60:63], v[24:27], v[232:239], v3
  ds_read_b128 v[16:19], v116 offset:2048
  ds_read_b128 v[20:23], v116 offset:3072
  v_smfmac_f32_16x16x64_bf16 v[60:63], v[28:31], v[240:247], v3
  buffer_load_dword v119, v0, s[8:11], s20 offen sc1
  v_smfmac_f32_16x16x64_bf16 v[60:63], v[32:35], v[248:255], v3
  v_mov_b32 v80, v26
  v_smfmac_f32_16x16x64_bf16 v[52:55], v[24:27], v[120:127], v3
  v_mov_b32 v81, v27
  v_smfmac_f32_16x16x64_bf16 v[52:55], v[28:31], v[128:135], v3
  v_mov_b32 v82, v32
  v_smfmac_f32_16x16x64_bf16 v[52:55], v[32:35], v[136:143], v3
  v_cvt_pk_bf16_f32 v66, v60, v61
  v_smfmac_f32_16x16x64_bf16 v[56:59], v[24:27], v[176:183], v3
  v_cvt_pk_bf16_f32 v67, v62, v63
  v_smfmac_f32_16x16x64_bf16 v[56:59], v[28:31], v[184:191], v3
  v_mov_b32 v83, v33
  v_mfma_f32_16x16x32_bf16 v[68:71], v[64:67], v[4:7], 0
  v_smfmac_f32_16x16x64_bf16 v[56:59], v[32:35], v[192:199], v3
  v_cvt_pk_bf16_f32 v64, v52, v53
  v_smfmac_f32_16x16x64_bf16 v[36:39], v[24:27], a[32:39], v3
  v_cvt_pk_bf16_f32 v65, v54, v55
  v_smfmac_f32_16x16x64_bf16 v[36:39], v[28:31], a[40:47], v3
  v_cvt_pk_bf16_f32 v78, v68, v69
  v_smfmac_f32_16x16x64_bf16 v[36:39], v[32:35], a[48:55], v3
  v_cvt_pk_bf16_f32 v79, v70, v71
  v_cvt_pk_bf16_f32 v66, v56, v57
  v_smfmac_f32_16x16x64_bf16 v[40:43], v[24:27], a[88:95], v3
  v_cvt_pk_bf16_f32 v67, v58, v59
  v_smfmac_f32_16x16x64_bf16 v[40:43], v[28:31], a[96:103], v3
  v_mfma_f32_16x16x32_bf16 v[72:75], v[64:67], v[4:7], 0
  ds_read_b128 v[52:55], v116 offset:16384
  ds_read_b128 v[56:59], v116 offset:17408
  v_smfmac_f32_16x16x64_bf16 v[40:43], v[32:35], a[104:111], v3
  v_cvt_pk_bf16_f32 v64, v36, v37
  v_smfmac_f32_16x16x64_bf16 v[44:47], v[24:27], a[144:151], v3
  v_cvt_pk_bf16_f32 v65, v38, v39
  v_smfmac_f32_16x16x64_bf16 v[44:47], v[28:31], a[152:159], v3
  v_cvt_pk_bf16_f32 v76, v72, v73
  v_smfmac_f32_16x16x64_bf16 v[44:47], v[32:35], a[160:167], v3
  v_cvt_pk_bf16_f32 v77, v74, v75
  v_cvt_pk_bf16_f32 v66, v40, v41
  v_smfmac_f32_16x16x64_bf16 v[48:51], v[24:27], a[200:207], v3
  v_cvt_pk_bf16_f32 v67, v42, v43
  v_smfmac_f32_16x16x64_bf16 v[48:51], v[28:31], a[208:215], v3
  v_mfma_f32_16x16x32_bf16 v[68:71], v[64:67], v[4:7], 0
  v_smfmac_f32_16x16x64_bf16 v[48:51], v[32:35], a[216:223], v3
  v_cvt_pk_bf16_f32 v64, v44, v45
  v_mfma_f32_16x16x32_bf16 v[84:87], v[80:83], v[76:79], 0
  v_cvt_pk_bf16_f32 v65, v46, v47
  s_waitcnt lgkmcnt(0)
  v_smfmac_f32_16x16x64_bf16 v[88:91], v[76:79], v[96:103], v118
  v_cvt_pk_bf16_f32 v60, v68, v69
  v_cvt_pk_bf16_f32 v61, v70, v71
  v_cvt_pk_bf16_f32 v66, v48, v49
  v_cvt_pk_bf16_f32 v67, v50, v51
  s_nop 1
  v_mfma_f32_16x16x32_bf16 v[72:75], v[64:67], v[4:7], 0
  v_smfmac_f32_16x16x64_bf16 v[92:95], v[76:79], v[104:111], v118
  s_nop 4
  v_cvt_pk_bf16_f32 v62, v72, v73
  v_cvt_pk_bf16_f32 v63, v74, v75
  s_nop 1
  v_mfma_f32_16x16x32_bf16 v[84:87], v[12:15], v[60:63], v[84:87]
  v_smfmac_f32_16x16x64_bf16 v[88:91], v[60:63], v[16:23], v118
  v_smfmac_f32_16x16x64_bf16 v[92:95], v[60:63], v[52:59], v118
  s_nop 1
  v_permlane32_swap_b32 v84, v86
  v_permlane32_swap_b32 v85, v87
  s_nop 0
  v_add_f32 v88, v88, v89
  v_add_f32_dpp v84, v86, v84 quad_perm:[1,0,3,2] row_mask:0xf bank_mask:0xf
  v_add_f32_dpp v85, v87, v85 quad_perm:[1,0,3,2] row_mask:0xf bank_mask:0xf
  v_add_f32 v89, v90, v91
  ds_write2_b32 v113, v84, v85 offset0:0 offset1:4
  ds_write2_b32 v112, v88, v89 offset0:0 offset1:128
  v_add_f32 v90, v92, v93
  v_add_f32 v91, v94, v95
  ds_write2_b32 v112, v90, v91 offset0:64 offset1:192
  v_cmp_u_f32 vcc, v88, v89
  s_cbranch_vccnz cA_sc1_retry
cA_sc1_cont:
  s_waitcnt lgkmcnt(0)
  s_barrier
  ds_read_b128 v[36:39], v114
  ds_read_b128 v[44:47], v115
  s_waitcnt lgkmcnt(0)
  v_add_f32 v36, v36, v38
  v_add_f32 v37, v37, v39
  v_add_f32 v44, v44, v45
  v_add_f32 v46, v46, v47
  v_add_f32 v44, v44, v46
  v_add_f32 v36, v36, v37
  v_exp_f32 v49, v44
  v_exp_f32 v48, v36
  v_add_f32 v50, abs(v36), abs(v44)
  v_fma_f32 v39, v49, s37, v48
  v_cmp_ngt_f32 vcc, s56, v50
  v_cndmask_b32 v41, v48, v49, s[38:39]
  v_add_f32_dpp v39, v39, v39 quad_perm:[1,0,3,2] row_mask:0xf bank_mask:0xf
  v_cndmask_b32 v40, v49, v48, s[38:39]
  v_mov_b32_dpp v46, v41 quad_perm:[1,0,3,2] row_mask:0xf bank_mask:0xf
  v_add_f32_dpp v39, v39, v39 quad_perm:[2,3,0,1] row_mask:0xf bank_mask:0xf
  v_cndmask_b32 v42, v46, v40, s[38:39]
  v_cndmask_b32 v43, v40, v46, s[38:39]
  v_add_f32_dpp v39, v39, v39 row_half_mirror row_mask:0xf bank_mask:0xf
  s_cbranch_vccnz cA_sc1_slow
  s_nop 0
  v_add_f32_dpp v47, v39, v39 row_mirror row_mask:0xf bank_mask:0xf
  v_add_f32_dpp v39, v39, v39 row_mirror row_mask:0xf bank_mask:0xf
  s_nop 1
  v_permlane16_swap_b32 v39, v47
  v_add_f32 v39, v39, v47
  v_rcp_f32 v39, v39
  s_mov_b64 exec, s[28:29]
  v_mul_f32 v42, v42, v39
  v_mul_f32 v43, v43, v39
  v_cvt_pk_bf16_f32 v42, v42, v43
cA_sc1_pst:
  buffer_store_dword v42, v1, s[8:11], s20 offen
  s_mov_b64 exec, -1
  s_barrier
  s_add_u32 s24, s24, 28672
  s_add_u32 s35, s35, 28672
  s_xor_b32 s25, s25, 28672
  s_add_u32 m0, s25, 7168
  s_add_u32 m0, s25, 11264
  s_add_u32 s22, s24, 4096
  buffer_load_dwordx4 v2, s[8:11], s22 offen offset:0 sc1 lds
  s_nop 5
  buffer_load_dwordx4 v2, s[8:11], s22 offen offset:1024 sc1 lds
  s_nop 5
  buffer_load_dwordx4 v2, s[8:11], s22 offen offset:2048 sc1 lds
  s_nop 5
  v_xor_b32 v116, 28672, v116
  v_add_u32 v117, s57, v117
  s_sub_u32 s57, 0, s57
  s_add_u32 s19, s19, 1
  s_mov_b32 s20, s21
  s_cmp_lt_u32 s19, 63
  s_cbranch_scc1 cA_sc1_loop
  s_branch cA_done
cA_sc1_slow:
  v_max_f32 v50, v36, v44
  s_nop 1
  v_max_f32_dpp v50, v50, v50 quad_perm:[1,0,3,2] row_mask:0xf bank_mask:0xf
  s_nop 1
  v_max_f32_dpp v50, v50, v50 quad_perm:[2,3,0,1] row_mask:0xf bank_mask:0xf
  s_nop 1
  v_max_f32_dpp v50, v50, v50 row_half_mirror row_mask:0xf bank_mask:0xf
  s_nop 1
  v_max_f32_dpp v50, v50, v50 row_mirror row_mask:0xf bank_mask:0xf
  v_mov_b32 v47, v50
  s_nop 1
  v_permlane16_swap_b32 v50, v47
  v_max_f32 v50, v50, v47
  v_sub_f32 v48, v36, v50
  v_sub_f32 v49, v44, v50
  v_exp_f32 v48, v48
  v_exp_f32 v49, v49
  s_add_u32 s31, s31, 0x100
  v_fma_f32 v39, v49, s37, v48
  v_cndmask_b32 v41, v48, v49, s[38:39]
  s_nop 0
  v_add_f32_dpp v39, v39, v39 quad_perm:[1,0,3,2] row_mask:0xf bank_mask:0xf
  v_cndmask_b32 v40, v49, v48, s[38:39]
  v_mov_b32_dpp v46, v41 quad_perm:[1,0,3,2] row_mask:0xf bank_mask:0xf
  v_add_f32_dpp v39, v39, v39 quad_perm:[2,3,0,1] row_mask:0xf bank_mask:0xf
  v_cndmask_b32 v42, v46, v40, s[38:39]
  v_cndmask_b32 v43, v40, v46, s[38:39]
  v_add_f32_dpp v39, v39, v39 row_half_mirror row_mask:0xf bank_mask:0xf
  s_nop 1
  v_add_f32_dpp v47, v39, v39 row_mirror row_mask:0xf bank_mask:0xf
  v_add_f32_dpp v39, v39, v39 row_mirror row_mask:0xf bank_mask:0xf
  s_nop 1
  v_permlane16_swap_b32 v39, v47
  v_add_f32 v39, v39, v47
  v_rcp_f32 v39, v39
  s_mov_b64 exec, s[28:29]
  v_mul_f32 v42, v42, v39
  v_mul_f32 v43, v43, v39
  v_cvt_pk_bf16_f32 v42, v42, v43
  v_min_u32 v42, -2, v42
  s_branch cA_sc1_pst
cA_sc1_retry:
  s_cmp_lg_u32 s62, 0
  s_cbranch_scc1 cA_sc1_cont
  s_waitcnt vmcnt(0) lgkmcnt(0)
cA_sc1_rv:
  buffer_load_dwordx4 v[8:11], v2, s[8:11], s20 offen offset:0 sc1
  buffer_load_dwordx4 v[12:15], v2, s[8:11], s20 offen offset:1024 sc1
  buffer_load_dwordx4 v[16:19], v2, s[8:11], s20 offen offset:2048 sc1
  buffer_load_dwordx4 v[20:23], v2, s[8:11], s20 offen offset:3072 sc1
  buffer_load_dwordx4 v[24:27], v2, s[8:11], s23 offen offset:0 sc1
  buffer_load_dwordx4 v[28:31], v2, s[8:11], s23 offen offset:1024 sc1
  buffer_load_dwordx4 v[32:35], v2, s[8:11], s23 offen offset:2048 sc1
  s_waitcnt vmcnt(0)
  v_max3_u32 v68, v8, v9, v10
  v_max3_u32 v68, v68, v11, v12
  v_max3_u32 v68, v68, v13, v14
  v_max3_u32 v68, v68, v15, v16
  v_max3_u32 v68, v68, v17, v18
  v_max3_u32 v68, v68, v19, v20
  v_max3_u32 v68, v68, v21, v22
  v_max3_u32 v68, v68, v23, v24
  v_max3_u32 v68, v68, v25, v26
  v_max3_u32 v68, v68, v27, v28
  v_max3_u32 v68, v68, v29, v30
  v_max3_u32 v68, v68, v31, v32
  v_max3_u32 v68, v68, v33, v34
  v_max_u32 v68, v68, v35
  v_cmp_eq_u32 vcc, -1, v68
  s_cbranch_vccz cA_sc1_rk
  s_add_u32 s30, s30, 1
  s_cmp_lt_u32 s30, 400000
  s_cbranch_scc1 cA_sc1_rv
  s_branch cA_abort
cA_sc1_rk:
  s_mov_b32 s62, 1
  v_mov_b32 v36, 0
  v_mov_b32 v37, 0
  v_mov_b32 v38, 0
  v_mov_b32 v39, 0
  v_mov_b32 v40, 0
  v_mov_b32 v41, 0
  v_mov_b32 v42, 0
  v_mov_b32 v43, 0
  v_mov_b32 v44, 0
  v_mov_b32 v45, 0
  v_mov_b32 v46, 0
  v_mov_b32 v47, 0
  v_mov_b32 v48, 0
  v_mov_b32 v49, 0
  v_mov_b32 v50, 0
  v_mov_b32 v51, 0
  v_mov_b32 v52, 0
  v_mov_b32 v53, 0
  v_mov_b32 v54, 0
  v_mov_b32 v55, 0
  v_mov_b32 v56, 0
  v_mov_b32 v57, 0
  v_mov_b32 v58, 0
  v_mov_b32 v59, 0
  v_mov_b32 v60, 0
  v_mov_b32 v61, 0
  v_mov_b32 v62, 0
  v_mov_b32 v63, 0
  v_mov_b32 v88, 0
  v_mov_b32 v89, 0
  v_mov_b32 v90, 0
  v_mov_b32 v91, 0
  v_mov_b32 v92, 0
  v_mov_b32 v93, 0
  v_mov_b32 v94, 0
  v_mov_b32 v95, 0
  v_mov_b32 v64, 0
  v_mov_b32 v65, 0
  s_add_u32 s31, s31, 1
  ds_read_b128 v[96:99], v117 offset:0
  ds_read_b128 v[100:103], v117 offset:1024
  ds_read_b128 v[104:107], v117 offset:14336
  ds_read_b128 v[108:111], v117 offset:15360
  v_smfmac_f32_16x16x64_bf16 v[36:39], v[8:11], a[0:7], v3
  v_smfmac_f32_16x16x64_bf16 v[40:43], v[8:11], a[56:63], v3
  v_smfmac_f32_16x16x64_bf16 v[44:47], v[8:11], a[112:119], v3
  v_smfmac_f32_16x16x64_bf16 v[48:51], v[8:11], a[168:175], v3
  v_smfmac_f32_16x16x64_bf16 v[52:55], v[8:11], a[224:231], v3
  v_smfmac_f32_16x16x64_bf16 v[56:59], v[8:11], v[144:151], v3
  v_smfmac_f32_16x16x64_bf16 v[60:63], v[8:11], v[200:207], v3
  v_smfmac_f32_16x16x64_bf16 v[36:39], v[12:15], a[8:15], v3
  v_smfmac_f32_16x16x64_bf16 v[40:43], v[12:15], a[64:71], v3
  v_smfmac_f32_16x16x64_bf16 v[44:47], v[12:15], a[120:127], v3
  v_smfmac_f32_16x16x64_bf16 v[48:51], v[12:15], a[176:183], v3
  v_smfmac_f32_16x16x64_bf16 v[52:55], v[12:15], a[232:239], v3
  v_smfmac_f32_16x16x64_bf16 v[56:59], v[12:15], v[152:159], v3
  v_smfmac_f32_16x16x64_bf16 v[60:63], v[12:15], v[208:215], v3
  v_smfmac_f32_16x16x64_bf16 v[36:39], v[16:19], a[16:23], v3
  v_smfmac_f32_16x16x64_bf16 v[40:43], v[16:19], a[72:79], v3
  v_smfmac_f32_16x16x64_bf16 v[44:47], v[16:19], a[128:135], v3
  v_smfmac_f32_16x16x64_bf16 v[48:51], v[16:19], a[184:191], v3
  v_smfmac_f32_16x16x64_bf16 v[52:55], v[16:19], a[240:247], v3
  v_smfmac_f32_16x16x64_bf16 v[56:59], v[16:19], v[160:167], v3
  v_smfmac_f32_16x16x64_bf16 v[60:63], v[16:19], v[216:223], v3
  v_smfmac_f32_16x16x64_bf16 v[36:39], v[20:23], a[24:31], v3
  v_smfmac_f32_16x16x64_bf16 v[40:43], v[20:23], a[80:87], v3
  v_smfmac_f32_16x16x64_bf16 v[44:47], v[20:23], a[136:143], v3
  v_smfmac_f32_16x16x64_bf16 v[48:51], v[20:23], a[192:199], v3
  v_smfmac_f32_16x16x64_bf16 v[52:55], v[20:23], a[248:255], v3
  v_smfmac_f32_16x16x64_bf16 v[56:59], v[20:23], v[168:175], v3
  v_smfmac_f32_16x16x64_bf16 v[60:63], v[20:23], v[224:231], v3
  s_xor_b32 s58, s25, 28672
  s_add_u32 s59, s24, 28672
  s_add_u32 m0, s58, 7168
  s_branch cA_sc1_ph2
.p2align 6

cA_sc2_loop:
  s_add_u32 s23, s20, 4096
  s_add_u32 s21, s20, 20480
  v_mov_b32 v48, 0
  v_mov_b32 v49, 0
  v_mov_b32 v50, 0
  v_mov_b32 v51, 0
  v_mov_b32 v52, 0
  v_mov_b32 v53, 0
  v_mov_b32 v54, 0
  v_mov_b32 v55, 0
  v_mov_b32 v56, 0
  v_mov_b32 v57, 0
  v_mov_b32 v58, 0
  v_mov_b32 v59, 0
  v_mov_b32 v60, 0
  v_mov_b32 v61, 0
  v_mov_b32 v62, 0
  v_mov_b32 v63, 0
  v_mov_b32 v88, 0
  v_mov_b32 v89, 0
  v_mov_b32 v90, 0
  v_mov_b32 v91, 0
  v_mov_b32 v92, 0
  v_mov_b32 v93, 0
  v_mov_b32 v94, 0
  v_mov_b32 v95, 0
  v_mov_b32 v66, 0
  v_mov_b32 v67, 0
  s_mov_b32 s30, 0
  s_mov_b32 s62, 0
  s_waitcnt vmcnt(0)
  s_barrier
cA_sc2_ld:
  buffer_load_dwordx4 v[8:11], v2, s[8:11], s20 offen offset:0
  v_mov_b32 v36, 0
  v_mov_b32 v37, 0
  v_mov_b32 v38, 0
  v_mov_b32 v39, 0
  buffer_load_dwordx4 v[12:15], v2, s[8:11], s20 offen offset:1024
  v_mov_b32 v40, 0
  v_mov_b32 v41, 0
  v_mov_b32 v42, 0
  v_mov_b32 v43, 0
  buffer_load_dwordx4 v[16:19], v2, s[8:11], s20 offen offset:2048
  v_mov_b32 v44, 0
  v_mov_b32 v45, 0
  v_mov_b32 v46, 0
  v_mov_b32 v47, 0
  ds_read_b128 v[96:99], v117 offset:0
  ds_read_b128 v[100:103], v117 offset:1024
  ds_read_b128 v[104:107], v117 offset:14336
  ds_read_b128 v[108:111], v117 offset:15360
  s_waitcnt vmcnt(2)
  v_smfmac_f32_16x16x64_bf16 v[36:39], v[8:11], a[0:7], v3
  v_smfmac_f32_16x16x64_bf16 v[40:43], v[8:11], a[56:63], v3
  buffer_load_dwordx4 v[20:23], v2, s[8:11], s20 offen offset:3072
  v_smfmac_f32_16x16x64_bf16 v[44:47], v[8:11], a[112:119], v3
  v_smfmac_f32_16x16x64_bf16 v[48:51], v[8:11], a[168:175], v3
  v_smfmac_f32_16x16x64_bf16 v[52:55], v[8:11], a[224:231], v3
  buffer_load_dwordx4 v[24:27], v2, s[8:11], s23 offen offset:0
  v_smfmac_f32_16x16x64_bf16 v[56:59], v[8:11], v[144:151], v3
  v_smfmac_f32_16x16x64_bf16 v[60:63], v[8:11], v[200:207], v3
  s_waitcnt vmcnt(3)
  v_smfmac_f32_16x16x64_bf16 v[36:39], v[12:15], a[8:15], v3
  v_smfmac_f32_16x16x64_bf16 v[40:43], v[12:15], a[64:71], v3
  buffer_load_dwordx4 v[28:31], v2, s[8:11], s23 offen offset:1024
  v_smfmac_f32_16x16x64_bf16 v[44:47], v[12:15], a[120:127], v3
  v_smfmac_f32_16x16x64_bf16 v[48:51], v[12:15], a[176:183], v3
  v_smfmac_f32_16x16x64_bf16 v[52:55], v[12:15], a[232:239], v3
  buffer_load_dwordx4 v[32:35], v2, s[8:11], s23 offen offset:2048
  v_smfmac_f32_16x16x64_bf16 v[56:59], v[12:15], v[152:159], v3
  v_smfmac_f32_16x16x64_bf16 v[60:63], v[12:15], v[208:215], v3
  s_waitcnt vmcnt(4)
  v_smfmac_f32_16x16x64_bf16 v[36:39], v[16:19], a[16:23], v3
  v_smfmac_f32_16x16x64_bf16 v[40:43], v[16:19], a[72:79], v3
  s_xor_b32 s58, s25, 28672
  s_add_u32 s59, s24, 28672
  s_add_u32 m0, s58, 14336
  v_smfmac_f32_16x16x64_bf16 v[44:47], v[16:19], a[128:135], v3
  buffer_load_dwordx4 v2, s[8:11], s59 offen offset:0 sc1 lds
  v_smfmac_f32_16x16x64_bf16 v[48:51], v[16:19], a[184:191], v3
  v_smfmac_f32_16x16x64_bf16 v[52:55], v[16:19], a[240:247], v3
  v_smfmac_f32_16x16x64_bf16 v[56:59], v[16:19], v[160:167], v3
  v_smfmac_f32_16x16x64_bf16 v[60:63], v[16:19], v[216:223], v3
  buffer_load_dwordx4 v2, s[8:11], s59 offen offset:1024 sc1 lds
  s_waitcnt vmcnt(5)
  v_smfmac_f32_16x16x64_bf16 v[36:39], v[20:23], a[24:31], v3
  v_smfmac_f32_16x16x64_bf16 v[40:43], v[20:23], a[80:87], v3
  v_smfmac_f32_16x16x64_bf16 v[44:47], v[20:23], a[136:143], v3
  v_smfmac_f32_16x16x64_bf16 v[48:51], v[20:23], a[192:199], v3
  buffer_load_dwordx4 v2, s[8:11], s59 offen offset:2048 sc1 lds
  v_smfmac_f32_16x16x64_bf16 v[52:55], v[20:23], a[248:255], v3
  v_smfmac_f32_16x16x64_bf16 v[56:59], v[20:23], v[168:175], v3
  v_smfmac_f32_16x16x64_bf16 v[60:63], v[20:23], v[224:231], v3
  s_waitcnt vmcnt(3)
cA_sc2_ph2:
  v_smfmac_f32_16x16x64_bf16 v[60:63], v[24:27], v[232:239], v3
  buffer_load_dwordx4 v2, s[8:11], s59 offen offset:3072 sc1 lds
  ds_read_b128 v[8:11], v116 offset:4096
  ds_read_b128 v[12:15], v116 offset:5120
  v_smfmac_f32_16x16x64_bf16 v[60:63], v[28:31], v[240:247], v3
  buffer_load_dword v119, v0, s[8:11], s24 offen sc1
  v_smfmac_f32_16x16x64_bf16 v[60:63], v[32:35], v[248:255], v3
  v_mov_b32 v80, v28
  v_smfmac_f32_16x16x64_bf16 v[52:55], v[24:27], v[120:127], v3
  v_mov_b32 v81, v29
  v_smfmac_f32_16x16x64_bf16 v[52:55], v[28:31], v[128:135], v3
  v_mov_b32 v82, v34
  v_smfmac_f32_16x16x64_bf16 v[52:55], v[32:35], v[136:143], v3
  v_cvt_pk_bf16_f32 v64, v60, v61
  v_smfmac_f32_16x16x64_bf16 v[56:59], v[24:27], v[176:183], v3
  v_cvt_pk_bf16_f32 v65, v62, v63
  v_smfmac_f32_16x16x64_bf16 v[56:59], v[28:31], v[184:191], v3
  v_mov_b32 v83, v35
  v_mfma_f32_16x16x32_bf16 v[68:71], v[64:67], v[4:7], 0
  v_smfmac_f32_16x16x64_bf16 v[56:59], v[32:35], v[192:199], v3
  v_cvt_pk_bf16_f32 v64, v52, v53
  v_smfmac_f32_16x16x64_bf16 v[36:39], v[24:27], a[32:39], v3
  v_cvt_pk_bf16_f32 v65, v54, v55
  v_smfmac_f32_16x16x64_bf16 v[36:39], v[28:31], a[40:47], v3
  v_cvt_pk_bf16_f32 v78, v68, v69
  v_smfmac_f32_16x16x64_bf16 v[36:39], v[32:35], a[48:55], v3
  v_cvt_pk_bf16_f32 v79, v70, v71
  v_cvt_pk_bf16_f32 v66, v56, v57
  v_smfmac_f32_16x16x64_bf16 v[40:43], v[24:27], a[88:95], v3
  v_cvt_pk_bf16_f32 v67, v58, v59
  v_smfmac_f32_16x16x64_bf16 v[40:43], v[28:31], a[96:103], v3
  v_mfma_f32_16x16x32_bf16 v[72:75], v[64:67], v[4:7], 0
  ds_read_b128 v[52:55], v116 offset:18432
  ds_read_b128 v[56:59], v116 offset:19456
  v_smfmac_f32_16x16x64_bf16 v[40:43], v[32:35], a[104:111], v3
  v_cvt_pk_bf16_f32 v64, v36, v37
  v_smfmac_f32_16x16x64_bf16 v[44:47], v[24:27], a[144:151], v3
  v_cvt_pk_bf16_f32 v65, v38, v39
  v_smfmac_f32_16x16x64_bf16 v[44:47], v[28:31], a[152:159], v3
  v_cvt_pk_bf16_f32 v76, v72, v73
  v_smfmac_f32_16x16x64_bf16 v[44:47], v[32:35], a[160:167], v3
  v_cvt_pk_bf16_f32 v77, v74, v75
  v_cvt_pk_bf16_f32 v66, v40, v41
  v_smfmac_f32_16x16x64_bf16 v[48:51], v[24:27], a[200:207], v3
  v_cvt_pk_bf16_f32 v67, v42, v43
  v_smfmac_f32_16x16x64_bf16 v[48:51], v[28:31], a[208:215], v3
  v_mfma_f32_16x16x32_bf16 v[68:71], v[64:67], v[4:7], 0
  v_smfmac_f32_16x16x64_bf16 v[48:51], v[32:35], a[216:223], v3
  v_cvt_pk_bf16_f32 v64, v44, v45
  v_mfma_f32_16x16x32_bf16 v[84:87], v[80:83], v[76:79], 0
  v_cvt_pk_bf16_f32 v65, v46, v47
  s_waitcnt lgkmcnt(0)
  v_smfmac_f32_16x16x64_bf16 v[88:91], v[76:79], v[96:103], v118
  v_cvt_pk_bf16_f32 v60, v68, v69
  v_cvt_pk_bf16_f32 v61, v70, v71
  v_cvt_pk_bf16_f32 v66, v48, v49
  v_cvt_pk_bf16_f32 v67, v50, v51
  s_nop 1
  v_mfma_f32_16x16x32_bf16 v[72:75], v[64:67], v[4:7], 0
  v_smfmac_f32_16x16x64_bf16 v[92:95], v[76:79], v[104:111], v118
  s_nop 4
  v_cvt_pk_bf16_f32 v62, v72, v73
  v_cvt_pk_bf16_f32 v63, v74, v75
  s_nop 1
  v_mfma_f32_16x16x32_bf16 v[84:87], v[16:19], v[60:63], v[84:87]
  v_smfmac_f32_16x16x64_bf16 v[88:91], v[60:63], v[8:15], v118
  v_smfmac_f32_16x16x64_bf16 v[92:95], v[60:63], v[52:59], v118
  s_nop 1
  v_permlane32_swap_b32 v84, v86
  v_permlane32_swap_b32 v85, v87
  s_nop 0
  v_add_f32 v88, v88, v89
  v_add_f32_dpp v84, v86, v84 quad_perm:[1,0,3,2] row_mask:0xf bank_mask:0xf
  v_add_f32_dpp v85, v87, v85 quad_perm:[1,0,3,2] row_mask:0xf bank_mask:0xf
  v_add_f32 v89, v90, v91
  ds_write2_b32 v113, v84, v85 offset0:0 offset1:4
  ds_write2_b32 v112, v88, v89 offset0:0 offset1:128
  v_add_f32 v90, v92, v93
  v_add_f32 v91, v94, v95
  ds_write2_b32 v112, v90, v91 offset0:64 offset1:192
  v_cmp_u_f32 vcc, v88, v89
  s_cbranch_vccnz cA_sc2_retry
cA_sc2_cont:
  s_waitcnt lgkmcnt(0)
  s_barrier
  ds_read_b128 v[36:39], v114
  ds_read_b128 v[44:47], v115
  s_waitcnt lgkmcnt(0)
  v_add_f32 v36, v36, v38
  v_add_f32 v37, v37, v39
  v_add_f32 v44, v44, v45
  v_add_f32 v46, v46, v47
  v_add_f32 v44, v44, v46
  v_add_f32 v36, v36, v37
  v_exp_f32 v49, v44
  v_exp_f32 v48, v36
  v_add_f32 v50, abs(v36), abs(v44)
  v_fma_f32 v39, v49, s37, v48
  v_cmp_ngt_f32 vcc, s56, v50
  v_cndmask_b32 v41, v48, v49, s[38:39]
  v_add_f32_dpp v39, v39, v39 quad_perm:[1,0,3,2] row_mask:0xf bank_mask:0xf
  v_cndmask_b32 v40, v49, v48, s[38:39]
  v_mov_b32_dpp v46, v41 quad_perm:[1,0,3,2] row_mask:0xf bank_mask:0xf
  v_add_f32_dpp v39, v39, v39 quad_perm:[2,3,0,1] row_mask:0xf bank_mask:0xf
  v_cndmask_b32 v42, v46, v40, s[38:39]
  v_cndmask_b32 v43, v40, v46, s[38:39]
  v_add_f32_dpp v39, v39, v39 row_half_mirror row_mask:0xf bank_mask:0xf
  s_cbranch_vccnz cA_sc2_slow
  s_nop 0
  v_add_f32_dpp v47, v39, v39 row_mirror row_mask:0xf bank_mask:0xf
  v_add_f32_dpp v39, v39, v39 row_mirror row_mask:0xf bank_mask:0xf
  s_nop 1
  v_permlane16_swap_b32 v39, v47
  v_add_f32 v39, v39, v47
  v_rcp_f32 v39, v39
  s_mov_b64 exec, s[28:29]
  v_mul_f32 v42, v42, v39
  v_mul_f32 v43, v43, v39
  v_cvt_pk_bf16_f32 v42, v42, v43
cA_sc2_pst:
  buffer_store_dword v42, v1, s[8:11], s20 offen
  s_mov_b64 exec, -1
  s_barrier
  s_add_u32 s24, s24, 28672
  s_add_u32 s35, s35, 28672
  s_xor_b32 s25, s25, 28672
  s_add_u32 m0, s25, 14336
  s_add_u32 m0, s25, 18432
  s_add_u32 s22, s24, 4096
  buffer_load_dwordx4 v2, s[8:11], s22 offen offset:0 sc1 lds
  s_nop 5
  buffer_load_dwordx4 v2, s[8:11], s22 offen offset:1024 sc1 lds
  s_nop 5
  buffer_load_dwordx4 v2, s[8:11], s22 offen offset:2048 sc1 lds
  s_nop 5
  v_xor_b32 v116, 28672, v116
  v_add_u32 v117, s57, v117
  s_sub_u32 s57, 0, s57
  s_add_u32 s19, s19, 1
  s_mov_b32 s20, s21
  s_cmp_lt_u32 s19, 63
  s_cbranch_scc1 cA_sc2_loop
  s_branch cA_done
cA_sc2_slow:
  v_max_f32 v50, v36, v44
  s_nop 1
  v_max_f32_dpp v50, v50, v50 quad_perm:[1,0,3,2] row_mask:0xf bank_mask:0xf
  s_nop 1
  v_max_f32_dpp v50, v50, v50 quad_perm:[2,3,0,1] row_mask:0xf bank_mask:0xf
  s_nop 1
  v_max_f32_dpp v50, v50, v50 row_half_mirror row_mask:0xf bank_mask:0xf
  s_nop 1
  v_max_f32_dpp v50, v50, v50 row_mirror row_mask:0xf bank_mask:0xf
  v_mov_b32 v47, v50
  s_nop 1
  v_permlane16_swap_b32 v50, v47
  v_max_f32 v50, v50, v47
  v_sub_f32 v48, v36, v50
  v_sub_f32 v49, v44, v50
  v_exp_f32 v48, v48
  v_exp_f32 v49, v49
  s_add_u32 s31, s31, 0x100
  v_fma_f32 v39, v49, s37, v48
  v_cndmask_b32 v41, v48, v49, s[38:39]
  s_nop 0
  v_add_f32_dpp v39, v39, v39 quad_perm:[1,0,3,2] row_mask:0xf bank_mask:0xf
  v_cndmask_b32 v40, v49, v48, s[38:39]
  v_mov_b32_dpp v46, v41 quad_perm:[1,0,3,2] row_mask:0xf bank_mask:0xf
  v_add_f32_dpp v39, v39, v39 quad_perm:[2,3,0,1] row_mask:0xf bank_mask:0xf
  v_cndmask_b32 v42, v46, v40, s[38:39]
  v_cndmask_b32 v43, v40, v46, s[38:39]
  v_add_f32_dpp v39, v39, v39 row_half_mirror row_mask:0xf bank_mask:0xf
  s_nop 1
  v_add_f32_dpp v47, v39, v39 row_mirror row_mask:0xf bank_mask:0xf
  v_add_f32_dpp v39, v39, v39 row_mirror row_mask:0xf bank_mask:0xf
  s_nop 1
  v_permlane16_swap_b32 v39, v47
  v_add_f32 v39, v39, v47
  v_rcp_f32 v39, v39
  s_mov_b64 exec, s[28:29]
  v_mul_f32 v42, v42, v39
  v_mul_f32 v43, v43, v39
  v_cvt_pk_bf16_f32 v42, v42, v43
  v_min_u32 v42, -2, v42
  s_branch cA_sc2_pst
cA_sc2_retry:
  s_cmp_lg_u32 s62, 0
  s_cbranch_scc1 cA_sc2_cont
  s_waitcnt vmcnt(0) lgkmcnt(0)
cA_sc2_rv:
  buffer_load_dwordx4 v[8:11], v2, s[8:11], s20 offen offset:0 sc1
  buffer_load_dwordx4 v[12:15], v2, s[8:11], s20 offen offset:1024 sc1
  buffer_load_dwordx4 v[16:19], v2, s[8:11], s20 offen offset:2048 sc1
  buffer_load_dwordx4 v[20:23], v2, s[8:11], s20 offen offset:3072 sc1
  buffer_load_dwordx4 v[24:27], v2, s[8:11], s23 offen offset:0 sc1
  buffer_load_dwordx4 v[28:31], v2, s[8:11], s23 offen offset:1024 sc1
  buffer_load_dwordx4 v[32:35], v2, s[8:11], s23 offen offset:2048 sc1
  s_waitcnt vmcnt(0)
  v_max3_u32 v68, v8, v9, v10
  v_max3_u32 v68, v68, v11, v12
  v_max3_u32 v68, v68, v13, v14
  v_max3_u32 v68, v68, v15, v16
  v_max3_u32 v68, v68, v17, v18
  v_max3_u32 v68, v68, v19, v20
  v_max3_u32 v68, v68, v21, v22
  v_max3_u32 v68, v68, v23, v24
  v_max3_u32 v68, v68, v25, v26
  v_max3_u32 v68, v68, v27, v28
  v_max3_u32 v68, v68, v29, v30
  v_max3_u32 v68, v68, v31, v32
  v_max3_u32 v68, v68, v33, v34
  v_max_u32 v68, v68, v35
  v_cmp_eq_u32 vcc, -1, v68
  s_cbranch_vccz cA_sc2_rk
  s_add_u32 s30, s30, 1
  s_cmp_lt_u32 s30, 400000
  s_cbranch_scc1 cA_sc2_rv
  s_branch cA_abort
cA_sc2_rk:
  s_mov_b32 s62, 1
  v_mov_b32 v36, 0
  v_mov_b32 v37, 0
  v_mov_b32 v38, 0
  v_mov_b32 v39, 0
  v_mov_b32 v40, 0
  v_mov_b32 v41, 0
  v_mov_b32 v42, 0
  v_mov_b32 v43, 0
  v_mov_b32 v44, 0
  v_mov_b32 v45, 0
  v_mov_b32 v46, 0
  v_mov_b32 v47, 0
  v_mov_b32 v48, 0
  v_mov_b32 v49, 0
  v_mov_b32 v50, 0
  v_mov_b32 v51, 0
  v_mov_b32 v52, 0
  v_mov_b32 v53, 0
  v_mov_b32 v54, 0
  v_mov_b32 v55, 0
  v_mov_b32 v56, 0
  v_mov_b32 v57, 0
  v_mov_b32 v58, 0
  v_mov_b32 v59, 0
  v_mov_b32 v60, 0
  v_mov_b32 v61, 0
  v_mov_b32 v62, 0
  v_mov_b32 v63, 0
  v_mov_b32 v88, 0
  v_mov_b32 v89, 0
  v_mov_b32 v90, 0
  v_mov_b32 v91, 0
  v_mov_b32 v92, 0
  v_mov_b32 v93, 0
  v_mov_b32 v94, 0
  v_mov_b32 v95, 0
  v_mov_b32 v66, 0
  v_mov_b32 v67, 0
  s_add_u32 s31, s31, 1
  ds_read_b128 v[96:99], v117 offset:0
  ds_read_b128 v[100:103], v117 offset:1024
  ds_read_b128 v[104:107], v117 offset:14336
  ds_read_b128 v[108:111], v117 offset:15360
  v_smfmac_f32_16x16x64_bf16 v[36:39], v[8:11], a[0:7], v3
  v_smfmac_f32_16x16x64_bf16 v[40:43], v[8:11], a[56:63], v3
  v_smfmac_f32_16x16x64_bf16 v[44:47], v[8:11], a[112:119], v3
  v_smfmac_f32_16x16x64_bf16 v[48:51], v[8:11], a[168:175], v3
  v_smfmac_f32_16x16x64_bf16 v[52:55], v[8:11], a[224:231], v3
  v_smfmac_f32_16x16x64_bf16 v[56:59], v[8:11], v[144:151], v3
  v_smfmac_f32_16x16x64_bf16 v[60:63], v[8:11], v[200:207], v3
  v_smfmac_f32_16x16x64_bf16 v[36:39], v[12:15], a[8:15], v3
  v_smfmac_f32_16x16x64_bf16 v[40:43], v[12:15], a[64:71], v3
  v_smfmac_f32_16x16x64_bf16 v[44:47], v[12:15], a[120:127], v3
  v_smfmac_f32_16x16x64_bf16 v[48:51], v[12:15], a[176:183], v3
  v_smfmac_f32_16x16x64_bf16 v[52:55], v[12:15], a[232:239], v3
  v_smfmac_f32_16x16x64_bf16 v[56:59], v[12:15], v[152:159], v3
  v_smfmac_f32_16x16x64_bf16 v[60:63], v[12:15], v[208:215], v3
  v_smfmac_f32_16x16x64_bf16 v[36:39], v[16:19], a[16:23], v3
  v_smfmac_f32_16x16x64_bf16 v[40:43], v[16:19], a[72:79], v3
  v_smfmac_f32_16x16x64_bf16 v[44:47], v[16:19], a[128:135], v3
  v_smfmac_f32_16x16x64_bf16 v[48:51], v[16:19], a[184:191], v3
  v_smfmac_f32_16x16x64_bf16 v[52:55], v[16:19], a[240:247], v3
  v_smfmac_f32_16x16x64_bf16 v[56:59], v[16:19], v[160:167], v3
  v_smfmac_f32_16x16x64_bf16 v[60:63], v[16:19], v[216:223], v3
  v_smfmac_f32_16x16x64_bf16 v[36:39], v[20:23], a[24:31], v3
  v_smfmac_f32_16x16x64_bf16 v[40:43], v[20:23], a[80:87], v3
  v_smfmac_f32_16x16x64_bf16 v[44:47], v[20:23], a[136:143], v3
  v_smfmac_f32_16x16x64_bf16 v[48:51], v[20:23], a[192:199], v3
  v_smfmac_f32_16x16x64_bf16 v[52:55], v[20:23], a[248:255], v3
  v_smfmac_f32_16x16x64_bf16 v[56:59], v[20:23], v[168:175], v3
  v_smfmac_f32_16x16x64_bf16 v[60:63], v[20:23], v[224:231], v3
  s_xor_b32 s58, s25, 28672
  s_add_u32 s59, s24, 28672
  s_add_u32 m0, s58, 14336
  s_branch cA_sc2_ph2
.p2align 6

cA_sc3_loop:
  s_add_u32 s23, s20, 4096
  s_add_u32 s21, s20, 20480
  v_mov_b32 v48, 0
  v_mov_b32 v49, 0
  v_mov_b32 v50, 0
  v_mov_b32 v51, 0
  v_mov_b32 v52, 0
  v_mov_b32 v53, 0
  v_mov_b32 v54, 0
  v_mov_b32 v55, 0
  v_mov_b32 v56, 0
  v_mov_b32 v57, 0
  v_mov_b32 v58, 0
  v_mov_b32 v59, 0
  v_mov_b32 v60, 0
  v_mov_b32 v61, 0
  v_mov_b32 v62, 0
  v_mov_b32 v63, 0
  v_mov_b32 v88, 0
  v_mov_b32 v89, 0
  v_mov_b32 v90, 0
  v_mov_b32 v91, 0
  v_mov_b32 v92, 0
  v_mov_b32 v93, 0
  v_mov_b32 v94, 0
  v_mov_b32 v95, 0
  v_mov_b32 v64, 0
  v_mov_b32 v65, 0
  s_mov_b32 s30, 0
  s_mov_b32 s62, 0
  s_waitcnt vmcnt(0)
  s_barrier
cA_sc3_ld:
  buffer_load_dwordx4 v[8:11], v2, s[8:11], s20 offen offset:0
  v_mov_b32 v36, 0
  v_mov_b32 v37, 0
  v_mov_b32 v38, 0
  v_mov_b32 v39, 0
  buffer_load_dwordx4 v[12:15], v2, s[8:11], s20 offen offset:1024
  v_mov_b32 v40, 0
  v_mov_b32 v41, 0
  v_mov_b32 v42, 0
  v_mov_b32 v43, 0
  buffer_load_dwordx4 v[16:19], v2, s[8:11], s20 offen offset:2048
  v_mov_b32 v44, 0
  v_mov_b32 v45, 0
  v_mov_b32 v46, 0
  v_mov_b32 v47, 0
  ds_read_b128 v[96:99], v117 offset:0
  ds_read_b128 v[100:103], v117 offset:1024
  ds_read_b128 v[104:107], v117 offset:14336
  ds_read_b128 v[108:111], v117 offset:15360
  s_waitcnt vmcnt(2)
  v_smfmac_f32_16x16x64_bf16 v[36:39], v[8:11], a[0:7], v3
  v_smfmac_f32_16x16x64_bf16 v[40:43], v[8:11], a[56:63], v3
  buffer_load_dwordx4 v[20:23], v2, s[8:11], s20 offen offset:3072
  v_smfmac_f32_16x16x64_bf16 v[44:47], v[8:11], a[112:119], v3
  v_smfmac_f32_16x16x64_bf16 v[48:51], v[8:11], a[168:175], v3
  v_smfmac_f32_16x16x64_bf16 v[52:55], v[8:11], a[224:231], v3
  buffer_load_dwordx4 v[24:27], v2, s[8:11], s23 offen offset:0
  v_smfmac_f32_16x16x64_bf16 v[56:59], v[8:11], v[144:151], v3
  v_smfmac_f32_16x16x64_bf16 v[60:63], v[8:11], v[200:207], v3
  s_waitcnt vmcnt(3)
  v_smfmac_f32_16x16x64_bf16 v[36:39], v[12:15], a[8:15], v3
  v_smfmac_f32_16x16x64_bf16 v[40:43], v[12:15], a[64:71], v3
  buffer_load_dwordx4 v[28:31], v2, s[8:11], s23 offen offset:1024
  v_smfmac_f32_16x16x64_bf16 v[44:47], v[12:15], a[120:127], v3
  v_smfmac_f32_16x16x64_bf16 v[48:51], v[12:15], a[176:183], v3
  v_smfmac_f32_16x16x64_bf16 v[52:55], v[12:15], a[232:239], v3
  buffer_load_dwordx4 v[32:35], v2, s[8:11], s23 offen offset:2048
  v_smfmac_f32_16x16x64_bf16 v[56:59], v[12:15], v[152:159], v3
  v_smfmac_f32_16x16x64_bf16 v[60:63], v[12:15], v[208:215], v3
  s_waitcnt vmcnt(4)
  v_smfmac_f32_16x16x64_bf16 v[36:39], v[16:19], a[16:23], v3
  v_smfmac_f32_16x16x64_bf16 v[40:43], v[16:19], a[72:79], v3
  v_smfmac_f32_16x16x64_bf16 v[44:47], v[16:19], a[128:135], v3
  s_xor_b32 s58, s25, 28672
  s_add_u32 s59, s24, 28672
  s_add_u32 m0, s58, 21504
  v_smfmac_f32_16x16x64_bf16 v[48:51], v[16:19], a[184:191], v3
  buffer_load_dwordx4 v2, s[8:11], s59 offen offset:0 sc1 lds
  v_smfmac_f32_16x16x64_bf16 v[52:55], v[16:19], a[240:247], v3
  v_smfmac_f32_16x16x64_bf16 v[56:59], v[16:19], v[160:167], v3
  v_smfmac_f32_16x16x64_bf16 v[60:63], v[16:19], v[216:223], v3
  s_waitcnt vmcnt(4)
  v_smfmac_f32_16x16x64_bf16 v[36:39], v[20:23], a[24:31], v3
  buffer_load_dwordx4 v2, s[8:11], s59 offen offset:1024 sc1 lds
  v_smfmac_f32_16x16x64_bf16 v[40:43], v[20:23], a[80:87], v3
  v_smfmac_f32_16x16x64_bf16 v[44:47], v[20:23], a[136:143], v3
  v_smfmac_f32_16x16x64_bf16 v[48:51], v[20:23], a[192:199], v3
  v_smfmac_f32_16x16x64_bf16 v[52:55], v[20:23], a[248:255], v3
  buffer_load_dwordx4 v2, s[8:11], s59 offen offset:2048 sc1 lds
  v_smfmac_f32_16x16x64_bf16 v[56:59], v[20:23], v[168:175], v3
  v_smfmac_f32_16x16x64_bf16 v[60:63], v[20:23], v[224:231], v3
  s_waitcnt vmcnt(3)
cA_sc3_ph2:
  v_smfmac_f32_16x16x64_bf16 v[60:63], v[24:27], v[232:239], v3
  ds_read_b128 v[8:11], v116 offset:6144
  ds_read_b128 v[12:15], v116 offset:7168
  v_smfmac_f32_16x16x64_bf16 v[60:63], v[28:31], v[240:247], v3
  buffer_load_dwordx4 v2, s[8:11], s59 offen offset:3072 sc1 lds
  v_smfmac_f32_16x16x64_bf16 v[60:63], v[32:35], v[248:255], v3
  v_mov_b32 v80, v30
  v_smfmac_f32_16x16x64_bf16 v[52:55], v[24:27], v[120:127], v3
  v_mov_b32 v81, v31
  v_smfmac_f32_16x16x64_bf16 v[52:55], v[28:31], v[128:135], v3
  v_mov_b32 v82, v34
  v_smfmac_f32_16x16x64_bf16 v[52:55], v[32:35], v[136:143], v3
  v_cvt_pk_bf16_f32 v66, v60, v61
  v_smfmac_f32_16x16x64_bf16 v[56:59], v[24:27], v[176:183], v3
  v_cvt_pk_bf16_f32 v67, v62, v63
  v_smfmac_f32_16x16x64_bf16 v[56:59], v[28:31], v[184:191], v3
  v_mov_b32 v83, v35
  v_mfma_f32_16x16x32_bf16 v[68:71], v[64:67], v[4:7], 0
  v_smfmac_f32_16x16x64_bf16 v[56:59], v[32:35], v[192:199], v3
  v_cvt_pk_bf16_f32 v64, v52, v53
  v_smfmac_f32_16x16x64_bf16 v[36:39], v[24:27], a[32:39], v3
  v_cvt_pk_bf16_f32 v65, v54, v55
  v_smfmac_f32_16x16x64_bf16 v[36:39], v[28:31], a[40:47], v3
  v_cvt_pk_bf16_f32 v78, v68, v69
  v_smfmac_f32_16x16x64_bf16 v[36:39], v[32:35], a[48:55], v3
  v_cvt_pk_bf16_f32 v79, v70, v71
  v_cvt_pk_bf16_f32 v66, v56, v57
  v_smfmac_f32_16x16x64_bf16 v[40:43], v[24:27], a[88:95], v3
  v_cvt_pk_bf16_f32 v67, v58, v59
  v_smfmac_f32_16x16x64_bf16 v[40:43], v[28:31], a[96:103], v3
  v_mfma_f32_16x16x32_bf16 v[72:75], v[64:67], v[4:7], 0
  ds_read_b128 v[52:55], v116 offset:20480
  ds_read_b128 v[56:59], v116 offset:21504
  v_smfmac_f32_16x16x64_bf16 v[40:43], v[32:35], a[104:111], v3
  v_cvt_pk_bf16_f32 v64, v36, v37
  v_smfmac_f32_16x16x64_bf16 v[44:47], v[24:27], a[144:151], v3
  v_cvt_pk_bf16_f32 v65, v38, v39
  v_smfmac_f32_16x16x64_bf16 v[44:47], v[28:31], a[152:159], v3
  v_cvt_pk_bf16_f32 v76, v72, v73
  v_smfmac_f32_16x16x64_bf16 v[44:47], v[32:35], a[160:167], v3
  v_cvt_pk_bf16_f32 v77, v74, v75
  v_cvt_pk_bf16_f32 v66, v40, v41
  v_smfmac_f32_16x16x64_bf16 v[48:51], v[24:27], a[200:207], v3
  v_cvt_pk_bf16_f32 v67, v42, v43
  v_smfmac_f32_16x16x64_bf16 v[48:51], v[28:31], a[208:215], v3
  v_mfma_f32_16x16x32_bf16 v[68:71], v[64:67], v[4:7], 0
  v_smfmac_f32_16x16x64_bf16 v[48:51], v[32:35], a[216:223], v3
  v_cvt_pk_bf16_f32 v64, v44, v45
  v_mfma_f32_16x16x32_bf16 v[84:87], v[80:83], v[76:79], 0
  v_cvt_pk_bf16_f32 v65, v46, v47
  s_waitcnt lgkmcnt(0)
  v_smfmac_f32_16x16x64_bf16 v[88:91], v[76:79], v[96:103], v118
  v_cvt_pk_bf16_f32 v60, v68, v69
  v_cvt_pk_bf16_f32 v61, v70, v71
  v_cvt_pk_bf16_f32 v66, v48, v49
  v_cvt_pk_bf16_f32 v67, v50, v51
  s_nop 1
  v_mfma_f32_16x16x32_bf16 v[72:75], v[64:67], v[4:7], 0
  v_smfmac_f32_16x16x64_bf16 v[92:95], v[76:79], v[104:111], v118
  s_nop 4
  v_cvt_pk_bf16_f32 v62, v72, v73
  v_cvt_pk_bf16_f32 v63, v74, v75
  s_nop 1
  v_mfma_f32_16x16x32_bf16 v[84:87], v[20:23], v[60:63], v[84:87]
  v_smfmac_f32_16x16x64_bf16 v[88:91], v[60:63], v[8:15], v118
  v_smfmac_f32_16x16x64_bf16 v[92:95], v[60:63], v[52:59], v118
  s_nop 1
  v_permlane32_swap_b32 v84, v86
  v_permlane32_swap_b32 v85, v87
  s_nop 0
  v_add_f32 v88, v88, v89
  v_add_f32_dpp v84, v86, v84 quad_perm:[1,0,3,2] row_mask:0xf bank_mask:0xf
  v_add_f32_dpp v85, v87, v85 quad_perm:[1,0,3,2] row_mask:0xf bank_mask:0xf
  v_add_f32 v89, v90, v91
  ds_write2_b32 v113, v84, v85 offset0:0 offset1:4
  ds_write2_b32 v112, v88, v89 offset0:0 offset1:128
  v_add_f32 v90, v92, v93
  v_add_f32 v91, v94, v95
  ds_write2_b32 v112, v90, v91 offset0:64 offset1:192
  v_cmp_u_f32 vcc, v88, v89
  s_cbranch_vccnz cA_sc3_retry
cA_sc3_cont:
  s_waitcnt lgkmcnt(0)
  s_barrier
  ds_read_b128 v[36:39], v114
  ds_read_b128 v[44:47], v115
  s_waitcnt lgkmcnt(0)
  v_add_f32 v36, v36, v38
  v_add_f32 v37, v37, v39
  v_add_f32 v44, v44, v45
  v_add_f32 v46, v46, v47
  v_add_f32 v44, v44, v46
  v_add_f32 v36, v36, v37
  v_exp_f32 v49, v44
  v_exp_f32 v48, v36
  v_add_f32 v50, abs(v36), abs(v44)
  v_fma_f32 v39, v49, s37, v48
  v_cmp_ngt_f32 vcc, s56, v50
  v_cndmask_b32 v41, v48, v49, s[38:39]
  v_add_f32_dpp v39, v39, v39 quad_perm:[1,0,3,2] row_mask:0xf bank_mask:0xf
  v_cndmask_b32 v40, v49, v48, s[38:39]
  v_mov_b32_dpp v46, v41 quad_perm:[1,0,3,2] row_mask:0xf bank_mask:0xf
  v_add_f32_dpp v39, v39, v39 quad_perm:[2,3,0,1] row_mask:0xf bank_mask:0xf
  v_cndmask_b32 v42, v46, v40, s[38:39]
  v_cndmask_b32 v43, v40, v46, s[38:39]
  v_add_f32_dpp v39, v39, v39 row_half_mirror row_mask:0xf bank_mask:0xf
  s_cbranch_vccnz cA_sc3_slow
  s_nop 0
  v_add_f32_dpp v47, v39, v39 row_mirror row_mask:0xf bank_mask:0xf
  v_add_f32_dpp v39, v39, v39 row_mirror row_mask:0xf bank_mask:0xf
  s_nop 1
  v_permlane16_swap_b32 v39, v47
  v_add_f32 v39, v39, v47
  v_rcp_f32 v39, v39
  s_mov_b64 exec, s[28:29]
  v_mul_f32 v42, v42, v39
  v_mul_f32 v43, v43, v39
  v_cvt_pk_bf16_f32 v42, v42, v43
cA_sc3_pst:
  buffer_store_dword v42, v1, s[8:11], s20 offen
  s_mov_b64 exec, -1
  s_barrier
  s_add_u32 s24, s24, 28672
  s_add_u32 s35, s35, 28672
  s_xor_b32 s25, s25, 28672
  s_add_u32 m0, s25, 21504
  s_add_u32 m0, s25, 25600
  s_add_u32 s22, s24, 4096
  buffer_load_dwordx4 v2, s[8:11], s22 offen offset:0 sc1 lds
  s_nop 5
  buffer_load_dwordx4 v2, s[8:11], s22 offen offset:1024 sc1 lds
  s_nop 5
  buffer_load_dwordx4 v2, s[8:11], s22 offen offset:2048 sc1 lds
  s_nop 5
  v_xor_b32 v116, 28672, v116
  v_add_u32 v117, s57, v117
  s_sub_u32 s57, 0, s57
  s_add_u32 s19, s19, 1
  s_mov_b32 s20, s21
  s_cmp_lt_u32 s19, 63
  s_cbranch_scc1 cA_sc3_loop
  s_branch cA_done
cA_sc3_slow:
  v_max_f32 v50, v36, v44
  s_nop 1
  v_max_f32_dpp v50, v50, v50 quad_perm:[1,0,3,2] row_mask:0xf bank_mask:0xf
  s_nop 1
  v_max_f32_dpp v50, v50, v50 quad_perm:[2,3,0,1] row_mask:0xf bank_mask:0xf
  s_nop 1
  v_max_f32_dpp v50, v50, v50 row_half_mirror row_mask:0xf bank_mask:0xf
  s_nop 1
  v_max_f32_dpp v50, v50, v50 row_mirror row_mask:0xf bank_mask:0xf
  v_mov_b32 v47, v50
  s_nop 1
  v_permlane16_swap_b32 v50, v47
  v_max_f32 v50, v50, v47
  v_sub_f32 v48, v36, v50
  v_sub_f32 v49, v44, v50
  v_exp_f32 v48, v48
  v_exp_f32 v49, v49
  s_add_u32 s31, s31, 0x100
  v_fma_f32 v39, v49, s37, v48
  v_cndmask_b32 v41, v48, v49, s[38:39]
  s_nop 0
  v_add_f32_dpp v39, v39, v39 quad_perm:[1,0,3,2] row_mask:0xf bank_mask:0xf
  v_cndmask_b32 v40, v49, v48, s[38:39]
  v_mov_b32_dpp v46, v41 quad_perm:[1,0,3,2] row_mask:0xf bank_mask:0xf
  v_add_f32_dpp v39, v39, v39 quad_perm:[2,3,0,1] row_mask:0xf bank_mask:0xf
  v_cndmask_b32 v42, v46, v40, s[38:39]
  v_cndmask_b32 v43, v40, v46, s[38:39]
  v_add_f32_dpp v39, v39, v39 row_half_mirror row_mask:0xf bank_mask:0xf
  s_nop 1
  v_add_f32_dpp v47, v39, v39 row_mirror row_mask:0xf bank_mask:0xf
  v_add_f32_dpp v39, v39, v39 row_mirror row_mask:0xf bank_mask:0xf
  s_nop 1
  v_permlane16_swap_b32 v39, v47
  v_add_f32 v39, v39, v47
  v_rcp_f32 v39, v39
  s_mov_b64 exec, s[28:29]
  v_mul_f32 v42, v42, v39
  v_mul_f32 v43, v43, v39
  v_cvt_pk_bf16_f32 v42, v42, v43
  v_min_u32 v42, -2, v42
  s_branch cA_sc3_pst
cA_sc3_retry:
  s_cmp_lg_u32 s62, 0
  s_cbranch_scc1 cA_sc3_cont
  s_waitcnt vmcnt(0) lgkmcnt(0)
cA_sc3_rv:
  buffer_load_dwordx4 v[8:11], v2, s[8:11], s20 offen offset:0 sc1
  buffer_load_dwordx4 v[12:15], v2, s[8:11], s20 offen offset:1024 sc1
  buffer_load_dwordx4 v[16:19], v2, s[8:11], s20 offen offset:2048 sc1
  buffer_load_dwordx4 v[20:23], v2, s[8:11], s20 offen offset:3072 sc1
  buffer_load_dwordx4 v[24:27], v2, s[8:11], s23 offen offset:0 sc1
  buffer_load_dwordx4 v[28:31], v2, s[8:11], s23 offen offset:1024 sc1
  buffer_load_dwordx4 v[32:35], v2, s[8:11], s23 offen offset:2048 sc1
  s_waitcnt vmcnt(0)
  v_max3_u32 v68, v8, v9, v10
  v_max3_u32 v68, v68, v11, v12
  v_max3_u32 v68, v68, v13, v14
  v_max3_u32 v68, v68, v15, v16
  v_max3_u32 v68, v68, v17, v18
  v_max3_u32 v68, v68, v19, v20
  v_max3_u32 v68, v68, v21, v22
  v_max3_u32 v68, v68, v23, v24
  v_max3_u32 v68, v68, v25, v26
  v_max3_u32 v68, v68, v27, v28
  v_max3_u32 v68, v68, v29, v30
  v_max3_u32 v68, v68, v31, v32
  v_max3_u32 v68, v68, v33, v34
  v_max_u32 v68, v68, v35
  v_cmp_eq_u32 vcc, -1, v68
  s_cbranch_vccz cA_sc3_rk
  s_add_u32 s30, s30, 1
  s_cmp_lt_u32 s30, 400000
  s_cbranch_scc1 cA_sc3_rv
  s_branch cA_abort
cA_sc3_rk:
  s_mov_b32 s62, 1
  v_mov_b32 v36, 0
  v_mov_b32 v37, 0
  v_mov_b32 v38, 0
  v_mov_b32 v39, 0
  v_mov_b32 v40, 0
  v_mov_b32 v41, 0
  v_mov_b32 v42, 0
  v_mov_b32 v43, 0
  v_mov_b32 v44, 0
  v_mov_b32 v45, 0
  v_mov_b32 v46, 0
  v_mov_b32 v47, 0
  v_mov_b32 v48, 0
  v_mov_b32 v49, 0
  v_mov_b32 v50, 0
  v_mov_b32 v51, 0
  v_mov_b32 v52, 0
  v_mov_b32 v53, 0
  v_mov_b32 v54, 0
  v_mov_b32 v55, 0
  v_mov_b32 v56, 0
  v_mov_b32 v57, 0
  v_mov_b32 v58, 0
  v_mov_b32 v59, 0
  v_mov_b32 v60, 0
  v_mov_b32 v61, 0
  v_mov_b32 v62, 0
  v_mov_b32 v63, 0
  v_mov_b32 v88, 0
  v_mov_b32 v89, 0
  v_mov_b32 v90, 0
  v_mov_b32 v91, 0
  v_mov_b32 v92, 0
  v_mov_b32 v93, 0
  v_mov_b32 v94, 0
  v_mov_b32 v95, 0
  v_mov_b32 v64, 0
  v_mov_b32 v65, 0
  s_add_u32 s31, s31, 1
  ds_read_b128 v[96:99], v117 offset:0
  ds_read_b128 v[100:103], v117 offset:1024
  ds_read_b128 v[104:107], v117 offset:14336
  ds_read_b128 v[108:111], v117 offset:15360
  v_smfmac_f32_16x16x64_bf16 v[36:39], v[8:11], a[0:7], v3
  v_smfmac_f32_16x16x64_bf16 v[40:43], v[8:11], a[56:63], v3
  v_smfmac_f32_16x16x64_bf16 v[44:47], v[8:11], a[112:119], v3
  v_smfmac_f32_16x16x64_bf16 v[48:51], v[8:11], a[168:175], v3
  v_smfmac_f32_16x16x64_bf16 v[52:55], v[8:11], a[224:231], v3
  v_smfmac_f32_16x16x64_bf16 v[56:59], v[8:11], v[144:151], v3
  v_smfmac_f32_16x16x64_bf16 v[60:63], v[8:11], v[200:207], v3
  v_smfmac_f32_16x16x64_bf16 v[36:39], v[12:15], a[8:15], v3
  v_smfmac_f32_16x16x64_bf16 v[40:43], v[12:15], a[64:71], v3
  v_smfmac_f32_16x16x64_bf16 v[44:47], v[12:15], a[120:127], v3
  v_smfmac_f32_16x16x64_bf16 v[48:51], v[12:15], a[176:183], v3
  v_smfmac_f32_16x16x64_bf16 v[52:55], v[12:15], a[232:239], v3
  v_smfmac_f32_16x16x64_bf16 v[56:59], v[12:15], v[152:159], v3
  v_smfmac_f32_16x16x64_bf16 v[60:63], v[12:15], v[208:215], v3
  v_smfmac_f32_16x16x64_bf16 v[36:39], v[16:19], a[16:23], v3
  v_smfmac_f32_16x16x64_bf16 v[40:43], v[16:19], a[72:79], v3
  v_smfmac_f32_16x16x64_bf16 v[44:47], v[16:19], a[128:135], v3
  v_smfmac_f32_16x16x64_bf16 v[48:51], v[16:19], a[184:191], v3
  v_smfmac_f32_16x16x64_bf16 v[52:55], v[16:19], a[240:247], v3
  v_smfmac_f32_16x16x64_bf16 v[56:59], v[16:19], v[160:167], v3
  v_smfmac_f32_16x16x64_bf16 v[60:63], v[16:19], v[216:223], v3
  v_smfmac_f32_16x16x64_bf16 v[36:39], v[20:23], a[24:31], v3
  v_smfmac_f32_16x16x64_bf16 v[40:43], v[20:23], a[80:87], v3
  v_smfmac_f32_16x16x64_bf16 v[44:47], v[20:23], a[136:143], v3
  v_smfmac_f32_16x16x64_bf16 v[48:51], v[20:23], a[192:199], v3
  v_smfmac_f32_16x16x64_bf16 v[52:55], v[20:23], a[248:255], v3
  v_smfmac_f32_16x16x64_bf16 v[56:59], v[20:23], v[168:175], v3
  v_smfmac_f32_16x16x64_bf16 v[60:63], v[20:23], v[224:231], v3
  s_xor_b32 s58, s25, 28672
  s_add_u32 s59, s24, 28672
  s_add_u32 m0, s58, 21504
  s_branch cA_sc3_ph2
.p2align 6

cA_va0_loop:
  s_add_u32 s23, s20, 4096
  s_add_u32 s21, s20, 20480
  s_mov_b32 s30, 0
  s_cmp_lg_u32 s19, s38
  s_cbranch_scc1 cA_va0_vok
  s_branch cA_va0_voc
cA_va0_vow:
  s_sub_u32 s22, s39, s35
  v_lshlrev_b32 v63, 7, v2
  v_min_u32 v63, s22, v63
  buffer_load_dword v63, v63, s[8:11], s35 offen sc1
  s_waitcnt vmcnt(0)
cA_va0_voc:
  v_readfirstlane_b32 s22, v63
  s_cmp_eq_u32 s22, 56
  s_cbranch_scc1 cA_va0_vod
  s_sleep 1
  s_add_u32 s30, s30, 1
  s_cmp_lt_u32 s30, 400000
  s_cbranch_scc1 cA_va0_vow
  s_branch cA_abort
cA_va0_vod:
  s_add_u32 s35, s35, 2048
  s_add_u32 s38, s19, 8
  s_and_b32 s38, s38, -8
  s_cmp_eq_u32 s19, 0
  s_cselect_b32 s38, 4, s38
  v_cmp_ne_u32 vcc, 56, v63
  s_nop 3
  s_cmp_eq_u64 vcc, 0
  s_cselect_b32 s38, 99, s38
cA_va0_vok:
  s_cmp_eq_u32 s19, 63
  s_cbranch_scc1 cA_done
  s_barrier
  s_add_u32 s22, s25, 0
  buffer_load_dwordx4 v[80:83], v6, s[8:11], s22 offen offset:0 sc1
  buffer_load_dwordx4 v[84:87], v6, s[8:11], s22 offen offset:1792 sc1
  s_add_u32 s22, s25, 3584
  buffer_load_dwordx4 v[88:91], v6, s[8:11], s22 offen offset:0 sc1
  buffer_load_dwordx4 v[92:95], v6, s[8:11], s22 offen offset:1792 sc1
  s_add_u32 s22, s25, 7168
  buffer_load_dwordx4 v[96:99], v6, s[8:11], s22 offen offset:0 sc1
  buffer_load_dwordx4 v[100:103], v6, s[8:11], s22 offen offset:1792 sc1
  s_add_u32 s22, s25, 10752
  buffer_load_dwordx4 v[104:107], v6, s[8:11], s22 offen offset:0 sc1
  buffer_load_dwordx4 v[108:111], v6, s[8:11], s22 offen offset:1792 sc1
  s_add_u32 s22, s25, 14336
  buffer_load_dwordx4 v[112:115], v6, s[8:11], s22 offen offset:0 sc1
  buffer_load_dwordx4 v[116:119], v6, s[8:11], s22 offen offset:1792 sc1
  s_add_u32 s22, s25, 17920
  buffer_load_dwordx4 v[120:123], v6, s[8:11], s22 offen offset:0 sc1
  buffer_load_dwordx4 v[124:127], v6, s[8:11], s22 offen offset:1792 sc1
  s_add_u32 s22, s19, 1
  s_cmp_lg_u32 s22, s38
  s_cbranch_scc1 cA_va0_nk
  s_sub_u32 s22, s39, s35
  v_lshlrev_b32 v63, 7, v2
  v_min_u32 v63, s22, v63
  buffer_load_dword v63, v63, s[8:11], s35 offen sc1
cA_va0_nk:
  s_barrier
  ds_read_b128 v[8:11], v0 offset:8192
  ds_read_b128 v[12:15], v0 offset:9216
  ds_read_b128 v[16:19], v0 offset:10240
  ds_read_b128 v[20:23], v0 offset:11264
  ds_read_b128 v[24:27], v0 offset:12288
  ds_read_b128 v[28:31], v0 offset:13312
  ds_read_b128 v[32:35], v0 offset:14336
  s_waitcnt lgkmcnt(0)
  v_smfmac_f32_16x16x64_bf16 v[36:39], v[8:11], a[0:7], v3
  s_add_u32 s22, s25, 21504
  buffer_load_dwordx4 v[128:131], v6, s[8:11], s22 offen offset:0 sc1
  v_smfmac_f32_16x16x64_bf16 v[36:39], v[12:15], a[8:15], v3
  v_smfmac_f32_16x16x64_bf16 v[36:39], v[16:19], a[16:23], v3
  s_add_u32 s22, s25, 21504
  buffer_load_dwordx4 v[132:135], v6, s[8:11], s22 offen offset:1792 sc1
  v_smfmac_f32_16x16x64_bf16 v[36:39], v[20:23], a[24:31], v3
  v_smfmac_f32_16x16x64_bf16 v[36:39], v[24:27], a[32:39], v3
  s_add_u32 s22, s25, 25088
  buffer_load_dwordx4 v[136:139], v6, s[8:11], s22 offen offset:0 sc1
  v_smfmac_f32_16x16x64_bf16 v[36:39], v[28:31], a[40:47], v3
  v_smfmac_f32_16x16x64_bf16 v[36:39], v[32:35], a[48:55], v3
  s_add_u32 s22, s25, 25088
  buffer_load_dwordx4 v[140:143], v6, s[8:11], s22 offen offset:1792 sc1
  v_smfmac_f32_16x16x64_bf16 v[40:43], v[8:11], a[56:63], v3
  v_smfmac_f32_16x16x64_bf16 v[40:43], v[12:15], a[64:71], v3
  v_smfmac_f32_16x16x64_bf16 v[40:43], v[16:19], a[72:79], v3
  v_add_f32 v36, v36, v37
  v_smfmac_f32_16x16x64_bf16 v[40:43], v[20:23], a[80:87], v3
  v_add_f32 v38, v38, v39
  v_smfmac_f32_16x16x64_bf16 v[40:43], v[24:27], a[88:95], v3
  v_cvt_pk_bf16_f32 v36, v36, v38
  v_smfmac_f32_16x16x64_bf16 v[40:43], v[28:31], a[96:103], v3
  ds_write_b32 v60, v36
  v_smfmac_f32_16x16x64_bf16 v[40:43], v[32:35], a[104:111], v3
  v_smfmac_f32_16x16x64_bf16 v[44:47], v[8:11], a[112:119], v3
  v_smfmac_f32_16x16x64_bf16 v[44:47], v[12:15], a[120:127], v3
  v_smfmac_f32_16x16x64_bf16 v[44:47], v[16:19], a[128:135], v3
  v_add_f32 v40, v40, v41
  v_smfmac_f32_16x16x64_bf16 v[44:47], v[20:23], a[136:143], v3
  v_add_f32 v42, v42, v43
  v_smfmac_f32_16x16x64_bf16 v[44:47], v[24:27], a[144:151], v3
  v_cvt_pk_bf16_f32 v40, v40, v42
  v_smfmac_f32_16x16x64_bf16 v[44:47], v[28:31], a[152:159], v3
  ds_write_b32 v61, v40
  v_smfmac_f32_16x16x64_bf16 v[44:47], v[32:35], a[160:167], v3
  v_smfmac_f32_16x16x64_bf16 v[48:51], v[8:11], a[168:175], v3
  v_smfmac_f32_16x16x64_bf16 v[48:51], v[12:15], a[176:183], v3
  v_smfmac_f32_16x16x64_bf16 v[48:51], v[16:19], a[184:191], v3
  v_add_f32 v44, v44, v45
  v_smfmac_f32_16x16x64_bf16 v[48:51], v[20:23], a[192:199], v3
  v_add_f32 v46, v46, v47
  v_smfmac_f32_16x16x64_bf16 v[48:51], v[24:27], a[200:207], v3
  v_cvt_pk_bf16_f32 v44, v44, v46
  v_smfmac_f32_16x16x64_bf16 v[48:51], v[28:31], a[208:215], v3
  ds_write_b32 v62, v44
  v_smfmac_f32_16x16x64_bf16 v[48:51], v[32:35], a[216:223], v3
  v_smfmac_f32_16x16x64_bf16 v[52:55], v[8:11], a[224:231], v3
  v_smfmac_f32_16x16x64_bf16 v[52:55], v[12:15], a[232:239], v3
  v_smfmac_f32_16x16x64_bf16 v[52:55], v[16:19], a[240:247], v3
  v_add_f32 v48, v48, v49
  v_smfmac_f32_16x16x64_bf16 v[52:55], v[20:23], a[248:255], v3
  v_add_f32 v50, v50, v51
  v_smfmac_f32_16x16x64_bf16 v[52:55], v[24:27], v[176:183], v3
  v_cvt_pk_bf16_f32 v48, v48, v50
  v_smfmac_f32_16x16x64_bf16 v[52:55], v[28:31], v[184:191], v3
  ds_write_b32 v170, v48
  v_smfmac_f32_16x16x64_bf16 v[52:55], v[32:35], v[192:199], v3
  v_smfmac_f32_16x16x64_bf16 v[56:59], v[8:11], v[200:207], v3
  v_smfmac_f32_16x16x64_bf16 v[56:59], v[12:15], v[208:215], v3
  v_smfmac_f32_16x16x64_bf16 v[56:59], v[16:19], v[216:223], v3
  v_add_f32 v52, v52, v53
  v_smfmac_f32_16x16x64_bf16 v[56:59], v[20:23], v[224:231], v3
  v_add_f32 v54, v54, v55
  v_smfmac_f32_16x16x64_bf16 v[56:59], v[24:27], v[232:239], v3
  v_cvt_pk_bf16_f32 v52, v52, v54
  v_smfmac_f32_16x16x64_bf16 v[56:59], v[28:31], v[240:247], v3
  ds_write_b32 v171, v52
  v_smfmac_f32_16x16x64_bf16 v[56:59], v[32:35], v[248:255], v3
  s_nop 7
  v_add_f32 v56, v56, v57
  v_add_f32 v58, v58, v59
  v_cvt_pk_bf16_f32 v56, v56, v58
  ds_write_b32 v172, v56
  buffer_load_dword v164, v4, s[8:11], s20 offen sc1
  s_waitcnt lgkmcnt(0)
  v_mov_b32 v36, 0
  v_mov_b32 v37, 0
  v_mov_b32 v38, 0
  v_mov_b32 v39, 0
  v_mov_b32 v40, 0
  v_mov_b32 v41, 0
  v_mov_b32 v42, 0
  v_mov_b32 v43, 0
  buffer_load_dword v165, v4, s[8:11], s20 offen sc1
  v_mov_b32 v44, 0
  v_mov_b32 v45, 0
  v_mov_b32 v46, 0
  v_mov_b32 v47, 0
  v_mov_b32 v48, 0
  v_mov_b32 v49, 0
  v_mov_b32 v50, 0
  v_mov_b32 v51, 0
  buffer_load_dword v166, v4, s[8:11], s20 offen sc1
  v_mov_b32 v52, 0
  v_mov_b32 v53, 0
  v_mov_b32 v54, 0
  v_mov_b32 v55, 0
  v_mov_b32 v56, 0
  v_mov_b32 v57, 0
  v_mov_b32 v58, 0
  v_mov_b32 v59, 0
  buffer_load_dword v167, v4, s[8:11], s20 offen sc1
  s_cmp_eq_u32 s19, 63
  s_cbranch_scc1 cA_va0_last
  s_add_u32 s22, s20, 9216
  s_add_u32 s34, s20, 13312
  s_add_u32 s36, s20, 7168
  s_mov_b32 s37, 0
  v_mov_b32 v156, 0
  v_mov_b32 v157, 0
  v_mov_b32 v158, 0
  v_mov_b32 v159, 0
  buffer_load_dword v168, v4, s[8:11], s20 offen sc1
cA_va0_fw_l:
  s_waitcnt vmcnt(4)
  v_cmp_eq_u32 vcc, -1, v164
  s_cbranch_vccz cA_va0_fw_d
  buffer_load_dword v164, v4, s[8:11], s20 offen sc1
  s_waitcnt vmcnt(4)
  v_cmp_eq_u32 vcc, -1, v165
  s_cbranch_vccz cA_va0_fw_d
  buffer_load_dword v165, v4, s[8:11], s20 offen sc1
  s_waitcnt vmcnt(4)
  v_cmp_eq_u32 vcc, -1, v166
  s_cbranch_vccz cA_va0_fw_d
  buffer_load_dword v166, v4, s[8:11], s20 offen sc1
  s_waitcnt vmcnt(4)
  v_cmp_eq_u32 vcc, -1, v167
  s_cbranch_vccz cA_va0_fw_d
  buffer_load_dword v167, v4, s[8:11], s20 offen sc1
  s_waitcnt vmcnt(4)
  v_cmp_eq_u32 vcc, -1, v168
  s_cbranch_vccz cA_va0_fw_d
  buffer_load_dword v168, v4, s[8:11], s20 offen sc1
  s_add_u32 s30, s30, 1
  s_cmp_lt_u32 s30, 400000
  s_cbranch_scc1 cA_va0_fw_l
  s_branch cA_abort
cA_va0_fw_d:
  s_waitcnt lgkmcnt(0)
  buffer_load_dwordx4 v[8:11], v5, s[8:11], s22 offen offset:0
  buffer_load_dwordx4 v[12:15], v5, s[8:11], s22 offen offset:1024
  buffer_load_dwordx4 v[16:19], v5, s[8:11], s22 offen offset:2048
  buffer_load_dwordx4 v[20:23], v5, s[8:11], s22 offen offset:3072
  buffer_load_dwordx4 v[24:27], v5, s[8:11], s34 offen offset:0
  buffer_load_dwordx4 v[28:31], v5, s[8:11], s34 offen offset:1024
  buffer_load_dwordx4 v[32:35], v5, s[8:11], s34 offen offset:2048
  buffer_load_dwordx4 v[144:147], v5, s[8:11], s34 offen offset:3072
  buffer_load_dwordx4 v[148:151], v2, s[8:11], s36 offen offset:0
  buffer_load_dwordx4 v[152:155], v2, s[8:11], s36 offen offset:1024
  s_barrier
  ds_read_b128 v[64:67], v2 offset:0
  ds_read_b128 v[68:71], v2 offset:1024
  ds_read_b128 v[72:75], v2 offset:2048
  ds_read_b128 v[76:79], v2 offset:3072
  s_waitcnt vmcnt(9)
  v_smfmac_f32_16x16x64_bf16 v[156:159], v[8:11], v[80:87], v3
  s_waitcnt vmcnt(8)
  v_smfmac_f32_16x16x64_bf16 v[156:159], v[12:15], v[88:95], v3
  s_waitcnt vmcnt(7)
  v_smfmac_f32_16x16x64_bf16 v[156:159], v[16:19], v[96:103], v3
  s_waitcnt vmcnt(6)
  v_smfmac_f32_16x16x64_bf16 v[156:159], v[20:23], v[104:111], v3
  s_waitcnt vmcnt(5)
  v_smfmac_f32_16x16x64_bf16 v[156:159], v[24:27], v[112:119], v3
  s_waitcnt vmcnt(4)
  v_smfmac_f32_16x16x64_bf16 v[156:159], v[28:31], v[120:127], v3
  s_waitcnt vmcnt(3)
  v_smfmac_f32_16x16x64_bf16 v[156:159], v[32:35], v[128:135], v3
  s_waitcnt vmcnt(2)
  v_smfmac_f32_16x16x64_bf16 v[156:159], v[144:147], v[136:143], v3
  s_waitcnt vmcnt(1) lgkmcnt(0)
  v_smfmac_f32_16x16x64_bf16 v[156:159], v[148:151], v[64:71], v3
  s_waitcnt vmcnt(0)
  v_smfmac_f32_16x16x64_bf16 v[156:159], v[152:155], v[72:79], v3
cA_va0_ep:
  s_nop 7
  v_add_f32 v160, v156, v157
  v_add_f32 v161, v158, v159
  v_cmp_u_f32 vcc, v160, v161
  v_mov_b32_dpp v162, v160 row_ror:8 row_mask:0xf bank_mask:0xf
  v_mov_b32_dpp v160, v161 row_ror:8 row_mask:0xf bank_mask:0xc
  s_cbranch_vccnz cA_va0_rp
  v_mov_b32_dpp v161, v162 quad_perm:[0,1,2,3] row_mask:0xf bank_mask:0x3
  v_cvt_pk_bf16_f32 v160, v160, v161
cA_va0_pc:
  buffer_store_dword v160, v1, s[8:11], s21 offen
  s_cmp_lg_u32 s19, 62
  s_cbranch_scc1 cA_va0_nl
  s_mov_b32 s22, 88531968
  buffer_store_dword v160, v1, s[8:11], s22 offen sc1
  s_mov_b64 exec, -1
  s_branch cA_done
cA_va0_nl:
  s_mov_b64 exec, -1
  s_add_u32 s25, s25, 28672
  s_add_u32 s19, s19, 1
  s_mov_b32 s20, s21
  s_branch cA_va0_loop
cA_va0_last:
  s_waitcnt lgkmcnt(0)
  s_barrier
  s_branch cA_done
cA_va0_rp:
  s_cmp_eq_u32 s37, 0
  s_cbranch_scc1 cA_va0_rv
  v_mov_b32_dpp v161, v162 quad_perm:[0,1,2,3] row_mask:0xf bank_mask:0x3
  v_cvt_pk_bf16_f32 v160, v160, v161
  v_min_u32 v160, -2, v160
  s_branch cA_va0_pc
cA_va0_rv:
  buffer_load_dwordx4 v[8:11], v5, s[8:11], s22 offen offset:0 sc1
  buffer_load_dwordx4 v[12:15], v5, s[8:11], s22 offen offset:1024 sc1
  buffer_load_dwordx4 v[16:19], v5, s[8:11], s22 offen offset:2048 sc1
  buffer_load_dwordx4 v[20:23], v5, s[8:11], s22 offen offset:3072 sc1
  buffer_load_dwordx4 v[24:27], v5, s[8:11], s34 offen offset:0 sc1
  buffer_load_dwordx4 v[28:31], v5, s[8:11], s34 offen offset:1024 sc1
  buffer_load_dwordx4 v[32:35], v5, s[8:11], s34 offen offset:2048 sc1
  buffer_load_dwordx4 v[144:147], v5, s[8:11], s34 offen offset:3072 sc1
  buffer_load_dwordx4 v[148:151], v2, s[8:11], s36 offen offset:0 sc1
  buffer_load_dwordx4 v[152:155], v2, s[8:11], s36 offen offset:1024 sc1
  s_waitcnt vmcnt(0)
  v_max3_u32 v175, v8, v9, v10
  v_max3_u32 v175, v175, v11, v12
  v_max3_u32 v175, v175, v13, v14
  v_max3_u32 v175, v175, v15, v16
  v_max3_u32 v175, v175, v17, v18
  v_max3_u32 v175, v175, v19, v20
  v_max3_u32 v175, v175, v21, v22
  v_max3_u32 v175, v175, v23, v24
  v_max3_u32 v175, v175, v25, v26
  v_max3_u32 v175, v175, v27, v28
  v_max3_u32 v175, v175, v29, v30
  v_max3_u32 v175, v175, v31, v32
  v_max3_u32 v175, v175, v33, v34
  v_max3_u32 v175, v175, v35, v144
  v_max3_u32 v175, v175, v145, v146
  v_max3_u32 v175, v175, v147, v148
  v_max3_u32 v175, v175, v149, v150
  v_max3_u32 v175, v175, v151, v152
  v_max3_u32 v175, v175, v153, v154
  v_max_u32 v175, v175, v155
  v_cmp_eq_u32 vcc, -1, v175
  s_cbranch_vccz cA_va0_rk
  s_add_u32 s30, s30, 1
  s_cmp_lt_u32 s30, 400000
  s_cbranch_scc1 cA_va0_rv
  s_branch cA_abort
cA_va0_rk:
  s_mov_b32 s37, 1
  s_add_u32 s31, s31, 0x10000
  v_mov_b32 v156, 0
  v_mov_b32 v157, 0
  v_mov_b32 v158, 0
  v_mov_b32 v159, 0
  s_nop 1
  v_smfmac_f32_16x16x64_bf16 v[156:159], v[8:11], v[80:87], v3
  v_smfmac_f32_16x16x64_bf16 v[156:159], v[12:15], v[88:95], v3
  v_smfmac_f32_16x16x64_bf16 v[156:159], v[16:19], v[96:103], v3
  v_smfmac_f32_16x16x64_bf16 v[156:159], v[20:23], v[104:111], v3
  v_smfmac_f32_16x16x64_bf16 v[156:159], v[24:27], v[112:119], v3
  v_smfmac_f32_16x16x64_bf16 v[156:159], v[28:31], v[120:127], v3
  v_smfmac_f32_16x16x64_bf16 v[156:159], v[32:35], v[128:135], v3
  v_smfmac_f32_16x16x64_bf16 v[156:159], v[144:147], v[136:143], v3
  v_smfmac_f32_16x16x64_bf16 v[156:159], v[148:151], v[64:71], v3
  v_smfmac_f32_16x16x64_bf16 v[156:159], v[152:155], v[72:79], v3
  s_nop 7
  s_branch cA_va0_ep
.p2align 6

cA_va1_loop:
  s_add_u32 s23, s20, 4096
  s_add_u32 s21, s20, 20480
  s_mov_b32 s30, 0
  s_cmp_lg_u32 s19, s38
  s_cbranch_scc1 cA_va1_vok
  s_branch cA_va1_voc
cA_va1_vow:
  s_sub_u32 s22, s39, s35
  v_lshlrev_b32 v63, 7, v2
  v_min_u32 v63, s22, v63
  buffer_load_dword v63, v63, s[8:11], s35 offen sc1
  s_waitcnt vmcnt(0)
cA_va1_voc:
  v_readfirstlane_b32 s22, v63
  s_cmp_eq_u32 s22, 56
  s_cbranch_scc1 cA_va1_vod
  s_sleep 1
  s_add_u32 s30, s30, 1
  s_cmp_lt_u32 s30, 400000
  s_cbranch_scc1 cA_va1_vow
  s_branch cA_abort
cA_va1_vod:
  s_add_u32 s35, s35, 2048
  s_add_u32 s38, s19, 8
  s_and_b32 s38, s38, -8
  s_cmp_eq_u32 s19, 0
  s_cselect_b32 s38, 4, s38
  v_cmp_ne_u32 vcc, 56, v63
  s_nop 3
  s_cmp_eq_u64 vcc, 0
  s_cselect_b32 s38, 99, s38
cA_va1_vok:
  s_cmp_eq_u32 s19, 63
  s_cbranch_scc1 cA_done
  s_barrier
  s_add_u32 s22, s25, 0
  buffer_load_dwordx4 v[80:83], v6, s[8:11], s22 offen offset:0 sc1
  buffer_load_dwordx4 v[84:87], v6, s[8:11], s22 offen offset:1792 sc1
  s_add_u32 s22, s25, 3584
  buffer_load_dwordx4 v[88:91], v6, s[8:11], s22 offen offset:0 sc1
  buffer_load_dwordx4 v[92:95], v6, s[8:11], s22 offen offset:1792 sc1
  s_add_u32 s22, s25, 7168
  buffer_load_dwordx4 v[96:99], v6, s[8:11], s22 offen offset:0 sc1
  buffer_load_dwordx4 v[100:103], v6, s[8:11], s22 offen offset:1792 sc1
  s_add_u32 s22, s25, 10752
  buffer_load_dwordx4 v[104:107], v6, s[8:11], s22 offen offset:0 sc1
  buffer_load_dwordx4 v[108:111], v6, s[8:11], s22 offen offset:1792 sc1
  s_add_u32 s22, s25, 14336
  buffer_load_dwordx4 v[112:115], v6, s[8:11], s22 offen offset:0 sc1
  buffer_load_dwordx4 v[116:119], v6, s[8:11], s22 offen offset:1792 sc1
  s_add_u32 s22, s25, 17920
  buffer_load_dwordx4 v[120:123], v6, s[8:11], s22 offen offset:0 sc1
  buffer_load_dwordx4 v[124:127], v6, s[8:11], s22 offen offset:1792 sc1
  s_add_u32 s22, s19, 1
  s_cmp_lg_u32 s22, s38
  s_cbranch_scc1 cA_va1_nk
  s_sub_u32 s22, s39, s35
  v_lshlrev_b32 v63, 7, v2
  v_min_u32 v63, s22, v63
  buffer_load_dword v63, v63, s[8:11], s35 offen sc1
cA_va1_nk:
  s_barrier
  ds_read_b128 v[8:11], v0 offset:8192
  ds_read_b128 v[12:15], v0 offset:9216
  ds_read_b128 v[16:19], v0 offset:10240
  ds_read_b128 v[20:23], v0 offset:11264
  ds_read_b128 v[24:27], v0 offset:12288
  ds_read_b128 v[28:31], v0 offset:13312
  ds_read_b128 v[32:35], v0 offset:14336
  s_waitcnt lgkmcnt(0)
  v_smfmac_f32_16x16x64_bf16 v[36:39], v[8:11], a[0:7], v3
  s_add_u32 s22, s25, 21504
  buffer_load_dwordx4 v[128:131], v6, s[8:11], s22 offen offset:0 sc1
  v_smfmac_f32_16x16x64_bf16 v[36:39], v[12:15], a[8:15], v3
  v_smfmac_f32_16x16x64_bf16 v[36:39], v[16:19], a[16:23], v3
  s_add_u32 s22, s25, 21504
  buffer_load_dwordx4 v[132:135], v6, s[8:11], s22 offen offset:1792 sc1
  v_smfmac_f32_16x16x64_bf16 v[36:39], v[20:23], a[24:31], v3
  v_smfmac_f32_16x16x64_bf16 v[36:39], v[24:27], a[32:39], v3
  s_add_u32 s22, s25, 25088
  buffer_load_dwordx4 v[136:139], v6, s[8:11], s22 offen offset:0 sc1
  v_smfmac_f32_16x16x64_bf16 v[36:39], v[28:31], a[40:47], v3
  v_smfmac_f32_16x16x64_bf16 v[36:39], v[32:35], a[48:55], v3
  s_add_u32 s22, s25, 25088
  buffer_load_dwordx4 v[140:143], v6, s[8:11], s22 offen offset:1792 sc1
  v_smfmac_f32_16x16x64_bf16 v[40:43], v[8:11], a[56:63], v3
  v_smfmac_f32_16x16x64_bf16 v[40:43], v[12:15], a[64:71], v3
  v_smfmac_f32_16x16x64_bf16 v[40:43], v[16:19], a[72:79], v3
  v_add_f32 v36, v36, v37
  v_smfmac_f32_16x16x64_bf16 v[40:43], v[20:23], a[80:87], v3
  v_add_f32 v38, v38, v39
  v_smfmac_f32_16x16x64_bf16 v[40:43], v[24:27], a[88:95], v3
  v_cvt_pk_bf16_f32 v36, v36, v38
  v_smfmac_f32_16x16x64_bf16 v[40:43], v[28:31], a[96:103], v3
  ds_write_b32 v60, v36
  v_smfmac_f32_16x16x64_bf16 v[40:43], v[32:35], a[104:111], v3
  v_smfmac_f32_16x16x64_bf16 v[44:47], v[8:11], a[112:119], v3
  v_smfmac_f32_16x16x64_bf16 v[44:47], v[12:15], a[120:127], v3
  v_smfmac_f32_16x16x64_bf16 v[44:47], v[16:19], a[128:135], v3
  v_add_f32 v40, v40, v41
  v_smfmac_f32_16x16x64_bf16 v[44:47], v[20:23], a[136:143], v3
  v_add_f32 v42, v42, v43
  v_smfmac_f32_16x16x64_bf16 v[44:47], v[24:27], a[144:151], v3
  v_cvt_pk_bf16_f32 v40, v40, v42
  v_smfmac_f32_16x16x64_bf16 v[44:47], v[28:31], a[152:159], v3
  ds_write_b32 v61, v40
  v_smfmac_f32_16x16x64_bf16 v[44:47], v[32:35], a[160:167], v3
  v_smfmac_f32_16x16x64_bf16 v[48:51], v[8:11], a[168:175], v3
  v_smfmac_f32_16x16x64_bf16 v[48:51], v[12:15], a[176:183], v3
  v_smfmac_f32_16x16x64_bf16 v[48:51], v[16:19], a[184:191], v3
  v_add_f32 v44, v44, v45
  v_smfmac_f32_16x16x64_bf16 v[48:51], v[20:23], a[192:199], v3
  v_add_f32 v46, v46, v47
  v_smfmac_f32_16x16x64_bf16 v[48:51], v[24:27], a[200:207], v3
  v_cvt_pk_bf16_f32 v44, v44, v46
  v_smfmac_f32_16x16x64_bf16 v[48:51], v[28:31], a[208:215], v3
  ds_write_b32 v62, v44
  v_smfmac_f32_16x16x64_bf16 v[48:51], v[32:35], a[216:223], v3
  v_smfmac_f32_16x16x64_bf16 v[52:55], v[8:11], a[224:231], v3
  v_smfmac_f32_16x16x64_bf16 v[52:55], v[12:15], a[232:239], v3
  v_smfmac_f32_16x16x64_bf16 v[52:55], v[16:19], a[240:247], v3
  v_add_f32 v48, v48, v49
  v_smfmac_f32_16x16x64_bf16 v[52:55], v[20:23], a[248:255], v3
  v_add_f32 v50, v50, v51
  v_smfmac_f32_16x16x64_bf16 v[52:55], v[24:27], v[176:183], v3
  v_cvt_pk_bf16_f32 v48, v48, v50
  v_smfmac_f32_16x16x64_bf16 v[52:55], v[28:31], v[184:191], v3
  ds_write_b32 v170, v48
  v_smfmac_f32_16x16x64_bf16 v[52:55], v[32:35], v[192:199], v3
  v_smfmac_f32_16x16x64_bf16 v[56:59], v[8:11], v[200:207], v3
  v_smfmac_f32_16x16x64_bf16 v[56:59], v[12:15], v[208:215], v3
  v_smfmac_f32_16x16x64_bf16 v[56:59], v[16:19], v[216:223], v3
  v_add_f32 v52, v52, v53
  v_smfmac_f32_16x16x64_bf16 v[56:59], v[20:23], v[224:231], v3
  v_add_f32 v54, v54, v55
  v_smfmac_f32_16x16x64_bf16 v[56:59], v[24:27], v[232:239], v3
  v_cvt_pk_bf16_f32 v52, v52, v54
  v_smfmac_f32_16x16x64_bf16 v[56:59], v[28:31], v[240:247], v3
  ds_write_b32 v171, v52
  v_smfmac_f32_16x16x64_bf16 v[56:59], v[32:35], v[248:255], v3
  s_nop 7
  v_add_f32 v56, v56, v57
  v_add_f32 v58, v58, v59
  v_cvt_pk_bf16_f32 v56, v56, v58
  ds_write_b32 v172, v56
  s_waitcnt lgkmcnt(0)
  v_mov_b32 v36, 0
  v_mov_b32 v37, 0
  v_mov_b32 v38, 0
  v_mov_b32 v39, 0
  v_mov_b32 v40, 0
  v_mov_b32 v41, 0
  v_mov_b32 v42, 0
  v_mov_b32 v43, 0
  v_mov_b32 v44, 0
  v_mov_b32 v45, 0
  v_mov_b32 v46, 0
  v_mov_b32 v47, 0
  v_mov_b32 v48, 0
  v_mov_b32 v49, 0
  v_mov_b32 v50, 0
  v_mov_b32 v51, 0
  v_mov_b32 v52, 0
  v_mov_b32 v53, 0
  v_mov_b32 v54, 0
  v_mov_b32 v55, 0
  v_mov_b32 v56, 0
  v_mov_b32 v57, 0
  v_mov_b32 v58, 0
  v_mov_b32 v59, 0
  s_cmp_eq_u32 s19, 63
  s_cbranch_scc1 cA_va1_last
  s_add_u32 s22, s20, 9216
  s_add_u32 s34, s20, 13312
  s_add_u32 s36, s20, 7168
  s_mov_b32 s37, 0
  v_mov_b32 v156, 0
  v_mov_b32 v157, 0
  v_mov_b32 v158, 0
  v_mov_b32 v159, 0
  s_barrier
  s_waitcnt lgkmcnt(0)
  buffer_load_dwordx4 v[8:11], v5, s[8:11], s22 offen offset:0
  buffer_load_dwordx4 v[12:15], v5, s[8:11], s22 offen offset:1024
  buffer_load_dwordx4 v[16:19], v5, s[8:11], s22 offen offset:2048
  buffer_load_dwordx4 v[20:23], v5, s[8:11], s22 offen offset:3072
  buffer_load_dwordx4 v[24:27], v5, s[8:11], s34 offen offset:0
  buffer_load_dwordx4 v[28:31], v5, s[8:11], s34 offen offset:1024
  buffer_load_dwordx4 v[32:35], v5, s[8:11], s34 offen offset:2048
  buffer_load_dwordx4 v[144:147], v5, s[8:11], s34 offen offset:3072
  s_sub_u32 s23, s21, 4
  s_mov_b64 exec, 65535
  buffer_store_dword v2, v7, s[8:11], s23 offen
  s_mov_b64 exec, -1
  buffer_load_dwordx4 v[148:151], v2, s[8:11], s36 offen offset:0
  buffer_load_dwordx4 v[152:155], v2, s[8:11], s36 offen offset:1024
  ds_read_b128 v[64:67], v2 offset:4096
  ds_read_b128 v[68:71], v2 offset:5120
  ds_read_b128 v[72:75], v2 offset:6144
  ds_read_b128 v[76:79], v2 offset:7168
  s_waitcnt vmcnt(10)
  v_smfmac_f32_16x16x64_bf16 v[156:159], v[8:11], v[80:87], v3
  s_waitcnt vmcnt(9)
  v_smfmac_f32_16x16x64_bf16 v[156:159], v[12:15], v[88:95], v3
  s_waitcnt vmcnt(8)
  v_smfmac_f32_16x16x64_bf16 v[156:159], v[16:19], v[96:103], v3
  s_waitcnt vmcnt(7)
  v_smfmac_f32_16x16x64_bf16 v[156:159], v[20:23], v[104:111], v3
  s_waitcnt vmcnt(6)
  v_smfmac_f32_16x16x64_bf16 v[156:159], v[24:27], v[112:119], v3
  s_mov_b64 exec, 65535
  buffer_store_dword v2, v7, s[8:11], s21 offen
  s_mov_b64 exec, -1
  s_waitcnt vmcnt(6)
  v_smfmac_f32_16x16x64_bf16 v[156:159], v[28:31], v[120:127], v3
  s_waitcnt vmcnt(5)
  v_smfmac_f32_16x16x64_bf16 v[156:159], v[32:35], v[128:135], v3
  s_waitcnt vmcnt(4)
  v_smfmac_f32_16x16x64_bf16 v[156:159], v[144:147], v[136:143], v3
  s_waitcnt vmcnt(2) lgkmcnt(0)
  v_smfmac_f32_16x16x64_bf16 v[156:159], v[148:151], v[64:71], v3
  s_waitcnt vmcnt(1)
  v_smfmac_f32_16x16x64_bf16 v[156:159], v[152:155], v[72:79], v3
cA_va1_ep:
  s_nop 7
  v_add_f32 v160, v156, v157
  v_add_f32 v161, v158, v159
  v_cmp_u_f32 vcc, v160, v161
  v_mov_b32_dpp v162, v160 row_ror:8 row_mask:0xf bank_mask:0xf
  v_mov_b32_dpp v160, v161 row_ror:8 row_mask:0xf bank_mask:0xc
  s_cbranch_vccnz cA_va1_rp
  v_mov_b32_dpp v161, v162 quad_perm:[0,1,2,3] row_mask:0xf bank_mask:0x3
  v_cvt_pk_bf16_f32 v160, v160, v161
cA_va1_pc:
  s_mov_b64 exec, s[26:27]
  buffer_store_dword v160, v1, s[8:11], s21 offen
  s_cmp_lg_u32 s19, 62
  s_cbranch_scc1 cA_va1_nl
  s_mov_b32 s22, 88531968
  buffer_store_dword v160, v1, s[8:11], s22 offen sc1
  s_mov_b64 exec, -1
  s_branch cA_done
cA_va1_nl:
  s_mov_b64 exec, -1
  s_cmp_lg_u32 s19, 0
  s_cbranch_scc1 cA_va1_s0
  v_add_u32 v7, 512, v7
  v_lshl_add_u32 v7, v2, 3, v7
  s_mov_b64 exec, 65535
  buffer_store_dword v2, v7, s[8:11], s21 offen
  buffer_store_dword v2, v7, s[8:11], s23 offen
  s_mov_b64 exec, -1
cA_va1_s0:
  s_add_u32 s25, s25, 28672
  s_add_u32 s19, s19, 1
  s_mov_b32 s20, s21
  s_branch cA_va1_loop
cA_va1_last:
  s_waitcnt lgkmcnt(0)
  s_barrier
  s_branch cA_done
cA_va1_rp:
  s_cmp_eq_u32 s37, 0
  s_cbranch_scc1 cA_va1_rv
  v_mov_b32_dpp v161, v162 quad_perm:[0,1,2,3] row_mask:0xf bank_mask:0x3
  v_cvt_pk_bf16_f32 v160, v160, v161
  v_min_u32 v160, -2, v160
  s_branch cA_va1_pc
cA_va1_rv:
  buffer_load_dwordx4 v[8:11], v5, s[8:11], s22 offen offset:0 sc1
  buffer_load_dwordx4 v[12:15], v5, s[8:11], s22 offen offset:1024 sc1
  buffer_load_dwordx4 v[16:19], v5, s[8:11], s22 offen offset:2048 sc1
  buffer_load_dwordx4 v[20:23], v5, s[8:11], s22 offen offset:3072 sc1
  buffer_load_dwordx4 v[24:27], v5, s[8:11], s34 offen offset:0 sc1
  buffer_load_dwordx4 v[28:31], v5, s[8:11], s34 offen offset:1024 sc1
  buffer_load_dwordx4 v[32:35], v5, s[8:11], s34 offen offset:2048 sc1
  buffer_load_dwordx4 v[144:147], v5, s[8:11], s34 offen offset:3072 sc1
  buffer_load_dwordx4 v[148:151], v2, s[8:11], s36 offen offset:0 sc1
  buffer_load_dwordx4 v[152:155], v2, s[8:11], s36 offen offset:1024 sc1
  s_waitcnt vmcnt(0)
  v_max3_u32 v175, v8, v9, v10
  v_max3_u32 v175, v175, v11, v12
  v_max3_u32 v175, v175, v13, v14
  v_max3_u32 v175, v175, v15, v16
  v_max3_u32 v175, v175, v17, v18
  v_max3_u32 v175, v175, v19, v20
  v_max3_u32 v175, v175, v21, v22
  v_max3_u32 v175, v175, v23, v24
  v_max3_u32 v175, v175, v25, v26
  v_max3_u32 v175, v175, v27, v28
  v_max3_u32 v175, v175, v29, v30
  v_max3_u32 v175, v175, v31, v32
  v_max3_u32 v175, v175, v33, v34
  v_max3_u32 v175, v175, v35, v144
  v_max3_u32 v175, v175, v145, v146
  v_max3_u32 v175, v175, v147, v148
  v_max3_u32 v175, v175, v149, v150
  v_max3_u32 v175, v175, v151, v152
  v_max3_u32 v175, v175, v153, v154
  v_max_u32 v175, v175, v155
  v_cmp_eq_u32 vcc, -1, v175
  s_cbranch_vccz cA_va1_rk
  s_add_u32 s30, s30, 1
  s_cmp_lt_u32 s30, 400000
  s_cbranch_scc1 cA_va1_rv
  s_branch cA_abort
cA_va1_rk:
  s_mov_b32 s37, 1
  s_add_u32 s31, s31, 0x10000
  v_mov_b32 v156, 0
  v_mov_b32 v157, 0
  v_mov_b32 v158, 0
  v_mov_b32 v159, 0
  s_nop 1
  v_smfmac_f32_16x16x64_bf16 v[156:159], v[8:11], v[80:87], v3
  v_smfmac_f32_16x16x64_bf16 v[156:159], v[12:15], v[88:95], v3
  v_smfmac_f32_16x16x64_bf16 v[156:159], v[16:19], v[96:103], v3
  v_smfmac_f32_16x16x64_bf16 v[156:159], v[20:23], v[104:111], v3
  v_smfmac_f32_16x16x64_bf16 v[156:159], v[24:27], v[112:119], v3
  v_smfmac_f32_16x16x64_bf16 v[156:159], v[28:31], v[120:127], v3
  v_smfmac_f32_16x16x64_bf16 v[156:159], v[32:35], v[128:135], v3
  v_smfmac_f32_16x16x64_bf16 v[156:159], v[144:147], v[136:143], v3
  v_smfmac_f32_16x16x64_bf16 v[156:159], v[148:151], v[64:71], v3
  v_smfmac_f32_16x16x64_bf16 v[156:159], v[152:155], v[72:79], v3
  s_nop 7
  s_branch cA_va1_ep
.p2align 6

cA_va2_loop:
  s_add_u32 s23, s20, 4096
  s_add_u32 s21, s20, 20480
  v_mov_b32 v36, 0
  v_mov_b32 v37, 0
  v_mov_b32 v38, 0
  v_mov_b32 v39, 0
  v_mov_b32 v40, 0
  v_mov_b32 v41, 0
  v_mov_b32 v42, 0
  v_mov_b32 v43, 0
  v_mov_b32 v44, 0
  v_mov_b32 v45, 0
  v_mov_b32 v46, 0
  v_mov_b32 v47, 0
  v_mov_b32 v48, 0
  v_mov_b32 v49, 0
  v_mov_b32 v50, 0
  v_mov_b32 v51, 0
  v_mov_b32 v52, 0
  v_mov_b32 v53, 0
  v_mov_b32 v54, 0
  v_mov_b32 v55, 0
  v_mov_b32 v56, 0
  v_mov_b32 v57, 0
  v_mov_b32 v58, 0
  v_mov_b32 v59, 0
  v_mov_b32 v60, 0
  v_mov_b32 v61, 0
  v_mov_b32 v62, 0
  v_mov_b32 v63, 0
  v_mov_b32 v64, 0
  v_mov_b32 v65, 0
  v_mov_b32 v66, 0
  v_mov_b32 v67, 0
  s_mov_b32 s30, 0
  buffer_load_dword v76, v119, s[8:11], s20 offen sc1
  buffer_load_dword v77, v119, s[8:11], s20 offen sc1
  buffer_load_dword v78, v119, s[8:11], s20 offen sc1
cA_va2_fp_l:
  s_waitcnt vmcnt(2)
  v_cmp_eq_u32 vcc, -1, v76
  s_cbranch_vccz cA_va2_fp_d
  buffer_load_dword v76, v119, s[8:11], s20 offen sc1
  s_waitcnt vmcnt(2)
  v_cmp_eq_u32 vcc, -1, v77
  s_cbranch_vccz cA_va2_fp_d
  buffer_load_dword v77, v119, s[8:11], s20 offen sc1
  s_waitcnt vmcnt(2)
  v_cmp_eq_u32 vcc, -1, v78
  s_cbranch_vccz cA_va2_fp_d
  buffer_load_dword v78, v119, s[8:11], s20 offen sc1
  s_add_u32 s30, s30, 1
  s_cmp_lt_u32 s30, 400000
  s_cbranch_scc1 cA_va2_fp_l
  s_branch cA_abort
cA_va2_fp_d:
  s_nop 15
  s_nop 3
  buffer_load_dwordx4 v[8:11], v2, s[8:11], s20 offen offset:0 sc1
  buffer_load_dwordx4 v[12:15], v2, s[8:11], s20 offen offset:1024 sc1
  buffer_load_dwordx4 v[16:19], v2, s[8:11], s20 offen offset:2048 sc1
  buffer_load_dwordx4 v[20:23], v2, s[8:11], s20 offen offset:3072 sc1
  s_barrier
cA_va2_ld:
  s_waitcnt vmcnt(0)
  v_max3_u32 v84, v8, v9, v10
  v_max3_u32 v84, v84, v11, v12
  v_max3_u32 v84, v84, v13, v14
  v_max3_u32 v84, v84, v15, v16
  v_max3_u32 v84, v84, v17, v18
  v_max3_u32 v84, v84, v19, v20
  v_max3_u32 v84, v84, v21, v22
  v_max_u32 v84, v84, v23
  v_cmp_eq_u32 vcc, -1, v84
  ds_write_b128 v2, v[8:11] offset:8192
  ds_write_b128 v2, v[12:15] offset:9216
  ds_write_b128 v2, v[16:19] offset:10240
  ds_write_b128 v2, v[20:23] offset:11264
  s_cbranch_vccnz cA_va2_retry
  s_waitcnt lgkmcnt(0)
  s_barrier
  ds_read_b128 v[8:11], v5 offset:8192
  ds_read_b128 v[12:15], v5 offset:9216
  ds_read_b128 v[16:19], v5 offset:10240
  ds_read_b128 v[20:23], v5 offset:11264
  ds_read_b128 v[24:27], v5 offset:12288
  ds_read_b128 v[28:31], v5 offset:13312
  ds_read_b128 v[32:35], v5 offset:14336
  ds_read_b128 v[92:95], v0
  s_waitcnt lgkmcnt(0)
  s_mov_b64 exec, s[26:27]
  buffer_store_dwordx4 v[92:95], v2, s[8:11], s36 offen sc1
  s_mov_b64 exec, -1
  s_add_u32 s36, s36, 7168
  s_cmp_eq_u32 s19, 63
  s_cbranch_scc1 cA_done
  ds_read_b128 v[76:79], v1 offset:0
  ds_read_b128 v[80:83], v1 offset:1024
  ds_read_b128 v[84:87], v1 offset:2048
  ds_read_b128 v[88:91], v1 offset:3072
  ds_read_b128 v[92:95], v1 offset:4096
  ds_read_b128 v[96:99], v1 offset:5120
  v_smfmac_f32_16x16x64_bf16 v[60:63], v[8:11], v[200:207], v3
  v_smfmac_f32_16x16x64_bf16 v[60:63], v[12:15], v[208:215], v3
  s_waitcnt lgkmcnt(4)
  v_smfmac_f32_16x16x64_bf16 v[64:67], v[8:11], v[76:83], v3
  ds_read_b128 v[76:79], v1 offset:6144
  ds_read_b128 v[80:83], v1 offset:7168
  v_smfmac_f32_16x16x64_bf16 v[60:63], v[16:19], v[216:223], v3
  v_smfmac_f32_16x16x64_bf16 v[60:63], v[20:23], v[224:231], v3
  s_waitcnt lgkmcnt(4)
  v_smfmac_f32_16x16x64_bf16 v[64:67], v[12:15], v[84:91], v3
  ds_read_b128 v[84:87], v1 offset:8192
  ds_read_b128 v[88:91], v1 offset:9216
  v_smfmac_f32_16x16x64_bf16 v[60:63], v[24:27], v[232:239], v3
  v_smfmac_f32_16x16x64_bf16 v[60:63], v[28:31], v[240:247], v3
  s_waitcnt lgkmcnt(4)
  v_smfmac_f32_16x16x64_bf16 v[64:67], v[16:19], v[92:99], v3
  ds_read_b128 v[92:95], v1 offset:10240
  ds_read_b128 v[96:99], v1 offset:11264
  v_smfmac_f32_16x16x64_bf16 v[60:63], v[32:35], v[248:255], v3
  v_smfmac_f32_16x16x64_bf16 v[36:39], v[8:11], a[0:7], v3
  s_waitcnt lgkmcnt(4)
  v_smfmac_f32_16x16x64_bf16 v[64:67], v[20:23], v[76:83], v3
  ds_read_b128 v[76:79], v1 offset:12288
  ds_read_b128 v[80:83], v1 offset:13312
  v_smfmac_f32_16x16x64_bf16 v[36:39], v[12:15], a[8:15], v3
  v_add_f32 v60, v60, v61
  v_smfmac_f32_16x16x64_bf16 v[36:39], v[16:19], a[16:23], v3
  v_add_f32 v62, v62, v63
  s_waitcnt lgkmcnt(4)
  v_smfmac_f32_16x16x64_bf16 v[64:67], v[24:27], v[84:91], v3
  v_cvt_pk_bf16_f32 v60, v60, v62
  v_smfmac_f32_16x16x64_bf16 v[36:39], v[20:23], a[24:31], v3
  ds_write_b32 v106, v60
  v_smfmac_f32_16x16x64_bf16 v[36:39], v[24:27], a[32:39], v3
  s_waitcnt lgkmcnt(2)
  v_smfmac_f32_16x16x64_bf16 v[64:67], v[28:31], v[92:99], v3
  v_smfmac_f32_16x16x64_bf16 v[36:39], v[28:31], a[40:47], v3
  v_smfmac_f32_16x16x64_bf16 v[36:39], v[32:35], a[48:55], v3
  s_waitcnt lgkmcnt(0)
  v_smfmac_f32_16x16x64_bf16 v[64:67], v[32:35], v[76:83], v3
  v_smfmac_f32_16x16x64_bf16 v[40:43], v[8:11], a[56:63], v3
  v_smfmac_f32_16x16x64_bf16 v[40:43], v[12:15], a[64:71], v3
  v_add_f32 v36, v36, v37
  v_smfmac_f32_16x16x64_bf16 v[40:43], v[16:19], a[72:79], v3
  v_add_f32 v38, v38, v39
  v_smfmac_f32_16x16x64_bf16 v[40:43], v[20:23], a[80:87], v3
  v_cvt_pk_bf16_f32 v36, v36, v38
  v_smfmac_f32_16x16x64_bf16 v[40:43], v[24:27], a[88:95], v3
  ds_write_b32 v100, v36
  v_smfmac_f32_16x16x64_bf16 v[40:43], v[28:31], a[96:103], v3
  v_add_f32 v64, v64, v65
  v_smfmac_f32_16x16x64_bf16 v[40:43], v[32:35], a[104:111], v3
  v_add_f32 v66, v66, v67
  v_smfmac_f32_16x16x64_bf16 v[44:47], v[8:11], a[112:119], v3
  v_cvt_pk_bf16_f32 v64, v64, v66
  v_smfmac_f32_16x16x64_bf16 v[44:47], v[12:15], a[120:127], v3
  ds_write_b32 v107, v64
  v_smfmac_f32_16x16x64_bf16 v[44:47], v[16:19], a[128:135], v3
  v_add_f32 v40, v40, v41
  v_smfmac_f32_16x16x64_bf16 v[44:47], v[20:23], a[136:143], v3
  v_add_f32 v42, v42, v43
  v_smfmac_f32_16x16x64_bf16 v[44:47], v[24:27], a[144:151], v3
  v_cvt_pk_bf16_f32 v40, v40, v42
  v_smfmac_f32_16x16x64_bf16 v[44:47], v[28:31], a[152:159], v3
  ds_write_b32 v101, v40
  v_smfmac_f32_16x16x64_bf16 v[44:47], v[32:35], a[160:167], v3
  v_smfmac_f32_16x16x64_bf16 v[48:51], v[8:11], a[168:175], v3
  v_smfmac_f32_16x16x64_bf16 v[48:51], v[12:15], a[176:183], v3
  v_smfmac_f32_16x16x64_bf16 v[48:51], v[16:19], a[184:191], v3
  v_add_f32 v44, v44, v45
  v_smfmac_f32_16x16x64_bf16 v[48:51], v[20:23], a[192:199], v3
  v_add_f32 v46, v46, v47
  v_smfmac_f32_16x16x64_bf16 v[48:51], v[24:27], a[200:207], v3
  v_cvt_pk_bf16_f32 v44, v44, v46
  v_smfmac_f32_16x16x64_bf16 v[48:51], v[28:31], a[208:215], v3
  ds_write_b32 v102, v44
  v_smfmac_f32_16x16x64_bf16 v[48:51], v[32:35], a[216:223], v3
  v_smfmac_f32_16x16x64_bf16 v[52:55], v[8:11], a[224:231], v3
  v_smfmac_f32_16x16x64_bf16 v[52:55], v[12:15], a[232:239], v3
  v_smfmac_f32_16x16x64_bf16 v[52:55], v[16:19], a[240:247], v3
  v_add_f32 v48, v48, v49
  v_smfmac_f32_16x16x64_bf16 v[52:55], v[20:23], a[248:255], v3
  v_add_f32 v50, v50, v51
  v_smfmac_f32_16x16x64_bf16 v[52:55], v[24:27], v[120:127], v3
  v_cvt_pk_bf16_f32 v48, v48, v50
  v_smfmac_f32_16x16x64_bf16 v[52:55], v[28:31], v[128:135], v3
  ds_write_b32 v103, v48
  v_smfmac_f32_16x16x64_bf16 v[52:55], v[32:35], v[136:143], v3
  v_smfmac_f32_16x16x64_bf16 v[56:59], v[8:11], v[144:151], v3
  v_smfmac_f32_16x16x64_bf16 v[56:59], v[12:15], v[152:159], v3
  v_smfmac_f32_16x16x64_bf16 v[56:59], v[16:19], v[160:167], v3
  v_add_f32 v52, v52, v53
  v_smfmac_f32_16x16x64_bf16 v[56:59], v[20:23], v[168:175], v3
  v_add_f32 v54, v54, v55
  v_smfmac_f32_16x16x64_bf16 v[56:59], v[24:27], v[176:183], v3
  v_cvt_pk_bf16_f32 v52, v52, v54
  v_smfmac_f32_16x16x64_bf16 v[56:59], v[28:31], v[184:191], v3
  ds_write_b32 v104, v52
  v_smfmac_f32_16x16x64_bf16 v[56:59], v[32:35], v[192:199], v3
  s_nop 7
  v_add_f32 v56, v56, v57
  v_add_f32 v58, v58, v59
  v_cvt_pk_bf16_f32 v56, v56, v58
  ds_write_b32 v105, v56
  s_waitcnt lgkmcnt(0)
  s_barrier
  s_cmp_eq_u32 s19, 62
  s_cbranch_scc1 cA_done
  s_waitcnt vmcnt(0) lgkmcnt(0)
  s_add_u32 s19, s19, 1
  s_mov_b32 s20, s21
  s_branch cA_va2_loop
cA_va2_retry:
  s_waitcnt lgkmcnt(0)
  buffer_load_dwordx4 v[8:11], v2, s[8:11], s20 offen offset:0 sc1
  buffer_load_dwordx4 v[12:15], v2, s[8:11], s20 offen offset:1024 sc1
  buffer_load_dwordx4 v[16:19], v2, s[8:11], s20 offen offset:2048 sc1
  buffer_load_dwordx4 v[20:23], v2, s[8:11], s20 offen offset:3072 sc1
  s_add_u32 s31, s31, 1
  s_add_u32 s30, s30, 1
  s_cmp_lt_u32 s30, 400000
  s_cbranch_scc1 cA_va2_ld
  s_branch cA_abort
cA_va2_last:
  s_waitcnt lgkmcnt(0)
  buffer_store_dwordx4 v[100:103], v2, s[8:11], s24 offen offset:0 sc1
  buffer_store_dwordx4 v[104:107], v2, s[8:11], s24 offen offset:1024 sc1
  buffer_store_dwordx4 v[108:111], v2, s[8:11], s24 offen offset:2048 sc1
  buffer_store_dwordx4 v[4:7], v2, s[8:11], s24 offen offset:3072 sc1
  s_add_u32 s24, s24, 8192
  s_waitcnt vmcnt(0)
  s_mov_b64 exec, 1
  buffer_store_dword v117, v2, s[8:11], s34 offen sc1
  s_mov_b64 exec, -1
  s_add_u32 s34, s34, 8
  s_mov_b64 exec, 1
  buffer_store_dword v117, v2, s[8:11], s34 offen sc1
  s_mov_b64 exec, -1
  s_add_u32 s34, s34, 8
  s_branch cA_done
.p2align 6

cA_va3_loop:
  s_add_u32 s23, s20, 4096
  s_add_u32 s21, s20, 20480
  v_mov_b32 v36, 0
  v_mov_b32 v37, 0
  v_mov_b32 v38, 0
  v_mov_b32 v39, 0
  v_mov_b32 v40, 0
  v_mov_b32 v41, 0
  v_mov_b32 v42, 0
  v_mov_b32 v43, 0
  v_mov_b32 v44, 0
  v_mov_b32 v45, 0
  v_mov_b32 v46, 0
  v_mov_b32 v47, 0
  v_mov_b32 v48, 0
  v_mov_b32 v49, 0
  v_mov_b32 v50, 0
  v_mov_b32 v51, 0
  v_mov_b32 v52, 0
  v_mov_b32 v53, 0
  v_mov_b32 v54, 0
  v_mov_b32 v55, 0
  v_mov_b32 v56, 0
  v_mov_b32 v57, 0
  v_mov_b32 v58, 0
  v_mov_b32 v59, 0
  v_mov_b32 v60, 0
  v_mov_b32 v61, 0
  v_mov_b32 v62, 0
  v_mov_b32 v63, 0
  v_mov_b32 v64, 0
  v_mov_b32 v65, 0
  v_mov_b32 v66, 0
  v_mov_b32 v67, 0
  s_mov_b32 s30, 0
  buffer_load_dword v76, v119, s[8:11], s20 offen sc1
  buffer_load_dword v77, v119, s[8:11], s20 offen sc1
  buffer_load_dword v78, v119, s[8:11], s20 offen sc1
cA_va3_fp_l:
  s_waitcnt vmcnt(2)
  v_cmp_eq_u32 vcc, -1, v76
  s_cbranch_vccz cA_va3_fp_d
  buffer_load_dword v76, v119, s[8:11], s20 offen sc1
  s_waitcnt vmcnt(2)
  v_cmp_eq_u32 vcc, -1, v77
  s_cbranch_vccz cA_va3_fp_d
  buffer_load_dword v77, v119, s[8:11], s20 offen sc1
  s_waitcnt vmcnt(2)
  v_cmp_eq_u32 vcc, -1, v78
  s_cbranch_vccz cA_va3_fp_d
  buffer_load_dword v78, v119, s[8:11], s20 offen sc1
  s_add_u32 s30, s30, 1
  s_cmp_lt_u32 s30, 400000
  s_cbranch_scc1 cA_va3_fp_l
  s_branch cA_abort
cA_va3_fp_d:
  buffer_load_dwordx4 v[24:27], v2, s[8:11], s23 offen offset:0 sc1
  buffer_load_dwordx4 v[28:31], v2, s[8:11], s23 offen offset:1024 sc1
  buffer_load_dwordx4 v[32:35], v2, s[8:11], s23 offen offset:2048 sc1
  s_barrier
cA_va3_ld:
  s_waitcnt vmcnt(0)
  v_max3_u32 v84, v24, v25, v26
  v_max3_u32 v84, v84, v27, v28
  v_max3_u32 v84, v84, v29, v30
  v_max3_u32 v84, v84, v31, v32
  v_max3_u32 v84, v84, v33, v34
  v_max_u32 v84, v84, v35
  v_cmp_eq_u32 vcc, -1, v84
  ds_write_b128 v2, v[24:27] offset:12288
  ds_write_b128 v2, v[28:31] offset:13312
  ds_write_b128 v2, v[32:35] offset:14336
  s_cbranch_vccnz cA_va3_retry
  s_waitcnt lgkmcnt(0)
  s_barrier
  ds_read_b128 v[8:11], v5 offset:8192
  ds_read_b128 v[12:15], v5 offset:9216
  ds_read_b128 v[16:19], v5 offset:10240
  ds_read_b128 v[20:23], v5 offset:11264
  ds_read_b128 v[24:27], v5 offset:12288
  ds_read_b128 v[28:31], v5 offset:13312
  ds_read_b128 v[32:35], v5 offset:14336
  s_waitcnt lgkmcnt(0)
  s_cmp_eq_u32 s19, 63
  s_cbranch_scc1 cA_done
  ds_read_b128 v[76:79], v1 offset:0
  ds_read_b128 v[80:83], v1 offset:1024
  ds_read_b128 v[84:87], v1 offset:2048
  ds_read_b128 v[88:91], v1 offset:3072
  ds_read_b128 v[92:95], v1 offset:4096
  ds_read_b128 v[96:99], v1 offset:5120
  v_smfmac_f32_16x16x64_bf16 v[60:63], v[8:11], v[200:207], v3
  v_smfmac_f32_16x16x64_bf16 v[60:63], v[12:15], v[208:215], v3
  s_waitcnt lgkmcnt(4)
  v_smfmac_f32_16x16x64_bf16 v[64:67], v[8:11], v[76:83], v3
  ds_read_b128 v[76:79], v1 offset:6144
  ds_read_b128 v[80:83], v1 offset:7168
  v_smfmac_f32_16x16x64_bf16 v[60:63], v[16:19], v[216:223], v3
  v_smfmac_f32_16x16x64_bf16 v[60:63], v[20:23], v[224:231], v3
  s_waitcnt lgkmcnt(4)
  v_smfmac_f32_16x16x64_bf16 v[64:67], v[12:15], v[84:91], v3
  ds_read_b128 v[84:87], v1 offset:8192
  ds_read_b128 v[88:91], v1 offset:9216
  v_smfmac_f32_16x16x64_bf16 v[60:63], v[24:27], v[232:239], v3
  v_smfmac_f32_16x16x64_bf16 v[60:63], v[28:31], v[240:247], v3
  s_waitcnt lgkmcnt(4)
  v_smfmac_f32_16x16x64_bf16 v[64:67], v[16:19], v[92:99], v3
  ds_read_b128 v[92:95], v1 offset:10240
  ds_read_b128 v[96:99], v1 offset:11264
  v_smfmac_f32_16x16x64_bf16 v[60:63], v[32:35], v[248:255], v3
  v_smfmac_f32_16x16x64_bf16 v[36:39], v[8:11], a[0:7], v3
  s_waitcnt lgkmcnt(4)
  v_smfmac_f32_16x16x64_bf16 v[64:67], v[20:23], v[76:83], v3
  ds_read_b128 v[76:79], v1 offset:12288
  ds_read_b128 v[80:83], v1 offset:13312
  v_smfmac_f32_16x16x64_bf16 v[36:39], v[12:15], a[8:15], v3
  v_add_f32 v60, v60, v61
  v_smfmac_f32_16x16x64_bf16 v[36:39], v[16:19], a[16:23], v3
  v_add_f32 v62, v62, v63
  s_waitcnt lgkmcnt(4)
  v_smfmac_f32_16x16x64_bf16 v[64:67], v[24:27], v[84:91], v3
  v_cvt_pk_bf16_f32 v60, v60, v62
  v_smfmac_f32_16x16x64_bf16 v[36:39], v[20:23], a[24:31], v3
  ds_write_b32 v106, v60
  v_smfmac_f32_16x16x64_bf16 v[36:39], v[24:27], a[32:39], v3
  s_waitcnt lgkmcnt(2)
  v_smfmac_f32_16x16x64_bf16 v[64:67], v[28:31], v[92:99], v3
  v_smfmac_f32_16x16x64_bf16 v[36:39], v[28:31], a[40:47], v3
  v_smfmac_f32_16x16x64_bf16 v[36:39], v[32:35], a[48:55], v3
  s_waitcnt lgkmcnt(0)
  v_smfmac_f32_16x16x64_bf16 v[64:67], v[32:35], v[76:83], v3
  v_smfmac_f32_16x16x64_bf16 v[40:43], v[8:11], a[56:63], v3
  v_smfmac_f32_16x16x64_bf16 v[40:43], v[12:15], a[64:71], v3
  v_add_f32 v36, v36, v37
  v_smfmac_f32_16x16x64_bf16 v[40:43], v[16:19], a[72:79], v3
  v_add_f32 v38, v38, v39
  v_smfmac_f32_16x16x64_bf16 v[40:43], v[20:23], a[80:87], v3
  v_cvt_pk_bf16_f32 v36, v36, v38
  v_smfmac_f32_16x16x64_bf16 v[40:43], v[24:27], a[88:95], v3
  ds_write_b32 v100, v36
  v_smfmac_f32_16x16x64_bf16 v[40:43], v[28:31], a[96:103], v3
  v_add_f32 v64, v64, v65
  v_smfmac_f32_16x16x64_bf16 v[40:43], v[32:35], a[104:111], v3
  v_add_f32 v66, v66, v67
  v_smfmac_f32_16x16x64_bf16 v[44:47], v[8:11], a[112:119], v3
  v_cvt_pk_bf16_f32 v64, v64, v66
  v_smfmac_f32_16x16x64_bf16 v[44:47], v[12:15], a[120:127], v3
  ds_write_b32 v107, v64
  v_smfmac_f32_16x16x64_bf16 v[44:47], v[16:19], a[128:135], v3
  v_add_f32 v40, v40, v41
  v_smfmac_f32_16x16x64_bf16 v[44:47], v[20:23], a[136:143], v3
  v_add_f32 v42, v42, v43
  v_smfmac_f32_16x16x64_bf16 v[44:47], v[24:27], a[144:151], v3
  v_cvt_pk_bf16_f32 v40, v40, v42
  v_smfmac_f32_16x16x64_bf16 v[44:47], v[28:31], a[152:159], v3
  ds_write_b32 v101, v40
  v_smfmac_f32_16x16x64_bf16 v[44:47], v[32:35], a[160:167], v3
  v_smfmac_f32_16x16x64_bf16 v[48:51], v[8:11], a[168:175], v3
  v_smfmac_f32_16x16x64_bf16 v[48:51], v[12:15], a[176:183], v3
  v_smfmac_f32_16x16x64_bf16 v[48:51], v[16:19], a[184:191], v3
  v_add_f32 v44, v44, v45
  v_smfmac_f32_16x16x64_bf16 v[48:51], v[20:23], a[192:199], v3
  v_add_f32 v46, v46, v47
  v_smfmac_f32_16x16x64_bf16 v[48:51], v[24:27], a[200:207], v3
  v_cvt_pk_bf16_f32 v44, v44, v46
  v_smfmac_f32_16x16x64_bf16 v[48:51], v[28:31], a[208:215], v3
  ds_write_b32 v102, v44
  v_smfmac_f32_16x16x64_bf16 v[48:51], v[32:35], a[216:223], v3
  v_smfmac_f32_16x16x64_bf16 v[52:55], v[8:11], a[224:231], v3
  v_smfmac_f32_16x16x64_bf16 v[52:55], v[12:15], a[232:239], v3
  v_smfmac_f32_16x16x64_bf16 v[52:55], v[16:19], a[240:247], v3
  v_add_f32 v48, v48, v49
  v_smfmac_f32_16x16x64_bf16 v[52:55], v[20:23], a[248:255], v3
  v_add_f32 v50, v50, v51
  v_smfmac_f32_16x16x64_bf16 v[52:55], v[24:27], v[120:127], v3
  v_cvt_pk_bf16_f32 v48, v48, v50
  v_smfmac_f32_16x16x64_bf16 v[52:55], v[28:31], v[128:135], v3
  ds_write_b32 v103, v48
  v_smfmac_f32_16x16x64_bf16 v[52:55], v[32:35], v[136:143], v3
  v_smfmac_f32_16x16x64_bf16 v[56:59], v[8:11], v[144:151], v3
  v_smfmac_f32_16x16x64_bf16 v[56:59], v[12:15], v[152:159], v3
  v_smfmac_f32_16x16x64_bf16 v[56:59], v[16:19], v[160:167], v3
  v_add_f32 v52, v52, v53
  v_smfmac_f32_16x16x64_bf16 v[56:59], v[20:23], v[168:175], v3
  v_add_f32 v54, v54, v55
  v_smfmac_f32_16x16x64_bf16 v[56:59], v[24:27], v[176:183], v3
  v_cvt_pk_bf16_f32 v52, v52, v54
  v_smfmac_f32_16x16x64_bf16 v[56:59], v[28:31], v[184:191], v3
  ds_write_b32 v104, v52
  v_smfmac_f32_16x16x64_bf16 v[56:59], v[32:35], v[192:199], v3
  s_nop 7
  v_add_f32 v56, v56, v57
  v_add_f32 v58, v58, v59
  v_cvt_pk_bf16_f32 v56, v56, v58
  ds_write_b32 v105, v56
  s_waitcnt lgkmcnt(0)
  s_barrier
  s_cmp_eq_u32 s19, 62
  s_cbranch_scc1 cA_done
  s_waitcnt vmcnt(0) lgkmcnt(0)
  s_add_u32 s19, s19, 1
  s_mov_b32 s20, s21
  s_branch cA_va3_loop
cA_va3_retry:
  s_waitcnt lgkmcnt(0)
  buffer_load_dwordx4 v[24:27], v2, s[8:11], s23 offen offset:0 sc1
  buffer_load_dwordx4 v[28:31], v2, s[8:11], s23 offen offset:1024 sc1
  buffer_load_dwordx4 v[32:35], v2, s[8:11], s23 offen offset:2048 sc1
  s_add_u32 s31, s31, 1
  s_add_u32 s30, s30, 1
  s_cmp_lt_u32 s30, 400000
  s_cbranch_scc1 cA_va3_ld
  s_branch cA_abort
cA_va3_last:
  s_waitcnt lgkmcnt(0)
  buffer_store_dwordx4 v[100:103], v2, s[8:11], s24 offen offset:0 sc1
  buffer_store_dwordx4 v[104:107], v2, s[8:11], s24 offen offset:1024 sc1
  buffer_store_dwordx4 v[108:111], v2, s[8:11], s24 offen offset:2048 sc1
  buffer_store_dwordx4 v[4:7], v2, s[8:11], s24 offen offset:3072 sc1
  s_add_u32 s24, s24, 8192
  s_waitcnt vmcnt(0)
  s_mov_b64 exec, 1
  buffer_store_dword v117, v2, s[8:11], s34 offen sc1
  s_mov_b64 exec, -1
  s_add_u32 s34, s34, 8
  s_mov_b64 exec, 1
  buffer_store_dword v117, v2, s[8:11], s34 offen sc1
  s_mov_b64 exec, -1
  s_add_u32 s34, s34, 8
  s_branch cA_done
cA_abort:
  v_mov_b32 v4, 0xdead
  v_mov_b32 v5, 16
  buffer_store_dword v4, v5, s[12:15], 0 offen
  s_branch ch_end
cA_done:
  s_branch ch_end
.p2align 6

cB_sc0_loop:
  s_add_u32 s23, s20, 4096
  s_add_u32 s21, s20, 20480
  v_mov_b32 v48, 0
  v_mov_b32 v49, 0
  v_mov_b32 v50, 0
  v_mov_b32 v51, 0
  v_mov_b32 v52, 0
  v_mov_b32 v53, 0
  v_mov_b32 v54, 0
  v_mov_b32 v55, 0
  v_mov_b32 v56, 0
  v_mov_b32 v57, 0
  v_mov_b32 v58, 0
  v_mov_b32 v59, 0
  v_mov_b32 v60, 0
  v_mov_b32 v61, 0
  v_mov_b32 v62, 0
  v_mov_b32 v63, 0
  v_mov_b32 v88, 0
  v_mov_b32 v89, 0
  v_mov_b32 v90, 0
  v_mov_b32 v91, 0
  v_mov_b32 v92, 0
  v_mov_b32 v93, 0
  v_mov_b32 v94, 0
  v_mov_b32 v95, 0
  v_mov_b32 v66, 0
  v_mov_b32 v67, 0
  s_mov_b32 s30, 0
  s_mov_b32 s62, 0
  buffer_load_dword v68, v0, s[8:11], s20 offen sc1
  s_nop 7
  buffer_load_dword v69, v0, s[8:11], s20 offen sc1
  s_nop 7
  buffer_load_dword v70, v0, s[8:11], s20 offen sc1
  s_nop 7
  buffer_load_dword v71, v0, s[8:11], s20 offen sc1
  s_nop 7
  buffer_load_dword v72, v0, s[8:11], s20 offen sc1
cB_sc0_fp_l:
  s_waitcnt vmcnt(4)
  v_cmp_eq_u32 vcc, -1, v68
  s_cbranch_vccz cB_sc0_fp_d
  buffer_load_dword v68, v0, s[8:11], s20 offen sc1
  s_waitcnt vmcnt(4)
  v_cmp_eq_u32 vcc, -1, v69
  s_cbranch_vccz cB_sc0_fp_d
  buffer_load_dword v69, v0, s[8:11], s20 offen sc1
  s_waitcnt vmcnt(4)
  v_cmp_eq_u32 vcc, -1, v70
  s_cbranch_vccz cB_sc0_fp_d
  buffer_load_dword v70, v0, s[8:11], s20 offen sc1
  s_waitcnt vmcnt(4)
  v_cmp_eq_u32 vcc, -1, v71
  s_cbranch_vccz cB_sc0_fp_d
  buffer_load_dword v71, v0, s[8:11], s20 offen sc1
  s_waitcnt vmcnt(4)
  v_cmp_eq_u32 vcc, -1, v72
  s_cbranch_vccz cB_sc0_fp_d
  buffer_load_dword v72, v0, s[8:11], s20 offen sc1
  s_add_u32 s30, s30, 1
  s_cmp_lt_u32 s30, 400000
  s_cbranch_scc1 cB_sc0_fp_l
  s_branch cB_abort
cB_sc0_fp_d:
  buffer_load_dwordx4 v[8:11], v2, s[8:11], s20 offen offset:0 sc1
  s_barrier
  s_branch cB_sc0_ld1
cB_sc0_ld:
  buffer_load_dwordx4 v[8:11], v2, s[8:11], s20 offen offset:0 sc1
cB_sc0_ld1:
  v_mov_b32 v36, 0
  v_mov_b32 v37, 0
  v_mov_b32 v38, 0
  v_mov_b32 v39, 0
  buffer_load_dwordx4 v[12:15], v2, s[8:11], s20 offen offset:1024 sc1
  v_mov_b32 v40, 0
  v_mov_b32 v41, 0
  v_mov_b32 v42, 0
  v_mov_b32 v43, 0
  buffer_load_dwordx4 v[16:19], v2, s[8:11], s20 offen offset:2048 sc1
  v_mov_b32 v44, 0
  v_mov_b32 v45, 0
  v_mov_b32 v46, 0
  v_mov_b32 v47, 0
  ds_read_b128 v[96:99], v117 offset:0
  ds_read_b128 v[100:103], v117 offset:1024
  ds_read_b128 v[104:107], v117 offset:14336
  ds_read_b128 v[108:111], v117 offset:15360
  s_waitcnt vmcnt(2)
  v_smfmac_f32_16x16x64_bf16 v[36:39], v[8:11], a[0:7], v3
  v_smfmac_f32_16x16x64_bf16 v[40:43], v[8:11], a[56:63], v3
  buffer_load_dwordx4 v[20:23], v2, s[8:11], s20 offen offset:3072 sc1
  v_smfmac_f32_16x16x64_bf16 v[44:47], v[8:11], a[112:119], v3
  v_smfmac_f32_16x16x64_bf16 v[48:51], v[8:11], a[168:175], v3
  v_smfmac_f32_16x16x64_bf16 v[52:55], v[8:11], a[224:231], v3
  buffer_load_dwordx4 v[24:27], v2, s[8:11], s23 offen offset:0 sc1
  v_smfmac_f32_16x16x64_bf16 v[56:59], v[8:11], v[144:151], v3
  v_smfmac_f32_16x16x64_bf16 v[60:63], v[8:11], v[200:207], v3
  s_waitcnt vmcnt(3)
  v_smfmac_f32_16x16x64_bf16 v[36:39], v[12:15], a[8:15], v3
  v_smfmac_f32_16x16x64_bf16 v[40:43], v[12:15], a[64:71], v3
  buffer_load_dwordx4 v[28:31], v2, s[8:11], s23 offen offset:1024 sc1
  v_smfmac_f32_16x16x64_bf16 v[44:47], v[12:15], a[120:127], v3
  v_smfmac_f32_16x16x64_bf16 v[48:51], v[12:15], a[176:183], v3
  v_smfmac_f32_16x16x64_bf16 v[52:55], v[12:15], a[232:239], v3
  buffer_load_dwordx4 v[32:35], v2, s[8:11], s23 offen offset:2048 sc1
  v_smfmac_f32_16x16x64_bf16 v[56:59], v[12:15], v[152:159], v3
  v_smfmac_f32_16x16x64_bf16 v[60:63], v[12:15], v[208:215], v3
  s_xor_b32 s58, s25, 28672
  s_add_u32 s59, s24, 28672
  s_add_u32 m0, s58, 0
  s_waitcnt vmcnt(4)
  v_smfmac_f32_16x16x64_bf16 v[36:39], v[16:19], a[16:23], v3
  buffer_load_dwordx4 v2, s[8:11], s59 offen offset:0 sc1 lds
  v_smfmac_f32_16x16x64_bf16 v[40:43], v[16:19], a[72:79], v3
  v_smfmac_f32_16x16x64_bf16 v[44:47], v[16:19], a[128:135], v3
  v_smfmac_f32_16x16x64_bf16 v[48:51], v[16:19], a[184:191], v3
  v_smfmac_f32_16x16x64_bf16 v[52:55], v[16:19], a[240:247], v3
  buffer_load_dwordx4 v2, s[8:11], s59 offen offset:1024 sc1 lds
  v_smfmac_f32_16x16x64_bf16 v[56:59], v[16:19], v[160:167], v3
  v_smfmac_f32_16x16x64_bf16 v[60:63], v[16:19], v[216:223], v3
  s_waitcnt vmcnt(5)
  v_smfmac_f32_16x16x64_bf16 v[36:39], v[20:23], a[24:31], v3
  v_smfmac_f32_16x16x64_bf16 v[40:43], v[20:23], a[80:87], v3
  buffer_load_dwordx4 v2, s[8:11], s59 offen offset:2048 sc1 lds
  v_smfmac_f32_16x16x64_bf16 v[44:47], v[20:23], a[136:143], v3
  v_smfmac_f32_16x16x64_bf16 v[48:51], v[20:23], a[192:199], v3
  v_smfmac_f32_16x16x64_bf16 v[52:55], v[20:23], a[248:255], v3
  v_smfmac_f32_16x16x64_bf16 v[56:59], v[20:23], v[168:175], v3
  buffer_load_dwordx4 v2, s[8:11], s59 offen offset:3072 sc1 lds
  v_smfmac_f32_16x16x64_bf16 v[60:63], v[20:23], v[224:231], v3
  s_waitcnt vmcnt(4)
cB_sc0_ph2:
  v_smfmac_f32_16x16x64_bf16 v[60:63], v[24:27], v[232:239], v3
  ds_read_b128 v[12:15], v116 offset:0
  ds_read_b128 v[16:19], v116 offset:1024
  v_smfmac_f32_16x16x64_bf16 v[60:63], v[28:31], v[240:247], v3
  v_smfmac_f32_16x16x64_bf16 v[60:63], v[32:35], v[248:255], v3
  v_mov_b32 v80, v24
  v_smfmac_f32_16x16x64_bf16 v[52:55], v[24:27], v[120:127], v3
  v_mov_b32 v81, v25
  v_smfmac_f32_16x16x64_bf16 v[52:55], v[28:31], v[128:135], v3
  v_mov_b32 v82, v32
  v_smfmac_f32_16x16x64_bf16 v[52:55], v[32:35], v[136:143], v3
  v_cvt_pk_bf16_f32 v64, v60, v61
  v_smfmac_f32_16x16x64_bf16 v[56:59], v[24:27], v[176:183], v3
  v_cvt_pk_bf16_f32 v65, v62, v63
  v_smfmac_f32_16x16x64_bf16 v[56:59], v[28:31], v[184:191], v3
  v_mov_b32 v83, v33
  v_mfma_f32_16x16x32_bf16 v[68:71], v[64:67], v[4:7], 0
  v_smfmac_f32_16x16x64_bf16 v[56:59], v[32:35], v[192:199], v3
  v_cvt_pk_bf16_f32 v64, v52, v53
  v_smfmac_f32_16x16x64_bf16 v[36:39], v[24:27], a[32:39], v3
  v_cvt_pk_bf16_f32 v65, v54, v55
  v_smfmac_f32_16x16x64_bf16 v[36:39], v[28:31], a[40:47], v3
  v_cvt_pk_bf16_f32 v78, v68, v69
  v_smfmac_f32_16x16x64_bf16 v[36:39], v[32:35], a[48:55], v3
  v_cvt_pk_bf16_f32 v79, v70, v71
  v_cvt_pk_bf16_f32 v66, v56, v57
  v_smfmac_f32_16x16x64_bf16 v[40:43], v[24:27], a[88:95], v3
  v_cvt_pk_bf16_f32 v67, v58, v59
  v_smfmac_f32_16x16x64_bf16 v[40:43], v[28:31], a[96:103], v3
  v_mfma_f32_16x16x32_bf16 v[72:75], v[64:67], v[4:7], 0
  ds_read_b128 v[52:55], v116 offset:14336
  ds_read_b128 v[56:59], v116 offset:15360
  v_smfmac_f32_16x16x64_bf16 v[40:43], v[32:35], a[104:111], v3
  v_cvt_pk_bf16_f32 v64, v36, v37
  v_smfmac_f32_16x16x64_bf16 v[44:47], v[24:27], a[144:151], v3
  v_cvt_pk_bf16_f32 v65, v38, v39
  v_smfmac_f32_16x16x64_bf16 v[44:47], v[28:31], a[152:159], v3
  v_cvt_pk_bf16_f32 v76, v72, v73
  v_smfmac_f32_16x16x64_bf16 v[44:47], v[32:35], a[160:167], v3
  v_cvt_pk_bf16_f32 v77, v74, v75
  v_cvt_pk_bf16_f32 v66, v40, v41
  v_smfmac_f32_16x16x64_bf16 v[48:51], v[24:27], a[200:207], v3
  v_cvt_pk_bf16_f32 v67, v42, v43
  v_smfmac_f32_16x16x64_bf16 v[48:51], v[28:31], a[208:215], v3
  v_mfma_f32_16x16x32_bf16 v[68:71], v[64:67], v[4:7], 0
  v_smfmac_f32_16x16x64_bf16 v[48:51], v[32:35], a[216:223], v3
  v_cvt_pk_bf16_f32 v64, v44, v45
  v_mfma_f32_16x16x32_bf16 v[84:87], v[80:83], v[76:79], 0
  v_cvt_pk_bf16_f32 v65, v46, v47
  s_waitcnt lgkmcnt(0)
  v_smfmac_f32_16x16x64_bf16 v[88:91], v[76:79], v[96:103], v118
  v_cvt_pk_bf16_f32 v60, v68, v69
  v_cvt_pk_bf16_f32 v61, v70, v71
  v_cvt_pk_bf16_f32 v66, v48, v49
  v_cvt_pk_bf16_f32 v67, v50, v51
  s_nop 1
  v_mfma_f32_16x16x32_bf16 v[72:75], v[64:67], v[4:7], 0
  v_smfmac_f32_16x16x64_bf16 v[92:95], v[76:79], v[104:111], v118
  s_nop 4
  v_cvt_pk_bf16_f32 v62, v72, v73
  v_cvt_pk_bf16_f32 v63, v74, v75
  s_nop 1
  v_mfma_f32_16x16x32_bf16 v[84:87], v[8:11], v[60:63], v[84:87]
  v_smfmac_f32_16x16x64_bf16 v[88:91], v[60:63], v[12:19], v118
  v_smfmac_f32_16x16x64_bf16 v[92:95], v[60:63], v[52:59], v118
  s_nop 1
  v_permlane32_swap_b32 v84, v86
  v_permlane32_swap_b32 v85, v87
  s_nop 0
  v_add_f32 v88, v88, v89
  v_add_f32_dpp v84, v86, v84 quad_perm:[1,0,3,2] row_mask:0xf bank_mask:0xf
  v_add_f32_dpp v85, v87, v85 quad_perm:[1,0,3,2] row_mask:0xf bank_mask:0xf
  v_add_f32 v89, v90, v91
  ds_write2_b32 v113, v84, v85 offset0:0 offset1:4
  ds_write2_b32 v112, v88, v89 offset0:0 offset1:128
  v_add_f32 v90, v92, v93
  v_add_f32 v91, v94, v95
  ds_write2_b32 v112, v90, v91 offset0:64 offset1:192
  v_cmp_u_f32 vcc, v88, v89
  s_cbranch_vccnz cB_sc0_retry
cB_sc0_cont:
  s_waitcnt lgkmcnt(0)
  s_barrier
  ds_read_b128 v[36:39], v114
  ds_read_b128 v[44:47], v115
  s_waitcnt lgkmcnt(0)
  v_add_f32 v36, v36, v38
  v_add_f32 v37, v37, v39
  v_add_f32 v44, v44, v45
  buffer_store_dword v2, v119, s[8:11], s20 offen sc1
  v_add_f32 v46, v46, v47
  v_add_f32 v44, v44, v46
  v_add_f32 v36, v36, v37
  v_exp_f32 v49, v44
  v_exp_f32 v48, v36
  v_add_f32 v50, abs(v36), abs(v44)
  v_fma_f32 v39, v49, s37, v48
  v_cmp_ngt_f32 vcc, s56, v50
  v_cndmask_b32 v41, v48, v49, s[38:39]
  v_add_f32_dpp v39, v39, v39 quad_perm:[1,0,3,2] row_mask:0xf bank_mask:0xf
  v_cndmask_b32 v40, v49, v48, s[38:39]
  v_mov_b32_dpp v46, v41 quad_perm:[1,0,3,2] row_mask:0xf bank_mask:0xf
  v_add_f32_dpp v39, v39, v39 quad_perm:[2,3,0,1] row_mask:0xf bank_mask:0xf
  v_cndmask_b32 v42, v46, v40, s[38:39]
  v_cndmask_b32 v43, v40, v46, s[38:39]
  v_add_f32_dpp v39, v39, v39 row_half_mirror row_mask:0xf bank_mask:0xf
  s_cbranch_vccnz cB_sc0_slow
  s_nop 0
  v_add_f32_dpp v47, v39, v39 row_mirror row_mask:0xf bank_mask:0xf
  v_add_f32_dpp v39, v39, v39 row_mirror row_mask:0xf bank_mask:0xf
  s_nop 1
  v_permlane16_swap_b32 v39, v47
  v_add_f32 v39, v39, v47
  v_rcp_f32 v39, v39
  s_mov_b64 exec, s[28:29]
  v_mul_f32 v42, v42, v39
  v_mul_f32 v43, v43, v39
  v_cvt_pk_bf16_f32 v42, v42, v43
cB_sc0_pst:
  buffer_store_dword v42, v1, s[8:11], s20 offen sc1
  s_mov_b64 exec, -1
  s_barrier
  s_cmp_lg_u32 s19, 0
  s_cbranch_scc1 cB_sc0_s0
  s_sub_u32 s36, s36, 64
  v_subrev_u32 v119, 64, v119
  v_lshl_add_u32 v56, v2, 3, s36
  s_mov_b64 exec, 15
  buffer_store_dword v2, v56, s[8:11], s20 offen sc1
  s_mov_b64 exec, -1
cB_sc0_s0:
  s_add_u32 s24, s24, 28672
  s_add_u32 s35, s35, 28672
  s_xor_b32 s25, s25, 28672
  s_add_u32 m0, s25, 0
  s_add_u32 m0, s25, 4096
  s_add_u32 s22, s24, 4096
  buffer_load_dwordx4 v2, s[8:11], s22 offen offset:0 sc1 lds
  s_nop 5
  buffer_load_dwordx4 v2, s[8:11], s22 offen offset:1024 sc1 lds
  s_nop 5
  buffer_load_dwordx4 v2, s[8:11], s22 offen offset:2048 sc1 lds
  s_nop 5
  v_xor_b32 v116, 28672, v116
  v_add_u32 v117, s57, v117
  s_sub_u32 s57, 0, s57
  s_add_u32 s19, s19, 1
  s_mov_b32 s20, s21
  s_cmp_lt_u32 s19, 63
  s_cbranch_scc1 cB_sc0_loop
  s_branch cB_done
cB_sc0_slow:
  v_max_f32 v50, v36, v44
  s_nop 1
  v_max_f32_dpp v50, v50, v50 quad_perm:[1,0,3,2] row_mask:0xf bank_mask:0xf
  s_nop 1
  v_max_f32_dpp v50, v50, v50 quad_perm:[2,3,0,1] row_mask:0xf bank_mask:0xf
  s_nop 1
  v_max_f32_dpp v50, v50, v50 row_half_mirror row_mask:0xf bank_mask:0xf
  s_nop 1
  v_max_f32_dpp v50, v50, v50 row_mirror row_mask:0xf bank_mask:0xf
  v_mov_b32 v47, v50
  s_nop 1
  v_permlane16_swap_b32 v50, v47
  v_max_f32 v50, v50, v47
  v_sub_f32 v48, v36, v50
  v_sub_f32 v49, v44, v50
  v_exp_f32 v48, v48
  v_exp_f32 v49, v49
  s_add_u32 s31, s31, 0x100
  v_fma_f32 v39, v49, s37, v48
  v_cndmask_b32 v41, v48, v49, s[38:39]
  s_nop 0
  v_add_f32_dpp v39, v39, v39 quad_perm:[1,0,3,2] row_mask:0xf bank_mask:0xf
  v_cndmask_b32 v40, v49, v48, s[38:39]
  v_mov_b32_dpp v46, v41 quad_perm:[1,0,3,2] row_mask:0xf bank_mask:0xf
  v_add_f32_dpp v39, v39, v39 quad_perm:[2,3,0,1] row_mask:0xf bank_mask:0xf
  v_cndmask_b32 v42, v46, v40, s[38:39]
  v_cndmask_b32 v43, v40, v46, s[38:39]
  v_add_f32_dpp v39, v39, v39 row_half_mirror row_mask:0xf bank_mask:0xf
  s_nop 1
  v_add_f32_dpp v47, v39, v39 row_mirror row_mask:0xf bank_mask:0xf
  v_add_f32_dpp v39, v39, v39 row_mirror row_mask:0xf bank_mask:0xf
  s_nop 1
  v_permlane16_swap_b32 v39, v47
  v_add_f32 v39, v39, v47
  v_rcp_f32 v39, v39
  s_mov_b64 exec, s[28:29]
  v_mul_f32 v42, v42, v39
  v_mul_f32 v43, v43, v39
  v_cvt_pk_bf16_f32 v42, v42, v43
  v_min_u32 v42, -2, v42
  s_branch cB_sc0_pst
cB_sc0_retry:
  s_cmp_lg_u32 s62, 0
  s_cbranch_scc1 cB_sc0_cont
  s_waitcnt vmcnt(0) lgkmcnt(0)
cB_sc0_rv:
  buffer_load_dwordx4 v[8:11], v2, s[8:11], s20 offen offset:0 sc1
  buffer_load_dwordx4 v[12:15], v2, s[8:11], s20 offen offset:1024 sc1
  buffer_load_dwordx4 v[16:19], v2, s[8:11], s20 offen offset:2048 sc1
  buffer_load_dwordx4 v[20:23], v2, s[8:11], s20 offen offset:3072 sc1
  buffer_load_dwordx4 v[24:27], v2, s[8:11], s23 offen offset:0 sc1
  buffer_load_dwordx4 v[28:31], v2, s[8:11], s23 offen offset:1024 sc1
  buffer_load_dwordx4 v[32:35], v2, s[8:11], s23 offen offset:2048 sc1
  s_waitcnt vmcnt(0)
  v_max3_u32 v68, v8, v9, v10
  v_max3_u32 v68, v68, v11, v12
  v_max3_u32 v68, v68, v13, v14
  v_max3_u32 v68, v68, v15, v16
  v_max3_u32 v68, v68, v17, v18
  v_max3_u32 v68, v68, v19, v20
  v_max3_u32 v68, v68, v21, v22
  v_max3_u32 v68, v68, v23, v24
  v_max3_u32 v68, v68, v25, v26
  v_max3_u32 v68, v68, v27, v28
  v_max3_u32 v68, v68, v29, v30
  v_max3_u32 v68, v68, v31, v32
  v_max3_u32 v68, v68, v33, v34
  v_max_u32 v68, v68, v35
  v_cmp_eq_u32 vcc, -1, v68
  s_cbranch_vccz cB_sc0_rk
  s_add_u32 s30, s30, 1
  s_cmp_lt_u32 s30, 400000
  s_cbranch_scc1 cB_sc0_rv
  s_branch cB_abort
cB_sc0_rk:
  s_mov_b32 s62, 1
  v_mov_b32 v36, 0
  v_mov_b32 v37, 0
  v_mov_b32 v38, 0
  v_mov_b32 v39, 0
  v_mov_b32 v40, 0
  v_mov_b32 v41, 0
  v_mov_b32 v42, 0
  v_mov_b32 v43, 0
  v_mov_b32 v44, 0
  v_mov_b32 v45, 0
  v_mov_b32 v46, 0
  v_mov_b32 v47, 0
  v_mov_b32 v48, 0
  v_mov_b32 v49, 0
  v_mov_b32 v50, 0
  v_mov_b32 v51, 0
  v_mov_b32 v52, 0
  v_mov_b32 v53, 0
  v_mov_b32 v54, 0
  v_mov_b32 v55, 0
  v_mov_b32 v56, 0
  v_mov_b32 v57, 0
  v_mov_b32 v58, 0
  v_mov_b32 v59, 0
  v_mov_b32 v60, 0
  v_mov_b32 v61, 0
  v_mov_b32 v62, 0
  v_mov_b32 v63, 0
  v_mov_b32 v88, 0
  v_mov_b32 v89, 0
  v_mov_b32 v90, 0
  v_mov_b32 v91, 0
  v_mov_b32 v92, 0
  v_mov_b32 v93, 0
  v_mov_b32 v94, 0
  v_mov_b32 v95, 0
  v_mov_b32 v66, 0
  v_mov_b32 v67, 0
  s_add_u32 s31, s31, 1
  ds_read_b128 v[96:99], v117 offset:0
  ds_read_b128 v[100:103], v117 offset:1024
  ds_read_b128 v[104:107], v117 offset:14336
  ds_read_b128 v[108:111], v117 offset:15360
  v_smfmac_f32_16x16x64_bf16 v[36:39], v[8:11], a[0:7], v3
  v_smfmac_f32_16x16x64_bf16 v[40:43], v[8:11], a[56:63], v3
  v_smfmac_f32_16x16x64_bf16 v[44:47], v[8:11], a[112:119], v3
  v_smfmac_f32_16x16x64_bf16 v[48:51], v[8:11], a[168:175], v3
  v_smfmac_f32_16x16x64_bf16 v[52:55], v[8:11], a[224:231], v3
  v_smfmac_f32_16x16x64_bf16 v[56:59], v[8:11], v[144:151], v3
  v_smfmac_f32_16x16x64_bf16 v[60:63], v[8:11], v[200:207], v3
  v_smfmac_f32_16x16x64_bf16 v[36:39], v[12:15], a[8:15], v3
  v_smfmac_f32_16x16x64_bf16 v[40:43], v[12:15], a[64:71], v3
  v_smfmac_f32_16x16x64_bf16 v[44:47], v[12:15], a[120:127], v3
  v_smfmac_f32_16x16x64_bf16 v[48:51], v[12:15], a[176:183], v3
  v_smfmac_f32_16x16x64_bf16 v[52:55], v[12:15], a[232:239], v3
  v_smfmac_f32_16x16x64_bf16 v[56:59], v[12:15], v[152:159], v3
  v_smfmac_f32_16x16x64_bf16 v[60:63], v[12:15], v[208:215], v3
  v_smfmac_f32_16x16x64_bf16 v[36:39], v[16:19], a[16:23], v3
  v_smfmac_f32_16x16x64_bf16 v[40:43], v[16:19], a[72:79], v3
  v_smfmac_f32_16x16x64_bf16 v[44:47], v[16:19], a[128:135], v3
  v_smfmac_f32_16x16x64_bf16 v[48:51], v[16:19], a[184:191], v3
  v_smfmac_f32_16x16x64_bf16 v[52:55], v[16:19], a[240:247], v3
  v_smfmac_f32_16x16x64_bf16 v[56:59], v[16:19], v[160:167], v3
  v_smfmac_f32_16x16x64_bf16 v[60:63], v[16:19], v[216:223], v3
  v_smfmac_f32_16x16x64_bf16 v[36:39], v[20:23], a[24:31], v3
  v_smfmac_f32_16x16x64_bf16 v[40:43], v[20:23], a[80:87], v3
  v_smfmac_f32_16x16x64_bf16 v[44:47], v[20:23], a[136:143], v3
  v_smfmac_f32_16x16x64_bf16 v[48:51], v[20:23], a[192:199], v3
  v_smfmac_f32_16x16x64_bf16 v[52:55], v[20:23], a[248:255], v3
  v_smfmac_f32_16x16x64_bf16 v[56:59], v[20:23], v[168:175], v3
  v_smfmac_f32_16x16x64_bf16 v[60:63], v[20:23], v[224:231], v3
  s_xor_b32 s58, s25, 28672
  s_add_u32 s59, s24, 28672
  s_add_u32 m0, s58, 0
  s_branch cB_sc0_ph2
.p2align 6

cB_sc1_loop:
  s_add_u32 s23, s20, 4096
  s_add_u32 s21, s20, 20480
  v_mov_b32 v48, 0
  v_mov_b32 v49, 0
  v_mov_b32 v50, 0
  v_mov_b32 v51, 0
  v_mov_b32 v52, 0
  v_mov_b32 v53, 0
  v_mov_b32 v54, 0
  v_mov_b32 v55, 0
  v_mov_b32 v56, 0
  v_mov_b32 v57, 0
  v_mov_b32 v58, 0
  v_mov_b32 v59, 0
  v_mov_b32 v60, 0
  v_mov_b32 v61, 0
  v_mov_b32 v62, 0
  v_mov_b32 v63, 0
  v_mov_b32 v88, 0
  v_mov_b32 v89, 0
  v_mov_b32 v90, 0
  v_mov_b32 v91, 0
  v_mov_b32 v92, 0
  v_mov_b32 v93, 0
  v_mov_b32 v94, 0
  v_mov_b32 v95, 0
  v_mov_b32 v64, 0
  v_mov_b32 v65, 0
  s_mov_b32 s30, 0
  s_mov_b32 s62, 0
  s_waitcnt vmcnt(0)
  s_barrier
cB_sc1_ld:
  buffer_load_dwordx4 v[8:11], v2, s[8:11], s20 offen offset:0 sc1
  v_mov_b32 v36, 0
  v_mov_b32 v37, 0
  v_mov_b32 v38, 0
  v_mov_b32 v39, 0
  buffer_load_dwordx4 v[12:15], v2, s[8:11], s20 offen offset:1024 sc1
  v_mov_b32 v40, 0
  v_mov_b32 v41, 0
  v_mov_b32 v42, 0
  v_mov_b32 v43, 0
  buffer_load_dwordx4 v[16:19], v2, s[8:11], s20 offen offset:2048 sc1
  v_mov_b32 v44, 0
  v_mov_b32 v45, 0
  v_mov_b32 v46, 0
  v_mov_b32 v47, 0
  ds_read_b128 v[96:99], v117 offset:0
  ds_read_b128 v[100:103], v117 offset:1024
  ds_read_b128 v[104:107], v117 offset:14336
  ds_read_b128 v[108:111], v117 offset:15360
  s_waitcnt vmcnt(2)
  v_smfmac_f32_16x16x64_bf16 v[36:39], v[8:11], a[0:7], v3
  v_smfmac_f32_16x16x64_bf16 v[40:43], v[8:11], a[56:63], v3
  buffer_load_dwordx4 v[20:23], v2, s[8:11], s20 offen offset:3072 sc1
  v_smfmac_f32_16x16x64_bf16 v[44:47], v[8:11], a[112:119], v3
  v_smfmac_f32_16x16x64_bf16 v[48:51], v[8:11], a[168:175], v3
  v_smfmac_f32_16x16x64_bf16 v[52:55], v[8:11], a[224:231], v3
  buffer_load_dwordx4 v[24:27], v2, s[8:11], s23 offen offset:0 sc1
  v_smfmac_f32_16x16x64_bf16 v[56:59], v[8:11], v[144:151], v3
  v_smfmac_f32_16x16x64_bf16 v[60:63], v[8:11], v[200:207], v3
  s_waitcnt vmcnt(3)
  v_smfmac_f32_16x16x64_bf16 v[36:39], v[12:15], a[8:15], v3
  v_smfmac_f32_16x16x64_bf16 v[40:43], v[12:15], a[64:71], v3
  buffer_load_dwordx4 v[28:31], v2, s[8:11], s23 offen offset:1024 sc1
  v_smfmac_f32_16x16x64_bf16 v[44:47], v[12:15], a[120:127], v3
  v_smfmac_f32_16x16x64_bf16 v[48:51], v[12:15], a[176:183], v3
  v_smfmac_f32_16x16x64_bf16 v[52:55], v[12:15], a[232:239], v3
  buffer_load_dwordx4 v[32:35], v2, s[8:11], s23 offen offset:2048 sc1
  v_smfmac_f32_16x16x64_bf16 v[56:59], v[12:15], v[152:159], v3
  v_smfmac_f32_16x16x64_bf16 v[60:63], v[12:15], v[208:215], v3
  s_waitcnt vmcnt(4)
  v_smfmac_f32_16x16x64_bf16 v[36:39], v[16:19], a[16:23], v3
  s_xor_b32 s58, s25, 28672
  s_add_u32 s59, s24, 28672
  s_add_u32 m0, s58, 7168
  v_smfmac_f32_16x16x64_bf16 v[40:43], v[16:19], a[72:79], v3
  buffer_load_dwordx4 v2, s[8:11], s59 offen offset:0 sc1 lds
  v_smfmac_f32_16x16x64_bf16 v[44:47], v[16:19], a[128:135], v3
  v_smfmac_f32_16x16x64_bf16 v[48:51], v[16:19], a[184:191], v3
  v_smfmac_f32_16x16x64_bf16 v[52:55], v[16:19], a[240:247], v3
  v_smfmac_f32_16x16x64_bf16 v[56:59], v[16:19], v[160:167], v3
  buffer_load_dwordx4 v2, s[8:11], s59 offen offset:1024 sc1 lds
  v_smfmac_f32_16x16x64_bf16 v[60:63], v[16:19], v[216:223], v3
  s_waitcnt vmcnt(5)
  v_smfmac_f32_16x16x64_bf16 v[36:39], v[20:23], a[24:31], v3
  v_smfmac_f32_16x16x64_bf16 v[40:43], v[20:23], a[80:87], v3
  v_smfmac_f32_16x16x64_bf16 v[44:47], v[20:23], a[136:143], v3
  buffer_load_dwordx4 v2, s[8:11], s59 offen offset:2048 sc1 lds
  v_smfmac_f32_16x16x64_bf16 v[48:51], v[20:23], a[192:199], v3
  v_smfmac_f32_16x16x64_bf16 v[52:55], v[20:23], a[248:255], v3
  v_smfmac_f32_16x16x64_bf16 v[56:59], v[20:23], v[168:175], v3
  v_smfmac_f32_16x16x64_bf16 v[60:63], v[20:23], v[224:231], v3
  buffer_load_dwordx4 v2, s[8:11], s59 offen offset:3072 sc1 lds
  s_waitcnt vmcnt(4)
cB_sc1_ph2:
  v_smfmac_f32_16x16x64_bf16 v[60:63], v[24:27], v[232:239], v3
  ds_read_b128 v[16:19], v116 offset:2048
  ds_read_b128 v[20:23], v116 offset:3072
  v_smfmac_f32_16x16x64_bf16 v[60:63], v[28:31], v[240:247], v3
  buffer_load_dword v119, v0, s[8:11], s20 offen sc1
  v_smfmac_f32_16x16x64_bf16 v[60:63], v[32:35], v[248:255], v3
  v_mov_b32 v80, v26
  v_smfmac_f32_16x16x64_bf16 v[52:55], v[24:27], v[120:127], v3
  v_mov_b32 v81, v27
  v_smfmac_f32_16x16x64_bf16 v[52:55], v[28:31], v[128:135], v3
  v_mov_b32 v82, v32
  v_smfmac_f32_16x16x64_bf16 v[52:55], v[32:35], v[136:143], v3
  v_cvt_pk_bf16_f32 v66, v60, v61
  v_smfmac_f32_16x16x64_bf16 v[56:59], v[24:27], v[176:183], v3
  v_cvt_pk_bf16_f32 v67, v62, v63
  v_smfmac_f32_16x16x64_bf16 v[56:59], v[28:31], v[184:191], v3
  v_mov_b32 v83, v33
  v_mfma_f32_16x16x32_bf16 v[68:71], v[64:67], v[4:7], 0
  v_smfmac_f32_16x16x64_bf16 v[56:59], v[32:35], v[192:199], v3
  v_cvt_pk_bf16_f32 v64, v52, v53
  v_smfmac_f32_16x16x64_bf16 v[36:39], v[24:27], a[32:39], v3
  v_cvt_pk_bf16_f32 v65, v54, v55
  v_smfmac_f32_16x16x64_bf16 v[36:39], v[28:31], a[40:47], v3
  v_cvt_pk_bf16_f32 v78, v68, v69
  v_smfmac_f32_16x16x64_bf16 v[36:39], v[32:35], a[48:55], v3
  v_cvt_pk_bf16_f32 v79, v70, v71
  v_cvt_pk_bf16_f32 v66, v56, v57
  v_smfmac_f32_16x16x64_bf16 v[40:43], v[24:27], a[88:95], v3
  v_cvt_pk_bf16_f32 v67, v58, v59
  v_smfmac_f32_16x16x64_bf16 v[40:43], v[28:31], a[96:103], v3
  v_mfma_f32_16x16x32_bf16 v[72:75], v[64:67], v[4:7], 0
  ds_read_b128 v[52:55], v116 offset:16384
  ds_read_b128 v[56:59], v116 offset:17408
  v_smfmac_f32_16x16x64_bf16 v[40:43], v[32:35], a[104:111], v3
  v_cvt_pk_bf16_f32 v64, v36, v37
  v_smfmac_f32_16x16x64_bf16 v[44:47], v[24:27], a[144:151], v3
  v_cvt_pk_bf16_f32 v65, v38, v39
  v_smfmac_f32_16x16x64_bf16 v[44:47], v[28:31], a[152:159], v3
  v_cvt_pk_bf16_f32 v76, v72, v73
  v_smfmac_f32_16x16x64_bf16 v[44:47], v[32:35], a[160:167], v3
  v_cvt_pk_bf16_f32 v77, v74, v75
  v_cvt_pk_bf16_f32 v66, v40, v41
  v_smfmac_f32_16x16x64_bf16 v[48:51], v[24:27], a[200:207], v3
  v_cvt_pk_bf16_f32 v67, v42, v43
  v_smfmac_f32_16x16x64_bf16 v[48:51], v[28:31], a[208:215], v3
  v_mfma_f32_16x16x32_bf16 v[68:71], v[64:67], v[4:7], 0
  v_smfmac_f32_16x16x64_bf16 v[48:51], v[32:35], a[216:223], v3
  v_cvt_pk_bf16_f32 v64, v44, v45
  v_mfma_f32_16x16x32_bf16 v[84:87], v[80:83], v[76:79], 0
  v_cvt_pk_bf16_f32 v65, v46, v47
  s_waitcnt lgkmcnt(0)
  v_smfmac_f32_16x16x64_bf16 v[88:91], v[76:79], v[96:103], v118
  v_cvt_pk_bf16_f32 v60, v68, v69
  v_cvt_pk_bf16_f32 v61, v70, v71
  v_cvt_pk_bf16_f32 v66, v48, v49
  v_cvt_pk_bf16_f32 v67, v50, v51
  s_nop 1
  v_mfma_f32_16x16x32_bf16 v[72:75], v[64:67], v[4:7], 0
  v_smfmac_f32_16x16x64_bf16 v[92:95], v[76:79], v[104:111], v118
  s_nop 4
  v_cvt_pk_bf16_f32 v62, v72, v73
  v_cvt_pk_bf16_f32 v63, v74, v75
  s_nop 1
  v_mfma_f32_16x16x32_bf16 v[84:87], v[12:15], v[60:63], v[84:87]
  v_smfmac_f32_16x16x64_bf16 v[88:91], v[60:63], v[16:23], v118
  v_smfmac_f32_16x16x64_bf16 v[92:95], v[60:63], v[52:59], v118
  s_nop 1
  v_permlane32_swap_b32 v84, v86
  v_permlane32_swap_b32 v85, v87
  s_nop 0
  v_add_f32 v88, v88, v89
  v_add_f32_dpp v84, v86, v84 quad_perm:[1,0,3,2] row_mask:0xf bank_mask:0xf
  v_add_f32_dpp v85, v87, v85 quad_perm:[1,0,3,2] row_mask:0xf bank_mask:0xf
  v_add_f32 v89, v90, v91
  ds_write2_b32 v113, v84, v85 offset0:0 offset1:4
  ds_write2_b32 v112, v88, v89 offset0:0 offset1:128
  v_add_f32 v90, v92, v93
  v_add_f32 v91, v94, v95
  ds_write2_b32 v112, v90, v91 offset0:64 offset1:192
  v_cmp_u_f32 vcc, v88, v89
  s_cbranch_vccnz cB_sc1_retry
cB_sc1_cont:
  s_waitcnt lgkmcnt(0)
  s_barrier
  ds_read_b128 v[36:39], v114
  ds_read_b128 v[44:47], v115
  s_waitcnt lgkmcnt(0)
  v_add_f32 v36, v36, v38
  v_add_f32 v37, v37, v39
  v_add_f32 v44, v44, v45
  v_add_f32 v46, v46, v47
  v_add_f32 v44, v44, v46
  v_add_f32 v36, v36, v37
  v_exp_f32 v49, v44
  v_exp_f32 v48, v36
  v_add_f32 v50, abs(v36), abs(v44)
  v_fma_f32 v39, v49, s37, v48
  v_cmp_ngt_f32 vcc, s56, v50
  v_cndmask_b32 v41, v48, v49, s[38:39]
  v_add_f32_dpp v39, v39, v39 quad_perm:[1,0,3,2] row_mask:0xf bank_mask:0xf
  v_cndmask_b32 v40, v49, v48, s[38:39]
  v_mov_b32_dpp v46, v41 quad_perm:[1,0,3,2] row_mask:0xf bank_mask:0xf
  v_add_f32_dpp v39, v39, v39 quad_perm:[2,3,0,1] row_mask:0xf bank_mask:0xf
  v_cndmask_b32 v42, v46, v40, s[38:39]
  v_cndmask_b32 v43, v40, v46, s[38:39]
  v_add_f32_dpp v39, v39, v39 row_half_mirror row_mask:0xf bank_mask:0xf
  s_cbranch_vccnz cB_sc1_slow
  s_nop 0
  v_add_f32_dpp v47, v39, v39 row_mirror row_mask:0xf bank_mask:0xf
  v_add_f32_dpp v39, v39, v39 row_mirror row_mask:0xf bank_mask:0xf
  s_nop 1
  v_permlane16_swap_b32 v39, v47
  v_add_f32 v39, v39, v47
  v_rcp_f32 v39, v39
  s_mov_b64 exec, s[28:29]
  v_mul_f32 v42, v42, v39
  v_mul_f32 v43, v43, v39
  v_cvt_pk_bf16_f32 v42, v42, v43
cB_sc1_pst:
  buffer_store_dword v42, v1, s[8:11], s20 offen sc1
  s_mov_b64 exec, -1
  s_barrier
  s_add_u32 s24, s24, 28672
  s_add_u32 s35, s35, 28672
  s_xor_b32 s25, s25, 28672
  s_add_u32 m0, s25, 7168
  s_add_u32 m0, s25, 11264
  s_add_u32 s22, s24, 4096
  buffer_load_dwordx4 v2, s[8:11], s22 offen offset:0 sc1 lds
  s_nop 5
  buffer_load_dwordx4 v2, s[8:11], s22 offen offset:1024 sc1 lds
  s_nop 5
  buffer_load_dwordx4 v2, s[8:11], s22 offen offset:2048 sc1 lds
  s_nop 5
  v_xor_b32 v116, 28672, v116
  v_add_u32 v117, s57, v117
  s_sub_u32 s57, 0, s57
  s_add_u32 s19, s19, 1
  s_mov_b32 s20, s21
  s_cmp_lt_u32 s19, 63
  s_cbranch_scc1 cB_sc1_loop
  s_branch cB_done
cB_sc1_slow:
  v_max_f32 v50, v36, v44
  s_nop 1
  v_max_f32_dpp v50, v50, v50 quad_perm:[1,0,3,2] row_mask:0xf bank_mask:0xf
  s_nop 1
  v_max_f32_dpp v50, v50, v50 quad_perm:[2,3,0,1] row_mask:0xf bank_mask:0xf
  s_nop 1
  v_max_f32_dpp v50, v50, v50 row_half_mirror row_mask:0xf bank_mask:0xf
  s_nop 1
  v_max_f32_dpp v50, v50, v50 row_mirror row_mask:0xf bank_mask:0xf
  v_mov_b32 v47, v50
  s_nop 1
  v_permlane16_swap_b32 v50, v47
  v_max_f32 v50, v50, v47
  v_sub_f32 v48, v36, v50
  v_sub_f32 v49, v44, v50
  v_exp_f32 v48, v48
  v_exp_f32 v49, v49
  s_add_u32 s31, s31, 0x100
  v_fma_f32 v39, v49, s37, v48
  v_cndmask_b32 v41, v48, v49, s[38:39]
  s_nop 0
  v_add_f32_dpp v39, v39, v39 quad_perm:[1,0,3,2] row_mask:0xf bank_mask:0xf
  v_cndmask_b32 v40, v49, v48, s[38:39]
  v_mov_b32_dpp v46, v41 quad_perm:[1,0,3,2] row_mask:0xf bank_mask:0xf
  v_add_f32_dpp v39, v39, v39 quad_perm:[2,3,0,1] row_mask:0xf bank_mask:0xf
  v_cndmask_b32 v42, v46, v40, s[38:39]
  v_cndmask_b32 v43, v40, v46, s[38:39]
  v_add_f32_dpp v39, v39, v39 row_half_mirror row_mask:0xf bank_mask:0xf
  s_nop 1
  v_add_f32_dpp v47, v39, v39 row_mirror row_mask:0xf bank_mask:0xf
  v_add_f32_dpp v39, v39, v39 row_mirror row_mask:0xf bank_mask:0xf
  s_nop 1
  v_permlane16_swap_b32 v39, v47
  v_add_f32 v39, v39, v47
  v_rcp_f32 v39, v39
  s_mov_b64 exec, s[28:29]
  v_mul_f32 v42, v42, v39
  v_mul_f32 v43, v43, v39
  v_cvt_pk_bf16_f32 v42, v42, v43
  v_min_u32 v42, -2, v42
  s_branch cB_sc1_pst
cB_sc1_retry:
  s_cmp_lg_u32 s62, 0
  s_cbranch_scc1 cB_sc1_cont
  s_waitcnt vmcnt(0) lgkmcnt(0)
cB_sc1_rv:
  buffer_load_dwordx4 v[8:11], v2, s[8:11], s20 offen offset:0 sc1
  buffer_load_dwordx4 v[12:15], v2, s[8:11], s20 offen offset:1024 sc1
  buffer_load_dwordx4 v[16:19], v2, s[8:11], s20 offen offset:2048 sc1
  buffer_load_dwordx4 v[20:23], v2, s[8:11], s20 offen offset:3072 sc1
  buffer_load_dwordx4 v[24:27], v2, s[8:11], s23 offen offset:0 sc1
  buffer_load_dwordx4 v[28:31], v2, s[8:11], s23 offen offset:1024 sc1
  buffer_load_dwordx4 v[32:35], v2, s[8:11], s23 offen offset:2048 sc1
  s_waitcnt vmcnt(0)
  v_max3_u32 v68, v8, v9, v10
  v_max3_u32 v68, v68, v11, v12
  v_max3_u32 v68, v68, v13, v14
  v_max3_u32 v68, v68, v15, v16
  v_max3_u32 v68, v68, v17, v18
  v_max3_u32 v68, v68, v19, v20
  v_max3_u32 v68, v68, v21, v22
  v_max3_u32 v68, v68, v23, v24
  v_max3_u32 v68, v68, v25, v26
  v_max3_u32 v68, v68, v27, v28
  v_max3_u32 v68, v68, v29, v30
  v_max3_u32 v68, v68, v31, v32
  v_max3_u32 v68, v68, v33, v34
  v_max_u32 v68, v68, v35
  v_cmp_eq_u32 vcc, -1, v68
  s_cbranch_vccz cB_sc1_rk
  s_add_u32 s30, s30, 1
  s_cmp_lt_u32 s30, 400000
  s_cbranch_scc1 cB_sc1_rv
  s_branch cB_abort
cB_sc1_rk:
  s_mov_b32 s62, 1
  v_mov_b32 v36, 0
  v_mov_b32 v37, 0
  v_mov_b32 v38, 0
  v_mov_b32 v39, 0
  v_mov_b32 v40, 0
  v_mov_b32 v41, 0
  v_mov_b32 v42, 0
  v_mov_b32 v43, 0
  v_mov_b32 v44, 0
  v_mov_b32 v45, 0
  v_mov_b32 v46, 0
  v_mov_b32 v47, 0
  v_mov_b32 v48, 0
  v_mov_b32 v49, 0
  v_mov_b32 v50, 0
  v_mov_b32 v51, 0
  v_mov_b32 v52, 0
  v_mov_b32 v53, 0
  v_mov_b32 v54, 0
  v_mov_b32 v55, 0
  v_mov_b32 v56, 0
  v_mov_b32 v57, 0
  v_mov_b32 v58, 0
  v_mov_b32 v59, 0
  v_mov_b32 v60, 0
  v_mov_b32 v61, 0
  v_mov_b32 v62, 0
  v_mov_b32 v63, 0
  v_mov_b32 v88, 0
  v_mov_b32 v89, 0
  v_mov_b32 v90, 0
  v_mov_b32 v91, 0
  v_mov_b32 v92, 0
  v_mov_b32 v93, 0
  v_mov_b32 v94, 0
  v_mov_b32 v95, 0
  v_mov_b32 v64, 0
  v_mov_b32 v65, 0
  s_add_u32 s31, s31, 1
  ds_read_b128 v[96:99], v117 offset:0
  ds_read_b128 v[100:103], v117 offset:1024
  ds_read_b128 v[104:107], v117 offset:14336
  ds_read_b128 v[108:111], v117 offset:15360
  v_smfmac_f32_16x16x64_bf16 v[36:39], v[8:11], a[0:7], v3
  v_smfmac_f32_16x16x64_bf16 v[40:43], v[8:11], a[56:63], v3
  v_smfmac_f32_16x16x64_bf16 v[44:47], v[8:11], a[112:119], v3
  v_smfmac_f32_16x16x64_bf16 v[48:51], v[8:11], a[168:175], v3
  v_smfmac_f32_16x16x64_bf16 v[52:55], v[8:11], a[224:231], v3
  v_smfmac_f32_16x16x64_bf16 v[56:59], v[8:11], v[144:151], v3
  v_smfmac_f32_16x16x64_bf16 v[60:63], v[8:11], v[200:207], v3
  v_smfmac_f32_16x16x64_bf16 v[36:39], v[12:15], a[8:15], v3
  v_smfmac_f32_16x16x64_bf16 v[40:43], v[12:15], a[64:71], v3
  v_smfmac_f32_16x16x64_bf16 v[44:47], v[12:15], a[120:127], v3
  v_smfmac_f32_16x16x64_bf16 v[48:51], v[12:15], a[176:183], v3
  v_smfmac_f32_16x16x64_bf16 v[52:55], v[12:15], a[232:239], v3
  v_smfmac_f32_16x16x64_bf16 v[56:59], v[12:15], v[152:159], v3
  v_smfmac_f32_16x16x64_bf16 v[60:63], v[12:15], v[208:215], v3
  v_smfmac_f32_16x16x64_bf16 v[36:39], v[16:19], a[16:23], v3
  v_smfmac_f32_16x16x64_bf16 v[40:43], v[16:19], a[72:79], v3
  v_smfmac_f32_16x16x64_bf16 v[44:47], v[16:19], a[128:135], v3
  v_smfmac_f32_16x16x64_bf16 v[48:51], v[16:19], a[184:191], v3
  v_smfmac_f32_16x16x64_bf16 v[52:55], v[16:19], a[240:247], v3
  v_smfmac_f32_16x16x64_bf16 v[56:59], v[16:19], v[160:167], v3
  v_smfmac_f32_16x16x64_bf16 v[60:63], v[16:19], v[216:223], v3
  v_smfmac_f32_16x16x64_bf16 v[36:39], v[20:23], a[24:31], v3
  v_smfmac_f32_16x16x64_bf16 v[40:43], v[20:23], a[80:87], v3
  v_smfmac_f32_16x16x64_bf16 v[44:47], v[20:23], a[136:143], v3
  v_smfmac_f32_16x16x64_bf16 v[48:51], v[20:23], a[192:199], v3
  v_smfmac_f32_16x16x64_bf16 v[52:55], v[20:23], a[248:255], v3
  v_smfmac_f32_16x16x64_bf16 v[56:59], v[20:23], v[168:175], v3
  v_smfmac_f32_16x16x64_bf16 v[60:63], v[20:23], v[224:231], v3
  s_xor_b32 s58, s25, 28672
  s_add_u32 s59, s24, 28672
  s_add_u32 m0, s58, 7168
  s_branch cB_sc1_ph2
.p2align 6

cB_sc2_loop:
  s_add_u32 s23, s20, 4096
  s_add_u32 s21, s20, 20480
  v_mov_b32 v48, 0
  v_mov_b32 v49, 0
  v_mov_b32 v50, 0
  v_mov_b32 v51, 0
  v_mov_b32 v52, 0
  v_mov_b32 v53, 0
  v_mov_b32 v54, 0
  v_mov_b32 v55, 0
  v_mov_b32 v56, 0
  v_mov_b32 v57, 0
  v_mov_b32 v58, 0
  v_mov_b32 v59, 0
  v_mov_b32 v60, 0
  v_mov_b32 v61, 0
  v_mov_b32 v62, 0
  v_mov_b32 v63, 0
  v_mov_b32 v88, 0
  v_mov_b32 v89, 0
  v_mov_b32 v90, 0
  v_mov_b32 v91, 0
  v_mov_b32 v92, 0
  v_mov_b32 v93, 0
  v_mov_b32 v94, 0
  v_mov_b32 v95, 0
  v_mov_b32 v66, 0
  v_mov_b32 v67, 0
  s_mov_b32 s30, 0
  s_mov_b32 s62, 0
  s_waitcnt vmcnt(0)
  s_barrier
cB_sc2_ld:
  buffer_load_dwordx4 v[8:11], v2, s[8:11], s20 offen offset:0 sc1
  v_mov_b32 v36, 0
  v_mov_b32 v37, 0
  v_mov_b32 v38, 0
  v_mov_b32 v39, 0
  buffer_load_dwordx4 v[12:15], v2, s[8:11], s20 offen offset:1024 sc1
  v_mov_b32 v40, 0
  v_mov_b32 v41, 0
  v_mov_b32 v42, 0
  v_mov_b32 v43, 0
  buffer_load_dwordx4 v[16:19], v2, s[8:11], s20 offen offset:2048 sc1
  v_mov_b32 v44, 0
  v_mov_b32 v45, 0
  v_mov_b32 v46, 0
  v_mov_b32 v47, 0
  ds_read_b128 v[96:99], v117 offset:0
  ds_read_b128 v[100:103], v117 offset:1024
  ds_read_b128 v[104:107], v117 offset:14336
  ds_read_b128 v[108:111], v117 offset:15360
  s_waitcnt vmcnt(2)
  v_smfmac_f32_16x16x64_bf16 v[36:39], v[8:11], a[0:7], v3
  v_smfmac_f32_16x16x64_bf16 v[40:43], v[8:11], a[56:63], v3
  buffer_load_dwordx4 v[20:23], v2, s[8:11], s20 offen offset:3072 sc1
  v_smfmac_f32_16x16x64_bf16 v[44:47], v[8:11], a[112:119], v3
  v_smfmac_f32_16x16x64_bf16 v[48:51], v[8:11], a[168:175], v3
  v_smfmac_f32_16x16x64_bf16 v[52:55], v[8:11], a[224:231], v3
  buffer_load_dwordx4 v[24:27], v2, s[8:11], s23 offen offset:0 sc1
  v_smfmac_f32_16x16x64_bf16 v[56:59], v[8:11], v[144:151], v3
  v_smfmac_f32_16x16x64_bf16 v[60:63], v[8:11], v[200:207], v3
  s_waitcnt vmcnt(3)
  v_smfmac_f32_16x16x64_bf16 v[36:39], v[12:15], a[8:15], v3
  v_smfmac_f32_16x16x64_bf16 v[40:43], v[12:15], a[64:71], v3
  buffer_load_dwordx4 v[28:31], v2, s[8:11], s23 offen offset:1024 sc1
  v_smfmac_f32_16x16x64_bf16 v[44:47], v[12:15], a[120:127], v3
  v_smfmac_f32_16x16x64_bf16 v[48:51], v[12:15], a[176:183], v3
  v_smfmac_f32_16x16x64_bf16 v[52:55], v[12:15], a[232:239], v3
  buffer_load_dwordx4 v[32:35], v2, s[8:11], s23 offen offset:2048 sc1
  v_smfmac_f32_16x16x64_bf16 v[56:59], v[12:15], v[152:159], v3
  v_smfmac_f32_16x16x64_bf16 v[60:63], v[12:15], v[208:215], v3
  s_waitcnt vmcnt(4)
  v_smfmac_f32_16x16x64_bf16 v[36:39], v[16:19], a[16:23], v3
  v_smfmac_f32_16x16x64_bf16 v[40:43], v[16:19], a[72:79], v3
  s_xor_b32 s58, s25, 28672
  s_add_u32 s59, s24, 28672
  s_add_u32 m0, s58, 14336
  v_smfmac_f32_16x16x64_bf16 v[44:47], v[16:19], a[128:135], v3
  buffer_load_dwordx4 v2, s[8:11], s59 offen offset:0 sc1 lds
  v_smfmac_f32_16x16x64_bf16 v[48:51], v[16:19], a[184:191], v3
  v_smfmac_f32_16x16x64_bf16 v[52:55], v[16:19], a[240:247], v3
  v_smfmac_f32_16x16x64_bf16 v[56:59], v[16:19], v[160:167], v3
  v_smfmac_f32_16x16x64_bf16 v[60:63], v[16:19], v[216:223], v3
  buffer_load_dwordx4 v2, s[8:11], s59 offen offset:1024 sc1 lds
  s_waitcnt vmcnt(5)
  v_smfmac_f32_16x16x64_bf16 v[36:39], v[20:23], a[24:31], v3
  v_smfmac_f32_16x16x64_bf16 v[40:43], v[20:23], a[80:87], v3
  v_smfmac_f32_16x16x64_bf16 v[44:47], v[20:23], a[136:143], v3
  v_smfmac_f32_16x16x64_bf16 v[48:51], v[20:23], a[192:199], v3
  buffer_load_dwordx4 v2, s[8:11], s59 offen offset:2048 sc1 lds
  v_smfmac_f32_16x16x64_bf16 v[52:55], v[20:23], a[248:255], v3
  v_smfmac_f32_16x16x64_bf16 v[56:59], v[20:23], v[168:175], v3
  v_smfmac_f32_16x16x64_bf16 v[60:63], v[20:23], v[224:231], v3
  s_waitcnt vmcnt(3)
cB_sc2_ph2:
  v_smfmac_f32_16x16x64_bf16 v[60:63], v[24:27], v[232:239], v3
  buffer_load_dwordx4 v2, s[8:11], s59 offen offset:3072 sc1 lds
  ds_read_b128 v[8:11], v116 offset:4096
  ds_read_b128 v[12:15], v116 offset:5120
  v_smfmac_f32_16x16x64_bf16 v[60:63], v[28:31], v[240:247], v3
  buffer_load_dword v119, v0, s[8:11], s24 offen sc1
  v_smfmac_f32_16x16x64_bf16 v[60:63], v[32:35], v[248:255], v3
  v_mov_b32 v80, v28
  v_smfmac_f32_16x16x64_bf16 v[52:55], v[24:27], v[120:127], v3
  v_mov_b32 v81, v29
  v_smfmac_f32_16x16x64_bf16 v[52:55], v[28:31], v[128:135], v3
  v_mov_b32 v82, v34
  v_smfmac_f32_16x16x64_bf16 v[52:55], v[32:35], v[136:143], v3
  v_cvt_pk_bf16_f32 v64, v60, v61
  v_smfmac_f32_16x16x64_bf16 v[56:59], v[24:27], v[176:183], v3
  v_cvt_pk_bf16_f32 v65, v62, v63
  v_smfmac_f32_16x16x64_bf16 v[56:59], v[28:31], v[184:191], v3
  v_mov_b32 v83, v35
  v_mfma_f32_16x16x32_bf16 v[68:71], v[64:67], v[4:7], 0
  v_smfmac_f32_16x16x64_bf16 v[56:59], v[32:35], v[192:199], v3
  v_cvt_pk_bf16_f32 v64, v52, v53
  v_smfmac_f32_16x16x64_bf16 v[36:39], v[24:27], a[32:39], v3
  v_cvt_pk_bf16_f32 v65, v54, v55
  v_smfmac_f32_16x16x64_bf16 v[36:39], v[28:31], a[40:47], v3
  v_cvt_pk_bf16_f32 v78, v68, v69
  v_smfmac_f32_16x16x64_bf16 v[36:39], v[32:35], a[48:55], v3
  v_cvt_pk_bf16_f32 v79, v70, v71
  v_cvt_pk_bf16_f32 v66, v56, v57
  v_smfmac_f32_16x16x64_bf16 v[40:43], v[24:27], a[88:95], v3
  v_cvt_pk_bf16_f32 v67, v58, v59
  v_smfmac_f32_16x16x64_bf16 v[40:43], v[28:31], a[96:103], v3
  v_mfma_f32_16x16x32_bf16 v[72:75], v[64:67], v[4:7], 0
  ds_read_b128 v[52:55], v116 offset:18432
  ds_read_b128 v[56:59], v116 offset:19456
  v_smfmac_f32_16x16x64_bf16 v[40:43], v[32:35], a[104:111], v3
  v_cvt_pk_bf16_f32 v64, v36, v37
  v_smfmac_f32_16x16x64_bf16 v[44:47], v[24:27], a[144:151], v3
  v_cvt_pk_bf16_f32 v65, v38, v39
  v_smfmac_f32_16x16x64_bf16 v[44:47], v[28:31], a[152:159], v3
  v_cvt_pk_bf16_f32 v76, v72, v73
  v_smfmac_f32_16x16x64_bf16 v[44:47], v[32:35], a[160:167], v3
  v_cvt_pk_bf16_f32 v77, v74, v75
  v_cvt_pk_bf16_f32 v66, v40, v41
  v_smfmac_f32_16x16x64_bf16 v[48:51], v[24:27], a[200:207], v3
  v_cvt_pk_bf16_f32 v67, v42, v43
  v_smfmac_f32_16x16x64_bf16 v[48:51], v[28:31], a[208:215], v3
  v_mfma_f32_16x16x32_bf16 v[68:71], v[64:67], v[4:7], 0
  v_smfmac_f32_16x16x64_bf16 v[48:51], v[32:35], a[216:223], v3
  v_cvt_pk_bf16_f32 v64, v44, v45
  v_mfma_f32_16x16x32_bf16 v[84:87], v[80:83], v[76:79], 0
  v_cvt_pk_bf16_f32 v65, v46, v47
  s_waitcnt lgkmcnt(0)
  v_smfmac_f32_16x16x64_bf16 v[88:91], v[76:79], v[96:103], v118
  v_cvt_pk_bf16_f32 v60, v68, v69
  v_cvt_pk_bf16_f32 v61, v70, v71
  v_cvt_pk_bf16_f32 v66, v48, v49
  v_cvt_pk_bf16_f32 v67, v50, v51
  s_nop 1
  v_mfma_f32_16x16x32_bf16 v[72:75], v[64:67], v[4:7], 0
  v_smfmac_f32_16x16x64_bf16 v[92:95], v[76:79], v[104:111], v118
  s_nop 4
  v_cvt_pk_bf16_f32 v62, v72, v73
  v_cvt_pk_bf16_f32 v63, v74, v75
  s_nop 1
  v_mfma_f32_16x16x32_bf16 v[84:87], v[16:19], v[60:63], v[84:87]
  v_smfmac_f32_16x16x64_bf16 v[88:91], v[60:63], v[8:15], v118
  v_smfmac_f32_16x16x64_bf16 v[92:95], v[60:63], v[52:59], v118
  s_nop 1
  v_permlane32_swap_b32 v84, v86
  v_permlane32_swap_b32 v85, v87
  s_nop 0
  v_add_f32 v88, v88, v89
  v_add_f32_dpp v84, v86, v84 quad_perm:[1,0,3,2] row_mask:0xf bank_mask:0xf
  v_add_f32_dpp v85, v87, v85 quad_perm:[1,0,3,2] row_mask:0xf bank_mask:0xf
  v_add_f32 v89, v90, v91
  ds_write2_b32 v113, v84, v85 offset0:0 offset1:4
  ds_write2_b32 v112, v88, v89 offset0:0 offset1:128
  v_add_f32 v90, v92, v93
  v_add_f32 v91, v94, v95
  ds_write2_b32 v112, v90, v91 offset0:64 offset1:192
  v_cmp_u_f32 vcc, v88, v89
  s_cbranch_vccnz cB_sc2_retry
cB_sc2_cont:
  s_waitcnt lgkmcnt(0)
  s_barrier
  ds_read_b128 v[36:39], v114
  ds_read_b128 v[44:47], v115
  s_waitcnt lgkmcnt(0)
  v_add_f32 v36, v36, v38
  v_add_f32 v37, v37, v39
  v_add_f32 v44, v44, v45
  v_add_f32 v46, v46, v47
  v_add_f32 v44, v44, v46
  v_add_f32 v36, v36, v37
  v_exp_f32 v49, v44
  v_exp_f32 v48, v36
  v_add_f32 v50, abs(v36), abs(v44)
  v_fma_f32 v39, v49, s37, v48
  v_cmp_ngt_f32 vcc, s56, v50
  v_cndmask_b32 v41, v48, v49, s[38:39]
  v_add_f32_dpp v39, v39, v39 quad_perm:[1,0,3,2] row_mask:0xf bank_mask:0xf
  v_cndmask_b32 v40, v49, v48, s[38:39]
  v_mov_b32_dpp v46, v41 quad_perm:[1,0,3,2] row_mask:0xf bank_mask:0xf
  v_add_f32_dpp v39, v39, v39 quad_perm:[2,3,0,1] row_mask:0xf bank_mask:0xf
  v_cndmask_b32 v42, v46, v40, s[38:39]
  v_cndmask_b32 v43, v40, v46, s[38:39]
  v_add_f32_dpp v39, v39, v39 row_half_mirror row_mask:0xf bank_mask:0xf
  s_cbranch_vccnz cB_sc2_slow
  s_nop 0
  v_add_f32_dpp v47, v39, v39 row_mirror row_mask:0xf bank_mask:0xf
  v_add_f32_dpp v39, v39, v39 row_mirror row_mask:0xf bank_mask:0xf
  s_nop 1
  v_permlane16_swap_b32 v39, v47
  v_add_f32 v39, v39, v47
  v_rcp_f32 v39, v39
  s_mov_b64 exec, s[28:29]
  v_mul_f32 v42, v42, v39
  v_mul_f32 v43, v43, v39
  v_cvt_pk_bf16_f32 v42, v42, v43
cB_sc2_pst:
  buffer_store_dword v42, v1, s[8:11], s20 offen sc1
  s_mov_b64 exec, -1
  s_barrier
  s_add_u32 s24, s24, 28672
  s_add_u32 s35, s35, 28672
  s_xor_b32 s25, s25, 28672
  s_add_u32 m0, s25, 14336
  s_add_u32 m0, s25, 18432
  s_add_u32 s22, s24, 4096
  buffer_load_dwordx4 v2, s[8:11], s22 offen offset:0 sc1 lds
  s_nop 5
  buffer_load_dwordx4 v2, s[8:11], s22 offen offset:1024 sc1 lds
  s_nop 5
  buffer_load_dwordx4 v2, s[8:11], s22 offen offset:2048 sc1 lds
  s_nop 5
  v_xor_b32 v116, 28672, v116
  v_add_u32 v117, s57, v117
  s_sub_u32 s57, 0, s57
  s_add_u32 s19, s19, 1
  s_mov_b32 s20, s21
  s_cmp_lt_u32 s19, 63
  s_cbranch_scc1 cB_sc2_loop
  s_branch cB_done
cB_sc2_slow:
  v_max_f32 v50, v36, v44
  s_nop 1
  v_max_f32_dpp v50, v50, v50 quad_perm:[1,0,3,2] row_mask:0xf bank_mask:0xf
  s_nop 1
  v_max_f32_dpp v50, v50, v50 quad_perm:[2,3,0,1] row_mask:0xf bank_mask:0xf
  s_nop 1
  v_max_f32_dpp v50, v50, v50 row_half_mirror row_mask:0xf bank_mask:0xf
  s_nop 1
  v_max_f32_dpp v50, v50, v50 row_mirror row_mask:0xf bank_mask:0xf
  v_mov_b32 v47, v50
  s_nop 1
  v_permlane16_swap_b32 v50, v47
  v_max_f32 v50, v50, v47
  v_sub_f32 v48, v36, v50
  v_sub_f32 v49, v44, v50
  v_exp_f32 v48, v48
  v_exp_f32 v49, v49
  s_add_u32 s31, s31, 0x100
  v_fma_f32 v39, v49, s37, v48
  v_cndmask_b32 v41, v48, v49, s[38:39]
  s_nop 0
  v_add_f32_dpp v39, v39, v39 quad_perm:[1,0,3,2] row_mask:0xf bank_mask:0xf
  v_cndmask_b32 v40, v49, v48, s[38:39]
  v_mov_b32_dpp v46, v41 quad_perm:[1,0,3,2] row_mask:0xf bank_mask:0xf
  v_add_f32_dpp v39, v39, v39 quad_perm:[2,3,0,1] row_mask:0xf bank_mask:0xf
  v_cndmask_b32 v42, v46, v40, s[38:39]
  v_cndmask_b32 v43, v40, v46, s[38:39]
  v_add_f32_dpp v39, v39, v39 row_half_mirror row_mask:0xf bank_mask:0xf
  s_nop 1
  v_add_f32_dpp v47, v39, v39 row_mirror row_mask:0xf bank_mask:0xf
  v_add_f32_dpp v39, v39, v39 row_mirror row_mask:0xf bank_mask:0xf
  s_nop 1
  v_permlane16_swap_b32 v39, v47
  v_add_f32 v39, v39, v47
  v_rcp_f32 v39, v39
  s_mov_b64 exec, s[28:29]
  v_mul_f32 v42, v42, v39
  v_mul_f32 v43, v43, v39
  v_cvt_pk_bf16_f32 v42, v42, v43
  v_min_u32 v42, -2, v42
  s_branch cB_sc2_pst
cB_sc2_retry:
  s_cmp_lg_u32 s62, 0
  s_cbranch_scc1 cB_sc2_cont
  s_waitcnt vmcnt(0) lgkmcnt(0)
cB_sc2_rv:
  buffer_load_dwordx4 v[8:11], v2, s[8:11], s20 offen offset:0 sc1
  buffer_load_dwordx4 v[12:15], v2, s[8:11], s20 offen offset:1024 sc1
  buffer_load_dwordx4 v[16:19], v2, s[8:11], s20 offen offset:2048 sc1
  buffer_load_dwordx4 v[20:23], v2, s[8:11], s20 offen offset:3072 sc1
  buffer_load_dwordx4 v[24:27], v2, s[8:11], s23 offen offset:0 sc1
  buffer_load_dwordx4 v[28:31], v2, s[8:11], s23 offen offset:1024 sc1
  buffer_load_dwordx4 v[32:35], v2, s[8:11], s23 offen offset:2048 sc1
  s_waitcnt vmcnt(0)
  v_max3_u32 v68, v8, v9, v10
  v_max3_u32 v68, v68, v11, v12
  v_max3_u32 v68, v68, v13, v14
  v_max3_u32 v68, v68, v15, v16
  v_max3_u32 v68, v68, v17, v18
  v_max3_u32 v68, v68, v19, v20
  v_max3_u32 v68, v68, v21, v22
  v_max3_u32 v68, v68, v23, v24
  v_max3_u32 v68, v68, v25, v26
  v_max3_u32 v68, v68, v27, v28
  v_max3_u32 v68, v68, v29, v30
  v_max3_u32 v68, v68, v31, v32
  v_max3_u32 v68, v68, v33, v34
  v_max_u32 v68, v68, v35
  v_cmp_eq_u32 vcc, -1, v68
  s_cbranch_vccz cB_sc2_rk
  s_add_u32 s30, s30, 1
  s_cmp_lt_u32 s30, 400000
  s_cbranch_scc1 cB_sc2_rv
  s_branch cB_abort
cB_sc2_rk:
  s_mov_b32 s62, 1
  v_mov_b32 v36, 0
  v_mov_b32 v37, 0
  v_mov_b32 v38, 0
  v_mov_b32 v39, 0
  v_mov_b32 v40, 0
  v_mov_b32 v41, 0
  v_mov_b32 v42, 0
  v_mov_b32 v43, 0
  v_mov_b32 v44, 0
  v_mov_b32 v45, 0
  v_mov_b32 v46, 0
  v_mov_b32 v47, 0
  v_mov_b32 v48, 0
  v_mov_b32 v49, 0
  v_mov_b32 v50, 0
  v_mov_b32 v51, 0
  v_mov_b32 v52, 0
  v_mov_b32 v53, 0
  v_mov_b32 v54, 0
  v_mov_b32 v55, 0
  v_mov_b32 v56, 0
  v_mov_b32 v57, 0
  v_mov_b32 v58, 0
  v_mov_b32 v59, 0
  v_mov_b32 v60, 0
  v_mov_b32 v61, 0
  v_mov_b32 v62, 0
  v_mov_b32 v63, 0
  v_mov_b32 v88, 0
  v_mov_b32 v89, 0
  v_mov_b32 v90, 0
  v_mov_b32 v91, 0
  v_mov_b32 v92, 0
  v_mov_b32 v93, 0
  v_mov_b32 v94, 0
  v_mov_b32 v95, 0
  v_mov_b32 v66, 0
  v_mov_b32 v67, 0
  s_add_u32 s31, s31, 1
  ds_read_b128 v[96:99], v117 offset:0
  ds_read_b128 v[100:103], v117 offset:1024
  ds_read_b128 v[104:107], v117 offset:14336
  ds_read_b128 v[108:111], v117 offset:15360
  v_smfmac_f32_16x16x64_bf16 v[36:39], v[8:11], a[0:7], v3
  v_smfmac_f32_16x16x64_bf16 v[40:43], v[8:11], a[56:63], v3
  v_smfmac_f32_16x16x64_bf16 v[44:47], v[8:11], a[112:119], v3
  v_smfmac_f32_16x16x64_bf16 v[48:51], v[8:11], a[168:175], v3
  v_smfmac_f32_16x16x64_bf16 v[52:55], v[8:11], a[224:231], v3
  v_smfmac_f32_16x16x64_bf16 v[56:59], v[8:11], v[144:151], v3
  v_smfmac_f32_16x16x64_bf16 v[60:63], v[8:11], v[200:207], v3
  v_smfmac_f32_16x16x64_bf16 v[36:39], v[12:15], a[8:15], v3
  v_smfmac_f32_16x16x64_bf16 v[40:43], v[12:15], a[64:71], v3
  v_smfmac_f32_16x16x64_bf16 v[44:47], v[12:15], a[120:127], v3
  v_smfmac_f32_16x16x64_bf16 v[48:51], v[12:15], a[176:183], v3
  v_smfmac_f32_16x16x64_bf16 v[52:55], v[12:15], a[232:239], v3
  v_smfmac_f32_16x16x64_bf16 v[56:59], v[12:15], v[152:159], v3
  v_smfmac_f32_16x16x64_bf16 v[60:63], v[12:15], v[208:215], v3
  v_smfmac_f32_16x16x64_bf16 v[36:39], v[16:19], a[16:23], v3
  v_smfmac_f32_16x16x64_bf16 v[40:43], v[16:19], a[72:79], v3
  v_smfmac_f32_16x16x64_bf16 v[44:47], v[16:19], a[128:135], v3
  v_smfmac_f32_16x16x64_bf16 v[48:51], v[16:19], a[184:191], v3
  v_smfmac_f32_16x16x64_bf16 v[52:55], v[16:19], a[240:247], v3
  v_smfmac_f32_16x16x64_bf16 v[56:59], v[16:19], v[160:167], v3
  v_smfmac_f32_16x16x64_bf16 v[60:63], v[16:19], v[216:223], v3
  v_smfmac_f32_16x16x64_bf16 v[36:39], v[20:23], a[24:31], v3
  v_smfmac_f32_16x16x64_bf16 v[40:43], v[20:23], a[80:87], v3
  v_smfmac_f32_16x16x64_bf16 v[44:47], v[20:23], a[136:143], v3
  v_smfmac_f32_16x16x64_bf16 v[48:51], v[20:23], a[192:199], v3
  v_smfmac_f32_16x16x64_bf16 v[52:55], v[20:23], a[248:255], v3
  v_smfmac_f32_16x16x64_bf16 v[56:59], v[20:23], v[168:175], v3
  v_smfmac_f32_16x16x64_bf16 v[60:63], v[20:23], v[224:231], v3
  s_xor_b32 s58, s25, 28672
  s_add_u32 s59, s24, 28672
  s_add_u32 m0, s58, 14336
  s_branch cB_sc2_ph2
.p2align 6

cB_sc3_loop:
  s_add_u32 s23, s20, 4096
  s_add_u32 s21, s20, 20480
  v_mov_b32 v48, 0
  v_mov_b32 v49, 0
  v_mov_b32 v50, 0
  v_mov_b32 v51, 0
  v_mov_b32 v52, 0
  v_mov_b32 v53, 0
  v_mov_b32 v54, 0
  v_mov_b32 v55, 0
  v_mov_b32 v56, 0
  v_mov_b32 v57, 0
  v_mov_b32 v58, 0
  v_mov_b32 v59, 0
  v_mov_b32 v60, 0
  v_mov_b32 v61, 0
  v_mov_b32 v62, 0
  v_mov_b32 v63, 0
  v_mov_b32 v88, 0
  v_mov_b32 v89, 0
  v_mov_b32 v90, 0
  v_mov_b32 v91, 0
  v_mov_b32 v92, 0
  v_mov_b32 v93, 0
  v_mov_b32 v94, 0
  v_mov_b32 v95, 0
  v_mov_b32 v64, 0
  v_mov_b32 v65, 0
  s_mov_b32 s30, 0
  s_mov_b32 s62, 0
  s_waitcnt vmcnt(0)
  s_barrier
cB_sc3_ld:
  buffer_load_dwordx4 v[8:11], v2, s[8:11], s20 offen offset:0 sc1
  v_mov_b32 v36, 0
  v_mov_b32 v37, 0
  v_mov_b32 v38, 0
  v_mov_b32 v39, 0
  buffer_load_dwordx4 v[12:15], v2, s[8:11], s20 offen offset:1024 sc1
  v_mov_b32 v40, 0
  v_mov_b32 v41, 0
  v_mov_b32 v42, 0
  v_mov_b32 v43, 0
  buffer_load_dwordx4 v[16:19], v2, s[8:11], s20 offen offset:2048 sc1
  v_mov_b32 v44, 0
  v_mov_b32 v45, 0
  v_mov_b32 v46, 0
  v_mov_b32 v47, 0
  ds_read_b128 v[96:99], v117 offset:0
  ds_read_b128 v[100:103], v117 offset:1024
  ds_read_b128 v[104:107], v117 offset:14336
  ds_read_b128 v[108:111], v117 offset:15360
  s_waitcnt vmcnt(2)
  v_smfmac_f32_16x16x64_bf16 v[36:39], v[8:11], a[0:7], v3
  v_smfmac_f32_16x16x64_bf16 v[40:43], v[8:11], a[56:63], v3
  buffer_load_dwordx4 v[20:23], v2, s[8:11], s20 offen offset:3072 sc1
  v_smfmac_f32_16x16x64_bf16 v[44:47], v[8:11], a[112:119], v3
  v_smfmac_f32_16x16x64_bf16 v[48:51], v[8:11], a[168:175], v3
  v_smfmac_f32_16x16x64_bf16 v[52:55], v[8:11], a[224:231], v3
  buffer_load_dwordx4 v[24:27], v2, s[8:11], s23 offen offset:0 sc1
  v_smfmac_f32_16x16x64_bf16 v[56:59], v[8:11], v[144:151], v3
  v_smfmac_f32_16x16x64_bf16 v[60:63], v[8:11], v[200:207], v3
  s_waitcnt vmcnt(3)
  v_smfmac_f32_16x16x64_bf16 v[36:39], v[12:15], a[8:15], v3
  v_smfmac_f32_16x16x64_bf16 v[40:43], v[12:15], a[64:71], v3
  buffer_load_dwordx4 v[28:31], v2, s[8:11], s23 offen offset:1024 sc1
  v_smfmac_f32_16x16x64_bf16 v[44:47], v[12:15], a[120:127], v3
  v_smfmac_f32_16x16x64_bf16 v[48:51], v[12:15], a[176:183], v3
  v_smfmac_f32_16x16x64_bf16 v[52:55], v[12:15], a[232:239], v3
  buffer_load_dwordx4 v[32:35], v2, s[8:11], s23 offen offset:2048 sc1
  v_smfmac_f32_16x16x64_bf16 v[56:59], v[12:15], v[152:159], v3
  v_smfmac_f32_16x16x64_bf16 v[60:63], v[12:15], v[208:215], v3
  s_waitcnt vmcnt(4)
  v_smfmac_f32_16x16x64_bf16 v[36:39], v[16:19], a[16:23], v3
  v_smfmac_f32_16x16x64_bf16 v[40:43], v[16:19], a[72:79], v3
  v_smfmac_f32_16x16x64_bf16 v[44:47], v[16:19], a[128:135], v3
  s_xor_b32 s58, s25, 28672
  s_add_u32 s59, s24, 28672
  s_add_u32 m0, s58, 21504
  v_smfmac_f32_16x16x64_bf16 v[48:51], v[16:19], a[184:191], v3
  buffer_load_dwordx4 v2, s[8:11], s59 offen offset:0 sc1 lds
  v_smfmac_f32_16x16x64_bf16 v[52:55], v[16:19], a[240:247], v3
  v_smfmac_f32_16x16x64_bf16 v[56:59], v[16:19], v[160:167], v3
  v_smfmac_f32_16x16x64_bf16 v[60:63], v[16:19], v[216:223], v3
  s_waitcnt vmcnt(4)
  v_smfmac_f32_16x16x64_bf16 v[36:39], v[20:23], a[24:31], v3
  buffer_load_dwordx4 v2, s[8:11], s59 offen offset:1024 sc1 lds
  v_smfmac_f32_16x16x64_bf16 v[40:43], v[20:23], a[80:87], v3
  v_smfmac_f32_16x16x64_bf16 v[44:47], v[20:23], a[136:143], v3
  v_smfmac_f32_16x16x64_bf16 v[48:51], v[20:23], a[192:199], v3
  v_smfmac_f32_16x16x64_bf16 v[52:55], v[20:23], a[248:255], v3
  buffer_load_dwordx4 v2, s[8:11], s59 offen offset:2048 sc1 lds
  v_smfmac_f32_16x16x64_bf16 v[56:59], v[20:23], v[168:175], v3
  v_smfmac_f32_16x16x64_bf16 v[60:63], v[20:23], v[224:231], v3
  s_waitcnt vmcnt(3)
cB_sc3_ph2:
  v_smfmac_f32_16x16x64_bf16 v[60:63], v[24:27], v[232:239], v3
  ds_read_b128 v[8:11], v116 offset:6144
  ds_read_b128 v[12:15], v116 offset:7168
  v_smfmac_f32_16x16x64_bf16 v[60:63], v[28:31], v[240:247], v3
  buffer_load_dwordx4 v2, s[8:11], s59 offen offset:3072 sc1 lds
  v_smfmac_f32_16x16x64_bf16 v[60:63], v[32:35], v[248:255], v3
  v_mov_b32 v80, v30
  v_smfmac_f32_16x16x64_bf16 v[52:55], v[24:27], v[120:127], v3
  v_mov_b32 v81, v31
  v_smfmac_f32_16x16x64_bf16 v[52:55], v[28:31], v[128:135], v3
  v_mov_b32 v82, v34
  v_smfmac_f32_16x16x64_bf16 v[52:55], v[32:35], v[136:143], v3
  v_cvt_pk_bf16_f32 v66, v60, v61
  v_smfmac_f32_16x16x64_bf16 v[56:59], v[24:27], v[176:183], v3
  v_cvt_pk_bf16_f32 v67, v62, v63
  v_smfmac_f32_16x16x64_bf16 v[56:59], v[28:31], v[184:191], v3
  v_mov_b32 v83, v35
  v_mfma_f32_16x16x32_bf16 v[68:71], v[64:67], v[4:7], 0
  v_smfmac_f32_16x16x64_bf16 v[56:59], v[32:35], v[192:199], v3
  v_cvt_pk_bf16_f32 v64, v52, v53
  v_smfmac_f32_16x16x64_bf16 v[36:39], v[24:27], a[32:39], v3
  v_cvt_pk_bf16_f32 v65, v54, v55
  v_smfmac_f32_16x16x64_bf16 v[36:39], v[28:31], a[40:47], v3
  v_cvt_pk_bf16_f32 v78, v68, v69
  v_smfmac_f32_16x16x64_bf16 v[36:39], v[32:35], a[48:55], v3
  v_cvt_pk_bf16_f32 v79, v70, v71
  v_cvt_pk_bf16_f32 v66, v56, v57
  v_smfmac_f32_16x16x64_bf16 v[40:43], v[24:27], a[88:95], v3
  v_cvt_pk_bf16_f32 v67, v58, v59
  v_smfmac_f32_16x16x64_bf16 v[40:43], v[28:31], a[96:103], v3
  v_mfma_f32_16x16x32_bf16 v[72:75], v[64:67], v[4:7], 0
  ds_read_b128 v[52:55], v116 offset:20480
  ds_read_b128 v[56:59], v116 offset:21504
  v_smfmac_f32_16x16x64_bf16 v[40:43], v[32:35], a[104:111], v3
  v_cvt_pk_bf16_f32 v64, v36, v37
  v_smfmac_f32_16x16x64_bf16 v[44:47], v[24:27], a[144:151], v3
  v_cvt_pk_bf16_f32 v65, v38, v39
  v_smfmac_f32_16x16x64_bf16 v[44:47], v[28:31], a[152:159], v3
  v_cvt_pk_bf16_f32 v76, v72, v73
  v_smfmac_f32_16x16x64_bf16 v[44:47], v[32:35], a[160:167], v3
  v_cvt_pk_bf16_f32 v77, v74, v75
  v_cvt_pk_bf16_f32 v66, v40, v41
  v_smfmac_f32_16x16x64_bf16 v[48:51], v[24:27], a[200:207], v3
  v_cvt_pk_bf16_f32 v67, v42, v43
  v_smfmac_f32_16x16x64_bf16 v[48:51], v[28:31], a[208:215], v3
  v_mfma_f32_16x16x32_bf16 v[68:71], v[64:67], v[4:7], 0
  v_smfmac_f32_16x16x64_bf16 v[48:51], v[32:35], a[216:223], v3
  v_cvt_pk_bf16_f32 v64, v44, v45
  v_mfma_f32_16x16x32_bf16 v[84:87], v[80:83], v[76:79], 0
  v_cvt_pk_bf16_f32 v65, v46, v47
  s_waitcnt lgkmcnt(0)
  v_smfmac_f32_16x16x64_bf16 v[88:91], v[76:79], v[96:103], v118
  v_cvt_pk_bf16_f32 v60, v68, v69
  v_cvt_pk_bf16_f32 v61, v70, v71
  v_cvt_pk_bf16_f32 v66, v48, v49
  v_cvt_pk_bf16_f32 v67, v50, v51
  s_nop 1
  v_mfma_f32_16x16x32_bf16 v[72:75], v[64:67], v[4:7], 0
  v_smfmac_f32_16x16x64_bf16 v[92:95], v[76:79], v[104:111], v118
  s_nop 4
  v_cvt_pk_bf16_f32 v62, v72, v73
  v_cvt_pk_bf16_f32 v63, v74, v75
  s_nop 1
  v_mfma_f32_16x16x32_bf16 v[84:87], v[20:23], v[60:63], v[84:87]
  v_smfmac_f32_16x16x64_bf16 v[88:91], v[60:63], v[8:15], v118
  v_smfmac_f32_16x16x64_bf16 v[92:95], v[60:63], v[52:59], v118
  s_nop 1
  v_permlane32_swap_b32 v84, v86
  v_permlane32_swap_b32 v85, v87
  s_nop 0
  v_add_f32 v88, v88, v89
  v_add_f32_dpp v84, v86, v84 quad_perm:[1,0,3,2] row_mask:0xf bank_mask:0xf
  v_add_f32_dpp v85, v87, v85 quad_perm:[1,0,3,2] row_mask:0xf bank_mask:0xf
  v_add_f32 v89, v90, v91
  ds_write2_b32 v113, v84, v85 offset0:0 offset1:4
  ds_write2_b32 v112, v88, v89 offset0:0 offset1:128
  v_add_f32 v90, v92, v93
  v_add_f32 v91, v94, v95
  ds_write2_b32 v112, v90, v91 offset0:64 offset1:192
  v_cmp_u_f32 vcc, v88, v89
  s_cbranch_vccnz cB_sc3_retry
cB_sc3_cont:
  s_waitcnt lgkmcnt(0)
  s_barrier
  ds_read_b128 v[36:39], v114
  ds_read_b128 v[44:47], v115
  s_waitcnt lgkmcnt(0)
  v_add_f32 v36, v36, v38
  v_add_f32 v37, v37, v39
  v_add_f32 v44, v44, v45
  v_add_f32 v46, v46, v47
  v_add_f32 v44, v44, v46
  v_add_f32 v36, v36, v37
  v_exp_f32 v49, v44
  v_exp_f32 v48, v36
  v_add_f32 v50, abs(v36), abs(v44)
  v_fma_f32 v39, v49, s37, v48
  v_cmp_ngt_f32 vcc, s56, v50
  v_cndmask_b32 v41, v48, v49, s[38:39]
  v_add_f32_dpp v39, v39, v39 quad_perm:[1,0,3,2] row_mask:0xf bank_mask:0xf
  v_cndmask_b32 v40, v49, v48, s[38:39]
  v_mov_b32_dpp v46, v41 quad_perm:[1,0,3,2] row_mask:0xf bank_mask:0xf
  v_add_f32_dpp v39, v39, v39 quad_perm:[2,3,0,1] row_mask:0xf bank_mask:0xf
  v_cndmask_b32 v42, v46, v40, s[38:39]
  v_cndmask_b32 v43, v40, v46, s[38:39]
  v_add_f32_dpp v39, v39, v39 row_half_mirror row_mask:0xf bank_mask:0xf
  s_cbranch_vccnz cB_sc3_slow
  s_nop 0
  v_add_f32_dpp v47, v39, v39 row_mirror row_mask:0xf bank_mask:0xf
  v_add_f32_dpp v39, v39, v39 row_mirror row_mask:0xf bank_mask:0xf
  s_nop 1
  v_permlane16_swap_b32 v39, v47
  v_add_f32 v39, v39, v47
  v_rcp_f32 v39, v39
  s_mov_b64 exec, s[28:29]
  v_mul_f32 v42, v42, v39
  v_mul_f32 v43, v43, v39
  v_cvt_pk_bf16_f32 v42, v42, v43
cB_sc3_pst:
  buffer_store_dword v42, v1, s[8:11], s20 offen sc1
  s_mov_b64 exec, -1
  s_barrier
  s_add_u32 s24, s24, 28672
  s_add_u32 s35, s35, 28672
  s_xor_b32 s25, s25, 28672
  s_add_u32 m0, s25, 21504
  s_add_u32 m0, s25, 25600
  s_add_u32 s22, s24, 4096
  buffer_load_dwordx4 v2, s[8:11], s22 offen offset:0 sc1 lds
  s_nop 5
  buffer_load_dwordx4 v2, s[8:11], s22 offen offset:1024 sc1 lds
  s_nop 5
  buffer_load_dwordx4 v2, s[8:11], s22 offen offset:2048 sc1 lds
  s_nop 5
  v_xor_b32 v116, 28672, v116
  v_add_u32 v117, s57, v117
  s_sub_u32 s57, 0, s57
  s_add_u32 s19, s19, 1
  s_mov_b32 s20, s21
  s_cmp_lt_u32 s19, 63
  s_cbranch_scc1 cB_sc3_loop
  s_branch cB_done
cB_sc3_slow:
  v_max_f32 v50, v36, v44
  s_nop 1
  v_max_f32_dpp v50, v50, v50 quad_perm:[1,0,3,2] row_mask:0xf bank_mask:0xf
  s_nop 1
  v_max_f32_dpp v50, v50, v50 quad_perm:[2,3,0,1] row_mask:0xf bank_mask:0xf
  s_nop 1
  v_max_f32_dpp v50, v50, v50 row_half_mirror row_mask:0xf bank_mask:0xf
  s_nop 1
  v_max_f32_dpp v50, v50, v50 row_mirror row_mask:0xf bank_mask:0xf
  v_mov_b32 v47, v50
  s_nop 1
  v_permlane16_swap_b32 v50, v47
  v_max_f32 v50, v50, v47
  v_sub_f32 v48, v36, v50
  v_sub_f32 v49, v44, v50
  v_exp_f32 v48, v48
  v_exp_f32 v49, v49
  s_add_u32 s31, s31, 0x100
  v_fma_f32 v39, v49, s37, v48
  v_cndmask_b32 v41, v48, v49, s[38:39]
  s_nop 0
  v_add_f32_dpp v39, v39, v39 quad_perm:[1,0,3,2] row_mask:0xf bank_mask:0xf
  v_cndmask_b32 v40, v49, v48, s[38:39]
  v_mov_b32_dpp v46, v41 quad_perm:[1,0,3,2] row_mask:0xf bank_mask:0xf
  v_add_f32_dpp v39, v39, v39 quad_perm:[2,3,0,1] row_mask:0xf bank_mask:0xf
  v_cndmask_b32 v42, v46, v40, s[38:39]
  v_cndmask_b32 v43, v40, v46, s[38:39]
  v_add_f32_dpp v39, v39, v39 row_half_mirror row_mask:0xf bank_mask:0xf
  s_nop 1
  v_add_f32_dpp v47, v39, v39 row_mirror row_mask:0xf bank_mask:0xf
  v_add_f32_dpp v39, v39, v39 row_mirror row_mask:0xf bank_mask:0xf
  s_nop 1
  v_permlane16_swap_b32 v39, v47
  v_add_f32 v39, v39, v47
  v_rcp_f32 v39, v39
  s_mov_b64 exec, s[28:29]
  v_mul_f32 v42, v42, v39
  v_mul_f32 v43, v43, v39
  v_cvt_pk_bf16_f32 v42, v42, v43
  v_min_u32 v42, -2, v42
  s_branch cB_sc3_pst
cB_sc3_retry:
  s_cmp_lg_u32 s62, 0
  s_cbranch_scc1 cB_sc3_cont
  s_waitcnt vmcnt(0) lgkmcnt(0)
cB_sc3_rv:
  buffer_load_dwordx4 v[8:11], v2, s[8:11], s20 offen offset:0 sc1
  buffer_load_dwordx4 v[12:15], v2, s[8:11], s20 offen offset:1024 sc1
  buffer_load_dwordx4 v[16:19], v2, s[8:11], s20 offen offset:2048 sc1
  buffer_load_dwordx4 v[20:23], v2, s[8:11], s20 offen offset:3072 sc1
  buffer_load_dwordx4 v[24:27], v2, s[8:11], s23 offen offset:0 sc1
  buffer_load_dwordx4 v[28:31], v2, s[8:11], s23 offen offset:1024 sc1
  buffer_load_dwordx4 v[32:35], v2, s[8:11], s23 offen offset:2048 sc1
  s_waitcnt vmcnt(0)
  v_max3_u32 v68, v8, v9, v10
  v_max3_u32 v68, v68, v11, v12
  v_max3_u32 v68, v68, v13, v14
  v_max3_u32 v68, v68, v15, v16
  v_max3_u32 v68, v68, v17, v18
  v_max3_u32 v68, v68, v19, v20
  v_max3_u32 v68, v68, v21, v22
  v_max3_u32 v68, v68, v23, v24
  v_max3_u32 v68, v68, v25, v26
  v_max3_u32 v68, v68, v27, v28
  v_max3_u32 v68, v68, v29, v30
  v_max3_u32 v68, v68, v31, v32
  v_max3_u32 v68, v68, v33, v34
  v_max_u32 v68, v68, v35
  v_cmp_eq_u32 vcc, -1, v68
  s_cbranch_vccz cB_sc3_rk
  s_add_u32 s30, s30, 1
  s_cmp_lt_u32 s30, 400000
  s_cbranch_scc1 cB_sc3_rv
  s_branch cB_abort
cB_sc3_rk:
  s_mov_b32 s62, 1
  v_mov_b32 v36, 0
  v_mov_b32 v37, 0
  v_mov_b32 v38, 0
  v_mov_b32 v39, 0
  v_mov_b32 v40, 0
  v_mov_b32 v41, 0
  v_mov_b32 v42, 0
  v_mov_b32 v43, 0
  v_mov_b32 v44, 0
  v_mov_b32 v45, 0
  v_mov_b32 v46, 0
  v_mov_b32 v47, 0
  v_mov_b32 v48, 0
  v_mov_b32 v49, 0
  v_mov_b32 v50, 0
  v_mov_b32 v51, 0
  v_mov_b32 v52, 0
  v_mov_b32 v53, 0
  v_mov_b32 v54, 0
  v_mov_b32 v55, 0
  v_mov_b32 v56, 0
  v_mov_b32 v57, 0
  v_mov_b32 v58, 0
  v_mov_b32 v59, 0
  v_mov_b32 v60, 0
  v_mov_b32 v61, 0
  v_mov_b32 v62, 0
  v_mov_b32 v63, 0
  v_mov_b32 v88, 0
  v_mov_b32 v89, 0
  v_mov_b32 v90, 0
  v_mov_b32 v91, 0
  v_mov_b32 v92, 0
  v_mov_b32 v93, 0
  v_mov_b32 v94, 0
  v_mov_b32 v95, 0
  v_mov_b32 v64, 0
  v_mov_b32 v65, 0
  s_add_u32 s31, s31, 1
  ds_read_b128 v[96:99], v117 offset:0
  ds_read_b128 v[100:103], v117 offset:1024
  ds_read_b128 v[104:107], v117 offset:14336
  ds_read_b128 v[108:111], v117 offset:15360
  v_smfmac_f32_16x16x64_bf16 v[36:39], v[8:11], a[0:7], v3
  v_smfmac_f32_16x16x64_bf16 v[40:43], v[8:11], a[56:63], v3
  v_smfmac_f32_16x16x64_bf16 v[44:47], v[8:11], a[112:119], v3
  v_smfmac_f32_16x16x64_bf16 v[48:51], v[8:11], a[168:175], v3
  v_smfmac_f32_16x16x64_bf16 v[52:55], v[8:11], a[224:231], v3
  v_smfmac_f32_16x16x64_bf16 v[56:59], v[8:11], v[144:151], v3
  v_smfmac_f32_16x16x64_bf16 v[60:63], v[8:11], v[200:207], v3
  v_smfmac_f32_16x16x64_bf16 v[36:39], v[12:15], a[8:15], v3
  v_smfmac_f32_16x16x64_bf16 v[40:43], v[12:15], a[64:71], v3
  v_smfmac_f32_16x16x64_bf16 v[44:47], v[12:15], a[120:127], v3
  v_smfmac_f32_16x16x64_bf16 v[48:51], v[12:15], a[176:183], v3
  v_smfmac_f32_16x16x64_bf16 v[52:55], v[12:15], a[232:239], v3
  v_smfmac_f32_16x16x64_bf16 v[56:59], v[12:15], v[152:159], v3
  v_smfmac_f32_16x16x64_bf16 v[60:63], v[12:15], v[208:215], v3
  v_smfmac_f32_16x16x64_bf16 v[36:39], v[16:19], a[16:23], v3
  v_smfmac_f32_16x16x64_bf16 v[40:43], v[16:19], a[72:79], v3
  v_smfmac_f32_16x16x64_bf16 v[44:47], v[16:19], a[128:135], v3
  v_smfmac_f32_16x16x64_bf16 v[48:51], v[16:19], a[184:191], v3
  v_smfmac_f32_16x16x64_bf16 v[52:55], v[16:19], a[240:247], v3
  v_smfmac_f32_16x16x64_bf16 v[56:59], v[16:19], v[160:167], v3
  v_smfmac_f32_16x16x64_bf16 v[60:63], v[16:19], v[216:223], v3
  v_smfmac_f32_16x16x64_bf16 v[36:39], v[20:23], a[24:31], v3
  v_smfmac_f32_16x16x64_bf16 v[40:43], v[20:23], a[80:87], v3
  v_smfmac_f32_16x16x64_bf16 v[44:47], v[20:23], a[136:143], v3
  v_smfmac_f32_16x16x64_bf16 v[48:51], v[20:23], a[192:199], v3
  v_smfmac_f32_16x16x64_bf16 v[52:55], v[20:23], a[248:255], v3
  v_smfmac_f32_16x16x64_bf16 v[56:59], v[20:23], v[168:175], v3
  v_smfmac_f32_16x16x64_bf16 v[60:63], v[20:23], v[224:231], v3
  s_xor_b32 s58, s25, 28672
  s_add_u32 s59, s24, 28672
  s_add_u32 m0, s58, 21504
  s_branch cB_sc3_ph2
.p2align 6

cB_va0_loop:
  s_add_u32 s23, s20, 4096
  s_add_u32 s21, s20, 20480
  s_mov_b32 s30, 0
  s_cmp_lg_u32 s19, s38
  s_cbranch_scc1 cB_va0_vok
  s_branch cB_va0_voc
cB_va0_vow:
  s_sub_u32 s22, s39, s35
  v_lshlrev_b32 v63, 7, v2
  v_min_u32 v63, s22, v63
  buffer_load_dword v63, v63, s[8:11], s35 offen sc1
  s_waitcnt vmcnt(0)
cB_va0_voc:
  v_readfirstlane_b32 s22, v63
  s_cmp_eq_u32 s22, 56
  s_cbranch_scc1 cB_va0_vod
  s_sleep 1
  s_add_u32 s30, s30, 1
  s_cmp_lt_u32 s30, 400000
  s_cbranch_scc1 cB_va0_vow
  s_branch cB_abort
cB_va0_vod:
  s_add_u32 s35, s35, 2048
  s_add_u32 s38, s19, 8
  s_and_b32 s38, s38, -8
  s_cmp_eq_u32 s19, 0
  s_cselect_b32 s38, 4, s38
  v_cmp_ne_u32 vcc, 56, v63
  s_nop 3
  s_cmp_eq_u64 vcc, 0
  s_cselect_b32 s38, 99, s38
cB_va0_vok:
  s_cmp_eq_u32 s19, 63
  s_cbranch_scc1 cB_done
  s_barrier
  s_add_u32 s22, s25, 0
  buffer_load_dwordx4 v[80:83], v6, s[8:11], s22 offen offset:0 sc1
  buffer_load_dwordx4 v[84:87], v6, s[8:11], s22 offen offset:1792 sc1
  s_add_u32 s22, s25, 3584
  buffer_load_dwordx4 v[88:91], v6, s[8:11], s22 offen offset:0 sc1
  buffer_load_dwordx4 v[92:95], v6, s[8:11], s22 offen offset:1792 sc1
  s_add_u32 s22, s25, 7168
  buffer_load_dwordx4 v[96:99], v6, s[8:11], s22 offen offset:0 sc1
  buffer_load_dwordx4 v[100:103], v6, s[8:11], s22 offen offset:1792 sc1
  s_add_u32 s22, s25, 10752
  buffer_load_dwordx4 v[104:107], v6, s[8:11], s22 offen offset:0 sc1
  buffer_load_dwordx4 v[108:111], v6, s[8:11], s22 offen offset:1792 sc1
  s_add_u32 s22, s25, 14336
  buffer_load_dwordx4 v[112:115], v6, s[8:11], s22 offen offset:0 sc1
  buffer_load_dwordx4 v[116:119], v6, s[8:11], s22 offen offset:1792 sc1
  s_add_u32 s22, s25, 17920
  buffer_load_dwordx4 v[120:123], v6, s[8:11], s22 offen offset:0 sc1
  buffer_load_dwordx4 v[124:127], v6, s[8:11], s22 offen offset:1792 sc1
  s_add_u32 s22, s19, 1
  s_cmp_lg_u32 s22, s38
  s_cbranch_scc1 cB_va0_nk
  s_sub_u32 s22, s39, s35
  v_lshlrev_b32 v63, 7, v2
  v_min_u32 v63, s22, v63
  buffer_load_dword v63, v63, s[8:11], s35 offen sc1
cB_va0_nk:
  s_barrier
  ds_read_b128 v[8:11], v0 offset:8192
  ds_read_b128 v[12:15], v0 offset:9216
  ds_read_b128 v[16:19], v0 offset:10240
  ds_read_b128 v[20:23], v0 offset:11264
  ds_read_b128 v[24:27], v0 offset:12288
  ds_read_b128 v[28:31], v0 offset:13312
  ds_read_b128 v[32:35], v0 offset:14336
  s_waitcnt lgkmcnt(0)
  v_smfmac_f32_16x16x64_bf16 v[36:39], v[8:11], a[0:7], v3
  s_add_u32 s22, s25, 21504
  buffer_load_dwordx4 v[128:131], v6, s[8:11], s22 offen offset:0 sc1
  v_smfmac_f32_16x16x64_bf16 v[36:39], v[12:15], a[8:15], v3
  v_smfmac_f32_16x16x64_bf16 v[36:39], v[16:19], a[16:23], v3
  s_add_u32 s22, s25, 21504
  buffer_load_dwordx4 v[132:135], v6, s[8:11], s22 offen offset:1792 sc1
  v_smfmac_f32_16x16x64_bf16 v[36:39], v[20:23], a[24:31], v3
  v_smfmac_f32_16x16x64_bf16 v[36:39], v[24:27], a[32:39], v3
  s_add_u32 s22, s25, 25088
  buffer_load_dwordx4 v[136:139], v6, s[8:11], s22 offen offset:0 sc1
  v_smfmac_f32_16x16x64_bf16 v[36:39], v[28:31], a[40:47], v3
  v_smfmac_f32_16x16x64_bf16 v[36:39], v[32:35], a[48:55], v3
  s_add_u32 s22, s25, 25088
  buffer_load_dwordx4 v[140:143], v6, s[8:11], s22 offen offset:1792 sc1
  v_smfmac_f32_16x16x64_bf16 v[40:43], v[8:11], a[56:63], v3
  v_smfmac_f32_16x16x64_bf16 v[40:43], v[12:15], a[64:71], v3
  v_smfmac_f32_16x16x64_bf16 v[40:43], v[16:19], a[72:79], v3
  v_add_f32 v36, v36, v37
  v_smfmac_f32_16x16x64_bf16 v[40:43], v[20:23], a[80:87], v3
  v_add_f32 v38, v38, v39
  v_smfmac_f32_16x16x64_bf16 v[40:43], v[24:27], a[88:95], v3
  v_cvt_pk_bf16_f32 v36, v36, v38
  v_smfmac_f32_16x16x64_bf16 v[40:43], v[28:31], a[96:103], v3
  ds_write_b32 v60, v36
  v_smfmac_f32_16x16x64_bf16 v[40:43], v[32:35], a[104:111], v3
  v_smfmac_f32_16x16x64_bf16 v[44:47], v[8:11], a[112:119], v3
  v_smfmac_f32_16x16x64_bf16 v[44:47], v[12:15], a[120:127], v3
  v_smfmac_f32_16x16x64_bf16 v[44:47], v[16:19], a[128:135], v3
  v_add_f32 v40, v40, v41
  v_smfmac_f32_16x16x64_bf16 v[44:47], v[20:23], a[136:143], v3
  v_add_f32 v42, v42, v43
  v_smfmac_f32_16x16x64_bf16 v[44:47], v[24:27], a[144:151], v3
  v_cvt_pk_bf16_f32 v40, v40, v42
  v_smfmac_f32_16x16x64_bf16 v[44:47], v[28:31], a[152:159], v3
  ds_write_b32 v61, v40
  v_smfmac_f32_16x16x64_bf16 v[44:47], v[32:35], a[160:167], v3
  v_smfmac_f32_16x16x64_bf16 v[48:51], v[8:11], a[168:175], v3
  v_smfmac_f32_16x16x64_bf16 v[48:51], v[12:15], a[176:183], v3
  v_smfmac_f32_16x16x64_bf16 v[48:51], v[16:19], a[184:191], v3
  v_add_f32 v44, v44, v45
  v_smfmac_f32_16x16x64_bf16 v[48:51], v[20:23], a[192:199], v3
  v_add_f32 v46, v46, v47
  v_smfmac_f32_16x16x64_bf16 v[48:51], v[24:27], a[200:207], v3
  v_cvt_pk_bf16_f32 v44, v44, v46
  v_smfmac_f32_16x16x64_bf16 v[48:51], v[28:31], a[208:215], v3
  ds_write_b32 v62, v44
  v_smfmac_f32_16x16x64_bf16 v[48:51], v[32:35], a[216:223], v3
  v_smfmac_f32_16x16x64_bf16 v[52:55], v[8:11], a[224:231], v3
  v_smfmac_f32_16x16x64_bf16 v[52:55], v[12:15], a[232:239], v3
  v_smfmac_f32_16x16x64_bf16 v[52:55], v[16:19], a[240:247], v3
  v_add_f32 v48, v48, v49
  v_smfmac_f32_16x16x64_bf16 v[52:55], v[20:23], a[248:255], v3
  v_add_f32 v50, v50, v51
  v_smfmac_f32_16x16x64_bf16 v[52:55], v[24:27], v[176:183], v3
  v_cvt_pk_bf16_f32 v48, v48, v50
  v_smfmac_f32_16x16x64_bf16 v[52:55], v[28:31], v[184:191], v3
  ds_write_b32 v170, v48
  v_smfmac_f32_16x16x64_bf16 v[52:55], v[32:35], v[192:199], v3
  v_smfmac_f32_16x16x64_bf16 v[56:59], v[8:11], v[200:207], v3
  v_smfmac_f32_16x16x64_bf16 v[56:59], v[12:15], v[208:215], v3
  v_smfmac_f32_16x16x64_bf16 v[56:59], v[16:19], v[216:223], v3
  v_add_f32 v52, v52, v53
  v_smfmac_f32_16x16x64_bf16 v[56:59], v[20:23], v[224:231], v3
  v_add_f32 v54, v54, v55
  v_smfmac_f32_16x16x64_bf16 v[56:59], v[24:27], v[232:239], v3
  v_cvt_pk_bf16_f32 v52, v52, v54
  v_smfmac_f32_16x16x64_bf16 v[56:59], v[28:31], v[240:247], v3
  ds_write_b32 v171, v52
  v_smfmac_f32_16x16x64_bf16 v[56:59], v[32:35], v[248:255], v3
  s_nop 7
  v_add_f32 v56, v56, v57
  v_add_f32 v58, v58, v59
  v_cvt_pk_bf16_f32 v56, v56, v58
  ds_write_b32 v172, v56
  buffer_load_dword v164, v4, s[8:11], s20 offen sc1
  s_waitcnt lgkmcnt(0)
  v_mov_b32 v36, 0
  v_mov_b32 v37, 0
  v_mov_b32 v38, 0
  v_mov_b32 v39, 0
  v_mov_b32 v40, 0
  v_mov_b32 v41, 0
  v_mov_b32 v42, 0
  v_mov_b32 v43, 0
  buffer_load_dword v165, v4, s[8:11], s20 offen sc1
  v_mov_b32 v44, 0
  v_mov_b32 v45, 0
  v_mov_b32 v46, 0
  v_mov_b32 v47, 0
  v_mov_b32 v48, 0
  v_mov_b32 v49, 0
  v_mov_b32 v50, 0
  v_mov_b32 v51, 0
  buffer_load_dword v166, v4, s[8:11], s20 offen sc1
  v_mov_b32 v52, 0
  v_mov_b32 v53, 0
  v_mov_b32 v54, 0
  v_mov_b32 v55, 0
  v_mov_b32 v56, 0
  v_mov_b32 v57, 0
  v_mov_b32 v58, 0
  v_mov_b32 v59, 0
  buffer_load_dword v167, v4, s[8:11], s20 offen sc1
  s_cmp_eq_u32 s19, 63
  s_cbranch_scc1 cB_va0_last
  s_add_u32 s22, s20, 9216
  s_add_u32 s34, s20, 13312
  s_add_u32 s36, s20, 7168
  s_mov_b32 s37, 0
  v_mov_b32 v156, 0
  v_mov_b32 v157, 0
  v_mov_b32 v158, 0
  v_mov_b32 v159, 0
  buffer_load_dword v168, v4, s[8:11], s20 offen sc1
cB_va0_fw_l:
  s_waitcnt vmcnt(4)
  v_cmp_eq_u32 vcc, -1, v164
  s_cbranch_vccz cB_va0_fw_d
  buffer_load_dword v164, v4, s[8:11], s20 offen sc1
  s_waitcnt vmcnt(4)
  v_cmp_eq_u32 vcc, -1, v165
  s_cbranch_vccz cB_va0_fw_d
  buffer_load_dword v165, v4, s[8:11], s20 offen sc1
  s_waitcnt vmcnt(4)
  v_cmp_eq_u32 vcc, -1, v166
  s_cbranch_vccz cB_va0_fw_d
  buffer_load_dword v166, v4, s[8:11], s20 offen sc1
  s_waitcnt vmcnt(4)
  v_cmp_eq_u32 vcc, -1, v167
  s_cbranch_vccz cB_va0_fw_d
  buffer_load_dword v167, v4, s[8:11], s20 offen sc1
  s_waitcnt vmcnt(4)
  v_cmp_eq_u32 vcc, -1, v168
  s_cbranch_vccz cB_va0_fw_d
  buffer_load_dword v168, v4, s[8:11], s20 offen sc1
  s_add_u32 s30, s30, 1
  s_cmp_lt_u32 s30, 400000
  s_cbranch_scc1 cB_va0_fw_l
  s_branch cB_abort
cB_va0_fw_d:
  s_waitcnt lgkmcnt(0)
  buffer_load_dwordx4 v[8:11], v5, s[8:11], s22 offen offset:0 sc1
  buffer_load_dwordx4 v[12:15], v5, s[8:11], s22 offen offset:1024 sc1
  buffer_load_dwordx4 v[16:19], v5, s[8:11], s22 offen offset:2048 sc1
  buffer_load_dwordx4 v[20:23], v5, s[8:11], s22 offen offset:3072 sc1
  buffer_load_dwordx4 v[24:27], v5, s[8:11], s34 offen offset:0 sc1
  buffer_load_dwordx4 v[28:31], v5, s[8:11], s34 offen offset:1024 sc1
  buffer_load_dwordx4 v[32:35], v5, s[8:11], s34 offen offset:2048 sc1
  buffer_load_dwordx4 v[144:147], v5, s[8:11], s34 offen offset:3072 sc1
  buffer_load_dwordx4 v[148:151], v2, s[8:11], s36 offen offset:0 sc1
  buffer_load_dwordx4 v[152:155], v2, s[8:11], s36 offen offset:1024 sc1
  s_barrier
  ds_read_b128 v[64:67], v2 offset:0
  ds_read_b128 v[68:71], v2 offset:1024
  ds_read_b128 v[72:75], v2 offset:2048
  ds_read_b128 v[76:79], v2 offset:3072
  s_waitcnt vmcnt(9)
  v_smfmac_f32_16x16x64_bf16 v[156:159], v[8:11], v[80:87], v3
  s_waitcnt vmcnt(8)
  v_smfmac_f32_16x16x64_bf16 v[156:159], v[12:15], v[88:95], v3
  s_waitcnt vmcnt(7)
  v_smfmac_f32_16x16x64_bf16 v[156:159], v[16:19], v[96:103], v3
  s_waitcnt vmcnt(6)
  v_smfmac_f32_16x16x64_bf16 v[156:159], v[20:23], v[104:111], v3
  s_waitcnt vmcnt(5)
  v_smfmac_f32_16x16x64_bf16 v[156:159], v[24:27], v[112:119], v3
  s_waitcnt vmcnt(4)
  v_smfmac_f32_16x16x64_bf16 v[156:159], v[28:31], v[120:127], v3
  s_waitcnt vmcnt(3)
  v_smfmac_f32_16x16x64_bf16 v[156:159], v[32:35], v[128:135], v3
  s_waitcnt vmcnt(2)
  v_smfmac_f32_16x16x64_bf16 v[156:159], v[144:147], v[136:143], v3
  s_waitcnt vmcnt(1) lgkmcnt(0)
  v_smfmac_f32_16x16x64_bf16 v[156:159], v[148:151], v[64:71], v3
  s_waitcnt vmcnt(0)
  v_smfmac_f32_16x16x64_bf16 v[156:159], v[152:155], v[72:79], v3
cB_va0_ep:
  s_nop 7
  v_add_f32 v160, v156, v157
  v_add_f32 v161, v158, v159
  v_cmp_u_f32 vcc, v160, v161
  v_mov_b32_dpp v162, v160 row_ror:8 row_mask:0xf bank_mask:0xf
  v_mov_b32_dpp v160, v161 row_ror:8 row_mask:0xf bank_mask:0xc
  s_cbranch_vccnz cB_va0_rp
  v_mov_b32_dpp v161, v162 quad_perm:[0,1,2,3] row_mask:0xf bank_mask:0x3
  v_cvt_pk_bf16_f32 v160, v160, v161
cB_va0_pc:
  buffer_store_dword v160, v1, s[8:11], s21 offen sc1
  s_cmp_lg_u32 s19, 62
  s_cbranch_scc1 cB_va0_nl
  s_mov_b32 s22, 88531968
  buffer_store_dword v160, v1, s[8:11], s22 offen sc1
  s_mov_b64 exec, -1
  s_branch cB_done
cB_va0_nl:
  s_mov_b64 exec, -1
  s_add_u32 s25, s25, 28672
  s_add_u32 s19, s19, 1
  s_mov_b32 s20, s21
  s_branch cB_va0_loop
cB_va0_last:
  s_waitcnt lgkmcnt(0)
  s_barrier
  s_branch cB_done
cB_va0_rp:
  s_cmp_eq_u32 s37, 0
  s_cbranch_scc1 cB_va0_rv
  v_mov_b32_dpp v161, v162 quad_perm:[0,1,2,3] row_mask:0xf bank_mask:0x3
  v_cvt_pk_bf16_f32 v160, v160, v161
  v_min_u32 v160, -2, v160
  s_branch cB_va0_pc
cB_va0_rv:
  buffer_load_dwordx4 v[8:11], v5, s[8:11], s22 offen offset:0 sc1
  buffer_load_dwordx4 v[12:15], v5, s[8:11], s22 offen offset:1024 sc1
  buffer_load_dwordx4 v[16:19], v5, s[8:11], s22 offen offset:2048 sc1
  buffer_load_dwordx4 v[20:23], v5, s[8:11], s22 offen offset:3072 sc1
  buffer_load_dwordx4 v[24:27], v5, s[8:11], s34 offen offset:0 sc1
  buffer_load_dwordx4 v[28:31], v5, s[8:11], s34 offen offset:1024 sc1
  buffer_load_dwordx4 v[32:35], v5, s[8:11], s34 offen offset:2048 sc1
  buffer_load_dwordx4 v[144:147], v5, s[8:11], s34 offen offset:3072 sc1
  buffer_load_dwordx4 v[148:151], v2, s[8:11], s36 offen offset:0 sc1
  buffer_load_dwordx4 v[152:155], v2, s[8:11], s36 offen offset:1024 sc1
  s_waitcnt vmcnt(0)
  v_max3_u32 v175, v8, v9, v10
  v_max3_u32 v175, v175, v11, v12
  v_max3_u32 v175, v175, v13, v14
  v_max3_u32 v175, v175, v15, v16
  v_max3_u32 v175, v175, v17, v18
  v_max3_u32 v175, v175, v19, v20
  v_max3_u32 v175, v175, v21, v22
  v_max3_u32 v175, v175, v23, v24
  v_max3_u32 v175, v175, v25, v26
  v_max3_u32 v175, v175, v27, v28
  v_max3_u32 v175, v175, v29, v30
  v_max3_u32 v175, v175, v31, v32
  v_max3_u32 v175, v175, v33, v34
  v_max3_u32 v175, v175, v35, v144
  v_max3_u32 v175, v175, v145, v146
  v_max3_u32 v175, v175, v147, v148
  v_max3_u32 v175, v175, v149, v150
  v_max3_u32 v175, v175, v151, v152
  v_max3_u32 v175, v175, v153, v154
  v_max_u32 v175, v175, v155
  v_cmp_eq_u32 vcc, -1, v175
  s_cbranch_vccz cB_va0_rk
  s_add_u32 s30, s30, 1
  s_cmp_lt_u32 s30, 400000
  s_cbranch_scc1 cB_va0_rv
  s_branch cB_abort
cB_va0_rk:
  s_mov_b32 s37, 1
  s_add_u32 s31, s31, 0x10000
  v_mov_b32 v156, 0
  v_mov_b32 v157, 0
  v_mov_b32 v158, 0
  v_mov_b32 v159, 0
  s_nop 1
  v_smfmac_f32_16x16x64_bf16 v[156:159], v[8:11], v[80:87], v3
  v_smfmac_f32_16x16x64_bf16 v[156:159], v[12:15], v[88:95], v3
  v_smfmac_f32_16x16x64_bf16 v[156:159], v[16:19], v[96:103], v3
  v_smfmac_f32_16x16x64_bf16 v[156:159], v[20:23], v[104:111], v3
  v_smfmac_f32_16x16x64_bf16 v[156:159], v[24:27], v[112:119], v3
  v_smfmac_f32_16x16x64_bf16 v[156:159], v[28:31], v[120:127], v3
  v_smfmac_f32_16x16x64_bf16 v[156:159], v[32:35], v[128:135], v3
  v_smfmac_f32_16x16x64_bf16 v[156:159], v[144:147], v[136:143], v3
  v_smfmac_f32_16x16x64_bf16 v[156:159], v[148:151], v[64:71], v3
  v_smfmac_f32_16x16x64_bf16 v[156:159], v[152:155], v[72:79], v3
  s_nop 7
  s_branch cB_va0_ep
.p2align 6

cB_va1_loop:
  s_add_u32 s23, s20, 4096
  s_add_u32 s21, s20, 20480
  s_mov_b32 s30, 0
  s_cmp_lg_u32 s19, s38
  s_cbranch_scc1 cB_va1_vok
  s_branch cB_va1_voc
cB_va1_vow:
  s_sub_u32 s22, s39, s35
  v_lshlrev_b32 v63, 7, v2
  v_min_u32 v63, s22, v63
  buffer_load_dword v63, v63, s[8:11], s35 offen sc1
  s_waitcnt vmcnt(0)
cB_va1_voc:
  v_readfirstlane_b32 s22, v63
  s_cmp_eq_u32 s22, 56
  s_cbranch_scc1 cB_va1_vod
  s_sleep 1
  s_add_u32 s30, s30, 1
  s_cmp_lt_u32 s30, 400000
  s_cbranch_scc1 cB_va1_vow
  s_branch cB_abort
cB_va1_vod:
  s_add_u32 s35, s35, 2048
  s_add_u32 s38, s19, 8
  s_and_b32 s38, s38, -8
  s_cmp_eq_u32 s19, 0
  s_cselect_b32 s38, 4, s38
  v_cmp_ne_u32 vcc, 56, v63
  s_nop 3
  s_cmp_eq_u64 vcc, 0
  s_cselect_b32 s38, 99, s38
cB_va1_vok:
  s_cmp_eq_u32 s19, 63
  s_cbranch_scc1 cB_done
  s_barrier
  s_add_u32 s22, s25, 0
  buffer_load_dwordx4 v[80:83], v6, s[8:11], s22 offen offset:0 sc1
  buffer_load_dwordx4 v[84:87], v6, s[8:11], s22 offen offset:1792 sc1
  s_add_u32 s22, s25, 3584
  buffer_load_dwordx4 v[88:91], v6, s[8:11], s22 offen offset:0 sc1
  buffer_load_dwordx4 v[92:95], v6, s[8:11], s22 offen offset:1792 sc1
  s_add_u32 s22, s25, 7168
  buffer_load_dwordx4 v[96:99], v6, s[8:11], s22 offen offset:0 sc1
  buffer_load_dwordx4 v[100:103], v6, s[8:11], s22 offen offset:1792 sc1
  s_add_u32 s22, s25, 10752
  buffer_load_dwordx4 v[104:107], v6, s[8:11], s22 offen offset:0 sc1
  buffer_load_dwordx4 v[108:111], v6, s[8:11], s22 offen offset:1792 sc1
  s_add_u32 s22, s25, 14336
  buffer_load_dwordx4 v[112:115], v6, s[8:11], s22 offen offset:0 sc1
  buffer_load_dwordx4 v[116:119], v6, s[8:11], s22 offen offset:1792 sc1
  s_add_u32 s22, s25, 17920
  buffer_load_dwordx4 v[120:123], v6, s[8:11], s22 offen offset:0 sc1
  buffer_load_dwordx4 v[124:127], v6, s[8:11], s22 offen offset:1792 sc1
  s_add_u32 s22, s19, 1
  s_cmp_lg_u32 s22, s38
  s_cbranch_scc1 cB_va1_nk
  s_sub_u32 s22, s39, s35
  v_lshlrev_b32 v63, 7, v2
  v_min_u32 v63, s22, v63
  buffer_load_dword v63, v63, s[8:11], s35 offen sc1
cB_va1_nk:
  s_barrier
  ds_read_b128 v[8:11], v0 offset:8192
  ds_read_b128 v[12:15], v0 offset:9216
  ds_read_b128 v[16:19], v0 offset:10240
  ds_read_b128 v[20:23], v0 offset:11264
  ds_read_b128 v[24:27], v0 offset:12288
  ds_read_b128 v[28:31], v0 offset:13312
  ds_read_b128 v[32:35], v0 offset:14336
  s_waitcnt lgkmcnt(0)
  v_smfmac_f32_16x16x64_bf16 v[36:39], v[8:11], a[0:7], v3
  s_add_u32 s22, s25, 21504
  buffer_load_dwordx4 v[128:131], v6, s[8:11], s22 offen offset:0 sc1
  v_smfmac_f32_16x16x64_bf16 v[36:39], v[12:15], a[8:15], v3
  v_smfmac_f32_16x16x64_bf16 v[36:39], v[16:19], a[16:23], v3
  s_add_u32 s22, s25, 21504
  buffer_load_dwordx4 v[132:135], v6, s[8:11], s22 offen offset:1792 sc1
  v_smfmac_f32_16x16x64_bf16 v[36:39], v[20:23], a[24:31], v3
  v_smfmac_f32_16x16x64_bf16 v[36:39], v[24:27], a[32:39], v3
  s_add_u32 s22, s25, 25088
  buffer_load_dwordx4 v[136:139], v6, s[8:11], s22 offen offset:0 sc1
  v_smfmac_f32_16x16x64_bf16 v[36:39], v[28:31], a[40:47], v3
  v_smfmac_f32_16x16x64_bf16 v[36:39], v[32:35], a[48:55], v3
  s_add_u32 s22, s25, 25088
  buffer_load_dwordx4 v[140:143], v6, s[8:11], s22 offen offset:1792 sc1
  v_smfmac_f32_16x16x64_bf16 v[40:43], v[8:11], a[56:63], v3
  v_smfmac_f32_16x16x64_bf16 v[40:43], v[12:15], a[64:71], v3
  v_smfmac_f32_16x16x64_bf16 v[40:43], v[16:19], a[72:79], v3
  v_add_f32 v36, v36, v37
  v_smfmac_f32_16x16x64_bf16 v[40:43], v[20:23], a[80:87], v3
  v_add_f32 v38, v38, v39
  v_smfmac_f32_16x16x64_bf16 v[40:43], v[24:27], a[88:95], v3
  v_cvt_pk_bf16_f32 v36, v36, v38
  v_smfmac_f32_16x16x64_bf16 v[40:43], v[28:31], a[96:103], v3
  ds_write_b32 v60, v36
  v_smfmac_f32_16x16x64_bf16 v[40:43], v[32:35], a[104:111], v3
  v_smfmac_f32_16x16x64_bf16 v[44:47], v[8:11], a[112:119], v3
  v_smfmac_f32_16x16x64_bf16 v[44:47], v[12:15], a[120:127], v3
  v_smfmac_f32_16x16x64_bf16 v[44:47], v[16:19], a[128:135], v3
  v_add_f32 v40, v40, v41
  v_smfmac_f32_16x16x64_bf16 v[44:47], v[20:23], a[136:143], v3
  v_add_f32 v42, v42, v43
  v_smfmac_f32_16x16x64_bf16 v[44:47], v[24:27], a[144:151], v3
  v_cvt_pk_bf16_f32 v40, v40, v42
  v_smfmac_f32_16x16x64_bf16 v[44:47], v[28:31], a[152:159], v3
  ds_write_b32 v61, v40
  v_smfmac_f32_16x16x64_bf16 v[44:47], v[32:35], a[160:167], v3
  v_smfmac_f32_16x16x64_bf16 v[48:51], v[8:11], a[168:175], v3
  v_smfmac_f32_16x16x64_bf16 v[48:51], v[12:15], a[176:183], v3
  v_smfmac_f32_16x16x64_bf16 v[48:51], v[16:19], a[184:191], v3
  v_add_f32 v44, v44, v45
  v_smfmac_f32_16x16x64_bf16 v[48:51], v[20:23], a[192:199], v3
  v_add_f32 v46, v46, v47
  v_smfmac_f32_16x16x64_bf16 v[48:51], v[24:27], a[200:207], v3
  v_cvt_pk_bf16_f32 v44, v44, v46
  v_smfmac_f32_16x16x64_bf16 v[48:51], v[28:31], a[208:215], v3
  ds_write_b32 v62, v44
  v_smfmac_f32_16x16x64_bf16 v[48:51], v[32:35], a[216:223], v3
  v_smfmac_f32_16x16x64_bf16 v[52:55], v[8:11], a[224:231], v3
  v_smfmac_f32_16x16x64_bf16 v[52:55], v[12:15], a[232:239], v3
  v_smfmac_f32_16x16x64_bf16 v[52:55], v[16:19], a[240:247], v3
  v_add_f32 v48, v48, v49
  v_smfmac_f32_16x16x64_bf16 v[52:55], v[20:23], a[248:255], v3
  v_add_f32 v50, v50, v51
  v_smfmac_f32_16x16x64_bf16 v[52:55], v[24:27], v[176:183], v3
  v_cvt_pk_bf16_f32 v48, v48, v50
  v_smfmac_f32_16x16x64_bf16 v[52:55], v[28:31], v[184:191], v3
  ds_write_b32 v170, v48
  v_smfmac_f32_16x16x64_bf16 v[52:55], v[32:35], v[192:199], v3
  v_smfmac_f32_16x16x64_bf16 v[56:59], v[8:11], v[200:207], v3
  v_smfmac_f32_16x16x64_bf16 v[56:59], v[12:15], v[208:215], v3
  v_smfmac_f32_16x16x64_bf16 v[56:59], v[16:19], v[216:223], v3
  v_add_f32 v52, v52, v53
  v_smfmac_f32_16x16x64_bf16 v[56:59], v[20:23], v[224:231], v3
  v_add_f32 v54, v54, v55
  v_smfmac_f32_16x16x64_bf16 v[56:59], v[24:27], v[232:239], v3
  v_cvt_pk_bf16_f32 v52, v52, v54
  v_smfmac_f32_16x16x64_bf16 v[56:59], v[28:31], v[240:247], v3
  ds_write_b32 v171, v52
  v_smfmac_f32_16x16x64_bf16 v[56:59], v[32:35], v[248:255], v3
  s_nop 7
  v_add_f32 v56, v56, v57
  v_add_f32 v58, v58, v59
  v_cvt_pk_bf16_f32 v56, v56, v58
  ds_write_b32 v172, v56
  s_waitcnt lgkmcnt(0)
  v_mov_b32 v36, 0
  v_mov_b32 v37, 0
  v_mov_b32 v38, 0
  v_mov_b32 v39, 0
  v_mov_b32 v40, 0
  v_mov_b32 v41, 0
  v_mov_b32 v42, 0
  v_mov_b32 v43, 0
  v_mov_b32 v44, 0
  v_mov_b32 v45, 0
  v_mov_b32 v46, 0
  v_mov_b32 v47, 0
  v_mov_b32 v48, 0
  v_mov_b32 v49, 0
  v_mov_b32 v50, 0
  v_mov_b32 v51, 0
  v_mov_b32 v52, 0
  v_mov_b32 v53, 0
  v_mov_b32 v54, 0
  v_mov_b32 v55, 0
  v_mov_b32 v56, 0
  v_mov_b32 v57, 0
  v_mov_b32 v58, 0
  v_mov_b32 v59, 0
  s_cmp_eq_u32 s19, 63
  s_cbranch_scc1 cB_va1_last
  s_add_u32 s22, s20, 9216
  s_add_u32 s34, s20, 13312
  s_add_u32 s36, s20, 7168
  s_mov_b32 s37, 0
  v_mov_b32 v156, 0
  v_mov_b32 v157, 0
  v_mov_b32 v158, 0
  v_mov_b32 v159, 0
  s_barrier
  s_waitcnt lgkmcnt(0)
  buffer_load_dwordx4 v[8:11], v5, s[8:11], s22 offen offset:0 sc1
  buffer_load_dwordx4 v[12:15], v5, s[8:11], s22 offen offset:1024 sc1
  buffer_load_dwordx4 v[16:19], v5, s[8:11], s22 offen offset:2048 sc1
  buffer_load_dwordx4 v[20:23], v5, s[8:11], s22 offen offset:3072 sc1
  buffer_load_dwordx4 v[24:27], v5, s[8:11], s34 offen offset:0 sc1
  buffer_load_dwordx4 v[28:31], v5, s[8:11], s34 offen offset:1024 sc1
  buffer_load_dwordx4 v[32:35], v5, s[8:11], s34 offen offset:2048 sc1
  buffer_load_dwordx4 v[144:147], v5, s[8:11], s34 offen offset:3072 sc1
  s_sub_u32 s23, s21, 4
  s_mov_b64 exec, 65535
  buffer_store_dword v2, v7, s[8:11], s23 offen sc1
  s_mov_b64 exec, -1
  buffer_load_dwordx4 v[148:151], v2, s[8:11], s36 offen offset:0 sc1
  buffer_load_dwordx4 v[152:155], v2, s[8:11], s36 offen offset:1024 sc1
  ds_read_b128 v[64:67], v2 offset:4096
  ds_read_b128 v[68:71], v2 offset:5120
  ds_read_b128 v[72:75], v2 offset:6144
  ds_read_b128 v[76:79], v2 offset:7168
  s_waitcnt vmcnt(10)
  v_smfmac_f32_16x16x64_bf16 v[156:159], v[8:11], v[80:87], v3
  s_waitcnt vmcnt(9)
  v_smfmac_f32_16x16x64_bf16 v[156:159], v[12:15], v[88:95], v3
  s_waitcnt vmcnt(8)
  v_smfmac_f32_16x16x64_bf16 v[156:159], v[16:19], v[96:103], v3
  s_waitcnt vmcnt(7)
  v_smfmac_f32_16x16x64_bf16 v[156:159], v[20:23], v[104:111], v3
  s_waitcnt vmcnt(6)
  v_smfmac_f32_16x16x64_bf16 v[156:159], v[24:27], v[112:119], v3
  s_mov_b64 exec, 65535
  buffer_store_dword v2, v7, s[8:11], s21 offen sc1
  s_mov_b64 exec, -1
  s_waitcnt vmcnt(6)
  v_smfmac_f32_16x16x64_bf16 v[156:159], v[28:31], v[120:127], v3
  s_waitcnt vmcnt(5)
  v_smfmac_f32_16x16x64_bf16 v[156:159], v[32:35], v[128:135], v3
  s_waitcnt vmcnt(4)
  v_smfmac_f32_16x16x64_bf16 v[156:159], v[144:147], v[136:143], v3
  s_waitcnt vmcnt(2) lgkmcnt(0)
  v_smfmac_f32_16x16x64_bf16 v[156:159], v[148:151], v[64:71], v3
  s_waitcnt vmcnt(1)
  v_smfmac_f32_16x16x64_bf16 v[156:159], v[152:155], v[72:79], v3
cB_va1_ep:
  s_nop 7
  v_add_f32 v160, v156, v157
  v_add_f32 v161, v158, v159
  v_cmp_u_f32 vcc, v160, v161
  v_mov_b32_dpp v162, v160 row_ror:8 row_mask:0xf bank_mask:0xf
  v_mov_b32_dpp v160, v161 row_ror:8 row_mask:0xf bank_mask:0xc
  s_cbranch_vccnz cB_va1_rp
  v_mov_b32_dpp v161, v162 quad_perm:[0,1,2,3] row_mask:0xf bank_mask:0x3
  v_cvt_pk_bf16_f32 v160, v160, v161
cB_va1_pc:
  s_mov_b64 exec, s[26:27]
  buffer_store_dword v160, v1, s[8:11], s21 offen sc1
  s_cmp_lg_u32 s19, 62
  s_cbranch_scc1 cB_va1_nl
  s_mov_b32 s22, 88531968
  buffer_store_dword v160, v1, s[8:11], s22 offen sc1
  s_mov_b64 exec, -1
  s_branch cB_done
cB_va1_nl:
  s_mov_b64 exec, -1
  s_cmp_lg_u32 s19, 0
  s_cbranch_scc1 cB_va1_s0
  v_add_u32 v7, 512, v7
  v_lshl_add_u32 v7, v2, 3, v7
  s_mov_b64 exec, 65535
  buffer_store_dword v2, v7, s[8:11], s21 offen sc1
  buffer_store_dword v2, v7, s[8:11], s23 offen sc1
  s_mov_b64 exec, -1
cB_va1_s0:
  s_add_u32 s25, s25, 28672
  s_add_u32 s19, s19, 1
  s_mov_b32 s20, s21
  s_branch cB_va1_loop
cB_va1_last:
  s_waitcnt lgkmcnt(0)
  s_barrier
  s_branch cB_done
cB_va1_rp:
  s_cmp_eq_u32 s37, 0
  s_cbranch_scc1 cB_va1_rv
  v_mov_b32_dpp v161, v162 quad_perm:[0,1,2,3] row_mask:0xf bank_mask:0x3
  v_cvt_pk_bf16_f32 v160, v160, v161
  v_min_u32 v160, -2, v160
  s_branch cB_va1_pc
cB_va1_rv:
  buffer_load_dwordx4 v[8:11], v5, s[8:11], s22 offen offset:0 sc1
  buffer_load_dwordx4 v[12:15], v5, s[8:11], s22 offen offset:1024 sc1
  buffer_load_dwordx4 v[16:19], v5, s[8:11], s22 offen offset:2048 sc1
  buffer_load_dwordx4 v[20:23], v5, s[8:11], s22 offen offset:3072 sc1
  buffer_load_dwordx4 v[24:27], v5, s[8:11], s34 offen offset:0 sc1
  buffer_load_dwordx4 v[28:31], v5, s[8:11], s34 offen offset:1024 sc1
  buffer_load_dwordx4 v[32:35], v5, s[8:11], s34 offen offset:2048 sc1
  buffer_load_dwordx4 v[144:147], v5, s[8:11], s34 offen offset:3072 sc1
  buffer_load_dwordx4 v[148:151], v2, s[8:11], s36 offen offset:0 sc1
  buffer_load_dwordx4 v[152:155], v2, s[8:11], s36 offen offset:1024 sc1
  s_waitcnt vmcnt(0)
  v_max3_u32 v175, v8, v9, v10
  v_max3_u32 v175, v175, v11, v12
  v_max3_u32 v175, v175, v13, v14
  v_max3_u32 v175, v175, v15, v16
  v_max3_u32 v175, v175, v17, v18
  v_max3_u32 v175, v175, v19, v20
  v_max3_u32 v175, v175, v21, v22
  v_max3_u32 v175, v175, v23, v24
  v_max3_u32 v175, v175, v25, v26
  v_max3_u32 v175, v175, v27, v28
  v_max3_u32 v175, v175, v29, v30
  v_max3_u32 v175, v175, v31, v32
  v_max3_u32 v175, v175, v33, v34
  v_max3_u32 v175, v175, v35, v144
  v_max3_u32 v175, v175, v145, v146
  v_max3_u32 v175, v175, v147, v148
  v_max3_u32 v175, v175, v149, v150
  v_max3_u32 v175, v175, v151, v152
  v_max3_u32 v175, v175, v153, v154
  v_max_u32 v175, v175, v155
  v_cmp_eq_u32 vcc, -1, v175
  s_cbranch_vccz cB_va1_rk
  s_add_u32 s30, s30, 1
  s_cmp_lt_u32 s30, 400000
  s_cbranch_scc1 cB_va1_rv
  s_branch cB_abort
cB_va1_rk:
  s_mov_b32 s37, 1
  s_add_u32 s31, s31, 0x10000
  v_mov_b32 v156, 0
  v_mov_b32 v157, 0
  v_mov_b32 v158, 0
  v_mov_b32 v159, 0
  s_nop 1
  v_smfmac_f32_16x16x64_bf16 v[156:159], v[8:11], v[80:87], v3
  v_smfmac_f32_16x16x64_bf16 v[156:159], v[12:15], v[88:95], v3
  v_smfmac_f32_16x16x64_bf16 v[156:159], v[16:19], v[96:103], v3
  v_smfmac_f32_16x16x64_bf16 v[156:159], v[20:23], v[104:111], v3
  v_smfmac_f32_16x16x64_bf16 v[156:159], v[24:27], v[112:119], v3
  v_smfmac_f32_16x16x64_bf16 v[156:159], v[28:31], v[120:127], v3
  v_smfmac_f32_16x16x64_bf16 v[156:159], v[32:35], v[128:135], v3
  v_smfmac_f32_16x16x64_bf16 v[156:159], v[144:147], v[136:143], v3
  v_smfmac_f32_16x16x64_bf16 v[156:159], v[148:151], v[64:71], v3
  v_smfmac_f32_16x16x64_bf16 v[156:159], v[152:155], v[72:79], v3
  s_nop 7
  s_branch cB_va1_ep
.p2align 6

cB_va2_loop:
  s_add_u32 s23, s20, 4096
  s_add_u32 s21, s20, 20480
  v_mov_b32 v36, 0
  v_mov_b32 v37, 0
  v_mov_b32 v38, 0
  v_mov_b32 v39, 0
  v_mov_b32 v40, 0
  v_mov_b32 v41, 0
  v_mov_b32 v42, 0
  v_mov_b32 v43, 0
  v_mov_b32 v44, 0
  v_mov_b32 v45, 0
  v_mov_b32 v46, 0
  v_mov_b32 v47, 0
  v_mov_b32 v48, 0
  v_mov_b32 v49, 0
  v_mov_b32 v50, 0
  v_mov_b32 v51, 0
  v_mov_b32 v52, 0
  v_mov_b32 v53, 0
  v_mov_b32 v54, 0
  v_mov_b32 v55, 0
  v_mov_b32 v56, 0
  v_mov_b32 v57, 0
  v_mov_b32 v58, 0
  v_mov_b32 v59, 0
  v_mov_b32 v60, 0
  v_mov_b32 v61, 0
  v_mov_b32 v62, 0
  v_mov_b32 v63, 0
  v_mov_b32 v64, 0
  v_mov_b32 v65, 0
  v_mov_b32 v66, 0
  v_mov_b32 v67, 0
  s_mov_b32 s30, 0
  buffer_load_dword v76, v119, s[8:11], s20 offen sc1
  buffer_load_dword v77, v119, s[8:11], s20 offen sc1
  buffer_load_dword v78, v119, s[8:11], s20 offen sc1
cB_va2_fp_l:
  s_waitcnt vmcnt(2)
  v_cmp_eq_u32 vcc, -1, v76
  s_cbranch_vccz cB_va2_fp_d
  buffer_load_dword v76, v119, s[8:11], s20 offen sc1
  s_waitcnt vmcnt(2)
  v_cmp_eq_u32 vcc, -1, v77
  s_cbranch_vccz cB_va2_fp_d
  buffer_load_dword v77, v119, s[8:11], s20 offen sc1
  s_waitcnt vmcnt(2)
  v_cmp_eq_u32 vcc, -1, v78
  s_cbranch_vccz cB_va2_fp_d
  buffer_load_dword v78, v119, s[8:11], s20 offen sc1
  s_add_u32 s30, s30, 1
  s_cmp_lt_u32 s30, 400000
  s_cbranch_scc1 cB_va2_fp_l
  s_branch cB_abort
cB_va2_fp_d:
  s_nop 15
  s_nop 3
  buffer_load_dwordx4 v[8:11], v2, s[8:11], s20 offen offset:0 sc1
  buffer_load_dwordx4 v[12:15], v2, s[8:11], s20 offen offset:1024 sc1
  buffer_load_dwordx4 v[16:19], v2, s[8:11], s20 offen offset:2048 sc1
  buffer_load_dwordx4 v[20:23], v2, s[8:11], s20 offen offset:3072 sc1
  s_barrier
cB_va2_ld:
  s_waitcnt vmcnt(0)
  v_max3_u32 v84, v8, v9, v10
  v_max3_u32 v84, v84, v11, v12
  v_max3_u32 v84, v84, v13, v14
  v_max3_u32 v84, v84, v15, v16
  v_max3_u32 v84, v84, v17, v18
  v_max3_u32 v84, v84, v19, v20
  v_max3_u32 v84, v84, v21, v22
  v_max_u32 v84, v84, v23
  v_cmp_eq_u32 vcc, -1, v84
  ds_write_b128 v2, v[8:11] offset:8192
  ds_write_b128 v2, v[12:15] offset:9216
  ds_write_b128 v2, v[16:19] offset:10240
  ds_write_b128 v2, v[20:23] offset:11264
  s_cbranch_vccnz cB_va2_retry
  s_waitcnt lgkmcnt(0)
  s_barrier
  ds_read_b128 v[8:11], v5 offset:8192
  ds_read_b128 v[12:15], v5 offset:9216
  ds_read_b128 v[16:19], v5 offset:10240
  ds_read_b128 v[20:23], v5 offset:11264
  ds_read_b128 v[24:27], v5 offset:12288
  ds_read_b128 v[28:31], v5 offset:13312
  ds_read_b128 v[32:35], v5 offset:14336
  ds_read_b128 v[92:95], v0
  s_waitcnt lgkmcnt(0)
  s_mov_b64 exec, s[26:27]
  buffer_store_dwordx4 v[92:95], v2, s[8:11], s36 offen sc1
  s_mov_b64 exec, -1
  s_add_u32 s36, s36, 7168
  s_cmp_eq_u32 s19, 63
  s_cbranch_scc1 cB_done
  ds_read_b128 v[76:79], v1 offset:0
  ds_read_b128 v[80:83], v1 offset:1024
  ds_read_b128 v[84:87], v1 offset:2048
  ds_read_b128 v[88:91], v1 offset:3072
  ds_read_b128 v[92:95], v1 offset:4096
  ds_read_b128 v[96:99], v1 offset:5120
  v_smfmac_f32_16x16x64_bf16 v[60:63], v[8:11], v[200:207], v3
  v_smfmac_f32_16x16x64_bf16 v[60:63], v[12:15], v[208:215], v3
  s_waitcnt lgkmcnt(4)
  v_smfmac_f32_16x16x64_bf16 v[64:67], v[8:11], v[76:83], v3
  ds_read_b128 v[76:79], v1 offset:6144
  ds_read_b128 v[80:83], v1 offset:7168
  v_smfmac_f32_16x16x64_bf16 v[60:63], v[16:19], v[216:223], v3
  v_smfmac_f32_16x16x64_bf16 v[60:63], v[20:23], v[224:231], v3
  s_waitcnt lgkmcnt(4)
  v_smfmac_f32_16x16x64_bf16 v[64:67], v[12:15], v[84:91], v3
  ds_read_b128 v[84:87], v1 offset:8192
  ds_read_b128 v[88:91], v1 offset:9216
  v_smfmac_f32_16x16x64_bf16 v[60:63], v[24:27], v[232:239], v3
  v_smfmac_f32_16x16x64_bf16 v[60:63], v[28:31], v[240:247], v3
  s_waitcnt lgkmcnt(4)
  v_smfmac_f32_16x16x64_bf16 v[64:67], v[16:19], v[92:99], v3
  ds_read_b128 v[92:95], v1 offset:10240
  ds_read_b128 v[96:99], v1 offset:11264
  v_smfmac_f32_16x16x64_bf16 v[60:63], v[32:35], v[248:255], v3
  v_smfmac_f32_16x16x64_bf16 v[36:39], v[8:11], a[0:7], v3
  s_waitcnt lgkmcnt(4)
  v_smfmac_f32_16x16x64_bf16 v[64:67], v[20:23], v[76:83], v3
  ds_read_b128 v[76:79], v1 offset:12288
  ds_read_b128 v[80:83], v1 offset:13312
  v_smfmac_f32_16x16x64_bf16 v[36:39], v[12:15], a[8:15], v3
  v_add_f32 v60, v60, v61
  v_smfmac_f32_16x16x64_bf16 v[36:39], v[16:19], a[16:23], v3
  v_add_f32 v62, v62, v63
  s_waitcnt lgkmcnt(4)
  v_smfmac_f32_16x16x64_bf16 v[64:67], v[24:27], v[84:91], v3
  v_cvt_pk_bf16_f32 v60, v60, v62
  v_smfmac_f32_16x16x64_bf16 v[36:39], v[20:23], a[24:31], v3
  ds_write_b32 v106, v60
  v_smfmac_f32_16x16x64_bf16 v[36:39], v[24:27], a[32:39], v3
  s_waitcnt lgkmcnt(2)
  v_smfmac_f32_16x16x64_bf16 v[64:67], v[28:31], v[92:99], v3
  v_smfmac_f32_16x16x64_bf16 v[36:39], v[28:31], a[40:47], v3
  v_smfmac_f32_16x16x64_bf16 v[36:39], v[32:35], a[48:55], v3
  s_waitcnt lgkmcnt(0)
  v_smfmac_f32_16x16x64_bf16 v[64:67], v[32:35], v[76:83], v3
  v_smfmac_f32_16x16x64_bf16 v[40:43], v[8:11], a[56:63], v3
  v_smfmac_f32_16x16x64_bf16 v[40:43], v[12:15], a[64:71], v3
  v_add_f32 v36, v36, v37
  v_smfmac_f32_16x16x64_bf16 v[40:43], v[16:19], a[72:79], v3
  v_add_f32 v38, v38, v39
  v_smfmac_f32_16x16x64_bf16 v[40:43], v[20:23], a[80:87], v3
  v_cvt_pk_bf16_f32 v36, v36, v38
  v_smfmac_f32_16x16x64_bf16 v[40:43], v[24:27], a[88:95], v3
  ds_write_b32 v100, v36
  v_smfmac_f32_16x16x64_bf16 v[40:43], v[28:31], a[96:103], v3
  v_add_f32 v64, v64, v65
  v_smfmac_f32_16x16x64_bf16 v[40:43], v[32:35], a[104:111], v3
  v_add_f32 v66, v66, v67
  v_smfmac_f32_16x16x64_bf16 v[44:47], v[8:11], a[112:119], v3
  v_cvt_pk_bf16_f32 v64, v64, v66
  v_smfmac_f32_16x16x64_bf16 v[44:47], v[12:15], a[120:127], v3
  ds_write_b32 v107, v64
  v_smfmac_f32_16x16x64_bf16 v[44:47], v[16:19], a[128:135], v3
  v_add_f32 v40, v40, v41
  v_smfmac_f32_16x16x64_bf16 v[44:47], v[20:23], a[136:143], v3
  v_add_f32 v42, v42, v43
  v_smfmac_f32_16x16x64_bf16 v[44:47], v[24:27], a[144:151], v3
  v_cvt_pk_bf16_f32 v40, v40, v42
  v_smfmac_f32_16x16x64_bf16 v[44:47], v[28:31], a[152:159], v3
  ds_write_b32 v101, v40
  v_smfmac_f32_16x16x64_bf16 v[44:47], v[32:35], a[160:167], v3
  v_smfmac_f32_16x16x64_bf16 v[48:51], v[8:11], a[168:175], v3
  v_smfmac_f32_16x16x64_bf16 v[48:51], v[12:15], a[176:183], v3
  v_smfmac_f32_16x16x64_bf16 v[48:51], v[16:19], a[184:191], v3
  v_add_f32 v44, v44, v45
  v_smfmac_f32_16x16x64_bf16 v[48:51], v[20:23], a[192:199], v3
  v_add_f32 v46, v46, v47
  v_smfmac_f32_16x16x64_bf16 v[48:51], v[24:27], a[200:207], v3
  v_cvt_pk_bf16_f32 v44, v44, v46
  v_smfmac_f32_16x16x64_bf16 v[48:51], v[28:31], a[208:215], v3
  ds_write_b32 v102, v44
  v_smfmac_f32_16x16x64_bf16 v[48:51], v[32:35], a[216:223], v3
  v_smfmac_f32_16x16x64_bf16 v[52:55], v[8:11], a[224:231], v3
  v_smfmac_f32_16x16x64_bf16 v[52:55], v[12:15], a[232:239], v3
  v_smfmac_f32_16x16x64_bf16 v[52:55], v[16:19], a[240:247], v3
  v_add_f32 v48, v48, v49
  v_smfmac_f32_16x16x64_bf16 v[52:55], v[20:23], a[248:255], v3
  v_add_f32 v50, v50, v51
  v_smfmac_f32_16x16x64_bf16 v[52:55], v[24:27], v[120:127], v3
  v_cvt_pk_bf16_f32 v48, v48, v50
  v_smfmac_f32_16x16x64_bf16 v[52:55], v[28:31], v[128:135], v3
  ds_write_b32 v103, v48
  v_smfmac_f32_16x16x64_bf16 v[52:55], v[32:35], v[136:143], v3
  v_smfmac_f32_16x16x64_bf16 v[56:59], v[8:11], v[144:151], v3
  v_smfmac_f32_16x16x64_bf16 v[56:59], v[12:15], v[152:159], v3
  v_smfmac_f32_16x16x64_bf16 v[56:59], v[16:19], v[160:167], v3
  v_add_f32 v52, v52, v53
  v_smfmac_f32_16x16x64_bf16 v[56:59], v[20:23], v[168:175], v3
  v_add_f32 v54, v54, v55
  v_smfmac_f32_16x16x64_bf16 v[56:59], v[24:27], v[176:183], v3
  v_cvt_pk_bf16_f32 v52, v52, v54
  v_smfmac_f32_16x16x64_bf16 v[56:59], v[28:31], v[184:191], v3
  ds_write_b32 v104, v52
  v_smfmac_f32_16x16x64_bf16 v[56:59], v[32:35], v[192:199], v3
  s_nop 7
  v_add_f32 v56, v56, v57
  v_add_f32 v58, v58, v59
  v_cvt_pk_bf16_f32 v56, v56, v58
  ds_write_b32 v105, v56
  s_waitcnt lgkmcnt(0)
  s_barrier
  s_cmp_eq_u32 s19, 62
  s_cbranch_scc1 cB_done
  s_waitcnt vmcnt(0) lgkmcnt(0)
  s_add_u32 s19, s19, 1
  s_mov_b32 s20, s21
  s_branch cB_va2_loop
cB_va2_retry:
  s_waitcnt lgkmcnt(0)
  buffer_load_dwordx4 v[8:11], v2, s[8:11], s20 offen offset:0 sc1
  buffer_load_dwordx4 v[12:15], v2, s[8:11], s20 offen offset:1024 sc1
  buffer_load_dwordx4 v[16:19], v2, s[8:11], s20 offen offset:2048 sc1
  buffer_load_dwordx4 v[20:23], v2, s[8:11], s20 offen offset:3072 sc1
  s_add_u32 s31, s31, 1
  s_add_u32 s30, s30, 1
  s_cmp_lt_u32 s30, 400000
  s_cbranch_scc1 cB_va2_ld
  s_branch cB_abort
cB_va2_last:
  s_waitcnt lgkmcnt(0)
  buffer_store_dwordx4 v[100:103], v2, s[8:11], s24 offen offset:0 sc1
  buffer_store_dwordx4 v[104:107], v2, s[8:11], s24 offen offset:1024 sc1
  buffer_store_dwordx4 v[108:111], v2, s[8:11], s24 offen offset:2048 sc1
  buffer_store_dwordx4 v[4:7], v2, s[8:11], s24 offen offset:3072 sc1
  s_add_u32 s24, s24, 8192
  s_waitcnt vmcnt(0)
  s_mov_b64 exec, 1
  buffer_store_dword v117, v2, s[8:11], s34 offen sc1
  s_mov_b64 exec, -1
  s_add_u32 s34, s34, 8
  s_mov_b64 exec, 1
  buffer_store_dword v117, v2, s[8:11], s34 offen sc1
  s_mov_b64 exec, -1
  s_add_u32 s34, s34, 8
  s_branch cB_done
.p2align 6

cB_va3_loop:
  s_add_u32 s23, s20, 4096
  s_add_u32 s21, s20, 20480
  v_mov_b32 v36, 0
  v_mov_b32 v37, 0
  v_mov_b32 v38, 0
  v_mov_b32 v39, 0
  v_mov_b32 v40, 0
  v_mov_b32 v41, 0
  v_mov_b32 v42, 0
  v_mov_b32 v43, 0
  v_mov_b32 v44, 0
  v_mov_b32 v45, 0
  v_mov_b32 v46, 0
  v_mov_b32 v47, 0
  v_mov_b32 v48, 0
  v_mov_b32 v49, 0
  v_mov_b32 v50, 0
  v_mov_b32 v51, 0
  v_mov_b32 v52, 0
  v_mov_b32 v53, 0
  v_mov_b32 v54, 0
  v_mov_b32 v55, 0
  v_mov_b32 v56, 0
  v_mov_b32 v57, 0
  v_mov_b32 v58, 0
  v_mov_b32 v59, 0
  v_mov_b32 v60, 0
  v_mov_b32 v61, 0
  v_mov_b32 v62, 0
  v_mov_b32 v63, 0
  v_mov_b32 v64, 0
  v_mov_b32 v65, 0
  v_mov_b32 v66, 0
  v_mov_b32 v67, 0
  s_mov_b32 s30, 0
  buffer_load_dword v76, v119, s[8:11], s20 offen sc1
  buffer_load_dword v77, v119, s[8:11], s20 offen sc1
  buffer_load_dword v78, v119, s[8:11], s20 offen sc1
cB_va3_fp_l:
  s_waitcnt vmcnt(2)
  v_cmp_eq_u32 vcc, -1, v76
  s_cbranch_vccz cB_va3_fp_d
  buffer_load_dword v76, v119, s[8:11], s20 offen sc1
  s_waitcnt vmcnt(2)
  v_cmp_eq_u32 vcc, -1, v77
  s_cbranch_vccz cB_va3_fp_d
  buffer_load_dword v77, v119, s[8:11], s20 offen sc1
  s_waitcnt vmcnt(2)
  v_cmp_eq_u32 vcc, -1, v78
  s_cbranch_vccz cB_va3_fp_d
  buffer_load_dword v78, v119, s[8:11], s20 offen sc1
  s_add_u32 s30, s30, 1
  s_cmp_lt_u32 s30, 400000
  s_cbranch_scc1 cB_va3_fp_l
  s_branch cB_abort
cB_va3_fp_d:
  buffer_load_dwordx4 v[24:27], v2, s[8:11], s23 offen offset:0 sc1
  buffer_load_dwordx4 v[28:31], v2, s[8:11], s23 offen offset:1024 sc1
  buffer_load_dwordx4 v[32:35], v2, s[8:11], s23 offen offset:2048 sc1
  s_barrier
cB_va3_ld:
  s_waitcnt vmcnt(0)
  v_max3_u32 v84, v24, v25, v26
  v_max3_u32 v84, v84, v27, v28
  v_max3_u32 v84, v84, v29, v30
  v_max3_u32 v84, v84, v31, v32
  v_max3_u32 v84, v84, v33, v34
  v_max_u32 v84, v84, v35
  v_cmp_eq_u32 vcc, -1, v84
  ds_write_b128 v2, v[24:27] offset:12288
  ds_write_b128 v2, v[28:31] offset:13312
  ds_write_b128 v2, v[32:35] offset:14336
  s_cbranch_vccnz cB_va3_retry
  s_waitcnt lgkmcnt(0)
  s_barrier
  ds_read_b128 v[8:11], v5 offset:8192
  ds_read_b128 v[12:15], v5 offset:9216
  ds_read_b128 v[16:19], v5 offset:10240
  ds_read_b128 v[20:23], v5 offset:11264
  ds_read_b128 v[24:27], v5 offset:12288
  ds_read_b128 v[28:31], v5 offset:13312
  ds_read_b128 v[32:35], v5 offset:14336
  s_waitcnt lgkmcnt(0)
  s_cmp_eq_u32 s19, 63
  s_cbranch_scc1 cB_done
  ds_read_b128 v[76:79], v1 offset:0
  ds_read_b128 v[80:83], v1 offset:1024
  ds_read_b128 v[84:87], v1 offset:2048
  ds_read_b128 v[88:91], v1 offset:3072
  ds_read_b128 v[92:95], v1 offset:4096
  ds_read_b128 v[96:99], v1 offset:5120
  v_smfmac_f32_16x16x64_bf16 v[60:63], v[8:11], v[200:207], v3
  v_smfmac_f32_16x16x64_bf16 v[60:63], v[12:15], v[208:215], v3
  s_waitcnt lgkmcnt(4)
  v_smfmac_f32_16x16x64_bf16 v[64:67], v[8:11], v[76:83], v3
  ds_read_b128 v[76:79], v1 offset:6144
  ds_read_b128 v[80:83], v1 offset:7168
  v_smfmac_f32_16x16x64_bf16 v[60:63], v[16:19], v[216:223], v3
  v_smfmac_f32_16x16x64_bf16 v[60:63], v[20:23], v[224:231], v3
  s_waitcnt lgkmcnt(4)
  v_smfmac_f32_16x16x64_bf16 v[64:67], v[12:15], v[84:91], v3
  ds_read_b128 v[84:87], v1 offset:8192
  ds_read_b128 v[88:91], v1 offset:9216
  v_smfmac_f32_16x16x64_bf16 v[60:63], v[24:27], v[232:239], v3
  v_smfmac_f32_16x16x64_bf16 v[60:63], v[28:31], v[240:247], v3
  s_waitcnt lgkmcnt(4)
  v_smfmac_f32_16x16x64_bf16 v[64:67], v[16:19], v[92:99], v3
  ds_read_b128 v[92:95], v1 offset:10240
  ds_read_b128 v[96:99], v1 offset:11264
  v_smfmac_f32_16x16x64_bf16 v[60:63], v[32:35], v[248:255], v3
  v_smfmac_f32_16x16x64_bf16 v[36:39], v[8:11], a[0:7], v3
  s_waitcnt lgkmcnt(4)
  v_smfmac_f32_16x16x64_bf16 v[64:67], v[20:23], v[76:83], v3
  ds_read_b128 v[76:79], v1 offset:12288
  ds_read_b128 v[80:83], v1 offset:13312
  v_smfmac_f32_16x16x64_bf16 v[36:39], v[12:15], a[8:15], v3
  v_add_f32 v60, v60, v61
  v_smfmac_f32_16x16x64_bf16 v[36:39], v[16:19], a[16:23], v3
  v_add_f32 v62, v62, v63
  s_waitcnt lgkmcnt(4)
  v_smfmac_f32_16x16x64_bf16 v[64:67], v[24:27], v[84:91], v3
  v_cvt_pk_bf16_f32 v60, v60, v62
  v_smfmac_f32_16x16x64_bf16 v[36:39], v[20:23], a[24:31], v3
  ds_write_b32 v106, v60
  v_smfmac_f32_16x16x64_bf16 v[36:39], v[24:27], a[32:39], v3
  s_waitcnt lgkmcnt(2)
  v_smfmac_f32_16x16x64_bf16 v[64:67], v[28:31], v[92:99], v3
  v_smfmac_f32_16x16x64_bf16 v[36:39], v[28:31], a[40:47], v3
  v_smfmac_f32_16x16x64_bf16 v[36:39], v[32:35], a[48:55], v3
  s_waitcnt lgkmcnt(0)
  v_smfmac_f32_16x16x64_bf16 v[64:67], v[32:35], v[76:83], v3
  v_smfmac_f32_16x16x64_bf16 v[40:43], v[8:11], a[56:63], v3
  v_smfmac_f32_16x16x64_bf16 v[40:43], v[12:15], a[64:71], v3
  v_add_f32 v36, v36, v37
  v_smfmac_f32_16x16x64_bf16 v[40:43], v[16:19], a[72:79], v3
  v_add_f32 v38, v38, v39
  v_smfmac_f32_16x16x64_bf16 v[40:43], v[20:23], a[80:87], v3
  v_cvt_pk_bf16_f32 v36, v36, v38
  v_smfmac_f32_16x16x64_bf16 v[40:43], v[24:27], a[88:95], v3
  ds_write_b32 v100, v36
  v_smfmac_f32_16x16x64_bf16 v[40:43], v[28:31], a[96:103], v3
  v_add_f32 v64, v64, v65
  v_smfmac_f32_16x16x64_bf16 v[40:43], v[32:35], a[104:111], v3
  v_add_f32 v66, v66, v67
  v_smfmac_f32_16x16x64_bf16 v[44:47], v[8:11], a[112:119], v3
  v_cvt_pk_bf16_f32 v64, v64, v66
  v_smfmac_f32_16x16x64_bf16 v[44:47], v[12:15], a[120:127], v3
  ds_write_b32 v107, v64
  v_smfmac_f32_16x16x64_bf16 v[44:47], v[16:19], a[128:135], v3
  v_add_f32 v40, v40, v41
  v_smfmac_f32_16x16x64_bf16 v[44:47], v[20:23], a[136:143], v3
  v_add_f32 v42, v42, v43
  v_smfmac_f32_16x16x64_bf16 v[44:47], v[24:27], a[144:151], v3
  v_cvt_pk_bf16_f32 v40, v40, v42
  v_smfmac_f32_16x16x64_bf16 v[44:47], v[28:31], a[152:159], v3
  ds_write_b32 v101, v40
  v_smfmac_f32_16x16x64_bf16 v[44:47], v[32:35], a[160:167], v3
  v_smfmac_f32_16x16x64_bf16 v[48:51], v[8:11], a[168:175], v3
  v_smfmac_f32_16x16x64_bf16 v[48:51], v[12:15], a[176:183], v3
  v_smfmac_f32_16x16x64_bf16 v[48:51], v[16:19], a[184:191], v3
  v_add_f32 v44, v44, v45
  v_smfmac_f32_16x16x64_bf16 v[48:51], v[20:23], a[192:199], v3
  v_add_f32 v46, v46, v47
  v_smfmac_f32_16x16x64_bf16 v[48:51], v[24:27], a[200:207], v3
  v_cvt_pk_bf16_f32 v44, v44, v46
  v_smfmac_f32_16x16x64_bf16 v[48:51], v[28:31], a[208:215], v3
  ds_write_b32 v102, v44
  v_smfmac_f32_16x16x64_bf16 v[48:51], v[32:35], a[216:223], v3
  v_smfmac_f32_16x16x64_bf16 v[52:55], v[8:11], a[224:231], v3
  v_smfmac_f32_16x16x64_bf16 v[52:55], v[12:15], a[232:239], v3
  v_smfmac_f32_16x16x64_bf16 v[52:55], v[16:19], a[240:247], v3
  v_add_f32 v48, v48, v49
  v_smfmac_f32_16x16x64_bf16 v[52:55], v[20:23], a[248:255], v3
  v_add_f32 v50, v50, v51
  v_smfmac_f32_16x16x64_bf16 v[52:55], v[24:27], v[120:127], v3
  v_cvt_pk_bf16_f32 v48, v48, v50
  v_smfmac_f32_16x16x64_bf16 v[52:55], v[28:31], v[128:135], v3
  ds_write_b32 v103, v48
  v_smfmac_f32_16x16x64_bf16 v[52:55], v[32:35], v[136:143], v3
  v_smfmac_f32_16x16x64_bf16 v[56:59], v[8:11], v[144:151], v3
  v_smfmac_f32_16x16x64_bf16 v[56:59], v[12:15], v[152:159], v3
  v_smfmac_f32_16x16x64_bf16 v[56:59], v[16:19], v[160:167], v3
  v_add_f32 v52, v52, v53
  v_smfmac_f32_16x16x64_bf16 v[56:59], v[20:23], v[168:175], v3
  v_add_f32 v54, v54, v55
  v_smfmac_f32_16x16x64_bf16 v[56:59], v[24:27], v[176:183], v3
  v_cvt_pk_bf16_f32 v52, v52, v54
  v_smfmac_f32_16x16x64_bf16 v[56:59], v[28:31], v[184:191], v3
  ds_write_b32 v104, v52
  v_smfmac_f32_16x16x64_bf16 v[56:59], v[32:35], v[192:199], v3
  s_nop 7
  v_add_f32 v56, v56, v57
  v_add_f32 v58, v58, v59
  v_cvt_pk_bf16_f32 v56, v56, v58
  ds_write_b32 v105, v56
  s_waitcnt lgkmcnt(0)
  s_barrier
  s_cmp_eq_u32 s19, 62
  s_cbranch_scc1 cB_done
  s_waitcnt vmcnt(0) lgkmcnt(0)
  s_add_u32 s19, s19, 1
  s_mov_b32 s20, s21
  s_branch cB_va3_loop
cB_va3_retry:
  s_waitcnt lgkmcnt(0)
  buffer_load_dwordx4 v[24:27], v2, s[8:11], s23 offen offset:0 sc1
  buffer_load_dwordx4 v[28:31], v2, s[8:11], s23 offen offset:1024 sc1
  buffer_load_dwordx4 v[32:35], v2, s[8:11], s23 offen offset:2048 sc1
  s_add_u32 s31, s31, 1
  s_add_u32 s30, s30, 1
  s_cmp_lt_u32 s30, 400000
  s_cbranch_scc1 cB_va3_ld
  s_branch cB_abort
cB_va3_last:
  s_waitcnt lgkmcnt(0)
  buffer_store_dwordx4 v[100:103], v2, s[8:11], s24 offen offset:0 sc1
  buffer_store_dwordx4 v[104:107], v2, s[8:11], s24 offen offset:1024 sc1
  buffer_store_dwordx4 v[108:111], v2, s[8:11], s24 offen offset:2048 sc1
  buffer_store_dwordx4 v[4:7], v2, s[8:11], s24 offen offset:3072 sc1
  s_add_u32 s24, s24, 8192
  s_waitcnt vmcnt(0)
  s_mov_b64 exec, 1
  buffer_store_dword v117, v2, s[8:11], s34 offen sc1
  s_mov_b64 exec, -1
  s_add_u32 s34, s34, 8
  s_mov_b64 exec, 1
  buffer_store_dword v117, v2, s[8:11], s34 offen sc1
  s_mov_b64 exec, -1
  s_add_u32 s34, s34, 8
  s_branch cB_done
cB_abort:
  v_mov_b32 v4, 0xdead
  v_mov_b32 v5, 16
  buffer_store_dword v4, v5, s[12:15], 0 offen
  s_branch ch_end
cB_done:
  s_branch ch_end
m_reclaim:
  s_waitcnt vmcnt(0)
  s_lshr_b32 s20, s3, 5
  s_cmp_lg_u32 s16, 0
  s_cbranch_scc1 w0_17
  s_mov_b32 s21, 0
  s_mov_b64 exec, 1
rc_l:
  s_cmp_lg_u32 s70, -1
  s_cbranch_scc1 rc_t
  s_add_u32 s20, s20, 1
  s_cmp_lt_u32 s20, 8
  s_cselect_b32 s20, s20, 0
  s_mov_b32 s70, 0
  s_mov_b32 s3, -1
  s_add_u32 s21, s21, 1
  s_cmp_ge_u32 s21, 9
  s_cbranch_scc1 rc_d
rc_t:
  s_ff0_i32_b32 s22, s70
  s_lshl_b32 s23, 1, s22
  s_and_b32 s71, s20, 4
  s_mul_i32 s71, s71, 12
  s_lshl_b32 s3, s20, 2
  s_add_u32 s3, s3, s71
  v_mov_b32 v242, s23
  v_mov_b32 v243, 32
  buffer_atomic_or v242, v243, s[12:15], s3 offen sc0
  s_waitcnt vmcnt(0)
  v_readfirstlane_b32 s70, v242
  s_lshl_b32 s3, s20, 5
  s_add_u32 s3, s3, s22
  s_bitcmp1_b32 s70, s22
  s_cbranch_scc1 rc_l
rc_d:
  s_mov_b64 exec, -1
  v_mov_b32 v242, s3
w0_17:
  v_mov_b32 v250, 160000
  s_add_u32 s101, s101, 1
  s_barrier
  s_mov_b64 exec, 1
  s_cmp_lg_u32 s16, 0
  s_cbranch_scc1 w0_18
  ds_write_b32 v250, v242 offset:0
  s_waitcnt lgkmcnt(0)
  v_mov_b32 v242, s101
  ds_write_b32 v250, v242 offset:16
  s_waitcnt lgkmcnt(0)
w0_18:
  s_mov_b64 exec, -1
  s_barrier
  ds_read_b32 v242, v250 offset:0
  ds_read_b32 v250, v250 offset:16
  s_waitcnt lgkmcnt(0)
  v_readfirstlane_b32 s3, v242
  v_cmp_ne_u32 vcc, s101, v250
  s_cbranch_vccnz ch_end
  s_cmp_lg_u32 s3, -1
  s_cbranch_scc1 m_start
  v_mov_b32 v250, 0
  s_branch wk_ask
m_bjob:
  v_and_b32 v1, 63, v0
  v_lshlrev_b32 v2, 4, v1
  v_lshrrev_b32 v3, 4, v1
  v_and_b32 v4, 15, v1
  s_sub_u32 s18, s3, 32
  s_mul_i32 s17, s18, 4682
  s_lshr_b32 s17, s17, 16
  s_mul_i32 s20, s17, 14
  s_sub_u32 s19, s18, s20
  s_cmp_ge_u32 s19, 7
  s_cselect_b32 s31, 7, 0
  s_sub_u32 s19, s19, s31
  s_mov_b32 s60, s44
  s_and_b32 s61, s45, 0xffff
  s_mov_b32 s62, 3670016
  s_mov_b32 s63, 0x20000
  s_mov_b32 s56, s46
  s_and_b32 s57, s47, 0xffff
  s_mov_b32 s58, 3670016
  s_mov_b32 s59, 0x20000
  s_lshl_b32 s30, s16, 13
  s_mul_i32 s27, s17, 229376
  s_lshl_b32 s29, s19, 7
  s_add_u32 s27, s27, s29
  v_lshrrev_b32 v7, 3, v1
  v_and_b32 v8, 7, v1
  v_and_b32 v9, 2, v7
  v_xor_b32 v8, v8, v9
  s_lshl_b32 s29, s16, 6
  v_add_u32 v7, s29, v7
  v_mul_u32_u24 v7, 896, v7
  v_lshl_add_u32 v7, v8, 4, v7
  v_xor_b32 v8, 64, v7
  s_add_u32 m0, s30, 0
  s_add_u32 s22, s27, 0
  buffer_load_dwordx4 v7, s[56:59], s22 offen offset:0 lds
  s_add_u32 s22, s27, 6144
  buffer_load_dwordx4 v8, s[56:59], s22 offen offset:1024 lds
  s_add_u32 s22, s27, 12288
  buffer_load_dwordx4 v7, s[56:59], s22 offen offset:2048 lds
  s_add_u32 s22, s27, 18432
  buffer_load_dwordx4 v8, s[56:59], s22 offen offset:3072 lds
  s_add_u32 m0, s30, 4096
  s_add_u32 s22, s27, 28672
  buffer_load_dwordx4 v7, s[56:59], s22 offen offset:0 lds
  s_add_u32 s22, s27, 34816
  buffer_load_dwordx4 v8, s[56:59], s22 offen offset:1024 lds
  s_add_u32 s22, s27, 40960
  buffer_load_dwordx4 v7, s[56:59], s22 offen offset:2048 lds
  s_add_u32 s22, s27, 47104
  buffer_load_dwordx4 v8, s[56:59], s22 offen offset:3072 lds
  v_lshrrev_b32 v5, 5, v1
  v_and_b32 v6, 31, v1
  s_lshl_b32 s25, s16, 15
  s_add_u32 s25, s25, 32768
  s_lshl_b32 s26, s17, 9
  s_add_u32 s28, s19, s16
  s_cmp_ge_u32 s28, 7
  s_cselect_b32 s20, 7, 0
  s_sub_u32 s28, s28, s20
  s_add_u32 s28, s28, s31
  s_add_u32 s29, s19, s16
  s_add_u32 s29, s29, 4
  s_cmp_ge_u32 s29, 7
  s_cselect_b32 s20, 7, 0
  s_sub_u32 s29, s29, s20
  s_add_u32 s29, s29, s31
  s_lshl_b32 s32, s28, 18
  s_add_u32 s32, s32, s26
  s_lshl_b32 s33, s29, 18
  s_add_u32 s33, s33, s26
  v_xor_b32 v8, v6, v5
  v_lshlrev_b32 v8, 4, v8
  v_lshl_add_u32 v8, v5, 13, v8
  v_xor_b32 v12, 0, v8
  v_xor_b32 v13, 32, v8
  v_add_u32 v13, 15360, v13
  v_xor_b32 v14, 0, v8
  v_add_u32 v14, 30720, v14
  v_xor_b32 v15, 32, v8
  v_add_u32 v15, 46080, v15
  s_add_u32 s20, s16, 0
  s_and_b32 s20, s20, 3
  s_mul_i32 s21, s20, 65600
  s_lshl_b32 s20, s20, 12
  s_add_u32 s48, s20, s25
  s_mov_b32 m0, s48
  v_xor_b32 v16, s21, v12
  buffer_load_dwordx4 v16, s[60:63], s32 offen offset:0 lds
  v_xor_b32 v17, s21, v13
  buffer_load_dwordx4 v17, s[60:63], s32 offen offset:1024 lds
  v_xor_b32 v18, s21, v14
  buffer_load_dwordx4 v18, s[60:63], s32 offen offset:2048 lds
  v_xor_b32 v19, s21, v15
  buffer_load_dwordx4 v19, s[60:63], s32 offen offset:3072 lds
  s_add_u32 s20, s16, 1
  s_and_b32 s20, s20, 3
  s_mul_i32 s21, s20, 65600
  s_lshl_b32 s20, s20, 12
  s_add_u32 s49, s20, s25
  s_mov_b32 m0, s49
  v_xor_b32 v20, s21, v12
  buffer_load_dwordx4 v20, s[60:63], s32 offen offset:0 lds
  v_xor_b32 v21, s21, v13
  buffer_load_dwordx4 v21, s[60:63], s32 offen offset:1024 lds
  v_xor_b32 v22, s21, v14
  buffer_load_dwordx4 v22, s[60:63], s32 offen offset:2048 lds
  v_xor_b32 v23, s21, v15
  buffer_load_dwordx4 v23, s[60:63], s32 offen offset:3072 lds
  s_add_u32 s20, s16, 2
  s_and_b32 s20, s20, 3
  s_mul_i32 s21, s20, 65600
  s_lshl_b32 s20, s20, 12
  s_add_u32 s50, s20, s25
  s_mov_b32 m0, s50
  v_xor_b32 v24, s21, v12
  buffer_load_dwordx4 v24, s[60:63], s32 offen offset:0 lds
  v_xor_b32 v25, s21, v13
  buffer_load_dwordx4 v25, s[60:63], s32 offen offset:1024 lds
  v_xor_b32 v26, s21, v14
  buffer_load_dwordx4 v26, s[60:63], s32 offen offset:2048 lds
  v_xor_b32 v27, s21, v15
  buffer_load_dwordx4 v27, s[60:63], s32 offen offset:3072 lds
  s_add_u32 s20, s16, 3
  s_and_b32 s20, s20, 3
  s_mul_i32 s21, s20, 65600
  s_lshl_b32 s20, s20, 12
  s_add_u32 s51, s20, s25
  s_mov_b32 m0, s51
  v_xor_b32 v28, s21, v12
  buffer_load_dwordx4 v28, s[60:63], s32 offen offset:0 lds
  v_xor_b32 v29, s21, v13
  buffer_load_dwordx4 v29, s[60:63], s32 offen offset:1024 lds
  v_xor_b32 v30, s21, v14
  buffer_load_dwordx4 v30, s[60:63], s32 offen offset:2048 lds
  v_xor_b32 v31, s21, v15
  buffer_load_dwordx4 v31, s[60:63], s32 offen offset:3072 lds
  s_cmp_lg_u32 s66, 0
  s_cbranch_scc1 bj_ci
  s_cmp_lg_u32 s16, 0
  s_cbranch_scc1 w0_19
  s_lshr_b32 s70, s3, 5
  s_and_b32 s71, s70, 4
  s_mul_i32 s71, s71, 12
  s_lshl_b32 s70, s70, 2
  s_add_u32 s70, s70, s71
  s_lshl_b32 s71, 1, s3
  v_mov_b32 v44, s71
  v_mov_b32 v45, 32
  s_mov_b64 exec, 1
  buffer_atomic_or v44, v45, s[12:15], s70 offen sc0
  buffer_load_dwordx2 v[46:47], v45, s[12:15], 0 offen offset:96 sc1
  s_mov_b64 exec, -1
w0_19:
bj_ci:
  s_lshl_b32 s30, s19, 6
  s_add_u32 s30, s30, 0
  s_cmp_lt_u32 s19, 4
  s_cselect_b32 s20, 0, 256
  s_sub_u32 s30, s30, s20
  v_add_u32 v8, s30, v4
  s_lshr_b32 s20, s20, 4
  s_cmp_lt_u32 s19, 4
  s_movk_i32 s21, 5462
  s_cselect_b32 s21, 4096, s21
  s_cselect_b32 s30, 16, 12
  v_mul_u32_u24 v10, s21, v8
  v_lshrrev_b32 v10, 16, v10
  v_mul_u32_u24 v11, s30, v10
  v_sub_u32 v32, v8, v11
  v_add_u32 v32, s20, v32
  s_lshl_b32 s30, s17, 4
  s_mul_i32 s20, s17, 12
  s_add_u32 s20, s20, 240
  s_cmp_lt_u32 s19, 4
  s_cselect_b32 s30, s30, s20
  v_add_u32 v32, s30, v32
  v_lshrrev_b32 v33, 4, v32
  v_and_b32 v32, 15, v32
  s_mov_b32 s30, 401408
  v_mul_lo_u32 v10, v10, s30
  v_mul_u32_u24 v33, 14336, v33
  v_add_u32 v10, v10, v33
  v_lshl_add_u32 v10, v3, 8, v10
  v_lshl_add_u32 v10, v32, 4, v10
  v_add_u32 v12, 6422528, v10
  s_lshl_b32 s30, s19, 6
  s_add_u32 s30, s30, 16
  s_cmp_lt_u32 s19, 4
  s_cselect_b32 s20, 0, 256
  s_sub_u32 s30, s30, s20
  v_add_u32 v8, s30, v4
  s_lshr_b32 s20, s20, 4
  s_cmp_lt_u32 s19, 4
  s_movk_i32 s21, 5462
  s_cselect_b32 s21, 4096, s21
  s_cselect_b32 s30, 16, 12
  v_mul_u32_u24 v10, s21, v8
  v_lshrrev_b32 v10, 16, v10
  v_mul_u32_u24 v11, s30, v10
  v_sub_u32 v32, v8, v11
  v_add_u32 v32, s20, v32
  s_lshl_b32 s30, s17, 4
  s_mul_i32 s20, s17, 12
  s_add_u32 s20, s20, 240
  s_cmp_lt_u32 s19, 4
  s_cselect_b32 s30, s30, s20
  v_add_u32 v32, s30, v32
  v_lshrrev_b32 v33, 4, v32
  v_and_b32 v32, 15, v32
  s_mov_b32 s30, 401408
  v_mul_lo_u32 v10, v10, s30
  v_mul_u32_u24 v33, 14336, v33
  v_add_u32 v10, v10, v33
  v_lshl_add_u32 v10, v3, 8, v10
  v_lshl_add_u32 v10, v32, 4, v10
  v_add_u32 v13, 6422528, v10
  s_lshl_b32 s30, s19, 6
  s_add_u32 s30, s30, 32
  s_cmp_lt_u32 s19, 4
  s_cselect_b32 s20, 0, 256
  s_sub_u32 s30, s30, s20
  v_add_u32 v8, s30, v4
  s_lshr_b32 s20, s20, 4
  s_cmp_lt_u32 s19, 4
  s_movk_i32 s21, 5462
  s_cselect_b32 s21, 4096, s21
  s_cselect_b32 s30, 16, 12
  v_mul_u32_u24 v10, s21, v8
  v_lshrrev_b32 v10, 16, v10
  v_mul_u32_u24 v11, s30, v10
  v_sub_u32 v32, v8, v11
  v_add_u32 v32, s20, v32
  s_lshl_b32 s30, s17, 4
  s_mul_i32 s20, s17, 12
  s_add_u32 s20, s20, 240
  s_cmp_lt_u32 s19, 4
  s_cselect_b32 s30, s30, s20
  v_add_u32 v32, s30, v32
  v_lshrrev_b32 v33, 4, v32
  v_and_b32 v32, 15, v32
  s_mov_b32 s30, 401408
  v_mul_lo_u32 v10, v10, s30
  v_mul_u32_u24 v33, 14336, v33
  v_add_u32 v10, v10, v33
  v_lshl_add_u32 v10, v3, 8, v10
  v_lshl_add_u32 v10, v32, 4, v10
  v_add_u32 v14, 6422528, v10
  s_lshl_b32 s30, s19, 6
  s_add_u32 s30, s30, 48
  s_cmp_lt_u32 s19, 4
  s_cselect_b32 s20, 0, 256
  s_sub_u32 s30, s30, s20
  v_add_u32 v8, s30, v4
  s_lshr_b32 s20, s20, 4
  s_cmp_lt_u32 s19, 4
  s_movk_i32 s21, 5462
  s_cselect_b32 s21, 4096, s21
  s_cselect_b32 s30, 16, 12
  v_mul_u32_u24 v10, s21, v8
  v_lshrrev_b32 v10, 16, v10
  v_mul_u32_u24 v11, s30, v10
  v_sub_u32 v32, v8, v11
  v_add_u32 v32, s20, v32
  s_lshl_b32 s30, s17, 4
  s_mul_i32 s20, s17, 12
  s_add_u32 s20, s20, 240
  s_cmp_lt_u32 s19, 4
  s_cselect_b32 s30, s30, s20
  v_add_u32 v32, s30, v32
  v_lshrrev_b32 v33, 4, v32
  v_and_b32 v32, 15, v32
  s_mov_b32 s30, 401408
  v_mul_lo_u32 v10, v10, s30
  v_mul_u32_u24 v33, 14336, v33
  v_add_u32 v10, v10, v33
  v_lshl_add_u32 v10, v3, 8, v10
  v_lshl_add_u32 v10, v32, 4, v10
  v_add_u32 v15, 6422528, v10
  v_lshrrev_b32 v7, 2, v4
  v_lshlrev_b32 v7, 3, v7
  v_and_b32 v8, 3, v4
  v_add_u32 v7, v7, v8
  v_xor_b32 v10, v3, v4
  v_lshlrev_b32 v10, 4, v10
  v_lshl_add_u32 v10, v7, 9, v10
  v_add_u32 v10, s25, v10
  v_xor_b32 v32, 0, v10
  v_xor_b32 v33, 64, v10
  v_xor_b32 v34, 128, v10
  v_xor_b32 v35, 192, v10
  v_lshrrev_b32 v7, 2, v4
  v_lshl_add_u32 v7, v3, 3, v7
  v_lshlrev_b32 v7, 7, v7
  v_and_b32 v8, 3, v4
  v_lshl_add_u32 v7, v8, 3, v7
  v_lshrrev_b32 v8, 3, v4
  v_lshl_add_u32 v7, v8, 5, v7
  v_and_b32 v8, 1, v3
  v_lshl_add_u32 v7, v8, 6, v7
  s_waitcnt vmcnt(16)
  s_barrier
  s_cmp_eq_u32 s16, 3
  s_cbranch_scc1 bj_np0
  s_add_u32 m0, s48, 16384
  s_nop 0
  buffer_load_dwordx4 v16, s[60:63], s33 offen offset:0 lds
  buffer_load_dwordx4 v17, s[60:63], s33 offen offset:1024 lds
  buffer_load_dwordx4 v18, s[60:63], s33 offen offset:2048 lds
  buffer_load_dwordx4 v19, s[60:63], s33 offen offset:3072 lds
bj_np0:
  v_xor_b32 v9, 0, v7
  ds_read_b64_tr_b16 v[128:129], v9 offset:0
  ds_read_b64_tr_b16 v[130:131], v9 offset:512
  ds_read_b64_tr_b16 v[132:133], v9 offset:4096
  ds_read_b64_tr_b16 v[134:135], v9 offset:4608
  ds_read_b64_tr_b16 v[136:137], v9 offset:8192
  ds_read_b64_tr_b16 v[138:139], v9 offset:8704
  ds_read_b64_tr_b16 v[140:141], v9 offset:12288
  ds_read_b64_tr_b16 v[142:143], v9 offset:12800
  s_waitcnt lgkmcnt(6)
  ds_read_b64_tr_b16 v[144:145], v9 offset:16384
  ds_read_b64_tr_b16 v[146:147], v9 offset:16896
  ds_read_b64_tr_b16 v[148:149], v9 offset:20480
  ds_read_b64_tr_b16 v[150:151], v9 offset:20992
  ds_read_b64_tr_b16 v[152:153], v9 offset:24576
  ds_read_b64_tr_b16 v[154:155], v9 offset:25088
  ds_read_b64_tr_b16 v[156:157], v9 offset:28672
  ds_read_b64_tr_b16 v[158:159], v9 offset:29184
  s_waitcnt lgkmcnt(6)
  s_cmp_eq_u32 s16, 3
  s_cbranch_scc1 bj_np1
  s_add_u32 m0, s49, 16384
  s_nop 0
  buffer_load_dwordx4 v20, s[60:63], s33 offen offset:0 lds
  buffer_load_dwordx4 v21, s[60:63], s33 offen offset:1024 lds
  buffer_load_dwordx4 v22, s[60:63], s33 offen offset:2048 lds
  buffer_load_dwordx4 v23, s[60:63], s33 offen offset:3072 lds
bj_np1:
  v_xor_b32 v9, 32, v7
  ds_read_b64_tr_b16 v[160:161], v9 offset:0
  ds_read_b64_tr_b16 v[162:163], v9 offset:512
  ds_read_b64_tr_b16 v[164:165], v9 offset:4096
  ds_read_b64_tr_b16 v[166:167], v9 offset:4608
  ds_read_b64_tr_b16 v[168:169], v9 offset:8192
  ds_read_b64_tr_b16 v[170:171], v9 offset:8704
  ds_read_b64_tr_b16 v[172:173], v9 offset:12288
  ds_read_b64_tr_b16 v[174:175], v9 offset:12800
  s_waitcnt lgkmcnt(6)
  ds_read_b64_tr_b16 v[176:177], v9 offset:16384
  ds_read_b64_tr_b16 v[178:179], v9 offset:16896
  ds_read_b64_tr_b16 v[180:181], v9 offset:20480
  ds_read_b64_tr_b16 v[182:183], v9 offset:20992
  ds_read_b64_tr_b16 v[184:185], v9 offset:24576
  ds_read_b64_tr_b16 v[186:187], v9 offset:25088
  ds_read_b64_tr_b16 v[188:189], v9 offset:28672
  ds_read_b64_tr_b16 v[190:191], v9 offset:29184
  s_waitcnt lgkmcnt(6)
  s_cmp_eq_u32 s16, 3
  s_cbranch_scc1 bj_np2
  s_add_u32 m0, s50, 16384
  s_nop 0
  buffer_load_dwordx4 v24, s[60:63], s33 offen offset:0 lds
  buffer_load_dwordx4 v25, s[60:63], s33 offen offset:1024 lds
  buffer_load_dwordx4 v26, s[60:63], s33 offen offset:2048 lds
  buffer_load_dwordx4 v27, s[60:63], s33 offen offset:3072 lds
bj_np2:
  v_xor_b32 v9, 64, v7
  ds_read_b64_tr_b16 v[192:193], v9 offset:0
  ds_read_b64_tr_b16 v[194:195], v9 offset:512
  ds_read_b64_tr_b16 v[196:197], v9 offset:4096
  ds_read_b64_tr_b16 v[198:199], v9 offset:4608
  ds_read_b64_tr_b16 v[200:201], v9 offset:8192
  ds_read_b64_tr_b16 v[202:203], v9 offset:8704
  ds_read_b64_tr_b16 v[204:205], v9 offset:12288
  ds_read_b64_tr_b16 v[206:207], v9 offset:12800
  s_waitcnt lgkmcnt(6)
  ds_read_b64_tr_b16 v[208:209], v9 offset:16384
  ds_read_b64_tr_b16 v[210:211], v9 offset:16896
  ds_read_b64_tr_b16 v[212:213], v9 offset:20480
  ds_read_b64_tr_b16 v[214:215], v9 offset:20992
  ds_read_b64_tr_b16 v[216:217], v9 offset:24576
  ds_read_b64_tr_b16 v[218:219], v9 offset:25088
  ds_read_b64_tr_b16 v[220:221], v9 offset:28672
  ds_read_b64_tr_b16 v[222:223], v9 offset:29184
  s_waitcnt lgkmcnt(6)
  s_cmp_eq_u32 s16, 3
  s_cbranch_scc1 bj_np3
  s_add_u32 m0, s51, 16384
  s_nop 0
  buffer_load_dwordx4 v28, s[60:63], s33 offen offset:0 lds
  buffer_load_dwordx4 v29, s[60:63], s33 offen offset:1024 lds
  buffer_load_dwordx4 v30, s[60:63], s33 offen offset:2048 lds
  buffer_load_dwordx4 v31, s[60:63], s33 offen offset:3072 lds
bj_np3:
  v_xor_b32 v9, 96, v7
  ds_read_b64_tr_b16 v[224:225], v9 offset:0
  ds_read_b64_tr_b16 v[226:227], v9 offset:512
  ds_read_b64_tr_b16 v[228:229], v9 offset:4096
  ds_read_b64_tr_b16 v[230:231], v9 offset:4608
  ds_read_b64_tr_b16 v[232:233], v9 offset:8192
  ds_read_b64_tr_b16 v[234:235], v9 offset:8704
  ds_read_b64_tr_b16 v[236:237], v9 offset:12288
  ds_read_b64_tr_b16 v[238:239], v9 offset:12800
  s_waitcnt lgkmcnt(6)
  ds_read_b64_tr_b16 v[240:241], v9 offset:16384
  ds_read_b64_tr_b16 v[242:243], v9 offset:16896
  ds_read_b64_tr_b16 v[244:245], v9 offset:20480
  ds_read_b64_tr_b16 v[246:247], v9 offset:20992
  ds_read_b64_tr_b16 v[248:249], v9 offset:24576
  ds_read_b64_tr_b16 v[250:251], v9 offset:25088
  ds_read_b64_tr_b16 v[252:253], v9 offset:28672
  ds_read_b64_tr_b16 v[254:255], v9 offset:29184
  s_waitcnt lgkmcnt(6)
  s_mov_b32 s52, s36
  s_and_b32 s53, s37, 0xffff
  s_mov_b32 s54, 1835008
  s_mov_b32 s55, 0x20000
  s_lshl_b32 s20, s18, 8
  v_add_u32 v95, s20, v0
  s_mov_b32 s21, 9586981
  v_mul_hi_u32 v6, v95, s21
  v_mul_u32_u24 v7, 448, v6
  v_sub_u32 v7, v95, v7
  v_lshrrev_b32 v8, 4, v7
  v_and_b32 v7, 15, v7
  v_lshl_add_u32 v9, v6, 4, v7
  v_mul_u32_u24 v9, 896, v9
  v_lshl_add_u32 v9, v8, 5, v9
  buffer_load_dwordx4 v[84:87], v9, s[52:55], 0 offen
  buffer_load_dwordx4 v[88:91], v9, s[52:55], 0 offen offset:16
  v_mul_u32_u24 v6, 14336, v6
  v_lshl_add_u32 v6, v7, 4, v6
  v_lshl_add_u32 v92, v8, 9, v6
  v_lshrrev_b32 v7, 2, v8
  v_lshl_add_u32 v6, v7, 11, v6
  v_and_b32 v7, 3, v8
  v_lshl_add_u32 v93, v7, 8, v6
  s_mov_b32 s72, s38
  s_and_b32 s73, s39, 0xffff
  s_mov_b32 s74, 7168
  s_mov_b32 s75, 0x20000
  v_min_u32 v6, 223, v0
  v_lshrrev_b32 v7, 3, v6
  v_and_b32 v6, 7, v6
  v_mul_u32_u24 v9, 896, v6
  v_lshl_add_u32 v9, v7, 5, v9
  buffer_load_dwordx4 v[36:39], v9, s[72:75], 0 offen
  buffer_load_dwordx4 v[40:43], v9, s[72:75], 0 offen offset:16
  v_lshlrev_b32 v7, 8, v7
  v_lshl_add_u32 v94, v6, 4, v7
  s_lshl_b32 s26, s17, 9
  s_waitcnt vmcnt(20) lgkmcnt(0)
  s_cmp_lg_u32 s16, 3
  s_cbranch_scc1 w3_20
  s_waitcnt vmcnt(4)
w3_20:
  ds_read_b128 v[52:55], v32 offset:0
  ds_read_b128 v[56:59], v33 offset:0
  ds_read_b128 v[60:63], v34 offset:0
  ds_read_b128 v[64:67], v35 offset:0
  s_waitcnt lgkmcnt(3)
  v_mfma_f32_16x16x32_bf16 v[96:99], v[52:55], v[128:131], 0
  v_mfma_f32_16x16x32_bf16 v[100:103], v[52:55], v[160:163], 0
  v_mfma_f32_16x16x32_bf16 v[104:107], v[52:55], v[192:195], 0
  v_mfma_f32_16x16x32_bf16 v[108:111], v[52:55], v[224:227], 0
  ds_read_b128 v[52:55], v32 offset:256
  s_waitcnt lgkmcnt(3)
  v_mfma_f32_16x16x32_bf16 v[96:99], v[56:59], v[132:135], v[96:99]
  v_mfma_f32_16x16x32_bf16 v[100:103], v[56:59], v[164:167], v[100:103]
  v_mfma_f32_16x16x32_bf16 v[104:107], v[56:59], v[196:199], v[104:107]
  v_mfma_f32_16x16x32_bf16 v[108:111], v[56:59], v[228:231], v[108:111]
  ds_read_b128 v[56:59], v33 offset:256
  s_waitcnt lgkmcnt(3)
  v_mfma_f32_16x16x32_bf16 v[96:99], v[60:63], v[136:139], v[96:99]
  v_mfma_f32_16x16x32_bf16 v[100:103], v[60:63], v[168:171], v[100:103]
  v_mfma_f32_16x16x32_bf16 v[104:107], v[60:63], v[200:203], v[104:107]
  v_mfma_f32_16x16x32_bf16 v[108:111], v[60:63], v[232:235], v[108:111]
  ds_read_b128 v[60:63], v34 offset:256
  s_waitcnt lgkmcnt(3)
  v_mfma_f32_16x16x32_bf16 v[96:99], v[64:67], v[140:143], v[96:99]
  v_mfma_f32_16x16x32_bf16 v[100:103], v[64:67], v[172:175], v[100:103]
  v_mfma_f32_16x16x32_bf16 v[104:107], v[64:67], v[204:207], v[104:107]
  v_mfma_f32_16x16x32_bf16 v[108:111], v[64:67], v[236:239], v[108:111]
  ds_read_b128 v[64:67], v35 offset:256
  s_waitcnt lgkmcnt(3)
  v_mfma_f32_16x16x32_bf16 v[96:99], v[52:55], v[144:147], v[96:99]
  v_mfma_f32_16x16x32_bf16 v[100:103], v[52:55], v[176:179], v[100:103]
  v_mfma_f32_16x16x32_bf16 v[104:107], v[52:55], v[208:211], v[104:107]
  v_mfma_f32_16x16x32_bf16 v[108:111], v[52:55], v[240:243], v[108:111]
  ds_read_b128 v[52:55], v32 offset:2048
  s_waitcnt lgkmcnt(3)
  v_mfma_f32_16x16x32_bf16 v[96:99], v[56:59], v[148:151], v[96:99]
  v_mfma_f32_16x16x32_bf16 v[100:103], v[56:59], v[180:183], v[100:103]
  v_mfma_f32_16x16x32_bf16 v[104:107], v[56:59], v[212:215], v[104:107]
  v_mfma_f32_16x16x32_bf16 v[108:111], v[56:59], v[244:247], v[108:111]
  ds_read_b128 v[56:59], v33 offset:2048
  s_waitcnt lgkmcnt(3)
  v_mfma_f32_16x16x32_bf16 v[96:99], v[60:63], v[152:155], v[96:99]
  v_mfma_f32_16x16x32_bf16 v[100:103], v[60:63], v[184:187], v[100:103]
  v_mfma_f32_16x16x32_bf16 v[104:107], v[60:63], v[216:219], v[104:107]
  v_mfma_f32_16x16x32_bf16 v[108:111], v[60:63], v[248:251], v[108:111]
  ds_read_b128 v[60:63], v34 offset:2048
  s_waitcnt lgkmcnt(3)
  v_mfma_f32_16x16x32_bf16 v[96:99], v[64:67], v[156:159], v[96:99]
  v_mfma_f32_16x16x32_bf16 v[100:103], v[64:67], v[188:191], v[100:103]
  v_mfma_f32_16x16x32_bf16 v[104:107], v[64:67], v[220:223], v[104:107]
  v_mfma_f32_16x16x32_bf16 v[108:111], v[64:67], v[252:255], v[108:111]
  ds_read_b128 v[64:67], v35 offset:2048
  s_waitcnt lgkmcnt(3)
  v_mfma_f32_16x16x32_bf16 v[112:115], v[52:55], v[128:131], 0
  v_mfma_f32_16x16x32_bf16 v[116:119], v[52:55], v[160:163], 0
  v_mfma_f32_16x16x32_bf16 v[120:123], v[52:55], v[192:195], 0
  v_mfma_f32_16x16x32_bf16 v[124:127], v[52:55], v[224:227], 0
  ds_read_b128 v[52:55], v32 offset:2304
  s_waitcnt lgkmcnt(3)
  v_mfma_f32_16x16x32_bf16 v[112:115], v[56:59], v[132:135], v[112:115]
  v_mfma_f32_16x16x32_bf16 v[116:119], v[56:59], v[164:167], v[116:119]
  v_mfma_f32_16x16x32_bf16 v[120:123], v[56:59], v[196:199], v[120:123]
  v_mfma_f32_16x16x32_bf16 v[124:127], v[56:59], v[228:231], v[124:127]
  ds_read_b128 v[56:59], v33 offset:2304
  s_waitcnt lgkmcnt(3)
  v_mfma_f32_16x16x32_bf16 v[112:115], v[60:63], v[136:139], v[112:115]
  v_mfma_f32_16x16x32_bf16 v[116:119], v[60:63], v[168:171], v[116:119]
  v_mfma_f32_16x16x32_bf16 v[120:123], v[60:63], v[200:203], v[120:123]
  v_mfma_f32_16x16x32_bf16 v[124:127], v[60:63], v[232:235], v[124:127]
  ds_read_b128 v[60:63], v34 offset:2304
  s_waitcnt lgkmcnt(3)
  v_mfma_f32_16x16x32_bf16 v[112:115], v[64:67], v[140:143], v[112:115]
  v_mfma_f32_16x16x32_bf16 v[116:119], v[64:67], v[172:175], v[116:119]
  v_mfma_f32_16x16x32_bf16 v[120:123], v[64:67], v[204:207], v[120:123]
  v_mfma_f32_16x16x32_bf16 v[124:127], v[64:67], v[236:239], v[124:127]
  ds_read_b128 v[64:67], v35 offset:2304
  s_waitcnt lgkmcnt(3)
  v_mfma_f32_16x16x32_bf16 v[112:115], v[52:55], v[144:147], v[112:115]
  v_mfma_f32_16x16x32_bf16 v[116:119], v[52:55], v[176:179], v[116:119]
  v_mfma_f32_16x16x32_bf16 v[120:123], v[52:55], v[208:211], v[120:123]
  v_mfma_f32_16x16x32_bf16 v[124:127], v[52:55], v[240:243], v[124:127]
  s_waitcnt lgkmcnt(2)
  v_mfma_f32_16x16x32_bf16 v[112:115], v[56:59], v[148:151], v[112:115]
  v_mfma_f32_16x16x32_bf16 v[116:119], v[56:59], v[180:183], v[116:119]
  v_mfma_f32_16x16x32_bf16 v[120:123], v[56:59], v[212:215], v[120:123]
  v_mfma_f32_16x16x32_bf16 v[124:127], v[56:59], v[244:247], v[124:127]
  s_waitcnt lgkmcnt(1)
  v_mfma_f32_16x16x32_bf16 v[112:115], v[60:63], v[152:155], v[112:115]
  v_mfma_f32_16x16x32_bf16 v[116:119], v[60:63], v[184:187], v[116:119]
  v_mfma_f32_16x16x32_bf16 v[120:123], v[60:63], v[216:219], v[120:123]
  v_mfma_f32_16x16x32_bf16 v[124:127], v[60:63], v[248:251], v[124:127]
  s_waitcnt lgkmcnt(0)
  v_mfma_f32_16x16x32_bf16 v[112:115], v[64:67], v[156:159], v[112:115]
  v_mfma_f32_16x16x32_bf16 v[116:119], v[64:67], v[188:191], v[116:119]
  v_mfma_f32_16x16x32_bf16 v[120:123], v[64:67], v[220:223], v[120:123]
  v_mfma_f32_16x16x32_bf16 v[124:127], v[64:67], v[252:255], v[124:127]
  s_lshl_b32 s30, s28, 10
  v_cvt_pk_bf16_f32 v68, v96, v97
  v_cvt_pk_bf16_f32 v69, v98, v99
  v_cvt_pk_bf16_f32 v70, v112, v113
  v_cvt_pk_bf16_f32 v71, v114, v115
  buffer_store_dwordx4 v[68:71], v12, s[8:11], s30 offen sc1
  v_cvt_pk_bf16_f32 v72, v100, v101
  v_cvt_pk_bf16_f32 v73, v102, v103
  v_cvt_pk_bf16_f32 v74, v116, v117
  v_cvt_pk_bf16_f32 v75, v118, v119
  buffer_store_dwordx4 v[72:75], v13, s[8:11], s30 offen sc1
  v_cvt_pk_bf16_f32 v76, v104, v105
  v_cvt_pk_bf16_f32 v77, v106, v107
  v_cvt_pk_bf16_f32 v78, v120, v121
  v_cvt_pk_bf16_f32 v79, v122, v123
  buffer_store_dwordx4 v[76:79], v14, s[8:11], s30 offen sc1
  v_cvt_pk_bf16_f32 v80, v108, v109
  v_cvt_pk_bf16_f32 v81, v110, v111
  v_cvt_pk_bf16_f32 v82, v124, v125
  v_cvt_pk_bf16_f32 v83, v126, v127
  buffer_store_dwordx4 v[80:83], v15, s[8:11], s30 offen sc1
  s_cmp_eq_u32 s16, 3
  s_cbranch_scc1 bj_w3
  s_waitcnt vmcnt(8)
  ds_read_b128 v[52:55], v32 offset:16384
  ds_read_b128 v[56:59], v33 offset:16384
  ds_read_b128 v[60:63], v34 offset:16384
  ds_read_b128 v[64:67], v35 offset:16384
  s_waitcnt lgkmcnt(3)
  v_mfma_f32_16x16x32_bf16 v[96:99], v[52:55], v[128:131], 0
  v_mfma_f32_16x16x32_bf16 v[100:103], v[52:55], v[160:163], 0
  v_mfma_f32_16x16x32_bf16 v[104:107], v[52:55], v[192:195], 0
  v_mfma_f32_16x16x32_bf16 v[108:111], v[52:55], v[224:227], 0
  ds_read_b128 v[52:55], v32 offset:16640
  s_waitcnt lgkmcnt(3)
  v_mfma_f32_16x16x32_bf16 v[96:99], v[56:59], v[132:135], v[96:99]
  v_mfma_f32_16x16x32_bf16 v[100:103], v[56:59], v[164:167], v[100:103]
  v_mfma_f32_16x16x32_bf16 v[104:107], v[56:59], v[196:199], v[104:107]
  v_mfma_f32_16x16x32_bf16 v[108:111], v[56:59], v[228:231], v[108:111]
  ds_read_b128 v[56:59], v33 offset:16640
  s_waitcnt lgkmcnt(3)
  v_mfma_f32_16x16x32_bf16 v[96:99], v[60:63], v[136:139], v[96:99]
  v_mfma_f32_16x16x32_bf16 v[100:103], v[60:63], v[168:171], v[100:103]
  v_mfma_f32_16x16x32_bf16 v[104:107], v[60:63], v[200:203], v[104:107]
  v_mfma_f32_16x16x32_bf16 v[108:111], v[60:63], v[232:235], v[108:111]
  ds_read_b128 v[60:63], v34 offset:16640
  s_waitcnt lgkmcnt(3)
  v_mfma_f32_16x16x32_bf16 v[96:99], v[64:67], v[140:143], v[96:99]
  v_mfma_f32_16x16x32_bf16 v[100:103], v[64:67], v[172:175], v[100:103]
  v_mfma_f32_16x16x32_bf16 v[104:107], v[64:67], v[204:207], v[104:107]
  v_mfma_f32_16x16x32_bf16 v[108:111], v[64:67], v[236:239], v[108:111]
  ds_read_b128 v[64:67], v35 offset:16640
  s_waitcnt lgkmcnt(3)
  v_mfma_f32_16x16x32_bf16 v[96:99], v[52:55], v[144:147], v[96:99]
  v_mfma_f32_16x16x32_bf16 v[100:103], v[52:55], v[176:179], v[100:103]
  v_mfma_f32_16x16x32_bf16 v[104:107], v[52:55], v[208:211], v[104:107]
  v_mfma_f32_16x16x32_bf16 v[108:111], v[52:55], v[240:243], v[108:111]
  ds_read_b128 v[52:55], v32 offset:18432
  s_waitcnt lgkmcnt(3)
  v_mfma_f32_16x16x32_bf16 v[96:99], v[56:59], v[148:151], v[96:99]
  v_mfma_f32_16x16x32_bf16 v[100:103], v[56:59], v[180:183], v[100:103]
  v_mfma_f32_16x16x32_bf16 v[104:107], v[56:59], v[212:215], v[104:107]
  v_mfma_f32_16x16x32_bf16 v[108:111], v[56:59], v[244:247], v[108:111]
  ds_read_b128 v[56:59], v33 offset:18432
  s_waitcnt lgkmcnt(3)
  v_mfma_f32_16x16x32_bf16 v[96:99], v[60:63], v[152:155], v[96:99]
  v_mfma_f32_16x16x32_bf16 v[100:103], v[60:63], v[184:187], v[100:103]
  v_mfma_f32_16x16x32_bf16 v[104:107], v[60:63], v[216:219], v[104:107]
  v_mfma_f32_16x16x32_bf16 v[108:111], v[60:63], v[248:251], v[108:111]
  ds_read_b128 v[60:63], v34 offset:18432
  s_waitcnt lgkmcnt(3)
  v_mfma_f32_16x16x32_bf16 v[96:99], v[64:67], v[156:159], v[96:99]
  v_mfma_f32_16x16x32_bf16 v[100:103], v[64:67], v[188:191], v[100:103]
  v_mfma_f32_16x16x32_bf16 v[104:107], v[64:67], v[220:223], v[104:107]
  v_mfma_f32_16x16x32_bf16 v[108:111], v[64:67], v[252:255], v[108:111]
  ds_read_b128 v[64:67], v35 offset:18432
  s_waitcnt lgkmcnt(3)
  v_mfma_f32_16x16x32_bf16 v[112:115], v[52:55], v[128:131], 0
  v_mfma_f32_16x16x32_bf16 v[116:119], v[52:55], v[160:163], 0
  v_mfma_f32_16x16x32_bf16 v[120:123], v[52:55], v[192:195], 0
  v_mfma_f32_16x16x32_bf16 v[124:127], v[52:55], v[224:227], 0
  ds_read_b128 v[52:55], v32 offset:18688
  s_waitcnt lgkmcnt(3)
  v_mfma_f32_16x16x32_bf16 v[112:115], v[56:59], v[132:135], v[112:115]
  v_mfma_f32_16x16x32_bf16 v[116:119], v[56:59], v[164:167], v[116:119]
  v_mfma_f32_16x16x32_bf16 v[120:123], v[56:59], v[196:199], v[120:123]
  v_mfma_f32_16x16x32_bf16 v[124:127], v[56:59], v[228:231], v[124:127]
  ds_read_b128 v[56:59], v33 offset:18688
  s_waitcnt lgkmcnt(3)
  v_mfma_f32_16x16x32_bf16 v[112:115], v[60:63], v[136:139], v[112:115]
  v_mfma_f32_16x16x32_bf16 v[116:119], v[60:63], v[168:171], v[116:119]
  v_mfma_f32_16x16x32_bf16 v[120:123], v[60:63], v[200:203], v[120:123]
  v_mfma_f32_16x16x32_bf16 v[124:127], v[60:63], v[232:235], v[124:127]
  ds_read_b128 v[60:63], v34 offset:18688
  s_waitcnt lgkmcnt(3)
  v_mfma_f32_16x16x32_bf16 v[112:115], v[64:67], v[140:143], v[112:115]
  v_mfma_f32_16x16x32_bf16 v[116:119], v[64:67], v[172:175], v[116:119]
  v_mfma_f32_16x16x32_bf16 v[120:123], v[64:67], v[204:207], v[120:123]
  v_mfma_f32_16x16x32_bf16 v[124:127], v[64:67], v[236:239], v[124:127]
  ds_read_b128 v[64:67], v35 offset:18688
  s_waitcnt lgkmcnt(3)
  v_mfma_f32_16x16x32_bf16 v[112:115], v[52:55], v[144:147], v[112:115]
  v_mfma_f32_16x16x32_bf16 v[116:119], v[52:55], v[176:179], v[116:119]
  v_mfma_f32_16x16x32_bf16 v[120:123], v[52:55], v[208:211], v[120:123]
  v_mfma_f32_16x16x32_bf16 v[124:127], v[52:55], v[240:243], v[124:127]
  s_waitcnt lgkmcnt(2)
  v_mfma_f32_16x16x32_bf16 v[112:115], v[56:59], v[148:151], v[112:115]
  v_mfma_f32_16x16x32_bf16 v[116:119], v[56:59], v[180:183], v[116:119]
  v_mfma_f32_16x16x32_bf16 v[120:123], v[56:59], v[212:215], v[120:123]
  v_mfma_f32_16x16x32_bf16 v[124:127], v[56:59], v[244:247], v[124:127]
  s_waitcnt lgkmcnt(1)
  v_mfma_f32_16x16x32_bf16 v[112:115], v[60:63], v[152:155], v[112:115]
  v_mfma_f32_16x16x32_bf16 v[116:119], v[60:63], v[184:187], v[116:119]
  v_mfma_f32_16x16x32_bf16 v[120:123], v[60:63], v[216:219], v[120:123]
  v_mfma_f32_16x16x32_bf16 v[124:127], v[60:63], v[248:251], v[124:127]
  s_waitcnt lgkmcnt(0)
  v_mfma_f32_16x16x32_bf16 v[112:115], v[64:67], v[156:159], v[112:115]
  v_mfma_f32_16x16x32_bf16 v[116:119], v[64:67], v[188:191], v[116:119]
  v_mfma_f32_16x16x32_bf16 v[120:123], v[64:67], v[220:223], v[120:123]
  v_mfma_f32_16x16x32_bf16 v[124:127], v[64:67], v[252:255], v[124:127]
  s_lshl_b32 s30, s29, 10
  v_cvt_pk_bf16_f32 v68, v96, v97
  v_cvt_pk_bf16_f32 v69, v98, v99
  v_cvt_pk_bf16_f32 v70, v112, v113
  v_cvt_pk_bf16_f32 v71, v114, v115
  buffer_store_dwordx4 v[68:71], v12, s[8:11], s30 offen sc1
  v_cvt_pk_bf16_f32 v72, v100, v101
  v_cvt_pk_bf16_f32 v73, v102, v103
  v_cvt_pk_bf16_f32 v74, v116, v117
  v_cvt_pk_bf16_f32 v75, v118, v119
  buffer_store_dwordx4 v[72:75], v13, s[8:11], s30 offen sc1
  v_cvt_pk_bf16_f32 v76, v104, v105
  v_cvt_pk_bf16_f32 v77, v106, v107
  v_cvt_pk_bf16_f32 v78, v120, v121
  v_cvt_pk_bf16_f32 v79, v122, v123
  buffer_store_dwordx4 v[76:79], v14, s[8:11], s30 offen sc1
  v_cvt_pk_bf16_f32 v80, v108, v109
  v_cvt_pk_bf16_f32 v81, v110, v111
  v_cvt_pk_bf16_f32 v82, v124, v125
  v_cvt_pk_bf16_f32 v83, v126, v127
  buffer_store_dwordx4 v[80:83], v15, s[8:11], s30 offen sc1
bj_w3:
  s_lshl_b32 s77, s19, 8
  s_lshl_b32 s21, s17, 4
  s_add_u32 s77, s77, s21
  s_cmp_lg_u32 s31, 0
  s_cselect_b32 s21, 8, 0
  s_add_u32 s77, s77, s21
  s_add_u32 s77, s77, 88600576
  s_add_u32 s78, s77, 2048
  s_cmp_lg_u32 s66, 0
  s_cbranch_scc1 bj_cf
  s_cmp_lg_u32 s16, 0
  s_cbranch_scc1 w0_21
  s_waitcnt vmcnt(8)
  v_readfirstlane_b32 s70, v46
  s_cmp_lg_u32 s70, 0
  s_cbranch_scc1 bj_nz
  v_mov_b32 v45, 128
  v_mov_b32 v46, s88
  v_mov_b32 v47, s89
  v_mov_b32 v48, 0
  v_mov_b32 v49, 0
  s_mov_b64 exec, 1
  buffer_atomic_cmpswap_x2 v[46:49], v45, s[12:15], 0 offen sc0
  s_mov_b64 exec, -1
  s_waitcnt vmcnt(0)
  v_readfirstlane_b32 s70, v46
  s_cmp_lg_u32 s70, 0
  s_cbranch_scc1 bj_nz
  v_mov_b32 v46, s88
  v_mov_b32 v47, s89
bj_nz:
w0_21:
  v_mov_b32 v45, 160000
  s_add_u32 s101, s101, 1
  s_barrier
  s_mov_b64 exec, 1
  s_cmp_lg_u32 s16, 0
  s_cbranch_scc1 w0_22
  ds_write_b32 v45, v44 offset:0
  ds_write_b32 v45, v46 offset:4
  ds_write_b32 v45, v47 offset:8
  s_waitcnt lgkmcnt(0)
  v_mov_b32 v44, s101
  ds_write_b32 v45, v44 offset:16
  s_waitcnt lgkmcnt(0)
w0_22:
  s_mov_b64 exec, -1
  s_barrier
  ds_read_b32 v44, v45 offset:0
  ds_read_b32 v46, v45 offset:4
  ds_read_b32 v47, v45 offset:8
  ds_read_b32 v45, v45 offset:16
  s_waitcnt lgkmcnt(0)
  v_readfirstlane_b32 s70, v44
  v_readfirstlane_b32 s88, v46
  v_readfirstlane_b32 s89, v47
  v_cmp_ne_u32 vcc, s101, v45
  s_cbranch_vccnz ch_end
  s_mov_b32 s66, 1
  s_bitcmp1_b32 s70, s3
  s_cbranch_scc1 m_reclaim
bj_cf:
  s_barrier
  s_mov_b32 s56, s40
  s_and_b32 s57, s41, 0xffff
  s_mov_b32 s58, 3670016
  s_mov_b32 s59, 0x20000
  s_mov_b32 s60, s42
  s_and_b32 s61, s43, 0xffff
  s_mov_b32 s62, 3670016
  s_mov_b32 s63, 0x20000
  s_add_u32 s28, s31, s19
  v_lshrrev_b32 v5, 5, v1
  v_and_b32 v6, 31, v1
  v_xor_b32 v6, v6, v5
  v_lshlrev_b32 v6, 4, v6
  v_lshl_add_u32 v6, v5, 13, v6
  s_lshl_b32 s20, s16, 6
  v_xor_b32 v7, s20, v6
  s_lshl_b32 s22, s28, 18
  s_lshl_b32 s21, s16, 16
  s_add_u32 s22, s22, s21
  s_add_u32 s22, s22, s26
  s_lshl_b32 m0, s16, 12
  v_xor_b32 v8, 0, v7
  buffer_load_dwordx4 v8, s[56:59], s22 offen offset:0 lds
  v_xor_b32 v8, 32, v7
  v_add_u32 v8, 15360, v8
  buffer_load_dwordx4 v8, s[56:59], s22 offen offset:1024 lds
  v_xor_b32 v8, 0, v7
  v_add_u32 v8, 30720, v8
  buffer_load_dwordx4 v8, s[56:59], s22 offen offset:2048 lds
  v_xor_b32 v8, 32, v7
  v_add_u32 v8, 46080, v8
  buffer_load_dwordx4 v8, s[56:59], s22 offen offset:3072 lds
  v_xor_b32 v16, 0, v6
  v_xor_b32 v17, 32, v6
  v_add_u32 v17, 31744, v17
  v_xor_b32 v18, 64, v6
  v_add_u32 v18, 129024, v18
  v_xor_b32 v19, 96, v6
  v_add_u32 v19, 160768, v19
  v_xor_b32 v20, 128, v6
  v_add_u32 v20, 262144, v20
  v_xor_b32 v21, 160, v6
  v_add_u32 v21, 293888, v21
  v_xor_b32 v22, 192, v6
  v_add_u32 v22, 391168, v22
  v_xor_b32 v23, 224, v6
  v_add_u32 v23, 422912, v23
  s_lshr_b32 s20, s16, 1
  s_lshl_b32 s20, s20, 16
  s_and_b32 s21, s16, 1
  s_lshl_b32 s21, s21, 14
  s_add_u32 s20, s20, s21
  s_add_u32 s29, s20, s26
  s_mul_i32 s25, s16, 24576
  s_add_u32 s25, s25, 16384
  s_add_u32 s22, s29, 2097152
  s_add_u32 m0, s25, 0
  s_nop 0
  buffer_load_dwordx4 v16, s[60:63], s22 offen offset:0 lds
  buffer_load_dwordx4 v17, s[60:63], s22 offen offset:1024 lds
  buffer_load_dwordx4 v18, s[60:63], s22 offen offset:2048 lds
  buffer_load_dwordx4 v19, s[60:63], s22 offen offset:3072 lds
  s_add_u32 m0, s25, 4096
  s_nop 0
  buffer_load_dwordx4 v20, s[60:63], s22 offen offset:0 lds
  buffer_load_dwordx4 v21, s[60:63], s22 offen offset:1024 lds
  buffer_load_dwordx4 v22, s[60:63], s22 offen offset:2048 lds
  buffer_load_dwordx4 v23, s[60:63], s22 offen offset:3072 lds
  s_waitcnt vmcnt(12)
  s_barrier
  s_cmp_lg_u32 s16, 0
  s_cbranch_scc1 pub_23
  v_mul_u32_u24 v50, 2048, v1
  v_mov_b32 v48, s88
  v_mov_b32 v49, s89
  s_mov_b64 exec, 1
  buffer_store_dwordx2 v[48:49], v50, s[8:11], s77 offen sc1
  s_mov_b64 exec, -1
pub_23:
  s_cmp_ge_u32 s18, 70
  s_cbranch_scc1 bk_nm
  s_mov_b32 s20, 71565312
  buffer_store_dwordx4 v[84:87], v92, s[8:11], s20 offen sc1
  buffer_store_dwordx4 v[88:91], v92, s[8:11], s20 offen offset:256 sc1
  s_cmp_lg_u32 s18, 0
  s_cbranch_scc1 bk_nm
  v_min_u32 v104, -2, v36
  v_min_u32 v108, -2, v37
  v_min_u32 v105, -2, v38
  v_min_u32 v109, -2, v39
  v_min_u32 v106, -2, v40
  v_min_u32 v110, -2, v41
  v_min_u32 v107, -2, v42
  v_min_u32 v111, -2, v43
  s_mov_b32 s20, 88653824
  s_mov_b32 s21, 88080384
  buffer_store_dwordx4 v[104:107], v94, s[8:11], s20 offen sc1
  buffer_store_dwordx4 v[108:111], v94, s[8:11], s20 offen offset:128 sc1
  buffer_store_dwordx4 v[104:107], v94, s[8:11], s21 offen sc1
  buffer_store_dwordx4 v[108:111], v94, s[8:11], s21 offen offset:128 sc1
bk_nm:
  s_mov_b32 s23, 88653824
  v_add_u32 v6, 448, v95
  v_subrev_u32 v7, 1152, v6
  v_mov_b32 v52, -1
  v_mov_b32 v9, 0
  v_cmp_gt_u32 vcc, 128, v7
  s_nop 1
  v_cndmask_b32 v52, v52, v9, vcc
  v_mov_b32 v53, v52
  v_mov_b32 v54, v52
  v_mov_b32 v55, v52
  v_lshlrev_b32 v8, 4, v6
  v_mov_b32 v9, 0x10000000
  v_cmp_lt_u32 vcc, 25599, v6
  s_nop 1
  v_cndmask_b32 v8, v8, v9, vcc
  buffer_store_dwordx4 v[52:55], v8, s[8:11], s23 offen sc1
  s_mov_b32 s23, 87957504
  v_add_u32 v6, 448, v95
  v_cmp_gt_u32 vcc, 7680, v95
  s_nop 1
  v_cndmask_b32 v6, v6, v95, vcc
  v_subrev_u32 v7, 36352, v6
  v_mov_b32 v56, -1
  v_mov_b32 v9, 0
  v_cmp_gt_u32 vcc, 1048576, v7
  s_nop 1
  v_cndmask_b32 v56, v56, v9, vcc
  v_mov_b32 v57, v56
  v_mov_b32 v58, v56
  v_mov_b32 v59, v56
  v_lshlrev_b32 v8, 4, v6
  v_mov_b32 v9, 0x10000000
  v_cmp_lt_u32 vcc, 40191, v6
  s_nop 1
  v_cndmask_b32 v8, v8, v9, vcc
  buffer_store_dwordx4 v[56:59], v8, s[8:11], s23 offen sc1
  s_add_u32 s22, s29, 2621440
  s_add_u32 m0, s25, 8192
  s_nop 0
  buffer_load_dwordx4 v16, s[60:63], s22 offen offset:0 lds
  buffer_load_dwordx4 v17, s[60:63], s22 offen offset:1024 lds
  buffer_load_dwordx4 v18, s[60:63], s22 offen offset:2048 lds
  buffer_load_dwordx4 v19, s[60:63], s22 offen offset:3072 lds
  s_add_u32 m0, s25, 12288
  s_nop 0
  buffer_load_dwordx4 v20, s[60:63], s22 offen offset:0 lds
  buffer_load_dwordx4 v21, s[60:63], s22 offen offset:1024 lds
  buffer_load_dwordx4 v22, s[60:63], s22 offen offset:2048 lds
  buffer_load_dwordx4 v23, s[60:63], s22 offen offset:3072 lds
  s_add_u32 s22, s29, 3145728
  s_add_u32 m0, s25, 16384
  s_nop 0
  buffer_load_dwordx4 v16, s[60:63], s22 offen offset:0 lds
  buffer_load_dwordx4 v17, s[60:63], s22 offen offset:1024 lds
  buffer_load_dwordx4 v18, s[60:63], s22 offen offset:2048 lds
  buffer_load_dwordx4 v19, s[60:63], s22 offen offset:3072 lds
  s_add_u32 m0, s25, 20480
  s_nop 0
  buffer_load_dwordx4 v20, s[60:63], s22 offen offset:0 lds
  buffer_load_dwordx4 v21, s[60:63], s22 offen offset:1024 lds
  buffer_load_dwordx4 v22, s[60:63], s22 offen offset:2048 lds
  buffer_load_dwordx4 v23, s[60:63], s22 offen offset:3072 lds
  v_mov_b32 v250, s68
  s_or_b32 s20, s69, s16
  s_cbranch_scc1 bj_ht
  s_cmp_lg_u32 s16, 0
  s_cbranch_scc1 w0_24
  v_mov_b32 v250, 1
  v_mov_b32 v251, 192
  s_mov_b64 exec, 1
  buffer_atomic_add v250, v251, s[12:15], 0 offen sc0
  s_mov_b64 exec, -1
w0_24:
  s_branch bj_h2
bj_ht:
  buffer_load_dword v251, off, s[8:11], s77
bj_h2:
  v_lshrrev_b32 v7, 2, v4
  v_lshlrev_b32 v7, 3, v7
  v_and_b32 v8, 3, v4
  v_add_u32 v7, v7, v8
  v_xor_b32 v10, v3, v4
  v_lshlrev_b32 v10, 4, v10
  v_lshl_add_u32 v11, v4, 9, v10
  v_add_u32 v11, s25, v11
  v_lshl_add_u32 v10, v7, 9, v10
  v_xor_b32 v32, 0, v10
  v_xor_b32 v36, 0, v11
  v_xor_b32 v33, 64, v10
  v_xor_b32 v37, 64, v11
  v_xor_b32 v34, 128, v10
  v_xor_b32 v38, 128, v11
  v_xor_b32 v35, 192, v10
  v_xor_b32 v39, 192, v11
  s_mul_i32 s30, s17, 401408
  s_mul_i32 s20, s16, 14336
  s_add_u32 s30, s30, s20
  s_lshl_b32 s20, s28, 10
  s_add_u32 s30, s30, s20
  s_mov_b32 s24, 1035512379
  s_lshl_b32 s20, s17, 7
  s_lshl_b32 s28, s28, 3
  s_add_u32 s28, s28, s20
  s_add_u32 s28, s28, 88635392
  s_waitcnt vmcnt(1)
  s_barrier
  s_cmp_lg_u32 s16, 0
  s_cbranch_scc1 w0_25
  v_mul_u32_u24 v50, 2048, v1
  v_mov_b32 v48, s88
  v_mov_b32 v49, s89
  s_mov_b64 exec, 511
  buffer_store_dwordx2 v[48:49], v50, s[8:11], s78 offen sc1
  s_mov_b64 exec, -1
w0_25:
  ds_read_b128 v[128:131], v32 offset:0
  ds_read_b128 v[132:135], v32 offset:2048
  ds_read_b128 v[136:139], v36 offset:0
  ds_read_b128 v[140:143], v36 offset:8192
  ds_read_b128 v[144:147], v36 offset:16384
  ds_read_b128 v[148:151], v33 offset:0
  ds_read_b128 v[152:155], v33 offset:2048
  ds_read_b128 v[156:159], v37 offset:0
  ds_read_b128 v[160:163], v37 offset:8192
  ds_read_b128 v[164:167], v37 offset:16384
  ds_read_b128 v[168:171], v34 offset:0
  ds_read_b128 v[172:175], v34 offset:2048
  ds_read_b128 v[176:179], v38 offset:0
  ds_read_b128 v[180:183], v38 offset:8192
  ds_read_b128 v[184:187], v38 offset:16384
  s_waitcnt lgkmcnt(10)
  v_mfma_f32_16x16x32_bf16 v[96:99], v[128:131], v[136:139], 0
  v_mfma_f32_16x16x32_bf16 v[100:103], v[132:135], v[136:139], 0
  v_mfma_f32_16x16x32_bf16 v[104:107], v[128:131], v[140:143], 0
  v_mfma_f32_16x16x32_bf16 v[108:111], v[132:135], v[140:143], 0
  v_mfma_f32_16x16x32_bf16 v[112:115], v[128:131], v[144:147], 0
  v_mfma_f32_16x16x32_bf16 v[116:119], v[132:135], v[144:147], 0
  ds_read_b128 v[128:131], v35 offset:0
  ds_read_b128 v[132:135], v35 offset:2048
  ds_read_b128 v[136:139], v39 offset:0
  ds_read_b128 v[140:143], v39 offset:8192
  ds_read_b128 v[144:147], v39 offset:16384
  s_waitcnt lgkmcnt(10)
  v_mfma_f32_16x16x32_bf16 v[96:99], v[148:151], v[156:159], v[96:99]
  v_mfma_f32_16x16x32_bf16 v[100:103], v[152:155], v[156:159], v[100:103]
  v_mfma_f32_16x16x32_bf16 v[104:107], v[148:151], v[160:163], v[104:107]
  v_mfma_f32_16x16x32_bf16 v[108:111], v[152:155], v[160:163], v[108:111]
  v_mfma_f32_16x16x32_bf16 v[112:115], v[148:151], v[164:167], v[112:115]
  v_mfma_f32_16x16x32_bf16 v[116:119], v[152:155], v[164:167], v[116:119]
  ds_read_b128 v[148:151], v32 offset:256
  ds_read_b128 v[152:155], v32 offset:2304
  ds_read_b128 v[156:159], v36 offset:256
  ds_read_b128 v[160:163], v36 offset:8448
  ds_read_b128 v[164:167], v36 offset:16640
  s_waitcnt lgkmcnt(10)
  v_mfma_f32_16x16x32_bf16 v[96:99], v[168:171], v[176:179], v[96:99]
  v_mfma_f32_16x16x32_bf16 v[100:103], v[172:175], v[176:179], v[100:103]
  v_mfma_f32_16x16x32_bf16 v[104:107], v[168:171], v[180:183], v[104:107]
  v_mfma_f32_16x16x32_bf16 v[108:111], v[172:175], v[180:183], v[108:111]
  v_mfma_f32_16x16x32_bf16 v[112:115], v[168:171], v[184:187], v[112:115]
  v_mfma_f32_16x16x32_bf16 v[116:119], v[172:175], v[184:187], v[116:119]
  ds_read_b128 v[168:171], v33 offset:256
  ds_read_b128 v[172:175], v33 offset:2304
  ds_read_b128 v[176:179], v37 offset:256
  ds_read_b128 v[180:183], v37 offset:8448
  ds_read_b128 v[184:187], v37 offset:16640
  s_waitcnt lgkmcnt(10)
  v_mfma_f32_16x16x32_bf16 v[96:99], v[128:131], v[136:139], v[96:99]
  v_mfma_f32_16x16x32_bf16 v[100:103], v[132:135], v[136:139], v[100:103]
  v_mfma_f32_16x16x32_bf16 v[104:107], v[128:131], v[140:143], v[104:107]
  v_mfma_f32_16x16x32_bf16 v[108:111], v[132:135], v[140:143], v[108:111]
  v_mfma_f32_16x16x32_bf16 v[112:115], v[128:131], v[144:147], v[112:115]
  v_mfma_f32_16x16x32_bf16 v[116:119], v[132:135], v[144:147], v[116:119]
  ds_read_b128 v[128:131], v34 offset:256
  ds_read_b128 v[132:135], v34 offset:2304
  ds_read_b128 v[136:139], v38 offset:256
  ds_read_b128 v[140:143], v38 offset:8448
  ds_read_b128 v[144:147], v38 offset:16640
  s_waitcnt lgkmcnt(10)
  v_mfma_f32_16x16x32_bf16 v[96:99], v[148:151], v[156:159], v[96:99]
  v_mfma_f32_16x16x32_bf16 v[100:103], v[152:155], v[156:159], v[100:103]
  v_mfma_f32_16x16x32_bf16 v[104:107], v[148:151], v[160:163], v[104:107]
  v_mfma_f32_16x16x32_bf16 v[108:111], v[152:155], v[160:163], v[108:111]
  v_mfma_f32_16x16x32_bf16 v[112:115], v[148:151], v[164:167], v[112:115]
  v_mfma_f32_16x16x32_bf16 v[116:119], v[152:155], v[164:167], v[116:119]
  ds_read_b128 v[148:151], v35 offset:256
  ds_read_b128 v[152:155], v35 offset:2304
  ds_read_b128 v[156:159], v39 offset:256
  ds_read_b128 v[160:163], v39 offset:8448
  ds_read_b128 v[164:167], v39 offset:16640
  s_waitcnt lgkmcnt(10)
  v_mfma_f32_16x16x32_bf16 v[96:99], v[168:171], v[176:179], v[96:99]
  v_mfma_f32_16x16x32_bf16 v[100:103], v[172:175], v[176:179], v[100:103]
  v_mfma_f32_16x16x32_bf16 v[104:107], v[168:171], v[180:183], v[104:107]
  v_mfma_f32_16x16x32_bf16 v[108:111], v[172:175], v[180:183], v[108:111]
  v_mfma_f32_16x16x32_bf16 v[112:115], v[168:171], v[184:187], v[112:115]
  v_mfma_f32_16x16x32_bf16 v[116:119], v[172:175], v[184:187], v[116:119]
  s_waitcnt lgkmcnt(5)
  v_mfma_f32_16x16x32_bf16 v[96:99], v[128:131], v[136:139], v[96:99]
  v_mfma_f32_16x16x32_bf16 v[100:103], v[132:135], v[136:139], v[100:103]
  v_mfma_f32_16x16x32_bf16 v[104:107], v[128:131], v[140:143], v[104:107]
  v_mfma_f32_16x16x32_bf16 v[108:111], v[132:135], v[140:143], v[108:111]
  v_mfma_f32_16x16x32_bf16 v[112:115], v[128:131], v[144:147], v[112:115]
  v_mfma_f32_16x16x32_bf16 v[116:119], v[132:135], v[144:147], v[116:119]
  s_waitcnt lgkmcnt(0)
  v_mfma_f32_16x16x32_bf16 v[96:99], v[148:151], v[156:159], v[96:99]
  v_mfma_f32_16x16x32_bf16 v[100:103], v[152:155], v[156:159], v[100:103]
  v_mfma_f32_16x16x32_bf16 v[104:107], v[148:151], v[160:163], v[104:107]
  v_mfma_f32_16x16x32_bf16 v[108:111], v[152:155], v[160:163], v[108:111]
  v_mfma_f32_16x16x32_bf16 v[112:115], v[148:151], v[164:167], v[112:115]
  v_mfma_f32_16x16x32_bf16 v[116:119], v[152:155], v[164:167], v[116:119]
  v_mul_f32 v96, s24, v96
  v_mul_f32 v97, s24, v97
  v_mul_f32 v98, s24, v98
  v_mul_f32 v99, s24, v99
  v_mul_f32 v100, s24, v100
  v_mul_f32 v101, s24, v101
  v_mul_f32 v102, s24, v102
  v_mul_f32 v103, s24, v103
  v_cvt_pk_bf16_f32 v68, v96, v97
  v_cvt_pk_bf16_f32 v69, v98, v99
  v_cvt_pk_bf16_f32 v70, v100, v101
  v_cvt_pk_bf16_f32 v71, v102, v103
  s_add_u32 s20, s30, 229376
  buffer_store_dwordx4 v[68:71], v2, s[8:11], s20 offen sc1
  v_mul_f32 v104, s24, v104
  v_mul_f32 v105, s24, v105
  v_mul_f32 v106, s24, v106
  v_mul_f32 v107, s24, v107
  v_mul_f32 v108, s24, v108
  v_mul_f32 v109, s24, v109
  v_mul_f32 v110, s24, v110
  v_mul_f32 v111, s24, v111
  v_cvt_pk_bf16_f32 v72, v104, v105
  v_cvt_pk_bf16_f32 v73, v106, v107
  v_cvt_pk_bf16_f32 v74, v108, v109
  v_cvt_pk_bf16_f32 v75, v110, v111
  s_add_u32 s20, s30, 286720
  buffer_store_dwordx4 v[72:75], v2, s[8:11], s20 offen sc1
  v_mul_f32 v112, s24, v112
  v_mul_f32 v113, s24, v113
  v_mul_f32 v114, s24, v114
  v_mul_f32 v115, s24, v115
  v_mul_f32 v116, s24, v116
  v_mul_f32 v117, s24, v117
  v_mul_f32 v118, s24, v118
  v_mul_f32 v119, s24, v119
  v_cvt_pk_bf16_f32 v76, v112, v113
  v_cvt_pk_bf16_f32 v77, v114, v115
  v_cvt_pk_bf16_f32 v78, v116, v117
  v_cvt_pk_bf16_f32 v79, v118, v119
  s_add_u32 s20, s30, 344064
  buffer_store_dwordx4 v[76:79], v2, s[8:11], s20 offen sc1
  s_waitcnt vmcnt(0)
  s_barrier
  s_cmp_lg_u32 s16, 0
  s_cbranch_scc1 pub_26
  v_mul_u32_u24 v26, 2048, v1
  v_mov_b32 v24, s88
  v_mov_b32 v25, s89
  s_mov_b64 exec, 1
  buffer_store_dwordx2 v[24:25], v26, s[8:11], s28 offen sc1
  s_mov_b64 exec, -1
pub_26:
  v_mov_b32 v6, 160000
  s_add_u32 s101, s101, 1
  s_barrier
  s_mov_b64 exec, 1
  s_cmp_lg_u32 s16, 0
  s_cbranch_scc1 w0_27
  ds_write_b32 v6, v250 offset:0
  s_waitcnt lgkmcnt(0)
  v_mov_b32 v250, s101
  ds_write_b32 v6, v250 offset:16
  s_waitcnt lgkmcnt(0)
w0_27:
  s_mov_b64 exec, -1
  s_barrier
  ds_read_b32 v250, v6 offset:0
  ds_read_b32 v6, v6 offset:16
  s_waitcnt lgkmcnt(0)
  v_readfirstlane_b32 s3, v250
  v_cmp_ne_u32 vcc, s101, v6
  s_cbranch_vccnz ch_end
  s_branch wk_have
wk_loop:
  s_waitcnt vmcnt(0) lgkmcnt(0)
  s_cmp_eq_u32 s96, 1
  s_cbranch_scc1 wk_ask
  s_mov_b32 s96, 1
  s_cmp_lg_u32 s16, 0
  s_cbranch_scc1 w0_28
  s_mov_b32 s30, 0
  v_mov_b32 v243, 32
sf_l:
  buffer_load_dword v242, v243, s[12:15], 0 offen sc1
  s_waitcnt vmcnt(0)
  v_readfirstlane_b32 s70, v242
  s_cmp_eq_u32 s70, -1
  s_cbranch_scc1 sf_d
  s_sleep 16
  s_add_u32 s30, s30, 1
  s_cmp_lt_u32 s30, 64
  s_cbranch_scc1 sf_l
  s_mov_b32 s20, 0
  s_mov_b32 s21, 0
  s_mov_b64 exec, 1
sf_c_l:
  s_cmp_lg_u32 s70, -1
  s_cbranch_scc1 sf_c_t
  s_add_u32 s20, s20, 1
  s_cmp_lt_u32 s20, 8
  s_cselect_b32 s20, s20, 0
  s_mov_b32 s70, 0
  s_mov_b32 s3, -1
  s_add_u32 s21, s21, 1
  s_cmp_ge_u32 s21, 1
  s_cbranch_scc1 sf_c_d
sf_c_t:
  s_ff0_i32_b32 s22, s70
  s_lshl_b32 s23, 1, s22
  s_and_b32 s71, s20, 4
  s_mul_i32 s71, s71, 12
  s_lshl_b32 s3, s20, 2
  s_add_u32 s3, s3, s71
  v_mov_b32 v242, s23
  v_mov_b32 v243, 32
  buffer_atomic_or v242, v243, s[12:15], s3 offen sc0
  s_waitcnt vmcnt(0)
  v_readfirstlane_b32 s70, v242
  s_lshl_b32 s3, s20, 5
  s_add_u32 s3, s3, s22
  s_bitcmp1_b32 s70, s22
  s_cbranch_scc1 sf_c_l
sf_c_d:
  s_mov_b64 exec, -1
  v_mov_b32 v242, s3
sf_d:
w0_28:
  v_mov_b32 v243, 160000
  s_add_u32 s101, s101, 1
  s_barrier
  s_mov_b64 exec, 1
  s_cmp_lg_u32 s16, 0
  s_cbranch_scc1 w0_29
  ds_write_b32 v243, v242 offset:0
  s_waitcnt lgkmcnt(0)
  v_mov_b32 v242, s101
  ds_write_b32 v243, v242 offset:16
  s_waitcnt lgkmcnt(0)
w0_29:
  s_mov_b64 exec, -1
  s_barrier
  ds_read_b32 v242, v243 offset:0
  ds_read_b32 v243, v243 offset:16
  s_waitcnt lgkmcnt(0)
  v_readfirstlane_b32 s3, v242
  v_cmp_ne_u32 vcc, s101, v243
  s_cbranch_vccnz ch_end
  s_cmp_eq_u32 s3, -1
  s_cbranch_scc1 wk_ask
  s_load_dwordx8 s[36:43], s[0:1], 56
  s_load_dwordx4 s[44:47], s[0:1], 88
  s_getreg_b32 s67, hwreg(HW_REG_XCC_ID)
  s_and_b32 s67, s67, 7
  s_mov_b32 s66, 1
  s_waitcnt lgkmcnt(0)
  s_branch m_start
wk_ask:
  v_readfirstlane_b32 s22, v250
  s_cmp_ge_u32 s22, 1440
  s_cbranch_scc1 wk_next
  s_cmp_lg_u32 s16, 0
  s_cbranch_scc1 w0_30
  v_mov_b32 v250, 1
  v_mov_b32 v251, 192
  s_mov_b64 exec, 1
  buffer_atomic_add v250, v251, s[12:15], 0 offen sc0
  s_mov_b64 exec, -1
w0_30:
wk_next:
  s_waitcnt vmcnt(0)
  v_mov_b32 v6, 160000
  s_add_u32 s101, s101, 1
  s_barrier
  s_mov_b64 exec, 1
  s_cmp_lg_u32 s16, 0
  s_cbranch_scc1 w0_31
  ds_write_b32 v6, v250 offset:0
  s_waitcnt lgkmcnt(0)
  v_mov_b32 v250, s101
  ds_write_b32 v6, v250 offset:16
  s_waitcnt lgkmcnt(0)
w0_31:
  s_mov_b64 exec, -1
  s_barrier
  ds_read_b32 v250, v6 offset:0
  ds_read_b32 v6, v6 offset:16
  s_waitcnt lgkmcnt(0)
  v_readfirstlane_b32 s3, v250
  v_cmp_ne_u32 vcc, s101, v6
  s_cbranch_vccnz ch_end
wk_have:
  s_cmp_ge_u32 s3, 1440
  s_cbranch_scc1 ch_end
  v_mov_b32 v250, 0
  v_mov_b32 v251, 192
  v_and_b32 v1, 63, v0
  v_lshlrev_b32 v2, 4, v1
  v_lshrrev_b32 v3, 4, v1
  v_and_b32 v4, 15, v1
  s_cmp_lg_u32 s97, 0
  s_cbranch_scc1 wk_go
  s_mov_b32 s68, s3
  s_mov_b32 s69, 1
  s_cmp_lg_u32 s16, 0
  s_cbranch_scc1 w0_32
  s_add_u32 s20, s67, 1
  s_lshl_b32 s22, s20, 11
  s_add_u32 s22, s22, 88602624
  v_add_u32 v24, 1024, v2
  v_min_u32 v24, 1776, v24
  s_mov_b32 s30, 0
wk_af:
  buffer_load_dwordx4 v[28:31], v2, s[8:11], s22 offen sc1
  buffer_load_dwordx4 v[32:35], v24, s[8:11], s22 offen sc1
  s_waitcnt vmcnt(0)
  v_cmp_ne_u64 vcc, s[88:89], v[28:29]
  s_cbranch_vccnz wk_af_no
  v_cmp_ne_u64 vcc, s[88:89], v[30:31]
  s_cbranch_vccnz wk_af_no
  v_cmp_ne_u64 vcc, s[88:89], v[32:33]
  s_cbranch_vccnz wk_af_no
  v_cmp_ne_u64 vcc, s[88:89], v[34:35]
  s_cbranch_vccnz wk_af_no
  s_branch wk_af_ok
wk_af_no:
  s_sleep 4
  s_add_u32 s30, s30, 1
  s_and_b32 s20, s30, 63
  s_cbranch_scc1 wk_ns
  s_mov_b32 s20, 1
  s_mov_b32 s70, 0
  s_mov_b32 s21, 0
  s_mov_b64 exec, 1
wk_st_l:
  s_cmp_lg_u32 s70, -1
  s_cbranch_scc1 wk_st_t
  s_add_u32 s20, s20, 1
  s_cmp_lt_u32 s20, 8
  s_cselect_b32 s20, s20, 1
  s_mov_b32 s70, 0
  s_mov_b32 s3, -1
  s_add_u32 s21, s21, 1
  s_cmp_ge_u32 s21, 7
  s_cbranch_scc1 wk_st_d
wk_st_t:
  s_ff0_i32_b32 s22, s70
  s_lshl_b32 s23, 1, s22
  s_and_b32 s71, s20, 4
  s_mul_i32 s71, s71, 12
  s_lshl_b32 s3, s20, 2
  s_add_u32 s3, s3, s71
  v_mov_b32 v242, s23
  v_mov_b32 v243, 32
  buffer_atomic_or v242, v243, s[12:15], s3 offen sc0
  s_waitcnt vmcnt(0)
  v_readfirstlane_b32 s70, v242
  s_lshl_b32 s3, s20, 5
  s_add_u32 s3, s3, s22
  s_bitcmp1_b32 s70, s22
  s_cbranch_scc1 wk_st_l
wk_st_d:
  s_mov_b64 exec, -1
  v_mov_b32 v242, s3
  s_cmp_lg_u32 s3, -1
  s_cbranch_scc1 wk_pd
  s_add_u32 s20, s67, 1
  s_lshl_b32 s22, s20, 11
  s_add_u32 s22, s22, 88602624
wk_ns:
  s_cmp_lt_u32 s30, 50000
  s_cbranch_scc1 wk_af
  s_branch cA_abort
wk_af_ok:
  v_mov_b32 v242, -1
wk_pd:
w0_32:
  v_mov_b32 v243, 160000
  s_add_u32 s101, s101, 1
  s_barrier
  s_mov_b64 exec, 1
  s_cmp_lg_u32 s16, 0
  s_cbranch_scc1 w0_33
  ds_write_b32 v243, v242 offset:0
  s_waitcnt lgkmcnt(0)
  v_mov_b32 v242, s101
  ds_write_b32 v243, v242 offset:16
  s_waitcnt lgkmcnt(0)
w0_33:
  s_mov_b64 exec, -1
  s_barrier
  ds_read_b32 v242, v243 offset:0
  ds_read_b32 v243, v243 offset:16
  s_waitcnt lgkmcnt(0)
  v_readfirstlane_b32 s3, v242
  v_cmp_ne_u32 vcc, s101, v243
  s_cbranch_vccnz ch_end
  s_cmp_lg_u32 s3, -1
  s_cbranch_scc1 m_bjob
  s_mov_b32 s3, s68
  s_mov_b32 s97, 1
wk_go:
  s_cmp_lt_u32 s3, 368
  s_cbranch_scc1 wk_g2
  s_sub_u32 s20, s3, 432
  s_cmp_lt_u32 s20, 128
  s_cbranch_scc1 wk_g2
  s_cmp_eq_u32 s97, 2
  s_cbranch_scc1 wk_g2
  s_getreg_b32 s20, hwreg(HW_REG_XCC_ID)
  s_and_b32 s20, s20, 7
  s_cmp_lg_u32 s16, 0
  s_cbranch_scc1 w0_34
  s_lshl_b32 s22, s20, 11
  s_add_u32 s22, s22, 88637440
  v_add_u32 v24, 1024, v2
  v_min_u32 v24, 1776, v24
  s_mov_b32 s30, 0
wk_i2:
  buffer_load_dwordx4 v[28:31], v2, s[8:11], s22 offen sc1
  buffer_load_dwordx4 v[32:35], v24, s[8:11], s22 offen sc1
  s_waitcnt vmcnt(0)
  v_cmp_ne_u64 vcc, s[88:89], v[28:29]
  s_cbranch_vccnz wk_i2_no
  v_cmp_ne_u64 vcc, s[88:89], v[30:31]
  s_cbranch_vccnz wk_i2_no
  v_cmp_ne_u64 vcc, s[88:89], v[32:33]
  s_cbranch_vccnz wk_i2_no
  v_cmp_ne_u64 vcc, s[88:89], v[34:35]
  s_cbranch_vccnz wk_i2_no
  s_branch wk_i2_ok
wk_i2_no:
  s_sleep 4
  s_add_u32 s30, s30, 1
  s_cmp_lt_u32 s30, 50000
  s_cbranch_scc1 wk_i2
  s_branch cA_abort
wk_i2_ok:
w0_34:
  v_mov_b32 v242, 0
  v_mov_b32 v243, 160000
  s_add_u32 s101, s101, 1
  s_barrier
  s_mov_b64 exec, 1
  s_cmp_lg_u32 s16, 0
  s_cbranch_scc1 w0_35
  ds_write_b32 v243, v242 offset:0
  s_waitcnt lgkmcnt(0)
  v_mov_b32 v242, s101
  ds_write_b32 v243, v242 offset:16
  s_waitcnt lgkmcnt(0)
w0_35:
  s_mov_b64 exec, -1
  s_barrier
  ds_read_b32 v242, v243 offset:0
  ds_read_b32 v243, v243 offset:16
  s_waitcnt lgkmcnt(0)
  v_readfirstlane_b32 s20, v242
  v_cmp_ne_u32 vcc, s101, v243
  s_cbranch_vccnz ch_end
  s_mov_b32 s97, 2
wk_g2:
  s_cmp_ge_u32 s3, 864
  s_cbranch_scc1 wk_tok
  s_cmp_ge_u32 s3, 752
  s_cbranch_scc1 wk_s4d
  s_cmp_ge_u32 s3, 624
  s_cbranch_scc1 wk_f
  s_cmp_ge_u32 s3, 560
  s_cbranch_scc1 wk_vf
  s_cmp_ge_u32 s3, 432
  s_cbranch_scc1 wk_a
  s_cmp_ge_u32 s3, 368
  s_cbranch_scc1 wk_vh
  s_cmp_ge_u32 s3, 256
  s_cbranch_scc1 wk_v7
  s_cmp_ge_u32 s3, 224
  s_cbranch_scc1 wk_srv
  s_sub_u32 s20, s3, 0
  s_cmp_ge_u32 s20, 112
  s_cselect_b32 s18, 1, 0
  s_cselect_b32 s21, 112, 0
  s_sub_u32 s20, s20, s21
  s_and_b32 s17, s20, 15
  s_add_u32 s17, s17, 16
  s_lshr_b32 s34, s20, 4
  s_lshl_b32 s34, s34, 1
  s_add_u32 s35, s34, 2
  s_cmp_eq_u32 s18, 0
  s_cbranch_scc1 wf_nw
  s_and_b32 s20, s3, 3
  s_lshl_b32 s20, s20, 3
  s_add_u32 s20, s20, 8
  s_cmp_eq_u32 s16, 0
  s_cselect_b32 s20, 0, s20
  s_cmp_ge_u32 s16, 2
  s_cselect_b32 s20, 112, s20
  s_load_dwordx2 s[72:73], s[0:1], s20
  s_lshr_b32 s21, s3, 2
  s_lshl_b32 s21, s21, 12
  s_mov_b32 s74, 229376
  s_lshl_b32 s22, s3, 13
  s_cmp_eq_u32 s16, 0
  s_cselect_b32 s21, s22, s21
  s_cselect_b32 s74, 1835008, s74
  s_lshl_b32 s22, s3, 1
  s_add_u32 s22, s22, s16
  s_sub_u32 s22, s22, 2
  s_lshl_b32 s22, s22, 13
  s_cmp_ge_u32 s16, 2
  s_cselect_b32 s21, s22, s21
  s_cselect_b32 s74, 3670016, s74
  v_lshlrev_b32 v6, 3, v2
  s_cmp_lt_u32 s16, 2
  s_cbranch_scc1 lw_36
  s_lshl_b32 s21, s3, 6
  v_add_u32 v6, s21, v1
  v_mul_u32_u24 v7, 37450, v6
  v_lshrrev_b32 v7, 18, v7
  v_add_u32 v7, 1, v7
  v_mul_u32_u24 v7, 7, v7
  v_add_u32 v6, v6, v7
  v_lshlrev_b32 v6, 7, v6
  s_mov_b32 s21, 0
  s_cmp_eq_u32 s16, 3
  s_cselect_b32 s74, 0, s74
lw_36:
  s_cmp_eq_u32 s16, 1
  s_cselect_b32 exec_hi, 0, -1
  s_waitcnt lgkmcnt(0)
  s_and_b32 s73, s73, 0xffff
  s_mov_b32 s75, 0x20000
  buffer_load_dword v7, v6, s[72:75], s21 offen
  s_mov_b64 exec, -1
  s_sub_u32 s3, s3, 112
  s_and_b32 s20, s3, 3
  s_lshl_b32 s20, s20, 3
  s_add_u32 s20, s20, 8
  s_cmp_eq_u32 s16, 0
  s_cselect_b32 s20, 0, s20
  s_cmp_ge_u32 s16, 2
  s_cselect_b32 s20, 112, s20
  s_load_dwordx2 s[72:73], s[0:1], s20
  s_lshr_b32 s21, s3, 2
  s_lshl_b32 s21, s21, 12
  s_mov_b32 s74, 229376
  s_lshl_b32 s22, s3, 13
  s_cmp_eq_u32 s16, 0
  s_cselect_b32 s21, s22, s21
  s_cselect_b32 s74, 1835008, s74
  s_lshl_b32 s22, s3, 1
  s_add_u32 s22, s22, s16
  s_sub_u32 s22, s22, 2
  s_lshl_b32 s22, s22, 13
  s_cmp_ge_u32 s16, 2
  s_cselect_b32 s21, s22, s21
  s_cselect_b32 s74, 3670016, s74
  v_lshlrev_b32 v6, 3, v2
  s_cmp_lt_u32 s16, 2
  s_cbranch_scc1 lw_37
  s_lshl_b32 s21, s3, 6
  v_add_u32 v6, s21, v1
  v_mul_u32_u24 v7, 37450, v6
  v_lshrrev_b32 v7, 18, v7
  v_add_u32 v7, 1, v7
  v_mul_u32_u24 v7, 7, v7
  v_add_u32 v6, v6, v7
  v_lshlrev_b32 v6, 7, v6
  s_mov_b32 s21, 0
  s_cmp_eq_u32 s16, 3
  s_cselect_b32 s74, 0, s74
lw_37:
  s_cmp_eq_u32 s16, 1
  s_cselect_b32 exec_hi, 0, -1
  s_waitcnt lgkmcnt(0)
  s_and_b32 s73, s73, 0xffff
  s_mov_b32 s75, 0x20000
  buffer_load_dword v7, v6, s[72:75], s21 offen
  s_mov_b64 exec, -1
  s_add_u32 s3, s3, 112
wf_nw:
  s_lshl_b32 s20, s18, 3
  s_lshl_b32 s21, s16, 1
  s_add_u32 s20, s20, s21
  s_mul_i32 s21, s20, 14336
  s_add_u32 s21, s21, 71565312
  s_add_u32 s22, s21, 0
  buffer_load_dwordx4 a[0:3], v2, s[8:11], s22 offen offset:0 sc1
  buffer_load_dwordx4 a[4:7], v2, s[8:11], s22 offen offset:1024 sc1
  buffer_load_dwordx4 a[8:11], v2, s[8:11], s22 offen offset:2048 sc1
  buffer_load_dwordx4 a[12:15], v2, s[8:11], s22 offen offset:3072 sc1
  s_add_u32 s22, s21, 4096
  buffer_load_dwordx4 a[16:19], v2, s[8:11], s22 offen offset:0 sc1
  buffer_load_dwordx4 a[20:23], v2, s[8:11], s22 offen offset:1024 sc1
  buffer_load_dwordx4 a[24:27], v2, s[8:11], s22 offen offset:2048 sc1
  buffer_load_dwordx4 a[28:31], v2, s[8:11], s22 offen offset:3072 sc1
  s_add_u32 s22, s21, 8192
  buffer_load_dwordx4 a[32:35], v2, s[8:11], s22 offen offset:0 sc1
  buffer_load_dwordx4 a[36:39], v2, s[8:11], s22 offen offset:1024 sc1
  buffer_load_dwordx4 a[40:43], v2, s[8:11], s22 offen offset:2048 sc1
  buffer_load_dwordx4 a[44:47], v2, s[8:11], s22 offen offset:3072 sc1
  s_add_u32 s22, s21, 12288
  buffer_load_dwordx4 a[48:51], v2, s[8:11], s22 offen offset:0 sc1
  buffer_load_dwordx4 a[52:55], v2, s[8:11], s22 offen offset:1024 sc1
  buffer_load_dwordx4 a[56:59], v2, s[8:11], s22 offen offset:2048 sc1
  buffer_load_dwordx4 a[60:63], v2, s[8:11], s22 offen offset:3072 sc1
  s_add_u32 s22, s21, 16384
  buffer_load_dwordx4 a[64:67], v2, s[8:11], s22 offen offset:0 sc1
  buffer_load_dwordx4 a[68:71], v2, s[8:11], s22 offen offset:1024 sc1
  buffer_load_dwordx4 a[72:75], v2, s[8:11], s22 offen offset:2048 sc1
  buffer_load_dwordx4 a[76:79], v2, s[8:11], s22 offen offset:3072 sc1
  s_add_u32 s22, s21, 20480
  buffer_load_dwordx4 a[80:83], v2, s[8:11], s22 offen offset:0 sc1
  buffer_load_dwordx4 a[84:87], v2, s[8:11], s22 offen offset:1024 sc1
  buffer_load_dwordx4 a[88:91], v2, s[8:11], s22 offen offset:2048 sc1
  buffer_load_dwordx4 a[92:95], v2, s[8:11], s22 offen offset:3072 sc1
  s_add_u32 s22, s21, 24576
  buffer_load_dwordx4 a[96:99], v2, s[8:11], s22 offen offset:0 sc1
  buffer_load_dwordx4 a[100:103], v2, s[8:11], s22 offen offset:1024 sc1
  buffer_load_dwordx4 a[104:107], v2, s[8:11], s22 offen offset:2048 sc1
  buffer_load_dwordx4 a[108:111], v2, s[8:11], s22 offen offset:3072 sc1
  s_waitcnt vmcnt(40)
  s_mul_i32 s23, s17, 401408
  s_and_b32 s22, s16, 1
  s_mul_i32 s22, s22, 7168
  s_add_u32 s23, s23, s22
  s_add_u32 s23, s23, 0
  s_lshr_b32 s22, s16, 1
  s_mul_i32 s22, s22, 14336
  s_add_u32 s23, s23, s22
  s_mul_i32 s27, s16, 7168
  s_lshr_b32 s28, s20, 1
wf_vo:
  s_sub_u32 s29, s17, 16
  s_lshl_b32 s29, s29, 6
  s_add_u32 s29, s29, s28
  s_mul_i32 s29, s29, 28672
  s_add_u32 s29, s29, 42205184
  v_lshlrev_b32 v6, 4, v3
  v_mad_u32_u24 v7, v3, 12, 64
  s_mov_b32 s31, 0
  s_lshl_b32 s24, s34, 1
  s_mul_i32 s24, s24, 14336
  s_add_u32 s24, s24, s23
  s_cmp_lt_u32 s34, s35
  s_cselect_b32 s24, s24, 0x10000000
  s_add_u32 m0, s31, s27
  s_nop 0
  buffer_load_dwordx4 v2, s[8:11], s24 offen offset:0 sc1 lds
  buffer_load_dwordx4 v2, s[8:11], s24 offen offset:1024 sc1 lds
  buffer_load_dwordx4 v2, s[8:11], s24 offen offset:2048 sc1 lds
  buffer_load_dwordx4 v2, s[8:11], s24 offen offset:3072 sc1 lds
  s_add_u32 m0, m0, 4096
  s_add_u32 s24, s24, 4096
  buffer_load_dwordx4 v2, s[8:11], s24 offen offset:0 sc1 lds
  buffer_load_dwordx4 v2, s[8:11], s24 offen offset:1024 sc1 lds
  buffer_load_dwordx4 v2, s[8:11], s24 offen offset:2048 sc1 lds
  s_add_u32 s30, s34, 1
  s_mov_b32 s31, 28672
  s_lshl_b32 s24, s30, 1
  s_mul_i32 s24, s24, 14336
  s_add_u32 s24, s24, s23
  s_cmp_lt_u32 s30, s35
  s_cselect_b32 s24, s24, 0x10000000
  s_add_u32 m0, s31, s27
  s_nop 0
  buffer_load_dwordx4 v2, s[8:11], s24 offen offset:0 sc1 lds
  buffer_load_dwordx4 v2, s[8:11], s24 offen offset:1024 sc1 lds
  buffer_load_dwordx4 v2, s[8:11], s24 offen offset:2048 sc1 lds
  buffer_load_dwordx4 v2, s[8:11], s24 offen offset:3072 sc1 lds
  s_add_u32 m0, m0, 4096
  s_add_u32 s24, s24, 4096
  buffer_load_dwordx4 v2, s[8:11], s24 offen offset:0 sc1 lds
  buffer_load_dwordx4 v2, s[8:11], s24 offen offset:1024 sc1 lds
  buffer_load_dwordx4 v2, s[8:11], s24 offen offset:2048 sc1 lds
  s_mov_b32 s19, s34
  s_mov_b32 s32, 0
  s_mov_b32 s33, 57344
  s_waitcnt vmcnt(7)
  s_branch wf_vo_in
wf_vo_loop:
  s_waitcnt vmcnt(9)
wf_vo_in:
  s_barrier
  s_add_u32 s30, s19, 2
  s_lshl_b32 s24, s30, 1
  s_mul_i32 s24, s24, 14336
  s_add_u32 s24, s24, s23
  s_cmp_lt_u32 s30, s35
  s_cselect_b32 s24, s24, 0x10000000
  s_add_u32 m0, s33, s27
  s_nop 0
  buffer_load_dwordx4 v2, s[8:11], s24 offen offset:0 sc1 lds
  buffer_load_dwordx4 v2, s[8:11], s24 offen offset:1024 sc1 lds
  buffer_load_dwordx4 v2, s[8:11], s24 offen offset:2048 sc1 lds
  buffer_load_dwordx4 v2, s[8:11], s24 offen offset:3072 sc1 lds
  s_add_u32 m0, m0, 4096
  s_add_u32 s24, s24, 4096
  buffer_load_dwordx4 v2, s[8:11], s24 offen offset:0 sc1 lds
  buffer_load_dwordx4 v2, s[8:11], s24 offen offset:1024 sc1 lds
  buffer_load_dwordx4 v2, s[8:11], s24 offen offset:2048 sc1 lds
  v_add_u32 v5, s32, v2
  ds_read_b128 v[8:11], v5 offset:0
  ds_read_b128 v[12:15], v5 offset:14336
  ds_read_b128 v[16:19], v5 offset:1024
  ds_read_b128 v[20:23], v5 offset:15360
  ds_read_b128 v[24:27], v5 offset:2048
  ds_read_b128 v[28:31], v5 offset:16384
  ds_read_b128 v[32:35], v5 offset:3072
  s_waitcnt lgkmcnt(6)
  v_mfma_f32_16x16x32_bf16 v[40:43], a[0:3], v[8:11], 0
  v_mfma_f32_16x16x32_bf16 v[44:47], a[56:59], v[8:11], 0
  ds_read_b128 v[36:39], v5 offset:17408
  s_waitcnt lgkmcnt(6)
  v_mfma_f32_16x16x32_bf16 v[56:59], a[0:3], v[12:15], 0
  v_mfma_f32_16x16x32_bf16 v[60:63], a[56:59], v[12:15], 0
  ds_read_b128 v[8:11], v5 offset:4096
  s_waitcnt lgkmcnt(6)
  v_mfma_f32_16x16x32_bf16 v[40:43], a[4:7], v[16:19], v[40:43]
  v_mfma_f32_16x16x32_bf16 v[44:47], a[60:63], v[16:19], v[44:47]
  ds_read_b128 v[12:15], v5 offset:18432
  s_waitcnt lgkmcnt(6)
  v_mfma_f32_16x16x32_bf16 v[56:59], a[4:7], v[20:23], v[56:59]
  v_mfma_f32_16x16x32_bf16 v[60:63], a[60:63], v[20:23], v[60:63]
  ds_read_b128 v[16:19], v5 offset:5120
  s_waitcnt lgkmcnt(6)
  v_mfma_f32_16x16x32_bf16 v[40:43], a[8:11], v[24:27], v[40:43]
  v_mfma_f32_16x16x32_bf16 v[44:47], a[64:67], v[24:27], v[44:47]
  ds_read_b128 v[20:23], v5 offset:19456
  s_waitcnt lgkmcnt(6)
  v_mfma_f32_16x16x32_bf16 v[56:59], a[8:11], v[28:31], v[56:59]
  v_mfma_f32_16x16x32_bf16 v[60:63], a[64:67], v[28:31], v[60:63]
  ds_read_b128 v[24:27], v5 offset:6144
  s_waitcnt lgkmcnt(6)
  v_mfma_f32_16x16x32_bf16 v[40:43], a[12:15], v[32:35], v[40:43]
  v_mfma_f32_16x16x32_bf16 v[44:47], a[68:71], v[32:35], v[44:47]
  ds_read_b128 v[28:31], v5 offset:20480
  s_waitcnt lgkmcnt(6)
  v_mfma_f32_16x16x32_bf16 v[56:59], a[12:15], v[36:39], v[56:59]
  v_mfma_f32_16x16x32_bf16 v[60:63], a[68:71], v[36:39], v[60:63]
  ds_read_b128 v[32:35], v5 offset:7168
  s_waitcnt lgkmcnt(6)
  v_mfma_f32_16x16x32_bf16 v[40:43], a[16:19], v[8:11], v[40:43]
  v_mfma_f32_16x16x32_bf16 v[44:47], a[72:75], v[8:11], v[44:47]
  ds_read_b128 v[36:39], v5 offset:21504
  s_waitcnt lgkmcnt(6)
  v_mfma_f32_16x16x32_bf16 v[56:59], a[16:19], v[12:15], v[56:59]
  v_mfma_f32_16x16x32_bf16 v[60:63], a[72:75], v[12:15], v[60:63]
  ds_read_b128 v[8:11], v5 offset:8192
  s_waitcnt lgkmcnt(6)
  v_mfma_f32_16x16x32_bf16 v[40:43], a[20:23], v[16:19], v[40:43]
  v_mfma_f32_16x16x32_bf16 v[44:47], a[76:79], v[16:19], v[44:47]
  ds_read_b128 v[12:15], v5 offset:22528
  s_waitcnt lgkmcnt(6)
  v_mfma_f32_16x16x32_bf16 v[56:59], a[20:23], v[20:23], v[56:59]
  v_mfma_f32_16x16x32_bf16 v[60:63], a[76:79], v[20:23], v[60:63]
  ds_read_b128 v[16:19], v5 offset:9216
  s_waitcnt lgkmcnt(6)
  v_mfma_f32_16x16x32_bf16 v[40:43], a[24:27], v[24:27], v[40:43]
  v_mfma_f32_16x16x32_bf16 v[44:47], a[80:83], v[24:27], v[44:47]
  ds_read_b128 v[20:23], v5 offset:23552
  s_waitcnt lgkmcnt(6)
  v_mfma_f32_16x16x32_bf16 v[56:59], a[24:27], v[28:31], v[56:59]
  v_mfma_f32_16x16x32_bf16 v[60:63], a[80:83], v[28:31], v[60:63]
  ds_read_b128 v[24:27], v5 offset:10240
  s_waitcnt lgkmcnt(6)
  v_mfma_f32_16x16x32_bf16 v[40:43], a[28:31], v[32:35], v[40:43]
  v_mfma_f32_16x16x32_bf16 v[44:47], a[84:87], v[32:35], v[44:47]
  ds_read_b128 v[28:31], v5 offset:24576
  s_waitcnt lgkmcnt(6)
  v_mfma_f32_16x16x32_bf16 v[56:59], a[28:31], v[36:39], v[56:59]
  v_mfma_f32_16x16x32_bf16 v[60:63], a[84:87], v[36:39], v[60:63]
  ds_read_b128 v[32:35], v5 offset:11264
  s_waitcnt lgkmcnt(6)
  v_mfma_f32_16x16x32_bf16 v[40:43], a[32:35], v[8:11], v[40:43]
  v_mfma_f32_16x16x32_bf16 v[44:47], a[88:91], v[8:11], v[44:47]
  ds_read_b128 v[36:39], v5 offset:25600
  s_waitcnt lgkmcnt(6)
  v_mfma_f32_16x16x32_bf16 v[56:59], a[32:35], v[12:15], v[56:59]
  v_mfma_f32_16x16x32_bf16 v[60:63], a[88:91], v[12:15], v[60:63]
  ds_read_b128 v[8:11], v5 offset:12288
  s_waitcnt lgkmcnt(6)
  v_mfma_f32_16x16x32_bf16 v[40:43], a[36:39], v[16:19], v[40:43]
  v_mfma_f32_16x16x32_bf16 v[44:47], a[92:95], v[16:19], v[44:47]
  ds_read_b128 v[12:15], v5 offset:26624
  s_waitcnt lgkmcnt(6)
  v_mfma_f32_16x16x32_bf16 v[56:59], a[36:39], v[20:23], v[56:59]
  v_mfma_f32_16x16x32_bf16 v[60:63], a[92:95], v[20:23], v[60:63]
  ds_read_b128 v[16:19], v5 offset:13312
  s_waitcnt lgkmcnt(6)
  v_mfma_f32_16x16x32_bf16 v[40:43], a[40:43], v[24:27], v[40:43]
  v_mfma_f32_16x16x32_bf16 v[44:47], a[96:99], v[24:27], v[44:47]
  ds_read_b128 v[20:23], v5 offset:27648
  s_waitcnt lgkmcnt(6)
  v_mfma_f32_16x16x32_bf16 v[56:59], a[40:43], v[28:31], v[56:59]
  v_mfma_f32_16x16x32_bf16 v[60:63], a[96:99], v[28:31], v[60:63]
  s_waitcnt lgkmcnt(5)
  v_mfma_f32_16x16x32_bf16 v[40:43], a[44:47], v[32:35], v[40:43]
  v_mfma_f32_16x16x32_bf16 v[44:47], a[100:103], v[32:35], v[44:47]
  s_waitcnt lgkmcnt(4)
  v_mfma_f32_16x16x32_bf16 v[56:59], a[44:47], v[36:39], v[56:59]
  v_mfma_f32_16x16x32_bf16 v[60:63], a[100:103], v[36:39], v[60:63]
  s_waitcnt lgkmcnt(3)
  v_mfma_f32_16x16x32_bf16 v[40:43], a[48:51], v[8:11], v[40:43]
  v_mfma_f32_16x16x32_bf16 v[44:47], a[104:107], v[8:11], v[44:47]
  s_waitcnt lgkmcnt(2)
  v_mfma_f32_16x16x32_bf16 v[56:59], a[48:51], v[12:15], v[56:59]
  v_mfma_f32_16x16x32_bf16 v[60:63], a[104:107], v[12:15], v[60:63]
  s_waitcnt lgkmcnt(1)
  v_mfma_f32_16x16x32_bf16 v[40:43], a[52:55], v[16:19], v[40:43]
  v_mfma_f32_16x16x32_bf16 v[44:47], a[108:111], v[16:19], v[44:47]
  s_waitcnt lgkmcnt(0)
  v_mfma_f32_16x16x32_bf16 v[56:59], a[52:55], v[20:23], v[56:59]
  v_mfma_f32_16x16x32_bf16 v[60:63], a[108:111], v[20:23], v[60:63]
  s_add_u32 s25, s29, 28672
  s_lshl_b32 s24, s19, 5
  s_add_u32 s24, s24, 0
  v_add_u32 v88, s24, v4
  s_cmp_lt_u32 s19, 8
  s_cselect_b64 vcc, -1, 0
  s_cselect_b32 s24, 0, 256
  v_subrev_u32 v88, s24, v88
  s_movk_i32 s24, 5462
  s_cselect_b32 s24, 4096, s24
  v_mul_u32_u24 v89, s24, v88
  v_lshrrev_b32 v89, 16, v89
  s_movk_i32 s24, 100
  s_cselect_b32 s24, 96, s24
  v_mul_u32_u24 v89, s24, v89
  v_cndmask_b32 v92, v7, v6, vcc
  v_add3_u32 v88, v88, v89, v92
  v_lshlrev_b32 v90, 4, v88
  v_cvt_pk_bf16_f32 v72, v40, v41
  v_cvt_pk_bf16_f32 v73, v42, v43
  v_cvt_pk_bf16_f32 v74, v44, v45
  v_cvt_pk_bf16_f32 v75, v46, v47
  buffer_store_dwordx4 v[72:75], v90, s[8:11], s29 offen sc1
  s_lshl_b32 s24, s19, 5
  s_add_u32 s24, s24, 16
  v_add_u32 v88, s24, v4
  s_cmp_lt_u32 s19, 8
  s_cselect_b64 vcc, -1, 0
  s_cselect_b32 s24, 0, 256
  v_subrev_u32 v88, s24, v88
  s_movk_i32 s24, 5462
  s_cselect_b32 s24, 4096, s24
  v_mul_u32_u24 v89, s24, v88
  v_lshrrev_b32 v89, 16, v89
  s_movk_i32 s24, 100
  s_cselect_b32 s24, 96, s24
  v_mul_u32_u24 v89, s24, v89
  v_cndmask_b32 v92, v7, v6, vcc
  v_add3_u32 v88, v88, v89, v92
  v_lshlrev_b32 v91, 4, v88
  v_cvt_pk_bf16_f32 v80, v56, v57
  v_cvt_pk_bf16_f32 v81, v58, v59
  v_cvt_pk_bf16_f32 v82, v60, v61
  v_cvt_pk_bf16_f32 v83, v62, v63
  buffer_store_dwordx4 v[80:83], v91, s[8:11], s29 offen sc1
  s_mov_b32 s33, s32
  s_add_u32 s32, s32, 28672
  s_cmp_eq_u32 s32, 86016
  s_cselect_b32 s32, 0, s32
  s_add_u32 s19, s19, 1
  s_cmp_lt_u32 s19, s35
  s_cbranch_scc1 wf_vo_loop
  s_branch wf_done
wf_done:
  s_lshr_b32 s20, s18, 1
  s_lshl_b32 s20, s20, 4
  s_and_b32 s21, s17, 15
  s_add_u32 s20, s20, s21
  s_lshl_b32 s20, s20, 7
  s_cmp_lt_u32 s17, 16
  s_cselect_b32 s21, 16384, 0
  s_add_u32 s20, s20, s21
  s_add_u32 s20, s20, 88541184
  s_sub_u32 s21, s35, s34
  s_lshr_b32 s21, s21, 1
  v_mov_b32 v5, s21
  v_mov_b32 v6, 0
  s_waitcnt vmcnt(0)
  s_mov_b64 exec, 1
  s_cmp_lg_u32 s18, 0
  s_cbranch_scc1 wf_h1
  v_mov_b32 v7, 2
  s_sub_u32 s21, s20, 2048
  buffer_atomic_add v7, v6, s[8:11], s21 offen
wf_h1:
  buffer_atomic_add v5, v6, s[8:11], s20 offen
  s_mov_b64 exec, -1
  s_load_dwordx8 s[36:43], s[0:1], 56
  s_load_dwordx4 s[44:47], s[0:1], 88
  s_waitcnt lgkmcnt(0)
  s_mov_b32 s52, s36
  s_and_b32 s53, s37, 0xffff
  s_mov_b32 s54, 1835008
  s_mov_b32 s55, 0x20000
  s_lshl_b32 s20, s3, 8
  v_add_u32 v95, s20, v0
  s_mov_b32 s21, 9586981
  v_mul_hi_u32 v6, v95, s21
  v_mul_u32_u24 v7, 448, v6
  v_sub_u32 v7, v95, v7
  v_lshrrev_b32 v8, 4, v7
  v_and_b32 v7, 15, v7
  v_lshl_add_u32 v9, v6, 4, v7
  v_mul_u32_u24 v9, 896, v9
  v_lshl_add_u32 v9, v8, 5, v9
  buffer_load_dwordx4 v[84:87], v9, s[52:55], 0 offen
  buffer_load_dwordx4 v[88:91], v9, s[52:55], 0 offen offset:16
  v_mul_u32_u24 v6, 14336, v6
  v_lshl_add_u32 v6, v7, 4, v6
  v_lshl_add_u32 v92, v8, 9, v6
  v_lshrrev_b32 v7, 2, v8
  v_lshl_add_u32 v6, v7, 11, v6
  v_and_b32 v7, 3, v8
  v_lshl_add_u32 v93, v7, 8, v6
  v_mov_b32 v52, -1
  v_mov_b32 v53, -1
  v_mov_b32 v54, -1
  v_mov_b32 v55, -1
  s_mov_b32 s23, 89063424
  v_lshlrev_b32 v8, 4, v95
  buffer_store_dwordx4 v[52:55], v8, s[8:11], s23 offen sc1
  v_add_u32 v8, 917504, v8
  v_mov_b32 v9, 0x10000000
  v_cmp_lt_u32 vcc, 1535, v95
  s_nop 1
  v_cndmask_b32 v8, v8, v9, vcc
  buffer_store_dwordx4 v[52:55], v8, s[8:11], s23 offen sc1
  s_waitcnt vmcnt(1)
  v_mov_b32 v96, v84
  v_mov_b32 v100, v85
  v_mov_b32 v97, v86
  v_mov_b32 v101, v87
  v_mov_b32 v98, v88
  v_mov_b32 v102, v89
  v_mov_b32 v99, v90
  v_mov_b32 v103, v91
  s_mov_b32 s20, 71565312
  s_mov_b32 s21, 73400320
  buffer_store_dwordx4 v[96:99], v93, s[8:11], s21 offen sc1
  buffer_store_dwordx4 v[100:103], v93, s[8:11], s21 offen offset:1024 sc1
  s_cmp_lt_u32 s3, 70
  s_cbranch_scc1 i2_nx
  buffer_store_dwordx4 v[84:87], v92, s[8:11], s20 offen sc1
  buffer_store_dwordx4 v[88:91], v92, s[8:11], s20 offen offset:256 sc1
i2_nx:
  s_lshl_b32 s20, s3, 3
  s_add_u32 s20, s20, 88637440
  s_waitcnt vmcnt(0)
  s_barrier
  s_cmp_lg_u32 s16, 0
  s_cbranch_scc1 pub_38
  v_mul_u32_u24 v26, 2048, v1
  v_mov_b32 v24, s88
  v_mov_b32 v25, s89
  s_mov_b64 exec, 255
  buffer_store_dwordx2 v[24:25], v26, s[8:11], s20 offen sc1
  s_mov_b64 exec, -1
pub_38:
  s_branch wk_loop
wk_v7:
  s_sub_u32 s20, s3, 256
  s_mov_b32 s18, 1
  s_and_b32 s17, s20, 15
  s_add_u32 s17, s17, 16
  s_lshr_b32 s34, s20, 4
  s_lshl_b32 s34, s34, 1
  s_add_u32 s35, s34, 2
  s_branch wk_gemm
wk_vh:
  s_sub_u32 s20, s3, 368
  s_and_b32 s17, s20, 15
  s_add_u32 s17, s17, 16
  s_lshr_b32 s18, s20, 5
  s_add_u32 s18, s18, 2
  s_bitcmp1_b32 s20, 4
  s_cselect_b32 s34, 7, 0
  s_add_u32 s35, s34, 7
  s_branch wk_gemm
wk_vf:
  s_sub_u32 s20, s3, 560
  s_and_b32 s17, s20, 15
  s_add_u32 s17, s17, 16
  s_lshr_b32 s18, s20, 4
  s_add_u32 s18, s18, 4
  s_mov_b32 s34, 0
  s_mov_b32 s35, 14
  s_branch wk_gemm
wk_f:
  s_sub_u32 s20, s3, 624
  s_and_b32 s17, s20, 15
  s_lshr_b32 s18, s20, 4
  s_mov_b32 s34, 0
  s_mov_b32 s35, 14
  s_lshl_b32 s22, s17, 7
  s_add_u32 s22, s22, 88633344
  s_add_u32 s23, s22, 2048
  v_min_u32 v24, 48, v2
  v_min_u32 v25, 96, v2
  s_mov_b32 s30, 0
wk_aw:
  buffer_load_dwordx4 v[28:31], v24, s[8:11], s22 offen sc1
  buffer_load_dwordx4 v[32:35], v25, s[8:11], s23 offen sc1
  s_waitcnt vmcnt(0)
  v_cmp_ne_u64 vcc, s[88:89], v[28:29]
  s_cbranch_vccnz wk_aw_no
  v_cmp_ne_u64 vcc, s[88:89], v[30:31]
  s_cbranch_vccnz wk_aw_no
  v_cmp_ne_u64 vcc, s[88:89], v[32:33]
  s_cbranch_vccnz wk_aw_no
  v_cmp_ne_u64 vcc, s[88:89], v[34:35]
  s_cbranch_vccnz wk_aw_no
  s_branch wk_aw_ok
wk_aw_no:
  s_sleep 6
  s_add_u32 s30, s30, 1
  s_cmp_lt_u32 s30, 50000
  s_cbranch_scc1 wk_aw
  s_branch cA_abort
wk_aw_ok:
wk_gemm:
  s_lshl_b32 s20, s18, 4
  s_lshl_b32 s21, s16, 2
  s_add_u32 s20, s20, s21
  s_mul_i32 s21, s20, 14336
  s_add_u32 s21, s21, 71565312
  s_add_u32 s22, s21, 0
  buffer_load_dwordx4 a[0:3], v2, s[8:11], s22 offen offset:0 sc1
  buffer_load_dwordx4 a[4:7], v2, s[8:11], s22 offen offset:1024 sc1
  buffer_load_dwordx4 a[8:11], v2, s[8:11], s22 offen offset:2048 sc1
  buffer_load_dwordx4 a[12:15], v2, s[8:11], s22 offen offset:3072 sc1
  s_add_u32 s22, s21, 4096
  buffer_load_dwordx4 a[16:19], v2, s[8:11], s22 offen offset:0 sc1
  buffer_load_dwordx4 a[20:23], v2, s[8:11], s22 offen offset:1024 sc1
  buffer_load_dwordx4 a[24:27], v2, s[8:11], s22 offen offset:2048 sc1
  buffer_load_dwordx4 a[28:31], v2, s[8:11], s22 offen offset:3072 sc1
  s_add_u32 s22, s21, 8192
  buffer_load_dwordx4 a[32:35], v2, s[8:11], s22 offen offset:0 sc1
  buffer_load_dwordx4 a[36:39], v2, s[8:11], s22 offen offset:1024 sc1
  buffer_load_dwordx4 a[40:43], v2, s[8:11], s22 offen offset:2048 sc1
  buffer_load_dwordx4 a[44:47], v2, s[8:11], s22 offen offset:3072 sc1
  s_add_u32 s22, s21, 12288
  buffer_load_dwordx4 a[48:51], v2, s[8:11], s22 offen offset:0 sc1
  buffer_load_dwordx4 a[52:55], v2, s[8:11], s22 offen offset:1024 sc1
  buffer_load_dwordx4 a[56:59], v2, s[8:11], s22 offen offset:2048 sc1
  buffer_load_dwordx4 a[60:63], v2, s[8:11], s22 offen offset:3072 sc1
  s_add_u32 s22, s21, 16384
  buffer_load_dwordx4 a[64:67], v2, s[8:11], s22 offen offset:0 sc1
  buffer_load_dwordx4 a[68:71], v2, s[8:11], s22 offen offset:1024 sc1
  buffer_load_dwordx4 a[72:75], v2, s[8:11], s22 offen offset:2048 sc1
  buffer_load_dwordx4 a[76:79], v2, s[8:11], s22 offen offset:3072 sc1
  s_add_u32 s22, s21, 20480
  buffer_load_dwordx4 a[80:83], v2, s[8:11], s22 offen offset:0 sc1
  buffer_load_dwordx4 a[84:87], v2, s[8:11], s22 offen offset:1024 sc1
  buffer_load_dwordx4 a[88:91], v2, s[8:11], s22 offen offset:2048 sc1
  buffer_load_dwordx4 a[92:95], v2, s[8:11], s22 offen offset:3072 sc1
  s_add_u32 s22, s21, 24576
  buffer_load_dwordx4 a[96:99], v2, s[8:11], s22 offen offset:0 sc1
  buffer_load_dwordx4 a[100:103], v2, s[8:11], s22 offen offset:1024 sc1
  buffer_load_dwordx4 a[104:107], v2, s[8:11], s22 offen offset:2048 sc1
  buffer_load_dwordx4 a[108:111], v2, s[8:11], s22 offen offset:3072 sc1
  s_add_u32 s22, s21, 28672
  buffer_load_dwordx4 a[112:115], v2, s[8:11], s22 offen offset:0 sc1
  buffer_load_dwordx4 a[116:119], v2, s[8:11], s22 offen offset:1024 sc1
  buffer_load_dwordx4 a[120:123], v2, s[8:11], s22 offen offset:2048 sc1
  buffer_load_dwordx4 a[124:127], v2, s[8:11], s22 offen offset:3072 sc1
  s_add_u32 s22, s21, 32768
  buffer_load_dwordx4 a[128:131], v2, s[8:11], s22 offen offset:0 sc1
  buffer_load_dwordx4 a[132:135], v2, s[8:11], s22 offen offset:1024 sc1
  buffer_load_dwordx4 a[136:139], v2, s[8:11], s22 offen offset:2048 sc1
  buffer_load_dwordx4 a[140:143], v2, s[8:11], s22 offen offset:3072 sc1
  s_add_u32 s22, s21, 36864
  buffer_load_dwordx4 a[144:147], v2, s[8:11], s22 offen offset:0 sc1
  buffer_load_dwordx4 a[148:151], v2, s[8:11], s22 offen offset:1024 sc1
  buffer_load_dwordx4 a[152:155], v2, s[8:11], s22 offen offset:2048 sc1
  buffer_load_dwordx4 a[156:159], v2, s[8:11], s22 offen offset:3072 sc1
  s_add_u32 s22, s21, 40960
  buffer_load_dwordx4 a[160:163], v2, s[8:11], s22 offen offset:0 sc1
  buffer_load_dwordx4 a[164:167], v2, s[8:11], s22 offen offset:1024 sc1
  buffer_load_dwordx4 a[168:171], v2, s[8:11], s22 offen offset:2048 sc1
  buffer_load_dwordx4 a[172:175], v2, s[8:11], s22 offen offset:3072 sc1
  s_add_u32 s22, s21, 45056
  buffer_load_dwordx4 a[176:179], v2, s[8:11], s22 offen offset:0 sc1
  buffer_load_dwordx4 a[180:183], v2, s[8:11], s22 offen offset:1024 sc1
  buffer_load_dwordx4 a[184:187], v2, s[8:11], s22 offen offset:2048 sc1
  buffer_load_dwordx4 a[188:191], v2, s[8:11], s22 offen offset:3072 sc1
  s_add_u32 s22, s21, 49152
  buffer_load_dwordx4 a[192:195], v2, s[8:11], s22 offen offset:0 sc1
  buffer_load_dwordx4 a[196:199], v2, s[8:11], s22 offen offset:1024 sc1
  buffer_load_dwordx4 a[200:203], v2, s[8:11], s22 offen offset:2048 sc1
  buffer_load_dwordx4 a[204:207], v2, s[8:11], s22 offen offset:3072 sc1
  s_add_u32 s22, s21, 53248
  buffer_load_dwordx4 a[208:211], v2, s[8:11], s22 offen offset:0 sc1
  buffer_load_dwordx4 a[212:215], v2, s[8:11], s22 offen offset:1024 sc1
  buffer_load_dwordx4 a[216:219], v2, s[8:11], s22 offen offset:2048 sc1
  buffer_load_dwordx4 a[220:223], v2, s[8:11], s22 offen offset:3072 sc1
  s_waitcnt vmcnt(40)
  s_mul_i32 s23, s17, 401408
  s_and_b32 s22, s16, 1
  s_mul_i32 s22, s22, 7168
  s_add_u32 s23, s23, s22
  s_add_u32 s23, s23, 0
  s_lshr_b32 s22, s16, 1
  s_mul_i32 s22, s22, 14336
  s_add_u32 s23, s23, s22
  s_mul_i32 s27, s16, 7168
  s_lshr_b32 s28, s20, 1
  s_cmp_lt_u32 s17, 16
  s_cbranch_scc0 wg_vo
  s_add_u32 s23, s23, s22
  s_lshl_b32 s29, s28, 4
  s_add_u32 s29, s29, s17
  s_mul_i32 s29, s29, 28672
  s_add_u32 s29, s29, 12845056
  s_mov_b32 s31, 0
  s_lshr_b32 s24, s34, 1
  s_lshl_b32 s24, s24, 2
  s_and_b32 s25, s34, 1
  s_add_u32 s24, s24, s25
  s_mul_i32 s24, s24, 14336
  s_add_u32 s24, s24, s23
  s_cmp_lt_u32 s34, s35
  s_cselect_b32 s24, s24, 0x10000000
  s_add_u32 m0, s31, s27
  s_nop 0
  buffer_load_dwordx4 v2, s[8:11], s24 offen offset:0 sc1 lds
  buffer_load_dwordx4 v2, s[8:11], s24 offen offset:1024 sc1 lds
  buffer_load_dwordx4 v2, s[8:11], s24 offen offset:2048 sc1 lds
  buffer_load_dwordx4 v2, s[8:11], s24 offen offset:3072 sc1 lds
  s_add_u32 m0, m0, 4096
  s_add_u32 s24, s24, 4096
  buffer_load_dwordx4 v2, s[8:11], s24 offen offset:0 sc1 lds
  buffer_load_dwordx4 v2, s[8:11], s24 offen offset:1024 sc1 lds
  buffer_load_dwordx4 v2, s[8:11], s24 offen offset:2048 sc1 lds
  s_add_u32 s30, s34, 1
  s_mov_b32 s31, 28672
  s_lshr_b32 s24, s30, 1
  s_lshl_b32 s24, s24, 2
  s_and_b32 s25, s30, 1
  s_add_u32 s24, s24, s25
  s_mul_i32 s24, s24, 14336
  s_add_u32 s24, s24, s23
  s_cmp_lt_u32 s30, s35
  s_cselect_b32 s24, s24, 0x10000000
  s_add_u32 m0, s31, s27
  s_nop 0
  buffer_load_dwordx4 v2, s[8:11], s24 offen offset:0 sc1 lds
  buffer_load_dwordx4 v2, s[8:11], s24 offen offset:1024 sc1 lds
  buffer_load_dwordx4 v2, s[8:11], s24 offen offset:2048 sc1 lds
  buffer_load_dwordx4 v2, s[8:11], s24 offen offset:3072 sc1 lds
  s_add_u32 m0, m0, 4096
  s_add_u32 s24, s24, 4096
  buffer_load_dwordx4 v2, s[8:11], s24 offen offset:0 sc1 lds
  buffer_load_dwordx4 v2, s[8:11], s24 offen offset:1024 sc1 lds
  buffer_load_dwordx4 v2, s[8:11], s24 offen offset:2048 sc1 lds
  s_mov_b32 s19, s34
  s_mov_b32 s32, 0
  s_mov_b32 s33, 57344
  s_waitcnt vmcnt(7)
  s_branch wg_f_in
wg_f_loop:
  s_waitcnt vmcnt(11)
wg_f_in:
  s_barrier
  s_add_u32 s30, s19, 2
  s_lshr_b32 s24, s30, 1
  s_lshl_b32 s24, s24, 2
  s_and_b32 s25, s30, 1
  s_add_u32 s24, s24, s25
  s_mul_i32 s24, s24, 14336
  s_add_u32 s24, s24, s23
  s_cmp_lt_u32 s30, s35
  s_cselect_b32 s24, s24, 0x10000000
  s_add_u32 m0, s33, s27
  s_nop 0
  buffer_load_dwordx4 v2, s[8:11], s24 offen offset:0 sc1 lds
  buffer_load_dwordx4 v2, s[8:11], s24 offen offset:1024 sc1 lds
  buffer_load_dwordx4 v2, s[8:11], s24 offen offset:2048 sc1 lds
  buffer_load_dwordx4 v2, s[8:11], s24 offen offset:3072 sc1 lds
  s_add_u32 m0, m0, 4096
  s_add_u32 s24, s24, 4096
  buffer_load_dwordx4 v2, s[8:11], s24 offen offset:0 sc1 lds
  buffer_load_dwordx4 v2, s[8:11], s24 offen offset:1024 sc1 lds
  buffer_load_dwordx4 v2, s[8:11], s24 offen offset:2048 sc1 lds
  v_add_u32 v5, s32, v2
  ds_read_b128 v[8:11], v5 offset:0
  ds_read_b128 v[12:15], v5 offset:14336
  ds_read_b128 v[16:19], v5 offset:1024
  ds_read_b128 v[20:23], v5 offset:15360
  ds_read_b128 v[24:27], v5 offset:2048
  ds_read_b128 v[28:31], v5 offset:16384
  ds_read_b128 v[32:35], v5 offset:3072
  s_waitcnt lgkmcnt(6)
  v_mfma_f32_16x16x32_bf16 v[40:43], v[8:11], a[0:3], 0
  v_mfma_f32_16x16x32_bf16 v[44:47], v[8:11], a[56:59], 0
  v_mfma_f32_16x16x32_bf16 v[48:51], v[8:11], a[112:115], 0
  v_mfma_f32_16x16x32_bf16 v[52:55], v[8:11], a[168:171], 0
  ds_read_b128 v[36:39], v5 offset:17408
  s_waitcnt lgkmcnt(6)
  v_mfma_f32_16x16x32_bf16 v[56:59], v[12:15], a[0:3], 0
  v_mfma_f32_16x16x32_bf16 v[60:63], v[12:15], a[56:59], 0
  v_mfma_f32_16x16x32_bf16 v[64:67], v[12:15], a[112:115], 0
  v_mfma_f32_16x16x32_bf16 v[68:71], v[12:15], a[168:171], 0
  ds_read_b128 v[8:11], v5 offset:4096
  s_waitcnt lgkmcnt(6)
  v_mfma_f32_16x16x32_bf16 v[40:43], v[16:19], a[4:7], v[40:43]
  v_mfma_f32_16x16x32_bf16 v[44:47], v[16:19], a[60:63], v[44:47]
  v_mfma_f32_16x16x32_bf16 v[48:51], v[16:19], a[116:119], v[48:51]
  v_mfma_f32_16x16x32_bf16 v[52:55], v[16:19], a[172:175], v[52:55]
  ds_read_b128 v[12:15], v5 offset:18432
  s_waitcnt lgkmcnt(6)
  v_mfma_f32_16x16x32_bf16 v[56:59], v[20:23], a[4:7], v[56:59]
  v_mfma_f32_16x16x32_bf16 v[60:63], v[20:23], a[60:63], v[60:63]
  v_mfma_f32_16x16x32_bf16 v[64:67], v[20:23], a[116:119], v[64:67]
  v_mfma_f32_16x16x32_bf16 v[68:71], v[20:23], a[172:175], v[68:71]
  ds_read_b128 v[16:19], v5 offset:5120
  s_waitcnt lgkmcnt(6)
  v_mfma_f32_16x16x32_bf16 v[40:43], v[24:27], a[8:11], v[40:43]
  v_mfma_f32_16x16x32_bf16 v[44:47], v[24:27], a[64:67], v[44:47]
  v_mfma_f32_16x16x32_bf16 v[48:51], v[24:27], a[120:123], v[48:51]
  v_mfma_f32_16x16x32_bf16 v[52:55], v[24:27], a[176:179], v[52:55]
  ds_read_b128 v[20:23], v5 offset:19456
  s_waitcnt lgkmcnt(6)
  v_mfma_f32_16x16x32_bf16 v[56:59], v[28:31], a[8:11], v[56:59]
  v_mfma_f32_16x16x32_bf16 v[60:63], v[28:31], a[64:67], v[60:63]
  v_mfma_f32_16x16x32_bf16 v[64:67], v[28:31], a[120:123], v[64:67]
  v_mfma_f32_16x16x32_bf16 v[68:71], v[28:31], a[176:179], v[68:71]
  ds_read_b128 v[24:27], v5 offset:6144
  s_waitcnt lgkmcnt(6)
  v_mfma_f32_16x16x32_bf16 v[40:43], v[32:35], a[12:15], v[40:43]
  v_mfma_f32_16x16x32_bf16 v[44:47], v[32:35], a[68:71], v[44:47]
  v_mfma_f32_16x16x32_bf16 v[48:51], v[32:35], a[124:127], v[48:51]
  v_mfma_f32_16x16x32_bf16 v[52:55], v[32:35], a[180:183], v[52:55]
  ds_read_b128 v[28:31], v5 offset:20480
  s_waitcnt lgkmcnt(6)
  v_mfma_f32_16x16x32_bf16 v[56:59], v[36:39], a[12:15], v[56:59]
  v_mfma_f32_16x16x32_bf16 v[60:63], v[36:39], a[68:71], v[60:63]
  v_mfma_f32_16x16x32_bf16 v[64:67], v[36:39], a[124:127], v[64:67]
  v_mfma_f32_16x16x32_bf16 v[68:71], v[36:39], a[180:183], v[68:71]
  ds_read_b128 v[32:35], v5 offset:7168
  s_waitcnt lgkmcnt(6)
  v_mfma_f32_16x16x32_bf16 v[40:43], v[8:11], a[16:19], v[40:43]
  v_mfma_f32_16x16x32_bf16 v[44:47], v[8:11], a[72:75], v[44:47]
  v_mfma_f32_16x16x32_bf16 v[48:51], v[8:11], a[128:131], v[48:51]
  v_mfma_f32_16x16x32_bf16 v[52:55], v[8:11], a[184:187], v[52:55]
  ds_read_b128 v[36:39], v5 offset:21504
  s_waitcnt lgkmcnt(6)
  v_mfma_f32_16x16x32_bf16 v[56:59], v[12:15], a[16:19], v[56:59]
  v_mfma_f32_16x16x32_bf16 v[60:63], v[12:15], a[72:75], v[60:63]
  v_mfma_f32_16x16x32_bf16 v[64:67], v[12:15], a[128:131], v[64:67]
  v_mfma_f32_16x16x32_bf16 v[68:71], v[12:15], a[184:187], v[68:71]
  ds_read_b128 v[8:11], v5 offset:8192
  s_waitcnt lgkmcnt(6)
  v_mfma_f32_16x16x32_bf16 v[40:43], v[16:19], a[20:23], v[40:43]
  v_mfma_f32_16x16x32_bf16 v[44:47], v[16:19], a[76:79], v[44:47]
  v_mfma_f32_16x16x32_bf16 v[48:51], v[16:19], a[132:135], v[48:51]
  v_mfma_f32_16x16x32_bf16 v[52:55], v[16:19], a[188:191], v[52:55]
  ds_read_b128 v[12:15], v5 offset:22528
  s_waitcnt lgkmcnt(6)
  v_mfma_f32_16x16x32_bf16 v[56:59], v[20:23], a[20:23], v[56:59]
  v_mfma_f32_16x16x32_bf16 v[60:63], v[20:23], a[76:79], v[60:63]
  v_mfma_f32_16x16x32_bf16 v[64:67], v[20:23], a[132:135], v[64:67]
  v_mfma_f32_16x16x32_bf16 v[68:71], v[20:23], a[188:191], v[68:71]
  ds_read_b128 v[16:19], v5 offset:9216
  s_waitcnt lgkmcnt(6)
  v_mfma_f32_16x16x32_bf16 v[40:43], v[24:27], a[24:27], v[40:43]
  v_mfma_f32_16x16x32_bf16 v[44:47], v[24:27], a[80:83], v[44:47]
  v_mfma_f32_16x16x32_bf16 v[48:51], v[24:27], a[136:139], v[48:51]
  v_mfma_f32_16x16x32_bf16 v[52:55], v[24:27], a[192:195], v[52:55]
  ds_read_b128 v[20:23], v5 offset:23552
  s_waitcnt lgkmcnt(6)
  v_mfma_f32_16x16x32_bf16 v[56:59], v[28:31], a[24:27], v[56:59]
  v_mfma_f32_16x16x32_bf16 v[60:63], v[28:31], a[80:83], v[60:63]
  v_mfma_f32_16x16x32_bf16 v[64:67], v[28:31], a[136:139], v[64:67]
  v_mfma_f32_16x16x32_bf16 v[68:71], v[28:31], a[192:195], v[68:71]
  ds_read_b128 v[24:27], v5 offset:10240
  s_waitcnt lgkmcnt(6)
  v_mfma_f32_16x16x32_bf16 v[40:43], v[32:35], a[28:31], v[40:43]
  v_mfma_f32_16x16x32_bf16 v[44:47], v[32:35], a[84:87], v[44:47]
  v_mfma_f32_16x16x32_bf16 v[48:51], v[32:35], a[140:143], v[48:51]
  v_mfma_f32_16x16x32_bf16 v[52:55], v[32:35], a[196:199], v[52:55]
  ds_read_b128 v[28:31], v5 offset:24576
  s_waitcnt lgkmcnt(6)
  v_mfma_f32_16x16x32_bf16 v[56:59], v[36:39], a[28:31], v[56:59]
  v_mfma_f32_16x16x32_bf16 v[60:63], v[36:39], a[84:87], v[60:63]
  v_mfma_f32_16x16x32_bf16 v[64:67], v[36:39], a[140:143], v[64:67]
  v_mfma_f32_16x16x32_bf16 v[68:71], v[36:39], a[196:199], v[68:71]
  ds_read_b128 v[32:35], v5 offset:11264
  s_waitcnt lgkmcnt(6)
  v_mfma_f32_16x16x32_bf16 v[40:43], v[8:11], a[32:35], v[40:43]
  v_mfma_f32_16x16x32_bf16 v[44:47], v[8:11], a[88:91], v[44:47]
  v_mfma_f32_16x16x32_bf16 v[48:51], v[8:11], a[144:147], v[48:51]
  v_mfma_f32_16x16x32_bf16 v[52:55], v[8:11], a[200:203], v[52:55]
  ds_read_b128 v[36:39], v5 offset:25600
  s_waitcnt lgkmcnt(6)
  v_mfma_f32_16x16x32_bf16 v[56:59], v[12:15], a[32:35], v[56:59]
  v_mfma_f32_16x16x32_bf16 v[60:63], v[12:15], a[88:91], v[60:63]
  v_mfma_f32_16x16x32_bf16 v[64:67], v[12:15], a[144:147], v[64:67]
  v_mfma_f32_16x16x32_bf16 v[68:71], v[12:15], a[200:203], v[68:71]
  ds_read_b128 v[8:11], v5 offset:12288
  s_waitcnt lgkmcnt(6)
  v_mfma_f32_16x16x32_bf16 v[40:43], v[16:19], a[36:39], v[40:43]
  v_mfma_f32_16x16x32_bf16 v[44:47], v[16:19], a[92:95], v[44:47]
  v_mfma_f32_16x16x32_bf16 v[48:51], v[16:19], a[148:151], v[48:51]
  v_mfma_f32_16x16x32_bf16 v[52:55], v[16:19], a[204:207], v[52:55]
  ds_read_b128 v[12:15], v5 offset:26624
  s_waitcnt lgkmcnt(6)
  v_mfma_f32_16x16x32_bf16 v[56:59], v[20:23], a[36:39], v[56:59]
  v_mfma_f32_16x16x32_bf16 v[60:63], v[20:23], a[92:95], v[60:63]
  v_mfma_f32_16x16x32_bf16 v[64:67], v[20:23], a[148:151], v[64:67]
  v_mfma_f32_16x16x32_bf16 v[68:71], v[20:23], a[204:207], v[68:71]
  ds_read_b128 v[16:19], v5 offset:13312
  s_waitcnt lgkmcnt(6)
  v_mfma_f32_16x16x32_bf16 v[40:43], v[24:27], a[40:43], v[40:43]
  v_mfma_f32_16x16x32_bf16 v[44:47], v[24:27], a[96:99], v[44:47]
  v_mfma_f32_16x16x32_bf16 v[48:51], v[24:27], a[152:155], v[48:51]
  v_mfma_f32_16x16x32_bf16 v[52:55], v[24:27], a[208:211], v[52:55]
  ds_read_b128 v[20:23], v5 offset:27648
  s_waitcnt lgkmcnt(6)
  v_mfma_f32_16x16x32_bf16 v[56:59], v[28:31], a[40:43], v[56:59]
  v_mfma_f32_16x16x32_bf16 v[60:63], v[28:31], a[96:99], v[60:63]
  v_mfma_f32_16x16x32_bf16 v[64:67], v[28:31], a[152:155], v[64:67]
  v_mfma_f32_16x16x32_bf16 v[68:71], v[28:31], a[208:211], v[68:71]
  s_waitcnt lgkmcnt(5)
  v_mfma_f32_16x16x32_bf16 v[40:43], v[32:35], a[44:47], v[40:43]
  v_mfma_f32_16x16x32_bf16 v[44:47], v[32:35], a[100:103], v[44:47]
  v_mfma_f32_16x16x32_bf16 v[48:51], v[32:35], a[156:159], v[48:51]
  v_mfma_f32_16x16x32_bf16 v[52:55], v[32:35], a[212:215], v[52:55]
  s_waitcnt lgkmcnt(4)
  v_mfma_f32_16x16x32_bf16 v[56:59], v[36:39], a[44:47], v[56:59]
  v_mfma_f32_16x16x32_bf16 v[60:63], v[36:39], a[100:103], v[60:63]
  v_mfma_f32_16x16x32_bf16 v[64:67], v[36:39], a[156:159], v[64:67]
  v_mfma_f32_16x16x32_bf16 v[68:71], v[36:39], a[212:215], v[68:71]
  s_waitcnt lgkmcnt(3)
  v_mfma_f32_16x16x32_bf16 v[40:43], v[8:11], a[48:51], v[40:43]
  v_mfma_f32_16x16x32_bf16 v[44:47], v[8:11], a[104:107], v[44:47]
  v_mfma_f32_16x16x32_bf16 v[48:51], v[8:11], a[160:163], v[48:51]
  v_mfma_f32_16x16x32_bf16 v[52:55], v[8:11], a[216:219], v[52:55]
  s_waitcnt lgkmcnt(2)
  v_mfma_f32_16x16x32_bf16 v[56:59], v[12:15], a[48:51], v[56:59]
  v_mfma_f32_16x16x32_bf16 v[60:63], v[12:15], a[104:107], v[60:63]
  v_mfma_f32_16x16x32_bf16 v[64:67], v[12:15], a[160:163], v[64:67]
  v_mfma_f32_16x16x32_bf16 v[68:71], v[12:15], a[216:219], v[68:71]
  s_waitcnt lgkmcnt(1)
  v_mfma_f32_16x16x32_bf16 v[40:43], v[16:19], a[52:55], v[40:43]
  v_mfma_f32_16x16x32_bf16 v[44:47], v[16:19], a[108:111], v[44:47]
  v_mfma_f32_16x16x32_bf16 v[48:51], v[16:19], a[164:167], v[48:51]
  v_mfma_f32_16x16x32_bf16 v[52:55], v[16:19], a[220:223], v[52:55]
  s_waitcnt lgkmcnt(0)
  v_mfma_f32_16x16x32_bf16 v[56:59], v[20:23], a[52:55], v[56:59]
  v_mfma_f32_16x16x32_bf16 v[60:63], v[20:23], a[108:111], v[60:63]
  v_mfma_f32_16x16x32_bf16 v[64:67], v[20:23], a[164:167], v[64:67]
  v_mfma_f32_16x16x32_bf16 v[68:71], v[20:23], a[220:223], v[68:71]
  s_lshl_b32 s24, s19, 10
  s_add_u32 s24, s24, s29
  v_cvt_pk_bf16_f32 v72, v40, v41
  v_cvt_pk_bf16_f32 v73, v42, v43
  v_cvt_pk_bf16_f32 v74, v56, v57
  v_cvt_pk_bf16_f32 v75, v58, v59
  s_add_u32 s25, s24, 0
  buffer_store_dwordx4 v[72:75], v2, s[8:11], s25 offen sc1
  v_cvt_pk_bf16_f32 v76, v44, v45
  v_cvt_pk_bf16_f32 v77, v46, v47
  v_cvt_pk_bf16_f32 v78, v60, v61
  v_cvt_pk_bf16_f32 v79, v62, v63
  s_add_u32 s25, s24, 14336
  buffer_store_dwordx4 v[76:79], v2, s[8:11], s25 offen sc1
  v_cvt_pk_bf16_f32 v80, v48, v49
  v_cvt_pk_bf16_f32 v81, v50, v51
  v_cvt_pk_bf16_f32 v82, v64, v65
  v_cvt_pk_bf16_f32 v83, v66, v67
  s_add_u32 s25, s24, 458752
  buffer_store_dwordx4 v[80:83], v2, s[8:11], s25 offen sc1
  v_cvt_pk_bf16_f32 v84, v52, v53
  v_cvt_pk_bf16_f32 v85, v54, v55
  v_cvt_pk_bf16_f32 v86, v68, v69
  v_cvt_pk_bf16_f32 v87, v70, v71
  s_add_u32 s25, s24, 473088
  buffer_store_dwordx4 v[84:87], v2, s[8:11], s25 offen sc1
  s_mov_b32 s33, s32
  s_add_u32 s32, s32, 28672
  s_cmp_eq_u32 s32, 86016
  s_cselect_b32 s32, 0, s32
  s_add_u32 s19, s19, 1
  s_cmp_lt_u32 s19, s35
  s_cbranch_scc1 wg_f_loop
  s_branch wg_done
wg_vo:
  s_sub_u32 s29, s17, 16
  s_lshl_b32 s29, s29, 6
  s_add_u32 s29, s29, s28
  s_mul_i32 s29, s29, 28672
  s_add_u32 s29, s29, 42205184
  v_lshlrev_b32 v6, 4, v3
  v_mad_u32_u24 v7, v3, 12, 64
  s_mov_b32 s31, 0
  s_lshl_b32 s24, s34, 1
  s_mul_i32 s24, s24, 14336
  s_add_u32 s24, s24, s23
  s_cmp_lt_u32 s34, s35
  s_cselect_b32 s24, s24, 0x10000000
  s_add_u32 m0, s31, s27
  s_nop 0
  buffer_load_dwordx4 v2, s[8:11], s24 offen offset:0 sc1 lds
  buffer_load_dwordx4 v2, s[8:11], s24 offen offset:1024 sc1 lds
  buffer_load_dwordx4 v2, s[8:11], s24 offen offset:2048 sc1 lds
  buffer_load_dwordx4 v2, s[8:11], s24 offen offset:3072 sc1 lds
  s_add_u32 m0, m0, 4096
  s_add_u32 s24, s24, 4096
  buffer_load_dwordx4 v2, s[8:11], s24 offen offset:0 sc1 lds
  buffer_load_dwordx4 v2, s[8:11], s24 offen offset:1024 sc1 lds
  buffer_load_dwordx4 v2, s[8:11], s24 offen offset:2048 sc1 lds
  s_add_u32 s30, s34, 1
  s_mov_b32 s31, 28672
  s_lshl_b32 s24, s30, 1
  s_mul_i32 s24, s24, 14336
  s_add_u32 s24, s24, s23
  s_cmp_lt_u32 s30, s35
  s_cselect_b32 s24, s24, 0x10000000
  s_add_u32 m0, s31, s27
  s_nop 0
  buffer_load_dwordx4 v2, s[8:11], s24 offen offset:0 sc1 lds
  buffer_load_dwordx4 v2, s[8:11], s24 offen offset:1024 sc1 lds
  buffer_load_dwordx4 v2, s[8:11], s24 offen offset:2048 sc1 lds
  buffer_load_dwordx4 v2, s[8:11], s24 offen offset:3072 sc1 lds
  s_add_u32 m0, m0, 4096
  s_add_u32 s24, s24, 4096
  buffer_load_dwordx4 v2, s[8:11], s24 offen offset:0 sc1 lds
  buffer_load_dwordx4 v2, s[8:11], s24 offen offset:1024 sc1 lds
  buffer_load_dwordx4 v2, s[8:11], s24 offen offset:2048 sc1 lds
  s_mov_b32 s19, s34
  s_mov_b32 s32, 0
  s_mov_b32 s33, 57344
  s_waitcnt vmcnt(7)
  s_branch wg_vo_in
wg_vo_loop:
  s_waitcnt vmcnt(11)
wg_vo_in:
  s_barrier
  s_add_u32 s30, s19, 2
  s_lshl_b32 s24, s30, 1
  s_mul_i32 s24, s24, 14336
  s_add_u32 s24, s24, s23
  s_cmp_lt_u32 s30, s35
  s_cselect_b32 s24, s24, 0x10000000
  s_add_u32 m0, s33, s27
  s_nop 0
  buffer_load_dwordx4 v2, s[8:11], s24 offen offset:0 sc1 lds
  buffer_load_dwordx4 v2, s[8:11], s24 offen offset:1024 sc1 lds
  buffer_load_dwordx4 v2, s[8:11], s24 offen offset:2048 sc1 lds
  buffer_load_dwordx4 v2, s[8:11], s24 offen offset:3072 sc1 lds
  s_add_u32 m0, m0, 4096
  s_add_u32 s24, s24, 4096
  buffer_load_dwordx4 v2, s[8:11], s24 offen offset:0 sc1 lds
  buffer_load_dwordx4 v2, s[8:11], s24 offen offset:1024 sc1 lds
  buffer_load_dwordx4 v2, s[8:11], s24 offen offset:2048 sc1 lds
  v_add_u32 v5, s32, v2
  ds_read_b128 v[8:11], v5 offset:0
  ds_read_b128 v[12:15], v5 offset:14336
  ds_read_b128 v[16:19], v5 offset:1024
  ds_read_b128 v[20:23], v5 offset:15360
  ds_read_b128 v[24:27], v5 offset:2048
  ds_read_b128 v[28:31], v5 offset:16384
  ds_read_b128 v[32:35], v5 offset:3072
  s_waitcnt lgkmcnt(6)
  v_mfma_f32_16x16x32_bf16 v[40:43], a[0:3], v[8:11], 0
  v_mfma_f32_16x16x32_bf16 v[44:47], a[56:59], v[8:11], 0
  v_mfma_f32_16x16x32_bf16 v[48:51], a[112:115], v[8:11], 0
  v_mfma_f32_16x16x32_bf16 v[52:55], a[168:171], v[8:11], 0
  ds_read_b128 v[36:39], v5 offset:17408
  s_waitcnt lgkmcnt(6)
  v_mfma_f32_16x16x32_bf16 v[56:59], a[0:3], v[12:15], 0
  v_mfma_f32_16x16x32_bf16 v[60:63], a[56:59], v[12:15], 0
  v_mfma_f32_16x16x32_bf16 v[64:67], a[112:115], v[12:15], 0
  v_mfma_f32_16x16x32_bf16 v[68:71], a[168:171], v[12:15], 0
  ds_read_b128 v[8:11], v5 offset:4096
  s_waitcnt lgkmcnt(6)
  v_mfma_f32_16x16x32_bf16 v[40:43], a[4:7], v[16:19], v[40:43]
  v_mfma_f32_16x16x32_bf16 v[44:47], a[60:63], v[16:19], v[44:47]
  v_mfma_f32_16x16x32_bf16 v[48:51], a[116:119], v[16:19], v[48:51]
  v_mfma_f32_16x16x32_bf16 v[52:55], a[172:175], v[16:19], v[52:55]
  ds_read_b128 v[12:15], v5 offset:18432
  s_waitcnt lgkmcnt(6)
  v_mfma_f32_16x16x32_bf16 v[56:59], a[4:7], v[20:23], v[56:59]
  v_mfma_f32_16x16x32_bf16 v[60:63], a[60:63], v[20:23], v[60:63]
  v_mfma_f32_16x16x32_bf16 v[64:67], a[116:119], v[20:23], v[64:67]
  v_mfma_f32_16x16x32_bf16 v[68:71], a[172:175], v[20:23], v[68:71]
  ds_read_b128 v[16:19], v5 offset:5120
  s_waitcnt lgkmcnt(6)
  v_mfma_f32_16x16x32_bf16 v[40:43], a[8:11], v[24:27], v[40:43]
  v_mfma_f32_16x16x32_bf16 v[44:47], a[64:67], v[24:27], v[44:47]
  v_mfma_f32_16x16x32_bf16 v[48:51], a[120:123], v[24:27], v[48:51]
  v_mfma_f32_16x16x32_bf16 v[52:55], a[176:179], v[24:27], v[52:55]
  ds_read_b128 v[20:23], v5 offset:19456
  s_waitcnt lgkmcnt(6)
  v_mfma_f32_16x16x32_bf16 v[56:59], a[8:11], v[28:31], v[56:59]
  v_mfma_f32_16x16x32_bf16 v[60:63], a[64:67], v[28:31], v[60:63]
  v_mfma_f32_16x16x32_bf16 v[64:67], a[120:123], v[28:31], v[64:67]
  v_mfma_f32_16x16x32_bf16 v[68:71], a[176:179], v[28:31], v[68:71]
  ds_read_b128 v[24:27], v5 offset:6144
  s_waitcnt lgkmcnt(6)
  v_mfma_f32_16x16x32_bf16 v[40:43], a[12:15], v[32:35], v[40:43]
  v_mfma_f32_16x16x32_bf16 v[44:47], a[68:71], v[32:35], v[44:47]
  v_mfma_f32_16x16x32_bf16 v[48:51], a[124:127], v[32:35], v[48:51]
  v_mfma_f32_16x16x32_bf16 v[52:55], a[180:183], v[32:35], v[52:55]
  ds_read_b128 v[28:31], v5 offset:20480
  s_waitcnt lgkmcnt(6)
  v_mfma_f32_16x16x32_bf16 v[56:59], a[12:15], v[36:39], v[56:59]
  v_mfma_f32_16x16x32_bf16 v[60:63], a[68:71], v[36:39], v[60:63]
  v_mfma_f32_16x16x32_bf16 v[64:67], a[124:127], v[36:39], v[64:67]
  v_mfma_f32_16x16x32_bf16 v[68:71], a[180:183], v[36:39], v[68:71]
  ds_read_b128 v[32:35], v5 offset:7168
  s_waitcnt lgkmcnt(6)
  v_mfma_f32_16x16x32_bf16 v[40:43], a[16:19], v[8:11], v[40:43]
  v_mfma_f32_16x16x32_bf16 v[44:47], a[72:75], v[8:11], v[44:47]
  v_mfma_f32_16x16x32_bf16 v[48:51], a[128:131], v[8:11], v[48:51]
  v_mfma_f32_16x16x32_bf16 v[52:55], a[184:187], v[8:11], v[52:55]
  ds_read_b128 v[36:39], v5 offset:21504
  s_waitcnt lgkmcnt(6)
  v_mfma_f32_16x16x32_bf16 v[56:59], a[16:19], v[12:15], v[56:59]
  v_mfma_f32_16x16x32_bf16 v[60:63], a[72:75], v[12:15], v[60:63]
  v_mfma_f32_16x16x32_bf16 v[64:67], a[128:131], v[12:15], v[64:67]
  v_mfma_f32_16x16x32_bf16 v[68:71], a[184:187], v[12:15], v[68:71]
  ds_read_b128 v[8:11], v5 offset:8192
  s_waitcnt lgkmcnt(6)
  v_mfma_f32_16x16x32_bf16 v[40:43], a[20:23], v[16:19], v[40:43]
  v_mfma_f32_16x16x32_bf16 v[44:47], a[76:79], v[16:19], v[44:47]
  v_mfma_f32_16x16x32_bf16 v[48:51], a[132:135], v[16:19], v[48:51]
  v_mfma_f32_16x16x32_bf16 v[52:55], a[188:191], v[16:19], v[52:55]
  ds_read_b128 v[12:15], v5 offset:22528
  s_waitcnt lgkmcnt(6)
  v_mfma_f32_16x16x32_bf16 v[56:59], a[20:23], v[20:23], v[56:59]
  v_mfma_f32_16x16x32_bf16 v[60:63], a[76:79], v[20:23], v[60:63]
  v_mfma_f32_16x16x32_bf16 v[64:67], a[132:135], v[20:23], v[64:67]
  v_mfma_f32_16x16x32_bf16 v[68:71], a[188:191], v[20:23], v[68:71]
  ds_read_b128 v[16:19], v5 offset:9216
  s_waitcnt lgkmcnt(6)
  v_mfma_f32_16x16x32_bf16 v[40:43], a[24:27], v[24:27], v[40:43]
  v_mfma_f32_16x16x32_bf16 v[44:47], a[80:83], v[24:27], v[44:47]
  v_mfma_f32_16x16x32_bf16 v[48:51], a[136:139], v[24:27], v[48:51]
  v_mfma_f32_16x16x32_bf16 v[52:55], a[192:195], v[24:27], v[52:55]
  ds_read_b128 v[20:23], v5 offset:23552
  s_waitcnt lgkmcnt(6)
  v_mfma_f32_16x16x32_bf16 v[56:59], a[24:27], v[28:31], v[56:59]
  v_mfma_f32_16x16x32_bf16 v[60:63], a[80:83], v[28:31], v[60:63]
  v_mfma_f32_16x16x32_bf16 v[64:67], a[136:139], v[28:31], v[64:67]
  v_mfma_f32_16x16x32_bf16 v[68:71], a[192:195], v[28:31], v[68:71]
  ds_read_b128 v[24:27], v5 offset:10240
  s_waitcnt lgkmcnt(6)
  v_mfma_f32_16x16x32_bf16 v[40:43], a[28:31], v[32:35], v[40:43]
  v_mfma_f32_16x16x32_bf16 v[44:47], a[84:87], v[32:35], v[44:47]
  v_mfma_f32_16x16x32_bf16 v[48:51], a[140:143], v[32:35], v[48:51]
  v_mfma_f32_16x16x32_bf16 v[52:55], a[196:199], v[32:35], v[52:55]
  ds_read_b128 v[28:31], v5 offset:24576
  s_waitcnt lgkmcnt(6)
  v_mfma_f32_16x16x32_bf16 v[56:59], a[28:31], v[36:39], v[56:59]
  v_mfma_f32_16x16x32_bf16 v[60:63], a[84:87], v[36:39], v[60:63]
  v_mfma_f32_16x16x32_bf16 v[64:67], a[140:143], v[36:39], v[64:67]
  v_mfma_f32_16x16x32_bf16 v[68:71], a[196:199], v[36:39], v[68:71]
  ds_read_b128 v[32:35], v5 offset:11264
  s_waitcnt lgkmcnt(6)
  v_mfma_f32_16x16x32_bf16 v[40:43], a[32:35], v[8:11], v[40:43]
  v_mfma_f32_16x16x32_bf16 v[44:47], a[88:91], v[8:11], v[44:47]
  v_mfma_f32_16x16x32_bf16 v[48:51], a[144:147], v[8:11], v[48:51]
  v_mfma_f32_16x16x32_bf16 v[52:55], a[200:203], v[8:11], v[52:55]
  ds_read_b128 v[36:39], v5 offset:25600
  s_waitcnt lgkmcnt(6)
  v_mfma_f32_16x16x32_bf16 v[56:59], a[32:35], v[12:15], v[56:59]
  v_mfma_f32_16x16x32_bf16 v[60:63], a[88:91], v[12:15], v[60:63]
  v_mfma_f32_16x16x32_bf16 v[64:67], a[144:147], v[12:15], v[64:67]
  v_mfma_f32_16x16x32_bf16 v[68:71], a[200:203], v[12:15], v[68:71]
  ds_read_b128 v[8:11], v5 offset:12288
  s_waitcnt lgkmcnt(6)
  v_mfma_f32_16x16x32_bf16 v[40:43], a[36:39], v[16:19], v[40:43]
  v_mfma_f32_16x16x32_bf16 v[44:47], a[92:95], v[16:19], v[44:47]
  v_mfma_f32_16x16x32_bf16 v[48:51], a[148:151], v[16:19], v[48:51]
  v_mfma_f32_16x16x32_bf16 v[52:55], a[204:207], v[16:19], v[52:55]
  ds_read_b128 v[12:15], v5 offset:26624
  s_waitcnt lgkmcnt(6)
  v_mfma_f32_16x16x32_bf16 v[56:59], a[36:39], v[20:23], v[56:59]
  v_mfma_f32_16x16x32_bf16 v[60:63], a[92:95], v[20:23], v[60:63]
  v_mfma_f32_16x16x32_bf16 v[64:67], a[148:151], v[20:23], v[64:67]
  v_mfma_f32_16x16x32_bf16 v[68:71], a[204:207], v[20:23], v[68:71]
  ds_read_b128 v[16:19], v5 offset:13312
  s_waitcnt lgkmcnt(6)
  v_mfma_f32_16x16x32_bf16 v[40:43], a[40:43], v[24:27], v[40:43]
  v_mfma_f32_16x16x32_bf16 v[44:47], a[96:99], v[24:27], v[44:47]
  v_mfma_f32_16x16x32_bf16 v[48:51], a[152:155], v[24:27], v[48:51]
  v_mfma_f32_16x16x32_bf16 v[52:55], a[208:211], v[24:27], v[52:55]
  ds_read_b128 v[20:23], v5 offset:27648
  s_waitcnt lgkmcnt(6)
  v_mfma_f32_16x16x32_bf16 v[56:59], a[40:43], v[28:31], v[56:59]
  v_mfma_f32_16x16x32_bf16 v[60:63], a[96:99], v[28:31], v[60:63]
  v_mfma_f32_16x16x32_bf16 v[64:67], a[152:155], v[28:31], v[64:67]
  v_mfma_f32_16x16x32_bf16 v[68:71], a[208:211], v[28:31], v[68:71]
  s_waitcnt lgkmcnt(5)
  v_mfma_f32_16x16x32_bf16 v[40:43], a[44:47], v[32:35], v[40:43]
  v_mfma_f32_16x16x32_bf16 v[44:47], a[100:103], v[32:35], v[44:47]
  v_mfma_f32_16x16x32_bf16 v[48:51], a[156:159], v[32:35], v[48:51]
  v_mfma_f32_16x16x32_bf16 v[52:55], a[212:215], v[32:35], v[52:55]
  s_waitcnt lgkmcnt(4)
  v_mfma_f32_16x16x32_bf16 v[56:59], a[44:47], v[36:39], v[56:59]
  v_mfma_f32_16x16x32_bf16 v[60:63], a[100:103], v[36:39], v[60:63]
  v_mfma_f32_16x16x32_bf16 v[64:67], a[156:159], v[36:39], v[64:67]
  v_mfma_f32_16x16x32_bf16 v[68:71], a[212:215], v[36:39], v[68:71]
  s_waitcnt lgkmcnt(3)
  v_mfma_f32_16x16x32_bf16 v[40:43], a[48:51], v[8:11], v[40:43]
  v_mfma_f32_16x16x32_bf16 v[44:47], a[104:107], v[8:11], v[44:47]
  v_mfma_f32_16x16x32_bf16 v[48:51], a[160:163], v[8:11], v[48:51]
  v_mfma_f32_16x16x32_bf16 v[52:55], a[216:219], v[8:11], v[52:55]
  s_waitcnt lgkmcnt(2)
  v_mfma_f32_16x16x32_bf16 v[56:59], a[48:51], v[12:15], v[56:59]
  v_mfma_f32_16x16x32_bf16 v[60:63], a[104:107], v[12:15], v[60:63]
  v_mfma_f32_16x16x32_bf16 v[64:67], a[160:163], v[12:15], v[64:67]
  v_mfma_f32_16x16x32_bf16 v[68:71], a[216:219], v[12:15], v[68:71]
  s_waitcnt lgkmcnt(1)
  v_mfma_f32_16x16x32_bf16 v[40:43], a[52:55], v[16:19], v[40:43]
  v_mfma_f32_16x16x32_bf16 v[44:47], a[108:111], v[16:19], v[44:47]
  v_mfma_f32_16x16x32_bf16 v[48:51], a[164:167], v[16:19], v[48:51]
  v_mfma_f32_16x16x32_bf16 v[52:55], a[220:223], v[16:19], v[52:55]
  s_waitcnt lgkmcnt(0)
  v_mfma_f32_16x16x32_bf16 v[56:59], a[52:55], v[20:23], v[56:59]
  v_mfma_f32_16x16x32_bf16 v[60:63], a[108:111], v[20:23], v[60:63]
  v_mfma_f32_16x16x32_bf16 v[64:67], a[164:167], v[20:23], v[64:67]
  v_mfma_f32_16x16x32_bf16 v[68:71], a[220:223], v[20:23], v[68:71]
  s_add_u32 s25, s29, 28672
  s_lshl_b32 s24, s19, 5
  s_add_u32 s24, s24, 0
  v_add_u32 v88, s24, v4
  s_cmp_lt_u32 s19, 8
  s_cselect_b64 vcc, -1, 0
  s_cselect_b32 s24, 0, 256
  v_subrev_u32 v88, s24, v88
  s_movk_i32 s24, 5462
  s_cselect_b32 s24, 4096, s24
  v_mul_u32_u24 v89, s24, v88
  v_lshrrev_b32 v89, 16, v89
  s_movk_i32 s24, 100
  s_cselect_b32 s24, 96, s24
  v_mul_u32_u24 v89, s24, v89
  v_cndmask_b32 v92, v7, v6, vcc
  v_add3_u32 v88, v88, v89, v92
  v_lshlrev_b32 v90, 4, v88
  v_cvt_pk_bf16_f32 v72, v40, v41
  v_cvt_pk_bf16_f32 v73, v42, v43
  v_cvt_pk_bf16_f32 v74, v44, v45
  v_cvt_pk_bf16_f32 v75, v46, v47
  buffer_store_dwordx4 v[72:75], v90, s[8:11], s29 offen sc1
  v_cvt_pk_bf16_f32 v76, v48, v49
  v_cvt_pk_bf16_f32 v77, v50, v51
  v_cvt_pk_bf16_f32 v78, v52, v53
  v_cvt_pk_bf16_f32 v79, v54, v55
  buffer_store_dwordx4 v[76:79], v90, s[8:11], s25 offen sc1
  s_lshl_b32 s24, s19, 5
  s_add_u32 s24, s24, 16
  v_add_u32 v88, s24, v4
  s_cmp_lt_u32 s19, 8
  s_cselect_b64 vcc, -1, 0
  s_cselect_b32 s24, 0, 256
  v_subrev_u32 v88, s24, v88
  s_movk_i32 s24, 5462
  s_cselect_b32 s24, 4096, s24
  v_mul_u32_u24 v89, s24, v88
  v_lshrrev_b32 v89, 16, v89
  s_movk_i32 s24, 100
  s_cselect_b32 s24, 96, s24
  v_mul_u32_u24 v89, s24, v89
  v_cndmask_b32 v92, v7, v6, vcc
  v_add3_u32 v88, v88, v89, v92
  v_lshlrev_b32 v91, 4, v88
  v_cvt_pk_bf16_f32 v80, v56, v57
  v_cvt_pk_bf16_f32 v81, v58, v59
  v_cvt_pk_bf16_f32 v82, v60, v61
  v_cvt_pk_bf16_f32 v83, v62, v63
  buffer_store_dwordx4 v[80:83], v91, s[8:11], s29 offen sc1
  v_cvt_pk_bf16_f32 v84, v64, v65
  v_cvt_pk_bf16_f32 v85, v66, v67
  v_cvt_pk_bf16_f32 v86, v68, v69
  v_cvt_pk_bf16_f32 v87, v70, v71
  buffer_store_dwordx4 v[84:87], v91, s[8:11], s25 offen sc1
  s_mov_b32 s33, s32
  s_add_u32 s32, s32, 28672
  s_cmp_eq_u32 s32, 86016
  s_cselect_b32 s32, 0, s32
  s_add_u32 s19, s19, 1
  s_cmp_lt_u32 s19, s35
  s_cbranch_scc1 wg_vo_loop
  s_branch wg_done
wg_done:
  s_lshl_b32 s20, s18, 4
  s_and_b32 s21, s17, 15
  s_add_u32 s20, s20, s21
  s_lshl_b32 s20, s20, 7
  s_cmp_lt_u32 s17, 16
  s_cselect_b32 s21, 16384, 0
  s_add_u32 s20, s20, s21
  s_add_u32 s20, s20, 88541184
  s_sub_u32 s21, s35, s34
  v_mov_b32 v5, s21
  v_mov_b32 v6, 0
  s_waitcnt vmcnt(0)
  s_mov_b64 exec, 1
  buffer_atomic_add v5, v6, s[8:11], s20 offen
  s_mov_b64 exec, -1
  s_branch wk_loop
wk_a:
  s_load_dwordx8 s[36:43], s[0:1], 56
  s_load_dwordx4 s[44:47], s[0:1], 88
  s_sub_u32 s3, s3, 432
  s_and_b32 s17, s3, 15
  s_lshr_b32 s19, s3, 5
  s_bitcmp1_b32 s3, 4
  s_cselect_b32 s31, 7, 0
  s_waitcnt lgkmcnt(0)
  s_mov_b32 s60, s40
  s_and_b32 s61, s41, 0xffff
  s_mov_b32 s62, 3670016
  s_mov_b32 s63, 0x20000
  s_mov_b32 s56, s42
  s_and_b32 s57, s43, 0xffff
  s_mov_b32 s58, 3670016
  s_mov_b32 s59, 0x20000
  s_lshl_b32 s30, s16, 13
  s_lshl_b32 s27, s19, 19
  s_lshl_b32 s29, s16, 17
  s_add_u32 s27, s27, s29
  s_lshl_b32 s29, s17, 9
  s_add_u32 s27, s27, s29
  v_lshrrev_b32 v5, 5, v1
  v_and_b32 v6, 31, v1
  v_xor_b32 v6, v6, v5
  v_lshlrev_b32 v6, 4, v6
  v_lshl_add_u32 v6, v5, 13, v6
  s_add_u32 m0, s30, 0
  s_add_u32 s22, s27, 0
  v_xor_b32 v7, 0, v6
  buffer_load_dwordx4 v7, s[56:59], s22 offen offset:0 lds
  s_add_u32 s22, s27, 15360
  v_xor_b32 v7, 32, v6
  buffer_load_dwordx4 v7, s[56:59], s22 offen offset:1024 lds
  s_add_u32 s22, s27, 30720
  v_xor_b32 v7, 64, v6
  buffer_load_dwordx4 v7, s[56:59], s22 offen offset:2048 lds
  s_add_u32 s22, s27, 46080
  v_xor_b32 v7, 96, v6
  buffer_load_dwordx4 v7, s[56:59], s22 offen offset:3072 lds
  s_add_u32 m0, s30, 4096
  s_add_u32 s22, s27, 65536
  v_xor_b32 v7, 128, v6
  buffer_load_dwordx4 v7, s[56:59], s22 offen offset:0 lds
  s_add_u32 s22, s27, 80896
  v_xor_b32 v7, 160, v6
  buffer_load_dwordx4 v7, s[56:59], s22 offen offset:1024 lds
  s_add_u32 s22, s27, 96256
  v_xor_b32 v7, 192, v6
  buffer_load_dwordx4 v7, s[56:59], s22 offen offset:2048 lds
  s_add_u32 s22, s27, 111616
  v_xor_b32 v7, 224, v6
  buffer_load_dwordx4 v7, s[56:59], s22 offen offset:3072 lds
  v_lshrrev_b32 v5, 5, v1
  v_and_b32 v6, 31, v1
  s_lshl_b32 s25, s16, 15
  s_add_u32 s25, s25, 32768
  s_lshl_b32 s26, s17, 9
  s_add_u32 s28, s19, s16
  s_cmp_ge_u32 s28, 7
  s_cselect_b32 s20, 7, 0
  s_sub_u32 s28, s28, s20
  s_add_u32 s28, s28, s31
  s_add_u32 s29, s19, s16
  s_add_u32 s29, s29, 4
  s_cmp_ge_u32 s29, 7
  s_cselect_b32 s20, 7, 0
  s_sub_u32 s29, s29, s20
  s_add_u32 s29, s29, s31
  s_lshl_b32 s32, s28, 18
  s_add_u32 s32, s32, s26
  s_lshl_b32 s33, s29, 18
  s_add_u32 s33, s33, s26
  v_xor_b32 v8, v6, v5
  v_lshlrev_b32 v8, 4, v8
  v_lshl_add_u32 v8, v5, 13, v8
  v_xor_b32 v12, 0, v8
  v_xor_b32 v13, 32, v8
  v_add_u32 v13, 15360, v13
  v_xor_b32 v14, 0, v8
  v_add_u32 v14, 30720, v14
  v_xor_b32 v15, 32, v8
  v_add_u32 v15, 46080, v15
  s_add_u32 s20, s16, 0
  s_and_b32 s20, s20, 3
  s_mul_i32 s21, s20, 65600
  s_lshl_b32 s20, s20, 12
  s_add_u32 s48, s20, s25
  s_mov_b32 m0, s48
  v_xor_b32 v16, s21, v12
  buffer_load_dwordx4 v16, s[60:63], s32 offen offset:0 lds
  v_xor_b32 v17, s21, v13
  buffer_load_dwordx4 v17, s[60:63], s32 offen offset:1024 lds
  v_xor_b32 v18, s21, v14
  buffer_load_dwordx4 v18, s[60:63], s32 offen offset:2048 lds
  v_xor_b32 v19, s21, v15
  buffer_load_dwordx4 v19, s[60:63], s32 offen offset:3072 lds
  s_add_u32 s20, s16, 1
  s_and_b32 s20, s20, 3
  s_mul_i32 s21, s20, 65600
  s_lshl_b32 s20, s20, 12
  s_add_u32 s49, s20, s25
  s_mov_b32 m0, s49
  v_xor_b32 v20, s21, v12
  buffer_load_dwordx4 v20, s[60:63], s32 offen offset:0 lds
  v_xor_b32 v21, s21, v13
  buffer_load_dwordx4 v21, s[60:63], s32 offen offset:1024 lds
  v_xor_b32 v22, s21, v14
  buffer_load_dwordx4 v22, s[60:63], s32 offen offset:2048 lds
  v_xor_b32 v23, s21, v15
  buffer_load_dwordx4 v23, s[60:63], s32 offen offset:3072 lds
  s_add_u32 s20, s16, 2
  s_and_b32 s20, s20, 3
  s_mul_i32 s21, s20, 65600
  s_lshl_b32 s20, s20, 12
  s_add_u32 s50, s20, s25
  s_mov_b32 m0, s50
  v_xor_b32 v24, s21, v12
  buffer_load_dwordx4 v24, s[60:63], s32 offen offset:0 lds
  v_xor_b32 v25, s21, v13
  buffer_load_dwordx4 v25, s[60:63], s32 offen offset:1024 lds
  v_xor_b32 v26, s21, v14
  buffer_load_dwordx4 v26, s[60:63], s32 offen offset:2048 lds
  v_xor_b32 v27, s21, v15
  buffer_load_dwordx4 v27, s[60:63], s32 offen offset:3072 lds
  s_add_u32 s20, s16, 3
  s_and_b32 s20, s20, 3
  s_mul_i32 s21, s20, 65600
  s_lshl_b32 s20, s20, 12
  s_add_u32 s51, s20, s25
  s_mov_b32 m0, s51
  v_xor_b32 v28, s21, v12
  buffer_load_dwordx4 v28, s[60:63], s32 offen offset:0 lds
  v_xor_b32 v29, s21, v13
  buffer_load_dwordx4 v29, s[60:63], s32 offen offset:1024 lds
  v_xor_b32 v30, s21, v14
  buffer_load_dwordx4 v30, s[60:63], s32 offen offset:2048 lds
  v_xor_b32 v31, s21, v15
  buffer_load_dwordx4 v31, s[60:63], s32 offen offset:3072 lds
  s_mul_i32 s30, s17, 401408
  s_mul_i32 s20, s19, 57344
  s_add_u32 s30, s30, s20
  v_add_u32 v12, s30, v2
  v_add_u32 v13, 14336, v12
  v_add_u32 v14, 28672, v12
  v_add_u32 v15, 43008, v12
  v_lshrrev_b32 v7, 2, v4
  v_lshlrev_b32 v7, 3, v7
  v_and_b32 v8, 3, v4
  v_add_u32 v7, v7, v8
  v_xor_b32 v10, v3, v4
  v_lshlrev_b32 v10, 4, v10
  v_lshl_add_u32 v10, v7, 9, v10
  v_add_u32 v10, s25, v10
  v_xor_b32 v32, 0, v10
  v_xor_b32 v33, 64, v10
  v_xor_b32 v34, 128, v10
  v_xor_b32 v35, 192, v10
  v_and_b32 v8, 2, v4
  v_lshlrev_b32 v8, 1, v8
  v_and_b32 v9, 1, v4
  v_add_u32 v8, v8, v9
  v_lshrrev_b32 v7, 2, v4
  v_lshl_add_u32 v7, v7, 4, v8
  v_xor_b32 v8, v8, v3
  v_lshlrev_b32 v8, 4, v8
  v_lshl_add_u32 v7, v7, 9, v8
  s_mov_b32 s24, 1035512379
  s_waitcnt vmcnt(16)
  s_barrier
  s_cmp_eq_u32 s16, 3
  s_cbranch_scc1 aj_np0
  s_add_u32 m0, s48, 16384
  s_nop 0
  buffer_load_dwordx4 v16, s[60:63], s33 offen offset:0 lds
  buffer_load_dwordx4 v17, s[60:63], s33 offen offset:1024 lds
  buffer_load_dwordx4 v18, s[60:63], s33 offen offset:2048 lds
  buffer_load_dwordx4 v19, s[60:63], s33 offen offset:3072 lds
aj_np0:
  v_xor_b32 v8, 0, v7
  ds_read_b128 v[128:131], v8 offset:0
  v_xor_b32 v9, 64, v7
  ds_read_b128 v[132:135], v9 offset:0
  v_xor_b32 v10, 128, v7
  ds_read_b128 v[136:139], v10 offset:0
  v_xor_b32 v11, 192, v7
  ds_read_b128 v[140:143], v11 offset:0
  ds_read_b128 v[144:147], v8 offset:256
  ds_read_b128 v[148:151], v9 offset:256
  ds_read_b128 v[152:155], v10 offset:256
  ds_read_b128 v[156:159], v11 offset:256
  s_waitcnt lgkmcnt(4)
  s_cmp_eq_u32 s16, 3
  s_cbranch_scc1 aj_np1
  s_add_u32 m0, s49, 16384
  s_nop 0
  buffer_load_dwordx4 v20, s[60:63], s33 offen offset:0 lds
  buffer_load_dwordx4 v21, s[60:63], s33 offen offset:1024 lds
  buffer_load_dwordx4 v22, s[60:63], s33 offen offset:2048 lds
  buffer_load_dwordx4 v23, s[60:63], s33 offen offset:3072 lds
aj_np1:
  v_xor_b32 v8, 32, v7
  ds_read_b128 v[160:163], v8 offset:1024
  v_xor_b32 v9, 96, v7
  ds_read_b128 v[164:167], v9 offset:1024
  v_xor_b32 v10, 160, v7
  ds_read_b128 v[168:171], v10 offset:1024
  v_xor_b32 v11, 224, v7
  ds_read_b128 v[172:175], v11 offset:1024
  ds_read_b128 v[176:179], v8 offset:1280
  ds_read_b128 v[180:183], v9 offset:1280
  ds_read_b128 v[184:187], v10 offset:1280
  ds_read_b128 v[188:191], v11 offset:1280
  s_waitcnt lgkmcnt(4)
  s_cmp_eq_u32 s16, 3
  s_cbranch_scc1 aj_np2
  s_add_u32 m0, s50, 16384
  s_nop 0
  buffer_load_dwordx4 v24, s[60:63], s33 offen offset:0 lds
  buffer_load_dwordx4 v25, s[60:63], s33 offen offset:1024 lds
  buffer_load_dwordx4 v26, s[60:63], s33 offen offset:2048 lds
  buffer_load_dwordx4 v27, s[60:63], s33 offen offset:3072 lds
aj_np2:
  v_xor_b32 v8, 128, v7
  ds_read_b128 v[192:195], v8 offset:4096
  v_xor_b32 v9, 192, v7
  ds_read_b128 v[196:199], v9 offset:4096
  v_xor_b32 v10, 0, v7
  ds_read_b128 v[200:203], v10 offset:4096
  v_xor_b32 v11, 64, v7
  ds_read_b128 v[204:207], v11 offset:4096
  ds_read_b128 v[208:211], v8 offset:4352
  ds_read_b128 v[212:215], v9 offset:4352
  ds_read_b128 v[216:219], v10 offset:4352
  ds_read_b128 v[220:223], v11 offset:4352
  s_waitcnt lgkmcnt(4)
  s_cmp_eq_u32 s16, 3
  s_cbranch_scc1 aj_np3
  s_add_u32 m0, s51, 16384
  s_nop 0
  buffer_load_dwordx4 v28, s[60:63], s33 offen offset:0 lds
  buffer_load_dwordx4 v29, s[60:63], s33 offen offset:1024 lds
  buffer_load_dwordx4 v30, s[60:63], s33 offen offset:2048 lds
  buffer_load_dwordx4 v31, s[60:63], s33 offen offset:3072 lds
aj_np3:
  v_xor_b32 v8, 160, v7
  ds_read_b128 v[224:227], v8 offset:5120
  v_xor_b32 v9, 224, v7
  ds_read_b128 v[228:231], v9 offset:5120
  v_xor_b32 v10, 32, v7
  ds_read_b128 v[232:235], v10 offset:5120
  v_xor_b32 v11, 96, v7
  ds_read_b128 v[236:239], v11 offset:5120
  ds_read_b128 v[240:243], v8 offset:5376
  ds_read_b128 v[244:247], v9 offset:5376
  ds_read_b128 v[248:251], v10 offset:5376
  ds_read_b128 v[252:255], v11 offset:5376
  s_waitcnt lgkmcnt(4)
  s_waitcnt vmcnt(16) lgkmcnt(0)
  s_cmp_lg_u32 s16, 3
  s_cbranch_scc1 w3_39
  s_waitcnt vmcnt(0)
w3_39:
  ds_read_b128 v[52:55], v32 offset:0
  ds_read_b128 v[56:59], v33 offset:0
  ds_read_b128 v[60:63], v34 offset:0
  ds_read_b128 v[64:67], v35 offset:0
  s_waitcnt lgkmcnt(3)
  v_mfma_f32_16x16x32_bf16 v[96:99], v[52:55], v[128:131], 0
  v_mfma_f32_16x16x32_bf16 v[100:103], v[52:55], v[160:163], 0
  v_mfma_f32_16x16x32_bf16 v[104:107], v[52:55], v[192:195], 0
  v_mfma_f32_16x16x32_bf16 v[108:111], v[52:55], v[224:227], 0
  ds_read_b128 v[52:55], v32 offset:256
  s_waitcnt lgkmcnt(3)
  v_mfma_f32_16x16x32_bf16 v[96:99], v[56:59], v[132:135], v[96:99]
  v_mfma_f32_16x16x32_bf16 v[100:103], v[56:59], v[164:167], v[100:103]
  v_mfma_f32_16x16x32_bf16 v[104:107], v[56:59], v[196:199], v[104:107]
  v_mfma_f32_16x16x32_bf16 v[108:111], v[56:59], v[228:231], v[108:111]
  ds_read_b128 v[56:59], v33 offset:256
  s_waitcnt lgkmcnt(3)
  v_mfma_f32_16x16x32_bf16 v[96:99], v[60:63], v[136:139], v[96:99]
  v_mfma_f32_16x16x32_bf16 v[100:103], v[60:63], v[168:171], v[100:103]
  v_mfma_f32_16x16x32_bf16 v[104:107], v[60:63], v[200:203], v[104:107]
  v_mfma_f32_16x16x32_bf16 v[108:111], v[60:63], v[232:235], v[108:111]
  ds_read_b128 v[60:63], v34 offset:256
  s_waitcnt lgkmcnt(3)
  v_mfma_f32_16x16x32_bf16 v[96:99], v[64:67], v[140:143], v[96:99]
  v_mfma_f32_16x16x32_bf16 v[100:103], v[64:67], v[172:175], v[100:103]
  v_mfma_f32_16x16x32_bf16 v[104:107], v[64:67], v[204:207], v[104:107]
  v_mfma_f32_16x16x32_bf16 v[108:111], v[64:67], v[236:239], v[108:111]
  ds_read_b128 v[64:67], v35 offset:256
  s_waitcnt lgkmcnt(3)
  v_mfma_f32_16x16x32_bf16 v[96:99], v[52:55], v[144:147], v[96:99]
  v_mfma_f32_16x16x32_bf16 v[100:103], v[52:55], v[176:179], v[100:103]
  v_mfma_f32_16x16x32_bf16 v[104:107], v[52:55], v[208:211], v[104:107]
  v_mfma_f32_16x16x32_bf16 v[108:111], v[52:55], v[240:243], v[108:111]
  ds_read_b128 v[52:55], v32 offset:2048
  s_waitcnt lgkmcnt(3)
  v_mfma_f32_16x16x32_bf16 v[96:99], v[56:59], v[148:151], v[96:99]
  v_mfma_f32_16x16x32_bf16 v[100:103], v[56:59], v[180:183], v[100:103]
  v_mfma_f32_16x16x32_bf16 v[104:107], v[56:59], v[212:215], v[104:107]
  v_mfma_f32_16x16x32_bf16 v[108:111], v[56:59], v[244:247], v[108:111]
  ds_read_b128 v[56:59], v33 offset:2048
  s_waitcnt lgkmcnt(3)
  v_mfma_f32_16x16x32_bf16 v[96:99], v[60:63], v[152:155], v[96:99]
  v_mfma_f32_16x16x32_bf16 v[100:103], v[60:63], v[184:187], v[100:103]
  v_mfma_f32_16x16x32_bf16 v[104:107], v[60:63], v[216:219], v[104:107]
  v_mfma_f32_16x16x32_bf16 v[108:111], v[60:63], v[248:251], v[108:111]
  ds_read_b128 v[60:63], v34 offset:2048
  s_waitcnt lgkmcnt(3)
  v_mfma_f32_16x16x32_bf16 v[96:99], v[64:67], v[156:159], v[96:99]
  v_mfma_f32_16x16x32_bf16 v[100:103], v[64:67], v[188:191], v[100:103]
  v_mfma_f32_16x16x32_bf16 v[104:107], v[64:67], v[220:223], v[104:107]
  v_mfma_f32_16x16x32_bf16 v[108:111], v[64:67], v[252:255], v[108:111]
  ds_read_b128 v[64:67], v35 offset:2048
  s_waitcnt lgkmcnt(3)
  v_mfma_f32_16x16x32_bf16 v[112:115], v[52:55], v[128:131], 0
  v_mfma_f32_16x16x32_bf16 v[116:119], v[52:55], v[160:163], 0
  v_mfma_f32_16x16x32_bf16 v[120:123], v[52:55], v[192:195], 0
  v_mfma_f32_16x16x32_bf16 v[124:127], v[52:55], v[224:227], 0
  ds_read_b128 v[52:55], v32 offset:2304
  s_waitcnt lgkmcnt(3)
  v_mfma_f32_16x16x32_bf16 v[112:115], v[56:59], v[132:135], v[112:115]
  v_mfma_f32_16x16x32_bf16 v[116:119], v[56:59], v[164:167], v[116:119]
  v_mfma_f32_16x16x32_bf16 v[120:123], v[56:59], v[196:199], v[120:123]
  v_mfma_f32_16x16x32_bf16 v[124:127], v[56:59], v[228:231], v[124:127]
  ds_read_b128 v[56:59], v33 offset:2304
  s_waitcnt lgkmcnt(3)
  v_mfma_f32_16x16x32_bf16 v[112:115], v[60:63], v[136:139], v[112:115]
  v_mfma_f32_16x16x32_bf16 v[116:119], v[60:63], v[168:171], v[116:119]
  v_mfma_f32_16x16x32_bf16 v[120:123], v[60:63], v[200:203], v[120:123]
  v_mfma_f32_16x16x32_bf16 v[124:127], v[60:63], v[232:235], v[124:127]
  ds_read_b128 v[60:63], v34 offset:2304
  s_waitcnt lgkmcnt(3)
  v_mfma_f32_16x16x32_bf16 v[112:115], v[64:67], v[140:143], v[112:115]
  v_mfma_f32_16x16x32_bf16 v[116:119], v[64:67], v[172:175], v[116:119]
  v_mfma_f32_16x16x32_bf16 v[120:123], v[64:67], v[204:207], v[120:123]
  v_mfma_f32_16x16x32_bf16 v[124:127], v[64:67], v[236:239], v[124:127]
  ds_read_b128 v[64:67], v35 offset:2304
  s_waitcnt lgkmcnt(3)
  v_mfma_f32_16x16x32_bf16 v[112:115], v[52:55], v[144:147], v[112:115]
  v_mfma_f32_16x16x32_bf16 v[116:119], v[52:55], v[176:179], v[116:119]
  v_mfma_f32_16x16x32_bf16 v[120:123], v[52:55], v[208:211], v[120:123]
  v_mfma_f32_16x16x32_bf16 v[124:127], v[52:55], v[240:243], v[124:127]
  s_waitcnt lgkmcnt(2)
  v_mfma_f32_16x16x32_bf16 v[112:115], v[56:59], v[148:151], v[112:115]
  v_mfma_f32_16x16x32_bf16 v[116:119], v[56:59], v[180:183], v[116:119]
  v_mfma_f32_16x16x32_bf16 v[120:123], v[56:59], v[212:215], v[120:123]
  v_mfma_f32_16x16x32_bf16 v[124:127], v[56:59], v[244:247], v[124:127]
  s_waitcnt lgkmcnt(1)
  v_mfma_f32_16x16x32_bf16 v[112:115], v[60:63], v[152:155], v[112:115]
  v_mfma_f32_16x16x32_bf16 v[116:119], v[60:63], v[184:187], v[116:119]
  v_mfma_f32_16x16x32_bf16 v[120:123], v[60:63], v[216:219], v[120:123]
  v_mfma_f32_16x16x32_bf16 v[124:127], v[60:63], v[248:251], v[124:127]
  s_waitcnt lgkmcnt(0)
  v_mfma_f32_16x16x32_bf16 v[112:115], v[64:67], v[156:159], v[112:115]
  v_mfma_f32_16x16x32_bf16 v[116:119], v[64:67], v[188:191], v[116:119]
  v_mfma_f32_16x16x32_bf16 v[120:123], v[64:67], v[220:223], v[120:123]
  v_mfma_f32_16x16x32_bf16 v[124:127], v[64:67], v[252:255], v[124:127]
  s_lshl_b32 s30, s28, 10
  v_mul_f32 v96, s24, v96
  v_mul_f32 v97, s24, v97
  v_mul_f32 v98, s24, v98
  v_mul_f32 v99, s24, v99
  v_cvt_pk_bf16_f32 v68, v96, v97
  v_cvt_pk_bf16_f32 v69, v98, v99
  v_mul_f32 v112, s24, v112
  v_mul_f32 v113, s24, v113
  v_mul_f32 v114, s24, v114
  v_mul_f32 v115, s24, v115
  v_cvt_pk_bf16_f32 v70, v112, v113
  v_cvt_pk_bf16_f32 v71, v114, v115
  buffer_store_dwordx4 v[68:71], v12, s[8:11], s30 offen sc1
  v_mul_f32 v100, s24, v100
  v_mul_f32 v101, s24, v101
  v_mul_f32 v102, s24, v102
  v_mul_f32 v103, s24, v103
  v_cvt_pk_bf16_f32 v72, v100, v101
  v_cvt_pk_bf16_f32 v73, v102, v103
  v_mul_f32 v116, s24, v116
  v_mul_f32 v117, s24, v117
  v_mul_f32 v118, s24, v118
  v_mul_f32 v119, s24, v119
  v_cvt_pk_bf16_f32 v74, v116, v117
  v_cvt_pk_bf16_f32 v75, v118, v119
  buffer_store_dwordx4 v[72:75], v13, s[8:11], s30 offen sc1
  v_mul_f32 v104, s24, v104
  v_mul_f32 v105, s24, v105
  v_mul_f32 v106, s24, v106
  v_mul_f32 v107, s24, v107
  v_cvt_pk_bf16_f32 v76, v104, v105
  v_cvt_pk_bf16_f32 v77, v106, v107
  v_mul_f32 v120, s24, v120
  v_mul_f32 v121, s24, v121
  v_mul_f32 v122, s24, v122
  v_mul_f32 v123, s24, v123
  v_cvt_pk_bf16_f32 v78, v120, v121
  v_cvt_pk_bf16_f32 v79, v122, v123
  buffer_store_dwordx4 v[76:79], v14, s[8:11], s30 offen sc1
  v_mul_f32 v108, s24, v108
  v_mul_f32 v109, s24, v109
  v_mul_f32 v110, s24, v110
  v_mul_f32 v111, s24, v111
  v_cvt_pk_bf16_f32 v80, v108, v109
  v_cvt_pk_bf16_f32 v81, v110, v111
  v_mul_f32 v124, s24, v124
  v_mul_f32 v125, s24, v125
  v_mul_f32 v126, s24, v126
  v_mul_f32 v127, s24, v127
  v_cvt_pk_bf16_f32 v82, v124, v125
  v_cvt_pk_bf16_f32 v83, v126, v127
  buffer_store_dwordx4 v[80:83], v15, s[8:11], s30 offen sc1
  s_cmp_eq_u32 s16, 3
  s_cbranch_scc1 aj_w3
  s_waitcnt vmcnt(4)
  ds_read_b128 v[52:55], v32 offset:16384
  ds_read_b128 v[56:59], v33 offset:16384
  ds_read_b128 v[60:63], v34 offset:16384
  ds_read_b128 v[64:67], v35 offset:16384
  s_waitcnt lgkmcnt(3)
  v_mfma_f32_16x16x32_bf16 v[96:99], v[52:55], v[128:131], 0
  v_mfma_f32_16x16x32_bf16 v[100:103], v[52:55], v[160:163], 0
  v_mfma_f32_16x16x32_bf16 v[104:107], v[52:55], v[192:195], 0
  v_mfma_f32_16x16x32_bf16 v[108:111], v[52:55], v[224:227], 0
  ds_read_b128 v[52:55], v32 offset:16640
  s_waitcnt lgkmcnt(3)
  v_mfma_f32_16x16x32_bf16 v[96:99], v[56:59], v[132:135], v[96:99]
  v_mfma_f32_16x16x32_bf16 v[100:103], v[56:59], v[164:167], v[100:103]
  v_mfma_f32_16x16x32_bf16 v[104:107], v[56:59], v[196:199], v[104:107]
  v_mfma_f32_16x16x32_bf16 v[108:111], v[56:59], v[228:231], v[108:111]
  ds_read_b128 v[56:59], v33 offset:16640
  s_waitcnt lgkmcnt(3)
  v_mfma_f32_16x16x32_bf16 v[96:99], v[60:63], v[136:139], v[96:99]
  v_mfma_f32_16x16x32_bf16 v[100:103], v[60:63], v[168:171], v[100:103]
  v_mfma_f32_16x16x32_bf16 v[104:107], v[60:63], v[200:203], v[104:107]
  v_mfma_f32_16x16x32_bf16 v[108:111], v[60:63], v[232:235], v[108:111]
  ds_read_b128 v[60:63], v34 offset:16640
  s_waitcnt lgkmcnt(3)
  v_mfma_f32_16x16x32_bf16 v[96:99], v[64:67], v[140:143], v[96:99]
  v_mfma_f32_16x16x32_bf16 v[100:103], v[64:67], v[172:175], v[100:103]
  v_mfma_f32_16x16x32_bf16 v[104:107], v[64:67], v[204:207], v[104:107]
  v_mfma_f32_16x16x32_bf16 v[108:111], v[64:67], v[236:239], v[108:111]
  ds_read_b128 v[64:67], v35 offset:16640
  s_waitcnt lgkmcnt(3)
  v_mfma_f32_16x16x32_bf16 v[96:99], v[52:55], v[144:147], v[96:99]
  v_mfma_f32_16x16x32_bf16 v[100:103], v[52:55], v[176:179], v[100:103]
  v_mfma_f32_16x16x32_bf16 v[104:107], v[52:55], v[208:211], v[104:107]
  v_mfma_f32_16x16x32_bf16 v[108:111], v[52:55], v[240:243], v[108:111]
  ds_read_b128 v[52:55], v32 offset:18432
  s_waitcnt lgkmcnt(3)
  v_mfma_f32_16x16x32_bf16 v[96:99], v[56:59], v[148:151], v[96:99]
  v_mfma_f32_16x16x32_bf16 v[100:103], v[56:59], v[180:183], v[100:103]
  v_mfma_f32_16x16x32_bf16 v[104:107], v[56:59], v[212:215], v[104:107]
  v_mfma_f32_16x16x32_bf16 v[108:111], v[56:59], v[244:247], v[108:111]
  ds_read_b128 v[56:59], v33 offset:18432
  s_waitcnt lgkmcnt(3)
  v_mfma_f32_16x16x32_bf16 v[96:99], v[60:63], v[152:155], v[96:99]
  v_mfma_f32_16x16x32_bf16 v[100:103], v[60:63], v[184:187], v[100:103]
  v_mfma_f32_16x16x32_bf16 v[104:107], v[60:63], v[216:219], v[104:107]
  v_mfma_f32_16x16x32_bf16 v[108:111], v[60:63], v[248:251], v[108:111]
  ds_read_b128 v[60:63], v34 offset:18432
  s_waitcnt lgkmcnt(3)
  v_mfma_f32_16x16x32_bf16 v[96:99], v[64:67], v[156:159], v[96:99]
  v_mfma_f32_16x16x32_bf16 v[100:103], v[64:67], v[188:191], v[100:103]
  v_mfma_f32_16x16x32_bf16 v[104:107], v[64:67], v[220:223], v[104:107]
  v_mfma_f32_16x16x32_bf16 v[108:111], v[64:67], v[252:255], v[108:111]
  ds_read_b128 v[64:67], v35 offset:18432
  s_waitcnt lgkmcnt(3)
  v_mfma_f32_16x16x32_bf16 v[112:115], v[52:55], v[128:131], 0
  v_mfma_f32_16x16x32_bf16 v[116:119], v[52:55], v[160:163], 0
  v_mfma_f32_16x16x32_bf16 v[120:123], v[52:55], v[192:195], 0
  v_mfma_f32_16x16x32_bf16 v[124:127], v[52:55], v[224:227], 0
  ds_read_b128 v[52:55], v32 offset:18688
  s_waitcnt lgkmcnt(3)
  v_mfma_f32_16x16x32_bf16 v[112:115], v[56:59], v[132:135], v[112:115]
  v_mfma_f32_16x16x32_bf16 v[116:119], v[56:59], v[164:167], v[116:119]
  v_mfma_f32_16x16x32_bf16 v[120:123], v[56:59], v[196:199], v[120:123]
  v_mfma_f32_16x16x32_bf16 v[124:127], v[56:59], v[228:231], v[124:127]
  ds_read_b128 v[56:59], v33 offset:18688
  s_waitcnt lgkmcnt(3)
  v_mfma_f32_16x16x32_bf16 v[112:115], v[60:63], v[136:139], v[112:115]
  v_mfma_f32_16x16x32_bf16 v[116:119], v[60:63], v[168:171], v[116:119]
  v_mfma_f32_16x16x32_bf16 v[120:123], v[60:63], v[200:203], v[120:123]
  v_mfma_f32_16x16x32_bf16 v[124:127], v[60:63], v[232:235], v[124:127]
  ds_read_b128 v[60:63], v34 offset:18688
  s_waitcnt lgkmcnt(3)
  v_mfma_f32_16x16x32_bf16 v[112:115], v[64:67], v[140:143], v[112:115]
  v_mfma_f32_16x16x32_bf16 v[116:119], v[64:67], v[172:175], v[116:119]
  v_mfma_f32_16x16x32_bf16 v[120:123], v[64:67], v[204:207], v[120:123]
  v_mfma_f32_16x16x32_bf16 v[124:127], v[64:67], v[236:239], v[124:127]
  ds_read_b128 v[64:67], v35 offset:18688
  s_waitcnt lgkmcnt(3)
  v_mfma_f32_16x16x32_bf16 v[112:115], v[52:55], v[144:147], v[112:115]
  v_mfma_f32_16x16x32_bf16 v[116:119], v[52:55], v[176:179], v[116:119]
  v_mfma_f32_16x16x32_bf16 v[120:123], v[52:55], v[208:211], v[120:123]
  v_mfma_f32_16x16x32_bf16 v[124:127], v[52:55], v[240:243], v[124:127]
  s_waitcnt lgkmcnt(2)
  v_mfma_f32_16x16x32_bf16 v[112:115], v[56:59], v[148:151], v[112:115]
  v_mfma_f32_16x16x32_bf16 v[116:119], v[56:59], v[180:183], v[116:119]
  v_mfma_f32_16x16x32_bf16 v[120:123], v[56:59], v[212:215], v[120:123]
  v_mfma_f32_16x16x32_bf16 v[124:127], v[56:59], v[244:247], v[124:127]
  s_waitcnt lgkmcnt(1)
  v_mfma_f32_16x16x32_bf16 v[112:115], v[60:63], v[152:155], v[112:115]
  v_mfma_f32_16x16x32_bf16 v[116:119], v[60:63], v[184:187], v[116:119]
  v_mfma_f32_16x16x32_bf16 v[120:123], v[60:63], v[216:219], v[120:123]
  v_mfma_f32_16x16x32_bf16 v[124:127], v[60:63], v[248:251], v[124:127]
  s_waitcnt lgkmcnt(0)
  v_mfma_f32_16x16x32_bf16 v[112:115], v[64:67], v[156:159], v[112:115]
  v_mfma_f32_16x16x32_bf16 v[116:119], v[64:67], v[188:191], v[116:119]
  v_mfma_f32_16x16x32_bf16 v[120:123], v[64:67], v[220:223], v[120:123]
  v_mfma_f32_16x16x32_bf16 v[124:127], v[64:67], v[252:255], v[124:127]
  s_lshl_b32 s30, s29, 10
  v_mul_f32 v96, s24, v96
  v_mul_f32 v97, s24, v97
  v_mul_f32 v98, s24, v98
  v_mul_f32 v99, s24, v99
  v_cvt_pk_bf16_f32 v68, v96, v97
  v_cvt_pk_bf16_f32 v69, v98, v99
  v_mul_f32 v112, s24, v112
  v_mul_f32 v113, s24, v113
  v_mul_f32 v114, s24, v114
  v_mul_f32 v115, s24, v115
  v_cvt_pk_bf16_f32 v70, v112, v113
  v_cvt_pk_bf16_f32 v71, v114, v115
  buffer_store_dwordx4 v[68:71], v12, s[8:11], s30 offen sc1
  v_mul_f32 v100, s24, v100
  v_mul_f32 v101, s24, v101
  v_mul_f32 v102, s24, v102
  v_mul_f32 v103, s24, v103
  v_cvt_pk_bf16_f32 v72, v100, v101
  v_cvt_pk_bf16_f32 v73, v102, v103
  v_mul_f32 v116, s24, v116
  v_mul_f32 v117, s24, v117
  v_mul_f32 v118, s24, v118
  v_mul_f32 v119, s24, v119
  v_cvt_pk_bf16_f32 v74, v116, v117
  v_cvt_pk_bf16_f32 v75, v118, v119
  buffer_store_dwordx4 v[72:75], v13, s[8:11], s30 offen sc1
  v_mul_f32 v104, s24, v104
  v_mul_f32 v105, s24, v105
  v_mul_f32 v106, s24, v106
  v_mul_f32 v107, s24, v107
  v_cvt_pk_bf16_f32 v76, v104, v105
  v_cvt_pk_bf16_f32 v77, v106, v107
  v_mul_f32 v120, s24, v120
  v_mul_f32 v121, s24, v121
  v_mul_f32 v122, s24, v122
  v_mul_f32 v123, s24, v123
  v_cvt_pk_bf16_f32 v78, v120, v121
  v_cvt_pk_bf16_f32 v79, v122, v123
  buffer_store_dwordx4 v[76:79], v14, s[8:11], s30 offen sc1
  v_mul_f32 v108, s24, v108
  v_mul_f32 v109, s24, v109
  v_mul_f32 v110, s24, v110
  v_mul_f32 v111, s24, v111
  v_cvt_pk_bf16_f32 v80, v108, v109
  v_cvt_pk_bf16_f32 v81, v110, v111
  v_mul_f32 v124, s24, v124
  v_mul_f32 v125, s24, v125
  v_mul_f32 v126, s24, v126
  v_mul_f32 v127, s24, v127
  v_cvt_pk_bf16_f32 v82, v124, v125
  v_cvt_pk_bf16_f32 v83, v126, v127
  buffer_store_dwordx4 v[80:83], v15, s[8:11], s30 offen sc1
aj_w3:
  s_lshl_b32 s28, s17, 7
  s_lshl_b32 s21, s19, 4
  s_add_u32 s28, s28, s21
  s_cmp_lg_u32 s31, 0
  s_cselect_b32 s21, 8, 0
  s_add_u32 s28, s28, s21
  s_add_u32 s28, s28, 88633344
  s_waitcnt vmcnt(0)
  s_barrier
  s_cmp_lg_u32 s16, 0
  s_cbranch_scc1 pub_40
  v_mul_u32_u24 v26, 2048, v1
  v_mov_b32 v24, s88
  v_mov_b32 v25, s89
  s_mov_b64 exec, 1
  buffer_store_dwordx2 v[24:25], v26, s[8:11], s28 offen sc1
  s_mov_b64 exec, -1
pub_40:
  v_mov_b32 v250, 0
  s_branch wk_loop
wk_srv:
  s_sub_u32 s3, s3, 224
  s_and_b32 s18, s3, 15
  s_lshr_b32 s19, s3, 4
  s_and_b32 s19, s19, 1
  s_mul_i32 s20, s18, 401408
  s_add_u32 s20, s20, 6422528
  s_mul_i32 s21, s16, 43008
  s_add_u32 s21, s21, s20
  s_mul_i32 s22, s16, 57344
  s_add_u32 s20, s20, s22
  s_add_u32 s22, s20, 0
  buffer_load_dwordx4 a[0:3], v2, s[8:11], s22 offen offset:0 sc1
  buffer_load_dwordx4 a[4:7], v2, s[8:11], s22 offen offset:1024 sc1
  buffer_load_dwordx4 a[8:11], v2, s[8:11], s22 offen offset:2048 sc1
  buffer_load_dwordx4 a[12:15], v2, s[8:11], s22 offen offset:3072 sc1
  s_add_u32 s22, s20, 4096
  buffer_load_dwordx4 a[16:19], v2, s[8:11], s22 offen offset:0 sc1
  buffer_load_dwordx4 a[20:23], v2, s[8:11], s22 offen offset:1024 sc1
  buffer_load_dwordx4 a[24:27], v2, s[8:11], s22 offen offset:2048 sc1
  buffer_load_dwordx4 a[28:31], v2, s[8:11], s22 offen offset:3072 sc1
  s_add_u32 s22, s20, 8192
  buffer_load_dwordx4 a[32:35], v2, s[8:11], s22 offen offset:0 sc1
  buffer_load_dwordx4 a[36:39], v2, s[8:11], s22 offen offset:1024 sc1
  buffer_load_dwordx4 a[40:43], v2, s[8:11], s22 offen offset:2048 sc1
  buffer_load_dwordx4 a[44:47], v2, s[8:11], s22 offen offset:3072 sc1
  s_add_u32 s22, s20, 12288
  buffer_load_dwordx4 a[48:51], v2, s[8:11], s22 offen offset:0 sc1
  buffer_load_dwordx4 a[52:55], v2, s[8:11], s22 offen offset:1024 sc1
  buffer_load_dwordx4 a[56:59], v2, s[8:11], s22 offen offset:2048 sc1
  buffer_load_dwordx4 a[60:63], v2, s[8:11], s22 offen offset:3072 sc1
  s_add_u32 s22, s20, 16384
  buffer_load_dwordx4 a[64:67], v2, s[8:11], s22 offen offset:0 sc1
  buffer_load_dwordx4 a[68:71], v2, s[8:11], s22 offen offset:1024 sc1
  buffer_load_dwordx4 a[72:75], v2, s[8:11], s22 offen offset:2048 sc1
  buffer_load_dwordx4 a[76:79], v2, s[8:11], s22 offen offset:3072 sc1
  s_add_u32 s22, s20, 20480
  buffer_load_dwordx4 a[80:83], v2, s[8:11], s22 offen offset:0 sc1
  buffer_load_dwordx4 a[84:87], v2, s[8:11], s22 offen offset:1024 sc1
  buffer_load_dwordx4 a[88:91], v2, s[8:11], s22 offen offset:2048 sc1
  buffer_load_dwordx4 a[92:95], v2, s[8:11], s22 offen offset:3072 sc1
  s_add_u32 s22, s20, 24576
  buffer_load_dwordx4 a[96:99], v2, s[8:11], s22 offen offset:0 sc1
  buffer_load_dwordx4 a[100:103], v2, s[8:11], s22 offen offset:1024 sc1
  buffer_load_dwordx4 a[104:107], v2, s[8:11], s22 offen offset:2048 sc1
  buffer_load_dwordx4 a[108:111], v2, s[8:11], s22 offen offset:3072 sc1
  s_add_u32 s22, s20, 28672
  buffer_load_dwordx4 a[112:115], v2, s[8:11], s22 offen offset:0 sc1
  buffer_load_dwordx4 a[116:119], v2, s[8:11], s22 offen offset:1024 sc1
  buffer_load_dwordx4 a[120:123], v2, s[8:11], s22 offen offset:2048 sc1
  buffer_load_dwordx4 a[124:127], v2, s[8:11], s22 offen offset:3072 sc1
  s_waitcnt vmcnt(24)
  s_add_u32 s22, s20, 32768
  buffer_load_dwordx4 a[128:131], v2, s[8:11], s22 offen offset:0 sc1
  buffer_load_dwordx4 a[132:135], v2, s[8:11], s22 offen offset:1024 sc1
  buffer_load_dwordx4 a[136:139], v2, s[8:11], s22 offen offset:2048 sc1
  buffer_load_dwordx4 a[140:143], v2, s[8:11], s22 offen offset:3072 sc1
  s_add_u32 s22, s20, 36864
  buffer_load_dwordx4 a[144:147], v2, s[8:11], s22 offen offset:0 sc1
  buffer_load_dwordx4 a[148:151], v2, s[8:11], s22 offen offset:1024 sc1
  buffer_load_dwordx4 a[152:155], v2, s[8:11], s22 offen offset:2048 sc1
  buffer_load_dwordx4 a[156:159], v2, s[8:11], s22 offen offset:3072 sc1
  s_add_u32 s22, s20, 40960
  buffer_load_dwordx4 a[160:163], v2, s[8:11], s22 offen offset:0 sc1
  buffer_load_dwordx4 a[164:167], v2, s[8:11], s22 offen offset:1024 sc1
  buffer_load_dwordx4 a[168:171], v2, s[8:11], s22 offen offset:2048 sc1
  buffer_load_dwordx4 a[172:175], v2, s[8:11], s22 offen offset:3072 sc1
  s_add_u32 s22, s20, 45056
  buffer_load_dwordx4 a[176:179], v2, s[8:11], s22 offen offset:0 sc1
  buffer_load_dwordx4 a[180:183], v2, s[8:11], s22 offen offset:1024 sc1
  buffer_load_dwordx4 a[184:187], v2, s[8:11], s22 offen offset:2048 sc1
  buffer_load_dwordx4 a[188:191], v2, s[8:11], s22 offen offset:3072 sc1
  s_add_u32 s22, s20, 49152
  buffer_load_dwordx4 a[192:195], v2, s[8:11], s22 offen offset:0 sc1
  buffer_load_dwordx4 a[196:199], v2, s[8:11], s22 offen offset:1024 sc1
  buffer_load_dwordx4 a[200:203], v2, s[8:11], s22 offen offset:2048 sc1
  buffer_load_dwordx4 a[204:207], v2, s[8:11], s22 offen offset:3072 sc1
  s_add_u32 s22, s20, 53248
  buffer_load_dwordx4 a[208:211], v2, s[8:11], s22 offen offset:0 sc1
  buffer_load_dwordx4 a[212:215], v2, s[8:11], s22 offen offset:1024 sc1
  buffer_load_dwordx4 a[216:219], v2, s[8:11], s22 offen offset:2048 sc1
  buffer_load_dwordx4 a[220:223], v2, s[8:11], s22 offen offset:3072 sc1
  s_add_u32 s22, s21, 229376
  buffer_load_dwordx4 a[224:227], v2, s[8:11], s22 offen offset:0 sc1
  buffer_load_dwordx4 a[228:231], v2, s[8:11], s22 offen offset:1024 sc1
  buffer_load_dwordx4 a[232:235], v2, s[8:11], s22 offen offset:2048 sc1
  buffer_load_dwordx4 a[236:239], v2, s[8:11], s22 offen offset:3072 sc1
  s_add_u32 s22, s21, 233472
  buffer_load_dwordx4 a[240:243], v2, s[8:11], s22 offen offset:0 sc1
  buffer_load_dwordx4 a[244:247], v2, s[8:11], s22 offen offset:1024 sc1
  buffer_load_dwordx4 a[248:251], v2, s[8:11], s22 offen offset:2048 sc1
  buffer_load_dwordx4 a[252:255], v2, s[8:11], s22 offen offset:3072 sc1
  s_waitcnt vmcnt(24)
  s_add_u32 s22, s21, 237568
  buffer_load_dwordx4 v[120:123], v2, s[8:11], s22 offen offset:0 sc1
  buffer_load_dwordx4 v[124:127], v2, s[8:11], s22 offen offset:1024 sc1
  buffer_load_dwordx4 v[128:131], v2, s[8:11], s22 offen offset:2048 sc1
  buffer_load_dwordx4 v[132:135], v2, s[8:11], s22 offen offset:3072 sc1
  s_add_u32 s22, s21, 241664
  buffer_load_dwordx4 v[136:139], v2, s[8:11], s22 offen offset:0 sc1
  buffer_load_dwordx4 v[140:143], v2, s[8:11], s22 offen offset:1024 sc1
  buffer_load_dwordx4 v[144:147], v2, s[8:11], s22 offen offset:2048 sc1
  buffer_load_dwordx4 v[148:151], v2, s[8:11], s22 offen offset:3072 sc1
  s_add_u32 s22, s21, 245760
  buffer_load_dwordx4 v[152:155], v2, s[8:11], s22 offen offset:0 sc1
  buffer_load_dwordx4 v[156:159], v2, s[8:11], s22 offen offset:1024 sc1
  buffer_load_dwordx4 v[160:163], v2, s[8:11], s22 offen offset:2048 sc1
  buffer_load_dwordx4 v[164:167], v2, s[8:11], s22 offen offset:3072 sc1
  s_add_u32 s22, s21, 249856
  buffer_load_dwordx4 v[168:171], v2, s[8:11], s22 offen offset:0 sc1
  buffer_load_dwordx4 v[172:175], v2, s[8:11], s22 offen offset:1024 sc1
  buffer_load_dwordx4 v[176:179], v2, s[8:11], s22 offen offset:2048 sc1
  buffer_load_dwordx4 v[180:183], v2, s[8:11], s22 offen offset:3072 sc1
  s_add_u32 s22, s21, 253952
  buffer_load_dwordx4 v[184:187], v2, s[8:11], s22 offen offset:0 sc1
  buffer_load_dwordx4 v[188:191], v2, s[8:11], s22 offen offset:1024 sc1
  buffer_load_dwordx4 v[192:195], v2, s[8:11], s22 offen offset:2048 sc1
  buffer_load_dwordx4 v[196:199], v2, s[8:11], s22 offen offset:3072 sc1
  s_add_u32 s22, s21, 258048
  buffer_load_dwordx4 v[200:203], v2, s[8:11], s22 offen offset:0 sc1
  buffer_load_dwordx4 v[204:207], v2, s[8:11], s22 offen offset:1024 sc1
  buffer_load_dwordx4 v[208:211], v2, s[8:11], s22 offen offset:2048 sc1
  buffer_load_dwordx4 v[212:215], v2, s[8:11], s22 offen offset:3072 sc1
  s_add_u32 s22, s21, 262144
  buffer_load_dwordx4 v[216:219], v2, s[8:11], s22 offen offset:0 sc1
  buffer_load_dwordx4 v[220:223], v2, s[8:11], s22 offen offset:1024 sc1
  buffer_load_dwordx4 v[224:227], v2, s[8:11], s22 offen offset:2048 sc1
  buffer_load_dwordx4 v[228:231], v2, s[8:11], s22 offen offset:3072 sc1
  s_add_u32 s22, s21, 266240
  buffer_load_dwordx4 v[232:235], v2, s[8:11], s22 offen offset:0 sc1
  buffer_load_dwordx4 v[236:239], v2, s[8:11], s22 offen offset:1024 sc1
  buffer_load_dwordx4 v[240:243], v2, s[8:11], s22 offen offset:2048 sc1
  buffer_load_dwordx4 v[244:247], v2, s[8:11], s22 offen offset:3072 sc1
  s_waitcnt vmcnt(24)
  s_add_u32 s22, s21, 270336
  buffer_load_dwordx4 v[248:251], v2, s[8:11], s22 offen offset:0 sc1
  buffer_load_dwordx4 v[252:255], v2, s[8:11], s22 offen offset:1024 sc1
  v_mov_b32 v5, 0x4444
  v_mov_b32 v6, 0xeeee
  v_cmp_lt_u32 vcc, 7, v4
  s_nop 1
  v_cndmask_b32 v5, v5, v6, vcc
  s_lshl_b32 s23, s16, 11
  v_lshrrev_b32 v80, 1, v3
  v_and_b32 v81, 1, v3
  v_add_u32 v83, 0, v80
  v_mov_b32 v84, v4
  v_mov_b32 v86, 0
  v_lshl_add_u32 v86, v83, 8, v86
  v_lshl_add_u32 v86, v84, 4, v86
  v_lshl_add_u32 v86, v81, 3, v86
  v_add_u32 v72, s23, v86
  v_add_u32 v83, 2, v80
  v_mov_b32 v84, v4
  v_mov_b32 v86, 0
  v_lshl_add_u32 v86, v83, 8, v86
  v_lshl_add_u32 v86, v84, 4, v86
  v_lshl_add_u32 v86, v81, 3, v86
  v_add_u32 v73, s23, v86
  v_lshl_add_u32 v82, v80, 4, v4
  v_mul_u32_u24 v83, 5462, v82
  v_lshrrev_b32 v83, 16, v83
  v_mul_u32_u24 v84, 12, v83
  v_sub_u32 v84, v82, v84
  v_mov_b32 v86, 1024
  v_lshl_add_u32 v86, v83, 8, v86
  v_lshl_add_u32 v86, v84, 4, v86
  v_lshl_add_u32 v86, v81, 3, v86
  v_add_u32 v74, s23, v86
  v_add_u32 v82, 32, v4
  v_mul_u32_u24 v83, 5462, v82
  v_lshrrev_b32 v83, 16, v83
  v_mul_u32_u24 v84, 12, v83
  v_sub_u32 v84, v82, v84
  v_mov_b32 v86, 1024
  v_lshl_add_u32 v86, v83, 8, v86
  v_lshl_add_u32 v86, v84, 4, v86
  v_lshl_add_u32 v86, v81, 3, v86
  v_add_u32 v75, s23, v86
  v_add_u32 v76, s23, v2
  s_mul_i32 s27, s18, 448
  v_mov_b32 v77, s27
  v_mov_b32 v78, 1
  s_mov_b32 s17, s19
  s_mul_i32 s24, s19, 7168
  s_add_u32 s24, s24, 88080384
  s_mul_i32 s25, s18, 65
  s_add_u32 s25, s25, s19
  s_lshl_b32 s25, s25, 13
  s_add_u32 s25, s25, s23
  s_add_u32 s25, s25, 76947456
  s_lshl_b32 s26, s18, 6
  s_add_u32 s26, s26, s19
  s_lshl_b32 s26, s26, 4
  s_lshl_b32 s27, s16, 2
  s_add_u32 s26, s26, s27
  s_add_u32 s26, s26, 88582144
  v_mov_b32 v87, -1
ws_loop:
  v_mov_b32 v36, 0
  v_mov_b32 v37, 0
  v_mov_b32 v38, 0
  v_mov_b32 v39, 0
  v_mov_b32 v40, 0
  v_mov_b32 v41, 0
  v_mov_b32 v42, 0
  v_mov_b32 v43, 0
  v_mov_b32 v44, 0
  v_mov_b32 v45, 0
  v_mov_b32 v46, 0
  v_mov_b32 v47, 0
  v_mov_b32 v48, 0
  v_mov_b32 v49, 0
  v_mov_b32 v50, 0
  v_mov_b32 v51, 0
  v_mov_b32 v52, 0
  v_mov_b32 v53, 0
  v_mov_b32 v54, 0
  v_mov_b32 v55, 0
  v_mov_b32 v56, 0
  v_mov_b32 v57, 0
  v_mov_b32 v58, 0
  v_mov_b32 v59, 0
  v_mov_b32 v60, 0
  v_mov_b32 v61, 0
  v_mov_b32 v62, 0
  v_mov_b32 v63, 0
  s_mov_b32 s30, 0
  v_cmp_eq_u32 vcc, -1, v87
  s_cbranch_vccz ws_fl
ws_pm:
  s_cmp_ge_u32 s17, 61
  s_cbranch_scc1 mp_41a
  v_mov_b32 v79, 0
  s_mov_b64 exec, 1
  buffer_atomic_or v79, v77, s[8:11], s24 offen sc0
  s_mov_b64 exec, -1
  s_branch mp_41b
mp_41a:
  buffer_load_dword v79, v77, s[8:11], s24 offen sc1
mp_41b:
  s_waitcnt vmcnt(0)
  v_cmp_eq_u32 vcc, -1, v79
  s_cbranch_vccnz ws_pr
ws_fl:
  s_add_u32 s22, s24, 4096
  buffer_load_dwordx4 v[8:11], v2, s[8:11], s24 offen offset:0 sc1
  buffer_load_dwordx4 v[12:15], v2, s[8:11], s24 offen offset:1024 sc1
  buffer_load_dwordx4 v[16:19], v2, s[8:11], s24 offen offset:2048 sc1
  buffer_load_dwordx4 v[20:23], v2, s[8:11], s24 offen offset:3072 sc1
  buffer_load_dwordx4 v[24:27], v2, s[8:11], s22 offen offset:0 sc1
  buffer_load_dwordx4 v[28:31], v2, s[8:11], s22 offen offset:1024 sc1
  buffer_load_dwordx4 v[32:35], v2, s[8:11], s22 offen offset:2048 sc1
  s_waitcnt vmcnt(0)
  v_max_u32 v79, v8, v9
  v_max3_u32 v79, v79, v10, v11
  v_max3_u32 v79, v79, v12, v13
  v_max3_u32 v79, v79, v14, v15
  v_max3_u32 v79, v79, v16, v17
  v_max3_u32 v79, v79, v18, v19
  v_max3_u32 v79, v79, v20, v21
  v_max3_u32 v79, v79, v22, v23
  v_max3_u32 v79, v79, v24, v25
  v_max3_u32 v79, v79, v26, v27
  v_max3_u32 v79, v79, v28, v29
  v_max3_u32 v79, v79, v30, v31
  v_max3_u32 v79, v79, v32, v33
  v_max3_u32 v79, v79, v34, v35
  v_cmp_eq_u32 vcc, -1, v79
  s_cbranch_vccz ws_pk
ws_pr:
  s_sleep 1
  s_cmp_ge_u32 s17, 61
  s_cbranch_scc1 ws_sh
  s_sleep 6
ws_sh:
  s_add_u32 s30, s30, 1
  s_cmp_lt_u32 s30, 30000
  s_cbranch_scc1 ws_pm
  s_branch cA_abort
ws_pk:
  s_cmp_ge_u32 s17, 62
  s_cbranch_scc1 ws_na
  s_add_u32 s22, s24, 14336
  s_cmp_ge_u32 s17, 61
  s_cbranch_scc1 mp_42a
  v_mov_b32 v87, 0
  s_mov_b64 exec, 1
  buffer_atomic_or v87, v77, s[8:11], s22 offen sc0
  s_mov_b64 exec, -1
  s_branch mp_42b
mp_42a:
  buffer_load_dword v87, v77, s[8:11], s22 offen sc1
mp_42b:
ws_na:
  v_smfmac_f32_16x16x64_bf16 v[36:39], v[8:11], a[0:7], v5
  v_smfmac_f32_16x16x64_bf16 v[36:39], v[12:15], a[8:15], v5
  v_smfmac_f32_16x16x64_bf16 v[36:39], v[16:19], a[16:23], v5
  v_smfmac_f32_16x16x64_bf16 v[36:39], v[20:23], a[24:31], v5
  v_smfmac_f32_16x16x64_bf16 v[36:39], v[24:27], a[32:39], v5
  v_smfmac_f32_16x16x64_bf16 v[36:39], v[28:31], a[40:47], v5
  v_smfmac_f32_16x16x64_bf16 v[36:39], v[32:35], a[48:55], v5
  v_smfmac_f32_16x16x64_bf16 v[40:43], v[8:11], a[56:63], v5
  v_smfmac_f32_16x16x64_bf16 v[40:43], v[12:15], a[64:71], v5
  v_smfmac_f32_16x16x64_bf16 v[40:43], v[16:19], a[72:79], v5
  v_smfmac_f32_16x16x64_bf16 v[40:43], v[20:23], a[80:87], v5
  v_smfmac_f32_16x16x64_bf16 v[40:43], v[24:27], a[88:95], v5
  v_smfmac_f32_16x16x64_bf16 v[40:43], v[28:31], a[96:103], v5
  v_smfmac_f32_16x16x64_bf16 v[40:43], v[32:35], a[104:111], v5
  v_smfmac_f32_16x16x64_bf16 v[44:47], v[8:11], a[112:119], v5
  v_smfmac_f32_16x16x64_bf16 v[44:47], v[12:15], a[120:127], v5
  v_smfmac_f32_16x16x64_bf16 v[44:47], v[16:19], a[128:135], v5
  v_smfmac_f32_16x16x64_bf16 v[44:47], v[20:23], a[136:143], v5
  v_smfmac_f32_16x16x64_bf16 v[44:47], v[24:27], a[144:151], v5
  v_smfmac_f32_16x16x64_bf16 v[44:47], v[28:31], a[152:159], v5
  v_smfmac_f32_16x16x64_bf16 v[44:47], v[32:35], a[160:167], v5
  v_smfmac_f32_16x16x64_bf16 v[48:51], v[8:11], a[168:175], v5
  v_smfmac_f32_16x16x64_bf16 v[48:51], v[12:15], a[176:183], v5
  v_smfmac_f32_16x16x64_bf16 v[48:51], v[16:19], a[184:191], v5
  v_smfmac_f32_16x16x64_bf16 v[48:51], v[20:23], a[192:199], v5
  v_smfmac_f32_16x16x64_bf16 v[48:51], v[24:27], a[200:207], v5
  v_smfmac_f32_16x16x64_bf16 v[48:51], v[28:31], a[208:215], v5
  v_smfmac_f32_16x16x64_bf16 v[48:51], v[32:35], a[216:223], v5
  v_smfmac_f32_16x16x64_bf16 v[52:55], v[8:11], a[224:231], v5
  v_smfmac_f32_16x16x64_bf16 v[52:55], v[12:15], a[232:239], v5
  v_smfmac_f32_16x16x64_bf16 v[52:55], v[16:19], a[240:247], v5
  v_smfmac_f32_16x16x64_bf16 v[52:55], v[20:23], a[248:255], v5
  v_smfmac_f32_16x16x64_bf16 v[52:55], v[24:27], v[120:127], v5
  v_smfmac_f32_16x16x64_bf16 v[52:55], v[28:31], v[128:135], v5
  v_smfmac_f32_16x16x64_bf16 v[52:55], v[32:35], v[136:143], v5
  v_smfmac_f32_16x16x64_bf16 v[56:59], v[8:11], v[144:151], v5
  v_smfmac_f32_16x16x64_bf16 v[56:59], v[12:15], v[152:159], v5
  v_smfmac_f32_16x16x64_bf16 v[56:59], v[16:19], v[160:167], v5
  v_smfmac_f32_16x16x64_bf16 v[56:59], v[20:23], v[168:175], v5
  v_smfmac_f32_16x16x64_bf16 v[56:59], v[24:27], v[176:183], v5
  v_smfmac_f32_16x16x64_bf16 v[56:59], v[28:31], v[184:191], v5
  v_smfmac_f32_16x16x64_bf16 v[56:59], v[32:35], v[192:199], v5
  v_smfmac_f32_16x16x64_bf16 v[60:63], v[8:11], v[200:207], v5
  v_smfmac_f32_16x16x64_bf16 v[60:63], v[12:15], v[208:215], v5
  v_smfmac_f32_16x16x64_bf16 v[60:63], v[16:19], v[216:223], v5
  v_smfmac_f32_16x16x64_bf16 v[60:63], v[20:23], v[224:231], v5
  v_smfmac_f32_16x16x64_bf16 v[60:63], v[24:27], v[232:239], v5
  v_smfmac_f32_16x16x64_bf16 v[60:63], v[28:31], v[240:247], v5
  v_smfmac_f32_16x16x64_bf16 v[60:63], v[32:35], v[248:255], v5
  v_permlane32_swap_b32 v36, v40
  v_permlane32_swap_b32 v37, v41
  v_permlane32_swap_b32 v38, v42
  v_permlane32_swap_b32 v39, v43
  v_add_f32 v36, v36, v40
  v_add_f32 v37, v37, v41
  v_add_f32 v38, v38, v42
  v_add_f32 v39, v39, v43
  v_cvt_pk_bf16_f32 v40, v36, v37
  v_cvt_pk_bf16_f32 v41, v38, v39
  ds_write_b64 v72, v[40:41]
  v_permlane32_swap_b32 v44, v48
  v_permlane32_swap_b32 v45, v49
  v_permlane32_swap_b32 v46, v50
  v_permlane32_swap_b32 v47, v51
  v_add_f32 v44, v44, v48
  v_add_f32 v45, v45, v49
  v_add_f32 v46, v46, v50
  v_add_f32 v47, v47, v51
  v_cvt_pk_bf16_f32 v48, v44, v45
  v_cvt_pk_bf16_f32 v49, v46, v47
  ds_write_b64 v73, v[48:49]
  v_permlane32_swap_b32 v52, v56
  v_permlane32_swap_b32 v53, v57
  v_permlane32_swap_b32 v54, v58
  v_permlane32_swap_b32 v55, v59
  v_add_f32 v52, v52, v56
  v_add_f32 v53, v53, v57
  v_add_f32 v54, v54, v58
  v_add_f32 v55, v55, v59
  v_cvt_pk_bf16_f32 v56, v52, v53
  v_cvt_pk_bf16_f32 v57, v54, v55
  ds_write_b64 v74, v[56:57]
  v_mov_b32 v64, v60
  v_mov_b32 v65, v61
  v_mov_b32 v66, v62
  v_mov_b32 v67, v63
  v_permlane32_swap_b32 v60, v64
  v_permlane32_swap_b32 v61, v65
  v_permlane32_swap_b32 v62, v66
  v_permlane32_swap_b32 v63, v67
  v_add_f32 v60, v60, v64
  v_add_f32 v61, v61, v65
  v_add_f32 v62, v62, v66
  v_add_f32 v63, v63, v67
  v_cvt_pk_bf16_f32 v64, v60, v61
  v_cvt_pk_bf16_f32 v65, v62, v63
  ds_write_b64 v75, v[64:65]
  s_waitcnt lgkmcnt(0)
  ds_read_b128 v[64:67], v76
  ds_read_b128 v[68:71], v76 offset:1024
  s_waitcnt lgkmcnt(0)
  buffer_store_dwordx4 v[64:67], v2, s[8:11], s25 offen sc1
  buffer_store_dwordx4 v[68:71], v2, s[8:11], s25 offen offset:1024 sc1
  s_waitcnt vmcnt(0)
  s_mov_b64 exec, 1
  buffer_store_dword v78, v2, s[8:11], s26 offen sc1
  s_mov_b64 exec, -1
  s_add_u32 s24, s24, 14336
  s_add_u32 s25, s25, 16384
  s_add_u32 s26, s26, 32
  s_add_u32 s17, s17, 2
  s_cmp_lt_u32 s17, 64
  s_cbranch_scc1 ws_loop
  v_mov_b32 v250, 0
  s_branch wk_loop
wk_s4d:
  s_cmp_lg_u32 s16, 0
  s_cbranch_scc1 w0_43
  s_getreg_b32 s20, hwreg(HW_REG_XCC_ID)
  s_sub_u32 s20, s20, 1
  s_and_b32 s20, s20, 7
  s_mov_b64 exec, 1
s4_l:
  s_cmp_ge_u32 s20, 7
  s_cselect_b32 s20, 0, s20
  s_lshl_b32 s21, s20, 7
  s_add_u32 s21, s21, 88598528
  v_mov_b32 v242, 1
  buffer_atomic_add v242, off, s[8:11], s21 sc0
  s_waitcnt vmcnt(0)
  v_readfirstlane_b32 s21, v242
  s_lshl_b32 s22, s20, 4
  s_add_u32 s20, s20, 1
  s_cmp_ge_u32 s21, 16
  s_cbranch_scc1 s4_l
  v_add_u32 v242, s22, v242
  s_mov_b64 exec, -1
w0_43:
  v_mov_b32 v243, 160000
  s_add_u32 s101, s101, 1
  s_barrier
  s_mov_b64 exec, 1
  s_cmp_lg_u32 s16, 0
  s_cbranch_scc1 w0_44
  ds_write_b32 v243, v242 offset:0
  s_waitcnt lgkmcnt(0)
  v_mov_b32 v242, s101
  ds_write_b32 v243, v242 offset:16
  s_waitcnt lgkmcnt(0)
w0_44:
  s_mov_b64 exec, -1
  s_barrier
  ds_read_b32 v242, v243 offset:0
  ds_read_b32 v243, v243 offset:16
  s_waitcnt lgkmcnt(0)
  v_readfirstlane_b32 s3, v242
  v_cmp_ne_u32 vcc, s101, v243
  s_cbranch_vccnz ch_end
  s_load_dwordx8 s[40:47], s[0:1], 0
  s_load_dwordx4 s[48:51], s[0:1], 32
  s_load_dwordx2 s[52:53], s[0:1], 48
  s_load_dwordx2 s[54:55], s[0:1], 112
  v_lshrrev_b32 v1, 6, v0
  s_nop 0
  v_readfirstlane_b32 s16, v1
  v_and_b32 v1, 63, v0
  v_lshrrev_b32 v3, 4, v1
  v_and_b32 v4, 15, v1
  s_mul_i32 s17, s16, 24576
  s_waitcnt lgkmcnt(0)
  s_mov_b32 s60, s40
  s_and_b32 s61, s41, 0xffff
  s_mov_b32 s62, 1835008
  s_mov_b32 s63, 0x20000
  s_mov_b32 s64, s42
  s_and_b32 s65, s43, 0xffff
  s_mov_b32 s66, 229376
  s_mov_b32 s67, 0x20000
  s_mov_b32 s68, s44
  s_and_b32 s69, s45, 0xffff
  s_mov_b32 s70, 229376
  s_mov_b32 s71, 0x20000
  s_mov_b32 s72, s46
  s_and_b32 s73, s47, 0xffff
  s_mov_b32 s74, 229376
  s_mov_b32 s75, 0x20000
  s_mov_b32 s76, s48
  s_and_b32 s77, s49, 0xffff
  s_mov_b32 s78, 229376
  s_mov_b32 s79, 0x20000
  s_mov_b32 s80, s50
  s_and_b32 s81, s51, 0xffff
  s_mov_b32 s82, 896
  s_mov_b32 s83, 0x20000
  s_mov_b32 s84, s52
  s_and_b32 s85, s53, 0xffff
  s_mov_b32 s86, 896
  s_mov_b32 s87, 0x20000
  s_mov_b32 s92, s54
  s_and_b32 s93, s55, 0xffff
  s_mov_b32 s94, 3670016
  s_mov_b32 s95, 0x20000
  v_lshlrev_b32 v5, 5, v1
  v_sub_u32 v5, 2047, v5
  s_add_u32 s18, s17, 13056
  v_subrev_u32 v6, 0, v5
  v_max_i32 v7, 0, v6
  v_cvt_f32_u32 v7, v7
  v_cvt_pk_bf16_f32 v8, v7, v7
  v_and_b32 v7, 0xffff0000, v8
  v_lshrrev_b32 v8, 23, v7
  v_subrev_u32 v8, 134, v8
  v_max_i32 v8, 0, v8
  v_cvt_u32_f32 v7, v7
  v_lshrrev_b32 v7, v8, v7
  v_lshl_add_u32 v7, v8, 8, v7
  v_lshl_add_u32 v200, v7, 2, s18
  v_subrev_u32 v6, 1, v5
  v_max_i32 v7, 0, v6
  v_cvt_f32_u32 v7, v7
  v_cvt_pk_bf16_f32 v8, v7, v7
  v_and_b32 v7, 0xffff0000, v8
  v_lshrrev_b32 v8, 23, v7
  v_subrev_u32 v8, 134, v8
  v_max_i32 v8, 0, v8
  v_cvt_u32_f32 v7, v7
  v_lshrrev_b32 v7, v8, v7
  v_lshl_add_u32 v7, v8, 8, v7
  v_lshl_add_u32 v201, v7, 2, s18
  v_subrev_u32 v6, 2, v5
  v_max_i32 v7, 0, v6
  v_cvt_f32_u32 v7, v7
  v_cvt_pk_bf16_f32 v8, v7, v7
  v_and_b32 v7, 0xffff0000, v8
  v_lshrrev_b32 v8, 23, v7
  v_subrev_u32 v8, 134, v8
  v_max_i32 v8, 0, v8
  v_cvt_u32_f32 v7, v7
  v_lshrrev_b32 v7, v8, v7
  v_lshl_add_u32 v7, v8, 8, v7
  v_lshl_add_u32 v202, v7, 2, s18
  v_subrev_u32 v6, 3, v5
  v_max_i32 v7, 0, v6
  v_cvt_f32_u32 v7, v7
  v_cvt_pk_bf16_f32 v8, v7, v7
  v_and_b32 v7, 0xffff0000, v8
  v_lshrrev_b32 v8, 23, v7
  v_subrev_u32 v8, 134, v8
  v_max_i32 v8, 0, v8
  v_cvt_u32_f32 v7, v7
  v_lshrrev_b32 v7, v8, v7
  v_lshl_add_u32 v7, v8, 8, v7
  v_lshl_add_u32 v203, v7, 2, s18
  v_subrev_u32 v6, 4, v5
  v_max_i32 v7, 0, v6
  v_cvt_f32_u32 v7, v7
  v_cvt_pk_bf16_f32 v8, v7, v7
  v_and_b32 v7, 0xffff0000, v8
  v_lshrrev_b32 v8, 23, v7
  v_subrev_u32 v8, 134, v8
  v_max_i32 v8, 0, v8
  v_cvt_u32_f32 v7, v7
  v_lshrrev_b32 v7, v8, v7
  v_lshl_add_u32 v7, v8, 8, v7
  v_lshl_add_u32 v204, v7, 2, s18
  v_subrev_u32 v6, 5, v5
  v_max_i32 v7, 0, v6
  v_cvt_f32_u32 v7, v7
  v_cvt_pk_bf16_f32 v8, v7, v7
  v_and_b32 v7, 0xffff0000, v8
  v_lshrrev_b32 v8, 23, v7
  v_subrev_u32 v8, 134, v8
  v_max_i32 v8, 0, v8
  v_cvt_u32_f32 v7, v7
  v_lshrrev_b32 v7, v8, v7
  v_lshl_add_u32 v7, v8, 8, v7
  v_lshl_add_u32 v205, v7, 2, s18
  v_subrev_u32 v6, 6, v5
  v_max_i32 v7, 0, v6
  v_cvt_f32_u32 v7, v7
  v_cvt_pk_bf16_f32 v8, v7, v7
  v_and_b32 v7, 0xffff0000, v8
  v_lshrrev_b32 v8, 23, v7
  v_subrev_u32 v8, 134, v8
  v_max_i32 v8, 0, v8
  v_cvt_u32_f32 v7, v7
  v_lshrrev_b32 v7, v8, v7
  v_lshl_add_u32 v7, v8, 8, v7
  v_lshl_add_u32 v206, v7, 2, s18
  v_subrev_u32 v6, 7, v5
  v_max_i32 v7, 0, v6
  v_cvt_f32_u32 v7, v7
  v_cvt_pk_bf16_f32 v8, v7, v7
  v_and_b32 v7, 0xffff0000, v8
  v_lshrrev_b32 v8, 23, v7
  v_subrev_u32 v8, 134, v8
  v_max_i32 v8, 0, v8
  v_cvt_u32_f32 v7, v7
  v_lshrrev_b32 v7, v8, v7
  v_lshl_add_u32 v7, v8, 8, v7
  v_lshl_add_u32 v207, v7, 2, s18
  v_subrev_u32 v6, 8, v5
  v_max_i32 v7, 0, v6
  v_cvt_f32_u32 v7, v7
  v_cvt_pk_bf16_f32 v8, v7, v7
  v_and_b32 v7, 0xffff0000, v8
  v_lshrrev_b32 v8, 23, v7
  v_subrev_u32 v8, 134, v8
  v_max_i32 v8, 0, v8
  v_cvt_u32_f32 v7, v7
  v_lshrrev_b32 v7, v8, v7
  v_lshl_add_u32 v7, v8, 8, v7
  v_lshl_add_u32 v208, v7, 2, s18
  v_subrev_u32 v6, 9, v5
  v_max_i32 v7, 0, v6
  v_cvt_f32_u32 v7, v7
  v_cvt_pk_bf16_f32 v8, v7, v7
  v_and_b32 v7, 0xffff0000, v8
  v_lshrrev_b32 v8, 23, v7
  v_subrev_u32 v8, 134, v8
  v_max_i32 v8, 0, v8
  v_cvt_u32_f32 v7, v7
  v_lshrrev_b32 v7, v8, v7
  v_lshl_add_u32 v7, v8, 8, v7
  v_lshl_add_u32 v209, v7, 2, s18
  v_subrev_u32 v6, 10, v5
  v_max_i32 v7, 0, v6
  v_cvt_f32_u32 v7, v7
  v_cvt_pk_bf16_f32 v8, v7, v7
  v_and_b32 v7, 0xffff0000, v8
  v_lshrrev_b32 v8, 23, v7
  v_subrev_u32 v8, 134, v8
  v_max_i32 v8, 0, v8
  v_cvt_u32_f32 v7, v7
  v_lshrrev_b32 v7, v8, v7
  v_lshl_add_u32 v7, v8, 8, v7
  v_lshl_add_u32 v210, v7, 2, s18
  v_subrev_u32 v6, 11, v5
  v_max_i32 v7, 0, v6
  v_cvt_f32_u32 v7, v7
  v_cvt_pk_bf16_f32 v8, v7, v7
  v_and_b32 v7, 0xffff0000, v8
  v_lshrrev_b32 v8, 23, v7
  v_subrev_u32 v8, 134, v8
  v_max_i32 v8, 0, v8
  v_cvt_u32_f32 v7, v7
  v_lshrrev_b32 v7, v8, v7
  v_lshl_add_u32 v7, v8, 8, v7
  v_lshl_add_u32 v211, v7, 2, s18
  v_subrev_u32 v6, 12, v5
  v_max_i32 v7, 0, v6
  v_cvt_f32_u32 v7, v7
  v_cvt_pk_bf16_f32 v8, v7, v7
  v_and_b32 v7, 0xffff0000, v8
  v_lshrrev_b32 v8, 23, v7
  v_subrev_u32 v8, 134, v8
  v_max_i32 v8, 0, v8
  v_cvt_u32_f32 v7, v7
  v_lshrrev_b32 v7, v8, v7
  v_lshl_add_u32 v7, v8, 8, v7
  v_lshl_add_u32 v212, v7, 2, s18
  v_subrev_u32 v6, 13, v5
  v_max_i32 v7, 0, v6
  v_cvt_f32_u32 v7, v7
  v_cvt_pk_bf16_f32 v8, v7, v7
  v_and_b32 v7, 0xffff0000, v8
  v_lshrrev_b32 v8, 23, v7
  v_subrev_u32 v8, 134, v8
  v_max_i32 v8, 0, v8
  v_cvt_u32_f32 v7, v7
  v_lshrrev_b32 v7, v8, v7
  v_lshl_add_u32 v7, v8, 8, v7
  v_lshl_add_u32 v213, v7, 2, s18
  v_subrev_u32 v6, 14, v5
  v_max_i32 v7, 0, v6
  v_cvt_f32_u32 v7, v7
  v_cvt_pk_bf16_f32 v8, v7, v7
  v_and_b32 v7, 0xffff0000, v8
  v_lshrrev_b32 v8, 23, v7
  v_subrev_u32 v8, 134, v8
  v_max_i32 v8, 0, v8
  v_cvt_u32_f32 v7, v7
  v_lshrrev_b32 v7, v8, v7
  v_lshl_add_u32 v7, v8, 8, v7
  v_lshl_add_u32 v214, v7, 2, s18
  v_subrev_u32 v6, 15, v5
  v_max_i32 v7, 0, v6
  v_cvt_f32_u32 v7, v7
  v_cvt_pk_bf16_f32 v8, v7, v7
  v_and_b32 v7, 0xffff0000, v8
  v_lshrrev_b32 v8, 23, v7
  v_subrev_u32 v8, 134, v8
  v_max_i32 v8, 0, v8
  v_cvt_u32_f32 v7, v7
  v_lshrrev_b32 v7, v8, v7
  v_lshl_add_u32 v7, v8, 8, v7
  v_lshl_add_u32 v215, v7, 2, s18
  v_subrev_u32 v6, 16, v5
  v_max_i32 v7, 0, v6
  v_cvt_f32_u32 v7, v7
  v_cvt_pk_bf16_f32 v8, v7, v7
  v_and_b32 v7, 0xffff0000, v8
  v_lshrrev_b32 v8, 23, v7
  v_subrev_u32 v8, 134, v8
  v_max_i32 v8, 0, v8
  v_cvt_u32_f32 v7, v7
  v_lshrrev_b32 v7, v8, v7
  v_lshl_add_u32 v7, v8, 8, v7
  v_lshl_add_u32 v216, v7, 2, s18
  v_subrev_u32 v6, 17, v5
  v_max_i32 v7, 0, v6
  v_cvt_f32_u32 v7, v7
  v_cvt_pk_bf16_f32 v8, v7, v7
  v_and_b32 v7, 0xffff0000, v8
  v_lshrrev_b32 v8, 23, v7
  v_subrev_u32 v8, 134, v8
  v_max_i32 v8, 0, v8
  v_cvt_u32_f32 v7, v7
  v_lshrrev_b32 v7, v8, v7
  v_lshl_add_u32 v7, v8, 8, v7
  v_lshl_add_u32 v217, v7, 2, s18
  v_subrev_u32 v6, 18, v5
  v_max_i32 v7, 0, v6
  v_cvt_f32_u32 v7, v7
  v_cvt_pk_bf16_f32 v8, v7, v7
  v_and_b32 v7, 0xffff0000, v8
  v_lshrrev_b32 v8, 23, v7
  v_subrev_u32 v8, 134, v8
  v_max_i32 v8, 0, v8
  v_cvt_u32_f32 v7, v7
  v_lshrrev_b32 v7, v8, v7
  v_lshl_add_u32 v7, v8, 8, v7
  v_lshl_add_u32 v218, v7, 2, s18
  v_subrev_u32 v6, 19, v5
  v_max_i32 v7, 0, v6
  v_cvt_f32_u32 v7, v7
  v_cvt_pk_bf16_f32 v8, v7, v7
  v_and_b32 v7, 0xffff0000, v8
  v_lshrrev_b32 v8, 23, v7
  v_subrev_u32 v8, 134, v8
  v_max_i32 v8, 0, v8
  v_cvt_u32_f32 v7, v7
  v_lshrrev_b32 v7, v8, v7
  v_lshl_add_u32 v7, v8, 8, v7
  v_lshl_add_u32 v219, v7, 2, s18
  v_subrev_u32 v6, 20, v5
  v_max_i32 v7, 0, v6
  v_cvt_f32_u32 v7, v7
  v_cvt_pk_bf16_f32 v8, v7, v7
  v_and_b32 v7, 0xffff0000, v8
  v_lshrrev_b32 v8, 23, v7
  v_subrev_u32 v8, 134, v8
  v_max_i32 v8, 0, v8
  v_cvt_u32_f32 v7, v7
  v_lshrrev_b32 v7, v8, v7
  v_lshl_add_u32 v7, v8, 8, v7
  v_lshl_add_u32 v220, v7, 2, s18
  v_subrev_u32 v6, 21, v5
  v_max_i32 v7, 0, v6
  v_cvt_f32_u32 v7, v7
  v_cvt_pk_bf16_f32 v8, v7, v7
  v_and_b32 v7, 0xffff0000, v8
  v_lshrrev_b32 v8, 23, v7
  v_subrev_u32 v8, 134, v8
  v_max_i32 v8, 0, v8
  v_cvt_u32_f32 v7, v7
  v_lshrrev_b32 v7, v8, v7
  v_lshl_add_u32 v7, v8, 8, v7
  v_lshl_add_u32 v221, v7, 2, s18
  v_subrev_u32 v6, 22, v5
  v_max_i32 v7, 0, v6
  v_cvt_f32_u32 v7, v7
  v_cvt_pk_bf16_f32 v8, v7, v7
  v_and_b32 v7, 0xffff0000, v8
  v_lshrrev_b32 v8, 23, v7
  v_subrev_u32 v8, 134, v8
  v_max_i32 v8, 0, v8
  v_cvt_u32_f32 v7, v7
  v_lshrrev_b32 v7, v8, v7
  v_lshl_add_u32 v7, v8, 8, v7
  v_lshl_add_u32 v222, v7, 2, s18
  v_subrev_u32 v6, 23, v5
  v_max_i32 v7, 0, v6
  v_cvt_f32_u32 v7, v7
  v_cvt_pk_bf16_f32 v8, v7, v7
  v_and_b32 v7, 0xffff0000, v8
  v_lshrrev_b32 v8, 23, v7
  v_subrev_u32 v8, 134, v8
  v_max_i32 v8, 0, v8
  v_cvt_u32_f32 v7, v7
  v_lshrrev_b32 v7, v8, v7
  v_lshl_add_u32 v7, v8, 8, v7
  v_lshl_add_u32 v223, v7, 2, s18
  v_subrev_u32 v6, 24, v5
  v_max_i32 v7, 0, v6
  v_cvt_f32_u32 v7, v7
  v_cvt_pk_bf16_f32 v8, v7, v7
  v_and_b32 v7, 0xffff0000, v8
  v_lshrrev_b32 v8, 23, v7
  v_subrev_u32 v8, 134, v8
  v_max_i32 v8, 0, v8
  v_cvt_u32_f32 v7, v7
  v_lshrrev_b32 v7, v8, v7
  v_lshl_add_u32 v7, v8, 8, v7
  v_lshl_add_u32 v224, v7, 2, s18
  v_subrev_u32 v6, 25, v5
  v_max_i32 v7, 0, v6
  v_cvt_f32_u32 v7, v7
  v_cvt_pk_bf16_f32 v8, v7, v7
  v_and_b32 v7, 0xffff0000, v8
  v_lshrrev_b32 v8, 23, v7
  v_subrev_u32 v8, 134, v8
  v_max_i32 v8, 0, v8
  v_cvt_u32_f32 v7, v7
  v_lshrrev_b32 v7, v8, v7
  v_lshl_add_u32 v7, v8, 8, v7
  v_lshl_add_u32 v225, v7, 2, s18
  v_subrev_u32 v6, 26, v5
  v_max_i32 v7, 0, v6
  v_cvt_f32_u32 v7, v7
  v_cvt_pk_bf16_f32 v8, v7, v7
  v_and_b32 v7, 0xffff0000, v8
  v_lshrrev_b32 v8, 23, v7
  v_subrev_u32 v8, 134, v8
  v_max_i32 v8, 0, v8
  v_cvt_u32_f32 v7, v7
  v_lshrrev_b32 v7, v8, v7
  v_lshl_add_u32 v7, v8, 8, v7
  v_lshl_add_u32 v226, v7, 2, s18
  v_subrev_u32 v6, 27, v5
  v_max_i32 v7, 0, v6
  v_cvt_f32_u32 v7, v7
  v_cvt_pk_bf16_f32 v8, v7, v7
  v_and_b32 v7, 0xffff0000, v8
  v_lshrrev_b32 v8, 23, v7
  v_subrev_u32 v8, 134, v8
  v_max_i32 v8, 0, v8
  v_cvt_u32_f32 v7, v7
  v_lshrrev_b32 v7, v8, v7
  v_lshl_add_u32 v7, v8, 8, v7
  v_lshl_add_u32 v227, v7, 2, s18
  v_subrev_u32 v6, 28, v5
  v_max_i32 v7, 0, v6
  v_cvt_f32_u32 v7, v7
  v_cvt_pk_bf16_f32 v8, v7, v7
  v_and_b32 v7, 0xffff0000, v8
  v_lshrrev_b32 v8, 23, v7
  v_subrev_u32 v8, 134, v8
  v_max_i32 v8, 0, v8
  v_cvt_u32_f32 v7, v7
  v_lshrrev_b32 v7, v8, v7
  v_lshl_add_u32 v7, v8, 8, v7
  v_lshl_add_u32 v228, v7, 2, s18
  v_subrev_u32 v6, 29, v5
  v_max_i32 v7, 0, v6
  v_cvt_f32_u32 v7, v7
  v_cvt_pk_bf16_f32 v8, v7, v7
  v_and_b32 v7, 0xffff0000, v8
  v_lshrrev_b32 v8, 23, v7
  v_subrev_u32 v8, 134, v8
  v_max_i32 v8, 0, v8
  v_cvt_u32_f32 v7, v7
  v_lshrrev_b32 v7, v8, v7
  v_lshl_add_u32 v7, v8, 8, v7
  v_lshl_add_u32 v229, v7, 2, s18
  v_subrev_u32 v6, 30, v5
  v_max_i32 v7, 0, v6
  v_cvt_f32_u32 v7, v7
  v_cvt_pk_bf16_f32 v8, v7, v7
  v_and_b32 v7, 0xffff0000, v8
  v_lshrrev_b32 v8, 23, v7
  v_subrev_u32 v8, 134, v8
  v_max_i32 v8, 0, v8
  v_cvt_u32_f32 v7, v7
  v_lshrrev_b32 v7, v8, v7
  v_lshl_add_u32 v7, v8, 8, v7
  v_lshl_add_u32 v230, v7, 2, s18
  v_subrev_u32 v6, 31, v5
  v_max_i32 v7, 0, v6
  v_cvt_f32_u32 v7, v7
  v_cvt_pk_bf16_f32 v8, v7, v7
  v_and_b32 v7, 0xffff0000, v8
  v_lshrrev_b32 v8, 23, v7
  v_subrev_u32 v8, 134, v8
  v_max_i32 v8, 0, v8
  v_cvt_u32_f32 v7, v7
  v_lshrrev_b32 v7, v8, v7
  v_lshl_add_u32 v7, v8, 8, v7
  v_lshl_add_u32 v231, v7, 2, s18
  v_subrev_u32 v6, 32, v5
  v_max_i32 v7, 0, v6
  v_cvt_f32_u32 v7, v7
  v_cvt_pk_bf16_f32 v8, v7, v7
  v_and_b32 v7, 0xffff0000, v8
  v_lshrrev_b32 v8, 23, v7
  v_subrev_u32 v8, 134, v8
  v_max_i32 v8, 0, v8
  v_cvt_u32_f32 v7, v7
  v_lshrrev_b32 v7, v8, v7
  v_lshl_add_u32 v7, v8, 8, v7
  v_mov_b32 v8, 1280
  v_cmp_gt_i32 vcc, 0, v6
  s_nop 1
  v_cndmask_b32 v7, v7, v8, vcc
  v_lshl_add_u32 v232, v7, 2, s18
  v_mov_b32 v8, 0
  v_mov_b32 v9, 0
  v_lshlrev_b32 v5, 3, v1
  v_add_u32 v5, s17, v5
  ds_write_b64 v5, v[8:9]
  v_and_b32 v6, 15, v1
  v_lshlrev_b32 v6, 3, v6
  v_add_u32 v6, s17, v6
  ds_write_b64 v6, v[8:9] offset:8704
  ds_write_b64 v6, v[8:9] offset:12928
  v_mov_b32 v6, s17
  ds_write_b64 v6, v[8:9] offset:18176
  s_lshl_b32 s19, s3, 2
  s_add_u32 s20, s19, s16
  s_lshl_b32 s21, s3, 3
  v_mul_u32_u24 v5, 3584, v0
  v_mul_u32_u24 v141, 1792, v0
  s_lshl_b32 s22, s20, 9
  v_lshlrev_b32 v6, 3, v1
  buffer_load_dwordx2 v[24:25], v6, s[64:67], s22 offen
  buffer_load_dwordx2 v[26:27], v6, s[68:71], s22 offen
  buffer_load_dwordx2 v[28:29], v6, s[72:75], s22 offen
  buffer_load_dwordx2 v[30:31], v6, s[76:79], s22 offen
  s_lshl_b32 s22, s20, 1
  v_mov_b32 v7, 0
  buffer_load_ushort v32, v7, s[80:83], s22 offen
  buffer_load_ushort v33, v7, s[84:87], s22 offen
  s_mov_b32 s24, 0x05040100
  s_mov_b32 s25, 0x07060302
  s_barrier
  s_waitcnt vmcnt(0)
  s_mov_b32 s26, 1069066811
  s_mov_b32 s27, 1042479491
  v_lshlrev_b32 v32, 16, v32
  v_lshlrev_b32 v33, 16, v33
  v_mul_f32 v32, s26, v32
  v_exp_f32 v32, v32
  s_nop 0
  v_cvt_pk_bf16_f32 v34, v32, v32
  v_and_b32 v32, 0xffff0000, v34
  v_lshlrev_b32 v37, 6, v1
  v_add_u32 v37, s17, v37
  v_lshlrev_b32 v40, 16, v24
  v_lshlrev_b32 v41, 16, v26
  v_lshlrev_b32 v42, 16, v28
  v_lshlrev_b32 v43, 16, v30
  v_mul_f32 v40, s26, v40
  v_exp_f32 v40, v40
  s_nop 0
  v_cvt_pk_bf16_f32 v34, v40, v40
  v_and_b32 v40, 0xffff0000, v34
  v_mul_f32 v40, v40, v32
  v_mul_f32 v40, s26, v40
  v_sub_f32 v40, 0, v40
  v_mul_f32 v41, v41, v32
  v_mul_f32 v41, s27, v41
  v_mul_f32 v42, v42, v32
  v_mul_f32 v43, v43, v32
  v_add_f32 v42, v42, v42
  v_add_f32 v43, v43, v43
  ds_write_b128 v37, v[40:43] offset:18240
  v_and_b32 v40, 0xffff0000, v24
  v_and_b32 v41, 0xffff0000, v26
  v_and_b32 v42, 0xffff0000, v28
  v_and_b32 v43, 0xffff0000, v30
  v_mul_f32 v40, s26, v40
  v_exp_f32 v40, v40
  s_nop 0
  v_cvt_pk_bf16_f32 v34, v40, v40
  v_and_b32 v40, 0xffff0000, v34
  v_mul_f32 v40, v40, v32
  v_mul_f32 v40, s26, v40
  v_sub_f32 v40, 0, v40
  v_mul_f32 v41, v41, v32
  v_mul_f32 v41, s27, v41
  v_mul_f32 v42, v42, v32
  v_mul_f32 v43, v43, v32
  v_add_f32 v42, v42, v42
  v_add_f32 v43, v43, v43
  ds_write_b128 v37, v[40:43] offset:18256
  v_lshlrev_b32 v40, 16, v25
  v_lshlrev_b32 v41, 16, v27
  v_lshlrev_b32 v42, 16, v29
  v_lshlrev_b32 v43, 16, v31
  v_mul_f32 v40, s26, v40
  v_exp_f32 v40, v40
  s_nop 0
  v_cvt_pk_bf16_f32 v34, v40, v40
  v_and_b32 v40, 0xffff0000, v34
  v_mul_f32 v40, v40, v32
  v_mul_f32 v40, s26, v40
  v_sub_f32 v40, 0, v40
  v_mul_f32 v41, v41, v32
  v_mul_f32 v41, s27, v41
  v_mul_f32 v42, v42, v32
  v_mul_f32 v43, v43, v32
  v_add_f32 v42, v42, v42
  v_add_f32 v43, v43, v43
  ds_write_b128 v37, v[40:43] offset:18272
  v_and_b32 v40, 0xffff0000, v25
  v_and_b32 v41, 0xffff0000, v27
  v_and_b32 v42, 0xffff0000, v29
  v_and_b32 v43, 0xffff0000, v31
  v_mul_f32 v40, s26, v40
  v_exp_f32 v40, v40
  s_nop 0
  v_cvt_pk_bf16_f32 v34, v40, v40
  v_and_b32 v40, 0xffff0000, v34
  v_mul_f32 v40, v40, v32
  v_mul_f32 v40, s26, v40
  v_sub_f32 v40, 0, v40
  v_mul_f32 v41, v41, v32
  v_mul_f32 v41, s27, v41
  v_mul_f32 v42, v42, v32
  v_mul_f32 v43, v43, v32
  v_add_f32 v42, v42, v42
  v_add_f32 v43, v43, v43
  ds_write_b128 v37, v[40:43] offset:18288
  v_cvt_f32_u32 v44, v4
  v_lshlrev_b32 v45, 4, v4
  v_cvt_f32_u32 v45, v45
  v_lshlrev_b32 v46, 4, v3
  v_add_u32 v46, s17, v46
  v_mov_b32 v48, 0
  v_mov_b32 v49, 0
  v_mov_b32 v50, 0
  v_mov_b32 v51, 0
  v_mov_b32 v52, 0
  v_mov_b32 v53, 0
  v_mov_b32 v54, 0
  v_mov_b32 v55, 0
  v_mov_b32 v56, 0
  v_mov_b32 v57, 0
  v_mov_b32 v58, 0
  v_mov_b32 v59, 0
  v_mov_b32 v60, 0
  v_mov_b32 v61, 0
  v_mov_b32 v62, 0
  v_mov_b32 v63, 0
  v_mov_b32 v64, 0
  v_mov_b32 v65, 0
  v_mov_b32 v66, 0
  v_mov_b32 v67, 0
  s_waitcnt lgkmcnt(0)
  ds_read_b128 v[68:71], v46 offset:18240
  s_add_u32 s22, s21, 0
  buffer_load_dwordx2 v[8:9], v5, s[60:63], s22 offen offset:0
  s_mov_b32 s28, 0
  s_call_b64 s[30:31], wk_kl
  s_mov_b32 s28, 0
  s_call_b64 s[30:31], wk_kl
  s_add_u32 s22, s21, 0
  buffer_load_dwordx2 v[10:11], v5, s[60:63], s22 offen offset:896
  s_mov_b32 s28, 0
  s_call_b64 s[30:31], wk_kl
  s_mov_b32 s28, 0
  s_call_b64 s[30:31], wk_kl
  s_add_u32 s22, s21, 0
  buffer_load_dwordx2 v[12:13], v5, s[60:63], s22 offen offset:1792
  s_mov_b32 s28, 0
  s_call_b64 s[30:31], wk_kl
  s_mov_b32 s28, 0
  s_call_b64 s[30:31], wk_kl
  s_add_u32 s22, s21, 0
  buffer_load_dwordx2 v[14:15], v5, s[60:63], s22 offen offset:2688
  s_mov_b32 s28, 0
  s_call_b64 s[30:31], wk_kl
  s_mov_b32 s28, 0
  s_call_b64 s[30:31], wk_kl
  s_add_u32 s22, s21, 917504
  buffer_load_dwordx2 v[16:17], v5, s[60:63], s22 offen offset:0
  s_mov_b32 s28, 0
  s_call_b64 s[30:31], wk_kl
  s_mov_b32 s28, 0
  s_call_b64 s[30:31], wk_kl
  s_add_u32 s22, s21, 917504
  buffer_load_dwordx2 v[18:19], v5, s[60:63], s22 offen offset:896
  s_mov_b32 s28, 0
  s_call_b64 s[30:31], wk_kl
  s_mov_b32 s28, 0
  s_call_b64 s[30:31], wk_kl
  s_add_u32 s22, s21, 917504
  buffer_load_dwordx2 v[20:21], v5, s[60:63], s22 offen offset:1792
  s_mov_b32 s28, 0
  s_call_b64 s[30:31], wk_kl
  s_mov_b32 s28, 0
  s_call_b64 s[30:31], wk_kl
  s_add_u32 s22, s21, 917504
  buffer_load_dwordx2 v[22:23], v5, s[60:63], s22 offen offset:2688
  s_mov_b32 s28, 0
  s_call_b64 s[30:31], wk_kl
  s_mov_b32 s28, 0
  s_call_b64 s[30:31], wk_kl
  s_branch wk_kd
wk_kl:
  s_waitcnt lgkmcnt(0)
  v_mov_b32 v72, v68
  v_mov_b32 v73, v69
  v_mov_b32 v74, v70
  v_mov_b32 v75, v71
  v_add_u32 v46, 64, v46
  ds_read_b128 v[68:71], v46 offset:18240
  v_mul_f32 v80, v72, v45
  v_mul_f32 v81, v73, v45
  v_exp_f32 v80, v80
  v_fract_f32 v81, v81
  v_cos_f32 v76, v81
  v_sin_f32 v77, v81
  v_mul_f32 v76, v76, v80
  v_mul_f32 v77, v77, v80
  v_mul_f32 v80, v72, v44
  v_mul_f32 v81, v73, v44
  v_exp_f32 v80, v80
  v_fract_f32 v81, v81
  v_cos_f32 v78, v81
  v_sin_f32 v79, v81
  v_mul_f32 v78, v78, v80
  v_mul_f32 v79, v79, v80
  v_mul_f32 v82, v74, v76
  v_mul_f32 v83, v74, v77
  v_fma_f32 v82, -v75, v77, v82
  v_fma_f32 v83, -v75, v76, -v83
  v_mul_f32 v86, v76, v76
  v_mul_f32 v87, v76, v77
  v_fma_f32 v86, -v77, v77, v86
  v_add_f32 v87, v87, v87
  v_mfma_f32_16x16x4_f32 v[48:51], v82, v78, v[48:51]
  v_mul_f32 v88, v78, v78
  v_mul_f32 v89, v78, v79
  v_fma_f32 v88, -v79, v79, v88
  v_add_f32 v89, v89, v89
  v_mfma_f32_16x16x4_f32 v[48:51], v83, v79, v[48:51]
  v_mul_f32 v84, v74, v86
  v_mul_f32 v85, v74, v87
  v_fma_f32 v84, -v75, v87, v84
  v_fma_f32 v85, -v75, v86, -v85
  v_mul_f32 v76, v86, v86
  v_mul_f32 v77, v86, v87
  v_fma_f32 v76, -v87, v87, v76
  v_add_f32 v77, v77, v77
  v_mfma_f32_16x16x4_f32 v[52:55], v84, v88, v[52:55]
  v_mul_f32 v78, v88, v88
  v_mul_f32 v79, v88, v89
  v_fma_f32 v78, -v89, v89, v78
  v_add_f32 v79, v79, v79
  v_mfma_f32_16x16x4_f32 v[52:55], v85, v89, v[52:55]
  v_mul_f32 v82, v74, v76
  v_mul_f32 v83, v74, v77
  v_fma_f32 v82, -v75, v77, v82
  v_fma_f32 v83, -v75, v76, -v83
  v_mul_f32 v86, v76, v76
  v_mul_f32 v87, v76, v77
  v_fma_f32 v86, -v77, v77, v86
  v_add_f32 v87, v87, v87
  v_mfma_f32_16x16x4_f32 v[56:59], v82, v78, v[56:59]
  v_mul_f32 v88, v78, v78
  v_mul_f32 v89, v78, v79
  v_fma_f32 v88, -v79, v79, v88
  v_add_f32 v89, v89, v89
  v_mfma_f32_16x16x4_f32 v[56:59], v83, v79, v[56:59]
  v_mul_f32 v84, v74, v86
  v_mul_f32 v85, v74, v87
  v_fma_f32 v84, -v75, v87, v84
  v_fma_f32 v85, -v75, v86, -v85
  v_mul_f32 v76, v86, v86
  v_mul_f32 v77, v86, v87
  v_fma_f32 v76, -v87, v87, v76
  v_add_f32 v77, v77, v77
  v_mfma_f32_16x16x4_f32 v[60:63], v84, v88, v[60:63]
  v_mfma_f32_16x16x4_f32 v[60:63], v85, v89, v[60:63]
  v_mul_f32 v82, v74, v76
  v_fma_f32 v82, -v75, v77, v82
  s_nop 1
  v_mfma_f32_16x16x4_f32 v[64:67], v82, v88, v[64:67]
  s_add_u32 s28, s28, 1
  s_cmp_lt_u32 s28, 4
  s_cbranch_scc1 wk_kl
  s_setpc_b64 s[30:31]
wk_kd:
  s_nop 15
  s_nop 3
  s_waitcnt vmcnt(0)
  v_lshlrev_b32 v6, 3, v0
  v_perm_b32 v34, v10, v8, s24
  v_perm_b32 v35, v14, v12, s24
  v_add_u32 v36, 512, v6
  ds_write_b64 v36, v[34:35]
  v_perm_b32 v34, v10, v8, s25
  v_perm_b32 v35, v14, v12, s25
  v_add_u32 v36, 25088, v6
  ds_write_b64 v36, v[34:35]
  v_perm_b32 v34, v11, v9, s24
  v_perm_b32 v35, v15, v13, s24
  v_add_u32 v36, 49664, v6
  ds_write_b64 v36, v[34:35]
  v_perm_b32 v34, v11, v9, s25
  v_perm_b32 v35, v15, v13, s25
  v_add_u32 v36, 74240, v6
  ds_write_b64 v36, v[34:35]
  v_perm_b32 v34, v18, v16, s24
  v_perm_b32 v35, v22, v20, s24
  v_add_u32 v36, 2560, v6
  ds_write_b64 v36, v[34:35]
  v_perm_b32 v34, v18, v16, s25
  v_perm_b32 v35, v22, v20, s25
  v_add_u32 v36, 27136, v6
  ds_write_b64 v36, v[34:35]
  v_perm_b32 v34, v19, v17, s24
  v_perm_b32 v35, v23, v21, s24
  v_add_u32 v36, 51712, v6
  ds_write_b64 v36, v[34:35]
  v_perm_b32 v34, v19, v17, s25
  v_perm_b32 v35, v23, v21, s25
  v_add_u32 v36, 76288, v6
  ds_write_b64 v36, v[34:35]
  v_lshlrev_b32 v46, 8, v3
  v_lshl_add_u32 v46, v4, 2, v46
  v_add_u32 v46, s17, v46
  ds_write_b32 v46, v48 offset:13056
  ds_write_b32 v46, v49 offset:13120
  ds_write_b32 v46, v50 offset:13184
  ds_write_b32 v46, v51 offset:13248
  s_waitcnt lgkmcnt(8)
  ds_write_b32 v46, v52 offset:14080
  ds_write_b32 v46, v53 offset:14144
  ds_write_b32 v46, v54 offset:14208
  ds_write_b32 v46, v55 offset:14272
  s_waitcnt lgkmcnt(8)
  ds_write_b32 v46, v56 offset:15104
  ds_write_b32 v46, v57 offset:15168
  ds_write_b32 v46, v58 offset:15232
  ds_write_b32 v46, v59 offset:15296
  s_waitcnt lgkmcnt(8)
  ds_write_b32 v46, v60 offset:16128
  ds_write_b32 v46, v61 offset:16192
  ds_write_b32 v46, v62 offset:16256
  ds_write_b32 v46, v63 offset:16320
  s_waitcnt lgkmcnt(8)
  ds_write_b32 v46, v64 offset:17152
  ds_write_b32 v46, v65 offset:17216
  ds_write_b32 v46, v66 offset:17280
  ds_write_b32 v46, v67 offset:17344
  s_waitcnt lgkmcnt(8)
  s_waitcnt lgkmcnt(0)
  ds_read_b32 v48, v200
  ds_read_b32 v49, v201
  ds_read_b32 v50, v202
  ds_read_b32 v51, v203
  ds_read_b32 v52, v204
  ds_read_b32 v53, v205
  ds_read_b32 v54, v206
  ds_read_b32 v55, v207
  s_waitcnt lgkmcnt(4)
  ds_read_b32 v56, v208
  ds_read_b32 v57, v209
  ds_read_b32 v58, v210
  ds_read_b32 v59, v211
  ds_read_b32 v60, v212
  ds_read_b32 v61, v213
  ds_read_b32 v62, v214
  ds_read_b32 v63, v215
  s_waitcnt lgkmcnt(4)
  ds_read_b32 v64, v216
  ds_read_b32 v65, v217
  ds_read_b32 v66, v218
  ds_read_b32 v67, v219
  ds_read_b32 v68, v220
  ds_read_b32 v69, v221
  ds_read_b32 v70, v222
  ds_read_b32 v71, v223
  s_waitcnt lgkmcnt(4)
  ds_read_b32 v72, v224
  ds_read_b32 v73, v225
  ds_read_b32 v74, v226
  ds_read_b32 v75, v227
  ds_read_b32 v76, v228
  ds_read_b32 v77, v229
  ds_read_b32 v78, v230
  ds_read_b32 v79, v231
  s_waitcnt lgkmcnt(4)
  ds_read_b32 v80, v232
  s_waitcnt lgkmcnt(0)
  v_lshlrev_b32 v46, 6, v1
  v_add_u32 v46, s17, v46
  v_cvt_pk_bf16_f32 v84, v48, v49
  v_cvt_pk_bf16_f32 v88, v49, v50
  v_cvt_pk_bf16_f32 v85, v50, v51
  v_cvt_pk_bf16_f32 v89, v51, v52
  v_cvt_pk_bf16_f32 v86, v52, v53
  v_cvt_pk_bf16_f32 v90, v53, v54
  v_cvt_pk_bf16_f32 v87, v54, v55
  v_cvt_pk_bf16_f32 v91, v55, v56
  ds_write_b128 v46, v[84:87] offset:4608
  ds_write_b128 v46, v[88:91] offset:8832
  s_waitcnt lgkmcnt(0)
  v_cvt_pk_bf16_f32 v84, v56, v57
  v_cvt_pk_bf16_f32 v88, v57, v58
  v_cvt_pk_bf16_f32 v85, v58, v59
  v_cvt_pk_bf16_f32 v89, v59, v60
  v_cvt_pk_bf16_f32 v86, v60, v61
  v_cvt_pk_bf16_f32 v90, v61, v62
  v_cvt_pk_bf16_f32 v87, v62, v63
  v_cvt_pk_bf16_f32 v91, v63, v64
  ds_write_b128 v46, v[84:87] offset:4624
  ds_write_b128 v46, v[88:91] offset:8848
  s_waitcnt lgkmcnt(0)
  v_cvt_pk_bf16_f32 v84, v64, v65
  v_cvt_pk_bf16_f32 v88, v65, v66
  v_cvt_pk_bf16_f32 v85, v66, v67
  v_cvt_pk_bf16_f32 v89, v67, v68
  v_cvt_pk_bf16_f32 v86, v68, v69
  v_cvt_pk_bf16_f32 v90, v69, v70
  v_cvt_pk_bf16_f32 v87, v70, v71
  v_cvt_pk_bf16_f32 v91, v71, v72
  ds_write_b128 v46, v[84:87] offset:4640
  ds_write_b128 v46, v[88:91] offset:8864
  s_waitcnt lgkmcnt(0)
  v_cvt_pk_bf16_f32 v84, v72, v73
  v_cvt_pk_bf16_f32 v88, v73, v74
  v_cvt_pk_bf16_f32 v85, v74, v75
  v_cvt_pk_bf16_f32 v89, v75, v76
  v_cvt_pk_bf16_f32 v86, v76, v77
  v_cvt_pk_bf16_f32 v90, v77, v78
  v_cvt_pk_bf16_f32 v87, v78, v79
  v_cvt_pk_bf16_f32 v91, v79, v80
  ds_write_b128 v46, v[84:87] offset:4656
  ds_write_b128 v46, v[88:91] offset:8880
  s_waitcnt lgkmcnt(0)
  s_barrier
  v_lshrrev_b32 v47, 1, v3
  v_sub_u32 v46, v4, v47
  v_add_u32 v46, 1, v46
  v_lshlrev_b32 v46, 5, v46
  v_and_b32 v48, 1, v3
  v_lshl_add_u32 v46, v48, 4, v46
  v_add_u32 v46, s17, v46
  ds_read_b128 a[0:3], v46 offset:32
  ds_read_b128 a[4:7], v46 offset:96
  ds_read_b128 a[8:11], v46 offset:160
  ds_read_b128 a[12:15], v46 offset:224
  ds_read_b128 a[16:19], v46 offset:288
  ds_read_b128 a[20:23], v46 offset:352
  ds_read_b128 a[24:27], v46 offset:416
  ds_read_b128 a[28:31], v46 offset:480
  s_waitcnt lgkmcnt(4)
  ds_read_b128 a[32:35], v46 offset:544
  ds_read_b128 a[36:39], v46 offset:608
  ds_read_b128 a[40:43], v46 offset:672
  ds_read_b128 a[44:47], v46 offset:736
  ds_read_b128 a[48:51], v46 offset:800
  ds_read_b128 a[52:55], v46 offset:864
  ds_read_b128 a[56:59], v46 offset:928
  ds_read_b128 a[60:63], v46 offset:992
  s_waitcnt lgkmcnt(4)
  ds_read_b128 a[64:67], v46 offset:1056
  ds_read_b128 a[68:71], v46 offset:1120
  ds_read_b128 a[72:75], v46 offset:1184
  ds_read_b128 a[76:79], v46 offset:1248
  ds_read_b128 a[80:83], v46 offset:1312
  ds_read_b128 a[84:87], v46 offset:1376
  ds_read_b128 a[88:91], v46 offset:1440
  ds_read_b128 a[92:95], v46 offset:1504
  s_waitcnt lgkmcnt(4)
  ds_read_b128 a[96:99], v46 offset:1568
  ds_read_b128 a[100:103], v46 offset:1632
  ds_read_b128 a[104:107], v46 offset:1696
  ds_read_b128 a[108:111], v46 offset:1760
  ds_read_b128 a[112:115], v46 offset:1824
  ds_read_b128 a[116:119], v46 offset:1888
  ds_read_b128 a[120:123], v46 offset:1952
  ds_read_b128 a[124:127], v46 offset:2016
  s_waitcnt lgkmcnt(4)
  ds_read_b128 a[128:131], v46 offset:2080
  ds_read_b128 a[132:135], v46 offset:2144
  ds_read_b128 a[136:139], v46 offset:2208
  ds_read_b128 a[140:143], v46 offset:2272
  ds_read_b128 a[144:147], v46 offset:2336
  ds_read_b128 a[148:151], v46 offset:2400
  ds_read_b128 a[152:155], v46 offset:2464
  ds_read_b128 a[156:159], v46 offset:2528
  s_waitcnt lgkmcnt(4)
  ds_read_b128 a[160:163], v46 offset:2592
  ds_read_b128 a[164:167], v46 offset:2656
  ds_read_b128 a[168:171], v46 offset:2720
  ds_read_b128 a[172:175], v46 offset:2784
  ds_read_b128 a[176:179], v46 offset:2848
  ds_read_b128 a[180:183], v46 offset:2912
  ds_read_b128 a[184:187], v46 offset:2976
  ds_read_b128 a[188:191], v46 offset:3040
  s_waitcnt lgkmcnt(4)
  ds_read_b128 a[192:195], v46 offset:3104
  ds_read_b128 a[196:199], v46 offset:3168
  ds_read_b128 a[200:203], v46 offset:3232
  ds_read_b128 a[204:207], v46 offset:3296
  ds_read_b128 a[208:211], v46 offset:3360
  ds_read_b128 a[212:215], v46 offset:3424
  ds_read_b128 a[216:219], v46 offset:3488
  ds_read_b128 a[220:223], v46 offset:3552
  s_waitcnt lgkmcnt(4)
  ds_read_b128 a[224:227], v46 offset:3616
  ds_read_b128 a[228:231], v46 offset:3680
  ds_read_b128 a[232:235], v46 offset:3744
  ds_read_b128 a[236:239], v46 offset:3808
  ds_read_b128 a[240:243], v46 offset:3872
  ds_read_b128 a[244:247], v46 offset:3936
  ds_read_b128 a[248:251], v46 offset:4000
  ds_read_b128 a[252:255], v46 offset:4064
  s_waitcnt lgkmcnt(4)
  v_lshlrev_b32 v49, 4, v47
  v_add_u32 v49, v49, v4
  v_sub_u32 v49, 2047, v49
  v_lshl_add_u32 v49, v48, 3, v49
  v_and_b32 v50, 1, v49
  v_lshrrev_b32 v49, 1, v49
  v_lshlrev_b32 v49, 2, v49
  v_mul_u32_u24 v50, 4224, v50
  v_add3_u32 v49, v49, v50, s17
  v_add_u32 v49, 4608, v49
  v_subrev_u32 v52, 896, v49
  v_subrev_u32 v53, 1856, v49
  v_subrev_u32 v54, 2816, v49
  v_subrev_u32 v55, 3776, v49
  v_subrev_u32 v56, 4736, v49
  s_waitcnt lgkmcnt(0)
  ds_read2_b32 v[92:93], v52 offset0:224 offset1:225
  ds_read2_b32 v[94:95], v52 offset0:226 offset1:227
  ds_read2_b32 v[96:97], v52 offset0:208 offset1:209
  ds_read2_b32 v[98:99], v52 offset0:210 offset1:211
  ds_read2_b32 v[100:101], v52 offset0:192 offset1:193
  ds_read2_b32 v[102:103], v52 offset0:194 offset1:195
  ds_read2_b32 v[104:105], v52 offset0:176 offset1:177
  ds_read2_b32 v[106:107], v52 offset0:178 offset1:179
  s_waitcnt lgkmcnt(6)
  v_mfma_f32_16x16x32_bf16 v[60:63], v[92:95], a[28:31], 0
  v_mfma_f32_16x16x32_bf16 v[64:67], v[92:95], a[60:63], 0
  v_mfma_f32_16x16x32_bf16 v[68:71], v[92:95], a[92:95], 0
  v_mfma_f32_16x16x32_bf16 v[72:75], v[92:95], a[124:127], 0
  v_mfma_f32_16x16x32_bf16 v[76:79], v[92:95], a[156:159], 0
  v_mfma_f32_16x16x32_bf16 v[80:83], v[92:95], a[188:191], 0
  v_mfma_f32_16x16x32_bf16 v[84:87], v[92:95], a[220:223], 0
  v_mfma_f32_16x16x32_bf16 v[88:91], v[92:95], a[252:255], 0
  ds_read2_b32 v[92:93], v52 offset0:160 offset1:161
  ds_read2_b32 v[94:95], v52 offset0:162 offset1:163
  s_waitcnt lgkmcnt(6)
  v_mfma_f32_16x16x32_bf16 v[60:63], v[96:99], a[24:27], v[60:63]
  v_mfma_f32_16x16x32_bf16 v[64:67], v[96:99], a[56:59], v[64:67]
  v_mfma_f32_16x16x32_bf16 v[68:71], v[96:99], a[88:91], v[68:71]
  v_mfma_f32_16x16x32_bf16 v[72:75], v[96:99], a[120:123], v[72:75]
  v_mfma_f32_16x16x32_bf16 v[76:79], v[96:99], a[152:155], v[76:79]
  v_mfma_f32_16x16x32_bf16 v[80:83], v[96:99], a[184:187], v[80:83]
  v_mfma_f32_16x16x32_bf16 v[84:87], v[96:99], a[216:219], v[84:87]
  v_mfma_f32_16x16x32_bf16 v[88:91], v[96:99], a[248:251], v[88:91]
  ds_read2_b32 v[96:97], v52 offset0:144 offset1:145
  ds_read2_b32 v[98:99], v52 offset0:146 offset1:147
  s_waitcnt lgkmcnt(6)
  v_mfma_f32_16x16x32_bf16 v[60:63], v[100:103], a[20:23], v[60:63]
  v_mfma_f32_16x16x32_bf16 v[64:67], v[100:103], a[52:55], v[64:67]
  v_mfma_f32_16x16x32_bf16 v[68:71], v[100:103], a[84:87], v[68:71]
  v_mfma_f32_16x16x32_bf16 v[72:75], v[100:103], a[116:119], v[72:75]
  v_mfma_f32_16x16x32_bf16 v[76:79], v[100:103], a[148:151], v[76:79]
  v_mfma_f32_16x16x32_bf16 v[80:83], v[100:103], a[180:183], v[80:83]
  v_mfma_f32_16x16x32_bf16 v[84:87], v[100:103], a[212:215], v[84:87]
  v_mfma_f32_16x16x32_bf16 v[88:91], v[100:103], a[244:247], v[88:91]
  ds_read2_b32 v[100:101], v52 offset0:128 offset1:129
  ds_read2_b32 v[102:103], v52 offset0:130 offset1:131
  s_waitcnt lgkmcnt(6)
  v_mfma_f32_16x16x32_bf16 v[60:63], v[104:107], a[16:19], v[60:63]
  v_mfma_f32_16x16x32_bf16 v[64:67], v[104:107], a[48:51], v[64:67]
  v_mfma_f32_16x16x32_bf16 v[68:71], v[104:107], a[80:83], v[68:71]
  v_mfma_f32_16x16x32_bf16 v[72:75], v[104:107], a[112:115], v[72:75]
  v_mfma_f32_16x16x32_bf16 v[76:79], v[104:107], a[144:147], v[76:79]
  v_mfma_f32_16x16x32_bf16 v[80:83], v[104:107], a[176:179], v[80:83]
  v_mfma_f32_16x16x32_bf16 v[84:87], v[104:107], a[208:211], v[84:87]
  v_mfma_f32_16x16x32_bf16 v[88:91], v[104:107], a[240:243], v[88:91]
  ds_read2_b32 v[104:105], v52 offset0:112 offset1:113
  ds_read2_b32 v[106:107], v52 offset0:114 offset1:115
  s_waitcnt lgkmcnt(6)
  v_mfma_f32_16x16x32_bf16 v[60:63], v[92:95], a[12:15], v[60:63]
  v_mfma_f32_16x16x32_bf16 v[64:67], v[92:95], a[44:47], v[64:67]
  v_mfma_f32_16x16x32_bf16 v[68:71], v[92:95], a[76:79], v[68:71]
  v_mfma_f32_16x16x32_bf16 v[72:75], v[92:95], a[108:111], v[72:75]
  v_mfma_f32_16x16x32_bf16 v[76:79], v[92:95], a[140:143], v[76:79]
  v_mfma_f32_16x16x32_bf16 v[80:83], v[92:95], a[172:175], v[80:83]
  v_mfma_f32_16x16x32_bf16 v[84:87], v[92:95], a[204:207], v[84:87]
  v_mfma_f32_16x16x32_bf16 v[88:91], v[92:95], a[236:239], v[88:91]
  ds_read2_b32 v[92:93], v52 offset0:96 offset1:97
  ds_read2_b32 v[94:95], v52 offset0:98 offset1:99
  s_waitcnt lgkmcnt(6)
  v_mfma_f32_16x16x32_bf16 v[60:63], v[96:99], a[8:11], v[60:63]
  v_mfma_f32_16x16x32_bf16 v[64:67], v[96:99], a[40:43], v[64:67]
  v_mfma_f32_16x16x32_bf16 v[68:71], v[96:99], a[72:75], v[68:71]
  v_mfma_f32_16x16x32_bf16 v[72:75], v[96:99], a[104:107], v[72:75]
  v_mfma_f32_16x16x32_bf16 v[76:79], v[96:99], a[136:139], v[76:79]
  v_mfma_f32_16x16x32_bf16 v[80:83], v[96:99], a[168:171], v[80:83]
  v_mfma_f32_16x16x32_bf16 v[84:87], v[96:99], a[200:203], v[84:87]
  v_mfma_f32_16x16x32_bf16 v[88:91], v[96:99], a[232:235], v[88:91]
  ds_read2_b32 v[96:97], v52 offset0:80 offset1:81
  ds_read2_b32 v[98:99], v52 offset0:82 offset1:83
  s_waitcnt lgkmcnt(6)
  v_mfma_f32_16x16x32_bf16 v[60:63], v[100:103], a[4:7], v[60:63]
  v_mfma_f32_16x16x32_bf16 v[64:67], v[100:103], a[36:39], v[64:67]
  v_mfma_f32_16x16x32_bf16 v[68:71], v[100:103], a[68:71], v[68:71]
  v_mfma_f32_16x16x32_bf16 v[72:75], v[100:103], a[100:103], v[72:75]
  v_mfma_f32_16x16x32_bf16 v[76:79], v[100:103], a[132:135], v[76:79]
  v_mfma_f32_16x16x32_bf16 v[80:83], v[100:103], a[164:167], v[80:83]
  v_mfma_f32_16x16x32_bf16 v[84:87], v[100:103], a[196:199], v[84:87]
  v_mfma_f32_16x16x32_bf16 v[88:91], v[100:103], a[228:231], v[88:91]
  ds_read2_b32 v[100:101], v52 offset0:64 offset1:65
  ds_read2_b32 v[102:103], v52 offset0:66 offset1:67
  s_waitcnt lgkmcnt(6)
  v_mfma_f32_16x16x32_bf16 v[60:63], v[104:107], a[0:3], v[60:63]
  v_mfma_f32_16x16x32_bf16 v[64:67], v[104:107], a[32:35], v[64:67]
  v_mfma_f32_16x16x32_bf16 v[68:71], v[104:107], a[64:67], v[68:71]
  v_mfma_f32_16x16x32_bf16 v[72:75], v[104:107], a[96:99], v[72:75]
  v_mfma_f32_16x16x32_bf16 v[76:79], v[104:107], a[128:131], v[76:79]
  v_mfma_f32_16x16x32_bf16 v[80:83], v[104:107], a[160:163], v[80:83]
  v_mfma_f32_16x16x32_bf16 v[84:87], v[104:107], a[192:195], v[84:87]
  v_mfma_f32_16x16x32_bf16 v[88:91], v[104:107], a[224:227], v[88:91]
  ds_read2_b32 v[104:105], v52 offset0:48 offset1:49
  ds_read2_b32 v[106:107], v52 offset0:50 offset1:51
  s_waitcnt lgkmcnt(6)
  v_mfma_f32_16x16x32_bf16 v[64:67], v[92:95], a[28:31], v[64:67]
  v_mfma_f32_16x16x32_bf16 v[68:71], v[92:95], a[60:63], v[68:71]
  v_mfma_f32_16x16x32_bf16 v[72:75], v[92:95], a[92:95], v[72:75]
  v_mfma_f32_16x16x32_bf16 v[76:79], v[92:95], a[124:127], v[76:79]
  v_mfma_f32_16x16x32_bf16 v[80:83], v[92:95], a[156:159], v[80:83]
  v_mfma_f32_16x16x32_bf16 v[84:87], v[92:95], a[188:191], v[84:87]
  v_mfma_f32_16x16x32_bf16 v[88:91], v[92:95], a[220:223], v[88:91]
  ds_read2_b32 v[92:93], v52 offset0:32 offset1:33
  ds_read2_b32 v[94:95], v52 offset0:34 offset1:35
  s_waitcnt lgkmcnt(6)
  v_mfma_f32_16x16x32_bf16 v[64:67], v[96:99], a[24:27], v[64:67]
  v_mfma_f32_16x16x32_bf16 v[68:71], v[96:99], a[56:59], v[68:71]
  v_mfma_f32_16x16x32_bf16 v[72:75], v[96:99], a[88:91], v[72:75]
  v_mfma_f32_16x16x32_bf16 v[76:79], v[96:99], a[120:123], v[76:79]
  v_mfma_f32_16x16x32_bf16 v[80:83], v[96:99], a[152:155], v[80:83]
  v_mfma_f32_16x16x32_bf16 v[84:87], v[96:99], a[184:187], v[84:87]
  v_mfma_f32_16x16x32_bf16 v[88:91], v[96:99], a[216:219], v[88:91]
  ds_read2_b32 v[96:97], v52 offset0:16 offset1:17
  ds_read2_b32 v[98:99], v52 offset0:18 offset1:19
  s_waitcnt lgkmcnt(6)
  v_mfma_f32_16x16x32_bf16 v[64:67], v[100:103], a[20:23], v[64:67]
  v_mfma_f32_16x16x32_bf16 v[68:71], v[100:103], a[52:55], v[68:71]
  v_mfma_f32_16x16x32_bf16 v[72:75], v[100:103], a[84:87], v[72:75]
  v_mfma_f32_16x16x32_bf16 v[76:79], v[100:103], a[116:119], v[76:79]
  v_mfma_f32_16x16x32_bf16 v[80:83], v[100:103], a[148:151], v[80:83]
  v_mfma_f32_16x16x32_bf16 v[84:87], v[100:103], a[180:183], v[84:87]
  v_mfma_f32_16x16x32_bf16 v[88:91], v[100:103], a[212:215], v[88:91]
  ds_read2_b32 v[100:101], v52 offset0:0 offset1:1
  ds_read2_b32 v[102:103], v52 offset0:2 offset1:3
  s_waitcnt lgkmcnt(6)
  v_mfma_f32_16x16x32_bf16 v[64:67], v[104:107], a[16:19], v[64:67]
  v_mfma_f32_16x16x32_bf16 v[68:71], v[104:107], a[48:51], v[68:71]
  v_mfma_f32_16x16x32_bf16 v[72:75], v[104:107], a[80:83], v[72:75]
  v_mfma_f32_16x16x32_bf16 v[76:79], v[104:107], a[112:115], v[76:79]
  v_mfma_f32_16x16x32_bf16 v[80:83], v[104:107], a[144:147], v[80:83]
  v_mfma_f32_16x16x32_bf16 v[84:87], v[104:107], a[176:179], v[84:87]
  v_mfma_f32_16x16x32_bf16 v[88:91], v[104:107], a[208:211], v[88:91]
  ds_read2_b32 v[104:105], v53 offset0:224 offset1:225
  ds_read2_b32 v[106:107], v53 offset0:226 offset1:227
  s_waitcnt lgkmcnt(6)
  v_mfma_f32_16x16x32_bf16 v[64:67], v[92:95], a[12:15], v[64:67]
  v_mfma_f32_16x16x32_bf16 v[68:71], v[92:95], a[44:47], v[68:71]
  v_mfma_f32_16x16x32_bf16 v[72:75], v[92:95], a[76:79], v[72:75]
  v_mfma_f32_16x16x32_bf16 v[76:79], v[92:95], a[108:111], v[76:79]
  v_mfma_f32_16x16x32_bf16 v[80:83], v[92:95], a[140:143], v[80:83]
  v_mfma_f32_16x16x32_bf16 v[84:87], v[92:95], a[172:175], v[84:87]
  v_mfma_f32_16x16x32_bf16 v[88:91], v[92:95], a[204:207], v[88:91]
  ds_read2_b32 v[92:93], v53 offset0:208 offset1:209
  ds_read2_b32 v[94:95], v53 offset0:210 offset1:211
  s_waitcnt lgkmcnt(6)
  v_mfma_f32_16x16x32_bf16 v[64:67], v[96:99], a[8:11], v[64:67]
  v_mfma_f32_16x16x32_bf16 v[68:71], v[96:99], a[40:43], v[68:71]
  v_mfma_f32_16x16x32_bf16 v[72:75], v[96:99], a[72:75], v[72:75]
  v_mfma_f32_16x16x32_bf16 v[76:79], v[96:99], a[104:107], v[76:79]
  v_mfma_f32_16x16x32_bf16 v[80:83], v[96:99], a[136:139], v[80:83]
  v_mfma_f32_16x16x32_bf16 v[84:87], v[96:99], a[168:171], v[84:87]
  v_mfma_f32_16x16x32_bf16 v[88:91], v[96:99], a[200:203], v[88:91]
  ds_read2_b32 v[96:97], v53 offset0:192 offset1:193
  ds_read2_b32 v[98:99], v53 offset0:194 offset1:195
  s_waitcnt lgkmcnt(6)
  v_mfma_f32_16x16x32_bf16 v[64:67], v[100:103], a[4:7], v[64:67]
  v_mfma_f32_16x16x32_bf16 v[68:71], v[100:103], a[36:39], v[68:71]
  v_mfma_f32_16x16x32_bf16 v[72:75], v[100:103], a[68:71], v[72:75]
  v_mfma_f32_16x16x32_bf16 v[76:79], v[100:103], a[100:103], v[76:79]
  v_mfma_f32_16x16x32_bf16 v[80:83], v[100:103], a[132:135], v[80:83]
  v_mfma_f32_16x16x32_bf16 v[84:87], v[100:103], a[164:167], v[84:87]
  v_mfma_f32_16x16x32_bf16 v[88:91], v[100:103], a[196:199], v[88:91]
  ds_read2_b32 v[100:101], v53 offset0:176 offset1:177
  ds_read2_b32 v[102:103], v53 offset0:178 offset1:179
  s_waitcnt lgkmcnt(6)
  v_mfma_f32_16x16x32_bf16 v[64:67], v[104:107], a[0:3], v[64:67]
  v_mfma_f32_16x16x32_bf16 v[68:71], v[104:107], a[32:35], v[68:71]
  v_mfma_f32_16x16x32_bf16 v[72:75], v[104:107], a[64:67], v[72:75]
  v_mfma_f32_16x16x32_bf16 v[76:79], v[104:107], a[96:99], v[76:79]
  v_mfma_f32_16x16x32_bf16 v[80:83], v[104:107], a[128:131], v[80:83]
  v_mfma_f32_16x16x32_bf16 v[84:87], v[104:107], a[160:163], v[84:87]
  v_mfma_f32_16x16x32_bf16 v[88:91], v[104:107], a[192:195], v[88:91]
  ds_read2_b32 v[104:105], v53 offset0:160 offset1:161
  ds_read2_b32 v[106:107], v53 offset0:162 offset1:163
  s_waitcnt lgkmcnt(6)
  v_mfma_f32_16x16x32_bf16 v[68:71], v[92:95], a[28:31], v[68:71]
  v_mfma_f32_16x16x32_bf16 v[72:75], v[92:95], a[60:63], v[72:75]
  v_mfma_f32_16x16x32_bf16 v[76:79], v[92:95], a[92:95], v[76:79]
  v_mfma_f32_16x16x32_bf16 v[80:83], v[92:95], a[124:127], v[80:83]
  v_mfma_f32_16x16x32_bf16 v[84:87], v[92:95], a[156:159], v[84:87]
  v_mfma_f32_16x16x32_bf16 v[88:91], v[92:95], a[188:191], v[88:91]
  ds_read2_b32 v[92:93], v53 offset0:144 offset1:145
  ds_read2_b32 v[94:95], v53 offset0:146 offset1:147
  s_waitcnt lgkmcnt(6)
  v_mfma_f32_16x16x32_bf16 v[68:71], v[96:99], a[24:27], v[68:71]
  v_mfma_f32_16x16x32_bf16 v[72:75], v[96:99], a[56:59], v[72:75]
  v_mfma_f32_16x16x32_bf16 v[76:79], v[96:99], a[88:91], v[76:79]
  v_mfma_f32_16x16x32_bf16 v[80:83], v[96:99], a[120:123], v[80:83]
  v_mfma_f32_16x16x32_bf16 v[84:87], v[96:99], a[152:155], v[84:87]
  v_mfma_f32_16x16x32_bf16 v[88:91], v[96:99], a[184:187], v[88:91]
  ds_read2_b32 v[96:97], v53 offset0:128 offset1:129
  ds_read2_b32 v[98:99], v53 offset0:130 offset1:131
  s_waitcnt lgkmcnt(6)
  v_mfma_f32_16x16x32_bf16 v[68:71], v[100:103], a[20:23], v[68:71]
  v_mfma_f32_16x16x32_bf16 v[72:75], v[100:103], a[52:55], v[72:75]
  v_mfma_f32_16x16x32_bf16 v[76:79], v[100:103], a[84:87], v[76:79]
  v_mfma_f32_16x16x32_bf16 v[80:83], v[100:103], a[116:119], v[80:83]
  v_mfma_f32_16x16x32_bf16 v[84:87], v[100:103], a[148:151], v[84:87]
  v_mfma_f32_16x16x32_bf16 v[88:91], v[100:103], a[180:183], v[88:91]
  ds_read2_b32 v[100:101], v53 offset0:112 offset1:113
  ds_read2_b32 v[102:103], v53 offset0:114 offset1:115
  s_waitcnt lgkmcnt(6)
  v_mfma_f32_16x16x32_bf16 v[68:71], v[104:107], a[16:19], v[68:71]
  v_mfma_f32_16x16x32_bf16 v[72:75], v[104:107], a[48:51], v[72:75]
  v_mfma_f32_16x16x32_bf16 v[76:79], v[104:107], a[80:83], v[76:79]
  v_mfma_f32_16x16x32_bf16 v[80:83], v[104:107], a[112:115], v[80:83]
  v_mfma_f32_16x16x32_bf16 v[84:87], v[104:107], a[144:147], v[84:87]
  v_mfma_f32_16x16x32_bf16 v[88:91], v[104:107], a[176:179], v[88:91]
  ds_read2_b32 v[104:105], v53 offset0:96 offset1:97
  ds_read2_b32 v[106:107], v53 offset0:98 offset1:99
  s_waitcnt lgkmcnt(6)
  v_mfma_f32_16x16x32_bf16 v[68:71], v[92:95], a[12:15], v[68:71]
  v_mfma_f32_16x16x32_bf16 v[72:75], v[92:95], a[44:47], v[72:75]
  v_mfma_f32_16x16x32_bf16 v[76:79], v[92:95], a[76:79], v[76:79]
  v_mfma_f32_16x16x32_bf16 v[80:83], v[92:95], a[108:111], v[80:83]
  v_mfma_f32_16x16x32_bf16 v[84:87], v[92:95], a[140:143], v[84:87]
  v_mfma_f32_16x16x32_bf16 v[88:91], v[92:95], a[172:175], v[88:91]
  ds_read2_b32 v[92:93], v53 offset0:80 offset1:81
  ds_read2_b32 v[94:95], v53 offset0:82 offset1:83
  s_waitcnt lgkmcnt(6)
  v_mfma_f32_16x16x32_bf16 v[68:71], v[96:99], a[8:11], v[68:71]
  v_mfma_f32_16x16x32_bf16 v[72:75], v[96:99], a[40:43], v[72:75]
  v_mfma_f32_16x16x32_bf16 v[76:79], v[96:99], a[72:75], v[76:79]
  v_mfma_f32_16x16x32_bf16 v[80:83], v[96:99], a[104:107], v[80:83]
  v_mfma_f32_16x16x32_bf16 v[84:87], v[96:99], a[136:139], v[84:87]
  v_mfma_f32_16x16x32_bf16 v[88:91], v[96:99], a[168:171], v[88:91]
  ds_read2_b32 v[96:97], v53 offset0:64 offset1:65
  ds_read2_b32 v[98:99], v53 offset0:66 offset1:67
  s_waitcnt lgkmcnt(6)
  v_mfma_f32_16x16x32_bf16 v[68:71], v[100:103], a[4:7], v[68:71]
  v_mfma_f32_16x16x32_bf16 v[72:75], v[100:103], a[36:39], v[72:75]
  v_mfma_f32_16x16x32_bf16 v[76:79], v[100:103], a[68:71], v[76:79]
  v_mfma_f32_16x16x32_bf16 v[80:83], v[100:103], a[100:103], v[80:83]
  v_mfma_f32_16x16x32_bf16 v[84:87], v[100:103], a[132:135], v[84:87]
  v_mfma_f32_16x16x32_bf16 v[88:91], v[100:103], a[164:167], v[88:91]
  ds_read2_b32 v[100:101], v53 offset0:48 offset1:49
  ds_read2_b32 v[102:103], v53 offset0:50 offset1:51
  s_waitcnt lgkmcnt(6)
  v_mfma_f32_16x16x32_bf16 v[68:71], v[104:107], a[0:3], v[68:71]
  v_mfma_f32_16x16x32_bf16 v[72:75], v[104:107], a[32:35], v[72:75]
  v_mfma_f32_16x16x32_bf16 v[76:79], v[104:107], a[64:67], v[76:79]
  v_mfma_f32_16x16x32_bf16 v[80:83], v[104:107], a[96:99], v[80:83]
  v_mfma_f32_16x16x32_bf16 v[84:87], v[104:107], a[128:131], v[84:87]
  v_mfma_f32_16x16x32_bf16 v[88:91], v[104:107], a[160:163], v[88:91]
  ds_read2_b32 v[104:105], v53 offset0:32 offset1:33
  ds_read2_b32 v[106:107], v53 offset0:34 offset1:35
  s_waitcnt lgkmcnt(6)
  v_mfma_f32_16x16x32_bf16 v[72:75], v[92:95], a[28:31], v[72:75]
  v_mfma_f32_16x16x32_bf16 v[76:79], v[92:95], a[60:63], v[76:79]
  v_mfma_f32_16x16x32_bf16 v[80:83], v[92:95], a[92:95], v[80:83]
  v_mfma_f32_16x16x32_bf16 v[84:87], v[92:95], a[124:127], v[84:87]
  v_mfma_f32_16x16x32_bf16 v[88:91], v[92:95], a[156:159], v[88:91]
  ds_read2_b32 v[92:93], v53 offset0:16 offset1:17
  ds_read2_b32 v[94:95], v53 offset0:18 offset1:19
  s_waitcnt lgkmcnt(6)
  v_mfma_f32_16x16x32_bf16 v[72:75], v[96:99], a[24:27], v[72:75]
  v_mfma_f32_16x16x32_bf16 v[76:79], v[96:99], a[56:59], v[76:79]
  v_mfma_f32_16x16x32_bf16 v[80:83], v[96:99], a[88:91], v[80:83]
  v_mfma_f32_16x16x32_bf16 v[84:87], v[96:99], a[120:123], v[84:87]
  v_mfma_f32_16x16x32_bf16 v[88:91], v[96:99], a[152:155], v[88:91]
  ds_read2_b32 v[96:97], v53 offset0:0 offset1:1
  ds_read2_b32 v[98:99], v53 offset0:2 offset1:3
  s_waitcnt lgkmcnt(6)
  v_mfma_f32_16x16x32_bf16 v[72:75], v[100:103], a[20:23], v[72:75]
  v_mfma_f32_16x16x32_bf16 v[76:79], v[100:103], a[52:55], v[76:79]
  v_mfma_f32_16x16x32_bf16 v[80:83], v[100:103], a[84:87], v[80:83]
  v_mfma_f32_16x16x32_bf16 v[84:87], v[100:103], a[116:119], v[84:87]
  v_mfma_f32_16x16x32_bf16 v[88:91], v[100:103], a[148:151], v[88:91]
  ds_read2_b32 v[100:101], v54 offset0:224 offset1:225
  ds_read2_b32 v[102:103], v54 offset0:226 offset1:227
  s_waitcnt lgkmcnt(6)
  v_mfma_f32_16x16x32_bf16 v[72:75], v[104:107], a[16:19], v[72:75]
  v_mfma_f32_16x16x32_bf16 v[76:79], v[104:107], a[48:51], v[76:79]
  v_mfma_f32_16x16x32_bf16 v[80:83], v[104:107], a[80:83], v[80:83]
  v_mfma_f32_16x16x32_bf16 v[84:87], v[104:107], a[112:115], v[84:87]
  v_mfma_f32_16x16x32_bf16 v[88:91], v[104:107], a[144:147], v[88:91]
  ds_read2_b32 v[104:105], v54 offset0:208 offset1:209
  ds_read2_b32 v[106:107], v54 offset0:210 offset1:211
  s_waitcnt lgkmcnt(6)
  v_mfma_f32_16x16x32_bf16 v[72:75], v[92:95], a[12:15], v[72:75]
  v_mfma_f32_16x16x32_bf16 v[76:79], v[92:95], a[44:47], v[76:79]
  v_mfma_f32_16x16x32_bf16 v[80:83], v[92:95], a[76:79], v[80:83]
  v_mfma_f32_16x16x32_bf16 v[84:87], v[92:95], a[108:111], v[84:87]
  v_mfma_f32_16x16x32_bf16 v[88:91], v[92:95], a[140:143], v[88:91]
  ds_read2_b32 v[92:93], v54 offset0:192 offset1:193
  ds_read2_b32 v[94:95], v54 offset0:194 offset1:195
  s_waitcnt lgkmcnt(6)
  v_mfma_f32_16x16x32_bf16 v[72:75], v[96:99], a[8:11], v[72:75]
  v_mfma_f32_16x16x32_bf16 v[76:79], v[96:99], a[40:43], v[76:79]
  v_mfma_f32_16x16x32_bf16 v[80:83], v[96:99], a[72:75], v[80:83]
  v_mfma_f32_16x16x32_bf16 v[84:87], v[96:99], a[104:107], v[84:87]
  v_mfma_f32_16x16x32_bf16 v[88:91], v[96:99], a[136:139], v[88:91]
  ds_read2_b32 v[96:97], v54 offset0:176 offset1:177
  ds_read2_b32 v[98:99], v54 offset0:178 offset1:179
  s_waitcnt lgkmcnt(6)
  v_mfma_f32_16x16x32_bf16 v[72:75], v[100:103], a[4:7], v[72:75]
  v_mfma_f32_16x16x32_bf16 v[76:79], v[100:103], a[36:39], v[76:79]
  v_mfma_f32_16x16x32_bf16 v[80:83], v[100:103], a[68:71], v[80:83]
  v_mfma_f32_16x16x32_bf16 v[84:87], v[100:103], a[100:103], v[84:87]
  v_mfma_f32_16x16x32_bf16 v[88:91], v[100:103], a[132:135], v[88:91]
  ds_read2_b32 v[100:101], v54 offset0:160 offset1:161
  ds_read2_b32 v[102:103], v54 offset0:162 offset1:163
  s_waitcnt lgkmcnt(6)
  v_mfma_f32_16x16x32_bf16 v[72:75], v[104:107], a[0:3], v[72:75]
  v_mfma_f32_16x16x32_bf16 v[76:79], v[104:107], a[32:35], v[76:79]
  v_mfma_f32_16x16x32_bf16 v[80:83], v[104:107], a[64:67], v[80:83]
  v_mfma_f32_16x16x32_bf16 v[84:87], v[104:107], a[96:99], v[84:87]
  v_mfma_f32_16x16x32_bf16 v[88:91], v[104:107], a[128:131], v[88:91]
  ds_read2_b32 v[104:105], v54 offset0:144 offset1:145
  ds_read2_b32 v[106:107], v54 offset0:146 offset1:147
  s_waitcnt lgkmcnt(6)
  v_mfma_f32_16x16x32_bf16 v[76:79], v[92:95], a[28:31], v[76:79]
  v_mfma_f32_16x16x32_bf16 v[80:83], v[92:95], a[60:63], v[80:83]
  v_mfma_f32_16x16x32_bf16 v[84:87], v[92:95], a[92:95], v[84:87]
  v_mfma_f32_16x16x32_bf16 v[88:91], v[92:95], a[124:127], v[88:91]
  ds_read2_b32 v[92:93], v54 offset0:128 offset1:129
  ds_read2_b32 v[94:95], v54 offset0:130 offset1:131
  s_waitcnt lgkmcnt(6)
  v_mfma_f32_16x16x32_bf16 v[76:79], v[96:99], a[24:27], v[76:79]
  v_mfma_f32_16x16x32_bf16 v[80:83], v[96:99], a[56:59], v[80:83]
  v_mfma_f32_16x16x32_bf16 v[84:87], v[96:99], a[88:91], v[84:87]
  v_mfma_f32_16x16x32_bf16 v[88:91], v[96:99], a[120:123], v[88:91]
  ds_read2_b32 v[96:97], v54 offset0:112 offset1:113
  ds_read2_b32 v[98:99], v54 offset0:114 offset1:115
  s_waitcnt lgkmcnt(6)
  v_mfma_f32_16x16x32_bf16 v[76:79], v[100:103], a[20:23], v[76:79]
  v_mfma_f32_16x16x32_bf16 v[80:83], v[100:103], a[52:55], v[80:83]
  v_mfma_f32_16x16x32_bf16 v[84:87], v[100:103], a[84:87], v[84:87]
  v_mfma_f32_16x16x32_bf16 v[88:91], v[100:103], a[116:119], v[88:91]
  ds_read2_b32 v[100:101], v54 offset0:96 offset1:97
  ds_read2_b32 v[102:103], v54 offset0:98 offset1:99
  s_waitcnt lgkmcnt(6)
  v_mfma_f32_16x16x32_bf16 v[76:79], v[104:107], a[16:19], v[76:79]
  v_mfma_f32_16x16x32_bf16 v[80:83], v[104:107], a[48:51], v[80:83]
  v_mfma_f32_16x16x32_bf16 v[84:87], v[104:107], a[80:83], v[84:87]
  v_mfma_f32_16x16x32_bf16 v[88:91], v[104:107], a[112:115], v[88:91]
  ds_read2_b32 v[104:105], v54 offset0:80 offset1:81
  ds_read2_b32 v[106:107], v54 offset0:82 offset1:83
  s_waitcnt lgkmcnt(6)
  v_mfma_f32_16x16x32_bf16 v[76:79], v[92:95], a[12:15], v[76:79]
  v_mfma_f32_16x16x32_bf16 v[80:83], v[92:95], a[44:47], v[80:83]
  v_mfma_f32_16x16x32_bf16 v[84:87], v[92:95], a[76:79], v[84:87]
  v_mfma_f32_16x16x32_bf16 v[88:91], v[92:95], a[108:111], v[88:91]
  ds_read2_b32 v[92:93], v54 offset0:64 offset1:65
  ds_read2_b32 v[94:95], v54 offset0:66 offset1:67
  s_waitcnt lgkmcnt(6)
  v_mfma_f32_16x16x32_bf16 v[76:79], v[96:99], a[8:11], v[76:79]
  v_mfma_f32_16x16x32_bf16 v[80:83], v[96:99], a[40:43], v[80:83]
  v_mfma_f32_16x16x32_bf16 v[84:87], v[96:99], a[72:75], v[84:87]
  v_mfma_f32_16x16x32_bf16 v[88:91], v[96:99], a[104:107], v[88:91]
  ds_read2_b32 v[96:97], v54 offset0:48 offset1:49
  ds_read2_b32 v[98:99], v54 offset0:50 offset1:51
  s_waitcnt lgkmcnt(6)
  v_mfma_f32_16x16x32_bf16 v[76:79], v[100:103], a[4:7], v[76:79]
  v_mfma_f32_16x16x32_bf16 v[80:83], v[100:103], a[36:39], v[80:83]
  v_mfma_f32_16x16x32_bf16 v[84:87], v[100:103], a[68:71], v[84:87]
  v_mfma_f32_16x16x32_bf16 v[88:91], v[100:103], a[100:103], v[88:91]
  ds_read2_b32 v[100:101], v54 offset0:32 offset1:33
  ds_read2_b32 v[102:103], v54 offset0:34 offset1:35
  s_waitcnt lgkmcnt(6)
  v_mfma_f32_16x16x32_bf16 v[76:79], v[104:107], a[0:3], v[76:79]
  v_mfma_f32_16x16x32_bf16 v[80:83], v[104:107], a[32:35], v[80:83]
  v_mfma_f32_16x16x32_bf16 v[84:87], v[104:107], a[64:67], v[84:87]
  v_mfma_f32_16x16x32_bf16 v[88:91], v[104:107], a[96:99], v[88:91]
  ds_read2_b32 v[104:105], v54 offset0:16 offset1:17
  ds_read2_b32 v[106:107], v54 offset0:18 offset1:19
  s_waitcnt lgkmcnt(6)
  v_mfma_f32_16x16x32_bf16 v[80:83], v[92:95], a[28:31], v[80:83]
  v_mfma_f32_16x16x32_bf16 v[84:87], v[92:95], a[60:63], v[84:87]
  v_mfma_f32_16x16x32_bf16 v[88:91], v[92:95], a[92:95], v[88:91]
  ds_read2_b32 v[92:93], v54 offset0:0 offset1:1
  ds_read2_b32 v[94:95], v54 offset0:2 offset1:3
  s_waitcnt lgkmcnt(6)
  v_mfma_f32_16x16x32_bf16 v[80:83], v[96:99], a[24:27], v[80:83]
  v_mfma_f32_16x16x32_bf16 v[84:87], v[96:99], a[56:59], v[84:87]
  v_mfma_f32_16x16x32_bf16 v[88:91], v[96:99], a[88:91], v[88:91]
  ds_read2_b32 v[96:97], v55 offset0:224 offset1:225
  ds_read2_b32 v[98:99], v55 offset0:226 offset1:227
  s_waitcnt lgkmcnt(6)
  v_mfma_f32_16x16x32_bf16 v[80:83], v[100:103], a[20:23], v[80:83]
  v_mfma_f32_16x16x32_bf16 v[84:87], v[100:103], a[52:55], v[84:87]
  v_mfma_f32_16x16x32_bf16 v[88:91], v[100:103], a[84:87], v[88:91]
  ds_read2_b32 v[100:101], v55 offset0:208 offset1:209
  ds_read2_b32 v[102:103], v55 offset0:210 offset1:211
  s_waitcnt lgkmcnt(6)
  v_mfma_f32_16x16x32_bf16 v[80:83], v[104:107], a[16:19], v[80:83]
  v_mfma_f32_16x16x32_bf16 v[84:87], v[104:107], a[48:51], v[84:87]
  v_mfma_f32_16x16x32_bf16 v[88:91], v[104:107], a[80:83], v[88:91]
  ds_read2_b32 v[104:105], v55 offset0:192 offset1:193
  ds_read2_b32 v[106:107], v55 offset0:194 offset1:195
  s_waitcnt lgkmcnt(6)
  v_mfma_f32_16x16x32_bf16 v[80:83], v[92:95], a[12:15], v[80:83]
  v_mfma_f32_16x16x32_bf16 v[84:87], v[92:95], a[44:47], v[84:87]
  v_mfma_f32_16x16x32_bf16 v[88:91], v[92:95], a[76:79], v[88:91]
  ds_read2_b32 v[92:93], v55 offset0:176 offset1:177
  ds_read2_b32 v[94:95], v55 offset0:178 offset1:179
  s_waitcnt lgkmcnt(6)
  v_mfma_f32_16x16x32_bf16 v[80:83], v[96:99], a[8:11], v[80:83]
  v_mfma_f32_16x16x32_bf16 v[84:87], v[96:99], a[40:43], v[84:87]
  v_mfma_f32_16x16x32_bf16 v[88:91], v[96:99], a[72:75], v[88:91]
  ds_read2_b32 v[96:97], v55 offset0:160 offset1:161
  ds_read2_b32 v[98:99], v55 offset0:162 offset1:163
  s_waitcnt lgkmcnt(6)
  v_mfma_f32_16x16x32_bf16 v[80:83], v[100:103], a[4:7], v[80:83]
  v_mfma_f32_16x16x32_bf16 v[84:87], v[100:103], a[36:39], v[84:87]
  v_mfma_f32_16x16x32_bf16 v[88:91], v[100:103], a[68:71], v[88:91]
  ds_read2_b32 v[100:101], v55 offset0:144 offset1:145
  ds_read2_b32 v[102:103], v55 offset0:146 offset1:147
  s_waitcnt lgkmcnt(6)
  v_mfma_f32_16x16x32_bf16 v[80:83], v[104:107], a[0:3], v[80:83]
  v_mfma_f32_16x16x32_bf16 v[84:87], v[104:107], a[32:35], v[84:87]
  v_mfma_f32_16x16x32_bf16 v[88:91], v[104:107], a[64:67], v[88:91]
  ds_read2_b32 v[104:105], v55 offset0:128 offset1:129
  ds_read2_b32 v[106:107], v55 offset0:130 offset1:131
  s_waitcnt lgkmcnt(6)
  v_mfma_f32_16x16x32_bf16 v[84:87], v[92:95], a[28:31], v[84:87]
  v_mfma_f32_16x16x32_bf16 v[88:91], v[92:95], a[60:63], v[88:91]
  ds_read2_b32 v[92:93], v55 offset0:112 offset1:113
  ds_read2_b32 v[94:95], v55 offset0:114 offset1:115
  s_waitcnt lgkmcnt(6)
  v_mfma_f32_16x16x32_bf16 v[84:87], v[96:99], a[24:27], v[84:87]
  v_mfma_f32_16x16x32_bf16 v[88:91], v[96:99], a[56:59], v[88:91]
  ds_read2_b32 v[96:97], v55 offset0:96 offset1:97
  ds_read2_b32 v[98:99], v55 offset0:98 offset1:99
  s_waitcnt lgkmcnt(6)
  v_mfma_f32_16x16x32_bf16 v[84:87], v[100:103], a[20:23], v[84:87]
  v_mfma_f32_16x16x32_bf16 v[88:91], v[100:103], a[52:55], v[88:91]
  ds_read2_b32 v[100:101], v55 offset0:80 offset1:81
  ds_read2_b32 v[102:103], v55 offset0:82 offset1:83
  s_waitcnt lgkmcnt(6)
  v_mfma_f32_16x16x32_bf16 v[84:87], v[104:107], a[16:19], v[84:87]
  v_mfma_f32_16x16x32_bf16 v[88:91], v[104:107], a[48:51], v[88:91]
  ds_read2_b32 v[104:105], v55 offset0:64 offset1:65
  ds_read2_b32 v[106:107], v55 offset0:66 offset1:67
  s_waitcnt lgkmcnt(6)
  v_mfma_f32_16x16x32_bf16 v[84:87], v[92:95], a[12:15], v[84:87]
  v_mfma_f32_16x16x32_bf16 v[88:91], v[92:95], a[44:47], v[88:91]
  ds_read2_b32 v[92:93], v55 offset0:48 offset1:49
  ds_read2_b32 v[94:95], v55 offset0:50 offset1:51
  s_waitcnt lgkmcnt(6)
  v_mfma_f32_16x16x32_bf16 v[84:87], v[96:99], a[8:11], v[84:87]
  v_mfma_f32_16x16x32_bf16 v[88:91], v[96:99], a[40:43], v[88:91]
  ds_read2_b32 v[96:97], v55 offset0:32 offset1:33
  ds_read2_b32 v[98:99], v55 offset0:34 offset1:35
  s_waitcnt lgkmcnt(6)
  v_mfma_f32_16x16x32_bf16 v[84:87], v[100:103], a[4:7], v[84:87]
  v_mfma_f32_16x16x32_bf16 v[88:91], v[100:103], a[36:39], v[88:91]
  ds_read2_b32 v[100:101], v55 offset0:16 offset1:17
  ds_read2_b32 v[102:103], v55 offset0:18 offset1:19
  s_waitcnt lgkmcnt(6)
  v_mfma_f32_16x16x32_bf16 v[84:87], v[104:107], a[0:3], v[84:87]
  v_mfma_f32_16x16x32_bf16 v[88:91], v[104:107], a[32:35], v[88:91]
  ds_read2_b32 v[104:105], v55 offset0:0 offset1:1
  ds_read2_b32 v[106:107], v55 offset0:2 offset1:3
  s_waitcnt lgkmcnt(6)
  v_mfma_f32_16x16x32_bf16 v[88:91], v[92:95], a[28:31], v[88:91]
  ds_read2_b32 v[92:93], v56 offset0:224 offset1:225
  ds_read2_b32 v[94:95], v56 offset0:226 offset1:227
  s_waitcnt lgkmcnt(6)
  v_mfma_f32_16x16x32_bf16 v[88:91], v[96:99], a[24:27], v[88:91]
  ds_read2_b32 v[96:97], v56 offset0:208 offset1:209
  ds_read2_b32 v[98:99], v56 offset0:210 offset1:211
  s_waitcnt lgkmcnt(6)
  v_mfma_f32_16x16x32_bf16 v[88:91], v[100:103], a[20:23], v[88:91]
  ds_read2_b32 v[100:101], v56 offset0:192 offset1:193
  ds_read2_b32 v[102:103], v56 offset0:194 offset1:195
  s_waitcnt lgkmcnt(6)
  v_mfma_f32_16x16x32_bf16 v[88:91], v[104:107], a[16:19], v[88:91]
  ds_read2_b32 v[104:105], v56 offset0:176 offset1:177
  ds_read2_b32 v[106:107], v56 offset0:178 offset1:179
  s_waitcnt lgkmcnt(6)
  v_mfma_f32_16x16x32_bf16 v[88:91], v[92:95], a[12:15], v[88:91]
  s_waitcnt lgkmcnt(4)
  v_mfma_f32_16x16x32_bf16 v[88:91], v[96:99], a[8:11], v[88:91]
  s_waitcnt lgkmcnt(2)
  v_mfma_f32_16x16x32_bf16 v[88:91], v[100:103], a[4:7], v[88:91]
  s_waitcnt lgkmcnt(0)
  v_mfma_f32_16x16x32_bf16 v[88:91], v[104:107], a[0:3], v[88:91]
  v_lshlrev_b32 v46, 5, v4
  v_lshl_add_u32 v46, v3, 3, v46
  v_add_u32 v46, s17, v46
  ds_read_b64 v[108:109], v46 offset:512
  ds_read_b64 v[110:111], v46 offset:1024
  ds_read_b64 v[112:113], v46 offset:1536
  ds_read_b64 v[114:115], v46 offset:2048
  ds_read_b64 v[116:117], v46 offset:2560
  ds_read_b64 v[118:119], v46 offset:3072
  ds_read_b64 v[120:121], v46 offset:3584
  ds_read_b64 v[122:123], v46 offset:4096
  s_waitcnt lgkmcnt(0)
  v_lshlrev_b32 v124, 16, v108
  v_and_b32 v125, 0xffff0000, v108
  v_lshlrev_b32 v126, 16, v109
  v_and_b32 v127, 0xffff0000, v109
  v_mul_f32 v124, v124, v33
  v_mul_f32 v125, v125, v33
  v_mul_f32 v126, v126, v33
  v_mul_f32 v127, v127, v33
  v_cvt_pk_bf16_f32 v128, v124, v125
  v_cvt_pk_bf16_f32 v129, v126, v127
  v_cvt_pk_bf16_f32 v130, v60, v61
  v_cvt_pk_bf16_f32 v131, v62, v63
  v_lshlrev_b32 v124, 16, v128
  v_and_b32 v125, 0xffff0000, v128
  v_lshlrev_b32 v132, 16, v130
  v_and_b32 v133, 0xffff0000, v130
  v_lshlrev_b32 v126, 16, v129
  v_and_b32 v127, 0xffff0000, v129
  v_lshlrev_b32 v134, 16, v131
  v_and_b32 v135, 0xffff0000, v131
  v_add_f32 v124, v124, v132
  v_add_f32 v125, v125, v133
  v_add_f32 v126, v126, v134
  v_add_f32 v127, v127, v135
  v_cvt_pk_bf16_f32 v108, v124, v125
  v_cvt_pk_bf16_f32 v109, v126, v127
  ds_write_b64 v46, v[108:109] offset:512
  v_lshlrev_b32 v124, 16, v110
  v_and_b32 v125, 0xffff0000, v110
  v_lshlrev_b32 v126, 16, v111
  v_and_b32 v127, 0xffff0000, v111
  v_mul_f32 v124, v124, v33
  v_mul_f32 v125, v125, v33
  v_mul_f32 v126, v126, v33
  v_mul_f32 v127, v127, v33
  v_cvt_pk_bf16_f32 v128, v124, v125
  v_cvt_pk_bf16_f32 v129, v126, v127
  v_cvt_pk_bf16_f32 v130, v64, v65
  v_cvt_pk_bf16_f32 v131, v66, v67
  v_lshlrev_b32 v124, 16, v128
  v_and_b32 v125, 0xffff0000, v128
  v_lshlrev_b32 v132, 16, v130
  v_and_b32 v133, 0xffff0000, v130
  v_lshlrev_b32 v126, 16, v129
  v_and_b32 v127, 0xffff0000, v129
  v_lshlrev_b32 v134, 16, v131
  v_and_b32 v135, 0xffff0000, v131
  v_add_f32 v124, v124, v132
  v_add_f32 v125, v125, v133
  v_add_f32 v126, v126, v134
  v_add_f32 v127, v127, v135
  v_cvt_pk_bf16_f32 v110, v124, v125
  v_cvt_pk_bf16_f32 v111, v126, v127
  ds_write_b64 v46, v[110:111] offset:1024
  v_lshlrev_b32 v124, 16, v112
  v_and_b32 v125, 0xffff0000, v112
  v_lshlrev_b32 v126, 16, v113
  v_and_b32 v127, 0xffff0000, v113
  v_mul_f32 v124, v124, v33
  v_mul_f32 v125, v125, v33
  v_mul_f32 v126, v126, v33
  v_mul_f32 v127, v127, v33
  v_cvt_pk_bf16_f32 v128, v124, v125
  v_cvt_pk_bf16_f32 v129, v126, v127
  v_cvt_pk_bf16_f32 v130, v68, v69
  v_cvt_pk_bf16_f32 v131, v70, v71
  v_lshlrev_b32 v124, 16, v128
  v_and_b32 v125, 0xffff0000, v128
  v_lshlrev_b32 v132, 16, v130
  v_and_b32 v133, 0xffff0000, v130
  v_lshlrev_b32 v126, 16, v129
  v_and_b32 v127, 0xffff0000, v129
  v_lshlrev_b32 v134, 16, v131
  v_and_b32 v135, 0xffff0000, v131
  v_add_f32 v124, v124, v132
  v_add_f32 v125, v125, v133
  v_add_f32 v126, v126, v134
  v_add_f32 v127, v127, v135
  v_cvt_pk_bf16_f32 v112, v124, v125
  v_cvt_pk_bf16_f32 v113, v126, v127
  ds_write_b64 v46, v[112:113] offset:1536
  v_lshlrev_b32 v124, 16, v114
  v_and_b32 v125, 0xffff0000, v114
  v_lshlrev_b32 v126, 16, v115
  v_and_b32 v127, 0xffff0000, v115
  v_mul_f32 v124, v124, v33
  v_mul_f32 v125, v125, v33
  v_mul_f32 v126, v126, v33
  v_mul_f32 v127, v127, v33
  v_cvt_pk_bf16_f32 v128, v124, v125
  v_cvt_pk_bf16_f32 v129, v126, v127
  v_cvt_pk_bf16_f32 v130, v72, v73
  v_cvt_pk_bf16_f32 v131, v74, v75
  v_lshlrev_b32 v124, 16, v128
  v_and_b32 v125, 0xffff0000, v128
  v_lshlrev_b32 v132, 16, v130
  v_and_b32 v133, 0xffff0000, v130
  v_lshlrev_b32 v126, 16, v129
  v_and_b32 v127, 0xffff0000, v129
  v_lshlrev_b32 v134, 16, v131
  v_and_b32 v135, 0xffff0000, v131
  v_add_f32 v124, v124, v132
  v_add_f32 v125, v125, v133
  v_add_f32 v126, v126, v134
  v_add_f32 v127, v127, v135
  v_cvt_pk_bf16_f32 v114, v124, v125
  v_cvt_pk_bf16_f32 v115, v126, v127
  ds_write_b64 v46, v[114:115] offset:2048
  v_lshlrev_b32 v124, 16, v116
  v_and_b32 v125, 0xffff0000, v116
  v_lshlrev_b32 v126, 16, v117
  v_and_b32 v127, 0xffff0000, v117
  v_mul_f32 v124, v124, v33
  v_mul_f32 v125, v125, v33
  v_mul_f32 v126, v126, v33
  v_mul_f32 v127, v127, v33
  v_cvt_pk_bf16_f32 v128, v124, v125
  v_cvt_pk_bf16_f32 v129, v126, v127
  v_cvt_pk_bf16_f32 v130, v76, v77
  v_cvt_pk_bf16_f32 v131, v78, v79
  v_lshlrev_b32 v124, 16, v128
  v_and_b32 v125, 0xffff0000, v128
  v_lshlrev_b32 v132, 16, v130
  v_and_b32 v133, 0xffff0000, v130
  v_lshlrev_b32 v126, 16, v129
  v_and_b32 v127, 0xffff0000, v129
  v_lshlrev_b32 v134, 16, v131
  v_and_b32 v135, 0xffff0000, v131
  v_add_f32 v124, v124, v132
  v_add_f32 v125, v125, v133
  v_add_f32 v126, v126, v134
  v_add_f32 v127, v127, v135
  v_cvt_pk_bf16_f32 v116, v124, v125
  v_cvt_pk_bf16_f32 v117, v126, v127
  ds_write_b64 v46, v[116:117] offset:2560
  v_lshlrev_b32 v124, 16, v118
  v_and_b32 v125, 0xffff0000, v118
  v_lshlrev_b32 v126, 16, v119
  v_and_b32 v127, 0xffff0000, v119
  v_mul_f32 v124, v124, v33
  v_mul_f32 v125, v125, v33
  v_mul_f32 v126, v126, v33
  v_mul_f32 v127, v127, v33
  v_cvt_pk_bf16_f32 v128, v124, v125
  v_cvt_pk_bf16_f32 v129, v126, v127
  v_cvt_pk_bf16_f32 v130, v80, v81
  v_cvt_pk_bf16_f32 v131, v82, v83
  v_lshlrev_b32 v124, 16, v128
  v_and_b32 v125, 0xffff0000, v128
  v_lshlrev_b32 v132, 16, v130
  v_and_b32 v133, 0xffff0000, v130
  v_lshlrev_b32 v126, 16, v129
  v_and_b32 v127, 0xffff0000, v129
  v_lshlrev_b32 v134, 16, v131
  v_and_b32 v135, 0xffff0000, v131
  v_add_f32 v124, v124, v132
  v_add_f32 v125, v125, v133
  v_add_f32 v126, v126, v134
  v_add_f32 v127, v127, v135
  v_cvt_pk_bf16_f32 v118, v124, v125
  v_cvt_pk_bf16_f32 v119, v126, v127
  ds_write_b64 v46, v[118:119] offset:3072
  v_lshlrev_b32 v124, 16, v120
  v_and_b32 v125, 0xffff0000, v120
  v_lshlrev_b32 v126, 16, v121
  v_and_b32 v127, 0xffff0000, v121
  v_mul_f32 v124, v124, v33
  v_mul_f32 v125, v125, v33
  v_mul_f32 v126, v126, v33
  v_mul_f32 v127, v127, v33
  v_cvt_pk_bf16_f32 v128, v124, v125
  v_cvt_pk_bf16_f32 v129, v126, v127
  v_cvt_pk_bf16_f32 v130, v84, v85
  v_cvt_pk_bf16_f32 v131, v86, v87
  v_lshlrev_b32 v124, 16, v128
  v_and_b32 v125, 0xffff0000, v128
  v_lshlrev_b32 v132, 16, v130
  v_and_b32 v133, 0xffff0000, v130
  v_lshlrev_b32 v126, 16, v129
  v_and_b32 v127, 0xffff0000, v129
  v_lshlrev_b32 v134, 16, v131
  v_and_b32 v135, 0xffff0000, v131
  v_add_f32 v124, v124, v132
  v_add_f32 v125, v125, v133
  v_add_f32 v126, v126, v134
  v_add_f32 v127, v127, v135
  v_cvt_pk_bf16_f32 v120, v124, v125
  v_cvt_pk_bf16_f32 v121, v126, v127
  ds_write_b64 v46, v[120:121] offset:3584
  v_lshlrev_b32 v124, 16, v122
  v_and_b32 v125, 0xffff0000, v122
  v_lshlrev_b32 v126, 16, v123
  v_and_b32 v127, 0xffff0000, v123
  v_mul_f32 v124, v124, v33
  v_mul_f32 v125, v125, v33
  v_mul_f32 v126, v126, v33
  v_mul_f32 v127, v127, v33
  v_cvt_pk_bf16_f32 v128, v124, v125
  v_cvt_pk_bf16_f32 v129, v126, v127
  v_cvt_pk_bf16_f32 v130, v88, v89
  v_cvt_pk_bf16_f32 v131, v90, v91
  v_lshlrev_b32 v124, 16, v128
  v_and_b32 v125, 0xffff0000, v128
  v_lshlrev_b32 v132, 16, v130
  v_and_b32 v133, 0xffff0000, v130
  v_lshlrev_b32 v126, 16, v129
  v_and_b32 v127, 0xffff0000, v129
  v_lshlrev_b32 v134, 16, v131
  v_and_b32 v135, 0xffff0000, v131
  v_add_f32 v124, v124, v132
  v_add_f32 v125, v125, v133
  v_add_f32 v126, v126, v134
  v_add_f32 v127, v127, v135
  v_cvt_pk_bf16_f32 v122, v124, v125
  v_cvt_pk_bf16_f32 v123, v126, v127
  ds_write_b64 v46, v[122:123] offset:4096
  s_waitcnt lgkmcnt(0)
  s_barrier
  v_lshlrev_b32 v6, 3, v0
  v_lshlrev_b32 v5, 4, v0
  v_add_u32 v36, 512, v6
  ds_read_b64 v[8:9], v36
  v_add_u32 v36, 25088, v6
  ds_read_b64 v[10:11], v36
  v_add_u32 v36, 49664, v6
  ds_read_b64 v[12:13], v36
  v_add_u32 v36, 74240, v6
  ds_read_b64 v[14:15], v36
  s_waitcnt lgkmcnt(0)
  s_add_u32 s22, s21, 0
  s_add_u32 s23, s22, 3584
  v_perm_b32 v16, v10, v8, s24
  v_perm_b32 v17, v14, v12, s24
  s_lshl_b32 s22, s21, 11
  s_add_u32 s22, s22, 90177536
  v_perm_b32 v18, v10, v8, s25
  v_perm_b32 v19, v14, v12, s25
  buffer_store_dwordx4 v[16:19], v5, s[8:11], s22 offen sc1
  v_perm_b32 v20, v11, v9, s24
  v_perm_b32 v21, v15, v13, s24
  v_perm_b32 v22, v11, v9, s25
  v_perm_b32 v23, v15, v13, s25
  s_add_u32 s22, s22, 4096
  buffer_store_dwordx4 v[20:23], v5, s[8:11], s22 offen sc1
  v_add_u32 v36, 2560, v6
  ds_read_b64 v[8:9], v36
  v_add_u32 v36, 27136, v6
  ds_read_b64 v[10:11], v36
  v_add_u32 v36, 51712, v6
  ds_read_b64 v[12:13], v36
  v_add_u32 v36, 76288, v6
  ds_read_b64 v[14:15], v36
  s_waitcnt lgkmcnt(0)
  s_add_u32 s22, s21, 1835008
  s_add_u32 s23, s22, 3584
  v_perm_b32 v24, v10, v8, s24
  v_perm_b32 v25, v14, v12, s24
  s_lshl_b32 s22, s21, 11
  s_add_u32 s22, s22, 90185728
  v_perm_b32 v26, v10, v8, s25
  v_perm_b32 v27, v14, v12, s25
  buffer_store_dwordx4 v[24:27], v5, s[8:11], s22 offen sc1
  v_perm_b32 v28, v11, v9, s24
  v_perm_b32 v29, v15, v13, s24
  v_perm_b32 v30, v11, v9, s25
  v_perm_b32 v31, v15, v13, s25
  s_add_u32 s22, s22, 4096
  buffer_store_dwordx4 v[28:31], v5, s[8:11], s22 offen sc1
  s_waitcnt vmcnt(0)
  s_barrier
  s_cmp_lg_u32 s16, 0
  s_cbranch_scc1 wk_nc
  v_mov_b32 v5, 1
  s_mov_b32 s22, 88599424
  s_mov_b64 exec, 1
  buffer_atomic_add v5, off, s[8:11], s22
  s_mov_b64 exec, -1
wk_nc:
  s_branch wk_loop
wk_tok:
  s_sub_u32 s3, s3, 864
  s_cmp_lt_u32 s3, 512
  s_cbranch_scc1 wk_tk
  s_sub_u32 s3, s3, 64
  s_cmp_ge_i32 s3, 512
  s_cbranch_scc1 wk_tk
  s_sub_u32 s18, s3, 448
  s_mov_b32 s20, 88599424
  v_mov_b32 v8, 0
  s_mov_b32 s30, 0
wk_cw:
  buffer_load_dword v9, v8, s[8:11], s20 offen sc1
  s_waitcnt vmcnt(0)
  v_cmp_ne_u32 vcc, 112, v9
  s_cbranch_vccz wk_cw_ok
  s_sleep 32
  s_add_u32 s30, s30, 1
  s_cmp_lt_u32 s30, 50000
  s_cbranch_scc1 wk_cw
  s_branch cA_abort
wk_cw_ok:
  v_lshlrev_b32 v5, 14, v3
  v_and_b32 v6, 1, v4
  v_lshl_add_u32 v5, v6, 12, v5
  v_lshrrev_b32 v6, 1, v4
  v_lshl_add_u32 v5, v6, 4, v5
  s_mul_i32 s20, s16, 458752
  s_lshl_b32 s21, s18, 7
  s_add_u32 s20, s20, s21
  s_and_b32 s21, s18, 32
  s_lshl_b32 s21, s21, 7
  s_add_u32 s20, s20, s21
  s_add_u32 s20, s20, 90177536
  buffer_load_dwordx4 v[8:11], v5, s[8:11], s20 offen sc1
  s_add_u32 s20, s20, 65536
  buffer_load_dwordx4 v[12:15], v5, s[8:11], s20 offen sc1
  s_add_u32 s20, s20, 65536
  buffer_load_dwordx4 v[16:19], v5, s[8:11], s20 offen sc1
  s_add_u32 s20, s20, 65536
  buffer_load_dwordx4 v[20:23], v5, s[8:11], s20 offen sc1
  s_add_u32 s20, s20, 65536
  buffer_load_dwordx4 v[24:27], v5, s[8:11], s20 offen sc1
  s_add_u32 s20, s20, 65536
  buffer_load_dwordx4 v[28:31], v5, s[8:11], s20 offen sc1
  s_add_u32 s20, s20, 65536
  buffer_load_dwordx4 v[32:35], v5, s[8:11], s20 offen sc1
  s_add_u32 s20, s20, 65536
  v_mul_u32_u24 v6, 1824, v4
  v_lshl_add_u32 v6, v3, 3, v6
  s_mul_i32 s20, s16, 224
  v_add_u32 v6, s20, v6
  s_movk_i32 s22, 912
  v_add_u32 v36, 0, v0
  v_mul_u32_u24 v37, 18725, v36
  v_lshrrev_b32 v37, 20, v37
  v_mul_u32_u24 v38, 56, v37
  v_sub_u32 v36, v36, v38
  v_lshlrev_b32 v36, 4, v36
  v_mad_u32_u24 v40, v37, s22, v36
  v_mul_u32_u24 v37, 1792, v37
  v_add_u32 v48, v37, v36
  v_add_u32 v36, 256, v0
  v_mul_u32_u24 v37, 18725, v36
  v_lshrrev_b32 v37, 20, v37
  v_mul_u32_u24 v38, 56, v37
  v_sub_u32 v36, v36, v38
  v_lshlrev_b32 v36, 4, v36
  v_mad_u32_u24 v41, v37, s22, v36
  v_mul_u32_u24 v37, 1792, v37
  v_add_u32 v49, v37, v36
  v_add_u32 v36, 512, v0
  v_mul_u32_u24 v37, 18725, v36
  v_lshrrev_b32 v37, 20, v37
  v_mul_u32_u24 v38, 56, v37
  v_sub_u32 v36, v36, v38
  v_lshlrev_b32 v36, 4, v36
  v_mad_u32_u24 v42, v37, s22, v36
  v_mul_u32_u24 v37, 1792, v37
  v_add_u32 v50, v37, v36
  v_add_u32 v36, 768, v0
  v_mul_u32_u24 v37, 18725, v36
  v_lshrrev_b32 v37, 20, v37
  v_mul_u32_u24 v38, 56, v37
  v_sub_u32 v36, v36, v38
  v_lshlrev_b32 v36, 4, v36
  v_mad_u32_u24 v43, v37, s22, v36
  v_mul_u32_u24 v37, 1792, v37
  v_add_u32 v51, v37, v36
  v_add_u32 v36, 1024, v0
  v_mul_u32_u24 v37, 18725, v36
  v_lshrrev_b32 v37, 20, v37
  v_mul_u32_u24 v38, 56, v37
  v_sub_u32 v36, v36, v38
  v_lshlrev_b32 v36, 4, v36
  v_mad_u32_u24 v44, v37, s22, v36
  v_mul_u32_u24 v37, 1792, v37
  v_add_u32 v52, v37, v36
  v_add_u32 v36, 1280, v0
  v_mul_u32_u24 v37, 18725, v36
  v_lshrrev_b32 v37, 20, v37
  v_mul_u32_u24 v38, 56, v37
  v_sub_u32 v36, v36, v38
  v_lshlrev_b32 v36, 4, v36
  v_mad_u32_u24 v45, v37, s22, v36
  v_mul_u32_u24 v37, 1792, v37
  v_add_u32 v53, v37, v36
  v_add_u32 v36, 1536, v0
  v_mul_u32_u24 v37, 18725, v36
  v_lshrrev_b32 v37, 20, v37
  v_mul_u32_u24 v38, 56, v37
  v_sub_u32 v36, v36, v38
  v_lshlrev_b32 v36, 4, v36
  v_mad_u32_u24 v46, v37, s22, v36
  v_mul_u32_u24 v37, 1792, v37
  v_add_u32 v54, v37, v36
  s_waitcnt vmcnt(6)
  ds_write_b64 v6, v[8:9] offset:0
  ds_write_b64 v6, v[10:11] offset:912
  s_waitcnt vmcnt(5)
  ds_write_b64 v6, v[12:13] offset:32
  ds_write_b64 v6, v[14:15] offset:944
  s_waitcnt vmcnt(4)
  ds_write_b64 v6, v[16:17] offset:64
  ds_write_b64 v6, v[18:19] offset:976
  s_waitcnt vmcnt(3)
  ds_write_b64 v6, v[20:21] offset:96
  ds_write_b64 v6, v[22:23] offset:1008
  s_waitcnt vmcnt(2)
  ds_write_b64 v6, v[24:25] offset:128
  ds_write_b64 v6, v[26:27] offset:1040
  s_waitcnt vmcnt(1)
  ds_write_b64 v6, v[28:29] offset:160
  ds_write_b64 v6, v[30:31] offset:1072
  s_waitcnt vmcnt(0)
  ds_write_b64 v6, v[32:33] offset:192
  ds_write_b64 v6, v[34:35] offset:1104
  s_waitcnt lgkmcnt(0)
  s_barrier
  s_mul_i32 s20, s18, 57344
  ds_read_b128 v[8:11], v40
  ds_read_b128 v[12:15], v41
  ds_read_b128 v[16:19], v42
  ds_read_b128 v[20:23], v43
  ds_read_b128 v[24:27], v44
  ds_read_b128 v[28:31], v45
  ds_read_b128 v[32:35], v46
  s_waitcnt lgkmcnt(6)
  buffer_store_dwordx4 v[8:11], v48, s[92:95], s20 offen
  s_waitcnt lgkmcnt(5)
  buffer_store_dwordx4 v[12:15], v49, s[92:95], s20 offen
  s_waitcnt lgkmcnt(4)
  buffer_store_dwordx4 v[16:19], v50, s[92:95], s20 offen
  s_waitcnt lgkmcnt(3)
  buffer_store_dwordx4 v[20:23], v51, s[92:95], s20 offen
  s_waitcnt lgkmcnt(2)
  buffer_store_dwordx4 v[24:27], v52, s[92:95], s20 offen
  s_waitcnt lgkmcnt(1)
  buffer_store_dwordx4 v[28:31], v53, s[92:95], s20 offen
  s_waitcnt lgkmcnt(0)
  buffer_store_dwordx4 v[32:35], v54, s[92:95], s20 offen
  s_branch wk_loop
wk_tk:
  s_and_b32 s18, s3, 3
  s_lshr_b32 s17, s3, 2
  s_cmp_lt_u32 s17, 8
  s_cbranch_scc1 wk_tokp
  s_sub_u32 s17, s17, 64
  s_cmp_ge_i32 s17, 56
  s_cbranch_scc1 wk_toko
  s_add_u32 s20, s17, 56
  s_lshr_b32 s17, s20, 1
  s_bitcmp0_b32 s20, 0
  s_cbranch_scc1 wk_toko
  s_add_u32 s17, s17, 8
wk_tokp:
  s_lshl_b32 s20, s18, 2
  s_add_u32 s20, s20, s16
  s_lshl_b32 s21, s17, 4
  s_add_u32 s21, s21, s20
  s_mul_i32 s21, s21, 28672
  s_add_u32 s21, s21, 12845056
  s_mul_i32 s23, s17, 28672
  s_add_u32 s23, s23, 73400320
  s_mul_i32 s24, s17, 7168
  s_add_u32 s24, s24, 88080384
  s_lshr_b32 s25, s17, 3
  s_lshl_b32 s25, s25, 4
  s_add_u32 s25, s25, s20
  s_lshl_b32 s25, s25, 7
  s_add_u32 s25, s25, 88557568
  v_mov_b32 v60, 0
  s_mov_b32 s30, 0
wp_wf:
  buffer_load_dword v61, v60, s[8:11], s25 offen sc1
  s_waitcnt vmcnt(0)
  v_cmp_ne_u32 vcc, 56, v61
  s_cbranch_vccz wp_wf_ok
  s_sleep 1
  s_cmp_ge_u32 s17, 61
  s_cbranch_scc1 wp_wf_bo
  s_sleep 4
  s_cmp_ge_u32 s17, 56
  s_cbranch_scc1 wp_wf_bo
  s_sleep 40
wp_wf_bo:
  s_add_u32 s30, s30, 1
  s_cmp_lt_u32 s30, 30000
  s_cbranch_scc1 wp_wf
  s_branch wp_abort
wp_wf_ok:
  s_add_u32 s22, s21, 0
  buffer_load_dwordx4 a[0:3], v2, s[8:11], s22 offen offset:0 sc1
  buffer_load_dwordx4 a[4:7], v2, s[8:11], s22 offen offset:1024 sc1
  buffer_load_dwordx4 a[8:11], v2, s[8:11], s22 offen offset:2048 sc1
  buffer_load_dwordx4 a[12:15], v2, s[8:11], s22 offen offset:3072 sc1
  s_add_u32 s22, s21, 4096
  buffer_load_dwordx4 a[16:19], v2, s[8:11], s22 offen offset:0 sc1
  buffer_load_dwordx4 a[20:23], v2, s[8:11], s22 offen offset:1024 sc1
  buffer_load_dwordx4 a[24:27], v2, s[8:11], s22 offen offset:2048 sc1
  buffer_load_dwordx4 a[28:31], v2, s[8:11], s22 offen offset:3072 sc1
  s_add_u32 s22, s21, 8192
  buffer_load_dwordx4 a[32:35], v2, s[8:11], s22 offen offset:0 sc1
  buffer_load_dwordx4 a[36:39], v2, s[8:11], s22 offen offset:1024 sc1
  buffer_load_dwordx4 a[40:43], v2, s[8:11], s22 offen offset:2048 sc1
  buffer_load_dwordx4 a[44:47], v2, s[8:11], s22 offen offset:3072 sc1
  s_add_u32 s22, s21, 12288
  buffer_load_dwordx4 a[48:51], v2, s[8:11], s22 offen offset:0 sc1
  buffer_load_dwordx4 a[52:55], v2, s[8:11], s22 offen offset:1024 sc1
  buffer_load_dwordx4 a[56:59], v2, s[8:11], s22 offen offset:2048 sc1
  buffer_load_dwordx4 a[60:63], v2, s[8:11], s22 offen offset:3072 sc1
  s_add_u32 s22, s21, 16384
  buffer_load_dwordx4 a[64:67], v2, s[8:11], s22 offen offset:0 sc1
  buffer_load_dwordx4 a[68:71], v2, s[8:11], s22 offen offset:1024 sc1
  buffer_load_dwordx4 a[72:75], v2, s[8:11], s22 offen offset:2048 sc1
  buffer_load_dwordx4 a[76:79], v2, s[8:11], s22 offen offset:3072 sc1
  s_add_u32 s22, s21, 20480
  buffer_load_dwordx4 a[80:83], v2, s[8:11], s22 offen offset:0 sc1
  buffer_load_dwordx4 a[84:87], v2, s[8:11], s22 offen offset:1024 sc1
  buffer_load_dwordx4 a[88:91], v2, s[8:11], s22 offen offset:2048 sc1
  buffer_load_dwordx4 a[92:95], v2, s[8:11], s22 offen offset:3072 sc1
  s_add_u32 s22, s21, 24576
  buffer_load_dwordx4 a[96:99], v2, s[8:11], s22 offen offset:0 sc1
  buffer_load_dwordx4 a[100:103], v2, s[8:11], s22 offen offset:1024 sc1
  buffer_load_dwordx4 a[104:107], v2, s[8:11], s22 offen offset:2048 sc1
  buffer_load_dwordx4 a[108:111], v2, s[8:11], s22 offen offset:3072 sc1
  s_add_u32 s22, s23, 0
  buffer_load_dwordx4 a[112:115], v2, s[8:11], s22 offen offset:0 sc1
  buffer_load_dwordx4 a[116:119], v2, s[8:11], s22 offen offset:1024 sc1
  buffer_load_dwordx4 a[120:123], v2, s[8:11], s22 offen offset:2048 sc1
  buffer_load_dwordx4 a[124:127], v2, s[8:11], s22 offen offset:3072 sc1
  s_add_u32 s22, s23, 4096
  buffer_load_dwordx4 a[128:131], v2, s[8:11], s22 offen offset:0 sc1
  buffer_load_dwordx4 a[132:135], v2, s[8:11], s22 offen offset:1024 sc1
  buffer_load_dwordx4 a[136:139], v2, s[8:11], s22 offen offset:2048 sc1
  buffer_load_dwordx4 a[140:143], v2, s[8:11], s22 offen offset:3072 sc1
  s_add_u32 s22, s23, 8192
  buffer_load_dwordx4 a[144:147], v2, s[8:11], s22 offen offset:0 sc1
  buffer_load_dwordx4 a[148:151], v2, s[8:11], s22 offen offset:1024 sc1
  buffer_load_dwordx4 a[152:155], v2, s[8:11], s22 offen offset:2048 sc1
  buffer_load_dwordx4 a[156:159], v2, s[8:11], s22 offen offset:3072 sc1
  s_add_u32 s22, s23, 12288
  buffer_load_dwordx4 a[160:163], v2, s[8:11], s22 offen offset:0 sc1
  buffer_load_dwordx4 a[164:167], v2, s[8:11], s22 offen offset:1024 sc1
  buffer_load_dwordx4 a[168:171], v2, s[8:11], s22 offen offset:2048 sc1
  buffer_load_dwordx4 a[172:175], v2, s[8:11], s22 offen offset:3072 sc1
  s_add_u32 s22, s23, 16384
  buffer_load_dwordx4 a[176:179], v2, s[8:11], s22 offen offset:0 sc1
  buffer_load_dwordx4 a[180:183], v2, s[8:11], s22 offen offset:1024 sc1
  buffer_load_dwordx4 a[184:187], v2, s[8:11], s22 offen offset:2048 sc1
  buffer_load_dwordx4 a[188:191], v2, s[8:11], s22 offen offset:3072 sc1
  s_add_u32 s22, s23, 20480
  buffer_load_dwordx4 a[192:195], v2, s[8:11], s22 offen offset:0 sc1
  buffer_load_dwordx4 a[196:199], v2, s[8:11], s22 offen offset:1024 sc1
  buffer_load_dwordx4 a[200:203], v2, s[8:11], s22 offen offset:2048 sc1
  buffer_load_dwordx4 a[204:207], v2, s[8:11], s22 offen offset:3072 sc1
  s_add_u32 s22, s23, 24576
  buffer_load_dwordx4 a[208:211], v2, s[8:11], s22 offen offset:0 sc1
  buffer_load_dwordx4 a[212:215], v2, s[8:11], s22 offen offset:1024 sc1
  buffer_load_dwordx4 a[216:219], v2, s[8:11], s22 offen offset:2048 sc1
  buffer_load_dwordx4 a[220:223], v2, s[8:11], s22 offen offset:3072 sc1
  v_lshl_add_u32 v5, v3, 2, 0
  v_cmp_le_u32 s[40:41], v5, v4
  v_lshl_add_u32 v5, v3, 2, 1
  v_cmp_le_u32 s[42:43], v5, v4
  v_lshl_add_u32 v5, v3, 2, 2
  v_cmp_le_u32 s[44:45], v5, v4
  v_lshl_add_u32 v5, v3, 2, 3
  v_cmp_le_u32 s[46:47], v5, v4
  v_cmp_gt_u32 s[48:49], 2, v3
  v_mov_b32 v6, 0xff800000
  s_waitcnt vmcnt(0)
  v_mfma_f32_16x16x32_bf16 v[8:11], a[112:115], a[0:3], 0
  v_mfma_f32_16x16x32_bf16 v[12:15], a[112:115], a[56:59], 0
  v_mfma_f32_16x16x32_bf16 v[16:19], a[168:171], a[56:59], 0
  v_mfma_f32_16x16x32_bf16 v[8:11], a[116:119], a[4:7], v[8:11]
  v_mfma_f32_16x16x32_bf16 v[12:15], a[116:119], a[60:63], v[12:15]
  v_mfma_f32_16x16x32_bf16 v[16:19], a[172:175], a[60:63], v[16:19]
  v_mfma_f32_16x16x32_bf16 v[8:11], a[120:123], a[8:11], v[8:11]
  v_mfma_f32_16x16x32_bf16 v[12:15], a[120:123], a[64:67], v[12:15]
  v_mfma_f32_16x16x32_bf16 v[16:19], a[176:179], a[64:67], v[16:19]
  v_mfma_f32_16x16x32_bf16 v[8:11], a[124:127], a[12:15], v[8:11]
  v_mfma_f32_16x16x32_bf16 v[12:15], a[124:127], a[68:71], v[12:15]
  v_mfma_f32_16x16x32_bf16 v[16:19], a[180:183], a[68:71], v[16:19]
  v_mfma_f32_16x16x32_bf16 v[8:11], a[128:131], a[16:19], v[8:11]
  v_mfma_f32_16x16x32_bf16 v[12:15], a[128:131], a[72:75], v[12:15]
  v_mfma_f32_16x16x32_bf16 v[16:19], a[184:187], a[72:75], v[16:19]
  v_mfma_f32_16x16x32_bf16 v[8:11], a[132:135], a[20:23], v[8:11]
  v_mfma_f32_16x16x32_bf16 v[12:15], a[132:135], a[76:79], v[12:15]
  v_mfma_f32_16x16x32_bf16 v[16:19], a[188:191], a[76:79], v[16:19]
  v_mfma_f32_16x16x32_bf16 v[8:11], a[136:139], a[24:27], v[8:11]
  v_mfma_f32_16x16x32_bf16 v[12:15], a[136:139], a[80:83], v[12:15]
  v_mfma_f32_16x16x32_bf16 v[16:19], a[192:195], a[80:83], v[16:19]
  v_mfma_f32_16x16x32_bf16 v[8:11], a[140:143], a[28:31], v[8:11]
  v_mfma_f32_16x16x32_bf16 v[12:15], a[140:143], a[84:87], v[12:15]
  v_mfma_f32_16x16x32_bf16 v[16:19], a[196:199], a[84:87], v[16:19]
  v_mfma_f32_16x16x32_bf16 v[8:11], a[144:147], a[32:35], v[8:11]
  v_mfma_f32_16x16x32_bf16 v[12:15], a[144:147], a[88:91], v[12:15]
  v_mfma_f32_16x16x32_bf16 v[16:19], a[200:203], a[88:91], v[16:19]
  v_mfma_f32_16x16x32_bf16 v[8:11], a[148:151], a[36:39], v[8:11]
  v_mfma_f32_16x16x32_bf16 v[12:15], a[148:151], a[92:95], v[12:15]
  v_mfma_f32_16x16x32_bf16 v[16:19], a[204:207], a[92:95], v[16:19]
  v_mfma_f32_16x16x32_bf16 v[8:11], a[152:155], a[40:43], v[8:11]
  v_mfma_f32_16x16x32_bf16 v[12:15], a[152:155], a[96:99], v[12:15]
  v_mfma_f32_16x16x32_bf16 v[16:19], a[208:211], a[96:99], v[16:19]
  v_mfma_f32_16x16x32_bf16 v[8:11], a[156:159], a[44:47], v[8:11]
  v_mfma_f32_16x16x32_bf16 v[12:15], a[156:159], a[100:103], v[12:15]
  v_mfma_f32_16x16x32_bf16 v[16:19], a[212:215], a[100:103], v[16:19]
  v_mfma_f32_16x16x32_bf16 v[8:11], a[160:163], a[48:51], v[8:11]
  v_mfma_f32_16x16x32_bf16 v[12:15], a[160:163], a[104:107], v[12:15]
  v_mfma_f32_16x16x32_bf16 v[16:19], a[216:219], a[104:107], v[16:19]
  v_mfma_f32_16x16x32_bf16 v[8:11], a[164:167], a[52:55], v[8:11]
  v_mfma_f32_16x16x32_bf16 v[12:15], a[164:167], a[108:111], v[12:15]
  v_mfma_f32_16x16x32_bf16 v[16:19], a[220:223], a[108:111], v[16:19]
  s_mul_i32 s22, s20, 448
  v_mov_b32 v62, s22
  s_mov_b32 s30, 0
wp_pm:
  s_cmp_ge_u32 s17, 64
  s_cbranch_scc1 wp_pf
  s_cmp_ge_u32 s17, 61
  s_cbranch_scc1 mp_45a
  v_mov_b32 v61, 0
  s_mov_b64 exec, 1
  buffer_atomic_or v61, v62, s[8:11], s24 offen sc0
  s_mov_b64 exec, -1
  s_branch mp_45b
mp_45a:
  buffer_load_dword v61, v62, s[8:11], s24 offen sc1
mp_45b:
  s_waitcnt vmcnt(0)
  v_cmp_eq_u32 vcc, -1, v61
  s_cbranch_vccnz wp_pr
wp_pf:
  s_add_u32 s22, s24, 4096
  buffer_load_dwordx4 v[64:67], v2, s[8:11], s24 offen offset:0 sc1
  buffer_load_dwordx4 v[68:71], v2, s[8:11], s24 offen offset:1024 sc1
  buffer_load_dwordx4 v[72:75], v2, s[8:11], s24 offen offset:2048 sc1
  buffer_load_dwordx4 v[76:79], v2, s[8:11], s24 offen offset:3072 sc1
  buffer_load_dwordx4 v[80:83], v2, s[8:11], s22 offen offset:0 sc1
  buffer_load_dwordx4 v[84:87], v2, s[8:11], s22 offen offset:1024 sc1
  buffer_load_dwordx4 v[88:91], v2, s[8:11], s22 offen offset:2048 sc1
  s_waitcnt vmcnt(0)
  v_max_u32 v61, v64, v65
  v_max3_u32 v61, v61, v66, v67
  v_max3_u32 v61, v61, v68, v69
  v_max3_u32 v61, v61, v70, v71
  v_max3_u32 v61, v61, v72, v73
  v_max3_u32 v61, v61, v74, v75
  v_max3_u32 v61, v61, v76, v77
  v_max3_u32 v61, v61, v78, v79
  v_max3_u32 v61, v61, v80, v81
  v_max3_u32 v61, v61, v82, v83
  v_max3_u32 v61, v61, v84, v85
  v_max3_u32 v61, v61, v86, v87
  v_max3_u32 v61, v61, v88, v89
  v_max3_u32 v61, v61, v90, v91
  v_cmp_eq_u32 vcc, -1, v61
  s_cbranch_vccz wp_pk
wp_pr:
  s_sleep 1
  s_cmp_ge_u32 s17, 61
  s_cbranch_scc1 wp_pm_bo
  s_sleep 4
  s_cmp_ge_u32 s17, 56
  s_cbranch_scc1 wp_pm_bo
  s_sleep 40
wp_pm_bo:
  s_add_u32 s30, s30, 1
  s_cmp_lt_u32 s30, 30000
  s_cbranch_scc1 wp_pm
  s_branch wp_abort
wp_pk:
  s_cmp_lt_u32 s17, 56
  s_cbranch_scc1 pk_46
  buffer_load_dword v250, v251, s[12:15], 0 offen sc1
pk_46:
  v_mfma_f32_16x16x32_bf16 v[20:23], v[64:67], a[0:3], 0
  v_mfma_f32_16x16x32_bf16 v[24:27], v[64:67], a[4:7], 0
  v_mfma_f32_16x16x32_bf16 v[28:31], v[64:67], a[56:59], 0
  v_mfma_f32_16x16x32_bf16 v[32:35], v[64:67], a[60:63], 0
  v_mfma_f32_16x16x32_bf16 v[20:23], v[68:71], a[8:11], v[20:23]
  v_mfma_f32_16x16x32_bf16 v[24:27], v[68:71], a[12:15], v[24:27]
  v_mfma_f32_16x16x32_bf16 v[28:31], v[68:71], a[64:67], v[28:31]
  v_mfma_f32_16x16x32_bf16 v[32:35], v[68:71], a[68:71], v[32:35]
  v_mfma_f32_16x16x32_bf16 v[20:23], v[72:75], a[16:19], v[20:23]
  v_mfma_f32_16x16x32_bf16 v[24:27], v[72:75], a[20:23], v[24:27]
  v_mfma_f32_16x16x32_bf16 v[28:31], v[72:75], a[72:75], v[28:31]
  v_mfma_f32_16x16x32_bf16 v[32:35], v[72:75], a[76:79], v[32:35]
  v_mfma_f32_16x16x32_bf16 v[20:23], v[76:79], a[24:27], v[20:23]
  v_mfma_f32_16x16x32_bf16 v[24:27], v[76:79], a[28:31], v[24:27]
  v_mfma_f32_16x16x32_bf16 v[28:31], v[76:79], a[80:83], v[28:31]
  v_mfma_f32_16x16x32_bf16 v[32:35], v[76:79], a[84:87], v[32:35]
  v_mfma_f32_16x16x32_bf16 v[20:23], v[80:83], a[32:35], v[20:23]
  v_mfma_f32_16x16x32_bf16 v[24:27], v[80:83], a[36:39], v[24:27]
  v_mfma_f32_16x16x32_bf16 v[28:31], v[80:83], a[88:91], v[28:31]
  v_mfma_f32_16x16x32_bf16 v[32:35], v[80:83], a[92:95], v[32:35]
  v_mfma_f32_16x16x32_bf16 v[20:23], v[84:87], a[40:43], v[20:23]
  v_mfma_f32_16x16x32_bf16 v[24:27], v[84:87], a[44:47], v[24:27]
  v_mfma_f32_16x16x32_bf16 v[28:31], v[84:87], a[96:99], v[28:31]
  v_mfma_f32_16x16x32_bf16 v[32:35], v[84:87], a[100:103], v[32:35]
  v_mfma_f32_16x16x32_bf16 v[20:23], v[88:91], a[48:51], v[20:23]
  v_mfma_f32_16x16x32_bf16 v[24:27], v[88:91], a[52:55], v[24:27]
  v_mfma_f32_16x16x32_bf16 v[28:31], v[88:91], a[104:107], v[28:31]
  v_mfma_f32_16x16x32_bf16 v[32:35], v[88:91], a[108:111], v[32:35]
  s_lshl_b32 s25, s17, 1
  s_mul_i32 s25, s25, 20480
  s_add_u32 s25, s25, 85458944
  s_lshl_b32 s26, s20, 10
  s_add_u32 s26, s26, s25
  s_lshl_b32 s27, s18, 10
  s_add_u32 s27, s27, s25
  s_lshr_b32 s28, s16, 1
  s_lshl_b32 s28, s28, 3
  s_add_u32 s27, s27, s28
  s_add_u32 s27, s27, 16384
  s_and_b32 s28, s16, 1
  s_cmp_eq_u32 s28, 0
  s_cselect_b32 s50, -1, 0
  s_cselect_b32 s51, 0, -1
  v_cndmask_b32 v8, v6, v8, s[40:41]
  v_cndmask_b32 v9, v6, v9, s[42:43]
  v_cndmask_b32 v10, v6, v10, s[44:45]
  v_cndmask_b32 v11, v6, v11, s[46:47]
  v_cndmask_b32 v20, v24, v20, s[48:49]
  v_cndmask_b32 v21, v25, v21, s[48:49]
  v_cndmask_b32 v22, v26, v22, s[48:49]
  v_cndmask_b32 v23, v27, v23, s[48:49]
  v_mov_b32 v24, v20
  v_mov_b32 v25, v21
  v_mov_b32 v26, v22
  v_mov_b32 v27, v23
  v_permlane32_swap_b32 v20, v24
  v_permlane32_swap_b32 v21, v25
  v_permlane32_swap_b32 v22, v26
  v_permlane32_swap_b32 v23, v27
  v_add_f32 v20, v20, v24
  v_add_f32 v21, v21, v25
  v_add_f32 v22, v22, v26
  v_add_f32 v23, v23, v27
  v_max3_f32 v40, v8, v9, v10
  v_max3_f32 v40, v40, v11, v20
  v_max3_f32 v40, v40, v21, v22
  v_max_f32 v40, v40, v23
  v_mov_b32 v41, v40
  s_nop 1
  v_permlane16_swap_b32 v40, v41
  v_max_f32 v40, v40, v41
  v_mov_b32 v41, v40
  s_nop 1
  v_permlane32_swap_b32 v40, v41
  v_max_f32 v40, v40, v41
  v_sub_f32 v8, v8, v40
  v_sub_f32 v9, v9, v40
  v_sub_f32 v10, v10, v40
  v_sub_f32 v11, v11, v40
  v_sub_f32 v20, v20, v40
  v_sub_f32 v21, v21, v40
  v_sub_f32 v22, v22, v40
  v_sub_f32 v23, v23, v40
  v_exp_f32 v8, v8
  v_exp_f32 v9, v9
  v_exp_f32 v10, v10
  v_exp_f32 v11, v11
  v_exp_f32 v20, v20
  v_exp_f32 v21, v21
  v_exp_f32 v22, v22
  v_exp_f32 v23, v23
  v_add_f32 v42, v20, v21
  v_add_f32 v43, v22, v23
  v_add_f32 v42, v42, v43
  v_mul_f32 v42, 0.5, v42
  v_add_f32 v42, v42, v8
  v_add_f32 v42, v42, v9
  v_add_f32 v42, v42, v10
  v_add_f32 v42, v42, v11
  v_mov_b32 v41, v42
  s_nop 1
  v_permlane16_swap_b32 v42, v41
  v_add_f32 v42, v42, v41
  v_mov_b32 v41, v42
  s_nop 1
  v_permlane32_swap_b32 v42, v41
  v_add_f32 v42, v42, v41
  v_rcp_f32 v42, v42
  s_nop 0
  v_mul_f32 v8, v8, v42
  v_mul_f32 v9, v9, v42
  v_mul_f32 v10, v10, v42
  v_mul_f32 v11, v11, v42
  v_mul_f32 v20, v20, v42
  v_mul_f32 v21, v21, v42
  v_mul_f32 v22, v22, v42
  v_mul_f32 v23, v23, v42
  v_cvt_pk_bf16_f32 v44, v8, v9
  v_cvt_pk_bf16_f32 v45, v10, v11
  v_mov_b32 v46, 0
  v_mov_b32 v47, 0
  v_cvt_pk_bf16_f32 v48, v20, v21
  v_cvt_pk_bf16_f32 v49, v22, v23
  v_min_u32 v44, -2, v44
  v_min_u32 v45, -2, v45
  v_min_u32 v46, -2, v46
  v_min_u32 v47, -2, v47
  v_min_u32 v48, -2, v48
  v_min_u32 v49, -2, v49
  buffer_store_dwordx4 v[44:47], v2, s[8:11], s26 offen sc1
  s_mov_b64 exec, s[50:51]
  buffer_store_dwordx2 v[48:49], v2, s[8:11], s27 offen sc1
  s_mov_b64 exec, -1
  s_add_u32 s26, s26, 20480
  s_add_u32 s27, s27, 20480
  v_cndmask_b32 v16, v6, v16, s[40:41]
  v_cndmask_b32 v17, v6, v17, s[42:43]
  v_cndmask_b32 v18, v6, v18, s[44:45]
  v_cndmask_b32 v19, v6, v19, s[46:47]
  v_cndmask_b32 v28, v32, v28, s[48:49]
  v_cndmask_b32 v29, v33, v29, s[48:49]
  v_cndmask_b32 v30, v34, v30, s[48:49]
  v_cndmask_b32 v31, v35, v31, s[48:49]
  v_mov_b32 v32, v28
  v_mov_b32 v33, v29
  v_mov_b32 v34, v30
  v_mov_b32 v35, v31
  v_permlane32_swap_b32 v28, v32
  v_permlane32_swap_b32 v29, v33
  v_permlane32_swap_b32 v30, v34
  v_permlane32_swap_b32 v31, v35
  v_add_f32 v28, v28, v32
  v_add_f32 v29, v29, v33
  v_add_f32 v30, v30, v34
  v_add_f32 v31, v31, v35
  v_max3_f32 v40, v12, v13, v14
  v_max3_f32 v40, v40, v15, v16
  v_max3_f32 v40, v40, v17, v18
  v_max3_f32 v40, v40, v19, v28
  v_max3_f32 v40, v40, v29, v30
  v_max_f32 v40, v40, v31
  v_mov_b32 v41, v40
  s_nop 1
  v_permlane16_swap_b32 v40, v41
  v_max_f32 v40, v40, v41
  v_mov_b32 v41, v40
  s_nop 1
  v_permlane32_swap_b32 v40, v41
  v_max_f32 v40, v40, v41
  v_sub_f32 v12, v12, v40
  v_sub_f32 v13, v13, v40
  v_sub_f32 v14, v14, v40
  v_sub_f32 v15, v15, v40
  v_sub_f32 v16, v16, v40
  v_sub_f32 v17, v17, v40
  v_sub_f32 v18, v18, v40
  v_sub_f32 v19, v19, v40
  v_sub_f32 v28, v28, v40
  v_sub_f32 v29, v29, v40
  v_sub_f32 v30, v30, v40
  v_sub_f32 v31, v31, v40
  v_exp_f32 v12, v12
  v_exp_f32 v13, v13
  v_exp_f32 v14, v14
  v_exp_f32 v15, v15
  v_exp_f32 v16, v16
  v_exp_f32 v17, v17
  v_exp_f32 v18, v18
  v_exp_f32 v19, v19
  v_exp_f32 v28, v28
  v_exp_f32 v29, v29
  v_exp_f32 v30, v30
  v_exp_f32 v31, v31
  v_add_f32 v42, v28, v29
  v_add_f32 v43, v30, v31
  v_add_f32 v42, v42, v43
  v_mul_f32 v42, 0.5, v42
  v_add_f32 v42, v42, v12
  v_add_f32 v42, v42, v13
  v_add_f32 v42, v42, v14
  v_add_f32 v42, v42, v15
  v_add_f32 v42, v42, v16
  v_add_f32 v42, v42, v17
  v_add_f32 v42, v42, v18
  v_add_f32 v42, v42, v19
  v_mov_b32 v41, v42
  s_nop 1
  v_permlane16_swap_b32 v42, v41
  v_add_f32 v42, v42, v41
  v_mov_b32 v41, v42
  s_nop 1
  v_permlane32_swap_b32 v42, v41
  v_add_f32 v42, v42, v41
  v_rcp_f32 v42, v42
  s_nop 0
  v_mul_f32 v12, v12, v42
  v_mul_f32 v13, v13, v42
  v_mul_f32 v14, v14, v42
  v_mul_f32 v15, v15, v42
  v_mul_f32 v16, v16, v42
  v_mul_f32 v17, v17, v42
  v_mul_f32 v18, v18, v42
  v_mul_f32 v19, v19, v42
  v_mul_f32 v28, v28, v42
  v_mul_f32 v29, v29, v42
  v_mul_f32 v30, v30, v42
  v_mul_f32 v31, v31, v42
  v_cvt_pk_bf16_f32 v52, v12, v13
  v_cvt_pk_bf16_f32 v53, v14, v15
  v_cvt_pk_bf16_f32 v54, v16, v17
  v_cvt_pk_bf16_f32 v55, v18, v19
  v_cvt_pk_bf16_f32 v56, v28, v29
  v_cvt_pk_bf16_f32 v57, v30, v31
  v_min_u32 v52, -2, v52
  v_min_u32 v53, -2, v53
  v_min_u32 v54, -2, v54
  v_min_u32 v55, -2, v55
  v_min_u32 v56, -2, v56
  v_min_u32 v57, -2, v57
  buffer_store_dwordx4 v[52:55], v2, s[8:11], s26 offen sc1
  s_mov_b64 exec, s[50:51]
  buffer_store_dwordx2 v[56:57], v2, s[8:11], s27 offen sc1
  s_mov_b64 exec, -1
  s_lshl_b32 s25, s17, 7
  s_add_u32 s25, s25, 88573952
  v_mov_b32 v5, 1
  v_mov_b32 v6, 0
  s_waitcnt vmcnt(0)
  s_mov_b64 exec, 1
  buffer_atomic_add v5, v6, s[8:11], s25 offen
  s_mov_b64 exec, -1
  s_branch wk_loop
wk_toko:
  s_lshl_b32 s20, s18, 2
  s_add_u32 s20, s20, s16
  s_mul_i32 s24, s20, 65
  s_add_u32 s24, s24, s17
  s_lshl_b32 s24, s24, 13
  s_add_u32 s24, s24, 76947456
  s_lshl_b32 s21, s20, 6
  s_add_u32 s21, s21, s17
  s_mul_i32 s21, s21, 28672
  s_add_u32 s21, s21, 42205184
  s_lshl_b32 s25, s17, 1
  s_mul_i32 s25, s25, 20480
  s_add_u32 s25, s25, 85458944
  v_lshrrev_b32 v8, 5, v1
  v_and_b32 v9, 31, v1
  v_lshrrev_b32 v10, 4, v9
  v_min_u32 v5, 27, v9
  v_and_b32 v5, 15, v5
  v_lshlrev_b32 v6, 1, v10
  v_sub_u32 v6, 8, v6
  v_lshlrev_b32 v7, 10, v10
  v_lshl_add_u32 v7, v5, 4, v7
  v_lshlrev_b32 v6, 5, v6
  v_mad_u32_u24 v5, v8, v6, v7
  v_lshl_add_u32 v63, v6, 1, v5
  v_lshl_add_u32 v7, v8, 3, v7
  v_mul_u32_u24 v6, 20480, v10
  v_lshl_add_u32 v6, v8, 8, v6
  v_lshl_add_u32 v6, v4, 4, v6
  s_lshr_b32 s26, s17, 3
  s_lshl_b32 s26, s26, 4
  s_add_u32 s26, s26, s20
  s_lshl_b32 s26, s26, 7
  s_add_u32 s26, s26, 88541184
  v_mov_b32 v60, 0
  s_mov_b32 s30, 0
wo_wv:
  buffer_load_dword v61, v60, s[8:11], s26 offen sc1
  s_waitcnt vmcnt(0)
  v_cmp_ne_u32 vcc, 56, v61
  s_cbranch_vccz wo_wv_ok
  s_sleep 1
  s_cmp_ge_u32 s17, 61
  s_cbranch_scc1 wo_wv_bo
  s_sleep 4
  s_cmp_ge_u32 s17, 56
  s_cbranch_scc1 wo_wv_bo
  s_sleep 40
wo_wv_bo:
  s_add_u32 s30, s30, 1
  s_cmp_lt_u32 s30, 30000
  s_cbranch_scc1 wo_wv
  s_branch wo_abort
wo_wv_ok:
  s_add_u32 s22, s21, 0
  buffer_load_dwordx4 a[0:3], v5, s[8:11], s22 offen offset:0 sc1
  buffer_load_dwordx4 a[4:7], v63, s[8:11], s22 offen offset:0 sc1
  buffer_load_dwordx4 a[8:11], v5, s[8:11], s22 offen offset:1792 sc1
  buffer_load_dwordx4 a[12:15], v63, s[8:11], s22 offen offset:1792 sc1
  s_add_u32 s22, s21, 3584
  buffer_load_dwordx4 a[16:19], v5, s[8:11], s22 offen offset:0 sc1
  buffer_load_dwordx4 a[20:23], v63, s[8:11], s22 offen offset:0 sc1
  buffer_load_dwordx4 a[24:27], v5, s[8:11], s22 offen offset:1792 sc1
  buffer_load_dwordx4 a[28:31], v63, s[8:11], s22 offen offset:1792 sc1
  s_add_u32 s22, s21, 7168
  buffer_load_dwordx4 a[32:35], v5, s[8:11], s22 offen offset:0 sc1
  buffer_load_dwordx4 a[36:39], v63, s[8:11], s22 offen offset:0 sc1
  buffer_load_dwordx4 a[40:43], v5, s[8:11], s22 offen offset:1792 sc1
  buffer_load_dwordx4 a[44:47], v63, s[8:11], s22 offen offset:1792 sc1
  s_add_u32 s22, s21, 10752
  buffer_load_dwordx4 a[48:51], v5, s[8:11], s22 offen offset:0 sc1
  buffer_load_dwordx4 a[52:55], v63, s[8:11], s22 offen offset:0 sc1
  buffer_load_dwordx4 a[56:59], v5, s[8:11], s22 offen offset:1792 sc1
  buffer_load_dwordx4 a[60:63], v63, s[8:11], s22 offen offset:1792 sc1
  s_add_u32 s22, s21, 14336
  buffer_load_dwordx4 a[64:67], v5, s[8:11], s22 offen offset:0 sc1
  buffer_load_dwordx4 a[68:71], v63, s[8:11], s22 offen offset:0 sc1
  buffer_load_dwordx4 a[72:75], v5, s[8:11], s22 offen offset:1792 sc1
  buffer_load_dwordx4 a[76:79], v63, s[8:11], s22 offen offset:1792 sc1
  s_add_u32 s22, s21, 17920
  buffer_load_dwordx4 a[80:83], v5, s[8:11], s22 offen offset:0 sc1
  buffer_load_dwordx4 a[84:87], v63, s[8:11], s22 offen offset:0 sc1
  buffer_load_dwordx4 a[88:91], v5, s[8:11], s22 offen offset:1792 sc1
  buffer_load_dwordx4 a[92:95], v63, s[8:11], s22 offen offset:1792 sc1
  s_add_u32 s22, s21, 21504
  buffer_load_dwordx4 a[96:99], v5, s[8:11], s22 offen offset:0 sc1
  buffer_load_dwordx4 a[100:103], v63, s[8:11], s22 offen offset:0 sc1
  buffer_load_dwordx4 a[104:107], v5, s[8:11], s22 offen offset:1792 sc1
  buffer_load_dwordx4 a[108:111], v63, s[8:11], s22 offen offset:1792 sc1
  s_add_u32 s22, s21, 25088
  buffer_load_dwordx4 a[112:115], v5, s[8:11], s22 offen offset:0 sc1
  buffer_load_dwordx4 a[116:119], v63, s[8:11], s22 offen offset:0 sc1
  buffer_load_dwordx4 a[120:123], v5, s[8:11], s22 offen offset:1792 sc1
  buffer_load_dwordx4 a[124:127], v63, s[8:11], s22 offen offset:1792 sc1
  s_cmp_ge_u32 s17, 61
  s_cbranch_scc1 wo_lm
  s_lshl_b32 s26, s17, 7
  s_add_u32 s26, s26, 88573952
  v_mov_b32 v60, 0
  s_mov_b32 s30, 0
wo_wp:
  buffer_load_dword v61, v60, s[8:11], s26 offen sc1
  s_waitcnt vmcnt(0)
  v_cmp_ne_u32 vcc, 16, v61
  s_cbranch_vccz wo_wp_ok
  s_sleep 2
  s_cmp_ge_u32 s17, 61
  s_cbranch_scc1 wo_wp_bo
  s_sleep 4
  s_cmp_ge_u32 s17, 56
  s_cbranch_scc1 wo_wp_bo
  s_sleep 40
wo_wp_bo:
  s_add_u32 s30, s30, 1
  s_cmp_lt_u32 s30, 30000
  s_cbranch_scc1 wo_wp
  s_branch wo_abort
wo_wp_ok:
  s_branch wo_lp
wo_lm:
  s_mul_i32 s26, s17, 7168
  s_add_u32 s26, s26, 88080384
  v_mov_b32 v60, 0
  s_mov_b32 s30, 0
wo_wm:
  buffer_load_dword v61, v60, s[8:11], s26 offen sc1
  s_waitcnt vmcnt(0)
  v_cmp_eq_u32 vcc, -1, v61
  s_cbranch_vccz wo_wm_ok
  s_sleep 2
  s_cmp_ge_u32 s17, 61
  s_cbranch_scc1 wo_wm_bo
  s_sleep 4
  s_cmp_ge_u32 s17, 56
  s_cbranch_scc1 wo_wm_bo
  s_sleep 40
wo_wm_bo:
  s_add_u32 s30, s30, 1
  s_cmp_lt_u32 s30, 30000
  s_cbranch_scc1 wo_wm
  s_branch wo_abort
wo_wm_ok:
wo_lp:
  s_mul_i32 s26, s16, 10240
  s_add_u32 s27, s25, s26
  v_add_u32 v11, s26, v2
  s_lshl_b32 s26, s20, 6
  s_add_u32 s26, s26, s17
  s_lshl_b32 s26, s26, 4
  s_add_u32 s26, s26, 88582144
  v_lshlrev_b32 v60, 2, v3
  s_mov_b32 s30, 0
wo_pl:
  s_add_u32 s22, s27, 0
  buffer_load_dwordx4 v[128:131], v2, s[8:11], s22 offen offset:0 sc1
  buffer_load_dwordx4 v[132:135], v2, s[8:11], s22 offen offset:1024 sc1
  buffer_load_dwordx4 v[136:139], v2, s[8:11], s22 offen offset:2048 sc1
  buffer_load_dwordx4 v[140:143], v2, s[8:11], s22 offen offset:3072 sc1
  s_add_u32 s22, s27, 4096
  buffer_load_dwordx4 v[144:147], v2, s[8:11], s22 offen offset:0 sc1
  buffer_load_dwordx4 v[148:151], v2, s[8:11], s22 offen offset:1024 sc1
  buffer_load_dwordx4 v[152:155], v2, s[8:11], s22 offen offset:2048 sc1
  buffer_load_dwordx4 v[156:159], v2, s[8:11], s22 offen offset:3072 sc1
  s_add_u32 s22, s27, 8192
  buffer_load_dwordx4 v[160:163], v2, s[8:11], s22 offen offset:0 sc1
  buffer_load_dwordx4 v[164:167], v2, s[8:11], s22 offen offset:1024 sc1
  buffer_load_dword v61, v60, s[8:11], s26 offen sc1
  s_waitcnt vmcnt(1)
  v_max_u32 v62, v128, v129
  v_max3_u32 v62, v62, v130, v131
  v_max3_u32 v62, v62, v132, v133
  v_max3_u32 v62, v62, v134, v135
  v_max3_u32 v62, v62, v136, v137
  v_max3_u32 v62, v62, v138, v139
  v_max3_u32 v62, v62, v140, v141
  v_max3_u32 v62, v62, v142, v143
  v_max3_u32 v62, v62, v144, v145
  v_max3_u32 v62, v62, v146, v147
  v_max3_u32 v62, v62, v148, v149
  v_max3_u32 v62, v62, v150, v151
  v_max3_u32 v62, v62, v152, v153
  v_max3_u32 v62, v62, v154, v155
  v_max3_u32 v62, v62, v156, v157
  v_max3_u32 v62, v62, v158, v159
  v_max3_u32 v62, v62, v160, v161
  v_max3_u32 v62, v62, v162, v163
  v_max3_u32 v62, v62, v164, v165
  v_max3_u32 v62, v62, v166, v167
  v_cmp_eq_u32 vcc, -1, v62
  s_cbranch_vccz wo_pk
  s_add_u32 s30, s30, 1
  s_cmp_lt_u32 s30, 30000
  s_cbranch_scc1 wo_pl
  s_branch wo_abort
wo_pk:
  ds_write_b128 v11, v[128:131] offset:0
  ds_write_b128 v11, v[132:135] offset:1024
  ds_write_b128 v11, v[136:139] offset:2048
  ds_write_b128 v11, v[140:143] offset:3072
  ds_write_b128 v11, v[144:147] offset:4096
  ds_write_b128 v11, v[148:151] offset:5120
  ds_write_b128 v11, v[152:155] offset:6144
  ds_write_b128 v11, v[156:159] offset:7168
  ds_write_b128 v11, v[160:163] offset:8192
  ds_write_b128 v11, v[164:167] offset:9216
  s_waitcnt vmcnt(0)
  v_cmp_ne_u32 vcc, 1, v61
  s_mov_b32 s28, 0
  s_cbranch_vccnz wo_nt
  s_add_u32 s22, s24, 0
  buffer_load_dwordx2 v[28:29], v7, s[8:11], s22 offen offset:0 sc1
  buffer_load_dwordx2 v[30:31], v7, s[8:11], s22 offen offset:512 sc1
  buffer_load_dwordx2 v[32:33], v7, s[8:11], s22 offen offset:256 sc1
  buffer_load_dwordx2 v[34:35], v7, s[8:11], s22 offen offset:768 sc1
  buffer_load_dwordx2 v[36:37], v7, s[8:11], s22 offen offset:2048 sc1
  buffer_load_dwordx2 v[38:39], v7, s[8:11], s22 offen offset:2560 sc1
  buffer_load_dwordx2 v[40:41], v7, s[8:11], s22 offen offset:2304 sc1
  buffer_load_dwordx2 v[42:43], v7, s[8:11], s22 offen offset:2816 sc1
  s_add_u32 s22, s24, 4096
  buffer_load_dwordx2 v[44:45], v7, s[8:11], s22 offen offset:0 sc1
  buffer_load_dwordx2 v[46:47], v7, s[8:11], s22 offen offset:512 sc1
  buffer_load_dwordx2 v[48:49], v7, s[8:11], s22 offen offset:256 sc1
  buffer_load_dwordx2 v[50:51], v7, s[8:11], s22 offen offset:768 sc1
  buffer_load_dwordx2 v[52:53], v7, s[8:11], s22 offen offset:2048 sc1
  buffer_load_dwordx2 v[54:55], v7, s[8:11], s22 offen offset:2560 sc1
  buffer_load_dwordx2 v[56:57], v7, s[8:11], s22 offen offset:2304 sc1
  buffer_load_dwordx2 v[58:59], v7, s[8:11], s22 offen offset:2816 sc1
  s_mov_b32 s28, 1
wo_nt:
  s_cmp_lt_u32 s17, 56
  s_cbranch_scc1 pk_47
  buffer_load_dword v250, v251, s[12:15], 0 offen sc1
pk_47:
  s_waitcnt lgkmcnt(0)
  s_barrier
  buffer_load_dword v61, v60, s[8:11], s26 offen sc1
  ds_read_b128 v[64:67], v6 offset:0
  ds_read_b128 v[68:71], v6 offset:512
  ds_read_b128 v[72:75], v6 offset:1024
  ds_read_b128 v[76:79], v6 offset:1536
  ds_read_b128 v[80:83], v6 offset:2048
  ds_read_b128 v[84:87], v6 offset:2560
  ds_read_b128 v[88:91], v6 offset:3072
  s_waitcnt lgkmcnt(6)
  v_mfma_f32_32x32x16_bf16 v[12:27], a[0:3], v[64:67], 0
  ds_read_b128 v[92:95], v6 offset:3584
  s_waitcnt lgkmcnt(6)
  v_mfma_f32_32x32x16_bf16 v[12:27], a[4:7], v[68:71], v[12:27]
  ds_read_b128 v[64:67], v6 offset:4096
  s_waitcnt lgkmcnt(6)
  v_mfma_f32_32x32x16_bf16 v[12:27], a[8:11], v[72:75], v[12:27]
  ds_read_b128 v[68:71], v6 offset:4608
  s_waitcnt lgkmcnt(6)
  v_mfma_f32_32x32x16_bf16 v[12:27], a[12:15], v[76:79], v[12:27]
  ds_read_b128 v[72:75], v6 offset:5120
  s_waitcnt lgkmcnt(6)
  v_mfma_f32_32x32x16_bf16 v[12:27], a[16:19], v[80:83], v[12:27]
  ds_read_b128 v[76:79], v6 offset:5632
  s_waitcnt lgkmcnt(6)
  v_mfma_f32_32x32x16_bf16 v[12:27], a[20:23], v[84:87], v[12:27]
  ds_read_b128 v[80:83], v6 offset:6144
  s_waitcnt lgkmcnt(6)
  v_mfma_f32_32x32x16_bf16 v[12:27], a[24:27], v[88:91], v[12:27]
  ds_read_b128 v[84:87], v6 offset:6656
  s_waitcnt lgkmcnt(6)
  v_mfma_f32_32x32x16_bf16 v[12:27], a[28:31], v[92:95], v[12:27]
  ds_read_b128 v[88:91], v6 offset:7168
  s_waitcnt lgkmcnt(6)
  v_mfma_f32_32x32x16_bf16 v[12:27], a[32:35], v[64:67], v[12:27]
  ds_read_b128 v[92:95], v6 offset:7680
  s_waitcnt lgkmcnt(6)
  v_mfma_f32_32x32x16_bf16 v[12:27], a[36:39], v[68:71], v[12:27]
  ds_read_b128 v[64:67], v6 offset:8192
  s_waitcnt lgkmcnt(6)
  v_mfma_f32_32x32x16_bf16 v[12:27], a[40:43], v[72:75], v[12:27]
  ds_read_b128 v[68:71], v6 offset:8704
  s_waitcnt lgkmcnt(6)
  v_mfma_f32_32x32x16_bf16 v[12:27], a[44:47], v[76:79], v[12:27]
  ds_read_b128 v[72:75], v6 offset:9216
  s_waitcnt lgkmcnt(6)
  v_mfma_f32_32x32x16_bf16 v[12:27], a[48:51], v[80:83], v[12:27]
  ds_read_b128 v[76:79], v6 offset:9728
  s_waitcnt lgkmcnt(6)
  v_mfma_f32_32x32x16_bf16 v[12:27], a[52:55], v[84:87], v[12:27]
  ds_read_b128 v[80:83], v6 offset:10240
  s_waitcnt lgkmcnt(6)
  v_mfma_f32_32x32x16_bf16 v[12:27], a[56:59], v[88:91], v[12:27]
  ds_read_b128 v[84:87], v6 offset:10752
  s_waitcnt lgkmcnt(6)
  v_mfma_f32_32x32x16_bf16 v[12:27], a[60:63], v[92:95], v[12:27]
  ds_read_b128 v[88:91], v6 offset:11264
  s_waitcnt lgkmcnt(6)
  v_mfma_f32_32x32x16_bf16 v[12:27], a[64:67], v[64:67], v[12:27]
  ds_read_b128 v[92:95], v6 offset:11776
  s_waitcnt lgkmcnt(6)
  v_mfma_f32_32x32x16_bf16 v[12:27], a[68:71], v[68:71], v[12:27]
  ds_read_b128 v[64:67], v6 offset:12288
  s_waitcnt lgkmcnt(6)
  v_mfma_f32_32x32x16_bf16 v[12:27], a[72:75], v[72:75], v[12:27]
  ds_read_b128 v[68:71], v6 offset:12800
  s_waitcnt lgkmcnt(6)
  v_mfma_f32_32x32x16_bf16 v[12:27], a[76:79], v[76:79], v[12:27]
  s_cmp_lg_u32 s28, 0
  s_cbranch_scc1 wo_h2
  s_waitcnt vmcnt(0)
  v_cmp_ne_u32 vcc, 1, v61
  s_cbranch_vccnz wo_h2
  s_add_u32 s22, s24, 0
  buffer_load_dwordx2 v[28:29], v7, s[8:11], s22 offen offset:0 sc1
  buffer_load_dwordx2 v[30:31], v7, s[8:11], s22 offen offset:512 sc1
  buffer_load_dwordx2 v[32:33], v7, s[8:11], s22 offen offset:256 sc1
  buffer_load_dwordx2 v[34:35], v7, s[8:11], s22 offen offset:768 sc1
  buffer_load_dwordx2 v[36:37], v7, s[8:11], s22 offen offset:2048 sc1
  buffer_load_dwordx2 v[38:39], v7, s[8:11], s22 offen offset:2560 sc1
  buffer_load_dwordx2 v[40:41], v7, s[8:11], s22 offen offset:2304 sc1
  buffer_load_dwordx2 v[42:43], v7, s[8:11], s22 offen offset:2816 sc1
  s_add_u32 s22, s24, 4096
  buffer_load_dwordx2 v[44:45], v7, s[8:11], s22 offen offset:0 sc1
  buffer_load_dwordx2 v[46:47], v7, s[8:11], s22 offen offset:512 sc1
  buffer_load_dwordx2 v[48:49], v7, s[8:11], s22 offen offset:256 sc1
  buffer_load_dwordx2 v[50:51], v7, s[8:11], s22 offen offset:768 sc1
  buffer_load_dwordx2 v[52:53], v7, s[8:11], s22 offen offset:2048 sc1
  buffer_load_dwordx2 v[54:55], v7, s[8:11], s22 offen offset:2560 sc1
  buffer_load_dwordx2 v[56:57], v7, s[8:11], s22 offen offset:2304 sc1
  buffer_load_dwordx2 v[58:59], v7, s[8:11], s22 offen offset:2816 sc1
  s_mov_b32 s28, 1
wo_h2:
  ds_read_b128 v[72:75], v6 offset:13312
  s_waitcnt lgkmcnt(6)
  v_mfma_f32_32x32x16_bf16 v[12:27], a[80:83], v[80:83], v[12:27]
  ds_read_b128 v[76:79], v6 offset:13824
  s_waitcnt lgkmcnt(6)
  v_mfma_f32_32x32x16_bf16 v[12:27], a[84:87], v[84:87], v[12:27]
  ds_read_b128 v[80:83], v6 offset:14336
  s_waitcnt lgkmcnt(6)
  v_mfma_f32_32x32x16_bf16 v[12:27], a[88:91], v[88:91], v[12:27]
  ds_read_b128 v[84:87], v6 offset:14848
  s_waitcnt lgkmcnt(6)
  v_mfma_f32_32x32x16_bf16 v[12:27], a[92:95], v[92:95], v[12:27]
  ds_read_b128 v[88:91], v6 offset:15360
  s_waitcnt lgkmcnt(6)
  v_mfma_f32_32x32x16_bf16 v[12:27], a[96:99], v[64:67], v[12:27]
  ds_read_b128 v[92:95], v6 offset:15872
  s_waitcnt lgkmcnt(6)
  v_mfma_f32_32x32x16_bf16 v[12:27], a[100:103], v[68:71], v[12:27]
  ds_read_b128 v[64:67], v6 offset:16384
  s_waitcnt lgkmcnt(6)
  v_mfma_f32_32x32x16_bf16 v[12:27], a[104:107], v[72:75], v[12:27]
  ds_read_b128 v[68:71], v6 offset:16896
  s_waitcnt lgkmcnt(6)
  v_mfma_f32_32x32x16_bf16 v[12:27], a[108:111], v[76:79], v[12:27]
  ds_read_b128 v[72:75], v6 offset:17408
  s_waitcnt lgkmcnt(6)
  v_mfma_f32_32x32x16_bf16 v[12:27], a[112:115], v[80:83], v[12:27]
  ds_read_b128 v[76:79], v6 offset:17920
  s_waitcnt lgkmcnt(6)
  v_mfma_f32_32x32x16_bf16 v[12:27], a[116:119], v[84:87], v[12:27]
  ds_read_b128 v[80:83], v6 offset:18432
  s_waitcnt lgkmcnt(6)
  v_mfma_f32_32x32x16_bf16 v[12:27], a[120:123], v[88:91], v[12:27]
  ds_read_b128 v[84:87], v6 offset:18944
  s_waitcnt lgkmcnt(6)
  v_mfma_f32_32x32x16_bf16 v[12:27], a[124:127], v[92:95], v[12:27]
  s_cmp_lg_u32 s28, 0
  s_cbranch_scc1 wo_ht
  v_lshlrev_b32 v60, 2, v3
  s_mov_b32 s30, 0
wo_wt:
  buffer_load_dword v61, v60, s[8:11], s26 offen sc1
  s_waitcnt vmcnt(0)
  v_cmp_ne_u32 vcc, 1, v61
  s_cbranch_vccz wo_wt_ok
  s_sleep 1
  s_cmp_ge_u32 s17, 61
  s_cbranch_scc1 wo_wt_bo
  s_sleep 4
  s_cmp_ge_u32 s17, 56
  s_cbranch_scc1 wo_wt_bo
  s_sleep 40
wo_wt_bo:
  s_add_u32 s30, s30, 1
  s_cmp_lt_u32 s30, 30000
  s_cbranch_scc1 wo_wt
  s_branch wo_abort
wo_wt_ok:
  s_add_u32 s22, s24, 0
  buffer_load_dwordx2 v[28:29], v7, s[8:11], s22 offen offset:0 sc1
  buffer_load_dwordx2 v[30:31], v7, s[8:11], s22 offen offset:512 sc1
  buffer_load_dwordx2 v[32:33], v7, s[8:11], s22 offen offset:256 sc1
  buffer_load_dwordx2 v[34:35], v7, s[8:11], s22 offen offset:768 sc1
  buffer_load_dwordx2 v[36:37], v7, s[8:11], s22 offen offset:2048 sc1
  buffer_load_dwordx2 v[38:39], v7, s[8:11], s22 offen offset:2560 sc1
  buffer_load_dwordx2 v[40:41], v7, s[8:11], s22 offen offset:2304 sc1
  buffer_load_dwordx2 v[42:43], v7, s[8:11], s22 offen offset:2816 sc1
  s_add_u32 s22, s24, 4096
  buffer_load_dwordx2 v[44:45], v7, s[8:11], s22 offen offset:0 sc1
  buffer_load_dwordx2 v[46:47], v7, s[8:11], s22 offen offset:512 sc1
  buffer_load_dwordx2 v[48:49], v7, s[8:11], s22 offen offset:256 sc1
  buffer_load_dwordx2 v[50:51], v7, s[8:11], s22 offen offset:768 sc1
  buffer_load_dwordx2 v[52:53], v7, s[8:11], s22 offen offset:2048 sc1
  buffer_load_dwordx2 v[54:55], v7, s[8:11], s22 offen offset:2560 sc1
  buffer_load_dwordx2 v[56:57], v7, s[8:11], s22 offen offset:2304 sc1
  buffer_load_dwordx2 v[58:59], v7, s[8:11], s22 offen offset:2816 sc1
wo_ht:
  ds_read_b128 v[88:91], v6 offset:19456
  s_waitcnt lgkmcnt(6) vmcnt(0)
  v_mfma_f32_32x32x16_bf16 v[12:27], v[28:31], v[64:67], v[12:27]
  ds_read_b128 v[92:95], v6 offset:19968
  s_waitcnt lgkmcnt(6)
  v_mfma_f32_32x32x16_bf16 v[12:27], v[32:35], v[68:71], v[12:27]
  s_waitcnt lgkmcnt(5)
  v_mfma_f32_32x32x16_bf16 v[12:27], v[36:39], v[72:75], v[12:27]
  s_waitcnt lgkmcnt(4)
  v_mfma_f32_32x32x16_bf16 v[12:27], v[40:43], v[76:79], v[12:27]
  s_waitcnt lgkmcnt(3)
  v_mfma_f32_32x32x16_bf16 v[12:27], v[44:47], v[80:83], v[12:27]
  s_waitcnt lgkmcnt(2)
  v_mfma_f32_32x32x16_bf16 v[12:27], v[48:51], v[84:87], v[12:27]
  s_waitcnt lgkmcnt(1)
  v_mfma_f32_32x32x16_bf16 v[12:27], v[52:55], v[88:91], v[12:27]
  s_waitcnt lgkmcnt(0)
  v_mfma_f32_32x32x16_bf16 v[12:27], v[56:59], v[92:95], v[12:27]
  v_mul_u32_u24 v9, 240, v9
  s_movk_i32 s23, 240
  v_lshl_add_u32 v8, v8, 3, v9
  s_mul_i32 s22, s16, 24
  v_add_u32 v7, s22, v8
  s_lshl_b32 s22, s16, 5
  v_add_u32 v8, s22, v8
  v_min_u32 v11, 223, v0
  v_mul_u32_u24 v9, 4682, v11
  v_lshrrev_b32 v9, 16, v9
  v_mul_u32_u24 v10, 14, v9
  v_sub_u32 v10, v11, v10
  v_cmp_gt_u32 vcc, 8, v10
  v_lshlrev_b32 v10, 4, v10
  v_mad_u32_u24 v11, v9, s23, v10
  v_mul_u32_u24 v9, 1792, v9
  v_add_u32 v10, v9, v10
  s_lshl_b32 s22, s18, 7
  s_mul_i32 s27, s18, 96
  s_add_u32 s27, s27, 384
  v_mov_b32 v9, s22
  v_mov_b32 v5, s27
  v_cndmask_b32 v9, v5, v9, vcc
  v_add_u32 v10, v9, v10
  s_mul_i32 s26, s17, 57344
  s_add_u32 s26, s26, 896
  s_add_u32 s27, s26, 28672
  v_cvt_pk_bf16_f32 v96, v12, v13
  v_cvt_pk_bf16_f32 v97, v14, v15
  ds_write_b64 v8, v[96:97] offset:49152
  v_cvt_pk_bf16_f32 v98, v16, v17
  v_cvt_pk_bf16_f32 v99, v18, v19
  ds_write_b64 v8, v[98:99] offset:49168
  v_cvt_pk_bf16_f32 v100, v20, v21
  v_cvt_pk_bf16_f32 v101, v22, v23
  ds_write_b64 v7, v[100:101] offset:49280
  v_cvt_pk_bf16_f32 v102, v24, v25
  v_cvt_pk_bf16_f32 v103, v26, v27
  s_mov_b32 exec_hi, 0
  ds_write_b64 v7, v[102:103] offset:49296
  s_mov_b64 exec, -1
  s_waitcnt lgkmcnt(0)
  s_barrier
  ds_read_b128 v[104:107], v11 offset:49152
  ds_read_b128 v[108:111], v11 offset:52992
  s_cmp_lg_u32 s16, 3
  s_cselect_b32 exec_hi, -1, 0
  s_waitcnt lgkmcnt(1)
  buffer_store_dwordx4 v[104:107], v10, s[92:95], s26 offen
  s_waitcnt lgkmcnt(0)
  buffer_store_dwordx4 v[108:111], v10, s[92:95], s27 offen
  s_mov_b64 exec, -1
  v_readfirstlane_b32 s22, v250
  s_cmp_ge_u32 s22, 1440
  s_cbranch_scc1 ch_end
  s_branch wk_loop
wp_abort:
wo_abort:
  s_branch cA_abort
ch_end:
  s_endpgm

.section .rodata,"a"
.p2align 6
.amdhsa_kernel main_kernel
  .amdhsa_next_free_vgpr 512
  .amdhsa_next_free_sgpr 102
  .amdhsa_accum_offset 256
  .amdhsa_group_segment_fixed_size 0
  .amdhsa_kernarg_size 136
  .amdhsa_user_sgpr_count 2
  .amdhsa_user_sgpr_kernarg_segment_ptr 1
  .amdhsa_system_sgpr_workgroup_id_x 1
.end_amdhsa_kernel
```

```asm
; @launch kernel=main_kernel grid=(256,1,1) block=(256,1,1) lds=163840
.amdgcn_target "amdgcn-amd-amdhsa--gfx950"
.text
.globl main_kernel
.p2align 8
.type main_kernel,@function
main_kernel:
  s_cmp_ge_u32 s2, 256
  s_cbranch_scc1 ch_end
  s_load_dwordx4 s[4:7], s[0:1], 120
  s_load_dwordx2 s[92:93], s[0:1], 112
  s_load_dwordx8 s[36:43], s[0:1], 56
  s_load_dwordx4 s[44:47], s[0:1], 88
  s_memrealtime s[88:89]
  s_getpc_b64 s[98:99]
pf_main_kernel_1:
  s_sub_u32 s98, s98, pf_main_kernel_1-main_kernel
  s_subb_u32 s99, s99, 0
  s_lshr_b32 s20, s2, 3
  v_lshl_add_u32 v60, v0, 5, s20
  v_lshlrev_b32 v60, 7, v60
  v_min_u32 v60, ch_end-main_kernel-4, v60
  v_cmp_gt_u32 vcc, 32, v0
  s_and_saveexec_b64 s[22:23], vcc
  s_cbranch_execz pf_main_kernel_1_n
  global_load_dword v62, v60, s[98:99]
pf_main_kernel_1_n:
  s_mov_b64 exec, -1
  s_getreg_b32 s67, hwreg(HW_REG_XCC_ID)
  s_and_b32 s67, s67, 7
  v_lshrrev_b32 v1, 6, v0
  s_nop 0
  v_readfirstlane_b32 s16, v1
  s_mov_b32 s66, 0
  s_mov_b32 s68, 0
  s_mov_b32 s69, 0
  s_mov_b32 s96, 0
  s_mov_b32 s97, 0
  s_mov_b32 s101, 0x5eed0000
  s_sub_u32 s20, s67, 0
  s_lshr_b32 s21, s2, 3
  s_and_b32 s20, s20, 7
  s_lshl_b32 s3, s20, 5
  s_add_u32 s3, s3, s21
  s_waitcnt lgkmcnt(0)
  s_mov_b32 s8, s6
  s_and_b32 s9, s7, 0xffff
  s_mov_b32 s10, 0x10000000
  s_mov_b32 s11, 0x20000
  s_mov_b32 s12, s4
  s_and_b32 s13, s5, 0xffff
  s_mov_b32 s14, 256
  s_mov_b32 s15, 0x20000
  s_or_b32 s88, s88, 1
  s_and_b32 s93, s93, 0xffff
  s_mov_b32 s94, 3670016
  s_mov_b32 s95, 0x20000
m_start:
  s_cmp_ge_u32 s3, 32
  s_cbranch_scc1 m_bjob
  v_and_b32 v1, 63, v0
  v_lshlrev_b32 v2, 4, v1
  v_lshrrev_b32 v116, 4, v1
  v_and_b32 v117, 15, v1
  v_mov_b32 v3, 0x4444
  v_mov_b32 v118, 0xeeee
  v_cmp_lt_u32 vcc, 7, v117
  s_nop 1
  v_cndmask_b32 v3, v3, v118, vcc
  s_and_b32 s17, s3, 15
  s_cmp_ge_u32 s3, 16
  s_cbranch_scc1 m_val
  s_mov_b32 s60, s42
  s_and_b32 s61, s43, 0xffff
  s_mov_b32 s62, 3670016
  s_mov_b32 s63, 0x20000
  v_lshrrev_b32 v24, 5, v1
  v_and_b32 v25, 31, v1
  s_lshl_b32 s26, s17, 9
  s_lshl_b32 s25, s16, 12
  v_xor_b32 v26, v25, v24
  v_lshlrev_b32 v26, 4, v26
  v_lshl_add_u32 v26, v24, 13, v26
  v_xor_b32 v100, 0, v26
  v_xor_b32 v101, 0, v26
  v_add_u32 v101, 15360, v101
  v_xor_b32 v102, 32, v26
  v_add_u32 v102, 30720, v102
  v_xor_b32 v103, 32, v26
  v_add_u32 v103, 46080, v103
  s_lshl_b32 s23, s16, 19
  s_add_u32 s23, s23, s26
  s_add_u32 m0, s25, 16384
  s_nop 0
  buffer_load_dwordx4 v100, s[60:63], s23 offen offset:0 lds
  buffer_load_dwordx4 v101, s[60:63], s23 offen offset:1024 lds
  buffer_load_dwordx4 v102, s[60:63], s23 offen offset:2048 lds
  buffer_load_dwordx4 v103, s[60:63], s23 offen offset:3072 lds
  s_add_u32 m0, s25, 32768
  s_add_u32 s23, s23, 65536
  buffer_load_dwordx4 v100, s[60:63], s23 offen offset:0 lds
  buffer_load_dwordx4 v101, s[60:63], s23 offen offset:1024 lds
  buffer_load_dwordx4 v102, s[60:63], s23 offen offset:2048 lds
  buffer_load_dwordx4 v103, s[60:63], s23 offen offset:3072 lds
  v_xor_b32 v100, 64, v100
  v_xor_b32 v101, 64, v101
  v_xor_b32 v102, 64, v102
  v_xor_b32 v103, 64, v103
  s_add_u32 m0, s25, 49152
  s_add_u32 s23, s23, 65536
  buffer_load_dwordx4 v100, s[60:63], s23 offen offset:0 lds
  buffer_load_dwordx4 v101, s[60:63], s23 offen offset:1024 lds
  buffer_load_dwordx4 v102, s[60:63], s23 offen offset:2048 lds
  buffer_load_dwordx4 v103, s[60:63], s23 offen offset:3072 lds
  s_add_u32 m0, s25, 65536
  s_add_u32 s23, s23, 65536
  buffer_load_dwordx4 v100, s[60:63], s23 offen offset:0 lds
  buffer_load_dwordx4 v101, s[60:63], s23 offen offset:1024 lds
  buffer_load_dwordx4 v102, s[60:63], s23 offen offset:2048 lds
  buffer_load_dwordx4 v103, s[60:63], s23 offen offset:3072 lds
  v_xor_b32 v100, 192, v100
  v_xor_b32 v101, 192, v101
  v_xor_b32 v102, 192, v102
  v_xor_b32 v103, 192, v103
  s_add_u32 m0, s25, 81920
  s_add_u32 s23, s23, 65536
  buffer_load_dwordx4 v100, s[60:63], s23 offen offset:0 lds
  buffer_load_dwordx4 v101, s[60:63], s23 offen offset:1024 lds
  buffer_load_dwordx4 v102, s[60:63], s23 offen offset:2048 lds
  buffer_load_dwordx4 v103, s[60:63], s23 offen offset:3072 lds
  s_add_u32 m0, s25, 98304
  s_add_u32 s23, s23, 65536
  buffer_load_dwordx4 v100, s[60:63], s23 offen offset:0 lds
  buffer_load_dwordx4 v101, s[60:63], s23 offen offset:1024 lds
  buffer_load_dwordx4 v102, s[60:63], s23 offen offset:2048 lds
  buffer_load_dwordx4 v103, s[60:63], s23 offen offset:3072 lds
  v_xor_b32 v100, 64, v100
  v_xor_b32 v101, 64, v101
  v_xor_b32 v102, 64, v102
  v_xor_b32 v103, 64, v103
  s_add_u32 m0, s25, 114688
  s_add_u32 s23, s23, 65536
  buffer_load_dwordx4 v100, s[60:63], s23 offen offset:0 lds
  buffer_load_dwordx4 v101, s[60:63], s23 offen offset:1024 lds
  buffer_load_dwordx4 v102, s[60:63], s23 offen offset:2048 lds
  buffer_load_dwordx4 v103, s[60:63], s23 offen offset:3072 lds
  s_add_u32 m0, s25, 131072
  s_add_u32 s23, s23, 65536
  buffer_load_dwordx4 v100, s[60:63], s23 offen offset:0 lds
  buffer_load_dwordx4 v101, s[60:63], s23 offen offset:1024 lds
  buffer_load_dwordx4 v102, s[60:63], s23 offen offset:2048 lds
  buffer_load_dwordx4 v103, s[60:63], s23 offen offset:3072 lds
  s_mov_b32 s56, s40
  s_and_b32 s57, s41, 0xffff
  s_mov_b32 s58, 3670016
  s_mov_b32 s59, 0x20000
  s_lshl_b32 s21, s16, 16
  s_add_u32 s27, s26, s21
  s_lshr_b32 s20, s16, 1
  s_lshl_b32 s20, s20, 6
  v_xor_b32 v26, s20, v26
  v_xor_b32 v4, 0, v26
  v_xor_b32 v5, 32, v26
  v_add_u32 v5, 15360, v5
  v_xor_b32 v6, 128, v26
  v_add_u32 v6, 30720, v6
  v_xor_b32 v7, 160, v26
  v_add_u32 v7, 46080, v7
  s_add_u32 s22, s27, 0
  s_add_u32 m0, s25, 0
  s_nop 0
  buffer_load_dwordx4 v4, s[56:59], s22 offen offset:0 lds
  buffer_load_dwordx4 v5, s[56:59], s22 offen offset:1024 lds
  buffer_load_dwordx4 v6, s[56:59], s22 offen offset:2048 lds
  buffer_load_dwordx4 v7, s[56:59], s22 offen offset:3072 lds
  s_cmp_lg_u32 s66, 0
  s_cbranch_scc1 sc_ci
  s_cmp_lg_u32 s16, 0
  s_cbranch_scc1 w0_2
  s_lshr_b32 s70, s3, 5
  s_and_b32 s71, s70, 4
  s_mul_i32 s71, s71, 12
  s_lshl_b32 s70, s70, 2
  s_add_u32 s70, s70, s71
  s_lshl_b32 s71, 1, s3
  v_mov_b32 v248, s71
  v_mov_b32 v249, 32
  s_mov_b64 exec, 1
  buffer_atomic_or v248, v249, s[12:15], s70 offen sc0
  buffer_load_dwordx2 v[250:251], v249, s[12:15], 0 offen offset:96 sc1
  s_mov_b64 exec, -1
w0_2:
sc_ci:
  v_and_b32 v26, 15, v25
  v_xor_b32 v27, v26, v24
  v_lshlrev_b32 v27, 4, v27
  v_bfe_u32 v28, v25, 2, 1
  v_lshlrev_b32 v28, 4, v28
  v_lshrrev_b32 v29, 3, v25
  v_lshl_add_u32 v28, v29, 2, v28
  v_and_b32 v29, 3, v25
  v_add_u32 v28, v28, v29
  v_lshl_add_u32 v28, v28, 9, v27
  v_lshrrev_b32 v29, 2, v26
  v_lshlrev_b32 v29, 15, v29
  v_bfe_u32 v30, v26, 1, 1
  v_lshl_add_u32 v29, v30, 11, v29
  v_lshrrev_b32 v30, 4, v25
  v_lshl_add_u32 v29, v30, 10, v29
  v_and_b32 v31, 1, v26
  v_lshl_add_u32 v29, v31, 9, v29
  v_add_u32 v29, v29, v27
  v_add_u32 v29, s25, v29
  v_xor_b32 v8, 0, v28
  v_xor_b32 v104, 0, v29
  v_xor_b32 v9, 32, v28
  v_xor_b32 v105, 32, v29
  v_xor_b32 v10, 64, v28
  v_xor_b32 v106, 64, v29
  v_xor_b32 v11, 96, v28
  v_xor_b32 v107, 96, v29
  v_xor_b32 v12, 128, v28
  v_xor_b32 v108, 128, v29
  v_xor_b32 v13, 160, v28
  v_xor_b32 v109, 160, v29
  v_xor_b32 v14, 192, v28
  v_xor_b32 v110, 192, v29
  v_xor_b32 v15, 224, v28
  v_xor_b32 v111, 224, v29
  s_mov_b32 s52, 1035512379
  s_waitcnt vmcnt(4)
  ds_read_b128 v[120:123], v104 offset:16384
  ds_read_b128 v[124:127], v105 offset:16384
  ds_read_b128 v[128:131], v106 offset:16384
  ds_read_b128 v[132:135], v107 offset:16384
  ds_read_b128 v[136:139], v108 offset:16384
  ds_read_b128 v[140:143], v109 offset:16384
  ds_read_b128 v[144:147], v110 offset:16384
  ds_read_b128 v[148:151], v111 offset:16384
  s_waitcnt lgkmcnt(4)
  ds_read_b128 v[152:155], v104 offset:16640
  ds_read_b128 v[156:159], v105 offset:16640
  ds_read_b128 v[160:163], v106 offset:16640
  ds_read_b128 v[164:167], v107 offset:16640
  ds_read_b128 v[168:171], v108 offset:16640
  ds_read_b128 v[172:175], v109 offset:16640
  ds_read_b128 v[176:179], v110 offset:16640
  ds_read_b128 v[180:183], v111 offset:16640
  s_waitcnt lgkmcnt(4)
  ds_read_b128 v[184:187], v104 offset:32768
  ds_read_b128 v[188:191], v105 offset:32768
  ds_read_b128 v[192:195], v106 offset:32768
  ds_read_b128 v[196:199], v107 offset:32768
  ds_read_b128 v[200:203], v108 offset:32768
  ds_read_b128 v[204:207], v109 offset:32768
  ds_read_b128 v[208:211], v110 offset:32768
  ds_read_b128 v[212:215], v111 offset:32768
  s_waitcnt lgkmcnt(4)
  ds_read_b128 v[216:219], v104 offset:33024
  ds_read_b128 v[220:223], v105 offset:33024
  ds_read_b128 v[224:227], v106 offset:33024
  ds_read_b128 v[228:231], v107 offset:33024
  ds_read_b128 v[232:235], v108 offset:33024
  ds_read_b128 v[236:239], v109 offset:33024
  ds_read_b128 v[240:243], v110 offset:33024
  ds_read_b128 v[244:247], v111 offset:33024
  s_waitcnt lgkmcnt(4)
  s_waitcnt lgkmcnt(0)
  s_add_u32 s22, s27, 262144
  s_add_u32 m0, s25, 16384
  s_nop 0
  buffer_load_dwordx4 v4, s[56:59], s22 offen offset:0 lds
  buffer_load_dwordx4 v5, s[56:59], s22 offen offset:1024 lds
  buffer_load_dwordx4 v6, s[56:59], s22 offen offset:2048 lds
  buffer_load_dwordx4 v7, s[56:59], s22 offen offset:3072 lds
  s_add_u32 s22, s27, 524288
  s_add_u32 m0, s25, 32768
  s_nop 0
  buffer_load_dwordx4 v4, s[56:59], s22 offen offset:0 lds
  buffer_load_dwordx4 v5, s[56:59], s22 offen offset:1024 lds
  buffer_load_dwordx4 v6, s[56:59], s22 offen offset:2048 lds
  buffer_load_dwordx4 v7, s[56:59], s22 offen offset:3072 lds
  s_add_u32 s22, s27, 786432
  s_add_u32 m0, s25, 49152
  s_nop 0
  buffer_load_dwordx4 v4, s[56:59], s22 offen offset:0 lds
  buffer_load_dwordx4 v5, s[56:59], s22 offen offset:1024 lds
  buffer_load_dwordx4 v6, s[56:59], s22 offen offset:2048 lds
  buffer_load_dwordx4 v7, s[56:59], s22 offen offset:3072 lds
  s_cmp_lg_u32 s66, 0
  s_cbranch_scc1 sc_cf
  s_cmp_lg_u32 s16, 0
  s_cbranch_scc1 w0_3
  s_waitcnt vmcnt(12)
  v_readfirstlane_b32 s70, v250
  s_cmp_lg_u32 s70, 0
  s_cbranch_scc1 sc_nz
  v_mov_b32 v249, 128
  v_mov_b32 v250, s88
  v_mov_b32 v251, s89
  v_mov_b32 v252, 0
  v_mov_b32 v253, 0
  s_mov_b64 exec, 1
  buffer_atomic_cmpswap_x2 v[250:253], v249, s[12:15], 0 offen sc0
  s_mov_b64 exec, -1
  s_waitcnt vmcnt(0)
  v_readfirstlane_b32 s70, v250
  s_cmp_lg_u32 s70, 0
  s_cbranch_scc1 sc_nz
  v_mov_b32 v250, s88
  v_mov_b32 v251, s89
sc_nz:
w0_3:
  v_mov_b32 v249, 160000
  s_add_u32 s101, s101, 1
  s_barrier
  s_mov_b64 exec, 1
  s_cmp_lg_u32 s16, 0
  s_cbranch_scc1 w0_4
  ds_write_b32 v249, v248 offset:0
  ds_write_b32 v249, v250 offset:4
  ds_write_b32 v249, v251 offset:8
  s_waitcnt lgkmcnt(0)
  v_mov_b32 v248, s101
  ds_write_b32 v249, v248 offset:16
  s_waitcnt lgkmcnt(0)
w0_4:
  s_mov_b64 exec, -1
  s_barrier
  ds_read_b32 v248, v249 offset:0
  ds_read_b32 v250, v249 offset:4
  ds_read_b32 v251, v249 offset:8
  ds_read_b32 v249, v249 offset:16
  s_waitcnt lgkmcnt(0)
  v_readfirstlane_b32 s70, v248
  v_readfirstlane_b32 s88, v250
  v_readfirstlane_b32 s89, v251
  v_cmp_ne_u32 vcc, s101, v249
  s_cbranch_vccnz ch_end
  s_mov_b32 s66, 1
  s_bitcmp1_b32 s70, s3
  s_cbranch_scc1 m_reclaim
sc_cf:
  s_cmp_lg_u32 s16, 0
  s_cbranch_scc1 w0_5
  s_cmp_eq_u32 s67, 0
  s_cselect_b32 s20, 1, 0x10001
  v_mov_b32 v248, s20
  v_mov_b32 v249, 0
  s_mov_b64 exec, 1
  buffer_atomic_add v248, v249, s[12:15], 0 offen
  s_mov_b64 exec, -1
w0_5:
  s_lshl_b32 s28, s17, 7
  s_add_u32 s28, s28, 88635392
  v_min_u32 v113, 96, v2
  s_mov_b32 s29, 88602624
  v_add_u32 v112, 1024, v2
  v_min_u32 v112, 1776, v112
  s_mul_i32 s32, s17, 401408
  s_mul_i32 s33, s16, 14336
  s_add_u32 s32, s32, s33
  s_add_u32 s33, s32, s33
  s_add_u32 s32, s32, 344064
  s_add_u32 s33, s33, 229376
  s_waitcnt vmcnt(8)
  s_barrier
  ds_read_b128 v[16:19], v8 offset:0
  ds_read_b128 v[20:23], v9 offset:0
  ds_read_b128 v[24:27], v10 offset:0
  ds_read_b128 v[28:31], v11 offset:0
  s_waitcnt lgkmcnt(3)
  v_mfma_f32_32x32x16_bf16 v[32:47], v[16:19], v[120:123], 0
  s_add_u32 s22, s27, 1048576
  s_add_u32 m0, s25, 65536
  s_nop 0
  buffer_load_dwordx4 v4, s[56:59], s22 offen offset:0 lds
  v_mfma_f32_32x32x16_bf16 v[48:63], v[16:19], v[184:187], 0
  ds_read_b128 v[16:19], v12 offset:0
  s_waitcnt lgkmcnt(3)
  v_mfma_f32_32x32x16_bf16 v[32:47], v[20:23], v[124:127], v[32:47]
  buffer_load_dwordx4 v5, s[56:59], s22 offen offset:1024 lds
  v_mfma_f32_32x32x16_bf16 v[48:63], v[20:23], v[188:191], v[48:63]
  ds_read_b128 v[20:23], v13 offset:0
  s_waitcnt lgkmcnt(3)
  v_mfma_f32_32x32x16_bf16 v[32:47], v[24:27], v[128:131], v[32:47]
  buffer_load_dwordx4 v6, s[56:59], s22 offen offset:2048 lds
  v_mfma_f32_32x32x16_bf16 v[48:63], v[24:27], v[192:195], v[48:63]
  ds_read_b128 v[24:27], v14 offset:0
  s_waitcnt lgkmcnt(3)
  v_mfma_f32_32x32x16_bf16 v[32:47], v[28:31], v[132:135], v[32:47]
  buffer_load_dwordx4 v7, s[56:59], s22 offen offset:3072 lds
  v_mfma_f32_32x32x16_bf16 v[48:63], v[28:31], v[196:199], v[48:63]
  ds_read_b128 v[28:31], v15 offset:0
  s_waitcnt lgkmcnt(3)
  v_mfma_f32_32x32x16_bf16 v[32:47], v[16:19], v[136:139], v[32:47]
  s_add_u32 s22, s27, 1310720
  s_add_u32 m0, s25, 81920
  s_nop 0
  buffer_load_dwordx4 v4, s[56:59], s22 offen offset:0 lds
  v_mfma_f32_32x32x16_bf16 v[48:63], v[16:19], v[200:203], v[48:63]
  ds_read_b128 v[16:19], v8 offset:256
  s_waitcnt lgkmcnt(3)
  v_mfma_f32_32x32x16_bf16 v[32:47], v[20:23], v[140:143], v[32:47]
  buffer_load_dwordx4 v5, s[56:59], s22 offen offset:1024 lds
  v_mfma_f32_32x32x16_bf16 v[48:63], v[20:23], v[204:207], v[48:63]
  ds_read_b128 v[20:23], v9 offset:256
  s_waitcnt lgkmcnt(3)
  v_mfma_f32_32x32x16_bf16 v[32:47], v[24:27], v[144:147], v[32:47]
  buffer_load_dwordx4 v6, s[56:59], s22 offen offset:2048 lds
  v_mfma_f32_32x32x16_bf16 v[48:63], v[24:27], v[208:211], v[48:63]
  ds_read_b128 v[24:27], v10 offset:256
  s_waitcnt lgkmcnt(3)
  v_mfma_f32_32x32x16_bf16 v[32:47], v[28:31], v[148:151], v[32:47]
  buffer_load_dwordx4 v7, s[56:59], s22 offen offset:3072 lds
  v_mfma_f32_32x32x16_bf16 v[48:63], v[28:31], v[212:215], v[48:63]
  ds_read_b128 v[28:31], v11 offset:256
  s_waitcnt lgkmcnt(3)
  v_mfma_f32_32x32x16_bf16 v[32:47], v[16:19], v[152:155], v[32:47]
  s_add_u32 s22, s27, 1572864
  s_add_u32 m0, s25, 98304
  s_nop 0
  buffer_load_dwordx4 v4, s[56:59], s22 offen offset:0 lds
  v_mfma_f32_32x32x16_bf16 v[48:63], v[16:19], v[216:219], v[48:63]
  ds_read_b128 v[16:19], v12 offset:256
  s_waitcnt lgkmcnt(3)
  v_mfma_f32_32x32x16_bf16 v[32:47], v[20:23], v[156:159], v[32:47]
  buffer_load_dwordx4 v5, s[56:59], s22 offen offset:1024 lds
  v_mfma_f32_32x32x16_bf16 v[48:63], v[20:23], v[220:223], v[48:63]
  ds_read_b128 v[20:23], v13 offset:256
  s_waitcnt lgkmcnt(3)
  v_mfma_f32_32x32x16_bf16 v[32:47], v[24:27], v[160:163], v[32:47]
  buffer_load_dwordx4 v6, s[56:59], s22 offen offset:2048 lds
  v_mfma_f32_32x32x16_bf16 v[48:63], v[24:27], v[224:227], v[48:63]
  ds_read_b128 v[24:27], v14 offset:256
  s_waitcnt lgkmcnt(3)
  v_mfma_f32_32x32x16_bf16 v[32:47], v[28:31], v[164:167], v[32:47]
  buffer_load_dwordx4 v7, s[56:59], s22 offen offset:3072 lds
  v_mfma_f32_32x32x16_bf16 v[48:63], v[28:31], v[228:231], v[48:63]
  ds_read_b128 v[28:31], v15 offset:256
  s_waitcnt lgkmcnt(3)
  v_mfma_f32_32x32x16_bf16 v[32:47], v[16:19], v[168:171], v[32:47]
  s_add_u32 s22, s27, 1835008
  s_add_u32 m0, s25, 114688
  s_nop 0
  buffer_load_dwordx4 v4, s[56:59], s22 offen offset:0 lds
  v_mfma_f32_32x32x16_bf16 v[48:63], v[16:19], v[232:235], v[48:63]
  ds_read_b128 v[16:19], v8 offset:16384
  s_waitcnt lgkmcnt(3)
  v_mfma_f32_32x32x16_bf16 v[32:47], v[20:23], v[172:175], v[32:47]
  buffer_load_dwordx4 v5, s[56:59], s22 offen offset:1024 lds
  v_mfma_f32_32x32x16_bf16 v[48:63], v[20:23], v[236:239], v[48:63]
  ds_read_b128 v[20:23], v9 offset:16384
  s_waitcnt lgkmcnt(3)
  v_mfma_f32_32x32x16_bf16 v[32:47], v[24:27], v[176:179], v[32:47]
  buffer_load_dwordx4 v6, s[56:59], s22 offen offset:2048 lds
  v_mfma_f32_32x32x16_bf16 v[48:63], v[24:27], v[240:243], v[48:63]
  ds_read_b128 v[24:27], v10 offset:16384
  s_waitcnt lgkmcnt(3)
  v_mfma_f32_32x32x16_bf16 v[32:47], v[28:31], v[180:183], v[32:47]
  buffer_load_dwordx4 v7, s[56:59], s22 offen offset:3072 lds
  v_mfma_f32_32x32x16_bf16 v[48:63], v[28:31], v[244:247], v[48:63]
  s_waitcnt vmcnt(16)
  s_barrier
  ds_read_b128 v[28:31], v11 offset:16384
  s_waitcnt lgkmcnt(3)
  v_mfma_f32_32x32x16_bf16 v[64:79], v[16:19], v[120:123], 0
  s_add_u32 s22, s27, 2097152
  s_add_u32 m0, s25, 131072
  s_nop 0
  buffer_load_dwordx4 v4, s[56:59], s22 offen offset:0 lds
  v_mfma_f32_32x32x16_bf16 v[80:95], v[16:19], v[184:187], 0
  ds_read_b128 v[16:19], v12 offset:16384
  s_waitcnt lgkmcnt(3)
  v_mfma_f32_32x32x16_bf16 v[64:79], v[20:23], v[124:127], v[64:79]
  buffer_load_dwordx4 v5, s[56:59], s22 offen offset:1024 lds
  v_mul_f32 v32, s52, v32
  v_mul_f32 v33, s52, v33
  v_cvt_pk_bf16_f32 v32, v32, v33
  v_mfma_f32_32x32x16_bf16 v[80:95], v[20:23], v[188:191], v[80:95]
  v_mul_f32 v34, s52, v34
  v_mul_f32 v35, s52, v35
  ds_read_b128 v[20:23], v13 offset:16384
  s_waitcnt lgkmcnt(3)
  v_mfma_f32_32x32x16_bf16 v[64:79], v[24:27], v[128:131], v[64:79]
  buffer_load_dwordx4 v6, s[56:59], s22 offen offset:2048 lds
  v_cvt_pk_bf16_f32 v33, v34, v35
  v_mul_f32 v36, s52, v36
  v_mul_f32 v37, s52, v37
  v_mfma_f32_32x32x16_bf16 v[80:95], v[24:27], v[192:195], v[80:95]
  v_cvt_pk_bf16_f32 v34, v36, v37
  v_mul_f32 v38, s52, v38
  ds_read_b128 v[24:27], v14 offset:16384
  s_waitcnt lgkmcnt(3)
  v_mfma_f32_32x32x16_bf16 v[64:79], v[28:31], v[132:135], v[64:79]
  buffer_load_dwordx4 v7, s[56:59], s22 offen offset:3072 lds
  v_mul_f32 v39, s52, v39
  v_cvt_pk_bf16_f32 v35, v38, v39
  v_mul_f32 v40, s52, v40
  v_mfma_f32_32x32x16_bf16 v[80:95], v[28:31], v[196:199], v[80:95]
  v_mul_f32 v41, s52, v41
  v_cvt_pk_bf16_f32 v40, v40, v41
  ds_read_b128 v[28:31], v15 offset:16384
  s_waitcnt lgkmcnt(3)
  v_mfma_f32_32x32x16_bf16 v[64:79], v[16:19], v[136:139], v[64:79]
  s_add_u32 s22, s27, 2359296
  s_add_u32 m0, s25, 0
  s_nop 0
  buffer_load_dwordx4 v4, s[56:59], s22 offen offset:0 lds
  v_mul_f32 v42, s52, v42
  v_mul_f32 v43, s52, v43
  v_cvt_pk_bf16_f32 v41, v42, v43
  v_mfma_f32_32x32x16_bf16 v[80:95], v[16:19], v[200:203], v[80:95]
  v_mul_f32 v44, s52, v44
  v_mul_f32 v45, s52, v45
  ds_read_b128 v[16:19], v8 offset:16640
  s_waitcnt lgkmcnt(3)
  v_mfma_f32_32x32x16_bf16 v[64:79], v[20:23], v[140:143], v[64:79]
  buffer_load_dwordx4 v5, s[56:59], s22 offen offset:1024 lds
  v_cvt_pk_bf16_f32 v42, v44, v45
  v_mul_f32 v46, s52, v46
  v_mul_f32 v47, s52, v47
  v_mfma_f32_32x32x16_bf16 v[80:95], v[20:23], v[204:207], v[80:95]
  v_cvt_pk_bf16_f32 v43, v46, v47
  v_permlane16_swap_b32 v32, v40
  ds_read_b128 v[20:23], v9 offset:16640
  s_waitcnt lgkmcnt(3)
  v_mfma_f32_32x32x16_bf16 v[64:79], v[24:27], v[144:147], v[64:79]
  buffer_load_dwordx4 v6, s[56:59], s22 offen offset:2048 lds
  v_permlane16_swap_b32 v33, v41
  v_permlane16_swap_b32 v34, v42
  v_permlane16_swap_b32 v35, v43
  v_mfma_f32_32x32x16_bf16 v[80:95], v[24:27], v[208:211], v[80:95]
  v_accvgpr_write_b32 a0, v32
  v_accvgpr_write_b32 a1, v33
  ds_read_b128 v[24:27], v10 offset:16640
  s_waitcnt lgkmcnt(3)
  v_mfma_f32_32x32x16_bf16 v[64:79], v[28:31], v[148:151], v[64:79]
  buffer_load_dwordx4 v7, s[56:59], s22 offen offset:3072 lds
  v_accvgpr_write_b32 a2, v34
  v_accvgpr_write_b32 a3, v35
  v_accvgpr_write_b32 a56, v40
  v_mfma_f32_32x32x16_bf16 v[80:95], v[28:31], v[212:215], v[80:95]
  v_accvgpr_write_b32 a57, v41
  v_accvgpr_write_b32 a58, v42
  ds_read_b128 v[28:31], v11 offset:16640
  s_waitcnt lgkmcnt(3)
  v_mfma_f32_32x32x16_bf16 v[64:79], v[16:19], v[152:155], v[64:79]
  v_accvgpr_write_b32 a59, v43
  v_mul_f32 v48, s52, v48
  v_mul_f32 v49, s52, v49
  v_mfma_f32_32x32x16_bf16 v[80:95], v[16:19], v[216:219], v[80:95]
  v_cvt_pk_bf16_f32 v48, v48, v49
  v_mul_f32 v50, s52, v50
  ds_read_b128 v[16:19], v12 offset:16640
  s_waitcnt lgkmcnt(3)
  v_mfma_f32_32x32x16_bf16 v[64:79], v[20:23], v[156:159], v[64:79]
  v_mul_f32 v51, s52, v51
  v_cvt_pk_bf16_f32 v49, v50, v51
  v_mul_f32 v52, s52, v52
  v_mfma_f32_32x32x16_bf16 v[80:95], v[20:23], v[220:223], v[80:95]
  v_mul_f32 v53, s52, v53
  v_cvt_pk_bf16_f32 v50, v52, v53
  ds_read_b128 v[20:23], v13 offset:16640
  s_waitcnt lgkmcnt(3)
  v_mfma_f32_32x32x16_bf16 v[64:79], v[24:27], v[160:163], v[64:79]
  v_mul_f32 v54, s52, v54
  v_mul_f32 v55, s52, v55
  v_cvt_pk_bf16_f32 v51, v54, v55
  v_mfma_f32_32x32x16_bf16 v[80:95], v[24:27], v[224:227], v[80:95]
  v_mul_f32 v56, s52, v56
  v_mul_f32 v57, s52, v57
  ds_read_b128 v[24:27], v14 offset:16640
  s_waitcnt lgkmcnt(3)
  v_mfma_f32_32x32x16_bf16 v[64:79], v[28:31], v[164:167], v[64:79]
  v_cvt_pk_bf16_f32 v56, v56, v57
  v_mul_f32 v58, s52, v58
  v_mul_f32 v59, s52, v59
  v_mfma_f32_32x32x16_bf16 v[80:95], v[28:31], v[228:231], v[80:95]
  v_cvt_pk_bf16_f32 v57, v58, v59
  v_mul_f32 v60, s52, v60
  ds_read_b128 v[28:31], v15 offset:16640
  s_waitcnt lgkmcnt(3)
  v_mfma_f32_32x32x16_bf16 v[64:79], v[16:19], v[168:171], v[64:79]
  v_mul_f32 v61, s52, v61
  v_cvt_pk_bf16_f32 v58, v60, v61
  v_mul_f32 v62, s52, v62
  v_mfma_f32_32x32x16_bf16 v[80:95], v[16:19], v[232:235], v[80:95]
  v_mul_f32 v63, s52, v63
  v_cvt_pk_bf16_f32 v59, v62, v63
  ds_read_b128 v[16:19], v8 offset:32768
  s_waitcnt lgkmcnt(3)
  v_mfma_f32_32x32x16_bf16 v[64:79], v[20:23], v[172:175], v[64:79]
  v_permlane16_swap_b32 v48, v56
  v_permlane16_swap_b32 v49, v57
  v_permlane16_swap_b32 v50, v58
  v_mfma_f32_32x32x16_bf16 v[80:95], v[20:23], v[236:239], v[80:95]
  v_permlane16_swap_b32 v51, v59
  v_accvgpr_write_b32 a112, v48
  ds_read_b128 v[20:23], v9 offset:32768
  s_waitcnt lgkmcnt(3)
  v_mfma_f32_32x32x16_bf16 v[64:79], v[24:27], v[176:179], v[64:79]
  v_accvgpr_write_b32 a113, v49
  v_accvgpr_write_b32 a114, v50
  v_accvgpr_write_b32 a115, v51
  v_mfma_f32_32x32x16_bf16 v[80:95], v[24:27], v[240:243], v[80:95]
  v_accvgpr_write_b32 a168, v56
  v_accvgpr_write_b32 a169, v57
  ds_read_b128 v[24:27], v10 offset:32768
  s_waitcnt lgkmcnt(3)
  v_mfma_f32_32x32x16_bf16 v[64:79], v[28:31], v[180:183], v[64:79]
  v_accvgpr_write_b32 a170, v58
  v_accvgpr_write_b32 a171, v59
  v_mfma_f32_32x32x16_bf16 v[80:95], v[28:31], v[244:247], v[80:95]
  ds_read_b128 v[28:31], v11 offset:32768
  s_waitcnt lgkmcnt(3)
  v_mfma_f32_32x32x16_bf16 v[32:47], v[16:19], v[120:123], 0
  v_mfma_f32_32x32x16_bf16 v[48:63], v[16:19], v[184:187], 0
  ds_read_b128 v[16:19], v12 offset:32768
  s_waitcnt lgkmcnt(3)
  v_mfma_f32_32x32x16_bf16 v[32:47], v[20:23], v[124:127], v[32:47]
  v_mul_f32 v64, s52, v64
  v_mul_f32 v65, s52, v65
  v_cvt_pk_bf16_f32 v64, v64, v65
  v_mfma_f32_32x32x16_bf16 v[48:63], v[20:23], v[188:191], v[48:63]
  v_mul_f32 v66, s52, v66
  v_mul_f32 v67, s52, v67
  ds_read_b128 v[20:23], v13 offset:32768
  s_waitcnt lgkmcnt(3)
  v_mfma_f32_32x32x16_bf16 v[32:47], v[24:27], v[128:131], v[32:47]
  v_cvt_pk_bf16_f32 v65, v66, v67
  v_mul_f32 v68, s52, v68
  v_mul_f32 v69, s52, v69
  v_mfma_f32_32x32x16_bf16 v[48:63], v[24:27], v[192:195], v[48:63]
  v_cvt_pk_bf16_f32 v66, v68, v69
  v_mul_f32 v70, s52, v70
  ds_read_b128 v[24:27], v14 offset:32768
  s_waitcnt lgkmcnt(3)
  v_mfma_f32_32x32x16_bf16 v[32:47], v[28:31], v[132:135], v[32:47]
  v_mul_f32 v71, s52, v71
  v_cvt_pk_bf16_f32 v67, v70, v71
  v_mul_f32 v72, s52, v72
  v_mfma_f32_32x32x16_bf16 v[48:63], v[28:31], v[196:199], v[48:63]
  v_mul_f32 v73, s52, v73
  v_cvt_pk_bf16_f32 v72, v72, v73
  ds_read_b128 v[28:31], v15 offset:32768
  s_waitcnt lgkmcnt(3)
  v_mfma_f32_32x32x16_bf16 v[32:47], v[16:19], v[136:139], v[32:47]
  v_mul_f32 v74, s52, v74
  v_mul_f32 v75, s52, v75
  v_cvt_pk_bf16_f32 v73, v74, v75
  v_mfma_f32_32x32x16_bf16 v[48:63], v[16:19], v[200:203], v[48:63]
  v_mul_f32 v76, s52, v76
  v_mul_f32 v77, s52, v77
  ds_read_b128 v[16:19], v8 offset:33024
  s_waitcnt lgkmcnt(3)
  v_mfma_f32_32x32x16_bf16 v[32:47], v[20:23], v[140:143], v[32:47]
  v_cvt_pk_bf16_f32 v74, v76, v77
  v_mul_f32 v78, s52, v78
  v_mul_f32 v79, s52, v79
  v_mfma_f32_32x32x16_bf16 v[48:63], v[20:23], v[204:207], v[48:63]
  v_cvt_pk_bf16_f32 v75, v78, v79
  v_permlane16_swap_b32 v64, v72
  ds_read_b128 v[20:23], v9 offset:33024
  s_waitcnt lgkmcnt(3)
  v_mfma_f32_32x32x16_bf16 v[32:47], v[24:27], v[144:147], v[32:47]
  v_permlane16_swap_b32 v65, v73
  v_permlane16_swap_b32 v66, v74
  v_permlane16_swap_b32 v67, v75
  v_mfma_f32_32x32x16_bf16 v[48:63], v[24:27], v[208:211], v[48:63]
  v_accvgpr_write_b32 a4, v64
  v_accvgpr_write_b32 a5, v65
  ds_read_b128 v[24:27], v10 offset:33024
  s_waitcnt lgkmcnt(3)
  v_mfma_f32_32x32x16_bf16 v[32:47], v[28:31], v[148:151], v[32:47]
  v_accvgpr_write_b32 a6, v66
  v_accvgpr_write_b32 a7, v67
  v_accvgpr_write_b32 a60, v72
  v_mfma_f32_32x32x16_bf16 v[48:63], v[28:31], v[212:215], v[48:63]
  v_accvgpr_write_b32 a61, v73
  v_accvgpr_write_b32 a62, v74
  ds_read_b128 v[28:31], v11 offset:33024
  s_waitcnt lgkmcnt(3)
  v_mfma_f32_32x32x16_bf16 v[32:47], v[16:19], v[152:155], v[32:47]
  v_accvgpr_write_b32 a63, v75
  v_mul_f32 v80, s52, v80
  v_mul_f32 v81, s52, v81
  v_mfma_f32_32x32x16_bf16 v[48:63], v[16:19], v[216:219], v[48:63]
  v_cvt_pk_bf16_f32 v80, v80, v81
  v_mul_f32 v82, s52, v82
  ds_read_b128 v[16:19], v12 offset:33024
  s_waitcnt lgkmcnt(3)
  v_mfma_f32_32x32x16_bf16 v[32:47], v[20:23], v[156:159], v[32:47]
  v_mul_f32 v83, s52, v83
  v_cvt_pk_bf16_f32 v81, v82, v83
  v_mul_f32 v84, s52, v84
  v_mfma_f32_32x32x16_bf16 v[48:63], v[20:23], v[220:223], v[48:63]
  v_mul_f32 v85, s52, v85
  v_cvt_pk_bf16_f32 v82, v84, v85
  ds_read_b128 v[20:23], v13 offset:33024
  s_waitcnt lgkmcnt(3)
  v_mfma_f32_32x32x16_bf16 v[32:47], v[24:27], v[160:163], v[32:47]
  v_mul_f32 v86, s52, v86
  v_mul_f32 v87, s52, v87
  v_cvt_pk_bf16_f32 v83, v86, v87
  v_mfma_f32_32x32x16_bf16 v[48:63], v[24:27], v[224:227], v[48:63]
  v_mul_f32 v88, s52, v88
  v_mul_f32 v89, s52, v89
  ds_read_b128 v[24:27], v14 offset:33024
  s_waitcnt lgkmcnt(3)
  v_mfma_f32_32x32x16_bf16 v[32:47], v[28:31], v[164:167], v[32:47]
  v_cvt_pk_bf16_f32 v88, v88, v89
  v_mul_f32 v90, s52, v90
  v_mul_f32 v91, s52, v91
  v_mfma_f32_32x32x16_bf16 v[48:63], v[28:31], v[228:231], v[48:63]
  v_cvt_pk_bf16_f32 v89, v90, v91
  v_mul_f32 v92, s52, v92
  ds_read_b128 v[28:31], v15 offset:33024
  s_waitcnt lgkmcnt(3)
  v_mfma_f32_32x32x16_bf16 v[32:47], v[16:19], v[168:171], v[32:47]
  v_mul_f32 v93, s52, v93
  v_cvt_pk_bf16_f32 v90, v92, v93
  v_mul_f32 v94, s52, v94
  v_mfma_f32_32x32x16_bf16 v[48:63], v[16:19], v[232:235], v[48:63]
  v_mul_f32 v95, s52, v95
  v_cvt_pk_bf16_f32 v91, v94, v95
  ds_read_b128 v[16:19], v8 offset:49152
  s_waitcnt lgkmcnt(3)
  v_mfma_f32_32x32x16_bf16 v[32:47], v[20:23], v[172:175], v[32:47]
  v_permlane16_swap_b32 v80, v88
  v_permlane16_swap_b32 v81, v89
  v_permlane16_swap_b32 v82, v90
  v_mfma_f32_32x32x16_bf16 v[48:63], v[20:23], v[236:239], v[48:63]
  v_permlane16_swap_b32 v83, v91
  v_accvgpr_write_b32 a116, v80
  ds_read_b128 v[20:23], v9 offset:49152
  s_waitcnt lgkmcnt(3)
  v_mfma_f32_32x32x16_bf16 v[32:47], v[24:27], v[176:179], v[32:47]
  v_accvgpr_write_b32 a117, v81
  v_accvgpr_write_b32 a118, v82
  v_accvgpr_write_b32 a119, v83
  v_mfma_f32_32x32x16_bf16 v[48:63], v[24:27], v[240:243], v[48:63]
  v_accvgpr_write_b32 a172, v88
  v_accvgpr_write_b32 a173, v89
  ds_read_b128 v[24:27], v10 offset:49152
  s_waitcnt lgkmcnt(3)
  v_mfma_f32_32x32x16_bf16 v[32:47], v[28:31], v[180:183], v[32:47]
  v_accvgpr_write_b32 a174, v90
  v_accvgpr_write_b32 a175, v91
  v_mfma_f32_32x32x16_bf16 v[48:63], v[28:31], v[244:247], v[48:63]
  s_waitcnt vmcnt(16)
  s_barrier
  ds_read_b128 v[28:31], v11 offset:49152
  s_waitcnt lgkmcnt(3)
  v_mfma_f32_32x32x16_bf16 v[64:79], v[16:19], v[120:123], 0
  s_add_u32 s22, s27, 2621440
  s_add_u32 m0, s25, 16384
  s_nop 0
  buffer_load_dwordx4 v4, s[56:59], s22 offen offset:0 lds
  v_mfma_f32_32x32x16_bf16 v[80:95], v[16:19], v[184:187], 0
  ds_read_b128 v[16:19], v12 offset:49152
  s_waitcnt lgkmcnt(3)
  v_mfma_f32_32x32x16_bf16 v[64:79], v[20:23], v[124:127], v[64:79]
  buffer_load_dwordx4 v5, s[56:59], s22 offen offset:1024 lds
  v_mul_f32 v32, s52, v32
  v_mul_f32 v33, s52, v33
  v_cvt_pk_bf16_f32 v32, v32, v33
  v_mfma_f32_32x32x16_bf16 v[80:95], v[20:23], v[188:191], v[80:95]
  v_mul_f32 v34, s52, v34
  v_mul_f32 v35, s52, v35
  ds_read_b128 v[20:23], v13 offset:49152
  s_waitcnt lgkmcnt(3)
  v_mfma_f32_32x32x16_bf16 v[64:79], v[24:27], v[128:131], v[64:79]
  buffer_load_dwordx4 v6, s[56:59], s22 offen offset:2048 lds
  v_cvt_pk_bf16_f32 v33, v34, v35
  v_mul_f32 v36, s52, v36
  v_mul_f32 v37, s52, v37
  v_mfma_f32_32x32x16_bf16 v[80:95], v[24:27], v[192:195], v[80:95]
  v_cvt_pk_bf16_f32 v34, v36, v37
  v_mul_f32 v38, s52, v38
  ds_read_b128 v[24:27], v14 offset:49152
  s_waitcnt lgkmcnt(3)
  v_mfma_f32_32x32x16_bf16 v[64:79], v[28:31], v[132:135], v[64:79]
  buffer_load_dwordx4 v7, s[56:59], s22 offen offset:3072 lds
  v_mul_f32 v39, s52, v39
  v_cvt_pk_bf16_f32 v35, v38, v39
  v_mul_f32 v40, s52, v40
  v_mfma_f32_32x32x16_bf16 v[80:95], v[28:31], v[196:199], v[80:95]
  v_mul_f32 v41, s52, v41
  v_cvt_pk_bf16_f32 v40, v40, v41
  ds_read_b128 v[28:31], v15 offset:49152
  s_waitcnt lgkmcnt(3)
  v_mfma_f32_32x32x16_bf16 v[64:79], v[16:19], v[136:139], v[64:79]
  s_add_u32 s22, s27, 2883584
  s_add_u32 m0, s25, 32768
  s_nop 0
  buffer_load_dwordx4 v4, s[56:59], s22 offen offset:0 lds
  v_mul_f32 v42, s52, v42
  v_mul_f32 v43, s52, v43
  v_cvt_pk_bf16_f32 v41, v42, v43
  v_mfma_f32_32x32x16_bf16 v[80:95], v[16:19], v[200:203], v[80:95]
  v_mul_f32 v44, s52, v44
  v_mul_f32 v45, s52, v45
  ds_read_b128 v[16:19], v8 offset:49408
  s_waitcnt lgkmcnt(3)
  v_mfma_f32_32x32x16_bf16 v[64:79], v[20:23], v[140:143], v[64:79]
  buffer_load_dwordx4 v5, s[56:59], s22 offen offset:1024 lds
  v_cvt_pk_bf16_f32 v42, v44, v45
  v_mul_f32 v46, s52, v46
  v_mul_f32 v47, s52, v47
  v_mfma_f32_32x32x16_bf16 v[80:95], v[20:23], v[204:207], v[80:95]
  v_cvt_pk_bf16_f32 v43, v46, v47
  v_permlane16_swap_b32 v32, v40
  ds_read_b128 v[20:23], v9 offset:49408
  s_waitcnt lgkmcnt(3)
  v_mfma_f32_32x32x16_bf16 v[64:79], v[24:27], v[144:147], v[64:79]
  buffer_load_dwordx4 v6, s[56:59], s22 offen offset:2048 lds
  v_permlane16_swap_b32 v33, v41
  v_permlane16_swap_b32 v34, v42
  v_permlane16_swap_b32 v35, v43
  v_mfma_f32_32x32x16_bf16 v[80:95], v[24:27], v[208:211], v[80:95]
  v_accvgpr_write_b32 a8, v32
  v_accvgpr_write_b32 a9, v33
  ds_read_b128 v[24:27], v10 offset:49408
  s_waitcnt lgkmcnt(3)
  v_mfma_f32_32x32x16_bf16 v[64:79], v[28:31], v[148:151], v[64:79]
  buffer_load_dwordx4 v7, s[56:59], s22 offen offset:3072 lds
  v_accvgpr_write_b32 a10, v34
  v_accvgpr_write_b32 a11, v35
  v_accvgpr_write_b32 a64, v40
  v_mfma_f32_32x32x16_bf16 v[80:95], v[28:31], v[212:215], v[80:95]
  v_accvgpr_write_b32 a65, v41
  v_accvgpr_write_b32 a66, v42
  ds_read_b128 v[28:31], v11 offset:49408
  s_waitcnt lgkmcnt(3)
  v_mfma_f32_32x32x16_bf16 v[64:79], v[16:19], v[152:155], v[64:79]
  v_accvgpr_write_b32 a67, v43
  v_mul_f32 v48, s52, v48
  v_mul_f32 v49, s52, v49
  v_mfma_f32_32x32x16_bf16 v[80:95], v[16:19], v[216:219], v[80:95]
  v_cvt_pk_bf16_f32 v48, v48, v49
  v_mul_f32 v50, s52, v50
  ds_read_b128 v[16:19], v12 offset:49408
  s_waitcnt lgkmcnt(3)
  v_mfma_f32_32x32x16_bf16 v[64:79], v[20:23], v[156:159], v[64:79]
  v_mul_f32 v51, s52, v51
  v_cvt_pk_bf16_f32 v49, v50, v51
  v_mul_f32 v52, s52, v52
  v_mfma_f32_32x32x16_bf16 v[80:95], v[20:23], v[220:223], v[80:95]
  v_mul_f32 v53, s52, v53
  v_cvt_pk_bf16_f32 v50, v52, v53
  ds_read_b128 v[20:23], v13 offset:49408
  s_waitcnt lgkmcnt(3)
  v_mfma_f32_32x32x16_bf16 v[64:79], v[24:27], v[160:163], v[64:79]
  v_mul_f32 v54, s52, v54
  v_mul_f32 v55, s52, v55
  v_cvt_pk_bf16_f32 v51, v54, v55
  v_mfma_f32_32x32x16_bf16 v[80:95], v[24:27], v[224:227], v[80:95]
  v_mul_f32 v56, s52, v56
  v_mul_f32 v57, s52, v57
  ds_read_b128 v[24:27], v14 offset:49408
  s_waitcnt lgkmcnt(3)
  v_mfma_f32_32x32x16_bf16 v[64:79], v[28:31], v[164:167], v[64:79]
  v_cvt_pk_bf16_f32 v56, v56, v57
  v_mul_f32 v58, s52, v58
  v_mul_f32 v59, s52, v59
  v_mfma_f32_32x32x16_bf16 v[80:95], v[28:31], v[228:231], v[80:95]
  v_cvt_pk_bf16_f32 v57, v58, v59
  v_mul_f32 v60, s52, v60
  ds_read_b128 v[28:31], v15 offset:49408
  s_waitcnt lgkmcnt(3)
  v_mfma_f32_32x32x16_bf16 v[64:79], v[16:19], v[168:171], v[64:79]
  v_mul_f32 v61, s52, v61
  v_cvt_pk_bf16_f32 v58, v60, v61
  v_mul_f32 v62, s52, v62
  v_mfma_f32_32x32x16_bf16 v[80:95], v[16:19], v[232:235], v[80:95]
  v_mul_f32 v63, s52, v63
  v_cvt_pk_bf16_f32 v59, v62, v63
  v_xor_b32 v8, 65536, v8
  ds_read_b128 v[16:19], v8 offset:0
  s_waitcnt lgkmcnt(3)
  v_mfma_f32_32x32x16_bf16 v[64:79], v[20:23], v[172:175], v[64:79]
  v_permlane16_swap_b32 v48, v56
  v_permlane16_swap_b32 v49, v57
  v_permlane16_swap_b32 v50, v58
  v_mfma_f32_32x32x16_bf16 v[80:95], v[20:23], v[236:239], v[80:95]
  v_permlane16_swap_b32 v51, v59
  v_accvgpr_write_b32 a120, v48
  v_xor_b32 v9, 65536, v9
  ds_read_b128 v[20:23], v9 offset:0
  s_waitcnt lgkmcnt(3)
  v_mfma_f32_32x32x16_bf16 v[64:79], v[24:27], v[176:179], v[64:79]
  v_accvgpr_write_b32 a121, v49
  v_accvgpr_write_b32 a122, v50
  v_accvgpr_write_b32 a123, v51
  v_mfma_f32_32x32x16_bf16 v[80:95], v[24:27], v[240:243], v[80:95]
  v_accvgpr_write_b32 a176, v56
  v_accvgpr_write_b32 a177, v57
  v_xor_b32 v10, 65536, v10
  ds_read_b128 v[24:27], v10 offset:0
  s_waitcnt lgkmcnt(3)
  v_mfma_f32_32x32x16_bf16 v[64:79], v[28:31], v[180:183], v[64:79]
  v_accvgpr_write_b32 a178, v58
  v_accvgpr_write_b32 a179, v59
  v_mfma_f32_32x32x16_bf16 v[80:95], v[28:31], v[244:247], v[80:95]
  v_xor_b32 v11, 65536, v11
  ds_read_b128 v[28:31], v11 offset:0
  s_waitcnt lgkmcnt(3)
  v_mfma_f32_32x32x16_bf16 v[32:47], v[16:19], v[120:123], 0
  v_mfma_f32_32x32x16_bf16 v[48:63], v[16:19], v[184:187], 0
  v_xor_b32 v12, 65536, v12
  ds_read_b128 v[16:19], v12 offset:0
  s_waitcnt lgkmcnt(3)
  v_mfma_f32_32x32x16_bf16 v[32:47], v[20:23], v[124:127], v[32:47]
  v_mul_f32 v64, s52, v64
  v_mul_f32 v65, s52, v65
  v_cvt_pk_bf16_f32 v64, v64, v65
  v_mfma_f32_32x32x16_bf16 v[48:63], v[20:23], v[188:191], v[48:63]
  v_mul_f32 v66, s52, v66
  v_mul_f32 v67, s52, v67
  v_xor_b32 v13, 65536, v13
  ds_read_b128 v[20:23], v13 offset:0
  s_waitcnt lgkmcnt(3)
  v_mfma_f32_32x32x16_bf16 v[32:47], v[24:27], v[128:131], v[32:47]
  v_cvt_pk_bf16_f32 v65, v66, v67
  v_mul_f32 v68, s52, v68
  v_mul_f32 v69, s52, v69
  v_mfma_f32_32x32x16_bf16 v[48:63], v[24:27], v[192:195], v[48:63]
  v_cvt_pk_bf16_f32 v66, v68, v69
  v_mul_f32 v70, s52, v70
  v_xor_b32 v14, 65536, v14
  ds_read_b128 v[24:27], v14 offset:0
  s_waitcnt lgkmcnt(3)
  v_mfma_f32_32x32x16_bf16 v[32:47], v[28:31], v[132:135], v[32:47]
  v_mul_f32 v71, s52, v71
  v_cvt_pk_bf16_f32 v67, v70, v71
  v_mul_f32 v72, s52, v72
  v_mfma_f32_32x32x16_bf16 v[48:63], v[28:31], v[196:199], v[48:63]
  v_mul_f32 v73, s52, v73
  v_cvt_pk_bf16_f32 v72, v72, v73
  v_xor_b32 v15, 65536, v15
  ds_read_b128 v[28:31], v15 offset:0
  s_waitcnt lgkmcnt(3)
  v_mfma_f32_32x32x16_bf16 v[32:47], v[16:19], v[136:139], v[32:47]
  v_mul_f32 v74, s52, v74
  v_mul_f32 v75, s52, v75
  v_cvt_pk_bf16_f32 v73, v74, v75
  v_mfma_f32_32x32x16_bf16 v[48:63], v[16:19], v[200:203], v[48:63]
  v_mul_f32 v76, s52, v76
  v_mul_f32 v77, s52, v77
  ds_read_b128 v[16:19], v8 offset:256
  s_waitcnt lgkmcnt(3)
  v_mfma_f32_32x32x16_bf16 v[32:47], v[20:23], v[140:143], v[32:47]
  v_cvt_pk_bf16_f32 v74, v76, v77
  v_mul_f32 v78, s52, v78
  v_mul_f32 v79, s52, v79
  v_mfma_f32_32x32x16_bf16 v[48:63], v[20:23], v[204:207], v[48:63]
  v_cvt_pk_bf16_f32 v75, v78, v79
  v_permlane16_swap_b32 v64, v72
  ds_read_b128 v[20:23], v9 offset:256
  s_waitcnt lgkmcnt(3)
  v_mfma_f32_32x32x16_bf16 v[32:47], v[24:27], v[144:147], v[32:47]
  v_permlane16_swap_b32 v65, v73
  v_permlane16_swap_b32 v66, v74
  v_permlane16_swap_b32 v67, v75
  v_mfma_f32_32x32x16_bf16 v[48:63], v[24:27], v[208:211], v[48:63]
  v_accvgpr_write_b32 a12, v64
  v_accvgpr_write_b32 a13, v65
  ds_read_b128 v[24:27], v10 offset:256
  s_waitcnt lgkmcnt(3)
  v_mfma_f32_32x32x16_bf16 v[32:47], v[28:31], v[148:151], v[32:47]
  v_accvgpr_write_b32 a14, v66
  v_accvgpr_write_b32 a15, v67
  v_accvgpr_write_b32 a68, v72
  v_mfma_f32_32x32x16_bf16 v[48:63], v[28:31], v[212:215], v[48:63]
  v_accvgpr_write_b32 a69, v73
  v_accvgpr_write_b32 a70, v74
  ds_read_b128 v[28:31], v11 offset:256
  s_waitcnt lgkmcnt(3)
  v_mfma_f32_32x32x16_bf16 v[32:47], v[16:19], v[152:155], v[32:47]
  v_accvgpr_write_b32 a71, v75
  v_mul_f32 v80, s52, v80
  v_mul_f32 v81, s52, v81
  v_mfma_f32_32x32x16_bf16 v[48:63], v[16:19], v[216:219], v[48:63]
  v_cvt_pk_bf16_f32 v80, v80, v81
  v_mul_f32 v82, s52, v82
  ds_read_b128 v[16:19], v12 offset:256
  s_waitcnt lgkmcnt(3)
  v_mfma_f32_32x32x16_bf16 v[32:47], v[20:23], v[156:159], v[32:47]
  v_mul_f32 v83, s52, v83
  v_cvt_pk_bf16_f32 v81, v82, v83
  v_mul_f32 v84, s52, v84
  v_mfma_f32_32x32x16_bf16 v[48:63], v[20:23], v[220:223], v[48:63]
  v_mul_f32 v85, s52, v85
  v_cvt_pk_bf16_f32 v82, v84, v85
  ds_read_b128 v[20:23], v13 offset:256
  s_waitcnt lgkmcnt(3)
  v_mfma_f32_32x32x16_bf16 v[32:47], v[24:27], v[160:163], v[32:47]
  v_mul_f32 v86, s52, v86
  v_mul_f32 v87, s52, v87
  v_cvt_pk_bf16_f32 v83, v86, v87
  v_mfma_f32_32x32x16_bf16 v[48:63], v[24:27], v[224:227], v[48:63]
  v_mul_f32 v88, s52, v88
  v_mul_f32 v89, s52, v89
  ds_read_b128 v[24:27], v14 offset:256
  s_waitcnt lgkmcnt(3)
  v_mfma_f32_32x32x16_bf16 v[32:47], v[28:31], v[164:167], v[32:47]
  v_cvt_pk_bf16_f32 v88, v88, v89
  v_mul_f32 v90, s52, v90
  v_mul_f32 v91, s52, v91
  v_mfma_f32_32x32x16_bf16 v[48:63], v[28:31], v[228:231], v[48:63]
  v_cvt_pk_bf16_f32 v89, v90, v91
  v_mul_f32 v92, s52, v92
  ds_read_b128 v[28:31], v15 offset:256
  s_waitcnt lgkmcnt(3)
  v_mfma_f32_32x32x16_bf16 v[32:47], v[16:19], v[168:171], v[32:47]
  v_mul_f32 v93, s52, v93
  v_cvt_pk_bf16_f32 v90, v92, v93
  v_mul_f32 v94, s52, v94
  v_mfma_f32_32x32x16_bf16 v[48:63], v[16:19], v[232:235], v[48:63]
  v_mul_f32 v95, s52, v95
  v_cvt_pk_bf16_f32 v91, v94, v95
  ds_read_b128 v[16:19], v8 offset:16384
  s_waitcnt lgkmcnt(3)
  v_mfma_f32_32x32x16_bf16 v[32:47], v[20:23], v[172:175], v[32:47]
  v_permlane16_swap_b32 v80, v88
  v_permlane16_swap_b32 v81, v89
  v_permlane16_swap_b32 v82, v90
  v_mfma_f32_32x32x16_bf16 v[48:63], v[20:23], v[236:239], v[48:63]
  v_permlane16_swap_b32 v83, v91
  v_accvgpr_write_b32 a124, v80
  ds_read_b128 v[20:23], v9 offset:16384
  s_waitcnt lgkmcnt(3)
  v_mfma_f32_32x32x16_bf16 v[32:47], v[24:27], v[176:179], v[32:47]
  v_accvgpr_write_b32 a125, v81
  v_accvgpr_write_b32 a126, v82
  v_accvgpr_write_b32 a127, v83
  v_mfma_f32_32x32x16_bf16 v[48:63], v[24:27], v[240:243], v[48:63]
  v_accvgpr_write_b32 a180, v88
  v_accvgpr_write_b32 a181, v89
  ds_read_b128 v[24:27], v10 offset:16384
  s_waitcnt lgkmcnt(3)
  v_mfma_f32_32x32x16_bf16 v[32:47], v[28:31], v[180:183], v[32:47]
  v_accvgpr_write_b32 a182, v90
  v_accvgpr_write_b32 a183, v91
  v_mfma_f32_32x32x16_bf16 v[48:63], v[28:31], v[244:247], v[48:63]
  s_waitcnt vmcnt(16)
  s_barrier
  ds_read_b128 v[28:31], v11 offset:16384
  s_waitcnt lgkmcnt(3)
  v_mfma_f32_32x32x16_bf16 v[64:79], v[16:19], v[120:123], 0
  s_add_u32 s22, s27, 3145728
  s_add_u32 m0, s25, 49152
  s_nop 0
  buffer_load_dwordx4 v4, s[56:59], s22 offen offset:0 lds
  v_mfma_f32_32x32x16_bf16 v[80:95], v[16:19], v[184:187], 0
  ds_read_b128 v[16:19], v12 offset:16384
  s_waitcnt lgkmcnt(3)
  v_mfma_f32_32x32x16_bf16 v[64:79], v[20:23], v[124:127], v[64:79]
  buffer_load_dwordx4 v5, s[56:59], s22 offen offset:1024 lds
  v_mul_f32 v32, s52, v32
  v_mul_f32 v33, s52, v33
  v_cvt_pk_bf16_f32 v32, v32, v33
  v_mfma_f32_32x32x16_bf16 v[80:95], v[20:23], v[188:191], v[80:95]
  v_mul_f32 v34, s52, v34
  v_mul_f32 v35, s52, v35
  ds_read_b128 v[20:23], v13 offset:16384
  s_waitcnt lgkmcnt(3)
  v_mfma_f32_32x32x16_bf16 v[64:79], v[24:27], v[128:131], v[64:79]
  buffer_load_dwordx4 v6, s[56:59], s22 offen offset:2048 lds
  v_cvt_pk_bf16_f32 v33, v34, v35
  v_mul_f32 v36, s52, v36
  v_mul_f32 v37, s52, v37
  v_mfma_f32_32x32x16_bf16 v[80:95], v[24:27], v[192:195], v[80:95]
  v_cvt_pk_bf16_f32 v34, v36, v37
  v_mul_f32 v38, s52, v38
  ds_read_b128 v[24:27], v14 offset:16384
  s_waitcnt lgkmcnt(3)
  v_mfma_f32_32x32x16_bf16 v[64:79], v[28:31], v[132:135], v[64:79]
  buffer_load_dwordx4 v7, s[56:59], s22 offen offset:3072 lds
  v_mul_f32 v39, s52, v39
  v_cvt_pk_bf16_f32 v35, v38, v39
  v_mul_f32 v40, s52, v40
  v_mfma_f32_32x32x16_bf16 v[80:95], v[28:31], v[196:199], v[80:95]
  v_mul_f32 v41, s52, v41
  v_cvt_pk_bf16_f32 v40, v40, v41
  ds_read_b128 v[28:31], v15 offset:16384
  s_waitcnt lgkmcnt(3)
  v_mfma_f32_32x32x16_bf16 v[64:79], v[16:19], v[136:139], v[64:79]
  s_add_u32 s22, s27, 3407872
  s_add_u32 m0, s25, 65536
  s_nop 0
  buffer_load_dwordx4 v4, s[56:59], s22 offen offset:0 lds
  v_mul_f32 v42, s52, v42
  v_mul_f32 v43, s52, v43
  v_cvt_pk_bf16_f32 v41, v42, v43
  v_mfma_f32_32x32x16_bf16 v[80:95], v[16:19], v[200:203], v[80:95]
  v_mul_f32 v44, s52, v44
  v_mul_f32 v45, s52, v45
  ds_read_b128 v[16:19], v8 offset:16640
  s_waitcnt lgkmcnt(3)
  v_mfma_f32_32x32x16_bf16 v[64:79], v[20:23], v[140:143], v[64:79]
  buffer_load_dwordx4 v5, s[56:59], s22 offen offset:1024 lds
  v_cvt_pk_bf16_f32 v42, v44, v45
  v_mul_f32 v46, s52, v46
  v_mul_f32 v47, s52, v47
  v_mfma_f32_32x32x16_bf16 v[80:95], v[20:23], v[204:207], v[80:95]
  v_cvt_pk_bf16_f32 v43, v46, v47
  v_permlane16_swap_b32 v32, v40
  ds_read_b128 v[20:23], v9 offset:16640
  s_waitcnt lgkmcnt(3)
  v_mfma_f32_32x32x16_bf16 v[64:79], v[24:27], v[144:147], v[64:79]
  buffer_load_dwordx4 v6, s[56:59], s22 offen offset:2048 lds
  v_permlane16_swap_b32 v33, v41
  v_permlane16_swap_b32 v34, v42
  v_permlane16_swap_b32 v35, v43
  v_mfma_f32_32x32x16_bf16 v[80:95], v[24:27], v[208:211], v[80:95]
  v_accvgpr_write_b32 a16, v32
  v_accvgpr_write_b32 a17, v33
  ds_read_b128 v[24:27], v10 offset:16640
  s_waitcnt lgkmcnt(3)
  v_mfma_f32_32x32x16_bf16 v[64:79], v[28:31], v[148:151], v[64:79]
  buffer_load_dwordx4 v7, s[56:59], s22 offen offset:3072 lds
  v_accvgpr_write_b32 a18, v34
  v_accvgpr_write_b32 a19, v35
  v_accvgpr_write_b32 a72, v40
  v_mfma_f32_32x32x16_bf16 v[80:95], v[28:31], v[212:215], v[80:95]
  v_accvgpr_write_b32 a73, v41
  v_accvgpr_write_b32 a74, v42
  ds_read_b128 v[28:31], v11 offset:16640
  s_waitcnt lgkmcnt(3)
  v_mfma_f32_32x32x16_bf16 v[64:79], v[16:19], v[152:155], v[64:79]
  v_accvgpr_write_b32 a75, v43
  v_mul_f32 v48, s52, v48
  v_mul_f32 v49, s52, v49
  v_mfma_f32_32x32x16_bf16 v[80:95], v[16:19], v[216:219], v[80:95]
  v_cvt_pk_bf16_f32 v48, v48, v49
  v_mul_f32 v50, s52, v50
  ds_read_b128 v[16:19], v12 offset:16640
  s_waitcnt lgkmcnt(3)
  v_mfma_f32_32x32x16_bf16 v[64:79], v[20:23], v[156:159], v[64:79]
  v_mul_f32 v51, s52, v51
  v_cvt_pk_bf16_f32 v49, v50, v51
  v_mul_f32 v52, s52, v52
  v_mfma_f32_32x32x16_bf16 v[80:95], v[20:23], v[220:223], v[80:95]
  v_mul_f32 v53, s52, v53
  v_cvt_pk_bf16_f32 v50, v52, v53
  ds_read_b128 v[20:23], v13 offset:16640
  s_waitcnt lgkmcnt(3)
  v_mfma_f32_32x32x16_bf16 v[64:79], v[24:27], v[160:163], v[64:79]
  v_mul_f32 v54, s52, v54
  v_mul_f32 v55, s52, v55
  v_cvt_pk_bf16_f32 v51, v54, v55
  v_mfma_f32_32x32x16_bf16 v[80:95], v[24:27], v[224:227], v[80:95]
  v_mul_f32 v56, s52, v56
  v_mul_f32 v57, s52, v57
  ds_read_b128 v[24:27], v14 offset:16640
  s_waitcnt lgkmcnt(3)
  v_mfma_f32_32x32x16_bf16 v[64:79], v[28:31], v[164:167], v[64:79]
  v_cvt_pk_bf16_f32 v56, v56, v57
  v_mul_f32 v58, s52, v58
  v_mul_f32 v59, s52, v59
  v_mfma_f32_32x32x16_bf16 v[80:95], v[28:31], v[228:231], v[80:95]
  v_cvt_pk_bf16_f32 v57, v58, v59
  v_mul_f32 v60, s52, v60
  ds_read_b128 v[28:31], v15 offset:16640
  s_waitcnt lgkmcnt(3)
  v_mfma_f32_32x32x16_bf16 v[64:79], v[16:19], v[168:171], v[64:79]
  v_mul_f32 v61, s52, v61
  v_cvt_pk_bf16_f32 v58, v60, v61
  v_mul_f32 v62, s52, v62
  v_mfma_f32_32x32x16_bf16 v[80:95], v[16:19], v[232:235], v[80:95]
  v_mul_f32 v63, s52, v63
  v_cvt_pk_bf16_f32 v59, v62, v63
  ds_read_b128 v[16:19], v8 offset:32768
  s_waitcnt lgkmcnt(3)
  v_mfma_f32_32x32x16_bf16 v[64:79], v[20:23], v[172:175], v[64:79]
  v_permlane16_swap_b32 v48, v56
  v_permlane16_swap_b32 v49, v57
  v_permlane16_swap_b32 v50, v58
  v_mfma_f32_32x32x16_bf16 v[80:95], v[20:23], v[236:239], v[80:95]
  v_permlane16_swap_b32 v51, v59
  v_accvgpr_write_b32 a128, v48
  ds_read_b128 v[20:23], v9 offset:32768
  s_waitcnt lgkmcnt(3)
  v_mfma_f32_32x32x16_bf16 v[64:79], v[24:27], v[176:179], v[64:79]
  v_accvgpr_write_b32 a129, v49
  v_accvgpr_write_b32 a130, v50
  v_accvgpr_write_b32 a131, v51
  v_mfma_f32_32x32x16_bf16 v[80:95], v[24:27], v[240:243], v[80:95]
  v_accvgpr_write_b32 a184, v56
  v_accvgpr_write_b32 a185, v57
  ds_read_b128 v[24:27], v10 offset:32768
  s_waitcnt lgkmcnt(3)
  v_mfma_f32_32x32x16_bf16 v[64:79], v[28:31], v[180:183], v[64:79]
  v_accvgpr_write_b32 a186, v58
  v_accvgpr_write_b32 a187, v59
  v_mfma_f32_32x32x16_bf16 v[80:95], v[28:31], v[244:247], v[80:95]
  ds_read_b128 v[28:31], v11 offset:32768
  s_waitcnt lgkmcnt(3)
  v_mfma_f32_32x32x16_bf16 v[32:47], v[16:19], v[120:123], 0
  v_mfma_f32_32x32x16_bf16 v[48:63], v[16:19], v[184:187], 0
  ds_read_b128 v[16:19], v12 offset:32768
  s_waitcnt lgkmcnt(3)
  v_mfma_f32_32x32x16_bf16 v[32:47], v[20:23], v[124:127], v[32:47]
  v_mul_f32 v64, s52, v64
  v_mul_f32 v65, s52, v65
  v_cvt_pk_bf16_f32 v64, v64, v65
  v_mfma_f32_32x32x16_bf16 v[48:63], v[20:23], v[188:191], v[48:63]
  v_mul_f32 v66, s52, v66
  v_mul_f32 v67, s52, v67
  ds_read_b128 v[20:23], v13 offset:32768
  s_waitcnt lgkmcnt(3)
  v_mfma_f32_32x32x16_bf16 v[32:47], v[24:27], v[128:131], v[32:47]
  v_cvt_pk_bf16_f32 v65, v66, v67
  v_mul_f32 v68, s52, v68
  v_mul_f32 v69, s52, v69
  v_mfma_f32_32x32x16_bf16 v[48:63], v[24:27], v[192:195], v[48:63]
  v_cvt_pk_bf16_f32 v66, v68, v69
  v_mul_f32 v70, s52, v70
  ds_read_b128 v[24:27], v14 offset:32768
  s_waitcnt lgkmcnt(3)
  v_mfma_f32_32x32x16_bf16 v[32:47], v[28:31], v[132:135], v[32:47]
  v_mul_f32 v71, s52, v71
  v_cvt_pk_bf16_f32 v67, v70, v71
  v_mul_f32 v72, s52, v72
  v_mfma_f32_32x32x16_bf16 v[48:63], v[28:31], v[196:199], v[48:63]
  v_mul_f32 v73, s52, v73
  v_cvt_pk_bf16_f32 v72, v72, v73
  ds_read_b128 v[28:31], v15 offset:32768
  s_waitcnt lgkmcnt(3)
  v_mfma_f32_32x32x16_bf16 v[32:47], v[16:19], v[136:139], v[32:47]
  v_mul_f32 v74, s52, v74
  v_mul_f32 v75, s52, v75
  v_cvt_pk_bf16_f32 v73, v74, v75
  v_mfma_f32_32x32x16_bf16 v[48:63], v[16:19], v[200:203], v[48:63]
  v_mul_f32 v76, s52, v76
  v_mul_f32 v77, s52, v77
  ds_read_b128 v[16:19], v8 offset:33024
  s_waitcnt lgkmcnt(3)
  v_mfma_f32_32x32x16_bf16 v[32:47], v[20:23], v[140:143], v[32:47]
  v_cvt_pk_bf16_f32 v74, v76, v77
  v_mul_f32 v78, s52, v78
  v_mul_f32 v79, s52, v79
  v_mfma_f32_32x32x16_bf16 v[48:63], v[20:23], v[204:207], v[48:63]
  v_cvt_pk_bf16_f32 v75, v78, v79
  v_permlane16_swap_b32 v64, v72
  ds_read_b128 v[20:23], v9 offset:33024
  s_waitcnt lgkmcnt(3)
  v_mfma_f32_32x32x16_bf16 v[32:47], v[24:27], v[144:147], v[32:47]
  v_permlane16_swap_b32 v65, v73
  v_permlane16_swap_b32 v66, v74
  v_permlane16_swap_b32 v67, v75
  v_mfma_f32_32x32x16_bf16 v[48:63], v[24:27], v[208:211], v[48:63]
  v_accvgpr_write_b32 a20, v64
  v_accvgpr_write_b32 a21, v65
  ds_read_b128 v[24:27], v10 offset:33024
  s_waitcnt lgkmcnt(3)
  v_mfma_f32_32x32x16_bf16 v[32:47], v[28:31], v[148:151], v[32:47]
  v_accvgpr_write_b32 a22, v66
  v_accvgpr_write_b32 a23, v67
  v_accvgpr_write_b32 a76, v72
  v_mfma_f32_32x32x16_bf16 v[48:63], v[28:31], v[212:215], v[48:63]
  v_accvgpr_write_b32 a77, v73
  v_accvgpr_write_b32 a78, v74
  ds_read_b128 v[28:31], v11 offset:33024
  s_waitcnt lgkmcnt(3)
  v_mfma_f32_32x32x16_bf16 v[32:47], v[16:19], v[152:155], v[32:47]
  v_accvgpr_write_b32 a79, v75
  v_mul_f32 v80, s52, v80
  v_mul_f32 v81, s52, v81
  v_mfma_f32_32x32x16_bf16 v[48:63], v[16:19], v[216:219], v[48:63]
  v_cvt_pk_bf16_f32 v80, v80, v81
  v_mul_f32 v82, s52, v82
  ds_read_b128 v[16:19], v12 offset:33024
  s_waitcnt lgkmcnt(3)
  v_mfma_f32_32x32x16_bf16 v[32:47], v[20:23], v[156:159], v[32:47]
  v_mul_f32 v83, s52, v83
  v_cvt_pk_bf16_f32 v81, v82, v83
  v_mul_f32 v84, s52, v84
  v_mfma_f32_32x32x16_bf16 v[48:63], v[20:23], v[220:223], v[48:63]
  v_mul_f32 v85, s52, v85
  v_cvt_pk_bf16_f32 v82, v84, v85
  ds_read_b128 v[20:23], v13 offset:33024
  s_waitcnt lgkmcnt(3)
  v_mfma_f32_32x32x16_bf16 v[32:47], v[24:27], v[160:163], v[32:47]
  v_mul_f32 v86, s52, v86
  v_mul_f32 v87, s52, v87
  v_cvt_pk_bf16_f32 v83, v86, v87
  v_mfma_f32_32x32x16_bf16 v[48:63], v[24:27], v[224:227], v[48:63]
  v_mul_f32 v88, s52, v88
  v_mul_f32 v89, s52, v89
  ds_read_b128 v[24:27], v14 offset:33024
  s_waitcnt lgkmcnt(3)
  v_mfma_f32_32x32x16_bf16 v[32:47], v[28:31], v[164:167], v[32:47]
  v_cvt_pk_bf16_f32 v88, v88, v89
  v_mul_f32 v90, s52, v90
  v_mul_f32 v91, s52, v91
  v_mfma_f32_32x32x16_bf16 v[48:63], v[28:31], v[228:231], v[48:63]
  v_cvt_pk_bf16_f32 v89, v90, v91
  v_mul_f32 v92, s52, v92
  ds_read_b128 v[28:31], v15 offset:33024
  s_waitcnt lgkmcnt(3)
  v_mfma_f32_32x32x16_bf16 v[32:47], v[16:19], v[168:171], v[32:47]
  v_mul_f32 v93, s52, v93
  v_cvt_pk_bf16_f32 v90, v92, v93
  v_mul_f32 v94, s52, v94
  v_mfma_f32_32x32x16_bf16 v[48:63], v[16:19], v[232:235], v[48:63]
  v_mul_f32 v95, s52, v95
  v_cvt_pk_bf16_f32 v91, v94, v95
  ds_read_b128 v[16:19], v8 offset:49152
  s_waitcnt lgkmcnt(3)
  v_mfma_f32_32x32x16_bf16 v[32:47], v[20:23], v[172:175], v[32:47]
  v_permlane16_swap_b32 v80, v88
  v_permlane16_swap_b32 v81, v89
  v_permlane16_swap_b32 v82, v90
  v_mfma_f32_32x32x16_bf16 v[48:63], v[20:23], v[236:239], v[48:63]
  v_permlane16_swap_b32 v83, v91
  v_accvgpr_write_b32 a132, v80
  ds_read_b128 v[20:23], v9 offset:49152
  s_waitcnt lgkmcnt(3)
  v_mfma_f32_32x32x16_bf16 v[32:47], v[24:27], v[176:179], v[32:47]
  v_accvgpr_write_b32 a133, v81
  v_accvgpr_write_b32 a134, v82
  v_accvgpr_write_b32 a135, v83
  v_mfma_f32_32x32x16_bf16 v[48:63], v[24:27], v[240:243], v[48:63]
  v_accvgpr_write_b32 a188, v88
  v_accvgpr_write_b32 a189, v89
  ds_read_b128 v[24:27], v10 offset:49152
  s_waitcnt lgkmcnt(3)
  v_mfma_f32_32x32x16_bf16 v[32:47], v[28:31], v[180:183], v[32:47]
  v_accvgpr_write_b32 a190, v90
  v_accvgpr_write_b32 a191, v91
  v_mfma_f32_32x32x16_bf16 v[48:63], v[28:31], v[244:247], v[48:63]
  s_waitcnt vmcnt(16)
  s_barrier
  ds_read_b128 v[28:31], v11 offset:49152
  s_waitcnt lgkmcnt(3)
  v_mfma_f32_32x32x16_bf16 v[64:79], v[16:19], v[120:123], 0
  v_mfma_f32_32x32x16_bf16 v[80:95], v[16:19], v[184:187], 0
  ds_read_b128 v[16:19], v12 offset:49152
  s_waitcnt lgkmcnt(3)
  v_mfma_f32_32x32x16_bf16 v[64:79], v[20:23], v[124:127], v[64:79]
  v_mul_f32 v32, s52, v32
  v_mul_f32 v33, s52, v33
  v_cvt_pk_bf16_f32 v32, v32, v33
  v_mfma_f32_32x32x16_bf16 v[80:95], v[20:23], v[188:191], v[80:95]
  v_mul_f32 v34, s52, v34
  v_mul_f32 v35, s52, v35
  ds_read_b128 v[20:23], v13 offset:49152
  s_waitcnt lgkmcnt(3)
  v_mfma_f32_32x32x16_bf16 v[64:79], v[24:27], v[128:131], v[64:79]
  v_cvt_pk_bf16_f32 v33, v34, v35
  v_mul_f32 v36, s52, v36
  v_mul_f32 v37, s52, v37
  v_mfma_f32_32x32x16_bf16 v[80:95], v[24:27], v[192:195], v[80:95]
  v_cvt_pk_bf16_f32 v34, v36, v37
  v_mul_f32 v38, s52, v38
  ds_read_b128 v[24:27], v14 offset:49152
  s_waitcnt lgkmcnt(3)
  v_mfma_f32_32x32x16_bf16 v[64:79], v[28:31], v[132:135], v[64:79]
  v_mul_f32 v39, s52, v39
  v_cvt_pk_bf16_f32 v35, v38, v39
  v_mul_f32 v40, s52, v40
  v_mfma_f32_32x32x16_bf16 v[80:95], v[28:31], v[196:199], v[80:95]
  v_mul_f32 v41, s52, v41
  v_cvt_pk_bf16_f32 v40, v40, v41
  ds_read_b128 v[28:31], v15 offset:49152
  s_waitcnt lgkmcnt(3)
  v_mfma_f32_32x32x16_bf16 v[64:79], v[16:19], v[136:139], v[64:79]
  buffer_load_dwordx4 v[100:103], v113, s[8:11], s28 offen sc1
  v_mul_f32 v42, s52, v42
  v_mul_f32 v43, s52, v43
  v_cvt_pk_bf16_f32 v41, v42, v43
  v_mfma_f32_32x32x16_bf16 v[80:95], v[16:19], v[200:203], v[80:95]
  v_mul_f32 v44, s52, v44
  v_mul_f32 v45, s52, v45
  ds_read_b128 v[16:19], v8 offset:49408
  s_waitcnt lgkmcnt(3)
  v_mfma_f32_32x32x16_bf16 v[64:79], v[20:23], v[140:143], v[64:79]
  v_cvt_pk_bf16_f32 v42, v44, v45
  v_mul_f32 v46, s52, v46
  v_mul_f32 v47, s52, v47
  v_mfma_f32_32x32x16_bf16 v[80:95], v[20:23], v[204:207], v[80:95]
  v_cvt_pk_bf16_f32 v43, v46, v47
  v_permlane16_swap_b32 v32, v40
  ds_read_b128 v[20:23], v9 offset:49408
  s_waitcnt lgkmcnt(3)
  v_mfma_f32_32x32x16_bf16 v[64:79], v[24:27], v[144:147], v[64:79]
  v_permlane16_swap_b32 v33, v41
  v_permlane16_swap_b32 v34, v42
  v_permlane16_swap_b32 v35, v43
  v_mfma_f32_32x32x16_bf16 v[80:95], v[24:27], v[208:211], v[80:95]
  v_accvgpr_write_b32 a24, v32
  v_accvgpr_write_b32 a25, v33
  ds_read_b128 v[24:27], v10 offset:49408
  s_waitcnt lgkmcnt(3)
  v_mfma_f32_32x32x16_bf16 v[64:79], v[28:31], v[148:151], v[64:79]
  v_accvgpr_write_b32 a26, v34
  v_accvgpr_write_b32 a27, v35
  v_accvgpr_write_b32 a80, v40
  v_mfma_f32_32x32x16_bf16 v[80:95], v[28:31], v[212:215], v[80:95]
  v_accvgpr_write_b32 a81, v41
  v_accvgpr_write_b32 a82, v42
  ds_read_b128 v[28:31], v11 offset:49408
  s_waitcnt lgkmcnt(3)
  v_mfma_f32_32x32x16_bf16 v[64:79], v[16:19], v[152:155], v[64:79]
  v_accvgpr_write_b32 a83, v43
  v_mul_f32 v48, s52, v48
  v_mul_f32 v49, s52, v49
  v_mfma_f32_32x32x16_bf16 v[80:95], v[16:19], v[216:219], v[80:95]
  v_cvt_pk_bf16_f32 v48, v48, v49
  v_mul_f32 v50, s52, v50
  ds_read_b128 v[16:19], v12 offset:49408
  s_waitcnt lgkmcnt(3)
  v_mfma_f32_32x32x16_bf16 v[64:79], v[20:23], v[156:159], v[64:79]
  v_mul_f32 v51, s52, v51
  v_cvt_pk_bf16_f32 v49, v50, v51
  v_mul_f32 v52, s52, v52
  v_mfma_f32_32x32x16_bf16 v[80:95], v[20:23], v[220:223], v[80:95]
  v_mul_f32 v53, s52, v53
  v_cvt_pk_bf16_f32 v50, v52, v53
  ds_read_b128 v[20:23], v13 offset:49408
  s_waitcnt lgkmcnt(3)
  v_mfma_f32_32x32x16_bf16 v[64:79], v[24:27], v[160:163], v[64:79]
  v_mul_f32 v54, s52, v54
  v_mul_f32 v55, s52, v55
  v_cvt_pk_bf16_f32 v51, v54, v55
  v_mfma_f32_32x32x16_bf16 v[80:95], v[24:27], v[224:227], v[80:95]
  v_mul_f32 v56, s52, v56
  v_mul_f32 v57, s52, v57
  ds_read_b128 v[24:27], v14 offset:49408
  s_waitcnt lgkmcnt(3)
  v_mfma_f32_32x32x16_bf16 v[64:79], v[28:31], v[164:167], v[64:79]
  v_cvt_pk_bf16_f32 v56, v56, v57
  v_mul_f32 v58, s52, v58
  v_mul_f32 v59, s52, v59
  v_mfma_f32_32x32x16_bf16 v[80:95], v[28:31], v[228:231], v[80:95]
  v_cvt_pk_bf16_f32 v57, v58, v59
  v_mul_f32 v60, s52, v60
  ds_read_b128 v[28:31], v15 offset:49408
  s_waitcnt lgkmcnt(3)
  v_mfma_f32_32x32x16_bf16 v[64:79], v[16:19], v[168:171], v[64:79]
  v_mul_f32 v61, s52, v61
  v_cvt_pk_bf16_f32 v58, v60, v61
  v_mul_f32 v62, s52, v62
  v_mfma_f32_32x32x16_bf16 v[80:95], v[16:19], v[232:235], v[80:95]
  v_mul_f32 v63, s52, v63
  v_cvt_pk_bf16_f32 v59, v62, v63
  v_xor_b32 v8, 196608, v8
  ds_read_b128 v[16:19], v8 offset:0
  s_waitcnt lgkmcnt(3)
  v_mfma_f32_32x32x16_bf16 v[64:79], v[20:23], v[172:175], v[64:79]
  v_permlane16_swap_b32 v48, v56
  v_permlane16_swap_b32 v49, v57
  v_permlane16_swap_b32 v50, v58
  v_mfma_f32_32x32x16_bf16 v[80:95], v[20:23], v[236:239], v[80:95]
  v_permlane16_swap_b32 v51, v59
  v_accvgpr_write_b32 a136, v48
  v_xor_b32 v9, 196608, v9
  ds_read_b128 v[20:23], v9 offset:0
  s_waitcnt lgkmcnt(3)
  v_mfma_f32_32x32x16_bf16 v[64:79], v[24:27], v[176:179], v[64:79]
  v_accvgpr_write_b32 a137, v49
  v_accvgpr_write_b32 a138, v50
  v_accvgpr_write_b32 a139, v51
  v_mfma_f32_32x32x16_bf16 v[80:95], v[24:27], v[240:243], v[80:95]
  v_accvgpr_write_b32 a192, v56
  v_accvgpr_write_b32 a193, v57
  v_xor_b32 v10, 196608, v10
  ds_read_b128 v[24:27], v10 offset:0
  s_waitcnt lgkmcnt(3)
  v_mfma_f32_32x32x16_bf16 v[64:79], v[28:31], v[180:183], v[64:79]
  v_accvgpr_write_b32 a194, v58
  v_accvgpr_write_b32 a195, v59
  v_mfma_f32_32x32x16_bf16 v[80:95], v[28:31], v[244:247], v[80:95]
  v_xor_b32 v11, 196608, v11
  ds_read_b128 v[28:31], v11 offset:0
  s_waitcnt lgkmcnt(3)
  v_mfma_f32_32x32x16_bf16 v[32:47], v[16:19], v[120:123], 0
  s_waitcnt vmcnt(0)
  v_cmp_ne_u64 vcc, s[88:89], v[100:101]
  v_cmp_ne_u64 s[54:55], s[88:89], v[102:103]
  s_add_u32 s48, s33, 0
  v_mfma_f32_32x32x16_bf16 v[48:63], v[16:19], v[184:187], 0
  v_xor_b32 v12, 196608, v12
  ds_read_b128 v[16:19], v12 offset:0
  s_waitcnt lgkmcnt(3)
  v_mfma_f32_32x32x16_bf16 v[32:47], v[20:23], v[124:127], v[32:47]
  s_or_b64 vcc, vcc, s[54:55]
  s_cselect_b32 s48, 0x10000000, s48
  s_add_u32 s22, s48, 0
  buffer_load_dwordx4 a[224:227], v2, s[8:11], s22 offen sc1
  v_mul_f32 v64, s52, v64
  v_mul_f32 v65, s52, v65
  v_cvt_pk_bf16_f32 v64, v64, v65
  v_mfma_f32_32x32x16_bf16 v[48:63], v[20:23], v[188:191], v[48:63]
  v_mul_f32 v66, s52, v66
  v_mul_f32 v67, s52, v67
  v_xor_b32 v13, 196608, v13
  ds_read_b128 v[20:23], v13 offset:0
  s_waitcnt lgkmcnt(3)
  v_mfma_f32_32x32x16_bf16 v[32:47], v[24:27], v[128:131], v[32:47]
  v_cvt_pk_bf16_f32 v65, v66, v67
  v_mul_f32 v68, s52, v68
  v_mul_f32 v69, s52, v69
  v_mfma_f32_32x32x16_bf16 v[48:63], v[24:27], v[192:195], v[48:63]
  v_cvt_pk_bf16_f32 v66, v68, v69
  v_mul_f32 v70, s52, v70
  v_xor_b32 v14, 196608, v14
  ds_read_b128 v[24:27], v14 offset:0
  s_waitcnt lgkmcnt(3)
  v_mfma_f32_32x32x16_bf16 v[32:47], v[28:31], v[132:135], v[32:47]
  s_add_u32 s22, s48, 1024
  buffer_load_dwordx4 a[228:231], v2, s[8:11], s22 offen sc1
  v_mul_f32 v71, s52, v71
  v_cvt_pk_bf16_f32 v67, v70, v71
  v_mul_f32 v72, s52, v72
  v_mfma_f32_32x32x16_bf16 v[48:63], v[28:31], v[196:199], v[48:63]
  v_mul_f32 v73, s52, v73
  v_cvt_pk_bf16_f32 v72, v72, v73
  v_xor_b32 v15, 196608, v15
  ds_read_b128 v[28:31], v15 offset:0
  s_waitcnt lgkmcnt(3)
  v_mfma_f32_32x32x16_bf16 v[32:47], v[16:19], v[136:139], v[32:47]
  v_mul_f32 v74, s52, v74
  v_mul_f32 v75, s52, v75
  v_cvt_pk_bf16_f32 v73, v74, v75
  v_mfma_f32_32x32x16_bf16 v[48:63], v[16:19], v[200:203], v[48:63]
  v_mul_f32 v76, s52, v76
  v_mul_f32 v77, s52, v77
  ds_read_b128 v[16:19], v8 offset:256
  s_waitcnt lgkmcnt(3)
  v_mfma_f32_32x32x16_bf16 v[32:47], v[20:23], v[140:143], v[32:47]
  s_add_u32 s22, s48, 2048
  buffer_load_dwordx4 a[232:235], v2, s[8:11], s22 offen sc1
  v_cvt_pk_bf16_f32 v74, v76, v77
  v_mul_f32 v78, s52, v78
  v_mul_f32 v79, s52, v79
  v_mfma_f32_32x32x16_bf16 v[48:63], v[20:23], v[204:207], v[48:63]
  v_cvt_pk_bf16_f32 v75, v78, v79
  v_permlane16_swap_b32 v64, v72
  ds_read_b128 v[20:23], v9 offset:256
  s_waitcnt lgkmcnt(3)
  v_mfma_f32_32x32x16_bf16 v[32:47], v[24:27], v[144:147], v[32:47]
  v_permlane16_swap_b32 v65, v73
  v_permlane16_swap_b32 v66, v74
  v_permlane16_swap_b32 v67, v75
  v_mfma_f32_32x32x16_bf16 v[48:63], v[24:27], v[208:211], v[48:63]
  v_accvgpr_write_b32 a28, v64
  v_accvgpr_write_b32 a29, v65
  ds_read_b128 v[24:27], v10 offset:256
  s_waitcnt lgkmcnt(3)
  v_mfma_f32_32x32x16_bf16 v[32:47], v[28:31], v[148:151], v[32:47]
  s_add_u32 s22, s48, 3072
  buffer_load_dwordx4 a[236:239], v2, s[8:11], s22 offen sc1
  v_accvgpr_write_b32 a30, v66
  v_accvgpr_write_b32 a31, v67
  v_accvgpr_write_b32 a84, v72
  v_mfma_f32_32x32x16_bf16 v[48:63], v[28:31], v[212:215], v[48:63]
  v_accvgpr_write_b32 a85, v73
  v_accvgpr_write_b32 a86, v74
  ds_read_b128 v[28:31], v11 offset:256
  s_waitcnt lgkmcnt(3)
  v_mfma_f32_32x32x16_bf16 v[32:47], v[16:19], v[152:155], v[32:47]
  v_accvgpr_write_b32 a87, v75
  v_mul_f32 v80, s52, v80
  v_mul_f32 v81, s52, v81
  v_mfma_f32_32x32x16_bf16 v[48:63], v[16:19], v[216:219], v[48:63]
  v_cvt_pk_bf16_f32 v80, v80, v81
  v_mul_f32 v82, s52, v82
  ds_read_b128 v[16:19], v12 offset:256
  s_waitcnt lgkmcnt(3)
  v_mfma_f32_32x32x16_bf16 v[32:47], v[20:23], v[156:159], v[32:47]
  s_add_u32 s22, s48, 4096
  buffer_load_dwordx4 a[240:243], v2, s[8:11], s22 offen sc1
  v_mul_f32 v83, s52, v83
  v_cvt_pk_bf16_f32 v81, v82, v83
  v_mul_f32 v84, s52, v84
  v_mfma_f32_32x32x16_bf16 v[48:63], v[20:23], v[220:223], v[48:63]
  v_mul_f32 v85, s52, v85
  v_cvt_pk_bf16_f32 v82, v84, v85
  ds_read_b128 v[20:23], v13 offset:256
  s_waitcnt lgkmcnt(3)
  v_mfma_f32_32x32x16_bf16 v[32:47], v[24:27], v[160:163], v[32:47]
  v_mul_f32 v86, s52, v86
  v_mul_f32 v87, s52, v87
  v_cvt_pk_bf16_f32 v83, v86, v87
  v_mfma_f32_32x32x16_bf16 v[48:63], v[24:27], v[224:227], v[48:63]
  v_mul_f32 v88, s52, v88
  v_mul_f32 v89, s52, v89
  ds_read_b128 v[24:27], v14 offset:256
  s_waitcnt lgkmcnt(3)
  v_mfma_f32_32x32x16_bf16 v[32:47], v[28:31], v[164:167], v[32:47]
  s_add_u32 s22, s48, 5120
  buffer_load_dwordx4 a[244:247], v2, s[8:11], s22 offen sc1
  v_cvt_pk_bf16_f32 v88, v88, v89
  v_mul_f32 v90, s52, v90
  v_mul_f32 v91, s52, v91
  v_mfma_f32_32x32x16_bf16 v[48:63], v[28:31], v[228:231], v[48:63]
  v_cvt_pk_bf16_f32 v89, v90, v91
  v_mul_f32 v92, s52, v92
  ds_read_b128 v[28:31], v15 offset:256
  s_waitcnt lgkmcnt(3)
  v_mfma_f32_32x32x16_bf16 v[32:47], v[16:19], v[168:171], v[32:47]
  v_mul_f32 v93, s52, v93
  v_cvt_pk_bf16_f32 v90, v92, v93
  v_mul_f32 v94, s52, v94
  v_mfma_f32_32x32x16_bf16 v[48:63], v[16:19], v[232:235], v[48:63]
  v_mul_f32 v95, s52, v95
  v_cvt_pk_bf16_f32 v91, v94, v95
  v_xor_b32 v8, 131072, v8
  ds_read_b128 v[16:19], v8 offset:0
  s_waitcnt lgkmcnt(3)
  v_mfma_f32_32x32x16_bf16 v[32:47], v[20:23], v[172:175], v[32:47]
  s_add_u32 s22, s48, 6144
  buffer_load_dwordx4 a[248:251], v2, s[8:11], s22 offen sc1
  v_permlane16_swap_b32 v80, v88
  v_permlane16_swap_b32 v81, v89
  v_permlane16_swap_b32 v82, v90
  v_mfma_f32_32x32x16_bf16 v[48:63], v[20:23], v[236:239], v[48:63]
  v_permlane16_swap_b32 v83, v91
  v_accvgpr_write_b32 a140, v80
  v_xor_b32 v9, 131072, v9
  ds_read_b128 v[20:23], v9 offset:0
  s_waitcnt lgkmcnt(3)
  v_mfma_f32_32x32x16_bf16 v[32:47], v[24:27], v[176:179], v[32:47]
  v_accvgpr_write_b32 a141, v81
  v_accvgpr_write_b32 a142, v82
  v_accvgpr_write_b32 a143, v83
  v_mfma_f32_32x32x16_bf16 v[48:63], v[24:27], v[240:243], v[48:63]
  v_accvgpr_write_b32 a196, v88
  v_accvgpr_write_b32 a197, v89
  v_xor_b32 v10, 131072, v10
  ds_read_b128 v[24:27], v10 offset:0
  s_waitcnt lgkmcnt(3)
  v_mfma_f32_32x32x16_bf16 v[32:47], v[28:31], v[180:183], v[32:47]
  s_add_u32 s22, s48, 7168
  buffer_load_dwordx4 a[252:255], v2, s[8:11], s22 offen sc1
  v_accvgpr_write_b32 a198, v90
  v_accvgpr_write_b32 a199, v91
  v_mfma_f32_32x32x16_bf16 v[48:63], v[28:31], v[244:247], v[48:63]
  s_barrier
  v_xor_b32 v11, 131072, v11
  ds_read_b128 v[28:31], v11 offset:0
  s_waitcnt lgkmcnt(3)
  v_mfma_f32_32x32x16_bf16 v[64:79], v[16:19], v[120:123], 0
  v_mfma_f32_32x32x16_bf16 v[80:95], v[16:19], v[184:187], 0
  v_xor_b32 v12, 131072, v12
  ds_read_b128 v[16:19], v12 offset:0
  s_waitcnt lgkmcnt(3)
  v_mfma_f32_32x32x16_bf16 v[64:79], v[20:23], v[124:127], v[64:79]
  s_add_u32 s22, s48, 8192
  s_add_u32 m0, s25, 81920
  s_nop 0
  buffer_load_dwordx4 v2, s[8:11], s22 offen sc1 lds
  v_mul_f32 v32, s52, v32
  v_mul_f32 v33, s52, v33
  v_cvt_pk_bf16_f32 v32, v32, v33
  v_mfma_f32_32x32x16_bf16 v[80:95], v[20:23], v[188:191], v[80:95]
  v_mul_f32 v34, s52, v34
  v_mul_f32 v35, s52, v35
  v_xor_b32 v13, 131072, v13
  ds_read_b128 v[20:23], v13 offset:0
  s_waitcnt lgkmcnt(3)
  v_mfma_f32_32x32x16_bf16 v[64:79], v[24:27], v[128:131], v[64:79]
  v_cvt_pk_bf16_f32 v33, v34, v35
  v_mul_f32 v36, s52, v36
  v_mul_f32 v37, s52, v37
  v_mfma_f32_32x32x16_bf16 v[80:95], v[24:27], v[192:195], v[80:95]
  v_cvt_pk_bf16_f32 v34, v36, v37
  v_mul_f32 v38, s52, v38
  v_xor_b32 v14, 131072, v14
  ds_read_b128 v[24:27], v14 offset:0
  s_waitcnt lgkmcnt(3)
  v_mfma_f32_32x32x16_bf16 v[64:79], v[28:31], v[132:135], v[64:79]
  s_add_u32 s22, s48, 9216
  s_add_u32 m0, s25, 82944
  s_nop 0
  buffer_load_dwordx4 v2, s[8:11], s22 offen sc1 lds
  v_mul_f32 v39, s52, v39
  v_cvt_pk_bf16_f32 v35, v38, v39
  v_mul_f32 v40, s52, v40
  v_mfma_f32_32x32x16_bf16 v[80:95], v[28:31], v[196:199], v[80:95]
  v_mul_f32 v41, s52, v41
  v_cvt_pk_bf16_f32 v40, v40, v41
  v_xor_b32 v15, 131072, v15
  ds_read_b128 v[28:31], v15 offset:0
  s_waitcnt lgkmcnt(3)
  v_mfma_f32_32x32x16_bf16 v[64:79], v[16:19], v[136:139], v[64:79]
  buffer_load_dwordx4 v[100:103], v113, s[8:11], s28 offen sc1
  v_mul_f32 v42, s52, v42
  v_mul_f32 v43, s52, v43
  v_cvt_pk_bf16_f32 v41, v42, v43
  v_mfma_f32_32x32x16_bf16 v[80:95], v[16:19], v[200:203], v[80:95]
  v_mul_f32 v44, s52, v44
  v_mul_f32 v45, s52, v45
  ds_read_b128 v[16:19], v8 offset:256
  s_waitcnt lgkmcnt(3)
  v_mfma_f32_32x32x16_bf16 v[64:79], v[20:23], v[140:143], v[64:79]
  s_add_u32 s22, s48, 10240
  s_add_u32 m0, s25, 83968
  s_nop 0
  buffer_load_dwordx4 v2, s[8:11], s22 offen sc1 lds
  v_cvt_pk_bf16_f32 v42, v44, v45
  v_mul_f32 v46, s52, v46
  v_mul_f32 v47, s52, v47
  v_mfma_f32_32x32x16_bf16 v[80:95], v[20:23], v[204:207], v[80:95]
  v_cvt_pk_bf16_f32 v43, v46, v47
  v_permlane16_swap_b32 v32, v40
  ds_read_b128 v[20:23], v9 offset:256
  s_waitcnt lgkmcnt(3)
  v_mfma_f32_32x32x16_bf16 v[64:79], v[24:27], v[144:147], v[64:79]
  v_permlane16_swap_b32 v33, v41
  v_permlane16_swap_b32 v34, v42
  v_permlane16_swap_b32 v35, v43
  v_mfma_f32_32x32x16_bf16 v[80:95], v[24:27], v[208:211], v[80:95]
  v_accvgpr_write_b32 a32, v32
  v_accvgpr_write_b32 a33, v33
  ds_read_b128 v[24:27], v10 offset:256
  s_waitcnt lgkmcnt(3)
  v_mfma_f32_32x32x16_bf16 v[64:79], v[28:31], v[148:151], v[64:79]
  s_add_u32 s22, s48, 11264
  s_add_u32 m0, s25, 84992
  s_nop 0
  buffer_load_dwordx4 v2, s[8:11], s22 offen sc1 lds
  v_accvgpr_write_b32 a34, v34
  v_accvgpr_write_b32 a35, v35
  v_accvgpr_write_b32 a88, v40
  v_mfma_f32_32x32x16_bf16 v[80:95], v[28:31], v[212:215], v[80:95]
  v_accvgpr_write_b32 a89, v41
  v_accvgpr_write_b32 a90, v42
  ds_read_b128 v[28:31], v11 offset:256
  s_waitcnt lgkmcnt(3)
  v_mfma_f32_32x32x16_bf16 v[64:79], v[16:19], v[152:155], v[64:79]
  v_accvgpr_write_b32 a91, v43
  v_mul_f32 v48, s52, v48
  v_mul_f32 v49, s52, v49
  v_mfma_f32_32x32x16_bf16 v[80:95], v[16:19], v[216:219], v[80:95]
  v_cvt_pk_bf16_f32 v48, v48, v49
  v_mul_f32 v50, s52, v50
  ds_read_b128 v[16:19], v12 offset:256
  s_waitcnt lgkmcnt(3)
  v_mfma_f32_32x32x16_bf16 v[64:79], v[20:23], v[156:159], v[64:79]
  s_add_u32 s22, s48, 12288
  s_add_u32 m0, s25, 98304
  s_nop 0
  buffer_load_dwordx4 v2, s[8:11], s22 offen sc1 lds
  v_mul_f32 v51, s52, v51
  v_cvt_pk_bf16_f32 v49, v50, v51
  v_mul_f32 v52, s52, v52
  v_mfma_f32_32x32x16_bf16 v[80:95], v[20:23], v[220:223], v[80:95]
  v_mul_f32 v53, s52, v53
  v_cvt_pk_bf16_f32 v50, v52, v53
  ds_read_b128 v[20:23], v13 offset:256
  s_waitcnt lgkmcnt(3)
  v_mfma_f32_32x32x16_bf16 v[64:79], v[24:27], v[160:163], v[64:79]
  v_mul_f32 v54, s52, v54
  v_mul_f32 v55, s52, v55
  v_cvt_pk_bf16_f32 v51, v54, v55
  v_mfma_f32_32x32x16_bf16 v[80:95], v[24:27], v[224:227], v[80:95]
  v_mul_f32 v56, s52, v56
  v_mul_f32 v57, s52, v57
  ds_read_b128 v[24:27], v14 offset:256
  s_waitcnt lgkmcnt(3)
  v_mfma_f32_32x32x16_bf16 v[64:79], v[28:31], v[164:167], v[64:79]
  s_add_u32 s22, s48, 13312
  s_add_u32 m0, s25, 99328
  s_nop 0
  buffer_load_dwordx4 v2, s[8:11], s22 offen sc1 lds
  v_cvt_pk_bf16_f32 v56, v56, v57
  v_mul_f32 v58, s52, v58
  v_mul_f32 v59, s52, v59
  v_mfma_f32_32x32x16_bf16 v[80:95], v[28:31], v[228:231], v[80:95]
  v_cvt_pk_bf16_f32 v57, v58, v59
  v_mul_f32 v60, s52, v60
  ds_read_b128 v[28:31], v15 offset:256
  s_waitcnt lgkmcnt(3)
  v_mfma_f32_32x32x16_bf16 v[64:79], v[16:19], v[168:171], v[64:79]
  v_mul_f32 v61, s52, v61
  v_cvt_pk_bf16_f32 v58, v60, v61
  v_mul_f32 v62, s52, v62
  v_mfma_f32_32x32x16_bf16 v[80:95], v[16:19], v[232:235], v[80:95]
  v_mul_f32 v63, s52, v63
  v_cvt_pk_bf16_f32 v59, v62, v63
  ds_read_b128 v[16:19], v8 offset:16384
  s_waitcnt lgkmcnt(3)
  v_mfma_f32_32x32x16_bf16 v[64:79], v[20:23], v[172:175], v[64:79]
  v_permlane16_swap_b32 v48, v56
  v_permlane16_swap_b32 v49, v57
  v_permlane16_swap_b32 v50, v58
  v_mfma_f32_32x32x16_bf16 v[80:95], v[20:23], v[236:239], v[80:95]
  v_permlane16_swap_b32 v51, v59
  v_accvgpr_write_b32 a144, v48
  ds_read_b128 v[20:23], v9 offset:16384
  s_waitcnt lgkmcnt(3)
  v_mfma_f32_32x32x16_bf16 v[64:79], v[24:27], v[176:179], v[64:79]
  v_accvgpr_write_b32 a145, v49
  v_accvgpr_write_b32 a146, v50
  v_accvgpr_write_b32 a147, v51
  v_mfma_f32_32x32x16_bf16 v[80:95], v[24:27], v[240:243], v[80:95]
  v_accvgpr_write_b32 a200, v56
  v_accvgpr_write_b32 a201, v57
  ds_read_b128 v[24:27], v10 offset:16384
  s_waitcnt lgkmcnt(3)
  v_mfma_f32_32x32x16_bf16 v[64:79], v[28:31], v[180:183], v[64:79]
  v_accvgpr_write_b32 a202, v58
  v_accvgpr_write_b32 a203, v59
  v_mfma_f32_32x32x16_bf16 v[80:95], v[28:31], v[244:247], v[80:95]
  ds_read_b128 v[28:31], v11 offset:16384
  s_waitcnt lgkmcnt(3)
  v_mfma_f32_32x32x16_bf16 v[32:47], v[16:19], v[120:123], 0
  s_waitcnt vmcnt(4)
  v_cmp_ne_u64 vcc, s[88:89], v[100:101]
  v_cmp_ne_u64 s[54:55], s[88:89], v[102:103]
  s_add_u32 s49, s33, 14336
  v_mfma_f32_32x32x16_bf16 v[48:63], v[16:19], v[184:187], 0
  ds_read_b128 v[16:19], v12 offset:16384
  s_waitcnt lgkmcnt(3)
  v_mfma_f32_32x32x16_bf16 v[32:47], v[20:23], v[124:127], v[32:47]
  s_or_b64 vcc, vcc, s[54:55]
  s_cselect_b32 s49, 0x10000000, s49
  s_add_u32 s22, s49, 0
  s_add_u32 m0, s25, 100352
  s_nop 0
  buffer_load_dwordx4 v2, s[8:11], s22 offen sc1 lds
  v_mul_f32 v64, s52, v64
  v_mul_f32 v65, s52, v65
  v_cvt_pk_bf16_f32 v64, v64, v65
  v_mfma_f32_32x32x16_bf16 v[48:63], v[20:23], v[188:191], v[48:63]
  v_mul_f32 v66, s52, v66
  v_mul_f32 v67, s52, v67
  ds_read_b128 v[20:23], v13 offset:16384
  s_waitcnt lgkmcnt(3)
  v_mfma_f32_32x32x16_bf16 v[32:47], v[24:27], v[128:131], v[32:47]
  v_cvt_pk_bf16_f32 v65, v66, v67
  v_mul_f32 v68, s52, v68
  v_mul_f32 v69, s52, v69
  v_mfma_f32_32x32x16_bf16 v[48:63], v[24:27], v[192:195], v[48:63]
  v_cvt_pk_bf16_f32 v66, v68, v69
  v_mul_f32 v70, s52, v70
  ds_read_b128 v[24:27], v14 offset:16384
  s_waitcnt lgkmcnt(3)
  v_mfma_f32_32x32x16_bf16 v[32:47], v[28:31], v[132:135], v[32:47]
  s_add_u32 s22, s49, 1024
  s_add_u32 m0, s25, 101376
  s_nop 0
  buffer_load_dwordx4 v2, s[8:11], s22 offen sc1 lds
  v_mul_f32 v71, s52, v71
  v_cvt_pk_bf16_f32 v67, v70, v71
  v_mul_f32 v72, s52, v72
  v_mfma_f32_32x32x16_bf16 v[48:63], v[28:31], v[196:199], v[48:63]
  v_mul_f32 v73, s52, v73
  v_cvt_pk_bf16_f32 v72, v72, v73
  ds_read_b128 v[28:31], v15 offset:16384
  s_waitcnt lgkmcnt(3)
  v_mfma_f32_32x32x16_bf16 v[32:47], v[16:19], v[136:139], v[32:47]
  v_mul_f32 v74, s52, v74
  v_mul_f32 v75, s52, v75
  v_cvt_pk_bf16_f32 v73, v74, v75
  v_mfma_f32_32x32x16_bf16 v[48:63], v[16:19], v[200:203], v[48:63]
  v_mul_f32 v76, s52, v76
  v_mul_f32 v77, s52, v77
  ds_read_b128 v[16:19], v8 offset:16640
  s_waitcnt lgkmcnt(3)
  v_mfma_f32_32x32x16_bf16 v[32:47], v[20:23], v[140:143], v[32:47]
  s_add_u32 s22, s49, 2048
  s_add_u32 m0, s25, 147456
  s_nop 0
  buffer_load_dwordx4 v2, s[8:11], s22 offen sc1 lds
  v_cvt_pk_bf16_f32 v74, v76, v77
  v_mul_f32 v78, s52, v78
  v_mul_f32 v79, s52, v79
  v_mfma_f32_32x32x16_bf16 v[48:63], v[20:23], v[204:207], v[48:63]
  v_cvt_pk_bf16_f32 v75, v78, v79
  v_permlane16_swap_b32 v64, v72
  ds_read_b128 v[20:23], v9 offset:16640
  s_waitcnt lgkmcnt(3)
  v_mfma_f32_32x32x16_bf16 v[32:47], v[24:27], v[144:147], v[32:47]
  v_permlane16_swap_b32 v65, v73
  v_permlane16_swap_b32 v66, v74
  v_permlane16_swap_b32 v67, v75
  v_mfma_f32_32x32x16_bf16 v[48:63], v[24:27], v[208:211], v[48:63]
  v_accvgpr_write_b32 a36, v64
  v_accvgpr_write_b32 a37, v65
  ds_read_b128 v[24:27], v10 offset:16640
  s_waitcnt lgkmcnt(3)
  v_mfma_f32_32x32x16_bf16 v[32:47], v[28:31], v[148:151], v[32:47]
  s_add_u32 s22, s49, 3072
  s_add_u32 m0, s25, 148480
  s_nop 0
  buffer_load_dwordx4 v2, s[8:11], s22 offen sc1 lds
  v_accvgpr_write_b32 a38, v66
  v_accvgpr_write_b32 a39, v67
  v_accvgpr_write_b32 a92, v72
  v_mfma_f32_32x32x16_bf16 v[48:63], v[28:31], v[212:215], v[48:63]
  v_accvgpr_write_b32 a93, v73
  v_accvgpr_write_b32 a94, v74
  ds_read_b128 v[28:31], v11 offset:16640
  s_waitcnt lgkmcnt(3)
  v_mfma_f32_32x32x16_bf16 v[32:47], v[16:19], v[152:155], v[32:47]
  v_accvgpr_write_b32 a95, v75
  v_mul_f32 v80, s52, v80
  v_mul_f32 v81, s52, v81
  v_mfma_f32_32x32x16_bf16 v[48:63], v[16:19], v[216:219], v[48:63]
  v_cvt_pk_bf16_f32 v80, v80, v81
  v_mul_f32 v82, s52, v82
  ds_read_b128 v[16:19], v12 offset:16640
  s_waitcnt lgkmcnt(3)
  v_mfma_f32_32x32x16_bf16 v[32:47], v[20:23], v[156:159], v[32:47]
  s_add_u32 s22, s49, 4096
  s_add_u32 m0, s25, 149504
  s_nop 0
  buffer_load_dwordx4 v2, s[8:11], s22 offen sc1 lds
  v_mul_f32 v83, s52, v83
  v_cvt_pk_bf16_f32 v81, v82, v83
  v_mul_f32 v84, s52, v84
  v_mfma_f32_32x32x16_bf16 v[48:63], v[20:23], v[220:223], v[48:63]
  v_mul_f32 v85, s52, v85
  v_cvt_pk_bf16_f32 v82, v84, v85
  ds_read_b128 v[20:23], v13 offset:16640
  s_waitcnt lgkmcnt(3)
  v_mfma_f32_32x32x16_bf16 v[32:47], v[24:27], v[160:163], v[32:47]
  v_mul_f32 v86, s52, v86
  v_mul_f32 v87, s52, v87
  v_cvt_pk_bf16_f32 v83, v86, v87
  v_mfma_f32_32x32x16_bf16 v[48:63], v[24:27], v[224:227], v[48:63]
  v_mul_f32 v88, s52, v88
  v_mul_f32 v89, s52, v89
  ds_read_b128 v[24:27], v14 offset:16640
  s_waitcnt lgkmcnt(3)
  v_mfma_f32_32x32x16_bf16 v[32:47], v[28:31], v[164:167], v[32:47]
  s_add_u32 s22, s49, 5120
  s_add_u32 m0, s25, 150528
  s_nop 0
  buffer_load_dwordx4 v2, s[8:11], s22 offen sc1 lds
  v_cvt_pk_bf16_f32 v88, v88, v89
  v_mul_f32 v90, s52, v90
  v_mul_f32 v91, s52, v91
  v_mfma_f32_32x32x16_bf16 v[48:63], v[28:31], v[228:231], v[48:63]
  v_cvt_pk_bf16_f32 v89, v90, v91
  v_mul_f32 v92, s52, v92
  ds_read_b128 v[28:31], v15 offset:16640
  s_waitcnt lgkmcnt(3)
  v_mfma_f32_32x32x16_bf16 v[32:47], v[16:19], v[168:171], v[32:47]
  v_mul_f32 v93, s52, v93
  v_cvt_pk_bf16_f32 v90, v92, v93
  v_mul_f32 v94, s52, v94
  v_mfma_f32_32x32x16_bf16 v[48:63], v[16:19], v[232:235], v[48:63]
  v_mul_f32 v95, s52, v95
  v_cvt_pk_bf16_f32 v91, v94, v95
  ds_read_b128 v[16:19], v8 offset:32768
  s_waitcnt lgkmcnt(3)
  v_mfma_f32_32x32x16_bf16 v[32:47], v[20:23], v[172:175], v[32:47]
  s_add_u32 s22, s49, 6144
  s_add_u32 m0, s25, 114688
  s_nop 0
  buffer_load_dwordx4 v2, s[8:11], s22 offen sc1 lds
  v_permlane16_swap_b32 v80, v88
  v_permlane16_swap_b32 v81, v89
  v_permlane16_swap_b32 v82, v90
  v_mfma_f32_32x32x16_bf16 v[48:63], v[20:23], v[236:239], v[48:63]
  v_permlane16_swap_b32 v83, v91
  v_accvgpr_write_b32 a148, v80
  ds_read_b128 v[20:23], v9 offset:32768
  s_waitcnt lgkmcnt(3)
  v_mfma_f32_32x32x16_bf16 v[32:47], v[24:27], v[176:179], v[32:47]
  v_accvgpr_write_b32 a149, v81
  v_accvgpr_write_b32 a150, v82
  v_accvgpr_write_b32 a151, v83
  v_mfma_f32_32x32x16_bf16 v[48:63], v[24:27], v[240:243], v[48:63]
  v_accvgpr_write_b32 a204, v88
  v_accvgpr_write_b32 a205, v89
  ds_read_b128 v[24:27], v10 offset:32768
  s_waitcnt lgkmcnt(3)
  v_mfma_f32_32x32x16_bf16 v[32:47], v[28:31], v[180:183], v[32:47]
  s_add_u32 s22, s49, 7168
  s_add_u32 m0, s25, 115712
  s_nop 0
  buffer_load_dwordx4 v2, s[8:11], s22 offen sc1 lds
  v_accvgpr_write_b32 a206, v90
  v_accvgpr_write_b32 a207, v91
  v_mfma_f32_32x32x16_bf16 v[48:63], v[28:31], v[244:247], v[48:63]
  s_barrier
  ds_read_b128 v[28:31], v11 offset:32768
  s_waitcnt lgkmcnt(3)
  v_mfma_f32_32x32x16_bf16 v[64:79], v[16:19], v[120:123], 0
  v_mfma_f32_32x32x16_bf16 v[80:95], v[16:19], v[184:187], 0
  ds_read_b128 v[16:19], v12 offset:32768
  s_waitcnt lgkmcnt(3)
  v_mfma_f32_32x32x16_bf16 v[64:79], v[20:23], v[124:127], v[64:79]
  s_add_u32 s22, s49, 8192
  s_add_u32 m0, s25, 116736
  s_nop 0
  buffer_load_dwordx4 v2, s[8:11], s22 offen sc1 lds
  v_mul_f32 v32, s52, v32
  v_mul_f32 v33, s52, v33
  v_cvt_pk_bf16_f32 v32, v32, v33
  v_mfma_f32_32x32x16_bf16 v[80:95], v[20:23], v[188:191], v[80:95]
  v_mul_f32 v34, s52, v34
  v_mul_f32 v35, s52, v35
  ds_read_b128 v[20:23], v13 offset:32768
  s_waitcnt lgkmcnt(3)
  v_mfma_f32_32x32x16_bf16 v[64:79], v[24:27], v[128:131], v[64:79]
  v_cvt_pk_bf16_f32 v33, v34, v35
  v_mul_f32 v36, s52, v36
  v_mul_f32 v37, s52, v37
  v_mfma_f32_32x32x16_bf16 v[80:95], v[24:27], v[192:195], v[80:95]
  v_cvt_pk_bf16_f32 v34, v36, v37
  v_mul_f32 v38, s52, v38
  ds_read_b128 v[24:27], v14 offset:32768
  s_waitcnt lgkmcnt(3)
  v_mfma_f32_32x32x16_bf16 v[64:79], v[28:31], v[132:135], v[64:79]
  s_add_u32 s22, s49, 9216
  s_add_u32 m0, s25, 117760
  s_nop 0
  buffer_load_dwordx4 v2, s[8:11], s22 offen sc1 lds
  v_mul_f32 v39, s52, v39
  v_cvt_pk_bf16_f32 v35, v38, v39
  v_mul_f32 v40, s52, v40
  v_mfma_f32_32x32x16_bf16 v[80:95], v[28:31], v[196:199], v[80:95]
  v_mul_f32 v41, s52, v41
  v_cvt_pk_bf16_f32 v40, v40, v41
  ds_read_b128 v[28:31], v15 offset:32768
  s_waitcnt lgkmcnt(3)
  v_mfma_f32_32x32x16_bf16 v[64:79], v[16:19], v[136:139], v[64:79]
  buffer_load_dwordx4 v[100:103], v113, s[8:11], s28 offen sc1
  v_mul_f32 v42, s52, v42
  v_mul_f32 v43, s52, v43
  v_cvt_pk_bf16_f32 v41, v42, v43
  v_mfma_f32_32x32x16_bf16 v[80:95], v[16:19], v[200:203], v[80:95]
  v_mul_f32 v44, s52, v44
  v_mul_f32 v45, s52, v45
  ds_read_b128 v[16:19], v8 offset:33024
  s_waitcnt lgkmcnt(3)
  v_mfma_f32_32x32x16_bf16 v[64:79], v[20:23], v[140:143], v[64:79]
  s_add_u32 s22, s49, 10240
  s_add_u32 m0, s25, 131072
  s_nop 0
  buffer_load_dwordx4 v2, s[8:11], s22 offen sc1 lds
  v_cvt_pk_bf16_f32 v42, v44, v45
  v_mul_f32 v46, s52, v46
  v_mul_f32 v47, s52, v47
  v_mfma_f32_32x32x16_bf16 v[80:95], v[20:23], v[204:207], v[80:95]
  v_cvt_pk_bf16_f32 v43, v46, v47
  v_permlane16_swap_b32 v32, v40
  ds_read_b128 v[20:23], v9 offset:33024
  s_waitcnt lgkmcnt(3)
  v_mfma_f32_32x32x16_bf16 v[64:79], v[24:27], v[144:147], v[64:79]
  v_permlane16_swap_b32 v33, v41
  v_permlane16_swap_b32 v34, v42
  v_permlane16_swap_b32 v35, v43
  v_mfma_f32_32x32x16_bf16 v[80:95], v[24:27], v[208:211], v[80:95]
  v_accvgpr_write_b32 a40, v32
  v_accvgpr_write_b32 a41, v33
  ds_read_b128 v[24:27], v10 offset:33024
  s_waitcnt lgkmcnt(3)
  v_mfma_f32_32x32x16_bf16 v[64:79], v[28:31], v[148:151], v[64:79]
  s_add_u32 s22, s49, 11264
  s_add_u32 m0, s25, 132096
  s_nop 0
  buffer_load_dwordx4 v2, s[8:11], s22 offen sc1 lds
  v_accvgpr_write_b32 a42, v34
  v_accvgpr_write_b32 a43, v35
  v_accvgpr_write_b32 a96, v40
  v_mfma_f32_32x32x16_bf16 v[80:95], v[28:31], v[212:215], v[80:95]
  v_accvgpr_write_b32 a97, v41
  v_accvgpr_write_b32 a98, v42
  ds_read_b128 v[28:31], v11 offset:33024
  s_waitcnt lgkmcnt(3)
  v_mfma_f32_32x32x16_bf16 v[64:79], v[16:19], v[152:155], v[64:79]
  v_accvgpr_write_b32 a99, v43
  v_mul_f32 v48, s52, v48
  v_mul_f32 v49, s52, v49
  v_mfma_f32_32x32x16_bf16 v[80:95], v[16:19], v[216:219], v[80:95]
  v_cvt_pk_bf16_f32 v48, v48, v49
  v_mul_f32 v50, s52, v50
  ds_read_b128 v[16:19], v12 offset:33024
  s_waitcnt lgkmcnt(3)
  v_mfma_f32_32x32x16_bf16 v[64:79], v[20:23], v[156:159], v[64:79]
  s_add_u32 s22, s49, 12288
  s_add_u32 m0, s25, 133120
  s_nop 0
  buffer_load_dwordx4 v2, s[8:11], s22 offen sc1 lds
  v_mul_f32 v51, s52, v51
  v_cvt_pk_bf16_f32 v49, v50, v51
  v_mul_f32 v52, s52, v52
  v_mfma_f32_32x32x16_bf16 v[80:95], v[20:23], v[220:223], v[80:95]
  v_mul_f32 v53, s52, v53
  v_cvt_pk_bf16_f32 v50, v52, v53
  ds_read_b128 v[20:23], v13 offset:33024
  s_waitcnt lgkmcnt(3)
  v_mfma_f32_32x32x16_bf16 v[64:79], v[24:27], v[160:163], v[64:79]
  v_mul_f32 v54, s52, v54
  v_mul_f32 v55, s52, v55
  v_cvt_pk_bf16_f32 v51, v54, v55
  v_mfma_f32_32x32x16_bf16 v[80:95], v[24:27], v[224:227], v[80:95]
  v_mul_f32 v56, s52, v56
  v_mul_f32 v57, s52, v57
  ds_read_b128 v[24:27], v14 offset:33024
  s_waitcnt lgkmcnt(3)
  v_mfma_f32_32x32x16_bf16 v[64:79], v[28:31], v[164:167], v[64:79]
  s_add_u32 s22, s49, 13312
  s_add_u32 m0, s25, 134144
  s_nop 0
  buffer_load_dwordx4 v2, s[8:11], s22 offen sc1 lds
  v_cvt_pk_bf16_f32 v56, v56, v57
  v_mul_f32 v58, s52, v58
  v_mul_f32 v59, s52, v59
  v_mfma_f32_32x32x16_bf16 v[80:95], v[28:31], v[228:231], v[80:95]
  v_cvt_pk_bf16_f32 v57, v58, v59
  v_mul_f32 v60, s52, v60
  ds_read_b128 v[28:31], v15 offset:33024
  s_waitcnt lgkmcnt(3)
  v_mfma_f32_32x32x16_bf16 v[64:79], v[16:19], v[168:171], v[64:79]
  v_mul_f32 v61, s52, v61
  v_cvt_pk_bf16_f32 v58, v60, v61
  v_mul_f32 v62, s52, v62
  v_mfma_f32_32x32x16_bf16 v[80:95], v[16:19], v[232:235], v[80:95]
  v_mul_f32 v63, s52, v63
  v_cvt_pk_bf16_f32 v59, v62, v63
  ds_read_b128 v[16:19], v8 offset:49152
  s_waitcnt lgkmcnt(3)
  v_mfma_f32_32x32x16_bf16 v[64:79], v[20:23], v[172:175], v[64:79]
  v_permlane16_swap_b32 v48, v56
  v_permlane16_swap_b32 v49, v57
  v_permlane16_swap_b32 v50, v58
  v_mfma_f32_32x32x16_bf16 v[80:95], v[20:23], v[236:239], v[80:95]
  v_permlane16_swap_b32 v51, v59
  v_accvgpr_write_b32 a152, v48
  ds_read_b128 v[20:23], v9 offset:49152
  s_waitcnt lgkmcnt(3)
  v_mfma_f32_32x32x16_bf16 v[64:79], v[24:27], v[176:179], v[64:79]
  v_accvgpr_write_b32 a153, v49
  v_accvgpr_write_b32 a154, v50
  v_accvgpr_write_b32 a155, v51
  v_mfma_f32_32x32x16_bf16 v[80:95], v[24:27], v[240:243], v[80:95]
  v_accvgpr_write_b32 a208, v56
  v_accvgpr_write_b32 a209, v57
  ds_read_b128 v[24:27], v10 offset:49152
  s_waitcnt lgkmcnt(3)
  v_mfma_f32_32x32x16_bf16 v[64:79], v[28:31], v[180:183], v[64:79]
  v_accvgpr_write_b32 a210, v58
  v_accvgpr_write_b32 a211, v59
  v_mfma_f32_32x32x16_bf16 v[80:95], v[28:31], v[244:247], v[80:95]
  ds_read_b128 v[28:31], v11 offset:49152
  s_waitcnt lgkmcnt(3)
  v_mfma_f32_32x32x16_bf16 v[32:47], v[16:19], v[120:123], 0
  s_waitcnt vmcnt(4)
  v_cmp_ne_u64 vcc, s[88:89], v[100:101]
  v_cmp_ne_u64 s[54:55], s[88:89], v[102:103]
  s_add_u32 s50, s32, 0
  v_mfma_f32_32x32x16_bf16 v[48:63], v[16:19], v[184:187], 0
  ds_read_b128 v[16:19], v12 offset:49152
  s_waitcnt lgkmcnt(3)
  v_mfma_f32_32x32x16_bf16 v[32:47], v[20:23], v[124:127], v[32:47]
  s_or_b64 vcc, vcc, s[54:55]
  s_cselect_b32 s50, 0x10000000, s50
  s_add_u32 s22, s50, 12288
  buffer_load_dwordx4 v[248:251], v2, s[8:11], s22 offen sc1
  v_mul_f32 v64, s52, v64
  v_mul_f32 v65, s52, v65
  v_cvt_pk_bf16_f32 v64, v64, v65
  v_mfma_f32_32x32x16_bf16 v[48:63], v[20:23], v[188:191], v[48:63]
  v_mul_f32 v66, s52, v66
  v_mul_f32 v67, s52, v67
  ds_read_b128 v[20:23], v13 offset:49152
  s_waitcnt lgkmcnt(3)
  v_mfma_f32_32x32x16_bf16 v[32:47], v[24:27], v[128:131], v[32:47]
  s_add_u32 s22, s50, 13312
  buffer_load_dwordx4 v[252:255], v2, s[8:11], s22 offen sc1
  v_cvt_pk_bf16_f32 v65, v66, v67
  v_mul_f32 v68, s52, v68
  v_mul_f32 v69, s52, v69
  v_mfma_f32_32x32x16_bf16 v[48:63], v[24:27], v[192:195], v[48:63]
  v_cvt_pk_bf16_f32 v66, v68, v69
  v_mul_f32 v70, s52, v70
  ds_read_b128 v[24:27], v14 offset:49152
  s_waitcnt lgkmcnt(3)
  v_mfma_f32_32x32x16_bf16 v[32:47], v[28:31], v[132:135], v[32:47]
  s_add_u32 s22, s50, 0
  s_add_u32 m0, s25, 0
  s_nop 0
  buffer_load_dwordx4 v2, s[8:11], s22 offen sc1 lds
  v_mul_f32 v71, s52, v71
  v_cvt_pk_bf16_f32 v67, v70, v71
  v_mul_f32 v72, s52, v72
  v_mfma_f32_32x32x16_bf16 v[48:63], v[28:31], v[196:199], v[48:63]
  v_mul_f32 v73, s52, v73
  v_cvt_pk_bf16_f32 v72, v72, v73
  ds_read_b128 v[28:31], v15 offset:49152
  s_waitcnt lgkmcnt(3)
  v_mfma_f32_32x32x16_bf16 v[32:47], v[16:19], v[136:139], v[32:47]
  s_add_u32 s22, s50, 1024
  s_add_u32 m0, s25, 1024
  s_nop 0
  buffer_load_dwordx4 v2, s[8:11], s22 offen sc1 lds
  v_mul_f32 v74, s52, v74
  v_mul_f32 v75, s52, v75
  v_cvt_pk_bf16_f32 v73, v74, v75
  v_mfma_f32_32x32x16_bf16 v[48:63], v[16:19], v[200:203], v[48:63]
  v_mul_f32 v76, s52, v76
  v_mul_f32 v77, s52, v77
  ds_read_b128 v[16:19], v8 offset:49408
  s_waitcnt lgkmcnt(3)
  v_mfma_f32_32x32x16_bf16 v[32:47], v[20:23], v[140:143], v[32:47]
  s_add_u32 s22, s50, 2048
  s_add_u32 m0, s25, 2048
  s_nop 0
  buffer_load_dwordx4 v2, s[8:11], s22 offen sc1 lds
  v_cvt_pk_bf16_f32 v74, v76, v77
  v_mul_f32 v78, s52, v78
  v_mul_f32 v79, s52, v79
  v_mfma_f32_32x32x16_bf16 v[48:63], v[20:23], v[204:207], v[48:63]
  v_cvt_pk_bf16_f32 v75, v78, v79
  v_permlane16_swap_b32 v64, v72
  ds_read_b128 v[20:23], v9 offset:49408
  s_waitcnt lgkmcnt(3)
  v_mfma_f32_32x32x16_bf16 v[32:47], v[24:27], v[144:147], v[32:47]
  s_add_u32 s22, s50, 3072
  s_add_u32 m0, s25, 3072
  s_nop 0
  buffer_load_dwordx4 v2, s[8:11], s22 offen sc1 lds
  v_permlane16_swap_b32 v65, v73
  v_permlane16_swap_b32 v66, v74
  v_permlane16_swap_b32 v67, v75
  v_mfma_f32_32x32x16_bf16 v[48:63], v[24:27], v[208:211], v[48:63]
  v_accvgpr_write_b32 a44, v64
  v_accvgpr_write_b32 a45, v65
  ds_read_b128 v[24:27], v10 offset:49408
  s_waitcnt lgkmcnt(3)
  v_mfma_f32_32x32x16_bf16 v[32:47], v[28:31], v[148:151], v[32:47]
  s_add_u32 s22, s50, 4096
  s_add_u32 m0, s25, 16384
  s_nop 0
  buffer_load_dwordx4 v2, s[8:11], s22 offen sc1 lds
  v_accvgpr_write_b32 a46, v66
  v_accvgpr_write_b32 a47, v67
  v_accvgpr_write_b32 a100, v72
  v_mfma_f32_32x32x16_bf16 v[48:63], v[28:31], v[212:215], v[48:63]
  v_accvgpr_write_b32 a101, v73
  v_accvgpr_write_b32 a102, v74
  ds_read_b128 v[28:31], v11 offset:49408
  s_waitcnt lgkmcnt(3)
  v_mfma_f32_32x32x16_bf16 v[32:47], v[16:19], v[152:155], v[32:47]
  s_add_u32 s22, s50, 5120
  s_add_u32 m0, s25, 17408
  s_nop 0
  buffer_load_dwordx4 v2, s[8:11], s22 offen sc1 lds
  v_accvgpr_write_b32 a103, v75
  v_mul_f32 v80, s52, v80
  v_mul_f32 v81, s52, v81
  v_mfma_f32_32x32x16_bf16 v[48:63], v[16:19], v[216:219], v[48:63]
  v_cvt_pk_bf16_f32 v80, v80, v81
  v_mul_f32 v82, s52, v82
  ds_read_b128 v[16:19], v12 offset:49408
  s_waitcnt lgkmcnt(3)
  v_mfma_f32_32x32x16_bf16 v[32:47], v[20:23], v[156:159], v[32:47]
  s_add_u32 s22, s50, 6144
  s_add_u32 m0, s25, 18432
  s_nop 0
  buffer_load_dwordx4 v2, s[8:11], s22 offen sc1 lds
  v_mul_f32 v83, s52, v83
  v_cvt_pk_bf16_f32 v81, v82, v83
  v_mul_f32 v84, s52, v84
  v_mfma_f32_32x32x16_bf16 v[48:63], v[20:23], v[220:223], v[48:63]
  v_mul_f32 v85, s52, v85
  v_cvt_pk_bf16_f32 v82, v84, v85
  ds_read_b128 v[20:23], v13 offset:49408
  s_waitcnt lgkmcnt(3)
  v_mfma_f32_32x32x16_bf16 v[32:47], v[24:27], v[160:163], v[32:47]
  s_add_u32 s22, s50, 7168
  s_add_u32 m0, s25, 19456
  s_nop 0
  buffer_load_dwordx4 v2, s[8:11], s22 offen sc1 lds
  v_mul_f32 v86, s52, v86
  v_mul_f32 v87, s52, v87
  v_cvt_pk_bf16_f32 v83, v86, v87
  v_mfma_f32_32x32x16_bf16 v[48:63], v[24:27], v[224:227], v[48:63]
  v_mul_f32 v88, s52, v88
  v_mul_f32 v89, s52, v89
  ds_read_b128 v[24:27], v14 offset:49408
  s_waitcnt lgkmcnt(3)
  v_mfma_f32_32x32x16_bf16 v[32:47], v[28:31], v[164:167], v[32:47]
  v_cvt_pk_bf16_f32 v88, v88, v89
  v_mul_f32 v90, s52, v90
  v_mul_f32 v91, s52, v91
  v_mfma_f32_32x32x16_bf16 v[48:63], v[28:31], v[228:231], v[48:63]
  v_cvt_pk_bf16_f32 v89, v90, v91
  v_mul_f32 v92, s52, v92
  ds_read_b128 v[28:31], v15 offset:49408
  s_waitcnt lgkmcnt(3)
  v_mfma_f32_32x32x16_bf16 v[32:47], v[16:19], v[168:171], v[32:47]
  v_mul_f32 v93, s52, v93
  v_cvt_pk_bf16_f32 v90, v92, v93
  v_mul_f32 v94, s52, v94
  v_mfma_f32_32x32x16_bf16 v[48:63], v[16:19], v[232:235], v[48:63]
  v_mul_f32 v95, s52, v95
  v_cvt_pk_bf16_f32 v91, v94, v95
  v_xor_b32 v8, 65536, v8
  ds_read_b128 v[16:19], v8 offset:0
  s_waitcnt lgkmcnt(3)
  v_mfma_f32_32x32x16_bf16 v[32:47], v[20:23], v[172:175], v[32:47]
  v_permlane16_swap_b32 v80, v88
  v_permlane16_swap_b32 v81, v89
  v_permlane16_swap_b32 v82, v90
  v_mfma_f32_32x32x16_bf16 v[48:63], v[20:23], v[236:239], v[48:63]
  v_permlane16_swap_b32 v83, v91
  v_accvgpr_write_b32 a156, v80
  v_xor_b32 v9, 65536, v9
  ds_read_b128 v[20:23], v9 offset:0
  s_waitcnt lgkmcnt(3)
  v_mfma_f32_32x32x16_bf16 v[32:47], v[24:27], v[176:179], v[32:47]
  v_accvgpr_write_b32 a157, v81
  v_accvgpr_write_b32 a158, v82
  v_accvgpr_write_b32 a159, v83
  v_mfma_f32_32x32x16_bf16 v[48:63], v[24:27], v[240:243], v[48:63]
  v_accvgpr_write_b32 a212, v88
  v_accvgpr_write_b32 a213, v89
  v_xor_b32 v10, 65536, v10
  ds_read_b128 v[24:27], v10 offset:0
  s_waitcnt lgkmcnt(3)
  v_mfma_f32_32x32x16_bf16 v[32:47], v[28:31], v[180:183], v[32:47]
  v_accvgpr_write_b32 a214, v90
  v_accvgpr_write_b32 a215, v91
  v_mfma_f32_32x32x16_bf16 v[48:63], v[28:31], v[244:247], v[48:63]
  s_barrier
  v_xor_b32 v11, 65536, v11
  ds_read_b128 v[28:31], v11 offset:0
  s_waitcnt lgkmcnt(3)
  v_mfma_f32_32x32x16_bf16 v[64:79], v[16:19], v[120:123], 0
  s_add_u32 s22, s50, 8192
  s_add_u32 m0, s25, 32768
  s_nop 0
  buffer_load_dwordx4 v2, s[8:11], s22 offen sc1 lds
  v_mfma_f32_32x32x16_bf16 v[80:95], v[16:19], v[184:187], 0
  v_xor_b32 v12, 65536, v12
  ds_read_b128 v[16:19], v12 offset:0
  s_waitcnt lgkmcnt(3)
  v_mfma_f32_32x32x16_bf16 v[64:79], v[20:23], v[124:127], v[64:79]
  s_add_u32 s22, s50, 9216
  s_add_u32 m0, s25, 33792
  s_nop 0
  buffer_load_dwordx4 v2, s[8:11], s22 offen sc1 lds
  v_mul_f32 v32, s52, v32
  v_mul_f32 v33, s52, v33
  v_cvt_pk_bf16_f32 v32, v32, v33
  v_mfma_f32_32x32x16_bf16 v[80:95], v[20:23], v[188:191], v[80:95]
  v_mul_f32 v34, s52, v34
  v_mul_f32 v35, s52, v35
  v_xor_b32 v13, 65536, v13
  ds_read_b128 v[20:23], v13 offset:0
  s_waitcnt lgkmcnt(3)
  v_mfma_f32_32x32x16_bf16 v[64:79], v[24:27], v[128:131], v[64:79]
  s_add_u32 s22, s50, 10240
  s_add_u32 m0, s25, 34816
  s_nop 0
  buffer_load_dwordx4 v2, s[8:11], s22 offen sc1 lds
  v_cvt_pk_bf16_f32 v33, v34, v35
  v_mul_f32 v36, s52, v36
  v_mul_f32 v37, s52, v37
  v_mfma_f32_32x32x16_bf16 v[80:95], v[24:27], v[192:195], v[80:95]
  v_cvt_pk_bf16_f32 v34, v36, v37
  v_mul_f32 v38, s52, v38
  v_xor_b32 v14, 65536, v14
  ds_read_b128 v[24:27], v14 offset:0
  s_waitcnt lgkmcnt(3)
  v_mfma_f32_32x32x16_bf16 v[64:79], v[28:31], v[132:135], v[64:79]
  s_add_u32 s22, s50, 11264
  s_add_u32 m0, s25, 35840
  s_nop 0
  buffer_load_dwordx4 v2, s[8:11], s22 offen sc1 lds
  v_mul_f32 v39, s52, v39
  v_cvt_pk_bf16_f32 v35, v38, v39
  v_mul_f32 v40, s52, v40
  v_mfma_f32_32x32x16_bf16 v[80:95], v[28:31], v[196:199], v[80:95]
  v_mul_f32 v41, s52, v41
  v_cvt_pk_bf16_f32 v40, v40, v41
  v_xor_b32 v15, 65536, v15
  ds_read_b128 v[28:31], v15 offset:0
  s_waitcnt lgkmcnt(3)
  v_mfma_f32_32x32x16_bf16 v[64:79], v[16:19], v[136:139], v[64:79]
  buffer_load_dwordx4 v[100:103], v113, s[8:11], s28 offen sc1
  buffer_load_dwordx4 v[104:107], v2, s[8:11], s29 offen sc1
  buffer_load_dwordx4 v[108:111], v112, s[8:11], s29 offen sc1
  v_mul_f32 v42, s52, v42
  v_mul_f32 v43, s52, v43
  v_cvt_pk_bf16_f32 v41, v42, v43
  v_mfma_f32_32x32x16_bf16 v[80:95], v[16:19], v[200:203], v[80:95]
  v_mul_f32 v44, s52, v44
  v_mul_f32 v45, s52, v45
  ds_read_b128 v[16:19], v8 offset:256
  s_waitcnt lgkmcnt(3)
  v_mfma_f32_32x32x16_bf16 v[64:79], v[20:23], v[140:143], v[64:79]
  v_cvt_pk_bf16_f32 v42, v44, v45
  v_mul_f32 v46, s52, v46
  v_mul_f32 v47, s52, v47
  v_mfma_f32_32x32x16_bf16 v[80:95], v[20:23], v[204:207], v[80:95]
  v_cvt_pk_bf16_f32 v43, v46, v47
  v_permlane16_swap_b32 v32, v40
  ds_read_b128 v[20:23], v9 offset:256
  s_waitcnt lgkmcnt(3)
  v_mfma_f32_32x32x16_bf16 v[64:79], v[24:27], v[144:147], v[64:79]
  v_permlane16_swap_b32 v33, v41
  v_permlane16_swap_b32 v34, v42
  v_permlane16_swap_b32 v35, v43
  v_mfma_f32_32x32x16_bf16 v[80:95], v[24:27], v[208:211], v[80:95]
  v_accvgpr_write_b32 a48, v32
  v_accvgpr_write_b32 a49, v33
  ds_read_b128 v[24:27], v10 offset:256
  s_waitcnt lgkmcnt(3)
  v_mfma_f32_32x32x16_bf16 v[64:79], v[28:31], v[148:151], v[64:79]
  v_accvgpr_write_b32 a50, v34
  v_accvgpr_write_b32 a51, v35
  v_accvgpr_write_b32 a104, v40
  v_mfma_f32_32x32x16_bf16 v[80:95], v[28:31], v[212:215], v[80:95]
  v_accvgpr_write_b32 a105, v41
  v_accvgpr_write_b32 a106, v42
  ds_read_b128 v[28:31], v11 offset:256
  s_waitcnt lgkmcnt(3)
  v_mfma_f32_32x32x16_bf16 v[64:79], v[16:19], v[152:155], v[64:79]
  v_accvgpr_write_b32 a107, v43
  v_mul_f32 v48, s52, v48
  v_mul_f32 v49, s52, v49
  v_mfma_f32_32x32x16_bf16 v[80:95], v[16:19], v[216:219], v[80:95]
  v_cvt_pk_bf16_f32 v48, v48, v49
  v_mul_f32 v50, s52, v50
  ds_read_b128 v[16:19], v12 offset:256
  s_waitcnt lgkmcnt(3)
  v_mfma_f32_32x32x16_bf16 v[64:79], v[20:23], v[156:159], v[64:79]
  v_mul_f32 v51, s52, v51
  v_cvt_pk_bf16_f32 v49, v50, v51
  v_mul_f32 v52, s52, v52
  v_mfma_f32_32x32x16_bf16 v[80:95], v[20:23], v[220:223], v[80:95]
  v_mul_f32 v53, s52, v53
  v_cvt_pk_bf16_f32 v50, v52, v53
  ds_read_b128 v[20:23], v13 offset:256
  s_waitcnt lgkmcnt(3)
  v_mfma_f32_32x32x16_bf16 v[64:79], v[24:27], v[160:163], v[64:79]
  v_mul_f32 v54, s52, v54
  v_mul_f32 v55, s52, v55
  v_cvt_pk_bf16_f32 v51, v54, v55
  v_mfma_f32_32x32x16_bf16 v[80:95], v[24:27], v[224:227], v[80:95]
  v_mul_f32 v56, s52, v56
  v_mul_f32 v57, s52, v57
  ds_read_b128 v[24:27], v14 offset:256
  s_waitcnt lgkmcnt(3)
  v_mfma_f32_32x32x16_bf16 v[64:79], v[28:31], v[164:167], v[64:79]
  v_cvt_pk_bf16_f32 v56, v56, v57
  v_mul_f32 v58, s52, v58
  v_mul_f32 v59, s52, v59
  v_mfma_f32_32x32x16_bf16 v[80:95], v[28:31], v[228:231], v[80:95]
  v_cvt_pk_bf16_f32 v57, v58, v59
  v_mul_f32 v60, s52, v60
  ds_read_b128 v[28:31], v15 offset:256
  s_waitcnt lgkmcnt(3)
  v_mfma_f32_32x32x16_bf16 v[64:79], v[16:19], v[168:171], v[64:79]
  v_mul_f32 v61, s52, v61
  v_cvt_pk_bf16_f32 v58, v60, v61
  v_mul_f32 v62, s52, v62
  v_mfma_f32_32x32x16_bf16 v[80:95], v[16:19], v[232:235], v[80:95]
  v_mul_f32 v63, s52, v63
  v_cvt_pk_bf16_f32 v59, v62, v63
  s_waitcnt lgkmcnt(2)
  v_mfma_f32_32x32x16_bf16 v[64:79], v[20:23], v[172:175], v[64:79]
  v_permlane16_swap_b32 v48, v56
  v_permlane16_swap_b32 v49, v57
  v_permlane16_swap_b32 v50, v58
  v_mfma_f32_32x32x16_bf16 v[80:95], v[20:23], v[236:239], v[80:95]
  v_permlane16_swap_b32 v51, v59
  v_accvgpr_write_b32 a160, v48
  s_waitcnt lgkmcnt(1)
  v_mfma_f32_32x32x16_bf16 v[64:79], v[24:27], v[176:179], v[64:79]
  v_accvgpr_write_b32 a161, v49
  v_accvgpr_write_b32 a162, v50
  v_accvgpr_write_b32 a163, v51
  v_mfma_f32_32x32x16_bf16 v[80:95], v[24:27], v[240:243], v[80:95]
  v_accvgpr_write_b32 a216, v56
  v_accvgpr_write_b32 a217, v57
  s_waitcnt lgkmcnt(0)
  v_mfma_f32_32x32x16_bf16 v[64:79], v[28:31], v[180:183], v[64:79]
  v_accvgpr_write_b32 a218, v58
  v_accvgpr_write_b32 a219, v59
  v_mfma_f32_32x32x16_bf16 v[80:95], v[28:31], v[244:247], v[80:95]
  s_nop 4
  v_mul_f32 v64, s52, v64
  v_mul_f32 v65, s52, v65
  v_cvt_pk_bf16_f32 v64, v64, v65
  v_mul_f32 v66, s52, v66
  v_mul_f32 v67, s52, v67
  v_cvt_pk_bf16_f32 v65, v66, v67
  v_mul_f32 v68, s52, v68
  v_mul_f32 v69, s52, v69
  v_cvt_pk_bf16_f32 v66, v68, v69
  v_mul_f32 v70, s52, v70
  v_mul_f32 v71, s52, v71
  v_cvt_pk_bf16_f32 v67, v70, v71
  v_mul_f32 v72, s52, v72
  v_mul_f32 v73, s52, v73
  v_cvt_pk_bf16_f32 v72, v72, v73
  v_mul_f32 v74, s52, v74
  v_mul_f32 v75, s52, v75
  v_cvt_pk_bf16_f32 v73, v74, v75
  v_mul_f32 v76, s52, v76
  v_mul_f32 v77, s52, v77
  v_cvt_pk_bf16_f32 v74, v76, v77
  v_mul_f32 v78, s52, v78
  v_mul_f32 v79, s52, v79
  v_cvt_pk_bf16_f32 v75, v78, v79
  v_permlane16_swap_b32 v64, v72
  v_permlane16_swap_b32 v65, v73
  v_permlane16_swap_b32 v66, v74
  v_permlane16_swap_b32 v67, v75
  v_accvgpr_write_b32 a52, v64
  v_accvgpr_write_b32 a53, v65
  v_accvgpr_write_b32 a54, v66
  v_accvgpr_write_b32 a55, v67
  v_accvgpr_write_b32 a108, v72
  v_accvgpr_write_b32 a109, v73
  v_accvgpr_write_b32 a110, v74
  v_accvgpr_write_b32 a111, v75
  v_mul_f32 v80, s52, v80
  v_mul_f32 v81, s52, v81
  v_cvt_pk_bf16_f32 v80, v80, v81
  v_mul_f32 v82, s52, v82
  v_mul_f32 v83, s52, v83
  v_cvt_pk_bf16_f32 v81, v82, v83
  v_mul_f32 v84, s52, v84
  v_mul_f32 v85, s52, v85
  v_cvt_pk_bf16_f32 v82, v84, v85
  v_mul_f32 v86, s52, v86
  v_mul_f32 v87, s52, v87
  v_cvt_pk_bf16_f32 v83, v86, v87
  v_mul_f32 v88, s52, v88
  v_mul_f32 v89, s52, v89
  v_cvt_pk_bf16_f32 v88, v88, v89
  v_mul_f32 v90, s52, v90
  v_mul_f32 v91, s52, v91
  v_cvt_pk_bf16_f32 v89, v90, v91
  v_mul_f32 v92, s52, v92
  v_mul_f32 v93, s52, v93
  v_cvt_pk_bf16_f32 v90, v92, v93
  v_mul_f32 v94, s52, v94
  v_mul_f32 v95, s52, v95
  v_cvt_pk_bf16_f32 v91, v94, v95
  v_permlane16_swap_b32 v80, v88
  v_permlane16_swap_b32 v81, v89
  v_permlane16_swap_b32 v82, v90
  v_permlane16_swap_b32 v83, v91
  v_accvgpr_write_b32 a164, v80
  v_accvgpr_write_b32 a165, v81
  v_accvgpr_write_b32 a166, v82
  v_accvgpr_write_b32 a167, v83
  v_accvgpr_write_b32 a220, v88
  v_accvgpr_write_b32 a221, v89
  v_accvgpr_write_b32 a222, v90
  v_accvgpr_write_b32 a223, v91
  s_mov_b32 s30, 0
  s_branch sc_aw_w
sc_aw:
  buffer_load_dwordx4 v[100:103], v113, s[8:11], s28 offen sc1
  buffer_load_dwordx4 v[104:107], v2, s[8:11], s29 offen sc1
  buffer_load_dwordx4 v[108:111], v112, s[8:11], s29 offen sc1
sc_aw_w:
  s_waitcnt vmcnt(0)
  v_cmp_ne_u64 vcc, s[88:89], v[100:101]
  s_cbranch_vccnz sc_aw_no
  v_cmp_ne_u64 vcc, s[88:89], v[102:103]
  s_cbranch_vccnz sc_aw_no
  v_cmp_ne_u64 vcc, s[88:89], v[104:105]
  s_cbranch_vccnz sc_aw_no
  v_cmp_ne_u64 vcc, s[88:89], v[106:107]
  s_cbranch_vccnz sc_aw_no
  v_cmp_ne_u64 vcc, s[88:89], v[108:109]
  s_cbranch_vccnz sc_aw_no
  v_cmp_ne_u64 vcc, s[88:89], v[110:111]
  s_cbranch_vccnz sc_aw_no
  s_branch sc_aw_ok
sc_aw_no:
  s_sleep 1
  s_add_u32 s30, s30, 1
  s_cmp_lt_u32 s30, 50000
  s_cbranch_scc1 sc_aw
  s_branch cA_abort
sc_aw_ok:
  v_add_u32 v4, s25, v2
  v_add_u32 v5, 0x10000, v4
  v_add_u32 v6, 0x20000, v4
  s_cmp_eq_u32 s48, 0x10000000
  s_cbranch_scc1 sc_d0
  ds_read_b128 v[120:123], v5 offset:16384
  ds_read_b128 v[124:127], v5 offset:17408
  ds_read_b128 v[128:131], v5 offset:18432
  ds_read_b128 v[132:135], v5 offset:19456
  ds_read_b128 v[136:139], v5 offset:32768
  ds_read_b128 v[140:143], v5 offset:33792
  s_waitcnt lgkmcnt(0)
  s_branch sc_e0
sc_d0:
  s_add_u32 s22, s33, 0
  buffer_load_dwordx4 a[224:227], v2, s[8:11], s22 offen offset:0 sc1
  buffer_load_dwordx4 a[228:231], v2, s[8:11], s22 offen offset:1024 sc1
  buffer_load_dwordx4 a[232:235], v2, s[8:11], s22 offen offset:2048 sc1
  buffer_load_dwordx4 a[236:239], v2, s[8:11], s22 offen offset:3072 sc1
  s_add_u32 s22, s33, 4096
  buffer_load_dwordx4 a[240:243], v2, s[8:11], s22 offen offset:0 sc1
  buffer_load_dwordx4 a[244:247], v2, s[8:11], s22 offen offset:1024 sc1
  buffer_load_dwordx4 a[248:251], v2, s[8:11], s22 offen offset:2048 sc1
  buffer_load_dwordx4 a[252:255], v2, s[8:11], s22 offen offset:3072 sc1
  s_add_u32 s22, s33, 8192
  buffer_load_dwordx4 v[120:123], v2, s[8:11], s22 offen offset:0 sc1
  buffer_load_dwordx4 v[124:127], v2, s[8:11], s22 offen offset:1024 sc1
  buffer_load_dwordx4 v[128:131], v2, s[8:11], s22 offen offset:2048 sc1
  buffer_load_dwordx4 v[132:135], v2, s[8:11], s22 offen offset:3072 sc1
  s_add_u32 s22, s33, 12288
  buffer_load_dwordx4 v[136:139], v2, s[8:11], s22 offen offset:0 sc1
  buffer_load_dwordx4 v[140:143], v2, s[8:11], s22 offen offset:1024 sc1
sc_e0:
  s_cmp_eq_u32 s49, 0x10000000
  s_cbranch_scc1 sc_d1
  ds_read_b128 v[144:147], v5 offset:34816
  ds_read_b128 v[148:151], v5 offset:35840
  ds_read_b128 v[152:155], v6 offset:16384
  ds_read_b128 v[156:159], v6 offset:17408
  ds_read_b128 v[160:163], v6 offset:18432
  ds_read_b128 v[164:167], v6 offset:19456
  ds_read_b128 v[168:171], v5 offset:49152
  ds_read_b128 v[172:175], v5 offset:50176
  ds_read_b128 v[176:179], v5 offset:51200
  ds_read_b128 v[180:183], v5 offset:52224
  ds_read_b128 v[184:187], v6 offset:0
  ds_read_b128 v[188:191], v6 offset:1024
  ds_read_b128 v[192:195], v6 offset:2048
  ds_read_b128 v[196:199], v6 offset:3072
  s_waitcnt lgkmcnt(0)
  s_branch sc_e1
sc_d1:
  s_add_u32 s22, s33, 12288
  buffer_load_dwordx4 v[144:147], v2, s[8:11], s22 offen offset:2048 sc1
  buffer_load_dwordx4 v[148:151], v2, s[8:11], s22 offen offset:3072 sc1
  s_add_u32 s22, s33, 16384
  buffer_load_dwordx4 v[152:155], v2, s[8:11], s22 offen offset:0 sc1
  buffer_load_dwordx4 v[156:159], v2, s[8:11], s22 offen offset:1024 sc1
  buffer_load_dwordx4 v[160:163], v2, s[8:11], s22 offen offset:2048 sc1
  buffer_load_dwordx4 v[164:167], v2, s[8:11], s22 offen offset:3072 sc1
  s_add_u32 s22, s33, 20480
  buffer_load_dwordx4 v[168:171], v2, s[8:11], s22 offen offset:0 sc1
  buffer_load_dwordx4 v[172:175], v2, s[8:11], s22 offen offset:1024 sc1
  buffer_load_dwordx4 v[176:179], v2, s[8:11], s22 offen offset:2048 sc1
  buffer_load_dwordx4 v[180:183], v2, s[8:11], s22 offen offset:3072 sc1
  s_add_u32 s22, s33, 24576
  buffer_load_dwordx4 v[184:187], v2, s[8:11], s22 offen offset:0 sc1
  buffer_load_dwordx4 v[188:191], v2, s[8:11], s22 offen offset:1024 sc1
  buffer_load_dwordx4 v[192:195], v2, s[8:11], s22 offen offset:2048 sc1
  buffer_load_dwordx4 v[196:199], v2, s[8:11], s22 offen offset:3072 sc1
sc_e1:
  s_cmp_eq_u32 s50, 0x10000000
  s_cbranch_scc1 sc_d2
  ds_read_b128 v[200:203], v4 offset:0
  ds_read_b128 v[204:207], v4 offset:1024
  ds_read_b128 v[208:211], v4 offset:2048
  ds_read_b128 v[212:215], v4 offset:3072
  ds_read_b128 v[216:219], v4 offset:16384
  ds_read_b128 v[220:223], v4 offset:17408
  ds_read_b128 v[224:227], v4 offset:18432
  ds_read_b128 v[228:231], v4 offset:19456
  ds_read_b128 v[232:235], v4 offset:32768
  ds_read_b128 v[236:239], v4 offset:33792
  ds_read_b128 v[240:243], v4 offset:34816
  ds_read_b128 v[244:247], v4 offset:35840
  s_waitcnt lgkmcnt(0)
  s_branch sc_e2
sc_d2:
  s_add_u32 s22, s32, 0
  buffer_load_dwordx4 v[200:203], v2, s[8:11], s22 offen offset:0 sc1
  buffer_load_dwordx4 v[204:207], v2, s[8:11], s22 offen offset:1024 sc1
  buffer_load_dwordx4 v[208:211], v2, s[8:11], s22 offen offset:2048 sc1
  buffer_load_dwordx4 v[212:215], v2, s[8:11], s22 offen offset:3072 sc1
  s_add_u32 s22, s32, 4096
  buffer_load_dwordx4 v[216:219], v2, s[8:11], s22 offen offset:0 sc1
  buffer_load_dwordx4 v[220:223], v2, s[8:11], s22 offen offset:1024 sc1
  buffer_load_dwordx4 v[224:227], v2, s[8:11], s22 offen offset:2048 sc1
  buffer_load_dwordx4 v[228:231], v2, s[8:11], s22 offen offset:3072 sc1
  s_add_u32 s22, s32, 8192
  buffer_load_dwordx4 v[232:235], v2, s[8:11], s22 offen offset:0 sc1
  buffer_load_dwordx4 v[236:239], v2, s[8:11], s22 offen offset:1024 sc1
  buffer_load_dwordx4 v[240:243], v2, s[8:11], s22 offen offset:2048 sc1
  buffer_load_dwordx4 v[244:247], v2, s[8:11], s22 offen offset:3072 sc1
  s_add_u32 s22, s32, 12288
  buffer_load_dwordx4 v[248:251], v2, s[8:11], s22 offen offset:0 sc1
  buffer_load_dwordx4 v[252:255], v2, s[8:11], s22 offen offset:1024 sc1
sc_e2:
  s_barrier
  s_branch m_role
m_val:
  s_cmp_lg_u32 s16, 0
  s_cbranch_scc1 w0_6
  v_mov_b32 v233, 128
  v_mov_b32 v234, s88
  v_mov_b32 v235, s89
  v_mov_b32 v236, 0
  v_mov_b32 v237, 0
  s_mov_b64 exec, 1
  buffer_atomic_cmpswap_x2 v[234:237], v233, s[12:15], 0 offen sc0
  s_mov_b64 exec, -1
w0_6:
  s_cmp_lg_u32 s66, 0
  s_cbranch_scc1 va_ci
  s_cmp_lg_u32 s16, 0
  s_cbranch_scc1 w0_7
  s_lshr_b32 s70, s3, 5
  s_and_b32 s71, s70, 4
  s_mul_i32 s71, s71, 12
  s_lshl_b32 s70, s70, 2
  s_add_u32 s70, s70, s71
  s_lshl_b32 s71, 1, s3
  v_mov_b32 v242, s71
  v_mov_b32 v243, 32
  s_mov_b64 exec, 1
  buffer_atomic_or v242, v243, s[12:15], s70 offen sc0
  buffer_load_dwordx2 v[244:245], v243, s[12:15], 0 offen offset:96 sc1
  s_mov_b64 exec, -1
w0_7:
va_ci:
  s_mov_b32 s56, s40
  s_and_b32 s57, s41, 0xffff
  s_mov_b32 s58, 3670016
  s_mov_b32 s59, 0x20000
  v_lshrrev_b32 v24, 5, v1
  v_and_b32 v25, 31, v1
  v_lshlrev_b32 v25, 4, v25
  v_lshl_add_u32 v24, v24, 13, v25
  s_mov_b32 s60, s42
  s_and_b32 s61, s43, 0xffff
  s_mov_b32 s62, 3670016
  s_mov_b32 s63, 0x20000
  s_lshl_b32 s22, s17, 9
  s_lshl_b32 s23, s16, 19
  s_add_u32 s23, s22, s23
  s_add_u32 s21, s23, 262144
  buffer_load_dwordx4 v[28:31], v24, s[60:63], s21 offen
  s_add_u32 s21, s23, 278528
  buffer_load_dwordx4 v[28:31], v24, s[60:63], s21 offen
  s_add_u32 s21, s23, 294912
  buffer_load_dwordx4 v[28:31], v24, s[60:63], s21 offen
  s_add_u32 s21, s23, 311296
  buffer_load_dwordx4 v[28:31], v24, s[60:63], s21 offen
  s_add_u32 s21, s23, 327680
  buffer_load_dwordx4 v[28:31], v24, s[60:63], s21 offen
  s_add_u32 s21, s23, 344064
  buffer_load_dwordx4 v[28:31], v24, s[60:63], s21 offen
  s_add_u32 s21, s23, 360448
  buffer_load_dwordx4 v[28:31], v24, s[60:63], s21 offen
  s_add_u32 s21, s23, 376832
  buffer_load_dwordx4 v[28:31], v24, s[60:63], s21 offen
  s_add_u32 s21, s23, 393216
  buffer_load_dwordx4 v[28:31], v24, s[60:63], s21 offen
  s_add_u32 s21, s23, 409600
  buffer_load_dwordx4 v[28:31], v24, s[60:63], s21 offen
  s_add_u32 s21, s23, 425984
  buffer_load_dwordx4 v[28:31], v24, s[60:63], s21 offen
  s_add_u32 s21, s23, 442368
  buffer_load_dwordx4 v[28:31], v24, s[60:63], s21 offen
  s_add_u32 s21, s23, 458752
  buffer_load_dwordx4 v[28:31], v24, s[60:63], s21 offen
  s_add_u32 s21, s23, 475136
  buffer_load_dwordx4 v[28:31], v24, s[60:63], s21 offen
  s_add_u32 s21, s23, 491520
  buffer_load_dwordx4 v[28:31], v24, s[60:63], s21 offen
  s_add_u32 s21, s23, 507904
  buffer_load_dwordx4 v[28:31], v24, s[60:63], s21 offen
  s_lshl_b32 s23, s16, 14
  s_add_u32 s22, s22, s23
  s_mov_b32 s30, 0
va_pf:
  buffer_load_dwordx4 v[28:31], v24, s[56:59], s22 offen
  s_waitcnt vmcnt(40)
  s_add_u32 s22, s22, 65536
  s_add_u32 s30, s30, 1
  s_cmp_lt_u32 s30, 56
  s_cbranch_scc1 va_pf
  s_cmp_lg_u32 s66, 0
  s_cbranch_scc1 va_cf
  s_cmp_lg_u32 s16, 0
  s_cbranch_scc1 w0_8
  s_waitcnt vmcnt(40)
  v_readfirstlane_b32 s70, v244
  s_cmp_lg_u32 s70, 0
  s_cbranch_scc1 va_nz
  v_mov_b32 v243, 128
  v_mov_b32 v244, s88
  v_mov_b32 v245, s89
  v_mov_b32 v246, 0
  v_mov_b32 v247, 0
  s_mov_b64 exec, 1
  buffer_atomic_cmpswap_x2 v[244:247], v243, s[12:15], 0 offen sc0
  s_mov_b64 exec, -1
  s_waitcnt vmcnt(0)
  v_readfirstlane_b32 s70, v244
  s_cmp_lg_u32 s70, 0
  s_cbranch_scc1 va_nz
  v_mov_b32 v244, s88
  v_mov_b32 v245, s89
va_nz:
w0_8:
  v_mov_b32 v243, 160000
  s_add_u32 s101, s101, 1
  s_barrier
  s_mov_b64 exec, 1
  s_cmp_lg_u32 s16, 0
  s_cbranch_scc1 w0_9
  ds_write_b32 v243, v242 offset:0
  ds_write_b32 v243, v244 offset:4
  ds_write_b32 v243, v245 offset:8
  s_waitcnt lgkmcnt(0)
  v_mov_b32 v242, s101
  ds_write_b32 v243, v242 offset:16
  s_waitcnt lgkmcnt(0)
w0_9:
  s_mov_b64 exec, -1
  s_barrier
  ds_read_b32 v242, v243 offset:0
  ds_read_b32 v244, v243 offset:4
  ds_read_b32 v245, v243 offset:8
  ds_read_b32 v243, v243 offset:16
  s_waitcnt lgkmcnt(0)
  v_readfirstlane_b32 s70, v242
  v_readfirstlane_b32 s88, v244
  v_readfirstlane_b32 s89, v245
  v_cmp_ne_u32 vcc, s101, v243
  s_cbranch_vccnz ch_end
  s_mov_b32 s66, 1
  s_bitcmp1_b32 s70, s3
  s_cbranch_scc1 m_reclaim
va_cf:
  s_cmp_lg_u32 s16, 0
  s_cbranch_scc1 w0_10
  s_cmp_eq_u32 s67, 0
  s_cselect_b32 s20, 1, 0x10001
  v_mov_b32 v242, s20
  v_mov_b32 v243, 0
  s_mov_b64 exec, 1
  buffer_atomic_add v242, v243, s[12:15], 0 offen
  s_mov_b64 exec, -1
w0_10:
m_role:
  s_mov_b32 s17, s3
  v_and_b32 v1, 63, v0
  v_lshlrev_b32 v2, 4, v1
  v_lshrrev_b32 v116, 4, v1
  v_and_b32 v117, 15, v1
  v_mov_b32 v3, 0x4444
  v_mov_b32 v118, 0xeeee
  v_cmp_lt_u32 vcc, 7, v117
  s_nop 1
  v_cndmask_b32 v3, v3, v118, vcc
  s_mov_b32 s19, 0
  s_mov_b32 s20, 88653824
  s_lshr_b32 s22, s17, 4
  s_lshl_b32 s22, s22, 2
  s_add_u32 s22, s22, s16
  s_and_b32 s17, s17, 15
  s_cmp_eq_u32 s22, 0
  s_cbranch_scc1 ch_init0
  s_cmp_eq_u32 s22, 1
  s_cbranch_scc1 ch_init1
  s_cmp_eq_u32 s22, 2
  s_cbranch_scc1 ch_init2
  s_cmp_eq_u32 s22, 3
  s_cbranch_scc1 ch_init3
  s_cmp_eq_u32 s22, 4
  s_cbranch_scc1 ch_init4
  s_cmp_eq_u32 s22, 5
  s_cbranch_scc1 ch_init5
  s_cmp_eq_u32 s22, 6
  s_cbranch_scc1 ch_init6
  s_cmp_eq_u32 s22, 7
  s_cbranch_scc1 ch_init7
  s_branch ch_end
ch_init0:
  s_getpc_b64 s[98:99]
cpf_11:
  s_add_u32 s98, s98, cA_sc0_loop-cpf_11
  s_addc_u32 s99, s99, 0
  v_lshlrev_b32 v38, 2, v2
  global_load_dword v39, v38, s[98:99]
  s_mul_i32 s31, s17, 401408
  s_add_u32 s31, s31, 0
  s_mov_b32 s24, 71565312
  s_mov_b32 s25, 0
  s_add_u32 m0, s25, 0
  s_nop 0
  buffer_load_dwordx4 v2, s[8:11], s24 offen offset:0 sc1 lds
  buffer_load_dwordx4 v2, s[8:11], s24 offen offset:1024 sc1 lds
  buffer_load_dwordx4 v2, s[8:11], s24 offen offset:2048 sc1 lds
  buffer_load_dwordx4 v2, s[8:11], s24 offen offset:3072 sc1 lds
  s_add_u32 m0, s25, 4096
  s_add_u32 s22, s24, 4096
  buffer_load_dwordx4 v2, s[8:11], s22 offen offset:0 sc1 lds
  buffer_load_dwordx4 v2, s[8:11], s22 offen offset:1024 sc1 lds
  buffer_load_dwordx4 v2, s[8:11], s22 offen offset:2048 sc1 lds
  v_lshrrev_b32 v64, 1, v117
  v_and_b32 v65, 1, v116
  v_lshlrev_b32 v65, 2, v65
  v_sub_u32 v64, v64, v65
  v_and_b32 v65, 1, v117
  v_lshl_add_u32 v66, v65, 2, v64
  v_cmp_gt_u32 vcc, 4, v64
  v_mov_b32 v67, 99
  s_nop 0
  v_cndmask_b32 v66, v67, v66, vcc
  v_mov_b32 v68, 0x3f80
  v_mov_b32 v69, 0x3f800000
  v_mov_b32 v4, 0
  v_cmp_eq_u32 vcc, 0, v66
  s_nop 1
  v_cndmask_b32 v4, v4, v68, vcc
  v_cmp_eq_u32 vcc, 1, v66
  s_nop 1
  v_cndmask_b32 v4, v4, v69, vcc
  v_mov_b32 v5, 0
  v_cmp_eq_u32 vcc, 2, v66
  s_nop 1
  v_cndmask_b32 v5, v5, v68, vcc
  v_cmp_eq_u32 vcc, 3, v66
  s_nop 1
  v_cndmask_b32 v5, v5, v69, vcc
  v_mov_b32 v6, 0
  v_cmp_eq_u32 vcc, 4, v66
  s_nop 1
  v_cndmask_b32 v6, v6, v68, vcc
  v_cmp_eq_u32 vcc, 5, v66
  s_nop 1
  v_cndmask_b32 v6, v6, v69, vcc
  v_mov_b32 v7, 0
  v_cmp_eq_u32 vcc, 6, v66
  s_nop 1
  v_cndmask_b32 v7, v7, v68, vcc
  v_cmp_eq_u32 vcc, 7, v66
  s_nop 1
  v_cndmask_b32 v7, v7, v69, vcc
  v_lshrrev_b32 v64, 1, v116
  v_lshrrev_b32 v65, 3, v117
  v_cmp_eq_u32 s[26:27], v64, v65
  v_and_b32 v66, 1, v116
  v_add_u32 v64, 0, v64
  v_lshrrev_b32 v67, 1, v116
  v_lshlrev_b32 v67, 8, v67
  v_lshl_add_u32 v67, v66, 9, v67
  v_lshl_add_u32 v67, v117, 4, v67
  v_add_u32 v112, 57344, v67
  v_and_b32 v68, 7, v117
  v_lshlrev_b32 v67, 8, v64
  v_lshl_add_u32 v67, v68, 5, v67
  v_lshl_add_u32 v67, v66, 4, v67
  v_add_u32 v113, 65536, v67
  v_lshrrev_b32 v64, 5, v1
  v_and_b32 v65, 31, v1
  v_lshrrev_b32 v66, 3, v65
  v_and_b32 v67, 7, v65
  v_and_b32 v68, 3, v67
  v_lshl_add_u32 v68, v66, 2, v68
  v_lshrrev_b32 v69, 2, v67
  v_lshl_add_u32 v68, v69, 4, v68
  v_lshlrev_b32 v69, 11, v64
  v_lshl_add_u32 v69, v68, 4, v69
  v_add_u32 v114, 57344, v69
  v_add_u32 v70, 0, v64
  v_lshlrev_b32 v69, 9, v66
  v_lshl_add_u32 v69, v70, 5, v69
  v_lshl_add_u32 v69, v67, 2, v69
  v_add_u32 v115, 65536, v69
  v_lshlrev_b32 v69, 4, v68
  v_lshl_add_u32 v69, v64, 9, v69
  v_add_u32 v114, 57344, v69
  v_mul_u32_u24 v69, 144, v70
  v_lshl_add_u32 v69, v67, 4, v69
  v_add_u32 v115, 65536, v69
  v_and_b32 v71, 1, v116
  v_mul_u32_u24 v69, 2048, v71
  v_lshl_add_u32 v69, v64, 8, v69
  v_lshl_add_u32 v69, v117, 4, v69
  v_add_u32 v112, 57344, v69
  v_mul_u32_u24 v69, 144, v117
  v_lshl_add_u32 v69, v71, 6, v69
  v_lshl_add_u32 v69, v64, 5, v69
  v_add_u32 v113, 65536, v69
  v_mul_u32_u24 v69, 1024, v116
  v_lshl_add_u32 v69, v117, 4, v69
  v_and_b32 v72, 8, v117
  v_xor_b32 v72, 0, v72
  v_add_u32 v69, v69, v72
  v_add_u32 v112, 57344, v69
  v_lshrrev_b32 v72, 3, v117
  v_lshl_add_u32 v72, v71, 1, v72
  v_xor_b32 v72, 0, v72
  v_lshlrev_b32 v69, 10, v116
  v_lshl_add_u32 v69, v117, 4, v69
  v_lshl_add_u32 v69, v72, 2, v69
  v_add_u32 v112, 57344, v69
  v_lshrrev_b32 v69, 1, v117
  v_and_b32 v72, 1, v117
  v_lshl_add_u32 v69, v72, 3, v69
  v_mul_u32_u24 v69, 144, v69
  v_lshl_add_u32 v69, v71, 6, v69
  v_lshl_add_u32 v69, v64, 5, v69
  v_lshl_add_u32 v72, v72, 1, v71
  v_xor_b32 v72, 0, v72
  v_lshl_add_u32 v69, v72, 2, v69
  v_add_u32 v113, 65536, v69
  v_and_b32 v71, 1, v1
  v_cmp_eq_u32 s[38:39], 0, v71
  v_cmp_gt_u32 vcc, 8, v65
  s_or_b64 s[28:29], s[38:39], vcc
  v_lshrrev_b32 v72, 1, v67
  v_lshlrev_b32 v72, 2, v72
  v_lshl_add_u32 v72, v70, 4, v72
  s_lshl_b32 s22, s17, 9
  s_add_u32 s22, s22, 9216
  v_lshl_add_u32 v73, v66, 7, v72
  v_add_u32 v73, s22, v73
  s_lshl_b32 s22, s17, 7
  s_add_u32 s22, s22, 7168
  v_add_u32 v74, s22, v72
  v_bfe_u32 v72, v65, 1, 1
  v_lshlrev_b32 v72, 7, v72
  v_lshl_add_u32 v72, v70, 4, v72
  v_bfe_u32 v73, v65, 2, 2
  v_lshl_add_u32 v72, v73, 2, v72
  v_lshrrev_b32 v73, 4, v65
  v_lshl_add_u32 v73, v73, 8, v72
  s_lshl_b32 s22, s17, 9
  s_add_u32 s22, s22, 9216
  v_add_u32 v73, s22, v73
  s_lshr_b32 s22, s17, 1
  s_lshl_b32 s22, s22, 8
  s_and_b32 s34, s17, 1
  s_lshl_b32 s34, s34, 3
  s_add_u32 s22, s22, s34
  s_add_u32 s22, s22, 7168
  v_add_u32 v74, s22, v72
  v_bfe_u32 v72, v65, 1, 1
  v_lshl_add_u32 v72, v64, 1, v72
  v_lshlrev_b32 v72, 4, v72
  v_bfe_u32 v73, v65, 2, 2
  v_lshl_add_u32 v72, v73, 2, v72
  v_lshrrev_b32 v73, 4, v65
  v_lshl_add_u32 v73, v73, 6, v72
  s_lshl_b32 s22, s17, 9
  s_add_u32 s22, s22, 9216
  v_add_u32 v73, s22, v73
  v_lshrrev_b32 v72, 1, v65
  v_lshlrev_b32 v72, 2, v72
  v_lshl_add_u32 v72, v64, 5, v72
  s_lshr_b32 s22, s17, 1
  s_lshl_b32 s22, s22, 8
  s_and_b32 s34, s17, 1
  s_lshl_b32 s34, s34, 4
  s_add_u32 s22, s22, s34
  s_add_u32 s22, s22, 7168
  v_add_u32 v74, s22, v72
  v_lshlrev_b32 v0, 2, v65
  v_and_b32 v0, 120, v0
  s_and_b32 s22, s17, 15
  s_lshl_b32 s22, s22, 7
  s_add_u32 s22, s22, 18432
  v_add_u32 v0, s22, v0
  v_cndmask_b32 v1, v74, v73, s[38:39]
  s_lshl_b32 s36, s17, 2
  s_add_u32 s36, s36, 17472
  s_mov_b32 s37, 0x3e800000
  v_mov_b32 v64, 0
  v_mov_b32 v65, 0
  v_mov_b32 v66, 0
  v_mov_b32 v67, 0
  v_mov_b32 v68, 0
  v_mov_b32 v69, 0
  v_mov_b32 v70, 0
  v_mov_b32 v71, 0
  v_mov_b32 v72, 0
  v_mov_b32 v73, 0
  v_mov_b32 v74, 0
  v_mov_b32 v75, 0
  v_mov_b32 v76, 0
  v_mov_b32 v77, 0
  v_mov_b32 v78, 0
  v_mov_b32 v79, 0
  v_mov_b32 v80, 0
  v_mov_b32 v81, 0
  v_mov_b32 v82, 0
  v_mov_b32 v83, 0
  v_mov_b32 v84, 0
  v_mov_b32 v85, 0
  v_mov_b32 v86, 0
  v_mov_b32 v87, 0
  v_mov_b32 v88, 0
  v_mov_b32 v89, 0
  v_mov_b32 v90, 0
  v_mov_b32 v91, 0
  v_mov_b32 v92, 0
  v_mov_b32 v93, 0
  v_mov_b32 v94, 0
  v_mov_b32 v95, 0
  v_mov_b32 v96, 0
  v_mov_b32 v97, 0
  v_mov_b32 v98, 0
  v_mov_b32 v99, 0
  v_mov_b32 v100, 0
  v_mov_b32 v101, 0
  v_mov_b32 v102, 0
  v_mov_b32 v103, 0
  v_mov_b32 v104, 0
  v_mov_b32 v105, 0
  v_mov_b32 v106, 0
  v_mov_b32 v107, 0
  v_mov_b32 v108, 0
  v_mov_b32 v109, 0
  v_mov_b32 v110, 0
  v_mov_b32 v111, 0
  v_and_b32 v118, 1, v116
  v_cmp_eq_u32 vcc, 0, v118
  v_mov_b32 v118, 12288
  v_mov_b32 v119, 8192
  v_cndmask_b32 v118, v118, v119, vcc
  v_lshrrev_b32 v116, 1, v116
  v_lshl_add_u32 v118, v116, 9, v118
  v_lshl_add_u32 v117, v117, 4, v118
  s_mov_b32 s57, 28672
  v_bfe_u32 v118, v2, 4, 1
  v_mul_u32_u24 v118, 0xaaaa, v118
  v_add_u32 v118, 0x4444, v118
  s_mov_b32 s56, 0x42800000
  v_mov_b32 v116, v2
  s_mul_i32 s35, s17, 1835008
  s_add_u32 s35, s35, 42262528
  v_lshl_add_u32 v119, v2, 3, s36
  v_mov_b32 v8, 0x20000000
  v_cmp_gt_u32 vcc, 64, v2
  s_nop 1
  v_cndmask_b32 v119, v8, v119, vcc
  s_mov_b32 s30, 0
  v_mov_b32 v36, 0
ch_md0:
  buffer_load_dword v37, v36, s[12:15], 0 offen sc1
  s_waitcnt vmcnt(0)
  v_readfirstlane_b32 s22, v37
  s_and_b32 s31, s22, 0xffff
  s_cmp_ge_u32 s31, 32
  s_cbranch_scc1 ch_go0
  s_sleep 2
  s_add_u32 s30, s30, 1
  s_cmp_lt_u32 s30, 50000
  s_cbranch_scc1 ch_md0
  s_branch ch_end
ch_go0:
  s_mov_b32 s31, 0
  s_lshr_b32 s22, s22, 16
  s_cmp_lg_u32 s22, 0
  s_cbranch_scc1 cB_sc0_loop
  s_branch cA_sc0_loop
ch_init1:
  s_getpc_b64 s[98:99]
cpf_12:
  s_add_u32 s98, s98, cA_sc1_loop-cpf_12
  s_addc_u32 s99, s99, 0
  v_lshlrev_b32 v38, 2, v2
  global_load_dword v39, v38, s[98:99]
  s_mul_i32 s31, s17, 401408
  s_add_u32 s31, s31, 0
  s_mov_b32 s24, 71572480
  s_mov_b32 s25, 0
  s_add_u32 m0, s25, 7168
  s_nop 0
  buffer_load_dwordx4 v2, s[8:11], s24 offen offset:0 sc1 lds
  buffer_load_dwordx4 v2, s[8:11], s24 offen offset:1024 sc1 lds
  buffer_load_dwordx4 v2, s[8:11], s24 offen offset:2048 sc1 lds
  buffer_load_dwordx4 v2, s[8:11], s24 offen offset:3072 sc1 lds
  s_add_u32 m0, s25, 11264
  s_add_u32 s22, s24, 4096
  buffer_load_dwordx4 v2, s[8:11], s22 offen offset:0 sc1 lds
  buffer_load_dwordx4 v2, s[8:11], s22 offen offset:1024 sc1 lds
  buffer_load_dwordx4 v2, s[8:11], s22 offen offset:2048 sc1 lds
  v_lshrrev_b32 v64, 1, v117
  v_and_b32 v65, 1, v116
  v_lshlrev_b32 v65, 2, v65
  v_sub_u32 v64, v64, v65
  v_and_b32 v65, 1, v117
  v_lshl_add_u32 v66, v65, 2, v64
  v_cmp_gt_u32 vcc, 4, v64
  v_mov_b32 v67, 99
  s_nop 0
  v_cndmask_b32 v66, v67, v66, vcc
  v_mov_b32 v68, 0x3f80
  v_mov_b32 v69, 0x3f800000
  v_mov_b32 v4, 0
  v_cmp_eq_u32 vcc, 0, v66
  s_nop 1
  v_cndmask_b32 v4, v4, v68, vcc
  v_cmp_eq_u32 vcc, 1, v66
  s_nop 1
  v_cndmask_b32 v4, v4, v69, vcc
  v_mov_b32 v5, 0
  v_cmp_eq_u32 vcc, 2, v66
  s_nop 1
  v_cndmask_b32 v5, v5, v68, vcc
  v_cmp_eq_u32 vcc, 3, v66
  s_nop 1
  v_cndmask_b32 v5, v5, v69, vcc
  v_mov_b32 v6, 0
  v_cmp_eq_u32 vcc, 4, v66
  s_nop 1
  v_cndmask_b32 v6, v6, v68, vcc
  v_cmp_eq_u32 vcc, 5, v66
  s_nop 1
  v_cndmask_b32 v6, v6, v69, vcc
  v_mov_b32 v7, 0
  v_cmp_eq_u32 vcc, 6, v66
  s_nop 1
  v_cndmask_b32 v7, v7, v68, vcc
  v_cmp_eq_u32 vcc, 7, v66
  s_nop 1
  v_cndmask_b32 v7, v7, v69, vcc
  v_lshrrev_b32 v64, 1, v116
  v_lshrrev_b32 v65, 3, v117
  v_cmp_eq_u32 s[26:27], v64, v65
  v_and_b32 v66, 1, v116
  v_add_u32 v64, 2, v64
  v_lshrrev_b32 v67, 1, v116
  v_lshlrev_b32 v67, 8, v67
  v_lshl_add_u32 v67, v66, 9, v67
  v_lshl_add_u32 v67, v117, 4, v67
  v_add_u32 v112, 58368, v67
  v_and_b32 v68, 7, v117
  v_lshlrev_b32 v67, 8, v64
  v_lshl_add_u32 v67, v68, 5, v67
  v_lshl_add_u32 v67, v66, 4, v67
  v_add_u32 v113, 65536, v67
  v_lshrrev_b32 v64, 5, v1
  v_and_b32 v65, 31, v1
  v_lshrrev_b32 v66, 3, v65
  v_and_b32 v67, 7, v65
  v_and_b32 v68, 3, v67
  v_lshl_add_u32 v68, v66, 2, v68
  v_lshrrev_b32 v69, 2, v67
  v_lshl_add_u32 v68, v69, 4, v68
  v_lshlrev_b32 v69, 11, v64
  v_lshl_add_u32 v69, v68, 4, v69
  v_add_u32 v114, 57352, v69
  v_add_u32 v70, 2, v64
  v_lshlrev_b32 v69, 9, v66
  v_lshl_add_u32 v69, v70, 5, v69
  v_lshl_add_u32 v69, v67, 2, v69
  v_add_u32 v115, 65536, v69
  v_lshlrev_b32 v69, 4, v68
  v_lshl_add_u32 v69, v64, 9, v69
  v_add_u32 v114, 58368, v69
  v_mul_u32_u24 v69, 144, v70
  v_lshl_add_u32 v69, v67, 4, v69
  v_add_u32 v115, 65536, v69
  v_and_b32 v71, 1, v116
  v_mul_u32_u24 v69, 2048, v71
  v_lshl_add_u32 v69, v64, 8, v69
  v_lshl_add_u32 v69, v117, 4, v69
  v_add_u32 v112, 57352, v69
  v_mul_u32_u24 v69, 144, v117
  v_lshl_add_u32 v69, v71, 6, v69
  v_lshl_add_u32 v69, v64, 5, v69
  v_add_u32 v113, 65540, v69
  v_mul_u32_u24 v69, 1024, v116
  v_lshl_add_u32 v69, v117, 4, v69
  v_and_b32 v72, 8, v117
  v_xor_b32 v72, 8, v72
  v_add_u32 v69, v69, v72
  v_add_u32 v112, 57344, v69
  v_lshrrev_b32 v72, 3, v117
  v_lshl_add_u32 v72, v71, 1, v72
  v_xor_b32 v72, 1, v72
  v_lshlrev_b32 v69, 10, v116
  v_lshl_add_u32 v69, v117, 4, v69
  v_lshl_add_u32 v69, v72, 2, v69
  v_add_u32 v112, 57344, v69
  v_lshrrev_b32 v69, 1, v117
  v_and_b32 v72, 1, v117
  v_lshl_add_u32 v69, v72, 3, v69
  v_mul_u32_u24 v69, 144, v69
  v_lshl_add_u32 v69, v71, 6, v69
  v_lshl_add_u32 v69, v64, 5, v69
  v_lshl_add_u32 v72, v72, 1, v71
  v_xor_b32 v72, 1, v72
  v_lshl_add_u32 v69, v72, 2, v69
  v_add_u32 v113, 65536, v69
  v_and_b32 v71, 1, v1
  v_cmp_eq_u32 s[38:39], 0, v71
  v_cmp_gt_u32 vcc, 8, v65
  s_or_b64 s[28:29], s[38:39], vcc
  v_lshrrev_b32 v72, 1, v67
  v_lshlrev_b32 v72, 2, v72
  v_lshl_add_u32 v72, v70, 4, v72
  s_lshl_b32 s22, s17, 9
  s_add_u32 s22, s22, 9216
  v_lshl_add_u32 v73, v66, 7, v72
  v_add_u32 v73, s22, v73
  s_lshl_b32 s22, s17, 7
  s_add_u32 s22, s22, 7168
  v_add_u32 v74, s22, v72
  v_bfe_u32 v72, v65, 1, 1
  v_lshlrev_b32 v72, 7, v72
  v_lshl_add_u32 v72, v70, 4, v72
  v_bfe_u32 v73, v65, 2, 2
  v_lshl_add_u32 v72, v73, 2, v72
  v_lshrrev_b32 v73, 4, v65
  v_lshl_add_u32 v73, v73, 8, v72
  s_lshl_b32 s22, s17, 9
  s_add_u32 s22, s22, 9216
  v_add_u32 v73, s22, v73
  s_lshr_b32 s22, s17, 1
  s_lshl_b32 s22, s22, 8
  s_and_b32 s34, s17, 1
  s_lshl_b32 s34, s34, 3
  s_add_u32 s22, s22, s34
  s_add_u32 s22, s22, 7168
  v_add_u32 v74, s22, v72
  v_bfe_u32 v72, v65, 1, 1
  v_lshl_add_u32 v72, v64, 1, v72
  v_lshlrev_b32 v72, 4, v72
  v_bfe_u32 v73, v65, 2, 2
  v_lshl_add_u32 v72, v73, 2, v72
  v_lshrrev_b32 v73, 4, v65
  v_lshl_add_u32 v73, v73, 6, v72
  s_lshl_b32 s22, s17, 9
  s_add_u32 s22, s22, 9344
  v_add_u32 v73, s22, v73
  v_lshrrev_b32 v72, 1, v65
  v_lshlrev_b32 v72, 2, v72
  v_lshl_add_u32 v72, v64, 5, v72
  s_lshr_b32 s22, s17, 1
  s_lshl_b32 s22, s22, 8
  s_and_b32 s34, s17, 1
  s_lshl_b32 s34, s34, 4
  s_add_u32 s22, s22, s34
  s_add_u32 s22, s22, 7232
  v_add_u32 v74, s22, v72
  v_lshlrev_b32 v0, 2, v65
  v_and_b32 v0, 120, v0
  s_and_b32 s22, s17, 15
  s_lshl_b32 s22, s22, 7
  s_add_u32 s22, s22, 18432
  v_add_u32 v0, s22, v0
  v_cndmask_b32 v1, v74, v73, s[38:39]
  s_lshl_b32 s36, s17, 2
  s_add_u32 s36, s36, 17472
  s_mov_b32 s37, 0x3e800000
  v_mov_b32 v64, 0
  v_mov_b32 v65, 0
  v_mov_b32 v66, 0
  v_mov_b32 v67, 0
  v_mov_b32 v68, 0
  v_mov_b32 v69, 0
  v_mov_b32 v70, 0
  v_mov_b32 v71, 0
  v_mov_b32 v72, 0
  v_mov_b32 v73, 0
  v_mov_b32 v74, 0
  v_mov_b32 v75, 0
  v_mov_b32 v76, 0
  v_mov_b32 v77, 0
  v_mov_b32 v78, 0
  v_mov_b32 v79, 0
  v_mov_b32 v80, 0
  v_mov_b32 v81, 0
  v_mov_b32 v82, 0
  v_mov_b32 v83, 0
  v_mov_b32 v84, 0
  v_mov_b32 v85, 0
  v_mov_b32 v86, 0
  v_mov_b32 v87, 0
  v_mov_b32 v88, 0
  v_mov_b32 v89, 0
  v_mov_b32 v90, 0
  v_mov_b32 v91, 0
  v_mov_b32 v92, 0
  v_mov_b32 v93, 0
  v_mov_b32 v94, 0
  v_mov_b32 v95, 0
  v_mov_b32 v96, 0
  v_mov_b32 v97, 0
  v_mov_b32 v98, 0
  v_mov_b32 v99, 0
  v_mov_b32 v100, 0
  v_mov_b32 v101, 0
  v_mov_b32 v102, 0
  v_mov_b32 v103, 0
  v_mov_b32 v104, 0
  v_mov_b32 v105, 0
  v_mov_b32 v106, 0
  v_mov_b32 v107, 0
  v_mov_b32 v108, 0
  v_mov_b32 v109, 0
  v_mov_b32 v110, 0
  v_mov_b32 v111, 0
  v_and_b32 v118, 1, v116
  v_cmp_eq_u32 vcc, 0, v118
  v_mov_b32 v118, 12288
  v_mov_b32 v119, 8448
  v_cndmask_b32 v118, v118, v119, vcc
  v_lshrrev_b32 v116, 1, v116
  v_lshl_add_u32 v118, v116, 9, v118
  v_lshl_add_u32 v117, v117, 4, v118
  s_mov_b32 s57, 28672
  v_bfe_u32 v118, v2, 4, 1
  v_mul_u32_u24 v118, 0xaaaa, v118
  v_add_u32 v118, 0x4444, v118
  s_mov_b32 s56, 0x42800000
  v_mov_b32 v116, v2
  v_lshrrev_b32 v0, 4, v2
  v_min_u32 v0, 9, v0
  s_mul_i32 s22, s17, 10
  v_add_u32 v0, s22, v0
  v_lshlrev_b32 v0, 7, v0
  v_add_u32 v0, 40960, v0
  s_mov_b32 s22, 88633344
  buffer_load_dword v119, v0, s[8:11], s22 offen sc1
  s_mov_b32 s22, 88612864
  buffer_load_dword v119, v0, s[8:11], s22 offen sc1
  s_mul_i32 s35, s17, 1835008
  s_add_u32 s35, s35, 42269696
  s_mov_b32 s30, 0
  v_mov_b32 v36, 0
ch_md1:
  buffer_load_dword v37, v36, s[12:15], 0 offen sc1
  s_waitcnt vmcnt(0)
  v_readfirstlane_b32 s22, v37
  s_and_b32 s31, s22, 0xffff
  s_cmp_ge_u32 s31, 32
  s_cbranch_scc1 ch_go1
  s_sleep 2
  s_add_u32 s30, s30, 1
  s_cmp_lt_u32 s30, 50000
  s_cbranch_scc1 ch_md1
  s_branch ch_end
ch_go1:
  s_mov_b32 s31, 0
  s_lshr_b32 s22, s22, 16
  s_cmp_lg_u32 s22, 0
  s_cbranch_scc1 cB_sc1_loop
  s_branch cA_sc1_loop
ch_init2:
  s_getpc_b64 s[98:99]
cpf_13:
  s_add_u32 s98, s98, cA_sc2_loop-cpf_13
  s_addc_u32 s99, s99, 0
  v_lshlrev_b32 v38, 2, v2
  global_load_dword v39, v38, s[98:99]
  s_mul_i32 s31, s17, 401408
  s_add_u32 s31, s31, 0
  s_mov_b32 s24, 71579648
  s_mov_b32 s25, 0
  s_add_u32 m0, s25, 14336
  s_nop 0
  buffer_load_dwordx4 v2, s[8:11], s24 offen offset:0 sc1 lds
  buffer_load_dwordx4 v2, s[8:11], s24 offen offset:1024 sc1 lds
  buffer_load_dwordx4 v2, s[8:11], s24 offen offset:2048 sc1 lds
  buffer_load_dwordx4 v2, s[8:11], s24 offen offset:3072 sc1 lds
  s_add_u32 m0, s25, 18432
  s_add_u32 s22, s24, 4096
  buffer_load_dwordx4 v2, s[8:11], s22 offen offset:0 sc1 lds
  buffer_load_dwordx4 v2, s[8:11], s22 offen offset:1024 sc1 lds
  buffer_load_dwordx4 v2, s[8:11], s22 offen offset:2048 sc1 lds
  v_lshrrev_b32 v64, 1, v117
  v_and_b32 v65, 1, v116
  v_lshlrev_b32 v65, 2, v65
  v_sub_u32 v64, v64, v65
  v_and_b32 v65, 1, v117
  v_lshl_add_u32 v66, v65, 2, v64
  v_cmp_gt_u32 vcc, 4, v64
  v_mov_b32 v67, 99
  s_nop 0
  v_cndmask_b32 v66, v67, v66, vcc
  v_mov_b32 v68, 0x3f80
  v_mov_b32 v69, 0x3f800000
  v_mov_b32 v4, 0
  v_cmp_eq_u32 vcc, 0, v66
  s_nop 1
  v_cndmask_b32 v4, v4, v68, vcc
  v_cmp_eq_u32 vcc, 1, v66
  s_nop 1
  v_cndmask_b32 v4, v4, v69, vcc
  v_mov_b32 v5, 0
  v_cmp_eq_u32 vcc, 2, v66
  s_nop 1
  v_cndmask_b32 v5, v5, v68, vcc
  v_cmp_eq_u32 vcc, 3, v66
  s_nop 1
  v_cndmask_b32 v5, v5, v69, vcc
  v_mov_b32 v6, 0
  v_cmp_eq_u32 vcc, 4, v66
  s_nop 1
  v_cndmask_b32 v6, v6, v68, vcc
  v_cmp_eq_u32 vcc, 5, v66
  s_nop 1
  v_cndmask_b32 v6, v6, v69, vcc
  v_mov_b32 v7, 0
  v_cmp_eq_u32 vcc, 6, v66
  s_nop 1
  v_cndmask_b32 v7, v7, v68, vcc
  v_cmp_eq_u32 vcc, 7, v66
  s_nop 1
  v_cndmask_b32 v7, v7, v69, vcc
  v_lshrrev_b32 v64, 1, v116
  v_lshrrev_b32 v65, 3, v117
  v_cmp_eq_u32 s[26:27], v64, v65
  v_and_b32 v66, 1, v116
  v_add_u32 v64, 4, v64
  v_lshrrev_b32 v67, 1, v116
  v_lshlrev_b32 v67, 8, v67
  v_lshl_add_u32 v67, v66, 9, v67
  v_lshl_add_u32 v67, v117, 4, v67
  v_add_u32 v112, 59392, v67
  v_and_b32 v68, 7, v117
  v_lshlrev_b32 v67, 8, v64
  v_lshl_add_u32 v67, v68, 5, v67
  v_lshl_add_u32 v67, v66, 4, v67
  v_add_u32 v113, 65536, v67
  v_lshrrev_b32 v64, 5, v1
  v_and_b32 v65, 31, v1
  v_lshrrev_b32 v66, 3, v65
  v_and_b32 v67, 7, v65
  v_and_b32 v68, 3, v67
  v_lshl_add_u32 v68, v66, 2, v68
  v_lshrrev_b32 v69, 2, v67
  v_lshl_add_u32 v68, v69, 4, v68
  v_lshlrev_b32 v69, 11, v64
  v_lshl_add_u32 v69, v68, 4, v69
  v_add_u32 v114, 57856, v69
  v_add_u32 v70, 4, v64
  v_lshlrev_b32 v69, 9, v66
  v_lshl_add_u32 v69, v70, 5, v69
  v_lshl_add_u32 v69, v67, 2, v69
  v_add_u32 v115, 65536, v69
  v_lshlrev_b32 v69, 4, v68
  v_lshl_add_u32 v69, v64, 9, v69
  v_add_u32 v114, 59392, v69
  v_mul_u32_u24 v69, 144, v70
  v_lshl_add_u32 v69, v67, 4, v69
  v_add_u32 v115, 65536, v69
  v_and_b32 v71, 1, v116
  v_mul_u32_u24 v69, 2048, v71
  v_lshl_add_u32 v69, v64, 8, v69
  v_lshl_add_u32 v69, v117, 4, v69
  v_add_u32 v112, 57856, v69
  v_mul_u32_u24 v69, 144, v117
  v_lshl_add_u32 v69, v71, 6, v69
  v_lshl_add_u32 v69, v64, 5, v69
  v_add_u32 v113, 65544, v69
  v_mul_u32_u24 v69, 1024, v116
  v_lshl_add_u32 v69, v117, 4, v69
  v_and_b32 v72, 8, v117
  v_xor_b32 v72, 0, v72
  v_add_u32 v69, v69, v72
  v_add_u32 v112, 57856, v69
  v_lshrrev_b32 v72, 3, v117
  v_lshl_add_u32 v72, v71, 1, v72
  v_xor_b32 v72, 2, v72
  v_lshlrev_b32 v69, 10, v116
  v_lshl_add_u32 v69, v117, 4, v69
  v_lshl_add_u32 v69, v72, 2, v69
  v_add_u32 v112, 57344, v69
  v_lshrrev_b32 v69, 1, v117
  v_and_b32 v72, 1, v117
  v_lshl_add_u32 v69, v72, 3, v69
  v_mul_u32_u24 v69, 144, v69
  v_lshl_add_u32 v69, v71, 6, v69
  v_lshl_add_u32 v69, v64, 5, v69
  v_lshl_add_u32 v72, v72, 1, v71
  v_xor_b32 v72, 2, v72
  v_lshl_add_u32 v69, v72, 2, v69
  v_add_u32 v113, 65536, v69
  v_and_b32 v71, 1, v1
  v_cmp_eq_u32 s[38:39], 0, v71
  v_cmp_gt_u32 vcc, 8, v65
  s_or_b64 s[28:29], s[38:39], vcc
  v_lshrrev_b32 v72, 1, v67
  v_lshlrev_b32 v72, 2, v72
  v_lshl_add_u32 v72, v70, 4, v72
  s_lshl_b32 s22, s17, 9
  s_add_u32 s22, s22, 9216
  v_lshl_add_u32 v73, v66, 7, v72
  v_add_u32 v73, s22, v73
  s_lshl_b32 s22, s17, 7
  s_add_u32 s22, s22, 7168
  v_add_u32 v74, s22, v72
  v_bfe_u32 v72, v65, 1, 1
  v_lshlrev_b32 v72, 7, v72
  v_lshl_add_u32 v72, v70, 4, v72
  v_bfe_u32 v73, v65, 2, 2
  v_lshl_add_u32 v72, v73, 2, v72
  v_lshrrev_b32 v73, 4, v65
  v_lshl_add_u32 v73, v73, 8, v72
  s_lshl_b32 s22, s17, 9
  s_add_u32 s22, s22, 9216
  v_add_u32 v73, s22, v73
  s_lshr_b32 s22, s17, 1
  s_lshl_b32 s22, s22, 8
  s_and_b32 s34, s17, 1
  s_lshl_b32 s34, s34, 3
  s_add_u32 s22, s22, s34
  s_add_u32 s22, s22, 7168
  v_add_u32 v74, s22, v72
  v_bfe_u32 v72, v65, 1, 1
  v_lshl_add_u32 v72, v64, 1, v72
  v_lshlrev_b32 v72, 4, v72
  v_bfe_u32 v73, v65, 2, 2
  v_lshl_add_u32 v72, v73, 2, v72
  v_lshrrev_b32 v73, 4, v65
  v_lshl_add_u32 v73, v73, 6, v72
  s_lshl_b32 s22, s17, 9
  s_add_u32 s22, s22, 9472
  v_add_u32 v73, s22, v73
  v_lshrrev_b32 v72, 1, v65
  v_lshlrev_b32 v72, 2, v72
  v_lshl_add_u32 v72, v64, 5, v72
  s_lshr_b32 s22, s17, 1
  s_lshl_b32 s22, s22, 8
  s_and_b32 s34, s17, 1
  s_lshl_b32 s34, s34, 4
  s_add_u32 s22, s22, s34
  s_add_u32 s22, s22, 7296
  v_add_u32 v74, s22, v72
  v_lshlrev_b32 v0, 2, v65
  v_and_b32 v0, 120, v0
  s_and_b32 s22, s17, 15
  s_lshl_b32 s22, s22, 7
  s_add_u32 s22, s22, 18432
  v_add_u32 v0, s22, v0
  v_cndmask_b32 v1, v74, v73, s[38:39]
  s_lshl_b32 s36, s17, 2
  s_add_u32 s36, s36, 17472
  s_mov_b32 s37, 0x3e800000
  v_mov_b32 v64, 0
  v_mov_b32 v65, 0
  v_mov_b32 v66, 0
  v_mov_b32 v67, 0
  v_mov_b32 v68, 0
  v_mov_b32 v69, 0
  v_mov_b32 v70, 0
  v_mov_b32 v71, 0
  v_mov_b32 v72, 0
  v_mov_b32 v73, 0
  v_mov_b32 v74, 0
  v_mov_b32 v75, 0
  v_mov_b32 v76, 0
  v_mov_b32 v77, 0
  v_mov_b32 v78, 0
  v_mov_b32 v79, 0
  v_mov_b32 v80, 0
  v_mov_b32 v81, 0
  v_mov_b32 v82, 0
  v_mov_b32 v83, 0
  v_mov_b32 v84, 0
  v_mov_b32 v85, 0
  v_mov_b32 v86, 0
  v_mov_b32 v87, 0
  v_mov_b32 v88, 0
  v_mov_b32 v89, 0
  v_mov_b32 v90, 0
  v_mov_b32 v91, 0
  v_mov_b32 v92, 0
  v_mov_b32 v93, 0
  v_mov_b32 v94, 0
  v_mov_b32 v95, 0
  v_mov_b32 v96, 0
  v_mov_b32 v97, 0
  v_mov_b32 v98, 0
  v_mov_b32 v99, 0
  v_mov_b32 v100, 0
  v_mov_b32 v101, 0
  v_mov_b32 v102, 0
  v_mov_b32 v103, 0
  v_mov_b32 v104, 0
  v_mov_b32 v105, 0
  v_mov_b32 v106, 0
  v_mov_b32 v107, 0
  v_mov_b32 v108, 0
  v_mov_b32 v109, 0
  v_mov_b32 v110, 0
  v_mov_b32 v111, 0
  v_and_b32 v118, 1, v116
  v_cmp_eq_u32 vcc, 0, v118
  v_mov_b32 v118, 12544
  v_mov_b32 v119, 10240
  v_cndmask_b32 v118, v118, v119, vcc
  v_lshrrev_b32 v116, 1, v116
  v_lshl_add_u32 v118, v116, 9, v118
  v_lshl_add_u32 v117, v117, 4, v118
  s_mov_b32 s57, 28672
  v_bfe_u32 v118, v2, 4, 1
  v_mul_u32_u24 v118, 0xaaaa, v118
  v_add_u32 v118, 0x4444, v118
  s_mov_b32 s56, 0x42800000
  v_mov_b32 v116, v2
  v_lshrrev_b32 v0, 4, v2
  v_min_u32 v0, 13, v0
  s_mul_i32 s22, s17, 14
  v_add_u32 v0, s22, v0
  v_lshlrev_b32 v0, 7, v0
  v_add_u32 v0, 43008, v0
  s_mov_b32 s22, 71550976
  buffer_load_dword v119, v0, s[8:11], s22 offen sc1
  s_mov_b32 s22, 71522304
  buffer_load_dword v119, v0, s[8:11], s22 offen sc1
  s_mul_i32 s35, s17, 1835008
  s_add_u32 s35, s35, 42276864
  s_mov_b32 s30, 0
  v_mov_b32 v36, 0
ch_md2:
  buffer_load_dword v37, v36, s[12:15], 0 offen sc1
  s_waitcnt vmcnt(0)
  v_readfirstlane_b32 s22, v37
  s_and_b32 s31, s22, 0xffff
  s_cmp_ge_u32 s31, 32
  s_cbranch_scc1 ch_go2
  s_sleep 2
  s_add_u32 s30, s30, 1
  s_cmp_lt_u32 s30, 50000
  s_cbranch_scc1 ch_md2
  s_branch ch_end
ch_go2:
  s_mov_b32 s31, 0
  s_lshr_b32 s22, s22, 16
  s_cmp_lg_u32 s22, 0
  s_cbranch_scc1 cB_sc2_loop
  s_branch cA_sc2_loop
ch_init3:
  s_getpc_b64 s[98:99]
cpf_14:
  s_add_u32 s98, s98, cA_sc3_loop-cpf_14
  s_addc_u32 s99, s99, 0
  v_lshlrev_b32 v38, 2, v2
  global_load_dword v39, v38, s[98:99]
  s_mul_i32 s31, s17, 401408
  s_add_u32 s31, s31, 0
  s_mov_b32 s24, 71586816
  s_mov_b32 s25, 0
  s_add_u32 m0, s25, 21504
  s_nop 0
  buffer_load_dwordx4 v2, s[8:11], s24 offen offset:0 sc1 lds
  buffer_load_dwordx4 v2, s[8:11], s24 offen offset:1024 sc1 lds
  buffer_load_dwordx4 v2, s[8:11], s24 offen offset:2048 sc1 lds
  buffer_load_dwordx4 v2, s[8:11], s24 offen offset:3072 sc1 lds
  s_add_u32 m0, s25, 25600
  s_add_u32 s22, s24, 4096
  buffer_load_dwordx4 v2, s[8:11], s22 offen offset:0 sc1 lds
  buffer_load_dwordx4 v2, s[8:11], s22 offen offset:1024 sc1 lds
  buffer_load_dwordx4 v2, s[8:11], s22 offen offset:2048 sc1 lds
  v_lshrrev_b32 v64, 1, v117
  v_and_b32 v65, 1, v116
  v_lshlrev_b32 v65, 2, v65
  v_sub_u32 v64, v64, v65
  v_and_b32 v65, 1, v117
  v_lshl_add_u32 v66, v65, 2, v64
  v_cmp_gt_u32 vcc, 4, v64
  v_mov_b32 v67, 99
  s_nop 0
  v_cndmask_b32 v66, v67, v66, vcc
  v_mov_b32 v68, 0x3f80
  v_mov_b32 v69, 0x3f800000
  v_mov_b32 v4, 0
  v_cmp_eq_u32 vcc, 0, v66
  s_nop 1
  v_cndmask_b32 v4, v4, v68, vcc
  v_cmp_eq_u32 vcc, 1, v66
  s_nop 1
  v_cndmask_b32 v4, v4, v69, vcc
  v_mov_b32 v5, 0
  v_cmp_eq_u32 vcc, 2, v66
  s_nop 1
  v_cndmask_b32 v5, v5, v68, vcc
  v_cmp_eq_u32 vcc, 3, v66
  s_nop 1
  v_cndmask_b32 v5, v5, v69, vcc
  v_mov_b32 v6, 0
  v_cmp_eq_u32 vcc, 4, v66
  s_nop 1
  v_cndmask_b32 v6, v6, v68, vcc
  v_cmp_eq_u32 vcc, 5, v66
  s_nop 1
  v_cndmask_b32 v6, v6, v69, vcc
  v_mov_b32 v7, 0
  v_cmp_eq_u32 vcc, 6, v66
  s_nop 1
  v_cndmask_b32 v7, v7, v68, vcc
  v_cmp_eq_u32 vcc, 7, v66
  s_nop 1
  v_cndmask_b32 v7, v7, v69, vcc
  v_lshrrev_b32 v64, 1, v116
  v_lshrrev_b32 v65, 3, v117
  v_cmp_eq_u32 s[26:27], v64, v65
  v_and_b32 v66, 1, v116
  v_add_u32 v64, 6, v64
  v_lshrrev_b32 v67, 1, v116
  v_lshlrev_b32 v67, 8, v67
  v_lshl_add_u32 v67, v66, 9, v67
  v_lshl_add_u32 v67, v117, 4, v67
  v_add_u32 v112, 60416, v67
  v_and_b32 v68, 7, v117
  v_lshlrev_b32 v67, 8, v64
  v_lshl_add_u32 v67, v68, 5, v67
  v_lshl_add_u32 v67, v66, 4, v67
  v_add_u32 v113, 65536, v67
  v_lshrrev_b32 v64, 5, v1
  v_and_b32 v65, 31, v1
  v_lshrrev_b32 v66, 3, v65
  v_and_b32 v67, 7, v65
  v_and_b32 v68, 3, v67
  v_lshl_add_u32 v68, v66, 2, v68
  v_lshrrev_b32 v69, 2, v67
  v_lshl_add_u32 v68, v69, 4, v68
  v_lshlrev_b32 v69, 11, v64
  v_lshl_add_u32 v69, v68, 4, v69
  v_add_u32 v114, 57864, v69
  v_add_u32 v70, 6, v64
  v_lshlrev_b32 v69, 9, v66
  v_lshl_add_u32 v69, v70, 5, v69
  v_lshl_add_u32 v69, v67, 2, v69
  v_add_u32 v115, 65536, v69
  v_lshlrev_b32 v69, 4, v68
  v_lshl_add_u32 v69, v64, 9, v69
  v_add_u32 v114, 60416, v69
  v_mul_u32_u24 v69, 144, v70
  v_lshl_add_u32 v69, v67, 4, v69
  v_add_u32 v115, 65536, v69
  v_and_b32 v71, 1, v116
  v_mul_u32_u24 v69, 2048, v71
  v_lshl_add_u32 v69, v64, 8, v69
  v_lshl_add_u32 v69, v117, 4, v69
  v_add_u32 v112, 57864, v69
  v_mul_u32_u24 v69, 144, v117
  v_lshl_add_u32 v69, v71, 6, v69
  v_lshl_add_u32 v69, v64, 5, v69
  v_add_u32 v113, 65548, v69
  v_mul_u32_u24 v69, 1024, v116
  v_lshl_add_u32 v69, v117, 4, v69
  v_and_b32 v72, 8, v117
  v_xor_b32 v72, 8, v72
  v_add_u32 v69, v69, v72
  v_add_u32 v112, 57856, v69
  v_lshrrev_b32 v72, 3, v117
  v_lshl_add_u32 v72, v71, 1, v72
  v_xor_b32 v72, 3, v72
  v_lshlrev_b32 v69, 10, v116
  v_lshl_add_u32 v69, v117, 4, v69
  v_lshl_add_u32 v69, v72, 2, v69
  v_add_u32 v112, 57344, v69
  v_lshrrev_b32 v69, 1, v117
  v_and_b32 v72, 1, v117
  v_lshl_add_u32 v69, v72, 3, v69
  v_mul_u32_u24 v69, 144, v69
  v_lshl_add_u32 v69, v71, 6, v69
  v_lshl_add_u32 v69, v64, 5, v69
  v_lshl_add_u32 v72, v72, 1, v71
  v_xor_b32 v72, 3, v72
  v_lshl_add_u32 v69, v72, 2, v69
  v_add_u32 v113, 65536, v69
  v_and_b32 v71, 1, v1
  v_cmp_eq_u32 s[38:39], 0, v71
  v_cmp_gt_u32 vcc, 8, v65
  s_or_b64 s[28:29], s[38:39], vcc
  v_lshrrev_b32 v72, 1, v67
  v_lshlrev_b32 v72, 2, v72
  v_lshl_add_u32 v72, v70, 4, v72
  s_lshl_b32 s22, s17, 9
  s_add_u32 s22, s22, 9216
  v_lshl_add_u32 v73, v66, 7, v72
  v_add_u32 v73, s22, v73
  s_lshl_b32 s22, s17, 7
  s_add_u32 s22, s22, 7168
  v_add_u32 v74, s22, v72
  v_bfe_u32 v72, v65, 1, 1
  v_lshlrev_b32 v72, 7, v72
  v_lshl_add_u32 v72, v70, 4, v72
  v_bfe_u32 v73, v65, 2, 2
  v_lshl_add_u32 v72, v73, 2, v72
  v_lshrrev_b32 v73, 4, v65
  v_lshl_add_u32 v73, v73, 8, v72
  s_lshl_b32 s22, s17, 9
  s_add_u32 s22, s22, 9216
  v_add_u32 v73, s22, v73
  s_lshr_b32 s22, s17, 1
  s_lshl_b32 s22, s22, 8
  s_and_b32 s34, s17, 1
  s_lshl_b32 s34, s34, 3
  s_add_u32 s22, s22, s34
  s_add_u32 s22, s22, 7168
  v_add_u32 v74, s22, v72
  v_bfe_u32 v72, v65, 1, 1
  v_lshl_add_u32 v72, v64, 1, v72
  v_lshlrev_b32 v72, 4, v72
  v_bfe_u32 v73, v65, 2, 2
  v_lshl_add_u32 v72, v73, 2, v72
  v_lshrrev_b32 v73, 4, v65
  v_lshl_add_u32 v73, v73, 6, v72
  s_lshl_b32 s22, s17, 9
  s_add_u32 s22, s22, 9600
  v_add_u32 v73, s22, v73
  v_lshrrev_b32 v72, 1, v65
  v_lshlrev_b32 v72, 2, v72
  v_lshl_add_u32 v72, v64, 5, v72
  s_lshr_b32 s22, s17, 1
  s_lshl_b32 s22, s22, 8
  s_and_b32 s34, s17, 1
  s_lshl_b32 s34, s34, 4
  s_add_u32 s22, s22, s34
  s_add_u32 s22, s22, 7360
  v_add_u32 v74, s22, v72
  v_lshlrev_b32 v0, 2, v65
  v_and_b32 v0, 120, v0
  s_and_b32 s22, s17, 15
  s_lshl_b32 s22, s22, 7
  s_add_u32 s22, s22, 18432
  v_add_u32 v0, s22, v0
  v_cndmask_b32 v1, v74, v73, s[38:39]
  s_lshl_b32 s36, s17, 2
  s_add_u32 s36, s36, 17472
  s_mov_b32 s37, 0x3e800000
  v_mov_b32 v64, 0
  v_mov_b32 v65, 0
  v_mov_b32 v66, 0
  v_mov_b32 v67, 0
  v_mov_b32 v68, 0
  v_mov_b32 v69, 0
  v_mov_b32 v70, 0
  v_mov_b32 v71, 0
  v_mov_b32 v72, 0
  v_mov_b32 v73, 0
  v_mov_b32 v74, 0
  v_mov_b32 v75, 0
  v_mov_b32 v76, 0
  v_mov_b32 v77, 0
  v_mov_b32 v78, 0
  v_mov_b32 v79, 0
  v_mov_b32 v80, 0
  v_mov_b32 v81, 0
  v_mov_b32 v82, 0
  v_mov_b32 v83, 0
  v_mov_b32 v84, 0
  v_mov_b32 v85, 0
  v_mov_b32 v86, 0
  v_mov_b32 v87, 0
  v_mov_b32 v88, 0
  v_mov_b32 v89, 0
  v_mov_b32 v90, 0
  v_mov_b32 v91, 0
  v_mov_b32 v92, 0
  v_mov_b32 v93, 0
  v_mov_b32 v94, 0
  v_mov_b32 v95, 0
  v_mov_b32 v96, 0
  v_mov_b32 v97, 0
  v_mov_b32 v98, 0
  v_mov_b32 v99, 0
  v_mov_b32 v100, 0
  v_mov_b32 v101, 0
  v_mov_b32 v102, 0
  v_mov_b32 v103, 0
  v_mov_b32 v104, 0
  v_mov_b32 v105, 0
  v_mov_b32 v106, 0
  v_mov_b32 v107, 0
  v_mov_b32 v108, 0
  v_mov_b32 v109, 0
  v_mov_b32 v110, 0
  v_mov_b32 v111, 0
  v_and_b32 v118, 1, v116
  v_cmp_eq_u32 vcc, 0, v118
  v_mov_b32 v118, 12544
  v_mov_b32 v119, 10496
  v_cndmask_b32 v118, v118, v119, vcc
  v_lshrrev_b32 v116, 1, v116
  v_lshl_add_u32 v118, v116, 9, v118
  v_lshl_add_u32 v117, v117, 4, v118
  s_mov_b32 s57, 28672
  v_bfe_u32 v118, v2, 4, 1
  v_mul_u32_u24 v118, 0xaaaa, v118
  v_add_u32 v118, 0x4444, v118
  s_mov_b32 s56, 0x42800000
  v_mov_b32 v116, v2
  s_mul_i32 s35, s17, 1835008
  s_add_u32 s35, s35, 42284032
  s_mov_b32 s30, 0
  v_mov_b32 v36, 0
ch_md3:
  buffer_load_dword v37, v36, s[12:15], 0 offen sc1
  s_waitcnt vmcnt(0)
  v_readfirstlane_b32 s22, v37
  s_and_b32 s31, s22, 0xffff
  s_cmp_ge_u32 s31, 32
  s_cbranch_scc1 ch_go3
  s_sleep 2
  s_add_u32 s30, s30, 1
  s_cmp_lt_u32 s30, 50000
  s_cbranch_scc1 ch_md3
  s_branch ch_end
ch_go3:
  s_mov_b32 s31, 0
  s_lshr_b32 s22, s22, 16
  s_cmp_lg_u32 s22, 0
  s_cbranch_scc1 cB_sc3_loop
  s_branch cA_sc3_loop
ch_init4:
  s_mul_i32 s31, s17, 401408
  s_add_u32 s31, s31, 6422528
  s_lshl_b32 s22, s17, 4
  v_mov_b32 v38, s22
  v_mov_b32 v36, v38
  v_med3_u32 v37, v117, 0, 5
  v_lshrrev_b32 v36, 6, v36
  v_lshlrev_b32 v36, 8, v36
  v_lshl_add_u32 v36, v37, 4, v36
  s_mov_b32 s22, 88600576
  s_mov_b32 s30, 0
va_bw_16:
  buffer_load_dwordx4 v[40:43], v36, s[8:11], s22 offen sc1
  s_waitcnt vmcnt(0)
  v_cmp_ne_u64 vcc, s[88:89], v[40:41]
  s_cbranch_vccnz va_bw_16_no
  v_cmp_ne_u64 vcc, s[88:89], v[42:43]
  s_cbranch_vccnz va_bw_16_no
  s_branch va_bw_16_ok
va_bw_16_no:
  s_sleep 2
  s_add_u32 s30, s30, 1
  s_cmp_lt_u32 s30, 50000
  s_cbranch_scc1 va_bw_16
  s_branch cA_abort
va_bw_16_ok:
  s_add_u32 s22, s31, 0
  buffer_load_dwordx4 a[0:3], v2, s[8:11], s22 offen offset:0 sc1
  buffer_load_dwordx4 a[4:7], v2, s[8:11], s22 offen offset:1024 sc1
  buffer_load_dwordx4 a[8:11], v2, s[8:11], s22 offen offset:2048 sc1
  buffer_load_dwordx4 a[12:15], v2, s[8:11], s22 offen offset:3072 sc1
  s_add_u32 s22, s31, 4096
  buffer_load_dwordx4 a[16:19], v2, s[8:11], s22 offen offset:0 sc1
  buffer_load_dwordx4 a[20:23], v2, s[8:11], s22 offen offset:1024 sc1
  buffer_load_dwordx4 a[24:27], v2, s[8:11], s22 offen offset:2048 sc1
  buffer_load_dwordx4 a[28:31], v2, s[8:11], s22 offen offset:3072 sc1
  s_add_u32 s22, s31, 8192
  buffer_load_dwordx4 a[32:35], v2, s[8:11], s22 offen offset:0 sc1
  buffer_load_dwordx4 a[36:39], v2, s[8:11], s22 offen offset:1024 sc1
  buffer_load_dwordx4 a[40:43], v2, s[8:11], s22 offen offset:2048 sc1
  buffer_load_dwordx4 a[44:47], v2, s[8:11], s22 offen offset:3072 sc1
  s_add_u32 s22, s31, 12288
  buffer_load_dwordx4 a[48:51], v2, s[8:11], s22 offen offset:0 sc1
  buffer_load_dwordx4 a[52:55], v2, s[8:11], s22 offen offset:1024 sc1
  buffer_load_dwordx4 a[56:59], v2, s[8:11], s22 offen offset:2048 sc1
  buffer_load_dwordx4 a[60:63], v2, s[8:11], s22 offen offset:3072 sc1
  s_add_u32 s22, s31, 16384
  buffer_load_dwordx4 a[64:67], v2, s[8:11], s22 offen offset:0 sc1
  buffer_load_dwordx4 a[68:71], v2, s[8:11], s22 offen offset:1024 sc1
  buffer_load_dwordx4 a[72:75], v2, s[8:11], s22 offen offset:2048 sc1
  buffer_load_dwordx4 a[76:79], v2, s[8:11], s22 offen offset:3072 sc1
  s_add_u32 s22, s31, 20480
  buffer_load_dwordx4 a[80:83], v2, s[8:11], s22 offen offset:0 sc1
  buffer_load_dwordx4 a[84:87], v2, s[8:11], s22 offen offset:1024 sc1
  buffer_load_dwordx4 a[88:91], v2, s[8:11], s22 offen offset:2048 sc1
  buffer_load_dwordx4 a[92:95], v2, s[8:11], s22 offen offset:3072 sc1
  s_add_u32 s22, s31, 24576
  buffer_load_dwordx4 a[96:99], v2, s[8:11], s22 offen offset:0 sc1
  buffer_load_dwordx4 a[100:103], v2, s[8:11], s22 offen offset:1024 sc1
  buffer_load_dwordx4 a[104:107], v2, s[8:11], s22 offen offset:2048 sc1
  buffer_load_dwordx4 a[108:111], v2, s[8:11], s22 offen offset:3072 sc1
  s_add_u32 s22, s31, 28672
  buffer_load_dwordx4 a[112:115], v2, s[8:11], s22 offen offset:0 sc1
  buffer_load_dwordx4 a[116:119], v2, s[8:11], s22 offen offset:1024 sc1
  buffer_load_dwordx4 a[120:123], v2, s[8:11], s22 offen offset:2048 sc1
  buffer_load_dwordx4 a[124:127], v2, s[8:11], s22 offen offset:3072 sc1
  s_waitcnt vmcnt(24)
  s_add_u32 s22, s31, 32768
  buffer_load_dwordx4 a[128:131], v2, s[8:11], s22 offen offset:0 sc1
  buffer_load_dwordx4 a[132:135], v2, s[8:11], s22 offen offset:1024 sc1
  buffer_load_dwordx4 a[136:139], v2, s[8:11], s22 offen offset:2048 sc1
  buffer_load_dwordx4 a[140:143], v2, s[8:11], s22 offen offset:3072 sc1
  s_add_u32 s22, s31, 36864
  buffer_load_dwordx4 a[144:147], v2, s[8:11], s22 offen offset:0 sc1
  buffer_load_dwordx4 a[148:151], v2, s[8:11], s22 offen offset:1024 sc1
  buffer_load_dwordx4 a[152:155], v2, s[8:11], s22 offen offset:2048 sc1
  buffer_load_dwordx4 a[156:159], v2, s[8:11], s22 offen offset:3072 sc1
  s_add_u32 s22, s31, 40960
  buffer_load_dwordx4 a[160:163], v2, s[8:11], s22 offen offset:0 sc1
  buffer_load_dwordx4 a[164:167], v2, s[8:11], s22 offen offset:1024 sc1
  buffer_load_dwordx4 a[168:171], v2, s[8:11], s22 offen offset:2048 sc1
  buffer_load_dwordx4 a[172:175], v2, s[8:11], s22 offen offset:3072 sc1
  s_add_u32 s22, s31, 45056
  buffer_load_dwordx4 a[176:179], v2, s[8:11], s22 offen offset:0 sc1
  buffer_load_dwordx4 a[180:183], v2, s[8:11], s22 offen offset:1024 sc1
  buffer_load_dwordx4 a[184:187], v2, s[8:11], s22 offen offset:2048 sc1
  buffer_load_dwordx4 a[188:191], v2, s[8:11], s22 offen offset:3072 sc1
  s_add_u32 s22, s31, 49152
  buffer_load_dwordx4 a[192:195], v2, s[8:11], s22 offen offset:0 sc1
  buffer_load_dwordx4 a[196:199], v2, s[8:11], s22 offen offset:1024 sc1
  buffer_load_dwordx4 a[200:203], v2, s[8:11], s22 offen offset:2048 sc1
  buffer_load_dwordx4 a[204:207], v2, s[8:11], s22 offen offset:3072 sc1
  s_add_u32 s22, s31, 53248
  buffer_load_dwordx4 a[208:211], v2, s[8:11], s22 offen offset:0 sc1
  buffer_load_dwordx4 a[212:215], v2, s[8:11], s22 offen offset:1024 sc1
  buffer_load_dwordx4 a[216:219], v2, s[8:11], s22 offen offset:2048 sc1
  buffer_load_dwordx4 a[220:223], v2, s[8:11], s22 offen offset:3072 sc1
  s_add_u32 s22, s31, 57344
  buffer_load_dwordx4 a[224:227], v2, s[8:11], s22 offen offset:0 sc1
  buffer_load_dwordx4 a[228:231], v2, s[8:11], s22 offen offset:1024 sc1
  buffer_load_dwordx4 a[232:235], v2, s[8:11], s22 offen offset:2048 sc1
  buffer_load_dwordx4 a[236:239], v2, s[8:11], s22 offen offset:3072 sc1
  s_add_u32 s22, s31, 61440
  buffer_load_dwordx4 a[240:243], v2, s[8:11], s22 offen offset:0 sc1
  buffer_load_dwordx4 a[244:247], v2, s[8:11], s22 offen offset:1024 sc1
  buffer_load_dwordx4 a[248:251], v2, s[8:11], s22 offen offset:2048 sc1
  buffer_load_dwordx4 a[252:255], v2, s[8:11], s22 offen offset:3072 sc1
  s_waitcnt vmcnt(24)
  s_add_u32 s22, s31, 65536
  buffer_load_dwordx4 v[176:179], v2, s[8:11], s22 offen offset:0 sc1
  buffer_load_dwordx4 v[180:183], v2, s[8:11], s22 offen offset:1024 sc1
  buffer_load_dwordx4 v[184:187], v2, s[8:11], s22 offen offset:2048 sc1
  buffer_load_dwordx4 v[188:191], v2, s[8:11], s22 offen offset:3072 sc1
  s_add_u32 s22, s31, 69632
  buffer_load_dwordx4 v[192:195], v2, s[8:11], s22 offen offset:0 sc1
  buffer_load_dwordx4 v[196:199], v2, s[8:11], s22 offen offset:1024 sc1
  buffer_load_dwordx4 v[200:203], v2, s[8:11], s22 offen offset:2048 sc1
  buffer_load_dwordx4 v[204:207], v2, s[8:11], s22 offen offset:3072 sc1
  s_add_u32 s22, s31, 73728
  buffer_load_dwordx4 v[208:211], v2, s[8:11], s22 offen offset:0 sc1
  buffer_load_dwordx4 v[212:215], v2, s[8:11], s22 offen offset:1024 sc1
  buffer_load_dwordx4 v[216:219], v2, s[8:11], s22 offen offset:2048 sc1
  buffer_load_dwordx4 v[220:223], v2, s[8:11], s22 offen offset:3072 sc1
  s_add_u32 s22, s31, 77824
  buffer_load_dwordx4 v[224:227], v2, s[8:11], s22 offen offset:0 sc1
  buffer_load_dwordx4 v[228:231], v2, s[8:11], s22 offen offset:1024 sc1
  buffer_load_dwordx4 v[232:235], v2, s[8:11], s22 offen offset:2048 sc1
  buffer_load_dwordx4 v[236:239], v2, s[8:11], s22 offen offset:3072 sc1
  s_add_u32 s22, s31, 81920
  buffer_load_dwordx4 v[240:243], v2, s[8:11], s22 offen offset:0 sc1
  buffer_load_dwordx4 v[244:247], v2, s[8:11], s22 offen offset:1024 sc1
  buffer_load_dwordx4 v[248:251], v2, s[8:11], s22 offen offset:2048 sc1
  buffer_load_dwordx4 v[252:255], v2, s[8:11], s22 offen offset:3072 sc1
  s_lshl_b32 s22, s17, 4
  v_mov_b32 v38, s22
  s_mul_i32 s22, s17, 12
  s_add_u32 s23, s22, 267
  s_add_u32 s22, s22, 256
  v_mov_b32 v36, s23
  v_mov_b32 v37, s22
  v_cmp_eq_u32 vcc, 1, v116
  s_nop 1
  v_cndmask_b32 v36, v36, v37, vcc
  v_med3_u32 v37, v117, 4, 5
  v_lshrrev_b32 v36, 6, v36
  v_lshlrev_b32 v36, 8, v36
  v_lshl_add_u32 v36, v37, 4, v36
  s_mov_b32 s22, 88600576
  s_mov_b32 s30, 0
va_bw_17:
  buffer_load_dwordx4 v[40:43], v36, s[8:11], s22 offen sc1
  s_waitcnt vmcnt(0)
  v_cmp_ne_u64 vcc, s[88:89], v[40:41]
  s_cbranch_vccnz va_bw_17_no
  v_cmp_ne_u64 vcc, s[88:89], v[42:43]
  s_cbranch_vccnz va_bw_17_no
  s_branch va_bw_17_ok
va_bw_17_no:
  s_sleep 2
  s_add_u32 s30, s30, 1
  s_cmp_lt_u32 s30, 50000
  s_cbranch_scc1 va_bw_17
  s_branch cA_abort
va_bw_17_ok:
  s_mov_b32 m0, 16384
  s_add_u32 s22, s31, 272384
  buffer_load_dwordx4 v2, s[8:11], s22 offen offset:0 sc1 lds
  buffer_load_dwordx4 v2, s[8:11], s22 offen offset:1024 sc1 lds
  buffer_load_dwordx4 v2, s[8:11], s22 offen offset:2048 sc1 lds
  buffer_load_dwordx4 v2, s[8:11], s22 offen offset:3072 sc1 lds
  s_mov_b32 m0, 20480
  s_add_u32 s22, s31, 276480
  buffer_load_dwordx4 v2, s[8:11], s22 offen offset:0 sc1 lds
  buffer_load_dwordx4 v2, s[8:11], s22 offen offset:1024 sc1 lds
  buffer_load_dwordx4 v2, s[8:11], s22 offen offset:2048 sc1 lds
  buffer_load_dwordx4 v2, s[8:11], s22 offen offset:3072 sc1 lds
  s_mov_b32 m0, 24576
  s_add_u32 s22, s31, 280576
  buffer_load_dwordx4 v2, s[8:11], s22 offen offset:0 sc1 lds
  buffer_load_dwordx4 v2, s[8:11], s22 offen offset:1024 sc1 lds
  buffer_load_dwordx4 v2, s[8:11], s22 offen offset:2048 sc1 lds
  buffer_load_dwordx4 v2, s[8:11], s22 offen offset:3072 sc1 lds
  s_mov_b32 m0, 28672
  s_add_u32 s22, s31, 284672
  buffer_load_dwordx4 v2, s[8:11], s22 offen offset:0 sc1 lds
  buffer_load_dwordx4 v2, s[8:11], s22 offen offset:1024 sc1 lds
  v_mov_b32 v72, v116
  v_mov_b32 v73, v117
  v_lshrrev_b32 v65, 1, v72
  v_and_b32 v66, 1, v72
  v_mov_b32 v68, 0
  v_mov_b32 v69, v73
  v_mov_b32 v70, 0
  v_and_b32 v71, 1, v69
  v_lshrrev_b32 v69, 1, v69
  v_lshl_add_u32 v69, v71, 3, v69
  v_lshlrev_b32 v71, 12, v70
  v_lshrrev_b32 v70, 1, v68
  v_lshl_add_u32 v71, v70, 9, v71
  v_and_b32 v70, 1, v68
  v_lshl_add_u32 v71, v70, 2, v71
  v_lshl_add_u32 v71, v69, 4, v71
  v_lshl_add_u32 v71, v65, 8, v71
  v_lshl_add_u32 v60, v66, 3, v71
  v_mov_b32 v68, 1
  v_mov_b32 v69, v73
  v_mov_b32 v70, 0
  v_and_b32 v71, 1, v69
  v_lshrrev_b32 v69, 1, v69
  v_lshl_add_u32 v69, v71, 3, v69
  v_lshlrev_b32 v71, 12, v70
  v_lshrrev_b32 v70, 1, v68
  v_lshl_add_u32 v71, v70, 9, v71
  v_and_b32 v70, 1, v68
  v_lshl_add_u32 v71, v70, 2, v71
  v_lshl_add_u32 v71, v69, 4, v71
  v_lshl_add_u32 v71, v65, 8, v71
  v_lshl_add_u32 v61, v66, 3, v71
  v_mov_b32 v68, 2
  v_mov_b32 v69, v73
  v_mov_b32 v70, 0
  v_and_b32 v71, 1, v69
  v_lshrrev_b32 v69, 1, v69
  v_lshl_add_u32 v69, v71, 3, v69
  v_lshlrev_b32 v71, 12, v70
  v_lshrrev_b32 v70, 1, v68
  v_lshl_add_u32 v71, v70, 9, v71
  v_and_b32 v70, 1, v68
  v_lshl_add_u32 v71, v70, 2, v71
  v_lshl_add_u32 v71, v69, 4, v71
  v_lshl_add_u32 v71, v65, 8, v71
  v_lshl_add_u32 v62, v66, 3, v71
  v_mov_b32 v68, 3
  v_mov_b32 v69, v73
  v_mov_b32 v70, 0
  v_and_b32 v71, 1, v69
  v_lshrrev_b32 v69, 1, v69
  v_lshl_add_u32 v69, v71, 3, v69
  v_lshlrev_b32 v71, 12, v70
  v_lshrrev_b32 v70, 1, v68
  v_lshl_add_u32 v71, v70, 9, v71
  v_and_b32 v70, 1, v68
  v_lshl_add_u32 v71, v70, 2, v71
  v_lshl_add_u32 v71, v69, 4, v71
  v_lshl_add_u32 v71, v65, 8, v71
  v_lshl_add_u32 v170, v66, 3, v71
  v_mov_b32 v68, 4
  v_mov_b32 v69, v73
  v_mov_b32 v70, 0
  v_and_b32 v71, 1, v69
  v_lshrrev_b32 v69, 1, v69
  v_lshl_add_u32 v69, v71, 3, v69
  v_lshlrev_b32 v71, 12, v70
  v_lshrrev_b32 v70, 1, v68
  v_lshl_add_u32 v71, v70, 9, v71
  v_and_b32 v70, 1, v68
  v_lshl_add_u32 v71, v70, 2, v71
  v_lshl_add_u32 v71, v69, 4, v71
  v_lshl_add_u32 v71, v65, 8, v71
  v_lshl_add_u32 v171, v66, 3, v71
  v_mov_b32 v68, 5
  v_mov_b32 v69, v73
  v_mov_b32 v70, 0
  v_and_b32 v71, 1, v69
  v_lshrrev_b32 v69, 1, v69
  v_lshl_add_u32 v69, v71, 3, v69
  v_lshlrev_b32 v71, 12, v70
  v_lshrrev_b32 v70, 1, v68
  v_lshl_add_u32 v71, v70, 9, v71
  v_and_b32 v70, 1, v68
  v_lshl_add_u32 v71, v70, 2, v71
  v_lshl_add_u32 v71, v69, 4, v71
  v_lshl_add_u32 v71, v65, 8, v71
  v_lshl_add_u32 v172, v66, 3, v71
  v_and_b32 v0, 31, v1
  v_lshlrev_b32 v0, 2, v0
  v_add_u32 v0, 18432, v0
  v_min_u32 v4, 15, v73
  v_lshlrev_b32 v4, 2, v4
  s_and_b32 s22, s17, 3
  s_lshl_b32 s22, s22, 7
  s_add_u32 s22, s22, 17408
  v_add_u32 v4, s22, v4
  v_and_b32 v64, 7, v73
  v_lshlrev_b32 v5, 4, v64
  v_lshl_add_u32 v5, v72, 7, v5
  v_lshrrev_b32 v65, 3, v73
  v_lshl_add_u32 v5, v65, 9, v5
  s_lshl_b32 s22, s17, 3
  s_add_u32 s22, s22, 18432
  v_lshl_add_u32 v7, v2, 3, s22
  v_add_u32 v65, 0, v73
  v_min_u32 v65, 27, v65
  v_mad_u32_u24 v65, v72, 28, v65
  v_lshlrev_b32 v6, 4, v65
  s_lshr_b32 s22, s17, 1
  s_mul_i32 s22, s22, 7
  s_and_b32 s34, s17, 1
  s_lshl_b32 s35, s34, 2
  v_add_u32 v70, s35, v72
  v_mov_b32 v71, s34
  v_mov_b32 v69, 0
  v_cmp_eq_u32 vcc, 3, v72
  s_nop 1
  v_cndmask_b32 v70, v70, v72, vcc
  v_cndmask_b32 v69, v69, v71, vcc
  v_add_u32 v70, s22, v70
  v_lshrrev_b32 v68, 1, v70
  v_lshlrev_b32 v68, 8, v68
  v_lshl_add_u32 v68, v69, 7, v68
  v_and_b32 v69, 1, v70
  v_lshl_add_u32 v68, v69, 3, v68
  v_lshl_add_u32 v1, v64, 4, v68
  v_cmp_gt_u32 s[26:27], 8, v73
  v_lshrrev_b32 v65, 3, v73
  v_min_u32 v66, 7, v64
  v_lshl_add_u32 v66, v66, 1, v65
  v_mad_u32_u24 v66, v72, 16, v66
  v_lshlrev_b32 v66, 4, v66
  v_add_u32 v6, 0, v66
  s_mul_i32 s22, s17, 16
  s_add_u32 s22, s22, 0
  v_lshl_add_u32 v70, v64, 1, s22
  v_lshrrev_b32 v68, 4, v70
  v_lshlrev_b32 v68, 8, v68
  v_bfe_u32 v69, v70, 1, 1
  v_lshl_add_u32 v68, v69, 7, v68
  v_bfe_u32 v69, v70, 2, 2
  v_lshl_add_u32 v68, v69, 2, v68
  v_and_b32 v69, 1, v72
  v_lshl_add_u32 v65, v69, 2, v65
  v_lshrrev_b32 v69, 1, v72
  v_lshl_add_u32 v65, v69, 1, v65
  v_lshrrev_b32 v65, 3, v73
  v_lshl_add_u32 v65, v72, 1, v65
  v_lshrrev_b32 v5, 1, v72
  v_lshlrev_b32 v5, 9, v5
  v_lshrrev_b32 v69, 2, v73
  v_lshl_add_u32 v5, v69, 7, v5
  v_and_b32 v69, 1, v72
  v_lshl_add_u32 v5, v69, 6, v5
  v_and_b32 v69, 3, v73
  v_lshl_add_u32 v5, v69, 4, v5
  v_and_b32 v69, 1, v73
  v_mul_u32_u24 v69, 0xaaaa, v69
  v_add_u32 v0, 0x4444, v69
  v_lshl_add_u32 v1, v65, 4, v68
  v_cmp_gt_u32 s[26:27], 6, v64
  v_mov_b32 v156, 0
  v_mov_b32 v157, 0
  v_mov_b32 v158, 0
  v_mov_b32 v159, 0
  ds_write_b128 v2, v[156:159] offset:0
  ds_write_b128 v2, v[156:159] offset:1024
  ds_write_b128 v2, v[156:159] offset:2048
  ds_write_b128 v2, v[156:159] offset:3072
  s_mul_i32 s22, s17, 1835008
  s_add_u32 s25, s22, 42205184
  s_lshl_b32 s35, s17, 7
  s_add_u32 s35, s35, 88539136
  s_add_u32 s39, s35, 16384
  s_mov_b32 s38, 0
  v_mov_b32 v63, 0
  v_bfe_u32 v8, v2, 4, 1
  v_mul_u32_u24 v3, 0xaaaa, v8
  v_add_u32 v3, 0x4444, v3
  v_bfe_u32 v9, v2, 5, 3
  v_lshl_add_u32 v8, v8, 3, v9
  v_and_b32 v9, 0x300, v2
  v_lshl_add_u32 v0, v8, 4, v9
  s_getpc_b64 s[98:99]
cpf_15:
  s_add_u32 s98, s98, cA_va0_loop-cpf_15
  s_addc_u32 s99, s99, 0
  v_lshlrev_b32 v38, 2, v2
  global_load_dword v39, v38, s[98:99]
  s_lshl_b32 s22, 0, 11
  s_add_u32 s22, s22, 88602624
  v_add_u32 v36, 1024, v2
  v_min_u32 v36, 1776, v36
  s_mov_b32 s30, 0
va_iw4:
  buffer_load_dwordx4 v[40:43], v2, s[8:11], s22 offen sc1
  buffer_load_dwordx4 v[44:47], v36, s[8:11], s22 offen sc1
  s_waitcnt vmcnt(0)
  v_cmp_ne_u64 vcc, s[88:89], v[40:41]
  s_cbranch_vccnz va_iw4_no
  v_cmp_ne_u64 vcc, s[88:89], v[42:43]
  s_cbranch_vccnz va_iw4_no
  v_cmp_ne_u64 vcc, s[88:89], v[44:45]
  s_cbranch_vccnz va_iw4_no
  v_cmp_ne_u64 vcc, s[88:89], v[46:47]
  s_cbranch_vccnz va_iw4_no
  s_branch va_iw4_ok
va_iw4_no:
  s_sleep 2
  s_add_u32 s30, s30, 1
  s_cmp_lt_u32 s30, 50000
  s_cbranch_scc1 va_iw4
  s_branch cA_abort
va_iw4_ok:
  s_mov_b32 s30, 0
  v_mov_b32 v36, 0
ch_md4:
  buffer_load_dword v37, v36, s[12:15], 0 offen sc1
  s_waitcnt vmcnt(0)
  v_readfirstlane_b32 s22, v37
  s_and_b32 s31, s22, 0xffff
  s_cmp_ge_u32 s31, 32
  s_cbranch_scc1 ch_go4
  s_sleep 2
  s_add_u32 s30, s30, 1
  s_cmp_lt_u32 s30, 50000
  s_cbranch_scc1 ch_md4
  s_branch ch_end
ch_go4:
  s_mov_b32 s31, 0
  v_mov_b32 v36, 0
  v_mov_b32 v37, 0
  v_mov_b32 v38, 0
  v_mov_b32 v39, 0
  v_mov_b32 v40, 0
  v_mov_b32 v41, 0
  v_mov_b32 v42, 0
  v_mov_b32 v43, 0
  v_mov_b32 v44, 0
  v_mov_b32 v45, 0
  v_mov_b32 v46, 0
  v_mov_b32 v47, 0
  v_mov_b32 v48, 0
  v_mov_b32 v49, 0
  v_mov_b32 v50, 0
  v_mov_b32 v51, 0
  v_mov_b32 v52, 0
  v_mov_b32 v53, 0
  v_mov_b32 v54, 0
  v_mov_b32 v55, 0
  v_mov_b32 v56, 0
  v_mov_b32 v57, 0
  v_mov_b32 v58, 0
  v_mov_b32 v59, 0
  s_lshr_b32 s22, s22, 16
  s_cmp_lg_u32 s22, 0
  s_cbranch_scc1 cB_va0_loop
  s_branch cA_va0_loop
ch_init5:
  s_mul_i32 s31, s17, 401408
  s_add_u32 s31, s31, 6422528
  s_lshl_b32 s22, s17, 4
  v_mov_b32 v38, s22
  v_mov_b32 v36, v38
  v_med3_u32 v37, v117, 6, 11
  v_lshrrev_b32 v36, 6, v36
  v_lshlrev_b32 v36, 8, v36
  v_lshl_add_u32 v36, v37, 4, v36
  s_mov_b32 s22, 88600576
  s_mov_b32 s30, 0
va_bw_19:
  buffer_load_dwordx4 v[40:43], v36, s[8:11], s22 offen sc1
  s_waitcnt vmcnt(0)
  v_cmp_ne_u64 vcc, s[88:89], v[40:41]
  s_cbranch_vccnz va_bw_19_no
  v_cmp_ne_u64 vcc, s[88:89], v[42:43]
  s_cbranch_vccnz va_bw_19_no
  s_branch va_bw_19_ok
va_bw_19_no:
  s_sleep 2
  s_add_u32 s30, s30, 1
  s_cmp_lt_u32 s30, 50000
  s_cbranch_scc1 va_bw_19
  s_branch cA_abort
va_bw_19_ok:
  s_add_u32 s22, s31, 86016
  buffer_load_dwordx4 a[0:3], v2, s[8:11], s22 offen offset:0 sc1
  buffer_load_dwordx4 a[4:7], v2, s[8:11], s22 offen offset:1024 sc1
  buffer_load_dwordx4 a[8:11], v2, s[8:11], s22 offen offset:2048 sc1
  buffer_load_dwordx4 a[12:15], v2, s[8:11], s22 offen offset:3072 sc1
  s_add_u32 s22, s31, 90112
  buffer_load_dwordx4 a[16:19], v2, s[8:11], s22 offen offset:0 sc1
  buffer_load_dwordx4 a[20:23], v2, s[8:11], s22 offen offset:1024 sc1
  buffer_load_dwordx4 a[24:27], v2, s[8:11], s22 offen offset:2048 sc1
  buffer_load_dwordx4 a[28:31], v2, s[8:11], s22 offen offset:3072 sc1
  s_add_u32 s22, s31, 94208
  buffer_load_dwordx4 a[32:35], v2, s[8:11], s22 offen offset:0 sc1
  buffer_load_dwordx4 a[36:39], v2, s[8:11], s22 offen offset:1024 sc1
  buffer_load_dwordx4 a[40:43], v2, s[8:11], s22 offen offset:2048 sc1
  buffer_load_dwordx4 a[44:47], v2, s[8:11], s22 offen offset:3072 sc1
  s_add_u32 s22, s31, 98304
  buffer_load_dwordx4 a[48:51], v2, s[8:11], s22 offen offset:0 sc1
  buffer_load_dwordx4 a[52:55], v2, s[8:11], s22 offen offset:1024 sc1
  buffer_load_dwordx4 a[56:59], v2, s[8:11], s22 offen offset:2048 sc1
  buffer_load_dwordx4 a[60:63], v2, s[8:11], s22 offen offset:3072 sc1
  s_add_u32 s22, s31, 102400
  buffer_load_dwordx4 a[64:67], v2, s[8:11], s22 offen offset:0 sc1
  buffer_load_dwordx4 a[68:71], v2, s[8:11], s22 offen offset:1024 sc1
  buffer_load_dwordx4 a[72:75], v2, s[8:11], s22 offen offset:2048 sc1
  buffer_load_dwordx4 a[76:79], v2, s[8:11], s22 offen offset:3072 sc1
  s_add_u32 s22, s31, 106496
  buffer_load_dwordx4 a[80:83], v2, s[8:11], s22 offen offset:0 sc1
  buffer_load_dwordx4 a[84:87], v2, s[8:11], s22 offen offset:1024 sc1
  buffer_load_dwordx4 a[88:91], v2, s[8:11], s22 offen offset:2048 sc1
  buffer_load_dwordx4 a[92:95], v2, s[8:11], s22 offen offset:3072 sc1
  s_add_u32 s22, s31, 110592
  buffer_load_dwordx4 a[96:99], v2, s[8:11], s22 offen offset:0 sc1
  buffer_load_dwordx4 a[100:103], v2, s[8:11], s22 offen offset:1024 sc1
  buffer_load_dwordx4 a[104:107], v2, s[8:11], s22 offen offset:2048 sc1
  buffer_load_dwordx4 a[108:111], v2, s[8:11], s22 offen offset:3072 sc1
  s_add_u32 s22, s31, 114688
  buffer_load_dwordx4 a[112:115], v2, s[8:11], s22 offen offset:0 sc1
  buffer_load_dwordx4 a[116:119], v2, s[8:11], s22 offen offset:1024 sc1
  buffer_load_dwordx4 a[120:123], v2, s[8:11], s22 offen offset:2048 sc1
  buffer_load_dwordx4 a[124:127], v2, s[8:11], s22 offen offset:3072 sc1
  s_waitcnt vmcnt(24)
  s_add_u32 s22, s31, 118784
  buffer_load_dwordx4 a[128:131], v2, s[8:11], s22 offen offset:0 sc1
  buffer_load_dwordx4 a[132:135], v2, s[8:11], s22 offen offset:1024 sc1
  buffer_load_dwordx4 a[136:139], v2, s[8:11], s22 offen offset:2048 sc1
  buffer_load_dwordx4 a[140:143], v2, s[8:11], s22 offen offset:3072 sc1
  s_add_u32 s22, s31, 122880
  buffer_load_dwordx4 a[144:147], v2, s[8:11], s22 offen offset:0 sc1
  buffer_load_dwordx4 a[148:151], v2, s[8:11], s22 offen offset:1024 sc1
  buffer_load_dwordx4 a[152:155], v2, s[8:11], s22 offen offset:2048 sc1
  buffer_load_dwordx4 a[156:159], v2, s[8:11], s22 offen offset:3072 sc1
  s_add_u32 s22, s31, 126976
  buffer_load_dwordx4 a[160:163], v2, s[8:11], s22 offen offset:0 sc1
  buffer_load_dwordx4 a[164:167], v2, s[8:11], s22 offen offset:1024 sc1
  buffer_load_dwordx4 a[168:171], v2, s[8:11], s22 offen offset:2048 sc1
  buffer_load_dwordx4 a[172:175], v2, s[8:11], s22 offen offset:3072 sc1
  s_add_u32 s22, s31, 131072
  buffer_load_dwordx4 a[176:179], v2, s[8:11], s22 offen offset:0 sc1
  buffer_load_dwordx4 a[180:183], v2, s[8:11], s22 offen offset:1024 sc1
  buffer_load_dwordx4 a[184:187], v2, s[8:11], s22 offen offset:2048 sc1
  buffer_load_dwordx4 a[188:191], v2, s[8:11], s22 offen offset:3072 sc1
  s_add_u32 s22, s31, 135168
  buffer_load_dwordx4 a[192:195], v2, s[8:11], s22 offen offset:0 sc1
  buffer_load_dwordx4 a[196:199], v2, s[8:11], s22 offen offset:1024 sc1
  buffer_load_dwordx4 a[200:203], v2, s[8:11], s22 offen offset:2048 sc1
  buffer_load_dwordx4 a[204:207], v2, s[8:11], s22 offen offset:3072 sc1
  s_add_u32 s22, s31, 139264
  buffer_load_dwordx4 a[208:211], v2, s[8:11], s22 offen offset:0 sc1
  buffer_load_dwordx4 a[212:215], v2, s[8:11], s22 offen offset:1024 sc1
  buffer_load_dwordx4 a[216:219], v2, s[8:11], s22 offen offset:2048 sc1
  buffer_load_dwordx4 a[220:223], v2, s[8:11], s22 offen offset:3072 sc1
  s_add_u32 s22, s31, 143360
  buffer_load_dwordx4 a[224:227], v2, s[8:11], s22 offen offset:0 sc1
  buffer_load_dwordx4 a[228:231], v2, s[8:11], s22 offen offset:1024 sc1
  buffer_load_dwordx4 a[232:235], v2, s[8:11], s22 offen offset:2048 sc1
  buffer_load_dwordx4 a[236:239], v2, s[8:11], s22 offen offset:3072 sc1
  s_add_u32 s22, s31, 147456
  buffer_load_dwordx4 a[240:243], v2, s[8:11], s22 offen offset:0 sc1
  buffer_load_dwordx4 a[244:247], v2, s[8:11], s22 offen offset:1024 sc1
  buffer_load_dwordx4 a[248:251], v2, s[8:11], s22 offen offset:2048 sc1
  buffer_load_dwordx4 a[252:255], v2, s[8:11], s22 offen offset:3072 sc1
  s_waitcnt vmcnt(24)
  s_add_u32 s22, s31, 151552
  buffer_load_dwordx4 v[176:179], v2, s[8:11], s22 offen offset:0 sc1
  buffer_load_dwordx4 v[180:183], v2, s[8:11], s22 offen offset:1024 sc1
  buffer_load_dwordx4 v[184:187], v2, s[8:11], s22 offen offset:2048 sc1
  buffer_load_dwordx4 v[188:191], v2, s[8:11], s22 offen offset:3072 sc1
  s_add_u32 s22, s31, 155648
  buffer_load_dwordx4 v[192:195], v2, s[8:11], s22 offen offset:0 sc1
  buffer_load_dwordx4 v[196:199], v2, s[8:11], s22 offen offset:1024 sc1
  buffer_load_dwordx4 v[200:203], v2, s[8:11], s22 offen offset:2048 sc1
  buffer_load_dwordx4 v[204:207], v2, s[8:11], s22 offen offset:3072 sc1
  s_add_u32 s22, s31, 159744
  buffer_load_dwordx4 v[208:211], v2, s[8:11], s22 offen offset:0 sc1
  buffer_load_dwordx4 v[212:215], v2, s[8:11], s22 offen offset:1024 sc1
  buffer_load_dwordx4 v[216:219], v2, s[8:11], s22 offen offset:2048 sc1
  buffer_load_dwordx4 v[220:223], v2, s[8:11], s22 offen offset:3072 sc1
  s_add_u32 s22, s31, 163840
  buffer_load_dwordx4 v[224:227], v2, s[8:11], s22 offen offset:0 sc1
  buffer_load_dwordx4 v[228:231], v2, s[8:11], s22 offen offset:1024 sc1
  buffer_load_dwordx4 v[232:235], v2, s[8:11], s22 offen offset:2048 sc1
  buffer_load_dwordx4 v[236:239], v2, s[8:11], s22 offen offset:3072 sc1
  s_add_u32 s22, s31, 167936
  buffer_load_dwordx4 v[240:243], v2, s[8:11], s22 offen offset:0 sc1
  buffer_load_dwordx4 v[244:247], v2, s[8:11], s22 offen offset:1024 sc1
  buffer_load_dwordx4 v[248:251], v2, s[8:11], s22 offen offset:2048 sc1
  buffer_load_dwordx4 v[252:255], v2, s[8:11], s22 offen offset:3072 sc1
  s_lshl_b32 s22, s17, 4
  v_mov_b32 v38, s22
  s_mul_i32 s22, s17, 12
  s_add_u32 s23, s22, 267
  s_add_u32 s22, s22, 256
  v_mov_b32 v36, s23
  v_mov_b32 v37, s22
  v_cmp_eq_u32 vcc, 1, v116
  s_nop 1
  v_cndmask_b32 v36, v36, v37, vcc
  v_med3_u32 v37, v117, 14, 15
  v_lshrrev_b32 v36, 6, v36
  v_lshlrev_b32 v36, 8, v36
  v_lshl_add_u32 v36, v37, 4, v36
  s_mov_b32 s22, 88600576
  s_mov_b32 s30, 0
va_bw_20:
  buffer_load_dwordx4 v[40:43], v36, s[8:11], s22 offen sc1
  s_waitcnt vmcnt(0)
  v_cmp_ne_u64 vcc, s[88:89], v[40:41]
  s_cbranch_vccnz va_bw_20_no
  v_cmp_ne_u64 vcc, s[88:89], v[42:43]
  s_cbranch_vccnz va_bw_20_no
  s_branch va_bw_20_ok
va_bw_20_no:
  s_sleep 2
  s_add_u32 s30, s30, 1
  s_cmp_lt_u32 s30, 50000
  s_cbranch_scc1 va_bw_20
  s_branch cA_abort
va_bw_20_ok:
  s_mov_b32 m0, 59392
  s_add_u32 s22, s31, 387072
  buffer_load_dwordx4 v2, s[8:11], s22 offen offset:0 sc1 lds
  buffer_load_dwordx4 v2, s[8:11], s22 offen offset:1024 sc1 lds
  buffer_load_dwordx4 v2, s[8:11], s22 offen offset:2048 sc1 lds
  buffer_load_dwordx4 v2, s[8:11], s22 offen offset:3072 sc1 lds
  s_mov_b32 m0, 63488
  s_add_u32 s22, s31, 391168
  buffer_load_dwordx4 v2, s[8:11], s22 offen offset:0 sc1 lds
  buffer_load_dwordx4 v2, s[8:11], s22 offen offset:1024 sc1 lds
  buffer_load_dwordx4 v2, s[8:11], s22 offen offset:2048 sc1 lds
  buffer_load_dwordx4 v2, s[8:11], s22 offen offset:3072 sc1 lds
  s_mov_b32 m0, 67584
  s_add_u32 s22, s31, 395264
  buffer_load_dwordx4 v2, s[8:11], s22 offen offset:0 sc1 lds
  buffer_load_dwordx4 v2, s[8:11], s22 offen offset:1024 sc1 lds
  buffer_load_dwordx4 v2, s[8:11], s22 offen offset:2048 sc1 lds
  buffer_load_dwordx4 v2, s[8:11], s22 offen offset:3072 sc1 lds
  s_mov_b32 m0, 71680
  s_add_u32 s22, s31, 399360
  buffer_load_dwordx4 v2, s[8:11], s22 offen offset:0 sc1 lds
  buffer_load_dwordx4 v2, s[8:11], s22 offen offset:1024 sc1 lds
  v_mov_b32 v72, v116
  v_mov_b32 v73, v117
  v_lshrrev_b32 v65, 1, v72
  v_and_b32 v66, 1, v72
  v_mov_b32 v68, 6
  v_mov_b32 v69, v73
  v_mov_b32 v70, 0
  v_and_b32 v71, 1, v69
  v_lshrrev_b32 v69, 1, v69
  v_lshl_add_u32 v69, v71, 3, v69
  v_lshlrev_b32 v71, 12, v70
  v_lshrrev_b32 v70, 1, v68
  v_lshl_add_u32 v71, v70, 9, v71
  v_and_b32 v70, 1, v68
  v_lshl_add_u32 v71, v70, 2, v71
  v_lshl_add_u32 v71, v69, 4, v71
  v_lshl_add_u32 v71, v65, 8, v71
  v_lshl_add_u32 v60, v66, 3, v71
  v_mov_b32 v68, 7
  v_mov_b32 v69, v73
  v_mov_b32 v70, 0
  v_and_b32 v71, 1, v69
  v_lshrrev_b32 v69, 1, v69
  v_lshl_add_u32 v69, v71, 3, v69
  v_lshlrev_b32 v71, 12, v70
  v_lshrrev_b32 v70, 1, v68
  v_lshl_add_u32 v71, v70, 9, v71
  v_and_b32 v70, 1, v68
  v_lshl_add_u32 v71, v70, 2, v71
  v_lshl_add_u32 v71, v69, 4, v71
  v_lshl_add_u32 v71, v65, 8, v71
  v_lshl_add_u32 v61, v66, 3, v71
  v_mov_b32 v68, 8
  v_mov_b32 v69, v73
  v_mov_b32 v70, 0
  v_and_b32 v71, 1, v69
  v_lshrrev_b32 v69, 1, v69
  v_lshl_add_u32 v69, v71, 3, v69
  v_lshlrev_b32 v71, 12, v70
  v_lshrrev_b32 v70, 1, v68
  v_lshl_add_u32 v71, v70, 9, v71
  v_and_b32 v70, 1, v68
  v_lshl_add_u32 v71, v70, 2, v71
  v_lshl_add_u32 v71, v69, 4, v71
  v_lshl_add_u32 v71, v65, 8, v71
  v_lshl_add_u32 v62, v66, 3, v71
  v_mov_b32 v68, 9
  v_mov_b32 v69, v73
  v_mov_b32 v70, 0
  v_and_b32 v71, 1, v69
  v_lshrrev_b32 v69, 1, v69
  v_lshl_add_u32 v69, v71, 3, v69
  v_lshlrev_b32 v71, 12, v70
  v_lshrrev_b32 v70, 1, v68
  v_lshl_add_u32 v71, v70, 9, v71
  v_and_b32 v70, 1, v68
  v_lshl_add_u32 v71, v70, 2, v71
  v_lshl_add_u32 v71, v69, 4, v71
  v_lshl_add_u32 v71, v65, 8, v71
  v_lshl_add_u32 v170, v66, 3, v71
  v_mov_b32 v68, 10
  v_mov_b32 v69, v73
  v_mov_b32 v70, 0
  v_and_b32 v71, 1, v69
  v_lshrrev_b32 v69, 1, v69
  v_lshl_add_u32 v69, v71, 3, v69
  v_lshlrev_b32 v71, 12, v70
  v_lshrrev_b32 v70, 1, v68
  v_lshl_add_u32 v71, v70, 9, v71
  v_and_b32 v70, 1, v68
  v_lshl_add_u32 v71, v70, 2, v71
  v_lshl_add_u32 v71, v69, 4, v71
  v_lshl_add_u32 v71, v65, 8, v71
  v_lshl_add_u32 v171, v66, 3, v71
  v_mov_b32 v68, 11
  v_mov_b32 v69, v73
  v_mov_b32 v70, 0
  v_and_b32 v71, 1, v69
  v_lshrrev_b32 v69, 1, v69
  v_lshl_add_u32 v69, v71, 3, v69
  v_lshlrev_b32 v71, 12, v70
  v_lshrrev_b32 v70, 1, v68
  v_lshl_add_u32 v71, v70, 9, v71
  v_and_b32 v70, 1, v68
  v_lshl_add_u32 v71, v70, 2, v71
  v_lshl_add_u32 v71, v69, 4, v71
  v_lshl_add_u32 v71, v65, 8, v71
  v_lshl_add_u32 v172, v66, 3, v71
  v_and_b32 v0, 31, v1
  v_lshlrev_b32 v0, 2, v0
  v_add_u32 v0, 18432, v0
  v_min_u32 v4, 15, v73
  v_lshlrev_b32 v4, 2, v4
  s_and_b32 s22, s17, 3
  s_lshl_b32 s22, s22, 7
  s_add_u32 s22, s22, 17408
  v_add_u32 v4, s22, v4
  v_and_b32 v64, 7, v73
  v_lshlrev_b32 v5, 4, v64
  v_lshl_add_u32 v5, v72, 7, v5
  v_lshrrev_b32 v65, 3, v73
  v_lshl_add_u32 v5, v65, 9, v5
  s_lshl_b32 s22, s17, 3
  s_add_u32 s22, s22, 17924
  v_mov_b32 v7, s22
  v_add_u32 v65, 16, v73
  v_min_u32 v65, 27, v65
  v_mad_u32_u24 v65, v72, 28, v65
  v_lshlrev_b32 v6, 4, v65
  s_lshr_b32 s22, s17, 1
  s_mul_i32 s22, s22, 7
  s_and_b32 s34, s17, 1
  s_lshl_b32 s35, s34, 2
  v_add_u32 v70, s35, v72
  v_mov_b32 v71, s34
  v_mov_b32 v69, 1
  v_cmp_eq_u32 vcc, 3, v72
  s_nop 1
  v_cndmask_b32 v70, v70, v72, vcc
  v_cndmask_b32 v69, v69, v71, vcc
  v_add_u32 v70, s22, v70
  v_lshrrev_b32 v68, 1, v70
  v_lshlrev_b32 v68, 8, v68
  v_lshl_add_u32 v68, v69, 7, v68
  v_and_b32 v69, 1, v70
  v_lshl_add_u32 v68, v69, 3, v68
  v_lshl_add_u32 v1, v64, 4, v68
  v_cmp_gt_u32 s[26:27], 8, v73
  v_cmp_gt_u32 vcc, 3, v72
  s_and_b64 s[26:27], s[26:27], vcc
  v_lshrrev_b32 v65, 3, v73
  v_min_u32 v66, 5, v64
  v_lshl_add_u32 v66, v66, 1, v65
  v_mad_u32_u24 v66, v72, 12, v66
  v_lshlrev_b32 v66, 4, v66
  v_add_u32 v6, 1024, v66
  s_mul_i32 s22, s17, 12
  s_add_u32 s22, s22, 256
  v_lshl_add_u32 v70, v64, 1, s22
  v_lshrrev_b32 v68, 4, v70
  v_lshlrev_b32 v68, 8, v68
  v_bfe_u32 v69, v70, 1, 1
  v_lshl_add_u32 v68, v69, 7, v68
  v_bfe_u32 v69, v70, 2, 2
  v_lshl_add_u32 v68, v69, 2, v68
  v_and_b32 v69, 1, v72
  v_lshl_add_u32 v65, v69, 2, v65
  v_lshrrev_b32 v69, 1, v72
  v_lshl_add_u32 v65, v69, 1, v65
  v_lshrrev_b32 v65, 3, v73
  v_lshl_add_u32 v65, v72, 1, v65
  v_lshrrev_b32 v5, 1, v72
  v_lshlrev_b32 v5, 9, v5
  v_lshrrev_b32 v69, 2, v73
  v_lshl_add_u32 v5, v69, 7, v5
  v_and_b32 v69, 1, v72
  v_lshl_add_u32 v5, v69, 6, v5
  v_and_b32 v69, 3, v73
  v_lshl_add_u32 v5, v69, 4, v5
  v_and_b32 v69, 1, v73
  v_mul_u32_u24 v69, 0xaaaa, v69
  v_add_u32 v0, 0x4444, v69
  v_lshl_add_u32 v1, v65, 4, v68
  v_cmp_gt_u32 s[26:27], 6, v64
  v_mov_b32 v156, 0
  v_mov_b32 v157, 0
  v_mov_b32 v158, 0
  v_mov_b32 v159, 0
  ds_write_b128 v2, v[156:159] offset:4096
  ds_write_b128 v2, v[156:159] offset:5120
  ds_write_b128 v2, v[156:159] offset:6144
  ds_write_b128 v2, v[156:159] offset:7168
  s_mul_i32 s22, s17, 1835008
  s_add_u32 s25, s22, 42205184
  s_lshl_b32 s35, s17, 7
  s_add_u32 s35, s35, 88539136
  s_add_u32 s39, s35, 16384
  s_mov_b32 s38, 0
  v_mov_b32 v63, 0
  v_bfe_u32 v8, v2, 4, 1
  v_mul_u32_u24 v3, 0xaaaa, v8
  v_add_u32 v3, 0x4444, v3
  v_bfe_u32 v9, v2, 5, 3
  v_lshl_add_u32 v8, v8, 3, v9
  v_and_b32 v9, 0x300, v2
  v_lshl_add_u32 v0, v8, 4, v9
  s_getpc_b64 s[98:99]
cpf_18:
  s_add_u32 s98, s98, cA_va1_loop-cpf_18
  s_addc_u32 s99, s99, 0
  v_lshlrev_b32 v38, 2, v2
  global_load_dword v39, v38, s[98:99]
  s_lshl_b32 s22, 0, 11
  s_add_u32 s22, s22, 88602624
  v_add_u32 v36, 1024, v2
  v_min_u32 v36, 1776, v36
  s_mov_b32 s30, 0
va_iw5:
  buffer_load_dwordx4 v[40:43], v2, s[8:11], s22 offen sc1
  buffer_load_dwordx4 v[44:47], v36, s[8:11], s22 offen sc1
  s_waitcnt vmcnt(0)
  v_cmp_ne_u64 vcc, s[88:89], v[40:41]
  s_cbranch_vccnz va_iw5_no
  v_cmp_ne_u64 vcc, s[88:89], v[42:43]
  s_cbranch_vccnz va_iw5_no
  v_cmp_ne_u64 vcc, s[88:89], v[44:45]
  s_cbranch_vccnz va_iw5_no
  v_cmp_ne_u64 vcc, s[88:89], v[46:47]
  s_cbranch_vccnz va_iw5_no
  s_branch va_iw5_ok
va_iw5_no:
  s_sleep 2
  s_add_u32 s30, s30, 1
  s_cmp_lt_u32 s30, 50000
  s_cbranch_scc1 va_iw5
  s_branch cA_abort
va_iw5_ok:
  s_mov_b32 s30, 0
  v_mov_b32 v36, 0
ch_md5:
  buffer_load_dword v37, v36, s[12:15], 0 offen sc1
  s_waitcnt vmcnt(0)
  v_readfirstlane_b32 s22, v37
  s_and_b32 s31, s22, 0xffff
  s_cmp_ge_u32 s31, 32
  s_cbranch_scc1 ch_go5
  s_sleep 2
  s_add_u32 s30, s30, 1
  s_cmp_lt_u32 s30, 50000
  s_cbranch_scc1 ch_md5
  s_branch ch_end
ch_go5:
  s_mov_b32 s31, 0
  v_mov_b32 v36, 0
  v_mov_b32 v37, 0
  v_mov_b32 v38, 0
  v_mov_b32 v39, 0
  v_mov_b32 v40, 0
  v_mov_b32 v41, 0
  v_mov_b32 v42, 0
  v_mov_b32 v43, 0
  v_mov_b32 v44, 0
  v_mov_b32 v45, 0
  v_mov_b32 v46, 0
  v_mov_b32 v47, 0
  v_mov_b32 v48, 0
  v_mov_b32 v49, 0
  v_mov_b32 v50, 0
  v_mov_b32 v51, 0
  v_mov_b32 v52, 0
  v_mov_b32 v53, 0
  v_mov_b32 v54, 0
  v_mov_b32 v55, 0
  v_mov_b32 v56, 0
  v_mov_b32 v57, 0
  v_mov_b32 v58, 0
  v_mov_b32 v59, 0
  s_lshr_b32 s22, s22, 16
  s_cmp_lg_u32 s22, 0
  s_cbranch_scc1 cB_va1_loop
  s_branch cA_va1_loop
ch_init6:
  s_mul_i32 s31, s17, 401408
  s_add_u32 s31, s31, 6422528
  s_lshl_b32 s22, s17, 4
  v_mov_b32 v38, s22
  s_mul_i32 s22, s17, 12
  s_add_u32 s23, s22, 267
  s_add_u32 s22, s22, 256
  v_mov_b32 v36, s23
  v_mov_b32 v37, s22
  v_cmp_eq_u32 vcc, 1, v116
  s_nop 1
  v_cndmask_b32 v36, v36, v37, vcc
  v_med3_u32 v37, v117, 0, 3
  v_med3_u32 v39, v117, 12, 15
  v_cmp_eq_u32 vcc, 0, v116
  s_nop 1
  v_cndmask_b32 v36, v36, v38, vcc
  v_cndmask_b32 v37, v37, v39, vcc
  v_lshrrev_b32 v36, 6, v36
  v_lshlrev_b32 v36, 8, v36
  v_lshl_add_u32 v36, v37, 4, v36
  s_mov_b32 s22, 88600576
  s_mov_b32 s30, 0
va_bw_22:
  buffer_load_dwordx4 v[40:43], v36, s[8:11], s22 offen sc1
  s_waitcnt vmcnt(0)
  v_cmp_ne_u64 vcc, s[88:89], v[40:41]
  s_cbranch_vccnz va_bw_22_no
  v_cmp_ne_u64 vcc, s[88:89], v[42:43]
  s_cbranch_vccnz va_bw_22_no
  s_branch va_bw_22_ok
va_bw_22_no:
  s_sleep 2
  s_add_u32 s30, s30, 1
  s_cmp_lt_u32 s30, 50000
  s_cbranch_scc1 va_bw_22
  s_branch cA_abort
va_bw_22_ok:
  s_add_u32 s22, s31, 172032
  buffer_load_dwordx4 a[0:3], v2, s[8:11], s22 offen offset:0 sc1
  buffer_load_dwordx4 a[4:7], v2, s[8:11], s22 offen offset:1024 sc1
  buffer_load_dwordx4 a[8:11], v2, s[8:11], s22 offen offset:2048 sc1
  buffer_load_dwordx4 a[12:15], v2, s[8:11], s22 offen offset:3072 sc1
  s_add_u32 s22, s31, 176128
  buffer_load_dwordx4 a[16:19], v2, s[8:11], s22 offen offset:0 sc1
  buffer_load_dwordx4 a[20:23], v2, s[8:11], s22 offen offset:1024 sc1
  buffer_load_dwordx4 a[24:27], v2, s[8:11], s22 offen offset:2048 sc1
  buffer_load_dwordx4 a[28:31], v2, s[8:11], s22 offen offset:3072 sc1
  s_add_u32 s22, s31, 180224
  buffer_load_dwordx4 a[32:35], v2, s[8:11], s22 offen offset:0 sc1
  buffer_load_dwordx4 a[36:39], v2, s[8:11], s22 offen offset:1024 sc1
  buffer_load_dwordx4 a[40:43], v2, s[8:11], s22 offen offset:2048 sc1
  buffer_load_dwordx4 a[44:47], v2, s[8:11], s22 offen offset:3072 sc1
  s_add_u32 s22, s31, 184320
  buffer_load_dwordx4 a[48:51], v2, s[8:11], s22 offen offset:0 sc1
  buffer_load_dwordx4 a[52:55], v2, s[8:11], s22 offen offset:1024 sc1
  buffer_load_dwordx4 a[56:59], v2, s[8:11], s22 offen offset:2048 sc1
  buffer_load_dwordx4 a[60:63], v2, s[8:11], s22 offen offset:3072 sc1
  s_add_u32 s22, s31, 188416
  buffer_load_dwordx4 a[64:67], v2, s[8:11], s22 offen offset:0 sc1
  buffer_load_dwordx4 a[68:71], v2, s[8:11], s22 offen offset:1024 sc1
  buffer_load_dwordx4 a[72:75], v2, s[8:11], s22 offen offset:2048 sc1
  buffer_load_dwordx4 a[76:79], v2, s[8:11], s22 offen offset:3072 sc1
  s_add_u32 s22, s31, 192512
  buffer_load_dwordx4 a[80:83], v2, s[8:11], s22 offen offset:0 sc1
  buffer_load_dwordx4 a[84:87], v2, s[8:11], s22 offen offset:1024 sc1
  buffer_load_dwordx4 a[88:91], v2, s[8:11], s22 offen offset:2048 sc1
  buffer_load_dwordx4 a[92:95], v2, s[8:11], s22 offen offset:3072 sc1
  s_add_u32 s22, s31, 196608
  buffer_load_dwordx4 a[96:99], v2, s[8:11], s22 offen offset:0 sc1
  buffer_load_dwordx4 a[100:103], v2, s[8:11], s22 offen offset:1024 sc1
  buffer_load_dwordx4 a[104:107], v2, s[8:11], s22 offen offset:2048 sc1
  buffer_load_dwordx4 a[108:111], v2, s[8:11], s22 offen offset:3072 sc1
  s_add_u32 s22, s31, 200704
  buffer_load_dwordx4 a[112:115], v2, s[8:11], s22 offen offset:0 sc1
  buffer_load_dwordx4 a[116:119], v2, s[8:11], s22 offen offset:1024 sc1
  buffer_load_dwordx4 a[120:123], v2, s[8:11], s22 offen offset:2048 sc1
  buffer_load_dwordx4 a[124:127], v2, s[8:11], s22 offen offset:3072 sc1
  s_waitcnt vmcnt(24)
  s_add_u32 s22, s31, 204800
  buffer_load_dwordx4 a[128:131], v2, s[8:11], s22 offen offset:0 sc1
  buffer_load_dwordx4 a[132:135], v2, s[8:11], s22 offen offset:1024 sc1
  buffer_load_dwordx4 a[136:139], v2, s[8:11], s22 offen offset:2048 sc1
  buffer_load_dwordx4 a[140:143], v2, s[8:11], s22 offen offset:3072 sc1
  s_add_u32 s22, s31, 208896
  buffer_load_dwordx4 a[144:147], v2, s[8:11], s22 offen offset:0 sc1
  buffer_load_dwordx4 a[148:151], v2, s[8:11], s22 offen offset:1024 sc1
  buffer_load_dwordx4 a[152:155], v2, s[8:11], s22 offen offset:2048 sc1
  buffer_load_dwordx4 a[156:159], v2, s[8:11], s22 offen offset:3072 sc1
  s_add_u32 s22, s31, 212992
  buffer_load_dwordx4 a[160:163], v2, s[8:11], s22 offen offset:0 sc1
  buffer_load_dwordx4 a[164:167], v2, s[8:11], s22 offen offset:1024 sc1
  buffer_load_dwordx4 a[168:171], v2, s[8:11], s22 offen offset:2048 sc1
  buffer_load_dwordx4 a[172:175], v2, s[8:11], s22 offen offset:3072 sc1
  s_add_u32 s22, s31, 217088
  buffer_load_dwordx4 a[176:179], v2, s[8:11], s22 offen offset:0 sc1
  buffer_load_dwordx4 a[180:183], v2, s[8:11], s22 offen offset:1024 sc1
  buffer_load_dwordx4 a[184:187], v2, s[8:11], s22 offen offset:2048 sc1
  buffer_load_dwordx4 a[188:191], v2, s[8:11], s22 offen offset:3072 sc1
  s_add_u32 s22, s31, 221184
  buffer_load_dwordx4 a[192:195], v2, s[8:11], s22 offen offset:0 sc1
  buffer_load_dwordx4 a[196:199], v2, s[8:11], s22 offen offset:1024 sc1
  buffer_load_dwordx4 a[200:203], v2, s[8:11], s22 offen offset:2048 sc1
  buffer_load_dwordx4 a[204:207], v2, s[8:11], s22 offen offset:3072 sc1
  s_add_u32 s22, s31, 225280
  buffer_load_dwordx4 a[208:211], v2, s[8:11], s22 offen offset:0 sc1
  buffer_load_dwordx4 a[212:215], v2, s[8:11], s22 offen offset:1024 sc1
  buffer_load_dwordx4 a[216:219], v2, s[8:11], s22 offen offset:2048 sc1
  buffer_load_dwordx4 a[220:223], v2, s[8:11], s22 offen offset:3072 sc1
  s_add_u32 s22, s31, 229376
  buffer_load_dwordx4 a[224:227], v2, s[8:11], s22 offen offset:0 sc1
  buffer_load_dwordx4 a[228:231], v2, s[8:11], s22 offen offset:1024 sc1
  buffer_load_dwordx4 a[232:235], v2, s[8:11], s22 offen offset:2048 sc1
  buffer_load_dwordx4 a[236:239], v2, s[8:11], s22 offen offset:3072 sc1
  s_add_u32 s22, s31, 233472
  buffer_load_dwordx4 a[240:243], v2, s[8:11], s22 offen offset:0 sc1
  buffer_load_dwordx4 a[244:247], v2, s[8:11], s22 offen offset:1024 sc1
  buffer_load_dwordx4 a[248:251], v2, s[8:11], s22 offen offset:2048 sc1
  buffer_load_dwordx4 a[252:255], v2, s[8:11], s22 offen offset:3072 sc1
  s_waitcnt vmcnt(24)
  s_add_u32 s22, s31, 237568
  buffer_load_dwordx4 v[120:123], v2, s[8:11], s22 offen offset:0 sc1
  buffer_load_dwordx4 v[124:127], v2, s[8:11], s22 offen offset:1024 sc1
  buffer_load_dwordx4 v[128:131], v2, s[8:11], s22 offen offset:2048 sc1
  buffer_load_dwordx4 v[132:135], v2, s[8:11], s22 offen offset:3072 sc1
  s_add_u32 s22, s31, 241664
  buffer_load_dwordx4 v[136:139], v2, s[8:11], s22 offen offset:0 sc1
  buffer_load_dwordx4 v[140:143], v2, s[8:11], s22 offen offset:1024 sc1
  buffer_load_dwordx4 v[144:147], v2, s[8:11], s22 offen offset:2048 sc1
  buffer_load_dwordx4 v[148:151], v2, s[8:11], s22 offen offset:3072 sc1
  s_add_u32 s22, s31, 245760
  buffer_load_dwordx4 v[152:155], v2, s[8:11], s22 offen offset:0 sc1
  buffer_load_dwordx4 v[156:159], v2, s[8:11], s22 offen offset:1024 sc1
  buffer_load_dwordx4 v[160:163], v2, s[8:11], s22 offen offset:2048 sc1
  buffer_load_dwordx4 v[164:167], v2, s[8:11], s22 offen offset:3072 sc1
  s_add_u32 s22, s31, 249856
  buffer_load_dwordx4 v[168:171], v2, s[8:11], s22 offen offset:0 sc1
  buffer_load_dwordx4 v[172:175], v2, s[8:11], s22 offen offset:1024 sc1
  buffer_load_dwordx4 v[176:179], v2, s[8:11], s22 offen offset:2048 sc1
  buffer_load_dwordx4 v[180:183], v2, s[8:11], s22 offen offset:3072 sc1
  s_add_u32 s22, s31, 253952
  buffer_load_dwordx4 v[184:187], v2, s[8:11], s22 offen offset:0 sc1
  buffer_load_dwordx4 v[188:191], v2, s[8:11], s22 offen offset:1024 sc1
  buffer_load_dwordx4 v[192:195], v2, s[8:11], s22 offen offset:2048 sc1
  buffer_load_dwordx4 v[196:199], v2, s[8:11], s22 offen offset:3072 sc1
  s_add_u32 s22, s31, 258048
  buffer_load_dwordx4 v[200:203], v2, s[8:11], s22 offen offset:0 sc1
  buffer_load_dwordx4 v[204:207], v2, s[8:11], s22 offen offset:1024 sc1
  buffer_load_dwordx4 v[208:211], v2, s[8:11], s22 offen offset:2048 sc1
  buffer_load_dwordx4 v[212:215], v2, s[8:11], s22 offen offset:3072 sc1
  s_add_u32 s22, s31, 262144
  buffer_load_dwordx4 v[216:219], v2, s[8:11], s22 offen offset:0 sc1
  buffer_load_dwordx4 v[220:223], v2, s[8:11], s22 offen offset:1024 sc1
  buffer_load_dwordx4 v[224:227], v2, s[8:11], s22 offen offset:2048 sc1
  buffer_load_dwordx4 v[228:231], v2, s[8:11], s22 offen offset:3072 sc1
  s_add_u32 s22, s31, 266240
  buffer_load_dwordx4 v[232:235], v2, s[8:11], s22 offen offset:0 sc1
  buffer_load_dwordx4 v[236:239], v2, s[8:11], s22 offen offset:1024 sc1
  buffer_load_dwordx4 v[240:243], v2, s[8:11], s22 offen offset:2048 sc1
  buffer_load_dwordx4 v[244:247], v2, s[8:11], s22 offen offset:3072 sc1
  s_waitcnt vmcnt(24)
  s_add_u32 s22, s31, 270336
  buffer_load_dwordx4 v[248:251], v2, s[8:11], s22 offen offset:0 sc1
  buffer_load_dwordx4 v[252:255], v2, s[8:11], s22 offen offset:1024 sc1
  v_mov_b32 v72, v116
  v_mov_b32 v73, v117
  v_lshrrev_b32 v65, 1, v72
  v_and_b32 v66, 1, v72
  v_mov_b32 v68, 12
  v_mov_b32 v69, v73
  v_mov_b32 v70, 0
  v_and_b32 v71, 1, v69
  v_lshrrev_b32 v69, 1, v69
  v_lshl_add_u32 v69, v71, 3, v69
  v_lshlrev_b32 v71, 12, v70
  v_lshrrev_b32 v70, 1, v68
  v_lshl_add_u32 v71, v70, 9, v71
  v_and_b32 v70, 1, v68
  v_lshl_add_u32 v71, v70, 2, v71
  v_lshl_add_u32 v71, v69, 4, v71
  v_lshl_add_u32 v71, v65, 8, v71
  v_lshl_add_u32 v100, v66, 3, v71
  v_mov_b32 v68, 13
  v_mov_b32 v69, v73
  v_mov_b32 v70, 0
  v_and_b32 v71, 1, v69
  v_lshrrev_b32 v69, 1, v69
  v_lshl_add_u32 v69, v71, 3, v69
  v_lshlrev_b32 v71, 12, v70
  v_lshrrev_b32 v70, 1, v68
  v_lshl_add_u32 v71, v70, 9, v71
  v_and_b32 v70, 1, v68
  v_lshl_add_u32 v71, v70, 2, v71
  v_lshl_add_u32 v71, v69, 4, v71
  v_lshl_add_u32 v71, v65, 8, v71
  v_lshl_add_u32 v101, v66, 3, v71
  v_mov_b32 v68, 14
  v_mov_b32 v69, v73
  v_mov_b32 v70, 0
  v_and_b32 v71, 1, v69
  v_lshrrev_b32 v69, 1, v69
  v_lshl_add_u32 v69, v71, 3, v69
  v_lshlrev_b32 v71, 12, v70
  v_lshrrev_b32 v70, 1, v68
  v_lshl_add_u32 v71, v70, 9, v71
  v_and_b32 v70, 1, v68
  v_lshl_add_u32 v71, v70, 2, v71
  v_lshl_add_u32 v71, v69, 4, v71
  v_lshl_add_u32 v71, v65, 8, v71
  v_lshl_add_u32 v102, v66, 3, v71
  v_mov_b32 v68, 15
  v_mov_b32 v69, v73
  v_mov_b32 v70, 0
  v_and_b32 v71, 1, v69
  v_lshrrev_b32 v69, 1, v69
  v_lshl_add_u32 v69, v71, 3, v69
  v_lshlrev_b32 v71, 12, v70
  v_lshrrev_b32 v70, 1, v68
  v_lshl_add_u32 v71, v70, 9, v71
  v_and_b32 v70, 1, v68
  v_lshl_add_u32 v71, v70, 2, v71
  v_lshl_add_u32 v71, v69, 4, v71
  v_lshl_add_u32 v71, v65, 8, v71
  v_lshl_add_u32 v103, v66, 3, v71
  v_add_u32 v67, 0, v73
  v_mul_u32_u24 v68, 5462, v67
  v_lshrrev_b32 v68, 16, v68
  v_mul_u32_u24 v69, 12, v68
  v_sub_u32 v69, v67, v69
  v_mov_b32 v70, 1
  v_and_b32 v71, 1, v69
  v_lshrrev_b32 v69, 1, v69
  v_lshl_add_u32 v69, v71, 3, v69
  v_lshlrev_b32 v71, 12, v70
  v_lshrrev_b32 v70, 1, v68
  v_lshl_add_u32 v71, v70, 9, v71
  v_and_b32 v70, 1, v68
  v_lshl_add_u32 v71, v70, 2, v71
  v_lshl_add_u32 v71, v69, 4, v71
  v_lshl_add_u32 v71, v65, 8, v71
  v_lshl_add_u32 v104, v66, 3, v71
  v_add_u32 v67, 16, v73
  v_mul_u32_u24 v68, 5462, v67
  v_lshrrev_b32 v68, 16, v68
  v_mul_u32_u24 v69, 12, v68
  v_sub_u32 v69, v67, v69
  v_mov_b32 v70, 1
  v_and_b32 v71, 1, v69
  v_lshrrev_b32 v69, 1, v69
  v_lshl_add_u32 v69, v71, 3, v69
  v_lshlrev_b32 v71, 12, v70
  v_lshrrev_b32 v70, 1, v68
  v_lshl_add_u32 v71, v70, 9, v71
  v_and_b32 v70, 1, v68
  v_lshl_add_u32 v71, v70, 2, v71
  v_lshl_add_u32 v71, v69, 4, v71
  v_lshl_add_u32 v71, v65, 8, v71
  v_lshl_add_u32 v105, v66, 3, v71
  v_add_u32 v67, 32, v73
  v_mul_u32_u24 v68, 5462, v67
  v_lshrrev_b32 v68, 16, v68
  v_mul_u32_u24 v69, 12, v68
  v_sub_u32 v69, v67, v69
  v_mov_b32 v70, 1
  v_and_b32 v71, 1, v69
  v_lshrrev_b32 v69, 1, v69
  v_lshl_add_u32 v69, v71, 3, v69
  v_lshlrev_b32 v71, 12, v70
  v_lshrrev_b32 v70, 1, v68
  v_lshl_add_u32 v71, v70, 9, v71
  v_and_b32 v70, 1, v68
  v_lshl_add_u32 v71, v70, 2, v71
  v_lshl_add_u32 v71, v69, 4, v71
  v_lshl_add_u32 v71, v65, 8, v71
  v_lshl_add_u32 v106, v66, 3, v71
  v_add_u32 v67, 48, v73
  v_mul_u32_u24 v68, 5462, v67
  v_lshrrev_b32 v68, 16, v68
  v_mul_u32_u24 v69, 12, v68
  v_sub_u32 v69, v67, v69
  v_mov_b32 v70, 1
  v_and_b32 v71, 1, v69
  v_lshrrev_b32 v69, 1, v69
  v_lshl_add_u32 v69, v71, 3, v69
  v_lshlrev_b32 v71, 12, v70
  v_lshrrev_b32 v70, 1, v68
  v_lshl_add_u32 v71, v70, 9, v71
  v_and_b32 v70, 1, v68
  v_lshl_add_u32 v71, v70, 2, v71
  v_lshl_add_u32 v71, v69, 4, v71
  v_lshl_add_u32 v71, v65, 8, v71
  v_lshl_add_u32 v107, v66, 3, v71
  s_mul_i32 s24, s17, 532480
  s_add_u32 s24, s24, 76939264
  s_mul_i32 s34, s17, 640
  s_add_u32 s34, s34, 88582144
  s_mul_i32 s36, s17, 448
  v_add_u32 v0, s36, v2
  v_add_u32 v0, 8192, v0
  s_add_u32 s36, s36, 88080384
  s_mov_b32 s37, 76939264
  v_cmp_gt_u32 s[26:27], 28, v1
  v_and_b32 v119, 31, v1
  v_lshlrev_b32 v119, 2, v119
  v_and_b32 v119, 0x78, v119
  v_or_b32 v119, 0, v119
  s_add_u32 s22, s17, 16
  s_and_b32 s22, s22, 15
  s_lshl_b32 s22, s22, 7
  s_add_u32 s22, s22, 18432
  v_add_u32 v119, s22, v119
  v_min_u32 v118, 9, v1
  s_mul_i32 s22, s17, 10
  v_add_u32 v118, s22, v118
  v_lshlrev_b32 v118, 7, v118
  v_add_u32 v118, 40960, v118
  s_mov_b32 s39, 71565312
  v_add_u32 v1, 16384, v2
  v_mov_b32 v117, 1
  s_mul_i32 s38, s17, 1104
  s_add_u32 s38, s38, 20480
  v_bfe_u32 v8, v2, 4, 1
  v_mul_u32_u24 v3, 0xaaaa, v8
  v_add_u32 v3, 0x4444, v3
  v_bfe_u32 v9, v2, 5, 3
  v_lshl_add_u32 v8, v8, 3, v9
  v_and_b32 v9, 0x300, v2
  v_lshl_add_u32 v5, v8, 4, v9
  s_getpc_b64 s[98:99]
cpf_21:
  s_add_u32 s98, s98, cA_va2_loop-cpf_21
  s_addc_u32 s99, s99, 0
  v_lshlrev_b32 v38, 2, v2
  global_load_dword v39, v38, s[98:99]
  s_lshl_b32 s22, 0, 11
  s_add_u32 s22, s22, 88602624
  v_add_u32 v36, 1024, v2
  v_min_u32 v36, 1776, v36
  s_mov_b32 s30, 0
va_iw6:
  buffer_load_dwordx4 v[40:43], v2, s[8:11], s22 offen sc1
  buffer_load_dwordx4 v[44:47], v36, s[8:11], s22 offen sc1
  s_waitcnt vmcnt(0)
  v_cmp_ne_u64 vcc, s[88:89], v[40:41]
  s_cbranch_vccnz va_iw6_no
  v_cmp_ne_u64 vcc, s[88:89], v[42:43]
  s_cbranch_vccnz va_iw6_no
  v_cmp_ne_u64 vcc, s[88:89], v[44:45]
  s_cbranch_vccnz va_iw6_no
  v_cmp_ne_u64 vcc, s[88:89], v[46:47]
  s_cbranch_vccnz va_iw6_no
  s_branch va_iw6_ok
va_iw6_no:
  s_sleep 2
  s_add_u32 s30, s30, 1
  s_cmp_lt_u32 s30, 50000
  s_cbranch_scc1 va_iw6
  s_branch cA_abort
va_iw6_ok:
  s_mov_b32 s30, 0
  v_mov_b32 v36, 0
ch_md6:
  buffer_load_dword v37, v36, s[12:15], 0 offen sc1
  s_waitcnt vmcnt(0)
  v_readfirstlane_b32 s22, v37
  s_and_b32 s31, s22, 0xffff
  s_cmp_ge_u32 s31, 32
  s_cbranch_scc1 ch_go6
  s_sleep 2
  s_add_u32 s30, s30, 1
  s_cmp_lt_u32 s30, 50000
  s_cbranch_scc1 ch_md6
  s_branch ch_end
ch_go6:
  s_mov_b32 s31, 0
  s_lshr_b32 s22, s22, 16
  s_cmp_lg_u32 s22, 0
  s_cbranch_scc1 cB_va2_loop
  s_branch cA_va2_loop
ch_init7:
  s_mul_i32 s31, s17, 401408
  s_add_u32 s31, s31, 6422528
  s_lshl_b32 s22, s17, 4
  v_mov_b32 v38, s22
  s_mul_i32 s22, s17, 12
  s_add_u32 s23, s22, 267
  s_add_u32 s22, s22, 256
  v_mov_b32 v36, s23
  v_mov_b32 v37, s22
  v_cmp_eq_u32 vcc, 1, v116
  s_nop 1
  v_cndmask_b32 v36, v36, v37, vcc
  v_med3_u32 v37, v117, 5, 14
  v_lshrrev_b32 v36, 6, v36
  v_lshlrev_b32 v36, 8, v36
  v_lshl_add_u32 v36, v37, 4, v36
  s_mov_b32 s22, 88600576
  s_mov_b32 s30, 0
va_bw_24:
  buffer_load_dwordx4 v[40:43], v36, s[8:11], s22 offen sc1
  s_waitcnt vmcnt(0)
  v_cmp_ne_u64 vcc, s[88:89], v[40:41]
  s_cbranch_vccnz va_bw_24_no
  v_cmp_ne_u64 vcc, s[88:89], v[42:43]
  s_cbranch_vccnz va_bw_24_no
  s_branch va_bw_24_ok
va_bw_24_no:
  s_sleep 2
  s_add_u32 s30, s30, 1
  s_cmp_lt_u32 s30, 50000
  s_cbranch_scc1 va_bw_24
  s_branch cA_abort
va_bw_24_ok:
  s_add_u32 s22, s31, 286720
  buffer_load_dwordx4 a[0:3], v2, s[8:11], s22 offen offset:0 sc1
  buffer_load_dwordx4 a[4:7], v2, s[8:11], s22 offen offset:1024 sc1
  buffer_load_dwordx4 a[8:11], v2, s[8:11], s22 offen offset:2048 sc1
  buffer_load_dwordx4 a[12:15], v2, s[8:11], s22 offen offset:3072 sc1
  s_add_u32 s22, s31, 290816
  buffer_load_dwordx4 a[16:19], v2, s[8:11], s22 offen offset:0 sc1
  buffer_load_dwordx4 a[20:23], v2, s[8:11], s22 offen offset:1024 sc1
  buffer_load_dwordx4 a[24:27], v2, s[8:11], s22 offen offset:2048 sc1
  buffer_load_dwordx4 a[28:31], v2, s[8:11], s22 offen offset:3072 sc1
  s_add_u32 s22, s31, 294912
  buffer_load_dwordx4 a[32:35], v2, s[8:11], s22 offen offset:0 sc1
  buffer_load_dwordx4 a[36:39], v2, s[8:11], s22 offen offset:1024 sc1
  buffer_load_dwordx4 a[40:43], v2, s[8:11], s22 offen offset:2048 sc1
  buffer_load_dwordx4 a[44:47], v2, s[8:11], s22 offen offset:3072 sc1
  s_add_u32 s22, s31, 299008
  buffer_load_dwordx4 a[48:51], v2, s[8:11], s22 offen offset:0 sc1
  buffer_load_dwordx4 a[52:55], v2, s[8:11], s22 offen offset:1024 sc1
  buffer_load_dwordx4 a[56:59], v2, s[8:11], s22 offen offset:2048 sc1
  buffer_load_dwordx4 a[60:63], v2, s[8:11], s22 offen offset:3072 sc1
  s_add_u32 s22, s31, 303104
  buffer_load_dwordx4 a[64:67], v2, s[8:11], s22 offen offset:0 sc1
  buffer_load_dwordx4 a[68:71], v2, s[8:11], s22 offen offset:1024 sc1
  buffer_load_dwordx4 a[72:75], v2, s[8:11], s22 offen offset:2048 sc1
  buffer_load_dwordx4 a[76:79], v2, s[8:11], s22 offen offset:3072 sc1
  s_add_u32 s22, s31, 307200
  buffer_load_dwordx4 a[80:83], v2, s[8:11], s22 offen offset:0 sc1
  buffer_load_dwordx4 a[84:87], v2, s[8:11], s22 offen offset:1024 sc1
  buffer_load_dwordx4 a[88:91], v2, s[8:11], s22 offen offset:2048 sc1
  buffer_load_dwordx4 a[92:95], v2, s[8:11], s22 offen offset:3072 sc1
  s_add_u32 s22, s31, 311296
  buffer_load_dwordx4 a[96:99], v2, s[8:11], s22 offen offset:0 sc1
  buffer_load_dwordx4 a[100:103], v2, s[8:11], s22 offen offset:1024 sc1
  buffer_load_dwordx4 a[104:107], v2, s[8:11], s22 offen offset:2048 sc1
  buffer_load_dwordx4 a[108:111], v2, s[8:11], s22 offen offset:3072 sc1
  s_add_u32 s22, s31, 315392
  buffer_load_dwordx4 a[112:115], v2, s[8:11], s22 offen offset:0 sc1
  buffer_load_dwordx4 a[116:119], v2, s[8:11], s22 offen offset:1024 sc1
  buffer_load_dwordx4 a[120:123], v2, s[8:11], s22 offen offset:2048 sc1
  buffer_load_dwordx4 a[124:127], v2, s[8:11], s22 offen offset:3072 sc1
  s_waitcnt vmcnt(24)
  s_add_u32 s22, s31, 319488
  buffer_load_dwordx4 a[128:131], v2, s[8:11], s22 offen offset:0 sc1
  buffer_load_dwordx4 a[132:135], v2, s[8:11], s22 offen offset:1024 sc1
  buffer_load_dwordx4 a[136:139], v2, s[8:11], s22 offen offset:2048 sc1
  buffer_load_dwordx4 a[140:143], v2, s[8:11], s22 offen offset:3072 sc1
  s_add_u32 s22, s31, 323584
  buffer_load_dwordx4 a[144:147], v2, s[8:11], s22 offen offset:0 sc1
  buffer_load_dwordx4 a[148:151], v2, s[8:11], s22 offen offset:1024 sc1
  buffer_load_dwordx4 a[152:155], v2, s[8:11], s22 offen offset:2048 sc1
  buffer_load_dwordx4 a[156:159], v2, s[8:11], s22 offen offset:3072 sc1
  s_add_u32 s22, s31, 327680
  buffer_load_dwordx4 a[160:163], v2, s[8:11], s22 offen offset:0 sc1
  buffer_load_dwordx4 a[164:167], v2, s[8:11], s22 offen offset:1024 sc1
  buffer_load_dwordx4 a[168:171], v2, s[8:11], s22 offen offset:2048 sc1
  buffer_load_dwordx4 a[172:175], v2, s[8:11], s22 offen offset:3072 sc1
  s_add_u32 s22, s31, 331776
  buffer_load_dwordx4 a[176:179], v2, s[8:11], s22 offen offset:0 sc1
  buffer_load_dwordx4 a[180:183], v2, s[8:11], s22 offen offset:1024 sc1
  buffer_load_dwordx4 a[184:187], v2, s[8:11], s22 offen offset:2048 sc1
  buffer_load_dwordx4 a[188:191], v2, s[8:11], s22 offen offset:3072 sc1
  s_add_u32 s22, s31, 335872
  buffer_load_dwordx4 a[192:195], v2, s[8:11], s22 offen offset:0 sc1
  buffer_load_dwordx4 a[196:199], v2, s[8:11], s22 offen offset:1024 sc1
  buffer_load_dwordx4 a[200:203], v2, s[8:11], s22 offen offset:2048 sc1
  buffer_load_dwordx4 a[204:207], v2, s[8:11], s22 offen offset:3072 sc1
  s_add_u32 s22, s31, 339968
  buffer_load_dwordx4 a[208:211], v2, s[8:11], s22 offen offset:0 sc1
  buffer_load_dwordx4 a[212:215], v2, s[8:11], s22 offen offset:1024 sc1
  buffer_load_dwordx4 a[216:219], v2, s[8:11], s22 offen offset:2048 sc1
  buffer_load_dwordx4 a[220:223], v2, s[8:11], s22 offen offset:3072 sc1
  s_add_u32 s22, s31, 344064
  buffer_load_dwordx4 a[224:227], v2, s[8:11], s22 offen offset:0 sc1
  buffer_load_dwordx4 a[228:231], v2, s[8:11], s22 offen offset:1024 sc1
  buffer_load_dwordx4 a[232:235], v2, s[8:11], s22 offen offset:2048 sc1
  buffer_load_dwordx4 a[236:239], v2, s[8:11], s22 offen offset:3072 sc1
  s_add_u32 s22, s31, 348160
  buffer_load_dwordx4 a[240:243], v2, s[8:11], s22 offen offset:0 sc1
  buffer_load_dwordx4 a[244:247], v2, s[8:11], s22 offen offset:1024 sc1
  buffer_load_dwordx4 a[248:251], v2, s[8:11], s22 offen offset:2048 sc1
  buffer_load_dwordx4 a[252:255], v2, s[8:11], s22 offen offset:3072 sc1
  s_waitcnt vmcnt(24)
  s_add_u32 s22, s31, 352256
  buffer_load_dwordx4 v[120:123], v2, s[8:11], s22 offen offset:0 sc1
  buffer_load_dwordx4 v[124:127], v2, s[8:11], s22 offen offset:1024 sc1
  buffer_load_dwordx4 v[128:131], v2, s[8:11], s22 offen offset:2048 sc1
  buffer_load_dwordx4 v[132:135], v2, s[8:11], s22 offen offset:3072 sc1
  s_add_u32 s22, s31, 356352
  buffer_load_dwordx4 v[136:139], v2, s[8:11], s22 offen offset:0 sc1
  buffer_load_dwordx4 v[140:143], v2, s[8:11], s22 offen offset:1024 sc1
  buffer_load_dwordx4 v[144:147], v2, s[8:11], s22 offen offset:2048 sc1
  buffer_load_dwordx4 v[148:151], v2, s[8:11], s22 offen offset:3072 sc1
  s_add_u32 s22, s31, 360448
  buffer_load_dwordx4 v[152:155], v2, s[8:11], s22 offen offset:0 sc1
  buffer_load_dwordx4 v[156:159], v2, s[8:11], s22 offen offset:1024 sc1
  buffer_load_dwordx4 v[160:163], v2, s[8:11], s22 offen offset:2048 sc1
  buffer_load_dwordx4 v[164:167], v2, s[8:11], s22 offen offset:3072 sc1
  s_add_u32 s22, s31, 364544
  buffer_load_dwordx4 v[168:171], v2, s[8:11], s22 offen offset:0 sc1
  buffer_load_dwordx4 v[172:175], v2, s[8:11], s22 offen offset:1024 sc1
  buffer_load_dwordx4 v[176:179], v2, s[8:11], s22 offen offset:2048 sc1
  buffer_load_dwordx4 v[180:183], v2, s[8:11], s22 offen offset:3072 sc1
  s_add_u32 s22, s31, 368640
  buffer_load_dwordx4 v[184:187], v2, s[8:11], s22 offen offset:0 sc1
  buffer_load_dwordx4 v[188:191], v2, s[8:11], s22 offen offset:1024 sc1
  buffer_load_dwordx4 v[192:195], v2, s[8:11], s22 offen offset:2048 sc1
  buffer_load_dwordx4 v[196:199], v2, s[8:11], s22 offen offset:3072 sc1
  s_add_u32 s22, s31, 372736
  buffer_load_dwordx4 v[200:203], v2, s[8:11], s22 offen offset:0 sc1
  buffer_load_dwordx4 v[204:207], v2, s[8:11], s22 offen offset:1024 sc1
  buffer_load_dwordx4 v[208:211], v2, s[8:11], s22 offen offset:2048 sc1
  buffer_load_dwordx4 v[212:215], v2, s[8:11], s22 offen offset:3072 sc1
  s_add_u32 s22, s31, 376832
  buffer_load_dwordx4 v[216:219], v2, s[8:11], s22 offen offset:0 sc1
  buffer_load_dwordx4 v[220:223], v2, s[8:11], s22 offen offset:1024 sc1
  buffer_load_dwordx4 v[224:227], v2, s[8:11], s22 offen offset:2048 sc1
  buffer_load_dwordx4 v[228:231], v2, s[8:11], s22 offen offset:3072 sc1
  s_add_u32 s22, s31, 380928
  buffer_load_dwordx4 v[232:235], v2, s[8:11], s22 offen offset:0 sc1
  buffer_load_dwordx4 v[236:239], v2, s[8:11], s22 offen offset:1024 sc1
  buffer_load_dwordx4 v[240:243], v2, s[8:11], s22 offen offset:2048 sc1
  buffer_load_dwordx4 v[244:247], v2, s[8:11], s22 offen offset:3072 sc1
  s_waitcnt vmcnt(24)
  s_add_u32 s22, s31, 385024
  buffer_load_dwordx4 v[248:251], v2, s[8:11], s22 offen offset:0 sc1
  buffer_load_dwordx4 v[252:255], v2, s[8:11], s22 offen offset:1024 sc1
  v_mov_b32 v72, v116
  v_mov_b32 v73, v117
  v_lshrrev_b32 v65, 1, v72
  v_and_b32 v66, 1, v72
  v_add_u32 v67, 64, v73
  v_mul_u32_u24 v68, 5462, v67
  v_lshrrev_b32 v68, 16, v68
  v_mul_u32_u24 v69, 12, v68
  v_sub_u32 v69, v67, v69
  v_mov_b32 v70, 1
  v_and_b32 v71, 1, v69
  v_lshrrev_b32 v69, 1, v69
  v_lshl_add_u32 v69, v71, 3, v69
  v_lshlrev_b32 v71, 12, v70
  v_lshrrev_b32 v70, 1, v68
  v_lshl_add_u32 v71, v70, 9, v71
  v_and_b32 v70, 1, v68
  v_lshl_add_u32 v71, v70, 2, v71
  v_lshl_add_u32 v71, v69, 4, v71
  v_lshl_add_u32 v71, v65, 8, v71
  v_lshl_add_u32 v100, v66, 3, v71
  v_add_u32 v67, 80, v73
  v_mul_u32_u24 v68, 5462, v67
  v_lshrrev_b32 v68, 16, v68
  v_mul_u32_u24 v69, 12, v68
  v_sub_u32 v69, v67, v69
  v_mov_b32 v70, 1
  v_and_b32 v71, 1, v69
  v_lshrrev_b32 v69, 1, v69
  v_lshl_add_u32 v69, v71, 3, v69
  v_lshlrev_b32 v71, 12, v70
  v_lshrrev_b32 v70, 1, v68
  v_lshl_add_u32 v71, v70, 9, v71
  v_and_b32 v70, 1, v68
  v_lshl_add_u32 v71, v70, 2, v71
  v_lshl_add_u32 v71, v69, 4, v71
  v_lshl_add_u32 v71, v65, 8, v71
  v_lshl_add_u32 v101, v66, 3, v71
  v_add_u32 v67, 96, v73
  v_mul_u32_u24 v68, 5462, v67
  v_lshrrev_b32 v68, 16, v68
  v_mul_u32_u24 v69, 12, v68
  v_sub_u32 v69, v67, v69
  v_mov_b32 v70, 1
  v_and_b32 v71, 1, v69
  v_lshrrev_b32 v69, 1, v69
  v_lshl_add_u32 v69, v71, 3, v69
  v_lshlrev_b32 v71, 12, v70
  v_lshrrev_b32 v70, 1, v68
  v_lshl_add_u32 v71, v70, 9, v71
  v_and_b32 v70, 1, v68
  v_lshl_add_u32 v71, v70, 2, v71
  v_lshl_add_u32 v71, v69, 4, v71
  v_lshl_add_u32 v71, v65, 8, v71
  v_lshl_add_u32 v102, v66, 3, v71
  v_add_u32 v67, 112, v73
  v_mul_u32_u24 v68, 5462, v67
  v_lshrrev_b32 v68, 16, v68
  v_mul_u32_u24 v69, 12, v68
  v_sub_u32 v69, v67, v69
  v_mov_b32 v70, 1
  v_and_b32 v71, 1, v69
  v_lshrrev_b32 v69, 1, v69
  v_lshl_add_u32 v69, v71, 3, v69
  v_lshlrev_b32 v71, 12, v70
  v_lshrrev_b32 v70, 1, v68
  v_lshl_add_u32 v71, v70, 9, v71
  v_and_b32 v70, 1, v68
  v_lshl_add_u32 v71, v70, 2, v71
  v_lshl_add_u32 v71, v69, 4, v71
  v_lshl_add_u32 v71, v65, 8, v71
  v_lshl_add_u32 v103, v66, 3, v71
  v_add_u32 v67, 128, v73
  v_mul_u32_u24 v68, 5462, v67
  v_lshrrev_b32 v68, 16, v68
  v_mul_u32_u24 v69, 12, v68
  v_sub_u32 v69, v67, v69
  v_mov_b32 v70, 1
  v_and_b32 v71, 1, v69
  v_lshrrev_b32 v69, 1, v69
  v_lshl_add_u32 v69, v71, 3, v69
  v_lshlrev_b32 v71, 12, v70
  v_lshrrev_b32 v70, 1, v68
  v_lshl_add_u32 v71, v70, 9, v71
  v_and_b32 v70, 1, v68
  v_lshl_add_u32 v71, v70, 2, v71
  v_lshl_add_u32 v71, v69, 4, v71
  v_lshl_add_u32 v71, v65, 8, v71
  v_lshl_add_u32 v104, v66, 3, v71
  v_add_u32 v67, 144, v73
  v_mul_u32_u24 v68, 5462, v67
  v_lshrrev_b32 v68, 16, v68
  v_mul_u32_u24 v69, 12, v68
  v_sub_u32 v69, v67, v69
  v_mov_b32 v70, 1
  v_and_b32 v71, 1, v69
  v_lshrrev_b32 v69, 1, v69
  v_lshl_add_u32 v69, v71, 3, v69
  v_lshlrev_b32 v71, 12, v70
  v_lshrrev_b32 v70, 1, v68
  v_lshl_add_u32 v71, v70, 9, v71
  v_and_b32 v70, 1, v68
  v_lshl_add_u32 v71, v70, 2, v71
  v_lshl_add_u32 v71, v69, 4, v71
  v_lshl_add_u32 v71, v65, 8, v71
  v_lshl_add_u32 v105, v66, 3, v71
  v_add_u32 v67, 160, v73
  v_mul_u32_u24 v68, 5462, v67
  v_lshrrev_b32 v68, 16, v68
  v_mul_u32_u24 v69, 12, v68
  v_sub_u32 v69, v67, v69
  v_mov_b32 v70, 1
  v_and_b32 v71, 1, v69
  v_lshrrev_b32 v69, 1, v69
  v_lshl_add_u32 v69, v71, 3, v69
  v_lshlrev_b32 v71, 12, v70
  v_lshrrev_b32 v70, 1, v68
  v_lshl_add_u32 v71, v70, 9, v71
  v_and_b32 v70, 1, v68
  v_lshl_add_u32 v71, v70, 2, v71
  v_lshl_add_u32 v71, v69, 4, v71
  v_lshl_add_u32 v71, v65, 8, v71
  v_lshl_add_u32 v106, v66, 3, v71
  v_add_u32 v67, 176, v73
  v_mul_u32_u24 v68, 5462, v67
  v_lshrrev_b32 v68, 16, v68
  v_mul_u32_u24 v69, 12, v68
  v_sub_u32 v69, v67, v69
  v_mov_b32 v70, 1
  v_and_b32 v71, 1, v69
  v_lshrrev_b32 v69, 1, v69
  v_lshl_add_u32 v69, v71, 3, v69
  v_lshlrev_b32 v71, 12, v70
  v_lshrrev_b32 v70, 1, v68
  v_lshl_add_u32 v71, v70, 9, v71
  v_and_b32 v70, 1, v68
  v_lshl_add_u32 v71, v70, 2, v71
  v_lshl_add_u32 v71, v69, 4, v71
  v_lshl_add_u32 v71, v65, 8, v71
  v_lshl_add_u32 v107, v66, 3, v71
  s_mul_i32 s24, s17, 532480
  s_add_u32 s24, s24, 76943360
  s_mul_i32 s34, s17, 640
  s_add_u32 s34, s34, 88582148
  s_mul_i32 s36, s17, 448
  v_add_u32 v0, s36, v2
  v_add_u32 v0, 8192, v0
  s_add_u32 s36, s36, 88080384
  s_mov_b32 s37, 76939264
  v_cmp_gt_u32 s[26:27], 28, v1
  v_and_b32 v119, 31, v1
  v_lshlrev_b32 v119, 2, v119
  v_and_b32 v119, 0x78, v119
  v_or_b32 v119, 4, v119
  s_add_u32 s22, s17, 16
  s_and_b32 s22, s22, 15
  s_lshl_b32 s22, s22, 7
  s_add_u32 s22, s22, 18432
  v_add_u32 v119, s22, v119
  v_min_u32 v118, 13, v1
  s_mul_i32 s22, s17, 14
  v_add_u32 v118, s22, v118
  v_lshlrev_b32 v118, 7, v118
  v_add_u32 v118, 57344, v118
  s_mov_b32 s39, 71565312
  v_add_u32 v1, 59392, v2
  v_mov_b32 v117, 1
  s_mul_i32 s38, s17, 1104
  s_add_u32 s38, s38, 21504
  v_bfe_u32 v8, v2, 4, 1
  v_mul_u32_u24 v3, 0xaaaa, v8
  v_add_u32 v3, 0x4444, v3
  v_bfe_u32 v9, v2, 5, 3
  v_lshl_add_u32 v8, v8, 3, v9
  v_and_b32 v9, 0x300, v2
  v_lshl_add_u32 v5, v8, 4, v9
  s_getpc_b64 s[98:99]
cpf_23:
  s_add_u32 s98, s98, cA_va3_loop-cpf_23
  s_addc_u32 s99, s99, 0
  v_lshlrev_b32 v38, 2, v2
  global_load_dword v39, v38, s[98:99]
  s_lshl_b32 s22, 0, 11
  s_add_u32 s22, s22, 88602624
  v_add_u32 v36, 1024, v2
  v_min_u32 v36, 1776, v36
  s_mov_b32 s30, 0
va_iw7:
  buffer_load_dwordx4 v[40:43], v2, s[8:11], s22 offen sc1
  buffer_load_dwordx4 v[44:47], v36, s[8:11], s22 offen sc1
  s_waitcnt vmcnt(0)
  v_cmp_ne_u64 vcc, s[88:89], v[40:41]
  s_cbranch_vccnz va_iw7_no
  v_cmp_ne_u64 vcc, s[88:89], v[42:43]
  s_cbranch_vccnz va_iw7_no
  v_cmp_ne_u64 vcc, s[88:89], v[44:45]
  s_cbranch_vccnz va_iw7_no
  v_cmp_ne_u64 vcc, s[88:89], v[46:47]
  s_cbranch_vccnz va_iw7_no
  s_branch va_iw7_ok
va_iw7_no:
  s_sleep 2
  s_add_u32 s30, s30, 1
  s_cmp_lt_u32 s30, 50000
  s_cbranch_scc1 va_iw7
  s_branch cA_abort
va_iw7_ok:
  s_mov_b32 s30, 0
  v_mov_b32 v36, 0
ch_md7:
  buffer_load_dword v37, v36, s[12:15], 0 offen sc1
  s_waitcnt vmcnt(0)
  v_readfirstlane_b32 s22, v37
  s_and_b32 s31, s22, 0xffff
  s_cmp_ge_u32 s31, 32
  s_cbranch_scc1 ch_go7
  s_sleep 2
  s_add_u32 s30, s30, 1
  s_cmp_lt_u32 s30, 50000
  s_cbranch_scc1 ch_md7
  s_branch ch_end
ch_go7:
  s_mov_b32 s31, 0
  s_lshr_b32 s22, s22, 16
  s_cmp_lg_u32 s22, 0
  s_cbranch_scc1 cB_va3_loop
  s_branch cA_va3_loop
.p2align 6

cA_sc0_loop:
  s_add_u32 s23, s20, 4096
  s_add_u32 s21, s20, 20480
  v_mov_b32 v48, 0
  v_mov_b32 v49, 0
  v_mov_b32 v50, 0
  v_mov_b32 v51, 0
  v_mov_b32 v52, 0
  v_mov_b32 v53, 0
  v_mov_b32 v54, 0
  v_mov_b32 v55, 0
  v_mov_b32 v56, 0
  v_mov_b32 v57, 0
  v_mov_b32 v58, 0
  v_mov_b32 v59, 0
  v_mov_b32 v60, 0
  v_mov_b32 v61, 0
  v_mov_b32 v62, 0
  v_mov_b32 v63, 0
  v_mov_b32 v88, 0
  v_mov_b32 v89, 0
  v_mov_b32 v90, 0
  v_mov_b32 v91, 0
  v_mov_b32 v92, 0
  v_mov_b32 v93, 0
  v_mov_b32 v94, 0
  v_mov_b32 v95, 0
  v_mov_b32 v66, 0
  v_mov_b32 v67, 0
  s_mov_b32 s30, 0
  s_mov_b32 s62, 0
  buffer_load_dword v68, v0, s[8:11], s20 offen sc1
  s_nop 7
  buffer_load_dword v69, v0, s[8:11], s20 offen sc1
  s_nop 7
  buffer_load_dword v70, v0, s[8:11], s20 offen sc1
  s_nop 7
  buffer_load_dword v71, v0, s[8:11], s20 offen sc1
  s_nop 7
  buffer_load_dword v72, v0, s[8:11], s20 offen sc1
cA_sc0_fp_l:
  s_waitcnt vmcnt(4)
  v_cmp_eq_u32 vcc, -1, v68
  s_cbranch_vccz cA_sc0_fp_d
  buffer_load_dword v68, v0, s[8:11], s20 offen sc1
  s_waitcnt vmcnt(4)
  v_cmp_eq_u32 vcc, -1, v69
  s_cbranch_vccz cA_sc0_fp_d
  buffer_load_dword v69, v0, s[8:11], s20 offen sc1
  s_waitcnt vmcnt(4)
  v_cmp_eq_u32 vcc, -1, v70
  s_cbranch_vccz cA_sc0_fp_d
  buffer_load_dword v70, v0, s[8:11], s20 offen sc1
  s_waitcnt vmcnt(4)
  v_cmp_eq_u32 vcc, -1, v71
  s_cbranch_vccz cA_sc0_fp_d
  buffer_load_dword v71, v0, s[8:11], s20 offen sc1
  s_waitcnt vmcnt(4)
  v_cmp_eq_u32 vcc, -1, v72
  s_cbranch_vccz cA_sc0_fp_d
  buffer_load_dword v72, v0, s[8:11], s20 offen sc1
  s_add_u32 s30, s30, 1
  s_cmp_lt_u32 s30, 400000
  s_cbranch_scc1 cA_sc0_fp_l
  s_branch cA_abort
cA_sc0_fp_d:
  buffer_load_dwordx4 v[8:11], v2, s[8:11], s20 offen offset:0
  s_barrier
  s_branch cA_sc0_ld1
cA_sc0_ld:
  buffer_load_dwordx4 v[8:11], v2, s[8:11], s20 offen offset:0
cA_sc0_ld1:
  v_mov_b32 v36, 0
  v_mov_b32 v37, 0
  v_mov_b32 v38, 0
  v_mov_b32 v39, 0
  buffer_load_dwordx4 v[12:15], v2, s[8:11], s20 offen offset:1024
  v_mov_b32 v40, 0
  v_mov_b32 v41, 0
  v_mov_b32 v42, 0
  v_mov_b32 v43, 0
  buffer_load_dwordx4 v[16:19], v2, s[8:11], s20 offen offset:2048
  v_mov_b32 v44, 0
  v_mov_b32 v45, 0
  v_mov_b32 v46, 0
  v_mov_b32 v47, 0
  ds_read_b128 v[96:99], v117 offset:0
  ds_read_b128 v[100:103], v117 offset:1024
  ds_read_b128 v[104:107], v117 offset:14336
  ds_read_b128 v[108:111], v117 offset:15360
  s_waitcnt vmcnt(2)
  v_smfmac_f32_16x16x64_bf16 v[36:39], v[8:11], a[0:7], v3
  v_smfmac_f32_16x16x64_bf16 v[40:43], v[8:11], a[56:63], v3
  buffer_load_dwordx4 v[20:23], v2, s[8:11], s20 offen offset:3072
  v_smfmac_f32_16x16x64_bf16 v[44:47], v[8:11], a[112:119], v3
  v_smfmac_f32_16x16x64_bf16 v[48:51], v[8:11], a[168:175], v3
  v_smfmac_f32_16x16x64_bf16 v[52:55], v[8:11], a[224:231], v3
  buffer_load_dwordx4 v[24:27], v2, s[8:11], s23 offen offset:0
  v_smfmac_f32_16x16x64_bf16 v[56:59], v[8:11], v[144:151], v3
  v_smfmac_f32_16x16x64_bf16 v[60:63], v[8:11], v[200:207], v3
  s_waitcnt vmcnt(3)
  v_smfmac_f32_16x16x64_bf16 v[36:39], v[12:15], a[8:15], v3
  v_smfmac_f32_16x16x64_bf16 v[40:43], v[12:15], a[64:71], v3
  buffer_load_dwordx4 v[28:31], v2, s[8:11], s23 offen offset:1024
  v_smfmac_f32_16x16x64_bf16 v[44:47], v[12:15], a[120:127], v3
  v_smfmac_f32_16x16x64_bf16 v[48:51], v[12:15], a[176:183], v3
  v_smfmac_f32_16x16x64_bf16 v[52:55], v[12:15], a[232:239], v3
  buffer_load_dwordx4 v[32:35], v2, s[8:11], s23 offen offset:2048
  v_smfmac_f32_16x16x64_bf16 v[56:59], v[12:15], v[152:159], v3
  v_smfmac_f32_16x16x64_bf16 v[60:63], v[12:15], v[208:215], v3
  s_xor_b32 s58, s25, 28672
  s_add_u32 s59, s24, 28672
  s_add_u32 m0, s58, 0
  s_waitcnt vmcnt(4)
  v_smfmac_f32_16x16x64_bf16 v[36:39], v[16:19], a[16:23], v3
  buffer_load_dwordx4 v2, s[8:11], s59 offen offset:0 sc1 lds
  v_smfmac_f32_16x16x64_bf16 v[40:43], v[16:19], a[72:79], v3
  v_smfmac_f32_16x16x64_bf16 v[44:47], v[16:19], a[128:135], v3
  v_smfmac_f32_16x16x64_bf16 v[48:51], v[16:19], a[184:191], v3
  v_smfmac_f32_16x16x64_bf16 v[52:55], v[16:19], a[240:247], v3
  buffer_load_dwordx4 v2, s[8:11], s59 offen offset:1024 sc1 lds
  v_smfmac_f32_16x16x64_bf16 v[56:59], v[16:19], v[160:167], v3
  v_smfmac_f32_16x16x64_bf16 v[60:63], v[16:19], v[216:223], v3
  s_waitcnt vmcnt(5)
  v_smfmac_f32_16x16x64_bf16 v[36:39], v[20:23], a[24:31], v3
  v_smfmac_f32_16x16x64_bf16 v[40:43], v[20:23], a[80:87], v3
  buffer_load_dwordx4 v2, s[8:11], s59 offen offset:2048 sc1 lds
  v_smfmac_f32_16x16x64_bf16 v[44:47], v[20:23], a[136:143], v3
  v_smfmac_f32_16x16x64_bf16 v[48:51], v[20:23], a[192:199], v3
  v_smfmac_f32_16x16x64_bf16 v[52:55], v[20:23], a[248:255], v3
  v_smfmac_f32_16x16x64_bf16 v[56:59], v[20:23], v[168:175], v3
  buffer_load_dwordx4 v2, s[8:11], s59 offen offset:3072 sc1 lds
  v_smfmac_f32_16x16x64_bf16 v[60:63], v[20:23], v[224:231], v3
  s_waitcnt vmcnt(4)
cA_sc0_ph2:
  v_smfmac_f32_16x16x64_bf16 v[60:63], v[24:27], v[232:239], v3
  ds_read_b128 v[12:15], v116 offset:0
  ds_read_b128 v[16:19], v116 offset:1024
  v_smfmac_f32_16x16x64_bf16 v[60:63], v[28:31], v[240:247], v3
  v_smfmac_f32_16x16x64_bf16 v[60:63], v[32:35], v[248:255], v3
  v_mov_b32 v80, v24
  v_smfmac_f32_16x16x64_bf16 v[52:55], v[24:27], v[120:127], v3
  v_mov_b32 v81, v25
  v_smfmac_f32_16x16x64_bf16 v[52:55], v[28:31], v[128:135], v3
  v_mov_b32 v82, v32
  v_smfmac_f32_16x16x64_bf16 v[52:55], v[32:35], v[136:143], v3
  v_cvt_pk_bf16_f32 v64, v60, v61
  v_smfmac_f32_16x16x64_bf16 v[56:59], v[24:27], v[176:183], v3
  v_cvt_pk_bf16_f32 v65, v62, v63
  v_smfmac_f32_16x16x64_bf16 v[56:59], v[28:31], v[184:191], v3
  v_mov_b32 v83, v33
  v_mfma_f32_16x16x32_bf16 v[68:71], v[64:67], v[4:7], 0
  v_smfmac_f32_16x16x64_bf16 v[56:59], v[32:35], v[192:199], v3
  v_cvt_pk_bf16_f32 v64, v52, v53
  v_smfmac_f32_16x16x64_bf16 v[36:39], v[24:27], a[32:39], v3
  v_cvt_pk_bf16_f32 v65, v54, v55
  v_smfmac_f32_16x16x64_bf16 v[36:39], v[28:31], a[40:47], v3
  v_cvt_pk_bf16_f32 v78, v68, v69
  v_smfmac_f32_16x16x64_bf16 v[36:39], v[32:35], a[48:55], v3
  v_cvt_pk_bf16_f32 v79, v70, v71
  v_cvt_pk_bf16_f32 v66, v56, v57
  v_smfmac_f32_16x16x64_bf16 v[40:43], v[24:27], a[88:95], v3
  v_cvt_pk_bf16_f32 v67, v58, v59
  v_smfmac_f32_16x16x64_bf16 v[40:43], v[28:31], a[96:103], v3
  v_mfma_f32_16x16x32_bf16 v[72:75], v[64:67], v[4:7], 0
  ds_read_b128 v[52:55], v116 offset:14336
  ds_read_b128 v[56:59], v116 offset:15360
  v_smfmac_f32_16x16x64_bf16 v[40:43], v[32:35], a[104:111], v3
  v_cvt_pk_bf16_f32 v64, v36, v37
  v_smfmac_f32_16x16x64_bf16 v[44:47], v[24:27], a[144:151], v3
  v_cvt_pk_bf16_f32 v65, v38, v39
  v_smfmac_f32_16x16x64_bf16 v[44:47], v[28:31], a[152:159], v3
  v_cvt_pk_bf16_f32 v76, v72, v73
  v_smfmac_f32_16x16x64_bf16 v[44:47], v[32:35], a[160:167], v3
  v_cvt_pk_bf16_f32 v77, v74, v75
  v_cvt_pk_bf16_f32 v66, v40, v41
  v_smfmac_f32_16x16x64_bf16 v[48:51], v[24:27], a[200:207], v3
  v_cvt_pk_bf16_f32 v67, v42, v43
  v_smfmac_f32_16x16x64_bf16 v[48:51], v[28:31], a[208:215], v3
  v_mfma_f32_16x16x32_bf16 v[68:71], v[64:67], v[4:7], 0
  v_smfmac_f32_16x16x64_bf16 v[48:51], v[32:35], a[216:223], v3
  v_cvt_pk_bf16_f32 v64, v44, v45
  v_mfma_f32_16x16x32_bf16 v[84:87], v[80:83], v[76:79], 0
  v_cvt_pk_bf16_f32 v65, v46, v47
  s_waitcnt lgkmcnt(0)
  v_smfmac_f32_16x16x64_bf16 v[88:91], v[76:79], v[96:103], v118
  v_cvt_pk_bf16_f32 v60, v68, v69
  v_cvt_pk_bf16_f32 v61, v70, v71
  v_cvt_pk_bf16_f32 v66, v48, v49
  v_cvt_pk_bf16_f32 v67, v50, v51
  s_nop 1
  v_mfma_f32_16x16x32_bf16 v[72:75], v[64:67], v[4:7], 0
  v_smfmac_f32_16x16x64_bf16 v[92:95], v[76:79], v[104:111], v118
  s_nop 4
  v_cvt_pk_bf16_f32 v62, v72, v73
  v_cvt_pk_bf16_f32 v63, v74, v75
  s_nop 1
  v_mfma_f32_16x16x32_bf16 v[84:87], v[8:11], v[60:63], v[84:87]
  v_smfmac_f32_16x16x64_bf16 v[88:91], v[60:63], v[12:19], v118
  v_smfmac_f32_16x16x64_bf16 v[92:95], v[60:63], v[52:59], v118
  s_nop 1
  v_permlane32_swap_b32 v84, v86
  v_permlane32_swap_b32 v85, v87
  s_nop 0
  v_add_f32 v88, v88, v89
  v_add_f32_dpp v84, v86, v84 quad_perm:[1,0,3,2] row_mask:0xf bank_mask:0xf
  v_add_f32_dpp v85, v87, v85 quad_perm:[1,0,3,2] row_mask:0xf bank_mask:0xf
  v_add_f32 v89, v90, v91
  ds_write2_b32 v113, v84, v85 offset0:0 offset1:4
  ds_write2_b32 v112, v88, v89 offset0:0 offset1:128
  v_add_f32 v90, v92, v93
  v_add_f32 v91, v94, v95
  ds_write2_b32 v112, v90, v91 offset0:64 offset1:192
  v_cmp_u_f32 vcc, v88, v89
  s_cbranch_vccnz cA_sc0_retry
cA_sc0_cont:
  s_waitcnt lgkmcnt(0)
  s_barrier
  ds_read_b128 v[36:39], v114
  ds_read_b128 v[44:47], v115
  s_waitcnt lgkmcnt(0)
  v_add_f32 v36, v36, v38
  v_add_f32 v37, v37, v39
  v_add_f32 v44, v44, v45
  buffer_store_dword v2, v119, s[8:11], s20 offen
  v_add_f32 v46, v46, v47
  v_add_f32 v44, v44, v46
  v_add_f32 v36, v36, v37
  v_exp_f32 v49, v44
  v_exp_f32 v48, v36
  v_add_f32 v50, abs(v36), abs(v44)
  v_fma_f32 v39, v49, s37, v48
  v_cmp_ngt_f32 vcc, s56, v50
  v_cndmask_b32 v41, v48, v49, s[38:39]
  v_add_f32_dpp v39, v39, v39 quad_perm:[1,0,3,2] row_mask:0xf bank_mask:0xf
  v_cndmask_b32 v40, v49, v48, s[38:39]
  v_mov_b32_dpp v46, v41 quad_perm:[1,0,3,2] row_mask:0xf bank_mask:0xf
  v_add_f32_dpp v39, v39, v39 quad_perm:[2,3,0,1] row_mask:0xf bank_mask:0xf
  v_cndmask_b32 v42, v46, v40, s[38:39]
  v_cndmask_b32 v43, v40, v46, s[38:39]
  v_add_f32_dpp v39, v39, v39 row_half_mirror row_mask:0xf bank_mask:0xf
  s_cbranch_vccnz cA_sc0_slow
  s_nop 0
  v_add_f32_dpp v47, v39, v39 row_mirror row_mask:0xf bank_mask:0xf
  v_add_f32_dpp v39, v39, v39 row_mirror row_mask:0xf bank_mask:0xf
  s_nop 1
  v_permlane16_swap_b32 v39, v47
  v_add_f32 v39, v39, v47
  v_rcp_f32 v39, v39
  s_mov_b64 exec, s[28:29]
  v_mul_f32 v42, v42, v39
  v_mul_f32 v43, v43, v39
  v_cvt_pk_bf16_f32 v42, v42, v43
cA_sc0_pst:
  buffer_store_dword v42, v1, s[8:11], s20 offen
  s_mov_b64 exec, -1
  s_barrier
  s_cmp_lg_u32 s19, 0
  s_cbranch_scc1 cA_sc0_s0
  s_sub_u32 s36, s36, 64
  v_subrev_u32 v119, 64, v119
  v_lshl_add_u32 v56, v2, 3, s36
  s_mov_b64 exec, 15
  buffer_store_dword v2, v56, s[8:11], s20 offen
  s_mov_b64 exec, -1
cA_sc0_s0:
  s_add_u32 s24, s24, 28672
  s_add_u32 s35, s35, 28672
  s_xor_b32 s25, s25, 28672
  s_add_u32 m0, s25, 0
  s_add_u32 m0, s25, 4096
  s_add_u32 s22, s24, 4096
  buffer_load_dwordx4 v2, s[8:11], s22 offen offset:0 sc1 lds
  s_nop 5
  buffer_load_dwordx4 v2, s[8:11], s22 offen offset:1024 sc1 lds
  s_nop 5
  buffer_load_dwordx4 v2, s[8:11], s22 offen offset:2048 sc1 lds
  s_nop 5
  v_xor_b32 v116, 28672, v116
  v_add_u32 v117, s57, v117
  s_sub_u32 s57, 0, s57
  s_add_u32 s19, s19, 1
  s_mov_b32 s20, s21
  s_cmp_lt_u32 s19, 63
  s_cbranch_scc1 cA_sc0_loop
  s_branch cA_done
cA_sc0_slow:
  v_max_f32 v50, v36, v44
  s_nop 1
  v_max_f32_dpp v50, v50, v50 quad_perm:[1,0,3,2] row_mask:0xf bank_mask:0xf
  s_nop 1
  v_max_f32_dpp v50, v50, v50 quad_perm:[2,3,0,1] row_mask:0xf bank_mask:0xf
  s_nop 1
  v_max_f32_dpp v50, v50, v50 row_half_mirror row_mask:0xf bank_mask:0xf
  s_nop 1
  v_max_f32_dpp v50, v50, v50 row_mirror row_mask:0xf bank_mask:0xf
  v_mov_b32 v47, v50
  s_nop 1
  v_permlane16_swap_b32 v50, v47
  v_max_f32 v50, v50, v47
  v_sub_f32 v48, v36, v50
  v_sub_f32 v49, v44, v50
  v_exp_f32 v48, v48
  v_exp_f32 v49, v49
  s_add_u32 s31, s31, 0x100
  v_fma_f32 v39, v49, s37, v48
  v_cndmask_b32 v41, v48, v49, s[38:39]
  s_nop 0
  v_add_f32_dpp v39, v39, v39 quad_perm:[1,0,3,2] row_mask:0xf bank_mask:0xf
  v_cndmask_b32 v40, v49, v48, s[38:39]
  v_mov_b32_dpp v46, v41 quad_perm:[1,0,3,2] row_mask:0xf bank_mask:0xf
  v_add_f32_dpp v39, v39, v39 quad_perm:[2,3,0,1] row_mask:0xf bank_mask:0xf
  v_cndmask_b32 v42, v46, v40, s[38:39]
  v_cndmask_b32 v43, v40, v46, s[38:39]
  v_add_f32_dpp v39, v39, v39 row_half_mirror row_mask:0xf bank_mask:0xf
  s_nop 1
  v_add_f32_dpp v47, v39, v39 row_mirror row_mask:0xf bank_mask:0xf
  v_add_f32_dpp v39, v39, v39 row_mirror row_mask:0xf bank_mask:0xf
  s_nop 1
  v_permlane16_swap_b32 v39, v47
  v_add_f32 v39, v39, v47
  v_rcp_f32 v39, v39
  s_mov_b64 exec, s[28:29]
  v_mul_f32 v42, v42, v39
  v_mul_f32 v43, v43, v39
  v_cvt_pk_bf16_f32 v42, v42, v43
  v_min_u32 v42, -2, v42
  s_branch cA_sc0_pst
cA_sc0_retry:
  s_cmp_lg_u32 s62, 0
  s_cbranch_scc1 cA_sc0_cont
  s_waitcnt vmcnt(0) lgkmcnt(0)
cA_sc0_rv:
  buffer_load_dwordx4 v[8:11], v2, s[8:11], s20 offen offset:0 sc1
  buffer_load_dwordx4 v[12:15], v2, s[8:11], s20 offen offset:1024 sc1
  buffer_load_dwordx4 v[16:19], v2, s[8:11], s20 offen offset:2048 sc1
  buffer_load_dwordx4 v[20:23], v2, s[8:11], s20 offen offset:3072 sc1
  buffer_load_dwordx4 v[24:27], v2, s[8:11], s23 offen offset:0 sc1
  buffer_load_dwordx4 v[28:31], v2, s[8:11], s23 offen offset:1024 sc1
  buffer_load_dwordx4 v[32:35], v2, s[8:11], s23 offen offset:2048 sc1
  s_waitcnt vmcnt(0)
  v_max3_u32 v68, v8, v9, v10
  v_max3_u32 v68, v68, v11, v12
  v_max3_u32 v68, v68, v13, v14
  v_max3_u32 v68, v68, v15, v16
  v_max3_u32 v68, v68, v17, v18
  v_max3_u32 v68, v68, v19, v20
  v_max3_u32 v68, v68, v21, v22
  v_max3_u32 v68, v68, v23, v24
  v_max3_u32 v68, v68, v25, v26
  v_max3_u32 v68, v68, v27, v28
  v_max3_u32 v68, v68, v29, v30
  v_max3_u32 v68, v68, v31, v32
  v_max3_u32 v68, v68, v33, v34
  v_max_u32 v68, v68, v35
  v_cmp_eq_u32 vcc, -1, v68
  s_cbranch_vccz cA_sc0_rk
  s_add_u32 s30, s30, 1
  s_cmp_lt_u32 s30, 400000
  s_cbranch_scc1 cA_sc0_rv
  s_branch cA_abort
cA_sc0_rk:
  s_mov_b32 s62, 1
  v_mov_b32 v36, 0
  v_mov_b32 v37, 0
  v_mov_b32 v38, 0
  v_mov_b32 v39, 0
  v_mov_b32 v40, 0
  v_mov_b32 v41, 0
  v_mov_b32 v42, 0
  v_mov_b32 v43, 0
  v_mov_b32 v44, 0
  v_mov_b32 v45, 0
  v_mov_b32 v46, 0
  v_mov_b32 v47, 0
  v_mov_b32 v48, 0
  v_mov_b32 v49, 0
  v_mov_b32 v50, 0
  v_mov_b32 v51, 0
  v_mov_b32 v52, 0
  v_mov_b32 v53, 0
  v_mov_b32 v54, 0
  v_mov_b32 v55, 0
  v_mov_b32 v56, 0
  v_mov_b32 v57, 0
  v_mov_b32 v58, 0
  v_mov_b32 v59, 0
  v_mov_b32 v60, 0
  v_mov_b32 v61, 0
  v_mov_b32 v62, 0
  v_mov_b32 v63, 0
  v_mov_b32 v88, 0
  v_mov_b32 v89, 0
  v_mov_b32 v90, 0
  v_mov_b32 v91, 0
  v_mov_b32 v92, 0
  v_mov_b32 v93, 0
  v_mov_b32 v94, 0
  v_mov_b32 v95, 0
  v_mov_b32 v66, 0
  v_mov_b32 v67, 0
  s_add_u32 s31, s31, 1
  ds_read_b128 v[96:99], v117 offset:0
  ds_read_b128 v[100:103], v117 offset:1024
  ds_read_b128 v[104:107], v117 offset:14336
  ds_read_b128 v[108:111], v117 offset:15360
  v_smfmac_f32_16x16x64_bf16 v[36:39], v[8:11], a[0:7], v3
  v_smfmac_f32_16x16x64_bf16 v[40:43], v[8:11], a[56:63], v3
  v_smfmac_f32_16x16x64_bf16 v[44:47], v[8:11], a[112:119], v3
  v_smfmac_f32_16x16x64_bf16 v[48:51], v[8:11], a[168:175], v3
  v_smfmac_f32_16x16x64_bf16 v[52:55], v[8:11], a[224:231], v3
  v_smfmac_f32_16x16x64_bf16 v[56:59], v[8:11], v[144:151], v3
  v_smfmac_f32_16x16x64_bf16 v[60:63], v[8:11], v[200:207], v3
  v_smfmac_f32_16x16x64_bf16 v[36:39], v[12:15], a[8:15], v3
  v_smfmac_f32_16x16x64_bf16 v[40:43], v[12:15], a[64:71], v3
  v_smfmac_f32_16x16x64_bf16 v[44:47], v[12:15], a[120:127], v3
  v_smfmac_f32_16x16x64_bf16 v[48:51], v[12:15], a[176:183], v3
  v_smfmac_f32_16x16x64_bf16 v[52:55], v[12:15], a[232:239], v3
  v_smfmac_f32_16x16x64_bf16 v[56:59], v[12:15], v[152:159], v3
  v_smfmac_f32_16x16x64_bf16 v[60:63], v[12:15], v[208:215], v3
  v_smfmac_f32_16x16x64_bf16 v[36:39], v[16:19], a[16:23], v3
  v_smfmac_f32_16x16x64_bf16 v[40:43], v[16:19], a[72:79], v3
  v_smfmac_f32_16x16x64_bf16 v[44:47], v[16:19], a[128:135], v3
  v_smfmac_f32_16x16x64_bf16 v[48:51], v[16:19], a[184:191], v3
  v_smfmac_f32_16x16x64_bf16 v[52:55], v[16:19], a[240:247], v3
  v_smfmac_f32_16x16x64_bf16 v[56:59], v[16:19], v[160:167], v3
  v_smfmac_f32_16x16x64_bf16 v[60:63], v[16:19], v[216:223], v3
  v_smfmac_f32_16x16x64_bf16 v[36:39], v[20:23], a[24:31], v3
  v_smfmac_f32_16x16x64_bf16 v[40:43], v[20:23], a[80:87], v3
  v_smfmac_f32_16x16x64_bf16 v[44:47], v[20:23], a[136:143], v3
  v_smfmac_f32_16x16x64_bf16 v[48:51], v[20:23], a[192:199], v3
  v_smfmac_f32_16x16x64_bf16 v[52:55], v[20:23], a[248:255], v3
  v_smfmac_f32_16x16x64_bf16 v[56:59], v[20:23], v[168:175], v3
  v_smfmac_f32_16x16x64_bf16 v[60:63], v[20:23], v[224:231], v3
  s_xor_b32 s58, s25, 28672
  s_add_u32 s59, s24, 28672
  s_add_u32 m0, s58, 0
  s_branch cA_sc0_ph2
.p2align 6

cA_sc1_loop:
  s_add_u32 s23, s20, 4096
  s_add_u32 s21, s20, 20480
  v_mov_b32 v48, 0
  v_mov_b32 v49, 0
  v_mov_b32 v50, 0
  v_mov_b32 v51, 0
  v_mov_b32 v52, 0
  v_mov_b32 v53, 0
  v_mov_b32 v54, 0
  v_mov_b32 v55, 0
  v_mov_b32 v56, 0
  v_mov_b32 v57, 0
  v_mov_b32 v58, 0
  v_mov_b32 v59, 0
  v_mov_b32 v60, 0
  v_mov_b32 v61, 0
  v_mov_b32 v62, 0
  v_mov_b32 v63, 0
  v_mov_b32 v88, 0
  v_mov_b32 v89, 0
  v_mov_b32 v90, 0
  v_mov_b32 v91, 0
  v_mov_b32 v92, 0
  v_mov_b32 v93, 0
  v_mov_b32 v94, 0
  v_mov_b32 v95, 0
  v_mov_b32 v64, 0
  v_mov_b32 v65, 0
  s_mov_b32 s30, 0
  s_mov_b32 s62, 0
  s_waitcnt vmcnt(0)
  s_barrier
cA_sc1_ld:
  buffer_load_dwordx4 v[8:11], v2, s[8:11], s20 offen offset:0
  v_mov_b32 v36, 0
  v_mov_b32 v37, 0
  v_mov_b32 v38, 0
  v_mov_b32 v39, 0
  buffer_load_dwordx4 v[12:15], v2, s[8:11], s20 offen offset:1024
  v_mov_b32 v40, 0
  v_mov_b32 v41, 0
  v_mov_b32 v42, 0
  v_mov_b32 v43, 0
  buffer_load_dwordx4 v[16:19], v2, s[8:11], s20 offen offset:2048
  v_mov_b32 v44, 0
  v_mov_b32 v45, 0
  v_mov_b32 v46, 0
  v_mov_b32 v47, 0
  ds_read_b128 v[96:99], v117 offset:0
  ds_read_b128 v[100:103], v117 offset:1024
  ds_read_b128 v[104:107], v117 offset:14336
  ds_read_b128 v[108:111], v117 offset:15360
  s_waitcnt vmcnt(2)
  v_smfmac_f32_16x16x64_bf16 v[36:39], v[8:11], a[0:7], v3
  v_smfmac_f32_16x16x64_bf16 v[40:43], v[8:11], a[56:63], v3
  buffer_load_dwordx4 v[20:23], v2, s[8:11], s20 offen offset:3072
  v_smfmac_f32_16x16x64_bf16 v[44:47], v[8:11], a[112:119], v3
  v_smfmac_f32_16x16x64_bf16 v[48:51], v[8:11], a[168:175], v3
  v_smfmac_f32_16x16x64_bf16 v[52:55], v[8:11], a[224:231], v3
  buffer_load_dwordx4 v[24:27], v2, s[8:11], s23 offen offset:0
  v_smfmac_f32_16x16x64_bf16 v[56:59], v[8:11], v[144:151], v3
  v_smfmac_f32_16x16x64_bf16 v[60:63], v[8:11], v[200:207], v3
  s_waitcnt vmcnt(3)
  v_smfmac_f32_16x16x64_bf16 v[36:39], v[12:15], a[8:15], v3
  v_smfmac_f32_16x16x64_bf16 v[40:43], v[12:15], a[64:71], v3
  buffer_load_dwordx4 v[28:31], v2, s[8:11], s23 offen offset:1024
  v_smfmac_f32_16x16x64_bf16 v[44:47], v[12:15], a[120:127], v3
  v_smfmac_f32_16x16x64_bf16 v[48:51], v[12:15], a[176:183], v3
  v_smfmac_f32_16x16x64_bf16 v[52:55], v[12:15], a[232:239], v3
  buffer_load_dwordx4 v[32:35], v2, s[8:11], s23 offen offset:2048
  v_smfmac_f32_16x16x64_bf16 v[56:59], v[12:15], v[152:159], v3
  v_smfmac_f32_16x16x64_bf16 v[60:63], v[12:15], v[208:215], v3
  s_waitcnt vmcnt(4)
  v_smfmac_f32_16x16x64_bf16 v[36:39], v[16:19], a[16:23], v3
  s_xor_b32 s58, s25, 28672
  s_add_u32 s59, s24, 28672
  s_add_u32 m0, s58, 7168
  v_smfmac_f32_16x16x64_bf16 v[40:43], v[16:19], a[72:79], v3
  buffer_load_dwordx4 v2, s[8:11], s59 offen offset:0 sc1 lds
  v_smfmac_f32_16x16x64_bf16 v[44:47], v[16:19], a[128:135], v3
  v_smfmac_f32_16x16x64_bf16 v[48:51], v[16:19], a[184:191], v3
  v_smfmac_f32_16x16x64_bf16 v[52:55], v[16:19], a[240:247], v3
  v_smfmac_f32_16x16x64_bf16 v[56:59], v[16:19], v[160:167], v3
  buffer_load_dwordx4 v2, s[8:11], s59 offen offset:1024 sc1 lds
  v_smfmac_f32_16x16x64_bf16 v[60:63], v[16:19], v[216:223], v3
  s_waitcnt vmcnt(5)
  v_smfmac_f32_16x16x64_bf16 v[36:39], v[20:23], a[24:31], v3
  v_smfmac_f32_16x16x64_bf16 v[40:43], v[20:23], a[80:87], v3
  v_smfmac_f32_16x16x64_bf16 v[44:47], v[20:23], a[136:143], v3
  buffer_load_dwordx4 v2, s[8:11], s59 offen offset:2048 sc1 lds
  v_smfmac_f32_16x16x64_bf16 v[48:51], v[20:23], a[192:199], v3
  v_smfmac_f32_16x16x64_bf16 v[52:55], v[20:23], a[248:255], v3
  v_smfmac_f32_16x16x64_bf16 v[56:59], v[20:23], v[168:175], v3
  v_smfmac_f32_16x16x64_bf16 v[60:63], v[20:23], v[224:231], v3
  buffer_load_dwordx4 v2, s[8:11], s59 offen offset:3072 sc1 lds
  s_waitcnt vmcnt(4)
cA_sc1_ph2:
  v_smfmac_f32_16x16x64_bf16 v[60:63], v[24:27], v[232:239], v3
  ds_read_b128 v[16:19], v116 offset:2048
  ds_read_b128 v[20:23], v116 offset:3072
  v_smfmac_f32_16x16x64_bf16 v[60:63], v[28:31], v[240:247], v3
  buffer_load_dword v119, v0, s[8:11], s20 offen sc1
  v_smfmac_f32_16x16x64_bf16 v[60:63], v[32:35], v[248:255], v3
  v_mov_b32 v80, v26
  v_smfmac_f32_16x16x64_bf16 v[52:55], v[24:27], v[120:127], v3
  v_mov_b32 v81, v27
  v_smfmac_f32_16x16x64_bf16 v[52:55], v[28:31], v[128:135], v3
  v_mov_b32 v82, v32
  v_smfmac_f32_16x16x64_bf16 v[52:55], v[32:35], v[136:143], v3
  v_cvt_pk_bf16_f32 v66, v60, v61
  v_smfmac_f32_16x16x64_bf16 v[56:59], v[24:27], v[176:183], v3
  v_cvt_pk_bf16_f32 v67, v62, v63
  v_smfmac_f32_16x16x64_bf16 v[56:59], v[28:31], v[184:191], v3
  v_mov_b32 v83, v33
  v_mfma_f32_16x16x32_bf16 v[68:71], v[64:67], v[4:7], 0
  v_smfmac_f32_16x16x64_bf16 v[56:59], v[32:35], v[192:199], v3
  v_cvt_pk_bf16_f32 v64, v52, v53
  v_smfmac_f32_16x16x64_bf16 v[36:39], v[24:27], a[32:39], v3
  v_cvt_pk_bf16_f32 v65, v54, v55
  v_smfmac_f32_16x16x64_bf16 v[36:39], v[28:31], a[40:47], v3
  v_cvt_pk_bf16_f32 v78, v68, v69
  v_smfmac_f32_16x16x64_bf16 v[36:39], v[32:35], a[48:55], v3
  v_cvt_pk_bf16_f32 v79, v70, v71
  v_cvt_pk_bf16_f32 v66, v56, v57
  v_smfmac_f32_16x16x64_bf16 v[40:43], v[24:27], a[88:95], v3
  v_cvt_pk_bf16_f32 v67, v58, v59
  v_smfmac_f32_16x16x64_bf16 v[40:43], v[28:31], a[96:103], v3
  v_mfma_f32_16x16x32_bf16 v[72:75], v[64:67], v[4:7], 0
  ds_read_b128 v[52:55], v116 offset:16384
  ds_read_b128 v[56:59], v116 offset:17408
  v_smfmac_f32_16x16x64_bf16 v[40:43], v[32:35], a[104:111], v3
  v_cvt_pk_bf16_f32 v64, v36, v37
  v_smfmac_f32_16x16x64_bf16 v[44:47], v[24:27], a[144:151], v3
  v_cvt_pk_bf16_f32 v65, v38, v39
  v_smfmac_f32_16x16x64_bf16 v[44:47], v[28:31], a[152:159], v3
  v_cvt_pk_bf16_f32 v76, v72, v73
  v_smfmac_f32_16x16x64_bf16 v[44:47], v[32:35], a[160:167], v3
  v_cvt_pk_bf16_f32 v77, v74, v75
  v_cvt_pk_bf16_f32 v66, v40, v41
  v_smfmac_f32_16x16x64_bf16 v[48:51], v[24:27], a[200:207], v3
  v_cvt_pk_bf16_f32 v67, v42, v43
  v_smfmac_f32_16x16x64_bf16 v[48:51], v[28:31], a[208:215], v3
  v_mfma_f32_16x16x32_bf16 v[68:71], v[64:67], v[4:7], 0
  v_smfmac_f32_16x16x64_bf16 v[48:51], v[32:35], a[216:223], v3
  v_cvt_pk_bf16_f32 v64, v44, v45
  v_mfma_f32_16x16x32_bf16 v[84:87], v[80:83], v[76:79], 0
  v_cvt_pk_bf16_f32 v65, v46, v47
  s_waitcnt lgkmcnt(0)
  v_smfmac_f32_16x16x64_bf16 v[88:91], v[76:79], v[96:103], v118
  v_cvt_pk_bf16_f32 v60, v68, v69
  v_cvt_pk_bf16_f32 v61, v70, v71
  v_cvt_pk_bf16_f32 v66, v48, v49
  v_cvt_pk_bf16_f32 v67, v50, v51
  s_nop 1
  v_mfma_f32_16x16x32_bf16 v[72:75], v[64:67], v[4:7], 0
  v_smfmac_f32_16x16x64_bf16 v[92:95], v[76:79], v[104:111], v118
  s_nop 4
  v_cvt_pk_bf16_f32 v62, v72, v73
  v_cvt_pk_bf16_f32 v63, v74, v75
  s_nop 1
  v_mfma_f32_16x16x32_bf16 v[84:87], v[12:15], v[60:63], v[84:87]
  v_smfmac_f32_16x16x64_bf16 v[88:91], v[60:63], v[16:23], v118
  v_smfmac_f32_16x16x64_bf16 v[92:95], v[60:63], v[52:59], v118
  s_nop 1
  v_permlane32_swap_b32 v84, v86
  v_permlane32_swap_b32 v85, v87
  s_nop 0
  v_add_f32 v88, v88, v89
  v_add_f32_dpp v84, v86, v84 quad_perm:[1,0,3,2] row_mask:0xf bank_mask:0xf
  v_add_f32_dpp v85, v87, v85 quad_perm:[1,0,3,2] row_mask:0xf bank_mask:0xf
  v_add_f32 v89, v90, v91
  ds_write2_b32 v113, v84, v85 offset0:0 offset1:4
  ds_write2_b32 v112, v88, v89 offset0:0 offset1:128
  v_add_f32 v90, v92, v93
  v_add_f32 v91, v94, v95
  ds_write2_b32 v112, v90, v91 offset0:64 offset1:192
  v_cmp_u_f32 vcc, v88, v89
  s_cbranch_vccnz cA_sc1_retry
cA_sc1_cont:
  s_waitcnt lgkmcnt(0)
  s_barrier
  ds_read_b128 v[36:39], v114
  ds_read_b128 v[44:47], v115
  s_waitcnt lgkmcnt(0)
  v_add_f32 v36, v36, v38
  v_add_f32 v37, v37, v39
  v_add_f32 v44, v44, v45
  v_add_f32 v46, v46, v47
  v_add_f32 v44, v44, v46
  v_add_f32 v36, v36, v37
  v_exp_f32 v49, v44
  v_exp_f32 v48, v36
  v_add_f32 v50, abs(v36), abs(v44)
  v_fma_f32 v39, v49, s37, v48
  v_cmp_ngt_f32 vcc, s56, v50
  v_cndmask_b32 v41, v48, v49, s[38:39]
  v_add_f32_dpp v39, v39, v39 quad_perm:[1,0,3,2] row_mask:0xf bank_mask:0xf
  v_cndmask_b32 v40, v49, v48, s[38:39]
  v_mov_b32_dpp v46, v41 quad_perm:[1,0,3,2] row_mask:0xf bank_mask:0xf
  v_add_f32_dpp v39, v39, v39 quad_perm:[2,3,0,1] row_mask:0xf bank_mask:0xf
  v_cndmask_b32 v42, v46, v40, s[38:39]
  v_cndmask_b32 v43, v40, v46, s[38:39]
  v_add_f32_dpp v39, v39, v39 row_half_mirror row_mask:0xf bank_mask:0xf
  s_cbranch_vccnz cA_sc1_slow
  s_nop 0
  v_add_f32_dpp v47, v39, v39 row_mirror row_mask:0xf bank_mask:0xf
  v_add_f32_dpp v39, v39, v39 row_mirror row_mask:0xf bank_mask:0xf
  s_nop 1
  v_permlane16_swap_b32 v39, v47
  v_add_f32 v39, v39, v47
  v_rcp_f32 v39, v39
  s_mov_b64 exec, s[28:29]
  v_mul_f32 v42, v42, v39
  v_mul_f32 v43, v43, v39
  v_cvt_pk_bf16_f32 v42, v42, v43
cA_sc1_pst:
  buffer_store_dword v42, v1, s[8:11], s20 offen
  s_mov_b64 exec, -1
  s_barrier
  s_add_u32 s24, s24, 28672
  s_add_u32 s35, s35, 28672
  s_xor_b32 s25, s25, 28672
  s_add_u32 m0, s25, 7168
  s_add_u32 m0, s25, 11264
  s_add_u32 s22, s24, 4096
  buffer_load_dwordx4 v2, s[8:11], s22 offen offset:0 sc1 lds
  s_nop 5
  buffer_load_dwordx4 v2, s[8:11], s22 offen offset:1024 sc1 lds
  s_nop 5
  buffer_load_dwordx4 v2, s[8:11], s22 offen offset:2048 sc1 lds
  s_nop 5
  v_xor_b32 v116, 28672, v116
  v_add_u32 v117, s57, v117
  s_sub_u32 s57, 0, s57
  s_add_u32 s19, s19, 1
  s_mov_b32 s20, s21
  s_cmp_lt_u32 s19, 63
  s_cbranch_scc1 cA_sc1_loop
  s_branch cA_done
cA_sc1_slow:
  v_max_f32 v50, v36, v44
  s_nop 1
  v_max_f32_dpp v50, v50, v50 quad_perm:[1,0,3,2] row_mask:0xf bank_mask:0xf
  s_nop 1
  v_max_f32_dpp v50, v50, v50 quad_perm:[2,3,0,1] row_mask:0xf bank_mask:0xf
  s_nop 1
  v_max_f32_dpp v50, v50, v50 row_half_mirror row_mask:0xf bank_mask:0xf
  s_nop 1
  v_max_f32_dpp v50, v50, v50 row_mirror row_mask:0xf bank_mask:0xf
  v_mov_b32 v47, v50
  s_nop 1
  v_permlane16_swap_b32 v50, v47
  v_max_f32 v50, v50, v47
  v_sub_f32 v48, v36, v50
  v_sub_f32 v49, v44, v50
  v_exp_f32 v48, v48
  v_exp_f32 v49, v49
  s_add_u32 s31, s31, 0x100
  v_fma_f32 v39, v49, s37, v48
  v_cndmask_b32 v41, v48, v49, s[38:39]
  s_nop 0
  v_add_f32_dpp v39, v39, v39 quad_perm:[1,0,3,2] row_mask:0xf bank_mask:0xf
  v_cndmask_b32 v40, v49, v48, s[38:39]
  v_mov_b32_dpp v46, v41 quad_perm:[1,0,3,2] row_mask:0xf bank_mask:0xf
  v_add_f32_dpp v39, v39, v39 quad_perm:[2,3,0,1] row_mask:0xf bank_mask:0xf
  v_cndmask_b32 v42, v46, v40, s[38:39]
  v_cndmask_b32 v43, v40, v46, s[38:39]
  v_add_f32_dpp v39, v39, v39 row_half_mirror row_mask:0xf bank_mask:0xf
  s_nop 1
  v_add_f32_dpp v47, v39, v39 row_mirror row_mask:0xf bank_mask:0xf
  v_add_f32_dpp v39, v39, v39 row_mirror row_mask:0xf bank_mask:0xf
  s_nop 1
  v_permlane16_swap_b32 v39, v47
  v_add_f32 v39, v39, v47
  v_rcp_f32 v39, v39
  s_mov_b64 exec, s[28:29]
  v_mul_f32 v42, v42, v39
  v_mul_f32 v43, v43, v39
  v_cvt_pk_bf16_f32 v42, v42, v43
  v_min_u32 v42, -2, v42
  s_branch cA_sc1_pst
cA_sc1_retry:
  s_cmp_lg_u32 s62, 0
  s_cbranch_scc1 cA_sc1_cont
  s_waitcnt vmcnt(0) lgkmcnt(0)
cA_sc1_rv:
  buffer_load_dwordx4 v[8:11], v2, s[8:11], s20 offen offset:0 sc1
  buffer_load_dwordx4 v[12:15], v2, s[8:11], s20 offen offset:1024 sc1
  buffer_load_dwordx4 v[16:19], v2, s[8:11], s20 offen offset:2048 sc1
  buffer_load_dwordx4 v[20:23], v2, s[8:11], s20 offen offset:3072 sc1
  buffer_load_dwordx4 v[24:27], v2, s[8:11], s23 offen offset:0 sc1
  buffer_load_dwordx4 v[28:31], v2, s[8:11], s23 offen offset:1024 sc1
  buffer_load_dwordx4 v[32:35], v2, s[8:11], s23 offen offset:2048 sc1
  s_waitcnt vmcnt(0)
  v_max3_u32 v68, v8, v9, v10
  v_max3_u32 v68, v68, v11, v12
  v_max3_u32 v68, v68, v13, v14
  v_max3_u32 v68, v68, v15, v16
  v_max3_u32 v68, v68, v17, v18
  v_max3_u32 v68, v68, v19, v20
  v_max3_u32 v68, v68, v21, v22
  v_max3_u32 v68, v68, v23, v24
  v_max3_u32 v68, v68, v25, v26
  v_max3_u32 v68, v68, v27, v28
  v_max3_u32 v68, v68, v29, v30
  v_max3_u32 v68, v68, v31, v32
  v_max3_u32 v68, v68, v33, v34
  v_max_u32 v68, v68, v35
  v_cmp_eq_u32 vcc, -1, v68
  s_cbranch_vccz cA_sc1_rk
  s_add_u32 s30, s30, 1
  s_cmp_lt_u32 s30, 400000
  s_cbranch_scc1 cA_sc1_rv
  s_branch cA_abort
cA_sc1_rk:
  s_mov_b32 s62, 1
  v_mov_b32 v36, 0
  v_mov_b32 v37, 0
  v_mov_b32 v38, 0
  v_mov_b32 v39, 0
  v_mov_b32 v40, 0
  v_mov_b32 v41, 0
  v_mov_b32 v42, 0
  v_mov_b32 v43, 0
  v_mov_b32 v44, 0
  v_mov_b32 v45, 0
  v_mov_b32 v46, 0
  v_mov_b32 v47, 0
  v_mov_b32 v48, 0
  v_mov_b32 v49, 0
  v_mov_b32 v50, 0
  v_mov_b32 v51, 0
  v_mov_b32 v52, 0
  v_mov_b32 v53, 0
  v_mov_b32 v54, 0
  v_mov_b32 v55, 0
  v_mov_b32 v56, 0
  v_mov_b32 v57, 0
  v_mov_b32 v58, 0
  v_mov_b32 v59, 0
  v_mov_b32 v60, 0
  v_mov_b32 v61, 0
  v_mov_b32 v62, 0
  v_mov_b32 v63, 0
  v_mov_b32 v88, 0
  v_mov_b32 v89, 0
  v_mov_b32 v90, 0
  v_mov_b32 v91, 0
  v_mov_b32 v92, 0
  v_mov_b32 v93, 0
  v_mov_b32 v94, 0
  v_mov_b32 v95, 0
  v_mov_b32 v64, 0
  v_mov_b32 v65, 0
  s_add_u32 s31, s31, 1
  ds_read_b128 v[96:99], v117 offset:0
  ds_read_b128 v[100:103], v117 offset:1024
  ds_read_b128 v[104:107], v117 offset:14336
  ds_read_b128 v[108:111], v117 offset:15360
  v_smfmac_f32_16x16x64_bf16 v[36:39], v[8:11], a[0:7], v3
  v_smfmac_f32_16x16x64_bf16 v[40:43], v[8:11], a[56:63], v3
  v_smfmac_f32_16x16x64_bf16 v[44:47], v[8:11], a[112:119], v3
  v_smfmac_f32_16x16x64_bf16 v[48:51], v[8:11], a[168:175], v3
  v_smfmac_f32_16x16x64_bf16 v[52:55], v[8:11], a[224:231], v3
  v_smfmac_f32_16x16x64_bf16 v[56:59], v[8:11], v[144:151], v3
  v_smfmac_f32_16x16x64_bf16 v[60:63], v[8:11], v[200:207], v3
  v_smfmac_f32_16x16x64_bf16 v[36:39], v[12:15], a[8:15], v3
  v_smfmac_f32_16x16x64_bf16 v[40:43], v[12:15], a[64:71], v3
  v_smfmac_f32_16x16x64_bf16 v[44:47], v[12:15], a[120:127], v3
  v_smfmac_f32_16x16x64_bf16 v[48:51], v[12:15], a[176:183], v3
  v_smfmac_f32_16x16x64_bf16 v[52:55], v[12:15], a[232:239], v3
  v_smfmac_f32_16x16x64_bf16 v[56:59], v[12:15], v[152:159], v3
  v_smfmac_f32_16x16x64_bf16 v[60:63], v[12:15], v[208:215], v3
  v_smfmac_f32_16x16x64_bf16 v[36:39], v[16:19], a[16:23], v3
  v_smfmac_f32_16x16x64_bf16 v[40:43], v[16:19], a[72:79], v3
  v_smfmac_f32_16x16x64_bf16 v[44:47], v[16:19], a[128:135], v3
  v_smfmac_f32_16x16x64_bf16 v[48:51], v[16:19], a[184:191], v3
  v_smfmac_f32_16x16x64_bf16 v[52:55], v[16:19], a[240:247], v3
  v_smfmac_f32_16x16x64_bf16 v[56:59], v[16:19], v[160:167], v3
  v_smfmac_f32_16x16x64_bf16 v[60:63], v[16:19], v[216:223], v3
  v_smfmac_f32_16x16x64_bf16 v[36:39], v[20:23], a[24:31], v3
  v_smfmac_f32_16x16x64_bf16 v[40:43], v[20:23], a[80:87], v3
  v_smfmac_f32_16x16x64_bf16 v[44:47], v[20:23], a[136:143], v3
  v_smfmac_f32_16x16x64_bf16 v[48:51], v[20:23], a[192:199], v3
  v_smfmac_f32_16x16x64_bf16 v[52:55], v[20:23], a[248:255], v3
  v_smfmac_f32_16x16x64_bf16 v[56:59], v[20:23], v[168:175], v3
  v_smfmac_f32_16x16x64_bf16 v[60:63], v[20:23], v[224:231], v3
  s_xor_b32 s58, s25, 28672
  s_add_u32 s59, s24, 28672
  s_add_u32 m0, s58, 7168
  s_branch cA_sc1_ph2
.p2align 6

cA_sc2_loop:
  s_add_u32 s23, s20, 4096
  s_add_u32 s21, s20, 20480
  v_mov_b32 v48, 0
  v_mov_b32 v49, 0
  v_mov_b32 v50, 0
  v_mov_b32 v51, 0
  v_mov_b32 v52, 0
  v_mov_b32 v53, 0
  v_mov_b32 v54, 0
  v_mov_b32 v55, 0
  v_mov_b32 v56, 0
  v_mov_b32 v57, 0
  v_mov_b32 v58, 0
  v_mov_b32 v59, 0
  v_mov_b32 v60, 0
  v_mov_b32 v61, 0
  v_mov_b32 v62, 0
  v_mov_b32 v63, 0
  v_mov_b32 v88, 0
  v_mov_b32 v89, 0
  v_mov_b32 v90, 0
  v_mov_b32 v91, 0
  v_mov_b32 v92, 0
  v_mov_b32 v93, 0
  v_mov_b32 v94, 0
  v_mov_b32 v95, 0
  v_mov_b32 v66, 0
  v_mov_b32 v67, 0
  s_mov_b32 s30, 0
  s_mov_b32 s62, 0
  s_waitcnt vmcnt(0)
  s_barrier
cA_sc2_ld:
  buffer_load_dwordx4 v[8:11], v2, s[8:11], s20 offen offset:0
  v_mov_b32 v36, 0
  v_mov_b32 v37, 0
  v_mov_b32 v38, 0
  v_mov_b32 v39, 0
  buffer_load_dwordx4 v[12:15], v2, s[8:11], s20 offen offset:1024
  v_mov_b32 v40, 0
  v_mov_b32 v41, 0
  v_mov_b32 v42, 0
  v_mov_b32 v43, 0
  buffer_load_dwordx4 v[16:19], v2, s[8:11], s20 offen offset:2048
  v_mov_b32 v44, 0
  v_mov_b32 v45, 0
  v_mov_b32 v46, 0
  v_mov_b32 v47, 0
  ds_read_b128 v[96:99], v117 offset:0
  ds_read_b128 v[100:103], v117 offset:1024
  ds_read_b128 v[104:107], v117 offset:14336
  ds_read_b128 v[108:111], v117 offset:15360
  s_waitcnt vmcnt(2)
  v_smfmac_f32_16x16x64_bf16 v[36:39], v[8:11], a[0:7], v3
  v_smfmac_f32_16x16x64_bf16 v[40:43], v[8:11], a[56:63], v3
  buffer_load_dwordx4 v[20:23], v2, s[8:11], s20 offen offset:3072
  v_smfmac_f32_16x16x64_bf16 v[44:47], v[8:11], a[112:119], v3
  v_smfmac_f32_16x16x64_bf16 v[48:51], v[8:11], a[168:175], v3
  v_smfmac_f32_16x16x64_bf16 v[52:55], v[8:11], a[224:231], v3
  buffer_load_dwordx4 v[24:27], v2, s[8:11], s23 offen offset:0
  v_smfmac_f32_16x16x64_bf16 v[56:59], v[8:11], v[144:151], v3
  v_smfmac_f32_16x16x64_bf16 v[60:63], v[8:11], v[200:207], v3
  s_waitcnt vmcnt(3)
  v_smfmac_f32_16x16x64_bf16 v[36:39], v[12:15], a[8:15], v3
  v_smfmac_f32_16x16x64_bf16 v[40:43], v[12:15], a[64:71], v3
  buffer_load_dwordx4 v[28:31], v2, s[8:11], s23 offen offset:1024
  v_smfmac_f32_16x16x64_bf16 v[44:47], v[12:15], a[120:127], v3
  v_smfmac_f32_16x16x64_bf16 v[48:51], v[12:15], a[176:183], v3
  v_smfmac_f32_16x16x64_bf16 v[52:55], v[12:15], a[232:239], v3
  buffer_load_dwordx4 v[32:35], v2, s[8:11], s23 offen offset:2048
  v_smfmac_f32_16x16x64_bf16 v[56:59], v[12:15], v[152:159], v3
  v_smfmac_f32_16x16x64_bf16 v[60:63], v[12:15], v[208:215], v3
  s_waitcnt vmcnt(4)
  v_smfmac_f32_16x16x64_bf16 v[36:39], v[16:19], a[16:23], v3
  v_smfmac_f32_16x16x64_bf16 v[40:43], v[16:19], a[72:79], v3
  s_xor_b32 s58, s25, 28672
  s_add_u32 s59, s24, 28672
  s_add_u32 m0, s58, 14336
  v_smfmac_f32_16x16x64_bf16 v[44:47], v[16:19], a[128:135], v3
  buffer_load_dwordx4 v2, s[8:11], s59 offen offset:0 sc1 lds
  v_smfmac_f32_16x16x64_bf16 v[48:51], v[16:19], a[184:191], v3
  v_smfmac_f32_16x16x64_bf16 v[52:55], v[16:19], a[240:247], v3
  v_smfmac_f32_16x16x64_bf16 v[56:59], v[16:19], v[160:167], v3
  v_smfmac_f32_16x16x64_bf16 v[60:63], v[16:19], v[216:223], v3
  buffer_load_dwordx4 v2, s[8:11], s59 offen offset:1024 sc1 lds
  s_waitcnt vmcnt(5)
  v_smfmac_f32_16x16x64_bf16 v[36:39], v[20:23], a[24:31], v3
  v_smfmac_f32_16x16x64_bf16 v[40:43], v[20:23], a[80:87], v3
  v_smfmac_f32_16x16x64_bf16 v[44:47], v[20:23], a[136:143], v3
  v_smfmac_f32_16x16x64_bf16 v[48:51], v[20:23], a[192:199], v3
  buffer_load_dwordx4 v2, s[8:11], s59 offen offset:2048 sc1 lds
  v_smfmac_f32_16x16x64_bf16 v[52:55], v[20:23], a[248:255], v3
  v_smfmac_f32_16x16x64_bf16 v[56:59], v[20:23], v[168:175], v3
  v_smfmac_f32_16x16x64_bf16 v[60:63], v[20:23], v[224:231], v3
  s_waitcnt vmcnt(3)
cA_sc2_ph2:
  v_smfmac_f32_16x16x64_bf16 v[60:63], v[24:27], v[232:239], v3
  buffer_load_dwordx4 v2, s[8:11], s59 offen offset:3072 sc1 lds
  ds_read_b128 v[8:11], v116 offset:4096
  ds_read_b128 v[12:15], v116 offset:5120
  v_smfmac_f32_16x16x64_bf16 v[60:63], v[28:31], v[240:247], v3
  buffer_load_dword v119, v0, s[8:11], s24 offen sc1
  v_smfmac_f32_16x16x64_bf16 v[60:63], v[32:35], v[248:255], v3
  v_mov_b32 v80, v28
  v_smfmac_f32_16x16x64_bf16 v[52:55], v[24:27], v[120:127], v3
  v_mov_b32 v81, v29
  v_smfmac_f32_16x16x64_bf16 v[52:55], v[28:31], v[128:135], v3
  v_mov_b32 v82, v34
  v_smfmac_f32_16x16x64_bf16 v[52:55], v[32:35], v[136:143], v3
  v_cvt_pk_bf16_f32 v64, v60, v61
  v_smfmac_f32_16x16x64_bf16 v[56:59], v[24:27], v[176:183], v3
  v_cvt_pk_bf16_f32 v65, v62, v63
  v_smfmac_f32_16x16x64_bf16 v[56:59], v[28:31], v[184:191], v3
  v_mov_b32 v83, v35
  v_mfma_f32_16x16x32_bf16 v[68:71], v[64:67], v[4:7], 0
  v_smfmac_f32_16x16x64_bf16 v[56:59], v[32:35], v[192:199], v3
  v_cvt_pk_bf16_f32 v64, v52, v53
  v_smfmac_f32_16x16x64_bf16 v[36:39], v[24:27], a[32:39], v3
  v_cvt_pk_bf16_f32 v65, v54, v55
  v_smfmac_f32_16x16x64_bf16 v[36:39], v[28:31], a[40:47], v3
  v_cvt_pk_bf16_f32 v78, v68, v69
  v_smfmac_f32_16x16x64_bf16 v[36:39], v[32:35], a[48:55], v3
  v_cvt_pk_bf16_f32 v79, v70, v71
  v_cvt_pk_bf16_f32 v66, v56, v57
  v_smfmac_f32_16x16x64_bf16 v[40:43], v[24:27], a[88:95], v3
  v_cvt_pk_bf16_f32 v67, v58, v59
  v_smfmac_f32_16x16x64_bf16 v[40:43], v[28:31], a[96:103], v3
  v_mfma_f32_16x16x32_bf16 v[72:75], v[64:67], v[4:7], 0
  ds_read_b128 v[52:55], v116 offset:18432
  ds_read_b128 v[56:59], v116 offset:19456
  v_smfmac_f32_16x16x64_bf16 v[40:43], v[32:35], a[104:111], v3
  v_cvt_pk_bf16_f32 v64, v36, v37
  v_smfmac_f32_16x16x64_bf16 v[44:47], v[24:27], a[144:151], v3
  v_cvt_pk_bf16_f32 v65, v38, v39
  v_smfmac_f32_16x16x64_bf16 v[44:47], v[28:31], a[152:159], v3
  v_cvt_pk_bf16_f32 v76, v72, v73
  v_smfmac_f32_16x16x64_bf16 v[44:47], v[32:35], a[160:167], v3
  v_cvt_pk_bf16_f32 v77, v74, v75
  v_cvt_pk_bf16_f32 v66, v40, v41
  v_smfmac_f32_16x16x64_bf16 v[48:51], v[24:27], a[200:207], v3
  v_cvt_pk_bf16_f32 v67, v42, v43
  v_smfmac_f32_16x16x64_bf16 v[48:51], v[28:31], a[208:215], v3
  v_mfma_f32_16x16x32_bf16 v[68:71], v[64:67], v[4:7], 0
  v_smfmac_f32_16x16x64_bf16 v[48:51], v[32:35], a[216:223], v3
  v_cvt_pk_bf16_f32 v64, v44, v45
  v_mfma_f32_16x16x32_bf16 v[84:87], v[80:83], v[76:79], 0
  v_cvt_pk_bf16_f32 v65, v46, v47
  s_waitcnt lgkmcnt(0)
  v_smfmac_f32_16x16x64_bf16 v[88:91], v[76:79], v[96:103], v118
  v_cvt_pk_bf16_f32 v60, v68, v69
  v_cvt_pk_bf16_f32 v61, v70, v71
  v_cvt_pk_bf16_f32 v66, v48, v49
  v_cvt_pk_bf16_f32 v67, v50, v51
  s_nop 1
  v_mfma_f32_16x16x32_bf16 v[72:75], v[64:67], v[4:7], 0
  v_smfmac_f32_16x16x64_bf16 v[92:95], v[76:79], v[104:111], v118
  s_nop 4
  v_cvt_pk_bf16_f32 v62, v72, v73
  v_cvt_pk_bf16_f32 v63, v74, v75
  s_nop 1
  v_mfma_f32_16x16x32_bf16 v[84:87], v[16:19], v[60:63], v[84:87]
  v_smfmac_f32_16x16x64_bf16 v[88:91], v[60:63], v[8:15], v118
  v_smfmac_f32_16x16x64_bf16 v[92:95], v[60:63], v[52:59], v118
  s_nop 1
  v_permlane32_swap_b32 v84, v86
  v_permlane32_swap_b32 v85, v87
  s_nop 0
  v_add_f32 v88, v88, v89
  v_add_f32_dpp v84, v86, v84 quad_perm:[1,0,3,2] row_mask:0xf bank_mask:0xf
  v_add_f32_dpp v85, v87, v85 quad_perm:[1,0,3,2] row_mask:0xf bank_mask:0xf
  v_add_f32 v89, v90, v91
  ds_write2_b32 v113, v84, v85 offset0:0 offset1:4
  ds_write2_b32 v112, v88, v89 offset0:0 offset1:128
  v_add_f32 v90, v92, v93
  v_add_f32 v91, v94, v95
  ds_write2_b32 v112, v90, v91 offset0:64 offset1:192
  v_cmp_u_f32 vcc, v88, v89
  s_cbranch_vccnz cA_sc2_retry
cA_sc2_cont:
  s_waitcnt lgkmcnt(0)
  s_barrier
  ds_read_b128 v[36:39], v114
  ds_read_b128 v[44:47], v115
  s_waitcnt lgkmcnt(0)
  v_add_f32 v36, v36, v38
  v_add_f32 v37, v37, v39
  v_add_f32 v44, v44, v45
  v_add_f32 v46, v46, v47
  v_add_f32 v44, v44, v46
  v_add_f32 v36, v36, v37
  v_exp_f32 v49, v44
  v_exp_f32 v48, v36
  v_add_f32 v50, abs(v36), abs(v44)
  v_fma_f32 v39, v49, s37, v48
  v_cmp_ngt_f32 vcc, s56, v50
  v_cndmask_b32 v41, v48, v49, s[38:39]
  v_add_f32_dpp v39, v39, v39 quad_perm:[1,0,3,2] row_mask:0xf bank_mask:0xf
  v_cndmask_b32 v40, v49, v48, s[38:39]
  v_mov_b32_dpp v46, v41 quad_perm:[1,0,3,2] row_mask:0xf bank_mask:0xf
  v_add_f32_dpp v39, v39, v39 quad_perm:[2,3,0,1] row_mask:0xf bank_mask:0xf
  v_cndmask_b32 v42, v46, v40, s[38:39]
  v_cndmask_b32 v43, v40, v46, s[38:39]
  v_add_f32_dpp v39, v39, v39 row_half_mirror row_mask:0xf bank_mask:0xf
  s_cbranch_vccnz cA_sc2_slow
  s_nop 0
  v_add_f32_dpp v47, v39, v39 row_mirror row_mask:0xf bank_mask:0xf
  v_add_f32_dpp v39, v39, v39 row_mirror row_mask:0xf bank_mask:0xf
  s_nop 1
  v_permlane16_swap_b32 v39, v47
  v_add_f32 v39, v39, v47
  v_rcp_f32 v39, v39
  s_mov_b64 exec, s[28:29]
  v_mul_f32 v42, v42, v39
  v_mul_f32 v43, v43, v39
  v_cvt_pk_bf16_f32 v42, v42, v43
cA_sc2_pst:
  buffer_store_dword v42, v1, s[8:11], s20 offen
  s_mov_b64 exec, -1
  s_barrier
  s_add_u32 s24, s24, 28672
  s_add_u32 s35, s35, 28672
  s_xor_b32 s25, s25, 28672
  s_add_u32 m0, s25, 14336
  s_add_u32 m0, s25, 18432
  s_add_u32 s22, s24, 4096
  buffer_load_dwordx4 v2, s[8:11], s22 offen offset:0 sc1 lds
  s_nop 5
  buffer_load_dwordx4 v2, s[8:11], s22 offen offset:1024 sc1 lds
  s_nop 5
  buffer_load_dwordx4 v2, s[8:11], s22 offen offset:2048 sc1 lds
  s_nop 5
  v_xor_b32 v116, 28672, v116
  v_add_u32 v117, s57, v117
  s_sub_u32 s57, 0, s57
  s_add_u32 s19, s19, 1
  s_mov_b32 s20, s21
  s_cmp_lt_u32 s19, 63
  s_cbranch_scc1 cA_sc2_loop
  s_branch cA_done
cA_sc2_slow:
  v_max_f32 v50, v36, v44
  s_nop 1
  v_max_f32_dpp v50, v50, v50 quad_perm:[1,0,3,2] row_mask:0xf bank_mask:0xf
  s_nop 1
  v_max_f32_dpp v50, v50, v50 quad_perm:[2,3,0,1] row_mask:0xf bank_mask:0xf
  s_nop 1
  v_max_f32_dpp v50, v50, v50 row_half_mirror row_mask:0xf bank_mask:0xf
  s_nop 1
  v_max_f32_dpp v50, v50, v50 row_mirror row_mask:0xf bank_mask:0xf
  v_mov_b32 v47, v50
  s_nop 1
  v_permlane16_swap_b32 v50, v47
  v_max_f32 v50, v50, v47
  v_sub_f32 v48, v36, v50
  v_sub_f32 v49, v44, v50
  v_exp_f32 v48, v48
  v_exp_f32 v49, v49
  s_add_u32 s31, s31, 0x100
  v_fma_f32 v39, v49, s37, v48
  v_cndmask_b32 v41, v48, v49, s[38:39]
  s_nop 0
  v_add_f32_dpp v39, v39, v39 quad_perm:[1,0,3,2] row_mask:0xf bank_mask:0xf
  v_cndmask_b32 v40, v49, v48, s[38:39]
  v_mov_b32_dpp v46, v41 quad_perm:[1,0,3,2] row_mask:0xf bank_mask:0xf
  v_add_f32_dpp v39, v39, v39 quad_perm:[2,3,0,1] row_mask:0xf bank_mask:0xf
  v_cndmask_b32 v42, v46, v40, s[38:39]
  v_cndmask_b32 v43, v40, v46, s[38:39]
  v_add_f32_dpp v39, v39, v39 row_half_mirror row_mask:0xf bank_mask:0xf
  s_nop 1
  v_add_f32_dpp v47, v39, v39 row_mirror row_mask:0xf bank_mask:0xf
  v_add_f32_dpp v39, v39, v39 row_mirror row_mask:0xf bank_mask:0xf
  s_nop 1
  v_permlane16_swap_b32 v39, v47
  v_add_f32 v39, v39, v47
  v_rcp_f32 v39, v39
  s_mov_b64 exec, s[28:29]
  v_mul_f32 v42, v42, v39
  v_mul_f32 v43, v43, v39
  v_cvt_pk_bf16_f32 v42, v42, v43
  v_min_u32 v42, -2, v42
  s_branch cA_sc2_pst
cA_sc2_retry:
  s_cmp_lg_u32 s62, 0
  s_cbranch_scc1 cA_sc2_cont
  s_waitcnt vmcnt(0) lgkmcnt(0)
cA_sc2_rv:
  buffer_load_dwordx4 v[8:11], v2, s[8:11], s20 offen offset:0 sc1
  buffer_load_dwordx4 v[12:15], v2, s[8:11], s20 offen offset:1024 sc1
  buffer_load_dwordx4 v[16:19], v2, s[8:11], s20 offen offset:2048 sc1
  buffer_load_dwordx4 v[20:23], v2, s[8:11], s20 offen offset:3072 sc1
  buffer_load_dwordx4 v[24:27], v2, s[8:11], s23 offen offset:0 sc1
  buffer_load_dwordx4 v[28:31], v2, s[8:11], s23 offen offset:1024 sc1
  buffer_load_dwordx4 v[32:35], v2, s[8:11], s23 offen offset:2048 sc1
  s_waitcnt vmcnt(0)
  v_max3_u32 v68, v8, v9, v10
  v_max3_u32 v68, v68, v11, v12
  v_max3_u32 v68, v68, v13, v14
  v_max3_u32 v68, v68, v15, v16
  v_max3_u32 v68, v68, v17, v18
  v_max3_u32 v68, v68, v19, v20
  v_max3_u32 v68, v68, v21, v22
  v_max3_u32 v68, v68, v23, v24
  v_max3_u32 v68, v68, v25, v26
  v_max3_u32 v68, v68, v27, v28
  v_max3_u32 v68, v68, v29, v30
  v_max3_u32 v68, v68, v31, v32
  v_max3_u32 v68, v68, v33, v34
  v_max_u32 v68, v68, v35
  v_cmp_eq_u32 vcc, -1, v68
  s_cbranch_vccz cA_sc2_rk
  s_add_u32 s30, s30, 1
  s_cmp_lt_u32 s30, 400000
  s_cbranch_scc1 cA_sc2_rv
  s_branch cA_abort
cA_sc2_rk:
  s_mov_b32 s62, 1
  v_mov_b32 v36, 0
  v_mov_b32 v37, 0
  v_mov_b32 v38, 0
  v_mov_b32 v39, 0
  v_mov_b32 v40, 0
  v_mov_b32 v41, 0
  v_mov_b32 v42, 0
  v_mov_b32 v43, 0
  v_mov_b32 v44, 0
  v_mov_b32 v45, 0
  v_mov_b32 v46, 0
  v_mov_b32 v47, 0
  v_mov_b32 v48, 0
  v_mov_b32 v49, 0
  v_mov_b32 v50, 0
  v_mov_b32 v51, 0
  v_mov_b32 v52, 0
  v_mov_b32 v53, 0
  v_mov_b32 v54, 0
  v_mov_b32 v55, 0
  v_mov_b32 v56, 0
  v_mov_b32 v57, 0
  v_mov_b32 v58, 0
  v_mov_b32 v59, 0
  v_mov_b32 v60, 0
  v_mov_b32 v61, 0
  v_mov_b32 v62, 0
  v_mov_b32 v63, 0
  v_mov_b32 v88, 0
  v_mov_b32 v89, 0
  v_mov_b32 v90, 0
  v_mov_b32 v91, 0
  v_mov_b32 v92, 0
  v_mov_b32 v93, 0
  v_mov_b32 v94, 0
  v_mov_b32 v95, 0
  v_mov_b32 v66, 0
  v_mov_b32 v67, 0
  s_add_u32 s31, s31, 1
  ds_read_b128 v[96:99], v117 offset:0
  ds_read_b128 v[100:103], v117 offset:1024
  ds_read_b128 v[104:107], v117 offset:14336
  ds_read_b128 v[108:111], v117 offset:15360
  v_smfmac_f32_16x16x64_bf16 v[36:39], v[8:11], a[0:7], v3
  v_smfmac_f32_16x16x64_bf16 v[40:43], v[8:11], a[56:63], v3
  v_smfmac_f32_16x16x64_bf16 v[44:47], v[8:11], a[112:119], v3
  v_smfmac_f32_16x16x64_bf16 v[48:51], v[8:11], a[168:175], v3
  v_smfmac_f32_16x16x64_bf16 v[52:55], v[8:11], a[224:231], v3
  v_smfmac_f32_16x16x64_bf16 v[56:59], v[8:11], v[144:151], v3
  v_smfmac_f32_16x16x64_bf16 v[60:63], v[8:11], v[200:207], v3
  v_smfmac_f32_16x16x64_bf16 v[36:39], v[12:15], a[8:15], v3
  v_smfmac_f32_16x16x64_bf16 v[40:43], v[12:15], a[64:71], v3
  v_smfmac_f32_16x16x64_bf16 v[44:47], v[12:15], a[120:127], v3
  v_smfmac_f32_16x16x64_bf16 v[48:51], v[12:15], a[176:183], v3
  v_smfmac_f32_16x16x64_bf16 v[52:55], v[12:15], a[232:239], v3
  v_smfmac_f32_16x16x64_bf16 v[56:59], v[12:15], v[152:159], v3
  v_smfmac_f32_16x16x64_bf16 v[60:63], v[12:15], v[208:215], v3
  v_smfmac_f32_16x16x64_bf16 v[36:39], v[16:19], a[16:23], v3
  v_smfmac_f32_16x16x64_bf16 v[40:43], v[16:19], a[72:79], v3
  v_smfmac_f32_16x16x64_bf16 v[44:47], v[16:19], a[128:135], v3
  v_smfmac_f32_16x16x64_bf16 v[48:51], v[16:19], a[184:191], v3
  v_smfmac_f32_16x16x64_bf16 v[52:55], v[16:19], a[240:247], v3
  v_smfmac_f32_16x16x64_bf16 v[56:59], v[16:19], v[160:167], v3
  v_smfmac_f32_16x16x64_bf16 v[60:63], v[16:19], v[216:223], v3
  v_smfmac_f32_16x16x64_bf16 v[36:39], v[20:23], a[24:31], v3
  v_smfmac_f32_16x16x64_bf16 v[40:43], v[20:23], a[80:87], v3
  v_smfmac_f32_16x16x64_bf16 v[44:47], v[20:23], a[136:143], v3
  v_smfmac_f32_16x16x64_bf16 v[48:51], v[20:23], a[192:199], v3
  v_smfmac_f32_16x16x64_bf16 v[52:55], v[20:23], a[248:255], v3
  v_smfmac_f32_16x16x64_bf16 v[56:59], v[20:23], v[168:175], v3
  v_smfmac_f32_16x16x64_bf16 v[60:63], v[20:23], v[224:231], v3
  s_xor_b32 s58, s25, 28672
  s_add_u32 s59, s24, 28672
  s_add_u32 m0, s58, 14336
  s_branch cA_sc2_ph2
.p2align 6

cA_sc3_loop:
  s_add_u32 s23, s20, 4096
  s_add_u32 s21, s20, 20480
  v_mov_b32 v48, 0
  v_mov_b32 v49, 0
  v_mov_b32 v50, 0
  v_mov_b32 v51, 0
  v_mov_b32 v52, 0
  v_mov_b32 v53, 0
  v_mov_b32 v54, 0
  v_mov_b32 v55, 0
  v_mov_b32 v56, 0
  v_mov_b32 v57, 0
  v_mov_b32 v58, 0
  v_mov_b32 v59, 0
  v_mov_b32 v60, 0
  v_mov_b32 v61, 0
  v_mov_b32 v62, 0
  v_mov_b32 v63, 0
  v_mov_b32 v88, 0
  v_mov_b32 v89, 0
  v_mov_b32 v90, 0
  v_mov_b32 v91, 0
  v_mov_b32 v92, 0
  v_mov_b32 v93, 0
  v_mov_b32 v94, 0
  v_mov_b32 v95, 0
  v_mov_b32 v64, 0
  v_mov_b32 v65, 0
  s_mov_b32 s30, 0
  s_mov_b32 s62, 0
  s_waitcnt vmcnt(0)
  s_barrier
cA_sc3_ld:
  buffer_load_dwordx4 v[8:11], v2, s[8:11], s20 offen offset:0
  v_mov_b32 v36, 0
  v_mov_b32 v37, 0
  v_mov_b32 v38, 0
  v_mov_b32 v39, 0
  buffer_load_dwordx4 v[12:15], v2, s[8:11], s20 offen offset:1024
  v_mov_b32 v40, 0
  v_mov_b32 v41, 0
  v_mov_b32 v42, 0
  v_mov_b32 v43, 0
  buffer_load_dwordx4 v[16:19], v2, s[8:11], s20 offen offset:2048
  v_mov_b32 v44, 0
  v_mov_b32 v45, 0
  v_mov_b32 v46, 0
  v_mov_b32 v47, 0
  ds_read_b128 v[96:99], v117 offset:0
  ds_read_b128 v[100:103], v117 offset:1024
  ds_read_b128 v[104:107], v117 offset:14336
  ds_read_b128 v[108:111], v117 offset:15360
  s_waitcnt vmcnt(2)
  v_smfmac_f32_16x16x64_bf16 v[36:39], v[8:11], a[0:7], v3
  v_smfmac_f32_16x16x64_bf16 v[40:43], v[8:11], a[56:63], v3
  buffer_load_dwordx4 v[20:23], v2, s[8:11], s20 offen offset:3072
  v_smfmac_f32_16x16x64_bf16 v[44:47], v[8:11], a[112:119], v3
  v_smfmac_f32_16x16x64_bf16 v[48:51], v[8:11], a[168:175], v3
  v_smfmac_f32_16x16x64_bf16 v[52:55], v[8:11], a[224:231], v3
  buffer_load_dwordx4 v[24:27], v2, s[8:11], s23 offen offset:0
  v_smfmac_f32_16x16x64_bf16 v[56:59], v[8:11], v[144:151], v3
  v_smfmac_f32_16x16x64_bf16 v[60:63], v[8:11], v[200:207], v3
  s_waitcnt vmcnt(3)
  v_smfmac_f32_16x16x64_bf16 v[36:39], v[12:15], a[8:15], v3
  v_smfmac_f32_16x16x64_bf16 v[40:43], v[12:15], a[64:71], v3
  buffer_load_dwordx4 v[28:31], v2, s[8:11], s23 offen offset:1024
  v_smfmac_f32_16x16x64_bf16 v[44:47], v[12:15], a[120:127], v3
  v_smfmac_f32_16x16x64_bf16 v[48:51], v[12:15], a[176:183], v3
  v_smfmac_f32_16x16x64_bf16 v[52:55], v[12:15], a[232:239], v3
  buffer_load_dwordx4 v[32:35], v2, s[8:11], s23 offen offset:2048
  v_smfmac_f32_16x16x64_bf16 v[56:59], v[12:15], v[152:159], v3
  v_smfmac_f32_16x16x64_bf16 v[60:63], v[12:15], v[208:215], v3
  s_waitcnt vmcnt(4)
  v_smfmac_f32_16x16x64_bf16 v[36:39], v[16:19], a[16:23], v3
  v_smfmac_f32_16x16x64_bf16 v[40:43], v[16:19], a[72:79], v3
  v_smfmac_f32_16x16x64_bf16 v[44:47], v[16:19], a[128:135], v3
  s_xor_b32 s58, s25, 28672
  s_add_u32 s59, s24, 28672
  s_add_u32 m0, s58, 21504
  v_smfmac_f32_16x16x64_bf16 v[48:51], v[16:19], a[184:191], v3
  buffer_load_dwordx4 v2, s[8:11], s59 offen offset:0 sc1 lds
  v_smfmac_f32_16x16x64_bf16 v[52:55], v[16:19], a[240:247], v3
  v_smfmac_f32_16x16x64_bf16 v[56:59], v[16:19], v[160:167], v3
  v_smfmac_f32_16x16x64_bf16 v[60:63], v[16:19], v[216:223], v3
  s_waitcnt vmcnt(4)
  v_smfmac_f32_16x16x64_bf16 v[36:39], v[20:23], a[24:31], v3
  buffer_load_dwordx4 v2, s[8:11], s59 offen offset:1024 sc1 lds
  v_smfmac_f32_16x16x64_bf16 v[40:43], v[20:23], a[80:87], v3
  v_smfmac_f32_16x16x64_bf16 v[44:47], v[20:23], a[136:143], v3
  v_smfmac_f32_16x16x64_bf16 v[48:51], v[20:23], a[192:199], v3
  v_smfmac_f32_16x16x64_bf16 v[52:55], v[20:23], a[248:255], v3
  buffer_load_dwordx4 v2, s[8:11], s59 offen offset:2048 sc1 lds
  v_smfmac_f32_16x16x64_bf16 v[56:59], v[20:23], v[168:175], v3
  v_smfmac_f32_16x16x64_bf16 v[60:63], v[20:23], v[224:231], v3
  s_waitcnt vmcnt(3)
cA_sc3_ph2:
  v_smfmac_f32_16x16x64_bf16 v[60:63], v[24:27], v[232:239], v3
  ds_read_b128 v[8:11], v116 offset:6144
  ds_read_b128 v[12:15], v116 offset:7168
  v_smfmac_f32_16x16x64_bf16 v[60:63], v[28:31], v[240:247], v3
  buffer_load_dwordx4 v2, s[8:11], s59 offen offset:3072 sc1 lds
  v_smfmac_f32_16x16x64_bf16 v[60:63], v[32:35], v[248:255], v3
  v_mov_b32 v80, v30
  v_smfmac_f32_16x16x64_bf16 v[52:55], v[24:27], v[120:127], v3
  v_mov_b32 v81, v31
  v_smfmac_f32_16x16x64_bf16 v[52:55], v[28:31], v[128:135], v3
  v_mov_b32 v82, v34
  v_smfmac_f32_16x16x64_bf16 v[52:55], v[32:35], v[136:143], v3
  v_cvt_pk_bf16_f32 v66, v60, v61
  v_smfmac_f32_16x16x64_bf16 v[56:59], v[24:27], v[176:183], v3
  v_cvt_pk_bf16_f32 v67, v62, v63
  v_smfmac_f32_16x16x64_bf16 v[56:59], v[28:31], v[184:191], v3
  v_mov_b32 v83, v35
  v_mfma_f32_16x16x32_bf16 v[68:71], v[64:67], v[4:7], 0
  v_smfmac_f32_16x16x64_bf16 v[56:59], v[32:35], v[192:199], v3
  v_cvt_pk_bf16_f32 v64, v52, v53
  v_smfmac_f32_16x16x64_bf16 v[36:39], v[24:27], a[32:39], v3
  v_cvt_pk_bf16_f32 v65, v54, v55
  v_smfmac_f32_16x16x64_bf16 v[36:39], v[28:31], a[40:47], v3
  v_cvt_pk_bf16_f32 v78, v68, v69
  v_smfmac_f32_16x16x64_bf16 v[36:39], v[32:35], a[48:55], v3
  v_cvt_pk_bf16_f32 v79, v70, v71
  v_cvt_pk_bf16_f32 v66, v56, v57
  v_smfmac_f32_16x16x64_bf16 v[40:43], v[24:27], a[88:95], v3
  v_cvt_pk_bf16_f32 v67, v58, v59
  v_smfmac_f32_16x16x64_bf16 v[40:43], v[28:31], a[96:103], v3
  v_mfma_f32_16x16x32_bf16 v[72:75], v[64:67], v[4:7], 0
  ds_read_b128 v[52:55], v116 offset:20480
  ds_read_b128 v[56:59], v116 offset:21504
  v_smfmac_f32_16x16x64_bf16 v[40:43], v[32:35], a[104:111], v3
  v_cvt_pk_bf16_f32 v64, v36, v37
  v_smfmac_f32_16x16x64_bf16 v[44:47], v[24:27], a[144:151], v3
  v_cvt_pk_bf16_f32 v65, v38, v39
  v_smfmac_f32_16x16x64_bf16 v[44:47], v[28:31], a[152:159], v3
  v_cvt_pk_bf16_f32 v76, v72, v73
  v_smfmac_f32_16x16x64_bf16 v[44:47], v[32:35], a[160:167], v3
  v_cvt_pk_bf16_f32 v77, v74, v75
  v_cvt_pk_bf16_f32 v66, v40, v41
  v_smfmac_f32_16x16x64_bf16 v[48:51], v[24:27], a[200:207], v3
  v_cvt_pk_bf16_f32 v67, v42, v43
  v_smfmac_f32_16x16x64_bf16 v[48:51], v[28:31], a[208:215], v3
  v_mfma_f32_16x16x32_bf16 v[68:71], v[64:67], v[4:7], 0
  v_smfmac_f32_16x16x64_bf16 v[48:51], v[32:35], a[216:223], v3
  v_cvt_pk_bf16_f32 v64, v44, v45
  v_mfma_f32_16x16x32_bf16 v[84:87], v[80:83], v[76:79], 0
  v_cvt_pk_bf16_f32 v65, v46, v47
  s_waitcnt lgkmcnt(0)
  v_smfmac_f32_16x16x64_bf16 v[88:91], v[76:79], v[96:103], v118
  v_cvt_pk_bf16_f32 v60, v68, v69
  v_cvt_pk_bf16_f32 v61, v70, v71
  v_cvt_pk_bf16_f32 v66, v48, v49
  v_cvt_pk_bf16_f32 v67, v50, v51
  s_nop 1
  v_mfma_f32_16x16x32_bf16 v[72:75], v[64:67], v[4:7], 0
  v_smfmac_f32_16x16x64_bf16 v[92:95], v[76:79], v[104:111], v118
  s_nop 4
  v_cvt_pk_bf16_f32 v62, v72, v73
  v_cvt_pk_bf16_f32 v63, v74, v75
  s_nop 1
  v_mfma_f32_16x16x32_bf16 v[84:87], v[20:23], v[60:63], v[84:87]
  v_smfmac_f32_16x16x64_bf16 v[88:91], v[60:63], v[8:15], v118
  v_smfmac_f32_16x16x64_bf16 v[92:95], v[60:63], v[52:59], v118
  s_nop 1
  v_permlane32_swap_b32 v84, v86
  v_permlane32_swap_b32 v85, v87
  s_nop 0
  v_add_f32 v88, v88, v89
  v_add_f32_dpp v84, v86, v84 quad_perm:[1,0,3,2] row_mask:0xf bank_mask:0xf
  v_add_f32_dpp v85, v87, v85 quad_perm:[1,0,3,2] row_mask:0xf bank_mask:0xf
  v_add_f32 v89, v90, v91
  ds_write2_b32 v113, v84, v85 offset0:0 offset1:4
  ds_write2_b32 v112, v88, v89 offset0:0 offset1:128
  v_add_f32 v90, v92, v93
  v_add_f32 v91, v94, v95
  ds_write2_b32 v112, v90, v91 offset0:64 offset1:192
  v_cmp_u_f32 vcc, v88, v89
  s_cbranch_vccnz cA_sc3_retry
cA_sc3_cont:
  s_waitcnt lgkmcnt(0)
  s_barrier
  ds_read_b128 v[36:39], v114
  ds_read_b128 v[44:47], v115
  s_waitcnt lgkmcnt(0)
  v_add_f32 v36, v36, v38
  v_add_f32 v37, v37, v39
  v_add_f32 v44, v44, v45
  v_add_f32 v46, v46, v47
  v_add_f32 v44, v44, v46
  v_add_f32 v36, v36, v37
  v_exp_f32 v49, v44
  v_exp_f32 v48, v36
  v_add_f32 v50, abs(v36), abs(v44)
  v_fma_f32 v39, v49, s37, v48
  v_cmp_ngt_f32 vcc, s56, v50
  v_cndmask_b32 v41, v48, v49, s[38:39]
  v_add_f32_dpp v39, v39, v39 quad_perm:[1,0,3,2] row_mask:0xf bank_mask:0xf
  v_cndmask_b32 v40, v49, v48, s[38:39]
  v_mov_b32_dpp v46, v41 quad_perm:[1,0,3,2] row_mask:0xf bank_mask:0xf
  v_add_f32_dpp v39, v39, v39 quad_perm:[2,3,0,1] row_mask:0xf bank_mask:0xf
  v_cndmask_b32 v42, v46, v40, s[38:39]
  v_cndmask_b32 v43, v40, v46, s[38:39]
  v_add_f32_dpp v39, v39, v39 row_half_mirror row_mask:0xf bank_mask:0xf
  s_cbranch_vccnz cA_sc3_slow
  s_nop 0
  v_add_f32_dpp v47, v39, v39 row_mirror row_mask:0xf bank_mask:0xf
  v_add_f32_dpp v39, v39, v39 row_mirror row_mask:0xf bank_mask:0xf
  s_nop 1
  v_permlane16_swap_b32 v39, v47
  v_add_f32 v39, v39, v47
  v_rcp_f32 v39, v39
  s_mov_b64 exec, s[28:29]
  v_mul_f32 v42, v42, v39
  v_mul_f32 v43, v43, v39
  v_cvt_pk_bf16_f32 v42, v42, v43
cA_sc3_pst:
  buffer_store_dword v42, v1, s[8:11], s20 offen
  s_mov_b64 exec, -1
  s_barrier
  s_add_u32 s24, s24, 28672
  s_add_u32 s35, s35, 28672
  s_xor_b32 s25, s25, 28672
  s_add_u32 m0, s25, 21504
  s_add_u32 m0, s25, 25600
  s_add_u32 s22, s24, 4096
  buffer_load_dwordx4 v2, s[8:11], s22 offen offset:0 sc1 lds
  s_nop 5
  buffer_load_dwordx4 v2, s[8:11], s22 offen offset:1024 sc1 lds
  s_nop 5
  buffer_load_dwordx4 v2, s[8:11], s22 offen offset:2048 sc1 lds
  s_nop 5
  v_xor_b32 v116, 28672, v116
  v_add_u32 v117, s57, v117
  s_sub_u32 s57, 0, s57
  s_add_u32 s19, s19, 1
  s_mov_b32 s20, s21
  s_cmp_lt_u32 s19, 63
  s_cbranch_scc1 cA_sc3_loop
  s_branch cA_done
cA_sc3_slow:
  v_max_f32 v50, v36, v44
  s_nop 1
  v_max_f32_dpp v50, v50, v50 quad_perm:[1,0,3,2] row_mask:0xf bank_mask:0xf
  s_nop 1
  v_max_f32_dpp v50, v50, v50 quad_perm:[2,3,0,1] row_mask:0xf bank_mask:0xf
  s_nop 1
  v_max_f32_dpp v50, v50, v50 row_half_mirror row_mask:0xf bank_mask:0xf
  s_nop 1
  v_max_f32_dpp v50, v50, v50 row_mirror row_mask:0xf bank_mask:0xf
  v_mov_b32 v47, v50
  s_nop 1
  v_permlane16_swap_b32 v50, v47
  v_max_f32 v50, v50, v47
  v_sub_f32 v48, v36, v50
  v_sub_f32 v49, v44, v50
  v_exp_f32 v48, v48
  v_exp_f32 v49, v49
  s_add_u32 s31, s31, 0x100
  v_fma_f32 v39, v49, s37, v48
  v_cndmask_b32 v41, v48, v49, s[38:39]
  s_nop 0
  v_add_f32_dpp v39, v39, v39 quad_perm:[1,0,3,2] row_mask:0xf bank_mask:0xf
  v_cndmask_b32 v40, v49, v48, s[38:39]
  v_mov_b32_dpp v46, v41 quad_perm:[1,0,3,2] row_mask:0xf bank_mask:0xf
  v_add_f32_dpp v39, v39, v39 quad_perm:[2,3,0,1] row_mask:0xf bank_mask:0xf
  v_cndmask_b32 v42, v46, v40, s[38:39]
  v_cndmask_b32 v43, v40, v46, s[38:39]
  v_add_f32_dpp v39, v39, v39 row_half_mirror row_mask:0xf bank_mask:0xf
  s_nop 1
  v_add_f32_dpp v47, v39, v39 row_mirror row_mask:0xf bank_mask:0xf
  v_add_f32_dpp v39, v39, v39 row_mirror row_mask:0xf bank_mask:0xf
  s_nop 1
  v_permlane16_swap_b32 v39, v47
  v_add_f32 v39, v39, v47
  v_rcp_f32 v39, v39
  s_mov_b64 exec, s[28:29]
  v_mul_f32 v42, v42, v39
  v_mul_f32 v43, v43, v39
  v_cvt_pk_bf16_f32 v42, v42, v43
  v_min_u32 v42, -2, v42
  s_branch cA_sc3_pst
cA_sc3_retry:
  s_cmp_lg_u32 s62, 0
  s_cbranch_scc1 cA_sc3_cont
  s_waitcnt vmcnt(0) lgkmcnt(0)
cA_sc3_rv:
  buffer_load_dwordx4 v[8:11], v2, s[8:11], s20 offen offset:0 sc1
  buffer_load_dwordx4 v[12:15], v2, s[8:11], s20 offen offset:1024 sc1
  buffer_load_dwordx4 v[16:19], v2, s[8:11], s20 offen offset:2048 sc1
  buffer_load_dwordx4 v[20:23], v2, s[8:11], s20 offen offset:3072 sc1
  buffer_load_dwordx4 v[24:27], v2, s[8:11], s23 offen offset:0 sc1
  buffer_load_dwordx4 v[28:31], v2, s[8:11], s23 offen offset:1024 sc1
  buffer_load_dwordx4 v[32:35], v2, s[8:11], s23 offen offset:2048 sc1
  s_waitcnt vmcnt(0)
  v_max3_u32 v68, v8, v9, v10
  v_max3_u32 v68, v68, v11, v12
  v_max3_u32 v68, v68, v13, v14
  v_max3_u32 v68, v68, v15, v16
  v_max3_u32 v68, v68, v17, v18
  v_max3_u32 v68, v68, v19, v20
  v_max3_u32 v68, v68, v21, v22
  v_max3_u32 v68, v68, v23, v24
  v_max3_u32 v68, v68, v25, v26
  v_max3_u32 v68, v68, v27, v28
  v_max3_u32 v68, v68, v29, v30
  v_max3_u32 v68, v68, v31, v32
  v_max3_u32 v68, v68, v33, v34
  v_max_u32 v68, v68, v35
  v_cmp_eq_u32 vcc, -1, v68
  s_cbranch_vccz cA_sc3_rk
  s_add_u32 s30, s30, 1
  s_cmp_lt_u32 s30, 400000
  s_cbranch_scc1 cA_sc3_rv
  s_branch cA_abort
cA_sc3_rk:
  s_mov_b32 s62, 1
  v_mov_b32 v36, 0
  v_mov_b32 v37, 0
  v_mov_b32 v38, 0
  v_mov_b32 v39, 0
  v_mov_b32 v40, 0
  v_mov_b32 v41, 0
  v_mov_b32 v42, 0
  v_mov_b32 v43, 0
  v_mov_b32 v44, 0
  v_mov_b32 v45, 0
  v_mov_b32 v46, 0
  v_mov_b32 v47, 0
  v_mov_b32 v48, 0
  v_mov_b32 v49, 0
  v_mov_b32 v50, 0
  v_mov_b32 v51, 0
  v_mov_b32 v52, 0
  v_mov_b32 v53, 0
  v_mov_b32 v54, 0
  v_mov_b32 v55, 0
  v_mov_b32 v56, 0
  v_mov_b32 v57, 0
  v_mov_b32 v58, 0
  v_mov_b32 v59, 0
  v_mov_b32 v60, 0
  v_mov_b32 v61, 0
  v_mov_b32 v62, 0
  v_mov_b32 v63, 0
  v_mov_b32 v88, 0
  v_mov_b32 v89, 0
  v_mov_b32 v90, 0
  v_mov_b32 v91, 0
  v_mov_b32 v92, 0
  v_mov_b32 v93, 0
  v_mov_b32 v94, 0
  v_mov_b32 v95, 0
  v_mov_b32 v64, 0
  v_mov_b32 v65, 0
  s_add_u32 s31, s31, 1
  ds_read_b128 v[96:99], v117 offset:0
  ds_read_b128 v[100:103], v117 offset:1024
  ds_read_b128 v[104:107], v117 offset:14336
  ds_read_b128 v[108:111], v117 offset:15360
  v_smfmac_f32_16x16x64_bf16 v[36:39], v[8:11], a[0:7], v3
  v_smfmac_f32_16x16x64_bf16 v[40:43], v[8:11], a[56:63], v3
  v_smfmac_f32_16x16x64_bf16 v[44:47], v[8:11], a[112:119], v3
  v_smfmac_f32_16x16x64_bf16 v[48:51], v[8:11], a[168:175], v3
  v_smfmac_f32_16x16x64_bf16 v[52:55], v[8:11], a[224:231], v3
  v_smfmac_f32_16x16x64_bf16 v[56:59], v[8:11], v[144:151], v3
  v_smfmac_f32_16x16x64_bf16 v[60:63], v[8:11], v[200:207], v3
  v_smfmac_f32_16x16x64_bf16 v[36:39], v[12:15], a[8:15], v3
  v_smfmac_f32_16x16x64_bf16 v[40:43], v[12:15], a[64:71], v3
  v_smfmac_f32_16x16x64_bf16 v[44:47], v[12:15], a[120:127], v3
  v_smfmac_f32_16x16x64_bf16 v[48:51], v[12:15], a[176:183], v3
  v_smfmac_f32_16x16x64_bf16 v[52:55], v[12:15], a[232:239], v3
  v_smfmac_f32_16x16x64_bf16 v[56:59], v[12:15], v[152:159], v3
  v_smfmac_f32_16x16x64_bf16 v[60:63], v[12:15], v[208:215], v3
  v_smfmac_f32_16x16x64_bf16 v[36:39], v[16:19], a[16:23], v3
  v_smfmac_f32_16x16x64_bf16 v[40:43], v[16:19], a[72:79], v3
  v_smfmac_f32_16x16x64_bf16 v[44:47], v[16:19], a[128:135], v3
  v_smfmac_f32_16x16x64_bf16 v[48:51], v[16:19], a[184:191], v3
  v_smfmac_f32_16x16x64_bf16 v[52:55], v[16:19], a[240:247], v3
  v_smfmac_f32_16x16x64_bf16 v[56:59], v[16:19], v[160:167], v3
  v_smfmac_f32_16x16x64_bf16 v[60:63], v[16:19], v[216:223], v3
  v_smfmac_f32_16x16x64_bf16 v[36:39], v[20:23], a[24:31], v3
  v_smfmac_f32_16x16x64_bf16 v[40:43], v[20:23], a[80:87], v3
  v_smfmac_f32_16x16x64_bf16 v[44:47], v[20:23], a[136:143], v3
  v_smfmac_f32_16x16x64_bf16 v[48:51], v[20:23], a[192:199], v3
  v_smfmac_f32_16x16x64_bf16 v[52:55], v[20:23], a[248:255], v3
  v_smfmac_f32_16x16x64_bf16 v[56:59], v[20:23], v[168:175], v3
  v_smfmac_f32_16x16x64_bf16 v[60:63], v[20:23], v[224:231], v3
  s_xor_b32 s58, s25, 28672
  s_add_u32 s59, s24, 28672
  s_add_u32 m0, s58, 21504
  s_branch cA_sc3_ph2
.p2align 6

cA_va0_loop:
  s_add_u32 s23, s20, 4096
  s_add_u32 s21, s20, 20480
  s_mov_b32 s30, 0
  s_cmp_lg_u32 s19, s38
  s_cbranch_scc1 cA_va0_vok
  s_branch cA_va0_voc
cA_va0_vow:
  s_sub_u32 s22, s39, s35
  v_lshlrev_b32 v63, 7, v2
  v_min_u32 v63, s22, v63
  buffer_load_dword v63, v63, s[8:11], s35 offen sc1
  s_waitcnt vmcnt(0)
cA_va0_voc:
  v_readfirstlane_b32 s22, v63
  s_cmp_eq_u32 s22, 56
  s_cbranch_scc1 cA_va0_vod
  s_sleep 1
  s_add_u32 s30, s30, 1
  s_cmp_lt_u32 s30, 400000
  s_cbranch_scc1 cA_va0_vow
  s_branch cA_abort
cA_va0_vod:
  s_add_u32 s35, s35, 2048
  s_add_u32 s38, s19, 8
  s_and_b32 s38, s38, -8
  s_cmp_eq_u32 s19, 0
  s_cselect_b32 s38, 4, s38
  v_cmp_ne_u32 vcc, 56, v63
  s_nop 3
  s_cmp_eq_u64 vcc, 0
  s_cselect_b32 s38, 99, s38
cA_va0_vok:
  s_cmp_eq_u32 s19, 63
  s_cbranch_scc1 cA_done
  s_barrier
  s_add_u32 s22, s25, 0
  buffer_load_dwordx4 v[80:83], v6, s[8:11], s22 offen offset:0 sc1
  buffer_load_dwordx4 v[84:87], v6, s[8:11], s22 offen offset:1792 sc1
  s_add_u32 s22, s25, 3584
  buffer_load_dwordx4 v[88:91], v6, s[8:11], s22 offen offset:0 sc1
  buffer_load_dwordx4 v[92:95], v6, s[8:11], s22 offen offset:1792 sc1
  s_add_u32 s22, s25, 7168
  buffer_load_dwordx4 v[96:99], v6, s[8:11], s22 offen offset:0 sc1
  buffer_load_dwordx4 v[100:103], v6, s[8:11], s22 offen offset:1792 sc1
  s_add_u32 s22, s25, 10752
  buffer_load_dwordx4 v[104:107], v6, s[8:11], s22 offen offset:0 sc1
  buffer_load_dwordx4 v[108:111], v6, s[8:11], s22 offen offset:1792 sc1
  s_add_u32 s22, s25, 14336
  buffer_load_dwordx4 v[112:115], v6, s[8:11], s22 offen offset:0 sc1
  buffer_load_dwordx4 v[116:119], v6, s[8:11], s22 offen offset:1792 sc1
  s_add_u32 s22, s25, 17920
  buffer_load_dwordx4 v[120:123], v6, s[8:11], s22 offen offset:0 sc1
  buffer_load_dwordx4 v[124:127], v6, s[8:11], s22 offen offset:1792 sc1
  s_add_u32 s22, s19, 1
  s_cmp_lg_u32 s22, s38
  s_cbranch_scc1 cA_va0_nk
  s_sub_u32 s22, s39, s35
  v_lshlrev_b32 v63, 7, v2
  v_min_u32 v63, s22, v63
  buffer_load_dword v63, v63, s[8:11], s35 offen sc1
cA_va0_nk:
  s_barrier
  ds_read_b128 v[8:11], v0 offset:8192
  ds_read_b128 v[12:15], v0 offset:9216
  ds_read_b128 v[16:19], v0 offset:10240
  ds_read_b128 v[20:23], v0 offset:11264
  ds_read_b128 v[24:27], v0 offset:12288
  ds_read_b128 v[28:31], v0 offset:13312
  ds_read_b128 v[32:35], v0 offset:14336
  s_waitcnt lgkmcnt(0)
  v_smfmac_f32_16x16x64_bf16 v[36:39], v[8:11], a[0:7], v3
  s_add_u32 s22, s25, 21504
  buffer_load_dwordx4 v[128:131], v6, s[8:11], s22 offen offset:0 sc1
  v_smfmac_f32_16x16x64_bf16 v[36:39], v[12:15], a[8:15], v3
  v_smfmac_f32_16x16x64_bf16 v[36:39], v[16:19], a[16:23], v3
  s_add_u32 s22, s25, 21504
  buffer_load_dwordx4 v[132:135], v6, s[8:11], s22 offen offset:1792 sc1
  v_smfmac_f32_16x16x64_bf16 v[36:39], v[20:23], a[24:31], v3
  v_smfmac_f32_16x16x64_bf16 v[36:39], v[24:27], a[32:39], v3
  s_add_u32 s22, s25, 25088
  buffer_load_dwordx4 v[136:139], v6, s[8:11], s22 offen offset:0 sc1
  v_smfmac_f32_16x16x64_bf16 v[36:39], v[28:31], a[40:47], v3
  v_smfmac_f32_16x16x64_bf16 v[36:39], v[32:35], a[48:55], v3
  s_add_u32 s22, s25, 25088
  buffer_load_dwordx4 v[140:143], v6, s[8:11], s22 offen offset:1792 sc1
  v_smfmac_f32_16x16x64_bf16 v[40:43], v[8:11], a[56:63], v3
  v_smfmac_f32_16x16x64_bf16 v[40:43], v[12:15], a[64:71], v3
  v_smfmac_f32_16x16x64_bf16 v[40:43], v[16:19], a[72:79], v3
  v_add_f32 v36, v36, v37
  v_smfmac_f32_16x16x64_bf16 v[40:43], v[20:23], a[80:87], v3
  v_add_f32 v38, v38, v39
  v_smfmac_f32_16x16x64_bf16 v[40:43], v[24:27], a[88:95], v3
  v_cvt_pk_bf16_f32 v36, v36, v38
  v_smfmac_f32_16x16x64_bf16 v[40:43], v[28:31], a[96:103], v3
  ds_write_b32 v60, v36
  v_smfmac_f32_16x16x64_bf16 v[40:43], v[32:35], a[104:111], v3
  v_smfmac_f32_16x16x64_bf16 v[44:47], v[8:11], a[112:119], v3
  v_smfmac_f32_16x16x64_bf16 v[44:47], v[12:15], a[120:127], v3
  v_smfmac_f32_16x16x64_bf16 v[44:47], v[16:19], a[128:135], v3
  v_add_f32 v40, v40, v41
  v_smfmac_f32_16x16x64_bf16 v[44:47], v[20:23], a[136:143], v3
  v_add_f32 v42, v42, v43
  v_smfmac_f32_16x16x64_bf16 v[44:47], v[24:27], a[144:151], v3
  v_cvt_pk_bf16_f32 v40, v40, v42
  v_smfmac_f32_16x16x64_bf16 v[44:47], v[28:31], a[152:159], v3
  ds_write_b32 v61, v40
  v_smfmac_f32_16x16x64_bf16 v[44:47], v[32:35], a[160:167], v3
  v_smfmac_f32_16x16x64_bf16 v[48:51], v[8:11], a[168:175], v3
  v_smfmac_f32_16x16x64_bf16 v[48:51], v[12:15], a[176:183], v3
  v_smfmac_f32_16x16x64_bf16 v[48:51], v[16:19], a[184:191], v3
  v_add_f32 v44, v44, v45
  v_smfmac_f32_16x16x64_bf16 v[48:51], v[20:23], a[192:199], v3
  v_add_f32 v46, v46, v47
  v_smfmac_f32_16x16x64_bf16 v[48:51], v[24:27], a[200:207], v3
  v_cvt_pk_bf16_f32 v44, v44, v46
  v_smfmac_f32_16x16x64_bf16 v[48:51], v[28:31], a[208:215], v3
  ds_write_b32 v62, v44
  v_smfmac_f32_16x16x64_bf16 v[48:51], v[32:35], a[216:223], v3
  v_smfmac_f32_16x16x64_bf16 v[52:55], v[8:11], a[224:231], v3
  v_smfmac_f32_16x16x64_bf16 v[52:55], v[12:15], a[232:239], v3
  v_smfmac_f32_16x16x64_bf16 v[52:55], v[16:19], a[240:247], v3
  v_add_f32 v48, v48, v49
  v_smfmac_f32_16x16x64_bf16 v[52:55], v[20:23], a[248:255], v3
  v_add_f32 v50, v50, v51
  v_smfmac_f32_16x16x64_bf16 v[52:55], v[24:27], v[176:183], v3
  v_cvt_pk_bf16_f32 v48, v48, v50
  v_smfmac_f32_16x16x64_bf16 v[52:55], v[28:31], v[184:191], v3
  ds_write_b32 v170, v48
  v_smfmac_f32_16x16x64_bf16 v[52:55], v[32:35], v[192:199], v3
  v_smfmac_f32_16x16x64_bf16 v[56:59], v[8:11], v[200:207], v3
  v_smfmac_f32_16x16x64_bf16 v[56:59], v[12:15], v[208:215], v3
  v_smfmac_f32_16x16x64_bf16 v[56:59], v[16:19], v[216:223], v3
  v_add_f32 v52, v52, v53
  v_smfmac_f32_16x16x64_bf16 v[56:59], v[20:23], v[224:231], v3
  v_add_f32 v54, v54, v55
  v_smfmac_f32_16x16x64_bf16 v[56:59], v[24:27], v[232:239], v3
  v_cvt_pk_bf16_f32 v52, v52, v54
  v_smfmac_f32_16x16x64_bf16 v[56:59], v[28:31], v[240:247], v3
  ds_write_b32 v171, v52
  v_smfmac_f32_16x16x64_bf16 v[56:59], v[32:35], v[248:255], v3
  s_nop 7
  v_add_f32 v56, v56, v57
  v_add_f32 v58, v58, v59
  v_cvt_pk_bf16_f32 v56, v56, v58
  ds_write_b32 v172, v56
  buffer_load_dword v164, v4, s[8:11], s20 offen sc1
  s_waitcnt lgkmcnt(0)
  v_mov_b32 v36, 0
  v_mov_b32 v37, 0
  v_mov_b32 v38, 0
  v_mov_b32 v39, 0
  v_mov_b32 v40, 0
  v_mov_b32 v41, 0
  v_mov_b32 v42, 0
  v_mov_b32 v43, 0
  buffer_load_dword v165, v4, s[8:11], s20 offen sc1
  v_mov_b32 v44, 0
  v_mov_b32 v45, 0
  v_mov_b32 v46, 0
  v_mov_b32 v47, 0
  v_mov_b32 v48, 0
  v_mov_b32 v49, 0
  v_mov_b32 v50, 0
  v_mov_b32 v51, 0
  buffer_load_dword v166, v4, s[8:11], s20 offen sc1
  v_mov_b32 v52, 0
  v_mov_b32 v53, 0
  v_mov_b32 v54, 0
  v_mov_b32 v55, 0
  v_mov_b32 v56, 0
  v_mov_b32 v57, 0
  v_mov_b32 v58, 0
  v_mov_b32 v59, 0
  buffer_load_dword v167, v4, s[8:11], s20 offen sc1
  s_cmp_eq_u32 s19, 63
  s_cbranch_scc1 cA_va0_last
  s_add_u32 s22, s20, 9216
  s_add_u32 s34, s20, 13312
  s_add_u32 s36, s20, 7168
  s_mov_b32 s37, 0
  v_mov_b32 v156, 0
  v_mov_b32 v157, 0
  v_mov_b32 v158, 0
  v_mov_b32 v159, 0
  buffer_load_dword v168, v4, s[8:11], s20 offen sc1
cA_va0_fw_l:
  s_waitcnt vmcnt(4)
  v_cmp_eq_u32 vcc, -1, v164
  s_cbranch_vccz cA_va0_fw_d
  buffer_load_dword v164, v4, s[8:11], s20 offen sc1
  s_waitcnt vmcnt(4)
  v_cmp_eq_u32 vcc, -1, v165
  s_cbranch_vccz cA_va0_fw_d
  buffer_load_dword v165, v4, s[8:11], s20 offen sc1
  s_waitcnt vmcnt(4)
  v_cmp_eq_u32 vcc, -1, v166
  s_cbranch_vccz cA_va0_fw_d
  buffer_load_dword v166, v4, s[8:11], s20 offen sc1
  s_waitcnt vmcnt(4)
  v_cmp_eq_u32 vcc, -1, v167
  s_cbranch_vccz cA_va0_fw_d
  buffer_load_dword v167, v4, s[8:11], s20 offen sc1
  s_waitcnt vmcnt(4)
  v_cmp_eq_u32 vcc, -1, v168
  s_cbranch_vccz cA_va0_fw_d
  buffer_load_dword v168, v4, s[8:11], s20 offen sc1
  s_add_u32 s30, s30, 1
  s_cmp_lt_u32 s30, 400000
  s_cbranch_scc1 cA_va0_fw_l
  s_branch cA_abort
cA_va0_fw_d:
  s_waitcnt lgkmcnt(0)
  buffer_load_dwordx4 v[8:11], v5, s[8:11], s22 offen offset:0
  buffer_load_dwordx4 v[12:15], v5, s[8:11], s22 offen offset:1024
  buffer_load_dwordx4 v[16:19], v5, s[8:11], s22 offen offset:2048
  buffer_load_dwordx4 v[20:23], v5, s[8:11], s22 offen offset:3072
  buffer_load_dwordx4 v[24:27], v5, s[8:11], s34 offen offset:0
  buffer_load_dwordx4 v[28:31], v5, s[8:11], s34 offen offset:1024
  buffer_load_dwordx4 v[32:35], v5, s[8:11], s34 offen offset:2048
  buffer_load_dwordx4 v[144:147], v5, s[8:11], s34 offen offset:3072
  buffer_load_dwordx4 v[148:151], v2, s[8:11], s36 offen offset:0
  buffer_load_dwordx4 v[152:155], v2, s[8:11], s36 offen offset:1024
  s_barrier
  ds_read_b128 v[64:67], v2 offset:0
  ds_read_b128 v[68:71], v2 offset:1024
  ds_read_b128 v[72:75], v2 offset:2048
  ds_read_b128 v[76:79], v2 offset:3072
  s_waitcnt vmcnt(9)
  v_smfmac_f32_16x16x64_bf16 v[156:159], v[8:11], v[80:87], v3
  s_waitcnt vmcnt(8)
  v_smfmac_f32_16x16x64_bf16 v[156:159], v[12:15], v[88:95], v3
  s_waitcnt vmcnt(7)
  v_smfmac_f32_16x16x64_bf16 v[156:159], v[16:19], v[96:103], v3
  s_waitcnt vmcnt(6)
  v_smfmac_f32_16x16x64_bf16 v[156:159], v[20:23], v[104:111], v3
  s_waitcnt vmcnt(5)
  v_smfmac_f32_16x16x64_bf16 v[156:159], v[24:27], v[112:119], v3
  s_waitcnt vmcnt(4)
  v_smfmac_f32_16x16x64_bf16 v[156:159], v[28:31], v[120:127], v3
  s_waitcnt vmcnt(3)
  v_smfmac_f32_16x16x64_bf16 v[156:159], v[32:35], v[128:135], v3
  s_waitcnt vmcnt(2)
  v_smfmac_f32_16x16x64_bf16 v[156:159], v[144:147], v[136:143], v3
  s_waitcnt vmcnt(1) lgkmcnt(0)
  v_smfmac_f32_16x16x64_bf16 v[156:159], v[148:151], v[64:71], v3
  s_waitcnt vmcnt(0)
  v_smfmac_f32_16x16x64_bf16 v[156:159], v[152:155], v[72:79], v3
cA_va0_ep:
  s_nop 7
  v_add_f32 v160, v156, v157
  v_add_f32 v161, v158, v159
  v_cmp_u_f32 vcc, v160, v161
  v_mov_b32_dpp v162, v160 row_ror:8 row_mask:0xf bank_mask:0xf
  v_mov_b32_dpp v160, v161 row_ror:8 row_mask:0xf bank_mask:0xc
  s_cbranch_vccnz cA_va0_rp
  v_mov_b32_dpp v161, v162 quad_perm:[0,1,2,3] row_mask:0xf bank_mask:0x3
  v_cvt_pk_bf16_f32 v160, v160, v161
cA_va0_pc:
  buffer_store_dword v160, v1, s[8:11], s21 offen
  s_cmp_lg_u32 s19, 62
  s_cbranch_scc1 cA_va0_nl
  s_mov_b32 s22, 88531968
  buffer_store_dword v160, v1, s[8:11], s22 offen sc1
  s_mov_b64 exec, -1
  s_branch cA_done
cA_va0_nl:
  s_mov_b64 exec, -1
  s_add_u32 s25, s25, 28672
  s_add_u32 s19, s19, 1
  s_mov_b32 s20, s21
  s_branch cA_va0_loop
cA_va0_last:
  s_waitcnt lgkmcnt(0)
  s_barrier
  s_branch cA_done
cA_va0_rp:
  s_cmp_eq_u32 s37, 0
  s_cbranch_scc1 cA_va0_rv
  v_mov_b32_dpp v161, v162 quad_perm:[0,1,2,3] row_mask:0xf bank_mask:0x3
  v_cvt_pk_bf16_f32 v160, v160, v161
  v_min_u32 v160, -2, v160
  s_branch cA_va0_pc
cA_va0_rv:
  buffer_load_dwordx4 v[8:11], v5, s[8:11], s22 offen offset:0 sc1
  buffer_load_dwordx4 v[12:15], v5, s[8:11], s22 offen offset:1024 sc1
  buffer_load_dwordx4 v[16:19], v5, s[8:11], s22 offen offset:2048 sc1
  buffer_load_dwordx4 v[20:23], v5, s[8:11], s22 offen offset:3072 sc1
  buffer_load_dwordx4 v[24:27], v5, s[8:11], s34 offen offset:0 sc1
  buffer_load_dwordx4 v[28:31], v5, s[8:11], s34 offen offset:1024 sc1
  buffer_load_dwordx4 v[32:35], v5, s[8:11], s34 offen offset:2048 sc1
  buffer_load_dwordx4 v[144:147], v5, s[8:11], s34 offen offset:3072 sc1
  buffer_load_dwordx4 v[148:151], v2, s[8:11], s36 offen offset:0 sc1
  buffer_load_dwordx4 v[152:155], v2, s[8:11], s36 offen offset:1024 sc1
  s_waitcnt vmcnt(0)
  v_max3_u32 v175, v8, v9, v10
  v_max3_u32 v175, v175, v11, v12
  v_max3_u32 v175, v175, v13, v14
  v_max3_u32 v175, v175, v15, v16
  v_max3_u32 v175, v175, v17, v18
  v_max3_u32 v175, v175, v19, v20
  v_max3_u32 v175, v175, v21, v22
  v_max3_u32 v175, v175, v23, v24
  v_max3_u32 v175, v175, v25, v26
  v_max3_u32 v175, v175, v27, v28
  v_max3_u32 v175, v175, v29, v30
  v_max3_u32 v175, v175, v31, v32
  v_max3_u32 v175, v175, v33, v34
  v_max3_u32 v175, v175, v35, v144
  v_max3_u32 v175, v175, v145, v146
  v_max3_u32 v175, v175, v147, v148
  v_max3_u32 v175, v175, v149, v150
  v_max3_u32 v175, v175, v151, v152
  v_max3_u32 v175, v175, v153, v154
  v_max_u32 v175, v175, v155
  v_cmp_eq_u32 vcc, -1, v175
  s_cbranch_vccz cA_va0_rk
  s_add_u32 s30, s30, 1
  s_cmp_lt_u32 s30, 400000
  s_cbranch_scc1 cA_va0_rv
  s_branch cA_abort
cA_va0_rk:
  s_mov_b32 s37, 1
  s_add_u32 s31, s31, 0x10000
  v_mov_b32 v156, 0
  v_mov_b32 v157, 0
  v_mov_b32 v158, 0
  v_mov_b32 v159, 0
  s_nop 1
  v_smfmac_f32_16x16x64_bf16 v[156:159], v[8:11], v[80:87], v3
  v_smfmac_f32_16x16x64_bf16 v[156:159], v[12:15], v[88:95], v3
  v_smfmac_f32_16x16x64_bf16 v[156:159], v[16:19], v[96:103], v3
  v_smfmac_f32_16x16x64_bf16 v[156:159], v[20:23], v[104:111], v3
  v_smfmac_f32_16x16x64_bf16 v[156:159], v[24:27], v[112:119], v3
  v_smfmac_f32_16x16x64_bf16 v[156:159], v[28:31], v[120:127], v3
  v_smfmac_f32_16x16x64_bf16 v[156:159], v[32:35], v[128:135], v3
  v_smfmac_f32_16x16x64_bf16 v[156:159], v[144:147], v[136:143], v3
  v_smfmac_f32_16x16x64_bf16 v[156:159], v[148:151], v[64:71], v3
  v_smfmac_f32_16x16x64_bf16 v[156:159], v[152:155], v[72:79], v3
  s_nop 7
  s_branch cA_va0_ep
.p2align 6

cA_va1_loop:
  s_add_u32 s23, s20, 4096
  s_add_u32 s21, s20, 20480
  s_mov_b32 s30, 0
  s_cmp_lg_u32 s19, s38
  s_cbranch_scc1 cA_va1_vok
  s_branch cA_va1_voc
cA_va1_vow:
  s_sub_u32 s22, s39, s35
  v_lshlrev_b32 v63, 7, v2
  v_min_u32 v63, s22, v63
  buffer_load_dword v63, v63, s[8:11], s35 offen sc1
  s_waitcnt vmcnt(0)
cA_va1_voc:
  v_readfirstlane_b32 s22, v63
  s_cmp_eq_u32 s22, 56
  s_cbranch_scc1 cA_va1_vod
  s_sleep 1
  s_add_u32 s30, s30, 1
  s_cmp_lt_u32 s30, 400000
  s_cbranch_scc1 cA_va1_vow
  s_branch cA_abort
cA_va1_vod:
  s_add_u32 s35, s35, 2048
  s_add_u32 s38, s19, 8
  s_and_b32 s38, s38, -8
  s_cmp_eq_u32 s19, 0
  s_cselect_b32 s38, 4, s38
  v_cmp_ne_u32 vcc, 56, v63
  s_nop 3
  s_cmp_eq_u64 vcc, 0
  s_cselect_b32 s38, 99, s38
cA_va1_vok:
  s_cmp_eq_u32 s19, 63
  s_cbranch_scc1 cA_done
  s_barrier
  s_add_u32 s22, s25, 0
  buffer_load_dwordx4 v[80:83], v6, s[8:11], s22 offen offset:0 sc1
  buffer_load_dwordx4 v[84:87], v6, s[8:11], s22 offen offset:1792 sc1
  s_add_u32 s22, s25, 3584
  buffer_load_dwordx4 v[88:91], v6, s[8:11], s22 offen offset:0 sc1
  buffer_load_dwordx4 v[92:95], v6, s[8:11], s22 offen offset:1792 sc1
  s_add_u32 s22, s25, 7168
  buffer_load_dwordx4 v[96:99], v6, s[8:11], s22 offen offset:0 sc1
  buffer_load_dwordx4 v[100:103], v6, s[8:11], s22 offen offset:1792 sc1
  s_add_u32 s22, s25, 10752
  buffer_load_dwordx4 v[104:107], v6, s[8:11], s22 offen offset:0 sc1
  buffer_load_dwordx4 v[108:111], v6, s[8:11], s22 offen offset:1792 sc1
  s_add_u32 s22, s25, 14336
  buffer_load_dwordx4 v[112:115], v6, s[8:11], s22 offen offset:0 sc1
  buffer_load_dwordx4 v[116:119], v6, s[8:11], s22 offen offset:1792 sc1
  s_add_u32 s22, s25, 17920
  buffer_load_dwordx4 v[120:123], v6, s[8:11], s22 offen offset:0 sc1
  buffer_load_dwordx4 v[124:127], v6, s[8:11], s22 offen offset:1792 sc1
  s_add_u32 s22, s19, 1
  s_cmp_lg_u32 s22, s38
  s_cbranch_scc1 cA_va1_nk
  s_sub_u32 s22, s39, s35
  v_lshlrev_b32 v63, 7, v2
  v_min_u32 v63, s22, v63
  buffer_load_dword v63, v63, s[8:11], s35 offen sc1
cA_va1_nk:
  s_barrier
  ds_read_b128 v[8:11], v0 offset:8192
  ds_read_b128 v[12:15], v0 offset:9216
  ds_read_b128 v[16:19], v0 offset:10240
  ds_read_b128 v[20:23], v0 offset:11264
  ds_read_b128 v[24:27], v0 offset:12288
  ds_read_b128 v[28:31], v0 offset:13312
  ds_read_b128 v[32:35], v0 offset:14336
  s_waitcnt lgkmcnt(0)
  v_smfmac_f32_16x16x64_bf16 v[36:39], v[8:11], a[0:7], v3
  s_add_u32 s22, s25, 21504
  buffer_load_dwordx4 v[128:131], v6, s[8:11], s22 offen offset:0 sc1
  v_smfmac_f32_16x16x64_bf16 v[36:39], v[12:15], a[8:15], v3
  v_smfmac_f32_16x16x64_bf16 v[36:39], v[16:19], a[16:23], v3
  s_add_u32 s22, s25, 21504
  buffer_load_dwordx4 v[132:135], v6, s[8:11], s22 offen offset:1792 sc1
  v_smfmac_f32_16x16x64_bf16 v[36:39], v[20:23], a[24:31], v3
  v_smfmac_f32_16x16x64_bf16 v[36:39], v[24:27], a[32:39], v3
  s_add_u32 s22, s25, 25088
  buffer_load_dwordx4 v[136:139], v6, s[8:11], s22 offen offset:0 sc1
  v_smfmac_f32_16x16x64_bf16 v[36:39], v[28:31], a[40:47], v3
  v_smfmac_f32_16x16x64_bf16 v[36:39], v[32:35], a[48:55], v3
  s_add_u32 s22, s25, 25088
  buffer_load_dwordx4 v[140:143], v6, s[8:11], s22 offen offset:1792 sc1
  v_smfmac_f32_16x16x64_bf16 v[40:43], v[8:11], a[56:63], v3
  v_smfmac_f32_16x16x64_bf16 v[40:43], v[12:15], a[64:71], v3
  v_smfmac_f32_16x16x64_bf16 v[40:43], v[16:19], a[72:79], v3
  v_add_f32 v36, v36, v37
  v_smfmac_f32_16x16x64_bf16 v[40:43], v[20:23], a[80:87], v3
  v_add_f32 v38, v38, v39
  v_smfmac_f32_16x16x64_bf16 v[40:43], v[24:27], a[88:95], v3
  v_cvt_pk_bf16_f32 v36, v36, v38
  v_smfmac_f32_16x16x64_bf16 v[40:43], v[28:31], a[96:103], v3
  ds_write_b32 v60, v36
  v_smfmac_f32_16x16x64_bf16 v[40:43], v[32:35], a[104:111], v3
  v_smfmac_f32_16x16x64_bf16 v[44:47], v[8:11], a[112:119], v3
  v_smfmac_f32_16x16x64_bf16 v[44:47], v[12:15], a[120:127], v3
  v_smfmac_f32_16x16x64_bf16 v[44:47], v[16:19], a[128:135], v3
  v_add_f32 v40, v40, v41
  v_smfmac_f32_16x16x64_bf16 v[44:47], v[20:23], a[136:143], v3
  v_add_f32 v42, v42, v43
  v_smfmac_f32_16x16x64_bf16 v[44:47], v[24:27], a[144:151], v3
  v_cvt_pk_bf16_f32 v40, v40, v42
  v_smfmac_f32_16x16x64_bf16 v[44:47], v[28:31], a[152:159], v3
  ds_write_b32 v61, v40
  v_smfmac_f32_16x16x64_bf16 v[44:47], v[32:35], a[160:167], v3
  v_smfmac_f32_16x16x64_bf16 v[48:51], v[8:11], a[168:175], v3
  v_smfmac_f32_16x16x64_bf16 v[48:51], v[12:15], a[176:183], v3
  v_smfmac_f32_16x16x64_bf16 v[48:51], v[16:19], a[184:191], v3
  v_add_f32 v44, v44, v45
  v_smfmac_f32_16x16x64_bf16 v[48:51], v[20:23], a[192:199], v3
  v_add_f32 v46, v46, v47
  v_smfmac_f32_16x16x64_bf16 v[48:51], v[24:27], a[200:207], v3
  v_cvt_pk_bf16_f32 v44, v44, v46
  v_smfmac_f32_16x16x64_bf16 v[48:51], v[28:31], a[208:215], v3
  ds_write_b32 v62, v44
  v_smfmac_f32_16x16x64_bf16 v[48:51], v[32:35], a[216:223], v3
  v_smfmac_f32_16x16x64_bf16 v[52:55], v[8:11], a[224:231], v3
  v_smfmac_f32_16x16x64_bf16 v[52:55], v[12:15], a[232:239], v3
  v_smfmac_f32_16x16x64_bf16 v[52:55], v[16:19], a[240:247], v3
  v_add_f32 v48, v48, v49
  v_smfmac_f32_16x16x64_bf16 v[52:55], v[20:23], a[248:255], v3
  v_add_f32 v50, v50, v51
  v_smfmac_f32_16x16x64_bf16 v[52:55], v[24:27], v[176:183], v3
  v_cvt_pk_bf16_f32 v48, v48, v50
  v_smfmac_f32_16x16x64_bf16 v[52:55], v[28:31], v[184:191], v3
  ds_write_b32 v170, v48
  v_smfmac_f32_16x16x64_bf16 v[52:55], v[32:35], v[192:199], v3
  v_smfmac_f32_16x16x64_bf16 v[56:59], v[8:11], v[200:207], v3
  v_smfmac_f32_16x16x64_bf16 v[56:59], v[12:15], v[208:215], v3
  v_smfmac_f32_16x16x64_bf16 v[56:59], v[16:19], v[216:223], v3
  v_add_f32 v52, v52, v53
  v_smfmac_f32_16x16x64_bf16 v[56:59], v[20:23], v[224:231], v3
  v_add_f32 v54, v54, v55
  v_smfmac_f32_16x16x64_bf16 v[56:59], v[24:27], v[232:239], v3
  v_cvt_pk_bf16_f32 v52, v52, v54
  v_smfmac_f32_16x16x64_bf16 v[56:59], v[28:31], v[240:247], v3
  ds_write_b32 v171, v52
  v_smfmac_f32_16x16x64_bf16 v[56:59], v[32:35], v[248:255], v3
  s_nop 7
  v_add_f32 v56, v56, v57
  v_add_f32 v58, v58, v59
  v_cvt_pk_bf16_f32 v56, v56, v58
  ds_write_b32 v172, v56
  s_waitcnt lgkmcnt(0)
  v_mov_b32 v36, 0
  v_mov_b32 v37, 0
  v_mov_b32 v38, 0
  v_mov_b32 v39, 0
  v_mov_b32 v40, 0
  v_mov_b32 v41, 0
  v_mov_b32 v42, 0
  v_mov_b32 v43, 0
  v_mov_b32 v44, 0
  v_mov_b32 v45, 0
  v_mov_b32 v46, 0
  v_mov_b32 v47, 0
  v_mov_b32 v48, 0
  v_mov_b32 v49, 0
  v_mov_b32 v50, 0
  v_mov_b32 v51, 0
  v_mov_b32 v52, 0
  v_mov_b32 v53, 0
  v_mov_b32 v54, 0
  v_mov_b32 v55, 0
  v_mov_b32 v56, 0
  v_mov_b32 v57, 0
  v_mov_b32 v58, 0
  v_mov_b32 v59, 0
  s_cmp_eq_u32 s19, 63
  s_cbranch_scc1 cA_va1_last
  s_add_u32 s22, s20, 9216
  s_add_u32 s34, s20, 13312
  s_add_u32 s36, s20, 7168
  s_mov_b32 s37, 0
  v_mov_b32 v156, 0
  v_mov_b32 v157, 0
  v_mov_b32 v158, 0
  v_mov_b32 v159, 0
  s_barrier
  s_waitcnt lgkmcnt(0)
  buffer_load_dwordx4 v[8:11], v5, s[8:11], s22 offen offset:0
  buffer_load_dwordx4 v[12:15], v5, s[8:11], s22 offen offset:1024
  buffer_load_dwordx4 v[16:19], v5, s[8:11], s22 offen offset:2048
  buffer_load_dwordx4 v[20:23], v5, s[8:11], s22 offen offset:3072
  buffer_load_dwordx4 v[24:27], v5, s[8:11], s34 offen offset:0
  buffer_load_dwordx4 v[28:31], v5, s[8:11], s34 offen offset:1024
  buffer_load_dwordx4 v[32:35], v5, s[8:11], s34 offen offset:2048
  buffer_load_dwordx4 v[144:147], v5, s[8:11], s34 offen offset:3072
  s_sub_u32 s23, s21, 4
  s_mov_b64 exec, 65535
  buffer_store_dword v2, v7, s[8:11], s23 offen
  s_mov_b64 exec, -1
  buffer_load_dwordx4 v[148:151], v2, s[8:11], s36 offen offset:0
  buffer_load_dwordx4 v[152:155], v2, s[8:11], s36 offen offset:1024
  ds_read_b128 v[64:67], v2 offset:4096
  ds_read_b128 v[68:71], v2 offset:5120
  ds_read_b128 v[72:75], v2 offset:6144
  ds_read_b128 v[76:79], v2 offset:7168
  s_waitcnt vmcnt(10)
  v_smfmac_f32_16x16x64_bf16 v[156:159], v[8:11], v[80:87], v3
  s_waitcnt vmcnt(9)
  v_smfmac_f32_16x16x64_bf16 v[156:159], v[12:15], v[88:95], v3
  s_waitcnt vmcnt(8)
  v_smfmac_f32_16x16x64_bf16 v[156:159], v[16:19], v[96:103], v3
  s_waitcnt vmcnt(7)
  v_smfmac_f32_16x16x64_bf16 v[156:159], v[20:23], v[104:111], v3
  s_waitcnt vmcnt(6)
  v_smfmac_f32_16x16x64_bf16 v[156:159], v[24:27], v[112:119], v3
  s_mov_b64 exec, 65535
  buffer_store_dword v2, v7, s[8:11], s21 offen
  s_mov_b64 exec, -1
  s_waitcnt vmcnt(6)
  v_smfmac_f32_16x16x64_bf16 v[156:159], v[28:31], v[120:127], v3
  s_waitcnt vmcnt(5)
  v_smfmac_f32_16x16x64_bf16 v[156:159], v[32:35], v[128:135], v3
  s_waitcnt vmcnt(4)
  v_smfmac_f32_16x16x64_bf16 v[156:159], v[144:147], v[136:143], v3
  s_waitcnt vmcnt(2) lgkmcnt(0)
  v_smfmac_f32_16x16x64_bf16 v[156:159], v[148:151], v[64:71], v3
  s_waitcnt vmcnt(1)
  v_smfmac_f32_16x16x64_bf16 v[156:159], v[152:155], v[72:79], v3
cA_va1_ep:
  s_nop 7
  v_add_f32 v160, v156, v157
  v_add_f32 v161, v158, v159
  v_cmp_u_f32 vcc, v160, v161
  v_mov_b32_dpp v162, v160 row_ror:8 row_mask:0xf bank_mask:0xf
  v_mov_b32_dpp v160, v161 row_ror:8 row_mask:0xf bank_mask:0xc
  s_cbranch_vccnz cA_va1_rp
  v_mov_b32_dpp v161, v162 quad_perm:[0,1,2,3] row_mask:0xf bank_mask:0x3
  v_cvt_pk_bf16_f32 v160, v160, v161
cA_va1_pc:
  s_mov_b64 exec, s[26:27]
  buffer_store_dword v160, v1, s[8:11], s21 offen
  s_cmp_lg_u32 s19, 62
  s_cbranch_scc1 cA_va1_nl
  s_mov_b32 s22, 88531968
  buffer_store_dword v160, v1, s[8:11], s22 offen sc1
  s_mov_b64 exec, -1
  s_branch cA_done
cA_va1_nl:
  s_mov_b64 exec, -1
  s_cmp_lg_u32 s19, 0
  s_cbranch_scc1 cA_va1_s0
  v_add_u32 v7, 512, v7
  v_lshl_add_u32 v7, v2, 3, v7
  s_mov_b64 exec, 65535
  buffer_store_dword v2, v7, s[8:11], s21 offen
  buffer_store_dword v2, v7, s[8:11], s23 offen
  s_mov_b64 exec, -1
cA_va1_s0:
  s_add_u32 s25, s25, 28672
  s_add_u32 s19, s19, 1
  s_mov_b32 s20, s21
  s_branch cA_va1_loop
cA_va1_last:
  s_waitcnt lgkmcnt(0)
  s_barrier
  s_branch cA_done
cA_va1_rp:
  s_cmp_eq_u32 s37, 0
  s_cbranch_scc1 cA_va1_rv
  v_mov_b32_dpp v161, v162 quad_perm:[0,1,2,3] row_mask:0xf bank_mask:0x3
  v_cvt_pk_bf16_f32 v160, v160, v161
  v_min_u32 v160, -2, v160
  s_branch cA_va1_pc
cA_va1_rv:
  buffer_load_dwordx4 v[8:11], v5, s[8:11], s22 offen offset:0 sc1
  buffer_load_dwordx4 v[12:15], v5, s[8:11], s22 offen offset:1024 sc1
  buffer_load_dwordx4 v[16:19], v5, s[8:11], s22 offen offset:2048 sc1
  buffer_load_dwordx4 v[20:23], v5, s[8:11], s22 offen offset:3072 sc1
  buffer_load_dwordx4 v[24:27], v5, s[8:11], s34 offen offset:0 sc1
  buffer_load_dwordx4 v[28:31], v5, s[8:11], s34 offen offset:1024 sc1
  buffer_load_dwordx4 v[32:35], v5, s[8:11], s34 offen offset:2048 sc1
  buffer_load_dwordx4 v[144:147], v5, s[8:11], s34 offen offset:3072 sc1
  buffer_load_dwordx4 v[148:151], v2, s[8:11], s36 offen offset:0 sc1
  buffer_load_dwordx4 v[152:155], v2, s[8:11], s36 offen offset:1024 sc1
  s_waitcnt vmcnt(0)
  v_max3_u32 v175, v8, v9, v10
  v_max3_u32 v175, v175, v11, v12
  v_max3_u32 v175, v175, v13, v14
  v_max3_u32 v175, v175, v15, v16
  v_max3_u32 v175, v175, v17, v18
  v_max3_u32 v175, v175, v19, v20
  v_max3_u32 v175, v175, v21, v22
  v_max3_u32 v175, v175, v23, v24
  v_max3_u32 v175, v175, v25, v26
  v_max3_u32 v175, v175, v27, v28
  v_max3_u32 v175, v175, v29, v30
  v_max3_u32 v175, v175, v31, v32
  v_max3_u32 v175, v175, v33, v34
  v_max3_u32 v175, v175, v35, v144
  v_max3_u32 v175, v175, v145, v146
  v_max3_u32 v175, v175, v147, v148
  v_max3_u32 v175, v175, v149, v150
  v_max3_u32 v175, v175, v151, v152
  v_max3_u32 v175, v175, v153, v154
  v_max_u32 v175, v175, v155
  v_cmp_eq_u32 vcc, -1, v175
  s_cbranch_vccz cA_va1_rk
  s_add_u32 s30, s30, 1
  s_cmp_lt_u32 s30, 400000
  s_cbranch_scc1 cA_va1_rv
  s_branch cA_abort
cA_va1_rk:
  s_mov_b32 s37, 1
  s_add_u32 s31, s31, 0x10000
  v_mov_b32 v156, 0
  v_mov_b32 v157, 0
  v_mov_b32 v158, 0
  v_mov_b32 v159, 0
  s_nop 1
  v_smfmac_f32_16x16x64_bf16 v[156:159], v[8:11], v[80:87], v3
  v_smfmac_f32_16x16x64_bf16 v[156:159], v[12:15], v[88:95], v3
  v_smfmac_f32_16x16x64_bf16 v[156:159], v[16:19], v[96:103], v3
  v_smfmac_f32_16x16x64_bf16 v[156:159], v[20:23], v[104:111], v3
  v_smfmac_f32_16x16x64_bf16 v[156:159], v[24:27], v[112:119], v3
  v_smfmac_f32_16x16x64_bf16 v[156:159], v[28:31], v[120:127], v3
  v_smfmac_f32_16x16x64_bf16 v[156:159], v[32:35], v[128:135], v3
  v_smfmac_f32_16x16x64_bf16 v[156:159], v[144:147], v[136:143], v3
  v_smfmac_f32_16x16x64_bf16 v[156:159], v[148:151], v[64:71], v3
  v_smfmac_f32_16x16x64_bf16 v[156:159], v[152:155], v[72:79], v3
  s_nop 7
  s_branch cA_va1_ep
.p2align 6

cA_va2_loop:
  s_add_u32 s23, s20, 4096
  s_add_u32 s21, s20, 20480
  v_mov_b32 v36, 0
  v_mov_b32 v37, 0
  v_mov_b32 v38, 0
  v_mov_b32 v39, 0
  v_mov_b32 v40, 0
  v_mov_b32 v41, 0
  v_mov_b32 v42, 0
  v_mov_b32 v43, 0
  v_mov_b32 v44, 0
  v_mov_b32 v45, 0
  v_mov_b32 v46, 0
  v_mov_b32 v47, 0
  v_mov_b32 v48, 0
  v_mov_b32 v49, 0
  v_mov_b32 v50, 0
  v_mov_b32 v51, 0
  v_mov_b32 v52, 0
  v_mov_b32 v53, 0
  v_mov_b32 v54, 0
  v_mov_b32 v55, 0
  v_mov_b32 v56, 0
  v_mov_b32 v57, 0
  v_mov_b32 v58, 0
  v_mov_b32 v59, 0
  v_mov_b32 v60, 0
  v_mov_b32 v61, 0
  v_mov_b32 v62, 0
  v_mov_b32 v63, 0
  v_mov_b32 v64, 0
  v_mov_b32 v65, 0
  v_mov_b32 v66, 0
  v_mov_b32 v67, 0
  s_mov_b32 s30, 0
  buffer_load_dword v76, v119, s[8:11], s20 offen sc1
  buffer_load_dword v77, v119, s[8:11], s20 offen sc1
  buffer_load_dword v78, v119, s[8:11], s20 offen sc1
cA_va2_fp_l:
  s_waitcnt vmcnt(2)
  v_cmp_eq_u32 vcc, -1, v76
  s_cbranch_vccz cA_va2_fp_d
  buffer_load_dword v76, v119, s[8:11], s20 offen sc1
  s_waitcnt vmcnt(2)
  v_cmp_eq_u32 vcc, -1, v77
  s_cbranch_vccz cA_va2_fp_d
  buffer_load_dword v77, v119, s[8:11], s20 offen sc1
  s_waitcnt vmcnt(2)
  v_cmp_eq_u32 vcc, -1, v78
  s_cbranch_vccz cA_va2_fp_d
  buffer_load_dword v78, v119, s[8:11], s20 offen sc1
  s_add_u32 s30, s30, 1
  s_cmp_lt_u32 s30, 400000
  s_cbranch_scc1 cA_va2_fp_l
  s_branch cA_abort
cA_va2_fp_d:
  s_nop 15
  s_nop 3
  buffer_load_dwordx4 v[8:11], v2, s[8:11], s20 offen offset:0 sc1
  buffer_load_dwordx4 v[12:15], v2, s[8:11], s20 offen offset:1024 sc1
  buffer_load_dwordx4 v[16:19], v2, s[8:11], s20 offen offset:2048 sc1
  buffer_load_dwordx4 v[20:23], v2, s[8:11], s20 offen offset:3072 sc1
  s_barrier
cA_va2_ld:
  s_waitcnt vmcnt(0)
  v_max3_u32 v84, v8, v9, v10
  v_max3_u32 v84, v84, v11, v12
  v_max3_u32 v84, v84, v13, v14
  v_max3_u32 v84, v84, v15, v16
  v_max3_u32 v84, v84, v17, v18
  v_max3_u32 v84, v84, v19, v20
  v_max3_u32 v84, v84, v21, v22
  v_max_u32 v84, v84, v23
  v_cmp_eq_u32 vcc, -1, v84
  ds_write_b128 v2, v[8:11] offset:8192
  ds_write_b128 v2, v[12:15] offset:9216
  ds_write_b128 v2, v[16:19] offset:10240
  ds_write_b128 v2, v[20:23] offset:11264
  s_cbranch_vccnz cA_va2_retry
  s_waitcnt lgkmcnt(0)
  s_barrier
  ds_read_b128 v[8:11], v5 offset:8192
  ds_read_b128 v[12:15], v5 offset:9216
  ds_read_b128 v[16:19], v5 offset:10240
  ds_read_b128 v[20:23], v5 offset:11264
  ds_read_b128 v[24:27], v5 offset:12288
  ds_read_b128 v[28:31], v5 offset:13312
  ds_read_b128 v[32:35], v5 offset:14336
  ds_read_b128 v[92:95], v0
  s_waitcnt lgkmcnt(0)
  s_mov_b64 exec, s[26:27]
  buffer_store_dwordx4 v[92:95], v2, s[8:11], s36 offen sc1
  s_mov_b64 exec, -1
  s_add_u32 s36, s36, 7168
  s_cmp_eq_u32 s19, 63
  s_cbranch_scc1 cA_done
  ds_read_b128 v[76:79], v1 offset:0
  ds_read_b128 v[80:83], v1 offset:1024
  ds_read_b128 v[84:87], v1 offset:2048
  ds_read_b128 v[88:91], v1 offset:3072
  ds_read_b128 v[92:95], v1 offset:4096
  ds_read_b128 v[96:99], v1 offset:5120
  v_smfmac_f32_16x16x64_bf16 v[60:63], v[8:11], v[200:207], v3
  v_smfmac_f32_16x16x64_bf16 v[60:63], v[12:15], v[208:215], v3
  s_waitcnt lgkmcnt(4)
  v_smfmac_f32_16x16x64_bf16 v[64:67], v[8:11], v[76:83], v3
  ds_read_b128 v[76:79], v1 offset:6144
  ds_read_b128 v[80:83], v1 offset:7168
  v_smfmac_f32_16x16x64_bf16 v[60:63], v[16:19], v[216:223], v3
  v_smfmac_f32_16x16x64_bf16 v[60:63], v[20:23], v[224:231], v3
  s_waitcnt lgkmcnt(4)
  v_smfmac_f32_16x16x64_bf16 v[64:67], v[12:15], v[84:91], v3
  ds_read_b128 v[84:87], v1 offset:8192
  ds_read_b128 v[88:91], v1 offset:9216
  v_smfmac_f32_16x16x64_bf16 v[60:63], v[24:27], v[232:239], v3
  v_smfmac_f32_16x16x64_bf16 v[60:63], v[28:31], v[240:247], v3
  s_waitcnt lgkmcnt(4)
  v_smfmac_f32_16x16x64_bf16 v[64:67], v[16:19], v[92:99], v3
  ds_read_b128 v[92:95], v1 offset:10240
  ds_read_b128 v[96:99], v1 offset:11264
  v_smfmac_f32_16x16x64_bf16 v[60:63], v[32:35], v[248:255], v3
  v_smfmac_f32_16x16x64_bf16 v[36:39], v[8:11], a[0:7], v3
  s_waitcnt lgkmcnt(4)
  v_smfmac_f32_16x16x64_bf16 v[64:67], v[20:23], v[76:83], v3
  ds_read_b128 v[76:79], v1 offset:12288
  ds_read_b128 v[80:83], v1 offset:13312
  v_smfmac_f32_16x16x64_bf16 v[36:39], v[12:15], a[8:15], v3
  v_add_f32 v60, v60, v61
  v_smfmac_f32_16x16x64_bf16 v[36:39], v[16:19], a[16:23], v3
  v_add_f32 v62, v62, v63
  s_waitcnt lgkmcnt(4)
  v_smfmac_f32_16x16x64_bf16 v[64:67], v[24:27], v[84:91], v3
  v_cvt_pk_bf16_f32 v60, v60, v62
  v_smfmac_f32_16x16x64_bf16 v[36:39], v[20:23], a[24:31], v3
  ds_write_b32 v106, v60
  v_smfmac_f32_16x16x64_bf16 v[36:39], v[24:27], a[32:39], v3
  s_waitcnt lgkmcnt(2)
  v_smfmac_f32_16x16x64_bf16 v[64:67], v[28:31], v[92:99], v3
  v_smfmac_f32_16x16x64_bf16 v[36:39], v[28:31], a[40:47], v3
  v_smfmac_f32_16x16x64_bf16 v[36:39], v[32:35], a[48:55], v3
  s_waitcnt lgkmcnt(0)
  v_smfmac_f32_16x16x64_bf16 v[64:67], v[32:35], v[76:83], v3
  v_smfmac_f32_16x16x64_bf16 v[40:43], v[8:11], a[56:63], v3
  v_smfmac_f32_16x16x64_bf16 v[40:43], v[12:15], a[64:71], v3
  v_add_f32 v36, v36, v37
  v_smfmac_f32_16x16x64_bf16 v[40:43], v[16:19], a[72:79], v3
  v_add_f32 v38, v38, v39
  v_smfmac_f32_16x16x64_bf16 v[40:43], v[20:23], a[80:87], v3
  v_cvt_pk_bf16_f32 v36, v36, v38
  v_smfmac_f32_16x16x64_bf16 v[40:43], v[24:27], a[88:95], v3
  ds_write_b32 v100, v36
  v_smfmac_f32_16x16x64_bf16 v[40:43], v[28:31], a[96:103], v3
  v_add_f32 v64, v64, v65
  v_smfmac_f32_16x16x64_bf16 v[40:43], v[32:35], a[104:111], v3
  v_add_f32 v66, v66, v67
  v_smfmac_f32_16x16x64_bf16 v[44:47], v[8:11], a[112:119], v3
  v_cvt_pk_bf16_f32 v64, v64, v66
  v_smfmac_f32_16x16x64_bf16 v[44:47], v[12:15], a[120:127], v3
  ds_write_b32 v107, v64
  v_smfmac_f32_16x16x64_bf16 v[44:47], v[16:19], a[128:135], v3
  v_add_f32 v40, v40, v41
  v_smfmac_f32_16x16x64_bf16 v[44:47], v[20:23], a[136:143], v3
  v_add_f32 v42, v42, v43
  v_smfmac_f32_16x16x64_bf16 v[44:47], v[24:27], a[144:151], v3
  v_cvt_pk_bf16_f32 v40, v40, v42
  v_smfmac_f32_16x16x64_bf16 v[44:47], v[28:31], a[152:159], v3
  ds_write_b32 v101, v40
  v_smfmac_f32_16x16x64_bf16 v[44:47], v[32:35], a[160:167], v3
  v_smfmac_f32_16x16x64_bf16 v[48:51], v[8:11], a[168:175], v3
  v_smfmac_f32_16x16x64_bf16 v[48:51], v[12:15], a[176:183], v3
  v_smfmac_f32_16x16x64_bf16 v[48:51], v[16:19], a[184:191], v3
  v_add_f32 v44, v44, v45
  v_smfmac_f32_16x16x64_bf16 v[48:51], v[20:23], a[192:199], v3
  v_add_f32 v46, v46, v47
  v_smfmac_f32_16x16x64_bf16 v[48:51], v[24:27], a[200:207], v3
  v_cvt_pk_bf16_f32 v44, v44, v46
  v_smfmac_f32_16x16x64_bf16 v[48:51], v[28:31], a[208:215], v3
  ds_write_b32 v102, v44
  v_smfmac_f32_16x16x64_bf16 v[48:51], v[32:35], a[216:223], v3
  v_smfmac_f32_16x16x64_bf16 v[52:55], v[8:11], a[224:231], v3
  v_smfmac_f32_16x16x64_bf16 v[52:55], v[12:15], a[232:239], v3
  v_smfmac_f32_16x16x64_bf16 v[52:55], v[16:19], a[240:247], v3
  v_add_f32 v48, v48, v49
  v_smfmac_f32_16x16x64_bf16 v[52:55], v[20:23], a[248:255], v3
  v_add_f32 v50, v50, v51
  v_smfmac_f32_16x16x64_bf16 v[52:55], v[24:27], v[120:127], v3
  v_cvt_pk_bf16_f32 v48, v48, v50
  v_smfmac_f32_16x16x64_bf16 v[52:55], v[28:31], v[128:135], v3
  ds_write_b32 v103, v48
  v_smfmac_f32_16x16x64_bf16 v[52:55], v[32:35], v[136:143], v3
  v_smfmac_f32_16x16x64_bf16 v[56:59], v[8:11], v[144:151], v3
  v_smfmac_f32_16x16x64_bf16 v[56:59], v[12:15], v[152:159], v3
  v_smfmac_f32_16x16x64_bf16 v[56:59], v[16:19], v[160:167], v3
  v_add_f32 v52, v52, v53
  v_smfmac_f32_16x16x64_bf16 v[56:59], v[20:23], v[168:175], v3
  v_add_f32 v54, v54, v55
  v_smfmac_f32_16x16x64_bf16 v[56:59], v[24:27], v[176:183], v3
  v_cvt_pk_bf16_f32 v52, v52, v54
  v_smfmac_f32_16x16x64_bf16 v[56:59], v[28:31], v[184:191], v3
  ds_write_b32 v104, v52
  v_smfmac_f32_16x16x64_bf16 v[56:59], v[32:35], v[192:199], v3
  s_nop 7
  v_add_f32 v56, v56, v57
  v_add_f32 v58, v58, v59
  v_cvt_pk_bf16_f32 v56, v56, v58
  ds_write_b32 v105, v56
  s_waitcnt lgkmcnt(0)
  s_barrier
  s_cmp_eq_u32 s19, 62
  s_cbranch_scc1 cA_done
  s_waitcnt vmcnt(0) lgkmcnt(0)
  s_add_u32 s19, s19, 1
  s_mov_b32 s20, s21
  s_branch cA_va2_loop
cA_va2_retry:
  s_waitcnt lgkmcnt(0)
  buffer_load_dwordx4 v[8:11], v2, s[8:11], s20 offen offset:0 sc1
  buffer_load_dwordx4 v[12:15], v2, s[8:11], s20 offen offset:1024 sc1
  buffer_load_dwordx4 v[16:19], v2, s[8:11], s20 offen offset:2048 sc1
  buffer_load_dwordx4 v[20:23], v2, s[8:11], s20 offen offset:3072 sc1
  s_add_u32 s31, s31, 1
  s_add_u32 s30, s30, 1
  s_cmp_lt_u32 s30, 400000
  s_cbranch_scc1 cA_va2_ld
  s_branch cA_abort
cA_va2_last:
  s_waitcnt lgkmcnt(0)
  buffer_store_dwordx4 v[100:103], v2, s[8:11], s24 offen offset:0 sc1
  buffer_store_dwordx4 v[104:107], v2, s[8:11], s24 offen offset:1024 sc1
  buffer_store_dwordx4 v[108:111], v2, s[8:11], s24 offen offset:2048 sc1
  buffer_store_dwordx4 v[4:7], v2, s[8:11], s24 offen offset:3072 sc1
  s_add_u32 s24, s24, 8192
  s_waitcnt vmcnt(0)
  s_mov_b64 exec, 1
  buffer_store_dword v117, v2, s[8:11], s34 offen sc1
  s_mov_b64 exec, -1
  s_add_u32 s34, s34, 8
  s_mov_b64 exec, 1
  buffer_store_dword v117, v2, s[8:11], s34 offen sc1
  s_mov_b64 exec, -1
  s_add_u32 s34, s34, 8
  s_branch cA_done
.p2align 6

cA_va3_loop:
  s_add_u32 s23, s20, 4096
  s_add_u32 s21, s20, 20480
  v_mov_b32 v36, 0
  v_mov_b32 v37, 0
  v_mov_b32 v38, 0
  v_mov_b32 v39, 0
  v_mov_b32 v40, 0
  v_mov_b32 v41, 0
  v_mov_b32 v42, 0
  v_mov_b32 v43, 0
  v_mov_b32 v44, 0
  v_mov_b32 v45, 0
  v_mov_b32 v46, 0
  v_mov_b32 v47, 0
  v_mov_b32 v48, 0
  v_mov_b32 v49, 0
  v_mov_b32 v50, 0
  v_mov_b32 v51, 0
  v_mov_b32 v52, 0
  v_mov_b32 v53, 0
  v_mov_b32 v54, 0
  v_mov_b32 v55, 0
  v_mov_b32 v56, 0
  v_mov_b32 v57, 0
  v_mov_b32 v58, 0
  v_mov_b32 v59, 0
  v_mov_b32 v60, 0
  v_mov_b32 v61, 0
  v_mov_b32 v62, 0
  v_mov_b32 v63, 0
  v_mov_b32 v64, 0
  v_mov_b32 v65, 0
  v_mov_b32 v66, 0
  v_mov_b32 v67, 0
  s_mov_b32 s30, 0
  buffer_load_dword v76, v119, s[8:11], s20 offen sc1
  buffer_load_dword v77, v119, s[8:11], s20 offen sc1
  buffer_load_dword v78, v119, s[8:11], s20 offen sc1
cA_va3_fp_l:
  s_waitcnt vmcnt(2)
  v_cmp_eq_u32 vcc, -1, v76
  s_cbranch_vccz cA_va3_fp_d
  buffer_load_dword v76, v119, s[8:11], s20 offen sc1
  s_waitcnt vmcnt(2)
  v_cmp_eq_u32 vcc, -1, v77
  s_cbranch_vccz cA_va3_fp_d
  buffer_load_dword v77, v119, s[8:11], s20 offen sc1
  s_waitcnt vmcnt(2)
  v_cmp_eq_u32 vcc, -1, v78
  s_cbranch_vccz cA_va3_fp_d
  buffer_load_dword v78, v119, s[8:11], s20 offen sc1
  s_add_u32 s30, s30, 1
  s_cmp_lt_u32 s30, 400000
  s_cbranch_scc1 cA_va3_fp_l
  s_branch cA_abort
cA_va3_fp_d:
  buffer_load_dwordx4 v[24:27], v2, s[8:11], s23 offen offset:0 sc1
  buffer_load_dwordx4 v[28:31], v2, s[8:11], s23 offen offset:1024 sc1
  buffer_load_dwordx4 v[32:35], v2, s[8:11], s23 offen offset:2048 sc1
  s_barrier
cA_va3_ld:
  s_waitcnt vmcnt(0)
  v_max3_u32 v84, v24, v25, v26
  v_max3_u32 v84, v84, v27, v28
  v_max3_u32 v84, v84, v29, v30
  v_max3_u32 v84, v84, v31, v32
  v_max3_u32 v84, v84, v33, v34
  v_max_u32 v84, v84, v35
  v_cmp_eq_u32 vcc, -1, v84
  ds_write_b128 v2, v[24:27] offset:12288
  ds_write_b128 v2, v[28:31] offset:13312
  ds_write_b128 v2, v[32:35] offset:14336
  s_cbranch_vccnz cA_va3_retry
  s_waitcnt lgkmcnt(0)
  s_barrier
  ds_read_b128 v[8:11], v5 offset:8192
  ds_read_b128 v[12:15], v5 offset:9216
  ds_read_b128 v[16:19], v5 offset:10240
  ds_read_b128 v[20:23], v5 offset:11264
  ds_read_b128 v[24:27], v5 offset:12288
  ds_read_b128 v[28:31], v5 offset:13312
  ds_read_b128 v[32:35], v5 offset:14336
  s_waitcnt lgkmcnt(0)
  s_cmp_eq_u32 s19, 63
  s_cbranch_scc1 cA_done
  ds_read_b128 v[76:79], v1 offset:0
  ds_read_b128 v[80:83], v1 offset:1024
  ds_read_b128 v[84:87], v1 offset:2048
  ds_read_b128 v[88:91], v1 offset:3072
  ds_read_b128 v[92:95], v1 offset:4096
  ds_read_b128 v[96:99], v1 offset:5120
  v_smfmac_f32_16x16x64_bf16 v[60:63], v[8:11], v[200:207], v3
  v_smfmac_f32_16x16x64_bf16 v[60:63], v[12:15], v[208:215], v3
  s_waitcnt lgkmcnt(4)
  v_smfmac_f32_16x16x64_bf16 v[64:67], v[8:11], v[76:83], v3
  ds_read_b128 v[76:79], v1 offset:6144
  ds_read_b128 v[80:83], v1 offset:7168
  v_smfmac_f32_16x16x64_bf16 v[60:63], v[16:19], v[216:223], v3
  v_smfmac_f32_16x16x64_bf16 v[60:63], v[20:23], v[224:231], v3
  s_waitcnt lgkmcnt(4)
  v_smfmac_f32_16x16x64_bf16 v[64:67], v[12:15], v[84:91], v3
  ds_read_b128 v[84:87], v1 offset:8192
  ds_read_b128 v[88:91], v1 offset:9216
  v_smfmac_f32_16x16x64_bf16 v[60:63], v[24:27], v[232:239], v3
  v_smfmac_f32_16x16x64_bf16 v[60:63], v[28:31], v[240:247], v3
  s_waitcnt lgkmcnt(4)
  v_smfmac_f32_16x16x64_bf16 v[64:67], v[16:19], v[92:99], v3
  ds_read_b128 v[92:95], v1 offset:10240
  ds_read_b128 v[96:99], v1 offset:11264
  v_smfmac_f32_16x16x64_bf16 v[60:63], v[32:35], v[248:255], v3
  v_smfmac_f32_16x16x64_bf16 v[36:39], v[8:11], a[0:7], v3
  s_waitcnt lgkmcnt(4)
  v_smfmac_f32_16x16x64_bf16 v[64:67], v[20:23], v[76:83], v3
  ds_read_b128 v[76:79], v1 offset:12288
  ds_read_b128 v[80:83], v1 offset:13312
  v_smfmac_f32_16x16x64_bf16 v[36:39], v[12:15], a[8:15], v3
  v_add_f32 v60, v60, v61
  v_smfmac_f32_16x16x64_bf16 v[36:39], v[16:19], a[16:23], v3
  v_add_f32 v62, v62, v63
  s_waitcnt lgkmcnt(4)
  v_smfmac_f32_16x16x64_bf16 v[64:67], v[24:27], v[84:91], v3
  v_cvt_pk_bf16_f32 v60, v60, v62
  v_smfmac_f32_16x16x64_bf16 v[36:39], v[20:23], a[24:31], v3
  ds_write_b32 v106, v60
  v_smfmac_f32_16x16x64_bf16 v[36:39], v[24:27], a[32:39], v3
  s_waitcnt lgkmcnt(2)
  v_smfmac_f32_16x16x64_bf16 v[64:67], v[28:31], v[92:99], v3
  v_smfmac_f32_16x16x64_bf16 v[36:39], v[28:31], a[40:47], v3
  v_smfmac_f32_16x16x64_bf16 v[36:39], v[32:35], a[48:55], v3
  s_waitcnt lgkmcnt(0)
  v_smfmac_f32_16x16x64_bf16 v[64:67], v[32:35], v[76:83], v3
  v_smfmac_f32_16x16x64_bf16 v[40:43], v[8:11], a[56:63], v3
  v_smfmac_f32_16x16x64_bf16 v[40:43], v[12:15], a[64:71], v3
  v_add_f32 v36, v36, v37
  v_smfmac_f32_16x16x64_bf16 v[40:43], v[16:19], a[72:79], v3
  v_add_f32 v38, v38, v39
  v_smfmac_f32_16x16x64_bf16 v[40:43], v[20:23], a[80:87], v3
  v_cvt_pk_bf16_f32 v36, v36, v38
  v_smfmac_f32_16x16x64_bf16 v[40:43], v[24:27], a[88:95], v3
  ds_write_b32 v100, v36
  v_smfmac_f32_16x16x64_bf16 v[40:43], v[28:31], a[96:103], v3
  v_add_f32 v64, v64, v65
  v_smfmac_f32_16x16x64_bf16 v[40:43], v[32:35], a[104:111], v3
  v_add_f32 v66, v66, v67
  v_smfmac_f32_16x16x64_bf16 v[44:47], v[8:11], a[112:119], v3
  v_cvt_pk_bf16_f32 v64, v64, v66
  v_smfmac_f32_16x16x64_bf16 v[44:47], v[12:15], a[120:127], v3
  ds_write_b32 v107, v64
  v_smfmac_f32_16x16x64_bf16 v[44:47], v[16:19], a[128:135], v3
  v_add_f32 v40, v40, v41
  v_smfmac_f32_16x16x64_bf16 v[44:47], v[20:23], a[136:143], v3
  v_add_f32 v42, v42, v43
  v_smfmac_f32_16x16x64_bf16 v[44:47], v[24:27], a[144:151], v3
  v_cvt_pk_bf16_f32 v40, v40, v42
  v_smfmac_f32_16x16x64_bf16 v[44:47], v[28:31], a[152:159], v3
  ds_write_b32 v101, v40
  v_smfmac_f32_16x16x64_bf16 v[44:47], v[32:35], a[160:167], v3
  v_smfmac_f32_16x16x64_bf16 v[48:51], v[8:11], a[168:175], v3
  v_smfmac_f32_16x16x64_bf16 v[48:51], v[12:15], a[176:183], v3
  v_smfmac_f32_16x16x64_bf16 v[48:51], v[16:19], a[184:191], v3
  v_add_f32 v44, v44, v45
  v_smfmac_f32_16x16x64_bf16 v[48:51], v[20:23], a[192:199], v3
  v_add_f32 v46, v46, v47
  v_smfmac_f32_16x16x64_bf16 v[48:51], v[24:27], a[200:207], v3
  v_cvt_pk_bf16_f32 v44, v44, v46
  v_smfmac_f32_16x16x64_bf16 v[48:51], v[28:31], a[208:215], v3
  ds_write_b32 v102, v44
  v_smfmac_f32_16x16x64_bf16 v[48:51], v[32:35], a[216:223], v3
  v_smfmac_f32_16x16x64_bf16 v[52:55], v[8:11], a[224:231], v3
  v_smfmac_f32_16x16x64_bf16 v[52:55], v[12:15], a[232:239], v3
  v_smfmac_f32_16x16x64_bf16 v[52:55], v[16:19], a[240:247], v3
  v_add_f32 v48, v48, v49
  v_smfmac_f32_16x16x64_bf16 v[52:55], v[20:23], a[248:255], v3
  v_add_f32 v50, v50, v51
  v_smfmac_f32_16x16x64_bf16 v[52:55], v[24:27], v[120:127], v3
  v_cvt_pk_bf16_f32 v48, v48, v50
  v_smfmac_f32_16x16x64_bf16 v[52:55], v[28:31], v[128:135], v3
  ds_write_b32 v103, v48
  v_smfmac_f32_16x16x64_bf16 v[52:55], v[32:35], v[136:143], v3
  v_smfmac_f32_16x16x64_bf16 v[56:59], v[8:11], v[144:151], v3
  v_smfmac_f32_16x16x64_bf16 v[56:59], v[12:15], v[152:159], v3
  v_smfmac_f32_16x16x64_bf16 v[56:59], v[16:19], v[160:167], v3
  v_add_f32 v52, v52, v53
  v_smfmac_f32_16x16x64_bf16 v[56:59], v[20:23], v[168:175], v3
  v_add_f32 v54, v54, v55
  v_smfmac_f32_16x16x64_bf16 v[56:59], v[24:27], v[176:183], v3
  v_cvt_pk_bf16_f32 v52, v52, v54
  v_smfmac_f32_16x16x64_bf16 v[56:59], v[28:31], v[184:191], v3
  ds_write_b32 v104, v52
  v_smfmac_f32_16x16x64_bf16 v[56:59], v[32:35], v[192:199], v3
  s_nop 7
  v_add_f32 v56, v56, v57
  v_add_f32 v58, v58, v59
  v_cvt_pk_bf16_f32 v56, v56, v58
  ds_write_b32 v105, v56
  s_waitcnt lgkmcnt(0)
  s_barrier
  s_cmp_eq_u32 s19, 62
  s_cbranch_scc1 cA_done
  s_waitcnt vmcnt(0) lgkmcnt(0)
  s_add_u32 s19, s19, 1
  s_mov_b32 s20, s21
  s_branch cA_va3_loop
cA_va3_retry:
  s_waitcnt lgkmcnt(0)
  buffer_load_dwordx4 v[24:27], v2, s[8:11], s23 offen offset:0 sc1
  buffer_load_dwordx4 v[28:31], v2, s[8:11], s23 offen offset:1024 sc1
  buffer_load_dwordx4 v[32:35], v2, s[8:11], s23 offen offset:2048 sc1
  s_add_u32 s31, s31, 1
  s_add_u32 s30, s30, 1
  s_cmp_lt_u32 s30, 400000
  s_cbranch_scc1 cA_va3_ld
  s_branch cA_abort
cA_va3_last:
  s_waitcnt lgkmcnt(0)
  buffer_store_dwordx4 v[100:103], v2, s[8:11], s24 offen offset:0 sc1
  buffer_store_dwordx4 v[104:107], v2, s[8:11], s24 offen offset:1024 sc1
  buffer_store_dwordx4 v[108:111], v2, s[8:11], s24 offen offset:2048 sc1
  buffer_store_dwordx4 v[4:7], v2, s[8:11], s24 offen offset:3072 sc1
  s_add_u32 s24, s24, 8192
  s_waitcnt vmcnt(0)
  s_mov_b64 exec, 1
  buffer_store_dword v117, v2, s[8:11], s34 offen sc1
  s_mov_b64 exec, -1
  s_add_u32 s34, s34, 8
  s_mov_b64 exec, 1
  buffer_store_dword v117, v2, s[8:11], s34 offen sc1
  s_mov_b64 exec, -1
  s_add_u32 s34, s34, 8
  s_branch cA_done
cA_abort:
  v_mov_b32 v4, 0xdead
  v_mov_b32 v5, 16
  buffer_store_dword v4, v5, s[12:15], 0 offen
  s_branch ch_end
cA_done:
  s_branch ch_end
.p2align 6

cB_sc0_loop:
  s_add_u32 s23, s20, 4096
  s_add_u32 s21, s20, 20480
  v_mov_b32 v48, 0
  v_mov_b32 v49, 0
  v_mov_b32 v50, 0
  v_mov_b32 v51, 0
  v_mov_b32 v52, 0
  v_mov_b32 v53, 0
  v_mov_b32 v54, 0
  v_mov_b32 v55, 0
  v_mov_b32 v56, 0
  v_mov_b32 v57, 0
  v_mov_b32 v58, 0
  v_mov_b32 v59, 0
  v_mov_b32 v60, 0
  v_mov_b32 v61, 0
  v_mov_b32 v62, 0
  v_mov_b32 v63, 0
  v_mov_b32 v88, 0
  v_mov_b32 v89, 0
  v_mov_b32 v90, 0
  v_mov_b32 v91, 0
  v_mov_b32 v92, 0
  v_mov_b32 v93, 0
  v_mov_b32 v94, 0
  v_mov_b32 v95, 0
  v_mov_b32 v66, 0
  v_mov_b32 v67, 0
  s_mov_b32 s30, 0
  s_mov_b32 s62, 0
  buffer_load_dword v68, v0, s[8:11], s20 offen sc1
  s_nop 7
  buffer_load_dword v69, v0, s[8:11], s20 offen sc1
  s_nop 7
  buffer_load_dword v70, v0, s[8:11], s20 offen sc1
  s_nop 7
  buffer_load_dword v71, v0, s[8:11], s20 offen sc1
  s_nop 7
  buffer_load_dword v72, v0, s[8:11], s20 offen sc1
cB_sc0_fp_l:
  s_waitcnt vmcnt(4)
  v_cmp_eq_u32 vcc, -1, v68
  s_cbranch_vccz cB_sc0_fp_d
  buffer_load_dword v68, v0, s[8:11], s20 offen sc1
  s_waitcnt vmcnt(4)
  v_cmp_eq_u32 vcc, -1, v69
  s_cbranch_vccz cB_sc0_fp_d
  buffer_load_dword v69, v0, s[8:11], s20 offen sc1
  s_waitcnt vmcnt(4)
  v_cmp_eq_u32 vcc, -1, v70
  s_cbranch_vccz cB_sc0_fp_d
  buffer_load_dword v70, v0, s[8:11], s20 offen sc1
  s_waitcnt vmcnt(4)
  v_cmp_eq_u32 vcc, -1, v71
  s_cbranch_vccz cB_sc0_fp_d
  buffer_load_dword v71, v0, s[8:11], s20 offen sc1
  s_waitcnt vmcnt(4)
  v_cmp_eq_u32 vcc, -1, v72
  s_cbranch_vccz cB_sc0_fp_d
  buffer_load_dword v72, v0, s[8:11], s20 offen sc1
  s_add_u32 s30, s30, 1
  s_cmp_lt_u32 s30, 400000
  s_cbranch_scc1 cB_sc0_fp_l
  s_branch cB_abort
cB_sc0_fp_d:
  buffer_load_dwordx4 v[8:11], v2, s[8:11], s20 offen offset:0 sc1
  s_barrier
  s_branch cB_sc0_ld1
cB_sc0_ld:
  buffer_load_dwordx4 v[8:11], v2, s[8:11], s20 offen offset:0 sc1
cB_sc0_ld1:
  v_mov_b32 v36, 0
  v_mov_b32 v37, 0
  v_mov_b32 v38, 0
  v_mov_b32 v39, 0
  buffer_load_dwordx4 v[12:15], v2, s[8:11], s20 offen offset:1024 sc1
  v_mov_b32 v40, 0
  v_mov_b32 v41, 0
  v_mov_b32 v42, 0
  v_mov_b32 v43, 0
  buffer_load_dwordx4 v[16:19], v2, s[8:11], s20 offen offset:2048 sc1
  v_mov_b32 v44, 0
  v_mov_b32 v45, 0
  v_mov_b32 v46, 0
  v_mov_b32 v47, 0
  ds_read_b128 v[96:99], v117 offset:0
  ds_read_b128 v[100:103], v117 offset:1024
  ds_read_b128 v[104:107], v117 offset:14336
  ds_read_b128 v[108:111], v117 offset:15360
  s_waitcnt vmcnt(2)
  v_smfmac_f32_16x16x64_bf16 v[36:39], v[8:11], a[0:7], v3
  v_smfmac_f32_16x16x64_bf16 v[40:43], v[8:11], a[56:63], v3
  buffer_load_dwordx4 v[20:23], v2, s[8:11], s20 offen offset:3072 sc1
  v_smfmac_f32_16x16x64_bf16 v[44:47], v[8:11], a[112:119], v3
  v_smfmac_f32_16x16x64_bf16 v[48:51], v[8:11], a[168:175], v3
  v_smfmac_f32_16x16x64_bf16 v[52:55], v[8:11], a[224:231], v3
  buffer_load_dwordx4 v[24:27], v2, s[8:11], s23 offen offset:0 sc1
  v_smfmac_f32_16x16x64_bf16 v[56:59], v[8:11], v[144:151], v3
  v_smfmac_f32_16x16x64_bf16 v[60:63], v[8:11], v[200:207], v3
  s_waitcnt vmcnt(3)
  v_smfmac_f32_16x16x64_bf16 v[36:39], v[12:15], a[8:15], v3
  v_smfmac_f32_16x16x64_bf16 v[40:43], v[12:15], a[64:71], v3
  buffer_load_dwordx4 v[28:31], v2, s[8:11], s23 offen offset:1024 sc1
  v_smfmac_f32_16x16x64_bf16 v[44:47], v[12:15], a[120:127], v3
  v_smfmac_f32_16x16x64_bf16 v[48:51], v[12:15], a[176:183], v3
  v_smfmac_f32_16x16x64_bf16 v[52:55], v[12:15], a[232:239], v3
  buffer_load_dwordx4 v[32:35], v2, s[8:11], s23 offen offset:2048 sc1
  v_smfmac_f32_16x16x64_bf16 v[56:59], v[12:15], v[152:159], v3
  v_smfmac_f32_16x16x64_bf16 v[60:63], v[12:15], v[208:215], v3
  s_xor_b32 s58, s25, 28672
  s_add_u32 s59, s24, 28672
  s_add_u32 m0, s58, 0
  s_waitcnt vmcnt(4)
  v_smfmac_f32_16x16x64_bf16 v[36:39], v[16:19], a[16:23], v3
  buffer_load_dwordx4 v2, s[8:11], s59 offen offset:0 sc1 lds
  v_smfmac_f32_16x16x64_bf16 v[40:43], v[16:19], a[72:79], v3
  v_smfmac_f32_16x16x64_bf16 v[44:47], v[16:19], a[128:135], v3
  v_smfmac_f32_16x16x64_bf16 v[48:51], v[16:19], a[184:191], v3
  v_smfmac_f32_16x16x64_bf16 v[52:55], v[16:19], a[240:247], v3
  buffer_load_dwordx4 v2, s[8:11], s59 offen offset:1024 sc1 lds
  v_smfmac_f32_16x16x64_bf16 v[56:59], v[16:19], v[160:167], v3
  v_smfmac_f32_16x16x64_bf16 v[60:63], v[16:19], v[216:223], v3
  s_waitcnt vmcnt(5)
  v_smfmac_f32_16x16x64_bf16 v[36:39], v[20:23], a[24:31], v3
  v_smfmac_f32_16x16x64_bf16 v[40:43], v[20:23], a[80:87], v3
  buffer_load_dwordx4 v2, s[8:11], s59 offen offset:2048 sc1 lds
  v_smfmac_f32_16x16x64_bf16 v[44:47], v[20:23], a[136:143], v3
  v_smfmac_f32_16x16x64_bf16 v[48:51], v[20:23], a[192:199], v3
  v_smfmac_f32_16x16x64_bf16 v[52:55], v[20:23], a[248:255], v3
  v_smfmac_f32_16x16x64_bf16 v[56:59], v[20:23], v[168:175], v3
  buffer_load_dwordx4 v2, s[8:11], s59 offen offset:3072 sc1 lds
  v_smfmac_f32_16x16x64_bf16 v[60:63], v[20:23], v[224:231], v3
  s_waitcnt vmcnt(4)
cB_sc0_ph2:
  v_smfmac_f32_16x16x64_bf16 v[60:63], v[24:27], v[232:239], v3
  ds_read_b128 v[12:15], v116 offset:0
  ds_read_b128 v[16:19], v116 offset:1024
  v_smfmac_f32_16x16x64_bf16 v[60:63], v[28:31], v[240:247], v3
  v_smfmac_f32_16x16x64_bf16 v[60:63], v[32:35], v[248:255], v3
  v_mov_b32 v80, v24
  v_smfmac_f32_16x16x64_bf16 v[52:55], v[24:27], v[120:127], v3
  v_mov_b32 v81, v25
  v_smfmac_f32_16x16x64_bf16 v[52:55], v[28:31], v[128:135], v3
  v_mov_b32 v82, v32
  v_smfmac_f32_16x16x64_bf16 v[52:55], v[32:35], v[136:143], v3
  v_cvt_pk_bf16_f32 v64, v60, v61
  v_smfmac_f32_16x16x64_bf16 v[56:59], v[24:27], v[176:183], v3
  v_cvt_pk_bf16_f32 v65, v62, v63
  v_smfmac_f32_16x16x64_bf16 v[56:59], v[28:31], v[184:191], v3
  v_mov_b32 v83, v33
  v_mfma_f32_16x16x32_bf16 v[68:71], v[64:67], v[4:7], 0
  v_smfmac_f32_16x16x64_bf16 v[56:59], v[32:35], v[192:199], v3
  v_cvt_pk_bf16_f32 v64, v52, v53
  v_smfmac_f32_16x16x64_bf16 v[36:39], v[24:27], a[32:39], v3
  v_cvt_pk_bf16_f32 v65, v54, v55
  v_smfmac_f32_16x16x64_bf16 v[36:39], v[28:31], a[40:47], v3
  v_cvt_pk_bf16_f32 v78, v68, v69
  v_smfmac_f32_16x16x64_bf16 v[36:39], v[32:35], a[48:55], v3
  v_cvt_pk_bf16_f32 v79, v70, v71
  v_cvt_pk_bf16_f32 v66, v56, v57
  v_smfmac_f32_16x16x64_bf16 v[40:43], v[24:27], a[88:95], v3
  v_cvt_pk_bf16_f32 v67, v58, v59
  v_smfmac_f32_16x16x64_bf16 v[40:43], v[28:31], a[96:103], v3
  v_mfma_f32_16x16x32_bf16 v[72:75], v[64:67], v[4:7], 0
  ds_read_b128 v[52:55], v116 offset:14336
  ds_read_b128 v[56:59], v116 offset:15360
  v_smfmac_f32_16x16x64_bf16 v[40:43], v[32:35], a[104:111], v3
  v_cvt_pk_bf16_f32 v64, v36, v37
  v_smfmac_f32_16x16x64_bf16 v[44:47], v[24:27], a[144:151], v3
  v_cvt_pk_bf16_f32 v65, v38, v39
  v_smfmac_f32_16x16x64_bf16 v[44:47], v[28:31], a[152:159], v3
  v_cvt_pk_bf16_f32 v76, v72, v73
  v_smfmac_f32_16x16x64_bf16 v[44:47], v[32:35], a[160:167], v3
  v_cvt_pk_bf16_f32 v77, v74, v75
  v_cvt_pk_bf16_f32 v66, v40, v41
  v_smfmac_f32_16x16x64_bf16 v[48:51], v[24:27], a[200:207], v3
  v_cvt_pk_bf16_f32 v67, v42, v43
  v_smfmac_f32_16x16x64_bf16 v[48:51], v[28:31], a[208:215], v3
  v_mfma_f32_16x16x32_bf16 v[68:71], v[64:67], v[4:7], 0
  v_smfmac_f32_16x16x64_bf16 v[48:51], v[32:35], a[216:223], v3
  v_cvt_pk_bf16_f32 v64, v44, v45
  v_mfma_f32_16x16x32_bf16 v[84:87], v[80:83], v[76:79], 0
  v_cvt_pk_bf16_f32 v65, v46, v47
  s_waitcnt lgkmcnt(0)
  v_smfmac_f32_16x16x64_bf16 v[88:91], v[76:79], v[96:103], v118
  v_cvt_pk_bf16_f32 v60, v68, v69
  v_cvt_pk_bf16_f32 v61, v70, v71
  v_cvt_pk_bf16_f32 v66, v48, v49
  v_cvt_pk_bf16_f32 v67, v50, v51
  s_nop 1
  v_mfma_f32_16x16x32_bf16 v[72:75], v[64:67], v[4:7], 0
  v_smfmac_f32_16x16x64_bf16 v[92:95], v[76:79], v[104:111], v118
  s_nop 4
  v_cvt_pk_bf16_f32 v62, v72, v73
  v_cvt_pk_bf16_f32 v63, v74, v75
  s_nop 1
  v_mfma_f32_16x16x32_bf16 v[84:87], v[8:11], v[60:63], v[84:87]
  v_smfmac_f32_16x16x64_bf16 v[88:91], v[60:63], v[12:19], v118
  v_smfmac_f32_16x16x64_bf16 v[92:95], v[60:63], v[52:59], v118
  s_nop 1
  v_permlane32_swap_b32 v84, v86
  v_permlane32_swap_b32 v85, v87
  s_nop 0
  v_add_f32 v88, v88, v89
  v_add_f32_dpp v84, v86, v84 quad_perm:[1,0,3,2] row_mask:0xf bank_mask:0xf
  v_add_f32_dpp v85, v87, v85 quad_perm:[1,0,3,2] row_mask:0xf bank_mask:0xf
  v_add_f32 v89, v90, v91
  ds_write2_b32 v113, v84, v85 offset0:0 offset1:4
  ds_write2_b32 v112, v88, v89 offset0:0 offset1:128
  v_add_f32 v90, v92, v93
  v_add_f32 v91, v94, v95
  ds_write2_b32 v112, v90, v91 offset0:64 offset1:192
  v_cmp_u_f32 vcc, v88, v89
  s_cbranch_vccnz cB_sc0_retry
cB_sc0_cont:
  s_waitcnt lgkmcnt(0)
  s_barrier
  ds_read_b128 v[36:39], v114
  ds_read_b128 v[44:47], v115
  s_waitcnt lgkmcnt(0)
  v_add_f32 v36, v36, v38
  v_add_f32 v37, v37, v39
  v_add_f32 v44, v44, v45
  buffer_store_dword v2, v119, s[8:11], s20 offen sc1
  v_add_f32 v46, v46, v47
  v_add_f32 v44, v44, v46
  v_add_f32 v36, v36, v37
  v_exp_f32 v49, v44
  v_exp_f32 v48, v36
  v_add_f32 v50, abs(v36), abs(v44)
  v_fma_f32 v39, v49, s37, v48
  v_cmp_ngt_f32 vcc, s56, v50
  v_cndmask_b32 v41, v48, v49, s[38:39]
  v_add_f32_dpp v39, v39, v39 quad_perm:[1,0,3,2] row_mask:0xf bank_mask:0xf
  v_cndmask_b32 v40, v49, v48, s[38:39]
  v_mov_b32_dpp v46, v41 quad_perm:[1,0,3,2] row_mask:0xf bank_mask:0xf
  v_add_f32_dpp v39, v39, v39 quad_perm:[2,3,0,1] row_mask:0xf bank_mask:0xf
  v_cndmask_b32 v42, v46, v40, s[38:39]
  v_cndmask_b32 v43, v40, v46, s[38:39]
  v_add_f32_dpp v39, v39, v39 row_half_mirror row_mask:0xf bank_mask:0xf
  s_cbranch_vccnz cB_sc0_slow
  s_nop 0
  v_add_f32_dpp v47, v39, v39 row_mirror row_mask:0xf bank_mask:0xf
  v_add_f32_dpp v39, v39, v39 row_mirror row_mask:0xf bank_mask:0xf
  s_nop 1
  v_permlane16_swap_b32 v39, v47
  v_add_f32 v39, v39, v47
  v_rcp_f32 v39, v39
  s_mov_b64 exec, s[28:29]
  v_mul_f32 v42, v42, v39
  v_mul_f32 v43, v43, v39
  v_cvt_pk_bf16_f32 v42, v42, v43
cB_sc0_pst:
  buffer_store_dword v42, v1, s[8:11], s20 offen sc1
  s_mov_b64 exec, -1
  s_barrier
  s_cmp_lg_u32 s19, 0
  s_cbranch_scc1 cB_sc0_s0
  s_sub_u32 s36, s36, 64
  v_subrev_u32 v119, 64, v119
  v_lshl_add_u32 v56, v2, 3, s36
  s_mov_b64 exec, 15
  buffer_store_dword v2, v56, s[8:11], s20 offen sc1
  s_mov_b64 exec, -1
cB_sc0_s0:
  s_add_u32 s24, s24, 28672
  s_add_u32 s35, s35, 28672
  s_xor_b32 s25, s25, 28672
  s_add_u32 m0, s25, 0
  s_add_u32 m0, s25, 4096
  s_add_u32 s22, s24, 4096
  buffer_load_dwordx4 v2, s[8:11], s22 offen offset:0 sc1 lds
  s_nop 5
  buffer_load_dwordx4 v2, s[8:11], s22 offen offset:1024 sc1 lds
  s_nop 5
  buffer_load_dwordx4 v2, s[8:11], s22 offen offset:2048 sc1 lds
  s_nop 5
  v_xor_b32 v116, 28672, v116
  v_add_u32 v117, s57, v117
  s_sub_u32 s57, 0, s57
  s_add_u32 s19, s19, 1
  s_mov_b32 s20, s21
  s_cmp_lt_u32 s19, 63
  s_cbranch_scc1 cB_sc0_loop
  s_branch cB_done
cB_sc0_slow:
  v_max_f32 v50, v36, v44
  s_nop 1
  v_max_f32_dpp v50, v50, v50 quad_perm:[1,0,3,2] row_mask:0xf bank_mask:0xf
  s_nop 1
  v_max_f32_dpp v50, v50, v50 quad_perm:[2,3,0,1] row_mask:0xf bank_mask:0xf
  s_nop 1
  v_max_f32_dpp v50, v50, v50 row_half_mirror row_mask:0xf bank_mask:0xf
  s_nop 1
  v_max_f32_dpp v50, v50, v50 row_mirror row_mask:0xf bank_mask:0xf
  v_mov_b32 v47, v50
  s_nop 1
  v_permlane16_swap_b32 v50, v47
  v_max_f32 v50, v50, v47
  v_sub_f32 v48, v36, v50
  v_sub_f32 v49, v44, v50
  v_exp_f32 v48, v48
  v_exp_f32 v49, v49
  s_add_u32 s31, s31, 0x100
  v_fma_f32 v39, v49, s37, v48
  v_cndmask_b32 v41, v48, v49, s[38:39]
  s_nop 0
  v_add_f32_dpp v39, v39, v39 quad_perm:[1,0,3,2] row_mask:0xf bank_mask:0xf
  v_cndmask_b32 v40, v49, v48, s[38:39]
  v_mov_b32_dpp v46, v41 quad_perm:[1,0,3,2] row_mask:0xf bank_mask:0xf
  v_add_f32_dpp v39, v39, v39 quad_perm:[2,3,0,1] row_mask:0xf bank_mask:0xf
  v_cndmask_b32 v42, v46, v40, s[38:39]
  v_cndmask_b32 v43, v40, v46, s[38:39]
  v_add_f32_dpp v39, v39, v39 row_half_mirror row_mask:0xf bank_mask:0xf
  s_nop 1
  v_add_f32_dpp v47, v39, v39 row_mirror row_mask:0xf bank_mask:0xf
  v_add_f32_dpp v39, v39, v39 row_mirror row_mask:0xf bank_mask:0xf
  s_nop 1
  v_permlane16_swap_b32 v39, v47
  v_add_f32 v39, v39, v47
  v_rcp_f32 v39, v39
  s_mov_b64 exec, s[28:29]
  v_mul_f32 v42, v42, v39
  v_mul_f32 v43, v43, v39
  v_cvt_pk_bf16_f32 v42, v42, v43
  v_min_u32 v42, -2, v42
  s_branch cB_sc0_pst
cB_sc0_retry:
  s_cmp_lg_u32 s62, 0
  s_cbranch_scc1 cB_sc0_cont
  s_waitcnt vmcnt(0) lgkmcnt(0)
cB_sc0_rv:
  buffer_load_dwordx4 v[8:11], v2, s[8:11], s20 offen offset:0 sc1
  buffer_load_dwordx4 v[12:15], v2, s[8:11], s20 offen offset:1024 sc1
  buffer_load_dwordx4 v[16:19], v2, s[8:11], s20 offen offset:2048 sc1
  buffer_load_dwordx4 v[20:23], v2, s[8:11], s20 offen offset:3072 sc1
  buffer_load_dwordx4 v[24:27], v2, s[8:11], s23 offen offset:0 sc1
  buffer_load_dwordx4 v[28:31], v2, s[8:11], s23 offen offset:1024 sc1
  buffer_load_dwordx4 v[32:35], v2, s[8:11], s23 offen offset:2048 sc1
  s_waitcnt vmcnt(0)
  v_max3_u32 v68, v8, v9, v10
  v_max3_u32 v68, v68, v11, v12
  v_max3_u32 v68, v68, v13, v14
  v_max3_u32 v68, v68, v15, v16
  v_max3_u32 v68, v68, v17, v18
  v_max3_u32 v68, v68, v19, v20
  v_max3_u32 v68, v68, v21, v22
  v_max3_u32 v68, v68, v23, v24
  v_max3_u32 v68, v68, v25, v26
  v_max3_u32 v68, v68, v27, v28
  v_max3_u32 v68, v68, v29, v30
  v_max3_u32 v68, v68, v31, v32
  v_max3_u32 v68, v68, v33, v34
  v_max_u32 v68, v68, v35
  v_cmp_eq_u32 vcc, -1, v68
  s_cbranch_vccz cB_sc0_rk
  s_add_u32 s30, s30, 1
  s_cmp_lt_u32 s30, 400000
  s_cbranch_scc1 cB_sc0_rv
  s_branch cB_abort
cB_sc0_rk:
  s_mov_b32 s62, 1
  v_mov_b32 v36, 0
  v_mov_b32 v37, 0
  v_mov_b32 v38, 0
  v_mov_b32 v39, 0
  v_mov_b32 v40, 0
  v_mov_b32 v41, 0
  v_mov_b32 v42, 0
  v_mov_b32 v43, 0
  v_mov_b32 v44, 0
  v_mov_b32 v45, 0
  v_mov_b32 v46, 0
  v_mov_b32 v47, 0
  v_mov_b32 v48, 0
  v_mov_b32 v49, 0
  v_mov_b32 v50, 0
  v_mov_b32 v51, 0
  v_mov_b32 v52, 0
  v_mov_b32 v53, 0
  v_mov_b32 v54, 0
  v_mov_b32 v55, 0
  v_mov_b32 v56, 0
  v_mov_b32 v57, 0
  v_mov_b32 v58, 0
  v_mov_b32 v59, 0
  v_mov_b32 v60, 0
  v_mov_b32 v61, 0
  v_mov_b32 v62, 0
  v_mov_b32 v63, 0
  v_mov_b32 v88, 0
  v_mov_b32 v89, 0
  v_mov_b32 v90, 0
  v_mov_b32 v91, 0
  v_mov_b32 v92, 0
  v_mov_b32 v93, 0
  v_mov_b32 v94, 0
  v_mov_b32 v95, 0
  v_mov_b32 v66, 0
  v_mov_b32 v67, 0
  s_add_u32 s31, s31, 1
  ds_read_b128 v[96:99], v117 offset:0
  ds_read_b128 v[100:103], v117 offset:1024
  ds_read_b128 v[104:107], v117 offset:14336
  ds_read_b128 v[108:111], v117 offset:15360
  v_smfmac_f32_16x16x64_bf16 v[36:39], v[8:11], a[0:7], v3
  v_smfmac_f32_16x16x64_bf16 v[40:43], v[8:11], a[56:63], v3
  v_smfmac_f32_16x16x64_bf16 v[44:47], v[8:11], a[112:119], v3
  v_smfmac_f32_16x16x64_bf16 v[48:51], v[8:11], a[168:175], v3
  v_smfmac_f32_16x16x64_bf16 v[52:55], v[8:11], a[224:231], v3
  v_smfmac_f32_16x16x64_bf16 v[56:59], v[8:11], v[144:151], v3
  v_smfmac_f32_16x16x64_bf16 v[60:63], v[8:11], v[200:207], v3
  v_smfmac_f32_16x16x64_bf16 v[36:39], v[12:15], a[8:15], v3
  v_smfmac_f32_16x16x64_bf16 v[40:43], v[12:15], a[64:71], v3
  v_smfmac_f32_16x16x64_bf16 v[44:47], v[12:15], a[120:127], v3
  v_smfmac_f32_16x16x64_bf16 v[48:51], v[12:15], a[176:183], v3
  v_smfmac_f32_16x16x64_bf16 v[52:55], v[12:15], a[232:239], v3
  v_smfmac_f32_16x16x64_bf16 v[56:59], v[12:15], v[152:159], v3
  v_smfmac_f32_16x16x64_bf16 v[60:63], v[12:15], v[208:215], v3
  v_smfmac_f32_16x16x64_bf16 v[36:39], v[16:19], a[16:23], v3
  v_smfmac_f32_16x16x64_bf16 v[40:43], v[16:19], a[72:79], v3
  v_smfmac_f32_16x16x64_bf16 v[44:47], v[16:19], a[128:135], v3
  v_smfmac_f32_16x16x64_bf16 v[48:51], v[16:19], a[184:191], v3
  v_smfmac_f32_16x16x64_bf16 v[52:55], v[16:19], a[240:247], v3
  v_smfmac_f32_16x16x64_bf16 v[56:59], v[16:19], v[160:167], v3
  v_smfmac_f32_16x16x64_bf16 v[60:63], v[16:19], v[216:223], v3
  v_smfmac_f32_16x16x64_bf16 v[36:39], v[20:23], a[24:31], v3
  v_smfmac_f32_16x16x64_bf16 v[40:43], v[20:23], a[80:87], v3
  v_smfmac_f32_16x16x64_bf16 v[44:47], v[20:23], a[136:143], v3
  v_smfmac_f32_16x16x64_bf16 v[48:51], v[20:23], a[192:199], v3
  v_smfmac_f32_16x16x64_bf16 v[52:55], v[20:23], a[248:255], v3
  v_smfmac_f32_16x16x64_bf16 v[56:59], v[20:23], v[168:175], v3
  v_smfmac_f32_16x16x64_bf16 v[60:63], v[20:23], v[224:231], v3
  s_xor_b32 s58, s25, 28672
  s_add_u32 s59, s24, 28672
  s_add_u32 m0, s58, 0
  s_branch cB_sc0_ph2
.p2align 6

cB_sc1_loop:
  s_add_u32 s23, s20, 4096
  s_add_u32 s21, s20, 20480
  v_mov_b32 v48, 0
  v_mov_b32 v49, 0
  v_mov_b32 v50, 0
  v_mov_b32 v51, 0
  v_mov_b32 v52, 0
  v_mov_b32 v53, 0
  v_mov_b32 v54, 0
  v_mov_b32 v55, 0
  v_mov_b32 v56, 0
  v_mov_b32 v57, 0
  v_mov_b32 v58, 0
  v_mov_b32 v59, 0
  v_mov_b32 v60, 0
  v_mov_b32 v61, 0
  v_mov_b32 v62, 0
  v_mov_b32 v63, 0
  v_mov_b32 v88, 0
  v_mov_b32 v89, 0
  v_mov_b32 v90, 0
  v_mov_b32 v91, 0
  v_mov_b32 v92, 0
  v_mov_b32 v93, 0
  v_mov_b32 v94, 0
  v_mov_b32 v95, 0
  v_mov_b32 v64, 0
  v_mov_b32 v65, 0
  s_mov_b32 s30, 0
  s_mov_b32 s62, 0
  s_waitcnt vmcnt(0)
  s_barrier
cB_sc1_ld:
  buffer_load_dwordx4 v[8:11], v2, s[8:11], s20 offen offset:0 sc1
  v_mov_b32 v36, 0
  v_mov_b32 v37, 0
  v_mov_b32 v38, 0
  v_mov_b32 v39, 0
  buffer_load_dwordx4 v[12:15], v2, s[8:11], s20 offen offset:1024 sc1
  v_mov_b32 v40, 0
  v_mov_b32 v41, 0
  v_mov_b32 v42, 0
  v_mov_b32 v43, 0
  buffer_load_dwordx4 v[16:19], v2, s[8:11], s20 offen offset:2048 sc1
  v_mov_b32 v44, 0
  v_mov_b32 v45, 0
  v_mov_b32 v46, 0
  v_mov_b32 v47, 0
  ds_read_b128 v[96:99], v117 offset:0
  ds_read_b128 v[100:103], v117 offset:1024
  ds_read_b128 v[104:107], v117 offset:14336
  ds_read_b128 v[108:111], v117 offset:15360
  s_waitcnt vmcnt(2)
  v_smfmac_f32_16x16x64_bf16 v[36:39], v[8:11], a[0:7], v3
  v_smfmac_f32_16x16x64_bf16 v[40:43], v[8:11], a[56:63], v3
  buffer_load_dwordx4 v[20:23], v2, s[8:11], s20 offen offset:3072 sc1
  v_smfmac_f32_16x16x64_bf16 v[44:47], v[8:11], a[112:119], v3
  v_smfmac_f32_16x16x64_bf16 v[48:51], v[8:11], a[168:175], v3
  v_smfmac_f32_16x16x64_bf16 v[52:55], v[8:11], a[224:231], v3
  buffer_load_dwordx4 v[24:27], v2, s[8:11], s23 offen offset:0 sc1
  v_smfmac_f32_16x16x64_bf16 v[56:59], v[8:11], v[144:151], v3
  v_smfmac_f32_16x16x64_bf16 v[60:63], v[8:11], v[200:207], v3
  s_waitcnt vmcnt(3)
  v_smfmac_f32_16x16x64_bf16 v[36:39], v[12:15], a[8:15], v3
  v_smfmac_f32_16x16x64_bf16 v[40:43], v[12:15], a[64:71], v3
  buffer_load_dwordx4 v[28:31], v2, s[8:11], s23 offen offset:1024 sc1
  v_smfmac_f32_16x16x64_bf16 v[44:47], v[12:15], a[120:127], v3
  v_smfmac_f32_16x16x64_bf16 v[48:51], v[12:15], a[176:183], v3
  v_smfmac_f32_16x16x64_bf16 v[52:55], v[12:15], a[232:239], v3
  buffer_load_dwordx4 v[32:35], v2, s[8:11], s23 offen offset:2048 sc1
  v_smfmac_f32_16x16x64_bf16 v[56:59], v[12:15], v[152:159], v3
  v_smfmac_f32_16x16x64_bf16 v[60:63], v[12:15], v[208:215], v3
  s_waitcnt vmcnt(4)
  v_smfmac_f32_16x16x64_bf16 v[36:39], v[16:19], a[16:23], v3
  s_xor_b32 s58, s25, 28672
  s_add_u32 s59, s24, 28672
  s_add_u32 m0, s58, 7168
  v_smfmac_f32_16x16x64_bf16 v[40:43], v[16:19], a[72:79], v3
  buffer_load_dwordx4 v2, s[8:11], s59 offen offset:0 sc1 lds
  v_smfmac_f32_16x16x64_bf16 v[44:47], v[16:19], a[128:135], v3
  v_smfmac_f32_16x16x64_bf16 v[48:51], v[16:19], a[184:191], v3
  v_smfmac_f32_16x16x64_bf16 v[52:55], v[16:19], a[240:247], v3
  v_smfmac_f32_16x16x64_bf16 v[56:59], v[16:19], v[160:167], v3
  buffer_load_dwordx4 v2, s[8:11], s59 offen offset:1024 sc1 lds
  v_smfmac_f32_16x16x64_bf16 v[60:63], v[16:19], v[216:223], v3
  s_waitcnt vmcnt(5)
  v_smfmac_f32_16x16x64_bf16 v[36:39], v[20:23], a[24:31], v3
  v_smfmac_f32_16x16x64_bf16 v[40:43], v[20:23], a[80:87], v3
  v_smfmac_f32_16x16x64_bf16 v[44:47], v[20:23], a[136:143], v3
  buffer_load_dwordx4 v2, s[8:11], s59 offen offset:2048 sc1 lds
  v_smfmac_f32_16x16x64_bf16 v[48:51], v[20:23], a[192:199], v3
  v_smfmac_f32_16x16x64_bf16 v[52:55], v[20:23], a[248:255], v3
  v_smfmac_f32_16x16x64_bf16 v[56:59], v[20:23], v[168:175], v3
  v_smfmac_f32_16x16x64_bf16 v[60:63], v[20:23], v[224:231], v3
  buffer_load_dwordx4 v2, s[8:11], s59 offen offset:3072 sc1 lds
  s_waitcnt vmcnt(4)
cB_sc1_ph2:
  v_smfmac_f32_16x16x64_bf16 v[60:63], v[24:27], v[232:239], v3
  ds_read_b128 v[16:19], v116 offset:2048
  ds_read_b128 v[20:23], v116 offset:3072
  v_smfmac_f32_16x16x64_bf16 v[60:63], v[28:31], v[240:247], v3
  buffer_load_dword v119, v0, s[8:11], s20 offen sc1
  v_smfmac_f32_16x16x64_bf16 v[60:63], v[32:35], v[248:255], v3
  v_mov_b32 v80, v26
  v_smfmac_f32_16x16x64_bf16 v[52:55], v[24:27], v[120:127], v3
  v_mov_b32 v81, v27
  v_smfmac_f32_16x16x64_bf16 v[52:55], v[28:31], v[128:135], v3
  v_mov_b32 v82, v32
  v_smfmac_f32_16x16x64_bf16 v[52:55], v[32:35], v[136:143], v3
  v_cvt_pk_bf16_f32 v66, v60, v61
  v_smfmac_f32_16x16x64_bf16 v[56:59], v[24:27], v[176:183], v3
  v_cvt_pk_bf16_f32 v67, v62, v63
  v_smfmac_f32_16x16x64_bf16 v[56:59], v[28:31], v[184:191], v3
  v_mov_b32 v83, v33
  v_mfma_f32_16x16x32_bf16 v[68:71], v[64:67], v[4:7], 0
  v_smfmac_f32_16x16x64_bf16 v[56:59], v[32:35], v[192:199], v3
  v_cvt_pk_bf16_f32 v64, v52, v53
  v_smfmac_f32_16x16x64_bf16 v[36:39], v[24:27], a[32:39], v3
  v_cvt_pk_bf16_f32 v65, v54, v55
  v_smfmac_f32_16x16x64_bf16 v[36:39], v[28:31], a[40:47], v3
  v_cvt_pk_bf16_f32 v78, v68, v69
  v_smfmac_f32_16x16x64_bf16 v[36:39], v[32:35], a[48:55], v3
  v_cvt_pk_bf16_f32 v79, v70, v71
  v_cvt_pk_bf16_f32 v66, v56, v57
  v_smfmac_f32_16x16x64_bf16 v[40:43], v[24:27], a[88:95], v3
  v_cvt_pk_bf16_f32 v67, v58, v59
  v_smfmac_f32_16x16x64_bf16 v[40:43], v[28:31], a[96:103], v3
  v_mfma_f32_16x16x32_bf16 v[72:75], v[64:67], v[4:7], 0
  ds_read_b128 v[52:55], v116 offset:16384
  ds_read_b128 v[56:59], v116 offset:17408
  v_smfmac_f32_16x16x64_bf16 v[40:43], v[32:35], a[104:111], v3
  v_cvt_pk_bf16_f32 v64, v36, v37
  v_smfmac_f32_16x16x64_bf16 v[44:47], v[24:27], a[144:151], v3
  v_cvt_pk_bf16_f32 v65, v38, v39
  v_smfmac_f32_16x16x64_bf16 v[44:47], v[28:31], a[152:159], v3
  v_cvt_pk_bf16_f32 v76, v72, v73
  v_smfmac_f32_16x16x64_bf16 v[44:47], v[32:35], a[160:167], v3
  v_cvt_pk_bf16_f32 v77, v74, v75
  v_cvt_pk_bf16_f32 v66, v40, v41
  v_smfmac_f32_16x16x64_bf16 v[48:51], v[24:27], a[200:207], v3
  v_cvt_pk_bf16_f32 v67, v42, v43
  v_smfmac_f32_16x16x64_bf16 v[48:51], v[28:31], a[208:215], v3
  v_mfma_f32_16x16x32_bf16 v[68:71], v[64:67], v[4:7], 0
  v_smfmac_f32_16x16x64_bf16 v[48:51], v[32:35], a[216:223], v3
  v_cvt_pk_bf16_f32 v64, v44, v45
  v_mfma_f32_16x16x32_bf16 v[84:87], v[80:83], v[76:79], 0
  v_cvt_pk_bf16_f32 v65, v46, v47
  s_waitcnt lgkmcnt(0)
  v_smfmac_f32_16x16x64_bf16 v[88:91], v[76:79], v[96:103], v118
  v_cvt_pk_bf16_f32 v60, v68, v69
  v_cvt_pk_bf16_f32 v61, v70, v71
  v_cvt_pk_bf16_f32 v66, v48, v49
  v_cvt_pk_bf16_f32 v67, v50, v51
  s_nop 1
  v_mfma_f32_16x16x32_bf16 v[72:75], v[64:67], v[4:7], 0
  v_smfmac_f32_16x16x64_bf16 v[92:95], v[76:79], v[104:111], v118
  s_nop 4
  v_cvt_pk_bf16_f32 v62, v72, v73
  v_cvt_pk_bf16_f32 v63, v74, v75
  s_nop 1
  v_mfma_f32_16x16x32_bf16 v[84:87], v[12:15], v[60:63], v[84:87]
  v_smfmac_f32_16x16x64_bf16 v[88:91], v[60:63], v[16:23], v118
  v_smfmac_f32_16x16x64_bf16 v[92:95], v[60:63], v[52:59], v118
  s_nop 1
  v_permlane32_swap_b32 v84, v86
  v_permlane32_swap_b32 v85, v87
  s_nop 0
  v_add_f32 v88, v88, v89
  v_add_f32_dpp v84, v86, v84 quad_perm:[1,0,3,2] row_mask:0xf bank_mask:0xf
  v_add_f32_dpp v85, v87, v85 quad_perm:[1,0,3,2] row_mask:0xf bank_mask:0xf
  v_add_f32 v89, v90, v91
  ds_write2_b32 v113, v84, v85 offset0:0 offset1:4
  ds_write2_b32 v112, v88, v89 offset0:0 offset1:128
  v_add_f32 v90, v92, v93
  v_add_f32 v91, v94, v95
  ds_write2_b32 v112, v90, v91 offset0:64 offset1:192
  v_cmp_u_f32 vcc, v88, v89
  s_cbranch_vccnz cB_sc1_retry
cB_sc1_cont:
  s_waitcnt lgkmcnt(0)
  s_barrier
  ds_read_b128 v[36:39], v114
  ds_read_b128 v[44:47], v115
  s_waitcnt lgkmcnt(0)
  v_add_f32 v36, v36, v38
  v_add_f32 v37, v37, v39
  v_add_f32 v44, v44, v45
  v_add_f32 v46, v46, v47
  v_add_f32 v44, v44, v46
  v_add_f32 v36, v36, v37
  v_exp_f32 v49, v44
  v_exp_f32 v48, v36
  v_add_f32 v50, abs(v36), abs(v44)
  v_fma_f32 v39, v49, s37, v48
  v_cmp_ngt_f32 vcc, s56, v50
  v_cndmask_b32 v41, v48, v49, s[38:39]
  v_add_f32_dpp v39, v39, v39 quad_perm:[1,0,3,2] row_mask:0xf bank_mask:0xf
  v_cndmask_b32 v40, v49, v48, s[38:39]
  v_mov_b32_dpp v46, v41 quad_perm:[1,0,3,2] row_mask:0xf bank_mask:0xf
  v_add_f32_dpp v39, v39, v39 quad_perm:[2,3,0,1] row_mask:0xf bank_mask:0xf
  v_cndmask_b32 v42, v46, v40, s[38:39]
  v_cndmask_b32 v43, v40, v46, s[38:39]
  v_add_f32_dpp v39, v39, v39 row_half_mirror row_mask:0xf bank_mask:0xf
  s_cbranch_vccnz cB_sc1_slow
  s_nop 0
  v_add_f32_dpp v47, v39, v39 row_mirror row_mask:0xf bank_mask:0xf
  v_add_f32_dpp v39, v39, v39 row_mirror row_mask:0xf bank_mask:0xf
  s_nop 1
  v_permlane16_swap_b32 v39, v47
  v_add_f32 v39, v39, v47
  v_rcp_f32 v39, v39
  s_mov_b64 exec, s[28:29]
  v_mul_f32 v42, v42, v39
  v_mul_f32 v43, v43, v39
  v_cvt_pk_bf16_f32 v42, v42, v43
cB_sc1_pst:
  buffer_store_dword v42, v1, s[8:11], s20 offen sc1
  s_mov_b64 exec, -1
  s_barrier
  s_add_u32 s24, s24, 28672
  s_add_u32 s35, s35, 28672
  s_xor_b32 s25, s25, 28672
  s_add_u32 m0, s25, 7168
  s_add_u32 m0, s25, 11264
  s_add_u32 s22, s24, 4096
  buffer_load_dwordx4 v2, s[8:11], s22 offen offset:0 sc1 lds
  s_nop 5
  buffer_load_dwordx4 v2, s[8:11], s22 offen offset:1024 sc1 lds
  s_nop 5
  buffer_load_dwordx4 v2, s[8:11], s22 offen offset:2048 sc1 lds
  s_nop 5
  v_xor_b32 v116, 28672, v116
  v_add_u32 v117, s57, v117
  s_sub_u32 s57, 0, s57
  s_add_u32 s19, s19, 1
  s_mov_b32 s20, s21
  s_cmp_lt_u32 s19, 63
  s_cbranch_scc1 cB_sc1_loop
  s_branch cB_done
cB_sc1_slow:
  v_max_f32 v50, v36, v44
  s_nop 1
  v_max_f32_dpp v50, v50, v50 quad_perm:[1,0,3,2] row_mask:0xf bank_mask:0xf
  s_nop 1
  v_max_f32_dpp v50, v50, v50 quad_perm:[2,3,0,1] row_mask:0xf bank_mask:0xf
  s_nop 1
  v_max_f32_dpp v50, v50, v50 row_half_mirror row_mask:0xf bank_mask:0xf
  s_nop 1
  v_max_f32_dpp v50, v50, v50 row_mirror row_mask:0xf bank_mask:0xf
  v_mov_b32 v47, v50
  s_nop 1
  v_permlane16_swap_b32 v50, v47
  v_max_f32 v50, v50, v47
  v_sub_f32 v48, v36, v50
  v_sub_f32 v49, v44, v50
  v_exp_f32 v48, v48
  v_exp_f32 v49, v49
  s_add_u32 s31, s31, 0x100
  v_fma_f32 v39, v49, s37, v48
  v_cndmask_b32 v41, v48, v49, s[38:39]
  s_nop 0
  v_add_f32_dpp v39, v39, v39 quad_perm:[1,0,3,2] row_mask:0xf bank_mask:0xf
  v_cndmask_b32 v40, v49, v48, s[38:39]
  v_mov_b32_dpp v46, v41 quad_perm:[1,0,3,2] row_mask:0xf bank_mask:0xf
  v_add_f32_dpp v39, v39, v39 quad_perm:[2,3,0,1] row_mask:0xf bank_mask:0xf
  v_cndmask_b32 v42, v46, v40, s[38:39]
  v_cndmask_b32 v43, v40, v46, s[38:39]
  v_add_f32_dpp v39, v39, v39 row_half_mirror row_mask:0xf bank_mask:0xf
  s_nop 1
  v_add_f32_dpp v47, v39, v39 row_mirror row_mask:0xf bank_mask:0xf
  v_add_f32_dpp v39, v39, v39 row_mirror row_mask:0xf bank_mask:0xf
  s_nop 1
  v_permlane16_swap_b32 v39, v47
  v_add_f32 v39, v39, v47
  v_rcp_f32 v39, v39
  s_mov_b64 exec, s[28:29]
  v_mul_f32 v42, v42, v39
  v_mul_f32 v43, v43, v39
  v_cvt_pk_bf16_f32 v42, v42, v43
  v_min_u32 v42, -2, v42
  s_branch cB_sc1_pst
cB_sc1_retry:
  s_cmp_lg_u32 s62, 0
  s_cbranch_scc1 cB_sc1_cont
  s_waitcnt vmcnt(0) lgkmcnt(0)
cB_sc1_rv:
  buffer_load_dwordx4 v[8:11], v2, s[8:11], s20 offen offset:0 sc1
  buffer_load_dwordx4 v[12:15], v2, s[8:11], s20 offen offset:1024 sc1
  buffer_load_dwordx4 v[16:19], v2, s[8:11], s20 offen offset:2048 sc1
  buffer_load_dwordx4 v[20:23], v2, s[8:11], s20 offen offset:3072 sc1
  buffer_load_dwordx4 v[24:27], v2, s[8:11], s23 offen offset:0 sc1
  buffer_load_dwordx4 v[28:31], v2, s[8:11], s23 offen offset:1024 sc1
  buffer_load_dwordx4 v[32:35], v2, s[8:11], s23 offen offset:2048 sc1
  s_waitcnt vmcnt(0)
  v_max3_u32 v68, v8, v9, v10
  v_max3_u32 v68, v68, v11, v12
  v_max3_u32 v68, v68, v13, v14
  v_max3_u32 v68, v68, v15, v16
  v_max3_u32 v68, v68, v17, v18
  v_max3_u32 v68, v68, v19, v20
  v_max3_u32 v68, v68, v21, v22
  v_max3_u32 v68, v68, v23, v24
  v_max3_u32 v68, v68, v25, v26
  v_max3_u32 v68, v68, v27, v28
  v_max3_u32 v68, v68, v29, v30
  v_max3_u32 v68, v68, v31, v32
  v_max3_u32 v68, v68, v33, v34
  v_max_u32 v68, v68, v35
  v_cmp_eq_u32 vcc, -1, v68
  s_cbranch_vccz cB_sc1_rk
  s_add_u32 s30, s30, 1
  s_cmp_lt_u32 s30, 400000
  s_cbranch_scc1 cB_sc1_rv
  s_branch cB_abort
cB_sc1_rk:
  s_mov_b32 s62, 1
  v_mov_b32 v36, 0
  v_mov_b32 v37, 0
  v_mov_b32 v38, 0
  v_mov_b32 v39, 0
  v_mov_b32 v40, 0
  v_mov_b32 v41, 0
  v_mov_b32 v42, 0
  v_mov_b32 v43, 0
  v_mov_b32 v44, 0
  v_mov_b32 v45, 0
  v_mov_b32 v46, 0
  v_mov_b32 v47, 0
  v_mov_b32 v48, 0
  v_mov_b32 v49, 0
  v_mov_b32 v50, 0
  v_mov_b32 v51, 0
  v_mov_b32 v52, 0
  v_mov_b32 v53, 0
  v_mov_b32 v54, 0
  v_mov_b32 v55, 0
  v_mov_b32 v56, 0
  v_mov_b32 v57, 0
  v_mov_b32 v58, 0
  v_mov_b32 v59, 0
  v_mov_b32 v60, 0
  v_mov_b32 v61, 0
  v_mov_b32 v62, 0
  v_mov_b32 v63, 0
  v_mov_b32 v88, 0
  v_mov_b32 v89, 0
  v_mov_b32 v90, 0
  v_mov_b32 v91, 0
  v_mov_b32 v92, 0
  v_mov_b32 v93, 0
  v_mov_b32 v94, 0
  v_mov_b32 v95, 0
  v_mov_b32 v64, 0
  v_mov_b32 v65, 0
  s_add_u32 s31, s31, 1
  ds_read_b128 v[96:99], v117 offset:0
  ds_read_b128 v[100:103], v117 offset:1024
  ds_read_b128 v[104:107], v117 offset:14336
  ds_read_b128 v[108:111], v117 offset:15360
  v_smfmac_f32_16x16x64_bf16 v[36:39], v[8:11], a[0:7], v3
  v_smfmac_f32_16x16x64_bf16 v[40:43], v[8:11], a[56:63], v3
  v_smfmac_f32_16x16x64_bf16 v[44:47], v[8:11], a[112:119], v3
  v_smfmac_f32_16x16x64_bf16 v[48:51], v[8:11], a[168:175], v3
  v_smfmac_f32_16x16x64_bf16 v[52:55], v[8:11], a[224:231], v3
  v_smfmac_f32_16x16x64_bf16 v[56:59], v[8:11], v[144:151], v3
  v_smfmac_f32_16x16x64_bf16 v[60:63], v[8:11], v[200:207], v3
  v_smfmac_f32_16x16x64_bf16 v[36:39], v[12:15], a[8:15], v3
  v_smfmac_f32_16x16x64_bf16 v[40:43], v[12:15], a[64:71], v3
  v_smfmac_f32_16x16x64_bf16 v[44:47], v[12:15], a[120:127], v3
  v_smfmac_f32_16x16x64_bf16 v[48:51], v[12:15], a[176:183], v3
  v_smfmac_f32_16x16x64_bf16 v[52:55], v[12:15], a[232:239], v3
  v_smfmac_f32_16x16x64_bf16 v[56:59], v[12:15], v[152:159], v3
  v_smfmac_f32_16x16x64_bf16 v[60:63], v[12:15], v[208:215], v3
  v_smfmac_f32_16x16x64_bf16 v[36:39], v[16:19], a[16:23], v3
  v_smfmac_f32_16x16x64_bf16 v[40:43], v[16:19], a[72:79], v3
  v_smfmac_f32_16x16x64_bf16 v[44:47], v[16:19], a[128:135], v3
  v_smfmac_f32_16x16x64_bf16 v[48:51], v[16:19], a[184:191], v3
  v_smfmac_f32_16x16x64_bf16 v[52:55], v[16:19], a[240:247], v3
  v_smfmac_f32_16x16x64_bf16 v[56:59], v[16:19], v[160:167], v3
  v_smfmac_f32_16x16x64_bf16 v[60:63], v[16:19], v[216:223], v3
  v_smfmac_f32_16x16x64_bf16 v[36:39], v[20:23], a[24:31], v3
  v_smfmac_f32_16x16x64_bf16 v[40:43], v[20:23], a[80:87], v3
  v_smfmac_f32_16x16x64_bf16 v[44:47], v[20:23], a[136:143], v3
  v_smfmac_f32_16x16x64_bf16 v[48:51], v[20:23], a[192:199], v3
  v_smfmac_f32_16x16x64_bf16 v[52:55], v[20:23], a[248:255], v3
  v_smfmac_f32_16x16x64_bf16 v[56:59], v[20:23], v[168:175], v3
  v_smfmac_f32_16x16x64_bf16 v[60:63], v[20:23], v[224:231], v3
  s_xor_b32 s58, s25, 28672
  s_add_u32 s59, s24, 28672
  s_add_u32 m0, s58, 7168
  s_branch cB_sc1_ph2
.p2align 6

cB_sc2_loop:
  s_add_u32 s23, s20, 4096
  s_add_u32 s21, s20, 20480
  v_mov_b32 v48, 0
  v_mov_b32 v49, 0
  v_mov_b32 v50, 0
  v_mov_b32 v51, 0
  v_mov_b32 v52, 0
  v_mov_b32 v53, 0
  v_mov_b32 v54, 0
  v_mov_b32 v55, 0
  v_mov_b32 v56, 0
  v_mov_b32 v57, 0
  v_mov_b32 v58, 0
  v_mov_b32 v59, 0
  v_mov_b32 v60, 0
  v_mov_b32 v61, 0
  v_mov_b32 v62, 0
  v_mov_b32 v63, 0
  v_mov_b32 v88, 0
  v_mov_b32 v89, 0
  v_mov_b32 v90, 0
  v_mov_b32 v91, 0
  v_mov_b32 v92, 0
  v_mov_b32 v93, 0
  v_mov_b32 v94, 0
  v_mov_b32 v95, 0
  v_mov_b32 v66, 0
  v_mov_b32 v67, 0
  s_mov_b32 s30, 0
  s_mov_b32 s62, 0
  s_waitcnt vmcnt(0)
  s_barrier
cB_sc2_ld:
  buffer_load_dwordx4 v[8:11], v2, s[8:11], s20 offen offset:0 sc1
  v_mov_b32 v36, 0
  v_mov_b32 v37, 0
  v_mov_b32 v38, 0
  v_mov_b32 v39, 0
  buffer_load_dwordx4 v[12:15], v2, s[8:11], s20 offen offset:1024 sc1
  v_mov_b32 v40, 0
  v_mov_b32 v41, 0
  v_mov_b32 v42, 0
  v_mov_b32 v43, 0
  buffer_load_dwordx4 v[16:19], v2, s[8:11], s20 offen offset:2048 sc1
  v_mov_b32 v44, 0
  v_mov_b32 v45, 0
  v_mov_b32 v46, 0
  v_mov_b32 v47, 0
  ds_read_b128 v[96:99], v117 offset:0
  ds_read_b128 v[100:103], v117 offset:1024
  ds_read_b128 v[104:107], v117 offset:14336
  ds_read_b128 v[108:111], v117 offset:15360
  s_waitcnt vmcnt(2)
  v_smfmac_f32_16x16x64_bf16 v[36:39], v[8:11], a[0:7], v3
  v_smfmac_f32_16x16x64_bf16 v[40:43], v[8:11], a[56:63], v3
  buffer_load_dwordx4 v[20:23], v2, s[8:11], s20 offen offset:3072 sc1
  v_smfmac_f32_16x16x64_bf16 v[44:47], v[8:11], a[112:119], v3
  v_smfmac_f32_16x16x64_bf16 v[48:51], v[8:11], a[168:175], v3
  v_smfmac_f32_16x16x64_bf16 v[52:55], v[8:11], a[224:231], v3
  buffer_load_dwordx4 v[24:27], v2, s[8:11], s23 offen offset:0 sc1
  v_smfmac_f32_16x16x64_bf16 v[56:59], v[8:11], v[144:151], v3
  v_smfmac_f32_16x16x64_bf16 v[60:63], v[8:11], v[200:207], v3
  s_waitcnt vmcnt(3)
  v_smfmac_f32_16x16x64_bf16 v[36:39], v[12:15], a[8:15], v3
  v_smfmac_f32_16x16x64_bf16 v[40:43], v[12:15], a[64:71], v3
  buffer_load_dwordx4 v[28:31], v2, s[8:11], s23 offen offset:1024 sc1
  v_smfmac_f32_16x16x64_bf16 v[44:47], v[12:15], a[120:127], v3
  v_smfmac_f32_16x16x64_bf16 v[48:51], v[12:15], a[176:183], v3
  v_smfmac_f32_16x16x64_bf16 v[52:55], v[12:15], a[232:239], v3
  buffer_load_dwordx4 v[32:35], v2, s[8:11], s23 offen offset:2048 sc1
  v_smfmac_f32_16x16x64_bf16 v[56:59], v[12:15], v[152:159], v3
  v_smfmac_f32_16x16x64_bf16 v[60:63], v[12:15], v[208:215], v3
  s_waitcnt vmcnt(4)
  v_smfmac_f32_16x16x64_bf16 v[36:39], v[16:19], a[16:23], v3
  v_smfmac_f32_16x16x64_bf16 v[40:43], v[16:19], a[72:79], v3
  s_xor_b32 s58, s25, 28672
  s_add_u32 s59, s24, 28672
  s_add_u32 m0, s58, 14336
  v_smfmac_f32_16x16x64_bf16 v[44:47], v[16:19], a[128:135], v3
  buffer_load_dwordx4 v2, s[8:11], s59 offen offset:0 sc1 lds
  v_smfmac_f32_16x16x64_bf16 v[48:51], v[16:19], a[184:191], v3
  v_smfmac_f32_16x16x64_bf16 v[52:55], v[16:19], a[240:247], v3
  v_smfmac_f32_16x16x64_bf16 v[56:59], v[16:19], v[160:167], v3
  v_smfmac_f32_16x16x64_bf16 v[60:63], v[16:19], v[216:223], v3
  buffer_load_dwordx4 v2, s[8:11], s59 offen offset:1024 sc1 lds
  s_waitcnt vmcnt(5)
  v_smfmac_f32_16x16x64_bf16 v[36:39], v[20:23], a[24:31], v3
  v_smfmac_f32_16x16x64_bf16 v[40:43], v[20:23], a[80:87], v3
  v_smfmac_f32_16x16x64_bf16 v[44:47], v[20:23], a[136:143], v3
  v_smfmac_f32_16x16x64_bf16 v[48:51], v[20:23], a[192:199], v3
  buffer_load_dwordx4 v2, s[8:11], s59 offen offset:2048 sc1 lds
  v_smfmac_f32_16x16x64_bf16 v[52:55], v[20:23], a[248:255], v3
  v_smfmac_f32_16x16x64_bf16 v[56:59], v[20:23], v[168:175], v3
  v_smfmac_f32_16x16x64_bf16 v[60:63], v[20:23], v[224:231], v3
  s_waitcnt vmcnt(3)
cB_sc2_ph2:
  v_smfmac_f32_16x16x64_bf16 v[60:63], v[24:27], v[232:239], v3
  buffer_load_dwordx4 v2, s[8:11], s59 offen offset:3072 sc1 lds
  ds_read_b128 v[8:11], v116 offset:4096
  ds_read_b128 v[12:15], v116 offset:5120
  v_smfmac_f32_16x16x64_bf16 v[60:63], v[28:31], v[240:247], v3
  buffer_load_dword v119, v0, s[8:11], s24 offen sc1
  v_smfmac_f32_16x16x64_bf16 v[60:63], v[32:35], v[248:255], v3
  v_mov_b32 v80, v28
  v_smfmac_f32_16x16x64_bf16 v[52:55], v[24:27], v[120:127], v3
  v_mov_b32 v81, v29
  v_smfmac_f32_16x16x64_bf16 v[52:55], v[28:31], v[128:135], v3
  v_mov_b32 v82, v34
  v_smfmac_f32_16x16x64_bf16 v[52:55], v[32:35], v[136:143], v3
  v_cvt_pk_bf16_f32 v64, v60, v61
  v_smfmac_f32_16x16x64_bf16 v[56:59], v[24:27], v[176:183], v3
  v_cvt_pk_bf16_f32 v65, v62, v63
  v_smfmac_f32_16x16x64_bf16 v[56:59], v[28:31], v[184:191], v3
  v_mov_b32 v83, v35
  v_mfma_f32_16x16x32_bf16 v[68:71], v[64:67], v[4:7], 0
  v_smfmac_f32_16x16x64_bf16 v[56:59], v[32:35], v[192:199], v3
  v_cvt_pk_bf16_f32 v64, v52, v53
  v_smfmac_f32_16x16x64_bf16 v[36:39], v[24:27], a[32:39], v3
  v_cvt_pk_bf16_f32 v65, v54, v55
  v_smfmac_f32_16x16x64_bf16 v[36:39], v[28:31], a[40:47], v3
  v_cvt_pk_bf16_f32 v78, v68, v69
  v_smfmac_f32_16x16x64_bf16 v[36:39], v[32:35], a[48:55], v3
  v_cvt_pk_bf16_f32 v79, v70, v71
  v_cvt_pk_bf16_f32 v66, v56, v57
  v_smfmac_f32_16x16x64_bf16 v[40:43], v[24:27], a[88:95], v3
  v_cvt_pk_bf16_f32 v67, v58, v59
  v_smfmac_f32_16x16x64_bf16 v[40:43], v[28:31], a[96:103], v3
  v_mfma_f32_16x16x32_bf16 v[72:75], v[64:67], v[4:7], 0
  ds_read_b128 v[52:55], v116 offset:18432
  ds_read_b128 v[56:59], v116 offset:19456
  v_smfmac_f32_16x16x64_bf16 v[40:43], v[32:35], a[104:111], v3
  v_cvt_pk_bf16_f32 v64, v36, v37
  v_smfmac_f32_16x16x64_bf16 v[44:47], v[24:27], a[144:151], v3
  v_cvt_pk_bf16_f32 v65, v38, v39
  v_smfmac_f32_16x16x64_bf16 v[44:47], v[28:31], a[152:159], v3
  v_cvt_pk_bf16_f32 v76, v72, v73
  v_smfmac_f32_16x16x64_bf16 v[44:47], v[32:35], a[160:167], v3
  v_cvt_pk_bf16_f32 v77, v74, v75
  v_cvt_pk_bf16_f32 v66, v40, v41
  v_smfmac_f32_16x16x64_bf16 v[48:51], v[24:27], a[200:207], v3
  v_cvt_pk_bf16_f32 v67, v42, v43
  v_smfmac_f32_16x16x64_bf16 v[48:51], v[28:31], a[208:215], v3
  v_mfma_f32_16x16x32_bf16 v[68:71], v[64:67], v[4:7], 0
  v_smfmac_f32_16x16x64_bf16 v[48:51], v[32:35], a[216:223], v3
  v_cvt_pk_bf16_f32 v64, v44, v45
  v_mfma_f32_16x16x32_bf16 v[84:87], v[80:83], v[76:79], 0
  v_cvt_pk_bf16_f32 v65, v46, v47
  s_waitcnt lgkmcnt(0)
  v_smfmac_f32_16x16x64_bf16 v[88:91], v[76:79], v[96:103], v118
  v_cvt_pk_bf16_f32 v60, v68, v69
  v_cvt_pk_bf16_f32 v61, v70, v71
  v_cvt_pk_bf16_f32 v66, v48, v49
  v_cvt_pk_bf16_f32 v67, v50, v51
  s_nop 1
  v_mfma_f32_16x16x32_bf16 v[72:75], v[64:67], v[4:7], 0
  v_smfmac_f32_16x16x64_bf16 v[92:95], v[76:79], v[104:111], v118
  s_nop 4
  v_cvt_pk_bf16_f32 v62, v72, v73
  v_cvt_pk_bf16_f32 v63, v74, v75
  s_nop 1
  v_mfma_f32_16x16x32_bf16 v[84:87], v[16:19], v[60:63], v[84:87]
  v_smfmac_f32_16x16x64_bf16 v[88:91], v[60:63], v[8:15], v118
  v_smfmac_f32_16x16x64_bf16 v[92:95], v[60:63], v[52:59], v118
  s_nop 1
  v_permlane32_swap_b32 v84, v86
  v_permlane32_swap_b32 v85, v87
  s_nop 0
  v_add_f32 v88, v88, v89
  v_add_f32_dpp v84, v86, v84 quad_perm:[1,0,3,2] row_mask:0xf bank_mask:0xf
  v_add_f32_dpp v85, v87, v85 quad_perm:[1,0,3,2] row_mask:0xf bank_mask:0xf
  v_add_f32 v89, v90, v91
  ds_write2_b32 v113, v84, v85 offset0:0 offset1:4
  ds_write2_b32 v112, v88, v89 offset0:0 offset1:128
  v_add_f32 v90, v92, v93
  v_add_f32 v91, v94, v95
  ds_write2_b32 v112, v90, v91 offset0:64 offset1:192
  v_cmp_u_f32 vcc, v88, v89
  s_cbranch_vccnz cB_sc2_retry
cB_sc2_cont:
  s_waitcnt lgkmcnt(0)
  s_barrier
  ds_read_b128 v[36:39], v114
  ds_read_b128 v[44:47], v115
  s_waitcnt lgkmcnt(0)
  v_add_f32 v36, v36, v38
  v_add_f32 v37, v37, v39
  v_add_f32 v44, v44, v45
  v_add_f32 v46, v46, v47
  v_add_f32 v44, v44, v46
  v_add_f32 v36, v36, v37
  v_exp_f32 v49, v44
  v_exp_f32 v48, v36
  v_add_f32 v50, abs(v36), abs(v44)
  v_fma_f32 v39, v49, s37, v48
  v_cmp_ngt_f32 vcc, s56, v50
  v_cndmask_b32 v41, v48, v49, s[38:39]
  v_add_f32_dpp v39, v39, v39 quad_perm:[1,0,3,2] row_mask:0xf bank_mask:0xf
  v_cndmask_b32 v40, v49, v48, s[38:39]
  v_mov_b32_dpp v46, v41 quad_perm:[1,0,3,2] row_mask:0xf bank_mask:0xf
  v_add_f32_dpp v39, v39, v39 quad_perm:[2,3,0,1] row_mask:0xf bank_mask:0xf
  v_cndmask_b32 v42, v46, v40, s[38:39]
  v_cndmask_b32 v43, v40, v46, s[38:39]
  v_add_f32_dpp v39, v39, v39 row_half_mirror row_mask:0xf bank_mask:0xf
  s_cbranch_vccnz cB_sc2_slow
  s_nop 0
  v_add_f32_dpp v47, v39, v39 row_mirror row_mask:0xf bank_mask:0xf
  v_add_f32_dpp v39, v39, v39 row_mirror row_mask:0xf bank_mask:0xf
  s_nop 1
  v_permlane16_swap_b32 v39, v47
  v_add_f32 v39, v39, v47
  v_rcp_f32 v39, v39
  s_mov_b64 exec, s[28:29]
  v_mul_f32 v42, v42, v39
  v_mul_f32 v43, v43, v39
  v_cvt_pk_bf16_f32 v42, v42, v43
cB_sc2_pst:
  buffer_store_dword v42, v1, s[8:11], s20 offen sc1
  s_mov_b64 exec, -1
  s_barrier
  s_add_u32 s24, s24, 28672
  s_add_u32 s35, s35, 28672
  s_xor_b32 s25, s25, 28672
  s_add_u32 m0, s25, 14336
  s_add_u32 m0, s25, 18432
  s_add_u32 s22, s24, 4096
  buffer_load_dwordx4 v2, s[8:11], s22 offen offset:0 sc1 lds
  s_nop 5
  buffer_load_dwordx4 v2, s[8:11], s22 offen offset:1024 sc1 lds
  s_nop 5
  buffer_load_dwordx4 v2, s[8:11], s22 offen offset:2048 sc1 lds
  s_nop 5
  v_xor_b32 v116, 28672, v116
  v_add_u32 v117, s57, v117
  s_sub_u32 s57, 0, s57
  s_add_u32 s19, s19, 1
  s_mov_b32 s20, s21
  s_cmp_lt_u32 s19, 63
  s_cbranch_scc1 cB_sc2_loop
  s_branch cB_done
cB_sc2_slow:
  v_max_f32 v50, v36, v44
  s_nop 1
  v_max_f32_dpp v50, v50, v50 quad_perm:[1,0,3,2] row_mask:0xf bank_mask:0xf
  s_nop 1
  v_max_f32_dpp v50, v50, v50 quad_perm:[2,3,0,1] row_mask:0xf bank_mask:0xf
  s_nop 1
  v_max_f32_dpp v50, v50, v50 row_half_mirror row_mask:0xf bank_mask:0xf
  s_nop 1
  v_max_f32_dpp v50, v50, v50 row_mirror row_mask:0xf bank_mask:0xf
  v_mov_b32 v47, v50
  s_nop 1
  v_permlane16_swap_b32 v50, v47
  v_max_f32 v50, v50, v47
  v_sub_f32 v48, v36, v50
  v_sub_f32 v49, v44, v50
  v_exp_f32 v48, v48
  v_exp_f32 v49, v49
  s_add_u32 s31, s31, 0x100
  v_fma_f32 v39, v49, s37, v48
  v_cndmask_b32 v41, v48, v49, s[38:39]
  s_nop 0
  v_add_f32_dpp v39, v39, v39 quad_perm:[1,0,3,2] row_mask:0xf bank_mask:0xf
  v_cndmask_b32 v40, v49, v48, s[38:39]
  v_mov_b32_dpp v46, v41 quad_perm:[1,0,3,2] row_mask:0xf bank_mask:0xf
  v_add_f32_dpp v39, v39, v39 quad_perm:[2,3,0,1] row_mask:0xf bank_mask:0xf
  v_cndmask_b32 v42, v46, v40, s[38:39]
  v_cndmask_b32 v43, v40, v46, s[38:39]
  v_add_f32_dpp v39, v39, v39 row_half_mirror row_mask:0xf bank_mask:0xf
  s_nop 1
  v_add_f32_dpp v47, v39, v39 row_mirror row_mask:0xf bank_mask:0xf
  v_add_f32_dpp v39, v39, v39 row_mirror row_mask:0xf bank_mask:0xf
  s_nop 1
  v_permlane16_swap_b32 v39, v47
  v_add_f32 v39, v39, v47
  v_rcp_f32 v39, v39
  s_mov_b64 exec, s[28:29]
  v_mul_f32 v42, v42, v39
  v_mul_f32 v43, v43, v39
  v_cvt_pk_bf16_f32 v42, v42, v43
  v_min_u32 v42, -2, v42
  s_branch cB_sc2_pst
cB_sc2_retry:
  s_cmp_lg_u32 s62, 0
  s_cbranch_scc1 cB_sc2_cont
  s_waitcnt vmcnt(0) lgkmcnt(0)
cB_sc2_rv:
  buffer_load_dwordx4 v[8:11], v2, s[8:11], s20 offen offset:0 sc1
  buffer_load_dwordx4 v[12:15], v2, s[8:11], s20 offen offset:1024 sc1
  buffer_load_dwordx4 v[16:19], v2, s[8:11], s20 offen offset:2048 sc1
  buffer_load_dwordx4 v[20:23], v2, s[8:11], s20 offen offset:3072 sc1
  buffer_load_dwordx4 v[24:27], v2, s[8:11], s23 offen offset:0 sc1
  buffer_load_dwordx4 v[28:31], v2, s[8:11], s23 offen offset:1024 sc1
  buffer_load_dwordx4 v[32:35], v2, s[8:11], s23 offen offset:2048 sc1
  s_waitcnt vmcnt(0)
  v_max3_u32 v68, v8, v9, v10
  v_max3_u32 v68, v68, v11, v12
  v_max3_u32 v68, v68, v13, v14
  v_max3_u32 v68, v68, v15, v16
  v_max3_u32 v68, v68, v17, v18
  v_max3_u32 v68, v68, v19, v20
  v_max3_u32 v68, v68, v21, v22
  v_max3_u32 v68, v68, v23, v24
  v_max3_u32 v68, v68, v25, v26
  v_max3_u32 v68, v68, v27, v28
  v_max3_u32 v68, v68, v29, v30
  v_max3_u32 v68, v68, v31, v32
  v_max3_u32 v68, v68, v33, v34
  v_max_u32 v68, v68, v35
  v_cmp_eq_u32 vcc, -1, v68
  s_cbranch_vccz cB_sc2_rk
  s_add_u32 s30, s30, 1
  s_cmp_lt_u32 s30, 400000
  s_cbranch_scc1 cB_sc2_rv
  s_branch cB_abort
cB_sc2_rk:
  s_mov_b32 s62, 1
  v_mov_b32 v36, 0
  v_mov_b32 v37, 0
  v_mov_b32 v38, 0
  v_mov_b32 v39, 0
  v_mov_b32 v40, 0
  v_mov_b32 v41, 0
  v_mov_b32 v42, 0
  v_mov_b32 v43, 0
  v_mov_b32 v44, 0
  v_mov_b32 v45, 0
  v_mov_b32 v46, 0
  v_mov_b32 v47, 0
  v_mov_b32 v48, 0
  v_mov_b32 v49, 0
  v_mov_b32 v50, 0
  v_mov_b32 v51, 0
  v_mov_b32 v52, 0
  v_mov_b32 v53, 0
  v_mov_b32 v54, 0
  v_mov_b32 v55, 0
  v_mov_b32 v56, 0
  v_mov_b32 v57, 0
  v_mov_b32 v58, 0
  v_mov_b32 v59, 0
  v_mov_b32 v60, 0
  v_mov_b32 v61, 0
  v_mov_b32 v62, 0
  v_mov_b32 v63, 0
  v_mov_b32 v88, 0
  v_mov_b32 v89, 0
  v_mov_b32 v90, 0
  v_mov_b32 v91, 0
  v_mov_b32 v92, 0
  v_mov_b32 v93, 0
  v_mov_b32 v94, 0
  v_mov_b32 v95, 0
  v_mov_b32 v66, 0
  v_mov_b32 v67, 0
  s_add_u32 s31, s31, 1
  ds_read_b128 v[96:99], v117 offset:0
  ds_read_b128 v[100:103], v117 offset:1024
  ds_read_b128 v[104:107], v117 offset:14336
  ds_read_b128 v[108:111], v117 offset:15360
  v_smfmac_f32_16x16x64_bf16 v[36:39], v[8:11], a[0:7], v3
  v_smfmac_f32_16x16x64_bf16 v[40:43], v[8:11], a[56:63], v3
  v_smfmac_f32_16x16x64_bf16 v[44:47], v[8:11], a[112:119], v3
  v_smfmac_f32_16x16x64_bf16 v[48:51], v[8:11], a[168:175], v3
  v_smfmac_f32_16x16x64_bf16 v[52:55], v[8:11], a[224:231], v3
  v_smfmac_f32_16x16x64_bf16 v[56:59], v[8:11], v[144:151], v3
  v_smfmac_f32_16x16x64_bf16 v[60:63], v[8:11], v[200:207], v3
  v_smfmac_f32_16x16x64_bf16 v[36:39], v[12:15], a[8:15], v3
  v_smfmac_f32_16x16x64_bf16 v[40:43], v[12:15], a[64:71], v3
  v_smfmac_f32_16x16x64_bf16 v[44:47], v[12:15], a[120:127], v3
  v_smfmac_f32_16x16x64_bf16 v[48:51], v[12:15], a[176:183], v3
  v_smfmac_f32_16x16x64_bf16 v[52:55], v[12:15], a[232:239], v3
  v_smfmac_f32_16x16x64_bf16 v[56:59], v[12:15], v[152:159], v3
  v_smfmac_f32_16x16x64_bf16 v[60:63], v[12:15], v[208:215], v3
  v_smfmac_f32_16x16x64_bf16 v[36:39], v[16:19], a[16:23], v3
  v_smfmac_f32_16x16x64_bf16 v[40:43], v[16:19], a[72:79], v3
  v_smfmac_f32_16x16x64_bf16 v[44:47], v[16:19], a[128:135], v3
  v_smfmac_f32_16x16x64_bf16 v[48:51], v[16:19], a[184:191], v3
  v_smfmac_f32_16x16x64_bf16 v[52:55], v[16:19], a[240:247], v3
  v_smfmac_f32_16x16x64_bf16 v[56:59], v[16:19], v[160:167], v3
  v_smfmac_f32_16x16x64_bf16 v[60:63], v[16:19], v[216:223], v3
  v_smfmac_f32_16x16x64_bf16 v[36:39], v[20:23], a[24:31], v3
  v_smfmac_f32_16x16x64_bf16 v[40:43], v[20:23], a[80:87], v3
  v_smfmac_f32_16x16x64_bf16 v[44:47], v[20:23], a[136:143], v3
  v_smfmac_f32_16x16x64_bf16 v[48:51], v[20:23], a[192:199], v3
  v_smfmac_f32_16x16x64_bf16 v[52:55], v[20:23], a[248:255], v3
  v_smfmac_f32_16x16x64_bf16 v[56:59], v[20:23], v[168:175], v3
  v_smfmac_f32_16x16x64_bf16 v[60:63], v[20:23], v[224:231], v3
  s_xor_b32 s58, s25, 28672
  s_add_u32 s59, s24, 28672
  s_add_u32 m0, s58, 14336
  s_branch cB_sc2_ph2
.p2align 6

cB_sc3_loop:
  s_add_u32 s23, s20, 4096
  s_add_u32 s21, s20, 20480
  v_mov_b32 v48, 0
  v_mov_b32 v49, 0
  v_mov_b32 v50, 0
  v_mov_b32 v51, 0
  v_mov_b32 v52, 0
  v_mov_b32 v53, 0
  v_mov_b32 v54, 0
  v_mov_b32 v55, 0
  v_mov_b32 v56, 0
  v_mov_b32 v57, 0
  v_mov_b32 v58, 0
  v_mov_b32 v59, 0
  v_mov_b32 v60, 0
  v_mov_b32 v61, 0
  v_mov_b32 v62, 0
  v_mov_b32 v63, 0
  v_mov_b32 v88, 0
  v_mov_b32 v89, 0
  v_mov_b32 v90, 0
  v_mov_b32 v91, 0
  v_mov_b32 v92, 0
  v_mov_b32 v93, 0
  v_mov_b32 v94, 0
  v_mov_b32 v95, 0
  v_mov_b32 v64, 0
  v_mov_b32 v65, 0
  s_mov_b32 s30, 0
  s_mov_b32 s62, 0
  s_waitcnt vmcnt(0)
  s_barrier
cB_sc3_ld:
  buffer_load_dwordx4 v[8:11], v2, s[8:11], s20 offen offset:0 sc1
  v_mov_b32 v36, 0
  v_mov_b32 v37, 0
  v_mov_b32 v38, 0
  v_mov_b32 v39, 0
  buffer_load_dwordx4 v[12:15], v2, s[8:11], s20 offen offset:1024 sc1
  v_mov_b32 v40, 0
  v_mov_b32 v41, 0
  v_mov_b32 v42, 0
  v_mov_b32 v43, 0
  buffer_load_dwordx4 v[16:19], v2, s[8:11], s20 offen offset:2048 sc1
  v_mov_b32 v44, 0
  v_mov_b32 v45, 0
  v_mov_b32 v46, 0
  v_mov_b32 v47, 0
  ds_read_b128 v[96:99], v117 offset:0
  ds_read_b128 v[100:103], v117 offset:1024
  ds_read_b128 v[104:107], v117 offset:14336
  ds_read_b128 v[108:111], v117 offset:15360
  s_waitcnt vmcnt(2)
  v_smfmac_f32_16x16x64_bf16 v[36:39], v[8:11], a[0:7], v3
  v_smfmac_f32_16x16x64_bf16 v[40:43], v[8:11], a[56:63], v3
  buffer_load_dwordx4 v[20:23], v2, s[8:11], s20 offen offset:3072 sc1
  v_smfmac_f32_16x16x64_bf16 v[44:47], v[8:11], a[112:119], v3
  v_smfmac_f32_16x16x64_bf16 v[48:51], v[8:11], a[168:175], v3
  v_smfmac_f32_16x16x64_bf16 v[52:55], v[8:11], a[224:231], v3
  buffer_load_dwordx4 v[24:27], v2, s[8:11], s23 offen offset:0 sc1
  v_smfmac_f32_16x16x64_bf16 v[56:59], v[8:11], v[144:151], v3
  v_smfmac_f32_16x16x64_bf16 v[60:63], v[8:11], v[200:207], v3
  s_waitcnt vmcnt(3)
  v_smfmac_f32_16x16x64_bf16 v[36:39], v[12:15], a[8:15], v3
  v_smfmac_f32_16x16x64_bf16 v[40:43], v[12:15], a[64:71], v3
  buffer_load_dwordx4 v[28:31], v2, s[8:11], s23 offen offset:1024 sc1
  v_smfmac_f32_16x16x64_bf16 v[44:47], v[12:15], a[120:127], v3
  v_smfmac_f32_16x16x64_bf16 v[48:51], v[12:15], a[176:183], v3
  v_smfmac_f32_16x16x64_bf16 v[52:55], v[12:15], a[232:239], v3
  buffer_load_dwordx4 v[32:35], v2, s[8:11], s23 offen offset:2048 sc1
  v_smfmac_f32_16x16x64_bf16 v[56:59], v[12:15], v[152:159], v3
  v_smfmac_f32_16x16x64_bf16 v[60:63], v[12:15], v[208:215], v3
  s_waitcnt vmcnt(4)
  v_smfmac_f32_16x16x64_bf16 v[36:39], v[16:19], a[16:23], v3
  v_smfmac_f32_16x16x64_bf16 v[40:43], v[16:19], a[72:79], v3
  v_smfmac_f32_16x16x64_bf16 v[44:47], v[16:19], a[128:135], v3
  s_xor_b32 s58, s25, 28672
  s_add_u32 s59, s24, 28672
  s_add_u32 m0, s58, 21504
  v_smfmac_f32_16x16x64_bf16 v[48:51], v[16:19], a[184:191], v3
  buffer_load_dwordx4 v2, s[8:11], s59 offen offset:0 sc1 lds
  v_smfmac_f32_16x16x64_bf16 v[52:55], v[16:19], a[240:247], v3
  v_smfmac_f32_16x16x64_bf16 v[56:59], v[16:19], v[160:167], v3
  v_smfmac_f32_16x16x64_bf16 v[60:63], v[16:19], v[216:223], v3
  s_waitcnt vmcnt(4)
  v_smfmac_f32_16x16x64_bf16 v[36:39], v[20:23], a[24:31], v3
  buffer_load_dwordx4 v2, s[8:11], s59 offen offset:1024 sc1 lds
  v_smfmac_f32_16x16x64_bf16 v[40:43], v[20:23], a[80:87], v3
  v_smfmac_f32_16x16x64_bf16 v[44:47], v[20:23], a[136:143], v3
  v_smfmac_f32_16x16x64_bf16 v[48:51], v[20:23], a[192:199], v3
  v_smfmac_f32_16x16x64_bf16 v[52:55], v[20:23], a[248:255], v3
  buffer_load_dwordx4 v2, s[8:11], s59 offen offset:2048 sc1 lds
  v_smfmac_f32_16x16x64_bf16 v[56:59], v[20:23], v[168:175], v3
  v_smfmac_f32_16x16x64_bf16 v[60:63], v[20:23], v[224:231], v3
  s_waitcnt vmcnt(3)
cB_sc3_ph2:
  v_smfmac_f32_16x16x64_bf16 v[60:63], v[24:27], v[232:239], v3
  ds_read_b128 v[8:11], v116 offset:6144
  ds_read_b128 v[12:15], v116 offset:7168
  v_smfmac_f32_16x16x64_bf16 v[60:63], v[28:31], v[240:247], v3
  buffer_load_dwordx4 v2, s[8:11], s59 offen offset:3072 sc1 lds
  v_smfmac_f32_16x16x64_bf16 v[60:63], v[32:35], v[248:255], v3
  v_mov_b32 v80, v30
  v_smfmac_f32_16x16x64_bf16 v[52:55], v[24:27], v[120:127], v3
  v_mov_b32 v81, v31
  v_smfmac_f32_16x16x64_bf16 v[52:55], v[28:31], v[128:135], v3
  v_mov_b32 v82, v34
  v_smfmac_f32_16x16x64_bf16 v[52:55], v[32:35], v[136:143], v3
  v_cvt_pk_bf16_f32 v66, v60, v61
  v_smfmac_f32_16x16x64_bf16 v[56:59], v[24:27], v[176:183], v3
  v_cvt_pk_bf16_f32 v67, v62, v63
  v_smfmac_f32_16x16x64_bf16 v[56:59], v[28:31], v[184:191], v3
  v_mov_b32 v83, v35
  v_mfma_f32_16x16x32_bf16 v[68:71], v[64:67], v[4:7], 0
  v_smfmac_f32_16x16x64_bf16 v[56:59], v[32:35], v[192:199], v3
  v_cvt_pk_bf16_f32 v64, v52, v53
  v_smfmac_f32_16x16x64_bf16 v[36:39], v[24:27], a[32:39], v3
  v_cvt_pk_bf16_f32 v65, v54, v55
  v_smfmac_f32_16x16x64_bf16 v[36:39], v[28:31], a[40:47], v3
  v_cvt_pk_bf16_f32 v78, v68, v69
  v_smfmac_f32_16x16x64_bf16 v[36:39], v[32:35], a[48:55], v3
  v_cvt_pk_bf16_f32 v79, v70, v71
  v_cvt_pk_bf16_f32 v66, v56, v57
  v_smfmac_f32_16x16x64_bf16 v[40:43], v[24:27], a[88:95], v3
  v_cvt_pk_bf16_f32 v67, v58, v59
  v_smfmac_f32_16x16x64_bf16 v[40:43], v[28:31], a[96:103], v3
  v_mfma_f32_16x16x32_bf16 v[72:75], v[64:67], v[4:7], 0
  ds_read_b128 v[52:55], v116 offset:20480
  ds_read_b128 v[56:59], v116 offset:21504
  v_smfmac_f32_16x16x64_bf16 v[40:43], v[32:35], a[104:111], v3
  v_cvt_pk_bf16_f32 v64, v36, v37
  v_smfmac_f32_16x16x64_bf16 v[44:47], v[24:27], a[144:151], v3
  v_cvt_pk_bf16_f32 v65, v38, v39
  v_smfmac_f32_16x16x64_bf16 v[44:47], v[28:31], a[152:159], v3
  v_cvt_pk_bf16_f32 v76, v72, v73
  v_smfmac_f32_16x16x64_bf16 v[44:47], v[32:35], a[160:167], v3
  v_cvt_pk_bf16_f32 v77, v74, v75
  v_cvt_pk_bf16_f32 v66, v40, v41
  v_smfmac_f32_16x16x64_bf16 v[48:51], v[24:27], a[200:207], v3
  v_cvt_pk_bf16_f32 v67, v42, v43
  v_smfmac_f32_16x16x64_bf16 v[48:51], v[28:31], a[208:215], v3
  v_mfma_f32_16x16x32_bf16 v[68:71], v[64:67], v[4:7], 0
  v_smfmac_f32_16x16x64_bf16 v[48:51], v[32:35], a[216:223], v3
  v_cvt_pk_bf16_f32 v64, v44, v45
  v_mfma_f32_16x16x32_bf16 v[84:87], v[80:83], v[76:79], 0
  v_cvt_pk_bf16_f32 v65, v46, v47
  s_waitcnt lgkmcnt(0)
  v_smfmac_f32_16x16x64_bf16 v[88:91], v[76:79], v[96:103], v118
  v_cvt_pk_bf16_f32 v60, v68, v69
  v_cvt_pk_bf16_f32 v61, v70, v71
  v_cvt_pk_bf16_f32 v66, v48, v49
  v_cvt_pk_bf16_f32 v67, v50, v51
  s_nop 1
  v_mfma_f32_16x16x32_bf16 v[72:75], v[64:67], v[4:7], 0
  v_smfmac_f32_16x16x64_bf16 v[92:95], v[76:79], v[104:111], v118
  s_nop 4
  v_cvt_pk_bf16_f32 v62, v72, v73
  v_cvt_pk_bf16_f32 v63, v74, v75
  s_nop 1
  v_mfma_f32_16x16x32_bf16 v[84:87], v[20:23], v[60:63], v[84:87]
  v_smfmac_f32_16x16x64_bf16 v[88:91], v[60:63], v[8:15], v118
  v_smfmac_f32_16x16x64_bf16 v[92:95], v[60:63], v[52:59], v118
  s_nop 1
  v_permlane32_swap_b32 v84, v86
  v_permlane32_swap_b32 v85, v87
  s_nop 0
  v_add_f32 v88, v88, v89
  v_add_f32_dpp v84, v86, v84 quad_perm:[1,0,3,2] row_mask:0xf bank_mask:0xf
  v_add_f32_dpp v85, v87, v85 quad_perm:[1,0,3,2] row_mask:0xf bank_mask:0xf
  v_add_f32 v89, v90, v91
  ds_write2_b32 v113, v84, v85 offset0:0 offset1:4
  ds_write2_b32 v112, v88, v89 offset0:0 offset1:128
  v_add_f32 v90, v92, v93
  v_add_f32 v91, v94, v95
  ds_write2_b32 v112, v90, v91 offset0:64 offset1:192
  v_cmp_u_f32 vcc, v88, v89
  s_cbranch_vccnz cB_sc3_retry
cB_sc3_cont:
  s_waitcnt lgkmcnt(0)
  s_barrier
  ds_read_b128 v[36:39], v114
  ds_read_b128 v[44:47], v115
  s_waitcnt lgkmcnt(0)
  v_add_f32 v36, v36, v38
  v_add_f32 v37, v37, v39
  v_add_f32 v44, v44, v45
  v_add_f32 v46, v46, v47
  v_add_f32 v44, v44, v46
  v_add_f32 v36, v36, v37
  v_exp_f32 v49, v44
  v_exp_f32 v48, v36
  v_add_f32 v50, abs(v36), abs(v44)
  v_fma_f32 v39, v49, s37, v48
  v_cmp_ngt_f32 vcc, s56, v50
  v_cndmask_b32 v41, v48, v49, s[38:39]
  v_add_f32_dpp v39, v39, v39 quad_perm:[1,0,3,2] row_mask:0xf bank_mask:0xf
  v_cndmask_b32 v40, v49, v48, s[38:39]
  v_mov_b32_dpp v46, v41 quad_perm:[1,0,3,2] row_mask:0xf bank_mask:0xf
  v_add_f32_dpp v39, v39, v39 quad_perm:[2,3,0,1] row_mask:0xf bank_mask:0xf
  v_cndmask_b32 v42, v46, v40, s[38:39]
  v_cndmask_b32 v43, v40, v46, s[38:39]
  v_add_f32_dpp v39, v39, v39 row_half_mirror row_mask:0xf bank_mask:0xf
  s_cbranch_vccnz cB_sc3_slow
  s_nop 0
  v_add_f32_dpp v47, v39, v39 row_mirror row_mask:0xf bank_mask:0xf
  v_add_f32_dpp v39, v39, v39 row_mirror row_mask:0xf bank_mask:0xf
  s_nop 1
  v_permlane16_swap_b32 v39, v47
  v_add_f32 v39, v39, v47
  v_rcp_f32 v39, v39
  s_mov_b64 exec, s[28:29]
  v_mul_f32 v42, v42, v39
  v_mul_f32 v43, v43, v39
  v_cvt_pk_bf16_f32 v42, v42, v43
cB_sc3_pst:
  buffer_store_dword v42, v1, s[8:11], s20 offen sc1
  s_mov_b64 exec, -1
  s_barrier
  s_add_u32 s24, s24, 28672
  s_add_u32 s35, s35, 28672
  s_xor_b32 s25, s25, 28672
  s_add_u32 m0, s25, 21504
  s_add_u32 m0, s25, 25600
  s_add_u32 s22, s24, 4096
  buffer_load_dwordx4 v2, s[8:11], s22 offen offset:0 sc1 lds
  s_nop 5
  buffer_load_dwordx4 v2, s[8:11], s22 offen offset:1024 sc1 lds
  s_nop 5
  buffer_load_dwordx4 v2, s[8:11], s22 offen offset:2048 sc1 lds
  s_nop 5
  v_xor_b32 v116, 28672, v116
  v_add_u32 v117, s57, v117
  s_sub_u32 s57, 0, s57
  s_add_u32 s19, s19, 1
  s_mov_b32 s20, s21
  s_cmp_lt_u32 s19, 63
  s_cbranch_scc1 cB_sc3_loop
  s_branch cB_done
cB_sc3_slow:
  v_max_f32 v50, v36, v44
  s_nop 1
  v_max_f32_dpp v50, v50, v50 quad_perm:[1,0,3,2] row_mask:0xf bank_mask:0xf
  s_nop 1
  v_max_f32_dpp v50, v50, v50 quad_perm:[2,3,0,1] row_mask:0xf bank_mask:0xf
  s_nop 1
  v_max_f32_dpp v50, v50, v50 row_half_mirror row_mask:0xf bank_mask:0xf
  s_nop 1
  v_max_f32_dpp v50, v50, v50 row_mirror row_mask:0xf bank_mask:0xf
  v_mov_b32 v47, v50
  s_nop 1
  v_permlane16_swap_b32 v50, v47
  v_max_f32 v50, v50, v47
  v_sub_f32 v48, v36, v50
  v_sub_f32 v49, v44, v50
  v_exp_f32 v48, v48
  v_exp_f32 v49, v49
  s_add_u32 s31, s31, 0x100
  v_fma_f32 v39, v49, s37, v48
  v_cndmask_b32 v41, v48, v49, s[38:39]
  s_nop 0
  v_add_f32_dpp v39, v39, v39 quad_perm:[1,0,3,2] row_mask:0xf bank_mask:0xf
  v_cndmask_b32 v40, v49, v48, s[38:39]
  v_mov_b32_dpp v46, v41 quad_perm:[1,0,3,2] row_mask:0xf bank_mask:0xf
  v_add_f32_dpp v39, v39, v39 quad_perm:[2,3,0,1] row_mask:0xf bank_mask:0xf
  v_cndmask_b32 v42, v46, v40, s[38:39]
  v_cndmask_b32 v43, v40, v46, s[38:39]
  v_add_f32_dpp v39, v39, v39 row_half_mirror row_mask:0xf bank_mask:0xf
  s_nop 1
  v_add_f32_dpp v47, v39, v39 row_mirror row_mask:0xf bank_mask:0xf
  v_add_f32_dpp v39, v39, v39 row_mirror row_mask:0xf bank_mask:0xf
  s_nop 1
  v_permlane16_swap_b32 v39, v47
  v_add_f32 v39, v39, v47
  v_rcp_f32 v39, v39
  s_mov_b64 exec, s[28:29]
  v_mul_f32 v42, v42, v39
  v_mul_f32 v43, v43, v39
  v_cvt_pk_bf16_f32 v42, v42, v43
  v_min_u32 v42, -2, v42
  s_branch cB_sc3_pst
cB_sc3_retry:
  s_cmp_lg_u32 s62, 0
  s_cbranch_scc1 cB_sc3_cont
  s_waitcnt vmcnt(0) lgkmcnt(0)
cB_sc3_rv:
  buffer_load_dwordx4 v[8:11], v2, s[8:11], s20 offen offset:0 sc1
  buffer_load_dwordx4 v[12:15], v2, s[8:11], s20 offen offset:1024 sc1
  buffer_load_dwordx4 v[16:19], v2, s[8:11], s20 offen offset:2048 sc1
  buffer_load_dwordx4 v[20:23], v2, s[8:11], s20 offen offset:3072 sc1
  buffer_load_dwordx4 v[24:27], v2, s[8:11], s23 offen offset:0 sc1
  buffer_load_dwordx4 v[28:31], v2, s[8:11], s23 offen offset:1024 sc1
  buffer_load_dwordx4 v[32:35], v2, s[8:11], s23 offen offset:2048 sc1
  s_waitcnt vmcnt(0)
  v_max3_u32 v68, v8, v9, v10
  v_max3_u32 v68, v68, v11, v12
  v_max3_u32 v68, v68, v13, v14
  v_max3_u32 v68, v68, v15, v16
  v_max3_u32 v68, v68, v17, v18
  v_max3_u32 v68, v68, v19, v20
  v_max3_u32 v68, v68, v21, v22
  v_max3_u32 v68, v68, v23, v24
  v_max3_u32 v68, v68, v25, v26
  v_max3_u32 v68, v68, v27, v28
  v_max3_u32 v68, v68, v29, v30
  v_max3_u32 v68, v68, v31, v32
  v_max3_u32 v68, v68, v33, v34
  v_max_u32 v68, v68, v35
  v_cmp_eq_u32 vcc, -1, v68
  s_cbranch_vccz cB_sc3_rk
  s_add_u32 s30, s30, 1
  s_cmp_lt_u32 s30, 400000
  s_cbranch_scc1 cB_sc3_rv
  s_branch cB_abort
cB_sc3_rk:
  s_mov_b32 s62, 1
  v_mov_b32 v36, 0
  v_mov_b32 v37, 0
  v_mov_b32 v38, 0
  v_mov_b32 v39, 0
  v_mov_b32 v40, 0
  v_mov_b32 v41, 0
  v_mov_b32 v42, 0
  v_mov_b32 v43, 0
  v_mov_b32 v44, 0
  v_mov_b32 v45, 0
  v_mov_b32 v46, 0
  v_mov_b32 v47, 0
  v_mov_b32 v48, 0
  v_mov_b32 v49, 0
  v_mov_b32 v50, 0
  v_mov_b32 v51, 0
  v_mov_b32 v52, 0
  v_mov_b32 v53, 0
  v_mov_b32 v54, 0
  v_mov_b32 v55, 0
  v_mov_b32 v56, 0
  v_mov_b32 v57, 0
  v_mov_b32 v58, 0
  v_mov_b32 v59, 0
  v_mov_b32 v60, 0
  v_mov_b32 v61, 0
  v_mov_b32 v62, 0
  v_mov_b32 v63, 0
  v_mov_b32 v88, 0
  v_mov_b32 v89, 0
  v_mov_b32 v90, 0
  v_mov_b32 v91, 0
  v_mov_b32 v92, 0
  v_mov_b32 v93, 0
  v_mov_b32 v94, 0
  v_mov_b32 v95, 0
  v_mov_b32 v64, 0
  v_mov_b32 v65, 0
  s_add_u32 s31, s31, 1
  ds_read_b128 v[96:99], v117 offset:0
  ds_read_b128 v[100:103], v117 offset:1024
  ds_read_b128 v[104:107], v117 offset:14336
  ds_read_b128 v[108:111], v117 offset:15360
  v_smfmac_f32_16x16x64_bf16 v[36:39], v[8:11], a[0:7], v3
  v_smfmac_f32_16x16x64_bf16 v[40:43], v[8:11], a[56:63], v3
  v_smfmac_f32_16x16x64_bf16 v[44:47], v[8:11], a[112:119], v3
  v_smfmac_f32_16x16x64_bf16 v[48:51], v[8:11], a[168:175], v3
  v_smfmac_f32_16x16x64_bf16 v[52:55], v[8:11], a[224:231], v3
  v_smfmac_f32_16x16x64_bf16 v[56:59], v[8:11], v[144:151], v3
  v_smfmac_f32_16x16x64_bf16 v[60:63], v[8:11], v[200:207], v3
  v_smfmac_f32_16x16x64_bf16 v[36:39], v[12:15], a[8:15], v3
  v_smfmac_f32_16x16x64_bf16 v[40:43], v[12:15], a[64:71], v3
  v_smfmac_f32_16x16x64_bf16 v[44:47], v[12:15], a[120:127], v3
  v_smfmac_f32_16x16x64_bf16 v[48:51], v[12:15], a[176:183], v3
  v_smfmac_f32_16x16x64_bf16 v[52:55], v[12:15], a[232:239], v3
  v_smfmac_f32_16x16x64_bf16 v[56:59], v[12:15], v[152:159], v3
  v_smfmac_f32_16x16x64_bf16 v[60:63], v[12:15], v[208:215], v3
  v_smfmac_f32_16x16x64_bf16 v[36:39], v[16:19], a[16:23], v3
  v_smfmac_f32_16x16x64_bf16 v[40:43], v[16:19], a[72:79], v3
  v_smfmac_f32_16x16x64_bf16 v[44:47], v[16:19], a[128:135], v3
  v_smfmac_f32_16x16x64_bf16 v[48:51], v[16:19], a[184:191], v3
  v_smfmac_f32_16x16x64_bf16 v[52:55], v[16:19], a[240:247], v3
  v_smfmac_f32_16x16x64_bf16 v[56:59], v[16:19], v[160:167], v3
  v_smfmac_f32_16x16x64_bf16 v[60:63], v[16:19], v[216:223], v3
  v_smfmac_f32_16x16x64_bf16 v[36:39], v[20:23], a[24:31], v3
  v_smfmac_f32_16x16x64_bf16 v[40:43], v[20:23], a[80:87], v3
  v_smfmac_f32_16x16x64_bf16 v[44:47], v[20:23], a[136:143], v3
  v_smfmac_f32_16x16x64_bf16 v[48:51], v[20:23], a[192:199], v3
  v_smfmac_f32_16x16x64_bf16 v[52:55], v[20:23], a[248:255], v3
  v_smfmac_f32_16x16x64_bf16 v[56:59], v[20:23], v[168:175], v3
  v_smfmac_f32_16x16x64_bf16 v[60:63], v[20:23], v[224:231], v3
  s_xor_b32 s58, s25, 28672
  s_add_u32 s59, s24, 28672
  s_add_u32 m0, s58, 21504
  s_branch cB_sc3_ph2
.p2align 6

cB_va0_loop:
  s_add_u32 s23, s20, 4096
  s_add_u32 s21, s20, 20480
  s_mov_b32 s30, 0
  s_cmp_lg_u32 s19, s38
  s_cbranch_scc1 cB_va0_vok
  s_branch cB_va0_voc
cB_va0_vow:
  s_sub_u32 s22, s39, s35
  v_lshlrev_b32 v63, 7, v2
  v_min_u32 v63, s22, v63
  buffer_load_dword v63, v63, s[8:11], s35 offen sc1
  s_waitcnt vmcnt(0)
cB_va0_voc:
  v_readfirstlane_b32 s22, v63
  s_cmp_eq_u32 s22, 56
  s_cbranch_scc1 cB_va0_vod
  s_sleep 1
  s_add_u32 s30, s30, 1
  s_cmp_lt_u32 s30, 400000
  s_cbranch_scc1 cB_va0_vow
  s_branch cB_abort
cB_va0_vod:
  s_add_u32 s35, s35, 2048
  s_add_u32 s38, s19, 8
  s_and_b32 s38, s38, -8
  s_cmp_eq_u32 s19, 0
  s_cselect_b32 s38, 4, s38
  v_cmp_ne_u32 vcc, 56, v63
  s_nop 3
  s_cmp_eq_u64 vcc, 0
  s_cselect_b32 s38, 99, s38
cB_va0_vok:
  s_cmp_eq_u32 s19, 63
  s_cbranch_scc1 cB_done
  s_barrier
  s_add_u32 s22, s25, 0
  buffer_load_dwordx4 v[80:83], v6, s[8:11], s22 offen offset:0 sc1
  buffer_load_dwordx4 v[84:87], v6, s[8:11], s22 offen offset:1792 sc1
  s_add_u32 s22, s25, 3584
  buffer_load_dwordx4 v[88:91], v6, s[8:11], s22 offen offset:0 sc1
  buffer_load_dwordx4 v[92:95], v6, s[8:11], s22 offen offset:1792 sc1
  s_add_u32 s22, s25, 7168
  buffer_load_dwordx4 v[96:99], v6, s[8:11], s22 offen offset:0 sc1
  buffer_load_dwordx4 v[100:103], v6, s[8:11], s22 offen offset:1792 sc1
  s_add_u32 s22, s25, 10752
  buffer_load_dwordx4 v[104:107], v6, s[8:11], s22 offen offset:0 sc1
  buffer_load_dwordx4 v[108:111], v6, s[8:11], s22 offen offset:1792 sc1
  s_add_u32 s22, s25, 14336
  buffer_load_dwordx4 v[112:115], v6, s[8:11], s22 offen offset:0 sc1
  buffer_load_dwordx4 v[116:119], v6, s[8:11], s22 offen offset:1792 sc1
  s_add_u32 s22, s25, 17920
  buffer_load_dwordx4 v[120:123], v6, s[8:11], s22 offen offset:0 sc1
  buffer_load_dwordx4 v[124:127], v6, s[8:11], s22 offen offset:1792 sc1
  s_add_u32 s22, s19, 1
  s_cmp_lg_u32 s22, s38
  s_cbranch_scc1 cB_va0_nk
  s_sub_u32 s22, s39, s35
  v_lshlrev_b32 v63, 7, v2
  v_min_u32 v63, s22, v63
  buffer_load_dword v63, v63, s[8:11], s35 offen sc1
cB_va0_nk:
  s_barrier
  ds_read_b128 v[8:11], v0 offset:8192
  ds_read_b128 v[12:15], v0 offset:9216
  ds_read_b128 v[16:19], v0 offset:10240
  ds_read_b128 v[20:23], v0 offset:11264
  ds_read_b128 v[24:27], v0 offset:12288
  ds_read_b128 v[28:31], v0 offset:13312
  ds_read_b128 v[32:35], v0 offset:14336
  s_waitcnt lgkmcnt(0)
  v_smfmac_f32_16x16x64_bf16 v[36:39], v[8:11], a[0:7], v3
  s_add_u32 s22, s25, 21504
  buffer_load_dwordx4 v[128:131], v6, s[8:11], s22 offen offset:0 sc1
  v_smfmac_f32_16x16x64_bf16 v[36:39], v[12:15], a[8:15], v3
  v_smfmac_f32_16x16x64_bf16 v[36:39], v[16:19], a[16:23], v3
  s_add_u32 s22, s25, 21504
  buffer_load_dwordx4 v[132:135], v6, s[8:11], s22 offen offset:1792 sc1
  v_smfmac_f32_16x16x64_bf16 v[36:39], v[20:23], a[24:31], v3
  v_smfmac_f32_16x16x64_bf16 v[36:39], v[24:27], a[32:39], v3
  s_add_u32 s22, s25, 25088
  buffer_load_dwordx4 v[136:139], v6, s[8:11], s22 offen offset:0 sc1
  v_smfmac_f32_16x16x64_bf16 v[36:39], v[28:31], a[40:47], v3
  v_smfmac_f32_16x16x64_bf16 v[36:39], v[32:35], a[48:55], v3
  s_add_u32 s22, s25, 25088
  buffer_load_dwordx4 v[140:143], v6, s[8:11], s22 offen offset:1792 sc1
  v_smfmac_f32_16x16x64_bf16 v[40:43], v[8:11], a[56:63], v3
  v_smfmac_f32_16x16x64_bf16 v[40:43], v[12:15], a[64:71], v3
  v_smfmac_f32_16x16x64_bf16 v[40:43], v[16:19], a[72:79], v3
  v_add_f32 v36, v36, v37
  v_smfmac_f32_16x16x64_bf16 v[40:43], v[20:23], a[80:87], v3
  v_add_f32 v38, v38, v39
  v_smfmac_f32_16x16x64_bf16 v[40:43], v[24:27], a[88:95], v3
  v_cvt_pk_bf16_f32 v36, v36, v38
  v_smfmac_f32_16x16x64_bf16 v[40:43], v[28:31], a[96:103], v3
  ds_write_b32 v60, v36
  v_smfmac_f32_16x16x64_bf16 v[40:43], v[32:35], a[104:111], v3
  v_smfmac_f32_16x16x64_bf16 v[44:47], v[8:11], a[112:119], v3
  v_smfmac_f32_16x16x64_bf16 v[44:47], v[12:15], a[120:127], v3
  v_smfmac_f32_16x16x64_bf16 v[44:47], v[16:19], a[128:135], v3
  v_add_f32 v40, v40, v41
  v_smfmac_f32_16x16x64_bf16 v[44:47], v[20:23], a[136:143], v3
  v_add_f32 v42, v42, v43
  v_smfmac_f32_16x16x64_bf16 v[44:47], v[24:27], a[144:151], v3
  v_cvt_pk_bf16_f32 v40, v40, v42
  v_smfmac_f32_16x16x64_bf16 v[44:47], v[28:31], a[152:159], v3
  ds_write_b32 v61, v40
  v_smfmac_f32_16x16x64_bf16 v[44:47], v[32:35], a[160:167], v3
  v_smfmac_f32_16x16x64_bf16 v[48:51], v[8:11], a[168:175], v3
  v_smfmac_f32_16x16x64_bf16 v[48:51], v[12:15], a[176:183], v3
  v_smfmac_f32_16x16x64_bf16 v[48:51], v[16:19], a[184:191], v3
  v_add_f32 v44, v44, v45
  v_smfmac_f32_16x16x64_bf16 v[48:51], v[20:23], a[192:199], v3
  v_add_f32 v46, v46, v47
  v_smfmac_f32_16x16x64_bf16 v[48:51], v[24:27], a[200:207], v3
  v_cvt_pk_bf16_f32 v44, v44, v46
  v_smfmac_f32_16x16x64_bf16 v[48:51], v[28:31], a[208:215], v3
  ds_write_b32 v62, v44
  v_smfmac_f32_16x16x64_bf16 v[48:51], v[32:35], a[216:223], v3
  v_smfmac_f32_16x16x64_bf16 v[52:55], v[8:11], a[224:231], v3
  v_smfmac_f32_16x16x64_bf16 v[52:55], v[12:15], a[232:239], v3
  v_smfmac_f32_16x16x64_bf16 v[52:55], v[16:19], a[240:247], v3
  v_add_f32 v48, v48, v49
  v_smfmac_f32_16x16x64_bf16 v[52:55], v[20:23], a[248:255], v3
  v_add_f32 v50, v50, v51
  v_smfmac_f32_16x16x64_bf16 v[52:55], v[24:27], v[176:183], v3
  v_cvt_pk_bf16_f32 v48, v48, v50
  v_smfmac_f32_16x16x64_bf16 v[52:55], v[28:31], v[184:191], v3
  ds_write_b32 v170, v48
  v_smfmac_f32_16x16x64_bf16 v[52:55], v[32:35], v[192:199], v3
  v_smfmac_f32_16x16x64_bf16 v[56:59], v[8:11], v[200:207], v3
  v_smfmac_f32_16x16x64_bf16 v[56:59], v[12:15], v[208:215], v3
  v_smfmac_f32_16x16x64_bf16 v[56:59], v[16:19], v[216:223], v3
  v_add_f32 v52, v52, v53
  v_smfmac_f32_16x16x64_bf16 v[56:59], v[20:23], v[224:231], v3
  v_add_f32 v54, v54, v55
  v_smfmac_f32_16x16x64_bf16 v[56:59], v[24:27], v[232:239], v3
  v_cvt_pk_bf16_f32 v52, v52, v54
  v_smfmac_f32_16x16x64_bf16 v[56:59], v[28:31], v[240:247], v3
  ds_write_b32 v171, v52
  v_smfmac_f32_16x16x64_bf16 v[56:59], v[32:35], v[248:255], v3
  s_nop 7
  v_add_f32 v56, v56, v57
  v_add_f32 v58, v58, v59
  v_cvt_pk_bf16_f32 v56, v56, v58
  ds_write_b32 v172, v56
  buffer_load_dword v164, v4, s[8:11], s20 offen sc1
  s_waitcnt lgkmcnt(0)
  v_mov_b32 v36, 0
  v_mov_b32 v37, 0
  v_mov_b32 v38, 0
  v_mov_b32 v39, 0
  v_mov_b32 v40, 0
  v_mov_b32 v41, 0
  v_mov_b32 v42, 0
  v_mov_b32 v43, 0
  buffer_load_dword v165, v4, s[8:11], s20 offen sc1
  v_mov_b32 v44, 0
  v_mov_b32 v45, 0
  v_mov_b32 v46, 0
  v_mov_b32 v47, 0
  v_mov_b32 v48, 0
  v_mov_b32 v49, 0
  v_mov_b32 v50, 0
  v_mov_b32 v51, 0
  buffer_load_dword v166, v4, s[8:11], s20 offen sc1
  v_mov_b32 v52, 0
  v_mov_b32 v53, 0
  v_mov_b32 v54, 0
  v_mov_b32 v55, 0
  v_mov_b32 v56, 0
  v_mov_b32 v57, 0
  v_mov_b32 v58, 0
  v_mov_b32 v59, 0
  buffer_load_dword v167, v4, s[8:11], s20 offen sc1
  s_cmp_eq_u32 s19, 63
  s_cbranch_scc1 cB_va0_last
  s_add_u32 s22, s20, 9216
  s_add_u32 s34, s20, 13312
  s_add_u32 s36, s20, 7168
  s_mov_b32 s37, 0
  v_mov_b32 v156, 0
  v_mov_b32 v157, 0
  v_mov_b32 v158, 0
  v_mov_b32 v159, 0
  buffer_load_dword v168, v4, s[8:11], s20 offen sc1
cB_va0_fw_l:
  s_waitcnt vmcnt(4)
  v_cmp_eq_u32 vcc, -1, v164
  s_cbranch_vccz cB_va0_fw_d
  buffer_load_dword v164, v4, s[8:11], s20 offen sc1
  s_waitcnt vmcnt(4)
  v_cmp_eq_u32 vcc, -1, v165
  s_cbranch_vccz cB_va0_fw_d
  buffer_load_dword v165, v4, s[8:11], s20 offen sc1
  s_waitcnt vmcnt(4)
  v_cmp_eq_u32 vcc, -1, v166
  s_cbranch_vccz cB_va0_fw_d
  buffer_load_dword v166, v4, s[8:11], s20 offen sc1
  s_waitcnt vmcnt(4)
  v_cmp_eq_u32 vcc, -1, v167
  s_cbranch_vccz cB_va0_fw_d
  buffer_load_dword v167, v4, s[8:11], s20 offen sc1
  s_waitcnt vmcnt(4)
  v_cmp_eq_u32 vcc, -1, v168
  s_cbranch_vccz cB_va0_fw_d
  buffer_load_dword v168, v4, s[8:11], s20 offen sc1
  s_add_u32 s30, s30, 1
  s_cmp_lt_u32 s30, 400000
  s_cbranch_scc1 cB_va0_fw_l
  s_branch cB_abort
cB_va0_fw_d:
  s_waitcnt lgkmcnt(0)
  buffer_load_dwordx4 v[8:11], v5, s[8:11], s22 offen offset:0 sc1
  buffer_load_dwordx4 v[12:15], v5, s[8:11], s22 offen offset:1024 sc1
  buffer_load_dwordx4 v[16:19], v5, s[8:11], s22 offen offset:2048 sc1
  buffer_load_dwordx4 v[20:23], v5, s[8:11], s22 offen offset:3072 sc1
  buffer_load_dwordx4 v[24:27], v5, s[8:11], s34 offen offset:0 sc1
  buffer_load_dwordx4 v[28:31], v5, s[8:11], s34 offen offset:1024 sc1
  buffer_load_dwordx4 v[32:35], v5, s[8:11], s34 offen offset:2048 sc1
  buffer_load_dwordx4 v[144:147], v5, s[8:11], s34 offen offset:3072 sc1
  buffer_load_dwordx4 v[148:151], v2, s[8:11], s36 offen offset:0 sc1
  buffer_load_dwordx4 v[152:155], v2, s[8:11], s36 offen offset:1024 sc1
  s_barrier
  ds_read_b128 v[64:67], v2 offset:0
  ds_read_b128 v[68:71], v2 offset:1024
  ds_read_b128 v[72:75], v2 offset:2048
  ds_read_b128 v[76:79], v2 offset:3072
  s_waitcnt vmcnt(9)
  v_smfmac_f32_16x16x64_bf16 v[156:159], v[8:11], v[80:87], v3
  s_waitcnt vmcnt(8)
  v_smfmac_f32_16x16x64_bf16 v[156:159], v[12:15], v[88:95], v3
  s_waitcnt vmcnt(7)
  v_smfmac_f32_16x16x64_bf16 v[156:159], v[16:19], v[96:103], v3
  s_waitcnt vmcnt(6)
  v_smfmac_f32_16x16x64_bf16 v[156:159], v[20:23], v[104:111], v3
  s_waitcnt vmcnt(5)
  v_smfmac_f32_16x16x64_bf16 v[156:159], v[24:27], v[112:119], v3
  s_waitcnt vmcnt(4)
  v_smfmac_f32_16x16x64_bf16 v[156:159], v[28:31], v[120:127], v3
  s_waitcnt vmcnt(3)
  v_smfmac_f32_16x16x64_bf16 v[156:159], v[32:35], v[128:135], v3
  s_waitcnt vmcnt(2)
  v_smfmac_f32_16x16x64_bf16 v[156:159], v[144:147], v[136:143], v3
  s_waitcnt vmcnt(1) lgkmcnt(0)
  v_smfmac_f32_16x16x64_bf16 v[156:159], v[148:151], v[64:71], v3
  s_waitcnt vmcnt(0)
  v_smfmac_f32_16x16x64_bf16 v[156:159], v[152:155], v[72:79], v3
cB_va0_ep:
  s_nop 7
  v_add_f32 v160, v156, v157
  v_add_f32 v161, v158, v159
  v_cmp_u_f32 vcc, v160, v161
  v_mov_b32_dpp v162, v160 row_ror:8 row_mask:0xf bank_mask:0xf
  v_mov_b32_dpp v160, v161 row_ror:8 row_mask:0xf bank_mask:0xc
  s_cbranch_vccnz cB_va0_rp
  v_mov_b32_dpp v161, v162 quad_perm:[0,1,2,3] row_mask:0xf bank_mask:0x3
  v_cvt_pk_bf16_f32 v160, v160, v161
cB_va0_pc:
  buffer_store_dword v160, v1, s[8:11], s21 offen sc1
  s_cmp_lg_u32 s19, 62
  s_cbranch_scc1 cB_va0_nl
  s_mov_b32 s22, 88531968
  buffer_store_dword v160, v1, s[8:11], s22 offen sc1
  s_mov_b64 exec, -1
  s_branch cB_done
cB_va0_nl:
  s_mov_b64 exec, -1
  s_add_u32 s25, s25, 28672
  s_add_u32 s19, s19, 1
  s_mov_b32 s20, s21
  s_branch cB_va0_loop
cB_va0_last:
  s_waitcnt lgkmcnt(0)
  s_barrier
  s_branch cB_done
cB_va0_rp:
  s_cmp_eq_u32 s37, 0
  s_cbranch_scc1 cB_va0_rv
  v_mov_b32_dpp v161, v162 quad_perm:[0,1,2,3] row_mask:0xf bank_mask:0x3
  v_cvt_pk_bf16_f32 v160, v160, v161
  v_min_u32 v160, -2, v160
  s_branch cB_va0_pc
cB_va0_rv:
  buffer_load_dwordx4 v[8:11], v5, s[8:11], s22 offen offset:0 sc1
  buffer_load_dwordx4 v[12:15], v5, s[8:11], s22 offen offset:1024 sc1
  buffer_load_dwordx4 v[16:19], v5, s[8:11], s22 offen offset:2048 sc1
  buffer_load_dwordx4 v[20:23], v5, s[8:11], s22 offen offset:3072 sc1
  buffer_load_dwordx4 v[24:27], v5, s[8:11], s34 offen offset:0 sc1
  buffer_load_dwordx4 v[28:31], v5, s[8:11], s34 offen offset:1024 sc1
  buffer_load_dwordx4 v[32:35], v5, s[8:11], s34 offen offset:2048 sc1
  buffer_load_dwordx4 v[144:147], v5, s[8:11], s34 offen offset:3072 sc1
  buffer_load_dwordx4 v[148:151], v2, s[8:11], s36 offen offset:0 sc1
  buffer_load_dwordx4 v[152:155], v2, s[8:11], s36 offen offset:1024 sc1
  s_waitcnt vmcnt(0)
  v_max3_u32 v175, v8, v9, v10
  v_max3_u32 v175, v175, v11, v12
  v_max3_u32 v175, v175, v13, v14
  v_max3_u32 v175, v175, v15, v16
  v_max3_u32 v175, v175, v17, v18
  v_max3_u32 v175, v175, v19, v20
  v_max3_u32 v175, v175, v21, v22
  v_max3_u32 v175, v175, v23, v24
  v_max3_u32 v175, v175, v25, v26
  v_max3_u32 v175, v175, v27, v28
  v_max3_u32 v175, v175, v29, v30
  v_max3_u32 v175, v175, v31, v32
  v_max3_u32 v175, v175, v33, v34
  v_max3_u32 v175, v175, v35, v144
  v_max3_u32 v175, v175, v145, v146
  v_max3_u32 v175, v175, v147, v148
  v_max3_u32 v175, v175, v149, v150
  v_max3_u32 v175, v175, v151, v152
  v_max3_u32 v175, v175, v153, v154
  v_max_u32 v175, v175, v155
  v_cmp_eq_u32 vcc, -1, v175
  s_cbranch_vccz cB_va0_rk
  s_add_u32 s30, s30, 1
  s_cmp_lt_u32 s30, 400000
  s_cbranch_scc1 cB_va0_rv
  s_branch cB_abort
cB_va0_rk:
  s_mov_b32 s37, 1
  s_add_u32 s31, s31, 0x10000
  v_mov_b32 v156, 0
  v_mov_b32 v157, 0
  v_mov_b32 v158, 0
  v_mov_b32 v159, 0
  s_nop 1
  v_smfmac_f32_16x16x64_bf16 v[156:159], v[8:11], v[80:87], v3
  v_smfmac_f32_16x16x64_bf16 v[156:159], v[12:15], v[88:95], v3
  v_smfmac_f32_16x16x64_bf16 v[156:159], v[16:19], v[96:103], v3
  v_smfmac_f32_16x16x64_bf16 v[156:159], v[20:23], v[104:111], v3
  v_smfmac_f32_16x16x64_bf16 v[156:159], v[24:27], v[112:119], v3
  v_smfmac_f32_16x16x64_bf16 v[156:159], v[28:31], v[120:127], v3
  v_smfmac_f32_16x16x64_bf16 v[156:159], v[32:35], v[128:135], v3
  v_smfmac_f32_16x16x64_bf16 v[156:159], v[144:147], v[136:143], v3
  v_smfmac_f32_16x16x64_bf16 v[156:159], v[148:151], v[64:71], v3
  v_smfmac_f32_16x16x64_bf16 v[156:159], v[152:155], v[72:79], v3
  s_nop 7
  s_branch cB_va0_ep
.p2align 6

cB_va1_loop:
  s_add_u32 s23, s20, 4096
  s_add_u32 s21, s20, 20480
  s_mov_b32 s30, 0
  s_cmp_lg_u32 s19, s38
  s_cbranch_scc1 cB_va1_vok
  s_branch cB_va1_voc
cB_va1_vow:
  s_sub_u32 s22, s39, s35
  v_lshlrev_b32 v63, 7, v2
  v_min_u32 v63, s22, v63
  buffer_load_dword v63, v63, s[8:11], s35 offen sc1
  s_waitcnt vmcnt(0)
cB_va1_voc:
  v_readfirstlane_b32 s22, v63
  s_cmp_eq_u32 s22, 56
  s_cbranch_scc1 cB_va1_vod
  s_sleep 1
  s_add_u32 s30, s30, 1
  s_cmp_lt_u32 s30, 400000
  s_cbranch_scc1 cB_va1_vow
  s_branch cB_abort
cB_va1_vod:
  s_add_u32 s35, s35, 2048
  s_add_u32 s38, s19, 8
  s_and_b32 s38, s38, -8
  s_cmp_eq_u32 s19, 0
  s_cselect_b32 s38, 4, s38
  v_cmp_ne_u32 vcc, 56, v63
  s_nop 3
  s_cmp_eq_u64 vcc, 0
  s_cselect_b32 s38, 99, s38
cB_va1_vok:
  s_cmp_eq_u32 s19, 63
  s_cbranch_scc1 cB_done
  s_barrier
  s_add_u32 s22, s25, 0
  buffer_load_dwordx4 v[80:83], v6, s[8:11], s22 offen offset:0 sc1
  buffer_load_dwordx4 v[84:87], v6, s[8:11], s22 offen offset:1792 sc1
  s_add_u32 s22, s25, 3584
  buffer_load_dwordx4 v[88:91], v6, s[8:11], s22 offen offset:0 sc1
  buffer_load_dwordx4 v[92:95], v6, s[8:11], s22 offen offset:1792 sc1
  s_add_u32 s22, s25, 7168
  buffer_load_dwordx4 v[96:99], v6, s[8:11], s22 offen offset:0 sc1
  buffer_load_dwordx4 v[100:103], v6, s[8:11], s22 offen offset:1792 sc1
  s_add_u32 s22, s25, 10752
  buffer_load_dwordx4 v[104:107], v6, s[8:11], s22 offen offset:0 sc1
  buffer_load_dwordx4 v[108:111], v6, s[8:11], s22 offen offset:1792 sc1
  s_add_u32 s22, s25, 14336
  buffer_load_dwordx4 v[112:115], v6, s[8:11], s22 offen offset:0 sc1
  buffer_load_dwordx4 v[116:119], v6, s[8:11], s22 offen offset:1792 sc1
  s_add_u32 s22, s25, 17920
  buffer_load_dwordx4 v[120:123], v6, s[8:11], s22 offen offset:0 sc1
  buffer_load_dwordx4 v[124:127], v6, s[8:11], s22 offen offset:1792 sc1
  s_add_u32 s22, s19, 1
  s_cmp_lg_u32 s22, s38
  s_cbranch_scc1 cB_va1_nk
  s_sub_u32 s22, s39, s35
  v_lshlrev_b32 v63, 7, v2
  v_min_u32 v63, s22, v63
  buffer_load_dword v63, v63, s[8:11], s35 offen sc1
cB_va1_nk:
  s_barrier
  ds_read_b128 v[8:11], v0 offset:8192
  ds_read_b128 v[12:15], v0 offset:9216
  ds_read_b128 v[16:19], v0 offset:10240
  ds_read_b128 v[20:23], v0 offset:11264
  ds_read_b128 v[24:27], v0 offset:12288
  ds_read_b128 v[28:31], v0 offset:13312
  ds_read_b128 v[32:35], v0 offset:14336
  s_waitcnt lgkmcnt(0)
  v_smfmac_f32_16x16x64_bf16 v[36:39], v[8:11], a[0:7], v3
  s_add_u32 s22, s25, 21504
  buffer_load_dwordx4 v[128:131], v6, s[8:11], s22 offen offset:0 sc1
  v_smfmac_f32_16x16x64_bf16 v[36:39], v[12:15], a[8:15], v3
  v_smfmac_f32_16x16x64_bf16 v[36:39], v[16:19], a[16:23], v3
  s_add_u32 s22, s25, 21504
  buffer_load_dwordx4 v[132:135], v6, s[8:11], s22 offen offset:1792 sc1
  v_smfmac_f32_16x16x64_bf16 v[36:39], v[20:23], a[24:31], v3
  v_smfmac_f32_16x16x64_bf16 v[36:39], v[24:27], a[32:39], v3
  s_add_u32 s22, s25, 25088
  buffer_load_dwordx4 v[136:139], v6, s[8:11], s22 offen offset:0 sc1
  v_smfmac_f32_16x16x64_bf16 v[36:39], v[28:31], a[40:47], v3
  v_smfmac_f32_16x16x64_bf16 v[36:39], v[32:35], a[48:55], v3
  s_add_u32 s22, s25, 25088
  buffer_load_dwordx4 v[140:143], v6, s[8:11], s22 offen offset:1792 sc1
  v_smfmac_f32_16x16x64_bf16 v[40:43], v[8:11], a[56:63], v3
  v_smfmac_f32_16x16x64_bf16 v[40:43], v[12:15], a[64:71], v3
  v_smfmac_f32_16x16x64_bf16 v[40:43], v[16:19], a[72:79], v3
  v_add_f32 v36, v36, v37
  v_smfmac_f32_16x16x64_bf16 v[40:43], v[20:23], a[80:87], v3
  v_add_f32 v38, v38, v39
  v_smfmac_f32_16x16x64_bf16 v[40:43], v[24:27], a[88:95], v3
  v_cvt_pk_bf16_f32 v36, v36, v38
  v_smfmac_f32_16x16x64_bf16 v[40:43], v[28:31], a[96:103], v3
  ds_write_b32 v60, v36
  v_smfmac_f32_16x16x64_bf16 v[40:43], v[32:35], a[104:111], v3
  v_smfmac_f32_16x16x64_bf16 v[44:47], v[8:11], a[112:119], v3
  v_smfmac_f32_16x16x64_bf16 v[44:47], v[12:15], a[120:127], v3
  v_smfmac_f32_16x16x64_bf16 v[44:47], v[16:19], a[128:135], v3
  v_add_f32 v40, v40, v41
  v_smfmac_f32_16x16x64_bf16 v[44:47], v[20:23], a[136:143], v3
  v_add_f32 v42, v42, v43
  v_smfmac_f32_16x16x64_bf16 v[44:47], v[24:27], a[144:151], v3
  v_cvt_pk_bf16_f32 v40, v40, v42
  v_smfmac_f32_16x16x64_bf16 v[44:47], v[28:31], a[152:159], v3
  ds_write_b32 v61, v40
  v_smfmac_f32_16x16x64_bf16 v[44:47], v[32:35], a[160:167], v3
  v_smfmac_f32_16x16x64_bf16 v[48:51], v[8:11], a[168:175], v3
  v_smfmac_f32_16x16x64_bf16 v[48:51], v[12:15], a[176:183], v3
  v_smfmac_f32_16x16x64_bf16 v[48:51], v[16:19], a[184:191], v3
  v_add_f32 v44, v44, v45
  v_smfmac_f32_16x16x64_bf16 v[48:51], v[20:23], a[192:199], v3
  v_add_f32 v46, v46, v47
  v_smfmac_f32_16x16x64_bf16 v[48:51], v[24:27], a[200:207], v3
  v_cvt_pk_bf16_f32 v44, v44, v46
  v_smfmac_f32_16x16x64_bf16 v[48:51], v[28:31], a[208:215], v3
  ds_write_b32 v62, v44
  v_smfmac_f32_16x16x64_bf16 v[48:51], v[32:35], a[216:223], v3
  v_smfmac_f32_16x16x64_bf16 v[52:55], v[8:11], a[224:231], v3
  v_smfmac_f32_16x16x64_bf16 v[52:55], v[12:15], a[232:239], v3
  v_smfmac_f32_16x16x64_bf16 v[52:55], v[16:19], a[240:247], v3
  v_add_f32 v48, v48, v49
  v_smfmac_f32_16x16x64_bf16 v[52:55], v[20:23], a[248:255], v3
  v_add_f32 v50, v50, v51
  v_smfmac_f32_16x16x64_bf16 v[52:55], v[24:27], v[176:183], v3
  v_cvt_pk_bf16_f32 v48, v48, v50
  v_smfmac_f32_16x16x64_bf16 v[52:55], v[28:31], v[184:191], v3
  ds_write_b32 v170, v48
  v_smfmac_f32_16x16x64_bf16 v[52:55], v[32:35], v[192:199], v3
  v_smfmac_f32_16x16x64_bf16 v[56:59], v[8:11], v[200:207], v3
  v_smfmac_f32_16x16x64_bf16 v[56:59], v[12:15], v[208:215], v3
  v_smfmac_f32_16x16x64_bf16 v[56:59], v[16:19], v[216:223], v3
  v_add_f32 v52, v52, v53
  v_smfmac_f32_16x16x64_bf16 v[56:59], v[20:23], v[224:231], v3
  v_add_f32 v54, v54, v55
  v_smfmac_f32_16x16x64_bf16 v[56:59], v[24:27], v[232:239], v3
  v_cvt_pk_bf16_f32 v52, v52, v54
  v_smfmac_f32_16x16x64_bf16 v[56:59], v[28:31], v[240:247], v3
  ds_write_b32 v171, v52
  v_smfmac_f32_16x16x64_bf16 v[56:59], v[32:35], v[248:255], v3
  s_nop 7
  v_add_f32 v56, v56, v57
  v_add_f32 v58, v58, v59
  v_cvt_pk_bf16_f32 v56, v56, v58
  ds_write_b32 v172, v56
  s_waitcnt lgkmcnt(0)
  v_mov_b32 v36, 0
  v_mov_b32 v37, 0
  v_mov_b32 v38, 0
  v_mov_b32 v39, 0
  v_mov_b32 v40, 0
  v_mov_b32 v41, 0
  v_mov_b32 v42, 0
  v_mov_b32 v43, 0
  v_mov_b32 v44, 0
  v_mov_b32 v45, 0
  v_mov_b32 v46, 0
  v_mov_b32 v47, 0
  v_mov_b32 v48, 0
  v_mov_b32 v49, 0
  v_mov_b32 v50, 0
  v_mov_b32 v51, 0
  v_mov_b32 v52, 0
  v_mov_b32 v53, 0
  v_mov_b32 v54, 0
  v_mov_b32 v55, 0
  v_mov_b32 v56, 0
  v_mov_b32 v57, 0
  v_mov_b32 v58, 0
  v_mov_b32 v59, 0
  s_cmp_eq_u32 s19, 63
  s_cbranch_scc1 cB_va1_last
  s_add_u32 s22, s20, 9216
  s_add_u32 s34, s20, 13312
  s_add_u32 s36, s20, 7168
  s_mov_b32 s37, 0
  v_mov_b32 v156, 0
  v_mov_b32 v157, 0
  v_mov_b32 v158, 0
  v_mov_b32 v159, 0
  s_barrier
  s_waitcnt lgkmcnt(0)
  buffer_load_dwordx4 v[8:11], v5, s[8:11], s22 offen offset:0 sc1
  buffer_load_dwordx4 v[12:15], v5, s[8:11], s22 offen offset:1024 sc1
  buffer_load_dwordx4 v[16:19], v5, s[8:11], s22 offen offset:2048 sc1
  buffer_load_dwordx4 v[20:23], v5, s[8:11], s22 offen offset:3072 sc1
  buffer_load_dwordx4 v[24:27], v5, s[8:11], s34 offen offset:0 sc1
  buffer_load_dwordx4 v[28:31], v5, s[8:11], s34 offen offset:1024 sc1
  buffer_load_dwordx4 v[32:35], v5, s[8:11], s34 offen offset:2048 sc1
  buffer_load_dwordx4 v[144:147], v5, s[8:11], s34 offen offset:3072 sc1
  s_sub_u32 s23, s21, 4
  s_mov_b64 exec, 65535
  buffer_store_dword v2, v7, s[8:11], s23 offen sc1
  s_mov_b64 exec, -1
  buffer_load_dwordx4 v[148:151], v2, s[8:11], s36 offen offset:0 sc1
  buffer_load_dwordx4 v[152:155], v2, s[8:11], s36 offen offset:1024 sc1
  ds_read_b128 v[64:67], v2 offset:4096
  ds_read_b128 v[68:71], v2 offset:5120
  ds_read_b128 v[72:75], v2 offset:6144
  ds_read_b128 v[76:79], v2 offset:7168
  s_waitcnt vmcnt(10)
  v_smfmac_f32_16x16x64_bf16 v[156:159], v[8:11], v[80:87], v3
  s_waitcnt vmcnt(9)
  v_smfmac_f32_16x16x64_bf16 v[156:159], v[12:15], v[88:95], v3
  s_waitcnt vmcnt(8)
  v_smfmac_f32_16x16x64_bf16 v[156:159], v[16:19], v[96:103], v3
  s_waitcnt vmcnt(7)
  v_smfmac_f32_16x16x64_bf16 v[156:159], v[20:23], v[104:111], v3
  s_waitcnt vmcnt(6)
  v_smfmac_f32_16x16x64_bf16 v[156:159], v[24:27], v[112:119], v3
  s_mov_b64 exec, 65535
  buffer_store_dword v2, v7, s[8:11], s21 offen sc1
  s_mov_b64 exec, -1
  s_waitcnt vmcnt(6)
  v_smfmac_f32_16x16x64_bf16 v[156:159], v[28:31], v[120:127], v3
  s_waitcnt vmcnt(5)
  v_smfmac_f32_16x16x64_bf16 v[156:159], v[32:35], v[128:135], v3
  s_waitcnt vmcnt(4)
  v_smfmac_f32_16x16x64_bf16 v[156:159], v[144:147], v[136:143], v3
  s_waitcnt vmcnt(2) lgkmcnt(0)
  v_smfmac_f32_16x16x64_bf16 v[156:159], v[148:151], v[64:71], v3
  s_waitcnt vmcnt(1)
  v_smfmac_f32_16x16x64_bf16 v[156:159], v[152:155], v[72:79], v3
cB_va1_ep:
  s_nop 7
  v_add_f32 v160, v156, v157
  v_add_f32 v161, v158, v159
  v_cmp_u_f32 vcc, v160, v161
  v_mov_b32_dpp v162, v160 row_ror:8 row_mask:0xf bank_mask:0xf
  v_mov_b32_dpp v160, v161 row_ror:8 row_mask:0xf bank_mask:0xc
  s_cbranch_vccnz cB_va1_rp
  v_mov_b32_dpp v161, v162 quad_perm:[0,1,2,3] row_mask:0xf bank_mask:0x3
  v_cvt_pk_bf16_f32 v160, v160, v161
cB_va1_pc:
  s_mov_b64 exec, s[26:27]
  buffer_store_dword v160, v1, s[8:11], s21 offen sc1
  s_cmp_lg_u32 s19, 62
  s_cbranch_scc1 cB_va1_nl
  s_mov_b32 s22, 88531968
  buffer_store_dword v160, v1, s[8:11], s22 offen sc1
  s_mov_b64 exec, -1
  s_branch cB_done
cB_va1_nl:
  s_mov_b64 exec, -1
  s_cmp_lg_u32 s19, 0
  s_cbranch_scc1 cB_va1_s0
  v_add_u32 v7, 512, v7
  v_lshl_add_u32 v7, v2, 3, v7
  s_mov_b64 exec, 65535
  buffer_store_dword v2, v7, s[8:11], s21 offen sc1
  buffer_store_dword v2, v7, s[8:11], s23 offen sc1
  s_mov_b64 exec, -1
cB_va1_s0:
  s_add_u32 s25, s25, 28672
  s_add_u32 s19, s19, 1
  s_mov_b32 s20, s21
  s_branch cB_va1_loop
cB_va1_last:
  s_waitcnt lgkmcnt(0)
  s_barrier
  s_branch cB_done
cB_va1_rp:
  s_cmp_eq_u32 s37, 0
  s_cbranch_scc1 cB_va1_rv
  v_mov_b32_dpp v161, v162 quad_perm:[0,1,2,3] row_mask:0xf bank_mask:0x3
  v_cvt_pk_bf16_f32 v160, v160, v161
  v_min_u32 v160, -2, v160
  s_branch cB_va1_pc
cB_va1_rv:
  buffer_load_dwordx4 v[8:11], v5, s[8:11], s22 offen offset:0 sc1
  buffer_load_dwordx4 v[12:15], v5, s[8:11], s22 offen offset:1024 sc1
  buffer_load_dwordx4 v[16:19], v5, s[8:11], s22 offen offset:2048 sc1
  buffer_load_dwordx4 v[20:23], v5, s[8:11], s22 offen offset:3072 sc1
  buffer_load_dwordx4 v[24:27], v5, s[8:11], s34 offen offset:0 sc1
  buffer_load_dwordx4 v[28:31], v5, s[8:11], s34 offen offset:1024 sc1
  buffer_load_dwordx4 v[32:35], v5, s[8:11], s34 offen offset:2048 sc1
  buffer_load_dwordx4 v[144:147], v5, s[8:11], s34 offen offset:3072 sc1
  buffer_load_dwordx4 v[148:151], v2, s[8:11], s36 offen offset:0 sc1
  buffer_load_dwordx4 v[152:155], v2, s[8:11], s36 offen offset:1024 sc1
  s_waitcnt vmcnt(0)
  v_max3_u32 v175, v8, v9, v10
  v_max3_u32 v175, v175, v11, v12
  v_max3_u32 v175, v175, v13, v14
  v_max3_u32 v175, v175, v15, v16
  v_max3_u32 v175, v175, v17, v18
  v_max3_u32 v175, v175, v19, v20
  v_max3_u32 v175, v175, v21, v22
  v_max3_u32 v175, v175, v23, v24
  v_max3_u32 v175, v175, v25, v26
  v_max3_u32 v175, v175, v27, v28
  v_max3_u32 v175, v175, v29, v30
  v_max3_u32 v175, v175, v31, v32
  v_max3_u32 v175, v175, v33, v34
  v_max3_u32 v175, v175, v35, v144
  v_max3_u32 v175, v175, v145, v146
  v_max3_u32 v175, v175, v147, v148
  v_max3_u32 v175, v175, v149, v150
  v_max3_u32 v175, v175, v151, v152
  v_max3_u32 v175, v175, v153, v154
  v_max_u32 v175, v175, v155
  v_cmp_eq_u32 vcc, -1, v175
  s_cbranch_vccz cB_va1_rk
  s_add_u32 s30, s30, 1
  s_cmp_lt_u32 s30, 400000
  s_cbranch_scc1 cB_va1_rv
  s_branch cB_abort
cB_va1_rk:
  s_mov_b32 s37, 1
  s_add_u32 s31, s31, 0x10000
  v_mov_b32 v156, 0
  v_mov_b32 v157, 0
  v_mov_b32 v158, 0
  v_mov_b32 v159, 0
  s_nop 1
  v_smfmac_f32_16x16x64_bf16 v[156:159], v[8:11], v[80:87], v3
  v_smfmac_f32_16x16x64_bf16 v[156:159], v[12:15], v[88:95], v3
  v_smfmac_f32_16x16x64_bf16 v[156:159], v[16:19], v[96:103], v3
  v_smfmac_f32_16x16x64_bf16 v[156:159], v[20:23], v[104:111], v3
  v_smfmac_f32_16x16x64_bf16 v[156:159], v[24:27], v[112:119], v3
  v_smfmac_f32_16x16x64_bf16 v[156:159], v[28:31], v[120:127], v3
  v_smfmac_f32_16x16x64_bf16 v[156:159], v[32:35], v[128:135], v3
  v_smfmac_f32_16x16x64_bf16 v[156:159], v[144:147], v[136:143], v3
  v_smfmac_f32_16x16x64_bf16 v[156:159], v[148:151], v[64:71], v3
  v_smfmac_f32_16x16x64_bf16 v[156:159], v[152:155], v[72:79], v3
  s_nop 7
  s_branch cB_va1_ep
.p2align 6

cB_va2_loop:
  s_add_u32 s23, s20, 4096
  s_add_u32 s21, s20, 20480
  v_mov_b32 v36, 0
  v_mov_b32 v37, 0
  v_mov_b32 v38, 0
  v_mov_b32 v39, 0
  v_mov_b32 v40, 0
  v_mov_b32 v41, 0
  v_mov_b32 v42, 0
  v_mov_b32 v43, 0
  v_mov_b32 v44, 0
  v_mov_b32 v45, 0
  v_mov_b32 v46, 0
  v_mov_b32 v47, 0
  v_mov_b32 v48, 0
  v_mov_b32 v49, 0
  v_mov_b32 v50, 0
  v_mov_b32 v51, 0
  v_mov_b32 v52, 0
  v_mov_b32 v53, 0
  v_mov_b32 v54, 0
  v_mov_b32 v55, 0
  v_mov_b32 v56, 0
  v_mov_b32 v57, 0
  v_mov_b32 v58, 0
  v_mov_b32 v59, 0
  v_mov_b32 v60, 0
  v_mov_b32 v61, 0
  v_mov_b32 v62, 0
  v_mov_b32 v63, 0
  v_mov_b32 v64, 0
  v_mov_b32 v65, 0
  v_mov_b32 v66, 0
  v_mov_b32 v67, 0
  s_mov_b32 s30, 0
  buffer_load_dword v76, v119, s[8:11], s20 offen sc1
  buffer_load_dword v77, v119, s[8:11], s20 offen sc1
  buffer_load_dword v78, v119, s[8:11], s20 offen sc1
cB_va2_fp_l:
  s_waitcnt vmcnt(2)
  v_cmp_eq_u32 vcc, -1, v76
  s_cbranch_vccz cB_va2_fp_d
  buffer_load_dword v76, v119, s[8:11], s20 offen sc1
  s_waitcnt vmcnt(2)
  v_cmp_eq_u32 vcc, -1, v77
  s_cbranch_vccz cB_va2_fp_d
  buffer_load_dword v77, v119, s[8:11], s20 offen sc1
  s_waitcnt vmcnt(2)
  v_cmp_eq_u32 vcc, -1, v78
  s_cbranch_vccz cB_va2_fp_d
  buffer_load_dword v78, v119, s[8:11], s20 offen sc1
  s_add_u32 s30, s30, 1
  s_cmp_lt_u32 s30, 400000
  s_cbranch_scc1 cB_va2_fp_l
  s_branch cB_abort
cB_va2_fp_d:
  s_nop 15
  s_nop 3
  buffer_load_dwordx4 v[8:11], v2, s[8:11], s20 offen offset:0 sc1
  buffer_load_dwordx4 v[12:15], v2, s[8:11], s20 offen offset:1024 sc1
  buffer_load_dwordx4 v[16:19], v2, s[8:11], s20 offen offset:2048 sc1
  buffer_load_dwordx4 v[20:23], v2, s[8:11], s20 offen offset:3072 sc1
  s_barrier
cB_va2_ld:
  s_waitcnt vmcnt(0)
  v_max3_u32 v84, v8, v9, v10
  v_max3_u32 v84, v84, v11, v12
  v_max3_u32 v84, v84, v13, v14
  v_max3_u32 v84, v84, v15, v16
  v_max3_u32 v84, v84, v17, v18
  v_max3_u32 v84, v84, v19, v20
  v_max3_u32 v84, v84, v21, v22
  v_max_u32 v84, v84, v23
  v_cmp_eq_u32 vcc, -1, v84
  ds_write_b128 v2, v[8:11] offset:8192
  ds_write_b128 v2, v[12:15] offset:9216
  ds_write_b128 v2, v[16:19] offset:10240
  ds_write_b128 v2, v[20:23] offset:11264
  s_cbranch_vccnz cB_va2_retry
  s_waitcnt lgkmcnt(0)
  s_barrier
  ds_read_b128 v[8:11], v5 offset:8192
  ds_read_b128 v[12:15], v5 offset:9216
  ds_read_b128 v[16:19], v5 offset:10240
  ds_read_b128 v[20:23], v5 offset:11264
  ds_read_b128 v[24:27], v5 offset:12288
  ds_read_b128 v[28:31], v5 offset:13312
  ds_read_b128 v[32:35], v5 offset:14336
  ds_read_b128 v[92:95], v0
  s_waitcnt lgkmcnt(0)
  s_mov_b64 exec, s[26:27]
  buffer_store_dwordx4 v[92:95], v2, s[8:11], s36 offen sc1
  s_mov_b64 exec, -1
  s_add_u32 s36, s36, 7168
  s_cmp_eq_u32 s19, 63
  s_cbranch_scc1 cB_done
  ds_read_b128 v[76:79], v1 offset:0
  ds_read_b128 v[80:83], v1 offset:1024
  ds_read_b128 v[84:87], v1 offset:2048
  ds_read_b128 v[88:91], v1 offset:3072
  ds_read_b128 v[92:95], v1 offset:4096
  ds_read_b128 v[96:99], v1 offset:5120
  v_smfmac_f32_16x16x64_bf16 v[60:63], v[8:11], v[200:207], v3
  v_smfmac_f32_16x16x64_bf16 v[60:63], v[12:15], v[208:215], v3
  s_waitcnt lgkmcnt(4)
  v_smfmac_f32_16x16x64_bf16 v[64:67], v[8:11], v[76:83], v3
  ds_read_b128 v[76:79], v1 offset:6144
  ds_read_b128 v[80:83], v1 offset:7168
  v_smfmac_f32_16x16x64_bf16 v[60:63], v[16:19], v[216:223], v3
  v_smfmac_f32_16x16x64_bf16 v[60:63], v[20:23], v[224:231], v3
  s_waitcnt lgkmcnt(4)
  v_smfmac_f32_16x16x64_bf16 v[64:67], v[12:15], v[84:91], v3
  ds_read_b128 v[84:87], v1 offset:8192
  ds_read_b128 v[88:91], v1 offset:9216
  v_smfmac_f32_16x16x64_bf16 v[60:63], v[24:27], v[232:239], v3
  v_smfmac_f32_16x16x64_bf16 v[60:63], v[28:31], v[240:247], v3
  s_waitcnt lgkmcnt(4)
  v_smfmac_f32_16x16x64_bf16 v[64:67], v[16:19], v[92:99], v3
  ds_read_b128 v[92:95], v1 offset:10240
  ds_read_b128 v[96:99], v1 offset:11264
  v_smfmac_f32_16x16x64_bf16 v[60:63], v[32:35], v[248:255], v3
  v_smfmac_f32_16x16x64_bf16 v[36:39], v[8:11], a[0:7], v3
  s_waitcnt lgkmcnt(4)
  v_smfmac_f32_16x16x64_bf16 v[64:67], v[20:23], v[76:83], v3
  ds_read_b128 v[76:79], v1 offset:12288
  ds_read_b128 v[80:83], v1 offset:13312
  v_smfmac_f32_16x16x64_bf16 v[36:39], v[12:15], a[8:15], v3
  v_add_f32 v60, v60, v61
  v_smfmac_f32_16x16x64_bf16 v[36:39], v[16:19], a[16:23], v3
  v_add_f32 v62, v62, v63
  s_waitcnt lgkmcnt(4)
  v_smfmac_f32_16x16x64_bf16 v[64:67], v[24:27], v[84:91], v3
  v_cvt_pk_bf16_f32 v60, v60, v62
  v_smfmac_f32_16x16x64_bf16 v[36:39], v[20:23], a[24:31], v3
  ds_write_b32 v106, v60
  v_smfmac_f32_16x16x64_bf16 v[36:39], v[24:27], a[32:39], v3
  s_waitcnt lgkmcnt(2)
  v_smfmac_f32_16x16x64_bf16 v[64:67], v[28:31], v[92:99], v3
  v_smfmac_f32_16x16x64_bf16 v[36:39], v[28:31], a[40:47], v3
  v_smfmac_f32_16x16x64_bf16 v[36:39], v[32:35], a[48:55], v3
  s_waitcnt lgkmcnt(0)
  v_smfmac_f32_16x16x64_bf16 v[64:67], v[32:35], v[76:83], v3
  v_smfmac_f32_16x16x64_bf16 v[40:43], v[8:11], a[56:63], v3
  v_smfmac_f32_16x16x64_bf16 v[40:43], v[12:15], a[64:71], v3
  v_add_f32 v36, v36, v37
  v_smfmac_f32_16x16x64_bf16 v[40:43], v[16:19], a[72:79], v3
  v_add_f32 v38, v38, v39
  v_smfmac_f32_16x16x64_bf16 v[40:43], v[20:23], a[80:87], v3
  v_cvt_pk_bf16_f32 v36, v36, v38
  v_smfmac_f32_16x16x64_bf16 v[40:43], v[24:27], a[88:95], v3
  ds_write_b32 v100, v36
  v_smfmac_f32_16x16x64_bf16 v[40:43], v[28:31], a[96:103], v3
  v_add_f32 v64, v64, v65
  v_smfmac_f32_16x16x64_bf16 v[40:43], v[32:35], a[104:111], v3
  v_add_f32 v66, v66, v67
  v_smfmac_f32_16x16x64_bf16 v[44:47], v[8:11], a[112:119], v3
  v_cvt_pk_bf16_f32 v64, v64, v66
  v_smfmac_f32_16x16x64_bf16 v[44:47], v[12:15], a[120:127], v3
  ds_write_b32 v107, v64
  v_smfmac_f32_16x16x64_bf16 v[44:47], v[16:19], a[128:135], v3
  v_add_f32 v40, v40, v41
  v_smfmac_f32_16x16x64_bf16 v[44:47], v[20:23], a[136:143], v3
  v_add_f32 v42, v42, v43
  v_smfmac_f32_16x16x64_bf16 v[44:47], v[24:27], a[144:151], v3
  v_cvt_pk_bf16_f32 v40, v40, v42
  v_smfmac_f32_16x16x64_bf16 v[44:47], v[28:31], a[152:159], v3
  ds_write_b32 v101, v40
  v_smfmac_f32_16x16x64_bf16 v[44:47], v[32:35], a[160:167], v3
  v_smfmac_f32_16x16x64_bf16 v[48:51], v[8:11], a[168:175], v3
  v_smfmac_f32_16x16x64_bf16 v[48:51], v[12:15], a[176:183], v3
  v_smfmac_f32_16x16x64_bf16 v[48:51], v[16:19], a[184:191], v3
  v_add_f32 v44, v44, v45
  v_smfmac_f32_16x16x64_bf16 v[48:51], v[20:23], a[192:199], v3
  v_add_f32 v46, v46, v47
  v_smfmac_f32_16x16x64_bf16 v[48:51], v[24:27], a[200:207], v3
  v_cvt_pk_bf16_f32 v44, v44, v46
  v_smfmac_f32_16x16x64_bf16 v[48:51], v[28:31], a[208:215], v3
  ds_write_b32 v102, v44
  v_smfmac_f32_16x16x64_bf16 v[48:51], v[32:35], a[216:223], v3
  v_smfmac_f32_16x16x64_bf16 v[52:55], v[8:11], a[224:231], v3
  v_smfmac_f32_16x16x64_bf16 v[52:55], v[12:15], a[232:239], v3
  v_smfmac_f32_16x16x64_bf16 v[52:55], v[16:19], a[240:247], v3
  v_add_f32 v48, v48, v49
  v_smfmac_f32_16x16x64_bf16 v[52:55], v[20:23], a[248:255], v3
  v_add_f32 v50, v50, v51
  v_smfmac_f32_16x16x64_bf16 v[52:55], v[24:27], v[120:127], v3
  v_cvt_pk_bf16_f32 v48, v48, v50
  v_smfmac_f32_16x16x64_bf16 v[52:55], v[28:31], v[128:135], v3
  ds_write_b32 v103, v48
  v_smfmac_f32_16x16x64_bf16 v[52:55], v[32:35], v[136:143], v3
  v_smfmac_f32_16x16x64_bf16 v[56:59], v[8:11], v[144:151], v3
  v_smfmac_f32_16x16x64_bf16 v[56:59], v[12:15], v[152:159], v3
  v_smfmac_f32_16x16x64_bf16 v[56:59], v[16:19], v[160:167], v3
  v_add_f32 v52, v52, v53
  v_smfmac_f32_16x16x64_bf16 v[56:59], v[20:23], v[168:175], v3
  v_add_f32 v54, v54, v55
  v_smfmac_f32_16x16x64_bf16 v[56:59], v[24:27], v[176:183], v3
  v_cvt_pk_bf16_f32 v52, v52, v54
  v_smfmac_f32_16x16x64_bf16 v[56:59], v[28:31], v[184:191], v3
  ds_write_b32 v104, v52
  v_smfmac_f32_16x16x64_bf16 v[56:59], v[32:35], v[192:199], v3
  s_nop 7
  v_add_f32 v56, v56, v57
  v_add_f32 v58, v58, v59
  v_cvt_pk_bf16_f32 v56, v56, v58
  ds_write_b32 v105, v56
  s_waitcnt lgkmcnt(0)
  s_barrier
  s_cmp_eq_u32 s19, 62
  s_cbranch_scc1 cB_done
  s_waitcnt vmcnt(0) lgkmcnt(0)
  s_add_u32 s19, s19, 1
  s_mov_b32 s20, s21
  s_branch cB_va2_loop
cB_va2_retry:
  s_waitcnt lgkmcnt(0)
  buffer_load_dwordx4 v[8:11], v2, s[8:11], s20 offen offset:0 sc1
  buffer_load_dwordx4 v[12:15], v2, s[8:11], s20 offen offset:1024 sc1
  buffer_load_dwordx4 v[16:19], v2, s[8:11], s20 offen offset:2048 sc1
  buffer_load_dwordx4 v[20:23], v2, s[8:11], s20 offen offset:3072 sc1
  s_add_u32 s31, s31, 1
  s_add_u32 s30, s30, 1
  s_cmp_lt_u32 s30, 400000
  s_cbranch_scc1 cB_va2_ld
  s_branch cB_abort
cB_va2_last:
  s_waitcnt lgkmcnt(0)
  buffer_store_dwordx4 v[100:103], v2, s[8:11], s24 offen offset:0 sc1
  buffer_store_dwordx4 v[104:107], v2, s[8:11], s24 offen offset:1024 sc1
  buffer_store_dwordx4 v[108:111], v2, s[8:11], s24 offen offset:2048 sc1
  buffer_store_dwordx4 v[4:7], v2, s[8:11], s24 offen offset:3072 sc1
  s_add_u32 s24, s24, 8192
  s_waitcnt vmcnt(0)
  s_mov_b64 exec, 1
  buffer_store_dword v117, v2, s[8:11], s34 offen sc1
  s_mov_b64 exec, -1
  s_add_u32 s34, s34, 8
  s_mov_b64 exec, 1
  buffer_store_dword v117, v2, s[8:11], s34 offen sc1
  s_mov_b64 exec, -1
  s_add_u32 s34, s34, 8
  s_branch cB_done
.p2align 6

cB_va3_loop:
  s_add_u32 s23, s20, 4096
  s_add_u32 s21, s20, 20480
  v_mov_b32 v36, 0
  v_mov_b32 v37, 0
  v_mov_b32 v38, 0
  v_mov_b32 v39, 0
  v_mov_b32 v40, 0
  v_mov_b32 v41, 0
  v_mov_b32 v42, 0
  v_mov_b32 v43, 0
  v_mov_b32 v44, 0
  v_mov_b32 v45, 0
  v_mov_b32 v46, 0
  v_mov_b32 v47, 0
  v_mov_b32 v48, 0
  v_mov_b32 v49, 0
  v_mov_b32 v50, 0
  v_mov_b32 v51, 0
  v_mov_b32 v52, 0
  v_mov_b32 v53, 0
  v_mov_b32 v54, 0
  v_mov_b32 v55, 0
  v_mov_b32 v56, 0
  v_mov_b32 v57, 0
  v_mov_b32 v58, 0
  v_mov_b32 v59, 0
  v_mov_b32 v60, 0
  v_mov_b32 v61, 0
  v_mov_b32 v62, 0
  v_mov_b32 v63, 0
  v_mov_b32 v64, 0
  v_mov_b32 v65, 0
  v_mov_b32 v66, 0
  v_mov_b32 v67, 0
  s_mov_b32 s30, 0
  buffer_load_dword v76, v119, s[8:11], s20 offen sc1
  buffer_load_dword v77, v119, s[8:11], s20 offen sc1
  buffer_load_dword v78, v119, s[8:11], s20 offen sc1
cB_va3_fp_l:
  s_waitcnt vmcnt(2)
  v_cmp_eq_u32 vcc, -1, v76
  s_cbranch_vccz cB_va3_fp_d
  buffer_load_dword v76, v119, s[8:11], s20 offen sc1
  s_waitcnt vmcnt(2)
  v_cmp_eq_u32 vcc, -1, v77
  s_cbranch_vccz cB_va3_fp_d
  buffer_load_dword v77, v119, s[8:11], s20 offen sc1
  s_waitcnt vmcnt(2)
  v_cmp_eq_u32 vcc, -1, v78
  s_cbranch_vccz cB_va3_fp_d
  buffer_load_dword v78, v119, s[8:11], s20 offen sc1
  s_add_u32 s30, s30, 1
  s_cmp_lt_u32 s30, 400000
  s_cbranch_scc1 cB_va3_fp_l
  s_branch cB_abort
cB_va3_fp_d:
  buffer_load_dwordx4 v[24:27], v2, s[8:11], s23 offen offset:0 sc1
  buffer_load_dwordx4 v[28:31], v2, s[8:11], s23 offen offset:1024 sc1
  buffer_load_dwordx4 v[32:35], v2, s[8:11], s23 offen offset:2048 sc1
  s_barrier
cB_va3_ld:
  s_waitcnt vmcnt(0)
  v_max3_u32 v84, v24, v25, v26
  v_max3_u32 v84, v84, v27, v28
  v_max3_u32 v84, v84, v29, v30
  v_max3_u32 v84, v84, v31, v32
  v_max3_u32 v84, v84, v33, v34
  v_max_u32 v84, v84, v35
  v_cmp_eq_u32 vcc, -1, v84
  ds_write_b128 v2, v[24:27] offset:12288
  ds_write_b128 v2, v[28:31] offset:13312
  ds_write_b128 v2, v[32:35] offset:14336
  s_cbranch_vccnz cB_va3_retry
  s_waitcnt lgkmcnt(0)
  s_barrier
  ds_read_b128 v[8:11], v5 offset:8192
  ds_read_b128 v[12:15], v5 offset:9216
  ds_read_b128 v[16:19], v5 offset:10240
  ds_read_b128 v[20:23], v5 offset:11264
  ds_read_b128 v[24:27], v5 offset:12288
  ds_read_b128 v[28:31], v5 offset:13312
  ds_read_b128 v[32:35], v5 offset:14336
  s_waitcnt lgkmcnt(0)
  s_cmp_eq_u32 s19, 63
  s_cbranch_scc1 cB_done
  ds_read_b128 v[76:79], v1 offset:0
  ds_read_b128 v[80:83], v1 offset:1024
  ds_read_b128 v[84:87], v1 offset:2048
  ds_read_b128 v[88:91], v1 offset:3072
  ds_read_b128 v[92:95], v1 offset:4096
  ds_read_b128 v[96:99], v1 offset:5120
  v_smfmac_f32_16x16x64_bf16 v[60:63], v[8:11], v[200:207], v3
  v_smfmac_f32_16x16x64_bf16 v[60:63], v[12:15], v[208:215], v3
  s_waitcnt lgkmcnt(4)
  v_smfmac_f32_16x16x64_bf16 v[64:67], v[8:11], v[76:83], v3
  ds_read_b128 v[76:79], v1 offset:6144
  ds_read_b128 v[80:83], v1 offset:7168
  v_smfmac_f32_16x16x64_bf16 v[60:63], v[16:19], v[216:223], v3
  v_smfmac_f32_16x16x64_bf16 v[60:63], v[20:23], v[224:231], v3
  s_waitcnt lgkmcnt(4)
  v_smfmac_f32_16x16x64_bf16 v[64:67], v[12:15], v[84:91], v3
  ds_read_b128 v[84:87], v1 offset:8192
  ds_read_b128 v[88:91], v1 offset:9216
  v_smfmac_f32_16x16x64_bf16 v[60:63], v[24:27], v[232:239], v3
  v_smfmac_f32_16x16x64_bf16 v[60:63], v[28:31], v[240:247], v3
  s_waitcnt lgkmcnt(4)
  v_smfmac_f32_16x16x64_bf16 v[64:67], v[16:19], v[92:99], v3
  ds_read_b128 v[92:95], v1 offset:10240
  ds_read_b128 v[96:99], v1 offset:11264
  v_smfmac_f32_16x16x64_bf16 v[60:63], v[32:35], v[248:255], v3
  v_smfmac_f32_16x16x64_bf16 v[36:39], v[8:11], a[0:7], v3
  s_waitcnt lgkmcnt(4)
  v_smfmac_f32_16x16x64_bf16 v[64:67], v[20:23], v[76:83], v3
  ds_read_b128 v[76:79], v1 offset:12288
  ds_read_b128 v[80:83], v1 offset:13312
  v_smfmac_f32_16x16x64_bf16 v[36:39], v[12:15], a[8:15], v3
  v_add_f32 v60, v60, v61
  v_smfmac_f32_16x16x64_bf16 v[36:39], v[16:19], a[16:23], v3
  v_add_f32 v62, v62, v63
  s_waitcnt lgkmcnt(4)
  v_smfmac_f32_16x16x64_bf16 v[64:67], v[24:27], v[84:91], v3
  v_cvt_pk_bf16_f32 v60, v60, v62
  v_smfmac_f32_16x16x64_bf16 v[36:39], v[20:23], a[24:31], v3
  ds_write_b32 v106, v60
  v_smfmac_f32_16x16x64_bf16 v[36:39], v[24:27], a[32:39], v3
  s_waitcnt lgkmcnt(2)
  v_smfmac_f32_16x16x64_bf16 v[64:67], v[28:31], v[92:99], v3
  v_smfmac_f32_16x16x64_bf16 v[36:39], v[28:31], a[40:47], v3
  v_smfmac_f32_16x16x64_bf16 v[36:39], v[32:35], a[48:55], v3
  s_waitcnt lgkmcnt(0)
  v_smfmac_f32_16x16x64_bf16 v[64:67], v[32:35], v[76:83], v3
  v_smfmac_f32_16x16x64_bf16 v[40:43], v[8:11], a[56:63], v3
  v_smfmac_f32_16x16x64_bf16 v[40:43], v[12:15], a[64:71], v3
  v_add_f32 v36, v36, v37
  v_smfmac_f32_16x16x64_bf16 v[40:43], v[16:19], a[72:79], v3
  v_add_f32 v38, v38, v39
  v_smfmac_f32_16x16x64_bf16 v[40:43], v[20:23], a[80:87], v3
  v_cvt_pk_bf16_f32 v36, v36, v38
  v_smfmac_f32_16x16x64_bf16 v[40:43], v[24:27], a[88:95], v3
  ds_write_b32 v100, v36
  v_smfmac_f32_16x16x64_bf16 v[40:43], v[28:31], a[96:103], v3
  v_add_f32 v64, v64, v65
  v_smfmac_f32_16x16x64_bf16 v[40:43], v[32:35], a[104:111], v3
  v_add_f32 v66, v66, v67
  v_smfmac_f32_16x16x64_bf16 v[44:47], v[8:11], a[112:119], v3
  v_cvt_pk_bf16_f32 v64, v64, v66
  v_smfmac_f32_16x16x64_bf16 v[44:47], v[12:15], a[120:127], v3
  ds_write_b32 v107, v64
  v_smfmac_f32_16x16x64_bf16 v[44:47], v[16:19], a[128:135], v3
  v_add_f32 v40, v40, v41
  v_smfmac_f32_16x16x64_bf16 v[44:47], v[20:23], a[136:143], v3
  v_add_f32 v42, v42, v43
  v_smfmac_f32_16x16x64_bf16 v[44:47], v[24:27], a[144:151], v3
  v_cvt_pk_bf16_f32 v40, v40, v42
  v_smfmac_f32_16x16x64_bf16 v[44:47], v[28:31], a[152:159], v3
  ds_write_b32 v101, v40
  v_smfmac_f32_16x16x64_bf16 v[44:47], v[32:35], a[160:167], v3
  v_smfmac_f32_16x16x64_bf16 v[48:51], v[8:11], a[168:175], v3
  v_smfmac_f32_16x16x64_bf16 v[48:51], v[12:15], a[176:183], v3
  v_smfmac_f32_16x16x64_bf16 v[48:51], v[16:19], a[184:191], v3
  v_add_f32 v44, v44, v45
  v_smfmac_f32_16x16x64_bf16 v[48:51], v[20:23], a[192:199], v3
  v_add_f32 v46, v46, v47
  v_smfmac_f32_16x16x64_bf16 v[48:51], v[24:27], a[200:207], v3
  v_cvt_pk_bf16_f32 v44, v44, v46
  v_smfmac_f32_16x16x64_bf16 v[48:51], v[28:31], a[208:215], v3
  ds_write_b32 v102, v44
  v_smfmac_f32_16x16x64_bf16 v[48:51], v[32:35], a[216:223], v3
  v_smfmac_f32_16x16x64_bf16 v[52:55], v[8:11], a[224:231], v3
  v_smfmac_f32_16x16x64_bf16 v[52:55], v[12:15], a[232:239], v3
  v_smfmac_f32_16x16x64_bf16 v[52:55], v[16:19], a[240:247], v3
  v_add_f32 v48, v48, v49
  v_smfmac_f32_16x16x64_bf16 v[52:55], v[20:23], a[248:255], v3
  v_add_f32 v50, v50, v51
  v_smfmac_f32_16x16x64_bf16 v[52:55], v[24:27], v[120:127], v3
  v_cvt_pk_bf16_f32 v48, v48, v50
  v_smfmac_f32_16x16x64_bf16 v[52:55], v[28:31], v[128:135], v3
  ds_write_b32 v103, v48
  v_smfmac_f32_16x16x64_bf16 v[52:55], v[32:35], v[136:143], v3
  v_smfmac_f32_16x16x64_bf16 v[56:59], v[8:11], v[144:151], v3
  v_smfmac_f32_16x16x64_bf16 v[56:59], v[12:15], v[152:159], v3
  v_smfmac_f32_16x16x64_bf16 v[56:59], v[16:19], v[160:167], v3
  v_add_f32 v52, v52, v53
  v_smfmac_f32_16x16x64_bf16 v[56:59], v[20:23], v[168:175], v3
  v_add_f32 v54, v54, v55
  v_smfmac_f32_16x16x64_bf16 v[56:59], v[24:27], v[176:183], v3
  v_cvt_pk_bf16_f32 v52, v52, v54
  v_smfmac_f32_16x16x64_bf16 v[56:59], v[28:31], v[184:191], v3
  ds_write_b32 v104, v52
  v_smfmac_f32_16x16x64_bf16 v[56:59], v[32:35], v[192:199], v3
  s_nop 7
  v_add_f32 v56, v56, v57
  v_add_f32 v58, v58, v59
  v_cvt_pk_bf16_f32 v56, v56, v58
  ds_write_b32 v105, v56
  s_waitcnt lgkmcnt(0)
  s_barrier
  s_cmp_eq_u32 s19, 62
  s_cbranch_scc1 cB_done
  s_waitcnt vmcnt(0) lgkmcnt(0)
  s_add_u32 s19, s19, 1
  s_mov_b32 s20, s21
  s_branch cB_va3_loop
cB_va3_retry:
  s_waitcnt lgkmcnt(0)
  buffer_load_dwordx4 v[24:27], v2, s[8:11], s23 offen offset:0 sc1
  buffer_load_dwordx4 v[28:31], v2, s[8:11], s23 offen offset:1024 sc1
  buffer_load_dwordx4 v[32:35], v2, s[8:11], s23 offen offset:2048 sc1
  s_add_u32 s31, s31, 1
  s_add_u32 s30, s30, 1
  s_cmp_lt_u32 s30, 400000
  s_cbranch_scc1 cB_va3_ld
  s_branch cB_abort
cB_va3_last:
  s_waitcnt lgkmcnt(0)
  buffer_store_dwordx4 v[100:103], v2, s[8:11], s24 offen offset:0 sc1
  buffer_store_dwordx4 v[104:107], v2, s[8:11], s24 offen offset:1024 sc1
  buffer_store_dwordx4 v[108:111], v2, s[8:11], s24 offen offset:2048 sc1
  buffer_store_dwordx4 v[4:7], v2, s[8:11], s24 offen offset:3072 sc1
  s_add_u32 s24, s24, 8192
  s_waitcnt vmcnt(0)
  s_mov_b64 exec, 1
  buffer_store_dword v117, v2, s[8:11], s34 offen sc1
  s_mov_b64 exec, -1
  s_add_u32 s34, s34, 8
  s_mov_b64 exec, 1
  buffer_store_dword v117, v2, s[8:11], s34 offen sc1
  s_mov_b64 exec, -1
  s_add_u32 s34, s34, 8
  s_branch cB_done
cB_abort:
  v_mov_b32 v4, 0xdead
  v_mov_b32 v5, 16
  buffer_store_dword v4, v5, s[12:15], 0 offen
  s_branch ch_end
cB_done:
  s_branch ch_end
m_reclaim:
  s_waitcnt vmcnt(0)
  s_lshr_b32 s20, s3, 5
  s_cmp_lg_u32 s16, 0
  s_cbranch_scc1 w0_25
  s_mov_b32 s21, 0
  s_mov_b64 exec, 1
rc_l:
  s_cmp_lg_u32 s70, -1
  s_cbranch_scc1 rc_t
  s_add_u32 s20, s20, 1
  s_cmp_lt_u32 s20, 8
  s_cselect_b32 s20, s20, 0
  s_mov_b32 s70, 0
  s_mov_b32 s3, -1
  s_add_u32 s21, s21, 1
  s_cmp_ge_u32 s21, 9
  s_cbranch_scc1 rc_d
rc_t:
  s_ff0_i32_b32 s22, s70
  s_lshl_b32 s23, 1, s22
  s_and_b32 s71, s20, 4
  s_mul_i32 s71, s71, 12
  s_lshl_b32 s3, s20, 2
  s_add_u32 s3, s3, s71
  v_mov_b32 v242, s23
  v_mov_b32 v243, 32
  buffer_atomic_or v242, v243, s[12:15], s3 offen sc0
  s_waitcnt vmcnt(0)
  v_readfirstlane_b32 s70, v242
  s_lshl_b32 s3, s20, 5
  s_add_u32 s3, s3, s22
  s_bitcmp1_b32 s70, s22
  s_cbranch_scc1 rc_l
rc_d:
  s_mov_b64 exec, -1
  v_mov_b32 v242, s3
w0_25:
  v_mov_b32 v250, 160000
  s_add_u32 s101, s101, 1
  s_barrier
  s_mov_b64 exec, 1
  s_cmp_lg_u32 s16, 0
  s_cbranch_scc1 w0_26
  ds_write_b32 v250, v242 offset:0
  s_waitcnt lgkmcnt(0)
  v_mov_b32 v242, s101
  ds_write_b32 v250, v242 offset:16
  s_waitcnt lgkmcnt(0)
w0_26:
  s_mov_b64 exec, -1
  s_barrier
  ds_read_b32 v242, v250 offset:0
  ds_read_b32 v250, v250 offset:16
  s_waitcnt lgkmcnt(0)
  v_readfirstlane_b32 s3, v242
  v_cmp_ne_u32 vcc, s101, v250
  s_cbranch_vccnz ch_end
  s_cmp_lg_u32 s3, -1
  s_cbranch_scc1 m_start
  v_mov_b32 v250, 0
  s_branch wk_ask
m_bjob:
  v_and_b32 v1, 63, v0
  v_lshlrev_b32 v2, 4, v1
  v_lshrrev_b32 v3, 4, v1
  v_and_b32 v4, 15, v1
  s_sub_u32 s18, s3, 32
  s_mul_i32 s17, s18, 4682
  s_lshr_b32 s17, s17, 16
  s_mul_i32 s20, s17, 14
  s_sub_u32 s19, s18, s20
  s_cmp_ge_u32 s19, 7
  s_cselect_b32 s31, 7, 0
  s_sub_u32 s19, s19, s31
  s_mov_b32 s60, s44
  s_and_b32 s61, s45, 0xffff
  s_mov_b32 s62, 3670016
  s_mov_b32 s63, 0x20000
  s_mov_b32 s56, s46
  s_and_b32 s57, s47, 0xffff
  s_mov_b32 s58, 3670016
  s_mov_b32 s59, 0x20000
  s_lshl_b32 s30, s16, 13
  s_mul_i32 s27, s17, 229376
  s_lshl_b32 s29, s19, 7
  s_add_u32 s27, s27, s29
  v_lshrrev_b32 v7, 3, v1
  v_and_b32 v8, 7, v1
  v_and_b32 v9, 2, v7
  v_xor_b32 v8, v8, v9
  s_lshl_b32 s29, s16, 6
  v_add_u32 v7, s29, v7
  v_mul_u32_u24 v7, 896, v7
  v_lshl_add_u32 v7, v8, 4, v7
  v_xor_b32 v8, 64, v7
  s_add_u32 m0, s30, 0
  s_add_u32 s22, s27, 0
  buffer_load_dwordx4 v7, s[56:59], s22 offen offset:0 lds
  s_add_u32 s22, s27, 6144
  buffer_load_dwordx4 v8, s[56:59], s22 offen offset:1024 lds
  s_add_u32 s22, s27, 12288
  buffer_load_dwordx4 v7, s[56:59], s22 offen offset:2048 lds
  s_add_u32 s22, s27, 18432
  buffer_load_dwordx4 v8, s[56:59], s22 offen offset:3072 lds
  s_add_u32 m0, s30, 4096
  s_add_u32 s22, s27, 28672
  buffer_load_dwordx4 v7, s[56:59], s22 offen offset:0 lds
  s_add_u32 s22, s27, 34816
  buffer_load_dwordx4 v8, s[56:59], s22 offen offset:1024 lds
  s_add_u32 s22, s27, 40960
  buffer_load_dwordx4 v7, s[56:59], s22 offen offset:2048 lds
  s_add_u32 s22, s27, 47104
  buffer_load_dwordx4 v8, s[56:59], s22 offen offset:3072 lds
  v_lshrrev_b32 v5, 5, v1
  v_and_b32 v6, 31, v1
  s_lshl_b32 s25, s16, 15
  s_add_u32 s25, s25, 32768
  s_lshl_b32 s26, s17, 9
  s_add_u32 s28, s19, s16
  s_cmp_ge_u32 s28, 7
  s_cselect_b32 s20, 7, 0
  s_sub_u32 s28, s28, s20
  s_add_u32 s28, s28, s31
  s_add_u32 s29, s19, s16
  s_add_u32 s29, s29, 4
  s_cmp_ge_u32 s29, 7
  s_cselect_b32 s20, 7, 0
  s_sub_u32 s29, s29, s20
  s_add_u32 s29, s29, s31
  s_lshl_b32 s32, s28, 18
  s_add_u32 s32, s32, s26
  s_lshl_b32 s33, s29, 18
  s_add_u32 s33, s33, s26
  v_xor_b32 v8, v6, v5
  v_lshlrev_b32 v8, 4, v8
  v_lshl_add_u32 v8, v5, 13, v8
  v_xor_b32 v12, 0, v8
  v_xor_b32 v13, 32, v8
  v_add_u32 v13, 15360, v13
  v_xor_b32 v14, 0, v8
  v_add_u32 v14, 30720, v14
  v_xor_b32 v15, 32, v8
  v_add_u32 v15, 46080, v15
  s_add_u32 s20, s16, 0
  s_and_b32 s20, s20, 3
  s_mul_i32 s21, s20, 65600
  s_lshl_b32 s20, s20, 12
  s_add_u32 s48, s20, s25
  s_mov_b32 m0, s48
  v_xor_b32 v16, s21, v12
  buffer_load_dwordx4 v16, s[60:63], s32 offen offset:0 lds
  v_xor_b32 v17, s21, v13
  buffer_load_dwordx4 v17, s[60:63], s32 offen offset:1024 lds
  v_xor_b32 v18, s21, v14
  buffer_load_dwordx4 v18, s[60:63], s32 offen offset:2048 lds
  v_xor_b32 v19, s21, v15
  buffer_load_dwordx4 v19, s[60:63], s32 offen offset:3072 lds
  s_add_u32 s20, s16, 1
  s_and_b32 s20, s20, 3
  s_mul_i32 s21, s20, 65600
  s_lshl_b32 s20, s20, 12
  s_add_u32 s49, s20, s25
  s_mov_b32 m0, s49
  v_xor_b32 v20, s21, v12
  buffer_load_dwordx4 v20, s[60:63], s32 offen offset:0 lds
  v_xor_b32 v21, s21, v13
  buffer_load_dwordx4 v21, s[60:63], s32 offen offset:1024 lds
  v_xor_b32 v22, s21, v14
  buffer_load_dwordx4 v22, s[60:63], s32 offen offset:2048 lds
  v_xor_b32 v23, s21, v15
  buffer_load_dwordx4 v23, s[60:63], s32 offen offset:3072 lds
  s_add_u32 s20, s16, 2
  s_and_b32 s20, s20, 3
  s_mul_i32 s21, s20, 65600
  s_lshl_b32 s20, s20, 12
  s_add_u32 s50, s20, s25
  s_mov_b32 m0, s50
  v_xor_b32 v24, s21, v12
  buffer_load_dwordx4 v24, s[60:63], s32 offen offset:0 lds
  v_xor_b32 v25, s21, v13
  buffer_load_dwordx4 v25, s[60:63], s32 offen offset:1024 lds
  v_xor_b32 v26, s21, v14
  buffer_load_dwordx4 v26, s[60:63], s32 offen offset:2048 lds
  v_xor_b32 v27, s21, v15
  buffer_load_dwordx4 v27, s[60:63], s32 offen offset:3072 lds
  s_add_u32 s20, s16, 3
  s_and_b32 s20, s20, 3
  s_mul_i32 s21, s20, 65600
  s_lshl_b32 s20, s20, 12
  s_add_u32 s51, s20, s25
  s_mov_b32 m0, s51
  v_xor_b32 v28, s21, v12
  buffer_load_dwordx4 v28, s[60:63], s32 offen offset:0 lds
  v_xor_b32 v29, s21, v13
  buffer_load_dwordx4 v29, s[60:63], s32 offen offset:1024 lds
  v_xor_b32 v30, s21, v14
  buffer_load_dwordx4 v30, s[60:63], s32 offen offset:2048 lds
  v_xor_b32 v31, s21, v15
  buffer_load_dwordx4 v31, s[60:63], s32 offen offset:3072 lds
  s_cmp_lg_u32 s66, 0
  s_cbranch_scc1 bj_ci
  s_cmp_lg_u32 s16, 0
  s_cbranch_scc1 w0_27
  s_lshr_b32 s70, s3, 5
  s_and_b32 s71, s70, 4
  s_mul_i32 s71, s71, 12
  s_lshl_b32 s70, s70, 2
  s_add_u32 s70, s70, s71
  s_lshl_b32 s71, 1, s3
  v_mov_b32 v44, s71
  v_mov_b32 v45, 32
  s_mov_b64 exec, 1
  buffer_atomic_or v44, v45, s[12:15], s70 offen sc0
  buffer_load_dwordx2 v[46:47], v45, s[12:15], 0 offen offset:96 sc1
  s_mov_b64 exec, -1
w0_27:
bj_ci:
  s_lshl_b32 s30, s19, 6
  s_add_u32 s30, s30, 0
  s_cmp_lt_u32 s19, 4
  s_cselect_b32 s20, 0, 256
  s_sub_u32 s30, s30, s20
  v_add_u32 v8, s30, v4
  s_lshr_b32 s20, s20, 4
  s_cmp_lt_u32 s19, 4
  s_movk_i32 s21, 5462
  s_cselect_b32 s21, 4096, s21
  s_cselect_b32 s30, 16, 12
  v_mul_u32_u24 v10, s21, v8
  v_lshrrev_b32 v10, 16, v10
  v_mul_u32_u24 v11, s30, v10
  v_sub_u32 v32, v8, v11
  v_add_u32 v32, s20, v32
  s_lshl_b32 s30, s17, 4
  s_mul_i32 s20, s17, 12
  s_add_u32 s20, s20, 240
  s_cmp_lt_u32 s19, 4
  s_cselect_b32 s30, s30, s20
  v_add_u32 v32, s30, v32
  v_lshrrev_b32 v33, 4, v32
  v_and_b32 v32, 15, v32
  s_mov_b32 s30, 401408
  v_mul_lo_u32 v10, v10, s30
  v_mul_u32_u24 v33, 14336, v33
  v_add_u32 v10, v10, v33
  v_lshl_add_u32 v10, v3, 8, v10
  v_lshl_add_u32 v10, v32, 4, v10
  v_add_u32 v12, 6422528, v10
  s_lshl_b32 s30, s19, 6
  s_add_u32 s30, s30, 16
  s_cmp_lt_u32 s19, 4
  s_cselect_b32 s20, 0, 256
  s_sub_u32 s30, s30, s20
  v_add_u32 v8, s30, v4
  s_lshr_b32 s20, s20, 4
  s_cmp_lt_u32 s19, 4
  s_movk_i32 s21, 5462
  s_cselect_b32 s21, 4096, s21
  s_cselect_b32 s30, 16, 12
  v_mul_u32_u24 v10, s21, v8
  v_lshrrev_b32 v10, 16, v10
  v_mul_u32_u24 v11, s30, v10
  v_sub_u32 v32, v8, v11
  v_add_u32 v32, s20, v32
  s_lshl_b32 s30, s17, 4
  s_mul_i32 s20, s17, 12
  s_add_u32 s20, s20, 240
  s_cmp_lt_u32 s19, 4
  s_cselect_b32 s30, s30, s20
  v_add_u32 v32, s30, v32
  v_lshrrev_b32 v33, 4, v32
  v_and_b32 v32, 15, v32
  s_mov_b32 s30, 401408
  v_mul_lo_u32 v10, v10, s30
  v_mul_u32_u24 v33, 14336, v33
  v_add_u32 v10, v10, v33
  v_lshl_add_u32 v10, v3, 8, v10
  v_lshl_add_u32 v10, v32, 4, v10
  v_add_u32 v13, 6422528, v10
  s_lshl_b32 s30, s19, 6
  s_add_u32 s30, s30, 32
  s_cmp_lt_u32 s19, 4
  s_cselect_b32 s20, 0, 256
  s_sub_u32 s30, s30, s20
  v_add_u32 v8, s30, v4
  s_lshr_b32 s20, s20, 4
  s_cmp_lt_u32 s19, 4
  s_movk_i32 s21, 5462
  s_cselect_b32 s21, 4096, s21
  s_cselect_b32 s30, 16, 12
  v_mul_u32_u24 v10, s21, v8
  v_lshrrev_b32 v10, 16, v10
  v_mul_u32_u24 v11, s30, v10
  v_sub_u32 v32, v8, v11
  v_add_u32 v32, s20, v32
  s_lshl_b32 s30, s17, 4
  s_mul_i32 s20, s17, 12
  s_add_u32 s20, s20, 240
  s_cmp_lt_u32 s19, 4
  s_cselect_b32 s30, s30, s20
  v_add_u32 v32, s30, v32
  v_lshrrev_b32 v33, 4, v32
  v_and_b32 v32, 15, v32
  s_mov_b32 s30, 401408
  v_mul_lo_u32 v10, v10, s30
  v_mul_u32_u24 v33, 14336, v33
  v_add_u32 v10, v10, v33
  v_lshl_add_u32 v10, v3, 8, v10
  v_lshl_add_u32 v10, v32, 4, v10
  v_add_u32 v14, 6422528, v10
  s_lshl_b32 s30, s19, 6
  s_add_u32 s30, s30, 48
  s_cmp_lt_u32 s19, 4
  s_cselect_b32 s20, 0, 256
  s_sub_u32 s30, s30, s20
  v_add_u32 v8, s30, v4
  s_lshr_b32 s20, s20, 4
  s_cmp_lt_u32 s19, 4
  s_movk_i32 s21, 5462
  s_cselect_b32 s21, 4096, s21
  s_cselect_b32 s30, 16, 12
  v_mul_u32_u24 v10, s21, v8
  v_lshrrev_b32 v10, 16, v10
  v_mul_u32_u24 v11, s30, v10
  v_sub_u32 v32, v8, v11
  v_add_u32 v32, s20, v32
  s_lshl_b32 s30, s17, 4
  s_mul_i32 s20, s17, 12
  s_add_u32 s20, s20, 240
  s_cmp_lt_u32 s19, 4
  s_cselect_b32 s30, s30, s20
  v_add_u32 v32, s30, v32
  v_lshrrev_b32 v33, 4, v32
  v_and_b32 v32, 15, v32
  s_mov_b32 s30, 401408
  v_mul_lo_u32 v10, v10, s30
  v_mul_u32_u24 v33, 14336, v33
  v_add_u32 v10, v10, v33
  v_lshl_add_u32 v10, v3, 8, v10
  v_lshl_add_u32 v10, v32, 4, v10
  v_add_u32 v15, 6422528, v10
  v_lshrrev_b32 v7, 2, v4
  v_lshlrev_b32 v7, 3, v7
  v_and_b32 v8, 3, v4
  v_add_u32 v7, v7, v8
  v_xor_b32 v10, v3, v4
  v_lshlrev_b32 v10, 4, v10
  v_lshl_add_u32 v10, v7, 9, v10
  v_add_u32 v10, s25, v10
  v_xor_b32 v32, 0, v10
  v_xor_b32 v33, 64, v10
  v_xor_b32 v34, 128, v10
  v_xor_b32 v35, 192, v10
  v_lshrrev_b32 v7, 2, v4
  v_lshl_add_u32 v7, v3, 3, v7
  v_lshlrev_b32 v7, 7, v7
  v_and_b32 v8, 3, v4
  v_lshl_add_u32 v7, v8, 3, v7
  v_lshrrev_b32 v8, 3, v4
  v_lshl_add_u32 v7, v8, 5, v7
  v_and_b32 v8, 1, v3
  v_lshl_add_u32 v7, v8, 6, v7
  s_waitcnt vmcnt(16)
  s_barrier
  s_cmp_eq_u32 s16, 3
  s_cbranch_scc1 bj_np0
  s_add_u32 m0, s48, 16384
  s_nop 0
  buffer_load_dwordx4 v16, s[60:63], s33 offen offset:0 lds
  buffer_load_dwordx4 v17, s[60:63], s33 offen offset:1024 lds
  buffer_load_dwordx4 v18, s[60:63], s33 offen offset:2048 lds
  buffer_load_dwordx4 v19, s[60:63], s33 offen offset:3072 lds
bj_np0:
  v_xor_b32 v9, 0, v7
  ds_read_b64_tr_b16 v[128:129], v9 offset:0
  ds_read_b64_tr_b16 v[130:131], v9 offset:512
  ds_read_b64_tr_b16 v[132:133], v9 offset:4096
  ds_read_b64_tr_b16 v[134:135], v9 offset:4608
  ds_read_b64_tr_b16 v[136:137], v9 offset:8192
  ds_read_b64_tr_b16 v[138:139], v9 offset:8704
  ds_read_b64_tr_b16 v[140:141], v9 offset:12288
  ds_read_b64_tr_b16 v[142:143], v9 offset:12800
  s_waitcnt lgkmcnt(6)
  ds_read_b64_tr_b16 v[144:145], v9 offset:16384
  ds_read_b64_tr_b16 v[146:147], v9 offset:16896
  ds_read_b64_tr_b16 v[148:149], v9 offset:20480
  ds_read_b64_tr_b16 v[150:151], v9 offset:20992
  ds_read_b64_tr_b16 v[152:153], v9 offset:24576
  ds_read_b64_tr_b16 v[154:155], v9 offset:25088
  ds_read_b64_tr_b16 v[156:157], v9 offset:28672
  ds_read_b64_tr_b16 v[158:159], v9 offset:29184
  s_waitcnt lgkmcnt(6)
  s_cmp_eq_u32 s16, 3
  s_cbranch_scc1 bj_np1
  s_add_u32 m0, s49, 16384
  s_nop 0
  buffer_load_dwordx4 v20, s[60:63], s33 offen offset:0 lds
  buffer_load_dwordx4 v21, s[60:63], s33 offen offset:1024 lds
  buffer_load_dwordx4 v22, s[60:63], s33 offen offset:2048 lds
  buffer_load_dwordx4 v23, s[60:63], s33 offen offset:3072 lds
bj_np1:
  v_xor_b32 v9, 32, v7
  ds_read_b64_tr_b16 v[160:161], v9 offset:0
  ds_read_b64_tr_b16 v[162:163], v9 offset:512
  ds_read_b64_tr_b16 v[164:165], v9 offset:4096
  ds_read_b64_tr_b16 v[166:167], v9 offset:4608
  ds_read_b64_tr_b16 v[168:169], v9 offset:8192
  ds_read_b64_tr_b16 v[170:171], v9 offset:8704
  ds_read_b64_tr_b16 v[172:173], v9 offset:12288
  ds_read_b64_tr_b16 v[174:175], v9 offset:12800
  s_waitcnt lgkmcnt(6)
  ds_read_b64_tr_b16 v[176:177], v9 offset:16384
  ds_read_b64_tr_b16 v[178:179], v9 offset:16896
  ds_read_b64_tr_b16 v[180:181], v9 offset:20480
  ds_read_b64_tr_b16 v[182:183], v9 offset:20992
  ds_read_b64_tr_b16 v[184:185], v9 offset:24576
  ds_read_b64_tr_b16 v[186:187], v9 offset:25088
  ds_read_b64_tr_b16 v[188:189], v9 offset:28672
  ds_read_b64_tr_b16 v[190:191], v9 offset:29184
  s_waitcnt lgkmcnt(6)
  s_cmp_eq_u32 s16, 3
  s_cbranch_scc1 bj_np2
  s_add_u32 m0, s50, 16384
  s_nop 0
  buffer_load_dwordx4 v24, s[60:63], s33 offen offset:0 lds
  buffer_load_dwordx4 v25, s[60:63], s33 offen offset:1024 lds
  buffer_load_dwordx4 v26, s[60:63], s33 offen offset:2048 lds
  buffer_load_dwordx4 v27, s[60:63], s33 offen offset:3072 lds
bj_np2:
  v_xor_b32 v9, 64, v7
  ds_read_b64_tr_b16 v[192:193], v9 offset:0
  ds_read_b64_tr_b16 v[194:195], v9 offset:512
  ds_read_b64_tr_b16 v[196:197], v9 offset:4096
  ds_read_b64_tr_b16 v[198:199], v9 offset:4608
  ds_read_b64_tr_b16 v[200:201], v9 offset:8192
  ds_read_b64_tr_b16 v[202:203], v9 offset:8704
  ds_read_b64_tr_b16 v[204:205], v9 offset:12288
  ds_read_b64_tr_b16 v[206:207], v9 offset:12800
  s_waitcnt lgkmcnt(6)
  ds_read_b64_tr_b16 v[208:209], v9 offset:16384
  ds_read_b64_tr_b16 v[210:211], v9 offset:16896
  ds_read_b64_tr_b16 v[212:213], v9 offset:20480
  ds_read_b64_tr_b16 v[214:215], v9 offset:20992
  ds_read_b64_tr_b16 v[216:217], v9 offset:24576
  ds_read_b64_tr_b16 v[218:219], v9 offset:25088
  ds_read_b64_tr_b16 v[220:221], v9 offset:28672
  ds_read_b64_tr_b16 v[222:223], v9 offset:29184
  s_waitcnt lgkmcnt(6)
  s_cmp_eq_u32 s16, 3
  s_cbranch_scc1 bj_np3
  s_add_u32 m0, s51, 16384
  s_nop 0
  buffer_load_dwordx4 v28, s[60:63], s33 offen offset:0 lds
  buffer_load_dwordx4 v29, s[60:63], s33 offen offset:1024 lds
  buffer_load_dwordx4 v30, s[60:63], s33 offen offset:2048 lds
  buffer_load_dwordx4 v31, s[60:63], s33 offen offset:3072 lds
bj_np3:
  v_xor_b32 v9, 96, v7
  ds_read_b64_tr_b16 v[224:225], v9 offset:0
  ds_read_b64_tr_b16 v[226:227], v9 offset:512
  ds_read_b64_tr_b16 v[228:229], v9 offset:4096
  ds_read_b64_tr_b16 v[230:231], v9 offset:4608
  ds_read_b64_tr_b16 v[232:233], v9 offset:8192
  ds_read_b64_tr_b16 v[234:235], v9 offset:8704
  ds_read_b64_tr_b16 v[236:237], v9 offset:12288
  ds_read_b64_tr_b16 v[238:239], v9 offset:12800
  s_waitcnt lgkmcnt(6)
  ds_read_b64_tr_b16 v[240:241], v9 offset:16384
  ds_read_b64_tr_b16 v[242:243], v9 offset:16896
  ds_read_b64_tr_b16 v[244:245], v9 offset:20480
  ds_read_b64_tr_b16 v[246:247], v9 offset:20992
  ds_read_b64_tr_b16 v[248:249], v9 offset:24576
  ds_read_b64_tr_b16 v[250:251], v9 offset:25088
  ds_read_b64_tr_b16 v[252:253], v9 offset:28672
  ds_read_b64_tr_b16 v[254:255], v9 offset:29184
  s_waitcnt lgkmcnt(6)
  s_mov_b32 s52, s36
  s_and_b32 s53, s37, 0xffff
  s_mov_b32 s54, 1835008
  s_mov_b32 s55, 0x20000
  s_lshl_b32 s20, s18, 8
  v_add_u32 v95, s20, v0
  s_mov_b32 s21, 9586981
  v_mul_hi_u32 v6, v95, s21
  v_mul_u32_u24 v7, 448, v6
  v_sub_u32 v7, v95, v7
  v_lshrrev_b32 v8, 4, v7
  v_and_b32 v7, 15, v7
  v_lshl_add_u32 v9, v6, 4, v7
  v_mul_u32_u24 v9, 896, v9
  v_lshl_add_u32 v9, v8, 5, v9
  buffer_load_dwordx4 v[84:87], v9, s[52:55], 0 offen
  buffer_load_dwordx4 v[88:91], v9, s[52:55], 0 offen offset:16
  v_mul_u32_u24 v6, 14336, v6
  v_lshl_add_u32 v6, v7, 4, v6
  v_lshl_add_u32 v92, v8, 9, v6
  v_lshrrev_b32 v7, 2, v8
  v_lshl_add_u32 v6, v7, 11, v6
  v_and_b32 v7, 3, v8
  v_lshl_add_u32 v93, v7, 8, v6
  s_mov_b32 s72, s38
  s_and_b32 s73, s39, 0xffff
  s_mov_b32 s74, 7168
  s_mov_b32 s75, 0x20000
  v_min_u32 v6, 223, v0
  v_lshrrev_b32 v7, 3, v6
  v_and_b32 v6, 7, v6
  v_mul_u32_u24 v9, 896, v6
  v_lshl_add_u32 v9, v7, 5, v9
  buffer_load_dwordx4 v[36:39], v9, s[72:75], 0 offen
  buffer_load_dwordx4 v[40:43], v9, s[72:75], 0 offen offset:16
  v_lshlrev_b32 v7, 8, v7
  v_lshl_add_u32 v94, v6, 4, v7
  s_lshl_b32 s26, s17, 9
  s_waitcnt vmcnt(20) lgkmcnt(0)
  s_cmp_lg_u32 s16, 3
  s_cbranch_scc1 w3_28
  s_waitcnt vmcnt(4)
w3_28:
  ds_read_b128 v[52:55], v32 offset:0
  ds_read_b128 v[56:59], v33 offset:0
  ds_read_b128 v[60:63], v34 offset:0
  ds_read_b128 v[64:67], v35 offset:0
  s_waitcnt lgkmcnt(3)
  v_mfma_f32_16x16x32_bf16 v[96:99], v[52:55], v[128:131], 0
  v_mfma_f32_16x16x32_bf16 v[100:103], v[52:55], v[160:163], 0
  v_mfma_f32_16x16x32_bf16 v[104:107], v[52:55], v[192:195], 0
  v_mfma_f32_16x16x32_bf16 v[108:111], v[52:55], v[224:227], 0
  ds_read_b128 v[52:55], v32 offset:256
  s_waitcnt lgkmcnt(3)
  v_mfma_f32_16x16x32_bf16 v[96:99], v[56:59], v[132:135], v[96:99]
  v_mfma_f32_16x16x32_bf16 v[100:103], v[56:59], v[164:167], v[100:103]
  v_mfma_f32_16x16x32_bf16 v[104:107], v[56:59], v[196:199], v[104:107]
  v_mfma_f32_16x16x32_bf16 v[108:111], v[56:59], v[228:231], v[108:111]
  ds_read_b128 v[56:59], v33 offset:256
  s_waitcnt lgkmcnt(3)
  v_mfma_f32_16x16x32_bf16 v[96:99], v[60:63], v[136:139], v[96:99]
  v_mfma_f32_16x16x32_bf16 v[100:103], v[60:63], v[168:171], v[100:103]
  v_mfma_f32_16x16x32_bf16 v[104:107], v[60:63], v[200:203], v[104:107]
  v_mfma_f32_16x16x32_bf16 v[108:111], v[60:63], v[232:235], v[108:111]
  ds_read_b128 v[60:63], v34 offset:256
  s_waitcnt lgkmcnt(3)
  v_mfma_f32_16x16x32_bf16 v[96:99], v[64:67], v[140:143], v[96:99]
  v_mfma_f32_16x16x32_bf16 v[100:103], v[64:67], v[172:175], v[100:103]
  v_mfma_f32_16x16x32_bf16 v[104:107], v[64:67], v[204:207], v[104:107]
  v_mfma_f32_16x16x32_bf16 v[108:111], v[64:67], v[236:239], v[108:111]
  ds_read_b128 v[64:67], v35 offset:256
  s_waitcnt lgkmcnt(3)
  v_mfma_f32_16x16x32_bf16 v[96:99], v[52:55], v[144:147], v[96:99]
  v_mfma_f32_16x16x32_bf16 v[100:103], v[52:55], v[176:179], v[100:103]
  v_mfma_f32_16x16x32_bf16 v[104:107], v[52:55], v[208:211], v[104:107]
  v_mfma_f32_16x16x32_bf16 v[108:111], v[52:55], v[240:243], v[108:111]
  ds_read_b128 v[52:55], v32 offset:2048
  s_waitcnt lgkmcnt(3)
  v_mfma_f32_16x16x32_bf16 v[96:99], v[56:59], v[148:151], v[96:99]
  v_mfma_f32_16x16x32_bf16 v[100:103], v[56:59], v[180:183], v[100:103]
  v_mfma_f32_16x16x32_bf16 v[104:107], v[56:59], v[212:215], v[104:107]
  v_mfma_f32_16x16x32_bf16 v[108:111], v[56:59], v[244:247], v[108:111]
  ds_read_b128 v[56:59], v33 offset:2048
  s_waitcnt lgkmcnt(3)
  v_mfma_f32_16x16x32_bf16 v[96:99], v[60:63], v[152:155], v[96:99]
  v_mfma_f32_16x16x32_bf16 v[100:103], v[60:63], v[184:187], v[100:103]
  v_mfma_f32_16x16x32_bf16 v[104:107], v[60:63], v[216:219], v[104:107]
  v_mfma_f32_16x16x32_bf16 v[108:111], v[60:63], v[248:251], v[108:111]
  ds_read_b128 v[60:63], v34 offset:2048
  s_waitcnt lgkmcnt(3)
  v_mfma_f32_16x16x32_bf16 v[96:99], v[64:67], v[156:159], v[96:99]
  v_mfma_f32_16x16x32_bf16 v[100:103], v[64:67], v[188:191], v[100:103]
  v_mfma_f32_16x16x32_bf16 v[104:107], v[64:67], v[220:223], v[104:107]
  v_mfma_f32_16x16x32_bf16 v[108:111], v[64:67], v[252:255], v[108:111]
  ds_read_b128 v[64:67], v35 offset:2048
  s_waitcnt lgkmcnt(3)
  v_mfma_f32_16x16x32_bf16 v[112:115], v[52:55], v[128:131], 0
  v_mfma_f32_16x16x32_bf16 v[116:119], v[52:55], v[160:163], 0
  v_mfma_f32_16x16x32_bf16 v[120:123], v[52:55], v[192:195], 0
  v_mfma_f32_16x16x32_bf16 v[124:127], v[52:55], v[224:227], 0
  ds_read_b128 v[52:55], v32 offset:2304
  s_waitcnt lgkmcnt(3)
  v_mfma_f32_16x16x32_bf16 v[112:115], v[56:59], v[132:135], v[112:115]
  v_mfma_f32_16x16x32_bf16 v[116:119], v[56:59], v[164:167], v[116:119]
  v_mfma_f32_16x16x32_bf16 v[120:123], v[56:59], v[196:199], v[120:123]
  v_mfma_f32_16x16x32_bf16 v[124:127], v[56:59], v[228:231], v[124:127]
  ds_read_b128 v[56:59], v33 offset:2304
  s_waitcnt lgkmcnt(3)
  v_mfma_f32_16x16x32_bf16 v[112:115], v[60:63], v[136:139], v[112:115]
  v_mfma_f32_16x16x32_bf16 v[116:119], v[60:63], v[168:171], v[116:119]
  v_mfma_f32_16x16x32_bf16 v[120:123], v[60:63], v[200:203], v[120:123]
  v_mfma_f32_16x16x32_bf16 v[124:127], v[60:63], v[232:235], v[124:127]
  ds_read_b128 v[60:63], v34 offset:2304
  s_waitcnt lgkmcnt(3)
  v_mfma_f32_16x16x32_bf16 v[112:115], v[64:67], v[140:143], v[112:115]
  v_mfma_f32_16x16x32_bf16 v[116:119], v[64:67], v[172:175], v[116:119]
  v_mfma_f32_16x16x32_bf16 v[120:123], v[64:67], v[204:207], v[120:123]
  v_mfma_f32_16x16x32_bf16 v[124:127], v[64:67], v[236:239], v[124:127]
  ds_read_b128 v[64:67], v35 offset:2304
  s_waitcnt lgkmcnt(3)
  v_mfma_f32_16x16x32_bf16 v[112:115], v[52:55], v[144:147], v[112:115]
  v_mfma_f32_16x16x32_bf16 v[116:119], v[52:55], v[176:179], v[116:119]
  v_mfma_f32_16x16x32_bf16 v[120:123], v[52:55], v[208:211], v[120:123]
  v_mfma_f32_16x16x32_bf16 v[124:127], v[52:55], v[240:243], v[124:127]
  s_waitcnt lgkmcnt(2)
  v_mfma_f32_16x16x32_bf16 v[112:115], v[56:59], v[148:151], v[112:115]
  v_mfma_f32_16x16x32_bf16 v[116:119], v[56:59], v[180:183], v[116:119]
  v_mfma_f32_16x16x32_bf16 v[120:123], v[56:59], v[212:215], v[120:123]
  v_mfma_f32_16x16x32_bf16 v[124:127], v[56:59], v[244:247], v[124:127]
  s_waitcnt lgkmcnt(1)
  v_mfma_f32_16x16x32_bf16 v[112:115], v[60:63], v[152:155], v[112:115]
  v_mfma_f32_16x16x32_bf16 v[116:119], v[60:63], v[184:187], v[116:119]
  v_mfma_f32_16x16x32_bf16 v[120:123], v[60:63], v[216:219], v[120:123]
  v_mfma_f32_16x16x32_bf16 v[124:127], v[60:63], v[248:251], v[124:127]
  s_waitcnt lgkmcnt(0)
  v_mfma_f32_16x16x32_bf16 v[112:115], v[64:67], v[156:159], v[112:115]
  v_mfma_f32_16x16x32_bf16 v[116:119], v[64:67], v[188:191], v[116:119]
  v_mfma_f32_16x16x32_bf16 v[120:123], v[64:67], v[220:223], v[120:123]
  v_mfma_f32_16x16x32_bf16 v[124:127], v[64:67], v[252:255], v[124:127]
  s_lshl_b32 s30, s28, 10
  v_cvt_pk_bf16_f32 v68, v96, v97
  v_cvt_pk_bf16_f32 v69, v98, v99
  v_cvt_pk_bf16_f32 v70, v112, v113
  v_cvt_pk_bf16_f32 v71, v114, v115
  buffer_store_dwordx4 v[68:71], v12, s[8:11], s30 offen sc1
  v_cvt_pk_bf16_f32 v72, v100, v101
  v_cvt_pk_bf16_f32 v73, v102, v103
  v_cvt_pk_bf16_f32 v74, v116, v117
  v_cvt_pk_bf16_f32 v75, v118, v119
  buffer_store_dwordx4 v[72:75], v13, s[8:11], s30 offen sc1
  v_cvt_pk_bf16_f32 v76, v104, v105
  v_cvt_pk_bf16_f32 v77, v106, v107
  v_cvt_pk_bf16_f32 v78, v120, v121
  v_cvt_pk_bf16_f32 v79, v122, v123
  buffer_store_dwordx4 v[76:79], v14, s[8:11], s30 offen sc1
  v_cvt_pk_bf16_f32 v80, v108, v109
  v_cvt_pk_bf16_f32 v81, v110, v111
  v_cvt_pk_bf16_f32 v82, v124, v125
  v_cvt_pk_bf16_f32 v83, v126, v127
  buffer_store_dwordx4 v[80:83], v15, s[8:11], s30 offen sc1
  s_cmp_eq_u32 s16, 3
  s_cbranch_scc1 bj_w3
  s_waitcnt vmcnt(8)
  ds_read_b128 v[52:55], v32 offset:16384
  ds_read_b128 v[56:59], v33 offset:16384
  ds_read_b128 v[60:63], v34 offset:16384
  ds_read_b128 v[64:67], v35 offset:16384
  s_waitcnt lgkmcnt(3)
  v_mfma_f32_16x16x32_bf16 v[96:99], v[52:55], v[128:131], 0
  v_mfma_f32_16x16x32_bf16 v[100:103], v[52:55], v[160:163], 0
  v_mfma_f32_16x16x32_bf16 v[104:107], v[52:55], v[192:195], 0
  v_mfma_f32_16x16x32_bf16 v[108:111], v[52:55], v[224:227], 0
  ds_read_b128 v[52:55], v32 offset:16640
  s_waitcnt lgkmcnt(3)
  v_mfma_f32_16x16x32_bf16 v[96:99], v[56:59], v[132:135], v[96:99]
  v_mfma_f32_16x16x32_bf16 v[100:103], v[56:59], v[164:167], v[100:103]
  v_mfma_f32_16x16x32_bf16 v[104:107], v[56:59], v[196:199], v[104:107]
  v_mfma_f32_16x16x32_bf16 v[108:111], v[56:59], v[228:231], v[108:111]
  ds_read_b128 v[56:59], v33 offset:16640
  s_waitcnt lgkmcnt(3)
  v_mfma_f32_16x16x32_bf16 v[96:99], v[60:63], v[136:139], v[96:99]
  v_mfma_f32_16x16x32_bf16 v[100:103], v[60:63], v[168:171], v[100:103]
  v_mfma_f32_16x16x32_bf16 v[104:107], v[60:63], v[200:203], v[104:107]
  v_mfma_f32_16x16x32_bf16 v[108:111], v[60:63], v[232:235], v[108:111]
  ds_read_b128 v[60:63], v34 offset:16640
  s_waitcnt lgkmcnt(3)
  v_mfma_f32_16x16x32_bf16 v[96:99], v[64:67], v[140:143], v[96:99]
  v_mfma_f32_16x16x32_bf16 v[100:103], v[64:67], v[172:175], v[100:103]
  v_mfma_f32_16x16x32_bf16 v[104:107], v[64:67], v[204:207], v[104:107]
  v_mfma_f32_16x16x32_bf16 v[108:111], v[64:67], v[236:239], v[108:111]
  ds_read_b128 v[64:67], v35 offset:16640
  s_waitcnt lgkmcnt(3)
  v_mfma_f32_16x16x32_bf16 v[96:99], v[52:55], v[144:147], v[96:99]
  v_mfma_f32_16x16x32_bf16 v[100:103], v[52:55], v[176:179], v[100:103]
  v_mfma_f32_16x16x32_bf16 v[104:107], v[52:55], v[208:211], v[104:107]
  v_mfma_f32_16x16x32_bf16 v[108:111], v[52:55], v[240:243], v[108:111]
  ds_read_b128 v[52:55], v32 offset:18432
  s_waitcnt lgkmcnt(3)
  v_mfma_f32_16x16x32_bf16 v[96:99], v[56:59], v[148:151], v[96:99]
  v_mfma_f32_16x16x32_bf16 v[100:103], v[56:59], v[180:183], v[100:103]
  v_mfma_f32_16x16x32_bf16 v[104:107], v[56:59], v[212:215], v[104:107]
  v_mfma_f32_16x16x32_bf16 v[108:111], v[56:59], v[244:247], v[108:111]
  ds_read_b128 v[56:59], v33 offset:18432
  s_waitcnt lgkmcnt(3)
  v_mfma_f32_16x16x32_bf16 v[96:99], v[60:63], v[152:155], v[96:99]
  v_mfma_f32_16x16x32_bf16 v[100:103], v[60:63], v[184:187], v[100:103]
  v_mfma_f32_16x16x32_bf16 v[104:107], v[60:63], v[216:219], v[104:107]
  v_mfma_f32_16x16x32_bf16 v[108:111], v[60:63], v[248:251], v[108:111]
  ds_read_b128 v[60:63], v34 offset:18432
  s_waitcnt lgkmcnt(3)
  v_mfma_f32_16x16x32_bf16 v[96:99], v[64:67], v[156:159], v[96:99]
  v_mfma_f32_16x16x32_bf16 v[100:103], v[64:67], v[188:191], v[100:103]
  v_mfma_f32_16x16x32_bf16 v[104:107], v[64:67], v[220:223], v[104:107]
  v_mfma_f32_16x16x32_bf16 v[108:111], v[64:67], v[252:255], v[108:111]
  ds_read_b128 v[64:67], v35 offset:18432
  s_waitcnt lgkmcnt(3)
  v_mfma_f32_16x16x32_bf16 v[112:115], v[52:55], v[128:131], 0
  v_mfma_f32_16x16x32_bf16 v[116:119], v[52:55], v[160:163], 0
  v_mfma_f32_16x16x32_bf16 v[120:123], v[52:55], v[192:195], 0
  v_mfma_f32_16x16x32_bf16 v[124:127], v[52:55], v[224:227], 0
  ds_read_b128 v[52:55], v32 offset:18688
  s_waitcnt lgkmcnt(3)
  v_mfma_f32_16x16x32_bf16 v[112:115], v[56:59], v[132:135], v[112:115]
  v_mfma_f32_16x16x32_bf16 v[116:119], v[56:59], v[164:167], v[116:119]
  v_mfma_f32_16x16x32_bf16 v[120:123], v[56:59], v[196:199], v[120:123]
  v_mfma_f32_16x16x32_bf16 v[124:127], v[56:59], v[228:231], v[124:127]
  ds_read_b128 v[56:59], v33 offset:18688
  s_waitcnt lgkmcnt(3)
  v_mfma_f32_16x16x32_bf16 v[112:115], v[60:63], v[136:139], v[112:115]
  v_mfma_f32_16x16x32_bf16 v[116:119], v[60:63], v[168:171], v[116:119]
  v_mfma_f32_16x16x32_bf16 v[120:123], v[60:63], v[200:203], v[120:123]
  v_mfma_f32_16x16x32_bf16 v[124:127], v[60:63], v[232:235], v[124:127]
  ds_read_b128 v[60:63], v34 offset:18688
  s_waitcnt lgkmcnt(3)
  v_mfma_f32_16x16x32_bf16 v[112:115], v[64:67], v[140:143], v[112:115]
  v_mfma_f32_16x16x32_bf16 v[116:119], v[64:67], v[172:175], v[116:119]
  v_mfma_f32_16x16x32_bf16 v[120:123], v[64:67], v[204:207], v[120:123]
  v_mfma_f32_16x16x32_bf16 v[124:127], v[64:67], v[236:239], v[124:127]
  ds_read_b128 v[64:67], v35 offset:18688
  s_waitcnt lgkmcnt(3)
  v_mfma_f32_16x16x32_bf16 v[112:115], v[52:55], v[144:147], v[112:115]
  v_mfma_f32_16x16x32_bf16 v[116:119], v[52:55], v[176:179], v[116:119]
  v_mfma_f32_16x16x32_bf16 v[120:123], v[52:55], v[208:211], v[120:123]
  v_mfma_f32_16x16x32_bf16 v[124:127], v[52:55], v[240:243], v[124:127]
  s_waitcnt lgkmcnt(2)
  v_mfma_f32_16x16x32_bf16 v[112:115], v[56:59], v[148:151], v[112:115]
  v_mfma_f32_16x16x32_bf16 v[116:119], v[56:59], v[180:183], v[116:119]
  v_mfma_f32_16x16x32_bf16 v[120:123], v[56:59], v[212:215], v[120:123]
  v_mfma_f32_16x16x32_bf16 v[124:127], v[56:59], v[244:247], v[124:127]
  s_waitcnt lgkmcnt(1)
  v_mfma_f32_16x16x32_bf16 v[112:115], v[60:63], v[152:155], v[112:115]
  v_mfma_f32_16x16x32_bf16 v[116:119], v[60:63], v[184:187], v[116:119]
  v_mfma_f32_16x16x32_bf16 v[120:123], v[60:63], v[216:219], v[120:123]
  v_mfma_f32_16x16x32_bf16 v[124:127], v[60:63], v[248:251], v[124:127]
  s_waitcnt lgkmcnt(0)
  v_mfma_f32_16x16x32_bf16 v[112:115], v[64:67], v[156:159], v[112:115]
  v_mfma_f32_16x16x32_bf16 v[116:119], v[64:67], v[188:191], v[116:119]
  v_mfma_f32_16x16x32_bf16 v[120:123], v[64:67], v[220:223], v[120:123]
  v_mfma_f32_16x16x32_bf16 v[124:127], v[64:67], v[252:255], v[124:127]
  s_lshl_b32 s30, s29, 10
  v_cvt_pk_bf16_f32 v68, v96, v97
  v_cvt_pk_bf16_f32 v69, v98, v99
  v_cvt_pk_bf16_f32 v70, v112, v113
  v_cvt_pk_bf16_f32 v71, v114, v115
  buffer_store_dwordx4 v[68:71], v12, s[8:11], s30 offen sc1
  v_cvt_pk_bf16_f32 v72, v100, v101
  v_cvt_pk_bf16_f32 v73, v102, v103
  v_cvt_pk_bf16_f32 v74, v116, v117
  v_cvt_pk_bf16_f32 v75, v118, v119
  buffer_store_dwordx4 v[72:75], v13, s[8:11], s30 offen sc1
  v_cvt_pk_bf16_f32 v76, v104, v105
  v_cvt_pk_bf16_f32 v77, v106, v107
  v_cvt_pk_bf16_f32 v78, v120, v121
  v_cvt_pk_bf16_f32 v79, v122, v123
  buffer_store_dwordx4 v[76:79], v14, s[8:11], s30 offen sc1
  v_cvt_pk_bf16_f32 v80, v108, v109
  v_cvt_pk_bf16_f32 v81, v110, v111
  v_cvt_pk_bf16_f32 v82, v124, v125
  v_cvt_pk_bf16_f32 v83, v126, v127
  buffer_store_dwordx4 v[80:83], v15, s[8:11], s30 offen sc1
bj_w3:
  s_lshl_b32 s77, s19, 8
  s_lshl_b32 s21, s17, 4
  s_add_u32 s77, s77, s21
  s_cmp_lg_u32 s31, 0
  s_cselect_b32 s21, 8, 0
  s_add_u32 s77, s77, s21
  s_add_u32 s77, s77, 88600576
  s_add_u32 s78, s77, 2048
  s_cmp_lg_u32 s66, 0
  s_cbranch_scc1 bj_cf
  s_cmp_lg_u32 s16, 0
  s_cbranch_scc1 w0_29
  s_waitcnt vmcnt(8)
  v_readfirstlane_b32 s70, v46
  s_cmp_lg_u32 s70, 0
  s_cbranch_scc1 bj_nz
  v_mov_b32 v45, 128
  v_mov_b32 v46, s88
  v_mov_b32 v47, s89
  v_mov_b32 v48, 0
  v_mov_b32 v49, 0
  s_mov_b64 exec, 1
  buffer_atomic_cmpswap_x2 v[46:49], v45, s[12:15], 0 offen sc0
  s_mov_b64 exec, -1
  s_waitcnt vmcnt(0)
  v_readfirstlane_b32 s70, v46
  s_cmp_lg_u32 s70, 0
  s_cbranch_scc1 bj_nz
  v_mov_b32 v46, s88
  v_mov_b32 v47, s89
bj_nz:
w0_29:
  v_mov_b32 v45, 160000
  s_add_u32 s101, s101, 1
  s_barrier
  s_mov_b64 exec, 1
  s_cmp_lg_u32 s16, 0
  s_cbranch_scc1 w0_30
  ds_write_b32 v45, v44 offset:0
  ds_write_b32 v45, v46 offset:4
  ds_write_b32 v45, v47 offset:8
  s_waitcnt lgkmcnt(0)
  v_mov_b32 v44, s101
  ds_write_b32 v45, v44 offset:16
  s_waitcnt lgkmcnt(0)
w0_30:
  s_mov_b64 exec, -1
  s_barrier
  ds_read_b32 v44, v45 offset:0
  ds_read_b32 v46, v45 offset:4
  ds_read_b32 v47, v45 offset:8
  ds_read_b32 v45, v45 offset:16
  s_waitcnt lgkmcnt(0)
  v_readfirstlane_b32 s70, v44
  v_readfirstlane_b32 s88, v46
  v_readfirstlane_b32 s89, v47
  v_cmp_ne_u32 vcc, s101, v45
  s_cbranch_vccnz ch_end
  s_mov_b32 s66, 1
  s_bitcmp1_b32 s70, s3
  s_cbranch_scc1 m_reclaim
bj_cf:
  s_barrier
  s_mov_b32 s56, s40
  s_and_b32 s57, s41, 0xffff
  s_mov_b32 s58, 3670016
  s_mov_b32 s59, 0x20000
  s_mov_b32 s60, s42
  s_and_b32 s61, s43, 0xffff
  s_mov_b32 s62, 3670016
  s_mov_b32 s63, 0x20000
  s_add_u32 s28, s31, s19
  v_lshrrev_b32 v5, 5, v1
  v_and_b32 v6, 31, v1
  v_xor_b32 v6, v6, v5
  v_lshlrev_b32 v6, 4, v6
  v_lshl_add_u32 v6, v5, 13, v6
  s_lshl_b32 s20, s16, 6
  v_xor_b32 v7, s20, v6
  s_lshl_b32 s22, s28, 18
  s_lshl_b32 s21, s16, 16
  s_add_u32 s22, s22, s21
  s_add_u32 s22, s22, s26
  s_lshl_b32 m0, s16, 12
  v_xor_b32 v8, 0, v7
  buffer_load_dwordx4 v8, s[56:59], s22 offen offset:0 lds
  v_xor_b32 v8, 32, v7
  v_add_u32 v8, 15360, v8
  buffer_load_dwordx4 v8, s[56:59], s22 offen offset:1024 lds
  v_xor_b32 v8, 0, v7
  v_add_u32 v8, 30720, v8
  buffer_load_dwordx4 v8, s[56:59], s22 offen offset:2048 lds
  v_xor_b32 v8, 32, v7
  v_add_u32 v8, 46080, v8
  buffer_load_dwordx4 v8, s[56:59], s22 offen offset:3072 lds
  v_xor_b32 v16, 0, v6
  v_xor_b32 v17, 32, v6
  v_add_u32 v17, 31744, v17
  v_xor_b32 v18, 64, v6
  v_add_u32 v18, 129024, v18
  v_xor_b32 v19, 96, v6
  v_add_u32 v19, 160768, v19
  v_xor_b32 v20, 128, v6
  v_add_u32 v20, 262144, v20
  v_xor_b32 v21, 160, v6
  v_add_u32 v21, 293888, v21
  v_xor_b32 v22, 192, v6
  v_add_u32 v22, 391168, v22
  v_xor_b32 v23, 224, v6
  v_add_u32 v23, 422912, v23
  s_lshr_b32 s20, s16, 1
  s_lshl_b32 s20, s20, 16
  s_and_b32 s21, s16, 1
  s_lshl_b32 s21, s21, 14
  s_add_u32 s20, s20, s21
  s_add_u32 s29, s20, s26
  s_mul_i32 s25, s16, 24576
  s_add_u32 s25, s25, 16384
  s_add_u32 s22, s29, 2097152
  s_add_u32 m0, s25, 0
  s_nop 0
  buffer_load_dwordx4 v16, s[60:63], s22 offen offset:0 lds
  buffer_load_dwordx4 v17, s[60:63], s22 offen offset:1024 lds
  buffer_load_dwordx4 v18, s[60:63], s22 offen offset:2048 lds
  buffer_load_dwordx4 v19, s[60:63], s22 offen offset:3072 lds
  s_add_u32 m0, s25, 4096
  s_nop 0
  buffer_load_dwordx4 v20, s[60:63], s22 offen offset:0 lds
  buffer_load_dwordx4 v21, s[60:63], s22 offen offset:1024 lds
  buffer_load_dwordx4 v22, s[60:63], s22 offen offset:2048 lds
  buffer_load_dwordx4 v23, s[60:63], s22 offen offset:3072 lds
  s_waitcnt vmcnt(12)
  s_barrier
  s_cmp_lg_u32 s16, 0
  s_cbranch_scc1 pub_31
  v_mul_u32_u24 v50, 2048, v1
  v_mov_b32 v48, s88
  v_mov_b32 v49, s89
  s_mov_b64 exec, 1
  buffer_store_dwordx2 v[48:49], v50, s[8:11], s77 offen sc1
  s_mov_b64 exec, -1
pub_31:
  s_cmp_ge_u32 s18, 70
  s_cbranch_scc1 bk_nm
  s_mov_b32 s20, 71565312
  buffer_store_dwordx4 v[84:87], v92, s[8:11], s20 offen sc1
  buffer_store_dwordx4 v[88:91], v92, s[8:11], s20 offen offset:256 sc1
  s_cmp_lg_u32 s18, 0
  s_cbranch_scc1 bk_nm
  v_min_u32 v104, -2, v36
  v_min_u32 v108, -2, v37
  v_min_u32 v105, -2, v38
  v_min_u32 v109, -2, v39
  v_min_u32 v106, -2, v40
  v_min_u32 v110, -2, v41
  v_min_u32 v107, -2, v42
  v_min_u32 v111, -2, v43
  s_mov_b32 s20, 88653824
  s_mov_b32 s21, 88080384
  buffer_store_dwordx4 v[104:107], v94, s[8:11], s20 offen sc1
  buffer_store_dwordx4 v[108:111], v94, s[8:11], s20 offen offset:128 sc1
  buffer_store_dwordx4 v[104:107], v94, s[8:11], s21 offen sc1
  buffer_store_dwordx4 v[108:111], v94, s[8:11], s21 offen offset:128 sc1
bk_nm:
  s_mov_b32 s23, 88653824
  v_add_u32 v6, 448, v95
  v_subrev_u32 v7, 1152, v6
  v_mov_b32 v52, -1
  v_mov_b32 v9, 0
  v_cmp_gt_u32 vcc, 128, v7
  s_nop 1
  v_cndmask_b32 v52, v52, v9, vcc
  v_mov_b32 v53, v52
  v_mov_b32 v54, v52
  v_mov_b32 v55, v52
  v_lshlrev_b32 v8, 4, v6
  v_mov_b32 v9, 0x10000000
  v_cmp_lt_u32 vcc, 25599, v6
  s_nop 1
  v_cndmask_b32 v8, v8, v9, vcc
  buffer_store_dwordx4 v[52:55], v8, s[8:11], s23 offen sc1
  s_mov_b32 s23, 87957504
  v_add_u32 v6, 448, v95
  v_cmp_gt_u32 vcc, 7680, v95
  s_nop 1
  v_cndmask_b32 v6, v6, v95, vcc
  v_subrev_u32 v7, 36352, v6
  v_mov_b32 v56, -1
  v_mov_b32 v9, 0
  v_cmp_gt_u32 vcc, 1048576, v7
  s_nop 1
  v_cndmask_b32 v56, v56, v9, vcc
  v_mov_b32 v57, v56
  v_mov_b32 v58, v56
  v_mov_b32 v59, v56
  v_lshlrev_b32 v8, 4, v6
  v_mov_b32 v9, 0x10000000
  v_cmp_lt_u32 vcc, 40191, v6
  s_nop 1
  v_cndmask_b32 v8, v8, v9, vcc
  buffer_store_dwordx4 v[56:59], v8, s[8:11], s23 offen sc1
  s_add_u32 s22, s29, 2621440
  s_add_u32 m0, s25, 8192
  s_nop 0
  buffer_load_dwordx4 v16, s[60:63], s22 offen offset:0 lds
  buffer_load_dwordx4 v17, s[60:63], s22 offen offset:1024 lds
  buffer_load_dwordx4 v18, s[60:63], s22 offen offset:2048 lds
  buffer_load_dwordx4 v19, s[60:63], s22 offen offset:3072 lds
  s_add_u32 m0, s25, 12288
  s_nop 0
  buffer_load_dwordx4 v20, s[60:63], s22 offen offset:0 lds
  buffer_load_dwordx4 v21, s[60:63], s22 offen offset:1024 lds
  buffer_load_dwordx4 v22, s[60:63], s22 offen offset:2048 lds
  buffer_load_dwordx4 v23, s[60:63], s22 offen offset:3072 lds
  s_add_u32 s22, s29, 3145728
  s_add_u32 m0, s25, 16384
  s_nop 0
  buffer_load_dwordx4 v16, s[60:63], s22 offen offset:0 lds
  buffer_load_dwordx4 v17, s[60:63], s22 offen offset:1024 lds
  buffer_load_dwordx4 v18, s[60:63], s22 offen offset:2048 lds
  buffer_load_dwordx4 v19, s[60:63], s22 offen offset:3072 lds
  s_add_u32 m0, s25, 20480
  s_nop 0
  buffer_load_dwordx4 v20, s[60:63], s22 offen offset:0 lds
  buffer_load_dwordx4 v21, s[60:63], s22 offen offset:1024 lds
  buffer_load_dwordx4 v22, s[60:63], s22 offen offset:2048 lds
  buffer_load_dwordx4 v23, s[60:63], s22 offen offset:3072 lds
  v_mov_b32 v250, s68
  s_or_b32 s20, s69, s16
  s_cbranch_scc1 bj_ht
  s_cmp_lg_u32 s16, 0
  s_cbranch_scc1 w0_32
  v_mov_b32 v250, 1
  v_mov_b32 v251, 192
  s_mov_b64 exec, 1
  buffer_atomic_add v250, v251, s[12:15], 0 offen sc0
  s_mov_b64 exec, -1
w0_32:
  s_branch bj_h2
bj_ht:
  buffer_load_dword v251, off, s[8:11], s77
bj_h2:
  v_lshrrev_b32 v7, 2, v4
  v_lshlrev_b32 v7, 3, v7
  v_and_b32 v8, 3, v4
  v_add_u32 v7, v7, v8
  v_xor_b32 v10, v3, v4
  v_lshlrev_b32 v10, 4, v10
  v_lshl_add_u32 v11, v4, 9, v10
  v_add_u32 v11, s25, v11
  v_lshl_add_u32 v10, v7, 9, v10
  v_xor_b32 v32, 0, v10
  v_xor_b32 v36, 0, v11
  v_xor_b32 v33, 64, v10
  v_xor_b32 v37, 64, v11
  v_xor_b32 v34, 128, v10
  v_xor_b32 v38, 128, v11
  v_xor_b32 v35, 192, v10
  v_xor_b32 v39, 192, v11
  s_mul_i32 s30, s17, 401408
  s_mul_i32 s20, s16, 14336
  s_add_u32 s30, s30, s20
  s_lshl_b32 s20, s28, 10
  s_add_u32 s30, s30, s20
  s_mov_b32 s24, 1035512379
  s_lshl_b32 s20, s17, 7
  s_lshl_b32 s28, s28, 3
  s_add_u32 s28, s28, s20
  s_add_u32 s28, s28, 88635392
  s_waitcnt vmcnt(1)
  s_barrier
  s_cmp_lg_u32 s16, 0
  s_cbranch_scc1 w0_33
  v_mul_u32_u24 v50, 2048, v1
  v_mov_b32 v48, s88
  v_mov_b32 v49, s89
  s_mov_b64 exec, 511
  buffer_store_dwordx2 v[48:49], v50, s[8:11], s78 offen sc1
  s_mov_b64 exec, -1
w0_33:
  ds_read_b128 v[128:131], v32 offset:0
  ds_read_b128 v[132:135], v32 offset:2048
  ds_read_b128 v[136:139], v36 offset:0
  ds_read_b128 v[140:143], v36 offset:8192
  ds_read_b128 v[144:147], v36 offset:16384
  ds_read_b128 v[148:151], v33 offset:0
  ds_read_b128 v[152:155], v33 offset:2048
  ds_read_b128 v[156:159], v37 offset:0
  ds_read_b128 v[160:163], v37 offset:8192
  ds_read_b128 v[164:167], v37 offset:16384
  ds_read_b128 v[168:171], v34 offset:0
  ds_read_b128 v[172:175], v34 offset:2048
  ds_read_b128 v[176:179], v38 offset:0
  ds_read_b128 v[180:183], v38 offset:8192
  ds_read_b128 v[184:187], v38 offset:16384
  s_waitcnt lgkmcnt(10)
  v_mfma_f32_16x16x32_bf16 v[96:99], v[128:131], v[136:139], 0
  v_mfma_f32_16x16x32_bf16 v[100:103], v[132:135], v[136:139], 0
  v_mfma_f32_16x16x32_bf16 v[104:107], v[128:131], v[140:143], 0
  v_mfma_f32_16x16x32_bf16 v[108:111], v[132:135], v[140:143], 0
  v_mfma_f32_16x16x32_bf16 v[112:115], v[128:131], v[144:147], 0
  v_mfma_f32_16x16x32_bf16 v[116:119], v[132:135], v[144:147], 0
  ds_read_b128 v[128:131], v35 offset:0
  ds_read_b128 v[132:135], v35 offset:2048
  ds_read_b128 v[136:139], v39 offset:0
  ds_read_b128 v[140:143], v39 offset:8192
  ds_read_b128 v[144:147], v39 offset:16384
  s_waitcnt lgkmcnt(10)
  v_mfma_f32_16x16x32_bf16 v[96:99], v[148:151], v[156:159], v[96:99]
  v_mfma_f32_16x16x32_bf16 v[100:103], v[152:155], v[156:159], v[100:103]
  v_mfma_f32_16x16x32_bf16 v[104:107], v[148:151], v[160:163], v[104:107]
  v_mfma_f32_16x16x32_bf16 v[108:111], v[152:155], v[160:163], v[108:111]
  v_mfma_f32_16x16x32_bf16 v[112:115], v[148:151], v[164:167], v[112:115]
  v_mfma_f32_16x16x32_bf16 v[116:119], v[152:155], v[164:167], v[116:119]
  ds_read_b128 v[148:151], v32 offset:256
  ds_read_b128 v[152:155], v32 offset:2304
  ds_read_b128 v[156:159], v36 offset:256
  ds_read_b128 v[160:163], v36 offset:8448
  ds_read_b128 v[164:167], v36 offset:16640
  s_waitcnt lgkmcnt(10)
  v_mfma_f32_16x16x32_bf16 v[96:99], v[168:171], v[176:179], v[96:99]
  v_mfma_f32_16x16x32_bf16 v[100:103], v[172:175], v[176:179], v[100:103]
  v_mfma_f32_16x16x32_bf16 v[104:107], v[168:171], v[180:183], v[104:107]
  v_mfma_f32_16x16x32_bf16 v[108:111], v[172:175], v[180:183], v[108:111]
  v_mfma_f32_16x16x32_bf16 v[112:115], v[168:171], v[184:187], v[112:115]
  v_mfma_f32_16x16x32_bf16 v[116:119], v[172:175], v[184:187], v[116:119]
  ds_read_b128 v[168:171], v33 offset:256
  ds_read_b128 v[172:175], v33 offset:2304
  ds_read_b128 v[176:179], v37 offset:256
  ds_read_b128 v[180:183], v37 offset:8448
  ds_read_b128 v[184:187], v37 offset:16640
  s_waitcnt lgkmcnt(10)
  v_mfma_f32_16x16x32_bf16 v[96:99], v[128:131], v[136:139], v[96:99]
  v_mfma_f32_16x16x32_bf16 v[100:103], v[132:135], v[136:139], v[100:103]
  v_mfma_f32_16x16x32_bf16 v[104:107], v[128:131], v[140:143], v[104:107]
  v_mfma_f32_16x16x32_bf16 v[108:111], v[132:135], v[140:143], v[108:111]
  v_mfma_f32_16x16x32_bf16 v[112:115], v[128:131], v[144:147], v[112:115]
  v_mfma_f32_16x16x32_bf16 v[116:119], v[132:135], v[144:147], v[116:119]
  ds_read_b128 v[128:131], v34 offset:256
  ds_read_b128 v[132:135], v34 offset:2304
  ds_read_b128 v[136:139], v38 offset:256
  ds_read_b128 v[140:143], v38 offset:8448
  ds_read_b128 v[144:147], v38 offset:16640
  s_waitcnt lgkmcnt(10)
  v_mfma_f32_16x16x32_bf16 v[96:99], v[148:151], v[156:159], v[96:99]
  v_mfma_f32_16x16x32_bf16 v[100:103], v[152:155], v[156:159], v[100:103]
  v_mfma_f32_16x16x32_bf16 v[104:107], v[148:151], v[160:163], v[104:107]
  v_mfma_f32_16x16x32_bf16 v[108:111], v[152:155], v[160:163], v[108:111]
  v_mfma_f32_16x16x32_bf16 v[112:115], v[148:151], v[164:167], v[112:115]
  v_mfma_f32_16x16x32_bf16 v[116:119], v[152:155], v[164:167], v[116:119]
  ds_read_b128 v[148:151], v35 offset:256
  ds_read_b128 v[152:155], v35 offset:2304
  ds_read_b128 v[156:159], v39 offset:256
  ds_read_b128 v[160:163], v39 offset:8448
  ds_read_b128 v[164:167], v39 offset:16640
  s_waitcnt lgkmcnt(10)
  v_mfma_f32_16x16x32_bf16 v[96:99], v[168:171], v[176:179], v[96:99]
  v_mfma_f32_16x16x32_bf16 v[100:103], v[172:175], v[176:179], v[100:103]
  v_mfma_f32_16x16x32_bf16 v[104:107], v[168:171], v[180:183], v[104:107]
  v_mfma_f32_16x16x32_bf16 v[108:111], v[172:175], v[180:183], v[108:111]
  v_mfma_f32_16x16x32_bf16 v[112:115], v[168:171], v[184:187], v[112:115]
  v_mfma_f32_16x16x32_bf16 v[116:119], v[172:175], v[184:187], v[116:119]
  s_waitcnt lgkmcnt(5)
  v_mfma_f32_16x16x32_bf16 v[96:99], v[128:131], v[136:139], v[96:99]
  v_mfma_f32_16x16x32_bf16 v[100:103], v[132:135], v[136:139], v[100:103]
  v_mfma_f32_16x16x32_bf16 v[104:107], v[128:131], v[140:143], v[104:107]
  v_mfma_f32_16x16x32_bf16 v[108:111], v[132:135], v[140:143], v[108:111]
  v_mfma_f32_16x16x32_bf16 v[112:115], v[128:131], v[144:147], v[112:115]
  v_mfma_f32_16x16x32_bf16 v[116:119], v[132:135], v[144:147], v[116:119]
  s_waitcnt lgkmcnt(0)
  v_mfma_f32_16x16x32_bf16 v[96:99], v[148:151], v[156:159], v[96:99]
  v_mfma_f32_16x16x32_bf16 v[100:103], v[152:155], v[156:159], v[100:103]
  v_mfma_f32_16x16x32_bf16 v[104:107], v[148:151], v[160:163], v[104:107]
  v_mfma_f32_16x16x32_bf16 v[108:111], v[152:155], v[160:163], v[108:111]
  v_mfma_f32_16x16x32_bf16 v[112:115], v[148:151], v[164:167], v[112:115]
  v_mfma_f32_16x16x32_bf16 v[116:119], v[152:155], v[164:167], v[116:119]
  v_mul_f32 v96, s24, v96
  v_mul_f32 v97, s24, v97
  v_mul_f32 v98, s24, v98
  v_mul_f32 v99, s24, v99
  v_mul_f32 v100, s24, v100
  v_mul_f32 v101, s24, v101
  v_mul_f32 v102, s24, v102
  v_mul_f32 v103, s24, v103
  v_cvt_pk_bf16_f32 v68, v96, v97
  v_cvt_pk_bf16_f32 v69, v98, v99
  v_cvt_pk_bf16_f32 v70, v100, v101
  v_cvt_pk_bf16_f32 v71, v102, v103
  s_add_u32 s20, s30, 229376
  buffer_store_dwordx4 v[68:71], v2, s[8:11], s20 offen sc1
  v_mul_f32 v104, s24, v104
  v_mul_f32 v105, s24, v105
  v_mul_f32 v106, s24, v106
  v_mul_f32 v107, s24, v107
  v_mul_f32 v108, s24, v108
  v_mul_f32 v109, s24, v109
  v_mul_f32 v110, s24, v110
  v_mul_f32 v111, s24, v111
  v_cvt_pk_bf16_f32 v72, v104, v105
  v_cvt_pk_bf16_f32 v73, v106, v107
  v_cvt_pk_bf16_f32 v74, v108, v109
  v_cvt_pk_bf16_f32 v75, v110, v111
  s_add_u32 s20, s30, 286720
  buffer_store_dwordx4 v[72:75], v2, s[8:11], s20 offen sc1
  v_mul_f32 v112, s24, v112
  v_mul_f32 v113, s24, v113
  v_mul_f32 v114, s24, v114
  v_mul_f32 v115, s24, v115
  v_mul_f32 v116, s24, v116
  v_mul_f32 v117, s24, v117
  v_mul_f32 v118, s24, v118
  v_mul_f32 v119, s24, v119
  v_cvt_pk_bf16_f32 v76, v112, v113
  v_cvt_pk_bf16_f32 v77, v114, v115
  v_cvt_pk_bf16_f32 v78, v116, v117
  v_cvt_pk_bf16_f32 v79, v118, v119
  s_add_u32 s20, s30, 344064
  buffer_store_dwordx4 v[76:79], v2, s[8:11], s20 offen sc1
  s_waitcnt vmcnt(0)
  s_barrier
  s_cmp_lg_u32 s16, 0
  s_cbranch_scc1 pub_34
  v_mul_u32_u24 v26, 2048, v1
  v_mov_b32 v24, s88
  v_mov_b32 v25, s89
  s_mov_b64 exec, 1
  buffer_store_dwordx2 v[24:25], v26, s[8:11], s28 offen sc1
  s_mov_b64 exec, -1
pub_34:
  v_mov_b32 v6, 160000
  s_add_u32 s101, s101, 1
  s_barrier
  s_mov_b64 exec, 1
  s_cmp_lg_u32 s16, 0
  s_cbranch_scc1 w0_35
  ds_write_b32 v6, v250 offset:0
  s_waitcnt lgkmcnt(0)
  v_mov_b32 v250, s101
  ds_write_b32 v6, v250 offset:16
  s_waitcnt lgkmcnt(0)
w0_35:
  s_mov_b64 exec, -1
  s_barrier
  ds_read_b32 v250, v6 offset:0
  ds_read_b32 v6, v6 offset:16
  s_waitcnt lgkmcnt(0)
  v_readfirstlane_b32 s3, v250
  v_cmp_ne_u32 vcc, s101, v6
  s_cbranch_vccnz ch_end
  s_branch wk_have
wk_loop:
  s_waitcnt vmcnt(0) lgkmcnt(0)
  s_cmp_eq_u32 s96, 1
  s_cbranch_scc1 wk_ask
  s_mov_b32 s96, 1
  s_cmp_lg_u32 s16, 0
  s_cbranch_scc1 w0_36
  s_mov_b32 s30, 0
  v_mov_b32 v243, 32
sf_l:
  buffer_load_dword v242, v243, s[12:15], 0 offen sc1
  s_waitcnt vmcnt(0)
  v_readfirstlane_b32 s70, v242
  s_cmp_eq_u32 s70, -1
  s_cbranch_scc1 sf_d
  s_sleep 16
  s_add_u32 s30, s30, 1
  s_cmp_lt_u32 s30, 64
  s_cbranch_scc1 sf_l
  s_mov_b32 s20, 0
  s_mov_b32 s21, 0
  s_mov_b64 exec, 1
sf_c_l:
  s_cmp_lg_u32 s70, -1
  s_cbranch_scc1 sf_c_t
  s_add_u32 s20, s20, 1
  s_cmp_lt_u32 s20, 8
  s_cselect_b32 s20, s20, 0
  s_mov_b32 s70, 0
  s_mov_b32 s3, -1
  s_add_u32 s21, s21, 1
  s_cmp_ge_u32 s21, 1
  s_cbranch_scc1 sf_c_d
sf_c_t:
  s_ff0_i32_b32 s22, s70
  s_lshl_b32 s23, 1, s22
  s_and_b32 s71, s20, 4
  s_mul_i32 s71, s71, 12
  s_lshl_b32 s3, s20, 2
  s_add_u32 s3, s3, s71
  v_mov_b32 v242, s23
  v_mov_b32 v243, 32
  buffer_atomic_or v242, v243, s[12:15], s3 offen sc0
  s_waitcnt vmcnt(0)
  v_readfirstlane_b32 s70, v242
  s_lshl_b32 s3, s20, 5
  s_add_u32 s3, s3, s22
  s_bitcmp1_b32 s70, s22
  s_cbranch_scc1 sf_c_l
sf_c_d:
  s_mov_b64 exec, -1
  v_mov_b32 v242, s3
sf_d:
w0_36:
  v_mov_b32 v243, 160000
  s_add_u32 s101, s101, 1
  s_barrier
  s_mov_b64 exec, 1
  s_cmp_lg_u32 s16, 0
  s_cbranch_scc1 w0_37
  ds_write_b32 v243, v242 offset:0
  s_waitcnt lgkmcnt(0)
  v_mov_b32 v242, s101
  ds_write_b32 v243, v242 offset:16
  s_waitcnt lgkmcnt(0)
w0_37:
  s_mov_b64 exec, -1
  s_barrier
  ds_read_b32 v242, v243 offset:0
  ds_read_b32 v243, v243 offset:16
  s_waitcnt lgkmcnt(0)
  v_readfirstlane_b32 s3, v242
  v_cmp_ne_u32 vcc, s101, v243
  s_cbranch_vccnz ch_end
  s_cmp_eq_u32 s3, -1
  s_cbranch_scc1 wk_ask
  s_load_dwordx8 s[36:43], s[0:1], 56
  s_load_dwordx4 s[44:47], s[0:1], 88
  s_getreg_b32 s67, hwreg(HW_REG_XCC_ID)
  s_and_b32 s67, s67, 7
  s_mov_b32 s66, 1
  s_waitcnt lgkmcnt(0)
  s_branch m_start
wk_ask:
  v_readfirstlane_b32 s22, v250
  s_cmp_ge_u32 s22, 1440
  s_cbranch_scc1 wk_next
  s_cmp_lg_u32 s16, 0
  s_cbranch_scc1 w0_38
  v_mov_b32 v250, 1
  v_mov_b32 v251, 192
  s_mov_b64 exec, 1
  buffer_atomic_add v250, v251, s[12:15], 0 offen sc0
  s_mov_b64 exec, -1
w0_38:
wk_next:
  s_waitcnt vmcnt(0)
  v_mov_b32 v6, 160000
  s_add_u32 s101, s101, 1
  s_barrier
  s_mov_b64 exec, 1
  s_cmp_lg_u32 s16, 0
  s_cbranch_scc1 w0_39
  ds_write_b32 v6, v250 offset:0
  s_waitcnt lgkmcnt(0)
  v_mov_b32 v250, s101
  ds_write_b32 v6, v250 offset:16
  s_waitcnt lgkmcnt(0)
w0_39:
  s_mov_b64 exec, -1
  s_barrier
  ds_read_b32 v250, v6 offset:0
  ds_read_b32 v6, v6 offset:16
  s_waitcnt lgkmcnt(0)
  v_readfirstlane_b32 s3, v250
  v_cmp_ne_u32 vcc, s101, v6
  s_cbranch_vccnz ch_end
wk_have:
  s_cmp_ge_u32 s3, 1440
  s_cbranch_scc1 ch_end
  v_mov_b32 v250, 0
  v_mov_b32 v251, 192
  v_and_b32 v1, 63, v0
  v_lshlrev_b32 v2, 4, v1
  v_lshrrev_b32 v3, 4, v1
  v_and_b32 v4, 15, v1
  s_cmp_lg_u32 s97, 0
  s_cbranch_scc1 wk_go
  s_mov_b32 s68, s3
  s_mov_b32 s69, 1
  s_cmp_lg_u32 s16, 0
  s_cbranch_scc1 w0_40
  s_add_u32 s20, s67, 1
  s_lshl_b32 s22, s20, 11
  s_add_u32 s22, s22, 88602624
  v_add_u32 v24, 1024, v2
  v_min_u32 v24, 1776, v24
  s_mov_b32 s30, 0
wk_af:
  buffer_load_dwordx4 v[28:31], v2, s[8:11], s22 offen sc1
  buffer_load_dwordx4 v[32:35], v24, s[8:11], s22 offen sc1
  s_waitcnt vmcnt(0)
  v_cmp_ne_u64 vcc, s[88:89], v[28:29]
  s_cbranch_vccnz wk_af_no
  v_cmp_ne_u64 vcc, s[88:89], v[30:31]
  s_cbranch_vccnz wk_af_no
  v_cmp_ne_u64 vcc, s[88:89], v[32:33]
  s_cbranch_vccnz wk_af_no
  v_cmp_ne_u64 vcc, s[88:89], v[34:35]
  s_cbranch_vccnz wk_af_no
  s_branch wk_af_ok
wk_af_no:
  s_sleep 4
  s_add_u32 s30, s30, 1
  s_and_b32 s20, s30, 63
  s_cbranch_scc1 wk_ns
  s_mov_b32 s20, 1
  s_mov_b32 s70, 0
  s_mov_b32 s21, 0
  s_mov_b64 exec, 1
wk_st_l:
  s_cmp_lg_u32 s70, -1
  s_cbranch_scc1 wk_st_t
  s_add_u32 s20, s20, 1
  s_cmp_lt_u32 s20, 8
  s_cselect_b32 s20, s20, 1
  s_mov_b32 s70, 0
  s_mov_b32 s3, -1
  s_add_u32 s21, s21, 1
  s_cmp_ge_u32 s21, 7
  s_cbranch_scc1 wk_st_d
wk_st_t:
  s_ff0_i32_b32 s22, s70
  s_lshl_b32 s23, 1, s22
  s_and_b32 s71, s20, 4
  s_mul_i32 s71, s71, 12
  s_lshl_b32 s3, s20, 2
  s_add_u32 s3, s3, s71
  v_mov_b32 v242, s23
  v_mov_b32 v243, 32
  buffer_atomic_or v242, v243, s[12:15], s3 offen sc0
  s_waitcnt vmcnt(0)
  v_readfirstlane_b32 s70, v242
  s_lshl_b32 s3, s20, 5
  s_add_u32 s3, s3, s22
  s_bitcmp1_b32 s70, s22
  s_cbranch_scc1 wk_st_l
wk_st_d:
  s_mov_b64 exec, -1
  v_mov_b32 v242, s3
  s_cmp_lg_u32 s3, -1
  s_cbranch_scc1 wk_pd
  s_add_u32 s20, s67, 1
  s_lshl_b32 s22, s20, 11
  s_add_u32 s22, s22, 88602624
wk_ns:
  s_cmp_lt_u32 s30, 50000
  s_cbranch_scc1 wk_af
  s_branch cA_abort
wk_af_ok:
  v_mov_b32 v242, -1
wk_pd:
w0_40:
  v_mov_b32 v243, 160000
  s_add_u32 s101, s101, 1
  s_barrier
  s_mov_b64 exec, 1
  s_cmp_lg_u32 s16, 0
  s_cbranch_scc1 w0_41
  ds_write_b32 v243, v242 offset:0
  s_waitcnt lgkmcnt(0)
  v_mov_b32 v242, s101
  ds_write_b32 v243, v242 offset:16
  s_waitcnt lgkmcnt(0)
w0_41:
  s_mov_b64 exec, -1
  s_barrier
  ds_read_b32 v242, v243 offset:0
  ds_read_b32 v243, v243 offset:16
  s_waitcnt lgkmcnt(0)
  v_readfirstlane_b32 s3, v242
  v_cmp_ne_u32 vcc, s101, v243
  s_cbranch_vccnz ch_end
  s_cmp_lg_u32 s3, -1
  s_cbranch_scc1 m_bjob
  s_mov_b32 s3, s68
  s_mov_b32 s97, 1
wk_go:
  s_cmp_lt_u32 s3, 368
  s_cbranch_scc1 wk_g2
  s_sub_u32 s20, s3, 432
  s_cmp_lt_u32 s20, 128
  s_cbranch_scc1 wk_g2
  s_cmp_eq_u32 s97, 2
  s_cbranch_scc1 wk_g2
  s_getreg_b32 s20, hwreg(HW_REG_XCC_ID)
  s_and_b32 s20, s20, 7
  s_cmp_lg_u32 s16, 0
  s_cbranch_scc1 w0_42
  s_lshl_b32 s22, s20, 11
  s_add_u32 s22, s22, 88637440
  v_add_u32 v24, 1024, v2
  v_min_u32 v24, 1776, v24
  s_mov_b32 s30, 0
wk_i2:
  buffer_load_dwordx4 v[28:31], v2, s[8:11], s22 offen sc1
  buffer_load_dwordx4 v[32:35], v24, s[8:11], s22 offen sc1
  s_waitcnt vmcnt(0)
  v_cmp_ne_u64 vcc, s[88:89], v[28:29]
  s_cbranch_vccnz wk_i2_no
  v_cmp_ne_u64 vcc, s[88:89], v[30:31]
  s_cbranch_vccnz wk_i2_no
  v_cmp_ne_u64 vcc, s[88:89], v[32:33]
  s_cbranch_vccnz wk_i2_no
  v_cmp_ne_u64 vcc, s[88:89], v[34:35]
  s_cbranch_vccnz wk_i2_no
  s_branch wk_i2_ok
wk_i2_no:
  s_sleep 4
  s_add_u32 s30, s30, 1
  s_cmp_lt_u32 s30, 50000
  s_cbranch_scc1 wk_i2
  s_branch cA_abort
wk_i2_ok:
w0_42:
  v_mov_b32 v242, 0
  v_mov_b32 v243, 160000
  s_add_u32 s101, s101, 1
  s_barrier
  s_mov_b64 exec, 1
  s_cmp_lg_u32 s16, 0
  s_cbranch_scc1 w0_43
  ds_write_b32 v243, v242 offset:0
  s_waitcnt lgkmcnt(0)
  v_mov_b32 v242, s101
  ds_write_b32 v243, v242 offset:16
  s_waitcnt lgkmcnt(0)
w0_43:
  s_mov_b64 exec, -1
  s_barrier
  ds_read_b32 v242, v243 offset:0
  ds_read_b32 v243, v243 offset:16
  s_waitcnt lgkmcnt(0)
  v_readfirstlane_b32 s20, v242
  v_cmp_ne_u32 vcc, s101, v243
  s_cbranch_vccnz ch_end
  s_mov_b32 s97, 2
wk_g2:
  s_cmp_ge_u32 s3, 864
  s_cbranch_scc1 wk_tok
  s_cmp_ge_u32 s3, 752
  s_cbranch_scc1 wk_s4d
  s_cmp_ge_u32 s3, 624
  s_cbranch_scc1 wk_f
  s_cmp_ge_u32 s3, 560
  s_cbranch_scc1 wk_vf
  s_cmp_ge_u32 s3, 432
  s_cbranch_scc1 wk_a
  s_cmp_ge_u32 s3, 368
  s_cbranch_scc1 wk_vh
  s_cmp_ge_u32 s3, 256
  s_cbranch_scc1 wk_v7
  s_cmp_ge_u32 s3, 224
  s_cbranch_scc1 wk_srv
  s_sub_u32 s20, s3, 0
  s_cmp_ge_u32 s20, 112
  s_cselect_b32 s18, 1, 0
  s_cselect_b32 s21, 112, 0
  s_sub_u32 s20, s20, s21
  s_and_b32 s17, s20, 15
  s_add_u32 s17, s17, 16
  s_lshr_b32 s34, s20, 4
  s_lshl_b32 s34, s34, 1
  s_add_u32 s35, s34, 2
  s_cmp_eq_u32 s18, 0
  s_cbranch_scc1 wf_nw
  s_and_b32 s20, s3, 3
  s_lshl_b32 s20, s20, 3
  s_add_u32 s20, s20, 8
  s_cmp_eq_u32 s16, 0
  s_cselect_b32 s20, 0, s20
  s_cmp_ge_u32 s16, 2
  s_cselect_b32 s20, 112, s20
  s_load_dwordx2 s[72:73], s[0:1], s20
  s_lshr_b32 s21, s3, 2
  s_lshl_b32 s21, s21, 12
  s_mov_b32 s74, 229376
  s_lshl_b32 s22, s3, 13
  s_cmp_eq_u32 s16, 0
  s_cselect_b32 s21, s22, s21
  s_cselect_b32 s74, 1835008, s74
  s_lshl_b32 s22, s3, 1
  s_add_u32 s22, s22, s16
  s_sub_u32 s22, s22, 2
  s_lshl_b32 s22, s22, 13
  s_cmp_ge_u32 s16, 2
  s_cselect_b32 s21, s22, s21
  s_cselect_b32 s74, 3670016, s74
  v_lshlrev_b32 v6, 3, v2
  s_cmp_lt_u32 s16, 2
  s_cbranch_scc1 lw_44
  s_lshl_b32 s21, s3, 6
  v_add_u32 v6, s21, v1
  v_mul_u32_u24 v7, 37450, v6
  v_lshrrev_b32 v7, 18, v7
  v_add_u32 v7, 1, v7
  v_mul_u32_u24 v7, 7, v7
  v_add_u32 v6, v6, v7
  v_lshlrev_b32 v6, 7, v6
  s_mov_b32 s21, 0
  s_cmp_eq_u32 s16, 3
  s_cselect_b32 s74, 0, s74
lw_44:
  s_cmp_eq_u32 s16, 1
  s_cselect_b32 exec_hi, 0, -1
  s_waitcnt lgkmcnt(0)
  s_and_b32 s73, s73, 0xffff
  s_mov_b32 s75, 0x20000
  buffer_load_dword v7, v6, s[72:75], s21 offen
  s_mov_b64 exec, -1
  s_sub_u32 s3, s3, 112
  s_and_b32 s20, s3, 3
  s_lshl_b32 s20, s20, 3
  s_add_u32 s20, s20, 8
  s_cmp_eq_u32 s16, 0
  s_cselect_b32 s20, 0, s20
  s_cmp_ge_u32 s16, 2
  s_cselect_b32 s20, 112, s20
  s_load_dwordx2 s[72:73], s[0:1], s20
  s_lshr_b32 s21, s3, 2
  s_lshl_b32 s21, s21, 12
  s_mov_b32 s74, 229376
  s_lshl_b32 s22, s3, 13
  s_cmp_eq_u32 s16, 0
  s_cselect_b32 s21, s22, s21
  s_cselect_b32 s74, 1835008, s74
  s_lshl_b32 s22, s3, 1
  s_add_u32 s22, s22, s16
  s_sub_u32 s22, s22, 2
  s_lshl_b32 s22, s22, 13
  s_cmp_ge_u32 s16, 2
  s_cselect_b32 s21, s22, s21
  s_cselect_b32 s74, 3670016, s74
  v_lshlrev_b32 v6, 3, v2
  s_cmp_lt_u32 s16, 2
  s_cbranch_scc1 lw_45
  s_lshl_b32 s21, s3, 6
  v_add_u32 v6, s21, v1
  v_mul_u32_u24 v7, 37450, v6
  v_lshrrev_b32 v7, 18, v7
  v_add_u32 v7, 1, v7
  v_mul_u32_u24 v7, 7, v7
  v_add_u32 v6, v6, v7
  v_lshlrev_b32 v6, 7, v6
  s_mov_b32 s21, 0
  s_cmp_eq_u32 s16, 3
  s_cselect_b32 s74, 0, s74
lw_45:
  s_cmp_eq_u32 s16, 1
  s_cselect_b32 exec_hi, 0, -1
  s_waitcnt lgkmcnt(0)
  s_and_b32 s73, s73, 0xffff
  s_mov_b32 s75, 0x20000
  buffer_load_dword v7, v6, s[72:75], s21 offen
  s_mov_b64 exec, -1
  s_add_u32 s3, s3, 112
wf_nw:
  s_lshl_b32 s20, s18, 3
  s_lshl_b32 s21, s16, 1
  s_add_u32 s20, s20, s21
  s_mul_i32 s21, s20, 14336
  s_add_u32 s21, s21, 71565312
  s_add_u32 s22, s21, 0
  buffer_load_dwordx4 a[0:3], v2, s[8:11], s22 offen offset:0 sc1
  buffer_load_dwordx4 a[4:7], v2, s[8:11], s22 offen offset:1024 sc1
  buffer_load_dwordx4 a[8:11], v2, s[8:11], s22 offen offset:2048 sc1
  buffer_load_dwordx4 a[12:15], v2, s[8:11], s22 offen offset:3072 sc1
  s_add_u32 s22, s21, 4096
  buffer_load_dwordx4 a[16:19], v2, s[8:11], s22 offen offset:0 sc1
  buffer_load_dwordx4 a[20:23], v2, s[8:11], s22 offen offset:1024 sc1
  buffer_load_dwordx4 a[24:27], v2, s[8:11], s22 offen offset:2048 sc1
  buffer_load_dwordx4 a[28:31], v2, s[8:11], s22 offen offset:3072 sc1
  s_add_u32 s22, s21, 8192
  buffer_load_dwordx4 a[32:35], v2, s[8:11], s22 offen offset:0 sc1
  buffer_load_dwordx4 a[36:39], v2, s[8:11], s22 offen offset:1024 sc1
  buffer_load_dwordx4 a[40:43], v2, s[8:11], s22 offen offset:2048 sc1
  buffer_load_dwordx4 a[44:47], v2, s[8:11], s22 offen offset:3072 sc1
  s_add_u32 s22, s21, 12288
  buffer_load_dwordx4 a[48:51], v2, s[8:11], s22 offen offset:0 sc1
  buffer_load_dwordx4 a[52:55], v2, s[8:11], s22 offen offset:1024 sc1
  buffer_load_dwordx4 a[56:59], v2, s[8:11], s22 offen offset:2048 sc1
  buffer_load_dwordx4 a[60:63], v2, s[8:11], s22 offen offset:3072 sc1
  s_add_u32 s22, s21, 16384
  buffer_load_dwordx4 a[64:67], v2, s[8:11], s22 offen offset:0 sc1
  buffer_load_dwordx4 a[68:71], v2, s[8:11], s22 offen offset:1024 sc1
  buffer_load_dwordx4 a[72:75], v2, s[8:11], s22 offen offset:2048 sc1
  buffer_load_dwordx4 a[76:79], v2, s[8:11], s22 offen offset:3072 sc1
  s_add_u32 s22, s21, 20480
  buffer_load_dwordx4 a[80:83], v2, s[8:11], s22 offen offset:0 sc1
  buffer_load_dwordx4 a[84:87], v2, s[8:11], s22 offen offset:1024 sc1
  buffer_load_dwordx4 a[88:91], v2, s[8:11], s22 offen offset:2048 sc1
  buffer_load_dwordx4 a[92:95], v2, s[8:11], s22 offen offset:3072 sc1
  s_add_u32 s22, s21, 24576
  buffer_load_dwordx4 a[96:99], v2, s[8:11], s22 offen offset:0 sc1
  buffer_load_dwordx4 a[100:103], v2, s[8:11], s22 offen offset:1024 sc1
  buffer_load_dwordx4 a[104:107], v2, s[8:11], s22 offen offset:2048 sc1
  buffer_load_dwordx4 a[108:111], v2, s[8:11], s22 offen offset:3072 sc1
  s_waitcnt vmcnt(40)
  s_mul_i32 s23, s17, 401408
  s_and_b32 s22, s16, 1
  s_mul_i32 s22, s22, 7168
  s_add_u32 s23, s23, s22
  s_add_u32 s23, s23, 0
  s_lshr_b32 s22, s16, 1
  s_mul_i32 s22, s22, 14336
  s_add_u32 s23, s23, s22
  s_mul_i32 s27, s16, 7168
  s_lshr_b32 s28, s20, 1
wf_vo:
  s_sub_u32 s29, s17, 16
  s_lshl_b32 s29, s29, 6
  s_add_u32 s29, s29, s28
  s_mul_i32 s29, s29, 28672
  s_add_u32 s29, s29, 42205184
  v_lshlrev_b32 v6, 4, v3
  v_mad_u32_u24 v7, v3, 12, 64
  s_mov_b32 s31, 0
  s_lshl_b32 s24, s34, 1
  s_mul_i32 s24, s24, 14336
  s_add_u32 s24, s24, s23
  s_cmp_lt_u32 s34, s35
  s_cselect_b32 s24, s24, 0x10000000
  s_add_u32 m0, s31, s27
  s_nop 0
  buffer_load_dwordx4 v2, s[8:11], s24 offen offset:0 sc1 lds
  buffer_load_dwordx4 v2, s[8:11], s24 offen offset:1024 sc1 lds
  buffer_load_dwordx4 v2, s[8:11], s24 offen offset:2048 sc1 lds
  buffer_load_dwordx4 v2, s[8:11], s24 offen offset:3072 sc1 lds
  s_add_u32 m0, m0, 4096
  s_add_u32 s24, s24, 4096
  buffer_load_dwordx4 v2, s[8:11], s24 offen offset:0 sc1 lds
  buffer_load_dwordx4 v2, s[8:11], s24 offen offset:1024 sc1 lds
  buffer_load_dwordx4 v2, s[8:11], s24 offen offset:2048 sc1 lds
  s_add_u32 s30, s34, 1
  s_mov_b32 s31, 28672
  s_lshl_b32 s24, s30, 1
  s_mul_i32 s24, s24, 14336
  s_add_u32 s24, s24, s23
  s_cmp_lt_u32 s30, s35
  s_cselect_b32 s24, s24, 0x10000000
  s_add_u32 m0, s31, s27
  s_nop 0
  buffer_load_dwordx4 v2, s[8:11], s24 offen offset:0 sc1 lds
  buffer_load_dwordx4 v2, s[8:11], s24 offen offset:1024 sc1 lds
  buffer_load_dwordx4 v2, s[8:11], s24 offen offset:2048 sc1 lds
  buffer_load_dwordx4 v2, s[8:11], s24 offen offset:3072 sc1 lds
  s_add_u32 m0, m0, 4096
  s_add_u32 s24, s24, 4096
  buffer_load_dwordx4 v2, s[8:11], s24 offen offset:0 sc1 lds
  buffer_load_dwordx4 v2, s[8:11], s24 offen offset:1024 sc1 lds
  buffer_load_dwordx4 v2, s[8:11], s24 offen offset:2048 sc1 lds
  s_mov_b32 s19, s34
  s_mov_b32 s32, 0
  s_mov_b32 s33, 57344
  s_waitcnt vmcnt(7)
  s_branch wf_vo_in
wf_vo_loop:
  s_waitcnt vmcnt(9)
wf_vo_in:
  s_barrier
  s_add_u32 s30, s19, 2
  s_lshl_b32 s24, s30, 1
  s_mul_i32 s24, s24, 14336
  s_add_u32 s24, s24, s23
  s_cmp_lt_u32 s30, s35
  s_cselect_b32 s24, s24, 0x10000000
  s_add_u32 m0, s33, s27
  s_nop 0
  buffer_load_dwordx4 v2, s[8:11], s24 offen offset:0 sc1 lds
  buffer_load_dwordx4 v2, s[8:11], s24 offen offset:1024 sc1 lds
  buffer_load_dwordx4 v2, s[8:11], s24 offen offset:2048 sc1 lds
  buffer_load_dwordx4 v2, s[8:11], s24 offen offset:3072 sc1 lds
  s_add_u32 m0, m0, 4096
  s_add_u32 s24, s24, 4096
  buffer_load_dwordx4 v2, s[8:11], s24 offen offset:0 sc1 lds
  buffer_load_dwordx4 v2, s[8:11], s24 offen offset:1024 sc1 lds
  buffer_load_dwordx4 v2, s[8:11], s24 offen offset:2048 sc1 lds
  v_add_u32 v5, s32, v2
  ds_read_b128 v[8:11], v5 offset:0
  ds_read_b128 v[12:15], v5 offset:14336
  ds_read_b128 v[16:19], v5 offset:1024
  ds_read_b128 v[20:23], v5 offset:15360
  ds_read_b128 v[24:27], v5 offset:2048
  ds_read_b128 v[28:31], v5 offset:16384
  ds_read_b128 v[32:35], v5 offset:3072
  s_waitcnt lgkmcnt(6)
  v_mfma_f32_16x16x32_bf16 v[40:43], a[0:3], v[8:11], 0
  v_mfma_f32_16x16x32_bf16 v[44:47], a[56:59], v[8:11], 0
  ds_read_b128 v[36:39], v5 offset:17408
  s_waitcnt lgkmcnt(6)
  v_mfma_f32_16x16x32_bf16 v[56:59], a[0:3], v[12:15], 0
  v_mfma_f32_16x16x32_bf16 v[60:63], a[56:59], v[12:15], 0
  ds_read_b128 v[8:11], v5 offset:4096
  s_waitcnt lgkmcnt(6)
  v_mfma_f32_16x16x32_bf16 v[40:43], a[4:7], v[16:19], v[40:43]
  v_mfma_f32_16x16x32_bf16 v[44:47], a[60:63], v[16:19], v[44:47]
  ds_read_b128 v[12:15], v5 offset:18432
  s_waitcnt lgkmcnt(6)
  v_mfma_f32_16x16x32_bf16 v[56:59], a[4:7], v[20:23], v[56:59]
  v_mfma_f32_16x16x32_bf16 v[60:63], a[60:63], v[20:23], v[60:63]
  ds_read_b128 v[16:19], v5 offset:5120
  s_waitcnt lgkmcnt(6)
  v_mfma_f32_16x16x32_bf16 v[40:43], a[8:11], v[24:27], v[40:43]
  v_mfma_f32_16x16x32_bf16 v[44:47], a[64:67], v[24:27], v[44:47]
  ds_read_b128 v[20:23], v5 offset:19456
  s_waitcnt lgkmcnt(6)
  v_mfma_f32_16x16x32_bf16 v[56:59], a[8:11], v[28:31], v[56:59]
  v_mfma_f32_16x16x32_bf16 v[60:63], a[64:67], v[28:31], v[60:63]
  ds_read_b128 v[24:27], v5 offset:6144
  s_waitcnt lgkmcnt(6)
  v_mfma_f32_16x16x32_bf16 v[40:43], a[12:15], v[32:35], v[40:43]
  v_mfma_f32_16x16x32_bf16 v[44:47], a[68:71], v[32:35], v[44:47]
  ds_read_b128 v[28:31], v5 offset:20480
  s_waitcnt lgkmcnt(6)
  v_mfma_f32_16x16x32_bf16 v[56:59], a[12:15], v[36:39], v[56:59]
  v_mfma_f32_16x16x32_bf16 v[60:63], a[68:71], v[36:39], v[60:63]
  ds_read_b128 v[32:35], v5 offset:7168
  s_waitcnt lgkmcnt(6)
  v_mfma_f32_16x16x32_bf16 v[40:43], a[16:19], v[8:11], v[40:43]
  v_mfma_f32_16x16x32_bf16 v[44:47], a[72:75], v[8:11], v[44:47]
  ds_read_b128 v[36:39], v5 offset:21504
  s_waitcnt lgkmcnt(6)
  v_mfma_f32_16x16x32_bf16 v[56:59], a[16:19], v[12:15], v[56:59]
  v_mfma_f32_16x16x32_bf16 v[60:63], a[72:75], v[12:15], v[60:63]
  ds_read_b128 v[8:11], v5 offset:8192
  s_waitcnt lgkmcnt(6)
  v_mfma_f32_16x16x32_bf16 v[40:43], a[20:23], v[16:19], v[40:43]
  v_mfma_f32_16x16x32_bf16 v[44:47], a[76:79], v[16:19], v[44:47]
  ds_read_b128 v[12:15], v5 offset:22528
  s_waitcnt lgkmcnt(6)
  v_mfma_f32_16x16x32_bf16 v[56:59], a[20:23], v[20:23], v[56:59]
  v_mfma_f32_16x16x32_bf16 v[60:63], a[76:79], v[20:23], v[60:63]
  ds_read_b128 v[16:19], v5 offset:9216
  s_waitcnt lgkmcnt(6)
  v_mfma_f32_16x16x32_bf16 v[40:43], a[24:27], v[24:27], v[40:43]
  v_mfma_f32_16x16x32_bf16 v[44:47], a[80:83], v[24:27], v[44:47]
  ds_read_b128 v[20:23], v5 offset:23552
  s_waitcnt lgkmcnt(6)
  v_mfma_f32_16x16x32_bf16 v[56:59], a[24:27], v[28:31], v[56:59]
  v_mfma_f32_16x16x32_bf16 v[60:63], a[80:83], v[28:31], v[60:63]
  ds_read_b128 v[24:27], v5 offset:10240
  s_waitcnt lgkmcnt(6)
  v_mfma_f32_16x16x32_bf16 v[40:43], a[28:31], v[32:35], v[40:43]
  v_mfma_f32_16x16x32_bf16 v[44:47], a[84:87], v[32:35], v[44:47]
  ds_read_b128 v[28:31], v5 offset:24576
  s_waitcnt lgkmcnt(6)
  v_mfma_f32_16x16x32_bf16 v[56:59], a[28:31], v[36:39], v[56:59]
  v_mfma_f32_16x16x32_bf16 v[60:63], a[84:87], v[36:39], v[60:63]
  ds_read_b128 v[32:35], v5 offset:11264
  s_waitcnt lgkmcnt(6)
  v_mfma_f32_16x16x32_bf16 v[40:43], a[32:35], v[8:11], v[40:43]
  v_mfma_f32_16x16x32_bf16 v[44:47], a[88:91], v[8:11], v[44:47]
  ds_read_b128 v[36:39], v5 offset:25600
  s_waitcnt lgkmcnt(6)
  v_mfma_f32_16x16x32_bf16 v[56:59], a[32:35], v[12:15], v[56:59]
  v_mfma_f32_16x16x32_bf16 v[60:63], a[88:91], v[12:15], v[60:63]
  ds_read_b128 v[8:11], v5 offset:12288
  s_waitcnt lgkmcnt(6)
  v_mfma_f32_16x16x32_bf16 v[40:43], a[36:39], v[16:19], v[40:43]
  v_mfma_f32_16x16x32_bf16 v[44:47], a[92:95], v[16:19], v[44:47]
  ds_read_b128 v[12:15], v5 offset:26624
  s_waitcnt lgkmcnt(6)
  v_mfma_f32_16x16x32_bf16 v[56:59], a[36:39], v[20:23], v[56:59]
  v_mfma_f32_16x16x32_bf16 v[60:63], a[92:95], v[20:23], v[60:63]
  ds_read_b128 v[16:19], v5 offset:13312
  s_waitcnt lgkmcnt(6)
  v_mfma_f32_16x16x32_bf16 v[40:43], a[40:43], v[24:27], v[40:43]
  v_mfma_f32_16x16x32_bf16 v[44:47], a[96:99], v[24:27], v[44:47]
  ds_read_b128 v[20:23], v5 offset:27648
  s_waitcnt lgkmcnt(6)
  v_mfma_f32_16x16x32_bf16 v[56:59], a[40:43], v[28:31], v[56:59]
  v_mfma_f32_16x16x32_bf16 v[60:63], a[96:99], v[28:31], v[60:63]
  s_waitcnt lgkmcnt(5)
  v_mfma_f32_16x16x32_bf16 v[40:43], a[44:47], v[32:35], v[40:43]
  v_mfma_f32_16x16x32_bf16 v[44:47], a[100:103], v[32:35], v[44:47]
  s_waitcnt lgkmcnt(4)
  v_mfma_f32_16x16x32_bf16 v[56:59], a[44:47], v[36:39], v[56:59]
  v_mfma_f32_16x16x32_bf16 v[60:63], a[100:103], v[36:39], v[60:63]
  s_waitcnt lgkmcnt(3)
  v_mfma_f32_16x16x32_bf16 v[40:43], a[48:51], v[8:11], v[40:43]
  v_mfma_f32_16x16x32_bf16 v[44:47], a[104:107], v[8:11], v[44:47]
  s_waitcnt lgkmcnt(2)
  v_mfma_f32_16x16x32_bf16 v[56:59], a[48:51], v[12:15], v[56:59]
  v_mfma_f32_16x16x32_bf16 v[60:63], a[104:107], v[12:15], v[60:63]
  s_waitcnt lgkmcnt(1)
  v_mfma_f32_16x16x32_bf16 v[40:43], a[52:55], v[16:19], v[40:43]
  v_mfma_f32_16x16x32_bf16 v[44:47], a[108:111], v[16:19], v[44:47]
  s_waitcnt lgkmcnt(0)
  v_mfma_f32_16x16x32_bf16 v[56:59], a[52:55], v[20:23], v[56:59]
  v_mfma_f32_16x16x32_bf16 v[60:63], a[108:111], v[20:23], v[60:63]
  s_add_u32 s25, s29, 28672
  s_lshl_b32 s24, s19, 5
  s_add_u32 s24, s24, 0
  v_add_u32 v88, s24, v4
  s_cmp_lt_u32 s19, 8
  s_cselect_b64 vcc, -1, 0
  s_cselect_b32 s24, 0, 256
  v_subrev_u32 v88, s24, v88
  s_movk_i32 s24, 5462
  s_cselect_b32 s24, 4096, s24
  v_mul_u32_u24 v89, s24, v88
  v_lshrrev_b32 v89, 16, v89
  s_movk_i32 s24, 100
  s_cselect_b32 s24, 96, s24
  v_mul_u32_u24 v89, s24, v89
  v_cndmask_b32 v92, v7, v6, vcc
  v_add3_u32 v88, v88, v89, v92
  v_lshlrev_b32 v90, 4, v88
  v_cvt_pk_bf16_f32 v72, v40, v41
  v_cvt_pk_bf16_f32 v73, v42, v43
  v_cvt_pk_bf16_f32 v74, v44, v45
  v_cvt_pk_bf16_f32 v75, v46, v47
  buffer_store_dwordx4 v[72:75], v90, s[8:11], s29 offen sc1
  s_lshl_b32 s24, s19, 5
  s_add_u32 s24, s24, 16
  v_add_u32 v88, s24, v4
  s_cmp_lt_u32 s19, 8
  s_cselect_b64 vcc, -1, 0
  s_cselect_b32 s24, 0, 256
  v_subrev_u32 v88, s24, v88
  s_movk_i32 s24, 5462
  s_cselect_b32 s24, 4096, s24
  v_mul_u32_u24 v89, s24, v88
  v_lshrrev_b32 v89, 16, v89
  s_movk_i32 s24, 100
  s_cselect_b32 s24, 96, s24
  v_mul_u32_u24 v89, s24, v89
  v_cndmask_b32 v92, v7, v6, vcc
  v_add3_u32 v88, v88, v89, v92
  v_lshlrev_b32 v91, 4, v88
  v_cvt_pk_bf16_f32 v80, v56, v57
  v_cvt_pk_bf16_f32 v81, v58, v59
  v_cvt_pk_bf16_f32 v82, v60, v61
  v_cvt_pk_bf16_f32 v83, v62, v63
  buffer_store_dwordx4 v[80:83], v91, s[8:11], s29 offen sc1
  s_mov_b32 s33, s32
  s_add_u32 s32, s32, 28672
  s_cmp_eq_u32 s32, 86016
  s_cselect_b32 s32, 0, s32
  s_add_u32 s19, s19, 1
  s_cmp_lt_u32 s19, s35
  s_cbranch_scc1 wf_vo_loop
  s_branch wf_done
wf_done:
  s_lshr_b32 s20, s18, 1
  s_lshl_b32 s20, s20, 4
  s_and_b32 s21, s17, 15
  s_add_u32 s20, s20, s21
  s_lshl_b32 s20, s20, 7
  s_cmp_lt_u32 s17, 16
  s_cselect_b32 s21, 16384, 0
  s_add_u32 s20, s20, s21
  s_add_u32 s20, s20, 88541184
  s_sub_u32 s21, s35, s34
  s_lshr_b32 s21, s21, 1
  v_mov_b32 v5, s21
  v_mov_b32 v6, 0
  s_waitcnt vmcnt(0)
  s_mov_b64 exec, 1
  s_cmp_lg_u32 s18, 0
  s_cbranch_scc1 wf_h1
  v_mov_b32 v7, 2
  s_sub_u32 s21, s20, 2048
  buffer_atomic_add v7, v6, s[8:11], s21 offen
wf_h1:
  buffer_atomic_add v5, v6, s[8:11], s20 offen
  s_mov_b64 exec, -1
  s_load_dwordx8 s[36:43], s[0:1], 56
  s_load_dwordx4 s[44:47], s[0:1], 88
  s_waitcnt lgkmcnt(0)
  s_mov_b32 s52, s36
  s_and_b32 s53, s37, 0xffff
  s_mov_b32 s54, 1835008
  s_mov_b32 s55, 0x20000
  s_lshl_b32 s20, s3, 8
  v_add_u32 v95, s20, v0
  s_mov_b32 s21, 9586981
  v_mul_hi_u32 v6, v95, s21
  v_mul_u32_u24 v7, 448, v6
  v_sub_u32 v7, v95, v7
  v_lshrrev_b32 v8, 4, v7
  v_and_b32 v7, 15, v7
  v_lshl_add_u32 v9, v6, 4, v7
  v_mul_u32_u24 v9, 896, v9
  v_lshl_add_u32 v9, v8, 5, v9
  buffer_load_dwordx4 v[84:87], v9, s[52:55], 0 offen
  buffer_load_dwordx4 v[88:91], v9, s[52:55], 0 offen offset:16
  v_mul_u32_u24 v6, 14336, v6
  v_lshl_add_u32 v6, v7, 4, v6
  v_lshl_add_u32 v92, v8, 9, v6
  v_lshrrev_b32 v7, 2, v8
  v_lshl_add_u32 v6, v7, 11, v6
  v_and_b32 v7, 3, v8
  v_lshl_add_u32 v93, v7, 8, v6
  v_mov_b32 v52, -1
  v_mov_b32 v53, -1
  v_mov_b32 v54, -1
  v_mov_b32 v55, -1
  s_mov_b32 s23, 89063424
  v_lshlrev_b32 v8, 4, v95
  buffer_store_dwordx4 v[52:55], v8, s[8:11], s23 offen sc1
  v_add_u32 v8, 917504, v8
  v_mov_b32 v9, 0x10000000
  v_cmp_lt_u32 vcc, 1535, v95
  s_nop 1
  v_cndmask_b32 v8, v8, v9, vcc
  buffer_store_dwordx4 v[52:55], v8, s[8:11], s23 offen sc1
  s_waitcnt vmcnt(1)
  v_mov_b32 v96, v84
  v_mov_b32 v100, v85
  v_mov_b32 v97, v86
  v_mov_b32 v101, v87
  v_mov_b32 v98, v88
  v_mov_b32 v102, v89
  v_mov_b32 v99, v90
  v_mov_b32 v103, v91
  s_mov_b32 s20, 71565312
  s_mov_b32 s21, 73400320
  buffer_store_dwordx4 v[96:99], v93, s[8:11], s21 offen sc1
  buffer_store_dwordx4 v[100:103], v93, s[8:11], s21 offen offset:1024 sc1
  s_cmp_lt_u32 s3, 70
  s_cbranch_scc1 i2_nx
  buffer_store_dwordx4 v[84:87], v92, s[8:11], s20 offen sc1
  buffer_store_dwordx4 v[88:91], v92, s[8:11], s20 offen offset:256 sc1
i2_nx:
  s_lshl_b32 s20, s3, 3
  s_add_u32 s20, s20, 88637440
  s_waitcnt vmcnt(0)
  s_barrier
  s_cmp_lg_u32 s16, 0
  s_cbranch_scc1 pub_46
  v_mul_u32_u24 v26, 2048, v1
  v_mov_b32 v24, s88
  v_mov_b32 v25, s89
  s_mov_b64 exec, 255
  buffer_store_dwordx2 v[24:25], v26, s[8:11], s20 offen sc1
  s_mov_b64 exec, -1
pub_46:
  s_branch wk_loop
wk_v7:
  s_sub_u32 s20, s3, 256
  s_mov_b32 s18, 1
  s_and_b32 s17, s20, 15
  s_add_u32 s17, s17, 16
  s_lshr_b32 s34, s20, 4
  s_lshl_b32 s34, s34, 1
  s_add_u32 s35, s34, 2
  s_branch wk_gemm
wk_vh:
  s_sub_u32 s20, s3, 368
  s_and_b32 s17, s20, 15
  s_add_u32 s17, s17, 16
  s_lshr_b32 s18, s20, 5
  s_add_u32 s18, s18, 2
  s_bitcmp1_b32 s20, 4
  s_cselect_b32 s34, 7, 0
  s_add_u32 s35, s34, 7
  s_branch wk_gemm
wk_vf:
  s_sub_u32 s20, s3, 560
  s_and_b32 s17, s20, 15
  s_add_u32 s17, s17, 16
  s_lshr_b32 s18, s20, 4
  s_add_u32 s18, s18, 4
  s_mov_b32 s34, 0
  s_mov_b32 s35, 14
  s_branch wk_gemm
wk_f:
  s_sub_u32 s20, s3, 624
  s_and_b32 s17, s20, 15
  s_lshr_b32 s18, s20, 4
  s_mov_b32 s34, 0
  s_mov_b32 s35, 14
  s_lshl_b32 s22, s17, 7
  s_add_u32 s22, s22, 88633344
  s_add_u32 s23, s22, 2048
  v_min_u32 v24, 48, v2
  v_min_u32 v25, 96, v2
  s_mov_b32 s30, 0
wk_aw:
  buffer_load_dwordx4 v[28:31], v24, s[8:11], s22 offen sc1
  buffer_load_dwordx4 v[32:35], v25, s[8:11], s23 offen sc1
  s_waitcnt vmcnt(0)
  v_cmp_ne_u64 vcc, s[88:89], v[28:29]
  s_cbranch_vccnz wk_aw_no
  v_cmp_ne_u64 vcc, s[88:89], v[30:31]
  s_cbranch_vccnz wk_aw_no
  v_cmp_ne_u64 vcc, s[88:89], v[32:33]
  s_cbranch_vccnz wk_aw_no
  v_cmp_ne_u64 vcc, s[88:89], v[34:35]
  s_cbranch_vccnz wk_aw_no
  s_branch wk_aw_ok
wk_aw_no:
  s_sleep 6
  s_add_u32 s30, s30, 1
  s_cmp_lt_u32 s30, 50000
  s_cbranch_scc1 wk_aw
  s_branch cA_abort
wk_aw_ok:
wk_gemm:
  s_lshl_b32 s20, s18, 4
  s_lshl_b32 s21, s16, 2
  s_add_u32 s20, s20, s21
  s_mul_i32 s21, s20, 14336
  s_add_u32 s21, s21, 71565312
  s_add_u32 s22, s21, 0
  buffer_load_dwordx4 a[0:3], v2, s[8:11], s22 offen offset:0 sc1
  buffer_load_dwordx4 a[4:7], v2, s[8:11], s22 offen offset:1024 sc1
  buffer_load_dwordx4 a[8:11], v2, s[8:11], s22 offen offset:2048 sc1
  buffer_load_dwordx4 a[12:15], v2, s[8:11], s22 offen offset:3072 sc1
  s_add_u32 s22, s21, 4096
  buffer_load_dwordx4 a[16:19], v2, s[8:11], s22 offen offset:0 sc1
  buffer_load_dwordx4 a[20:23], v2, s[8:11], s22 offen offset:1024 sc1
  buffer_load_dwordx4 a[24:27], v2, s[8:11], s22 offen offset:2048 sc1
  buffer_load_dwordx4 a[28:31], v2, s[8:11], s22 offen offset:3072 sc1
  s_add_u32 s22, s21, 8192
  buffer_load_dwordx4 a[32:35], v2, s[8:11], s22 offen offset:0 sc1
  buffer_load_dwordx4 a[36:39], v2, s[8:11], s22 offen offset:1024 sc1
  buffer_load_dwordx4 a[40:43], v2, s[8:11], s22 offen offset:2048 sc1
  buffer_load_dwordx4 a[44:47], v2, s[8:11], s22 offen offset:3072 sc1
  s_add_u32 s22, s21, 12288
  buffer_load_dwordx4 a[48:51], v2, s[8:11], s22 offen offset:0 sc1
  buffer_load_dwordx4 a[52:55], v2, s[8:11], s22 offen offset:1024 sc1
  buffer_load_dwordx4 a[56:59], v2, s[8:11], s22 offen offset:2048 sc1
  buffer_load_dwordx4 a[60:63], v2, s[8:11], s22 offen offset:3072 sc1
  s_add_u32 s22, s21, 16384
  buffer_load_dwordx4 a[64:67], v2, s[8:11], s22 offen offset:0 sc1
  buffer_load_dwordx4 a[68:71], v2, s[8:11], s22 offen offset:1024 sc1
  buffer_load_dwordx4 a[72:75], v2, s[8:11], s22 offen offset:2048 sc1
  buffer_load_dwordx4 a[76:79], v2, s[8:11], s22 offen offset:3072 sc1
  s_add_u32 s22, s21, 20480
  buffer_load_dwordx4 a[80:83], v2, s[8:11], s22 offen offset:0 sc1
  buffer_load_dwordx4 a[84:87], v2, s[8:11], s22 offen offset:1024 sc1
  buffer_load_dwordx4 a[88:91], v2, s[8:11], s22 offen offset:2048 sc1
  buffer_load_dwordx4 a[92:95], v2, s[8:11], s22 offen offset:3072 sc1
  s_add_u32 s22, s21, 24576
  buffer_load_dwordx4 a[96:99], v2, s[8:11], s22 offen offset:0 sc1
  buffer_load_dwordx4 a[100:103], v2, s[8:11], s22 offen offset:1024 sc1
  buffer_load_dwordx4 a[104:107], v2, s[8:11], s22 offen offset:2048 sc1
  buffer_load_dwordx4 a[108:111], v2, s[8:11], s22 offen offset:3072 sc1
  s_add_u32 s22, s21, 28672
  buffer_load_dwordx4 a[112:115], v2, s[8:11], s22 offen offset:0 sc1
  buffer_load_dwordx4 a[116:119], v2, s[8:11], s22 offen offset:1024 sc1
  buffer_load_dwordx4 a[120:123], v2, s[8:11], s22 offen offset:2048 sc1
  buffer_load_dwordx4 a[124:127], v2, s[8:11], s22 offen offset:3072 sc1
  s_add_u32 s22, s21, 32768
  buffer_load_dwordx4 a[128:131], v2, s[8:11], s22 offen offset:0 sc1
  buffer_load_dwordx4 a[132:135], v2, s[8:11], s22 offen offset:1024 sc1
  buffer_load_dwordx4 a[136:139], v2, s[8:11], s22 offen offset:2048 sc1
  buffer_load_dwordx4 a[140:143], v2, s[8:11], s22 offen offset:3072 sc1
  s_add_u32 s22, s21, 36864
  buffer_load_dwordx4 a[144:147], v2, s[8:11], s22 offen offset:0 sc1
  buffer_load_dwordx4 a[148:151], v2, s[8:11], s22 offen offset:1024 sc1
  buffer_load_dwordx4 a[152:155], v2, s[8:11], s22 offen offset:2048 sc1
  buffer_load_dwordx4 a[156:159], v2, s[8:11], s22 offen offset:3072 sc1
  s_add_u32 s22, s21, 40960
  buffer_load_dwordx4 a[160:163], v2, s[8:11], s22 offen offset:0 sc1
  buffer_load_dwordx4 a[164:167], v2, s[8:11], s22 offen offset:1024 sc1
  buffer_load_dwordx4 a[168:171], v2, s[8:11], s22 offen offset:2048 sc1
  buffer_load_dwordx4 a[172:175], v2, s[8:11], s22 offen offset:3072 sc1
  s_add_u32 s22, s21, 45056
  buffer_load_dwordx4 a[176:179], v2, s[8:11], s22 offen offset:0 sc1
  buffer_load_dwordx4 a[180:183], v2, s[8:11], s22 offen offset:1024 sc1
  buffer_load_dwordx4 a[184:187], v2, s[8:11], s22 offen offset:2048 sc1
  buffer_load_dwordx4 a[188:191], v2, s[8:11], s22 offen offset:3072 sc1
  s_add_u32 s22, s21, 49152
  buffer_load_dwordx4 a[192:195], v2, s[8:11], s22 offen offset:0 sc1
  buffer_load_dwordx4 a[196:199], v2, s[8:11], s22 offen offset:1024 sc1
  buffer_load_dwordx4 a[200:203], v2, s[8:11], s22 offen offset:2048 sc1
  buffer_load_dwordx4 a[204:207], v2, s[8:11], s22 offen offset:3072 sc1
  s_add_u32 s22, s21, 53248
  buffer_load_dwordx4 a[208:211], v2, s[8:11], s22 offen offset:0 sc1
  buffer_load_dwordx4 a[212:215], v2, s[8:11], s22 offen offset:1024 sc1
  buffer_load_dwordx4 a[216:219], v2, s[8:11], s22 offen offset:2048 sc1
  buffer_load_dwordx4 a[220:223], v2, s[8:11], s22 offen offset:3072 sc1
  s_waitcnt vmcnt(40)
  s_mul_i32 s23, s17, 401408
  s_and_b32 s22, s16, 1
  s_mul_i32 s22, s22, 7168
  s_add_u32 s23, s23, s22
  s_add_u32 s23, s23, 0
  s_lshr_b32 s22, s16, 1
  s_mul_i32 s22, s22, 14336
  s_add_u32 s23, s23, s22
  s_mul_i32 s27, s16, 7168
  s_lshr_b32 s28, s20, 1
  s_cmp_lt_u32 s17, 16
  s_cbranch_scc0 wg_vo
  s_add_u32 s23, s23, s22
  s_lshl_b32 s29, s28, 4
  s_add_u32 s29, s29, s17
  s_mul_i32 s29, s29, 28672
  s_add_u32 s29, s29, 12845056
  s_mov_b32 s31, 0
  s_lshr_b32 s24, s34, 1
  s_lshl_b32 s24, s24, 2
  s_and_b32 s25, s34, 1
  s_add_u32 s24, s24, s25
  s_mul_i32 s24, s24, 14336
  s_add_u32 s24, s24, s23
  s_cmp_lt_u32 s34, s35
  s_cselect_b32 s24, s24, 0x10000000
  s_add_u32 m0, s31, s27
  s_nop 0
  buffer_load_dwordx4 v2, s[8:11], s24 offen offset:0 sc1 lds
  buffer_load_dwordx4 v2, s[8:11], s24 offen offset:1024 sc1 lds
  buffer_load_dwordx4 v2, s[8:11], s24 offen offset:2048 sc1 lds
  buffer_load_dwordx4 v2, s[8:11], s24 offen offset:3072 sc1 lds
  s_add_u32 m0, m0, 4096
  s_add_u32 s24, s24, 4096
  buffer_load_dwordx4 v2, s[8:11], s24 offen offset:0 sc1 lds
  buffer_load_dwordx4 v2, s[8:11], s24 offen offset:1024 sc1 lds
  buffer_load_dwordx4 v2, s[8:11], s24 offen offset:2048 sc1 lds
  s_add_u32 s30, s34, 1
  s_mov_b32 s31, 28672
  s_lshr_b32 s24, s30, 1
  s_lshl_b32 s24, s24, 2
  s_and_b32 s25, s30, 1
  s_add_u32 s24, s24, s25
  s_mul_i32 s24, s24, 14336
  s_add_u32 s24, s24, s23
  s_cmp_lt_u32 s30, s35
  s_cselect_b32 s24, s24, 0x10000000
  s_add_u32 m0, s31, s27
  s_nop 0
  buffer_load_dwordx4 v2, s[8:11], s24 offen offset:0 sc1 lds
  buffer_load_dwordx4 v2, s[8:11], s24 offen offset:1024 sc1 lds
  buffer_load_dwordx4 v2, s[8:11], s24 offen offset:2048 sc1 lds
  buffer_load_dwordx4 v2, s[8:11], s24 offen offset:3072 sc1 lds
  s_add_u32 m0, m0, 4096
  s_add_u32 s24, s24, 4096
  buffer_load_dwordx4 v2, s[8:11], s24 offen offset:0 sc1 lds
  buffer_load_dwordx4 v2, s[8:11], s24 offen offset:1024 sc1 lds
  buffer_load_dwordx4 v2, s[8:11], s24 offen offset:2048 sc1 lds
  s_mov_b32 s19, s34
  s_mov_b32 s32, 0
  s_mov_b32 s33, 57344
  s_waitcnt vmcnt(7)
  s_branch wg_f_in
wg_f_loop:
  s_waitcnt vmcnt(11)
wg_f_in:
  s_barrier
  s_add_u32 s30, s19, 2
  s_lshr_b32 s24, s30, 1
  s_lshl_b32 s24, s24, 2
  s_and_b32 s25, s30, 1
  s_add_u32 s24, s24, s25
  s_mul_i32 s24, s24, 14336
  s_add_u32 s24, s24, s23
  s_cmp_lt_u32 s30, s35
  s_cselect_b32 s24, s24, 0x10000000
  s_add_u32 m0, s33, s27
  s_nop 0
  buffer_load_dwordx4 v2, s[8:11], s24 offen offset:0 sc1 lds
  buffer_load_dwordx4 v2, s[8:11], s24 offen offset:1024 sc1 lds
  buffer_load_dwordx4 v2, s[8:11], s24 offen offset:2048 sc1 lds
  buffer_load_dwordx4 v2, s[8:11], s24 offen offset:3072 sc1 lds
  s_add_u32 m0, m0, 4096
  s_add_u32 s24, s24, 4096
  buffer_load_dwordx4 v2, s[8:11], s24 offen offset:0 sc1 lds
  buffer_load_dwordx4 v2, s[8:11], s24 offen offset:1024 sc1 lds
  buffer_load_dwordx4 v2, s[8:11], s24 offen offset:2048 sc1 lds
  v_add_u32 v5, s32, v2
  ds_read_b128 v[8:11], v5 offset:0
  ds_read_b128 v[12:15], v5 offset:14336
  ds_read_b128 v[16:19], v5 offset:1024
  ds_read_b128 v[20:23], v5 offset:15360
  ds_read_b128 v[24:27], v5 offset:2048
  ds_read_b128 v[28:31], v5 offset:16384
  ds_read_b128 v[32:35], v5 offset:3072
  s_waitcnt lgkmcnt(6)
  v_mfma_f32_16x16x32_bf16 v[40:43], v[8:11], a[0:3], 0
  v_mfma_f32_16x16x32_bf16 v[44:47], v[8:11], a[56:59], 0
  v_mfma_f32_16x16x32_bf16 v[48:51], v[8:11], a[112:115], 0
  v_mfma_f32_16x16x32_bf16 v[52:55], v[8:11], a[168:171], 0
  ds_read_b128 v[36:39], v5 offset:17408
  s_waitcnt lgkmcnt(6)
  v_mfma_f32_16x16x32_bf16 v[56:59], v[12:15], a[0:3], 0
  v_mfma_f32_16x16x32_bf16 v[60:63], v[12:15], a[56:59], 0
  v_mfma_f32_16x16x32_bf16 v[64:67], v[12:15], a[112:115], 0
  v_mfma_f32_16x16x32_bf16 v[68:71], v[12:15], a[168:171], 0
  ds_read_b128 v[8:11], v5 offset:4096
  s_waitcnt lgkmcnt(6)
  v_mfma_f32_16x16x32_bf16 v[40:43], v[16:19], a[4:7], v[40:43]
  v_mfma_f32_16x16x32_bf16 v[44:47], v[16:19], a[60:63], v[44:47]
  v_mfma_f32_16x16x32_bf16 v[48:51], v[16:19], a[116:119], v[48:51]
  v_mfma_f32_16x16x32_bf16 v[52:55], v[16:19], a[172:175], v[52:55]
  ds_read_b128 v[12:15], v5 offset:18432
  s_waitcnt lgkmcnt(6)
  v_mfma_f32_16x16x32_bf16 v[56:59], v[20:23], a[4:7], v[56:59]
  v_mfma_f32_16x16x32_bf16 v[60:63], v[20:23], a[60:63], v[60:63]
  v_mfma_f32_16x16x32_bf16 v[64:67], v[20:23], a[116:119], v[64:67]
  v_mfma_f32_16x16x32_bf16 v[68:71], v[20:23], a[172:175], v[68:71]
  ds_read_b128 v[16:19], v5 offset:5120
  s_waitcnt lgkmcnt(6)
  v_mfma_f32_16x16x32_bf16 v[40:43], v[24:27], a[8:11], v[40:43]
  v_mfma_f32_16x16x32_bf16 v[44:47], v[24:27], a[64:67], v[44:47]
  v_mfma_f32_16x16x32_bf16 v[48:51], v[24:27], a[120:123], v[48:51]
  v_mfma_f32_16x16x32_bf16 v[52:55], v[24:27], a[176:179], v[52:55]
  ds_read_b128 v[20:23], v5 offset:19456
  s_waitcnt lgkmcnt(6)
  v_mfma_f32_16x16x32_bf16 v[56:59], v[28:31], a[8:11], v[56:59]
  v_mfma_f32_16x16x32_bf16 v[60:63], v[28:31], a[64:67], v[60:63]
  v_mfma_f32_16x16x32_bf16 v[64:67], v[28:31], a[120:123], v[64:67]
  v_mfma_f32_16x16x32_bf16 v[68:71], v[28:31], a[176:179], v[68:71]
  ds_read_b128 v[24:27], v5 offset:6144
  s_waitcnt lgkmcnt(6)
  v_mfma_f32_16x16x32_bf16 v[40:43], v[32:35], a[12:15], v[40:43]
  v_mfma_f32_16x16x32_bf16 v[44:47], v[32:35], a[68:71], v[44:47]
  v_mfma_f32_16x16x32_bf16 v[48:51], v[32:35], a[124:127], v[48:51]
  v_mfma_f32_16x16x32_bf16 v[52:55], v[32:35], a[180:183], v[52:55]
  ds_read_b128 v[28:31], v5 offset:20480
  s_waitcnt lgkmcnt(6)
  v_mfma_f32_16x16x32_bf16 v[56:59], v[36:39], a[12:15], v[56:59]
  v_mfma_f32_16x16x32_bf16 v[60:63], v[36:39], a[68:71], v[60:63]
  v_mfma_f32_16x16x32_bf16 v[64:67], v[36:39], a[124:127], v[64:67]
  v_mfma_f32_16x16x32_bf16 v[68:71], v[36:39], a[180:183], v[68:71]
  ds_read_b128 v[32:35], v5 offset:7168
  s_waitcnt lgkmcnt(6)
  v_mfma_f32_16x16x32_bf16 v[40:43], v[8:11], a[16:19], v[40:43]
  v_mfma_f32_16x16x32_bf16 v[44:47], v[8:11], a[72:75], v[44:47]
  v_mfma_f32_16x16x32_bf16 v[48:51], v[8:11], a[128:131], v[48:51]
  v_mfma_f32_16x16x32_bf16 v[52:55], v[8:11], a[184:187], v[52:55]
  ds_read_b128 v[36:39], v5 offset:21504
  s_waitcnt lgkmcnt(6)
  v_mfma_f32_16x16x32_bf16 v[56:59], v[12:15], a[16:19], v[56:59]
  v_mfma_f32_16x16x32_bf16 v[60:63], v[12:15], a[72:75], v[60:63]
  v_mfma_f32_16x16x32_bf16 v[64:67], v[12:15], a[128:131], v[64:67]
  v_mfma_f32_16x16x32_bf16 v[68:71], v[12:15], a[184:187], v[68:71]
  ds_read_b128 v[8:11], v5 offset:8192
  s_waitcnt lgkmcnt(6)
  v_mfma_f32_16x16x32_bf16 v[40:43], v[16:19], a[20:23], v[40:43]
  v_mfma_f32_16x16x32_bf16 v[44:47], v[16:19], a[76:79], v[44:47]
  v_mfma_f32_16x16x32_bf16 v[48:51], v[16:19], a[132:135], v[48:51]
  v_mfma_f32_16x16x32_bf16 v[52:55], v[16:19], a[188:191], v[52:55]
  ds_read_b128 v[12:15], v5 offset:22528
  s_waitcnt lgkmcnt(6)
  v_mfma_f32_16x16x32_bf16 v[56:59], v[20:23], a[20:23], v[56:59]
  v_mfma_f32_16x16x32_bf16 v[60:63], v[20:23], a[76:79], v[60:63]
  v_mfma_f32_16x16x32_bf16 v[64:67], v[20:23], a[132:135], v[64:67]
  v_mfma_f32_16x16x32_bf16 v[68:71], v[20:23], a[188:191], v[68:71]
  ds_read_b128 v[16:19], v5 offset:9216
  s_waitcnt lgkmcnt(6)
  v_mfma_f32_16x16x32_bf16 v[40:43], v[24:27], a[24:27], v[40:43]
  v_mfma_f32_16x16x32_bf16 v[44:47], v[24:27], a[80:83], v[44:47]
  v_mfma_f32_16x16x32_bf16 v[48:51], v[24:27], a[136:139], v[48:51]
  v_mfma_f32_16x16x32_bf16 v[52:55], v[24:27], a[192:195], v[52:55]
  ds_read_b128 v[20:23], v5 offset:23552
  s_waitcnt lgkmcnt(6)
  v_mfma_f32_16x16x32_bf16 v[56:59], v[28:31], a[24:27], v[56:59]
  v_mfma_f32_16x16x32_bf16 v[60:63], v[28:31], a[80:83], v[60:63]
  v_mfma_f32_16x16x32_bf16 v[64:67], v[28:31], a[136:139], v[64:67]
  v_mfma_f32_16x16x32_bf16 v[68:71], v[28:31], a[192:195], v[68:71]
  ds_read_b128 v[24:27], v5 offset:10240
  s_waitcnt lgkmcnt(6)
  v_mfma_f32_16x16x32_bf16 v[40:43], v[32:35], a[28:31], v[40:43]
  v_mfma_f32_16x16x32_bf16 v[44:47], v[32:35], a[84:87], v[44:47]
  v_mfma_f32_16x16x32_bf16 v[48:51], v[32:35], a[140:143], v[48:51]
  v_mfma_f32_16x16x32_bf16 v[52:55], v[32:35], a[196:199], v[52:55]
  ds_read_b128 v[28:31], v5 offset:24576
  s_waitcnt lgkmcnt(6)
  v_mfma_f32_16x16x32_bf16 v[56:59], v[36:39], a[28:31], v[56:59]
  v_mfma_f32_16x16x32_bf16 v[60:63], v[36:39], a[84:87], v[60:63]
  v_mfma_f32_16x16x32_bf16 v[64:67], v[36:39], a[140:143], v[64:67]
  v_mfma_f32_16x16x32_bf16 v[68:71], v[36:39], a[196:199], v[68:71]
  ds_read_b128 v[32:35], v5 offset:11264
  s_waitcnt lgkmcnt(6)
  v_mfma_f32_16x16x32_bf16 v[40:43], v[8:11], a[32:35], v[40:43]
  v_mfma_f32_16x16x32_bf16 v[44:47], v[8:11], a[88:91], v[44:47]
  v_mfma_f32_16x16x32_bf16 v[48:51], v[8:11], a[144:147], v[48:51]
  v_mfma_f32_16x16x32_bf16 v[52:55], v[8:11], a[200:203], v[52:55]
  ds_read_b128 v[36:39], v5 offset:25600
  s_waitcnt lgkmcnt(6)
  v_mfma_f32_16x16x32_bf16 v[56:59], v[12:15], a[32:35], v[56:59]
  v_mfma_f32_16x16x32_bf16 v[60:63], v[12:15], a[88:91], v[60:63]
  v_mfma_f32_16x16x32_bf16 v[64:67], v[12:15], a[144:147], v[64:67]
  v_mfma_f32_16x16x32_bf16 v[68:71], v[12:15], a[200:203], v[68:71]
  ds_read_b128 v[8:11], v5 offset:12288
  s_waitcnt lgkmcnt(6)
  v_mfma_f32_16x16x32_bf16 v[40:43], v[16:19], a[36:39], v[40:43]
  v_mfma_f32_16x16x32_bf16 v[44:47], v[16:19], a[92:95], v[44:47]
  v_mfma_f32_16x16x32_bf16 v[48:51], v[16:19], a[148:151], v[48:51]
  v_mfma_f32_16x16x32_bf16 v[52:55], v[16:19], a[204:207], v[52:55]
  ds_read_b128 v[12:15], v5 offset:26624
  s_waitcnt lgkmcnt(6)
  v_mfma_f32_16x16x32_bf16 v[56:59], v[20:23], a[36:39], v[56:59]
  v_mfma_f32_16x16x32_bf16 v[60:63], v[20:23], a[92:95], v[60:63]
  v_mfma_f32_16x16x32_bf16 v[64:67], v[20:23], a[148:151], v[64:67]
  v_mfma_f32_16x16x32_bf16 v[68:71], v[20:23], a[204:207], v[68:71]
  ds_read_b128 v[16:19], v5 offset:13312
  s_waitcnt lgkmcnt(6)
  v_mfma_f32_16x16x32_bf16 v[40:43], v[24:27], a[40:43], v[40:43]
  v_mfma_f32_16x16x32_bf16 v[44:47], v[24:27], a[96:99], v[44:47]
  v_mfma_f32_16x16x32_bf16 v[48:51], v[24:27], a[152:155], v[48:51]
  v_mfma_f32_16x16x32_bf16 v[52:55], v[24:27], a[208:211], v[52:55]
  ds_read_b128 v[20:23], v5 offset:27648
  s_waitcnt lgkmcnt(6)
  v_mfma_f32_16x16x32_bf16 v[56:59], v[28:31], a[40:43], v[56:59]
  v_mfma_f32_16x16x32_bf16 v[60:63], v[28:31], a[96:99], v[60:63]
  v_mfma_f32_16x16x32_bf16 v[64:67], v[28:31], a[152:155], v[64:67]
  v_mfma_f32_16x16x32_bf16 v[68:71], v[28:31], a[208:211], v[68:71]
  s_waitcnt lgkmcnt(5)
  v_mfma_f32_16x16x32_bf16 v[40:43], v[32:35], a[44:47], v[40:43]
  v_mfma_f32_16x16x32_bf16 v[44:47], v[32:35], a[100:103], v[44:47]
  v_mfma_f32_16x16x32_bf16 v[48:51], v[32:35], a[156:159], v[48:51]
  v_mfma_f32_16x16x32_bf16 v[52:55], v[32:35], a[212:215], v[52:55]
  s_waitcnt lgkmcnt(4)
  v_mfma_f32_16x16x32_bf16 v[56:59], v[36:39], a[44:47], v[56:59]
  v_mfma_f32_16x16x32_bf16 v[60:63], v[36:39], a[100:103], v[60:63]
  v_mfma_f32_16x16x32_bf16 v[64:67], v[36:39], a[156:159], v[64:67]
  v_mfma_f32_16x16x32_bf16 v[68:71], v[36:39], a[212:215], v[68:71]
  s_waitcnt lgkmcnt(3)
  v_mfma_f32_16x16x32_bf16 v[40:43], v[8:11], a[48:51], v[40:43]
  v_mfma_f32_16x16x32_bf16 v[44:47], v[8:11], a[104:107], v[44:47]
  v_mfma_f32_16x16x32_bf16 v[48:51], v[8:11], a[160:163], v[48:51]
  v_mfma_f32_16x16x32_bf16 v[52:55], v[8:11], a[216:219], v[52:55]
  s_waitcnt lgkmcnt(2)
  v_mfma_f32_16x16x32_bf16 v[56:59], v[12:15], a[48:51], v[56:59]
  v_mfma_f32_16x16x32_bf16 v[60:63], v[12:15], a[104:107], v[60:63]
  v_mfma_f32_16x16x32_bf16 v[64:67], v[12:15], a[160:163], v[64:67]
  v_mfma_f32_16x16x32_bf16 v[68:71], v[12:15], a[216:219], v[68:71]
  s_waitcnt lgkmcnt(1)
  v_mfma_f32_16x16x32_bf16 v[40:43], v[16:19], a[52:55], v[40:43]
  v_mfma_f32_16x16x32_bf16 v[44:47], v[16:19], a[108:111], v[44:47]
  v_mfma_f32_16x16x32_bf16 v[48:51], v[16:19], a[164:167], v[48:51]
  v_mfma_f32_16x16x32_bf16 v[52:55], v[16:19], a[220:223], v[52:55]
  s_waitcnt lgkmcnt(0)
  v_mfma_f32_16x16x32_bf16 v[56:59], v[20:23], a[52:55], v[56:59]
  v_mfma_f32_16x16x32_bf16 v[60:63], v[20:23], a[108:111], v[60:63]
  v_mfma_f32_16x16x32_bf16 v[64:67], v[20:23], a[164:167], v[64:67]
  v_mfma_f32_16x16x32_bf16 v[68:71], v[20:23], a[220:223], v[68:71]
  s_lshl_b32 s24, s19, 10
  s_add_u32 s24, s24, s29
  v_cvt_pk_bf16_f32 v72, v40, v41
  v_cvt_pk_bf16_f32 v73, v42, v43
  v_cvt_pk_bf16_f32 v74, v56, v57
  v_cvt_pk_bf16_f32 v75, v58, v59
  s_add_u32 s25, s24, 0
  buffer_store_dwordx4 v[72:75], v2, s[8:11], s25 offen sc1
  v_cvt_pk_bf16_f32 v76, v44, v45
  v_cvt_pk_bf16_f32 v77, v46, v47
  v_cvt_pk_bf16_f32 v78, v60, v61
  v_cvt_pk_bf16_f32 v79, v62, v63
  s_add_u32 s25, s24, 14336
  buffer_store_dwordx4 v[76:79], v2, s[8:11], s25 offen sc1
  v_cvt_pk_bf16_f32 v80, v48, v49
  v_cvt_pk_bf16_f32 v81, v50, v51
  v_cvt_pk_bf16_f32 v82, v64, v65
  v_cvt_pk_bf16_f32 v83, v66, v67
  s_add_u32 s25, s24, 458752
  buffer_store_dwordx4 v[80:83], v2, s[8:11], s25 offen sc1
  v_cvt_pk_bf16_f32 v84, v52, v53
  v_cvt_pk_bf16_f32 v85, v54, v55
  v_cvt_pk_bf16_f32 v86, v68, v69
  v_cvt_pk_bf16_f32 v87, v70, v71
  s_add_u32 s25, s24, 473088
  buffer_store_dwordx4 v[84:87], v2, s[8:11], s25 offen sc1
  s_mov_b32 s33, s32
  s_add_u32 s32, s32, 28672
  s_cmp_eq_u32 s32, 86016
  s_cselect_b32 s32, 0, s32
  s_add_u32 s19, s19, 1
  s_cmp_lt_u32 s19, s35
  s_cbranch_scc1 wg_f_loop
  s_branch wg_done
wg_vo:
  s_sub_u32 s29, s17, 16
  s_lshl_b32 s29, s29, 6
  s_add_u32 s29, s29, s28
  s_mul_i32 s29, s29, 28672
  s_add_u32 s29, s29, 42205184
  v_lshlrev_b32 v6, 4, v3
  v_mad_u32_u24 v7, v3, 12, 64
  s_mov_b32 s31, 0
  s_lshl_b32 s24, s34, 1
  s_mul_i32 s24, s24, 14336
  s_add_u32 s24, s24, s23
  s_cmp_lt_u32 s34, s35
  s_cselect_b32 s24, s24, 0x10000000
  s_add_u32 m0, s31, s27
  s_nop 0
  buffer_load_dwordx4 v2, s[8:11], s24 offen offset:0 sc1 lds
  buffer_load_dwordx4 v2, s[8:11], s24 offen offset:1024 sc1 lds
  buffer_load_dwordx4 v2, s[8:11], s24 offen offset:2048 sc1 lds
  buffer_load_dwordx4 v2, s[8:11], s24 offen offset:3072 sc1 lds
  s_add_u32 m0, m0, 4096
  s_add_u32 s24, s24, 4096
  buffer_load_dwordx4 v2, s[8:11], s24 offen offset:0 sc1 lds
  buffer_load_dwordx4 v2, s[8:11], s24 offen offset:1024 sc1 lds
  buffer_load_dwordx4 v2, s[8:11], s24 offen offset:2048 sc1 lds
  s_add_u32 s30, s34, 1
  s_mov_b32 s31, 28672
  s_lshl_b32 s24, s30, 1
  s_mul_i32 s24, s24, 14336
  s_add_u32 s24, s24, s23
  s_cmp_lt_u32 s30, s35
  s_cselect_b32 s24, s24, 0x10000000
  s_add_u32 m0, s31, s27
  s_nop 0
  buffer_load_dwordx4 v2, s[8:11], s24 offen offset:0 sc1 lds
  buffer_load_dwordx4 v2, s[8:11], s24 offen offset:1024 sc1 lds
  buffer_load_dwordx4 v2, s[8:11], s24 offen offset:2048 sc1 lds
  buffer_load_dwordx4 v2, s[8:11], s24 offen offset:3072 sc1 lds
  s_add_u32 m0, m0, 4096
  s_add_u32 s24, s24, 4096
  buffer_load_dwordx4 v2, s[8:11], s24 offen offset:0 sc1 lds
  buffer_load_dwordx4 v2, s[8:11], s24 offen offset:1024 sc1 lds
  buffer_load_dwordx4 v2, s[8:11], s24 offen offset:2048 sc1 lds
  s_mov_b32 s19, s34
  s_mov_b32 s32, 0
  s_mov_b32 s33, 57344
  s_waitcnt vmcnt(7)
  s_branch wg_vo_in
wg_vo_loop:
  s_waitcnt vmcnt(11)
wg_vo_in:
  s_barrier
  s_add_u32 s30, s19, 2
  s_lshl_b32 s24, s30, 1
  s_mul_i32 s24, s24, 14336
  s_add_u32 s24, s24, s23
  s_cmp_lt_u32 s30, s35
  s_cselect_b32 s24, s24, 0x10000000
  s_add_u32 m0, s33, s27
  s_nop 0
  buffer_load_dwordx4 v2, s[8:11], s24 offen offset:0 sc1 lds
  buffer_load_dwordx4 v2, s[8:11], s24 offen offset:1024 sc1 lds
  buffer_load_dwordx4 v2, s[8:11], s24 offen offset:2048 sc1 lds
  buffer_load_dwordx4 v2, s[8:11], s24 offen offset:3072 sc1 lds
  s_add_u32 m0, m0, 4096
  s_add_u32 s24, s24, 4096
  buffer_load_dwordx4 v2, s[8:11], s24 offen offset:0 sc1 lds
  buffer_load_dwordx4 v2, s[8:11], s24 offen offset:1024 sc1 lds
  buffer_load_dwordx4 v2, s[8:11], s24 offen offset:2048 sc1 lds
  v_add_u32 v5, s32, v2
  ds_read_b128 v[8:11], v5 offset:0
  ds_read_b128 v[12:15], v5 offset:14336
  ds_read_b128 v[16:19], v5 offset:1024
  ds_read_b128 v[20:23], v5 offset:15360
  ds_read_b128 v[24:27], v5 offset:2048
  ds_read_b128 v[28:31], v5 offset:16384
  ds_read_b128 v[32:35], v5 offset:3072
  s_waitcnt lgkmcnt(6)
  v_mfma_f32_16x16x32_bf16 v[40:43], a[0:3], v[8:11], 0
  v_mfma_f32_16x16x32_bf16 v[44:47], a[56:59], v[8:11], 0
  v_mfma_f32_16x16x32_bf16 v[48:51], a[112:115], v[8:11], 0
  v_mfma_f32_16x16x32_bf16 v[52:55], a[168:171], v[8:11], 0
  ds_read_b128 v[36:39], v5 offset:17408
  s_waitcnt lgkmcnt(6)
  v_mfma_f32_16x16x32_bf16 v[56:59], a[0:3], v[12:15], 0
  v_mfma_f32_16x16x32_bf16 v[60:63], a[56:59], v[12:15], 0
  v_mfma_f32_16x16x32_bf16 v[64:67], a[112:115], v[12:15], 0
  v_mfma_f32_16x16x32_bf16 v[68:71], a[168:171], v[12:15], 0
  ds_read_b128 v[8:11], v5 offset:4096
  s_waitcnt lgkmcnt(6)
  v_mfma_f32_16x16x32_bf16 v[40:43], a[4:7], v[16:19], v[40:43]
  v_mfma_f32_16x16x32_bf16 v[44:47], a[60:63], v[16:19], v[44:47]
  v_mfma_f32_16x16x32_bf16 v[48:51], a[116:119], v[16:19], v[48:51]
  v_mfma_f32_16x16x32_bf16 v[52:55], a[172:175], v[16:19], v[52:55]
  ds_read_b128 v[12:15], v5 offset:18432
  s_waitcnt lgkmcnt(6)
  v_mfma_f32_16x16x32_bf16 v[56:59], a[4:7], v[20:23], v[56:59]
  v_mfma_f32_16x16x32_bf16 v[60:63], a[60:63], v[20:23], v[60:63]
  v_mfma_f32_16x16x32_bf16 v[64:67], a[116:119], v[20:23], v[64:67]
  v_mfma_f32_16x16x32_bf16 v[68:71], a[172:175], v[20:23], v[68:71]
  ds_read_b128 v[16:19], v5 offset:5120
  s_waitcnt lgkmcnt(6)
  v_mfma_f32_16x16x32_bf16 v[40:43], a[8:11], v[24:27], v[40:43]
  v_mfma_f32_16x16x32_bf16 v[44:47], a[64:67], v[24:27], v[44:47]
  v_mfma_f32_16x16x32_bf16 v[48:51], a[120:123], v[24:27], v[48:51]
  v_mfma_f32_16x16x32_bf16 v[52:55], a[176:179], v[24:27], v[52:55]
  ds_read_b128 v[20:23], v5 offset:19456
  s_waitcnt lgkmcnt(6)
  v_mfma_f32_16x16x32_bf16 v[56:59], a[8:11], v[28:31], v[56:59]
  v_mfma_f32_16x16x32_bf16 v[60:63], a[64:67], v[28:31], v[60:63]
  v_mfma_f32_16x16x32_bf16 v[64:67], a[120:123], v[28:31], v[64:67]
  v_mfma_f32_16x16x32_bf16 v[68:71], a[176:179], v[28:31], v[68:71]
  ds_read_b128 v[24:27], v5 offset:6144
  s_waitcnt lgkmcnt(6)
  v_mfma_f32_16x16x32_bf16 v[40:43], a[12:15], v[32:35], v[40:43]
  v_mfma_f32_16x16x32_bf16 v[44:47], a[68:71], v[32:35], v[44:47]
  v_mfma_f32_16x16x32_bf16 v[48:51], a[124:127], v[32:35], v[48:51]
  v_mfma_f32_16x16x32_bf16 v[52:55], a[180:183], v[32:35], v[52:55]
  ds_read_b128 v[28:31], v5 offset:20480
  s_waitcnt lgkmcnt(6)
  v_mfma_f32_16x16x32_bf16 v[56:59], a[12:15], v[36:39], v[56:59]
  v_mfma_f32_16x16x32_bf16 v[60:63], a[68:71], v[36:39], v[60:63]
  v_mfma_f32_16x16x32_bf16 v[64:67], a[124:127], v[36:39], v[64:67]
  v_mfma_f32_16x16x32_bf16 v[68:71], a[180:183], v[36:39], v[68:71]
  ds_read_b128 v[32:35], v5 offset:7168
  s_waitcnt lgkmcnt(6)
  v_mfma_f32_16x16x32_bf16 v[40:43], a[16:19], v[8:11], v[40:43]
  v_mfma_f32_16x16x32_bf16 v[44:47], a[72:75], v[8:11], v[44:47]
  v_mfma_f32_16x16x32_bf16 v[48:51], a[128:131], v[8:11], v[48:51]
  v_mfma_f32_16x16x32_bf16 v[52:55], a[184:187], v[8:11], v[52:55]
  ds_read_b128 v[36:39], v5 offset:21504
  s_waitcnt lgkmcnt(6)
  v_mfma_f32_16x16x32_bf16 v[56:59], a[16:19], v[12:15], v[56:59]
  v_mfma_f32_16x16x32_bf16 v[60:63], a[72:75], v[12:15], v[60:63]
  v_mfma_f32_16x16x32_bf16 v[64:67], a[128:131], v[12:15], v[64:67]
  v_mfma_f32_16x16x32_bf16 v[68:71], a[184:187], v[12:15], v[68:71]
  ds_read_b128 v[8:11], v5 offset:8192
  s_waitcnt lgkmcnt(6)
  v_mfma_f32_16x16x32_bf16 v[40:43], a[20:23], v[16:19], v[40:43]
  v_mfma_f32_16x16x32_bf16 v[44:47], a[76:79], v[16:19], v[44:47]
  v_mfma_f32_16x16x32_bf16 v[48:51], a[132:135], v[16:19], v[48:51]
  v_mfma_f32_16x16x32_bf16 v[52:55], a[188:191], v[16:19], v[52:55]
  ds_read_b128 v[12:15], v5 offset:22528
  s_waitcnt lgkmcnt(6)
  v_mfma_f32_16x16x32_bf16 v[56:59], a[20:23], v[20:23], v[56:59]
  v_mfma_f32_16x16x32_bf16 v[60:63], a[76:79], v[20:23], v[60:63]
  v_mfma_f32_16x16x32_bf16 v[64:67], a[132:135], v[20:23], v[64:67]
  v_mfma_f32_16x16x32_bf16 v[68:71], a[188:191], v[20:23], v[68:71]
  ds_read_b128 v[16:19], v5 offset:9216
  s_waitcnt lgkmcnt(6)
  v_mfma_f32_16x16x32_bf16 v[40:43], a[24:27], v[24:27], v[40:43]
  v_mfma_f32_16x16x32_bf16 v[44:47], a[80:83], v[24:27], v[44:47]
  v_mfma_f32_16x16x32_bf16 v[48:51], a[136:139], v[24:27], v[48:51]
  v_mfma_f32_16x16x32_bf16 v[52:55], a[192:195], v[24:27], v[52:55]
  ds_read_b128 v[20:23], v5 offset:23552
  s_waitcnt lgkmcnt(6)
  v_mfma_f32_16x16x32_bf16 v[56:59], a[24:27], v[28:31], v[56:59]
  v_mfma_f32_16x16x32_bf16 v[60:63], a[80:83], v[28:31], v[60:63]
  v_mfma_f32_16x16x32_bf16 v[64:67], a[136:139], v[28:31], v[64:67]
  v_mfma_f32_16x16x32_bf16 v[68:71], a[192:195], v[28:31], v[68:71]
  ds_read_b128 v[24:27], v5 offset:10240
  s_waitcnt lgkmcnt(6)
  v_mfma_f32_16x16x32_bf16 v[40:43], a[28:31], v[32:35], v[40:43]
  v_mfma_f32_16x16x32_bf16 v[44:47], a[84:87], v[32:35], v[44:47]
  v_mfma_f32_16x16x32_bf16 v[48:51], a[140:143], v[32:35], v[48:51]
  v_mfma_f32_16x16x32_bf16 v[52:55], a[196:199], v[32:35], v[52:55]
  ds_read_b128 v[28:31], v5 offset:24576
  s_waitcnt lgkmcnt(6)
  v_mfma_f32_16x16x32_bf16 v[56:59], a[28:31], v[36:39], v[56:59]
  v_mfma_f32_16x16x32_bf16 v[60:63], a[84:87], v[36:39], v[60:63]
  v_mfma_f32_16x16x32_bf16 v[64:67], a[140:143], v[36:39], v[64:67]
  v_mfma_f32_16x16x32_bf16 v[68:71], a[196:199], v[36:39], v[68:71]
  ds_read_b128 v[32:35], v5 offset:11264
  s_waitcnt lgkmcnt(6)
  v_mfma_f32_16x16x32_bf16 v[40:43], a[32:35], v[8:11], v[40:43]
  v_mfma_f32_16x16x32_bf16 v[44:47], a[88:91], v[8:11], v[44:47]
  v_mfma_f32_16x16x32_bf16 v[48:51], a[144:147], v[8:11], v[48:51]
  v_mfma_f32_16x16x32_bf16 v[52:55], a[200:203], v[8:11], v[52:55]
  ds_read_b128 v[36:39], v5 offset:25600
  s_waitcnt lgkmcnt(6)
  v_mfma_f32_16x16x32_bf16 v[56:59], a[32:35], v[12:15], v[56:59]
  v_mfma_f32_16x16x32_bf16 v[60:63], a[88:91], v[12:15], v[60:63]
  v_mfma_f32_16x16x32_bf16 v[64:67], a[144:147], v[12:15], v[64:67]
  v_mfma_f32_16x16x32_bf16 v[68:71], a[200:203], v[12:15], v[68:71]
  ds_read_b128 v[8:11], v5 offset:12288
  s_waitcnt lgkmcnt(6)
  v_mfma_f32_16x16x32_bf16 v[40:43], a[36:39], v[16:19], v[40:43]
  v_mfma_f32_16x16x32_bf16 v[44:47], a[92:95], v[16:19], v[44:47]
  v_mfma_f32_16x16x32_bf16 v[48:51], a[148:151], v[16:19], v[48:51]
  v_mfma_f32_16x16x32_bf16 v[52:55], a[204:207], v[16:19], v[52:55]
  ds_read_b128 v[12:15], v5 offset:26624
  s_waitcnt lgkmcnt(6)
  v_mfma_f32_16x16x32_bf16 v[56:59], a[36:39], v[20:23], v[56:59]
  v_mfma_f32_16x16x32_bf16 v[60:63], a[92:95], v[20:23], v[60:63]
  v_mfma_f32_16x16x32_bf16 v[64:67], a[148:151], v[20:23], v[64:67]
  v_mfma_f32_16x16x32_bf16 v[68:71], a[204:207], v[20:23], v[68:71]
  ds_read_b128 v[16:19], v5 offset:13312
  s_waitcnt lgkmcnt(6)
  v_mfma_f32_16x16x32_bf16 v[40:43], a[40:43], v[24:27], v[40:43]
  v_mfma_f32_16x16x32_bf16 v[44:47], a[96:99], v[24:27], v[44:47]
  v_mfma_f32_16x16x32_bf16 v[48:51], a[152:155], v[24:27], v[48:51]
  v_mfma_f32_16x16x32_bf16 v[52:55], a[208:211], v[24:27], v[52:55]
  ds_read_b128 v[20:23], v5 offset:27648
  s_waitcnt lgkmcnt(6)
  v_mfma_f32_16x16x32_bf16 v[56:59], a[40:43], v[28:31], v[56:59]
  v_mfma_f32_16x16x32_bf16 v[60:63], a[96:99], v[28:31], v[60:63]
  v_mfma_f32_16x16x32_bf16 v[64:67], a[152:155], v[28:31], v[64:67]
  v_mfma_f32_16x16x32_bf16 v[68:71], a[208:211], v[28:31], v[68:71]
  s_waitcnt lgkmcnt(5)
  v_mfma_f32_16x16x32_bf16 v[40:43], a[44:47], v[32:35], v[40:43]
  v_mfma_f32_16x16x32_bf16 v[44:47], a[100:103], v[32:35], v[44:47]
  v_mfma_f32_16x16x32_bf16 v[48:51], a[156:159], v[32:35], v[48:51]
  v_mfma_f32_16x16x32_bf16 v[52:55], a[212:215], v[32:35], v[52:55]
  s_waitcnt lgkmcnt(4)
  v_mfma_f32_16x16x32_bf16 v[56:59], a[44:47], v[36:39], v[56:59]
  v_mfma_f32_16x16x32_bf16 v[60:63], a[100:103], v[36:39], v[60:63]
  v_mfma_f32_16x16x32_bf16 v[64:67], a[156:159], v[36:39], v[64:67]
  v_mfma_f32_16x16x32_bf16 v[68:71], a[212:215], v[36:39], v[68:71]
  s_waitcnt lgkmcnt(3)
  v_mfma_f32_16x16x32_bf16 v[40:43], a[48:51], v[8:11], v[40:43]
  v_mfma_f32_16x16x32_bf16 v[44:47], a[104:107], v[8:11], v[44:47]
  v_mfma_f32_16x16x32_bf16 v[48:51], a[160:163], v[8:11], v[48:51]
  v_mfma_f32_16x16x32_bf16 v[52:55], a[216:219], v[8:11], v[52:55]
  s_waitcnt lgkmcnt(2)
  v_mfma_f32_16x16x32_bf16 v[56:59], a[48:51], v[12:15], v[56:59]
  v_mfma_f32_16x16x32_bf16 v[60:63], a[104:107], v[12:15], v[60:63]
  v_mfma_f32_16x16x32_bf16 v[64:67], a[160:163], v[12:15], v[64:67]
  v_mfma_f32_16x16x32_bf16 v[68:71], a[216:219], v[12:15], v[68:71]
  s_waitcnt lgkmcnt(1)
  v_mfma_f32_16x16x32_bf16 v[40:43], a[52:55], v[16:19], v[40:43]
  v_mfma_f32_16x16x32_bf16 v[44:47], a[108:111], v[16:19], v[44:47]
  v_mfma_f32_16x16x32_bf16 v[48:51], a[164:167], v[16:19], v[48:51]
  v_mfma_f32_16x16x32_bf16 v[52:55], a[220:223], v[16:19], v[52:55]
  s_waitcnt lgkmcnt(0)
  v_mfma_f32_16x16x32_bf16 v[56:59], a[52:55], v[20:23], v[56:59]
  v_mfma_f32_16x16x32_bf16 v[60:63], a[108:111], v[20:23], v[60:63]
  v_mfma_f32_16x16x32_bf16 v[64:67], a[164:167], v[20:23], v[64:67]
  v_mfma_f32_16x16x32_bf16 v[68:71], a[220:223], v[20:23], v[68:71]
  s_add_u32 s25, s29, 28672
  s_lshl_b32 s24, s19, 5
  s_add_u32 s24, s24, 0
  v_add_u32 v88, s24, v4
  s_cmp_lt_u32 s19, 8
  s_cselect_b64 vcc, -1, 0
  s_cselect_b32 s24, 0, 256
  v_subrev_u32 v88, s24, v88
  s_movk_i32 s24, 5462
  s_cselect_b32 s24, 4096, s24
  v_mul_u32_u24 v89, s24, v88
  v_lshrrev_b32 v89, 16, v89
  s_movk_i32 s24, 100
  s_cselect_b32 s24, 96, s24
  v_mul_u32_u24 v89, s24, v89
  v_cndmask_b32 v92, v7, v6, vcc
  v_add3_u32 v88, v88, v89, v92
  v_lshlrev_b32 v90, 4, v88
  v_cvt_pk_bf16_f32 v72, v40, v41
  v_cvt_pk_bf16_f32 v73, v42, v43
  v_cvt_pk_bf16_f32 v74, v44, v45
  v_cvt_pk_bf16_f32 v75, v46, v47
  buffer_store_dwordx4 v[72:75], v90, s[8:11], s29 offen sc1
  v_cvt_pk_bf16_f32 v76, v48, v49
  v_cvt_pk_bf16_f32 v77, v50, v51
  v_cvt_pk_bf16_f32 v78, v52, v53
  v_cvt_pk_bf16_f32 v79, v54, v55
  buffer_store_dwordx4 v[76:79], v90, s[8:11], s25 offen sc1
  s_lshl_b32 s24, s19, 5
  s_add_u32 s24, s24, 16
  v_add_u32 v88, s24, v4
  s_cmp_lt_u32 s19, 8
  s_cselect_b64 vcc, -1, 0
  s_cselect_b32 s24, 0, 256
  v_subrev_u32 v88, s24, v88
  s_movk_i32 s24, 5462
  s_cselect_b32 s24, 4096, s24
  v_mul_u32_u24 v89, s24, v88
  v_lshrrev_b32 v89, 16, v89
  s_movk_i32 s24, 100
  s_cselect_b32 s24, 96, s24
  v_mul_u32_u24 v89, s24, v89
  v_cndmask_b32 v92, v7, v6, vcc
  v_add3_u32 v88, v88, v89, v92
  v_lshlrev_b32 v91, 4, v88
  v_cvt_pk_bf16_f32 v80, v56, v57
  v_cvt_pk_bf16_f32 v81, v58, v59
  v_cvt_pk_bf16_f32 v82, v60, v61
  v_cvt_pk_bf16_f32 v83, v62, v63
  buffer_store_dwordx4 v[80:83], v91, s[8:11], s29 offen sc1
  v_cvt_pk_bf16_f32 v84, v64, v65
  v_cvt_pk_bf16_f32 v85, v66, v67
  v_cvt_pk_bf16_f32 v86, v68, v69
  v_cvt_pk_bf16_f32 v87, v70, v71
  buffer_store_dwordx4 v[84:87], v91, s[8:11], s25 offen sc1
  s_mov_b32 s33, s32
  s_add_u32 s32, s32, 28672
  s_cmp_eq_u32 s32, 86016
  s_cselect_b32 s32, 0, s32
  s_add_u32 s19, s19, 1
  s_cmp_lt_u32 s19, s35
  s_cbranch_scc1 wg_vo_loop
  s_branch wg_done
wg_done:
  s_lshl_b32 s20, s18, 4
  s_and_b32 s21, s17, 15
  s_add_u32 s20, s20, s21
  s_lshl_b32 s20, s20, 7
  s_cmp_lt_u32 s17, 16
  s_cselect_b32 s21, 16384, 0
  s_add_u32 s20, s20, s21
  s_add_u32 s20, s20, 88541184
  s_sub_u32 s21, s35, s34
  v_mov_b32 v5, s21
  v_mov_b32 v6, 0
  s_waitcnt vmcnt(0)
  s_mov_b64 exec, 1
  buffer_atomic_add v5, v6, s[8:11], s20 offen
  s_mov_b64 exec, -1
  s_branch wk_loop
wk_a:
  s_load_dwordx8 s[36:43], s[0:1], 56
  s_load_dwordx4 s[44:47], s[0:1], 88
  s_sub_u32 s3, s3, 432
  s_and_b32 s17, s3, 15
  s_lshr_b32 s19, s3, 5
  s_bitcmp1_b32 s3, 4
  s_cselect_b32 s31, 7, 0
  s_waitcnt lgkmcnt(0)
  s_mov_b32 s60, s40
  s_and_b32 s61, s41, 0xffff
  s_mov_b32 s62, 3670016
  s_mov_b32 s63, 0x20000
  s_mov_b32 s56, s42
  s_and_b32 s57, s43, 0xffff
  s_mov_b32 s58, 3670016
  s_mov_b32 s59, 0x20000
  s_lshl_b32 s30, s16, 13
  s_lshl_b32 s27, s19, 19
  s_lshl_b32 s29, s16, 17
  s_add_u32 s27, s27, s29
  s_lshl_b32 s29, s17, 9
  s_add_u32 s27, s27, s29
  v_lshrrev_b32 v5, 5, v1
  v_and_b32 v6, 31, v1
  v_xor_b32 v6, v6, v5
  v_lshlrev_b32 v6, 4, v6
  v_lshl_add_u32 v6, v5, 13, v6
  s_add_u32 m0, s30, 0
  s_add_u32 s22, s27, 0
  v_xor_b32 v7, 0, v6
  buffer_load_dwordx4 v7, s[56:59], s22 offen offset:0 lds
  s_add_u32 s22, s27, 15360
  v_xor_b32 v7, 32, v6
  buffer_load_dwordx4 v7, s[56:59], s22 offen offset:1024 lds
  s_add_u32 s22, s27, 30720
  v_xor_b32 v7, 64, v6
  buffer_load_dwordx4 v7, s[56:59], s22 offen offset:2048 lds
  s_add_u32 s22, s27, 46080
  v_xor_b32 v7, 96, v6
  buffer_load_dwordx4 v7, s[56:59], s22 offen offset:3072 lds
  s_add_u32 m0, s30, 4096
  s_add_u32 s22, s27, 65536
  v_xor_b32 v7, 128, v6
  buffer_load_dwordx4 v7, s[56:59], s22 offen offset:0 lds
  s_add_u32 s22, s27, 80896
  v_xor_b32 v7, 160, v6
  buffer_load_dwordx4 v7, s[56:59], s22 offen offset:1024 lds
  s_add_u32 s22, s27, 96256
  v_xor_b32 v7, 192, v6
  buffer_load_dwordx4 v7, s[56:59], s22 offen offset:2048 lds
  s_add_u32 s22, s27, 111616
  v_xor_b32 v7, 224, v6
  buffer_load_dwordx4 v7, s[56:59], s22 offen offset:3072 lds
  v_lshrrev_b32 v5, 5, v1
  v_and_b32 v6, 31, v1
  s_lshl_b32 s25, s16, 15
  s_add_u32 s25, s25, 32768
  s_lshl_b32 s26, s17, 9
  s_add_u32 s28, s19, s16
  s_cmp_ge_u32 s28, 7
  s_cselect_b32 s20, 7, 0
  s_sub_u32 s28, s28, s20
  s_add_u32 s28, s28, s31
  s_add_u32 s29, s19, s16
  s_add_u32 s29, s29, 4
  s_cmp_ge_u32 s29, 7
  s_cselect_b32 s20, 7, 0
  s_sub_u32 s29, s29, s20
  s_add_u32 s29, s29, s31
  s_lshl_b32 s32, s28, 18
  s_add_u32 s32, s32, s26
  s_lshl_b32 s33, s29, 18
  s_add_u32 s33, s33, s26
  v_xor_b32 v8, v6, v5
  v_lshlrev_b32 v8, 4, v8
  v_lshl_add_u32 v8, v5, 13, v8
  v_xor_b32 v12, 0, v8
  v_xor_b32 v13, 32, v8
  v_add_u32 v13, 15360, v13
  v_xor_b32 v14, 0, v8
  v_add_u32 v14, 30720, v14
  v_xor_b32 v15, 32, v8
  v_add_u32 v15, 46080, v15
  s_add_u32 s20, s16, 0
  s_and_b32 s20, s20, 3
  s_mul_i32 s21, s20, 65600
  s_lshl_b32 s20, s20, 12
  s_add_u32 s48, s20, s25
  s_mov_b32 m0, s48
  v_xor_b32 v16, s21, v12
  buffer_load_dwordx4 v16, s[60:63], s32 offen offset:0 lds
  v_xor_b32 v17, s21, v13
  buffer_load_dwordx4 v17, s[60:63], s32 offen offset:1024 lds
  v_xor_b32 v18, s21, v14
  buffer_load_dwordx4 v18, s[60:63], s32 offen offset:2048 lds
  v_xor_b32 v19, s21, v15
  buffer_load_dwordx4 v19, s[60:63], s32 offen offset:3072 lds
  s_add_u32 s20, s16, 1
  s_and_b32 s20, s20, 3
  s_mul_i32 s21, s20, 65600
  s_lshl_b32 s20, s20, 12
  s_add_u32 s49, s20, s25
  s_mov_b32 m0, s49
  v_xor_b32 v20, s21, v12
  buffer_load_dwordx4 v20, s[60:63], s32 offen offset:0 lds
  v_xor_b32 v21, s21, v13
  buffer_load_dwordx4 v21, s[60:63], s32 offen offset:1024 lds
  v_xor_b32 v22, s21, v14
  buffer_load_dwordx4 v22, s[60:63], s32 offen offset:2048 lds
  v_xor_b32 v23, s21, v15
  buffer_load_dwordx4 v23, s[60:63], s32 offen offset:3072 lds
  s_add_u32 s20, s16, 2
  s_and_b32 s20, s20, 3
  s_mul_i32 s21, s20, 65600
  s_lshl_b32 s20, s20, 12
  s_add_u32 s50, s20, s25
  s_mov_b32 m0, s50
  v_xor_b32 v24, s21, v12
  buffer_load_dwordx4 v24, s[60:63], s32 offen offset:0 lds
  v_xor_b32 v25, s21, v13
  buffer_load_dwordx4 v25, s[60:63], s32 offen offset:1024 lds
  v_xor_b32 v26, s21, v14
  buffer_load_dwordx4 v26, s[60:63], s32 offen offset:2048 lds
  v_xor_b32 v27, s21, v15
  buffer_load_dwordx4 v27, s[60:63], s32 offen offset:3072 lds
  s_add_u32 s20, s16, 3
  s_and_b32 s20, s20, 3
  s_mul_i32 s21, s20, 65600
  s_lshl_b32 s20, s20, 12
  s_add_u32 s51, s20, s25
  s_mov_b32 m0, s51
  v_xor_b32 v28, s21, v12
  buffer_load_dwordx4 v28, s[60:63], s32 offen offset:0 lds
  v_xor_b32 v29, s21, v13
  buffer_load_dwordx4 v29, s[60:63], s32 offen offset:1024 lds
  v_xor_b32 v30, s21, v14
  buffer_load_dwordx4 v30, s[60:63], s32 offen offset:2048 lds
  v_xor_b32 v31, s21, v15
  buffer_load_dwordx4 v31, s[60:63], s32 offen offset:3072 lds
  s_mul_i32 s30, s17, 401408
  s_mul_i32 s20, s19, 57344
  s_add_u32 s30, s30, s20
  v_add_u32 v12, s30, v2
  v_add_u32 v13, 14336, v12
  v_add_u32 v14, 28672, v12
  v_add_u32 v15, 43008, v12
  v_lshrrev_b32 v7, 2, v4
  v_lshlrev_b32 v7, 3, v7
  v_and_b32 v8, 3, v4
  v_add_u32 v7, v7, v8
  v_xor_b32 v10, v3, v4
  v_lshlrev_b32 v10, 4, v10
  v_lshl_add_u32 v10, v7, 9, v10
  v_add_u32 v10, s25, v10
  v_xor_b32 v32, 0, v10
  v_xor_b32 v33, 64, v10
  v_xor_b32 v34, 128, v10
  v_xor_b32 v35, 192, v10
  v_and_b32 v8, 2, v4
  v_lshlrev_b32 v8, 1, v8
  v_and_b32 v9, 1, v4
  v_add_u32 v8, v8, v9
  v_lshrrev_b32 v7, 2, v4
  v_lshl_add_u32 v7, v7, 4, v8
  v_xor_b32 v8, v8, v3
  v_lshlrev_b32 v8, 4, v8
  v_lshl_add_u32 v7, v7, 9, v8
  s_mov_b32 s24, 1035512379
  s_waitcnt vmcnt(16)
  s_barrier
  s_cmp_eq_u32 s16, 3
  s_cbranch_scc1 aj_np0
  s_add_u32 m0, s48, 16384
  s_nop 0
  buffer_load_dwordx4 v16, s[60:63], s33 offen offset:0 lds
  buffer_load_dwordx4 v17, s[60:63], s33 offen offset:1024 lds
  buffer_load_dwordx4 v18, s[60:63], s33 offen offset:2048 lds
  buffer_load_dwordx4 v19, s[60:63], s33 offen offset:3072 lds
aj_np0:
  v_xor_b32 v8, 0, v7
  ds_read_b128 v[128:131], v8 offset:0
  v_xor_b32 v9, 64, v7
  ds_read_b128 v[132:135], v9 offset:0
  v_xor_b32 v10, 128, v7
  ds_read_b128 v[136:139], v10 offset:0
  v_xor_b32 v11, 192, v7
  ds_read_b128 v[140:143], v11 offset:0
  ds_read_b128 v[144:147], v8 offset:256
  ds_read_b128 v[148:151], v9 offset:256
  ds_read_b128 v[152:155], v10 offset:256
  ds_read_b128 v[156:159], v11 offset:256
  s_waitcnt lgkmcnt(4)
  s_cmp_eq_u32 s16, 3
  s_cbranch_scc1 aj_np1
  s_add_u32 m0, s49, 16384
  s_nop 0
  buffer_load_dwordx4 v20, s[60:63], s33 offen offset:0 lds
  buffer_load_dwordx4 v21, s[60:63], s33 offen offset:1024 lds
  buffer_load_dwordx4 v22, s[60:63], s33 offen offset:2048 lds
  buffer_load_dwordx4 v23, s[60:63], s33 offen offset:3072 lds
aj_np1:
  v_xor_b32 v8, 32, v7
  ds_read_b128 v[160:163], v8 offset:1024
  v_xor_b32 v9, 96, v7
  ds_read_b128 v[164:167], v9 offset:1024
  v_xor_b32 v10, 160, v7
  ds_read_b128 v[168:171], v10 offset:1024
  v_xor_b32 v11, 224, v7
  ds_read_b128 v[172:175], v11 offset:1024
  ds_read_b128 v[176:179], v8 offset:1280
  ds_read_b128 v[180:183], v9 offset:1280
  ds_read_b128 v[184:187], v10 offset:1280
  ds_read_b128 v[188:191], v11 offset:1280
  s_waitcnt lgkmcnt(4)
  s_cmp_eq_u32 s16, 3
  s_cbranch_scc1 aj_np2
  s_add_u32 m0, s50, 16384
  s_nop 0
  buffer_load_dwordx4 v24, s[60:63], s33 offen offset:0 lds
  buffer_load_dwordx4 v25, s[60:63], s33 offen offset:1024 lds
  buffer_load_dwordx4 v26, s[60:63], s33 offen offset:2048 lds
  buffer_load_dwordx4 v27, s[60:63], s33 offen offset:3072 lds
aj_np2:
  v_xor_b32 v8, 128, v7
  ds_read_b128 v[192:195], v8 offset:4096
  v_xor_b32 v9, 192, v7
  ds_read_b128 v[196:199], v9 offset:4096
  v_xor_b32 v10, 0, v7
  ds_read_b128 v[200:203], v10 offset:4096
  v_xor_b32 v11, 64, v7
  ds_read_b128 v[204:207], v11 offset:4096
  ds_read_b128 v[208:211], v8 offset:4352
  ds_read_b128 v[212:215], v9 offset:4352
  ds_read_b128 v[216:219], v10 offset:4352
  ds_read_b128 v[220:223], v11 offset:4352
  s_waitcnt lgkmcnt(4)
  s_cmp_eq_u32 s16, 3
  s_cbranch_scc1 aj_np3
  s_add_u32 m0, s51, 16384
  s_nop 0
  buffer_load_dwordx4 v28, s[60:63], s33 offen offset:0 lds
  buffer_load_dwordx4 v29, s[60:63], s33 offen offset:1024 lds
  buffer_load_dwordx4 v30, s[60:63], s33 offen offset:2048 lds
  buffer_load_dwordx4 v31, s[60:63], s33 offen offset:3072 lds
aj_np3:
  v_xor_b32 v8, 160, v7
  ds_read_b128 v[224:227], v8 offset:5120
  v_xor_b32 v9, 224, v7
  ds_read_b128 v[228:231], v9 offset:5120
  v_xor_b32 v10, 32, v7
  ds_read_b128 v[232:235], v10 offset:5120
  v_xor_b32 v11, 96, v7
  ds_read_b128 v[236:239], v11 offset:5120
  ds_read_b128 v[240:243], v8 offset:5376
  ds_read_b128 v[244:247], v9 offset:5376
  ds_read_b128 v[248:251], v10 offset:5376
  ds_read_b128 v[252:255], v11 offset:5376
  s_waitcnt lgkmcnt(4)
  s_waitcnt vmcnt(16) lgkmcnt(0)
  s_cmp_lg_u32 s16, 3
  s_cbranch_scc1 w3_47
  s_waitcnt vmcnt(0)
w3_47:
  ds_read_b128 v[52:55], v32 offset:0
  ds_read_b128 v[56:59], v33 offset:0
  ds_read_b128 v[60:63], v34 offset:0
  ds_read_b128 v[64:67], v35 offset:0
  s_waitcnt lgkmcnt(3)
  v_mfma_f32_16x16x32_bf16 v[96:99], v[52:55], v[128:131], 0
  v_mfma_f32_16x16x32_bf16 v[100:103], v[52:55], v[160:163], 0
  v_mfma_f32_16x16x32_bf16 v[104:107], v[52:55], v[192:195], 0
  v_mfma_f32_16x16x32_bf16 v[108:111], v[52:55], v[224:227], 0
  ds_read_b128 v[52:55], v32 offset:256
  s_waitcnt lgkmcnt(3)
  v_mfma_f32_16x16x32_bf16 v[96:99], v[56:59], v[132:135], v[96:99]
  v_mfma_f32_16x16x32_bf16 v[100:103], v[56:59], v[164:167], v[100:103]
  v_mfma_f32_16x16x32_bf16 v[104:107], v[56:59], v[196:199], v[104:107]
  v_mfma_f32_16x16x32_bf16 v[108:111], v[56:59], v[228:231], v[108:111]
  ds_read_b128 v[56:59], v33 offset:256
  s_waitcnt lgkmcnt(3)
  v_mfma_f32_16x16x32_bf16 v[96:99], v[60:63], v[136:139], v[96:99]
  v_mfma_f32_16x16x32_bf16 v[100:103], v[60:63], v[168:171], v[100:103]
  v_mfma_f32_16x16x32_bf16 v[104:107], v[60:63], v[200:203], v[104:107]
  v_mfma_f32_16x16x32_bf16 v[108:111], v[60:63], v[232:235], v[108:111]
  ds_read_b128 v[60:63], v34 offset:256
  s_waitcnt lgkmcnt(3)
  v_mfma_f32_16x16x32_bf16 v[96:99], v[64:67], v[140:143], v[96:99]
  v_mfma_f32_16x16x32_bf16 v[100:103], v[64:67], v[172:175], v[100:103]
  v_mfma_f32_16x16x32_bf16 v[104:107], v[64:67], v[204:207], v[104:107]
  v_mfma_f32_16x16x32_bf16 v[108:111], v[64:67], v[236:239], v[108:111]
  ds_read_b128 v[64:67], v35 offset:256
  s_waitcnt lgkmcnt(3)
  v_mfma_f32_16x16x32_bf16 v[96:99], v[52:55], v[144:147], v[96:99]
  v_mfma_f32_16x16x32_bf16 v[100:103], v[52:55], v[176:179], v[100:103]
  v_mfma_f32_16x16x32_bf16 v[104:107], v[52:55], v[208:211], v[104:107]
  v_mfma_f32_16x16x32_bf16 v[108:111], v[52:55], v[240:243], v[108:111]
  ds_read_b128 v[52:55], v32 offset:2048
  s_waitcnt lgkmcnt(3)
  v_mfma_f32_16x16x32_bf16 v[96:99], v[56:59], v[148:151], v[96:99]
  v_mfma_f32_16x16x32_bf16 v[100:103], v[56:59], v[180:183], v[100:103]
  v_mfma_f32_16x16x32_bf16 v[104:107], v[56:59], v[212:215], v[104:107]
  v_mfma_f32_16x16x32_bf16 v[108:111], v[56:59], v[244:247], v[108:111]
  ds_read_b128 v[56:59], v33 offset:2048
  s_waitcnt lgkmcnt(3)
  v_mfma_f32_16x16x32_bf16 v[96:99], v[60:63], v[152:155], v[96:99]
  v_mfma_f32_16x16x32_bf16 v[100:103], v[60:63], v[184:187], v[100:103]
  v_mfma_f32_16x16x32_bf16 v[104:107], v[60:63], v[216:219], v[104:107]
  v_mfma_f32_16x16x32_bf16 v[108:111], v[60:63], v[248:251], v[108:111]
  ds_read_b128 v[60:63], v34 offset:2048
  s_waitcnt lgkmcnt(3)
  v_mfma_f32_16x16x32_bf16 v[96:99], v[64:67], v[156:159], v[96:99]
  v_mfma_f32_16x16x32_bf16 v[100:103], v[64:67], v[188:191], v[100:103]
  v_mfma_f32_16x16x32_bf16 v[104:107], v[64:67], v[220:223], v[104:107]
  v_mfma_f32_16x16x32_bf16 v[108:111], v[64:67], v[252:255], v[108:111]
  ds_read_b128 v[64:67], v35 offset:2048
  s_waitcnt lgkmcnt(3)
  v_mfma_f32_16x16x32_bf16 v[112:115], v[52:55], v[128:131], 0
  v_mfma_f32_16x16x32_bf16 v[116:119], v[52:55], v[160:163], 0
  v_mfma_f32_16x16x32_bf16 v[120:123], v[52:55], v[192:195], 0
  v_mfma_f32_16x16x32_bf16 v[124:127], v[52:55], v[224:227], 0
  ds_read_b128 v[52:55], v32 offset:2304
  s_waitcnt lgkmcnt(3)
  v_mfma_f32_16x16x32_bf16 v[112:115], v[56:59], v[132:135], v[112:115]
  v_mfma_f32_16x16x32_bf16 v[116:119], v[56:59], v[164:167], v[116:119]
  v_mfma_f32_16x16x32_bf16 v[120:123], v[56:59], v[196:199], v[120:123]
  v_mfma_f32_16x16x32_bf16 v[124:127], v[56:59], v[228:231], v[124:127]
  ds_read_b128 v[56:59], v33 offset:2304
  s_waitcnt lgkmcnt(3)
  v_mfma_f32_16x16x32_bf16 v[112:115], v[60:63], v[136:139], v[112:115]
  v_mfma_f32_16x16x32_bf16 v[116:119], v[60:63], v[168:171], v[116:119]
  v_mfma_f32_16x16x32_bf16 v[120:123], v[60:63], v[200:203], v[120:123]
  v_mfma_f32_16x16x32_bf16 v[124:127], v[60:63], v[232:235], v[124:127]
  ds_read_b128 v[60:63], v34 offset:2304
  s_waitcnt lgkmcnt(3)
  v_mfma_f32_16x16x32_bf16 v[112:115], v[64:67], v[140:143], v[112:115]
  v_mfma_f32_16x16x32_bf16 v[116:119], v[64:67], v[172:175], v[116:119]
  v_mfma_f32_16x16x32_bf16 v[120:123], v[64:67], v[204:207], v[120:123]
  v_mfma_f32_16x16x32_bf16 v[124:127], v[64:67], v[236:239], v[124:127]
  ds_read_b128 v[64:67], v35 offset:2304
  s_waitcnt lgkmcnt(3)
  v_mfma_f32_16x16x32_bf16 v[112:115], v[52:55], v[144:147], v[112:115]
  v_mfma_f32_16x16x32_bf16 v[116:119], v[52:55], v[176:179], v[116:119]
  v_mfma_f32_16x16x32_bf16 v[120:123], v[52:55], v[208:211], v[120:123]
  v_mfma_f32_16x16x32_bf16 v[124:127], v[52:55], v[240:243], v[124:127]
  s_waitcnt lgkmcnt(2)
  v_mfma_f32_16x16x32_bf16 v[112:115], v[56:59], v[148:151], v[112:115]
  v_mfma_f32_16x16x32_bf16 v[116:119], v[56:59], v[180:183], v[116:119]
  v_mfma_f32_16x16x32_bf16 v[120:123], v[56:59], v[212:215], v[120:123]
  v_mfma_f32_16x16x32_bf16 v[124:127], v[56:59], v[244:247], v[124:127]
  s_waitcnt lgkmcnt(1)
  v_mfma_f32_16x16x32_bf16 v[112:115], v[60:63], v[152:155], v[112:115]
  v_mfma_f32_16x16x32_bf16 v[116:119], v[60:63], v[184:187], v[116:119]
  v_mfma_f32_16x16x32_bf16 v[120:123], v[60:63], v[216:219], v[120:123]
  v_mfma_f32_16x16x32_bf16 v[124:127], v[60:63], v[248:251], v[124:127]
  s_waitcnt lgkmcnt(0)
  v_mfma_f32_16x16x32_bf16 v[112:115], v[64:67], v[156:159], v[112:115]
  v_mfma_f32_16x16x32_bf16 v[116:119], v[64:67], v[188:191], v[116:119]
  v_mfma_f32_16x16x32_bf16 v[120:123], v[64:67], v[220:223], v[120:123]
  v_mfma_f32_16x16x32_bf16 v[124:127], v[64:67], v[252:255], v[124:127]
  s_lshl_b32 s30, s28, 10
  v_mul_f32 v96, s24, v96
  v_mul_f32 v97, s24, v97
  v_mul_f32 v98, s24, v98
  v_mul_f32 v99, s24, v99
  v_cvt_pk_bf16_f32 v68, v96, v97
  v_cvt_pk_bf16_f32 v69, v98, v99
  v_mul_f32 v112, s24, v112
  v_mul_f32 v113, s24, v113
  v_mul_f32 v114, s24, v114
  v_mul_f32 v115, s24, v115
  v_cvt_pk_bf16_f32 v70, v112, v113
  v_cvt_pk_bf16_f32 v71, v114, v115
  buffer_store_dwordx4 v[68:71], v12, s[8:11], s30 offen sc1
  v_mul_f32 v100, s24, v100
  v_mul_f32 v101, s24, v101
  v_mul_f32 v102, s24, v102
  v_mul_f32 v103, s24, v103
  v_cvt_pk_bf16_f32 v72, v100, v101
  v_cvt_pk_bf16_f32 v73, v102, v103
  v_mul_f32 v116, s24, v116
  v_mul_f32 v117, s24, v117
  v_mul_f32 v118, s24, v118
  v_mul_f32 v119, s24, v119
  v_cvt_pk_bf16_f32 v74, v116, v117
  v_cvt_pk_bf16_f32 v75, v118, v119
  buffer_store_dwordx4 v[72:75], v13, s[8:11], s30 offen sc1
  v_mul_f32 v104, s24, v104
  v_mul_f32 v105, s24, v105
  v_mul_f32 v106, s24, v106
  v_mul_f32 v107, s24, v107
  v_cvt_pk_bf16_f32 v76, v104, v105
  v_cvt_pk_bf16_f32 v77, v106, v107
  v_mul_f32 v120, s24, v120
  v_mul_f32 v121, s24, v121
  v_mul_f32 v122, s24, v122
  v_mul_f32 v123, s24, v123
  v_cvt_pk_bf16_f32 v78, v120, v121
  v_cvt_pk_bf16_f32 v79, v122, v123
  buffer_store_dwordx4 v[76:79], v14, s[8:11], s30 offen sc1
  v_mul_f32 v108, s24, v108
  v_mul_f32 v109, s24, v109
  v_mul_f32 v110, s24, v110
  v_mul_f32 v111, s24, v111
  v_cvt_pk_bf16_f32 v80, v108, v109
  v_cvt_pk_bf16_f32 v81, v110, v111
  v_mul_f32 v124, s24, v124
  v_mul_f32 v125, s24, v125
  v_mul_f32 v126, s24, v126
  v_mul_f32 v127, s24, v127
  v_cvt_pk_bf16_f32 v82, v124, v125
  v_cvt_pk_bf16_f32 v83, v126, v127
  buffer_store_dwordx4 v[80:83], v15, s[8:11], s30 offen sc1
  s_cmp_eq_u32 s16, 3
  s_cbranch_scc1 aj_w3
  s_waitcnt vmcnt(4)
  ds_read_b128 v[52:55], v32 offset:16384
  ds_read_b128 v[56:59], v33 offset:16384
  ds_read_b128 v[60:63], v34 offset:16384
  ds_read_b128 v[64:67], v35 offset:16384
  s_waitcnt lgkmcnt(3)
  v_mfma_f32_16x16x32_bf16 v[96:99], v[52:55], v[128:131], 0
  v_mfma_f32_16x16x32_bf16 v[100:103], v[52:55], v[160:163], 0
  v_mfma_f32_16x16x32_bf16 v[104:107], v[52:55], v[192:195], 0
  v_mfma_f32_16x16x32_bf16 v[108:111], v[52:55], v[224:227], 0
  ds_read_b128 v[52:55], v32 offset:16640
  s_waitcnt lgkmcnt(3)
  v_mfma_f32_16x16x32_bf16 v[96:99], v[56:59], v[132:135], v[96:99]
  v_mfma_f32_16x16x32_bf16 v[100:103], v[56:59], v[164:167], v[100:103]
  v_mfma_f32_16x16x32_bf16 v[104:107], v[56:59], v[196:199], v[104:107]
  v_mfma_f32_16x16x32_bf16 v[108:111], v[56:59], v[228:231], v[108:111]
  ds_read_b128 v[56:59], v33 offset:16640
  s_waitcnt lgkmcnt(3)
  v_mfma_f32_16x16x32_bf16 v[96:99], v[60:63], v[136:139], v[96:99]
  v_mfma_f32_16x16x32_bf16 v[100:103], v[60:63], v[168:171], v[100:103]
  v_mfma_f32_16x16x32_bf16 v[104:107], v[60:63], v[200:203], v[104:107]
  v_mfma_f32_16x16x32_bf16 v[108:111], v[60:63], v[232:235], v[108:111]
  ds_read_b128 v[60:63], v34 offset:16640
  s_waitcnt lgkmcnt(3)
  v_mfma_f32_16x16x32_bf16 v[96:99], v[64:67], v[140:143], v[96:99]
  v_mfma_f32_16x16x32_bf16 v[100:103], v[64:67], v[172:175], v[100:103]
  v_mfma_f32_16x16x32_bf16 v[104:107], v[64:67], v[204:207], v[104:107]
  v_mfma_f32_16x16x32_bf16 v[108:111], v[64:67], v[236:239], v[108:111]
  ds_read_b128 v[64:67], v35 offset:16640
  s_waitcnt lgkmcnt(3)
  v_mfma_f32_16x16x32_bf16 v[96:99], v[52:55], v[144:147], v[96:99]
  v_mfma_f32_16x16x32_bf16 v[100:103], v[52:55], v[176:179], v[100:103]
  v_mfma_f32_16x16x32_bf16 v[104:107], v[52:55], v[208:211], v[104:107]
  v_mfma_f32_16x16x32_bf16 v[108:111], v[52:55], v[240:243], v[108:111]
  ds_read_b128 v[52:55], v32 offset:18432
  s_waitcnt lgkmcnt(3)
  v_mfma_f32_16x16x32_bf16 v[96:99], v[56:59], v[148:151], v[96:99]
  v_mfma_f32_16x16x32_bf16 v[100:103], v[56:59], v[180:183], v[100:103]
  v_mfma_f32_16x16x32_bf16 v[104:107], v[56:59], v[212:215], v[104:107]
  v_mfma_f32_16x16x32_bf16 v[108:111], v[56:59], v[244:247], v[108:111]
  ds_read_b128 v[56:59], v33 offset:18432
  s_waitcnt lgkmcnt(3)
  v_mfma_f32_16x16x32_bf16 v[96:99], v[60:63], v[152:155], v[96:99]
  v_mfma_f32_16x16x32_bf16 v[100:103], v[60:63], v[184:187], v[100:103]
  v_mfma_f32_16x16x32_bf16 v[104:107], v[60:63], v[216:219], v[104:107]
  v_mfma_f32_16x16x32_bf16 v[108:111], v[60:63], v[248:251], v[108:111]
  ds_read_b128 v[60:63], v34 offset:18432
  s_waitcnt lgkmcnt(3)
  v_mfma_f32_16x16x32_bf16 v[96:99], v[64:67], v[156:159], v[96:99]
  v_mfma_f32_16x16x32_bf16 v[100:103], v[64:67], v[188:191], v[100:103]
  v_mfma_f32_16x16x32_bf16 v[104:107], v[64:67], v[220:223], v[104:107]
  v_mfma_f32_16x16x32_bf16 v[108:111], v[64:67], v[252:255], v[108:111]
  ds_read_b128 v[64:67], v35 offset:18432
  s_waitcnt lgkmcnt(3)
  v_mfma_f32_16x16x32_bf16 v[112:115], v[52:55], v[128:131], 0
  v_mfma_f32_16x16x32_bf16 v[116:119], v[52:55], v[160:163], 0
  v_mfma_f32_16x16x32_bf16 v[120:123], v[52:55], v[192:195], 0
  v_mfma_f32_16x16x32_bf16 v[124:127], v[52:55], v[224:227], 0
  ds_read_b128 v[52:55], v32 offset:18688
  s_waitcnt lgkmcnt(3)
  v_mfma_f32_16x16x32_bf16 v[112:115], v[56:59], v[132:135], v[112:115]
  v_mfma_f32_16x16x32_bf16 v[116:119], v[56:59], v[164:167], v[116:119]
  v_mfma_f32_16x16x32_bf16 v[120:123], v[56:59], v[196:199], v[120:123]
  v_mfma_f32_16x16x32_bf16 v[124:127], v[56:59], v[228:231], v[124:127]
  ds_read_b128 v[56:59], v33 offset:18688
  s_waitcnt lgkmcnt(3)
  v_mfma_f32_16x16x32_bf16 v[112:115], v[60:63], v[136:139], v[112:115]
  v_mfma_f32_16x16x32_bf16 v[116:119], v[60:63], v[168:171], v[116:119]
  v_mfma_f32_16x16x32_bf16 v[120:123], v[60:63], v[200:203], v[120:123]
  v_mfma_f32_16x16x32_bf16 v[124:127], v[60:63], v[232:235], v[124:127]
  ds_read_b128 v[60:63], v34 offset:18688
  s_waitcnt lgkmcnt(3)
  v_mfma_f32_16x16x32_bf16 v[112:115], v[64:67], v[140:143], v[112:115]
  v_mfma_f32_16x16x32_bf16 v[116:119], v[64:67], v[172:175], v[116:119]
  v_mfma_f32_16x16x32_bf16 v[120:123], v[64:67], v[204:207], v[120:123]
  v_mfma_f32_16x16x32_bf16 v[124:127], v[64:67], v[236:239], v[124:127]
  ds_read_b128 v[64:67], v35 offset:18688
  s_waitcnt lgkmcnt(3)
  v_mfma_f32_16x16x32_bf16 v[112:115], v[52:55], v[144:147], v[112:115]
  v_mfma_f32_16x16x32_bf16 v[116:119], v[52:55], v[176:179], v[116:119]
  v_mfma_f32_16x16x32_bf16 v[120:123], v[52:55], v[208:211], v[120:123]
  v_mfma_f32_16x16x32_bf16 v[124:127], v[52:55], v[240:243], v[124:127]
  s_waitcnt lgkmcnt(2)
  v_mfma_f32_16x16x32_bf16 v[112:115], v[56:59], v[148:151], v[112:115]
  v_mfma_f32_16x16x32_bf16 v[116:119], v[56:59], v[180:183], v[116:119]
  v_mfma_f32_16x16x32_bf16 v[120:123], v[56:59], v[212:215], v[120:123]
  v_mfma_f32_16x16x32_bf16 v[124:127], v[56:59], v[244:247], v[124:127]
  s_waitcnt lgkmcnt(1)
  v_mfma_f32_16x16x32_bf16 v[112:115], v[60:63], v[152:155], v[112:115]
  v_mfma_f32_16x16x32_bf16 v[116:119], v[60:63], v[184:187], v[116:119]
  v_mfma_f32_16x16x32_bf16 v[120:123], v[60:63], v[216:219], v[120:123]
  v_mfma_f32_16x16x32_bf16 v[124:127], v[60:63], v[248:251], v[124:127]
  s_waitcnt lgkmcnt(0)
  v_mfma_f32_16x16x32_bf16 v[112:115], v[64:67], v[156:159], v[112:115]
  v_mfma_f32_16x16x32_bf16 v[116:119], v[64:67], v[188:191], v[116:119]
  v_mfma_f32_16x16x32_bf16 v[120:123], v[64:67], v[220:223], v[120:123]
  v_mfma_f32_16x16x32_bf16 v[124:127], v[64:67], v[252:255], v[124:127]
  s_lshl_b32 s30, s29, 10
  v_mul_f32 v96, s24, v96
  v_mul_f32 v97, s24, v97
  v_mul_f32 v98, s24, v98
  v_mul_f32 v99, s24, v99
  v_cvt_pk_bf16_f32 v68, v96, v97
  v_cvt_pk_bf16_f32 v69, v98, v99
  v_mul_f32 v112, s24, v112
  v_mul_f32 v113, s24, v113
  v_mul_f32 v114, s24, v114
  v_mul_f32 v115, s24, v115
  v_cvt_pk_bf16_f32 v70, v112, v113
  v_cvt_pk_bf16_f32 v71, v114, v115
  buffer_store_dwordx4 v[68:71], v12, s[8:11], s30 offen sc1
  v_mul_f32 v100, s24, v100
  v_mul_f32 v101, s24, v101
  v_mul_f32 v102, s24, v102
  v_mul_f32 v103, s24, v103
  v_cvt_pk_bf16_f32 v72, v100, v101
  v_cvt_pk_bf16_f32 v73, v102, v103
  v_mul_f32 v116, s24, v116
  v_mul_f32 v117, s24, v117
  v_mul_f32 v118, s24, v118
  v_mul_f32 v119, s24, v119
  v_cvt_pk_bf16_f32 v74, v116, v117
  v_cvt_pk_bf16_f32 v75, v118, v119
  buffer_store_dwordx4 v[72:75], v13, s[8:11], s30 offen sc1
  v_mul_f32 v104, s24, v104
  v_mul_f32 v105, s24, v105
  v_mul_f32 v106, s24, v106
  v_mul_f32 v107, s24, v107
  v_cvt_pk_bf16_f32 v76, v104, v105
  v_cvt_pk_bf16_f32 v77, v106, v107
  v_mul_f32 v120, s24, v120
  v_mul_f32 v121, s24, v121
  v_mul_f32 v122, s24, v122
  v_mul_f32 v123, s24, v123
  v_cvt_pk_bf16_f32 v78, v120, v121
  v_cvt_pk_bf16_f32 v79, v122, v123
  buffer_store_dwordx4 v[76:79], v14, s[8:11], s30 offen sc1
  v_mul_f32 v108, s24, v108
  v_mul_f32 v109, s24, v109
  v_mul_f32 v110, s24, v110
  v_mul_f32 v111, s24, v111
  v_cvt_pk_bf16_f32 v80, v108, v109
  v_cvt_pk_bf16_f32 v81, v110, v111
  v_mul_f32 v124, s24, v124
  v_mul_f32 v125, s24, v125
  v_mul_f32 v126, s24, v126
  v_mul_f32 v127, s24, v127
  v_cvt_pk_bf16_f32 v82, v124, v125
  v_cvt_pk_bf16_f32 v83, v126, v127
  buffer_store_dwordx4 v[80:83], v15, s[8:11], s30 offen sc1
aj_w3:
  s_lshl_b32 s28, s17, 7
  s_lshl_b32 s21, s19, 4
  s_add_u32 s28, s28, s21
  s_cmp_lg_u32 s31, 0
  s_cselect_b32 s21, 8, 0
  s_add_u32 s28, s28, s21
  s_add_u32 s28, s28, 88633344
  s_waitcnt vmcnt(0)
  s_barrier
  s_cmp_lg_u32 s16, 0
  s_cbranch_scc1 pub_48
  v_mul_u32_u24 v26, 2048, v1
  v_mov_b32 v24, s88
  v_mov_b32 v25, s89
  s_mov_b64 exec, 1
  buffer_store_dwordx2 v[24:25], v26, s[8:11], s28 offen sc1
  s_mov_b64 exec, -1
pub_48:
  v_mov_b32 v250, 0
  s_branch wk_loop
wk_srv:
  s_sub_u32 s3, s3, 224
  s_and_b32 s18, s3, 15
  s_lshr_b32 s19, s3, 4
  s_and_b32 s19, s19, 1
  s_mul_i32 s20, s18, 401408
  s_add_u32 s20, s20, 6422528
  s_mul_i32 s21, s16, 43008
  s_add_u32 s21, s21, s20
  s_mul_i32 s22, s16, 57344
  s_add_u32 s20, s20, s22
  s_add_u32 s22, s20, 0
  buffer_load_dwordx4 a[0:3], v2, s[8:11], s22 offen offset:0 sc1
  buffer_load_dwordx4 a[4:7], v2, s[8:11], s22 offen offset:1024 sc1
  buffer_load_dwordx4 a[8:11], v2, s[8:11], s22 offen offset:2048 sc1
  buffer_load_dwordx4 a[12:15], v2, s[8:11], s22 offen offset:3072 sc1
  s_add_u32 s22, s20, 4096
  buffer_load_dwordx4 a[16:19], v2, s[8:11], s22 offen offset:0 sc1
  buffer_load_dwordx4 a[20:23], v2, s[8:11], s22 offen offset:1024 sc1
  buffer_load_dwordx4 a[24:27], v2, s[8:11], s22 offen offset:2048 sc1
  buffer_load_dwordx4 a[28:31], v2, s[8:11], s22 offen offset:3072 sc1
  s_add_u32 s22, s20, 8192
  buffer_load_dwordx4 a[32:35], v2, s[8:11], s22 offen offset:0 sc1
  buffer_load_dwordx4 a[36:39], v2, s[8:11], s22 offen offset:1024 sc1
  buffer_load_dwordx4 a[40:43], v2, s[8:11], s22 offen offset:2048 sc1
  buffer_load_dwordx4 a[44:47], v2, s[8:11], s22 offen offset:3072 sc1
  s_add_u32 s22, s20, 12288
  buffer_load_dwordx4 a[48:51], v2, s[8:11], s22 offen offset:0 sc1
  buffer_load_dwordx4 a[52:55], v2, s[8:11], s22 offen offset:1024 sc1
  buffer_load_dwordx4 a[56:59], v2, s[8:11], s22 offen offset:2048 sc1
  buffer_load_dwordx4 a[60:63], v2, s[8:11], s22 offen offset:3072 sc1
  s_add_u32 s22, s20, 16384
  buffer_load_dwordx4 a[64:67], v2, s[8:11], s22 offen offset:0 sc1
  buffer_load_dwordx4 a[68:71], v2, s[8:11], s22 offen offset:1024 sc1
  buffer_load_dwordx4 a[72:75], v2, s[8:11], s22 offen offset:2048 sc1
  buffer_load_dwordx4 a[76:79], v2, s[8:11], s22 offen offset:3072 sc1
  s_add_u32 s22, s20, 20480
  buffer_load_dwordx4 a[80:83], v2, s[8:11], s22 offen offset:0 sc1
  buffer_load_dwordx4 a[84:87], v2, s[8:11], s22 offen offset:1024 sc1
  buffer_load_dwordx4 a[88:91], v2, s[8:11], s22 offen offset:2048 sc1
  buffer_load_dwordx4 a[92:95], v2, s[8:11], s22 offen offset:3072 sc1
  s_add_u32 s22, s20, 24576
  buffer_load_dwordx4 a[96:99], v2, s[8:11], s22 offen offset:0 sc1
  buffer_load_dwordx4 a[100:103], v2, s[8:11], s22 offen offset:1024 sc1
  buffer_load_dwordx4 a[104:107], v2, s[8:11], s22 offen offset:2048 sc1
  buffer_load_dwordx4 a[108:111], v2, s[8:11], s22 offen offset:3072 sc1
  s_add_u32 s22, s20, 28672
  buffer_load_dwordx4 a[112:115], v2, s[8:11], s22 offen offset:0 sc1
  buffer_load_dwordx4 a[116:119], v2, s[8:11], s22 offen offset:1024 sc1
  buffer_load_dwordx4 a[120:123], v2, s[8:11], s22 offen offset:2048 sc1
  buffer_load_dwordx4 a[124:127], v2, s[8:11], s22 offen offset:3072 sc1
  s_waitcnt vmcnt(24)
  s_add_u32 s22, s20, 32768
  buffer_load_dwordx4 a[128:131], v2, s[8:11], s22 offen offset:0 sc1
  buffer_load_dwordx4 a[132:135], v2, s[8:11], s22 offen offset:1024 sc1
  buffer_load_dwordx4 a[136:139], v2, s[8:11], s22 offen offset:2048 sc1
  buffer_load_dwordx4 a[140:143], v2, s[8:11], s22 offen offset:3072 sc1
  s_add_u32 s22, s20, 36864
  buffer_load_dwordx4 a[144:147], v2, s[8:11], s22 offen offset:0 sc1
  buffer_load_dwordx4 a[148:151], v2, s[8:11], s22 offen offset:1024 sc1
  buffer_load_dwordx4 a[152:155], v2, s[8:11], s22 offen offset:2048 sc1
  buffer_load_dwordx4 a[156:159], v2, s[8:11], s22 offen offset:3072 sc1
  s_add_u32 s22, s20, 40960
  buffer_load_dwordx4 a[160:163], v2, s[8:11], s22 offen offset:0 sc1
  buffer_load_dwordx4 a[164:167], v2, s[8:11], s22 offen offset:1024 sc1
  buffer_load_dwordx4 a[168:171], v2, s[8:11], s22 offen offset:2048 sc1
  buffer_load_dwordx4 a[172:175], v2, s[8:11], s22 offen offset:3072 sc1
  s_add_u32 s22, s20, 45056
  buffer_load_dwordx4 a[176:179], v2, s[8:11], s22 offen offset:0 sc1
  buffer_load_dwordx4 a[180:183], v2, s[8:11], s22 offen offset:1024 sc1
  buffer_load_dwordx4 a[184:187], v2, s[8:11], s22 offen offset:2048 sc1
  buffer_load_dwordx4 a[188:191], v2, s[8:11], s22 offen offset:3072 sc1
  s_add_u32 s22, s20, 49152
  buffer_load_dwordx4 a[192:195], v2, s[8:11], s22 offen offset:0 sc1
  buffer_load_dwordx4 a[196:199], v2, s[8:11], s22 offen offset:1024 sc1
  buffer_load_dwordx4 a[200:203], v2, s[8:11], s22 offen offset:2048 sc1
  buffer_load_dwordx4 a[204:207], v2, s[8:11], s22 offen offset:3072 sc1
  s_add_u32 s22, s20, 53248
  buffer_load_dwordx4 a[208:211], v2, s[8:11], s22 offen offset:0 sc1
  buffer_load_dwordx4 a[212:215], v2, s[8:11], s22 offen offset:1024 sc1
  buffer_load_dwordx4 a[216:219], v2, s[8:11], s22 offen offset:2048 sc1
  buffer_load_dwordx4 a[220:223], v2, s[8:11], s22 offen offset:3072 sc1
  s_add_u32 s22, s21, 229376
  buffer_load_dwordx4 a[224:227], v2, s[8:11], s22 offen offset:0 sc1
  buffer_load_dwordx4 a[228:231], v2, s[8:11], s22 offen offset:1024 sc1
  buffer_load_dwordx4 a[232:235], v2, s[8:11], s22 offen offset:2048 sc1
  buffer_load_dwordx4 a[236:239], v2, s[8:11], s22 offen offset:3072 sc1
  s_add_u32 s22, s21, 233472
  buffer_load_dwordx4 a[240:243], v2, s[8:11], s22 offen offset:0 sc1
  buffer_load_dwordx4 a[244:247], v2, s[8:11], s22 offen offset:1024 sc1
  buffer_load_dwordx4 a[248:251], v2, s[8:11], s22 offen offset:2048 sc1
  buffer_load_dwordx4 a[252:255], v2, s[8:11], s22 offen offset:3072 sc1
  s_waitcnt vmcnt(24)
  s_add_u32 s22, s21, 237568
  buffer_load_dwordx4 v[120:123], v2, s[8:11], s22 offen offset:0 sc1
  buffer_load_dwordx4 v[124:127], v2, s[8:11], s22 offen offset:1024 sc1
  buffer_load_dwordx4 v[128:131], v2, s[8:11], s22 offen offset:2048 sc1
  buffer_load_dwordx4 v[132:135], v2, s[8:11], s22 offen offset:3072 sc1
  s_add_u32 s22, s21, 241664
  buffer_load_dwordx4 v[136:139], v2, s[8:11], s22 offen offset:0 sc1
  buffer_load_dwordx4 v[140:143], v2, s[8:11], s22 offen offset:1024 sc1
  buffer_load_dwordx4 v[144:147], v2, s[8:11], s22 offen offset:2048 sc1
  buffer_load_dwordx4 v[148:151], v2, s[8:11], s22 offen offset:3072 sc1
  s_add_u32 s22, s21, 245760
  buffer_load_dwordx4 v[152:155], v2, s[8:11], s22 offen offset:0 sc1
  buffer_load_dwordx4 v[156:159], v2, s[8:11], s22 offen offset:1024 sc1
  buffer_load_dwordx4 v[160:163], v2, s[8:11], s22 offen offset:2048 sc1
  buffer_load_dwordx4 v[164:167], v2, s[8:11], s22 offen offset:3072 sc1
  s_add_u32 s22, s21, 249856
  buffer_load_dwordx4 v[168:171], v2, s[8:11], s22 offen offset:0 sc1
  buffer_load_dwordx4 v[172:175], v2, s[8:11], s22 offen offset:1024 sc1
  buffer_load_dwordx4 v[176:179], v2, s[8:11], s22 offen offset:2048 sc1
  buffer_load_dwordx4 v[180:183], v2, s[8:11], s22 offen offset:3072 sc1
  s_add_u32 s22, s21, 253952
  buffer_load_dwordx4 v[184:187], v2, s[8:11], s22 offen offset:0 sc1
  buffer_load_dwordx4 v[188:191], v2, s[8:11], s22 offen offset:1024 sc1
  buffer_load_dwordx4 v[192:195], v2, s[8:11], s22 offen offset:2048 sc1
  buffer_load_dwordx4 v[196:199], v2, s[8:11], s22 offen offset:3072 sc1
  s_add_u32 s22, s21, 258048
  buffer_load_dwordx4 v[200:203], v2, s[8:11], s22 offen offset:0 sc1
  buffer_load_dwordx4 v[204:207], v2, s[8:11], s22 offen offset:1024 sc1
  buffer_load_dwordx4 v[208:211], v2, s[8:11], s22 offen offset:2048 sc1
  buffer_load_dwordx4 v[212:215], v2, s[8:11], s22 offen offset:3072 sc1
  s_add_u32 s22, s21, 262144
  buffer_load_dwordx4 v[216:219], v2, s[8:11], s22 offen offset:0 sc1
  buffer_load_dwordx4 v[220:223], v2, s[8:11], s22 offen offset:1024 sc1
  buffer_load_dwordx4 v[224:227], v2, s[8:11], s22 offen offset:2048 sc1
  buffer_load_dwordx4 v[228:231], v2, s[8:11], s22 offen offset:3072 sc1
  s_add_u32 s22, s21, 266240
  buffer_load_dwordx4 v[232:235], v2, s[8:11], s22 offen offset:0 sc1
  buffer_load_dwordx4 v[236:239], v2, s[8:11], s22 offen offset:1024 sc1
  buffer_load_dwordx4 v[240:243], v2, s[8:11], s22 offen offset:2048 sc1
  buffer_load_dwordx4 v[244:247], v2, s[8:11], s22 offen offset:3072 sc1
  s_waitcnt vmcnt(24)
  s_add_u32 s22, s21, 270336
  buffer_load_dwordx4 v[248:251], v2, s[8:11], s22 offen offset:0 sc1
  buffer_load_dwordx4 v[252:255], v2, s[8:11], s22 offen offset:1024 sc1
  v_mov_b32 v5, 0x4444
  v_mov_b32 v6, 0xeeee
  v_cmp_lt_u32 vcc, 7, v4
  s_nop 1
  v_cndmask_b32 v5, v5, v6, vcc
  s_lshl_b32 s23, s16, 11
  v_lshrrev_b32 v80, 1, v3
  v_and_b32 v81, 1, v3
  v_add_u32 v83, 0, v80
  v_mov_b32 v84, v4
  v_mov_b32 v86, 0
  v_lshl_add_u32 v86, v83, 8, v86
  v_lshl_add_u32 v86, v84, 4, v86
  v_lshl_add_u32 v86, v81, 3, v86
  v_add_u32 v72, s23, v86
  v_add_u32 v83, 2, v80
  v_mov_b32 v84, v4
  v_mov_b32 v86, 0
  v_lshl_add_u32 v86, v83, 8, v86
  v_lshl_add_u32 v86, v84, 4, v86
  v_lshl_add_u32 v86, v81, 3, v86
  v_add_u32 v73, s23, v86
  v_lshl_add_u32 v82, v80, 4, v4
  v_mul_u32_u24 v83, 5462, v82
  v_lshrrev_b32 v83, 16, v83
  v_mul_u32_u24 v84, 12, v83
  v_sub_u32 v84, v82, v84
  v_mov_b32 v86, 1024
  v_lshl_add_u32 v86, v83, 8, v86
  v_lshl_add_u32 v86, v84, 4, v86
  v_lshl_add_u32 v86, v81, 3, v86
  v_add_u32 v74, s23, v86
  v_add_u32 v82, 32, v4
  v_mul_u32_u24 v83, 5462, v82
  v_lshrrev_b32 v83, 16, v83
  v_mul_u32_u24 v84, 12, v83
  v_sub_u32 v84, v82, v84
  v_mov_b32 v86, 1024
  v_lshl_add_u32 v86, v83, 8, v86
  v_lshl_add_u32 v86, v84, 4, v86
  v_lshl_add_u32 v86, v81, 3, v86
  v_add_u32 v75, s23, v86
  v_add_u32 v76, s23, v2
  s_mul_i32 s27, s18, 448
  v_mov_b32 v77, s27
  v_mov_b32 v78, 1
  s_mov_b32 s17, s19
  s_mul_i32 s24, s19, 7168
  s_add_u32 s24, s24, 88080384
  s_mul_i32 s25, s18, 65
  s_add_u32 s25, s25, s19
  s_lshl_b32 s25, s25, 13
  s_add_u32 s25, s25, s23
  s_add_u32 s25, s25, 76947456
  s_lshl_b32 s26, s18, 6
  s_add_u32 s26, s26, s19
  s_lshl_b32 s26, s26, 4
  s_lshl_b32 s27, s16, 2
  s_add_u32 s26, s26, s27
  s_add_u32 s26, s26, 88582144
  v_mov_b32 v87, -1
ws_loop:
  v_mov_b32 v36, 0
  v_mov_b32 v37, 0
  v_mov_b32 v38, 0
  v_mov_b32 v39, 0
  v_mov_b32 v40, 0
  v_mov_b32 v41, 0
  v_mov_b32 v42, 0
  v_mov_b32 v43, 0
  v_mov_b32 v44, 0
  v_mov_b32 v45, 0
  v_mov_b32 v46, 0
  v_mov_b32 v47, 0
  v_mov_b32 v48, 0
  v_mov_b32 v49, 0
  v_mov_b32 v50, 0
  v_mov_b32 v51, 0
  v_mov_b32 v52, 0
  v_mov_b32 v53, 0
  v_mov_b32 v54, 0
  v_mov_b32 v55, 0
  v_mov_b32 v56, 0
  v_mov_b32 v57, 0
  v_mov_b32 v58, 0
  v_mov_b32 v59, 0
  v_mov_b32 v60, 0
  v_mov_b32 v61, 0
  v_mov_b32 v62, 0
  v_mov_b32 v63, 0
  s_mov_b32 s30, 0
  v_cmp_eq_u32 vcc, -1, v87
  s_cbranch_vccz ws_fl
ws_pm:
  s_cmp_ge_u32 s17, 61
  s_cbranch_scc1 mp_49a
  v_mov_b32 v79, 0
  s_mov_b64 exec, 1
  buffer_atomic_or v79, v77, s[8:11], s24 offen sc0
  s_mov_b64 exec, -1
  s_branch mp_49b
mp_49a:
  buffer_load_dword v79, v77, s[8:11], s24 offen sc1
mp_49b:
  s_waitcnt vmcnt(0)
  v_cmp_eq_u32 vcc, -1, v79
  s_cbranch_vccnz ws_pr
ws_fl:
  s_add_u32 s22, s24, 4096
  buffer_load_dwordx4 v[8:11], v2, s[8:11], s24 offen offset:0 sc1
  buffer_load_dwordx4 v[12:15], v2, s[8:11], s24 offen offset:1024 sc1
  buffer_load_dwordx4 v[16:19], v2, s[8:11], s24 offen offset:2048 sc1
  buffer_load_dwordx4 v[20:23], v2, s[8:11], s24 offen offset:3072 sc1
  buffer_load_dwordx4 v[24:27], v2, s[8:11], s22 offen offset:0 sc1
  buffer_load_dwordx4 v[28:31], v2, s[8:11], s22 offen offset:1024 sc1
  buffer_load_dwordx4 v[32:35], v2, s[8:11], s22 offen offset:2048 sc1
  s_waitcnt vmcnt(0)
  v_max_u32 v79, v8, v9
  v_max3_u32 v79, v79, v10, v11
  v_max3_u32 v79, v79, v12, v13
  v_max3_u32 v79, v79, v14, v15
  v_max3_u32 v79, v79, v16, v17
  v_max3_u32 v79, v79, v18, v19
  v_max3_u32 v79, v79, v20, v21
  v_max3_u32 v79, v79, v22, v23
  v_max3_u32 v79, v79, v24, v25
  v_max3_u32 v79, v79, v26, v27
  v_max3_u32 v79, v79, v28, v29
  v_max3_u32 v79, v79, v30, v31
  v_max3_u32 v79, v79, v32, v33
  v_max3_u32 v79, v79, v34, v35
  v_cmp_eq_u32 vcc, -1, v79
  s_cbranch_vccz ws_pk
ws_pr:
  s_sleep 1
  s_cmp_ge_u32 s17, 61
  s_cbranch_scc1 ws_sh
  s_sleep 6
ws_sh:
  s_add_u32 s30, s30, 1
  s_cmp_lt_u32 s30, 30000
  s_cbranch_scc1 ws_pm
  s_branch cA_abort
ws_pk:
  s_cmp_ge_u32 s17, 62
  s_cbranch_scc1 ws_na
  s_add_u32 s22, s24, 14336
  s_cmp_ge_u32 s17, 61
  s_cbranch_scc1 mp_50a
  v_mov_b32 v87, 0
  s_mov_b64 exec, 1
  buffer_atomic_or v87, v77, s[8:11], s22 offen sc0
  s_mov_b64 exec, -1
  s_branch mp_50b
mp_50a:
  buffer_load_dword v87, v77, s[8:11], s22 offen sc1
mp_50b:
ws_na:
  v_smfmac_f32_16x16x64_bf16 v[36:39], v[8:11], a[0:7], v5
  v_smfmac_f32_16x16x64_bf16 v[36:39], v[12:15], a[8:15], v5
  v_smfmac_f32_16x16x64_bf16 v[36:39], v[16:19], a[16:23], v5
  v_smfmac_f32_16x16x64_bf16 v[36:39], v[20:23], a[24:31], v5
  v_smfmac_f32_16x16x64_bf16 v[36:39], v[24:27], a[32:39], v5
  v_smfmac_f32_16x16x64_bf16 v[36:39], v[28:31], a[40:47], v5
  v_smfmac_f32_16x16x64_bf16 v[36:39], v[32:35], a[48:55], v5
  v_smfmac_f32_16x16x64_bf16 v[40:43], v[8:11], a[56:63], v5
  v_smfmac_f32_16x16x64_bf16 v[40:43], v[12:15], a[64:71], v5
  v_smfmac_f32_16x16x64_bf16 v[40:43], v[16:19], a[72:79], v5
  v_smfmac_f32_16x16x64_bf16 v[40:43], v[20:23], a[80:87], v5
  v_smfmac_f32_16x16x64_bf16 v[40:43], v[24:27], a[88:95], v5
  v_smfmac_f32_16x16x64_bf16 v[40:43], v[28:31], a[96:103], v5
  v_smfmac_f32_16x16x64_bf16 v[40:43], v[32:35], a[104:111], v5
  v_smfmac_f32_16x16x64_bf16 v[44:47], v[8:11], a[112:119], v5
  v_smfmac_f32_16x16x64_bf16 v[44:47], v[12:15], a[120:127], v5
  v_smfmac_f32_16x16x64_bf16 v[44:47], v[16:19], a[128:135], v5
  v_smfmac_f32_16x16x64_bf16 v[44:47], v[20:23], a[136:143], v5
  v_smfmac_f32_16x16x64_bf16 v[44:47], v[24:27], a[144:151], v5
  v_smfmac_f32_16x16x64_bf16 v[44:47], v[28:31], a[152:159], v5
  v_smfmac_f32_16x16x64_bf16 v[44:47], v[32:35], a[160:167], v5
  v_smfmac_f32_16x16x64_bf16 v[48:51], v[8:11], a[168:175], v5
  v_smfmac_f32_16x16x64_bf16 v[48:51], v[12:15], a[176:183], v5
  v_smfmac_f32_16x16x64_bf16 v[48:51], v[16:19], a[184:191], v5
  v_smfmac_f32_16x16x64_bf16 v[48:51], v[20:23], a[192:199], v5
  v_smfmac_f32_16x16x64_bf16 v[48:51], v[24:27], a[200:207], v5
  v_smfmac_f32_16x16x64_bf16 v[48:51], v[28:31], a[208:215], v5
  v_smfmac_f32_16x16x64_bf16 v[48:51], v[32:35], a[216:223], v5
  v_smfmac_f32_16x16x64_bf16 v[52:55], v[8:11], a[224:231], v5
  v_smfmac_f32_16x16x64_bf16 v[52:55], v[12:15], a[232:239], v5
  v_smfmac_f32_16x16x64_bf16 v[52:55], v[16:19], a[240:247], v5
  v_smfmac_f32_16x16x64_bf16 v[52:55], v[20:23], a[248:255], v5
  v_smfmac_f32_16x16x64_bf16 v[52:55], v[24:27], v[120:127], v5
  v_smfmac_f32_16x16x64_bf16 v[52:55], v[28:31], v[128:135], v5
  v_smfmac_f32_16x16x64_bf16 v[52:55], v[32:35], v[136:143], v5
  v_smfmac_f32_16x16x64_bf16 v[56:59], v[8:11], v[144:151], v5
  v_smfmac_f32_16x16x64_bf16 v[56:59], v[12:15], v[152:159], v5
  v_smfmac_f32_16x16x64_bf16 v[56:59], v[16:19], v[160:167], v5
  v_smfmac_f32_16x16x64_bf16 v[56:59], v[20:23], v[168:175], v5
  v_smfmac_f32_16x16x64_bf16 v[56:59], v[24:27], v[176:183], v5
  v_smfmac_f32_16x16x64_bf16 v[56:59], v[28:31], v[184:191], v5
  v_smfmac_f32_16x16x64_bf16 v[56:59], v[32:35], v[192:199], v5
  v_smfmac_f32_16x16x64_bf16 v[60:63], v[8:11], v[200:207], v5
  v_smfmac_f32_16x16x64_bf16 v[60:63], v[12:15], v[208:215], v5
  v_smfmac_f32_16x16x64_bf16 v[60:63], v[16:19], v[216:223], v5
  v_smfmac_f32_16x16x64_bf16 v[60:63], v[20:23], v[224:231], v5
  v_smfmac_f32_16x16x64_bf16 v[60:63], v[24:27], v[232:239], v5
  v_smfmac_f32_16x16x64_bf16 v[60:63], v[28:31], v[240:247], v5
  v_smfmac_f32_16x16x64_bf16 v[60:63], v[32:35], v[248:255], v5
  v_permlane32_swap_b32 v36, v40
  v_permlane32_swap_b32 v37, v41
  v_permlane32_swap_b32 v38, v42
  v_permlane32_swap_b32 v39, v43
  v_add_f32 v36, v36, v40
  v_add_f32 v37, v37, v41
  v_add_f32 v38, v38, v42
  v_add_f32 v39, v39, v43
  v_cvt_pk_bf16_f32 v40, v36, v37
  v_cvt_pk_bf16_f32 v41, v38, v39
  ds_write_b64 v72, v[40:41]
  v_permlane32_swap_b32 v44, v48
  v_permlane32_swap_b32 v45, v49
  v_permlane32_swap_b32 v46, v50
  v_permlane32_swap_b32 v47, v51
  v_add_f32 v44, v44, v48
  v_add_f32 v45, v45, v49
  v_add_f32 v46, v46, v50
  v_add_f32 v47, v47, v51
  v_cvt_pk_bf16_f32 v48, v44, v45
  v_cvt_pk_bf16_f32 v49, v46, v47
  ds_write_b64 v73, v[48:49]
  v_permlane32_swap_b32 v52, v56
  v_permlane32_swap_b32 v53, v57
  v_permlane32_swap_b32 v54, v58
  v_permlane32_swap_b32 v55, v59
  v_add_f32 v52, v52, v56
  v_add_f32 v53, v53, v57
  v_add_f32 v54, v54, v58
  v_add_f32 v55, v55, v59
  v_cvt_pk_bf16_f32 v56, v52, v53
  v_cvt_pk_bf16_f32 v57, v54, v55
  ds_write_b64 v74, v[56:57]
  v_mov_b32 v64, v60
  v_mov_b32 v65, v61
  v_mov_b32 v66, v62
  v_mov_b32 v67, v63
  v_permlane32_swap_b32 v60, v64
  v_permlane32_swap_b32 v61, v65
  v_permlane32_swap_b32 v62, v66
  v_permlane32_swap_b32 v63, v67
  v_add_f32 v60, v60, v64
  v_add_f32 v61, v61, v65
  v_add_f32 v62, v62, v66
  v_add_f32 v63, v63, v67
  v_cvt_pk_bf16_f32 v64, v60, v61
  v_cvt_pk_bf16_f32 v65, v62, v63
  ds_write_b64 v75, v[64:65]
  s_waitcnt lgkmcnt(0)
  ds_read_b128 v[64:67], v76
  ds_read_b128 v[68:71], v76 offset:1024
  s_waitcnt lgkmcnt(0)
  buffer_store_dwordx4 v[64:67], v2, s[8:11], s25 offen sc1
  buffer_store_dwordx4 v[68:71], v2, s[8:11], s25 offen offset:1024 sc1
  s_waitcnt vmcnt(0)
  s_mov_b64 exec, 1
  buffer_store_dword v78, v2, s[8:11], s26 offen sc1
  s_mov_b64 exec, -1
  s_add_u32 s24, s24, 14336
  s_add_u32 s25, s25, 16384
  s_add_u32 s26, s26, 32
  s_add_u32 s17, s17, 2
  s_cmp_lt_u32 s17, 64
  s_cbranch_scc1 ws_loop
  v_mov_b32 v250, 0
  s_branch wk_loop
wk_s4d:
  s_cmp_lg_u32 s16, 0
  s_cbranch_scc1 w0_51
  s_getreg_b32 s20, hwreg(HW_REG_XCC_ID)
  s_sub_u32 s20, s20, 1
  s_and_b32 s20, s20, 7
  s_mov_b64 exec, 1
s4_l:
  s_cmp_ge_u32 s20, 7
  s_cselect_b32 s20, 0, s20
  s_lshl_b32 s21, s20, 7
  s_add_u32 s21, s21, 88598528
  v_mov_b32 v242, 1
  buffer_atomic_add v242, off, s[8:11], s21 sc0
  s_waitcnt vmcnt(0)
  v_readfirstlane_b32 s21, v242
  s_lshl_b32 s22, s20, 4
  s_add_u32 s20, s20, 1
  s_cmp_ge_u32 s21, 16
  s_cbranch_scc1 s4_l
  v_add_u32 v242, s22, v242
  s_mov_b64 exec, -1
w0_51:
  v_mov_b32 v243, 160000
  s_add_u32 s101, s101, 1
  s_barrier
  s_mov_b64 exec, 1
  s_cmp_lg_u32 s16, 0
  s_cbranch_scc1 w0_52
  ds_write_b32 v243, v242 offset:0
  s_waitcnt lgkmcnt(0)
  v_mov_b32 v242, s101
  ds_write_b32 v243, v242 offset:16
  s_waitcnt lgkmcnt(0)
w0_52:
  s_mov_b64 exec, -1
  s_barrier
  ds_read_b32 v242, v243 offset:0
  ds_read_b32 v243, v243 offset:16
  s_waitcnt lgkmcnt(0)
  v_readfirstlane_b32 s3, v242
  v_cmp_ne_u32 vcc, s101, v243
  s_cbranch_vccnz ch_end
  s_load_dwordx8 s[40:47], s[0:1], 0
  s_load_dwordx4 s[48:51], s[0:1], 32
  s_load_dwordx2 s[52:53], s[0:1], 48
  s_load_dwordx2 s[54:55], s[0:1], 112
  v_lshrrev_b32 v1, 6, v0
  s_nop 0
  v_readfirstlane_b32 s16, v1
  v_and_b32 v1, 63, v0
  v_lshrrev_b32 v3, 4, v1
  v_and_b32 v4, 15, v1
  s_mul_i32 s17, s16, 24576
  s_waitcnt lgkmcnt(0)
  s_mov_b32 s60, s40
  s_and_b32 s61, s41, 0xffff
  s_mov_b32 s62, 1835008
  s_mov_b32 s63, 0x20000
  s_mov_b32 s64, s42
  s_and_b32 s65, s43, 0xffff
  s_mov_b32 s66, 229376
  s_mov_b32 s67, 0x20000
  s_mov_b32 s68, s44
  s_and_b32 s69, s45, 0xffff
  s_mov_b32 s70, 229376
  s_mov_b32 s71, 0x20000
  s_mov_b32 s72, s46
  s_and_b32 s73, s47, 0xffff
  s_mov_b32 s74, 229376
  s_mov_b32 s75, 0x20000
  s_mov_b32 s76, s48
  s_and_b32 s77, s49, 0xffff
  s_mov_b32 s78, 229376
  s_mov_b32 s79, 0x20000
  s_mov_b32 s80, s50
  s_and_b32 s81, s51, 0xffff
  s_mov_b32 s82, 896
  s_mov_b32 s83, 0x20000
  s_mov_b32 s84, s52
  s_and_b32 s85, s53, 0xffff
  s_mov_b32 s86, 896
  s_mov_b32 s87, 0x20000
  s_mov_b32 s92, s54
  s_and_b32 s93, s55, 0xffff
  s_mov_b32 s94, 3670016
  s_mov_b32 s95, 0x20000
  v_lshlrev_b32 v5, 5, v1
  v_sub_u32 v5, 2047, v5
  s_add_u32 s18, s17, 13056
  v_subrev_u32 v6, 0, v5
  v_max_i32 v7, 0, v6
  v_cvt_f32_u32 v7, v7
  v_cvt_pk_bf16_f32 v8, v7, v7
  v_and_b32 v7, 0xffff0000, v8
  v_lshrrev_b32 v8, 23, v7
  v_subrev_u32 v8, 134, v8
  v_max_i32 v8, 0, v8
  v_cvt_u32_f32 v7, v7
  v_lshrrev_b32 v7, v8, v7
  v_lshl_add_u32 v7, v8, 8, v7
  v_lshl_add_u32 v200, v7, 2, s18
  v_subrev_u32 v6, 1, v5
  v_max_i32 v7, 0, v6
  v_cvt_f32_u32 v7, v7
  v_cvt_pk_bf16_f32 v8, v7, v7
  v_and_b32 v7, 0xffff0000, v8
  v_lshrrev_b32 v8, 23, v7
  v_subrev_u32 v8, 134, v8
  v_max_i32 v8, 0, v8
  v_cvt_u32_f32 v7, v7
  v_lshrrev_b32 v7, v8, v7
  v_lshl_add_u32 v7, v8, 8, v7
  v_lshl_add_u32 v201, v7, 2, s18
  v_subrev_u32 v6, 2, v5
  v_max_i32 v7, 0, v6
  v_cvt_f32_u32 v7, v7
  v_cvt_pk_bf16_f32 v8, v7, v7
  v_and_b32 v7, 0xffff0000, v8
  v_lshrrev_b32 v8, 23, v7
  v_subrev_u32 v8, 134, v8
  v_max_i32 v8, 0, v8
  v_cvt_u32_f32 v7, v7
  v_lshrrev_b32 v7, v8, v7
  v_lshl_add_u32 v7, v8, 8, v7
  v_lshl_add_u32 v202, v7, 2, s18
  v_subrev_u32 v6, 3, v5
  v_max_i32 v7, 0, v6
  v_cvt_f32_u32 v7, v7
  v_cvt_pk_bf16_f32 v8, v7, v7
  v_and_b32 v7, 0xffff0000, v8
  v_lshrrev_b32 v8, 23, v7
  v_subrev_u32 v8, 134, v8
  v_max_i32 v8, 0, v8
  v_cvt_u32_f32 v7, v7
  v_lshrrev_b32 v7, v8, v7
  v_lshl_add_u32 v7, v8, 8, v7
  v_lshl_add_u32 v203, v7, 2, s18
  v_subrev_u32 v6, 4, v5
  v_max_i32 v7, 0, v6
  v_cvt_f32_u32 v7, v7
  v_cvt_pk_bf16_f32 v8, v7, v7
  v_and_b32 v7, 0xffff0000, v8
  v_lshrrev_b32 v8, 23, v7
  v_subrev_u32 v8, 134, v8
  v_max_i32 v8, 0, v8
  v_cvt_u32_f32 v7, v7
  v_lshrrev_b32 v7, v8, v7
  v_lshl_add_u32 v7, v8, 8, v7
  v_lshl_add_u32 v204, v7, 2, s18
  v_subrev_u32 v6, 5, v5
  v_max_i32 v7, 0, v6
  v_cvt_f32_u32 v7, v7
  v_cvt_pk_bf16_f32 v8, v7, v7
  v_and_b32 v7, 0xffff0000, v8
  v_lshrrev_b32 v8, 23, v7
  v_subrev_u32 v8, 134, v8
  v_max_i32 v8, 0, v8
  v_cvt_u32_f32 v7, v7
  v_lshrrev_b32 v7, v8, v7
  v_lshl_add_u32 v7, v8, 8, v7
  v_lshl_add_u32 v205, v7, 2, s18
  v_subrev_u32 v6, 6, v5
  v_max_i32 v7, 0, v6
  v_cvt_f32_u32 v7, v7
  v_cvt_pk_bf16_f32 v8, v7, v7
  v_and_b32 v7, 0xffff0000, v8
  v_lshrrev_b32 v8, 23, v7
  v_subrev_u32 v8, 134, v8
  v_max_i32 v8, 0, v8
  v_cvt_u32_f32 v7, v7
  v_lshrrev_b32 v7, v8, v7
  v_lshl_add_u32 v7, v8, 8, v7
  v_lshl_add_u32 v206, v7, 2, s18
  v_subrev_u32 v6, 7, v5
  v_max_i32 v7, 0, v6
  v_cvt_f32_u32 v7, v7
  v_cvt_pk_bf16_f32 v8, v7, v7
  v_and_b32 v7, 0xffff0000, v8
  v_lshrrev_b32 v8, 23, v7
  v_subrev_u32 v8, 134, v8
  v_max_i32 v8, 0, v8
  v_cvt_u32_f32 v7, v7
  v_lshrrev_b32 v7, v8, v7
  v_lshl_add_u32 v7, v8, 8, v7
  v_lshl_add_u32 v207, v7, 2, s18
  v_subrev_u32 v6, 8, v5
  v_max_i32 v7, 0, v6
  v_cvt_f32_u32 v7, v7
  v_cvt_pk_bf16_f32 v8, v7, v7
  v_and_b32 v7, 0xffff0000, v8
  v_lshrrev_b32 v8, 23, v7
  v_subrev_u32 v8, 134, v8
  v_max_i32 v8, 0, v8
  v_cvt_u32_f32 v7, v7
  v_lshrrev_b32 v7, v8, v7
  v_lshl_add_u32 v7, v8, 8, v7
  v_lshl_add_u32 v208, v7, 2, s18
  v_subrev_u32 v6, 9, v5
  v_max_i32 v7, 0, v6
  v_cvt_f32_u32 v7, v7
  v_cvt_pk_bf16_f32 v8, v7, v7
  v_and_b32 v7, 0xffff0000, v8
  v_lshrrev_b32 v8, 23, v7
  v_subrev_u32 v8, 134, v8
  v_max_i32 v8, 0, v8
  v_cvt_u32_f32 v7, v7
  v_lshrrev_b32 v7, v8, v7
  v_lshl_add_u32 v7, v8, 8, v7
  v_lshl_add_u32 v209, v7, 2, s18
  v_subrev_u32 v6, 10, v5
  v_max_i32 v7, 0, v6
  v_cvt_f32_u32 v7, v7
  v_cvt_pk_bf16_f32 v8, v7, v7
  v_and_b32 v7, 0xffff0000, v8
  v_lshrrev_b32 v8, 23, v7
  v_subrev_u32 v8, 134, v8
  v_max_i32 v8, 0, v8
  v_cvt_u32_f32 v7, v7
  v_lshrrev_b32 v7, v8, v7
  v_lshl_add_u32 v7, v8, 8, v7
  v_lshl_add_u32 v210, v7, 2, s18
  v_subrev_u32 v6, 11, v5
  v_max_i32 v7, 0, v6
  v_cvt_f32_u32 v7, v7
  v_cvt_pk_bf16_f32 v8, v7, v7
  v_and_b32 v7, 0xffff0000, v8
  v_lshrrev_b32 v8, 23, v7
  v_subrev_u32 v8, 134, v8
  v_max_i32 v8, 0, v8
  v_cvt_u32_f32 v7, v7
  v_lshrrev_b32 v7, v8, v7
  v_lshl_add_u32 v7, v8, 8, v7
  v_lshl_add_u32 v211, v7, 2, s18
  v_subrev_u32 v6, 12, v5
  v_max_i32 v7, 0, v6
  v_cvt_f32_u32 v7, v7
  v_cvt_pk_bf16_f32 v8, v7, v7
  v_and_b32 v7, 0xffff0000, v8
  v_lshrrev_b32 v8, 23, v7
  v_subrev_u32 v8, 134, v8
  v_max_i32 v8, 0, v8
  v_cvt_u32_f32 v7, v7
  v_lshrrev_b32 v7, v8, v7
  v_lshl_add_u32 v7, v8, 8, v7
  v_lshl_add_u32 v212, v7, 2, s18
  v_subrev_u32 v6, 13, v5
  v_max_i32 v7, 0, v6
  v_cvt_f32_u32 v7, v7
  v_cvt_pk_bf16_f32 v8, v7, v7
  v_and_b32 v7, 0xffff0000, v8
  v_lshrrev_b32 v8, 23, v7
  v_subrev_u32 v8, 134, v8
  v_max_i32 v8, 0, v8
  v_cvt_u32_f32 v7, v7
  v_lshrrev_b32 v7, v8, v7
  v_lshl_add_u32 v7, v8, 8, v7
  v_lshl_add_u32 v213, v7, 2, s18
  v_subrev_u32 v6, 14, v5
  v_max_i32 v7, 0, v6
  v_cvt_f32_u32 v7, v7
  v_cvt_pk_bf16_f32 v8, v7, v7
  v_and_b32 v7, 0xffff0000, v8
  v_lshrrev_b32 v8, 23, v7
  v_subrev_u32 v8, 134, v8
  v_max_i32 v8, 0, v8
  v_cvt_u32_f32 v7, v7
  v_lshrrev_b32 v7, v8, v7
  v_lshl_add_u32 v7, v8, 8, v7
  v_lshl_add_u32 v214, v7, 2, s18
  v_subrev_u32 v6, 15, v5
  v_max_i32 v7, 0, v6
  v_cvt_f32_u32 v7, v7
  v_cvt_pk_bf16_f32 v8, v7, v7
  v_and_b32 v7, 0xffff0000, v8
  v_lshrrev_b32 v8, 23, v7
  v_subrev_u32 v8, 134, v8
  v_max_i32 v8, 0, v8
  v_cvt_u32_f32 v7, v7
  v_lshrrev_b32 v7, v8, v7
  v_lshl_add_u32 v7, v8, 8, v7
  v_lshl_add_u32 v215, v7, 2, s18
  v_subrev_u32 v6, 16, v5
  v_max_i32 v7, 0, v6
  v_cvt_f32_u32 v7, v7
  v_cvt_pk_bf16_f32 v8, v7, v7
  v_and_b32 v7, 0xffff0000, v8
  v_lshrrev_b32 v8, 23, v7
  v_subrev_u32 v8, 134, v8
  v_max_i32 v8, 0, v8
  v_cvt_u32_f32 v7, v7
  v_lshrrev_b32 v7, v8, v7
  v_lshl_add_u32 v7, v8, 8, v7
  v_lshl_add_u32 v216, v7, 2, s18
  v_subrev_u32 v6, 17, v5
  v_max_i32 v7, 0, v6
  v_cvt_f32_u32 v7, v7
  v_cvt_pk_bf16_f32 v8, v7, v7
  v_and_b32 v7, 0xffff0000, v8
  v_lshrrev_b32 v8, 23, v7
  v_subrev_u32 v8, 134, v8
  v_max_i32 v8, 0, v8
  v_cvt_u32_f32 v7, v7
  v_lshrrev_b32 v7, v8, v7
  v_lshl_add_u32 v7, v8, 8, v7
  v_lshl_add_u32 v217, v7, 2, s18
  v_subrev_u32 v6, 18, v5
  v_max_i32 v7, 0, v6
  v_cvt_f32_u32 v7, v7
  v_cvt_pk_bf16_f32 v8, v7, v7
  v_and_b32 v7, 0xffff0000, v8
  v_lshrrev_b32 v8, 23, v7
  v_subrev_u32 v8, 134, v8
  v_max_i32 v8, 0, v8
  v_cvt_u32_f32 v7, v7
  v_lshrrev_b32 v7, v8, v7
  v_lshl_add_u32 v7, v8, 8, v7
  v_lshl_add_u32 v218, v7, 2, s18
  v_subrev_u32 v6, 19, v5
  v_max_i32 v7, 0, v6
  v_cvt_f32_u32 v7, v7
  v_cvt_pk_bf16_f32 v8, v7, v7
  v_and_b32 v7, 0xffff0000, v8
  v_lshrrev_b32 v8, 23, v7
  v_subrev_u32 v8, 134, v8
  v_max_i32 v8, 0, v8
  v_cvt_u32_f32 v7, v7
  v_lshrrev_b32 v7, v8, v7
  v_lshl_add_u32 v7, v8, 8, v7
  v_lshl_add_u32 v219, v7, 2, s18
  v_subrev_u32 v6, 20, v5
  v_max_i32 v7, 0, v6
  v_cvt_f32_u32 v7, v7
  v_cvt_pk_bf16_f32 v8, v7, v7
  v_and_b32 v7, 0xffff0000, v8
  v_lshrrev_b32 v8, 23, v7
  v_subrev_u32 v8, 134, v8
  v_max_i32 v8, 0, v8
  v_cvt_u32_f32 v7, v7
  v_lshrrev_b32 v7, v8, v7
  v_lshl_add_u32 v7, v8, 8, v7
  v_lshl_add_u32 v220, v7, 2, s18
  v_subrev_u32 v6, 21, v5
  v_max_i32 v7, 0, v6
  v_cvt_f32_u32 v7, v7
  v_cvt_pk_bf16_f32 v8, v7, v7
  v_and_b32 v7, 0xffff0000, v8
  v_lshrrev_b32 v8, 23, v7
  v_subrev_u32 v8, 134, v8
  v_max_i32 v8, 0, v8
  v_cvt_u32_f32 v7, v7
  v_lshrrev_b32 v7, v8, v7
  v_lshl_add_u32 v7, v8, 8, v7
  v_lshl_add_u32 v221, v7, 2, s18
  v_subrev_u32 v6, 22, v5
  v_max_i32 v7, 0, v6
  v_cvt_f32_u32 v7, v7
  v_cvt_pk_bf16_f32 v8, v7, v7
  v_and_b32 v7, 0xffff0000, v8
  v_lshrrev_b32 v8, 23, v7
  v_subrev_u32 v8, 134, v8
  v_max_i32 v8, 0, v8
  v_cvt_u32_f32 v7, v7
  v_lshrrev_b32 v7, v8, v7
  v_lshl_add_u32 v7, v8, 8, v7
  v_lshl_add_u32 v222, v7, 2, s18
  v_subrev_u32 v6, 23, v5
  v_max_i32 v7, 0, v6
  v_cvt_f32_u32 v7, v7
  v_cvt_pk_bf16_f32 v8, v7, v7
  v_and_b32 v7, 0xffff0000, v8
  v_lshrrev_b32 v8, 23, v7
  v_subrev_u32 v8, 134, v8
  v_max_i32 v8, 0, v8
  v_cvt_u32_f32 v7, v7
  v_lshrrev_b32 v7, v8, v7
  v_lshl_add_u32 v7, v8, 8, v7
  v_lshl_add_u32 v223, v7, 2, s18
  v_subrev_u32 v6, 24, v5
  v_max_i32 v7, 0, v6
  v_cvt_f32_u32 v7, v7
  v_cvt_pk_bf16_f32 v8, v7, v7
  v_and_b32 v7, 0xffff0000, v8
  v_lshrrev_b32 v8, 23, v7
  v_subrev_u32 v8, 134, v8
  v_max_i32 v8, 0, v8
  v_cvt_u32_f32 v7, v7
  v_lshrrev_b32 v7, v8, v7
  v_lshl_add_u32 v7, v8, 8, v7
  v_lshl_add_u32 v224, v7, 2, s18
  v_subrev_u32 v6, 25, v5
  v_max_i32 v7, 0, v6
  v_cvt_f32_u32 v7, v7
  v_cvt_pk_bf16_f32 v8, v7, v7
  v_and_b32 v7, 0xffff0000, v8
  v_lshrrev_b32 v8, 23, v7
  v_subrev_u32 v8, 134, v8
  v_max_i32 v8, 0, v8
  v_cvt_u32_f32 v7, v7
  v_lshrrev_b32 v7, v8, v7
  v_lshl_add_u32 v7, v8, 8, v7
  v_lshl_add_u32 v225, v7, 2, s18
  v_subrev_u32 v6, 26, v5
  v_max_i32 v7, 0, v6
  v_cvt_f32_u32 v7, v7
  v_cvt_pk_bf16_f32 v8, v7, v7
  v_and_b32 v7, 0xffff0000, v8
  v_lshrrev_b32 v8, 23, v7
  v_subrev_u32 v8, 134, v8
  v_max_i32 v8, 0, v8
  v_cvt_u32_f32 v7, v7
  v_lshrrev_b32 v7, v8, v7
  v_lshl_add_u32 v7, v8, 8, v7
  v_lshl_add_u32 v226, v7, 2, s18
  v_subrev_u32 v6, 27, v5
  v_max_i32 v7, 0, v6
  v_cvt_f32_u32 v7, v7
  v_cvt_pk_bf16_f32 v8, v7, v7
  v_and_b32 v7, 0xffff0000, v8
  v_lshrrev_b32 v8, 23, v7
  v_subrev_u32 v8, 134, v8
  v_max_i32 v8, 0, v8
  v_cvt_u32_f32 v7, v7
  v_lshrrev_b32 v7, v8, v7
  v_lshl_add_u32 v7, v8, 8, v7
  v_lshl_add_u32 v227, v7, 2, s18
  v_subrev_u32 v6, 28, v5
  v_max_i32 v7, 0, v6
  v_cvt_f32_u32 v7, v7
  v_cvt_pk_bf16_f32 v8, v7, v7
  v_and_b32 v7, 0xffff0000, v8
  v_lshrrev_b32 v8, 23, v7
  v_subrev_u32 v8, 134, v8
  v_max_i32 v8, 0, v8
  v_cvt_u32_f32 v7, v7
  v_lshrrev_b32 v7, v8, v7
  v_lshl_add_u32 v7, v8, 8, v7
  v_lshl_add_u32 v228, v7, 2, s18
  v_subrev_u32 v6, 29, v5
  v_max_i32 v7, 0, v6
  v_cvt_f32_u32 v7, v7
  v_cvt_pk_bf16_f32 v8, v7, v7
  v_and_b32 v7, 0xffff0000, v8
  v_lshrrev_b32 v8, 23, v7
  v_subrev_u32 v8, 134, v8
  v_max_i32 v8, 0, v8
  v_cvt_u32_f32 v7, v7
  v_lshrrev_b32 v7, v8, v7
  v_lshl_add_u32 v7, v8, 8, v7
  v_lshl_add_u32 v229, v7, 2, s18
  v_subrev_u32 v6, 30, v5
  v_max_i32 v7, 0, v6
  v_cvt_f32_u32 v7, v7
  v_cvt_pk_bf16_f32 v8, v7, v7
  v_and_b32 v7, 0xffff0000, v8
  v_lshrrev_b32 v8, 23, v7
  v_subrev_u32 v8, 134, v8
  v_max_i32 v8, 0, v8
  v_cvt_u32_f32 v7, v7
  v_lshrrev_b32 v7, v8, v7
  v_lshl_add_u32 v7, v8, 8, v7
  v_lshl_add_u32 v230, v7, 2, s18
  v_subrev_u32 v6, 31, v5
  v_max_i32 v7, 0, v6
  v_cvt_f32_u32 v7, v7
  v_cvt_pk_bf16_f32 v8, v7, v7
  v_and_b32 v7, 0xffff0000, v8
  v_lshrrev_b32 v8, 23, v7
  v_subrev_u32 v8, 134, v8
  v_max_i32 v8, 0, v8
  v_cvt_u32_f32 v7, v7
  v_lshrrev_b32 v7, v8, v7
  v_lshl_add_u32 v7, v8, 8, v7
  v_lshl_add_u32 v231, v7, 2, s18
  v_subrev_u32 v6, 32, v5
  v_max_i32 v7, 0, v6
  v_cvt_f32_u32 v7, v7
  v_cvt_pk_bf16_f32 v8, v7, v7
  v_and_b32 v7, 0xffff0000, v8
  v_lshrrev_b32 v8, 23, v7
  v_subrev_u32 v8, 134, v8
  v_max_i32 v8, 0, v8
  v_cvt_u32_f32 v7, v7
  v_lshrrev_b32 v7, v8, v7
  v_lshl_add_u32 v7, v8, 8, v7
  v_mov_b32 v8, 1280
  v_cmp_gt_i32 vcc, 0, v6
  s_nop 1
  v_cndmask_b32 v7, v7, v8, vcc
  v_lshl_add_u32 v232, v7, 2, s18
  v_mov_b32 v8, 0
  v_mov_b32 v9, 0
  v_lshlrev_b32 v5, 3, v1
  v_add_u32 v5, s17, v5
  ds_write_b64 v5, v[8:9]
  v_and_b32 v6, 15, v1
  v_lshlrev_b32 v6, 3, v6
  v_add_u32 v6, s17, v6
  ds_write_b64 v6, v[8:9] offset:8704
  ds_write_b64 v6, v[8:9] offset:12928
  v_mov_b32 v6, s17
  ds_write_b64 v6, v[8:9] offset:18176
  s_lshl_b32 s19, s3, 2
  s_add_u32 s20, s19, s16
  s_lshl_b32 s21, s3, 3
  v_mul_u32_u24 v5, 3584, v0
  v_mul_u32_u24 v141, 1792, v0
  s_lshl_b32 s22, s20, 9
  v_lshlrev_b32 v6, 3, v1
  buffer_load_dwordx2 v[24:25], v6, s[64:67], s22 offen
  buffer_load_dwordx2 v[26:27], v6, s[68:71], s22 offen
  buffer_load_dwordx2 v[28:29], v6, s[72:75], s22 offen
  buffer_load_dwordx2 v[30:31], v6, s[76:79], s22 offen
  s_lshl_b32 s22, s20, 1
  v_mov_b32 v7, 0
  buffer_load_ushort v32, v7, s[80:83], s22 offen
  buffer_load_ushort v33, v7, s[84:87], s22 offen
  s_mov_b32 s24, 0x05040100
  s_mov_b32 s25, 0x07060302
  s_barrier
  s_waitcnt vmcnt(0)
  s_mov_b32 s26, 1069066811
  s_mov_b32 s27, 1042479491
  v_lshlrev_b32 v32, 16, v32
  v_lshlrev_b32 v33, 16, v33
  v_mul_f32 v32, s26, v32
  v_exp_f32 v32, v32
  s_nop 0
  v_cvt_pk_bf16_f32 v34, v32, v32
  v_and_b32 v32, 0xffff0000, v34
  v_lshlrev_b32 v37, 6, v1
  v_add_u32 v37, s17, v37
  v_lshlrev_b32 v40, 16, v24
  v_lshlrev_b32 v41, 16, v26
  v_lshlrev_b32 v42, 16, v28
  v_lshlrev_b32 v43, 16, v30
  v_mul_f32 v40, s26, v40
  v_exp_f32 v40, v40
  s_nop 0
  v_cvt_pk_bf16_f32 v34, v40, v40
  v_and_b32 v40, 0xffff0000, v34
  v_mul_f32 v40, v40, v32
  v_mul_f32 v40, s26, v40
  v_sub_f32 v40, 0, v40
  v_mul_f32 v41, v41, v32
  v_mul_f32 v41, s27, v41
  v_mul_f32 v42, v42, v32
  v_mul_f32 v43, v43, v32
  v_add_f32 v42, v42, v42
  v_add_f32 v43, v43, v43
  ds_write_b128 v37, v[40:43] offset:18240
  v_and_b32 v40, 0xffff0000, v24
  v_and_b32 v41, 0xffff0000, v26
  v_and_b32 v42, 0xffff0000, v28
  v_and_b32 v43, 0xffff0000, v30
  v_mul_f32 v40, s26, v40
  v_exp_f32 v40, v40
  s_nop 0
  v_cvt_pk_bf16_f32 v34, v40, v40
  v_and_b32 v40, 0xffff0000, v34
  v_mul_f32 v40, v40, v32
  v_mul_f32 v40, s26, v40
  v_sub_f32 v40, 0, v40
  v_mul_f32 v41, v41, v32
  v_mul_f32 v41, s27, v41
  v_mul_f32 v42, v42, v32
  v_mul_f32 v43, v43, v32
  v_add_f32 v42, v42, v42
  v_add_f32 v43, v43, v43
  ds_write_b128 v37, v[40:43] offset:18256
  v_lshlrev_b32 v40, 16, v25
  v_lshlrev_b32 v41, 16, v27
  v_lshlrev_b32 v42, 16, v29
  v_lshlrev_b32 v43, 16, v31
  v_mul_f32 v40, s26, v40
  v_exp_f32 v40, v40
  s_nop 0
  v_cvt_pk_bf16_f32 v34, v40, v40
  v_and_b32 v40, 0xffff0000, v34
  v_mul_f32 v40, v40, v32
  v_mul_f32 v40, s26, v40
  v_sub_f32 v40, 0, v40
  v_mul_f32 v41, v41, v32
  v_mul_f32 v41, s27, v41
  v_mul_f32 v42, v42, v32
  v_mul_f32 v43, v43, v32
  v_add_f32 v42, v42, v42
  v_add_f32 v43, v43, v43
  ds_write_b128 v37, v[40:43] offset:18272
  v_and_b32 v40, 0xffff0000, v25
  v_and_b32 v41, 0xffff0000, v27
  v_and_b32 v42, 0xffff0000, v29
  v_and_b32 v43, 0xffff0000, v31
  v_mul_f32 v40, s26, v40
  v_exp_f32 v40, v40
  s_nop 0
  v_cvt_pk_bf16_f32 v34, v40, v40
  v_and_b32 v40, 0xffff0000, v34
  v_mul_f32 v40, v40, v32
  v_mul_f32 v40, s26, v40
  v_sub_f32 v40, 0, v40
  v_mul_f32 v41, v41, v32
  v_mul_f32 v41, s27, v41
  v_mul_f32 v42, v42, v32
  v_mul_f32 v43, v43, v32
  v_add_f32 v42, v42, v42
  v_add_f32 v43, v43, v43
  ds_write_b128 v37, v[40:43] offset:18288
  v_cvt_f32_u32 v44, v4
  v_lshlrev_b32 v45, 4, v4
  v_cvt_f32_u32 v45, v45
  v_lshlrev_b32 v46, 4, v3
  v_add_u32 v46, s17, v46
  v_mov_b32 v48, 0
  v_mov_b32 v49, 0
  v_mov_b32 v50, 0
  v_mov_b32 v51, 0
  v_mov_b32 v52, 0
  v_mov_b32 v53, 0
  v_mov_b32 v54, 0
  v_mov_b32 v55, 0
  v_mov_b32 v56, 0
  v_mov_b32 v57, 0
  v_mov_b32 v58, 0
  v_mov_b32 v59, 0
  v_mov_b32 v60, 0
  v_mov_b32 v61, 0
  v_mov_b32 v62, 0
  v_mov_b32 v63, 0
  v_mov_b32 v64, 0
  v_mov_b32 v65, 0
  v_mov_b32 v66, 0
  v_mov_b32 v67, 0
  s_waitcnt lgkmcnt(0)
  ds_read_b128 v[68:71], v46 offset:18240
  s_add_u32 s22, s21, 0
  buffer_load_dwordx2 v[8:9], v5, s[60:63], s22 offen offset:0
  s_mov_b32 s28, 0
  s_call_b64 s[30:31], wk_kl
  s_mov_b32 s28, 0
  s_call_b64 s[30:31], wk_kl
  s_add_u32 s22, s21, 0
  buffer_load_dwordx2 v[10:11], v5, s[60:63], s22 offen offset:896
  s_mov_b32 s28, 0
  s_call_b64 s[30:31], wk_kl
  s_mov_b32 s28, 0
  s_call_b64 s[30:31], wk_kl
  s_add_u32 s22, s21, 0
  buffer_load_dwordx2 v[12:13], v5, s[60:63], s22 offen offset:1792
  s_mov_b32 s28, 0
  s_call_b64 s[30:31], wk_kl
  s_mov_b32 s28, 0
  s_call_b64 s[30:31], wk_kl
  s_add_u32 s22, s21, 0
  buffer_load_dwordx2 v[14:15], v5, s[60:63], s22 offen offset:2688
  s_mov_b32 s28, 0
  s_call_b64 s[30:31], wk_kl
  s_mov_b32 s28, 0
  s_call_b64 s[30:31], wk_kl
  s_add_u32 s22, s21, 917504
  buffer_load_dwordx2 v[16:17], v5, s[60:63], s22 offen offset:0
  s_mov_b32 s28, 0
  s_call_b64 s[30:31], wk_kl
  s_mov_b32 s28, 0
  s_call_b64 s[30:31], wk_kl
  s_add_u32 s22, s21, 917504
  buffer_load_dwordx2 v[18:19], v5, s[60:63], s22 offen offset:896
  s_mov_b32 s28, 0
  s_call_b64 s[30:31], wk_kl
  s_mov_b32 s28, 0
  s_call_b64 s[30:31], wk_kl
  s_add_u32 s22, s21, 917504
  buffer_load_dwordx2 v[20:21], v5, s[60:63], s22 offen offset:1792
  s_mov_b32 s28, 0
  s_call_b64 s[30:31], wk_kl
  s_mov_b32 s28, 0
  s_call_b64 s[30:31], wk_kl
  s_add_u32 s22, s21, 917504
  buffer_load_dwordx2 v[22:23], v5, s[60:63], s22 offen offset:2688
  s_mov_b32 s28, 0
  s_call_b64 s[30:31], wk_kl
  s_mov_b32 s28, 0
  s_call_b64 s[30:31], wk_kl
  s_branch wk_kd
wk_kl:
  s_waitcnt lgkmcnt(0)
  v_mov_b32 v72, v68
  v_mov_b32 v73, v69
  v_mov_b32 v74, v70
  v_mov_b32 v75, v71
  v_add_u32 v46, 64, v46
  ds_read_b128 v[68:71], v46 offset:18240
  v_mul_f32 v80, v72, v45
  v_mul_f32 v81, v73, v45
  v_exp_f32 v80, v80
  v_fract_f32 v81, v81
  v_cos_f32 v76, v81
  v_sin_f32 v77, v81
  v_mul_f32 v76, v76, v80
  v_mul_f32 v77, v77, v80
  v_mul_f32 v80, v72, v44
  v_mul_f32 v81, v73, v44
  v_exp_f32 v80, v80
  v_fract_f32 v81, v81
  v_cos_f32 v78, v81
  v_sin_f32 v79, v81
  v_mul_f32 v78, v78, v80
  v_mul_f32 v79, v79, v80
  v_mul_f32 v82, v74, v76
  v_mul_f32 v83, v74, v77
  v_fma_f32 v82, -v75, v77, v82
  v_fma_f32 v83, -v75, v76, -v83
  v_mul_f32 v86, v76, v76
  v_mul_f32 v87, v76, v77
  v_fma_f32 v86, -v77, v77, v86
  v_add_f32 v87, v87, v87
  v_mfma_f32_16x16x4_f32 v[48:51], v82, v78, v[48:51]
  v_mul_f32 v88, v78, v78
  v_mul_f32 v89, v78, v79
  v_fma_f32 v88, -v79, v79, v88
  v_add_f32 v89, v89, v89
  v_mfma_f32_16x16x4_f32 v[48:51], v83, v79, v[48:51]
  v_mul_f32 v84, v74, v86
  v_mul_f32 v85, v74, v87
  v_fma_f32 v84, -v75, v87, v84
  v_fma_f32 v85, -v75, v86, -v85
  v_mul_f32 v76, v86, v86
  v_mul_f32 v77, v86, v87
  v_fma_f32 v76, -v87, v87, v76
  v_add_f32 v77, v77, v77
  v_mfma_f32_16x16x4_f32 v[52:55], v84, v88, v[52:55]
  v_mul_f32 v78, v88, v88
  v_mul_f32 v79, v88, v89
  v_fma_f32 v78, -v89, v89, v78
  v_add_f32 v79, v79, v79
  v_mfma_f32_16x16x4_f32 v[52:55], v85, v89, v[52:55]
  v_mul_f32 v82, v74, v76
  v_mul_f32 v83, v74, v77
  v_fma_f32 v82, -v75, v77, v82
  v_fma_f32 v83, -v75, v76, -v83
  v_mul_f32 v86, v76, v76
  v_mul_f32 v87, v76, v77
  v_fma_f32 v86, -v77, v77, v86
  v_add_f32 v87, v87, v87
  v_mfma_f32_16x16x4_f32 v[56:59], v82, v78, v[56:59]
  v_mul_f32 v88, v78, v78
  v_mul_f32 v89, v78, v79
  v_fma_f32 v88, -v79, v79, v88
  v_add_f32 v89, v89, v89
  v_mfma_f32_16x16x4_f32 v[56:59], v83, v79, v[56:59]
  v_mul_f32 v84, v74, v86
  v_mul_f32 v85, v74, v87
  v_fma_f32 v84, -v75, v87, v84
  v_fma_f32 v85, -v75, v86, -v85
  v_mul_f32 v76, v86, v86
  v_mul_f32 v77, v86, v87
  v_fma_f32 v76, -v87, v87, v76
  v_add_f32 v77, v77, v77
  v_mfma_f32_16x16x4_f32 v[60:63], v84, v88, v[60:63]
  v_mfma_f32_16x16x4_f32 v[60:63], v85, v89, v[60:63]
  v_mul_f32 v82, v74, v76
  v_fma_f32 v82, -v75, v77, v82
  s_nop 1
  v_mfma_f32_16x16x4_f32 v[64:67], v82, v88, v[64:67]
  s_add_u32 s28, s28, 1
  s_cmp_lt_u32 s28, 4
  s_cbranch_scc1 wk_kl
  s_setpc_b64 s[30:31]
wk_kd:
  s_nop 15
  s_nop 3
  s_waitcnt vmcnt(0)
  v_lshlrev_b32 v6, 3, v0
  v_perm_b32 v34, v10, v8, s24
  v_perm_b32 v35, v14, v12, s24
  v_add_u32 v36, 512, v6
  ds_write_b64 v36, v[34:35]
  v_perm_b32 v34, v10, v8, s25
  v_perm_b32 v35, v14, v12, s25
  v_add_u32 v36, 25088, v6
  ds_write_b64 v36, v[34:35]
  v_perm_b32 v34, v11, v9, s24
  v_perm_b32 v35, v15, v13, s24
  v_add_u32 v36, 49664, v6
  ds_write_b64 v36, v[34:35]
  v_perm_b32 v34, v11, v9, s25
  v_perm_b32 v35, v15, v13, s25
  v_add_u32 v36, 74240, v6
  ds_write_b64 v36, v[34:35]
  v_perm_b32 v34, v18, v16, s24
  v_perm_b32 v35, v22, v20, s24
  v_add_u32 v36, 2560, v6
  ds_write_b64 v36, v[34:35]
  v_perm_b32 v34, v18, v16, s25
  v_perm_b32 v35, v22, v20, s25
  v_add_u32 v36, 27136, v6
  ds_write_b64 v36, v[34:35]
  v_perm_b32 v34, v19, v17, s24
  v_perm_b32 v35, v23, v21, s24
  v_add_u32 v36, 51712, v6
  ds_write_b64 v36, v[34:35]
  v_perm_b32 v34, v19, v17, s25
  v_perm_b32 v35, v23, v21, s25
  v_add_u32 v36, 76288, v6
  ds_write_b64 v36, v[34:35]
  v_lshlrev_b32 v46, 8, v3
  v_lshl_add_u32 v46, v4, 2, v46
  v_add_u32 v46, s17, v46
  ds_write_b32 v46, v48 offset:13056
  ds_write_b32 v46, v49 offset:13120
  ds_write_b32 v46, v50 offset:13184
  ds_write_b32 v46, v51 offset:13248
  s_waitcnt lgkmcnt(8)
  ds_write_b32 v46, v52 offset:14080
  ds_write_b32 v46, v53 offset:14144
  ds_write_b32 v46, v54 offset:14208
  ds_write_b32 v46, v55 offset:14272
  s_waitcnt lgkmcnt(8)
  ds_write_b32 v46, v56 offset:15104
  ds_write_b32 v46, v57 offset:15168
  ds_write_b32 v46, v58 offset:15232
  ds_write_b32 v46, v59 offset:15296
  s_waitcnt lgkmcnt(8)
  ds_write_b32 v46, v60 offset:16128
  ds_write_b32 v46, v61 offset:16192
  ds_write_b32 v46, v62 offset:16256
  ds_write_b32 v46, v63 offset:16320
  s_waitcnt lgkmcnt(8)
  ds_write_b32 v46, v64 offset:17152
  ds_write_b32 v46, v65 offset:17216
  ds_write_b32 v46, v66 offset:17280
  ds_write_b32 v46, v67 offset:17344
  s_waitcnt lgkmcnt(8)
  s_waitcnt lgkmcnt(0)
  ds_read_b32 v48, v200
  ds_read_b32 v49, v201
  ds_read_b32 v50, v202
  ds_read_b32 v51, v203
  ds_read_b32 v52, v204
  ds_read_b32 v53, v205
  ds_read_b32 v54, v206
  ds_read_b32 v55, v207
  s_waitcnt lgkmcnt(4)
  ds_read_b32 v56, v208
  ds_read_b32 v57, v209
  ds_read_b32 v58, v210
  ds_read_b32 v59, v211
  ds_read_b32 v60, v212
  ds_read_b32 v61, v213
  ds_read_b32 v62, v214
  ds_read_b32 v63, v215
  s_waitcnt lgkmcnt(4)
  ds_read_b32 v64, v216
  ds_read_b32 v65, v217
  ds_read_b32 v66, v218
  ds_read_b32 v67, v219
  ds_read_b32 v68, v220
  ds_read_b32 v69, v221
  ds_read_b32 v70, v222
  ds_read_b32 v71, v223
  s_waitcnt lgkmcnt(4)
  ds_read_b32 v72, v224
  ds_read_b32 v73, v225
  ds_read_b32 v74, v226
  ds_read_b32 v75, v227
  ds_read_b32 v76, v228
  ds_read_b32 v77, v229
  ds_read_b32 v78, v230
  ds_read_b32 v79, v231
  s_waitcnt lgkmcnt(4)
  ds_read_b32 v80, v232
  s_waitcnt lgkmcnt(0)
  v_lshlrev_b32 v46, 6, v1
  v_add_u32 v46, s17, v46
  v_cvt_pk_bf16_f32 v84, v48, v49
  v_cvt_pk_bf16_f32 v88, v49, v50
  v_cvt_pk_bf16_f32 v85, v50, v51
  v_cvt_pk_bf16_f32 v89, v51, v52
  v_cvt_pk_bf16_f32 v86, v52, v53
  v_cvt_pk_bf16_f32 v90, v53, v54
  v_cvt_pk_bf16_f32 v87, v54, v55
  v_cvt_pk_bf16_f32 v91, v55, v56
  ds_write_b128 v46, v[84:87] offset:4608
  ds_write_b128 v46, v[88:91] offset:8832
  s_waitcnt lgkmcnt(0)
  v_cvt_pk_bf16_f32 v84, v56, v57
  v_cvt_pk_bf16_f32 v88, v57, v58
  v_cvt_pk_bf16_f32 v85, v58, v59
  v_cvt_pk_bf16_f32 v89, v59, v60
  v_cvt_pk_bf16_f32 v86, v60, v61
  v_cvt_pk_bf16_f32 v90, v61, v62
  v_cvt_pk_bf16_f32 v87, v62, v63
  v_cvt_pk_bf16_f32 v91, v63, v64
  ds_write_b128 v46, v[84:87] offset:4624
  ds_write_b128 v46, v[88:91] offset:8848
  s_waitcnt lgkmcnt(0)
  v_cvt_pk_bf16_f32 v84, v64, v65
  v_cvt_pk_bf16_f32 v88, v65, v66
  v_cvt_pk_bf16_f32 v85, v66, v67
  v_cvt_pk_bf16_f32 v89, v67, v68
  v_cvt_pk_bf16_f32 v86, v68, v69
  v_cvt_pk_bf16_f32 v90, v69, v70
  v_cvt_pk_bf16_f32 v87, v70, v71
  v_cvt_pk_bf16_f32 v91, v71, v72
  ds_write_b128 v46, v[84:87] offset:4640
  ds_write_b128 v46, v[88:91] offset:8864
  s_waitcnt lgkmcnt(0)
  v_cvt_pk_bf16_f32 v84, v72, v73
  v_cvt_pk_bf16_f32 v88, v73, v74
  v_cvt_pk_bf16_f32 v85, v74, v75
  v_cvt_pk_bf16_f32 v89, v75, v76
  v_cvt_pk_bf16_f32 v86, v76, v77
  v_cvt_pk_bf16_f32 v90, v77, v78
  v_cvt_pk_bf16_f32 v87, v78, v79
  v_cvt_pk_bf16_f32 v91, v79, v80
  ds_write_b128 v46, v[84:87] offset:4656
  ds_write_b128 v46, v[88:91] offset:8880
  s_waitcnt lgkmcnt(0)
  s_barrier
  v_lshrrev_b32 v47, 1, v3
  v_sub_u32 v46, v4, v47
  v_add_u32 v46, 1, v46
  v_lshlrev_b32 v46, 5, v46
  v_and_b32 v48, 1, v3
  v_lshl_add_u32 v46, v48, 4, v46
  v_add_u32 v46, s17, v46
  ds_read_b128 a[0:3], v46 offset:32
  ds_read_b128 a[4:7], v46 offset:96
  ds_read_b128 a[8:11], v46 offset:160
  ds_read_b128 a[12:15], v46 offset:224
  ds_read_b128 a[16:19], v46 offset:288
  ds_read_b128 a[20:23], v46 offset:352
  ds_read_b128 a[24:27], v46 offset:416
  ds_read_b128 a[28:31], v46 offset:480
  s_waitcnt lgkmcnt(4)
  ds_read_b128 a[32:35], v46 offset:544
  ds_read_b128 a[36:39], v46 offset:608
  ds_read_b128 a[40:43], v46 offset:672
  ds_read_b128 a[44:47], v46 offset:736
  ds_read_b128 a[48:51], v46 offset:800
  ds_read_b128 a[52:55], v46 offset:864
  ds_read_b128 a[56:59], v46 offset:928
  ds_read_b128 a[60:63], v46 offset:992
  s_waitcnt lgkmcnt(4)
  ds_read_b128 a[64:67], v46 offset:1056
  ds_read_b128 a[68:71], v46 offset:1120
  ds_read_b128 a[72:75], v46 offset:1184
  ds_read_b128 a[76:79], v46 offset:1248
  ds_read_b128 a[80:83], v46 offset:1312
  ds_read_b128 a[84:87], v46 offset:1376
  ds_read_b128 a[88:91], v46 offset:1440
  ds_read_b128 a[92:95], v46 offset:1504
  s_waitcnt lgkmcnt(4)
  ds_read_b128 a[96:99], v46 offset:1568
  ds_read_b128 a[100:103], v46 offset:1632
  ds_read_b128 a[104:107], v46 offset:1696
  ds_read_b128 a[108:111], v46 offset:1760
  ds_read_b128 a[112:115], v46 offset:1824
  ds_read_b128 a[116:119], v46 offset:1888
  ds_read_b128 a[120:123], v46 offset:1952
  ds_read_b128 a[124:127], v46 offset:2016
  s_waitcnt lgkmcnt(4)
  ds_read_b128 a[128:131], v46 offset:2080
  ds_read_b128 a[132:135], v46 offset:2144
  ds_read_b128 a[136:139], v46 offset:2208
  ds_read_b128 a[140:143], v46 offset:2272
  ds_read_b128 a[144:147], v46 offset:2336
  ds_read_b128 a[148:151], v46 offset:2400
  ds_read_b128 a[152:155], v46 offset:2464
  ds_read_b128 a[156:159], v46 offset:2528
  s_waitcnt lgkmcnt(4)
  ds_read_b128 a[160:163], v46 offset:2592
  ds_read_b128 a[164:167], v46 offset:2656
  ds_read_b128 a[168:171], v46 offset:2720
  ds_read_b128 a[172:175], v46 offset:2784
  ds_read_b128 a[176:179], v46 offset:2848
  ds_read_b128 a[180:183], v46 offset:2912
  ds_read_b128 a[184:187], v46 offset:2976
  ds_read_b128 a[188:191], v46 offset:3040
  s_waitcnt lgkmcnt(4)
  ds_read_b128 a[192:195], v46 offset:3104
  ds_read_b128 a[196:199], v46 offset:3168
  ds_read_b128 a[200:203], v46 offset:3232
  ds_read_b128 a[204:207], v46 offset:3296
  ds_read_b128 a[208:211], v46 offset:3360
  ds_read_b128 a[212:215], v46 offset:3424
  ds_read_b128 a[216:219], v46 offset:3488
  ds_read_b128 a[220:223], v46 offset:3552
  s_waitcnt lgkmcnt(4)
  ds_read_b128 a[224:227], v46 offset:3616
  ds_read_b128 a[228:231], v46 offset:3680
  ds_read_b128 a[232:235], v46 offset:3744
  ds_read_b128 a[236:239], v46 offset:3808
  ds_read_b128 a[240:243], v46 offset:3872
  ds_read_b128 a[244:247], v46 offset:3936
  ds_read_b128 a[248:251], v46 offset:4000
  ds_read_b128 a[252:255], v46 offset:4064
  s_waitcnt lgkmcnt(4)
  v_lshlrev_b32 v49, 4, v47
  v_add_u32 v49, v49, v4
  v_sub_u32 v49, 2047, v49
  v_lshl_add_u32 v49, v48, 3, v49
  v_and_b32 v50, 1, v49
  v_lshrrev_b32 v49, 1, v49
  v_lshlrev_b32 v49, 2, v49
  v_mul_u32_u24 v50, 4224, v50
  v_add3_u32 v49, v49, v50, s17
  v_add_u32 v49, 4608, v49
  v_subrev_u32 v52, 896, v49
  v_subrev_u32 v53, 1856, v49
  v_subrev_u32 v54, 2816, v49
  v_subrev_u32 v55, 3776, v49
  v_subrev_u32 v56, 4736, v49
  s_waitcnt lgkmcnt(0)
  ds_read2_b32 v[92:93], v52 offset0:224 offset1:225
  ds_read2_b32 v[94:95], v52 offset0:226 offset1:227
  ds_read2_b32 v[96:97], v52 offset0:208 offset1:209
  ds_read2_b32 v[98:99], v52 offset0:210 offset1:211
  ds_read2_b32 v[100:101], v52 offset0:192 offset1:193
  ds_read2_b32 v[102:103], v52 offset0:194 offset1:195
  ds_read2_b32 v[104:105], v52 offset0:176 offset1:177
  ds_read2_b32 v[106:107], v52 offset0:178 offset1:179
  s_waitcnt lgkmcnt(6)
  v_mfma_f32_16x16x32_bf16 v[60:63], v[92:95], a[28:31], 0
  v_mfma_f32_16x16x32_bf16 v[64:67], v[92:95], a[60:63], 0
  v_mfma_f32_16x16x32_bf16 v[68:71], v[92:95], a[92:95], 0
  v_mfma_f32_16x16x32_bf16 v[72:75], v[92:95], a[124:127], 0
  v_mfma_f32_16x16x32_bf16 v[76:79], v[92:95], a[156:159], 0
  v_mfma_f32_16x16x32_bf16 v[80:83], v[92:95], a[188:191], 0
  v_mfma_f32_16x16x32_bf16 v[84:87], v[92:95], a[220:223], 0
  v_mfma_f32_16x16x32_bf16 v[88:91], v[92:95], a[252:255], 0
  ds_read2_b32 v[92:93], v52 offset0:160 offset1:161
  ds_read2_b32 v[94:95], v52 offset0:162 offset1:163
  s_waitcnt lgkmcnt(6)
  v_mfma_f32_16x16x32_bf16 v[60:63], v[96:99], a[24:27], v[60:63]
  v_mfma_f32_16x16x32_bf16 v[64:67], v[96:99], a[56:59], v[64:67]
  v_mfma_f32_16x16x32_bf16 v[68:71], v[96:99], a[88:91], v[68:71]
  v_mfma_f32_16x16x32_bf16 v[72:75], v[96:99], a[120:123], v[72:75]
  v_mfma_f32_16x16x32_bf16 v[76:79], v[96:99], a[152:155], v[76:79]
  v_mfma_f32_16x16x32_bf16 v[80:83], v[96:99], a[184:187], v[80:83]
  v_mfma_f32_16x16x32_bf16 v[84:87], v[96:99], a[216:219], v[84:87]
  v_mfma_f32_16x16x32_bf16 v[88:91], v[96:99], a[248:251], v[88:91]
  ds_read2_b32 v[96:97], v52 offset0:144 offset1:145
  ds_read2_b32 v[98:99], v52 offset0:146 offset1:147
  s_waitcnt lgkmcnt(6)
  v_mfma_f32_16x16x32_bf16 v[60:63], v[100:103], a[20:23], v[60:63]
  v_mfma_f32_16x16x32_bf16 v[64:67], v[100:103], a[52:55], v[64:67]
  v_mfma_f32_16x16x32_bf16 v[68:71], v[100:103], a[84:87], v[68:71]
  v_mfma_f32_16x16x32_bf16 v[72:75], v[100:103], a[116:119], v[72:75]
  v_mfma_f32_16x16x32_bf16 v[76:79], v[100:103], a[148:151], v[76:79]
  v_mfma_f32_16x16x32_bf16 v[80:83], v[100:103], a[180:183], v[80:83]
  v_mfma_f32_16x16x32_bf16 v[84:87], v[100:103], a[212:215], v[84:87]
  v_mfma_f32_16x16x32_bf16 v[88:91], v[100:103], a[244:247], v[88:91]
  ds_read2_b32 v[100:101], v52 offset0:128 offset1:129
  ds_read2_b32 v[102:103], v52 offset0:130 offset1:131
  s_waitcnt lgkmcnt(6)
  v_mfma_f32_16x16x32_bf16 v[60:63], v[104:107], a[16:19], v[60:63]
  v_mfma_f32_16x16x32_bf16 v[64:67], v[104:107], a[48:51], v[64:67]
  v_mfma_f32_16x16x32_bf16 v[68:71], v[104:107], a[80:83], v[68:71]
  v_mfma_f32_16x16x32_bf16 v[72:75], v[104:107], a[112:115], v[72:75]
  v_mfma_f32_16x16x32_bf16 v[76:79], v[104:107], a[144:147], v[76:79]
  v_mfma_f32_16x16x32_bf16 v[80:83], v[104:107], a[176:179], v[80:83]
  v_mfma_f32_16x16x32_bf16 v[84:87], v[104:107], a[208:211], v[84:87]
  v_mfma_f32_16x16x32_bf16 v[88:91], v[104:107], a[240:243], v[88:91]
  ds_read2_b32 v[104:105], v52 offset0:112 offset1:113
  ds_read2_b32 v[106:107], v52 offset0:114 offset1:115
  s_waitcnt lgkmcnt(6)
  v_mfma_f32_16x16x32_bf16 v[60:63], v[92:95], a[12:15], v[60:63]
  v_mfma_f32_16x16x32_bf16 v[64:67], v[92:95], a[44:47], v[64:67]
  v_mfma_f32_16x16x32_bf16 v[68:71], v[92:95], a[76:79], v[68:71]
  v_mfma_f32_16x16x32_bf16 v[72:75], v[92:95], a[108:111], v[72:75]
  v_mfma_f32_16x16x32_bf16 v[76:79], v[92:95], a[140:143], v[76:79]
  v_mfma_f32_16x16x32_bf16 v[80:83], v[92:95], a[172:175], v[80:83]
  v_mfma_f32_16x16x32_bf16 v[84:87], v[92:95], a[204:207], v[84:87]
  v_mfma_f32_16x16x32_bf16 v[88:91], v[92:95], a[236:239], v[88:91]
  ds_read2_b32 v[92:93], v52 offset0:96 offset1:97
  ds_read2_b32 v[94:95], v52 offset0:98 offset1:99
  s_waitcnt lgkmcnt(6)
  v_mfma_f32_16x16x32_bf16 v[60:63], v[96:99], a[8:11], v[60:63]
  v_mfma_f32_16x16x32_bf16 v[64:67], v[96:99], a[40:43], v[64:67]
  v_mfma_f32_16x16x32_bf16 v[68:71], v[96:99], a[72:75], v[68:71]
  v_mfma_f32_16x16x32_bf16 v[72:75], v[96:99], a[104:107], v[72:75]
  v_mfma_f32_16x16x32_bf16 v[76:79], v[96:99], a[136:139], v[76:79]
  v_mfma_f32_16x16x32_bf16 v[80:83], v[96:99], a[168:171], v[80:83]
  v_mfma_f32_16x16x32_bf16 v[84:87], v[96:99], a[200:203], v[84:87]
  v_mfma_f32_16x16x32_bf16 v[88:91], v[96:99], a[232:235], v[88:91]
  ds_read2_b32 v[96:97], v52 offset0:80 offset1:81
  ds_read2_b32 v[98:99], v52 offset0:82 offset1:83
  s_waitcnt lgkmcnt(6)
  v_mfma_f32_16x16x32_bf16 v[60:63], v[100:103], a[4:7], v[60:63]
  v_mfma_f32_16x16x32_bf16 v[64:67], v[100:103], a[36:39], v[64:67]
  v_mfma_f32_16x16x32_bf16 v[68:71], v[100:103], a[68:71], v[68:71]
  v_mfma_f32_16x16x32_bf16 v[72:75], v[100:103], a[100:103], v[72:75]
  v_mfma_f32_16x16x32_bf16 v[76:79], v[100:103], a[132:135], v[76:79]
  v_mfma_f32_16x16x32_bf16 v[80:83], v[100:103], a[164:167], v[80:83]
  v_mfma_f32_16x16x32_bf16 v[84:87], v[100:103], a[196:199], v[84:87]
  v_mfma_f32_16x16x32_bf16 v[88:91], v[100:103], a[228:231], v[88:91]
  ds_read2_b32 v[100:101], v52 offset0:64 offset1:65
  ds_read2_b32 v[102:103], v52 offset0:66 offset1:67
  s_waitcnt lgkmcnt(6)
  v_mfma_f32_16x16x32_bf16 v[60:63], v[104:107], a[0:3], v[60:63]
  v_mfma_f32_16x16x32_bf16 v[64:67], v[104:107], a[32:35], v[64:67]
  v_mfma_f32_16x16x32_bf16 v[68:71], v[104:107], a[64:67], v[68:71]
  v_mfma_f32_16x16x32_bf16 v[72:75], v[104:107], a[96:99], v[72:75]
  v_mfma_f32_16x16x32_bf16 v[76:79], v[104:107], a[128:131], v[76:79]
  v_mfma_f32_16x16x32_bf16 v[80:83], v[104:107], a[160:163], v[80:83]
  v_mfma_f32_16x16x32_bf16 v[84:87], v[104:107], a[192:195], v[84:87]
  v_mfma_f32_16x16x32_bf16 v[88:91], v[104:107], a[224:227], v[88:91]
  ds_read2_b32 v[104:105], v52 offset0:48 offset1:49
  ds_read2_b32 v[106:107], v52 offset0:50 offset1:51
  s_waitcnt lgkmcnt(6)
  v_mfma_f32_16x16x32_bf16 v[64:67], v[92:95], a[28:31], v[64:67]
  v_mfma_f32_16x16x32_bf16 v[68:71], v[92:95], a[60:63], v[68:71]
  v_mfma_f32_16x16x32_bf16 v[72:75], v[92:95], a[92:95], v[72:75]
  v_mfma_f32_16x16x32_bf16 v[76:79], v[92:95], a[124:127], v[76:79]
  v_mfma_f32_16x16x32_bf16 v[80:83], v[92:95], a[156:159], v[80:83]
  v_mfma_f32_16x16x32_bf16 v[84:87], v[92:95], a[188:191], v[84:87]
  v_mfma_f32_16x16x32_bf16 v[88:91], v[92:95], a[220:223], v[88:91]
  ds_read2_b32 v[92:93], v52 offset0:32 offset1:33
  ds_read2_b32 v[94:95], v52 offset0:34 offset1:35
  s_waitcnt lgkmcnt(6)
  v_mfma_f32_16x16x32_bf16 v[64:67], v[96:99], a[24:27], v[64:67]
  v_mfma_f32_16x16x32_bf16 v[68:71], v[96:99], a[56:59], v[68:71]
  v_mfma_f32_16x16x32_bf16 v[72:75], v[96:99], a[88:91], v[72:75]
  v_mfma_f32_16x16x32_bf16 v[76:79], v[96:99], a[120:123], v[76:79]
  v_mfma_f32_16x16x32_bf16 v[80:83], v[96:99], a[152:155], v[80:83]
  v_mfma_f32_16x16x32_bf16 v[84:87], v[96:99], a[184:187], v[84:87]
  v_mfma_f32_16x16x32_bf16 v[88:91], v[96:99], a[216:219], v[88:91]
  ds_read2_b32 v[96:97], v52 offset0:16 offset1:17
  ds_read2_b32 v[98:99], v52 offset0:18 offset1:19
  s_waitcnt lgkmcnt(6)
  v_mfma_f32_16x16x32_bf16 v[64:67], v[100:103], a[20:23], v[64:67]
  v_mfma_f32_16x16x32_bf16 v[68:71], v[100:103], a[52:55], v[68:71]
  v_mfma_f32_16x16x32_bf16 v[72:75], v[100:103], a[84:87], v[72:75]
  v_mfma_f32_16x16x32_bf16 v[76:79], v[100:103], a[116:119], v[76:79]
  v_mfma_f32_16x16x32_bf16 v[80:83], v[100:103], a[148:151], v[80:83]
  v_mfma_f32_16x16x32_bf16 v[84:87], v[100:103], a[180:183], v[84:87]
  v_mfma_f32_16x16x32_bf16 v[88:91], v[100:103], a[212:215], v[88:91]
  ds_read2_b32 v[100:101], v52 offset0:0 offset1:1
  ds_read2_b32 v[102:103], v52 offset0:2 offset1:3
  s_waitcnt lgkmcnt(6)
  v_mfma_f32_16x16x32_bf16 v[64:67], v[104:107], a[16:19], v[64:67]
  v_mfma_f32_16x16x32_bf16 v[68:71], v[104:107], a[48:51], v[68:71]
  v_mfma_f32_16x16x32_bf16 v[72:75], v[104:107], a[80:83], v[72:75]
  v_mfma_f32_16x16x32_bf16 v[76:79], v[104:107], a[112:115], v[76:79]
  v_mfma_f32_16x16x32_bf16 v[80:83], v[104:107], a[144:147], v[80:83]
  v_mfma_f32_16x16x32_bf16 v[84:87], v[104:107], a[176:179], v[84:87]
  v_mfma_f32_16x16x32_bf16 v[88:91], v[104:107], a[208:211], v[88:91]
  ds_read2_b32 v[104:105], v53 offset0:224 offset1:225
  ds_read2_b32 v[106:107], v53 offset0:226 offset1:227
  s_waitcnt lgkmcnt(6)
  v_mfma_f32_16x16x32_bf16 v[64:67], v[92:95], a[12:15], v[64:67]
  v_mfma_f32_16x16x32_bf16 v[68:71], v[92:95], a[44:47], v[68:71]
  v_mfma_f32_16x16x32_bf16 v[72:75], v[92:95], a[76:79], v[72:75]
  v_mfma_f32_16x16x32_bf16 v[76:79], v[92:95], a[108:111], v[76:79]
  v_mfma_f32_16x16x32_bf16 v[80:83], v[92:95], a[140:143], v[80:83]
  v_mfma_f32_16x16x32_bf16 v[84:87], v[92:95], a[172:175], v[84:87]
  v_mfma_f32_16x16x32_bf16 v[88:91], v[92:95], a[204:207], v[88:91]
  ds_read2_b32 v[92:93], v53 offset0:208 offset1:209
  ds_read2_b32 v[94:95], v53 offset0:210 offset1:211
  s_waitcnt lgkmcnt(6)
  v_mfma_f32_16x16x32_bf16 v[64:67], v[96:99], a[8:11], v[64:67]
  v_mfma_f32_16x16x32_bf16 v[68:71], v[96:99], a[40:43], v[68:71]
  v_mfma_f32_16x16x32_bf16 v[72:75], v[96:99], a[72:75], v[72:75]
  v_mfma_f32_16x16x32_bf16 v[76:79], v[96:99], a[104:107], v[76:79]
  v_mfma_f32_16x16x32_bf16 v[80:83], v[96:99], a[136:139], v[80:83]
  v_mfma_f32_16x16x32_bf16 v[84:87], v[96:99], a[168:171], v[84:87]
  v_mfma_f32_16x16x32_bf16 v[88:91], v[96:99], a[200:203], v[88:91]
  ds_read2_b32 v[96:97], v53 offset0:192 offset1:193
  ds_read2_b32 v[98:99], v53 offset0:194 offset1:195
  s_waitcnt lgkmcnt(6)
  v_mfma_f32_16x16x32_bf16 v[64:67], v[100:103], a[4:7], v[64:67]
  v_mfma_f32_16x16x32_bf16 v[68:71], v[100:103], a[36:39], v[68:71]
  v_mfma_f32_16x16x32_bf16 v[72:75], v[100:103], a[68:71], v[72:75]
  v_mfma_f32_16x16x32_bf16 v[76:79], v[100:103], a[100:103], v[76:79]
  v_mfma_f32_16x16x32_bf16 v[80:83], v[100:103], a[132:135], v[80:83]
  v_mfma_f32_16x16x32_bf16 v[84:87], v[100:103], a[164:167], v[84:87]
  v_mfma_f32_16x16x32_bf16 v[88:91], v[100:103], a[196:199], v[88:91]
  ds_read2_b32 v[100:101], v53 offset0:176 offset1:177
  ds_read2_b32 v[102:103], v53 offset0:178 offset1:179
  s_waitcnt lgkmcnt(6)
  v_mfma_f32_16x16x32_bf16 v[64:67], v[104:107], a[0:3], v[64:67]
  v_mfma_f32_16x16x32_bf16 v[68:71], v[104:107], a[32:35], v[68:71]
  v_mfma_f32_16x16x32_bf16 v[72:75], v[104:107], a[64:67], v[72:75]
  v_mfma_f32_16x16x32_bf16 v[76:79], v[104:107], a[96:99], v[76:79]
  v_mfma_f32_16x16x32_bf16 v[80:83], v[104:107], a[128:131], v[80:83]
  v_mfma_f32_16x16x32_bf16 v[84:87], v[104:107], a[160:163], v[84:87]
  v_mfma_f32_16x16x32_bf16 v[88:91], v[104:107], a[192:195], v[88:91]
  ds_read2_b32 v[104:105], v53 offset0:160 offset1:161
  ds_read2_b32 v[106:107], v53 offset0:162 offset1:163
  s_waitcnt lgkmcnt(6)
  v_mfma_f32_16x16x32_bf16 v[68:71], v[92:95], a[28:31], v[68:71]
  v_mfma_f32_16x16x32_bf16 v[72:75], v[92:95], a[60:63], v[72:75]
  v_mfma_f32_16x16x32_bf16 v[76:79], v[92:95], a[92:95], v[76:79]
  v_mfma_f32_16x16x32_bf16 v[80:83], v[92:95], a[124:127], v[80:83]
  v_mfma_f32_16x16x32_bf16 v[84:87], v[92:95], a[156:159], v[84:87]
  v_mfma_f32_16x16x32_bf16 v[88:91], v[92:95], a[188:191], v[88:91]
  ds_read2_b32 v[92:93], v53 offset0:144 offset1:145
  ds_read2_b32 v[94:95], v53 offset0:146 offset1:147
  s_waitcnt lgkmcnt(6)
  v_mfma_f32_16x16x32_bf16 v[68:71], v[96:99], a[24:27], v[68:71]
  v_mfma_f32_16x16x32_bf16 v[72:75], v[96:99], a[56:59], v[72:75]
  v_mfma_f32_16x16x32_bf16 v[76:79], v[96:99], a[88:91], v[76:79]
  v_mfma_f32_16x16x32_bf16 v[80:83], v[96:99], a[120:123], v[80:83]
  v_mfma_f32_16x16x32_bf16 v[84:87], v[96:99], a[152:155], v[84:87]
  v_mfma_f32_16x16x32_bf16 v[88:91], v[96:99], a[184:187], v[88:91]
  ds_read2_b32 v[96:97], v53 offset0:128 offset1:129
  ds_read2_b32 v[98:99], v53 offset0:130 offset1:131
  s_waitcnt lgkmcnt(6)
  v_mfma_f32_16x16x32_bf16 v[68:71], v[100:103], a[20:23], v[68:71]
  v_mfma_f32_16x16x32_bf16 v[72:75], v[100:103], a[52:55], v[72:75]
  v_mfma_f32_16x16x32_bf16 v[76:79], v[100:103], a[84:87], v[76:79]
  v_mfma_f32_16x16x32_bf16 v[80:83], v[100:103], a[116:119], v[80:83]
  v_mfma_f32_16x16x32_bf16 v[84:87], v[100:103], a[148:151], v[84:87]
  v_mfma_f32_16x16x32_bf16 v[88:91], v[100:103], a[180:183], v[88:91]
  ds_read2_b32 v[100:101], v53 offset0:112 offset1:113
  ds_read2_b32 v[102:103], v53 offset0:114 offset1:115
  s_waitcnt lgkmcnt(6)
  v_mfma_f32_16x16x32_bf16 v[68:71], v[104:107], a[16:19], v[68:71]
  v_mfma_f32_16x16x32_bf16 v[72:75], v[104:107], a[48:51], v[72:75]
  v_mfma_f32_16x16x32_bf16 v[76:79], v[104:107], a[80:83], v[76:79]
  v_mfma_f32_16x16x32_bf16 v[80:83], v[104:107], a[112:115], v[80:83]
  v_mfma_f32_16x16x32_bf16 v[84:87], v[104:107], a[144:147], v[84:87]
  v_mfma_f32_16x16x32_bf16 v[88:91], v[104:107], a[176:179], v[88:91]
  ds_read2_b32 v[104:105], v53 offset0:96 offset1:97
  ds_read2_b32 v[106:107], v53 offset0:98 offset1:99
  s_waitcnt lgkmcnt(6)
  v_mfma_f32_16x16x32_bf16 v[68:71], v[92:95], a[12:15], v[68:71]
  v_mfma_f32_16x16x32_bf16 v[72:75], v[92:95], a[44:47], v[72:75]
  v_mfma_f32_16x16x32_bf16 v[76:79], v[92:95], a[76:79], v[76:79]
  v_mfma_f32_16x16x32_bf16 v[80:83], v[92:95], a[108:111], v[80:83]
  v_mfma_f32_16x16x32_bf16 v[84:87], v[92:95], a[140:143], v[84:87]
  v_mfma_f32_16x16x32_bf16 v[88:91], v[92:95], a[172:175], v[88:91]
  ds_read2_b32 v[92:93], v53 offset0:80 offset1:81
  ds_read2_b32 v[94:95], v53 offset0:82 offset1:83
  s_waitcnt lgkmcnt(6)
  v_mfma_f32_16x16x32_bf16 v[68:71], v[96:99], a[8:11], v[68:71]
  v_mfma_f32_16x16x32_bf16 v[72:75], v[96:99], a[40:43], v[72:75]
  v_mfma_f32_16x16x32_bf16 v[76:79], v[96:99], a[72:75], v[76:79]
  v_mfma_f32_16x16x32_bf16 v[80:83], v[96:99], a[104:107], v[80:83]
  v_mfma_f32_16x16x32_bf16 v[84:87], v[96:99], a[136:139], v[84:87]
  v_mfma_f32_16x16x32_bf16 v[88:91], v[96:99], a[168:171], v[88:91]
  ds_read2_b32 v[96:97], v53 offset0:64 offset1:65
  ds_read2_b32 v[98:99], v53 offset0:66 offset1:67
  s_waitcnt lgkmcnt(6)
  v_mfma_f32_16x16x32_bf16 v[68:71], v[100:103], a[4:7], v[68:71]
  v_mfma_f32_16x16x32_bf16 v[72:75], v[100:103], a[36:39], v[72:75]
  v_mfma_f32_16x16x32_bf16 v[76:79], v[100:103], a[68:71], v[76:79]
  v_mfma_f32_16x16x32_bf16 v[80:83], v[100:103], a[100:103], v[80:83]
  v_mfma_f32_16x16x32_bf16 v[84:87], v[100:103], a[132:135], v[84:87]
  v_mfma_f32_16x16x32_bf16 v[88:91], v[100:103], a[164:167], v[88:91]
  ds_read2_b32 v[100:101], v53 offset0:48 offset1:49
  ds_read2_b32 v[102:103], v53 offset0:50 offset1:51
  s_waitcnt lgkmcnt(6)
  v_mfma_f32_16x16x32_bf16 v[68:71], v[104:107], a[0:3], v[68:71]
  v_mfma_f32_16x16x32_bf16 v[72:75], v[104:107], a[32:35], v[72:75]
  v_mfma_f32_16x16x32_bf16 v[76:79], v[104:107], a[64:67], v[76:79]
  v_mfma_f32_16x16x32_bf16 v[80:83], v[104:107], a[96:99], v[80:83]
  v_mfma_f32_16x16x32_bf16 v[84:87], v[104:107], a[128:131], v[84:87]
  v_mfma_f32_16x16x32_bf16 v[88:91], v[104:107], a[160:163], v[88:91]
  ds_read2_b32 v[104:105], v53 offset0:32 offset1:33
  ds_read2_b32 v[106:107], v53 offset0:34 offset1:35
  s_waitcnt lgkmcnt(6)
  v_mfma_f32_16x16x32_bf16 v[72:75], v[92:95], a[28:31], v[72:75]
  v_mfma_f32_16x16x32_bf16 v[76:79], v[92:95], a[60:63], v[76:79]
  v_mfma_f32_16x16x32_bf16 v[80:83], v[92:95], a[92:95], v[80:83]
  v_mfma_f32_16x16x32_bf16 v[84:87], v[92:95], a[124:127], v[84:87]
  v_mfma_f32_16x16x32_bf16 v[88:91], v[92:95], a[156:159], v[88:91]
  ds_read2_b32 v[92:93], v53 offset0:16 offset1:17
  ds_read2_b32 v[94:95], v53 offset0:18 offset1:19
  s_waitcnt lgkmcnt(6)
  v_mfma_f32_16x16x32_bf16 v[72:75], v[96:99], a[24:27], v[72:75]
  v_mfma_f32_16x16x32_bf16 v[76:79], v[96:99], a[56:59], v[76:79]
  v_mfma_f32_16x16x32_bf16 v[80:83], v[96:99], a[88:91], v[80:83]
  v_mfma_f32_16x16x32_bf16 v[84:87], v[96:99], a[120:123], v[84:87]
  v_mfma_f32_16x16x32_bf16 v[88:91], v[96:99], a[152:155], v[88:91]
  ds_read2_b32 v[96:97], v53 offset0:0 offset1:1
  ds_read2_b32 v[98:99], v53 offset0:2 offset1:3
  s_waitcnt lgkmcnt(6)
  v_mfma_f32_16x16x32_bf16 v[72:75], v[100:103], a[20:23], v[72:75]
  v_mfma_f32_16x16x32_bf16 v[76:79], v[100:103], a[52:55], v[76:79]
  v_mfma_f32_16x16x32_bf16 v[80:83], v[100:103], a[84:87], v[80:83]
  v_mfma_f32_16x16x32_bf16 v[84:87], v[100:103], a[116:119], v[84:87]
  v_mfma_f32_16x16x32_bf16 v[88:91], v[100:103], a[148:151], v[88:91]
  ds_read2_b32 v[100:101], v54 offset0:224 offset1:225
  ds_read2_b32 v[102:103], v54 offset0:226 offset1:227
  s_waitcnt lgkmcnt(6)
  v_mfma_f32_16x16x32_bf16 v[72:75], v[104:107], a[16:19], v[72:75]
  v_mfma_f32_16x16x32_bf16 v[76:79], v[104:107], a[48:51], v[76:79]
  v_mfma_f32_16x16x32_bf16 v[80:83], v[104:107], a[80:83], v[80:83]
  v_mfma_f32_16x16x32_bf16 v[84:87], v[104:107], a[112:115], v[84:87]
  v_mfma_f32_16x16x32_bf16 v[88:91], v[104:107], a[144:147], v[88:91]
  ds_read2_b32 v[104:105], v54 offset0:208 offset1:209
  ds_read2_b32 v[106:107], v54 offset0:210 offset1:211
  s_waitcnt lgkmcnt(6)
  v_mfma_f32_16x16x32_bf16 v[72:75], v[92:95], a[12:15], v[72:75]
  v_mfma_f32_16x16x32_bf16 v[76:79], v[92:95], a[44:47], v[76:79]
  v_mfma_f32_16x16x32_bf16 v[80:83], v[92:95], a[76:79], v[80:83]
  v_mfma_f32_16x16x32_bf16 v[84:87], v[92:95], a[108:111], v[84:87]
  v_mfma_f32_16x16x32_bf16 v[88:91], v[92:95], a[140:143], v[88:91]
  ds_read2_b32 v[92:93], v54 offset0:192 offset1:193
  ds_read2_b32 v[94:95], v54 offset0:194 offset1:195
  s_waitcnt lgkmcnt(6)
  v_mfma_f32_16x16x32_bf16 v[72:75], v[96:99], a[8:11], v[72:75]
  v_mfma_f32_16x16x32_bf16 v[76:79], v[96:99], a[40:43], v[76:79]
  v_mfma_f32_16x16x32_bf16 v[80:83], v[96:99], a[72:75], v[80:83]
  v_mfma_f32_16x16x32_bf16 v[84:87], v[96:99], a[104:107], v[84:87]
  v_mfma_f32_16x16x32_bf16 v[88:91], v[96:99], a[136:139], v[88:91]
  ds_read2_b32 v[96:97], v54 offset0:176 offset1:177
  ds_read2_b32 v[98:99], v54 offset0:178 offset1:179
  s_waitcnt lgkmcnt(6)
  v_mfma_f32_16x16x32_bf16 v[72:75], v[100:103], a[4:7], v[72:75]
  v_mfma_f32_16x16x32_bf16 v[76:79], v[100:103], a[36:39], v[76:79]
  v_mfma_f32_16x16x32_bf16 v[80:83], v[100:103], a[68:71], v[80:83]
  v_mfma_f32_16x16x32_bf16 v[84:87], v[100:103], a[100:103], v[84:87]
  v_mfma_f32_16x16x32_bf16 v[88:91], v[100:103], a[132:135], v[88:91]
  ds_read2_b32 v[100:101], v54 offset0:160 offset1:161
  ds_read2_b32 v[102:103], v54 offset0:162 offset1:163
  s_waitcnt lgkmcnt(6)
  v_mfma_f32_16x16x32_bf16 v[72:75], v[104:107], a[0:3], v[72:75]
  v_mfma_f32_16x16x32_bf16 v[76:79], v[104:107], a[32:35], v[76:79]
  v_mfma_f32_16x16x32_bf16 v[80:83], v[104:107], a[64:67], v[80:83]
  v_mfma_f32_16x16x32_bf16 v[84:87], v[104:107], a[96:99], v[84:87]
  v_mfma_f32_16x16x32_bf16 v[88:91], v[104:107], a[128:131], v[88:91]
  ds_read2_b32 v[104:105], v54 offset0:144 offset1:145
  ds_read2_b32 v[106:107], v54 offset0:146 offset1:147
  s_waitcnt lgkmcnt(6)
  v_mfma_f32_16x16x32_bf16 v[76:79], v[92:95], a[28:31], v[76:79]
  v_mfma_f32_16x16x32_bf16 v[80:83], v[92:95], a[60:63], v[80:83]
  v_mfma_f32_16x16x32_bf16 v[84:87], v[92:95], a[92:95], v[84:87]
  v_mfma_f32_16x16x32_bf16 v[88:91], v[92:95], a[124:127], v[88:91]
  ds_read2_b32 v[92:93], v54 offset0:128 offset1:129
  ds_read2_b32 v[94:95], v54 offset0:130 offset1:131
  s_waitcnt lgkmcnt(6)
  v_mfma_f32_16x16x32_bf16 v[76:79], v[96:99], a[24:27], v[76:79]
  v_mfma_f32_16x16x32_bf16 v[80:83], v[96:99], a[56:59], v[80:83]
  v_mfma_f32_16x16x32_bf16 v[84:87], v[96:99], a[88:91], v[84:87]
  v_mfma_f32_16x16x32_bf16 v[88:91], v[96:99], a[120:123], v[88:91]
  ds_read2_b32 v[96:97], v54 offset0:112 offset1:113
  ds_read2_b32 v[98:99], v54 offset0:114 offset1:115
  s_waitcnt lgkmcnt(6)
  v_mfma_f32_16x16x32_bf16 v[76:79], v[100:103], a[20:23], v[76:79]
  v_mfma_f32_16x16x32_bf16 v[80:83], v[100:103], a[52:55], v[80:83]
  v_mfma_f32_16x16x32_bf16 v[84:87], v[100:103], a[84:87], v[84:87]
  v_mfma_f32_16x16x32_bf16 v[88:91], v[100:103], a[116:119], v[88:91]
  ds_read2_b32 v[100:101], v54 offset0:96 offset1:97
  ds_read2_b32 v[102:103], v54 offset0:98 offset1:99
  s_waitcnt lgkmcnt(6)
  v_mfma_f32_16x16x32_bf16 v[76:79], v[104:107], a[16:19], v[76:79]
  v_mfma_f32_16x16x32_bf16 v[80:83], v[104:107], a[48:51], v[80:83]
  v_mfma_f32_16x16x32_bf16 v[84:87], v[104:107], a[80:83], v[84:87]
  v_mfma_f32_16x16x32_bf16 v[88:91], v[104:107], a[112:115], v[88:91]
  ds_read2_b32 v[104:105], v54 offset0:80 offset1:81
  ds_read2_b32 v[106:107], v54 offset0:82 offset1:83
  s_waitcnt lgkmcnt(6)
  v_mfma_f32_16x16x32_bf16 v[76:79], v[92:95], a[12:15], v[76:79]
  v_mfma_f32_16x16x32_bf16 v[80:83], v[92:95], a[44:47], v[80:83]
  v_mfma_f32_16x16x32_bf16 v[84:87], v[92:95], a[76:79], v[84:87]
  v_mfma_f32_16x16x32_bf16 v[88:91], v[92:95], a[108:111], v[88:91]
  ds_read2_b32 v[92:93], v54 offset0:64 offset1:65
  ds_read2_b32 v[94:95], v54 offset0:66 offset1:67
  s_waitcnt lgkmcnt(6)
  v_mfma_f32_16x16x32_bf16 v[76:79], v[96:99], a[8:11], v[76:79]
  v_mfma_f32_16x16x32_bf16 v[80:83], v[96:99], a[40:43], v[80:83]
  v_mfma_f32_16x16x32_bf16 v[84:87], v[96:99], a[72:75], v[84:87]
  v_mfma_f32_16x16x32_bf16 v[88:91], v[96:99], a[104:107], v[88:91]
  ds_read2_b32 v[96:97], v54 offset0:48 offset1:49
  ds_read2_b32 v[98:99], v54 offset0:50 offset1:51
  s_waitcnt lgkmcnt(6)
  v_mfma_f32_16x16x32_bf16 v[76:79], v[100:103], a[4:7], v[76:79]
  v_mfma_f32_16x16x32_bf16 v[80:83], v[100:103], a[36:39], v[80:83]
  v_mfma_f32_16x16x32_bf16 v[84:87], v[100:103], a[68:71], v[84:87]
  v_mfma_f32_16x16x32_bf16 v[88:91], v[100:103], a[100:103], v[88:91]
  ds_read2_b32 v[100:101], v54 offset0:32 offset1:33
  ds_read2_b32 v[102:103], v54 offset0:34 offset1:35
  s_waitcnt lgkmcnt(6)
  v_mfma_f32_16x16x32_bf16 v[76:79], v[104:107], a[0:3], v[76:79]
  v_mfma_f32_16x16x32_bf16 v[80:83], v[104:107], a[32:35], v[80:83]
  v_mfma_f32_16x16x32_bf16 v[84:87], v[104:107], a[64:67], v[84:87]
  v_mfma_f32_16x16x32_bf16 v[88:91], v[104:107], a[96:99], v[88:91]
  ds_read2_b32 v[104:105], v54 offset0:16 offset1:17
  ds_read2_b32 v[106:107], v54 offset0:18 offset1:19
  s_waitcnt lgkmcnt(6)
  v_mfma_f32_16x16x32_bf16 v[80:83], v[92:95], a[28:31], v[80:83]
  v_mfma_f32_16x16x32_bf16 v[84:87], v[92:95], a[60:63], v[84:87]
  v_mfma_f32_16x16x32_bf16 v[88:91], v[92:95], a[92:95], v[88:91]
  ds_read2_b32 v[92:93], v54 offset0:0 offset1:1
  ds_read2_b32 v[94:95], v54 offset0:2 offset1:3
  s_waitcnt lgkmcnt(6)
  v_mfma_f32_16x16x32_bf16 v[80:83], v[96:99], a[24:27], v[80:83]
  v_mfma_f32_16x16x32_bf16 v[84:87], v[96:99], a[56:59], v[84:87]
  v_mfma_f32_16x16x32_bf16 v[88:91], v[96:99], a[88:91], v[88:91]
  ds_read2_b32 v[96:97], v55 offset0:224 offset1:225
  ds_read2_b32 v[98:99], v55 offset0:226 offset1:227
  s_waitcnt lgkmcnt(6)
  v_mfma_f32_16x16x32_bf16 v[80:83], v[100:103], a[20:23], v[80:83]
  v_mfma_f32_16x16x32_bf16 v[84:87], v[100:103], a[52:55], v[84:87]
  v_mfma_f32_16x16x32_bf16 v[88:91], v[100:103], a[84:87], v[88:91]
  ds_read2_b32 v[100:101], v55 offset0:208 offset1:209
  ds_read2_b32 v[102:103], v55 offset0:210 offset1:211
  s_waitcnt lgkmcnt(6)
  v_mfma_f32_16x16x32_bf16 v[80:83], v[104:107], a[16:19], v[80:83]
  v_mfma_f32_16x16x32_bf16 v[84:87], v[104:107], a[48:51], v[84:87]
  v_mfma_f32_16x16x32_bf16 v[88:91], v[104:107], a[80:83], v[88:91]
  ds_read2_b32 v[104:105], v55 offset0:192 offset1:193
  ds_read2_b32 v[106:107], v55 offset0:194 offset1:195
  s_waitcnt lgkmcnt(6)
  v_mfma_f32_16x16x32_bf16 v[80:83], v[92:95], a[12:15], v[80:83]
  v_mfma_f32_16x16x32_bf16 v[84:87], v[92:95], a[44:47], v[84:87]
  v_mfma_f32_16x16x32_bf16 v[88:91], v[92:95], a[76:79], v[88:91]
  ds_read2_b32 v[92:93], v55 offset0:176 offset1:177
  ds_read2_b32 v[94:95], v55 offset0:178 offset1:179
  s_waitcnt lgkmcnt(6)
  v_mfma_f32_16x16x32_bf16 v[80:83], v[96:99], a[8:11], v[80:83]
  v_mfma_f32_16x16x32_bf16 v[84:87], v[96:99], a[40:43], v[84:87]
  v_mfma_f32_16x16x32_bf16 v[88:91], v[96:99], a[72:75], v[88:91]
  ds_read2_b32 v[96:97], v55 offset0:160 offset1:161
  ds_read2_b32 v[98:99], v55 offset0:162 offset1:163
  s_waitcnt lgkmcnt(6)
  v_mfma_f32_16x16x32_bf16 v[80:83], v[100:103], a[4:7], v[80:83]
  v_mfma_f32_16x16x32_bf16 v[84:87], v[100:103], a[36:39], v[84:87]
  v_mfma_f32_16x16x32_bf16 v[88:91], v[100:103], a[68:71], v[88:91]
  ds_read2_b32 v[100:101], v55 offset0:144 offset1:145
  ds_read2_b32 v[102:103], v55 offset0:146 offset1:147
  s_waitcnt lgkmcnt(6)
  v_mfma_f32_16x16x32_bf16 v[80:83], v[104:107], a[0:3], v[80:83]
  v_mfma_f32_16x16x32_bf16 v[84:87], v[104:107], a[32:35], v[84:87]
  v_mfma_f32_16x16x32_bf16 v[88:91], v[104:107], a[64:67], v[88:91]
  ds_read2_b32 v[104:105], v55 offset0:128 offset1:129
  ds_read2_b32 v[106:107], v55 offset0:130 offset1:131
  s_waitcnt lgkmcnt(6)
  v_mfma_f32_16x16x32_bf16 v[84:87], v[92:95], a[28:31], v[84:87]
  v_mfma_f32_16x16x32_bf16 v[88:91], v[92:95], a[60:63], v[88:91]
  ds_read2_b32 v[92:93], v55 offset0:112 offset1:113
  ds_read2_b32 v[94:95], v55 offset0:114 offset1:115
  s_waitcnt lgkmcnt(6)
  v_mfma_f32_16x16x32_bf16 v[84:87], v[96:99], a[24:27], v[84:87]
  v_mfma_f32_16x16x32_bf16 v[88:91], v[96:99], a[56:59], v[88:91]
  ds_read2_b32 v[96:97], v55 offset0:96 offset1:97
  ds_read2_b32 v[98:99], v55 offset0:98 offset1:99
  s_waitcnt lgkmcnt(6)
  v_mfma_f32_16x16x32_bf16 v[84:87], v[100:103], a[20:23], v[84:87]
  v_mfma_f32_16x16x32_bf16 v[88:91], v[100:103], a[52:55], v[88:91]
  ds_read2_b32 v[100:101], v55 offset0:80 offset1:81
  ds_read2_b32 v[102:103], v55 offset0:82 offset1:83
  s_waitcnt lgkmcnt(6)
  v_mfma_f32_16x16x32_bf16 v[84:87], v[104:107], a[16:19], v[84:87]
  v_mfma_f32_16x16x32_bf16 v[88:91], v[104:107], a[48:51], v[88:91]
  ds_read2_b32 v[104:105], v55 offset0:64 offset1:65
  ds_read2_b32 v[106:107], v55 offset0:66 offset1:67
  s_waitcnt lgkmcnt(6)
  v_mfma_f32_16x16x32_bf16 v[84:87], v[92:95], a[12:15], v[84:87]
  v_mfma_f32_16x16x32_bf16 v[88:91], v[92:95], a[44:47], v[88:91]
  ds_read2_b32 v[92:93], v55 offset0:48 offset1:49
  ds_read2_b32 v[94:95], v55 offset0:50 offset1:51
  s_waitcnt lgkmcnt(6)
  v_mfma_f32_16x16x32_bf16 v[84:87], v[96:99], a[8:11], v[84:87]
  v_mfma_f32_16x16x32_bf16 v[88:91], v[96:99], a[40:43], v[88:91]
  ds_read2_b32 v[96:97], v55 offset0:32 offset1:33
  ds_read2_b32 v[98:99], v55 offset0:34 offset1:35
  s_waitcnt lgkmcnt(6)
  v_mfma_f32_16x16x32_bf16 v[84:87], v[100:103], a[4:7], v[84:87]
  v_mfma_f32_16x16x32_bf16 v[88:91], v[100:103], a[36:39], v[88:91]
  ds_read2_b32 v[100:101], v55 offset0:16 offset1:17
  ds_read2_b32 v[102:103], v55 offset0:18 offset1:19
  s_waitcnt lgkmcnt(6)
  v_mfma_f32_16x16x32_bf16 v[84:87], v[104:107], a[0:3], v[84:87]
  v_mfma_f32_16x16x32_bf16 v[88:91], v[104:107], a[32:35], v[88:91]
  ds_read2_b32 v[104:105], v55 offset0:0 offset1:1
  ds_read2_b32 v[106:107], v55 offset0:2 offset1:3
  s_waitcnt lgkmcnt(6)
  v_mfma_f32_16x16x32_bf16 v[88:91], v[92:95], a[28:31], v[88:91]
  ds_read2_b32 v[92:93], v56 offset0:224 offset1:225
  ds_read2_b32 v[94:95], v56 offset0:226 offset1:227
  s_waitcnt lgkmcnt(6)
  v_mfma_f32_16x16x32_bf16 v[88:91], v[96:99], a[24:27], v[88:91]
  ds_read2_b32 v[96:97], v56 offset0:208 offset1:209
  ds_read2_b32 v[98:99], v56 offset0:210 offset1:211
  s_waitcnt lgkmcnt(6)
  v_mfma_f32_16x16x32_bf16 v[88:91], v[100:103], a[20:23], v[88:91]
  ds_read2_b32 v[100:101], v56 offset0:192 offset1:193
  ds_read2_b32 v[102:103], v56 offset0:194 offset1:195
  s_waitcnt lgkmcnt(6)
  v_mfma_f32_16x16x32_bf16 v[88:91], v[104:107], a[16:19], v[88:91]
  ds_read2_b32 v[104:105], v56 offset0:176 offset1:177
  ds_read2_b32 v[106:107], v56 offset0:178 offset1:179
  s_waitcnt lgkmcnt(6)
  v_mfma_f32_16x16x32_bf16 v[88:91], v[92:95], a[12:15], v[88:91]
  s_waitcnt lgkmcnt(4)
  v_mfma_f32_16x16x32_bf16 v[88:91], v[96:99], a[8:11], v[88:91]
  s_waitcnt lgkmcnt(2)
  v_mfma_f32_16x16x32_bf16 v[88:91], v[100:103], a[4:7], v[88:91]
  s_waitcnt lgkmcnt(0)
  v_mfma_f32_16x16x32_bf16 v[88:91], v[104:107], a[0:3], v[88:91]
  v_lshlrev_b32 v46, 5, v4
  v_lshl_add_u32 v46, v3, 3, v46
  v_add_u32 v46, s17, v46
  ds_read_b64 v[108:109], v46 offset:512
  ds_read_b64 v[110:111], v46 offset:1024
  ds_read_b64 v[112:113], v46 offset:1536
  ds_read_b64 v[114:115], v46 offset:2048
  ds_read_b64 v[116:117], v46 offset:2560
  ds_read_b64 v[118:119], v46 offset:3072
  ds_read_b64 v[120:121], v46 offset:3584
  ds_read_b64 v[122:123], v46 offset:4096
  s_waitcnt lgkmcnt(0)
  v_lshlrev_b32 v124, 16, v108
  v_and_b32 v125, 0xffff0000, v108
  v_lshlrev_b32 v126, 16, v109
  v_and_b32 v127, 0xffff0000, v109
  v_mul_f32 v124, v124, v33
  v_mul_f32 v125, v125, v33
  v_mul_f32 v126, v126, v33
  v_mul_f32 v127, v127, v33
  v_cvt_pk_bf16_f32 v128, v124, v125
  v_cvt_pk_bf16_f32 v129, v126, v127
  v_cvt_pk_bf16_f32 v130, v60, v61
  v_cvt_pk_bf16_f32 v131, v62, v63
  v_lshlrev_b32 v124, 16, v128
  v_and_b32 v125, 0xffff0000, v128
  v_lshlrev_b32 v132, 16, v130
  v_and_b32 v133, 0xffff0000, v130
  v_lshlrev_b32 v126, 16, v129
  v_and_b32 v127, 0xffff0000, v129
  v_lshlrev_b32 v134, 16, v131
  v_and_b32 v135, 0xffff0000, v131
  v_add_f32 v124, v124, v132
  v_add_f32 v125, v125, v133
  v_add_f32 v126, v126, v134
  v_add_f32 v127, v127, v135
  v_cvt_pk_bf16_f32 v108, v124, v125
  v_cvt_pk_bf16_f32 v109, v126, v127
  ds_write_b64 v46, v[108:109] offset:512
  v_lshlrev_b32 v124, 16, v110
  v_and_b32 v125, 0xffff0000, v110
  v_lshlrev_b32 v126, 16, v111
  v_and_b32 v127, 0xffff0000, v111
  v_mul_f32 v124, v124, v33
  v_mul_f32 v125, v125, v33
  v_mul_f32 v126, v126, v33
  v_mul_f32 v127, v127, v33
  v_cvt_pk_bf16_f32 v128, v124, v125
  v_cvt_pk_bf16_f32 v129, v126, v127
  v_cvt_pk_bf16_f32 v130, v64, v65
  v_cvt_pk_bf16_f32 v131, v66, v67
  v_lshlrev_b32 v124, 16, v128
  v_and_b32 v125, 0xffff0000, v128
  v_lshlrev_b32 v132, 16, v130
  v_and_b32 v133, 0xffff0000, v130
  v_lshlrev_b32 v126, 16, v129
  v_and_b32 v127, 0xffff0000, v129
  v_lshlrev_b32 v134, 16, v131
  v_and_b32 v135, 0xffff0000, v131
  v_add_f32 v124, v124, v132
  v_add_f32 v125, v125, v133
  v_add_f32 v126, v126, v134
  v_add_f32 v127, v127, v135
  v_cvt_pk_bf16_f32 v110, v124, v125
  v_cvt_pk_bf16_f32 v111, v126, v127
  ds_write_b64 v46, v[110:111] offset:1024
  v_lshlrev_b32 v124, 16, v112
  v_and_b32 v125, 0xffff0000, v112
  v_lshlrev_b32 v126, 16, v113
  v_and_b32 v127, 0xffff0000, v113
  v_mul_f32 v124, v124, v33
  v_mul_f32 v125, v125, v33
  v_mul_f32 v126, v126, v33
  v_mul_f32 v127, v127, v33
  v_cvt_pk_bf16_f32 v128, v124, v125
  v_cvt_pk_bf16_f32 v129, v126, v127
  v_cvt_pk_bf16_f32 v130, v68, v69
  v_cvt_pk_bf16_f32 v131, v70, v71
  v_lshlrev_b32 v124, 16, v128
  v_and_b32 v125, 0xffff0000, v128
  v_lshlrev_b32 v132, 16, v130
  v_and_b32 v133, 0xffff0000, v130
  v_lshlrev_b32 v126, 16, v129
  v_and_b32 v127, 0xffff0000, v129
  v_lshlrev_b32 v134, 16, v131
  v_and_b32 v135, 0xffff0000, v131
  v_add_f32 v124, v124, v132
  v_add_f32 v125, v125, v133
  v_add_f32 v126, v126, v134
  v_add_f32 v127, v127, v135
  v_cvt_pk_bf16_f32 v112, v124, v125
  v_cvt_pk_bf16_f32 v113, v126, v127
  ds_write_b64 v46, v[112:113] offset:1536
  v_lshlrev_b32 v124, 16, v114
  v_and_b32 v125, 0xffff0000, v114
  v_lshlrev_b32 v126, 16, v115
  v_and_b32 v127, 0xffff0000, v115
  v_mul_f32 v124, v124, v33
  v_mul_f32 v125, v125, v33
  v_mul_f32 v126, v126, v33
  v_mul_f32 v127, v127, v33
  v_cvt_pk_bf16_f32 v128, v124, v125
  v_cvt_pk_bf16_f32 v129, v126, v127
  v_cvt_pk_bf16_f32 v130, v72, v73
  v_cvt_pk_bf16_f32 v131, v74, v75
  v_lshlrev_b32 v124, 16, v128
  v_and_b32 v125, 0xffff0000, v128
  v_lshlrev_b32 v132, 16, v130
  v_and_b32 v133, 0xffff0000, v130
  v_lshlrev_b32 v126, 16, v129
  v_and_b32 v127, 0xffff0000, v129
  v_lshlrev_b32 v134, 16, v131
  v_and_b32 v135, 0xffff0000, v131
  v_add_f32 v124, v124, v132
  v_add_f32 v125, v125, v133
  v_add_f32 v126, v126, v134
  v_add_f32 v127, v127, v135
  v_cvt_pk_bf16_f32 v114, v124, v125
  v_cvt_pk_bf16_f32 v115, v126, v127
  ds_write_b64 v46, v[114:115] offset:2048
  v_lshlrev_b32 v124, 16, v116
  v_and_b32 v125, 0xffff0000, v116
  v_lshlrev_b32 v126, 16, v117
  v_and_b32 v127, 0xffff0000, v117
  v_mul_f32 v124, v124, v33
  v_mul_f32 v125, v125, v33
  v_mul_f32 v126, v126, v33
  v_mul_f32 v127, v127, v33
  v_cvt_pk_bf16_f32 v128, v124, v125
  v_cvt_pk_bf16_f32 v129, v126, v127
  v_cvt_pk_bf16_f32 v130, v76, v77
  v_cvt_pk_bf16_f32 v131, v78, v79
  v_lshlrev_b32 v124, 16, v128
  v_and_b32 v125, 0xffff0000, v128
  v_lshlrev_b32 v132, 16, v130
  v_and_b32 v133, 0xffff0000, v130
  v_lshlrev_b32 v126, 16, v129
  v_and_b32 v127, 0xffff0000, v129
  v_lshlrev_b32 v134, 16, v131
  v_and_b32 v135, 0xffff0000, v131
  v_add_f32 v124, v124, v132
  v_add_f32 v125, v125, v133
  v_add_f32 v126, v126, v134
  v_add_f32 v127, v127, v135
  v_cvt_pk_bf16_f32 v116, v124, v125
  v_cvt_pk_bf16_f32 v117, v126, v127
  ds_write_b64 v46, v[116:117] offset:2560
  v_lshlrev_b32 v124, 16, v118
  v_and_b32 v125, 0xffff0000, v118
  v_lshlrev_b32 v126, 16, v119
  v_and_b32 v127, 0xffff0000, v119
  v_mul_f32 v124, v124, v33
  v_mul_f32 v125, v125, v33
  v_mul_f32 v126, v126, v33
  v_mul_f32 v127, v127, v33
  v_cvt_pk_bf16_f32 v128, v124, v125
  v_cvt_pk_bf16_f32 v129, v126, v127
  v_cvt_pk_bf16_f32 v130, v80, v81
  v_cvt_pk_bf16_f32 v131, v82, v83
  v_lshlrev_b32 v124, 16, v128
  v_and_b32 v125, 0xffff0000, v128
  v_lshlrev_b32 v132, 16, v130
  v_and_b32 v133, 0xffff0000, v130
  v_lshlrev_b32 v126, 16, v129
  v_and_b32 v127, 0xffff0000, v129
  v_lshlrev_b32 v134, 16, v131
  v_and_b32 v135, 0xffff0000, v131
  v_add_f32 v124, v124, v132
  v_add_f32 v125, v125, v133
  v_add_f32 v126, v126, v134
  v_add_f32 v127, v127, v135
  v_cvt_pk_bf16_f32 v118, v124, v125
  v_cvt_pk_bf16_f32 v119, v126, v127
  ds_write_b64 v46, v[118:119] offset:3072
  v_lshlrev_b32 v124, 16, v120
  v_and_b32 v125, 0xffff0000, v120
  v_lshlrev_b32 v126, 16, v121
  v_and_b32 v127, 0xffff0000, v121
  v_mul_f32 v124, v124, v33
  v_mul_f32 v125, v125, v33
  v_mul_f32 v126, v126, v33
  v_mul_f32 v127, v127, v33
  v_cvt_pk_bf16_f32 v128, v124, v125
  v_cvt_pk_bf16_f32 v129, v126, v127
  v_cvt_pk_bf16_f32 v130, v84, v85
  v_cvt_pk_bf16_f32 v131, v86, v87
  v_lshlrev_b32 v124, 16, v128
  v_and_b32 v125, 0xffff0000, v128
  v_lshlrev_b32 v132, 16, v130
  v_and_b32 v133, 0xffff0000, v130
  v_lshlrev_b32 v126, 16, v129
  v_and_b32 v127, 0xffff0000, v129
  v_lshlrev_b32 v134, 16, v131
  v_and_b32 v135, 0xffff0000, v131
  v_add_f32 v124, v124, v132
  v_add_f32 v125, v125, v133
  v_add_f32 v126, v126, v134
  v_add_f32 v127, v127, v135
  v_cvt_pk_bf16_f32 v120, v124, v125
  v_cvt_pk_bf16_f32 v121, v126, v127
  ds_write_b64 v46, v[120:121] offset:3584
  v_lshlrev_b32 v124, 16, v122
  v_and_b32 v125, 0xffff0000, v122
  v_lshlrev_b32 v126, 16, v123
  v_and_b32 v127, 0xffff0000, v123
  v_mul_f32 v124, v124, v33
  v_mul_f32 v125, v125, v33
  v_mul_f32 v126, v126, v33
  v_mul_f32 v127, v127, v33
  v_cvt_pk_bf16_f32 v128, v124, v125
  v_cvt_pk_bf16_f32 v129, v126, v127
  v_cvt_pk_bf16_f32 v130, v88, v89
  v_cvt_pk_bf16_f32 v131, v90, v91
  v_lshlrev_b32 v124, 16, v128
  v_and_b32 v125, 0xffff0000, v128
  v_lshlrev_b32 v132, 16, v130
  v_and_b32 v133, 0xffff0000, v130
  v_lshlrev_b32 v126, 16, v129
  v_and_b32 v127, 0xffff0000, v129
  v_lshlrev_b32 v134, 16, v131
  v_and_b32 v135, 0xffff0000, v131
  v_add_f32 v124, v124, v132
  v_add_f32 v125, v125, v133
  v_add_f32 v126, v126, v134
  v_add_f32 v127, v127, v135
  v_cvt_pk_bf16_f32 v122, v124, v125
  v_cvt_pk_bf16_f32 v123, v126, v127
  ds_write_b64 v46, v[122:123] offset:4096
  s_waitcnt lgkmcnt(0)
  s_barrier
  v_lshlrev_b32 v6, 3, v0
  v_lshlrev_b32 v5, 4, v0
  v_add_u32 v36, 512, v6
  ds_read_b64 v[8:9], v36
  v_add_u32 v36, 25088, v6
  ds_read_b64 v[10:11], v36
  v_add_u32 v36, 49664, v6
  ds_read_b64 v[12:13], v36
  v_add_u32 v36, 74240, v6
  ds_read_b64 v[14:15], v36
  s_waitcnt lgkmcnt(0)
  s_add_u32 s22, s21, 0
  s_add_u32 s23, s22, 3584
  v_perm_b32 v16, v10, v8, s24
  v_perm_b32 v17, v14, v12, s24
  s_lshl_b32 s22, s21, 11
  s_add_u32 s22, s22, 90177536
  v_perm_b32 v18, v10, v8, s25
  v_perm_b32 v19, v14, v12, s25
  buffer_store_dwordx4 v[16:19], v5, s[8:11], s22 offen sc1
  v_perm_b32 v20, v11, v9, s24
  v_perm_b32 v21, v15, v13, s24
  v_perm_b32 v22, v11, v9, s25
  v_perm_b32 v23, v15, v13, s25
  s_add_u32 s22, s22, 4096
  buffer_store_dwordx4 v[20:23], v5, s[8:11], s22 offen sc1
  v_add_u32 v36, 2560, v6
  ds_read_b64 v[8:9], v36
  v_add_u32 v36, 27136, v6
  ds_read_b64 v[10:11], v36
  v_add_u32 v36, 51712, v6
  ds_read_b64 v[12:13], v36
  v_add_u32 v36, 76288, v6
  ds_read_b64 v[14:15], v36
  s_waitcnt lgkmcnt(0)
  s_add_u32 s22, s21, 1835008
  s_add_u32 s23, s22, 3584
  v_perm_b32 v24, v10, v8, s24
  v_perm_b32 v25, v14, v12, s24
  s_lshl_b32 s22, s21, 11
  s_add_u32 s22, s22, 90185728
  v_perm_b32 v26, v10, v8, s25
  v_perm_b32 v27, v14, v12, s25
  buffer_store_dwordx4 v[24:27], v5, s[8:11], s22 offen sc1
  v_perm_b32 v28, v11, v9, s24
  v_perm_b32 v29, v15, v13, s24
  v_perm_b32 v30, v11, v9, s25
  v_perm_b32 v31, v15, v13, s25
  s_add_u32 s22, s22, 4096
  buffer_store_dwordx4 v[28:31], v5, s[8:11], s22 offen sc1
  s_waitcnt vmcnt(0)
  s_barrier
  s_cmp_lg_u32 s16, 0
  s_cbranch_scc1 wk_nc
  v_mov_b32 v5, 1
  s_mov_b32 s22, 88599424
  s_mov_b64 exec, 1
  buffer_atomic_add v5, off, s[8:11], s22
  s_mov_b64 exec, -1
wk_nc:
  s_branch wk_loop
wk_tok:
  s_sub_u32 s3, s3, 864
  s_cmp_lt_u32 s3, 512
  s_cbranch_scc1 wk_tk
  s_sub_u32 s3, s3, 64
  s_cmp_ge_i32 s3, 512
  s_cbranch_scc1 wk_tk
  s_sub_u32 s18, s3, 448
  s_mov_b32 s20, 88599424
  v_mov_b32 v8, 0
  s_mov_b32 s30, 0
wk_cw:
  buffer_load_dword v9, v8, s[8:11], s20 offen sc1
  s_waitcnt vmcnt(0)
  v_cmp_ne_u32 vcc, 112, v9
  s_cbranch_vccz wk_cw_ok
  s_sleep 32
  s_add_u32 s30, s30, 1
  s_cmp_lt_u32 s30, 50000
  s_cbranch_scc1 wk_cw
  s_branch cA_abort
wk_cw_ok:
  v_lshlrev_b32 v5, 14, v3
  v_and_b32 v6, 1, v4
  v_lshl_add_u32 v5, v6, 12, v5
  v_lshrrev_b32 v6, 1, v4
  v_lshl_add_u32 v5, v6, 4, v5
  s_mul_i32 s20, s16, 458752
  s_lshl_b32 s21, s18, 7
  s_add_u32 s20, s20, s21
  s_and_b32 s21, s18, 32
  s_lshl_b32 s21, s21, 7
  s_add_u32 s20, s20, s21
  s_add_u32 s20, s20, 90177536
  buffer_load_dwordx4 v[8:11], v5, s[8:11], s20 offen sc1
  s_add_u32 s20, s20, 65536
  buffer_load_dwordx4 v[12:15], v5, s[8:11], s20 offen sc1
  s_add_u32 s20, s20, 65536
  buffer_load_dwordx4 v[16:19], v5, s[8:11], s20 offen sc1
  s_add_u32 s20, s20, 65536
  buffer_load_dwordx4 v[20:23], v5, s[8:11], s20 offen sc1
  s_add_u32 s20, s20, 65536
  buffer_load_dwordx4 v[24:27], v5, s[8:11], s20 offen sc1
  s_add_u32 s20, s20, 65536
  buffer_load_dwordx4 v[28:31], v5, s[8:11], s20 offen sc1
  s_add_u32 s20, s20, 65536
  buffer_load_dwordx4 v[32:35], v5, s[8:11], s20 offen sc1
  s_add_u32 s20, s20, 65536
  v_mul_u32_u24 v6, 1824, v4
  v_lshl_add_u32 v6, v3, 3, v6
  s_mul_i32 s20, s16, 224
  v_add_u32 v6, s20, v6
  s_movk_i32 s22, 912
  v_add_u32 v36, 0, v0
  v_mul_u32_u24 v37, 18725, v36
  v_lshrrev_b32 v37, 20, v37
  v_mul_u32_u24 v38, 56, v37
  v_sub_u32 v36, v36, v38
  v_lshlrev_b32 v36, 4, v36
  v_mad_u32_u24 v40, v37, s22, v36
  v_mul_u32_u24 v37, 1792, v37
  v_add_u32 v48, v37, v36
  v_add_u32 v36, 256, v0
  v_mul_u32_u24 v37, 18725, v36
  v_lshrrev_b32 v37, 20, v37
  v_mul_u32_u24 v38, 56, v37
  v_sub_u32 v36, v36, v38
  v_lshlrev_b32 v36, 4, v36
  v_mad_u32_u24 v41, v37, s22, v36
  v_mul_u32_u24 v37, 1792, v37
  v_add_u32 v49, v37, v36
  v_add_u32 v36, 512, v0
  v_mul_u32_u24 v37, 18725, v36
  v_lshrrev_b32 v37, 20, v37
  v_mul_u32_u24 v38, 56, v37
  v_sub_u32 v36, v36, v38
  v_lshlrev_b32 v36, 4, v36
  v_mad_u32_u24 v42, v37, s22, v36
  v_mul_u32_u24 v37, 1792, v37
  v_add_u32 v50, v37, v36
  v_add_u32 v36, 768, v0
  v_mul_u32_u24 v37, 18725, v36
  v_lshrrev_b32 v37, 20, v37
  v_mul_u32_u24 v38, 56, v37
  v_sub_u32 v36, v36, v38
  v_lshlrev_b32 v36, 4, v36
  v_mad_u32_u24 v43, v37, s22, v36
  v_mul_u32_u24 v37, 1792, v37
  v_add_u32 v51, v37, v36
  v_add_u32 v36, 1024, v0
  v_mul_u32_u24 v37, 18725, v36
  v_lshrrev_b32 v37, 20, v37
  v_mul_u32_u24 v38, 56, v37
  v_sub_u32 v36, v36, v38
  v_lshlrev_b32 v36, 4, v36
  v_mad_u32_u24 v44, v37, s22, v36
  v_mul_u32_u24 v37, 1792, v37
  v_add_u32 v52, v37, v36
  v_add_u32 v36, 1280, v0
  v_mul_u32_u24 v37, 18725, v36
  v_lshrrev_b32 v37, 20, v37
  v_mul_u32_u24 v38, 56, v37
  v_sub_u32 v36, v36, v38
  v_lshlrev_b32 v36, 4, v36
  v_mad_u32_u24 v45, v37, s22, v36
  v_mul_u32_u24 v37, 1792, v37
  v_add_u32 v53, v37, v36
  v_add_u32 v36, 1536, v0
  v_mul_u32_u24 v37, 18725, v36
  v_lshrrev_b32 v37, 20, v37
  v_mul_u32_u24 v38, 56, v37
  v_sub_u32 v36, v36, v38
  v_lshlrev_b32 v36, 4, v36
  v_mad_u32_u24 v46, v37, s22, v36
  v_mul_u32_u24 v37, 1792, v37
  v_add_u32 v54, v37, v36
  s_waitcnt vmcnt(6)
  ds_write_b64 v6, v[8:9] offset:0
  ds_write_b64 v6, v[10:11] offset:912
  s_waitcnt vmcnt(5)
  ds_write_b64 v6, v[12:13] offset:32
  ds_write_b64 v6, v[14:15] offset:944
  s_waitcnt vmcnt(4)
  ds_write_b64 v6, v[16:17] offset:64
  ds_write_b64 v6, v[18:19] offset:976
  s_waitcnt vmcnt(3)
  ds_write_b64 v6, v[20:21] offset:96
  ds_write_b64 v6, v[22:23] offset:1008
  s_waitcnt vmcnt(2)
  ds_write_b64 v6, v[24:25] offset:128
  ds_write_b64 v6, v[26:27] offset:1040
  s_waitcnt vmcnt(1)
  ds_write_b64 v6, v[28:29] offset:160
  ds_write_b64 v6, v[30:31] offset:1072
  s_waitcnt vmcnt(0)
  ds_write_b64 v6, v[32:33] offset:192
  ds_write_b64 v6, v[34:35] offset:1104
  s_waitcnt lgkmcnt(0)
  s_barrier
  s_mul_i32 s20, s18, 57344
  ds_read_b128 v[8:11], v40
  ds_read_b128 v[12:15], v41
  ds_read_b128 v[16:19], v42
  ds_read_b128 v[20:23], v43
  ds_read_b128 v[24:27], v44
  ds_read_b128 v[28:31], v45
  ds_read_b128 v[32:35], v46
  s_waitcnt lgkmcnt(6)
  buffer_store_dwordx4 v[8:11], v48, s[92:95], s20 offen
  s_waitcnt lgkmcnt(5)
  buffer_store_dwordx4 v[12:15], v49, s[92:95], s20 offen
  s_waitcnt lgkmcnt(4)
  buffer_store_dwordx4 v[16:19], v50, s[92:95], s20 offen
  s_waitcnt lgkmcnt(3)
  buffer_store_dwordx4 v[20:23], v51, s[92:95], s20 offen
  s_waitcnt lgkmcnt(2)
  buffer_store_dwordx4 v[24:27], v52, s[92:95], s20 offen
  s_waitcnt lgkmcnt(1)
  buffer_store_dwordx4 v[28:31], v53, s[92:95], s20 offen
  s_waitcnt lgkmcnt(0)
  buffer_store_dwordx4 v[32:35], v54, s[92:95], s20 offen
  s_branch wk_loop
wk_tk:
  s_and_b32 s18, s3, 3
  s_lshr_b32 s17, s3, 2
  s_cmp_lt_u32 s17, 8
  s_cbranch_scc1 wk_tokp
  s_sub_u32 s17, s17, 64
  s_cmp_ge_i32 s17, 56
  s_cbranch_scc1 wk_toko
  s_add_u32 s20, s17, 56
  s_lshr_b32 s17, s20, 1
  s_bitcmp0_b32 s20, 0
  s_cbranch_scc1 wk_toko
  s_add_u32 s17, s17, 8
wk_tokp:
  s_lshl_b32 s20, s18, 2
  s_add_u32 s20, s20, s16
  s_lshl_b32 s21, s17, 4
  s_add_u32 s21, s21, s20
  s_mul_i32 s21, s21, 28672
  s_add_u32 s21, s21, 12845056
  s_mul_i32 s23, s17, 28672
  s_add_u32 s23, s23, 73400320
  s_mul_i32 s24, s17, 7168
  s_add_u32 s24, s24, 88080384
  s_lshr_b32 s25, s17, 3
  s_lshl_b32 s25, s25, 4
  s_add_u32 s25, s25, s20
  s_lshl_b32 s25, s25, 7
  s_add_u32 s25, s25, 88557568
  v_mov_b32 v60, 0
  s_mov_b32 s30, 0
wp_wf:
  buffer_load_dword v61, v60, s[8:11], s25 offen sc1
  s_waitcnt vmcnt(0)
  v_cmp_ne_u32 vcc, 56, v61
  s_cbranch_vccz wp_wf_ok
  s_sleep 1
  s_cmp_ge_u32 s17, 61
  s_cbranch_scc1 wp_wf_bo
  s_sleep 4
  s_cmp_ge_u32 s17, 56
  s_cbranch_scc1 wp_wf_bo
  s_sleep 40
wp_wf_bo:
  s_add_u32 s30, s30, 1
  s_cmp_lt_u32 s30, 30000
  s_cbranch_scc1 wp_wf
  s_branch wp_abort
wp_wf_ok:
  s_add_u32 s22, s21, 0
  buffer_load_dwordx4 a[0:3], v2, s[8:11], s22 offen offset:0 sc1
  buffer_load_dwordx4 a[4:7], v2, s[8:11], s22 offen offset:1024 sc1
  buffer_load_dwordx4 a[8:11], v2, s[8:11], s22 offen offset:2048 sc1
  buffer_load_dwordx4 a[12:15], v2, s[8:11], s22 offen offset:3072 sc1
  s_add_u32 s22, s21, 4096
  buffer_load_dwordx4 a[16:19], v2, s[8:11], s22 offen offset:0 sc1
  buffer_load_dwordx4 a[20:23], v2, s[8:11], s22 offen offset:1024 sc1
  buffer_load_dwordx4 a[24:27], v2, s[8:11], s22 offen offset:2048 sc1
  buffer_load_dwordx4 a[28:31], v2, s[8:11], s22 offen offset:3072 sc1
  s_add_u32 s22, s21, 8192
  buffer_load_dwordx4 a[32:35], v2, s[8:11], s22 offen offset:0 sc1
  buffer_load_dwordx4 a[36:39], v2, s[8:11], s22 offen offset:1024 sc1
  buffer_load_dwordx4 a[40:43], v2, s[8:11], s22 offen offset:2048 sc1
  buffer_load_dwordx4 a[44:47], v2, s[8:11], s22 offen offset:3072 sc1
  s_add_u32 s22, s21, 12288
  buffer_load_dwordx4 a[48:51], v2, s[8:11], s22 offen offset:0 sc1
  buffer_load_dwordx4 a[52:55], v2, s[8:11], s22 offen offset:1024 sc1
  buffer_load_dwordx4 a[56:59], v2, s[8:11], s22 offen offset:2048 sc1
  buffer_load_dwordx4 a[60:63], v2, s[8:11], s22 offen offset:3072 sc1
  s_add_u32 s22, s21, 16384
  buffer_load_dwordx4 a[64:67], v2, s[8:11], s22 offen offset:0 sc1
  buffer_load_dwordx4 a[68:71], v2, s[8:11], s22 offen offset:1024 sc1
  buffer_load_dwordx4 a[72:75], v2, s[8:11], s22 offen offset:2048 sc1
  buffer_load_dwordx4 a[76:79], v2, s[8:11], s22 offen offset:3072 sc1
  s_add_u32 s22, s21, 20480
  buffer_load_dwordx4 a[80:83], v2, s[8:11], s22 offen offset:0 sc1
  buffer_load_dwordx4 a[84:87], v2, s[8:11], s22 offen offset:1024 sc1
  buffer_load_dwordx4 a[88:91], v2, s[8:11], s22 offen offset:2048 sc1
  buffer_load_dwordx4 a[92:95], v2, s[8:11], s22 offen offset:3072 sc1
  s_add_u32 s22, s21, 24576
  buffer_load_dwordx4 a[96:99], v2, s[8:11], s22 offen offset:0 sc1
  buffer_load_dwordx4 a[100:103], v2, s[8:11], s22 offen offset:1024 sc1
  buffer_load_dwordx4 a[104:107], v2, s[8:11], s22 offen offset:2048 sc1
  buffer_load_dwordx4 a[108:111], v2, s[8:11], s22 offen offset:3072 sc1
  s_add_u32 s22, s23, 0
  buffer_load_dwordx4 a[112:115], v2, s[8:11], s22 offen offset:0 sc1
  buffer_load_dwordx4 a[116:119], v2, s[8:11], s22 offen offset:1024 sc1
  buffer_load_dwordx4 a[120:123], v2, s[8:11], s22 offen offset:2048 sc1
  buffer_load_dwordx4 a[124:127], v2, s[8:11], s22 offen offset:3072 sc1
  s_add_u32 s22, s23, 4096
  buffer_load_dwordx4 a[128:131], v2, s[8:11], s22 offen offset:0 sc1
  buffer_load_dwordx4 a[132:135], v2, s[8:11], s22 offen offset:1024 sc1
  buffer_load_dwordx4 a[136:139], v2, s[8:11], s22 offen offset:2048 sc1
  buffer_load_dwordx4 a[140:143], v2, s[8:11], s22 offen offset:3072 sc1
  s_add_u32 s22, s23, 8192
  buffer_load_dwordx4 a[144:147], v2, s[8:11], s22 offen offset:0 sc1
  buffer_load_dwordx4 a[148:151], v2, s[8:11], s22 offen offset:1024 sc1
  buffer_load_dwordx4 a[152:155], v2, s[8:11], s22 offen offset:2048 sc1
  buffer_load_dwordx4 a[156:159], v2, s[8:11], s22 offen offset:3072 sc1
  s_add_u32 s22, s23, 12288
  buffer_load_dwordx4 a[160:163], v2, s[8:11], s22 offen offset:0 sc1
  buffer_load_dwordx4 a[164:167], v2, s[8:11], s22 offen offset:1024 sc1
  buffer_load_dwordx4 a[168:171], v2, s[8:11], s22 offen offset:2048 sc1
  buffer_load_dwordx4 a[172:175], v2, s[8:11], s22 offen offset:3072 sc1
  s_add_u32 s22, s23, 16384
  buffer_load_dwordx4 a[176:179], v2, s[8:11], s22 offen offset:0 sc1
  buffer_load_dwordx4 a[180:183], v2, s[8:11], s22 offen offset:1024 sc1
  buffer_load_dwordx4 a[184:187], v2, s[8:11], s22 offen offset:2048 sc1
  buffer_load_dwordx4 a[188:191], v2, s[8:11], s22 offen offset:3072 sc1
  s_add_u32 s22, s23, 20480
  buffer_load_dwordx4 a[192:195], v2, s[8:11], s22 offen offset:0 sc1
  buffer_load_dwordx4 a[196:199], v2, s[8:11], s22 offen offset:1024 sc1
  buffer_load_dwordx4 a[200:203], v2, s[8:11], s22 offen offset:2048 sc1
  buffer_load_dwordx4 a[204:207], v2, s[8:11], s22 offen offset:3072 sc1
  s_add_u32 s22, s23, 24576
  buffer_load_dwordx4 a[208:211], v2, s[8:11], s22 offen offset:0 sc1
  buffer_load_dwordx4 a[212:215], v2, s[8:11], s22 offen offset:1024 sc1
  buffer_load_dwordx4 a[216:219], v2, s[8:11], s22 offen offset:2048 sc1
  buffer_load_dwordx4 a[220:223], v2, s[8:11], s22 offen offset:3072 sc1
  v_lshl_add_u32 v5, v3, 2, 0
  v_cmp_le_u32 s[40:41], v5, v4
  v_lshl_add_u32 v5, v3, 2, 1
  v_cmp_le_u32 s[42:43], v5, v4
  v_lshl_add_u32 v5, v3, 2, 2
  v_cmp_le_u32 s[44:45], v5, v4
  v_lshl_add_u32 v5, v3, 2, 3
  v_cmp_le_u32 s[46:47], v5, v4
  v_cmp_gt_u32 s[48:49], 2, v3
  v_mov_b32 v6, 0xff800000
  s_waitcnt vmcnt(0)
  v_mfma_f32_16x16x32_bf16 v[8:11], a[112:115], a[0:3], 0
  v_mfma_f32_16x16x32_bf16 v[12:15], a[112:115], a[56:59], 0
  v_mfma_f32_16x16x32_bf16 v[16:19], a[168:171], a[56:59], 0
  v_mfma_f32_16x16x32_bf16 v[8:11], a[116:119], a[4:7], v[8:11]
  v_mfma_f32_16x16x32_bf16 v[12:15], a[116:119], a[60:63], v[12:15]
  v_mfma_f32_16x16x32_bf16 v[16:19], a[172:175], a[60:63], v[16:19]
  v_mfma_f32_16x16x32_bf16 v[8:11], a[120:123], a[8:11], v[8:11]
  v_mfma_f32_16x16x32_bf16 v[12:15], a[120:123], a[64:67], v[12:15]
  v_mfma_f32_16x16x32_bf16 v[16:19], a[176:179], a[64:67], v[16:19]
  v_mfma_f32_16x16x32_bf16 v[8:11], a[124:127], a[12:15], v[8:11]
  v_mfma_f32_16x16x32_bf16 v[12:15], a[124:127], a[68:71], v[12:15]
  v_mfma_f32_16x16x32_bf16 v[16:19], a[180:183], a[68:71], v[16:19]
  v_mfma_f32_16x16x32_bf16 v[8:11], a[128:131], a[16:19], v[8:11]
  v_mfma_f32_16x16x32_bf16 v[12:15], a[128:131], a[72:75], v[12:15]
  v_mfma_f32_16x16x32_bf16 v[16:19], a[184:187], a[72:75], v[16:19]
  v_mfma_f32_16x16x32_bf16 v[8:11], a[132:135], a[20:23], v[8:11]
  v_mfma_f32_16x16x32_bf16 v[12:15], a[132:135], a[76:79], v[12:15]
  v_mfma_f32_16x16x32_bf16 v[16:19], a[188:191], a[76:79], v[16:19]
  v_mfma_f32_16x16x32_bf16 v[8:11], a[136:139], a[24:27], v[8:11]
  v_mfma_f32_16x16x32_bf16 v[12:15], a[136:139], a[80:83], v[12:15]
  v_mfma_f32_16x16x32_bf16 v[16:19], a[192:195], a[80:83], v[16:19]
  v_mfma_f32_16x16x32_bf16 v[8:11], a[140:143], a[28:31], v[8:11]
  v_mfma_f32_16x16x32_bf16 v[12:15], a[140:143], a[84:87], v[12:15]
  v_mfma_f32_16x16x32_bf16 v[16:19], a[196:199], a[84:87], v[16:19]
  v_mfma_f32_16x16x32_bf16 v[8:11], a[144:147], a[32:35], v[8:11]
  v_mfma_f32_16x16x32_bf16 v[12:15], a[144:147], a[88:91], v[12:15]
  v_mfma_f32_16x16x32_bf16 v[16:19], a[200:203], a[88:91], v[16:19]
  v_mfma_f32_16x16x32_bf16 v[8:11], a[148:151], a[36:39], v[8:11]
  v_mfma_f32_16x16x32_bf16 v[12:15], a[148:151], a[92:95], v[12:15]
  v_mfma_f32_16x16x32_bf16 v[16:19], a[204:207], a[92:95], v[16:19]
  v_mfma_f32_16x16x32_bf16 v[8:11], a[152:155], a[40:43], v[8:11]
  v_mfma_f32_16x16x32_bf16 v[12:15], a[152:155], a[96:99], v[12:15]
  v_mfma_f32_16x16x32_bf16 v[16:19], a[208:211], a[96:99], v[16:19]
  v_mfma_f32_16x16x32_bf16 v[8:11], a[156:159], a[44:47], v[8:11]
  v_mfma_f32_16x16x32_bf16 v[12:15], a[156:159], a[100:103], v[12:15]
  v_mfma_f32_16x16x32_bf16 v[16:19], a[212:215], a[100:103], v[16:19]
  v_mfma_f32_16x16x32_bf16 v[8:11], a[160:163], a[48:51], v[8:11]
  v_mfma_f32_16x16x32_bf16 v[12:15], a[160:163], a[104:107], v[12:15]
  v_mfma_f32_16x16x32_bf16 v[16:19], a[216:219], a[104:107], v[16:19]
  v_mfma_f32_16x16x32_bf16 v[8:11], a[164:167], a[52:55], v[8:11]
  v_mfma_f32_16x16x32_bf16 v[12:15], a[164:167], a[108:111], v[12:15]
  v_mfma_f32_16x16x32_bf16 v[16:19], a[220:223], a[108:111], v[16:19]
  s_mul_i32 s22, s20, 448
  v_mov_b32 v62, s22
  s_mov_b32 s30, 0
wp_pm:
  s_cmp_ge_u32 s17, 64
  s_cbranch_scc1 wp_pf
  s_cmp_ge_u32 s17, 61
  s_cbranch_scc1 mp_53a
  v_mov_b32 v61, 0
  s_mov_b64 exec, 1
  buffer_atomic_or v61, v62, s[8:11], s24 offen sc0
  s_mov_b64 exec, -1
  s_branch mp_53b
mp_53a:
  buffer_load_dword v61, v62, s[8:11], s24 offen sc1
mp_53b:
  s_waitcnt vmcnt(0)
  v_cmp_eq_u32 vcc, -1, v61
  s_cbranch_vccnz wp_pr
wp_pf:
  s_add_u32 s22, s24, 4096
  buffer_load_dwordx4 v[64:67], v2, s[8:11], s24 offen offset:0 sc1
  buffer_load_dwordx4 v[68:71], v2, s[8:11], s24 offen offset:1024 sc1
  buffer_load_dwordx4 v[72:75], v2, s[8:11], s24 offen offset:2048 sc1
  buffer_load_dwordx4 v[76:79], v2, s[8:11], s24 offen offset:3072 sc1
  buffer_load_dwordx4 v[80:83], v2, s[8:11], s22 offen offset:0 sc1
  buffer_load_dwordx4 v[84:87], v2, s[8:11], s22 offen offset:1024 sc1
  buffer_load_dwordx4 v[88:91], v2, s[8:11], s22 offen offset:2048 sc1
  s_waitcnt vmcnt(0)
  v_max_u32 v61, v64, v65
  v_max3_u32 v61, v61, v66, v67
  v_max3_u32 v61, v61, v68, v69
  v_max3_u32 v61, v61, v70, v71
  v_max3_u32 v61, v61, v72, v73
  v_max3_u32 v61, v61, v74, v75
  v_max3_u32 v61, v61, v76, v77
  v_max3_u32 v61, v61, v78, v79
  v_max3_u32 v61, v61, v80, v81
  v_max3_u32 v61, v61, v82, v83
  v_max3_u32 v61, v61, v84, v85
  v_max3_u32 v61, v61, v86, v87
  v_max3_u32 v61, v61, v88, v89
  v_max3_u32 v61, v61, v90, v91
  v_cmp_eq_u32 vcc, -1, v61
  s_cbranch_vccz wp_pk
wp_pr:
  s_sleep 1
  s_cmp_ge_u32 s17, 61
  s_cbranch_scc1 wp_pm_bo
  s_sleep 4
  s_cmp_ge_u32 s17, 56
  s_cbranch_scc1 wp_pm_bo
  s_sleep 40
wp_pm_bo:
  s_add_u32 s30, s30, 1
  s_cmp_lt_u32 s30, 30000
  s_cbranch_scc1 wp_pm
  s_branch wp_abort
wp_pk:
  s_cmp_lt_u32 s17, 56
  s_cbranch_scc1 pk_54
  buffer_load_dword v250, v251, s[12:15], 0 offen sc1
pk_54:
  v_mfma_f32_16x16x32_bf16 v[20:23], v[64:67], a[0:3], 0
  v_mfma_f32_16x16x32_bf16 v[24:27], v[64:67], a[4:7], 0
  v_mfma_f32_16x16x32_bf16 v[28:31], v[64:67], a[56:59], 0
  v_mfma_f32_16x16x32_bf16 v[32:35], v[64:67], a[60:63], 0
  v_mfma_f32_16x16x32_bf16 v[20:23], v[68:71], a[8:11], v[20:23]
  v_mfma_f32_16x16x32_bf16 v[24:27], v[68:71], a[12:15], v[24:27]
  v_mfma_f32_16x16x32_bf16 v[28:31], v[68:71], a[64:67], v[28:31]
  v_mfma_f32_16x16x32_bf16 v[32:35], v[68:71], a[68:71], v[32:35]
  v_mfma_f32_16x16x32_bf16 v[20:23], v[72:75], a[16:19], v[20:23]
  v_mfma_f32_16x16x32_bf16 v[24:27], v[72:75], a[20:23], v[24:27]
  v_mfma_f32_16x16x32_bf16 v[28:31], v[72:75], a[72:75], v[28:31]
  v_mfma_f32_16x16x32_bf16 v[32:35], v[72:75], a[76:79], v[32:35]
  v_mfma_f32_16x16x32_bf16 v[20:23], v[76:79], a[24:27], v[20:23]
  v_mfma_f32_16x16x32_bf16 v[24:27], v[76:79], a[28:31], v[24:27]
  v_mfma_f32_16x16x32_bf16 v[28:31], v[76:79], a[80:83], v[28:31]
  v_mfma_f32_16x16x32_bf16 v[32:35], v[76:79], a[84:87], v[32:35]
  v_mfma_f32_16x16x32_bf16 v[20:23], v[80:83], a[32:35], v[20:23]
  v_mfma_f32_16x16x32_bf16 v[24:27], v[80:83], a[36:39], v[24:27]
  v_mfma_f32_16x16x32_bf16 v[28:31], v[80:83], a[88:91], v[28:31]
  v_mfma_f32_16x16x32_bf16 v[32:35], v[80:83], a[92:95], v[32:35]
  v_mfma_f32_16x16x32_bf16 v[20:23], v[84:87], a[40:43], v[20:23]
  v_mfma_f32_16x16x32_bf16 v[24:27], v[84:87], a[44:47], v[24:27]
  v_mfma_f32_16x16x32_bf16 v[28:31], v[84:87], a[96:99], v[28:31]
  v_mfma_f32_16x16x32_bf16 v[32:35], v[84:87], a[100:103], v[32:35]
  v_mfma_f32_16x16x32_bf16 v[20:23], v[88:91], a[48:51], v[20:23]
  v_mfma_f32_16x16x32_bf16 v[24:27], v[88:91], a[52:55], v[24:27]
  v_mfma_f32_16x16x32_bf16 v[28:31], v[88:91], a[104:107], v[28:31]
  v_mfma_f32_16x16x32_bf16 v[32:35], v[88:91], a[108:111], v[32:35]
  s_lshl_b32 s25, s17, 1
  s_mul_i32 s25, s25, 20480
  s_add_u32 s25, s25, 85458944
  s_lshl_b32 s26, s20, 10
  s_add_u32 s26, s26, s25
  s_lshl_b32 s27, s18, 10
  s_add_u32 s27, s27, s25
  s_lshr_b32 s28, s16, 1
  s_lshl_b32 s28, s28, 3
  s_add_u32 s27, s27, s28
  s_add_u32 s27, s27, 16384
  s_and_b32 s28, s16, 1
  s_cmp_eq_u32 s28, 0
  s_cselect_b32 s50, -1, 0
  s_cselect_b32 s51, 0, -1
  v_cndmask_b32 v8, v6, v8, s[40:41]
  v_cndmask_b32 v9, v6, v9, s[42:43]
  v_cndmask_b32 v10, v6, v10, s[44:45]
  v_cndmask_b32 v11, v6, v11, s[46:47]
  v_cndmask_b32 v20, v24, v20, s[48:49]
  v_cndmask_b32 v21, v25, v21, s[48:49]
  v_cndmask_b32 v22, v26, v22, s[48:49]
  v_cndmask_b32 v23, v27, v23, s[48:49]
  v_mov_b32 v24, v20
  v_mov_b32 v25, v21
  v_mov_b32 v26, v22
  v_mov_b32 v27, v23
  v_permlane32_swap_b32 v20, v24
  v_permlane32_swap_b32 v21, v25
  v_permlane32_swap_b32 v22, v26
  v_permlane32_swap_b32 v23, v27
  v_add_f32 v20, v20, v24
  v_add_f32 v21, v21, v25
  v_add_f32 v22, v22, v26
  v_add_f32 v23, v23, v27
  v_max3_f32 v40, v8, v9, v10
  v_max3_f32 v40, v40, v11, v20
  v_max3_f32 v40, v40, v21, v22
  v_max_f32 v40, v40, v23
  v_mov_b32 v41, v40
  s_nop 1
  v_permlane16_swap_b32 v40, v41
  v_max_f32 v40, v40, v41
  v_mov_b32 v41, v40
  s_nop 1
  v_permlane32_swap_b32 v40, v41
  v_max_f32 v40, v40, v41
  v_sub_f32 v8, v8, v40
  v_sub_f32 v9, v9, v40
  v_sub_f32 v10, v10, v40
  v_sub_f32 v11, v11, v40
  v_sub_f32 v20, v20, v40
  v_sub_f32 v21, v21, v40
  v_sub_f32 v22, v22, v40
  v_sub_f32 v23, v23, v40
  v_exp_f32 v8, v8
  v_exp_f32 v9, v9
  v_exp_f32 v10, v10
  v_exp_f32 v11, v11
  v_exp_f32 v20, v20
  v_exp_f32 v21, v21
  v_exp_f32 v22, v22
  v_exp_f32 v23, v23
  v_add_f32 v42, v20, v21
  v_add_f32 v43, v22, v23
  v_add_f32 v42, v42, v43
  v_mul_f32 v42, 0.5, v42
  v_add_f32 v42, v42, v8
  v_add_f32 v42, v42, v9
  v_add_f32 v42, v42, v10
  v_add_f32 v42, v42, v11
  v_mov_b32 v41, v42
  s_nop 1
  v_permlane16_swap_b32 v42, v41
  v_add_f32 v42, v42, v41
  v_mov_b32 v41, v42
  s_nop 1
  v_permlane32_swap_b32 v42, v41
  v_add_f32 v42, v42, v41
  v_rcp_f32 v42, v42
  s_nop 0
  v_mul_f32 v8, v8, v42
  v_mul_f32 v9, v9, v42
  v_mul_f32 v10, v10, v42
  v_mul_f32 v11, v11, v42
  v_mul_f32 v20, v20, v42
  v_mul_f32 v21, v21, v42
  v_mul_f32 v22, v22, v42
  v_mul_f32 v23, v23, v42
  v_cvt_pk_bf16_f32 v44, v8, v9
  v_cvt_pk_bf16_f32 v45, v10, v11
  v_mov_b32 v46, 0
  v_mov_b32 v47, 0
  v_cvt_pk_bf16_f32 v48, v20, v21
  v_cvt_pk_bf16_f32 v49, v22, v23
  v_min_u32 v44, -2, v44
  v_min_u32 v45, -2, v45
  v_min_u32 v46, -2, v46
  v_min_u32 v47, -2, v47
  v_min_u32 v48, -2, v48
  v_min_u32 v49, -2, v49
  buffer_store_dwordx4 v[44:47], v2, s[8:11], s26 offen sc1
  s_mov_b64 exec, s[50:51]
  buffer_store_dwordx2 v[48:49], v2, s[8:11], s27 offen sc1
  s_mov_b64 exec, -1
  s_add_u32 s26, s26, 20480
  s_add_u32 s27, s27, 20480
  v_cndmask_b32 v16, v6, v16, s[40:41]
  v_cndmask_b32 v17, v6, v17, s[42:43]
  v_cndmask_b32 v18, v6, v18, s[44:45]
  v_cndmask_b32 v19, v6, v19, s[46:47]
  v_cndmask_b32 v28, v32, v28, s[48:49]
  v_cndmask_b32 v29, v33, v29, s[48:49]
  v_cndmask_b32 v30, v34, v30, s[48:49]
  v_cndmask_b32 v31, v35, v31, s[48:49]
  v_mov_b32 v32, v28
  v_mov_b32 v33, v29
  v_mov_b32 v34, v30
  v_mov_b32 v35, v31
  v_permlane32_swap_b32 v28, v32
  v_permlane32_swap_b32 v29, v33
  v_permlane32_swap_b32 v30, v34
  v_permlane32_swap_b32 v31, v35
  v_add_f32 v28, v28, v32
  v_add_f32 v29, v29, v33
  v_add_f32 v30, v30, v34
  v_add_f32 v31, v31, v35
  v_max3_f32 v40, v12, v13, v14
  v_max3_f32 v40, v40, v15, v16
  v_max3_f32 v40, v40, v17, v18
  v_max3_f32 v40, v40, v19, v28
  v_max3_f32 v40, v40, v29, v30
  v_max_f32 v40, v40, v31
  v_mov_b32 v41, v40
  s_nop 1
  v_permlane16_swap_b32 v40, v41
  v_max_f32 v40, v40, v41
  v_mov_b32 v41, v40
  s_nop 1
  v_permlane32_swap_b32 v40, v41
  v_max_f32 v40, v40, v41
  v_sub_f32 v12, v12, v40
  v_sub_f32 v13, v13, v40
  v_sub_f32 v14, v14, v40
  v_sub_f32 v15, v15, v40
  v_sub_f32 v16, v16, v40
  v_sub_f32 v17, v17, v40
  v_sub_f32 v18, v18, v40
  v_sub_f32 v19, v19, v40
  v_sub_f32 v28, v28, v40
  v_sub_f32 v29, v29, v40
  v_sub_f32 v30, v30, v40
  v_sub_f32 v31, v31, v40
  v_exp_f32 v12, v12
  v_exp_f32 v13, v13
  v_exp_f32 v14, v14
  v_exp_f32 v15, v15
  v_exp_f32 v16, v16
  v_exp_f32 v17, v17
  v_exp_f32 v18, v18
  v_exp_f32 v19, v19
  v_exp_f32 v28, v28
  v_exp_f32 v29, v29
  v_exp_f32 v30, v30
  v_exp_f32 v31, v31
  v_add_f32 v42, v28, v29
  v_add_f32 v43, v30, v31
  v_add_f32 v42, v42, v43
  v_mul_f32 v42, 0.5, v42
  v_add_f32 v42, v42, v12
  v_add_f32 v42, v42, v13
  v_add_f32 v42, v42, v14
  v_add_f32 v42, v42, v15
  v_add_f32 v42, v42, v16
  v_add_f32 v42, v42, v17
  v_add_f32 v42, v42, v18
  v_add_f32 v42, v42, v19
  v_mov_b32 v41, v42
  s_nop 1
  v_permlane16_swap_b32 v42, v41
  v_add_f32 v42, v42, v41
  v_mov_b32 v41, v42
  s_nop 1
  v_permlane32_swap_b32 v42, v41
  v_add_f32 v42, v42, v41
  v_rcp_f32 v42, v42
  s_nop 0
  v_mul_f32 v12, v12, v42
  v_mul_f32 v13, v13, v42
  v_mul_f32 v14, v14, v42
  v_mul_f32 v15, v15, v42
  v_mul_f32 v16, v16, v42
  v_mul_f32 v17, v17, v42
  v_mul_f32 v18, v18, v42
  v_mul_f32 v19, v19, v42
  v_mul_f32 v28, v28, v42
  v_mul_f32 v29, v29, v42
  v_mul_f32 v30, v30, v42
  v_mul_f32 v31, v31, v42
  v_cvt_pk_bf16_f32 v52, v12, v13
  v_cvt_pk_bf16_f32 v53, v14, v15
  v_cvt_pk_bf16_f32 v54, v16, v17
  v_cvt_pk_bf16_f32 v55, v18, v19
  v_cvt_pk_bf16_f32 v56, v28, v29
  v_cvt_pk_bf16_f32 v57, v30, v31
  v_min_u32 v52, -2, v52
  v_min_u32 v53, -2, v53
  v_min_u32 v54, -2, v54
  v_min_u32 v55, -2, v55
  v_min_u32 v56, -2, v56
  v_min_u32 v57, -2, v57
  buffer_store_dwordx4 v[52:55], v2, s[8:11], s26 offen sc1
  s_mov_b64 exec, s[50:51]
  buffer_store_dwordx2 v[56:57], v2, s[8:11], s27 offen sc1
  s_mov_b64 exec, -1
  s_lshl_b32 s25, s17, 7
  s_add_u32 s25, s25, 88573952
  v_mov_b32 v5, 1
  v_mov_b32 v6, 0
  s_waitcnt vmcnt(0)
  s_mov_b64 exec, 1
  buffer_atomic_add v5, v6, s[8:11], s25 offen
  s_mov_b64 exec, -1
  s_branch wk_loop
wk_toko:
  s_lshl_b32 s20, s18, 2
  s_add_u32 s20, s20, s16
  s_mul_i32 s24, s20, 65
  s_add_u32 s24, s24, s17
  s_lshl_b32 s24, s24, 13
  s_add_u32 s24, s24, 76947456
  s_lshl_b32 s21, s20, 6
  s_add_u32 s21, s21, s17
  s_mul_i32 s21, s21, 28672
  s_add_u32 s21, s21, 42205184
  s_lshl_b32 s25, s17, 1
  s_mul_i32 s25, s25, 20480
  s_add_u32 s25, s25, 85458944
  v_lshrrev_b32 v8, 5, v1
  v_and_b32 v9, 31, v1
  v_lshrrev_b32 v10, 4, v9
  v_min_u32 v5, 27, v9
  v_and_b32 v5, 15, v5
  v_lshlrev_b32 v6, 1, v10
  v_sub_u32 v6, 8, v6
  v_lshlrev_b32 v7, 10, v10
  v_lshl_add_u32 v7, v5, 4, v7
  v_lshlrev_b32 v6, 5, v6
  v_mad_u32_u24 v5, v8, v6, v7
  v_lshl_add_u32 v63, v6, 1, v5
  v_lshl_add_u32 v7, v8, 3, v7
  v_mul_u32_u24 v6, 20480, v10
  v_lshl_add_u32 v6, v8, 8, v6
  v_lshl_add_u32 v6, v4, 4, v6
  s_lshr_b32 s26, s17, 3
  s_lshl_b32 s26, s26, 4
  s_add_u32 s26, s26, s20
  s_lshl_b32 s26, s26, 7
  s_add_u32 s26, s26, 88541184
  v_mov_b32 v60, 0
  s_mov_b32 s30, 0
wo_wv:
  buffer_load_dword v61, v60, s[8:11], s26 offen sc1
  s_waitcnt vmcnt(0)
  v_cmp_ne_u32 vcc, 56, v61
  s_cbranch_vccz wo_wv_ok
  s_sleep 1
  s_cmp_ge_u32 s17, 61
  s_cbranch_scc1 wo_wv_bo
  s_sleep 4
  s_cmp_ge_u32 s17, 56
  s_cbranch_scc1 wo_wv_bo
  s_sleep 40
wo_wv_bo:
  s_add_u32 s30, s30, 1
  s_cmp_lt_u32 s30, 30000
  s_cbranch_scc1 wo_wv
  s_branch wo_abort
wo_wv_ok:
  s_add_u32 s22, s21, 0
  buffer_load_dwordx4 a[0:3], v5, s[8:11], s22 offen offset:0 sc1
  buffer_load_dwordx4 a[4:7], v63, s[8:11], s22 offen offset:0 sc1
  buffer_load_dwordx4 a[8:11], v5, s[8:11], s22 offen offset:1792 sc1
  buffer_load_dwordx4 a[12:15], v63, s[8:11], s22 offen offset:1792 sc1
  s_add_u32 s22, s21, 3584
  buffer_load_dwordx4 a[16:19], v5, s[8:11], s22 offen offset:0 sc1
  buffer_load_dwordx4 a[20:23], v63, s[8:11], s22 offen offset:0 sc1
  buffer_load_dwordx4 a[24:27], v5, s[8:11], s22 offen offset:1792 sc1
  buffer_load_dwordx4 a[28:31], v63, s[8:11], s22 offen offset:1792 sc1
  s_add_u32 s22, s21, 7168
  buffer_load_dwordx4 a[32:35], v5, s[8:11], s22 offen offset:0 sc1
  buffer_load_dwordx4 a[36:39], v63, s[8:11], s22 offen offset:0 sc1
  buffer_load_dwordx4 a[40:43], v5, s[8:11], s22 offen offset:1792 sc1
  buffer_load_dwordx4 a[44:47], v63, s[8:11], s22 offen offset:1792 sc1
  s_add_u32 s22, s21, 10752
  buffer_load_dwordx4 a[48:51], v5, s[8:11], s22 offen offset:0 sc1
  buffer_load_dwordx4 a[52:55], v63, s[8:11], s22 offen offset:0 sc1
  buffer_load_dwordx4 a[56:59], v5, s[8:11], s22 offen offset:1792 sc1
  buffer_load_dwordx4 a[60:63], v63, s[8:11], s22 offen offset:1792 sc1
  s_add_u32 s22, s21, 14336
  buffer_load_dwordx4 a[64:67], v5, s[8:11], s22 offen offset:0 sc1
  buffer_load_dwordx4 a[68:71], v63, s[8:11], s22 offen offset:0 sc1
  buffer_load_dwordx4 a[72:75], v5, s[8:11], s22 offen offset:1792 sc1
  buffer_load_dwordx4 a[76:79], v63, s[8:11], s22 offen offset:1792 sc1
  s_add_u32 s22, s21, 17920
  buffer_load_dwordx4 a[80:83], v5, s[8:11], s22 offen offset:0 sc1
  buffer_load_dwordx4 a[84:87], v63, s[8:11], s22 offen offset:0 sc1
  buffer_load_dwordx4 a[88:91], v5, s[8:11], s22 offen offset:1792 sc1
  buffer_load_dwordx4 a[92:95], v63, s[8:11], s22 offen offset:1792 sc1
  s_add_u32 s22, s21, 21504
  buffer_load_dwordx4 a[96:99], v5, s[8:11], s22 offen offset:0 sc1
  buffer_load_dwordx4 a[100:103], v63, s[8:11], s22 offen offset:0 sc1
  buffer_load_dwordx4 a[104:107], v5, s[8:11], s22 offen offset:1792 sc1
  buffer_load_dwordx4 a[108:111], v63, s[8:11], s22 offen offset:1792 sc1
  s_add_u32 s22, s21, 25088
  buffer_load_dwordx4 a[112:115], v5, s[8:11], s22 offen offset:0 sc1
  buffer_load_dwordx4 a[116:119], v63, s[8:11], s22 offen offset:0 sc1
  buffer_load_dwordx4 a[120:123], v5, s[8:11], s22 offen offset:1792 sc1
  buffer_load_dwordx4 a[124:127], v63, s[8:11], s22 offen offset:1792 sc1
  s_cmp_ge_u32 s17, 61
  s_cbranch_scc1 wo_lm
  s_lshl_b32 s26, s17, 7
  s_add_u32 s26, s26, 88573952
  v_mov_b32 v60, 0
  s_mov_b32 s30, 0
wo_wp:
  buffer_load_dword v61, v60, s[8:11], s26 offen sc1
  s_waitcnt vmcnt(0)
  v_cmp_ne_u32 vcc, 16, v61
  s_cbranch_vccz wo_wp_ok
  s_sleep 2
  s_cmp_ge_u32 s17, 61
  s_cbranch_scc1 wo_wp_bo
  s_sleep 4
  s_cmp_ge_u32 s17, 56
  s_cbranch_scc1 wo_wp_bo
  s_sleep 40
wo_wp_bo:
  s_add_u32 s30, s30, 1
  s_cmp_lt_u32 s30, 30000
  s_cbranch_scc1 wo_wp
  s_branch wo_abort
wo_wp_ok:
  s_branch wo_lp
wo_lm:
  s_mul_i32 s26, s17, 7168
  s_add_u32 s26, s26, 88080384
  v_mov_b32 v60, 0
  s_mov_b32 s30, 0
wo_wm:
  buffer_load_dword v61, v60, s[8:11], s26 offen sc1
  s_waitcnt vmcnt(0)
  v_cmp_eq_u32 vcc, -1, v61
  s_cbranch_vccz wo_wm_ok
  s_sleep 2
  s_cmp_ge_u32 s17, 61
  s_cbranch_scc1 wo_wm_bo
  s_sleep 4
  s_cmp_ge_u32 s17, 56
  s_cbranch_scc1 wo_wm_bo
  s_sleep 40
wo_wm_bo:
  s_add_u32 s30, s30, 1
  s_cmp_lt_u32 s30, 30000
  s_cbranch_scc1 wo_wm
  s_branch wo_abort
wo_wm_ok:
wo_lp:
  s_mul_i32 s26, s16, 10240
  s_add_u32 s27, s25, s26
  v_add_u32 v11, s26, v2
  s_lshl_b32 s26, s20, 6
  s_add_u32 s26, s26, s17
  s_lshl_b32 s26, s26, 4
  s_add_u32 s26, s26, 88582144
  v_lshlrev_b32 v60, 2, v3
  s_mov_b32 s30, 0
wo_pl:
  s_add_u32 s22, s27, 0
  buffer_load_dwordx4 v[128:131], v2, s[8:11], s22 offen offset:0 sc1
  buffer_load_dwordx4 v[132:135], v2, s[8:11], s22 offen offset:1024 sc1
  buffer_load_dwordx4 v[136:139], v2, s[8:11], s22 offen offset:2048 sc1
  buffer_load_dwordx4 v[140:143], v2, s[8:11], s22 offen offset:3072 sc1
  s_add_u32 s22, s27, 4096
  buffer_load_dwordx4 v[144:147], v2, s[8:11], s22 offen offset:0 sc1
  buffer_load_dwordx4 v[148:151], v2, s[8:11], s22 offen offset:1024 sc1
  buffer_load_dwordx4 v[152:155], v2, s[8:11], s22 offen offset:2048 sc1
  buffer_load_dwordx4 v[156:159], v2, s[8:11], s22 offen offset:3072 sc1
  s_add_u32 s22, s27, 8192
  buffer_load_dwordx4 v[160:163], v2, s[8:11], s22 offen offset:0 sc1
  buffer_load_dwordx4 v[164:167], v2, s[8:11], s22 offen offset:1024 sc1
  buffer_load_dword v61, v60, s[8:11], s26 offen sc1
  s_waitcnt vmcnt(1)
  v_max_u32 v62, v128, v129
  v_max3_u32 v62, v62, v130, v131
  v_max3_u32 v62, v62, v132, v133
  v_max3_u32 v62, v62, v134, v135
  v_max3_u32 v62, v62, v136, v137
  v_max3_u32 v62, v62, v138, v139
  v_max3_u32 v62, v62, v140, v141
  v_max3_u32 v62, v62, v142, v143
  v_max3_u32 v62, v62, v144, v145
  v_max3_u32 v62, v62, v146, v147
  v_max3_u32 v62, v62, v148, v149
  v_max3_u32 v62, v62, v150, v151
  v_max3_u32 v62, v62, v152, v153
  v_max3_u32 v62, v62, v154, v155
  v_max3_u32 v62, v62, v156, v157
  v_max3_u32 v62, v62, v158, v159
  v_max3_u32 v62, v62, v160, v161
  v_max3_u32 v62, v62, v162, v163
  v_max3_u32 v62, v62, v164, v165
  v_max3_u32 v62, v62, v166, v167
  v_cmp_eq_u32 vcc, -1, v62
  s_cbranch_vccz wo_pk
  s_add_u32 s30, s30, 1
  s_cmp_lt_u32 s30, 30000
  s_cbranch_scc1 wo_pl
  s_branch wo_abort
wo_pk:
  ds_write_b128 v11, v[128:131] offset:0
  ds_write_b128 v11, v[132:135] offset:1024
  ds_write_b128 v11, v[136:139] offset:2048
  ds_write_b128 v11, v[140:143] offset:3072
  ds_write_b128 v11, v[144:147] offset:4096
  ds_write_b128 v11, v[148:151] offset:5120
  ds_write_b128 v11, v[152:155] offset:6144
  ds_write_b128 v11, v[156:159] offset:7168
  ds_write_b128 v11, v[160:163] offset:8192
  ds_write_b128 v11, v[164:167] offset:9216
  s_waitcnt vmcnt(0)
  v_cmp_ne_u32 vcc, 1, v61
  s_mov_b32 s28, 0
  s_cbranch_vccnz wo_nt
  s_add_u32 s22, s24, 0
  buffer_load_dwordx2 v[28:29], v7, s[8:11], s22 offen offset:0 sc1
  buffer_load_dwordx2 v[30:31], v7, s[8:11], s22 offen offset:512 sc1
  buffer_load_dwordx2 v[32:33], v7, s[8:11], s22 offen offset:256 sc1
  buffer_load_dwordx2 v[34:35], v7, s[8:11], s22 offen offset:768 sc1
  buffer_load_dwordx2 v[36:37], v7, s[8:11], s22 offen offset:2048 sc1
  buffer_load_dwordx2 v[38:39], v7, s[8:11], s22 offen offset:2560 sc1
  buffer_load_dwordx2 v[40:41], v7, s[8:11], s22 offen offset:2304 sc1
  buffer_load_dwordx2 v[42:43], v7, s[8:11], s22 offen offset:2816 sc1
  s_add_u32 s22, s24, 4096
  buffer_load_dwordx2 v[44:45], v7, s[8:11], s22 offen offset:0 sc1
  buffer_load_dwordx2 v[46:47], v7, s[8:11], s22 offen offset:512 sc1
  buffer_load_dwordx2 v[48:49], v7, s[8:11], s22 offen offset:256 sc1
  buffer_load_dwordx2 v[50:51], v7, s[8:11], s22 offen offset:768 sc1
  buffer_load_dwordx2 v[52:53], v7, s[8:11], s22 offen offset:2048 sc1
  buffer_load_dwordx2 v[54:55], v7, s[8:11], s22 offen offset:2560 sc1
  buffer_load_dwordx2 v[56:57], v7, s[8:11], s22 offen offset:2304 sc1
  buffer_load_dwordx2 v[58:59], v7, s[8:11], s22 offen offset:2816 sc1
  s_mov_b32 s28, 1
wo_nt:
  s_cmp_lt_u32 s17, 56
  s_cbranch_scc1 pk_55
  buffer_load_dword v250, v251, s[12:15], 0 offen sc1
pk_55:
  s_waitcnt lgkmcnt(0)
  s_barrier
  buffer_load_dword v61, v60, s[8:11], s26 offen sc1
  ds_read_b128 v[64:67], v6 offset:0
  ds_read_b128 v[68:71], v6 offset:512
  ds_read_b128 v[72:75], v6 offset:1024
  ds_read_b128 v[76:79], v6 offset:1536
  ds_read_b128 v[80:83], v6 offset:2048
  ds_read_b128 v[84:87], v6 offset:2560
  ds_read_b128 v[88:91], v6 offset:3072
  s_waitcnt lgkmcnt(6)
  v_mfma_f32_32x32x16_bf16 v[12:27], a[0:3], v[64:67], 0
  ds_read_b128 v[92:95], v6 offset:3584
  s_waitcnt lgkmcnt(6)
  v_mfma_f32_32x32x16_bf16 v[12:27], a[4:7], v[68:71], v[12:27]
  ds_read_b128 v[64:67], v6 offset:4096
  s_waitcnt lgkmcnt(6)
  v_mfma_f32_32x32x16_bf16 v[12:27], a[8:11], v[72:75], v[12:27]
  ds_read_b128 v[68:71], v6 offset:4608
  s_waitcnt lgkmcnt(6)
  v_mfma_f32_32x32x16_bf16 v[12:27], a[12:15], v[76:79], v[12:27]
  ds_read_b128 v[72:75], v6 offset:5120
  s_waitcnt lgkmcnt(6)
  v_mfma_f32_32x32x16_bf16 v[12:27], a[16:19], v[80:83], v[12:27]
  ds_read_b128 v[76:79], v6 offset:5632
  s_waitcnt lgkmcnt(6)
  v_mfma_f32_32x32x16_bf16 v[12:27], a[20:23], v[84:87], v[12:27]
  ds_read_b128 v[80:83], v6 offset:6144
  s_waitcnt lgkmcnt(6)
  v_mfma_f32_32x32x16_bf16 v[12:27], a[24:27], v[88:91], v[12:27]
  ds_read_b128 v[84:87], v6 offset:6656
  s_waitcnt lgkmcnt(6)
  v_mfma_f32_32x32x16_bf16 v[12:27], a[28:31], v[92:95], v[12:27]
  ds_read_b128 v[88:91], v6 offset:7168
  s_waitcnt lgkmcnt(6)
  v_mfma_f32_32x32x16_bf16 v[12:27], a[32:35], v[64:67], v[12:27]
  ds_read_b128 v[92:95], v6 offset:7680
  s_waitcnt lgkmcnt(6)
  v_mfma_f32_32x32x16_bf16 v[12:27], a[36:39], v[68:71], v[12:27]
  ds_read_b128 v[64:67], v6 offset:8192
  s_waitcnt lgkmcnt(6)
  v_mfma_f32_32x32x16_bf16 v[12:27], a[40:43], v[72:75], v[12:27]
  ds_read_b128 v[68:71], v6 offset:8704
  s_waitcnt lgkmcnt(6)
  v_mfma_f32_32x32x16_bf16 v[12:27], a[44:47], v[76:79], v[12:27]
  ds_read_b128 v[72:75], v6 offset:9216
  s_waitcnt lgkmcnt(6)
  v_mfma_f32_32x32x16_bf16 v[12:27], a[48:51], v[80:83], v[12:27]
  ds_read_b128 v[76:79], v6 offset:9728
  s_waitcnt lgkmcnt(6)
  v_mfma_f32_32x32x16_bf16 v[12:27], a[52:55], v[84:87], v[12:27]
  ds_read_b128 v[80:83], v6 offset:10240
  s_waitcnt lgkmcnt(6)
  v_mfma_f32_32x32x16_bf16 v[12:27], a[56:59], v[88:91], v[12:27]
  ds_read_b128 v[84:87], v6 offset:10752
  s_waitcnt lgkmcnt(6)
  v_mfma_f32_32x32x16_bf16 v[12:27], a[60:63], v[92:95], v[12:27]
  ds_read_b128 v[88:91], v6 offset:11264
  s_waitcnt lgkmcnt(6)
  v_mfma_f32_32x32x16_bf16 v[12:27], a[64:67], v[64:67], v[12:27]
  ds_read_b128 v[92:95], v6 offset:11776
  s_waitcnt lgkmcnt(6)
  v_mfma_f32_32x32x16_bf16 v[12:27], a[68:71], v[68:71], v[12:27]
  ds_read_b128 v[64:67], v6 offset:12288
  s_waitcnt lgkmcnt(6)
  v_mfma_f32_32x32x16_bf16 v[12:27], a[72:75], v[72:75], v[12:27]
  ds_read_b128 v[68:71], v6 offset:12800
  s_waitcnt lgkmcnt(6)
  v_mfma_f32_32x32x16_bf16 v[12:27], a[76:79], v[76:79], v[12:27]
  s_cmp_lg_u32 s28, 0
  s_cbranch_scc1 wo_h2
  s_waitcnt vmcnt(0)
  v_cmp_ne_u32 vcc, 1, v61
  s_cbranch_vccnz wo_h2
  s_add_u32 s22, s24, 0
  buffer_load_dwordx2 v[28:29], v7, s[8:11], s22 offen offset:0 sc1
  buffer_load_dwordx2 v[30:31], v7, s[8:11], s22 offen offset:512 sc1
  buffer_load_dwordx2 v[32:33], v7, s[8:11], s22 offen offset:256 sc1
  buffer_load_dwordx2 v[34:35], v7, s[8:11], s22 offen offset:768 sc1
  buffer_load_dwordx2 v[36:37], v7, s[8:11], s22 offen offset:2048 sc1
  buffer_load_dwordx2 v[38:39], v7, s[8:11], s22 offen offset:2560 sc1
  buffer_load_dwordx2 v[40:41], v7, s[8:11], s22 offen offset:2304 sc1
  buffer_load_dwordx2 v[42:43], v7, s[8:11], s22 offen offset:2816 sc1
  s_add_u32 s22, s24, 4096
  buffer_load_dwordx2 v[44:45], v7, s[8:11], s22 offen offset:0 sc1
  buffer_load_dwordx2 v[46:47], v7, s[8:11], s22 offen offset:512 sc1
  buffer_load_dwordx2 v[48:49], v7, s[8:11], s22 offen offset:256 sc1
  buffer_load_dwordx2 v[50:51], v7, s[8:11], s22 offen offset:768 sc1
  buffer_load_dwordx2 v[52:53], v7, s[8:11], s22 offen offset:2048 sc1
  buffer_load_dwordx2 v[54:55], v7, s[8:11], s22 offen offset:2560 sc1
  buffer_load_dwordx2 v[56:57], v7, s[8:11], s22 offen offset:2304 sc1
  buffer_load_dwordx2 v[58:59], v7, s[8:11], s22 offen offset:2816 sc1
  s_mov_b32 s28, 1
wo_h2:
  ds_read_b128 v[72:75], v6 offset:13312
  s_waitcnt lgkmcnt(6)
  v_mfma_f32_32x32x16_bf16 v[12:27], a[80:83], v[80:83], v[12:27]
  ds_read_b128 v[76:79], v6 offset:13824
  s_waitcnt lgkmcnt(6)
  v_mfma_f32_32x32x16_bf16 v[12:27], a[84:87], v[84:87], v[12:27]
  ds_read_b128 v[80:83], v6 offset:14336
  s_waitcnt lgkmcnt(6)
  v_mfma_f32_32x32x16_bf16 v[12:27], a[88:91], v[88:91], v[12:27]
  ds_read_b128 v[84:87], v6 offset:14848
  s_waitcnt lgkmcnt(6)
  v_mfma_f32_32x32x16_bf16 v[12:27], a[92:95], v[92:95], v[12:27]
  ds_read_b128 v[88:91], v6 offset:15360
  s_waitcnt lgkmcnt(6)
  v_mfma_f32_32x32x16_bf16 v[12:27], a[96:99], v[64:67], v[12:27]
  ds_read_b128 v[92:95], v6 offset:15872
  s_waitcnt lgkmcnt(6)
  v_mfma_f32_32x32x16_bf16 v[12:27], a[100:103], v[68:71], v[12:27]
  ds_read_b128 v[64:67], v6 offset:16384
  s_waitcnt lgkmcnt(6)
  v_mfma_f32_32x32x16_bf16 v[12:27], a[104:107], v[72:75], v[12:27]
  ds_read_b128 v[68:71], v6 offset:16896
  s_waitcnt lgkmcnt(6)
  v_mfma_f32_32x32x16_bf16 v[12:27], a[108:111], v[76:79], v[12:27]
  ds_read_b128 v[72:75], v6 offset:17408
  s_waitcnt lgkmcnt(6)
  v_mfma_f32_32x32x16_bf16 v[12:27], a[112:115], v[80:83], v[12:27]
  ds_read_b128 v[76:79], v6 offset:17920
  s_waitcnt lgkmcnt(6)
  v_mfma_f32_32x32x16_bf16 v[12:27], a[116:119], v[84:87], v[12:27]
  ds_read_b128 v[80:83], v6 offset:18432
  s_waitcnt lgkmcnt(6)
  v_mfma_f32_32x32x16_bf16 v[12:27], a[120:123], v[88:91], v[12:27]
  ds_read_b128 v[84:87], v6 offset:18944
  s_waitcnt lgkmcnt(6)
  v_mfma_f32_32x32x16_bf16 v[12:27], a[124:127], v[92:95], v[12:27]
  s_cmp_lg_u32 s28, 0
  s_cbranch_scc1 wo_ht
  v_lshlrev_b32 v60, 2, v3
  s_mov_b32 s30, 0
wo_wt:
  buffer_load_dword v61, v60, s[8:11], s26 offen sc1
  s_waitcnt vmcnt(0)
  v_cmp_ne_u32 vcc, 1, v61
  s_cbranch_vccz wo_wt_ok
  s_sleep 1
  s_cmp_ge_u32 s17, 61
  s_cbranch_scc1 wo_wt_bo
  s_sleep 4
  s_cmp_ge_u32 s17, 56
  s_cbranch_scc1 wo_wt_bo
  s_sleep 40
wo_wt_bo:
  s_add_u32 s30, s30, 1
  s_cmp_lt_u32 s30, 30000
  s_cbranch_scc1 wo_wt
  s_branch wo_abort
wo_wt_ok:
  s_add_u32 s22, s24, 0
  buffer_load_dwordx2 v[28:29], v7, s[8:11], s22 offen offset:0 sc1
  buffer_load_dwordx2 v[30:31], v7, s[8:11], s22 offen offset:512 sc1
  buffer_load_dwordx2 v[32:33], v7, s[8:11], s22 offen offset:256 sc1
  buffer_load_dwordx2 v[34:35], v7, s[8:11], s22 offen offset:768 sc1
  buffer_load_dwordx2 v[36:37], v7, s[8:11], s22 offen offset:2048 sc1
  buffer_load_dwordx2 v[38:39], v7, s[8:11], s22 offen offset:2560 sc1
  buffer_load_dwordx2 v[40:41], v7, s[8:11], s22 offen offset:2304 sc1
  buffer_load_dwordx2 v[42:43], v7, s[8:11], s22 offen offset:2816 sc1
  s_add_u32 s22, s24, 4096
  buffer_load_dwordx2 v[44:45], v7, s[8:11], s22 offen offset:0 sc1
  buffer_load_dwordx2 v[46:47], v7, s[8:11], s22 offen offset:512 sc1
  buffer_load_dwordx2 v[48:49], v7, s[8:11], s22 offen offset:256 sc1
  buffer_load_dwordx2 v[50:51], v7, s[8:11], s22 offen offset:768 sc1
  buffer_load_dwordx2 v[52:53], v7, s[8:11], s22 offen offset:2048 sc1
  buffer_load_dwordx2 v[54:55], v7, s[8:11], s22 offen offset:2560 sc1
  buffer_load_dwordx2 v[56:57], v7, s[8:11], s22 offen offset:2304 sc1
  buffer_load_dwordx2 v[58:59], v7, s[8:11], s22 offen offset:2816 sc1
wo_ht:
  ds_read_b128 v[88:91], v6 offset:19456
  s_waitcnt lgkmcnt(6) vmcnt(0)
  v_mfma_f32_32x32x16_bf16 v[12:27], v[28:31], v[64:67], v[12:27]
  ds_read_b128 v[92:95], v6 offset:19968
  s_waitcnt lgkmcnt(6)
  v_mfma_f32_32x32x16_bf16 v[12:27], v[32:35], v[68:71], v[12:27]
  s_waitcnt lgkmcnt(5)
  v_mfma_f32_32x32x16_bf16 v[12:27], v[36:39], v[72:75], v[12:27]
  s_waitcnt lgkmcnt(4)
  v_mfma_f32_32x32x16_bf16 v[12:27], v[40:43], v[76:79], v[12:27]
  s_waitcnt lgkmcnt(3)
  v_mfma_f32_32x32x16_bf16 v[12:27], v[44:47], v[80:83], v[12:27]
  s_waitcnt lgkmcnt(2)
  v_mfma_f32_32x32x16_bf16 v[12:27], v[48:51], v[84:87], v[12:27]
  s_waitcnt lgkmcnt(1)
  v_mfma_f32_32x32x16_bf16 v[12:27], v[52:55], v[88:91], v[12:27]
  s_waitcnt lgkmcnt(0)
  v_mfma_f32_32x32x16_bf16 v[12:27], v[56:59], v[92:95], v[12:27]
  v_mul_u32_u24 v9, 240, v9
  s_movk_i32 s23, 240
  v_lshl_add_u32 v8, v8, 3, v9
  s_mul_i32 s22, s16, 24
  v_add_u32 v7, s22, v8
  s_lshl_b32 s22, s16, 5
  v_add_u32 v8, s22, v8
  v_min_u32 v11, 223, v0
  v_mul_u32_u24 v9, 4682, v11
  v_lshrrev_b32 v9, 16, v9
  v_mul_u32_u24 v10, 14, v9
  v_sub_u32 v10, v11, v10
  v_cmp_gt_u32 vcc, 8, v10
  v_lshlrev_b32 v10, 4, v10
  v_mad_u32_u24 v11, v9, s23, v10
  v_mul_u32_u24 v9, 1792, v9
  v_add_u32 v10, v9, v10
  s_lshl_b32 s22, s18, 7
  s_mul_i32 s27, s18, 96
  s_add_u32 s27, s27, 384
  v_mov_b32 v9, s22
  v_mov_b32 v5, s27
  v_cndmask_b32 v9, v5, v9, vcc
  v_add_u32 v10, v9, v10
  s_mul_i32 s26, s17, 57344
  s_add_u32 s26, s26, 896
  s_add_u32 s27, s26, 28672
  v_cvt_pk_bf16_f32 v96, v12, v13
  v_cvt_pk_bf16_f32 v97, v14, v15
  ds_write_b64 v8, v[96:97] offset:49152
  v_cvt_pk_bf16_f32 v98, v16, v17
  v_cvt_pk_bf16_f32 v99, v18, v19
  ds_write_b64 v8, v[98:99] offset:49168
  v_cvt_pk_bf16_f32 v100, v20, v21
  v_cvt_pk_bf16_f32 v101, v22, v23
  ds_write_b64 v7, v[100:101] offset:49280
  v_cvt_pk_bf16_f32 v102, v24, v25
  v_cvt_pk_bf16_f32 v103, v26, v27
  s_mov_b32 exec_hi, 0
  ds_write_b64 v7, v[102:103] offset:49296
  s_mov_b64 exec, -1
  s_waitcnt lgkmcnt(0)
  s_barrier
  ds_read_b128 v[104:107], v11 offset:49152
  ds_read_b128 v[108:111], v11 offset:52992
  s_cmp_lg_u32 s16, 3
  s_cselect_b32 exec_hi, -1, 0
  s_waitcnt lgkmcnt(1)
  buffer_store_dwordx4 v[104:107], v10, s[92:95], s26 offen
  s_waitcnt lgkmcnt(0)
  buffer_store_dwordx4 v[108:111], v10, s[92:95], s27 offen
  s_mov_b64 exec, -1
  v_readfirstlane_b32 s22, v250
  s_cmp_ge_u32 s22, 1440
  s_cbranch_scc1 ch_end
  s_branch wk_loop
wp_abort:
wo_abort:
  s_branch cA_abort
ch_end:
  s_endpgm

.section .rodata,"a"
.p2align 6
.amdhsa_kernel main_kernel
  .amdhsa_next_free_vgpr 512
  .amdhsa_next_free_sgpr 102
  .amdhsa_accum_offset 256
  .amdhsa_group_segment_fixed_size 0
  .amdhsa_kernarg_size 136
  .amdhsa_user_sgpr_count 2
  .amdhsa_user_sgpr_kernarg_segment_ptr 1
  .amdhsa_system_sgpr_workgroup_id_x 1
.end_amdhsa_kernel
```

```asm
; @launch kernel=main_kernel grid=(256,1,1) block=(256,1,1) lds=163840
.amdgcn_target "amdgcn-amd-amdhsa--gfx950"
.text
.globl main_kernel
.p2align 8
.type main_kernel,@function
main_kernel:
  s_cmp_ge_u32 s2, 256
  s_cbranch_scc1 ch_end
  s_load_dwordx4 s[4:7], s[0:1], 120
  s_load_dwordx2 s[92:93], s[0:1], 112
  s_load_dwordx8 s[36:43], s[0:1], 56
  s_load_dwordx4 s[44:47], s[0:1], 88
  s_memrealtime s[88:89]
  s_getpc_b64 s[98:99]
pf_main_kernel_1:
  s_sub_u32 s98, s98, pf_main_kernel_1-main_kernel
  s_subb_u32 s99, s99, 0
  s_lshr_b32 s20, s2, 3
  v_lshl_add_u32 v60, v0, 5, s20
  v_lshlrev_b32 v60, 7, v60
  v_min_u32 v60, ch_end-main_kernel-4, v60
  v_cmp_gt_u32 vcc, 32, v0
  s_and_saveexec_b64 s[22:23], vcc
  s_cbranch_execz pf_main_kernel_1_n
  global_load_dword v62, v60, s[98:99]
pf_main_kernel_1_n:
  s_mov_b64 exec, -1
  s_getreg_b32 s67, hwreg(HW_REG_XCC_ID)
  s_and_b32 s67, s67, 7
  v_lshrrev_b32 v1, 6, v0
  s_nop 0
  v_readfirstlane_b32 s16, v1
  s_mov_b32 s66, 0
  s_mov_b32 s68, 0
  s_mov_b32 s69, 0
  s_mov_b32 s96, 0
  s_mov_b32 s97, 0
  s_mov_b32 s101, 0x5eed0000
  s_sub_u32 s20, s67, 0
  s_lshr_b32 s21, s2, 3
  s_and_b32 s20, s20, 7
  s_lshl_b32 s3, s20, 5
  s_add_u32 s3, s3, s21
  s_waitcnt lgkmcnt(0)
  s_mov_b32 s8, s6
  s_and_b32 s9, s7, 0xffff
  s_mov_b32 s10, 0x10000000
  s_mov_b32 s11, 0x20000
  s_mov_b32 s12, s4
  s_and_b32 s13, s5, 0xffff
  s_mov_b32 s14, 256
  s_mov_b32 s15, 0x20000
  s_or_b32 s88, s88, 1
  s_and_b32 s93, s93, 0xffff
  s_mov_b32 s94, 3670016
  s_mov_b32 s95, 0x20000
m_start:
  s_cmp_ge_u32 s3, 32
  s_cbranch_scc1 m_bjob
  v_and_b32 v1, 63, v0
  v_lshlrev_b32 v2, 4, v1
  v_lshrrev_b32 v116, 4, v1
  v_and_b32 v117, 15, v1
  v_mov_b32 v3, 0x4444
  v_mov_b32 v118, 0xeeee
  v_cmp_lt_u32 vcc, 7, v117
  s_nop 1
  v_cndmask_b32 v3, v3, v118, vcc
  s_and_b32 s17, s3, 15
  s_cmp_ge_u32 s3, 16
  s_cbranch_scc1 m_val
  s_mov_b32 s60, s42
  s_and_b32 s61, s43, 0xffff
  s_mov_b32 s62, 3670016
  s_mov_b32 s63, 0x20000
  v_lshrrev_b32 v24, 5, v1
  v_and_b32 v25, 31, v1
  s_lshl_b32 s26, s17, 9
  s_lshl_b32 s25, s16, 12
  v_xor_b32 v26, v25, v24
  v_lshlrev_b32 v26, 4, v26
  v_lshl_add_u32 v26, v24, 13, v26
  v_xor_b32 v100, 0, v26
  v_xor_b32 v101, 0, v26
  v_add_u32 v101, 15360, v101
  v_xor_b32 v102, 32, v26
  v_add_u32 v102, 30720, v102
  v_xor_b32 v103, 32, v26
  v_add_u32 v103, 46080, v103
  s_lshl_b32 s23, s16, 19
  s_add_u32 s23, s23, s26
  s_add_u32 m0, s25, 16384
  s_nop 0
  buffer_load_dwordx4 v100, s[60:63], s23 offen offset:0 lds
  buffer_load_dwordx4 v101, s[60:63], s23 offen offset:1024 lds
  buffer_load_dwordx4 v102, s[60:63], s23 offen offset:2048 lds
  buffer_load_dwordx4 v103, s[60:63], s23 offen offset:3072 lds
  s_add_u32 m0, s25, 32768
  s_add_u32 s23, s23, 65536
  buffer_load_dwordx4 v100, s[60:63], s23 offen offset:0 lds
  buffer_load_dwordx4 v101, s[60:63], s23 offen offset:1024 lds
  buffer_load_dwordx4 v102, s[60:63], s23 offen offset:2048 lds
  buffer_load_dwordx4 v103, s[60:63], s23 offen offset:3072 lds
  v_xor_b32 v100, 64, v100
  v_xor_b32 v101, 64, v101
  v_xor_b32 v102, 64, v102
  v_xor_b32 v103, 64, v103
  s_add_u32 m0, s25, 49152
  s_add_u32 s23, s23, 65536
  buffer_load_dwordx4 v100, s[60:63], s23 offen offset:0 lds
  buffer_load_dwordx4 v101, s[60:63], s23 offen offset:1024 lds
  buffer_load_dwordx4 v102, s[60:63], s23 offen offset:2048 lds
  buffer_load_dwordx4 v103, s[60:63], s23 offen offset:3072 lds
  s_add_u32 m0, s25, 65536
  s_add_u32 s23, s23, 65536
  buffer_load_dwordx4 v100, s[60:63], s23 offen offset:0 lds
  buffer_load_dwordx4 v101, s[60:63], s23 offen offset:1024 lds
  buffer_load_dwordx4 v102, s[60:63], s23 offen offset:2048 lds
  buffer_load_dwordx4 v103, s[60:63], s23 offen offset:3072 lds
  v_xor_b32 v100, 192, v100
  v_xor_b32 v101, 192, v101
  v_xor_b32 v102, 192, v102
  v_xor_b32 v103, 192, v103
  s_add_u32 m0, s25, 81920
  s_add_u32 s23, s23, 65536
  buffer_load_dwordx4 v100, s[60:63], s23 offen offset:0 lds
  buffer_load_dwordx4 v101, s[60:63], s23 offen offset:1024 lds
  buffer_load_dwordx4 v102, s[60:63], s23 offen offset:2048 lds
  buffer_load_dwordx4 v103, s[60:63], s23 offen offset:3072 lds
  s_add_u32 m0, s25, 98304
  s_add_u32 s23, s23, 65536
  buffer_load_dwordx4 v100, s[60:63], s23 offen offset:0 lds
  buffer_load_dwordx4 v101, s[60:63], s23 offen offset:1024 lds
  buffer_load_dwordx4 v102, s[60:63], s23 offen offset:2048 lds
  buffer_load_dwordx4 v103, s[60:63], s23 offen offset:3072 lds
  v_xor_b32 v100, 64, v100
  v_xor_b32 v101, 64, v101
  v_xor_b32 v102, 64, v102
  v_xor_b32 v103, 64, v103
  s_add_u32 m0, s25, 114688
  s_add_u32 s23, s23, 65536
  buffer_load_dwordx4 v100, s[60:63], s23 offen offset:0 lds
  buffer_load_dwordx4 v101, s[60:63], s23 offen offset:1024 lds
  buffer_load_dwordx4 v102, s[60:63], s23 offen offset:2048 lds
  buffer_load_dwordx4 v103, s[60:63], s23 offen offset:3072 lds
  s_add_u32 m0, s25, 131072
  s_add_u32 s23, s23, 65536
  buffer_load_dwordx4 v100, s[60:63], s23 offen offset:0 lds
  buffer_load_dwordx4 v101, s[60:63], s23 offen offset:1024 lds
  buffer_load_dwordx4 v102, s[60:63], s23 offen offset:2048 lds
  buffer_load_dwordx4 v103, s[60:63], s23 offen offset:3072 lds
  s_mov_b32 s56, s40
  s_and_b32 s57, s41, 0xffff
  s_mov_b32 s58, 3670016
  s_mov_b32 s59, 0x20000
  s_lshl_b32 s21, s16, 16
  s_add_u32 s27, s26, s21
  s_lshr_b32 s20, s16, 1
  s_lshl_b32 s20, s20, 6
  v_xor_b32 v26, s20, v26
  v_xor_b32 v4, 0, v26
  v_xor_b32 v5, 32, v26
  v_add_u32 v5, 15360, v5
  v_xor_b32 v6, 128, v26
  v_add_u32 v6, 30720, v6
  v_xor_b32 v7, 160, v26
  v_add_u32 v7, 46080, v7
  s_add_u32 s22, s27, 0
  s_add_u32 m0, s25, 0
  s_nop 0
  buffer_load_dwordx4 v4, s[56:59], s22 offen offset:0 lds
  buffer_load_dwordx4 v5, s[56:59], s22 offen offset:1024 lds
  buffer_load_dwordx4 v6, s[56:59], s22 offen offset:2048 lds
  buffer_load_dwordx4 v7, s[56:59], s22 offen offset:3072 lds
  s_cmp_lg_u32 s66, 0
  s_cbranch_scc1 sc_ci
  s_cmp_lg_u32 s16, 0
  s_cbranch_scc1 w0_2
  s_lshr_b32 s70, s3, 5
  s_and_b32 s71, s70, 4
  s_mul_i32 s71, s71, 12
  s_lshl_b32 s70, s70, 2
  s_add_u32 s70, s70, s71
  s_lshl_b32 s71, 1, s3
  v_mov_b32 v248, s71
  v_mov_b32 v249, 32
  s_mov_b64 exec, 1
  buffer_atomic_or v248, v249, s[12:15], s70 offen sc0
  buffer_load_dwordx2 v[250:251], v249, s[12:15], 0 offen offset:96 sc1
  s_mov_b64 exec, -1
w0_2:
sc_ci:
  v_and_b32 v26, 15, v25
  v_xor_b32 v27, v26, v24
  v_lshlrev_b32 v27, 4, v27
  v_bfe_u32 v28, v25, 2, 1
  v_lshlrev_b32 v28, 4, v28
  v_lshrrev_b32 v29, 3, v25
  v_lshl_add_u32 v28, v29, 2, v28
  v_and_b32 v29, 3, v25
  v_add_u32 v28, v28, v29
  v_lshl_add_u32 v28, v28, 9, v27
  v_lshrrev_b32 v29, 2, v26
  v_lshlrev_b32 v29, 15, v29
  v_bfe_u32 v30, v26, 1, 1
  v_lshl_add_u32 v29, v30, 11, v29
  v_lshrrev_b32 v30, 4, v25
  v_lshl_add_u32 v29, v30, 10, v29
  v_and_b32 v31, 1, v26
  v_lshl_add_u32 v29, v31, 9, v29
  v_add_u32 v29, v29, v27
  v_add_u32 v29, s25, v29
  v_xor_b32 v8, 0, v28
  v_xor_b32 v104, 0, v29
  v_xor_b32 v9, 32, v28
  v_xor_b32 v105, 32, v29
  v_xor_b32 v10, 64, v28
  v_xor_b32 v106, 64, v29
  v_xor_b32 v11, 96, v28
  v_xor_b32 v107, 96, v29
  v_xor_b32 v12, 128, v28
  v_xor_b32 v108, 128, v29
  v_xor_b32 v13, 160, v28
  v_xor_b32 v109, 160, v29
  v_xor_b32 v14, 192, v28
  v_xor_b32 v110, 192, v29
  v_xor_b32 v15, 224, v28
  v_xor_b32 v111, 224, v29
  s_mov_b32 s52, 1035512379
  s_waitcnt vmcnt(4)
  ds_read_b128 v[120:123], v104 offset:16384
  ds_read_b128 v[124:127], v105 offset:16384
  ds_read_b128 v[128:131], v106 offset:16384
  ds_read_b128 v[132:135], v107 offset:16384
  ds_read_b128 v[136:139], v108 offset:16384
  ds_read_b128 v[140:143], v109 offset:16384
  ds_read_b128 v[144:147], v110 offset:16384
  ds_read_b128 v[148:151], v111 offset:16384
  s_waitcnt lgkmcnt(4)
  ds_read_b128 v[152:155], v104 offset:16640
  ds_read_b128 v[156:159], v105 offset:16640
  ds_read_b128 v[160:163], v106 offset:16640
  ds_read_b128 v[164:167], v107 offset:16640
  ds_read_b128 v[168:171], v108 offset:16640
  ds_read_b128 v[172:175], v109 offset:16640
  ds_read_b128 v[176:179], v110 offset:16640
  ds_read_b128 v[180:183], v111 offset:16640
  s_waitcnt lgkmcnt(4)
  ds_read_b128 v[184:187], v104 offset:32768
  ds_read_b128 v[188:191], v105 offset:32768
  ds_read_b128 v[192:195], v106 offset:32768
  ds_read_b128 v[196:199], v107 offset:32768
  ds_read_b128 v[200:203], v108 offset:32768
  ds_read_b128 v[204:207], v109 offset:32768
  ds_read_b128 v[208:211], v110 offset:32768
  ds_read_b128 v[212:215], v111 offset:32768
  s_waitcnt lgkmcnt(4)
  ds_read_b128 v[216:219], v104 offset:33024
  ds_read_b128 v[220:223], v105 offset:33024
  ds_read_b128 v[224:227], v106 offset:33024
  ds_read_b128 v[228:231], v107 offset:33024
  ds_read_b128 v[232:235], v108 offset:33024
  ds_read_b128 v[236:239], v109 offset:33024
  ds_read_b128 v[240:243], v110 offset:33024
  ds_read_b128 v[244:247], v111 offset:33024
  s_waitcnt lgkmcnt(4)
  s_waitcnt lgkmcnt(0)
  s_add_u32 s22, s27, 262144
  s_add_u32 m0, s25, 16384
  s_nop 0
  buffer_load_dwordx4 v4, s[56:59], s22 offen offset:0 lds
  buffer_load_dwordx4 v5, s[56:59], s22 offen offset:1024 lds
  buffer_load_dwordx4 v6, s[56:59], s22 offen offset:2048 lds
  buffer_load_dwordx4 v7, s[56:59], s22 offen offset:3072 lds
  s_add_u32 s22, s27, 524288
  s_add_u32 m0, s25, 32768
  s_nop 0
  buffer_load_dwordx4 v4, s[56:59], s22 offen offset:0 lds
  buffer_load_dwordx4 v5, s[56:59], s22 offen offset:1024 lds
  buffer_load_dwordx4 v6, s[56:59], s22 offen offset:2048 lds
  buffer_load_dwordx4 v7, s[56:59], s22 offen offset:3072 lds
  s_add_u32 s22, s27, 786432
  s_add_u32 m0, s25, 49152
  s_nop 0
  buffer_load_dwordx4 v4, s[56:59], s22 offen offset:0 lds
  buffer_load_dwordx4 v5, s[56:59], s22 offen offset:1024 lds
  buffer_load_dwordx4 v6, s[56:59], s22 offen offset:2048 lds
  buffer_load_dwordx4 v7, s[56:59], s22 offen offset:3072 lds
  s_cmp_lg_u32 s66, 0
  s_cbranch_scc1 sc_cf
  s_cmp_lg_u32 s16, 0
  s_cbranch_scc1 w0_3
  s_waitcnt vmcnt(12)
  v_readfirstlane_b32 s70, v250
  s_cmp_lg_u32 s70, 0
  s_cbranch_scc1 sc_nz
  v_mov_b32 v249, 128
  v_mov_b32 v250, s88
  v_mov_b32 v251, s89
  v_mov_b32 v252, 0
  v_mov_b32 v253, 0
  s_mov_b64 exec, 1
  buffer_atomic_cmpswap_x2 v[250:253], v249, s[12:15], 0 offen sc0
  s_mov_b64 exec, -1
  s_waitcnt vmcnt(0)
  v_readfirstlane_b32 s70, v250
  s_cmp_lg_u32 s70, 0
  s_cbranch_scc1 sc_nz
  v_mov_b32 v250, s88
  v_mov_b32 v251, s89
sc_nz:
w0_3:
  v_mov_b32 v249, 160000
  s_add_u32 s101, s101, 1
  s_barrier
  s_mov_b64 exec, 1
  s_cmp_lg_u32 s16, 0
  s_cbranch_scc1 w0_4
  ds_write_b32 v249, v248 offset:0
  ds_write_b32 v249, v250 offset:4
  ds_write_b32 v249, v251 offset:8
  s_waitcnt lgkmcnt(0)
  v_mov_b32 v248, s101
  ds_write_b32 v249, v248 offset:16
  s_waitcnt lgkmcnt(0)
w0_4:
  s_mov_b64 exec, -1
  s_barrier
  ds_read_b32 v248, v249 offset:0
  ds_read_b32 v250, v249 offset:4
  ds_read_b32 v251, v249 offset:8
  ds_read_b32 v249, v249 offset:16
  s_waitcnt lgkmcnt(0)
  v_readfirstlane_b32 s70, v248
  v_readfirstlane_b32 s88, v250
  v_readfirstlane_b32 s89, v251
  v_cmp_ne_u32 vcc, s101, v249
  s_cbranch_vccnz ch_end
  s_mov_b32 s66, 1
  s_bitcmp1_b32 s70, s3
  s_cbranch_scc1 m_reclaim
sc_cf:
  s_cmp_lg_u32 s16, 0
  s_cbranch_scc1 w0_5
  s_cmp_eq_u32 s67, 0
  s_cselect_b32 s20, 1, 0x10001
  v_mov_b32 v248, s20
  v_mov_b32 v249, 0
  s_mov_b64 exec, 1
  buffer_atomic_add v248, v249, s[12:15], 0 offen
  s_mov_b64 exec, -1
w0_5:
  s_lshl_b32 s28, s17, 7
  s_add_u32 s28, s28, 88635392
  v_min_u32 v113, 96, v2
  s_mov_b32 s29, 88602624
  v_add_u32 v112, 1024, v2
  v_min_u32 v112, 1776, v112
  s_mul_i32 s32, s17, 401408
  s_mul_i32 s33, s16, 14336
  s_add_u32 s32, s32, s33
  s_add_u32 s33, s32, s33
  s_add_u32 s32, s32, 344064
  s_add_u32 s33, s33, 229376
  s_waitcnt vmcnt(8)
  s_barrier
  ds_read_b128 v[16:19], v8 offset:0
  ds_read_b128 v[20:23], v9 offset:0
  ds_read_b128 v[24:27], v10 offset:0
  ds_read_b128 v[28:31], v11 offset:0
  s_waitcnt lgkmcnt(3)
  v_mfma_f32_32x32x16_bf16 v[32:47], v[16:19], v[120:123], 0
  s_add_u32 s22, s27, 1048576
  s_add_u32 m0, s25, 65536
  s_nop 0
  buffer_load_dwordx4 v4, s[56:59], s22 offen offset:0 lds
  v_mfma_f32_32x32x16_bf16 v[48:63], v[16:19], v[184:187], 0
  ds_read_b128 v[16:19], v12 offset:0
  s_waitcnt lgkmcnt(3)
  v_mfma_f32_32x32x16_bf16 v[32:47], v[20:23], v[124:127], v[32:47]
  buffer_load_dwordx4 v5, s[56:59], s22 offen offset:1024 lds
  v_mfma_f32_32x32x16_bf16 v[48:63], v[20:23], v[188:191], v[48:63]
  ds_read_b128 v[20:23], v13 offset:0
  s_waitcnt lgkmcnt(3)
  v_mfma_f32_32x32x16_bf16 v[32:47], v[24:27], v[128:131], v[32:47]
  buffer_load_dwordx4 v6, s[56:59], s22 offen offset:2048 lds
  v_mfma_f32_32x32x16_bf16 v[48:63], v[24:27], v[192:195], v[48:63]
  ds_read_b128 v[24:27], v14 offset:0
  s_waitcnt lgkmcnt(3)
  v_mfma_f32_32x32x16_bf16 v[32:47], v[28:31], v[132:135], v[32:47]
  buffer_load_dwordx4 v7, s[56:59], s22 offen offset:3072 lds
  v_mfma_f32_32x32x16_bf16 v[48:63], v[28:31], v[196:199], v[48:63]
  ds_read_b128 v[28:31], v15 offset:0
  s_waitcnt lgkmcnt(3)
  v_mfma_f32_32x32x16_bf16 v[32:47], v[16:19], v[136:139], v[32:47]
  s_add_u32 s22, s27, 1310720
  s_add_u32 m0, s25, 81920
  s_nop 0
  buffer_load_dwordx4 v4, s[56:59], s22 offen offset:0 lds
  v_mfma_f32_32x32x16_bf16 v[48:63], v[16:19], v[200:203], v[48:63]
  ds_read_b128 v[16:19], v8 offset:256
  s_waitcnt lgkmcnt(3)
  v_mfma_f32_32x32x16_bf16 v[32:47], v[20:23], v[140:143], v[32:47]
  buffer_load_dwordx4 v5, s[56:59], s22 offen offset:1024 lds
  v_mfma_f32_32x32x16_bf16 v[48:63], v[20:23], v[204:207], v[48:63]
  ds_read_b128 v[20:23], v9 offset:256
  s_waitcnt lgkmcnt(3)
  v_mfma_f32_32x32x16_bf16 v[32:47], v[24:27], v[144:147], v[32:47]
  buffer_load_dwordx4 v6, s[56:59], s22 offen offset:2048 lds
  v_mfma_f32_32x32x16_bf16 v[48:63], v[24:27], v[208:211], v[48:63]
  ds_read_b128 v[24:27], v10 offset:256
  s_waitcnt lgkmcnt(3)
  v_mfma_f32_32x32x16_bf16 v[32:47], v[28:31], v[148:151], v[32:47]
  buffer_load_dwordx4 v7, s[56:59], s22 offen offset:3072 lds
  v_mfma_f32_32x32x16_bf16 v[48:63], v[28:31], v[212:215], v[48:63]
  ds_read_b128 v[28:31], v11 offset:256
  s_waitcnt lgkmcnt(3)
  v_mfma_f32_32x32x16_bf16 v[32:47], v[16:19], v[152:155], v[32:47]
  s_add_u32 s22, s27, 1572864
  s_add_u32 m0, s25, 98304
  s_nop 0
  buffer_load_dwordx4 v4, s[56:59], s22 offen offset:0 lds
  v_mfma_f32_32x32x16_bf16 v[48:63], v[16:19], v[216:219], v[48:63]
  ds_read_b128 v[16:19], v12 offset:256
  s_waitcnt lgkmcnt(3)
  v_mfma_f32_32x32x16_bf16 v[32:47], v[20:23], v[156:159], v[32:47]
  buffer_load_dwordx4 v5, s[56:59], s22 offen offset:1024 lds
  v_mfma_f32_32x32x16_bf16 v[48:63], v[20:23], v[220:223], v[48:63]
  ds_read_b128 v[20:23], v13 offset:256
  s_waitcnt lgkmcnt(3)
  v_mfma_f32_32x32x16_bf16 v[32:47], v[24:27], v[160:163], v[32:47]
  buffer_load_dwordx4 v6, s[56:59], s22 offen offset:2048 lds
  v_mfma_f32_32x32x16_bf16 v[48:63], v[24:27], v[224:227], v[48:63]
  ds_read_b128 v[24:27], v14 offset:256
  s_waitcnt lgkmcnt(3)
  v_mfma_f32_32x32x16_bf16 v[32:47], v[28:31], v[164:167], v[32:47]
  buffer_load_dwordx4 v7, s[56:59], s22 offen offset:3072 lds
  v_mfma_f32_32x32x16_bf16 v[48:63], v[28:31], v[228:231], v[48:63]
  ds_read_b128 v[28:31], v15 offset:256
  s_waitcnt lgkmcnt(3)
  v_mfma_f32_32x32x16_bf16 v[32:47], v[16:19], v[168:171], v[32:47]
  s_add_u32 s22, s27, 1835008
  s_add_u32 m0, s25, 114688
  s_nop 0
  buffer_load_dwordx4 v4, s[56:59], s22 offen offset:0 lds
  v_mfma_f32_32x32x16_bf16 v[48:63], v[16:19], v[232:235], v[48:63]
  ds_read_b128 v[16:19], v8 offset:16384
  s_waitcnt lgkmcnt(3)
  v_mfma_f32_32x32x16_bf16 v[32:47], v[20:23], v[172:175], v[32:47]
  buffer_load_dwordx4 v5, s[56:59], s22 offen offset:1024 lds
  v_mfma_f32_32x32x16_bf16 v[48:63], v[20:23], v[236:239], v[48:63]
  ds_read_b128 v[20:23], v9 offset:16384
  s_waitcnt lgkmcnt(3)
  v_mfma_f32_32x32x16_bf16 v[32:47], v[24:27], v[176:179], v[32:47]
  buffer_load_dwordx4 v6, s[56:59], s22 offen offset:2048 lds
  v_mfma_f32_32x32x16_bf16 v[48:63], v[24:27], v[240:243], v[48:63]
  ds_read_b128 v[24:27], v10 offset:16384
  s_waitcnt lgkmcnt(3)
  v_mfma_f32_32x32x16_bf16 v[32:47], v[28:31], v[180:183], v[32:47]
  buffer_load_dwordx4 v7, s[56:59], s22 offen offset:3072 lds
  v_mfma_f32_32x32x16_bf16 v[48:63], v[28:31], v[244:247], v[48:63]
  s_waitcnt vmcnt(16)
  s_barrier
  ds_read_b128 v[28:31], v11 offset:16384
  s_waitcnt lgkmcnt(3)
  v_mfma_f32_32x32x16_bf16 v[64:79], v[16:19], v[120:123], 0
  s_add_u32 s22, s27, 2097152
  s_add_u32 m0, s25, 131072
  s_nop 0
  buffer_load_dwordx4 v4, s[56:59], s22 offen offset:0 lds
  v_mfma_f32_32x32x16_bf16 v[80:95], v[16:19], v[184:187], 0
  ds_read_b128 v[16:19], v12 offset:16384
  s_waitcnt lgkmcnt(3)
  v_mfma_f32_32x32x16_bf16 v[64:79], v[20:23], v[124:127], v[64:79]
  buffer_load_dwordx4 v5, s[56:59], s22 offen offset:1024 lds
  v_mul_f32 v32, s52, v32
  v_mul_f32 v33, s52, v33
  v_cvt_pk_bf16_f32 v32, v32, v33
  v_mfma_f32_32x32x16_bf16 v[80:95], v[20:23], v[188:191], v[80:95]
  v_mul_f32 v34, s52, v34
  v_mul_f32 v35, s52, v35
  ds_read_b128 v[20:23], v13 offset:16384
  s_waitcnt lgkmcnt(3)
  v_mfma_f32_32x32x16_bf16 v[64:79], v[24:27], v[128:131], v[64:79]
  buffer_load_dwordx4 v6, s[56:59], s22 offen offset:2048 lds
  v_cvt_pk_bf16_f32 v33, v34, v35
  v_mul_f32 v36, s52, v36
  v_mul_f32 v37, s52, v37
  v_mfma_f32_32x32x16_bf16 v[80:95], v[24:27], v[192:195], v[80:95]
  v_cvt_pk_bf16_f32 v34, v36, v37
  v_mul_f32 v38, s52, v38
  ds_read_b128 v[24:27], v14 offset:16384
  s_waitcnt lgkmcnt(3)
  v_mfma_f32_32x32x16_bf16 v[64:79], v[28:31], v[132:135], v[64:79]
  buffer_load_dwordx4 v7, s[56:59], s22 offen offset:3072 lds
  v_mul_f32 v39, s52, v39
  v_cvt_pk_bf16_f32 v35, v38, v39
  v_mul_f32 v40, s52, v40
  v_mfma_f32_32x32x16_bf16 v[80:95], v[28:31], v[196:199], v[80:95]
  v_mul_f32 v41, s52, v41
  v_cvt_pk_bf16_f32 v40, v40, v41
  ds_read_b128 v[28:31], v15 offset:16384
  s_waitcnt lgkmcnt(3)
  v_mfma_f32_32x32x16_bf16 v[64:79], v[16:19], v[136:139], v[64:79]
  s_add_u32 s22, s27, 2359296
  s_add_u32 m0, s25, 0
  s_nop 0
  buffer_load_dwordx4 v4, s[56:59], s22 offen offset:0 lds
  v_mul_f32 v42, s52, v42
  v_mul_f32 v43, s52, v43
  v_cvt_pk_bf16_f32 v41, v42, v43
  v_mfma_f32_32x32x16_bf16 v[80:95], v[16:19], v[200:203], v[80:95]
  v_mul_f32 v44, s52, v44
  v_mul_f32 v45, s52, v45
  ds_read_b128 v[16:19], v8 offset:16640
  s_waitcnt lgkmcnt(3)
  v_mfma_f32_32x32x16_bf16 v[64:79], v[20:23], v[140:143], v[64:79]
  buffer_load_dwordx4 v5, s[56:59], s22 offen offset:1024 lds
  v_cvt_pk_bf16_f32 v42, v44, v45
  v_mul_f32 v46, s52, v46
  v_mul_f32 v47, s52, v47
  v_mfma_f32_32x32x16_bf16 v[80:95], v[20:23], v[204:207], v[80:95]
  v_cvt_pk_bf16_f32 v43, v46, v47
  v_permlane16_swap_b32 v32, v40
  ds_read_b128 v[20:23], v9 offset:16640
  s_waitcnt lgkmcnt(3)
  v_mfma_f32_32x32x16_bf16 v[64:79], v[24:27], v[144:147], v[64:79]
  buffer_load_dwordx4 v6, s[56:59], s22 offen offset:2048 lds
  v_permlane16_swap_b32 v33, v41
  v_permlane16_swap_b32 v34, v42
  v_permlane16_swap_b32 v35, v43
  v_mfma_f32_32x32x16_bf16 v[80:95], v[24:27], v[208:211], v[80:95]
  v_accvgpr_write_b32 a0, v32
  v_accvgpr_write_b32 a1, v33
  ds_read_b128 v[24:27], v10 offset:16640
  s_waitcnt lgkmcnt(3)
  v_mfma_f32_32x32x16_bf16 v[64:79], v[28:31], v[148:151], v[64:79]
  buffer_load_dwordx4 v7, s[56:59], s22 offen offset:3072 lds
  v_accvgpr_write_b32 a2, v34
  v_accvgpr_write_b32 a3, v35
  v_accvgpr_write_b32 a56, v40
  v_mfma_f32_32x32x16_bf16 v[80:95], v[28:31], v[212:215], v[80:95]
  v_accvgpr_write_b32 a57, v41
  v_accvgpr_write_b32 a58, v42
  ds_read_b128 v[28:31], v11 offset:16640
  s_waitcnt lgkmcnt(3)
  v_mfma_f32_32x32x16_bf16 v[64:79], v[16:19], v[152:155], v[64:79]
  v_accvgpr_write_b32 a59, v43
  v_mul_f32 v48, s52, v48
  v_mul_f32 v49, s52, v49
  v_mfma_f32_32x32x16_bf16 v[80:95], v[16:19], v[216:219], v[80:95]
  v_cvt_pk_bf16_f32 v48, v48, v49
  v_mul_f32 v50, s52, v50
  ds_read_b128 v[16:19], v12 offset:16640
  s_waitcnt lgkmcnt(3)
  v_mfma_f32_32x32x16_bf16 v[64:79], v[20:23], v[156:159], v[64:79]
  v_mul_f32 v51, s52, v51
  v_cvt_pk_bf16_f32 v49, v50, v51
  v_mul_f32 v52, s52, v52
  v_mfma_f32_32x32x16_bf16 v[80:95], v[20:23], v[220:223], v[80:95]
  v_mul_f32 v53, s52, v53
  v_cvt_pk_bf16_f32 v50, v52, v53
  ds_read_b128 v[20:23], v13 offset:16640
  s_waitcnt lgkmcnt(3)
  v_mfma_f32_32x32x16_bf16 v[64:79], v[24:27], v[160:163], v[64:79]
  v_mul_f32 v54, s52, v54
  v_mul_f32 v55, s52, v55
  v_cvt_pk_bf16_f32 v51, v54, v55
  v_mfma_f32_32x32x16_bf16 v[80:95], v[24:27], v[224:227], v[80:95]
  v_mul_f32 v56, s52, v56
  v_mul_f32 v57, s52, v57
  ds_read_b128 v[24:27], v14 offset:16640
  s_waitcnt lgkmcnt(3)
  v_mfma_f32_32x32x16_bf16 v[64:79], v[28:31], v[164:167], v[64:79]
  v_cvt_pk_bf16_f32 v56, v56, v57
  v_mul_f32 v58, s52, v58
  v_mul_f32 v59, s52, v59
  v_mfma_f32_32x32x16_bf16 v[80:95], v[28:31], v[228:231], v[80:95]
  v_cvt_pk_bf16_f32 v57, v58, v59
  v_mul_f32 v60, s52, v60
  ds_read_b128 v[28:31], v15 offset:16640
  s_waitcnt lgkmcnt(3)
  v_mfma_f32_32x32x16_bf16 v[64:79], v[16:19], v[168:171], v[64:79]
  v_mul_f32 v61, s52, v61
  v_cvt_pk_bf16_f32 v58, v60, v61
  v_mul_f32 v62, s52, v62
  v_mfma_f32_32x32x16_bf16 v[80:95], v[16:19], v[232:235], v[80:95]
  v_mul_f32 v63, s52, v63
  v_cvt_pk_bf16_f32 v59, v62, v63
  ds_read_b128 v[16:19], v8 offset:32768
  s_waitcnt lgkmcnt(3)
  v_mfma_f32_32x32x16_bf16 v[64:79], v[20:23], v[172:175], v[64:79]
  v_permlane16_swap_b32 v48, v56
  v_permlane16_swap_b32 v49, v57
  v_permlane16_swap_b32 v50, v58
  v_mfma_f32_32x32x16_bf16 v[80:95], v[20:23], v[236:239], v[80:95]
  v_permlane16_swap_b32 v51, v59
  v_accvgpr_write_b32 a112, v48
  ds_read_b128 v[20:23], v9 offset:32768
  s_waitcnt lgkmcnt(3)
  v_mfma_f32_32x32x16_bf16 v[64:79], v[24:27], v[176:179], v[64:79]
  v_accvgpr_write_b32 a113, v49
  v_accvgpr_write_b32 a114, v50
  v_accvgpr_write_b32 a115, v51
  v_mfma_f32_32x32x16_bf16 v[80:95], v[24:27], v[240:243], v[80:95]
  v_accvgpr_write_b32 a168, v56
  v_accvgpr_write_b32 a169, v57
  ds_read_b128 v[24:27], v10 offset:32768
  s_waitcnt lgkmcnt(3)
  v_mfma_f32_32x32x16_bf16 v[64:79], v[28:31], v[180:183], v[64:79]
  v_accvgpr_write_b32 a170, v58
  v_accvgpr_write_b32 a171, v59
  v_mfma_f32_32x32x16_bf16 v[80:95], v[28:31], v[244:247], v[80:95]
  ds_read_b128 v[28:31], v11 offset:32768
  s_waitcnt lgkmcnt(3)
  v_mfma_f32_32x32x16_bf16 v[32:47], v[16:19], v[120:123], 0
  v_mfma_f32_32x32x16_bf16 v[48:63], v[16:19], v[184:187], 0
  ds_read_b128 v[16:19], v12 offset:32768
  s_waitcnt lgkmcnt(3)
  v_mfma_f32_32x32x16_bf16 v[32:47], v[20:23], v[124:127], v[32:47]
  v_mul_f32 v64, s52, v64
  v_mul_f32 v65, s52, v65
  v_cvt_pk_bf16_f32 v64, v64, v65
  v_mfma_f32_32x32x16_bf16 v[48:63], v[20:23], v[188:191], v[48:63]
  v_mul_f32 v66, s52, v66
  v_mul_f32 v67, s52, v67
  ds_read_b128 v[20:23], v13 offset:32768
  s_waitcnt lgkmcnt(3)
  v_mfma_f32_32x32x16_bf16 v[32:47], v[24:27], v[128:131], v[32:47]
  v_cvt_pk_bf16_f32 v65, v66, v67
  v_mul_f32 v68, s52, v68
  v_mul_f32 v69, s52, v69
  v_mfma_f32_32x32x16_bf16 v[48:63], v[24:27], v[192:195], v[48:63]
  v_cvt_pk_bf16_f32 v66, v68, v69
  v_mul_f32 v70, s52, v70
  ds_read_b128 v[24:27], v14 offset:32768
  s_waitcnt lgkmcnt(3)
  v_mfma_f32_32x32x16_bf16 v[32:47], v[28:31], v[132:135], v[32:47]
  v_mul_f32 v71, s52, v71
  v_cvt_pk_bf16_f32 v67, v70, v71
  v_mul_f32 v72, s52, v72
  v_mfma_f32_32x32x16_bf16 v[48:63], v[28:31], v[196:199], v[48:63]
  v_mul_f32 v73, s52, v73
  v_cvt_pk_bf16_f32 v72, v72, v73
  ds_read_b128 v[28:31], v15 offset:32768
  s_waitcnt lgkmcnt(3)
  v_mfma_f32_32x32x16_bf16 v[32:47], v[16:19], v[136:139], v[32:47]
  v_mul_f32 v74, s52, v74
  v_mul_f32 v75, s52, v75
  v_cvt_pk_bf16_f32 v73, v74, v75
  v_mfma_f32_32x32x16_bf16 v[48:63], v[16:19], v[200:203], v[48:63]
  v_mul_f32 v76, s52, v76
  v_mul_f32 v77, s52, v77
  ds_read_b128 v[16:19], v8 offset:33024
  s_waitcnt lgkmcnt(3)
  v_mfma_f32_32x32x16_bf16 v[32:47], v[20:23], v[140:143], v[32:47]
  v_cvt_pk_bf16_f32 v74, v76, v77
  v_mul_f32 v78, s52, v78
  v_mul_f32 v79, s52, v79
  v_mfma_f32_32x32x16_bf16 v[48:63], v[20:23], v[204:207], v[48:63]
  v_cvt_pk_bf16_f32 v75, v78, v79
  v_permlane16_swap_b32 v64, v72
  ds_read_b128 v[20:23], v9 offset:33024
  s_waitcnt lgkmcnt(3)
  v_mfma_f32_32x32x16_bf16 v[32:47], v[24:27], v[144:147], v[32:47]
  v_permlane16_swap_b32 v65, v73
  v_permlane16_swap_b32 v66, v74
  v_permlane16_swap_b32 v67, v75
  v_mfma_f32_32x32x16_bf16 v[48:63], v[24:27], v[208:211], v[48:63]
  v_accvgpr_write_b32 a4, v64
  v_accvgpr_write_b32 a5, v65
  ds_read_b128 v[24:27], v10 offset:33024
  s_waitcnt lgkmcnt(3)
  v_mfma_f32_32x32x16_bf16 v[32:47], v[28:31], v[148:151], v[32:47]
  v_accvgpr_write_b32 a6, v66
  v_accvgpr_write_b32 a7, v67
  v_accvgpr_write_b32 a60, v72
  v_mfma_f32_32x32x16_bf16 v[48:63], v[28:31], v[212:215], v[48:63]
  v_accvgpr_write_b32 a61, v73
  v_accvgpr_write_b32 a62, v74
  ds_read_b128 v[28:31], v11 offset:33024
  s_waitcnt lgkmcnt(3)
  v_mfma_f32_32x32x16_bf16 v[32:47], v[16:19], v[152:155], v[32:47]
  v_accvgpr_write_b32 a63, v75
  v_mul_f32 v80, s52, v80
  v_mul_f32 v81, s52, v81
  v_mfma_f32_32x32x16_bf16 v[48:63], v[16:19], v[216:219], v[48:63]
  v_cvt_pk_bf16_f32 v80, v80, v81
  v_mul_f32 v82, s52, v82
  ds_read_b128 v[16:19], v12 offset:33024
  s_waitcnt lgkmcnt(3)
  v_mfma_f32_32x32x16_bf16 v[32:47], v[20:23], v[156:159], v[32:47]
  v_mul_f32 v83, s52, v83
  v_cvt_pk_bf16_f32 v81, v82, v83
  v_mul_f32 v84, s52, v84
  v_mfma_f32_32x32x16_bf16 v[48:63], v[20:23], v[220:223], v[48:63]
  v_mul_f32 v85, s52, v85
  v_cvt_pk_bf16_f32 v82, v84, v85
  ds_read_b128 v[20:23], v13 offset:33024
  s_waitcnt lgkmcnt(3)
  v_mfma_f32_32x32x16_bf16 v[32:47], v[24:27], v[160:163], v[32:47]
  v_mul_f32 v86, s52, v86
  v_mul_f32 v87, s52, v87
  v_cvt_pk_bf16_f32 v83, v86, v87
  v_mfma_f32_32x32x16_bf16 v[48:63], v[24:27], v[224:227], v[48:63]
  v_mul_f32 v88, s52, v88
  v_mul_f32 v89, s52, v89
  ds_read_b128 v[24:27], v14 offset:33024
  s_waitcnt lgkmcnt(3)
  v_mfma_f32_32x32x16_bf16 v[32:47], v[28:31], v[164:167], v[32:47]
  v_cvt_pk_bf16_f32 v88, v88, v89
  v_mul_f32 v90, s52, v90
  v_mul_f32 v91, s52, v91
  v_mfma_f32_32x32x16_bf16 v[48:63], v[28:31], v[228:231], v[48:63]
  v_cvt_pk_bf16_f32 v89, v90, v91
  v_mul_f32 v92, s52, v92
  ds_read_b128 v[28:31], v15 offset:33024
  s_waitcnt lgkmcnt(3)
  v_mfma_f32_32x32x16_bf16 v[32:47], v[16:19], v[168:171], v[32:47]
  v_mul_f32 v93, s52, v93
  v_cvt_pk_bf16_f32 v90, v92, v93
  v_mul_f32 v94, s52, v94
  v_mfma_f32_32x32x16_bf16 v[48:63], v[16:19], v[232:235], v[48:63]
  v_mul_f32 v95, s52, v95
  v_cvt_pk_bf16_f32 v91, v94, v95
  ds_read_b128 v[16:19], v8 offset:49152
  s_waitcnt lgkmcnt(3)
  v_mfma_f32_32x32x16_bf16 v[32:47], v[20:23], v[172:175], v[32:47]
  v_permlane16_swap_b32 v80, v88
  v_permlane16_swap_b32 v81, v89
  v_permlane16_swap_b32 v82, v90
  v_mfma_f32_32x32x16_bf16 v[48:63], v[20:23], v[236:239], v[48:63]
  v_permlane16_swap_b32 v83, v91
  v_accvgpr_write_b32 a116, v80
  ds_read_b128 v[20:23], v9 offset:49152
  s_waitcnt lgkmcnt(3)
  v_mfma_f32_32x32x16_bf16 v[32:47], v[24:27], v[176:179], v[32:47]
  v_accvgpr_write_b32 a117, v81
  v_accvgpr_write_b32 a118, v82
  v_accvgpr_write_b32 a119, v83
  v_mfma_f32_32x32x16_bf16 v[48:63], v[24:27], v[240:243], v[48:63]
  v_accvgpr_write_b32 a172, v88
  v_accvgpr_write_b32 a173, v89
  ds_read_b128 v[24:27], v10 offset:49152
  s_waitcnt lgkmcnt(3)
  v_mfma_f32_32x32x16_bf16 v[32:47], v[28:31], v[180:183], v[32:47]
  v_accvgpr_write_b32 a174, v90
  v_accvgpr_write_b32 a175, v91
  v_mfma_f32_32x32x16_bf16 v[48:63], v[28:31], v[244:247], v[48:63]
  s_waitcnt vmcnt(16)
  s_barrier
  ds_read_b128 v[28:31], v11 offset:49152
  s_waitcnt lgkmcnt(3)
  v_mfma_f32_32x32x16_bf16 v[64:79], v[16:19], v[120:123], 0
  s_add_u32 s22, s27, 2621440
  s_add_u32 m0, s25, 16384
  s_nop 0
  buffer_load_dwordx4 v4, s[56:59], s22 offen offset:0 lds
  v_mfma_f32_32x32x16_bf16 v[80:95], v[16:19], v[184:187], 0
  ds_read_b128 v[16:19], v12 offset:49152
  s_waitcnt lgkmcnt(3)
  v_mfma_f32_32x32x16_bf16 v[64:79], v[20:23], v[124:127], v[64:79]
  buffer_load_dwordx4 v5, s[56:59], s22 offen offset:1024 lds
  v_mul_f32 v32, s52, v32
  v_mul_f32 v33, s52, v33
  v_cvt_pk_bf16_f32 v32, v32, v33
  v_mfma_f32_32x32x16_bf16 v[80:95], v[20:23], v[188:191], v[80:95]
  v_mul_f32 v34, s52, v34
  v_mul_f32 v35, s52, v35
  ds_read_b128 v[20:23], v13 offset:49152
  s_waitcnt lgkmcnt(3)
  v_mfma_f32_32x32x16_bf16 v[64:79], v[24:27], v[128:131], v[64:79]
  buffer_load_dwordx4 v6, s[56:59], s22 offen offset:2048 lds
  v_cvt_pk_bf16_f32 v33, v34, v35
  v_mul_f32 v36, s52, v36
  v_mul_f32 v37, s52, v37
  v_mfma_f32_32x32x16_bf16 v[80:95], v[24:27], v[192:195], v[80:95]
  v_cvt_pk_bf16_f32 v34, v36, v37
  v_mul_f32 v38, s52, v38
  ds_read_b128 v[24:27], v14 offset:49152
  s_waitcnt lgkmcnt(3)
  v_mfma_f32_32x32x16_bf16 v[64:79], v[28:31], v[132:135], v[64:79]
  buffer_load_dwordx4 v7, s[56:59], s22 offen offset:3072 lds
  v_mul_f32 v39, s52, v39
  v_cvt_pk_bf16_f32 v35, v38, v39
  v_mul_f32 v40, s52, v40
  v_mfma_f32_32x32x16_bf16 v[80:95], v[28:31], v[196:199], v[80:95]
  v_mul_f32 v41, s52, v41
  v_cvt_pk_bf16_f32 v40, v40, v41
  ds_read_b128 v[28:31], v15 offset:49152
  s_waitcnt lgkmcnt(3)
  v_mfma_f32_32x32x16_bf16 v[64:79], v[16:19], v[136:139], v[64:79]
  s_add_u32 s22, s27, 2883584
  s_add_u32 m0, s25, 32768
  s_nop 0
  buffer_load_dwordx4 v4, s[56:59], s22 offen offset:0 lds
  v_mul_f32 v42, s52, v42
  v_mul_f32 v43, s52, v43
  v_cvt_pk_bf16_f32 v41, v42, v43
  v_mfma_f32_32x32x16_bf16 v[80:95], v[16:19], v[200:203], v[80:95]
  v_mul_f32 v44, s52, v44
  v_mul_f32 v45, s52, v45
  ds_read_b128 v[16:19], v8 offset:49408
  s_waitcnt lgkmcnt(3)
  v_mfma_f32_32x32x16_bf16 v[64:79], v[20:23], v[140:143], v[64:79]
  buffer_load_dwordx4 v5, s[56:59], s22 offen offset:1024 lds
  v_cvt_pk_bf16_f32 v42, v44, v45
  v_mul_f32 v46, s52, v46
  v_mul_f32 v47, s52, v47
  v_mfma_f32_32x32x16_bf16 v[80:95], v[20:23], v[204:207], v[80:95]
  v_cvt_pk_bf16_f32 v43, v46, v47
  v_permlane16_swap_b32 v32, v40
  ds_read_b128 v[20:23], v9 offset:49408
  s_waitcnt lgkmcnt(3)
  v_mfma_f32_32x32x16_bf16 v[64:79], v[24:27], v[144:147], v[64:79]
  buffer_load_dwordx4 v6, s[56:59], s22 offen offset:2048 lds
  v_permlane16_swap_b32 v33, v41
  v_permlane16_swap_b32 v34, v42
  v_permlane16_swap_b32 v35, v43
  v_mfma_f32_32x32x16_bf16 v[80:95], v[24:27], v[208:211], v[80:95]
  v_accvgpr_write_b32 a8, v32
  v_accvgpr_write_b32 a9, v33
  ds_read_b128 v[24:27], v10 offset:49408
  s_waitcnt lgkmcnt(3)
  v_mfma_f32_32x32x16_bf16 v[64:79], v[28:31], v[148:151], v[64:79]
  buffer_load_dwordx4 v7, s[56:59], s22 offen offset:3072 lds
  v_accvgpr_write_b32 a10, v34
  v_accvgpr_write_b32 a11, v35
  v_accvgpr_write_b32 a64, v40
  v_mfma_f32_32x32x16_bf16 v[80:95], v[28:31], v[212:215], v[80:95]
  v_accvgpr_write_b32 a65, v41
  v_accvgpr_write_b32 a66, v42
  ds_read_b128 v[28:31], v11 offset:49408
  s_waitcnt lgkmcnt(3)
  v_mfma_f32_32x32x16_bf16 v[64:79], v[16:19], v[152:155], v[64:79]
  v_accvgpr_write_b32 a67, v43
  v_mul_f32 v48, s52, v48
  v_mul_f32 v49, s52, v49
  v_mfma_f32_32x32x16_bf16 v[80:95], v[16:19], v[216:219], v[80:95]
  v_cvt_pk_bf16_f32 v48, v48, v49
  v_mul_f32 v50, s52, v50
  ds_read_b128 v[16:19], v12 offset:49408
  s_waitcnt lgkmcnt(3)
  v_mfma_f32_32x32x16_bf16 v[64:79], v[20:23], v[156:159], v[64:79]
  v_mul_f32 v51, s52, v51
  v_cvt_pk_bf16_f32 v49, v50, v51
  v_mul_f32 v52, s52, v52
  v_mfma_f32_32x32x16_bf16 v[80:95], v[20:23], v[220:223], v[80:95]
  v_mul_f32 v53, s52, v53
  v_cvt_pk_bf16_f32 v50, v52, v53
  ds_read_b128 v[20:23], v13 offset:49408
  s_waitcnt lgkmcnt(3)
  v_mfma_f32_32x32x16_bf16 v[64:79], v[24:27], v[160:163], v[64:79]
  v_mul_f32 v54, s52, v54
  v_mul_f32 v55, s52, v55
  v_cvt_pk_bf16_f32 v51, v54, v55
  v_mfma_f32_32x32x16_bf16 v[80:95], v[24:27], v[224:227], v[80:95]
  v_mul_f32 v56, s52, v56
  v_mul_f32 v57, s52, v57
  ds_read_b128 v[24:27], v14 offset:49408
  s_waitcnt lgkmcnt(3)
  v_mfma_f32_32x32x16_bf16 v[64:79], v[28:31], v[164:167], v[64:79]
  v_cvt_pk_bf16_f32 v56, v56, v57
  v_mul_f32 v58, s52, v58
  v_mul_f32 v59, s52, v59
  v_mfma_f32_32x32x16_bf16 v[80:95], v[28:31], v[228:231], v[80:95]
  v_cvt_pk_bf16_f32 v57, v58, v59
  v_mul_f32 v60, s52, v60
  ds_read_b128 v[28:31], v15 offset:49408
  s_waitcnt lgkmcnt(3)
  v_mfma_f32_32x32x16_bf16 v[64:79], v[16:19], v[168:171], v[64:79]
  v_mul_f32 v61, s52, v61
  v_cvt_pk_bf16_f32 v58, v60, v61
  v_mul_f32 v62, s52, v62
  v_mfma_f32_32x32x16_bf16 v[80:95], v[16:19], v[232:235], v[80:95]
  v_mul_f32 v63, s52, v63
  v_cvt_pk_bf16_f32 v59, v62, v63
  v_xor_b32 v8, 65536, v8
  ds_read_b128 v[16:19], v8 offset:0
  s_waitcnt lgkmcnt(3)
  v_mfma_f32_32x32x16_bf16 v[64:79], v[20:23], v[172:175], v[64:79]
  v_permlane16_swap_b32 v48, v56
  v_permlane16_swap_b32 v49, v57
  v_permlane16_swap_b32 v50, v58
  v_mfma_f32_32x32x16_bf16 v[80:95], v[20:23], v[236:239], v[80:95]
  v_permlane16_swap_b32 v51, v59
  v_accvgpr_write_b32 a120, v48
  v_xor_b32 v9, 65536, v9
  ds_read_b128 v[20:23], v9 offset:0
  s_waitcnt lgkmcnt(3)
  v_mfma_f32_32x32x16_bf16 v[64:79], v[24:27], v[176:179], v[64:79]
  v_accvgpr_write_b32 a121, v49
  v_accvgpr_write_b32 a122, v50
  v_accvgpr_write_b32 a123, v51
  v_mfma_f32_32x32x16_bf16 v[80:95], v[24:27], v[240:243], v[80:95]
  v_accvgpr_write_b32 a176, v56
  v_accvgpr_write_b32 a177, v57
  v_xor_b32 v10, 65536, v10
  ds_read_b128 v[24:27], v10 offset:0
  s_waitcnt lgkmcnt(3)
  v_mfma_f32_32x32x16_bf16 v[64:79], v[28:31], v[180:183], v[64:79]
  v_accvgpr_write_b32 a178, v58
  v_accvgpr_write_b32 a179, v59
  v_mfma_f32_32x32x16_bf16 v[80:95], v[28:31], v[244:247], v[80:95]
  v_xor_b32 v11, 65536, v11
  ds_read_b128 v[28:31], v11 offset:0
  s_waitcnt lgkmcnt(3)
  v_mfma_f32_32x32x16_bf16 v[32:47], v[16:19], v[120:123], 0
  v_mfma_f32_32x32x16_bf16 v[48:63], v[16:19], v[184:187], 0
  v_xor_b32 v12, 65536, v12
  ds_read_b128 v[16:19], v12 offset:0
  s_waitcnt lgkmcnt(3)
  v_mfma_f32_32x32x16_bf16 v[32:47], v[20:23], v[124:127], v[32:47]
  v_mul_f32 v64, s52, v64
  v_mul_f32 v65, s52, v65
  v_cvt_pk_bf16_f32 v64, v64, v65
  v_mfma_f32_32x32x16_bf16 v[48:63], v[20:23], v[188:191], v[48:63]
  v_mul_f32 v66, s52, v66
  v_mul_f32 v67, s52, v67
  v_xor_b32 v13, 65536, v13
  ds_read_b128 v[20:23], v13 offset:0
  s_waitcnt lgkmcnt(3)
  v_mfma_f32_32x32x16_bf16 v[32:47], v[24:27], v[128:131], v[32:47]
  v_cvt_pk_bf16_f32 v65, v66, v67
  v_mul_f32 v68, s52, v68
  v_mul_f32 v69, s52, v69
  v_mfma_f32_32x32x16_bf16 v[48:63], v[24:27], v[192:195], v[48:63]
  v_cvt_pk_bf16_f32 v66, v68, v69
  v_mul_f32 v70, s52, v70
  v_xor_b32 v14, 65536, v14
  ds_read_b128 v[24:27], v14 offset:0
  s_waitcnt lgkmcnt(3)
  v_mfma_f32_32x32x16_bf16 v[32:47], v[28:31], v[132:135], v[32:47]
  v_mul_f32 v71, s52, v71
  v_cvt_pk_bf16_f32 v67, v70, v71
  v_mul_f32 v72, s52, v72
  v_mfma_f32_32x32x16_bf16 v[48:63], v[28:31], v[196:199], v[48:63]
  v_mul_f32 v73, s52, v73
  v_cvt_pk_bf16_f32 v72, v72, v73
  v_xor_b32 v15, 65536, v15
  ds_read_b128 v[28:31], v15 offset:0
  s_waitcnt lgkmcnt(3)
  v_mfma_f32_32x32x16_bf16 v[32:47], v[16:19], v[136:139], v[32:47]
  v_mul_f32 v74, s52, v74
  v_mul_f32 v75, s52, v75
  v_cvt_pk_bf16_f32 v73, v74, v75
  v_mfma_f32_32x32x16_bf16 v[48:63], v[16:19], v[200:203], v[48:63]
  v_mul_f32 v76, s52, v76
  v_mul_f32 v77, s52, v77
  ds_read_b128 v[16:19], v8 offset:256
  s_waitcnt lgkmcnt(3)
  v_mfma_f32_32x32x16_bf16 v[32:47], v[20:23], v[140:143], v[32:47]
  v_cvt_pk_bf16_f32 v74, v76, v77
  v_mul_f32 v78, s52, v78
  v_mul_f32 v79, s52, v79
  v_mfma_f32_32x32x16_bf16 v[48:63], v[20:23], v[204:207], v[48:63]
  v_cvt_pk_bf16_f32 v75, v78, v79
  v_permlane16_swap_b32 v64, v72
  ds_read_b128 v[20:23], v9 offset:256
  s_waitcnt lgkmcnt(3)
  v_mfma_f32_32x32x16_bf16 v[32:47], v[24:27], v[144:147], v[32:47]
  v_permlane16_swap_b32 v65, v73
  v_permlane16_swap_b32 v66, v74
  v_permlane16_swap_b32 v67, v75
  v_mfma_f32_32x32x16_bf16 v[48:63], v[24:27], v[208:211], v[48:63]
  v_accvgpr_write_b32 a12, v64
  v_accvgpr_write_b32 a13, v65
  ds_read_b128 v[24:27], v10 offset:256
  s_waitcnt lgkmcnt(3)
  v_mfma_f32_32x32x16_bf16 v[32:47], v[28:31], v[148:151], v[32:47]
  v_accvgpr_write_b32 a14, v66
  v_accvgpr_write_b32 a15, v67
  v_accvgpr_write_b32 a68, v72
  v_mfma_f32_32x32x16_bf16 v[48:63], v[28:31], v[212:215], v[48:63]
  v_accvgpr_write_b32 a69, v73
  v_accvgpr_write_b32 a70, v74
  ds_read_b128 v[28:31], v11 offset:256
  s_waitcnt lgkmcnt(3)
  v_mfma_f32_32x32x16_bf16 v[32:47], v[16:19], v[152:155], v[32:47]
  v_accvgpr_write_b32 a71, v75
  v_mul_f32 v80, s52, v80
  v_mul_f32 v81, s52, v81
  v_mfma_f32_32x32x16_bf16 v[48:63], v[16:19], v[216:219], v[48:63]
  v_cvt_pk_bf16_f32 v80, v80, v81
  v_mul_f32 v82, s52, v82
  ds_read_b128 v[16:19], v12 offset:256
  s_waitcnt lgkmcnt(3)
  v_mfma_f32_32x32x16_bf16 v[32:47], v[20:23], v[156:159], v[32:47]
  v_mul_f32 v83, s52, v83
  v_cvt_pk_bf16_f32 v81, v82, v83
  v_mul_f32 v84, s52, v84
  v_mfma_f32_32x32x16_bf16 v[48:63], v[20:23], v[220:223], v[48:63]
  v_mul_f32 v85, s52, v85
  v_cvt_pk_bf16_f32 v82, v84, v85
  ds_read_b128 v[20:23], v13 offset:256
  s_waitcnt lgkmcnt(3)
  v_mfma_f32_32x32x16_bf16 v[32:47], v[24:27], v[160:163], v[32:47]
  v_mul_f32 v86, s52, v86
  v_mul_f32 v87, s52, v87
  v_cvt_pk_bf16_f32 v83, v86, v87
  v_mfma_f32_32x32x16_bf16 v[48:63], v[24:27], v[224:227], v[48:63]
  v_mul_f32 v88, s52, v88
  v_mul_f32 v89, s52, v89
  ds_read_b128 v[24:27], v14 offset:256
  s_waitcnt lgkmcnt(3)
  v_mfma_f32_32x32x16_bf16 v[32:47], v[28:31], v[164:167], v[32:47]
  v_cvt_pk_bf16_f32 v88, v88, v89
  v_mul_f32 v90, s52, v90
  v_mul_f32 v91, s52, v91
  v_mfma_f32_32x32x16_bf16 v[48:63], v[28:31], v[228:231], v[48:63]
  v_cvt_pk_bf16_f32 v89, v90, v91
  v_mul_f32 v92, s52, v92
  ds_read_b128 v[28:31], v15 offset:256
  s_waitcnt lgkmcnt(3)
  v_mfma_f32_32x32x16_bf16 v[32:47], v[16:19], v[168:171], v[32:47]
  v_mul_f32 v93, s52, v93
  v_cvt_pk_bf16_f32 v90, v92, v93
  v_mul_f32 v94, s52, v94
  v_mfma_f32_32x32x16_bf16 v[48:63], v[16:19], v[232:235], v[48:63]
  v_mul_f32 v95, s52, v95
  v_cvt_pk_bf16_f32 v91, v94, v95
  ds_read_b128 v[16:19], v8 offset:16384
  s_waitcnt lgkmcnt(3)
  v_mfma_f32_32x32x16_bf16 v[32:47], v[20:23], v[172:175], v[32:47]
  v_permlane16_swap_b32 v80, v88
  v_permlane16_swap_b32 v81, v89
  v_permlane16_swap_b32 v82, v90
  v_mfma_f32_32x32x16_bf16 v[48:63], v[20:23], v[236:239], v[48:63]
  v_permlane16_swap_b32 v83, v91
  v_accvgpr_write_b32 a124, v80
  ds_read_b128 v[20:23], v9 offset:16384
  s_waitcnt lgkmcnt(3)
  v_mfma_f32_32x32x16_bf16 v[32:47], v[24:27], v[176:179], v[32:47]
  v_accvgpr_write_b32 a125, v81
  v_accvgpr_write_b32 a126, v82
  v_accvgpr_write_b32 a127, v83
  v_mfma_f32_32x32x16_bf16 v[48:63], v[24:27], v[240:243], v[48:63]
  v_accvgpr_write_b32 a180, v88
  v_accvgpr_write_b32 a181, v89
  ds_read_b128 v[24:27], v10 offset:16384
  s_waitcnt lgkmcnt(3)
  v_mfma_f32_32x32x16_bf16 v[32:47], v[28:31], v[180:183], v[32:47]
  v_accvgpr_write_b32 a182, v90
  v_accvgpr_write_b32 a183, v91
  v_mfma_f32_32x32x16_bf16 v[48:63], v[28:31], v[244:247], v[48:63]
  s_waitcnt vmcnt(16)
  s_barrier
  ds_read_b128 v[28:31], v11 offset:16384
  s_waitcnt lgkmcnt(3)
  v_mfma_f32_32x32x16_bf16 v[64:79], v[16:19], v[120:123], 0
  s_add_u32 s22, s27, 3145728
  s_add_u32 m0, s25, 49152
  s_nop 0
  buffer_load_dwordx4 v4, s[56:59], s22 offen offset:0 lds
  v_mfma_f32_32x32x16_bf16 v[80:95], v[16:19], v[184:187], 0
  ds_read_b128 v[16:19], v12 offset:16384
  s_waitcnt lgkmcnt(3)
  v_mfma_f32_32x32x16_bf16 v[64:79], v[20:23], v[124:127], v[64:79]
  buffer_load_dwordx4 v5, s[56:59], s22 offen offset:1024 lds
  v_mul_f32 v32, s52, v32
  v_mul_f32 v33, s52, v33
  v_cvt_pk_bf16_f32 v32, v32, v33
  v_mfma_f32_32x32x16_bf16 v[80:95], v[20:23], v[188:191], v[80:95]
  v_mul_f32 v34, s52, v34
  v_mul_f32 v35, s52, v35
  ds_read_b128 v[20:23], v13 offset:16384
  s_waitcnt lgkmcnt(3)
  v_mfma_f32_32x32x16_bf16 v[64:79], v[24:27], v[128:131], v[64:79]
  buffer_load_dwordx4 v6, s[56:59], s22 offen offset:2048 lds
  v_cvt_pk_bf16_f32 v33, v34, v35
  v_mul_f32 v36, s52, v36
  v_mul_f32 v37, s52, v37
  v_mfma_f32_32x32x16_bf16 v[80:95], v[24:27], v[192:195], v[80:95]
  v_cvt_pk_bf16_f32 v34, v36, v37
  v_mul_f32 v38, s52, v38
  ds_read_b128 v[24:27], v14 offset:16384
  s_waitcnt lgkmcnt(3)
  v_mfma_f32_32x32x16_bf16 v[64:79], v[28:31], v[132:135], v[64:79]
  buffer_load_dwordx4 v7, s[56:59], s22 offen offset:3072 lds
  v_mul_f32 v39, s52, v39
  v_cvt_pk_bf16_f32 v35, v38, v39
  v_mul_f32 v40, s52, v40
  v_mfma_f32_32x32x16_bf16 v[80:95], v[28:31], v[196:199], v[80:95]
  v_mul_f32 v41, s52, v41
  v_cvt_pk_bf16_f32 v40, v40, v41
  ds_read_b128 v[28:31], v15 offset:16384
  s_waitcnt lgkmcnt(3)
  v_mfma_f32_32x32x16_bf16 v[64:79], v[16:19], v[136:139], v[64:79]
  s_add_u32 s22, s27, 3407872
  s_add_u32 m0, s25, 65536
  s_nop 0
  buffer_load_dwordx4 v4, s[56:59], s22 offen offset:0 lds
  v_mul_f32 v42, s52, v42
  v_mul_f32 v43, s52, v43
  v_cvt_pk_bf16_f32 v41, v42, v43
  v_mfma_f32_32x32x16_bf16 v[80:95], v[16:19], v[200:203], v[80:95]
  v_mul_f32 v44, s52, v44
  v_mul_f32 v45, s52, v45
  ds_read_b128 v[16:19], v8 offset:16640
  s_waitcnt lgkmcnt(3)
  v_mfma_f32_32x32x16_bf16 v[64:79], v[20:23], v[140:143], v[64:79]
  buffer_load_dwordx4 v5, s[56:59], s22 offen offset:1024 lds
  v_cvt_pk_bf16_f32 v42, v44, v45
  v_mul_f32 v46, s52, v46
  v_mul_f32 v47, s52, v47
  v_mfma_f32_32x32x16_bf16 v[80:95], v[20:23], v[204:207], v[80:95]
  v_cvt_pk_bf16_f32 v43, v46, v47
  v_permlane16_swap_b32 v32, v40
  ds_read_b128 v[20:23], v9 offset:16640
  s_waitcnt lgkmcnt(3)
  v_mfma_f32_32x32x16_bf16 v[64:79], v[24:27], v[144:147], v[64:79]
  buffer_load_dwordx4 v6, s[56:59], s22 offen offset:2048 lds
  v_permlane16_swap_b32 v33, v41
  v_permlane16_swap_b32 v34, v42
  v_permlane16_swap_b32 v35, v43
  v_mfma_f32_32x32x16_bf16 v[80:95], v[24:27], v[208:211], v[80:95]
  v_accvgpr_write_b32 a16, v32
  v_accvgpr_write_b32 a17, v33
  ds_read_b128 v[24:27], v10 offset:16640
  s_waitcnt lgkmcnt(3)
  v_mfma_f32_32x32x16_bf16 v[64:79], v[28:31], v[148:151], v[64:79]
  buffer_load_dwordx4 v7, s[56:59], s22 offen offset:3072 lds
  v_accvgpr_write_b32 a18, v34
  v_accvgpr_write_b32 a19, v35
  v_accvgpr_write_b32 a72, v40
  v_mfma_f32_32x32x16_bf16 v[80:95], v[28:31], v[212:215], v[80:95]
  v_accvgpr_write_b32 a73, v41
  v_accvgpr_write_b32 a74, v42
  ds_read_b128 v[28:31], v11 offset:16640
  s_waitcnt lgkmcnt(3)
  v_mfma_f32_32x32x16_bf16 v[64:79], v[16:19], v[152:155], v[64:79]
  v_accvgpr_write_b32 a75, v43
  v_mul_f32 v48, s52, v48
  v_mul_f32 v49, s52, v49
  v_mfma_f32_32x32x16_bf16 v[80:95], v[16:19], v[216:219], v[80:95]
  v_cvt_pk_bf16_f32 v48, v48, v49
  v_mul_f32 v50, s52, v50
  ds_read_b128 v[16:19], v12 offset:16640
  s_waitcnt lgkmcnt(3)
  v_mfma_f32_32x32x16_bf16 v[64:79], v[20:23], v[156:159], v[64:79]
  v_mul_f32 v51, s52, v51
  v_cvt_pk_bf16_f32 v49, v50, v51
  v_mul_f32 v52, s52, v52
  v_mfma_f32_32x32x16_bf16 v[80:95], v[20:23], v[220:223], v[80:95]
  v_mul_f32 v53, s52, v53
  v_cvt_pk_bf16_f32 v50, v52, v53
  ds_read_b128 v[20:23], v13 offset:16640
  s_waitcnt lgkmcnt(3)
  v_mfma_f32_32x32x16_bf16 v[64:79], v[24:27], v[160:163], v[64:79]
  v_mul_f32 v54, s52, v54
  v_mul_f32 v55, s52, v55
  v_cvt_pk_bf16_f32 v51, v54, v55
  v_mfma_f32_32x32x16_bf16 v[80:95], v[24:27], v[224:227], v[80:95]
  v_mul_f32 v56, s52, v56
  v_mul_f32 v57, s52, v57
  ds_read_b128 v[24:27], v14 offset:16640
  s_waitcnt lgkmcnt(3)
  v_mfma_f32_32x32x16_bf16 v[64:79], v[28:31], v[164:167], v[64:79]
  v_cvt_pk_bf16_f32 v56, v56, v57
  v_mul_f32 v58, s52, v58
  v_mul_f32 v59, s52, v59
  v_mfma_f32_32x32x16_bf16 v[80:95], v[28:31], v[228:231], v[80:95]
  v_cvt_pk_bf16_f32 v57, v58, v59
  v_mul_f32 v60, s52, v60
  ds_read_b128 v[28:31], v15 offset:16640
  s_waitcnt lgkmcnt(3)
  v_mfma_f32_32x32x16_bf16 v[64:79], v[16:19], v[168:171], v[64:79]
  v_mul_f32 v61, s52, v61
  v_cvt_pk_bf16_f32 v58, v60, v61
  v_mul_f32 v62, s52, v62
  v_mfma_f32_32x32x16_bf16 v[80:95], v[16:19], v[232:235], v[80:95]
  v_mul_f32 v63, s52, v63
  v_cvt_pk_bf16_f32 v59, v62, v63
  ds_read_b128 v[16:19], v8 offset:32768
  s_waitcnt lgkmcnt(3)
  v_mfma_f32_32x32x16_bf16 v[64:79], v[20:23], v[172:175], v[64:79]
  v_permlane16_swap_b32 v48, v56
  v_permlane16_swap_b32 v49, v57
  v_permlane16_swap_b32 v50, v58
  v_mfma_f32_32x32x16_bf16 v[80:95], v[20:23], v[236:239], v[80:95]
  v_permlane16_swap_b32 v51, v59
  v_accvgpr_write_b32 a128, v48
  ds_read_b128 v[20:23], v9 offset:32768
  s_waitcnt lgkmcnt(3)
  v_mfma_f32_32x32x16_bf16 v[64:79], v[24:27], v[176:179], v[64:79]
  v_accvgpr_write_b32 a129, v49
  v_accvgpr_write_b32 a130, v50
  v_accvgpr_write_b32 a131, v51
  v_mfma_f32_32x32x16_bf16 v[80:95], v[24:27], v[240:243], v[80:95]
  v_accvgpr_write_b32 a184, v56
  v_accvgpr_write_b32 a185, v57
  ds_read_b128 v[24:27], v10 offset:32768
  s_waitcnt lgkmcnt(3)
  v_mfma_f32_32x32x16_bf16 v[64:79], v[28:31], v[180:183], v[64:79]
  v_accvgpr_write_b32 a186, v58
  v_accvgpr_write_b32 a187, v59
  v_mfma_f32_32x32x16_bf16 v[80:95], v[28:31], v[244:247], v[80:95]
  ds_read_b128 v[28:31], v11 offset:32768
  s_waitcnt lgkmcnt(3)
  v_mfma_f32_32x32x16_bf16 v[32:47], v[16:19], v[120:123], 0
  v_mfma_f32_32x32x16_bf16 v[48:63], v[16:19], v[184:187], 0
  ds_read_b128 v[16:19], v12 offset:32768
  s_waitcnt lgkmcnt(3)
  v_mfma_f32_32x32x16_bf16 v[32:47], v[20:23], v[124:127], v[32:47]
  v_mul_f32 v64, s52, v64
  v_mul_f32 v65, s52, v65
  v_cvt_pk_bf16_f32 v64, v64, v65
  v_mfma_f32_32x32x16_bf16 v[48:63], v[20:23], v[188:191], v[48:63]
  v_mul_f32 v66, s52, v66
  v_mul_f32 v67, s52, v67
  ds_read_b128 v[20:23], v13 offset:32768
  s_waitcnt lgkmcnt(3)
  v_mfma_f32_32x32x16_bf16 v[32:47], v[24:27], v[128:131], v[32:47]
  v_cvt_pk_bf16_f32 v65, v66, v67
  v_mul_f32 v68, s52, v68
  v_mul_f32 v69, s52, v69
  v_mfma_f32_32x32x16_bf16 v[48:63], v[24:27], v[192:195], v[48:63]
  v_cvt_pk_bf16_f32 v66, v68, v69
  v_mul_f32 v70, s52, v70
  ds_read_b128 v[24:27], v14 offset:32768
  s_waitcnt lgkmcnt(3)
  v_mfma_f32_32x32x16_bf16 v[32:47], v[28:31], v[132:135], v[32:47]
  v_mul_f32 v71, s52, v71
  v_cvt_pk_bf16_f32 v67, v70, v71
  v_mul_f32 v72, s52, v72
  v_mfma_f32_32x32x16_bf16 v[48:63], v[28:31], v[196:199], v[48:63]
  v_mul_f32 v73, s52, v73
  v_cvt_pk_bf16_f32 v72, v72, v73
  ds_read_b128 v[28:31], v15 offset:32768
  s_waitcnt lgkmcnt(3)
  v_mfma_f32_32x32x16_bf16 v[32:47], v[16:19], v[136:139], v[32:47]
  v_mul_f32 v74, s52, v74
  v_mul_f32 v75, s52, v75
  v_cvt_pk_bf16_f32 v73, v74, v75
  v_mfma_f32_32x32x16_bf16 v[48:63], v[16:19], v[200:203], v[48:63]
  v_mul_f32 v76, s52, v76
  v_mul_f32 v77, s52, v77
  ds_read_b128 v[16:19], v8 offset:33024
  s_waitcnt lgkmcnt(3)
  v_mfma_f32_32x32x16_bf16 v[32:47], v[20:23], v[140:143], v[32:47]
  v_cvt_pk_bf16_f32 v74, v76, v77
  v_mul_f32 v78, s52, v78
  v_mul_f32 v79, s52, v79
  v_mfma_f32_32x32x16_bf16 v[48:63], v[20:23], v[204:207], v[48:63]
  v_cvt_pk_bf16_f32 v75, v78, v79
  v_permlane16_swap_b32 v64, v72
  ds_read_b128 v[20:23], v9 offset:33024
  s_waitcnt lgkmcnt(3)
  v_mfma_f32_32x32x16_bf16 v[32:47], v[24:27], v[144:147], v[32:47]
  v_permlane16_swap_b32 v65, v73
  v_permlane16_swap_b32 v66, v74
  v_permlane16_swap_b32 v67, v75
  v_mfma_f32_32x32x16_bf16 v[48:63], v[24:27], v[208:211], v[48:63]
  v_accvgpr_write_b32 a20, v64
  v_accvgpr_write_b32 a21, v65
  ds_read_b128 v[24:27], v10 offset:33024
  s_waitcnt lgkmcnt(3)
  v_mfma_f32_32x32x16_bf16 v[32:47], v[28:31], v[148:151], v[32:47]
  v_accvgpr_write_b32 a22, v66
  v_accvgpr_write_b32 a23, v67
  v_accvgpr_write_b32 a76, v72
  v_mfma_f32_32x32x16_bf16 v[48:63], v[28:31], v[212:215], v[48:63]
  v_accvgpr_write_b32 a77, v73
  v_accvgpr_write_b32 a78, v74
  ds_read_b128 v[28:31], v11 offset:33024
  s_waitcnt lgkmcnt(3)
  v_mfma_f32_32x32x16_bf16 v[32:47], v[16:19], v[152:155], v[32:47]
  v_accvgpr_write_b32 a79, v75
  v_mul_f32 v80, s52, v80
  v_mul_f32 v81, s52, v81
  v_mfma_f32_32x32x16_bf16 v[48:63], v[16:19], v[216:219], v[48:63]
  v_cvt_pk_bf16_f32 v80, v80, v81
  v_mul_f32 v82, s52, v82
  ds_read_b128 v[16:19], v12 offset:33024
  s_waitcnt lgkmcnt(3)
  v_mfma_f32_32x32x16_bf16 v[32:47], v[20:23], v[156:159], v[32:47]
  v_mul_f32 v83, s52, v83
  v_cvt_pk_bf16_f32 v81, v82, v83
  v_mul_f32 v84, s52, v84
  v_mfma_f32_32x32x16_bf16 v[48:63], v[20:23], v[220:223], v[48:63]
  v_mul_f32 v85, s52, v85
  v_cvt_pk_bf16_f32 v82, v84, v85
  ds_read_b128 v[20:23], v13 offset:33024
  s_waitcnt lgkmcnt(3)
  v_mfma_f32_32x32x16_bf16 v[32:47], v[24:27], v[160:163], v[32:47]
  v_mul_f32 v86, s52, v86
  v_mul_f32 v87, s52, v87
  v_cvt_pk_bf16_f32 v83, v86, v87
  v_mfma_f32_32x32x16_bf16 v[48:63], v[24:27], v[224:227], v[48:63]
  v_mul_f32 v88, s52, v88
  v_mul_f32 v89, s52, v89
  ds_read_b128 v[24:27], v14 offset:33024
  s_waitcnt lgkmcnt(3)
  v_mfma_f32_32x32x16_bf16 v[32:47], v[28:31], v[164:167], v[32:47]
  v_cvt_pk_bf16_f32 v88, v88, v89
  v_mul_f32 v90, s52, v90
  v_mul_f32 v91, s52, v91
  v_mfma_f32_32x32x16_bf16 v[48:63], v[28:31], v[228:231], v[48:63]
  v_cvt_pk_bf16_f32 v89, v90, v91
  v_mul_f32 v92, s52, v92
  ds_read_b128 v[28:31], v15 offset:33024
  s_waitcnt lgkmcnt(3)
  v_mfma_f32_32x32x16_bf16 v[32:47], v[16:19], v[168:171], v[32:47]
  v_mul_f32 v93, s52, v93
  v_cvt_pk_bf16_f32 v90, v92, v93
  v_mul_f32 v94, s52, v94
  v_mfma_f32_32x32x16_bf16 v[48:63], v[16:19], v[232:235], v[48:63]
  v_mul_f32 v95, s52, v95
  v_cvt_pk_bf16_f32 v91, v94, v95
  ds_read_b128 v[16:19], v8 offset:49152
  s_waitcnt lgkmcnt(3)
  v_mfma_f32_32x32x16_bf16 v[32:47], v[20:23], v[172:175], v[32:47]
  v_permlane16_swap_b32 v80, v88
  v_permlane16_swap_b32 v81, v89
  v_permlane16_swap_b32 v82, v90
  v_mfma_f32_32x32x16_bf16 v[48:63], v[20:23], v[236:239], v[48:63]
  v_permlane16_swap_b32 v83, v91
  v_accvgpr_write_b32 a132, v80
  ds_read_b128 v[20:23], v9 offset:49152
  s_waitcnt lgkmcnt(3)
  v_mfma_f32_32x32x16_bf16 v[32:47], v[24:27], v[176:179], v[32:47]
  v_accvgpr_write_b32 a133, v81
  v_accvgpr_write_b32 a134, v82
  v_accvgpr_write_b32 a135, v83
  v_mfma_f32_32x32x16_bf16 v[48:63], v[24:27], v[240:243], v[48:63]
  v_accvgpr_write_b32 a188, v88
  v_accvgpr_write_b32 a189, v89
  ds_read_b128 v[24:27], v10 offset:49152
  s_waitcnt lgkmcnt(3)
  v_mfma_f32_32x32x16_bf16 v[32:47], v[28:31], v[180:183], v[32:47]
  v_accvgpr_write_b32 a190, v90
  v_accvgpr_write_b32 a191, v91
  v_mfma_f32_32x32x16_bf16 v[48:63], v[28:31], v[244:247], v[48:63]
  s_waitcnt vmcnt(16)
  s_barrier
  ds_read_b128 v[28:31], v11 offset:49152
  s_waitcnt lgkmcnt(3)
  v_mfma_f32_32x32x16_bf16 v[64:79], v[16:19], v[120:123], 0
  v_mfma_f32_32x32x16_bf16 v[80:95], v[16:19], v[184:187], 0
  ds_read_b128 v[16:19], v12 offset:49152
  s_waitcnt lgkmcnt(3)
  v_mfma_f32_32x32x16_bf16 v[64:79], v[20:23], v[124:127], v[64:79]
  v_mul_f32 v32, s52, v32
  v_mul_f32 v33, s52, v33
  v_cvt_pk_bf16_f32 v32, v32, v33
  v_mfma_f32_32x32x16_bf16 v[80:95], v[20:23], v[188:191], v[80:95]
  v_mul_f32 v34, s52, v34
  v_mul_f32 v35, s52, v35
  ds_read_b128 v[20:23], v13 offset:49152
  s_waitcnt lgkmcnt(3)
  v_mfma_f32_32x32x16_bf16 v[64:79], v[24:27], v[128:131], v[64:79]
  v_cvt_pk_bf16_f32 v33, v34, v35
  v_mul_f32 v36, s52, v36
  v_mul_f32 v37, s52, v37
  v_mfma_f32_32x32x16_bf16 v[80:95], v[24:27], v[192:195], v[80:95]
  v_cvt_pk_bf16_f32 v34, v36, v37
  v_mul_f32 v38, s52, v38
  ds_read_b128 v[24:27], v14 offset:49152
  s_waitcnt lgkmcnt(3)
  v_mfma_f32_32x32x16_bf16 v[64:79], v[28:31], v[132:135], v[64:79]
  v_mul_f32 v39, s52, v39
  v_cvt_pk_bf16_f32 v35, v38, v39
  v_mul_f32 v40, s52, v40
  v_mfma_f32_32x32x16_bf16 v[80:95], v[28:31], v[196:199], v[80:95]
  v_mul_f32 v41, s52, v41
  v_cvt_pk_bf16_f32 v40, v40, v41
  ds_read_b128 v[28:31], v15 offset:49152
  s_waitcnt lgkmcnt(3)
  v_mfma_f32_32x32x16_bf16 v[64:79], v[16:19], v[136:139], v[64:79]
  buffer_load_dwordx4 v[100:103], v113, s[8:11], s28 offen sc1
  v_mul_f32 v42, s52, v42
  v_mul_f32 v43, s52, v43
  v_cvt_pk_bf16_f32 v41, v42, v43
  v_mfma_f32_32x32x16_bf16 v[80:95], v[16:19], v[200:203], v[80:95]
  v_mul_f32 v44, s52, v44
  v_mul_f32 v45, s52, v45
  ds_read_b128 v[16:19], v8 offset:49408
  s_waitcnt lgkmcnt(3)
  v_mfma_f32_32x32x16_bf16 v[64:79], v[20:23], v[140:143], v[64:79]
  v_cvt_pk_bf16_f32 v42, v44, v45
  v_mul_f32 v46, s52, v46
  v_mul_f32 v47, s52, v47
  v_mfma_f32_32x32x16_bf16 v[80:95], v[20:23], v[204:207], v[80:95]
  v_cvt_pk_bf16_f32 v43, v46, v47
  v_permlane16_swap_b32 v32, v40
  ds_read_b128 v[20:23], v9 offset:49408
  s_waitcnt lgkmcnt(3)
  v_mfma_f32_32x32x16_bf16 v[64:79], v[24:27], v[144:147], v[64:79]
  v_permlane16_swap_b32 v33, v41
  v_permlane16_swap_b32 v34, v42
  v_permlane16_swap_b32 v35, v43
  v_mfma_f32_32x32x16_bf16 v[80:95], v[24:27], v[208:211], v[80:95]
  v_accvgpr_write_b32 a24, v32
  v_accvgpr_write_b32 a25, v33
  ds_read_b128 v[24:27], v10 offset:49408
  s_waitcnt lgkmcnt(3)
  v_mfma_f32_32x32x16_bf16 v[64:79], v[28:31], v[148:151], v[64:79]
  v_accvgpr_write_b32 a26, v34
  v_accvgpr_write_b32 a27, v35
  v_accvgpr_write_b32 a80, v40
  v_mfma_f32_32x32x16_bf16 v[80:95], v[28:31], v[212:215], v[80:95]
  v_accvgpr_write_b32 a81, v41
  v_accvgpr_write_b32 a82, v42
  ds_read_b128 v[28:31], v11 offset:49408
  s_waitcnt lgkmcnt(3)
  v_mfma_f32_32x32x16_bf16 v[64:79], v[16:19], v[152:155], v[64:79]
  v_accvgpr_write_b32 a83, v43
  v_mul_f32 v48, s52, v48
  v_mul_f32 v49, s52, v49
  v_mfma_f32_32x32x16_bf16 v[80:95], v[16:19], v[216:219], v[80:95]
  v_cvt_pk_bf16_f32 v48, v48, v49
  v_mul_f32 v50, s52, v50
  ds_read_b128 v[16:19], v12 offset:49408
  s_waitcnt lgkmcnt(3)
  v_mfma_f32_32x32x16_bf16 v[64:79], v[20:23], v[156:159], v[64:79]
  v_mul_f32 v51, s52, v51
  v_cvt_pk_bf16_f32 v49, v50, v51
  v_mul_f32 v52, s52, v52
  v_mfma_f32_32x32x16_bf16 v[80:95], v[20:23], v[220:223], v[80:95]
  v_mul_f32 v53, s52, v53
  v_cvt_pk_bf16_f32 v50, v52, v53
  ds_read_b128 v[20:23], v13 offset:49408
  s_waitcnt lgkmcnt(3)
  v_mfma_f32_32x32x16_bf16 v[64:79], v[24:27], v[160:163], v[64:79]
  v_mul_f32 v54, s52, v54
  v_mul_f32 v55, s52, v55
  v_cvt_pk_bf16_f32 v51, v54, v55
  v_mfma_f32_32x32x16_bf16 v[80:95], v[24:27], v[224:227], v[80:95]
  v_mul_f32 v56, s52, v56
  v_mul_f32 v57, s52, v57
  ds_read_b128 v[24:27], v14 offset:49408
  s_waitcnt lgkmcnt(3)
  v_mfma_f32_32x32x16_bf16 v[64:79], v[28:31], v[164:167], v[64:79]
  v_cvt_pk_bf16_f32 v56, v56, v57
  v_mul_f32 v58, s52, v58
  v_mul_f32 v59, s52, v59
  v_mfma_f32_32x32x16_bf16 v[80:95], v[28:31], v[228:231], v[80:95]
  v_cvt_pk_bf16_f32 v57, v58, v59
  v_mul_f32 v60, s52, v60
  ds_read_b128 v[28:31], v15 offset:49408
  s_waitcnt lgkmcnt(3)
  v_mfma_f32_32x32x16_bf16 v[64:79], v[16:19], v[168:171], v[64:79]
  v_mul_f32 v61, s52, v61
  v_cvt_pk_bf16_f32 v58, v60, v61
  v_mul_f32 v62, s52, v62
  v_mfma_f32_32x32x16_bf16 v[80:95], v[16:19], v[232:235], v[80:95]
  v_mul_f32 v63, s52, v63
  v_cvt_pk_bf16_f32 v59, v62, v63
  v_xor_b32 v8, 196608, v8
  ds_read_b128 v[16:19], v8 offset:0
  s_waitcnt lgkmcnt(3)
  v_mfma_f32_32x32x16_bf16 v[64:79], v[20:23], v[172:175], v[64:79]
  v_permlane16_swap_b32 v48, v56
  v_permlane16_swap_b32 v49, v57
  v_permlane16_swap_b32 v50, v58
  v_mfma_f32_32x32x16_bf16 v[80:95], v[20:23], v[236:239], v[80:95]
  v_permlane16_swap_b32 v51, v59
  v_accvgpr_write_b32 a136, v48
  v_xor_b32 v9, 196608, v9
  ds_read_b128 v[20:23], v9 offset:0
  s_waitcnt lgkmcnt(3)
  v_mfma_f32_32x32x16_bf16 v[64:79], v[24:27], v[176:179], v[64:79]
  v_accvgpr_write_b32 a137, v49
  v_accvgpr_write_b32 a138, v50
  v_accvgpr_write_b32 a139, v51
  v_mfma_f32_32x32x16_bf16 v[80:95], v[24:27], v[240:243], v[80:95]
  v_accvgpr_write_b32 a192, v56
  v_accvgpr_write_b32 a193, v57
  v_xor_b32 v10, 196608, v10
  ds_read_b128 v[24:27], v10 offset:0
  s_waitcnt lgkmcnt(3)
  v_mfma_f32_32x32x16_bf16 v[64:79], v[28:31], v[180:183], v[64:79]
  v_accvgpr_write_b32 a194, v58
  v_accvgpr_write_b32 a195, v59
  v_mfma_f32_32x32x16_bf16 v[80:95], v[28:31], v[244:247], v[80:95]
  v_xor_b32 v11, 196608, v11
  ds_read_b128 v[28:31], v11 offset:0
  s_waitcnt lgkmcnt(3)
  v_mfma_f32_32x32x16_bf16 v[32:47], v[16:19], v[120:123], 0
  s_waitcnt vmcnt(0)
  v_cmp_ne_u64 vcc, s[88:89], v[100:101]
  v_cmp_ne_u64 s[54:55], s[88:89], v[102:103]
  s_add_u32 s48, s33, 0
  v_mfma_f32_32x32x16_bf16 v[48:63], v[16:19], v[184:187], 0
  v_xor_b32 v12, 196608, v12
  ds_read_b128 v[16:19], v12 offset:0
  s_waitcnt lgkmcnt(3)
  v_mfma_f32_32x32x16_bf16 v[32:47], v[20:23], v[124:127], v[32:47]
  s_or_b64 vcc, vcc, s[54:55]
  s_cselect_b32 s48, 0x10000000, s48
  s_add_u32 s22, s48, 0
  buffer_load_dwordx4 a[224:227], v2, s[8:11], s22 offen sc1
  v_mul_f32 v64, s52, v64
  v_mul_f32 v65, s52, v65
  v_cvt_pk_bf16_f32 v64, v64, v65
  v_mfma_f32_32x32x16_bf16 v[48:63], v[20:23], v[188:191], v[48:63]
  v_mul_f32 v66, s52, v66
  v_mul_f32 v67, s52, v67
  v_xor_b32 v13, 196608, v13
  ds_read_b128 v[20:23], v13 offset:0
  s_waitcnt lgkmcnt(3)
  v_mfma_f32_32x32x16_bf16 v[32:47], v[24:27], v[128:131], v[32:47]
  v_cvt_pk_bf16_f32 v65, v66, v67
  v_mul_f32 v68, s52, v68
  v_mul_f32 v69, s52, v69
  v_mfma_f32_32x32x16_bf16 v[48:63], v[24:27], v[192:195], v[48:63]
  v_cvt_pk_bf16_f32 v66, v68, v69
  v_mul_f32 v70, s52, v70
  v_xor_b32 v14, 196608, v14
  ds_read_b128 v[24:27], v14 offset:0
  s_waitcnt lgkmcnt(3)
  v_mfma_f32_32x32x16_bf16 v[32:47], v[28:31], v[132:135], v[32:47]
  s_add_u32 s22, s48, 1024
  buffer_load_dwordx4 a[228:231], v2, s[8:11], s22 offen sc1
  v_mul_f32 v71, s52, v71
  v_cvt_pk_bf16_f32 v67, v70, v71
  v_mul_f32 v72, s52, v72
  v_mfma_f32_32x32x16_bf16 v[48:63], v[28:31], v[196:199], v[48:63]
  v_mul_f32 v73, s52, v73
  v_cvt_pk_bf16_f32 v72, v72, v73
  v_xor_b32 v15, 196608, v15
  ds_read_b128 v[28:31], v15 offset:0
  s_waitcnt lgkmcnt(3)
  v_mfma_f32_32x32x16_bf16 v[32:47], v[16:19], v[136:139], v[32:47]
  v_mul_f32 v74, s52, v74
  v_mul_f32 v75, s52, v75
  v_cvt_pk_bf16_f32 v73, v74, v75
  v_mfma_f32_32x32x16_bf16 v[48:63], v[16:19], v[200:203], v[48:63]
  v_mul_f32 v76, s52, v76
  v_mul_f32 v77, s52, v77
  ds_read_b128 v[16:19], v8 offset:256
  s_waitcnt lgkmcnt(3)
  v_mfma_f32_32x32x16_bf16 v[32:47], v[20:23], v[140:143], v[32:47]
  s_add_u32 s22, s48, 2048
  buffer_load_dwordx4 a[232:235], v2, s[8:11], s22 offen sc1
  v_cvt_pk_bf16_f32 v74, v76, v77
  v_mul_f32 v78, s52, v78
  v_mul_f32 v79, s52, v79
  v_mfma_f32_32x32x16_bf16 v[48:63], v[20:23], v[204:207], v[48:63]
  v_cvt_pk_bf16_f32 v75, v78, v79
  v_permlane16_swap_b32 v64, v72
  ds_read_b128 v[20:23], v9 offset:256
  s_waitcnt lgkmcnt(3)
  v_mfma_f32_32x32x16_bf16 v[32:47], v[24:27], v[144:147], v[32:47]
  v_permlane16_swap_b32 v65, v73
  v_permlane16_swap_b32 v66, v74
  v_permlane16_swap_b32 v67, v75
  v_mfma_f32_32x32x16_bf16 v[48:63], v[24:27], v[208:211], v[48:63]
  v_accvgpr_write_b32 a28, v64
  v_accvgpr_write_b32 a29, v65
  ds_read_b128 v[24:27], v10 offset:256
  s_waitcnt lgkmcnt(3)
  v_mfma_f32_32x32x16_bf16 v[32:47], v[28:31], v[148:151], v[32:47]
  s_add_u32 s22, s48, 3072
  buffer_load_dwordx4 a[236:239], v2, s[8:11], s22 offen sc1
  v_accvgpr_write_b32 a30, v66
  v_accvgpr_write_b32 a31, v67
  v_accvgpr_write_b32 a84, v72
  v_mfma_f32_32x32x16_bf16 v[48:63], v[28:31], v[212:215], v[48:63]
  v_accvgpr_write_b32 a85, v73
  v_accvgpr_write_b32 a86, v74
  ds_read_b128 v[28:31], v11 offset:256
  s_waitcnt lgkmcnt(3)
  v_mfma_f32_32x32x16_bf16 v[32:47], v[16:19], v[152:155], v[32:47]
  v_accvgpr_write_b32 a87, v75
  v_mul_f32 v80, s52, v80
  v_mul_f32 v81, s52, v81
  v_mfma_f32_32x32x16_bf16 v[48:63], v[16:19], v[216:219], v[48:63]
  v_cvt_pk_bf16_f32 v80, v80, v81
  v_mul_f32 v82, s52, v82
  ds_read_b128 v[16:19], v12 offset:256
  s_waitcnt lgkmcnt(3)
  v_mfma_f32_32x32x16_bf16 v[32:47], v[20:23], v[156:159], v[32:47]
  s_add_u32 s22, s48, 4096
  buffer_load_dwordx4 a[240:243], v2, s[8:11], s22 offen sc1
  v_mul_f32 v83, s52, v83
  v_cvt_pk_bf16_f32 v81, v82, v83
  v_mul_f32 v84, s52, v84
  v_mfma_f32_32x32x16_bf16 v[48:63], v[20:23], v[220:223], v[48:63]
  v_mul_f32 v85, s52, v85
  v_cvt_pk_bf16_f32 v82, v84, v85
  ds_read_b128 v[20:23], v13 offset:256
  s_waitcnt lgkmcnt(3)
  v_mfma_f32_32x32x16_bf16 v[32:47], v[24:27], v[160:163], v[32:47]
  v_mul_f32 v86, s52, v86
  v_mul_f32 v87, s52, v87
  v_cvt_pk_bf16_f32 v83, v86, v87
  v_mfma_f32_32x32x16_bf16 v[48:63], v[24:27], v[224:227], v[48:63]
  v_mul_f32 v88, s52, v88
  v_mul_f32 v89, s52, v89
  ds_read_b128 v[24:27], v14 offset:256
  s_waitcnt lgkmcnt(3)
  v_mfma_f32_32x32x16_bf16 v[32:47], v[28:31], v[164:167], v[32:47]
  s_add_u32 s22, s48, 5120
  buffer_load_dwordx4 a[244:247], v2, s[8:11], s22 offen sc1
  v_cvt_pk_bf16_f32 v88, v88, v89
  v_mul_f32 v90, s52, v90
  v_mul_f32 v91, s52, v91
  v_mfma_f32_32x32x16_bf16 v[48:63], v[28:31], v[228:231], v[48:63]
  v_cvt_pk_bf16_f32 v89, v90, v91
  v_mul_f32 v92, s52, v92
  ds_read_b128 v[28:31], v15 offset:256
  s_waitcnt lgkmcnt(3)
  v_mfma_f32_32x32x16_bf16 v[32:47], v[16:19], v[168:171], v[32:47]
  v_mul_f32 v93, s52, v93
  v_cvt_pk_bf16_f32 v90, v92, v93
  v_mul_f32 v94, s52, v94
  v_mfma_f32_32x32x16_bf16 v[48:63], v[16:19], v[232:235], v[48:63]
  v_mul_f32 v95, s52, v95
  v_cvt_pk_bf16_f32 v91, v94, v95
  v_xor_b32 v8, 131072, v8
  ds_read_b128 v[16:19], v8 offset:0
  s_waitcnt lgkmcnt(3)
  v_mfma_f32_32x32x16_bf16 v[32:47], v[20:23], v[172:175], v[32:47]
  s_add_u32 s22, s48, 6144
  buffer_load_dwordx4 a[248:251], v2, s[8:11], s22 offen sc1
  v_permlane16_swap_b32 v80, v88
  v_permlane16_swap_b32 v81, v89
  v_permlane16_swap_b32 v82, v90
  v_mfma_f32_32x32x16_bf16 v[48:63], v[20:23], v[236:239], v[48:63]
  v_permlane16_swap_b32 v83, v91
  v_accvgpr_write_b32 a140, v80
  v_xor_b32 v9, 131072, v9
  ds_read_b128 v[20:23], v9 offset:0
  s_waitcnt lgkmcnt(3)
  v_mfma_f32_32x32x16_bf16 v[32:47], v[24:27], v[176:179], v[32:47]
  v_accvgpr_write_b32 a141, v81
  v_accvgpr_write_b32 a142, v82
  v_accvgpr_write_b32 a143, v83
  v_mfma_f32_32x32x16_bf16 v[48:63], v[24:27], v[240:243], v[48:63]
  v_accvgpr_write_b32 a196, v88
  v_accvgpr_write_b32 a197, v89
  v_xor_b32 v10, 131072, v10
  ds_read_b128 v[24:27], v10 offset:0
  s_waitcnt lgkmcnt(3)
  v_mfma_f32_32x32x16_bf16 v[32:47], v[28:31], v[180:183], v[32:47]
  s_add_u32 s22, s48, 7168
  buffer_load_dwordx4 a[252:255], v2, s[8:11], s22 offen sc1
  v_accvgpr_write_b32 a198, v90
  v_accvgpr_write_b32 a199, v91
  v_mfma_f32_32x32x16_bf16 v[48:63], v[28:31], v[244:247], v[48:63]
  s_barrier
  v_xor_b32 v11, 131072, v11
  ds_read_b128 v[28:31], v11 offset:0
  s_waitcnt lgkmcnt(3)
  v_mfma_f32_32x32x16_bf16 v[64:79], v[16:19], v[120:123], 0
  v_mfma_f32_32x32x16_bf16 v[80:95], v[16:19], v[184:187], 0
  v_xor_b32 v12, 131072, v12
  ds_read_b128 v[16:19], v12 offset:0
  s_waitcnt lgkmcnt(3)
  v_mfma_f32_32x32x16_bf16 v[64:79], v[20:23], v[124:127], v[64:79]
  s_add_u32 s22, s48, 8192
  s_add_u32 m0, s25, 81920
  s_nop 0
  buffer_load_dwordx4 v2, s[8:11], s22 offen sc1 lds
  v_mul_f32 v32, s52, v32
  v_mul_f32 v33, s52, v33
  v_cvt_pk_bf16_f32 v32, v32, v33
  v_mfma_f32_32x32x16_bf16 v[80:95], v[20:23], v[188:191], v[80:95]
  v_mul_f32 v34, s52, v34
  v_mul_f32 v35, s52, v35
  v_xor_b32 v13, 131072, v13
  ds_read_b128 v[20:23], v13 offset:0
  s_waitcnt lgkmcnt(3)
  v_mfma_f32_32x32x16_bf16 v[64:79], v[24:27], v[128:131], v[64:79]
  v_cvt_pk_bf16_f32 v33, v34, v35
  v_mul_f32 v36, s52, v36
  v_mul_f32 v37, s52, v37
  v_mfma_f32_32x32x16_bf16 v[80:95], v[24:27], v[192:195], v[80:95]
  v_cvt_pk_bf16_f32 v34, v36, v37
  v_mul_f32 v38, s52, v38
  v_xor_b32 v14, 131072, v14
  ds_read_b128 v[24:27], v14 offset:0
  s_waitcnt lgkmcnt(3)
  v_mfma_f32_32x32x16_bf16 v[64:79], v[28:31], v[132:135], v[64:79]
  s_add_u32 s22, s48, 9216
  s_add_u32 m0, s25, 82944
  s_nop 0
  buffer_load_dwordx4 v2, s[8:11], s22 offen sc1 lds
  v_mul_f32 v39, s52, v39
  v_cvt_pk_bf16_f32 v35, v38, v39
  v_mul_f32 v40, s52, v40
  v_mfma_f32_32x32x16_bf16 v[80:95], v[28:31], v[196:199], v[80:95]
  v_mul_f32 v41, s52, v41
  v_cvt_pk_bf16_f32 v40, v40, v41
  v_xor_b32 v15, 131072, v15
  ds_read_b128 v[28:31], v15 offset:0
  s_waitcnt lgkmcnt(3)
  v_mfma_f32_32x32x16_bf16 v[64:79], v[16:19], v[136:139], v[64:79]
  buffer_load_dwordx4 v[100:103], v113, s[8:11], s28 offen sc1
  v_mul_f32 v42, s52, v42
  v_mul_f32 v43, s52, v43
  v_cvt_pk_bf16_f32 v41, v42, v43
  v_mfma_f32_32x32x16_bf16 v[80:95], v[16:19], v[200:203], v[80:95]
  v_mul_f32 v44, s52, v44
  v_mul_f32 v45, s52, v45
  ds_read_b128 v[16:19], v8 offset:256
  s_waitcnt lgkmcnt(3)
  v_mfma_f32_32x32x16_bf16 v[64:79], v[20:23], v[140:143], v[64:79]
  s_add_u32 s22, s48, 10240
  s_add_u32 m0, s25, 83968
  s_nop 0
  buffer_load_dwordx4 v2, s[8:11], s22 offen sc1 lds
  v_cvt_pk_bf16_f32 v42, v44, v45
  v_mul_f32 v46, s52, v46
  v_mul_f32 v47, s52, v47
  v_mfma_f32_32x32x16_bf16 v[80:95], v[20:23], v[204:207], v[80:95]
  v_cvt_pk_bf16_f32 v43, v46, v47
  v_permlane16_swap_b32 v32, v40
  ds_read_b128 v[20:23], v9 offset:256
  s_waitcnt lgkmcnt(3)
  v_mfma_f32_32x32x16_bf16 v[64:79], v[24:27], v[144:147], v[64:79]
  v_permlane16_swap_b32 v33, v41
  v_permlane16_swap_b32 v34, v42
  v_permlane16_swap_b32 v35, v43
  v_mfma_f32_32x32x16_bf16 v[80:95], v[24:27], v[208:211], v[80:95]
  v_accvgpr_write_b32 a32, v32
  v_accvgpr_write_b32 a33, v33
  ds_read_b128 v[24:27], v10 offset:256
  s_waitcnt lgkmcnt(3)
  v_mfma_f32_32x32x16_bf16 v[64:79], v[28:31], v[148:151], v[64:79]
  s_add_u32 s22, s48, 11264
  s_add_u32 m0, s25, 84992
  s_nop 0
  buffer_load_dwordx4 v2, s[8:11], s22 offen sc1 lds
  v_accvgpr_write_b32 a34, v34
  v_accvgpr_write_b32 a35, v35
  v_accvgpr_write_b32 a88, v40
  v_mfma_f32_32x32x16_bf16 v[80:95], v[28:31], v[212:215], v[80:95]
  v_accvgpr_write_b32 a89, v41
  v_accvgpr_write_b32 a90, v42
  ds_read_b128 v[28:31], v11 offset:256
  s_waitcnt lgkmcnt(3)
  v_mfma_f32_32x32x16_bf16 v[64:79], v[16:19], v[152:155], v[64:79]
  v_accvgpr_write_b32 a91, v43
  v_mul_f32 v48, s52, v48
  v_mul_f32 v49, s52, v49
  v_mfma_f32_32x32x16_bf16 v[80:95], v[16:19], v[216:219], v[80:95]
  v_cvt_pk_bf16_f32 v48, v48, v49
  v_mul_f32 v50, s52, v50
  ds_read_b128 v[16:19], v12 offset:256
  s_waitcnt lgkmcnt(3)
  v_mfma_f32_32x32x16_bf16 v[64:79], v[20:23], v[156:159], v[64:79]
  s_add_u32 s22, s48, 12288
  s_add_u32 m0, s25, 98304
  s_nop 0
  buffer_load_dwordx4 v2, s[8:11], s22 offen sc1 lds
  v_mul_f32 v51, s52, v51
  v_cvt_pk_bf16_f32 v49, v50, v51
  v_mul_f32 v52, s52, v52
  v_mfma_f32_32x32x16_bf16 v[80:95], v[20:23], v[220:223], v[80:95]
  v_mul_f32 v53, s52, v53
  v_cvt_pk_bf16_f32 v50, v52, v53
  ds_read_b128 v[20:23], v13 offset:256
  s_waitcnt lgkmcnt(3)
  v_mfma_f32_32x32x16_bf16 v[64:79], v[24:27], v[160:163], v[64:79]
  v_mul_f32 v54, s52, v54
  v_mul_f32 v55, s52, v55
  v_cvt_pk_bf16_f32 v51, v54, v55
  v_mfma_f32_32x32x16_bf16 v[80:95], v[24:27], v[224:227], v[80:95]
  v_mul_f32 v56, s52, v56
  v_mul_f32 v57, s52, v57
  ds_read_b128 v[24:27], v14 offset:256
  s_waitcnt lgkmcnt(3)
  v_mfma_f32_32x32x16_bf16 v[64:79], v[28:31], v[164:167], v[64:79]
  s_add_u32 s22, s48, 13312
  s_add_u32 m0, s25, 99328
  s_nop 0
  buffer_load_dwordx4 v2, s[8:11], s22 offen sc1 lds
  v_cvt_pk_bf16_f32 v56, v56, v57
  v_mul_f32 v58, s52, v58
  v_mul_f32 v59, s52, v59
  v_mfma_f32_32x32x16_bf16 v[80:95], v[28:31], v[228:231], v[80:95]
  v_cvt_pk_bf16_f32 v57, v58, v59
  v_mul_f32 v60, s52, v60
  ds_read_b128 v[28:31], v15 offset:256
  s_waitcnt lgkmcnt(3)
  v_mfma_f32_32x32x16_bf16 v[64:79], v[16:19], v[168:171], v[64:79]
  v_mul_f32 v61, s52, v61
  v_cvt_pk_bf16_f32 v58, v60, v61
  v_mul_f32 v62, s52, v62
  v_mfma_f32_32x32x16_bf16 v[80:95], v[16:19], v[232:235], v[80:95]
  v_mul_f32 v63, s52, v63
  v_cvt_pk_bf16_f32 v59, v62, v63
  ds_read_b128 v[16:19], v8 offset:16384
  s_waitcnt lgkmcnt(3)
  v_mfma_f32_32x32x16_bf16 v[64:79], v[20:23], v[172:175], v[64:79]
  v_permlane16_swap_b32 v48, v56
  v_permlane16_swap_b32 v49, v57
  v_permlane16_swap_b32 v50, v58
  v_mfma_f32_32x32x16_bf16 v[80:95], v[20:23], v[236:239], v[80:95]
  v_permlane16_swap_b32 v51, v59
  v_accvgpr_write_b32 a144, v48
  ds_read_b128 v[20:23], v9 offset:16384
  s_waitcnt lgkmcnt(3)
  v_mfma_f32_32x32x16_bf16 v[64:79], v[24:27], v[176:179], v[64:79]
  v_accvgpr_write_b32 a145, v49
  v_accvgpr_write_b32 a146, v50
  v_accvgpr_write_b32 a147, v51
  v_mfma_f32_32x32x16_bf16 v[80:95], v[24:27], v[240:243], v[80:95]
  v_accvgpr_write_b32 a200, v56
  v_accvgpr_write_b32 a201, v57
  ds_read_b128 v[24:27], v10 offset:16384
  s_waitcnt lgkmcnt(3)
  v_mfma_f32_32x32x16_bf16 v[64:79], v[28:31], v[180:183], v[64:79]
  v_accvgpr_write_b32 a202, v58
  v_accvgpr_write_b32 a203, v59
  v_mfma_f32_32x32x16_bf16 v[80:95], v[28:31], v[244:247], v[80:95]
  ds_read_b128 v[28:31], v11 offset:16384
  s_waitcnt lgkmcnt(3)
  v_mfma_f32_32x32x16_bf16 v[32:47], v[16:19], v[120:123], 0
  s_waitcnt vmcnt(4)
  v_cmp_ne_u64 vcc, s[88:89], v[100:101]
  v_cmp_ne_u64 s[54:55], s[88:89], v[102:103]
  s_add_u32 s49, s33, 14336
  v_mfma_f32_32x32x16_bf16 v[48:63], v[16:19], v[184:187], 0
  ds_read_b128 v[16:19], v12 offset:16384
  s_waitcnt lgkmcnt(3)
  v_mfma_f32_32x32x16_bf16 v[32:47], v[20:23], v[124:127], v[32:47]
  s_or_b64 vcc, vcc, s[54:55]
  s_cselect_b32 s49, 0x10000000, s49
  s_add_u32 s22, s49, 0
  s_add_u32 m0, s25, 100352
  s_nop 0
  buffer_load_dwordx4 v2, s[8:11], s22 offen sc1 lds
  v_mul_f32 v64, s52, v64
  v_mul_f32 v65, s52, v65
  v_cvt_pk_bf16_f32 v64, v64, v65
  v_mfma_f32_32x32x16_bf16 v[48:63], v[20:23], v[188:191], v[48:63]
  v_mul_f32 v66, s52, v66
  v_mul_f32 v67, s52, v67
  ds_read_b128 v[20:23], v13 offset:16384
  s_waitcnt lgkmcnt(3)
  v_mfma_f32_32x32x16_bf16 v[32:47], v[24:27], v[128:131], v[32:47]
  v_cvt_pk_bf16_f32 v65, v66, v67
  v_mul_f32 v68, s52, v68
  v_mul_f32 v69, s52, v69
  v_mfma_f32_32x32x16_bf16 v[48:63], v[24:27], v[192:195], v[48:63]
  v_cvt_pk_bf16_f32 v66, v68, v69
  v_mul_f32 v70, s52, v70
  ds_read_b128 v[24:27], v14 offset:16384
  s_waitcnt lgkmcnt(3)
  v_mfma_f32_32x32x16_bf16 v[32:47], v[28:31], v[132:135], v[32:47]
  s_add_u32 s22, s49, 1024
  s_add_u32 m0, s25, 101376
  s_nop 0
  buffer_load_dwordx4 v2, s[8:11], s22 offen sc1 lds
  v_mul_f32 v71, s52, v71
  v_cvt_pk_bf16_f32 v67, v70, v71
  v_mul_f32 v72, s52, v72
  v_mfma_f32_32x32x16_bf16 v[48:63], v[28:31], v[196:199], v[48:63]
  v_mul_f32 v73, s52, v73
  v_cvt_pk_bf16_f32 v72, v72, v73
  ds_read_b128 v[28:31], v15 offset:16384
  s_waitcnt lgkmcnt(3)
  v_mfma_f32_32x32x16_bf16 v[32:47], v[16:19], v[136:139], v[32:47]
  v_mul_f32 v74, s52, v74
  v_mul_f32 v75, s52, v75
  v_cvt_pk_bf16_f32 v73, v74, v75
  v_mfma_f32_32x32x16_bf16 v[48:63], v[16:19], v[200:203], v[48:63]
  v_mul_f32 v76, s52, v76
  v_mul_f32 v77, s52, v77
  ds_read_b128 v[16:19], v8 offset:16640
  s_waitcnt lgkmcnt(3)
  v_mfma_f32_32x32x16_bf16 v[32:47], v[20:23], v[140:143], v[32:47]
  s_add_u32 s22, s49, 2048
  s_add_u32 m0, s25, 147456
  s_nop 0
  buffer_load_dwordx4 v2, s[8:11], s22 offen sc1 lds
  v_cvt_pk_bf16_f32 v74, v76, v77
  v_mul_f32 v78, s52, v78
  v_mul_f32 v79, s52, v79
  v_mfma_f32_32x32x16_bf16 v[48:63], v[20:23], v[204:207], v[48:63]
  v_cvt_pk_bf16_f32 v75, v78, v79
  v_permlane16_swap_b32 v64, v72
  ds_read_b128 v[20:23], v9 offset:16640
  s_waitcnt lgkmcnt(3)
  v_mfma_f32_32x32x16_bf16 v[32:47], v[24:27], v[144:147], v[32:47]
  v_permlane16_swap_b32 v65, v73
  v_permlane16_swap_b32 v66, v74
  v_permlane16_swap_b32 v67, v75
  v_mfma_f32_32x32x16_bf16 v[48:63], v[24:27], v[208:211], v[48:63]
  v_accvgpr_write_b32 a36, v64
  v_accvgpr_write_b32 a37, v65
  ds_read_b128 v[24:27], v10 offset:16640
  s_waitcnt lgkmcnt(3)
  v_mfma_f32_32x32x16_bf16 v[32:47], v[28:31], v[148:151], v[32:47]
  s_add_u32 s22, s49, 3072
  s_add_u32 m0, s25, 148480
  s_nop 0
  buffer_load_dwordx4 v2, s[8:11], s22 offen sc1 lds
  v_accvgpr_write_b32 a38, v66
  v_accvgpr_write_b32 a39, v67
  v_accvgpr_write_b32 a92, v72
  v_mfma_f32_32x32x16_bf16 v[48:63], v[28:31], v[212:215], v[48:63]
  v_accvgpr_write_b32 a93, v73
  v_accvgpr_write_b32 a94, v74
  ds_read_b128 v[28:31], v11 offset:16640
  s_waitcnt lgkmcnt(3)
  v_mfma_f32_32x32x16_bf16 v[32:47], v[16:19], v[152:155], v[32:47]
  v_accvgpr_write_b32 a95, v75
  v_mul_f32 v80, s52, v80
  v_mul_f32 v81, s52, v81
  v_mfma_f32_32x32x16_bf16 v[48:63], v[16:19], v[216:219], v[48:63]
  v_cvt_pk_bf16_f32 v80, v80, v81
  v_mul_f32 v82, s52, v82
  ds_read_b128 v[16:19], v12 offset:16640
  s_waitcnt lgkmcnt(3)
  v_mfma_f32_32x32x16_bf16 v[32:47], v[20:23], v[156:159], v[32:47]
  s_add_u32 s22, s49, 4096
  s_add_u32 m0, s25, 149504
  s_nop 0
  buffer_load_dwordx4 v2, s[8:11], s22 offen sc1 lds
  v_mul_f32 v83, s52, v83
  v_cvt_pk_bf16_f32 v81, v82, v83
  v_mul_f32 v84, s52, v84
  v_mfma_f32_32x32x16_bf16 v[48:63], v[20:23], v[220:223], v[48:63]
  v_mul_f32 v85, s52, v85
  v_cvt_pk_bf16_f32 v82, v84, v85
  ds_read_b128 v[20:23], v13 offset:16640
  s_waitcnt lgkmcnt(3)
  v_mfma_f32_32x32x16_bf16 v[32:47], v[24:27], v[160:163], v[32:47]
  v_mul_f32 v86, s52, v86
  v_mul_f32 v87, s52, v87
  v_cvt_pk_bf16_f32 v83, v86, v87
  v_mfma_f32_32x32x16_bf16 v[48:63], v[24:27], v[224:227], v[48:63]
  v_mul_f32 v88, s52, v88
  v_mul_f32 v89, s52, v89
  ds_read_b128 v[24:27], v14 offset:16640
  s_waitcnt lgkmcnt(3)
  v_mfma_f32_32x32x16_bf16 v[32:47], v[28:31], v[164:167], v[32:47]
  s_add_u32 s22, s49, 5120
  s_add_u32 m0, s25, 150528
  s_nop 0
  buffer_load_dwordx4 v2, s[8:11], s22 offen sc1 lds
  v_cvt_pk_bf16_f32 v88, v88, v89
  v_mul_f32 v90, s52, v90
  v_mul_f32 v91, s52, v91
  v_mfma_f32_32x32x16_bf16 v[48:63], v[28:31], v[228:231], v[48:63]
  v_cvt_pk_bf16_f32 v89, v90, v91
  v_mul_f32 v92, s52, v92
  ds_read_b128 v[28:31], v15 offset:16640
  s_waitcnt lgkmcnt(3)
  v_mfma_f32_32x32x16_bf16 v[32:47], v[16:19], v[168:171], v[32:47]
  v_mul_f32 v93, s52, v93
  v_cvt_pk_bf16_f32 v90, v92, v93
  v_mul_f32 v94, s52, v94
  v_mfma_f32_32x32x16_bf16 v[48:63], v[16:19], v[232:235], v[48:63]
  v_mul_f32 v95, s52, v95
  v_cvt_pk_bf16_f32 v91, v94, v95
  ds_read_b128 v[16:19], v8 offset:32768
  s_waitcnt lgkmcnt(3)
  v_mfma_f32_32x32x16_bf16 v[32:47], v[20:23], v[172:175], v[32:47]
  s_add_u32 s22, s49, 6144
  s_add_u32 m0, s25, 114688
  s_nop 0
  buffer_load_dwordx4 v2, s[8:11], s22 offen sc1 lds
  v_permlane16_swap_b32 v80, v88
  v_permlane16_swap_b32 v81, v89
  v_permlane16_swap_b32 v82, v90
  v_mfma_f32_32x32x16_bf16 v[48:63], v[20:23], v[236:239], v[48:63]
  v_permlane16_swap_b32 v83, v91
  v_accvgpr_write_b32 a148, v80
  ds_read_b128 v[20:23], v9 offset:32768
  s_waitcnt lgkmcnt(3)
  v_mfma_f32_32x32x16_bf16 v[32:47], v[24:27], v[176:179], v[32:47]
  v_accvgpr_write_b32 a149, v81
  v_accvgpr_write_b32 a150, v82
  v_accvgpr_write_b32 a151, v83
  v_mfma_f32_32x32x16_bf16 v[48:63], v[24:27], v[240:243], v[48:63]
  v_accvgpr_write_b32 a204, v88
  v_accvgpr_write_b32 a205, v89
  ds_read_b128 v[24:27], v10 offset:32768
  s_waitcnt lgkmcnt(3)
  v_mfma_f32_32x32x16_bf16 v[32:47], v[28:31], v[180:183], v[32:47]
  s_add_u32 s22, s49, 7168
  s_add_u32 m0, s25, 115712
  s_nop 0
  buffer_load_dwordx4 v2, s[8:11], s22 offen sc1 lds
  v_accvgpr_write_b32 a206, v90
  v_accvgpr_write_b32 a207, v91
  v_mfma_f32_32x32x16_bf16 v[48:63], v[28:31], v[244:247], v[48:63]
  s_barrier
  ds_read_b128 v[28:31], v11 offset:32768
  s_waitcnt lgkmcnt(3)
  v_mfma_f32_32x32x16_bf16 v[64:79], v[16:19], v[120:123], 0
  v_mfma_f32_32x32x16_bf16 v[80:95], v[16:19], v[184:187], 0
  ds_read_b128 v[16:19], v12 offset:32768
  s_waitcnt lgkmcnt(3)
  v_mfma_f32_32x32x16_bf16 v[64:79], v[20:23], v[124:127], v[64:79]
  s_add_u32 s22, s49, 8192
  s_add_u32 m0, s25, 116736
  s_nop 0
  buffer_load_dwordx4 v2, s[8:11], s22 offen sc1 lds
  v_mul_f32 v32, s52, v32
  v_mul_f32 v33, s52, v33
  v_cvt_pk_bf16_f32 v32, v32, v33
  v_mfma_f32_32x32x16_bf16 v[80:95], v[20:23], v[188:191], v[80:95]
  v_mul_f32 v34, s52, v34
  v_mul_f32 v35, s52, v35
  ds_read_b128 v[20:23], v13 offset:32768
  s_waitcnt lgkmcnt(3)
  v_mfma_f32_32x32x16_bf16 v[64:79], v[24:27], v[128:131], v[64:79]
  v_cvt_pk_bf16_f32 v33, v34, v35
  v_mul_f32 v36, s52, v36
  v_mul_f32 v37, s52, v37
  v_mfma_f32_32x32x16_bf16 v[80:95], v[24:27], v[192:195], v[80:95]
  v_cvt_pk_bf16_f32 v34, v36, v37
  v_mul_f32 v38, s52, v38
  ds_read_b128 v[24:27], v14 offset:32768
  s_waitcnt lgkmcnt(3)
  v_mfma_f32_32x32x16_bf16 v[64:79], v[28:31], v[132:135], v[64:79]
  s_add_u32 s22, s49, 9216
  s_add_u32 m0, s25, 117760
  s_nop 0
  buffer_load_dwordx4 v2, s[8:11], s22 offen sc1 lds
  v_mul_f32 v39, s52, v39
  v_cvt_pk_bf16_f32 v35, v38, v39
  v_mul_f32 v40, s52, v40
  v_mfma_f32_32x32x16_bf16 v[80:95], v[28:31], v[196:199], v[80:95]
  v_mul_f32 v41, s52, v41
  v_cvt_pk_bf16_f32 v40, v40, v41
  ds_read_b128 v[28:31], v15 offset:32768
  s_waitcnt lgkmcnt(3)
  v_mfma_f32_32x32x16_bf16 v[64:79], v[16:19], v[136:139], v[64:79]
  buffer_load_dwordx4 v[100:103], v113, s[8:11], s28 offen sc1
  v_mul_f32 v42, s52, v42
  v_mul_f32 v43, s52, v43
  v_cvt_pk_bf16_f32 v41, v42, v43
  v_mfma_f32_32x32x16_bf16 v[80:95], v[16:19], v[200:203], v[80:95]
  v_mul_f32 v44, s52, v44
  v_mul_f32 v45, s52, v45
  ds_read_b128 v[16:19], v8 offset:33024
  s_waitcnt lgkmcnt(3)
  v_mfma_f32_32x32x16_bf16 v[64:79], v[20:23], v[140:143], v[64:79]
  s_add_u32 s22, s49, 10240
  s_add_u32 m0, s25, 131072
  s_nop 0
  buffer_load_dwordx4 v2, s[8:11], s22 offen sc1 lds
  v_cvt_pk_bf16_f32 v42, v44, v45
  v_mul_f32 v46, s52, v46
  v_mul_f32 v47, s52, v47
  v_mfma_f32_32x32x16_bf16 v[80:95], v[20:23], v[204:207], v[80:95]
  v_cvt_pk_bf16_f32 v43, v46, v47
  v_permlane16_swap_b32 v32, v40
  ds_read_b128 v[20:23], v9 offset:33024
  s_waitcnt lgkmcnt(3)
  v_mfma_f32_32x32x16_bf16 v[64:79], v[24:27], v[144:147], v[64:79]
  v_permlane16_swap_b32 v33, v41
  v_permlane16_swap_b32 v34, v42
  v_permlane16_swap_b32 v35, v43
  v_mfma_f32_32x32x16_bf16 v[80:95], v[24:27], v[208:211], v[80:95]
  v_accvgpr_write_b32 a40, v32
  v_accvgpr_write_b32 a41, v33
  ds_read_b128 v[24:27], v10 offset:33024
  s_waitcnt lgkmcnt(3)
  v_mfma_f32_32x32x16_bf16 v[64:79], v[28:31], v[148:151], v[64:79]
  s_add_u32 s22, s49, 11264
  s_add_u32 m0, s25, 132096
  s_nop 0
  buffer_load_dwordx4 v2, s[8:11], s22 offen sc1 lds
  v_accvgpr_write_b32 a42, v34
  v_accvgpr_write_b32 a43, v35
  v_accvgpr_write_b32 a96, v40
  v_mfma_f32_32x32x16_bf16 v[80:95], v[28:31], v[212:215], v[80:95]
  v_accvgpr_write_b32 a97, v41
  v_accvgpr_write_b32 a98, v42
  ds_read_b128 v[28:31], v11 offset:33024
  s_waitcnt lgkmcnt(3)
  v_mfma_f32_32x32x16_bf16 v[64:79], v[16:19], v[152:155], v[64:79]
  v_accvgpr_write_b32 a99, v43
  v_mul_f32 v48, s52, v48
  v_mul_f32 v49, s52, v49
  v_mfma_f32_32x32x16_bf16 v[80:95], v[16:19], v[216:219], v[80:95]
  v_cvt_pk_bf16_f32 v48, v48, v49
  v_mul_f32 v50, s52, v50
  ds_read_b128 v[16:19], v12 offset:33024
  s_waitcnt lgkmcnt(3)
  v_mfma_f32_32x32x16_bf16 v[64:79], v[20:23], v[156:159], v[64:79]
  s_add_u32 s22, s49, 12288
  s_add_u32 m0, s25, 133120
  s_nop 0
  buffer_load_dwordx4 v2, s[8:11], s22 offen sc1 lds
  v_mul_f32 v51, s52, v51
  v_cvt_pk_bf16_f32 v49, v50, v51
  v_mul_f32 v52, s52, v52
  v_mfma_f32_32x32x16_bf16 v[80:95], v[20:23], v[220:223], v[80:95]
  v_mul_f32 v53, s52, v53
  v_cvt_pk_bf16_f32 v50, v52, v53
  ds_read_b128 v[20:23], v13 offset:33024
  s_waitcnt lgkmcnt(3)
  v_mfma_f32_32x32x16_bf16 v[64:79], v[24:27], v[160:163], v[64:79]
  v_mul_f32 v54, s52, v54
  v_mul_f32 v55, s52, v55
  v_cvt_pk_bf16_f32 v51, v54, v55
  v_mfma_f32_32x32x16_bf16 v[80:95], v[24:27], v[224:227], v[80:95]
  v_mul_f32 v56, s52, v56
  v_mul_f32 v57, s52, v57
  ds_read_b128 v[24:27], v14 offset:33024
  s_waitcnt lgkmcnt(3)
  v_mfma_f32_32x32x16_bf16 v[64:79], v[28:31], v[164:167], v[64:79]
  s_add_u32 s22, s49, 13312
  s_add_u32 m0, s25, 134144
  s_nop 0
  buffer_load_dwordx4 v2, s[8:11], s22 offen sc1 lds
  v_cvt_pk_bf16_f32 v56, v56, v57
  v_mul_f32 v58, s52, v58
  v_mul_f32 v59, s52, v59
  v_mfma_f32_32x32x16_bf16 v[80:95], v[28:31], v[228:231], v[80:95]
  v_cvt_pk_bf16_f32 v57, v58, v59
  v_mul_f32 v60, s52, v60
  ds_read_b128 v[28:31], v15 offset:33024
  s_waitcnt lgkmcnt(3)
  v_mfma_f32_32x32x16_bf16 v[64:79], v[16:19], v[168:171], v[64:79]
  v_mul_f32 v61, s52, v61
  v_cvt_pk_bf16_f32 v58, v60, v61
  v_mul_f32 v62, s52, v62
  v_mfma_f32_32x32x16_bf16 v[80:95], v[16:19], v[232:235], v[80:95]
  v_mul_f32 v63, s52, v63
  v_cvt_pk_bf16_f32 v59, v62, v63
  ds_read_b128 v[16:19], v8 offset:49152
  s_waitcnt lgkmcnt(3)
  v_mfma_f32_32x32x16_bf16 v[64:79], v[20:23], v[172:175], v[64:79]
  v_permlane16_swap_b32 v48, v56
  v_permlane16_swap_b32 v49, v57
  v_permlane16_swap_b32 v50, v58
  v_mfma_f32_32x32x16_bf16 v[80:95], v[20:23], v[236:239], v[80:95]
  v_permlane16_swap_b32 v51, v59
  v_accvgpr_write_b32 a152, v48
  ds_read_b128 v[20:23], v9 offset:49152
  s_waitcnt lgkmcnt(3)
  v_mfma_f32_32x32x16_bf16 v[64:79], v[24:27], v[176:179], v[64:79]
  v_accvgpr_write_b32 a153, v49
  v_accvgpr_write_b32 a154, v50
  v_accvgpr_write_b32 a155, v51
  v_mfma_f32_32x32x16_bf16 v[80:95], v[24:27], v[240:243], v[80:95]
  v_accvgpr_write_b32 a208, v56
  v_accvgpr_write_b32 a209, v57
  ds_read_b128 v[24:27], v10 offset:49152
  s_waitcnt lgkmcnt(3)
  v_mfma_f32_32x32x16_bf16 v[64:79], v[28:31], v[180:183], v[64:79]
  v_accvgpr_write_b32 a210, v58
  v_accvgpr_write_b32 a211, v59
  v_mfma_f32_32x32x16_bf16 v[80:95], v[28:31], v[244:247], v[80:95]
  ds_read_b128 v[28:31], v11 offset:49152
  s_waitcnt lgkmcnt(3)
  v_mfma_f32_32x32x16_bf16 v[32:47], v[16:19], v[120:123], 0
  s_waitcnt vmcnt(4)
  v_cmp_ne_u64 vcc, s[88:89], v[100:101]
  v_cmp_ne_u64 s[54:55], s[88:89], v[102:103]
  s_add_u32 s50, s32, 0
  v_mfma_f32_32x32x16_bf16 v[48:63], v[16:19], v[184:187], 0
  ds_read_b128 v[16:19], v12 offset:49152
  s_waitcnt lgkmcnt(3)
  v_mfma_f32_32x32x16_bf16 v[32:47], v[20:23], v[124:127], v[32:47]
  s_or_b64 vcc, vcc, s[54:55]
  s_cselect_b32 s50, 0x10000000, s50
  s_add_u32 s22, s50, 12288
  buffer_load_dwordx4 v[248:251], v2, s[8:11], s22 offen sc1
  v_mul_f32 v64, s52, v64
  v_mul_f32 v65, s52, v65
  v_cvt_pk_bf16_f32 v64, v64, v65
  v_mfma_f32_32x32x16_bf16 v[48:63], v[20:23], v[188:191], v[48:63]
  v_mul_f32 v66, s52, v66
  v_mul_f32 v67, s52, v67
  ds_read_b128 v[20:23], v13 offset:49152
  s_waitcnt lgkmcnt(3)
  v_mfma_f32_32x32x16_bf16 v[32:47], v[24:27], v[128:131], v[32:47]
  s_add_u32 s22, s50, 13312
  buffer_load_dwordx4 v[252:255], v2, s[8:11], s22 offen sc1
  v_cvt_pk_bf16_f32 v65, v66, v67
  v_mul_f32 v68, s52, v68
  v_mul_f32 v69, s52, v69
  v_mfma_f32_32x32x16_bf16 v[48:63], v[24:27], v[192:195], v[48:63]
  v_cvt_pk_bf16_f32 v66, v68, v69
  v_mul_f32 v70, s52, v70
  ds_read_b128 v[24:27], v14 offset:49152
  s_waitcnt lgkmcnt(3)
  v_mfma_f32_32x32x16_bf16 v[32:47], v[28:31], v[132:135], v[32:47]
  s_add_u32 s22, s50, 0
  s_add_u32 m0, s25, 0
  s_nop 0
  buffer_load_dwordx4 v2, s[8:11], s22 offen sc1 lds
  v_mul_f32 v71, s52, v71
  v_cvt_pk_bf16_f32 v67, v70, v71
  v_mul_f32 v72, s52, v72
  v_mfma_f32_32x32x16_bf16 v[48:63], v[28:31], v[196:199], v[48:63]
  v_mul_f32 v73, s52, v73
  v_cvt_pk_bf16_f32 v72, v72, v73
  ds_read_b128 v[28:31], v15 offset:49152
  s_waitcnt lgkmcnt(3)
  v_mfma_f32_32x32x16_bf16 v[32:47], v[16:19], v[136:139], v[32:47]
  s_add_u32 s22, s50, 1024
  s_add_u32 m0, s25, 1024
  s_nop 0
  buffer_load_dwordx4 v2, s[8:11], s22 offen sc1 lds
  v_mul_f32 v74, s52, v74
  v_mul_f32 v75, s52, v75
  v_cvt_pk_bf16_f32 v73, v74, v75
  v_mfma_f32_32x32x16_bf16 v[48:63], v[16:19], v[200:203], v[48:63]
  v_mul_f32 v76, s52, v76
  v_mul_f32 v77, s52, v77
  ds_read_b128 v[16:19], v8 offset:49408
  s_waitcnt lgkmcnt(3)
  v_mfma_f32_32x32x16_bf16 v[32:47], v[20:23], v[140:143], v[32:47]
  s_add_u32 s22, s50, 2048
  s_add_u32 m0, s25, 2048
  s_nop 0
  buffer_load_dwordx4 v2, s[8:11], s22 offen sc1 lds
  v_cvt_pk_bf16_f32 v74, v76, v77
  v_mul_f32 v78, s52, v78
  v_mul_f32 v79, s52, v79
  v_mfma_f32_32x32x16_bf16 v[48:63], v[20:23], v[204:207], v[48:63]
  v_cvt_pk_bf16_f32 v75, v78, v79
  v_permlane16_swap_b32 v64, v72
  ds_read_b128 v[20:23], v9 offset:49408
  s_waitcnt lgkmcnt(3)
  v_mfma_f32_32x32x16_bf16 v[32:47], v[24:27], v[144:147], v[32:47]
  s_add_u32 s22, s50, 3072
  s_add_u32 m0, s25, 3072
  s_nop 0
  buffer_load_dwordx4 v2, s[8:11], s22 offen sc1 lds
  v_permlane16_swap_b32 v65, v73
  v_permlane16_swap_b32 v66, v74
  v_permlane16_swap_b32 v67, v75
  v_mfma_f32_32x32x16_bf16 v[48:63], v[24:27], v[208:211], v[48:63]
  v_accvgpr_write_b32 a44, v64
  v_accvgpr_write_b32 a45, v65
  ds_read_b128 v[24:27], v10 offset:49408
  s_waitcnt lgkmcnt(3)
  v_mfma_f32_32x32x16_bf16 v[32:47], v[28:31], v[148:151], v[32:47]
  s_add_u32 s22, s50, 4096
  s_add_u32 m0, s25, 16384
  s_nop 0
  buffer_load_dwordx4 v2, s[8:11], s22 offen sc1 lds
  v_accvgpr_write_b32 a46, v66
  v_accvgpr_write_b32 a47, v67
  v_accvgpr_write_b32 a100, v72
  v_mfma_f32_32x32x16_bf16 v[48:63], v[28:31], v[212:215], v[48:63]
  v_accvgpr_write_b32 a101, v73
  v_accvgpr_write_b32 a102, v74
  ds_read_b128 v[28:31], v11 offset:49408
  s_waitcnt lgkmcnt(3)
  v_mfma_f32_32x32x16_bf16 v[32:47], v[16:19], v[152:155], v[32:47]
  s_add_u32 s22, s50, 5120
  s_add_u32 m0, s25, 17408
  s_nop 0
  buffer_load_dwordx4 v2, s[8:11], s22 offen sc1 lds
  v_accvgpr_write_b32 a103, v75
  v_mul_f32 v80, s52, v80
  v_mul_f32 v81, s52, v81
  v_mfma_f32_32x32x16_bf16 v[48:63], v[16:19], v[216:219], v[48:63]
  v_cvt_pk_bf16_f32 v80, v80, v81
  v_mul_f32 v82, s52, v82
  ds_read_b128 v[16:19], v12 offset:49408
  s_waitcnt lgkmcnt(3)
  v_mfma_f32_32x32x16_bf16 v[32:47], v[20:23], v[156:159], v[32:47]
  s_add_u32 s22, s50, 6144
  s_add_u32 m0, s25, 18432
  s_nop 0
  buffer_load_dwordx4 v2, s[8:11], s22 offen sc1 lds
  v_mul_f32 v83, s52, v83
  v_cvt_pk_bf16_f32 v81, v82, v83
  v_mul_f32 v84, s52, v84
  v_mfma_f32_32x32x16_bf16 v[48:63], v[20:23], v[220:223], v[48:63]
  v_mul_f32 v85, s52, v85
  v_cvt_pk_bf16_f32 v82, v84, v85
  ds_read_b128 v[20:23], v13 offset:49408
  s_waitcnt lgkmcnt(3)
  v_mfma_f32_32x32x16_bf16 v[32:47], v[24:27], v[160:163], v[32:47]
  s_add_u32 s22, s50, 7168
  s_add_u32 m0, s25, 19456
  s_nop 0
  buffer_load_dwordx4 v2, s[8:11], s22 offen sc1 lds
  v_mul_f32 v86, s52, v86
  v_mul_f32 v87, s52, v87
  v_cvt_pk_bf16_f32 v83, v86, v87
  v_mfma_f32_32x32x16_bf16 v[48:63], v[24:27], v[224:227], v[48:63]
  v_mul_f32 v88, s52, v88
  v_mul_f32 v89, s52, v89
  ds_read_b128 v[24:27], v14 offset:49408
  s_waitcnt lgkmcnt(3)
  v_mfma_f32_32x32x16_bf16 v[32:47], v[28:31], v[164:167], v[32:47]
  v_cvt_pk_bf16_f32 v88, v88, v89
  v_mul_f32 v90, s52, v90
  v_mul_f32 v91, s52, v91
  v_mfma_f32_32x32x16_bf16 v[48:63], v[28:31], v[228:231], v[48:63]
  v_cvt_pk_bf16_f32 v89, v90, v91
  v_mul_f32 v92, s52, v92
  ds_read_b128 v[28:31], v15 offset:49408
  s_waitcnt lgkmcnt(3)
  v_mfma_f32_32x32x16_bf16 v[32:47], v[16:19], v[168:171], v[32:47]
  v_mul_f32 v93, s52, v93
  v_cvt_pk_bf16_f32 v90, v92, v93
  v_mul_f32 v94, s52, v94
  v_mfma_f32_32x32x16_bf16 v[48:63], v[16:19], v[232:235], v[48:63]
  v_mul_f32 v95, s52, v95
  v_cvt_pk_bf16_f32 v91, v94, v95
  v_xor_b32 v8, 65536, v8
  ds_read_b128 v[16:19], v8 offset:0
  s_waitcnt lgkmcnt(3)
  v_mfma_f32_32x32x16_bf16 v[32:47], v[20:23], v[172:175], v[32:47]
  v_permlane16_swap_b32 v80, v88
  v_permlane16_swap_b32 v81, v89
  v_permlane16_swap_b32 v82, v90
  v_mfma_f32_32x32x16_bf16 v[48:63], v[20:23], v[236:239], v[48:63]
  v_permlane16_swap_b32 v83, v91
  v_accvgpr_write_b32 a156, v80
  v_xor_b32 v9, 65536, v9
  ds_read_b128 v[20:23], v9 offset:0
  s_waitcnt lgkmcnt(3)
  v_mfma_f32_32x32x16_bf16 v[32:47], v[24:27], v[176:179], v[32:47]
  v_accvgpr_write_b32 a157, v81
  v_accvgpr_write_b32 a158, v82
  v_accvgpr_write_b32 a159, v83
  v_mfma_f32_32x32x16_bf16 v[48:63], v[24:27], v[240:243], v[48:63]
  v_accvgpr_write_b32 a212, v88
  v_accvgpr_write_b32 a213, v89
  v_xor_b32 v10, 65536, v10
  ds_read_b128 v[24:27], v10 offset:0
  s_waitcnt lgkmcnt(3)
  v_mfma_f32_32x32x16_bf16 v[32:47], v[28:31], v[180:183], v[32:47]
  v_accvgpr_write_b32 a214, v90
  v_accvgpr_write_b32 a215, v91
  v_mfma_f32_32x32x16_bf16 v[48:63], v[28:31], v[244:247], v[48:63]
  s_barrier
  v_xor_b32 v11, 65536, v11
  ds_read_b128 v[28:31], v11 offset:0
  s_waitcnt lgkmcnt(3)
  v_mfma_f32_32x32x16_bf16 v[64:79], v[16:19], v[120:123], 0
  s_add_u32 s22, s50, 8192
  s_add_u32 m0, s25, 32768
  s_nop 0
  buffer_load_dwordx4 v2, s[8:11], s22 offen sc1 lds
  v_mfma_f32_32x32x16_bf16 v[80:95], v[16:19], v[184:187], 0
  v_xor_b32 v12, 65536, v12
  ds_read_b128 v[16:19], v12 offset:0
  s_waitcnt lgkmcnt(3)
  v_mfma_f32_32x32x16_bf16 v[64:79], v[20:23], v[124:127], v[64:79]
  s_add_u32 s22, s50, 9216
  s_add_u32 m0, s25, 33792
  s_nop 0
  buffer_load_dwordx4 v2, s[8:11], s22 offen sc1 lds
  v_mul_f32 v32, s52, v32
  v_mul_f32 v33, s52, v33
  v_cvt_pk_bf16_f32 v32, v32, v33
  v_mfma_f32_32x32x16_bf16 v[80:95], v[20:23], v[188:191], v[80:95]
  v_mul_f32 v34, s52, v34
  v_mul_f32 v35, s52, v35
  v_xor_b32 v13, 65536, v13
  ds_read_b128 v[20:23], v13 offset:0
  s_waitcnt lgkmcnt(3)
  v_mfma_f32_32x32x16_bf16 v[64:79], v[24:27], v[128:131], v[64:79]
  s_add_u32 s22, s50, 10240
  s_add_u32 m0, s25, 34816
  s_nop 0
  buffer_load_dwordx4 v2, s[8:11], s22 offen sc1 lds
  v_cvt_pk_bf16_f32 v33, v34, v35
  v_mul_f32 v36, s52, v36
  v_mul_f32 v37, s52, v37
  v_mfma_f32_32x32x16_bf16 v[80:95], v[24:27], v[192:195], v[80:95]
  v_cvt_pk_bf16_f32 v34, v36, v37
  v_mul_f32 v38, s52, v38
  v_xor_b32 v14, 65536, v14
  ds_read_b128 v[24:27], v14 offset:0
  s_waitcnt lgkmcnt(3)
  v_mfma_f32_32x32x16_bf16 v[64:79], v[28:31], v[132:135], v[64:79]
  s_add_u32 s22, s50, 11264
  s_add_u32 m0, s25, 35840
  s_nop 0
  buffer_load_dwordx4 v2, s[8:11], s22 offen sc1 lds
  v_mul_f32 v39, s52, v39
  v_cvt_pk_bf16_f32 v35, v38, v39
  v_mul_f32 v40, s52, v40
  v_mfma_f32_32x32x16_bf16 v[80:95], v[28:31], v[196:199], v[80:95]
  v_mul_f32 v41, s52, v41
  v_cvt_pk_bf16_f32 v40, v40, v41
  v_xor_b32 v15, 65536, v15
  ds_read_b128 v[28:31], v15 offset:0
  s_waitcnt lgkmcnt(3)
  v_mfma_f32_32x32x16_bf16 v[64:79], v[16:19], v[136:139], v[64:79]
  buffer_load_dwordx4 v[100:103], v113, s[8:11], s28 offen sc1
  buffer_load_dwordx4 v[104:107], v2, s[8:11], s29 offen sc1
  buffer_load_dwordx4 v[108:111], v112, s[8:11], s29 offen sc1
  v_mul_f32 v42, s52, v42
  v_mul_f32 v43, s52, v43
  v_cvt_pk_bf16_f32 v41, v42, v43
  v_mfma_f32_32x32x16_bf16 v[80:95], v[16:19], v[200:203], v[80:95]
  v_mul_f32 v44, s52, v44
  v_mul_f32 v45, s52, v45
  ds_read_b128 v[16:19], v8 offset:256
  s_waitcnt lgkmcnt(3)
  v_mfma_f32_32x32x16_bf16 v[64:79], v[20:23], v[140:143], v[64:79]
  v_cvt_pk_bf16_f32 v42, v44, v45
  v_mul_f32 v46, s52, v46
  v_mul_f32 v47, s52, v47
  v_mfma_f32_32x32x16_bf16 v[80:95], v[20:23], v[204:207], v[80:95]
  v_cvt_pk_bf16_f32 v43, v46, v47
  v_permlane16_swap_b32 v32, v40
  ds_read_b128 v[20:23], v9 offset:256
  s_waitcnt lgkmcnt(3)
  v_mfma_f32_32x32x16_bf16 v[64:79], v[24:27], v[144:147], v[64:79]
  v_permlane16_swap_b32 v33, v41
  v_permlane16_swap_b32 v34, v42
  v_permlane16_swap_b32 v35, v43
  v_mfma_f32_32x32x16_bf16 v[80:95], v[24:27], v[208:211], v[80:95]
  v_accvgpr_write_b32 a48, v32
  v_accvgpr_write_b32 a49, v33
  ds_read_b128 v[24:27], v10 offset:256
  s_waitcnt lgkmcnt(3)
  v_mfma_f32_32x32x16_bf16 v[64:79], v[28:31], v[148:151], v[64:79]
  v_accvgpr_write_b32 a50, v34
  v_accvgpr_write_b32 a51, v35
  v_accvgpr_write_b32 a104, v40
  v_mfma_f32_32x32x16_bf16 v[80:95], v[28:31], v[212:215], v[80:95]
  v_accvgpr_write_b32 a105, v41
  v_accvgpr_write_b32 a106, v42
  ds_read_b128 v[28:31], v11 offset:256
  s_waitcnt lgkmcnt(3)
  v_mfma_f32_32x32x16_bf16 v[64:79], v[16:19], v[152:155], v[64:79]
  v_accvgpr_write_b32 a107, v43
  v_mul_f32 v48, s52, v48
  v_mul_f32 v49, s52, v49
  v_mfma_f32_32x32x16_bf16 v[80:95], v[16:19], v[216:219], v[80:95]
  v_cvt_pk_bf16_f32 v48, v48, v49
  v_mul_f32 v50, s52, v50
  ds_read_b128 v[16:19], v12 offset:256
  s_waitcnt lgkmcnt(3)
  v_mfma_f32_32x32x16_bf16 v[64:79], v[20:23], v[156:159], v[64:79]
  v_mul_f32 v51, s52, v51
  v_cvt_pk_bf16_f32 v49, v50, v51
  v_mul_f32 v52, s52, v52
  v_mfma_f32_32x32x16_bf16 v[80:95], v[20:23], v[220:223], v[80:95]
  v_mul_f32 v53, s52, v53
  v_cvt_pk_bf16_f32 v50, v52, v53
  ds_read_b128 v[20:23], v13 offset:256
  s_waitcnt lgkmcnt(3)
  v_mfma_f32_32x32x16_bf16 v[64:79], v[24:27], v[160:163], v[64:79]
  v_mul_f32 v54, s52, v54
  v_mul_f32 v55, s52, v55
  v_cvt_pk_bf16_f32 v51, v54, v55
  v_mfma_f32_32x32x16_bf16 v[80:95], v[24:27], v[224:227], v[80:95]
  v_mul_f32 v56, s52, v56
  v_mul_f32 v57, s52, v57
  ds_read_b128 v[24:27], v14 offset:256
  s_waitcnt lgkmcnt(3)
  v_mfma_f32_32x32x16_bf16 v[64:79], v[28:31], v[164:167], v[64:79]
  v_cvt_pk_bf16_f32 v56, v56, v57
  v_mul_f32 v58, s52, v58
  v_mul_f32 v59, s52, v59
  v_mfma_f32_32x32x16_bf16 v[80:95], v[28:31], v[228:231], v[80:95]
  v_cvt_pk_bf16_f32 v57, v58, v59
  v_mul_f32 v60, s52, v60
  ds_read_b128 v[28:31], v15 offset:256
  s_waitcnt lgkmcnt(3)
  v_mfma_f32_32x32x16_bf16 v[64:79], v[16:19], v[168:171], v[64:79]
  v_mul_f32 v61, s52, v61
  v_cvt_pk_bf16_f32 v58, v60, v61
  v_mul_f32 v62, s52, v62
  v_mfma_f32_32x32x16_bf16 v[80:95], v[16:19], v[232:235], v[80:95]
  v_mul_f32 v63, s52, v63
  v_cvt_pk_bf16_f32 v59, v62, v63
  s_waitcnt lgkmcnt(2)
  v_mfma_f32_32x32x16_bf16 v[64:79], v[20:23], v[172:175], v[64:79]
  v_permlane16_swap_b32 v48, v56
  v_permlane16_swap_b32 v49, v57
  v_permlane16_swap_b32 v50, v58
  v_mfma_f32_32x32x16_bf16 v[80:95], v[20:23], v[236:239], v[80:95]
  v_permlane16_swap_b32 v51, v59
  v_accvgpr_write_b32 a160, v48
  s_waitcnt lgkmcnt(1)
  v_mfma_f32_32x32x16_bf16 v[64:79], v[24:27], v[176:179], v[64:79]
  v_accvgpr_write_b32 a161, v49
  v_accvgpr_write_b32 a162, v50
  v_accvgpr_write_b32 a163, v51
  v_mfma_f32_32x32x16_bf16 v[80:95], v[24:27], v[240:243], v[80:95]
  v_accvgpr_write_b32 a216, v56
  v_accvgpr_write_b32 a217, v57
  s_waitcnt lgkmcnt(0)
  v_mfma_f32_32x32x16_bf16 v[64:79], v[28:31], v[180:183], v[64:79]
  v_accvgpr_write_b32 a218, v58
  v_accvgpr_write_b32 a219, v59
  v_mfma_f32_32x32x16_bf16 v[80:95], v[28:31], v[244:247], v[80:95]
  s_nop 4
  v_mul_f32 v64, s52, v64
  v_mul_f32 v65, s52, v65
  v_cvt_pk_bf16_f32 v64, v64, v65
  v_mul_f32 v66, s52, v66
  v_mul_f32 v67, s52, v67
  v_cvt_pk_bf16_f32 v65, v66, v67
  v_mul_f32 v68, s52, v68
  v_mul_f32 v69, s52, v69
  v_cvt_pk_bf16_f32 v66, v68, v69
  v_mul_f32 v70, s52, v70
  v_mul_f32 v71, s52, v71
  v_cvt_pk_bf16_f32 v67, v70, v71
  v_mul_f32 v72, s52, v72
  v_mul_f32 v73, s52, v73
  v_cvt_pk_bf16_f32 v72, v72, v73
  v_mul_f32 v74, s52, v74
  v_mul_f32 v75, s52, v75
  v_cvt_pk_bf16_f32 v73, v74, v75
  v_mul_f32 v76, s52, v76
  v_mul_f32 v77, s52, v77
  v_cvt_pk_bf16_f32 v74, v76, v77
  v_mul_f32 v78, s52, v78
  v_mul_f32 v79, s52, v79
  v_cvt_pk_bf16_f32 v75, v78, v79
  v_permlane16_swap_b32 v64, v72
  v_permlane16_swap_b32 v65, v73
  v_permlane16_swap_b32 v66, v74
  v_permlane16_swap_b32 v67, v75
  v_accvgpr_write_b32 a52, v64
  v_accvgpr_write_b32 a53, v65
  v_accvgpr_write_b32 a54, v66
  v_accvgpr_write_b32 a55, v67
  v_accvgpr_write_b32 a108, v72
  v_accvgpr_write_b32 a109, v73
  v_accvgpr_write_b32 a110, v74
  v_accvgpr_write_b32 a111, v75
  v_mul_f32 v80, s52, v80
  v_mul_f32 v81, s52, v81
  v_cvt_pk_bf16_f32 v80, v80, v81
  v_mul_f32 v82, s52, v82
  v_mul_f32 v83, s52, v83
  v_cvt_pk_bf16_f32 v81, v82, v83
  v_mul_f32 v84, s52, v84
  v_mul_f32 v85, s52, v85
  v_cvt_pk_bf16_f32 v82, v84, v85
  v_mul_f32 v86, s52, v86
  v_mul_f32 v87, s52, v87
  v_cvt_pk_bf16_f32 v83, v86, v87
  v_mul_f32 v88, s52, v88
  v_mul_f32 v89, s52, v89
  v_cvt_pk_bf16_f32 v88, v88, v89
  v_mul_f32 v90, s52, v90
  v_mul_f32 v91, s52, v91
  v_cvt_pk_bf16_f32 v89, v90, v91
  v_mul_f32 v92, s52, v92
  v_mul_f32 v93, s52, v93
  v_cvt_pk_bf16_f32 v90, v92, v93
  v_mul_f32 v94, s52, v94
  v_mul_f32 v95, s52, v95
  v_cvt_pk_bf16_f32 v91, v94, v95
  v_permlane16_swap_b32 v80, v88
  v_permlane16_swap_b32 v81, v89
  v_permlane16_swap_b32 v82, v90
  v_permlane16_swap_b32 v83, v91
  v_accvgpr_write_b32 a164, v80
  v_accvgpr_write_b32 a165, v81
  v_accvgpr_write_b32 a166, v82
  v_accvgpr_write_b32 a167, v83
  v_accvgpr_write_b32 a220, v88
  v_accvgpr_write_b32 a221, v89
  v_accvgpr_write_b32 a222, v90
  v_accvgpr_write_b32 a223, v91
  s_mov_b32 s30, 0
  s_branch sc_aw_w
sc_aw:
  buffer_load_dwordx4 v[100:103], v113, s[8:11], s28 offen sc1
  buffer_load_dwordx4 v[104:107], v2, s[8:11], s29 offen sc1
  buffer_load_dwordx4 v[108:111], v112, s[8:11], s29 offen sc1
sc_aw_w:
  s_waitcnt vmcnt(0)
  v_cmp_ne_u64 vcc, s[88:89], v[100:101]
  s_cbranch_vccnz sc_aw_no
  v_cmp_ne_u64 vcc, s[88:89], v[102:103]
  s_cbranch_vccnz sc_aw_no
  v_cmp_ne_u64 vcc, s[88:89], v[104:105]
  s_cbranch_vccnz sc_aw_no
  v_cmp_ne_u64 vcc, s[88:89], v[106:107]
  s_cbranch_vccnz sc_aw_no
  v_cmp_ne_u64 vcc, s[88:89], v[108:109]
  s_cbranch_vccnz sc_aw_no
  v_cmp_ne_u64 vcc, s[88:89], v[110:111]
  s_cbranch_vccnz sc_aw_no
  s_branch sc_aw_ok
sc_aw_no:
  s_sleep 1
  s_add_u32 s30, s30, 1
  s_cmp_lt_u32 s30, 50000
  s_cbranch_scc1 sc_aw
  s_branch cA_abort
sc_aw_ok:
  v_add_u32 v4, s25, v2
  v_add_u32 v5, 0x10000, v4
  v_add_u32 v6, 0x20000, v4
  s_cmp_eq_u32 s48, 0x10000000
  s_cbranch_scc1 sc_d0
  ds_read_b128 v[120:123], v5 offset:16384
  ds_read_b128 v[124:127], v5 offset:17408
  ds_read_b128 v[128:131], v5 offset:18432
  ds_read_b128 v[132:135], v5 offset:19456
  ds_read_b128 v[136:139], v5 offset:32768
  ds_read_b128 v[140:143], v5 offset:33792
  s_waitcnt lgkmcnt(0)
  s_branch sc_e0
sc_d0:
  s_add_u32 s22, s33, 0
  buffer_load_dwordx4 a[224:227], v2, s[8:11], s22 offen offset:0 sc1
  buffer_load_dwordx4 a[228:231], v2, s[8:11], s22 offen offset:1024 sc1
  buffer_load_dwordx4 a[232:235], v2, s[8:11], s22 offen offset:2048 sc1
  buffer_load_dwordx4 a[236:239], v2, s[8:11], s22 offen offset:3072 sc1
  s_add_u32 s22, s33, 4096
  buffer_load_dwordx4 a[240:243], v2, s[8:11], s22 offen offset:0 sc1
  buffer_load_dwordx4 a[244:247], v2, s[8:11], s22 offen offset:1024 sc1
  buffer_load_dwordx4 a[248:251], v2, s[8:11], s22 offen offset:2048 sc1
  buffer_load_dwordx4 a[252:255], v2, s[8:11], s22 offen offset:3072 sc1
  s_add_u32 s22, s33, 8192
  buffer_load_dwordx4 v[120:123], v2, s[8:11], s22 offen offset:0 sc1
  buffer_load_dwordx4 v[124:127], v2, s[8:11], s22 offen offset:1024 sc1
  buffer_load_dwordx4 v[128:131], v2, s[8:11], s22 offen offset:2048 sc1
  buffer_load_dwordx4 v[132:135], v2, s[8:11], s22 offen offset:3072 sc1
  s_add_u32 s22, s33, 12288
  buffer_load_dwordx4 v[136:139], v2, s[8:11], s22 offen offset:0 sc1
  buffer_load_dwordx4 v[140:143], v2, s[8:11], s22 offen offset:1024 sc1
sc_e0:
  s_cmp_eq_u32 s49, 0x10000000
  s_cbranch_scc1 sc_d1
  ds_read_b128 v[144:147], v5 offset:34816
  ds_read_b128 v[148:151], v5 offset:35840
  ds_read_b128 v[152:155], v6 offset:16384
  ds_read_b128 v[156:159], v6 offset:17408
  ds_read_b128 v[160:163], v6 offset:18432
  ds_read_b128 v[164:167], v6 offset:19456
  ds_read_b128 v[168:171], v5 offset:49152
  ds_read_b128 v[172:175], v5 offset:50176
  ds_read_b128 v[176:179], v5 offset:51200
  ds_read_b128 v[180:183], v5 offset:52224
  ds_read_b128 v[184:187], v6 offset:0
  ds_read_b128 v[188:191], v6 offset:1024
  ds_read_b128 v[192:195], v6 offset:2048
  ds_read_b128 v[196:199], v6 offset:3072
  s_waitcnt lgkmcnt(0)
  s_branch sc_e1
sc_d1:
  s_add_u32 s22, s33, 12288
  buffer_load_dwordx4 v[144:147], v2, s[8:11], s22 offen offset:2048 sc1
  buffer_load_dwordx4 v[148:151], v2, s[8:11], s22 offen offset:3072 sc1
  s_add_u32 s22, s33, 16384
  buffer_load_dwordx4 v[152:155], v2, s[8:11], s22 offen offset:0 sc1
  buffer_load_dwordx4 v[156:159], v2, s[8:11], s22 offen offset:1024 sc1
  buffer_load_dwordx4 v[160:163], v2, s[8:11], s22 offen offset:2048 sc1
  buffer_load_dwordx4 v[164:167], v2, s[8:11], s22 offen offset:3072 sc1
  s_add_u32 s22, s33, 20480
  buffer_load_dwordx4 v[168:171], v2, s[8:11], s22 offen offset:0 sc1
  buffer_load_dwordx4 v[172:175], v2, s[8:11], s22 offen offset:1024 sc1
  buffer_load_dwordx4 v[176:179], v2, s[8:11], s22 offen offset:2048 sc1
  buffer_load_dwordx4 v[180:183], v2, s[8:11], s22 offen offset:3072 sc1
  s_add_u32 s22, s33, 24576
  buffer_load_dwordx4 v[184:187], v2, s[8:11], s22 offen offset:0 sc1
  buffer_load_dwordx4 v[188:191], v2, s[8:11], s22 offen offset:1024 sc1
  buffer_load_dwordx4 v[192:195], v2, s[8:11], s22 offen offset:2048 sc1
  buffer_load_dwordx4 v[196:199], v2, s[8:11], s22 offen offset:3072 sc1
sc_e1:
  s_cmp_eq_u32 s50, 0x10000000
  s_cbranch_scc1 sc_d2
  ds_read_b128 v[200:203], v4 offset:0
  ds_read_b128 v[204:207], v4 offset:1024
  ds_read_b128 v[208:211], v4 offset:2048
  ds_read_b128 v[212:215], v4 offset:3072
  ds_read_b128 v[216:219], v4 offset:16384
  ds_read_b128 v[220:223], v4 offset:17408
  ds_read_b128 v[224:227], v4 offset:18432
  ds_read_b128 v[228:231], v4 offset:19456
  ds_read_b128 v[232:235], v4 offset:32768
  ds_read_b128 v[236:239], v4 offset:33792
  ds_read_b128 v[240:243], v4 offset:34816
  ds_read_b128 v[244:247], v4 offset:35840
  s_waitcnt lgkmcnt(0)
  s_branch sc_e2
sc_d2:
  s_add_u32 s22, s32, 0
  buffer_load_dwordx4 v[200:203], v2, s[8:11], s22 offen offset:0 sc1
  buffer_load_dwordx4 v[204:207], v2, s[8:11], s22 offen offset:1024 sc1
  buffer_load_dwordx4 v[208:211], v2, s[8:11], s22 offen offset:2048 sc1
  buffer_load_dwordx4 v[212:215], v2, s[8:11], s22 offen offset:3072 sc1
  s_add_u32 s22, s32, 4096
  buffer_load_dwordx4 v[216:219], v2, s[8:11], s22 offen offset:0 sc1
  buffer_load_dwordx4 v[220:223], v2, s[8:11], s22 offen offset:1024 sc1
  buffer_load_dwordx4 v[224:227], v2, s[8:11], s22 offen offset:2048 sc1
  buffer_load_dwordx4 v[228:231], v2, s[8:11], s22 offen offset:3072 sc1
  s_add_u32 s22, s32, 8192
  buffer_load_dwordx4 v[232:235], v2, s[8:11], s22 offen offset:0 sc1
  buffer_load_dwordx4 v[236:239], v2, s[8:11], s22 offen offset:1024 sc1
  buffer_load_dwordx4 v[240:243], v2, s[8:11], s22 offen offset:2048 sc1
  buffer_load_dwordx4 v[244:247], v2, s[8:11], s22 offen offset:3072 sc1
  s_add_u32 s22, s32, 12288
  buffer_load_dwordx4 v[248:251], v2, s[8:11], s22 offen offset:0 sc1
  buffer_load_dwordx4 v[252:255], v2, s[8:11], s22 offen offset:1024 sc1
sc_e2:
  s_barrier
  s_branch m_role
m_val:
  s_cmp_lg_u32 s16, 0
  s_cbranch_scc1 w0_6
  v_mov_b32 v233, 128
  v_mov_b32 v234, s88
  v_mov_b32 v235, s89
  v_mov_b32 v236, 0
  v_mov_b32 v237, 0
  s_mov_b64 exec, 1
  buffer_atomic_cmpswap_x2 v[234:237], v233, s[12:15], 0 offen sc0
  s_mov_b64 exec, -1
w0_6:
  s_cmp_lg_u32 s66, 0
  s_cbranch_scc1 va_ci
  s_cmp_lg_u32 s16, 0
  s_cbranch_scc1 w0_7
  s_lshr_b32 s70, s3, 5
  s_and_b32 s71, s70, 4
  s_mul_i32 s71, s71, 12
  s_lshl_b32 s70, s70, 2
  s_add_u32 s70, s70, s71
  s_lshl_b32 s71, 1, s3
  v_mov_b32 v242, s71
  v_mov_b32 v243, 32
  s_mov_b64 exec, 1
  buffer_atomic_or v242, v243, s[12:15], s70 offen sc0
  buffer_load_dwordx2 v[244:245], v243, s[12:15], 0 offen offset:96 sc1
  s_mov_b64 exec, -1
w0_7:
va_ci:
  s_mov_b32 s56, s40
  s_and_b32 s57, s41, 0xffff
  s_mov_b32 s58, 3670016
  s_mov_b32 s59, 0x20000
  v_lshrrev_b32 v24, 5, v1
  v_and_b32 v25, 31, v1
  v_lshlrev_b32 v25, 4, v25
  v_lshl_add_u32 v24, v24, 13, v25
  s_mov_b32 s60, s42
  s_and_b32 s61, s43, 0xffff
  s_mov_b32 s62, 3670016
  s_mov_b32 s63, 0x20000
  s_lshl_b32 s22, s17, 9
  s_lshl_b32 s23, s16, 19
  s_add_u32 s23, s22, s23
  s_add_u32 s21, s23, 262144
  buffer_load_dwordx4 v[28:31], v24, s[60:63], s21 offen
  s_add_u32 s21, s23, 278528
  buffer_load_dwordx4 v[28:31], v24, s[60:63], s21 offen
  s_add_u32 s21, s23, 294912
  buffer_load_dwordx4 v[28:31], v24, s[60:63], s21 offen
  s_add_u32 s21, s23, 311296
  buffer_load_dwordx4 v[28:31], v24, s[60:63], s21 offen
  s_add_u32 s21, s23, 327680
  buffer_load_dwordx4 v[28:31], v24, s[60:63], s21 offen
  s_add_u32 s21, s23, 344064
  buffer_load_dwordx4 v[28:31], v24, s[60:63], s21 offen
  s_add_u32 s21, s23, 360448
  buffer_load_dwordx4 v[28:31], v24, s[60:63], s21 offen
  s_add_u32 s21, s23, 376832
  buffer_load_dwordx4 v[28:31], v24, s[60:63], s21 offen
  s_add_u32 s21, s23, 393216
  buffer_load_dwordx4 v[28:31], v24, s[60:63], s21 offen
  s_add_u32 s21, s23, 409600
  buffer_load_dwordx4 v[28:31], v24, s[60:63], s21 offen
  s_add_u32 s21, s23, 425984
  buffer_load_dwordx4 v[28:31], v24, s[60:63], s21 offen
  s_add_u32 s21, s23, 442368
  buffer_load_dwordx4 v[28:31], v24, s[60:63], s21 offen
  s_add_u32 s21, s23, 458752
  buffer_load_dwordx4 v[28:31], v24, s[60:63], s21 offen
  s_add_u32 s21, s23, 475136
  buffer_load_dwordx4 v[28:31], v24, s[60:63], s21 offen
  s_add_u32 s21, s23, 491520
  buffer_load_dwordx4 v[28:31], v24, s[60:63], s21 offen
  s_add_u32 s21, s23, 507904
  buffer_load_dwordx4 v[28:31], v24, s[60:63], s21 offen
  s_lshl_b32 s23, s16, 14
  s_add_u32 s22, s22, s23
  s_mov_b32 s30, 0
va_pf:
  buffer_load_dwordx4 v[28:31], v24, s[56:59], s22 offen
  s_waitcnt vmcnt(40)
  s_add_u32 s22, s22, 65536
  s_add_u32 s30, s30, 1
  s_cmp_lt_u32 s30, 56
  s_cbranch_scc1 va_pf
  s_cmp_lg_u32 s66, 0
  s_cbranch_scc1 va_cf
  s_cmp_lg_u32 s16, 0
  s_cbranch_scc1 w0_8
  s_waitcnt vmcnt(40)
  v_readfirstlane_b32 s70, v244
  s_cmp_lg_u32 s70, 0
  s_cbranch_scc1 va_nz
  v_mov_b32 v243, 128
  v_mov_b32 v244, s88
  v_mov_b32 v245, s89
  v_mov_b32 v246, 0
  v_mov_b32 v247, 0
  s_mov_b64 exec, 1
  buffer_atomic_cmpswap_x2 v[244:247], v243, s[12:15], 0 offen sc0
  s_mov_b64 exec, -1
  s_waitcnt vmcnt(0)
  v_readfirstlane_b32 s70, v244
  s_cmp_lg_u32 s70, 0
  s_cbranch_scc1 va_nz
  v_mov_b32 v244, s88
  v_mov_b32 v245, s89
va_nz:
w0_8:
  v_mov_b32 v243, 160000
  s_add_u32 s101, s101, 1
  s_barrier
  s_mov_b64 exec, 1
  s_cmp_lg_u32 s16, 0
  s_cbranch_scc1 w0_9
  ds_write_b32 v243, v242 offset:0
  ds_write_b32 v243, v244 offset:4
  ds_write_b32 v243, v245 offset:8
  s_waitcnt lgkmcnt(0)
  v_mov_b32 v242, s101
  ds_write_b32 v243, v242 offset:16
  s_waitcnt lgkmcnt(0)
w0_9:
  s_mov_b64 exec, -1
  s_barrier
  ds_read_b32 v242, v243 offset:0
  ds_read_b32 v244, v243 offset:4
  ds_read_b32 v245, v243 offset:8
  ds_read_b32 v243, v243 offset:16
  s_waitcnt lgkmcnt(0)
  v_readfirstlane_b32 s70, v242
  v_readfirstlane_b32 s88, v244
  v_readfirstlane_b32 s89, v245
  v_cmp_ne_u32 vcc, s101, v243
  s_cbranch_vccnz ch_end
  s_mov_b32 s66, 1
  s_bitcmp1_b32 s70, s3
  s_cbranch_scc1 m_reclaim
va_cf:
  s_cmp_lg_u32 s16, 0
  s_cbranch_scc1 w0_10
  s_cmp_eq_u32 s67, 0
  s_cselect_b32 s20, 1, 0x10001
  v_mov_b32 v242, s20
  v_mov_b32 v243, 0
  s_mov_b64 exec, 1
  buffer_atomic_add v242, v243, s[12:15], 0 offen
  s_mov_b64 exec, -1
w0_10:
m_role:
  s_mov_b32 s17, s3
  v_and_b32 v1, 63, v0
  v_lshlrev_b32 v2, 4, v1
  v_lshrrev_b32 v116, 4, v1
  v_and_b32 v117, 15, v1
  v_mov_b32 v3, 0x4444
  v_mov_b32 v118, 0xeeee
  v_cmp_lt_u32 vcc, 7, v117
  s_nop 1
  v_cndmask_b32 v3, v3, v118, vcc
  s_mov_b32 s19, 0
  s_mov_b32 s20, 88653824
  s_lshr_b32 s22, s17, 4
  s_lshl_b32 s22, s22, 2
  s_add_u32 s22, s22, s16
  s_and_b32 s17, s17, 15
  s_cmp_eq_u32 s22, 0
  s_cbranch_scc1 ch_init0
  s_cmp_eq_u32 s22, 1
  s_cbranch_scc1 ch_init1
  s_cmp_eq_u32 s22, 2
  s_cbranch_scc1 ch_init2
  s_cmp_eq_u32 s22, 3
  s_cbranch_scc1 ch_init3
  s_cmp_eq_u32 s22, 4
  s_cbranch_scc1 ch_init4
  s_cmp_eq_u32 s22, 5
  s_cbranch_scc1 ch_init5
  s_cmp_eq_u32 s22, 6
  s_cbranch_scc1 ch_init6
  s_cmp_eq_u32 s22, 7
  s_cbranch_scc1 ch_init7
  s_branch ch_end
ch_init0:
  s_getpc_b64 s[98:99]
cpf_11:
  s_add_u32 s98, s98, cA_sc0_loop-cpf_11
  s_addc_u32 s99, s99, 0
  v_lshlrev_b32 v38, 2, v2
  global_load_dword v39, v38, s[98:99]
  s_mul_i32 s31, s17, 401408
  s_add_u32 s31, s31, 0
  s_mov_b32 s24, 71565312
  s_mov_b32 s25, 0
  s_add_u32 m0, s25, 0
  s_nop 0
  buffer_load_dwordx4 v2, s[8:11], s24 offen offset:0 sc1 lds
  buffer_load_dwordx4 v2, s[8:11], s24 offen offset:1024 sc1 lds
  buffer_load_dwordx4 v2, s[8:11], s24 offen offset:2048 sc1 lds
  buffer_load_dwordx4 v2, s[8:11], s24 offen offset:3072 sc1 lds
  s_add_u32 m0, s25, 4096
  s_add_u32 s22, s24, 4096
  buffer_load_dwordx4 v2, s[8:11], s22 offen offset:0 sc1 lds
  buffer_load_dwordx4 v2, s[8:11], s22 offen offset:1024 sc1 lds
  buffer_load_dwordx4 v2, s[8:11], s22 offen offset:2048 sc1 lds
  v_lshrrev_b32 v64, 1, v117
  v_and_b32 v65, 1, v116
  v_lshlrev_b32 v65, 2, v65
  v_sub_u32 v64, v64, v65
  v_and_b32 v65, 1, v117
  v_lshl_add_u32 v66, v65, 2, v64
  v_cmp_gt_u32 vcc, 4, v64
  v_mov_b32 v67, 99
  s_nop 0
  v_cndmask_b32 v66, v67, v66, vcc
  v_mov_b32 v68, 0x3f80
  v_mov_b32 v69, 0x3f800000
  v_mov_b32 v4, 0
  v_cmp_eq_u32 vcc, 0, v66
  s_nop 1
  v_cndmask_b32 v4, v4, v68, vcc
  v_cmp_eq_u32 vcc, 1, v66
  s_nop 1
  v_cndmask_b32 v4, v4, v69, vcc
  v_mov_b32 v5, 0
  v_cmp_eq_u32 vcc, 2, v66
  s_nop 1
  v_cndmask_b32 v5, v5, v68, vcc
  v_cmp_eq_u32 vcc, 3, v66
  s_nop 1
  v_cndmask_b32 v5, v5, v69, vcc
  v_mov_b32 v6, 0
  v_cmp_eq_u32 vcc, 4, v66
  s_nop 1
  v_cndmask_b32 v6, v6, v68, vcc
  v_cmp_eq_u32 vcc, 5, v66
  s_nop 1
  v_cndmask_b32 v6, v6, v69, vcc
  v_mov_b32 v7, 0
  v_cmp_eq_u32 vcc, 6, v66
  s_nop 1
  v_cndmask_b32 v7, v7, v68, vcc
  v_cmp_eq_u32 vcc, 7, v66
  s_nop 1
  v_cndmask_b32 v7, v7, v69, vcc
  v_lshrrev_b32 v64, 1, v116
  v_lshrrev_b32 v65, 3, v117
  v_cmp_eq_u32 s[26:27], v64, v65
  v_and_b32 v66, 1, v116
  v_add_u32 v64, 0, v64
  v_lshrrev_b32 v67, 1, v116
  v_lshlrev_b32 v67, 8, v67
  v_lshl_add_u32 v67, v66, 9, v67
  v_lshl_add_u32 v67, v117, 4, v67
  v_add_u32 v112, 57344, v67
  v_and_b32 v68, 7, v117
  v_lshlrev_b32 v67, 8, v64
  v_lshl_add_u32 v67, v68, 5, v67
  v_lshl_add_u32 v67, v66, 4, v67
  v_add_u32 v113, 65536, v67
  v_lshrrev_b32 v64, 5, v1
  v_and_b32 v65, 31, v1
  v_lshrrev_b32 v66, 3, v65
  v_and_b32 v67, 7, v65
  v_and_b32 v68, 3, v67
  v_lshl_add_u32 v68, v66, 2, v68
  v_lshrrev_b32 v69, 2, v67
  v_lshl_add_u32 v68, v69, 4, v68
  v_lshlrev_b32 v69, 11, v64
  v_lshl_add_u32 v69, v68, 4, v69
  v_add_u32 v114, 57344, v69
  v_add_u32 v70, 0, v64
  v_lshlrev_b32 v69, 9, v66
  v_lshl_add_u32 v69, v70, 5, v69
  v_lshl_add_u32 v69, v67, 2, v69
  v_add_u32 v115, 65536, v69
  v_lshlrev_b32 v69, 4, v68
  v_lshl_add_u32 v69, v64, 9, v69
  v_add_u32 v114, 57344, v69
  v_mul_u32_u24 v69, 144, v70
  v_lshl_add_u32 v69, v67, 4, v69
  v_add_u32 v115, 65536, v69
  v_and_b32 v71, 1, v116
  v_mul_u32_u24 v69, 2048, v71
  v_lshl_add_u32 v69, v64, 8, v69
  v_lshl_add_u32 v69, v117, 4, v69
  v_add_u32 v112, 57344, v69
  v_mul_u32_u24 v69, 144, v117
  v_lshl_add_u32 v69, v71, 6, v69
  v_lshl_add_u32 v69, v64, 5, v69
  v_add_u32 v113, 65536, v69
  v_mul_u32_u24 v69, 1024, v116
  v_lshl_add_u32 v69, v117, 4, v69
  v_and_b32 v72, 8, v117
  v_xor_b32 v72, 0, v72
  v_add_u32 v69, v69, v72
  v_add_u32 v112, 57344, v69
  v_lshrrev_b32 v72, 3, v117
  v_lshl_add_u32 v72, v71, 1, v72
  v_xor_b32 v72, 0, v72
  v_lshlrev_b32 v69, 10, v116
  v_lshl_add_u32 v69, v117, 4, v69
  v_lshl_add_u32 v69, v72, 2, v69
  v_add_u32 v112, 57344, v69
  v_lshrrev_b32 v69, 1, v117
  v_and_b32 v72, 1, v117
  v_lshl_add_u32 v69, v72, 3, v69
  v_mul_u32_u24 v69, 144, v69
  v_lshl_add_u32 v69, v71, 6, v69
  v_lshl_add_u32 v69, v64, 5, v69
  v_lshl_add_u32 v72, v72, 1, v71
  v_xor_b32 v72, 0, v72
  v_lshl_add_u32 v69, v72, 2, v69
  v_add_u32 v113, 65536, v69
  v_and_b32 v71, 1, v1
  v_cmp_eq_u32 s[38:39], 0, v71
  v_cmp_gt_u32 vcc, 8, v65
  s_or_b64 s[28:29], s[38:39], vcc
  v_lshrrev_b32 v72, 1, v67
  v_lshlrev_b32 v72, 2, v72
  v_lshl_add_u32 v72, v70, 4, v72
  s_lshl_b32 s22, s17, 9
  s_add_u32 s22, s22, 9216
  v_lshl_add_u32 v73, v66, 7, v72
  v_add_u32 v73, s22, v73
  s_lshl_b32 s22, s17, 7
  s_add_u32 s22, s22, 7168
  v_add_u32 v74, s22, v72
  v_bfe_u32 v72, v65, 1, 1
  v_lshlrev_b32 v72, 7, v72
  v_lshl_add_u32 v72, v70, 4, v72
  v_bfe_u32 v73, v65, 2, 2
  v_lshl_add_u32 v72, v73, 2, v72
  v_lshrrev_b32 v73, 4, v65
  v_lshl_add_u32 v73, v73, 8, v72
  s_lshl_b32 s22, s17, 9
  s_add_u32 s22, s22, 9216
  v_add_u32 v73, s22, v73
  s_lshr_b32 s22, s17, 1
  s_lshl_b32 s22, s22, 8
  s_and_b32 s34, s17, 1
  s_lshl_b32 s34, s34, 3
  s_add_u32 s22, s22, s34
  s_add_u32 s22, s22, 7168
  v_add_u32 v74, s22, v72
  v_bfe_u32 v72, v65, 1, 1
  v_lshl_add_u32 v72, v64, 1, v72
  v_lshlrev_b32 v72, 4, v72
  v_bfe_u32 v73, v65, 2, 2
  v_lshl_add_u32 v72, v73, 2, v72
  v_lshrrev_b32 v73, 4, v65
  v_lshl_add_u32 v73, v73, 6, v72
  s_lshl_b32 s22, s17, 9
  s_add_u32 s22, s22, 9216
  v_add_u32 v73, s22, v73
  v_lshrrev_b32 v72, 1, v65
  v_lshlrev_b32 v72, 2, v72
  v_lshl_add_u32 v72, v64, 5, v72
  s_lshr_b32 s22, s17, 1
  s_lshl_b32 s22, s22, 8
  s_and_b32 s34, s17, 1
  s_lshl_b32 s34, s34, 4
  s_add_u32 s22, s22, s34
  s_add_u32 s22, s22, 7168
  v_add_u32 v74, s22, v72
  v_lshlrev_b32 v0, 2, v65
  v_and_b32 v0, 120, v0
  s_and_b32 s22, s17, 15
  s_lshl_b32 s22, s22, 7
  s_add_u32 s22, s22, 18432
  v_add_u32 v0, s22, v0
  v_cndmask_b32 v1, v74, v73, s[38:39]
  s_lshl_b32 s36, s17, 2
  s_add_u32 s36, s36, 17472
  s_mov_b32 s37, 0x3e800000
  v_mov_b32 v36, 0
  v_mov_b32 v37, 0
  v_mov_b32 v38, 0
  v_mov_b32 v39, 0
  v_mov_b32 v40, 0
  v_mov_b32 v41, 0
  v_mov_b32 v42, 0
  v_mov_b32 v43, 0
  v_mov_b32 v44, 0
  v_mov_b32 v45, 0
  v_mov_b32 v46, 0
  v_mov_b32 v47, 0
  v_mov_b32 v48, 0
  v_mov_b32 v49, 0
  v_mov_b32 v50, 0
  v_mov_b32 v51, 0
  v_mov_b32 v52, 0
  v_mov_b32 v53, 0
  v_mov_b32 v54, 0
  v_mov_b32 v55, 0
  v_mov_b32 v56, 0
  v_mov_b32 v57, 0
  v_mov_b32 v58, 0
  v_mov_b32 v59, 0
  v_mov_b32 v60, 0
  v_mov_b32 v61, 0
  v_mov_b32 v62, 0
  v_mov_b32 v63, 0
  v_mov_b32 v64, 0
  v_mov_b32 v65, 0
  v_mov_b32 v66, 0
  v_mov_b32 v67, 0
  v_mov_b32 v68, 0
  v_mov_b32 v69, 0
  v_mov_b32 v70, 0
  v_mov_b32 v71, 0
  v_mov_b32 v72, 0
  v_mov_b32 v73, 0
  v_mov_b32 v74, 0
  v_mov_b32 v75, 0
  v_mov_b32 v76, 0
  v_mov_b32 v77, 0
  v_mov_b32 v78, 0
  v_mov_b32 v79, 0
  v_mov_b32 v80, 0
  v_mov_b32 v81, 0
  v_mov_b32 v82, 0
  v_mov_b32 v83, 0
  v_mov_b32 v84, 0
  v_mov_b32 v85, 0
  v_mov_b32 v86, 0
  v_mov_b32 v87, 0
  v_mov_b32 v88, 0
  v_mov_b32 v89, 0
  v_mov_b32 v90, 0
  v_mov_b32 v91, 0
  v_mov_b32 v92, 0
  v_mov_b32 v93, 0
  v_mov_b32 v94, 0
  v_mov_b32 v95, 0
  v_mov_b32 v96, 0
  v_mov_b32 v97, 0
  v_mov_b32 v98, 0
  v_mov_b32 v99, 0
  v_mov_b32 v100, 0
  v_mov_b32 v101, 0
  v_mov_b32 v102, 0
  v_mov_b32 v103, 0
  v_mov_b32 v104, 0
  v_mov_b32 v105, 0
  v_mov_b32 v106, 0
  v_mov_b32 v107, 0
  v_mov_b32 v108, 0
  v_mov_b32 v109, 0
  v_mov_b32 v110, 0
  v_mov_b32 v111, 0
  v_and_b32 v118, 1, v116
  v_cmp_eq_u32 vcc, 0, v118
  v_mov_b32 v118, 12288
  v_mov_b32 v119, 8192
  v_cndmask_b32 v118, v118, v119, vcc
  v_lshrrev_b32 v116, 1, v116
  v_lshl_add_u32 v118, v116, 9, v118
  v_lshl_add_u32 v117, v117, 4, v118
  s_mov_b32 s57, 28672
  v_bfe_u32 v118, v2, 4, 1
  v_mul_u32_u24 v118, 0xaaaa, v118
  v_add_u32 v118, 0x4444, v118
  s_mov_b32 s56, 0x42800000
  v_mov_b32 v116, v2
  s_mul_i32 s35, s17, 1835008
  s_add_u32 s35, s35, 42262528
  v_lshl_add_u32 v119, v2, 3, s36
  v_mov_b32 v8, 0x20000000
  v_cmp_gt_u32 vcc, 64, v2
  s_nop 1
  v_cndmask_b32 v119, v8, v119, vcc
  s_mov_b32 s30, 0
  v_mov_b32 v36, 0
ch_md0:
  buffer_load_dword v37, v36, s[12:15], 0 offen sc1
  s_waitcnt vmcnt(0)
  v_readfirstlane_b32 s22, v37
  s_and_b32 s31, s22, 0xffff
  s_cmp_ge_u32 s31, 32
  s_cbranch_scc1 ch_go0
  s_sleep 2
  s_add_u32 s30, s30, 1
  s_cmp_lt_u32 s30, 50000
  s_cbranch_scc1 ch_md0
  s_branch ch_end
ch_go0:
  s_mov_b32 s31, 0
  s_lshr_b32 s22, s22, 16
  s_cmp_lg_u32 s22, 0
  s_cbranch_scc1 cB_sc0_loop
  s_branch cA_sc0_loop
ch_init1:
  s_getpc_b64 s[98:99]
cpf_12:
  s_add_u32 s98, s98, cA_sc1_loop-cpf_12
  s_addc_u32 s99, s99, 0
  v_lshlrev_b32 v38, 2, v2
  global_load_dword v39, v38, s[98:99]
  s_mul_i32 s31, s17, 401408
  s_add_u32 s31, s31, 0
  s_mov_b32 s24, 71572480
  s_mov_b32 s25, 0
  s_add_u32 m0, s25, 7168
  s_nop 0
  buffer_load_dwordx4 v2, s[8:11], s24 offen offset:0 sc1 lds
  buffer_load_dwordx4 v2, s[8:11], s24 offen offset:1024 sc1 lds
  buffer_load_dwordx4 v2, s[8:11], s24 offen offset:2048 sc1 lds
  buffer_load_dwordx4 v2, s[8:11], s24 offen offset:3072 sc1 lds
  s_add_u32 m0, s25, 11264
  s_add_u32 s22, s24, 4096
  buffer_load_dwordx4 v2, s[8:11], s22 offen offset:0 sc1 lds
  buffer_load_dwordx4 v2, s[8:11], s22 offen offset:1024 sc1 lds
  buffer_load_dwordx4 v2, s[8:11], s22 offen offset:2048 sc1 lds
  v_lshrrev_b32 v64, 1, v117
  v_and_b32 v65, 1, v116
  v_lshlrev_b32 v65, 2, v65
  v_sub_u32 v64, v64, v65
  v_and_b32 v65, 1, v117
  v_lshl_add_u32 v66, v65, 2, v64
  v_cmp_gt_u32 vcc, 4, v64
  v_mov_b32 v67, 99
  s_nop 0
  v_cndmask_b32 v66, v67, v66, vcc
  v_mov_b32 v68, 0x3f80
  v_mov_b32 v69, 0x3f800000
  v_mov_b32 v4, 0
  v_cmp_eq_u32 vcc, 0, v66
  s_nop 1
  v_cndmask_b32 v4, v4, v68, vcc
  v_cmp_eq_u32 vcc, 1, v66
  s_nop 1
  v_cndmask_b32 v4, v4, v69, vcc
  v_mov_b32 v5, 0
  v_cmp_eq_u32 vcc, 2, v66
  s_nop 1
  v_cndmask_b32 v5, v5, v68, vcc
  v_cmp_eq_u32 vcc, 3, v66
  s_nop 1
  v_cndmask_b32 v5, v5, v69, vcc
  v_mov_b32 v6, 0
  v_cmp_eq_u32 vcc, 4, v66
  s_nop 1
  v_cndmask_b32 v6, v6, v68, vcc
  v_cmp_eq_u32 vcc, 5, v66
  s_nop 1
  v_cndmask_b32 v6, v6, v69, vcc
  v_mov_b32 v7, 0
  v_cmp_eq_u32 vcc, 6, v66
  s_nop 1
  v_cndmask_b32 v7, v7, v68, vcc
  v_cmp_eq_u32 vcc, 7, v66
  s_nop 1
  v_cndmask_b32 v7, v7, v69, vcc
  v_lshrrev_b32 v64, 1, v116
  v_lshrrev_b32 v65, 3, v117
  v_cmp_eq_u32 s[26:27], v64, v65
  v_and_b32 v66, 1, v116
  v_add_u32 v64, 2, v64
  v_lshrrev_b32 v67, 1, v116
  v_lshlrev_b32 v67, 8, v67
  v_lshl_add_u32 v67, v66, 9, v67
  v_lshl_add_u32 v67, v117, 4, v67
  v_add_u32 v112, 58368, v67
  v_and_b32 v68, 7, v117
  v_lshlrev_b32 v67, 8, v64
  v_lshl_add_u32 v67, v68, 5, v67
  v_lshl_add_u32 v67, v66, 4, v67
  v_add_u32 v113, 65536, v67
  v_lshrrev_b32 v64, 5, v1
  v_and_b32 v65, 31, v1
  v_lshrrev_b32 v66, 3, v65
  v_and_b32 v67, 7, v65
  v_and_b32 v68, 3, v67
  v_lshl_add_u32 v68, v66, 2, v68
  v_lshrrev_b32 v69, 2, v67
  v_lshl_add_u32 v68, v69, 4, v68
  v_lshlrev_b32 v69, 11, v64
  v_lshl_add_u32 v69, v68, 4, v69
  v_add_u32 v114, 57352, v69
  v_add_u32 v70, 2, v64
  v_lshlrev_b32 v69, 9, v66
  v_lshl_add_u32 v69, v70, 5, v69
  v_lshl_add_u32 v69, v67, 2, v69
  v_add_u32 v115, 65536, v69
  v_lshlrev_b32 v69, 4, v68
  v_lshl_add_u32 v69, v64, 9, v69
  v_add_u32 v114, 58368, v69
  v_mul_u32_u24 v69, 144, v70
  v_lshl_add_u32 v69, v67, 4, v69
  v_add_u32 v115, 65536, v69
  v_and_b32 v71, 1, v116
  v_mul_u32_u24 v69, 2048, v71
  v_lshl_add_u32 v69, v64, 8, v69
  v_lshl_add_u32 v69, v117, 4, v69
  v_add_u32 v112, 57352, v69
  v_mul_u32_u24 v69, 144, v117
  v_lshl_add_u32 v69, v71, 6, v69
  v_lshl_add_u32 v69, v64, 5, v69
  v_add_u32 v113, 65540, v69
  v_mul_u32_u24 v69, 1024, v116
  v_lshl_add_u32 v69, v117, 4, v69
  v_and_b32 v72, 8, v117
  v_xor_b32 v72, 8, v72
  v_add_u32 v69, v69, v72
  v_add_u32 v112, 57344, v69
  v_lshrrev_b32 v72, 3, v117
  v_lshl_add_u32 v72, v71, 1, v72
  v_xor_b32 v72, 1, v72
  v_lshlrev_b32 v69, 10, v116
  v_lshl_add_u32 v69, v117, 4, v69
  v_lshl_add_u32 v69, v72, 2, v69
  v_add_u32 v112, 57344, v69
  v_lshrrev_b32 v69, 1, v117
  v_and_b32 v72, 1, v117
  v_lshl_add_u32 v69, v72, 3, v69
  v_mul_u32_u24 v69, 144, v69
  v_lshl_add_u32 v69, v71, 6, v69
  v_lshl_add_u32 v69, v64, 5, v69
  v_lshl_add_u32 v72, v72, 1, v71
  v_xor_b32 v72, 1, v72
  v_lshl_add_u32 v69, v72, 2, v69
  v_add_u32 v113, 65536, v69
  v_and_b32 v71, 1, v1
  v_cmp_eq_u32 s[38:39], 0, v71
  v_cmp_gt_u32 vcc, 8, v65
  s_or_b64 s[28:29], s[38:39], vcc
  v_lshrrev_b32 v72, 1, v67
  v_lshlrev_b32 v72, 2, v72
  v_lshl_add_u32 v72, v70, 4, v72
  s_lshl_b32 s22, s17, 9
  s_add_u32 s22, s22, 9216
  v_lshl_add_u32 v73, v66, 7, v72
  v_add_u32 v73, s22, v73
  s_lshl_b32 s22, s17, 7
  s_add_u32 s22, s22, 7168
  v_add_u32 v74, s22, v72
  v_bfe_u32 v72, v65, 1, 1
  v_lshlrev_b32 v72, 7, v72
  v_lshl_add_u32 v72, v70, 4, v72
  v_bfe_u32 v73, v65, 2, 2
  v_lshl_add_u32 v72, v73, 2, v72
  v_lshrrev_b32 v73, 4, v65
  v_lshl_add_u32 v73, v73, 8, v72
  s_lshl_b32 s22, s17, 9
  s_add_u32 s22, s22, 9216
  v_add_u32 v73, s22, v73
  s_lshr_b32 s22, s17, 1
  s_lshl_b32 s22, s22, 8
  s_and_b32 s34, s17, 1
  s_lshl_b32 s34, s34, 3
  s_add_u32 s22, s22, s34
  s_add_u32 s22, s22, 7168
  v_add_u32 v74, s22, v72
  v_bfe_u32 v72, v65, 1, 1
  v_lshl_add_u32 v72, v64, 1, v72
  v_lshlrev_b32 v72, 4, v72
  v_bfe_u32 v73, v65, 2, 2
  v_lshl_add_u32 v72, v73, 2, v72
  v_lshrrev_b32 v73, 4, v65
  v_lshl_add_u32 v73, v73, 6, v72
  s_lshl_b32 s22, s17, 9
  s_add_u32 s22, s22, 9344
  v_add_u32 v73, s22, v73
  v_lshrrev_b32 v72, 1, v65
  v_lshlrev_b32 v72, 2, v72
  v_lshl_add_u32 v72, v64, 5, v72
  s_lshr_b32 s22, s17, 1
  s_lshl_b32 s22, s22, 8
  s_and_b32 s34, s17, 1
  s_lshl_b32 s34, s34, 4
  s_add_u32 s22, s22, s34
  s_add_u32 s22, s22, 7232
  v_add_u32 v74, s22, v72
  v_lshlrev_b32 v0, 2, v65
  v_and_b32 v0, 120, v0
  s_and_b32 s22, s17, 15
  s_lshl_b32 s22, s22, 7
  s_add_u32 s22, s22, 18432
  v_add_u32 v0, s22, v0
  v_cndmask_b32 v1, v74, v73, s[38:39]
  s_lshl_b32 s36, s17, 2
  s_add_u32 s36, s36, 17472
  s_mov_b32 s37, 0x3e800000
  v_mov_b32 v36, 0
  v_mov_b32 v37, 0
  v_mov_b32 v38, 0
  v_mov_b32 v39, 0
  v_mov_b32 v40, 0
  v_mov_b32 v41, 0
  v_mov_b32 v42, 0
  v_mov_b32 v43, 0
  v_mov_b32 v44, 0
  v_mov_b32 v45, 0
  v_mov_b32 v46, 0
  v_mov_b32 v47, 0
  v_mov_b32 v48, 0
  v_mov_b32 v49, 0
  v_mov_b32 v50, 0
  v_mov_b32 v51, 0
  v_mov_b32 v52, 0
  v_mov_b32 v53, 0
  v_mov_b32 v54, 0
  v_mov_b32 v55, 0
  v_mov_b32 v56, 0
  v_mov_b32 v57, 0
  v_mov_b32 v58, 0
  v_mov_b32 v59, 0
  v_mov_b32 v60, 0
  v_mov_b32 v61, 0
  v_mov_b32 v62, 0
  v_mov_b32 v63, 0
  v_mov_b32 v64, 0
  v_mov_b32 v65, 0
  v_mov_b32 v66, 0
  v_mov_b32 v67, 0
  v_mov_b32 v68, 0
  v_mov_b32 v69, 0
  v_mov_b32 v70, 0
  v_mov_b32 v71, 0
  v_mov_b32 v72, 0
  v_mov_b32 v73, 0
  v_mov_b32 v74, 0
  v_mov_b32 v75, 0
  v_mov_b32 v76, 0
  v_mov_b32 v77, 0
  v_mov_b32 v78, 0
  v_mov_b32 v79, 0
  v_mov_b32 v80, 0
  v_mov_b32 v81, 0
  v_mov_b32 v82, 0
  v_mov_b32 v83, 0
  v_mov_b32 v84, 0
  v_mov_b32 v85, 0
  v_mov_b32 v86, 0
  v_mov_b32 v87, 0
  v_mov_b32 v88, 0
  v_mov_b32 v89, 0
  v_mov_b32 v90, 0
  v_mov_b32 v91, 0
  v_mov_b32 v92, 0
  v_mov_b32 v93, 0
  v_mov_b32 v94, 0
  v_mov_b32 v95, 0
  v_mov_b32 v96, 0
  v_mov_b32 v97, 0
  v_mov_b32 v98, 0
  v_mov_b32 v99, 0
  v_mov_b32 v100, 0
  v_mov_b32 v101, 0
  v_mov_b32 v102, 0
  v_mov_b32 v103, 0
  v_mov_b32 v104, 0
  v_mov_b32 v105, 0
  v_mov_b32 v106, 0
  v_mov_b32 v107, 0
  v_mov_b32 v108, 0
  v_mov_b32 v109, 0
  v_mov_b32 v110, 0
  v_mov_b32 v111, 0
  v_and_b32 v118, 1, v116
  v_cmp_eq_u32 vcc, 0, v118
  v_mov_b32 v118, 12288
  v_mov_b32 v119, 8448
  v_cndmask_b32 v118, v118, v119, vcc
  v_lshrrev_b32 v116, 1, v116
  v_lshl_add_u32 v118, v116, 9, v118
  v_lshl_add_u32 v117, v117, 4, v118
  s_mov_b32 s57, 28672
  v_bfe_u32 v118, v2, 4, 1
  v_mul_u32_u24 v118, 0xaaaa, v118
  v_add_u32 v118, 0x4444, v118
  s_mov_b32 s56, 0x42800000
  v_mov_b32 v116, v2
  v_lshrrev_b32 v0, 4, v2
  v_min_u32 v0, 9, v0
  s_mul_i32 s22, s17, 10
  v_add_u32 v0, s22, v0
  v_lshlrev_b32 v0, 7, v0
  v_add_u32 v0, 40960, v0
  s_mov_b32 s22, 88633344
  buffer_load_dword v119, v0, s[8:11], s22 offen sc1
  s_mov_b32 s22, 88612864
  buffer_load_dword v119, v0, s[8:11], s22 offen sc1
  s_mul_i32 s35, s17, 1835008
  s_add_u32 s35, s35, 42269696
  s_mov_b32 s30, 0
  v_mov_b32 v36, 0
ch_md1:
  buffer_load_dword v37, v36, s[12:15], 0 offen sc1
  s_waitcnt vmcnt(0)
  v_readfirstlane_b32 s22, v37
  s_and_b32 s31, s22, 0xffff
  s_cmp_ge_u32 s31, 32
  s_cbranch_scc1 ch_go1
  s_sleep 2
  s_add_u32 s30, s30, 1
  s_cmp_lt_u32 s30, 50000
  s_cbranch_scc1 ch_md1
  s_branch ch_end
ch_go1:
  s_mov_b32 s31, 0
  s_lshr_b32 s22, s22, 16
  s_cmp_lg_u32 s22, 0
  s_cbranch_scc1 cB_sc1_loop
  s_branch cA_sc1_loop
ch_init2:
  s_getpc_b64 s[98:99]
cpf_13:
  s_add_u32 s98, s98, cA_sc2_loop-cpf_13
  s_addc_u32 s99, s99, 0
  v_lshlrev_b32 v38, 2, v2
  global_load_dword v39, v38, s[98:99]
  s_mul_i32 s31, s17, 401408
  s_add_u32 s31, s31, 0
  s_mov_b32 s24, 71579648
  s_mov_b32 s25, 0
  s_add_u32 m0, s25, 14336
  s_nop 0
  buffer_load_dwordx4 v2, s[8:11], s24 offen offset:0 sc1 lds
  buffer_load_dwordx4 v2, s[8:11], s24 offen offset:1024 sc1 lds
  buffer_load_dwordx4 v2, s[8:11], s24 offen offset:2048 sc1 lds
  buffer_load_dwordx4 v2, s[8:11], s24 offen offset:3072 sc1 lds
  s_add_u32 m0, s25, 18432
  s_add_u32 s22, s24, 4096
  buffer_load_dwordx4 v2, s[8:11], s22 offen offset:0 sc1 lds
  buffer_load_dwordx4 v2, s[8:11], s22 offen offset:1024 sc1 lds
  buffer_load_dwordx4 v2, s[8:11], s22 offen offset:2048 sc1 lds
  v_lshrrev_b32 v64, 1, v117
  v_and_b32 v65, 1, v116
  v_lshlrev_b32 v65, 2, v65
  v_sub_u32 v64, v64, v65
  v_and_b32 v65, 1, v117
  v_lshl_add_u32 v66, v65, 2, v64
  v_cmp_gt_u32 vcc, 4, v64
  v_mov_b32 v67, 99
  s_nop 0
  v_cndmask_b32 v66, v67, v66, vcc
  v_mov_b32 v68, 0x3f80
  v_mov_b32 v69, 0x3f800000
  v_mov_b32 v4, 0
  v_cmp_eq_u32 vcc, 0, v66
  s_nop 1
  v_cndmask_b32 v4, v4, v68, vcc
  v_cmp_eq_u32 vcc, 1, v66
  s_nop 1
  v_cndmask_b32 v4, v4, v69, vcc
  v_mov_b32 v5, 0
  v_cmp_eq_u32 vcc, 2, v66
  s_nop 1
  v_cndmask_b32 v5, v5, v68, vcc
  v_cmp_eq_u32 vcc, 3, v66
  s_nop 1
  v_cndmask_b32 v5, v5, v69, vcc
  v_mov_b32 v6, 0
  v_cmp_eq_u32 vcc, 4, v66
  s_nop 1
  v_cndmask_b32 v6, v6, v68, vcc
  v_cmp_eq_u32 vcc, 5, v66
  s_nop 1
  v_cndmask_b32 v6, v6, v69, vcc
  v_mov_b32 v7, 0
  v_cmp_eq_u32 vcc, 6, v66
  s_nop 1
  v_cndmask_b32 v7, v7, v68, vcc
  v_cmp_eq_u32 vcc, 7, v66
  s_nop 1
  v_cndmask_b32 v7, v7, v69, vcc
  v_lshrrev_b32 v64, 1, v116
  v_lshrrev_b32 v65, 3, v117
  v_cmp_eq_u32 s[26:27], v64, v65
  v_and_b32 v66, 1, v116
  v_add_u32 v64, 4, v64
  v_lshrrev_b32 v67, 1, v116
  v_lshlrev_b32 v67, 8, v67
  v_lshl_add_u32 v67, v66, 9, v67
  v_lshl_add_u32 v67, v117, 4, v67
  v_add_u32 v112, 59392, v67
  v_and_b32 v68, 7, v117
  v_lshlrev_b32 v67, 8, v64
  v_lshl_add_u32 v67, v68, 5, v67
  v_lshl_add_u32 v67, v66, 4, v67
  v_add_u32 v113, 65536, v67
  v_lshrrev_b32 v64, 5, v1
  v_and_b32 v65, 31, v1
  v_lshrrev_b32 v66, 3, v65
  v_and_b32 v67, 7, v65
  v_and_b32 v68, 3, v67
  v_lshl_add_u32 v68, v66, 2, v68
  v_lshrrev_b32 v69, 2, v67
  v_lshl_add_u32 v68, v69, 4, v68
  v_lshlrev_b32 v69, 11, v64
  v_lshl_add_u32 v69, v68, 4, v69
  v_add_u32 v114, 57856, v69
  v_add_u32 v70, 4, v64
  v_lshlrev_b32 v69, 9, v66
  v_lshl_add_u32 v69, v70, 5, v69
  v_lshl_add_u32 v69, v67, 2, v69
  v_add_u32 v115, 65536, v69
  v_lshlrev_b32 v69, 4, v68
  v_lshl_add_u32 v69, v64, 9, v69
  v_add_u32 v114, 59392, v69
  v_mul_u32_u24 v69, 144, v70
  v_lshl_add_u32 v69, v67, 4, v69
  v_add_u32 v115, 65536, v69
  v_and_b32 v71, 1, v116
  v_mul_u32_u24 v69, 2048, v71
  v_lshl_add_u32 v69, v64, 8, v69
  v_lshl_add_u32 v69, v117, 4, v69
  v_add_u32 v112, 57856, v69
  v_mul_u32_u24 v69, 144, v117
  v_lshl_add_u32 v69, v71, 6, v69
  v_lshl_add_u32 v69, v64, 5, v69
  v_add_u32 v113, 65544, v69
  v_mul_u32_u24 v69, 1024, v116
  v_lshl_add_u32 v69, v117, 4, v69
  v_and_b32 v72, 8, v117
  v_xor_b32 v72, 0, v72
  v_add_u32 v69, v69, v72
  v_add_u32 v112, 57856, v69
  v_lshrrev_b32 v72, 3, v117
  v_lshl_add_u32 v72, v71, 1, v72
  v_xor_b32 v72, 2, v72
  v_lshlrev_b32 v69, 10, v116
  v_lshl_add_u32 v69, v117, 4, v69
  v_lshl_add_u32 v69, v72, 2, v69
  v_add_u32 v112, 57344, v69
  v_lshrrev_b32 v69, 1, v117
  v_and_b32 v72, 1, v117
  v_lshl_add_u32 v69, v72, 3, v69
  v_mul_u32_u24 v69, 144, v69
  v_lshl_add_u32 v69, v71, 6, v69
  v_lshl_add_u32 v69, v64, 5, v69
  v_lshl_add_u32 v72, v72, 1, v71
  v_xor_b32 v72, 2, v72
  v_lshl_add_u32 v69, v72, 2, v69
  v_add_u32 v113, 65536, v69
  v_and_b32 v71, 1, v1
  v_cmp_eq_u32 s[38:39], 0, v71
  v_cmp_gt_u32 vcc, 8, v65
  s_or_b64 s[28:29], s[38:39], vcc
  v_lshrrev_b32 v72, 1, v67
  v_lshlrev_b32 v72, 2, v72
  v_lshl_add_u32 v72, v70, 4, v72
  s_lshl_b32 s22, s17, 9
  s_add_u32 s22, s22, 9216
  v_lshl_add_u32 v73, v66, 7, v72
  v_add_u32 v73, s22, v73
  s_lshl_b32 s22, s17, 7
  s_add_u32 s22, s22, 7168
  v_add_u32 v74, s22, v72
  v_bfe_u32 v72, v65, 1, 1
  v_lshlrev_b32 v72, 7, v72
  v_lshl_add_u32 v72, v70, 4, v72
  v_bfe_u32 v73, v65, 2, 2
  v_lshl_add_u32 v72, v73, 2, v72
  v_lshrrev_b32 v73, 4, v65
  v_lshl_add_u32 v73, v73, 8, v72
  s_lshl_b32 s22, s17, 9
  s_add_u32 s22, s22, 9216
  v_add_u32 v73, s22, v73
  s_lshr_b32 s22, s17, 1
  s_lshl_b32 s22, s22, 8
  s_and_b32 s34, s17, 1
  s_lshl_b32 s34, s34, 3
  s_add_u32 s22, s22, s34
  s_add_u32 s22, s22, 7168
  v_add_u32 v74, s22, v72
  v_bfe_u32 v72, v65, 1, 1
  v_lshl_add_u32 v72, v64, 1, v72
  v_lshlrev_b32 v72, 4, v72
  v_bfe_u32 v73, v65, 2, 2
  v_lshl_add_u32 v72, v73, 2, v72
  v_lshrrev_b32 v73, 4, v65
  v_lshl_add_u32 v73, v73, 6, v72
  s_lshl_b32 s22, s17, 9
  s_add_u32 s22, s22, 9472
  v_add_u32 v73, s22, v73
  v_lshrrev_b32 v72, 1, v65
  v_lshlrev_b32 v72, 2, v72
  v_lshl_add_u32 v72, v64, 5, v72
  s_lshr_b32 s22, s17, 1
  s_lshl_b32 s22, s22, 8
  s_and_b32 s34, s17, 1
  s_lshl_b32 s34, s34, 4
  s_add_u32 s22, s22, s34
  s_add_u32 s22, s22, 7296
  v_add_u32 v74, s22, v72
  v_lshlrev_b32 v0, 2, v65
  v_and_b32 v0, 120, v0
  s_and_b32 s22, s17, 15
  s_lshl_b32 s22, s22, 7
  s_add_u32 s22, s22, 18432
  v_add_u32 v0, s22, v0
  v_cndmask_b32 v1, v74, v73, s[38:39]
  s_lshl_b32 s36, s17, 2
  s_add_u32 s36, s36, 17472
  s_mov_b32 s37, 0x3e800000
  v_mov_b32 v36, 0
  v_mov_b32 v37, 0
  v_mov_b32 v38, 0
  v_mov_b32 v39, 0
  v_mov_b32 v40, 0
  v_mov_b32 v41, 0
  v_mov_b32 v42, 0
  v_mov_b32 v43, 0
  v_mov_b32 v44, 0
  v_mov_b32 v45, 0
  v_mov_b32 v46, 0
  v_mov_b32 v47, 0
  v_mov_b32 v48, 0
  v_mov_b32 v49, 0
  v_mov_b32 v50, 0
  v_mov_b32 v51, 0
  v_mov_b32 v52, 0
  v_mov_b32 v53, 0
  v_mov_b32 v54, 0
  v_mov_b32 v55, 0
  v_mov_b32 v56, 0
  v_mov_b32 v57, 0
  v_mov_b32 v58, 0
  v_mov_b32 v59, 0
  v_mov_b32 v60, 0
  v_mov_b32 v61, 0
  v_mov_b32 v62, 0
  v_mov_b32 v63, 0
  v_mov_b32 v64, 0
  v_mov_b32 v65, 0
  v_mov_b32 v66, 0
  v_mov_b32 v67, 0
  v_mov_b32 v68, 0
  v_mov_b32 v69, 0
  v_mov_b32 v70, 0
  v_mov_b32 v71, 0
  v_mov_b32 v72, 0
  v_mov_b32 v73, 0
  v_mov_b32 v74, 0
  v_mov_b32 v75, 0
  v_mov_b32 v76, 0
  v_mov_b32 v77, 0
  v_mov_b32 v78, 0
  v_mov_b32 v79, 0
  v_mov_b32 v80, 0
  v_mov_b32 v81, 0
  v_mov_b32 v82, 0
  v_mov_b32 v83, 0
  v_mov_b32 v84, 0
  v_mov_b32 v85, 0
  v_mov_b32 v86, 0
  v_mov_b32 v87, 0
  v_mov_b32 v88, 0
  v_mov_b32 v89, 0
  v_mov_b32 v90, 0
  v_mov_b32 v91, 0
  v_mov_b32 v92, 0
  v_mov_b32 v93, 0
  v_mov_b32 v94, 0
  v_mov_b32 v95, 0
  v_mov_b32 v96, 0
  v_mov_b32 v97, 0
  v_mov_b32 v98, 0
  v_mov_b32 v99, 0
  v_mov_b32 v100, 0
  v_mov_b32 v101, 0
  v_mov_b32 v102, 0
  v_mov_b32 v103, 0
  v_mov_b32 v104, 0
  v_mov_b32 v105, 0
  v_mov_b32 v106, 0
  v_mov_b32 v107, 0
  v_mov_b32 v108, 0
  v_mov_b32 v109, 0
  v_mov_b32 v110, 0
  v_mov_b32 v111, 0
  v_and_b32 v118, 1, v116
  v_cmp_eq_u32 vcc, 0, v118
  v_mov_b32 v118, 12544
  v_mov_b32 v119, 10240
  v_cndmask_b32 v118, v118, v119, vcc
  v_lshrrev_b32 v116, 1, v116
  v_lshl_add_u32 v118, v116, 9, v118
  v_lshl_add_u32 v117, v117, 4, v118
  s_mov_b32 s57, 28672
  v_bfe_u32 v118, v2, 4, 1
  v_mul_u32_u24 v118, 0xaaaa, v118
  v_add_u32 v118, 0x4444, v118
  s_mov_b32 s56, 0x42800000
  v_mov_b32 v116, v2
  v_lshrrev_b32 v0, 4, v2
  v_min_u32 v0, 13, v0
  s_mul_i32 s22, s17, 14
  v_add_u32 v0, s22, v0
  v_lshlrev_b32 v0, 7, v0
  v_add_u32 v0, 43008, v0
  s_mov_b32 s22, 71550976
  buffer_load_dword v119, v0, s[8:11], s22 offen sc1
  s_mov_b32 s22, 71522304
  buffer_load_dword v119, v0, s[8:11], s22 offen sc1
  s_mul_i32 s35, s17, 1835008
  s_add_u32 s35, s35, 42276864
  s_mov_b32 s30, 0
  v_mov_b32 v36, 0
ch_md2:
  buffer_load_dword v37, v36, s[12:15], 0 offen sc1
  s_waitcnt vmcnt(0)
  v_readfirstlane_b32 s22, v37
  s_and_b32 s31, s22, 0xffff
  s_cmp_ge_u32 s31, 32
  s_cbranch_scc1 ch_go2
  s_sleep 2
  s_add_u32 s30, s30, 1
  s_cmp_lt_u32 s30, 50000
  s_cbranch_scc1 ch_md2
  s_branch ch_end
ch_go2:
  s_mov_b32 s31, 0
  s_lshr_b32 s22, s22, 16
  s_cmp_lg_u32 s22, 0
  s_cbranch_scc1 cB_sc2_loop
  s_branch cA_sc2_loop
ch_init3:
  s_getpc_b64 s[98:99]
cpf_14:
  s_add_u32 s98, s98, cA_sc3_loop-cpf_14
  s_addc_u32 s99, s99, 0
  v_lshlrev_b32 v38, 2, v2
  global_load_dword v39, v38, s[98:99]
  s_mul_i32 s31, s17, 401408
  s_add_u32 s31, s31, 0
  s_mov_b32 s24, 71586816
  s_mov_b32 s25, 0
  s_add_u32 m0, s25, 21504
  s_nop 0
  buffer_load_dwordx4 v2, s[8:11], s24 offen offset:0 sc1 lds
  buffer_load_dwordx4 v2, s[8:11], s24 offen offset:1024 sc1 lds
  buffer_load_dwordx4 v2, s[8:11], s24 offen offset:2048 sc1 lds
  buffer_load_dwordx4 v2, s[8:11], s24 offen offset:3072 sc1 lds
  s_add_u32 m0, s25, 25600
  s_add_u32 s22, s24, 4096
  buffer_load_dwordx4 v2, s[8:11], s22 offen offset:0 sc1 lds
  buffer_load_dwordx4 v2, s[8:11], s22 offen offset:1024 sc1 lds
  buffer_load_dwordx4 v2, s[8:11], s22 offen offset:2048 sc1 lds
  v_lshrrev_b32 v64, 1, v117
  v_and_b32 v65, 1, v116
  v_lshlrev_b32 v65, 2, v65
  v_sub_u32 v64, v64, v65
  v_and_b32 v65, 1, v117
  v_lshl_add_u32 v66, v65, 2, v64
  v_cmp_gt_u32 vcc, 4, v64
  v_mov_b32 v67, 99
  s_nop 0
  v_cndmask_b32 v66, v67, v66, vcc
  v_mov_b32 v68, 0x3f80
  v_mov_b32 v69, 0x3f800000
  v_mov_b32 v4, 0
  v_cmp_eq_u32 vcc, 0, v66
  s_nop 1
  v_cndmask_b32 v4, v4, v68, vcc
  v_cmp_eq_u32 vcc, 1, v66
  s_nop 1
  v_cndmask_b32 v4, v4, v69, vcc
  v_mov_b32 v5, 0
  v_cmp_eq_u32 vcc, 2, v66
  s_nop 1
  v_cndmask_b32 v5, v5, v68, vcc
  v_cmp_eq_u32 vcc, 3, v66
  s_nop 1
  v_cndmask_b32 v5, v5, v69, vcc
  v_mov_b32 v6, 0
  v_cmp_eq_u32 vcc, 4, v66
  s_nop 1
  v_cndmask_b32 v6, v6, v68, vcc
  v_cmp_eq_u32 vcc, 5, v66
  s_nop 1
  v_cndmask_b32 v6, v6, v69, vcc
  v_mov_b32 v7, 0
  v_cmp_eq_u32 vcc, 6, v66
  s_nop 1
  v_cndmask_b32 v7, v7, v68, vcc
  v_cmp_eq_u32 vcc, 7, v66
  s_nop 1
  v_cndmask_b32 v7, v7, v69, vcc
  v_lshrrev_b32 v64, 1, v116
  v_lshrrev_b32 v65, 3, v117
  v_cmp_eq_u32 s[26:27], v64, v65
  v_and_b32 v66, 1, v116
  v_add_u32 v64, 6, v64
  v_lshrrev_b32 v67, 1, v116
  v_lshlrev_b32 v67, 8, v67
  v_lshl_add_u32 v67, v66, 9, v67
  v_lshl_add_u32 v67, v117, 4, v67
  v_add_u32 v112, 60416, v67
  v_and_b32 v68, 7, v117
  v_lshlrev_b32 v67, 8, v64
  v_lshl_add_u32 v67, v68, 5, v67
  v_lshl_add_u32 v67, v66, 4, v67
  v_add_u32 v113, 65536, v67
  v_lshrrev_b32 v64, 5, v1
  v_and_b32 v65, 31, v1
  v_lshrrev_b32 v66, 3, v65
  v_and_b32 v67, 7, v65
  v_and_b32 v68, 3, v67
  v_lshl_add_u32 v68, v66, 2, v68
  v_lshrrev_b32 v69, 2, v67
  v_lshl_add_u32 v68, v69, 4, v68
  v_lshlrev_b32 v69, 11, v64
  v_lshl_add_u32 v69, v68, 4, v69
  v_add_u32 v114, 57864, v69
  v_add_u32 v70, 6, v64
  v_lshlrev_b32 v69, 9, v66
  v_lshl_add_u32 v69, v70, 5, v69
  v_lshl_add_u32 v69, v67, 2, v69
  v_add_u32 v115, 65536, v69
  v_lshlrev_b32 v69, 4, v68
  v_lshl_add_u32 v69, v64, 9, v69
  v_add_u32 v114, 60416, v69
  v_mul_u32_u24 v69, 144, v70
  v_lshl_add_u32 v69, v67, 4, v69
  v_add_u32 v115, 65536, v69
  v_and_b32 v71, 1, v116
  v_mul_u32_u24 v69, 2048, v71
  v_lshl_add_u32 v69, v64, 8, v69
  v_lshl_add_u32 v69, v117, 4, v69
  v_add_u32 v112, 57864, v69
  v_mul_u32_u24 v69, 144, v117
  v_lshl_add_u32 v69, v71, 6, v69
  v_lshl_add_u32 v69, v64, 5, v69
  v_add_u32 v113, 65548, v69
  v_mul_u32_u24 v69, 1024, v116
  v_lshl_add_u32 v69, v117, 4, v69
  v_and_b32 v72, 8, v117
  v_xor_b32 v72, 8, v72
  v_add_u32 v69, v69, v72
  v_add_u32 v112, 57856, v69
  v_lshrrev_b32 v72, 3, v117
  v_lshl_add_u32 v72, v71, 1, v72
  v_xor_b32 v72, 3, v72
  v_lshlrev_b32 v69, 10, v116
  v_lshl_add_u32 v69, v117, 4, v69
  v_lshl_add_u32 v69, v72, 2, v69
  v_add_u32 v112, 57344, v69
  v_lshrrev_b32 v69, 1, v117
  v_and_b32 v72, 1, v117
  v_lshl_add_u32 v69, v72, 3, v69
  v_mul_u32_u24 v69, 144, v69
  v_lshl_add_u32 v69, v71, 6, v69
  v_lshl_add_u32 v69, v64, 5, v69
  v_lshl_add_u32 v72, v72, 1, v71
  v_xor_b32 v72, 3, v72
  v_lshl_add_u32 v69, v72, 2, v69
  v_add_u32 v113, 65536, v69
  v_and_b32 v71, 1, v1
  v_cmp_eq_u32 s[38:39], 0, v71
  v_cmp_gt_u32 vcc, 8, v65
  s_or_b64 s[28:29], s[38:39], vcc
  v_lshrrev_b32 v72, 1, v67
  v_lshlrev_b32 v72, 2, v72
  v_lshl_add_u32 v72, v70, 4, v72
  s_lshl_b32 s22, s17, 9
  s_add_u32 s22, s22, 9216
  v_lshl_add_u32 v73, v66, 7, v72
  v_add_u32 v73, s22, v73
  s_lshl_b32 s22, s17, 7
  s_add_u32 s22, s22, 7168
  v_add_u32 v74, s22, v72
  v_bfe_u32 v72, v65, 1, 1
  v_lshlrev_b32 v72, 7, v72
  v_lshl_add_u32 v72, v70, 4, v72
  v_bfe_u32 v73, v65, 2, 2
  v_lshl_add_u32 v72, v73, 2, v72
  v_lshrrev_b32 v73, 4, v65
  v_lshl_add_u32 v73, v73, 8, v72
  s_lshl_b32 s22, s17, 9
  s_add_u32 s22, s22, 9216
  v_add_u32 v73, s22, v73
  s_lshr_b32 s22, s17, 1
  s_lshl_b32 s22, s22, 8
  s_and_b32 s34, s17, 1
  s_lshl_b32 s34, s34, 3
  s_add_u32 s22, s22, s34
  s_add_u32 s22, s22, 7168
  v_add_u32 v74, s22, v72
  v_bfe_u32 v72, v65, 1, 1
  v_lshl_add_u32 v72, v64, 1, v72
  v_lshlrev_b32 v72, 4, v72
  v_bfe_u32 v73, v65, 2, 2
  v_lshl_add_u32 v72, v73, 2, v72
  v_lshrrev_b32 v73, 4, v65
  v_lshl_add_u32 v73, v73, 6, v72
  s_lshl_b32 s22, s17, 9
  s_add_u32 s22, s22, 9600
  v_add_u32 v73, s22, v73
  v_lshrrev_b32 v72, 1, v65
  v_lshlrev_b32 v72, 2, v72
  v_lshl_add_u32 v72, v64, 5, v72
  s_lshr_b32 s22, s17, 1
  s_lshl_b32 s22, s22, 8
  s_and_b32 s34, s17, 1
  s_lshl_b32 s34, s34, 4
  s_add_u32 s22, s22, s34
  s_add_u32 s22, s22, 7360
  v_add_u32 v74, s22, v72
  v_lshlrev_b32 v0, 2, v65
  v_and_b32 v0, 120, v0
  s_and_b32 s22, s17, 15
  s_lshl_b32 s22, s22, 7
  s_add_u32 s22, s22, 18432
  v_add_u32 v0, s22, v0
  v_cndmask_b32 v1, v74, v73, s[38:39]
  s_lshl_b32 s36, s17, 2
  s_add_u32 s36, s36, 17472
  s_mov_b32 s37, 0x3e800000
  v_mov_b32 v36, 0
  v_mov_b32 v37, 0
  v_mov_b32 v38, 0
  v_mov_b32 v39, 0
  v_mov_b32 v40, 0
  v_mov_b32 v41, 0
  v_mov_b32 v42, 0
  v_mov_b32 v43, 0
  v_mov_b32 v44, 0
  v_mov_b32 v45, 0
  v_mov_b32 v46, 0
  v_mov_b32 v47, 0
  v_mov_b32 v48, 0
  v_mov_b32 v49, 0
  v_mov_b32 v50, 0
  v_mov_b32 v51, 0
  v_mov_b32 v52, 0
  v_mov_b32 v53, 0
  v_mov_b32 v54, 0
  v_mov_b32 v55, 0
  v_mov_b32 v56, 0
  v_mov_b32 v57, 0
  v_mov_b32 v58, 0
  v_mov_b32 v59, 0
  v_mov_b32 v60, 0
  v_mov_b32 v61, 0
  v_mov_b32 v62, 0
  v_mov_b32 v63, 0
  v_mov_b32 v64, 0
  v_mov_b32 v65, 0
  v_mov_b32 v66, 0
  v_mov_b32 v67, 0
  v_mov_b32 v68, 0
  v_mov_b32 v69, 0
  v_mov_b32 v70, 0
  v_mov_b32 v71, 0
  v_mov_b32 v72, 0
  v_mov_b32 v73, 0
  v_mov_b32 v74, 0
  v_mov_b32 v75, 0
  v_mov_b32 v76, 0
  v_mov_b32 v77, 0
  v_mov_b32 v78, 0
  v_mov_b32 v79, 0
  v_mov_b32 v80, 0
  v_mov_b32 v81, 0
  v_mov_b32 v82, 0
  v_mov_b32 v83, 0
  v_mov_b32 v84, 0
  v_mov_b32 v85, 0
  v_mov_b32 v86, 0
  v_mov_b32 v87, 0
  v_mov_b32 v88, 0
  v_mov_b32 v89, 0
  v_mov_b32 v90, 0
  v_mov_b32 v91, 0
  v_mov_b32 v92, 0
  v_mov_b32 v93, 0
  v_mov_b32 v94, 0
  v_mov_b32 v95, 0
  v_mov_b32 v96, 0
  v_mov_b32 v97, 0
  v_mov_b32 v98, 0
  v_mov_b32 v99, 0
  v_mov_b32 v100, 0
  v_mov_b32 v101, 0
  v_mov_b32 v102, 0
  v_mov_b32 v103, 0
  v_mov_b32 v104, 0
  v_mov_b32 v105, 0
  v_mov_b32 v106, 0
  v_mov_b32 v107, 0
  v_mov_b32 v108, 0
  v_mov_b32 v109, 0
  v_mov_b32 v110, 0
  v_mov_b32 v111, 0
  v_and_b32 v118, 1, v116
  v_cmp_eq_u32 vcc, 0, v118
  v_mov_b32 v118, 12544
  v_mov_b32 v119, 10496
  v_cndmask_b32 v118, v118, v119, vcc
  v_lshrrev_b32 v116, 1, v116
  v_lshl_add_u32 v118, v116, 9, v118
  v_lshl_add_u32 v117, v117, 4, v118
  s_mov_b32 s57, 28672
  v_bfe_u32 v118, v2, 4, 1
  v_mul_u32_u24 v118, 0xaaaa, v118
  v_add_u32 v118, 0x4444, v118
  s_mov_b32 s56, 0x42800000
  v_mov_b32 v116, v2
  s_mul_i32 s35, s17, 1835008
  s_add_u32 s35, s35, 42284032
  s_mov_b32 s30, 0
  v_mov_b32 v36, 0
ch_md3:
  buffer_load_dword v37, v36, s[12:15], 0 offen sc1
  s_waitcnt vmcnt(0)
  v_readfirstlane_b32 s22, v37
  s_and_b32 s31, s22, 0xffff
  s_cmp_ge_u32 s31, 32
  s_cbranch_scc1 ch_go3
  s_sleep 2
  s_add_u32 s30, s30, 1
  s_cmp_lt_u32 s30, 50000
  s_cbranch_scc1 ch_md3
  s_branch ch_end
ch_go3:
  s_mov_b32 s31, 0
  s_lshr_b32 s22, s22, 16
  s_cmp_lg_u32 s22, 0
  s_cbranch_scc1 cB_sc3_loop
  s_branch cA_sc3_loop
ch_init4:
  s_mul_i32 s31, s17, 401408
  s_add_u32 s31, s31, 6422528
  s_lshl_b32 s22, s17, 4
  v_mov_b32 v38, s22
  v_mov_b32 v36, v38
  v_med3_u32 v37, v117, 0, 5
  v_lshrrev_b32 v36, 6, v36
  v_lshlrev_b32 v36, 8, v36
  v_lshl_add_u32 v36, v37, 4, v36
  s_mov_b32 s22, 88600576
  s_mov_b32 s30, 0
va_bw_16:
  buffer_load_dwordx4 v[40:43], v36, s[8:11], s22 offen sc1
  s_waitcnt vmcnt(0)
  v_cmp_ne_u64 vcc, s[88:89], v[40:41]
  s_cbranch_vccnz va_bw_16_no
  v_cmp_ne_u64 vcc, s[88:89], v[42:43]
  s_cbranch_vccnz va_bw_16_no
  s_branch va_bw_16_ok
va_bw_16_no:
  s_sleep 2
  s_add_u32 s30, s30, 1
  s_cmp_lt_u32 s30, 50000
  s_cbranch_scc1 va_bw_16
  s_branch cA_abort
va_bw_16_ok:
  s_add_u32 s22, s31, 0
  buffer_load_dwordx4 a[0:3], v2, s[8:11], s22 offen offset:0 sc1
  buffer_load_dwordx4 a[4:7], v2, s[8:11], s22 offen offset:1024 sc1
  buffer_load_dwordx4 a[8:11], v2, s[8:11], s22 offen offset:2048 sc1
  buffer_load_dwordx4 a[12:15], v2, s[8:11], s22 offen offset:3072 sc1
  s_add_u32 s22, s31, 4096
  buffer_load_dwordx4 a[16:19], v2, s[8:11], s22 offen offset:0 sc1
  buffer_load_dwordx4 a[20:23], v2, s[8:11], s22 offen offset:1024 sc1
  buffer_load_dwordx4 a[24:27], v2, s[8:11], s22 offen offset:2048 sc1
  buffer_load_dwordx4 a[28:31], v2, s[8:11], s22 offen offset:3072 sc1
  s_add_u32 s22, s31, 8192
  buffer_load_dwordx4 a[32:35], v2, s[8:11], s22 offen offset:0 sc1
  buffer_load_dwordx4 a[36:39], v2, s[8:11], s22 offen offset:1024 sc1
  buffer_load_dwordx4 a[40:43], v2, s[8:11], s22 offen offset:2048 sc1
  buffer_load_dwordx4 a[44:47], v2, s[8:11], s22 offen offset:3072 sc1
  s_add_u32 s22, s31, 12288
  buffer_load_dwordx4 a[48:51], v2, s[8:11], s22 offen offset:0 sc1
  buffer_load_dwordx4 a[52:55], v2, s[8:11], s22 offen offset:1024 sc1
  buffer_load_dwordx4 a[56:59], v2, s[8:11], s22 offen offset:2048 sc1
  buffer_load_dwordx4 a[60:63], v2, s[8:11], s22 offen offset:3072 sc1
  s_add_u32 s22, s31, 16384
  buffer_load_dwordx4 a[64:67], v2, s[8:11], s22 offen offset:0 sc1
  buffer_load_dwordx4 a[68:71], v2, s[8:11], s22 offen offset:1024 sc1
  buffer_load_dwordx4 a[72:75], v2, s[8:11], s22 offen offset:2048 sc1
  buffer_load_dwordx4 a[76:79], v2, s[8:11], s22 offen offset:3072 sc1
  s_add_u32 s22, s31, 20480
  buffer_load_dwordx4 a[80:83], v2, s[8:11], s22 offen offset:0 sc1
  buffer_load_dwordx4 a[84:87], v2, s[8:11], s22 offen offset:1024 sc1
  buffer_load_dwordx4 a[88:91], v2, s[8:11], s22 offen offset:2048 sc1
  buffer_load_dwordx4 a[92:95], v2, s[8:11], s22 offen offset:3072 sc1
  s_add_u32 s22, s31, 24576
  buffer_load_dwordx4 a[96:99], v2, s[8:11], s22 offen offset:0 sc1
  buffer_load_dwordx4 a[100:103], v2, s[8:11], s22 offen offset:1024 sc1
  buffer_load_dwordx4 a[104:107], v2, s[8:11], s22 offen offset:2048 sc1
  buffer_load_dwordx4 a[108:111], v2, s[8:11], s22 offen offset:3072 sc1
  s_add_u32 s22, s31, 28672
  buffer_load_dwordx4 a[112:115], v2, s[8:11], s22 offen offset:0 sc1
  buffer_load_dwordx4 a[116:119], v2, s[8:11], s22 offen offset:1024 sc1
  buffer_load_dwordx4 a[120:123], v2, s[8:11], s22 offen offset:2048 sc1
  buffer_load_dwordx4 a[124:127], v2, s[8:11], s22 offen offset:3072 sc1
  s_waitcnt vmcnt(24)
  s_add_u32 s22, s31, 32768
  buffer_load_dwordx4 a[128:131], v2, s[8:11], s22 offen offset:0 sc1
  buffer_load_dwordx4 a[132:135], v2, s[8:11], s22 offen offset:1024 sc1
  buffer_load_dwordx4 a[136:139], v2, s[8:11], s22 offen offset:2048 sc1
  buffer_load_dwordx4 a[140:143], v2, s[8:11], s22 offen offset:3072 sc1
  s_add_u32 s22, s31, 36864
  buffer_load_dwordx4 a[144:147], v2, s[8:11], s22 offen offset:0 sc1
  buffer_load_dwordx4 a[148:151], v2, s[8:11], s22 offen offset:1024 sc1
  buffer_load_dwordx4 a[152:155], v2, s[8:11], s22 offen offset:2048 sc1
  buffer_load_dwordx4 a[156:159], v2, s[8:11], s22 offen offset:3072 sc1
  s_add_u32 s22, s31, 40960
  buffer_load_dwordx4 a[160:163], v2, s[8:11], s22 offen offset:0 sc1
  buffer_load_dwordx4 a[164:167], v2, s[8:11], s22 offen offset:1024 sc1
  buffer_load_dwordx4 a[168:171], v2, s[8:11], s22 offen offset:2048 sc1
  buffer_load_dwordx4 a[172:175], v2, s[8:11], s22 offen offset:3072 sc1
  s_add_u32 s22, s31, 45056
  buffer_load_dwordx4 a[176:179], v2, s[8:11], s22 offen offset:0 sc1
  buffer_load_dwordx4 a[180:183], v2, s[8:11], s22 offen offset:1024 sc1
  buffer_load_dwordx4 a[184:187], v2, s[8:11], s22 offen offset:2048 sc1
  buffer_load_dwordx4 a[188:191], v2, s[8:11], s22 offen offset:3072 sc1
  s_add_u32 s22, s31, 49152
  buffer_load_dwordx4 a[192:195], v2, s[8:11], s22 offen offset:0 sc1
  buffer_load_dwordx4 a[196:199], v2, s[8:11], s22 offen offset:1024 sc1
  buffer_load_dwordx4 a[200:203], v2, s[8:11], s22 offen offset:2048 sc1
  buffer_load_dwordx4 a[204:207], v2, s[8:11], s22 offen offset:3072 sc1
  s_add_u32 s22, s31, 53248
  buffer_load_dwordx4 a[208:211], v2, s[8:11], s22 offen offset:0 sc1
  buffer_load_dwordx4 a[212:215], v2, s[8:11], s22 offen offset:1024 sc1
  buffer_load_dwordx4 a[216:219], v2, s[8:11], s22 offen offset:2048 sc1
  buffer_load_dwordx4 a[220:223], v2, s[8:11], s22 offen offset:3072 sc1
  s_add_u32 s22, s31, 57344
  buffer_load_dwordx4 a[224:227], v2, s[8:11], s22 offen offset:0 sc1
  buffer_load_dwordx4 a[228:231], v2, s[8:11], s22 offen offset:1024 sc1
  buffer_load_dwordx4 a[232:235], v2, s[8:11], s22 offen offset:2048 sc1
  buffer_load_dwordx4 a[236:239], v2, s[8:11], s22 offen offset:3072 sc1
  s_add_u32 s22, s31, 61440
  buffer_load_dwordx4 a[240:243], v2, s[8:11], s22 offen offset:0 sc1
  buffer_load_dwordx4 a[244:247], v2, s[8:11], s22 offen offset:1024 sc1
  buffer_load_dwordx4 a[248:251], v2, s[8:11], s22 offen offset:2048 sc1
  buffer_load_dwordx4 a[252:255], v2, s[8:11], s22 offen offset:3072 sc1
  s_waitcnt vmcnt(24)
  s_add_u32 s22, s31, 65536
  buffer_load_dwordx4 v[176:179], v2, s[8:11], s22 offen offset:0 sc1
  buffer_load_dwordx4 v[180:183], v2, s[8:11], s22 offen offset:1024 sc1
  buffer_load_dwordx4 v[184:187], v2, s[8:11], s22 offen offset:2048 sc1
  buffer_load_dwordx4 v[188:191], v2, s[8:11], s22 offen offset:3072 sc1
  s_add_u32 s22, s31, 69632
  buffer_load_dwordx4 v[192:195], v2, s[8:11], s22 offen offset:0 sc1
  buffer_load_dwordx4 v[196:199], v2, s[8:11], s22 offen offset:1024 sc1
  buffer_load_dwordx4 v[200:203], v2, s[8:11], s22 offen offset:2048 sc1
  buffer_load_dwordx4 v[204:207], v2, s[8:11], s22 offen offset:3072 sc1
  s_add_u32 s22, s31, 73728
  buffer_load_dwordx4 v[208:211], v2, s[8:11], s22 offen offset:0 sc1
  buffer_load_dwordx4 v[212:215], v2, s[8:11], s22 offen offset:1024 sc1
  buffer_load_dwordx4 v[216:219], v2, s[8:11], s22 offen offset:2048 sc1
  buffer_load_dwordx4 v[220:223], v2, s[8:11], s22 offen offset:3072 sc1
  s_add_u32 s22, s31, 77824
  buffer_load_dwordx4 v[224:227], v2, s[8:11], s22 offen offset:0 sc1
  buffer_load_dwordx4 v[228:231], v2, s[8:11], s22 offen offset:1024 sc1
  buffer_load_dwordx4 v[232:235], v2, s[8:11], s22 offen offset:2048 sc1
  buffer_load_dwordx4 v[236:239], v2, s[8:11], s22 offen offset:3072 sc1
  s_add_u32 s22, s31, 81920
  buffer_load_dwordx4 v[240:243], v2, s[8:11], s22 offen offset:0 sc1
  buffer_load_dwordx4 v[244:247], v2, s[8:11], s22 offen offset:1024 sc1
  buffer_load_dwordx4 v[248:251], v2, s[8:11], s22 offen offset:2048 sc1
  buffer_load_dwordx4 v[252:255], v2, s[8:11], s22 offen offset:3072 sc1
  s_lshl_b32 s22, s17, 4
  v_mov_b32 v38, s22
  s_mul_i32 s22, s17, 12
  s_add_u32 s23, s22, 267
  s_add_u32 s22, s22, 256
  v_mov_b32 v36, s23
  v_mov_b32 v37, s22
  v_cmp_eq_u32 vcc, 1, v116
  s_nop 1
  v_cndmask_b32 v36, v36, v37, vcc
  v_med3_u32 v37, v117, 4, 5
  v_lshrrev_b32 v36, 6, v36
  v_lshlrev_b32 v36, 8, v36
  v_lshl_add_u32 v36, v37, 4, v36
  s_mov_b32 s22, 88600576
  s_mov_b32 s30, 0
va_bw_17:
  buffer_load_dwordx4 v[40:43], v36, s[8:11], s22 offen sc1
  s_waitcnt vmcnt(0)
  v_cmp_ne_u64 vcc, s[88:89], v[40:41]
  s_cbranch_vccnz va_bw_17_no
  v_cmp_ne_u64 vcc, s[88:89], v[42:43]
  s_cbranch_vccnz va_bw_17_no
  s_branch va_bw_17_ok
va_bw_17_no:
  s_sleep 2
  s_add_u32 s30, s30, 1
  s_cmp_lt_u32 s30, 50000
  s_cbranch_scc1 va_bw_17
  s_branch cA_abort
va_bw_17_ok:
  s_mov_b32 m0, 16384
  s_add_u32 s22, s31, 272384
  buffer_load_dwordx4 v2, s[8:11], s22 offen offset:0 sc1 lds
  buffer_load_dwordx4 v2, s[8:11], s22 offen offset:1024 sc1 lds
  buffer_load_dwordx4 v2, s[8:11], s22 offen offset:2048 sc1 lds
  buffer_load_dwordx4 v2, s[8:11], s22 offen offset:3072 sc1 lds
  s_mov_b32 m0, 20480
  s_add_u32 s22, s31, 276480
  buffer_load_dwordx4 v2, s[8:11], s22 offen offset:0 sc1 lds
  buffer_load_dwordx4 v2, s[8:11], s22 offen offset:1024 sc1 lds
  buffer_load_dwordx4 v2, s[8:11], s22 offen offset:2048 sc1 lds
  buffer_load_dwordx4 v2, s[8:11], s22 offen offset:3072 sc1 lds
  s_mov_b32 m0, 24576
  s_add_u32 s22, s31, 280576
  buffer_load_dwordx4 v2, s[8:11], s22 offen offset:0 sc1 lds
  buffer_load_dwordx4 v2, s[8:11], s22 offen offset:1024 sc1 lds
  buffer_load_dwordx4 v2, s[8:11], s22 offen offset:2048 sc1 lds
  buffer_load_dwordx4 v2, s[8:11], s22 offen offset:3072 sc1 lds
  s_mov_b32 m0, 28672
  s_add_u32 s22, s31, 284672
  buffer_load_dwordx4 v2, s[8:11], s22 offen offset:0 sc1 lds
  buffer_load_dwordx4 v2, s[8:11], s22 offen offset:1024 sc1 lds
  v_mov_b32 v72, v116
  v_mov_b32 v73, v117
  v_lshrrev_b32 v65, 1, v72
  v_and_b32 v66, 1, v72
  v_mov_b32 v68, 0
  v_mov_b32 v69, v73
  v_mov_b32 v70, 0
  v_and_b32 v71, 1, v69
  v_lshrrev_b32 v69, 1, v69
  v_lshl_add_u32 v69, v71, 3, v69
  v_lshlrev_b32 v71, 12, v70
  v_lshrrev_b32 v70, 1, v68
  v_lshl_add_u32 v71, v70, 9, v71
  v_and_b32 v70, 1, v68
  v_lshl_add_u32 v71, v70, 2, v71
  v_lshl_add_u32 v71, v69, 4, v71
  v_lshl_add_u32 v71, v65, 8, v71
  v_lshl_add_u32 v60, v66, 3, v71
  v_mov_b32 v68, 1
  v_mov_b32 v69, v73
  v_mov_b32 v70, 0
  v_and_b32 v71, 1, v69
  v_lshrrev_b32 v69, 1, v69
  v_lshl_add_u32 v69, v71, 3, v69
  v_lshlrev_b32 v71, 12, v70
  v_lshrrev_b32 v70, 1, v68
  v_lshl_add_u32 v71, v70, 9, v71
  v_and_b32 v70, 1, v68
  v_lshl_add_u32 v71, v70, 2, v71
  v_lshl_add_u32 v71, v69, 4, v71
  v_lshl_add_u32 v71, v65, 8, v71
  v_lshl_add_u32 v61, v66, 3, v71
  v_mov_b32 v68, 2
  v_mov_b32 v69, v73
  v_mov_b32 v70, 0
  v_and_b32 v71, 1, v69
  v_lshrrev_b32 v69, 1, v69
  v_lshl_add_u32 v69, v71, 3, v69
  v_lshlrev_b32 v71, 12, v70
  v_lshrrev_b32 v70, 1, v68
  v_lshl_add_u32 v71, v70, 9, v71
  v_and_b32 v70, 1, v68
  v_lshl_add_u32 v71, v70, 2, v71
  v_lshl_add_u32 v71, v69, 4, v71
  v_lshl_add_u32 v71, v65, 8, v71
  v_lshl_add_u32 v62, v66, 3, v71
  v_mov_b32 v68, 3
  v_mov_b32 v69, v73
  v_mov_b32 v70, 0
  v_and_b32 v71, 1, v69
  v_lshrrev_b32 v69, 1, v69
  v_lshl_add_u32 v69, v71, 3, v69
  v_lshlrev_b32 v71, 12, v70
  v_lshrrev_b32 v70, 1, v68
  v_lshl_add_u32 v71, v70, 9, v71
  v_and_b32 v70, 1, v68
  v_lshl_add_u32 v71, v70, 2, v71
  v_lshl_add_u32 v71, v69, 4, v71
  v_lshl_add_u32 v71, v65, 8, v71
  v_lshl_add_u32 v170, v66, 3, v71
  v_mov_b32 v68, 4
  v_mov_b32 v69, v73
  v_mov_b32 v70, 0
  v_and_b32 v71, 1, v69
  v_lshrrev_b32 v69, 1, v69
  v_lshl_add_u32 v69, v71, 3, v69
  v_lshlrev_b32 v71, 12, v70
  v_lshrrev_b32 v70, 1, v68
  v_lshl_add_u32 v71, v70, 9, v71
  v_and_b32 v70, 1, v68
  v_lshl_add_u32 v71, v70, 2, v71
  v_lshl_add_u32 v71, v69, 4, v71
  v_lshl_add_u32 v71, v65, 8, v71
  v_lshl_add_u32 v171, v66, 3, v71
  v_mov_b32 v68, 5
  v_mov_b32 v69, v73
  v_mov_b32 v70, 0
  v_and_b32 v71, 1, v69
  v_lshrrev_b32 v69, 1, v69
  v_lshl_add_u32 v69, v71, 3, v69
  v_lshlrev_b32 v71, 12, v70
  v_lshrrev_b32 v70, 1, v68
  v_lshl_add_u32 v71, v70, 9, v71
  v_and_b32 v70, 1, v68
  v_lshl_add_u32 v71, v70, 2, v71
  v_lshl_add_u32 v71, v69, 4, v71
  v_lshl_add_u32 v71, v65, 8, v71
  v_lshl_add_u32 v172, v66, 3, v71
  v_and_b32 v0, 31, v1
  v_lshlrev_b32 v0, 2, v0
  v_add_u32 v0, 18432, v0
  v_min_u32 v4, 15, v73
  v_lshlrev_b32 v4, 2, v4
  s_and_b32 s22, s17, 3
  s_lshl_b32 s22, s22, 7
  s_add_u32 s22, s22, 17408
  v_add_u32 v4, s22, v4
  v_and_b32 v64, 7, v73
  v_lshlrev_b32 v5, 4, v64
  v_lshl_add_u32 v5, v72, 7, v5
  v_lshrrev_b32 v65, 3, v73
  v_lshl_add_u32 v5, v65, 9, v5
  s_lshl_b32 s22, s17, 3
  s_add_u32 s22, s22, 18432
  v_lshl_add_u32 v7, v2, 3, s22
  v_add_u32 v65, 0, v73
  v_min_u32 v65, 27, v65
  v_mad_u32_u24 v65, v72, 28, v65
  v_lshlrev_b32 v6, 4, v65
  s_lshr_b32 s22, s17, 1
  s_mul_i32 s22, s22, 7
  s_and_b32 s34, s17, 1
  s_lshl_b32 s35, s34, 2
  v_add_u32 v70, s35, v72
  v_mov_b32 v71, s34
  v_mov_b32 v69, 0
  v_cmp_eq_u32 vcc, 3, v72
  s_nop 1
  v_cndmask_b32 v70, v70, v72, vcc
  v_cndmask_b32 v69, v69, v71, vcc
  v_add_u32 v70, s22, v70
  v_lshrrev_b32 v68, 1, v70
  v_lshlrev_b32 v68, 8, v68
  v_lshl_add_u32 v68, v69, 7, v68
  v_and_b32 v69, 1, v70
  v_lshl_add_u32 v68, v69, 3, v68
  v_lshl_add_u32 v1, v64, 4, v68
  v_cmp_gt_u32 s[26:27], 8, v73
  v_lshrrev_b32 v65, 3, v73
  v_min_u32 v66, 7, v64
  v_lshl_add_u32 v66, v66, 1, v65
  v_mad_u32_u24 v66, v72, 16, v66
  v_lshlrev_b32 v66, 4, v66
  v_add_u32 v6, 0, v66
  s_mul_i32 s22, s17, 16
  s_add_u32 s22, s22, 0
  v_lshl_add_u32 v70, v64, 1, s22
  v_lshrrev_b32 v68, 4, v70
  v_lshlrev_b32 v68, 8, v68
  v_bfe_u32 v69, v70, 1, 1
  v_lshl_add_u32 v68, v69, 7, v68
  v_bfe_u32 v69, v70, 2, 2
  v_lshl_add_u32 v68, v69, 2, v68
  v_and_b32 v69, 1, v72
  v_lshl_add_u32 v65, v69, 2, v65
  v_lshrrev_b32 v69, 1, v72
  v_lshl_add_u32 v65, v69, 1, v65
  v_lshrrev_b32 v65, 3, v73
  v_lshl_add_u32 v65, v72, 1, v65
  v_lshrrev_b32 v5, 1, v72
  v_lshlrev_b32 v5, 9, v5
  v_lshrrev_b32 v69, 2, v73
  v_lshl_add_u32 v5, v69, 7, v5
  v_and_b32 v69, 1, v72
  v_lshl_add_u32 v5, v69, 6, v5
  v_and_b32 v69, 3, v73
  v_lshl_add_u32 v5, v69, 4, v5
  v_and_b32 v69, 1, v73
  v_mul_u32_u24 v69, 0xaaaa, v69
  v_add_u32 v0, 0x4444, v69
  v_lshl_add_u32 v1, v65, 4, v68
  v_cmp_gt_u32 s[26:27], 6, v64
  v_mov_b32 v156, 0
  v_mov_b32 v157, 0
  v_mov_b32 v158, 0
  v_mov_b32 v159, 0
  ds_write_b128 v2, v[156:159] offset:0
  ds_write_b128 v2, v[156:159] offset:1024
  ds_write_b128 v2, v[156:159] offset:2048
  ds_write_b128 v2, v[156:159] offset:3072
  s_mul_i32 s22, s17, 1835008
  s_add_u32 s25, s22, 42205184
  s_lshl_b32 s35, s17, 7
  s_add_u32 s35, s35, 88539136
  s_add_u32 s39, s35, 16384
  s_mov_b32 s38, 0
  v_mov_b32 v63, 0
  v_bfe_u32 v8, v2, 4, 1
  v_mul_u32_u24 v3, 0xaaaa, v8
  v_add_u32 v3, 0x4444, v3
  v_bfe_u32 v9, v2, 5, 3
  v_lshl_add_u32 v8, v8, 3, v9
  v_and_b32 v9, 0x300, v2
  v_lshl_add_u32 v0, v8, 4, v9
  s_getpc_b64 s[98:99]
cpf_15:
  s_add_u32 s98, s98, cA_va0_loop-cpf_15
  s_addc_u32 s99, s99, 0
  v_lshlrev_b32 v38, 2, v2
  global_load_dword v39, v38, s[98:99]
  s_lshl_b32 s22, 0, 11
  s_add_u32 s22, s22, 88602624
  v_add_u32 v36, 1024, v2
  v_min_u32 v36, 1776, v36
  s_mov_b32 s30, 0
va_iw4:
  buffer_load_dwordx4 v[40:43], v2, s[8:11], s22 offen sc1
  buffer_load_dwordx4 v[44:47], v36, s[8:11], s22 offen sc1
  s_waitcnt vmcnt(0)
  v_cmp_ne_u64 vcc, s[88:89], v[40:41]
  s_cbranch_vccnz va_iw4_no
  v_cmp_ne_u64 vcc, s[88:89], v[42:43]
  s_cbranch_vccnz va_iw4_no
  v_cmp_ne_u64 vcc, s[88:89], v[44:45]
  s_cbranch_vccnz va_iw4_no
  v_cmp_ne_u64 vcc, s[88:89], v[46:47]
  s_cbranch_vccnz va_iw4_no
  s_branch va_iw4_ok
va_iw4_no:
  s_sleep 2
  s_add_u32 s30, s30, 1
  s_cmp_lt_u32 s30, 50000
  s_cbranch_scc1 va_iw4
  s_branch cA_abort
va_iw4_ok:
  s_mov_b32 s30, 0
  v_mov_b32 v36, 0
ch_md4:
  buffer_load_dword v37, v36, s[12:15], 0 offen sc1
  s_waitcnt vmcnt(0)
  v_readfirstlane_b32 s22, v37
  s_and_b32 s31, s22, 0xffff
  s_cmp_ge_u32 s31, 32
  s_cbranch_scc1 ch_go4
  s_sleep 2
  s_add_u32 s30, s30, 1
  s_cmp_lt_u32 s30, 50000
  s_cbranch_scc1 ch_md4
  s_branch ch_end
ch_go4:
  s_mov_b32 s31, 0
  v_mov_b32 v36, 0
  v_mov_b32 v37, 0
  v_mov_b32 v38, 0
  v_mov_b32 v39, 0
  v_mov_b32 v40, 0
  v_mov_b32 v41, 0
  v_mov_b32 v42, 0
  v_mov_b32 v43, 0
  v_mov_b32 v44, 0
  v_mov_b32 v45, 0
  v_mov_b32 v46, 0
  v_mov_b32 v47, 0
  v_mov_b32 v48, 0
  v_mov_b32 v49, 0
  v_mov_b32 v50, 0
  v_mov_b32 v51, 0
  v_mov_b32 v52, 0
  v_mov_b32 v53, 0
  v_mov_b32 v54, 0
  v_mov_b32 v55, 0
  v_mov_b32 v56, 0
  v_mov_b32 v57, 0
  v_mov_b32 v58, 0
  v_mov_b32 v59, 0
  s_lshr_b32 s22, s22, 16
  s_cmp_lg_u32 s22, 0
  s_cbranch_scc1 cB_va0_loop
  s_branch cA_va0_loop
ch_init5:
  s_mul_i32 s31, s17, 401408
  s_add_u32 s31, s31, 6422528
  s_lshl_b32 s22, s17, 4
  v_mov_b32 v38, s22
  v_mov_b32 v36, v38
  v_med3_u32 v37, v117, 6, 11
  v_lshrrev_b32 v36, 6, v36
  v_lshlrev_b32 v36, 8, v36
  v_lshl_add_u32 v36, v37, 4, v36
  s_mov_b32 s22, 88600576
  s_mov_b32 s30, 0
va_bw_19:
  buffer_load_dwordx4 v[40:43], v36, s[8:11], s22 offen sc1
  s_waitcnt vmcnt(0)
  v_cmp_ne_u64 vcc, s[88:89], v[40:41]
  s_cbranch_vccnz va_bw_19_no
  v_cmp_ne_u64 vcc, s[88:89], v[42:43]
  s_cbranch_vccnz va_bw_19_no
  s_branch va_bw_19_ok
va_bw_19_no:
  s_sleep 2
  s_add_u32 s30, s30, 1
  s_cmp_lt_u32 s30, 50000
  s_cbranch_scc1 va_bw_19
  s_branch cA_abort
va_bw_19_ok:
  s_add_u32 s22, s31, 86016
  buffer_load_dwordx4 a[0:3], v2, s[8:11], s22 offen offset:0 sc1
  buffer_load_dwordx4 a[4:7], v2, s[8:11], s22 offen offset:1024 sc1
  buffer_load_dwordx4 a[8:11], v2, s[8:11], s22 offen offset:2048 sc1
  buffer_load_dwordx4 a[12:15], v2, s[8:11], s22 offen offset:3072 sc1
  s_add_u32 s22, s31, 90112
  buffer_load_dwordx4 a[16:19], v2, s[8:11], s22 offen offset:0 sc1
  buffer_load_dwordx4 a[20:23], v2, s[8:11], s22 offen offset:1024 sc1
  buffer_load_dwordx4 a[24:27], v2, s[8:11], s22 offen offset:2048 sc1
  buffer_load_dwordx4 a[28:31], v2, s[8:11], s22 offen offset:3072 sc1
  s_add_u32 s22, s31, 94208
  buffer_load_dwordx4 a[32:35], v2, s[8:11], s22 offen offset:0 sc1
  buffer_load_dwordx4 a[36:39], v2, s[8:11], s22 offen offset:1024 sc1
  buffer_load_dwordx4 a[40:43], v2, s[8:11], s22 offen offset:2048 sc1
  buffer_load_dwordx4 a[44:47], v2, s[8:11], s22 offen offset:3072 sc1
  s_add_u32 s22, s31, 98304
  buffer_load_dwordx4 a[48:51], v2, s[8:11], s22 offen offset:0 sc1
  buffer_load_dwordx4 a[52:55], v2, s[8:11], s22 offen offset:1024 sc1
  buffer_load_dwordx4 a[56:59], v2, s[8:11], s22 offen offset:2048 sc1
  buffer_load_dwordx4 a[60:63], v2, s[8:11], s22 offen offset:3072 sc1
  s_add_u32 s22, s31, 102400
  buffer_load_dwordx4 a[64:67], v2, s[8:11], s22 offen offset:0 sc1
  buffer_load_dwordx4 a[68:71], v2, s[8:11], s22 offen offset:1024 sc1
  buffer_load_dwordx4 a[72:75], v2, s[8:11], s22 offen offset:2048 sc1
  buffer_load_dwordx4 a[76:79], v2, s[8:11], s22 offen offset:3072 sc1
  s_add_u32 s22, s31, 106496
  buffer_load_dwordx4 a[80:83], v2, s[8:11], s22 offen offset:0 sc1
  buffer_load_dwordx4 a[84:87], v2, s[8:11], s22 offen offset:1024 sc1
  buffer_load_dwordx4 a[88:91], v2, s[8:11], s22 offen offset:2048 sc1
  buffer_load_dwordx4 a[92:95], v2, s[8:11], s22 offen offset:3072 sc1
  s_add_u32 s22, s31, 110592
  buffer_load_dwordx4 a[96:99], v2, s[8:11], s22 offen offset:0 sc1
  buffer_load_dwordx4 a[100:103], v2, s[8:11], s22 offen offset:1024 sc1
  buffer_load_dwordx4 a[104:107], v2, s[8:11], s22 offen offset:2048 sc1
  buffer_load_dwordx4 a[108:111], v2, s[8:11], s22 offen offset:3072 sc1
  s_add_u32 s22, s31, 114688
  buffer_load_dwordx4 a[112:115], v2, s[8:11], s22 offen offset:0 sc1
  buffer_load_dwordx4 a[116:119], v2, s[8:11], s22 offen offset:1024 sc1
  buffer_load_dwordx4 a[120:123], v2, s[8:11], s22 offen offset:2048 sc1
  buffer_load_dwordx4 a[124:127], v2, s[8:11], s22 offen offset:3072 sc1
  s_waitcnt vmcnt(24)
  s_add_u32 s22, s31, 118784
  buffer_load_dwordx4 a[128:131], v2, s[8:11], s22 offen offset:0 sc1
  buffer_load_dwordx4 a[132:135], v2, s[8:11], s22 offen offset:1024 sc1
  buffer_load_dwordx4 a[136:139], v2, s[8:11], s22 offen offset:2048 sc1
  buffer_load_dwordx4 a[140:143], v2, s[8:11], s22 offen offset:3072 sc1
  s_add_u32 s22, s31, 122880
  buffer_load_dwordx4 a[144:147], v2, s[8:11], s22 offen offset:0 sc1
  buffer_load_dwordx4 a[148:151], v2, s[8:11], s22 offen offset:1024 sc1
  buffer_load_dwordx4 a[152:155], v2, s[8:11], s22 offen offset:2048 sc1
  buffer_load_dwordx4 a[156:159], v2, s[8:11], s22 offen offset:3072 sc1
  s_add_u32 s22, s31, 126976
  buffer_load_dwordx4 a[160:163], v2, s[8:11], s22 offen offset:0 sc1
  buffer_load_dwordx4 a[164:167], v2, s[8:11], s22 offen offset:1024 sc1
  buffer_load_dwordx4 a[168:171], v2, s[8:11], s22 offen offset:2048 sc1
  buffer_load_dwordx4 a[172:175], v2, s[8:11], s22 offen offset:3072 sc1
  s_add_u32 s22, s31, 131072
  buffer_load_dwordx4 a[176:179], v2, s[8:11], s22 offen offset:0 sc1
  buffer_load_dwordx4 a[180:183], v2, s[8:11], s22 offen offset:1024 sc1
  buffer_load_dwordx4 a[184:187], v2, s[8:11], s22 offen offset:2048 sc1
  buffer_load_dwordx4 a[188:191], v2, s[8:11], s22 offen offset:3072 sc1
  s_add_u32 s22, s31, 135168
  buffer_load_dwordx4 a[192:195], v2, s[8:11], s22 offen offset:0 sc1
  buffer_load_dwordx4 a[196:199], v2, s[8:11], s22 offen offset:1024 sc1
  buffer_load_dwordx4 a[200:203], v2, s[8:11], s22 offen offset:2048 sc1
  buffer_load_dwordx4 a[204:207], v2, s[8:11], s22 offen offset:3072 sc1
  s_add_u32 s22, s31, 139264
  buffer_load_dwordx4 a[208:211], v2, s[8:11], s22 offen offset:0 sc1
  buffer_load_dwordx4 a[212:215], v2, s[8:11], s22 offen offset:1024 sc1
  buffer_load_dwordx4 a[216:219], v2, s[8:11], s22 offen offset:2048 sc1
  buffer_load_dwordx4 a[220:223], v2, s[8:11], s22 offen offset:3072 sc1
  s_add_u32 s22, s31, 143360
  buffer_load_dwordx4 a[224:227], v2, s[8:11], s22 offen offset:0 sc1
  buffer_load_dwordx4 a[228:231], v2, s[8:11], s22 offen offset:1024 sc1
  buffer_load_dwordx4 a[232:235], v2, s[8:11], s22 offen offset:2048 sc1
  buffer_load_dwordx4 a[236:239], v2, s[8:11], s22 offen offset:3072 sc1
  s_add_u32 s22, s31, 147456
  buffer_load_dwordx4 a[240:243], v2, s[8:11], s22 offen offset:0 sc1
  buffer_load_dwordx4 a[244:247], v2, s[8:11], s22 offen offset:1024 sc1
  buffer_load_dwordx4 a[248:251], v2, s[8:11], s22 offen offset:2048 sc1
  buffer_load_dwordx4 a[252:255], v2, s[8:11], s22 offen offset:3072 sc1
  s_waitcnt vmcnt(24)
  s_add_u32 s22, s31, 151552
  buffer_load_dwordx4 v[176:179], v2, s[8:11], s22 offen offset:0 sc1
  buffer_load_dwordx4 v[180:183], v2, s[8:11], s22 offen offset:1024 sc1
  buffer_load_dwordx4 v[184:187], v2, s[8:11], s22 offen offset:2048 sc1
  buffer_load_dwordx4 v[188:191], v2, s[8:11], s22 offen offset:3072 sc1
  s_add_u32 s22, s31, 155648
  buffer_load_dwordx4 v[192:195], v2, s[8:11], s22 offen offset:0 sc1
  buffer_load_dwordx4 v[196:199], v2, s[8:11], s22 offen offset:1024 sc1
  buffer_load_dwordx4 v[200:203], v2, s[8:11], s22 offen offset:2048 sc1
  buffer_load_dwordx4 v[204:207], v2, s[8:11], s22 offen offset:3072 sc1
  s_add_u32 s22, s31, 159744
  buffer_load_dwordx4 v[208:211], v2, s[8:11], s22 offen offset:0 sc1
  buffer_load_dwordx4 v[212:215], v2, s[8:11], s22 offen offset:1024 sc1
  buffer_load_dwordx4 v[216:219], v2, s[8:11], s22 offen offset:2048 sc1
  buffer_load_dwordx4 v[220:223], v2, s[8:11], s22 offen offset:3072 sc1
  s_add_u32 s22, s31, 163840
  buffer_load_dwordx4 v[224:227], v2, s[8:11], s22 offen offset:0 sc1
  buffer_load_dwordx4 v[228:231], v2, s[8:11], s22 offen offset:1024 sc1
  buffer_load_dwordx4 v[232:235], v2, s[8:11], s22 offen offset:2048 sc1
  buffer_load_dwordx4 v[236:239], v2, s[8:11], s22 offen offset:3072 sc1
  s_add_u32 s22, s31, 167936
  buffer_load_dwordx4 v[240:243], v2, s[8:11], s22 offen offset:0 sc1
  buffer_load_dwordx4 v[244:247], v2, s[8:11], s22 offen offset:1024 sc1
  buffer_load_dwordx4 v[248:251], v2, s[8:11], s22 offen offset:2048 sc1
  buffer_load_dwordx4 v[252:255], v2, s[8:11], s22 offen offset:3072 sc1
  s_lshl_b32 s22, s17, 4
  v_mov_b32 v38, s22
  s_mul_i32 s22, s17, 12
  s_add_u32 s23, s22, 267
  s_add_u32 s22, s22, 256
  v_mov_b32 v36, s23
  v_mov_b32 v37, s22
  v_cmp_eq_u32 vcc, 1, v116
  s_nop 1
  v_cndmask_b32 v36, v36, v37, vcc
  v_med3_u32 v37, v117, 14, 15
  v_lshrrev_b32 v36, 6, v36
  v_lshlrev_b32 v36, 8, v36
  v_lshl_add_u32 v36, v37, 4, v36
  s_mov_b32 s22, 88600576
  s_mov_b32 s30, 0
va_bw_20:
  buffer_load_dwordx4 v[40:43], v36, s[8:11], s22 offen sc1
  s_waitcnt vmcnt(0)
  v_cmp_ne_u64 vcc, s[88:89], v[40:41]
  s_cbranch_vccnz va_bw_20_no
  v_cmp_ne_u64 vcc, s[88:89], v[42:43]
  s_cbranch_vccnz va_bw_20_no
  s_branch va_bw_20_ok
va_bw_20_no:
  s_sleep 2
  s_add_u32 s30, s30, 1
  s_cmp_lt_u32 s30, 50000
  s_cbranch_scc1 va_bw_20
  s_branch cA_abort
va_bw_20_ok:
  s_mov_b32 m0, 59392
  s_add_u32 s22, s31, 387072
  buffer_load_dwordx4 v2, s[8:11], s22 offen offset:0 sc1 lds
  buffer_load_dwordx4 v2, s[8:11], s22 offen offset:1024 sc1 lds
  buffer_load_dwordx4 v2, s[8:11], s22 offen offset:2048 sc1 lds
  buffer_load_dwordx4 v2, s[8:11], s22 offen offset:3072 sc1 lds
  s_mov_b32 m0, 63488
  s_add_u32 s22, s31, 391168
  buffer_load_dwordx4 v2, s[8:11], s22 offen offset:0 sc1 lds
  buffer_load_dwordx4 v2, s[8:11], s22 offen offset:1024 sc1 lds
  buffer_load_dwordx4 v2, s[8:11], s22 offen offset:2048 sc1 lds
  buffer_load_dwordx4 v2, s[8:11], s22 offen offset:3072 sc1 lds
  s_mov_b32 m0, 67584
  s_add_u32 s22, s31, 395264
  buffer_load_dwordx4 v2, s[8:11], s22 offen offset:0 sc1 lds
  buffer_load_dwordx4 v2, s[8:11], s22 offen offset:1024 sc1 lds
  buffer_load_dwordx4 v2, s[8:11], s22 offen offset:2048 sc1 lds
  buffer_load_dwordx4 v2, s[8:11], s22 offen offset:3072 sc1 lds
  s_mov_b32 m0, 71680
  s_add_u32 s22, s31, 399360
  buffer_load_dwordx4 v2, s[8:11], s22 offen offset:0 sc1 lds
  buffer_load_dwordx4 v2, s[8:11], s22 offen offset:1024 sc1 lds
  v_mov_b32 v72, v116
  v_mov_b32 v73, v117
  v_lshrrev_b32 v65, 1, v72
  v_and_b32 v66, 1, v72
  v_mov_b32 v68, 6
  v_mov_b32 v69, v73
  v_mov_b32 v70, 0
  v_and_b32 v71, 1, v69
  v_lshrrev_b32 v69, 1, v69
  v_lshl_add_u32 v69, v71, 3, v69
  v_lshlrev_b32 v71, 12, v70
  v_lshrrev_b32 v70, 1, v68
  v_lshl_add_u32 v71, v70, 9, v71
  v_and_b32 v70, 1, v68
  v_lshl_add_u32 v71, v70, 2, v71
  v_lshl_add_u32 v71, v69, 4, v71
  v_lshl_add_u32 v71, v65, 8, v71
  v_lshl_add_u32 v60, v66, 3, v71
  v_mov_b32 v68, 7
  v_mov_b32 v69, v73
  v_mov_b32 v70, 0
  v_and_b32 v71, 1, v69
  v_lshrrev_b32 v69, 1, v69
  v_lshl_add_u32 v69, v71, 3, v69
  v_lshlrev_b32 v71, 12, v70
  v_lshrrev_b32 v70, 1, v68
  v_lshl_add_u32 v71, v70, 9, v71
  v_and_b32 v70, 1, v68
  v_lshl_add_u32 v71, v70, 2, v71
  v_lshl_add_u32 v71, v69, 4, v71
  v_lshl_add_u32 v71, v65, 8, v71
  v_lshl_add_u32 v61, v66, 3, v71
  v_mov_b32 v68, 8
  v_mov_b32 v69, v73
  v_mov_b32 v70, 0
  v_and_b32 v71, 1, v69
  v_lshrrev_b32 v69, 1, v69
  v_lshl_add_u32 v69, v71, 3, v69
  v_lshlrev_b32 v71, 12, v70
  v_lshrrev_b32 v70, 1, v68
  v_lshl_add_u32 v71, v70, 9, v71
  v_and_b32 v70, 1, v68
  v_lshl_add_u32 v71, v70, 2, v71
  v_lshl_add_u32 v71, v69, 4, v71
  v_lshl_add_u32 v71, v65, 8, v71
  v_lshl_add_u32 v62, v66, 3, v71
  v_mov_b32 v68, 9
  v_mov_b32 v69, v73
  v_mov_b32 v70, 0
  v_and_b32 v71, 1, v69
  v_lshrrev_b32 v69, 1, v69
  v_lshl_add_u32 v69, v71, 3, v69
  v_lshlrev_b32 v71, 12, v70
  v_lshrrev_b32 v70, 1, v68
  v_lshl_add_u32 v71, v70, 9, v71
  v_and_b32 v70, 1, v68
  v_lshl_add_u32 v71, v70, 2, v71
  v_lshl_add_u32 v71, v69, 4, v71
  v_lshl_add_u32 v71, v65, 8, v71
  v_lshl_add_u32 v170, v66, 3, v71
  v_mov_b32 v68, 10
  v_mov_b32 v69, v73
  v_mov_b32 v70, 0
  v_and_b32 v71, 1, v69
  v_lshrrev_b32 v69, 1, v69
  v_lshl_add_u32 v69, v71, 3, v69
  v_lshlrev_b32 v71, 12, v70
  v_lshrrev_b32 v70, 1, v68
  v_lshl_add_u32 v71, v70, 9, v71
  v_and_b32 v70, 1, v68
  v_lshl_add_u32 v71, v70, 2, v71
  v_lshl_add_u32 v71, v69, 4, v71
  v_lshl_add_u32 v71, v65, 8, v71
  v_lshl_add_u32 v171, v66, 3, v71
  v_mov_b32 v68, 11
  v_mov_b32 v69, v73
  v_mov_b32 v70, 0
  v_and_b32 v71, 1, v69
  v_lshrrev_b32 v69, 1, v69
  v_lshl_add_u32 v69, v71, 3, v69
  v_lshlrev_b32 v71, 12, v70
  v_lshrrev_b32 v70, 1, v68
  v_lshl_add_u32 v71, v70, 9, v71
  v_and_b32 v70, 1, v68
  v_lshl_add_u32 v71, v70, 2, v71
  v_lshl_add_u32 v71, v69, 4, v71
  v_lshl_add_u32 v71, v65, 8, v71
  v_lshl_add_u32 v172, v66, 3, v71
  v_and_b32 v0, 31, v1
  v_lshlrev_b32 v0, 2, v0
  v_add_u32 v0, 18432, v0
  v_min_u32 v4, 15, v73
  v_lshlrev_b32 v4, 2, v4
  s_and_b32 s22, s17, 3
  s_lshl_b32 s22, s22, 7
  s_add_u32 s22, s22, 17408
  v_add_u32 v4, s22, v4
  v_and_b32 v64, 7, v73
  v_lshlrev_b32 v5, 4, v64
  v_lshl_add_u32 v5, v72, 7, v5
  v_lshrrev_b32 v65, 3, v73
  v_lshl_add_u32 v5, v65, 9, v5
  s_lshl_b32 s22, s17, 3
  s_add_u32 s22, s22, 17924
  v_mov_b32 v7, s22
  v_add_u32 v65, 16, v73
  v_min_u32 v65, 27, v65
  v_mad_u32_u24 v65, v72, 28, v65
  v_lshlrev_b32 v6, 4, v65
  s_lshr_b32 s22, s17, 1
  s_mul_i32 s22, s22, 7
  s_and_b32 s34, s17, 1
  s_lshl_b32 s35, s34, 2
  v_add_u32 v70, s35, v72
  v_mov_b32 v71, s34
  v_mov_b32 v69, 1
  v_cmp_eq_u32 vcc, 3, v72
  s_nop 1
  v_cndmask_b32 v70, v70, v72, vcc
  v_cndmask_b32 v69, v69, v71, vcc
  v_add_u32 v70, s22, v70
  v_lshrrev_b32 v68, 1, v70
  v_lshlrev_b32 v68, 8, v68
  v_lshl_add_u32 v68, v69, 7, v68
  v_and_b32 v69, 1, v70
  v_lshl_add_u32 v68, v69, 3, v68
  v_lshl_add_u32 v1, v64, 4, v68
  v_cmp_gt_u32 s[26:27], 8, v73
  v_cmp_gt_u32 vcc, 3, v72
  s_and_b64 s[26:27], s[26:27], vcc
  v_lshrrev_b32 v65, 3, v73
  v_min_u32 v66, 5, v64
  v_lshl_add_u32 v66, v66, 1, v65
  v_mad_u32_u24 v66, v72, 12, v66
  v_lshlrev_b32 v66, 4, v66
  v_add_u32 v6, 1024, v66
  s_mul_i32 s22, s17, 12
  s_add_u32 s22, s22, 256
  v_lshl_add_u32 v70, v64, 1, s22
  v_lshrrev_b32 v68, 4, v70
  v_lshlrev_b32 v68, 8, v68
  v_bfe_u32 v69, v70, 1, 1
  v_lshl_add_u32 v68, v69, 7, v68
  v_bfe_u32 v69, v70, 2, 2
  v_lshl_add_u32 v68, v69, 2, v68
  v_and_b32 v69, 1, v72
  v_lshl_add_u32 v65, v69, 2, v65
  v_lshrrev_b32 v69, 1, v72
  v_lshl_add_u32 v65, v69, 1, v65
  v_lshrrev_b32 v65, 3, v73
  v_lshl_add_u32 v65, v72, 1, v65
  v_lshrrev_b32 v5, 1, v72
  v_lshlrev_b32 v5, 9, v5
  v_lshrrev_b32 v69, 2, v73
  v_lshl_add_u32 v5, v69, 7, v5
  v_and_b32 v69, 1, v72
  v_lshl_add_u32 v5, v69, 6, v5
  v_and_b32 v69, 3, v73
  v_lshl_add_u32 v5, v69, 4, v5
  v_and_b32 v69, 1, v73
  v_mul_u32_u24 v69, 0xaaaa, v69
  v_add_u32 v0, 0x4444, v69
  v_lshl_add_u32 v1, v65, 4, v68
  v_cmp_gt_u32 s[26:27], 6, v64
  v_mov_b32 v156, 0
  v_mov_b32 v157, 0
  v_mov_b32 v158, 0
  v_mov_b32 v159, 0
  ds_write_b128 v2, v[156:159] offset:4096
  ds_write_b128 v2, v[156:159] offset:5120
  ds_write_b128 v2, v[156:159] offset:6144
  ds_write_b128 v2, v[156:159] offset:7168
  s_mul_i32 s22, s17, 1835008
  s_add_u32 s25, s22, 42205184
  s_lshl_b32 s35, s17, 7
  s_add_u32 s35, s35, 88539136
  s_add_u32 s39, s35, 16384
  s_mov_b32 s38, 0
  v_mov_b32 v63, 0
  v_bfe_u32 v8, v2, 4, 1
  v_mul_u32_u24 v3, 0xaaaa, v8
  v_add_u32 v3, 0x4444, v3
  v_bfe_u32 v9, v2, 5, 3
  v_lshl_add_u32 v8, v8, 3, v9
  v_and_b32 v9, 0x300, v2
  v_lshl_add_u32 v0, v8, 4, v9
  s_getpc_b64 s[98:99]
cpf_18:
  s_add_u32 s98, s98, cA_va1_loop-cpf_18
  s_addc_u32 s99, s99, 0
  v_lshlrev_b32 v38, 2, v2
  global_load_dword v39, v38, s[98:99]
  s_lshl_b32 s22, 0, 11
  s_add_u32 s22, s22, 88602624
  v_add_u32 v36, 1024, v2
  v_min_u32 v36, 1776, v36
  s_mov_b32 s30, 0
va_iw5:
  buffer_load_dwordx4 v[40:43], v2, s[8:11], s22 offen sc1
  buffer_load_dwordx4 v[44:47], v36, s[8:11], s22 offen sc1
  s_waitcnt vmcnt(0)
  v_cmp_ne_u64 vcc, s[88:89], v[40:41]
  s_cbranch_vccnz va_iw5_no
  v_cmp_ne_u64 vcc, s[88:89], v[42:43]
  s_cbranch_vccnz va_iw5_no
  v_cmp_ne_u64 vcc, s[88:89], v[44:45]
  s_cbranch_vccnz va_iw5_no
  v_cmp_ne_u64 vcc, s[88:89], v[46:47]
  s_cbranch_vccnz va_iw5_no
  s_branch va_iw5_ok
va_iw5_no:
  s_sleep 2
  s_add_u32 s30, s30, 1
  s_cmp_lt_u32 s30, 50000
  s_cbranch_scc1 va_iw5
  s_branch cA_abort
va_iw5_ok:
  s_mov_b32 s30, 0
  v_mov_b32 v36, 0
ch_md5:
  buffer_load_dword v37, v36, s[12:15], 0 offen sc1
  s_waitcnt vmcnt(0)
  v_readfirstlane_b32 s22, v37
  s_and_b32 s31, s22, 0xffff
  s_cmp_ge_u32 s31, 32
  s_cbranch_scc1 ch_go5
  s_sleep 2
  s_add_u32 s30, s30, 1
  s_cmp_lt_u32 s30, 50000
  s_cbranch_scc1 ch_md5
  s_branch ch_end
ch_go5:
  s_mov_b32 s31, 0
  v_mov_b32 v36, 0
  v_mov_b32 v37, 0
  v_mov_b32 v38, 0
  v_mov_b32 v39, 0
  v_mov_b32 v40, 0
  v_mov_b32 v41, 0
  v_mov_b32 v42, 0
  v_mov_b32 v43, 0
  v_mov_b32 v44, 0
  v_mov_b32 v45, 0
  v_mov_b32 v46, 0
  v_mov_b32 v47, 0
  v_mov_b32 v48, 0
  v_mov_b32 v49, 0
  v_mov_b32 v50, 0
  v_mov_b32 v51, 0
  v_mov_b32 v52, 0
  v_mov_b32 v53, 0
  v_mov_b32 v54, 0
  v_mov_b32 v55, 0
  v_mov_b32 v56, 0
  v_mov_b32 v57, 0
  v_mov_b32 v58, 0
  v_mov_b32 v59, 0
  s_lshr_b32 s22, s22, 16
  s_cmp_lg_u32 s22, 0
  s_cbranch_scc1 cB_va1_loop
  s_branch cA_va1_loop
ch_init6:
  s_mul_i32 s31, s17, 401408
  s_add_u32 s31, s31, 6422528
  s_lshl_b32 s22, s17, 4
  v_mov_b32 v38, s22
  s_mul_i32 s22, s17, 12
  s_add_u32 s23, s22, 267
  s_add_u32 s22, s22, 256
  v_mov_b32 v36, s23
  v_mov_b32 v37, s22
  v_cmp_eq_u32 vcc, 1, v116
  s_nop 1
  v_cndmask_b32 v36, v36, v37, vcc
  v_med3_u32 v37, v117, 0, 3
  v_med3_u32 v39, v117, 12, 15
  v_cmp_eq_u32 vcc, 0, v116
  s_nop 1
  v_cndmask_b32 v36, v36, v38, vcc
  v_cndmask_b32 v37, v37, v39, vcc
  v_lshrrev_b32 v36, 6, v36
  v_lshlrev_b32 v36, 8, v36
  v_lshl_add_u32 v36, v37, 4, v36
  s_mov_b32 s22, 88600576
  s_mov_b32 s30, 0
va_bw_22:
  buffer_load_dwordx4 v[40:43], v36, s[8:11], s22 offen sc1
  s_waitcnt vmcnt(0)
  v_cmp_ne_u64 vcc, s[88:89], v[40:41]
  s_cbranch_vccnz va_bw_22_no
  v_cmp_ne_u64 vcc, s[88:89], v[42:43]
  s_cbranch_vccnz va_bw_22_no
  s_branch va_bw_22_ok
va_bw_22_no:
  s_sleep 2
  s_add_u32 s30, s30, 1
  s_cmp_lt_u32 s30, 50000
  s_cbranch_scc1 va_bw_22
  s_branch cA_abort
va_bw_22_ok:
  s_add_u32 s22, s31, 172032
  buffer_load_dwordx4 a[0:3], v2, s[8:11], s22 offen offset:0 sc1
  buffer_load_dwordx4 a[4:7], v2, s[8:11], s22 offen offset:1024 sc1
  buffer_load_dwordx4 a[8:11], v2, s[8:11], s22 offen offset:2048 sc1
  buffer_load_dwordx4 a[12:15], v2, s[8:11], s22 offen offset:3072 sc1
  s_add_u32 s22, s31, 176128
  buffer_load_dwordx4 a[16:19], v2, s[8:11], s22 offen offset:0 sc1
  buffer_load_dwordx4 a[20:23], v2, s[8:11], s22 offen offset:1024 sc1
  buffer_load_dwordx4 a[24:27], v2, s[8:11], s22 offen offset:2048 sc1
  buffer_load_dwordx4 a[28:31], v2, s[8:11], s22 offen offset:3072 sc1
  s_add_u32 s22, s31, 180224
  buffer_load_dwordx4 a[32:35], v2, s[8:11], s22 offen offset:0 sc1
  buffer_load_dwordx4 a[36:39], v2, s[8:11], s22 offen offset:1024 sc1
  buffer_load_dwordx4 a[40:43], v2, s[8:11], s22 offen offset:2048 sc1
  buffer_load_dwordx4 a[44:47], v2, s[8:11], s22 offen offset:3072 sc1
  s_add_u32 s22, s31, 184320
  buffer_load_dwordx4 a[48:51], v2, s[8:11], s22 offen offset:0 sc1
  buffer_load_dwordx4 a[52:55], v2, s[8:11], s22 offen offset:1024 sc1
  buffer_load_dwordx4 a[56:59], v2, s[8:11], s22 offen offset:2048 sc1
  buffer_load_dwordx4 a[60:63], v2, s[8:11], s22 offen offset:3072 sc1
  s_add_u32 s22, s31, 188416
  buffer_load_dwordx4 a[64:67], v2, s[8:11], s22 offen offset:0 sc1
  buffer_load_dwordx4 a[68:71], v2, s[8:11], s22 offen offset:1024 sc1
  buffer_load_dwordx4 a[72:75], v2, s[8:11], s22 offen offset:2048 sc1
  buffer_load_dwordx4 a[76:79], v2, s[8:11], s22 offen offset:3072 sc1
  s_add_u32 s22, s31, 192512
  buffer_load_dwordx4 a[80:83], v2, s[8:11], s22 offen offset:0 sc1
  buffer_load_dwordx4 a[84:87], v2, s[8:11], s22 offen offset:1024 sc1
  buffer_load_dwordx4 a[88:91], v2, s[8:11], s22 offen offset:2048 sc1
  buffer_load_dwordx4 a[92:95], v2, s[8:11], s22 offen offset:3072 sc1
  s_add_u32 s22, s31, 196608
  buffer_load_dwordx4 a[96:99], v2, s[8:11], s22 offen offset:0 sc1
  buffer_load_dwordx4 a[100:103], v2, s[8:11], s22 offen offset:1024 sc1
  buffer_load_dwordx4 a[104:107], v2, s[8:11], s22 offen offset:2048 sc1
  buffer_load_dwordx4 a[108:111], v2, s[8:11], s22 offen offset:3072 sc1
  s_add_u32 s22, s31, 200704
  buffer_load_dwordx4 a[112:115], v2, s[8:11], s22 offen offset:0 sc1
  buffer_load_dwordx4 a[116:119], v2, s[8:11], s22 offen offset:1024 sc1
  buffer_load_dwordx4 a[120:123], v2, s[8:11], s22 offen offset:2048 sc1
  buffer_load_dwordx4 a[124:127], v2, s[8:11], s22 offen offset:3072 sc1
  s_waitcnt vmcnt(24)
  s_add_u32 s22, s31, 204800
  buffer_load_dwordx4 a[128:131], v2, s[8:11], s22 offen offset:0 sc1
  buffer_load_dwordx4 a[132:135], v2, s[8:11], s22 offen offset:1024 sc1
  buffer_load_dwordx4 a[136:139], v2, s[8:11], s22 offen offset:2048 sc1
  buffer_load_dwordx4 a[140:143], v2, s[8:11], s22 offen offset:3072 sc1
  s_add_u32 s22, s31, 208896
  buffer_load_dwordx4 a[144:147], v2, s[8:11], s22 offen offset:0 sc1
  buffer_load_dwordx4 a[148:151], v2, s[8:11], s22 offen offset:1024 sc1
  buffer_load_dwordx4 a[152:155], v2, s[8:11], s22 offen offset:2048 sc1
  buffer_load_dwordx4 a[156:159], v2, s[8:11], s22 offen offset:3072 sc1
  s_add_u32 s22, s31, 212992
  buffer_load_dwordx4 a[160:163], v2, s[8:11], s22 offen offset:0 sc1
  buffer_load_dwordx4 a[164:167], v2, s[8:11], s22 offen offset:1024 sc1
  buffer_load_dwordx4 a[168:171], v2, s[8:11], s22 offen offset:2048 sc1
  buffer_load_dwordx4 a[172:175], v2, s[8:11], s22 offen offset:3072 sc1
  s_add_u32 s22, s31, 217088
  buffer_load_dwordx4 a[176:179], v2, s[8:11], s22 offen offset:0 sc1
  buffer_load_dwordx4 a[180:183], v2, s[8:11], s22 offen offset:1024 sc1
  buffer_load_dwordx4 a[184:187], v2, s[8:11], s22 offen offset:2048 sc1
  buffer_load_dwordx4 a[188:191], v2, s[8:11], s22 offen offset:3072 sc1
  s_add_u32 s22, s31, 221184
  buffer_load_dwordx4 a[192:195], v2, s[8:11], s22 offen offset:0 sc1
  buffer_load_dwordx4 a[196:199], v2, s[8:11], s22 offen offset:1024 sc1
  buffer_load_dwordx4 a[200:203], v2, s[8:11], s22 offen offset:2048 sc1
  buffer_load_dwordx4 a[204:207], v2, s[8:11], s22 offen offset:3072 sc1
  s_add_u32 s22, s31, 225280
  buffer_load_dwordx4 a[208:211], v2, s[8:11], s22 offen offset:0 sc1
  buffer_load_dwordx4 a[212:215], v2, s[8:11], s22 offen offset:1024 sc1
  buffer_load_dwordx4 a[216:219], v2, s[8:11], s22 offen offset:2048 sc1
  buffer_load_dwordx4 a[220:223], v2, s[8:11], s22 offen offset:3072 sc1
  s_add_u32 s22, s31, 229376
  buffer_load_dwordx4 a[224:227], v2, s[8:11], s22 offen offset:0 sc1
  buffer_load_dwordx4 a[228:231], v2, s[8:11], s22 offen offset:1024 sc1
  buffer_load_dwordx4 a[232:235], v2, s[8:11], s22 offen offset:2048 sc1
  buffer_load_dwordx4 a[236:239], v2, s[8:11], s22 offen offset:3072 sc1
  s_add_u32 s22, s31, 233472
  buffer_load_dwordx4 a[240:243], v2, s[8:11], s22 offen offset:0 sc1
  buffer_load_dwordx4 a[244:247], v2, s[8:11], s22 offen offset:1024 sc1
  buffer_load_dwordx4 a[248:251], v2, s[8:11], s22 offen offset:2048 sc1
  buffer_load_dwordx4 a[252:255], v2, s[8:11], s22 offen offset:3072 sc1
  s_waitcnt vmcnt(24)
  s_add_u32 s22, s31, 237568
  buffer_load_dwordx4 v[120:123], v2, s[8:11], s22 offen offset:0 sc1
  buffer_load_dwordx4 v[124:127], v2, s[8:11], s22 offen offset:1024 sc1
  buffer_load_dwordx4 v[128:131], v2, s[8:11], s22 offen offset:2048 sc1
  buffer_load_dwordx4 v[132:135], v2, s[8:11], s22 offen offset:3072 sc1
  s_add_u32 s22, s31, 241664
  buffer_load_dwordx4 v[136:139], v2, s[8:11], s22 offen offset:0 sc1
  buffer_load_dwordx4 v[140:143], v2, s[8:11], s22 offen offset:1024 sc1
  buffer_load_dwordx4 v[144:147], v2, s[8:11], s22 offen offset:2048 sc1
  buffer_load_dwordx4 v[148:151], v2, s[8:11], s22 offen offset:3072 sc1
  s_add_u32 s22, s31, 245760
  buffer_load_dwordx4 v[152:155], v2, s[8:11], s22 offen offset:0 sc1
  buffer_load_dwordx4 v[156:159], v2, s[8:11], s22 offen offset:1024 sc1
  buffer_load_dwordx4 v[160:163], v2, s[8:11], s22 offen offset:2048 sc1
  buffer_load_dwordx4 v[164:167], v2, s[8:11], s22 offen offset:3072 sc1
  s_add_u32 s22, s31, 249856
  buffer_load_dwordx4 v[168:171], v2, s[8:11], s22 offen offset:0 sc1
  buffer_load_dwordx4 v[172:175], v2, s[8:11], s22 offen offset:1024 sc1
  buffer_load_dwordx4 v[176:179], v2, s[8:11], s22 offen offset:2048 sc1
  buffer_load_dwordx4 v[180:183], v2, s[8:11], s22 offen offset:3072 sc1
  s_add_u32 s22, s31, 253952
  buffer_load_dwordx4 v[184:187], v2, s[8:11], s22 offen offset:0 sc1
  buffer_load_dwordx4 v[188:191], v2, s[8:11], s22 offen offset:1024 sc1
  buffer_load_dwordx4 v[192:195], v2, s[8:11], s22 offen offset:2048 sc1
  buffer_load_dwordx4 v[196:199], v2, s[8:11], s22 offen offset:3072 sc1
  s_add_u32 s22, s31, 258048
  buffer_load_dwordx4 v[200:203], v2, s[8:11], s22 offen offset:0 sc1
  buffer_load_dwordx4 v[204:207], v2, s[8:11], s22 offen offset:1024 sc1
  buffer_load_dwordx4 v[208:211], v2, s[8:11], s22 offen offset:2048 sc1
  buffer_load_dwordx4 v[212:215], v2, s[8:11], s22 offen offset:3072 sc1
  s_add_u32 s22, s31, 262144
  buffer_load_dwordx4 v[216:219], v2, s[8:11], s22 offen offset:0 sc1
  buffer_load_dwordx4 v[220:223], v2, s[8:11], s22 offen offset:1024 sc1
  buffer_load_dwordx4 v[224:227], v2, s[8:11], s22 offen offset:2048 sc1
  buffer_load_dwordx4 v[228:231], v2, s[8:11], s22 offen offset:3072 sc1
  s_add_u32 s22, s31, 266240
  buffer_load_dwordx4 v[232:235], v2, s[8:11], s22 offen offset:0 sc1
  buffer_load_dwordx4 v[236:239], v2, s[8:11], s22 offen offset:1024 sc1
  buffer_load_dwordx4 v[240:243], v2, s[8:11], s22 offen offset:2048 sc1
  buffer_load_dwordx4 v[244:247], v2, s[8:11], s22 offen offset:3072 sc1
  s_waitcnt vmcnt(24)
  s_add_u32 s22, s31, 270336
  buffer_load_dwordx4 v[248:251], v2, s[8:11], s22 offen offset:0 sc1
  buffer_load_dwordx4 v[252:255], v2, s[8:11], s22 offen offset:1024 sc1
  v_mov_b32 v72, v116
  v_mov_b32 v73, v117
  v_lshrrev_b32 v65, 1, v72
  v_and_b32 v66, 1, v72
  v_mov_b32 v68, 12
  v_mov_b32 v69, v73
  v_mov_b32 v70, 0
  v_and_b32 v71, 1, v69
  v_lshrrev_b32 v69, 1, v69
  v_lshl_add_u32 v69, v71, 3, v69
  v_lshlrev_b32 v71, 12, v70
  v_lshrrev_b32 v70, 1, v68
  v_lshl_add_u32 v71, v70, 9, v71
  v_and_b32 v70, 1, v68
  v_lshl_add_u32 v71, v70, 2, v71
  v_lshl_add_u32 v71, v69, 4, v71
  v_lshl_add_u32 v71, v65, 8, v71
  v_lshl_add_u32 v100, v66, 3, v71
  v_mov_b32 v68, 13
  v_mov_b32 v69, v73
  v_mov_b32 v70, 0
  v_and_b32 v71, 1, v69
  v_lshrrev_b32 v69, 1, v69
  v_lshl_add_u32 v69, v71, 3, v69
  v_lshlrev_b32 v71, 12, v70
  v_lshrrev_b32 v70, 1, v68
  v_lshl_add_u32 v71, v70, 9, v71
  v_and_b32 v70, 1, v68
  v_lshl_add_u32 v71, v70, 2, v71
  v_lshl_add_u32 v71, v69, 4, v71
  v_lshl_add_u32 v71, v65, 8, v71
  v_lshl_add_u32 v101, v66, 3, v71
  v_mov_b32 v68, 14
  v_mov_b32 v69, v73
  v_mov_b32 v70, 0
  v_and_b32 v71, 1, v69
  v_lshrrev_b32 v69, 1, v69
  v_lshl_add_u32 v69, v71, 3, v69
  v_lshlrev_b32 v71, 12, v70
  v_lshrrev_b32 v70, 1, v68
  v_lshl_add_u32 v71, v70, 9, v71
  v_and_b32 v70, 1, v68
  v_lshl_add_u32 v71, v70, 2, v71
  v_lshl_add_u32 v71, v69, 4, v71
  v_lshl_add_u32 v71, v65, 8, v71
  v_lshl_add_u32 v102, v66, 3, v71
  v_mov_b32 v68, 15
  v_mov_b32 v69, v73
  v_mov_b32 v70, 0
  v_and_b32 v71, 1, v69
  v_lshrrev_b32 v69, 1, v69
  v_lshl_add_u32 v69, v71, 3, v69
  v_lshlrev_b32 v71, 12, v70
  v_lshrrev_b32 v70, 1, v68
  v_lshl_add_u32 v71, v70, 9, v71
  v_and_b32 v70, 1, v68
  v_lshl_add_u32 v71, v70, 2, v71
  v_lshl_add_u32 v71, v69, 4, v71
  v_lshl_add_u32 v71, v65, 8, v71
  v_lshl_add_u32 v103, v66, 3, v71
  v_add_u32 v67, 0, v73
  v_mul_u32_u24 v68, 5462, v67
  v_lshrrev_b32 v68, 16, v68
  v_mul_u32_u24 v69, 12, v68
  v_sub_u32 v69, v67, v69
  v_mov_b32 v70, 1
  v_and_b32 v71, 1, v69
  v_lshrrev_b32 v69, 1, v69
  v_lshl_add_u32 v69, v71, 3, v69
  v_lshlrev_b32 v71, 12, v70
  v_lshrrev_b32 v70, 1, v68
  v_lshl_add_u32 v71, v70, 9, v71
  v_and_b32 v70, 1, v68
  v_lshl_add_u32 v71, v70, 2, v71
  v_lshl_add_u32 v71, v69, 4, v71
  v_lshl_add_u32 v71, v65, 8, v71
  v_lshl_add_u32 v104, v66, 3, v71
  v_add_u32 v67, 16, v73
  v_mul_u32_u24 v68, 5462, v67
  v_lshrrev_b32 v68, 16, v68
  v_mul_u32_u24 v69, 12, v68
  v_sub_u32 v69, v67, v69
  v_mov_b32 v70, 1
  v_and_b32 v71, 1, v69
  v_lshrrev_b32 v69, 1, v69
  v_lshl_add_u32 v69, v71, 3, v69
  v_lshlrev_b32 v71, 12, v70
  v_lshrrev_b32 v70, 1, v68
  v_lshl_add_u32 v71, v70, 9, v71
  v_and_b32 v70, 1, v68
  v_lshl_add_u32 v71, v70, 2, v71
  v_lshl_add_u32 v71, v69, 4, v71
  v_lshl_add_u32 v71, v65, 8, v71
  v_lshl_add_u32 v105, v66, 3, v71
  v_add_u32 v67, 32, v73
  v_mul_u32_u24 v68, 5462, v67
  v_lshrrev_b32 v68, 16, v68
  v_mul_u32_u24 v69, 12, v68
  v_sub_u32 v69, v67, v69
  v_mov_b32 v70, 1
  v_and_b32 v71, 1, v69
  v_lshrrev_b32 v69, 1, v69
  v_lshl_add_u32 v69, v71, 3, v69
  v_lshlrev_b32 v71, 12, v70
  v_lshrrev_b32 v70, 1, v68
  v_lshl_add_u32 v71, v70, 9, v71
  v_and_b32 v70, 1, v68
  v_lshl_add_u32 v71, v70, 2, v71
  v_lshl_add_u32 v71, v69, 4, v71
  v_lshl_add_u32 v71, v65, 8, v71
  v_lshl_add_u32 v106, v66, 3, v71
  v_add_u32 v67, 48, v73
  v_mul_u32_u24 v68, 5462, v67
  v_lshrrev_b32 v68, 16, v68
  v_mul_u32_u24 v69, 12, v68
  v_sub_u32 v69, v67, v69
  v_mov_b32 v70, 1
  v_and_b32 v71, 1, v69
  v_lshrrev_b32 v69, 1, v69
  v_lshl_add_u32 v69, v71, 3, v69
  v_lshlrev_b32 v71, 12, v70
  v_lshrrev_b32 v70, 1, v68
  v_lshl_add_u32 v71, v70, 9, v71
  v_and_b32 v70, 1, v68
  v_lshl_add_u32 v71, v70, 2, v71
  v_lshl_add_u32 v71, v69, 4, v71
  v_lshl_add_u32 v71, v65, 8, v71
  v_lshl_add_u32 v107, v66, 3, v71
  s_mul_i32 s24, s17, 532480
  s_add_u32 s24, s24, 76939264
  s_mul_i32 s34, s17, 640
  s_add_u32 s34, s34, 88582144
  s_mul_i32 s36, s17, 448
  v_add_u32 v0, s36, v2
  v_add_u32 v0, 8192, v0
  s_add_u32 s36, s36, 88080384
  s_mov_b32 s37, 76939264
  v_cmp_gt_u32 s[26:27], 28, v1
  v_and_b32 v119, 31, v1
  v_lshlrev_b32 v119, 2, v119
  v_and_b32 v119, 0x78, v119
  v_or_b32 v119, 4, v119
  s_add_u32 s22, s17, 16
  s_and_b32 s22, s22, 15
  s_lshl_b32 s22, s22, 7
  s_add_u32 s22, s22, 18432
  v_add_u32 v119, s22, v119
  v_min_u32 v118, 9, v1
  s_mul_i32 s22, s17, 10
  v_add_u32 v118, s22, v118
  v_lshlrev_b32 v118, 7, v118
  v_add_u32 v118, 40960, v118
  s_mov_b32 s39, 71565312
  v_add_u32 v1, 16384, v2
  v_mov_b32 v117, 1
  s_mul_i32 s38, s17, 1104
  s_add_u32 s38, s38, 20480
  v_bfe_u32 v8, v2, 4, 1
  v_mul_u32_u24 v3, 0xaaaa, v8
  v_add_u32 v3, 0x4444, v3
  v_bfe_u32 v9, v2, 5, 3
  v_lshl_add_u32 v8, v8, 3, v9
  v_and_b32 v9, 0x300, v2
  v_lshl_add_u32 v5, v8, 4, v9
  s_getpc_b64 s[98:99]
cpf_21:
  s_add_u32 s98, s98, cA_va2_loop-cpf_21
  s_addc_u32 s99, s99, 0
  v_lshlrev_b32 v38, 2, v2
  global_load_dword v39, v38, s[98:99]
  s_lshl_b32 s22, 0, 11
  s_add_u32 s22, s22, 88602624
  v_add_u32 v36, 1024, v2
  v_min_u32 v36, 1776, v36
  s_mov_b32 s30, 0
va_iw6:
  buffer_load_dwordx4 v[40:43], v2, s[8:11], s22 offen sc1
  buffer_load_dwordx4 v[44:47], v36, s[8:11], s22 offen sc1
  s_waitcnt vmcnt(0)
  v_cmp_ne_u64 vcc, s[88:89], v[40:41]
  s_cbranch_vccnz va_iw6_no
  v_cmp_ne_u64 vcc, s[88:89], v[42:43]
  s_cbranch_vccnz va_iw6_no
  v_cmp_ne_u64 vcc, s[88:89], v[44:45]
  s_cbranch_vccnz va_iw6_no
  v_cmp_ne_u64 vcc, s[88:89], v[46:47]
  s_cbranch_vccnz va_iw6_no
  s_branch va_iw6_ok
va_iw6_no:
  s_sleep 2
  s_add_u32 s30, s30, 1
  s_cmp_lt_u32 s30, 50000
  s_cbranch_scc1 va_iw6
  s_branch cA_abort
va_iw6_ok:
  s_mov_b32 s30, 0
  v_mov_b32 v36, 0
ch_md6:
  buffer_load_dword v37, v36, s[12:15], 0 offen sc1
  s_waitcnt vmcnt(0)
  v_readfirstlane_b32 s22, v37
  s_and_b32 s31, s22, 0xffff
  s_cmp_ge_u32 s31, 32
  s_cbranch_scc1 ch_go6
  s_sleep 2
  s_add_u32 s30, s30, 1
  s_cmp_lt_u32 s30, 50000
  s_cbranch_scc1 ch_md6
  s_branch ch_end
ch_go6:
  s_mov_b32 s31, 0
  s_lshr_b32 s22, s22, 16
  s_cmp_lg_u32 s22, 0
  s_cbranch_scc1 cB_va2_loop
  s_branch cA_va2_loop
ch_init7:
  s_mul_i32 s31, s17, 401408
  s_add_u32 s31, s31, 6422528
  s_lshl_b32 s22, s17, 4
  v_mov_b32 v38, s22
  s_mul_i32 s22, s17, 12
  s_add_u32 s23, s22, 267
  s_add_u32 s22, s22, 256
  v_mov_b32 v36, s23
  v_mov_b32 v37, s22
  v_cmp_eq_u32 vcc, 1, v116
  s_nop 1
  v_cndmask_b32 v36, v36, v37, vcc
  v_med3_u32 v37, v117, 5, 14
  v_lshrrev_b32 v36, 6, v36
  v_lshlrev_b32 v36, 8, v36
  v_lshl_add_u32 v36, v37, 4, v36
  s_mov_b32 s22, 88600576
  s_mov_b32 s30, 0
va_bw_24:
  buffer_load_dwordx4 v[40:43], v36, s[8:11], s22 offen sc1
  s_waitcnt vmcnt(0)
  v_cmp_ne_u64 vcc, s[88:89], v[40:41]
  s_cbranch_vccnz va_bw_24_no
  v_cmp_ne_u64 vcc, s[88:89], v[42:43]
  s_cbranch_vccnz va_bw_24_no
  s_branch va_bw_24_ok
va_bw_24_no:
  s_sleep 2
  s_add_u32 s30, s30, 1
  s_cmp_lt_u32 s30, 50000
  s_cbranch_scc1 va_bw_24
  s_branch cA_abort
va_bw_24_ok:
  s_add_u32 s22, s31, 286720
  buffer_load_dwordx4 a[0:3], v2, s[8:11], s22 offen offset:0 sc1
  buffer_load_dwordx4 a[4:7], v2, s[8:11], s22 offen offset:1024 sc1
  buffer_load_dwordx4 a[8:11], v2, s[8:11], s22 offen offset:2048 sc1
  buffer_load_dwordx4 a[12:15], v2, s[8:11], s22 offen offset:3072 sc1
  s_add_u32 s22, s31, 290816
  buffer_load_dwordx4 a[16:19], v2, s[8:11], s22 offen offset:0 sc1
  buffer_load_dwordx4 a[20:23], v2, s[8:11], s22 offen offset:1024 sc1
  buffer_load_dwordx4 a[24:27], v2, s[8:11], s22 offen offset:2048 sc1
  buffer_load_dwordx4 a[28:31], v2, s[8:11], s22 offen offset:3072 sc1
  s_add_u32 s22, s31, 294912
  buffer_load_dwordx4 a[32:35], v2, s[8:11], s22 offen offset:0 sc1
  buffer_load_dwordx4 a[36:39], v2, s[8:11], s22 offen offset:1024 sc1
  buffer_load_dwordx4 a[40:43], v2, s[8:11], s22 offen offset:2048 sc1
  buffer_load_dwordx4 a[44:47], v2, s[8:11], s22 offen offset:3072 sc1
  s_add_u32 s22, s31, 299008
  buffer_load_dwordx4 a[48:51], v2, s[8:11], s22 offen offset:0 sc1
  buffer_load_dwordx4 a[52:55], v2, s[8:11], s22 offen offset:1024 sc1
  buffer_load_dwordx4 a[56:59], v2, s[8:11], s22 offen offset:2048 sc1
  buffer_load_dwordx4 a[60:63], v2, s[8:11], s22 offen offset:3072 sc1
  s_add_u32 s22, s31, 303104
  buffer_load_dwordx4 a[64:67], v2, s[8:11], s22 offen offset:0 sc1
  buffer_load_dwordx4 a[68:71], v2, s[8:11], s22 offen offset:1024 sc1
  buffer_load_dwordx4 a[72:75], v2, s[8:11], s22 offen offset:2048 sc1
  buffer_load_dwordx4 a[76:79], v2, s[8:11], s22 offen offset:3072 sc1
  s_add_u32 s22, s31, 307200
  buffer_load_dwordx4 a[80:83], v2, s[8:11], s22 offen offset:0 sc1
  buffer_load_dwordx4 a[84:87], v2, s[8:11], s22 offen offset:1024 sc1
  buffer_load_dwordx4 a[88:91], v2, s[8:11], s22 offen offset:2048 sc1
  buffer_load_dwordx4 a[92:95], v2, s[8:11], s22 offen offset:3072 sc1
  s_add_u32 s22, s31, 311296
  buffer_load_dwordx4 a[96:99], v2, s[8:11], s22 offen offset:0 sc1
  buffer_load_dwordx4 a[100:103], v2, s[8:11], s22 offen offset:1024 sc1
  buffer_load_dwordx4 a[104:107], v2, s[8:11], s22 offen offset:2048 sc1
  buffer_load_dwordx4 a[108:111], v2, s[8:11], s22 offen offset:3072 sc1
  s_add_u32 s22, s31, 315392
  buffer_load_dwordx4 a[112:115], v2, s[8:11], s22 offen offset:0 sc1
  buffer_load_dwordx4 a[116:119], v2, s[8:11], s22 offen offset:1024 sc1
  buffer_load_dwordx4 a[120:123], v2, s[8:11], s22 offen offset:2048 sc1
  buffer_load_dwordx4 a[124:127], v2, s[8:11], s22 offen offset:3072 sc1
  s_waitcnt vmcnt(24)
  s_add_u32 s22, s31, 319488
  buffer_load_dwordx4 a[128:131], v2, s[8:11], s22 offen offset:0 sc1
  buffer_load_dwordx4 a[132:135], v2, s[8:11], s22 offen offset:1024 sc1
  buffer_load_dwordx4 a[136:139], v2, s[8:11], s22 offen offset:2048 sc1
  buffer_load_dwordx4 a[140:143], v2, s[8:11], s22 offen offset:3072 sc1
  s_add_u32 s22, s31, 323584
  buffer_load_dwordx4 a[144:147], v2, s[8:11], s22 offen offset:0 sc1
  buffer_load_dwordx4 a[148:151], v2, s[8:11], s22 offen offset:1024 sc1
  buffer_load_dwordx4 a[152:155], v2, s[8:11], s22 offen offset:2048 sc1
  buffer_load_dwordx4 a[156:159], v2, s[8:11], s22 offen offset:3072 sc1
  s_add_u32 s22, s31, 327680
  buffer_load_dwordx4 a[160:163], v2, s[8:11], s22 offen offset:0 sc1
  buffer_load_dwordx4 a[164:167], v2, s[8:11], s22 offen offset:1024 sc1
  buffer_load_dwordx4 a[168:171], v2, s[8:11], s22 offen offset:2048 sc1
  buffer_load_dwordx4 a[172:175], v2, s[8:11], s22 offen offset:3072 sc1
  s_add_u32 s22, s31, 331776
  buffer_load_dwordx4 a[176:179], v2, s[8:11], s22 offen offset:0 sc1
  buffer_load_dwordx4 a[180:183], v2, s[8:11], s22 offen offset:1024 sc1
  buffer_load_dwordx4 a[184:187], v2, s[8:11], s22 offen offset:2048 sc1
  buffer_load_dwordx4 a[188:191], v2, s[8:11], s22 offen offset:3072 sc1
  s_add_u32 s22, s31, 335872
  buffer_load_dwordx4 a[192:195], v2, s[8:11], s22 offen offset:0 sc1
  buffer_load_dwordx4 a[196:199], v2, s[8:11], s22 offen offset:1024 sc1
  buffer_load_dwordx4 a[200:203], v2, s[8:11], s22 offen offset:2048 sc1
  buffer_load_dwordx4 a[204:207], v2, s[8:11], s22 offen offset:3072 sc1
  s_add_u32 s22, s31, 339968
  buffer_load_dwordx4 a[208:211], v2, s[8:11], s22 offen offset:0 sc1
  buffer_load_dwordx4 a[212:215], v2, s[8:11], s22 offen offset:1024 sc1
  buffer_load_dwordx4 a[216:219], v2, s[8:11], s22 offen offset:2048 sc1
  buffer_load_dwordx4 a[220:223], v2, s[8:11], s22 offen offset:3072 sc1
  s_add_u32 s22, s31, 344064
  buffer_load_dwordx4 a[224:227], v2, s[8:11], s22 offen offset:0 sc1
  buffer_load_dwordx4 a[228:231], v2, s[8:11], s22 offen offset:1024 sc1
  buffer_load_dwordx4 a[232:235], v2, s[8:11], s22 offen offset:2048 sc1
  buffer_load_dwordx4 a[236:239], v2, s[8:11], s22 offen offset:3072 sc1
  s_add_u32 s22, s31, 348160
  buffer_load_dwordx4 a[240:243], v2, s[8:11], s22 offen offset:0 sc1
  buffer_load_dwordx4 a[244:247], v2, s[8:11], s22 offen offset:1024 sc1
  buffer_load_dwordx4 a[248:251], v2, s[8:11], s22 offen offset:2048 sc1
  buffer_load_dwordx4 a[252:255], v2, s[8:11], s22 offen offset:3072 sc1
  s_waitcnt vmcnt(24)
  s_add_u32 s22, s31, 352256
  buffer_load_dwordx4 v[120:123], v2, s[8:11], s22 offen offset:0 sc1
  buffer_load_dwordx4 v[124:127], v2, s[8:11], s22 offen offset:1024 sc1
  buffer_load_dwordx4 v[128:131], v2, s[8:11], s22 offen offset:2048 sc1
  buffer_load_dwordx4 v[132:135], v2, s[8:11], s22 offen offset:3072 sc1
  s_add_u32 s22, s31, 356352
  buffer_load_dwordx4 v[136:139], v2, s[8:11], s22 offen offset:0 sc1
  buffer_load_dwordx4 v[140:143], v2, s[8:11], s22 offen offset:1024 sc1
  buffer_load_dwordx4 v[144:147], v2, s[8:11], s22 offen offset:2048 sc1
  buffer_load_dwordx4 v[148:151], v2, s[8:11], s22 offen offset:3072 sc1
  s_add_u32 s22, s31, 360448
  buffer_load_dwordx4 v[152:155], v2, s[8:11], s22 offen offset:0 sc1
  buffer_load_dwordx4 v[156:159], v2, s[8:11], s22 offen offset:1024 sc1
  buffer_load_dwordx4 v[160:163], v2, s[8:11], s22 offen offset:2048 sc1
  buffer_load_dwordx4 v[164:167], v2, s[8:11], s22 offen offset:3072 sc1
  s_add_u32 s22, s31, 364544
  buffer_load_dwordx4 v[168:171], v2, s[8:11], s22 offen offset:0 sc1
  buffer_load_dwordx4 v[172:175], v2, s[8:11], s22 offen offset:1024 sc1
  buffer_load_dwordx4 v[176:179], v2, s[8:11], s22 offen offset:2048 sc1
  buffer_load_dwordx4 v[180:183], v2, s[8:11], s22 offen offset:3072 sc1
  s_add_u32 s22, s31, 368640
  buffer_load_dwordx4 v[184:187], v2, s[8:11], s22 offen offset:0 sc1
  buffer_load_dwordx4 v[188:191], v2, s[8:11], s22 offen offset:1024 sc1
  buffer_load_dwordx4 v[192:195], v2, s[8:11], s22 offen offset:2048 sc1
  buffer_load_dwordx4 v[196:199], v2, s[8:11], s22 offen offset:3072 sc1
  s_add_u32 s22, s31, 372736
  buffer_load_dwordx4 v[200:203], v2, s[8:11], s22 offen offset:0 sc1
  buffer_load_dwordx4 v[204:207], v2, s[8:11], s22 offen offset:1024 sc1
  buffer_load_dwordx4 v[208:211], v2, s[8:11], s22 offen offset:2048 sc1
  buffer_load_dwordx4 v[212:215], v2, s[8:11], s22 offen offset:3072 sc1
  s_add_u32 s22, s31, 376832
  buffer_load_dwordx4 v[216:219], v2, s[8:11], s22 offen offset:0 sc1
  buffer_load_dwordx4 v[220:223], v2, s[8:11], s22 offen offset:1024 sc1
  buffer_load_dwordx4 v[224:227], v2, s[8:11], s22 offen offset:2048 sc1
  buffer_load_dwordx4 v[228:231], v2, s[8:11], s22 offen offset:3072 sc1
  s_add_u32 s22, s31, 380928
  buffer_load_dwordx4 v[232:235], v2, s[8:11], s22 offen offset:0 sc1
  buffer_load_dwordx4 v[236:239], v2, s[8:11], s22 offen offset:1024 sc1
  buffer_load_dwordx4 v[240:243], v2, s[8:11], s22 offen offset:2048 sc1
  buffer_load_dwordx4 v[244:247], v2, s[8:11], s22 offen offset:3072 sc1
  s_waitcnt vmcnt(24)
  s_add_u32 s22, s31, 385024
  buffer_load_dwordx4 v[248:251], v2, s[8:11], s22 offen offset:0 sc1
  buffer_load_dwordx4 v[252:255], v2, s[8:11], s22 offen offset:1024 sc1
  v_mov_b32 v72, v116
  v_mov_b32 v73, v117
  v_lshrrev_b32 v65, 1, v72
  v_and_b32 v66, 1, v72
  v_add_u32 v67, 64, v73
  v_mul_u32_u24 v68, 5462, v67
  v_lshrrev_b32 v68, 16, v68
  v_mul_u32_u24 v69, 12, v68
  v_sub_u32 v69, v67, v69
  v_mov_b32 v70, 1
  v_and_b32 v71, 1, v69
  v_lshrrev_b32 v69, 1, v69
  v_lshl_add_u32 v69, v71, 3, v69
  v_lshlrev_b32 v71, 12, v70
  v_lshrrev_b32 v70, 1, v68
  v_lshl_add_u32 v71, v70, 9, v71
  v_and_b32 v70, 1, v68
  v_lshl_add_u32 v71, v70, 2, v71
  v_lshl_add_u32 v71, v69, 4, v71
  v_lshl_add_u32 v71, v65, 8, v71
  v_lshl_add_u32 v100, v66, 3, v71
  v_add_u32 v67, 80, v73
  v_mul_u32_u24 v68, 5462, v67
  v_lshrrev_b32 v68, 16, v68
  v_mul_u32_u24 v69, 12, v68
  v_sub_u32 v69, v67, v69
  v_mov_b32 v70, 1
  v_and_b32 v71, 1, v69
  v_lshrrev_b32 v69, 1, v69
  v_lshl_add_u32 v69, v71, 3, v69
  v_lshlrev_b32 v71, 12, v70
  v_lshrrev_b32 v70, 1, v68
  v_lshl_add_u32 v71, v70, 9, v71
  v_and_b32 v70, 1, v68
  v_lshl_add_u32 v71, v70, 2, v71
  v_lshl_add_u32 v71, v69, 4, v71
  v_lshl_add_u32 v71, v65, 8, v71
  v_lshl_add_u32 v101, v66, 3, v71
  v_add_u32 v67, 96, v73
  v_mul_u32_u24 v68, 5462, v67
  v_lshrrev_b32 v68, 16, v68
  v_mul_u32_u24 v69, 12, v68
  v_sub_u32 v69, v67, v69
  v_mov_b32 v70, 1
  v_and_b32 v71, 1, v69
  v_lshrrev_b32 v69, 1, v69
  v_lshl_add_u32 v69, v71, 3, v69
  v_lshlrev_b32 v71, 12, v70
  v_lshrrev_b32 v70, 1, v68
  v_lshl_add_u32 v71, v70, 9, v71
  v_and_b32 v70, 1, v68
  v_lshl_add_u32 v71, v70, 2, v71
  v_lshl_add_u32 v71, v69, 4, v71
  v_lshl_add_u32 v71, v65, 8, v71
  v_lshl_add_u32 v102, v66, 3, v71
  v_add_u32 v67, 112, v73
  v_mul_u32_u24 v68, 5462, v67
  v_lshrrev_b32 v68, 16, v68
  v_mul_u32_u24 v69, 12, v68
  v_sub_u32 v69, v67, v69
  v_mov_b32 v70, 1
  v_and_b32 v71, 1, v69
  v_lshrrev_b32 v69, 1, v69
  v_lshl_add_u32 v69, v71, 3, v69
  v_lshlrev_b32 v71, 12, v70
  v_lshrrev_b32 v70, 1, v68
  v_lshl_add_u32 v71, v70, 9, v71
  v_and_b32 v70, 1, v68
  v_lshl_add_u32 v71, v70, 2, v71
  v_lshl_add_u32 v71, v69, 4, v71
  v_lshl_add_u32 v71, v65, 8, v71
  v_lshl_add_u32 v103, v66, 3, v71
  v_add_u32 v67, 128, v73
  v_mul_u32_u24 v68, 5462, v67
  v_lshrrev_b32 v68, 16, v68
  v_mul_u32_u24 v69, 12, v68
  v_sub_u32 v69, v67, v69
  v_mov_b32 v70, 1
  v_and_b32 v71, 1, v69
  v_lshrrev_b32 v69, 1, v69
  v_lshl_add_u32 v69, v71, 3, v69
  v_lshlrev_b32 v71, 12, v70
  v_lshrrev_b32 v70, 1, v68
  v_lshl_add_u32 v71, v70, 9, v71
  v_and_b32 v70, 1, v68
  v_lshl_add_u32 v71, v70, 2, v71
  v_lshl_add_u32 v71, v69, 4, v71
  v_lshl_add_u32 v71, v65, 8, v71
  v_lshl_add_u32 v104, v66, 3, v71
  v_add_u32 v67, 144, v73
  v_mul_u32_u24 v68, 5462, v67
  v_lshrrev_b32 v68, 16, v68
  v_mul_u32_u24 v69, 12, v68
  v_sub_u32 v69, v67, v69
  v_mov_b32 v70, 1
  v_and_b32 v71, 1, v69
  v_lshrrev_b32 v69, 1, v69
  v_lshl_add_u32 v69, v71, 3, v69
  v_lshlrev_b32 v71, 12, v70
  v_lshrrev_b32 v70, 1, v68
  v_lshl_add_u32 v71, v70, 9, v71
  v_and_b32 v70, 1, v68
  v_lshl_add_u32 v71, v70, 2, v71
  v_lshl_add_u32 v71, v69, 4, v71
  v_lshl_add_u32 v71, v65, 8, v71
  v_lshl_add_u32 v105, v66, 3, v71
  v_add_u32 v67, 160, v73
  v_mul_u32_u24 v68, 5462, v67
  v_lshrrev_b32 v68, 16, v68
  v_mul_u32_u24 v69, 12, v68
  v_sub_u32 v69, v67, v69
  v_mov_b32 v70, 1
  v_and_b32 v71, 1, v69
  v_lshrrev_b32 v69, 1, v69
  v_lshl_add_u32 v69, v71, 3, v69
  v_lshlrev_b32 v71, 12, v70
  v_lshrrev_b32 v70, 1, v68
  v_lshl_add_u32 v71, v70, 9, v71
  v_and_b32 v70, 1, v68
  v_lshl_add_u32 v71, v70, 2, v71
  v_lshl_add_u32 v71, v69, 4, v71
  v_lshl_add_u32 v71, v65, 8, v71
  v_lshl_add_u32 v106, v66, 3, v71
  v_add_u32 v67, 176, v73
  v_mul_u32_u24 v68, 5462, v67
  v_lshrrev_b32 v68, 16, v68
  v_mul_u32_u24 v69, 12, v68
  v_sub_u32 v69, v67, v69
  v_mov_b32 v70, 1
  v_and_b32 v71, 1, v69
  v_lshrrev_b32 v69, 1, v69
  v_lshl_add_u32 v69, v71, 3, v69
  v_lshlrev_b32 v71, 12, v70
  v_lshrrev_b32 v70, 1, v68
  v_lshl_add_u32 v71, v70, 9, v71
  v_and_b32 v70, 1, v68
  v_lshl_add_u32 v71, v70, 2, v71
  v_lshl_add_u32 v71, v69, 4, v71
  v_lshl_add_u32 v71, v65, 8, v71
  v_lshl_add_u32 v107, v66, 3, v71
  s_mul_i32 s24, s17, 532480
  s_add_u32 s24, s24, 76943360
  s_mul_i32 s34, s17, 640
  s_add_u32 s34, s34, 88582148
  s_mul_i32 s36, s17, 448
  v_add_u32 v0, s36, v2
  v_add_u32 v0, 8192, v0
  s_add_u32 s36, s36, 88080384
  s_mov_b32 s37, 76939264
  v_cmp_gt_u32 s[26:27], 28, v1
  v_and_b32 v119, 31, v1
  v_lshlrev_b32 v119, 2, v119
  v_and_b32 v119, 0x78, v119
  v_or_b32 v119, 4, v119
  s_add_u32 s22, s17, 16
  s_and_b32 s22, s22, 15
  s_lshl_b32 s22, s22, 7
  s_add_u32 s22, s22, 18432
  v_add_u32 v119, s22, v119
  v_min_u32 v118, 13, v1
  s_mul_i32 s22, s17, 14
  v_add_u32 v118, s22, v118
  v_lshlrev_b32 v118, 7, v118
  v_add_u32 v118, 57344, v118
  s_mov_b32 s39, 71565312
  v_add_u32 v1, 59392, v2
  v_mov_b32 v117, 1
  s_mul_i32 s38, s17, 1104
  s_add_u32 s38, s38, 21504
  v_bfe_u32 v8, v2, 4, 1
  v_mul_u32_u24 v3, 0xaaaa, v8
  v_add_u32 v3, 0x4444, v3
  v_bfe_u32 v9, v2, 5, 3
  v_lshl_add_u32 v8, v8, 3, v9
  v_and_b32 v9, 0x300, v2
  v_lshl_add_u32 v5, v8, 4, v9
  s_getpc_b64 s[98:99]
cpf_23:
  s_add_u32 s98, s98, cA_va3_loop-cpf_23
  s_addc_u32 s99, s99, 0
  v_lshlrev_b32 v38, 2, v2
  global_load_dword v39, v38, s[98:99]
  s_lshl_b32 s22, 0, 11
  s_add_u32 s22, s22, 88602624
  v_add_u32 v36, 1024, v2
  v_min_u32 v36, 1776, v36
  s_mov_b32 s30, 0
va_iw7:
  buffer_load_dwordx4 v[40:43], v2, s[8:11], s22 offen sc1
  buffer_load_dwordx4 v[44:47], v36, s[8:11], s22 offen sc1
  s_waitcnt vmcnt(0)
  v_cmp_ne_u64 vcc, s[88:89], v[40:41]
  s_cbranch_vccnz va_iw7_no
  v_cmp_ne_u64 vcc, s[88:89], v[42:43]
  s_cbranch_vccnz va_iw7_no
  v_cmp_ne_u64 vcc, s[88:89], v[44:45]
  s_cbranch_vccnz va_iw7_no
  v_cmp_ne_u64 vcc, s[88:89], v[46:47]
  s_cbranch_vccnz va_iw7_no
  s_branch va_iw7_ok
va_iw7_no:
  s_sleep 2
  s_add_u32 s30, s30, 1
  s_cmp_lt_u32 s30, 50000
  s_cbranch_scc1 va_iw7
  s_branch cA_abort
va_iw7_ok:
  s_mov_b32 s30, 0
  v_mov_b32 v36, 0
ch_md7:
  buffer_load_dword v37, v36, s[12:15], 0 offen sc1
  s_waitcnt vmcnt(0)
  v_readfirstlane_b32 s22, v37
  s_and_b32 s31, s22, 0xffff
  s_cmp_ge_u32 s31, 32
  s_cbranch_scc1 ch_go7
  s_sleep 2
  s_add_u32 s30, s30, 1
  s_cmp_lt_u32 s30, 50000
  s_cbranch_scc1 ch_md7
  s_branch ch_end
ch_go7:
  s_mov_b32 s31, 0
  s_lshr_b32 s22, s22, 16
  s_cmp_lg_u32 s22, 0
  s_cbranch_scc1 cB_va3_loop
  s_branch cA_va3_loop
.p2align 6

cA_sc0_loop:
  s_add_u32 s23, s20, 4096
  s_add_u32 s21, s20, 20480
  s_mov_b32 s30, 0
  s_mov_b32 s62, 0
  buffer_load_dword v68, v0, s[8:11], s20 offen sc1
  v_mov_b32 v48, 0
  v_mov_b32 v49, 0
  v_mov_b32 v50, 0
  v_mov_b32 v51, 0
  v_mov_b32 v52, 0
  v_mov_b32 v53, 0
  v_mov_b32 v54, 0
  v_mov_b32 v55, 0
  buffer_load_dword v69, v0, s[8:11], s20 offen sc1
  v_mov_b32 v56, 0
  v_mov_b32 v57, 0
  v_mov_b32 v58, 0
  v_mov_b32 v59, 0
  v_mov_b32 v60, 0
  v_mov_b32 v61, 0
  v_mov_b32 v62, 0
  v_mov_b32 v63, 0
  buffer_load_dword v70, v0, s[8:11], s20 offen sc1
  v_mov_b32 v88, 0
  v_mov_b32 v89, 0
  v_mov_b32 v90, 0
  v_mov_b32 v91, 0
  v_mov_b32 v92, 0
  v_mov_b32 v93, 0
  v_mov_b32 v94, 0
  v_mov_b32 v95, 0
  buffer_load_dword v71, v0, s[8:11], s20 offen sc1
  v_mov_b32 v66, 0
  v_mov_b32 v67, 0
  buffer_load_dword v72, v0, s[8:11], s20 offen sc1
cA_sc0_fp_l:
  s_waitcnt vmcnt(4)
  v_cmp_eq_u32 vcc, -1, v68
  s_cbranch_vccz cA_sc0_fp_d
  buffer_load_dword v68, v0, s[8:11], s20 offen sc1
  s_waitcnt vmcnt(4)
  v_cmp_eq_u32 vcc, -1, v69
  s_cbranch_vccz cA_sc0_fp_d
  buffer_load_dword v69, v0, s[8:11], s20 offen sc1
  s_waitcnt vmcnt(4)
  v_cmp_eq_u32 vcc, -1, v70
  s_cbranch_vccz cA_sc0_fp_d
  buffer_load_dword v70, v0, s[8:11], s20 offen sc1
  s_waitcnt vmcnt(4)
  v_cmp_eq_u32 vcc, -1, v71
  s_cbranch_vccz cA_sc0_fp_d
  buffer_load_dword v71, v0, s[8:11], s20 offen sc1
  s_waitcnt vmcnt(4)
  v_cmp_eq_u32 vcc, -1, v72
  s_cbranch_vccz cA_sc0_fp_d
  buffer_load_dword v72, v0, s[8:11], s20 offen sc1
  s_add_u32 s30, s30, 1
  s_cmp_lt_u32 s30, 400000
  s_cbranch_scc1 cA_sc0_fp_l
  s_branch cA_abort
cA_sc0_fp_d:
  buffer_load_dwordx4 v[8:11], v2, s[8:11], s20 offen offset:0
  s_barrier
  s_branch cA_sc0_ld1
cA_sc0_ld:
  buffer_load_dwordx4 v[8:11], v2, s[8:11], s20 offen offset:0
cA_sc0_ld1:
  v_mov_b32 v36, 0
  v_mov_b32 v37, 0
  v_mov_b32 v38, 0
  v_mov_b32 v39, 0
  buffer_load_dwordx4 v[12:15], v2, s[8:11], s20 offen offset:1024
  v_mov_b32 v40, 0
  v_mov_b32 v41, 0
  v_mov_b32 v42, 0
  v_mov_b32 v43, 0
  buffer_load_dwordx4 v[16:19], v2, s[8:11], s20 offen offset:2048
  v_mov_b32 v44, 0
  v_mov_b32 v45, 0
  v_mov_b32 v46, 0
  v_mov_b32 v47, 0
  ds_read_b128 v[96:99], v117 offset:0
  ds_read_b128 v[100:103], v117 offset:1024
  ds_read_b128 v[104:107], v117 offset:14336
  ds_read_b128 v[108:111], v117 offset:15360
  s_waitcnt vmcnt(2)
  v_smfmac_f32_16x16x64_bf16 v[36:39], v[8:11], a[0:7], v3
  v_smfmac_f32_16x16x64_bf16 v[40:43], v[8:11], a[56:63], v3
  buffer_load_dwordx4 v[20:23], v2, s[8:11], s20 offen offset:3072
  v_smfmac_f32_16x16x64_bf16 v[44:47], v[8:11], a[112:119], v3
  v_smfmac_f32_16x16x64_bf16 v[48:51], v[8:11], a[168:175], v3
  v_smfmac_f32_16x16x64_bf16 v[52:55], v[8:11], a[224:231], v3
  buffer_load_dwordx4 v[24:27], v2, s[8:11], s23 offen offset:0
  v_smfmac_f32_16x16x64_bf16 v[56:59], v[8:11], v[144:151], v3
  v_smfmac_f32_16x16x64_bf16 v[60:63], v[8:11], v[200:207], v3
  s_waitcnt vmcnt(3)
  v_smfmac_f32_16x16x64_bf16 v[36:39], v[12:15], a[8:15], v3
  v_smfmac_f32_16x16x64_bf16 v[40:43], v[12:15], a[64:71], v3
  buffer_load_dwordx4 v[28:31], v2, s[8:11], s23 offen offset:1024
  v_smfmac_f32_16x16x64_bf16 v[44:47], v[12:15], a[120:127], v3
  v_smfmac_f32_16x16x64_bf16 v[48:51], v[12:15], a[176:183], v3
  v_smfmac_f32_16x16x64_bf16 v[52:55], v[12:15], a[232:239], v3
  buffer_load_dwordx4 v[32:35], v2, s[8:11], s23 offen offset:2048
  v_smfmac_f32_16x16x64_bf16 v[56:59], v[12:15], v[152:159], v3
  v_smfmac_f32_16x16x64_bf16 v[60:63], v[12:15], v[208:215], v3
  s_xor_b32 s58, s25, 28672
  s_add_u32 s59, s24, 28672
  s_add_u32 m0, s58, 0
  s_waitcnt vmcnt(4)
  v_smfmac_f32_16x16x64_bf16 v[36:39], v[16:19], a[16:23], v3
  buffer_load_dwordx4 v2, s[8:11], s59 offen offset:0 sc1 lds
  v_smfmac_f32_16x16x64_bf16 v[40:43], v[16:19], a[72:79], v3
  v_smfmac_f32_16x16x64_bf16 v[44:47], v[16:19], a[128:135], v3
  v_smfmac_f32_16x16x64_bf16 v[48:51], v[16:19], a[184:191], v3
  v_smfmac_f32_16x16x64_bf16 v[52:55], v[16:19], a[240:247], v3
  buffer_load_dwordx4 v2, s[8:11], s59 offen offset:1024 sc1 lds
  v_smfmac_f32_16x16x64_bf16 v[56:59], v[16:19], v[160:167], v3
  v_smfmac_f32_16x16x64_bf16 v[60:63], v[16:19], v[216:223], v3
  s_waitcnt vmcnt(5)
  v_smfmac_f32_16x16x64_bf16 v[36:39], v[20:23], a[24:31], v3
  v_smfmac_f32_16x16x64_bf16 v[40:43], v[20:23], a[80:87], v3
  buffer_load_dwordx4 v2, s[8:11], s59 offen offset:2048 sc1 lds
  v_smfmac_f32_16x16x64_bf16 v[44:47], v[20:23], a[136:143], v3
  v_smfmac_f32_16x16x64_bf16 v[48:51], v[20:23], a[192:199], v3
  v_smfmac_f32_16x16x64_bf16 v[52:55], v[20:23], a[248:255], v3
  v_smfmac_f32_16x16x64_bf16 v[56:59], v[20:23], v[168:175], v3
  buffer_load_dwordx4 v2, s[8:11], s59 offen offset:3072 sc1 lds
  v_smfmac_f32_16x16x64_bf16 v[60:63], v[20:23], v[224:231], v3
  s_waitcnt vmcnt(4)
cA_sc0_ph2:
  v_smfmac_f32_16x16x64_bf16 v[60:63], v[24:27], v[232:239], v3
  ds_read_b128 v[12:15], v116 offset:0
  ds_read_b128 v[16:19], v116 offset:1024
  v_smfmac_f32_16x16x64_bf16 v[60:63], v[28:31], v[240:247], v3
  v_smfmac_f32_16x16x64_bf16 v[60:63], v[32:35], v[248:255], v3
  v_mov_b32 v80, v24
  v_smfmac_f32_16x16x64_bf16 v[52:55], v[24:27], v[120:127], v3
  v_mov_b32 v81, v25
  v_smfmac_f32_16x16x64_bf16 v[52:55], v[28:31], v[128:135], v3
  v_mov_b32 v82, v32
  v_smfmac_f32_16x16x64_bf16 v[52:55], v[32:35], v[136:143], v3
  v_cvt_pk_bf16_f32 v64, v60, v61
  v_smfmac_f32_16x16x64_bf16 v[56:59], v[24:27], v[176:183], v3
  v_cvt_pk_bf16_f32 v65, v62, v63
  v_smfmac_f32_16x16x64_bf16 v[56:59], v[28:31], v[184:191], v3
  v_mov_b32 v83, v33
  v_mfma_f32_16x16x32_bf16 v[68:71], v[64:67], v[4:7], 0
  v_smfmac_f32_16x16x64_bf16 v[56:59], v[32:35], v[192:199], v3
  v_cvt_pk_bf16_f32 v64, v52, v53
  v_smfmac_f32_16x16x64_bf16 v[36:39], v[24:27], a[32:39], v3
  v_cvt_pk_bf16_f32 v65, v54, v55
  v_smfmac_f32_16x16x64_bf16 v[36:39], v[28:31], a[40:47], v3
  v_cvt_pk_bf16_f32 v78, v68, v69
  v_smfmac_f32_16x16x64_bf16 v[36:39], v[32:35], a[48:55], v3
  v_cvt_pk_bf16_f32 v79, v70, v71
  v_cvt_pk_bf16_f32 v66, v56, v57
  v_smfmac_f32_16x16x64_bf16 v[40:43], v[24:27], a[88:95], v3
  v_cvt_pk_bf16_f32 v67, v58, v59
  v_smfmac_f32_16x16x64_bf16 v[40:43], v[28:31], a[96:103], v3
  v_mfma_f32_16x16x32_bf16 v[72:75], v[64:67], v[4:7], 0
  ds_read_b128 v[52:55], v116 offset:14336
  ds_read_b128 v[56:59], v116 offset:15360
  v_smfmac_f32_16x16x64_bf16 v[40:43], v[32:35], a[104:111], v3
  v_cvt_pk_bf16_f32 v64, v36, v37
  v_smfmac_f32_16x16x64_bf16 v[44:47], v[24:27], a[144:151], v3
  v_cvt_pk_bf16_f32 v65, v38, v39
  v_smfmac_f32_16x16x64_bf16 v[44:47], v[28:31], a[152:159], v3
  v_cvt_pk_bf16_f32 v76, v72, v73
  v_smfmac_f32_16x16x64_bf16 v[44:47], v[32:35], a[160:167], v3
  v_cvt_pk_bf16_f32 v77, v74, v75
  v_cvt_pk_bf16_f32 v66, v40, v41
  v_smfmac_f32_16x16x64_bf16 v[48:51], v[24:27], a[200:207], v3
  v_cvt_pk_bf16_f32 v67, v42, v43
  v_smfmac_f32_16x16x64_bf16 v[48:51], v[28:31], a[208:215], v3
  v_mfma_f32_16x16x32_bf16 v[68:71], v[64:67], v[4:7], 0
  v_smfmac_f32_16x16x64_bf16 v[48:51], v[32:35], a[216:223], v3
  v_cvt_pk_bf16_f32 v64, v44, v45
  v_mfma_f32_16x16x32_bf16 v[84:87], v[80:83], v[76:79], 0
  v_cvt_pk_bf16_f32 v65, v46, v47
  s_waitcnt lgkmcnt(0)
  v_smfmac_f32_16x16x64_bf16 v[88:91], v[76:79], v[96:103], v118
  v_cvt_pk_bf16_f32 v60, v68, v69
  v_cvt_pk_bf16_f32 v61, v70, v71
  v_cvt_pk_bf16_f32 v66, v48, v49
  v_cvt_pk_bf16_f32 v67, v50, v51
  s_nop 1
  v_mfma_f32_16x16x32_bf16 v[72:75], v[64:67], v[4:7], 0
  v_smfmac_f32_16x16x64_bf16 v[92:95], v[76:79], v[104:111], v118
  s_nop 4
  v_cvt_pk_bf16_f32 v62, v72, v73
  v_cvt_pk_bf16_f32 v63, v74, v75
  s_nop 1
  v_mfma_f32_16x16x32_bf16 v[84:87], v[8:11], v[60:63], v[84:87]
  v_smfmac_f32_16x16x64_bf16 v[88:91], v[60:63], v[12:19], v118
  v_smfmac_f32_16x16x64_bf16 v[92:95], v[60:63], v[52:59], v118
  s_nop 1
  v_permlane32_swap_b32 v84, v86
  v_permlane32_swap_b32 v85, v87
  s_nop 0
  v_add_f32 v88, v88, v89
  v_add_f32_dpp v84, v86, v84 quad_perm:[1,0,3,2] row_mask:0xf bank_mask:0xf
  v_add_f32_dpp v85, v87, v85 quad_perm:[1,0,3,2] row_mask:0xf bank_mask:0xf
  v_add_f32 v89, v90, v91
  ds_write2_b32 v113, v84, v85 offset0:0 offset1:4
  ds_write2_b32 v112, v88, v89 offset0:0 offset1:128
  v_add_f32 v90, v92, v93
  v_add_f32 v91, v94, v95
  ds_write2_b32 v112, v90, v91 offset0:64 offset1:192
  v_cmp_u_f32 vcc, v88, v89
  s_cbranch_vccnz cA_sc0_retry
cA_sc0_cont:
  s_waitcnt lgkmcnt(0)
  s_barrier
  ds_read_b128 v[36:39], v114
  ds_read_b128 v[44:47], v115
  s_waitcnt lgkmcnt(0)
  v_add_f32 v36, v36, v38
  v_add_f32 v37, v37, v39
  v_add_f32 v44, v44, v45
  buffer_store_dword v2, v119, s[8:11], s20 offen
  v_add_f32 v46, v46, v47
  v_add_f32 v44, v44, v46
  v_add_f32 v36, v36, v37
  v_exp_f32 v49, v44
  v_exp_f32 v48, v36
  v_add_f32 v50, abs(v36), abs(v44)
  v_fma_f32 v39, v49, s37, v48
  v_cmp_ngt_f32 vcc, s56, v50
  v_cndmask_b32 v41, v48, v49, s[38:39]
  v_add_f32_dpp v39, v39, v39 quad_perm:[1,0,3,2] row_mask:0xf bank_mask:0xf
  v_cndmask_b32 v40, v49, v48, s[38:39]
  v_mov_b32_dpp v46, v41 quad_perm:[1,0,3,2] row_mask:0xf bank_mask:0xf
  v_add_f32_dpp v39, v39, v39 quad_perm:[2,3,0,1] row_mask:0xf bank_mask:0xf
  v_cndmask_b32 v42, v46, v40, s[38:39]
  v_cndmask_b32 v43, v40, v46, s[38:39]
  v_add_f32_dpp v39, v39, v39 row_half_mirror row_mask:0xf bank_mask:0xf
  s_cbranch_vccnz cA_sc0_slow
  s_nop 0
  v_add_f32_dpp v47, v39, v39 row_mirror row_mask:0xf bank_mask:0xf
  v_add_f32_dpp v39, v39, v39 row_mirror row_mask:0xf bank_mask:0xf
  s_nop 1
  v_permlane16_swap_b32 v39, v47
  v_add_f32 v39, v39, v47
  v_rcp_f32 v39, v39
  s_mov_b64 exec, s[28:29]
  v_mul_f32 v42, v42, v39
  v_mul_f32 v43, v43, v39
  v_cvt_pk_bf16_f32 v42, v42, v43
cA_sc0_pst:
  buffer_store_dword v42, v1, s[8:11], s20 offen
  s_mov_b64 exec, -1
  s_barrier
  s_cmp_lg_u32 s19, 0
  s_cbranch_scc1 cA_sc0_s0
  s_sub_u32 s36, s36, 64
  v_subrev_u32 v119, 64, v119
  v_lshl_add_u32 v56, v2, 3, s36
  s_mov_b64 exec, 15
  buffer_store_dword v2, v56, s[8:11], s20 offen
  s_mov_b64 exec, -1
cA_sc0_s0:
  s_add_u32 s24, s24, 28672
  s_add_u32 s35, s35, 28672
  s_xor_b32 s25, s25, 28672
  s_add_u32 m0, s25, 0
  s_add_u32 m0, s25, 4096
  s_add_u32 s22, s24, 4096
  buffer_load_dwordx4 v2, s[8:11], s22 offen offset:0 sc1 lds
  buffer_load_dwordx4 v2, s[8:11], s22 offen offset:1024 sc1 lds
  buffer_load_dwordx4 v2, s[8:11], s22 offen offset:2048 sc1 lds
  v_xor_b32 v116, 28672, v116
  v_add_u32 v117, s57, v117
  s_sub_u32 s57, 0, s57
  s_add_u32 s19, s19, 1
  s_mov_b32 s20, s21
  s_cmp_lt_u32 s19, 63
  s_cbranch_scc1 cA_sc0_loop
  s_branch cA_done
cA_sc0_slow:
  v_max_f32 v50, v36, v44
  s_nop 1
  v_max_f32_dpp v50, v50, v50 quad_perm:[1,0,3,2] row_mask:0xf bank_mask:0xf
  s_nop 1
  v_max_f32_dpp v50, v50, v50 quad_perm:[2,3,0,1] row_mask:0xf bank_mask:0xf
  s_nop 1
  v_max_f32_dpp v50, v50, v50 row_half_mirror row_mask:0xf bank_mask:0xf
  s_nop 1
  v_max_f32_dpp v50, v50, v50 row_mirror row_mask:0xf bank_mask:0xf
  v_mov_b32 v47, v50
  s_nop 1
  v_permlane16_swap_b32 v50, v47
  v_max_f32 v50, v50, v47
  v_sub_f32 v48, v36, v50
  v_sub_f32 v49, v44, v50
  v_exp_f32 v48, v48
  v_exp_f32 v49, v49
  s_add_u32 s31, s31, 0x100
  v_fma_f32 v39, v49, s37, v48
  v_cndmask_b32 v41, v48, v49, s[38:39]
  s_nop 0
  v_add_f32_dpp v39, v39, v39 quad_perm:[1,0,3,2] row_mask:0xf bank_mask:0xf
  v_cndmask_b32 v40, v49, v48, s[38:39]
  v_mov_b32_dpp v46, v41 quad_perm:[1,0,3,2] row_mask:0xf bank_mask:0xf
  v_add_f32_dpp v39, v39, v39 quad_perm:[2,3,0,1] row_mask:0xf bank_mask:0xf
  v_cndmask_b32 v42, v46, v40, s[38:39]
  v_cndmask_b32 v43, v40, v46, s[38:39]
  v_add_f32_dpp v39, v39, v39 row_half_mirror row_mask:0xf bank_mask:0xf
  s_nop 1
  v_add_f32_dpp v47, v39, v39 row_mirror row_mask:0xf bank_mask:0xf
  v_add_f32_dpp v39, v39, v39 row_mirror row_mask:0xf bank_mask:0xf
  s_nop 1
  v_permlane16_swap_b32 v39, v47
  v_add_f32 v39, v39, v47
  v_rcp_f32 v39, v39
  s_mov_b64 exec, s[28:29]
  v_mul_f32 v42, v42, v39
  v_mul_f32 v43, v43, v39
  v_cvt_pk_bf16_f32 v42, v42, v43
  v_min_u32 v42, -2, v42
  s_branch cA_sc0_pst
cA_sc0_retry:
  s_cmp_lg_u32 s62, 0
  s_cbranch_scc1 cA_sc0_cont
  s_waitcnt vmcnt(0) lgkmcnt(0)
cA_sc0_rv:
  buffer_load_dwordx4 v[8:11], v2, s[8:11], s20 offen offset:0 sc1
  buffer_load_dwordx4 v[12:15], v2, s[8:11], s20 offen offset:1024 sc1
  buffer_load_dwordx4 v[16:19], v2, s[8:11], s20 offen offset:2048 sc1
  buffer_load_dwordx4 v[20:23], v2, s[8:11], s20 offen offset:3072 sc1
  buffer_load_dwordx4 v[24:27], v2, s[8:11], s23 offen offset:0 sc1
  buffer_load_dwordx4 v[28:31], v2, s[8:11], s23 offen offset:1024 sc1
  buffer_load_dwordx4 v[32:35], v2, s[8:11], s23 offen offset:2048 sc1
  s_waitcnt vmcnt(0)
  v_max3_u32 v68, v8, v9, v10
  v_max3_u32 v68, v68, v11, v12
  v_max3_u32 v68, v68, v13, v14
  v_max3_u32 v68, v68, v15, v16
  v_max3_u32 v68, v68, v17, v18
  v_max3_u32 v68, v68, v19, v20
  v_max3_u32 v68, v68, v21, v22
  v_max3_u32 v68, v68, v23, v24
  v_max3_u32 v68, v68, v25, v26
  v_max3_u32 v68, v68, v27, v28
  v_max3_u32 v68, v68, v29, v30
  v_max3_u32 v68, v68, v31, v32
  v_max3_u32 v68, v68, v33, v34
  v_max_u32 v68, v68, v35
  v_cmp_eq_u32 vcc, -1, v68
  s_cbranch_vccz cA_sc0_rk
  s_add_u32 s30, s30, 1
  s_cmp_lt_u32 s30, 400000
  s_cbranch_scc1 cA_sc0_rv
  s_branch cA_abort
cA_sc0_rk:
  s_mov_b32 s62, 1
  v_mov_b32 v36, 0
  v_mov_b32 v37, 0
  v_mov_b32 v38, 0
  v_mov_b32 v39, 0
  v_mov_b32 v40, 0
  v_mov_b32 v41, 0
  v_mov_b32 v42, 0
  v_mov_b32 v43, 0
  v_mov_b32 v44, 0
  v_mov_b32 v45, 0
  v_mov_b32 v46, 0
  v_mov_b32 v47, 0
  v_mov_b32 v48, 0
  v_mov_b32 v49, 0
  v_mov_b32 v50, 0
  v_mov_b32 v51, 0
  v_mov_b32 v52, 0
  v_mov_b32 v53, 0
  v_mov_b32 v54, 0
  v_mov_b32 v55, 0
  v_mov_b32 v56, 0
  v_mov_b32 v57, 0
  v_mov_b32 v58, 0
  v_mov_b32 v59, 0
  v_mov_b32 v60, 0
  v_mov_b32 v61, 0
  v_mov_b32 v62, 0
  v_mov_b32 v63, 0
  v_mov_b32 v88, 0
  v_mov_b32 v89, 0
  v_mov_b32 v90, 0
  v_mov_b32 v91, 0
  v_mov_b32 v92, 0
  v_mov_b32 v93, 0
  v_mov_b32 v94, 0
  v_mov_b32 v95, 0
  v_mov_b32 v66, 0
  v_mov_b32 v67, 0
  s_add_u32 s31, s31, 1
  ds_read_b128 v[96:99], v117 offset:0
  ds_read_b128 v[100:103], v117 offset:1024
  ds_read_b128 v[104:107], v117 offset:14336
  ds_read_b128 v[108:111], v117 offset:15360
  v_smfmac_f32_16x16x64_bf16 v[36:39], v[8:11], a[0:7], v3
  v_smfmac_f32_16x16x64_bf16 v[40:43], v[8:11], a[56:63], v3
  v_smfmac_f32_16x16x64_bf16 v[44:47], v[8:11], a[112:119], v3
  v_smfmac_f32_16x16x64_bf16 v[48:51], v[8:11], a[168:175], v3
  v_smfmac_f32_16x16x64_bf16 v[52:55], v[8:11], a[224:231], v3
  v_smfmac_f32_16x16x64_bf16 v[56:59], v[8:11], v[144:151], v3
  v_smfmac_f32_16x16x64_bf16 v[60:63], v[8:11], v[200:207], v3
  v_smfmac_f32_16x16x64_bf16 v[36:39], v[12:15], a[8:15], v3
  v_smfmac_f32_16x16x64_bf16 v[40:43], v[12:15], a[64:71], v3
  v_smfmac_f32_16x16x64_bf16 v[44:47], v[12:15], a[120:127], v3
  v_smfmac_f32_16x16x64_bf16 v[48:51], v[12:15], a[176:183], v3
  v_smfmac_f32_16x16x64_bf16 v[52:55], v[12:15], a[232:239], v3
  v_smfmac_f32_16x16x64_bf16 v[56:59], v[12:15], v[152:159], v3
  v_smfmac_f32_16x16x64_bf16 v[60:63], v[12:15], v[208:215], v3
  v_smfmac_f32_16x16x64_bf16 v[36:39], v[16:19], a[16:23], v3
  v_smfmac_f32_16x16x64_bf16 v[40:43], v[16:19], a[72:79], v3
  v_smfmac_f32_16x16x64_bf16 v[44:47], v[16:19], a[128:135], v3
  v_smfmac_f32_16x16x64_bf16 v[48:51], v[16:19], a[184:191], v3
  v_smfmac_f32_16x16x64_bf16 v[52:55], v[16:19], a[240:247], v3
  v_smfmac_f32_16x16x64_bf16 v[56:59], v[16:19], v[160:167], v3
  v_smfmac_f32_16x16x64_bf16 v[60:63], v[16:19], v[216:223], v3
  v_smfmac_f32_16x16x64_bf16 v[36:39], v[20:23], a[24:31], v3
  v_smfmac_f32_16x16x64_bf16 v[40:43], v[20:23], a[80:87], v3
  v_smfmac_f32_16x16x64_bf16 v[44:47], v[20:23], a[136:143], v3
  v_smfmac_f32_16x16x64_bf16 v[48:51], v[20:23], a[192:199], v3
  v_smfmac_f32_16x16x64_bf16 v[52:55], v[20:23], a[248:255], v3
  v_smfmac_f32_16x16x64_bf16 v[56:59], v[20:23], v[168:175], v3
  v_smfmac_f32_16x16x64_bf16 v[60:63], v[20:23], v[224:231], v3
  s_xor_b32 s58, s25, 28672
  s_add_u32 s59, s24, 28672
  s_add_u32 m0, s58, 0
  s_branch cA_sc0_ph2
.p2align 6

cA_sc1_loop:
  s_add_u32 s23, s20, 4096
  s_add_u32 s21, s20, 20480
  s_mov_b32 s30, 0
  s_mov_b32 s62, 0
  s_waitcnt vmcnt(0)
  s_barrier
cA_sc1_ld:
  buffer_load_dwordx4 v[8:11], v2, s[8:11], s20 offen offset:0
  v_mov_b32 v36, 0
  v_mov_b32 v37, 0
  v_mov_b32 v38, 0
  v_mov_b32 v39, 0
  buffer_load_dwordx4 v[12:15], v2, s[8:11], s20 offen offset:1024
  v_mov_b32 v40, 0
  v_mov_b32 v41, 0
  v_mov_b32 v42, 0
  v_mov_b32 v43, 0
  buffer_load_dwordx4 v[16:19], v2, s[8:11], s20 offen offset:2048
  v_mov_b32 v44, 0
  v_mov_b32 v45, 0
  v_mov_b32 v46, 0
  v_mov_b32 v47, 0
  ds_read_b128 v[96:99], v117 offset:0
  ds_read_b128 v[100:103], v117 offset:1024
  ds_read_b128 v[104:107], v117 offset:14336
  ds_read_b128 v[108:111], v117 offset:15360
  s_waitcnt vmcnt(2)
  v_smfmac_f32_16x16x64_bf16 v[36:39], v[8:11], a[0:7], v3
  v_smfmac_f32_16x16x64_bf16 v[40:43], v[8:11], a[56:63], v3
  buffer_load_dwordx4 v[20:23], v2, s[8:11], s20 offen offset:3072
  v_smfmac_f32_16x16x64_bf16 v[44:47], v[8:11], a[112:119], v3
  v_smfmac_f32_16x16x64_bf16 v[48:51], v[8:11], a[168:175], v3
  v_smfmac_f32_16x16x64_bf16 v[52:55], v[8:11], a[224:231], v3
  buffer_load_dwordx4 v[24:27], v2, s[8:11], s23 offen offset:0
  v_smfmac_f32_16x16x64_bf16 v[56:59], v[8:11], v[144:151], v3
  v_smfmac_f32_16x16x64_bf16 v[60:63], v[8:11], v[200:207], v3
  s_waitcnt vmcnt(3)
  v_smfmac_f32_16x16x64_bf16 v[36:39], v[12:15], a[8:15], v3
  v_smfmac_f32_16x16x64_bf16 v[40:43], v[12:15], a[64:71], v3
  buffer_load_dwordx4 v[28:31], v2, s[8:11], s23 offen offset:1024
  v_smfmac_f32_16x16x64_bf16 v[44:47], v[12:15], a[120:127], v3
  v_smfmac_f32_16x16x64_bf16 v[48:51], v[12:15], a[176:183], v3
  v_smfmac_f32_16x16x64_bf16 v[52:55], v[12:15], a[232:239], v3
  buffer_load_dwordx4 v[32:35], v2, s[8:11], s23 offen offset:2048
  v_smfmac_f32_16x16x64_bf16 v[56:59], v[12:15], v[152:159], v3
  v_smfmac_f32_16x16x64_bf16 v[60:63], v[12:15], v[208:215], v3
  s_waitcnt vmcnt(4)
  v_smfmac_f32_16x16x64_bf16 v[36:39], v[16:19], a[16:23], v3
  s_xor_b32 s58, s25, 28672
  s_add_u32 s59, s24, 28672
  s_add_u32 m0, s58, 7168
  v_smfmac_f32_16x16x64_bf16 v[40:43], v[16:19], a[72:79], v3
  buffer_load_dwordx4 v2, s[8:11], s59 offen offset:0 sc1 lds
  v_smfmac_f32_16x16x64_bf16 v[44:47], v[16:19], a[128:135], v3
  v_smfmac_f32_16x16x64_bf16 v[48:51], v[16:19], a[184:191], v3
  v_smfmac_f32_16x16x64_bf16 v[52:55], v[16:19], a[240:247], v3
  v_smfmac_f32_16x16x64_bf16 v[56:59], v[16:19], v[160:167], v3
  buffer_load_dwordx4 v2, s[8:11], s59 offen offset:1024 sc1 lds
  v_smfmac_f32_16x16x64_bf16 v[60:63], v[16:19], v[216:223], v3
  s_waitcnt vmcnt(5)
  v_smfmac_f32_16x16x64_bf16 v[36:39], v[20:23], a[24:31], v3
  v_smfmac_f32_16x16x64_bf16 v[40:43], v[20:23], a[80:87], v3
  v_smfmac_f32_16x16x64_bf16 v[44:47], v[20:23], a[136:143], v3
  buffer_load_dwordx4 v2, s[8:11], s59 offen offset:2048 sc1 lds
  v_smfmac_f32_16x16x64_bf16 v[48:51], v[20:23], a[192:199], v3
  v_smfmac_f32_16x16x64_bf16 v[52:55], v[20:23], a[248:255], v3
  v_smfmac_f32_16x16x64_bf16 v[56:59], v[20:23], v[168:175], v3
  v_smfmac_f32_16x16x64_bf16 v[60:63], v[20:23], v[224:231], v3
  buffer_load_dwordx4 v2, s[8:11], s59 offen offset:3072 sc1 lds
  s_waitcnt vmcnt(4)
cA_sc1_ph2:
  v_smfmac_f32_16x16x64_bf16 v[60:63], v[24:27], v[232:239], v3
  ds_read_b128 v[16:19], v116 offset:2048
  ds_read_b128 v[20:23], v116 offset:3072
  v_smfmac_f32_16x16x64_bf16 v[60:63], v[28:31], v[240:247], v3
  buffer_load_dword v119, v0, s[8:11], s20 offen sc1
  v_smfmac_f32_16x16x64_bf16 v[60:63], v[32:35], v[248:255], v3
  v_mov_b32 v80, v26
  v_smfmac_f32_16x16x64_bf16 v[52:55], v[24:27], v[120:127], v3
  v_mov_b32 v81, v27
  v_smfmac_f32_16x16x64_bf16 v[52:55], v[28:31], v[128:135], v3
  v_mov_b32 v82, v32
  v_smfmac_f32_16x16x64_bf16 v[52:55], v[32:35], v[136:143], v3
  v_cvt_pk_bf16_f32 v66, v60, v61
  v_smfmac_f32_16x16x64_bf16 v[56:59], v[24:27], v[176:183], v3
  v_cvt_pk_bf16_f32 v67, v62, v63
  v_smfmac_f32_16x16x64_bf16 v[56:59], v[28:31], v[184:191], v3
  v_mov_b32 v83, v33
  v_mfma_f32_16x16x32_bf16 v[68:71], v[64:67], v[4:7], 0
  v_smfmac_f32_16x16x64_bf16 v[56:59], v[32:35], v[192:199], v3
  v_cvt_pk_bf16_f32 v64, v52, v53
  v_smfmac_f32_16x16x64_bf16 v[36:39], v[24:27], a[32:39], v3
  v_cvt_pk_bf16_f32 v65, v54, v55
  v_smfmac_f32_16x16x64_bf16 v[36:39], v[28:31], a[40:47], v3
  v_cvt_pk_bf16_f32 v78, v68, v69
  v_smfmac_f32_16x16x64_bf16 v[36:39], v[32:35], a[48:55], v3
  v_cvt_pk_bf16_f32 v79, v70, v71
  v_cvt_pk_bf16_f32 v66, v56, v57
  v_smfmac_f32_16x16x64_bf16 v[40:43], v[24:27], a[88:95], v3
  v_cvt_pk_bf16_f32 v67, v58, v59
  v_smfmac_f32_16x16x64_bf16 v[40:43], v[28:31], a[96:103], v3
  v_mfma_f32_16x16x32_bf16 v[72:75], v[64:67], v[4:7], 0
  ds_read_b128 v[52:55], v116 offset:16384
  ds_read_b128 v[56:59], v116 offset:17408
  v_smfmac_f32_16x16x64_bf16 v[40:43], v[32:35], a[104:111], v3
  v_cvt_pk_bf16_f32 v64, v36, v37
  v_smfmac_f32_16x16x64_bf16 v[44:47], v[24:27], a[144:151], v3
  v_cvt_pk_bf16_f32 v65, v38, v39
  v_smfmac_f32_16x16x64_bf16 v[44:47], v[28:31], a[152:159], v3
  v_cvt_pk_bf16_f32 v76, v72, v73
  v_smfmac_f32_16x16x64_bf16 v[44:47], v[32:35], a[160:167], v3
  v_cvt_pk_bf16_f32 v77, v74, v75
  v_cvt_pk_bf16_f32 v66, v40, v41
  v_smfmac_f32_16x16x64_bf16 v[48:51], v[24:27], a[200:207], v3
  v_cvt_pk_bf16_f32 v67, v42, v43
  v_smfmac_f32_16x16x64_bf16 v[48:51], v[28:31], a[208:215], v3
  v_mfma_f32_16x16x32_bf16 v[68:71], v[64:67], v[4:7], 0
  v_smfmac_f32_16x16x64_bf16 v[48:51], v[32:35], a[216:223], v3
  v_cvt_pk_bf16_f32 v64, v44, v45
  v_mfma_f32_16x16x32_bf16 v[84:87], v[80:83], v[76:79], 0
  v_cvt_pk_bf16_f32 v65, v46, v47
  s_waitcnt lgkmcnt(0)
  v_smfmac_f32_16x16x64_bf16 v[88:91], v[76:79], v[96:103], v118
  v_cvt_pk_bf16_f32 v60, v68, v69
  v_cvt_pk_bf16_f32 v61, v70, v71
  v_cvt_pk_bf16_f32 v66, v48, v49
  v_cvt_pk_bf16_f32 v67, v50, v51
  s_nop 1
  v_mfma_f32_16x16x32_bf16 v[72:75], v[64:67], v[4:7], 0
  v_smfmac_f32_16x16x64_bf16 v[92:95], v[76:79], v[104:111], v118
  s_nop 4
  v_cvt_pk_bf16_f32 v62, v72, v73
  v_cvt_pk_bf16_f32 v63, v74, v75
  s_nop 1
  v_mfma_f32_16x16x32_bf16 v[84:87], v[12:15], v[60:63], v[84:87]
  v_smfmac_f32_16x16x64_bf16 v[88:91], v[60:63], v[16:23], v118
  v_smfmac_f32_16x16x64_bf16 v[92:95], v[60:63], v[52:59], v118
  s_nop 1
  v_permlane32_swap_b32 v84, v86
  v_permlane32_swap_b32 v85, v87
  s_nop 0
  v_add_f32 v88, v88, v89
  v_add_f32_dpp v84, v86, v84 quad_perm:[1,0,3,2] row_mask:0xf bank_mask:0xf
  v_add_f32_dpp v85, v87, v85 quad_perm:[1,0,3,2] row_mask:0xf bank_mask:0xf
  v_add_f32 v89, v90, v91
  ds_write2_b32 v113, v84, v85 offset0:0 offset1:4
  ds_write2_b32 v112, v88, v89 offset0:0 offset1:128
  v_add_f32 v90, v92, v93
  v_add_f32 v91, v94, v95
  ds_write2_b32 v112, v90, v91 offset0:64 offset1:192
  v_cmp_u_f32 vcc, v88, v89
  s_cbranch_vccnz cA_sc1_retry
cA_sc1_cont:
  s_waitcnt lgkmcnt(0)
  s_barrier
  ds_read_b128 v[36:39], v114
  ds_read_b128 v[44:47], v115
  s_waitcnt lgkmcnt(0)
  v_add_f32 v36, v36, v38
  v_add_f32 v37, v37, v39
  v_add_f32 v44, v44, v45
  v_add_f32 v46, v46, v47
  v_add_f32 v44, v44, v46
  v_add_f32 v36, v36, v37
  v_exp_f32 v49, v44
  v_exp_f32 v48, v36
  v_add_f32 v50, abs(v36), abs(v44)
  v_fma_f32 v39, v49, s37, v48
  v_cmp_ngt_f32 vcc, s56, v50
  v_cndmask_b32 v41, v48, v49, s[38:39]
  v_add_f32_dpp v39, v39, v39 quad_perm:[1,0,3,2] row_mask:0xf bank_mask:0xf
  v_cndmask_b32 v40, v49, v48, s[38:39]
  v_mov_b32_dpp v46, v41 quad_perm:[1,0,3,2] row_mask:0xf bank_mask:0xf
  v_add_f32_dpp v39, v39, v39 quad_perm:[2,3,0,1] row_mask:0xf bank_mask:0xf
  v_cndmask_b32 v42, v46, v40, s[38:39]
  v_cndmask_b32 v43, v40, v46, s[38:39]
  v_add_f32_dpp v39, v39, v39 row_half_mirror row_mask:0xf bank_mask:0xf
  s_cbranch_vccnz cA_sc1_slow
  s_nop 0
  v_add_f32_dpp v47, v39, v39 row_mirror row_mask:0xf bank_mask:0xf
  v_add_f32_dpp v39, v39, v39 row_mirror row_mask:0xf bank_mask:0xf
  s_nop 1
  v_permlane16_swap_b32 v39, v47
  v_add_f32 v39, v39, v47
  v_rcp_f32 v39, v39
  s_mov_b64 exec, s[28:29]
  v_mul_f32 v42, v42, v39
  v_mul_f32 v43, v43, v39
  v_cvt_pk_bf16_f32 v42, v42, v43
cA_sc1_pst:
  buffer_store_dword v42, v1, s[8:11], s20 offen
  s_mov_b64 exec, -1
  s_barrier
  s_add_u32 s24, s24, 28672
  s_add_u32 s35, s35, 28672
  s_xor_b32 s25, s25, 28672
  s_add_u32 m0, s25, 7168
  s_add_u32 m0, s25, 11264
  s_add_u32 s22, s24, 4096
  buffer_load_dwordx4 v2, s[8:11], s22 offen offset:0 sc1 lds
  v_mov_b32 v48, 0
  v_mov_b32 v49, 0
  v_mov_b32 v50, 0
  v_mov_b32 v51, 0
  v_mov_b32 v52, 0
  v_mov_b32 v53, 0
  buffer_load_dwordx4 v2, s[8:11], s22 offen offset:1024 sc1 lds
  v_mov_b32 v54, 0
  v_mov_b32 v55, 0
  v_mov_b32 v56, 0
  v_mov_b32 v57, 0
  v_mov_b32 v58, 0
  v_mov_b32 v59, 0
  buffer_load_dwordx4 v2, s[8:11], s22 offen offset:2048 sc1 lds
  v_mov_b32 v60, 0
  v_mov_b32 v61, 0
  v_mov_b32 v62, 0
  v_mov_b32 v63, 0
  v_mov_b32 v88, 0
  v_mov_b32 v89, 0
  v_mov_b32 v90, 0
  v_mov_b32 v91, 0
  v_mov_b32 v92, 0
  v_mov_b32 v93, 0
  v_mov_b32 v94, 0
  v_mov_b32 v95, 0
  v_mov_b32 v64, 0
  v_mov_b32 v65, 0
  v_xor_b32 v116, 28672, v116
  v_add_u32 v117, s57, v117
  s_sub_u32 s57, 0, s57
  s_add_u32 s19, s19, 1
  s_mov_b32 s20, s21
  s_cmp_lt_u32 s19, 63
  s_cbranch_scc1 cA_sc1_loop
  s_branch cA_done
cA_sc1_slow:
  v_max_f32 v50, v36, v44
  s_nop 1
  v_max_f32_dpp v50, v50, v50 quad_perm:[1,0,3,2] row_mask:0xf bank_mask:0xf
  s_nop 1
  v_max_f32_dpp v50, v50, v50 quad_perm:[2,3,0,1] row_mask:0xf bank_mask:0xf
  s_nop 1
  v_max_f32_dpp v50, v50, v50 row_half_mirror row_mask:0xf bank_mask:0xf
  s_nop 1
  v_max_f32_dpp v50, v50, v50 row_mirror row_mask:0xf bank_mask:0xf
  v_mov_b32 v47, v50
  s_nop 1
  v_permlane16_swap_b32 v50, v47
  v_max_f32 v50, v50, v47
  v_sub_f32 v48, v36, v50
  v_sub_f32 v49, v44, v50
  v_exp_f32 v48, v48
  v_exp_f32 v49, v49
  s_add_u32 s31, s31, 0x100
  v_fma_f32 v39, v49, s37, v48
  v_cndmask_b32 v41, v48, v49, s[38:39]
  s_nop 0
  v_add_f32_dpp v39, v39, v39 quad_perm:[1,0,3,2] row_mask:0xf bank_mask:0xf
  v_cndmask_b32 v40, v49, v48, s[38:39]
  v_mov_b32_dpp v46, v41 quad_perm:[1,0,3,2] row_mask:0xf bank_mask:0xf
  v_add_f32_dpp v39, v39, v39 quad_perm:[2,3,0,1] row_mask:0xf bank_mask:0xf
  v_cndmask_b32 v42, v46, v40, s[38:39]
  v_cndmask_b32 v43, v40, v46, s[38:39]
  v_add_f32_dpp v39, v39, v39 row_half_mirror row_mask:0xf bank_mask:0xf
  s_nop 1
  v_add_f32_dpp v47, v39, v39 row_mirror row_mask:0xf bank_mask:0xf
  v_add_f32_dpp v39, v39, v39 row_mirror row_mask:0xf bank_mask:0xf
  s_nop 1
  v_permlane16_swap_b32 v39, v47
  v_add_f32 v39, v39, v47
  v_rcp_f32 v39, v39
  s_mov_b64 exec, s[28:29]
  v_mul_f32 v42, v42, v39
  v_mul_f32 v43, v43, v39
  v_cvt_pk_bf16_f32 v42, v42, v43
  v_min_u32 v42, -2, v42
  s_branch cA_sc1_pst
cA_sc1_retry:
  s_cmp_lg_u32 s62, 0
  s_cbranch_scc1 cA_sc1_cont
  s_waitcnt vmcnt(0) lgkmcnt(0)
cA_sc1_rv:
  buffer_load_dwordx4 v[8:11], v2, s[8:11], s20 offen offset:0 sc1
  buffer_load_dwordx4 v[12:15], v2, s[8:11], s20 offen offset:1024 sc1
  buffer_load_dwordx4 v[16:19], v2, s[8:11], s20 offen offset:2048 sc1
  buffer_load_dwordx4 v[20:23], v2, s[8:11], s20 offen offset:3072 sc1
  buffer_load_dwordx4 v[24:27], v2, s[8:11], s23 offen offset:0 sc1
  buffer_load_dwordx4 v[28:31], v2, s[8:11], s23 offen offset:1024 sc1
  buffer_load_dwordx4 v[32:35], v2, s[8:11], s23 offen offset:2048 sc1
  s_waitcnt vmcnt(0)
  v_max3_u32 v68, v8, v9, v10
  v_max3_u32 v68, v68, v11, v12
  v_max3_u32 v68, v68, v13, v14
  v_max3_u32 v68, v68, v15, v16
  v_max3_u32 v68, v68, v17, v18
  v_max3_u32 v68, v68, v19, v20
  v_max3_u32 v68, v68, v21, v22
  v_max3_u32 v68, v68, v23, v24
  v_max3_u32 v68, v68, v25, v26
  v_max3_u32 v68, v68, v27, v28
  v_max3_u32 v68, v68, v29, v30
  v_max3_u32 v68, v68, v31, v32
  v_max3_u32 v68, v68, v33, v34
  v_max_u32 v68, v68, v35
  v_cmp_eq_u32 vcc, -1, v68
  s_cbranch_vccz cA_sc1_rk
  s_add_u32 s30, s30, 1
  s_cmp_lt_u32 s30, 400000
  s_cbranch_scc1 cA_sc1_rv
  s_branch cA_abort
cA_sc1_rk:
  s_mov_b32 s62, 1
  v_mov_b32 v36, 0
  v_mov_b32 v37, 0
  v_mov_b32 v38, 0
  v_mov_b32 v39, 0
  v_mov_b32 v40, 0
  v_mov_b32 v41, 0
  v_mov_b32 v42, 0
  v_mov_b32 v43, 0
  v_mov_b32 v44, 0
  v_mov_b32 v45, 0
  v_mov_b32 v46, 0
  v_mov_b32 v47, 0
  v_mov_b32 v48, 0
  v_mov_b32 v49, 0
  v_mov_b32 v50, 0
  v_mov_b32 v51, 0
  v_mov_b32 v52, 0
  v_mov_b32 v53, 0
  v_mov_b32 v54, 0
  v_mov_b32 v55, 0
  v_mov_b32 v56, 0
  v_mov_b32 v57, 0
  v_mov_b32 v58, 0
  v_mov_b32 v59, 0
  v_mov_b32 v60, 0
  v_mov_b32 v61, 0
  v_mov_b32 v62, 0
  v_mov_b32 v63, 0
  v_mov_b32 v88, 0
  v_mov_b32 v89, 0
  v_mov_b32 v90, 0
  v_mov_b32 v91, 0
  v_mov_b32 v92, 0
  v_mov_b32 v93, 0
  v_mov_b32 v94, 0
  v_mov_b32 v95, 0
  v_mov_b32 v64, 0
  v_mov_b32 v65, 0
  s_add_u32 s31, s31, 1
  ds_read_b128 v[96:99], v117 offset:0
  ds_read_b128 v[100:103], v117 offset:1024
  ds_read_b128 v[104:107], v117 offset:14336
  ds_read_b128 v[108:111], v117 offset:15360
  v_smfmac_f32_16x16x64_bf16 v[36:39], v[8:11], a[0:7], v3
  v_smfmac_f32_16x16x64_bf16 v[40:43], v[8:11], a[56:63], v3
  v_smfmac_f32_16x16x64_bf16 v[44:47], v[8:11], a[112:119], v3
  v_smfmac_f32_16x16x64_bf16 v[48:51], v[8:11], a[168:175], v3
  v_smfmac_f32_16x16x64_bf16 v[52:55], v[8:11], a[224:231], v3
  v_smfmac_f32_16x16x64_bf16 v[56:59], v[8:11], v[144:151], v3
  v_smfmac_f32_16x16x64_bf16 v[60:63], v[8:11], v[200:207], v3
  v_smfmac_f32_16x16x64_bf16 v[36:39], v[12:15], a[8:15], v3
  v_smfmac_f32_16x16x64_bf16 v[40:43], v[12:15], a[64:71], v3
  v_smfmac_f32_16x16x64_bf16 v[44:47], v[12:15], a[120:127], v3
  v_smfmac_f32_16x16x64_bf16 v[48:51], v[12:15], a[176:183], v3
  v_smfmac_f32_16x16x64_bf16 v[52:55], v[12:15], a[232:239], v3
  v_smfmac_f32_16x16x64_bf16 v[56:59], v[12:15], v[152:159], v3
  v_smfmac_f32_16x16x64_bf16 v[60:63], v[12:15], v[208:215], v3
  v_smfmac_f32_16x16x64_bf16 v[36:39], v[16:19], a[16:23], v3
  v_smfmac_f32_16x16x64_bf16 v[40:43], v[16:19], a[72:79], v3
  v_smfmac_f32_16x16x64_bf16 v[44:47], v[16:19], a[128:135], v3
  v_smfmac_f32_16x16x64_bf16 v[48:51], v[16:19], a[184:191], v3
  v_smfmac_f32_16x16x64_bf16 v[52:55], v[16:19], a[240:247], v3
  v_smfmac_f32_16x16x64_bf16 v[56:59], v[16:19], v[160:167], v3
  v_smfmac_f32_16x16x64_bf16 v[60:63], v[16:19], v[216:223], v3
  v_smfmac_f32_16x16x64_bf16 v[36:39], v[20:23], a[24:31], v3
  v_smfmac_f32_16x16x64_bf16 v[40:43], v[20:23], a[80:87], v3
  v_smfmac_f32_16x16x64_bf16 v[44:47], v[20:23], a[136:143], v3
  v_smfmac_f32_16x16x64_bf16 v[48:51], v[20:23], a[192:199], v3
  v_smfmac_f32_16x16x64_bf16 v[52:55], v[20:23], a[248:255], v3
  v_smfmac_f32_16x16x64_bf16 v[56:59], v[20:23], v[168:175], v3
  v_smfmac_f32_16x16x64_bf16 v[60:63], v[20:23], v[224:231], v3
  s_xor_b32 s58, s25, 28672
  s_add_u32 s59, s24, 28672
  s_add_u32 m0, s58, 7168
  s_branch cA_sc1_ph2
.p2align 6

cA_sc2_loop:
  s_add_u32 s23, s20, 4096
  s_add_u32 s21, s20, 20480
  s_mov_b32 s30, 0
  s_mov_b32 s62, 0
  s_waitcnt vmcnt(0)
  s_barrier
cA_sc2_ld:
  buffer_load_dwordx4 v[8:11], v2, s[8:11], s20 offen offset:0
  v_mov_b32 v36, 0
  v_mov_b32 v37, 0
  v_mov_b32 v38, 0
  v_mov_b32 v39, 0
  buffer_load_dwordx4 v[12:15], v2, s[8:11], s20 offen offset:1024
  v_mov_b32 v40, 0
  v_mov_b32 v41, 0
  v_mov_b32 v42, 0
  v_mov_b32 v43, 0
  buffer_load_dwordx4 v[16:19], v2, s[8:11], s20 offen offset:2048
  v_mov_b32 v44, 0
  v_mov_b32 v45, 0
  v_mov_b32 v46, 0
  v_mov_b32 v47, 0
  ds_read_b128 v[96:99], v117 offset:0
  ds_read_b128 v[100:103], v117 offset:1024
  ds_read_b128 v[104:107], v117 offset:14336
  ds_read_b128 v[108:111], v117 offset:15360
  s_waitcnt vmcnt(2)
  v_smfmac_f32_16x16x64_bf16 v[36:39], v[8:11], a[0:7], v3
  v_smfmac_f32_16x16x64_bf16 v[40:43], v[8:11], a[56:63], v3
  buffer_load_dwordx4 v[20:23], v2, s[8:11], s20 offen offset:3072
  v_smfmac_f32_16x16x64_bf16 v[44:47], v[8:11], a[112:119], v3
  v_smfmac_f32_16x16x64_bf16 v[48:51], v[8:11], a[168:175], v3
  v_smfmac_f32_16x16x64_bf16 v[52:55], v[8:11], a[224:231], v3
  buffer_load_dwordx4 v[24:27], v2, s[8:11], s23 offen offset:0
  v_smfmac_f32_16x16x64_bf16 v[56:59], v[8:11], v[144:151], v3
  v_smfmac_f32_16x16x64_bf16 v[60:63], v[8:11], v[200:207], v3
  s_waitcnt vmcnt(3)
  v_smfmac_f32_16x16x64_bf16 v[36:39], v[12:15], a[8:15], v3
  v_smfmac_f32_16x16x64_bf16 v[40:43], v[12:15], a[64:71], v3
  buffer_load_dwordx4 v[28:31], v2, s[8:11], s23 offen offset:1024
  v_smfmac_f32_16x16x64_bf16 v[44:47], v[12:15], a[120:127], v3
  v_smfmac_f32_16x16x64_bf16 v[48:51], v[12:15], a[176:183], v3
  v_smfmac_f32_16x16x64_bf16 v[52:55], v[12:15], a[232:239], v3
  buffer_load_dwordx4 v[32:35], v2, s[8:11], s23 offen offset:2048
  v_smfmac_f32_16x16x64_bf16 v[56:59], v[12:15], v[152:159], v3
  v_smfmac_f32_16x16x64_bf16 v[60:63], v[12:15], v[208:215], v3
  s_waitcnt vmcnt(4)
  v_smfmac_f32_16x16x64_bf16 v[36:39], v[16:19], a[16:23], v3
  v_smfmac_f32_16x16x64_bf16 v[40:43], v[16:19], a[72:79], v3
  s_xor_b32 s58, s25, 28672
  s_add_u32 s59, s24, 28672
  s_add_u32 m0, s58, 14336
  v_smfmac_f32_16x16x64_bf16 v[44:47], v[16:19], a[128:135], v3
  buffer_load_dwordx4 v2, s[8:11], s59 offen offset:0 sc1 lds
  v_smfmac_f32_16x16x64_bf16 v[48:51], v[16:19], a[184:191], v3
  v_smfmac_f32_16x16x64_bf16 v[52:55], v[16:19], a[240:247], v3
  v_smfmac_f32_16x16x64_bf16 v[56:59], v[16:19], v[160:167], v3
  v_smfmac_f32_16x16x64_bf16 v[60:63], v[16:19], v[216:223], v3
  buffer_load_dwordx4 v2, s[8:11], s59 offen offset:1024 sc1 lds
  s_waitcnt vmcnt(5)
  v_smfmac_f32_16x16x64_bf16 v[36:39], v[20:23], a[24:31], v3
  v_smfmac_f32_16x16x64_bf16 v[40:43], v[20:23], a[80:87], v3
  v_smfmac_f32_16x16x64_bf16 v[44:47], v[20:23], a[136:143], v3
  v_smfmac_f32_16x16x64_bf16 v[48:51], v[20:23], a[192:199], v3
  buffer_load_dwordx4 v2, s[8:11], s59 offen offset:2048 sc1 lds
  v_smfmac_f32_16x16x64_bf16 v[52:55], v[20:23], a[248:255], v3
  v_smfmac_f32_16x16x64_bf16 v[56:59], v[20:23], v[168:175], v3
  v_smfmac_f32_16x16x64_bf16 v[60:63], v[20:23], v[224:231], v3
  s_waitcnt vmcnt(3)
cA_sc2_ph2:
  v_smfmac_f32_16x16x64_bf16 v[60:63], v[24:27], v[232:239], v3
  buffer_load_dwordx4 v2, s[8:11], s59 offen offset:3072 sc1 lds
  ds_read_b128 v[8:11], v116 offset:4096
  ds_read_b128 v[12:15], v116 offset:5120
  v_smfmac_f32_16x16x64_bf16 v[60:63], v[28:31], v[240:247], v3
  buffer_load_dword v119, v0, s[8:11], s24 offen sc1
  v_smfmac_f32_16x16x64_bf16 v[60:63], v[32:35], v[248:255], v3
  v_mov_b32 v80, v28
  v_smfmac_f32_16x16x64_bf16 v[52:55], v[24:27], v[120:127], v3
  v_mov_b32 v81, v29
  v_smfmac_f32_16x16x64_bf16 v[52:55], v[28:31], v[128:135], v3
  v_mov_b32 v82, v34
  v_smfmac_f32_16x16x64_bf16 v[52:55], v[32:35], v[136:143], v3
  v_cvt_pk_bf16_f32 v64, v60, v61
  v_smfmac_f32_16x16x64_bf16 v[56:59], v[24:27], v[176:183], v3
  v_cvt_pk_bf16_f32 v65, v62, v63
  v_smfmac_f32_16x16x64_bf16 v[56:59], v[28:31], v[184:191], v3
  v_mov_b32 v83, v35
  v_mfma_f32_16x16x32_bf16 v[68:71], v[64:67], v[4:7], 0
  v_smfmac_f32_16x16x64_bf16 v[56:59], v[32:35], v[192:199], v3
  v_cvt_pk_bf16_f32 v64, v52, v53
  v_smfmac_f32_16x16x64_bf16 v[36:39], v[24:27], a[32:39], v3
  v_cvt_pk_bf16_f32 v65, v54, v55
  v_smfmac_f32_16x16x64_bf16 v[36:39], v[28:31], a[40:47], v3
  v_cvt_pk_bf16_f32 v78, v68, v69
  v_smfmac_f32_16x16x64_bf16 v[36:39], v[32:35], a[48:55], v3
  v_cvt_pk_bf16_f32 v79, v70, v71
  v_cvt_pk_bf16_f32 v66, v56, v57
  v_smfmac_f32_16x16x64_bf16 v[40:43], v[24:27], a[88:95], v3
  v_cvt_pk_bf16_f32 v67, v58, v59
  v_smfmac_f32_16x16x64_bf16 v[40:43], v[28:31], a[96:103], v3
  v_mfma_f32_16x16x32_bf16 v[72:75], v[64:67], v[4:7], 0
  ds_read_b128 v[52:55], v116 offset:18432
  ds_read_b128 v[56:59], v116 offset:19456
  v_smfmac_f32_16x16x64_bf16 v[40:43], v[32:35], a[104:111], v3
  v_cvt_pk_bf16_f32 v64, v36, v37
  v_smfmac_f32_16x16x64_bf16 v[44:47], v[24:27], a[144:151], v3
  v_cvt_pk_bf16_f32 v65, v38, v39
  v_smfmac_f32_16x16x64_bf16 v[44:47], v[28:31], a[152:159], v3
  v_cvt_pk_bf16_f32 v76, v72, v73
  v_smfmac_f32_16x16x64_bf16 v[44:47], v[32:35], a[160:167], v3
  v_cvt_pk_bf16_f32 v77, v74, v75
  v_cvt_pk_bf16_f32 v66, v40, v41
  v_smfmac_f32_16x16x64_bf16 v[48:51], v[24:27], a[200:207], v3
  v_cvt_pk_bf16_f32 v67, v42, v43
  v_smfmac_f32_16x16x64_bf16 v[48:51], v[28:31], a[208:215], v3
  v_mfma_f32_16x16x32_bf16 v[68:71], v[64:67], v[4:7], 0
  v_smfmac_f32_16x16x64_bf16 v[48:51], v[32:35], a[216:223], v3
  v_cvt_pk_bf16_f32 v64, v44, v45
  v_mfma_f32_16x16x32_bf16 v[84:87], v[80:83], v[76:79], 0
  v_cvt_pk_bf16_f32 v65, v46, v47
  s_waitcnt lgkmcnt(0)
  v_smfmac_f32_16x16x64_bf16 v[88:91], v[76:79], v[96:103], v118
  v_cvt_pk_bf16_f32 v60, v68, v69
  v_cvt_pk_bf16_f32 v61, v70, v71
  v_cvt_pk_bf16_f32 v66, v48, v49
  v_cvt_pk_bf16_f32 v67, v50, v51
  s_nop 1
  v_mfma_f32_16x16x32_bf16 v[72:75], v[64:67], v[4:7], 0
  v_smfmac_f32_16x16x64_bf16 v[92:95], v[76:79], v[104:111], v118
  s_nop 4
  v_cvt_pk_bf16_f32 v62, v72, v73
  v_cvt_pk_bf16_f32 v63, v74, v75
  s_nop 1
  v_mfma_f32_16x16x32_bf16 v[84:87], v[16:19], v[60:63], v[84:87]
  v_smfmac_f32_16x16x64_bf16 v[88:91], v[60:63], v[8:15], v118
  v_smfmac_f32_16x16x64_bf16 v[92:95], v[60:63], v[52:59], v118
  s_nop 1
  v_permlane32_swap_b32 v84, v86
  v_permlane32_swap_b32 v85, v87
  s_nop 0
  v_add_f32 v88, v88, v89
  v_add_f32_dpp v84, v86, v84 quad_perm:[1,0,3,2] row_mask:0xf bank_mask:0xf
  v_add_f32_dpp v85, v87, v85 quad_perm:[1,0,3,2] row_mask:0xf bank_mask:0xf
  v_add_f32 v89, v90, v91
  ds_write2_b32 v113, v84, v85 offset0:0 offset1:4
  ds_write2_b32 v112, v88, v89 offset0:0 offset1:128
  v_add_f32 v90, v92, v93
  v_add_f32 v91, v94, v95
  ds_write2_b32 v112, v90, v91 offset0:64 offset1:192
  v_cmp_u_f32 vcc, v88, v89
  s_cbranch_vccnz cA_sc2_retry
cA_sc2_cont:
  s_waitcnt lgkmcnt(0)
  s_barrier
  ds_read_b128 v[36:39], v114
  ds_read_b128 v[44:47], v115
  s_waitcnt lgkmcnt(0)
  v_add_f32 v36, v36, v38
  v_add_f32 v37, v37, v39
  v_add_f32 v44, v44, v45
  v_add_f32 v46, v46, v47
  v_add_f32 v44, v44, v46
  v_add_f32 v36, v36, v37
  v_exp_f32 v49, v44
  v_exp_f32 v48, v36
  v_add_f32 v50, abs(v36), abs(v44)
  v_fma_f32 v39, v49, s37, v48
  v_cmp_ngt_f32 vcc, s56, v50
  v_cndmask_b32 v41, v48, v49, s[38:39]
  v_add_f32_dpp v39, v39, v39 quad_perm:[1,0,3,2] row_mask:0xf bank_mask:0xf
  v_cndmask_b32 v40, v49, v48, s[38:39]
  v_mov_b32_dpp v46, v41 quad_perm:[1,0,3,2] row_mask:0xf bank_mask:0xf
  v_add_f32_dpp v39, v39, v39 quad_perm:[2,3,0,1] row_mask:0xf bank_mask:0xf
  v_cndmask_b32 v42, v46, v40, s[38:39]
  v_cndmask_b32 v43, v40, v46, s[38:39]
  v_add_f32_dpp v39, v39, v39 row_half_mirror row_mask:0xf bank_mask:0xf
  s_cbranch_vccnz cA_sc2_slow
  s_nop 0
  v_add_f32_dpp v47, v39, v39 row_mirror row_mask:0xf bank_mask:0xf
  v_add_f32_dpp v39, v39, v39 row_mirror row_mask:0xf bank_mask:0xf
  s_nop 1
  v_permlane16_swap_b32 v39, v47
  v_add_f32 v39, v39, v47
  v_rcp_f32 v39, v39
  s_mov_b64 exec, s[28:29]
  v_mul_f32 v42, v42, v39
  v_mul_f32 v43, v43, v39
  v_cvt_pk_bf16_f32 v42, v42, v43
cA_sc2_pst:
  buffer_store_dword v42, v1, s[8:11], s20 offen
  s_mov_b64 exec, -1
  s_barrier
  s_add_u32 s24, s24, 28672
  s_add_u32 s35, s35, 28672
  s_xor_b32 s25, s25, 28672
  s_add_u32 m0, s25, 14336
  s_add_u32 m0, s25, 18432
  s_add_u32 s22, s24, 4096
  buffer_load_dwordx4 v2, s[8:11], s22 offen offset:0 sc1 lds
  v_mov_b32 v48, 0
  v_mov_b32 v49, 0
  v_mov_b32 v50, 0
  v_mov_b32 v51, 0
  v_mov_b32 v52, 0
  v_mov_b32 v53, 0
  buffer_load_dwordx4 v2, s[8:11], s22 offen offset:1024 sc1 lds
  v_mov_b32 v54, 0
  v_mov_b32 v55, 0
  v_mov_b32 v56, 0
  v_mov_b32 v57, 0
  v_mov_b32 v58, 0
  v_mov_b32 v59, 0
  buffer_load_dwordx4 v2, s[8:11], s22 offen offset:2048 sc1 lds
  v_mov_b32 v60, 0
  v_mov_b32 v61, 0
  v_mov_b32 v62, 0
  v_mov_b32 v63, 0
  v_mov_b32 v88, 0
  v_mov_b32 v89, 0
  v_mov_b32 v90, 0
  v_mov_b32 v91, 0
  v_mov_b32 v92, 0
  v_mov_b32 v93, 0
  v_mov_b32 v94, 0
  v_mov_b32 v95, 0
  v_mov_b32 v66, 0
  v_mov_b32 v67, 0
  v_xor_b32 v116, 28672, v116
  v_add_u32 v117, s57, v117
  s_sub_u32 s57, 0, s57
  s_add_u32 s19, s19, 1
  s_mov_b32 s20, s21
  s_cmp_lt_u32 s19, 63
  s_cbranch_scc1 cA_sc2_loop
  s_branch cA_done
cA_sc2_slow:
  v_max_f32 v50, v36, v44
  s_nop 1
  v_max_f32_dpp v50, v50, v50 quad_perm:[1,0,3,2] row_mask:0xf bank_mask:0xf
  s_nop 1
  v_max_f32_dpp v50, v50, v50 quad_perm:[2,3,0,1] row_mask:0xf bank_mask:0xf
  s_nop 1
  v_max_f32_dpp v50, v50, v50 row_half_mirror row_mask:0xf bank_mask:0xf
  s_nop 1
  v_max_f32_dpp v50, v50, v50 row_mirror row_mask:0xf bank_mask:0xf
  v_mov_b32 v47, v50
  s_nop 1
  v_permlane16_swap_b32 v50, v47
  v_max_f32 v50, v50, v47
  v_sub_f32 v48, v36, v50
  v_sub_f32 v49, v44, v50
  v_exp_f32 v48, v48
  v_exp_f32 v49, v49
  s_add_u32 s31, s31, 0x100
  v_fma_f32 v39, v49, s37, v48
  v_cndmask_b32 v41, v48, v49, s[38:39]
  s_nop 0
  v_add_f32_dpp v39, v39, v39 quad_perm:[1,0,3,2] row_mask:0xf bank_mask:0xf
  v_cndmask_b32 v40, v49, v48, s[38:39]
  v_mov_b32_dpp v46, v41 quad_perm:[1,0,3,2] row_mask:0xf bank_mask:0xf
  v_add_f32_dpp v39, v39, v39 quad_perm:[2,3,0,1] row_mask:0xf bank_mask:0xf
  v_cndmask_b32 v42, v46, v40, s[38:39]
  v_cndmask_b32 v43, v40, v46, s[38:39]
  v_add_f32_dpp v39, v39, v39 row_half_mirror row_mask:0xf bank_mask:0xf
  s_nop 1
  v_add_f32_dpp v47, v39, v39 row_mirror row_mask:0xf bank_mask:0xf
  v_add_f32_dpp v39, v39, v39 row_mirror row_mask:0xf bank_mask:0xf
  s_nop 1
  v_permlane16_swap_b32 v39, v47
  v_add_f32 v39, v39, v47
  v_rcp_f32 v39, v39
  s_mov_b64 exec, s[28:29]
  v_mul_f32 v42, v42, v39
  v_mul_f32 v43, v43, v39
  v_cvt_pk_bf16_f32 v42, v42, v43
  v_min_u32 v42, -2, v42
  s_branch cA_sc2_pst
cA_sc2_retry:
  s_cmp_lg_u32 s62, 0
  s_cbranch_scc1 cA_sc2_cont
  s_waitcnt vmcnt(0) lgkmcnt(0)
cA_sc2_rv:
  buffer_load_dwordx4 v[8:11], v2, s[8:11], s20 offen offset:0 sc1
  buffer_load_dwordx4 v[12:15], v2, s[8:11], s20 offen offset:1024 sc1
  buffer_load_dwordx4 v[16:19], v2, s[8:11], s20 offen offset:2048 sc1
  buffer_load_dwordx4 v[20:23], v2, s[8:11], s20 offen offset:3072 sc1
  buffer_load_dwordx4 v[24:27], v2, s[8:11], s23 offen offset:0 sc1
  buffer_load_dwordx4 v[28:31], v2, s[8:11], s23 offen offset:1024 sc1
  buffer_load_dwordx4 v[32:35], v2, s[8:11], s23 offen offset:2048 sc1
  s_waitcnt vmcnt(0)
  v_max3_u32 v68, v8, v9, v10
  v_max3_u32 v68, v68, v11, v12
  v_max3_u32 v68, v68, v13, v14
  v_max3_u32 v68, v68, v15, v16
  v_max3_u32 v68, v68, v17, v18
  v_max3_u32 v68, v68, v19, v20
  v_max3_u32 v68, v68, v21, v22
  v_max3_u32 v68, v68, v23, v24
  v_max3_u32 v68, v68, v25, v26
  v_max3_u32 v68, v68, v27, v28
  v_max3_u32 v68, v68, v29, v30
  v_max3_u32 v68, v68, v31, v32
  v_max3_u32 v68, v68, v33, v34
  v_max_u32 v68, v68, v35
  v_cmp_eq_u32 vcc, -1, v68
  s_cbranch_vccz cA_sc2_rk
  s_add_u32 s30, s30, 1
  s_cmp_lt_u32 s30, 400000
  s_cbranch_scc1 cA_sc2_rv
  s_branch cA_abort
cA_sc2_rk:
  s_mov_b32 s62, 1
  v_mov_b32 v36, 0
  v_mov_b32 v37, 0
  v_mov_b32 v38, 0
  v_mov_b32 v39, 0
  v_mov_b32 v40, 0
  v_mov_b32 v41, 0
  v_mov_b32 v42, 0
  v_mov_b32 v43, 0
  v_mov_b32 v44, 0
  v_mov_b32 v45, 0
  v_mov_b32 v46, 0
  v_mov_b32 v47, 0
  v_mov_b32 v48, 0
  v_mov_b32 v49, 0
  v_mov_b32 v50, 0
  v_mov_b32 v51, 0
  v_mov_b32 v52, 0
  v_mov_b32 v53, 0
  v_mov_b32 v54, 0
  v_mov_b32 v55, 0
  v_mov_b32 v56, 0
  v_mov_b32 v57, 0
  v_mov_b32 v58, 0
  v_mov_b32 v59, 0
  v_mov_b32 v60, 0
  v_mov_b32 v61, 0
  v_mov_b32 v62, 0
  v_mov_b32 v63, 0
  v_mov_b32 v88, 0
  v_mov_b32 v89, 0
  v_mov_b32 v90, 0
  v_mov_b32 v91, 0
  v_mov_b32 v92, 0
  v_mov_b32 v93, 0
  v_mov_b32 v94, 0
  v_mov_b32 v95, 0
  v_mov_b32 v66, 0
  v_mov_b32 v67, 0
  s_add_u32 s31, s31, 1
  ds_read_b128 v[96:99], v117 offset:0
  ds_read_b128 v[100:103], v117 offset:1024
  ds_read_b128 v[104:107], v117 offset:14336
  ds_read_b128 v[108:111], v117 offset:15360
  v_smfmac_f32_16x16x64_bf16 v[36:39], v[8:11], a[0:7], v3
  v_smfmac_f32_16x16x64_bf16 v[40:43], v[8:11], a[56:63], v3
  v_smfmac_f32_16x16x64_bf16 v[44:47], v[8:11], a[112:119], v3
  v_smfmac_f32_16x16x64_bf16 v[48:51], v[8:11], a[168:175], v3
  v_smfmac_f32_16x16x64_bf16 v[52:55], v[8:11], a[224:231], v3
  v_smfmac_f32_16x16x64_bf16 v[56:59], v[8:11], v[144:151], v3
  v_smfmac_f32_16x16x64_bf16 v[60:63], v[8:11], v[200:207], v3
  v_smfmac_f32_16x16x64_bf16 v[36:39], v[12:15], a[8:15], v3
  v_smfmac_f32_16x16x64_bf16 v[40:43], v[12:15], a[64:71], v3
  v_smfmac_f32_16x16x64_bf16 v[44:47], v[12:15], a[120:127], v3
  v_smfmac_f32_16x16x64_bf16 v[48:51], v[12:15], a[176:183], v3
  v_smfmac_f32_16x16x64_bf16 v[52:55], v[12:15], a[232:239], v3
  v_smfmac_f32_16x16x64_bf16 v[56:59], v[12:15], v[152:159], v3
  v_smfmac_f32_16x16x64_bf16 v[60:63], v[12:15], v[208:215], v3
  v_smfmac_f32_16x16x64_bf16 v[36:39], v[16:19], a[16:23], v3
  v_smfmac_f32_16x16x64_bf16 v[40:43], v[16:19], a[72:79], v3
  v_smfmac_f32_16x16x64_bf16 v[44:47], v[16:19], a[128:135], v3
  v_smfmac_f32_16x16x64_bf16 v[48:51], v[16:19], a[184:191], v3
  v_smfmac_f32_16x16x64_bf16 v[52:55], v[16:19], a[240:247], v3
  v_smfmac_f32_16x16x64_bf16 v[56:59], v[16:19], v[160:167], v3
  v_smfmac_f32_16x16x64_bf16 v[60:63], v[16:19], v[216:223], v3
  v_smfmac_f32_16x16x64_bf16 v[36:39], v[20:23], a[24:31], v3
  v_smfmac_f32_16x16x64_bf16 v[40:43], v[20:23], a[80:87], v3
  v_smfmac_f32_16x16x64_bf16 v[44:47], v[20:23], a[136:143], v3
  v_smfmac_f32_16x16x64_bf16 v[48:51], v[20:23], a[192:199], v3
  v_smfmac_f32_16x16x64_bf16 v[52:55], v[20:23], a[248:255], v3
  v_smfmac_f32_16x16x64_bf16 v[56:59], v[20:23], v[168:175], v3
  v_smfmac_f32_16x16x64_bf16 v[60:63], v[20:23], v[224:231], v3
  s_xor_b32 s58, s25, 28672
  s_add_u32 s59, s24, 28672
  s_add_u32 m0, s58, 14336
  s_branch cA_sc2_ph2
.p2align 6

cA_sc3_loop:
  s_add_u32 s23, s20, 4096
  s_add_u32 s21, s20, 20480
  s_mov_b32 s30, 0
  s_mov_b32 s62, 0
  s_waitcnt vmcnt(0)
  s_barrier
cA_sc3_ld:
  buffer_load_dwordx4 v[8:11], v2, s[8:11], s20 offen offset:0
  v_mov_b32 v36, 0
  v_mov_b32 v37, 0
  v_mov_b32 v38, 0
  v_mov_b32 v39, 0
  buffer_load_dwordx4 v[12:15], v2, s[8:11], s20 offen offset:1024
  v_mov_b32 v40, 0
  v_mov_b32 v41, 0
  v_mov_b32 v42, 0
  v_mov_b32 v43, 0
  buffer_load_dwordx4 v[16:19], v2, s[8:11], s20 offen offset:2048
  v_mov_b32 v44, 0
  v_mov_b32 v45, 0
  v_mov_b32 v46, 0
  v_mov_b32 v47, 0
  ds_read_b128 v[96:99], v117 offset:0
  ds_read_b128 v[100:103], v117 offset:1024
  ds_read_b128 v[104:107], v117 offset:14336
  ds_read_b128 v[108:111], v117 offset:15360
  s_waitcnt vmcnt(2)
  v_smfmac_f32_16x16x64_bf16 v[36:39], v[8:11], a[0:7], v3
  v_smfmac_f32_16x16x64_bf16 v[40:43], v[8:11], a[56:63], v3
  buffer_load_dwordx4 v[20:23], v2, s[8:11], s20 offen offset:3072
  v_smfmac_f32_16x16x64_bf16 v[44:47], v[8:11], a[112:119], v3
  v_smfmac_f32_16x16x64_bf16 v[48:51], v[8:11], a[168:175], v3
  v_smfmac_f32_16x16x64_bf16 v[52:55], v[8:11], a[224:231], v3
  buffer_load_dwordx4 v[24:27], v2, s[8:11], s23 offen offset:0
  v_smfmac_f32_16x16x64_bf16 v[56:59], v[8:11], v[144:151], v3
  v_smfmac_f32_16x16x64_bf16 v[60:63], v[8:11], v[200:207], v3
  s_waitcnt vmcnt(3)
  v_smfmac_f32_16x16x64_bf16 v[36:39], v[12:15], a[8:15], v3
  v_smfmac_f32_16x16x64_bf16 v[40:43], v[12:15], a[64:71], v3
  buffer_load_dwordx4 v[28:31], v2, s[8:11], s23 offen offset:1024
  v_smfmac_f32_16x16x64_bf16 v[44:47], v[12:15], a[120:127], v3
  v_smfmac_f32_16x16x64_bf16 v[48:51], v[12:15], a[176:183], v3
  v_smfmac_f32_16x16x64_bf16 v[52:55], v[12:15], a[232:239], v3
  buffer_load_dwordx4 v[32:35], v2, s[8:11], s23 offen offset:2048
  v_smfmac_f32_16x16x64_bf16 v[56:59], v[12:15], v[152:159], v3
  v_smfmac_f32_16x16x64_bf16 v[60:63], v[12:15], v[208:215], v3
  s_waitcnt vmcnt(4)
  v_smfmac_f32_16x16x64_bf16 v[36:39], v[16:19], a[16:23], v3
  v_smfmac_f32_16x16x64_bf16 v[40:43], v[16:19], a[72:79], v3
  v_smfmac_f32_16x16x64_bf16 v[44:47], v[16:19], a[128:135], v3
  s_xor_b32 s58, s25, 28672
  s_add_u32 s59, s24, 28672
  s_add_u32 m0, s58, 21504
  v_smfmac_f32_16x16x64_bf16 v[48:51], v[16:19], a[184:191], v3
  buffer_load_dwordx4 v2, s[8:11], s59 offen offset:0 sc1 lds
  v_smfmac_f32_16x16x64_bf16 v[52:55], v[16:19], a[240:247], v3
  v_smfmac_f32_16x16x64_bf16 v[56:59], v[16:19], v[160:167], v3
  v_smfmac_f32_16x16x64_bf16 v[60:63], v[16:19], v[216:223], v3
  s_waitcnt vmcnt(4)
  v_smfmac_f32_16x16x64_bf16 v[36:39], v[20:23], a[24:31], v3
  buffer_load_dwordx4 v2, s[8:11], s59 offen offset:1024 sc1 lds
  v_smfmac_f32_16x16x64_bf16 v[40:43], v[20:23], a[80:87], v3
  v_smfmac_f32_16x16x64_bf16 v[44:47], v[20:23], a[136:143], v3
  v_smfmac_f32_16x16x64_bf16 v[48:51], v[20:23], a[192:199], v3
  v_smfmac_f32_16x16x64_bf16 v[52:55], v[20:23], a[248:255], v3
  buffer_load_dwordx4 v2, s[8:11], s59 offen offset:2048 sc1 lds
  v_smfmac_f32_16x16x64_bf16 v[56:59], v[20:23], v[168:175], v3
  v_smfmac_f32_16x16x64_bf16 v[60:63], v[20:23], v[224:231], v3
  s_waitcnt vmcnt(3)
cA_sc3_ph2:
  v_smfmac_f32_16x16x64_bf16 v[60:63], v[24:27], v[232:239], v3
  ds_read_b128 v[8:11], v116 offset:6144
  ds_read_b128 v[12:15], v116 offset:7168
  v_smfmac_f32_16x16x64_bf16 v[60:63], v[28:31], v[240:247], v3
  buffer_load_dwordx4 v2, s[8:11], s59 offen offset:3072 sc1 lds
  v_smfmac_f32_16x16x64_bf16 v[60:63], v[32:35], v[248:255], v3
  v_mov_b32 v80, v30
  v_smfmac_f32_16x16x64_bf16 v[52:55], v[24:27], v[120:127], v3
  v_mov_b32 v81, v31
  v_smfmac_f32_16x16x64_bf16 v[52:55], v[28:31], v[128:135], v3
  v_mov_b32 v82, v34
  v_smfmac_f32_16x16x64_bf16 v[52:55], v[32:35], v[136:143], v3
  v_cvt_pk_bf16_f32 v66, v60, v61
  v_smfmac_f32_16x16x64_bf16 v[56:59], v[24:27], v[176:183], v3
  v_cvt_pk_bf16_f32 v67, v62, v63
  v_smfmac_f32_16x16x64_bf16 v[56:59], v[28:31], v[184:191], v3
  v_mov_b32 v83, v35
  v_mfma_f32_16x16x32_bf16 v[68:71], v[64:67], v[4:7], 0
  v_smfmac_f32_16x16x64_bf16 v[56:59], v[32:35], v[192:199], v3
  v_cvt_pk_bf16_f32 v64, v52, v53
  v_smfmac_f32_16x16x64_bf16 v[36:39], v[24:27], a[32:39], v3
  v_cvt_pk_bf16_f32 v65, v54, v55
  v_smfmac_f32_16x16x64_bf16 v[36:39], v[28:31], a[40:47], v3
  v_cvt_pk_bf16_f32 v78, v68, v69
  v_smfmac_f32_16x16x64_bf16 v[36:39], v[32:35], a[48:55], v3
  v_cvt_pk_bf16_f32 v79, v70, v71
  v_cvt_pk_bf16_f32 v66, v56, v57
  v_smfmac_f32_16x16x64_bf16 v[40:43], v[24:27], a[88:95], v3
  v_cvt_pk_bf16_f32 v67, v58, v59
  v_smfmac_f32_16x16x64_bf16 v[40:43], v[28:31], a[96:103], v3
  v_mfma_f32_16x16x32_bf16 v[72:75], v[64:67], v[4:7], 0
  ds_read_b128 v[52:55], v116 offset:20480
  ds_read_b128 v[56:59], v116 offset:21504
  v_smfmac_f32_16x16x64_bf16 v[40:43], v[32:35], a[104:111], v3
  v_cvt_pk_bf16_f32 v64, v36, v37
  v_smfmac_f32_16x16x64_bf16 v[44:47], v[24:27], a[144:151], v3
  v_cvt_pk_bf16_f32 v65, v38, v39
  v_smfmac_f32_16x16x64_bf16 v[44:47], v[28:31], a[152:159], v3
  v_cvt_pk_bf16_f32 v76, v72, v73
  v_smfmac_f32_16x16x64_bf16 v[44:47], v[32:35], a[160:167], v3
  v_cvt_pk_bf16_f32 v77, v74, v75
  v_cvt_pk_bf16_f32 v66, v40, v41
  v_smfmac_f32_16x16x64_bf16 v[48:51], v[24:27], a[200:207], v3
  v_cvt_pk_bf16_f32 v67, v42, v43
  v_smfmac_f32_16x16x64_bf16 v[48:51], v[28:31], a[208:215], v3
  v_mfma_f32_16x16x32_bf16 v[68:71], v[64:67], v[4:7], 0
  v_smfmac_f32_16x16x64_bf16 v[48:51], v[32:35], a[216:223], v3
  v_cvt_pk_bf16_f32 v64, v44, v45
  v_mfma_f32_16x16x32_bf16 v[84:87], v[80:83], v[76:79], 0
  v_cvt_pk_bf16_f32 v65, v46, v47
  s_waitcnt lgkmcnt(0)
  v_smfmac_f32_16x16x64_bf16 v[88:91], v[76:79], v[96:103], v118
  v_cvt_pk_bf16_f32 v60, v68, v69
  v_cvt_pk_bf16_f32 v61, v70, v71
  v_cvt_pk_bf16_f32 v66, v48, v49
  v_cvt_pk_bf16_f32 v67, v50, v51
  s_nop 1
  v_mfma_f32_16x16x32_bf16 v[72:75], v[64:67], v[4:7], 0
  v_smfmac_f32_16x16x64_bf16 v[92:95], v[76:79], v[104:111], v118
  s_nop 4
  v_cvt_pk_bf16_f32 v62, v72, v73
  v_cvt_pk_bf16_f32 v63, v74, v75
  s_nop 1
  v_mfma_f32_16x16x32_bf16 v[84:87], v[20:23], v[60:63], v[84:87]
  v_smfmac_f32_16x16x64_bf16 v[88:91], v[60:63], v[8:15], v118
  v_smfmac_f32_16x16x64_bf16 v[92:95], v[60:63], v[52:59], v118
  s_nop 1
  v_permlane32_swap_b32 v84, v86
  v_permlane32_swap_b32 v85, v87
  s_nop 0
  v_add_f32 v88, v88, v89
  v_add_f32_dpp v84, v86, v84 quad_perm:[1,0,3,2] row_mask:0xf bank_mask:0xf
  v_add_f32_dpp v85, v87, v85 quad_perm:[1,0,3,2] row_mask:0xf bank_mask:0xf
  v_add_f32 v89, v90, v91
  ds_write2_b32 v113, v84, v85 offset0:0 offset1:4
  ds_write2_b32 v112, v88, v89 offset0:0 offset1:128
  v_add_f32 v90, v92, v93
  v_add_f32 v91, v94, v95
  ds_write2_b32 v112, v90, v91 offset0:64 offset1:192
  v_cmp_u_f32 vcc, v88, v89
  s_cbranch_vccnz cA_sc3_retry
cA_sc3_cont:
  s_waitcnt lgkmcnt(0)
  s_barrier
  ds_read_b128 v[36:39], v114
  ds_read_b128 v[44:47], v115
  s_waitcnt lgkmcnt(0)
  v_add_f32 v36, v36, v38
  v_add_f32 v37, v37, v39
  v_add_f32 v44, v44, v45
  v_add_f32 v46, v46, v47
  v_add_f32 v44, v44, v46
  v_add_f32 v36, v36, v37
  v_exp_f32 v49, v44
  v_exp_f32 v48, v36
  v_add_f32 v50, abs(v36), abs(v44)
  v_fma_f32 v39, v49, s37, v48
  v_cmp_ngt_f32 vcc, s56, v50
  v_cndmask_b32 v41, v48, v49, s[38:39]
  v_add_f32_dpp v39, v39, v39 quad_perm:[1,0,3,2] row_mask:0xf bank_mask:0xf
  v_cndmask_b32 v40, v49, v48, s[38:39]
  v_mov_b32_dpp v46, v41 quad_perm:[1,0,3,2] row_mask:0xf bank_mask:0xf
  v_add_f32_dpp v39, v39, v39 quad_perm:[2,3,0,1] row_mask:0xf bank_mask:0xf
  v_cndmask_b32 v42, v46, v40, s[38:39]
  v_cndmask_b32 v43, v40, v46, s[38:39]
  v_add_f32_dpp v39, v39, v39 row_half_mirror row_mask:0xf bank_mask:0xf
  s_cbranch_vccnz cA_sc3_slow
  s_nop 0
  v_add_f32_dpp v47, v39, v39 row_mirror row_mask:0xf bank_mask:0xf
  v_add_f32_dpp v39, v39, v39 row_mirror row_mask:0xf bank_mask:0xf
  s_nop 1
  v_permlane16_swap_b32 v39, v47
  v_add_f32 v39, v39, v47
  v_rcp_f32 v39, v39
  s_mov_b64 exec, s[28:29]
  v_mul_f32 v42, v42, v39
  v_mul_f32 v43, v43, v39
  v_cvt_pk_bf16_f32 v42, v42, v43
cA_sc3_pst:
  buffer_store_dword v42, v1, s[8:11], s20 offen
  s_mov_b64 exec, -1
  s_barrier
  s_add_u32 s24, s24, 28672
  s_add_u32 s35, s35, 28672
  s_xor_b32 s25, s25, 28672
  s_add_u32 m0, s25, 21504
  s_add_u32 m0, s25, 25600
  s_add_u32 s22, s24, 4096
  buffer_load_dwordx4 v2, s[8:11], s22 offen offset:0 sc1 lds
  v_mov_b32 v48, 0
  v_mov_b32 v49, 0
  v_mov_b32 v50, 0
  v_mov_b32 v51, 0
  v_mov_b32 v52, 0
  v_mov_b32 v53, 0
  buffer_load_dwordx4 v2, s[8:11], s22 offen offset:1024 sc1 lds
  v_mov_b32 v54, 0
  v_mov_b32 v55, 0
  v_mov_b32 v56, 0
  v_mov_b32 v57, 0
  v_mov_b32 v58, 0
  v_mov_b32 v59, 0
  buffer_load_dwordx4 v2, s[8:11], s22 offen offset:2048 sc1 lds
  v_mov_b32 v60, 0
  v_mov_b32 v61, 0
  v_mov_b32 v62, 0
  v_mov_b32 v63, 0
  v_mov_b32 v88, 0
  v_mov_b32 v89, 0
  v_mov_b32 v90, 0
  v_mov_b32 v91, 0
  v_mov_b32 v92, 0
  v_mov_b32 v93, 0
  v_mov_b32 v94, 0
  v_mov_b32 v95, 0
  v_mov_b32 v64, 0
  v_mov_b32 v65, 0
  v_xor_b32 v116, 28672, v116
  v_add_u32 v117, s57, v117
  s_sub_u32 s57, 0, s57
  s_add_u32 s19, s19, 1
  s_mov_b32 s20, s21
  s_cmp_lt_u32 s19, 63
  s_cbranch_scc1 cA_sc3_loop
  s_branch cA_done
cA_sc3_slow:
  v_max_f32 v50, v36, v44
  s_nop 1
  v_max_f32_dpp v50, v50, v50 quad_perm:[1,0,3,2] row_mask:0xf bank_mask:0xf
  s_nop 1
  v_max_f32_dpp v50, v50, v50 quad_perm:[2,3,0,1] row_mask:0xf bank_mask:0xf
  s_nop 1
  v_max_f32_dpp v50, v50, v50 row_half_mirror row_mask:0xf bank_mask:0xf
  s_nop 1
  v_max_f32_dpp v50, v50, v50 row_mirror row_mask:0xf bank_mask:0xf
  v_mov_b32 v47, v50
  s_nop 1
  v_permlane16_swap_b32 v50, v47
  v_max_f32 v50, v50, v47
  v_sub_f32 v48, v36, v50
  v_sub_f32 v49, v44, v50
  v_exp_f32 v48, v48
  v_exp_f32 v49, v49
  s_add_u32 s31, s31, 0x100
  v_fma_f32 v39, v49, s37, v48
  v_cndmask_b32 v41, v48, v49, s[38:39]
  s_nop 0
  v_add_f32_dpp v39, v39, v39 quad_perm:[1,0,3,2] row_mask:0xf bank_mask:0xf
  v_cndmask_b32 v40, v49, v48, s[38:39]
  v_mov_b32_dpp v46, v41 quad_perm:[1,0,3,2] row_mask:0xf bank_mask:0xf
  v_add_f32_dpp v39, v39, v39 quad_perm:[2,3,0,1] row_mask:0xf bank_mask:0xf
  v_cndmask_b32 v42, v46, v40, s[38:39]
  v_cndmask_b32 v43, v40, v46, s[38:39]
  v_add_f32_dpp v39, v39, v39 row_half_mirror row_mask:0xf bank_mask:0xf
  s_nop 1
  v_add_f32_dpp v47, v39, v39 row_mirror row_mask:0xf bank_mask:0xf
  v_add_f32_dpp v39, v39, v39 row_mirror row_mask:0xf bank_mask:0xf
  s_nop 1
  v_permlane16_swap_b32 v39, v47
  v_add_f32 v39, v39, v47
  v_rcp_f32 v39, v39
  s_mov_b64 exec, s[28:29]
  v_mul_f32 v42, v42, v39
  v_mul_f32 v43, v43, v39
  v_cvt_pk_bf16_f32 v42, v42, v43
  v_min_u32 v42, -2, v42
  s_branch cA_sc3_pst
cA_sc3_retry:
  s_cmp_lg_u32 s62, 0
  s_cbranch_scc1 cA_sc3_cont
  s_waitcnt vmcnt(0) lgkmcnt(0)
cA_sc3_rv:
  buffer_load_dwordx4 v[8:11], v2, s[8:11], s20 offen offset:0 sc1
  buffer_load_dwordx4 v[12:15], v2, s[8:11], s20 offen offset:1024 sc1
  buffer_load_dwordx4 v[16:19], v2, s[8:11], s20 offen offset:2048 sc1
  buffer_load_dwordx4 v[20:23], v2, s[8:11], s20 offen offset:3072 sc1
  buffer_load_dwordx4 v[24:27], v2, s[8:11], s23 offen offset:0 sc1
  buffer_load_dwordx4 v[28:31], v2, s[8:11], s23 offen offset:1024 sc1
  buffer_load_dwordx4 v[32:35], v2, s[8:11], s23 offen offset:2048 sc1
  s_waitcnt vmcnt(0)
  v_max3_u32 v68, v8, v9, v10
  v_max3_u32 v68, v68, v11, v12
  v_max3_u32 v68, v68, v13, v14
  v_max3_u32 v68, v68, v15, v16
  v_max3_u32 v68, v68, v17, v18
  v_max3_u32 v68, v68, v19, v20
  v_max3_u32 v68, v68, v21, v22
  v_max3_u32 v68, v68, v23, v24
  v_max3_u32 v68, v68, v25, v26
  v_max3_u32 v68, v68, v27, v28
  v_max3_u32 v68, v68, v29, v30
  v_max3_u32 v68, v68, v31, v32
  v_max3_u32 v68, v68, v33, v34
  v_max_u32 v68, v68, v35
  v_cmp_eq_u32 vcc, -1, v68
  s_cbranch_vccz cA_sc3_rk
  s_add_u32 s30, s30, 1
  s_cmp_lt_u32 s30, 400000
  s_cbranch_scc1 cA_sc3_rv
  s_branch cA_abort
cA_sc3_rk:
  s_mov_b32 s62, 1
  v_mov_b32 v36, 0
  v_mov_b32 v37, 0
  v_mov_b32 v38, 0
  v_mov_b32 v39, 0
  v_mov_b32 v40, 0
  v_mov_b32 v41, 0
  v_mov_b32 v42, 0
  v_mov_b32 v43, 0
  v_mov_b32 v44, 0
  v_mov_b32 v45, 0
  v_mov_b32 v46, 0
  v_mov_b32 v47, 0
  v_mov_b32 v48, 0
  v_mov_b32 v49, 0
  v_mov_b32 v50, 0
  v_mov_b32 v51, 0
  v_mov_b32 v52, 0
  v_mov_b32 v53, 0
  v_mov_b32 v54, 0
  v_mov_b32 v55, 0
  v_mov_b32 v56, 0
  v_mov_b32 v57, 0
  v_mov_b32 v58, 0
  v_mov_b32 v59, 0
  v_mov_b32 v60, 0
  v_mov_b32 v61, 0
  v_mov_b32 v62, 0
  v_mov_b32 v63, 0
  v_mov_b32 v88, 0
  v_mov_b32 v89, 0
  v_mov_b32 v90, 0
  v_mov_b32 v91, 0
  v_mov_b32 v92, 0
  v_mov_b32 v93, 0
  v_mov_b32 v94, 0
  v_mov_b32 v95, 0
  v_mov_b32 v64, 0
  v_mov_b32 v65, 0
  s_add_u32 s31, s31, 1
  ds_read_b128 v[96:99], v117 offset:0
  ds_read_b128 v[100:103], v117 offset:1024
  ds_read_b128 v[104:107], v117 offset:14336
  ds_read_b128 v[108:111], v117 offset:15360
  v_smfmac_f32_16x16x64_bf16 v[36:39], v[8:11], a[0:7], v3
  v_smfmac_f32_16x16x64_bf16 v[40:43], v[8:11], a[56:63], v3
  v_smfmac_f32_16x16x64_bf16 v[44:47], v[8:11], a[112:119], v3
  v_smfmac_f32_16x16x64_bf16 v[48:51], v[8:11], a[168:175], v3
  v_smfmac_f32_16x16x64_bf16 v[52:55], v[8:11], a[224:231], v3
  v_smfmac_f32_16x16x64_bf16 v[56:59], v[8:11], v[144:151], v3
  v_smfmac_f32_16x16x64_bf16 v[60:63], v[8:11], v[200:207], v3
  v_smfmac_f32_16x16x64_bf16 v[36:39], v[12:15], a[8:15], v3
  v_smfmac_f32_16x16x64_bf16 v[40:43], v[12:15], a[64:71], v3
  v_smfmac_f32_16x16x64_bf16 v[44:47], v[12:15], a[120:127], v3
  v_smfmac_f32_16x16x64_bf16 v[48:51], v[12:15], a[176:183], v3
  v_smfmac_f32_16x16x64_bf16 v[52:55], v[12:15], a[232:239], v3
  v_smfmac_f32_16x16x64_bf16 v[56:59], v[12:15], v[152:159], v3
  v_smfmac_f32_16x16x64_bf16 v[60:63], v[12:15], v[208:215], v3
  v_smfmac_f32_16x16x64_bf16 v[36:39], v[16:19], a[16:23], v3
  v_smfmac_f32_16x16x64_bf16 v[40:43], v[16:19], a[72:79], v3
  v_smfmac_f32_16x16x64_bf16 v[44:47], v[16:19], a[128:135], v3
  v_smfmac_f32_16x16x64_bf16 v[48:51], v[16:19], a[184:191], v3
  v_smfmac_f32_16x16x64_bf16 v[52:55], v[16:19], a[240:247], v3
  v_smfmac_f32_16x16x64_bf16 v[56:59], v[16:19], v[160:167], v3
  v_smfmac_f32_16x16x64_bf16 v[60:63], v[16:19], v[216:223], v3
  v_smfmac_f32_16x16x64_bf16 v[36:39], v[20:23], a[24:31], v3
  v_smfmac_f32_16x16x64_bf16 v[40:43], v[20:23], a[80:87], v3
  v_smfmac_f32_16x16x64_bf16 v[44:47], v[20:23], a[136:143], v3
  v_smfmac_f32_16x16x64_bf16 v[48:51], v[20:23], a[192:199], v3
  v_smfmac_f32_16x16x64_bf16 v[52:55], v[20:23], a[248:255], v3
  v_smfmac_f32_16x16x64_bf16 v[56:59], v[20:23], v[168:175], v3
  v_smfmac_f32_16x16x64_bf16 v[60:63], v[20:23], v[224:231], v3
  s_xor_b32 s58, s25, 28672
  s_add_u32 s59, s24, 28672
  s_add_u32 m0, s58, 21504
  s_branch cA_sc3_ph2
.p2align 6

cA_va0_loop:
  s_add_u32 s23, s20, 4096
  s_add_u32 s21, s20, 20480
  s_mov_b32 s30, 0
  s_cmp_lg_u32 s19, s38
  s_cbranch_scc1 cA_va0_vok
  s_branch cA_va0_voc
cA_va0_vow:
  s_sub_u32 s22, s39, s35
  v_lshlrev_b32 v63, 7, v2
  v_min_u32 v63, s22, v63
  buffer_load_dword v63, v63, s[8:11], s35 offen sc1
  s_waitcnt vmcnt(0)
cA_va0_voc:
  v_readfirstlane_b32 s22, v63
  s_cmp_eq_u32 s22, 56
  s_cbranch_scc1 cA_va0_vod
  s_sleep 1
  s_add_u32 s30, s30, 1
  s_cmp_lt_u32 s30, 400000
  s_cbranch_scc1 cA_va0_vow
  s_branch cA_abort
cA_va0_vod:
  s_add_u32 s35, s35, 2048
  s_add_u32 s38, s19, 8
  s_and_b32 s38, s38, -8
  s_cmp_eq_u32 s19, 0
  s_cselect_b32 s38, 4, s38
  v_cmp_ne_u32 vcc, 56, v63
  s_nop 3
  s_cmp_eq_u64 vcc, 0
  s_cselect_b32 s38, 99, s38
cA_va0_vok:
  s_cmp_eq_u32 s19, 63
  s_cbranch_scc1 cA_done
  s_barrier
  s_add_u32 s22, s25, 0
  buffer_load_dwordx4 v[80:83], v6, s[8:11], s22 offen offset:0 sc1
  buffer_load_dwordx4 v[84:87], v6, s[8:11], s22 offen offset:1792 sc1
  s_add_u32 s22, s25, 3584
  buffer_load_dwordx4 v[88:91], v6, s[8:11], s22 offen offset:0 sc1
  buffer_load_dwordx4 v[92:95], v6, s[8:11], s22 offen offset:1792 sc1
  s_add_u32 s22, s25, 7168
  buffer_load_dwordx4 v[96:99], v6, s[8:11], s22 offen offset:0 sc1
  buffer_load_dwordx4 v[100:103], v6, s[8:11], s22 offen offset:1792 sc1
  s_add_u32 s22, s25, 10752
  buffer_load_dwordx4 v[104:107], v6, s[8:11], s22 offen offset:0 sc1
  buffer_load_dwordx4 v[108:111], v6, s[8:11], s22 offen offset:1792 sc1
  s_add_u32 s22, s25, 14336
  buffer_load_dwordx4 v[112:115], v6, s[8:11], s22 offen offset:0 sc1
  buffer_load_dwordx4 v[116:119], v6, s[8:11], s22 offen offset:1792 sc1
  s_add_u32 s22, s25, 17920
  buffer_load_dwordx4 v[120:123], v6, s[8:11], s22 offen offset:0 sc1
  buffer_load_dwordx4 v[124:127], v6, s[8:11], s22 offen offset:1792 sc1
  s_add_u32 s22, s19, 1
  s_cmp_lg_u32 s22, s38
  s_cbranch_scc1 cA_va0_nk
  s_sub_u32 s22, s39, s35
  v_lshlrev_b32 v63, 7, v2
  v_min_u32 v63, s22, v63
  buffer_load_dword v63, v63, s[8:11], s35 offen sc1
cA_va0_nk:
  s_barrier
  ds_read_b128 v[8:11], v0 offset:8192
  ds_read_b128 v[12:15], v0 offset:9216
  ds_read_b128 v[16:19], v0 offset:10240
  ds_read_b128 v[20:23], v0 offset:11264
  ds_read_b128 v[24:27], v0 offset:12288
  ds_read_b128 v[28:31], v0 offset:13312
  ds_read_b128 v[32:35], v0 offset:14336
  s_waitcnt lgkmcnt(0)
  v_smfmac_f32_16x16x64_bf16 v[36:39], v[8:11], a[0:7], v3
  s_add_u32 s22, s25, 21504
  buffer_load_dwordx4 v[128:131], v6, s[8:11], s22 offen offset:0 sc1
  v_smfmac_f32_16x16x64_bf16 v[36:39], v[12:15], a[8:15], v3
  v_smfmac_f32_16x16x64_bf16 v[36:39], v[16:19], a[16:23], v3
  s_add_u32 s22, s25, 21504
  buffer_load_dwordx4 v[132:135], v6, s[8:11], s22 offen offset:1792 sc1
  v_smfmac_f32_16x16x64_bf16 v[36:39], v[20:23], a[24:31], v3
  v_smfmac_f32_16x16x64_bf16 v[36:39], v[24:27], a[32:39], v3
  s_add_u32 s22, s25, 25088
  buffer_load_dwordx4 v[136:139], v6, s[8:11], s22 offen offset:0 sc1
  v_smfmac_f32_16x16x64_bf16 v[36:39], v[28:31], a[40:47], v3
  v_smfmac_f32_16x16x64_bf16 v[36:39], v[32:35], a[48:55], v3
  s_add_u32 s22, s25, 25088
  buffer_load_dwordx4 v[140:143], v6, s[8:11], s22 offen offset:1792 sc1
  v_smfmac_f32_16x16x64_bf16 v[40:43], v[8:11], a[56:63], v3
  v_smfmac_f32_16x16x64_bf16 v[40:43], v[12:15], a[64:71], v3
  v_smfmac_f32_16x16x64_bf16 v[40:43], v[16:19], a[72:79], v3
  v_add_f32 v36, v36, v37
  v_smfmac_f32_16x16x64_bf16 v[40:43], v[20:23], a[80:87], v3
  v_add_f32 v38, v38, v39
  v_smfmac_f32_16x16x64_bf16 v[40:43], v[24:27], a[88:95], v3
  v_cvt_pk_bf16_f32 v36, v36, v38
  v_smfmac_f32_16x16x64_bf16 v[40:43], v[28:31], a[96:103], v3
  ds_write_b32 v60, v36
  v_smfmac_f32_16x16x64_bf16 v[40:43], v[32:35], a[104:111], v3
  v_smfmac_f32_16x16x64_bf16 v[44:47], v[8:11], a[112:119], v3
  v_smfmac_f32_16x16x64_bf16 v[44:47], v[12:15], a[120:127], v3
  v_smfmac_f32_16x16x64_bf16 v[44:47], v[16:19], a[128:135], v3
  v_add_f32 v40, v40, v41
  v_smfmac_f32_16x16x64_bf16 v[44:47], v[20:23], a[136:143], v3
  v_add_f32 v42, v42, v43
  v_smfmac_f32_16x16x64_bf16 v[44:47], v[24:27], a[144:151], v3
  v_cvt_pk_bf16_f32 v40, v40, v42
  v_smfmac_f32_16x16x64_bf16 v[44:47], v[28:31], a[152:159], v3
  ds_write_b32 v61, v40
  v_smfmac_f32_16x16x64_bf16 v[44:47], v[32:35], a[160:167], v3
  v_smfmac_f32_16x16x64_bf16 v[48:51], v[8:11], a[168:175], v3
  v_smfmac_f32_16x16x64_bf16 v[48:51], v[12:15], a[176:183], v3
  v_smfmac_f32_16x16x64_bf16 v[48:51], v[16:19], a[184:191], v3
  v_add_f32 v44, v44, v45
  v_smfmac_f32_16x16x64_bf16 v[48:51], v[20:23], a[192:199], v3
  v_add_f32 v46, v46, v47
  v_smfmac_f32_16x16x64_bf16 v[48:51], v[24:27], a[200:207], v3
  v_cvt_pk_bf16_f32 v44, v44, v46
  v_smfmac_f32_16x16x64_bf16 v[48:51], v[28:31], a[208:215], v3
  ds_write_b32 v62, v44
  v_smfmac_f32_16x16x64_bf16 v[48:51], v[32:35], a[216:223], v3
  v_smfmac_f32_16x16x64_bf16 v[52:55], v[8:11], a[224:231], v3
  v_smfmac_f32_16x16x64_bf16 v[52:55], v[12:15], a[232:239], v3
  v_smfmac_f32_16x16x64_bf16 v[52:55], v[16:19], a[240:247], v3
  v_add_f32 v48, v48, v49
  v_smfmac_f32_16x16x64_bf16 v[52:55], v[20:23], a[248:255], v3
  v_add_f32 v50, v50, v51
  v_smfmac_f32_16x16x64_bf16 v[52:55], v[24:27], v[176:183], v3
  v_cvt_pk_bf16_f32 v48, v48, v50
  v_smfmac_f32_16x16x64_bf16 v[52:55], v[28:31], v[184:191], v3
  ds_write_b32 v170, v48
  v_smfmac_f32_16x16x64_bf16 v[52:55], v[32:35], v[192:199], v3
  v_smfmac_f32_16x16x64_bf16 v[56:59], v[8:11], v[200:207], v3
  v_smfmac_f32_16x16x64_bf16 v[56:59], v[12:15], v[208:215], v3
  v_smfmac_f32_16x16x64_bf16 v[56:59], v[16:19], v[216:223], v3
  v_add_f32 v52, v52, v53
  v_smfmac_f32_16x16x64_bf16 v[56:59], v[20:23], v[224:231], v3
  v_add_f32 v54, v54, v55
  v_smfmac_f32_16x16x64_bf16 v[56:59], v[24:27], v[232:239], v3
  v_cvt_pk_bf16_f32 v52, v52, v54
  v_smfmac_f32_16x16x64_bf16 v[56:59], v[28:31], v[240:247], v3
  ds_write_b32 v171, v52
  v_smfmac_f32_16x16x64_bf16 v[56:59], v[32:35], v[248:255], v3
  s_nop 7
  v_add_f32 v56, v56, v57
  v_add_f32 v58, v58, v59
  v_cvt_pk_bf16_f32 v56, v56, v58
  ds_write_b32 v172, v56
  buffer_load_dword v164, v4, s[8:11], s20 offen sc1
  s_waitcnt lgkmcnt(0)
  v_mov_b32 v36, 0
  v_mov_b32 v37, 0
  v_mov_b32 v38, 0
  v_mov_b32 v39, 0
  v_mov_b32 v40, 0
  v_mov_b32 v41, 0
  v_mov_b32 v42, 0
  v_mov_b32 v43, 0
  buffer_load_dword v165, v4, s[8:11], s20 offen sc1
  v_mov_b32 v44, 0
  v_mov_b32 v45, 0
  v_mov_b32 v46, 0
  v_mov_b32 v47, 0
  v_mov_b32 v48, 0
  v_mov_b32 v49, 0
  v_mov_b32 v50, 0
  v_mov_b32 v51, 0
  buffer_load_dword v166, v4, s[8:11], s20 offen sc1
  v_mov_b32 v52, 0
  v_mov_b32 v53, 0
  v_mov_b32 v54, 0
  v_mov_b32 v55, 0
  v_mov_b32 v56, 0
  v_mov_b32 v57, 0
  v_mov_b32 v58, 0
  v_mov_b32 v59, 0
  buffer_load_dword v167, v4, s[8:11], s20 offen sc1
  s_cmp_eq_u32 s19, 63
  s_cbranch_scc1 cA_va0_last
  s_add_u32 s22, s20, 9216
  s_add_u32 s34, s20, 13312
  s_add_u32 s36, s20, 7168
  s_mov_b32 s37, 0
  v_mov_b32 v156, 0
  v_mov_b32 v157, 0
  v_mov_b32 v158, 0
  v_mov_b32 v159, 0
  buffer_load_dword v168, v4, s[8:11], s20 offen sc1
cA_va0_fw_l:
  s_waitcnt vmcnt(4)
  v_cmp_eq_u32 vcc, -1, v164
  s_cbranch_vccz cA_va0_fw_d
  buffer_load_dword v164, v4, s[8:11], s20 offen sc1
  s_waitcnt vmcnt(4)
  v_cmp_eq_u32 vcc, -1, v165
  s_cbranch_vccz cA_va0_fw_d
  buffer_load_dword v165, v4, s[8:11], s20 offen sc1
  s_waitcnt vmcnt(4)
  v_cmp_eq_u32 vcc, -1, v166
  s_cbranch_vccz cA_va0_fw_d
  buffer_load_dword v166, v4, s[8:11], s20 offen sc1
  s_waitcnt vmcnt(4)
  v_cmp_eq_u32 vcc, -1, v167
  s_cbranch_vccz cA_va0_fw_d
  buffer_load_dword v167, v4, s[8:11], s20 offen sc1
  s_waitcnt vmcnt(4)
  v_cmp_eq_u32 vcc, -1, v168
  s_cbranch_vccz cA_va0_fw_d
  buffer_load_dword v168, v4, s[8:11], s20 offen sc1
  s_add_u32 s30, s30, 1
  s_cmp_lt_u32 s30, 400000
  s_cbranch_scc1 cA_va0_fw_l
  s_branch cA_abort
cA_va0_fw_d:
  s_waitcnt lgkmcnt(0)
  buffer_load_dwordx4 v[8:11], v5, s[8:11], s22 offen offset:0
  buffer_load_dwordx4 v[12:15], v5, s[8:11], s22 offen offset:1024
  buffer_load_dwordx4 v[16:19], v5, s[8:11], s22 offen offset:2048
  buffer_load_dwordx4 v[20:23], v5, s[8:11], s22 offen offset:3072
  buffer_load_dwordx4 v[24:27], v5, s[8:11], s34 offen offset:0
  buffer_load_dwordx4 v[28:31], v5, s[8:11], s34 offen offset:1024
  buffer_load_dwordx4 v[32:35], v5, s[8:11], s34 offen offset:2048
  buffer_load_dwordx4 v[144:147], v5, s[8:11], s34 offen offset:3072
  buffer_load_dwordx4 v[148:151], v2, s[8:11], s36 offen offset:0
  buffer_load_dwordx4 v[152:155], v2, s[8:11], s36 offen offset:1024
  s_barrier
  ds_read_b128 v[64:67], v2 offset:0
  ds_read_b128 v[68:71], v2 offset:1024
  ds_read_b128 v[72:75], v2 offset:2048
  ds_read_b128 v[76:79], v2 offset:3072
  s_waitcnt vmcnt(9)
  v_smfmac_f32_16x16x64_bf16 v[156:159], v[8:11], v[80:87], v3
  s_waitcnt vmcnt(8)
  v_smfmac_f32_16x16x64_bf16 v[156:159], v[12:15], v[88:95], v3
  s_waitcnt vmcnt(7)
  v_smfmac_f32_16x16x64_bf16 v[156:159], v[16:19], v[96:103], v3
  s_waitcnt vmcnt(6)
  v_smfmac_f32_16x16x64_bf16 v[156:159], v[20:23], v[104:111], v3
  s_waitcnt vmcnt(5)
  v_smfmac_f32_16x16x64_bf16 v[156:159], v[24:27], v[112:119], v3
  s_waitcnt vmcnt(4)
  v_smfmac_f32_16x16x64_bf16 v[156:159], v[28:31], v[120:127], v3
  s_waitcnt vmcnt(3)
  v_smfmac_f32_16x16x64_bf16 v[156:159], v[32:35], v[128:135], v3
  s_waitcnt vmcnt(2)
  v_smfmac_f32_16x16x64_bf16 v[156:159], v[144:147], v[136:143], v3
  s_waitcnt vmcnt(1) lgkmcnt(0)
  v_smfmac_f32_16x16x64_bf16 v[156:159], v[148:151], v[64:71], v3
  s_waitcnt vmcnt(0)
  v_smfmac_f32_16x16x64_bf16 v[156:159], v[152:155], v[72:79], v3
cA_va0_ep:
  s_nop 7
  v_add_f32 v160, v156, v157
  v_add_f32 v161, v158, v159
  v_cmp_u_f32 vcc, v160, v161
  v_mov_b32_dpp v162, v160 row_ror:8 row_mask:0xf bank_mask:0xf
  v_mov_b32_dpp v160, v161 row_ror:8 row_mask:0xf bank_mask:0xc
  s_cbranch_vccnz cA_va0_rp
  v_mov_b32_dpp v161, v162 quad_perm:[0,1,2,3] row_mask:0xf bank_mask:0x3
  v_cvt_pk_bf16_f32 v160, v160, v161
cA_va0_pc:
  buffer_store_dword v160, v1, s[8:11], s21 offen
  s_cmp_lg_u32 s19, 62
  s_cbranch_scc1 cA_va0_nl
  s_mov_b32 s22, 88531968
  buffer_store_dword v160, v1, s[8:11], s22 offen sc1
  s_mov_b64 exec, -1
  s_branch cA_done
cA_va0_nl:
  s_mov_b64 exec, -1
  s_add_u32 s25, s25, 28672
  s_add_u32 s19, s19, 1
  s_mov_b32 s20, s21
  s_branch cA_va0_loop
cA_va0_last:
  s_waitcnt lgkmcnt(0)
  s_barrier
  s_branch cA_done
cA_va0_rp:
  s_cmp_eq_u32 s37, 0
  s_cbranch_scc1 cA_va0_rv
  v_mov_b32_dpp v161, v162 quad_perm:[0,1,2,3] row_mask:0xf bank_mask:0x3
  v_cvt_pk_bf16_f32 v160, v160, v161
  v_min_u32 v160, -2, v160
  s_branch cA_va0_pc
cA_va0_rv:
  buffer_load_dwordx4 v[8:11], v5, s[8:11], s22 offen offset:0 sc1
  buffer_load_dwordx4 v[12:15], v5, s[8:11], s22 offen offset:1024 sc1
  buffer_load_dwordx4 v[16:19], v5, s[8:11], s22 offen offset:2048 sc1
  buffer_load_dwordx4 v[20:23], v5, s[8:11], s22 offen offset:3072 sc1
  buffer_load_dwordx4 v[24:27], v5, s[8:11], s34 offen offset:0 sc1
  buffer_load_dwordx4 v[28:31], v5, s[8:11], s34 offen offset:1024 sc1
  buffer_load_dwordx4 v[32:35], v5, s[8:11], s34 offen offset:2048 sc1
  buffer_load_dwordx4 v[144:147], v5, s[8:11], s34 offen offset:3072 sc1
  buffer_load_dwordx4 v[148:151], v2, s[8:11], s36 offen offset:0 sc1
  buffer_load_dwordx4 v[152:155], v2, s[8:11], s36 offen offset:1024 sc1
  s_waitcnt vmcnt(0)
  v_max3_u32 v175, v8, v9, v10
  v_max3_u32 v175, v175, v11, v12
  v_max3_u32 v175, v175, v13, v14
  v_max3_u32 v175, v175, v15, v16
  v_max3_u32 v175, v175, v17, v18
  v_max3_u32 v175, v175, v19, v20
  v_max3_u32 v175, v175, v21, v22
  v_max3_u32 v175, v175, v23, v24
  v_max3_u32 v175, v175, v25, v26
  v_max3_u32 v175, v175, v27, v28
  v_max3_u32 v175, v175, v29, v30
  v_max3_u32 v175, v175, v31, v32
  v_max3_u32 v175, v175, v33, v34
  v_max3_u32 v175, v175, v35, v144
  v_max3_u32 v175, v175, v145, v146
  v_max3_u32 v175, v175, v147, v148
  v_max3_u32 v175, v175, v149, v150
  v_max3_u32 v175, v175, v151, v152
  v_max3_u32 v175, v175, v153, v154
  v_max_u32 v175, v175, v155
  v_cmp_eq_u32 vcc, -1, v175
  s_cbranch_vccz cA_va0_rk
  s_add_u32 s30, s30, 1
  s_cmp_lt_u32 s30, 400000
  s_cbranch_scc1 cA_va0_rv
  s_branch cA_abort
cA_va0_rk:
  s_mov_b32 s37, 1
  s_add_u32 s31, s31, 0x10000
  v_mov_b32 v156, 0
  v_mov_b32 v157, 0
  v_mov_b32 v158, 0
  v_mov_b32 v159, 0
  s_nop 1
  v_smfmac_f32_16x16x64_bf16 v[156:159], v[8:11], v[80:87], v3
  v_smfmac_f32_16x16x64_bf16 v[156:159], v[12:15], v[88:95], v3
  v_smfmac_f32_16x16x64_bf16 v[156:159], v[16:19], v[96:103], v3
  v_smfmac_f32_16x16x64_bf16 v[156:159], v[20:23], v[104:111], v3
  v_smfmac_f32_16x16x64_bf16 v[156:159], v[24:27], v[112:119], v3
  v_smfmac_f32_16x16x64_bf16 v[156:159], v[28:31], v[120:127], v3
  v_smfmac_f32_16x16x64_bf16 v[156:159], v[32:35], v[128:135], v3
  v_smfmac_f32_16x16x64_bf16 v[156:159], v[144:147], v[136:143], v3
  v_smfmac_f32_16x16x64_bf16 v[156:159], v[148:151], v[64:71], v3
  v_smfmac_f32_16x16x64_bf16 v[156:159], v[152:155], v[72:79], v3
  s_nop 7
  s_branch cA_va0_ep
.p2align 6

cA_va1_loop:
  s_add_u32 s23, s20, 4096
  s_add_u32 s21, s20, 20480
  s_mov_b32 s30, 0
  s_cmp_lg_u32 s19, s38
  s_cbranch_scc1 cA_va1_vok
  s_branch cA_va1_voc
cA_va1_vow:
  s_sub_u32 s22, s39, s35
  v_lshlrev_b32 v63, 7, v2
  v_min_u32 v63, s22, v63
  buffer_load_dword v63, v63, s[8:11], s35 offen sc1
  s_waitcnt vmcnt(0)
cA_va1_voc:
  v_readfirstlane_b32 s22, v63
  s_cmp_eq_u32 s22, 56
  s_cbranch_scc1 cA_va1_vod
  s_sleep 1
  s_add_u32 s30, s30, 1
  s_cmp_lt_u32 s30, 400000
  s_cbranch_scc1 cA_va1_vow
  s_branch cA_abort
cA_va1_vod:
  s_add_u32 s35, s35, 2048
  s_add_u32 s38, s19, 8
  s_and_b32 s38, s38, -8
  s_cmp_eq_u32 s19, 0
  s_cselect_b32 s38, 4, s38
  v_cmp_ne_u32 vcc, 56, v63
  s_nop 3
  s_cmp_eq_u64 vcc, 0
  s_cselect_b32 s38, 99, s38
cA_va1_vok:
  s_cmp_eq_u32 s19, 63
  s_cbranch_scc1 cA_done
  s_barrier
  s_add_u32 s22, s25, 0
  buffer_load_dwordx4 v[80:83], v6, s[8:11], s22 offen offset:0 sc1
  buffer_load_dwordx4 v[84:87], v6, s[8:11], s22 offen offset:1792 sc1
  s_add_u32 s22, s25, 3584
  buffer_load_dwordx4 v[88:91], v6, s[8:11], s22 offen offset:0 sc1
  buffer_load_dwordx4 v[92:95], v6, s[8:11], s22 offen offset:1792 sc1
  s_add_u32 s22, s25, 7168
  buffer_load_dwordx4 v[96:99], v6, s[8:11], s22 offen offset:0 sc1
  buffer_load_dwordx4 v[100:103], v6, s[8:11], s22 offen offset:1792 sc1
  s_add_u32 s22, s25, 10752
  buffer_load_dwordx4 v[104:107], v6, s[8:11], s22 offen offset:0 sc1
  buffer_load_dwordx4 v[108:111], v6, s[8:11], s22 offen offset:1792 sc1
  s_add_u32 s22, s25, 14336
  buffer_load_dwordx4 v[112:115], v6, s[8:11], s22 offen offset:0 sc1
  buffer_load_dwordx4 v[116:119], v6, s[8:11], s22 offen offset:1792 sc1
  s_add_u32 s22, s25, 17920
  buffer_load_dwordx4 v[120:123], v6, s[8:11], s22 offen offset:0 sc1
  buffer_load_dwordx4 v[124:127], v6, s[8:11], s22 offen offset:1792 sc1
  s_add_u32 s22, s19, 1
  s_cmp_lg_u32 s22, s38
  s_cbranch_scc1 cA_va1_nk
  s_sub_u32 s22, s39, s35
  v_lshlrev_b32 v63, 7, v2
  v_min_u32 v63, s22, v63
  buffer_load_dword v63, v63, s[8:11], s35 offen sc1
cA_va1_nk:
  s_barrier
  ds_read_b128 v[8:11], v0 offset:8192
  ds_read_b128 v[12:15], v0 offset:9216
  ds_read_b128 v[16:19], v0 offset:10240
  ds_read_b128 v[20:23], v0 offset:11264
  ds_read_b128 v[24:27], v0 offset:12288
  ds_read_b128 v[28:31], v0 offset:13312
  ds_read_b128 v[32:35], v0 offset:14336
  s_waitcnt lgkmcnt(0)
  v_smfmac_f32_16x16x64_bf16 v[36:39], v[8:11], a[0:7], v3
  s_add_u32 s22, s25, 21504
  buffer_load_dwordx4 v[128:131], v6, s[8:11], s22 offen offset:0 sc1
  v_smfmac_f32_16x16x64_bf16 v[36:39], v[12:15], a[8:15], v3
  v_smfmac_f32_16x16x64_bf16 v[36:39], v[16:19], a[16:23], v3
  s_add_u32 s22, s25, 21504
  buffer_load_dwordx4 v[132:135], v6, s[8:11], s22 offen offset:1792 sc1
  v_smfmac_f32_16x16x64_bf16 v[36:39], v[20:23], a[24:31], v3
  v_smfmac_f32_16x16x64_bf16 v[36:39], v[24:27], a[32:39], v3
  s_add_u32 s22, s25, 25088
  buffer_load_dwordx4 v[136:139], v6, s[8:11], s22 offen offset:0 sc1
  v_smfmac_f32_16x16x64_bf16 v[36:39], v[28:31], a[40:47], v3
  v_smfmac_f32_16x16x64_bf16 v[36:39], v[32:35], a[48:55], v3
  s_add_u32 s22, s25, 25088
  buffer_load_dwordx4 v[140:143], v6, s[8:11], s22 offen offset:1792 sc1
  v_smfmac_f32_16x16x64_bf16 v[40:43], v[8:11], a[56:63], v3
  v_smfmac_f32_16x16x64_bf16 v[40:43], v[12:15], a[64:71], v3
  v_smfmac_f32_16x16x64_bf16 v[40:43], v[16:19], a[72:79], v3
  v_add_f32 v36, v36, v37
  v_smfmac_f32_16x16x64_bf16 v[40:43], v[20:23], a[80:87], v3
  v_add_f32 v38, v38, v39
  v_smfmac_f32_16x16x64_bf16 v[40:43], v[24:27], a[88:95], v3
  v_cvt_pk_bf16_f32 v36, v36, v38
  v_smfmac_f32_16x16x64_bf16 v[40:43], v[28:31], a[96:103], v3
  ds_write_b32 v60, v36
  v_smfmac_f32_16x16x64_bf16 v[40:43], v[32:35], a[104:111], v3
  v_smfmac_f32_16x16x64_bf16 v[44:47], v[8:11], a[112:119], v3
  v_smfmac_f32_16x16x64_bf16 v[44:47], v[12:15], a[120:127], v3
  v_smfmac_f32_16x16x64_bf16 v[44:47], v[16:19], a[128:135], v3
  v_add_f32 v40, v40, v41
  v_smfmac_f32_16x16x64_bf16 v[44:47], v[20:23], a[136:143], v3
  v_add_f32 v42, v42, v43
  v_smfmac_f32_16x16x64_bf16 v[44:47], v[24:27], a[144:151], v3
  v_cvt_pk_bf16_f32 v40, v40, v42
  v_smfmac_f32_16x16x64_bf16 v[44:47], v[28:31], a[152:159], v3
  ds_write_b32 v61, v40
  v_smfmac_f32_16x16x64_bf16 v[44:47], v[32:35], a[160:167], v3
  v_smfmac_f32_16x16x64_bf16 v[48:51], v[8:11], a[168:175], v3
  v_smfmac_f32_16x16x64_bf16 v[48:51], v[12:15], a[176:183], v3
  v_smfmac_f32_16x16x64_bf16 v[48:51], v[16:19], a[184:191], v3
  v_add_f32 v44, v44, v45
  v_smfmac_f32_16x16x64_bf16 v[48:51], v[20:23], a[192:199], v3
  v_add_f32 v46, v46, v47
  v_smfmac_f32_16x16x64_bf16 v[48:51], v[24:27], a[200:207], v3
  v_cvt_pk_bf16_f32 v44, v44, v46
  v_smfmac_f32_16x16x64_bf16 v[48:51], v[28:31], a[208:215], v3
  ds_write_b32 v62, v44
  v_smfmac_f32_16x16x64_bf16 v[48:51], v[32:35], a[216:223], v3
  v_smfmac_f32_16x16x64_bf16 v[52:55], v[8:11], a[224:231], v3
  v_smfmac_f32_16x16x64_bf16 v[52:55], v[12:15], a[232:239], v3
  v_smfmac_f32_16x16x64_bf16 v[52:55], v[16:19], a[240:247], v3
  v_add_f32 v48, v48, v49
  v_smfmac_f32_16x16x64_bf16 v[52:55], v[20:23], a[248:255], v3
  v_add_f32 v50, v50, v51
  v_smfmac_f32_16x16x64_bf16 v[52:55], v[24:27], v[176:183], v3
  v_cvt_pk_bf16_f32 v48, v48, v50
  v_smfmac_f32_16x16x64_bf16 v[52:55], v[28:31], v[184:191], v3
  ds_write_b32 v170, v48
  v_smfmac_f32_16x16x64_bf16 v[52:55], v[32:35], v[192:199], v3
  v_smfmac_f32_16x16x64_bf16 v[56:59], v[8:11], v[200:207], v3
  v_smfmac_f32_16x16x64_bf16 v[56:59], v[12:15], v[208:215], v3
  v_smfmac_f32_16x16x64_bf16 v[56:59], v[16:19], v[216:223], v3
  v_add_f32 v52, v52, v53
  v_smfmac_f32_16x16x64_bf16 v[56:59], v[20:23], v[224:231], v3
  v_add_f32 v54, v54, v55
  v_smfmac_f32_16x16x64_bf16 v[56:59], v[24:27], v[232:239], v3
  v_cvt_pk_bf16_f32 v52, v52, v54
  v_smfmac_f32_16x16x64_bf16 v[56:59], v[28:31], v[240:247], v3
  ds_write_b32 v171, v52
  v_smfmac_f32_16x16x64_bf16 v[56:59], v[32:35], v[248:255], v3
  s_nop 7
  v_add_f32 v56, v56, v57
  v_add_f32 v58, v58, v59
  v_cvt_pk_bf16_f32 v56, v56, v58
  ds_write_b32 v172, v56
  s_waitcnt lgkmcnt(0)
  v_mov_b32 v36, 0
  v_mov_b32 v37, 0
  v_mov_b32 v38, 0
  v_mov_b32 v39, 0
  v_mov_b32 v40, 0
  v_mov_b32 v41, 0
  v_mov_b32 v42, 0
  v_mov_b32 v43, 0
  v_mov_b32 v44, 0
  v_mov_b32 v45, 0
  v_mov_b32 v46, 0
  v_mov_b32 v47, 0
  v_mov_b32 v48, 0
  v_mov_b32 v49, 0
  v_mov_b32 v50, 0
  v_mov_b32 v51, 0
  v_mov_b32 v52, 0
  v_mov_b32 v53, 0
  v_mov_b32 v54, 0
  v_mov_b32 v55, 0
  v_mov_b32 v56, 0
  v_mov_b32 v57, 0
  v_mov_b32 v58, 0
  v_mov_b32 v59, 0
  s_cmp_eq_u32 s19, 63
  s_cbranch_scc1 cA_va1_last
  s_add_u32 s22, s20, 9216
  s_add_u32 s34, s20, 13312
  s_add_u32 s36, s20, 7168
  s_mov_b32 s37, 0
  v_mov_b32 v156, 0
  v_mov_b32 v157, 0
  v_mov_b32 v158, 0
  v_mov_b32 v159, 0
  s_barrier
  s_waitcnt lgkmcnt(0)
  buffer_load_dwordx4 v[8:11], v5, s[8:11], s22 offen offset:0
  buffer_load_dwordx4 v[12:15], v5, s[8:11], s22 offen offset:1024
  buffer_load_dwordx4 v[16:19], v5, s[8:11], s22 offen offset:2048
  buffer_load_dwordx4 v[20:23], v5, s[8:11], s22 offen offset:3072
  buffer_load_dwordx4 v[24:27], v5, s[8:11], s34 offen offset:0
  buffer_load_dwordx4 v[28:31], v5, s[8:11], s34 offen offset:1024
  buffer_load_dwordx4 v[32:35], v5, s[8:11], s34 offen offset:2048
  buffer_load_dwordx4 v[144:147], v5, s[8:11], s34 offen offset:3072
  s_sub_u32 s23, s21, 4
  s_mov_b64 exec, 65535
  buffer_store_dword v2, v7, s[8:11], s23 offen
  s_mov_b64 exec, -1
  buffer_load_dwordx4 v[148:151], v2, s[8:11], s36 offen offset:0
  buffer_load_dwordx4 v[152:155], v2, s[8:11], s36 offen offset:1024
  ds_read_b128 v[64:67], v2 offset:4096
  ds_read_b128 v[68:71], v2 offset:5120
  ds_read_b128 v[72:75], v2 offset:6144
  ds_read_b128 v[76:79], v2 offset:7168
  s_waitcnt vmcnt(10)
  v_smfmac_f32_16x16x64_bf16 v[156:159], v[8:11], v[80:87], v3
  s_waitcnt vmcnt(9)
  v_smfmac_f32_16x16x64_bf16 v[156:159], v[12:15], v[88:95], v3
  s_waitcnt vmcnt(8)
  v_smfmac_f32_16x16x64_bf16 v[156:159], v[16:19], v[96:103], v3
  s_waitcnt vmcnt(7)
  v_smfmac_f32_16x16x64_bf16 v[156:159], v[20:23], v[104:111], v3
  s_waitcnt vmcnt(6)
  v_smfmac_f32_16x16x64_bf16 v[156:159], v[24:27], v[112:119], v3
  s_mov_b64 exec, 65535
  buffer_store_dword v2, v7, s[8:11], s21 offen
  s_mov_b64 exec, -1
  s_waitcnt vmcnt(6)
  v_smfmac_f32_16x16x64_bf16 v[156:159], v[28:31], v[120:127], v3
  s_waitcnt vmcnt(5)
  v_smfmac_f32_16x16x64_bf16 v[156:159], v[32:35], v[128:135], v3
  s_waitcnt vmcnt(4)
  v_smfmac_f32_16x16x64_bf16 v[156:159], v[144:147], v[136:143], v3
  s_waitcnt vmcnt(2) lgkmcnt(0)
  v_smfmac_f32_16x16x64_bf16 v[156:159], v[148:151], v[64:71], v3
  s_waitcnt vmcnt(1)
  v_smfmac_f32_16x16x64_bf16 v[156:159], v[152:155], v[72:79], v3
cA_va1_ep:
  s_nop 7
  v_add_f32 v160, v156, v157
  v_add_f32 v161, v158, v159
  v_cmp_u_f32 vcc, v160, v161
  v_mov_b32_dpp v162, v160 row_ror:8 row_mask:0xf bank_mask:0xf
  v_mov_b32_dpp v160, v161 row_ror:8 row_mask:0xf bank_mask:0xc
  s_cbranch_vccnz cA_va1_rp
  v_mov_b32_dpp v161, v162 quad_perm:[0,1,2,3] row_mask:0xf bank_mask:0x3
  v_cvt_pk_bf16_f32 v160, v160, v161
cA_va1_pc:
  s_mov_b64 exec, s[26:27]
  buffer_store_dword v160, v1, s[8:11], s21 offen
  s_cmp_lg_u32 s19, 62
  s_cbranch_scc1 cA_va1_nl
  s_mov_b32 s22, 88531968
  buffer_store_dword v160, v1, s[8:11], s22 offen sc1
  s_mov_b64 exec, -1
  s_branch cA_done
cA_va1_nl:
  s_mov_b64 exec, -1
  s_cmp_lg_u32 s19, 0
  s_cbranch_scc1 cA_va1_s0
  v_add_u32 v7, 512, v7
  v_lshl_add_u32 v7, v2, 3, v7
  s_mov_b64 exec, 65535
  buffer_store_dword v2, v7, s[8:11], s21 offen
  buffer_store_dword v2, v7, s[8:11], s23 offen
  s_mov_b64 exec, -1
cA_va1_s0:
  s_add_u32 s25, s25, 28672
  s_add_u32 s19, s19, 1
  s_mov_b32 s20, s21
  s_branch cA_va1_loop
cA_va1_last:
  s_waitcnt lgkmcnt(0)
  s_barrier
  s_branch cA_done
cA_va1_rp:
  s_cmp_eq_u32 s37, 0
  s_cbranch_scc1 cA_va1_rv
  v_mov_b32_dpp v161, v162 quad_perm:[0,1,2,3] row_mask:0xf bank_mask:0x3
  v_cvt_pk_bf16_f32 v160, v160, v161
  v_min_u32 v160, -2, v160
  s_branch cA_va1_pc
cA_va1_rv:
  buffer_load_dwordx4 v[8:11], v5, s[8:11], s22 offen offset:0 sc1
  buffer_load_dwordx4 v[12:15], v5, s[8:11], s22 offen offset:1024 sc1
  buffer_load_dwordx4 v[16:19], v5, s[8:11], s22 offen offset:2048 sc1
  buffer_load_dwordx4 v[20:23], v5, s[8:11], s22 offen offset:3072 sc1
  buffer_load_dwordx4 v[24:27], v5, s[8:11], s34 offen offset:0 sc1
  buffer_load_dwordx4 v[28:31], v5, s[8:11], s34 offen offset:1024 sc1
  buffer_load_dwordx4 v[32:35], v5, s[8:11], s34 offen offset:2048 sc1
  buffer_load_dwordx4 v[144:147], v5, s[8:11], s34 offen offset:3072 sc1
  buffer_load_dwordx4 v[148:151], v2, s[8:11], s36 offen offset:0 sc1
  buffer_load_dwordx4 v[152:155], v2, s[8:11], s36 offen offset:1024 sc1
  s_waitcnt vmcnt(0)
  v_max3_u32 v175, v8, v9, v10
  v_max3_u32 v175, v175, v11, v12
  v_max3_u32 v175, v175, v13, v14
  v_max3_u32 v175, v175, v15, v16
  v_max3_u32 v175, v175, v17, v18
  v_max3_u32 v175, v175, v19, v20
  v_max3_u32 v175, v175, v21, v22
  v_max3_u32 v175, v175, v23, v24
  v_max3_u32 v175, v175, v25, v26
  v_max3_u32 v175, v175, v27, v28
  v_max3_u32 v175, v175, v29, v30
  v_max3_u32 v175, v175, v31, v32
  v_max3_u32 v175, v175, v33, v34
  v_max3_u32 v175, v175, v35, v144
  v_max3_u32 v175, v175, v145, v146
  v_max3_u32 v175, v175, v147, v148
  v_max3_u32 v175, v175, v149, v150
  v_max3_u32 v175, v175, v151, v152
  v_max3_u32 v175, v175, v153, v154
  v_max_u32 v175, v175, v155
  v_cmp_eq_u32 vcc, -1, v175
  s_cbranch_vccz cA_va1_rk
  s_add_u32 s30, s30, 1
  s_cmp_lt_u32 s30, 400000
  s_cbranch_scc1 cA_va1_rv
  s_branch cA_abort
cA_va1_rk:
  s_mov_b32 s37, 1
  s_add_u32 s31, s31, 0x10000
  v_mov_b32 v156, 0
  v_mov_b32 v157, 0
  v_mov_b32 v158, 0
  v_mov_b32 v159, 0
  s_nop 1
  v_smfmac_f32_16x16x64_bf16 v[156:159], v[8:11], v[80:87], v3
  v_smfmac_f32_16x16x64_bf16 v[156:159], v[12:15], v[88:95], v3
  v_smfmac_f32_16x16x64_bf16 v[156:159], v[16:19], v[96:103], v3
  v_smfmac_f32_16x16x64_bf16 v[156:159], v[20:23], v[104:111], v3
  v_smfmac_f32_16x16x64_bf16 v[156:159], v[24:27], v[112:119], v3
  v_smfmac_f32_16x16x64_bf16 v[156:159], v[28:31], v[120:127], v3
  v_smfmac_f32_16x16x64_bf16 v[156:159], v[32:35], v[128:135], v3
  v_smfmac_f32_16x16x64_bf16 v[156:159], v[144:147], v[136:143], v3
  v_smfmac_f32_16x16x64_bf16 v[156:159], v[148:151], v[64:71], v3
  v_smfmac_f32_16x16x64_bf16 v[156:159], v[152:155], v[72:79], v3
  s_nop 7
  s_branch cA_va1_ep
.p2align 6

cA_va2_loop:
  s_add_u32 s23, s20, 4096
  s_add_u32 s21, s20, 20480
  v_mov_b32 v36, 0
  v_mov_b32 v37, 0
  v_mov_b32 v38, 0
  v_mov_b32 v39, 0
  v_mov_b32 v40, 0
  v_mov_b32 v41, 0
  v_mov_b32 v42, 0
  v_mov_b32 v43, 0
  v_mov_b32 v44, 0
  v_mov_b32 v45, 0
  v_mov_b32 v46, 0
  v_mov_b32 v47, 0
  v_mov_b32 v48, 0
  v_mov_b32 v49, 0
  v_mov_b32 v50, 0
  v_mov_b32 v51, 0
  v_mov_b32 v52, 0
  v_mov_b32 v53, 0
  v_mov_b32 v54, 0
  v_mov_b32 v55, 0
  v_mov_b32 v56, 0
  v_mov_b32 v57, 0
  v_mov_b32 v58, 0
  v_mov_b32 v59, 0
  v_mov_b32 v60, 0
  v_mov_b32 v61, 0
  v_mov_b32 v62, 0
  v_mov_b32 v63, 0
  v_mov_b32 v64, 0
  v_mov_b32 v65, 0
  v_mov_b32 v66, 0
  v_mov_b32 v67, 0
  s_mov_b32 s30, 0
  buffer_load_dword v76, v119, s[8:11], s20 offen sc1
  buffer_load_dword v77, v119, s[8:11], s20 offen sc1
  buffer_load_dword v78, v119, s[8:11], s20 offen sc1
cA_va2_fp_l:
  s_waitcnt vmcnt(2)
  v_cmp_eq_u32 vcc, -1, v76
  s_cbranch_vccz cA_va2_fp_d
  buffer_load_dword v76, v119, s[8:11], s20 offen sc1
  s_waitcnt vmcnt(2)
  v_cmp_eq_u32 vcc, -1, v77
  s_cbranch_vccz cA_va2_fp_d
  buffer_load_dword v77, v119, s[8:11], s20 offen sc1
  s_waitcnt vmcnt(2)
  v_cmp_eq_u32 vcc, -1, v78
  s_cbranch_vccz cA_va2_fp_d
  buffer_load_dword v78, v119, s[8:11], s20 offen sc1
  s_add_u32 s30, s30, 1
  s_cmp_lt_u32 s30, 400000
  s_cbranch_scc1 cA_va2_fp_l
  s_branch cA_abort
cA_va2_fp_d:
  buffer_load_dwordx4 v[8:11], v2, s[8:11], s20 offen offset:0 sc1
  buffer_load_dwordx4 v[12:15], v2, s[8:11], s20 offen offset:1024 sc1
  buffer_load_dwordx4 v[16:19], v2, s[8:11], s20 offen offset:2048 sc1
  buffer_load_dwordx4 v[20:23], v2, s[8:11], s20 offen offset:3072 sc1
  s_barrier
cA_va2_ld:
  s_waitcnt vmcnt(0)
  v_max3_u32 v84, v8, v9, v10
  v_max3_u32 v84, v84, v11, v12
  v_max3_u32 v84, v84, v13, v14
  v_max3_u32 v84, v84, v15, v16
  v_max3_u32 v84, v84, v17, v18
  v_max3_u32 v84, v84, v19, v20
  v_max3_u32 v84, v84, v21, v22
  v_max_u32 v84, v84, v23
  v_cmp_eq_u32 vcc, -1, v84
  ds_write_b128 v2, v[8:11] offset:8192
  ds_write_b128 v2, v[12:15] offset:9216
  ds_write_b128 v2, v[16:19] offset:10240
  ds_write_b128 v2, v[20:23] offset:11264
  s_cbranch_vccnz cA_va2_retry
  s_waitcnt lgkmcnt(0)
  s_barrier
  ds_read_b128 v[8:11], v5 offset:8192
  ds_read_b128 v[12:15], v5 offset:9216
  ds_read_b128 v[16:19], v5 offset:10240
  ds_read_b128 v[20:23], v5 offset:11264
  ds_read_b128 v[24:27], v5 offset:12288
  ds_read_b128 v[28:31], v5 offset:13312
  ds_read_b128 v[32:35], v5 offset:14336
  ds_read_b128 v[92:95], v0
  s_waitcnt lgkmcnt(0)
  s_mov_b64 exec, s[26:27]
  buffer_store_dwordx4 v[92:95], v2, s[8:11], s36 offen sc1
  s_mov_b64 exec, -1
  s_add_u32 s36, s36, 7168
  s_cmp_eq_u32 s19, 63
  s_cbranch_scc1 cA_done
  ds_read_b128 v[76:79], v1 offset:0
  ds_read_b128 v[80:83], v1 offset:1024
  ds_read_b128 v[84:87], v1 offset:2048
  ds_read_b128 v[88:91], v1 offset:3072
  ds_read_b128 v[92:95], v1 offset:4096
  ds_read_b128 v[96:99], v1 offset:5120
  v_smfmac_f32_16x16x64_bf16 v[60:63], v[8:11], v[200:207], v3
  v_smfmac_f32_16x16x64_bf16 v[60:63], v[12:15], v[208:215], v3
  s_waitcnt lgkmcnt(4)
  v_smfmac_f32_16x16x64_bf16 v[64:67], v[8:11], v[76:83], v3
  ds_read_b128 v[76:79], v1 offset:6144
  ds_read_b128 v[80:83], v1 offset:7168
  v_smfmac_f32_16x16x64_bf16 v[60:63], v[16:19], v[216:223], v3
  v_smfmac_f32_16x16x64_bf16 v[60:63], v[20:23], v[224:231], v3
  s_waitcnt lgkmcnt(4)
  v_smfmac_f32_16x16x64_bf16 v[64:67], v[12:15], v[84:91], v3
  ds_read_b128 v[84:87], v1 offset:8192
  ds_read_b128 v[88:91], v1 offset:9216
  v_smfmac_f32_16x16x64_bf16 v[60:63], v[24:27], v[232:239], v3
  v_smfmac_f32_16x16x64_bf16 v[60:63], v[28:31], v[240:247], v3
  s_waitcnt lgkmcnt(4)
  v_smfmac_f32_16x16x64_bf16 v[64:67], v[16:19], v[92:99], v3
  ds_read_b128 v[92:95], v1 offset:10240
  ds_read_b128 v[96:99], v1 offset:11264
  v_smfmac_f32_16x16x64_bf16 v[60:63], v[32:35], v[248:255], v3
  v_smfmac_f32_16x16x64_bf16 v[36:39], v[8:11], a[0:7], v3
  s_waitcnt lgkmcnt(4)
  v_smfmac_f32_16x16x64_bf16 v[64:67], v[20:23], v[76:83], v3
  ds_read_b128 v[76:79], v1 offset:12288
  ds_read_b128 v[80:83], v1 offset:13312
  v_smfmac_f32_16x16x64_bf16 v[36:39], v[12:15], a[8:15], v3
  v_add_f32 v60, v60, v61
  v_smfmac_f32_16x16x64_bf16 v[36:39], v[16:19], a[16:23], v3
  v_add_f32 v62, v62, v63
  s_waitcnt lgkmcnt(4)
  v_smfmac_f32_16x16x64_bf16 v[64:67], v[24:27], v[84:91], v3
  v_cvt_pk_bf16_f32 v60, v60, v62
  v_smfmac_f32_16x16x64_bf16 v[36:39], v[20:23], a[24:31], v3
  ds_write_b32 v106, v60
  v_smfmac_f32_16x16x64_bf16 v[36:39], v[24:27], a[32:39], v3
  s_waitcnt lgkmcnt(2)
  v_smfmac_f32_16x16x64_bf16 v[64:67], v[28:31], v[92:99], v3
  v_smfmac_f32_16x16x64_bf16 v[36:39], v[28:31], a[40:47], v3
  v_smfmac_f32_16x16x64_bf16 v[36:39], v[32:35], a[48:55], v3
  s_waitcnt lgkmcnt(0)
  v_smfmac_f32_16x16x64_bf16 v[64:67], v[32:35], v[76:83], v3
  v_smfmac_f32_16x16x64_bf16 v[40:43], v[8:11], a[56:63], v3
  v_smfmac_f32_16x16x64_bf16 v[40:43], v[12:15], a[64:71], v3
  v_add_f32 v36, v36, v37
  v_smfmac_f32_16x16x64_bf16 v[40:43], v[16:19], a[72:79], v3
  v_add_f32 v38, v38, v39
  v_smfmac_f32_16x16x64_bf16 v[40:43], v[20:23], a[80:87], v3
  v_cvt_pk_bf16_f32 v36, v36, v38
  v_smfmac_f32_16x16x64_bf16 v[40:43], v[24:27], a[88:95], v3
  ds_write_b32 v100, v36
  v_smfmac_f32_16x16x64_bf16 v[40:43], v[28:31], a[96:103], v3
  v_add_f32 v64, v64, v65
  v_smfmac_f32_16x16x64_bf16 v[40:43], v[32:35], a[104:111], v3
  v_add_f32 v66, v66, v67
  v_smfmac_f32_16x16x64_bf16 v[44:47], v[8:11], a[112:119], v3
  v_cvt_pk_bf16_f32 v64, v64, v66
  v_smfmac_f32_16x16x64_bf16 v[44:47], v[12:15], a[120:127], v3
  ds_write_b32 v107, v64
  v_smfmac_f32_16x16x64_bf16 v[44:47], v[16:19], a[128:135], v3
  v_add_f32 v40, v40, v41
  v_smfmac_f32_16x16x64_bf16 v[44:47], v[20:23], a[136:143], v3
  v_add_f32 v42, v42, v43
  v_smfmac_f32_16x16x64_bf16 v[44:47], v[24:27], a[144:151], v3
  v_cvt_pk_bf16_f32 v40, v40, v42
  v_smfmac_f32_16x16x64_bf16 v[44:47], v[28:31], a[152:159], v3
  ds_write_b32 v101, v40
  v_smfmac_f32_16x16x64_bf16 v[44:47], v[32:35], a[160:167], v3
  v_smfmac_f32_16x16x64_bf16 v[48:51], v[8:11], a[168:175], v3
  v_smfmac_f32_16x16x64_bf16 v[48:51], v[12:15], a[176:183], v3
  v_smfmac_f32_16x16x64_bf16 v[48:51], v[16:19], a[184:191], v3
  v_add_f32 v44, v44, v45
  v_smfmac_f32_16x16x64_bf16 v[48:51], v[20:23], a[192:199], v3
  v_add_f32 v46, v46, v47
  v_smfmac_f32_16x16x64_bf16 v[48:51], v[24:27], a[200:207], v3
  v_cvt_pk_bf16_f32 v44, v44, v46
  v_smfmac_f32_16x16x64_bf16 v[48:51], v[28:31], a[208:215], v3
  ds_write_b32 v102, v44
  v_smfmac_f32_16x16x64_bf16 v[48:51], v[32:35], a[216:223], v3
  v_smfmac_f32_16x16x64_bf16 v[52:55], v[8:11], a[224:231], v3
  v_smfmac_f32_16x16x64_bf16 v[52:55], v[12:15], a[232:239], v3
  v_smfmac_f32_16x16x64_bf16 v[52:55], v[16:19], a[240:247], v3
  v_add_f32 v48, v48, v49
  v_smfmac_f32_16x16x64_bf16 v[52:55], v[20:23], a[248:255], v3
  v_add_f32 v50, v50, v51
  v_smfmac_f32_16x16x64_bf16 v[52:55], v[24:27], v[120:127], v3
  v_cvt_pk_bf16_f32 v48, v48, v50
  v_smfmac_f32_16x16x64_bf16 v[52:55], v[28:31], v[128:135], v3
  ds_write_b32 v103, v48
  v_smfmac_f32_16x16x64_bf16 v[52:55], v[32:35], v[136:143], v3
  v_smfmac_f32_16x16x64_bf16 v[56:59], v[8:11], v[144:151], v3
  v_smfmac_f32_16x16x64_bf16 v[56:59], v[12:15], v[152:159], v3
  v_smfmac_f32_16x16x64_bf16 v[56:59], v[16:19], v[160:167], v3
  v_add_f32 v52, v52, v53
  v_smfmac_f32_16x16x64_bf16 v[56:59], v[20:23], v[168:175], v3
  v_add_f32 v54, v54, v55
  v_smfmac_f32_16x16x64_bf16 v[56:59], v[24:27], v[176:183], v3
  v_cvt_pk_bf16_f32 v52, v52, v54
  v_smfmac_f32_16x16x64_bf16 v[56:59], v[28:31], v[184:191], v3
  ds_write_b32 v104, v52
  v_smfmac_f32_16x16x64_bf16 v[56:59], v[32:35], v[192:199], v3
  s_nop 7
  v_add_f32 v56, v56, v57
  v_add_f32 v58, v58, v59
  v_cvt_pk_bf16_f32 v56, v56, v58
  ds_write_b32 v105, v56
  s_waitcnt lgkmcnt(0)
  s_barrier
  s_cmp_eq_u32 s19, 62
  s_cbranch_scc1 cA_done
  s_waitcnt vmcnt(0) lgkmcnt(0)
  s_add_u32 s19, s19, 1
  s_mov_b32 s20, s21
  s_branch cA_va2_loop
cA_va2_retry:
  s_waitcnt lgkmcnt(0)
  buffer_load_dwordx4 v[8:11], v2, s[8:11], s20 offen offset:0 sc1
  buffer_load_dwordx4 v[12:15], v2, s[8:11], s20 offen offset:1024 sc1
  buffer_load_dwordx4 v[16:19], v2, s[8:11], s20 offen offset:2048 sc1
  buffer_load_dwordx4 v[20:23], v2, s[8:11], s20 offen offset:3072 sc1
  s_add_u32 s31, s31, 1
  s_add_u32 s30, s30, 1
  s_cmp_lt_u32 s30, 400000
  s_cbranch_scc1 cA_va2_ld
  s_branch cA_abort
cA_va2_last:
  s_waitcnt lgkmcnt(0)
  buffer_store_dwordx4 v[100:103], v2, s[8:11], s24 offen offset:0 sc1
  buffer_store_dwordx4 v[104:107], v2, s[8:11], s24 offen offset:1024 sc1
  buffer_store_dwordx4 v[108:111], v2, s[8:11], s24 offen offset:2048 sc1
  buffer_store_dwordx4 v[4:7], v2, s[8:11], s24 offen offset:3072 sc1
  s_add_u32 s24, s24, 8192
  s_waitcnt vmcnt(0)
  s_mov_b64 exec, 1
  buffer_store_dword v117, v2, s[8:11], s34 offen sc1
  s_mov_b64 exec, -1
  s_add_u32 s34, s34, 8
  s_mov_b64 exec, 1
  buffer_store_dword v117, v2, s[8:11], s34 offen sc1
  s_mov_b64 exec, -1
  s_add_u32 s34, s34, 8
  s_branch cA_done
.p2align 6

cA_va3_loop:
  s_add_u32 s23, s20, 4096
  s_add_u32 s21, s20, 20480
  v_mov_b32 v36, 0
  v_mov_b32 v37, 0
  v_mov_b32 v38, 0
  v_mov_b32 v39, 0
  v_mov_b32 v40, 0
  v_mov_b32 v41, 0
  v_mov_b32 v42, 0
  v_mov_b32 v43, 0
  v_mov_b32 v44, 0
  v_mov_b32 v45, 0
  v_mov_b32 v46, 0
  v_mov_b32 v47, 0
  v_mov_b32 v48, 0
  v_mov_b32 v49, 0
  v_mov_b32 v50, 0
  v_mov_b32 v51, 0
  v_mov_b32 v52, 0
  v_mov_b32 v53, 0
  v_mov_b32 v54, 0
  v_mov_b32 v55, 0
  v_mov_b32 v56, 0
  v_mov_b32 v57, 0
  v_mov_b32 v58, 0
  v_mov_b32 v59, 0
  v_mov_b32 v60, 0
  v_mov_b32 v61, 0
  v_mov_b32 v62, 0
  v_mov_b32 v63, 0
  v_mov_b32 v64, 0
  v_mov_b32 v65, 0
  v_mov_b32 v66, 0
  v_mov_b32 v67, 0
  s_mov_b32 s30, 0
  buffer_load_dword v76, v119, s[8:11], s20 offen sc1
  buffer_load_dword v77, v119, s[8:11], s20 offen sc1
  buffer_load_dword v78, v119, s[8:11], s20 offen sc1
cA_va3_fp_l:
  s_waitcnt vmcnt(2)
  v_cmp_eq_u32 vcc, -1, v76
  s_cbranch_vccz cA_va3_fp_d
  buffer_load_dword v76, v119, s[8:11], s20 offen sc1
  s_waitcnt vmcnt(2)
  v_cmp_eq_u32 vcc, -1, v77
  s_cbranch_vccz cA_va3_fp_d
  buffer_load_dword v77, v119, s[8:11], s20 offen sc1
  s_waitcnt vmcnt(2)
  v_cmp_eq_u32 vcc, -1, v78
  s_cbranch_vccz cA_va3_fp_d
  buffer_load_dword v78, v119, s[8:11], s20 offen sc1
  s_add_u32 s30, s30, 1
  s_cmp_lt_u32 s30, 400000
  s_cbranch_scc1 cA_va3_fp_l
  s_branch cA_abort
cA_va3_fp_d:
  buffer_load_dwordx4 v[24:27], v2, s[8:11], s23 offen offset:0 sc1
  buffer_load_dwordx4 v[28:31], v2, s[8:11], s23 offen offset:1024 sc1
  buffer_load_dwordx4 v[32:35], v2, s[8:11], s23 offen offset:2048 sc1
  s_barrier
cA_va3_ld:
  s_waitcnt vmcnt(0)
  v_max3_u32 v84, v24, v25, v26
  v_max3_u32 v84, v84, v27, v28
  v_max3_u32 v84, v84, v29, v30
  v_max3_u32 v84, v84, v31, v32
  v_max3_u32 v84, v84, v33, v34
  v_max_u32 v84, v84, v35
  v_cmp_eq_u32 vcc, -1, v84
  ds_write_b128 v2, v[24:27] offset:12288
  ds_write_b128 v2, v[28:31] offset:13312
  ds_write_b128 v2, v[32:35] offset:14336
  s_cbranch_vccnz cA_va3_retry
  s_waitcnt lgkmcnt(0)
  s_barrier
  ds_read_b128 v[8:11], v5 offset:8192
  ds_read_b128 v[12:15], v5 offset:9216
  ds_read_b128 v[16:19], v5 offset:10240
  ds_read_b128 v[20:23], v5 offset:11264
  ds_read_b128 v[24:27], v5 offset:12288
  ds_read_b128 v[28:31], v5 offset:13312
  ds_read_b128 v[32:35], v5 offset:14336
  s_waitcnt lgkmcnt(0)
  s_cmp_eq_u32 s19, 63
  s_cbranch_scc1 cA_done
  ds_read_b128 v[76:79], v1 offset:0
  ds_read_b128 v[80:83], v1 offset:1024
  ds_read_b128 v[84:87], v1 offset:2048
  ds_read_b128 v[88:91], v1 offset:3072
  ds_read_b128 v[92:95], v1 offset:4096
  ds_read_b128 v[96:99], v1 offset:5120
  v_smfmac_f32_16x16x64_bf16 v[60:63], v[8:11], v[200:207], v3
  v_smfmac_f32_16x16x64_bf16 v[60:63], v[12:15], v[208:215], v3
  s_waitcnt lgkmcnt(4)
  v_smfmac_f32_16x16x64_bf16 v[64:67], v[8:11], v[76:83], v3
  ds_read_b128 v[76:79], v1 offset:6144
  ds_read_b128 v[80:83], v1 offset:7168
  v_smfmac_f32_16x16x64_bf16 v[60:63], v[16:19], v[216:223], v3
  v_smfmac_f32_16x16x64_bf16 v[60:63], v[20:23], v[224:231], v3
  s_waitcnt lgkmcnt(4)
  v_smfmac_f32_16x16x64_bf16 v[64:67], v[12:15], v[84:91], v3
  ds_read_b128 v[84:87], v1 offset:8192
  ds_read_b128 v[88:91], v1 offset:9216
  v_smfmac_f32_16x16x64_bf16 v[60:63], v[24:27], v[232:239], v3
  v_smfmac_f32_16x16x64_bf16 v[60:63], v[28:31], v[240:247], v3
  s_waitcnt lgkmcnt(4)
  v_smfmac_f32_16x16x64_bf16 v[64:67], v[16:19], v[92:99], v3
  ds_read_b128 v[92:95], v1 offset:10240
  ds_read_b128 v[96:99], v1 offset:11264
  v_smfmac_f32_16x16x64_bf16 v[60:63], v[32:35], v[248:255], v3
  v_smfmac_f32_16x16x64_bf16 v[36:39], v[8:11], a[0:7], v3
  s_waitcnt lgkmcnt(4)
  v_smfmac_f32_16x16x64_bf16 v[64:67], v[20:23], v[76:83], v3
  ds_read_b128 v[76:79], v1 offset:12288
  ds_read_b128 v[80:83], v1 offset:13312
  v_smfmac_f32_16x16x64_bf16 v[36:39], v[12:15], a[8:15], v3
  v_add_f32 v60, v60, v61
  v_smfmac_f32_16x16x64_bf16 v[36:39], v[16:19], a[16:23], v3
  v_add_f32 v62, v62, v63
  s_waitcnt lgkmcnt(4)
  v_smfmac_f32_16x16x64_bf16 v[64:67], v[24:27], v[84:91], v3
  v_cvt_pk_bf16_f32 v60, v60, v62
  v_smfmac_f32_16x16x64_bf16 v[36:39], v[20:23], a[24:31], v3
  ds_write_b32 v106, v60
  v_smfmac_f32_16x16x64_bf16 v[36:39], v[24:27], a[32:39], v3
  s_waitcnt lgkmcnt(2)
  v_smfmac_f32_16x16x64_bf16 v[64:67], v[28:31], v[92:99], v3
  v_smfmac_f32_16x16x64_bf16 v[36:39], v[28:31], a[40:47], v3
  v_smfmac_f32_16x16x64_bf16 v[36:39], v[32:35], a[48:55], v3
  s_waitcnt lgkmcnt(0)
  v_smfmac_f32_16x16x64_bf16 v[64:67], v[32:35], v[76:83], v3
  v_smfmac_f32_16x16x64_bf16 v[40:43], v[8:11], a[56:63], v3
  v_smfmac_f32_16x16x64_bf16 v[40:43], v[12:15], a[64:71], v3
  v_add_f32 v36, v36, v37
  v_smfmac_f32_16x16x64_bf16 v[40:43], v[16:19], a[72:79], v3
  v_add_f32 v38, v38, v39
  v_smfmac_f32_16x16x64_bf16 v[40:43], v[20:23], a[80:87], v3
  v_cvt_pk_bf16_f32 v36, v36, v38
  v_smfmac_f32_16x16x64_bf16 v[40:43], v[24:27], a[88:95], v3
  ds_write_b32 v100, v36
  v_smfmac_f32_16x16x64_bf16 v[40:43], v[28:31], a[96:103], v3
  v_add_f32 v64, v64, v65
  v_smfmac_f32_16x16x64_bf16 v[40:43], v[32:35], a[104:111], v3
  v_add_f32 v66, v66, v67
  v_smfmac_f32_16x16x64_bf16 v[44:47], v[8:11], a[112:119], v3
  v_cvt_pk_bf16_f32 v64, v64, v66
  v_smfmac_f32_16x16x64_bf16 v[44:47], v[12:15], a[120:127], v3
  ds_write_b32 v107, v64
  v_smfmac_f32_16x16x64_bf16 v[44:47], v[16:19], a[128:135], v3
  v_add_f32 v40, v40, v41
  v_smfmac_f32_16x16x64_bf16 v[44:47], v[20:23], a[136:143], v3
  v_add_f32 v42, v42, v43
  v_smfmac_f32_16x16x64_bf16 v[44:47], v[24:27], a[144:151], v3
  v_cvt_pk_bf16_f32 v40, v40, v42
  v_smfmac_f32_16x16x64_bf16 v[44:47], v[28:31], a[152:159], v3
  ds_write_b32 v101, v40
  v_smfmac_f32_16x16x64_bf16 v[44:47], v[32:35], a[160:167], v3
  v_smfmac_f32_16x16x64_bf16 v[48:51], v[8:11], a[168:175], v3
  v_smfmac_f32_16x16x64_bf16 v[48:51], v[12:15], a[176:183], v3
  v_smfmac_f32_16x16x64_bf16 v[48:51], v[16:19], a[184:191], v3
  v_add_f32 v44, v44, v45
  v_smfmac_f32_16x16x64_bf16 v[48:51], v[20:23], a[192:199], v3
  v_add_f32 v46, v46, v47
  v_smfmac_f32_16x16x64_bf16 v[48:51], v[24:27], a[200:207], v3
  v_cvt_pk_bf16_f32 v44, v44, v46
  v_smfmac_f32_16x16x64_bf16 v[48:51], v[28:31], a[208:215], v3
  ds_write_b32 v102, v44
  v_smfmac_f32_16x16x64_bf16 v[48:51], v[32:35], a[216:223], v3
  v_smfmac_f32_16x16x64_bf16 v[52:55], v[8:11], a[224:231], v3
  v_smfmac_f32_16x16x64_bf16 v[52:55], v[12:15], a[232:239], v3
  v_smfmac_f32_16x16x64_bf16 v[52:55], v[16:19], a[240:247], v3
  v_add_f32 v48, v48, v49
  v_smfmac_f32_16x16x64_bf16 v[52:55], v[20:23], a[248:255], v3
  v_add_f32 v50, v50, v51
  v_smfmac_f32_16x16x64_bf16 v[52:55], v[24:27], v[120:127], v3
  v_cvt_pk_bf16_f32 v48, v48, v50
  v_smfmac_f32_16x16x64_bf16 v[52:55], v[28:31], v[128:135], v3
  ds_write_b32 v103, v48
  v_smfmac_f32_16x16x64_bf16 v[52:55], v[32:35], v[136:143], v3
  v_smfmac_f32_16x16x64_bf16 v[56:59], v[8:11], v[144:151], v3
  v_smfmac_f32_16x16x64_bf16 v[56:59], v[12:15], v[152:159], v3
  v_smfmac_f32_16x16x64_bf16 v[56:59], v[16:19], v[160:167], v3
  v_add_f32 v52, v52, v53
  v_smfmac_f32_16x16x64_bf16 v[56:59], v[20:23], v[168:175], v3
  v_add_f32 v54, v54, v55
  v_smfmac_f32_16x16x64_bf16 v[56:59], v[24:27], v[176:183], v3
  v_cvt_pk_bf16_f32 v52, v52, v54
  v_smfmac_f32_16x16x64_bf16 v[56:59], v[28:31], v[184:191], v3
  ds_write_b32 v104, v52
  v_smfmac_f32_16x16x64_bf16 v[56:59], v[32:35], v[192:199], v3
  s_nop 7
  v_add_f32 v56, v56, v57
  v_add_f32 v58, v58, v59
  v_cvt_pk_bf16_f32 v56, v56, v58
  ds_write_b32 v105, v56
  s_waitcnt lgkmcnt(0)
  s_barrier
  s_cmp_eq_u32 s19, 62
  s_cbranch_scc1 cA_done
  s_waitcnt vmcnt(0) lgkmcnt(0)
  s_add_u32 s19, s19, 1
  s_mov_b32 s20, s21
  s_branch cA_va3_loop
cA_va3_retry:
  s_waitcnt lgkmcnt(0)
  buffer_load_dwordx4 v[24:27], v2, s[8:11], s23 offen offset:0 sc1
  buffer_load_dwordx4 v[28:31], v2, s[8:11], s23 offen offset:1024 sc1
  buffer_load_dwordx4 v[32:35], v2, s[8:11], s23 offen offset:2048 sc1
  s_add_u32 s31, s31, 1
  s_add_u32 s30, s30, 1
  s_cmp_lt_u32 s30, 400000
  s_cbranch_scc1 cA_va3_ld
  s_branch cA_abort
cA_va3_last:
  s_waitcnt lgkmcnt(0)
  buffer_store_dwordx4 v[100:103], v2, s[8:11], s24 offen offset:0 sc1
  buffer_store_dwordx4 v[104:107], v2, s[8:11], s24 offen offset:1024 sc1
  buffer_store_dwordx4 v[108:111], v2, s[8:11], s24 offen offset:2048 sc1
  buffer_store_dwordx4 v[4:7], v2, s[8:11], s24 offen offset:3072 sc1
  s_add_u32 s24, s24, 8192
  s_waitcnt vmcnt(0)
  s_mov_b64 exec, 1
  buffer_store_dword v117, v2, s[8:11], s34 offen sc1
  s_mov_b64 exec, -1
  s_add_u32 s34, s34, 8
  s_mov_b64 exec, 1
  buffer_store_dword v117, v2, s[8:11], s34 offen sc1
  s_mov_b64 exec, -1
  s_add_u32 s34, s34, 8
  s_branch cA_done
cA_abort:
  v_mov_b32 v4, 0xdead
  v_mov_b32 v5, 16
  buffer_store_dword v4, v5, s[12:15], 0 offen
  s_branch ch_end
cA_done:
  s_branch ch_end
.p2align 6

cB_sc0_loop:
  s_add_u32 s23, s20, 4096
  s_add_u32 s21, s20, 20480
  s_mov_b32 s30, 0
  s_mov_b32 s62, 0
  buffer_load_dword v68, v0, s[8:11], s20 offen sc1
  v_mov_b32 v48, 0
  v_mov_b32 v49, 0
  v_mov_b32 v50, 0
  v_mov_b32 v51, 0
  v_mov_b32 v52, 0
  v_mov_b32 v53, 0
  v_mov_b32 v54, 0
  v_mov_b32 v55, 0
  buffer_load_dword v69, v0, s[8:11], s20 offen sc1
  v_mov_b32 v56, 0
  v_mov_b32 v57, 0
  v_mov_b32 v58, 0
  v_mov_b32 v59, 0
  v_mov_b32 v60, 0
  v_mov_b32 v61, 0
  v_mov_b32 v62, 0
  v_mov_b32 v63, 0
  buffer_load_dword v70, v0, s[8:11], s20 offen sc1
  v_mov_b32 v88, 0
  v_mov_b32 v89, 0
  v_mov_b32 v90, 0
  v_mov_b32 v91, 0
  v_mov_b32 v92, 0
  v_mov_b32 v93, 0
  v_mov_b32 v94, 0
  v_mov_b32 v95, 0
  buffer_load_dword v71, v0, s[8:11], s20 offen sc1
  v_mov_b32 v66, 0
  v_mov_b32 v67, 0
  buffer_load_dword v72, v0, s[8:11], s20 offen sc1
cB_sc0_fp_l:
  s_waitcnt vmcnt(4)
  v_cmp_eq_u32 vcc, -1, v68
  s_cbranch_vccz cB_sc0_fp_d
  buffer_load_dword v68, v0, s[8:11], s20 offen sc1
  s_waitcnt vmcnt(4)
  v_cmp_eq_u32 vcc, -1, v69
  s_cbranch_vccz cB_sc0_fp_d
  buffer_load_dword v69, v0, s[8:11], s20 offen sc1
  s_waitcnt vmcnt(4)
  v_cmp_eq_u32 vcc, -1, v70
  s_cbranch_vccz cB_sc0_fp_d
  buffer_load_dword v70, v0, s[8:11], s20 offen sc1
  s_waitcnt vmcnt(4)
  v_cmp_eq_u32 vcc, -1, v71
  s_cbranch_vccz cB_sc0_fp_d
  buffer_load_dword v71, v0, s[8:11], s20 offen sc1
  s_waitcnt vmcnt(4)
  v_cmp_eq_u32 vcc, -1, v72
  s_cbranch_vccz cB_sc0_fp_d
  buffer_load_dword v72, v0, s[8:11], s20 offen sc1
  s_add_u32 s30, s30, 1
  s_cmp_lt_u32 s30, 400000
  s_cbranch_scc1 cB_sc0_fp_l
  s_branch cB_abort
cB_sc0_fp_d:
  buffer_load_dwordx4 v[8:11], v2, s[8:11], s20 offen offset:0 sc1
  s_barrier
  s_branch cB_sc0_ld1
cB_sc0_ld:
  buffer_load_dwordx4 v[8:11], v2, s[8:11], s20 offen offset:0 sc1
cB_sc0_ld1:
  v_mov_b32 v36, 0
  v_mov_b32 v37, 0
  v_mov_b32 v38, 0
  v_mov_b32 v39, 0
  buffer_load_dwordx4 v[12:15], v2, s[8:11], s20 offen offset:1024 sc1
  v_mov_b32 v40, 0
  v_mov_b32 v41, 0
  v_mov_b32 v42, 0
  v_mov_b32 v43, 0
  buffer_load_dwordx4 v[16:19], v2, s[8:11], s20 offen offset:2048 sc1
  v_mov_b32 v44, 0
  v_mov_b32 v45, 0
  v_mov_b32 v46, 0
  v_mov_b32 v47, 0
  ds_read_b128 v[96:99], v117 offset:0
  ds_read_b128 v[100:103], v117 offset:1024
  ds_read_b128 v[104:107], v117 offset:14336
  ds_read_b128 v[108:111], v117 offset:15360
  s_waitcnt vmcnt(2)
  v_smfmac_f32_16x16x64_bf16 v[36:39], v[8:11], a[0:7], v3
  v_smfmac_f32_16x16x64_bf16 v[40:43], v[8:11], a[56:63], v3
  buffer_load_dwordx4 v[20:23], v2, s[8:11], s20 offen offset:3072 sc1
  v_smfmac_f32_16x16x64_bf16 v[44:47], v[8:11], a[112:119], v3
  v_smfmac_f32_16x16x64_bf16 v[48:51], v[8:11], a[168:175], v3
  v_smfmac_f32_16x16x64_bf16 v[52:55], v[8:11], a[224:231], v3
  buffer_load_dwordx4 v[24:27], v2, s[8:11], s23 offen offset:0 sc1
  v_smfmac_f32_16x16x64_bf16 v[56:59], v[8:11], v[144:151], v3
  v_smfmac_f32_16x16x64_bf16 v[60:63], v[8:11], v[200:207], v3
  s_waitcnt vmcnt(3)
  v_smfmac_f32_16x16x64_bf16 v[36:39], v[12:15], a[8:15], v3
  v_smfmac_f32_16x16x64_bf16 v[40:43], v[12:15], a[64:71], v3
  buffer_load_dwordx4 v[28:31], v2, s[8:11], s23 offen offset:1024 sc1
  v_smfmac_f32_16x16x64_bf16 v[44:47], v[12:15], a[120:127], v3
  v_smfmac_f32_16x16x64_bf16 v[48:51], v[12:15], a[176:183], v3
  v_smfmac_f32_16x16x64_bf16 v[52:55], v[12:15], a[232:239], v3
  buffer_load_dwordx4 v[32:35], v2, s[8:11], s23 offen offset:2048 sc1
  v_smfmac_f32_16x16x64_bf16 v[56:59], v[12:15], v[152:159], v3
  v_smfmac_f32_16x16x64_bf16 v[60:63], v[12:15], v[208:215], v3
  s_xor_b32 s58, s25, 28672
  s_add_u32 s59, s24, 28672
  s_add_u32 m0, s58, 0
  s_waitcnt vmcnt(4)
  v_smfmac_f32_16x16x64_bf16 v[36:39], v[16:19], a[16:23], v3
  buffer_load_dwordx4 v2, s[8:11], s59 offen offset:0 sc1 lds
  v_smfmac_f32_16x16x64_bf16 v[40:43], v[16:19], a[72:79], v3
  v_smfmac_f32_16x16x64_bf16 v[44:47], v[16:19], a[128:135], v3
  v_smfmac_f32_16x16x64_bf16 v[48:51], v[16:19], a[184:191], v3
  v_smfmac_f32_16x16x64_bf16 v[52:55], v[16:19], a[240:247], v3
  buffer_load_dwordx4 v2, s[8:11], s59 offen offset:1024 sc1 lds
  v_smfmac_f32_16x16x64_bf16 v[56:59], v[16:19], v[160:167], v3
  v_smfmac_f32_16x16x64_bf16 v[60:63], v[16:19], v[216:223], v3
  s_waitcnt vmcnt(5)
  v_smfmac_f32_16x16x64_bf16 v[36:39], v[20:23], a[24:31], v3
  v_smfmac_f32_16x16x64_bf16 v[40:43], v[20:23], a[80:87], v3
  buffer_load_dwordx4 v2, s[8:11], s59 offen offset:2048 sc1 lds
  v_smfmac_f32_16x16x64_bf16 v[44:47], v[20:23], a[136:143], v3
  v_smfmac_f32_16x16x64_bf16 v[48:51], v[20:23], a[192:199], v3
  v_smfmac_f32_16x16x64_bf16 v[52:55], v[20:23], a[248:255], v3
  v_smfmac_f32_16x16x64_bf16 v[56:59], v[20:23], v[168:175], v3
  buffer_load_dwordx4 v2, s[8:11], s59 offen offset:3072 sc1 lds
  v_smfmac_f32_16x16x64_bf16 v[60:63], v[20:23], v[224:231], v3
  s_waitcnt vmcnt(4)
cB_sc0_ph2:
  v_smfmac_f32_16x16x64_bf16 v[60:63], v[24:27], v[232:239], v3
  ds_read_b128 v[12:15], v116 offset:0
  ds_read_b128 v[16:19], v116 offset:1024
  v_smfmac_f32_16x16x64_bf16 v[60:63], v[28:31], v[240:247], v3
  v_smfmac_f32_16x16x64_bf16 v[60:63], v[32:35], v[248:255], v3
  v_mov_b32 v80, v24
  v_smfmac_f32_16x16x64_bf16 v[52:55], v[24:27], v[120:127], v3
  v_mov_b32 v81, v25
  v_smfmac_f32_16x16x64_bf16 v[52:55], v[28:31], v[128:135], v3
  v_mov_b32 v82, v32
  v_smfmac_f32_16x16x64_bf16 v[52:55], v[32:35], v[136:143], v3
  v_cvt_pk_bf16_f32 v64, v60, v61
  v_smfmac_f32_16x16x64_bf16 v[56:59], v[24:27], v[176:183], v3
  v_cvt_pk_bf16_f32 v65, v62, v63
  v_smfmac_f32_16x16x64_bf16 v[56:59], v[28:31], v[184:191], v3
  v_mov_b32 v83, v33
  v_mfma_f32_16x16x32_bf16 v[68:71], v[64:67], v[4:7], 0
  v_smfmac_f32_16x16x64_bf16 v[56:59], v[32:35], v[192:199], v3
  v_cvt_pk_bf16_f32 v64, v52, v53
  v_smfmac_f32_16x16x64_bf16 v[36:39], v[24:27], a[32:39], v3
  v_cvt_pk_bf16_f32 v65, v54, v55
  v_smfmac_f32_16x16x64_bf16 v[36:39], v[28:31], a[40:47], v3
  v_cvt_pk_bf16_f32 v78, v68, v69
  v_smfmac_f32_16x16x64_bf16 v[36:39], v[32:35], a[48:55], v3
  v_cvt_pk_bf16_f32 v79, v70, v71
  v_cvt_pk_bf16_f32 v66, v56, v57
  v_smfmac_f32_16x16x64_bf16 v[40:43], v[24:27], a[88:95], v3
  v_cvt_pk_bf16_f32 v67, v58, v59
  v_smfmac_f32_16x16x64_bf16 v[40:43], v[28:31], a[96:103], v3
  v_mfma_f32_16x16x32_bf16 v[72:75], v[64:67], v[4:7], 0
  ds_read_b128 v[52:55], v116 offset:14336
  ds_read_b128 v[56:59], v116 offset:15360
  v_smfmac_f32_16x16x64_bf16 v[40:43], v[32:35], a[104:111], v3
  v_cvt_pk_bf16_f32 v64, v36, v37
  v_smfmac_f32_16x16x64_bf16 v[44:47], v[24:27], a[144:151], v3
  v_cvt_pk_bf16_f32 v65, v38, v39
  v_smfmac_f32_16x16x64_bf16 v[44:47], v[28:31], a[152:159], v3
  v_cvt_pk_bf16_f32 v76, v72, v73
  v_smfmac_f32_16x16x64_bf16 v[44:47], v[32:35], a[160:167], v3
  v_cvt_pk_bf16_f32 v77, v74, v75
  v_cvt_pk_bf16_f32 v66, v40, v41
  v_smfmac_f32_16x16x64_bf16 v[48:51], v[24:27], a[200:207], v3
  v_cvt_pk_bf16_f32 v67, v42, v43
  v_smfmac_f32_16x16x64_bf16 v[48:51], v[28:31], a[208:215], v3
  v_mfma_f32_16x16x32_bf16 v[68:71], v[64:67], v[4:7], 0
  v_smfmac_f32_16x16x64_bf16 v[48:51], v[32:35], a[216:223], v3
  v_cvt_pk_bf16_f32 v64, v44, v45
  v_mfma_f32_16x16x32_bf16 v[84:87], v[80:83], v[76:79], 0
  v_cvt_pk_bf16_f32 v65, v46, v47
  s_waitcnt lgkmcnt(0)
  v_smfmac_f32_16x16x64_bf16 v[88:91], v[76:79], v[96:103], v118
  v_cvt_pk_bf16_f32 v60, v68, v69
  v_cvt_pk_bf16_f32 v61, v70, v71
  v_cvt_pk_bf16_f32 v66, v48, v49
  v_cvt_pk_bf16_f32 v67, v50, v51
  s_nop 1
  v_mfma_f32_16x16x32_bf16 v[72:75], v[64:67], v[4:7], 0
  v_smfmac_f32_16x16x64_bf16 v[92:95], v[76:79], v[104:111], v118
  s_nop 4
  v_cvt_pk_bf16_f32 v62, v72, v73
  v_cvt_pk_bf16_f32 v63, v74, v75
  s_nop 1
  v_mfma_f32_16x16x32_bf16 v[84:87], v[8:11], v[60:63], v[84:87]
  v_smfmac_f32_16x16x64_bf16 v[88:91], v[60:63], v[12:19], v118
  v_smfmac_f32_16x16x64_bf16 v[92:95], v[60:63], v[52:59], v118
  s_nop 1
  v_permlane32_swap_b32 v84, v86
  v_permlane32_swap_b32 v85, v87
  s_nop 0
  v_add_f32 v88, v88, v89
  v_add_f32_dpp v84, v86, v84 quad_perm:[1,0,3,2] row_mask:0xf bank_mask:0xf
  v_add_f32_dpp v85, v87, v85 quad_perm:[1,0,3,2] row_mask:0xf bank_mask:0xf
  v_add_f32 v89, v90, v91
  ds_write2_b32 v113, v84, v85 offset0:0 offset1:4
  ds_write2_b32 v112, v88, v89 offset0:0 offset1:128
  v_add_f32 v90, v92, v93
  v_add_f32 v91, v94, v95
  ds_write2_b32 v112, v90, v91 offset0:64 offset1:192
  v_cmp_u_f32 vcc, v88, v89
  s_cbranch_vccnz cB_sc0_retry
cB_sc0_cont:
  s_waitcnt lgkmcnt(0)
  s_barrier
  ds_read_b128 v[36:39], v114
  ds_read_b128 v[44:47], v115
  s_waitcnt lgkmcnt(0)
  v_add_f32 v36, v36, v38
  v_add_f32 v37, v37, v39
  v_add_f32 v44, v44, v45
  buffer_store_dword v2, v119, s[8:11], s20 offen sc1
  v_add_f32 v46, v46, v47
  v_add_f32 v44, v44, v46
  v_add_f32 v36, v36, v37
  v_exp_f32 v49, v44
  v_exp_f32 v48, v36
  v_add_f32 v50, abs(v36), abs(v44)
  v_fma_f32 v39, v49, s37, v48
  v_cmp_ngt_f32 vcc, s56, v50
  v_cndmask_b32 v41, v48, v49, s[38:39]
  v_add_f32_dpp v39, v39, v39 quad_perm:[1,0,3,2] row_mask:0xf bank_mask:0xf
  v_cndmask_b32 v40, v49, v48, s[38:39]
  v_mov_b32_dpp v46, v41 quad_perm:[1,0,3,2] row_mask:0xf bank_mask:0xf
  v_add_f32_dpp v39, v39, v39 quad_perm:[2,3,0,1] row_mask:0xf bank_mask:0xf
  v_cndmask_b32 v42, v46, v40, s[38:39]
  v_cndmask_b32 v43, v40, v46, s[38:39]
  v_add_f32_dpp v39, v39, v39 row_half_mirror row_mask:0xf bank_mask:0xf
  s_cbranch_vccnz cB_sc0_slow
  s_nop 0
  v_add_f32_dpp v47, v39, v39 row_mirror row_mask:0xf bank_mask:0xf
  v_add_f32_dpp v39, v39, v39 row_mirror row_mask:0xf bank_mask:0xf
  s_nop 1
  v_permlane16_swap_b32 v39, v47
  v_add_f32 v39, v39, v47
  v_rcp_f32 v39, v39
  s_mov_b64 exec, s[28:29]
  v_mul_f32 v42, v42, v39
  v_mul_f32 v43, v43, v39
  v_cvt_pk_bf16_f32 v42, v42, v43
cB_sc0_pst:
  buffer_store_dword v42, v1, s[8:11], s20 offen sc1
  s_mov_b64 exec, -1
  s_barrier
  s_cmp_lg_u32 s19, 0
  s_cbranch_scc1 cB_sc0_s0
  s_sub_u32 s36, s36, 64
  v_subrev_u32 v119, 64, v119
  v_lshl_add_u32 v56, v2, 3, s36
  s_mov_b64 exec, 15
  buffer_store_dword v2, v56, s[8:11], s20 offen sc1
  s_mov_b64 exec, -1
cB_sc0_s0:
  s_add_u32 s24, s24, 28672
  s_add_u32 s35, s35, 28672
  s_xor_b32 s25, s25, 28672
  s_add_u32 m0, s25, 0
  s_add_u32 m0, s25, 4096
  s_add_u32 s22, s24, 4096
  buffer_load_dwordx4 v2, s[8:11], s22 offen offset:0 sc1 lds
  buffer_load_dwordx4 v2, s[8:11], s22 offen offset:1024 sc1 lds
  buffer_load_dwordx4 v2, s[8:11], s22 offen offset:2048 sc1 lds
  v_xor_b32 v116, 28672, v116
  v_add_u32 v117, s57, v117
  s_sub_u32 s57, 0, s57
  s_add_u32 s19, s19, 1
  s_mov_b32 s20, s21
  s_cmp_lt_u32 s19, 63
  s_cbranch_scc1 cB_sc0_loop
  s_branch cB_done
cB_sc0_slow:
  v_max_f32 v50, v36, v44
  s_nop 1
  v_max_f32_dpp v50, v50, v50 quad_perm:[1,0,3,2] row_mask:0xf bank_mask:0xf
  s_nop 1
  v_max_f32_dpp v50, v50, v50 quad_perm:[2,3,0,1] row_mask:0xf bank_mask:0xf
  s_nop 1
  v_max_f32_dpp v50, v50, v50 row_half_mirror row_mask:0xf bank_mask:0xf
  s_nop 1
  v_max_f32_dpp v50, v50, v50 row_mirror row_mask:0xf bank_mask:0xf
  v_mov_b32 v47, v50
  s_nop 1
  v_permlane16_swap_b32 v50, v47
  v_max_f32 v50, v50, v47
  v_sub_f32 v48, v36, v50
  v_sub_f32 v49, v44, v50
  v_exp_f32 v48, v48
  v_exp_f32 v49, v49
  s_add_u32 s31, s31, 0x100
  v_fma_f32 v39, v49, s37, v48
  v_cndmask_b32 v41, v48, v49, s[38:39]
  s_nop 0
  v_add_f32_dpp v39, v39, v39 quad_perm:[1,0,3,2] row_mask:0xf bank_mask:0xf
  v_cndmask_b32 v40, v49, v48, s[38:39]
  v_mov_b32_dpp v46, v41 quad_perm:[1,0,3,2] row_mask:0xf bank_mask:0xf
  v_add_f32_dpp v39, v39, v39 quad_perm:[2,3,0,1] row_mask:0xf bank_mask:0xf
  v_cndmask_b32 v42, v46, v40, s[38:39]
  v_cndmask_b32 v43, v40, v46, s[38:39]
  v_add_f32_dpp v39, v39, v39 row_half_mirror row_mask:0xf bank_mask:0xf
  s_nop 1
  v_add_f32_dpp v47, v39, v39 row_mirror row_mask:0xf bank_mask:0xf
  v_add_f32_dpp v39, v39, v39 row_mirror row_mask:0xf bank_mask:0xf
  s_nop 1
  v_permlane16_swap_b32 v39, v47
  v_add_f32 v39, v39, v47
  v_rcp_f32 v39, v39
  s_mov_b64 exec, s[28:29]
  v_mul_f32 v42, v42, v39
  v_mul_f32 v43, v43, v39
  v_cvt_pk_bf16_f32 v42, v42, v43
  v_min_u32 v42, -2, v42
  s_branch cB_sc0_pst
cB_sc0_retry:
  s_cmp_lg_u32 s62, 0
  s_cbranch_scc1 cB_sc0_cont
  s_waitcnt vmcnt(0) lgkmcnt(0)
cB_sc0_rv:
  buffer_load_dwordx4 v[8:11], v2, s[8:11], s20 offen offset:0 sc1
  buffer_load_dwordx4 v[12:15], v2, s[8:11], s20 offen offset:1024 sc1
  buffer_load_dwordx4 v[16:19], v2, s[8:11], s20 offen offset:2048 sc1
  buffer_load_dwordx4 v[20:23], v2, s[8:11], s20 offen offset:3072 sc1
  buffer_load_dwordx4 v[24:27], v2, s[8:11], s23 offen offset:0 sc1
  buffer_load_dwordx4 v[28:31], v2, s[8:11], s23 offen offset:1024 sc1
  buffer_load_dwordx4 v[32:35], v2, s[8:11], s23 offen offset:2048 sc1
  s_waitcnt vmcnt(0)
  v_max3_u32 v68, v8, v9, v10
  v_max3_u32 v68, v68, v11, v12
  v_max3_u32 v68, v68, v13, v14
  v_max3_u32 v68, v68, v15, v16
  v_max3_u32 v68, v68, v17, v18
  v_max3_u32 v68, v68, v19, v20
  v_max3_u32 v68, v68, v21, v22
  v_max3_u32 v68, v68, v23, v24
  v_max3_u32 v68, v68, v25, v26
  v_max3_u32 v68, v68, v27, v28
  v_max3_u32 v68, v68, v29, v30
  v_max3_u32 v68, v68, v31, v32
  v_max3_u32 v68, v68, v33, v34
  v_max_u32 v68, v68, v35
  v_cmp_eq_u32 vcc, -1, v68
  s_cbranch_vccz cB_sc0_rk
  s_add_u32 s30, s30, 1
  s_cmp_lt_u32 s30, 400000
  s_cbranch_scc1 cB_sc0_rv
  s_branch cB_abort
cB_sc0_rk:
  s_mov_b32 s62, 1
  v_mov_b32 v36, 0
  v_mov_b32 v37, 0
  v_mov_b32 v38, 0
  v_mov_b32 v39, 0
  v_mov_b32 v40, 0
  v_mov_b32 v41, 0
  v_mov_b32 v42, 0
  v_mov_b32 v43, 0
  v_mov_b32 v44, 0
  v_mov_b32 v45, 0
  v_mov_b32 v46, 0
  v_mov_b32 v47, 0
  v_mov_b32 v48, 0
  v_mov_b32 v49, 0
  v_mov_b32 v50, 0
  v_mov_b32 v51, 0
  v_mov_b32 v52, 0
  v_mov_b32 v53, 0
  v_mov_b32 v54, 0
  v_mov_b32 v55, 0
  v_mov_b32 v56, 0
  v_mov_b32 v57, 0
  v_mov_b32 v58, 0
  v_mov_b32 v59, 0
  v_mov_b32 v60, 0
  v_mov_b32 v61, 0
  v_mov_b32 v62, 0
  v_mov_b32 v63, 0
  v_mov_b32 v88, 0
  v_mov_b32 v89, 0
  v_mov_b32 v90, 0
  v_mov_b32 v91, 0
  v_mov_b32 v92, 0
  v_mov_b32 v93, 0
  v_mov_b32 v94, 0
  v_mov_b32 v95, 0
  v_mov_b32 v66, 0
  v_mov_b32 v67, 0
  s_add_u32 s31, s31, 1
  ds_read_b128 v[96:99], v117 offset:0
  ds_read_b128 v[100:103], v117 offset:1024
  ds_read_b128 v[104:107], v117 offset:14336
  ds_read_b128 v[108:111], v117 offset:15360
  v_smfmac_f32_16x16x64_bf16 v[36:39], v[8:11], a[0:7], v3
  v_smfmac_f32_16x16x64_bf16 v[40:43], v[8:11], a[56:63], v3
  v_smfmac_f32_16x16x64_bf16 v[44:47], v[8:11], a[112:119], v3
  v_smfmac_f32_16x16x64_bf16 v[48:51], v[8:11], a[168:175], v3
  v_smfmac_f32_16x16x64_bf16 v[52:55], v[8:11], a[224:231], v3
  v_smfmac_f32_16x16x64_bf16 v[56:59], v[8:11], v[144:151], v3
  v_smfmac_f32_16x16x64_bf16 v[60:63], v[8:11], v[200:207], v3
  v_smfmac_f32_16x16x64_bf16 v[36:39], v[12:15], a[8:15], v3
  v_smfmac_f32_16x16x64_bf16 v[40:43], v[12:15], a[64:71], v3
  v_smfmac_f32_16x16x64_bf16 v[44:47], v[12:15], a[120:127], v3
  v_smfmac_f32_16x16x64_bf16 v[48:51], v[12:15], a[176:183], v3
  v_smfmac_f32_16x16x64_bf16 v[52:55], v[12:15], a[232:239], v3
  v_smfmac_f32_16x16x64_bf16 v[56:59], v[12:15], v[152:159], v3
  v_smfmac_f32_16x16x64_bf16 v[60:63], v[12:15], v[208:215], v3
  v_smfmac_f32_16x16x64_bf16 v[36:39], v[16:19], a[16:23], v3
  v_smfmac_f32_16x16x64_bf16 v[40:43], v[16:19], a[72:79], v3
  v_smfmac_f32_16x16x64_bf16 v[44:47], v[16:19], a[128:135], v3
  v_smfmac_f32_16x16x64_bf16 v[48:51], v[16:19], a[184:191], v3
  v_smfmac_f32_16x16x64_bf16 v[52:55], v[16:19], a[240:247], v3
  v_smfmac_f32_16x16x64_bf16 v[56:59], v[16:19], v[160:167], v3
  v_smfmac_f32_16x16x64_bf16 v[60:63], v[16:19], v[216:223], v3
  v_smfmac_f32_16x16x64_bf16 v[36:39], v[20:23], a[24:31], v3
  v_smfmac_f32_16x16x64_bf16 v[40:43], v[20:23], a[80:87], v3
  v_smfmac_f32_16x16x64_bf16 v[44:47], v[20:23], a[136:143], v3
  v_smfmac_f32_16x16x64_bf16 v[48:51], v[20:23], a[192:199], v3
  v_smfmac_f32_16x16x64_bf16 v[52:55], v[20:23], a[248:255], v3
  v_smfmac_f32_16x16x64_bf16 v[56:59], v[20:23], v[168:175], v3
  v_smfmac_f32_16x16x64_bf16 v[60:63], v[20:23], v[224:231], v3
  s_xor_b32 s58, s25, 28672
  s_add_u32 s59, s24, 28672
  s_add_u32 m0, s58, 0
  s_branch cB_sc0_ph2
.p2align 6

cB_sc1_loop:
  s_add_u32 s23, s20, 4096
  s_add_u32 s21, s20, 20480
  s_mov_b32 s30, 0
  s_mov_b32 s62, 0
  s_waitcnt vmcnt(0)
  s_barrier
cB_sc1_ld:
  buffer_load_dwordx4 v[8:11], v2, s[8:11], s20 offen offset:0 sc1
  v_mov_b32 v36, 0
  v_mov_b32 v37, 0
  v_mov_b32 v38, 0
  v_mov_b32 v39, 0
  buffer_load_dwordx4 v[12:15], v2, s[8:11], s20 offen offset:1024 sc1
  v_mov_b32 v40, 0
  v_mov_b32 v41, 0
  v_mov_b32 v42, 0
  v_mov_b32 v43, 0
  buffer_load_dwordx4 v[16:19], v2, s[8:11], s20 offen offset:2048 sc1
  v_mov_b32 v44, 0
  v_mov_b32 v45, 0
  v_mov_b32 v46, 0
  v_mov_b32 v47, 0
  ds_read_b128 v[96:99], v117 offset:0
  ds_read_b128 v[100:103], v117 offset:1024
  ds_read_b128 v[104:107], v117 offset:14336
  ds_read_b128 v[108:111], v117 offset:15360
  s_waitcnt vmcnt(2)
  v_smfmac_f32_16x16x64_bf16 v[36:39], v[8:11], a[0:7], v3
  v_smfmac_f32_16x16x64_bf16 v[40:43], v[8:11], a[56:63], v3
  buffer_load_dwordx4 v[20:23], v2, s[8:11], s20 offen offset:3072 sc1
  v_smfmac_f32_16x16x64_bf16 v[44:47], v[8:11], a[112:119], v3
  v_smfmac_f32_16x16x64_bf16 v[48:51], v[8:11], a[168:175], v3
  v_smfmac_f32_16x16x64_bf16 v[52:55], v[8:11], a[224:231], v3
  buffer_load_dwordx4 v[24:27], v2, s[8:11], s23 offen offset:0 sc1
  v_smfmac_f32_16x16x64_bf16 v[56:59], v[8:11], v[144:151], v3
  v_smfmac_f32_16x16x64_bf16 v[60:63], v[8:11], v[200:207], v3
  s_waitcnt vmcnt(3)
  v_smfmac_f32_16x16x64_bf16 v[36:39], v[12:15], a[8:15], v3
  v_smfmac_f32_16x16x64_bf16 v[40:43], v[12:15], a[64:71], v3
  buffer_load_dwordx4 v[28:31], v2, s[8:11], s23 offen offset:1024 sc1
  v_smfmac_f32_16x16x64_bf16 v[44:47], v[12:15], a[120:127], v3
  v_smfmac_f32_16x16x64_bf16 v[48:51], v[12:15], a[176:183], v3
  v_smfmac_f32_16x16x64_bf16 v[52:55], v[12:15], a[232:239], v3
  buffer_load_dwordx4 v[32:35], v2, s[8:11], s23 offen offset:2048 sc1
  v_smfmac_f32_16x16x64_bf16 v[56:59], v[12:15], v[152:159], v3
  v_smfmac_f32_16x16x64_bf16 v[60:63], v[12:15], v[208:215], v3
  s_waitcnt vmcnt(4)
  v_smfmac_f32_16x16x64_bf16 v[36:39], v[16:19], a[16:23], v3
  s_xor_b32 s58, s25, 28672
  s_add_u32 s59, s24, 28672
  s_add_u32 m0, s58, 7168
  v_smfmac_f32_16x16x64_bf16 v[40:43], v[16:19], a[72:79], v3
  buffer_load_dwordx4 v2, s[8:11], s59 offen offset:0 sc1 lds
  v_smfmac_f32_16x16x64_bf16 v[44:47], v[16:19], a[128:135], v3
  v_smfmac_f32_16x16x64_bf16 v[48:51], v[16:19], a[184:191], v3
  v_smfmac_f32_16x16x64_bf16 v[52:55], v[16:19], a[240:247], v3
  v_smfmac_f32_16x16x64_bf16 v[56:59], v[16:19], v[160:167], v3
  buffer_load_dwordx4 v2, s[8:11], s59 offen offset:1024 sc1 lds
  v_smfmac_f32_16x16x64_bf16 v[60:63], v[16:19], v[216:223], v3
  s_waitcnt vmcnt(5)
  v_smfmac_f32_16x16x64_bf16 v[36:39], v[20:23], a[24:31], v3
  v_smfmac_f32_16x16x64_bf16 v[40:43], v[20:23], a[80:87], v3
  v_smfmac_f32_16x16x64_bf16 v[44:47], v[20:23], a[136:143], v3
  buffer_load_dwordx4 v2, s[8:11], s59 offen offset:2048 sc1 lds
  v_smfmac_f32_16x16x64_bf16 v[48:51], v[20:23], a[192:199], v3
  v_smfmac_f32_16x16x64_bf16 v[52:55], v[20:23], a[248:255], v3
  v_smfmac_f32_16x16x64_bf16 v[56:59], v[20:23], v[168:175], v3
  v_smfmac_f32_16x16x64_bf16 v[60:63], v[20:23], v[224:231], v3
  buffer_load_dwordx4 v2, s[8:11], s59 offen offset:3072 sc1 lds
  s_waitcnt vmcnt(4)
cB_sc1_ph2:
  v_smfmac_f32_16x16x64_bf16 v[60:63], v[24:27], v[232:239], v3
  ds_read_b128 v[16:19], v116 offset:2048
  ds_read_b128 v[20:23], v116 offset:3072
  v_smfmac_f32_16x16x64_bf16 v[60:63], v[28:31], v[240:247], v3
  buffer_load_dword v119, v0, s[8:11], s20 offen sc1
  v_smfmac_f32_16x16x64_bf16 v[60:63], v[32:35], v[248:255], v3
  v_mov_b32 v80, v26
  v_smfmac_f32_16x16x64_bf16 v[52:55], v[24:27], v[120:127], v3
  v_mov_b32 v81, v27
  v_smfmac_f32_16x16x64_bf16 v[52:55], v[28:31], v[128:135], v3
  v_mov_b32 v82, v32
  v_smfmac_f32_16x16x64_bf16 v[52:55], v[32:35], v[136:143], v3
  v_cvt_pk_bf16_f32 v66, v60, v61
  v_smfmac_f32_16x16x64_bf16 v[56:59], v[24:27], v[176:183], v3
  v_cvt_pk_bf16_f32 v67, v62, v63
  v_smfmac_f32_16x16x64_bf16 v[56:59], v[28:31], v[184:191], v3
  v_mov_b32 v83, v33
  v_mfma_f32_16x16x32_bf16 v[68:71], v[64:67], v[4:7], 0
  v_smfmac_f32_16x16x64_bf16 v[56:59], v[32:35], v[192:199], v3
  v_cvt_pk_bf16_f32 v64, v52, v53
  v_smfmac_f32_16x16x64_bf16 v[36:39], v[24:27], a[32:39], v3
  v_cvt_pk_bf16_f32 v65, v54, v55
  v_smfmac_f32_16x16x64_bf16 v[36:39], v[28:31], a[40:47], v3
  v_cvt_pk_bf16_f32 v78, v68, v69
  v_smfmac_f32_16x16x64_bf16 v[36:39], v[32:35], a[48:55], v3
  v_cvt_pk_bf16_f32 v79, v70, v71
  v_cvt_pk_bf16_f32 v66, v56, v57
  v_smfmac_f32_16x16x64_bf16 v[40:43], v[24:27], a[88:95], v3
  v_cvt_pk_bf16_f32 v67, v58, v59
  v_smfmac_f32_16x16x64_bf16 v[40:43], v[28:31], a[96:103], v3
  v_mfma_f32_16x16x32_bf16 v[72:75], v[64:67], v[4:7], 0
  ds_read_b128 v[52:55], v116 offset:16384
  ds_read_b128 v[56:59], v116 offset:17408
  v_smfmac_f32_16x16x64_bf16 v[40:43], v[32:35], a[104:111], v3
  v_cvt_pk_bf16_f32 v64, v36, v37
  v_smfmac_f32_16x16x64_bf16 v[44:47], v[24:27], a[144:151], v3
  v_cvt_pk_bf16_f32 v65, v38, v39
  v_smfmac_f32_16x16x64_bf16 v[44:47], v[28:31], a[152:159], v3
  v_cvt_pk_bf16_f32 v76, v72, v73
  v_smfmac_f32_16x16x64_bf16 v[44:47], v[32:35], a[160:167], v3
  v_cvt_pk_bf16_f32 v77, v74, v75
  v_cvt_pk_bf16_f32 v66, v40, v41
  v_smfmac_f32_16x16x64_bf16 v[48:51], v[24:27], a[200:207], v3
  v_cvt_pk_bf16_f32 v67, v42, v43
  v_smfmac_f32_16x16x64_bf16 v[48:51], v[28:31], a[208:215], v3
  v_mfma_f32_16x16x32_bf16 v[68:71], v[64:67], v[4:7], 0
  v_smfmac_f32_16x16x64_bf16 v[48:51], v[32:35], a[216:223], v3
  v_cvt_pk_bf16_f32 v64, v44, v45
  v_mfma_f32_16x16x32_bf16 v[84:87], v[80:83], v[76:79], 0
  v_cvt_pk_bf16_f32 v65, v46, v47
  s_waitcnt lgkmcnt(0)
  v_smfmac_f32_16x16x64_bf16 v[88:91], v[76:79], v[96:103], v118
  v_cvt_pk_bf16_f32 v60, v68, v69
  v_cvt_pk_bf16_f32 v61, v70, v71
  v_cvt_pk_bf16_f32 v66, v48, v49
  v_cvt_pk_bf16_f32 v67, v50, v51
  s_nop 1
  v_mfma_f32_16x16x32_bf16 v[72:75], v[64:67], v[4:7], 0
  v_smfmac_f32_16x16x64_bf16 v[92:95], v[76:79], v[104:111], v118
  s_nop 4
  v_cvt_pk_bf16_f32 v62, v72, v73
  v_cvt_pk_bf16_f32 v63, v74, v75
  s_nop 1
  v_mfma_f32_16x16x32_bf16 v[84:87], v[12:15], v[60:63], v[84:87]
  v_smfmac_f32_16x16x64_bf16 v[88:91], v[60:63], v[16:23], v118
  v_smfmac_f32_16x16x64_bf16 v[92:95], v[60:63], v[52:59], v118
  s_nop 1
  v_permlane32_swap_b32 v84, v86
  v_permlane32_swap_b32 v85, v87
  s_nop 0
  v_add_f32 v88, v88, v89
  v_add_f32_dpp v84, v86, v84 quad_perm:[1,0,3,2] row_mask:0xf bank_mask:0xf
  v_add_f32_dpp v85, v87, v85 quad_perm:[1,0,3,2] row_mask:0xf bank_mask:0xf
  v_add_f32 v89, v90, v91
  ds_write2_b32 v113, v84, v85 offset0:0 offset1:4
  ds_write2_b32 v112, v88, v89 offset0:0 offset1:128
  v_add_f32 v90, v92, v93
  v_add_f32 v91, v94, v95
  ds_write2_b32 v112, v90, v91 offset0:64 offset1:192
  v_cmp_u_f32 vcc, v88, v89
  s_cbranch_vccnz cB_sc1_retry
cB_sc1_cont:
  s_waitcnt lgkmcnt(0)
  s_barrier
  ds_read_b128 v[36:39], v114
  ds_read_b128 v[44:47], v115
  s_waitcnt lgkmcnt(0)
  v_add_f32 v36, v36, v38
  v_add_f32 v37, v37, v39
  v_add_f32 v44, v44, v45
  v_add_f32 v46, v46, v47
  v_add_f32 v44, v44, v46
  v_add_f32 v36, v36, v37
  v_exp_f32 v49, v44
  v_exp_f32 v48, v36
  v_add_f32 v50, abs(v36), abs(v44)
  v_fma_f32 v39, v49, s37, v48
  v_cmp_ngt_f32 vcc, s56, v50
  v_cndmask_b32 v41, v48, v49, s[38:39]
  v_add_f32_dpp v39, v39, v39 quad_perm:[1,0,3,2] row_mask:0xf bank_mask:0xf
  v_cndmask_b32 v40, v49, v48, s[38:39]
  v_mov_b32_dpp v46, v41 quad_perm:[1,0,3,2] row_mask:0xf bank_mask:0xf
  v_add_f32_dpp v39, v39, v39 quad_perm:[2,3,0,1] row_mask:0xf bank_mask:0xf
  v_cndmask_b32 v42, v46, v40, s[38:39]
  v_cndmask_b32 v43, v40, v46, s[38:39]
  v_add_f32_dpp v39, v39, v39 row_half_mirror row_mask:0xf bank_mask:0xf
  s_cbranch_vccnz cB_sc1_slow
  s_nop 0
  v_add_f32_dpp v47, v39, v39 row_mirror row_mask:0xf bank_mask:0xf
  v_add_f32_dpp v39, v39, v39 row_mirror row_mask:0xf bank_mask:0xf
  s_nop 1
  v_permlane16_swap_b32 v39, v47
  v_add_f32 v39, v39, v47
  v_rcp_f32 v39, v39
  s_mov_b64 exec, s[28:29]
  v_mul_f32 v42, v42, v39
  v_mul_f32 v43, v43, v39
  v_cvt_pk_bf16_f32 v42, v42, v43
cB_sc1_pst:
  buffer_store_dword v42, v1, s[8:11], s20 offen sc1
  s_mov_b64 exec, -1
  s_barrier
  s_add_u32 s24, s24, 28672
  s_add_u32 s35, s35, 28672
  s_xor_b32 s25, s25, 28672
  s_add_u32 m0, s25, 7168
  s_add_u32 m0, s25, 11264
  s_add_u32 s22, s24, 4096
  buffer_load_dwordx4 v2, s[8:11], s22 offen offset:0 sc1 lds
  v_mov_b32 v48, 0
  v_mov_b32 v49, 0
  v_mov_b32 v50, 0
  v_mov_b32 v51, 0
  v_mov_b32 v52, 0
  v_mov_b32 v53, 0
  buffer_load_dwordx4 v2, s[8:11], s22 offen offset:1024 sc1 lds
  v_mov_b32 v54, 0
  v_mov_b32 v55, 0
  v_mov_b32 v56, 0
  v_mov_b32 v57, 0
  v_mov_b32 v58, 0
  v_mov_b32 v59, 0
  buffer_load_dwordx4 v2, s[8:11], s22 offen offset:2048 sc1 lds
  v_mov_b32 v60, 0
  v_mov_b32 v61, 0
  v_mov_b32 v62, 0
  v_mov_b32 v63, 0
  v_mov_b32 v88, 0
  v_mov_b32 v89, 0
  v_mov_b32 v90, 0
  v_mov_b32 v91, 0
  v_mov_b32 v92, 0
  v_mov_b32 v93, 0
  v_mov_b32 v94, 0
  v_mov_b32 v95, 0
  v_mov_b32 v64, 0
  v_mov_b32 v65, 0
  v_xor_b32 v116, 28672, v116
  v_add_u32 v117, s57, v117
  s_sub_u32 s57, 0, s57
  s_add_u32 s19, s19, 1
  s_mov_b32 s20, s21
  s_cmp_lt_u32 s19, 63
  s_cbranch_scc1 cB_sc1_loop
  s_branch cB_done
cB_sc1_slow:
  v_max_f32 v50, v36, v44
  s_nop 1
  v_max_f32_dpp v50, v50, v50 quad_perm:[1,0,3,2] row_mask:0xf bank_mask:0xf
  s_nop 1
  v_max_f32_dpp v50, v50, v50 quad_perm:[2,3,0,1] row_mask:0xf bank_mask:0xf
  s_nop 1
  v_max_f32_dpp v50, v50, v50 row_half_mirror row_mask:0xf bank_mask:0xf
  s_nop 1
  v_max_f32_dpp v50, v50, v50 row_mirror row_mask:0xf bank_mask:0xf
  v_mov_b32 v47, v50
  s_nop 1
  v_permlane16_swap_b32 v50, v47
  v_max_f32 v50, v50, v47
  v_sub_f32 v48, v36, v50
  v_sub_f32 v49, v44, v50
  v_exp_f32 v48, v48
  v_exp_f32 v49, v49
  s_add_u32 s31, s31, 0x100
  v_fma_f32 v39, v49, s37, v48
  v_cndmask_b32 v41, v48, v49, s[38:39]
  s_nop 0
  v_add_f32_dpp v39, v39, v39 quad_perm:[1,0,3,2] row_mask:0xf bank_mask:0xf
  v_cndmask_b32 v40, v49, v48, s[38:39]
  v_mov_b32_dpp v46, v41 quad_perm:[1,0,3,2] row_mask:0xf bank_mask:0xf
  v_add_f32_dpp v39, v39, v39 quad_perm:[2,3,0,1] row_mask:0xf bank_mask:0xf
  v_cndmask_b32 v42, v46, v40, s[38:39]
  v_cndmask_b32 v43, v40, v46, s[38:39]
  v_add_f32_dpp v39, v39, v39 row_half_mirror row_mask:0xf bank_mask:0xf
  s_nop 1
  v_add_f32_dpp v47, v39, v39 row_mirror row_mask:0xf bank_mask:0xf
  v_add_f32_dpp v39, v39, v39 row_mirror row_mask:0xf bank_mask:0xf
  s_nop 1
  v_permlane16_swap_b32 v39, v47
  v_add_f32 v39, v39, v47
  v_rcp_f32 v39, v39
  s_mov_b64 exec, s[28:29]
  v_mul_f32 v42, v42, v39
  v_mul_f32 v43, v43, v39
  v_cvt_pk_bf16_f32 v42, v42, v43
  v_min_u32 v42, -2, v42
  s_branch cB_sc1_pst
cB_sc1_retry:
  s_cmp_lg_u32 s62, 0
  s_cbranch_scc1 cB_sc1_cont
  s_waitcnt vmcnt(0) lgkmcnt(0)
cB_sc1_rv:
  buffer_load_dwordx4 v[8:11], v2, s[8:11], s20 offen offset:0 sc1
  buffer_load_dwordx4 v[12:15], v2, s[8:11], s20 offen offset:1024 sc1
  buffer_load_dwordx4 v[16:19], v2, s[8:11], s20 offen offset:2048 sc1
  buffer_load_dwordx4 v[20:23], v2, s[8:11], s20 offen offset:3072 sc1
  buffer_load_dwordx4 v[24:27], v2, s[8:11], s23 offen offset:0 sc1
  buffer_load_dwordx4 v[28:31], v2, s[8:11], s23 offen offset:1024 sc1
  buffer_load_dwordx4 v[32:35], v2, s[8:11], s23 offen offset:2048 sc1
  s_waitcnt vmcnt(0)
  v_max3_u32 v68, v8, v9, v10
  v_max3_u32 v68, v68, v11, v12
  v_max3_u32 v68, v68, v13, v14
  v_max3_u32 v68, v68, v15, v16
  v_max3_u32 v68, v68, v17, v18
  v_max3_u32 v68, v68, v19, v20
  v_max3_u32 v68, v68, v21, v22
  v_max3_u32 v68, v68, v23, v24
  v_max3_u32 v68, v68, v25, v26
  v_max3_u32 v68, v68, v27, v28
  v_max3_u32 v68, v68, v29, v30
  v_max3_u32 v68, v68, v31, v32
  v_max3_u32 v68, v68, v33, v34
  v_max_u32 v68, v68, v35
  v_cmp_eq_u32 vcc, -1, v68
  s_cbranch_vccz cB_sc1_rk
  s_add_u32 s30, s30, 1
  s_cmp_lt_u32 s30, 400000
  s_cbranch_scc1 cB_sc1_rv
  s_branch cB_abort
cB_sc1_rk:
  s_mov_b32 s62, 1
  v_mov_b32 v36, 0
  v_mov_b32 v37, 0
  v_mov_b32 v38, 0
  v_mov_b32 v39, 0
  v_mov_b32 v40, 0
  v_mov_b32 v41, 0
  v_mov_b32 v42, 0
  v_mov_b32 v43, 0
  v_mov_b32 v44, 0
  v_mov_b32 v45, 0
  v_mov_b32 v46, 0
  v_mov_b32 v47, 0
  v_mov_b32 v48, 0
  v_mov_b32 v49, 0
  v_mov_b32 v50, 0
  v_mov_b32 v51, 0
  v_mov_b32 v52, 0
  v_mov_b32 v53, 0
  v_mov_b32 v54, 0
  v_mov_b32 v55, 0
  v_mov_b32 v56, 0
  v_mov_b32 v57, 0
  v_mov_b32 v58, 0
  v_mov_b32 v59, 0
  v_mov_b32 v60, 0
  v_mov_b32 v61, 0
  v_mov_b32 v62, 0
  v_mov_b32 v63, 0
  v_mov_b32 v88, 0
  v_mov_b32 v89, 0
  v_mov_b32 v90, 0
  v_mov_b32 v91, 0
  v_mov_b32 v92, 0
  v_mov_b32 v93, 0
  v_mov_b32 v94, 0
  v_mov_b32 v95, 0
  v_mov_b32 v64, 0
  v_mov_b32 v65, 0
  s_add_u32 s31, s31, 1
  ds_read_b128 v[96:99], v117 offset:0
  ds_read_b128 v[100:103], v117 offset:1024
  ds_read_b128 v[104:107], v117 offset:14336
  ds_read_b128 v[108:111], v117 offset:15360
  v_smfmac_f32_16x16x64_bf16 v[36:39], v[8:11], a[0:7], v3
  v_smfmac_f32_16x16x64_bf16 v[40:43], v[8:11], a[56:63], v3
  v_smfmac_f32_16x16x64_bf16 v[44:47], v[8:11], a[112:119], v3
  v_smfmac_f32_16x16x64_bf16 v[48:51], v[8:11], a[168:175], v3
  v_smfmac_f32_16x16x64_bf16 v[52:55], v[8:11], a[224:231], v3
  v_smfmac_f32_16x16x64_bf16 v[56:59], v[8:11], v[144:151], v3
  v_smfmac_f32_16x16x64_bf16 v[60:63], v[8:11], v[200:207], v3
  v_smfmac_f32_16x16x64_bf16 v[36:39], v[12:15], a[8:15], v3
  v_smfmac_f32_16x16x64_bf16 v[40:43], v[12:15], a[64:71], v3
  v_smfmac_f32_16x16x64_bf16 v[44:47], v[12:15], a[120:127], v3
  v_smfmac_f32_16x16x64_bf16 v[48:51], v[12:15], a[176:183], v3
  v_smfmac_f32_16x16x64_bf16 v[52:55], v[12:15], a[232:239], v3
  v_smfmac_f32_16x16x64_bf16 v[56:59], v[12:15], v[152:159], v3
  v_smfmac_f32_16x16x64_bf16 v[60:63], v[12:15], v[208:215], v3
  v_smfmac_f32_16x16x64_bf16 v[36:39], v[16:19], a[16:23], v3
  v_smfmac_f32_16x16x64_bf16 v[40:43], v[16:19], a[72:79], v3
  v_smfmac_f32_16x16x64_bf16 v[44:47], v[16:19], a[128:135], v3
  v_smfmac_f32_16x16x64_bf16 v[48:51], v[16:19], a[184:191], v3
  v_smfmac_f32_16x16x64_bf16 v[52:55], v[16:19], a[240:247], v3
  v_smfmac_f32_16x16x64_bf16 v[56:59], v[16:19], v[160:167], v3
  v_smfmac_f32_16x16x64_bf16 v[60:63], v[16:19], v[216:223], v3
  v_smfmac_f32_16x16x64_bf16 v[36:39], v[20:23], a[24:31], v3
  v_smfmac_f32_16x16x64_bf16 v[40:43], v[20:23], a[80:87], v3
  v_smfmac_f32_16x16x64_bf16 v[44:47], v[20:23], a[136:143], v3
  v_smfmac_f32_16x16x64_bf16 v[48:51], v[20:23], a[192:199], v3
  v_smfmac_f32_16x16x64_bf16 v[52:55], v[20:23], a[248:255], v3
  v_smfmac_f32_16x16x64_bf16 v[56:59], v[20:23], v[168:175], v3
  v_smfmac_f32_16x16x64_bf16 v[60:63], v[20:23], v[224:231], v3
  s_xor_b32 s58, s25, 28672
  s_add_u32 s59, s24, 28672
  s_add_u32 m0, s58, 7168
  s_branch cB_sc1_ph2
.p2align 6

cB_sc2_loop:
  s_add_u32 s23, s20, 4096
  s_add_u32 s21, s20, 20480
  s_mov_b32 s30, 0
  s_mov_b32 s62, 0
  s_waitcnt vmcnt(0)
  s_barrier
cB_sc2_ld:
  buffer_load_dwordx4 v[8:11], v2, s[8:11], s20 offen offset:0 sc1
  v_mov_b32 v36, 0
  v_mov_b32 v37, 0
  v_mov_b32 v38, 0
  v_mov_b32 v39, 0
  buffer_load_dwordx4 v[12:15], v2, s[8:11], s20 offen offset:1024 sc1
  v_mov_b32 v40, 0
  v_mov_b32 v41, 0
  v_mov_b32 v42, 0
  v_mov_b32 v43, 0
  buffer_load_dwordx4 v[16:19], v2, s[8:11], s20 offen offset:2048 sc1
  v_mov_b32 v44, 0
  v_mov_b32 v45, 0
  v_mov_b32 v46, 0
  v_mov_b32 v47, 0
  ds_read_b128 v[96:99], v117 offset:0
  ds_read_b128 v[100:103], v117 offset:1024
  ds_read_b128 v[104:107], v117 offset:14336
  ds_read_b128 v[108:111], v117 offset:15360
  s_waitcnt vmcnt(2)
  v_smfmac_f32_16x16x64_bf16 v[36:39], v[8:11], a[0:7], v3
  v_smfmac_f32_16x16x64_bf16 v[40:43], v[8:11], a[56:63], v3
  buffer_load_dwordx4 v[20:23], v2, s[8:11], s20 offen offset:3072 sc1
  v_smfmac_f32_16x16x64_bf16 v[44:47], v[8:11], a[112:119], v3
  v_smfmac_f32_16x16x64_bf16 v[48:51], v[8:11], a[168:175], v3
  v_smfmac_f32_16x16x64_bf16 v[52:55], v[8:11], a[224:231], v3
  buffer_load_dwordx4 v[24:27], v2, s[8:11], s23 offen offset:0 sc1
  v_smfmac_f32_16x16x64_bf16 v[56:59], v[8:11], v[144:151], v3
  v_smfmac_f32_16x16x64_bf16 v[60:63], v[8:11], v[200:207], v3
  s_waitcnt vmcnt(3)
  v_smfmac_f32_16x16x64_bf16 v[36:39], v[12:15], a[8:15], v3
  v_smfmac_f32_16x16x64_bf16 v[40:43], v[12:15], a[64:71], v3
  buffer_load_dwordx4 v[28:31], v2, s[8:11], s23 offen offset:1024 sc1
  v_smfmac_f32_16x16x64_bf16 v[44:47], v[12:15], a[120:127], v3
  v_smfmac_f32_16x16x64_bf16 v[48:51], v[12:15], a[176:183], v3
  v_smfmac_f32_16x16x64_bf16 v[52:55], v[12:15], a[232:239], v3
  buffer_load_dwordx4 v[32:35], v2, s[8:11], s23 offen offset:2048 sc1
  v_smfmac_f32_16x16x64_bf16 v[56:59], v[12:15], v[152:159], v3
  v_smfmac_f32_16x16x64_bf16 v[60:63], v[12:15], v[208:215], v3
  s_waitcnt vmcnt(4)
  v_smfmac_f32_16x16x64_bf16 v[36:39], v[16:19], a[16:23], v3
  v_smfmac_f32_16x16x64_bf16 v[40:43], v[16:19], a[72:79], v3
  s_xor_b32 s58, s25, 28672
  s_add_u32 s59, s24, 28672
  s_add_u32 m0, s58, 14336
  v_smfmac_f32_16x16x64_bf16 v[44:47], v[16:19], a[128:135], v3
  buffer_load_dwordx4 v2, s[8:11], s59 offen offset:0 sc1 lds
  v_smfmac_f32_16x16x64_bf16 v[48:51], v[16:19], a[184:191], v3
  v_smfmac_f32_16x16x64_bf16 v[52:55], v[16:19], a[240:247], v3
  v_smfmac_f32_16x16x64_bf16 v[56:59], v[16:19], v[160:167], v3
  v_smfmac_f32_16x16x64_bf16 v[60:63], v[16:19], v[216:223], v3
  buffer_load_dwordx4 v2, s[8:11], s59 offen offset:1024 sc1 lds
  s_waitcnt vmcnt(5)
  v_smfmac_f32_16x16x64_bf16 v[36:39], v[20:23], a[24:31], v3
  v_smfmac_f32_16x16x64_bf16 v[40:43], v[20:23], a[80:87], v3
  v_smfmac_f32_16x16x64_bf16 v[44:47], v[20:23], a[136:143], v3
  v_smfmac_f32_16x16x64_bf16 v[48:51], v[20:23], a[192:199], v3
  buffer_load_dwordx4 v2, s[8:11], s59 offen offset:2048 sc1 lds
  v_smfmac_f32_16x16x64_bf16 v[52:55], v[20:23], a[248:255], v3
  v_smfmac_f32_16x16x64_bf16 v[56:59], v[20:23], v[168:175], v3
  v_smfmac_f32_16x16x64_bf16 v[60:63], v[20:23], v[224:231], v3
  s_waitcnt vmcnt(3)
cB_sc2_ph2:
  v_smfmac_f32_16x16x64_bf16 v[60:63], v[24:27], v[232:239], v3
  buffer_load_dwordx4 v2, s[8:11], s59 offen offset:3072 sc1 lds
  ds_read_b128 v[8:11], v116 offset:4096
  ds_read_b128 v[12:15], v116 offset:5120
  v_smfmac_f32_16x16x64_bf16 v[60:63], v[28:31], v[240:247], v3
  buffer_load_dword v119, v0, s[8:11], s24 offen sc1
  v_smfmac_f32_16x16x64_bf16 v[60:63], v[32:35], v[248:255], v3
  v_mov_b32 v80, v28
  v_smfmac_f32_16x16x64_bf16 v[52:55], v[24:27], v[120:127], v3
  v_mov_b32 v81, v29
  v_smfmac_f32_16x16x64_bf16 v[52:55], v[28:31], v[128:135], v3
  v_mov_b32 v82, v34
  v_smfmac_f32_16x16x64_bf16 v[52:55], v[32:35], v[136:143], v3
  v_cvt_pk_bf16_f32 v64, v60, v61
  v_smfmac_f32_16x16x64_bf16 v[56:59], v[24:27], v[176:183], v3
  v_cvt_pk_bf16_f32 v65, v62, v63
  v_smfmac_f32_16x16x64_bf16 v[56:59], v[28:31], v[184:191], v3
  v_mov_b32 v83, v35
  v_mfma_f32_16x16x32_bf16 v[68:71], v[64:67], v[4:7], 0
  v_smfmac_f32_16x16x64_bf16 v[56:59], v[32:35], v[192:199], v3
  v_cvt_pk_bf16_f32 v64, v52, v53
  v_smfmac_f32_16x16x64_bf16 v[36:39], v[24:27], a[32:39], v3
  v_cvt_pk_bf16_f32 v65, v54, v55
  v_smfmac_f32_16x16x64_bf16 v[36:39], v[28:31], a[40:47], v3
  v_cvt_pk_bf16_f32 v78, v68, v69
  v_smfmac_f32_16x16x64_bf16 v[36:39], v[32:35], a[48:55], v3
  v_cvt_pk_bf16_f32 v79, v70, v71
  v_cvt_pk_bf16_f32 v66, v56, v57
  v_smfmac_f32_16x16x64_bf16 v[40:43], v[24:27], a[88:95], v3
  v_cvt_pk_bf16_f32 v67, v58, v59
  v_smfmac_f32_16x16x64_bf16 v[40:43], v[28:31], a[96:103], v3
  v_mfma_f32_16x16x32_bf16 v[72:75], v[64:67], v[4:7], 0
  ds_read_b128 v[52:55], v116 offset:18432
  ds_read_b128 v[56:59], v116 offset:19456
  v_smfmac_f32_16x16x64_bf16 v[40:43], v[32:35], a[104:111], v3
  v_cvt_pk_bf16_f32 v64, v36, v37
  v_smfmac_f32_16x16x64_bf16 v[44:47], v[24:27], a[144:151], v3
  v_cvt_pk_bf16_f32 v65, v38, v39
  v_smfmac_f32_16x16x64_bf16 v[44:47], v[28:31], a[152:159], v3
  v_cvt_pk_bf16_f32 v76, v72, v73
  v_smfmac_f32_16x16x64_bf16 v[44:47], v[32:35], a[160:167], v3
  v_cvt_pk_bf16_f32 v77, v74, v75
  v_cvt_pk_bf16_f32 v66, v40, v41
  v_smfmac_f32_16x16x64_bf16 v[48:51], v[24:27], a[200:207], v3
  v_cvt_pk_bf16_f32 v67, v42, v43
  v_smfmac_f32_16x16x64_bf16 v[48:51], v[28:31], a[208:215], v3
  v_mfma_f32_16x16x32_bf16 v[68:71], v[64:67], v[4:7], 0
  v_smfmac_f32_16x16x64_bf16 v[48:51], v[32:35], a[216:223], v3
  v_cvt_pk_bf16_f32 v64, v44, v45
  v_mfma_f32_16x16x32_bf16 v[84:87], v[80:83], v[76:79], 0
  v_cvt_pk_bf16_f32 v65, v46, v47
  s_waitcnt lgkmcnt(0)
  v_smfmac_f32_16x16x64_bf16 v[88:91], v[76:79], v[96:103], v118
  v_cvt_pk_bf16_f32 v60, v68, v69
  v_cvt_pk_bf16_f32 v61, v70, v71
  v_cvt_pk_bf16_f32 v66, v48, v49
  v_cvt_pk_bf16_f32 v67, v50, v51
  s_nop 1
  v_mfma_f32_16x16x32_bf16 v[72:75], v[64:67], v[4:7], 0
  v_smfmac_f32_16x16x64_bf16 v[92:95], v[76:79], v[104:111], v118
  s_nop 4
  v_cvt_pk_bf16_f32 v62, v72, v73
  v_cvt_pk_bf16_f32 v63, v74, v75
  s_nop 1
  v_mfma_f32_16x16x32_bf16 v[84:87], v[16:19], v[60:63], v[84:87]
  v_smfmac_f32_16x16x64_bf16 v[88:91], v[60:63], v[8:15], v118
  v_smfmac_f32_16x16x64_bf16 v[92:95], v[60:63], v[52:59], v118
  s_nop 1
  v_permlane32_swap_b32 v84, v86
  v_permlane32_swap_b32 v85, v87
  s_nop 0
  v_add_f32 v88, v88, v89
  v_add_f32_dpp v84, v86, v84 quad_perm:[1,0,3,2] row_mask:0xf bank_mask:0xf
  v_add_f32_dpp v85, v87, v85 quad_perm:[1,0,3,2] row_mask:0xf bank_mask:0xf
  v_add_f32 v89, v90, v91
  ds_write2_b32 v113, v84, v85 offset0:0 offset1:4
  ds_write2_b32 v112, v88, v89 offset0:0 offset1:128
  v_add_f32 v90, v92, v93
  v_add_f32 v91, v94, v95
  ds_write2_b32 v112, v90, v91 offset0:64 offset1:192
  v_cmp_u_f32 vcc, v88, v89
  s_cbranch_vccnz cB_sc2_retry
cB_sc2_cont:
  s_waitcnt lgkmcnt(0)
  s_barrier
  ds_read_b128 v[36:39], v114
  ds_read_b128 v[44:47], v115
  s_waitcnt lgkmcnt(0)
  v_add_f32 v36, v36, v38
  v_add_f32 v37, v37, v39
  v_add_f32 v44, v44, v45
  v_add_f32 v46, v46, v47
  v_add_f32 v44, v44, v46
  v_add_f32 v36, v36, v37
  v_exp_f32 v49, v44
  v_exp_f32 v48, v36
  v_add_f32 v50, abs(v36), abs(v44)
  v_fma_f32 v39, v49, s37, v48
  v_cmp_ngt_f32 vcc, s56, v50
  v_cndmask_b32 v41, v48, v49, s[38:39]
  v_add_f32_dpp v39, v39, v39 quad_perm:[1,0,3,2] row_mask:0xf bank_mask:0xf
  v_cndmask_b32 v40, v49, v48, s[38:39]
  v_mov_b32_dpp v46, v41 quad_perm:[1,0,3,2] row_mask:0xf bank_mask:0xf
  v_add_f32_dpp v39, v39, v39 quad_perm:[2,3,0,1] row_mask:0xf bank_mask:0xf
  v_cndmask_b32 v42, v46, v40, s[38:39]
  v_cndmask_b32 v43, v40, v46, s[38:39]
  v_add_f32_dpp v39, v39, v39 row_half_mirror row_mask:0xf bank_mask:0xf
  s_cbranch_vccnz cB_sc2_slow
  s_nop 0
  v_add_f32_dpp v47, v39, v39 row_mirror row_mask:0xf bank_mask:0xf
  v_add_f32_dpp v39, v39, v39 row_mirror row_mask:0xf bank_mask:0xf
  s_nop 1
  v_permlane16_swap_b32 v39, v47
  v_add_f32 v39, v39, v47
  v_rcp_f32 v39, v39
  s_mov_b64 exec, s[28:29]
  v_mul_f32 v42, v42, v39
  v_mul_f32 v43, v43, v39
  v_cvt_pk_bf16_f32 v42, v42, v43
cB_sc2_pst:
  buffer_store_dword v42, v1, s[8:11], s20 offen sc1
  s_mov_b64 exec, -1
  s_barrier
  s_add_u32 s24, s24, 28672
  s_add_u32 s35, s35, 28672
  s_xor_b32 s25, s25, 28672
  s_add_u32 m0, s25, 14336
  s_add_u32 m0, s25, 18432
  s_add_u32 s22, s24, 4096
  buffer_load_dwordx4 v2, s[8:11], s22 offen offset:0 sc1 lds
  v_mov_b32 v48, 0
  v_mov_b32 v49, 0
  v_mov_b32 v50, 0
  v_mov_b32 v51, 0
  v_mov_b32 v52, 0
  v_mov_b32 v53, 0
  buffer_load_dwordx4 v2, s[8:11], s22 offen offset:1024 sc1 lds
  v_mov_b32 v54, 0
  v_mov_b32 v55, 0
  v_mov_b32 v56, 0
  v_mov_b32 v57, 0
  v_mov_b32 v58, 0
  v_mov_b32 v59, 0
  buffer_load_dwordx4 v2, s[8:11], s22 offen offset:2048 sc1 lds
  v_mov_b32 v60, 0
  v_mov_b32 v61, 0
  v_mov_b32 v62, 0
  v_mov_b32 v63, 0
  v_mov_b32 v88, 0
  v_mov_b32 v89, 0
  v_mov_b32 v90, 0
  v_mov_b32 v91, 0
  v_mov_b32 v92, 0
  v_mov_b32 v93, 0
  v_mov_b32 v94, 0
  v_mov_b32 v95, 0
  v_mov_b32 v66, 0
  v_mov_b32 v67, 0
  v_xor_b32 v116, 28672, v116
  v_add_u32 v117, s57, v117
  s_sub_u32 s57, 0, s57
  s_add_u32 s19, s19, 1
  s_mov_b32 s20, s21
  s_cmp_lt_u32 s19, 63
  s_cbranch_scc1 cB_sc2_loop
  s_branch cB_done
cB_sc2_slow:
  v_max_f32 v50, v36, v44
  s_nop 1
  v_max_f32_dpp v50, v50, v50 quad_perm:[1,0,3,2] row_mask:0xf bank_mask:0xf
  s_nop 1
  v_max_f32_dpp v50, v50, v50 quad_perm:[2,3,0,1] row_mask:0xf bank_mask:0xf
  s_nop 1
  v_max_f32_dpp v50, v50, v50 row_half_mirror row_mask:0xf bank_mask:0xf
  s_nop 1
  v_max_f32_dpp v50, v50, v50 row_mirror row_mask:0xf bank_mask:0xf
  v_mov_b32 v47, v50
  s_nop 1
  v_permlane16_swap_b32 v50, v47
  v_max_f32 v50, v50, v47
  v_sub_f32 v48, v36, v50
  v_sub_f32 v49, v44, v50
  v_exp_f32 v48, v48
  v_exp_f32 v49, v49
  s_add_u32 s31, s31, 0x100
  v_fma_f32 v39, v49, s37, v48
  v_cndmask_b32 v41, v48, v49, s[38:39]
  s_nop 0
  v_add_f32_dpp v39, v39, v39 quad_perm:[1,0,3,2] row_mask:0xf bank_mask:0xf
  v_cndmask_b32 v40, v49, v48, s[38:39]
  v_mov_b32_dpp v46, v41 quad_perm:[1,0,3,2] row_mask:0xf bank_mask:0xf
  v_add_f32_dpp v39, v39, v39 quad_perm:[2,3,0,1] row_mask:0xf bank_mask:0xf
  v_cndmask_b32 v42, v46, v40, s[38:39]
  v_cndmask_b32 v43, v40, v46, s[38:39]
  v_add_f32_dpp v39, v39, v39 row_half_mirror row_mask:0xf bank_mask:0xf
  s_nop 1
  v_add_f32_dpp v47, v39, v39 row_mirror row_mask:0xf bank_mask:0xf
  v_add_f32_dpp v39, v39, v39 row_mirror row_mask:0xf bank_mask:0xf
  s_nop 1
  v_permlane16_swap_b32 v39, v47
  v_add_f32 v39, v39, v47
  v_rcp_f32 v39, v39
  s_mov_b64 exec, s[28:29]
  v_mul_f32 v42, v42, v39
  v_mul_f32 v43, v43, v39
  v_cvt_pk_bf16_f32 v42, v42, v43
  v_min_u32 v42, -2, v42
  s_branch cB_sc2_pst
cB_sc2_retry:
  s_cmp_lg_u32 s62, 0
  s_cbranch_scc1 cB_sc2_cont
  s_waitcnt vmcnt(0) lgkmcnt(0)
cB_sc2_rv:
  buffer_load_dwordx4 v[8:11], v2, s[8:11], s20 offen offset:0 sc1
  buffer_load_dwordx4 v[12:15], v2, s[8:11], s20 offen offset:1024 sc1
  buffer_load_dwordx4 v[16:19], v2, s[8:11], s20 offen offset:2048 sc1
  buffer_load_dwordx4 v[20:23], v2, s[8:11], s20 offen offset:3072 sc1
  buffer_load_dwordx4 v[24:27], v2, s[8:11], s23 offen offset:0 sc1
  buffer_load_dwordx4 v[28:31], v2, s[8:11], s23 offen offset:1024 sc1
  buffer_load_dwordx4 v[32:35], v2, s[8:11], s23 offen offset:2048 sc1
  s_waitcnt vmcnt(0)
  v_max3_u32 v68, v8, v9, v10
  v_max3_u32 v68, v68, v11, v12
  v_max3_u32 v68, v68, v13, v14
  v_max3_u32 v68, v68, v15, v16
  v_max3_u32 v68, v68, v17, v18
  v_max3_u32 v68, v68, v19, v20
  v_max3_u32 v68, v68, v21, v22
  v_max3_u32 v68, v68, v23, v24
  v_max3_u32 v68, v68, v25, v26
  v_max3_u32 v68, v68, v27, v28
  v_max3_u32 v68, v68, v29, v30
  v_max3_u32 v68, v68, v31, v32
  v_max3_u32 v68, v68, v33, v34
  v_max_u32 v68, v68, v35
  v_cmp_eq_u32 vcc, -1, v68
  s_cbranch_vccz cB_sc2_rk
  s_add_u32 s30, s30, 1
  s_cmp_lt_u32 s30, 400000
  s_cbranch_scc1 cB_sc2_rv
  s_branch cB_abort
cB_sc2_rk:
  s_mov_b32 s62, 1
  v_mov_b32 v36, 0
  v_mov_b32 v37, 0
  v_mov_b32 v38, 0
  v_mov_b32 v39, 0
  v_mov_b32 v40, 0
  v_mov_b32 v41, 0
  v_mov_b32 v42, 0
  v_mov_b32 v43, 0
  v_mov_b32 v44, 0
  v_mov_b32 v45, 0
  v_mov_b32 v46, 0
  v_mov_b32 v47, 0
  v_mov_b32 v48, 0
  v_mov_b32 v49, 0
  v_mov_b32 v50, 0
  v_mov_b32 v51, 0
  v_mov_b32 v52, 0
  v_mov_b32 v53, 0
  v_mov_b32 v54, 0
  v_mov_b32 v55, 0
  v_mov_b32 v56, 0
  v_mov_b32 v57, 0
  v_mov_b32 v58, 0
  v_mov_b32 v59, 0
  v_mov_b32 v60, 0
  v_mov_b32 v61, 0
  v_mov_b32 v62, 0
  v_mov_b32 v63, 0
  v_mov_b32 v88, 0
  v_mov_b32 v89, 0
  v_mov_b32 v90, 0
  v_mov_b32 v91, 0
  v_mov_b32 v92, 0
  v_mov_b32 v93, 0
  v_mov_b32 v94, 0
  v_mov_b32 v95, 0
  v_mov_b32 v66, 0
  v_mov_b32 v67, 0
  s_add_u32 s31, s31, 1
  ds_read_b128 v[96:99], v117 offset:0
  ds_read_b128 v[100:103], v117 offset:1024
  ds_read_b128 v[104:107], v117 offset:14336
  ds_read_b128 v[108:111], v117 offset:15360
  v_smfmac_f32_16x16x64_bf16 v[36:39], v[8:11], a[0:7], v3
  v_smfmac_f32_16x16x64_bf16 v[40:43], v[8:11], a[56:63], v3
  v_smfmac_f32_16x16x64_bf16 v[44:47], v[8:11], a[112:119], v3
  v_smfmac_f32_16x16x64_bf16 v[48:51], v[8:11], a[168:175], v3
  v_smfmac_f32_16x16x64_bf16 v[52:55], v[8:11], a[224:231], v3
  v_smfmac_f32_16x16x64_bf16 v[56:59], v[8:11], v[144:151], v3
  v_smfmac_f32_16x16x64_bf16 v[60:63], v[8:11], v[200:207], v3
  v_smfmac_f32_16x16x64_bf16 v[36:39], v[12:15], a[8:15], v3
  v_smfmac_f32_16x16x64_bf16 v[40:43], v[12:15], a[64:71], v3
  v_smfmac_f32_16x16x64_bf16 v[44:47], v[12:15], a[120:127], v3
  v_smfmac_f32_16x16x64_bf16 v[48:51], v[12:15], a[176:183], v3
  v_smfmac_f32_16x16x64_bf16 v[52:55], v[12:15], a[232:239], v3
  v_smfmac_f32_16x16x64_bf16 v[56:59], v[12:15], v[152:159], v3
  v_smfmac_f32_16x16x64_bf16 v[60:63], v[12:15], v[208:215], v3
  v_smfmac_f32_16x16x64_bf16 v[36:39], v[16:19], a[16:23], v3
  v_smfmac_f32_16x16x64_bf16 v[40:43], v[16:19], a[72:79], v3
  v_smfmac_f32_16x16x64_bf16 v[44:47], v[16:19], a[128:135], v3
  v_smfmac_f32_16x16x64_bf16 v[48:51], v[16:19], a[184:191], v3
  v_smfmac_f32_16x16x64_bf16 v[52:55], v[16:19], a[240:247], v3
  v_smfmac_f32_16x16x64_bf16 v[56:59], v[16:19], v[160:167], v3
  v_smfmac_f32_16x16x64_bf16 v[60:63], v[16:19], v[216:223], v3
  v_smfmac_f32_16x16x64_bf16 v[36:39], v[20:23], a[24:31], v3
  v_smfmac_f32_16x16x64_bf16 v[40:43], v[20:23], a[80:87], v3
  v_smfmac_f32_16x16x64_bf16 v[44:47], v[20:23], a[136:143], v3
  v_smfmac_f32_16x16x64_bf16 v[48:51], v[20:23], a[192:199], v3
  v_smfmac_f32_16x16x64_bf16 v[52:55], v[20:23], a[248:255], v3
  v_smfmac_f32_16x16x64_bf16 v[56:59], v[20:23], v[168:175], v3
  v_smfmac_f32_16x16x64_bf16 v[60:63], v[20:23], v[224:231], v3
  s_xor_b32 s58, s25, 28672
  s_add_u32 s59, s24, 28672
  s_add_u32 m0, s58, 14336
  s_branch cB_sc2_ph2
.p2align 6

cB_sc3_loop:
  s_add_u32 s23, s20, 4096
  s_add_u32 s21, s20, 20480
  s_mov_b32 s30, 0
  s_mov_b32 s62, 0
  s_waitcnt vmcnt(0)
  s_barrier
cB_sc3_ld:
  buffer_load_dwordx4 v[8:11], v2, s[8:11], s20 offen offset:0 sc1
  v_mov_b32 v36, 0
  v_mov_b32 v37, 0
  v_mov_b32 v38, 0
  v_mov_b32 v39, 0
  buffer_load_dwordx4 v[12:15], v2, s[8:11], s20 offen offset:1024 sc1
  v_mov_b32 v40, 0
  v_mov_b32 v41, 0
  v_mov_b32 v42, 0
  v_mov_b32 v43, 0
  buffer_load_dwordx4 v[16:19], v2, s[8:11], s20 offen offset:2048 sc1
  v_mov_b32 v44, 0
  v_mov_b32 v45, 0
  v_mov_b32 v46, 0
  v_mov_b32 v47, 0
  ds_read_b128 v[96:99], v117 offset:0
  ds_read_b128 v[100:103], v117 offset:1024
  ds_read_b128 v[104:107], v117 offset:14336
  ds_read_b128 v[108:111], v117 offset:15360
  s_waitcnt vmcnt(2)
  v_smfmac_f32_16x16x64_bf16 v[36:39], v[8:11], a[0:7], v3
  v_smfmac_f32_16x16x64_bf16 v[40:43], v[8:11], a[56:63], v3
  buffer_load_dwordx4 v[20:23], v2, s[8:11], s20 offen offset:3072 sc1
  v_smfmac_f32_16x16x64_bf16 v[44:47], v[8:11], a[112:119], v3
  v_smfmac_f32_16x16x64_bf16 v[48:51], v[8:11], a[168:175], v3
  v_smfmac_f32_16x16x64_bf16 v[52:55], v[8:11], a[224:231], v3
  buffer_load_dwordx4 v[24:27], v2, s[8:11], s23 offen offset:0 sc1
  v_smfmac_f32_16x16x64_bf16 v[56:59], v[8:11], v[144:151], v3
  v_smfmac_f32_16x16x64_bf16 v[60:63], v[8:11], v[200:207], v3
  s_waitcnt vmcnt(3)
  v_smfmac_f32_16x16x64_bf16 v[36:39], v[12:15], a[8:15], v3
  v_smfmac_f32_16x16x64_bf16 v[40:43], v[12:15], a[64:71], v3
  buffer_load_dwordx4 v[28:31], v2, s[8:11], s23 offen offset:1024 sc1
  v_smfmac_f32_16x16x64_bf16 v[44:47], v[12:15], a[120:127], v3
  v_smfmac_f32_16x16x64_bf16 v[48:51], v[12:15], a[176:183], v3
  v_smfmac_f32_16x16x64_bf16 v[52:55], v[12:15], a[232:239], v3
  buffer_load_dwordx4 v[32:35], v2, s[8:11], s23 offen offset:2048 sc1
  v_smfmac_f32_16x16x64_bf16 v[56:59], v[12:15], v[152:159], v3
  v_smfmac_f32_16x16x64_bf16 v[60:63], v[12:15], v[208:215], v3
  s_waitcnt vmcnt(4)
  v_smfmac_f32_16x16x64_bf16 v[36:39], v[16:19], a[16:23], v3
  v_smfmac_f32_16x16x64_bf16 v[40:43], v[16:19], a[72:79], v3
  v_smfmac_f32_16x16x64_bf16 v[44:47], v[16:19], a[128:135], v3
  s_xor_b32 s58, s25, 28672
  s_add_u32 s59, s24, 28672
  s_add_u32 m0, s58, 21504
  v_smfmac_f32_16x16x64_bf16 v[48:51], v[16:19], a[184:191], v3
  buffer_load_dwordx4 v2, s[8:11], s59 offen offset:0 sc1 lds
  v_smfmac_f32_16x16x64_bf16 v[52:55], v[16:19], a[240:247], v3
  v_smfmac_f32_16x16x64_bf16 v[56:59], v[16:19], v[160:167], v3
  v_smfmac_f32_16x16x64_bf16 v[60:63], v[16:19], v[216:223], v3
  s_waitcnt vmcnt(4)
  v_smfmac_f32_16x16x64_bf16 v[36:39], v[20:23], a[24:31], v3
  buffer_load_dwordx4 v2, s[8:11], s59 offen offset:1024 sc1 lds
  v_smfmac_f32_16x16x64_bf16 v[40:43], v[20:23], a[80:87], v3
  v_smfmac_f32_16x16x64_bf16 v[44:47], v[20:23], a[136:143], v3
  v_smfmac_f32_16x16x64_bf16 v[48:51], v[20:23], a[192:199], v3
  v_smfmac_f32_16x16x64_bf16 v[52:55], v[20:23], a[248:255], v3
  buffer_load_dwordx4 v2, s[8:11], s59 offen offset:2048 sc1 lds
  v_smfmac_f32_16x16x64_bf16 v[56:59], v[20:23], v[168:175], v3
  v_smfmac_f32_16x16x64_bf16 v[60:63], v[20:23], v[224:231], v3
  s_waitcnt vmcnt(3)
cB_sc3_ph2:
  v_smfmac_f32_16x16x64_bf16 v[60:63], v[24:27], v[232:239], v3
  ds_read_b128 v[8:11], v116 offset:6144
  ds_read_b128 v[12:15], v116 offset:7168
  v_smfmac_f32_16x16x64_bf16 v[60:63], v[28:31], v[240:247], v3
  buffer_load_dwordx4 v2, s[8:11], s59 offen offset:3072 sc1 lds
  v_smfmac_f32_16x16x64_bf16 v[60:63], v[32:35], v[248:255], v3
  v_mov_b32 v80, v30
  v_smfmac_f32_16x16x64_bf16 v[52:55], v[24:27], v[120:127], v3
  v_mov_b32 v81, v31
  v_smfmac_f32_16x16x64_bf16 v[52:55], v[28:31], v[128:135], v3
  v_mov_b32 v82, v34
  v_smfmac_f32_16x16x64_bf16 v[52:55], v[32:35], v[136:143], v3
  v_cvt_pk_bf16_f32 v66, v60, v61
  v_smfmac_f32_16x16x64_bf16 v[56:59], v[24:27], v[176:183], v3
  v_cvt_pk_bf16_f32 v67, v62, v63
  v_smfmac_f32_16x16x64_bf16 v[56:59], v[28:31], v[184:191], v3
  v_mov_b32 v83, v35
  v_mfma_f32_16x16x32_bf16 v[68:71], v[64:67], v[4:7], 0
  v_smfmac_f32_16x16x64_bf16 v[56:59], v[32:35], v[192:199], v3
  v_cvt_pk_bf16_f32 v64, v52, v53
  v_smfmac_f32_16x16x64_bf16 v[36:39], v[24:27], a[32:39], v3
  v_cvt_pk_bf16_f32 v65, v54, v55
  v_smfmac_f32_16x16x64_bf16 v[36:39], v[28:31], a[40:47], v3
  v_cvt_pk_bf16_f32 v78, v68, v69
  v_smfmac_f32_16x16x64_bf16 v[36:39], v[32:35], a[48:55], v3
  v_cvt_pk_bf16_f32 v79, v70, v71
  v_cvt_pk_bf16_f32 v66, v56, v57
  v_smfmac_f32_16x16x64_bf16 v[40:43], v[24:27], a[88:95], v3
  v_cvt_pk_bf16_f32 v67, v58, v59
  v_smfmac_f32_16x16x64_bf16 v[40:43], v[28:31], a[96:103], v3
  v_mfma_f32_16x16x32_bf16 v[72:75], v[64:67], v[4:7], 0
  ds_read_b128 v[52:55], v116 offset:20480
  ds_read_b128 v[56:59], v116 offset:21504
  v_smfmac_f32_16x16x64_bf16 v[40:43], v[32:35], a[104:111], v3
  v_cvt_pk_bf16_f32 v64, v36, v37
  v_smfmac_f32_16x16x64_bf16 v[44:47], v[24:27], a[144:151], v3
  v_cvt_pk_bf16_f32 v65, v38, v39
  v_smfmac_f32_16x16x64_bf16 v[44:47], v[28:31], a[152:159], v3
  v_cvt_pk_bf16_f32 v76, v72, v73
  v_smfmac_f32_16x16x64_bf16 v[44:47], v[32:35], a[160:167], v3
  v_cvt_pk_bf16_f32 v77, v74, v75
  v_cvt_pk_bf16_f32 v66, v40, v41
  v_smfmac_f32_16x16x64_bf16 v[48:51], v[24:27], a[200:207], v3
  v_cvt_pk_bf16_f32 v67, v42, v43
  v_smfmac_f32_16x16x64_bf16 v[48:51], v[28:31], a[208:215], v3
  v_mfma_f32_16x16x32_bf16 v[68:71], v[64:67], v[4:7], 0
  v_smfmac_f32_16x16x64_bf16 v[48:51], v[32:35], a[216:223], v3
  v_cvt_pk_bf16_f32 v64, v44, v45
  v_mfma_f32_16x16x32_bf16 v[84:87], v[80:83], v[76:79], 0
  v_cvt_pk_bf16_f32 v65, v46, v47
  s_waitcnt lgkmcnt(0)
  v_smfmac_f32_16x16x64_bf16 v[88:91], v[76:79], v[96:103], v118
  v_cvt_pk_bf16_f32 v60, v68, v69
  v_cvt_pk_bf16_f32 v61, v70, v71
  v_cvt_pk_bf16_f32 v66, v48, v49
  v_cvt_pk_bf16_f32 v67, v50, v51
  s_nop 1
  v_mfma_f32_16x16x32_bf16 v[72:75], v[64:67], v[4:7], 0
  v_smfmac_f32_16x16x64_bf16 v[92:95], v[76:79], v[104:111], v118
  s_nop 4
  v_cvt_pk_bf16_f32 v62, v72, v73
  v_cvt_pk_bf16_f32 v63, v74, v75
  s_nop 1
  v_mfma_f32_16x16x32_bf16 v[84:87], v[20:23], v[60:63], v[84:87]
  v_smfmac_f32_16x16x64_bf16 v[88:91], v[60:63], v[8:15], v118
  v_smfmac_f32_16x16x64_bf16 v[92:95], v[60:63], v[52:59], v118
  s_nop 1
  v_permlane32_swap_b32 v84, v86
  v_permlane32_swap_b32 v85, v87
  s_nop 0
  v_add_f32 v88, v88, v89
  v_add_f32_dpp v84, v86, v84 quad_perm:[1,0,3,2] row_mask:0xf bank_mask:0xf
  v_add_f32_dpp v85, v87, v85 quad_perm:[1,0,3,2] row_mask:0xf bank_mask:0xf
  v_add_f32 v89, v90, v91
  ds_write2_b32 v113, v84, v85 offset0:0 offset1:4
  ds_write2_b32 v112, v88, v89 offset0:0 offset1:128
  v_add_f32 v90, v92, v93
  v_add_f32 v91, v94, v95
  ds_write2_b32 v112, v90, v91 offset0:64 offset1:192
  v_cmp_u_f32 vcc, v88, v89
  s_cbranch_vccnz cB_sc3_retry
cB_sc3_cont:
  s_waitcnt lgkmcnt(0)
  s_barrier
  ds_read_b128 v[36:39], v114
  ds_read_b128 v[44:47], v115
  s_waitcnt lgkmcnt(0)
  v_add_f32 v36, v36, v38
  v_add_f32 v37, v37, v39
  v_add_f32 v44, v44, v45
  v_add_f32 v46, v46, v47
  v_add_f32 v44, v44, v46
  v_add_f32 v36, v36, v37
  v_exp_f32 v49, v44
  v_exp_f32 v48, v36
  v_add_f32 v50, abs(v36), abs(v44)
  v_fma_f32 v39, v49, s37, v48
  v_cmp_ngt_f32 vcc, s56, v50
  v_cndmask_b32 v41, v48, v49, s[38:39]
  v_add_f32_dpp v39, v39, v39 quad_perm:[1,0,3,2] row_mask:0xf bank_mask:0xf
  v_cndmask_b32 v40, v49, v48, s[38:39]
  v_mov_b32_dpp v46, v41 quad_perm:[1,0,3,2] row_mask:0xf bank_mask:0xf
  v_add_f32_dpp v39, v39, v39 quad_perm:[2,3,0,1] row_mask:0xf bank_mask:0xf
  v_cndmask_b32 v42, v46, v40, s[38:39]
  v_cndmask_b32 v43, v40, v46, s[38:39]
  v_add_f32_dpp v39, v39, v39 row_half_mirror row_mask:0xf bank_mask:0xf
  s_cbranch_vccnz cB_sc3_slow
  s_nop 0
  v_add_f32_dpp v47, v39, v39 row_mirror row_mask:0xf bank_mask:0xf
  v_add_f32_dpp v39, v39, v39 row_mirror row_mask:0xf bank_mask:0xf
  s_nop 1
  v_permlane16_swap_b32 v39, v47
  v_add_f32 v39, v39, v47
  v_rcp_f32 v39, v39
  s_mov_b64 exec, s[28:29]
  v_mul_f32 v42, v42, v39
  v_mul_f32 v43, v43, v39
  v_cvt_pk_bf16_f32 v42, v42, v43
cB_sc3_pst:
  buffer_store_dword v42, v1, s[8:11], s20 offen sc1
  s_mov_b64 exec, -1
  s_barrier
  s_add_u32 s24, s24, 28672
  s_add_u32 s35, s35, 28672
  s_xor_b32 s25, s25, 28672
  s_add_u32 m0, s25, 21504
  s_add_u32 m0, s25, 25600
  s_add_u32 s22, s24, 4096
  buffer_load_dwordx4 v2, s[8:11], s22 offen offset:0 sc1 lds
  v_mov_b32 v48, 0
  v_mov_b32 v49, 0
  v_mov_b32 v50, 0
  v_mov_b32 v51, 0
  v_mov_b32 v52, 0
  v_mov_b32 v53, 0
  buffer_load_dwordx4 v2, s[8:11], s22 offen offset:1024 sc1 lds
  v_mov_b32 v54, 0
  v_mov_b32 v55, 0
  v_mov_b32 v56, 0
  v_mov_b32 v57, 0
  v_mov_b32 v58, 0
  v_mov_b32 v59, 0
  buffer_load_dwordx4 v2, s[8:11], s22 offen offset:2048 sc1 lds
  v_mov_b32 v60, 0
  v_mov_b32 v61, 0
  v_mov_b32 v62, 0
  v_mov_b32 v63, 0
  v_mov_b32 v88, 0
  v_mov_b32 v89, 0
  v_mov_b32 v90, 0
  v_mov_b32 v91, 0
  v_mov_b32 v92, 0
  v_mov_b32 v93, 0
  v_mov_b32 v94, 0
  v_mov_b32 v95, 0
  v_mov_b32 v64, 0
  v_mov_b32 v65, 0
  v_xor_b32 v116, 28672, v116
  v_add_u32 v117, s57, v117
  s_sub_u32 s57, 0, s57
  s_add_u32 s19, s19, 1
  s_mov_b32 s20, s21
  s_cmp_lt_u32 s19, 63
  s_cbranch_scc1 cB_sc3_loop
  s_branch cB_done
cB_sc3_slow:
  v_max_f32 v50, v36, v44
  s_nop 1
  v_max_f32_dpp v50, v50, v50 quad_perm:[1,0,3,2] row_mask:0xf bank_mask:0xf
  s_nop 1
  v_max_f32_dpp v50, v50, v50 quad_perm:[2,3,0,1] row_mask:0xf bank_mask:0xf
  s_nop 1
  v_max_f32_dpp v50, v50, v50 row_half_mirror row_mask:0xf bank_mask:0xf
  s_nop 1
  v_max_f32_dpp v50, v50, v50 row_mirror row_mask:0xf bank_mask:0xf
  v_mov_b32 v47, v50
  s_nop 1
  v_permlane16_swap_b32 v50, v47
  v_max_f32 v50, v50, v47
  v_sub_f32 v48, v36, v50
  v_sub_f32 v49, v44, v50
  v_exp_f32 v48, v48
  v_exp_f32 v49, v49
  s_add_u32 s31, s31, 0x100
  v_fma_f32 v39, v49, s37, v48
  v_cndmask_b32 v41, v48, v49, s[38:39]
  s_nop 0
  v_add_f32_dpp v39, v39, v39 quad_perm:[1,0,3,2] row_mask:0xf bank_mask:0xf
  v_cndmask_b32 v40, v49, v48, s[38:39]
  v_mov_b32_dpp v46, v41 quad_perm:[1,0,3,2] row_mask:0xf bank_mask:0xf
  v_add_f32_dpp v39, v39, v39 quad_perm:[2,3,0,1] row_mask:0xf bank_mask:0xf
  v_cndmask_b32 v42, v46, v40, s[38:39]
  v_cndmask_b32 v43, v40, v46, s[38:39]
  v_add_f32_dpp v39, v39, v39 row_half_mirror row_mask:0xf bank_mask:0xf
  s_nop 1
  v_add_f32_dpp v47, v39, v39 row_mirror row_mask:0xf bank_mask:0xf
  v_add_f32_dpp v39, v39, v39 row_mirror row_mask:0xf bank_mask:0xf
  s_nop 1
  v_permlane16_swap_b32 v39, v47
  v_add_f32 v39, v39, v47
  v_rcp_f32 v39, v39
  s_mov_b64 exec, s[28:29]
  v_mul_f32 v42, v42, v39
  v_mul_f32 v43, v43, v39
  v_cvt_pk_bf16_f32 v42, v42, v43
  v_min_u32 v42, -2, v42
  s_branch cB_sc3_pst
cB_sc3_retry:
  s_cmp_lg_u32 s62, 0
  s_cbranch_scc1 cB_sc3_cont
  s_waitcnt vmcnt(0) lgkmcnt(0)
cB_sc3_rv:
  buffer_load_dwordx4 v[8:11], v2, s[8:11], s20 offen offset:0 sc1
  buffer_load_dwordx4 v[12:15], v2, s[8:11], s20 offen offset:1024 sc1
  buffer_load_dwordx4 v[16:19], v2, s[8:11], s20 offen offset:2048 sc1
  buffer_load_dwordx4 v[20:23], v2, s[8:11], s20 offen offset:3072 sc1
  buffer_load_dwordx4 v[24:27], v2, s[8:11], s23 offen offset:0 sc1
  buffer_load_dwordx4 v[28:31], v2, s[8:11], s23 offen offset:1024 sc1
  buffer_load_dwordx4 v[32:35], v2, s[8:11], s23 offen offset:2048 sc1
  s_waitcnt vmcnt(0)
  v_max3_u32 v68, v8, v9, v10
  v_max3_u32 v68, v68, v11, v12
  v_max3_u32 v68, v68, v13, v14
  v_max3_u32 v68, v68, v15, v16
  v_max3_u32 v68, v68, v17, v18
  v_max3_u32 v68, v68, v19, v20
  v_max3_u32 v68, v68, v21, v22
  v_max3_u32 v68, v68, v23, v24
  v_max3_u32 v68, v68, v25, v26
  v_max3_u32 v68, v68, v27, v28
  v_max3_u32 v68, v68, v29, v30
  v_max3_u32 v68, v68, v31, v32
  v_max3_u32 v68, v68, v33, v34
  v_max_u32 v68, v68, v35
  v_cmp_eq_u32 vcc, -1, v68
  s_cbranch_vccz cB_sc3_rk
  s_add_u32 s30, s30, 1
  s_cmp_lt_u32 s30, 400000
  s_cbranch_scc1 cB_sc3_rv
  s_branch cB_abort
cB_sc3_rk:
  s_mov_b32 s62, 1
  v_mov_b32 v36, 0
  v_mov_b32 v37, 0
  v_mov_b32 v38, 0
  v_mov_b32 v39, 0
  v_mov_b32 v40, 0
  v_mov_b32 v41, 0
  v_mov_b32 v42, 0
  v_mov_b32 v43, 0
  v_mov_b32 v44, 0
  v_mov_b32 v45, 0
  v_mov_b32 v46, 0
  v_mov_b32 v47, 0
  v_mov_b32 v48, 0
  v_mov_b32 v49, 0
  v_mov_b32 v50, 0
  v_mov_b32 v51, 0
  v_mov_b32 v52, 0
  v_mov_b32 v53, 0
  v_mov_b32 v54, 0
  v_mov_b32 v55, 0
  v_mov_b32 v56, 0
  v_mov_b32 v57, 0
  v_mov_b32 v58, 0
  v_mov_b32 v59, 0
  v_mov_b32 v60, 0
  v_mov_b32 v61, 0
  v_mov_b32 v62, 0
  v_mov_b32 v63, 0
  v_mov_b32 v88, 0
  v_mov_b32 v89, 0
  v_mov_b32 v90, 0
  v_mov_b32 v91, 0
  v_mov_b32 v92, 0
  v_mov_b32 v93, 0
  v_mov_b32 v94, 0
  v_mov_b32 v95, 0
  v_mov_b32 v64, 0
  v_mov_b32 v65, 0
  s_add_u32 s31, s31, 1
  ds_read_b128 v[96:99], v117 offset:0
  ds_read_b128 v[100:103], v117 offset:1024
  ds_read_b128 v[104:107], v117 offset:14336
  ds_read_b128 v[108:111], v117 offset:15360
  v_smfmac_f32_16x16x64_bf16 v[36:39], v[8:11], a[0:7], v3
  v_smfmac_f32_16x16x64_bf16 v[40:43], v[8:11], a[56:63], v3
  v_smfmac_f32_16x16x64_bf16 v[44:47], v[8:11], a[112:119], v3
  v_smfmac_f32_16x16x64_bf16 v[48:51], v[8:11], a[168:175], v3
  v_smfmac_f32_16x16x64_bf16 v[52:55], v[8:11], a[224:231], v3
  v_smfmac_f32_16x16x64_bf16 v[56:59], v[8:11], v[144:151], v3
  v_smfmac_f32_16x16x64_bf16 v[60:63], v[8:11], v[200:207], v3
  v_smfmac_f32_16x16x64_bf16 v[36:39], v[12:15], a[8:15], v3
  v_smfmac_f32_16x16x64_bf16 v[40:43], v[12:15], a[64:71], v3
  v_smfmac_f32_16x16x64_bf16 v[44:47], v[12:15], a[120:127], v3
  v_smfmac_f32_16x16x64_bf16 v[48:51], v[12:15], a[176:183], v3
  v_smfmac_f32_16x16x64_bf16 v[52:55], v[12:15], a[232:239], v3
  v_smfmac_f32_16x16x64_bf16 v[56:59], v[12:15], v[152:159], v3
  v_smfmac_f32_16x16x64_bf16 v[60:63], v[12:15], v[208:215], v3
  v_smfmac_f32_16x16x64_bf16 v[36:39], v[16:19], a[16:23], v3
  v_smfmac_f32_16x16x64_bf16 v[40:43], v[16:19], a[72:79], v3
  v_smfmac_f32_16x16x64_bf16 v[44:47], v[16:19], a[128:135], v3
  v_smfmac_f32_16x16x64_bf16 v[48:51], v[16:19], a[184:191], v3
  v_smfmac_f32_16x16x64_bf16 v[52:55], v[16:19], a[240:247], v3
  v_smfmac_f32_16x16x64_bf16 v[56:59], v[16:19], v[160:167], v3
  v_smfmac_f32_16x16x64_bf16 v[60:63], v[16:19], v[216:223], v3
  v_smfmac_f32_16x16x64_bf16 v[36:39], v[20:23], a[24:31], v3
  v_smfmac_f32_16x16x64_bf16 v[40:43], v[20:23], a[80:87], v3
  v_smfmac_f32_16x16x64_bf16 v[44:47], v[20:23], a[136:143], v3
  v_smfmac_f32_16x16x64_bf16 v[48:51], v[20:23], a[192:199], v3
  v_smfmac_f32_16x16x64_bf16 v[52:55], v[20:23], a[248:255], v3
  v_smfmac_f32_16x16x64_bf16 v[56:59], v[20:23], v[168:175], v3
  v_smfmac_f32_16x16x64_bf16 v[60:63], v[20:23], v[224:231], v3
  s_xor_b32 s58, s25, 28672
  s_add_u32 s59, s24, 28672
  s_add_u32 m0, s58, 21504
  s_branch cB_sc3_ph2
.p2align 6

cB_va0_loop:
  s_add_u32 s23, s20, 4096
  s_add_u32 s21, s20, 20480
  s_mov_b32 s30, 0
  s_cmp_lg_u32 s19, s38
  s_cbranch_scc1 cB_va0_vok
  s_branch cB_va0_voc
cB_va0_vow:
  s_sub_u32 s22, s39, s35
  v_lshlrev_b32 v63, 7, v2
  v_min_u32 v63, s22, v63
  buffer_load_dword v63, v63, s[8:11], s35 offen sc1
  s_waitcnt vmcnt(0)
cB_va0_voc:
  v_readfirstlane_b32 s22, v63
  s_cmp_eq_u32 s22, 56
  s_cbranch_scc1 cB_va0_vod
  s_sleep 1
  s_add_u32 s30, s30, 1
  s_cmp_lt_u32 s30, 400000
  s_cbranch_scc1 cB_va0_vow
  s_branch cB_abort
cB_va0_vod:
  s_add_u32 s35, s35, 2048
  s_add_u32 s38, s19, 8
  s_and_b32 s38, s38, -8
  s_cmp_eq_u32 s19, 0
  s_cselect_b32 s38, 4, s38
  v_cmp_ne_u32 vcc, 56, v63
  s_nop 3
  s_cmp_eq_u64 vcc, 0
  s_cselect_b32 s38, 99, s38
cB_va0_vok:
  s_cmp_eq_u32 s19, 63
  s_cbranch_scc1 cB_done
  s_barrier
  s_add_u32 s22, s25, 0
  buffer_load_dwordx4 v[80:83], v6, s[8:11], s22 offen offset:0 sc1
  buffer_load_dwordx4 v[84:87], v6, s[8:11], s22 offen offset:1792 sc1
  s_add_u32 s22, s25, 3584
  buffer_load_dwordx4 v[88:91], v6, s[8:11], s22 offen offset:0 sc1
  buffer_load_dwordx4 v[92:95], v6, s[8:11], s22 offen offset:1792 sc1
  s_add_u32 s22, s25, 7168
  buffer_load_dwordx4 v[96:99], v6, s[8:11], s22 offen offset:0 sc1
  buffer_load_dwordx4 v[100:103], v6, s[8:11], s22 offen offset:1792 sc1
  s_add_u32 s22, s25, 10752
  buffer_load_dwordx4 v[104:107], v6, s[8:11], s22 offen offset:0 sc1
  buffer_load_dwordx4 v[108:111], v6, s[8:11], s22 offen offset:1792 sc1
  s_add_u32 s22, s25, 14336
  buffer_load_dwordx4 v[112:115], v6, s[8:11], s22 offen offset:0 sc1
  buffer_load_dwordx4 v[116:119], v6, s[8:11], s22 offen offset:1792 sc1
  s_add_u32 s22, s25, 17920
  buffer_load_dwordx4 v[120:123], v6, s[8:11], s22 offen offset:0 sc1
  buffer_load_dwordx4 v[124:127], v6, s[8:11], s22 offen offset:1792 sc1
  s_add_u32 s22, s19, 1
  s_cmp_lg_u32 s22, s38
  s_cbranch_scc1 cB_va0_nk
  s_sub_u32 s22, s39, s35
  v_lshlrev_b32 v63, 7, v2
  v_min_u32 v63, s22, v63
  buffer_load_dword v63, v63, s[8:11], s35 offen sc1
cB_va0_nk:
  s_barrier
  ds_read_b128 v[8:11], v0 offset:8192
  ds_read_b128 v[12:15], v0 offset:9216
  ds_read_b128 v[16:19], v0 offset:10240
  ds_read_b128 v[20:23], v0 offset:11264
  ds_read_b128 v[24:27], v0 offset:12288
  ds_read_b128 v[28:31], v0 offset:13312
  ds_read_b128 v[32:35], v0 offset:14336
  s_waitcnt lgkmcnt(0)
  v_smfmac_f32_16x16x64_bf16 v[36:39], v[8:11], a[0:7], v3
  s_add_u32 s22, s25, 21504
  buffer_load_dwordx4 v[128:131], v6, s[8:11], s22 offen offset:0 sc1
  v_smfmac_f32_16x16x64_bf16 v[36:39], v[12:15], a[8:15], v3
  v_smfmac_f32_16x16x64_bf16 v[36:39], v[16:19], a[16:23], v3
  s_add_u32 s22, s25, 21504
  buffer_load_dwordx4 v[132:135], v6, s[8:11], s22 offen offset:1792 sc1
  v_smfmac_f32_16x16x64_bf16 v[36:39], v[20:23], a[24:31], v3
  v_smfmac_f32_16x16x64_bf16 v[36:39], v[24:27], a[32:39], v3
  s_add_u32 s22, s25, 25088
  buffer_load_dwordx4 v[136:139], v6, s[8:11], s22 offen offset:0 sc1
  v_smfmac_f32_16x16x64_bf16 v[36:39], v[28:31], a[40:47], v3
  v_smfmac_f32_16x16x64_bf16 v[36:39], v[32:35], a[48:55], v3
  s_add_u32 s22, s25, 25088
  buffer_load_dwordx4 v[140:143], v6, s[8:11], s22 offen offset:1792 sc1
  v_smfmac_f32_16x16x64_bf16 v[40:43], v[8:11], a[56:63], v3
  v_smfmac_f32_16x16x64_bf16 v[40:43], v[12:15], a[64:71], v3
  v_smfmac_f32_16x16x64_bf16 v[40:43], v[16:19], a[72:79], v3
  v_add_f32 v36, v36, v37
  v_smfmac_f32_16x16x64_bf16 v[40:43], v[20:23], a[80:87], v3
  v_add_f32 v38, v38, v39
  v_smfmac_f32_16x16x64_bf16 v[40:43], v[24:27], a[88:95], v3
  v_cvt_pk_bf16_f32 v36, v36, v38
  v_smfmac_f32_16x16x64_bf16 v[40:43], v[28:31], a[96:103], v3
  ds_write_b32 v60, v36
  v_smfmac_f32_16x16x64_bf16 v[40:43], v[32:35], a[104:111], v3
  v_smfmac_f32_16x16x64_bf16 v[44:47], v[8:11], a[112:119], v3
  v_smfmac_f32_16x16x64_bf16 v[44:47], v[12:15], a[120:127], v3
  v_smfmac_f32_16x16x64_bf16 v[44:47], v[16:19], a[128:135], v3
  v_add_f32 v40, v40, v41
  v_smfmac_f32_16x16x64_bf16 v[44:47], v[20:23], a[136:143], v3
  v_add_f32 v42, v42, v43
  v_smfmac_f32_16x16x64_bf16 v[44:47], v[24:27], a[144:151], v3
  v_cvt_pk_bf16_f32 v40, v40, v42
  v_smfmac_f32_16x16x64_bf16 v[44:47], v[28:31], a[152:159], v3
  ds_write_b32 v61, v40
  v_smfmac_f32_16x16x64_bf16 v[44:47], v[32:35], a[160:167], v3
  v_smfmac_f32_16x16x64_bf16 v[48:51], v[8:11], a[168:175], v3
  v_smfmac_f32_16x16x64_bf16 v[48:51], v[12:15], a[176:183], v3
  v_smfmac_f32_16x16x64_bf16 v[48:51], v[16:19], a[184:191], v3
  v_add_f32 v44, v44, v45
  v_smfmac_f32_16x16x64_bf16 v[48:51], v[20:23], a[192:199], v3
  v_add_f32 v46, v46, v47
  v_smfmac_f32_16x16x64_bf16 v[48:51], v[24:27], a[200:207], v3
  v_cvt_pk_bf16_f32 v44, v44, v46
  v_smfmac_f32_16x16x64_bf16 v[48:51], v[28:31], a[208:215], v3
  ds_write_b32 v62, v44
  v_smfmac_f32_16x16x64_bf16 v[48:51], v[32:35], a[216:223], v3
  v_smfmac_f32_16x16x64_bf16 v[52:55], v[8:11], a[224:231], v3
  v_smfmac_f32_16x16x64_bf16 v[52:55], v[12:15], a[232:239], v3
  v_smfmac_f32_16x16x64_bf16 v[52:55], v[16:19], a[240:247], v3
  v_add_f32 v48, v48, v49
  v_smfmac_f32_16x16x64_bf16 v[52:55], v[20:23], a[248:255], v3
  v_add_f32 v50, v50, v51
  v_smfmac_f32_16x16x64_bf16 v[52:55], v[24:27], v[176:183], v3
  v_cvt_pk_bf16_f32 v48, v48, v50
  v_smfmac_f32_16x16x64_bf16 v[52:55], v[28:31], v[184:191], v3
  ds_write_b32 v170, v48
  v_smfmac_f32_16x16x64_bf16 v[52:55], v[32:35], v[192:199], v3
  v_smfmac_f32_16x16x64_bf16 v[56:59], v[8:11], v[200:207], v3
  v_smfmac_f32_16x16x64_bf16 v[56:59], v[12:15], v[208:215], v3
  v_smfmac_f32_16x16x64_bf16 v[56:59], v[16:19], v[216:223], v3
  v_add_f32 v52, v52, v53
  v_smfmac_f32_16x16x64_bf16 v[56:59], v[20:23], v[224:231], v3
  v_add_f32 v54, v54, v55
  v_smfmac_f32_16x16x64_bf16 v[56:59], v[24:27], v[232:239], v3
  v_cvt_pk_bf16_f32 v52, v52, v54
  v_smfmac_f32_16x16x64_bf16 v[56:59], v[28:31], v[240:247], v3
  ds_write_b32 v171, v52
  v_smfmac_f32_16x16x64_bf16 v[56:59], v[32:35], v[248:255], v3
  s_nop 7
  v_add_f32 v56, v56, v57
  v_add_f32 v58, v58, v59
  v_cvt_pk_bf16_f32 v56, v56, v58
  ds_write_b32 v172, v56
  buffer_load_dword v164, v4, s[8:11], s20 offen sc1
  s_waitcnt lgkmcnt(0)
  v_mov_b32 v36, 0
  v_mov_b32 v37, 0
  v_mov_b32 v38, 0
  v_mov_b32 v39, 0
  v_mov_b32 v40, 0
  v_mov_b32 v41, 0
  v_mov_b32 v42, 0
  v_mov_b32 v43, 0
  buffer_load_dword v165, v4, s[8:11], s20 offen sc1
  v_mov_b32 v44, 0
  v_mov_b32 v45, 0
  v_mov_b32 v46, 0
  v_mov_b32 v47, 0
  v_mov_b32 v48, 0
  v_mov_b32 v49, 0
  v_mov_b32 v50, 0
  v_mov_b32 v51, 0
  buffer_load_dword v166, v4, s[8:11], s20 offen sc1
  v_mov_b32 v52, 0
  v_mov_b32 v53, 0
  v_mov_b32 v54, 0
  v_mov_b32 v55, 0
  v_mov_b32 v56, 0
  v_mov_b32 v57, 0
  v_mov_b32 v58, 0
  v_mov_b32 v59, 0
  buffer_load_dword v167, v4, s[8:11], s20 offen sc1
  s_cmp_eq_u32 s19, 63
  s_cbranch_scc1 cB_va0_last
  s_add_u32 s22, s20, 9216
  s_add_u32 s34, s20, 13312
  s_add_u32 s36, s20, 7168
  s_mov_b32 s37, 0
  v_mov_b32 v156, 0
  v_mov_b32 v157, 0
  v_mov_b32 v158, 0
  v_mov_b32 v159, 0
  buffer_load_dword v168, v4, s[8:11], s20 offen sc1
cB_va0_fw_l:
  s_waitcnt vmcnt(4)
  v_cmp_eq_u32 vcc, -1, v164
  s_cbranch_vccz cB_va0_fw_d
  buffer_load_dword v164, v4, s[8:11], s20 offen sc1
  s_waitcnt vmcnt(4)
  v_cmp_eq_u32 vcc, -1, v165
  s_cbranch_vccz cB_va0_fw_d
  buffer_load_dword v165, v4, s[8:11], s20 offen sc1
  s_waitcnt vmcnt(4)
  v_cmp_eq_u32 vcc, -1, v166
  s_cbranch_vccz cB_va0_fw_d
  buffer_load_dword v166, v4, s[8:11], s20 offen sc1
  s_waitcnt vmcnt(4)
  v_cmp_eq_u32 vcc, -1, v167
  s_cbranch_vccz cB_va0_fw_d
  buffer_load_dword v167, v4, s[8:11], s20 offen sc1
  s_waitcnt vmcnt(4)
  v_cmp_eq_u32 vcc, -1, v168
  s_cbranch_vccz cB_va0_fw_d
  buffer_load_dword v168, v4, s[8:11], s20 offen sc1
  s_add_u32 s30, s30, 1
  s_cmp_lt_u32 s30, 400000
  s_cbranch_scc1 cB_va0_fw_l
  s_branch cB_abort
cB_va0_fw_d:
  s_waitcnt lgkmcnt(0)
  buffer_load_dwordx4 v[8:11], v5, s[8:11], s22 offen offset:0 sc1
  buffer_load_dwordx4 v[12:15], v5, s[8:11], s22 offen offset:1024 sc1
  buffer_load_dwordx4 v[16:19], v5, s[8:11], s22 offen offset:2048 sc1
  buffer_load_dwordx4 v[20:23], v5, s[8:11], s22 offen offset:3072 sc1
  buffer_load_dwordx4 v[24:27], v5, s[8:11], s34 offen offset:0 sc1
  buffer_load_dwordx4 v[28:31], v5, s[8:11], s34 offen offset:1024 sc1
  buffer_load_dwordx4 v[32:35], v5, s[8:11], s34 offen offset:2048 sc1
  buffer_load_dwordx4 v[144:147], v5, s[8:11], s34 offen offset:3072 sc1
  buffer_load_dwordx4 v[148:151], v2, s[8:11], s36 offen offset:0 sc1
  buffer_load_dwordx4 v[152:155], v2, s[8:11], s36 offen offset:1024 sc1
  s_barrier
  ds_read_b128 v[64:67], v2 offset:0
  ds_read_b128 v[68:71], v2 offset:1024
  ds_read_b128 v[72:75], v2 offset:2048
  ds_read_b128 v[76:79], v2 offset:3072
  s_waitcnt vmcnt(9)
  v_smfmac_f32_16x16x64_bf16 v[156:159], v[8:11], v[80:87], v3
  s_waitcnt vmcnt(8)
  v_smfmac_f32_16x16x64_bf16 v[156:159], v[12:15], v[88:95], v3
  s_waitcnt vmcnt(7)
  v_smfmac_f32_16x16x64_bf16 v[156:159], v[16:19], v[96:103], v3
  s_waitcnt vmcnt(6)
  v_smfmac_f32_16x16x64_bf16 v[156:159], v[20:23], v[104:111], v3
  s_waitcnt vmcnt(5)
  v_smfmac_f32_16x16x64_bf16 v[156:159], v[24:27], v[112:119], v3
  s_waitcnt vmcnt(4)
  v_smfmac_f32_16x16x64_bf16 v[156:159], v[28:31], v[120:127], v3
  s_waitcnt vmcnt(3)
  v_smfmac_f32_16x16x64_bf16 v[156:159], v[32:35], v[128:135], v3
  s_waitcnt vmcnt(2)
  v_smfmac_f32_16x16x64_bf16 v[156:159], v[144:147], v[136:143], v3
  s_waitcnt vmcnt(1) lgkmcnt(0)
  v_smfmac_f32_16x16x64_bf16 v[156:159], v[148:151], v[64:71], v3
  s_waitcnt vmcnt(0)
  v_smfmac_f32_16x16x64_bf16 v[156:159], v[152:155], v[72:79], v3
cB_va0_ep:
  s_nop 7
  v_add_f32 v160, v156, v157
  v_add_f32 v161, v158, v159
  v_cmp_u_f32 vcc, v160, v161
  v_mov_b32_dpp v162, v160 row_ror:8 row_mask:0xf bank_mask:0xf
  v_mov_b32_dpp v160, v161 row_ror:8 row_mask:0xf bank_mask:0xc
  s_cbranch_vccnz cB_va0_rp
  v_mov_b32_dpp v161, v162 quad_perm:[0,1,2,3] row_mask:0xf bank_mask:0x3
  v_cvt_pk_bf16_f32 v160, v160, v161
cB_va0_pc:
  buffer_store_dword v160, v1, s[8:11], s21 offen sc1
  s_cmp_lg_u32 s19, 62
  s_cbranch_scc1 cB_va0_nl
  s_mov_b32 s22, 88531968
  buffer_store_dword v160, v1, s[8:11], s22 offen sc1
  s_mov_b64 exec, -1
  s_branch cB_done
cB_va0_nl:
  s_mov_b64 exec, -1
  s_add_u32 s25, s25, 28672
  s_add_u32 s19, s19, 1
  s_mov_b32 s20, s21
  s_branch cB_va0_loop
cB_va0_last:
  s_waitcnt lgkmcnt(0)
  s_barrier
  s_branch cB_done
cB_va0_rp:
  s_cmp_eq_u32 s37, 0
  s_cbranch_scc1 cB_va0_rv
  v_mov_b32_dpp v161, v162 quad_perm:[0,1,2,3] row_mask:0xf bank_mask:0x3
  v_cvt_pk_bf16_f32 v160, v160, v161
  v_min_u32 v160, -2, v160
  s_branch cB_va0_pc
cB_va0_rv:
  buffer_load_dwordx4 v[8:11], v5, s[8:11], s22 offen offset:0 sc1
  buffer_load_dwordx4 v[12:15], v5, s[8:11], s22 offen offset:1024 sc1
  buffer_load_dwordx4 v[16:19], v5, s[8:11], s22 offen offset:2048 sc1
  buffer_load_dwordx4 v[20:23], v5, s[8:11], s22 offen offset:3072 sc1
  buffer_load_dwordx4 v[24:27], v5, s[8:11], s34 offen offset:0 sc1
  buffer_load_dwordx4 v[28:31], v5, s[8:11], s34 offen offset:1024 sc1
  buffer_load_dwordx4 v[32:35], v5, s[8:11], s34 offen offset:2048 sc1
  buffer_load_dwordx4 v[144:147], v5, s[8:11], s34 offen offset:3072 sc1
  buffer_load_dwordx4 v[148:151], v2, s[8:11], s36 offen offset:0 sc1
  buffer_load_dwordx4 v[152:155], v2, s[8:11], s36 offen offset:1024 sc1
  s_waitcnt vmcnt(0)
  v_max3_u32 v175, v8, v9, v10
  v_max3_u32 v175, v175, v11, v12
  v_max3_u32 v175, v175, v13, v14
  v_max3_u32 v175, v175, v15, v16
  v_max3_u32 v175, v175, v17, v18
  v_max3_u32 v175, v175, v19, v20
  v_max3_u32 v175, v175, v21, v22
  v_max3_u32 v175, v175, v23, v24
  v_max3_u32 v175, v175, v25, v26
  v_max3_u32 v175, v175, v27, v28
  v_max3_u32 v175, v175, v29, v30
  v_max3_u32 v175, v175, v31, v32
  v_max3_u32 v175, v175, v33, v34
  v_max3_u32 v175, v175, v35, v144
  v_max3_u32 v175, v175, v145, v146
  v_max3_u32 v175, v175, v147, v148
  v_max3_u32 v175, v175, v149, v150
  v_max3_u32 v175, v175, v151, v152
  v_max3_u32 v175, v175, v153, v154
  v_max_u32 v175, v175, v155
  v_cmp_eq_u32 vcc, -1, v175
  s_cbranch_vccz cB_va0_rk
  s_add_u32 s30, s30, 1
  s_cmp_lt_u32 s30, 400000
  s_cbranch_scc1 cB_va0_rv
  s_branch cB_abort
cB_va0_rk:
  s_mov_b32 s37, 1
  s_add_u32 s31, s31, 0x10000
  v_mov_b32 v156, 0
  v_mov_b32 v157, 0
  v_mov_b32 v158, 0
  v_mov_b32 v159, 0
  s_nop 1
  v_smfmac_f32_16x16x64_bf16 v[156:159], v[8:11], v[80:87], v3
  v_smfmac_f32_16x16x64_bf16 v[156:159], v[12:15], v[88:95], v3
  v_smfmac_f32_16x16x64_bf16 v[156:159], v[16:19], v[96:103], v3
  v_smfmac_f32_16x16x64_bf16 v[156:159], v[20:23], v[104:111], v3
  v_smfmac_f32_16x16x64_bf16 v[156:159], v[24:27], v[112:119], v3
  v_smfmac_f32_16x16x64_bf16 v[156:159], v[28:31], v[120:127], v3
  v_smfmac_f32_16x16x64_bf16 v[156:159], v[32:35], v[128:135], v3
  v_smfmac_f32_16x16x64_bf16 v[156:159], v[144:147], v[136:143], v3
  v_smfmac_f32_16x16x64_bf16 v[156:159], v[148:151], v[64:71], v3
  v_smfmac_f32_16x16x64_bf16 v[156:159], v[152:155], v[72:79], v3
  s_nop 7
  s_branch cB_va0_ep
.p2align 6

cB_va1_loop:
  s_add_u32 s23, s20, 4096
  s_add_u32 s21, s20, 20480
  s_mov_b32 s30, 0
  s_cmp_lg_u32 s19, s38
  s_cbranch_scc1 cB_va1_vok
  s_branch cB_va1_voc
cB_va1_vow:
  s_sub_u32 s22, s39, s35
  v_lshlrev_b32 v63, 7, v2
  v_min_u32 v63, s22, v63
  buffer_load_dword v63, v63, s[8:11], s35 offen sc1
  s_waitcnt vmcnt(0)
cB_va1_voc:
  v_readfirstlane_b32 s22, v63
  s_cmp_eq_u32 s22, 56
  s_cbranch_scc1 cB_va1_vod
  s_sleep 1
  s_add_u32 s30, s30, 1
  s_cmp_lt_u32 s30, 400000
  s_cbranch_scc1 cB_va1_vow
  s_branch cB_abort
cB_va1_vod:
  s_add_u32 s35, s35, 2048
  s_add_u32 s38, s19, 8
  s_and_b32 s38, s38, -8
  s_cmp_eq_u32 s19, 0
  s_cselect_b32 s38, 4, s38
  v_cmp_ne_u32 vcc, 56, v63
  s_nop 3
  s_cmp_eq_u64 vcc, 0
  s_cselect_b32 s38, 99, s38
cB_va1_vok:
  s_cmp_eq_u32 s19, 63
  s_cbranch_scc1 cB_done
  s_barrier
  s_add_u32 s22, s25, 0
  buffer_load_dwordx4 v[80:83], v6, s[8:11], s22 offen offset:0 sc1
  buffer_load_dwordx4 v[84:87], v6, s[8:11], s22 offen offset:1792 sc1
  s_add_u32 s22, s25, 3584
  buffer_load_dwordx4 v[88:91], v6, s[8:11], s22 offen offset:0 sc1
  buffer_load_dwordx4 v[92:95], v6, s[8:11], s22 offen offset:1792 sc1
  s_add_u32 s22, s25, 7168
  buffer_load_dwordx4 v[96:99], v6, s[8:11], s22 offen offset:0 sc1
  buffer_load_dwordx4 v[100:103], v6, s[8:11], s22 offen offset:1792 sc1
  s_add_u32 s22, s25, 10752
  buffer_load_dwordx4 v[104:107], v6, s[8:11], s22 offen offset:0 sc1
  buffer_load_dwordx4 v[108:111], v6, s[8:11], s22 offen offset:1792 sc1
  s_add_u32 s22, s25, 14336
  buffer_load_dwordx4 v[112:115], v6, s[8:11], s22 offen offset:0 sc1
  buffer_load_dwordx4 v[116:119], v6, s[8:11], s22 offen offset:1792 sc1
  s_add_u32 s22, s25, 17920
  buffer_load_dwordx4 v[120:123], v6, s[8:11], s22 offen offset:0 sc1
  buffer_load_dwordx4 v[124:127], v6, s[8:11], s22 offen offset:1792 sc1
  s_add_u32 s22, s19, 1
  s_cmp_lg_u32 s22, s38
  s_cbranch_scc1 cB_va1_nk
  s_sub_u32 s22, s39, s35
  v_lshlrev_b32 v63, 7, v2
  v_min_u32 v63, s22, v63
  buffer_load_dword v63, v63, s[8:11], s35 offen sc1
cB_va1_nk:
  s_barrier
  ds_read_b128 v[8:11], v0 offset:8192
  ds_read_b128 v[12:15], v0 offset:9216
  ds_read_b128 v[16:19], v0 offset:10240
  ds_read_b128 v[20:23], v0 offset:11264
  ds_read_b128 v[24:27], v0 offset:12288
  ds_read_b128 v[28:31], v0 offset:13312
  ds_read_b128 v[32:35], v0 offset:14336
  s_waitcnt lgkmcnt(0)
  v_smfmac_f32_16x16x64_bf16 v[36:39], v[8:11], a[0:7], v3
  s_add_u32 s22, s25, 21504
  buffer_load_dwordx4 v[128:131], v6, s[8:11], s22 offen offset:0 sc1
  v_smfmac_f32_16x16x64_bf16 v[36:39], v[12:15], a[8:15], v3
  v_smfmac_f32_16x16x64_bf16 v[36:39], v[16:19], a[16:23], v3
  s_add_u32 s22, s25, 21504
  buffer_load_dwordx4 v[132:135], v6, s[8:11], s22 offen offset:1792 sc1
  v_smfmac_f32_16x16x64_bf16 v[36:39], v[20:23], a[24:31], v3
  v_smfmac_f32_16x16x64_bf16 v[36:39], v[24:27], a[32:39], v3
  s_add_u32 s22, s25, 25088
  buffer_load_dwordx4 v[136:139], v6, s[8:11], s22 offen offset:0 sc1
  v_smfmac_f32_16x16x64_bf16 v[36:39], v[28:31], a[40:47], v3
  v_smfmac_f32_16x16x64_bf16 v[36:39], v[32:35], a[48:55], v3
  s_add_u32 s22, s25, 25088
  buffer_load_dwordx4 v[140:143], v6, s[8:11], s22 offen offset:1792 sc1
  v_smfmac_f32_16x16x64_bf16 v[40:43], v[8:11], a[56:63], v3
  v_smfmac_f32_16x16x64_bf16 v[40:43], v[12:15], a[64:71], v3
  v_smfmac_f32_16x16x64_bf16 v[40:43], v[16:19], a[72:79], v3
  v_add_f32 v36, v36, v37
  v_smfmac_f32_16x16x64_bf16 v[40:43], v[20:23], a[80:87], v3
  v_add_f32 v38, v38, v39
  v_smfmac_f32_16x16x64_bf16 v[40:43], v[24:27], a[88:95], v3
  v_cvt_pk_bf16_f32 v36, v36, v38
  v_smfmac_f32_16x16x64_bf16 v[40:43], v[28:31], a[96:103], v3
  ds_write_b32 v60, v36
  v_smfmac_f32_16x16x64_bf16 v[40:43], v[32:35], a[104:111], v3
  v_smfmac_f32_16x16x64_bf16 v[44:47], v[8:11], a[112:119], v3
  v_smfmac_f32_16x16x64_bf16 v[44:47], v[12:15], a[120:127], v3
  v_smfmac_f32_16x16x64_bf16 v[44:47], v[16:19], a[128:135], v3
  v_add_f32 v40, v40, v41
  v_smfmac_f32_16x16x64_bf16 v[44:47], v[20:23], a[136:143], v3
  v_add_f32 v42, v42, v43
  v_smfmac_f32_16x16x64_bf16 v[44:47], v[24:27], a[144:151], v3
  v_cvt_pk_bf16_f32 v40, v40, v42
  v_smfmac_f32_16x16x64_bf16 v[44:47], v[28:31], a[152:159], v3
  ds_write_b32 v61, v40
  v_smfmac_f32_16x16x64_bf16 v[44:47], v[32:35], a[160:167], v3
  v_smfmac_f32_16x16x64_bf16 v[48:51], v[8:11], a[168:175], v3
  v_smfmac_f32_16x16x64_bf16 v[48:51], v[12:15], a[176:183], v3
  v_smfmac_f32_16x16x64_bf16 v[48:51], v[16:19], a[184:191], v3
  v_add_f32 v44, v44, v45
  v_smfmac_f32_16x16x64_bf16 v[48:51], v[20:23], a[192:199], v3
  v_add_f32 v46, v46, v47
  v_smfmac_f32_16x16x64_bf16 v[48:51], v[24:27], a[200:207], v3
  v_cvt_pk_bf16_f32 v44, v44, v46
  v_smfmac_f32_16x16x64_bf16 v[48:51], v[28:31], a[208:215], v3
  ds_write_b32 v62, v44
  v_smfmac_f32_16x16x64_bf16 v[48:51], v[32:35], a[216:223], v3
  v_smfmac_f32_16x16x64_bf16 v[52:55], v[8:11], a[224:231], v3
  v_smfmac_f32_16x16x64_bf16 v[52:55], v[12:15], a[232:239], v3
  v_smfmac_f32_16x16x64_bf16 v[52:55], v[16:19], a[240:247], v3
  v_add_f32 v48, v48, v49
  v_smfmac_f32_16x16x64_bf16 v[52:55], v[20:23], a[248:255], v3
  v_add_f32 v50, v50, v51
  v_smfmac_f32_16x16x64_bf16 v[52:55], v[24:27], v[176:183], v3
  v_cvt_pk_bf16_f32 v48, v48, v50
  v_smfmac_f32_16x16x64_bf16 v[52:55], v[28:31], v[184:191], v3
  ds_write_b32 v170, v48
  v_smfmac_f32_16x16x64_bf16 v[52:55], v[32:35], v[192:199], v3
  v_smfmac_f32_16x16x64_bf16 v[56:59], v[8:11], v[200:207], v3
  v_smfmac_f32_16x16x64_bf16 v[56:59], v[12:15], v[208:215], v3
  v_smfmac_f32_16x16x64_bf16 v[56:59], v[16:19], v[216:223], v3
  v_add_f32 v52, v52, v53
  v_smfmac_f32_16x16x64_bf16 v[56:59], v[20:23], v[224:231], v3
  v_add_f32 v54, v54, v55
  v_smfmac_f32_16x16x64_bf16 v[56:59], v[24:27], v[232:239], v3
  v_cvt_pk_bf16_f32 v52, v52, v54
  v_smfmac_f32_16x16x64_bf16 v[56:59], v[28:31], v[240:247], v3
  ds_write_b32 v171, v52
  v_smfmac_f32_16x16x64_bf16 v[56:59], v[32:35], v[248:255], v3
  s_nop 7
  v_add_f32 v56, v56, v57
  v_add_f32 v58, v58, v59
  v_cvt_pk_bf16_f32 v56, v56, v58
  ds_write_b32 v172, v56
  s_waitcnt lgkmcnt(0)
  v_mov_b32 v36, 0
  v_mov_b32 v37, 0
  v_mov_b32 v38, 0
  v_mov_b32 v39, 0
  v_mov_b32 v40, 0
  v_mov_b32 v41, 0
  v_mov_b32 v42, 0
  v_mov_b32 v43, 0
  v_mov_b32 v44, 0
  v_mov_b32 v45, 0
  v_mov_b32 v46, 0
  v_mov_b32 v47, 0
  v_mov_b32 v48, 0
  v_mov_b32 v49, 0
  v_mov_b32 v50, 0
  v_mov_b32 v51, 0
  v_mov_b32 v52, 0
  v_mov_b32 v53, 0
  v_mov_b32 v54, 0
  v_mov_b32 v55, 0
  v_mov_b32 v56, 0
  v_mov_b32 v57, 0
  v_mov_b32 v58, 0
  v_mov_b32 v59, 0
  s_cmp_eq_u32 s19, 63
  s_cbranch_scc1 cB_va1_last
  s_add_u32 s22, s20, 9216
  s_add_u32 s34, s20, 13312
  s_add_u32 s36, s20, 7168
  s_mov_b32 s37, 0
  v_mov_b32 v156, 0
  v_mov_b32 v157, 0
  v_mov_b32 v158, 0
  v_mov_b32 v159, 0
  s_barrier
  s_waitcnt lgkmcnt(0)
  buffer_load_dwordx4 v[8:11], v5, s[8:11], s22 offen offset:0 sc1
  buffer_load_dwordx4 v[12:15], v5, s[8:11], s22 offen offset:1024 sc1
  buffer_load_dwordx4 v[16:19], v5, s[8:11], s22 offen offset:2048 sc1
  buffer_load_dwordx4 v[20:23], v5, s[8:11], s22 offen offset:3072 sc1
  buffer_load_dwordx4 v[24:27], v5, s[8:11], s34 offen offset:0 sc1
  buffer_load_dwordx4 v[28:31], v5, s[8:11], s34 offen offset:1024 sc1
  buffer_load_dwordx4 v[32:35], v5, s[8:11], s34 offen offset:2048 sc1
  buffer_load_dwordx4 v[144:147], v5, s[8:11], s34 offen offset:3072 sc1
  s_sub_u32 s23, s21, 4
  s_mov_b64 exec, 65535
  buffer_store_dword v2, v7, s[8:11], s23 offen sc1
  s_mov_b64 exec, -1
  buffer_load_dwordx4 v[148:151], v2, s[8:11], s36 offen offset:0 sc1
  buffer_load_dwordx4 v[152:155], v2, s[8:11], s36 offen offset:1024 sc1
  ds_read_b128 v[64:67], v2 offset:4096
  ds_read_b128 v[68:71], v2 offset:5120
  ds_read_b128 v[72:75], v2 offset:6144
  ds_read_b128 v[76:79], v2 offset:7168
  s_waitcnt vmcnt(10)
  v_smfmac_f32_16x16x64_bf16 v[156:159], v[8:11], v[80:87], v3
  s_waitcnt vmcnt(9)
  v_smfmac_f32_16x16x64_bf16 v[156:159], v[12:15], v[88:95], v3
  s_waitcnt vmcnt(8)
  v_smfmac_f32_16x16x64_bf16 v[156:159], v[16:19], v[96:103], v3
  s_waitcnt vmcnt(7)
  v_smfmac_f32_16x16x64_bf16 v[156:159], v[20:23], v[104:111], v3
  s_waitcnt vmcnt(6)
  v_smfmac_f32_16x16x64_bf16 v[156:159], v[24:27], v[112:119], v3
  s_mov_b64 exec, 65535
  buffer_store_dword v2, v7, s[8:11], s21 offen sc1
  s_mov_b64 exec, -1
  s_waitcnt vmcnt(6)
  v_smfmac_f32_16x16x64_bf16 v[156:159], v[28:31], v[120:127], v3
  s_waitcnt vmcnt(5)
  v_smfmac_f32_16x16x64_bf16 v[156:159], v[32:35], v[128:135], v3
  s_waitcnt vmcnt(4)
  v_smfmac_f32_16x16x64_bf16 v[156:159], v[144:147], v[136:143], v3
  s_waitcnt vmcnt(2) lgkmcnt(0)
  v_smfmac_f32_16x16x64_bf16 v[156:159], v[148:151], v[64:71], v3
  s_waitcnt vmcnt(1)
  v_smfmac_f32_16x16x64_bf16 v[156:159], v[152:155], v[72:79], v3
cB_va1_ep:
  s_nop 7
  v_add_f32 v160, v156, v157
  v_add_f32 v161, v158, v159
  v_cmp_u_f32 vcc, v160, v161
  v_mov_b32_dpp v162, v160 row_ror:8 row_mask:0xf bank_mask:0xf
  v_mov_b32_dpp v160, v161 row_ror:8 row_mask:0xf bank_mask:0xc
  s_cbranch_vccnz cB_va1_rp
  v_mov_b32_dpp v161, v162 quad_perm:[0,1,2,3] row_mask:0xf bank_mask:0x3
  v_cvt_pk_bf16_f32 v160, v160, v161
cB_va1_pc:
  s_mov_b64 exec, s[26:27]
  buffer_store_dword v160, v1, s[8:11], s21 offen sc1
  s_cmp_lg_u32 s19, 62
  s_cbranch_scc1 cB_va1_nl
  s_mov_b32 s22, 88531968
  buffer_store_dword v160, v1, s[8:11], s22 offen sc1
  s_mov_b64 exec, -1
  s_branch cB_done
cB_va1_nl:
  s_mov_b64 exec, -1
  s_cmp_lg_u32 s19, 0
  s_cbranch_scc1 cB_va1_s0
  v_add_u32 v7, 512, v7
  v_lshl_add_u32 v7, v2, 3, v7
  s_mov_b64 exec, 65535
  buffer_store_dword v2, v7, s[8:11], s21 offen sc1
  buffer_store_dword v2, v7, s[8:11], s23 offen sc1
  s_mov_b64 exec, -1
cB_va1_s0:
  s_add_u32 s25, s25, 28672
  s_add_u32 s19, s19, 1
  s_mov_b32 s20, s21
  s_branch cB_va1_loop
cB_va1_last:
  s_waitcnt lgkmcnt(0)
  s_barrier
  s_branch cB_done
cB_va1_rp:
  s_cmp_eq_u32 s37, 0
  s_cbranch_scc1 cB_va1_rv
  v_mov_b32_dpp v161, v162 quad_perm:[0,1,2,3] row_mask:0xf bank_mask:0x3
  v_cvt_pk_bf16_f32 v160, v160, v161
  v_min_u32 v160, -2, v160
  s_branch cB_va1_pc
cB_va1_rv:
  buffer_load_dwordx4 v[8:11], v5, s[8:11], s22 offen offset:0 sc1
  buffer_load_dwordx4 v[12:15], v5, s[8:11], s22 offen offset:1024 sc1
  buffer_load_dwordx4 v[16:19], v5, s[8:11], s22 offen offset:2048 sc1
  buffer_load_dwordx4 v[20:23], v5, s[8:11], s22 offen offset:3072 sc1
  buffer_load_dwordx4 v[24:27], v5, s[8:11], s34 offen offset:0 sc1
  buffer_load_dwordx4 v[28:31], v5, s[8:11], s34 offen offset:1024 sc1
  buffer_load_dwordx4 v[32:35], v5, s[8:11], s34 offen offset:2048 sc1
  buffer_load_dwordx4 v[144:147], v5, s[8:11], s34 offen offset:3072 sc1
  buffer_load_dwordx4 v[148:151], v2, s[8:11], s36 offen offset:0 sc1
  buffer_load_dwordx4 v[152:155], v2, s[8:11], s36 offen offset:1024 sc1
  s_waitcnt vmcnt(0)
  v_max3_u32 v175, v8, v9, v10
  v_max3_u32 v175, v175, v11, v12
  v_max3_u32 v175, v175, v13, v14
  v_max3_u32 v175, v175, v15, v16
  v_max3_u32 v175, v175, v17, v18
  v_max3_u32 v175, v175, v19, v20
  v_max3_u32 v175, v175, v21, v22
  v_max3_u32 v175, v175, v23, v24
  v_max3_u32 v175, v175, v25, v26
  v_max3_u32 v175, v175, v27, v28
  v_max3_u32 v175, v175, v29, v30
  v_max3_u32 v175, v175, v31, v32
  v_max3_u32 v175, v175, v33, v34
  v_max3_u32 v175, v175, v35, v144
  v_max3_u32 v175, v175, v145, v146
  v_max3_u32 v175, v175, v147, v148
  v_max3_u32 v175, v175, v149, v150
  v_max3_u32 v175, v175, v151, v152
  v_max3_u32 v175, v175, v153, v154
  v_max_u32 v175, v175, v155
  v_cmp_eq_u32 vcc, -1, v175
  s_cbranch_vccz cB_va1_rk
  s_add_u32 s30, s30, 1
  s_cmp_lt_u32 s30, 400000
  s_cbranch_scc1 cB_va1_rv
  s_branch cB_abort
cB_va1_rk:
  s_mov_b32 s37, 1
  s_add_u32 s31, s31, 0x10000
  v_mov_b32 v156, 0
  v_mov_b32 v157, 0
  v_mov_b32 v158, 0
  v_mov_b32 v159, 0
  s_nop 1
  v_smfmac_f32_16x16x64_bf16 v[156:159], v[8:11], v[80:87], v3
  v_smfmac_f32_16x16x64_bf16 v[156:159], v[12:15], v[88:95], v3
  v_smfmac_f32_16x16x64_bf16 v[156:159], v[16:19], v[96:103], v3
  v_smfmac_f32_16x16x64_bf16 v[156:159], v[20:23], v[104:111], v3
  v_smfmac_f32_16x16x64_bf16 v[156:159], v[24:27], v[112:119], v3
  v_smfmac_f32_16x16x64_bf16 v[156:159], v[28:31], v[120:127], v3
  v_smfmac_f32_16x16x64_bf16 v[156:159], v[32:35], v[128:135], v3
  v_smfmac_f32_16x16x64_bf16 v[156:159], v[144:147], v[136:143], v3
  v_smfmac_f32_16x16x64_bf16 v[156:159], v[148:151], v[64:71], v3
  v_smfmac_f32_16x16x64_bf16 v[156:159], v[152:155], v[72:79], v3
  s_nop 7
  s_branch cB_va1_ep
.p2align 6

cB_va2_loop:
  s_add_u32 s23, s20, 4096
  s_add_u32 s21, s20, 20480
  v_mov_b32 v36, 0
  v_mov_b32 v37, 0
  v_mov_b32 v38, 0
  v_mov_b32 v39, 0
  v_mov_b32 v40, 0
  v_mov_b32 v41, 0
  v_mov_b32 v42, 0
  v_mov_b32 v43, 0
  v_mov_b32 v44, 0
  v_mov_b32 v45, 0
  v_mov_b32 v46, 0
  v_mov_b32 v47, 0
  v_mov_b32 v48, 0
  v_mov_b32 v49, 0
  v_mov_b32 v50, 0
  v_mov_b32 v51, 0
  v_mov_b32 v52, 0
  v_mov_b32 v53, 0
  v_mov_b32 v54, 0
  v_mov_b32 v55, 0
  v_mov_b32 v56, 0
  v_mov_b32 v57, 0
  v_mov_b32 v58, 0
  v_mov_b32 v59, 0
  v_mov_b32 v60, 0
  v_mov_b32 v61, 0
  v_mov_b32 v62, 0
  v_mov_b32 v63, 0
  v_mov_b32 v64, 0
  v_mov_b32 v65, 0
  v_mov_b32 v66, 0
  v_mov_b32 v67, 0
  s_mov_b32 s30, 0
  buffer_load_dword v76, v119, s[8:11], s20 offen sc1
  buffer_load_dword v77, v119, s[8:11], s20 offen sc1
  buffer_load_dword v78, v119, s[8:11], s20 offen sc1
cB_va2_fp_l:
  s_waitcnt vmcnt(2)
  v_cmp_eq_u32 vcc, -1, v76
  s_cbranch_vccz cB_va2_fp_d
  buffer_load_dword v76, v119, s[8:11], s20 offen sc1
  s_waitcnt vmcnt(2)
  v_cmp_eq_u32 vcc, -1, v77
  s_cbranch_vccz cB_va2_fp_d
  buffer_load_dword v77, v119, s[8:11], s20 offen sc1
  s_waitcnt vmcnt(2)
  v_cmp_eq_u32 vcc, -1, v78
  s_cbranch_vccz cB_va2_fp_d
  buffer_load_dword v78, v119, s[8:11], s20 offen sc1
  s_add_u32 s30, s30, 1
  s_cmp_lt_u32 s30, 400000
  s_cbranch_scc1 cB_va2_fp_l
  s_branch cB_abort
cB_va2_fp_d:
  buffer_load_dwordx4 v[8:11], v2, s[8:11], s20 offen offset:0 sc1
  buffer_load_dwordx4 v[12:15], v2, s[8:11], s20 offen offset:1024 sc1
  buffer_load_dwordx4 v[16:19], v2, s[8:11], s20 offen offset:2048 sc1
  buffer_load_dwordx4 v[20:23], v2, s[8:11], s20 offen offset:3072 sc1
  s_barrier
cB_va2_ld:
  s_waitcnt vmcnt(0)
  v_max3_u32 v84, v8, v9, v10
  v_max3_u32 v84, v84, v11, v12
  v_max3_u32 v84, v84, v13, v14
  v_max3_u32 v84, v84, v15, v16
  v_max3_u32 v84, v84, v17, v18
  v_max3_u32 v84, v84, v19, v20
  v_max3_u32 v84, v84, v21, v22
  v_max_u32 v84, v84, v23
  v_cmp_eq_u32 vcc, -1, v84
  ds_write_b128 v2, v[8:11] offset:8192
  ds_write_b128 v2, v[12:15] offset:9216
  ds_write_b128 v2, v[16:19] offset:10240
  ds_write_b128 v2, v[20:23] offset:11264
  s_cbranch_vccnz cB_va2_retry
  s_waitcnt lgkmcnt(0)
  s_barrier
  ds_read_b128 v[8:11], v5 offset:8192
  ds_read_b128 v[12:15], v5 offset:9216
  ds_read_b128 v[16:19], v5 offset:10240
  ds_read_b128 v[20:23], v5 offset:11264
  ds_read_b128 v[24:27], v5 offset:12288
  ds_read_b128 v[28:31], v5 offset:13312
  ds_read_b128 v[32:35], v5 offset:14336
  ds_read_b128 v[92:95], v0
  s_waitcnt lgkmcnt(0)
  s_mov_b64 exec, s[26:27]
  buffer_store_dwordx4 v[92:95], v2, s[8:11], s36 offen sc1
  s_mov_b64 exec, -1
  s_add_u32 s36, s36, 7168
  s_cmp_eq_u32 s19, 63
  s_cbranch_scc1 cB_done
  ds_read_b128 v[76:79], v1 offset:0
  ds_read_b128 v[80:83], v1 offset:1024
  ds_read_b128 v[84:87], v1 offset:2048
  ds_read_b128 v[88:91], v1 offset:3072
  ds_read_b128 v[92:95], v1 offset:4096
  ds_read_b128 v[96:99], v1 offset:5120
  v_smfmac_f32_16x16x64_bf16 v[60:63], v[8:11], v[200:207], v3
  v_smfmac_f32_16x16x64_bf16 v[60:63], v[12:15], v[208:215], v3
  s_waitcnt lgkmcnt(4)
  v_smfmac_f32_16x16x64_bf16 v[64:67], v[8:11], v[76:83], v3
  ds_read_b128 v[76:79], v1 offset:6144
  ds_read_b128 v[80:83], v1 offset:7168
  v_smfmac_f32_16x16x64_bf16 v[60:63], v[16:19], v[216:223], v3
  v_smfmac_f32_16x16x64_bf16 v[60:63], v[20:23], v[224:231], v3
  s_waitcnt lgkmcnt(4)
  v_smfmac_f32_16x16x64_bf16 v[64:67], v[12:15], v[84:91], v3
  ds_read_b128 v[84:87], v1 offset:8192
  ds_read_b128 v[88:91], v1 offset:9216
  v_smfmac_f32_16x16x64_bf16 v[60:63], v[24:27], v[232:239], v3
  v_smfmac_f32_16x16x64_bf16 v[60:63], v[28:31], v[240:247], v3
  s_waitcnt lgkmcnt(4)
  v_smfmac_f32_16x16x64_bf16 v[64:67], v[16:19], v[92:99], v3
  ds_read_b128 v[92:95], v1 offset:10240
  ds_read_b128 v[96:99], v1 offset:11264
  v_smfmac_f32_16x16x64_bf16 v[60:63], v[32:35], v[248:255], v3
  v_smfmac_f32_16x16x64_bf16 v[36:39], v[8:11], a[0:7], v3
  s_waitcnt lgkmcnt(4)
  v_smfmac_f32_16x16x64_bf16 v[64:67], v[20:23], v[76:83], v3
  ds_read_b128 v[76:79], v1 offset:12288
  ds_read_b128 v[80:83], v1 offset:13312
  v_smfmac_f32_16x16x64_bf16 v[36:39], v[12:15], a[8:15], v3
  v_add_f32 v60, v60, v61
  v_smfmac_f32_16x16x64_bf16 v[36:39], v[16:19], a[16:23], v3
  v_add_f32 v62, v62, v63
  s_waitcnt lgkmcnt(4)
  v_smfmac_f32_16x16x64_bf16 v[64:67], v[24:27], v[84:91], v3
  v_cvt_pk_bf16_f32 v60, v60, v62
  v_smfmac_f32_16x16x64_bf16 v[36:39], v[20:23], a[24:31], v3
  ds_write_b32 v106, v60
  v_smfmac_f32_16x16x64_bf16 v[36:39], v[24:27], a[32:39], v3
  s_waitcnt lgkmcnt(2)
  v_smfmac_f32_16x16x64_bf16 v[64:67], v[28:31], v[92:99], v3
  v_smfmac_f32_16x16x64_bf16 v[36:39], v[28:31], a[40:47], v3
  v_smfmac_f32_16x16x64_bf16 v[36:39], v[32:35], a[48:55], v3
  s_waitcnt lgkmcnt(0)
  v_smfmac_f32_16x16x64_bf16 v[64:67], v[32:35], v[76:83], v3
  v_smfmac_f32_16x16x64_bf16 v[40:43], v[8:11], a[56:63], v3
  v_smfmac_f32_16x16x64_bf16 v[40:43], v[12:15], a[64:71], v3
  v_add_f32 v36, v36, v37
  v_smfmac_f32_16x16x64_bf16 v[40:43], v[16:19], a[72:79], v3
  v_add_f32 v38, v38, v39
  v_smfmac_f32_16x16x64_bf16 v[40:43], v[20:23], a[80:87], v3
  v_cvt_pk_bf16_f32 v36, v36, v38
  v_smfmac_f32_16x16x64_bf16 v[40:43], v[24:27], a[88:95], v3
  ds_write_b32 v100, v36
  v_smfmac_f32_16x16x64_bf16 v[40:43], v[28:31], a[96:103], v3
  v_add_f32 v64, v64, v65
  v_smfmac_f32_16x16x64_bf16 v[40:43], v[32:35], a[104:111], v3
  v_add_f32 v66, v66, v67
  v_smfmac_f32_16x16x64_bf16 v[44:47], v[8:11], a[112:119], v3
  v_cvt_pk_bf16_f32 v64, v64, v66
  v_smfmac_f32_16x16x64_bf16 v[44:47], v[12:15], a[120:127], v3
  ds_write_b32 v107, v64
  v_smfmac_f32_16x16x64_bf16 v[44:47], v[16:19], a[128:135], v3
  v_add_f32 v40, v40, v41
  v_smfmac_f32_16x16x64_bf16 v[44:47], v[20:23], a[136:143], v3
  v_add_f32 v42, v42, v43
  v_smfmac_f32_16x16x64_bf16 v[44:47], v[24:27], a[144:151], v3
  v_cvt_pk_bf16_f32 v40, v40, v42
  v_smfmac_f32_16x16x64_bf16 v[44:47], v[28:31], a[152:159], v3
  ds_write_b32 v101, v40
  v_smfmac_f32_16x16x64_bf16 v[44:47], v[32:35], a[160:167], v3
  v_smfmac_f32_16x16x64_bf16 v[48:51], v[8:11], a[168:175], v3
  v_smfmac_f32_16x16x64_bf16 v[48:51], v[12:15], a[176:183], v3
  v_smfmac_f32_16x16x64_bf16 v[48:51], v[16:19], a[184:191], v3
  v_add_f32 v44, v44, v45
  v_smfmac_f32_16x16x64_bf16 v[48:51], v[20:23], a[192:199], v3
  v_add_f32 v46, v46, v47
  v_smfmac_f32_16x16x64_bf16 v[48:51], v[24:27], a[200:207], v3
  v_cvt_pk_bf16_f32 v44, v44, v46
  v_smfmac_f32_16x16x64_bf16 v[48:51], v[28:31], a[208:215], v3
  ds_write_b32 v102, v44
  v_smfmac_f32_16x16x64_bf16 v[48:51], v[32:35], a[216:223], v3
  v_smfmac_f32_16x16x64_bf16 v[52:55], v[8:11], a[224:231], v3
  v_smfmac_f32_16x16x64_bf16 v[52:55], v[12:15], a[232:239], v3
  v_smfmac_f32_16x16x64_bf16 v[52:55], v[16:19], a[240:247], v3
  v_add_f32 v48, v48, v49
  v_smfmac_f32_16x16x64_bf16 v[52:55], v[20:23], a[248:255], v3
  v_add_f32 v50, v50, v51
  v_smfmac_f32_16x16x64_bf16 v[52:55], v[24:27], v[120:127], v3
  v_cvt_pk_bf16_f32 v48, v48, v50
  v_smfmac_f32_16x16x64_bf16 v[52:55], v[28:31], v[128:135], v3
  ds_write_b32 v103, v48
  v_smfmac_f32_16x16x64_bf16 v[52:55], v[32:35], v[136:143], v3
  v_smfmac_f32_16x16x64_bf16 v[56:59], v[8:11], v[144:151], v3
  v_smfmac_f32_16x16x64_bf16 v[56:59], v[12:15], v[152:159], v3
  v_smfmac_f32_16x16x64_bf16 v[56:59], v[16:19], v[160:167], v3
  v_add_f32 v52, v52, v53
  v_smfmac_f32_16x16x64_bf16 v[56:59], v[20:23], v[168:175], v3
  v_add_f32 v54, v54, v55
  v_smfmac_f32_16x16x64_bf16 v[56:59], v[24:27], v[176:183], v3
  v_cvt_pk_bf16_f32 v52, v52, v54
  v_smfmac_f32_16x16x64_bf16 v[56:59], v[28:31], v[184:191], v3
  ds_write_b32 v104, v52
  v_smfmac_f32_16x16x64_bf16 v[56:59], v[32:35], v[192:199], v3
  s_nop 7
  v_add_f32 v56, v56, v57
  v_add_f32 v58, v58, v59
  v_cvt_pk_bf16_f32 v56, v56, v58
  ds_write_b32 v105, v56
  s_waitcnt lgkmcnt(0)
  s_barrier
  s_cmp_eq_u32 s19, 62
  s_cbranch_scc1 cB_done
  s_waitcnt vmcnt(0) lgkmcnt(0)
  s_add_u32 s19, s19, 1
  s_mov_b32 s20, s21
  s_branch cB_va2_loop
cB_va2_retry:
  s_waitcnt lgkmcnt(0)
  buffer_load_dwordx4 v[8:11], v2, s[8:11], s20 offen offset:0 sc1
  buffer_load_dwordx4 v[12:15], v2, s[8:11], s20 offen offset:1024 sc1
  buffer_load_dwordx4 v[16:19], v2, s[8:11], s20 offen offset:2048 sc1
  buffer_load_dwordx4 v[20:23], v2, s[8:11], s20 offen offset:3072 sc1
  s_add_u32 s31, s31, 1
  s_add_u32 s30, s30, 1
  s_cmp_lt_u32 s30, 400000
  s_cbranch_scc1 cB_va2_ld
  s_branch cB_abort
cB_va2_last:
  s_waitcnt lgkmcnt(0)
  buffer_store_dwordx4 v[100:103], v2, s[8:11], s24 offen offset:0 sc1
  buffer_store_dwordx4 v[104:107], v2, s[8:11], s24 offen offset:1024 sc1
  buffer_store_dwordx4 v[108:111], v2, s[8:11], s24 offen offset:2048 sc1
  buffer_store_dwordx4 v[4:7], v2, s[8:11], s24 offen offset:3072 sc1
  s_add_u32 s24, s24, 8192
  s_waitcnt vmcnt(0)
  s_mov_b64 exec, 1
  buffer_store_dword v117, v2, s[8:11], s34 offen sc1
  s_mov_b64 exec, -1
  s_add_u32 s34, s34, 8
  s_mov_b64 exec, 1
  buffer_store_dword v117, v2, s[8:11], s34 offen sc1
  s_mov_b64 exec, -1
  s_add_u32 s34, s34, 8
  s_branch cB_done
.p2align 6

cB_va3_loop:
  s_add_u32 s23, s20, 4096
  s_add_u32 s21, s20, 20480
  v_mov_b32 v36, 0
  v_mov_b32 v37, 0
  v_mov_b32 v38, 0
  v_mov_b32 v39, 0
  v_mov_b32 v40, 0
  v_mov_b32 v41, 0
  v_mov_b32 v42, 0
  v_mov_b32 v43, 0
  v_mov_b32 v44, 0
  v_mov_b32 v45, 0
  v_mov_b32 v46, 0
  v_mov_b32 v47, 0
  v_mov_b32 v48, 0
  v_mov_b32 v49, 0
  v_mov_b32 v50, 0
  v_mov_b32 v51, 0
  v_mov_b32 v52, 0
  v_mov_b32 v53, 0
  v_mov_b32 v54, 0
  v_mov_b32 v55, 0
  v_mov_b32 v56, 0
  v_mov_b32 v57, 0
  v_mov_b32 v58, 0
  v_mov_b32 v59, 0
  v_mov_b32 v60, 0
  v_mov_b32 v61, 0
  v_mov_b32 v62, 0
  v_mov_b32 v63, 0
  v_mov_b32 v64, 0
  v_mov_b32 v65, 0
  v_mov_b32 v66, 0
  v_mov_b32 v67, 0
  s_mov_b32 s30, 0
  buffer_load_dword v76, v119, s[8:11], s20 offen sc1
  buffer_load_dword v77, v119, s[8:11], s20 offen sc1
  buffer_load_dword v78, v119, s[8:11], s20 offen sc1
cB_va3_fp_l:
  s_waitcnt vmcnt(2)
  v_cmp_eq_u32 vcc, -1, v76
  s_cbranch_vccz cB_va3_fp_d
  buffer_load_dword v76, v119, s[8:11], s20 offen sc1
  s_waitcnt vmcnt(2)
  v_cmp_eq_u32 vcc, -1, v77
  s_cbranch_vccz cB_va3_fp_d
  buffer_load_dword v77, v119, s[8:11], s20 offen sc1
  s_waitcnt vmcnt(2)
  v_cmp_eq_u32 vcc, -1, v78
  s_cbranch_vccz cB_va3_fp_d
  buffer_load_dword v78, v119, s[8:11], s20 offen sc1
  s_add_u32 s30, s30, 1
  s_cmp_lt_u32 s30, 400000
  s_cbranch_scc1 cB_va3_fp_l
  s_branch cB_abort
cB_va3_fp_d:
  buffer_load_dwordx4 v[24:27], v2, s[8:11], s23 offen offset:0 sc1
  buffer_load_dwordx4 v[28:31], v2, s[8:11], s23 offen offset:1024 sc1
  buffer_load_dwordx4 v[32:35], v2, s[8:11], s23 offen offset:2048 sc1
  s_barrier
cB_va3_ld:
  s_waitcnt vmcnt(0)
  v_max3_u32 v84, v24, v25, v26
  v_max3_u32 v84, v84, v27, v28
  v_max3_u32 v84, v84, v29, v30
  v_max3_u32 v84, v84, v31, v32
  v_max3_u32 v84, v84, v33, v34
  v_max_u32 v84, v84, v35
  v_cmp_eq_u32 vcc, -1, v84
  ds_write_b128 v2, v[24:27] offset:12288
  ds_write_b128 v2, v[28:31] offset:13312
  ds_write_b128 v2, v[32:35] offset:14336
  s_cbranch_vccnz cB_va3_retry
  s_waitcnt lgkmcnt(0)
  s_barrier
  ds_read_b128 v[8:11], v5 offset:8192
  ds_read_b128 v[12:15], v5 offset:9216
  ds_read_b128 v[16:19], v5 offset:10240
  ds_read_b128 v[20:23], v5 offset:11264
  ds_read_b128 v[24:27], v5 offset:12288
  ds_read_b128 v[28:31], v5 offset:13312
  ds_read_b128 v[32:35], v5 offset:14336
  s_waitcnt lgkmcnt(0)
  s_cmp_eq_u32 s19, 63
  s_cbranch_scc1 cB_done
  ds_read_b128 v[76:79], v1 offset:0
  ds_read_b128 v[80:83], v1 offset:1024
  ds_read_b128 v[84:87], v1 offset:2048
  ds_read_b128 v[88:91], v1 offset:3072
  ds_read_b128 v[92:95], v1 offset:4096
  ds_read_b128 v[96:99], v1 offset:5120
  v_smfmac_f32_16x16x64_bf16 v[60:63], v[8:11], v[200:207], v3
  v_smfmac_f32_16x16x64_bf16 v[60:63], v[12:15], v[208:215], v3
  s_waitcnt lgkmcnt(4)
  v_smfmac_f32_16x16x64_bf16 v[64:67], v[8:11], v[76:83], v3
  ds_read_b128 v[76:79], v1 offset:6144
  ds_read_b128 v[80:83], v1 offset:7168
  v_smfmac_f32_16x16x64_bf16 v[60:63], v[16:19], v[216:223], v3
  v_smfmac_f32_16x16x64_bf16 v[60:63], v[20:23], v[224:231], v3
  s_waitcnt lgkmcnt(4)
  v_smfmac_f32_16x16x64_bf16 v[64:67], v[12:15], v[84:91], v3
  ds_read_b128 v[84:87], v1 offset:8192
  ds_read_b128 v[88:91], v1 offset:9216
  v_smfmac_f32_16x16x64_bf16 v[60:63], v[24:27], v[232:239], v3
  v_smfmac_f32_16x16x64_bf16 v[60:63], v[28:31], v[240:247], v3
  s_waitcnt lgkmcnt(4)
  v_smfmac_f32_16x16x64_bf16 v[64:67], v[16:19], v[92:99], v3
  ds_read_b128 v[92:95], v1 offset:10240
  ds_read_b128 v[96:99], v1 offset:11264
  v_smfmac_f32_16x16x64_bf16 v[60:63], v[32:35], v[248:255], v3
  v_smfmac_f32_16x16x64_bf16 v[36:39], v[8:11], a[0:7], v3
  s_waitcnt lgkmcnt(4)
  v_smfmac_f32_16x16x64_bf16 v[64:67], v[20:23], v[76:83], v3
  ds_read_b128 v[76:79], v1 offset:12288
  ds_read_b128 v[80:83], v1 offset:13312
  v_smfmac_f32_16x16x64_bf16 v[36:39], v[12:15], a[8:15], v3
  v_add_f32 v60, v60, v61
  v_smfmac_f32_16x16x64_bf16 v[36:39], v[16:19], a[16:23], v3
  v_add_f32 v62, v62, v63
  s_waitcnt lgkmcnt(4)
  v_smfmac_f32_16x16x64_bf16 v[64:67], v[24:27], v[84:91], v3
  v_cvt_pk_bf16_f32 v60, v60, v62
  v_smfmac_f32_16x16x64_bf16 v[36:39], v[20:23], a[24:31], v3
  ds_write_b32 v106, v60
  v_smfmac_f32_16x16x64_bf16 v[36:39], v[24:27], a[32:39], v3
  s_waitcnt lgkmcnt(2)
  v_smfmac_f32_16x16x64_bf16 v[64:67], v[28:31], v[92:99], v3
  v_smfmac_f32_16x16x64_bf16 v[36:39], v[28:31], a[40:47], v3
  v_smfmac_f32_16x16x64_bf16 v[36:39], v[32:35], a[48:55], v3
  s_waitcnt lgkmcnt(0)
  v_smfmac_f32_16x16x64_bf16 v[64:67], v[32:35], v[76:83], v3
  v_smfmac_f32_16x16x64_bf16 v[40:43], v[8:11], a[56:63], v3
  v_smfmac_f32_16x16x64_bf16 v[40:43], v[12:15], a[64:71], v3
  v_add_f32 v36, v36, v37
  v_smfmac_f32_16x16x64_bf16 v[40:43], v[16:19], a[72:79], v3
  v_add_f32 v38, v38, v39
  v_smfmac_f32_16x16x64_bf16 v[40:43], v[20:23], a[80:87], v3
  v_cvt_pk_bf16_f32 v36, v36, v38
  v_smfmac_f32_16x16x64_bf16 v[40:43], v[24:27], a[88:95], v3
  ds_write_b32 v100, v36
  v_smfmac_f32_16x16x64_bf16 v[40:43], v[28:31], a[96:103], v3
  v_add_f32 v64, v64, v65
  v_smfmac_f32_16x16x64_bf16 v[40:43], v[32:35], a[104:111], v3
  v_add_f32 v66, v66, v67
  v_smfmac_f32_16x16x64_bf16 v[44:47], v[8:11], a[112:119], v3
  v_cvt_pk_bf16_f32 v64, v64, v66
  v_smfmac_f32_16x16x64_bf16 v[44:47], v[12:15], a[120:127], v3
  ds_write_b32 v107, v64
  v_smfmac_f32_16x16x64_bf16 v[44:47], v[16:19], a[128:135], v3
  v_add_f32 v40, v40, v41
  v_smfmac_f32_16x16x64_bf16 v[44:47], v[20:23], a[136:143], v3
  v_add_f32 v42, v42, v43
  v_smfmac_f32_16x16x64_bf16 v[44:47], v[24:27], a[144:151], v3
  v_cvt_pk_bf16_f32 v40, v40, v42
  v_smfmac_f32_16x16x64_bf16 v[44:47], v[28:31], a[152:159], v3
  ds_write_b32 v101, v40
  v_smfmac_f32_16x16x64_bf16 v[44:47], v[32:35], a[160:167], v3
  v_smfmac_f32_16x16x64_bf16 v[48:51], v[8:11], a[168:175], v3
  v_smfmac_f32_16x16x64_bf16 v[48:51], v[12:15], a[176:183], v3
  v_smfmac_f32_16x16x64_bf16 v[48:51], v[16:19], a[184:191], v3
  v_add_f32 v44, v44, v45
  v_smfmac_f32_16x16x64_bf16 v[48:51], v[20:23], a[192:199], v3
  v_add_f32 v46, v46, v47
  v_smfmac_f32_16x16x64_bf16 v[48:51], v[24:27], a[200:207], v3
  v_cvt_pk_bf16_f32 v44, v44, v46
  v_smfmac_f32_16x16x64_bf16 v[48:51], v[28:31], a[208:215], v3
  ds_write_b32 v102, v44
  v_smfmac_f32_16x16x64_bf16 v[48:51], v[32:35], a[216:223], v3
  v_smfmac_f32_16x16x64_bf16 v[52:55], v[8:11], a[224:231], v3
  v_smfmac_f32_16x16x64_bf16 v[52:55], v[12:15], a[232:239], v3
  v_smfmac_f32_16x16x64_bf16 v[52:55], v[16:19], a[240:247], v3
  v_add_f32 v48, v48, v49
  v_smfmac_f32_16x16x64_bf16 v[52:55], v[20:23], a[248:255], v3
  v_add_f32 v50, v50, v51
  v_smfmac_f32_16x16x64_bf16 v[52:55], v[24:27], v[120:127], v3
  v_cvt_pk_bf16_f32 v48, v48, v50
  v_smfmac_f32_16x16x64_bf16 v[52:55], v[28:31], v[128:135], v3
  ds_write_b32 v103, v48
  v_smfmac_f32_16x16x64_bf16 v[52:55], v[32:35], v[136:143], v3
  v_smfmac_f32_16x16x64_bf16 v[56:59], v[8:11], v[144:151], v3
  v_smfmac_f32_16x16x64_bf16 v[56:59], v[12:15], v[152:159], v3
  v_smfmac_f32_16x16x64_bf16 v[56:59], v[16:19], v[160:167], v3
  v_add_f32 v52, v52, v53
  v_smfmac_f32_16x16x64_bf16 v[56:59], v[20:23], v[168:175], v3
  v_add_f32 v54, v54, v55
  v_smfmac_f32_16x16x64_bf16 v[56:59], v[24:27], v[176:183], v3
  v_cvt_pk_bf16_f32 v52, v52, v54
  v_smfmac_f32_16x16x64_bf16 v[56:59], v[28:31], v[184:191], v3
  ds_write_b32 v104, v52
  v_smfmac_f32_16x16x64_bf16 v[56:59], v[32:35], v[192:199], v3
  s_nop 7
  v_add_f32 v56, v56, v57
  v_add_f32 v58, v58, v59
  v_cvt_pk_bf16_f32 v56, v56, v58
  ds_write_b32 v105, v56
  s_waitcnt lgkmcnt(0)
  s_barrier
  s_cmp_eq_u32 s19, 62
  s_cbranch_scc1 cB_done
  s_waitcnt vmcnt(0) lgkmcnt(0)
  s_add_u32 s19, s19, 1
  s_mov_b32 s20, s21
  s_branch cB_va3_loop
cB_va3_retry:
  s_waitcnt lgkmcnt(0)
  buffer_load_dwordx4 v[24:27], v2, s[8:11], s23 offen offset:0 sc1
  buffer_load_dwordx4 v[28:31], v2, s[8:11], s23 offen offset:1024 sc1
  buffer_load_dwordx4 v[32:35], v2, s[8:11], s23 offen offset:2048 sc1
  s_add_u32 s31, s31, 1
  s_add_u32 s30, s30, 1
  s_cmp_lt_u32 s30, 400000
  s_cbranch_scc1 cB_va3_ld
  s_branch cB_abort
cB_va3_last:
  s_waitcnt lgkmcnt(0)
  buffer_store_dwordx4 v[100:103], v2, s[8:11], s24 offen offset:0 sc1
  buffer_store_dwordx4 v[104:107], v2, s[8:11], s24 offen offset:1024 sc1
  buffer_store_dwordx4 v[108:111], v2, s[8:11], s24 offen offset:2048 sc1
  buffer_store_dwordx4 v[4:7], v2, s[8:11], s24 offen offset:3072 sc1
  s_add_u32 s24, s24, 8192
  s_waitcnt vmcnt(0)
  s_mov_b64 exec, 1
  buffer_store_dword v117, v2, s[8:11], s34 offen sc1
  s_mov_b64 exec, -1
  s_add_u32 s34, s34, 8
  s_mov_b64 exec, 1
  buffer_store_dword v117, v2, s[8:11], s34 offen sc1
  s_mov_b64 exec, -1
  s_add_u32 s34, s34, 8
  s_branch cB_done
cB_abort:
  v_mov_b32 v4, 0xdead
  v_mov_b32 v5, 16
  buffer_store_dword v4, v5, s[12:15], 0 offen
  s_branch ch_end
cB_done:
  s_branch ch_end
m_reclaim:
  s_waitcnt vmcnt(0)
  s_lshr_b32 s20, s3, 5
  s_cmp_lg_u32 s16, 0
  s_cbranch_scc1 w0_25
  s_mov_b32 s21, 0
  s_mov_b64 exec, 1
rc_l:
  s_cmp_lg_u32 s70, -1
  s_cbranch_scc1 rc_t
  s_add_u32 s20, s20, 1
  s_cmp_lt_u32 s20, 8
  s_cselect_b32 s20, s20, 0
  s_mov_b32 s70, 0
  s_mov_b32 s3, -1
  s_add_u32 s21, s21, 1
  s_cmp_ge_u32 s21, 9
  s_cbranch_scc1 rc_d
rc_t:
  s_ff0_i32_b32 s22, s70
  s_lshl_b32 s23, 1, s22
  s_and_b32 s71, s20, 4
  s_mul_i32 s71, s71, 12
  s_lshl_b32 s3, s20, 2
  s_add_u32 s3, s3, s71
  v_mov_b32 v242, s23
  v_mov_b32 v243, 32
  buffer_atomic_or v242, v243, s[12:15], s3 offen sc0
  s_waitcnt vmcnt(0)
  v_readfirstlane_b32 s70, v242
  s_lshl_b32 s3, s20, 5
  s_add_u32 s3, s3, s22
  s_bitcmp1_b32 s70, s22
  s_cbranch_scc1 rc_l
rc_d:
  s_mov_b64 exec, -1
  v_mov_b32 v242, s3
w0_25:
  v_mov_b32 v250, 160000
  s_add_u32 s101, s101, 1
  s_barrier
  s_mov_b64 exec, 1
  s_cmp_lg_u32 s16, 0
  s_cbranch_scc1 w0_26
  ds_write_b32 v250, v242 offset:0
  s_waitcnt lgkmcnt(0)
  v_mov_b32 v242, s101
  ds_write_b32 v250, v242 offset:16
  s_waitcnt lgkmcnt(0)
w0_26:
  s_mov_b64 exec, -1
  s_barrier
  ds_read_b32 v242, v250 offset:0
  ds_read_b32 v250, v250 offset:16
  s_waitcnt lgkmcnt(0)
  v_readfirstlane_b32 s3, v242
  v_cmp_ne_u32 vcc, s101, v250
  s_cbranch_vccnz ch_end
  s_cmp_lg_u32 s3, -1
  s_cbranch_scc1 m_start
  v_mov_b32 v250, 0
  s_branch wk_ask
m_bjob:
  v_and_b32 v1, 63, v0
  v_lshlrev_b32 v2, 4, v1
  v_lshrrev_b32 v3, 4, v1
  v_and_b32 v4, 15, v1
  s_sub_u32 s18, s3, 32
  s_mul_i32 s17, s18, 4682
  s_lshr_b32 s17, s17, 16
  s_mul_i32 s20, s17, 14
  s_sub_u32 s19, s18, s20
  s_cmp_ge_u32 s19, 7
  s_cselect_b32 s31, 7, 0
  s_sub_u32 s19, s19, s31
  s_mov_b32 s60, s44
  s_and_b32 s61, s45, 0xffff
  s_mov_b32 s62, 3670016
  s_mov_b32 s63, 0x20000
  s_mov_b32 s56, s46
  s_and_b32 s57, s47, 0xffff
  s_mov_b32 s58, 3670016
  s_mov_b32 s59, 0x20000
  s_lshl_b32 s30, s16, 13
  s_mul_i32 s27, s17, 229376
  s_lshl_b32 s29, s19, 7
  s_add_u32 s27, s27, s29
  v_lshrrev_b32 v7, 3, v1
  v_and_b32 v8, 7, v1
  v_and_b32 v9, 2, v7
  v_xor_b32 v8, v8, v9
  s_lshl_b32 s29, s16, 6
  v_add_u32 v7, s29, v7
  v_mul_u32_u24 v7, 896, v7
  v_lshl_add_u32 v7, v8, 4, v7
  v_xor_b32 v8, 64, v7
  s_add_u32 m0, s30, 0
  s_add_u32 s22, s27, 0
  buffer_load_dwordx4 v7, s[56:59], s22 offen offset:0 lds
  s_add_u32 s22, s27, 6144
  buffer_load_dwordx4 v8, s[56:59], s22 offen offset:1024 lds
  s_add_u32 s22, s27, 12288
  buffer_load_dwordx4 v7, s[56:59], s22 offen offset:2048 lds
  s_add_u32 s22, s27, 18432
  buffer_load_dwordx4 v8, s[56:59], s22 offen offset:3072 lds
  s_add_u32 m0, s30, 4096
  s_add_u32 s22, s27, 28672
  buffer_load_dwordx4 v7, s[56:59], s22 offen offset:0 lds
  s_add_u32 s22, s27, 34816
  buffer_load_dwordx4 v8, s[56:59], s22 offen offset:1024 lds
  s_add_u32 s22, s27, 40960
  buffer_load_dwordx4 v7, s[56:59], s22 offen offset:2048 lds
  s_add_u32 s22, s27, 47104
  buffer_load_dwordx4 v8, s[56:59], s22 offen offset:3072 lds
  v_lshrrev_b32 v5, 5, v1
  v_and_b32 v6, 31, v1
  s_lshl_b32 s25, s16, 15
  s_add_u32 s25, s25, 32768
  s_lshl_b32 s26, s17, 9
  s_add_u32 s28, s19, s16
  s_cmp_ge_u32 s28, 7
  s_cselect_b32 s20, 7, 0
  s_sub_u32 s28, s28, s20
  s_add_u32 s28, s28, s31
  s_add_u32 s29, s19, s16
  s_add_u32 s29, s29, 4
  s_cmp_ge_u32 s29, 7
  s_cselect_b32 s20, 7, 0
  s_sub_u32 s29, s29, s20
  s_add_u32 s29, s29, s31
  s_lshl_b32 s32, s28, 18
  s_add_u32 s32, s32, s26
  s_lshl_b32 s33, s29, 18
  s_add_u32 s33, s33, s26
  v_xor_b32 v8, v6, v5
  v_lshlrev_b32 v8, 4, v8
  v_lshl_add_u32 v8, v5, 13, v8
  v_xor_b32 v12, 0, v8
  v_xor_b32 v13, 32, v8
  v_add_u32 v13, 15360, v13
  v_xor_b32 v14, 0, v8
  v_add_u32 v14, 30720, v14
  v_xor_b32 v15, 32, v8
  v_add_u32 v15, 46080, v15
  s_add_u32 s20, s16, 0
  s_and_b32 s20, s20, 3
  s_mul_i32 s21, s20, 65600
  s_lshl_b32 s20, s20, 12
  s_add_u32 s48, s20, s25
  s_mov_b32 m0, s48
  v_xor_b32 v16, s21, v12
  buffer_load_dwordx4 v16, s[60:63], s32 offen offset:0 lds
  v_xor_b32 v17, s21, v13
  buffer_load_dwordx4 v17, s[60:63], s32 offen offset:1024 lds
  v_xor_b32 v18, s21, v14
  buffer_load_dwordx4 v18, s[60:63], s32 offen offset:2048 lds
  v_xor_b32 v19, s21, v15
  buffer_load_dwordx4 v19, s[60:63], s32 offen offset:3072 lds
  s_add_u32 s20, s16, 1
  s_and_b32 s20, s20, 3
  s_mul_i32 s21, s20, 65600
  s_lshl_b32 s20, s20, 12
  s_add_u32 s49, s20, s25
  s_mov_b32 m0, s49
  v_xor_b32 v20, s21, v12
  buffer_load_dwordx4 v20, s[60:63], s32 offen offset:0 lds
  v_xor_b32 v21, s21, v13
  buffer_load_dwordx4 v21, s[60:63], s32 offen offset:1024 lds
  v_xor_b32 v22, s21, v14
  buffer_load_dwordx4 v22, s[60:63], s32 offen offset:2048 lds
  v_xor_b32 v23, s21, v15
  buffer_load_dwordx4 v23, s[60:63], s32 offen offset:3072 lds
  s_add_u32 s20, s16, 2
  s_and_b32 s20, s20, 3
  s_mul_i32 s21, s20, 65600
  s_lshl_b32 s20, s20, 12
  s_add_u32 s50, s20, s25
  s_mov_b32 m0, s50
  v_xor_b32 v24, s21, v12
  buffer_load_dwordx4 v24, s[60:63], s32 offen offset:0 lds
  v_xor_b32 v25, s21, v13
  buffer_load_dwordx4 v25, s[60:63], s32 offen offset:1024 lds
  v_xor_b32 v26, s21, v14
  buffer_load_dwordx4 v26, s[60:63], s32 offen offset:2048 lds
  v_xor_b32 v27, s21, v15
  buffer_load_dwordx4 v27, s[60:63], s32 offen offset:3072 lds
  s_add_u32 s20, s16, 3
  s_and_b32 s20, s20, 3
  s_mul_i32 s21, s20, 65600
  s_lshl_b32 s20, s20, 12
  s_add_u32 s51, s20, s25
  s_mov_b32 m0, s51
  v_xor_b32 v28, s21, v12
  buffer_load_dwordx4 v28, s[60:63], s32 offen offset:0 lds
  v_xor_b32 v29, s21, v13
  buffer_load_dwordx4 v29, s[60:63], s32 offen offset:1024 lds
  v_xor_b32 v30, s21, v14
  buffer_load_dwordx4 v30, s[60:63], s32 offen offset:2048 lds
  v_xor_b32 v31, s21, v15
  buffer_load_dwordx4 v31, s[60:63], s32 offen offset:3072 lds
  s_cmp_lg_u32 s66, 0
  s_cbranch_scc1 bj_ci
  s_cmp_lg_u32 s16, 0
  s_cbranch_scc1 w0_27
  s_lshr_b32 s70, s3, 5
  s_and_b32 s71, s70, 4
  s_mul_i32 s71, s71, 12
  s_lshl_b32 s70, s70, 2
  s_add_u32 s70, s70, s71
  s_lshl_b32 s71, 1, s3
  v_mov_b32 v44, s71
  v_mov_b32 v45, 32
  s_mov_b64 exec, 1
  buffer_atomic_or v44, v45, s[12:15], s70 offen sc0
  buffer_load_dwordx2 v[46:47], v45, s[12:15], 0 offen offset:96 sc1
  s_mov_b64 exec, -1
w0_27:
bj_ci:
  s_lshl_b32 s30, s19, 6
  s_add_u32 s30, s30, 0
  s_cmp_lt_u32 s19, 4
  s_cselect_b32 s20, 0, 256
  s_sub_u32 s30, s30, s20
  v_add_u32 v8, s30, v4
  s_lshr_b32 s20, s20, 4
  s_cmp_lt_u32 s19, 4
  s_movk_i32 s21, 5462
  s_cselect_b32 s21, 4096, s21
  s_cselect_b32 s30, 16, 12
  v_mul_u32_u24 v10, s21, v8
  v_lshrrev_b32 v10, 16, v10
  v_mul_u32_u24 v11, s30, v10
  v_sub_u32 v32, v8, v11
  v_add_u32 v32, s20, v32
  s_lshl_b32 s30, s17, 4
  s_mul_i32 s20, s17, 12
  s_add_u32 s20, s20, 240
  s_cmp_lt_u32 s19, 4
  s_cselect_b32 s30, s30, s20
  v_add_u32 v32, s30, v32
  v_lshrrev_b32 v33, 4, v32
  v_and_b32 v32, 15, v32
  s_mov_b32 s30, 401408
  v_mul_lo_u32 v10, v10, s30
  v_mul_u32_u24 v33, 14336, v33
  v_add_u32 v10, v10, v33
  v_lshl_add_u32 v10, v3, 8, v10
  v_lshl_add_u32 v10, v32, 4, v10
  v_add_u32 v12, 6422528, v10
  s_lshl_b32 s30, s19, 6
  s_add_u32 s30, s30, 16
  s_cmp_lt_u32 s19, 4
  s_cselect_b32 s20, 0, 256
  s_sub_u32 s30, s30, s20
  v_add_u32 v8, s30, v4
  s_lshr_b32 s20, s20, 4
  s_cmp_lt_u32 s19, 4
  s_movk_i32 s21, 5462
  s_cselect_b32 s21, 4096, s21
  s_cselect_b32 s30, 16, 12
  v_mul_u32_u24 v10, s21, v8
  v_lshrrev_b32 v10, 16, v10
  v_mul_u32_u24 v11, s30, v10
  v_sub_u32 v32, v8, v11
  v_add_u32 v32, s20, v32
  s_lshl_b32 s30, s17, 4
  s_mul_i32 s20, s17, 12
  s_add_u32 s20, s20, 240
  s_cmp_lt_u32 s19, 4
  s_cselect_b32 s30, s30, s20
  v_add_u32 v32, s30, v32
  v_lshrrev_b32 v33, 4, v32
  v_and_b32 v32, 15, v32
  s_mov_b32 s30, 401408
  v_mul_lo_u32 v10, v10, s30
  v_mul_u32_u24 v33, 14336, v33
  v_add_u32 v10, v10, v33
  v_lshl_add_u32 v10, v3, 8, v10
  v_lshl_add_u32 v10, v32, 4, v10
  v_add_u32 v13, 6422528, v10
  s_lshl_b32 s30, s19, 6
  s_add_u32 s30, s30, 32
  s_cmp_lt_u32 s19, 4
  s_cselect_b32 s20, 0, 256
  s_sub_u32 s30, s30, s20
  v_add_u32 v8, s30, v4
  s_lshr_b32 s20, s20, 4
  s_cmp_lt_u32 s19, 4
  s_movk_i32 s21, 5462
  s_cselect_b32 s21, 4096, s21
  s_cselect_b32 s30, 16, 12
  v_mul_u32_u24 v10, s21, v8
  v_lshrrev_b32 v10, 16, v10
  v_mul_u32_u24 v11, s30, v10
  v_sub_u32 v32, v8, v11
  v_add_u32 v32, s20, v32
  s_lshl_b32 s30, s17, 4
  s_mul_i32 s20, s17, 12
  s_add_u32 s20, s20, 240
  s_cmp_lt_u32 s19, 4
  s_cselect_b32 s30, s30, s20
  v_add_u32 v32, s30, v32
  v_lshrrev_b32 v33, 4, v32
  v_and_b32 v32, 15, v32
  s_mov_b32 s30, 401408
  v_mul_lo_u32 v10, v10, s30
  v_mul_u32_u24 v33, 14336, v33
  v_add_u32 v10, v10, v33
  v_lshl_add_u32 v10, v3, 8, v10
  v_lshl_add_u32 v10, v32, 4, v10
  v_add_u32 v14, 6422528, v10
  s_lshl_b32 s30, s19, 6
  s_add_u32 s30, s30, 48
  s_cmp_lt_u32 s19, 4
  s_cselect_b32 s20, 0, 256
  s_sub_u32 s30, s30, s20
  v_add_u32 v8, s30, v4
  s_lshr_b32 s20, s20, 4
  s_cmp_lt_u32 s19, 4
  s_movk_i32 s21, 5462
  s_cselect_b32 s21, 4096, s21
  s_cselect_b32 s30, 16, 12
  v_mul_u32_u24 v10, s21, v8
  v_lshrrev_b32 v10, 16, v10
  v_mul_u32_u24 v11, s30, v10
  v_sub_u32 v32, v8, v11
  v_add_u32 v32, s20, v32
  s_lshl_b32 s30, s17, 4
  s_mul_i32 s20, s17, 12
  s_add_u32 s20, s20, 240
  s_cmp_lt_u32 s19, 4
  s_cselect_b32 s30, s30, s20
  v_add_u32 v32, s30, v32
  v_lshrrev_b32 v33, 4, v32
  v_and_b32 v32, 15, v32
  s_mov_b32 s30, 401408
  v_mul_lo_u32 v10, v10, s30
  v_mul_u32_u24 v33, 14336, v33
  v_add_u32 v10, v10, v33
  v_lshl_add_u32 v10, v3, 8, v10
  v_lshl_add_u32 v10, v32, 4, v10
  v_add_u32 v15, 6422528, v10
  v_lshrrev_b32 v7, 2, v4
  v_lshlrev_b32 v7, 3, v7
  v_and_b32 v8, 3, v4
  v_add_u32 v7, v7, v8
  v_xor_b32 v10, v3, v4
  v_lshlrev_b32 v10, 4, v10
  v_lshl_add_u32 v10, v7, 9, v10
  v_add_u32 v10, s25, v10
  v_xor_b32 v32, 0, v10
  v_xor_b32 v33, 64, v10
  v_xor_b32 v34, 128, v10
  v_xor_b32 v35, 192, v10
  v_lshrrev_b32 v7, 2, v4
  v_lshl_add_u32 v7, v3, 3, v7
  v_lshlrev_b32 v7, 7, v7
  v_and_b32 v8, 3, v4
  v_lshl_add_u32 v7, v8, 3, v7
  v_lshrrev_b32 v8, 3, v4
  v_lshl_add_u32 v7, v8, 5, v7
  v_and_b32 v8, 1, v3
  v_lshl_add_u32 v7, v8, 6, v7
  s_waitcnt vmcnt(16)
  s_barrier
  s_cmp_eq_u32 s16, 3
  s_cbranch_scc1 bj_np0
  s_add_u32 m0, s48, 16384
  s_nop 0
  buffer_load_dwordx4 v16, s[60:63], s33 offen offset:0 lds
  buffer_load_dwordx4 v17, s[60:63], s33 offen offset:1024 lds
  buffer_load_dwordx4 v18, s[60:63], s33 offen offset:2048 lds
  buffer_load_dwordx4 v19, s[60:63], s33 offen offset:3072 lds
bj_np0:
  v_xor_b32 v9, 0, v7
  ds_read_b64_tr_b16 v[128:129], v9 offset:0
  ds_read_b64_tr_b16 v[130:131], v9 offset:512
  ds_read_b64_tr_b16 v[132:133], v9 offset:4096
  ds_read_b64_tr_b16 v[134:135], v9 offset:4608
  ds_read_b64_tr_b16 v[136:137], v9 offset:8192
  ds_read_b64_tr_b16 v[138:139], v9 offset:8704
  ds_read_b64_tr_b16 v[140:141], v9 offset:12288
  ds_read_b64_tr_b16 v[142:143], v9 offset:12800
  s_waitcnt lgkmcnt(6)
  ds_read_b64_tr_b16 v[144:145], v9 offset:16384
  ds_read_b64_tr_b16 v[146:147], v9 offset:16896
  ds_read_b64_tr_b16 v[148:149], v9 offset:20480
  ds_read_b64_tr_b16 v[150:151], v9 offset:20992
  ds_read_b64_tr_b16 v[152:153], v9 offset:24576
  ds_read_b64_tr_b16 v[154:155], v9 offset:25088
  ds_read_b64_tr_b16 v[156:157], v9 offset:28672
  ds_read_b64_tr_b16 v[158:159], v9 offset:29184
  s_waitcnt lgkmcnt(6)
  s_cmp_eq_u32 s16, 3
  s_cbranch_scc1 bj_np1
  s_add_u32 m0, s49, 16384
  s_nop 0
  buffer_load_dwordx4 v20, s[60:63], s33 offen offset:0 lds
  buffer_load_dwordx4 v21, s[60:63], s33 offen offset:1024 lds
  buffer_load_dwordx4 v22, s[60:63], s33 offen offset:2048 lds
  buffer_load_dwordx4 v23, s[60:63], s33 offen offset:3072 lds
bj_np1:
  v_xor_b32 v9, 32, v7
  ds_read_b64_tr_b16 v[160:161], v9 offset:0
  ds_read_b64_tr_b16 v[162:163], v9 offset:512
  ds_read_b64_tr_b16 v[164:165], v9 offset:4096
  ds_read_b64_tr_b16 v[166:167], v9 offset:4608
  ds_read_b64_tr_b16 v[168:169], v9 offset:8192
  ds_read_b64_tr_b16 v[170:171], v9 offset:8704
  ds_read_b64_tr_b16 v[172:173], v9 offset:12288
  ds_read_b64_tr_b16 v[174:175], v9 offset:12800
  s_waitcnt lgkmcnt(6)
  ds_read_b64_tr_b16 v[176:177], v9 offset:16384
  ds_read_b64_tr_b16 v[178:179], v9 offset:16896
  ds_read_b64_tr_b16 v[180:181], v9 offset:20480
  ds_read_b64_tr_b16 v[182:183], v9 offset:20992
  ds_read_b64_tr_b16 v[184:185], v9 offset:24576
  ds_read_b64_tr_b16 v[186:187], v9 offset:25088
  ds_read_b64_tr_b16 v[188:189], v9 offset:28672
  ds_read_b64_tr_b16 v[190:191], v9 offset:29184
  s_waitcnt lgkmcnt(6)
  s_cmp_eq_u32 s16, 3
  s_cbranch_scc1 bj_np2
  s_add_u32 m0, s50, 16384
  s_nop 0
  buffer_load_dwordx4 v24, s[60:63], s33 offen offset:0 lds
  buffer_load_dwordx4 v25, s[60:63], s33 offen offset:1024 lds
  buffer_load_dwordx4 v26, s[60:63], s33 offen offset:2048 lds
  buffer_load_dwordx4 v27, s[60:63], s33 offen offset:3072 lds
bj_np2:
  v_xor_b32 v9, 64, v7
  ds_read_b64_tr_b16 v[192:193], v9 offset:0
  ds_read_b64_tr_b16 v[194:195], v9 offset:512
  ds_read_b64_tr_b16 v[196:197], v9 offset:4096
  ds_read_b64_tr_b16 v[198:199], v9 offset:4608
  ds_read_b64_tr_b16 v[200:201], v9 offset:8192
  ds_read_b64_tr_b16 v[202:203], v9 offset:8704
  ds_read_b64_tr_b16 v[204:205], v9 offset:12288
  ds_read_b64_tr_b16 v[206:207], v9 offset:12800
  s_waitcnt lgkmcnt(6)
  ds_read_b64_tr_b16 v[208:209], v9 offset:16384
  ds_read_b64_tr_b16 v[210:211], v9 offset:16896
  ds_read_b64_tr_b16 v[212:213], v9 offset:20480
  ds_read_b64_tr_b16 v[214:215], v9 offset:20992
  ds_read_b64_tr_b16 v[216:217], v9 offset:24576
  ds_read_b64_tr_b16 v[218:219], v9 offset:25088
  ds_read_b64_tr_b16 v[220:221], v9 offset:28672
  ds_read_b64_tr_b16 v[222:223], v9 offset:29184
  s_waitcnt lgkmcnt(6)
  s_cmp_eq_u32 s16, 3
  s_cbranch_scc1 bj_np3
  s_add_u32 m0, s51, 16384
  s_nop 0
  buffer_load_dwordx4 v28, s[60:63], s33 offen offset:0 lds
  buffer_load_dwordx4 v29, s[60:63], s33 offen offset:1024 lds
  buffer_load_dwordx4 v30, s[60:63], s33 offen offset:2048 lds
  buffer_load_dwordx4 v31, s[60:63], s33 offen offset:3072 lds
bj_np3:
  v_xor_b32 v9, 96, v7
  ds_read_b64_tr_b16 v[224:225], v9 offset:0
  ds_read_b64_tr_b16 v[226:227], v9 offset:512
  ds_read_b64_tr_b16 v[228:229], v9 offset:4096
  ds_read_b64_tr_b16 v[230:231], v9 offset:4608
  ds_read_b64_tr_b16 v[232:233], v9 offset:8192
  ds_read_b64_tr_b16 v[234:235], v9 offset:8704
  ds_read_b64_tr_b16 v[236:237], v9 offset:12288
  ds_read_b64_tr_b16 v[238:239], v9 offset:12800
  s_waitcnt lgkmcnt(6)
  ds_read_b64_tr_b16 v[240:241], v9 offset:16384
  ds_read_b64_tr_b16 v[242:243], v9 offset:16896
  ds_read_b64_tr_b16 v[244:245], v9 offset:20480
  ds_read_b64_tr_b16 v[246:247], v9 offset:20992
  ds_read_b64_tr_b16 v[248:249], v9 offset:24576
  ds_read_b64_tr_b16 v[250:251], v9 offset:25088
  ds_read_b64_tr_b16 v[252:253], v9 offset:28672
  ds_read_b64_tr_b16 v[254:255], v9 offset:29184
  s_waitcnt lgkmcnt(6)
  s_mov_b32 s52, s36
  s_and_b32 s53, s37, 0xffff
  s_mov_b32 s54, 1835008
  s_mov_b32 s55, 0x20000
  s_lshl_b32 s20, s18, 8
  v_add_u32 v95, s20, v0
  s_mov_b32 s21, 9586981
  v_mul_hi_u32 v6, v95, s21
  v_mul_u32_u24 v7, 448, v6
  v_sub_u32 v7, v95, v7
  v_lshrrev_b32 v8, 4, v7
  v_and_b32 v7, 15, v7
  v_lshl_add_u32 v9, v6, 4, v7
  v_mul_u32_u24 v9, 896, v9
  v_lshl_add_u32 v9, v8, 5, v9
  buffer_load_dwordx4 v[84:87], v9, s[52:55], 0 offen
  buffer_load_dwordx4 v[88:91], v9, s[52:55], 0 offen offset:16
  v_mul_u32_u24 v6, 14336, v6
  v_lshl_add_u32 v6, v7, 4, v6
  v_lshl_add_u32 v92, v8, 9, v6
  v_lshrrev_b32 v7, 2, v8
  v_lshl_add_u32 v6, v7, 11, v6
  v_and_b32 v7, 3, v8
  v_lshl_add_u32 v93, v7, 8, v6
  s_mov_b32 s72, s38
  s_and_b32 s73, s39, 0xffff
  s_mov_b32 s74, 7168
  s_mov_b32 s75, 0x20000
  v_min_u32 v6, 223, v0
  v_lshrrev_b32 v7, 3, v6
  v_and_b32 v6, 7, v6
  v_mul_u32_u24 v9, 896, v6
  v_lshl_add_u32 v9, v7, 5, v9
  buffer_load_dwordx4 v[36:39], v9, s[72:75], 0 offen
  buffer_load_dwordx4 v[40:43], v9, s[72:75], 0 offen offset:16
  v_lshlrev_b32 v7, 8, v7
  v_lshl_add_u32 v94, v6, 4, v7
  s_lshl_b32 s26, s17, 9
  s_waitcnt vmcnt(20) lgkmcnt(0)
  s_cmp_lg_u32 s16, 3
  s_cbranch_scc1 w3_28
  s_waitcnt vmcnt(4)
w3_28:
  ds_read_b128 v[52:55], v32 offset:0
  ds_read_b128 v[56:59], v33 offset:0
  ds_read_b128 v[60:63], v34 offset:0
  ds_read_b128 v[64:67], v35 offset:0
  s_waitcnt lgkmcnt(3)
  v_mfma_f32_16x16x32_bf16 v[96:99], v[52:55], v[128:131], 0
  v_mfma_f32_16x16x32_bf16 v[100:103], v[52:55], v[160:163], 0
  v_mfma_f32_16x16x32_bf16 v[104:107], v[52:55], v[192:195], 0
  v_mfma_f32_16x16x32_bf16 v[108:111], v[52:55], v[224:227], 0
  ds_read_b128 v[52:55], v32 offset:256
  s_waitcnt lgkmcnt(3)
  v_mfma_f32_16x16x32_bf16 v[96:99], v[56:59], v[132:135], v[96:99]
  v_mfma_f32_16x16x32_bf16 v[100:103], v[56:59], v[164:167], v[100:103]
  v_mfma_f32_16x16x32_bf16 v[104:107], v[56:59], v[196:199], v[104:107]
  v_mfma_f32_16x16x32_bf16 v[108:111], v[56:59], v[228:231], v[108:111]
  ds_read_b128 v[56:59], v33 offset:256
  s_waitcnt lgkmcnt(3)
  v_mfma_f32_16x16x32_bf16 v[96:99], v[60:63], v[136:139], v[96:99]
  v_mfma_f32_16x16x32_bf16 v[100:103], v[60:63], v[168:171], v[100:103]
  v_mfma_f32_16x16x32_bf16 v[104:107], v[60:63], v[200:203], v[104:107]
  v_mfma_f32_16x16x32_bf16 v[108:111], v[60:63], v[232:235], v[108:111]
  ds_read_b128 v[60:63], v34 offset:256
  s_waitcnt lgkmcnt(3)
  v_mfma_f32_16x16x32_bf16 v[96:99], v[64:67], v[140:143], v[96:99]
  v_mfma_f32_16x16x32_bf16 v[100:103], v[64:67], v[172:175], v[100:103]
  v_mfma_f32_16x16x32_bf16 v[104:107], v[64:67], v[204:207], v[104:107]
  v_mfma_f32_16x16x32_bf16 v[108:111], v[64:67], v[236:239], v[108:111]
  ds_read_b128 v[64:67], v35 offset:256
  s_waitcnt lgkmcnt(3)
  v_mfma_f32_16x16x32_bf16 v[96:99], v[52:55], v[144:147], v[96:99]
  v_mfma_f32_16x16x32_bf16 v[100:103], v[52:55], v[176:179], v[100:103]
  v_mfma_f32_16x16x32_bf16 v[104:107], v[52:55], v[208:211], v[104:107]
  v_mfma_f32_16x16x32_bf16 v[108:111], v[52:55], v[240:243], v[108:111]
  ds_read_b128 v[52:55], v32 offset:2048
  s_waitcnt lgkmcnt(3)
  v_mfma_f32_16x16x32_bf16 v[96:99], v[56:59], v[148:151], v[96:99]
  v_mfma_f32_16x16x32_bf16 v[100:103], v[56:59], v[180:183], v[100:103]
  v_mfma_f32_16x16x32_bf16 v[104:107], v[56:59], v[212:215], v[104:107]
  v_mfma_f32_16x16x32_bf16 v[108:111], v[56:59], v[244:247], v[108:111]
  ds_read_b128 v[56:59], v33 offset:2048
  s_waitcnt lgkmcnt(3)
  v_mfma_f32_16x16x32_bf16 v[96:99], v[60:63], v[152:155], v[96:99]
  v_mfma_f32_16x16x32_bf16 v[100:103], v[60:63], v[184:187], v[100:103]
  v_mfma_f32_16x16x32_bf16 v[104:107], v[60:63], v[216:219], v[104:107]
  v_mfma_f32_16x16x32_bf16 v[108:111], v[60:63], v[248:251], v[108:111]
  ds_read_b128 v[60:63], v34 offset:2048
  s_waitcnt lgkmcnt(3)
  v_mfma_f32_16x16x32_bf16 v[96:99], v[64:67], v[156:159], v[96:99]
  v_mfma_f32_16x16x32_bf16 v[100:103], v[64:67], v[188:191], v[100:103]
  v_mfma_f32_16x16x32_bf16 v[104:107], v[64:67], v[220:223], v[104:107]
  v_mfma_f32_16x16x32_bf16 v[108:111], v[64:67], v[252:255], v[108:111]
  ds_read_b128 v[64:67], v35 offset:2048
  s_waitcnt lgkmcnt(3)
  v_mfma_f32_16x16x32_bf16 v[112:115], v[52:55], v[128:131], 0
  v_mfma_f32_16x16x32_bf16 v[116:119], v[52:55], v[160:163], 0
  v_mfma_f32_16x16x32_bf16 v[120:123], v[52:55], v[192:195], 0
  v_mfma_f32_16x16x32_bf16 v[124:127], v[52:55], v[224:227], 0
  ds_read_b128 v[52:55], v32 offset:2304
  s_waitcnt lgkmcnt(3)
  v_mfma_f32_16x16x32_bf16 v[112:115], v[56:59], v[132:135], v[112:115]
  v_mfma_f32_16x16x32_bf16 v[116:119], v[56:59], v[164:167], v[116:119]
  v_mfma_f32_16x16x32_bf16 v[120:123], v[56:59], v[196:199], v[120:123]
  v_mfma_f32_16x16x32_bf16 v[124:127], v[56:59], v[228:231], v[124:127]
  ds_read_b128 v[56:59], v33 offset:2304
  s_waitcnt lgkmcnt(3)
  v_mfma_f32_16x16x32_bf16 v[112:115], v[60:63], v[136:139], v[112:115]
  v_mfma_f32_16x16x32_bf16 v[116:119], v[60:63], v[168:171], v[116:119]
  v_mfma_f32_16x16x32_bf16 v[120:123], v[60:63], v[200:203], v[120:123]
  v_mfma_f32_16x16x32_bf16 v[124:127], v[60:63], v[232:235], v[124:127]
  ds_read_b128 v[60:63], v34 offset:2304
  s_waitcnt lgkmcnt(3)
  v_mfma_f32_16x16x32_bf16 v[112:115], v[64:67], v[140:143], v[112:115]
  v_mfma_f32_16x16x32_bf16 v[116:119], v[64:67], v[172:175], v[116:119]
  v_mfma_f32_16x16x32_bf16 v[120:123], v[64:67], v[204:207], v[120:123]
  v_mfma_f32_16x16x32_bf16 v[124:127], v[64:67], v[236:239], v[124:127]
  ds_read_b128 v[64:67], v35 offset:2304
  s_waitcnt lgkmcnt(3)
  v_mfma_f32_16x16x32_bf16 v[112:115], v[52:55], v[144:147], v[112:115]
  v_mfma_f32_16x16x32_bf16 v[116:119], v[52:55], v[176:179], v[116:119]
  v_mfma_f32_16x16x32_bf16 v[120:123], v[52:55], v[208:211], v[120:123]
  v_mfma_f32_16x16x32_bf16 v[124:127], v[52:55], v[240:243], v[124:127]
  s_waitcnt lgkmcnt(2)
  v_mfma_f32_16x16x32_bf16 v[112:115], v[56:59], v[148:151], v[112:115]
  v_mfma_f32_16x16x32_bf16 v[116:119], v[56:59], v[180:183], v[116:119]
  v_mfma_f32_16x16x32_bf16 v[120:123], v[56:59], v[212:215], v[120:123]
  v_mfma_f32_16x16x32_bf16 v[124:127], v[56:59], v[244:247], v[124:127]
  s_waitcnt lgkmcnt(1)
  v_mfma_f32_16x16x32_bf16 v[112:115], v[60:63], v[152:155], v[112:115]
  v_mfma_f32_16x16x32_bf16 v[116:119], v[60:63], v[184:187], v[116:119]
  v_mfma_f32_16x16x32_bf16 v[120:123], v[60:63], v[216:219], v[120:123]
  v_mfma_f32_16x16x32_bf16 v[124:127], v[60:63], v[248:251], v[124:127]
  s_waitcnt lgkmcnt(0)
  v_mfma_f32_16x16x32_bf16 v[112:115], v[64:67], v[156:159], v[112:115]
  v_mfma_f32_16x16x32_bf16 v[116:119], v[64:67], v[188:191], v[116:119]
  v_mfma_f32_16x16x32_bf16 v[120:123], v[64:67], v[220:223], v[120:123]
  v_mfma_f32_16x16x32_bf16 v[124:127], v[64:67], v[252:255], v[124:127]
  s_lshl_b32 s30, s28, 10
  v_cvt_pk_bf16_f32 v68, v96, v97
  v_cvt_pk_bf16_f32 v69, v98, v99
  v_cvt_pk_bf16_f32 v70, v112, v113
  v_cvt_pk_bf16_f32 v71, v114, v115
  buffer_store_dwordx4 v[68:71], v12, s[8:11], s30 offen sc1
  v_cvt_pk_bf16_f32 v72, v100, v101
  v_cvt_pk_bf16_f32 v73, v102, v103
  v_cvt_pk_bf16_f32 v74, v116, v117
  v_cvt_pk_bf16_f32 v75, v118, v119
  buffer_store_dwordx4 v[72:75], v13, s[8:11], s30 offen sc1
  v_cvt_pk_bf16_f32 v76, v104, v105
  v_cvt_pk_bf16_f32 v77, v106, v107
  v_cvt_pk_bf16_f32 v78, v120, v121
  v_cvt_pk_bf16_f32 v79, v122, v123
  buffer_store_dwordx4 v[76:79], v14, s[8:11], s30 offen sc1
  v_cvt_pk_bf16_f32 v80, v108, v109
  v_cvt_pk_bf16_f32 v81, v110, v111
  v_cvt_pk_bf16_f32 v82, v124, v125
  v_cvt_pk_bf16_f32 v83, v126, v127
  buffer_store_dwordx4 v[80:83], v15, s[8:11], s30 offen sc1
  s_cmp_eq_u32 s16, 3
  s_cbranch_scc1 bj_w3
  s_waitcnt vmcnt(8)
  ds_read_b128 v[52:55], v32 offset:16384
  ds_read_b128 v[56:59], v33 offset:16384
  ds_read_b128 v[60:63], v34 offset:16384
  ds_read_b128 v[64:67], v35 offset:16384
  s_waitcnt lgkmcnt(3)
  v_mfma_f32_16x16x32_bf16 v[96:99], v[52:55], v[128:131], 0
  v_mfma_f32_16x16x32_bf16 v[100:103], v[52:55], v[160:163], 0
  v_mfma_f32_16x16x32_bf16 v[104:107], v[52:55], v[192:195], 0
  v_mfma_f32_16x16x32_bf16 v[108:111], v[52:55], v[224:227], 0
  ds_read_b128 v[52:55], v32 offset:16640
  s_waitcnt lgkmcnt(3)
  v_mfma_f32_16x16x32_bf16 v[96:99], v[56:59], v[132:135], v[96:99]
  v_mfma_f32_16x16x32_bf16 v[100:103], v[56:59], v[164:167], v[100:103]
  v_mfma_f32_16x16x32_bf16 v[104:107], v[56:59], v[196:199], v[104:107]
  v_mfma_f32_16x16x32_bf16 v[108:111], v[56:59], v[228:231], v[108:111]
  ds_read_b128 v[56:59], v33 offset:16640
  s_waitcnt lgkmcnt(3)
  v_mfma_f32_16x16x32_bf16 v[96:99], v[60:63], v[136:139], v[96:99]
  v_mfma_f32_16x16x32_bf16 v[100:103], v[60:63], v[168:171], v[100:103]
  v_mfma_f32_16x16x32_bf16 v[104:107], v[60:63], v[200:203], v[104:107]
  v_mfma_f32_16x16x32_bf16 v[108:111], v[60:63], v[232:235], v[108:111]
  ds_read_b128 v[60:63], v34 offset:16640
  s_waitcnt lgkmcnt(3)
  v_mfma_f32_16x16x32_bf16 v[96:99], v[64:67], v[140:143], v[96:99]
  v_mfma_f32_16x16x32_bf16 v[100:103], v[64:67], v[172:175], v[100:103]
  v_mfma_f32_16x16x32_bf16 v[104:107], v[64:67], v[204:207], v[104:107]
  v_mfma_f32_16x16x32_bf16 v[108:111], v[64:67], v[236:239], v[108:111]
  ds_read_b128 v[64:67], v35 offset:16640
  s_waitcnt lgkmcnt(3)
  v_mfma_f32_16x16x32_bf16 v[96:99], v[52:55], v[144:147], v[96:99]
  v_mfma_f32_16x16x32_bf16 v[100:103], v[52:55], v[176:179], v[100:103]
  v_mfma_f32_16x16x32_bf16 v[104:107], v[52:55], v[208:211], v[104:107]
  v_mfma_f32_16x16x32_bf16 v[108:111], v[52:55], v[240:243], v[108:111]
  ds_read_b128 v[52:55], v32 offset:18432
  s_waitcnt lgkmcnt(3)
  v_mfma_f32_16x16x32_bf16 v[96:99], v[56:59], v[148:151], v[96:99]
  v_mfma_f32_16x16x32_bf16 v[100:103], v[56:59], v[180:183], v[100:103]
  v_mfma_f32_16x16x32_bf16 v[104:107], v[56:59], v[212:215], v[104:107]
  v_mfma_f32_16x16x32_bf16 v[108:111], v[56:59], v[244:247], v[108:111]
  ds_read_b128 v[56:59], v33 offset:18432
  s_waitcnt lgkmcnt(3)
  v_mfma_f32_16x16x32_bf16 v[96:99], v[60:63], v[152:155], v[96:99]
  v_mfma_f32_16x16x32_bf16 v[100:103], v[60:63], v[184:187], v[100:103]
  v_mfma_f32_16x16x32_bf16 v[104:107], v[60:63], v[216:219], v[104:107]
  v_mfma_f32_16x16x32_bf16 v[108:111], v[60:63], v[248:251], v[108:111]
  ds_read_b128 v[60:63], v34 offset:18432
  s_waitcnt lgkmcnt(3)
  v_mfma_f32_16x16x32_bf16 v[96:99], v[64:67], v[156:159], v[96:99]
  v_mfma_f32_16x16x32_bf16 v[100:103], v[64:67], v[188:191], v[100:103]
  v_mfma_f32_16x16x32_bf16 v[104:107], v[64:67], v[220:223], v[104:107]
  v_mfma_f32_16x16x32_bf16 v[108:111], v[64:67], v[252:255], v[108:111]
  ds_read_b128 v[64:67], v35 offset:18432
  s_waitcnt lgkmcnt(3)
  v_mfma_f32_16x16x32_bf16 v[112:115], v[52:55], v[128:131], 0
  v_mfma_f32_16x16x32_bf16 v[116:119], v[52:55], v[160:163], 0
  v_mfma_f32_16x16x32_bf16 v[120:123], v[52:55], v[192:195], 0
  v_mfma_f32_16x16x32_bf16 v[124:127], v[52:55], v[224:227], 0
  ds_read_b128 v[52:55], v32 offset:18688
  s_waitcnt lgkmcnt(3)
  v_mfma_f32_16x16x32_bf16 v[112:115], v[56:59], v[132:135], v[112:115]
  v_mfma_f32_16x16x32_bf16 v[116:119], v[56:59], v[164:167], v[116:119]
  v_mfma_f32_16x16x32_bf16 v[120:123], v[56:59], v[196:199], v[120:123]
  v_mfma_f32_16x16x32_bf16 v[124:127], v[56:59], v[228:231], v[124:127]
  ds_read_b128 v[56:59], v33 offset:18688
  s_waitcnt lgkmcnt(3)
  v_mfma_f32_16x16x32_bf16 v[112:115], v[60:63], v[136:139], v[112:115]
  v_mfma_f32_16x16x32_bf16 v[116:119], v[60:63], v[168:171], v[116:119]
  v_mfma_f32_16x16x32_bf16 v[120:123], v[60:63], v[200:203], v[120:123]
  v_mfma_f32_16x16x32_bf16 v[124:127], v[60:63], v[232:235], v[124:127]
  ds_read_b128 v[60:63], v34 offset:18688
  s_waitcnt lgkmcnt(3)
  v_mfma_f32_16x16x32_bf16 v[112:115], v[64:67], v[140:143], v[112:115]
  v_mfma_f32_16x16x32_bf16 v[116:119], v[64:67], v[172:175], v[116:119]
  v_mfma_f32_16x16x32_bf16 v[120:123], v[64:67], v[204:207], v[120:123]
  v_mfma_f32_16x16x32_bf16 v[124:127], v[64:67], v[236:239], v[124:127]
  ds_read_b128 v[64:67], v35 offset:18688
  s_waitcnt lgkmcnt(3)
  v_mfma_f32_16x16x32_bf16 v[112:115], v[52:55], v[144:147], v[112:115]
  v_mfma_f32_16x16x32_bf16 v[116:119], v[52:55], v[176:179], v[116:119]
  v_mfma_f32_16x16x32_bf16 v[120:123], v[52:55], v[208:211], v[120:123]
  v_mfma_f32_16x16x32_bf16 v[124:127], v[52:55], v[240:243], v[124:127]
  s_waitcnt lgkmcnt(2)
  v_mfma_f32_16x16x32_bf16 v[112:115], v[56:59], v[148:151], v[112:115]
  v_mfma_f32_16x16x32_bf16 v[116:119], v[56:59], v[180:183], v[116:119]
  v_mfma_f32_16x16x32_bf16 v[120:123], v[56:59], v[212:215], v[120:123]
  v_mfma_f32_16x16x32_bf16 v[124:127], v[56:59], v[244:247], v[124:127]
  s_waitcnt lgkmcnt(1)
  v_mfma_f32_16x16x32_bf16 v[112:115], v[60:63], v[152:155], v[112:115]
  v_mfma_f32_16x16x32_bf16 v[116:119], v[60:63], v[184:187], v[116:119]
  v_mfma_f32_16x16x32_bf16 v[120:123], v[60:63], v[216:219], v[120:123]
  v_mfma_f32_16x16x32_bf16 v[124:127], v[60:63], v[248:251], v[124:127]
  s_waitcnt lgkmcnt(0)
  v_mfma_f32_16x16x32_bf16 v[112:115], v[64:67], v[156:159], v[112:115]
  v_mfma_f32_16x16x32_bf16 v[116:119], v[64:67], v[188:191], v[116:119]
  v_mfma_f32_16x16x32_bf16 v[120:123], v[64:67], v[220:223], v[120:123]
  v_mfma_f32_16x16x32_bf16 v[124:127], v[64:67], v[252:255], v[124:127]
  s_lshl_b32 s30, s29, 10
  v_cvt_pk_bf16_f32 v68, v96, v97
  v_cvt_pk_bf16_f32 v69, v98, v99
  v_cvt_pk_bf16_f32 v70, v112, v113
  v_cvt_pk_bf16_f32 v71, v114, v115
  buffer_store_dwordx4 v[68:71], v12, s[8:11], s30 offen sc1
  v_cvt_pk_bf16_f32 v72, v100, v101
  v_cvt_pk_bf16_f32 v73, v102, v103
  v_cvt_pk_bf16_f32 v74, v116, v117
  v_cvt_pk_bf16_f32 v75, v118, v119
  buffer_store_dwordx4 v[72:75], v13, s[8:11], s30 offen sc1
  v_cvt_pk_bf16_f32 v76, v104, v105
  v_cvt_pk_bf16_f32 v77, v106, v107
  v_cvt_pk_bf16_f32 v78, v120, v121
  v_cvt_pk_bf16_f32 v79, v122, v123
  buffer_store_dwordx4 v[76:79], v14, s[8:11], s30 offen sc1
  v_cvt_pk_bf16_f32 v80, v108, v109
  v_cvt_pk_bf16_f32 v81, v110, v111
  v_cvt_pk_bf16_f32 v82, v124, v125
  v_cvt_pk_bf16_f32 v83, v126, v127
  buffer_store_dwordx4 v[80:83], v15, s[8:11], s30 offen sc1
bj_w3:
  s_lshl_b32 s77, s19, 8
  s_lshl_b32 s21, s17, 4
  s_add_u32 s77, s77, s21
  s_cmp_lg_u32 s31, 0
  s_cselect_b32 s21, 8, 0
  s_add_u32 s77, s77, s21
  s_add_u32 s77, s77, 88600576
  s_add_u32 s78, s77, 2048
  s_cmp_lg_u32 s66, 0
  s_cbranch_scc1 bj_cf
  s_cmp_lg_u32 s16, 0
  s_cbranch_scc1 w0_29
  s_waitcnt vmcnt(8)
  v_readfirstlane_b32 s70, v46
  s_cmp_lg_u32 s70, 0
  s_cbranch_scc1 bj_nz
  v_mov_b32 v45, 128
  v_mov_b32 v46, s88
  v_mov_b32 v47, s89
  v_mov_b32 v48, 0
  v_mov_b32 v49, 0
  s_mov_b64 exec, 1
  buffer_atomic_cmpswap_x2 v[46:49], v45, s[12:15], 0 offen sc0
  s_mov_b64 exec, -1
  s_waitcnt vmcnt(0)
  v_readfirstlane_b32 s70, v46
  s_cmp_lg_u32 s70, 0
  s_cbranch_scc1 bj_nz
  v_mov_b32 v46, s88
  v_mov_b32 v47, s89
bj_nz:
w0_29:
  v_mov_b32 v45, 160000
  s_add_u32 s101, s101, 1
  s_barrier
  s_mov_b64 exec, 1
  s_cmp_lg_u32 s16, 0
  s_cbranch_scc1 w0_30
  ds_write_b32 v45, v44 offset:0
  ds_write_b32 v45, v46 offset:4
  ds_write_b32 v45, v47 offset:8
  s_waitcnt lgkmcnt(0)
  v_mov_b32 v44, s101
  ds_write_b32 v45, v44 offset:16
  s_waitcnt lgkmcnt(0)
w0_30:
  s_mov_b64 exec, -1
  s_barrier
  ds_read_b32 v44, v45 offset:0
  ds_read_b32 v46, v45 offset:4
  ds_read_b32 v47, v45 offset:8
  ds_read_b32 v45, v45 offset:16
  s_waitcnt lgkmcnt(0)
  v_readfirstlane_b32 s70, v44
  v_readfirstlane_b32 s88, v46
  v_readfirstlane_b32 s89, v47
  v_cmp_ne_u32 vcc, s101, v45
  s_cbranch_vccnz ch_end
  s_mov_b32 s66, 1
  s_bitcmp1_b32 s70, s3
  s_cbranch_scc1 m_reclaim
bj_cf:
  s_barrier
  s_mov_b32 s56, s40
  s_and_b32 s57, s41, 0xffff
  s_mov_b32 s58, 3670016
  s_mov_b32 s59, 0x20000
  s_mov_b32 s60, s42
  s_and_b32 s61, s43, 0xffff
  s_mov_b32 s62, 3670016
  s_mov_b32 s63, 0x20000
  s_add_u32 s28, s31, s19
  v_lshrrev_b32 v5, 5, v1
  v_and_b32 v6, 31, v1
  v_xor_b32 v6, v6, v5
  v_lshlrev_b32 v6, 4, v6
  v_lshl_add_u32 v6, v5, 13, v6
  s_lshl_b32 s20, s16, 6
  v_xor_b32 v7, s20, v6
  s_lshl_b32 s22, s28, 18
  s_lshl_b32 s21, s16, 16
  s_add_u32 s22, s22, s21
  s_add_u32 s22, s22, s26
  s_lshl_b32 m0, s16, 12
  v_xor_b32 v8, 0, v7
  buffer_load_dwordx4 v8, s[56:59], s22 offen offset:0 lds
  v_xor_b32 v8, 32, v7
  v_add_u32 v8, 15360, v8
  buffer_load_dwordx4 v8, s[56:59], s22 offen offset:1024 lds
  v_xor_b32 v8, 0, v7
  v_add_u32 v8, 30720, v8
  buffer_load_dwordx4 v8, s[56:59], s22 offen offset:2048 lds
  v_xor_b32 v8, 32, v7
  v_add_u32 v8, 46080, v8
  buffer_load_dwordx4 v8, s[56:59], s22 offen offset:3072 lds
  v_xor_b32 v16, 0, v6
  v_xor_b32 v17, 32, v6
  v_add_u32 v17, 31744, v17
  v_xor_b32 v18, 64, v6
  v_add_u32 v18, 129024, v18
  v_xor_b32 v19, 96, v6
  v_add_u32 v19, 160768, v19
  v_xor_b32 v20, 128, v6
  v_add_u32 v20, 262144, v20
  v_xor_b32 v21, 160, v6
  v_add_u32 v21, 293888, v21
  v_xor_b32 v22, 192, v6
  v_add_u32 v22, 391168, v22
  v_xor_b32 v23, 224, v6
  v_add_u32 v23, 422912, v23
  s_lshr_b32 s20, s16, 1
  s_lshl_b32 s20, s20, 16
  s_and_b32 s21, s16, 1
  s_lshl_b32 s21, s21, 14
  s_add_u32 s20, s20, s21
  s_add_u32 s29, s20, s26
  s_mul_i32 s25, s16, 24576
  s_add_u32 s25, s25, 16384
  s_add_u32 s22, s29, 2097152
  s_add_u32 m0, s25, 0
  s_nop 0
  buffer_load_dwordx4 v16, s[60:63], s22 offen offset:0 lds
  buffer_load_dwordx4 v17, s[60:63], s22 offen offset:1024 lds
  buffer_load_dwordx4 v18, s[60:63], s22 offen offset:2048 lds
  buffer_load_dwordx4 v19, s[60:63], s22 offen offset:3072 lds
  s_add_u32 m0, s25, 4096
  s_nop 0
  buffer_load_dwordx4 v20, s[60:63], s22 offen offset:0 lds
  buffer_load_dwordx4 v21, s[60:63], s22 offen offset:1024 lds
  buffer_load_dwordx4 v22, s[60:63], s22 offen offset:2048 lds
  buffer_load_dwordx4 v23, s[60:63], s22 offen offset:3072 lds
  s_waitcnt vmcnt(12)
  s_barrier
  s_cmp_lg_u32 s16, 0
  s_cbranch_scc1 pub_31
  v_mul_u32_u24 v50, 2048, v1
  v_mov_b32 v48, s88
  v_mov_b32 v49, s89
  s_mov_b64 exec, 1
  buffer_store_dwordx2 v[48:49], v50, s[8:11], s77 offen sc1
  s_mov_b64 exec, -1
pub_31:
  s_cmp_ge_u32 s18, 70
  s_cbranch_scc1 bk_nm
  s_mov_b32 s20, 71565312
  buffer_store_dwordx4 v[84:87], v92, s[8:11], s20 offen sc1
  buffer_store_dwordx4 v[88:91], v92, s[8:11], s20 offen offset:256 sc1
  s_cmp_lg_u32 s18, 0
  s_cbranch_scc1 bk_nm
  v_min_u32 v104, -2, v36
  v_min_u32 v108, -2, v37
  v_min_u32 v105, -2, v38
  v_min_u32 v109, -2, v39
  v_min_u32 v106, -2, v40
  v_min_u32 v110, -2, v41
  v_min_u32 v107, -2, v42
  v_min_u32 v111, -2, v43
  s_mov_b32 s20, 88653824
  s_mov_b32 s21, 88080384
  buffer_store_dwordx4 v[104:107], v94, s[8:11], s20 offen sc1
  buffer_store_dwordx4 v[108:111], v94, s[8:11], s20 offen offset:128 sc1
  buffer_store_dwordx4 v[104:107], v94, s[8:11], s21 offen sc1
  buffer_store_dwordx4 v[108:111], v94, s[8:11], s21 offen offset:128 sc1
bk_nm:
  s_mov_b32 s23, 88653824
  v_add_u32 v6, 448, v95
  v_subrev_u32 v7, 1152, v6
  v_mov_b32 v52, -1
  v_mov_b32 v9, 0
  v_cmp_gt_u32 vcc, 128, v7
  s_nop 1
  v_cndmask_b32 v52, v52, v9, vcc
  v_mov_b32 v53, v52
  v_mov_b32 v54, v52
  v_mov_b32 v55, v52
  v_lshlrev_b32 v8, 4, v6
  v_mov_b32 v9, 0x10000000
  v_cmp_lt_u32 vcc, 25599, v6
  s_nop 1
  v_cndmask_b32 v8, v8, v9, vcc
  buffer_store_dwordx4 v[52:55], v8, s[8:11], s23 offen sc1
  s_mov_b32 s23, 87957504
  v_add_u32 v6, 448, v95
  v_cmp_gt_u32 vcc, 7680, v95
  s_nop 1
  v_cndmask_b32 v6, v6, v95, vcc
  v_subrev_u32 v7, 36352, v6
  v_mov_b32 v56, -1
  v_mov_b32 v9, 0
  v_cmp_gt_u32 vcc, 1048576, v7
  s_nop 1
  v_cndmask_b32 v56, v56, v9, vcc
  v_mov_b32 v57, v56
  v_mov_b32 v58, v56
  v_mov_b32 v59, v56
  v_lshlrev_b32 v8, 4, v6
  v_mov_b32 v9, 0x10000000
  v_cmp_lt_u32 vcc, 40191, v6
  s_nop 1
  v_cndmask_b32 v8, v8, v9, vcc
  buffer_store_dwordx4 v[56:59], v8, s[8:11], s23 offen sc1
  s_add_u32 s22, s29, 2621440
  s_add_u32 m0, s25, 8192
  s_nop 0
  buffer_load_dwordx4 v16, s[60:63], s22 offen offset:0 lds
  buffer_load_dwordx4 v17, s[60:63], s22 offen offset:1024 lds
  buffer_load_dwordx4 v18, s[60:63], s22 offen offset:2048 lds
  buffer_load_dwordx4 v19, s[60:63], s22 offen offset:3072 lds
  s_add_u32 m0, s25, 12288
  s_nop 0
  buffer_load_dwordx4 v20, s[60:63], s22 offen offset:0 lds
  buffer_load_dwordx4 v21, s[60:63], s22 offen offset:1024 lds
  buffer_load_dwordx4 v22, s[60:63], s22 offen offset:2048 lds
  buffer_load_dwordx4 v23, s[60:63], s22 offen offset:3072 lds
  s_add_u32 s22, s29, 3145728
  s_add_u32 m0, s25, 16384
  s_nop 0
  buffer_load_dwordx4 v16, s[60:63], s22 offen offset:0 lds
  buffer_load_dwordx4 v17, s[60:63], s22 offen offset:1024 lds
  buffer_load_dwordx4 v18, s[60:63], s22 offen offset:2048 lds
  buffer_load_dwordx4 v19, s[60:63], s22 offen offset:3072 lds
  s_add_u32 m0, s25, 20480
  s_nop 0
  buffer_load_dwordx4 v20, s[60:63], s22 offen offset:0 lds
  buffer_load_dwordx4 v21, s[60:63], s22 offen offset:1024 lds
  buffer_load_dwordx4 v22, s[60:63], s22 offen offset:2048 lds
  buffer_load_dwordx4 v23, s[60:63], s22 offen offset:3072 lds
  v_mov_b32 v250, s68
  s_or_b32 s20, s69, s16
  s_cbranch_scc1 bj_ht
  s_cmp_lg_u32 s16, 0
  s_cbranch_scc1 w0_32
  v_mov_b32 v250, 1
  v_mov_b32 v251, 192
  s_mov_b64 exec, 1
  buffer_atomic_add v250, v251, s[12:15], 0 offen sc0
  s_mov_b64 exec, -1
w0_32:
  s_branch bj_h2
bj_ht:
  buffer_load_dword v251, off, s[8:11], s77
bj_h2:
  v_lshrrev_b32 v7, 2, v4
  v_lshlrev_b32 v7, 3, v7
  v_and_b32 v8, 3, v4
  v_add_u32 v7, v7, v8
  v_xor_b32 v10, v3, v4
  v_lshlrev_b32 v10, 4, v10
  v_lshl_add_u32 v11, v4, 9, v10
  v_add_u32 v11, s25, v11
  v_lshl_add_u32 v10, v7, 9, v10
  v_xor_b32 v32, 0, v10
  v_xor_b32 v36, 0, v11
  v_xor_b32 v33, 64, v10
  v_xor_b32 v37, 64, v11
  v_xor_b32 v34, 128, v10
  v_xor_b32 v38, 128, v11
  v_xor_b32 v35, 192, v10
  v_xor_b32 v39, 192, v11
  s_mul_i32 s30, s17, 401408
  s_mul_i32 s20, s16, 14336
  s_add_u32 s30, s30, s20
  s_lshl_b32 s20, s28, 10
  s_add_u32 s30, s30, s20
  s_mov_b32 s24, 1035512379
  s_lshl_b32 s20, s17, 7
  s_lshl_b32 s28, s28, 3
  s_add_u32 s28, s28, s20
  s_add_u32 s28, s28, 88635392
  s_waitcnt vmcnt(1)
  s_barrier
  s_cmp_lg_u32 s16, 0
  s_cbranch_scc1 w0_33
  v_mul_u32_u24 v50, 2048, v1
  v_mov_b32 v48, s88
  v_mov_b32 v49, s89
  s_mov_b64 exec, 511
  buffer_store_dwordx2 v[48:49], v50, s[8:11], s78 offen sc1
  s_mov_b64 exec, -1
w0_33:
  ds_read_b128 v[128:131], v32 offset:0
  ds_read_b128 v[132:135], v32 offset:2048
  ds_read_b128 v[136:139], v36 offset:0
  ds_read_b128 v[140:143], v36 offset:8192
  ds_read_b128 v[144:147], v36 offset:16384
  ds_read_b128 v[148:151], v33 offset:0
  ds_read_b128 v[152:155], v33 offset:2048
  ds_read_b128 v[156:159], v37 offset:0
  ds_read_b128 v[160:163], v37 offset:8192
  ds_read_b128 v[164:167], v37 offset:16384
  ds_read_b128 v[168:171], v34 offset:0
  ds_read_b128 v[172:175], v34 offset:2048
  ds_read_b128 v[176:179], v38 offset:0
  ds_read_b128 v[180:183], v38 offset:8192
  ds_read_b128 v[184:187], v38 offset:16384
  s_waitcnt lgkmcnt(10)
  v_mfma_f32_16x16x32_bf16 v[96:99], v[128:131], v[136:139], 0
  v_mfma_f32_16x16x32_bf16 v[100:103], v[132:135], v[136:139], 0
  v_mfma_f32_16x16x32_bf16 v[104:107], v[128:131], v[140:143], 0
  v_mfma_f32_16x16x32_bf16 v[108:111], v[132:135], v[140:143], 0
  v_mfma_f32_16x16x32_bf16 v[112:115], v[128:131], v[144:147], 0
  v_mfma_f32_16x16x32_bf16 v[116:119], v[132:135], v[144:147], 0
  ds_read_b128 v[128:131], v35 offset:0
  ds_read_b128 v[132:135], v35 offset:2048
  ds_read_b128 v[136:139], v39 offset:0
  ds_read_b128 v[140:143], v39 offset:8192
  ds_read_b128 v[144:147], v39 offset:16384
  s_waitcnt lgkmcnt(10)
  v_mfma_f32_16x16x32_bf16 v[96:99], v[148:151], v[156:159], v[96:99]
  v_mfma_f32_16x16x32_bf16 v[100:103], v[152:155], v[156:159], v[100:103]
  v_mfma_f32_16x16x32_bf16 v[104:107], v[148:151], v[160:163], v[104:107]
  v_mfma_f32_16x16x32_bf16 v[108:111], v[152:155], v[160:163], v[108:111]
  v_mfma_f32_16x16x32_bf16 v[112:115], v[148:151], v[164:167], v[112:115]
  v_mfma_f32_16x16x32_bf16 v[116:119], v[152:155], v[164:167], v[116:119]
  ds_read_b128 v[148:151], v32 offset:256
  ds_read_b128 v[152:155], v32 offset:2304
  ds_read_b128 v[156:159], v36 offset:256
  ds_read_b128 v[160:163], v36 offset:8448
  ds_read_b128 v[164:167], v36 offset:16640
  s_waitcnt lgkmcnt(10)
  v_mfma_f32_16x16x32_bf16 v[96:99], v[168:171], v[176:179], v[96:99]
  v_mfma_f32_16x16x32_bf16 v[100:103], v[172:175], v[176:179], v[100:103]
  v_mfma_f32_16x16x32_bf16 v[104:107], v[168:171], v[180:183], v[104:107]
  v_mfma_f32_16x16x32_bf16 v[108:111], v[172:175], v[180:183], v[108:111]
  v_mfma_f32_16x16x32_bf16 v[112:115], v[168:171], v[184:187], v[112:115]
  v_mfma_f32_16x16x32_bf16 v[116:119], v[172:175], v[184:187], v[116:119]
  ds_read_b128 v[168:171], v33 offset:256
  ds_read_b128 v[172:175], v33 offset:2304
  ds_read_b128 v[176:179], v37 offset:256
  ds_read_b128 v[180:183], v37 offset:8448
  ds_read_b128 v[184:187], v37 offset:16640
  s_waitcnt lgkmcnt(10)
  v_mfma_f32_16x16x32_bf16 v[96:99], v[128:131], v[136:139], v[96:99]
  v_mfma_f32_16x16x32_bf16 v[100:103], v[132:135], v[136:139], v[100:103]
  v_mfma_f32_16x16x32_bf16 v[104:107], v[128:131], v[140:143], v[104:107]
  v_mfma_f32_16x16x32_bf16 v[108:111], v[132:135], v[140:143], v[108:111]
  v_mfma_f32_16x16x32_bf16 v[112:115], v[128:131], v[144:147], v[112:115]
  v_mfma_f32_16x16x32_bf16 v[116:119], v[132:135], v[144:147], v[116:119]
  ds_read_b128 v[128:131], v34 offset:256
  ds_read_b128 v[132:135], v34 offset:2304
  ds_read_b128 v[136:139], v38 offset:256
  ds_read_b128 v[140:143], v38 offset:8448
  ds_read_b128 v[144:147], v38 offset:16640
  s_waitcnt lgkmcnt(10)
  v_mfma_f32_16x16x32_bf16 v[96:99], v[148:151], v[156:159], v[96:99]
  v_mfma_f32_16x16x32_bf16 v[100:103], v[152:155], v[156:159], v[100:103]
  v_mfma_f32_16x16x32_bf16 v[104:107], v[148:151], v[160:163], v[104:107]
  v_mfma_f32_16x16x32_bf16 v[108:111], v[152:155], v[160:163], v[108:111]
  v_mfma_f32_16x16x32_bf16 v[112:115], v[148:151], v[164:167], v[112:115]
  v_mfma_f32_16x16x32_bf16 v[116:119], v[152:155], v[164:167], v[116:119]
  ds_read_b128 v[148:151], v35 offset:256
  ds_read_b128 v[152:155], v35 offset:2304
  ds_read_b128 v[156:159], v39 offset:256
  ds_read_b128 v[160:163], v39 offset:8448
  ds_read_b128 v[164:167], v39 offset:16640
  s_waitcnt lgkmcnt(10)
  v_mfma_f32_16x16x32_bf16 v[96:99], v[168:171], v[176:179], v[96:99]
  v_mfma_f32_16x16x32_bf16 v[100:103], v[172:175], v[176:179], v[100:103]
  v_mfma_f32_16x16x32_bf16 v[104:107], v[168:171], v[180:183], v[104:107]
  v_mfma_f32_16x16x32_bf16 v[108:111], v[172:175], v[180:183], v[108:111]
  v_mfma_f32_16x16x32_bf16 v[112:115], v[168:171], v[184:187], v[112:115]
  v_mfma_f32_16x16x32_bf16 v[116:119], v[172:175], v[184:187], v[116:119]
  s_waitcnt lgkmcnt(5)
  v_mfma_f32_16x16x32_bf16 v[96:99], v[128:131], v[136:139], v[96:99]
  v_mfma_f32_16x16x32_bf16 v[100:103], v[132:135], v[136:139], v[100:103]
  v_mfma_f32_16x16x32_bf16 v[104:107], v[128:131], v[140:143], v[104:107]
  v_mfma_f32_16x16x32_bf16 v[108:111], v[132:135], v[140:143], v[108:111]
  v_mfma_f32_16x16x32_bf16 v[112:115], v[128:131], v[144:147], v[112:115]
  v_mfma_f32_16x16x32_bf16 v[116:119], v[132:135], v[144:147], v[116:119]
  s_waitcnt lgkmcnt(0)
  v_mfma_f32_16x16x32_bf16 v[96:99], v[148:151], v[156:159], v[96:99]
  v_mfma_f32_16x16x32_bf16 v[100:103], v[152:155], v[156:159], v[100:103]
  v_mfma_f32_16x16x32_bf16 v[104:107], v[148:151], v[160:163], v[104:107]
  v_mfma_f32_16x16x32_bf16 v[108:111], v[152:155], v[160:163], v[108:111]
  v_mfma_f32_16x16x32_bf16 v[112:115], v[148:151], v[164:167], v[112:115]
  v_mfma_f32_16x16x32_bf16 v[116:119], v[152:155], v[164:167], v[116:119]
  v_mul_f32 v96, s24, v96
  v_mul_f32 v97, s24, v97
  v_mul_f32 v98, s24, v98
  v_mul_f32 v99, s24, v99
  v_mul_f32 v100, s24, v100
  v_mul_f32 v101, s24, v101
  v_mul_f32 v102, s24, v102
  v_mul_f32 v103, s24, v103
  v_cvt_pk_bf16_f32 v68, v96, v97
  v_cvt_pk_bf16_f32 v69, v98, v99
  v_cvt_pk_bf16_f32 v70, v100, v101
  v_cvt_pk_bf16_f32 v71, v102, v103
  s_add_u32 s20, s30, 229376
  buffer_store_dwordx4 v[68:71], v2, s[8:11], s20 offen sc1
  v_mul_f32 v104, s24, v104
  v_mul_f32 v105, s24, v105
  v_mul_f32 v106, s24, v106
  v_mul_f32 v107, s24, v107
  v_mul_f32 v108, s24, v108
  v_mul_f32 v109, s24, v109
  v_mul_f32 v110, s24, v110
  v_mul_f32 v111, s24, v111
  v_cvt_pk_bf16_f32 v72, v104, v105
  v_cvt_pk_bf16_f32 v73, v106, v107
  v_cvt_pk_bf16_f32 v74, v108, v109
  v_cvt_pk_bf16_f32 v75, v110, v111
  s_add_u32 s20, s30, 286720
  buffer_store_dwordx4 v[72:75], v2, s[8:11], s20 offen sc1
  v_mul_f32 v112, s24, v112
  v_mul_f32 v113, s24, v113
  v_mul_f32 v114, s24, v114
  v_mul_f32 v115, s24, v115
  v_mul_f32 v116, s24, v116
  v_mul_f32 v117, s24, v117
  v_mul_f32 v118, s24, v118
  v_mul_f32 v119, s24, v119
  v_cvt_pk_bf16_f32 v76, v112, v113
  v_cvt_pk_bf16_f32 v77, v114, v115
  v_cvt_pk_bf16_f32 v78, v116, v117
  v_cvt_pk_bf16_f32 v79, v118, v119
  s_add_u32 s20, s30, 344064
  buffer_store_dwordx4 v[76:79], v2, s[8:11], s20 offen sc1
  s_waitcnt vmcnt(0)
  s_barrier
  s_cmp_lg_u32 s16, 0
  s_cbranch_scc1 pub_34
  v_mul_u32_u24 v26, 2048, v1
  v_mov_b32 v24, s88
  v_mov_b32 v25, s89
  s_mov_b64 exec, 1
  buffer_store_dwordx2 v[24:25], v26, s[8:11], s28 offen sc1
  s_mov_b64 exec, -1
pub_34:
  v_mov_b32 v6, 160000
  s_add_u32 s101, s101, 1
  s_barrier
  s_mov_b64 exec, 1
  s_cmp_lg_u32 s16, 0
  s_cbranch_scc1 w0_35
  ds_write_b32 v6, v250 offset:0
  s_waitcnt lgkmcnt(0)
  v_mov_b32 v250, s101
  ds_write_b32 v6, v250 offset:16
  s_waitcnt lgkmcnt(0)
w0_35:
  s_mov_b64 exec, -1
  s_barrier
  ds_read_b32 v250, v6 offset:0
  ds_read_b32 v6, v6 offset:16
  s_waitcnt lgkmcnt(0)
  v_readfirstlane_b32 s3, v250
  v_cmp_ne_u32 vcc, s101, v6
  s_cbranch_vccnz ch_end
  s_branch wk_have
wk_loop:
  s_waitcnt vmcnt(0) lgkmcnt(0)
  s_cmp_eq_u32 s96, 1
  s_cbranch_scc1 wk_ask
  s_mov_b32 s96, 1
  s_cmp_lg_u32 s16, 0
  s_cbranch_scc1 w0_36
  s_mov_b32 s30, 0
  v_mov_b32 v243, 32
sf_l:
  buffer_load_dword v242, v243, s[12:15], 0 offen sc1
  s_waitcnt vmcnt(0)
  v_readfirstlane_b32 s70, v242
  s_cmp_eq_u32 s70, -1
  s_cbranch_scc1 sf_d
  s_sleep 16
  s_add_u32 s30, s30, 1
  s_cmp_lt_u32 s30, 64
  s_cbranch_scc1 sf_l
  s_mov_b32 s20, 0
  s_mov_b32 s21, 0
  s_mov_b64 exec, 1
sf_c_l:
  s_cmp_lg_u32 s70, -1
  s_cbranch_scc1 sf_c_t
  s_add_u32 s20, s20, 1
  s_cmp_lt_u32 s20, 8
  s_cselect_b32 s20, s20, 0
  s_mov_b32 s70, 0
  s_mov_b32 s3, -1
  s_add_u32 s21, s21, 1
  s_cmp_ge_u32 s21, 1
  s_cbranch_scc1 sf_c_d
sf_c_t:
  s_ff0_i32_b32 s22, s70
  s_lshl_b32 s23, 1, s22
  s_and_b32 s71, s20, 4
  s_mul_i32 s71, s71, 12
  s_lshl_b32 s3, s20, 2
  s_add_u32 s3, s3, s71
  v_mov_b32 v242, s23
  v_mov_b32 v243, 32
  buffer_atomic_or v242, v243, s[12:15], s3 offen sc0
  s_waitcnt vmcnt(0)
  v_readfirstlane_b32 s70, v242
  s_lshl_b32 s3, s20, 5
  s_add_u32 s3, s3, s22
  s_bitcmp1_b32 s70, s22
  s_cbranch_scc1 sf_c_l
sf_c_d:
  s_mov_b64 exec, -1
  v_mov_b32 v242, s3
sf_d:
w0_36:
  v_mov_b32 v243, 160000
  s_add_u32 s101, s101, 1
  s_barrier
  s_mov_b64 exec, 1
  s_cmp_lg_u32 s16, 0
  s_cbranch_scc1 w0_37
  ds_write_b32 v243, v242 offset:0
  s_waitcnt lgkmcnt(0)
  v_mov_b32 v242, s101
  ds_write_b32 v243, v242 offset:16
  s_waitcnt lgkmcnt(0)
w0_37:
  s_mov_b64 exec, -1
  s_barrier
  ds_read_b32 v242, v243 offset:0
  ds_read_b32 v243, v243 offset:16
  s_waitcnt lgkmcnt(0)
  v_readfirstlane_b32 s3, v242
  v_cmp_ne_u32 vcc, s101, v243
  s_cbranch_vccnz ch_end
  s_cmp_eq_u32 s3, -1
  s_cbranch_scc1 wk_ask
  s_load_dwordx8 s[36:43], s[0:1], 56
  s_load_dwordx4 s[44:47], s[0:1], 88
  s_getreg_b32 s67, hwreg(HW_REG_XCC_ID)
  s_and_b32 s67, s67, 7
  s_mov_b32 s66, 1
  s_waitcnt lgkmcnt(0)
  s_branch m_start
wk_ask:
  v_readfirstlane_b32 s22, v250
  s_cmp_ge_u32 s22, 1440
  s_cbranch_scc1 wk_next
  s_cmp_lg_u32 s16, 0
  s_cbranch_scc1 w0_38
  v_mov_b32 v250, 1
  v_mov_b32 v251, 192
  s_mov_b64 exec, 1
  buffer_atomic_add v250, v251, s[12:15], 0 offen sc0
  s_mov_b64 exec, -1
w0_38:
wk_next:
  s_waitcnt vmcnt(0)
  v_mov_b32 v6, 160000
  s_add_u32 s101, s101, 1
  s_barrier
  s_mov_b64 exec, 1
  s_cmp_lg_u32 s16, 0
  s_cbranch_scc1 w0_39
  ds_write_b32 v6, v250 offset:0
  s_waitcnt lgkmcnt(0)
  v_mov_b32 v250, s101
  ds_write_b32 v6, v250 offset:16
  s_waitcnt lgkmcnt(0)
w0_39:
  s_mov_b64 exec, -1
  s_barrier
  ds_read_b32 v250, v6 offset:0
  ds_read_b32 v6, v6 offset:16
  s_waitcnt lgkmcnt(0)
  v_readfirstlane_b32 s3, v250
  v_cmp_ne_u32 vcc, s101, v6
  s_cbranch_vccnz ch_end
wk_have:
  s_cmp_ge_u32 s3, 1440
  s_cbranch_scc1 ch_end
  v_mov_b32 v250, 0
  v_mov_b32 v251, 192
  v_and_b32 v1, 63, v0
  v_lshlrev_b32 v2, 4, v1
  v_lshrrev_b32 v3, 4, v1
  v_and_b32 v4, 15, v1
  s_cmp_lg_u32 s97, 0
  s_cbranch_scc1 wk_go
  s_mov_b32 s68, s3
  s_mov_b32 s69, 1
  s_cmp_lg_u32 s16, 0
  s_cbranch_scc1 w0_40
  s_add_u32 s20, s67, 1
  s_lshl_b32 s22, s20, 11
  s_add_u32 s22, s22, 88602624
  v_add_u32 v24, 1024, v2
  v_min_u32 v24, 1776, v24
  s_mov_b32 s30, 0
wk_af:
  buffer_load_dwordx4 v[28:31], v2, s[8:11], s22 offen sc1
  buffer_load_dwordx4 v[32:35], v24, s[8:11], s22 offen sc1
  s_waitcnt vmcnt(0)
  v_cmp_ne_u64 vcc, s[88:89], v[28:29]
  s_cbranch_vccnz wk_af_no
  v_cmp_ne_u64 vcc, s[88:89], v[30:31]
  s_cbranch_vccnz wk_af_no
  v_cmp_ne_u64 vcc, s[88:89], v[32:33]
  s_cbranch_vccnz wk_af_no
  v_cmp_ne_u64 vcc, s[88:89], v[34:35]
  s_cbranch_vccnz wk_af_no
  s_branch wk_af_ok
wk_af_no:
  s_sleep 4
  s_add_u32 s30, s30, 1
  s_and_b32 s20, s30, 63
  s_cbranch_scc1 wk_ns
  s_mov_b32 s20, 1
  s_mov_b32 s70, 0
  s_mov_b32 s21, 0
  s_mov_b64 exec, 1
wk_st_l:
  s_cmp_lg_u32 s70, -1
  s_cbranch_scc1 wk_st_t
  s_add_u32 s20, s20, 1
  s_cmp_lt_u32 s20, 8
  s_cselect_b32 s20, s20, 1
  s_mov_b32 s70, 0
  s_mov_b32 s3, -1
  s_add_u32 s21, s21, 1
  s_cmp_ge_u32 s21, 7
  s_cbranch_scc1 wk_st_d
wk_st_t:
  s_ff0_i32_b32 s22, s70
  s_lshl_b32 s23, 1, s22
  s_and_b32 s71, s20, 4
  s_mul_i32 s71, s71, 12
  s_lshl_b32 s3, s20, 2
  s_add_u32 s3, s3, s71
  v_mov_b32 v242, s23
  v_mov_b32 v243, 32
  buffer_atomic_or v242, v243, s[12:15], s3 offen sc0
  s_waitcnt vmcnt(0)
  v_readfirstlane_b32 s70, v242
  s_lshl_b32 s3, s20, 5
  s_add_u32 s3, s3, s22
  s_bitcmp1_b32 s70, s22
  s_cbranch_scc1 wk_st_l
wk_st_d:
  s_mov_b64 exec, -1
  v_mov_b32 v242, s3
  s_cmp_lg_u32 s3, -1
  s_cbranch_scc1 wk_pd
  s_add_u32 s20, s67, 1
  s_lshl_b32 s22, s20, 11
  s_add_u32 s22, s22, 88602624
wk_ns:
  s_cmp_lt_u32 s30, 50000
  s_cbranch_scc1 wk_af
  s_branch cA_abort
wk_af_ok:
  v_mov_b32 v242, -1
wk_pd:
w0_40:
  v_mov_b32 v243, 160000
  s_add_u32 s101, s101, 1
  s_barrier
  s_mov_b64 exec, 1
  s_cmp_lg_u32 s16, 0
  s_cbranch_scc1 w0_41
  ds_write_b32 v243, v242 offset:0
  s_waitcnt lgkmcnt(0)
  v_mov_b32 v242, s101
  ds_write_b32 v243, v242 offset:16
  s_waitcnt lgkmcnt(0)
w0_41:
  s_mov_b64 exec, -1
  s_barrier
  ds_read_b32 v242, v243 offset:0
  ds_read_b32 v243, v243 offset:16
  s_waitcnt lgkmcnt(0)
  v_readfirstlane_b32 s3, v242
  v_cmp_ne_u32 vcc, s101, v243
  s_cbranch_vccnz ch_end
  s_cmp_lg_u32 s3, -1
  s_cbranch_scc1 m_bjob
  s_mov_b32 s3, s68
  s_mov_b32 s97, 1
wk_go:
  s_cmp_lt_u32 s3, 368
  s_cbranch_scc1 wk_g2
  s_sub_u32 s20, s3, 432
  s_cmp_lt_u32 s20, 128
  s_cbranch_scc1 wk_g2
  s_cmp_eq_u32 s97, 2
  s_cbranch_scc1 wk_g2
  s_getreg_b32 s20, hwreg(HW_REG_XCC_ID)
  s_and_b32 s20, s20, 7
  s_cmp_lg_u32 s16, 0
  s_cbranch_scc1 w0_42
  s_lshl_b32 s22, s20, 11
  s_add_u32 s22, s22, 88637440
  v_add_u32 v24, 1024, v2
  v_min_u32 v24, 1776, v24
  s_mov_b32 s30, 0
wk_i2:
  buffer_load_dwordx4 v[28:31], v2, s[8:11], s22 offen sc1
  buffer_load_dwordx4 v[32:35], v24, s[8:11], s22 offen sc1
  s_waitcnt vmcnt(0)
  v_cmp_ne_u64 vcc, s[88:89], v[28:29]
  s_cbranch_vccnz wk_i2_no
  v_cmp_ne_u64 vcc, s[88:89], v[30:31]
  s_cbranch_vccnz wk_i2_no
  v_cmp_ne_u64 vcc, s[88:89], v[32:33]
  s_cbranch_vccnz wk_i2_no
  v_cmp_ne_u64 vcc, s[88:89], v[34:35]
  s_cbranch_vccnz wk_i2_no
  s_branch wk_i2_ok
wk_i2_no:
  s_sleep 4
  s_add_u32 s30, s30, 1
  s_cmp_lt_u32 s30, 50000
  s_cbranch_scc1 wk_i2
  s_branch cA_abort
wk_i2_ok:
w0_42:
  v_mov_b32 v242, 0
  v_mov_b32 v243, 160000
  s_add_u32 s101, s101, 1
  s_barrier
  s_mov_b64 exec, 1
  s_cmp_lg_u32 s16, 0
  s_cbranch_scc1 w0_43
  ds_write_b32 v243, v242 offset:0
  s_waitcnt lgkmcnt(0)
  v_mov_b32 v242, s101
  ds_write_b32 v243, v242 offset:16
  s_waitcnt lgkmcnt(0)
w0_43:
  s_mov_b64 exec, -1
  s_barrier
  ds_read_b32 v242, v243 offset:0
  ds_read_b32 v243, v243 offset:16
  s_waitcnt lgkmcnt(0)
  v_readfirstlane_b32 s20, v242
  v_cmp_ne_u32 vcc, s101, v243
  s_cbranch_vccnz ch_end
  s_mov_b32 s97, 2
wk_g2:
  s_cmp_ge_u32 s3, 864
  s_cbranch_scc1 wk_tok
  s_cmp_ge_u32 s3, 752
  s_cbranch_scc1 wk_s4d
  s_cmp_ge_u32 s3, 624
  s_cbranch_scc1 wk_f
  s_cmp_ge_u32 s3, 560
  s_cbranch_scc1 wk_vf
  s_cmp_ge_u32 s3, 432
  s_cbranch_scc1 wk_a
  s_cmp_ge_u32 s3, 368
  s_cbranch_scc1 wk_vh
  s_cmp_ge_u32 s3, 256
  s_cbranch_scc1 wk_v7
  s_cmp_ge_u32 s3, 224
  s_cbranch_scc1 wk_srv
  s_sub_u32 s20, s3, 0
  s_cmp_ge_u32 s20, 112
  s_cselect_b32 s18, 1, 0
  s_cselect_b32 s21, 112, 0
  s_sub_u32 s20, s20, s21
  s_and_b32 s17, s20, 15
  s_add_u32 s17, s17, 16
  s_lshr_b32 s34, s20, 4
  s_lshl_b32 s34, s34, 1
  s_add_u32 s35, s34, 2
  s_cmp_eq_u32 s18, 0
  s_cbranch_scc1 wf_nw
  s_and_b32 s20, s3, 3
  s_lshl_b32 s20, s20, 3
  s_add_u32 s20, s20, 8
  s_cmp_eq_u32 s16, 0
  s_cselect_b32 s20, 0, s20
  s_cmp_ge_u32 s16, 2
  s_cselect_b32 s20, 112, s20
  s_load_dwordx2 s[72:73], s[0:1], s20
  s_lshr_b32 s21, s3, 2
  s_lshl_b32 s21, s21, 12
  s_mov_b32 s74, 229376
  s_lshl_b32 s22, s3, 13
  s_cmp_eq_u32 s16, 0
  s_cselect_b32 s21, s22, s21
  s_cselect_b32 s74, 1835008, s74
  s_lshl_b32 s22, s3, 1
  s_add_u32 s22, s22, s16
  s_sub_u32 s22, s22, 2
  s_lshl_b32 s22, s22, 13
  s_cmp_ge_u32 s16, 2
  s_cselect_b32 s21, s22, s21
  s_cselect_b32 s74, 3670016, s74
  v_lshlrev_b32 v6, 3, v2
  s_cmp_lt_u32 s16, 2
  s_cbranch_scc1 lw_44
  s_lshl_b32 s21, s3, 6
  v_add_u32 v6, s21, v1
  v_mul_u32_u24 v7, 37450, v6
  v_lshrrev_b32 v7, 18, v7
  v_add_u32 v7, 1, v7
  v_mul_u32_u24 v7, 7, v7
  v_add_u32 v6, v6, v7
  v_lshlrev_b32 v6, 7, v6
  s_mov_b32 s21, 0
  s_cmp_eq_u32 s16, 3
  s_cselect_b32 s74, 0, s74
lw_44:
  s_cmp_eq_u32 s16, 1
  s_cselect_b32 exec_hi, 0, -1
  s_waitcnt lgkmcnt(0)
  s_and_b32 s73, s73, 0xffff
  s_mov_b32 s75, 0x20000
  buffer_load_dword v7, v6, s[72:75], s21 offen
  s_mov_b64 exec, -1
  s_sub_u32 s3, s3, 112
  s_and_b32 s20, s3, 3
  s_lshl_b32 s20, s20, 3
  s_add_u32 s20, s20, 8
  s_cmp_eq_u32 s16, 0
  s_cselect_b32 s20, 0, s20
  s_cmp_ge_u32 s16, 2
  s_cselect_b32 s20, 112, s20
  s_load_dwordx2 s[72:73], s[0:1], s20
  s_lshr_b32 s21, s3, 2
  s_lshl_b32 s21, s21, 12
  s_mov_b32 s74, 229376
  s_lshl_b32 s22, s3, 13
  s_cmp_eq_u32 s16, 0
  s_cselect_b32 s21, s22, s21
  s_cselect_b32 s74, 1835008, s74
  s_lshl_b32 s22, s3, 1
  s_add_u32 s22, s22, s16
  s_sub_u32 s22, s22, 2
  s_lshl_b32 s22, s22, 13
  s_cmp_ge_u32 s16, 2
  s_cselect_b32 s21, s22, s21
  s_cselect_b32 s74, 3670016, s74
  v_lshlrev_b32 v6, 3, v2
  s_cmp_lt_u32 s16, 2
  s_cbranch_scc1 lw_45
  s_lshl_b32 s21, s3, 6
  v_add_u32 v6, s21, v1
  v_mul_u32_u24 v7, 37450, v6
  v_lshrrev_b32 v7, 18, v7
  v_add_u32 v7, 1, v7
  v_mul_u32_u24 v7, 7, v7
  v_add_u32 v6, v6, v7
  v_lshlrev_b32 v6, 7, v6
  s_mov_b32 s21, 0
  s_cmp_eq_u32 s16, 3
  s_cselect_b32 s74, 0, s74
lw_45:
  s_cmp_eq_u32 s16, 1
  s_cselect_b32 exec_hi, 0, -1
  s_waitcnt lgkmcnt(0)
  s_and_b32 s73, s73, 0xffff
  s_mov_b32 s75, 0x20000
  buffer_load_dword v7, v6, s[72:75], s21 offen
  s_mov_b64 exec, -1
  s_add_u32 s3, s3, 112
wf_nw:
  s_lshl_b32 s20, s18, 3
  s_lshl_b32 s21, s16, 1
  s_add_u32 s20, s20, s21
  s_mul_i32 s21, s20, 14336
  s_add_u32 s21, s21, 71565312
  s_add_u32 s22, s21, 0
  buffer_load_dwordx4 a[0:3], v2, s[8:11], s22 offen offset:0 sc1
  buffer_load_dwordx4 a[4:7], v2, s[8:11], s22 offen offset:1024 sc1
  buffer_load_dwordx4 a[8:11], v2, s[8:11], s22 offen offset:2048 sc1
  buffer_load_dwordx4 a[12:15], v2, s[8:11], s22 offen offset:3072 sc1
  s_add_u32 s22, s21, 4096
  buffer_load_dwordx4 a[16:19], v2, s[8:11], s22 offen offset:0 sc1
  buffer_load_dwordx4 a[20:23], v2, s[8:11], s22 offen offset:1024 sc1
  buffer_load_dwordx4 a[24:27], v2, s[8:11], s22 offen offset:2048 sc1
  buffer_load_dwordx4 a[28:31], v2, s[8:11], s22 offen offset:3072 sc1
  s_add_u32 s22, s21, 8192
  buffer_load_dwordx4 a[32:35], v2, s[8:11], s22 offen offset:0 sc1
  buffer_load_dwordx4 a[36:39], v2, s[8:11], s22 offen offset:1024 sc1
  buffer_load_dwordx4 a[40:43], v2, s[8:11], s22 offen offset:2048 sc1
  buffer_load_dwordx4 a[44:47], v2, s[8:11], s22 offen offset:3072 sc1
  s_add_u32 s22, s21, 12288
  buffer_load_dwordx4 a[48:51], v2, s[8:11], s22 offen offset:0 sc1
  buffer_load_dwordx4 a[52:55], v2, s[8:11], s22 offen offset:1024 sc1
  buffer_load_dwordx4 a[56:59], v2, s[8:11], s22 offen offset:2048 sc1
  buffer_load_dwordx4 a[60:63], v2, s[8:11], s22 offen offset:3072 sc1
  s_add_u32 s22, s21, 16384
  buffer_load_dwordx4 a[64:67], v2, s[8:11], s22 offen offset:0 sc1
  buffer_load_dwordx4 a[68:71], v2, s[8:11], s22 offen offset:1024 sc1
  buffer_load_dwordx4 a[72:75], v2, s[8:11], s22 offen offset:2048 sc1
  buffer_load_dwordx4 a[76:79], v2, s[8:11], s22 offen offset:3072 sc1
  s_add_u32 s22, s21, 20480
  buffer_load_dwordx4 a[80:83], v2, s[8:11], s22 offen offset:0 sc1
  buffer_load_dwordx4 a[84:87], v2, s[8:11], s22 offen offset:1024 sc1
  buffer_load_dwordx4 a[88:91], v2, s[8:11], s22 offen offset:2048 sc1
  buffer_load_dwordx4 a[92:95], v2, s[8:11], s22 offen offset:3072 sc1
  s_add_u32 s22, s21, 24576
  buffer_load_dwordx4 a[96:99], v2, s[8:11], s22 offen offset:0 sc1
  buffer_load_dwordx4 a[100:103], v2, s[8:11], s22 offen offset:1024 sc1
  buffer_load_dwordx4 a[104:107], v2, s[8:11], s22 offen offset:2048 sc1
  buffer_load_dwordx4 a[108:111], v2, s[8:11], s22 offen offset:3072 sc1
  s_waitcnt vmcnt(40)
  s_mul_i32 s23, s17, 401408
  s_and_b32 s22, s16, 1
  s_mul_i32 s22, s22, 7168
  s_add_u32 s23, s23, s22
  s_add_u32 s23, s23, 0
  s_lshr_b32 s22, s16, 1
  s_mul_i32 s22, s22, 14336
  s_add_u32 s23, s23, s22
  s_mul_i32 s27, s16, 7168
  s_lshr_b32 s28, s20, 1
wf_vo:
  s_sub_u32 s29, s17, 16
  s_lshl_b32 s29, s29, 6
  s_add_u32 s29, s29, s28
  s_mul_i32 s29, s29, 28672
  s_add_u32 s29, s29, 42205184
  v_lshlrev_b32 v6, 4, v3
  v_mad_u32_u24 v7, v3, 12, 64
  s_mov_b32 s31, 0
  s_lshl_b32 s24, s34, 1
  s_mul_i32 s24, s24, 14336
  s_add_u32 s24, s24, s23
  s_cmp_lt_u32 s34, s35
  s_cselect_b32 s24, s24, 0x10000000
  s_add_u32 m0, s31, s27
  s_nop 0
  buffer_load_dwordx4 v2, s[8:11], s24 offen offset:0 sc1 lds
  buffer_load_dwordx4 v2, s[8:11], s24 offen offset:1024 sc1 lds
  buffer_load_dwordx4 v2, s[8:11], s24 offen offset:2048 sc1 lds
  buffer_load_dwordx4 v2, s[8:11], s24 offen offset:3072 sc1 lds
  s_add_u32 m0, m0, 4096
  s_add_u32 s24, s24, 4096
  buffer_load_dwordx4 v2, s[8:11], s24 offen offset:0 sc1 lds
  buffer_load_dwordx4 v2, s[8:11], s24 offen offset:1024 sc1 lds
  buffer_load_dwordx4 v2, s[8:11], s24 offen offset:2048 sc1 lds
  s_add_u32 s30, s34, 1
  s_mov_b32 s31, 28672
  s_lshl_b32 s24, s30, 1
  s_mul_i32 s24, s24, 14336
  s_add_u32 s24, s24, s23
  s_cmp_lt_u32 s30, s35
  s_cselect_b32 s24, s24, 0x10000000
  s_add_u32 m0, s31, s27
  s_nop 0
  buffer_load_dwordx4 v2, s[8:11], s24 offen offset:0 sc1 lds
  buffer_load_dwordx4 v2, s[8:11], s24 offen offset:1024 sc1 lds
  buffer_load_dwordx4 v2, s[8:11], s24 offen offset:2048 sc1 lds
  buffer_load_dwordx4 v2, s[8:11], s24 offen offset:3072 sc1 lds
  s_add_u32 m0, m0, 4096
  s_add_u32 s24, s24, 4096
  buffer_load_dwordx4 v2, s[8:11], s24 offen offset:0 sc1 lds
  buffer_load_dwordx4 v2, s[8:11], s24 offen offset:1024 sc1 lds
  buffer_load_dwordx4 v2, s[8:11], s24 offen offset:2048 sc1 lds
  s_mov_b32 s19, s34
  s_mov_b32 s32, 0
  s_mov_b32 s33, 57344
  s_waitcnt vmcnt(7)
  s_branch wf_vo_in
wf_vo_loop:
  s_waitcnt vmcnt(9)
wf_vo_in:
  s_barrier
  s_add_u32 s30, s19, 2
  s_lshl_b32 s24, s30, 1
  s_mul_i32 s24, s24, 14336
  s_add_u32 s24, s24, s23
  s_cmp_lt_u32 s30, s35
  s_cselect_b32 s24, s24, 0x10000000
  s_add_u32 m0, s33, s27
  s_nop 0
  buffer_load_dwordx4 v2, s[8:11], s24 offen offset:0 sc1 lds
  buffer_load_dwordx4 v2, s[8:11], s24 offen offset:1024 sc1 lds
  buffer_load_dwordx4 v2, s[8:11], s24 offen offset:2048 sc1 lds
  buffer_load_dwordx4 v2, s[8:11], s24 offen offset:3072 sc1 lds
  s_add_u32 m0, m0, 4096
  s_add_u32 s24, s24, 4096
  buffer_load_dwordx4 v2, s[8:11], s24 offen offset:0 sc1 lds
  buffer_load_dwordx4 v2, s[8:11], s24 offen offset:1024 sc1 lds
  buffer_load_dwordx4 v2, s[8:11], s24 offen offset:2048 sc1 lds
  v_add_u32 v5, s32, v2
  ds_read_b128 v[8:11], v5 offset:0
  ds_read_b128 v[12:15], v5 offset:14336
  ds_read_b128 v[16:19], v5 offset:1024
  ds_read_b128 v[20:23], v5 offset:15360
  ds_read_b128 v[24:27], v5 offset:2048
  ds_read_b128 v[28:31], v5 offset:16384
  ds_read_b128 v[32:35], v5 offset:3072
  s_waitcnt lgkmcnt(6)
  v_mfma_f32_16x16x32_bf16 v[40:43], a[0:3], v[8:11], 0
  v_mfma_f32_16x16x32_bf16 v[44:47], a[56:59], v[8:11], 0
  ds_read_b128 v[36:39], v5 offset:17408
  s_waitcnt lgkmcnt(6)
  v_mfma_f32_16x16x32_bf16 v[56:59], a[0:3], v[12:15], 0
  v_mfma_f32_16x16x32_bf16 v[60:63], a[56:59], v[12:15], 0
  ds_read_b128 v[8:11], v5 offset:4096
  s_waitcnt lgkmcnt(6)
  v_mfma_f32_16x16x32_bf16 v[40:43], a[4:7], v[16:19], v[40:43]
  v_mfma_f32_16x16x32_bf16 v[44:47], a[60:63], v[16:19], v[44:47]
  ds_read_b128 v[12:15], v5 offset:18432
  s_waitcnt lgkmcnt(6)
  v_mfma_f32_16x16x32_bf16 v[56:59], a[4:7], v[20:23], v[56:59]
  v_mfma_f32_16x16x32_bf16 v[60:63], a[60:63], v[20:23], v[60:63]
  ds_read_b128 v[16:19], v5 offset:5120
  s_waitcnt lgkmcnt(6)
  v_mfma_f32_16x16x32_bf16 v[40:43], a[8:11], v[24:27], v[40:43]
  v_mfma_f32_16x16x32_bf16 v[44:47], a[64:67], v[24:27], v[44:47]
  ds_read_b128 v[20:23], v5 offset:19456
  s_waitcnt lgkmcnt(6)
  v_mfma_f32_16x16x32_bf16 v[56:59], a[8:11], v[28:31], v[56:59]
  v_mfma_f32_16x16x32_bf16 v[60:63], a[64:67], v[28:31], v[60:63]
  ds_read_b128 v[24:27], v5 offset:6144
  s_waitcnt lgkmcnt(6)
  v_mfma_f32_16x16x32_bf16 v[40:43], a[12:15], v[32:35], v[40:43]
  v_mfma_f32_16x16x32_bf16 v[44:47], a[68:71], v[32:35], v[44:47]
  ds_read_b128 v[28:31], v5 offset:20480
  s_waitcnt lgkmcnt(6)
  v_mfma_f32_16x16x32_bf16 v[56:59], a[12:15], v[36:39], v[56:59]
  v_mfma_f32_16x16x32_bf16 v[60:63], a[68:71], v[36:39], v[60:63]
  ds_read_b128 v[32:35], v5 offset:7168
  s_waitcnt lgkmcnt(6)
  v_mfma_f32_16x16x32_bf16 v[40:43], a[16:19], v[8:11], v[40:43]
  v_mfma_f32_16x16x32_bf16 v[44:47], a[72:75], v[8:11], v[44:47]
  ds_read_b128 v[36:39], v5 offset:21504
  s_waitcnt lgkmcnt(6)
  v_mfma_f32_16x16x32_bf16 v[56:59], a[16:19], v[12:15], v[56:59]
  v_mfma_f32_16x16x32_bf16 v[60:63], a[72:75], v[12:15], v[60:63]
  ds_read_b128 v[8:11], v5 offset:8192
  s_waitcnt lgkmcnt(6)
  v_mfma_f32_16x16x32_bf16 v[40:43], a[20:23], v[16:19], v[40:43]
  v_mfma_f32_16x16x32_bf16 v[44:47], a[76:79], v[16:19], v[44:47]
  ds_read_b128 v[12:15], v5 offset:22528
  s_waitcnt lgkmcnt(6)
  v_mfma_f32_16x16x32_bf16 v[56:59], a[20:23], v[20:23], v[56:59]
  v_mfma_f32_16x16x32_bf16 v[60:63], a[76:79], v[20:23], v[60:63]
  ds_read_b128 v[16:19], v5 offset:9216
  s_waitcnt lgkmcnt(6)
  v_mfma_f32_16x16x32_bf16 v[40:43], a[24:27], v[24:27], v[40:43]
  v_mfma_f32_16x16x32_bf16 v[44:47], a[80:83], v[24:27], v[44:47]
  ds_read_b128 v[20:23], v5 offset:23552
  s_waitcnt lgkmcnt(6)
  v_mfma_f32_16x16x32_bf16 v[56:59], a[24:27], v[28:31], v[56:59]
  v_mfma_f32_16x16x32_bf16 v[60:63], a[80:83], v[28:31], v[60:63]
  ds_read_b128 v[24:27], v5 offset:10240
  s_waitcnt lgkmcnt(6)
  v_mfma_f32_16x16x32_bf16 v[40:43], a[28:31], v[32:35], v[40:43]
  v_mfma_f32_16x16x32_bf16 v[44:47], a[84:87], v[32:35], v[44:47]
  ds_read_b128 v[28:31], v5 offset:24576
  s_waitcnt lgkmcnt(6)
  v_mfma_f32_16x16x32_bf16 v[56:59], a[28:31], v[36:39], v[56:59]
  v_mfma_f32_16x16x32_bf16 v[60:63], a[84:87], v[36:39], v[60:63]
  ds_read_b128 v[32:35], v5 offset:11264
  s_waitcnt lgkmcnt(6)
  v_mfma_f32_16x16x32_bf16 v[40:43], a[32:35], v[8:11], v[40:43]
  v_mfma_f32_16x16x32_bf16 v[44:47], a[88:91], v[8:11], v[44:47]
  ds_read_b128 v[36:39], v5 offset:25600
  s_waitcnt lgkmcnt(6)
  v_mfma_f32_16x16x32_bf16 v[56:59], a[32:35], v[12:15], v[56:59]
  v_mfma_f32_16x16x32_bf16 v[60:63], a[88:91], v[12:15], v[60:63]
  ds_read_b128 v[8:11], v5 offset:12288
  s_waitcnt lgkmcnt(6)
  v_mfma_f32_16x16x32_bf16 v[40:43], a[36:39], v[16:19], v[40:43]
  v_mfma_f32_16x16x32_bf16 v[44:47], a[92:95], v[16:19], v[44:47]
  ds_read_b128 v[12:15], v5 offset:26624
  s_waitcnt lgkmcnt(6)
  v_mfma_f32_16x16x32_bf16 v[56:59], a[36:39], v[20:23], v[56:59]
  v_mfma_f32_16x16x32_bf16 v[60:63], a[92:95], v[20:23], v[60:63]
  ds_read_b128 v[16:19], v5 offset:13312
  s_waitcnt lgkmcnt(6)
  v_mfma_f32_16x16x32_bf16 v[40:43], a[40:43], v[24:27], v[40:43]
  v_mfma_f32_16x16x32_bf16 v[44:47], a[96:99], v[24:27], v[44:47]
  ds_read_b128 v[20:23], v5 offset:27648
  s_waitcnt lgkmcnt(6)
  v_mfma_f32_16x16x32_bf16 v[56:59], a[40:43], v[28:31], v[56:59]
  v_mfma_f32_16x16x32_bf16 v[60:63], a[96:99], v[28:31], v[60:63]
  s_waitcnt lgkmcnt(5)
  v_mfma_f32_16x16x32_bf16 v[40:43], a[44:47], v[32:35], v[40:43]
  v_mfma_f32_16x16x32_bf16 v[44:47], a[100:103], v[32:35], v[44:47]
  s_waitcnt lgkmcnt(4)
  v_mfma_f32_16x16x32_bf16 v[56:59], a[44:47], v[36:39], v[56:59]
  v_mfma_f32_16x16x32_bf16 v[60:63], a[100:103], v[36:39], v[60:63]
  s_waitcnt lgkmcnt(3)
  v_mfma_f32_16x16x32_bf16 v[40:43], a[48:51], v[8:11], v[40:43]
  v_mfma_f32_16x16x32_bf16 v[44:47], a[104:107], v[8:11], v[44:47]
  s_waitcnt lgkmcnt(2)
  v_mfma_f32_16x16x32_bf16 v[56:59], a[48:51], v[12:15], v[56:59]
  v_mfma_f32_16x16x32_bf16 v[60:63], a[104:107], v[12:15], v[60:63]
  s_waitcnt lgkmcnt(1)
  v_mfma_f32_16x16x32_bf16 v[40:43], a[52:55], v[16:19], v[40:43]
  v_mfma_f32_16x16x32_bf16 v[44:47], a[108:111], v[16:19], v[44:47]
  s_waitcnt lgkmcnt(0)
  v_mfma_f32_16x16x32_bf16 v[56:59], a[52:55], v[20:23], v[56:59]
  v_mfma_f32_16x16x32_bf16 v[60:63], a[108:111], v[20:23], v[60:63]
  s_add_u32 s25, s29, 28672
  s_lshl_b32 s24, s19, 5
  s_add_u32 s24, s24, 0
  v_add_u32 v88, s24, v4
  s_cmp_lt_u32 s19, 8
  s_cselect_b64 vcc, -1, 0
  s_cselect_b32 s24, 0, 256
  v_subrev_u32 v88, s24, v88
  s_movk_i32 s24, 5462
  s_cselect_b32 s24, 4096, s24
  v_mul_u32_u24 v89, s24, v88
  v_lshrrev_b32 v89, 16, v89
  s_movk_i32 s24, 100
  s_cselect_b32 s24, 96, s24
  v_mul_u32_u24 v89, s24, v89
  v_cndmask_b32 v92, v7, v6, vcc
  v_add3_u32 v88, v88, v89, v92
  v_lshlrev_b32 v90, 4, v88
  v_cvt_pk_bf16_f32 v72, v40, v41
  v_cvt_pk_bf16_f32 v73, v42, v43
  v_cvt_pk_bf16_f32 v74, v44, v45
  v_cvt_pk_bf16_f32 v75, v46, v47
  buffer_store_dwordx4 v[72:75], v90, s[8:11], s29 offen sc1
  s_lshl_b32 s24, s19, 5
  s_add_u32 s24, s24, 16
  v_add_u32 v88, s24, v4
  s_cmp_lt_u32 s19, 8
  s_cselect_b64 vcc, -1, 0
  s_cselect_b32 s24, 0, 256
  v_subrev_u32 v88, s24, v88
  s_movk_i32 s24, 5462
  s_cselect_b32 s24, 4096, s24
  v_mul_u32_u24 v89, s24, v88
  v_lshrrev_b32 v89, 16, v89
  s_movk_i32 s24, 100
  s_cselect_b32 s24, 96, s24
  v_mul_u32_u24 v89, s24, v89
  v_cndmask_b32 v92, v7, v6, vcc
  v_add3_u32 v88, v88, v89, v92
  v_lshlrev_b32 v91, 4, v88
  v_cvt_pk_bf16_f32 v80, v56, v57
  v_cvt_pk_bf16_f32 v81, v58, v59
  v_cvt_pk_bf16_f32 v82, v60, v61
  v_cvt_pk_bf16_f32 v83, v62, v63
  buffer_store_dwordx4 v[80:83], v91, s[8:11], s29 offen sc1
  s_mov_b32 s33, s32
  s_add_u32 s32, s32, 28672
  s_cmp_eq_u32 s32, 86016
  s_cselect_b32 s32, 0, s32
  s_add_u32 s19, s19, 1
  s_cmp_lt_u32 s19, s35
  s_cbranch_scc1 wf_vo_loop
  s_branch wf_done
wf_done:
  s_lshr_b32 s20, s18, 1
  s_lshl_b32 s20, s20, 4
  s_and_b32 s21, s17, 15
  s_add_u32 s20, s20, s21
  s_lshl_b32 s20, s20, 7
  s_cmp_lt_u32 s17, 16
  s_cselect_b32 s21, 16384, 0
  s_add_u32 s20, s20, s21
  s_add_u32 s20, s20, 88541184
  s_sub_u32 s21, s35, s34
  s_lshr_b32 s21, s21, 1
  v_mov_b32 v5, s21
  v_mov_b32 v6, 0
  s_waitcnt vmcnt(0)
  s_mov_b64 exec, 1
  s_cmp_lg_u32 s18, 0
  s_cbranch_scc1 wf_h1
  v_mov_b32 v7, 2
  s_sub_u32 s21, s20, 2048
  buffer_atomic_add v7, v6, s[8:11], s21 offen
wf_h1:
  buffer_atomic_add v5, v6, s[8:11], s20 offen
  s_mov_b64 exec, -1
  s_load_dwordx8 s[36:43], s[0:1], 56
  s_load_dwordx4 s[44:47], s[0:1], 88
  s_waitcnt lgkmcnt(0)
  s_mov_b32 s52, s36
  s_and_b32 s53, s37, 0xffff
  s_mov_b32 s54, 1835008
  s_mov_b32 s55, 0x20000
  s_lshl_b32 s20, s3, 8
  v_add_u32 v95, s20, v0
  s_mov_b32 s21, 9586981
  v_mul_hi_u32 v6, v95, s21
  v_mul_u32_u24 v7, 448, v6
  v_sub_u32 v7, v95, v7
  v_lshrrev_b32 v8, 4, v7
  v_and_b32 v7, 15, v7
  v_lshl_add_u32 v9, v6, 4, v7
  v_mul_u32_u24 v9, 896, v9
  v_lshl_add_u32 v9, v8, 5, v9
  buffer_load_dwordx4 v[84:87], v9, s[52:55], 0 offen
  buffer_load_dwordx4 v[88:91], v9, s[52:55], 0 offen offset:16
  v_mul_u32_u24 v6, 14336, v6
  v_lshl_add_u32 v6, v7, 4, v6
  v_lshl_add_u32 v92, v8, 9, v6
  v_lshrrev_b32 v7, 2, v8
  v_lshl_add_u32 v6, v7, 11, v6
  v_and_b32 v7, 3, v8
  v_lshl_add_u32 v93, v7, 8, v6
  v_mov_b32 v52, -1
  v_mov_b32 v53, -1
  v_mov_b32 v54, -1
  v_mov_b32 v55, -1
  s_mov_b32 s23, 89063424
  v_lshlrev_b32 v8, 4, v95
  buffer_store_dwordx4 v[52:55], v8, s[8:11], s23 offen sc1
  v_add_u32 v8, 917504, v8
  v_mov_b32 v9, 0x10000000
  v_cmp_lt_u32 vcc, 1535, v95
  s_nop 1
  v_cndmask_b32 v8, v8, v9, vcc
  buffer_store_dwordx4 v[52:55], v8, s[8:11], s23 offen sc1
  s_waitcnt vmcnt(1)
  v_mov_b32 v96, v84
  v_mov_b32 v100, v85
  v_mov_b32 v97, v86
  v_mov_b32 v101, v87
  v_mov_b32 v98, v88
  v_mov_b32 v102, v89
  v_mov_b32 v99, v90
  v_mov_b32 v103, v91
  s_mov_b32 s20, 71565312
  s_mov_b32 s21, 73400320
  buffer_store_dwordx4 v[96:99], v93, s[8:11], s21 offen sc1
  buffer_store_dwordx4 v[100:103], v93, s[8:11], s21 offen offset:1024 sc1
  s_cmp_lt_u32 s3, 70
  s_cbranch_scc1 i2_nx
  buffer_store_dwordx4 v[84:87], v92, s[8:11], s20 offen sc1
  buffer_store_dwordx4 v[88:91], v92, s[8:11], s20 offen offset:256 sc1
i2_nx:
  s_lshl_b32 s20, s3, 3
  s_add_u32 s20, s20, 88637440
  s_waitcnt vmcnt(0)
  s_barrier
  s_cmp_lg_u32 s16, 0
  s_cbranch_scc1 pub_46
  v_mul_u32_u24 v26, 2048, v1
  v_mov_b32 v24, s88
  v_mov_b32 v25, s89
  s_mov_b64 exec, 255
  buffer_store_dwordx2 v[24:25], v26, s[8:11], s20 offen sc1
  s_mov_b64 exec, -1
pub_46:
  s_branch wk_loop
wk_v7:
  s_sub_u32 s20, s3, 256
  s_mov_b32 s18, 1
  s_and_b32 s17, s20, 15
  s_add_u32 s17, s17, 16
  s_lshr_b32 s34, s20, 4
  s_lshl_b32 s34, s34, 1
  s_add_u32 s35, s34, 2
  s_branch wk_gemm
wk_vh:
  s_sub_u32 s20, s3, 368
  s_and_b32 s17, s20, 15
  s_add_u32 s17, s17, 16
  s_lshr_b32 s18, s20, 5
  s_add_u32 s18, s18, 2
  s_bitcmp1_b32 s20, 4
  s_cselect_b32 s34, 7, 0
  s_add_u32 s35, s34, 7
  s_branch wk_gemm
wk_vf:
  s_sub_u32 s20, s3, 560
  s_and_b32 s17, s20, 15
  s_add_u32 s17, s17, 16
  s_lshr_b32 s18, s20, 4
  s_add_u32 s18, s18, 4
  s_mov_b32 s34, 0
  s_mov_b32 s35, 14
  s_branch wk_gemm
wk_f:
  s_sub_u32 s20, s3, 624
  s_and_b32 s17, s20, 15
  s_lshr_b32 s18, s20, 4
  s_mov_b32 s34, 0
  s_mov_b32 s35, 14
  s_lshl_b32 s22, s17, 7
  s_add_u32 s22, s22, 88633344
  s_add_u32 s23, s22, 2048
  v_min_u32 v24, 48, v2
  v_min_u32 v25, 96, v2
  s_mov_b32 s30, 0
wk_aw:
  buffer_load_dwordx4 v[28:31], v24, s[8:11], s22 offen sc1
  buffer_load_dwordx4 v[32:35], v25, s[8:11], s23 offen sc1
  s_waitcnt vmcnt(0)
  v_cmp_ne_u64 vcc, s[88:89], v[28:29]
  s_cbranch_vccnz wk_aw_no
  v_cmp_ne_u64 vcc, s[88:89], v[30:31]
  s_cbranch_vccnz wk_aw_no
  v_cmp_ne_u64 vcc, s[88:89], v[32:33]
  s_cbranch_vccnz wk_aw_no
  v_cmp_ne_u64 vcc, s[88:89], v[34:35]
  s_cbranch_vccnz wk_aw_no
  s_branch wk_aw_ok
wk_aw_no:
  s_sleep 6
  s_add_u32 s30, s30, 1
  s_cmp_lt_u32 s30, 50000
  s_cbranch_scc1 wk_aw
  s_branch cA_abort
wk_aw_ok:
wk_gemm:
  s_lshl_b32 s20, s18, 4
  s_lshl_b32 s21, s16, 2
  s_add_u32 s20, s20, s21
  s_mul_i32 s21, s20, 14336
  s_add_u32 s21, s21, 71565312
  s_add_u32 s22, s21, 0
  buffer_load_dwordx4 a[0:3], v2, s[8:11], s22 offen offset:0 sc1
  buffer_load_dwordx4 a[4:7], v2, s[8:11], s22 offen offset:1024 sc1
  buffer_load_dwordx4 a[8:11], v2, s[8:11], s22 offen offset:2048 sc1
  buffer_load_dwordx4 a[12:15], v2, s[8:11], s22 offen offset:3072 sc1
  s_add_u32 s22, s21, 4096
  buffer_load_dwordx4 a[16:19], v2, s[8:11], s22 offen offset:0 sc1
  buffer_load_dwordx4 a[20:23], v2, s[8:11], s22 offen offset:1024 sc1
  buffer_load_dwordx4 a[24:27], v2, s[8:11], s22 offen offset:2048 sc1
  buffer_load_dwordx4 a[28:31], v2, s[8:11], s22 offen offset:3072 sc1
  s_add_u32 s22, s21, 8192
  buffer_load_dwordx4 a[32:35], v2, s[8:11], s22 offen offset:0 sc1
  buffer_load_dwordx4 a[36:39], v2, s[8:11], s22 offen offset:1024 sc1
  buffer_load_dwordx4 a[40:43], v2, s[8:11], s22 offen offset:2048 sc1
  buffer_load_dwordx4 a[44:47], v2, s[8:11], s22 offen offset:3072 sc1
  s_add_u32 s22, s21, 12288
  buffer_load_dwordx4 a[48:51], v2, s[8:11], s22 offen offset:0 sc1
  buffer_load_dwordx4 a[52:55], v2, s[8:11], s22 offen offset:1024 sc1
  buffer_load_dwordx4 a[56:59], v2, s[8:11], s22 offen offset:2048 sc1
  buffer_load_dwordx4 a[60:63], v2, s[8:11], s22 offen offset:3072 sc1
  s_add_u32 s22, s21, 16384
  buffer_load_dwordx4 a[64:67], v2, s[8:11], s22 offen offset:0 sc1
  buffer_load_dwordx4 a[68:71], v2, s[8:11], s22 offen offset:1024 sc1
  buffer_load_dwordx4 a[72:75], v2, s[8:11], s22 offen offset:2048 sc1
  buffer_load_dwordx4 a[76:79], v2, s[8:11], s22 offen offset:3072 sc1
  s_add_u32 s22, s21, 20480
  buffer_load_dwordx4 a[80:83], v2, s[8:11], s22 offen offset:0 sc1
  buffer_load_dwordx4 a[84:87], v2, s[8:11], s22 offen offset:1024 sc1
  buffer_load_dwordx4 a[88:91], v2, s[8:11], s22 offen offset:2048 sc1
  buffer_load_dwordx4 a[92:95], v2, s[8:11], s22 offen offset:3072 sc1
  s_add_u32 s22, s21, 24576
  buffer_load_dwordx4 a[96:99], v2, s[8:11], s22 offen offset:0 sc1
  buffer_load_dwordx4 a[100:103], v2, s[8:11], s22 offen offset:1024 sc1
  buffer_load_dwordx4 a[104:107], v2, s[8:11], s22 offen offset:2048 sc1
  buffer_load_dwordx4 a[108:111], v2, s[8:11], s22 offen offset:3072 sc1
  s_add_u32 s22, s21, 28672
  buffer_load_dwordx4 a[112:115], v2, s[8:11], s22 offen offset:0 sc1
  buffer_load_dwordx4 a[116:119], v2, s[8:11], s22 offen offset:1024 sc1
  buffer_load_dwordx4 a[120:123], v2, s[8:11], s22 offen offset:2048 sc1
  buffer_load_dwordx4 a[124:127], v2, s[8:11], s22 offen offset:3072 sc1
  s_add_u32 s22, s21, 32768
  buffer_load_dwordx4 a[128:131], v2, s[8:11], s22 offen offset:0 sc1
  buffer_load_dwordx4 a[132:135], v2, s[8:11], s22 offen offset:1024 sc1
  buffer_load_dwordx4 a[136:139], v2, s[8:11], s22 offen offset:2048 sc1
  buffer_load_dwordx4 a[140:143], v2, s[8:11], s22 offen offset:3072 sc1
  s_add_u32 s22, s21, 36864
  buffer_load_dwordx4 a[144:147], v2, s[8:11], s22 offen offset:0 sc1
  buffer_load_dwordx4 a[148:151], v2, s[8:11], s22 offen offset:1024 sc1
  buffer_load_dwordx4 a[152:155], v2, s[8:11], s22 offen offset:2048 sc1
  buffer_load_dwordx4 a[156:159], v2, s[8:11], s22 offen offset:3072 sc1
  s_add_u32 s22, s21, 40960
  buffer_load_dwordx4 a[160:163], v2, s[8:11], s22 offen offset:0 sc1
  buffer_load_dwordx4 a[164:167], v2, s[8:11], s22 offen offset:1024 sc1
  buffer_load_dwordx4 a[168:171], v2, s[8:11], s22 offen offset:2048 sc1
  buffer_load_dwordx4 a[172:175], v2, s[8:11], s22 offen offset:3072 sc1
  s_add_u32 s22, s21, 45056
  buffer_load_dwordx4 a[176:179], v2, s[8:11], s22 offen offset:0 sc1
  buffer_load_dwordx4 a[180:183], v2, s[8:11], s22 offen offset:1024 sc1
  buffer_load_dwordx4 a[184:187], v2, s[8:11], s22 offen offset:2048 sc1
  buffer_load_dwordx4 a[188:191], v2, s[8:11], s22 offen offset:3072 sc1
  s_add_u32 s22, s21, 49152
  buffer_load_dwordx4 a[192:195], v2, s[8:11], s22 offen offset:0 sc1
  buffer_load_dwordx4 a[196:199], v2, s[8:11], s22 offen offset:1024 sc1
  buffer_load_dwordx4 a[200:203], v2, s[8:11], s22 offen offset:2048 sc1
  buffer_load_dwordx4 a[204:207], v2, s[8:11], s22 offen offset:3072 sc1
  s_add_u32 s22, s21, 53248
  buffer_load_dwordx4 a[208:211], v2, s[8:11], s22 offen offset:0 sc1
  buffer_load_dwordx4 a[212:215], v2, s[8:11], s22 offen offset:1024 sc1
  buffer_load_dwordx4 a[216:219], v2, s[8:11], s22 offen offset:2048 sc1
  buffer_load_dwordx4 a[220:223], v2, s[8:11], s22 offen offset:3072 sc1
  s_waitcnt vmcnt(40)
  s_mul_i32 s23, s17, 401408
  s_and_b32 s22, s16, 1
  s_mul_i32 s22, s22, 7168
  s_add_u32 s23, s23, s22
  s_add_u32 s23, s23, 0
  s_lshr_b32 s22, s16, 1
  s_mul_i32 s22, s22, 14336
  s_add_u32 s23, s23, s22
  s_mul_i32 s27, s16, 7168
  s_lshr_b32 s28, s20, 1
  s_cmp_lt_u32 s17, 16
  s_cbranch_scc0 wg_vo
  s_add_u32 s23, s23, s22
  s_lshl_b32 s29, s28, 4
  s_add_u32 s29, s29, s17
  s_mul_i32 s29, s29, 28672
  s_add_u32 s29, s29, 12845056
  s_mov_b32 s31, 0
  s_lshr_b32 s24, s34, 1
  s_lshl_b32 s24, s24, 2
  s_and_b32 s25, s34, 1
  s_add_u32 s24, s24, s25
  s_mul_i32 s24, s24, 14336
  s_add_u32 s24, s24, s23
  s_cmp_lt_u32 s34, s35
  s_cselect_b32 s24, s24, 0x10000000
  s_add_u32 m0, s31, s27
  s_nop 0
  buffer_load_dwordx4 v2, s[8:11], s24 offen offset:0 sc1 lds
  buffer_load_dwordx4 v2, s[8:11], s24 offen offset:1024 sc1 lds
  buffer_load_dwordx4 v2, s[8:11], s24 offen offset:2048 sc1 lds
  buffer_load_dwordx4 v2, s[8:11], s24 offen offset:3072 sc1 lds
  s_add_u32 m0, m0, 4096
  s_add_u32 s24, s24, 4096
  buffer_load_dwordx4 v2, s[8:11], s24 offen offset:0 sc1 lds
  buffer_load_dwordx4 v2, s[8:11], s24 offen offset:1024 sc1 lds
  buffer_load_dwordx4 v2, s[8:11], s24 offen offset:2048 sc1 lds
  s_add_u32 s30, s34, 1
  s_mov_b32 s31, 28672
  s_lshr_b32 s24, s30, 1
  s_lshl_b32 s24, s24, 2
  s_and_b32 s25, s30, 1
  s_add_u32 s24, s24, s25
  s_mul_i32 s24, s24, 14336
  s_add_u32 s24, s24, s23
  s_cmp_lt_u32 s30, s35
  s_cselect_b32 s24, s24, 0x10000000
  s_add_u32 m0, s31, s27
  s_nop 0
  buffer_load_dwordx4 v2, s[8:11], s24 offen offset:0 sc1 lds
  buffer_load_dwordx4 v2, s[8:11], s24 offen offset:1024 sc1 lds
  buffer_load_dwordx4 v2, s[8:11], s24 offen offset:2048 sc1 lds
  buffer_load_dwordx4 v2, s[8:11], s24 offen offset:3072 sc1 lds
  s_add_u32 m0, m0, 4096
  s_add_u32 s24, s24, 4096
  buffer_load_dwordx4 v2, s[8:11], s24 offen offset:0 sc1 lds
  buffer_load_dwordx4 v2, s[8:11], s24 offen offset:1024 sc1 lds
  buffer_load_dwordx4 v2, s[8:11], s24 offen offset:2048 sc1 lds
  s_mov_b32 s19, s34
  s_mov_b32 s32, 0
  s_mov_b32 s33, 57344
  s_waitcnt vmcnt(7)
  s_branch wg_f_in
wg_f_loop:
  s_waitcnt vmcnt(11)
wg_f_in:
  s_barrier
  s_add_u32 s30, s19, 2
  s_lshr_b32 s24, s30, 1
  s_lshl_b32 s24, s24, 2
  s_and_b32 s25, s30, 1
  s_add_u32 s24, s24, s25
  s_mul_i32 s24, s24, 14336
  s_add_u32 s24, s24, s23
  s_cmp_lt_u32 s30, s35
  s_cselect_b32 s24, s24, 0x10000000
  s_add_u32 m0, s33, s27
  s_nop 0
  buffer_load_dwordx4 v2, s[8:11], s24 offen offset:0 sc1 lds
  buffer_load_dwordx4 v2, s[8:11], s24 offen offset:1024 sc1 lds
  buffer_load_dwordx4 v2, s[8:11], s24 offen offset:2048 sc1 lds
  buffer_load_dwordx4 v2, s[8:11], s24 offen offset:3072 sc1 lds
  s_add_u32 m0, m0, 4096
  s_add_u32 s24, s24, 4096
  buffer_load_dwordx4 v2, s[8:11], s24 offen offset:0 sc1 lds
  buffer_load_dwordx4 v2, s[8:11], s24 offen offset:1024 sc1 lds
  buffer_load_dwordx4 v2, s[8:11], s24 offen offset:2048 sc1 lds
  v_add_u32 v5, s32, v2
  ds_read_b128 v[8:11], v5 offset:0
  ds_read_b128 v[12:15], v5 offset:14336
  ds_read_b128 v[16:19], v5 offset:1024
  ds_read_b128 v[20:23], v5 offset:15360
  ds_read_b128 v[24:27], v5 offset:2048
  ds_read_b128 v[28:31], v5 offset:16384
  ds_read_b128 v[32:35], v5 offset:3072
  s_waitcnt lgkmcnt(6)
  v_mfma_f32_16x16x32_bf16 v[40:43], v[8:11], a[0:3], 0
  v_mfma_f32_16x16x32_bf16 v[44:47], v[8:11], a[56:59], 0
  v_mfma_f32_16x16x32_bf16 v[48:51], v[8:11], a[112:115], 0
  v_mfma_f32_16x16x32_bf16 v[52:55], v[8:11], a[168:171], 0
  ds_read_b128 v[36:39], v5 offset:17408
  s_waitcnt lgkmcnt(6)
  v_mfma_f32_16x16x32_bf16 v[56:59], v[12:15], a[0:3], 0
  v_mfma_f32_16x16x32_bf16 v[60:63], v[12:15], a[56:59], 0
  v_mfma_f32_16x16x32_bf16 v[64:67], v[12:15], a[112:115], 0
  v_mfma_f32_16x16x32_bf16 v[68:71], v[12:15], a[168:171], 0
  ds_read_b128 v[8:11], v5 offset:4096
  s_waitcnt lgkmcnt(6)
  v_mfma_f32_16x16x32_bf16 v[40:43], v[16:19], a[4:7], v[40:43]
  v_mfma_f32_16x16x32_bf16 v[44:47], v[16:19], a[60:63], v[44:47]
  v_mfma_f32_16x16x32_bf16 v[48:51], v[16:19], a[116:119], v[48:51]
  v_mfma_f32_16x16x32_bf16 v[52:55], v[16:19], a[172:175], v[52:55]
  ds_read_b128 v[12:15], v5 offset:18432
  s_waitcnt lgkmcnt(6)
  v_mfma_f32_16x16x32_bf16 v[56:59], v[20:23], a[4:7], v[56:59]
  v_mfma_f32_16x16x32_bf16 v[60:63], v[20:23], a[60:63], v[60:63]
  v_mfma_f32_16x16x32_bf16 v[64:67], v[20:23], a[116:119], v[64:67]
  v_mfma_f32_16x16x32_bf16 v[68:71], v[20:23], a[172:175], v[68:71]
  ds_read_b128 v[16:19], v5 offset:5120
  s_waitcnt lgkmcnt(6)
  v_mfma_f32_16x16x32_bf16 v[40:43], v[24:27], a[8:11], v[40:43]
  v_mfma_f32_16x16x32_bf16 v[44:47], v[24:27], a[64:67], v[44:47]
  v_mfma_f32_16x16x32_bf16 v[48:51], v[24:27], a[120:123], v[48:51]
  v_mfma_f32_16x16x32_bf16 v[52:55], v[24:27], a[176:179], v[52:55]
  ds_read_b128 v[20:23], v5 offset:19456
  s_waitcnt lgkmcnt(6)
  v_mfma_f32_16x16x32_bf16 v[56:59], v[28:31], a[8:11], v[56:59]
  v_mfma_f32_16x16x32_bf16 v[60:63], v[28:31], a[64:67], v[60:63]
  v_mfma_f32_16x16x32_bf16 v[64:67], v[28:31], a[120:123], v[64:67]
  v_mfma_f32_16x16x32_bf16 v[68:71], v[28:31], a[176:179], v[68:71]
  ds_read_b128 v[24:27], v5 offset:6144
  s_waitcnt lgkmcnt(6)
  v_mfma_f32_16x16x32_bf16 v[40:43], v[32:35], a[12:15], v[40:43]
  v_mfma_f32_16x16x32_bf16 v[44:47], v[32:35], a[68:71], v[44:47]
  v_mfma_f32_16x16x32_bf16 v[48:51], v[32:35], a[124:127], v[48:51]
  v_mfma_f32_16x16x32_bf16 v[52:55], v[32:35], a[180:183], v[52:55]
  ds_read_b128 v[28:31], v5 offset:20480
  s_waitcnt lgkmcnt(6)
  v_mfma_f32_16x16x32_bf16 v[56:59], v[36:39], a[12:15], v[56:59]
  v_mfma_f32_16x16x32_bf16 v[60:63], v[36:39], a[68:71], v[60:63]
  v_mfma_f32_16x16x32_bf16 v[64:67], v[36:39], a[124:127], v[64:67]
  v_mfma_f32_16x16x32_bf16 v[68:71], v[36:39], a[180:183], v[68:71]
  ds_read_b128 v[32:35], v5 offset:7168
  s_waitcnt lgkmcnt(6)
  v_mfma_f32_16x16x32_bf16 v[40:43], v[8:11], a[16:19], v[40:43]
  v_mfma_f32_16x16x32_bf16 v[44:47], v[8:11], a[72:75], v[44:47]
  v_mfma_f32_16x16x32_bf16 v[48:51], v[8:11], a[128:131], v[48:51]
  v_mfma_f32_16x16x32_bf16 v[52:55], v[8:11], a[184:187], v[52:55]
  ds_read_b128 v[36:39], v5 offset:21504
  s_waitcnt lgkmcnt(6)
  v_mfma_f32_16x16x32_bf16 v[56:59], v[12:15], a[16:19], v[56:59]
  v_mfma_f32_16x16x32_bf16 v[60:63], v[12:15], a[72:75], v[60:63]
  v_mfma_f32_16x16x32_bf16 v[64:67], v[12:15], a[128:131], v[64:67]
  v_mfma_f32_16x16x32_bf16 v[68:71], v[12:15], a[184:187], v[68:71]
  ds_read_b128 v[8:11], v5 offset:8192
  s_waitcnt lgkmcnt(6)
  v_mfma_f32_16x16x32_bf16 v[40:43], v[16:19], a[20:23], v[40:43]
  v_mfma_f32_16x16x32_bf16 v[44:47], v[16:19], a[76:79], v[44:47]
  v_mfma_f32_16x16x32_bf16 v[48:51], v[16:19], a[132:135], v[48:51]
  v_mfma_f32_16x16x32_bf16 v[52:55], v[16:19], a[188:191], v[52:55]
  ds_read_b128 v[12:15], v5 offset:22528
  s_waitcnt lgkmcnt(6)
  v_mfma_f32_16x16x32_bf16 v[56:59], v[20:23], a[20:23], v[56:59]
  v_mfma_f32_16x16x32_bf16 v[60:63], v[20:23], a[76:79], v[60:63]
  v_mfma_f32_16x16x32_bf16 v[64:67], v[20:23], a[132:135], v[64:67]
  v_mfma_f32_16x16x32_bf16 v[68:71], v[20:23], a[188:191], v[68:71]
  ds_read_b128 v[16:19], v5 offset:9216
  s_waitcnt lgkmcnt(6)
  v_mfma_f32_16x16x32_bf16 v[40:43], v[24:27], a[24:27], v[40:43]
  v_mfma_f32_16x16x32_bf16 v[44:47], v[24:27], a[80:83], v[44:47]
  v_mfma_f32_16x16x32_bf16 v[48:51], v[24:27], a[136:139], v[48:51]
  v_mfma_f32_16x16x32_bf16 v[52:55], v[24:27], a[192:195], v[52:55]
  ds_read_b128 v[20:23], v5 offset:23552
  s_waitcnt lgkmcnt(6)
  v_mfma_f32_16x16x32_bf16 v[56:59], v[28:31], a[24:27], v[56:59]
  v_mfma_f32_16x16x32_bf16 v[60:63], v[28:31], a[80:83], v[60:63]
  v_mfma_f32_16x16x32_bf16 v[64:67], v[28:31], a[136:139], v[64:67]
  v_mfma_f32_16x16x32_bf16 v[68:71], v[28:31], a[192:195], v[68:71]
  ds_read_b128 v[24:27], v5 offset:10240
  s_waitcnt lgkmcnt(6)
  v_mfma_f32_16x16x32_bf16 v[40:43], v[32:35], a[28:31], v[40:43]
  v_mfma_f32_16x16x32_bf16 v[44:47], v[32:35], a[84:87], v[44:47]
  v_mfma_f32_16x16x32_bf16 v[48:51], v[32:35], a[140:143], v[48:51]
  v_mfma_f32_16x16x32_bf16 v[52:55], v[32:35], a[196:199], v[52:55]
  ds_read_b128 v[28:31], v5 offset:24576
  s_waitcnt lgkmcnt(6)
  v_mfma_f32_16x16x32_bf16 v[56:59], v[36:39], a[28:31], v[56:59]
  v_mfma_f32_16x16x32_bf16 v[60:63], v[36:39], a[84:87], v[60:63]
  v_mfma_f32_16x16x32_bf16 v[64:67], v[36:39], a[140:143], v[64:67]
  v_mfma_f32_16x16x32_bf16 v[68:71], v[36:39], a[196:199], v[68:71]
  ds_read_b128 v[32:35], v5 offset:11264
  s_waitcnt lgkmcnt(6)
  v_mfma_f32_16x16x32_bf16 v[40:43], v[8:11], a[32:35], v[40:43]
  v_mfma_f32_16x16x32_bf16 v[44:47], v[8:11], a[88:91], v[44:47]
  v_mfma_f32_16x16x32_bf16 v[48:51], v[8:11], a[144:147], v[48:51]
  v_mfma_f32_16x16x32_bf16 v[52:55], v[8:11], a[200:203], v[52:55]
  ds_read_b128 v[36:39], v5 offset:25600
  s_waitcnt lgkmcnt(6)
  v_mfma_f32_16x16x32_bf16 v[56:59], v[12:15], a[32:35], v[56:59]
  v_mfma_f32_16x16x32_bf16 v[60:63], v[12:15], a[88:91], v[60:63]
  v_mfma_f32_16x16x32_bf16 v[64:67], v[12:15], a[144:147], v[64:67]
  v_mfma_f32_16x16x32_bf16 v[68:71], v[12:15], a[200:203], v[68:71]
  ds_read_b128 v[8:11], v5 offset:12288
  s_waitcnt lgkmcnt(6)
  v_mfma_f32_16x16x32_bf16 v[40:43], v[16:19], a[36:39], v[40:43]
  v_mfma_f32_16x16x32_bf16 v[44:47], v[16:19], a[92:95], v[44:47]
  v_mfma_f32_16x16x32_bf16 v[48:51], v[16:19], a[148:151], v[48:51]
  v_mfma_f32_16x16x32_bf16 v[52:55], v[16:19], a[204:207], v[52:55]
  ds_read_b128 v[12:15], v5 offset:26624
  s_waitcnt lgkmcnt(6)
  v_mfma_f32_16x16x32_bf16 v[56:59], v[20:23], a[36:39], v[56:59]
  v_mfma_f32_16x16x32_bf16 v[60:63], v[20:23], a[92:95], v[60:63]
  v_mfma_f32_16x16x32_bf16 v[64:67], v[20:23], a[148:151], v[64:67]
  v_mfma_f32_16x16x32_bf16 v[68:71], v[20:23], a[204:207], v[68:71]
  ds_read_b128 v[16:19], v5 offset:13312
  s_waitcnt lgkmcnt(6)
  v_mfma_f32_16x16x32_bf16 v[40:43], v[24:27], a[40:43], v[40:43]
  v_mfma_f32_16x16x32_bf16 v[44:47], v[24:27], a[96:99], v[44:47]
  v_mfma_f32_16x16x32_bf16 v[48:51], v[24:27], a[152:155], v[48:51]
  v_mfma_f32_16x16x32_bf16 v[52:55], v[24:27], a[208:211], v[52:55]
  ds_read_b128 v[20:23], v5 offset:27648
  s_waitcnt lgkmcnt(6)
  v_mfma_f32_16x16x32_bf16 v[56:59], v[28:31], a[40:43], v[56:59]
  v_mfma_f32_16x16x32_bf16 v[60:63], v[28:31], a[96:99], v[60:63]
  v_mfma_f32_16x16x32_bf16 v[64:67], v[28:31], a[152:155], v[64:67]
  v_mfma_f32_16x16x32_bf16 v[68:71], v[28:31], a[208:211], v[68:71]
  s_waitcnt lgkmcnt(5)
  v_mfma_f32_16x16x32_bf16 v[40:43], v[32:35], a[44:47], v[40:43]
  v_mfma_f32_16x16x32_bf16 v[44:47], v[32:35], a[100:103], v[44:47]
  v_mfma_f32_16x16x32_bf16 v[48:51], v[32:35], a[156:159], v[48:51]
  v_mfma_f32_16x16x32_bf16 v[52:55], v[32:35], a[212:215], v[52:55]
  s_waitcnt lgkmcnt(4)
  v_mfma_f32_16x16x32_bf16 v[56:59], v[36:39], a[44:47], v[56:59]
  v_mfma_f32_16x16x32_bf16 v[60:63], v[36:39], a[100:103], v[60:63]
  v_mfma_f32_16x16x32_bf16 v[64:67], v[36:39], a[156:159], v[64:67]
  v_mfma_f32_16x16x32_bf16 v[68:71], v[36:39], a[212:215], v[68:71]
  s_waitcnt lgkmcnt(3)
  v_mfma_f32_16x16x32_bf16 v[40:43], v[8:11], a[48:51], v[40:43]
  v_mfma_f32_16x16x32_bf16 v[44:47], v[8:11], a[104:107], v[44:47]
  v_mfma_f32_16x16x32_bf16 v[48:51], v[8:11], a[160:163], v[48:51]
  v_mfma_f32_16x16x32_bf16 v[52:55], v[8:11], a[216:219], v[52:55]
  s_waitcnt lgkmcnt(2)
  v_mfma_f32_16x16x32_bf16 v[56:59], v[12:15], a[48:51], v[56:59]
  v_mfma_f32_16x16x32_bf16 v[60:63], v[12:15], a[104:107], v[60:63]
  v_mfma_f32_16x16x32_bf16 v[64:67], v[12:15], a[160:163], v[64:67]
  v_mfma_f32_16x16x32_bf16 v[68:71], v[12:15], a[216:219], v[68:71]
  s_waitcnt lgkmcnt(1)
  v_mfma_f32_16x16x32_bf16 v[40:43], v[16:19], a[52:55], v[40:43]
  v_mfma_f32_16x16x32_bf16 v[44:47], v[16:19], a[108:111], v[44:47]
  v_mfma_f32_16x16x32_bf16 v[48:51], v[16:19], a[164:167], v[48:51]
  v_mfma_f32_16x16x32_bf16 v[52:55], v[16:19], a[220:223], v[52:55]
  s_waitcnt lgkmcnt(0)
  v_mfma_f32_16x16x32_bf16 v[56:59], v[20:23], a[52:55], v[56:59]
  v_mfma_f32_16x16x32_bf16 v[60:63], v[20:23], a[108:111], v[60:63]
  v_mfma_f32_16x16x32_bf16 v[64:67], v[20:23], a[164:167], v[64:67]
  v_mfma_f32_16x16x32_bf16 v[68:71], v[20:23], a[220:223], v[68:71]
  s_lshl_b32 s24, s19, 10
  s_add_u32 s24, s24, s29
  v_cvt_pk_bf16_f32 v72, v40, v41
  v_cvt_pk_bf16_f32 v73, v42, v43
  v_cvt_pk_bf16_f32 v74, v56, v57
  v_cvt_pk_bf16_f32 v75, v58, v59
  s_add_u32 s25, s24, 0
  buffer_store_dwordx4 v[72:75], v2, s[8:11], s25 offen sc1
  v_cvt_pk_bf16_f32 v76, v44, v45
  v_cvt_pk_bf16_f32 v77, v46, v47
  v_cvt_pk_bf16_f32 v78, v60, v61
  v_cvt_pk_bf16_f32 v79, v62, v63
  s_add_u32 s25, s24, 14336
  buffer_store_dwordx4 v[76:79], v2, s[8:11], s25 offen sc1
  v_cvt_pk_bf16_f32 v80, v48, v49
  v_cvt_pk_bf16_f32 v81, v50, v51
  v_cvt_pk_bf16_f32 v82, v64, v65
  v_cvt_pk_bf16_f32 v83, v66, v67
  s_add_u32 s25, s24, 458752
  buffer_store_dwordx4 v[80:83], v2, s[8:11], s25 offen sc1
  v_cvt_pk_bf16_f32 v84, v52, v53
  v_cvt_pk_bf16_f32 v85, v54, v55
  v_cvt_pk_bf16_f32 v86, v68, v69
  v_cvt_pk_bf16_f32 v87, v70, v71
  s_add_u32 s25, s24, 473088
  buffer_store_dwordx4 v[84:87], v2, s[8:11], s25 offen sc1
  s_mov_b32 s33, s32
  s_add_u32 s32, s32, 28672
  s_cmp_eq_u32 s32, 86016
  s_cselect_b32 s32, 0, s32
  s_add_u32 s19, s19, 1
  s_cmp_lt_u32 s19, s35
  s_cbranch_scc1 wg_f_loop
  s_branch wg_done
wg_vo:
  s_sub_u32 s29, s17, 16
  s_lshl_b32 s29, s29, 6
  s_add_u32 s29, s29, s28
  s_mul_i32 s29, s29, 28672
  s_add_u32 s29, s29, 42205184
  v_lshlrev_b32 v6, 4, v3
  v_mad_u32_u24 v7, v3, 12, 64
  s_mov_b32 s31, 0
  s_lshl_b32 s24, s34, 1
  s_mul_i32 s24, s24, 14336
  s_add_u32 s24, s24, s23
  s_cmp_lt_u32 s34, s35
  s_cselect_b32 s24, s24, 0x10000000
  s_add_u32 m0, s31, s27
  s_nop 0
  buffer_load_dwordx4 v2, s[8:11], s24 offen offset:0 sc1 lds
  buffer_load_dwordx4 v2, s[8:11], s24 offen offset:1024 sc1 lds
  buffer_load_dwordx4 v2, s[8:11], s24 offen offset:2048 sc1 lds
  buffer_load_dwordx4 v2, s[8:11], s24 offen offset:3072 sc1 lds
  s_add_u32 m0, m0, 4096
  s_add_u32 s24, s24, 4096
  buffer_load_dwordx4 v2, s[8:11], s24 offen offset:0 sc1 lds
  buffer_load_dwordx4 v2, s[8:11], s24 offen offset:1024 sc1 lds
  buffer_load_dwordx4 v2, s[8:11], s24 offen offset:2048 sc1 lds
  s_add_u32 s30, s34, 1
  s_mov_b32 s31, 28672
  s_lshl_b32 s24, s30, 1
  s_mul_i32 s24, s24, 14336
  s_add_u32 s24, s24, s23
  s_cmp_lt_u32 s30, s35
  s_cselect_b32 s24, s24, 0x10000000
  s_add_u32 m0, s31, s27
  s_nop 0
  buffer_load_dwordx4 v2, s[8:11], s24 offen offset:0 sc1 lds
  buffer_load_dwordx4 v2, s[8:11], s24 offen offset:1024 sc1 lds
  buffer_load_dwordx4 v2, s[8:11], s24 offen offset:2048 sc1 lds
  buffer_load_dwordx4 v2, s[8:11], s24 offen offset:3072 sc1 lds
  s_add_u32 m0, m0, 4096
  s_add_u32 s24, s24, 4096
  buffer_load_dwordx4 v2, s[8:11], s24 offen offset:0 sc1 lds
  buffer_load_dwordx4 v2, s[8:11], s24 offen offset:1024 sc1 lds
  buffer_load_dwordx4 v2, s[8:11], s24 offen offset:2048 sc1 lds
  s_mov_b32 s19, s34
  s_mov_b32 s32, 0
  s_mov_b32 s33, 57344
  s_waitcnt vmcnt(7)
  s_branch wg_vo_in
wg_vo_loop:
  s_waitcnt vmcnt(11)
wg_vo_in:
  s_barrier
  s_add_u32 s30, s19, 2
  s_lshl_b32 s24, s30, 1
  s_mul_i32 s24, s24, 14336
  s_add_u32 s24, s24, s23
  s_cmp_lt_u32 s30, s35
  s_cselect_b32 s24, s24, 0x10000000
  s_add_u32 m0, s33, s27
  s_nop 0
  buffer_load_dwordx4 v2, s[8:11], s24 offen offset:0 sc1 lds
  buffer_load_dwordx4 v2, s[8:11], s24 offen offset:1024 sc1 lds
  buffer_load_dwordx4 v2, s[8:11], s24 offen offset:2048 sc1 lds
  buffer_load_dwordx4 v2, s[8:11], s24 offen offset:3072 sc1 lds
  s_add_u32 m0, m0, 4096
  s_add_u32 s24, s24, 4096
  buffer_load_dwordx4 v2, s[8:11], s24 offen offset:0 sc1 lds
  buffer_load_dwordx4 v2, s[8:11], s24 offen offset:1024 sc1 lds
  buffer_load_dwordx4 v2, s[8:11], s24 offen offset:2048 sc1 lds
  v_add_u32 v5, s32, v2
  ds_read_b128 v[8:11], v5 offset:0
  ds_read_b128 v[12:15], v5 offset:14336
  ds_read_b128 v[16:19], v5 offset:1024
  ds_read_b128 v[20:23], v5 offset:15360
  ds_read_b128 v[24:27], v5 offset:2048
  ds_read_b128 v[28:31], v5 offset:16384
  ds_read_b128 v[32:35], v5 offset:3072
  s_waitcnt lgkmcnt(6)
  v_mfma_f32_16x16x32_bf16 v[40:43], a[0:3], v[8:11], 0
  v_mfma_f32_16x16x32_bf16 v[44:47], a[56:59], v[8:11], 0
  v_mfma_f32_16x16x32_bf16 v[48:51], a[112:115], v[8:11], 0
  v_mfma_f32_16x16x32_bf16 v[52:55], a[168:171], v[8:11], 0
  ds_read_b128 v[36:39], v5 offset:17408
  s_waitcnt lgkmcnt(6)
  v_mfma_f32_16x16x32_bf16 v[56:59], a[0:3], v[12:15], 0
  v_mfma_f32_16x16x32_bf16 v[60:63], a[56:59], v[12:15], 0
  v_mfma_f32_16x16x32_bf16 v[64:67], a[112:115], v[12:15], 0
  v_mfma_f32_16x16x32_bf16 v[68:71], a[168:171], v[12:15], 0
  ds_read_b128 v[8:11], v5 offset:4096
  s_waitcnt lgkmcnt(6)
  v_mfma_f32_16x16x32_bf16 v[40:43], a[4:7], v[16:19], v[40:43]
  v_mfma_f32_16x16x32_bf16 v[44:47], a[60:63], v[16:19], v[44:47]
  v_mfma_f32_16x16x32_bf16 v[48:51], a[116:119], v[16:19], v[48:51]
  v_mfma_f32_16x16x32_bf16 v[52:55], a[172:175], v[16:19], v[52:55]
  ds_read_b128 v[12:15], v5 offset:18432
  s_waitcnt lgkmcnt(6)
  v_mfma_f32_16x16x32_bf16 v[56:59], a[4:7], v[20:23], v[56:59]
  v_mfma_f32_16x16x32_bf16 v[60:63], a[60:63], v[20:23], v[60:63]
  v_mfma_f32_16x16x32_bf16 v[64:67], a[116:119], v[20:23], v[64:67]
  v_mfma_f32_16x16x32_bf16 v[68:71], a[172:175], v[20:23], v[68:71]
  ds_read_b128 v[16:19], v5 offset:5120
  s_waitcnt lgkmcnt(6)
  v_mfma_f32_16x16x32_bf16 v[40:43], a[8:11], v[24:27], v[40:43]
  v_mfma_f32_16x16x32_bf16 v[44:47], a[64:67], v[24:27], v[44:47]
  v_mfma_f32_16x16x32_bf16 v[48:51], a[120:123], v[24:27], v[48:51]
  v_mfma_f32_16x16x32_bf16 v[52:55], a[176:179], v[24:27], v[52:55]
  ds_read_b128 v[20:23], v5 offset:19456
  s_waitcnt lgkmcnt(6)
  v_mfma_f32_16x16x32_bf16 v[56:59], a[8:11], v[28:31], v[56:59]
  v_mfma_f32_16x16x32_bf16 v[60:63], a[64:67], v[28:31], v[60:63]
  v_mfma_f32_16x16x32_bf16 v[64:67], a[120:123], v[28:31], v[64:67]
  v_mfma_f32_16x16x32_bf16 v[68:71], a[176:179], v[28:31], v[68:71]
  ds_read_b128 v[24:27], v5 offset:6144
  s_waitcnt lgkmcnt(6)
  v_mfma_f32_16x16x32_bf16 v[40:43], a[12:15], v[32:35], v[40:43]
  v_mfma_f32_16x16x32_bf16 v[44:47], a[68:71], v[32:35], v[44:47]
  v_mfma_f32_16x16x32_bf16 v[48:51], a[124:127], v[32:35], v[48:51]
  v_mfma_f32_16x16x32_bf16 v[52:55], a[180:183], v[32:35], v[52:55]
  ds_read_b128 v[28:31], v5 offset:20480
  s_waitcnt lgkmcnt(6)
  v_mfma_f32_16x16x32_bf16 v[56:59], a[12:15], v[36:39], v[56:59]
  v_mfma_f32_16x16x32_bf16 v[60:63], a[68:71], v[36:39], v[60:63]
  v_mfma_f32_16x16x32_bf16 v[64:67], a[124:127], v[36:39], v[64:67]
  v_mfma_f32_16x16x32_bf16 v[68:71], a[180:183], v[36:39], v[68:71]
  ds_read_b128 v[32:35], v5 offset:7168
  s_waitcnt lgkmcnt(6)
  v_mfma_f32_16x16x32_bf16 v[40:43], a[16:19], v[8:11], v[40:43]
  v_mfma_f32_16x16x32_bf16 v[44:47], a[72:75], v[8:11], v[44:47]
  v_mfma_f32_16x16x32_bf16 v[48:51], a[128:131], v[8:11], v[48:51]
  v_mfma_f32_16x16x32_bf16 v[52:55], a[184:187], v[8:11], v[52:55]
  ds_read_b128 v[36:39], v5 offset:21504
  s_waitcnt lgkmcnt(6)
  v_mfma_f32_16x16x32_bf16 v[56:59], a[16:19], v[12:15], v[56:59]
  v_mfma_f32_16x16x32_bf16 v[60:63], a[72:75], v[12:15], v[60:63]
  v_mfma_f32_16x16x32_bf16 v[64:67], a[128:131], v[12:15], v[64:67]
  v_mfma_f32_16x16x32_bf16 v[68:71], a[184:187], v[12:15], v[68:71]
  ds_read_b128 v[8:11], v5 offset:8192
  s_waitcnt lgkmcnt(6)
  v_mfma_f32_16x16x32_bf16 v[40:43], a[20:23], v[16:19], v[40:43]
  v_mfma_f32_16x16x32_bf16 v[44:47], a[76:79], v[16:19], v[44:47]
  v_mfma_f32_16x16x32_bf16 v[48:51], a[132:135], v[16:19], v[48:51]
  v_mfma_f32_16x16x32_bf16 v[52:55], a[188:191], v[16:19], v[52:55]
  ds_read_b128 v[12:15], v5 offset:22528
  s_waitcnt lgkmcnt(6)
  v_mfma_f32_16x16x32_bf16 v[56:59], a[20:23], v[20:23], v[56:59]
  v_mfma_f32_16x16x32_bf16 v[60:63], a[76:79], v[20:23], v[60:63]
  v_mfma_f32_16x16x32_bf16 v[64:67], a[132:135], v[20:23], v[64:67]
  v_mfma_f32_16x16x32_bf16 v[68:71], a[188:191], v[20:23], v[68:71]
  ds_read_b128 v[16:19], v5 offset:9216
  s_waitcnt lgkmcnt(6)
  v_mfma_f32_16x16x32_bf16 v[40:43], a[24:27], v[24:27], v[40:43]
  v_mfma_f32_16x16x32_bf16 v[44:47], a[80:83], v[24:27], v[44:47]
  v_mfma_f32_16x16x32_bf16 v[48:51], a[136:139], v[24:27], v[48:51]
  v_mfma_f32_16x16x32_bf16 v[52:55], a[192:195], v[24:27], v[52:55]
  ds_read_b128 v[20:23], v5 offset:23552
  s_waitcnt lgkmcnt(6)
  v_mfma_f32_16x16x32_bf16 v[56:59], a[24:27], v[28:31], v[56:59]
  v_mfma_f32_16x16x32_bf16 v[60:63], a[80:83], v[28:31], v[60:63]
  v_mfma_f32_16x16x32_bf16 v[64:67], a[136:139], v[28:31], v[64:67]
  v_mfma_f32_16x16x32_bf16 v[68:71], a[192:195], v[28:31], v[68:71]
  ds_read_b128 v[24:27], v5 offset:10240
  s_waitcnt lgkmcnt(6)
  v_mfma_f32_16x16x32_bf16 v[40:43], a[28:31], v[32:35], v[40:43]
  v_mfma_f32_16x16x32_bf16 v[44:47], a[84:87], v[32:35], v[44:47]
  v_mfma_f32_16x16x32_bf16 v[48:51], a[140:143], v[32:35], v[48:51]
  v_mfma_f32_16x16x32_bf16 v[52:55], a[196:199], v[32:35], v[52:55]
  ds_read_b128 v[28:31], v5 offset:24576
  s_waitcnt lgkmcnt(6)
  v_mfma_f32_16x16x32_bf16 v[56:59], a[28:31], v[36:39], v[56:59]
  v_mfma_f32_16x16x32_bf16 v[60:63], a[84:87], v[36:39], v[60:63]
  v_mfma_f32_16x16x32_bf16 v[64:67], a[140:143], v[36:39], v[64:67]
  v_mfma_f32_16x16x32_bf16 v[68:71], a[196:199], v[36:39], v[68:71]
  ds_read_b128 v[32:35], v5 offset:11264
  s_waitcnt lgkmcnt(6)
  v_mfma_f32_16x16x32_bf16 v[40:43], a[32:35], v[8:11], v[40:43]
  v_mfma_f32_16x16x32_bf16 v[44:47], a[88:91], v[8:11], v[44:47]
  v_mfma_f32_16x16x32_bf16 v[48:51], a[144:147], v[8:11], v[48:51]
  v_mfma_f32_16x16x32_bf16 v[52:55], a[200:203], v[8:11], v[52:55]
  ds_read_b128 v[36:39], v5 offset:25600
  s_waitcnt lgkmcnt(6)
  v_mfma_f32_16x16x32_bf16 v[56:59], a[32:35], v[12:15], v[56:59]
  v_mfma_f32_16x16x32_bf16 v[60:63], a[88:91], v[12:15], v[60:63]
  v_mfma_f32_16x16x32_bf16 v[64:67], a[144:147], v[12:15], v[64:67]
  v_mfma_f32_16x16x32_bf16 v[68:71], a[200:203], v[12:15], v[68:71]
  ds_read_b128 v[8:11], v5 offset:12288
  s_waitcnt lgkmcnt(6)
  v_mfma_f32_16x16x32_bf16 v[40:43], a[36:39], v[16:19], v[40:43]
  v_mfma_f32_16x16x32_bf16 v[44:47], a[92:95], v[16:19], v[44:47]
  v_mfma_f32_16x16x32_bf16 v[48:51], a[148:151], v[16:19], v[48:51]
  v_mfma_f32_16x16x32_bf16 v[52:55], a[204:207], v[16:19], v[52:55]
  ds_read_b128 v[12:15], v5 offset:26624
  s_waitcnt lgkmcnt(6)
  v_mfma_f32_16x16x32_bf16 v[56:59], a[36:39], v[20:23], v[56:59]
  v_mfma_f32_16x16x32_bf16 v[60:63], a[92:95], v[20:23], v[60:63]
  v_mfma_f32_16x16x32_bf16 v[64:67], a[148:151], v[20:23], v[64:67]
  v_mfma_f32_16x16x32_bf16 v[68:71], a[204:207], v[20:23], v[68:71]
  ds_read_b128 v[16:19], v5 offset:13312
  s_waitcnt lgkmcnt(6)
  v_mfma_f32_16x16x32_bf16 v[40:43], a[40:43], v[24:27], v[40:43]
  v_mfma_f32_16x16x32_bf16 v[44:47], a[96:99], v[24:27], v[44:47]
  v_mfma_f32_16x16x32_bf16 v[48:51], a[152:155], v[24:27], v[48:51]
  v_mfma_f32_16x16x32_bf16 v[52:55], a[208:211], v[24:27], v[52:55]
  ds_read_b128 v[20:23], v5 offset:27648
  s_waitcnt lgkmcnt(6)
  v_mfma_f32_16x16x32_bf16 v[56:59], a[40:43], v[28:31], v[56:59]
  v_mfma_f32_16x16x32_bf16 v[60:63], a[96:99], v[28:31], v[60:63]
  v_mfma_f32_16x16x32_bf16 v[64:67], a[152:155], v[28:31], v[64:67]
  v_mfma_f32_16x16x32_bf16 v[68:71], a[208:211], v[28:31], v[68:71]
  s_waitcnt lgkmcnt(5)
  v_mfma_f32_16x16x32_bf16 v[40:43], a[44:47], v[32:35], v[40:43]
  v_mfma_f32_16x16x32_bf16 v[44:47], a[100:103], v[32:35], v[44:47]
  v_mfma_f32_16x16x32_bf16 v[48:51], a[156:159], v[32:35], v[48:51]
  v_mfma_f32_16x16x32_bf16 v[52:55], a[212:215], v[32:35], v[52:55]
  s_waitcnt lgkmcnt(4)
  v_mfma_f32_16x16x32_bf16 v[56:59], a[44:47], v[36:39], v[56:59]
  v_mfma_f32_16x16x32_bf16 v[60:63], a[100:103], v[36:39], v[60:63]
  v_mfma_f32_16x16x32_bf16 v[64:67], a[156:159], v[36:39], v[64:67]
  v_mfma_f32_16x16x32_bf16 v[68:71], a[212:215], v[36:39], v[68:71]
  s_waitcnt lgkmcnt(3)
  v_mfma_f32_16x16x32_bf16 v[40:43], a[48:51], v[8:11], v[40:43]
  v_mfma_f32_16x16x32_bf16 v[44:47], a[104:107], v[8:11], v[44:47]
  v_mfma_f32_16x16x32_bf16 v[48:51], a[160:163], v[8:11], v[48:51]
  v_mfma_f32_16x16x32_bf16 v[52:55], a[216:219], v[8:11], v[52:55]
  s_waitcnt lgkmcnt(2)
  v_mfma_f32_16x16x32_bf16 v[56:59], a[48:51], v[12:15], v[56:59]
  v_mfma_f32_16x16x32_bf16 v[60:63], a[104:107], v[12:15], v[60:63]
  v_mfma_f32_16x16x32_bf16 v[64:67], a[160:163], v[12:15], v[64:67]
  v_mfma_f32_16x16x32_bf16 v[68:71], a[216:219], v[12:15], v[68:71]
  s_waitcnt lgkmcnt(1)
  v_mfma_f32_16x16x32_bf16 v[40:43], a[52:55], v[16:19], v[40:43]
  v_mfma_f32_16x16x32_bf16 v[44:47], a[108:111], v[16:19], v[44:47]
  v_mfma_f32_16x16x32_bf16 v[48:51], a[164:167], v[16:19], v[48:51]
  v_mfma_f32_16x16x32_bf16 v[52:55], a[220:223], v[16:19], v[52:55]
  s_waitcnt lgkmcnt(0)
  v_mfma_f32_16x16x32_bf16 v[56:59], a[52:55], v[20:23], v[56:59]
  v_mfma_f32_16x16x32_bf16 v[60:63], a[108:111], v[20:23], v[60:63]
  v_mfma_f32_16x16x32_bf16 v[64:67], a[164:167], v[20:23], v[64:67]
  v_mfma_f32_16x16x32_bf16 v[68:71], a[220:223], v[20:23], v[68:71]
  s_add_u32 s25, s29, 28672
  s_lshl_b32 s24, s19, 5
  s_add_u32 s24, s24, 0
  v_add_u32 v88, s24, v4
  s_cmp_lt_u32 s19, 8
  s_cselect_b64 vcc, -1, 0
  s_cselect_b32 s24, 0, 256
  v_subrev_u32 v88, s24, v88
  s_movk_i32 s24, 5462
  s_cselect_b32 s24, 4096, s24
  v_mul_u32_u24 v89, s24, v88
  v_lshrrev_b32 v89, 16, v89
  s_movk_i32 s24, 100
  s_cselect_b32 s24, 96, s24
  v_mul_u32_u24 v89, s24, v89
  v_cndmask_b32 v92, v7, v6, vcc
  v_add3_u32 v88, v88, v89, v92
  v_lshlrev_b32 v90, 4, v88
  v_cvt_pk_bf16_f32 v72, v40, v41
  v_cvt_pk_bf16_f32 v73, v42, v43
  v_cvt_pk_bf16_f32 v74, v44, v45
  v_cvt_pk_bf16_f32 v75, v46, v47
  buffer_store_dwordx4 v[72:75], v90, s[8:11], s29 offen sc1
  v_cvt_pk_bf16_f32 v76, v48, v49
  v_cvt_pk_bf16_f32 v77, v50, v51
  v_cvt_pk_bf16_f32 v78, v52, v53
  v_cvt_pk_bf16_f32 v79, v54, v55
  buffer_store_dwordx4 v[76:79], v90, s[8:11], s25 offen sc1
  s_lshl_b32 s24, s19, 5
  s_add_u32 s24, s24, 16
  v_add_u32 v88, s24, v4
  s_cmp_lt_u32 s19, 8
  s_cselect_b64 vcc, -1, 0
  s_cselect_b32 s24, 0, 256
  v_subrev_u32 v88, s24, v88
  s_movk_i32 s24, 5462
  s_cselect_b32 s24, 4096, s24
  v_mul_u32_u24 v89, s24, v88
  v_lshrrev_b32 v89, 16, v89
  s_movk_i32 s24, 100
  s_cselect_b32 s24, 96, s24
  v_mul_u32_u24 v89, s24, v89
  v_cndmask_b32 v92, v7, v6, vcc
  v_add3_u32 v88, v88, v89, v92
  v_lshlrev_b32 v91, 4, v88
  v_cvt_pk_bf16_f32 v80, v56, v57
  v_cvt_pk_bf16_f32 v81, v58, v59
  v_cvt_pk_bf16_f32 v82, v60, v61
  v_cvt_pk_bf16_f32 v83, v62, v63
  buffer_store_dwordx4 v[80:83], v91, s[8:11], s29 offen sc1
  v_cvt_pk_bf16_f32 v84, v64, v65
  v_cvt_pk_bf16_f32 v85, v66, v67
  v_cvt_pk_bf16_f32 v86, v68, v69
  v_cvt_pk_bf16_f32 v87, v70, v71
  buffer_store_dwordx4 v[84:87], v91, s[8:11], s25 offen sc1
  s_mov_b32 s33, s32
  s_add_u32 s32, s32, 28672
  s_cmp_eq_u32 s32, 86016
  s_cselect_b32 s32, 0, s32
  s_add_u32 s19, s19, 1
  s_cmp_lt_u32 s19, s35
  s_cbranch_scc1 wg_vo_loop
  s_branch wg_done
wg_done:
  s_lshl_b32 s20, s18, 4
  s_and_b32 s21, s17, 15
  s_add_u32 s20, s20, s21
  s_lshl_b32 s20, s20, 7
  s_cmp_lt_u32 s17, 16
  s_cselect_b32 s21, 16384, 0
  s_add_u32 s20, s20, s21
  s_add_u32 s20, s20, 88541184
  s_sub_u32 s21, s35, s34
  v_mov_b32 v5, s21
  v_mov_b32 v6, 0
  s_waitcnt vmcnt(0)
  s_mov_b64 exec, 1
  buffer_atomic_add v5, v6, s[8:11], s20 offen
  s_mov_b64 exec, -1
  s_branch wk_loop
wk_a:
  s_load_dwordx8 s[36:43], s[0:1], 56
  s_load_dwordx4 s[44:47], s[0:1], 88
  s_sub_u32 s3, s3, 432
  s_and_b32 s17, s3, 15
  s_lshr_b32 s19, s3, 5
  s_bitcmp1_b32 s3, 4
  s_cselect_b32 s31, 7, 0
  s_waitcnt lgkmcnt(0)
  s_mov_b32 s60, s40
  s_and_b32 s61, s41, 0xffff
  s_mov_b32 s62, 3670016
  s_mov_b32 s63, 0x20000
  s_mov_b32 s56, s42
  s_and_b32 s57, s43, 0xffff
  s_mov_b32 s58, 3670016
  s_mov_b32 s59, 0x20000
  s_lshl_b32 s30, s16, 13
  s_lshl_b32 s27, s19, 19
  s_lshl_b32 s29, s16, 17
  s_add_u32 s27, s27, s29
  s_lshl_b32 s29, s17, 9
  s_add_u32 s27, s27, s29
  v_lshrrev_b32 v5, 5, v1
  v_and_b32 v6, 31, v1
  v_xor_b32 v6, v6, v5
  v_lshlrev_b32 v6, 4, v6
  v_lshl_add_u32 v6, v5, 13, v6
  s_add_u32 m0, s30, 0
  s_add_u32 s22, s27, 0
  v_xor_b32 v7, 0, v6
  buffer_load_dwordx4 v7, s[56:59], s22 offen offset:0 lds
  s_add_u32 s22, s27, 15360
  v_xor_b32 v7, 32, v6
  buffer_load_dwordx4 v7, s[56:59], s22 offen offset:1024 lds
  s_add_u32 s22, s27, 30720
  v_xor_b32 v7, 64, v6
  buffer_load_dwordx4 v7, s[56:59], s22 offen offset:2048 lds
  s_add_u32 s22, s27, 46080
  v_xor_b32 v7, 96, v6
  buffer_load_dwordx4 v7, s[56:59], s22 offen offset:3072 lds
  s_add_u32 m0, s30, 4096
  s_add_u32 s22, s27, 65536
  v_xor_b32 v7, 128, v6
  buffer_load_dwordx4 v7, s[56:59], s22 offen offset:0 lds
  s_add_u32 s22, s27, 80896
  v_xor_b32 v7, 160, v6
  buffer_load_dwordx4 v7, s[56:59], s22 offen offset:1024 lds
  s_add_u32 s22, s27, 96256
  v_xor_b32 v7, 192, v6
  buffer_load_dwordx4 v7, s[56:59], s22 offen offset:2048 lds
  s_add_u32 s22, s27, 111616
  v_xor_b32 v7, 224, v6
  buffer_load_dwordx4 v7, s[56:59], s22 offen offset:3072 lds
  v_lshrrev_b32 v5, 5, v1
  v_and_b32 v6, 31, v1
  s_lshl_b32 s25, s16, 15
  s_add_u32 s25, s25, 32768
  s_lshl_b32 s26, s17, 9
  s_add_u32 s28, s19, s16
  s_cmp_ge_u32 s28, 7
  s_cselect_b32 s20, 7, 0
  s_sub_u32 s28, s28, s20
  s_add_u32 s28, s28, s31
  s_add_u32 s29, s19, s16
  s_add_u32 s29, s29, 4
  s_cmp_ge_u32 s29, 7
  s_cselect_b32 s20, 7, 0
  s_sub_u32 s29, s29, s20
  s_add_u32 s29, s29, s31
  s_lshl_b32 s32, s28, 18
  s_add_u32 s32, s32, s26
  s_lshl_b32 s33, s29, 18
  s_add_u32 s33, s33, s26
  v_xor_b32 v8, v6, v5
  v_lshlrev_b32 v8, 4, v8
  v_lshl_add_u32 v8, v5, 13, v8
  v_xor_b32 v12, 0, v8
  v_xor_b32 v13, 32, v8
  v_add_u32 v13, 15360, v13
  v_xor_b32 v14, 0, v8
  v_add_u32 v14, 30720, v14
  v_xor_b32 v15, 32, v8
  v_add_u32 v15, 46080, v15
  s_add_u32 s20, s16, 0
  s_and_b32 s20, s20, 3
  s_mul_i32 s21, s20, 65600
  s_lshl_b32 s20, s20, 12
  s_add_u32 s48, s20, s25
  s_mov_b32 m0, s48
  v_xor_b32 v16, s21, v12
  buffer_load_dwordx4 v16, s[60:63], s32 offen offset:0 lds
  v_xor_b32 v17, s21, v13
  buffer_load_dwordx4 v17, s[60:63], s32 offen offset:1024 lds
  v_xor_b32 v18, s21, v14
  buffer_load_dwordx4 v18, s[60:63], s32 offen offset:2048 lds
  v_xor_b32 v19, s21, v15
  buffer_load_dwordx4 v19, s[60:63], s32 offen offset:3072 lds
  s_add_u32 s20, s16, 1
  s_and_b32 s20, s20, 3
  s_mul_i32 s21, s20, 65600
  s_lshl_b32 s20, s20, 12
  s_add_u32 s49, s20, s25
  s_mov_b32 m0, s49
  v_xor_b32 v20, s21, v12
  buffer_load_dwordx4 v20, s[60:63], s32 offen offset:0 lds
  v_xor_b32 v21, s21, v13
  buffer_load_dwordx4 v21, s[60:63], s32 offen offset:1024 lds
  v_xor_b32 v22, s21, v14
  buffer_load_dwordx4 v22, s[60:63], s32 offen offset:2048 lds
  v_xor_b32 v23, s21, v15
  buffer_load_dwordx4 v23, s[60:63], s32 offen offset:3072 lds
  s_add_u32 s20, s16, 2
  s_and_b32 s20, s20, 3
  s_mul_i32 s21, s20, 65600
  s_lshl_b32 s20, s20, 12
  s_add_u32 s50, s20, s25
  s_mov_b32 m0, s50
  v_xor_b32 v24, s21, v12
  buffer_load_dwordx4 v24, s[60:63], s32 offen offset:0 lds
  v_xor_b32 v25, s21, v13
  buffer_load_dwordx4 v25, s[60:63], s32 offen offset:1024 lds
  v_xor_b32 v26, s21, v14
  buffer_load_dwordx4 v26, s[60:63], s32 offen offset:2048 lds
  v_xor_b32 v27, s21, v15
  buffer_load_dwordx4 v27, s[60:63], s32 offen offset:3072 lds
  s_add_u32 s20, s16, 3
  s_and_b32 s20, s20, 3
  s_mul_i32 s21, s20, 65600
  s_lshl_b32 s20, s20, 12
  s_add_u32 s51, s20, s25
  s_mov_b32 m0, s51
  v_xor_b32 v28, s21, v12
  buffer_load_dwordx4 v28, s[60:63], s32 offen offset:0 lds
  v_xor_b32 v29, s21, v13
  buffer_load_dwordx4 v29, s[60:63], s32 offen offset:1024 lds
  v_xor_b32 v30, s21, v14
  buffer_load_dwordx4 v30, s[60:63], s32 offen offset:2048 lds
  v_xor_b32 v31, s21, v15
  buffer_load_dwordx4 v31, s[60:63], s32 offen offset:3072 lds
  s_mul_i32 s30, s17, 401408
  s_mul_i32 s20, s19, 57344
  s_add_u32 s30, s30, s20
  v_add_u32 v12, s30, v2
  v_add_u32 v13, 14336, v12
  v_add_u32 v14, 28672, v12
  v_add_u32 v15, 43008, v12
  v_lshrrev_b32 v7, 2, v4
  v_lshlrev_b32 v7, 3, v7
  v_and_b32 v8, 3, v4
  v_add_u32 v7, v7, v8
  v_xor_b32 v10, v3, v4
  v_lshlrev_b32 v10, 4, v10
  v_lshl_add_u32 v10, v7, 9, v10
  v_add_u32 v10, s25, v10
  v_xor_b32 v32, 0, v10
  v_xor_b32 v33, 64, v10
  v_xor_b32 v34, 128, v10
  v_xor_b32 v35, 192, v10
  v_and_b32 v8, 2, v4
  v_lshlrev_b32 v8, 1, v8
  v_and_b32 v9, 1, v4
  v_add_u32 v8, v8, v9
  v_lshrrev_b32 v7, 2, v4
  v_lshl_add_u32 v7, v7, 4, v8
  v_xor_b32 v8, v8, v3
  v_lshlrev_b32 v8, 4, v8
  v_lshl_add_u32 v7, v7, 9, v8
  s_mov_b32 s24, 1035512379
  s_waitcnt vmcnt(16)
  s_barrier
  s_cmp_eq_u32 s16, 3
  s_cbranch_scc1 aj_np0
  s_add_u32 m0, s48, 16384
  s_nop 0
  buffer_load_dwordx4 v16, s[60:63], s33 offen offset:0 lds
  buffer_load_dwordx4 v17, s[60:63], s33 offen offset:1024 lds
  buffer_load_dwordx4 v18, s[60:63], s33 offen offset:2048 lds
  buffer_load_dwordx4 v19, s[60:63], s33 offen offset:3072 lds
aj_np0:
  v_xor_b32 v8, 0, v7
  ds_read_b128 v[128:131], v8 offset:0
  v_xor_b32 v9, 64, v7
  ds_read_b128 v[132:135], v9 offset:0
  v_xor_b32 v10, 128, v7
  ds_read_b128 v[136:139], v10 offset:0
  v_xor_b32 v11, 192, v7
  ds_read_b128 v[140:143], v11 offset:0
  ds_read_b128 v[144:147], v8 offset:256
  ds_read_b128 v[148:151], v9 offset:256
  ds_read_b128 v[152:155], v10 offset:256
  ds_read_b128 v[156:159], v11 offset:256
  s_waitcnt lgkmcnt(4)
  s_cmp_eq_u32 s16, 3
  s_cbranch_scc1 aj_np1
  s_add_u32 m0, s49, 16384
  s_nop 0
  buffer_load_dwordx4 v20, s[60:63], s33 offen offset:0 lds
  buffer_load_dwordx4 v21, s[60:63], s33 offen offset:1024 lds
  buffer_load_dwordx4 v22, s[60:63], s33 offen offset:2048 lds
  buffer_load_dwordx4 v23, s[60:63], s33 offen offset:3072 lds
aj_np1:
  v_xor_b32 v8, 32, v7
  ds_read_b128 v[160:163], v8 offset:1024
  v_xor_b32 v9, 96, v7
  ds_read_b128 v[164:167], v9 offset:1024
  v_xor_b32 v10, 160, v7
  ds_read_b128 v[168:171], v10 offset:1024
  v_xor_b32 v11, 224, v7
  ds_read_b128 v[172:175], v11 offset:1024
  ds_read_b128 v[176:179], v8 offset:1280
  ds_read_b128 v[180:183], v9 offset:1280
  ds_read_b128 v[184:187], v10 offset:1280
  ds_read_b128 v[188:191], v11 offset:1280
  s_waitcnt lgkmcnt(4)
  s_cmp_eq_u32 s16, 3
  s_cbranch_scc1 aj_np2
  s_add_u32 m0, s50, 16384
  s_nop 0
  buffer_load_dwordx4 v24, s[60:63], s33 offen offset:0 lds
  buffer_load_dwordx4 v25, s[60:63], s33 offen offset:1024 lds
  buffer_load_dwordx4 v26, s[60:63], s33 offen offset:2048 lds
  buffer_load_dwordx4 v27, s[60:63], s33 offen offset:3072 lds
aj_np2:
  v_xor_b32 v8, 128, v7
  ds_read_b128 v[192:195], v8 offset:4096
  v_xor_b32 v9, 192, v7
  ds_read_b128 v[196:199], v9 offset:4096
  v_xor_b32 v10, 0, v7
  ds_read_b128 v[200:203], v10 offset:4096
  v_xor_b32 v11, 64, v7
  ds_read_b128 v[204:207], v11 offset:4096
  ds_read_b128 v[208:211], v8 offset:4352
  ds_read_b128 v[212:215], v9 offset:4352
  ds_read_b128 v[216:219], v10 offset:4352
  ds_read_b128 v[220:223], v11 offset:4352
  s_waitcnt lgkmcnt(4)
  s_cmp_eq_u32 s16, 3
  s_cbranch_scc1 aj_np3
  s_add_u32 m0, s51, 16384
  s_nop 0
  buffer_load_dwordx4 v28, s[60:63], s33 offen offset:0 lds
  buffer_load_dwordx4 v29, s[60:63], s33 offen offset:1024 lds
  buffer_load_dwordx4 v30, s[60:63], s33 offen offset:2048 lds
  buffer_load_dwordx4 v31, s[60:63], s33 offen offset:3072 lds
aj_np3:
  v_xor_b32 v8, 160, v7
  ds_read_b128 v[224:227], v8 offset:5120
  v_xor_b32 v9, 224, v7
  ds_read_b128 v[228:231], v9 offset:5120
  v_xor_b32 v10, 32, v7
  ds_read_b128 v[232:235], v10 offset:5120
  v_xor_b32 v11, 96, v7
  ds_read_b128 v[236:239], v11 offset:5120
  ds_read_b128 v[240:243], v8 offset:5376
  ds_read_b128 v[244:247], v9 offset:5376
  ds_read_b128 v[248:251], v10 offset:5376
  ds_read_b128 v[252:255], v11 offset:5376
  s_waitcnt lgkmcnt(4)
  s_waitcnt vmcnt(16) lgkmcnt(0)
  s_cmp_lg_u32 s16, 3
  s_cbranch_scc1 w3_47
  s_waitcnt vmcnt(0)
w3_47:
  ds_read_b128 v[52:55], v32 offset:0
  ds_read_b128 v[56:59], v33 offset:0
  ds_read_b128 v[60:63], v34 offset:0
  ds_read_b128 v[64:67], v35 offset:0
  s_waitcnt lgkmcnt(3)
  v_mfma_f32_16x16x32_bf16 v[96:99], v[52:55], v[128:131], 0
  v_mfma_f32_16x16x32_bf16 v[100:103], v[52:55], v[160:163], 0
  v_mfma_f32_16x16x32_bf16 v[104:107], v[52:55], v[192:195], 0
  v_mfma_f32_16x16x32_bf16 v[108:111], v[52:55], v[224:227], 0
  ds_read_b128 v[52:55], v32 offset:256
  s_waitcnt lgkmcnt(3)
  v_mfma_f32_16x16x32_bf16 v[96:99], v[56:59], v[132:135], v[96:99]
  v_mfma_f32_16x16x32_bf16 v[100:103], v[56:59], v[164:167], v[100:103]
  v_mfma_f32_16x16x32_bf16 v[104:107], v[56:59], v[196:199], v[104:107]
  v_mfma_f32_16x16x32_bf16 v[108:111], v[56:59], v[228:231], v[108:111]
  ds_read_b128 v[56:59], v33 offset:256
  s_waitcnt lgkmcnt(3)
  v_mfma_f32_16x16x32_bf16 v[96:99], v[60:63], v[136:139], v[96:99]
  v_mfma_f32_16x16x32_bf16 v[100:103], v[60:63], v[168:171], v[100:103]
  v_mfma_f32_16x16x32_bf16 v[104:107], v[60:63], v[200:203], v[104:107]
  v_mfma_f32_16x16x32_bf16 v[108:111], v[60:63], v[232:235], v[108:111]
  ds_read_b128 v[60:63], v34 offset:256
  s_waitcnt lgkmcnt(3)
  v_mfma_f32_16x16x32_bf16 v[96:99], v[64:67], v[140:143], v[96:99]
  v_mfma_f32_16x16x32_bf16 v[100:103], v[64:67], v[172:175], v[100:103]
  v_mfma_f32_16x16x32_bf16 v[104:107], v[64:67], v[204:207], v[104:107]
  v_mfma_f32_16x16x32_bf16 v[108:111], v[64:67], v[236:239], v[108:111]
  ds_read_b128 v[64:67], v35 offset:256
  s_waitcnt lgkmcnt(3)
  v_mfma_f32_16x16x32_bf16 v[96:99], v[52:55], v[144:147], v[96:99]
  v_mfma_f32_16x16x32_bf16 v[100:103], v[52:55], v[176:179], v[100:103]
  v_mfma_f32_16x16x32_bf16 v[104:107], v[52:55], v[208:211], v[104:107]
  v_mfma_f32_16x16x32_bf16 v[108:111], v[52:55], v[240:243], v[108:111]
  ds_read_b128 v[52:55], v32 offset:2048
  s_waitcnt lgkmcnt(3)
  v_mfma_f32_16x16x32_bf16 v[96:99], v[56:59], v[148:151], v[96:99]
  v_mfma_f32_16x16x32_bf16 v[100:103], v[56:59], v[180:183], v[100:103]
  v_mfma_f32_16x16x32_bf16 v[104:107], v[56:59], v[212:215], v[104:107]
  v_mfma_f32_16x16x32_bf16 v[108:111], v[56:59], v[244:247], v[108:111]
  ds_read_b128 v[56:59], v33 offset:2048
  s_waitcnt lgkmcnt(3)
  v_mfma_f32_16x16x32_bf16 v[96:99], v[60:63], v[152:155], v[96:99]
  v_mfma_f32_16x16x32_bf16 v[100:103], v[60:63], v[184:187], v[100:103]
  v_mfma_f32_16x16x32_bf16 v[104:107], v[60:63], v[216:219], v[104:107]
  v_mfma_f32_16x16x32_bf16 v[108:111], v[60:63], v[248:251], v[108:111]
  ds_read_b128 v[60:63], v34 offset:2048
  s_waitcnt lgkmcnt(3)
  v_mfma_f32_16x16x32_bf16 v[96:99], v[64:67], v[156:159], v[96:99]
  v_mfma_f32_16x16x32_bf16 v[100:103], v[64:67], v[188:191], v[100:103]
  v_mfma_f32_16x16x32_bf16 v[104:107], v[64:67], v[220:223], v[104:107]
  v_mfma_f32_16x16x32_bf16 v[108:111], v[64:67], v[252:255], v[108:111]
  ds_read_b128 v[64:67], v35 offset:2048
  s_waitcnt lgkmcnt(3)
  v_mfma_f32_16x16x32_bf16 v[112:115], v[52:55], v[128:131], 0
  v_mfma_f32_16x16x32_bf16 v[116:119], v[52:55], v[160:163], 0
  v_mfma_f32_16x16x32_bf16 v[120:123], v[52:55], v[192:195], 0
  v_mfma_f32_16x16x32_bf16 v[124:127], v[52:55], v[224:227], 0
  ds_read_b128 v[52:55], v32 offset:2304
  s_waitcnt lgkmcnt(3)
  v_mfma_f32_16x16x32_bf16 v[112:115], v[56:59], v[132:135], v[112:115]
  v_mfma_f32_16x16x32_bf16 v[116:119], v[56:59], v[164:167], v[116:119]
  v_mfma_f32_16x16x32_bf16 v[120:123], v[56:59], v[196:199], v[120:123]
  v_mfma_f32_16x16x32_bf16 v[124:127], v[56:59], v[228:231], v[124:127]
  ds_read_b128 v[56:59], v33 offset:2304
  s_waitcnt lgkmcnt(3)
  v_mfma_f32_16x16x32_bf16 v[112:115], v[60:63], v[136:139], v[112:115]
  v_mfma_f32_16x16x32_bf16 v[116:119], v[60:63], v[168:171], v[116:119]
  v_mfma_f32_16x16x32_bf16 v[120:123], v[60:63], v[200:203], v[120:123]
  v_mfma_f32_16x16x32_bf16 v[124:127], v[60:63], v[232:235], v[124:127]
  ds_read_b128 v[60:63], v34 offset:2304
  s_waitcnt lgkmcnt(3)
  v_mfma_f32_16x16x32_bf16 v[112:115], v[64:67], v[140:143], v[112:115]
  v_mfma_f32_16x16x32_bf16 v[116:119], v[64:67], v[172:175], v[116:119]
  v_mfma_f32_16x16x32_bf16 v[120:123], v[64:67], v[204:207], v[120:123]
  v_mfma_f32_16x16x32_bf16 v[124:127], v[64:67], v[236:239], v[124:127]
  ds_read_b128 v[64:67], v35 offset:2304
  s_waitcnt lgkmcnt(3)
  v_mfma_f32_16x16x32_bf16 v[112:115], v[52:55], v[144:147], v[112:115]
  v_mfma_f32_16x16x32_bf16 v[116:119], v[52:55], v[176:179], v[116:119]
  v_mfma_f32_16x16x32_bf16 v[120:123], v[52:55], v[208:211], v[120:123]
  v_mfma_f32_16x16x32_bf16 v[124:127], v[52:55], v[240:243], v[124:127]
  s_waitcnt lgkmcnt(2)
  v_mfma_f32_16x16x32_bf16 v[112:115], v[56:59], v[148:151], v[112:115]
  v_mfma_f32_16x16x32_bf16 v[116:119], v[56:59], v[180:183], v[116:119]
  v_mfma_f32_16x16x32_bf16 v[120:123], v[56:59], v[212:215], v[120:123]
  v_mfma_f32_16x16x32_bf16 v[124:127], v[56:59], v[244:247], v[124:127]
  s_waitcnt lgkmcnt(1)
  v_mfma_f32_16x16x32_bf16 v[112:115], v[60:63], v[152:155], v[112:115]
  v_mfma_f32_16x16x32_bf16 v[116:119], v[60:63], v[184:187], v[116:119]
  v_mfma_f32_16x16x32_bf16 v[120:123], v[60:63], v[216:219], v[120:123]
  v_mfma_f32_16x16x32_bf16 v[124:127], v[60:63], v[248:251], v[124:127]
  s_waitcnt lgkmcnt(0)
  v_mfma_f32_16x16x32_bf16 v[112:115], v[64:67], v[156:159], v[112:115]
  v_mfma_f32_16x16x32_bf16 v[116:119], v[64:67], v[188:191], v[116:119]
  v_mfma_f32_16x16x32_bf16 v[120:123], v[64:67], v[220:223], v[120:123]
  v_mfma_f32_16x16x32_bf16 v[124:127], v[64:67], v[252:255], v[124:127]
  s_lshl_b32 s30, s28, 10
  v_mul_f32 v96, s24, v96
  v_mul_f32 v97, s24, v97
  v_mul_f32 v98, s24, v98
  v_mul_f32 v99, s24, v99
  v_cvt_pk_bf16_f32 v68, v96, v97
  v_cvt_pk_bf16_f32 v69, v98, v99
  v_mul_f32 v112, s24, v112
  v_mul_f32 v113, s24, v113
  v_mul_f32 v114, s24, v114
  v_mul_f32 v115, s24, v115
  v_cvt_pk_bf16_f32 v70, v112, v113
  v_cvt_pk_bf16_f32 v71, v114, v115
  buffer_store_dwordx4 v[68:71], v12, s[8:11], s30 offen sc1
  v_mul_f32 v100, s24, v100
  v_mul_f32 v101, s24, v101
  v_mul_f32 v102, s24, v102
  v_mul_f32 v103, s24, v103
  v_cvt_pk_bf16_f32 v72, v100, v101
  v_cvt_pk_bf16_f32 v73, v102, v103
  v_mul_f32 v116, s24, v116
  v_mul_f32 v117, s24, v117
  v_mul_f32 v118, s24, v118
  v_mul_f32 v119, s24, v119
  v_cvt_pk_bf16_f32 v74, v116, v117
  v_cvt_pk_bf16_f32 v75, v118, v119
  buffer_store_dwordx4 v[72:75], v13, s[8:11], s30 offen sc1
  v_mul_f32 v104, s24, v104
  v_mul_f32 v105, s24, v105
  v_mul_f32 v106, s24, v106
  v_mul_f32 v107, s24, v107
  v_cvt_pk_bf16_f32 v76, v104, v105
  v_cvt_pk_bf16_f32 v77, v106, v107
  v_mul_f32 v120, s24, v120
  v_mul_f32 v121, s24, v121
  v_mul_f32 v122, s24, v122
  v_mul_f32 v123, s24, v123
  v_cvt_pk_bf16_f32 v78, v120, v121
  v_cvt_pk_bf16_f32 v79, v122, v123
  buffer_store_dwordx4 v[76:79], v14, s[8:11], s30 offen sc1
  v_mul_f32 v108, s24, v108
  v_mul_f32 v109, s24, v109
  v_mul_f32 v110, s24, v110
  v_mul_f32 v111, s24, v111
  v_cvt_pk_bf16_f32 v80, v108, v109
  v_cvt_pk_bf16_f32 v81, v110, v111
  v_mul_f32 v124, s24, v124
  v_mul_f32 v125, s24, v125
  v_mul_f32 v126, s24, v126
  v_mul_f32 v127, s24, v127
  v_cvt_pk_bf16_f32 v82, v124, v125
  v_cvt_pk_bf16_f32 v83, v126, v127
  buffer_store_dwordx4 v[80:83], v15, s[8:11], s30 offen sc1
  s_cmp_eq_u32 s16, 3
  s_cbranch_scc1 aj_w3
  s_waitcnt vmcnt(4)
  ds_read_b128 v[52:55], v32 offset:16384
  ds_read_b128 v[56:59], v33 offset:16384
  ds_read_b128 v[60:63], v34 offset:16384
  ds_read_b128 v[64:67], v35 offset:16384
  s_waitcnt lgkmcnt(3)
  v_mfma_f32_16x16x32_bf16 v[96:99], v[52:55], v[128:131], 0
  v_mfma_f32_16x16x32_bf16 v[100:103], v[52:55], v[160:163], 0
  v_mfma_f32_16x16x32_bf16 v[104:107], v[52:55], v[192:195], 0
  v_mfma_f32_16x16x32_bf16 v[108:111], v[52:55], v[224:227], 0
  ds_read_b128 v[52:55], v32 offset:16640
  s_waitcnt lgkmcnt(3)
  v_mfma_f32_16x16x32_bf16 v[96:99], v[56:59], v[132:135], v[96:99]
  v_mfma_f32_16x16x32_bf16 v[100:103], v[56:59], v[164:167], v[100:103]
  v_mfma_f32_16x16x32_bf16 v[104:107], v[56:59], v[196:199], v[104:107]
  v_mfma_f32_16x16x32_bf16 v[108:111], v[56:59], v[228:231], v[108:111]
  ds_read_b128 v[56:59], v33 offset:16640
  s_waitcnt lgkmcnt(3)
  v_mfma_f32_16x16x32_bf16 v[96:99], v[60:63], v[136:139], v[96:99]
  v_mfma_f32_16x16x32_bf16 v[100:103], v[60:63], v[168:171], v[100:103]
  v_mfma_f32_16x16x32_bf16 v[104:107], v[60:63], v[200:203], v[104:107]
  v_mfma_f32_16x16x32_bf16 v[108:111], v[60:63], v[232:235], v[108:111]
  ds_read_b128 v[60:63], v34 offset:16640
  s_waitcnt lgkmcnt(3)
  v_mfma_f32_16x16x32_bf16 v[96:99], v[64:67], v[140:143], v[96:99]
  v_mfma_f32_16x16x32_bf16 v[100:103], v[64:67], v[172:175], v[100:103]
  v_mfma_f32_16x16x32_bf16 v[104:107], v[64:67], v[204:207], v[104:107]
  v_mfma_f32_16x16x32_bf16 v[108:111], v[64:67], v[236:239], v[108:111]
  ds_read_b128 v[64:67], v35 offset:16640
  s_waitcnt lgkmcnt(3)
  v_mfma_f32_16x16x32_bf16 v[96:99], v[52:55], v[144:147], v[96:99]
  v_mfma_f32_16x16x32_bf16 v[100:103], v[52:55], v[176:179], v[100:103]
  v_mfma_f32_16x16x32_bf16 v[104:107], v[52:55], v[208:211], v[104:107]
  v_mfma_f32_16x16x32_bf16 v[108:111], v[52:55], v[240:243], v[108:111]
  ds_read_b128 v[52:55], v32 offset:18432
  s_waitcnt lgkmcnt(3)
  v_mfma_f32_16x16x32_bf16 v[96:99], v[56:59], v[148:151], v[96:99]
  v_mfma_f32_16x16x32_bf16 v[100:103], v[56:59], v[180:183], v[100:103]
  v_mfma_f32_16x16x32_bf16 v[104:107], v[56:59], v[212:215], v[104:107]
  v_mfma_f32_16x16x32_bf16 v[108:111], v[56:59], v[244:247], v[108:111]
  ds_read_b128 v[56:59], v33 offset:18432
  s_waitcnt lgkmcnt(3)
  v_mfma_f32_16x16x32_bf16 v[96:99], v[60:63], v[152:155], v[96:99]
  v_mfma_f32_16x16x32_bf16 v[100:103], v[60:63], v[184:187], v[100:103]
  v_mfma_f32_16x16x32_bf16 v[104:107], v[60:63], v[216:219], v[104:107]
  v_mfma_f32_16x16x32_bf16 v[108:111], v[60:63], v[248:251], v[108:111]
  ds_read_b128 v[60:63], v34 offset:18432
  s_waitcnt lgkmcnt(3)
  v_mfma_f32_16x16x32_bf16 v[96:99], v[64:67], v[156:159], v[96:99]
  v_mfma_f32_16x16x32_bf16 v[100:103], v[64:67], v[188:191], v[100:103]
  v_mfma_f32_16x16x32_bf16 v[104:107], v[64:67], v[220:223], v[104:107]
  v_mfma_f32_16x16x32_bf16 v[108:111], v[64:67], v[252:255], v[108:111]
  ds_read_b128 v[64:67], v35 offset:18432
  s_waitcnt lgkmcnt(3)
  v_mfma_f32_16x16x32_bf16 v[112:115], v[52:55], v[128:131], 0
  v_mfma_f32_16x16x32_bf16 v[116:119], v[52:55], v[160:163], 0
  v_mfma_f32_16x16x32_bf16 v[120:123], v[52:55], v[192:195], 0
  v_mfma_f32_16x16x32_bf16 v[124:127], v[52:55], v[224:227], 0
  ds_read_b128 v[52:55], v32 offset:18688
  s_waitcnt lgkmcnt(3)
  v_mfma_f32_16x16x32_bf16 v[112:115], v[56:59], v[132:135], v[112:115]
  v_mfma_f32_16x16x32_bf16 v[116:119], v[56:59], v[164:167], v[116:119]
  v_mfma_f32_16x16x32_bf16 v[120:123], v[56:59], v[196:199], v[120:123]
  v_mfma_f32_16x16x32_bf16 v[124:127], v[56:59], v[228:231], v[124:127]
  ds_read_b128 v[56:59], v33 offset:18688
  s_waitcnt lgkmcnt(3)
  v_mfma_f32_16x16x32_bf16 v[112:115], v[60:63], v[136:139], v[112:115]
  v_mfma_f32_16x16x32_bf16 v[116:119], v[60:63], v[168:171], v[116:119]
  v_mfma_f32_16x16x32_bf16 v[120:123], v[60:63], v[200:203], v[120:123]
  v_mfma_f32_16x16x32_bf16 v[124:127], v[60:63], v[232:235], v[124:127]
  ds_read_b128 v[60:63], v34 offset:18688
  s_waitcnt lgkmcnt(3)
  v_mfma_f32_16x16x32_bf16 v[112:115], v[64:67], v[140:143], v[112:115]
  v_mfma_f32_16x16x32_bf16 v[116:119], v[64:67], v[172:175], v[116:119]
  v_mfma_f32_16x16x32_bf16 v[120:123], v[64:67], v[204:207], v[120:123]
  v_mfma_f32_16x16x32_bf16 v[124:127], v[64:67], v[236:239], v[124:127]
  ds_read_b128 v[64:67], v35 offset:18688
  s_waitcnt lgkmcnt(3)
  v_mfma_f32_16x16x32_bf16 v[112:115], v[52:55], v[144:147], v[112:115]
  v_mfma_f32_16x16x32_bf16 v[116:119], v[52:55], v[176:179], v[116:119]
  v_mfma_f32_16x16x32_bf16 v[120:123], v[52:55], v[208:211], v[120:123]
  v_mfma_f32_16x16x32_bf16 v[124:127], v[52:55], v[240:243], v[124:127]
  s_waitcnt lgkmcnt(2)
  v_mfma_f32_16x16x32_bf16 v[112:115], v[56:59], v[148:151], v[112:115]
  v_mfma_f32_16x16x32_bf16 v[116:119], v[56:59], v[180:183], v[116:119]
  v_mfma_f32_16x16x32_bf16 v[120:123], v[56:59], v[212:215], v[120:123]
  v_mfma_f32_16x16x32_bf16 v[124:127], v[56:59], v[244:247], v[124:127]
  s_waitcnt lgkmcnt(1)
  v_mfma_f32_16x16x32_bf16 v[112:115], v[60:63], v[152:155], v[112:115]
  v_mfma_f32_16x16x32_bf16 v[116:119], v[60:63], v[184:187], v[116:119]
  v_mfma_f32_16x16x32_bf16 v[120:123], v[60:63], v[216:219], v[120:123]
  v_mfma_f32_16x16x32_bf16 v[124:127], v[60:63], v[248:251], v[124:127]
  s_waitcnt lgkmcnt(0)
  v_mfma_f32_16x16x32_bf16 v[112:115], v[64:67], v[156:159], v[112:115]
  v_mfma_f32_16x16x32_bf16 v[116:119], v[64:67], v[188:191], v[116:119]
  v_mfma_f32_16x16x32_bf16 v[120:123], v[64:67], v[220:223], v[120:123]
  v_mfma_f32_16x16x32_bf16 v[124:127], v[64:67], v[252:255], v[124:127]
  s_lshl_b32 s30, s29, 10
  v_mul_f32 v96, s24, v96
  v_mul_f32 v97, s24, v97
  v_mul_f32 v98, s24, v98
  v_mul_f32 v99, s24, v99
  v_cvt_pk_bf16_f32 v68, v96, v97
  v_cvt_pk_bf16_f32 v69, v98, v99
  v_mul_f32 v112, s24, v112
  v_mul_f32 v113, s24, v113
  v_mul_f32 v114, s24, v114
  v_mul_f32 v115, s24, v115
  v_cvt_pk_bf16_f32 v70, v112, v113
  v_cvt_pk_bf16_f32 v71, v114, v115
  buffer_store_dwordx4 v[68:71], v12, s[8:11], s30 offen sc1
  v_mul_f32 v100, s24, v100
  v_mul_f32 v101, s24, v101
  v_mul_f32 v102, s24, v102
  v_mul_f32 v103, s24, v103
  v_cvt_pk_bf16_f32 v72, v100, v101
  v_cvt_pk_bf16_f32 v73, v102, v103
  v_mul_f32 v116, s24, v116
  v_mul_f32 v117, s24, v117
  v_mul_f32 v118, s24, v118
  v_mul_f32 v119, s24, v119
  v_cvt_pk_bf16_f32 v74, v116, v117
  v_cvt_pk_bf16_f32 v75, v118, v119
  buffer_store_dwordx4 v[72:75], v13, s[8:11], s30 offen sc1
  v_mul_f32 v104, s24, v104
  v_mul_f32 v105, s24, v105
  v_mul_f32 v106, s24, v106
  v_mul_f32 v107, s24, v107
  v_cvt_pk_bf16_f32 v76, v104, v105
  v_cvt_pk_bf16_f32 v77, v106, v107
  v_mul_f32 v120, s24, v120
  v_mul_f32 v121, s24, v121
  v_mul_f32 v122, s24, v122
  v_mul_f32 v123, s24, v123
  v_cvt_pk_bf16_f32 v78, v120, v121
  v_cvt_pk_bf16_f32 v79, v122, v123
  buffer_store_dwordx4 v[76:79], v14, s[8:11], s30 offen sc1
  v_mul_f32 v108, s24, v108
  v_mul_f32 v109, s24, v109
  v_mul_f32 v110, s24, v110
  v_mul_f32 v111, s24, v111
  v_cvt_pk_bf16_f32 v80, v108, v109
  v_cvt_pk_bf16_f32 v81, v110, v111
  v_mul_f32 v124, s24, v124
  v_mul_f32 v125, s24, v125
  v_mul_f32 v126, s24, v126
  v_mul_f32 v127, s24, v127
  v_cvt_pk_bf16_f32 v82, v124, v125
  v_cvt_pk_bf16_f32 v83, v126, v127
  buffer_store_dwordx4 v[80:83], v15, s[8:11], s30 offen sc1
aj_w3:
  s_lshl_b32 s28, s17, 7
  s_lshl_b32 s21, s19, 4
  s_add_u32 s28, s28, s21
  s_cmp_lg_u32 s31, 0
  s_cselect_b32 s21, 8, 0
  s_add_u32 s28, s28, s21
  s_add_u32 s28, s28, 88633344
  s_waitcnt vmcnt(0)
  s_barrier
  s_cmp_lg_u32 s16, 0
  s_cbranch_scc1 pub_48
  v_mul_u32_u24 v26, 2048, v1
  v_mov_b32 v24, s88
  v_mov_b32 v25, s89
  s_mov_b64 exec, 1
  buffer_store_dwordx2 v[24:25], v26, s[8:11], s28 offen sc1
  s_mov_b64 exec, -1
pub_48:
  v_mov_b32 v250, 0
  s_branch wk_loop
wk_srv:
  s_sub_u32 s3, s3, 224
  s_and_b32 s18, s3, 15
  s_lshr_b32 s19, s3, 4
  s_and_b32 s19, s19, 1
  s_mul_i32 s20, s18, 401408
  s_add_u32 s20, s20, 6422528
  s_mul_i32 s21, s16, 43008
  s_add_u32 s21, s21, s20
  s_mul_i32 s22, s16, 57344
  s_add_u32 s20, s20, s22
  s_add_u32 s22, s20, 0
  buffer_load_dwordx4 a[0:3], v2, s[8:11], s22 offen offset:0 sc1
  buffer_load_dwordx4 a[4:7], v2, s[8:11], s22 offen offset:1024 sc1
  buffer_load_dwordx4 a[8:11], v2, s[8:11], s22 offen offset:2048 sc1
  buffer_load_dwordx4 a[12:15], v2, s[8:11], s22 offen offset:3072 sc1
  s_add_u32 s22, s20, 4096
  buffer_load_dwordx4 a[16:19], v2, s[8:11], s22 offen offset:0 sc1
  buffer_load_dwordx4 a[20:23], v2, s[8:11], s22 offen offset:1024 sc1
  buffer_load_dwordx4 a[24:27], v2, s[8:11], s22 offen offset:2048 sc1
  buffer_load_dwordx4 a[28:31], v2, s[8:11], s22 offen offset:3072 sc1
  s_add_u32 s22, s20, 8192
  buffer_load_dwordx4 a[32:35], v2, s[8:11], s22 offen offset:0 sc1
  buffer_load_dwordx4 a[36:39], v2, s[8:11], s22 offen offset:1024 sc1
  buffer_load_dwordx4 a[40:43], v2, s[8:11], s22 offen offset:2048 sc1
  buffer_load_dwordx4 a[44:47], v2, s[8:11], s22 offen offset:3072 sc1
  s_add_u32 s22, s20, 12288
  buffer_load_dwordx4 a[48:51], v2, s[8:11], s22 offen offset:0 sc1
  buffer_load_dwordx4 a[52:55], v2, s[8:11], s22 offen offset:1024 sc1
  buffer_load_dwordx4 a[56:59], v2, s[8:11], s22 offen offset:2048 sc1
  buffer_load_dwordx4 a[60:63], v2, s[8:11], s22 offen offset:3072 sc1
  s_add_u32 s22, s20, 16384
  buffer_load_dwordx4 a[64:67], v2, s[8:11], s22 offen offset:0 sc1
  buffer_load_dwordx4 a[68:71], v2, s[8:11], s22 offen offset:1024 sc1
  buffer_load_dwordx4 a[72:75], v2, s[8:11], s22 offen offset:2048 sc1
  buffer_load_dwordx4 a[76:79], v2, s[8:11], s22 offen offset:3072 sc1
  s_add_u32 s22, s20, 20480
  buffer_load_dwordx4 a[80:83], v2, s[8:11], s22 offen offset:0 sc1
  buffer_load_dwordx4 a[84:87], v2, s[8:11], s22 offen offset:1024 sc1
  buffer_load_dwordx4 a[88:91], v2, s[8:11], s22 offen offset:2048 sc1
  buffer_load_dwordx4 a[92:95], v2, s[8:11], s22 offen offset:3072 sc1
  s_add_u32 s22, s20, 24576
  buffer_load_dwordx4 a[96:99], v2, s[8:11], s22 offen offset:0 sc1
  buffer_load_dwordx4 a[100:103], v2, s[8:11], s22 offen offset:1024 sc1
  buffer_load_dwordx4 a[104:107], v2, s[8:11], s22 offen offset:2048 sc1
  buffer_load_dwordx4 a[108:111], v2, s[8:11], s22 offen offset:3072 sc1
  s_add_u32 s22, s20, 28672
  buffer_load_dwordx4 a[112:115], v2, s[8:11], s22 offen offset:0 sc1
  buffer_load_dwordx4 a[116:119], v2, s[8:11], s22 offen offset:1024 sc1
  buffer_load_dwordx4 a[120:123], v2, s[8:11], s22 offen offset:2048 sc1
  buffer_load_dwordx4 a[124:127], v2, s[8:11], s22 offen offset:3072 sc1
  s_waitcnt vmcnt(24)
  s_add_u32 s22, s20, 32768
  buffer_load_dwordx4 a[128:131], v2, s[8:11], s22 offen offset:0 sc1
  buffer_load_dwordx4 a[132:135], v2, s[8:11], s22 offen offset:1024 sc1
  buffer_load_dwordx4 a[136:139], v2, s[8:11], s22 offen offset:2048 sc1
  buffer_load_dwordx4 a[140:143], v2, s[8:11], s22 offen offset:3072 sc1
  s_add_u32 s22, s20, 36864
  buffer_load_dwordx4 a[144:147], v2, s[8:11], s22 offen offset:0 sc1
  buffer_load_dwordx4 a[148:151], v2, s[8:11], s22 offen offset:1024 sc1
  buffer_load_dwordx4 a[152:155], v2, s[8:11], s22 offen offset:2048 sc1
  buffer_load_dwordx4 a[156:159], v2, s[8:11], s22 offen offset:3072 sc1
  s_add_u32 s22, s20, 40960
  buffer_load_dwordx4 a[160:163], v2, s[8:11], s22 offen offset:0 sc1
  buffer_load_dwordx4 a[164:167], v2, s[8:11], s22 offen offset:1024 sc1
  buffer_load_dwordx4 a[168:171], v2, s[8:11], s22 offen offset:2048 sc1
  buffer_load_dwordx4 a[172:175], v2, s[8:11], s22 offen offset:3072 sc1
  s_add_u32 s22, s20, 45056
  buffer_load_dwordx4 a[176:179], v2, s[8:11], s22 offen offset:0 sc1
  buffer_load_dwordx4 a[180:183], v2, s[8:11], s22 offen offset:1024 sc1
  buffer_load_dwordx4 a[184:187], v2, s[8:11], s22 offen offset:2048 sc1
  buffer_load_dwordx4 a[188:191], v2, s[8:11], s22 offen offset:3072 sc1
  s_add_u32 s22, s20, 49152
  buffer_load_dwordx4 a[192:195], v2, s[8:11], s22 offen offset:0 sc1
  buffer_load_dwordx4 a[196:199], v2, s[8:11], s22 offen offset:1024 sc1
  buffer_load_dwordx4 a[200:203], v2, s[8:11], s22 offen offset:2048 sc1
  buffer_load_dwordx4 a[204:207], v2, s[8:11], s22 offen offset:3072 sc1
  s_add_u32 s22, s20, 53248
  buffer_load_dwordx4 a[208:211], v2, s[8:11], s22 offen offset:0 sc1
  buffer_load_dwordx4 a[212:215], v2, s[8:11], s22 offen offset:1024 sc1
  buffer_load_dwordx4 a[216:219], v2, s[8:11], s22 offen offset:2048 sc1
  buffer_load_dwordx4 a[220:223], v2, s[8:11], s22 offen offset:3072 sc1
  s_add_u32 s22, s21, 229376
  buffer_load_dwordx4 a[224:227], v2, s[8:11], s22 offen offset:0 sc1
  buffer_load_dwordx4 a[228:231], v2, s[8:11], s22 offen offset:1024 sc1
  buffer_load_dwordx4 a[232:235], v2, s[8:11], s22 offen offset:2048 sc1
  buffer_load_dwordx4 a[236:239], v2, s[8:11], s22 offen offset:3072 sc1
  s_add_u32 s22, s21, 233472
  buffer_load_dwordx4 a[240:243], v2, s[8:11], s22 offen offset:0 sc1
  buffer_load_dwordx4 a[244:247], v2, s[8:11], s22 offen offset:1024 sc1
  buffer_load_dwordx4 a[248:251], v2, s[8:11], s22 offen offset:2048 sc1
  buffer_load_dwordx4 a[252:255], v2, s[8:11], s22 offen offset:3072 sc1
  s_waitcnt vmcnt(24)
  s_add_u32 s22, s21, 237568
  buffer_load_dwordx4 v[120:123], v2, s[8:11], s22 offen offset:0 sc1
  buffer_load_dwordx4 v[124:127], v2, s[8:11], s22 offen offset:1024 sc1
  buffer_load_dwordx4 v[128:131], v2, s[8:11], s22 offen offset:2048 sc1
  buffer_load_dwordx4 v[132:135], v2, s[8:11], s22 offen offset:3072 sc1
  s_add_u32 s22, s21, 241664
  buffer_load_dwordx4 v[136:139], v2, s[8:11], s22 offen offset:0 sc1
  buffer_load_dwordx4 v[140:143], v2, s[8:11], s22 offen offset:1024 sc1
  buffer_load_dwordx4 v[144:147], v2, s[8:11], s22 offen offset:2048 sc1
  buffer_load_dwordx4 v[148:151], v2, s[8:11], s22 offen offset:3072 sc1
  s_add_u32 s22, s21, 245760
  buffer_load_dwordx4 v[152:155], v2, s[8:11], s22 offen offset:0 sc1
  buffer_load_dwordx4 v[156:159], v2, s[8:11], s22 offen offset:1024 sc1
  buffer_load_dwordx4 v[160:163], v2, s[8:11], s22 offen offset:2048 sc1
  buffer_load_dwordx4 v[164:167], v2, s[8:11], s22 offen offset:3072 sc1
  s_add_u32 s22, s21, 249856
  buffer_load_dwordx4 v[168:171], v2, s[8:11], s22 offen offset:0 sc1
  buffer_load_dwordx4 v[172:175], v2, s[8:11], s22 offen offset:1024 sc1
  buffer_load_dwordx4 v[176:179], v2, s[8:11], s22 offen offset:2048 sc1
  buffer_load_dwordx4 v[180:183], v2, s[8:11], s22 offen offset:3072 sc1
  s_add_u32 s22, s21, 253952
  buffer_load_dwordx4 v[184:187], v2, s[8:11], s22 offen offset:0 sc1
  buffer_load_dwordx4 v[188:191], v2, s[8:11], s22 offen offset:1024 sc1
  buffer_load_dwordx4 v[192:195], v2, s[8:11], s22 offen offset:2048 sc1
  buffer_load_dwordx4 v[196:199], v2, s[8:11], s22 offen offset:3072 sc1
  s_add_u32 s22, s21, 258048
  buffer_load_dwordx4 v[200:203], v2, s[8:11], s22 offen offset:0 sc1
  buffer_load_dwordx4 v[204:207], v2, s[8:11], s22 offen offset:1024 sc1
  buffer_load_dwordx4 v[208:211], v2, s[8:11], s22 offen offset:2048 sc1
  buffer_load_dwordx4 v[212:215], v2, s[8:11], s22 offen offset:3072 sc1
  s_add_u32 s22, s21, 262144
  buffer_load_dwordx4 v[216:219], v2, s[8:11], s22 offen offset:0 sc1
  buffer_load_dwordx4 v[220:223], v2, s[8:11], s22 offen offset:1024 sc1
  buffer_load_dwordx4 v[224:227], v2, s[8:11], s22 offen offset:2048 sc1
  buffer_load_dwordx4 v[228:231], v2, s[8:11], s22 offen offset:3072 sc1
  s_add_u32 s22, s21, 266240
  buffer_load_dwordx4 v[232:235], v2, s[8:11], s22 offen offset:0 sc1
  buffer_load_dwordx4 v[236:239], v2, s[8:11], s22 offen offset:1024 sc1
  buffer_load_dwordx4 v[240:243], v2, s[8:11], s22 offen offset:2048 sc1
  buffer_load_dwordx4 v[244:247], v2, s[8:11], s22 offen offset:3072 sc1
  s_waitcnt vmcnt(24)
  s_add_u32 s22, s21, 270336
  buffer_load_dwordx4 v[248:251], v2, s[8:11], s22 offen offset:0 sc1
  buffer_load_dwordx4 v[252:255], v2, s[8:11], s22 offen offset:1024 sc1
  v_mov_b32 v5, 0x4444
  v_mov_b32 v6, 0xeeee
  v_cmp_lt_u32 vcc, 7, v4
  s_nop 1
  v_cndmask_b32 v5, v5, v6, vcc
  s_lshl_b32 s23, s16, 11
  v_lshrrev_b32 v80, 1, v3
  v_and_b32 v81, 1, v3
  v_add_u32 v83, 0, v80
  v_mov_b32 v84, v4
  v_mov_b32 v86, 0
  v_lshl_add_u32 v86, v83, 8, v86
  v_lshl_add_u32 v86, v84, 4, v86
  v_lshl_add_u32 v86, v81, 3, v86
  v_add_u32 v72, s23, v86
  v_add_u32 v83, 2, v80
  v_mov_b32 v84, v4
  v_mov_b32 v86, 0
  v_lshl_add_u32 v86, v83, 8, v86
  v_lshl_add_u32 v86, v84, 4, v86
  v_lshl_add_u32 v86, v81, 3, v86
  v_add_u32 v73, s23, v86
  v_lshl_add_u32 v82, v80, 4, v4
  v_mul_u32_u24 v83, 5462, v82
  v_lshrrev_b32 v83, 16, v83
  v_mul_u32_u24 v84, 12, v83
  v_sub_u32 v84, v82, v84
  v_mov_b32 v86, 1024
  v_lshl_add_u32 v86, v83, 8, v86
  v_lshl_add_u32 v86, v84, 4, v86
  v_lshl_add_u32 v86, v81, 3, v86
  v_add_u32 v74, s23, v86
  v_add_u32 v82, 32, v4
  v_mul_u32_u24 v83, 5462, v82
  v_lshrrev_b32 v83, 16, v83
  v_mul_u32_u24 v84, 12, v83
  v_sub_u32 v84, v82, v84
  v_mov_b32 v86, 1024
  v_lshl_add_u32 v86, v83, 8, v86
  v_lshl_add_u32 v86, v84, 4, v86
  v_lshl_add_u32 v86, v81, 3, v86
  v_add_u32 v75, s23, v86
  v_add_u32 v76, s23, v2
  s_mul_i32 s27, s18, 448
  v_mov_b32 v77, s27
  v_mov_b32 v78, 1
  s_mov_b32 s17, s19
  s_mul_i32 s24, s19, 7168
  s_add_u32 s24, s24, 88080384
  s_mul_i32 s25, s18, 65
  s_add_u32 s25, s25, s19
  s_lshl_b32 s25, s25, 13
  s_add_u32 s25, s25, s23
  s_add_u32 s25, s25, 76947456
  s_lshl_b32 s26, s18, 6
  s_add_u32 s26, s26, s19
  s_lshl_b32 s26, s26, 4
  s_lshl_b32 s27, s16, 2
  s_add_u32 s26, s26, s27
  s_add_u32 s26, s26, 88582144
  v_mov_b32 v87, -1
ws_loop:
  v_mov_b32 v36, 0
  v_mov_b32 v37, 0
  v_mov_b32 v38, 0
  v_mov_b32 v39, 0
  v_mov_b32 v40, 0
  v_mov_b32 v41, 0
  v_mov_b32 v42, 0
  v_mov_b32 v43, 0
  v_mov_b32 v44, 0
  v_mov_b32 v45, 0
  v_mov_b32 v46, 0
  v_mov_b32 v47, 0
  v_mov_b32 v48, 0
  v_mov_b32 v49, 0
  v_mov_b32 v50, 0
  v_mov_b32 v51, 0
  v_mov_b32 v52, 0
  v_mov_b32 v53, 0
  v_mov_b32 v54, 0
  v_mov_b32 v55, 0
  v_mov_b32 v56, 0
  v_mov_b32 v57, 0
  v_mov_b32 v58, 0
  v_mov_b32 v59, 0
  v_mov_b32 v60, 0
  v_mov_b32 v61, 0
  v_mov_b32 v62, 0
  v_mov_b32 v63, 0
  s_mov_b32 s30, 0
  v_cmp_eq_u32 vcc, -1, v87
  s_cbranch_vccz ws_fl
ws_pm:
  s_cmp_ge_u32 s17, 61
  s_cbranch_scc1 mp_49a
  v_mov_b32 v79, 0
  s_mov_b64 exec, 1
  buffer_atomic_or v79, v77, s[8:11], s24 offen sc0
  s_mov_b64 exec, -1
  s_branch mp_49b
mp_49a:
  buffer_load_dword v79, v77, s[8:11], s24 offen sc1
mp_49b:
  s_waitcnt vmcnt(0)
  v_cmp_eq_u32 vcc, -1, v79
  s_cbranch_vccnz ws_pr
ws_fl:
  s_add_u32 s22, s24, 4096
  buffer_load_dwordx4 v[8:11], v2, s[8:11], s24 offen offset:0 sc1
  buffer_load_dwordx4 v[12:15], v2, s[8:11], s24 offen offset:1024 sc1
  buffer_load_dwordx4 v[16:19], v2, s[8:11], s24 offen offset:2048 sc1
  buffer_load_dwordx4 v[20:23], v2, s[8:11], s24 offen offset:3072 sc1
  buffer_load_dwordx4 v[24:27], v2, s[8:11], s22 offen offset:0 sc1
  buffer_load_dwordx4 v[28:31], v2, s[8:11], s22 offen offset:1024 sc1
  buffer_load_dwordx4 v[32:35], v2, s[8:11], s22 offen offset:2048 sc1
  s_waitcnt vmcnt(0)
  v_max_u32 v79, v8, v9
  v_max3_u32 v79, v79, v10, v11
  v_max3_u32 v79, v79, v12, v13
  v_max3_u32 v79, v79, v14, v15
  v_max3_u32 v79, v79, v16, v17
  v_max3_u32 v79, v79, v18, v19
  v_max3_u32 v79, v79, v20, v21
  v_max3_u32 v79, v79, v22, v23
  v_max3_u32 v79, v79, v24, v25
  v_max3_u32 v79, v79, v26, v27
  v_max3_u32 v79, v79, v28, v29
  v_max3_u32 v79, v79, v30, v31
  v_max3_u32 v79, v79, v32, v33
  v_max3_u32 v79, v79, v34, v35
  v_cmp_eq_u32 vcc, -1, v79
  s_cbranch_vccz ws_pk
ws_pr:
  s_sleep 1
  s_cmp_ge_u32 s17, 61
  s_cbranch_scc1 ws_sh
  s_sleep 6
ws_sh:
  s_add_u32 s30, s30, 1
  s_cmp_lt_u32 s30, 30000
  s_cbranch_scc1 ws_pm
  s_branch cA_abort
ws_pk:
  s_cmp_ge_u32 s17, 62
  s_cbranch_scc1 ws_na
  s_add_u32 s22, s24, 14336
  s_cmp_ge_u32 s17, 61
  s_cbranch_scc1 mp_50a
  v_mov_b32 v87, 0
  s_mov_b64 exec, 1
  buffer_atomic_or v87, v77, s[8:11], s22 offen sc0
  s_mov_b64 exec, -1
  s_branch mp_50b
mp_50a:
  buffer_load_dword v87, v77, s[8:11], s22 offen sc1
mp_50b:
ws_na:
  v_smfmac_f32_16x16x64_bf16 v[36:39], v[8:11], a[0:7], v5
  v_smfmac_f32_16x16x64_bf16 v[36:39], v[12:15], a[8:15], v5
  v_smfmac_f32_16x16x64_bf16 v[36:39], v[16:19], a[16:23], v5
  v_smfmac_f32_16x16x64_bf16 v[36:39], v[20:23], a[24:31], v5
  v_smfmac_f32_16x16x64_bf16 v[36:39], v[24:27], a[32:39], v5
  v_smfmac_f32_16x16x64_bf16 v[36:39], v[28:31], a[40:47], v5
  v_smfmac_f32_16x16x64_bf16 v[36:39], v[32:35], a[48:55], v5
  v_smfmac_f32_16x16x64_bf16 v[40:43], v[8:11], a[56:63], v5
  v_smfmac_f32_16x16x64_bf16 v[40:43], v[12:15], a[64:71], v5
  v_smfmac_f32_16x16x64_bf16 v[40:43], v[16:19], a[72:79], v5
  v_smfmac_f32_16x16x64_bf16 v[40:43], v[20:23], a[80:87], v5
  v_smfmac_f32_16x16x64_bf16 v[40:43], v[24:27], a[88:95], v5
  v_smfmac_f32_16x16x64_bf16 v[40:43], v[28:31], a[96:103], v5
  v_smfmac_f32_16x16x64_bf16 v[40:43], v[32:35], a[104:111], v5
  v_smfmac_f32_16x16x64_bf16 v[44:47], v[8:11], a[112:119], v5
  v_smfmac_f32_16x16x64_bf16 v[44:47], v[12:15], a[120:127], v5
  v_smfmac_f32_16x16x64_bf16 v[44:47], v[16:19], a[128:135], v5
  v_smfmac_f32_16x16x64_bf16 v[44:47], v[20:23], a[136:143], v5
  v_smfmac_f32_16x16x64_bf16 v[44:47], v[24:27], a[144:151], v5
  v_smfmac_f32_16x16x64_bf16 v[44:47], v[28:31], a[152:159], v5
  v_smfmac_f32_16x16x64_bf16 v[44:47], v[32:35], a[160:167], v5
  v_smfmac_f32_16x16x64_bf16 v[48:51], v[8:11], a[168:175], v5
  v_smfmac_f32_16x16x64_bf16 v[48:51], v[12:15], a[176:183], v5
  v_smfmac_f32_16x16x64_bf16 v[48:51], v[16:19], a[184:191], v5
  v_smfmac_f32_16x16x64_bf16 v[48:51], v[20:23], a[192:199], v5
  v_smfmac_f32_16x16x64_bf16 v[48:51], v[24:27], a[200:207], v5
  v_smfmac_f32_16x16x64_bf16 v[48:51], v[28:31], a[208:215], v5
  v_smfmac_f32_16x16x64_bf16 v[48:51], v[32:35], a[216:223], v5
  v_smfmac_f32_16x16x64_bf16 v[52:55], v[8:11], a[224:231], v5
  v_smfmac_f32_16x16x64_bf16 v[52:55], v[12:15], a[232:239], v5
  v_smfmac_f32_16x16x64_bf16 v[52:55], v[16:19], a[240:247], v5
  v_smfmac_f32_16x16x64_bf16 v[52:55], v[20:23], a[248:255], v5
  v_smfmac_f32_16x16x64_bf16 v[52:55], v[24:27], v[120:127], v5
  v_smfmac_f32_16x16x64_bf16 v[52:55], v[28:31], v[128:135], v5
  v_smfmac_f32_16x16x64_bf16 v[52:55], v[32:35], v[136:143], v5
  v_smfmac_f32_16x16x64_bf16 v[56:59], v[8:11], v[144:151], v5
  v_smfmac_f32_16x16x64_bf16 v[56:59], v[12:15], v[152:159], v5
  v_smfmac_f32_16x16x64_bf16 v[56:59], v[16:19], v[160:167], v5
  v_smfmac_f32_16x16x64_bf16 v[56:59], v[20:23], v[168:175], v5
  v_smfmac_f32_16x16x64_bf16 v[56:59], v[24:27], v[176:183], v5
  v_smfmac_f32_16x16x64_bf16 v[56:59], v[28:31], v[184:191], v5
  v_smfmac_f32_16x16x64_bf16 v[56:59], v[32:35], v[192:199], v5
  v_smfmac_f32_16x16x64_bf16 v[60:63], v[8:11], v[200:207], v5
  v_smfmac_f32_16x16x64_bf16 v[60:63], v[12:15], v[208:215], v5
  v_smfmac_f32_16x16x64_bf16 v[60:63], v[16:19], v[216:223], v5
  v_smfmac_f32_16x16x64_bf16 v[60:63], v[20:23], v[224:231], v5
  v_smfmac_f32_16x16x64_bf16 v[60:63], v[24:27], v[232:239], v5
  v_smfmac_f32_16x16x64_bf16 v[60:63], v[28:31], v[240:247], v5
  v_smfmac_f32_16x16x64_bf16 v[60:63], v[32:35], v[248:255], v5
  v_permlane32_swap_b32 v36, v40
  v_permlane32_swap_b32 v37, v41
  v_permlane32_swap_b32 v38, v42
  v_permlane32_swap_b32 v39, v43
  v_add_f32 v36, v36, v40
  v_add_f32 v37, v37, v41
  v_add_f32 v38, v38, v42
  v_add_f32 v39, v39, v43
  v_cvt_pk_bf16_f32 v40, v36, v37
  v_cvt_pk_bf16_f32 v41, v38, v39
  ds_write_b64 v72, v[40:41]
  v_permlane32_swap_b32 v44, v48
  v_permlane32_swap_b32 v45, v49
  v_permlane32_swap_b32 v46, v50
  v_permlane32_swap_b32 v47, v51
  v_add_f32 v44, v44, v48
  v_add_f32 v45, v45, v49
  v_add_f32 v46, v46, v50
  v_add_f32 v47, v47, v51
  v_cvt_pk_bf16_f32 v48, v44, v45
  v_cvt_pk_bf16_f32 v49, v46, v47
  ds_write_b64 v73, v[48:49]
  v_permlane32_swap_b32 v52, v56
  v_permlane32_swap_b32 v53, v57
  v_permlane32_swap_b32 v54, v58
  v_permlane32_swap_b32 v55, v59
  v_add_f32 v52, v52, v56
  v_add_f32 v53, v53, v57
  v_add_f32 v54, v54, v58
  v_add_f32 v55, v55, v59
  v_cvt_pk_bf16_f32 v56, v52, v53
  v_cvt_pk_bf16_f32 v57, v54, v55
  ds_write_b64 v74, v[56:57]
  v_mov_b32 v64, v60
  v_mov_b32 v65, v61
  v_mov_b32 v66, v62
  v_mov_b32 v67, v63
  v_permlane32_swap_b32 v60, v64
  v_permlane32_swap_b32 v61, v65
  v_permlane32_swap_b32 v62, v66
  v_permlane32_swap_b32 v63, v67
  v_add_f32 v60, v60, v64
  v_add_f32 v61, v61, v65
  v_add_f32 v62, v62, v66
  v_add_f32 v63, v63, v67
  v_cvt_pk_bf16_f32 v64, v60, v61
  v_cvt_pk_bf16_f32 v65, v62, v63
  ds_write_b64 v75, v[64:65]
  s_waitcnt lgkmcnt(0)
  ds_read_b128 v[64:67], v76
  ds_read_b128 v[68:71], v76 offset:1024
  s_waitcnt lgkmcnt(0)
  buffer_store_dwordx4 v[64:67], v2, s[8:11], s25 offen sc1
  buffer_store_dwordx4 v[68:71], v2, s[8:11], s25 offen offset:1024 sc1
  s_waitcnt vmcnt(0)
  s_mov_b64 exec, 1
  buffer_store_dword v78, v2, s[8:11], s26 offen sc1
  s_mov_b64 exec, -1
  s_add_u32 s24, s24, 14336
  s_add_u32 s25, s25, 16384
  s_add_u32 s26, s26, 32
  s_add_u32 s17, s17, 2
  s_cmp_lt_u32 s17, 64
  s_cbranch_scc1 ws_loop
  v_mov_b32 v250, 0
  s_branch wk_loop
wk_s4d:
  s_cmp_lg_u32 s16, 0
  s_cbranch_scc1 w0_51
  s_getreg_b32 s20, hwreg(HW_REG_XCC_ID)
  s_sub_u32 s20, s20, 1
  s_and_b32 s20, s20, 7
  s_mov_b64 exec, 1
s4_l:
  s_cmp_ge_u32 s20, 7
  s_cselect_b32 s20, 0, s20
  s_lshl_b32 s21, s20, 7
  s_add_u32 s21, s21, 88598528
  v_mov_b32 v242, 1
  buffer_atomic_add v242, off, s[8:11], s21 sc0
  s_waitcnt vmcnt(0)
  v_readfirstlane_b32 s21, v242
  s_lshl_b32 s22, s20, 4
  s_add_u32 s20, s20, 1
  s_cmp_ge_u32 s21, 16
  s_cbranch_scc1 s4_l
  v_add_u32 v242, s22, v242
  s_mov_b64 exec, -1
w0_51:
  v_mov_b32 v243, 160000
  s_add_u32 s101, s101, 1
  s_barrier
  s_mov_b64 exec, 1
  s_cmp_lg_u32 s16, 0
  s_cbranch_scc1 w0_52
  ds_write_b32 v243, v242 offset:0
  s_waitcnt lgkmcnt(0)
  v_mov_b32 v242, s101
  ds_write_b32 v243, v242 offset:16
  s_waitcnt lgkmcnt(0)
w0_52:
  s_mov_b64 exec, -1
  s_barrier
  ds_read_b32 v242, v243 offset:0
  ds_read_b32 v243, v243 offset:16
  s_waitcnt lgkmcnt(0)
  v_readfirstlane_b32 s3, v242
  v_cmp_ne_u32 vcc, s101, v243
  s_cbranch_vccnz ch_end
  s_load_dwordx8 s[40:47], s[0:1], 0
  s_load_dwordx4 s[48:51], s[0:1], 32
  s_load_dwordx2 s[52:53], s[0:1], 48
  s_load_dwordx2 s[54:55], s[0:1], 112
  v_lshrrev_b32 v1, 6, v0
  s_nop 0
  v_readfirstlane_b32 s16, v1
  v_and_b32 v1, 63, v0
  v_lshrrev_b32 v3, 4, v1
  v_and_b32 v4, 15, v1
  s_mul_i32 s17, s16, 24576
  s_waitcnt lgkmcnt(0)
  s_mov_b32 s60, s40
  s_and_b32 s61, s41, 0xffff
  s_mov_b32 s62, 1835008
  s_mov_b32 s63, 0x20000
  s_mov_b32 s64, s42
  s_and_b32 s65, s43, 0xffff
  s_mov_b32 s66, 229376
  s_mov_b32 s67, 0x20000
  s_mov_b32 s68, s44
  s_and_b32 s69, s45, 0xffff
  s_mov_b32 s70, 229376
  s_mov_b32 s71, 0x20000
  s_mov_b32 s72, s46
  s_and_b32 s73, s47, 0xffff
  s_mov_b32 s74, 229376
  s_mov_b32 s75, 0x20000
  s_mov_b32 s76, s48
  s_and_b32 s77, s49, 0xffff
  s_mov_b32 s78, 229376
  s_mov_b32 s79, 0x20000
  s_mov_b32 s80, s50
  s_and_b32 s81, s51, 0xffff
  s_mov_b32 s82, 896
  s_mov_b32 s83, 0x20000
  s_mov_b32 s84, s52
  s_and_b32 s85, s53, 0xffff
  s_mov_b32 s86, 896
  s_mov_b32 s87, 0x20000
  s_mov_b32 s92, s54
  s_and_b32 s93, s55, 0xffff
  s_mov_b32 s94, 3670016
  s_mov_b32 s95, 0x20000
  v_lshlrev_b32 v5, 5, v1
  v_sub_u32 v5, 2047, v5
  s_add_u32 s18, s17, 13056
  v_subrev_u32 v6, 0, v5
  v_max_i32 v7, 0, v6
  v_cvt_f32_u32 v7, v7
  v_cvt_pk_bf16_f32 v8, v7, v7
  v_and_b32 v7, 0xffff0000, v8
  v_lshrrev_b32 v8, 23, v7
  v_subrev_u32 v8, 134, v8
  v_max_i32 v8, 0, v8
  v_cvt_u32_f32 v7, v7
  v_lshrrev_b32 v7, v8, v7
  v_lshl_add_u32 v7, v8, 8, v7
  v_lshl_add_u32 v200, v7, 2, s18
  v_subrev_u32 v6, 1, v5
  v_max_i32 v7, 0, v6
  v_cvt_f32_u32 v7, v7
  v_cvt_pk_bf16_f32 v8, v7, v7
  v_and_b32 v7, 0xffff0000, v8
  v_lshrrev_b32 v8, 23, v7
  v_subrev_u32 v8, 134, v8
  v_max_i32 v8, 0, v8
  v_cvt_u32_f32 v7, v7
  v_lshrrev_b32 v7, v8, v7
  v_lshl_add_u32 v7, v8, 8, v7
  v_lshl_add_u32 v201, v7, 2, s18
  v_subrev_u32 v6, 2, v5
  v_max_i32 v7, 0, v6
  v_cvt_f32_u32 v7, v7
  v_cvt_pk_bf16_f32 v8, v7, v7
  v_and_b32 v7, 0xffff0000, v8
  v_lshrrev_b32 v8, 23, v7
  v_subrev_u32 v8, 134, v8
  v_max_i32 v8, 0, v8
  v_cvt_u32_f32 v7, v7
  v_lshrrev_b32 v7, v8, v7
  v_lshl_add_u32 v7, v8, 8, v7
  v_lshl_add_u32 v202, v7, 2, s18
  v_subrev_u32 v6, 3, v5
  v_max_i32 v7, 0, v6
  v_cvt_f32_u32 v7, v7
  v_cvt_pk_bf16_f32 v8, v7, v7
  v_and_b32 v7, 0xffff0000, v8
  v_lshrrev_b32 v8, 23, v7
  v_subrev_u32 v8, 134, v8
  v_max_i32 v8, 0, v8
  v_cvt_u32_f32 v7, v7
  v_lshrrev_b32 v7, v8, v7
  v_lshl_add_u32 v7, v8, 8, v7
  v_lshl_add_u32 v203, v7, 2, s18
  v_subrev_u32 v6, 4, v5
  v_max_i32 v7, 0, v6
  v_cvt_f32_u32 v7, v7
  v_cvt_pk_bf16_f32 v8, v7, v7
  v_and_b32 v7, 0xffff0000, v8
  v_lshrrev_b32 v8, 23, v7
  v_subrev_u32 v8, 134, v8
  v_max_i32 v8, 0, v8
  v_cvt_u32_f32 v7, v7
  v_lshrrev_b32 v7, v8, v7
  v_lshl_add_u32 v7, v8, 8, v7
  v_lshl_add_u32 v204, v7, 2, s18
  v_subrev_u32 v6, 5, v5
  v_max_i32 v7, 0, v6
  v_cvt_f32_u32 v7, v7
  v_cvt_pk_bf16_f32 v8, v7, v7
  v_and_b32 v7, 0xffff0000, v8
  v_lshrrev_b32 v8, 23, v7
  v_subrev_u32 v8, 134, v8
  v_max_i32 v8, 0, v8
  v_cvt_u32_f32 v7, v7
  v_lshrrev_b32 v7, v8, v7
  v_lshl_add_u32 v7, v8, 8, v7
  v_lshl_add_u32 v205, v7, 2, s18
  v_subrev_u32 v6, 6, v5
  v_max_i32 v7, 0, v6
  v_cvt_f32_u32 v7, v7
  v_cvt_pk_bf16_f32 v8, v7, v7
  v_and_b32 v7, 0xffff0000, v8
  v_lshrrev_b32 v8, 23, v7
  v_subrev_u32 v8, 134, v8
  v_max_i32 v8, 0, v8
  v_cvt_u32_f32 v7, v7
  v_lshrrev_b32 v7, v8, v7
  v_lshl_add_u32 v7, v8, 8, v7
  v_lshl_add_u32 v206, v7, 2, s18
  v_subrev_u32 v6, 7, v5
  v_max_i32 v7, 0, v6
  v_cvt_f32_u32 v7, v7
  v_cvt_pk_bf16_f32 v8, v7, v7
  v_and_b32 v7, 0xffff0000, v8
  v_lshrrev_b32 v8, 23, v7
  v_subrev_u32 v8, 134, v8
  v_max_i32 v8, 0, v8
  v_cvt_u32_f32 v7, v7
  v_lshrrev_b32 v7, v8, v7
  v_lshl_add_u32 v7, v8, 8, v7
  v_lshl_add_u32 v207, v7, 2, s18
  v_subrev_u32 v6, 8, v5
  v_max_i32 v7, 0, v6
  v_cvt_f32_u32 v7, v7
  v_cvt_pk_bf16_f32 v8, v7, v7
  v_and_b32 v7, 0xffff0000, v8
  v_lshrrev_b32 v8, 23, v7
  v_subrev_u32 v8, 134, v8
  v_max_i32 v8, 0, v8
  v_cvt_u32_f32 v7, v7
  v_lshrrev_b32 v7, v8, v7
  v_lshl_add_u32 v7, v8, 8, v7
  v_lshl_add_u32 v208, v7, 2, s18
  v_subrev_u32 v6, 9, v5
  v_max_i32 v7, 0, v6
  v_cvt_f32_u32 v7, v7
  v_cvt_pk_bf16_f32 v8, v7, v7
  v_and_b32 v7, 0xffff0000, v8
  v_lshrrev_b32 v8, 23, v7
  v_subrev_u32 v8, 134, v8
  v_max_i32 v8, 0, v8
  v_cvt_u32_f32 v7, v7
  v_lshrrev_b32 v7, v8, v7
  v_lshl_add_u32 v7, v8, 8, v7
  v_lshl_add_u32 v209, v7, 2, s18
  v_subrev_u32 v6, 10, v5
  v_max_i32 v7, 0, v6
  v_cvt_f32_u32 v7, v7
  v_cvt_pk_bf16_f32 v8, v7, v7
  v_and_b32 v7, 0xffff0000, v8
  v_lshrrev_b32 v8, 23, v7
  v_subrev_u32 v8, 134, v8
  v_max_i32 v8, 0, v8
  v_cvt_u32_f32 v7, v7
  v_lshrrev_b32 v7, v8, v7
  v_lshl_add_u32 v7, v8, 8, v7
  v_lshl_add_u32 v210, v7, 2, s18
  v_subrev_u32 v6, 11, v5
  v_max_i32 v7, 0, v6
  v_cvt_f32_u32 v7, v7
  v_cvt_pk_bf16_f32 v8, v7, v7
  v_and_b32 v7, 0xffff0000, v8
  v_lshrrev_b32 v8, 23, v7
  v_subrev_u32 v8, 134, v8
  v_max_i32 v8, 0, v8
  v_cvt_u32_f32 v7, v7
  v_lshrrev_b32 v7, v8, v7
  v_lshl_add_u32 v7, v8, 8, v7
  v_lshl_add_u32 v211, v7, 2, s18
  v_subrev_u32 v6, 12, v5
  v_max_i32 v7, 0, v6
  v_cvt_f32_u32 v7, v7
  v_cvt_pk_bf16_f32 v8, v7, v7
  v_and_b32 v7, 0xffff0000, v8
  v_lshrrev_b32 v8, 23, v7
  v_subrev_u32 v8, 134, v8
  v_max_i32 v8, 0, v8
  v_cvt_u32_f32 v7, v7
  v_lshrrev_b32 v7, v8, v7
  v_lshl_add_u32 v7, v8, 8, v7
  v_lshl_add_u32 v212, v7, 2, s18
  v_subrev_u32 v6, 13, v5
  v_max_i32 v7, 0, v6
  v_cvt_f32_u32 v7, v7
  v_cvt_pk_bf16_f32 v8, v7, v7
  v_and_b32 v7, 0xffff0000, v8
  v_lshrrev_b32 v8, 23, v7
  v_subrev_u32 v8, 134, v8
  v_max_i32 v8, 0, v8
  v_cvt_u32_f32 v7, v7
  v_lshrrev_b32 v7, v8, v7
  v_lshl_add_u32 v7, v8, 8, v7
  v_lshl_add_u32 v213, v7, 2, s18
  v_subrev_u32 v6, 14, v5
  v_max_i32 v7, 0, v6
  v_cvt_f32_u32 v7, v7
  v_cvt_pk_bf16_f32 v8, v7, v7
  v_and_b32 v7, 0xffff0000, v8
  v_lshrrev_b32 v8, 23, v7
  v_subrev_u32 v8, 134, v8
  v_max_i32 v8, 0, v8
  v_cvt_u32_f32 v7, v7
  v_lshrrev_b32 v7, v8, v7
  v_lshl_add_u32 v7, v8, 8, v7
  v_lshl_add_u32 v214, v7, 2, s18
  v_subrev_u32 v6, 15, v5
  v_max_i32 v7, 0, v6
  v_cvt_f32_u32 v7, v7
  v_cvt_pk_bf16_f32 v8, v7, v7
  v_and_b32 v7, 0xffff0000, v8
  v_lshrrev_b32 v8, 23, v7
  v_subrev_u32 v8, 134, v8
  v_max_i32 v8, 0, v8
  v_cvt_u32_f32 v7, v7
  v_lshrrev_b32 v7, v8, v7
  v_lshl_add_u32 v7, v8, 8, v7
  v_lshl_add_u32 v215, v7, 2, s18
  v_subrev_u32 v6, 16, v5
  v_max_i32 v7, 0, v6
  v_cvt_f32_u32 v7, v7
  v_cvt_pk_bf16_f32 v8, v7, v7
  v_and_b32 v7, 0xffff0000, v8
  v_lshrrev_b32 v8, 23, v7
  v_subrev_u32 v8, 134, v8
  v_max_i32 v8, 0, v8
  v_cvt_u32_f32 v7, v7
  v_lshrrev_b32 v7, v8, v7
  v_lshl_add_u32 v7, v8, 8, v7
  v_lshl_add_u32 v216, v7, 2, s18
  v_subrev_u32 v6, 17, v5
  v_max_i32 v7, 0, v6
  v_cvt_f32_u32 v7, v7
  v_cvt_pk_bf16_f32 v8, v7, v7
  v_and_b32 v7, 0xffff0000, v8
  v_lshrrev_b32 v8, 23, v7
  v_subrev_u32 v8, 134, v8
  v_max_i32 v8, 0, v8
  v_cvt_u32_f32 v7, v7
  v_lshrrev_b32 v7, v8, v7
  v_lshl_add_u32 v7, v8, 8, v7
  v_lshl_add_u32 v217, v7, 2, s18
  v_subrev_u32 v6, 18, v5
  v_max_i32 v7, 0, v6
  v_cvt_f32_u32 v7, v7
  v_cvt_pk_bf16_f32 v8, v7, v7
  v_and_b32 v7, 0xffff0000, v8
  v_lshrrev_b32 v8, 23, v7
  v_subrev_u32 v8, 134, v8
  v_max_i32 v8, 0, v8
  v_cvt_u32_f32 v7, v7
  v_lshrrev_b32 v7, v8, v7
  v_lshl_add_u32 v7, v8, 8, v7
  v_lshl_add_u32 v218, v7, 2, s18
  v_subrev_u32 v6, 19, v5
  v_max_i32 v7, 0, v6
  v_cvt_f32_u32 v7, v7
  v_cvt_pk_bf16_f32 v8, v7, v7
  v_and_b32 v7, 0xffff0000, v8
  v_lshrrev_b32 v8, 23, v7
  v_subrev_u32 v8, 134, v8
  v_max_i32 v8, 0, v8
  v_cvt_u32_f32 v7, v7
  v_lshrrev_b32 v7, v8, v7
  v_lshl_add_u32 v7, v8, 8, v7
  v_lshl_add_u32 v219, v7, 2, s18
  v_subrev_u32 v6, 20, v5
  v_max_i32 v7, 0, v6
  v_cvt_f32_u32 v7, v7
  v_cvt_pk_bf16_f32 v8, v7, v7
  v_and_b32 v7, 0xffff0000, v8
  v_lshrrev_b32 v8, 23, v7
  v_subrev_u32 v8, 134, v8
  v_max_i32 v8, 0, v8
  v_cvt_u32_f32 v7, v7
  v_lshrrev_b32 v7, v8, v7
  v_lshl_add_u32 v7, v8, 8, v7
  v_lshl_add_u32 v220, v7, 2, s18
  v_subrev_u32 v6, 21, v5
  v_max_i32 v7, 0, v6
  v_cvt_f32_u32 v7, v7
  v_cvt_pk_bf16_f32 v8, v7, v7
  v_and_b32 v7, 0xffff0000, v8
  v_lshrrev_b32 v8, 23, v7
  v_subrev_u32 v8, 134, v8
  v_max_i32 v8, 0, v8
  v_cvt_u32_f32 v7, v7
  v_lshrrev_b32 v7, v8, v7
  v_lshl_add_u32 v7, v8, 8, v7
  v_lshl_add_u32 v221, v7, 2, s18
  v_subrev_u32 v6, 22, v5
  v_max_i32 v7, 0, v6
  v_cvt_f32_u32 v7, v7
  v_cvt_pk_bf16_f32 v8, v7, v7
  v_and_b32 v7, 0xffff0000, v8
  v_lshrrev_b32 v8, 23, v7
  v_subrev_u32 v8, 134, v8
  v_max_i32 v8, 0, v8
  v_cvt_u32_f32 v7, v7
  v_lshrrev_b32 v7, v8, v7
  v_lshl_add_u32 v7, v8, 8, v7
  v_lshl_add_u32 v222, v7, 2, s18
  v_subrev_u32 v6, 23, v5
  v_max_i32 v7, 0, v6
  v_cvt_f32_u32 v7, v7
  v_cvt_pk_bf16_f32 v8, v7, v7
  v_and_b32 v7, 0xffff0000, v8
  v_lshrrev_b32 v8, 23, v7
  v_subrev_u32 v8, 134, v8
  v_max_i32 v8, 0, v8
  v_cvt_u32_f32 v7, v7
  v_lshrrev_b32 v7, v8, v7
  v_lshl_add_u32 v7, v8, 8, v7
  v_lshl_add_u32 v223, v7, 2, s18
  v_subrev_u32 v6, 24, v5
  v_max_i32 v7, 0, v6
  v_cvt_f32_u32 v7, v7
  v_cvt_pk_bf16_f32 v8, v7, v7
  v_and_b32 v7, 0xffff0000, v8
  v_lshrrev_b32 v8, 23, v7
  v_subrev_u32 v8, 134, v8
  v_max_i32 v8, 0, v8
  v_cvt_u32_f32 v7, v7
  v_lshrrev_b32 v7, v8, v7
  v_lshl_add_u32 v7, v8, 8, v7
  v_lshl_add_u32 v224, v7, 2, s18
  v_subrev_u32 v6, 25, v5
  v_max_i32 v7, 0, v6
  v_cvt_f32_u32 v7, v7
  v_cvt_pk_bf16_f32 v8, v7, v7
  v_and_b32 v7, 0xffff0000, v8
  v_lshrrev_b32 v8, 23, v7
  v_subrev_u32 v8, 134, v8
  v_max_i32 v8, 0, v8
  v_cvt_u32_f32 v7, v7
  v_lshrrev_b32 v7, v8, v7
  v_lshl_add_u32 v7, v8, 8, v7
  v_lshl_add_u32 v225, v7, 2, s18
  v_subrev_u32 v6, 26, v5
  v_max_i32 v7, 0, v6
  v_cvt_f32_u32 v7, v7
  v_cvt_pk_bf16_f32 v8, v7, v7
  v_and_b32 v7, 0xffff0000, v8
  v_lshrrev_b32 v8, 23, v7
  v_subrev_u32 v8, 134, v8
  v_max_i32 v8, 0, v8
  v_cvt_u32_f32 v7, v7
  v_lshrrev_b32 v7, v8, v7
  v_lshl_add_u32 v7, v8, 8, v7
  v_lshl_add_u32 v226, v7, 2, s18
  v_subrev_u32 v6, 27, v5
  v_max_i32 v7, 0, v6
  v_cvt_f32_u32 v7, v7
  v_cvt_pk_bf16_f32 v8, v7, v7
  v_and_b32 v7, 0xffff0000, v8
  v_lshrrev_b32 v8, 23, v7
  v_subrev_u32 v8, 134, v8
  v_max_i32 v8, 0, v8
  v_cvt_u32_f32 v7, v7
  v_lshrrev_b32 v7, v8, v7
  v_lshl_add_u32 v7, v8, 8, v7
  v_lshl_add_u32 v227, v7, 2, s18
  v_subrev_u32 v6, 28, v5
  v_max_i32 v7, 0, v6
  v_cvt_f32_u32 v7, v7
  v_cvt_pk_bf16_f32 v8, v7, v7
  v_and_b32 v7, 0xffff0000, v8
  v_lshrrev_b32 v8, 23, v7
  v_subrev_u32 v8, 134, v8
  v_max_i32 v8, 0, v8
  v_cvt_u32_f32 v7, v7
  v_lshrrev_b32 v7, v8, v7
  v_lshl_add_u32 v7, v8, 8, v7
  v_lshl_add_u32 v228, v7, 2, s18
  v_subrev_u32 v6, 29, v5
  v_max_i32 v7, 0, v6
  v_cvt_f32_u32 v7, v7
  v_cvt_pk_bf16_f32 v8, v7, v7
  v_and_b32 v7, 0xffff0000, v8
  v_lshrrev_b32 v8, 23, v7
  v_subrev_u32 v8, 134, v8
  v_max_i32 v8, 0, v8
  v_cvt_u32_f32 v7, v7
  v_lshrrev_b32 v7, v8, v7
  v_lshl_add_u32 v7, v8, 8, v7
  v_lshl_add_u32 v229, v7, 2, s18
  v_subrev_u32 v6, 30, v5
  v_max_i32 v7, 0, v6
  v_cvt_f32_u32 v7, v7
  v_cvt_pk_bf16_f32 v8, v7, v7
  v_and_b32 v7, 0xffff0000, v8
  v_lshrrev_b32 v8, 23, v7
  v_subrev_u32 v8, 134, v8
  v_max_i32 v8, 0, v8
  v_cvt_u32_f32 v7, v7
  v_lshrrev_b32 v7, v8, v7
  v_lshl_add_u32 v7, v8, 8, v7
  v_lshl_add_u32 v230, v7, 2, s18
  v_subrev_u32 v6, 31, v5
  v_max_i32 v7, 0, v6
  v_cvt_f32_u32 v7, v7
  v_cvt_pk_bf16_f32 v8, v7, v7
  v_and_b32 v7, 0xffff0000, v8
  v_lshrrev_b32 v8, 23, v7
  v_subrev_u32 v8, 134, v8
  v_max_i32 v8, 0, v8
  v_cvt_u32_f32 v7, v7
  v_lshrrev_b32 v7, v8, v7
  v_lshl_add_u32 v7, v8, 8, v7
  v_lshl_add_u32 v231, v7, 2, s18
  v_subrev_u32 v6, 32, v5
  v_max_i32 v7, 0, v6
  v_cvt_f32_u32 v7, v7
  v_cvt_pk_bf16_f32 v8, v7, v7
  v_and_b32 v7, 0xffff0000, v8
  v_lshrrev_b32 v8, 23, v7
  v_subrev_u32 v8, 134, v8
  v_max_i32 v8, 0, v8
  v_cvt_u32_f32 v7, v7
  v_lshrrev_b32 v7, v8, v7
  v_lshl_add_u32 v7, v8, 8, v7
  v_mov_b32 v8, 1280
  v_cmp_gt_i32 vcc, 0, v6
  s_nop 1
  v_cndmask_b32 v7, v7, v8, vcc
  v_lshl_add_u32 v232, v7, 2, s18
  v_mov_b32 v8, 0
  v_mov_b32 v9, 0
  v_lshlrev_b32 v5, 3, v1
  v_add_u32 v5, s17, v5
  ds_write_b64 v5, v[8:9]
  v_and_b32 v6, 15, v1
  v_lshlrev_b32 v6, 3, v6
  v_add_u32 v6, s17, v6
  ds_write_b64 v6, v[8:9] offset:8704
  ds_write_b64 v6, v[8:9] offset:12928
  v_mov_b32 v6, s17
  ds_write_b64 v6, v[8:9] offset:18176
  s_lshl_b32 s19, s3, 2
  s_add_u32 s20, s19, s16
  s_lshl_b32 s21, s3, 3
  v_mul_u32_u24 v5, 3584, v0
  v_mul_u32_u24 v141, 1792, v0
  s_lshl_b32 s22, s20, 9
  v_lshlrev_b32 v6, 3, v1
  buffer_load_dwordx2 v[24:25], v6, s[64:67], s22 offen
  buffer_load_dwordx2 v[26:27], v6, s[68:71], s22 offen
  buffer_load_dwordx2 v[28:29], v6, s[72:75], s22 offen
  buffer_load_dwordx2 v[30:31], v6, s[76:79], s22 offen
  s_lshl_b32 s22, s20, 1
  v_mov_b32 v7, 0
  buffer_load_ushort v32, v7, s[80:83], s22 offen
  buffer_load_ushort v33, v7, s[84:87], s22 offen
  s_mov_b32 s24, 0x05040100
  s_mov_b32 s25, 0x07060302
  s_barrier
  s_waitcnt vmcnt(0)
  s_mov_b32 s26, 1069066811
  s_mov_b32 s27, 1042479491
  v_lshlrev_b32 v32, 16, v32
  v_lshlrev_b32 v33, 16, v33
  v_mul_f32 v32, s26, v32
  v_exp_f32 v32, v32
  s_nop 0
  v_cvt_pk_bf16_f32 v34, v32, v32
  v_and_b32 v32, 0xffff0000, v34
  v_lshlrev_b32 v37, 6, v1
  v_add_u32 v37, s17, v37
  v_lshlrev_b32 v40, 16, v24
  v_lshlrev_b32 v41, 16, v26
  v_lshlrev_b32 v42, 16, v28
  v_lshlrev_b32 v43, 16, v30
  v_mul_f32 v40, s26, v40
  v_exp_f32 v40, v40
  s_nop 0
  v_cvt_pk_bf16_f32 v34, v40, v40
  v_and_b32 v40, 0xffff0000, v34
  v_mul_f32 v40, v40, v32
  v_mul_f32 v40, s26, v40
  v_sub_f32 v40, 0, v40
  v_mul_f32 v41, v41, v32
  v_mul_f32 v41, s27, v41
  v_mul_f32 v42, v42, v32
  v_mul_f32 v43, v43, v32
  v_add_f32 v42, v42, v42
  v_add_f32 v43, v43, v43
  ds_write_b128 v37, v[40:43] offset:18240
  v_and_b32 v40, 0xffff0000, v24
  v_and_b32 v41, 0xffff0000, v26
  v_and_b32 v42, 0xffff0000, v28
  v_and_b32 v43, 0xffff0000, v30
  v_mul_f32 v40, s26, v40
  v_exp_f32 v40, v40
  s_nop 0
  v_cvt_pk_bf16_f32 v34, v40, v40
  v_and_b32 v40, 0xffff0000, v34
  v_mul_f32 v40, v40, v32
  v_mul_f32 v40, s26, v40
  v_sub_f32 v40, 0, v40
  v_mul_f32 v41, v41, v32
  v_mul_f32 v41, s27, v41
  v_mul_f32 v42, v42, v32
  v_mul_f32 v43, v43, v32
  v_add_f32 v42, v42, v42
  v_add_f32 v43, v43, v43
  ds_write_b128 v37, v[40:43] offset:18256
  v_lshlrev_b32 v40, 16, v25
  v_lshlrev_b32 v41, 16, v27
  v_lshlrev_b32 v42, 16, v29
  v_lshlrev_b32 v43, 16, v31
  v_mul_f32 v40, s26, v40
  v_exp_f32 v40, v40
  s_nop 0
  v_cvt_pk_bf16_f32 v34, v40, v40
  v_and_b32 v40, 0xffff0000, v34
  v_mul_f32 v40, v40, v32
  v_mul_f32 v40, s26, v40
  v_sub_f32 v40, 0, v40
  v_mul_f32 v41, v41, v32
  v_mul_f32 v41, s27, v41
  v_mul_f32 v42, v42, v32
  v_mul_f32 v43, v43, v32
  v_add_f32 v42, v42, v42
  v_add_f32 v43, v43, v43
  ds_write_b128 v37, v[40:43] offset:18272
  v_and_b32 v40, 0xffff0000, v25
  v_and_b32 v41, 0xffff0000, v27
  v_and_b32 v42, 0xffff0000, v29
  v_and_b32 v43, 0xffff0000, v31
  v_mul_f32 v40, s26, v40
  v_exp_f32 v40, v40
  s_nop 0
  v_cvt_pk_bf16_f32 v34, v40, v40
  v_and_b32 v40, 0xffff0000, v34
  v_mul_f32 v40, v40, v32
  v_mul_f32 v40, s26, v40
  v_sub_f32 v40, 0, v40
  v_mul_f32 v41, v41, v32
  v_mul_f32 v41, s27, v41
  v_mul_f32 v42, v42, v32
  v_mul_f32 v43, v43, v32
  v_add_f32 v42, v42, v42
  v_add_f32 v43, v43, v43
  ds_write_b128 v37, v[40:43] offset:18288
  v_cvt_f32_u32 v44, v4
  v_lshlrev_b32 v45, 4, v4
  v_cvt_f32_u32 v45, v45
  v_lshlrev_b32 v46, 4, v3
  v_add_u32 v46, s17, v46
  v_mov_b32 v48, 0
  v_mov_b32 v49, 0
  v_mov_b32 v50, 0
  v_mov_b32 v51, 0
  v_mov_b32 v52, 0
  v_mov_b32 v53, 0
  v_mov_b32 v54, 0
  v_mov_b32 v55, 0
  v_mov_b32 v56, 0
  v_mov_b32 v57, 0
  v_mov_b32 v58, 0
  v_mov_b32 v59, 0
  v_mov_b32 v60, 0
  v_mov_b32 v61, 0
  v_mov_b32 v62, 0
  v_mov_b32 v63, 0
  v_mov_b32 v64, 0
  v_mov_b32 v65, 0
  v_mov_b32 v66, 0
  v_mov_b32 v67, 0
  s_waitcnt lgkmcnt(0)
  ds_read_b128 v[68:71], v46 offset:18240
  s_add_u32 s22, s21, 0
  buffer_load_dwordx2 v[8:9], v5, s[60:63], s22 offen offset:0
  s_mov_b32 s28, 0
  s_call_b64 s[30:31], wk_kl
  s_mov_b32 s28, 0
  s_call_b64 s[30:31], wk_kl
  s_add_u32 s22, s21, 0
  buffer_load_dwordx2 v[10:11], v5, s[60:63], s22 offen offset:896
  s_mov_b32 s28, 0
  s_call_b64 s[30:31], wk_kl
  s_mov_b32 s28, 0
  s_call_b64 s[30:31], wk_kl
  s_add_u32 s22, s21, 0
  buffer_load_dwordx2 v[12:13], v5, s[60:63], s22 offen offset:1792
  s_mov_b32 s28, 0
  s_call_b64 s[30:31], wk_kl
  s_mov_b32 s28, 0
  s_call_b64 s[30:31], wk_kl
  s_add_u32 s22, s21, 0
  buffer_load_dwordx2 v[14:15], v5, s[60:63], s22 offen offset:2688
  s_mov_b32 s28, 0
  s_call_b64 s[30:31], wk_kl
  s_mov_b32 s28, 0
  s_call_b64 s[30:31], wk_kl
  s_add_u32 s22, s21, 917504
  buffer_load_dwordx2 v[16:17], v5, s[60:63], s22 offen offset:0
  s_mov_b32 s28, 0
  s_call_b64 s[30:31], wk_kl
  s_mov_b32 s28, 0
  s_call_b64 s[30:31], wk_kl
  s_add_u32 s22, s21, 917504
  buffer_load_dwordx2 v[18:19], v5, s[60:63], s22 offen offset:896
  s_mov_b32 s28, 0
  s_call_b64 s[30:31], wk_kl
  s_mov_b32 s28, 0
  s_call_b64 s[30:31], wk_kl
  s_add_u32 s22, s21, 917504
  buffer_load_dwordx2 v[20:21], v5, s[60:63], s22 offen offset:1792
  s_mov_b32 s28, 0
  s_call_b64 s[30:31], wk_kl
  s_mov_b32 s28, 0
  s_call_b64 s[30:31], wk_kl
  s_add_u32 s22, s21, 917504
  buffer_load_dwordx2 v[22:23], v5, s[60:63], s22 offen offset:2688
  s_mov_b32 s28, 0
  s_call_b64 s[30:31], wk_kl
  s_mov_b32 s28, 0
  s_call_b64 s[30:31], wk_kl
  s_branch wk_kd
wk_kl:
  s_waitcnt lgkmcnt(0)
  v_mov_b32 v72, v68
  v_mov_b32 v73, v69
  v_mov_b32 v74, v70
  v_mov_b32 v75, v71
  v_add_u32 v46, 64, v46
  ds_read_b128 v[68:71], v46 offset:18240
  v_mul_f32 v80, v72, v45
  v_mul_f32 v81, v73, v45
  v_exp_f32 v80, v80
  v_fract_f32 v81, v81
  v_cos_f32 v76, v81
  v_sin_f32 v77, v81
  v_mul_f32 v76, v76, v80
  v_mul_f32 v77, v77, v80
  v_mul_f32 v80, v72, v44
  v_mul_f32 v81, v73, v44
  v_exp_f32 v80, v80
  v_fract_f32 v81, v81
  v_cos_f32 v78, v81
  v_sin_f32 v79, v81
  v_mul_f32 v78, v78, v80
  v_mul_f32 v79, v79, v80
  v_mul_f32 v82, v74, v76
  v_mul_f32 v83, v74, v77
  v_fma_f32 v82, -v75, v77, v82
  v_fma_f32 v83, -v75, v76, -v83
  v_mul_f32 v86, v76, v76
  v_mul_f32 v87, v76, v77
  v_fma_f32 v86, -v77, v77, v86
  v_add_f32 v87, v87, v87
  v_mfma_f32_16x16x4_f32 v[48:51], v82, v78, v[48:51]
  v_mul_f32 v88, v78, v78
  v_mul_f32 v89, v78, v79
  v_fma_f32 v88, -v79, v79, v88
  v_add_f32 v89, v89, v89
  v_mfma_f32_16x16x4_f32 v[48:51], v83, v79, v[48:51]
  v_mul_f32 v84, v74, v86
  v_mul_f32 v85, v74, v87
  v_fma_f32 v84, -v75, v87, v84
  v_fma_f32 v85, -v75, v86, -v85
  v_mul_f32 v76, v86, v86
  v_mul_f32 v77, v86, v87
  v_fma_f32 v76, -v87, v87, v76
  v_add_f32 v77, v77, v77
  v_mfma_f32_16x16x4_f32 v[52:55], v84, v88, v[52:55]
  v_mul_f32 v78, v88, v88
  v_mul_f32 v79, v88, v89
  v_fma_f32 v78, -v89, v89, v78
  v_add_f32 v79, v79, v79
  v_mfma_f32_16x16x4_f32 v[52:55], v85, v89, v[52:55]
  v_mul_f32 v82, v74, v76
  v_mul_f32 v83, v74, v77
  v_fma_f32 v82, -v75, v77, v82
  v_fma_f32 v83, -v75, v76, -v83
  v_mul_f32 v86, v76, v76
  v_mul_f32 v87, v76, v77
  v_fma_f32 v86, -v77, v77, v86
  v_add_f32 v87, v87, v87
  v_mfma_f32_16x16x4_f32 v[56:59], v82, v78, v[56:59]
  v_mul_f32 v88, v78, v78
  v_mul_f32 v89, v78, v79
  v_fma_f32 v88, -v79, v79, v88
  v_add_f32 v89, v89, v89
  v_mfma_f32_16x16x4_f32 v[56:59], v83, v79, v[56:59]
  v_mul_f32 v84, v74, v86
  v_mul_f32 v85, v74, v87
  v_fma_f32 v84, -v75, v87, v84
  v_fma_f32 v85, -v75, v86, -v85
  v_mul_f32 v76, v86, v86
  v_mul_f32 v77, v86, v87
  v_fma_f32 v76, -v87, v87, v76
  v_add_f32 v77, v77, v77
  v_mfma_f32_16x16x4_f32 v[60:63], v84, v88, v[60:63]
  v_mfma_f32_16x16x4_f32 v[60:63], v85, v89, v[60:63]
  v_mul_f32 v82, v74, v76
  v_fma_f32 v82, -v75, v77, v82
  s_nop 1
  v_mfma_f32_16x16x4_f32 v[64:67], v82, v88, v[64:67]
  s_add_u32 s28, s28, 1
  s_cmp_lt_u32 s28, 4
  s_cbranch_scc1 wk_kl
  s_setpc_b64 s[30:31]
wk_kd:
  s_nop 15
  s_nop 3
  s_waitcnt vmcnt(0)
  v_lshlrev_b32 v6, 3, v0
  v_perm_b32 v34, v10, v8, s24
  v_perm_b32 v35, v14, v12, s24
  v_add_u32 v36, 512, v6
  ds_write_b64 v36, v[34:35]
  v_perm_b32 v34, v10, v8, s25
  v_perm_b32 v35, v14, v12, s25
  v_add_u32 v36, 25088, v6
  ds_write_b64 v36, v[34:35]
  v_perm_b32 v34, v11, v9, s24
  v_perm_b32 v35, v15, v13, s24
  v_add_u32 v36, 49664, v6
  ds_write_b64 v36, v[34:35]
  v_perm_b32 v34, v11, v9, s25
  v_perm_b32 v35, v15, v13, s25
  v_add_u32 v36, 74240, v6
  ds_write_b64 v36, v[34:35]
  v_perm_b32 v34, v18, v16, s24
  v_perm_b32 v35, v22, v20, s24
  v_add_u32 v36, 2560, v6
  ds_write_b64 v36, v[34:35]
  v_perm_b32 v34, v18, v16, s25
  v_perm_b32 v35, v22, v20, s25
  v_add_u32 v36, 27136, v6
  ds_write_b64 v36, v[34:35]
  v_perm_b32 v34, v19, v17, s24
  v_perm_b32 v35, v23, v21, s24
  v_add_u32 v36, 51712, v6
  ds_write_b64 v36, v[34:35]
  v_perm_b32 v34, v19, v17, s25
  v_perm_b32 v35, v23, v21, s25
  v_add_u32 v36, 76288, v6
  ds_write_b64 v36, v[34:35]
  v_lshlrev_b32 v46, 8, v3
  v_lshl_add_u32 v46, v4, 2, v46
  v_add_u32 v46, s17, v46
  ds_write_b32 v46, v48 offset:13056
  ds_write_b32 v46, v49 offset:13120
  ds_write_b32 v46, v50 offset:13184
  ds_write_b32 v46, v51 offset:13248
  s_waitcnt lgkmcnt(8)
  ds_write_b32 v46, v52 offset:14080
  ds_write_b32 v46, v53 offset:14144
  ds_write_b32 v46, v54 offset:14208
  ds_write_b32 v46, v55 offset:14272
  s_waitcnt lgkmcnt(8)
  ds_write_b32 v46, v56 offset:15104
  ds_write_b32 v46, v57 offset:15168
  ds_write_b32 v46, v58 offset:15232
  ds_write_b32 v46, v59 offset:15296
  s_waitcnt lgkmcnt(8)
  ds_write_b32 v46, v60 offset:16128
  ds_write_b32 v46, v61 offset:16192
  ds_write_b32 v46, v62 offset:16256
  ds_write_b32 v46, v63 offset:16320
  s_waitcnt lgkmcnt(8)
  ds_write_b32 v46, v64 offset:17152
  ds_write_b32 v46, v65 offset:17216
  ds_write_b32 v46, v66 offset:17280
  ds_write_b32 v46, v67 offset:17344
  s_waitcnt lgkmcnt(8)
  s_waitcnt lgkmcnt(0)
  ds_read_b32 v48, v200
  ds_read_b32 v49, v201
  ds_read_b32 v50, v202
  ds_read_b32 v51, v203
  ds_read_b32 v52, v204
  ds_read_b32 v53, v205
  ds_read_b32 v54, v206
  ds_read_b32 v55, v207
  s_waitcnt lgkmcnt(4)
  ds_read_b32 v56, v208
  ds_read_b32 v57, v209
  ds_read_b32 v58, v210
  ds_read_b32 v59, v211
  ds_read_b32 v60, v212
  ds_read_b32 v61, v213
  ds_read_b32 v62, v214
  ds_read_b32 v63, v215
  s_waitcnt lgkmcnt(4)
  ds_read_b32 v64, v216
  ds_read_b32 v65, v217
  ds_read_b32 v66, v218
  ds_read_b32 v67, v219
  ds_read_b32 v68, v220
  ds_read_b32 v69, v221
  ds_read_b32 v70, v222
  ds_read_b32 v71, v223
  s_waitcnt lgkmcnt(4)
  ds_read_b32 v72, v224
  ds_read_b32 v73, v225
  ds_read_b32 v74, v226
  ds_read_b32 v75, v227
  ds_read_b32 v76, v228
  ds_read_b32 v77, v229
  ds_read_b32 v78, v230
  ds_read_b32 v79, v231
  s_waitcnt lgkmcnt(4)
  ds_read_b32 v80, v232
  s_waitcnt lgkmcnt(0)
  v_lshlrev_b32 v46, 6, v1
  v_add_u32 v46, s17, v46
  v_cvt_pk_bf16_f32 v84, v48, v49
  v_cvt_pk_bf16_f32 v88, v49, v50
  v_cvt_pk_bf16_f32 v85, v50, v51
  v_cvt_pk_bf16_f32 v89, v51, v52
  v_cvt_pk_bf16_f32 v86, v52, v53
  v_cvt_pk_bf16_f32 v90, v53, v54
  v_cvt_pk_bf16_f32 v87, v54, v55
  v_cvt_pk_bf16_f32 v91, v55, v56
  ds_write_b128 v46, v[84:87] offset:4608
  ds_write_b128 v46, v[88:91] offset:8832
  s_waitcnt lgkmcnt(0)
  v_cvt_pk_bf16_f32 v84, v56, v57
  v_cvt_pk_bf16_f32 v88, v57, v58
  v_cvt_pk_bf16_f32 v85, v58, v59
  v_cvt_pk_bf16_f32 v89, v59, v60
  v_cvt_pk_bf16_f32 v86, v60, v61
  v_cvt_pk_bf16_f32 v90, v61, v62
  v_cvt_pk_bf16_f32 v87, v62, v63
  v_cvt_pk_bf16_f32 v91, v63, v64
  ds_write_b128 v46, v[84:87] offset:4624
  ds_write_b128 v46, v[88:91] offset:8848
  s_waitcnt lgkmcnt(0)
  v_cvt_pk_bf16_f32 v84, v64, v65
  v_cvt_pk_bf16_f32 v88, v65, v66
  v_cvt_pk_bf16_f32 v85, v66, v67
  v_cvt_pk_bf16_f32 v89, v67, v68
  v_cvt_pk_bf16_f32 v86, v68, v69
  v_cvt_pk_bf16_f32 v90, v69, v70
  v_cvt_pk_bf16_f32 v87, v70, v71
  v_cvt_pk_bf16_f32 v91, v71, v72
  ds_write_b128 v46, v[84:87] offset:4640
  ds_write_b128 v46, v[88:91] offset:8864
  s_waitcnt lgkmcnt(0)
  v_cvt_pk_bf16_f32 v84, v72, v73
  v_cvt_pk_bf16_f32 v88, v73, v74
  v_cvt_pk_bf16_f32 v85, v74, v75
  v_cvt_pk_bf16_f32 v89, v75, v76
  v_cvt_pk_bf16_f32 v86, v76, v77
  v_cvt_pk_bf16_f32 v90, v77, v78
  v_cvt_pk_bf16_f32 v87, v78, v79
  v_cvt_pk_bf16_f32 v91, v79, v80
  ds_write_b128 v46, v[84:87] offset:4656
  ds_write_b128 v46, v[88:91] offset:8880
  s_waitcnt lgkmcnt(0)
  s_barrier
  v_lshrrev_b32 v47, 1, v3
  v_sub_u32 v46, v4, v47
  v_add_u32 v46, 1, v46
  v_lshlrev_b32 v46, 5, v46
  v_and_b32 v48, 1, v3
  v_lshl_add_u32 v46, v48, 4, v46
  v_add_u32 v46, s17, v46
  ds_read_b128 a[0:3], v46 offset:32
  ds_read_b128 a[4:7], v46 offset:96
  ds_read_b128 a[8:11], v46 offset:160
  ds_read_b128 a[12:15], v46 offset:224
  ds_read_b128 a[16:19], v46 offset:288
  ds_read_b128 a[20:23], v46 offset:352
  ds_read_b128 a[24:27], v46 offset:416
  ds_read_b128 a[28:31], v46 offset:480
  s_waitcnt lgkmcnt(4)
  ds_read_b128 a[32:35], v46 offset:544
  ds_read_b128 a[36:39], v46 offset:608
  ds_read_b128 a[40:43], v46 offset:672
  ds_read_b128 a[44:47], v46 offset:736
  ds_read_b128 a[48:51], v46 offset:800
  ds_read_b128 a[52:55], v46 offset:864
  ds_read_b128 a[56:59], v46 offset:928
  ds_read_b128 a[60:63], v46 offset:992
  s_waitcnt lgkmcnt(4)
  ds_read_b128 a[64:67], v46 offset:1056
  ds_read_b128 a[68:71], v46 offset:1120
  ds_read_b128 a[72:75], v46 offset:1184
  ds_read_b128 a[76:79], v46 offset:1248
  ds_read_b128 a[80:83], v46 offset:1312
  ds_read_b128 a[84:87], v46 offset:1376
  ds_read_b128 a[88:91], v46 offset:1440
  ds_read_b128 a[92:95], v46 offset:1504
  s_waitcnt lgkmcnt(4)
  ds_read_b128 a[96:99], v46 offset:1568
  ds_read_b128 a[100:103], v46 offset:1632
  ds_read_b128 a[104:107], v46 offset:1696
  ds_read_b128 a[108:111], v46 offset:1760
  ds_read_b128 a[112:115], v46 offset:1824
  ds_read_b128 a[116:119], v46 offset:1888
  ds_read_b128 a[120:123], v46 offset:1952
  ds_read_b128 a[124:127], v46 offset:2016
  s_waitcnt lgkmcnt(4)
  ds_read_b128 a[128:131], v46 offset:2080
  ds_read_b128 a[132:135], v46 offset:2144
  ds_read_b128 a[136:139], v46 offset:2208
  ds_read_b128 a[140:143], v46 offset:2272
  ds_read_b128 a[144:147], v46 offset:2336
  ds_read_b128 a[148:151], v46 offset:2400
  ds_read_b128 a[152:155], v46 offset:2464
  ds_read_b128 a[156:159], v46 offset:2528
  s_waitcnt lgkmcnt(4)
  ds_read_b128 a[160:163], v46 offset:2592
  ds_read_b128 a[164:167], v46 offset:2656
  ds_read_b128 a[168:171], v46 offset:2720
  ds_read_b128 a[172:175], v46 offset:2784
  ds_read_b128 a[176:179], v46 offset:2848
  ds_read_b128 a[180:183], v46 offset:2912
  ds_read_b128 a[184:187], v46 offset:2976
  ds_read_b128 a[188:191], v46 offset:3040
  s_waitcnt lgkmcnt(4)
  ds_read_b128 a[192:195], v46 offset:3104
  ds_read_b128 a[196:199], v46 offset:3168
  ds_read_b128 a[200:203], v46 offset:3232
  ds_read_b128 a[204:207], v46 offset:3296
  ds_read_b128 a[208:211], v46 offset:3360
  ds_read_b128 a[212:215], v46 offset:3424
  ds_read_b128 a[216:219], v46 offset:3488
  ds_read_b128 a[220:223], v46 offset:3552
  s_waitcnt lgkmcnt(4)
  ds_read_b128 a[224:227], v46 offset:3616
  ds_read_b128 a[228:231], v46 offset:3680
  ds_read_b128 a[232:235], v46 offset:3744
  ds_read_b128 a[236:239], v46 offset:3808
  ds_read_b128 a[240:243], v46 offset:3872
  ds_read_b128 a[244:247], v46 offset:3936
  ds_read_b128 a[248:251], v46 offset:4000
  ds_read_b128 a[252:255], v46 offset:4064
  s_waitcnt lgkmcnt(4)
  v_lshlrev_b32 v49, 4, v47
  v_add_u32 v49, v49, v4
  v_sub_u32 v49, 2047, v49
  v_lshl_add_u32 v49, v48, 3, v49
  v_and_b32 v50, 1, v49
  v_lshrrev_b32 v49, 1, v49
  v_lshlrev_b32 v49, 2, v49
  v_mul_u32_u24 v50, 4224, v50
  v_add3_u32 v49, v49, v50, s17
  v_add_u32 v49, 4608, v49
  v_subrev_u32 v52, 896, v49
  v_subrev_u32 v53, 1856, v49
  v_subrev_u32 v54, 2816, v49
  v_subrev_u32 v55, 3776, v49
  v_subrev_u32 v56, 4736, v49
  s_waitcnt lgkmcnt(0)
  ds_read2_b32 v[92:93], v52 offset0:224 offset1:225
  ds_read2_b32 v[94:95], v52 offset0:226 offset1:227
  ds_read2_b32 v[96:97], v52 offset0:208 offset1:209
  ds_read2_b32 v[98:99], v52 offset0:210 offset1:211
  ds_read2_b32 v[100:101], v52 offset0:192 offset1:193
  ds_read2_b32 v[102:103], v52 offset0:194 offset1:195
  ds_read2_b32 v[104:105], v52 offset0:176 offset1:177
  ds_read2_b32 v[106:107], v52 offset0:178 offset1:179
  s_waitcnt lgkmcnt(6)
  v_mfma_f32_16x16x32_bf16 v[60:63], v[92:95], a[28:31], 0
  v_mfma_f32_16x16x32_bf16 v[64:67], v[92:95], a[60:63], 0
  v_mfma_f32_16x16x32_bf16 v[68:71], v[92:95], a[92:95], 0
  v_mfma_f32_16x16x32_bf16 v[72:75], v[92:95], a[124:127], 0
  v_mfma_f32_16x16x32_bf16 v[76:79], v[92:95], a[156:159], 0
  v_mfma_f32_16x16x32_bf16 v[80:83], v[92:95], a[188:191], 0
  v_mfma_f32_16x16x32_bf16 v[84:87], v[92:95], a[220:223], 0
  v_mfma_f32_16x16x32_bf16 v[88:91], v[92:95], a[252:255], 0
  ds_read2_b32 v[92:93], v52 offset0:160 offset1:161
  ds_read2_b32 v[94:95], v52 offset0:162 offset1:163
  s_waitcnt lgkmcnt(6)
  v_mfma_f32_16x16x32_bf16 v[60:63], v[96:99], a[24:27], v[60:63]
  v_mfma_f32_16x16x32_bf16 v[64:67], v[96:99], a[56:59], v[64:67]
  v_mfma_f32_16x16x32_bf16 v[68:71], v[96:99], a[88:91], v[68:71]
  v_mfma_f32_16x16x32_bf16 v[72:75], v[96:99], a[120:123], v[72:75]
  v_mfma_f32_16x16x32_bf16 v[76:79], v[96:99], a[152:155], v[76:79]
  v_mfma_f32_16x16x32_bf16 v[80:83], v[96:99], a[184:187], v[80:83]
  v_mfma_f32_16x16x32_bf16 v[84:87], v[96:99], a[216:219], v[84:87]
  v_mfma_f32_16x16x32_bf16 v[88:91], v[96:99], a[248:251], v[88:91]
  ds_read2_b32 v[96:97], v52 offset0:144 offset1:145
  ds_read2_b32 v[98:99], v52 offset0:146 offset1:147
  s_waitcnt lgkmcnt(6)
  v_mfma_f32_16x16x32_bf16 v[60:63], v[100:103], a[20:23], v[60:63]
  v_mfma_f32_16x16x32_bf16 v[64:67], v[100:103], a[52:55], v[64:67]
  v_mfma_f32_16x16x32_bf16 v[68:71], v[100:103], a[84:87], v[68:71]
  v_mfma_f32_16x16x32_bf16 v[72:75], v[100:103], a[116:119], v[72:75]
  v_mfma_f32_16x16x32_bf16 v[76:79], v[100:103], a[148:151], v[76:79]
  v_mfma_f32_16x16x32_bf16 v[80:83], v[100:103], a[180:183], v[80:83]
  v_mfma_f32_16x16x32_bf16 v[84:87], v[100:103], a[212:215], v[84:87]
  v_mfma_f32_16x16x32_bf16 v[88:91], v[100:103], a[244:247], v[88:91]
  ds_read2_b32 v[100:101], v52 offset0:128 offset1:129
  ds_read2_b32 v[102:103], v52 offset0:130 offset1:131
  s_waitcnt lgkmcnt(6)
  v_mfma_f32_16x16x32_bf16 v[60:63], v[104:107], a[16:19], v[60:63]
  v_mfma_f32_16x16x32_bf16 v[64:67], v[104:107], a[48:51], v[64:67]
  v_mfma_f32_16x16x32_bf16 v[68:71], v[104:107], a[80:83], v[68:71]
  v_mfma_f32_16x16x32_bf16 v[72:75], v[104:107], a[112:115], v[72:75]
  v_mfma_f32_16x16x32_bf16 v[76:79], v[104:107], a[144:147], v[76:79]
  v_mfma_f32_16x16x32_bf16 v[80:83], v[104:107], a[176:179], v[80:83]
  v_mfma_f32_16x16x32_bf16 v[84:87], v[104:107], a[208:211], v[84:87]
  v_mfma_f32_16x16x32_bf16 v[88:91], v[104:107], a[240:243], v[88:91]
  ds_read2_b32 v[104:105], v52 offset0:112 offset1:113
  ds_read2_b32 v[106:107], v52 offset0:114 offset1:115
  s_waitcnt lgkmcnt(6)
  v_mfma_f32_16x16x32_bf16 v[60:63], v[92:95], a[12:15], v[60:63]
  v_mfma_f32_16x16x32_bf16 v[64:67], v[92:95], a[44:47], v[64:67]
  v_mfma_f32_16x16x32_bf16 v[68:71], v[92:95], a[76:79], v[68:71]
  v_mfma_f32_16x16x32_bf16 v[72:75], v[92:95], a[108:111], v[72:75]
  v_mfma_f32_16x16x32_bf16 v[76:79], v[92:95], a[140:143], v[76:79]
  v_mfma_f32_16x16x32_bf16 v[80:83], v[92:95], a[172:175], v[80:83]
  v_mfma_f32_16x16x32_bf16 v[84:87], v[92:95], a[204:207], v[84:87]
  v_mfma_f32_16x16x32_bf16 v[88:91], v[92:95], a[236:239], v[88:91]
  ds_read2_b32 v[92:93], v52 offset0:96 offset1:97
  ds_read2_b32 v[94:95], v52 offset0:98 offset1:99
  s_waitcnt lgkmcnt(6)
  v_mfma_f32_16x16x32_bf16 v[60:63], v[96:99], a[8:11], v[60:63]
  v_mfma_f32_16x16x32_bf16 v[64:67], v[96:99], a[40:43], v[64:67]
  v_mfma_f32_16x16x32_bf16 v[68:71], v[96:99], a[72:75], v[68:71]
  v_mfma_f32_16x16x32_bf16 v[72:75], v[96:99], a[104:107], v[72:75]
  v_mfma_f32_16x16x32_bf16 v[76:79], v[96:99], a[136:139], v[76:79]
  v_mfma_f32_16x16x32_bf16 v[80:83], v[96:99], a[168:171], v[80:83]
  v_mfma_f32_16x16x32_bf16 v[84:87], v[96:99], a[200:203], v[84:87]
  v_mfma_f32_16x16x32_bf16 v[88:91], v[96:99], a[232:235], v[88:91]
  ds_read2_b32 v[96:97], v52 offset0:80 offset1:81
  ds_read2_b32 v[98:99], v52 offset0:82 offset1:83
  s_waitcnt lgkmcnt(6)
  v_mfma_f32_16x16x32_bf16 v[60:63], v[100:103], a[4:7], v[60:63]
  v_mfma_f32_16x16x32_bf16 v[64:67], v[100:103], a[36:39], v[64:67]
  v_mfma_f32_16x16x32_bf16 v[68:71], v[100:103], a[68:71], v[68:71]
  v_mfma_f32_16x16x32_bf16 v[72:75], v[100:103], a[100:103], v[72:75]
  v_mfma_f32_16x16x32_bf16 v[76:79], v[100:103], a[132:135], v[76:79]
  v_mfma_f32_16x16x32_bf16 v[80:83], v[100:103], a[164:167], v[80:83]
  v_mfma_f32_16x16x32_bf16 v[84:87], v[100:103], a[196:199], v[84:87]
  v_mfma_f32_16x16x32_bf16 v[88:91], v[100:103], a[228:231], v[88:91]
  ds_read2_b32 v[100:101], v52 offset0:64 offset1:65
  ds_read2_b32 v[102:103], v52 offset0:66 offset1:67
  s_waitcnt lgkmcnt(6)
  v_mfma_f32_16x16x32_bf16 v[60:63], v[104:107], a[0:3], v[60:63]
  v_mfma_f32_16x16x32_bf16 v[64:67], v[104:107], a[32:35], v[64:67]
  v_mfma_f32_16x16x32_bf16 v[68:71], v[104:107], a[64:67], v[68:71]
  v_mfma_f32_16x16x32_bf16 v[72:75], v[104:107], a[96:99], v[72:75]
  v_mfma_f32_16x16x32_bf16 v[76:79], v[104:107], a[128:131], v[76:79]
  v_mfma_f32_16x16x32_bf16 v[80:83], v[104:107], a[160:163], v[80:83]
  v_mfma_f32_16x16x32_bf16 v[84:87], v[104:107], a[192:195], v[84:87]
  v_mfma_f32_16x16x32_bf16 v[88:91], v[104:107], a[224:227], v[88:91]
  ds_read2_b32 v[104:105], v52 offset0:48 offset1:49
  ds_read2_b32 v[106:107], v52 offset0:50 offset1:51
  s_waitcnt lgkmcnt(6)
  v_mfma_f32_16x16x32_bf16 v[64:67], v[92:95], a[28:31], v[64:67]
  v_mfma_f32_16x16x32_bf16 v[68:71], v[92:95], a[60:63], v[68:71]
  v_mfma_f32_16x16x32_bf16 v[72:75], v[92:95], a[92:95], v[72:75]
  v_mfma_f32_16x16x32_bf16 v[76:79], v[92:95], a[124:127], v[76:79]
  v_mfma_f32_16x16x32_bf16 v[80:83], v[92:95], a[156:159], v[80:83]
  v_mfma_f32_16x16x32_bf16 v[84:87], v[92:95], a[188:191], v[84:87]
  v_mfma_f32_16x16x32_bf16 v[88:91], v[92:95], a[220:223], v[88:91]
  ds_read2_b32 v[92:93], v52 offset0:32 offset1:33
  ds_read2_b32 v[94:95], v52 offset0:34 offset1:35
  s_waitcnt lgkmcnt(6)
  v_mfma_f32_16x16x32_bf16 v[64:67], v[96:99], a[24:27], v[64:67]
  v_mfma_f32_16x16x32_bf16 v[68:71], v[96:99], a[56:59], v[68:71]
  v_mfma_f32_16x16x32_bf16 v[72:75], v[96:99], a[88:91], v[72:75]
  v_mfma_f32_16x16x32_bf16 v[76:79], v[96:99], a[120:123], v[76:79]
  v_mfma_f32_16x16x32_bf16 v[80:83], v[96:99], a[152:155], v[80:83]
  v_mfma_f32_16x16x32_bf16 v[84:87], v[96:99], a[184:187], v[84:87]
  v_mfma_f32_16x16x32_bf16 v[88:91], v[96:99], a[216:219], v[88:91]
  ds_read2_b32 v[96:97], v52 offset0:16 offset1:17
  ds_read2_b32 v[98:99], v52 offset0:18 offset1:19
  s_waitcnt lgkmcnt(6)
  v_mfma_f32_16x16x32_bf16 v[64:67], v[100:103], a[20:23], v[64:67]
  v_mfma_f32_16x16x32_bf16 v[68:71], v[100:103], a[52:55], v[68:71]
  v_mfma_f32_16x16x32_bf16 v[72:75], v[100:103], a[84:87], v[72:75]
  v_mfma_f32_16x16x32_bf16 v[76:79], v[100:103], a[116:119], v[76:79]
  v_mfma_f32_16x16x32_bf16 v[80:83], v[100:103], a[148:151], v[80:83]
  v_mfma_f32_16x16x32_bf16 v[84:87], v[100:103], a[180:183], v[84:87]
  v_mfma_f32_16x16x32_bf16 v[88:91], v[100:103], a[212:215], v[88:91]
  ds_read2_b32 v[100:101], v52 offset0:0 offset1:1
  ds_read2_b32 v[102:103], v52 offset0:2 offset1:3
  s_waitcnt lgkmcnt(6)
  v_mfma_f32_16x16x32_bf16 v[64:67], v[104:107], a[16:19], v[64:67]
  v_mfma_f32_16x16x32_bf16 v[68:71], v[104:107], a[48:51], v[68:71]
  v_mfma_f32_16x16x32_bf16 v[72:75], v[104:107], a[80:83], v[72:75]
  v_mfma_f32_16x16x32_bf16 v[76:79], v[104:107], a[112:115], v[76:79]
  v_mfma_f32_16x16x32_bf16 v[80:83], v[104:107], a[144:147], v[80:83]
  v_mfma_f32_16x16x32_bf16 v[84:87], v[104:107], a[176:179], v[84:87]
  v_mfma_f32_16x16x32_bf16 v[88:91], v[104:107], a[208:211], v[88:91]
  ds_read2_b32 v[104:105], v53 offset0:224 offset1:225
  ds_read2_b32 v[106:107], v53 offset0:226 offset1:227
  s_waitcnt lgkmcnt(6)
  v_mfma_f32_16x16x32_bf16 v[64:67], v[92:95], a[12:15], v[64:67]
  v_mfma_f32_16x16x32_bf16 v[68:71], v[92:95], a[44:47], v[68:71]
  v_mfma_f32_16x16x32_bf16 v[72:75], v[92:95], a[76:79], v[72:75]
  v_mfma_f32_16x16x32_bf16 v[76:79], v[92:95], a[108:111], v[76:79]
  v_mfma_f32_16x16x32_bf16 v[80:83], v[92:95], a[140:143], v[80:83]
  v_mfma_f32_16x16x32_bf16 v[84:87], v[92:95], a[172:175], v[84:87]
  v_mfma_f32_16x16x32_bf16 v[88:91], v[92:95], a[204:207], v[88:91]
  ds_read2_b32 v[92:93], v53 offset0:208 offset1:209
  ds_read2_b32 v[94:95], v53 offset0:210 offset1:211
  s_waitcnt lgkmcnt(6)
  v_mfma_f32_16x16x32_bf16 v[64:67], v[96:99], a[8:11], v[64:67]
  v_mfma_f32_16x16x32_bf16 v[68:71], v[96:99], a[40:43], v[68:71]
  v_mfma_f32_16x16x32_bf16 v[72:75], v[96:99], a[72:75], v[72:75]
  v_mfma_f32_16x16x32_bf16 v[76:79], v[96:99], a[104:107], v[76:79]
  v_mfma_f32_16x16x32_bf16 v[80:83], v[96:99], a[136:139], v[80:83]
  v_mfma_f32_16x16x32_bf16 v[84:87], v[96:99], a[168:171], v[84:87]
  v_mfma_f32_16x16x32_bf16 v[88:91], v[96:99], a[200:203], v[88:91]
  ds_read2_b32 v[96:97], v53 offset0:192 offset1:193
  ds_read2_b32 v[98:99], v53 offset0:194 offset1:195
  s_waitcnt lgkmcnt(6)
  v_mfma_f32_16x16x32_bf16 v[64:67], v[100:103], a[4:7], v[64:67]
  v_mfma_f32_16x16x32_bf16 v[68:71], v[100:103], a[36:39], v[68:71]
  v_mfma_f32_16x16x32_bf16 v[72:75], v[100:103], a[68:71], v[72:75]
  v_mfma_f32_16x16x32_bf16 v[76:79], v[100:103], a[100:103], v[76:79]
  v_mfma_f32_16x16x32_bf16 v[80:83], v[100:103], a[132:135], v[80:83]
  v_mfma_f32_16x16x32_bf16 v[84:87], v[100:103], a[164:167], v[84:87]
  v_mfma_f32_16x16x32_bf16 v[88:91], v[100:103], a[196:199], v[88:91]
  ds_read2_b32 v[100:101], v53 offset0:176 offset1:177
  ds_read2_b32 v[102:103], v53 offset0:178 offset1:179
  s_waitcnt lgkmcnt(6)
  v_mfma_f32_16x16x32_bf16 v[64:67], v[104:107], a[0:3], v[64:67]
  v_mfma_f32_16x16x32_bf16 v[68:71], v[104:107], a[32:35], v[68:71]
  v_mfma_f32_16x16x32_bf16 v[72:75], v[104:107], a[64:67], v[72:75]
  v_mfma_f32_16x16x32_bf16 v[76:79], v[104:107], a[96:99], v[76:79]
  v_mfma_f32_16x16x32_bf16 v[80:83], v[104:107], a[128:131], v[80:83]
  v_mfma_f32_16x16x32_bf16 v[84:87], v[104:107], a[160:163], v[84:87]
  v_mfma_f32_16x16x32_bf16 v[88:91], v[104:107], a[192:195], v[88:91]
  ds_read2_b32 v[104:105], v53 offset0:160 offset1:161
  ds_read2_b32 v[106:107], v53 offset0:162 offset1:163
  s_waitcnt lgkmcnt(6)
  v_mfma_f32_16x16x32_bf16 v[68:71], v[92:95], a[28:31], v[68:71]
  v_mfma_f32_16x16x32_bf16 v[72:75], v[92:95], a[60:63], v[72:75]
  v_mfma_f32_16x16x32_bf16 v[76:79], v[92:95], a[92:95], v[76:79]
  v_mfma_f32_16x16x32_bf16 v[80:83], v[92:95], a[124:127], v[80:83]
  v_mfma_f32_16x16x32_bf16 v[84:87], v[92:95], a[156:159], v[84:87]
  v_mfma_f32_16x16x32_bf16 v[88:91], v[92:95], a[188:191], v[88:91]
  ds_read2_b32 v[92:93], v53 offset0:144 offset1:145
  ds_read2_b32 v[94:95], v53 offset0:146 offset1:147
  s_waitcnt lgkmcnt(6)
  v_mfma_f32_16x16x32_bf16 v[68:71], v[96:99], a[24:27], v[68:71]
  v_mfma_f32_16x16x32_bf16 v[72:75], v[96:99], a[56:59], v[72:75]
  v_mfma_f32_16x16x32_bf16 v[76:79], v[96:99], a[88:91], v[76:79]
  v_mfma_f32_16x16x32_bf16 v[80:83], v[96:99], a[120:123], v[80:83]
  v_mfma_f32_16x16x32_bf16 v[84:87], v[96:99], a[152:155], v[84:87]
  v_mfma_f32_16x16x32_bf16 v[88:91], v[96:99], a[184:187], v[88:91]
  ds_read2_b32 v[96:97], v53 offset0:128 offset1:129
  ds_read2_b32 v[98:99], v53 offset0:130 offset1:131
  s_waitcnt lgkmcnt(6)
  v_mfma_f32_16x16x32_bf16 v[68:71], v[100:103], a[20:23], v[68:71]
  v_mfma_f32_16x16x32_bf16 v[72:75], v[100:103], a[52:55], v[72:75]
  v_mfma_f32_16x16x32_bf16 v[76:79], v[100:103], a[84:87], v[76:79]
  v_mfma_f32_16x16x32_bf16 v[80:83], v[100:103], a[116:119], v[80:83]
  v_mfma_f32_16x16x32_bf16 v[84:87], v[100:103], a[148:151], v[84:87]
  v_mfma_f32_16x16x32_bf16 v[88:91], v[100:103], a[180:183], v[88:91]
  ds_read2_b32 v[100:101], v53 offset0:112 offset1:113
  ds_read2_b32 v[102:103], v53 offset0:114 offset1:115
  s_waitcnt lgkmcnt(6)
  v_mfma_f32_16x16x32_bf16 v[68:71], v[104:107], a[16:19], v[68:71]
  v_mfma_f32_16x16x32_bf16 v[72:75], v[104:107], a[48:51], v[72:75]
  v_mfma_f32_16x16x32_bf16 v[76:79], v[104:107], a[80:83], v[76:79]
  v_mfma_f32_16x16x32_bf16 v[80:83], v[104:107], a[112:115], v[80:83]
  v_mfma_f32_16x16x32_bf16 v[84:87], v[104:107], a[144:147], v[84:87]
  v_mfma_f32_16x16x32_bf16 v[88:91], v[104:107], a[176:179], v[88:91]
  ds_read2_b32 v[104:105], v53 offset0:96 offset1:97
  ds_read2_b32 v[106:107], v53 offset0:98 offset1:99
  s_waitcnt lgkmcnt(6)
  v_mfma_f32_16x16x32_bf16 v[68:71], v[92:95], a[12:15], v[68:71]
  v_mfma_f32_16x16x32_bf16 v[72:75], v[92:95], a[44:47], v[72:75]
  v_mfma_f32_16x16x32_bf16 v[76:79], v[92:95], a[76:79], v[76:79]
  v_mfma_f32_16x16x32_bf16 v[80:83], v[92:95], a[108:111], v[80:83]
  v_mfma_f32_16x16x32_bf16 v[84:87], v[92:95], a[140:143], v[84:87]
  v_mfma_f32_16x16x32_bf16 v[88:91], v[92:95], a[172:175], v[88:91]
  ds_read2_b32 v[92:93], v53 offset0:80 offset1:81
  ds_read2_b32 v[94:95], v53 offset0:82 offset1:83
  s_waitcnt lgkmcnt(6)
  v_mfma_f32_16x16x32_bf16 v[68:71], v[96:99], a[8:11], v[68:71]
  v_mfma_f32_16x16x32_bf16 v[72:75], v[96:99], a[40:43], v[72:75]
  v_mfma_f32_16x16x32_bf16 v[76:79], v[96:99], a[72:75], v[76:79]
  v_mfma_f32_16x16x32_bf16 v[80:83], v[96:99], a[104:107], v[80:83]
  v_mfma_f32_16x16x32_bf16 v[84:87], v[96:99], a[136:139], v[84:87]
  v_mfma_f32_16x16x32_bf16 v[88:91], v[96:99], a[168:171], v[88:91]
  ds_read2_b32 v[96:97], v53 offset0:64 offset1:65
  ds_read2_b32 v[98:99], v53 offset0:66 offset1:67
  s_waitcnt lgkmcnt(6)
  v_mfma_f32_16x16x32_bf16 v[68:71], v[100:103], a[4:7], v[68:71]
  v_mfma_f32_16x16x32_bf16 v[72:75], v[100:103], a[36:39], v[72:75]
  v_mfma_f32_16x16x32_bf16 v[76:79], v[100:103], a[68:71], v[76:79]
  v_mfma_f32_16x16x32_bf16 v[80:83], v[100:103], a[100:103], v[80:83]
  v_mfma_f32_16x16x32_bf16 v[84:87], v[100:103], a[132:135], v[84:87]
  v_mfma_f32_16x16x32_bf16 v[88:91], v[100:103], a[164:167], v[88:91]
  ds_read2_b32 v[100:101], v53 offset0:48 offset1:49
  ds_read2_b32 v[102:103], v53 offset0:50 offset1:51
  s_waitcnt lgkmcnt(6)
  v_mfma_f32_16x16x32_bf16 v[68:71], v[104:107], a[0:3], v[68:71]
  v_mfma_f32_16x16x32_bf16 v[72:75], v[104:107], a[32:35], v[72:75]
  v_mfma_f32_16x16x32_bf16 v[76:79], v[104:107], a[64:67], v[76:79]
  v_mfma_f32_16x16x32_bf16 v[80:83], v[104:107], a[96:99], v[80:83]
  v_mfma_f32_16x16x32_bf16 v[84:87], v[104:107], a[128:131], v[84:87]
  v_mfma_f32_16x16x32_bf16 v[88:91], v[104:107], a[160:163], v[88:91]
  ds_read2_b32 v[104:105], v53 offset0:32 offset1:33
  ds_read2_b32 v[106:107], v53 offset0:34 offset1:35
  s_waitcnt lgkmcnt(6)
  v_mfma_f32_16x16x32_bf16 v[72:75], v[92:95], a[28:31], v[72:75]
  v_mfma_f32_16x16x32_bf16 v[76:79], v[92:95], a[60:63], v[76:79]
  v_mfma_f32_16x16x32_bf16 v[80:83], v[92:95], a[92:95], v[80:83]
  v_mfma_f32_16x16x32_bf16 v[84:87], v[92:95], a[124:127], v[84:87]
  v_mfma_f32_16x16x32_bf16 v[88:91], v[92:95], a[156:159], v[88:91]
  ds_read2_b32 v[92:93], v53 offset0:16 offset1:17
  ds_read2_b32 v[94:95], v53 offset0:18 offset1:19
  s_waitcnt lgkmcnt(6)
  v_mfma_f32_16x16x32_bf16 v[72:75], v[96:99], a[24:27], v[72:75]
  v_mfma_f32_16x16x32_bf16 v[76:79], v[96:99], a[56:59], v[76:79]
  v_mfma_f32_16x16x32_bf16 v[80:83], v[96:99], a[88:91], v[80:83]
  v_mfma_f32_16x16x32_bf16 v[84:87], v[96:99], a[120:123], v[84:87]
  v_mfma_f32_16x16x32_bf16 v[88:91], v[96:99], a[152:155], v[88:91]
  ds_read2_b32 v[96:97], v53 offset0:0 offset1:1
  ds_read2_b32 v[98:99], v53 offset0:2 offset1:3
  s_waitcnt lgkmcnt(6)
  v_mfma_f32_16x16x32_bf16 v[72:75], v[100:103], a[20:23], v[72:75]
  v_mfma_f32_16x16x32_bf16 v[76:79], v[100:103], a[52:55], v[76:79]
  v_mfma_f32_16x16x32_bf16 v[80:83], v[100:103], a[84:87], v[80:83]
  v_mfma_f32_16x16x32_bf16 v[84:87], v[100:103], a[116:119], v[84:87]
  v_mfma_f32_16x16x32_bf16 v[88:91], v[100:103], a[148:151], v[88:91]
  ds_read2_b32 v[100:101], v54 offset0:224 offset1:225
  ds_read2_b32 v[102:103], v54 offset0:226 offset1:227
  s_waitcnt lgkmcnt(6)
  v_mfma_f32_16x16x32_bf16 v[72:75], v[104:107], a[16:19], v[72:75]
  v_mfma_f32_16x16x32_bf16 v[76:79], v[104:107], a[48:51], v[76:79]
  v_mfma_f32_16x16x32_bf16 v[80:83], v[104:107], a[80:83], v[80:83]
  v_mfma_f32_16x16x32_bf16 v[84:87], v[104:107], a[112:115], v[84:87]
  v_mfma_f32_16x16x32_bf16 v[88:91], v[104:107], a[144:147], v[88:91]
  ds_read2_b32 v[104:105], v54 offset0:208 offset1:209
  ds_read2_b32 v[106:107], v54 offset0:210 offset1:211
  s_waitcnt lgkmcnt(6)
  v_mfma_f32_16x16x32_bf16 v[72:75], v[92:95], a[12:15], v[72:75]
  v_mfma_f32_16x16x32_bf16 v[76:79], v[92:95], a[44:47], v[76:79]
  v_mfma_f32_16x16x32_bf16 v[80:83], v[92:95], a[76:79], v[80:83]
  v_mfma_f32_16x16x32_bf16 v[84:87], v[92:95], a[108:111], v[84:87]
  v_mfma_f32_16x16x32_bf16 v[88:91], v[92:95], a[140:143], v[88:91]
  ds_read2_b32 v[92:93], v54 offset0:192 offset1:193
  ds_read2_b32 v[94:95], v54 offset0:194 offset1:195
  s_waitcnt lgkmcnt(6)
  v_mfma_f32_16x16x32_bf16 v[72:75], v[96:99], a[8:11], v[72:75]
  v_mfma_f32_16x16x32_bf16 v[76:79], v[96:99], a[40:43], v[76:79]
  v_mfma_f32_16x16x32_bf16 v[80:83], v[96:99], a[72:75], v[80:83]
  v_mfma_f32_16x16x32_bf16 v[84:87], v[96:99], a[104:107], v[84:87]
  v_mfma_f32_16x16x32_bf16 v[88:91], v[96:99], a[136:139], v[88:91]
  ds_read2_b32 v[96:97], v54 offset0:176 offset1:177
  ds_read2_b32 v[98:99], v54 offset0:178 offset1:179
  s_waitcnt lgkmcnt(6)
  v_mfma_f32_16x16x32_bf16 v[72:75], v[100:103], a[4:7], v[72:75]
  v_mfma_f32_16x16x32_bf16 v[76:79], v[100:103], a[36:39], v[76:79]
  v_mfma_f32_16x16x32_bf16 v[80:83], v[100:103], a[68:71], v[80:83]
  v_mfma_f32_16x16x32_bf16 v[84:87], v[100:103], a[100:103], v[84:87]
  v_mfma_f32_16x16x32_bf16 v[88:91], v[100:103], a[132:135], v[88:91]
  ds_read2_b32 v[100:101], v54 offset0:160 offset1:161
  ds_read2_b32 v[102:103], v54 offset0:162 offset1:163
  s_waitcnt lgkmcnt(6)
  v_mfma_f32_16x16x32_bf16 v[72:75], v[104:107], a[0:3], v[72:75]
  v_mfma_f32_16x16x32_bf16 v[76:79], v[104:107], a[32:35], v[76:79]
  v_mfma_f32_16x16x32_bf16 v[80:83], v[104:107], a[64:67], v[80:83]
  v_mfma_f32_16x16x32_bf16 v[84:87], v[104:107], a[96:99], v[84:87]
  v_mfma_f32_16x16x32_bf16 v[88:91], v[104:107], a[128:131], v[88:91]
  ds_read2_b32 v[104:105], v54 offset0:144 offset1:145
  ds_read2_b32 v[106:107], v54 offset0:146 offset1:147
  s_waitcnt lgkmcnt(6)
  v_mfma_f32_16x16x32_bf16 v[76:79], v[92:95], a[28:31], v[76:79]
  v_mfma_f32_16x16x32_bf16 v[80:83], v[92:95], a[60:63], v[80:83]
  v_mfma_f32_16x16x32_bf16 v[84:87], v[92:95], a[92:95], v[84:87]
  v_mfma_f32_16x16x32_bf16 v[88:91], v[92:95], a[124:127], v[88:91]
  ds_read2_b32 v[92:93], v54 offset0:128 offset1:129
  ds_read2_b32 v[94:95], v54 offset0:130 offset1:131
  s_waitcnt lgkmcnt(6)
  v_mfma_f32_16x16x32_bf16 v[76:79], v[96:99], a[24:27], v[76:79]
  v_mfma_f32_16x16x32_bf16 v[80:83], v[96:99], a[56:59], v[80:83]
  v_mfma_f32_16x16x32_bf16 v[84:87], v[96:99], a[88:91], v[84:87]
  v_mfma_f32_16x16x32_bf16 v[88:91], v[96:99], a[120:123], v[88:91]
  ds_read2_b32 v[96:97], v54 offset0:112 offset1:113
  ds_read2_b32 v[98:99], v54 offset0:114 offset1:115
  s_waitcnt lgkmcnt(6)
  v_mfma_f32_16x16x32_bf16 v[76:79], v[100:103], a[20:23], v[76:79]
  v_mfma_f32_16x16x32_bf16 v[80:83], v[100:103], a[52:55], v[80:83]
  v_mfma_f32_16x16x32_bf16 v[84:87], v[100:103], a[84:87], v[84:87]
  v_mfma_f32_16x16x32_bf16 v[88:91], v[100:103], a[116:119], v[88:91]
  ds_read2_b32 v[100:101], v54 offset0:96 offset1:97
  ds_read2_b32 v[102:103], v54 offset0:98 offset1:99
  s_waitcnt lgkmcnt(6)
  v_mfma_f32_16x16x32_bf16 v[76:79], v[104:107], a[16:19], v[76:79]
  v_mfma_f32_16x16x32_bf16 v[80:83], v[104:107], a[48:51], v[80:83]
  v_mfma_f32_16x16x32_bf16 v[84:87], v[104:107], a[80:83], v[84:87]
  v_mfma_f32_16x16x32_bf16 v[88:91], v[104:107], a[112:115], v[88:91]
  ds_read2_b32 v[104:105], v54 offset0:80 offset1:81
  ds_read2_b32 v[106:107], v54 offset0:82 offset1:83
  s_waitcnt lgkmcnt(6)
  v_mfma_f32_16x16x32_bf16 v[76:79], v[92:95], a[12:15], v[76:79]
  v_mfma_f32_16x16x32_bf16 v[80:83], v[92:95], a[44:47], v[80:83]
  v_mfma_f32_16x16x32_bf16 v[84:87], v[92:95], a[76:79], v[84:87]
  v_mfma_f32_16x16x32_bf16 v[88:91], v[92:95], a[108:111], v[88:91]
  ds_read2_b32 v[92:93], v54 offset0:64 offset1:65
  ds_read2_b32 v[94:95], v54 offset0:66 offset1:67
  s_waitcnt lgkmcnt(6)
  v_mfma_f32_16x16x32_bf16 v[76:79], v[96:99], a[8:11], v[76:79]
  v_mfma_f32_16x16x32_bf16 v[80:83], v[96:99], a[40:43], v[80:83]
  v_mfma_f32_16x16x32_bf16 v[84:87], v[96:99], a[72:75], v[84:87]
  v_mfma_f32_16x16x32_bf16 v[88:91], v[96:99], a[104:107], v[88:91]
  ds_read2_b32 v[96:97], v54 offset0:48 offset1:49
  ds_read2_b32 v[98:99], v54 offset0:50 offset1:51
  s_waitcnt lgkmcnt(6)
  v_mfma_f32_16x16x32_bf16 v[76:79], v[100:103], a[4:7], v[76:79]
  v_mfma_f32_16x16x32_bf16 v[80:83], v[100:103], a[36:39], v[80:83]
  v_mfma_f32_16x16x32_bf16 v[84:87], v[100:103], a[68:71], v[84:87]
  v_mfma_f32_16x16x32_bf16 v[88:91], v[100:103], a[100:103], v[88:91]
  ds_read2_b32 v[100:101], v54 offset0:32 offset1:33
  ds_read2_b32 v[102:103], v54 offset0:34 offset1:35
  s_waitcnt lgkmcnt(6)
  v_mfma_f32_16x16x32_bf16 v[76:79], v[104:107], a[0:3], v[76:79]
  v_mfma_f32_16x16x32_bf16 v[80:83], v[104:107], a[32:35], v[80:83]
  v_mfma_f32_16x16x32_bf16 v[84:87], v[104:107], a[64:67], v[84:87]
  v_mfma_f32_16x16x32_bf16 v[88:91], v[104:107], a[96:99], v[88:91]
  ds_read2_b32 v[104:105], v54 offset0:16 offset1:17
  ds_read2_b32 v[106:107], v54 offset0:18 offset1:19
  s_waitcnt lgkmcnt(6)
  v_mfma_f32_16x16x32_bf16 v[80:83], v[92:95], a[28:31], v[80:83]
  v_mfma_f32_16x16x32_bf16 v[84:87], v[92:95], a[60:63], v[84:87]
  v_mfma_f32_16x16x32_bf16 v[88:91], v[92:95], a[92:95], v[88:91]
  ds_read2_b32 v[92:93], v54 offset0:0 offset1:1
  ds_read2_b32 v[94:95], v54 offset0:2 offset1:3
  s_waitcnt lgkmcnt(6)
  v_mfma_f32_16x16x32_bf16 v[80:83], v[96:99], a[24:27], v[80:83]
  v_mfma_f32_16x16x32_bf16 v[84:87], v[96:99], a[56:59], v[84:87]
  v_mfma_f32_16x16x32_bf16 v[88:91], v[96:99], a[88:91], v[88:91]
  ds_read2_b32 v[96:97], v55 offset0:224 offset1:225
  ds_read2_b32 v[98:99], v55 offset0:226 offset1:227
  s_waitcnt lgkmcnt(6)
  v_mfma_f32_16x16x32_bf16 v[80:83], v[100:103], a[20:23], v[80:83]
  v_mfma_f32_16x16x32_bf16 v[84:87], v[100:103], a[52:55], v[84:87]
  v_mfma_f32_16x16x32_bf16 v[88:91], v[100:103], a[84:87], v[88:91]
  ds_read2_b32 v[100:101], v55 offset0:208 offset1:209
  ds_read2_b32 v[102:103], v55 offset0:210 offset1:211
  s_waitcnt lgkmcnt(6)
  v_mfma_f32_16x16x32_bf16 v[80:83], v[104:107], a[16:19], v[80:83]
  v_mfma_f32_16x16x32_bf16 v[84:87], v[104:107], a[48:51], v[84:87]
  v_mfma_f32_16x16x32_bf16 v[88:91], v[104:107], a[80:83], v[88:91]
  ds_read2_b32 v[104:105], v55 offset0:192 offset1:193
  ds_read2_b32 v[106:107], v55 offset0:194 offset1:195
  s_waitcnt lgkmcnt(6)
  v_mfma_f32_16x16x32_bf16 v[80:83], v[92:95], a[12:15], v[80:83]
  v_mfma_f32_16x16x32_bf16 v[84:87], v[92:95], a[44:47], v[84:87]
  v_mfma_f32_16x16x32_bf16 v[88:91], v[92:95], a[76:79], v[88:91]
  ds_read2_b32 v[92:93], v55 offset0:176 offset1:177
  ds_read2_b32 v[94:95], v55 offset0:178 offset1:179
  s_waitcnt lgkmcnt(6)
  v_mfma_f32_16x16x32_bf16 v[80:83], v[96:99], a[8:11], v[80:83]
  v_mfma_f32_16x16x32_bf16 v[84:87], v[96:99], a[40:43], v[84:87]
  v_mfma_f32_16x16x32_bf16 v[88:91], v[96:99], a[72:75], v[88:91]
  ds_read2_b32 v[96:97], v55 offset0:160 offset1:161
  ds_read2_b32 v[98:99], v55 offset0:162 offset1:163
  s_waitcnt lgkmcnt(6)
  v_mfma_f32_16x16x32_bf16 v[80:83], v[100:103], a[4:7], v[80:83]
  v_mfma_f32_16x16x32_bf16 v[84:87], v[100:103], a[36:39], v[84:87]
  v_mfma_f32_16x16x32_bf16 v[88:91], v[100:103], a[68:71], v[88:91]
  ds_read2_b32 v[100:101], v55 offset0:144 offset1:145
  ds_read2_b32 v[102:103], v55 offset0:146 offset1:147
  s_waitcnt lgkmcnt(6)
  v_mfma_f32_16x16x32_bf16 v[80:83], v[104:107], a[0:3], v[80:83]
  v_mfma_f32_16x16x32_bf16 v[84:87], v[104:107], a[32:35], v[84:87]
  v_mfma_f32_16x16x32_bf16 v[88:91], v[104:107], a[64:67], v[88:91]
  ds_read2_b32 v[104:105], v55 offset0:128 offset1:129
  ds_read2_b32 v[106:107], v55 offset0:130 offset1:131
  s_waitcnt lgkmcnt(6)
  v_mfma_f32_16x16x32_bf16 v[84:87], v[92:95], a[28:31], v[84:87]
  v_mfma_f32_16x16x32_bf16 v[88:91], v[92:95], a[60:63], v[88:91]
  ds_read2_b32 v[92:93], v55 offset0:112 offset1:113
  ds_read2_b32 v[94:95], v55 offset0:114 offset1:115
  s_waitcnt lgkmcnt(6)
  v_mfma_f32_16x16x32_bf16 v[84:87], v[96:99], a[24:27], v[84:87]
  v_mfma_f32_16x16x32_bf16 v[88:91], v[96:99], a[56:59], v[88:91]
  ds_read2_b32 v[96:97], v55 offset0:96 offset1:97
  ds_read2_b32 v[98:99], v55 offset0:98 offset1:99
  s_waitcnt lgkmcnt(6)
  v_mfma_f32_16x16x32_bf16 v[84:87], v[100:103], a[20:23], v[84:87]
  v_mfma_f32_16x16x32_bf16 v[88:91], v[100:103], a[52:55], v[88:91]
  ds_read2_b32 v[100:101], v55 offset0:80 offset1:81
  ds_read2_b32 v[102:103], v55 offset0:82 offset1:83
  s_waitcnt lgkmcnt(6)
  v_mfma_f32_16x16x32_bf16 v[84:87], v[104:107], a[16:19], v[84:87]
  v_mfma_f32_16x16x32_bf16 v[88:91], v[104:107], a[48:51], v[88:91]
  ds_read2_b32 v[104:105], v55 offset0:64 offset1:65
  ds_read2_b32 v[106:107], v55 offset0:66 offset1:67
  s_waitcnt lgkmcnt(6)
  v_mfma_f32_16x16x32_bf16 v[84:87], v[92:95], a[12:15], v[84:87]
  v_mfma_f32_16x16x32_bf16 v[88:91], v[92:95], a[44:47], v[88:91]
  ds_read2_b32 v[92:93], v55 offset0:48 offset1:49
  ds_read2_b32 v[94:95], v55 offset0:50 offset1:51
  s_waitcnt lgkmcnt(6)
  v_mfma_f32_16x16x32_bf16 v[84:87], v[96:99], a[8:11], v[84:87]
  v_mfma_f32_16x16x32_bf16 v[88:91], v[96:99], a[40:43], v[88:91]
  ds_read2_b32 v[96:97], v55 offset0:32 offset1:33
  ds_read2_b32 v[98:99], v55 offset0:34 offset1:35
  s_waitcnt lgkmcnt(6)
  v_mfma_f32_16x16x32_bf16 v[84:87], v[100:103], a[4:7], v[84:87]
  v_mfma_f32_16x16x32_bf16 v[88:91], v[100:103], a[36:39], v[88:91]
  ds_read2_b32 v[100:101], v55 offset0:16 offset1:17
  ds_read2_b32 v[102:103], v55 offset0:18 offset1:19
  s_waitcnt lgkmcnt(6)
  v_mfma_f32_16x16x32_bf16 v[84:87], v[104:107], a[0:3], v[84:87]
  v_mfma_f32_16x16x32_bf16 v[88:91], v[104:107], a[32:35], v[88:91]
  ds_read2_b32 v[104:105], v55 offset0:0 offset1:1
  ds_read2_b32 v[106:107], v55 offset0:2 offset1:3
  s_waitcnt lgkmcnt(6)
  v_mfma_f32_16x16x32_bf16 v[88:91], v[92:95], a[28:31], v[88:91]
  ds_read2_b32 v[92:93], v56 offset0:224 offset1:225
  ds_read2_b32 v[94:95], v56 offset0:226 offset1:227
  s_waitcnt lgkmcnt(6)
  v_mfma_f32_16x16x32_bf16 v[88:91], v[96:99], a[24:27], v[88:91]
  ds_read2_b32 v[96:97], v56 offset0:208 offset1:209
  ds_read2_b32 v[98:99], v56 offset0:210 offset1:211
  s_waitcnt lgkmcnt(6)
  v_mfma_f32_16x16x32_bf16 v[88:91], v[100:103], a[20:23], v[88:91]
  ds_read2_b32 v[100:101], v56 offset0:192 offset1:193
  ds_read2_b32 v[102:103], v56 offset0:194 offset1:195
  s_waitcnt lgkmcnt(6)
  v_mfma_f32_16x16x32_bf16 v[88:91], v[104:107], a[16:19], v[88:91]
  ds_read2_b32 v[104:105], v56 offset0:176 offset1:177
  ds_read2_b32 v[106:107], v56 offset0:178 offset1:179
  s_waitcnt lgkmcnt(6)
  v_mfma_f32_16x16x32_bf16 v[88:91], v[92:95], a[12:15], v[88:91]
  s_waitcnt lgkmcnt(4)
  v_mfma_f32_16x16x32_bf16 v[88:91], v[96:99], a[8:11], v[88:91]
  s_waitcnt lgkmcnt(2)
  v_mfma_f32_16x16x32_bf16 v[88:91], v[100:103], a[4:7], v[88:91]
  s_waitcnt lgkmcnt(0)
  v_mfma_f32_16x16x32_bf16 v[88:91], v[104:107], a[0:3], v[88:91]
  v_lshlrev_b32 v46, 5, v4
  v_lshl_add_u32 v46, v3, 3, v46
  v_add_u32 v46, s17, v46
  ds_read_b64 v[108:109], v46 offset:512
  ds_read_b64 v[110:111], v46 offset:1024
  ds_read_b64 v[112:113], v46 offset:1536
  ds_read_b64 v[114:115], v46 offset:2048
  ds_read_b64 v[116:117], v46 offset:2560
  ds_read_b64 v[118:119], v46 offset:3072
  ds_read_b64 v[120:121], v46 offset:3584
  ds_read_b64 v[122:123], v46 offset:4096
  s_waitcnt lgkmcnt(0)
  v_lshlrev_b32 v124, 16, v108
  v_and_b32 v125, 0xffff0000, v108
  v_lshlrev_b32 v126, 16, v109
  v_and_b32 v127, 0xffff0000, v109
  v_mul_f32 v124, v124, v33
  v_mul_f32 v125, v125, v33
  v_mul_f32 v126, v126, v33
  v_mul_f32 v127, v127, v33
  v_cvt_pk_bf16_f32 v128, v124, v125
  v_cvt_pk_bf16_f32 v129, v126, v127
  v_cvt_pk_bf16_f32 v130, v60, v61
  v_cvt_pk_bf16_f32 v131, v62, v63
  v_lshlrev_b32 v124, 16, v128
  v_and_b32 v125, 0xffff0000, v128
  v_lshlrev_b32 v132, 16, v130
  v_and_b32 v133, 0xffff0000, v130
  v_lshlrev_b32 v126, 16, v129
  v_and_b32 v127, 0xffff0000, v129
  v_lshlrev_b32 v134, 16, v131
  v_and_b32 v135, 0xffff0000, v131
  v_add_f32 v124, v124, v132
  v_add_f32 v125, v125, v133
  v_add_f32 v126, v126, v134
  v_add_f32 v127, v127, v135
  v_cvt_pk_bf16_f32 v108, v124, v125
  v_cvt_pk_bf16_f32 v109, v126, v127
  ds_write_b64 v46, v[108:109] offset:512
  v_lshlrev_b32 v124, 16, v110
  v_and_b32 v125, 0xffff0000, v110
  v_lshlrev_b32 v126, 16, v111
  v_and_b32 v127, 0xffff0000, v111
  v_mul_f32 v124, v124, v33
  v_mul_f32 v125, v125, v33
  v_mul_f32 v126, v126, v33
  v_mul_f32 v127, v127, v33
  v_cvt_pk_bf16_f32 v128, v124, v125
  v_cvt_pk_bf16_f32 v129, v126, v127
  v_cvt_pk_bf16_f32 v130, v64, v65
  v_cvt_pk_bf16_f32 v131, v66, v67
  v_lshlrev_b32 v124, 16, v128
  v_and_b32 v125, 0xffff0000, v128
  v_lshlrev_b32 v132, 16, v130
  v_and_b32 v133, 0xffff0000, v130
  v_lshlrev_b32 v126, 16, v129
  v_and_b32 v127, 0xffff0000, v129
  v_lshlrev_b32 v134, 16, v131
  v_and_b32 v135, 0xffff0000, v131
  v_add_f32 v124, v124, v132
  v_add_f32 v125, v125, v133
  v_add_f32 v126, v126, v134
  v_add_f32 v127, v127, v135
  v_cvt_pk_bf16_f32 v110, v124, v125
  v_cvt_pk_bf16_f32 v111, v126, v127
  ds_write_b64 v46, v[110:111] offset:1024
  v_lshlrev_b32 v124, 16, v112
  v_and_b32 v125, 0xffff0000, v112
  v_lshlrev_b32 v126, 16, v113
  v_and_b32 v127, 0xffff0000, v113
  v_mul_f32 v124, v124, v33
  v_mul_f32 v125, v125, v33
  v_mul_f32 v126, v126, v33
  v_mul_f32 v127, v127, v33
  v_cvt_pk_bf16_f32 v128, v124, v125
  v_cvt_pk_bf16_f32 v129, v126, v127
  v_cvt_pk_bf16_f32 v130, v68, v69
  v_cvt_pk_bf16_f32 v131, v70, v71
  v_lshlrev_b32 v124, 16, v128
  v_and_b32 v125, 0xffff0000, v128
  v_lshlrev_b32 v132, 16, v130
  v_and_b32 v133, 0xffff0000, v130
  v_lshlrev_b32 v126, 16, v129
  v_and_b32 v127, 0xffff0000, v129
  v_lshlrev_b32 v134, 16, v131
  v_and_b32 v135, 0xffff0000, v131
  v_add_f32 v124, v124, v132
  v_add_f32 v125, v125, v133
  v_add_f32 v126, v126, v134
  v_add_f32 v127, v127, v135
  v_cvt_pk_bf16_f32 v112, v124, v125
  v_cvt_pk_bf16_f32 v113, v126, v127
  ds_write_b64 v46, v[112:113] offset:1536
  v_lshlrev_b32 v124, 16, v114
  v_and_b32 v125, 0xffff0000, v114
  v_lshlrev_b32 v126, 16, v115
  v_and_b32 v127, 0xffff0000, v115
  v_mul_f32 v124, v124, v33
  v_mul_f32 v125, v125, v33
  v_mul_f32 v126, v126, v33
  v_mul_f32 v127, v127, v33
  v_cvt_pk_bf16_f32 v128, v124, v125
  v_cvt_pk_bf16_f32 v129, v126, v127
  v_cvt_pk_bf16_f32 v130, v72, v73
  v_cvt_pk_bf16_f32 v131, v74, v75
  v_lshlrev_b32 v124, 16, v128
  v_and_b32 v125, 0xffff0000, v128
  v_lshlrev_b32 v132, 16, v130
  v_and_b32 v133, 0xffff0000, v130
  v_lshlrev_b32 v126, 16, v129
  v_and_b32 v127, 0xffff0000, v129
  v_lshlrev_b32 v134, 16, v131
  v_and_b32 v135, 0xffff0000, v131
  v_add_f32 v124, v124, v132
  v_add_f32 v125, v125, v133
  v_add_f32 v126, v126, v134
  v_add_f32 v127, v127, v135
  v_cvt_pk_bf16_f32 v114, v124, v125
  v_cvt_pk_bf16_f32 v115, v126, v127
  ds_write_b64 v46, v[114:115] offset:2048
  v_lshlrev_b32 v124, 16, v116
  v_and_b32 v125, 0xffff0000, v116
  v_lshlrev_b32 v126, 16, v117
  v_and_b32 v127, 0xffff0000, v117
  v_mul_f32 v124, v124, v33
  v_mul_f32 v125, v125, v33
  v_mul_f32 v126, v126, v33
  v_mul_f32 v127, v127, v33
  v_cvt_pk_bf16_f32 v128, v124, v125
  v_cvt_pk_bf16_f32 v129, v126, v127
  v_cvt_pk_bf16_f32 v130, v76, v77
  v_cvt_pk_bf16_f32 v131, v78, v79
  v_lshlrev_b32 v124, 16, v128
  v_and_b32 v125, 0xffff0000, v128
  v_lshlrev_b32 v132, 16, v130
  v_and_b32 v133, 0xffff0000, v130
  v_lshlrev_b32 v126, 16, v129
  v_and_b32 v127, 0xffff0000, v129
  v_lshlrev_b32 v134, 16, v131
  v_and_b32 v135, 0xffff0000, v131
  v_add_f32 v124, v124, v132
  v_add_f32 v125, v125, v133
  v_add_f32 v126, v126, v134
  v_add_f32 v127, v127, v135
  v_cvt_pk_bf16_f32 v116, v124, v125
  v_cvt_pk_bf16_f32 v117, v126, v127
  ds_write_b64 v46, v[116:117] offset:2560
  v_lshlrev_b32 v124, 16, v118
  v_and_b32 v125, 0xffff0000, v118
  v_lshlrev_b32 v126, 16, v119
  v_and_b32 v127, 0xffff0000, v119
  v_mul_f32 v124, v124, v33
  v_mul_f32 v125, v125, v33
  v_mul_f32 v126, v126, v33
  v_mul_f32 v127, v127, v33
  v_cvt_pk_bf16_f32 v128, v124, v125
  v_cvt_pk_bf16_f32 v129, v126, v127
  v_cvt_pk_bf16_f32 v130, v80, v81
  v_cvt_pk_bf16_f32 v131, v82, v83
  v_lshlrev_b32 v124, 16, v128
  v_and_b32 v125, 0xffff0000, v128
  v_lshlrev_b32 v132, 16, v130
  v_and_b32 v133, 0xffff0000, v130
  v_lshlrev_b32 v126, 16, v129
  v_and_b32 v127, 0xffff0000, v129
  v_lshlrev_b32 v134, 16, v131
  v_and_b32 v135, 0xffff0000, v131
  v_add_f32 v124, v124, v132
  v_add_f32 v125, v125, v133
  v_add_f32 v126, v126, v134
  v_add_f32 v127, v127, v135
  v_cvt_pk_bf16_f32 v118, v124, v125
  v_cvt_pk_bf16_f32 v119, v126, v127
  ds_write_b64 v46, v[118:119] offset:3072
  v_lshlrev_b32 v124, 16, v120
  v_and_b32 v125, 0xffff0000, v120
  v_lshlrev_b32 v126, 16, v121
  v_and_b32 v127, 0xffff0000, v121
  v_mul_f32 v124, v124, v33
  v_mul_f32 v125, v125, v33
  v_mul_f32 v126, v126, v33
  v_mul_f32 v127, v127, v33
  v_cvt_pk_bf16_f32 v128, v124, v125
  v_cvt_pk_bf16_f32 v129, v126, v127
  v_cvt_pk_bf16_f32 v130, v84, v85
  v_cvt_pk_bf16_f32 v131, v86, v87
  v_lshlrev_b32 v124, 16, v128
  v_and_b32 v125, 0xffff0000, v128
  v_lshlrev_b32 v132, 16, v130
  v_and_b32 v133, 0xffff0000, v130
  v_lshlrev_b32 v126, 16, v129
  v_and_b32 v127, 0xffff0000, v129
  v_lshlrev_b32 v134, 16, v131
  v_and_b32 v135, 0xffff0000, v131
  v_add_f32 v124, v124, v132
  v_add_f32 v125, v125, v133
  v_add_f32 v126, v126, v134
  v_add_f32 v127, v127, v135
  v_cvt_pk_bf16_f32 v120, v124, v125
  v_cvt_pk_bf16_f32 v121, v126, v127
  ds_write_b64 v46, v[120:121] offset:3584
  v_lshlrev_b32 v124, 16, v122
  v_and_b32 v125, 0xffff0000, v122
  v_lshlrev_b32 v126, 16, v123
  v_and_b32 v127, 0xffff0000, v123
  v_mul_f32 v124, v124, v33
  v_mul_f32 v125, v125, v33
  v_mul_f32 v126, v126, v33
  v_mul_f32 v127, v127, v33
  v_cvt_pk_bf16_f32 v128, v124, v125
  v_cvt_pk_bf16_f32 v129, v126, v127
  v_cvt_pk_bf16_f32 v130, v88, v89
  v_cvt_pk_bf16_f32 v131, v90, v91
  v_lshlrev_b32 v124, 16, v128
  v_and_b32 v125, 0xffff0000, v128
  v_lshlrev_b32 v132, 16, v130
  v_and_b32 v133, 0xffff0000, v130
  v_lshlrev_b32 v126, 16, v129
  v_and_b32 v127, 0xffff0000, v129
  v_lshlrev_b32 v134, 16, v131
  v_and_b32 v135, 0xffff0000, v131
  v_add_f32 v124, v124, v132
  v_add_f32 v125, v125, v133
  v_add_f32 v126, v126, v134
  v_add_f32 v127, v127, v135
  v_cvt_pk_bf16_f32 v122, v124, v125
  v_cvt_pk_bf16_f32 v123, v126, v127
  ds_write_b64 v46, v[122:123] offset:4096
  s_waitcnt lgkmcnt(0)
  s_barrier
  v_lshlrev_b32 v6, 3, v0
  v_lshlrev_b32 v5, 4, v0
  v_add_u32 v36, 512, v6
  ds_read_b64 v[8:9], v36
  v_add_u32 v36, 25088, v6
  ds_read_b64 v[10:11], v36
  v_add_u32 v36, 49664, v6
  ds_read_b64 v[12:13], v36
  v_add_u32 v36, 74240, v6
  ds_read_b64 v[14:15], v36
  s_waitcnt lgkmcnt(0)
  s_add_u32 s22, s21, 0
  s_add_u32 s23, s22, 3584
  v_perm_b32 v16, v10, v8, s24
  v_perm_b32 v17, v14, v12, s24
  s_lshl_b32 s22, s21, 11
  s_add_u32 s22, s22, 90177536
  v_perm_b32 v18, v10, v8, s25
  v_perm_b32 v19, v14, v12, s25
  buffer_store_dwordx4 v[16:19], v5, s[8:11], s22 offen sc1
  v_perm_b32 v20, v11, v9, s24
  v_perm_b32 v21, v15, v13, s24
  v_perm_b32 v22, v11, v9, s25
  v_perm_b32 v23, v15, v13, s25
  s_add_u32 s22, s22, 4096
  buffer_store_dwordx4 v[20:23], v5, s[8:11], s22 offen sc1
  v_add_u32 v36, 2560, v6
  ds_read_b64 v[8:9], v36
  v_add_u32 v36, 27136, v6
  ds_read_b64 v[10:11], v36
  v_add_u32 v36, 51712, v6
  ds_read_b64 v[12:13], v36
  v_add_u32 v36, 76288, v6
  ds_read_b64 v[14:15], v36
  s_waitcnt lgkmcnt(0)
  s_add_u32 s22, s21, 1835008
  s_add_u32 s23, s22, 3584
  v_perm_b32 v24, v10, v8, s24
  v_perm_b32 v25, v14, v12, s24
  s_lshl_b32 s22, s21, 11
  s_add_u32 s22, s22, 90185728
  v_perm_b32 v26, v10, v8, s25
  v_perm_b32 v27, v14, v12, s25
  buffer_store_dwordx4 v[24:27], v5, s[8:11], s22 offen sc1
  v_perm_b32 v28, v11, v9, s24
  v_perm_b32 v29, v15, v13, s24
  v_perm_b32 v30, v11, v9, s25
  v_perm_b32 v31, v15, v13, s25
  s_add_u32 s22, s22, 4096
  buffer_store_dwordx4 v[28:31], v5, s[8:11], s22 offen sc1
  s_waitcnt vmcnt(0)
  s_barrier
  s_cmp_lg_u32 s16, 0
  s_cbranch_scc1 wk_nc
  v_mov_b32 v5, 1
  s_mov_b32 s22, 88599424
  s_mov_b64 exec, 1
  buffer_atomic_add v5, off, s[8:11], s22
  s_mov_b64 exec, -1
wk_nc:
  s_branch wk_loop
wk_tok:
  s_sub_u32 s3, s3, 864
  s_cmp_lt_u32 s3, 512
  s_cbranch_scc1 wk_tk
  s_sub_u32 s3, s3, 64
  s_cmp_ge_i32 s3, 512
  s_cbranch_scc1 wk_tk
  s_sub_u32 s18, s3, 448
  s_mov_b32 s20, 88599424
  v_mov_b32 v8, 0
  s_mov_b32 s30, 0
wk_cw:
  buffer_load_dword v9, v8, s[8:11], s20 offen sc1
  s_waitcnt vmcnt(0)
  v_cmp_ne_u32 vcc, 112, v9
  s_cbranch_vccz wk_cw_ok
  s_sleep 32
  s_add_u32 s30, s30, 1
  s_cmp_lt_u32 s30, 50000
  s_cbranch_scc1 wk_cw
  s_branch cA_abort
wk_cw_ok:
  v_lshlrev_b32 v5, 14, v3
  v_and_b32 v6, 1, v4
  v_lshl_add_u32 v5, v6, 12, v5
  v_lshrrev_b32 v6, 1, v4
  v_lshl_add_u32 v5, v6, 4, v5
  s_mul_i32 s20, s16, 458752
  s_lshl_b32 s21, s18, 7
  s_add_u32 s20, s20, s21
  s_and_b32 s21, s18, 32
  s_lshl_b32 s21, s21, 7
  s_add_u32 s20, s20, s21
  s_add_u32 s20, s20, 90177536
  buffer_load_dwordx4 v[8:11], v5, s[8:11], s20 offen sc1
  s_add_u32 s20, s20, 65536
  buffer_load_dwordx4 v[12:15], v5, s[8:11], s20 offen sc1
  s_add_u32 s20, s20, 65536
  buffer_load_dwordx4 v[16:19], v5, s[8:11], s20 offen sc1
  s_add_u32 s20, s20, 65536
  buffer_load_dwordx4 v[20:23], v5, s[8:11], s20 offen sc1
  s_add_u32 s20, s20, 65536
  buffer_load_dwordx4 v[24:27], v5, s[8:11], s20 offen sc1
  s_add_u32 s20, s20, 65536
  buffer_load_dwordx4 v[28:31], v5, s[8:11], s20 offen sc1
  s_add_u32 s20, s20, 65536
  buffer_load_dwordx4 v[32:35], v5, s[8:11], s20 offen sc1
  s_add_u32 s20, s20, 65536
  v_mul_u32_u24 v6, 1824, v4
  v_lshl_add_u32 v6, v3, 3, v6
  s_mul_i32 s20, s16, 224
  v_add_u32 v6, s20, v6
  s_movk_i32 s22, 912
  v_add_u32 v36, 0, v0
  v_mul_u32_u24 v37, 18725, v36
  v_lshrrev_b32 v37, 20, v37
  v_mul_u32_u24 v38, 56, v37
  v_sub_u32 v36, v36, v38
  v_lshlrev_b32 v36, 4, v36
  v_mad_u32_u24 v40, v37, s22, v36
  v_mul_u32_u24 v37, 1792, v37
  v_add_u32 v48, v37, v36
  v_add_u32 v36, 256, v0
  v_mul_u32_u24 v37, 18725, v36
  v_lshrrev_b32 v37, 20, v37
  v_mul_u32_u24 v38, 56, v37
  v_sub_u32 v36, v36, v38
  v_lshlrev_b32 v36, 4, v36
  v_mad_u32_u24 v41, v37, s22, v36
  v_mul_u32_u24 v37, 1792, v37
  v_add_u32 v49, v37, v36
  v_add_u32 v36, 512, v0
  v_mul_u32_u24 v37, 18725, v36
  v_lshrrev_b32 v37, 20, v37
  v_mul_u32_u24 v38, 56, v37
  v_sub_u32 v36, v36, v38
  v_lshlrev_b32 v36, 4, v36
  v_mad_u32_u24 v42, v37, s22, v36
  v_mul_u32_u24 v37, 1792, v37
  v_add_u32 v50, v37, v36
  v_add_u32 v36, 768, v0
  v_mul_u32_u24 v37, 18725, v36
  v_lshrrev_b32 v37, 20, v37
  v_mul_u32_u24 v38, 56, v37
  v_sub_u32 v36, v36, v38
  v_lshlrev_b32 v36, 4, v36
  v_mad_u32_u24 v43, v37, s22, v36
  v_mul_u32_u24 v37, 1792, v37
  v_add_u32 v51, v37, v36
  v_add_u32 v36, 1024, v0
  v_mul_u32_u24 v37, 18725, v36
  v_lshrrev_b32 v37, 20, v37
  v_mul_u32_u24 v38, 56, v37
  v_sub_u32 v36, v36, v38
  v_lshlrev_b32 v36, 4, v36
  v_mad_u32_u24 v44, v37, s22, v36
  v_mul_u32_u24 v37, 1792, v37
  v_add_u32 v52, v37, v36
  v_add_u32 v36, 1280, v0
  v_mul_u32_u24 v37, 18725, v36
  v_lshrrev_b32 v37, 20, v37
  v_mul_u32_u24 v38, 56, v37
  v_sub_u32 v36, v36, v38
  v_lshlrev_b32 v36, 4, v36
  v_mad_u32_u24 v45, v37, s22, v36
  v_mul_u32_u24 v37, 1792, v37
  v_add_u32 v53, v37, v36
  v_add_u32 v36, 1536, v0
  v_mul_u32_u24 v37, 18725, v36
  v_lshrrev_b32 v37, 20, v37
  v_mul_u32_u24 v38, 56, v37
  v_sub_u32 v36, v36, v38
  v_lshlrev_b32 v36, 4, v36
  v_mad_u32_u24 v46, v37, s22, v36
  v_mul_u32_u24 v37, 1792, v37
  v_add_u32 v54, v37, v36
  s_waitcnt vmcnt(6)
  ds_write_b64 v6, v[8:9] offset:0
  ds_write_b64 v6, v[10:11] offset:912
  s_waitcnt vmcnt(5)
  ds_write_b64 v6, v[12:13] offset:32
  ds_write_b64 v6, v[14:15] offset:944
  s_waitcnt vmcnt(4)
  ds_write_b64 v6, v[16:17] offset:64
  ds_write_b64 v6, v[18:19] offset:976
  s_waitcnt vmcnt(3)
  ds_write_b64 v6, v[20:21] offset:96
  ds_write_b64 v6, v[22:23] offset:1008
  s_waitcnt vmcnt(2)
  ds_write_b64 v6, v[24:25] offset:128
  ds_write_b64 v6, v[26:27] offset:1040
  s_waitcnt vmcnt(1)
  ds_write_b64 v6, v[28:29] offset:160
  ds_write_b64 v6, v[30:31] offset:1072
  s_waitcnt vmcnt(0)
  ds_write_b64 v6, v[32:33] offset:192
  ds_write_b64 v6, v[34:35] offset:1104
  s_waitcnt lgkmcnt(0)
  s_barrier
  s_mul_i32 s20, s18, 57344
  ds_read_b128 v[8:11], v40
  ds_read_b128 v[12:15], v41
  ds_read_b128 v[16:19], v42
  ds_read_b128 v[20:23], v43
  ds_read_b128 v[24:27], v44
  ds_read_b128 v[28:31], v45
  ds_read_b128 v[32:35], v46
  s_waitcnt lgkmcnt(6)
  buffer_store_dwordx4 v[8:11], v48, s[92:95], s20 offen
  s_waitcnt lgkmcnt(5)
  buffer_store_dwordx4 v[12:15], v49, s[92:95], s20 offen
  s_waitcnt lgkmcnt(4)
  buffer_store_dwordx4 v[16:19], v50, s[92:95], s20 offen
  s_waitcnt lgkmcnt(3)
  buffer_store_dwordx4 v[20:23], v51, s[92:95], s20 offen
  s_waitcnt lgkmcnt(2)
  buffer_store_dwordx4 v[24:27], v52, s[92:95], s20 offen
  s_waitcnt lgkmcnt(1)
  buffer_store_dwordx4 v[28:31], v53, s[92:95], s20 offen
  s_waitcnt lgkmcnt(0)
  buffer_store_dwordx4 v[32:35], v54, s[92:95], s20 offen
  s_branch wk_loop
wk_tk:
  s_and_b32 s18, s3, 3
  s_lshr_b32 s17, s3, 2
  s_cmp_lt_u32 s17, 8
  s_cbranch_scc1 wk_tokp
  s_sub_u32 s17, s17, 64
  s_cmp_ge_i32 s17, 56
  s_cbranch_scc1 wk_toko
  s_add_u32 s20, s17, 56
  s_lshr_b32 s17, s20, 1
  s_bitcmp0_b32 s20, 0
  s_cbranch_scc1 wk_toko
  s_add_u32 s17, s17, 8
wk_tokp:
  s_lshl_b32 s20, s18, 2
  s_add_u32 s20, s20, s16
  s_lshl_b32 s21, s17, 4
  s_add_u32 s21, s21, s20
  s_mul_i32 s21, s21, 28672
  s_add_u32 s21, s21, 12845056
  s_mul_i32 s23, s17, 28672
  s_add_u32 s23, s23, 73400320
  s_mul_i32 s24, s17, 7168
  s_add_u32 s24, s24, 88080384
  s_lshr_b32 s25, s17, 3
  s_lshl_b32 s25, s25, 4
  s_add_u32 s25, s25, s20
  s_lshl_b32 s25, s25, 7
  s_add_u32 s25, s25, 88557568
  v_mov_b32 v60, 0
  s_mov_b32 s30, 0
wp_wf:
  buffer_load_dword v61, v60, s[8:11], s25 offen sc1
  s_waitcnt vmcnt(0)
  v_cmp_ne_u32 vcc, 56, v61
  s_cbranch_vccz wp_wf_ok
  s_sleep 1
  s_cmp_ge_u32 s17, 61
  s_cbranch_scc1 wp_wf_bo
  s_sleep 4
  s_cmp_ge_u32 s17, 56
  s_cbranch_scc1 wp_wf_bo
  s_sleep 40
wp_wf_bo:
  s_add_u32 s30, s30, 1
  s_cmp_lt_u32 s30, 30000
  s_cbranch_scc1 wp_wf
  s_branch wp_abort
wp_wf_ok:
  s_add_u32 s22, s21, 0
  buffer_load_dwordx4 a[0:3], v2, s[8:11], s22 offen offset:0 sc1
  buffer_load_dwordx4 a[4:7], v2, s[8:11], s22 offen offset:1024 sc1
  buffer_load_dwordx4 a[8:11], v2, s[8:11], s22 offen offset:2048 sc1
  buffer_load_dwordx4 a[12:15], v2, s[8:11], s22 offen offset:3072 sc1
  s_add_u32 s22, s21, 4096
  buffer_load_dwordx4 a[16:19], v2, s[8:11], s22 offen offset:0 sc1
  buffer_load_dwordx4 a[20:23], v2, s[8:11], s22 offen offset:1024 sc1
  buffer_load_dwordx4 a[24:27], v2, s[8:11], s22 offen offset:2048 sc1
  buffer_load_dwordx4 a[28:31], v2, s[8:11], s22 offen offset:3072 sc1
  s_add_u32 s22, s21, 8192
  buffer_load_dwordx4 a[32:35], v2, s[8:11], s22 offen offset:0 sc1
  buffer_load_dwordx4 a[36:39], v2, s[8:11], s22 offen offset:1024 sc1
  buffer_load_dwordx4 a[40:43], v2, s[8:11], s22 offen offset:2048 sc1
  buffer_load_dwordx4 a[44:47], v2, s[8:11], s22 offen offset:3072 sc1
  s_add_u32 s22, s21, 12288
  buffer_load_dwordx4 a[48:51], v2, s[8:11], s22 offen offset:0 sc1
  buffer_load_dwordx4 a[52:55], v2, s[8:11], s22 offen offset:1024 sc1
  buffer_load_dwordx4 a[56:59], v2, s[8:11], s22 offen offset:2048 sc1
  buffer_load_dwordx4 a[60:63], v2, s[8:11], s22 offen offset:3072 sc1
  s_add_u32 s22, s21, 16384
  buffer_load_dwordx4 a[64:67], v2, s[8:11], s22 offen offset:0 sc1
  buffer_load_dwordx4 a[68:71], v2, s[8:11], s22 offen offset:1024 sc1
  buffer_load_dwordx4 a[72:75], v2, s[8:11], s22 offen offset:2048 sc1
  buffer_load_dwordx4 a[76:79], v2, s[8:11], s22 offen offset:3072 sc1
  s_add_u32 s22, s21, 20480
  buffer_load_dwordx4 a[80:83], v2, s[8:11], s22 offen offset:0 sc1
  buffer_load_dwordx4 a[84:87], v2, s[8:11], s22 offen offset:1024 sc1
  buffer_load_dwordx4 a[88:91], v2, s[8:11], s22 offen offset:2048 sc1
  buffer_load_dwordx4 a[92:95], v2, s[8:11], s22 offen offset:3072 sc1
  s_add_u32 s22, s21, 24576
  buffer_load_dwordx4 a[96:99], v2, s[8:11], s22 offen offset:0 sc1
  buffer_load_dwordx4 a[100:103], v2, s[8:11], s22 offen offset:1024 sc1
  buffer_load_dwordx4 a[104:107], v2, s[8:11], s22 offen offset:2048 sc1
  buffer_load_dwordx4 a[108:111], v2, s[8:11], s22 offen offset:3072 sc1
  s_add_u32 s22, s23, 0
  buffer_load_dwordx4 a[112:115], v2, s[8:11], s22 offen offset:0 sc1
  buffer_load_dwordx4 a[116:119], v2, s[8:11], s22 offen offset:1024 sc1
  buffer_load_dwordx4 a[120:123], v2, s[8:11], s22 offen offset:2048 sc1
  buffer_load_dwordx4 a[124:127], v2, s[8:11], s22 offen offset:3072 sc1
  s_add_u32 s22, s23, 4096
  buffer_load_dwordx4 a[128:131], v2, s[8:11], s22 offen offset:0 sc1
  buffer_load_dwordx4 a[132:135], v2, s[8:11], s22 offen offset:1024 sc1
  buffer_load_dwordx4 a[136:139], v2, s[8:11], s22 offen offset:2048 sc1
  buffer_load_dwordx4 a[140:143], v2, s[8:11], s22 offen offset:3072 sc1
  s_add_u32 s22, s23, 8192
  buffer_load_dwordx4 a[144:147], v2, s[8:11], s22 offen offset:0 sc1
  buffer_load_dwordx4 a[148:151], v2, s[8:11], s22 offen offset:1024 sc1
  buffer_load_dwordx4 a[152:155], v2, s[8:11], s22 offen offset:2048 sc1
  buffer_load_dwordx4 a[156:159], v2, s[8:11], s22 offen offset:3072 sc1
  s_add_u32 s22, s23, 12288
  buffer_load_dwordx4 a[160:163], v2, s[8:11], s22 offen offset:0 sc1
  buffer_load_dwordx4 a[164:167], v2, s[8:11], s22 offen offset:1024 sc1
  buffer_load_dwordx4 a[168:171], v2, s[8:11], s22 offen offset:2048 sc1
  buffer_load_dwordx4 a[172:175], v2, s[8:11], s22 offen offset:3072 sc1
  s_add_u32 s22, s23, 16384
  buffer_load_dwordx4 a[176:179], v2, s[8:11], s22 offen offset:0 sc1
  buffer_load_dwordx4 a[180:183], v2, s[8:11], s22 offen offset:1024 sc1
  buffer_load_dwordx4 a[184:187], v2, s[8:11], s22 offen offset:2048 sc1
  buffer_load_dwordx4 a[188:191], v2, s[8:11], s22 offen offset:3072 sc1
  s_add_u32 s22, s23, 20480
  buffer_load_dwordx4 a[192:195], v2, s[8:11], s22 offen offset:0 sc1
  buffer_load_dwordx4 a[196:199], v2, s[8:11], s22 offen offset:1024 sc1
  buffer_load_dwordx4 a[200:203], v2, s[8:11], s22 offen offset:2048 sc1
  buffer_load_dwordx4 a[204:207], v2, s[8:11], s22 offen offset:3072 sc1
  s_add_u32 s22, s23, 24576
  buffer_load_dwordx4 a[208:211], v2, s[8:11], s22 offen offset:0 sc1
  buffer_load_dwordx4 a[212:215], v2, s[8:11], s22 offen offset:1024 sc1
  buffer_load_dwordx4 a[216:219], v2, s[8:11], s22 offen offset:2048 sc1
  buffer_load_dwordx4 a[220:223], v2, s[8:11], s22 offen offset:3072 sc1
  v_lshl_add_u32 v5, v3, 2, 0
  v_cmp_le_u32 s[40:41], v5, v4
  v_lshl_add_u32 v5, v3, 2, 1
  v_cmp_le_u32 s[42:43], v5, v4
  v_lshl_add_u32 v5, v3, 2, 2
  v_cmp_le_u32 s[44:45], v5, v4
  v_lshl_add_u32 v5, v3, 2, 3
  v_cmp_le_u32 s[46:47], v5, v4
  v_cmp_gt_u32 s[48:49], 2, v3
  v_mov_b32 v6, 0xff800000
  s_waitcnt vmcnt(0)
  v_mfma_f32_16x16x32_bf16 v[8:11], a[112:115], a[0:3], 0
  v_mfma_f32_16x16x32_bf16 v[12:15], a[112:115], a[56:59], 0
  v_mfma_f32_16x16x32_bf16 v[16:19], a[168:171], a[56:59], 0
  v_mfma_f32_16x16x32_bf16 v[8:11], a[116:119], a[4:7], v[8:11]
  v_mfma_f32_16x16x32_bf16 v[12:15], a[116:119], a[60:63], v[12:15]
  v_mfma_f32_16x16x32_bf16 v[16:19], a[172:175], a[60:63], v[16:19]
  v_mfma_f32_16x16x32_bf16 v[8:11], a[120:123], a[8:11], v[8:11]
  v_mfma_f32_16x16x32_bf16 v[12:15], a[120:123], a[64:67], v[12:15]
  v_mfma_f32_16x16x32_bf16 v[16:19], a[176:179], a[64:67], v[16:19]
  v_mfma_f32_16x16x32_bf16 v[8:11], a[124:127], a[12:15], v[8:11]
  v_mfma_f32_16x16x32_bf16 v[12:15], a[124:127], a[68:71], v[12:15]
  v_mfma_f32_16x16x32_bf16 v[16:19], a[180:183], a[68:71], v[16:19]
  v_mfma_f32_16x16x32_bf16 v[8:11], a[128:131], a[16:19], v[8:11]
  v_mfma_f32_16x16x32_bf16 v[12:15], a[128:131], a[72:75], v[12:15]
  v_mfma_f32_16x16x32_bf16 v[16:19], a[184:187], a[72:75], v[16:19]
  v_mfma_f32_16x16x32_bf16 v[8:11], a[132:135], a[20:23], v[8:11]
  v_mfma_f32_16x16x32_bf16 v[12:15], a[132:135], a[76:79], v[12:15]
  v_mfma_f32_16x16x32_bf16 v[16:19], a[188:191], a[76:79], v[16:19]
  v_mfma_f32_16x16x32_bf16 v[8:11], a[136:139], a[24:27], v[8:11]
  v_mfma_f32_16x16x32_bf16 v[12:15], a[136:139], a[80:83], v[12:15]
  v_mfma_f32_16x16x32_bf16 v[16:19], a[192:195], a[80:83], v[16:19]
  v_mfma_f32_16x16x32_bf16 v[8:11], a[140:143], a[28:31], v[8:11]
  v_mfma_f32_16x16x32_bf16 v[12:15], a[140:143], a[84:87], v[12:15]
  v_mfma_f32_16x16x32_bf16 v[16:19], a[196:199], a[84:87], v[16:19]
  v_mfma_f32_16x16x32_bf16 v[8:11], a[144:147], a[32:35], v[8:11]
  v_mfma_f32_16x16x32_bf16 v[12:15], a[144:147], a[88:91], v[12:15]
  v_mfma_f32_16x16x32_bf16 v[16:19], a[200:203], a[88:91], v[16:19]
  v_mfma_f32_16x16x32_bf16 v[8:11], a[148:151], a[36:39], v[8:11]
  v_mfma_f32_16x16x32_bf16 v[12:15], a[148:151], a[92:95], v[12:15]
  v_mfma_f32_16x16x32_bf16 v[16:19], a[204:207], a[92:95], v[16:19]
  v_mfma_f32_16x16x32_bf16 v[8:11], a[152:155], a[40:43], v[8:11]
  v_mfma_f32_16x16x32_bf16 v[12:15], a[152:155], a[96:99], v[12:15]
  v_mfma_f32_16x16x32_bf16 v[16:19], a[208:211], a[96:99], v[16:19]
  v_mfma_f32_16x16x32_bf16 v[8:11], a[156:159], a[44:47], v[8:11]
  v_mfma_f32_16x16x32_bf16 v[12:15], a[156:159], a[100:103], v[12:15]
  v_mfma_f32_16x16x32_bf16 v[16:19], a[212:215], a[100:103], v[16:19]
  v_mfma_f32_16x16x32_bf16 v[8:11], a[160:163], a[48:51], v[8:11]
  v_mfma_f32_16x16x32_bf16 v[12:15], a[160:163], a[104:107], v[12:15]
  v_mfma_f32_16x16x32_bf16 v[16:19], a[216:219], a[104:107], v[16:19]
  v_mfma_f32_16x16x32_bf16 v[8:11], a[164:167], a[52:55], v[8:11]
  v_mfma_f32_16x16x32_bf16 v[12:15], a[164:167], a[108:111], v[12:15]
  v_mfma_f32_16x16x32_bf16 v[16:19], a[220:223], a[108:111], v[16:19]
  s_mul_i32 s22, s20, 448
  v_mov_b32 v62, s22
  s_mov_b32 s30, 0
wp_pm:
  s_cmp_ge_u32 s17, 64
  s_cbranch_scc1 wp_pf
  s_cmp_ge_u32 s17, 61
  s_cbranch_scc1 mp_53a
  v_mov_b32 v61, 0
  s_mov_b64 exec, 1
  buffer_atomic_or v61, v62, s[8:11], s24 offen sc0
  s_mov_b64 exec, -1
  s_branch mp_53b
mp_53a:
  buffer_load_dword v61, v62, s[8:11], s24 offen sc1
mp_53b:
  s_waitcnt vmcnt(0)
  v_cmp_eq_u32 vcc, -1, v61
  s_cbranch_vccnz wp_pr
wp_pf:
  s_add_u32 s22, s24, 4096
  buffer_load_dwordx4 v[64:67], v2, s[8:11], s24 offen offset:0 sc1
  buffer_load_dwordx4 v[68:71], v2, s[8:11], s24 offen offset:1024 sc1
  buffer_load_dwordx4 v[72:75], v2, s[8:11], s24 offen offset:2048 sc1
  buffer_load_dwordx4 v[76:79], v2, s[8:11], s24 offen offset:3072 sc1
  buffer_load_dwordx4 v[80:83], v2, s[8:11], s22 offen offset:0 sc1
  buffer_load_dwordx4 v[84:87], v2, s[8:11], s22 offen offset:1024 sc1
  buffer_load_dwordx4 v[88:91], v2, s[8:11], s22 offen offset:2048 sc1
  s_waitcnt vmcnt(0)
  v_max_u32 v61, v64, v65
  v_max3_u32 v61, v61, v66, v67
  v_max3_u32 v61, v61, v68, v69
  v_max3_u32 v61, v61, v70, v71
  v_max3_u32 v61, v61, v72, v73
  v_max3_u32 v61, v61, v74, v75
  v_max3_u32 v61, v61, v76, v77
  v_max3_u32 v61, v61, v78, v79
  v_max3_u32 v61, v61, v80, v81
  v_max3_u32 v61, v61, v82, v83
  v_max3_u32 v61, v61, v84, v85
  v_max3_u32 v61, v61, v86, v87
  v_max3_u32 v61, v61, v88, v89
  v_max3_u32 v61, v61, v90, v91
  v_cmp_eq_u32 vcc, -1, v61
  s_cbranch_vccz wp_pk
wp_pr:
  s_sleep 1
  s_cmp_ge_u32 s17, 61
  s_cbranch_scc1 wp_pm_bo
  s_sleep 4
  s_cmp_ge_u32 s17, 56
  s_cbranch_scc1 wp_pm_bo
  s_sleep 40
wp_pm_bo:
  s_add_u32 s30, s30, 1
  s_cmp_lt_u32 s30, 30000
  s_cbranch_scc1 wp_pm
  s_branch wp_abort
wp_pk:
  s_cmp_lt_u32 s17, 56
  s_cbranch_scc1 pk_54
  buffer_load_dword v250, v251, s[12:15], 0 offen sc1
pk_54:
  v_mfma_f32_16x16x32_bf16 v[20:23], v[64:67], a[0:3], 0
  v_mfma_f32_16x16x32_bf16 v[24:27], v[64:67], a[4:7], 0
  v_mfma_f32_16x16x32_bf16 v[28:31], v[64:67], a[56:59], 0
  v_mfma_f32_16x16x32_bf16 v[32:35], v[64:67], a[60:63], 0
  v_mfma_f32_16x16x32_bf16 v[20:23], v[68:71], a[8:11], v[20:23]
  v_mfma_f32_16x16x32_bf16 v[24:27], v[68:71], a[12:15], v[24:27]
  v_mfma_f32_16x16x32_bf16 v[28:31], v[68:71], a[64:67], v[28:31]
  v_mfma_f32_16x16x32_bf16 v[32:35], v[68:71], a[68:71], v[32:35]
  v_mfma_f32_16x16x32_bf16 v[20:23], v[72:75], a[16:19], v[20:23]
  v_mfma_f32_16x16x32_bf16 v[24:27], v[72:75], a[20:23], v[24:27]
  v_mfma_f32_16x16x32_bf16 v[28:31], v[72:75], a[72:75], v[28:31]
  v_mfma_f32_16x16x32_bf16 v[32:35], v[72:75], a[76:79], v[32:35]
  v_mfma_f32_16x16x32_bf16 v[20:23], v[76:79], a[24:27], v[20:23]
  v_mfma_f32_16x16x32_bf16 v[24:27], v[76:79], a[28:31], v[24:27]
  v_mfma_f32_16x16x32_bf16 v[28:31], v[76:79], a[80:83], v[28:31]
  v_mfma_f32_16x16x32_bf16 v[32:35], v[76:79], a[84:87], v[32:35]
  v_mfma_f32_16x16x32_bf16 v[20:23], v[80:83], a[32:35], v[20:23]
  v_mfma_f32_16x16x32_bf16 v[24:27], v[80:83], a[36:39], v[24:27]
  v_mfma_f32_16x16x32_bf16 v[28:31], v[80:83], a[88:91], v[28:31]
  v_mfma_f32_16x16x32_bf16 v[32:35], v[80:83], a[92:95], v[32:35]
  v_mfma_f32_16x16x32_bf16 v[20:23], v[84:87], a[40:43], v[20:23]
  v_mfma_f32_16x16x32_bf16 v[24:27], v[84:87], a[44:47], v[24:27]
  v_mfma_f32_16x16x32_bf16 v[28:31], v[84:87], a[96:99], v[28:31]
  v_mfma_f32_16x16x32_bf16 v[32:35], v[84:87], a[100:103], v[32:35]
  v_mfma_f32_16x16x32_bf16 v[20:23], v[88:91], a[48:51], v[20:23]
  v_mfma_f32_16x16x32_bf16 v[24:27], v[88:91], a[52:55], v[24:27]
  v_mfma_f32_16x16x32_bf16 v[28:31], v[88:91], a[104:107], v[28:31]
  v_mfma_f32_16x16x32_bf16 v[32:35], v[88:91], a[108:111], v[32:35]
  s_lshl_b32 s25, s17, 1
  s_mul_i32 s25, s25, 20480
  s_add_u32 s25, s25, 85458944
  s_lshl_b32 s26, s20, 10
  s_add_u32 s26, s26, s25
  s_lshl_b32 s27, s18, 10
  s_add_u32 s27, s27, s25
  s_lshr_b32 s28, s16, 1
  s_lshl_b32 s28, s28, 3
  s_add_u32 s27, s27, s28
  s_add_u32 s27, s27, 16384
  s_and_b32 s28, s16, 1
  s_cmp_eq_u32 s28, 0
  s_cselect_b32 s50, -1, 0
  s_cselect_b32 s51, 0, -1
  v_cndmask_b32 v8, v6, v8, s[40:41]
  v_cndmask_b32 v9, v6, v9, s[42:43]
  v_cndmask_b32 v10, v6, v10, s[44:45]
  v_cndmask_b32 v11, v6, v11, s[46:47]
  v_cndmask_b32 v20, v24, v20, s[48:49]
  v_cndmask_b32 v21, v25, v21, s[48:49]
  v_cndmask_b32 v22, v26, v22, s[48:49]
  v_cndmask_b32 v23, v27, v23, s[48:49]
  v_mov_b32 v24, v20
  v_mov_b32 v25, v21
  v_mov_b32 v26, v22
  v_mov_b32 v27, v23
  v_permlane32_swap_b32 v20, v24
  v_permlane32_swap_b32 v21, v25
  v_permlane32_swap_b32 v22, v26
  v_permlane32_swap_b32 v23, v27
  v_add_f32 v20, v20, v24
  v_add_f32 v21, v21, v25
  v_add_f32 v22, v22, v26
  v_add_f32 v23, v23, v27
  v_max3_f32 v40, v8, v9, v10
  v_max3_f32 v40, v40, v11, v20
  v_max3_f32 v40, v40, v21, v22
  v_max_f32 v40, v40, v23
  v_mov_b32 v41, v40
  s_nop 1
  v_permlane16_swap_b32 v40, v41
  v_max_f32 v40, v40, v41
  v_mov_b32 v41, v40
  s_nop 1
  v_permlane32_swap_b32 v40, v41
  v_max_f32 v40, v40, v41
  v_sub_f32 v8, v8, v40
  v_sub_f32 v9, v9, v40
  v_sub_f32 v10, v10, v40
  v_sub_f32 v11, v11, v40
  v_sub_f32 v20, v20, v40
  v_sub_f32 v21, v21, v40
  v_sub_f32 v22, v22, v40
  v_sub_f32 v23, v23, v40
  v_exp_f32 v8, v8
  v_exp_f32 v9, v9
  v_exp_f32 v10, v10
  v_exp_f32 v11, v11
  v_exp_f32 v20, v20
  v_exp_f32 v21, v21
  v_exp_f32 v22, v22
  v_exp_f32 v23, v23
  v_add_f32 v42, v20, v21
  v_add_f32 v43, v22, v23
  v_add_f32 v42, v42, v43
  v_mul_f32 v42, 0.5, v42
  v_add_f32 v42, v42, v8
  v_add_f32 v42, v42, v9
  v_add_f32 v42, v42, v10
  v_add_f32 v42, v42, v11
  v_mov_b32 v41, v42
  s_nop 1
  v_permlane16_swap_b32 v42, v41
  v_add_f32 v42, v42, v41
  v_mov_b32 v41, v42
  s_nop 1
  v_permlane32_swap_b32 v42, v41
  v_add_f32 v42, v42, v41
  v_rcp_f32 v42, v42
  s_nop 0
  v_mul_f32 v8, v8, v42
  v_mul_f32 v9, v9, v42
  v_mul_f32 v10, v10, v42
  v_mul_f32 v11, v11, v42
  v_mul_f32 v20, v20, v42
  v_mul_f32 v21, v21, v42
  v_mul_f32 v22, v22, v42
  v_mul_f32 v23, v23, v42
  v_cvt_pk_bf16_f32 v44, v8, v9
  v_cvt_pk_bf16_f32 v45, v10, v11
  v_mov_b32 v46, 0
  v_mov_b32 v47, 0
  v_cvt_pk_bf16_f32 v48, v20, v21
  v_cvt_pk_bf16_f32 v49, v22, v23
  v_min_u32 v44, -2, v44
  v_min_u32 v45, -2, v45
  v_min_u32 v46, -2, v46
  v_min_u32 v47, -2, v47
  v_min_u32 v48, -2, v48
  v_min_u32 v49, -2, v49
  buffer_store_dwordx4 v[44:47], v2, s[8:11], s26 offen sc1
  s_mov_b64 exec, s[50:51]
  buffer_store_dwordx2 v[48:49], v2, s[8:11], s27 offen sc1
  s_mov_b64 exec, -1
  s_add_u32 s26, s26, 20480
  s_add_u32 s27, s27, 20480
  v_cndmask_b32 v16, v6, v16, s[40:41]
  v_cndmask_b32 v17, v6, v17, s[42:43]
  v_cndmask_b32 v18, v6, v18, s[44:45]
  v_cndmask_b32 v19, v6, v19, s[46:47]
  v_cndmask_b32 v28, v32, v28, s[48:49]
  v_cndmask_b32 v29, v33, v29, s[48:49]
  v_cndmask_b32 v30, v34, v30, s[48:49]
  v_cndmask_b32 v31, v35, v31, s[48:49]
  v_mov_b32 v32, v28
  v_mov_b32 v33, v29
  v_mov_b32 v34, v30
  v_mov_b32 v35, v31
  v_permlane32_swap_b32 v28, v32
  v_permlane32_swap_b32 v29, v33
  v_permlane32_swap_b32 v30, v34
  v_permlane32_swap_b32 v31, v35
  v_add_f32 v28, v28, v32
  v_add_f32 v29, v29, v33
  v_add_f32 v30, v30, v34
  v_add_f32 v31, v31, v35
  v_max3_f32 v40, v12, v13, v14
  v_max3_f32 v40, v40, v15, v16
  v_max3_f32 v40, v40, v17, v18
  v_max3_f32 v40, v40, v19, v28
  v_max3_f32 v40, v40, v29, v30
  v_max_f32 v40, v40, v31
  v_mov_b32 v41, v40
  s_nop 1
  v_permlane16_swap_b32 v40, v41
  v_max_f32 v40, v40, v41
  v_mov_b32 v41, v40
  s_nop 1
  v_permlane32_swap_b32 v40, v41
  v_max_f32 v40, v40, v41
  v_sub_f32 v12, v12, v40
  v_sub_f32 v13, v13, v40
  v_sub_f32 v14, v14, v40
  v_sub_f32 v15, v15, v40
  v_sub_f32 v16, v16, v40
  v_sub_f32 v17, v17, v40
  v_sub_f32 v18, v18, v40
  v_sub_f32 v19, v19, v40
  v_sub_f32 v28, v28, v40
  v_sub_f32 v29, v29, v40
  v_sub_f32 v30, v30, v40
  v_sub_f32 v31, v31, v40
  v_exp_f32 v12, v12
  v_exp_f32 v13, v13
  v_exp_f32 v14, v14
  v_exp_f32 v15, v15
  v_exp_f32 v16, v16
  v_exp_f32 v17, v17
  v_exp_f32 v18, v18
  v_exp_f32 v19, v19
  v_exp_f32 v28, v28
  v_exp_f32 v29, v29
  v_exp_f32 v30, v30
  v_exp_f32 v31, v31
  v_add_f32 v42, v28, v29
  v_add_f32 v43, v30, v31
  v_add_f32 v42, v42, v43
  v_mul_f32 v42, 0.5, v42
  v_add_f32 v42, v42, v12
  v_add_f32 v42, v42, v13
  v_add_f32 v42, v42, v14
  v_add_f32 v42, v42, v15
  v_add_f32 v42, v42, v16
  v_add_f32 v42, v42, v17
  v_add_f32 v42, v42, v18
  v_add_f32 v42, v42, v19
  v_mov_b32 v41, v42
  s_nop 1
  v_permlane16_swap_b32 v42, v41
  v_add_f32 v42, v42, v41
  v_mov_b32 v41, v42
  s_nop 1
  v_permlane32_swap_b32 v42, v41
  v_add_f32 v42, v42, v41
  v_rcp_f32 v42, v42
  s_nop 0
  v_mul_f32 v12, v12, v42
  v_mul_f32 v13, v13, v42
  v_mul_f32 v14, v14, v42
  v_mul_f32 v15, v15, v42
  v_mul_f32 v16, v16, v42
  v_mul_f32 v17, v17, v42
  v_mul_f32 v18, v18, v42
  v_mul_f32 v19, v19, v42
  v_mul_f32 v28, v28, v42
  v_mul_f32 v29, v29, v42
  v_mul_f32 v30, v30, v42
  v_mul_f32 v31, v31, v42
  v_cvt_pk_bf16_f32 v52, v12, v13
  v_cvt_pk_bf16_f32 v53, v14, v15
  v_cvt_pk_bf16_f32 v54, v16, v17
  v_cvt_pk_bf16_f32 v55, v18, v19
  v_cvt_pk_bf16_f32 v56, v28, v29
  v_cvt_pk_bf16_f32 v57, v30, v31
  v_min_u32 v52, -2, v52
  v_min_u32 v53, -2, v53
  v_min_u32 v54, -2, v54
  v_min_u32 v55, -2, v55
  v_min_u32 v56, -2, v56
  v_min_u32 v57, -2, v57
  buffer_store_dwordx4 v[52:55], v2, s[8:11], s26 offen sc1
  s_mov_b64 exec, s[50:51]
  buffer_store_dwordx2 v[56:57], v2, s[8:11], s27 offen sc1
  s_mov_b64 exec, -1
  s_lshl_b32 s25, s17, 7
  s_add_u32 s25, s25, 88573952
  v_mov_b32 v5, 1
  v_mov_b32 v6, 0
  s_waitcnt vmcnt(0)
  s_mov_b64 exec, 1
  buffer_atomic_add v5, v6, s[8:11], s25 offen
  s_mov_b64 exec, -1
  s_branch wk_loop
wk_toko:
  s_lshl_b32 s20, s18, 2
  s_add_u32 s20, s20, s16
  s_mul_i32 s24, s20, 65
  s_add_u32 s24, s24, s17
  s_lshl_b32 s24, s24, 13
  s_add_u32 s24, s24, 76947456
  s_lshl_b32 s21, s20, 6
  s_add_u32 s21, s21, s17
  s_mul_i32 s21, s21, 28672
  s_add_u32 s21, s21, 42205184
  s_lshl_b32 s25, s17, 1
  s_mul_i32 s25, s25, 20480
  s_add_u32 s25, s25, 85458944
  v_lshrrev_b32 v8, 5, v1
  v_and_b32 v9, 31, v1
  v_lshrrev_b32 v10, 4, v9
  v_min_u32 v5, 27, v9
  v_and_b32 v5, 15, v5
  v_lshlrev_b32 v6, 1, v10
  v_sub_u32 v6, 8, v6
  v_lshlrev_b32 v7, 10, v10
  v_lshl_add_u32 v7, v5, 4, v7
  v_lshlrev_b32 v6, 5, v6
  v_mad_u32_u24 v5, v8, v6, v7
  v_lshl_add_u32 v63, v6, 1, v5
  v_lshl_add_u32 v7, v8, 3, v7
  v_mul_u32_u24 v6, 20480, v10
  v_lshl_add_u32 v6, v8, 8, v6
  v_lshl_add_u32 v6, v4, 4, v6
  s_lshr_b32 s26, s17, 3
  s_lshl_b32 s26, s26, 4
  s_add_u32 s26, s26, s20
  s_lshl_b32 s26, s26, 7
  s_add_u32 s26, s26, 88541184
  v_mov_b32 v60, 0
  s_mov_b32 s30, 0
wo_wv:
  buffer_load_dword v61, v60, s[8:11], s26 offen sc1
  s_waitcnt vmcnt(0)
  v_cmp_ne_u32 vcc, 56, v61
  s_cbranch_vccz wo_wv_ok
  s_sleep 1
  s_cmp_ge_u32 s17, 61
  s_cbranch_scc1 wo_wv_bo
  s_sleep 4
  s_cmp_ge_u32 s17, 56
  s_cbranch_scc1 wo_wv_bo
  s_sleep 40
wo_wv_bo:
  s_add_u32 s30, s30, 1
  s_cmp_lt_u32 s30, 30000
  s_cbranch_scc1 wo_wv
  s_branch wo_abort
wo_wv_ok:
  s_add_u32 s22, s21, 0
  buffer_load_dwordx4 a[0:3], v5, s[8:11], s22 offen offset:0 sc1
  buffer_load_dwordx4 a[4:7], v63, s[8:11], s22 offen offset:0 sc1
  buffer_load_dwordx4 a[8:11], v5, s[8:11], s22 offen offset:1792 sc1
  buffer_load_dwordx4 a[12:15], v63, s[8:11], s22 offen offset:1792 sc1
  s_add_u32 s22, s21, 3584
  buffer_load_dwordx4 a[16:19], v5, s[8:11], s22 offen offset:0 sc1
  buffer_load_dwordx4 a[20:23], v63, s[8:11], s22 offen offset:0 sc1
  buffer_load_dwordx4 a[24:27], v5, s[8:11], s22 offen offset:1792 sc1
  buffer_load_dwordx4 a[28:31], v63, s[8:11], s22 offen offset:1792 sc1
  s_add_u32 s22, s21, 7168
  buffer_load_dwordx4 a[32:35], v5, s[8:11], s22 offen offset:0 sc1
  buffer_load_dwordx4 a[36:39], v63, s[8:11], s22 offen offset:0 sc1
  buffer_load_dwordx4 a[40:43], v5, s[8:11], s22 offen offset:1792 sc1
  buffer_load_dwordx4 a[44:47], v63, s[8:11], s22 offen offset:1792 sc1
  s_add_u32 s22, s21, 10752
  buffer_load_dwordx4 a[48:51], v5, s[8:11], s22 offen offset:0 sc1
  buffer_load_dwordx4 a[52:55], v63, s[8:11], s22 offen offset:0 sc1
  buffer_load_dwordx4 a[56:59], v5, s[8:11], s22 offen offset:1792 sc1
  buffer_load_dwordx4 a[60:63], v63, s[8:11], s22 offen offset:1792 sc1
  s_add_u32 s22, s21, 14336
  buffer_load_dwordx4 a[64:67], v5, s[8:11], s22 offen offset:0 sc1
  buffer_load_dwordx4 a[68:71], v63, s[8:11], s22 offen offset:0 sc1
  buffer_load_dwordx4 a[72:75], v5, s[8:11], s22 offen offset:1792 sc1
  buffer_load_dwordx4 a[76:79], v63, s[8:11], s22 offen offset:1792 sc1
  s_add_u32 s22, s21, 17920
  buffer_load_dwordx4 a[80:83], v5, s[8:11], s22 offen offset:0 sc1
  buffer_load_dwordx4 a[84:87], v63, s[8:11], s22 offen offset:0 sc1
  buffer_load_dwordx4 a[88:91], v5, s[8:11], s22 offen offset:1792 sc1
  buffer_load_dwordx4 a[92:95], v63, s[8:11], s22 offen offset:1792 sc1
  s_add_u32 s22, s21, 21504
  buffer_load_dwordx4 a[96:99], v5, s[8:11], s22 offen offset:0 sc1
  buffer_load_dwordx4 a[100:103], v63, s[8:11], s22 offen offset:0 sc1
  buffer_load_dwordx4 a[104:107], v5, s[8:11], s22 offen offset:1792 sc1
  buffer_load_dwordx4 a[108:111], v63, s[8:11], s22 offen offset:1792 sc1
  s_add_u32 s22, s21, 25088
  buffer_load_dwordx4 a[112:115], v5, s[8:11], s22 offen offset:0 sc1
  buffer_load_dwordx4 a[116:119], v63, s[8:11], s22 offen offset:0 sc1
  buffer_load_dwordx4 a[120:123], v5, s[8:11], s22 offen offset:1792 sc1
  buffer_load_dwordx4 a[124:127], v63, s[8:11], s22 offen offset:1792 sc1
  s_cmp_ge_u32 s17, 61
  s_cbranch_scc1 wo_lm
  s_lshl_b32 s26, s17, 7
  s_add_u32 s26, s26, 88573952
  v_mov_b32 v60, 0
  s_mov_b32 s30, 0
wo_wp:
  buffer_load_dword v61, v60, s[8:11], s26 offen sc1
  s_waitcnt vmcnt(0)
  v_cmp_ne_u32 vcc, 16, v61
  s_cbranch_vccz wo_wp_ok
  s_sleep 2
  s_cmp_ge_u32 s17, 61
  s_cbranch_scc1 wo_wp_bo
  s_sleep 4
  s_cmp_ge_u32 s17, 56
  s_cbranch_scc1 wo_wp_bo
  s_sleep 40
wo_wp_bo:
  s_add_u32 s30, s30, 1
  s_cmp_lt_u32 s30, 30000
  s_cbranch_scc1 wo_wp
  s_branch wo_abort
wo_wp_ok:
  s_branch wo_lp
wo_lm:
  s_mul_i32 s26, s17, 7168
  s_add_u32 s26, s26, 88080384
  v_mov_b32 v60, 0
  s_mov_b32 s30, 0
wo_wm:
  buffer_load_dword v61, v60, s[8:11], s26 offen sc1
  s_waitcnt vmcnt(0)
  v_cmp_eq_u32 vcc, -1, v61
  s_cbranch_vccz wo_wm_ok
  s_sleep 2
  s_cmp_ge_u32 s17, 61
  s_cbranch_scc1 wo_wm_bo
  s_sleep 4
  s_cmp_ge_u32 s17, 56
  s_cbranch_scc1 wo_wm_bo
  s_sleep 40
wo_wm_bo:
  s_add_u32 s30, s30, 1
  s_cmp_lt_u32 s30, 30000
  s_cbranch_scc1 wo_wm
  s_branch wo_abort
wo_wm_ok:
wo_lp:
  s_mul_i32 s26, s16, 10240
  s_add_u32 s27, s25, s26
  v_add_u32 v11, s26, v2
  s_lshl_b32 s26, s20, 6
  s_add_u32 s26, s26, s17
  s_lshl_b32 s26, s26, 4
  s_add_u32 s26, s26, 88582144
  v_lshlrev_b32 v60, 2, v3
  s_mov_b32 s30, 0
wo_pl:
  s_add_u32 s22, s27, 0
  buffer_load_dwordx4 v[128:131], v2, s[8:11], s22 offen offset:0 sc1
  buffer_load_dwordx4 v[132:135], v2, s[8:11], s22 offen offset:1024 sc1
  buffer_load_dwordx4 v[136:139], v2, s[8:11], s22 offen offset:2048 sc1
  buffer_load_dwordx4 v[140:143], v2, s[8:11], s22 offen offset:3072 sc1
  s_add_u32 s22, s27, 4096
  buffer_load_dwordx4 v[144:147], v2, s[8:11], s22 offen offset:0 sc1
  buffer_load_dwordx4 v[148:151], v2, s[8:11], s22 offen offset:1024 sc1
  buffer_load_dwordx4 v[152:155], v2, s[8:11], s22 offen offset:2048 sc1
  buffer_load_dwordx4 v[156:159], v2, s[8:11], s22 offen offset:3072 sc1
  s_add_u32 s22, s27, 8192
  buffer_load_dwordx4 v[160:163], v2, s[8:11], s22 offen offset:0 sc1
  buffer_load_dwordx4 v[164:167], v2, s[8:11], s22 offen offset:1024 sc1
  buffer_load_dword v61, v60, s[8:11], s26 offen sc1
  s_waitcnt vmcnt(1)
  v_max_u32 v62, v128, v129
  v_max3_u32 v62, v62, v130, v131
  v_max3_u32 v62, v62, v132, v133
  v_max3_u32 v62, v62, v134, v135
  v_max3_u32 v62, v62, v136, v137
  v_max3_u32 v62, v62, v138, v139
  v_max3_u32 v62, v62, v140, v141
  v_max3_u32 v62, v62, v142, v143
  v_max3_u32 v62, v62, v144, v145
  v_max3_u32 v62, v62, v146, v147
  v_max3_u32 v62, v62, v148, v149
  v_max3_u32 v62, v62, v150, v151
  v_max3_u32 v62, v62, v152, v153
  v_max3_u32 v62, v62, v154, v155
  v_max3_u32 v62, v62, v156, v157
  v_max3_u32 v62, v62, v158, v159
  v_max3_u32 v62, v62, v160, v161
  v_max3_u32 v62, v62, v162, v163
  v_max3_u32 v62, v62, v164, v165
  v_max3_u32 v62, v62, v166, v167
  v_cmp_eq_u32 vcc, -1, v62
  s_cbranch_vccz wo_pk
  s_add_u32 s30, s30, 1
  s_cmp_lt_u32 s30, 30000
  s_cbranch_scc1 wo_pl
  s_branch wo_abort
wo_pk:
  ds_write_b128 v11, v[128:131] offset:0
  ds_write_b128 v11, v[132:135] offset:1024
  ds_write_b128 v11, v[136:139] offset:2048
  ds_write_b128 v11, v[140:143] offset:3072
  ds_write_b128 v11, v[144:147] offset:4096
  ds_write_b128 v11, v[148:151] offset:5120
  ds_write_b128 v11, v[152:155] offset:6144
  ds_write_b128 v11, v[156:159] offset:7168
  ds_write_b128 v11, v[160:163] offset:8192
  ds_write_b128 v11, v[164:167] offset:9216
  s_waitcnt vmcnt(0)
  v_cmp_ne_u32 vcc, 1, v61
  s_mov_b32 s28, 0
  s_cbranch_vccnz wo_nt
  s_add_u32 s22, s24, 0
  buffer_load_dwordx2 v[28:29], v7, s[8:11], s22 offen offset:0 sc1
  buffer_load_dwordx2 v[30:31], v7, s[8:11], s22 offen offset:512 sc1
  buffer_load_dwordx2 v[32:33], v7, s[8:11], s22 offen offset:256 sc1
  buffer_load_dwordx2 v[34:35], v7, s[8:11], s22 offen offset:768 sc1
  buffer_load_dwordx2 v[36:37], v7, s[8:11], s22 offen offset:2048 sc1
  buffer_load_dwordx2 v[38:39], v7, s[8:11], s22 offen offset:2560 sc1
  buffer_load_dwordx2 v[40:41], v7, s[8:11], s22 offen offset:2304 sc1
  buffer_load_dwordx2 v[42:43], v7, s[8:11], s22 offen offset:2816 sc1
  s_add_u32 s22, s24, 4096
  buffer_load_dwordx2 v[44:45], v7, s[8:11], s22 offen offset:0 sc1
  buffer_load_dwordx2 v[46:47], v7, s[8:11], s22 offen offset:512 sc1
  buffer_load_dwordx2 v[48:49], v7, s[8:11], s22 offen offset:256 sc1
  buffer_load_dwordx2 v[50:51], v7, s[8:11], s22 offen offset:768 sc1
  buffer_load_dwordx2 v[52:53], v7, s[8:11], s22 offen offset:2048 sc1
  buffer_load_dwordx2 v[54:55], v7, s[8:11], s22 offen offset:2560 sc1
  buffer_load_dwordx2 v[56:57], v7, s[8:11], s22 offen offset:2304 sc1
  buffer_load_dwordx2 v[58:59], v7, s[8:11], s22 offen offset:2816 sc1
  s_mov_b32 s28, 1
wo_nt:
  s_cmp_lt_u32 s17, 56
  s_cbranch_scc1 pk_55
  buffer_load_dword v250, v251, s[12:15], 0 offen sc1
pk_55:
  s_waitcnt lgkmcnt(0)
  s_barrier
  buffer_load_dword v61, v60, s[8:11], s26 offen sc1
  ds_read_b128 v[64:67], v6 offset:0
  ds_read_b128 v[68:71], v6 offset:512
  ds_read_b128 v[72:75], v6 offset:1024
  ds_read_b128 v[76:79], v6 offset:1536
  ds_read_b128 v[80:83], v6 offset:2048
  ds_read_b128 v[84:87], v6 offset:2560
  ds_read_b128 v[88:91], v6 offset:3072
  s_waitcnt lgkmcnt(6)
  v_mfma_f32_32x32x16_bf16 v[12:27], a[0:3], v[64:67], 0
  ds_read_b128 v[92:95], v6 offset:3584
  s_waitcnt lgkmcnt(6)
  v_mfma_f32_32x32x16_bf16 v[12:27], a[4:7], v[68:71], v[12:27]
  ds_read_b128 v[64:67], v6 offset:4096
  s_waitcnt lgkmcnt(6)
  v_mfma_f32_32x32x16_bf16 v[12:27], a[8:11], v[72:75], v[12:27]
  ds_read_b128 v[68:71], v6 offset:4608
  s_waitcnt lgkmcnt(6)
  v_mfma_f32_32x32x16_bf16 v[12:27], a[12:15], v[76:79], v[12:27]
  ds_read_b128 v[72:75], v6 offset:5120
  s_waitcnt lgkmcnt(6)
  v_mfma_f32_32x32x16_bf16 v[12:27], a[16:19], v[80:83], v[12:27]
  ds_read_b128 v[76:79], v6 offset:5632
  s_waitcnt lgkmcnt(6)
  v_mfma_f32_32x32x16_bf16 v[12:27], a[20:23], v[84:87], v[12:27]
  ds_read_b128 v[80:83], v6 offset:6144
  s_waitcnt lgkmcnt(6)
  v_mfma_f32_32x32x16_bf16 v[12:27], a[24:27], v[88:91], v[12:27]
  ds_read_b128 v[84:87], v6 offset:6656
  s_waitcnt lgkmcnt(6)
  v_mfma_f32_32x32x16_bf16 v[12:27], a[28:31], v[92:95], v[12:27]
  ds_read_b128 v[88:91], v6 offset:7168
  s_waitcnt lgkmcnt(6)
  v_mfma_f32_32x32x16_bf16 v[12:27], a[32:35], v[64:67], v[12:27]
  ds_read_b128 v[92:95], v6 offset:7680
  s_waitcnt lgkmcnt(6)
  v_mfma_f32_32x32x16_bf16 v[12:27], a[36:39], v[68:71], v[12:27]
  ds_read_b128 v[64:67], v6 offset:8192
  s_waitcnt lgkmcnt(6)
  v_mfma_f32_32x32x16_bf16 v[12:27], a[40:43], v[72:75], v[12:27]
  ds_read_b128 v[68:71], v6 offset:8704
  s_waitcnt lgkmcnt(6)
  v_mfma_f32_32x32x16_bf16 v[12:27], a[44:47], v[76:79], v[12:27]
  ds_read_b128 v[72:75], v6 offset:9216
  s_waitcnt lgkmcnt(6)
  v_mfma_f32_32x32x16_bf16 v[12:27], a[48:51], v[80:83], v[12:27]
  ds_read_b128 v[76:79], v6 offset:9728
  s_waitcnt lgkmcnt(6)
  v_mfma_f32_32x32x16_bf16 v[12:27], a[52:55], v[84:87], v[12:27]
  ds_read_b128 v[80:83], v6 offset:10240
  s_waitcnt lgkmcnt(6)
  v_mfma_f32_32x32x16_bf16 v[12:27], a[56:59], v[88:91], v[12:27]
  ds_read_b128 v[84:87], v6 offset:10752
  s_waitcnt lgkmcnt(6)
  v_mfma_f32_32x32x16_bf16 v[12:27], a[60:63], v[92:95], v[12:27]
  ds_read_b128 v[88:91], v6 offset:11264
  s_waitcnt lgkmcnt(6)
  v_mfma_f32_32x32x16_bf16 v[12:27], a[64:67], v[64:67], v[12:27]
  ds_read_b128 v[92:95], v6 offset:11776
  s_waitcnt lgkmcnt(6)
  v_mfma_f32_32x32x16_bf16 v[12:27], a[68:71], v[68:71], v[12:27]
  ds_read_b128 v[64:67], v6 offset:12288
  s_waitcnt lgkmcnt(6)
  v_mfma_f32_32x32x16_bf16 v[12:27], a[72:75], v[72:75], v[12:27]
  ds_read_b128 v[68:71], v6 offset:12800
  s_waitcnt lgkmcnt(6)
  v_mfma_f32_32x32x16_bf16 v[12:27], a[76:79], v[76:79], v[12:27]
  s_cmp_lg_u32 s28, 0
  s_cbranch_scc1 wo_h2
  s_waitcnt vmcnt(0)
  v_cmp_ne_u32 vcc, 1, v61
  s_cbranch_vccnz wo_h2
  s_add_u32 s22, s24, 0
  buffer_load_dwordx2 v[28:29], v7, s[8:11], s22 offen offset:0 sc1
  buffer_load_dwordx2 v[30:31], v7, s[8:11], s22 offen offset:512 sc1
  buffer_load_dwordx2 v[32:33], v7, s[8:11], s22 offen offset:256 sc1
  buffer_load_dwordx2 v[34:35], v7, s[8:11], s22 offen offset:768 sc1
  buffer_load_dwordx2 v[36:37], v7, s[8:11], s22 offen offset:2048 sc1
  buffer_load_dwordx2 v[38:39], v7, s[8:11], s22 offen offset:2560 sc1
  buffer_load_dwordx2 v[40:41], v7, s[8:11], s22 offen offset:2304 sc1
  buffer_load_dwordx2 v[42:43], v7, s[8:11], s22 offen offset:2816 sc1
  s_add_u32 s22, s24, 4096
  buffer_load_dwordx2 v[44:45], v7, s[8:11], s22 offen offset:0 sc1
  buffer_load_dwordx2 v[46:47], v7, s[8:11], s22 offen offset:512 sc1
  buffer_load_dwordx2 v[48:49], v7, s[8:11], s22 offen offset:256 sc1
  buffer_load_dwordx2 v[50:51], v7, s[8:11], s22 offen offset:768 sc1
  buffer_load_dwordx2 v[52:53], v7, s[8:11], s22 offen offset:2048 sc1
  buffer_load_dwordx2 v[54:55], v7, s[8:11], s22 offen offset:2560 sc1
  buffer_load_dwordx2 v[56:57], v7, s[8:11], s22 offen offset:2304 sc1
  buffer_load_dwordx2 v[58:59], v7, s[8:11], s22 offen offset:2816 sc1
  s_mov_b32 s28, 1
wo_h2:
  ds_read_b128 v[72:75], v6 offset:13312
  s_waitcnt lgkmcnt(6)
  v_mfma_f32_32x32x16_bf16 v[12:27], a[80:83], v[80:83], v[12:27]
  ds_read_b128 v[76:79], v6 offset:13824
  s_waitcnt lgkmcnt(6)
  v_mfma_f32_32x32x16_bf16 v[12:27], a[84:87], v[84:87], v[12:27]
  ds_read_b128 v[80:83], v6 offset:14336
  s_waitcnt lgkmcnt(6)
  v_mfma_f32_32x32x16_bf16 v[12:27], a[88:91], v[88:91], v[12:27]
  ds_read_b128 v[84:87], v6 offset:14848
  s_waitcnt lgkmcnt(6)
  v_mfma_f32_32x32x16_bf16 v[12:27], a[92:95], v[92:95], v[12:27]
  ds_read_b128 v[88:91], v6 offset:15360
  s_waitcnt lgkmcnt(6)
  v_mfma_f32_32x32x16_bf16 v[12:27], a[96:99], v[64:67], v[12:27]
  ds_read_b128 v[92:95], v6 offset:15872
  s_waitcnt lgkmcnt(6)
  v_mfma_f32_32x32x16_bf16 v[12:27], a[100:103], v[68:71], v[12:27]
  ds_read_b128 v[64:67], v6 offset:16384
  s_waitcnt lgkmcnt(6)
  v_mfma_f32_32x32x16_bf16 v[12:27], a[104:107], v[72:75], v[12:27]
  ds_read_b128 v[68:71], v6 offset:16896
  s_waitcnt lgkmcnt(6)
  v_mfma_f32_32x32x16_bf16 v[12:27], a[108:111], v[76:79], v[12:27]
  ds_read_b128 v[72:75], v6 offset:17408
  s_waitcnt lgkmcnt(6)
  v_mfma_f32_32x32x16_bf16 v[12:27], a[112:115], v[80:83], v[12:27]
  ds_read_b128 v[76:79], v6 offset:17920
  s_waitcnt lgkmcnt(6)
  v_mfma_f32_32x32x16_bf16 v[12:27], a[116:119], v[84:87], v[12:27]
  ds_read_b128 v[80:83], v6 offset:18432
  s_waitcnt lgkmcnt(6)
  v_mfma_f32_32x32x16_bf16 v[12:27], a[120:123], v[88:91], v[12:27]
  ds_read_b128 v[84:87], v6 offset:18944
  s_waitcnt lgkmcnt(6)
  v_mfma_f32_32x32x16_bf16 v[12:27], a[124:127], v[92:95], v[12:27]
  s_cmp_lg_u32 s28, 0
  s_cbranch_scc1 wo_ht
  v_lshlrev_b32 v60, 2, v3
  s_mov_b32 s30, 0
wo_wt:
  buffer_load_dword v61, v60, s[8:11], s26 offen sc1
  s_waitcnt vmcnt(0)
  v_cmp_ne_u32 vcc, 1, v61
  s_cbranch_vccz wo_wt_ok
  s_sleep 1
  s_cmp_ge_u32 s17, 61
  s_cbranch_scc1 wo_wt_bo
  s_sleep 4
  s_cmp_ge_u32 s17, 56
  s_cbranch_scc1 wo_wt_bo
  s_sleep 40
wo_wt_bo:
  s_add_u32 s30, s30, 1
  s_cmp_lt_u32 s30, 30000
  s_cbranch_scc1 wo_wt
  s_branch wo_abort
wo_wt_ok:
  s_add_u32 s22, s24, 0
  buffer_load_dwordx2 v[28:29], v7, s[8:11], s22 offen offset:0 sc1
  buffer_load_dwordx2 v[30:31], v7, s[8:11], s22 offen offset:512 sc1
  buffer_load_dwordx2 v[32:33], v7, s[8:11], s22 offen offset:256 sc1
  buffer_load_dwordx2 v[34:35], v7, s[8:11], s22 offen offset:768 sc1
  buffer_load_dwordx2 v[36:37], v7, s[8:11], s22 offen offset:2048 sc1
  buffer_load_dwordx2 v[38:39], v7, s[8:11], s22 offen offset:2560 sc1
  buffer_load_dwordx2 v[40:41], v7, s[8:11], s22 offen offset:2304 sc1
  buffer_load_dwordx2 v[42:43], v7, s[8:11], s22 offen offset:2816 sc1
  s_add_u32 s22, s24, 4096
  buffer_load_dwordx2 v[44:45], v7, s[8:11], s22 offen offset:0 sc1
  buffer_load_dwordx2 v[46:47], v7, s[8:11], s22 offen offset:512 sc1
  buffer_load_dwordx2 v[48:49], v7, s[8:11], s22 offen offset:256 sc1
  buffer_load_dwordx2 v[50:51], v7, s[8:11], s22 offen offset:768 sc1
  buffer_load_dwordx2 v[52:53], v7, s[8:11], s22 offen offset:2048 sc1
  buffer_load_dwordx2 v[54:55], v7, s[8:11], s22 offen offset:2560 sc1
  buffer_load_dwordx2 v[56:57], v7, s[8:11], s22 offen offset:2304 sc1
  buffer_load_dwordx2 v[58:59], v7, s[8:11], s22 offen offset:2816 sc1
wo_ht:
  ds_read_b128 v[88:91], v6 offset:19456
  s_waitcnt lgkmcnt(6) vmcnt(0)
  v_mfma_f32_32x32x16_bf16 v[12:27], v[28:31], v[64:67], v[12:27]
  ds_read_b128 v[92:95], v6 offset:19968
  s_waitcnt lgkmcnt(6)
  v_mfma_f32_32x32x16_bf16 v[12:27], v[32:35], v[68:71], v[12:27]
  s_waitcnt lgkmcnt(5)
  v_mfma_f32_32x32x16_bf16 v[12:27], v[36:39], v[72:75], v[12:27]
  s_waitcnt lgkmcnt(4)
  v_mfma_f32_32x32x16_bf16 v[12:27], v[40:43], v[76:79], v[12:27]
  s_waitcnt lgkmcnt(3)
  v_mfma_f32_32x32x16_bf16 v[12:27], v[44:47], v[80:83], v[12:27]
  s_waitcnt lgkmcnt(2)
  v_mfma_f32_32x32x16_bf16 v[12:27], v[48:51], v[84:87], v[12:27]
  s_waitcnt lgkmcnt(1)
  v_mfma_f32_32x32x16_bf16 v[12:27], v[52:55], v[88:91], v[12:27]
  s_waitcnt lgkmcnt(0)
  v_mfma_f32_32x32x16_bf16 v[12:27], v[56:59], v[92:95], v[12:27]
  v_mul_u32_u24 v9, 240, v9
  s_movk_i32 s23, 240
  v_lshl_add_u32 v8, v8, 3, v9
  s_mul_i32 s22, s16, 24
  v_add_u32 v7, s22, v8
  s_lshl_b32 s22, s16, 5
  v_add_u32 v8, s22, v8
  v_min_u32 v11, 223, v0
  v_mul_u32_u24 v9, 4682, v11
  v_lshrrev_b32 v9, 16, v9
  v_mul_u32_u24 v10, 14, v9
  v_sub_u32 v10, v11, v10
  v_cmp_gt_u32 vcc, 8, v10
  v_lshlrev_b32 v10, 4, v10
  v_mad_u32_u24 v11, v9, s23, v10
  v_mul_u32_u24 v9, 1792, v9
  v_add_u32 v10, v9, v10
  s_lshl_b32 s22, s18, 7
  s_mul_i32 s27, s18, 96
  s_add_u32 s27, s27, 384
  v_mov_b32 v9, s22
  v_mov_b32 v5, s27
  v_cndmask_b32 v9, v5, v9, vcc
  v_add_u32 v10, v9, v10
  s_mul_i32 s26, s17, 57344
  s_add_u32 s26, s26, 896
  s_add_u32 s27, s26, 28672
  v_cvt_pk_bf16_f32 v96, v12, v13
  v_cvt_pk_bf16_f32 v97, v14, v15
  ds_write_b64 v8, v[96:97] offset:49152
  v_cvt_pk_bf16_f32 v98, v16, v17
  v_cvt_pk_bf16_f32 v99, v18, v19
  ds_write_b64 v8, v[98:99] offset:49168
  v_cvt_pk_bf16_f32 v100, v20, v21
  v_cvt_pk_bf16_f32 v101, v22, v23
  ds_write_b64 v7, v[100:101] offset:49280
  v_cvt_pk_bf16_f32 v102, v24, v25
  v_cvt_pk_bf16_f32 v103, v26, v27
  s_mov_b32 exec_hi, 0
  ds_write_b64 v7, v[102:103] offset:49296
  s_mov_b64 exec, -1
  s_waitcnt lgkmcnt(0)
  s_barrier
  ds_read_b128 v[104:107], v11 offset:49152
  ds_read_b128 v[108:111], v11 offset:52992
  s_cmp_lg_u32 s16, 3
  s_cselect_b32 exec_hi, -1, 0
  s_waitcnt lgkmcnt(1)
  buffer_store_dwordx4 v[104:107], v10, s[92:95], s26 offen
  s_waitcnt lgkmcnt(0)
  buffer_store_dwordx4 v[108:111], v10, s[92:95], s27 offen
  s_mov_b64 exec, -1
  v_readfirstlane_b32 s22, v250
  s_cmp_ge_u32 s22, 1440
  s_cbranch_scc1 ch_end
  s_branch wk_loop
wp_abort:
wo_abort:
  s_branch cA_abort
ch_end:
  s_endpgm

.section .rodata,"a"
.p2align 6
.amdhsa_kernel main_kernel
  .amdhsa_next_free_vgpr 512
  .amdhsa_next_free_sgpr 102
  .amdhsa_accum_offset 256
  .amdhsa_group_segment_fixed_size 0
  .amdhsa_kernarg_size 136
  .amdhsa_user_sgpr_count 2
  .amdhsa_user_sgpr_kernarg_segment_ptr 1
  .amdhsa_system_sgpr_workgroup_id_x 1
.end_amdhsa_kernel
```

```asm
; @launch kernel=main_kernel grid=(256,1,1) block=(256,1,1) lds=163840
.amdgcn_target "amdgcn-amd-amdhsa--gfx950"
.text
.globl main_kernel
.p2align 8
.type main_kernel,@function
main_kernel:
  s_cmp_ge_u32 s2, 256
  s_cbranch_scc1 ch_end
  s_load_dwordx4 s[4:7], s[0:1], 120
  s_load_dwordx2 s[92:93], s[0:1], 112
  s_load_dwordx8 s[36:43], s[0:1], 56
  s_load_dwordx4 s[44:47], s[0:1], 88
  s_memrealtime s[88:89]
  s_getpc_b64 s[98:99]
pf_main_kernel_1:
  s_sub_u32 s98, s98, pf_main_kernel_1-main_kernel
  s_subb_u32 s99, s99, 0
  s_lshr_b32 s20, s2, 3
  v_lshl_add_u32 v60, v0, 5, s20
  v_lshlrev_b32 v60, 7, v60
  v_min_u32 v60, ch_end-main_kernel-4, v60
  v_cmp_gt_u32 vcc, 32, v0
  s_and_saveexec_b64 s[22:23], vcc
  s_cbranch_execz pf_main_kernel_1_n
  global_load_dword v62, v60, s[98:99]
pf_main_kernel_1_n:
  s_mov_b64 exec, -1
  s_getreg_b32 s67, hwreg(HW_REG_XCC_ID)
  s_and_b32 s67, s67, 7
  v_lshrrev_b32 v1, 6, v0
  s_nop 0
  v_readfirstlane_b32 s16, v1
  s_mov_b32 s66, 0
  s_mov_b32 s68, 0
  s_mov_b32 s69, 0
  s_mov_b32 s96, 0
  s_mov_b32 s97, 0
  s_mov_b32 s101, 0x5eed0000
  s_sub_u32 s20, s67, 0
  s_lshr_b32 s21, s2, 3
  s_and_b32 s20, s20, 7
  s_lshl_b32 s3, s20, 5
  s_add_u32 s3, s3, s21
  s_waitcnt lgkmcnt(0)
  s_mov_b32 s8, s6
  s_and_b32 s9, s7, 0xffff
  s_mov_b32 s10, 0x10000000
  s_mov_b32 s11, 0x20000
  s_mov_b32 s12, s4
  s_and_b32 s13, s5, 0xffff
  s_mov_b32 s14, 256
  s_mov_b32 s15, 0x20000
  s_or_b32 s88, s88, 1
  s_and_b32 s93, s93, 0xffff
  s_mov_b32 s94, 3670016
  s_mov_b32 s95, 0x20000
m_start:
  s_cmp_ge_u32 s3, 32
  s_cbranch_scc1 m_bjob
  v_and_b32 v1, 63, v0
  v_lshlrev_b32 v2, 4, v1
  v_lshrrev_b32 v116, 4, v1
  v_and_b32 v117, 15, v1
  v_mov_b32 v3, 0x4444
  v_mov_b32 v118, 0xeeee
  v_cmp_lt_u32 vcc, 7, v117
  s_nop 1
  v_cndmask_b32 v3, v3, v118, vcc
  s_and_b32 s17, s3, 15
  s_cmp_ge_u32 s3, 16
  s_cbranch_scc1 m_val
  s_mov_b32 s60, s42
  s_and_b32 s61, s43, 0xffff
  s_mov_b32 s62, 3670016
  s_mov_b32 s63, 0x20000
  v_lshrrev_b32 v24, 5, v1
  v_and_b32 v25, 31, v1
  s_lshl_b32 s26, s17, 9
  s_lshl_b32 s25, s16, 12
  v_xor_b32 v26, v25, v24
  v_lshlrev_b32 v26, 4, v26
  v_lshl_add_u32 v26, v24, 13, v26
  v_xor_b32 v100, 0, v26
  v_xor_b32 v101, 0, v26
  v_add_u32 v101, 15360, v101
  v_xor_b32 v102, 32, v26
  v_add_u32 v102, 30720, v102
  v_xor_b32 v103, 32, v26
  v_add_u32 v103, 46080, v103
  s_lshl_b32 s23, s16, 19
  s_add_u32 s23, s23, s26
  s_add_u32 m0, s25, 16384
  s_nop 0
  buffer_load_dwordx4 v100, s[60:63], s23 offen offset:0 lds
  buffer_load_dwordx4 v101, s[60:63], s23 offen offset:1024 lds
  buffer_load_dwordx4 v102, s[60:63], s23 offen offset:2048 lds
  buffer_load_dwordx4 v103, s[60:63], s23 offen offset:3072 lds
  s_add_u32 m0, s25, 32768
  s_add_u32 s23, s23, 65536
  buffer_load_dwordx4 v100, s[60:63], s23 offen offset:0 lds
  buffer_load_dwordx4 v101, s[60:63], s23 offen offset:1024 lds
  buffer_load_dwordx4 v102, s[60:63], s23 offen offset:2048 lds
  buffer_load_dwordx4 v103, s[60:63], s23 offen offset:3072 lds
  v_xor_b32 v100, 64, v100
  v_xor_b32 v101, 64, v101
  v_xor_b32 v102, 64, v102
  v_xor_b32 v103, 64, v103
  s_add_u32 m0, s25, 49152
  s_add_u32 s23, s23, 65536
  buffer_load_dwordx4 v100, s[60:63], s23 offen offset:0 lds
  buffer_load_dwordx4 v101, s[60:63], s23 offen offset:1024 lds
  buffer_load_dwordx4 v102, s[60:63], s23 offen offset:2048 lds
  buffer_load_dwordx4 v103, s[60:63], s23 offen offset:3072 lds
  s_add_u32 m0, s25, 65536
  s_add_u32 s23, s23, 65536
  buffer_load_dwordx4 v100, s[60:63], s23 offen offset:0 lds
  buffer_load_dwordx4 v101, s[60:63], s23 offen offset:1024 lds
  buffer_load_dwordx4 v102, s[60:63], s23 offen offset:2048 lds
  buffer_load_dwordx4 v103, s[60:63], s23 offen offset:3072 lds
  v_xor_b32 v100, 192, v100
  v_xor_b32 v101, 192, v101
  v_xor_b32 v102, 192, v102
  v_xor_b32 v103, 192, v103
  s_add_u32 m0, s25, 81920
  s_add_u32 s23, s23, 65536
  buffer_load_dwordx4 v100, s[60:63], s23 offen offset:0 lds
  buffer_load_dwordx4 v101, s[60:63], s23 offen offset:1024 lds
  buffer_load_dwordx4 v102, s[60:63], s23 offen offset:2048 lds
  buffer_load_dwordx4 v103, s[60:63], s23 offen offset:3072 lds
  s_add_u32 m0, s25, 98304
  s_add_u32 s23, s23, 65536
  buffer_load_dwordx4 v100, s[60:63], s23 offen offset:0 lds
  buffer_load_dwordx4 v101, s[60:63], s23 offen offset:1024 lds
  buffer_load_dwordx4 v102, s[60:63], s23 offen offset:2048 lds
  buffer_load_dwordx4 v103, s[60:63], s23 offen offset:3072 lds
  v_xor_b32 v100, 64, v100
  v_xor_b32 v101, 64, v101
  v_xor_b32 v102, 64, v102
  v_xor_b32 v103, 64, v103
  s_add_u32 m0, s25, 114688
  s_add_u32 s23, s23, 65536
  buffer_load_dwordx4 v100, s[60:63], s23 offen offset:0 lds
  buffer_load_dwordx4 v101, s[60:63], s23 offen offset:1024 lds
  buffer_load_dwordx4 v102, s[60:63], s23 offen offset:2048 lds
  buffer_load_dwordx4 v103, s[60:63], s23 offen offset:3072 lds
  s_add_u32 m0, s25, 131072
  s_add_u32 s23, s23, 65536
  buffer_load_dwordx4 v100, s[60:63], s23 offen offset:0 lds
  buffer_load_dwordx4 v101, s[60:63], s23 offen offset:1024 lds
  buffer_load_dwordx4 v102, s[60:63], s23 offen offset:2048 lds
  buffer_load_dwordx4 v103, s[60:63], s23 offen offset:3072 lds
  s_mov_b32 s56, s40
  s_and_b32 s57, s41, 0xffff
  s_mov_b32 s58, 3670016
  s_mov_b32 s59, 0x20000
  s_lshl_b32 s21, s16, 16
  s_add_u32 s27, s26, s21
  s_lshr_b32 s20, s16, 1
  s_lshl_b32 s20, s20, 6
  v_xor_b32 v26, s20, v26
  v_xor_b32 v4, 0, v26
  v_xor_b32 v5, 32, v26
  v_add_u32 v5, 15360, v5
  v_xor_b32 v6, 128, v26
  v_add_u32 v6, 30720, v6
  v_xor_b32 v7, 160, v26
  v_add_u32 v7, 46080, v7
  s_add_u32 s22, s27, 0
  s_add_u32 m0, s25, 0
  s_nop 0
  buffer_load_dwordx4 v4, s[56:59], s22 offen offset:0 lds
  buffer_load_dwordx4 v5, s[56:59], s22 offen offset:1024 lds
  buffer_load_dwordx4 v6, s[56:59], s22 offen offset:2048 lds
  buffer_load_dwordx4 v7, s[56:59], s22 offen offset:3072 lds
  s_cmp_lg_u32 s66, 0
  s_cbranch_scc1 sc_ci
  s_cmp_lg_u32 s16, 0
  s_cbranch_scc1 w0_2
  s_lshr_b32 s70, s3, 5
  s_and_b32 s71, s70, 4
  s_mul_i32 s71, s71, 12
  s_lshl_b32 s70, s70, 2
  s_add_u32 s70, s70, s71
  s_lshl_b32 s71, 1, s3
  v_mov_b32 v248, s71
  v_mov_b32 v249, 32
  s_mov_b64 exec, 1
  buffer_atomic_or v248, v249, s[12:15], s70 offen sc0
  buffer_load_dwordx2 v[250:251], v249, s[12:15], 0 offen offset:96 sc1
  s_mov_b64 exec, -1
w0_2:
sc_ci:
  v_and_b32 v26, 15, v25
  v_xor_b32 v27, v26, v24
  v_lshlrev_b32 v27, 4, v27
  v_bfe_u32 v28, v25, 2, 1
  v_lshlrev_b32 v28, 4, v28
  v_lshrrev_b32 v29, 3, v25
  v_lshl_add_u32 v28, v29, 2, v28
  v_and_b32 v29, 3, v25
  v_add_u32 v28, v28, v29
  v_lshl_add_u32 v28, v28, 9, v27
  v_lshrrev_b32 v29, 2, v26
  v_lshlrev_b32 v29, 15, v29
  v_bfe_u32 v30, v26, 1, 1
  v_lshl_add_u32 v29, v30, 11, v29
  v_lshrrev_b32 v30, 4, v25
  v_lshl_add_u32 v29, v30, 10, v29
  v_and_b32 v31, 1, v26
  v_lshl_add_u32 v29, v31, 9, v29
  v_add_u32 v29, v29, v27
  v_add_u32 v29, s25, v29
  v_xor_b32 v8, 0, v28
  v_xor_b32 v104, 0, v29
  v_xor_b32 v9, 32, v28
  v_xor_b32 v105, 32, v29
  v_xor_b32 v10, 64, v28
  v_xor_b32 v106, 64, v29
  v_xor_b32 v11, 96, v28
  v_xor_b32 v107, 96, v29
  v_xor_b32 v12, 128, v28
  v_xor_b32 v108, 128, v29
  v_xor_b32 v13, 160, v28
  v_xor_b32 v109, 160, v29
  v_xor_b32 v14, 192, v28
  v_xor_b32 v110, 192, v29
  v_xor_b32 v15, 224, v28
  v_xor_b32 v111, 224, v29
  s_mov_b32 s52, 1035512379
  s_waitcnt vmcnt(4)
  ds_read_b128 v[120:123], v104 offset:16384
  ds_read_b128 v[124:127], v105 offset:16384
  ds_read_b128 v[128:131], v106 offset:16384
  ds_read_b128 v[132:135], v107 offset:16384
  ds_read_b128 v[136:139], v108 offset:16384
  ds_read_b128 v[140:143], v109 offset:16384
  ds_read_b128 v[144:147], v110 offset:16384
  ds_read_b128 v[148:151], v111 offset:16384
  s_waitcnt lgkmcnt(4)
  ds_read_b128 v[152:155], v104 offset:16640
  ds_read_b128 v[156:159], v105 offset:16640
  ds_read_b128 v[160:163], v106 offset:16640
  ds_read_b128 v[164:167], v107 offset:16640
  ds_read_b128 v[168:171], v108 offset:16640
  ds_read_b128 v[172:175], v109 offset:16640
  ds_read_b128 v[176:179], v110 offset:16640
  ds_read_b128 v[180:183], v111 offset:16640
  s_waitcnt lgkmcnt(4)
  ds_read_b128 v[184:187], v104 offset:32768
  ds_read_b128 v[188:191], v105 offset:32768
  ds_read_b128 v[192:195], v106 offset:32768
  ds_read_b128 v[196:199], v107 offset:32768
  ds_read_b128 v[200:203], v108 offset:32768
  ds_read_b128 v[204:207], v109 offset:32768
  ds_read_b128 v[208:211], v110 offset:32768
  ds_read_b128 v[212:215], v111 offset:32768
  s_waitcnt lgkmcnt(4)
  ds_read_b128 v[216:219], v104 offset:33024
  ds_read_b128 v[220:223], v105 offset:33024
  ds_read_b128 v[224:227], v106 offset:33024
  ds_read_b128 v[228:231], v107 offset:33024
  ds_read_b128 v[232:235], v108 offset:33024
  ds_read_b128 v[236:239], v109 offset:33024
  ds_read_b128 v[240:243], v110 offset:33024
  ds_read_b128 v[244:247], v111 offset:33024
  s_waitcnt lgkmcnt(4)
  s_waitcnt lgkmcnt(0)
  s_add_u32 s22, s27, 262144
  s_add_u32 m0, s25, 16384
  s_nop 0
  buffer_load_dwordx4 v4, s[56:59], s22 offen offset:0 lds
  buffer_load_dwordx4 v5, s[56:59], s22 offen offset:1024 lds
  buffer_load_dwordx4 v6, s[56:59], s22 offen offset:2048 lds
  buffer_load_dwordx4 v7, s[56:59], s22 offen offset:3072 lds
  s_add_u32 s22, s27, 524288
  s_add_u32 m0, s25, 32768
  s_nop 0
  buffer_load_dwordx4 v4, s[56:59], s22 offen offset:0 lds
  buffer_load_dwordx4 v5, s[56:59], s22 offen offset:1024 lds
  buffer_load_dwordx4 v6, s[56:59], s22 offen offset:2048 lds
  buffer_load_dwordx4 v7, s[56:59], s22 offen offset:3072 lds
  s_add_u32 s22, s27, 786432
  s_add_u32 m0, s25, 49152
  s_nop 0
  buffer_load_dwordx4 v4, s[56:59], s22 offen offset:0 lds
  buffer_load_dwordx4 v5, s[56:59], s22 offen offset:1024 lds
  buffer_load_dwordx4 v6, s[56:59], s22 offen offset:2048 lds
  buffer_load_dwordx4 v7, s[56:59], s22 offen offset:3072 lds
  s_cmp_lg_u32 s66, 0
  s_cbranch_scc1 sc_cf
  s_cmp_lg_u32 s16, 0
  s_cbranch_scc1 w0_3
  s_waitcnt vmcnt(12)
  v_readfirstlane_b32 s70, v250
  s_cmp_lg_u32 s70, 0
  s_cbranch_scc1 sc_nz
  v_mov_b32 v249, 128
  v_mov_b32 v250, s88
  v_mov_b32 v251, s89
  v_mov_b32 v252, 0
  v_mov_b32 v253, 0
  s_mov_b64 exec, 1
  buffer_atomic_cmpswap_x2 v[250:253], v249, s[12:15], 0 offen sc0
  s_mov_b64 exec, -1
  s_waitcnt vmcnt(0)
  v_readfirstlane_b32 s70, v250
  s_cmp_lg_u32 s70, 0
  s_cbranch_scc1 sc_nz
  v_mov_b32 v250, s88
  v_mov_b32 v251, s89
sc_nz:
w0_3:
  v_mov_b32 v249, 160000
  s_add_u32 s101, s101, 1
  s_barrier
  s_mov_b64 exec, 1
  s_cmp_lg_u32 s16, 0
  s_cbranch_scc1 w0_4
  ds_write_b32 v249, v248 offset:0
  ds_write_b32 v249, v250 offset:4
  ds_write_b32 v249, v251 offset:8
  s_waitcnt lgkmcnt(0)
  v_mov_b32 v248, s101
  ds_write_b32 v249, v248 offset:16
  s_waitcnt lgkmcnt(0)
w0_4:
  s_mov_b64 exec, -1
  s_barrier
  ds_read_b32 v248, v249 offset:0
  ds_read_b32 v250, v249 offset:4
  ds_read_b32 v251, v249 offset:8
  ds_read_b32 v249, v249 offset:16
  s_waitcnt lgkmcnt(0)
  v_readfirstlane_b32 s70, v248
  v_readfirstlane_b32 s88, v250
  v_readfirstlane_b32 s89, v251
  v_cmp_ne_u32 vcc, s101, v249
  s_cbranch_vccnz ch_end
  s_mov_b32 s66, 1
  s_bitcmp1_b32 s70, s3
  s_cbranch_scc1 m_reclaim
sc_cf:
  s_cmp_lg_u32 s16, 0
  s_cbranch_scc1 w0_5
  s_cmp_eq_u32 s67, 0
  s_cselect_b32 s20, 1, 0x10001
  v_mov_b32 v248, s20
  v_mov_b32 v249, 0
  s_mov_b64 exec, 1
  buffer_atomic_add v248, v249, s[12:15], 0 offen
  s_mov_b64 exec, -1
w0_5:
  s_lshl_b32 s28, s17, 7
  s_add_u32 s28, s28, 88639488
  v_min_u32 v113, 96, v2
  s_mov_b32 s29, 88606720
  v_add_u32 v112, 1024, v2
  v_min_u32 v112, 1776, v112
  s_mul_i32 s32, s17, 401408
  s_mul_i32 s33, s16, 14336
  s_add_u32 s32, s32, s33
  s_add_u32 s33, s32, s33
  s_add_u32 s32, s32, 344064
  s_add_u32 s33, s33, 229376
  s_waitcnt vmcnt(8)
  s_barrier
  ds_read_b128 v[16:19], v8 offset:0
  ds_read_b128 v[20:23], v9 offset:0
  ds_read_b128 v[24:27], v10 offset:0
  ds_read_b128 v[28:31], v11 offset:0
  s_waitcnt lgkmcnt(3)
  v_mfma_f32_32x32x16_bf16 v[32:47], v[16:19], v[120:123], 0
  s_add_u32 s22, s27, 1048576
  s_add_u32 m0, s25, 65536
  s_nop 0
  buffer_load_dwordx4 v4, s[56:59], s22 offen offset:0 lds
  v_mfma_f32_32x32x16_bf16 v[48:63], v[16:19], v[184:187], 0
  ds_read_b128 v[16:19], v12 offset:0
  s_waitcnt lgkmcnt(3)
  v_mfma_f32_32x32x16_bf16 v[32:47], v[20:23], v[124:127], v[32:47]
  buffer_load_dwordx4 v5, s[56:59], s22 offen offset:1024 lds
  v_mfma_f32_32x32x16_bf16 v[48:63], v[20:23], v[188:191], v[48:63]
  ds_read_b128 v[20:23], v13 offset:0
  s_waitcnt lgkmcnt(3)
  v_mfma_f32_32x32x16_bf16 v[32:47], v[24:27], v[128:131], v[32:47]
  buffer_load_dwordx4 v6, s[56:59], s22 offen offset:2048 lds
  v_mfma_f32_32x32x16_bf16 v[48:63], v[24:27], v[192:195], v[48:63]
  ds_read_b128 v[24:27], v14 offset:0
  s_waitcnt lgkmcnt(3)
  v_mfma_f32_32x32x16_bf16 v[32:47], v[28:31], v[132:135], v[32:47]
  buffer_load_dwordx4 v7, s[56:59], s22 offen offset:3072 lds
  v_mfma_f32_32x32x16_bf16 v[48:63], v[28:31], v[196:199], v[48:63]
  ds_read_b128 v[28:31], v15 offset:0
  s_waitcnt lgkmcnt(3)
  v_mfma_f32_32x32x16_bf16 v[32:47], v[16:19], v[136:139], v[32:47]
  s_add_u32 s22, s27, 1310720
  s_add_u32 m0, s25, 81920
  s_nop 0
  buffer_load_dwordx4 v4, s[56:59], s22 offen offset:0 lds
  v_mfma_f32_32x32x16_bf16 v[48:63], v[16:19], v[200:203], v[48:63]
  ds_read_b128 v[16:19], v8 offset:256
  s_waitcnt lgkmcnt(3)
  v_mfma_f32_32x32x16_bf16 v[32:47], v[20:23], v[140:143], v[32:47]
  buffer_load_dwordx4 v5, s[56:59], s22 offen offset:1024 lds
  v_mfma_f32_32x32x16_bf16 v[48:63], v[20:23], v[204:207], v[48:63]
  ds_read_b128 v[20:23], v9 offset:256
  s_waitcnt lgkmcnt(3)
  v_mfma_f32_32x32x16_bf16 v[32:47], v[24:27], v[144:147], v[32:47]
  buffer_load_dwordx4 v6, s[56:59], s22 offen offset:2048 lds
  v_mfma_f32_32x32x16_bf16 v[48:63], v[24:27], v[208:211], v[48:63]
  ds_read_b128 v[24:27], v10 offset:256
  s_waitcnt lgkmcnt(3)
  v_mfma_f32_32x32x16_bf16 v[32:47], v[28:31], v[148:151], v[32:47]
  buffer_load_dwordx4 v7, s[56:59], s22 offen offset:3072 lds
  v_mfma_f32_32x32x16_bf16 v[48:63], v[28:31], v[212:215], v[48:63]
  ds_read_b128 v[28:31], v11 offset:256
  s_waitcnt lgkmcnt(3)
  v_mfma_f32_32x32x16_bf16 v[32:47], v[16:19], v[152:155], v[32:47]
  s_add_u32 s22, s27, 1572864
  s_add_u32 m0, s25, 98304
  s_nop 0
  buffer_load_dwordx4 v4, s[56:59], s22 offen offset:0 lds
  v_mfma_f32_32x32x16_bf16 v[48:63], v[16:19], v[216:219], v[48:63]
  ds_read_b128 v[16:19], v12 offset:256
  s_waitcnt lgkmcnt(3)
  v_mfma_f32_32x32x16_bf16 v[32:47], v[20:23], v[156:159], v[32:47]
  buffer_load_dwordx4 v5, s[56:59], s22 offen offset:1024 lds
  v_mfma_f32_32x32x16_bf16 v[48:63], v[20:23], v[220:223], v[48:63]
  ds_read_b128 v[20:23], v13 offset:256
  s_waitcnt lgkmcnt(3)
  v_mfma_f32_32x32x16_bf16 v[32:47], v[24:27], v[160:163], v[32:47]
  buffer_load_dwordx4 v6, s[56:59], s22 offen offset:2048 lds
  v_mfma_f32_32x32x16_bf16 v[48:63], v[24:27], v[224:227], v[48:63]
  ds_read_b128 v[24:27], v14 offset:256
  s_waitcnt lgkmcnt(3)
  v_mfma_f32_32x32x16_bf16 v[32:47], v[28:31], v[164:167], v[32:47]
  buffer_load_dwordx4 v7, s[56:59], s22 offen offset:3072 lds
  v_mfma_f32_32x32x16_bf16 v[48:63], v[28:31], v[228:231], v[48:63]
  ds_read_b128 v[28:31], v15 offset:256
  s_waitcnt lgkmcnt(3)
  v_mfma_f32_32x32x16_bf16 v[32:47], v[16:19], v[168:171], v[32:47]
  s_add_u32 s22, s27, 1835008
  s_add_u32 m0, s25, 114688
  s_nop 0
  buffer_load_dwordx4 v4, s[56:59], s22 offen offset:0 lds
  v_mfma_f32_32x32x16_bf16 v[48:63], v[16:19], v[232:235], v[48:63]
  ds_read_b128 v[16:19], v8 offset:16384
  s_waitcnt lgkmcnt(3)
  v_mfma_f32_32x32x16_bf16 v[32:47], v[20:23], v[172:175], v[32:47]
  buffer_load_dwordx4 v5, s[56:59], s22 offen offset:1024 lds
  v_mfma_f32_32x32x16_bf16 v[48:63], v[20:23], v[236:239], v[48:63]
  ds_read_b128 v[20:23], v9 offset:16384
  s_waitcnt lgkmcnt(3)
  v_mfma_f32_32x32x16_bf16 v[32:47], v[24:27], v[176:179], v[32:47]
  buffer_load_dwordx4 v6, s[56:59], s22 offen offset:2048 lds
  v_mfma_f32_32x32x16_bf16 v[48:63], v[24:27], v[240:243], v[48:63]
  ds_read_b128 v[24:27], v10 offset:16384
  s_waitcnt lgkmcnt(3)
  v_mfma_f32_32x32x16_bf16 v[32:47], v[28:31], v[180:183], v[32:47]
  buffer_load_dwordx4 v7, s[56:59], s22 offen offset:3072 lds
  v_mfma_f32_32x32x16_bf16 v[48:63], v[28:31], v[244:247], v[48:63]
  s_waitcnt vmcnt(16)
  s_barrier
  ds_read_b128 v[28:31], v11 offset:16384
  s_waitcnt lgkmcnt(3)
  v_mfma_f32_32x32x16_bf16 v[64:79], v[16:19], v[120:123], 0
  s_add_u32 s22, s27, 2097152
  s_add_u32 m0, s25, 131072
  s_nop 0
  buffer_load_dwordx4 v4, s[56:59], s22 offen offset:0 lds
  v_mfma_f32_32x32x16_bf16 v[80:95], v[16:19], v[184:187], 0
  ds_read_b128 v[16:19], v12 offset:16384
  s_waitcnt lgkmcnt(3)
  v_mfma_f32_32x32x16_bf16 v[64:79], v[20:23], v[124:127], v[64:79]
  buffer_load_dwordx4 v5, s[56:59], s22 offen offset:1024 lds
  v_mul_f32 v32, s52, v32
  v_mul_f32 v33, s52, v33
  v_cvt_pk_bf16_f32 v32, v32, v33
  v_mfma_f32_32x32x16_bf16 v[80:95], v[20:23], v[188:191], v[80:95]
  v_mul_f32 v34, s52, v34
  v_mul_f32 v35, s52, v35
  ds_read_b128 v[20:23], v13 offset:16384
  s_waitcnt lgkmcnt(3)
  v_mfma_f32_32x32x16_bf16 v[64:79], v[24:27], v[128:131], v[64:79]
  buffer_load_dwordx4 v6, s[56:59], s22 offen offset:2048 lds
  v_cvt_pk_bf16_f32 v33, v34, v35
  v_mul_f32 v36, s52, v36
  v_mul_f32 v37, s52, v37
  v_mfma_f32_32x32x16_bf16 v[80:95], v[24:27], v[192:195], v[80:95]
  v_cvt_pk_bf16_f32 v34, v36, v37
  v_mul_f32 v38, s52, v38
  ds_read_b128 v[24:27], v14 offset:16384
  s_waitcnt lgkmcnt(3)
  v_mfma_f32_32x32x16_bf16 v[64:79], v[28:31], v[132:135], v[64:79]
  buffer_load_dwordx4 v7, s[56:59], s22 offen offset:3072 lds
  v_mul_f32 v39, s52, v39
  v_cvt_pk_bf16_f32 v35, v38, v39
  v_mul_f32 v40, s52, v40
  v_mfma_f32_32x32x16_bf16 v[80:95], v[28:31], v[196:199], v[80:95]
  v_mul_f32 v41, s52, v41
  v_cvt_pk_bf16_f32 v40, v40, v41
  ds_read_b128 v[28:31], v15 offset:16384
  s_waitcnt lgkmcnt(3)
  v_mfma_f32_32x32x16_bf16 v[64:79], v[16:19], v[136:139], v[64:79]
  s_add_u32 s22, s27, 2359296
  s_add_u32 m0, s25, 0
  s_nop 0
  buffer_load_dwordx4 v4, s[56:59], s22 offen offset:0 lds
  v_mul_f32 v42, s52, v42
  v_mul_f32 v43, s52, v43
  v_cvt_pk_bf16_f32 v41, v42, v43
  v_mfma_f32_32x32x16_bf16 v[80:95], v[16:19], v[200:203], v[80:95]
  v_mul_f32 v44, s52, v44
  v_mul_f32 v45, s52, v45
  ds_read_b128 v[16:19], v8 offset:16640
  s_waitcnt lgkmcnt(3)
  v_mfma_f32_32x32x16_bf16 v[64:79], v[20:23], v[140:143], v[64:79]
  buffer_load_dwordx4 v5, s[56:59], s22 offen offset:1024 lds
  v_cvt_pk_bf16_f32 v42, v44, v45
  v_mul_f32 v46, s52, v46
  v_mul_f32 v47, s52, v47
  v_mfma_f32_32x32x16_bf16 v[80:95], v[20:23], v[204:207], v[80:95]
  v_cvt_pk_bf16_f32 v43, v46, v47
  v_permlane16_swap_b32 v32, v40
  ds_read_b128 v[20:23], v9 offset:16640
  s_waitcnt lgkmcnt(3)
  v_mfma_f32_32x32x16_bf16 v[64:79], v[24:27], v[144:147], v[64:79]
  buffer_load_dwordx4 v6, s[56:59], s22 offen offset:2048 lds
  v_permlane16_swap_b32 v33, v41
  v_permlane16_swap_b32 v34, v42
  v_permlane16_swap_b32 v35, v43
  v_mfma_f32_32x32x16_bf16 v[80:95], v[24:27], v[208:211], v[80:95]
  v_accvgpr_write_b32 a0, v32
  v_accvgpr_write_b32 a1, v33
  ds_read_b128 v[24:27], v10 offset:16640
  s_waitcnt lgkmcnt(3)
  v_mfma_f32_32x32x16_bf16 v[64:79], v[28:31], v[148:151], v[64:79]
  buffer_load_dwordx4 v7, s[56:59], s22 offen offset:3072 lds
  v_accvgpr_write_b32 a2, v34
  v_accvgpr_write_b32 a3, v35
  v_accvgpr_write_b32 a56, v40
  v_mfma_f32_32x32x16_bf16 v[80:95], v[28:31], v[212:215], v[80:95]
  v_accvgpr_write_b32 a57, v41
  v_accvgpr_write_b32 a58, v42
  ds_read_b128 v[28:31], v11 offset:16640
  s_waitcnt lgkmcnt(3)
  v_mfma_f32_32x32x16_bf16 v[64:79], v[16:19], v[152:155], v[64:79]
  v_accvgpr_write_b32 a59, v43
  v_mul_f32 v48, s52, v48
  v_mul_f32 v49, s52, v49
  v_mfma_f32_32x32x16_bf16 v[80:95], v[16:19], v[216:219], v[80:95]
  v_cvt_pk_bf16_f32 v48, v48, v49
  v_mul_f32 v50, s52, v50
  ds_read_b128 v[16:19], v12 offset:16640
  s_waitcnt lgkmcnt(3)
  v_mfma_f32_32x32x16_bf16 v[64:79], v[20:23], v[156:159], v[64:79]
  v_mul_f32 v51, s52, v51
  v_cvt_pk_bf16_f32 v49, v50, v51
  v_mul_f32 v52, s52, v52
  v_mfma_f32_32x32x16_bf16 v[80:95], v[20:23], v[220:223], v[80:95]
  v_mul_f32 v53, s52, v53
  v_cvt_pk_bf16_f32 v50, v52, v53
  ds_read_b128 v[20:23], v13 offset:16640
  s_waitcnt lgkmcnt(3)
  v_mfma_f32_32x32x16_bf16 v[64:79], v[24:27], v[160:163], v[64:79]
  v_mul_f32 v54, s52, v54
  v_mul_f32 v55, s52, v55
  v_cvt_pk_bf16_f32 v51, v54, v55
  v_mfma_f32_32x32x16_bf16 v[80:95], v[24:27], v[224:227], v[80:95]
  v_mul_f32 v56, s52, v56
  v_mul_f32 v57, s52, v57
  ds_read_b128 v[24:27], v14 offset:16640
  s_waitcnt lgkmcnt(3)
  v_mfma_f32_32x32x16_bf16 v[64:79], v[28:31], v[164:167], v[64:79]
  v_cvt_pk_bf16_f32 v56, v56, v57
  v_mul_f32 v58, s52, v58
  v_mul_f32 v59, s52, v59
  v_mfma_f32_32x32x16_bf16 v[80:95], v[28:31], v[228:231], v[80:95]
  v_cvt_pk_bf16_f32 v57, v58, v59
  v_mul_f32 v60, s52, v60
  ds_read_b128 v[28:31], v15 offset:16640
  s_waitcnt lgkmcnt(3)
  v_mfma_f32_32x32x16_bf16 v[64:79], v[16:19], v[168:171], v[64:79]
  v_mul_f32 v61, s52, v61
  v_cvt_pk_bf16_f32 v58, v60, v61
  v_mul_f32 v62, s52, v62
  v_mfma_f32_32x32x16_bf16 v[80:95], v[16:19], v[232:235], v[80:95]
  v_mul_f32 v63, s52, v63
  v_cvt_pk_bf16_f32 v59, v62, v63
  ds_read_b128 v[16:19], v8 offset:32768
  s_waitcnt lgkmcnt(3)
  v_mfma_f32_32x32x16_bf16 v[64:79], v[20:23], v[172:175], v[64:79]
  v_permlane16_swap_b32 v48, v56
  v_permlane16_swap_b32 v49, v57
  v_permlane16_swap_b32 v50, v58
  v_mfma_f32_32x32x16_bf16 v[80:95], v[20:23], v[236:239], v[80:95]
  v_permlane16_swap_b32 v51, v59
  v_accvgpr_write_b32 a112, v48
  ds_read_b128 v[20:23], v9 offset:32768
  s_waitcnt lgkmcnt(3)
  v_mfma_f32_32x32x16_bf16 v[64:79], v[24:27], v[176:179], v[64:79]
  v_accvgpr_write_b32 a113, v49
  v_accvgpr_write_b32 a114, v50
  v_accvgpr_write_b32 a115, v51
  v_mfma_f32_32x32x16_bf16 v[80:95], v[24:27], v[240:243], v[80:95]
  v_accvgpr_write_b32 a168, v56
  v_accvgpr_write_b32 a169, v57
  ds_read_b128 v[24:27], v10 offset:32768
  s_waitcnt lgkmcnt(3)
  v_mfma_f32_32x32x16_bf16 v[64:79], v[28:31], v[180:183], v[64:79]
  v_accvgpr_write_b32 a170, v58
  v_accvgpr_write_b32 a171, v59
  v_mfma_f32_32x32x16_bf16 v[80:95], v[28:31], v[244:247], v[80:95]
  ds_read_b128 v[28:31], v11 offset:32768
  s_waitcnt lgkmcnt(3)
  v_mfma_f32_32x32x16_bf16 v[32:47], v[16:19], v[120:123], 0
  v_mfma_f32_32x32x16_bf16 v[48:63], v[16:19], v[184:187], 0
  ds_read_b128 v[16:19], v12 offset:32768
  s_waitcnt lgkmcnt(3)
  v_mfma_f32_32x32x16_bf16 v[32:47], v[20:23], v[124:127], v[32:47]
  v_mul_f32 v64, s52, v64
  v_mul_f32 v65, s52, v65
  v_cvt_pk_bf16_f32 v64, v64, v65
  v_mfma_f32_32x32x16_bf16 v[48:63], v[20:23], v[188:191], v[48:63]
  v_mul_f32 v66, s52, v66
  v_mul_f32 v67, s52, v67
  ds_read_b128 v[20:23], v13 offset:32768
  s_waitcnt lgkmcnt(3)
  v_mfma_f32_32x32x16_bf16 v[32:47], v[24:27], v[128:131], v[32:47]
  v_cvt_pk_bf16_f32 v65, v66, v67
  v_mul_f32 v68, s52, v68
  v_mul_f32 v69, s52, v69
  v_mfma_f32_32x32x16_bf16 v[48:63], v[24:27], v[192:195], v[48:63]
  v_cvt_pk_bf16_f32 v66, v68, v69
  v_mul_f32 v70, s52, v70
  ds_read_b128 v[24:27], v14 offset:32768
  s_waitcnt lgkmcnt(3)
  v_mfma_f32_32x32x16_bf16 v[32:47], v[28:31], v[132:135], v[32:47]
  v_mul_f32 v71, s52, v71
  v_cvt_pk_bf16_f32 v67, v70, v71
  v_mul_f32 v72, s52, v72
  v_mfma_f32_32x32x16_bf16 v[48:63], v[28:31], v[196:199], v[48:63]
  v_mul_f32 v73, s52, v73
  v_cvt_pk_bf16_f32 v72, v72, v73
  ds_read_b128 v[28:31], v15 offset:32768
  s_waitcnt lgkmcnt(3)
  v_mfma_f32_32x32x16_bf16 v[32:47], v[16:19], v[136:139], v[32:47]
  v_mul_f32 v74, s52, v74
  v_mul_f32 v75, s52, v75
  v_cvt_pk_bf16_f32 v73, v74, v75
  v_mfma_f32_32x32x16_bf16 v[48:63], v[16:19], v[200:203], v[48:63]
  v_mul_f32 v76, s52, v76
  v_mul_f32 v77, s52, v77
  ds_read_b128 v[16:19], v8 offset:33024
  s_waitcnt lgkmcnt(3)
  v_mfma_f32_32x32x16_bf16 v[32:47], v[20:23], v[140:143], v[32:47]
  v_cvt_pk_bf16_f32 v74, v76, v77
  v_mul_f32 v78, s52, v78
  v_mul_f32 v79, s52, v79
  v_mfma_f32_32x32x16_bf16 v[48:63], v[20:23], v[204:207], v[48:63]
  v_cvt_pk_bf16_f32 v75, v78, v79
  v_permlane16_swap_b32 v64, v72
  ds_read_b128 v[20:23], v9 offset:33024
  s_waitcnt lgkmcnt(3)
  v_mfma_f32_32x32x16_bf16 v[32:47], v[24:27], v[144:147], v[32:47]
  v_permlane16_swap_b32 v65, v73
  v_permlane16_swap_b32 v66, v74
  v_permlane16_swap_b32 v67, v75
  v_mfma_f32_32x32x16_bf16 v[48:63], v[24:27], v[208:211], v[48:63]
  v_accvgpr_write_b32 a4, v64
  v_accvgpr_write_b32 a5, v65
  ds_read_b128 v[24:27], v10 offset:33024
  s_waitcnt lgkmcnt(3)
  v_mfma_f32_32x32x16_bf16 v[32:47], v[28:31], v[148:151], v[32:47]
  v_accvgpr_write_b32 a6, v66
  v_accvgpr_write_b32 a7, v67
  v_accvgpr_write_b32 a60, v72
  v_mfma_f32_32x32x16_bf16 v[48:63], v[28:31], v[212:215], v[48:63]
  v_accvgpr_write_b32 a61, v73
  v_accvgpr_write_b32 a62, v74
  ds_read_b128 v[28:31], v11 offset:33024
  s_waitcnt lgkmcnt(3)
  v_mfma_f32_32x32x16_bf16 v[32:47], v[16:19], v[152:155], v[32:47]
  v_accvgpr_write_b32 a63, v75
  v_mul_f32 v80, s52, v80
  v_mul_f32 v81, s52, v81
  v_mfma_f32_32x32x16_bf16 v[48:63], v[16:19], v[216:219], v[48:63]
  v_cvt_pk_bf16_f32 v80, v80, v81
  v_mul_f32 v82, s52, v82
  ds_read_b128 v[16:19], v12 offset:33024
  s_waitcnt lgkmcnt(3)
  v_mfma_f32_32x32x16_bf16 v[32:47], v[20:23], v[156:159], v[32:47]
  v_mul_f32 v83, s52, v83
  v_cvt_pk_bf16_f32 v81, v82, v83
  v_mul_f32 v84, s52, v84
  v_mfma_f32_32x32x16_bf16 v[48:63], v[20:23], v[220:223], v[48:63]
  v_mul_f32 v85, s52, v85
  v_cvt_pk_bf16_f32 v82, v84, v85
  ds_read_b128 v[20:23], v13 offset:33024
  s_waitcnt lgkmcnt(3)
  v_mfma_f32_32x32x16_bf16 v[32:47], v[24:27], v[160:163], v[32:47]
  v_mul_f32 v86, s52, v86
  v_mul_f32 v87, s52, v87
  v_cvt_pk_bf16_f32 v83, v86, v87
  v_mfma_f32_32x32x16_bf16 v[48:63], v[24:27], v[224:227], v[48:63]
  v_mul_f32 v88, s52, v88
  v_mul_f32 v89, s52, v89
  ds_read_b128 v[24:27], v14 offset:33024
  s_waitcnt lgkmcnt(3)
  v_mfma_f32_32x32x16_bf16 v[32:47], v[28:31], v[164:167], v[32:47]
  v_cvt_pk_bf16_f32 v88, v88, v89
  v_mul_f32 v90, s52, v90
  v_mul_f32 v91, s52, v91
  v_mfma_f32_32x32x16_bf16 v[48:63], v[28:31], v[228:231], v[48:63]
  v_cvt_pk_bf16_f32 v89, v90, v91
  v_mul_f32 v92, s52, v92
  ds_read_b128 v[28:31], v15 offset:33024
  s_waitcnt lgkmcnt(3)
  v_mfma_f32_32x32x16_bf16 v[32:47], v[16:19], v[168:171], v[32:47]
  v_mul_f32 v93, s52, v93
  v_cvt_pk_bf16_f32 v90, v92, v93
  v_mul_f32 v94, s52, v94
  v_mfma_f32_32x32x16_bf16 v[48:63], v[16:19], v[232:235], v[48:63]
  v_mul_f32 v95, s52, v95
  v_cvt_pk_bf16_f32 v91, v94, v95
  ds_read_b128 v[16:19], v8 offset:49152
  s_waitcnt lgkmcnt(3)
  v_mfma_f32_32x32x16_bf16 v[32:47], v[20:23], v[172:175], v[32:47]
  v_permlane16_swap_b32 v80, v88
  v_permlane16_swap_b32 v81, v89
  v_permlane16_swap_b32 v82, v90
  v_mfma_f32_32x32x16_bf16 v[48:63], v[20:23], v[236:239], v[48:63]
  v_permlane16_swap_b32 v83, v91
  v_accvgpr_write_b32 a116, v80
  ds_read_b128 v[20:23], v9 offset:49152
  s_waitcnt lgkmcnt(3)
  v_mfma_f32_32x32x16_bf16 v[32:47], v[24:27], v[176:179], v[32:47]
  v_accvgpr_write_b32 a117, v81
  v_accvgpr_write_b32 a118, v82
  v_accvgpr_write_b32 a119, v83
  v_mfma_f32_32x32x16_bf16 v[48:63], v[24:27], v[240:243], v[48:63]
  v_accvgpr_write_b32 a172, v88
  v_accvgpr_write_b32 a173, v89
  ds_read_b128 v[24:27], v10 offset:49152
  s_waitcnt lgkmcnt(3)
  v_mfma_f32_32x32x16_bf16 v[32:47], v[28:31], v[180:183], v[32:47]
  v_accvgpr_write_b32 a174, v90
  v_accvgpr_write_b32 a175, v91
  v_mfma_f32_32x32x16_bf16 v[48:63], v[28:31], v[244:247], v[48:63]
  s_waitcnt vmcnt(16)
  s_barrier
  ds_read_b128 v[28:31], v11 offset:49152
  s_waitcnt lgkmcnt(3)
  v_mfma_f32_32x32x16_bf16 v[64:79], v[16:19], v[120:123], 0
  s_add_u32 s22, s27, 2621440
  s_add_u32 m0, s25, 16384
  s_nop 0
  buffer_load_dwordx4 v4, s[56:59], s22 offen offset:0 lds
  v_mfma_f32_32x32x16_bf16 v[80:95], v[16:19], v[184:187], 0
  ds_read_b128 v[16:19], v12 offset:49152
  s_waitcnt lgkmcnt(3)
  v_mfma_f32_32x32x16_bf16 v[64:79], v[20:23], v[124:127], v[64:79]
  buffer_load_dwordx4 v5, s[56:59], s22 offen offset:1024 lds
  v_mul_f32 v32, s52, v32
  v_mul_f32 v33, s52, v33
  v_cvt_pk_bf16_f32 v32, v32, v33
  v_mfma_f32_32x32x16_bf16 v[80:95], v[20:23], v[188:191], v[80:95]
  v_mul_f32 v34, s52, v34
  v_mul_f32 v35, s52, v35
  ds_read_b128 v[20:23], v13 offset:49152
  s_waitcnt lgkmcnt(3)
  v_mfma_f32_32x32x16_bf16 v[64:79], v[24:27], v[128:131], v[64:79]
  buffer_load_dwordx4 v6, s[56:59], s22 offen offset:2048 lds
  v_cvt_pk_bf16_f32 v33, v34, v35
  v_mul_f32 v36, s52, v36
  v_mul_f32 v37, s52, v37
  v_mfma_f32_32x32x16_bf16 v[80:95], v[24:27], v[192:195], v[80:95]
  v_cvt_pk_bf16_f32 v34, v36, v37
  v_mul_f32 v38, s52, v38
  ds_read_b128 v[24:27], v14 offset:49152
  s_waitcnt lgkmcnt(3)
  v_mfma_f32_32x32x16_bf16 v[64:79], v[28:31], v[132:135], v[64:79]
  buffer_load_dwordx4 v7, s[56:59], s22 offen offset:3072 lds
  v_mul_f32 v39, s52, v39
  v_cvt_pk_bf16_f32 v35, v38, v39
  v_mul_f32 v40, s52, v40
  v_mfma_f32_32x32x16_bf16 v[80:95], v[28:31], v[196:199], v[80:95]
  v_mul_f32 v41, s52, v41
  v_cvt_pk_bf16_f32 v40, v40, v41
  ds_read_b128 v[28:31], v15 offset:49152
  s_waitcnt lgkmcnt(3)
  v_mfma_f32_32x32x16_bf16 v[64:79], v[16:19], v[136:139], v[64:79]
  s_add_u32 s22, s27, 2883584
  s_add_u32 m0, s25, 32768
  s_nop 0
  buffer_load_dwordx4 v4, s[56:59], s22 offen offset:0 lds
  v_mul_f32 v42, s52, v42
  v_mul_f32 v43, s52, v43
  v_cvt_pk_bf16_f32 v41, v42, v43
  v_mfma_f32_32x32x16_bf16 v[80:95], v[16:19], v[200:203], v[80:95]
  v_mul_f32 v44, s52, v44
  v_mul_f32 v45, s52, v45
  ds_read_b128 v[16:19], v8 offset:49408
  s_waitcnt lgkmcnt(3)
  v_mfma_f32_32x32x16_bf16 v[64:79], v[20:23], v[140:143], v[64:79]
  buffer_load_dwordx4 v5, s[56:59], s22 offen offset:1024 lds
  v_cvt_pk_bf16_f32 v42, v44, v45
  v_mul_f32 v46, s52, v46
  v_mul_f32 v47, s52, v47
  v_mfma_f32_32x32x16_bf16 v[80:95], v[20:23], v[204:207], v[80:95]
  v_cvt_pk_bf16_f32 v43, v46, v47
  v_permlane16_swap_b32 v32, v40
  ds_read_b128 v[20:23], v9 offset:49408
  s_waitcnt lgkmcnt(3)
  v_mfma_f32_32x32x16_bf16 v[64:79], v[24:27], v[144:147], v[64:79]
  buffer_load_dwordx4 v6, s[56:59], s22 offen offset:2048 lds
  v_permlane16_swap_b32 v33, v41
  v_permlane16_swap_b32 v34, v42
  v_permlane16_swap_b32 v35, v43
  v_mfma_f32_32x32x16_bf16 v[80:95], v[24:27], v[208:211], v[80:95]
  v_accvgpr_write_b32 a8, v32
  v_accvgpr_write_b32 a9, v33
  ds_read_b128 v[24:27], v10 offset:49408
  s_waitcnt lgkmcnt(3)
  v_mfma_f32_32x32x16_bf16 v[64:79], v[28:31], v[148:151], v[64:79]
  buffer_load_dwordx4 v7, s[56:59], s22 offen offset:3072 lds
  v_accvgpr_write_b32 a10, v34
  v_accvgpr_write_b32 a11, v35
  v_accvgpr_write_b32 a64, v40
  v_mfma_f32_32x32x16_bf16 v[80:95], v[28:31], v[212:215], v[80:95]
  v_accvgpr_write_b32 a65, v41
  v_accvgpr_write_b32 a66, v42
  ds_read_b128 v[28:31], v11 offset:49408
  s_waitcnt lgkmcnt(3)
  v_mfma_f32_32x32x16_bf16 v[64:79], v[16:19], v[152:155], v[64:79]
  v_accvgpr_write_b32 a67, v43
  v_mul_f32 v48, s52, v48
  v_mul_f32 v49, s52, v49
  v_mfma_f32_32x32x16_bf16 v[80:95], v[16:19], v[216:219], v[80:95]
  v_cvt_pk_bf16_f32 v48, v48, v49
  v_mul_f32 v50, s52, v50
  ds_read_b128 v[16:19], v12 offset:49408
  s_waitcnt lgkmcnt(3)
  v_mfma_f32_32x32x16_bf16 v[64:79], v[20:23], v[156:159], v[64:79]
  v_mul_f32 v51, s52, v51
  v_cvt_pk_bf16_f32 v49, v50, v51
  v_mul_f32 v52, s52, v52
  v_mfma_f32_32x32x16_bf16 v[80:95], v[20:23], v[220:223], v[80:95]
  v_mul_f32 v53, s52, v53
  v_cvt_pk_bf16_f32 v50, v52, v53
  ds_read_b128 v[20:23], v13 offset:49408
  s_waitcnt lgkmcnt(3)
  v_mfma_f32_32x32x16_bf16 v[64:79], v[24:27], v[160:163], v[64:79]
  v_mul_f32 v54, s52, v54
  v_mul_f32 v55, s52, v55
  v_cvt_pk_bf16_f32 v51, v54, v55
  v_mfma_f32_32x32x16_bf16 v[80:95], v[24:27], v[224:227], v[80:95]
  v_mul_f32 v56, s52, v56
  v_mul_f32 v57, s52, v57
  ds_read_b128 v[24:27], v14 offset:49408
  s_waitcnt lgkmcnt(3)
  v_mfma_f32_32x32x16_bf16 v[64:79], v[28:31], v[164:167], v[64:79]
  v_cvt_pk_bf16_f32 v56, v56, v57
  v_mul_f32 v58, s52, v58
  v_mul_f32 v59, s52, v59
  v_mfma_f32_32x32x16_bf16 v[80:95], v[28:31], v[228:231], v[80:95]
  v_cvt_pk_bf16_f32 v57, v58, v59
  v_mul_f32 v60, s52, v60
  ds_read_b128 v[28:31], v15 offset:49408
  s_waitcnt lgkmcnt(3)
  v_mfma_f32_32x32x16_bf16 v[64:79], v[16:19], v[168:171], v[64:79]
  v_mul_f32 v61, s52, v61
  v_cvt_pk_bf16_f32 v58, v60, v61
  v_mul_f32 v62, s52, v62
  v_mfma_f32_32x32x16_bf16 v[80:95], v[16:19], v[232:235], v[80:95]
  v_mul_f32 v63, s52, v63
  v_cvt_pk_bf16_f32 v59, v62, v63
  v_xor_b32 v8, 65536, v8
  ds_read_b128 v[16:19], v8 offset:0
  s_waitcnt lgkmcnt(3)
  v_mfma_f32_32x32x16_bf16 v[64:79], v[20:23], v[172:175], v[64:79]
  v_permlane16_swap_b32 v48, v56
  v_permlane16_swap_b32 v49, v57
  v_permlane16_swap_b32 v50, v58
  v_mfma_f32_32x32x16_bf16 v[80:95], v[20:23], v[236:239], v[80:95]
  v_permlane16_swap_b32 v51, v59
  v_accvgpr_write_b32 a120, v48
  v_xor_b32 v9, 65536, v9
  ds_read_b128 v[20:23], v9 offset:0
  s_waitcnt lgkmcnt(3)
  v_mfma_f32_32x32x16_bf16 v[64:79], v[24:27], v[176:179], v[64:79]
  v_accvgpr_write_b32 a121, v49
  v_accvgpr_write_b32 a122, v50
  v_accvgpr_write_b32 a123, v51
  v_mfma_f32_32x32x16_bf16 v[80:95], v[24:27], v[240:243], v[80:95]
  v_accvgpr_write_b32 a176, v56
  v_accvgpr_write_b32 a177, v57
  v_xor_b32 v10, 65536, v10
  ds_read_b128 v[24:27], v10 offset:0
  s_waitcnt lgkmcnt(3)
  v_mfma_f32_32x32x16_bf16 v[64:79], v[28:31], v[180:183], v[64:79]
  v_accvgpr_write_b32 a178, v58
  v_accvgpr_write_b32 a179, v59
  v_mfma_f32_32x32x16_bf16 v[80:95], v[28:31], v[244:247], v[80:95]
  v_xor_b32 v11, 65536, v11
  ds_read_b128 v[28:31], v11 offset:0
  s_waitcnt lgkmcnt(3)
  v_mfma_f32_32x32x16_bf16 v[32:47], v[16:19], v[120:123], 0
  v_mfma_f32_32x32x16_bf16 v[48:63], v[16:19], v[184:187], 0
  v_xor_b32 v12, 65536, v12
  ds_read_b128 v[16:19], v12 offset:0
  s_waitcnt lgkmcnt(3)
  v_mfma_f32_32x32x16_bf16 v[32:47], v[20:23], v[124:127], v[32:47]
  v_mul_f32 v64, s52, v64
  v_mul_f32 v65, s52, v65
  v_cvt_pk_bf16_f32 v64, v64, v65
  v_mfma_f32_32x32x16_bf16 v[48:63], v[20:23], v[188:191], v[48:63]
  v_mul_f32 v66, s52, v66
  v_mul_f32 v67, s52, v67
  v_xor_b32 v13, 65536, v13
  ds_read_b128 v[20:23], v13 offset:0
  s_waitcnt lgkmcnt(3)
  v_mfma_f32_32x32x16_bf16 v[32:47], v[24:27], v[128:131], v[32:47]
  v_cvt_pk_bf16_f32 v65, v66, v67
  v_mul_f32 v68, s52, v68
  v_mul_f32 v69, s52, v69
  v_mfma_f32_32x32x16_bf16 v[48:63], v[24:27], v[192:195], v[48:63]
  v_cvt_pk_bf16_f32 v66, v68, v69
  v_mul_f32 v70, s52, v70
  v_xor_b32 v14, 65536, v14
  ds_read_b128 v[24:27], v14 offset:0
  s_waitcnt lgkmcnt(3)
  v_mfma_f32_32x32x16_bf16 v[32:47], v[28:31], v[132:135], v[32:47]
  v_mul_f32 v71, s52, v71
  v_cvt_pk_bf16_f32 v67, v70, v71
  v_mul_f32 v72, s52, v72
  v_mfma_f32_32x32x16_bf16 v[48:63], v[28:31], v[196:199], v[48:63]
  v_mul_f32 v73, s52, v73
  v_cvt_pk_bf16_f32 v72, v72, v73
  v_xor_b32 v15, 65536, v15
  ds_read_b128 v[28:31], v15 offset:0
  s_waitcnt lgkmcnt(3)
  v_mfma_f32_32x32x16_bf16 v[32:47], v[16:19], v[136:139], v[32:47]
  v_mul_f32 v74, s52, v74
  v_mul_f32 v75, s52, v75
  v_cvt_pk_bf16_f32 v73, v74, v75
  v_mfma_f32_32x32x16_bf16 v[48:63], v[16:19], v[200:203], v[48:63]
  v_mul_f32 v76, s52, v76
  v_mul_f32 v77, s52, v77
  ds_read_b128 v[16:19], v8 offset:256
  s_waitcnt lgkmcnt(3)
  v_mfma_f32_32x32x16_bf16 v[32:47], v[20:23], v[140:143], v[32:47]
  v_cvt_pk_bf16_f32 v74, v76, v77
  v_mul_f32 v78, s52, v78
  v_mul_f32 v79, s52, v79
  v_mfma_f32_32x32x16_bf16 v[48:63], v[20:23], v[204:207], v[48:63]
  v_cvt_pk_bf16_f32 v75, v78, v79
  v_permlane16_swap_b32 v64, v72
  ds_read_b128 v[20:23], v9 offset:256
  s_waitcnt lgkmcnt(3)
  v_mfma_f32_32x32x16_bf16 v[32:47], v[24:27], v[144:147], v[32:47]
  v_permlane16_swap_b32 v65, v73
  v_permlane16_swap_b32 v66, v74
  v_permlane16_swap_b32 v67, v75
  v_mfma_f32_32x32x16_bf16 v[48:63], v[24:27], v[208:211], v[48:63]
  v_accvgpr_write_b32 a12, v64
  v_accvgpr_write_b32 a13, v65
  ds_read_b128 v[24:27], v10 offset:256
  s_waitcnt lgkmcnt(3)
  v_mfma_f32_32x32x16_bf16 v[32:47], v[28:31], v[148:151], v[32:47]
  v_accvgpr_write_b32 a14, v66
  v_accvgpr_write_b32 a15, v67
  v_accvgpr_write_b32 a68, v72
  v_mfma_f32_32x32x16_bf16 v[48:63], v[28:31], v[212:215], v[48:63]
  v_accvgpr_write_b32 a69, v73
  v_accvgpr_write_b32 a70, v74
  ds_read_b128 v[28:31], v11 offset:256
  s_waitcnt lgkmcnt(3)
  v_mfma_f32_32x32x16_bf16 v[32:47], v[16:19], v[152:155], v[32:47]
  v_accvgpr_write_b32 a71, v75
  v_mul_f32 v80, s52, v80
  v_mul_f32 v81, s52, v81
  v_mfma_f32_32x32x16_bf16 v[48:63], v[16:19], v[216:219], v[48:63]
  v_cvt_pk_bf16_f32 v80, v80, v81
  v_mul_f32 v82, s52, v82
  ds_read_b128 v[16:19], v12 offset:256
  s_waitcnt lgkmcnt(3)
  v_mfma_f32_32x32x16_bf16 v[32:47], v[20:23], v[156:159], v[32:47]
  v_mul_f32 v83, s52, v83
  v_cvt_pk_bf16_f32 v81, v82, v83
  v_mul_f32 v84, s52, v84
  v_mfma_f32_32x32x16_bf16 v[48:63], v[20:23], v[220:223], v[48:63]
  v_mul_f32 v85, s52, v85
  v_cvt_pk_bf16_f32 v82, v84, v85
  ds_read_b128 v[20:23], v13 offset:256
  s_waitcnt lgkmcnt(3)
  v_mfma_f32_32x32x16_bf16 v[32:47], v[24:27], v[160:163], v[32:47]
  v_mul_f32 v86, s52, v86
  v_mul_f32 v87, s52, v87
  v_cvt_pk_bf16_f32 v83, v86, v87
  v_mfma_f32_32x32x16_bf16 v[48:63], v[24:27], v[224:227], v[48:63]
  v_mul_f32 v88, s52, v88
  v_mul_f32 v89, s52, v89
  ds_read_b128 v[24:27], v14 offset:256
  s_waitcnt lgkmcnt(3)
  v_mfma_f32_32x32x16_bf16 v[32:47], v[28:31], v[164:167], v[32:47]
  v_cvt_pk_bf16_f32 v88, v88, v89
  v_mul_f32 v90, s52, v90
  v_mul_f32 v91, s52, v91
  v_mfma_f32_32x32x16_bf16 v[48:63], v[28:31], v[228:231], v[48:63]
  v_cvt_pk_bf16_f32 v89, v90, v91
  v_mul_f32 v92, s52, v92
  ds_read_b128 v[28:31], v15 offset:256
  s_waitcnt lgkmcnt(3)
  v_mfma_f32_32x32x16_bf16 v[32:47], v[16:19], v[168:171], v[32:47]
  v_mul_f32 v93, s52, v93
  v_cvt_pk_bf16_f32 v90, v92, v93
  v_mul_f32 v94, s52, v94
  v_mfma_f32_32x32x16_bf16 v[48:63], v[16:19], v[232:235], v[48:63]
  v_mul_f32 v95, s52, v95
  v_cvt_pk_bf16_f32 v91, v94, v95
  ds_read_b128 v[16:19], v8 offset:16384
  s_waitcnt lgkmcnt(3)
  v_mfma_f32_32x32x16_bf16 v[32:47], v[20:23], v[172:175], v[32:47]
  v_permlane16_swap_b32 v80, v88
  v_permlane16_swap_b32 v81, v89
  v_permlane16_swap_b32 v82, v90
  v_mfma_f32_32x32x16_bf16 v[48:63], v[20:23], v[236:239], v[48:63]
  v_permlane16_swap_b32 v83, v91
  v_accvgpr_write_b32 a124, v80
  ds_read_b128 v[20:23], v9 offset:16384
  s_waitcnt lgkmcnt(3)
  v_mfma_f32_32x32x16_bf16 v[32:47], v[24:27], v[176:179], v[32:47]
  v_accvgpr_write_b32 a125, v81
  v_accvgpr_write_b32 a126, v82
  v_accvgpr_write_b32 a127, v83
  v_mfma_f32_32x32x16_bf16 v[48:63], v[24:27], v[240:243], v[48:63]
  v_accvgpr_write_b32 a180, v88
  v_accvgpr_write_b32 a181, v89
  ds_read_b128 v[24:27], v10 offset:16384
  s_waitcnt lgkmcnt(3)
  v_mfma_f32_32x32x16_bf16 v[32:47], v[28:31], v[180:183], v[32:47]
  v_accvgpr_write_b32 a182, v90
  v_accvgpr_write_b32 a183, v91
  v_mfma_f32_32x32x16_bf16 v[48:63], v[28:31], v[244:247], v[48:63]
  s_waitcnt vmcnt(16)
  s_barrier
  ds_read_b128 v[28:31], v11 offset:16384
  s_waitcnt lgkmcnt(3)
  v_mfma_f32_32x32x16_bf16 v[64:79], v[16:19], v[120:123], 0
  s_add_u32 s22, s27, 3145728
  s_add_u32 m0, s25, 49152
  s_nop 0
  buffer_load_dwordx4 v4, s[56:59], s22 offen offset:0 lds
  v_mfma_f32_32x32x16_bf16 v[80:95], v[16:19], v[184:187], 0
  ds_read_b128 v[16:19], v12 offset:16384
  s_waitcnt lgkmcnt(3)
  v_mfma_f32_32x32x16_bf16 v[64:79], v[20:23], v[124:127], v[64:79]
  buffer_load_dwordx4 v5, s[56:59], s22 offen offset:1024 lds
  v_mul_f32 v32, s52, v32
  v_mul_f32 v33, s52, v33
  v_cvt_pk_bf16_f32 v32, v32, v33
  v_mfma_f32_32x32x16_bf16 v[80:95], v[20:23], v[188:191], v[80:95]
  v_mul_f32 v34, s52, v34
  v_mul_f32 v35, s52, v35
  ds_read_b128 v[20:23], v13 offset:16384
  s_waitcnt lgkmcnt(3)
  v_mfma_f32_32x32x16_bf16 v[64:79], v[24:27], v[128:131], v[64:79]
  buffer_load_dwordx4 v6, s[56:59], s22 offen offset:2048 lds
  v_cvt_pk_bf16_f32 v33, v34, v35
  v_mul_f32 v36, s52, v36
  v_mul_f32 v37, s52, v37
  v_mfma_f32_32x32x16_bf16 v[80:95], v[24:27], v[192:195], v[80:95]
  v_cvt_pk_bf16_f32 v34, v36, v37
  v_mul_f32 v38, s52, v38
  ds_read_b128 v[24:27], v14 offset:16384
  s_waitcnt lgkmcnt(3)
  v_mfma_f32_32x32x16_bf16 v[64:79], v[28:31], v[132:135], v[64:79]
  buffer_load_dwordx4 v7, s[56:59], s22 offen offset:3072 lds
  v_mul_f32 v39, s52, v39
  v_cvt_pk_bf16_f32 v35, v38, v39
  v_mul_f32 v40, s52, v40
  v_mfma_f32_32x32x16_bf16 v[80:95], v[28:31], v[196:199], v[80:95]
  v_mul_f32 v41, s52, v41
  v_cvt_pk_bf16_f32 v40, v40, v41
  ds_read_b128 v[28:31], v15 offset:16384
  s_waitcnt lgkmcnt(3)
  v_mfma_f32_32x32x16_bf16 v[64:79], v[16:19], v[136:139], v[64:79]
  s_add_u32 s22, s27, 3407872
  s_add_u32 m0, s25, 65536
  s_nop 0
  buffer_load_dwordx4 v4, s[56:59], s22 offen offset:0 lds
  v_mul_f32 v42, s52, v42
  v_mul_f32 v43, s52, v43
  v_cvt_pk_bf16_f32 v41, v42, v43
  v_mfma_f32_32x32x16_bf16 v[80:95], v[16:19], v[200:203], v[80:95]
  v_mul_f32 v44, s52, v44
  v_mul_f32 v45, s52, v45
  ds_read_b128 v[16:19], v8 offset:16640
  s_waitcnt lgkmcnt(3)
  v_mfma_f32_32x32x16_bf16 v[64:79], v[20:23], v[140:143], v[64:79]
  buffer_load_dwordx4 v5, s[56:59], s22 offen offset:1024 lds
  v_cvt_pk_bf16_f32 v42, v44, v45
  v_mul_f32 v46, s52, v46
  v_mul_f32 v47, s52, v47
  v_mfma_f32_32x32x16_bf16 v[80:95], v[20:23], v[204:207], v[80:95]
  v_cvt_pk_bf16_f32 v43, v46, v47
  v_permlane16_swap_b32 v32, v40
  ds_read_b128 v[20:23], v9 offset:16640
  s_waitcnt lgkmcnt(3)
  v_mfma_f32_32x32x16_bf16 v[64:79], v[24:27], v[144:147], v[64:79]
  buffer_load_dwordx4 v6, s[56:59], s22 offen offset:2048 lds
  v_permlane16_swap_b32 v33, v41
  v_permlane16_swap_b32 v34, v42
  v_permlane16_swap_b32 v35, v43
  v_mfma_f32_32x32x16_bf16 v[80:95], v[24:27], v[208:211], v[80:95]
  v_accvgpr_write_b32 a16, v32
  v_accvgpr_write_b32 a17, v33
  ds_read_b128 v[24:27], v10 offset:16640
  s_waitcnt lgkmcnt(3)
  v_mfma_f32_32x32x16_bf16 v[64:79], v[28:31], v[148:151], v[64:79]
  buffer_load_dwordx4 v7, s[56:59], s22 offen offset:3072 lds
  v_accvgpr_write_b32 a18, v34
  v_accvgpr_write_b32 a19, v35
  v_accvgpr_write_b32 a72, v40
  v_mfma_f32_32x32x16_bf16 v[80:95], v[28:31], v[212:215], v[80:95]
  v_accvgpr_write_b32 a73, v41
  v_accvgpr_write_b32 a74, v42
  ds_read_b128 v[28:31], v11 offset:16640
  s_waitcnt lgkmcnt(3)
  v_mfma_f32_32x32x16_bf16 v[64:79], v[16:19], v[152:155], v[64:79]
  v_accvgpr_write_b32 a75, v43
  v_mul_f32 v48, s52, v48
  v_mul_f32 v49, s52, v49
  v_mfma_f32_32x32x16_bf16 v[80:95], v[16:19], v[216:219], v[80:95]
  v_cvt_pk_bf16_f32 v48, v48, v49
  v_mul_f32 v50, s52, v50
  ds_read_b128 v[16:19], v12 offset:16640
  s_waitcnt lgkmcnt(3)
  v_mfma_f32_32x32x16_bf16 v[64:79], v[20:23], v[156:159], v[64:79]
  v_mul_f32 v51, s52, v51
  v_cvt_pk_bf16_f32 v49, v50, v51
  v_mul_f32 v52, s52, v52
  v_mfma_f32_32x32x16_bf16 v[80:95], v[20:23], v[220:223], v[80:95]
  v_mul_f32 v53, s52, v53
  v_cvt_pk_bf16_f32 v50, v52, v53
  ds_read_b128 v[20:23], v13 offset:16640
  s_waitcnt lgkmcnt(3)
  v_mfma_f32_32x32x16_bf16 v[64:79], v[24:27], v[160:163], v[64:79]
  v_mul_f32 v54, s52, v54
  v_mul_f32 v55, s52, v55
  v_cvt_pk_bf16_f32 v51, v54, v55
  v_mfma_f32_32x32x16_bf16 v[80:95], v[24:27], v[224:227], v[80:95]
  v_mul_f32 v56, s52, v56
  v_mul_f32 v57, s52, v57
  ds_read_b128 v[24:27], v14 offset:16640
  s_waitcnt lgkmcnt(3)
  v_mfma_f32_32x32x16_bf16 v[64:79], v[28:31], v[164:167], v[64:79]
  v_cvt_pk_bf16_f32 v56, v56, v57
  v_mul_f32 v58, s52, v58
  v_mul_f32 v59, s52, v59
  v_mfma_f32_32x32x16_bf16 v[80:95], v[28:31], v[228:231], v[80:95]
  v_cvt_pk_bf16_f32 v57, v58, v59
  v_mul_f32 v60, s52, v60
  ds_read_b128 v[28:31], v15 offset:16640
  s_waitcnt lgkmcnt(3)
  v_mfma_f32_32x32x16_bf16 v[64:79], v[16:19], v[168:171], v[64:79]
  v_mul_f32 v61, s52, v61
  v_cvt_pk_bf16_f32 v58, v60, v61
  v_mul_f32 v62, s52, v62
  v_mfma_f32_32x32x16_bf16 v[80:95], v[16:19], v[232:235], v[80:95]
  v_mul_f32 v63, s52, v63
  v_cvt_pk_bf16_f32 v59, v62, v63
  ds_read_b128 v[16:19], v8 offset:32768
  s_waitcnt lgkmcnt(3)
  v_mfma_f32_32x32x16_bf16 v[64:79], v[20:23], v[172:175], v[64:79]
  v_permlane16_swap_b32 v48, v56
  v_permlane16_swap_b32 v49, v57
  v_permlane16_swap_b32 v50, v58
  v_mfma_f32_32x32x16_bf16 v[80:95], v[20:23], v[236:239], v[80:95]
  v_permlane16_swap_b32 v51, v59
  v_accvgpr_write_b32 a128, v48
  ds_read_b128 v[20:23], v9 offset:32768
  s_waitcnt lgkmcnt(3)
  v_mfma_f32_32x32x16_bf16 v[64:79], v[24:27], v[176:179], v[64:79]
  v_accvgpr_write_b32 a129, v49
  v_accvgpr_write_b32 a130, v50
  v_accvgpr_write_b32 a131, v51
  v_mfma_f32_32x32x16_bf16 v[80:95], v[24:27], v[240:243], v[80:95]
  v_accvgpr_write_b32 a184, v56
  v_accvgpr_write_b32 a185, v57
  ds_read_b128 v[24:27], v10 offset:32768
  s_waitcnt lgkmcnt(3)
  v_mfma_f32_32x32x16_bf16 v[64:79], v[28:31], v[180:183], v[64:79]
  v_accvgpr_write_b32 a186, v58
  v_accvgpr_write_b32 a187, v59
  v_mfma_f32_32x32x16_bf16 v[80:95], v[28:31], v[244:247], v[80:95]
  ds_read_b128 v[28:31], v11 offset:32768
  s_waitcnt lgkmcnt(3)
  v_mfma_f32_32x32x16_bf16 v[32:47], v[16:19], v[120:123], 0
  v_mfma_f32_32x32x16_bf16 v[48:63], v[16:19], v[184:187], 0
  ds_read_b128 v[16:19], v12 offset:32768
  s_waitcnt lgkmcnt(3)
  v_mfma_f32_32x32x16_bf16 v[32:47], v[20:23], v[124:127], v[32:47]
  v_mul_f32 v64, s52, v64
  v_mul_f32 v65, s52, v65
  v_cvt_pk_bf16_f32 v64, v64, v65
  v_mfma_f32_32x32x16_bf16 v[48:63], v[20:23], v[188:191], v[48:63]
  v_mul_f32 v66, s52, v66
  v_mul_f32 v67, s52, v67
  ds_read_b128 v[20:23], v13 offset:32768
  s_waitcnt lgkmcnt(3)
  v_mfma_f32_32x32x16_bf16 v[32:47], v[24:27], v[128:131], v[32:47]
  v_cvt_pk_bf16_f32 v65, v66, v67
  v_mul_f32 v68, s52, v68
  v_mul_f32 v69, s52, v69
  v_mfma_f32_32x32x16_bf16 v[48:63], v[24:27], v[192:195], v[48:63]
  v_cvt_pk_bf16_f32 v66, v68, v69
  v_mul_f32 v70, s52, v70
  ds_read_b128 v[24:27], v14 offset:32768
  s_waitcnt lgkmcnt(3)
  v_mfma_f32_32x32x16_bf16 v[32:47], v[28:31], v[132:135], v[32:47]
  v_mul_f32 v71, s52, v71
  v_cvt_pk_bf16_f32 v67, v70, v71
  v_mul_f32 v72, s52, v72
  v_mfma_f32_32x32x16_bf16 v[48:63], v[28:31], v[196:199], v[48:63]
  v_mul_f32 v73, s52, v73
  v_cvt_pk_bf16_f32 v72, v72, v73
  ds_read_b128 v[28:31], v15 offset:32768
  s_waitcnt lgkmcnt(3)
  v_mfma_f32_32x32x16_bf16 v[32:47], v[16:19], v[136:139], v[32:47]
  v_mul_f32 v74, s52, v74
  v_mul_f32 v75, s52, v75
  v_cvt_pk_bf16_f32 v73, v74, v75
  v_mfma_f32_32x32x16_bf16 v[48:63], v[16:19], v[200:203], v[48:63]
  v_mul_f32 v76, s52, v76
  v_mul_f32 v77, s52, v77
  ds_read_b128 v[16:19], v8 offset:33024
  s_waitcnt lgkmcnt(3)
  v_mfma_f32_32x32x16_bf16 v[32:47], v[20:23], v[140:143], v[32:47]
  v_cvt_pk_bf16_f32 v74, v76, v77
  v_mul_f32 v78, s52, v78
  v_mul_f32 v79, s52, v79
  v_mfma_f32_32x32x16_bf16 v[48:63], v[20:23], v[204:207], v[48:63]
  v_cvt_pk_bf16_f32 v75, v78, v79
  v_permlane16_swap_b32 v64, v72
  ds_read_b128 v[20:23], v9 offset:33024
  s_waitcnt lgkmcnt(3)
  v_mfma_f32_32x32x16_bf16 v[32:47], v[24:27], v[144:147], v[32:47]
  v_permlane16_swap_b32 v65, v73
  v_permlane16_swap_b32 v66, v74
  v_permlane16_swap_b32 v67, v75
  v_mfma_f32_32x32x16_bf16 v[48:63], v[24:27], v[208:211], v[48:63]
  v_accvgpr_write_b32 a20, v64
  v_accvgpr_write_b32 a21, v65
  ds_read_b128 v[24:27], v10 offset:33024
  s_waitcnt lgkmcnt(3)
  v_mfma_f32_32x32x16_bf16 v[32:47], v[28:31], v[148:151], v[32:47]
  v_accvgpr_write_b32 a22, v66
  v_accvgpr_write_b32 a23, v67
  v_accvgpr_write_b32 a76, v72
  v_mfma_f32_32x32x16_bf16 v[48:63], v[28:31], v[212:215], v[48:63]
  v_accvgpr_write_b32 a77, v73
  v_accvgpr_write_b32 a78, v74
  ds_read_b128 v[28:31], v11 offset:33024
  s_waitcnt lgkmcnt(3)
  v_mfma_f32_32x32x16_bf16 v[32:47], v[16:19], v[152:155], v[32:47]
  v_accvgpr_write_b32 a79, v75
  v_mul_f32 v80, s52, v80
  v_mul_f32 v81, s52, v81
  v_mfma_f32_32x32x16_bf16 v[48:63], v[16:19], v[216:219], v[48:63]
  v_cvt_pk_bf16_f32 v80, v80, v81
  v_mul_f32 v82, s52, v82
  ds_read_b128 v[16:19], v12 offset:33024
  s_waitcnt lgkmcnt(3)
  v_mfma_f32_32x32x16_bf16 v[32:47], v[20:23], v[156:159], v[32:47]
  v_mul_f32 v83, s52, v83
  v_cvt_pk_bf16_f32 v81, v82, v83
  v_mul_f32 v84, s52, v84
  v_mfma_f32_32x32x16_bf16 v[48:63], v[20:23], v[220:223], v[48:63]
  v_mul_f32 v85, s52, v85
  v_cvt_pk_bf16_f32 v82, v84, v85
  ds_read_b128 v[20:23], v13 offset:33024
  s_waitcnt lgkmcnt(3)
  v_mfma_f32_32x32x16_bf16 v[32:47], v[24:27], v[160:163], v[32:47]
  v_mul_f32 v86, s52, v86
  v_mul_f32 v87, s52, v87
  v_cvt_pk_bf16_f32 v83, v86, v87
  v_mfma_f32_32x32x16_bf16 v[48:63], v[24:27], v[224:227], v[48:63]
  v_mul_f32 v88, s52, v88
  v_mul_f32 v89, s52, v89
  ds_read_b128 v[24:27], v14 offset:33024
  s_waitcnt lgkmcnt(3)
  v_mfma_f32_32x32x16_bf16 v[32:47], v[28:31], v[164:167], v[32:47]
  v_cvt_pk_bf16_f32 v88, v88, v89
  v_mul_f32 v90, s52, v90
  v_mul_f32 v91, s52, v91
  v_mfma_f32_32x32x16_bf16 v[48:63], v[28:31], v[228:231], v[48:63]
  v_cvt_pk_bf16_f32 v89, v90, v91
  v_mul_f32 v92, s52, v92
  ds_read_b128 v[28:31], v15 offset:33024
  s_waitcnt lgkmcnt(3)
  v_mfma_f32_32x32x16_bf16 v[32:47], v[16:19], v[168:171], v[32:47]
  v_mul_f32 v93, s52, v93
  v_cvt_pk_bf16_f32 v90, v92, v93
  v_mul_f32 v94, s52, v94
  v_mfma_f32_32x32x16_bf16 v[48:63], v[16:19], v[232:235], v[48:63]
  v_mul_f32 v95, s52, v95
  v_cvt_pk_bf16_f32 v91, v94, v95
  ds_read_b128 v[16:19], v8 offset:49152
  s_waitcnt lgkmcnt(3)
  v_mfma_f32_32x32x16_bf16 v[32:47], v[20:23], v[172:175], v[32:47]
  v_permlane16_swap_b32 v80, v88
  v_permlane16_swap_b32 v81, v89
  v_permlane16_swap_b32 v82, v90
  v_mfma_f32_32x32x16_bf16 v[48:63], v[20:23], v[236:239], v[48:63]
  v_permlane16_swap_b32 v83, v91
  v_accvgpr_write_b32 a132, v80
  ds_read_b128 v[20:23], v9 offset:49152
  s_waitcnt lgkmcnt(3)
  v_mfma_f32_32x32x16_bf16 v[32:47], v[24:27], v[176:179], v[32:47]
  v_accvgpr_write_b32 a133, v81
  v_accvgpr_write_b32 a134, v82
  v_accvgpr_write_b32 a135, v83
  v_mfma_f32_32x32x16_bf16 v[48:63], v[24:27], v[240:243], v[48:63]
  v_accvgpr_write_b32 a188, v88
  v_accvgpr_write_b32 a189, v89
  ds_read_b128 v[24:27], v10 offset:49152
  s_waitcnt lgkmcnt(3)
  v_mfma_f32_32x32x16_bf16 v[32:47], v[28:31], v[180:183], v[32:47]
  v_accvgpr_write_b32 a190, v90
  v_accvgpr_write_b32 a191, v91
  v_mfma_f32_32x32x16_bf16 v[48:63], v[28:31], v[244:247], v[48:63]
  s_waitcnt vmcnt(16)
  s_barrier
  ds_read_b128 v[28:31], v11 offset:49152
  s_waitcnt lgkmcnt(3)
  v_mfma_f32_32x32x16_bf16 v[64:79], v[16:19], v[120:123], 0
  v_mfma_f32_32x32x16_bf16 v[80:95], v[16:19], v[184:187], 0
  ds_read_b128 v[16:19], v12 offset:49152
  s_waitcnt lgkmcnt(3)
  v_mfma_f32_32x32x16_bf16 v[64:79], v[20:23], v[124:127], v[64:79]
  v_mul_f32 v32, s52, v32
  v_mul_f32 v33, s52, v33
  v_cvt_pk_bf16_f32 v32, v32, v33
  v_mfma_f32_32x32x16_bf16 v[80:95], v[20:23], v[188:191], v[80:95]
  v_mul_f32 v34, s52, v34
  v_mul_f32 v35, s52, v35
  ds_read_b128 v[20:23], v13 offset:49152
  s_waitcnt lgkmcnt(3)
  v_mfma_f32_32x32x16_bf16 v[64:79], v[24:27], v[128:131], v[64:79]
  v_cvt_pk_bf16_f32 v33, v34, v35
  v_mul_f32 v36, s52, v36
  v_mul_f32 v37, s52, v37
  v_mfma_f32_32x32x16_bf16 v[80:95], v[24:27], v[192:195], v[80:95]
  v_cvt_pk_bf16_f32 v34, v36, v37
  v_mul_f32 v38, s52, v38
  ds_read_b128 v[24:27], v14 offset:49152
  s_waitcnt lgkmcnt(3)
  v_mfma_f32_32x32x16_bf16 v[64:79], v[28:31], v[132:135], v[64:79]
  v_mul_f32 v39, s52, v39
  v_cvt_pk_bf16_f32 v35, v38, v39
  v_mul_f32 v40, s52, v40
  v_mfma_f32_32x32x16_bf16 v[80:95], v[28:31], v[196:199], v[80:95]
  v_mul_f32 v41, s52, v41
  v_cvt_pk_bf16_f32 v40, v40, v41
  ds_read_b128 v[28:31], v15 offset:49152
  s_waitcnt lgkmcnt(3)
  v_mfma_f32_32x32x16_bf16 v[64:79], v[16:19], v[136:139], v[64:79]
  buffer_load_dwordx4 v[100:103], v113, s[8:11], s28 offen sc1
  v_mul_f32 v42, s52, v42
  v_mul_f32 v43, s52, v43
  v_cvt_pk_bf16_f32 v41, v42, v43
  v_mfma_f32_32x32x16_bf16 v[80:95], v[16:19], v[200:203], v[80:95]
  v_mul_f32 v44, s52, v44
  v_mul_f32 v45, s52, v45
  ds_read_b128 v[16:19], v8 offset:49408
  s_waitcnt lgkmcnt(3)
  v_mfma_f32_32x32x16_bf16 v[64:79], v[20:23], v[140:143], v[64:79]
  v_cvt_pk_bf16_f32 v42, v44, v45
  v_mul_f32 v46, s52, v46
  v_mul_f32 v47, s52, v47
  v_mfma_f32_32x32x16_bf16 v[80:95], v[20:23], v[204:207], v[80:95]
  v_cvt_pk_bf16_f32 v43, v46, v47
  v_permlane16_swap_b32 v32, v40
  ds_read_b128 v[20:23], v9 offset:49408
  s_waitcnt lgkmcnt(3)
  v_mfma_f32_32x32x16_bf16 v[64:79], v[24:27], v[144:147], v[64:79]
  v_permlane16_swap_b32 v33, v41
  v_permlane16_swap_b32 v34, v42
  v_permlane16_swap_b32 v35, v43
  v_mfma_f32_32x32x16_bf16 v[80:95], v[24:27], v[208:211], v[80:95]
  v_accvgpr_write_b32 a24, v32
  v_accvgpr_write_b32 a25, v33
  ds_read_b128 v[24:27], v10 offset:49408
  s_waitcnt lgkmcnt(3)
  v_mfma_f32_32x32x16_bf16 v[64:79], v[28:31], v[148:151], v[64:79]
  v_accvgpr_write_b32 a26, v34
  v_accvgpr_write_b32 a27, v35
  v_accvgpr_write_b32 a80, v40
  v_mfma_f32_32x32x16_bf16 v[80:95], v[28:31], v[212:215], v[80:95]
  v_accvgpr_write_b32 a81, v41
  v_accvgpr_write_b32 a82, v42
  ds_read_b128 v[28:31], v11 offset:49408
  s_waitcnt lgkmcnt(3)
  v_mfma_f32_32x32x16_bf16 v[64:79], v[16:19], v[152:155], v[64:79]
  v_accvgpr_write_b32 a83, v43
  v_mul_f32 v48, s52, v48
  v_mul_f32 v49, s52, v49
  v_mfma_f32_32x32x16_bf16 v[80:95], v[16:19], v[216:219], v[80:95]
  v_cvt_pk_bf16_f32 v48, v48, v49
  v_mul_f32 v50, s52, v50
  ds_read_b128 v[16:19], v12 offset:49408
  s_waitcnt lgkmcnt(3)
  v_mfma_f32_32x32x16_bf16 v[64:79], v[20:23], v[156:159], v[64:79]
  v_mul_f32 v51, s52, v51
  v_cvt_pk_bf16_f32 v49, v50, v51
  v_mul_f32 v52, s52, v52
  v_mfma_f32_32x32x16_bf16 v[80:95], v[20:23], v[220:223], v[80:95]
  v_mul_f32 v53, s52, v53
  v_cvt_pk_bf16_f32 v50, v52, v53
  ds_read_b128 v[20:23], v13 offset:49408
  s_waitcnt lgkmcnt(3)
  v_mfma_f32_32x32x16_bf16 v[64:79], v[24:27], v[160:163], v[64:79]
  v_mul_f32 v54, s52, v54
  v_mul_f32 v55, s52, v55
  v_cvt_pk_bf16_f32 v51, v54, v55
  v_mfma_f32_32x32x16_bf16 v[80:95], v[24:27], v[224:227], v[80:95]
  v_mul_f32 v56, s52, v56
  v_mul_f32 v57, s52, v57
  ds_read_b128 v[24:27], v14 offset:49408
  s_waitcnt lgkmcnt(3)
  v_mfma_f32_32x32x16_bf16 v[64:79], v[28:31], v[164:167], v[64:79]
  v_cvt_pk_bf16_f32 v56, v56, v57
  v_mul_f32 v58, s52, v58
  v_mul_f32 v59, s52, v59
  v_mfma_f32_32x32x16_bf16 v[80:95], v[28:31], v[228:231], v[80:95]
  v_cvt_pk_bf16_f32 v57, v58, v59
  v_mul_f32 v60, s52, v60
  ds_read_b128 v[28:31], v15 offset:49408
  s_waitcnt lgkmcnt(3)
  v_mfma_f32_32x32x16_bf16 v[64:79], v[16:19], v[168:171], v[64:79]
  v_mul_f32 v61, s52, v61
  v_cvt_pk_bf16_f32 v58, v60, v61
  v_mul_f32 v62, s52, v62
  v_mfma_f32_32x32x16_bf16 v[80:95], v[16:19], v[232:235], v[80:95]
  v_mul_f32 v63, s52, v63
  v_cvt_pk_bf16_f32 v59, v62, v63
  v_xor_b32 v8, 196608, v8
  ds_read_b128 v[16:19], v8 offset:0
  s_waitcnt lgkmcnt(3)
  v_mfma_f32_32x32x16_bf16 v[64:79], v[20:23], v[172:175], v[64:79]
  v_permlane16_swap_b32 v48, v56
  v_permlane16_swap_b32 v49, v57
  v_permlane16_swap_b32 v50, v58
  v_mfma_f32_32x32x16_bf16 v[80:95], v[20:23], v[236:239], v[80:95]
  v_permlane16_swap_b32 v51, v59
  v_accvgpr_write_b32 a136, v48
  v_xor_b32 v9, 196608, v9
  ds_read_b128 v[20:23], v9 offset:0
  s_waitcnt lgkmcnt(3)
  v_mfma_f32_32x32x16_bf16 v[64:79], v[24:27], v[176:179], v[64:79]
  v_accvgpr_write_b32 a137, v49
  v_accvgpr_write_b32 a138, v50
  v_accvgpr_write_b32 a139, v51
  v_mfma_f32_32x32x16_bf16 v[80:95], v[24:27], v[240:243], v[80:95]
  v_accvgpr_write_b32 a192, v56
  v_accvgpr_write_b32 a193, v57
  v_xor_b32 v10, 196608, v10
  ds_read_b128 v[24:27], v10 offset:0
  s_waitcnt lgkmcnt(3)
  v_mfma_f32_32x32x16_bf16 v[64:79], v[28:31], v[180:183], v[64:79]
  v_accvgpr_write_b32 a194, v58
  v_accvgpr_write_b32 a195, v59
  v_mfma_f32_32x32x16_bf16 v[80:95], v[28:31], v[244:247], v[80:95]
  v_xor_b32 v11, 196608, v11
  ds_read_b128 v[28:31], v11 offset:0
  s_waitcnt lgkmcnt(3)
  v_mfma_f32_32x32x16_bf16 v[32:47], v[16:19], v[120:123], 0
  s_waitcnt vmcnt(0)
  v_cmp_ne_u64 vcc, s[88:89], v[100:101]
  v_cmp_ne_u64 s[54:55], s[88:89], v[102:103]
  s_add_u32 s48, s33, 0
  v_mfma_f32_32x32x16_bf16 v[48:63], v[16:19], v[184:187], 0
  v_xor_b32 v12, 196608, v12
  ds_read_b128 v[16:19], v12 offset:0
  s_waitcnt lgkmcnt(3)
  v_mfma_f32_32x32x16_bf16 v[32:47], v[20:23], v[124:127], v[32:47]
  s_or_b64 vcc, vcc, s[54:55]
  s_cselect_b32 s48, 0x10000000, s48
  s_add_u32 s22, s48, 0
  buffer_load_dwordx4 a[224:227], v2, s[8:11], s22 offen sc1
  v_mul_f32 v64, s52, v64
  v_mul_f32 v65, s52, v65
  v_cvt_pk_bf16_f32 v64, v64, v65
  v_mfma_f32_32x32x16_bf16 v[48:63], v[20:23], v[188:191], v[48:63]
  v_mul_f32 v66, s52, v66
  v_mul_f32 v67, s52, v67
  v_xor_b32 v13, 196608, v13
  ds_read_b128 v[20:23], v13 offset:0
  s_waitcnt lgkmcnt(3)
  v_mfma_f32_32x32x16_bf16 v[32:47], v[24:27], v[128:131], v[32:47]
  v_cvt_pk_bf16_f32 v65, v66, v67
  v_mul_f32 v68, s52, v68
  v_mul_f32 v69, s52, v69
  v_mfma_f32_32x32x16_bf16 v[48:63], v[24:27], v[192:195], v[48:63]
  v_cvt_pk_bf16_f32 v66, v68, v69
  v_mul_f32 v70, s52, v70
  v_xor_b32 v14, 196608, v14
  ds_read_b128 v[24:27], v14 offset:0
  s_waitcnt lgkmcnt(3)
  v_mfma_f32_32x32x16_bf16 v[32:47], v[28:31], v[132:135], v[32:47]
  s_add_u32 s22, s48, 1024
  buffer_load_dwordx4 a[228:231], v2, s[8:11], s22 offen sc1
  v_mul_f32 v71, s52, v71
  v_cvt_pk_bf16_f32 v67, v70, v71
  v_mul_f32 v72, s52, v72
  v_mfma_f32_32x32x16_bf16 v[48:63], v[28:31], v[196:199], v[48:63]
  v_mul_f32 v73, s52, v73
  v_cvt_pk_bf16_f32 v72, v72, v73
  v_xor_b32 v15, 196608, v15
  ds_read_b128 v[28:31], v15 offset:0
  s_waitcnt lgkmcnt(3)
  v_mfma_f32_32x32x16_bf16 v[32:47], v[16:19], v[136:139], v[32:47]
  v_mul_f32 v74, s52, v74
  v_mul_f32 v75, s52, v75
  v_cvt_pk_bf16_f32 v73, v74, v75
  v_mfma_f32_32x32x16_bf16 v[48:63], v[16:19], v[200:203], v[48:63]
  v_mul_f32 v76, s52, v76
  v_mul_f32 v77, s52, v77
  ds_read_b128 v[16:19], v8 offset:256
  s_waitcnt lgkmcnt(3)
  v_mfma_f32_32x32x16_bf16 v[32:47], v[20:23], v[140:143], v[32:47]
  s_add_u32 s22, s48, 2048
  buffer_load_dwordx4 a[232:235], v2, s[8:11], s22 offen sc1
  v_cvt_pk_bf16_f32 v74, v76, v77
  v_mul_f32 v78, s52, v78
  v_mul_f32 v79, s52, v79
  v_mfma_f32_32x32x16_bf16 v[48:63], v[20:23], v[204:207], v[48:63]
  v_cvt_pk_bf16_f32 v75, v78, v79
  v_permlane16_swap_b32 v64, v72
  ds_read_b128 v[20:23], v9 offset:256
  s_waitcnt lgkmcnt(3)
  v_mfma_f32_32x32x16_bf16 v[32:47], v[24:27], v[144:147], v[32:47]
  v_permlane16_swap_b32 v65, v73
  v_permlane16_swap_b32 v66, v74
  v_permlane16_swap_b32 v67, v75
  v_mfma_f32_32x32x16_bf16 v[48:63], v[24:27], v[208:211], v[48:63]
  v_accvgpr_write_b32 a28, v64
  v_accvgpr_write_b32 a29, v65
  ds_read_b128 v[24:27], v10 offset:256
  s_waitcnt lgkmcnt(3)
  v_mfma_f32_32x32x16_bf16 v[32:47], v[28:31], v[148:151], v[32:47]
  s_add_u32 s22, s48, 3072
  buffer_load_dwordx4 a[236:239], v2, s[8:11], s22 offen sc1
  v_accvgpr_write_b32 a30, v66
  v_accvgpr_write_b32 a31, v67
  v_accvgpr_write_b32 a84, v72
  v_mfma_f32_32x32x16_bf16 v[48:63], v[28:31], v[212:215], v[48:63]
  v_accvgpr_write_b32 a85, v73
  v_accvgpr_write_b32 a86, v74
  ds_read_b128 v[28:31], v11 offset:256
  s_waitcnt lgkmcnt(3)
  v_mfma_f32_32x32x16_bf16 v[32:47], v[16:19], v[152:155], v[32:47]
  v_accvgpr_write_b32 a87, v75
  v_mul_f32 v80, s52, v80
  v_mul_f32 v81, s52, v81
  v_mfma_f32_32x32x16_bf16 v[48:63], v[16:19], v[216:219], v[48:63]
  v_cvt_pk_bf16_f32 v80, v80, v81
  v_mul_f32 v82, s52, v82
  ds_read_b128 v[16:19], v12 offset:256
  s_waitcnt lgkmcnt(3)
  v_mfma_f32_32x32x16_bf16 v[32:47], v[20:23], v[156:159], v[32:47]
  s_add_u32 s22, s48, 4096
  buffer_load_dwordx4 a[240:243], v2, s[8:11], s22 offen sc1
  v_mul_f32 v83, s52, v83
  v_cvt_pk_bf16_f32 v81, v82, v83
  v_mul_f32 v84, s52, v84
  v_mfma_f32_32x32x16_bf16 v[48:63], v[20:23], v[220:223], v[48:63]
  v_mul_f32 v85, s52, v85
  v_cvt_pk_bf16_f32 v82, v84, v85
  ds_read_b128 v[20:23], v13 offset:256
  s_waitcnt lgkmcnt(3)
  v_mfma_f32_32x32x16_bf16 v[32:47], v[24:27], v[160:163], v[32:47]
  v_mul_f32 v86, s52, v86
  v_mul_f32 v87, s52, v87
  v_cvt_pk_bf16_f32 v83, v86, v87
  v_mfma_f32_32x32x16_bf16 v[48:63], v[24:27], v[224:227], v[48:63]
  v_mul_f32 v88, s52, v88
  v_mul_f32 v89, s52, v89
  ds_read_b128 v[24:27], v14 offset:256
  s_waitcnt lgkmcnt(3)
  v_mfma_f32_32x32x16_bf16 v[32:47], v[28:31], v[164:167], v[32:47]
  s_add_u32 s22, s48, 5120
  buffer_load_dwordx4 a[244:247], v2, s[8:11], s22 offen sc1
  v_cvt_pk_bf16_f32 v88, v88, v89
  v_mul_f32 v90, s52, v90
  v_mul_f32 v91, s52, v91
  v_mfma_f32_32x32x16_bf16 v[48:63], v[28:31], v[228:231], v[48:63]
  v_cvt_pk_bf16_f32 v89, v90, v91
  v_mul_f32 v92, s52, v92
  ds_read_b128 v[28:31], v15 offset:256
  s_waitcnt lgkmcnt(3)
  v_mfma_f32_32x32x16_bf16 v[32:47], v[16:19], v[168:171], v[32:47]
  v_mul_f32 v93, s52, v93
  v_cvt_pk_bf16_f32 v90, v92, v93
  v_mul_f32 v94, s52, v94
  v_mfma_f32_32x32x16_bf16 v[48:63], v[16:19], v[232:235], v[48:63]
  v_mul_f32 v95, s52, v95
  v_cvt_pk_bf16_f32 v91, v94, v95
  v_xor_b32 v8, 131072, v8
  ds_read_b128 v[16:19], v8 offset:0
  s_waitcnt lgkmcnt(3)
  v_mfma_f32_32x32x16_bf16 v[32:47], v[20:23], v[172:175], v[32:47]
  s_add_u32 s22, s48, 6144
  buffer_load_dwordx4 a[248:251], v2, s[8:11], s22 offen sc1
  v_permlane16_swap_b32 v80, v88
  v_permlane16_swap_b32 v81, v89
  v_permlane16_swap_b32 v82, v90
  v_mfma_f32_32x32x16_bf16 v[48:63], v[20:23], v[236:239], v[48:63]
  v_permlane16_swap_b32 v83, v91
  v_accvgpr_write_b32 a140, v80
  v_xor_b32 v9, 131072, v9
  ds_read_b128 v[20:23], v9 offset:0
  s_waitcnt lgkmcnt(3)
  v_mfma_f32_32x32x16_bf16 v[32:47], v[24:27], v[176:179], v[32:47]
  v_accvgpr_write_b32 a141, v81
  v_accvgpr_write_b32 a142, v82
  v_accvgpr_write_b32 a143, v83
  v_mfma_f32_32x32x16_bf16 v[48:63], v[24:27], v[240:243], v[48:63]
  v_accvgpr_write_b32 a196, v88
  v_accvgpr_write_b32 a197, v89
  v_xor_b32 v10, 131072, v10
  ds_read_b128 v[24:27], v10 offset:0
  s_waitcnt lgkmcnt(3)
  v_mfma_f32_32x32x16_bf16 v[32:47], v[28:31], v[180:183], v[32:47]
  s_add_u32 s22, s48, 7168
  buffer_load_dwordx4 a[252:255], v2, s[8:11], s22 offen sc1
  v_accvgpr_write_b32 a198, v90
  v_accvgpr_write_b32 a199, v91
  v_mfma_f32_32x32x16_bf16 v[48:63], v[28:31], v[244:247], v[48:63]
  s_barrier
  v_xor_b32 v11, 131072, v11
  ds_read_b128 v[28:31], v11 offset:0
  s_waitcnt lgkmcnt(3)
  v_mfma_f32_32x32x16_bf16 v[64:79], v[16:19], v[120:123], 0
  v_mfma_f32_32x32x16_bf16 v[80:95], v[16:19], v[184:187], 0
  v_xor_b32 v12, 131072, v12
  ds_read_b128 v[16:19], v12 offset:0
  s_waitcnt lgkmcnt(3)
  v_mfma_f32_32x32x16_bf16 v[64:79], v[20:23], v[124:127], v[64:79]
  s_add_u32 s22, s48, 8192
  s_add_u32 m0, s25, 81920
  s_nop 0
  buffer_load_dwordx4 v2, s[8:11], s22 offen sc1 lds
  v_mul_f32 v32, s52, v32
  v_mul_f32 v33, s52, v33
  v_cvt_pk_bf16_f32 v32, v32, v33
  v_mfma_f32_32x32x16_bf16 v[80:95], v[20:23], v[188:191], v[80:95]
  v_mul_f32 v34, s52, v34
  v_mul_f32 v35, s52, v35
  v_xor_b32 v13, 131072, v13
  ds_read_b128 v[20:23], v13 offset:0
  s_waitcnt lgkmcnt(3)
  v_mfma_f32_32x32x16_bf16 v[64:79], v[24:27], v[128:131], v[64:79]
  v_cvt_pk_bf16_f32 v33, v34, v35
  v_mul_f32 v36, s52, v36
  v_mul_f32 v37, s52, v37
  v_mfma_f32_32x32x16_bf16 v[80:95], v[24:27], v[192:195], v[80:95]
  v_cvt_pk_bf16_f32 v34, v36, v37
  v_mul_f32 v38, s52, v38
  v_xor_b32 v14, 131072, v14
  ds_read_b128 v[24:27], v14 offset:0
  s_waitcnt lgkmcnt(3)
  v_mfma_f32_32x32x16_bf16 v[64:79], v[28:31], v[132:135], v[64:79]
  s_add_u32 s22, s48, 9216
  s_add_u32 m0, s25, 82944
  s_nop 0
  buffer_load_dwordx4 v2, s[8:11], s22 offen sc1 lds
  v_mul_f32 v39, s52, v39
  v_cvt_pk_bf16_f32 v35, v38, v39
  v_mul_f32 v40, s52, v40
  v_mfma_f32_32x32x16_bf16 v[80:95], v[28:31], v[196:199], v[80:95]
  v_mul_f32 v41, s52, v41
  v_cvt_pk_bf16_f32 v40, v40, v41
  v_xor_b32 v15, 131072, v15
  ds_read_b128 v[28:31], v15 offset:0
  s_waitcnt lgkmcnt(3)
  v_mfma_f32_32x32x16_bf16 v[64:79], v[16:19], v[136:139], v[64:79]
  buffer_load_dwordx4 v[100:103], v113, s[8:11], s28 offen sc1
  v_mul_f32 v42, s52, v42
  v_mul_f32 v43, s52, v43
  v_cvt_pk_bf16_f32 v41, v42, v43
  v_mfma_f32_32x32x16_bf16 v[80:95], v[16:19], v[200:203], v[80:95]
  v_mul_f32 v44, s52, v44
  v_mul_f32 v45, s52, v45
  ds_read_b128 v[16:19], v8 offset:256
  s_waitcnt lgkmcnt(3)
  v_mfma_f32_32x32x16_bf16 v[64:79], v[20:23], v[140:143], v[64:79]
  s_add_u32 s22, s48, 10240
  s_add_u32 m0, s25, 83968
  s_nop 0
  buffer_load_dwordx4 v2, s[8:11], s22 offen sc1 lds
  v_cvt_pk_bf16_f32 v42, v44, v45
  v_mul_f32 v46, s52, v46
  v_mul_f32 v47, s52, v47
  v_mfma_f32_32x32x16_bf16 v[80:95], v[20:23], v[204:207], v[80:95]
  v_cvt_pk_bf16_f32 v43, v46, v47
  v_permlane16_swap_b32 v32, v40
  ds_read_b128 v[20:23], v9 offset:256
  s_waitcnt lgkmcnt(3)
  v_mfma_f32_32x32x16_bf16 v[64:79], v[24:27], v[144:147], v[64:79]
  v_permlane16_swap_b32 v33, v41
  v_permlane16_swap_b32 v34, v42
  v_permlane16_swap_b32 v35, v43
  v_mfma_f32_32x32x16_bf16 v[80:95], v[24:27], v[208:211], v[80:95]
  v_accvgpr_write_b32 a32, v32
  v_accvgpr_write_b32 a33, v33
  ds_read_b128 v[24:27], v10 offset:256
  s_waitcnt lgkmcnt(3)
  v_mfma_f32_32x32x16_bf16 v[64:79], v[28:31], v[148:151], v[64:79]
  s_add_u32 s22, s48, 11264
  s_add_u32 m0, s25, 84992
  s_nop 0
  buffer_load_dwordx4 v2, s[8:11], s22 offen sc1 lds
  v_accvgpr_write_b32 a34, v34
  v_accvgpr_write_b32 a35, v35
  v_accvgpr_write_b32 a88, v40
  v_mfma_f32_32x32x16_bf16 v[80:95], v[28:31], v[212:215], v[80:95]
  v_accvgpr_write_b32 a89, v41
  v_accvgpr_write_b32 a90, v42
  ds_read_b128 v[28:31], v11 offset:256
  s_waitcnt lgkmcnt(3)
  v_mfma_f32_32x32x16_bf16 v[64:79], v[16:19], v[152:155], v[64:79]
  v_accvgpr_write_b32 a91, v43
  v_mul_f32 v48, s52, v48
  v_mul_f32 v49, s52, v49
  v_mfma_f32_32x32x16_bf16 v[80:95], v[16:19], v[216:219], v[80:95]
  v_cvt_pk_bf16_f32 v48, v48, v49
  v_mul_f32 v50, s52, v50
  ds_read_b128 v[16:19], v12 offset:256
  s_waitcnt lgkmcnt(3)
  v_mfma_f32_32x32x16_bf16 v[64:79], v[20:23], v[156:159], v[64:79]
  s_add_u32 s22, s48, 12288
  s_add_u32 m0, s25, 98304
  s_nop 0
  buffer_load_dwordx4 v2, s[8:11], s22 offen sc1 lds
  v_mul_f32 v51, s52, v51
  v_cvt_pk_bf16_f32 v49, v50, v51
  v_mul_f32 v52, s52, v52
  v_mfma_f32_32x32x16_bf16 v[80:95], v[20:23], v[220:223], v[80:95]
  v_mul_f32 v53, s52, v53
  v_cvt_pk_bf16_f32 v50, v52, v53
  ds_read_b128 v[20:23], v13 offset:256
  s_waitcnt lgkmcnt(3)
  v_mfma_f32_32x32x16_bf16 v[64:79], v[24:27], v[160:163], v[64:79]
  v_mul_f32 v54, s52, v54
  v_mul_f32 v55, s52, v55
  v_cvt_pk_bf16_f32 v51, v54, v55
  v_mfma_f32_32x32x16_bf16 v[80:95], v[24:27], v[224:227], v[80:95]
  v_mul_f32 v56, s52, v56
  v_mul_f32 v57, s52, v57
  ds_read_b128 v[24:27], v14 offset:256
  s_waitcnt lgkmcnt(3)
  v_mfma_f32_32x32x16_bf16 v[64:79], v[28:31], v[164:167], v[64:79]
  s_add_u32 s22, s48, 13312
  s_add_u32 m0, s25, 99328
  s_nop 0
  buffer_load_dwordx4 v2, s[8:11], s22 offen sc1 lds
  v_cvt_pk_bf16_f32 v56, v56, v57
  v_mul_f32 v58, s52, v58
  v_mul_f32 v59, s52, v59
  v_mfma_f32_32x32x16_bf16 v[80:95], v[28:31], v[228:231], v[80:95]
  v_cvt_pk_bf16_f32 v57, v58, v59
  v_mul_f32 v60, s52, v60
  ds_read_b128 v[28:31], v15 offset:256
  s_waitcnt lgkmcnt(3)
  v_mfma_f32_32x32x16_bf16 v[64:79], v[16:19], v[168:171], v[64:79]
  v_mul_f32 v61, s52, v61
  v_cvt_pk_bf16_f32 v58, v60, v61
  v_mul_f32 v62, s52, v62
  v_mfma_f32_32x32x16_bf16 v[80:95], v[16:19], v[232:235], v[80:95]
  v_mul_f32 v63, s52, v63
  v_cvt_pk_bf16_f32 v59, v62, v63
  ds_read_b128 v[16:19], v8 offset:16384
  s_waitcnt lgkmcnt(3)
  v_mfma_f32_32x32x16_bf16 v[64:79], v[20:23], v[172:175], v[64:79]
  v_permlane16_swap_b32 v48, v56
  v_permlane16_swap_b32 v49, v57
  v_permlane16_swap_b32 v50, v58
  v_mfma_f32_32x32x16_bf16 v[80:95], v[20:23], v[236:239], v[80:95]
  v_permlane16_swap_b32 v51, v59
  v_accvgpr_write_b32 a144, v48
  ds_read_b128 v[20:23], v9 offset:16384
  s_waitcnt lgkmcnt(3)
  v_mfma_f32_32x32x16_bf16 v[64:79], v[24:27], v[176:179], v[64:79]
  v_accvgpr_write_b32 a145, v49
  v_accvgpr_write_b32 a146, v50
  v_accvgpr_write_b32 a147, v51
  v_mfma_f32_32x32x16_bf16 v[80:95], v[24:27], v[240:243], v[80:95]
  v_accvgpr_write_b32 a200, v56
  v_accvgpr_write_b32 a201, v57
  ds_read_b128 v[24:27], v10 offset:16384
  s_waitcnt lgkmcnt(3)
  v_mfma_f32_32x32x16_bf16 v[64:79], v[28:31], v[180:183], v[64:79]
  v_accvgpr_write_b32 a202, v58
  v_accvgpr_write_b32 a203, v59
  v_mfma_f32_32x32x16_bf16 v[80:95], v[28:31], v[244:247], v[80:95]
  ds_read_b128 v[28:31], v11 offset:16384
  s_waitcnt lgkmcnt(3)
  v_mfma_f32_32x32x16_bf16 v[32:47], v[16:19], v[120:123], 0
  s_waitcnt vmcnt(4)
  v_cmp_ne_u64 vcc, s[88:89], v[100:101]
  v_cmp_ne_u64 s[54:55], s[88:89], v[102:103]
  s_add_u32 s49, s33, 14336
  v_mfma_f32_32x32x16_bf16 v[48:63], v[16:19], v[184:187], 0
  ds_read_b128 v[16:19], v12 offset:16384
  s_waitcnt lgkmcnt(3)
  v_mfma_f32_32x32x16_bf16 v[32:47], v[20:23], v[124:127], v[32:47]
  s_or_b64 vcc, vcc, s[54:55]
  s_cselect_b32 s49, 0x10000000, s49
  s_add_u32 s22, s49, 0
  s_add_u32 m0, s25, 100352
  s_nop 0
  buffer_load_dwordx4 v2, s[8:11], s22 offen sc1 lds
  v_mul_f32 v64, s52, v64
  v_mul_f32 v65, s52, v65
  v_cvt_pk_bf16_f32 v64, v64, v65
  v_mfma_f32_32x32x16_bf16 v[48:63], v[20:23], v[188:191], v[48:63]
  v_mul_f32 v66, s52, v66
  v_mul_f32 v67, s52, v67
  ds_read_b128 v[20:23], v13 offset:16384
  s_waitcnt lgkmcnt(3)
  v_mfma_f32_32x32x16_bf16 v[32:47], v[24:27], v[128:131], v[32:47]
  v_cvt_pk_bf16_f32 v65, v66, v67
  v_mul_f32 v68, s52, v68
  v_mul_f32 v69, s52, v69
  v_mfma_f32_32x32x16_bf16 v[48:63], v[24:27], v[192:195], v[48:63]
  v_cvt_pk_bf16_f32 v66, v68, v69
  v_mul_f32 v70, s52, v70
  ds_read_b128 v[24:27], v14 offset:16384
  s_waitcnt lgkmcnt(3)
  v_mfma_f32_32x32x16_bf16 v[32:47], v[28:31], v[132:135], v[32:47]
  s_add_u32 s22, s49, 1024
  s_add_u32 m0, s25, 101376
  s_nop 0
  buffer_load_dwordx4 v2, s[8:11], s22 offen sc1 lds
  v_mul_f32 v71, s52, v71
  v_cvt_pk_bf16_f32 v67, v70, v71
  v_mul_f32 v72, s52, v72
  v_mfma_f32_32x32x16_bf16 v[48:63], v[28:31], v[196:199], v[48:63]
  v_mul_f32 v73, s52, v73
  v_cvt_pk_bf16_f32 v72, v72, v73
  ds_read_b128 v[28:31], v15 offset:16384
  s_waitcnt lgkmcnt(3)
  v_mfma_f32_32x32x16_bf16 v[32:47], v[16:19], v[136:139], v[32:47]
  v_mul_f32 v74, s52, v74
  v_mul_f32 v75, s52, v75
  v_cvt_pk_bf16_f32 v73, v74, v75
  v_mfma_f32_32x32x16_bf16 v[48:63], v[16:19], v[200:203], v[48:63]
  v_mul_f32 v76, s52, v76
  v_mul_f32 v77, s52, v77
  ds_read_b128 v[16:19], v8 offset:16640
  s_waitcnt lgkmcnt(3)
  v_mfma_f32_32x32x16_bf16 v[32:47], v[20:23], v[140:143], v[32:47]
  s_add_u32 s22, s49, 2048
  s_add_u32 m0, s25, 147456
  s_nop 0
  buffer_load_dwordx4 v2, s[8:11], s22 offen sc1 lds
  v_cvt_pk_bf16_f32 v74, v76, v77
  v_mul_f32 v78, s52, v78
  v_mul_f32 v79, s52, v79
  v_mfma_f32_32x32x16_bf16 v[48:63], v[20:23], v[204:207], v[48:63]
  v_cvt_pk_bf16_f32 v75, v78, v79
  v_permlane16_swap_b32 v64, v72
  ds_read_b128 v[20:23], v9 offset:16640
  s_waitcnt lgkmcnt(3)
  v_mfma_f32_32x32x16_bf16 v[32:47], v[24:27], v[144:147], v[32:47]
  v_permlane16_swap_b32 v65, v73
  v_permlane16_swap_b32 v66, v74
  v_permlane16_swap_b32 v67, v75
  v_mfma_f32_32x32x16_bf16 v[48:63], v[24:27], v[208:211], v[48:63]
  v_accvgpr_write_b32 a36, v64
  v_accvgpr_write_b32 a37, v65
  ds_read_b128 v[24:27], v10 offset:16640
  s_waitcnt lgkmcnt(3)
  v_mfma_f32_32x32x16_bf16 v[32:47], v[28:31], v[148:151], v[32:47]
  s_add_u32 s22, s49, 3072
  s_add_u32 m0, s25, 148480
  s_nop 0
  buffer_load_dwordx4 v2, s[8:11], s22 offen sc1 lds
  v_accvgpr_write_b32 a38, v66
  v_accvgpr_write_b32 a39, v67
  v_accvgpr_write_b32 a92, v72
  v_mfma_f32_32x32x16_bf16 v[48:63], v[28:31], v[212:215], v[48:63]
  v_accvgpr_write_b32 a93, v73
  v_accvgpr_write_b32 a94, v74
  ds_read_b128 v[28:31], v11 offset:16640
  s_waitcnt lgkmcnt(3)
  v_mfma_f32_32x32x16_bf16 v[32:47], v[16:19], v[152:155], v[32:47]
  v_accvgpr_write_b32 a95, v75
  v_mul_f32 v80, s52, v80
  v_mul_f32 v81, s52, v81
  v_mfma_f32_32x32x16_bf16 v[48:63], v[16:19], v[216:219], v[48:63]
  v_cvt_pk_bf16_f32 v80, v80, v81
  v_mul_f32 v82, s52, v82
  ds_read_b128 v[16:19], v12 offset:16640
  s_waitcnt lgkmcnt(3)
  v_mfma_f32_32x32x16_bf16 v[32:47], v[20:23], v[156:159], v[32:47]
  s_add_u32 s22, s49, 4096
  s_add_u32 m0, s25, 149504
  s_nop 0
  buffer_load_dwordx4 v2, s[8:11], s22 offen sc1 lds
  v_mul_f32 v83, s52, v83
  v_cvt_pk_bf16_f32 v81, v82, v83
  v_mul_f32 v84, s52, v84
  v_mfma_f32_32x32x16_bf16 v[48:63], v[20:23], v[220:223], v[48:63]
  v_mul_f32 v85, s52, v85
  v_cvt_pk_bf16_f32 v82, v84, v85
  ds_read_b128 v[20:23], v13 offset:16640
  s_waitcnt lgkmcnt(3)
  v_mfma_f32_32x32x16_bf16 v[32:47], v[24:27], v[160:163], v[32:47]
  v_mul_f32 v86, s52, v86
  v_mul_f32 v87, s52, v87
  v_cvt_pk_bf16_f32 v83, v86, v87
  v_mfma_f32_32x32x16_bf16 v[48:63], v[24:27], v[224:227], v[48:63]
  v_mul_f32 v88, s52, v88
  v_mul_f32 v89, s52, v89
  ds_read_b128 v[24:27], v14 offset:16640
  s_waitcnt lgkmcnt(3)
  v_mfma_f32_32x32x16_bf16 v[32:47], v[28:31], v[164:167], v[32:47]
  s_add_u32 s22, s49, 5120
  s_add_u32 m0, s25, 150528
  s_nop 0
  buffer_load_dwordx4 v2, s[8:11], s22 offen sc1 lds
  v_cvt_pk_bf16_f32 v88, v88, v89
  v_mul_f32 v90, s52, v90
  v_mul_f32 v91, s52, v91
  v_mfma_f32_32x32x16_bf16 v[48:63], v[28:31], v[228:231], v[48:63]
  v_cvt_pk_bf16_f32 v89, v90, v91
  v_mul_f32 v92, s52, v92
  ds_read_b128 v[28:31], v15 offset:16640
  s_waitcnt lgkmcnt(3)
  v_mfma_f32_32x32x16_bf16 v[32:47], v[16:19], v[168:171], v[32:47]
  v_mul_f32 v93, s52, v93
  v_cvt_pk_bf16_f32 v90, v92, v93
  v_mul_f32 v94, s52, v94
  v_mfma_f32_32x32x16_bf16 v[48:63], v[16:19], v[232:235], v[48:63]
  v_mul_f32 v95, s52, v95
  v_cvt_pk_bf16_f32 v91, v94, v95
  ds_read_b128 v[16:19], v8 offset:32768
  s_waitcnt lgkmcnt(3)
  v_mfma_f32_32x32x16_bf16 v[32:47], v[20:23], v[172:175], v[32:47]
  s_add_u32 s22, s49, 6144
  s_add_u32 m0, s25, 114688
  s_nop 0
  buffer_load_dwordx4 v2, s[8:11], s22 offen sc1 lds
  v_permlane16_swap_b32 v80, v88
  v_permlane16_swap_b32 v81, v89
  v_permlane16_swap_b32 v82, v90
  v_mfma_f32_32x32x16_bf16 v[48:63], v[20:23], v[236:239], v[48:63]
  v_permlane16_swap_b32 v83, v91
  v_accvgpr_write_b32 a148, v80
  ds_read_b128 v[20:23], v9 offset:32768
  s_waitcnt lgkmcnt(3)
  v_mfma_f32_32x32x16_bf16 v[32:47], v[24:27], v[176:179], v[32:47]
  v_accvgpr_write_b32 a149, v81
  v_accvgpr_write_b32 a150, v82
  v_accvgpr_write_b32 a151, v83
  v_mfma_f32_32x32x16_bf16 v[48:63], v[24:27], v[240:243], v[48:63]
  v_accvgpr_write_b32 a204, v88
  v_accvgpr_write_b32 a205, v89
  ds_read_b128 v[24:27], v10 offset:32768
  s_waitcnt lgkmcnt(3)
  v_mfma_f32_32x32x16_bf16 v[32:47], v[28:31], v[180:183], v[32:47]
  s_add_u32 s22, s49, 7168
  s_add_u32 m0, s25, 115712
  s_nop 0
  buffer_load_dwordx4 v2, s[8:11], s22 offen sc1 lds
  v_accvgpr_write_b32 a206, v90
  v_accvgpr_write_b32 a207, v91
  v_mfma_f32_32x32x16_bf16 v[48:63], v[28:31], v[244:247], v[48:63]
  s_barrier
  ds_read_b128 v[28:31], v11 offset:32768
  s_waitcnt lgkmcnt(3)
  v_mfma_f32_32x32x16_bf16 v[64:79], v[16:19], v[120:123], 0
  v_mfma_f32_32x32x16_bf16 v[80:95], v[16:19], v[184:187], 0
  ds_read_b128 v[16:19], v12 offset:32768
  s_waitcnt lgkmcnt(3)
  v_mfma_f32_32x32x16_bf16 v[64:79], v[20:23], v[124:127], v[64:79]
  s_add_u32 s22, s49, 8192
  s_add_u32 m0, s25, 116736
  s_nop 0
  buffer_load_dwordx4 v2, s[8:11], s22 offen sc1 lds
  v_mul_f32 v32, s52, v32
  v_mul_f32 v33, s52, v33
  v_cvt_pk_bf16_f32 v32, v32, v33
  v_mfma_f32_32x32x16_bf16 v[80:95], v[20:23], v[188:191], v[80:95]
  v_mul_f32 v34, s52, v34
  v_mul_f32 v35, s52, v35
  ds_read_b128 v[20:23], v13 offset:32768
  s_waitcnt lgkmcnt(3)
  v_mfma_f32_32x32x16_bf16 v[64:79], v[24:27], v[128:131], v[64:79]
  v_cvt_pk_bf16_f32 v33, v34, v35
  v_mul_f32 v36, s52, v36
  v_mul_f32 v37, s52, v37
  v_mfma_f32_32x32x16_bf16 v[80:95], v[24:27], v[192:195], v[80:95]
  v_cvt_pk_bf16_f32 v34, v36, v37
  v_mul_f32 v38, s52, v38
  ds_read_b128 v[24:27], v14 offset:32768
  s_waitcnt lgkmcnt(3)
  v_mfma_f32_32x32x16_bf16 v[64:79], v[28:31], v[132:135], v[64:79]
  s_add_u32 s22, s49, 9216
  s_add_u32 m0, s25, 117760
  s_nop 0
  buffer_load_dwordx4 v2, s[8:11], s22 offen sc1 lds
  v_mul_f32 v39, s52, v39
  v_cvt_pk_bf16_f32 v35, v38, v39
  v_mul_f32 v40, s52, v40
  v_mfma_f32_32x32x16_bf16 v[80:95], v[28:31], v[196:199], v[80:95]
  v_mul_f32 v41, s52, v41
  v_cvt_pk_bf16_f32 v40, v40, v41
  ds_read_b128 v[28:31], v15 offset:32768
  s_waitcnt lgkmcnt(3)
  v_mfma_f32_32x32x16_bf16 v[64:79], v[16:19], v[136:139], v[64:79]
  buffer_load_dwordx4 v[100:103], v113, s[8:11], s28 offen sc1
  v_mul_f32 v42, s52, v42
  v_mul_f32 v43, s52, v43
  v_cvt_pk_bf16_f32 v41, v42, v43
  v_mfma_f32_32x32x16_bf16 v[80:95], v[16:19], v[200:203], v[80:95]
  v_mul_f32 v44, s52, v44
  v_mul_f32 v45, s52, v45
  ds_read_b128 v[16:19], v8 offset:33024
  s_waitcnt lgkmcnt(3)
  v_mfma_f32_32x32x16_bf16 v[64:79], v[20:23], v[140:143], v[64:79]
  s_add_u32 s22, s49, 10240
  s_add_u32 m0, s25, 131072
  s_nop 0
  buffer_load_dwordx4 v2, s[8:11], s22 offen sc1 lds
  v_cvt_pk_bf16_f32 v42, v44, v45
  v_mul_f32 v46, s52, v46
  v_mul_f32 v47, s52, v47
  v_mfma_f32_32x32x16_bf16 v[80:95], v[20:23], v[204:207], v[80:95]
  v_cvt_pk_bf16_f32 v43, v46, v47
  v_permlane16_swap_b32 v32, v40
  ds_read_b128 v[20:23], v9 offset:33024
  s_waitcnt lgkmcnt(3)
  v_mfma_f32_32x32x16_bf16 v[64:79], v[24:27], v[144:147], v[64:79]
  v_permlane16_swap_b32 v33, v41
  v_permlane16_swap_b32 v34, v42
  v_permlane16_swap_b32 v35, v43
  v_mfma_f32_32x32x16_bf16 v[80:95], v[24:27], v[208:211], v[80:95]
  v_accvgpr_write_b32 a40, v32
  v_accvgpr_write_b32 a41, v33
  ds_read_b128 v[24:27], v10 offset:33024
  s_waitcnt lgkmcnt(3)
  v_mfma_f32_32x32x16_bf16 v[64:79], v[28:31], v[148:151], v[64:79]
  s_add_u32 s22, s49, 11264
  s_add_u32 m0, s25, 132096
  s_nop 0
  buffer_load_dwordx4 v2, s[8:11], s22 offen sc1 lds
  v_accvgpr_write_b32 a42, v34
  v_accvgpr_write_b32 a43, v35
  v_accvgpr_write_b32 a96, v40
  v_mfma_f32_32x32x16_bf16 v[80:95], v[28:31], v[212:215], v[80:95]
  v_accvgpr_write_b32 a97, v41
  v_accvgpr_write_b32 a98, v42
  ds_read_b128 v[28:31], v11 offset:33024
  s_waitcnt lgkmcnt(3)
  v_mfma_f32_32x32x16_bf16 v[64:79], v[16:19], v[152:155], v[64:79]
  v_accvgpr_write_b32 a99, v43
  v_mul_f32 v48, s52, v48
  v_mul_f32 v49, s52, v49
  v_mfma_f32_32x32x16_bf16 v[80:95], v[16:19], v[216:219], v[80:95]
  v_cvt_pk_bf16_f32 v48, v48, v49
  v_mul_f32 v50, s52, v50
  ds_read_b128 v[16:19], v12 offset:33024
  s_waitcnt lgkmcnt(3)
  v_mfma_f32_32x32x16_bf16 v[64:79], v[20:23], v[156:159], v[64:79]
  s_add_u32 s22, s49, 12288
  s_add_u32 m0, s25, 133120
  s_nop 0
  buffer_load_dwordx4 v2, s[8:11], s22 offen sc1 lds
  v_mul_f32 v51, s52, v51
  v_cvt_pk_bf16_f32 v49, v50, v51
  v_mul_f32 v52, s52, v52
  v_mfma_f32_32x32x16_bf16 v[80:95], v[20:23], v[220:223], v[80:95]
  v_mul_f32 v53, s52, v53
  v_cvt_pk_bf16_f32 v50, v52, v53
  ds_read_b128 v[20:23], v13 offset:33024
  s_waitcnt lgkmcnt(3)
  v_mfma_f32_32x32x16_bf16 v[64:79], v[24:27], v[160:163], v[64:79]
  v_mul_f32 v54, s52, v54
  v_mul_f32 v55, s52, v55
  v_cvt_pk_bf16_f32 v51, v54, v55
  v_mfma_f32_32x32x16_bf16 v[80:95], v[24:27], v[224:227], v[80:95]
  v_mul_f32 v56, s52, v56
  v_mul_f32 v57, s52, v57
  ds_read_b128 v[24:27], v14 offset:33024
  s_waitcnt lgkmcnt(3)
  v_mfma_f32_32x32x16_bf16 v[64:79], v[28:31], v[164:167], v[64:79]
  s_add_u32 s22, s49, 13312
  s_add_u32 m0, s25, 134144
  s_nop 0
  buffer_load_dwordx4 v2, s[8:11], s22 offen sc1 lds
  v_cvt_pk_bf16_f32 v56, v56, v57
  v_mul_f32 v58, s52, v58
  v_mul_f32 v59, s52, v59
  v_mfma_f32_32x32x16_bf16 v[80:95], v[28:31], v[228:231], v[80:95]
  v_cvt_pk_bf16_f32 v57, v58, v59
  v_mul_f32 v60, s52, v60
  ds_read_b128 v[28:31], v15 offset:33024
  s_waitcnt lgkmcnt(3)
  v_mfma_f32_32x32x16_bf16 v[64:79], v[16:19], v[168:171], v[64:79]
  v_mul_f32 v61, s52, v61
  v_cvt_pk_bf16_f32 v58, v60, v61
  v_mul_f32 v62, s52, v62
  v_mfma_f32_32x32x16_bf16 v[80:95], v[16:19], v[232:235], v[80:95]
  v_mul_f32 v63, s52, v63
  v_cvt_pk_bf16_f32 v59, v62, v63
  ds_read_b128 v[16:19], v8 offset:49152
  s_waitcnt lgkmcnt(3)
  v_mfma_f32_32x32x16_bf16 v[64:79], v[20:23], v[172:175], v[64:79]
  v_permlane16_swap_b32 v48, v56
  v_permlane16_swap_b32 v49, v57
  v_permlane16_swap_b32 v50, v58
  v_mfma_f32_32x32x16_bf16 v[80:95], v[20:23], v[236:239], v[80:95]
  v_permlane16_swap_b32 v51, v59
  v_accvgpr_write_b32 a152, v48
  ds_read_b128 v[20:23], v9 offset:49152
  s_waitcnt lgkmcnt(3)
  v_mfma_f32_32x32x16_bf16 v[64:79], v[24:27], v[176:179], v[64:79]
  v_accvgpr_write_b32 a153, v49
  v_accvgpr_write_b32 a154, v50
  v_accvgpr_write_b32 a155, v51
  v_mfma_f32_32x32x16_bf16 v[80:95], v[24:27], v[240:243], v[80:95]
  v_accvgpr_write_b32 a208, v56
  v_accvgpr_write_b32 a209, v57
  ds_read_b128 v[24:27], v10 offset:49152
  s_waitcnt lgkmcnt(3)
  v_mfma_f32_32x32x16_bf16 v[64:79], v[28:31], v[180:183], v[64:79]
  v_accvgpr_write_b32 a210, v58
  v_accvgpr_write_b32 a211, v59
  v_mfma_f32_32x32x16_bf16 v[80:95], v[28:31], v[244:247], v[80:95]
  ds_read_b128 v[28:31], v11 offset:49152
  s_waitcnt lgkmcnt(3)
  v_mfma_f32_32x32x16_bf16 v[32:47], v[16:19], v[120:123], 0
  s_waitcnt vmcnt(4)
  v_cmp_ne_u64 vcc, s[88:89], v[100:101]
  v_cmp_ne_u64 s[54:55], s[88:89], v[102:103]
  s_add_u32 s50, s32, 0
  v_mfma_f32_32x32x16_bf16 v[48:63], v[16:19], v[184:187], 0
  ds_read_b128 v[16:19], v12 offset:49152
  s_waitcnt lgkmcnt(3)
  v_mfma_f32_32x32x16_bf16 v[32:47], v[20:23], v[124:127], v[32:47]
  s_or_b64 vcc, vcc, s[54:55]
  s_cselect_b32 s50, 0x10000000, s50
  s_add_u32 s22, s50, 12288
  buffer_load_dwordx4 v[248:251], v2, s[8:11], s22 offen sc1
  v_mul_f32 v64, s52, v64
  v_mul_f32 v65, s52, v65
  v_cvt_pk_bf16_f32 v64, v64, v65
  v_mfma_f32_32x32x16_bf16 v[48:63], v[20:23], v[188:191], v[48:63]
  v_mul_f32 v66, s52, v66
  v_mul_f32 v67, s52, v67
  ds_read_b128 v[20:23], v13 offset:49152
  s_waitcnt lgkmcnt(3)
  v_mfma_f32_32x32x16_bf16 v[32:47], v[24:27], v[128:131], v[32:47]
  s_add_u32 s22, s50, 13312
  buffer_load_dwordx4 v[252:255], v2, s[8:11], s22 offen sc1
  v_cvt_pk_bf16_f32 v65, v66, v67
  v_mul_f32 v68, s52, v68
  v_mul_f32 v69, s52, v69
  v_mfma_f32_32x32x16_bf16 v[48:63], v[24:27], v[192:195], v[48:63]
  v_cvt_pk_bf16_f32 v66, v68, v69
  v_mul_f32 v70, s52, v70
  ds_read_b128 v[24:27], v14 offset:49152
  s_waitcnt lgkmcnt(3)
  v_mfma_f32_32x32x16_bf16 v[32:47], v[28:31], v[132:135], v[32:47]
  s_add_u32 s22, s50, 0
  s_add_u32 m0, s25, 0
  s_nop 0
  buffer_load_dwordx4 v2, s[8:11], s22 offen sc1 lds
  v_mul_f32 v71, s52, v71
  v_cvt_pk_bf16_f32 v67, v70, v71
  v_mul_f32 v72, s52, v72
  v_mfma_f32_32x32x16_bf16 v[48:63], v[28:31], v[196:199], v[48:63]
  v_mul_f32 v73, s52, v73
  v_cvt_pk_bf16_f32 v72, v72, v73
  ds_read_b128 v[28:31], v15 offset:49152
  s_waitcnt lgkmcnt(3)
  v_mfma_f32_32x32x16_bf16 v[32:47], v[16:19], v[136:139], v[32:47]
  s_add_u32 s22, s50, 1024
  s_add_u32 m0, s25, 1024
  s_nop 0
  buffer_load_dwordx4 v2, s[8:11], s22 offen sc1 lds
  v_mul_f32 v74, s52, v74
  v_mul_f32 v75, s52, v75
  v_cvt_pk_bf16_f32 v73, v74, v75
  v_mfma_f32_32x32x16_bf16 v[48:63], v[16:19], v[200:203], v[48:63]
  v_mul_f32 v76, s52, v76
  v_mul_f32 v77, s52, v77
  ds_read_b128 v[16:19], v8 offset:49408
  s_waitcnt lgkmcnt(3)
  v_mfma_f32_32x32x16_bf16 v[32:47], v[20:23], v[140:143], v[32:47]
  s_add_u32 s22, s50, 2048
  s_add_u32 m0, s25, 2048
  s_nop 0
  buffer_load_dwordx4 v2, s[8:11], s22 offen sc1 lds
  v_cvt_pk_bf16_f32 v74, v76, v77
  v_mul_f32 v78, s52, v78
  v_mul_f32 v79, s52, v79
  v_mfma_f32_32x32x16_bf16 v[48:63], v[20:23], v[204:207], v[48:63]
  v_cvt_pk_bf16_f32 v75, v78, v79
  v_permlane16_swap_b32 v64, v72
  ds_read_b128 v[20:23], v9 offset:49408
  s_waitcnt lgkmcnt(3)
  v_mfma_f32_32x32x16_bf16 v[32:47], v[24:27], v[144:147], v[32:47]
  s_add_u32 s22, s50, 3072
  s_add_u32 m0, s25, 3072
  s_nop 0
  buffer_load_dwordx4 v2, s[8:11], s22 offen sc1 lds
  v_permlane16_swap_b32 v65, v73
  v_permlane16_swap_b32 v66, v74
  v_permlane16_swap_b32 v67, v75
  v_mfma_f32_32x32x16_bf16 v[48:63], v[24:27], v[208:211], v[48:63]
  v_accvgpr_write_b32 a44, v64
  v_accvgpr_write_b32 a45, v65
  ds_read_b128 v[24:27], v10 offset:49408
  s_waitcnt lgkmcnt(3)
  v_mfma_f32_32x32x16_bf16 v[32:47], v[28:31], v[148:151], v[32:47]
  s_add_u32 s22, s50, 4096
  s_add_u32 m0, s25, 16384
  s_nop 0
  buffer_load_dwordx4 v2, s[8:11], s22 offen sc1 lds
  v_accvgpr_write_b32 a46, v66
  v_accvgpr_write_b32 a47, v67
  v_accvgpr_write_b32 a100, v72
  v_mfma_f32_32x32x16_bf16 v[48:63], v[28:31], v[212:215], v[48:63]
  v_accvgpr_write_b32 a101, v73
  v_accvgpr_write_b32 a102, v74
  ds_read_b128 v[28:31], v11 offset:49408
  s_waitcnt lgkmcnt(3)
  v_mfma_f32_32x32x16_bf16 v[32:47], v[16:19], v[152:155], v[32:47]
  s_add_u32 s22, s50, 5120
  s_add_u32 m0, s25, 17408
  s_nop 0
  buffer_load_dwordx4 v2, s[8:11], s22 offen sc1 lds
  v_accvgpr_write_b32 a103, v75
  v_mul_f32 v80, s52, v80
  v_mul_f32 v81, s52, v81
  v_mfma_f32_32x32x16_bf16 v[48:63], v[16:19], v[216:219], v[48:63]
  v_cvt_pk_bf16_f32 v80, v80, v81
  v_mul_f32 v82, s52, v82
  ds_read_b128 v[16:19], v12 offset:49408
  s_waitcnt lgkmcnt(3)
  v_mfma_f32_32x32x16_bf16 v[32:47], v[20:23], v[156:159], v[32:47]
  s_add_u32 s22, s50, 6144
  s_add_u32 m0, s25, 18432
  s_nop 0
  buffer_load_dwordx4 v2, s[8:11], s22 offen sc1 lds
  v_mul_f32 v83, s52, v83
  v_cvt_pk_bf16_f32 v81, v82, v83
  v_mul_f32 v84, s52, v84
  v_mfma_f32_32x32x16_bf16 v[48:63], v[20:23], v[220:223], v[48:63]
  v_mul_f32 v85, s52, v85
  v_cvt_pk_bf16_f32 v82, v84, v85
  ds_read_b128 v[20:23], v13 offset:49408
  s_waitcnt lgkmcnt(3)
  v_mfma_f32_32x32x16_bf16 v[32:47], v[24:27], v[160:163], v[32:47]
  s_add_u32 s22, s50, 7168
  s_add_u32 m0, s25, 19456
  s_nop 0
  buffer_load_dwordx4 v2, s[8:11], s22 offen sc1 lds
  v_mul_f32 v86, s52, v86
  v_mul_f32 v87, s52, v87
  v_cvt_pk_bf16_f32 v83, v86, v87
  v_mfma_f32_32x32x16_bf16 v[48:63], v[24:27], v[224:227], v[48:63]
  v_mul_f32 v88, s52, v88
  v_mul_f32 v89, s52, v89
  ds_read_b128 v[24:27], v14 offset:49408
  s_waitcnt lgkmcnt(3)
  v_mfma_f32_32x32x16_bf16 v[32:47], v[28:31], v[164:167], v[32:47]
  v_cvt_pk_bf16_f32 v88, v88, v89
  v_mul_f32 v90, s52, v90
  v_mul_f32 v91, s52, v91
  v_mfma_f32_32x32x16_bf16 v[48:63], v[28:31], v[228:231], v[48:63]
  v_cvt_pk_bf16_f32 v89, v90, v91
  v_mul_f32 v92, s52, v92
  ds_read_b128 v[28:31], v15 offset:49408
  s_waitcnt lgkmcnt(3)
  v_mfma_f32_32x32x16_bf16 v[32:47], v[16:19], v[168:171], v[32:47]
  v_mul_f32 v93, s52, v93
  v_cvt_pk_bf16_f32 v90, v92, v93
  v_mul_f32 v94, s52, v94
  v_mfma_f32_32x32x16_bf16 v[48:63], v[16:19], v[232:235], v[48:63]
  v_mul_f32 v95, s52, v95
  v_cvt_pk_bf16_f32 v91, v94, v95
  v_xor_b32 v8, 65536, v8
  ds_read_b128 v[16:19], v8 offset:0
  s_waitcnt lgkmcnt(3)
  v_mfma_f32_32x32x16_bf16 v[32:47], v[20:23], v[172:175], v[32:47]
  v_permlane16_swap_b32 v80, v88
  v_permlane16_swap_b32 v81, v89
  v_permlane16_swap_b32 v82, v90
  v_mfma_f32_32x32x16_bf16 v[48:63], v[20:23], v[236:239], v[48:63]
  v_permlane16_swap_b32 v83, v91
  v_accvgpr_write_b32 a156, v80
  v_xor_b32 v9, 65536, v9
  ds_read_b128 v[20:23], v9 offset:0
  s_waitcnt lgkmcnt(3)
  v_mfma_f32_32x32x16_bf16 v[32:47], v[24:27], v[176:179], v[32:47]
  v_accvgpr_write_b32 a157, v81
  v_accvgpr_write_b32 a158, v82
  v_accvgpr_write_b32 a159, v83
  v_mfma_f32_32x32x16_bf16 v[48:63], v[24:27], v[240:243], v[48:63]
  v_accvgpr_write_b32 a212, v88
  v_accvgpr_write_b32 a213, v89
  v_xor_b32 v10, 65536, v10
  ds_read_b128 v[24:27], v10 offset:0
  s_waitcnt lgkmcnt(3)
  v_mfma_f32_32x32x16_bf16 v[32:47], v[28:31], v[180:183], v[32:47]
  v_accvgpr_write_b32 a214, v90
  v_accvgpr_write_b32 a215, v91
  v_mfma_f32_32x32x16_bf16 v[48:63], v[28:31], v[244:247], v[48:63]
  s_barrier
  v_xor_b32 v11, 65536, v11
  ds_read_b128 v[28:31], v11 offset:0
  s_waitcnt lgkmcnt(3)
  v_mfma_f32_32x32x16_bf16 v[64:79], v[16:19], v[120:123], 0
  s_add_u32 s22, s50, 8192
  s_add_u32 m0, s25, 32768
  s_nop 0
  buffer_load_dwordx4 v2, s[8:11], s22 offen sc1 lds
  v_mfma_f32_32x32x16_bf16 v[80:95], v[16:19], v[184:187], 0
  v_xor_b32 v12, 65536, v12
  ds_read_b128 v[16:19], v12 offset:0
  s_waitcnt lgkmcnt(3)
  v_mfma_f32_32x32x16_bf16 v[64:79], v[20:23], v[124:127], v[64:79]
  s_add_u32 s22, s50, 9216
  s_add_u32 m0, s25, 33792
  s_nop 0
  buffer_load_dwordx4 v2, s[8:11], s22 offen sc1 lds
  v_mul_f32 v32, s52, v32
  v_mul_f32 v33, s52, v33
  v_cvt_pk_bf16_f32 v32, v32, v33
  v_mfma_f32_32x32x16_bf16 v[80:95], v[20:23], v[188:191], v[80:95]
  v_mul_f32 v34, s52, v34
  v_mul_f32 v35, s52, v35
  v_xor_b32 v13, 65536, v13
  ds_read_b128 v[20:23], v13 offset:0
  s_waitcnt lgkmcnt(3)
  v_mfma_f32_32x32x16_bf16 v[64:79], v[24:27], v[128:131], v[64:79]
  s_add_u32 s22, s50, 10240
  s_add_u32 m0, s25, 34816
  s_nop 0
  buffer_load_dwordx4 v2, s[8:11], s22 offen sc1 lds
  v_cvt_pk_bf16_f32 v33, v34, v35
  v_mul_f32 v36, s52, v36
  v_mul_f32 v37, s52, v37
  v_mfma_f32_32x32x16_bf16 v[80:95], v[24:27], v[192:195], v[80:95]
  v_cvt_pk_bf16_f32 v34, v36, v37
  v_mul_f32 v38, s52, v38
  v_xor_b32 v14, 65536, v14
  ds_read_b128 v[24:27], v14 offset:0
  s_waitcnt lgkmcnt(3)
  v_mfma_f32_32x32x16_bf16 v[64:79], v[28:31], v[132:135], v[64:79]
  s_add_u32 s22, s50, 11264
  s_add_u32 m0, s25, 35840
  s_nop 0
  buffer_load_dwordx4 v2, s[8:11], s22 offen sc1 lds
  v_mul_f32 v39, s52, v39
  v_cvt_pk_bf16_f32 v35, v38, v39
  v_mul_f32 v40, s52, v40
  v_mfma_f32_32x32x16_bf16 v[80:95], v[28:31], v[196:199], v[80:95]
  v_mul_f32 v41, s52, v41
  v_cvt_pk_bf16_f32 v40, v40, v41
  v_xor_b32 v15, 65536, v15
  ds_read_b128 v[28:31], v15 offset:0
  s_waitcnt lgkmcnt(3)
  v_mfma_f32_32x32x16_bf16 v[64:79], v[16:19], v[136:139], v[64:79]
  buffer_load_dwordx4 v[100:103], v113, s[8:11], s28 offen sc1
  buffer_load_dwordx4 v[104:107], v2, s[8:11], s29 offen sc1
  buffer_load_dwordx4 v[108:111], v112, s[8:11], s29 offen sc1
  v_mul_f32 v42, s52, v42
  v_mul_f32 v43, s52, v43
  v_cvt_pk_bf16_f32 v41, v42, v43
  v_mfma_f32_32x32x16_bf16 v[80:95], v[16:19], v[200:203], v[80:95]
  v_mul_f32 v44, s52, v44
  v_mul_f32 v45, s52, v45
  ds_read_b128 v[16:19], v8 offset:256
  s_waitcnt lgkmcnt(3)
  v_mfma_f32_32x32x16_bf16 v[64:79], v[20:23], v[140:143], v[64:79]
  v_cvt_pk_bf16_f32 v42, v44, v45
  v_mul_f32 v46, s52, v46
  v_mul_f32 v47, s52, v47
  v_mfma_f32_32x32x16_bf16 v[80:95], v[20:23], v[204:207], v[80:95]
  v_cvt_pk_bf16_f32 v43, v46, v47
  v_permlane16_swap_b32 v32, v40
  ds_read_b128 v[20:23], v9 offset:256
  s_waitcnt lgkmcnt(3)
  v_mfma_f32_32x32x16_bf16 v[64:79], v[24:27], v[144:147], v[64:79]
  v_permlane16_swap_b32 v33, v41
  v_permlane16_swap_b32 v34, v42
  v_permlane16_swap_b32 v35, v43
  v_mfma_f32_32x32x16_bf16 v[80:95], v[24:27], v[208:211], v[80:95]
  v_accvgpr_write_b32 a48, v32
  v_accvgpr_write_b32 a49, v33
  ds_read_b128 v[24:27], v10 offset:256
  s_waitcnt lgkmcnt(3)
  v_mfma_f32_32x32x16_bf16 v[64:79], v[28:31], v[148:151], v[64:79]
  v_accvgpr_write_b32 a50, v34
  v_accvgpr_write_b32 a51, v35
  v_accvgpr_write_b32 a104, v40
  v_mfma_f32_32x32x16_bf16 v[80:95], v[28:31], v[212:215], v[80:95]
  v_accvgpr_write_b32 a105, v41
  v_accvgpr_write_b32 a106, v42
  ds_read_b128 v[28:31], v11 offset:256
  s_waitcnt lgkmcnt(3)
  v_mfma_f32_32x32x16_bf16 v[64:79], v[16:19], v[152:155], v[64:79]
  v_accvgpr_write_b32 a107, v43
  v_mul_f32 v48, s52, v48
  v_mul_f32 v49, s52, v49
  v_mfma_f32_32x32x16_bf16 v[80:95], v[16:19], v[216:219], v[80:95]
  v_cvt_pk_bf16_f32 v48, v48, v49
  v_mul_f32 v50, s52, v50
  ds_read_b128 v[16:19], v12 offset:256
  s_waitcnt lgkmcnt(3)
  v_mfma_f32_32x32x16_bf16 v[64:79], v[20:23], v[156:159], v[64:79]
  v_mul_f32 v51, s52, v51
  v_cvt_pk_bf16_f32 v49, v50, v51
  v_mul_f32 v52, s52, v52
  v_mfma_f32_32x32x16_bf16 v[80:95], v[20:23], v[220:223], v[80:95]
  v_mul_f32 v53, s52, v53
  v_cvt_pk_bf16_f32 v50, v52, v53
  ds_read_b128 v[20:23], v13 offset:256
  s_waitcnt lgkmcnt(3)
  v_mfma_f32_32x32x16_bf16 v[64:79], v[24:27], v[160:163], v[64:79]
  v_mul_f32 v54, s52, v54
  v_mul_f32 v55, s52, v55
  v_cvt_pk_bf16_f32 v51, v54, v55
  v_mfma_f32_32x32x16_bf16 v[80:95], v[24:27], v[224:227], v[80:95]
  v_mul_f32 v56, s52, v56
  v_mul_f32 v57, s52, v57
  ds_read_b128 v[24:27], v14 offset:256
  s_waitcnt lgkmcnt(3)
  v_mfma_f32_32x32x16_bf16 v[64:79], v[28:31], v[164:167], v[64:79]
  v_cvt_pk_bf16_f32 v56, v56, v57
  v_mul_f32 v58, s52, v58
  v_mul_f32 v59, s52, v59
  v_mfma_f32_32x32x16_bf16 v[80:95], v[28:31], v[228:231], v[80:95]
  v_cvt_pk_bf16_f32 v57, v58, v59
  v_mul_f32 v60, s52, v60
  ds_read_b128 v[28:31], v15 offset:256
  s_waitcnt lgkmcnt(3)
  v_mfma_f32_32x32x16_bf16 v[64:79], v[16:19], v[168:171], v[64:79]
  v_mul_f32 v61, s52, v61
  v_cvt_pk_bf16_f32 v58, v60, v61
  v_mul_f32 v62, s52, v62
  v_mfma_f32_32x32x16_bf16 v[80:95], v[16:19], v[232:235], v[80:95]
  v_mul_f32 v63, s52, v63
  v_cvt_pk_bf16_f32 v59, v62, v63
  s_waitcnt lgkmcnt(2)
  v_mfma_f32_32x32x16_bf16 v[64:79], v[20:23], v[172:175], v[64:79]
  v_permlane16_swap_b32 v48, v56
  v_permlane16_swap_b32 v49, v57
  v_permlane16_swap_b32 v50, v58
  v_mfma_f32_32x32x16_bf16 v[80:95], v[20:23], v[236:239], v[80:95]
  v_permlane16_swap_b32 v51, v59
  v_accvgpr_write_b32 a160, v48
  s_waitcnt lgkmcnt(1)
  v_mfma_f32_32x32x16_bf16 v[64:79], v[24:27], v[176:179], v[64:79]
  v_accvgpr_write_b32 a161, v49
  v_accvgpr_write_b32 a162, v50
  v_accvgpr_write_b32 a163, v51
  v_mfma_f32_32x32x16_bf16 v[80:95], v[24:27], v[240:243], v[80:95]
  v_accvgpr_write_b32 a216, v56
  v_accvgpr_write_b32 a217, v57
  s_waitcnt lgkmcnt(0)
  v_mfma_f32_32x32x16_bf16 v[64:79], v[28:31], v[180:183], v[64:79]
  v_accvgpr_write_b32 a218, v58
  v_accvgpr_write_b32 a219, v59
  v_mfma_f32_32x32x16_bf16 v[80:95], v[28:31], v[244:247], v[80:95]
  s_nop 4
  v_mul_f32 v64, s52, v64
  v_mul_f32 v65, s52, v65
  v_cvt_pk_bf16_f32 v64, v64, v65
  v_mul_f32 v66, s52, v66
  v_mul_f32 v67, s52, v67
  v_cvt_pk_bf16_f32 v65, v66, v67
  v_mul_f32 v68, s52, v68
  v_mul_f32 v69, s52, v69
  v_cvt_pk_bf16_f32 v66, v68, v69
  v_mul_f32 v70, s52, v70
  v_mul_f32 v71, s52, v71
  v_cvt_pk_bf16_f32 v67, v70, v71
  v_mul_f32 v72, s52, v72
  v_mul_f32 v73, s52, v73
  v_cvt_pk_bf16_f32 v72, v72, v73
  v_mul_f32 v74, s52, v74
  v_mul_f32 v75, s52, v75
  v_cvt_pk_bf16_f32 v73, v74, v75
  v_mul_f32 v76, s52, v76
  v_mul_f32 v77, s52, v77
  v_cvt_pk_bf16_f32 v74, v76, v77
  v_mul_f32 v78, s52, v78
  v_mul_f32 v79, s52, v79
  v_cvt_pk_bf16_f32 v75, v78, v79
  v_permlane16_swap_b32 v64, v72
  v_permlane16_swap_b32 v65, v73
  v_permlane16_swap_b32 v66, v74
  v_permlane16_swap_b32 v67, v75
  v_accvgpr_write_b32 a52, v64
  v_accvgpr_write_b32 a53, v65
  v_accvgpr_write_b32 a54, v66
  v_accvgpr_write_b32 a55, v67
  v_accvgpr_write_b32 a108, v72
  v_accvgpr_write_b32 a109, v73
  v_accvgpr_write_b32 a110, v74
  v_accvgpr_write_b32 a111, v75
  v_mul_f32 v80, s52, v80
  v_mul_f32 v81, s52, v81
  v_cvt_pk_bf16_f32 v80, v80, v81
  v_mul_f32 v82, s52, v82
  v_mul_f32 v83, s52, v83
  v_cvt_pk_bf16_f32 v81, v82, v83
  v_mul_f32 v84, s52, v84
  v_mul_f32 v85, s52, v85
  v_cvt_pk_bf16_f32 v82, v84, v85
  v_mul_f32 v86, s52, v86
  v_mul_f32 v87, s52, v87
  v_cvt_pk_bf16_f32 v83, v86, v87
  v_mul_f32 v88, s52, v88
  v_mul_f32 v89, s52, v89
  v_cvt_pk_bf16_f32 v88, v88, v89
  v_mul_f32 v90, s52, v90
  v_mul_f32 v91, s52, v91
  v_cvt_pk_bf16_f32 v89, v90, v91
  v_mul_f32 v92, s52, v92
  v_mul_f32 v93, s52, v93
  v_cvt_pk_bf16_f32 v90, v92, v93
  v_mul_f32 v94, s52, v94
  v_mul_f32 v95, s52, v95
  v_cvt_pk_bf16_f32 v91, v94, v95
  v_permlane16_swap_b32 v80, v88
  v_permlane16_swap_b32 v81, v89
  v_permlane16_swap_b32 v82, v90
  v_permlane16_swap_b32 v83, v91
  v_accvgpr_write_b32 a164, v80
  v_accvgpr_write_b32 a165, v81
  v_accvgpr_write_b32 a166, v82
  v_accvgpr_write_b32 a167, v83
  v_accvgpr_write_b32 a220, v88
  v_accvgpr_write_b32 a221, v89
  v_accvgpr_write_b32 a222, v90
  v_accvgpr_write_b32 a223, v91
  s_mov_b32 s30, 0
  s_branch sc_aw_w
sc_aw:
  buffer_load_dwordx4 v[100:103], v113, s[8:11], s28 offen sc1
  buffer_load_dwordx4 v[104:107], v2, s[8:11], s29 offen sc1
  buffer_load_dwordx4 v[108:111], v112, s[8:11], s29 offen sc1
sc_aw_w:
  s_waitcnt vmcnt(0)
  v_cmp_ne_u64 vcc, s[88:89], v[100:101]
  s_cbranch_vccnz sc_aw_no
  v_cmp_ne_u64 vcc, s[88:89], v[102:103]
  s_cbranch_vccnz sc_aw_no
  v_cmp_ne_u64 vcc, s[88:89], v[104:105]
  s_cbranch_vccnz sc_aw_no
  v_cmp_ne_u64 vcc, s[88:89], v[106:107]
  s_cbranch_vccnz sc_aw_no
  v_cmp_ne_u64 vcc, s[88:89], v[108:109]
  s_cbranch_vccnz sc_aw_no
  v_cmp_ne_u64 vcc, s[88:89], v[110:111]
  s_cbranch_vccnz sc_aw_no
  s_branch sc_aw_ok
sc_aw_no:
  s_sleep 1
  s_add_u32 s30, s30, 1
  s_cmp_lt_u32 s30, 50000
  s_cbranch_scc1 sc_aw
  s_branch cA_abort
sc_aw_ok:
  v_add_u32 v4, s25, v2
  v_add_u32 v5, 0x10000, v4
  v_add_u32 v6, 0x20000, v4
  s_cmp_eq_u32 s48, 0x10000000
  s_cbranch_scc1 sc_d0
  ds_read_b128 v[120:123], v5 offset:16384
  ds_read_b128 v[124:127], v5 offset:17408
  ds_read_b128 v[128:131], v5 offset:18432
  ds_read_b128 v[132:135], v5 offset:19456
  ds_read_b128 v[136:139], v5 offset:32768
  ds_read_b128 v[140:143], v5 offset:33792
  s_waitcnt lgkmcnt(0)
  s_branch sc_e0
sc_d0:
  s_add_u32 s22, s33, 0
  buffer_load_dwordx4 a[224:227], v2, s[8:11], s22 offen offset:0 sc1
  buffer_load_dwordx4 a[228:231], v2, s[8:11], s22 offen offset:1024 sc1
  buffer_load_dwordx4 a[232:235], v2, s[8:11], s22 offen offset:2048 sc1
  buffer_load_dwordx4 a[236:239], v2, s[8:11], s22 offen offset:3072 sc1
  s_add_u32 s22, s33, 4096
  buffer_load_dwordx4 a[240:243], v2, s[8:11], s22 offen offset:0 sc1
  buffer_load_dwordx4 a[244:247], v2, s[8:11], s22 offen offset:1024 sc1
  buffer_load_dwordx4 a[248:251], v2, s[8:11], s22 offen offset:2048 sc1
  buffer_load_dwordx4 a[252:255], v2, s[8:11], s22 offen offset:3072 sc1
  s_add_u32 s22, s33, 8192
  buffer_load_dwordx4 v[120:123], v2, s[8:11], s22 offen offset:0 sc1
  buffer_load_dwordx4 v[124:127], v2, s[8:11], s22 offen offset:1024 sc1
  buffer_load_dwordx4 v[128:131], v2, s[8:11], s22 offen offset:2048 sc1
  buffer_load_dwordx4 v[132:135], v2, s[8:11], s22 offen offset:3072 sc1
  s_add_u32 s22, s33, 12288
  buffer_load_dwordx4 v[136:139], v2, s[8:11], s22 offen offset:0 sc1
  buffer_load_dwordx4 v[140:143], v2, s[8:11], s22 offen offset:1024 sc1
sc_e0:
  s_cmp_eq_u32 s49, 0x10000000
  s_cbranch_scc1 sc_d1
  ds_read_b128 v[144:147], v5 offset:34816
  ds_read_b128 v[148:151], v5 offset:35840
  ds_read_b128 v[152:155], v6 offset:16384
  ds_read_b128 v[156:159], v6 offset:17408
  ds_read_b128 v[160:163], v6 offset:18432
  ds_read_b128 v[164:167], v6 offset:19456
  ds_read_b128 v[168:171], v5 offset:49152
  ds_read_b128 v[172:175], v5 offset:50176
  ds_read_b128 v[176:179], v5 offset:51200
  ds_read_b128 v[180:183], v5 offset:52224
  ds_read_b128 v[184:187], v6 offset:0
  ds_read_b128 v[188:191], v6 offset:1024
  ds_read_b128 v[192:195], v6 offset:2048
  ds_read_b128 v[196:199], v6 offset:3072
  s_waitcnt lgkmcnt(0)
  s_branch sc_e1
sc_d1:
  s_add_u32 s22, s33, 12288
  buffer_load_dwordx4 v[144:147], v2, s[8:11], s22 offen offset:2048 sc1
  buffer_load_dwordx4 v[148:151], v2, s[8:11], s22 offen offset:3072 sc1
  s_add_u32 s22, s33, 16384
  buffer_load_dwordx4 v[152:155], v2, s[8:11], s22 offen offset:0 sc1
  buffer_load_dwordx4 v[156:159], v2, s[8:11], s22 offen offset:1024 sc1
  buffer_load_dwordx4 v[160:163], v2, s[8:11], s22 offen offset:2048 sc1
  buffer_load_dwordx4 v[164:167], v2, s[8:11], s22 offen offset:3072 sc1
  s_add_u32 s22, s33, 20480
  buffer_load_dwordx4 v[168:171], v2, s[8:11], s22 offen offset:0 sc1
  buffer_load_dwordx4 v[172:175], v2, s[8:11], s22 offen offset:1024 sc1
  buffer_load_dwordx4 v[176:179], v2, s[8:11], s22 offen offset:2048 sc1
  buffer_load_dwordx4 v[180:183], v2, s[8:11], s22 offen offset:3072 sc1
  s_add_u32 s22, s33, 24576
  buffer_load_dwordx4 v[184:187], v2, s[8:11], s22 offen offset:0 sc1
  buffer_load_dwordx4 v[188:191], v2, s[8:11], s22 offen offset:1024 sc1
  buffer_load_dwordx4 v[192:195], v2, s[8:11], s22 offen offset:2048 sc1
  buffer_load_dwordx4 v[196:199], v2, s[8:11], s22 offen offset:3072 sc1
sc_e1:
  s_cmp_eq_u32 s50, 0x10000000
  s_cbranch_scc1 sc_d2
  ds_read_b128 v[200:203], v4 offset:0
  ds_read_b128 v[204:207], v4 offset:1024
  ds_read_b128 v[208:211], v4 offset:2048
  ds_read_b128 v[212:215], v4 offset:3072
  ds_read_b128 v[216:219], v4 offset:16384
  ds_read_b128 v[220:223], v4 offset:17408
  ds_read_b128 v[224:227], v4 offset:18432
  ds_read_b128 v[228:231], v4 offset:19456
  ds_read_b128 v[232:235], v4 offset:32768
  ds_read_b128 v[236:239], v4 offset:33792
  ds_read_b128 v[240:243], v4 offset:34816
  ds_read_b128 v[244:247], v4 offset:35840
  s_waitcnt lgkmcnt(0)
  s_branch sc_e2
sc_d2:
  s_add_u32 s22, s32, 0
  buffer_load_dwordx4 v[200:203], v2, s[8:11], s22 offen offset:0 sc1
  buffer_load_dwordx4 v[204:207], v2, s[8:11], s22 offen offset:1024 sc1
  buffer_load_dwordx4 v[208:211], v2, s[8:11], s22 offen offset:2048 sc1
  buffer_load_dwordx4 v[212:215], v2, s[8:11], s22 offen offset:3072 sc1
  s_add_u32 s22, s32, 4096
  buffer_load_dwordx4 v[216:219], v2, s[8:11], s22 offen offset:0 sc1
  buffer_load_dwordx4 v[220:223], v2, s[8:11], s22 offen offset:1024 sc1
  buffer_load_dwordx4 v[224:227], v2, s[8:11], s22 offen offset:2048 sc1
  buffer_load_dwordx4 v[228:231], v2, s[8:11], s22 offen offset:3072 sc1
  s_add_u32 s22, s32, 8192
  buffer_load_dwordx4 v[232:235], v2, s[8:11], s22 offen offset:0 sc1
  buffer_load_dwordx4 v[236:239], v2, s[8:11], s22 offen offset:1024 sc1
  buffer_load_dwordx4 v[240:243], v2, s[8:11], s22 offen offset:2048 sc1
  buffer_load_dwordx4 v[244:247], v2, s[8:11], s22 offen offset:3072 sc1
  s_add_u32 s22, s32, 12288
  buffer_load_dwordx4 v[248:251], v2, s[8:11], s22 offen offset:0 sc1
  buffer_load_dwordx4 v[252:255], v2, s[8:11], s22 offen offset:1024 sc1
sc_e2:
  s_barrier
  s_branch m_role
m_val:
  s_cmp_lg_u32 s16, 0
  s_cbranch_scc1 w0_6
  v_mov_b32 v233, 128
  v_mov_b32 v234, s88
  v_mov_b32 v235, s89
  v_mov_b32 v236, 0
  v_mov_b32 v237, 0
  s_mov_b64 exec, 1
  buffer_atomic_cmpswap_x2 v[234:237], v233, s[12:15], 0 offen sc0
  s_mov_b64 exec, -1
w0_6:
  s_cmp_lg_u32 s66, 0
  s_cbranch_scc1 va_ci
  s_cmp_lg_u32 s16, 0
  s_cbranch_scc1 w0_7
  s_lshr_b32 s70, s3, 5
  s_and_b32 s71, s70, 4
  s_mul_i32 s71, s71, 12
  s_lshl_b32 s70, s70, 2
  s_add_u32 s70, s70, s71
  s_lshl_b32 s71, 1, s3
  v_mov_b32 v242, s71
  v_mov_b32 v243, 32
  s_mov_b64 exec, 1
  buffer_atomic_or v242, v243, s[12:15], s70 offen sc0
  buffer_load_dwordx2 v[244:245], v243, s[12:15], 0 offen offset:96 sc1
  s_mov_b64 exec, -1
w0_7:
va_ci:
  s_mov_b32 s56, s40
  s_and_b32 s57, s41, 0xffff
  s_mov_b32 s58, 3670016
  s_mov_b32 s59, 0x20000
  v_lshrrev_b32 v24, 5, v1
  v_and_b32 v25, 31, v1
  v_lshlrev_b32 v25, 4, v25
  v_lshl_add_u32 v24, v24, 13, v25
  s_mov_b32 s60, s42
  s_and_b32 s61, s43, 0xffff
  s_mov_b32 s62, 3670016
  s_mov_b32 s63, 0x20000
  s_lshl_b32 s22, s17, 9
  s_lshl_b32 s23, s16, 19
  s_add_u32 s23, s22, s23
  s_add_u32 s21, s23, 262144
  buffer_load_dwordx4 v[28:31], v24, s[60:63], s21 offen
  s_add_u32 s21, s23, 278528
  buffer_load_dwordx4 v[28:31], v24, s[60:63], s21 offen
  s_add_u32 s21, s23, 294912
  buffer_load_dwordx4 v[28:31], v24, s[60:63], s21 offen
  s_add_u32 s21, s23, 311296
  buffer_load_dwordx4 v[28:31], v24, s[60:63], s21 offen
  s_add_u32 s21, s23, 327680
  buffer_load_dwordx4 v[28:31], v24, s[60:63], s21 offen
  s_add_u32 s21, s23, 344064
  buffer_load_dwordx4 v[28:31], v24, s[60:63], s21 offen
  s_add_u32 s21, s23, 360448
  buffer_load_dwordx4 v[28:31], v24, s[60:63], s21 offen
  s_add_u32 s21, s23, 376832
  buffer_load_dwordx4 v[28:31], v24, s[60:63], s21 offen
  s_add_u32 s21, s23, 393216
  buffer_load_dwordx4 v[28:31], v24, s[60:63], s21 offen
  s_add_u32 s21, s23, 409600
  buffer_load_dwordx4 v[28:31], v24, s[60:63], s21 offen
  s_add_u32 s21, s23, 425984
  buffer_load_dwordx4 v[28:31], v24, s[60:63], s21 offen
  s_add_u32 s21, s23, 442368
  buffer_load_dwordx4 v[28:31], v24, s[60:63], s21 offen
  s_add_u32 s21, s23, 458752
  buffer_load_dwordx4 v[28:31], v24, s[60:63], s21 offen
  s_add_u32 s21, s23, 475136
  buffer_load_dwordx4 v[28:31], v24, s[60:63], s21 offen
  s_add_u32 s21, s23, 491520
  buffer_load_dwordx4 v[28:31], v24, s[60:63], s21 offen
  s_add_u32 s21, s23, 507904
  buffer_load_dwordx4 v[28:31], v24, s[60:63], s21 offen
  s_lshl_b32 s23, s16, 14
  s_add_u32 s22, s22, s23
  s_mov_b32 s30, 0
va_pf:
  buffer_load_dwordx4 v[28:31], v24, s[56:59], s22 offen
  s_waitcnt vmcnt(40)
  s_add_u32 s22, s22, 65536
  s_add_u32 s30, s30, 1
  s_cmp_lt_u32 s30, 56
  s_cbranch_scc1 va_pf
  s_cmp_lg_u32 s66, 0
  s_cbranch_scc1 va_cf
  s_cmp_lg_u32 s16, 0
  s_cbranch_scc1 w0_8
  s_waitcnt vmcnt(40)
  v_readfirstlane_b32 s70, v244
  s_cmp_lg_u32 s70, 0
  s_cbranch_scc1 va_nz
  v_mov_b32 v243, 128
  v_mov_b32 v244, s88
  v_mov_b32 v245, s89
  v_mov_b32 v246, 0
  v_mov_b32 v247, 0
  s_mov_b64 exec, 1
  buffer_atomic_cmpswap_x2 v[244:247], v243, s[12:15], 0 offen sc0
  s_mov_b64 exec, -1
  s_waitcnt vmcnt(0)
  v_readfirstlane_b32 s70, v244
  s_cmp_lg_u32 s70, 0
  s_cbranch_scc1 va_nz
  v_mov_b32 v244, s88
  v_mov_b32 v245, s89
va_nz:
w0_8:
  v_mov_b32 v243, 160000
  s_add_u32 s101, s101, 1
  s_barrier
  s_mov_b64 exec, 1
  s_cmp_lg_u32 s16, 0
  s_cbranch_scc1 w0_9
  ds_write_b32 v243, v242 offset:0
  ds_write_b32 v243, v244 offset:4
  ds_write_b32 v243, v245 offset:8
  s_waitcnt lgkmcnt(0)
  v_mov_b32 v242, s101
  ds_write_b32 v243, v242 offset:16
  s_waitcnt lgkmcnt(0)
w0_9:
  s_mov_b64 exec, -1
  s_barrier
  ds_read_b32 v242, v243 offset:0
  ds_read_b32 v244, v243 offset:4
  ds_read_b32 v245, v243 offset:8
  ds_read_b32 v243, v243 offset:16
  s_waitcnt lgkmcnt(0)
  v_readfirstlane_b32 s70, v242
  v_readfirstlane_b32 s88, v244
  v_readfirstlane_b32 s89, v245
  v_cmp_ne_u32 vcc, s101, v243
  s_cbranch_vccnz ch_end
  s_mov_b32 s66, 1
  s_bitcmp1_b32 s70, s3
  s_cbranch_scc1 m_reclaim
va_cf:
  s_cmp_lg_u32 s16, 0
  s_cbranch_scc1 w0_10
  s_cmp_eq_u32 s67, 0
  s_cselect_b32 s20, 1, 0x10001
  v_mov_b32 v242, s20
  v_mov_b32 v243, 0
  s_mov_b64 exec, 1
  buffer_atomic_add v242, v243, s[12:15], 0 offen
  s_mov_b64 exec, -1
w0_10:
m_role:
  s_mov_b32 s17, s3
  v_and_b32 v1, 63, v0
  v_lshlrev_b32 v2, 4, v1
  v_lshrrev_b32 v116, 4, v1
  v_and_b32 v117, 15, v1
  v_mov_b32 v3, 0x4444
  v_mov_b32 v118, 0xeeee
  v_cmp_lt_u32 vcc, 7, v117
  s_nop 1
  v_cndmask_b32 v3, v3, v118, vcc
  s_mov_b32 s19, 0
  s_mov_b32 s20, 88657920
  s_lshr_b32 s22, s17, 4
  s_lshl_b32 s22, s22, 2
  s_add_u32 s22, s22, s16
  s_and_b32 s17, s17, 15
  s_cmp_eq_u32 s22, 0
  s_cbranch_scc1 ch_init0
  s_cmp_eq_u32 s22, 1
  s_cbranch_scc1 ch_init1
  s_cmp_eq_u32 s22, 2
  s_cbranch_scc1 ch_init2
  s_cmp_eq_u32 s22, 3
  s_cbranch_scc1 ch_init3
  s_cmp_eq_u32 s22, 4
  s_cbranch_scc1 ch_init4
  s_cmp_eq_u32 s22, 5
  s_cbranch_scc1 ch_init5
  s_cmp_eq_u32 s22, 6
  s_cbranch_scc1 ch_init6
  s_cmp_eq_u32 s22, 7
  s_cbranch_scc1 ch_init7
  s_branch ch_end
ch_init0:
  s_getpc_b64 s[98:99]
cpf_11:
  s_add_u32 s98, s98, cA_sc0_loop-cpf_11
  s_addc_u32 s99, s99, 0
  v_lshlrev_b32 v38, 2, v2
  global_load_dword v39, v38, s[98:99]
  s_mul_i32 s31, s17, 401408
  s_add_u32 s31, s31, 0
  s_mov_b32 s24, 71565312
  s_mov_b32 s25, 0
  s_add_u32 m0, s25, 0
  s_nop 0
  buffer_load_dwordx4 v2, s[8:11], s24 offen offset:0 sc1 lds
  buffer_load_dwordx4 v2, s[8:11], s24 offen offset:1024 sc1 lds
  buffer_load_dwordx4 v2, s[8:11], s24 offen offset:2048 sc1 lds
  buffer_load_dwordx4 v2, s[8:11], s24 offen offset:3072 sc1 lds
  s_add_u32 m0, s25, 4096
  s_add_u32 s22, s24, 4096
  buffer_load_dwordx4 v2, s[8:11], s22 offen offset:0 sc1 lds
  buffer_load_dwordx4 v2, s[8:11], s22 offen offset:1024 sc1 lds
  buffer_load_dwordx4 v2, s[8:11], s22 offen offset:2048 sc1 lds
  v_lshrrev_b32 v64, 1, v117
  v_and_b32 v65, 1, v116
  v_lshlrev_b32 v65, 2, v65
  v_sub_u32 v64, v64, v65
  v_and_b32 v65, 1, v117
  v_lshl_add_u32 v66, v65, 2, v64
  v_cmp_gt_u32 vcc, 4, v64
  v_mov_b32 v67, 99
  s_nop 0
  v_cndmask_b32 v66, v67, v66, vcc
  v_mov_b32 v68, 0x3f80
  v_mov_b32 v69, 0x3f800000
  v_mov_b32 v4, 0
  v_cmp_eq_u32 vcc, 0, v66
  s_nop 1
  v_cndmask_b32 v4, v4, v68, vcc
  v_cmp_eq_u32 vcc, 1, v66
  s_nop 1
  v_cndmask_b32 v4, v4, v69, vcc
  v_mov_b32 v5, 0
  v_cmp_eq_u32 vcc, 2, v66
  s_nop 1
  v_cndmask_b32 v5, v5, v68, vcc
  v_cmp_eq_u32 vcc, 3, v66
  s_nop 1
  v_cndmask_b32 v5, v5, v69, vcc
  v_mov_b32 v6, 0
  v_cmp_eq_u32 vcc, 4, v66
  s_nop 1
  v_cndmask_b32 v6, v6, v68, vcc
  v_cmp_eq_u32 vcc, 5, v66
  s_nop 1
  v_cndmask_b32 v6, v6, v69, vcc
  v_mov_b32 v7, 0
  v_cmp_eq_u32 vcc, 6, v66
  s_nop 1
  v_cndmask_b32 v7, v7, v68, vcc
  v_cmp_eq_u32 vcc, 7, v66
  s_nop 1
  v_cndmask_b32 v7, v7, v69, vcc
  v_lshrrev_b32 v64, 1, v116
  v_lshrrev_b32 v65, 3, v117
  v_cmp_eq_u32 s[26:27], v64, v65
  v_and_b32 v66, 1, v116
  v_add_u32 v64, 0, v64
  v_lshrrev_b32 v67, 1, v116
  v_lshlrev_b32 v67, 8, v67
  v_lshl_add_u32 v67, v66, 9, v67
  v_lshl_add_u32 v67, v117, 4, v67
  v_add_u32 v112, 57344, v67
  v_and_b32 v68, 7, v117
  v_lshlrev_b32 v67, 8, v64
  v_lshl_add_u32 v67, v68, 5, v67
  v_lshl_add_u32 v67, v66, 4, v67
  v_add_u32 v113, 65536, v67
  v_lshrrev_b32 v64, 5, v1
  v_and_b32 v65, 31, v1
  v_lshrrev_b32 v66, 3, v65
  v_and_b32 v67, 7, v65
  v_and_b32 v68, 3, v67
  v_lshl_add_u32 v68, v66, 2, v68
  v_lshrrev_b32 v69, 2, v67
  v_lshl_add_u32 v68, v69, 4, v68
  v_lshlrev_b32 v69, 11, v64
  v_lshl_add_u32 v69, v68, 4, v69
  v_add_u32 v114, 57344, v69
  v_add_u32 v70, 0, v64
  v_lshlrev_b32 v69, 9, v66
  v_lshl_add_u32 v69, v70, 5, v69
  v_lshl_add_u32 v69, v67, 2, v69
  v_add_u32 v115, 65536, v69
  v_lshlrev_b32 v69, 4, v68
  v_lshl_add_u32 v69, v64, 9, v69
  v_add_u32 v114, 57344, v69
  v_mul_u32_u24 v69, 144, v70
  v_lshl_add_u32 v69, v67, 4, v69
  v_add_u32 v115, 65536, v69
  v_and_b32 v71, 1, v116
  v_mul_u32_u24 v69, 2048, v71
  v_lshl_add_u32 v69, v64, 8, v69
  v_lshl_add_u32 v69, v117, 4, v69
  v_add_u32 v112, 57344, v69
  v_mul_u32_u24 v69, 144, v117
  v_lshl_add_u32 v69, v71, 6, v69
  v_lshl_add_u32 v69, v64, 5, v69
  v_add_u32 v113, 65536, v69
  v_mul_u32_u24 v69, 1024, v116
  v_lshl_add_u32 v69, v117, 4, v69
  v_and_b32 v72, 8, v117
  v_xor_b32 v72, 0, v72
  v_add_u32 v69, v69, v72
  v_add_u32 v112, 57344, v69
  v_lshrrev_b32 v72, 3, v117
  v_lshl_add_u32 v72, v71, 1, v72
  v_xor_b32 v72, 0, v72
  v_lshlrev_b32 v69, 10, v116
  v_lshl_add_u32 v69, v117, 4, v69
  v_lshl_add_u32 v69, v72, 2, v69
  v_add_u32 v112, 57344, v69
  v_lshrrev_b32 v69, 1, v117
  v_and_b32 v72, 1, v117
  v_lshl_add_u32 v69, v72, 3, v69
  v_mul_u32_u24 v69, 144, v69
  v_lshl_add_u32 v69, v71, 6, v69
  v_lshl_add_u32 v69, v64, 5, v69
  v_lshl_add_u32 v72, v72, 1, v71
  v_xor_b32 v72, 0, v72
  v_lshl_add_u32 v69, v72, 2, v69
  v_add_u32 v113, 65536, v69
  v_and_b32 v71, 1, v1
  v_cmp_eq_u32 s[38:39], 0, v71
  v_cmp_gt_u32 vcc, 8, v65
  s_or_b64 s[28:29], s[38:39], vcc
  v_lshrrev_b32 v72, 1, v67
  v_lshlrev_b32 v72, 2, v72
  v_lshl_add_u32 v72, v70, 4, v72
  s_lshl_b32 s22, s17, 9
  s_add_u32 s22, s22, 9216
  v_lshl_add_u32 v73, v66, 7, v72
  v_add_u32 v73, s22, v73
  s_lshl_b32 s22, s17, 7
  s_add_u32 s22, s22, 7168
  v_add_u32 v74, s22, v72
  v_bfe_u32 v72, v65, 1, 1
  v_lshlrev_b32 v72, 7, v72
  v_lshl_add_u32 v72, v70, 4, v72
  v_bfe_u32 v73, v65, 2, 2
  v_lshl_add_u32 v72, v73, 2, v72
  v_lshrrev_b32 v73, 4, v65
  v_lshl_add_u32 v73, v73, 8, v72
  s_lshl_b32 s22, s17, 9
  s_add_u32 s22, s22, 9216
  v_add_u32 v73, s22, v73
  s_lshr_b32 s22, s17, 1
  s_lshl_b32 s22, s22, 8
  s_and_b32 s34, s17, 1
  s_lshl_b32 s34, s34, 3
  s_add_u32 s22, s22, s34
  s_add_u32 s22, s22, 7168
  v_add_u32 v74, s22, v72
  v_bfe_u32 v72, v65, 1, 1
  v_lshl_add_u32 v72, v64, 1, v72
  v_lshlrev_b32 v72, 4, v72
  v_bfe_u32 v73, v65, 2, 2
  v_lshl_add_u32 v72, v73, 2, v72
  v_lshrrev_b32 v73, 4, v65
  v_lshl_add_u32 v73, v73, 6, v72
  s_lshl_b32 s22, s17, 9
  s_add_u32 s22, s22, 9216
  v_add_u32 v73, s22, v73
  v_lshrrev_b32 v72, 1, v65
  v_lshlrev_b32 v72, 2, v72
  v_lshl_add_u32 v72, v64, 5, v72
  s_lshr_b32 s22, s17, 1
  s_lshl_b32 s22, s22, 8
  s_and_b32 s34, s17, 1
  s_lshl_b32 s34, s34, 4
  s_add_u32 s22, s22, s34
  s_add_u32 s22, s22, 7168
  v_add_u32 v74, s22, v72
  v_lshlrev_b32 v0, 2, v65
  v_and_b32 v0, 120, v0
  s_and_b32 s22, s17, 15
  s_lshl_b32 s22, s22, 7
  s_add_u32 s22, s22, 18432
  v_add_u32 v0, s22, v0
  v_cndmask_b32 v1, v74, v73, s[38:39]
  s_lshl_b32 s36, s17, 2
  s_add_u32 s36, s36, 17472
  s_mov_b32 s37, 0x3e800000
  v_mov_b32 v36, 0
  v_mov_b32 v37, 0
  v_mov_b32 v38, 0
  v_mov_b32 v39, 0
  v_mov_b32 v40, 0
  v_mov_b32 v41, 0
  v_mov_b32 v42, 0
  v_mov_b32 v43, 0
  v_mov_b32 v44, 0
  v_mov_b32 v45, 0
  v_mov_b32 v46, 0
  v_mov_b32 v47, 0
  v_mov_b32 v48, 0
  v_mov_b32 v49, 0
  v_mov_b32 v50, 0
  v_mov_b32 v51, 0
  v_mov_b32 v52, 0
  v_mov_b32 v53, 0
  v_mov_b32 v54, 0
  v_mov_b32 v55, 0
  v_mov_b32 v56, 0
  v_mov_b32 v57, 0
  v_mov_b32 v58, 0
  v_mov_b32 v59, 0
  v_mov_b32 v60, 0
  v_mov_b32 v61, 0
  v_mov_b32 v62, 0
  v_mov_b32 v63, 0
  v_mov_b32 v64, 0
  v_mov_b32 v65, 0
  v_mov_b32 v66, 0
  v_mov_b32 v67, 0
  v_mov_b32 v68, 0
  v_mov_b32 v69, 0
  v_mov_b32 v70, 0
  v_mov_b32 v71, 0
  v_mov_b32 v72, 0
  v_mov_b32 v73, 0
  v_mov_b32 v74, 0
  v_mov_b32 v75, 0
  v_mov_b32 v76, 0
  v_mov_b32 v77, 0
  v_mov_b32 v78, 0
  v_mov_b32 v79, 0
  v_mov_b32 v80, 0
  v_mov_b32 v81, 0
  v_mov_b32 v82, 0
  v_mov_b32 v83, 0
  v_mov_b32 v84, 0
  v_mov_b32 v85, 0
  v_mov_b32 v86, 0
  v_mov_b32 v87, 0
  v_mov_b32 v88, 0
  v_mov_b32 v89, 0
  v_mov_b32 v90, 0
  v_mov_b32 v91, 0
  v_mov_b32 v92, 0
  v_mov_b32 v93, 0
  v_mov_b32 v94, 0
  v_mov_b32 v95, 0
  v_mov_b32 v96, 0
  v_mov_b32 v97, 0
  v_mov_b32 v98, 0
  v_mov_b32 v99, 0
  v_mov_b32 v100, 0
  v_mov_b32 v101, 0
  v_mov_b32 v102, 0
  v_mov_b32 v103, 0
  v_mov_b32 v104, 0
  v_mov_b32 v105, 0
  v_mov_b32 v106, 0
  v_mov_b32 v107, 0
  v_mov_b32 v108, 0
  v_mov_b32 v109, 0
  v_mov_b32 v110, 0
  v_mov_b32 v111, 0
  v_and_b32 v118, 1, v116
  v_cmp_eq_u32 vcc, 0, v118
  v_mov_b32 v118, 12288
  v_mov_b32 v119, 8192
  v_cndmask_b32 v118, v118, v119, vcc
  v_lshrrev_b32 v116, 1, v116
  v_lshl_add_u32 v118, v116, 9, v118
  v_lshl_add_u32 v117, v117, 4, v118
  s_mov_b32 s57, 28672
  v_bfe_u32 v118, v2, 4, 1
  v_mul_u32_u24 v118, 0xaaaa, v118
  v_add_u32 v118, 0x4444, v118
  s_mov_b32 s56, 0x42800000
  v_mov_b32 v116, v2
  s_mul_i32 s35, s17, 1835008
  s_add_u32 s35, s35, 42262528
  v_lshl_add_u32 v119, v2, 3, s36
  v_mov_b32 v8, 0x20000000
  v_cmp_gt_u32 vcc, 64, v2
  s_nop 1
  v_cndmask_b32 v119, v8, v119, vcc
  s_mov_b32 s30, 0
  v_mov_b32 v36, 0
ch_md0:
  buffer_load_dword v37, v36, s[12:15], 0 offen sc1
  s_waitcnt vmcnt(0)
  v_readfirstlane_b32 s22, v37
  s_and_b32 s31, s22, 0xffff
  s_cmp_ge_u32 s31, 32
  s_cbranch_scc1 ch_go0
  s_sleep 2
  s_add_u32 s30, s30, 1
  s_cmp_lt_u32 s30, 50000
  s_cbranch_scc1 ch_md0
  s_branch ch_end
ch_go0:
  s_mov_b32 s31, 0
  s_lshr_b32 s22, s22, 16
  s_cmp_lg_u32 s22, 0
  s_cbranch_scc1 cB_sc0_loop
  s_branch cA_sc0_loop
ch_init1:
  s_getpc_b64 s[98:99]
cpf_12:
  s_add_u32 s98, s98, cA_sc1_loop-cpf_12
  s_addc_u32 s99, s99, 0
  v_lshlrev_b32 v38, 2, v2
  global_load_dword v39, v38, s[98:99]
  s_mul_i32 s31, s17, 401408
  s_add_u32 s31, s31, 0
  s_mov_b32 s24, 71572480
  s_mov_b32 s25, 0
  s_add_u32 m0, s25, 7168
  s_nop 0
  buffer_load_dwordx4 v2, s[8:11], s24 offen offset:0 sc1 lds
  buffer_load_dwordx4 v2, s[8:11], s24 offen offset:1024 sc1 lds
  buffer_load_dwordx4 v2, s[8:11], s24 offen offset:2048 sc1 lds
  buffer_load_dwordx4 v2, s[8:11], s24 offen offset:3072 sc1 lds
  s_add_u32 m0, s25, 11264
  s_add_u32 s22, s24, 4096
  buffer_load_dwordx4 v2, s[8:11], s22 offen offset:0 sc1 lds
  buffer_load_dwordx4 v2, s[8:11], s22 offen offset:1024 sc1 lds
  buffer_load_dwordx4 v2, s[8:11], s22 offen offset:2048 sc1 lds
  v_lshrrev_b32 v64, 1, v117
  v_and_b32 v65, 1, v116
  v_lshlrev_b32 v65, 2, v65
  v_sub_u32 v64, v64, v65
  v_and_b32 v65, 1, v117
  v_lshl_add_u32 v66, v65, 2, v64
  v_cmp_gt_u32 vcc, 4, v64
  v_mov_b32 v67, 99
  s_nop 0
  v_cndmask_b32 v66, v67, v66, vcc
  v_mov_b32 v68, 0x3f80
  v_mov_b32 v69, 0x3f800000
  v_mov_b32 v4, 0
  v_cmp_eq_u32 vcc, 0, v66
  s_nop 1
  v_cndmask_b32 v4, v4, v68, vcc
  v_cmp_eq_u32 vcc, 1, v66
  s_nop 1
  v_cndmask_b32 v4, v4, v69, vcc
  v_mov_b32 v5, 0
  v_cmp_eq_u32 vcc, 2, v66
  s_nop 1
  v_cndmask_b32 v5, v5, v68, vcc
  v_cmp_eq_u32 vcc, 3, v66
  s_nop 1
  v_cndmask_b32 v5, v5, v69, vcc
  v_mov_b32 v6, 0
  v_cmp_eq_u32 vcc, 4, v66
  s_nop 1
  v_cndmask_b32 v6, v6, v68, vcc
  v_cmp_eq_u32 vcc, 5, v66
  s_nop 1
  v_cndmask_b32 v6, v6, v69, vcc
  v_mov_b32 v7, 0
  v_cmp_eq_u32 vcc, 6, v66
  s_nop 1
  v_cndmask_b32 v7, v7, v68, vcc
  v_cmp_eq_u32 vcc, 7, v66
  s_nop 1
  v_cndmask_b32 v7, v7, v69, vcc
  v_lshrrev_b32 v64, 1, v116
  v_lshrrev_b32 v65, 3, v117
  v_cmp_eq_u32 s[26:27], v64, v65
  v_and_b32 v66, 1, v116
  v_add_u32 v64, 2, v64
  v_lshrrev_b32 v67, 1, v116
  v_lshlrev_b32 v67, 8, v67
  v_lshl_add_u32 v67, v66, 9, v67
  v_lshl_add_u32 v67, v117, 4, v67
  v_add_u32 v112, 58368, v67
  v_and_b32 v68, 7, v117
  v_lshlrev_b32 v67, 8, v64
  v_lshl_add_u32 v67, v68, 5, v67
  v_lshl_add_u32 v67, v66, 4, v67
  v_add_u32 v113, 65536, v67
  v_lshrrev_b32 v64, 5, v1
  v_and_b32 v65, 31, v1
  v_lshrrev_b32 v66, 3, v65
  v_and_b32 v67, 7, v65
  v_and_b32 v68, 3, v67
  v_lshl_add_u32 v68, v66, 2, v68
  v_lshrrev_b32 v69, 2, v67
  v_lshl_add_u32 v68, v69, 4, v68
  v_lshlrev_b32 v69, 11, v64
  v_lshl_add_u32 v69, v68, 4, v69
  v_add_u32 v114, 57352, v69
  v_add_u32 v70, 2, v64
  v_lshlrev_b32 v69, 9, v66
  v_lshl_add_u32 v69, v70, 5, v69
  v_lshl_add_u32 v69, v67, 2, v69
  v_add_u32 v115, 65536, v69
  v_lshlrev_b32 v69, 4, v68
  v_lshl_add_u32 v69, v64, 9, v69
  v_add_u32 v114, 58368, v69
  v_mul_u32_u24 v69, 144, v70
  v_lshl_add_u32 v69, v67, 4, v69
  v_add_u32 v115, 65536, v69
  v_and_b32 v71, 1, v116
  v_mul_u32_u24 v69, 2048, v71
  v_lshl_add_u32 v69, v64, 8, v69
  v_lshl_add_u32 v69, v117, 4, v69
  v_add_u32 v112, 57352, v69
  v_mul_u32_u24 v69, 144, v117
  v_lshl_add_u32 v69, v71, 6, v69
  v_lshl_add_u32 v69, v64, 5, v69
  v_add_u32 v113, 65540, v69
  v_mul_u32_u24 v69, 1024, v116
  v_lshl_add_u32 v69, v117, 4, v69
  v_and_b32 v72, 8, v117
  v_xor_b32 v72, 8, v72
  v_add_u32 v69, v69, v72
  v_add_u32 v112, 57344, v69
  v_lshrrev_b32 v72, 3, v117
  v_lshl_add_u32 v72, v71, 1, v72
  v_xor_b32 v72, 1, v72
  v_lshlrev_b32 v69, 10, v116
  v_lshl_add_u32 v69, v117, 4, v69
  v_lshl_add_u32 v69, v72, 2, v69
  v_add_u32 v112, 57344, v69
  v_lshrrev_b32 v69, 1, v117
  v_and_b32 v72, 1, v117
  v_lshl_add_u32 v69, v72, 3, v69
  v_mul_u32_u24 v69, 144, v69
  v_lshl_add_u32 v69, v71, 6, v69
  v_lshl_add_u32 v69, v64, 5, v69
  v_lshl_add_u32 v72, v72, 1, v71
  v_xor_b32 v72, 1, v72
  v_lshl_add_u32 v69, v72, 2, v69
  v_add_u32 v113, 65536, v69
  v_and_b32 v71, 1, v1
  v_cmp_eq_u32 s[38:39], 0, v71
  v_cmp_gt_u32 vcc, 8, v65
  s_or_b64 s[28:29], s[38:39], vcc
  v_lshrrev_b32 v72, 1, v67
  v_lshlrev_b32 v72, 2, v72
  v_lshl_add_u32 v72, v70, 4, v72
  s_lshl_b32 s22, s17, 9
  s_add_u32 s22, s22, 9216
  v_lshl_add_u32 v73, v66, 7, v72
  v_add_u32 v73, s22, v73
  s_lshl_b32 s22, s17, 7
  s_add_u32 s22, s22, 7168
  v_add_u32 v74, s22, v72
  v_bfe_u32 v72, v65, 1, 1
  v_lshlrev_b32 v72, 7, v72
  v_lshl_add_u32 v72, v70, 4, v72
  v_bfe_u32 v73, v65, 2, 2
  v_lshl_add_u32 v72, v73, 2, v72
  v_lshrrev_b32 v73, 4, v65
  v_lshl_add_u32 v73, v73, 8, v72
  s_lshl_b32 s22, s17, 9
  s_add_u32 s22, s22, 9216
  v_add_u32 v73, s22, v73
  s_lshr_b32 s22, s17, 1
  s_lshl_b32 s22, s22, 8
  s_and_b32 s34, s17, 1
  s_lshl_b32 s34, s34, 3
  s_add_u32 s22, s22, s34
  s_add_u32 s22, s22, 7168
  v_add_u32 v74, s22, v72
  v_bfe_u32 v72, v65, 1, 1
  v_lshl_add_u32 v72, v64, 1, v72
  v_lshlrev_b32 v72, 4, v72
  v_bfe_u32 v73, v65, 2, 2
  v_lshl_add_u32 v72, v73, 2, v72
  v_lshrrev_b32 v73, 4, v65
  v_lshl_add_u32 v73, v73, 6, v72
  s_lshl_b32 s22, s17, 9
  s_add_u32 s22, s22, 9344
  v_add_u32 v73, s22, v73
  v_lshrrev_b32 v72, 1, v65
  v_lshlrev_b32 v72, 2, v72
  v_lshl_add_u32 v72, v64, 5, v72
  s_lshr_b32 s22, s17, 1
  s_lshl_b32 s22, s22, 8
  s_and_b32 s34, s17, 1
  s_lshl_b32 s34, s34, 4
  s_add_u32 s22, s22, s34
  s_add_u32 s22, s22, 7232
  v_add_u32 v74, s22, v72
  v_lshlrev_b32 v0, 2, v65
  v_and_b32 v0, 120, v0
  s_and_b32 s22, s17, 15
  s_lshl_b32 s22, s22, 7
  s_add_u32 s22, s22, 18432
  v_add_u32 v0, s22, v0
  v_cndmask_b32 v1, v74, v73, s[38:39]
  s_lshl_b32 s36, s17, 2
  s_add_u32 s36, s36, 17472
  s_mov_b32 s37, 0x3e800000
  v_mov_b32 v36, 0
  v_mov_b32 v37, 0
  v_mov_b32 v38, 0
  v_mov_b32 v39, 0
  v_mov_b32 v40, 0
  v_mov_b32 v41, 0
  v_mov_b32 v42, 0
  v_mov_b32 v43, 0
  v_mov_b32 v44, 0
  v_mov_b32 v45, 0
  v_mov_b32 v46, 0
  v_mov_b32 v47, 0
  v_mov_b32 v48, 0
  v_mov_b32 v49, 0
  v_mov_b32 v50, 0
  v_mov_b32 v51, 0
  v_mov_b32 v52, 0
  v_mov_b32 v53, 0
  v_mov_b32 v54, 0
  v_mov_b32 v55, 0
  v_mov_b32 v56, 0
  v_mov_b32 v57, 0
  v_mov_b32 v58, 0
  v_mov_b32 v59, 0
  v_mov_b32 v60, 0
  v_mov_b32 v61, 0
  v_mov_b32 v62, 0
  v_mov_b32 v63, 0
  v_mov_b32 v64, 0
  v_mov_b32 v65, 0
  v_mov_b32 v66, 0
  v_mov_b32 v67, 0
  v_mov_b32 v68, 0
  v_mov_b32 v69, 0
  v_mov_b32 v70, 0
  v_mov_b32 v71, 0
  v_mov_b32 v72, 0
  v_mov_b32 v73, 0
  v_mov_b32 v74, 0
  v_mov_b32 v75, 0
  v_mov_b32 v76, 0
  v_mov_b32 v77, 0
  v_mov_b32 v78, 0
  v_mov_b32 v79, 0
  v_mov_b32 v80, 0
  v_mov_b32 v81, 0
  v_mov_b32 v82, 0
  v_mov_b32 v83, 0
  v_mov_b32 v84, 0
  v_mov_b32 v85, 0
  v_mov_b32 v86, 0
  v_mov_b32 v87, 0
  v_mov_b32 v88, 0
  v_mov_b32 v89, 0
  v_mov_b32 v90, 0
  v_mov_b32 v91, 0
  v_mov_b32 v92, 0
  v_mov_b32 v93, 0
  v_mov_b32 v94, 0
  v_mov_b32 v95, 0
  v_mov_b32 v96, 0
  v_mov_b32 v97, 0
  v_mov_b32 v98, 0
  v_mov_b32 v99, 0
  v_mov_b32 v100, 0
  v_mov_b32 v101, 0
  v_mov_b32 v102, 0
  v_mov_b32 v103, 0
  v_mov_b32 v104, 0
  v_mov_b32 v105, 0
  v_mov_b32 v106, 0
  v_mov_b32 v107, 0
  v_mov_b32 v108, 0
  v_mov_b32 v109, 0
  v_mov_b32 v110, 0
  v_mov_b32 v111, 0
  v_and_b32 v118, 1, v116
  v_cmp_eq_u32 vcc, 0, v118
  v_mov_b32 v118, 12288
  v_mov_b32 v119, 8448
  v_cndmask_b32 v118, v118, v119, vcc
  v_lshrrev_b32 v116, 1, v116
  v_lshl_add_u32 v118, v116, 9, v118
  v_lshl_add_u32 v117, v117, 4, v118
  s_mov_b32 s57, 28672
  v_bfe_u32 v118, v2, 4, 1
  v_mul_u32_u24 v118, 0xaaaa, v118
  v_add_u32 v118, 0x4444, v118
  s_mov_b32 s56, 0x42800000
  v_mov_b32 v116, v2
  v_lshrrev_b32 v0, 4, v2
  v_min_u32 v0, 9, v0
  s_mul_i32 s22, s17, 10
  v_add_u32 v0, s22, v0
  v_lshlrev_b32 v0, 7, v0
  v_add_u32 v0, 40960, v0
  s_mov_b32 s22, 88637440
  buffer_load_dword v119, v0, s[8:11], s22 offen sc1
  s_mov_b32 s22, 88616960
  buffer_load_dword v119, v0, s[8:11], s22 offen sc1
  s_mul_i32 s35, s17, 1835008
  s_add_u32 s35, s35, 42269696
  s_mov_b32 s30, 0
  v_mov_b32 v36, 0
ch_md1:
  buffer_load_dword v37, v36, s[12:15], 0 offen sc1
  s_waitcnt vmcnt(0)
  v_readfirstlane_b32 s22, v37
  s_and_b32 s31, s22, 0xffff
  s_cmp_ge_u32 s31, 32
  s_cbranch_scc1 ch_go1
  s_sleep 2
  s_add_u32 s30, s30, 1
  s_cmp_lt_u32 s30, 50000
  s_cbranch_scc1 ch_md1
  s_branch ch_end
ch_go1:
  s_mov_b32 s31, 0
  s_lshr_b32 s22, s22, 16
  s_cmp_lg_u32 s22, 0
  s_cbranch_scc1 cB_sc1_loop
  s_branch cA_sc1_loop
ch_init2:
  s_getpc_b64 s[98:99]
cpf_13:
  s_add_u32 s98, s98, cA_sc2_loop-cpf_13
  s_addc_u32 s99, s99, 0
  v_lshlrev_b32 v38, 2, v2
  global_load_dword v39, v38, s[98:99]
  s_mul_i32 s31, s17, 401408
  s_add_u32 s31, s31, 0
  s_mov_b32 s24, 71579648
  s_mov_b32 s25, 0
  s_add_u32 m0, s25, 14336
  s_nop 0
  buffer_load_dwordx4 v2, s[8:11], s24 offen offset:0 sc1 lds
  buffer_load_dwordx4 v2, s[8:11], s24 offen offset:1024 sc1 lds
  buffer_load_dwordx4 v2, s[8:11], s24 offen offset:2048 sc1 lds
  buffer_load_dwordx4 v2, s[8:11], s24 offen offset:3072 sc1 lds
  s_add_u32 m0, s25, 18432
  s_add_u32 s22, s24, 4096
  buffer_load_dwordx4 v2, s[8:11], s22 offen offset:0 sc1 lds
  buffer_load_dwordx4 v2, s[8:11], s22 offen offset:1024 sc1 lds
  buffer_load_dwordx4 v2, s[8:11], s22 offen offset:2048 sc1 lds
  v_lshrrev_b32 v64, 1, v117
  v_and_b32 v65, 1, v116
  v_lshlrev_b32 v65, 2, v65
  v_sub_u32 v64, v64, v65
  v_and_b32 v65, 1, v117
  v_lshl_add_u32 v66, v65, 2, v64
  v_cmp_gt_u32 vcc, 4, v64
  v_mov_b32 v67, 99
  s_nop 0
  v_cndmask_b32 v66, v67, v66, vcc
  v_mov_b32 v68, 0x3f80
  v_mov_b32 v69, 0x3f800000
  v_mov_b32 v4, 0
  v_cmp_eq_u32 vcc, 0, v66
  s_nop 1
  v_cndmask_b32 v4, v4, v68, vcc
  v_cmp_eq_u32 vcc, 1, v66
  s_nop 1
  v_cndmask_b32 v4, v4, v69, vcc
  v_mov_b32 v5, 0
  v_cmp_eq_u32 vcc, 2, v66
  s_nop 1
  v_cndmask_b32 v5, v5, v68, vcc
  v_cmp_eq_u32 vcc, 3, v66
  s_nop 1
  v_cndmask_b32 v5, v5, v69, vcc
  v_mov_b32 v6, 0
  v_cmp_eq_u32 vcc, 4, v66
  s_nop 1
  v_cndmask_b32 v6, v6, v68, vcc
  v_cmp_eq_u32 vcc, 5, v66
  s_nop 1
  v_cndmask_b32 v6, v6, v69, vcc
  v_mov_b32 v7, 0
  v_cmp_eq_u32 vcc, 6, v66
  s_nop 1
  v_cndmask_b32 v7, v7, v68, vcc
  v_cmp_eq_u32 vcc, 7, v66
  s_nop 1
  v_cndmask_b32 v7, v7, v69, vcc
  v_lshrrev_b32 v64, 1, v116
  v_lshrrev_b32 v65, 3, v117
  v_cmp_eq_u32 s[26:27], v64, v65
  v_and_b32 v66, 1, v116
  v_add_u32 v64, 4, v64
  v_lshrrev_b32 v67, 1, v116
  v_lshlrev_b32 v67, 8, v67
  v_lshl_add_u32 v67, v66, 9, v67
  v_lshl_add_u32 v67, v117, 4, v67
  v_add_u32 v112, 59392, v67
  v_and_b32 v68, 7, v117
  v_lshlrev_b32 v67, 8, v64
  v_lshl_add_u32 v67, v68, 5, v67
  v_lshl_add_u32 v67, v66, 4, v67
  v_add_u32 v113, 65536, v67
  v_lshrrev_b32 v64, 5, v1
  v_and_b32 v65, 31, v1
  v_lshrrev_b32 v66, 3, v65
  v_and_b32 v67, 7, v65
  v_and_b32 v68, 3, v67
  v_lshl_add_u32 v68, v66, 2, v68
  v_lshrrev_b32 v69, 2, v67
  v_lshl_add_u32 v68, v69, 4, v68
  v_lshlrev_b32 v69, 11, v64
  v_lshl_add_u32 v69, v68, 4, v69
  v_add_u32 v114, 57856, v69
  v_add_u32 v70, 4, v64
  v_lshlrev_b32 v69, 9, v66
  v_lshl_add_u32 v69, v70, 5, v69
  v_lshl_add_u32 v69, v67, 2, v69
  v_add_u32 v115, 65536, v69
  v_lshlrev_b32 v69, 4, v68
  v_lshl_add_u32 v69, v64, 9, v69
  v_add_u32 v114, 59392, v69
  v_mul_u32_u24 v69, 144, v70
  v_lshl_add_u32 v69, v67, 4, v69
  v_add_u32 v115, 65536, v69
  v_and_b32 v71, 1, v116
  v_mul_u32_u24 v69, 2048, v71
  v_lshl_add_u32 v69, v64, 8, v69
  v_lshl_add_u32 v69, v117, 4, v69
  v_add_u32 v112, 57856, v69
  v_mul_u32_u24 v69, 144, v117
  v_lshl_add_u32 v69, v71, 6, v69
  v_lshl_add_u32 v69, v64, 5, v69
  v_add_u32 v113, 65544, v69
  v_mul_u32_u24 v69, 1024, v116
  v_lshl_add_u32 v69, v117, 4, v69
  v_and_b32 v72, 8, v117
  v_xor_b32 v72, 0, v72
  v_add_u32 v69, v69, v72
  v_add_u32 v112, 57856, v69
  v_lshrrev_b32 v72, 3, v117
  v_lshl_add_u32 v72, v71, 1, v72
  v_xor_b32 v72, 2, v72
  v_lshlrev_b32 v69, 10, v116
  v_lshl_add_u32 v69, v117, 4, v69
  v_lshl_add_u32 v69, v72, 2, v69
  v_add_u32 v112, 57344, v69
  v_lshrrev_b32 v69, 1, v117
  v_and_b32 v72, 1, v117
  v_lshl_add_u32 v69, v72, 3, v69
  v_mul_u32_u24 v69, 144, v69
  v_lshl_add_u32 v69, v71, 6, v69
  v_lshl_add_u32 v69, v64, 5, v69
  v_lshl_add_u32 v72, v72, 1, v71
  v_xor_b32 v72, 2, v72
  v_lshl_add_u32 v69, v72, 2, v69
  v_add_u32 v113, 65536, v69
  v_and_b32 v71, 1, v1
  v_cmp_eq_u32 s[38:39], 0, v71
  v_cmp_gt_u32 vcc, 8, v65
  s_or_b64 s[28:29], s[38:39], vcc
  v_lshrrev_b32 v72, 1, v67
  v_lshlrev_b32 v72, 2, v72
  v_lshl_add_u32 v72, v70, 4, v72
  s_lshl_b32 s22, s17, 9
  s_add_u32 s22, s22, 9216
  v_lshl_add_u32 v73, v66, 7, v72
  v_add_u32 v73, s22, v73
  s_lshl_b32 s22, s17, 7
  s_add_u32 s22, s22, 7168
  v_add_u32 v74, s22, v72
  v_bfe_u32 v72, v65, 1, 1
  v_lshlrev_b32 v72, 7, v72
  v_lshl_add_u32 v72, v70, 4, v72
  v_bfe_u32 v73, v65, 2, 2
  v_lshl_add_u32 v72, v73, 2, v72
  v_lshrrev_b32 v73, 4, v65
  v_lshl_add_u32 v73, v73, 8, v72
  s_lshl_b32 s22, s17, 9
  s_add_u32 s22, s22, 9216
  v_add_u32 v73, s22, v73
  s_lshr_b32 s22, s17, 1
  s_lshl_b32 s22, s22, 8
  s_and_b32 s34, s17, 1
  s_lshl_b32 s34, s34, 3
  s_add_u32 s22, s22, s34
  s_add_u32 s22, s22, 7168
  v_add_u32 v74, s22, v72
  v_bfe_u32 v72, v65, 1, 1
  v_lshl_add_u32 v72, v64, 1, v72
  v_lshlrev_b32 v72, 4, v72
  v_bfe_u32 v73, v65, 2, 2
  v_lshl_add_u32 v72, v73, 2, v72
  v_lshrrev_b32 v73, 4, v65
  v_lshl_add_u32 v73, v73, 6, v72
  s_lshl_b32 s22, s17, 9
  s_add_u32 s22, s22, 9472
  v_add_u32 v73, s22, v73
  v_lshrrev_b32 v72, 1, v65
  v_lshlrev_b32 v72, 2, v72
  v_lshl_add_u32 v72, v64, 5, v72
  s_lshr_b32 s22, s17, 1
  s_lshl_b32 s22, s22, 8
  s_and_b32 s34, s17, 1
  s_lshl_b32 s34, s34, 4
  s_add_u32 s22, s22, s34
  s_add_u32 s22, s22, 7296
  v_add_u32 v74, s22, v72
  v_lshlrev_b32 v0, 2, v65
  v_and_b32 v0, 120, v0
  s_and_b32 s22, s17, 15
  s_lshl_b32 s22, s22, 7
  s_add_u32 s22, s22, 18432
  v_add_u32 v0, s22, v0
  v_cndmask_b32 v1, v74, v73, s[38:39]
  s_lshl_b32 s36, s17, 2
  s_add_u32 s36, s36, 17472
  s_mov_b32 s37, 0x3e800000
  v_mov_b32 v36, 0
  v_mov_b32 v37, 0
  v_mov_b32 v38, 0
  v_mov_b32 v39, 0
  v_mov_b32 v40, 0
  v_mov_b32 v41, 0
  v_mov_b32 v42, 0
  v_mov_b32 v43, 0
  v_mov_b32 v44, 0
  v_mov_b32 v45, 0
  v_mov_b32 v46, 0
  v_mov_b32 v47, 0
  v_mov_b32 v48, 0
  v_mov_b32 v49, 0
  v_mov_b32 v50, 0
  v_mov_b32 v51, 0
  v_mov_b32 v52, 0
  v_mov_b32 v53, 0
  v_mov_b32 v54, 0
  v_mov_b32 v55, 0
  v_mov_b32 v56, 0
  v_mov_b32 v57, 0
  v_mov_b32 v58, 0
  v_mov_b32 v59, 0
  v_mov_b32 v60, 0
  v_mov_b32 v61, 0
  v_mov_b32 v62, 0
  v_mov_b32 v63, 0
  v_mov_b32 v64, 0
  v_mov_b32 v65, 0
  v_mov_b32 v66, 0
  v_mov_b32 v67, 0
  v_mov_b32 v68, 0
  v_mov_b32 v69, 0
  v_mov_b32 v70, 0
  v_mov_b32 v71, 0
  v_mov_b32 v72, 0
  v_mov_b32 v73, 0
  v_mov_b32 v74, 0
  v_mov_b32 v75, 0
  v_mov_b32 v76, 0
  v_mov_b32 v77, 0
  v_mov_b32 v78, 0
  v_mov_b32 v79, 0
  v_mov_b32 v80, 0
  v_mov_b32 v81, 0
  v_mov_b32 v82, 0
  v_mov_b32 v83, 0
  v_mov_b32 v84, 0
  v_mov_b32 v85, 0
  v_mov_b32 v86, 0
  v_mov_b32 v87, 0
  v_mov_b32 v88, 0
  v_mov_b32 v89, 0
  v_mov_b32 v90, 0
  v_mov_b32 v91, 0
  v_mov_b32 v92, 0
  v_mov_b32 v93, 0
  v_mov_b32 v94, 0
  v_mov_b32 v95, 0
  v_mov_b32 v96, 0
  v_mov_b32 v97, 0
  v_mov_b32 v98, 0
  v_mov_b32 v99, 0
  v_mov_b32 v100, 0
  v_mov_b32 v101, 0
  v_mov_b32 v102, 0
  v_mov_b32 v103, 0
  v_mov_b32 v104, 0
  v_mov_b32 v105, 0
  v_mov_b32 v106, 0
  v_mov_b32 v107, 0
  v_mov_b32 v108, 0
  v_mov_b32 v109, 0
  v_mov_b32 v110, 0
  v_mov_b32 v111, 0
  v_and_b32 v118, 1, v116
  v_cmp_eq_u32 vcc, 0, v118
  v_mov_b32 v118, 12544
  v_mov_b32 v119, 10240
  v_cndmask_b32 v118, v118, v119, vcc
  v_lshrrev_b32 v116, 1, v116
  v_lshl_add_u32 v118, v116, 9, v118
  v_lshl_add_u32 v117, v117, 4, v118
  s_mov_b32 s57, 28672
  v_bfe_u32 v118, v2, 4, 1
  v_mul_u32_u24 v118, 0xaaaa, v118
  v_add_u32 v118, 0x4444, v118
  s_mov_b32 s56, 0x42800000
  v_mov_b32 v116, v2
  v_lshrrev_b32 v0, 4, v2
  v_min_u32 v0, 13, v0
  s_mul_i32 s22, s17, 14
  v_add_u32 v0, s22, v0
  v_lshlrev_b32 v0, 7, v0
  v_add_u32 v0, 43008, v0
  s_mov_b32 s22, 71550976
  buffer_load_dword v119, v0, s[8:11], s22 offen sc1
  s_mov_b32 s22, 71522304
  buffer_load_dword v119, v0, s[8:11], s22 offen sc1
  s_mul_i32 s35, s17, 1835008
  s_add_u32 s35, s35, 42276864
  s_mov_b32 s30, 0
  v_mov_b32 v36, 0
ch_md2:
  buffer_load_dword v37, v36, s[12:15], 0 offen sc1
  s_waitcnt vmcnt(0)
  v_readfirstlane_b32 s22, v37
  s_and_b32 s31, s22, 0xffff
  s_cmp_ge_u32 s31, 32
  s_cbranch_scc1 ch_go2
  s_sleep 2
  s_add_u32 s30, s30, 1
  s_cmp_lt_u32 s30, 50000
  s_cbranch_scc1 ch_md2
  s_branch ch_end
ch_go2:
  s_mov_b32 s31, 0
  s_lshr_b32 s22, s22, 16
  s_cmp_lg_u32 s22, 0
  s_cbranch_scc1 cB_sc2_loop
  s_branch cA_sc2_loop
ch_init3:
  s_getpc_b64 s[98:99]
cpf_14:
  s_add_u32 s98, s98, cA_sc3_loop-cpf_14
  s_addc_u32 s99, s99, 0
  v_lshlrev_b32 v38, 2, v2
  global_load_dword v39, v38, s[98:99]
  s_mul_i32 s31, s17, 401408
  s_add_u32 s31, s31, 0
  s_mov_b32 s24, 71586816
  s_mov_b32 s25, 0
  s_add_u32 m0, s25, 21504
  s_nop 0
  buffer_load_dwordx4 v2, s[8:11], s24 offen offset:0 sc1 lds
  buffer_load_dwordx4 v2, s[8:11], s24 offen offset:1024 sc1 lds
  buffer_load_dwordx4 v2, s[8:11], s24 offen offset:2048 sc1 lds
  buffer_load_dwordx4 v2, s[8:11], s24 offen offset:3072 sc1 lds
  s_add_u32 m0, s25, 25600
  s_add_u32 s22, s24, 4096
  buffer_load_dwordx4 v2, s[8:11], s22 offen offset:0 sc1 lds
  buffer_load_dwordx4 v2, s[8:11], s22 offen offset:1024 sc1 lds
  buffer_load_dwordx4 v2, s[8:11], s22 offen offset:2048 sc1 lds
  v_lshrrev_b32 v64, 1, v117
  v_and_b32 v65, 1, v116
  v_lshlrev_b32 v65, 2, v65
  v_sub_u32 v64, v64, v65
  v_and_b32 v65, 1, v117
  v_lshl_add_u32 v66, v65, 2, v64
  v_cmp_gt_u32 vcc, 4, v64
  v_mov_b32 v67, 99
  s_nop 0
  v_cndmask_b32 v66, v67, v66, vcc
  v_mov_b32 v68, 0x3f80
  v_mov_b32 v69, 0x3f800000
  v_mov_b32 v4, 0
  v_cmp_eq_u32 vcc, 0, v66
  s_nop 1
  v_cndmask_b32 v4, v4, v68, vcc
  v_cmp_eq_u32 vcc, 1, v66
  s_nop 1
  v_cndmask_b32 v4, v4, v69, vcc
  v_mov_b32 v5, 0
  v_cmp_eq_u32 vcc, 2, v66
  s_nop 1
  v_cndmask_b32 v5, v5, v68, vcc
  v_cmp_eq_u32 vcc, 3, v66
  s_nop 1
  v_cndmask_b32 v5, v5, v69, vcc
  v_mov_b32 v6, 0
  v_cmp_eq_u32 vcc, 4, v66
  s_nop 1
  v_cndmask_b32 v6, v6, v68, vcc
  v_cmp_eq_u32 vcc, 5, v66
  s_nop 1
  v_cndmask_b32 v6, v6, v69, vcc
  v_mov_b32 v7, 0
  v_cmp_eq_u32 vcc, 6, v66
  s_nop 1
  v_cndmask_b32 v7, v7, v68, vcc
  v_cmp_eq_u32 vcc, 7, v66
  s_nop 1
  v_cndmask_b32 v7, v7, v69, vcc
  v_lshrrev_b32 v64, 1, v116
  v_lshrrev_b32 v65, 3, v117
  v_cmp_eq_u32 s[26:27], v64, v65
  v_and_b32 v66, 1, v116
  v_add_u32 v64, 6, v64
  v_lshrrev_b32 v67, 1, v116
  v_lshlrev_b32 v67, 8, v67
  v_lshl_add_u32 v67, v66, 9, v67
  v_lshl_add_u32 v67, v117, 4, v67
  v_add_u32 v112, 60416, v67
  v_and_b32 v68, 7, v117
  v_lshlrev_b32 v67, 8, v64
  v_lshl_add_u32 v67, v68, 5, v67
  v_lshl_add_u32 v67, v66, 4, v67
  v_add_u32 v113, 65536, v67
  v_lshrrev_b32 v64, 5, v1
  v_and_b32 v65, 31, v1
  v_lshrrev_b32 v66, 3, v65
  v_and_b32 v67, 7, v65
  v_and_b32 v68, 3, v67
  v_lshl_add_u32 v68, v66, 2, v68
  v_lshrrev_b32 v69, 2, v67
  v_lshl_add_u32 v68, v69, 4, v68
  v_lshlrev_b32 v69, 11, v64
  v_lshl_add_u32 v69, v68, 4, v69
  v_add_u32 v114, 57864, v69
  v_add_u32 v70, 6, v64
  v_lshlrev_b32 v69, 9, v66
  v_lshl_add_u32 v69, v70, 5, v69
  v_lshl_add_u32 v69, v67, 2, v69
  v_add_u32 v115, 65536, v69
  v_lshlrev_b32 v69, 4, v68
  v_lshl_add_u32 v69, v64, 9, v69
  v_add_u32 v114, 60416, v69
  v_mul_u32_u24 v69, 144, v70
  v_lshl_add_u32 v69, v67, 4, v69
  v_add_u32 v115, 65536, v69
  v_and_b32 v71, 1, v116
  v_mul_u32_u24 v69, 2048, v71
  v_lshl_add_u32 v69, v64, 8, v69
  v_lshl_add_u32 v69, v117, 4, v69
  v_add_u32 v112, 57864, v69
  v_mul_u32_u24 v69, 144, v117
  v_lshl_add_u32 v69, v71, 6, v69
  v_lshl_add_u32 v69, v64, 5, v69
  v_add_u32 v113, 65548, v69
  v_mul_u32_u24 v69, 1024, v116
  v_lshl_add_u32 v69, v117, 4, v69
  v_and_b32 v72, 8, v117
  v_xor_b32 v72, 8, v72
  v_add_u32 v69, v69, v72
  v_add_u32 v112, 57856, v69
  v_lshrrev_b32 v72, 3, v117
  v_lshl_add_u32 v72, v71, 1, v72
  v_xor_b32 v72, 3, v72
  v_lshlrev_b32 v69, 10, v116
  v_lshl_add_u32 v69, v117, 4, v69
  v_lshl_add_u32 v69, v72, 2, v69
  v_add_u32 v112, 57344, v69
  v_lshrrev_b32 v69, 1, v117
  v_and_b32 v72, 1, v117
  v_lshl_add_u32 v69, v72, 3, v69
  v_mul_u32_u24 v69, 144, v69
  v_lshl_add_u32 v69, v71, 6, v69
  v_lshl_add_u32 v69, v64, 5, v69
  v_lshl_add_u32 v72, v72, 1, v71
  v_xor_b32 v72, 3, v72
  v_lshl_add_u32 v69, v72, 2, v69
  v_add_u32 v113, 65536, v69
  v_and_b32 v71, 1, v1
  v_cmp_eq_u32 s[38:39], 0, v71
  v_cmp_gt_u32 vcc, 8, v65
  s_or_b64 s[28:29], s[38:39], vcc
  v_lshrrev_b32 v72, 1, v67
  v_lshlrev_b32 v72, 2, v72
  v_lshl_add_u32 v72, v70, 4, v72
  s_lshl_b32 s22, s17, 9
  s_add_u32 s22, s22, 9216
  v_lshl_add_u32 v73, v66, 7, v72
  v_add_u32 v73, s22, v73
  s_lshl_b32 s22, s17, 7
  s_add_u32 s22, s22, 7168
  v_add_u32 v74, s22, v72
  v_bfe_u32 v72, v65, 1, 1
  v_lshlrev_b32 v72, 7, v72
  v_lshl_add_u32 v72, v70, 4, v72
  v_bfe_u32 v73, v65, 2, 2
  v_lshl_add_u32 v72, v73, 2, v72
  v_lshrrev_b32 v73, 4, v65
  v_lshl_add_u32 v73, v73, 8, v72
  s_lshl_b32 s22, s17, 9
  s_add_u32 s22, s22, 9216
  v_add_u32 v73, s22, v73
  s_lshr_b32 s22, s17, 1
  s_lshl_b32 s22, s22, 8
  s_and_b32 s34, s17, 1
  s_lshl_b32 s34, s34, 3
  s_add_u32 s22, s22, s34
  s_add_u32 s22, s22, 7168
  v_add_u32 v74, s22, v72
  v_bfe_u32 v72, v65, 1, 1
  v_lshl_add_u32 v72, v64, 1, v72
  v_lshlrev_b32 v72, 4, v72
  v_bfe_u32 v73, v65, 2, 2
  v_lshl_add_u32 v72, v73, 2, v72
  v_lshrrev_b32 v73, 4, v65
  v_lshl_add_u32 v73, v73, 6, v72
  s_lshl_b32 s22, s17, 9
  s_add_u32 s22, s22, 9600
  v_add_u32 v73, s22, v73
  v_lshrrev_b32 v72, 1, v65
  v_lshlrev_b32 v72, 2, v72
  v_lshl_add_u32 v72, v64, 5, v72
  s_lshr_b32 s22, s17, 1
  s_lshl_b32 s22, s22, 8
  s_and_b32 s34, s17, 1
  s_lshl_b32 s34, s34, 4
  s_add_u32 s22, s22, s34
  s_add_u32 s22, s22, 7360
  v_add_u32 v74, s22, v72
  v_lshlrev_b32 v0, 2, v65
  v_and_b32 v0, 120, v0
  s_and_b32 s22, s17, 15
  s_lshl_b32 s22, s22, 7
  s_add_u32 s22, s22, 18432
  v_add_u32 v0, s22, v0
  v_cndmask_b32 v1, v74, v73, s[38:39]
  s_lshl_b32 s36, s17, 2
  s_add_u32 s36, s36, 17472
  s_mov_b32 s37, 0x3e800000
  v_mov_b32 v36, 0
  v_mov_b32 v37, 0
  v_mov_b32 v38, 0
  v_mov_b32 v39, 0
  v_mov_b32 v40, 0
  v_mov_b32 v41, 0
  v_mov_b32 v42, 0
  v_mov_b32 v43, 0
  v_mov_b32 v44, 0
  v_mov_b32 v45, 0
  v_mov_b32 v46, 0
  v_mov_b32 v47, 0
  v_mov_b32 v48, 0
  v_mov_b32 v49, 0
  v_mov_b32 v50, 0
  v_mov_b32 v51, 0
  v_mov_b32 v52, 0
  v_mov_b32 v53, 0
  v_mov_b32 v54, 0
  v_mov_b32 v55, 0
  v_mov_b32 v56, 0
  v_mov_b32 v57, 0
  v_mov_b32 v58, 0
  v_mov_b32 v59, 0
  v_mov_b32 v60, 0
  v_mov_b32 v61, 0
  v_mov_b32 v62, 0
  v_mov_b32 v63, 0
  v_mov_b32 v64, 0
  v_mov_b32 v65, 0
  v_mov_b32 v66, 0
  v_mov_b32 v67, 0
  v_mov_b32 v68, 0
  v_mov_b32 v69, 0
  v_mov_b32 v70, 0
  v_mov_b32 v71, 0
  v_mov_b32 v72, 0
  v_mov_b32 v73, 0
  v_mov_b32 v74, 0
  v_mov_b32 v75, 0
  v_mov_b32 v76, 0
  v_mov_b32 v77, 0
  v_mov_b32 v78, 0
  v_mov_b32 v79, 0
  v_mov_b32 v80, 0
  v_mov_b32 v81, 0
  v_mov_b32 v82, 0
  v_mov_b32 v83, 0
  v_mov_b32 v84, 0
  v_mov_b32 v85, 0
  v_mov_b32 v86, 0
  v_mov_b32 v87, 0
  v_mov_b32 v88, 0
  v_mov_b32 v89, 0
  v_mov_b32 v90, 0
  v_mov_b32 v91, 0
  v_mov_b32 v92, 0
  v_mov_b32 v93, 0
  v_mov_b32 v94, 0
  v_mov_b32 v95, 0
  v_mov_b32 v96, 0
  v_mov_b32 v97, 0
  v_mov_b32 v98, 0
  v_mov_b32 v99, 0
  v_mov_b32 v100, 0
  v_mov_b32 v101, 0
  v_mov_b32 v102, 0
  v_mov_b32 v103, 0
  v_mov_b32 v104, 0
  v_mov_b32 v105, 0
  v_mov_b32 v106, 0
  v_mov_b32 v107, 0
  v_mov_b32 v108, 0
  v_mov_b32 v109, 0
  v_mov_b32 v110, 0
  v_mov_b32 v111, 0
  v_and_b32 v118, 1, v116
  v_cmp_eq_u32 vcc, 0, v118
  v_mov_b32 v118, 12544
  v_mov_b32 v119, 10496
  v_cndmask_b32 v118, v118, v119, vcc
  v_lshrrev_b32 v116, 1, v116
  v_lshl_add_u32 v118, v116, 9, v118
  v_lshl_add_u32 v117, v117, 4, v118
  s_mov_b32 s57, 28672
  v_bfe_u32 v118, v2, 4, 1
  v_mul_u32_u24 v118, 0xaaaa, v118
  v_add_u32 v118, 0x4444, v118
  s_mov_b32 s56, 0x42800000
  v_mov_b32 v116, v2
  s_mul_i32 s35, s17, 1835008
  s_add_u32 s35, s35, 42284032
  s_mov_b32 s30, 0
  v_mov_b32 v36, 0
ch_md3:
  buffer_load_dword v37, v36, s[12:15], 0 offen sc1
  s_waitcnt vmcnt(0)
  v_readfirstlane_b32 s22, v37
  s_and_b32 s31, s22, 0xffff
  s_cmp_ge_u32 s31, 32
  s_cbranch_scc1 ch_go3
  s_sleep 2
  s_add_u32 s30, s30, 1
  s_cmp_lt_u32 s30, 50000
  s_cbranch_scc1 ch_md3
  s_branch ch_end
ch_go3:
  s_mov_b32 s31, 0
  s_lshr_b32 s22, s22, 16
  s_cmp_lg_u32 s22, 0
  s_cbranch_scc1 cB_sc3_loop
  s_branch cA_sc3_loop
ch_init4:
  s_mul_i32 s31, s17, 401408
  s_add_u32 s31, s31, 6422528
  s_lshl_b32 s22, s17, 4
  v_mov_b32 v38, s22
  v_mov_b32 v36, v38
  v_med3_u32 v37, v117, 0, 5
  v_lshrrev_b32 v36, 6, v36
  v_lshlrev_b32 v36, 8, v36
  v_lshl_add_u32 v36, v37, 4, v36
  s_mov_b32 s22, 88604672
  s_mov_b32 s30, 0
va_bw_16:
  buffer_load_dwordx4 v[40:43], v36, s[8:11], s22 offen sc1
  s_waitcnt vmcnt(0)
  v_cmp_ne_u64 vcc, s[88:89], v[40:41]
  s_cbranch_vccnz va_bw_16_no
  v_cmp_ne_u64 vcc, s[88:89], v[42:43]
  s_cbranch_vccnz va_bw_16_no
  s_branch va_bw_16_ok
va_bw_16_no:
  s_sleep 2
  s_add_u32 s30, s30, 1
  s_cmp_lt_u32 s30, 50000
  s_cbranch_scc1 va_bw_16
  s_branch cA_abort
va_bw_16_ok:
  s_add_u32 s22, s31, 0
  buffer_load_dwordx4 a[0:3], v2, s[8:11], s22 offen offset:0 sc1
  buffer_load_dwordx4 a[4:7], v2, s[8:11], s22 offen offset:1024 sc1
  buffer_load_dwordx4 a[8:11], v2, s[8:11], s22 offen offset:2048 sc1
  buffer_load_dwordx4 a[12:15], v2, s[8:11], s22 offen offset:3072 sc1
  s_add_u32 s22, s31, 4096
  buffer_load_dwordx4 a[16:19], v2, s[8:11], s22 offen offset:0 sc1
  buffer_load_dwordx4 a[20:23], v2, s[8:11], s22 offen offset:1024 sc1
  buffer_load_dwordx4 a[24:27], v2, s[8:11], s22 offen offset:2048 sc1
  buffer_load_dwordx4 a[28:31], v2, s[8:11], s22 offen offset:3072 sc1
  s_add_u32 s22, s31, 8192
  buffer_load_dwordx4 a[32:35], v2, s[8:11], s22 offen offset:0 sc1
  buffer_load_dwordx4 a[36:39], v2, s[8:11], s22 offen offset:1024 sc1
  buffer_load_dwordx4 a[40:43], v2, s[8:11], s22 offen offset:2048 sc1
  buffer_load_dwordx4 a[44:47], v2, s[8:11], s22 offen offset:3072 sc1
  s_add_u32 s22, s31, 12288
  buffer_load_dwordx4 a[48:51], v2, s[8:11], s22 offen offset:0 sc1
  buffer_load_dwordx4 a[52:55], v2, s[8:11], s22 offen offset:1024 sc1
  buffer_load_dwordx4 a[56:59], v2, s[8:11], s22 offen offset:2048 sc1
  buffer_load_dwordx4 a[60:63], v2, s[8:11], s22 offen offset:3072 sc1
  s_add_u32 s22, s31, 16384
  buffer_load_dwordx4 a[64:67], v2, s[8:11], s22 offen offset:0 sc1
  buffer_load_dwordx4 a[68:71], v2, s[8:11], s22 offen offset:1024 sc1
  buffer_load_dwordx4 a[72:75], v2, s[8:11], s22 offen offset:2048 sc1
  buffer_load_dwordx4 a[76:79], v2, s[8:11], s22 offen offset:3072 sc1
  s_add_u32 s22, s31, 20480
  buffer_load_dwordx4 a[80:83], v2, s[8:11], s22 offen offset:0 sc1
  buffer_load_dwordx4 a[84:87], v2, s[8:11], s22 offen offset:1024 sc1
  buffer_load_dwordx4 a[88:91], v2, s[8:11], s22 offen offset:2048 sc1
  buffer_load_dwordx4 a[92:95], v2, s[8:11], s22 offen offset:3072 sc1
  s_add_u32 s22, s31, 24576
  buffer_load_dwordx4 a[96:99], v2, s[8:11], s22 offen offset:0 sc1
  buffer_load_dwordx4 a[100:103], v2, s[8:11], s22 offen offset:1024 sc1
  buffer_load_dwordx4 a[104:107], v2, s[8:11], s22 offen offset:2048 sc1
  buffer_load_dwordx4 a[108:111], v2, s[8:11], s22 offen offset:3072 sc1
  s_add_u32 s22, s31, 28672
  buffer_load_dwordx4 a[112:115], v2, s[8:11], s22 offen offset:0 sc1
  buffer_load_dwordx4 a[116:119], v2, s[8:11], s22 offen offset:1024 sc1
  buffer_load_dwordx4 a[120:123], v2, s[8:11], s22 offen offset:2048 sc1
  buffer_load_dwordx4 a[124:127], v2, s[8:11], s22 offen offset:3072 sc1
  s_waitcnt vmcnt(24)
  s_add_u32 s22, s31, 32768
  buffer_load_dwordx4 a[128:131], v2, s[8:11], s22 offen offset:0 sc1
  buffer_load_dwordx4 a[132:135], v2, s[8:11], s22 offen offset:1024 sc1
  buffer_load_dwordx4 a[136:139], v2, s[8:11], s22 offen offset:2048 sc1
  buffer_load_dwordx4 a[140:143], v2, s[8:11], s22 offen offset:3072 sc1
  s_add_u32 s22, s31, 36864
  buffer_load_dwordx4 a[144:147], v2, s[8:11], s22 offen offset:0 sc1
  buffer_load_dwordx4 a[148:151], v2, s[8:11], s22 offen offset:1024 sc1
  buffer_load_dwordx4 a[152:155], v2, s[8:11], s22 offen offset:2048 sc1
  buffer_load_dwordx4 a[156:159], v2, s[8:11], s22 offen offset:3072 sc1
  s_add_u32 s22, s31, 40960
  buffer_load_dwordx4 a[160:163], v2, s[8:11], s22 offen offset:0 sc1
  buffer_load_dwordx4 a[164:167], v2, s[8:11], s22 offen offset:1024 sc1
  buffer_load_dwordx4 a[168:171], v2, s[8:11], s22 offen offset:2048 sc1
  buffer_load_dwordx4 a[172:175], v2, s[8:11], s22 offen offset:3072 sc1
  s_add_u32 s22, s31, 45056
  buffer_load_dwordx4 a[176:179], v2, s[8:11], s22 offen offset:0 sc1
  buffer_load_dwordx4 a[180:183], v2, s[8:11], s22 offen offset:1024 sc1
  buffer_load_dwordx4 a[184:187], v2, s[8:11], s22 offen offset:2048 sc1
  buffer_load_dwordx4 a[188:191], v2, s[8:11], s22 offen offset:3072 sc1
  s_add_u32 s22, s31, 49152
  buffer_load_dwordx4 a[192:195], v2, s[8:11], s22 offen offset:0 sc1
  buffer_load_dwordx4 a[196:199], v2, s[8:11], s22 offen offset:1024 sc1
  buffer_load_dwordx4 a[200:203], v2, s[8:11], s22 offen offset:2048 sc1
  buffer_load_dwordx4 a[204:207], v2, s[8:11], s22 offen offset:3072 sc1
  s_add_u32 s22, s31, 53248
  buffer_load_dwordx4 a[208:211], v2, s[8:11], s22 offen offset:0 sc1
  buffer_load_dwordx4 a[212:215], v2, s[8:11], s22 offen offset:1024 sc1
  buffer_load_dwordx4 a[216:219], v2, s[8:11], s22 offen offset:2048 sc1
  buffer_load_dwordx4 a[220:223], v2, s[8:11], s22 offen offset:3072 sc1
  s_add_u32 s22, s31, 57344
  buffer_load_dwordx4 a[224:227], v2, s[8:11], s22 offen offset:0 sc1
  buffer_load_dwordx4 a[228:231], v2, s[8:11], s22 offen offset:1024 sc1
  buffer_load_dwordx4 a[232:235], v2, s[8:11], s22 offen offset:2048 sc1
  buffer_load_dwordx4 a[236:239], v2, s[8:11], s22 offen offset:3072 sc1
  s_add_u32 s22, s31, 61440
  buffer_load_dwordx4 a[240:243], v2, s[8:11], s22 offen offset:0 sc1
  buffer_load_dwordx4 a[244:247], v2, s[8:11], s22 offen offset:1024 sc1
  buffer_load_dwordx4 a[248:251], v2, s[8:11], s22 offen offset:2048 sc1
  buffer_load_dwordx4 a[252:255], v2, s[8:11], s22 offen offset:3072 sc1
  s_waitcnt vmcnt(24)
  s_add_u32 s22, s31, 65536
  buffer_load_dwordx4 v[176:179], v2, s[8:11], s22 offen offset:0 sc1
  buffer_load_dwordx4 v[180:183], v2, s[8:11], s22 offen offset:1024 sc1
  buffer_load_dwordx4 v[184:187], v2, s[8:11], s22 offen offset:2048 sc1
  buffer_load_dwordx4 v[188:191], v2, s[8:11], s22 offen offset:3072 sc1
  s_add_u32 s22, s31, 69632
  buffer_load_dwordx4 v[192:195], v2, s[8:11], s22 offen offset:0 sc1
  buffer_load_dwordx4 v[196:199], v2, s[8:11], s22 offen offset:1024 sc1
  buffer_load_dwordx4 v[200:203], v2, s[8:11], s22 offen offset:2048 sc1
  buffer_load_dwordx4 v[204:207], v2, s[8:11], s22 offen offset:3072 sc1
  s_add_u32 s22, s31, 73728
  buffer_load_dwordx4 v[208:211], v2, s[8:11], s22 offen offset:0 sc1
  buffer_load_dwordx4 v[212:215], v2, s[8:11], s22 offen offset:1024 sc1
  buffer_load_dwordx4 v[216:219], v2, s[8:11], s22 offen offset:2048 sc1
  buffer_load_dwordx4 v[220:223], v2, s[8:11], s22 offen offset:3072 sc1
  s_add_u32 s22, s31, 77824
  buffer_load_dwordx4 v[224:227], v2, s[8:11], s22 offen offset:0 sc1
  buffer_load_dwordx4 v[228:231], v2, s[8:11], s22 offen offset:1024 sc1
  buffer_load_dwordx4 v[232:235], v2, s[8:11], s22 offen offset:2048 sc1
  buffer_load_dwordx4 v[236:239], v2, s[8:11], s22 offen offset:3072 sc1
  s_add_u32 s22, s31, 81920
  buffer_load_dwordx4 v[240:243], v2, s[8:11], s22 offen offset:0 sc1
  buffer_load_dwordx4 v[244:247], v2, s[8:11], s22 offen offset:1024 sc1
  buffer_load_dwordx4 v[248:251], v2, s[8:11], s22 offen offset:2048 sc1
  buffer_load_dwordx4 v[252:255], v2, s[8:11], s22 offen offset:3072 sc1
  s_lshl_b32 s22, s17, 4
  v_mov_b32 v38, s22
  s_mul_i32 s22, s17, 12
  s_add_u32 s23, s22, 267
  s_add_u32 s22, s22, 256
  v_mov_b32 v36, s23
  v_mov_b32 v37, s22
  v_cmp_eq_u32 vcc, 1, v116
  s_nop 1
  v_cndmask_b32 v36, v36, v37, vcc
  v_med3_u32 v37, v117, 4, 5
  v_lshrrev_b32 v36, 6, v36
  v_lshlrev_b32 v36, 8, v36
  v_lshl_add_u32 v36, v37, 4, v36
  s_mov_b32 s22, 88604672
  s_mov_b32 s30, 0
va_bw_17:
  buffer_load_dwordx4 v[40:43], v36, s[8:11], s22 offen sc1
  s_waitcnt vmcnt(0)
  v_cmp_ne_u64 vcc, s[88:89], v[40:41]
  s_cbranch_vccnz va_bw_17_no
  v_cmp_ne_u64 vcc, s[88:89], v[42:43]
  s_cbranch_vccnz va_bw_17_no
  s_branch va_bw_17_ok
va_bw_17_no:
  s_sleep 2
  s_add_u32 s30, s30, 1
  s_cmp_lt_u32 s30, 50000
  s_cbranch_scc1 va_bw_17
  s_branch cA_abort
va_bw_17_ok:
  s_mov_b32 m0, 16384
  s_add_u32 s22, s31, 272384
  buffer_load_dwordx4 v2, s[8:11], s22 offen offset:0 sc1 lds
  buffer_load_dwordx4 v2, s[8:11], s22 offen offset:1024 sc1 lds
  buffer_load_dwordx4 v2, s[8:11], s22 offen offset:2048 sc1 lds
  buffer_load_dwordx4 v2, s[8:11], s22 offen offset:3072 sc1 lds
  s_mov_b32 m0, 20480
  s_add_u32 s22, s31, 276480
  buffer_load_dwordx4 v2, s[8:11], s22 offen offset:0 sc1 lds
  buffer_load_dwordx4 v2, s[8:11], s22 offen offset:1024 sc1 lds
  buffer_load_dwordx4 v2, s[8:11], s22 offen offset:2048 sc1 lds
  buffer_load_dwordx4 v2, s[8:11], s22 offen offset:3072 sc1 lds
  s_mov_b32 m0, 24576
  s_add_u32 s22, s31, 280576
  buffer_load_dwordx4 v2, s[8:11], s22 offen offset:0 sc1 lds
  buffer_load_dwordx4 v2, s[8:11], s22 offen offset:1024 sc1 lds
  buffer_load_dwordx4 v2, s[8:11], s22 offen offset:2048 sc1 lds
  buffer_load_dwordx4 v2, s[8:11], s22 offen offset:3072 sc1 lds
  s_mov_b32 m0, 28672
  s_add_u32 s22, s31, 284672
  buffer_load_dwordx4 v2, s[8:11], s22 offen offset:0 sc1 lds
  buffer_load_dwordx4 v2, s[8:11], s22 offen offset:1024 sc1 lds
  v_mov_b32 v72, v116
  v_mov_b32 v73, v117
  v_lshrrev_b32 v65, 1, v72
  v_and_b32 v66, 1, v72
  v_mov_b32 v68, 0
  v_mov_b32 v69, v73
  v_mov_b32 v70, 0
  v_and_b32 v71, 1, v69
  v_lshrrev_b32 v69, 1, v69
  v_lshl_add_u32 v69, v71, 3, v69
  v_lshlrev_b32 v71, 12, v70
  v_lshrrev_b32 v70, 1, v68
  v_lshl_add_u32 v71, v70, 9, v71
  v_and_b32 v70, 1, v68
  v_lshl_add_u32 v71, v70, 2, v71
  v_lshl_add_u32 v71, v69, 4, v71
  v_lshl_add_u32 v71, v65, 8, v71
  v_lshl_add_u32 v60, v66, 3, v71
  v_mov_b32 v68, 1
  v_mov_b32 v69, v73
  v_mov_b32 v70, 0
  v_and_b32 v71, 1, v69
  v_lshrrev_b32 v69, 1, v69
  v_lshl_add_u32 v69, v71, 3, v69
  v_lshlrev_b32 v71, 12, v70
  v_lshrrev_b32 v70, 1, v68
  v_lshl_add_u32 v71, v70, 9, v71
  v_and_b32 v70, 1, v68
  v_lshl_add_u32 v71, v70, 2, v71
  v_lshl_add_u32 v71, v69, 4, v71
  v_lshl_add_u32 v71, v65, 8, v71
  v_lshl_add_u32 v61, v66, 3, v71
  v_mov_b32 v68, 2
  v_mov_b32 v69, v73
  v_mov_b32 v70, 0
  v_and_b32 v71, 1, v69
  v_lshrrev_b32 v69, 1, v69
  v_lshl_add_u32 v69, v71, 3, v69
  v_lshlrev_b32 v71, 12, v70
  v_lshrrev_b32 v70, 1, v68
  v_lshl_add_u32 v71, v70, 9, v71
  v_and_b32 v70, 1, v68
  v_lshl_add_u32 v71, v70, 2, v71
  v_lshl_add_u32 v71, v69, 4, v71
  v_lshl_add_u32 v71, v65, 8, v71
  v_lshl_add_u32 v62, v66, 3, v71
  v_mov_b32 v68, 3
  v_mov_b32 v69, v73
  v_mov_b32 v70, 0
  v_and_b32 v71, 1, v69
  v_lshrrev_b32 v69, 1, v69
  v_lshl_add_u32 v69, v71, 3, v69
  v_lshlrev_b32 v71, 12, v70
  v_lshrrev_b32 v70, 1, v68
  v_lshl_add_u32 v71, v70, 9, v71
  v_and_b32 v70, 1, v68
  v_lshl_add_u32 v71, v70, 2, v71
  v_lshl_add_u32 v71, v69, 4, v71
  v_lshl_add_u32 v71, v65, 8, v71
  v_lshl_add_u32 v170, v66, 3, v71
  v_mov_b32 v68, 4
  v_mov_b32 v69, v73
  v_mov_b32 v70, 0
  v_and_b32 v71, 1, v69
  v_lshrrev_b32 v69, 1, v69
  v_lshl_add_u32 v69, v71, 3, v69
  v_lshlrev_b32 v71, 12, v70
  v_lshrrev_b32 v70, 1, v68
  v_lshl_add_u32 v71, v70, 9, v71
  v_and_b32 v70, 1, v68
  v_lshl_add_u32 v71, v70, 2, v71
  v_lshl_add_u32 v71, v69, 4, v71
  v_lshl_add_u32 v71, v65, 8, v71
  v_lshl_add_u32 v171, v66, 3, v71
  v_mov_b32 v68, 5
  v_mov_b32 v69, v73
  v_mov_b32 v70, 0
  v_and_b32 v71, 1, v69
  v_lshrrev_b32 v69, 1, v69
  v_lshl_add_u32 v69, v71, 3, v69
  v_lshlrev_b32 v71, 12, v70
  v_lshrrev_b32 v70, 1, v68
  v_lshl_add_u32 v71, v70, 9, v71
  v_and_b32 v70, 1, v68
  v_lshl_add_u32 v71, v70, 2, v71
  v_lshl_add_u32 v71, v69, 4, v71
  v_lshl_add_u32 v71, v65, 8, v71
  v_lshl_add_u32 v172, v66, 3, v71
  v_and_b32 v0, 31, v1
  v_lshlrev_b32 v0, 2, v0
  v_add_u32 v0, 18432, v0
  v_min_u32 v4, 15, v73
  v_lshlrev_b32 v4, 2, v4
  s_and_b32 s22, s17, 3
  s_lshl_b32 s22, s22, 7
  s_add_u32 s22, s22, 17408
  v_add_u32 v4, s22, v4
  v_and_b32 v64, 7, v73
  v_lshlrev_b32 v5, 4, v64
  v_lshl_add_u32 v5, v72, 7, v5
  v_lshrrev_b32 v65, 3, v73
  v_lshl_add_u32 v5, v65, 9, v5
  s_lshl_b32 s22, s17, 3
  s_add_u32 s22, s22, 18432
  v_lshl_add_u32 v7, v2, 3, s22
  v_add_u32 v65, 0, v73
  v_min_u32 v65, 27, v65
  v_mad_u32_u24 v65, v72, 28, v65
  v_lshlrev_b32 v6, 4, v65
  s_lshr_b32 s22, s17, 1
  s_mul_i32 s22, s22, 7
  s_and_b32 s34, s17, 1
  s_lshl_b32 s35, s34, 2
  v_add_u32 v70, s35, v72
  v_mov_b32 v71, s34
  v_mov_b32 v69, 0
  v_cmp_eq_u32 vcc, 3, v72
  s_nop 1
  v_cndmask_b32 v70, v70, v72, vcc
  v_cndmask_b32 v69, v69, v71, vcc
  v_add_u32 v70, s22, v70
  v_lshrrev_b32 v68, 1, v70
  v_lshlrev_b32 v68, 8, v68
  v_lshl_add_u32 v68, v69, 7, v68
  v_and_b32 v69, 1, v70
  v_lshl_add_u32 v68, v69, 3, v68
  v_lshl_add_u32 v1, v64, 4, v68
  v_cmp_gt_u32 s[26:27], 8, v73
  v_lshrrev_b32 v65, 3, v73
  v_min_u32 v66, 7, v64
  v_lshl_add_u32 v66, v66, 1, v65
  v_mad_u32_u24 v66, v72, 16, v66
  v_lshlrev_b32 v66, 4, v66
  v_add_u32 v6, 0, v66
  s_mul_i32 s22, s17, 16
  s_add_u32 s22, s22, 0
  v_lshl_add_u32 v70, v64, 1, s22
  v_lshrrev_b32 v68, 4, v70
  v_lshlrev_b32 v68, 8, v68
  v_bfe_u32 v69, v70, 1, 1
  v_lshl_add_u32 v68, v69, 7, v68
  v_bfe_u32 v69, v70, 2, 2
  v_lshl_add_u32 v68, v69, 2, v68
  v_and_b32 v69, 1, v72
  v_lshl_add_u32 v65, v69, 2, v65
  v_lshrrev_b32 v69, 1, v72
  v_lshl_add_u32 v65, v69, 1, v65
  v_lshrrev_b32 v65, 3, v73
  v_lshl_add_u32 v65, v72, 1, v65
  v_lshrrev_b32 v5, 1, v72
  v_lshlrev_b32 v5, 9, v5
  v_lshrrev_b32 v69, 2, v73
  v_lshl_add_u32 v5, v69, 7, v5
  v_and_b32 v69, 1, v72
  v_lshl_add_u32 v5, v69, 6, v5
  v_and_b32 v69, 3, v73
  v_lshl_add_u32 v5, v69, 4, v5
  v_and_b32 v69, 1, v73
  v_mul_u32_u24 v69, 0xaaaa, v69
  v_add_u32 v0, 0x4444, v69
  v_lshl_add_u32 v1, v65, 4, v68
  v_cmp_gt_u32 s[26:27], 6, v64
  v_mov_b32 v156, 0
  v_mov_b32 v157, 0
  v_mov_b32 v158, 0
  v_mov_b32 v159, 0
  ds_write_b128 v2, v[156:159] offset:0
  ds_write_b128 v2, v[156:159] offset:1024
  ds_write_b128 v2, v[156:159] offset:2048
  ds_write_b128 v2, v[156:159] offset:3072
  s_mul_i32 s22, s17, 1835008
  s_add_u32 s25, s22, 42205184
  s_lshl_b32 s35, s17, 7
  s_add_u32 s35, s35, 88539136
  s_add_u32 s39, s35, 16384
  s_mov_b32 s38, 0
  v_mov_b32 v63, 0
  v_bfe_u32 v8, v2, 4, 1
  v_mul_u32_u24 v3, 0xaaaa, v8
  v_add_u32 v3, 0x4444, v3
  v_bfe_u32 v9, v2, 5, 3
  v_lshl_add_u32 v8, v8, 3, v9
  v_and_b32 v9, 0x300, v2
  v_lshl_add_u32 v0, v8, 4, v9
  s_getpc_b64 s[98:99]
cpf_15:
  s_add_u32 s98, s98, cA_va0_loop-cpf_15
  s_addc_u32 s99, s99, 0
  v_lshlrev_b32 v38, 2, v2
  global_load_dword v39, v38, s[98:99]
  s_lshl_b32 s22, 0, 11
  s_add_u32 s22, s22, 88606720
  v_add_u32 v36, 1024, v2
  v_min_u32 v36, 1776, v36
  s_mov_b32 s30, 0
va_iw4:
  buffer_load_dwordx4 v[40:43], v2, s[8:11], s22 offen sc1
  buffer_load_dwordx4 v[44:47], v36, s[8:11], s22 offen sc1
  s_waitcnt vmcnt(0)
  v_cmp_ne_u64 vcc, s[88:89], v[40:41]
  s_cbranch_vccnz va_iw4_no
  v_cmp_ne_u64 vcc, s[88:89], v[42:43]
  s_cbranch_vccnz va_iw4_no
  v_cmp_ne_u64 vcc, s[88:89], v[44:45]
  s_cbranch_vccnz va_iw4_no
  v_cmp_ne_u64 vcc, s[88:89], v[46:47]
  s_cbranch_vccnz va_iw4_no
  s_branch va_iw4_ok
va_iw4_no:
  s_sleep 2
  s_add_u32 s30, s30, 1
  s_cmp_lt_u32 s30, 50000
  s_cbranch_scc1 va_iw4
  s_branch cA_abort
va_iw4_ok:
  s_mov_b32 s30, 0
  v_mov_b32 v36, 0
ch_md4:
  buffer_load_dword v37, v36, s[12:15], 0 offen sc1
  s_waitcnt vmcnt(0)
  v_readfirstlane_b32 s22, v37
  s_and_b32 s31, s22, 0xffff
  s_cmp_ge_u32 s31, 32
  s_cbranch_scc1 ch_go4
  s_sleep 2
  s_add_u32 s30, s30, 1
  s_cmp_lt_u32 s30, 50000
  s_cbranch_scc1 ch_md4
  s_branch ch_end
ch_go4:
  s_mov_b32 s31, 0
  v_mov_b32 v36, 0
  v_mov_b32 v37, 0
  v_mov_b32 v38, 0
  v_mov_b32 v39, 0
  v_mov_b32 v40, 0
  v_mov_b32 v41, 0
  v_mov_b32 v42, 0
  v_mov_b32 v43, 0
  v_mov_b32 v44, 0
  v_mov_b32 v45, 0
  v_mov_b32 v46, 0
  v_mov_b32 v47, 0
  v_mov_b32 v48, 0
  v_mov_b32 v49, 0
  v_mov_b32 v50, 0
  v_mov_b32 v51, 0
  v_mov_b32 v52, 0
  v_mov_b32 v53, 0
  v_mov_b32 v54, 0
  v_mov_b32 v55, 0
  v_mov_b32 v56, 0
  v_mov_b32 v57, 0
  v_mov_b32 v58, 0
  v_mov_b32 v59, 0
  s_lshr_b32 s22, s22, 16
  s_cmp_lg_u32 s22, 0
  s_cbranch_scc1 cB_va0_loop
  s_branch cA_va0_loop
ch_init5:
  s_mul_i32 s31, s17, 401408
  s_add_u32 s31, s31, 6422528
  s_lshl_b32 s22, s17, 4
  v_mov_b32 v38, s22
  v_mov_b32 v36, v38
  v_med3_u32 v37, v117, 6, 11
  v_lshrrev_b32 v36, 6, v36
  v_lshlrev_b32 v36, 8, v36
  v_lshl_add_u32 v36, v37, 4, v36
  s_mov_b32 s22, 88604672
  s_mov_b32 s30, 0
va_bw_19:
  buffer_load_dwordx4 v[40:43], v36, s[8:11], s22 offen sc1
  s_waitcnt vmcnt(0)
  v_cmp_ne_u64 vcc, s[88:89], v[40:41]
  s_cbranch_vccnz va_bw_19_no
  v_cmp_ne_u64 vcc, s[88:89], v[42:43]
  s_cbranch_vccnz va_bw_19_no
  s_branch va_bw_19_ok
va_bw_19_no:
  s_sleep 2
  s_add_u32 s30, s30, 1
  s_cmp_lt_u32 s30, 50000
  s_cbranch_scc1 va_bw_19
  s_branch cA_abort
va_bw_19_ok:
  s_add_u32 s22, s31, 86016
  buffer_load_dwordx4 a[0:3], v2, s[8:11], s22 offen offset:0 sc1
  buffer_load_dwordx4 a[4:7], v2, s[8:11], s22 offen offset:1024 sc1
  buffer_load_dwordx4 a[8:11], v2, s[8:11], s22 offen offset:2048 sc1
  buffer_load_dwordx4 a[12:15], v2, s[8:11], s22 offen offset:3072 sc1
  s_add_u32 s22, s31, 90112
  buffer_load_dwordx4 a[16:19], v2, s[8:11], s22 offen offset:0 sc1
  buffer_load_dwordx4 a[20:23], v2, s[8:11], s22 offen offset:1024 sc1
  buffer_load_dwordx4 a[24:27], v2, s[8:11], s22 offen offset:2048 sc1
  buffer_load_dwordx4 a[28:31], v2, s[8:11], s22 offen offset:3072 sc1
  s_add_u32 s22, s31, 94208
  buffer_load_dwordx4 a[32:35], v2, s[8:11], s22 offen offset:0 sc1
  buffer_load_dwordx4 a[36:39], v2, s[8:11], s22 offen offset:1024 sc1
  buffer_load_dwordx4 a[40:43], v2, s[8:11], s22 offen offset:2048 sc1
  buffer_load_dwordx4 a[44:47], v2, s[8:11], s22 offen offset:3072 sc1
  s_add_u32 s22, s31, 98304
  buffer_load_dwordx4 a[48:51], v2, s[8:11], s22 offen offset:0 sc1
  buffer_load_dwordx4 a[52:55], v2, s[8:11], s22 offen offset:1024 sc1
  buffer_load_dwordx4 a[56:59], v2, s[8:11], s22 offen offset:2048 sc1
  buffer_load_dwordx4 a[60:63], v2, s[8:11], s22 offen offset:3072 sc1
  s_add_u32 s22, s31, 102400
  buffer_load_dwordx4 a[64:67], v2, s[8:11], s22 offen offset:0 sc1
  buffer_load_dwordx4 a[68:71], v2, s[8:11], s22 offen offset:1024 sc1
  buffer_load_dwordx4 a[72:75], v2, s[8:11], s22 offen offset:2048 sc1
  buffer_load_dwordx4 a[76:79], v2, s[8:11], s22 offen offset:3072 sc1
  s_add_u32 s22, s31, 106496
  buffer_load_dwordx4 a[80:83], v2, s[8:11], s22 offen offset:0 sc1
  buffer_load_dwordx4 a[84:87], v2, s[8:11], s22 offen offset:1024 sc1
  buffer_load_dwordx4 a[88:91], v2, s[8:11], s22 offen offset:2048 sc1
  buffer_load_dwordx4 a[92:95], v2, s[8:11], s22 offen offset:3072 sc1
  s_add_u32 s22, s31, 110592
  buffer_load_dwordx4 a[96:99], v2, s[8:11], s22 offen offset:0 sc1
  buffer_load_dwordx4 a[100:103], v2, s[8:11], s22 offen offset:1024 sc1
  buffer_load_dwordx4 a[104:107], v2, s[8:11], s22 offen offset:2048 sc1
  buffer_load_dwordx4 a[108:111], v2, s[8:11], s22 offen offset:3072 sc1
  s_add_u32 s22, s31, 114688
  buffer_load_dwordx4 a[112:115], v2, s[8:11], s22 offen offset:0 sc1
  buffer_load_dwordx4 a[116:119], v2, s[8:11], s22 offen offset:1024 sc1
  buffer_load_dwordx4 a[120:123], v2, s[8:11], s22 offen offset:2048 sc1
  buffer_load_dwordx4 a[124:127], v2, s[8:11], s22 offen offset:3072 sc1
  s_waitcnt vmcnt(24)
  s_add_u32 s22, s31, 118784
  buffer_load_dwordx4 a[128:131], v2, s[8:11], s22 offen offset:0 sc1
  buffer_load_dwordx4 a[132:135], v2, s[8:11], s22 offen offset:1024 sc1
  buffer_load_dwordx4 a[136:139], v2, s[8:11], s22 offen offset:2048 sc1
  buffer_load_dwordx4 a[140:143], v2, s[8:11], s22 offen offset:3072 sc1
  s_add_u32 s22, s31, 122880
  buffer_load_dwordx4 a[144:147], v2, s[8:11], s22 offen offset:0 sc1
  buffer_load_dwordx4 a[148:151], v2, s[8:11], s22 offen offset:1024 sc1
  buffer_load_dwordx4 a[152:155], v2, s[8:11], s22 offen offset:2048 sc1
  buffer_load_dwordx4 a[156:159], v2, s[8:11], s22 offen offset:3072 sc1
  s_add_u32 s22, s31, 126976
  buffer_load_dwordx4 a[160:163], v2, s[8:11], s22 offen offset:0 sc1
  buffer_load_dwordx4 a[164:167], v2, s[8:11], s22 offen offset:1024 sc1
  buffer_load_dwordx4 a[168:171], v2, s[8:11], s22 offen offset:2048 sc1
  buffer_load_dwordx4 a[172:175], v2, s[8:11], s22 offen offset:3072 sc1
  s_add_u32 s22, s31, 131072
  buffer_load_dwordx4 a[176:179], v2, s[8:11], s22 offen offset:0 sc1
  buffer_load_dwordx4 a[180:183], v2, s[8:11], s22 offen offset:1024 sc1
  buffer_load_dwordx4 a[184:187], v2, s[8:11], s22 offen offset:2048 sc1
  buffer_load_dwordx4 a[188:191], v2, s[8:11], s22 offen offset:3072 sc1
  s_add_u32 s22, s31, 135168
  buffer_load_dwordx4 a[192:195], v2, s[8:11], s22 offen offset:0 sc1
  buffer_load_dwordx4 a[196:199], v2, s[8:11], s22 offen offset:1024 sc1
  buffer_load_dwordx4 a[200:203], v2, s[8:11], s22 offen offset:2048 sc1
  buffer_load_dwordx4 a[204:207], v2, s[8:11], s22 offen offset:3072 sc1
  s_add_u32 s22, s31, 139264
  buffer_load_dwordx4 a[208:211], v2, s[8:11], s22 offen offset:0 sc1
  buffer_load_dwordx4 a[212:215], v2, s[8:11], s22 offen offset:1024 sc1
  buffer_load_dwordx4 a[216:219], v2, s[8:11], s22 offen offset:2048 sc1
  buffer_load_dwordx4 a[220:223], v2, s[8:11], s22 offen offset:3072 sc1
  s_add_u32 s22, s31, 143360
  buffer_load_dwordx4 a[224:227], v2, s[8:11], s22 offen offset:0 sc1
  buffer_load_dwordx4 a[228:231], v2, s[8:11], s22 offen offset:1024 sc1
  buffer_load_dwordx4 a[232:235], v2, s[8:11], s22 offen offset:2048 sc1
  buffer_load_dwordx4 a[236:239], v2, s[8:11], s22 offen offset:3072 sc1
  s_add_u32 s22, s31, 147456
  buffer_load_dwordx4 a[240:243], v2, s[8:11], s22 offen offset:0 sc1
  buffer_load_dwordx4 a[244:247], v2, s[8:11], s22 offen offset:1024 sc1
  buffer_load_dwordx4 a[248:251], v2, s[8:11], s22 offen offset:2048 sc1
  buffer_load_dwordx4 a[252:255], v2, s[8:11], s22 offen offset:3072 sc1
  s_waitcnt vmcnt(24)
  s_add_u32 s22, s31, 151552
  buffer_load_dwordx4 v[176:179], v2, s[8:11], s22 offen offset:0 sc1
  buffer_load_dwordx4 v[180:183], v2, s[8:11], s22 offen offset:1024 sc1
  buffer_load_dwordx4 v[184:187], v2, s[8:11], s22 offen offset:2048 sc1
  buffer_load_dwordx4 v[188:191], v2, s[8:11], s22 offen offset:3072 sc1
  s_add_u32 s22, s31, 155648
  buffer_load_dwordx4 v[192:195], v2, s[8:11], s22 offen offset:0 sc1
  buffer_load_dwordx4 v[196:199], v2, s[8:11], s22 offen offset:1024 sc1
  buffer_load_dwordx4 v[200:203], v2, s[8:11], s22 offen offset:2048 sc1
  buffer_load_dwordx4 v[204:207], v2, s[8:11], s22 offen offset:3072 sc1
  s_add_u32 s22, s31, 159744
  buffer_load_dwordx4 v[208:211], v2, s[8:11], s22 offen offset:0 sc1
  buffer_load_dwordx4 v[212:215], v2, s[8:11], s22 offen offset:1024 sc1
  buffer_load_dwordx4 v[216:219], v2, s[8:11], s22 offen offset:2048 sc1
  buffer_load_dwordx4 v[220:223], v2, s[8:11], s22 offen offset:3072 sc1
  s_add_u32 s22, s31, 163840
  buffer_load_dwordx4 v[224:227], v2, s[8:11], s22 offen offset:0 sc1
  buffer_load_dwordx4 v[228:231], v2, s[8:11], s22 offen offset:1024 sc1
  buffer_load_dwordx4 v[232:235], v2, s[8:11], s22 offen offset:2048 sc1
  buffer_load_dwordx4 v[236:239], v2, s[8:11], s22 offen offset:3072 sc1
  s_add_u32 s22, s31, 167936
  buffer_load_dwordx4 v[240:243], v2, s[8:11], s22 offen offset:0 sc1
  buffer_load_dwordx4 v[244:247], v2, s[8:11], s22 offen offset:1024 sc1
  buffer_load_dwordx4 v[248:251], v2, s[8:11], s22 offen offset:2048 sc1
  buffer_load_dwordx4 v[252:255], v2, s[8:11], s22 offen offset:3072 sc1
  s_lshl_b32 s22, s17, 4
  v_mov_b32 v38, s22
  s_mul_i32 s22, s17, 12
  s_add_u32 s23, s22, 267
  s_add_u32 s22, s22, 256
  v_mov_b32 v36, s23
  v_mov_b32 v37, s22
  v_cmp_eq_u32 vcc, 1, v116
  s_nop 1
  v_cndmask_b32 v36, v36, v37, vcc
  v_med3_u32 v37, v117, 14, 15
  v_lshrrev_b32 v36, 6, v36
  v_lshlrev_b32 v36, 8, v36
  v_lshl_add_u32 v36, v37, 4, v36
  s_mov_b32 s22, 88604672
  s_mov_b32 s30, 0
va_bw_20:
  buffer_load_dwordx4 v[40:43], v36, s[8:11], s22 offen sc1
  s_waitcnt vmcnt(0)
  v_cmp_ne_u64 vcc, s[88:89], v[40:41]
  s_cbranch_vccnz va_bw_20_no
  v_cmp_ne_u64 vcc, s[88:89], v[42:43]
  s_cbranch_vccnz va_bw_20_no
  s_branch va_bw_20_ok
va_bw_20_no:
  s_sleep 2
  s_add_u32 s30, s30, 1
  s_cmp_lt_u32 s30, 50000
  s_cbranch_scc1 va_bw_20
  s_branch cA_abort
va_bw_20_ok:
  s_mov_b32 m0, 59392
  s_add_u32 s22, s31, 387072
  buffer_load_dwordx4 v2, s[8:11], s22 offen offset:0 sc1 lds
  buffer_load_dwordx4 v2, s[8:11], s22 offen offset:1024 sc1 lds
  buffer_load_dwordx4 v2, s[8:11], s22 offen offset:2048 sc1 lds
  buffer_load_dwordx4 v2, s[8:11], s22 offen offset:3072 sc1 lds
  s_mov_b32 m0, 63488
  s_add_u32 s22, s31, 391168
  buffer_load_dwordx4 v2, s[8:11], s22 offen offset:0 sc1 lds
  buffer_load_dwordx4 v2, s[8:11], s22 offen offset:1024 sc1 lds
  buffer_load_dwordx4 v2, s[8:11], s22 offen offset:2048 sc1 lds
  buffer_load_dwordx4 v2, s[8:11], s22 offen offset:3072 sc1 lds
  s_mov_b32 m0, 67584
  s_add_u32 s22, s31, 395264
  buffer_load_dwordx4 v2, s[8:11], s22 offen offset:0 sc1 lds
  buffer_load_dwordx4 v2, s[8:11], s22 offen offset:1024 sc1 lds
  buffer_load_dwordx4 v2, s[8:11], s22 offen offset:2048 sc1 lds
  buffer_load_dwordx4 v2, s[8:11], s22 offen offset:3072 sc1 lds
  s_mov_b32 m0, 71680
  s_add_u32 s22, s31, 399360
  buffer_load_dwordx4 v2, s[8:11], s22 offen offset:0 sc1 lds
  buffer_load_dwordx4 v2, s[8:11], s22 offen offset:1024 sc1 lds
  v_mov_b32 v72, v116
  v_mov_b32 v73, v117
  v_lshrrev_b32 v65, 1, v72
  v_and_b32 v66, 1, v72
  v_mov_b32 v68, 6
  v_mov_b32 v69, v73
  v_mov_b32 v70, 0
  v_and_b32 v71, 1, v69
  v_lshrrev_b32 v69, 1, v69
  v_lshl_add_u32 v69, v71, 3, v69
  v_lshlrev_b32 v71, 12, v70
  v_lshrrev_b32 v70, 1, v68
  v_lshl_add_u32 v71, v70, 9, v71
  v_and_b32 v70, 1, v68
  v_lshl_add_u32 v71, v70, 2, v71
  v_lshl_add_u32 v71, v69, 4, v71
  v_lshl_add_u32 v71, v65, 8, v71
  v_lshl_add_u32 v60, v66, 3, v71
  v_mov_b32 v68, 7
  v_mov_b32 v69, v73
  v_mov_b32 v70, 0
  v_and_b32 v71, 1, v69
  v_lshrrev_b32 v69, 1, v69
  v_lshl_add_u32 v69, v71, 3, v69
  v_lshlrev_b32 v71, 12, v70
  v_lshrrev_b32 v70, 1, v68
  v_lshl_add_u32 v71, v70, 9, v71
  v_and_b32 v70, 1, v68
  v_lshl_add_u32 v71, v70, 2, v71
  v_lshl_add_u32 v71, v69, 4, v71
  v_lshl_add_u32 v71, v65, 8, v71
  v_lshl_add_u32 v61, v66, 3, v71
  v_mov_b32 v68, 8
  v_mov_b32 v69, v73
  v_mov_b32 v70, 0
  v_and_b32 v71, 1, v69
  v_lshrrev_b32 v69, 1, v69
  v_lshl_add_u32 v69, v71, 3, v69
  v_lshlrev_b32 v71, 12, v70
  v_lshrrev_b32 v70, 1, v68
  v_lshl_add_u32 v71, v70, 9, v71
  v_and_b32 v70, 1, v68
  v_lshl_add_u32 v71, v70, 2, v71
  v_lshl_add_u32 v71, v69, 4, v71
  v_lshl_add_u32 v71, v65, 8, v71
  v_lshl_add_u32 v62, v66, 3, v71
  v_mov_b32 v68, 9
  v_mov_b32 v69, v73
  v_mov_b32 v70, 0
  v_and_b32 v71, 1, v69
  v_lshrrev_b32 v69, 1, v69
  v_lshl_add_u32 v69, v71, 3, v69
  v_lshlrev_b32 v71, 12, v70
  v_lshrrev_b32 v70, 1, v68
  v_lshl_add_u32 v71, v70, 9, v71
  v_and_b32 v70, 1, v68
  v_lshl_add_u32 v71, v70, 2, v71
  v_lshl_add_u32 v71, v69, 4, v71
  v_lshl_add_u32 v71, v65, 8, v71
  v_lshl_add_u32 v170, v66, 3, v71
  v_mov_b32 v68, 10
  v_mov_b32 v69, v73
  v_mov_b32 v70, 0
  v_and_b32 v71, 1, v69
  v_lshrrev_b32 v69, 1, v69
  v_lshl_add_u32 v69, v71, 3, v69
  v_lshlrev_b32 v71, 12, v70
  v_lshrrev_b32 v70, 1, v68
  v_lshl_add_u32 v71, v70, 9, v71
  v_and_b32 v70, 1, v68
  v_lshl_add_u32 v71, v70, 2, v71
  v_lshl_add_u32 v71, v69, 4, v71
  v_lshl_add_u32 v71, v65, 8, v71
  v_lshl_add_u32 v171, v66, 3, v71
  v_mov_b32 v68, 11
  v_mov_b32 v69, v73
  v_mov_b32 v70, 0
  v_and_b32 v71, 1, v69
  v_lshrrev_b32 v69, 1, v69
  v_lshl_add_u32 v69, v71, 3, v69
  v_lshlrev_b32 v71, 12, v70
  v_lshrrev_b32 v70, 1, v68
  v_lshl_add_u32 v71, v70, 9, v71
  v_and_b32 v70, 1, v68
  v_lshl_add_u32 v71, v70, 2, v71
  v_lshl_add_u32 v71, v69, 4, v71
  v_lshl_add_u32 v71, v65, 8, v71
  v_lshl_add_u32 v172, v66, 3, v71
  v_and_b32 v0, 31, v1
  v_lshlrev_b32 v0, 2, v0
  v_add_u32 v0, 18432, v0
  v_min_u32 v4, 15, v73
  v_lshlrev_b32 v4, 2, v4
  s_and_b32 s22, s17, 3
  s_lshl_b32 s22, s22, 7
  s_add_u32 s22, s22, 17408
  v_add_u32 v4, s22, v4
  v_and_b32 v64, 7, v73
  v_lshlrev_b32 v5, 4, v64
  v_lshl_add_u32 v5, v72, 7, v5
  v_lshrrev_b32 v65, 3, v73
  v_lshl_add_u32 v5, v65, 9, v5
  s_lshl_b32 s22, s17, 3
  s_add_u32 s22, s22, 17924
  v_mov_b32 v7, s22
  v_add_u32 v65, 16, v73
  v_min_u32 v65, 27, v65
  v_mad_u32_u24 v65, v72, 28, v65
  v_lshlrev_b32 v6, 4, v65
  s_lshr_b32 s22, s17, 1
  s_mul_i32 s22, s22, 7
  s_and_b32 s34, s17, 1
  s_lshl_b32 s35, s34, 2
  v_add_u32 v70, s35, v72
  v_mov_b32 v71, s34
  v_mov_b32 v69, 1
  v_cmp_eq_u32 vcc, 3, v72
  s_nop 1
  v_cndmask_b32 v70, v70, v72, vcc
  v_cndmask_b32 v69, v69, v71, vcc
  v_add_u32 v70, s22, v70
  v_lshrrev_b32 v68, 1, v70
  v_lshlrev_b32 v68, 8, v68
  v_lshl_add_u32 v68, v69, 7, v68
  v_and_b32 v69, 1, v70
  v_lshl_add_u32 v68, v69, 3, v68
  v_lshl_add_u32 v1, v64, 4, v68
  v_cmp_gt_u32 s[26:27], 8, v73
  v_cmp_gt_u32 vcc, 3, v72
  s_and_b64 s[26:27], s[26:27], vcc
  v_lshrrev_b32 v65, 3, v73
  v_min_u32 v66, 5, v64
  v_lshl_add_u32 v66, v66, 1, v65
  v_mad_u32_u24 v66, v72, 12, v66
  v_lshlrev_b32 v66, 4, v66
  v_add_u32 v6, 1024, v66
  s_mul_i32 s22, s17, 12
  s_add_u32 s22, s22, 256
  v_lshl_add_u32 v70, v64, 1, s22
  v_lshrrev_b32 v68, 4, v70
  v_lshlrev_b32 v68, 8, v68
  v_bfe_u32 v69, v70, 1, 1
  v_lshl_add_u32 v68, v69, 7, v68
  v_bfe_u32 v69, v70, 2, 2
  v_lshl_add_u32 v68, v69, 2, v68
  v_and_b32 v69, 1, v72
  v_lshl_add_u32 v65, v69, 2, v65
  v_lshrrev_b32 v69, 1, v72
  v_lshl_add_u32 v65, v69, 1, v65
  v_lshrrev_b32 v65, 3, v73
  v_lshl_add_u32 v65, v72, 1, v65
  v_lshrrev_b32 v5, 1, v72
  v_lshlrev_b32 v5, 9, v5
  v_lshrrev_b32 v69, 2, v73
  v_lshl_add_u32 v5, v69, 7, v5
  v_and_b32 v69, 1, v72
  v_lshl_add_u32 v5, v69, 6, v5
  v_and_b32 v69, 3, v73
  v_lshl_add_u32 v5, v69, 4, v5
  v_and_b32 v69, 1, v73
  v_mul_u32_u24 v69, 0xaaaa, v69
  v_add_u32 v0, 0x4444, v69
  v_lshl_add_u32 v1, v65, 4, v68
  v_cmp_gt_u32 s[26:27], 6, v64
  v_mov_b32 v156, 0
  v_mov_b32 v157, 0
  v_mov_b32 v158, 0
  v_mov_b32 v159, 0
  ds_write_b128 v2, v[156:159] offset:4096
  ds_write_b128 v2, v[156:159] offset:5120
  ds_write_b128 v2, v[156:159] offset:6144
  ds_write_b128 v2, v[156:159] offset:7168
  s_mul_i32 s22, s17, 1835008
  s_add_u32 s25, s22, 42205184
  s_lshl_b32 s35, s17, 7
  s_add_u32 s35, s35, 88539136
  s_add_u32 s39, s35, 16384
  s_mov_b32 s38, 0
  v_mov_b32 v63, 0
  v_bfe_u32 v8, v2, 4, 1
  v_mul_u32_u24 v3, 0xaaaa, v8
  v_add_u32 v3, 0x4444, v3
  v_bfe_u32 v9, v2, 5, 3
  v_lshl_add_u32 v8, v8, 3, v9
  v_and_b32 v9, 0x300, v2
  v_lshl_add_u32 v0, v8, 4, v9
  s_getpc_b64 s[98:99]
cpf_18:
  s_add_u32 s98, s98, cA_va1_loop-cpf_18
  s_addc_u32 s99, s99, 0
  v_lshlrev_b32 v38, 2, v2
  global_load_dword v39, v38, s[98:99]
  s_lshl_b32 s22, 0, 11
  s_add_u32 s22, s22, 88606720
  v_add_u32 v36, 1024, v2
  v_min_u32 v36, 1776, v36
  s_mov_b32 s30, 0
va_iw5:
  buffer_load_dwordx4 v[40:43], v2, s[8:11], s22 offen sc1
  buffer_load_dwordx4 v[44:47], v36, s[8:11], s22 offen sc1
  s_waitcnt vmcnt(0)
  v_cmp_ne_u64 vcc, s[88:89], v[40:41]
  s_cbranch_vccnz va_iw5_no
  v_cmp_ne_u64 vcc, s[88:89], v[42:43]
  s_cbranch_vccnz va_iw5_no
  v_cmp_ne_u64 vcc, s[88:89], v[44:45]
  s_cbranch_vccnz va_iw5_no
  v_cmp_ne_u64 vcc, s[88:89], v[46:47]
  s_cbranch_vccnz va_iw5_no
  s_branch va_iw5_ok
va_iw5_no:
  s_sleep 2
  s_add_u32 s30, s30, 1
  s_cmp_lt_u32 s30, 50000
  s_cbranch_scc1 va_iw5
  s_branch cA_abort
va_iw5_ok:
  s_mov_b32 s30, 0
  v_mov_b32 v36, 0
ch_md5:
  buffer_load_dword v37, v36, s[12:15], 0 offen sc1
  s_waitcnt vmcnt(0)
  v_readfirstlane_b32 s22, v37
  s_and_b32 s31, s22, 0xffff
  s_cmp_ge_u32 s31, 32
  s_cbranch_scc1 ch_go5
  s_sleep 2
  s_add_u32 s30, s30, 1
  s_cmp_lt_u32 s30, 50000
  s_cbranch_scc1 ch_md5
  s_branch ch_end
ch_go5:
  s_mov_b32 s31, 0
  v_mov_b32 v36, 0
  v_mov_b32 v37, 0
  v_mov_b32 v38, 0
  v_mov_b32 v39, 0
  v_mov_b32 v40, 0
  v_mov_b32 v41, 0
  v_mov_b32 v42, 0
  v_mov_b32 v43, 0
  v_mov_b32 v44, 0
  v_mov_b32 v45, 0
  v_mov_b32 v46, 0
  v_mov_b32 v47, 0
  v_mov_b32 v48, 0
  v_mov_b32 v49, 0
  v_mov_b32 v50, 0
  v_mov_b32 v51, 0
  v_mov_b32 v52, 0
  v_mov_b32 v53, 0
  v_mov_b32 v54, 0
  v_mov_b32 v55, 0
  v_mov_b32 v56, 0
  v_mov_b32 v57, 0
  v_mov_b32 v58, 0
  v_mov_b32 v59, 0
  s_lshr_b32 s22, s22, 16
  s_cmp_lg_u32 s22, 0
  s_cbranch_scc1 cB_va1_loop
  s_branch cA_va1_loop
ch_init6:
  s_mul_i32 s31, s17, 401408
  s_add_u32 s31, s31, 6422528
  s_lshl_b32 s22, s17, 4
  v_mov_b32 v38, s22
  s_mul_i32 s22, s17, 12
  s_add_u32 s23, s22, 267
  s_add_u32 s22, s22, 256
  v_mov_b32 v36, s23
  v_mov_b32 v37, s22
  v_cmp_eq_u32 vcc, 1, v116
  s_nop 1
  v_cndmask_b32 v36, v36, v37, vcc
  v_med3_u32 v37, v117, 0, 3
  v_med3_u32 v39, v117, 12, 15
  v_cmp_eq_u32 vcc, 0, v116
  s_nop 1
  v_cndmask_b32 v36, v36, v38, vcc
  v_cndmask_b32 v37, v37, v39, vcc
  v_lshrrev_b32 v36, 6, v36
  v_lshlrev_b32 v36, 8, v36
  v_lshl_add_u32 v36, v37, 4, v36
  s_mov_b32 s22, 88604672
  s_mov_b32 s30, 0
va_bw_22:
  buffer_load_dwordx4 v[40:43], v36, s[8:11], s22 offen sc1
  s_waitcnt vmcnt(0)
  v_cmp_ne_u64 vcc, s[88:89], v[40:41]
  s_cbranch_vccnz va_bw_22_no
  v_cmp_ne_u64 vcc, s[88:89], v[42:43]
  s_cbranch_vccnz va_bw_22_no
  s_branch va_bw_22_ok
va_bw_22_no:
  s_sleep 2
  s_add_u32 s30, s30, 1
  s_cmp_lt_u32 s30, 50000
  s_cbranch_scc1 va_bw_22
  s_branch cA_abort
va_bw_22_ok:
  s_add_u32 s22, s31, 172032
  buffer_load_dwordx4 a[0:3], v2, s[8:11], s22 offen offset:0 sc1
  buffer_load_dwordx4 a[4:7], v2, s[8:11], s22 offen offset:1024 sc1
  buffer_load_dwordx4 a[8:11], v2, s[8:11], s22 offen offset:2048 sc1
  buffer_load_dwordx4 a[12:15], v2, s[8:11], s22 offen offset:3072 sc1
  s_add_u32 s22, s31, 176128
  buffer_load_dwordx4 a[16:19], v2, s[8:11], s22 offen offset:0 sc1
  buffer_load_dwordx4 a[20:23], v2, s[8:11], s22 offen offset:1024 sc1
  buffer_load_dwordx4 a[24:27], v2, s[8:11], s22 offen offset:2048 sc1
  buffer_load_dwordx4 a[28:31], v2, s[8:11], s22 offen offset:3072 sc1
  s_add_u32 s22, s31, 180224
  buffer_load_dwordx4 a[32:35], v2, s[8:11], s22 offen offset:0 sc1
  buffer_load_dwordx4 a[36:39], v2, s[8:11], s22 offen offset:1024 sc1
  buffer_load_dwordx4 a[40:43], v2, s[8:11], s22 offen offset:2048 sc1
  buffer_load_dwordx4 a[44:47], v2, s[8:11], s22 offen offset:3072 sc1
  s_add_u32 s22, s31, 184320
  buffer_load_dwordx4 a[48:51], v2, s[8:11], s22 offen offset:0 sc1
  buffer_load_dwordx4 a[52:55], v2, s[8:11], s22 offen offset:1024 sc1
  buffer_load_dwordx4 a[56:59], v2, s[8:11], s22 offen offset:2048 sc1
  buffer_load_dwordx4 a[60:63], v2, s[8:11], s22 offen offset:3072 sc1
  s_add_u32 s22, s31, 188416
  buffer_load_dwordx4 a[64:67], v2, s[8:11], s22 offen offset:0 sc1
  buffer_load_dwordx4 a[68:71], v2, s[8:11], s22 offen offset:1024 sc1
  buffer_load_dwordx4 a[72:75], v2, s[8:11], s22 offen offset:2048 sc1
  buffer_load_dwordx4 a[76:79], v2, s[8:11], s22 offen offset:3072 sc1
  s_add_u32 s22, s31, 192512
  buffer_load_dwordx4 a[80:83], v2, s[8:11], s22 offen offset:0 sc1
  buffer_load_dwordx4 a[84:87], v2, s[8:11], s22 offen offset:1024 sc1
  buffer_load_dwordx4 a[88:91], v2, s[8:11], s22 offen offset:2048 sc1
  buffer_load_dwordx4 a[92:95], v2, s[8:11], s22 offen offset:3072 sc1
  s_add_u32 s22, s31, 196608
  buffer_load_dwordx4 a[96:99], v2, s[8:11], s22 offen offset:0 sc1
  buffer_load_dwordx4 a[100:103], v2, s[8:11], s22 offen offset:1024 sc1
  buffer_load_dwordx4 a[104:107], v2, s[8:11], s22 offen offset:2048 sc1
  buffer_load_dwordx4 a[108:111], v2, s[8:11], s22 offen offset:3072 sc1
  s_add_u32 s22, s31, 200704
  buffer_load_dwordx4 a[112:115], v2, s[8:11], s22 offen offset:0 sc1
  buffer_load_dwordx4 a[116:119], v2, s[8:11], s22 offen offset:1024 sc1
  buffer_load_dwordx4 a[120:123], v2, s[8:11], s22 offen offset:2048 sc1
  buffer_load_dwordx4 a[124:127], v2, s[8:11], s22 offen offset:3072 sc1
  s_waitcnt vmcnt(24)
  s_add_u32 s22, s31, 204800
  buffer_load_dwordx4 a[128:131], v2, s[8:11], s22 offen offset:0 sc1
  buffer_load_dwordx4 a[132:135], v2, s[8:11], s22 offen offset:1024 sc1
  buffer_load_dwordx4 a[136:139], v2, s[8:11], s22 offen offset:2048 sc1
  buffer_load_dwordx4 a[140:143], v2, s[8:11], s22 offen offset:3072 sc1
  s_add_u32 s22, s31, 208896
  buffer_load_dwordx4 a[144:147], v2, s[8:11], s22 offen offset:0 sc1
  buffer_load_dwordx4 a[148:151], v2, s[8:11], s22 offen offset:1024 sc1
  buffer_load_dwordx4 a[152:155], v2, s[8:11], s22 offen offset:2048 sc1
  buffer_load_dwordx4 a[156:159], v2, s[8:11], s22 offen offset:3072 sc1
  s_add_u32 s22, s31, 212992
  buffer_load_dwordx4 a[160:163], v2, s[8:11], s22 offen offset:0 sc1
  buffer_load_dwordx4 a[164:167], v2, s[8:11], s22 offen offset:1024 sc1
  buffer_load_dwordx4 a[168:171], v2, s[8:11], s22 offen offset:2048 sc1
  buffer_load_dwordx4 a[172:175], v2, s[8:11], s22 offen offset:3072 sc1
  s_add_u32 s22, s31, 217088
  buffer_load_dwordx4 a[176:179], v2, s[8:11], s22 offen offset:0 sc1
  buffer_load_dwordx4 a[180:183], v2, s[8:11], s22 offen offset:1024 sc1
  buffer_load_dwordx4 a[184:187], v2, s[8:11], s22 offen offset:2048 sc1
  buffer_load_dwordx4 a[188:191], v2, s[8:11], s22 offen offset:3072 sc1
  s_add_u32 s22, s31, 221184
  buffer_load_dwordx4 a[192:195], v2, s[8:11], s22 offen offset:0 sc1
  buffer_load_dwordx4 a[196:199], v2, s[8:11], s22 offen offset:1024 sc1
  buffer_load_dwordx4 a[200:203], v2, s[8:11], s22 offen offset:2048 sc1
  buffer_load_dwordx4 a[204:207], v2, s[8:11], s22 offen offset:3072 sc1
  s_add_u32 s22, s31, 225280
  buffer_load_dwordx4 a[208:211], v2, s[8:11], s22 offen offset:0 sc1
  buffer_load_dwordx4 a[212:215], v2, s[8:11], s22 offen offset:1024 sc1
  buffer_load_dwordx4 a[216:219], v2, s[8:11], s22 offen offset:2048 sc1
  buffer_load_dwordx4 a[220:223], v2, s[8:11], s22 offen offset:3072 sc1
  s_add_u32 s22, s31, 229376
  buffer_load_dwordx4 a[224:227], v2, s[8:11], s22 offen offset:0 sc1
  buffer_load_dwordx4 a[228:231], v2, s[8:11], s22 offen offset:1024 sc1
  buffer_load_dwordx4 a[232:235], v2, s[8:11], s22 offen offset:2048 sc1
  buffer_load_dwordx4 a[236:239], v2, s[8:11], s22 offen offset:3072 sc1
  s_add_u32 s22, s31, 233472
  buffer_load_dwordx4 a[240:243], v2, s[8:11], s22 offen offset:0 sc1
  buffer_load_dwordx4 a[244:247], v2, s[8:11], s22 offen offset:1024 sc1
  buffer_load_dwordx4 a[248:251], v2, s[8:11], s22 offen offset:2048 sc1
  buffer_load_dwordx4 a[252:255], v2, s[8:11], s22 offen offset:3072 sc1
  s_waitcnt vmcnt(24)
  s_add_u32 s22, s31, 237568
  buffer_load_dwordx4 v[120:123], v2, s[8:11], s22 offen offset:0 sc1
  buffer_load_dwordx4 v[124:127], v2, s[8:11], s22 offen offset:1024 sc1
  buffer_load_dwordx4 v[128:131], v2, s[8:11], s22 offen offset:2048 sc1
  buffer_load_dwordx4 v[132:135], v2, s[8:11], s22 offen offset:3072 sc1
  s_add_u32 s22, s31, 241664
  buffer_load_dwordx4 v[136:139], v2, s[8:11], s22 offen offset:0 sc1
  buffer_load_dwordx4 v[140:143], v2, s[8:11], s22 offen offset:1024 sc1
  buffer_load_dwordx4 v[144:147], v2, s[8:11], s22 offen offset:2048 sc1
  buffer_load_dwordx4 v[148:151], v2, s[8:11], s22 offen offset:3072 sc1
  s_add_u32 s22, s31, 245760
  buffer_load_dwordx4 v[152:155], v2, s[8:11], s22 offen offset:0 sc1
  buffer_load_dwordx4 v[156:159], v2, s[8:11], s22 offen offset:1024 sc1
  buffer_load_dwordx4 v[160:163], v2, s[8:11], s22 offen offset:2048 sc1
  buffer_load_dwordx4 v[164:167], v2, s[8:11], s22 offen offset:3072 sc1
  s_add_u32 s22, s31, 249856
  buffer_load_dwordx4 v[168:171], v2, s[8:11], s22 offen offset:0 sc1
  buffer_load_dwordx4 v[172:175], v2, s[8:11], s22 offen offset:1024 sc1
  buffer_load_dwordx4 v[176:179], v2, s[8:11], s22 offen offset:2048 sc1
  buffer_load_dwordx4 v[180:183], v2, s[8:11], s22 offen offset:3072 sc1
  s_add_u32 s22, s31, 253952
  buffer_load_dwordx4 v[184:187], v2, s[8:11], s22 offen offset:0 sc1
  buffer_load_dwordx4 v[188:191], v2, s[8:11], s22 offen offset:1024 sc1
  buffer_load_dwordx4 v[192:195], v2, s[8:11], s22 offen offset:2048 sc1
  buffer_load_dwordx4 v[196:199], v2, s[8:11], s22 offen offset:3072 sc1
  s_add_u32 s22, s31, 258048
  buffer_load_dwordx4 v[200:203], v2, s[8:11], s22 offen offset:0 sc1
  buffer_load_dwordx4 v[204:207], v2, s[8:11], s22 offen offset:1024 sc1
  buffer_load_dwordx4 v[208:211], v2, s[8:11], s22 offen offset:2048 sc1
  buffer_load_dwordx4 v[212:215], v2, s[8:11], s22 offen offset:3072 sc1
  s_add_u32 s22, s31, 262144
  buffer_load_dwordx4 v[216:219], v2, s[8:11], s22 offen offset:0 sc1
  buffer_load_dwordx4 v[220:223], v2, s[8:11], s22 offen offset:1024 sc1
  buffer_load_dwordx4 v[224:227], v2, s[8:11], s22 offen offset:2048 sc1
  buffer_load_dwordx4 v[228:231], v2, s[8:11], s22 offen offset:3072 sc1
  s_add_u32 s22, s31, 266240
  buffer_load_dwordx4 v[232:235], v2, s[8:11], s22 offen offset:0 sc1
  buffer_load_dwordx4 v[236:239], v2, s[8:11], s22 offen offset:1024 sc1
  buffer_load_dwordx4 v[240:243], v2, s[8:11], s22 offen offset:2048 sc1
  buffer_load_dwordx4 v[244:247], v2, s[8:11], s22 offen offset:3072 sc1
  s_waitcnt vmcnt(24)
  s_add_u32 s22, s31, 270336
  buffer_load_dwordx4 v[248:251], v2, s[8:11], s22 offen offset:0 sc1
  buffer_load_dwordx4 v[252:255], v2, s[8:11], s22 offen offset:1024 sc1
  v_mov_b32 v72, v116
  v_mov_b32 v73, v117
  v_lshrrev_b32 v65, 1, v72
  v_and_b32 v66, 1, v72
  v_mov_b32 v68, 12
  v_mov_b32 v69, v73
  v_mov_b32 v70, 0
  v_and_b32 v71, 1, v69
  v_lshrrev_b32 v69, 1, v69
  v_lshl_add_u32 v69, v71, 3, v69
  v_lshlrev_b32 v71, 12, v70
  v_lshrrev_b32 v70, 1, v68
  v_lshl_add_u32 v71, v70, 9, v71
  v_and_b32 v70, 1, v68
  v_lshl_add_u32 v71, v70, 2, v71
  v_lshl_add_u32 v71, v69, 4, v71
  v_lshl_add_u32 v71, v65, 8, v71
  v_lshl_add_u32 v100, v66, 3, v71
  v_mov_b32 v68, 13
  v_mov_b32 v69, v73
  v_mov_b32 v70, 0
  v_and_b32 v71, 1, v69
  v_lshrrev_b32 v69, 1, v69
  v_lshl_add_u32 v69, v71, 3, v69
  v_lshlrev_b32 v71, 12, v70
  v_lshrrev_b32 v70, 1, v68
  v_lshl_add_u32 v71, v70, 9, v71
  v_and_b32 v70, 1, v68
  v_lshl_add_u32 v71, v70, 2, v71
  v_lshl_add_u32 v71, v69, 4, v71
  v_lshl_add_u32 v71, v65, 8, v71
  v_lshl_add_u32 v101, v66, 3, v71
  v_mov_b32 v68, 14
  v_mov_b32 v69, v73
  v_mov_b32 v70, 0
  v_and_b32 v71, 1, v69
  v_lshrrev_b32 v69, 1, v69
  v_lshl_add_u32 v69, v71, 3, v69
  v_lshlrev_b32 v71, 12, v70
  v_lshrrev_b32 v70, 1, v68
  v_lshl_add_u32 v71, v70, 9, v71
  v_and_b32 v70, 1, v68
  v_lshl_add_u32 v71, v70, 2, v71
  v_lshl_add_u32 v71, v69, 4, v71
  v_lshl_add_u32 v71, v65, 8, v71
  v_lshl_add_u32 v102, v66, 3, v71
  v_mov_b32 v68, 15
  v_mov_b32 v69, v73
  v_mov_b32 v70, 0
  v_and_b32 v71, 1, v69
  v_lshrrev_b32 v69, 1, v69
  v_lshl_add_u32 v69, v71, 3, v69
  v_lshlrev_b32 v71, 12, v70
  v_lshrrev_b32 v70, 1, v68
  v_lshl_add_u32 v71, v70, 9, v71
  v_and_b32 v70, 1, v68
  v_lshl_add_u32 v71, v70, 2, v71
  v_lshl_add_u32 v71, v69, 4, v71
  v_lshl_add_u32 v71, v65, 8, v71
  v_lshl_add_u32 v103, v66, 3, v71
  v_add_u32 v67, 0, v73
  v_mul_u32_u24 v68, 5462, v67
  v_lshrrev_b32 v68, 16, v68
  v_mul_u32_u24 v69, 12, v68
  v_sub_u32 v69, v67, v69
  v_mov_b32 v70, 1
  v_and_b32 v71, 1, v69
  v_lshrrev_b32 v69, 1, v69
  v_lshl_add_u32 v69, v71, 3, v69
  v_lshlrev_b32 v71, 12, v70
  v_lshrrev_b32 v70, 1, v68
  v_lshl_add_u32 v71, v70, 9, v71
  v_and_b32 v70, 1, v68
  v_lshl_add_u32 v71, v70, 2, v71
  v_lshl_add_u32 v71, v69, 4, v71
  v_lshl_add_u32 v71, v65, 8, v71
  v_lshl_add_u32 v104, v66, 3, v71
  v_add_u32 v67, 16, v73
  v_mul_u32_u24 v68, 5462, v67
  v_lshrrev_b32 v68, 16, v68
  v_mul_u32_u24 v69, 12, v68
  v_sub_u32 v69, v67, v69
  v_mov_b32 v70, 1
  v_and_b32 v71, 1, v69
  v_lshrrev_b32 v69, 1, v69
  v_lshl_add_u32 v69, v71, 3, v69
  v_lshlrev_b32 v71, 12, v70
  v_lshrrev_b32 v70, 1, v68
  v_lshl_add_u32 v71, v70, 9, v71
  v_and_b32 v70, 1, v68
  v_lshl_add_u32 v71, v70, 2, v71
  v_lshl_add_u32 v71, v69, 4, v71
  v_lshl_add_u32 v71, v65, 8, v71
  v_lshl_add_u32 v105, v66, 3, v71
  v_add_u32 v67, 32, v73
  v_mul_u32_u24 v68, 5462, v67
  v_lshrrev_b32 v68, 16, v68
  v_mul_u32_u24 v69, 12, v68
  v_sub_u32 v69, v67, v69
  v_mov_b32 v70, 1
  v_and_b32 v71, 1, v69
  v_lshrrev_b32 v69, 1, v69
  v_lshl_add_u32 v69, v71, 3, v69
  v_lshlrev_b32 v71, 12, v70
  v_lshrrev_b32 v70, 1, v68
  v_lshl_add_u32 v71, v70, 9, v71
  v_and_b32 v70, 1, v68
  v_lshl_add_u32 v71, v70, 2, v71
  v_lshl_add_u32 v71, v69, 4, v71
  v_lshl_add_u32 v71, v65, 8, v71
  v_lshl_add_u32 v106, v66, 3, v71
  v_add_u32 v67, 48, v73
  v_mul_u32_u24 v68, 5462, v67
  v_lshrrev_b32 v68, 16, v68
  v_mul_u32_u24 v69, 12, v68
  v_sub_u32 v69, v67, v69
  v_mov_b32 v70, 1
  v_and_b32 v71, 1, v69
  v_lshrrev_b32 v69, 1, v69
  v_lshl_add_u32 v69, v71, 3, v69
  v_lshlrev_b32 v71, 12, v70
  v_lshrrev_b32 v70, 1, v68
  v_lshl_add_u32 v71, v70, 9, v71
  v_and_b32 v70, 1, v68
  v_lshl_add_u32 v71, v70, 2, v71
  v_lshl_add_u32 v71, v69, 4, v71
  v_lshl_add_u32 v71, v65, 8, v71
  v_lshl_add_u32 v107, v66, 3, v71
  s_mul_i32 s24, s17, 532480
  s_add_u32 s24, s24, 76939264
  s_mul_i32 s34, s17, 640
  s_add_u32 s34, s34, 88582144
  s_mul_i32 s36, s17, 448
  v_add_u32 v0, s36, v2
  v_add_u32 v0, 8192, v0
  s_add_u32 s36, s36, 88080384
  s_mov_b32 s37, 76939264
  v_cmp_gt_u32 s[26:27], 28, v1
  v_and_b32 v119, 31, v1
  v_lshlrev_b32 v119, 2, v119
  v_and_b32 v119, 0x78, v119
  v_or_b32 v119, 4, v119
  s_add_u32 s22, s17, 16
  s_and_b32 s22, s22, 15
  s_lshl_b32 s22, s22, 7
  s_add_u32 s22, s22, 18432
  v_add_u32 v119, s22, v119
  v_min_u32 v118, 9, v1
  s_mul_i32 s22, s17, 10
  v_add_u32 v118, s22, v118
  v_lshlrev_b32 v118, 7, v118
  v_add_u32 v118, 40960, v118
  s_mov_b32 s39, 71565312
  v_add_u32 v1, 16384, v2
  v_mov_b32 v117, 1
  s_mul_i32 s38, s17, 1104
  s_add_u32 s38, s38, 20480
  v_bfe_u32 v8, v2, 4, 1
  v_mul_u32_u24 v3, 0xaaaa, v8
  v_add_u32 v3, 0x4444, v3
  v_bfe_u32 v9, v2, 5, 3
  v_lshl_add_u32 v8, v8, 3, v9
  v_and_b32 v9, 0x300, v2
  v_lshl_add_u32 v5, v8, 4, v9
  s_getpc_b64 s[98:99]
cpf_21:
  s_add_u32 s98, s98, cA_va2_loop-cpf_21
  s_addc_u32 s99, s99, 0
  v_lshlrev_b32 v38, 2, v2
  global_load_dword v39, v38, s[98:99]
  s_lshl_b32 s22, 0, 11
  s_add_u32 s22, s22, 88606720
  v_add_u32 v36, 1024, v2
  v_min_u32 v36, 1776, v36
  s_mov_b32 s30, 0
va_iw6:
  buffer_load_dwordx4 v[40:43], v2, s[8:11], s22 offen sc1
  buffer_load_dwordx4 v[44:47], v36, s[8:11], s22 offen sc1
  s_waitcnt vmcnt(0)
  v_cmp_ne_u64 vcc, s[88:89], v[40:41]
  s_cbranch_vccnz va_iw6_no
  v_cmp_ne_u64 vcc, s[88:89], v[42:43]
  s_cbranch_vccnz va_iw6_no
  v_cmp_ne_u64 vcc, s[88:89], v[44:45]
  s_cbranch_vccnz va_iw6_no
  v_cmp_ne_u64 vcc, s[88:89], v[46:47]
  s_cbranch_vccnz va_iw6_no
  s_branch va_iw6_ok
va_iw6_no:
  s_sleep 2
  s_add_u32 s30, s30, 1
  s_cmp_lt_u32 s30, 50000
  s_cbranch_scc1 va_iw6
  s_branch cA_abort
va_iw6_ok:
  s_mov_b32 s30, 0
  v_mov_b32 v36, 0
ch_md6:
  buffer_load_dword v37, v36, s[12:15], 0 offen sc1
  s_waitcnt vmcnt(0)
  v_readfirstlane_b32 s22, v37
  s_and_b32 s31, s22, 0xffff
  s_cmp_ge_u32 s31, 32
  s_cbranch_scc1 ch_go6
  s_sleep 2
  s_add_u32 s30, s30, 1
  s_cmp_lt_u32 s30, 50000
  s_cbranch_scc1 ch_md6
  s_branch ch_end
ch_go6:
  s_mov_b32 s31, 0
  s_lshr_b32 s22, s22, 16
  s_cmp_lg_u32 s22, 0
  s_cbranch_scc1 cB_va2_loop
  s_branch cA_va2_loop
ch_init7:
  s_mul_i32 s31, s17, 401408
  s_add_u32 s31, s31, 6422528
  s_lshl_b32 s22, s17, 4
  v_mov_b32 v38, s22
  s_mul_i32 s22, s17, 12
  s_add_u32 s23, s22, 267
  s_add_u32 s22, s22, 256
  v_mov_b32 v36, s23
  v_mov_b32 v37, s22
  v_cmp_eq_u32 vcc, 1, v116
  s_nop 1
  v_cndmask_b32 v36, v36, v37, vcc
  v_med3_u32 v37, v117, 5, 14
  v_lshrrev_b32 v36, 6, v36
  v_lshlrev_b32 v36, 8, v36
  v_lshl_add_u32 v36, v37, 4, v36
  s_mov_b32 s22, 88604672
  s_mov_b32 s30, 0
va_bw_24:
  buffer_load_dwordx4 v[40:43], v36, s[8:11], s22 offen sc1
  s_waitcnt vmcnt(0)
  v_cmp_ne_u64 vcc, s[88:89], v[40:41]
  s_cbranch_vccnz va_bw_24_no
  v_cmp_ne_u64 vcc, s[88:89], v[42:43]
  s_cbranch_vccnz va_bw_24_no
  s_branch va_bw_24_ok
va_bw_24_no:
  s_sleep 2
  s_add_u32 s30, s30, 1
  s_cmp_lt_u32 s30, 50000
  s_cbranch_scc1 va_bw_24
  s_branch cA_abort
va_bw_24_ok:
  s_add_u32 s22, s31, 286720
  buffer_load_dwordx4 a[0:3], v2, s[8:11], s22 offen offset:0 sc1
  buffer_load_dwordx4 a[4:7], v2, s[8:11], s22 offen offset:1024 sc1
  buffer_load_dwordx4 a[8:11], v2, s[8:11], s22 offen offset:2048 sc1
  buffer_load_dwordx4 a[12:15], v2, s[8:11], s22 offen offset:3072 sc1
  s_add_u32 s22, s31, 290816
  buffer_load_dwordx4 a[16:19], v2, s[8:11], s22 offen offset:0 sc1
  buffer_load_dwordx4 a[20:23], v2, s[8:11], s22 offen offset:1024 sc1
  buffer_load_dwordx4 a[24:27], v2, s[8:11], s22 offen offset:2048 sc1
  buffer_load_dwordx4 a[28:31], v2, s[8:11], s22 offen offset:3072 sc1
  s_add_u32 s22, s31, 294912
  buffer_load_dwordx4 a[32:35], v2, s[8:11], s22 offen offset:0 sc1
  buffer_load_dwordx4 a[36:39], v2, s[8:11], s22 offen offset:1024 sc1
  buffer_load_dwordx4 a[40:43], v2, s[8:11], s22 offen offset:2048 sc1
  buffer_load_dwordx4 a[44:47], v2, s[8:11], s22 offen offset:3072 sc1
  s_add_u32 s22, s31, 299008
  buffer_load_dwordx4 a[48:51], v2, s[8:11], s22 offen offset:0 sc1
  buffer_load_dwordx4 a[52:55], v2, s[8:11], s22 offen offset:1024 sc1
  buffer_load_dwordx4 a[56:59], v2, s[8:11], s22 offen offset:2048 sc1
  buffer_load_dwordx4 a[60:63], v2, s[8:11], s22 offen offset:3072 sc1
  s_add_u32 s22, s31, 303104
  buffer_load_dwordx4 a[64:67], v2, s[8:11], s22 offen offset:0 sc1
  buffer_load_dwordx4 a[68:71], v2, s[8:11], s22 offen offset:1024 sc1
  buffer_load_dwordx4 a[72:75], v2, s[8:11], s22 offen offset:2048 sc1
  buffer_load_dwordx4 a[76:79], v2, s[8:11], s22 offen offset:3072 sc1
  s_add_u32 s22, s31, 307200
  buffer_load_dwordx4 a[80:83], v2, s[8:11], s22 offen offset:0 sc1
  buffer_load_dwordx4 a[84:87], v2, s[8:11], s22 offen offset:1024 sc1
  buffer_load_dwordx4 a[88:91], v2, s[8:11], s22 offen offset:2048 sc1
  buffer_load_dwordx4 a[92:95], v2, s[8:11], s22 offen offset:3072 sc1
  s_add_u32 s22, s31, 311296
  buffer_load_dwordx4 a[96:99], v2, s[8:11], s22 offen offset:0 sc1
  buffer_load_dwordx4 a[100:103], v2, s[8:11], s22 offen offset:1024 sc1
  buffer_load_dwordx4 a[104:107], v2, s[8:11], s22 offen offset:2048 sc1
  buffer_load_dwordx4 a[108:111], v2, s[8:11], s22 offen offset:3072 sc1
  s_add_u32 s22, s31, 315392
  buffer_load_dwordx4 a[112:115], v2, s[8:11], s22 offen offset:0 sc1
  buffer_load_dwordx4 a[116:119], v2, s[8:11], s22 offen offset:1024 sc1
  buffer_load_dwordx4 a[120:123], v2, s[8:11], s22 offen offset:2048 sc1
  buffer_load_dwordx4 a[124:127], v2, s[8:11], s22 offen offset:3072 sc1
  s_waitcnt vmcnt(24)
  s_add_u32 s22, s31, 319488
  buffer_load_dwordx4 a[128:131], v2, s[8:11], s22 offen offset:0 sc1
  buffer_load_dwordx4 a[132:135], v2, s[8:11], s22 offen offset:1024 sc1
  buffer_load_dwordx4 a[136:139], v2, s[8:11], s22 offen offset:2048 sc1
  buffer_load_dwordx4 a[140:143], v2, s[8:11], s22 offen offset:3072 sc1
  s_add_u32 s22, s31, 323584
  buffer_load_dwordx4 a[144:147], v2, s[8:11], s22 offen offset:0 sc1
  buffer_load_dwordx4 a[148:151], v2, s[8:11], s22 offen offset:1024 sc1
  buffer_load_dwordx4 a[152:155], v2, s[8:11], s22 offen offset:2048 sc1
  buffer_load_dwordx4 a[156:159], v2, s[8:11], s22 offen offset:3072 sc1
  s_add_u32 s22, s31, 327680
  buffer_load_dwordx4 a[160:163], v2, s[8:11], s22 offen offset:0 sc1
  buffer_load_dwordx4 a[164:167], v2, s[8:11], s22 offen offset:1024 sc1
  buffer_load_dwordx4 a[168:171], v2, s[8:11], s22 offen offset:2048 sc1
  buffer_load_dwordx4 a[172:175], v2, s[8:11], s22 offen offset:3072 sc1
  s_add_u32 s22, s31, 331776
  buffer_load_dwordx4 a[176:179], v2, s[8:11], s22 offen offset:0 sc1
  buffer_load_dwordx4 a[180:183], v2, s[8:11], s22 offen offset:1024 sc1
  buffer_load_dwordx4 a[184:187], v2, s[8:11], s22 offen offset:2048 sc1
  buffer_load_dwordx4 a[188:191], v2, s[8:11], s22 offen offset:3072 sc1
  s_add_u32 s22, s31, 335872
  buffer_load_dwordx4 a[192:195], v2, s[8:11], s22 offen offset:0 sc1
  buffer_load_dwordx4 a[196:199], v2, s[8:11], s22 offen offset:1024 sc1
  buffer_load_dwordx4 a[200:203], v2, s[8:11], s22 offen offset:2048 sc1
  buffer_load_dwordx4 a[204:207], v2, s[8:11], s22 offen offset:3072 sc1
  s_add_u32 s22, s31, 339968
  buffer_load_dwordx4 a[208:211], v2, s[8:11], s22 offen offset:0 sc1
  buffer_load_dwordx4 a[212:215], v2, s[8:11], s22 offen offset:1024 sc1
  buffer_load_dwordx4 a[216:219], v2, s[8:11], s22 offen offset:2048 sc1
  buffer_load_dwordx4 a[220:223], v2, s[8:11], s22 offen offset:3072 sc1
  s_add_u32 s22, s31, 344064
  buffer_load_dwordx4 a[224:227], v2, s[8:11], s22 offen offset:0 sc1
  buffer_load_dwordx4 a[228:231], v2, s[8:11], s22 offen offset:1024 sc1
  buffer_load_dwordx4 a[232:235], v2, s[8:11], s22 offen offset:2048 sc1
  buffer_load_dwordx4 a[236:239], v2, s[8:11], s22 offen offset:3072 sc1
  s_add_u32 s22, s31, 348160
  buffer_load_dwordx4 a[240:243], v2, s[8:11], s22 offen offset:0 sc1
  buffer_load_dwordx4 a[244:247], v2, s[8:11], s22 offen offset:1024 sc1
  buffer_load_dwordx4 a[248:251], v2, s[8:11], s22 offen offset:2048 sc1
  buffer_load_dwordx4 a[252:255], v2, s[8:11], s22 offen offset:3072 sc1
  s_waitcnt vmcnt(24)
  s_add_u32 s22, s31, 352256
  buffer_load_dwordx4 v[120:123], v2, s[8:11], s22 offen offset:0 sc1
  buffer_load_dwordx4 v[124:127], v2, s[8:11], s22 offen offset:1024 sc1
  buffer_load_dwordx4 v[128:131], v2, s[8:11], s22 offen offset:2048 sc1
  buffer_load_dwordx4 v[132:135], v2, s[8:11], s22 offen offset:3072 sc1
  s_add_u32 s22, s31, 356352
  buffer_load_dwordx4 v[136:139], v2, s[8:11], s22 offen offset:0 sc1
  buffer_load_dwordx4 v[140:143], v2, s[8:11], s22 offen offset:1024 sc1
  buffer_load_dwordx4 v[144:147], v2, s[8:11], s22 offen offset:2048 sc1
  buffer_load_dwordx4 v[148:151], v2, s[8:11], s22 offen offset:3072 sc1
  s_add_u32 s22, s31, 360448
  buffer_load_dwordx4 v[152:155], v2, s[8:11], s22 offen offset:0 sc1
  buffer_load_dwordx4 v[156:159], v2, s[8:11], s22 offen offset:1024 sc1
  buffer_load_dwordx4 v[160:163], v2, s[8:11], s22 offen offset:2048 sc1
  buffer_load_dwordx4 v[164:167], v2, s[8:11], s22 offen offset:3072 sc1
  s_add_u32 s22, s31, 364544
  buffer_load_dwordx4 v[168:171], v2, s[8:11], s22 offen offset:0 sc1
  buffer_load_dwordx4 v[172:175], v2, s[8:11], s22 offen offset:1024 sc1
  buffer_load_dwordx4 v[176:179], v2, s[8:11], s22 offen offset:2048 sc1
  buffer_load_dwordx4 v[180:183], v2, s[8:11], s22 offen offset:3072 sc1
  s_add_u32 s22, s31, 368640
  buffer_load_dwordx4 v[184:187], v2, s[8:11], s22 offen offset:0 sc1
  buffer_load_dwordx4 v[188:191], v2, s[8:11], s22 offen offset:1024 sc1
  buffer_load_dwordx4 v[192:195], v2, s[8:11], s22 offen offset:2048 sc1
  buffer_load_dwordx4 v[196:199], v2, s[8:11], s22 offen offset:3072 sc1
  s_add_u32 s22, s31, 372736
  buffer_load_dwordx4 v[200:203], v2, s[8:11], s22 offen offset:0 sc1
  buffer_load_dwordx4 v[204:207], v2, s[8:11], s22 offen offset:1024 sc1
  buffer_load_dwordx4 v[208:211], v2, s[8:11], s22 offen offset:2048 sc1
  buffer_load_dwordx4 v[212:215], v2, s[8:11], s22 offen offset:3072 sc1
  s_add_u32 s22, s31, 376832
  buffer_load_dwordx4 v[216:219], v2, s[8:11], s22 offen offset:0 sc1
  buffer_load_dwordx4 v[220:223], v2, s[8:11], s22 offen offset:1024 sc1
  buffer_load_dwordx4 v[224:227], v2, s[8:11], s22 offen offset:2048 sc1
  buffer_load_dwordx4 v[228:231], v2, s[8:11], s22 offen offset:3072 sc1
  s_add_u32 s22, s31, 380928
  buffer_load_dwordx4 v[232:235], v2, s[8:11], s22 offen offset:0 sc1
  buffer_load_dwordx4 v[236:239], v2, s[8:11], s22 offen offset:1024 sc1
  buffer_load_dwordx4 v[240:243], v2, s[8:11], s22 offen offset:2048 sc1
  buffer_load_dwordx4 v[244:247], v2, s[8:11], s22 offen offset:3072 sc1
  s_waitcnt vmcnt(24)
  s_add_u32 s22, s31, 385024
  buffer_load_dwordx4 v[248:251], v2, s[8:11], s22 offen offset:0 sc1
  buffer_load_dwordx4 v[252:255], v2, s[8:11], s22 offen offset:1024 sc1
  v_mov_b32 v72, v116
  v_mov_b32 v73, v117
  v_lshrrev_b32 v65, 1, v72
  v_and_b32 v66, 1, v72
  v_add_u32 v67, 64, v73
  v_mul_u32_u24 v68, 5462, v67
  v_lshrrev_b32 v68, 16, v68
  v_mul_u32_u24 v69, 12, v68
  v_sub_u32 v69, v67, v69
  v_mov_b32 v70, 1
  v_and_b32 v71, 1, v69
  v_lshrrev_b32 v69, 1, v69
  v_lshl_add_u32 v69, v71, 3, v69
  v_lshlrev_b32 v71, 12, v70
  v_lshrrev_b32 v70, 1, v68
  v_lshl_add_u32 v71, v70, 9, v71
  v_and_b32 v70, 1, v68
  v_lshl_add_u32 v71, v70, 2, v71
  v_lshl_add_u32 v71, v69, 4, v71
  v_lshl_add_u32 v71, v65, 8, v71
  v_lshl_add_u32 v100, v66, 3, v71
  v_add_u32 v67, 80, v73
  v_mul_u32_u24 v68, 5462, v67
  v_lshrrev_b32 v68, 16, v68
  v_mul_u32_u24 v69, 12, v68
  v_sub_u32 v69, v67, v69
  v_mov_b32 v70, 1
  v_and_b32 v71, 1, v69
  v_lshrrev_b32 v69, 1, v69
  v_lshl_add_u32 v69, v71, 3, v69
  v_lshlrev_b32 v71, 12, v70
  v_lshrrev_b32 v70, 1, v68
  v_lshl_add_u32 v71, v70, 9, v71
  v_and_b32 v70, 1, v68
  v_lshl_add_u32 v71, v70, 2, v71
  v_lshl_add_u32 v71, v69, 4, v71
  v_lshl_add_u32 v71, v65, 8, v71
  v_lshl_add_u32 v101, v66, 3, v71
  v_add_u32 v67, 96, v73
  v_mul_u32_u24 v68, 5462, v67
  v_lshrrev_b32 v68, 16, v68
  v_mul_u32_u24 v69, 12, v68
  v_sub_u32 v69, v67, v69
  v_mov_b32 v70, 1
  v_and_b32 v71, 1, v69
  v_lshrrev_b32 v69, 1, v69
  v_lshl_add_u32 v69, v71, 3, v69
  v_lshlrev_b32 v71, 12, v70
  v_lshrrev_b32 v70, 1, v68
  v_lshl_add_u32 v71, v70, 9, v71
  v_and_b32 v70, 1, v68
  v_lshl_add_u32 v71, v70, 2, v71
  v_lshl_add_u32 v71, v69, 4, v71
  v_lshl_add_u32 v71, v65, 8, v71
  v_lshl_add_u32 v102, v66, 3, v71
  v_add_u32 v67, 112, v73
  v_mul_u32_u24 v68, 5462, v67
  v_lshrrev_b32 v68, 16, v68
  v_mul_u32_u24 v69, 12, v68
  v_sub_u32 v69, v67, v69
  v_mov_b32 v70, 1
  v_and_b32 v71, 1, v69
  v_lshrrev_b32 v69, 1, v69
  v_lshl_add_u32 v69, v71, 3, v69
  v_lshlrev_b32 v71, 12, v70
  v_lshrrev_b32 v70, 1, v68
  v_lshl_add_u32 v71, v70, 9, v71
  v_and_b32 v70, 1, v68
  v_lshl_add_u32 v71, v70, 2, v71
  v_lshl_add_u32 v71, v69, 4, v71
  v_lshl_add_u32 v71, v65, 8, v71
  v_lshl_add_u32 v103, v66, 3, v71
  v_add_u32 v67, 128, v73
  v_mul_u32_u24 v68, 5462, v67
  v_lshrrev_b32 v68, 16, v68
  v_mul_u32_u24 v69, 12, v68
  v_sub_u32 v69, v67, v69
  v_mov_b32 v70, 1
  v_and_b32 v71, 1, v69
  v_lshrrev_b32 v69, 1, v69
  v_lshl_add_u32 v69, v71, 3, v69
  v_lshlrev_b32 v71, 12, v70
  v_lshrrev_b32 v70, 1, v68
  v_lshl_add_u32 v71, v70, 9, v71
  v_and_b32 v70, 1, v68
  v_lshl_add_u32 v71, v70, 2, v71
  v_lshl_add_u32 v71, v69, 4, v71
  v_lshl_add_u32 v71, v65, 8, v71
  v_lshl_add_u32 v104, v66, 3, v71
  v_add_u32 v67, 144, v73
  v_mul_u32_u24 v68, 5462, v67
  v_lshrrev_b32 v68, 16, v68
  v_mul_u32_u24 v69, 12, v68
  v_sub_u32 v69, v67, v69
  v_mov_b32 v70, 1
  v_and_b32 v71, 1, v69
  v_lshrrev_b32 v69, 1, v69
  v_lshl_add_u32 v69, v71, 3, v69
  v_lshlrev_b32 v71, 12, v70
  v_lshrrev_b32 v70, 1, v68
  v_lshl_add_u32 v71, v70, 9, v71
  v_and_b32 v70, 1, v68
  v_lshl_add_u32 v71, v70, 2, v71
  v_lshl_add_u32 v71, v69, 4, v71
  v_lshl_add_u32 v71, v65, 8, v71
  v_lshl_add_u32 v105, v66, 3, v71
  v_add_u32 v67, 160, v73
  v_mul_u32_u24 v68, 5462, v67
  v_lshrrev_b32 v68, 16, v68
  v_mul_u32_u24 v69, 12, v68
  v_sub_u32 v69, v67, v69
  v_mov_b32 v70, 1
  v_and_b32 v71, 1, v69
  v_lshrrev_b32 v69, 1, v69
  v_lshl_add_u32 v69, v71, 3, v69
  v_lshlrev_b32 v71, 12, v70
  v_lshrrev_b32 v70, 1, v68
  v_lshl_add_u32 v71, v70, 9, v71
  v_and_b32 v70, 1, v68
  v_lshl_add_u32 v71, v70, 2, v71
  v_lshl_add_u32 v71, v69, 4, v71
  v_lshl_add_u32 v71, v65, 8, v71
  v_lshl_add_u32 v106, v66, 3, v71
  v_add_u32 v67, 176, v73
  v_mul_u32_u24 v68, 5462, v67
  v_lshrrev_b32 v68, 16, v68
  v_mul_u32_u24 v69, 12, v68
  v_sub_u32 v69, v67, v69
  v_mov_b32 v70, 1
  v_and_b32 v71, 1, v69
  v_lshrrev_b32 v69, 1, v69
  v_lshl_add_u32 v69, v71, 3, v69
  v_lshlrev_b32 v71, 12, v70
  v_lshrrev_b32 v70, 1, v68
  v_lshl_add_u32 v71, v70, 9, v71
  v_and_b32 v70, 1, v68
  v_lshl_add_u32 v71, v70, 2, v71
  v_lshl_add_u32 v71, v69, 4, v71
  v_lshl_add_u32 v71, v65, 8, v71
  v_lshl_add_u32 v107, v66, 3, v71
  s_mul_i32 s24, s17, 532480
  s_add_u32 s24, s24, 76943360
  s_mul_i32 s34, s17, 640
  s_add_u32 s34, s34, 88582148
  s_mul_i32 s36, s17, 448
  v_add_u32 v0, s36, v2
  v_add_u32 v0, 8192, v0
  s_add_u32 s36, s36, 88080384
  s_mov_b32 s37, 76939264
  v_cmp_gt_u32 s[26:27], 28, v1
  v_and_b32 v119, 31, v1
  v_lshlrev_b32 v119, 2, v119
  v_and_b32 v119, 0x78, v119
  v_or_b32 v119, 4, v119
  s_add_u32 s22, s17, 16
  s_and_b32 s22, s22, 15
  s_lshl_b32 s22, s22, 7
  s_add_u32 s22, s22, 18432
  v_add_u32 v119, s22, v119
  v_min_u32 v118, 13, v1
  s_mul_i32 s22, s17, 14
  v_add_u32 v118, s22, v118
  v_lshlrev_b32 v118, 7, v118
  v_add_u32 v118, 57344, v118
  s_mov_b32 s39, 71565312
  v_add_u32 v1, 59392, v2
  v_mov_b32 v117, 1
  s_mul_i32 s38, s17, 1104
  s_add_u32 s38, s38, 21504
  v_bfe_u32 v8, v2, 4, 1
  v_mul_u32_u24 v3, 0xaaaa, v8
  v_add_u32 v3, 0x4444, v3
  v_bfe_u32 v9, v2, 5, 3
  v_lshl_add_u32 v8, v8, 3, v9
  v_and_b32 v9, 0x300, v2
  v_lshl_add_u32 v5, v8, 4, v9
  s_getpc_b64 s[98:99]
cpf_23:
  s_add_u32 s98, s98, cA_va3_loop-cpf_23
  s_addc_u32 s99, s99, 0
  v_lshlrev_b32 v38, 2, v2
  global_load_dword v39, v38, s[98:99]
  s_lshl_b32 s22, 0, 11
  s_add_u32 s22, s22, 88606720
  v_add_u32 v36, 1024, v2
  v_min_u32 v36, 1776, v36
  s_mov_b32 s30, 0
va_iw7:
  buffer_load_dwordx4 v[40:43], v2, s[8:11], s22 offen sc1
  buffer_load_dwordx4 v[44:47], v36, s[8:11], s22 offen sc1
  s_waitcnt vmcnt(0)
  v_cmp_ne_u64 vcc, s[88:89], v[40:41]
  s_cbranch_vccnz va_iw7_no
  v_cmp_ne_u64 vcc, s[88:89], v[42:43]
  s_cbranch_vccnz va_iw7_no
  v_cmp_ne_u64 vcc, s[88:89], v[44:45]
  s_cbranch_vccnz va_iw7_no
  v_cmp_ne_u64 vcc, s[88:89], v[46:47]
  s_cbranch_vccnz va_iw7_no
  s_branch va_iw7_ok
va_iw7_no:
  s_sleep 2
  s_add_u32 s30, s30, 1
  s_cmp_lt_u32 s30, 50000
  s_cbranch_scc1 va_iw7
  s_branch cA_abort
va_iw7_ok:
  s_mov_b32 s30, 0
  v_mov_b32 v36, 0
ch_md7:
  buffer_load_dword v37, v36, s[12:15], 0 offen sc1
  s_waitcnt vmcnt(0)
  v_readfirstlane_b32 s22, v37
  s_and_b32 s31, s22, 0xffff
  s_cmp_ge_u32 s31, 32
  s_cbranch_scc1 ch_go7
  s_sleep 2
  s_add_u32 s30, s30, 1
  s_cmp_lt_u32 s30, 50000
  s_cbranch_scc1 ch_md7
  s_branch ch_end
ch_go7:
  s_mov_b32 s31, 0
  s_lshr_b32 s22, s22, 16
  s_cmp_lg_u32 s22, 0
  s_cbranch_scc1 cB_va3_loop
  s_branch cA_va3_loop
.p2align 6

cA_sc0_loop:
  s_add_u32 s23, s20, 4096
  s_add_u32 s21, s20, 20480
  s_mov_b32 s30, 0
  s_mov_b32 s62, 0
  buffer_load_dword v68, v0, s[8:11], s20 offen sc1
  v_mov_b32 v48, 0
  v_mov_b32 v49, 0
  v_mov_b32 v50, 0
  v_mov_b32 v51, 0
  v_mov_b32 v52, 0
  v_mov_b32 v53, 0
  v_mov_b32 v54, 0
  v_mov_b32 v55, 0
  buffer_load_dword v69, v0, s[8:11], s20 offen sc1
  v_mov_b32 v56, 0
  v_mov_b32 v57, 0
  v_mov_b32 v58, 0
  v_mov_b32 v59, 0
  v_mov_b32 v60, 0
  v_mov_b32 v61, 0
  v_mov_b32 v62, 0
  v_mov_b32 v63, 0
  buffer_load_dword v70, v0, s[8:11], s20 offen sc1
  v_mov_b32 v88, 0
  v_mov_b32 v89, 0
  v_mov_b32 v90, 0
  v_mov_b32 v91, 0
  v_mov_b32 v92, 0
  v_mov_b32 v93, 0
  v_mov_b32 v94, 0
  v_mov_b32 v95, 0
  buffer_load_dword v71, v0, s[8:11], s20 offen sc1
  v_mov_b32 v66, 0
  v_mov_b32 v67, 0
  buffer_load_dword v72, v0, s[8:11], s20 offen sc1
cA_sc0_fp_l:
  s_waitcnt vmcnt(4)
  v_cmp_eq_u32 vcc, -1, v68
  s_cbranch_vccz cA_sc0_fp_d
  buffer_load_dword v68, v0, s[8:11], s20 offen sc1
  s_waitcnt vmcnt(4)
  v_cmp_eq_u32 vcc, -1, v69
  s_cbranch_vccz cA_sc0_fp_d
  buffer_load_dword v69, v0, s[8:11], s20 offen sc1
  s_waitcnt vmcnt(4)
  v_cmp_eq_u32 vcc, -1, v70
  s_cbranch_vccz cA_sc0_fp_d
  buffer_load_dword v70, v0, s[8:11], s20 offen sc1
  s_waitcnt vmcnt(4)
  v_cmp_eq_u32 vcc, -1, v71
  s_cbranch_vccz cA_sc0_fp_d
  buffer_load_dword v71, v0, s[8:11], s20 offen sc1
  s_waitcnt vmcnt(4)
  v_cmp_eq_u32 vcc, -1, v72
  s_cbranch_vccz cA_sc0_fp_d
  buffer_load_dword v72, v0, s[8:11], s20 offen sc1
  s_add_u32 s30, s30, 1
  s_cmp_lt_u32 s30, 400000
  s_cbranch_scc1 cA_sc0_fp_l
  s_branch cA_abort
cA_sc0_fp_d:
  buffer_load_dwordx4 v[8:11], v2, s[8:11], s20 offen offset:0
  s_barrier
  s_branch cA_sc0_ld1
cA_sc0_ld:
  buffer_load_dwordx4 v[8:11], v2, s[8:11], s20 offen offset:0
cA_sc0_ld1:
  v_mov_b32 v36, 0
  v_mov_b32 v37, 0
  v_mov_b32 v38, 0
  v_mov_b32 v39, 0
  buffer_load_dwordx4 v[12:15], v2, s[8:11], s20 offen offset:1024
  v_mov_b32 v40, 0
  v_mov_b32 v41, 0
  v_mov_b32 v42, 0
  v_mov_b32 v43, 0
  buffer_load_dwordx4 v[16:19], v2, s[8:11], s20 offen offset:2048
  v_mov_b32 v44, 0
  v_mov_b32 v45, 0
  v_mov_b32 v46, 0
  v_mov_b32 v47, 0
  ds_read_b128 v[96:99], v117 offset:0
  ds_read_b128 v[100:103], v117 offset:1024
  ds_read_b128 v[104:107], v117 offset:14336
  ds_read_b128 v[108:111], v117 offset:15360
  s_waitcnt vmcnt(2)
  v_smfmac_f32_16x16x64_bf16 v[36:39], v[8:11], a[0:7], v3
  v_smfmac_f32_16x16x64_bf16 v[40:43], v[8:11], a[56:63], v3
  buffer_load_dwordx4 v[20:23], v2, s[8:11], s20 offen offset:3072
  v_smfmac_f32_16x16x64_bf16 v[44:47], v[8:11], a[112:119], v3
  v_smfmac_f32_16x16x64_bf16 v[48:51], v[8:11], a[168:175], v3
  v_smfmac_f32_16x16x64_bf16 v[52:55], v[8:11], a[224:231], v3
  buffer_load_dwordx4 v[24:27], v2, s[8:11], s23 offen offset:0
  v_smfmac_f32_16x16x64_bf16 v[56:59], v[8:11], v[144:151], v3
  v_smfmac_f32_16x16x64_bf16 v[60:63], v[8:11], v[200:207], v3
  s_waitcnt vmcnt(3)
  v_smfmac_f32_16x16x64_bf16 v[36:39], v[12:15], a[8:15], v3
  v_smfmac_f32_16x16x64_bf16 v[40:43], v[12:15], a[64:71], v3
  buffer_load_dwordx4 v[28:31], v2, s[8:11], s23 offen offset:1024
  v_smfmac_f32_16x16x64_bf16 v[44:47], v[12:15], a[120:127], v3
  v_smfmac_f32_16x16x64_bf16 v[48:51], v[12:15], a[176:183], v3
  v_smfmac_f32_16x16x64_bf16 v[52:55], v[12:15], a[232:239], v3
  buffer_load_dwordx4 v[32:35], v2, s[8:11], s23 offen offset:2048
  v_smfmac_f32_16x16x64_bf16 v[56:59], v[12:15], v[152:159], v3
  v_smfmac_f32_16x16x64_bf16 v[60:63], v[12:15], v[208:215], v3
  s_xor_b32 s58, s25, 28672
  s_add_u32 s59, s24, 28672
  s_add_u32 m0, s58, 0
  s_waitcnt vmcnt(4)
  v_smfmac_f32_16x16x64_bf16 v[36:39], v[16:19], a[16:23], v3
  buffer_load_dwordx4 v2, s[8:11], s59 offen offset:0 sc1 lds
  v_smfmac_f32_16x16x64_bf16 v[40:43], v[16:19], a[72:79], v3
  v_smfmac_f32_16x16x64_bf16 v[44:47], v[16:19], a[128:135], v3
  v_smfmac_f32_16x16x64_bf16 v[48:51], v[16:19], a[184:191], v3
  v_smfmac_f32_16x16x64_bf16 v[52:55], v[16:19], a[240:247], v3
  buffer_load_dwordx4 v2, s[8:11], s59 offen offset:1024 sc1 lds
  v_smfmac_f32_16x16x64_bf16 v[56:59], v[16:19], v[160:167], v3
  v_smfmac_f32_16x16x64_bf16 v[60:63], v[16:19], v[216:223], v3
  s_waitcnt vmcnt(5)
  v_smfmac_f32_16x16x64_bf16 v[36:39], v[20:23], a[24:31], v3
  v_smfmac_f32_16x16x64_bf16 v[40:43], v[20:23], a[80:87], v3
  buffer_load_dwordx4 v2, s[8:11], s59 offen offset:2048 sc1 lds
  v_smfmac_f32_16x16x64_bf16 v[44:47], v[20:23], a[136:143], v3
  v_smfmac_f32_16x16x64_bf16 v[48:51], v[20:23], a[192:199], v3
  v_smfmac_f32_16x16x64_bf16 v[52:55], v[20:23], a[248:255], v3
  v_smfmac_f32_16x16x64_bf16 v[56:59], v[20:23], v[168:175], v3
  buffer_load_dwordx4 v2, s[8:11], s59 offen offset:3072 sc1 lds
  v_smfmac_f32_16x16x64_bf16 v[60:63], v[20:23], v[224:231], v3
  s_waitcnt vmcnt(4)
cA_sc0_ph2:
  v_smfmac_f32_16x16x64_bf16 v[60:63], v[24:27], v[232:239], v3
  ds_read_b128 v[12:15], v116 offset:0
  ds_read_b128 v[16:19], v116 offset:1024
  v_smfmac_f32_16x16x64_bf16 v[60:63], v[28:31], v[240:247], v3
  v_smfmac_f32_16x16x64_bf16 v[60:63], v[32:35], v[248:255], v3
  v_mov_b32 v80, v24
  v_smfmac_f32_16x16x64_bf16 v[52:55], v[24:27], v[120:127], v3
  v_mov_b32 v81, v25
  v_smfmac_f32_16x16x64_bf16 v[52:55], v[28:31], v[128:135], v3
  v_mov_b32 v82, v32
  v_smfmac_f32_16x16x64_bf16 v[52:55], v[32:35], v[136:143], v3
  v_cvt_pk_bf16_f32 v64, v60, v61
  v_smfmac_f32_16x16x64_bf16 v[56:59], v[24:27], v[176:183], v3
  v_cvt_pk_bf16_f32 v65, v62, v63
  v_smfmac_f32_16x16x64_bf16 v[56:59], v[28:31], v[184:191], v3
  v_mov_b32 v83, v33
  v_mfma_f32_16x16x32_bf16 v[68:71], v[64:67], v[4:7], 0
  v_smfmac_f32_16x16x64_bf16 v[56:59], v[32:35], v[192:199], v3
  v_cvt_pk_bf16_f32 v64, v52, v53
  v_smfmac_f32_16x16x64_bf16 v[36:39], v[24:27], a[32:39], v3
  v_cvt_pk_bf16_f32 v65, v54, v55
  v_smfmac_f32_16x16x64_bf16 v[36:39], v[28:31], a[40:47], v3
  v_cvt_pk_bf16_f32 v78, v68, v69
  v_smfmac_f32_16x16x64_bf16 v[36:39], v[32:35], a[48:55], v3
  v_cvt_pk_bf16_f32 v79, v70, v71
  v_cvt_pk_bf16_f32 v66, v56, v57
  v_smfmac_f32_16x16x64_bf16 v[40:43], v[24:27], a[88:95], v3
  v_cvt_pk_bf16_f32 v67, v58, v59
  v_smfmac_f32_16x16x64_bf16 v[40:43], v[28:31], a[96:103], v3
  v_mfma_f32_16x16x32_bf16 v[72:75], v[64:67], v[4:7], 0
  ds_read_b128 v[52:55], v116 offset:14336
  ds_read_b128 v[56:59], v116 offset:15360
  v_smfmac_f32_16x16x64_bf16 v[40:43], v[32:35], a[104:111], v3
  v_cvt_pk_bf16_f32 v64, v36, v37
  v_smfmac_f32_16x16x64_bf16 v[44:47], v[24:27], a[144:151], v3
  v_cvt_pk_bf16_f32 v65, v38, v39
  v_smfmac_f32_16x16x64_bf16 v[44:47], v[28:31], a[152:159], v3
  v_cvt_pk_bf16_f32 v76, v72, v73
  v_smfmac_f32_16x16x64_bf16 v[44:47], v[32:35], a[160:167], v3
  v_cvt_pk_bf16_f32 v77, v74, v75
  v_cvt_pk_bf16_f32 v66, v40, v41
  v_smfmac_f32_16x16x64_bf16 v[48:51], v[24:27], a[200:207], v3
  v_cvt_pk_bf16_f32 v67, v42, v43
  v_smfmac_f32_16x16x64_bf16 v[48:51], v[28:31], a[208:215], v3
  v_mfma_f32_16x16x32_bf16 v[68:71], v[64:67], v[4:7], 0
  v_smfmac_f32_16x16x64_bf16 v[48:51], v[32:35], a[216:223], v3
  v_cvt_pk_bf16_f32 v64, v44, v45
  v_mfma_f32_16x16x32_bf16 v[84:87], v[80:83], v[76:79], 0
  v_cvt_pk_bf16_f32 v65, v46, v47
  s_waitcnt lgkmcnt(0)
  v_smfmac_f32_16x16x64_bf16 v[88:91], v[76:79], v[96:103], v118
  v_cvt_pk_bf16_f32 v60, v68, v69
  v_cvt_pk_bf16_f32 v61, v70, v71
  v_cvt_pk_bf16_f32 v66, v48, v49
  v_cvt_pk_bf16_f32 v67, v50, v51
  s_nop 1
  v_mfma_f32_16x16x32_bf16 v[72:75], v[64:67], v[4:7], 0
  v_smfmac_f32_16x16x64_bf16 v[92:95], v[76:79], v[104:111], v118
  s_nop 4
  v_cvt_pk_bf16_f32 v62, v72, v73
  v_cvt_pk_bf16_f32 v63, v74, v75
  s_nop 1
  v_mfma_f32_16x16x32_bf16 v[84:87], v[8:11], v[60:63], v[84:87]
  v_smfmac_f32_16x16x64_bf16 v[88:91], v[60:63], v[12:19], v118
  v_smfmac_f32_16x16x64_bf16 v[92:95], v[60:63], v[52:59], v118
  s_nop 1
  v_permlane32_swap_b32 v84, v86
  v_permlane32_swap_b32 v85, v87
  s_nop 0
  v_add_f32 v88, v88, v89
  v_add_f32_dpp v84, v86, v84 quad_perm:[1,0,3,2] row_mask:0xf bank_mask:0xf
  v_add_f32_dpp v85, v87, v85 quad_perm:[1,0,3,2] row_mask:0xf bank_mask:0xf
  v_add_f32 v89, v90, v91
  ds_write2_b32 v113, v84, v85 offset0:0 offset1:4
  ds_write2_b32 v112, v88, v89 offset0:0 offset1:128
  v_add_f32 v90, v92, v93
  v_add_f32 v91, v94, v95
  ds_write2_b32 v112, v90, v91 offset0:64 offset1:192
  v_cmp_u_f32 vcc, v88, v89
  s_cbranch_vccnz cA_sc0_retry
cA_sc0_cont:
  s_waitcnt lgkmcnt(0)
  s_barrier
  ds_read_b128 v[36:39], v114
  ds_read_b128 v[44:47], v115
  s_waitcnt lgkmcnt(0)
  v_add_f32 v36, v36, v38
  v_add_f32 v37, v37, v39
  v_add_f32 v44, v44, v45
  buffer_store_dword v2, v119, s[8:11], s20 offen
  v_add_f32 v46, v46, v47
  v_add_f32 v44, v44, v46
  v_add_f32 v36, v36, v37
  v_exp_f32 v49, v44
  v_exp_f32 v48, v36
  v_add_f32 v50, abs(v36), abs(v44)
  v_fma_f32 v39, v49, s37, v48
  v_cmp_ngt_f32 vcc, s56, v50
  v_cndmask_b32 v41, v48, v49, s[38:39]
  v_add_f32_dpp v39, v39, v39 quad_perm:[1,0,3,2] row_mask:0xf bank_mask:0xf
  v_cndmask_b32 v40, v49, v48, s[38:39]
  v_mov_b32_dpp v46, v41 quad_perm:[1,0,3,2] row_mask:0xf bank_mask:0xf
  v_add_f32_dpp v39, v39, v39 quad_perm:[2,3,0,1] row_mask:0xf bank_mask:0xf
  v_cndmask_b32 v42, v46, v40, s[38:39]
  v_cndmask_b32 v43, v40, v46, s[38:39]
  v_add_f32_dpp v39, v39, v39 row_half_mirror row_mask:0xf bank_mask:0xf
  s_cbranch_vccnz cA_sc0_slow
  s_nop 0
  v_add_f32_dpp v47, v39, v39 row_mirror row_mask:0xf bank_mask:0xf
  v_add_f32_dpp v39, v39, v39 row_mirror row_mask:0xf bank_mask:0xf
  s_nop 1
  v_permlane16_swap_b32 v39, v47
  v_add_f32 v39, v39, v47
  v_rcp_f32 v39, v39
  s_mov_b64 exec, s[28:29]
  v_mul_f32 v42, v42, v39
  v_mul_f32 v43, v43, v39
  v_cvt_pk_bf16_f32 v42, v42, v43
cA_sc0_pst:
  buffer_store_dword v42, v1, s[8:11], s20 offen
  s_mov_b64 exec, -1
  s_barrier
  s_cmp_lg_u32 s19, 0
  s_cbranch_scc1 cA_sc0_s0
  s_sub_u32 s36, s36, 64
  v_subrev_u32 v119, 64, v119
  v_lshl_add_u32 v56, v2, 3, s36
  s_mov_b64 exec, 15
  buffer_store_dword v2, v56, s[8:11], s20 offen
  s_mov_b64 exec, -1
cA_sc0_s0:
  s_add_u32 s24, s24, 28672
  s_add_u32 s35, s35, 28672
  s_xor_b32 s25, s25, 28672
  s_add_u32 m0, s25, 0
  s_add_u32 m0, s25, 4096
  s_add_u32 s22, s24, 4096
  buffer_load_dwordx4 v2, s[8:11], s22 offen offset:0 sc1 lds
  buffer_load_dwordx4 v2, s[8:11], s22 offen offset:1024 sc1 lds
  buffer_load_dwordx4 v2, s[8:11], s22 offen offset:2048 sc1 lds
  v_xor_b32 v116, 28672, v116
  v_add_u32 v117, s57, v117
  s_sub_u32 s57, 0, s57
  s_add_u32 s19, s19, 1
  s_mov_b32 s20, s21
  s_cmp_lt_u32 s19, 63
  s_cbranch_scc1 cA_sc0_loop
  s_branch cA_done
cA_sc0_slow:
  v_max_f32 v50, v36, v44
  s_nop 1
  v_max_f32_dpp v50, v50, v50 quad_perm:[1,0,3,2] row_mask:0xf bank_mask:0xf
  s_nop 1
  v_max_f32_dpp v50, v50, v50 quad_perm:[2,3,0,1] row_mask:0xf bank_mask:0xf
  s_nop 1
  v_max_f32_dpp v50, v50, v50 row_half_mirror row_mask:0xf bank_mask:0xf
  s_nop 1
  v_max_f32_dpp v50, v50, v50 row_mirror row_mask:0xf bank_mask:0xf
  v_mov_b32 v47, v50
  s_nop 1
  v_permlane16_swap_b32 v50, v47
  v_max_f32 v50, v50, v47
  v_sub_f32 v48, v36, v50
  v_sub_f32 v49, v44, v50
  v_exp_f32 v48, v48
  v_exp_f32 v49, v49
  s_add_u32 s31, s31, 0x100
  v_fma_f32 v39, v49, s37, v48
  v_cndmask_b32 v41, v48, v49, s[38:39]
  s_nop 0
  v_add_f32_dpp v39, v39, v39 quad_perm:[1,0,3,2] row_mask:0xf bank_mask:0xf
  v_cndmask_b32 v40, v49, v48, s[38:39]
  v_mov_b32_dpp v46, v41 quad_perm:[1,0,3,2] row_mask:0xf bank_mask:0xf
  v_add_f32_dpp v39, v39, v39 quad_perm:[2,3,0,1] row_mask:0xf bank_mask:0xf
  v_cndmask_b32 v42, v46, v40, s[38:39]
  v_cndmask_b32 v43, v40, v46, s[38:39]
  v_add_f32_dpp v39, v39, v39 row_half_mirror row_mask:0xf bank_mask:0xf
  s_nop 1
  v_add_f32_dpp v47, v39, v39 row_mirror row_mask:0xf bank_mask:0xf
  v_add_f32_dpp v39, v39, v39 row_mirror row_mask:0xf bank_mask:0xf
  s_nop 1
  v_permlane16_swap_b32 v39, v47
  v_add_f32 v39, v39, v47
  v_rcp_f32 v39, v39
  s_mov_b64 exec, s[28:29]
  v_mul_f32 v42, v42, v39
  v_mul_f32 v43, v43, v39
  v_cvt_pk_bf16_f32 v42, v42, v43
  v_min_u32 v42, -2, v42
  s_branch cA_sc0_pst
cA_sc0_retry:
  s_cmp_lg_u32 s62, 0
  s_cbranch_scc1 cA_sc0_cont
  s_waitcnt vmcnt(0) lgkmcnt(0)
cA_sc0_rv:
  buffer_load_dwordx4 v[8:11], v2, s[8:11], s20 offen offset:0 sc1
  buffer_load_dwordx4 v[12:15], v2, s[8:11], s20 offen offset:1024 sc1
  buffer_load_dwordx4 v[16:19], v2, s[8:11], s20 offen offset:2048 sc1
  buffer_load_dwordx4 v[20:23], v2, s[8:11], s20 offen offset:3072 sc1
  buffer_load_dwordx4 v[24:27], v2, s[8:11], s23 offen offset:0 sc1
  buffer_load_dwordx4 v[28:31], v2, s[8:11], s23 offen offset:1024 sc1
  buffer_load_dwordx4 v[32:35], v2, s[8:11], s23 offen offset:2048 sc1
  s_waitcnt vmcnt(0)
  v_max3_u32 v68, v8, v9, v10
  v_max3_u32 v68, v68, v11, v12
  v_max3_u32 v68, v68, v13, v14
  v_max3_u32 v68, v68, v15, v16
  v_max3_u32 v68, v68, v17, v18
  v_max3_u32 v68, v68, v19, v20
  v_max3_u32 v68, v68, v21, v22
  v_max3_u32 v68, v68, v23, v24
  v_max3_u32 v68, v68, v25, v26
  v_max3_u32 v68, v68, v27, v28
  v_max3_u32 v68, v68, v29, v30
  v_max3_u32 v68, v68, v31, v32
  v_max3_u32 v68, v68, v33, v34
  v_max_u32 v68, v68, v35
  v_cmp_eq_u32 vcc, -1, v68
  s_cbranch_vccz cA_sc0_rk
  s_add_u32 s30, s30, 1
  s_cmp_lt_u32 s30, 400000
  s_cbranch_scc1 cA_sc0_rv
  s_branch cA_abort
cA_sc0_rk:
  s_mov_b32 s62, 1
  v_mov_b32 v36, 0
  v_mov_b32 v37, 0
  v_mov_b32 v38, 0
  v_mov_b32 v39, 0
  v_mov_b32 v40, 0
  v_mov_b32 v41, 0
  v_mov_b32 v42, 0
  v_mov_b32 v43, 0
  v_mov_b32 v44, 0
  v_mov_b32 v45, 0
  v_mov_b32 v46, 0
  v_mov_b32 v47, 0
  v_mov_b32 v48, 0
  v_mov_b32 v49, 0
  v_mov_b32 v50, 0
  v_mov_b32 v51, 0
  v_mov_b32 v52, 0
  v_mov_b32 v53, 0
  v_mov_b32 v54, 0
  v_mov_b32 v55, 0
  v_mov_b32 v56, 0
  v_mov_b32 v57, 0
  v_mov_b32 v58, 0
  v_mov_b32 v59, 0
  v_mov_b32 v60, 0
  v_mov_b32 v61, 0
  v_mov_b32 v62, 0
  v_mov_b32 v63, 0
  v_mov_b32 v88, 0
  v_mov_b32 v89, 0
  v_mov_b32 v90, 0
  v_mov_b32 v91, 0
  v_mov_b32 v92, 0
  v_mov_b32 v93, 0
  v_mov_b32 v94, 0
  v_mov_b32 v95, 0
  v_mov_b32 v66, 0
  v_mov_b32 v67, 0
  s_add_u32 s31, s31, 1
  ds_read_b128 v[96:99], v117 offset:0
  ds_read_b128 v[100:103], v117 offset:1024
  ds_read_b128 v[104:107], v117 offset:14336
  ds_read_b128 v[108:111], v117 offset:15360
  v_smfmac_f32_16x16x64_bf16 v[36:39], v[8:11], a[0:7], v3
  v_smfmac_f32_16x16x64_bf16 v[40:43], v[8:11], a[56:63], v3
  v_smfmac_f32_16x16x64_bf16 v[44:47], v[8:11], a[112:119], v3
  v_smfmac_f32_16x16x64_bf16 v[48:51], v[8:11], a[168:175], v3
  v_smfmac_f32_16x16x64_bf16 v[52:55], v[8:11], a[224:231], v3
  v_smfmac_f32_16x16x64_bf16 v[56:59], v[8:11], v[144:151], v3
  v_smfmac_f32_16x16x64_bf16 v[60:63], v[8:11], v[200:207], v3
  v_smfmac_f32_16x16x64_bf16 v[36:39], v[12:15], a[8:15], v3
  v_smfmac_f32_16x16x64_bf16 v[40:43], v[12:15], a[64:71], v3
  v_smfmac_f32_16x16x64_bf16 v[44:47], v[12:15], a[120:127], v3
  v_smfmac_f32_16x16x64_bf16 v[48:51], v[12:15], a[176:183], v3
  v_smfmac_f32_16x16x64_bf16 v[52:55], v[12:15], a[232:239], v3
  v_smfmac_f32_16x16x64_bf16 v[56:59], v[12:15], v[152:159], v3
  v_smfmac_f32_16x16x64_bf16 v[60:63], v[12:15], v[208:215], v3
  v_smfmac_f32_16x16x64_bf16 v[36:39], v[16:19], a[16:23], v3
  v_smfmac_f32_16x16x64_bf16 v[40:43], v[16:19], a[72:79], v3
  v_smfmac_f32_16x16x64_bf16 v[44:47], v[16:19], a[128:135], v3
  v_smfmac_f32_16x16x64_bf16 v[48:51], v[16:19], a[184:191], v3
  v_smfmac_f32_16x16x64_bf16 v[52:55], v[16:19], a[240:247], v3
  v_smfmac_f32_16x16x64_bf16 v[56:59], v[16:19], v[160:167], v3
  v_smfmac_f32_16x16x64_bf16 v[60:63], v[16:19], v[216:223], v3
  v_smfmac_f32_16x16x64_bf16 v[36:39], v[20:23], a[24:31], v3
  v_smfmac_f32_16x16x64_bf16 v[40:43], v[20:23], a[80:87], v3
  v_smfmac_f32_16x16x64_bf16 v[44:47], v[20:23], a[136:143], v3
  v_smfmac_f32_16x16x64_bf16 v[48:51], v[20:23], a[192:199], v3
  v_smfmac_f32_16x16x64_bf16 v[52:55], v[20:23], a[248:255], v3
  v_smfmac_f32_16x16x64_bf16 v[56:59], v[20:23], v[168:175], v3
  v_smfmac_f32_16x16x64_bf16 v[60:63], v[20:23], v[224:231], v3
  s_xor_b32 s58, s25, 28672
  s_add_u32 s59, s24, 28672
  s_add_u32 m0, s58, 0
  s_branch cA_sc0_ph2
.p2align 6

cA_sc1_loop:
  s_add_u32 s23, s20, 4096
  s_add_u32 s21, s20, 20480
  s_mov_b32 s30, 0
  s_mov_b32 s62, 0
  s_waitcnt vmcnt(0)
  s_barrier
cA_sc1_ld:
  buffer_load_dwordx4 v[8:11], v2, s[8:11], s20 offen offset:0
  v_mov_b32 v36, 0
  v_mov_b32 v37, 0
  v_mov_b32 v38, 0
  v_mov_b32 v39, 0
  buffer_load_dwordx4 v[12:15], v2, s[8:11], s20 offen offset:1024
  v_mov_b32 v40, 0
  v_mov_b32 v41, 0
  v_mov_b32 v42, 0
  v_mov_b32 v43, 0
  buffer_load_dwordx4 v[16:19], v2, s[8:11], s20 offen offset:2048
  v_mov_b32 v44, 0
  v_mov_b32 v45, 0
  v_mov_b32 v46, 0
  v_mov_b32 v47, 0
  ds_read_b128 v[96:99], v117 offset:0
  ds_read_b128 v[100:103], v117 offset:1024
  ds_read_b128 v[104:107], v117 offset:14336
  ds_read_b128 v[108:111], v117 offset:15360
  s_waitcnt vmcnt(2)
  v_smfmac_f32_16x16x64_bf16 v[36:39], v[8:11], a[0:7], v3
  v_smfmac_f32_16x16x64_bf16 v[40:43], v[8:11], a[56:63], v3
  buffer_load_dwordx4 v[20:23], v2, s[8:11], s20 offen offset:3072
  v_smfmac_f32_16x16x64_bf16 v[44:47], v[8:11], a[112:119], v3
  v_smfmac_f32_16x16x64_bf16 v[48:51], v[8:11], a[168:175], v3
  v_smfmac_f32_16x16x64_bf16 v[52:55], v[8:11], a[224:231], v3
  buffer_load_dwordx4 v[24:27], v2, s[8:11], s23 offen offset:0
  v_smfmac_f32_16x16x64_bf16 v[56:59], v[8:11], v[144:151], v3
  v_smfmac_f32_16x16x64_bf16 v[60:63], v[8:11], v[200:207], v3
  s_waitcnt vmcnt(3)
  v_smfmac_f32_16x16x64_bf16 v[36:39], v[12:15], a[8:15], v3
  v_smfmac_f32_16x16x64_bf16 v[40:43], v[12:15], a[64:71], v3
  buffer_load_dwordx4 v[28:31], v2, s[8:11], s23 offen offset:1024
  v_smfmac_f32_16x16x64_bf16 v[44:47], v[12:15], a[120:127], v3
  v_smfmac_f32_16x16x64_bf16 v[48:51], v[12:15], a[176:183], v3
  v_smfmac_f32_16x16x64_bf16 v[52:55], v[12:15], a[232:239], v3
  buffer_load_dwordx4 v[32:35], v2, s[8:11], s23 offen offset:2048
  v_smfmac_f32_16x16x64_bf16 v[56:59], v[12:15], v[152:159], v3
  v_smfmac_f32_16x16x64_bf16 v[60:63], v[12:15], v[208:215], v3
  s_waitcnt vmcnt(4)
  v_smfmac_f32_16x16x64_bf16 v[36:39], v[16:19], a[16:23], v3
  s_xor_b32 s58, s25, 28672
  s_add_u32 s59, s24, 28672
  s_add_u32 m0, s58, 7168
  v_smfmac_f32_16x16x64_bf16 v[40:43], v[16:19], a[72:79], v3
  buffer_load_dwordx4 v2, s[8:11], s59 offen offset:0 sc1 lds
  v_smfmac_f32_16x16x64_bf16 v[44:47], v[16:19], a[128:135], v3
  v_smfmac_f32_16x16x64_bf16 v[48:51], v[16:19], a[184:191], v3
  v_smfmac_f32_16x16x64_bf16 v[52:55], v[16:19], a[240:247], v3
  v_smfmac_f32_16x16x64_bf16 v[56:59], v[16:19], v[160:167], v3
  buffer_load_dwordx4 v2, s[8:11], s59 offen offset:1024 sc1 lds
  v_smfmac_f32_16x16x64_bf16 v[60:63], v[16:19], v[216:223], v3
  s_waitcnt vmcnt(5)
  v_smfmac_f32_16x16x64_bf16 v[36:39], v[20:23], a[24:31], v3
  v_smfmac_f32_16x16x64_bf16 v[40:43], v[20:23], a[80:87], v3
  v_smfmac_f32_16x16x64_bf16 v[44:47], v[20:23], a[136:143], v3
  buffer_load_dwordx4 v2, s[8:11], s59 offen offset:2048 sc1 lds
  v_smfmac_f32_16x16x64_bf16 v[48:51], v[20:23], a[192:199], v3
  v_smfmac_f32_16x16x64_bf16 v[52:55], v[20:23], a[248:255], v3
  v_smfmac_f32_16x16x64_bf16 v[56:59], v[20:23], v[168:175], v3
  v_smfmac_f32_16x16x64_bf16 v[60:63], v[20:23], v[224:231], v3
  buffer_load_dwordx4 v2, s[8:11], s59 offen offset:3072 sc1 lds
  s_waitcnt vmcnt(4)
cA_sc1_ph2:
  v_smfmac_f32_16x16x64_bf16 v[60:63], v[24:27], v[232:239], v3
  ds_read_b128 v[16:19], v116 offset:2048
  ds_read_b128 v[20:23], v116 offset:3072
  v_smfmac_f32_16x16x64_bf16 v[60:63], v[28:31], v[240:247], v3
  buffer_load_dword v119, v0, s[8:11], s20 offen sc1
  v_smfmac_f32_16x16x64_bf16 v[60:63], v[32:35], v[248:255], v3
  v_mov_b32 v80, v26
  v_smfmac_f32_16x16x64_bf16 v[52:55], v[24:27], v[120:127], v3
  v_mov_b32 v81, v27
  v_smfmac_f32_16x16x64_bf16 v[52:55], v[28:31], v[128:135], v3
  v_mov_b32 v82, v32
  v_smfmac_f32_16x16x64_bf16 v[52:55], v[32:35], v[136:143], v3
  v_cvt_pk_bf16_f32 v66, v60, v61
  v_smfmac_f32_16x16x64_bf16 v[56:59], v[24:27], v[176:183], v3
  v_cvt_pk_bf16_f32 v67, v62, v63
  v_smfmac_f32_16x16x64_bf16 v[56:59], v[28:31], v[184:191], v3
  v_mov_b32 v83, v33
  v_mfma_f32_16x16x32_bf16 v[68:71], v[64:67], v[4:7], 0
  v_smfmac_f32_16x16x64_bf16 v[56:59], v[32:35], v[192:199], v3
  v_cvt_pk_bf16_f32 v64, v52, v53
  v_smfmac_f32_16x16x64_bf16 v[36:39], v[24:27], a[32:39], v3
  v_cvt_pk_bf16_f32 v65, v54, v55
  v_smfmac_f32_16x16x64_bf16 v[36:39], v[28:31], a[40:47], v3
  v_cvt_pk_bf16_f32 v78, v68, v69
  v_smfmac_f32_16x16x64_bf16 v[36:39], v[32:35], a[48:55], v3
  v_cvt_pk_bf16_f32 v79, v70, v71
  v_cvt_pk_bf16_f32 v66, v56, v57
  v_smfmac_f32_16x16x64_bf16 v[40:43], v[24:27], a[88:95], v3
  v_cvt_pk_bf16_f32 v67, v58, v59
  v_smfmac_f32_16x16x64_bf16 v[40:43], v[28:31], a[96:103], v3
  v_mfma_f32_16x16x32_bf16 v[72:75], v[64:67], v[4:7], 0
  ds_read_b128 v[52:55], v116 offset:16384
  ds_read_b128 v[56:59], v116 offset:17408
  v_smfmac_f32_16x16x64_bf16 v[40:43], v[32:35], a[104:111], v3
  v_cvt_pk_bf16_f32 v64, v36, v37
  v_smfmac_f32_16x16x64_bf16 v[44:47], v[24:27], a[144:151], v3
  v_cvt_pk_bf16_f32 v65, v38, v39
  v_smfmac_f32_16x16x64_bf16 v[44:47], v[28:31], a[152:159], v3
  v_cvt_pk_bf16_f32 v76, v72, v73
  v_smfmac_f32_16x16x64_bf16 v[44:47], v[32:35], a[160:167], v3
  v_cvt_pk_bf16_f32 v77, v74, v75
  v_cvt_pk_bf16_f32 v66, v40, v41
  v_smfmac_f32_16x16x64_bf16 v[48:51], v[24:27], a[200:207], v3
  v_cvt_pk_bf16_f32 v67, v42, v43
  v_smfmac_f32_16x16x64_bf16 v[48:51], v[28:31], a[208:215], v3
  v_mfma_f32_16x16x32_bf16 v[68:71], v[64:67], v[4:7], 0
  v_smfmac_f32_16x16x64_bf16 v[48:51], v[32:35], a[216:223], v3
  v_cvt_pk_bf16_f32 v64, v44, v45
  v_mfma_f32_16x16x32_bf16 v[84:87], v[80:83], v[76:79], 0
  v_cvt_pk_bf16_f32 v65, v46, v47
  s_waitcnt lgkmcnt(0)
  v_smfmac_f32_16x16x64_bf16 v[88:91], v[76:79], v[96:103], v118
  v_cvt_pk_bf16_f32 v60, v68, v69
  v_cvt_pk_bf16_f32 v61, v70, v71
  v_cvt_pk_bf16_f32 v66, v48, v49
  v_cvt_pk_bf16_f32 v67, v50, v51
  s_nop 1
  v_mfma_f32_16x16x32_bf16 v[72:75], v[64:67], v[4:7], 0
  v_smfmac_f32_16x16x64_bf16 v[92:95], v[76:79], v[104:111], v118
  s_nop 4
  v_cvt_pk_bf16_f32 v62, v72, v73
  v_cvt_pk_bf16_f32 v63, v74, v75
  s_nop 1
  v_mfma_f32_16x16x32_bf16 v[84:87], v[12:15], v[60:63], v[84:87]
  v_smfmac_f32_16x16x64_bf16 v[88:91], v[60:63], v[16:23], v118
  v_smfmac_f32_16x16x64_bf16 v[92:95], v[60:63], v[52:59], v118
  s_nop 1
  v_permlane32_swap_b32 v84, v86
  v_permlane32_swap_b32 v85, v87
  s_nop 0
  v_add_f32 v88, v88, v89
  v_add_f32_dpp v84, v86, v84 quad_perm:[1,0,3,2] row_mask:0xf bank_mask:0xf
  v_add_f32_dpp v85, v87, v85 quad_perm:[1,0,3,2] row_mask:0xf bank_mask:0xf
  v_add_f32 v89, v90, v91
  ds_write2_b32 v113, v84, v85 offset0:0 offset1:4
  ds_write2_b32 v112, v88, v89 offset0:0 offset1:128
  v_add_f32 v90, v92, v93
  v_add_f32 v91, v94, v95
  ds_write2_b32 v112, v90, v91 offset0:64 offset1:192
  v_cmp_u_f32 vcc, v88, v89
  s_cbranch_vccnz cA_sc1_retry
cA_sc1_cont:
  s_waitcnt lgkmcnt(0)
  s_barrier
  ds_read_b128 v[36:39], v114
  ds_read_b128 v[44:47], v115
  s_waitcnt lgkmcnt(0)
  v_add_f32 v36, v36, v38
  v_add_f32 v37, v37, v39
  v_add_f32 v44, v44, v45
  v_add_f32 v46, v46, v47
  v_add_f32 v44, v44, v46
  v_add_f32 v36, v36, v37
  v_exp_f32 v49, v44
  v_exp_f32 v48, v36
  v_add_f32 v50, abs(v36), abs(v44)
  v_fma_f32 v39, v49, s37, v48
  v_cmp_ngt_f32 vcc, s56, v50
  v_cndmask_b32 v41, v48, v49, s[38:39]
  v_add_f32_dpp v39, v39, v39 quad_perm:[1,0,3,2] row_mask:0xf bank_mask:0xf
  v_cndmask_b32 v40, v49, v48, s[38:39]
  v_mov_b32_dpp v46, v41 quad_perm:[1,0,3,2] row_mask:0xf bank_mask:0xf
  v_add_f32_dpp v39, v39, v39 quad_perm:[2,3,0,1] row_mask:0xf bank_mask:0xf
  v_cndmask_b32 v42, v46, v40, s[38:39]
  v_cndmask_b32 v43, v40, v46, s[38:39]
  v_add_f32_dpp v39, v39, v39 row_half_mirror row_mask:0xf bank_mask:0xf
  s_cbranch_vccnz cA_sc1_slow
  s_nop 0
  v_add_f32_dpp v47, v39, v39 row_mirror row_mask:0xf bank_mask:0xf
  v_add_f32_dpp v39, v39, v39 row_mirror row_mask:0xf bank_mask:0xf
  s_nop 1
  v_permlane16_swap_b32 v39, v47
  v_add_f32 v39, v39, v47
  v_rcp_f32 v39, v39
  s_mov_b64 exec, s[28:29]
  v_mul_f32 v42, v42, v39
  v_mul_f32 v43, v43, v39
  v_cvt_pk_bf16_f32 v42, v42, v43
cA_sc1_pst:
  buffer_store_dword v42, v1, s[8:11], s20 offen
  s_mov_b64 exec, -1
  s_barrier
  s_add_u32 s24, s24, 28672
  s_add_u32 s35, s35, 28672
  s_xor_b32 s25, s25, 28672
  s_add_u32 m0, s25, 7168
  s_add_u32 m0, s25, 11264
  s_add_u32 s22, s24, 4096
  buffer_load_dwordx4 v2, s[8:11], s22 offen offset:0 sc1 lds
  v_mov_b32 v48, 0
  v_mov_b32 v49, 0
  v_mov_b32 v50, 0
  v_mov_b32 v51, 0
  v_mov_b32 v52, 0
  v_mov_b32 v53, 0
  buffer_load_dwordx4 v2, s[8:11], s22 offen offset:1024 sc1 lds
  v_mov_b32 v54, 0
  v_mov_b32 v55, 0
  v_mov_b32 v56, 0
  v_mov_b32 v57, 0
  v_mov_b32 v58, 0
  v_mov_b32 v59, 0
  buffer_load_dwordx4 v2, s[8:11], s22 offen offset:2048 sc1 lds
  v_mov_b32 v60, 0
  v_mov_b32 v61, 0
  v_mov_b32 v62, 0
  v_mov_b32 v63, 0
  v_mov_b32 v88, 0
  v_mov_b32 v89, 0
  v_mov_b32 v90, 0
  v_mov_b32 v91, 0
  v_mov_b32 v92, 0
  v_mov_b32 v93, 0
  v_mov_b32 v94, 0
  v_mov_b32 v95, 0
  v_mov_b32 v64, 0
  v_mov_b32 v65, 0
  v_xor_b32 v116, 28672, v116
  v_add_u32 v117, s57, v117
  s_sub_u32 s57, 0, s57
  s_add_u32 s19, s19, 1
  s_mov_b32 s20, s21
  s_cmp_lt_u32 s19, 63
  s_cbranch_scc1 cA_sc1_loop
  s_branch cA_done
cA_sc1_slow:
  v_max_f32 v50, v36, v44
  s_nop 1
  v_max_f32_dpp v50, v50, v50 quad_perm:[1,0,3,2] row_mask:0xf bank_mask:0xf
  s_nop 1
  v_max_f32_dpp v50, v50, v50 quad_perm:[2,3,0,1] row_mask:0xf bank_mask:0xf
  s_nop 1
  v_max_f32_dpp v50, v50, v50 row_half_mirror row_mask:0xf bank_mask:0xf
  s_nop 1
  v_max_f32_dpp v50, v50, v50 row_mirror row_mask:0xf bank_mask:0xf
  v_mov_b32 v47, v50
  s_nop 1
  v_permlane16_swap_b32 v50, v47
  v_max_f32 v50, v50, v47
  v_sub_f32 v48, v36, v50
  v_sub_f32 v49, v44, v50
  v_exp_f32 v48, v48
  v_exp_f32 v49, v49
  s_add_u32 s31, s31, 0x100
  v_fma_f32 v39, v49, s37, v48
  v_cndmask_b32 v41, v48, v49, s[38:39]
  s_nop 0
  v_add_f32_dpp v39, v39, v39 quad_perm:[1,0,3,2] row_mask:0xf bank_mask:0xf
  v_cndmask_b32 v40, v49, v48, s[38:39]
  v_mov_b32_dpp v46, v41 quad_perm:[1,0,3,2] row_mask:0xf bank_mask:0xf
  v_add_f32_dpp v39, v39, v39 quad_perm:[2,3,0,1] row_mask:0xf bank_mask:0xf
  v_cndmask_b32 v42, v46, v40, s[38:39]
  v_cndmask_b32 v43, v40, v46, s[38:39]
  v_add_f32_dpp v39, v39, v39 row_half_mirror row_mask:0xf bank_mask:0xf
  s_nop 1
  v_add_f32_dpp v47, v39, v39 row_mirror row_mask:0xf bank_mask:0xf
  v_add_f32_dpp v39, v39, v39 row_mirror row_mask:0xf bank_mask:0xf
  s_nop 1
  v_permlane16_swap_b32 v39, v47
  v_add_f32 v39, v39, v47
  v_rcp_f32 v39, v39
  s_mov_b64 exec, s[28:29]
  v_mul_f32 v42, v42, v39
  v_mul_f32 v43, v43, v39
  v_cvt_pk_bf16_f32 v42, v42, v43
  v_min_u32 v42, -2, v42
  s_branch cA_sc1_pst
cA_sc1_retry:
  s_cmp_lg_u32 s62, 0
  s_cbranch_scc1 cA_sc1_cont
  s_waitcnt vmcnt(0) lgkmcnt(0)
cA_sc1_rv:
  buffer_load_dwordx4 v[8:11], v2, s[8:11], s20 offen offset:0 sc1
  buffer_load_dwordx4 v[12:15], v2, s[8:11], s20 offen offset:1024 sc1
  buffer_load_dwordx4 v[16:19], v2, s[8:11], s20 offen offset:2048 sc1
  buffer_load_dwordx4 v[20:23], v2, s[8:11], s20 offen offset:3072 sc1
  buffer_load_dwordx4 v[24:27], v2, s[8:11], s23 offen offset:0 sc1
  buffer_load_dwordx4 v[28:31], v2, s[8:11], s23 offen offset:1024 sc1
  buffer_load_dwordx4 v[32:35], v2, s[8:11], s23 offen offset:2048 sc1
  s_waitcnt vmcnt(0)
  v_max3_u32 v68, v8, v9, v10
  v_max3_u32 v68, v68, v11, v12
  v_max3_u32 v68, v68, v13, v14
  v_max3_u32 v68, v68, v15, v16
  v_max3_u32 v68, v68, v17, v18
  v_max3_u32 v68, v68, v19, v20
  v_max3_u32 v68, v68, v21, v22
  v_max3_u32 v68, v68, v23, v24
  v_max3_u32 v68, v68, v25, v26
  v_max3_u32 v68, v68, v27, v28
  v_max3_u32 v68, v68, v29, v30
  v_max3_u32 v68, v68, v31, v32
  v_max3_u32 v68, v68, v33, v34
  v_max_u32 v68, v68, v35
  v_cmp_eq_u32 vcc, -1, v68
  s_cbranch_vccz cA_sc1_rk
  s_add_u32 s30, s30, 1
  s_cmp_lt_u32 s30, 400000
  s_cbranch_scc1 cA_sc1_rv
  s_branch cA_abort
cA_sc1_rk:
  s_mov_b32 s62, 1
  v_mov_b32 v36, 0
  v_mov_b32 v37, 0
  v_mov_b32 v38, 0
  v_mov_b32 v39, 0
  v_mov_b32 v40, 0
  v_mov_b32 v41, 0
  v_mov_b32 v42, 0
  v_mov_b32 v43, 0
  v_mov_b32 v44, 0
  v_mov_b32 v45, 0
  v_mov_b32 v46, 0
  v_mov_b32 v47, 0
  v_mov_b32 v48, 0
  v_mov_b32 v49, 0
  v_mov_b32 v50, 0
  v_mov_b32 v51, 0
  v_mov_b32 v52, 0
  v_mov_b32 v53, 0
  v_mov_b32 v54, 0
  v_mov_b32 v55, 0
  v_mov_b32 v56, 0
  v_mov_b32 v57, 0
  v_mov_b32 v58, 0
  v_mov_b32 v59, 0
  v_mov_b32 v60, 0
  v_mov_b32 v61, 0
  v_mov_b32 v62, 0
  v_mov_b32 v63, 0
  v_mov_b32 v88, 0
  v_mov_b32 v89, 0
  v_mov_b32 v90, 0
  v_mov_b32 v91, 0
  v_mov_b32 v92, 0
  v_mov_b32 v93, 0
  v_mov_b32 v94, 0
  v_mov_b32 v95, 0
  v_mov_b32 v64, 0
  v_mov_b32 v65, 0
  s_add_u32 s31, s31, 1
  ds_read_b128 v[96:99], v117 offset:0
  ds_read_b128 v[100:103], v117 offset:1024
  ds_read_b128 v[104:107], v117 offset:14336
  ds_read_b128 v[108:111], v117 offset:15360
  v_smfmac_f32_16x16x64_bf16 v[36:39], v[8:11], a[0:7], v3
  v_smfmac_f32_16x16x64_bf16 v[40:43], v[8:11], a[56:63], v3
  v_smfmac_f32_16x16x64_bf16 v[44:47], v[8:11], a[112:119], v3
  v_smfmac_f32_16x16x64_bf16 v[48:51], v[8:11], a[168:175], v3
  v_smfmac_f32_16x16x64_bf16 v[52:55], v[8:11], a[224:231], v3
  v_smfmac_f32_16x16x64_bf16 v[56:59], v[8:11], v[144:151], v3
  v_smfmac_f32_16x16x64_bf16 v[60:63], v[8:11], v[200:207], v3
  v_smfmac_f32_16x16x64_bf16 v[36:39], v[12:15], a[8:15], v3
  v_smfmac_f32_16x16x64_bf16 v[40:43], v[12:15], a[64:71], v3
  v_smfmac_f32_16x16x64_bf16 v[44:47], v[12:15], a[120:127], v3
  v_smfmac_f32_16x16x64_bf16 v[48:51], v[12:15], a[176:183], v3
  v_smfmac_f32_16x16x64_bf16 v[52:55], v[12:15], a[232:239], v3
  v_smfmac_f32_16x16x64_bf16 v[56:59], v[12:15], v[152:159], v3
  v_smfmac_f32_16x16x64_bf16 v[60:63], v[12:15], v[208:215], v3
  v_smfmac_f32_16x16x64_bf16 v[36:39], v[16:19], a[16:23], v3
  v_smfmac_f32_16x16x64_bf16 v[40:43], v[16:19], a[72:79], v3
  v_smfmac_f32_16x16x64_bf16 v[44:47], v[16:19], a[128:135], v3
  v_smfmac_f32_16x16x64_bf16 v[48:51], v[16:19], a[184:191], v3
  v_smfmac_f32_16x16x64_bf16 v[52:55], v[16:19], a[240:247], v3
  v_smfmac_f32_16x16x64_bf16 v[56:59], v[16:19], v[160:167], v3
  v_smfmac_f32_16x16x64_bf16 v[60:63], v[16:19], v[216:223], v3
  v_smfmac_f32_16x16x64_bf16 v[36:39], v[20:23], a[24:31], v3
  v_smfmac_f32_16x16x64_bf16 v[40:43], v[20:23], a[80:87], v3
  v_smfmac_f32_16x16x64_bf16 v[44:47], v[20:23], a[136:143], v3
  v_smfmac_f32_16x16x64_bf16 v[48:51], v[20:23], a[192:199], v3
  v_smfmac_f32_16x16x64_bf16 v[52:55], v[20:23], a[248:255], v3
  v_smfmac_f32_16x16x64_bf16 v[56:59], v[20:23], v[168:175], v3
  v_smfmac_f32_16x16x64_bf16 v[60:63], v[20:23], v[224:231], v3
  s_xor_b32 s58, s25, 28672
  s_add_u32 s59, s24, 28672
  s_add_u32 m0, s58, 7168
  s_branch cA_sc1_ph2
.p2align 6

cA_sc2_loop:
  s_add_u32 s23, s20, 4096
  s_add_u32 s21, s20, 20480
  s_mov_b32 s30, 0
  s_mov_b32 s62, 0
  s_waitcnt vmcnt(0)
  s_barrier
cA_sc2_ld:
  buffer_load_dwordx4 v[8:11], v2, s[8:11], s20 offen offset:0
  v_mov_b32 v36, 0
  v_mov_b32 v37, 0
  v_mov_b32 v38, 0
  v_mov_b32 v39, 0
  buffer_load_dwordx4 v[12:15], v2, s[8:11], s20 offen offset:1024
  v_mov_b32 v40, 0
  v_mov_b32 v41, 0
  v_mov_b32 v42, 0
  v_mov_b32 v43, 0
  buffer_load_dwordx4 v[16:19], v2, s[8:11], s20 offen offset:2048
  v_mov_b32 v44, 0
  v_mov_b32 v45, 0
  v_mov_b32 v46, 0
  v_mov_b32 v47, 0
  ds_read_b128 v[96:99], v117 offset:0
  ds_read_b128 v[100:103], v117 offset:1024
  ds_read_b128 v[104:107], v117 offset:14336
  ds_read_b128 v[108:111], v117 offset:15360
  s_waitcnt vmcnt(2)
  v_smfmac_f32_16x16x64_bf16 v[36:39], v[8:11], a[0:7], v3
  v_smfmac_f32_16x16x64_bf16 v[40:43], v[8:11], a[56:63], v3
  buffer_load_dwordx4 v[20:23], v2, s[8:11], s20 offen offset:3072
  v_smfmac_f32_16x16x64_bf16 v[44:47], v[8:11], a[112:119], v3
  v_smfmac_f32_16x16x64_bf16 v[48:51], v[8:11], a[168:175], v3
  v_smfmac_f32_16x16x64_bf16 v[52:55], v[8:11], a[224:231], v3
  buffer_load_dwordx4 v[24:27], v2, s[8:11], s23 offen offset:0
  v_smfmac_f32_16x16x64_bf16 v[56:59], v[8:11], v[144:151], v3
  v_smfmac_f32_16x16x64_bf16 v[60:63], v[8:11], v[200:207], v3
  s_waitcnt vmcnt(3)
  v_smfmac_f32_16x16x64_bf16 v[36:39], v[12:15], a[8:15], v3
  v_smfmac_f32_16x16x64_bf16 v[40:43], v[12:15], a[64:71], v3
  buffer_load_dwordx4 v[28:31], v2, s[8:11], s23 offen offset:1024
  v_smfmac_f32_16x16x64_bf16 v[44:47], v[12:15], a[120:127], v3
  v_smfmac_f32_16x16x64_bf16 v[48:51], v[12:15], a[176:183], v3
  v_smfmac_f32_16x16x64_bf16 v[52:55], v[12:15], a[232:239], v3
  buffer_load_dwordx4 v[32:35], v2, s[8:11], s23 offen offset:2048
  v_smfmac_f32_16x16x64_bf16 v[56:59], v[12:15], v[152:159], v3
  v_smfmac_f32_16x16x64_bf16 v[60:63], v[12:15], v[208:215], v3
  s_waitcnt vmcnt(4)
  v_smfmac_f32_16x16x64_bf16 v[36:39], v[16:19], a[16:23], v3
  v_smfmac_f32_16x16x64_bf16 v[40:43], v[16:19], a[72:79], v3
  s_xor_b32 s58, s25, 28672
  s_add_u32 s59, s24, 28672
  s_add_u32 m0, s58, 14336
  v_smfmac_f32_16x16x64_bf16 v[44:47], v[16:19], a[128:135], v3
  buffer_load_dwordx4 v2, s[8:11], s59 offen offset:0 sc1 lds
  v_smfmac_f32_16x16x64_bf16 v[48:51], v[16:19], a[184:191], v3
  v_smfmac_f32_16x16x64_bf16 v[52:55], v[16:19], a[240:247], v3
  v_smfmac_f32_16x16x64_bf16 v[56:59], v[16:19], v[160:167], v3
  v_smfmac_f32_16x16x64_bf16 v[60:63], v[16:19], v[216:223], v3
  buffer_load_dwordx4 v2, s[8:11], s59 offen offset:1024 sc1 lds
  s_waitcnt vmcnt(5)
  v_smfmac_f32_16x16x64_bf16 v[36:39], v[20:23], a[24:31], v3
  v_smfmac_f32_16x16x64_bf16 v[40:43], v[20:23], a[80:87], v3
  v_smfmac_f32_16x16x64_bf16 v[44:47], v[20:23], a[136:143], v3
  v_smfmac_f32_16x16x64_bf16 v[48:51], v[20:23], a[192:199], v3
  buffer_load_dwordx4 v2, s[8:11], s59 offen offset:2048 sc1 lds
  v_smfmac_f32_16x16x64_bf16 v[52:55], v[20:23], a[248:255], v3
  v_smfmac_f32_16x16x64_bf16 v[56:59], v[20:23], v[168:175], v3
  v_smfmac_f32_16x16x64_bf16 v[60:63], v[20:23], v[224:231], v3
  s_waitcnt vmcnt(3)
cA_sc2_ph2:
  v_smfmac_f32_16x16x64_bf16 v[60:63], v[24:27], v[232:239], v3
  buffer_load_dwordx4 v2, s[8:11], s59 offen offset:3072 sc1 lds
  ds_read_b128 v[8:11], v116 offset:4096
  ds_read_b128 v[12:15], v116 offset:5120
  v_smfmac_f32_16x16x64_bf16 v[60:63], v[28:31], v[240:247], v3
  buffer_load_dword v119, v0, s[8:11], s24 offen sc1
  v_smfmac_f32_16x16x64_bf16 v[60:63], v[32:35], v[248:255], v3
  v_mov_b32 v80, v28
  v_smfmac_f32_16x16x64_bf16 v[52:55], v[24:27], v[120:127], v3
  v_mov_b32 v81, v29
  v_smfmac_f32_16x16x64_bf16 v[52:55], v[28:31], v[128:135], v3
  v_mov_b32 v82, v34
  v_smfmac_f32_16x16x64_bf16 v[52:55], v[32:35], v[136:143], v3
  v_cvt_pk_bf16_f32 v64, v60, v61
  v_smfmac_f32_16x16x64_bf16 v[56:59], v[24:27], v[176:183], v3
  v_cvt_pk_bf16_f32 v65, v62, v63
  v_smfmac_f32_16x16x64_bf16 v[56:59], v[28:31], v[184:191], v3
  v_mov_b32 v83, v35
  v_mfma_f32_16x16x32_bf16 v[68:71], v[64:67], v[4:7], 0
  v_smfmac_f32_16x16x64_bf16 v[56:59], v[32:35], v[192:199], v3
  v_cvt_pk_bf16_f32 v64, v52, v53
  v_smfmac_f32_16x16x64_bf16 v[36:39], v[24:27], a[32:39], v3
  v_cvt_pk_bf16_f32 v65, v54, v55
  v_smfmac_f32_16x16x64_bf16 v[36:39], v[28:31], a[40:47], v3
  v_cvt_pk_bf16_f32 v78, v68, v69
  v_smfmac_f32_16x16x64_bf16 v[36:39], v[32:35], a[48:55], v3
  v_cvt_pk_bf16_f32 v79, v70, v71
  v_cvt_pk_bf16_f32 v66, v56, v57
  v_smfmac_f32_16x16x64_bf16 v[40:43], v[24:27], a[88:95], v3
  v_cvt_pk_bf16_f32 v67, v58, v59
  v_smfmac_f32_16x16x64_bf16 v[40:43], v[28:31], a[96:103], v3
  v_mfma_f32_16x16x32_bf16 v[72:75], v[64:67], v[4:7], 0
  ds_read_b128 v[52:55], v116 offset:18432
  ds_read_b128 v[56:59], v116 offset:19456
  v_smfmac_f32_16x16x64_bf16 v[40:43], v[32:35], a[104:111], v3
  v_cvt_pk_bf16_f32 v64, v36, v37
  v_smfmac_f32_16x16x64_bf16 v[44:47], v[24:27], a[144:151], v3
  v_cvt_pk_bf16_f32 v65, v38, v39
  v_smfmac_f32_16x16x64_bf16 v[44:47], v[28:31], a[152:159], v3
  v_cvt_pk_bf16_f32 v76, v72, v73
  v_smfmac_f32_16x16x64_bf16 v[44:47], v[32:35], a[160:167], v3
  v_cvt_pk_bf16_f32 v77, v74, v75
  v_cvt_pk_bf16_f32 v66, v40, v41
  v_smfmac_f32_16x16x64_bf16 v[48:51], v[24:27], a[200:207], v3
  v_cvt_pk_bf16_f32 v67, v42, v43
  v_smfmac_f32_16x16x64_bf16 v[48:51], v[28:31], a[208:215], v3
  v_mfma_f32_16x16x32_bf16 v[68:71], v[64:67], v[4:7], 0
  v_smfmac_f32_16x16x64_bf16 v[48:51], v[32:35], a[216:223], v3
  v_cvt_pk_bf16_f32 v64, v44, v45
  v_mfma_f32_16x16x32_bf16 v[84:87], v[80:83], v[76:79], 0
  v_cvt_pk_bf16_f32 v65, v46, v47
  s_waitcnt lgkmcnt(0)
  v_smfmac_f32_16x16x64_bf16 v[88:91], v[76:79], v[96:103], v118
  v_cvt_pk_bf16_f32 v60, v68, v69
  v_cvt_pk_bf16_f32 v61, v70, v71
  v_cvt_pk_bf16_f32 v66, v48, v49
  v_cvt_pk_bf16_f32 v67, v50, v51
  s_nop 1
  v_mfma_f32_16x16x32_bf16 v[72:75], v[64:67], v[4:7], 0
  v_smfmac_f32_16x16x64_bf16 v[92:95], v[76:79], v[104:111], v118
  s_nop 4
  v_cvt_pk_bf16_f32 v62, v72, v73
  v_cvt_pk_bf16_f32 v63, v74, v75
  s_nop 1
  v_mfma_f32_16x16x32_bf16 v[84:87], v[16:19], v[60:63], v[84:87]
  v_smfmac_f32_16x16x64_bf16 v[88:91], v[60:63], v[8:15], v118
  v_smfmac_f32_16x16x64_bf16 v[92:95], v[60:63], v[52:59], v118
  s_nop 1
  v_permlane32_swap_b32 v84, v86
  v_permlane32_swap_b32 v85, v87
  s_nop 0
  v_add_f32 v88, v88, v89
  v_add_f32_dpp v84, v86, v84 quad_perm:[1,0,3,2] row_mask:0xf bank_mask:0xf
  v_add_f32_dpp v85, v87, v85 quad_perm:[1,0,3,2] row_mask:0xf bank_mask:0xf
  v_add_f32 v89, v90, v91
  ds_write2_b32 v113, v84, v85 offset0:0 offset1:4
  ds_write2_b32 v112, v88, v89 offset0:0 offset1:128
  v_add_f32 v90, v92, v93
  v_add_f32 v91, v94, v95
  ds_write2_b32 v112, v90, v91 offset0:64 offset1:192
  v_cmp_u_f32 vcc, v88, v89
  s_cbranch_vccnz cA_sc2_retry
cA_sc2_cont:
  s_waitcnt lgkmcnt(0)
  s_barrier
  ds_read_b128 v[36:39], v114
  ds_read_b128 v[44:47], v115
  s_waitcnt lgkmcnt(0)
  v_add_f32 v36, v36, v38
  v_add_f32 v37, v37, v39
  v_add_f32 v44, v44, v45
  v_add_f32 v46, v46, v47
  v_add_f32 v44, v44, v46
  v_add_f32 v36, v36, v37
  v_exp_f32 v49, v44
  v_exp_f32 v48, v36
  v_add_f32 v50, abs(v36), abs(v44)
  v_fma_f32 v39, v49, s37, v48
  v_cmp_ngt_f32 vcc, s56, v50
  v_cndmask_b32 v41, v48, v49, s[38:39]
  v_add_f32_dpp v39, v39, v39 quad_perm:[1,0,3,2] row_mask:0xf bank_mask:0xf
  v_cndmask_b32 v40, v49, v48, s[38:39]
  v_mov_b32_dpp v46, v41 quad_perm:[1,0,3,2] row_mask:0xf bank_mask:0xf
  v_add_f32_dpp v39, v39, v39 quad_perm:[2,3,0,1] row_mask:0xf bank_mask:0xf
  v_cndmask_b32 v42, v46, v40, s[38:39]
  v_cndmask_b32 v43, v40, v46, s[38:39]
  v_add_f32_dpp v39, v39, v39 row_half_mirror row_mask:0xf bank_mask:0xf
  s_cbranch_vccnz cA_sc2_slow
  s_nop 0
  v_add_f32_dpp v47, v39, v39 row_mirror row_mask:0xf bank_mask:0xf
  v_add_f32_dpp v39, v39, v39 row_mirror row_mask:0xf bank_mask:0xf
  s_nop 1
  v_permlane16_swap_b32 v39, v47
  v_add_f32 v39, v39, v47
  v_rcp_f32 v39, v39
  s_mov_b64 exec, s[28:29]
  v_mul_f32 v42, v42, v39
  v_mul_f32 v43, v43, v39
  v_cvt_pk_bf16_f32 v42, v42, v43
cA_sc2_pst:
  buffer_store_dword v42, v1, s[8:11], s20 offen
  s_mov_b64 exec, -1
  s_barrier
  s_add_u32 s24, s24, 28672
  s_add_u32 s35, s35, 28672
  s_xor_b32 s25, s25, 28672
  s_add_u32 m0, s25, 14336
  s_add_u32 m0, s25, 18432
  s_add_u32 s22, s24, 4096
  buffer_load_dwordx4 v2, s[8:11], s22 offen offset:0 sc1 lds
  v_mov_b32 v48, 0
  v_mov_b32 v49, 0
  v_mov_b32 v50, 0
  v_mov_b32 v51, 0
  v_mov_b32 v52, 0
  v_mov_b32 v53, 0
  buffer_load_dwordx4 v2, s[8:11], s22 offen offset:1024 sc1 lds
  v_mov_b32 v54, 0
  v_mov_b32 v55, 0
  v_mov_b32 v56, 0
  v_mov_b32 v57, 0
  v_mov_b32 v58, 0
  v_mov_b32 v59, 0
  buffer_load_dwordx4 v2, s[8:11], s22 offen offset:2048 sc1 lds
  v_mov_b32 v60, 0
  v_mov_b32 v61, 0
  v_mov_b32 v62, 0
  v_mov_b32 v63, 0
  v_mov_b32 v88, 0
  v_mov_b32 v89, 0
  v_mov_b32 v90, 0
  v_mov_b32 v91, 0
  v_mov_b32 v92, 0
  v_mov_b32 v93, 0
  v_mov_b32 v94, 0
  v_mov_b32 v95, 0
  v_mov_b32 v66, 0
  v_mov_b32 v67, 0
  v_xor_b32 v116, 28672, v116
  v_add_u32 v117, s57, v117
  s_sub_u32 s57, 0, s57
  s_add_u32 s19, s19, 1
  s_mov_b32 s20, s21
  s_cmp_lt_u32 s19, 63
  s_cbranch_scc1 cA_sc2_loop
  s_branch cA_done
cA_sc2_slow:
  v_max_f32 v50, v36, v44
  s_nop 1
  v_max_f32_dpp v50, v50, v50 quad_perm:[1,0,3,2] row_mask:0xf bank_mask:0xf
  s_nop 1
  v_max_f32_dpp v50, v50, v50 quad_perm:[2,3,0,1] row_mask:0xf bank_mask:0xf
  s_nop 1
  v_max_f32_dpp v50, v50, v50 row_half_mirror row_mask:0xf bank_mask:0xf
  s_nop 1
  v_max_f32_dpp v50, v50, v50 row_mirror row_mask:0xf bank_mask:0xf
  v_mov_b32 v47, v50
  s_nop 1
  v_permlane16_swap_b32 v50, v47
  v_max_f32 v50, v50, v47
  v_sub_f32 v48, v36, v50
  v_sub_f32 v49, v44, v50
  v_exp_f32 v48, v48
  v_exp_f32 v49, v49
  s_add_u32 s31, s31, 0x100
  v_fma_f32 v39, v49, s37, v48
  v_cndmask_b32 v41, v48, v49, s[38:39]
  s_nop 0
  v_add_f32_dpp v39, v39, v39 quad_perm:[1,0,3,2] row_mask:0xf bank_mask:0xf
  v_cndmask_b32 v40, v49, v48, s[38:39]
  v_mov_b32_dpp v46, v41 quad_perm:[1,0,3,2] row_mask:0xf bank_mask:0xf
  v_add_f32_dpp v39, v39, v39 quad_perm:[2,3,0,1] row_mask:0xf bank_mask:0xf
  v_cndmask_b32 v42, v46, v40, s[38:39]
  v_cndmask_b32 v43, v40, v46, s[38:39]
  v_add_f32_dpp v39, v39, v39 row_half_mirror row_mask:0xf bank_mask:0xf
  s_nop 1
  v_add_f32_dpp v47, v39, v39 row_mirror row_mask:0xf bank_mask:0xf
  v_add_f32_dpp v39, v39, v39 row_mirror row_mask:0xf bank_mask:0xf
  s_nop 1
  v_permlane16_swap_b32 v39, v47
  v_add_f32 v39, v39, v47
  v_rcp_f32 v39, v39
  s_mov_b64 exec, s[28:29]
  v_mul_f32 v42, v42, v39
  v_mul_f32 v43, v43, v39
  v_cvt_pk_bf16_f32 v42, v42, v43
  v_min_u32 v42, -2, v42
  s_branch cA_sc2_pst
cA_sc2_retry:
  s_cmp_lg_u32 s62, 0
  s_cbranch_scc1 cA_sc2_cont
  s_waitcnt vmcnt(0) lgkmcnt(0)
cA_sc2_rv:
  buffer_load_dwordx4 v[8:11], v2, s[8:11], s20 offen offset:0 sc1
  buffer_load_dwordx4 v[12:15], v2, s[8:11], s20 offen offset:1024 sc1
  buffer_load_dwordx4 v[16:19], v2, s[8:11], s20 offen offset:2048 sc1
  buffer_load_dwordx4 v[20:23], v2, s[8:11], s20 offen offset:3072 sc1
  buffer_load_dwordx4 v[24:27], v2, s[8:11], s23 offen offset:0 sc1
  buffer_load_dwordx4 v[28:31], v2, s[8:11], s23 offen offset:1024 sc1
  buffer_load_dwordx4 v[32:35], v2, s[8:11], s23 offen offset:2048 sc1
  s_waitcnt vmcnt(0)
  v_max3_u32 v68, v8, v9, v10
  v_max3_u32 v68, v68, v11, v12
  v_max3_u32 v68, v68, v13, v14
  v_max3_u32 v68, v68, v15, v16
  v_max3_u32 v68, v68, v17, v18
  v_max3_u32 v68, v68, v19, v20
  v_max3_u32 v68, v68, v21, v22
  v_max3_u32 v68, v68, v23, v24
  v_max3_u32 v68, v68, v25, v26
  v_max3_u32 v68, v68, v27, v28
  v_max3_u32 v68, v68, v29, v30
  v_max3_u32 v68, v68, v31, v32
  v_max3_u32 v68, v68, v33, v34
  v_max_u32 v68, v68, v35
  v_cmp_eq_u32 vcc, -1, v68
  s_cbranch_vccz cA_sc2_rk
  s_add_u32 s30, s30, 1
  s_cmp_lt_u32 s30, 400000
  s_cbranch_scc1 cA_sc2_rv
  s_branch cA_abort
cA_sc2_rk:
  s_mov_b32 s62, 1
  v_mov_b32 v36, 0
  v_mov_b32 v37, 0
  v_mov_b32 v38, 0
  v_mov_b32 v39, 0
  v_mov_b32 v40, 0
  v_mov_b32 v41, 0
  v_mov_b32 v42, 0
  v_mov_b32 v43, 0
  v_mov_b32 v44, 0
  v_mov_b32 v45, 0
  v_mov_b32 v46, 0
  v_mov_b32 v47, 0
  v_mov_b32 v48, 0
  v_mov_b32 v49, 0
  v_mov_b32 v50, 0
  v_mov_b32 v51, 0
  v_mov_b32 v52, 0
  v_mov_b32 v53, 0
  v_mov_b32 v54, 0
  v_mov_b32 v55, 0
  v_mov_b32 v56, 0
  v_mov_b32 v57, 0
  v_mov_b32 v58, 0
  v_mov_b32 v59, 0
  v_mov_b32 v60, 0
  v_mov_b32 v61, 0
  v_mov_b32 v62, 0
  v_mov_b32 v63, 0
  v_mov_b32 v88, 0
  v_mov_b32 v89, 0
  v_mov_b32 v90, 0
  v_mov_b32 v91, 0
  v_mov_b32 v92, 0
  v_mov_b32 v93, 0
  v_mov_b32 v94, 0
  v_mov_b32 v95, 0
  v_mov_b32 v66, 0
  v_mov_b32 v67, 0
  s_add_u32 s31, s31, 1
  ds_read_b128 v[96:99], v117 offset:0
  ds_read_b128 v[100:103], v117 offset:1024
  ds_read_b128 v[104:107], v117 offset:14336
  ds_read_b128 v[108:111], v117 offset:15360
  v_smfmac_f32_16x16x64_bf16 v[36:39], v[8:11], a[0:7], v3
  v_smfmac_f32_16x16x64_bf16 v[40:43], v[8:11], a[56:63], v3
  v_smfmac_f32_16x16x64_bf16 v[44:47], v[8:11], a[112:119], v3
  v_smfmac_f32_16x16x64_bf16 v[48:51], v[8:11], a[168:175], v3
  v_smfmac_f32_16x16x64_bf16 v[52:55], v[8:11], a[224:231], v3
  v_smfmac_f32_16x16x64_bf16 v[56:59], v[8:11], v[144:151], v3
  v_smfmac_f32_16x16x64_bf16 v[60:63], v[8:11], v[200:207], v3
  v_smfmac_f32_16x16x64_bf16 v[36:39], v[12:15], a[8:15], v3
  v_smfmac_f32_16x16x64_bf16 v[40:43], v[12:15], a[64:71], v3
  v_smfmac_f32_16x16x64_bf16 v[44:47], v[12:15], a[120:127], v3
  v_smfmac_f32_16x16x64_bf16 v[48:51], v[12:15], a[176:183], v3
  v_smfmac_f32_16x16x64_bf16 v[52:55], v[12:15], a[232:239], v3
  v_smfmac_f32_16x16x64_bf16 v[56:59], v[12:15], v[152:159], v3
  v_smfmac_f32_16x16x64_bf16 v[60:63], v[12:15], v[208:215], v3
  v_smfmac_f32_16x16x64_bf16 v[36:39], v[16:19], a[16:23], v3
  v_smfmac_f32_16x16x64_bf16 v[40:43], v[16:19], a[72:79], v3
  v_smfmac_f32_16x16x64_bf16 v[44:47], v[16:19], a[128:135], v3
  v_smfmac_f32_16x16x64_bf16 v[48:51], v[16:19], a[184:191], v3
  v_smfmac_f32_16x16x64_bf16 v[52:55], v[16:19], a[240:247], v3
  v_smfmac_f32_16x16x64_bf16 v[56:59], v[16:19], v[160:167], v3
  v_smfmac_f32_16x16x64_bf16 v[60:63], v[16:19], v[216:223], v3
  v_smfmac_f32_16x16x64_bf16 v[36:39], v[20:23], a[24:31], v3
  v_smfmac_f32_16x16x64_bf16 v[40:43], v[20:23], a[80:87], v3
  v_smfmac_f32_16x16x64_bf16 v[44:47], v[20:23], a[136:143], v3
  v_smfmac_f32_16x16x64_bf16 v[48:51], v[20:23], a[192:199], v3
  v_smfmac_f32_16x16x64_bf16 v[52:55], v[20:23], a[248:255], v3
  v_smfmac_f32_16x16x64_bf16 v[56:59], v[20:23], v[168:175], v3
  v_smfmac_f32_16x16x64_bf16 v[60:63], v[20:23], v[224:231], v3
  s_xor_b32 s58, s25, 28672
  s_add_u32 s59, s24, 28672
  s_add_u32 m0, s58, 14336
  s_branch cA_sc2_ph2
.p2align 6

cA_sc3_loop:
  s_add_u32 s23, s20, 4096
  s_add_u32 s21, s20, 20480
  s_mov_b32 s30, 0
  s_mov_b32 s62, 0
  s_waitcnt vmcnt(0)
  s_barrier
cA_sc3_ld:
  buffer_load_dwordx4 v[8:11], v2, s[8:11], s20 offen offset:0
  v_mov_b32 v36, 0
  v_mov_b32 v37, 0
  v_mov_b32 v38, 0
  v_mov_b32 v39, 0
  buffer_load_dwordx4 v[12:15], v2, s[8:11], s20 offen offset:1024
  v_mov_b32 v40, 0
  v_mov_b32 v41, 0
  v_mov_b32 v42, 0
  v_mov_b32 v43, 0
  buffer_load_dwordx4 v[16:19], v2, s[8:11], s20 offen offset:2048
  v_mov_b32 v44, 0
  v_mov_b32 v45, 0
  v_mov_b32 v46, 0
  v_mov_b32 v47, 0
  ds_read_b128 v[96:99], v117 offset:0
  ds_read_b128 v[100:103], v117 offset:1024
  ds_read_b128 v[104:107], v117 offset:14336
  ds_read_b128 v[108:111], v117 offset:15360
  s_waitcnt vmcnt(2)
  v_smfmac_f32_16x16x64_bf16 v[36:39], v[8:11], a[0:7], v3
  v_smfmac_f32_16x16x64_bf16 v[40:43], v[8:11], a[56:63], v3
  buffer_load_dwordx4 v[20:23], v2, s[8:11], s20 offen offset:3072
  v_smfmac_f32_16x16x64_bf16 v[44:47], v[8:11], a[112:119], v3
  v_smfmac_f32_16x16x64_bf16 v[48:51], v[8:11], a[168:175], v3
  v_smfmac_f32_16x16x64_bf16 v[52:55], v[8:11], a[224:231], v3
  buffer_load_dwordx4 v[24:27], v2, s[8:11], s23 offen offset:0
  v_smfmac_f32_16x16x64_bf16 v[56:59], v[8:11], v[144:151], v3
  v_smfmac_f32_16x16x64_bf16 v[60:63], v[8:11], v[200:207], v3
  s_waitcnt vmcnt(3)
  v_smfmac_f32_16x16x64_bf16 v[36:39], v[12:15], a[8:15], v3
  v_smfmac_f32_16x16x64_bf16 v[40:43], v[12:15], a[64:71], v3
  buffer_load_dwordx4 v[28:31], v2, s[8:11], s23 offen offset:1024
  v_smfmac_f32_16x16x64_bf16 v[44:47], v[12:15], a[120:127], v3
  v_smfmac_f32_16x16x64_bf16 v[48:51], v[12:15], a[176:183], v3
  v_smfmac_f32_16x16x64_bf16 v[52:55], v[12:15], a[232:239], v3
  buffer_load_dwordx4 v[32:35], v2, s[8:11], s23 offen offset:2048
  v_smfmac_f32_16x16x64_bf16 v[56:59], v[12:15], v[152:159], v3
  v_smfmac_f32_16x16x64_bf16 v[60:63], v[12:15], v[208:215], v3
  s_waitcnt vmcnt(4)
  v_smfmac_f32_16x16x64_bf16 v[36:39], v[16:19], a[16:23], v3
  v_smfmac_f32_16x16x64_bf16 v[40:43], v[16:19], a[72:79], v3
  v_smfmac_f32_16x16x64_bf16 v[44:47], v[16:19], a[128:135], v3
  s_xor_b32 s58, s25, 28672
  s_add_u32 s59, s24, 28672
  s_add_u32 m0, s58, 21504
  v_smfmac_f32_16x16x64_bf16 v[48:51], v[16:19], a[184:191], v3
  buffer_load_dwordx4 v2, s[8:11], s59 offen offset:0 sc1 lds
  v_smfmac_f32_16x16x64_bf16 v[52:55], v[16:19], a[240:247], v3
  v_smfmac_f32_16x16x64_bf16 v[56:59], v[16:19], v[160:167], v3
  v_smfmac_f32_16x16x64_bf16 v[60:63], v[16:19], v[216:223], v3
  s_waitcnt vmcnt(4)
  v_smfmac_f32_16x16x64_bf16 v[36:39], v[20:23], a[24:31], v3
  buffer_load_dwordx4 v2, s[8:11], s59 offen offset:1024 sc1 lds
  v_smfmac_f32_16x16x64_bf16 v[40:43], v[20:23], a[80:87], v3
  v_smfmac_f32_16x16x64_bf16 v[44:47], v[20:23], a[136:143], v3
  v_smfmac_f32_16x16x64_bf16 v[48:51], v[20:23], a[192:199], v3
  v_smfmac_f32_16x16x64_bf16 v[52:55], v[20:23], a[248:255], v3
  buffer_load_dwordx4 v2, s[8:11], s59 offen offset:2048 sc1 lds
  v_smfmac_f32_16x16x64_bf16 v[56:59], v[20:23], v[168:175], v3
  v_smfmac_f32_16x16x64_bf16 v[60:63], v[20:23], v[224:231], v3
  s_waitcnt vmcnt(3)
cA_sc3_ph2:
  v_smfmac_f32_16x16x64_bf16 v[60:63], v[24:27], v[232:239], v3
  ds_read_b128 v[8:11], v116 offset:6144
  ds_read_b128 v[12:15], v116 offset:7168
  v_smfmac_f32_16x16x64_bf16 v[60:63], v[28:31], v[240:247], v3
  buffer_load_dwordx4 v2, s[8:11], s59 offen offset:3072 sc1 lds
  v_smfmac_f32_16x16x64_bf16 v[60:63], v[32:35], v[248:255], v3
  v_mov_b32 v80, v30
  v_smfmac_f32_16x16x64_bf16 v[52:55], v[24:27], v[120:127], v3
  v_mov_b32 v81, v31
  v_smfmac_f32_16x16x64_bf16 v[52:55], v[28:31], v[128:135], v3
  v_mov_b32 v82, v34
  v_smfmac_f32_16x16x64_bf16 v[52:55], v[32:35], v[136:143], v3
  v_cvt_pk_bf16_f32 v66, v60, v61
  v_smfmac_f32_16x16x64_bf16 v[56:59], v[24:27], v[176:183], v3
  v_cvt_pk_bf16_f32 v67, v62, v63
  v_smfmac_f32_16x16x64_bf16 v[56:59], v[28:31], v[184:191], v3
  v_mov_b32 v83, v35
  v_mfma_f32_16x16x32_bf16 v[68:71], v[64:67], v[4:7], 0
  v_smfmac_f32_16x16x64_bf16 v[56:59], v[32:35], v[192:199], v3
  v_cvt_pk_bf16_f32 v64, v52, v53
  v_smfmac_f32_16x16x64_bf16 v[36:39], v[24:27], a[32:39], v3
  v_cvt_pk_bf16_f32 v65, v54, v55
  v_smfmac_f32_16x16x64_bf16 v[36:39], v[28:31], a[40:47], v3
  v_cvt_pk_bf16_f32 v78, v68, v69
  v_smfmac_f32_16x16x64_bf16 v[36:39], v[32:35], a[48:55], v3
  v_cvt_pk_bf16_f32 v79, v70, v71
  v_cvt_pk_bf16_f32 v66, v56, v57
  v_smfmac_f32_16x16x64_bf16 v[40:43], v[24:27], a[88:95], v3
  v_cvt_pk_bf16_f32 v67, v58, v59
  v_smfmac_f32_16x16x64_bf16 v[40:43], v[28:31], a[96:103], v3
  v_mfma_f32_16x16x32_bf16 v[72:75], v[64:67], v[4:7], 0
  ds_read_b128 v[52:55], v116 offset:20480
  ds_read_b128 v[56:59], v116 offset:21504
  v_smfmac_f32_16x16x64_bf16 v[40:43], v[32:35], a[104:111], v3
  v_cvt_pk_bf16_f32 v64, v36, v37
  v_smfmac_f32_16x16x64_bf16 v[44:47], v[24:27], a[144:151], v3
  v_cvt_pk_bf16_f32 v65, v38, v39
  v_smfmac_f32_16x16x64_bf16 v[44:47], v[28:31], a[152:159], v3
  v_cvt_pk_bf16_f32 v76, v72, v73
  v_smfmac_f32_16x16x64_bf16 v[44:47], v[32:35], a[160:167], v3
  v_cvt_pk_bf16_f32 v77, v74, v75
  v_cvt_pk_bf16_f32 v66, v40, v41
  v_smfmac_f32_16x16x64_bf16 v[48:51], v[24:27], a[200:207], v3
  v_cvt_pk_bf16_f32 v67, v42, v43
  v_smfmac_f32_16x16x64_bf16 v[48:51], v[28:31], a[208:215], v3
  v_mfma_f32_16x16x32_bf16 v[68:71], v[64:67], v[4:7], 0
  v_smfmac_f32_16x16x64_bf16 v[48:51], v[32:35], a[216:223], v3
  v_cvt_pk_bf16_f32 v64, v44, v45
  v_mfma_f32_16x16x32_bf16 v[84:87], v[80:83], v[76:79], 0
  v_cvt_pk_bf16_f32 v65, v46, v47
  s_waitcnt lgkmcnt(0)
  v_smfmac_f32_16x16x64_bf16 v[88:91], v[76:79], v[96:103], v118
  v_cvt_pk_bf16_f32 v60, v68, v69
  v_cvt_pk_bf16_f32 v61, v70, v71
  v_cvt_pk_bf16_f32 v66, v48, v49
  v_cvt_pk_bf16_f32 v67, v50, v51
  s_nop 1
  v_mfma_f32_16x16x32_bf16 v[72:75], v[64:67], v[4:7], 0
  v_smfmac_f32_16x16x64_bf16 v[92:95], v[76:79], v[104:111], v118
  s_nop 4
  v_cvt_pk_bf16_f32 v62, v72, v73
  v_cvt_pk_bf16_f32 v63, v74, v75
  s_nop 1
  v_mfma_f32_16x16x32_bf16 v[84:87], v[20:23], v[60:63], v[84:87]
  v_smfmac_f32_16x16x64_bf16 v[88:91], v[60:63], v[8:15], v118
  v_smfmac_f32_16x16x64_bf16 v[92:95], v[60:63], v[52:59], v118
  s_nop 1
  v_permlane32_swap_b32 v84, v86
  v_permlane32_swap_b32 v85, v87
  s_nop 0
  v_add_f32 v88, v88, v89
  v_add_f32_dpp v84, v86, v84 quad_perm:[1,0,3,2] row_mask:0xf bank_mask:0xf
  v_add_f32_dpp v85, v87, v85 quad_perm:[1,0,3,2] row_mask:0xf bank_mask:0xf
  v_add_f32 v89, v90, v91
  ds_write2_b32 v113, v84, v85 offset0:0 offset1:4
  ds_write2_b32 v112, v88, v89 offset0:0 offset1:128
  v_add_f32 v90, v92, v93
  v_add_f32 v91, v94, v95
  ds_write2_b32 v112, v90, v91 offset0:64 offset1:192
  v_cmp_u_f32 vcc, v88, v89
  s_cbranch_vccnz cA_sc3_retry
cA_sc3_cont:
  s_waitcnt lgkmcnt(0)
  s_barrier
  ds_read_b128 v[36:39], v114
  ds_read_b128 v[44:47], v115
  s_waitcnt lgkmcnt(0)
  v_add_f32 v36, v36, v38
  v_add_f32 v37, v37, v39
  v_add_f32 v44, v44, v45
  v_add_f32 v46, v46, v47
  v_add_f32 v44, v44, v46
  v_add_f32 v36, v36, v37
  v_exp_f32 v49, v44
  v_exp_f32 v48, v36
  v_add_f32 v50, abs(v36), abs(v44)
  v_fma_f32 v39, v49, s37, v48
  v_cmp_ngt_f32 vcc, s56, v50
  v_cndmask_b32 v41, v48, v49, s[38:39]
  v_add_f32_dpp v39, v39, v39 quad_perm:[1,0,3,2] row_mask:0xf bank_mask:0xf
  v_cndmask_b32 v40, v49, v48, s[38:39]
  v_mov_b32_dpp v46, v41 quad_perm:[1,0,3,2] row_mask:0xf bank_mask:0xf
  v_add_f32_dpp v39, v39, v39 quad_perm:[2,3,0,1] row_mask:0xf bank_mask:0xf
  v_cndmask_b32 v42, v46, v40, s[38:39]
  v_cndmask_b32 v43, v40, v46, s[38:39]
  v_add_f32_dpp v39, v39, v39 row_half_mirror row_mask:0xf bank_mask:0xf
  s_cbranch_vccnz cA_sc3_slow
  s_nop 0
  v_add_f32_dpp v47, v39, v39 row_mirror row_mask:0xf bank_mask:0xf
  v_add_f32_dpp v39, v39, v39 row_mirror row_mask:0xf bank_mask:0xf
  s_nop 1
  v_permlane16_swap_b32 v39, v47
  v_add_f32 v39, v39, v47
  v_rcp_f32 v39, v39
  s_mov_b64 exec, s[28:29]
  v_mul_f32 v42, v42, v39
  v_mul_f32 v43, v43, v39
  v_cvt_pk_bf16_f32 v42, v42, v43
cA_sc3_pst:
  buffer_store_dword v42, v1, s[8:11], s20 offen
  s_mov_b64 exec, -1
  s_barrier
  s_add_u32 s24, s24, 28672
  s_add_u32 s35, s35, 28672
  s_xor_b32 s25, s25, 28672
  s_add_u32 m0, s25, 21504
  s_add_u32 m0, s25, 25600
  s_add_u32 s22, s24, 4096
  buffer_load_dwordx4 v2, s[8:11], s22 offen offset:0 sc1 lds
  v_mov_b32 v48, 0
  v_mov_b32 v49, 0
  v_mov_b32 v50, 0
  v_mov_b32 v51, 0
  v_mov_b32 v52, 0
  v_mov_b32 v53, 0
  buffer_load_dwordx4 v2, s[8:11], s22 offen offset:1024 sc1 lds
  v_mov_b32 v54, 0
  v_mov_b32 v55, 0
  v_mov_b32 v56, 0
  v_mov_b32 v57, 0
  v_mov_b32 v58, 0
  v_mov_b32 v59, 0
  buffer_load_dwordx4 v2, s[8:11], s22 offen offset:2048 sc1 lds
  v_mov_b32 v60, 0
  v_mov_b32 v61, 0
  v_mov_b32 v62, 0
  v_mov_b32 v63, 0
  v_mov_b32 v88, 0
  v_mov_b32 v89, 0
  v_mov_b32 v90, 0
  v_mov_b32 v91, 0
  v_mov_b32 v92, 0
  v_mov_b32 v93, 0
  v_mov_b32 v94, 0
  v_mov_b32 v95, 0
  v_mov_b32 v64, 0
  v_mov_b32 v65, 0
  v_xor_b32 v116, 28672, v116
  v_add_u32 v117, s57, v117
  s_sub_u32 s57, 0, s57
  s_add_u32 s19, s19, 1
  s_mov_b32 s20, s21
  s_cmp_lt_u32 s19, 63
  s_cbranch_scc1 cA_sc3_loop
  s_branch cA_done
cA_sc3_slow:
  v_max_f32 v50, v36, v44
  s_nop 1
  v_max_f32_dpp v50, v50, v50 quad_perm:[1,0,3,2] row_mask:0xf bank_mask:0xf
  s_nop 1
  v_max_f32_dpp v50, v50, v50 quad_perm:[2,3,0,1] row_mask:0xf bank_mask:0xf
  s_nop 1
  v_max_f32_dpp v50, v50, v50 row_half_mirror row_mask:0xf bank_mask:0xf
  s_nop 1
  v_max_f32_dpp v50, v50, v50 row_mirror row_mask:0xf bank_mask:0xf
  v_mov_b32 v47, v50
  s_nop 1
  v_permlane16_swap_b32 v50, v47
  v_max_f32 v50, v50, v47
  v_sub_f32 v48, v36, v50
  v_sub_f32 v49, v44, v50
  v_exp_f32 v48, v48
  v_exp_f32 v49, v49
  s_add_u32 s31, s31, 0x100
  v_fma_f32 v39, v49, s37, v48
  v_cndmask_b32 v41, v48, v49, s[38:39]
  s_nop 0
  v_add_f32_dpp v39, v39, v39 quad_perm:[1,0,3,2] row_mask:0xf bank_mask:0xf
  v_cndmask_b32 v40, v49, v48, s[38:39]
  v_mov_b32_dpp v46, v41 quad_perm:[1,0,3,2] row_mask:0xf bank_mask:0xf
  v_add_f32_dpp v39, v39, v39 quad_perm:[2,3,0,1] row_mask:0xf bank_mask:0xf
  v_cndmask_b32 v42, v46, v40, s[38:39]
  v_cndmask_b32 v43, v40, v46, s[38:39]
  v_add_f32_dpp v39, v39, v39 row_half_mirror row_mask:0xf bank_mask:0xf
  s_nop 1
  v_add_f32_dpp v47, v39, v39 row_mirror row_mask:0xf bank_mask:0xf
  v_add_f32_dpp v39, v39, v39 row_mirror row_mask:0xf bank_mask:0xf
  s_nop 1
  v_permlane16_swap_b32 v39, v47
  v_add_f32 v39, v39, v47
  v_rcp_f32 v39, v39
  s_mov_b64 exec, s[28:29]
  v_mul_f32 v42, v42, v39
  v_mul_f32 v43, v43, v39
  v_cvt_pk_bf16_f32 v42, v42, v43
  v_min_u32 v42, -2, v42
  s_branch cA_sc3_pst
cA_sc3_retry:
  s_cmp_lg_u32 s62, 0
  s_cbranch_scc1 cA_sc3_cont
  s_waitcnt vmcnt(0) lgkmcnt(0)
cA_sc3_rv:
  buffer_load_dwordx4 v[8:11], v2, s[8:11], s20 offen offset:0 sc1
  buffer_load_dwordx4 v[12:15], v2, s[8:11], s20 offen offset:1024 sc1
  buffer_load_dwordx4 v[16:19], v2, s[8:11], s20 offen offset:2048 sc1
  buffer_load_dwordx4 v[20:23], v2, s[8:11], s20 offen offset:3072 sc1
  buffer_load_dwordx4 v[24:27], v2, s[8:11], s23 offen offset:0 sc1
  buffer_load_dwordx4 v[28:31], v2, s[8:11], s23 offen offset:1024 sc1
  buffer_load_dwordx4 v[32:35], v2, s[8:11], s23 offen offset:2048 sc1
  s_waitcnt vmcnt(0)
  v_max3_u32 v68, v8, v9, v10
  v_max3_u32 v68, v68, v11, v12
  v_max3_u32 v68, v68, v13, v14
  v_max3_u32 v68, v68, v15, v16
  v_max3_u32 v68, v68, v17, v18
  v_max3_u32 v68, v68, v19, v20
  v_max3_u32 v68, v68, v21, v22
  v_max3_u32 v68, v68, v23, v24
  v_max3_u32 v68, v68, v25, v26
  v_max3_u32 v68, v68, v27, v28
  v_max3_u32 v68, v68, v29, v30
  v_max3_u32 v68, v68, v31, v32
  v_max3_u32 v68, v68, v33, v34
  v_max_u32 v68, v68, v35
  v_cmp_eq_u32 vcc, -1, v68
  s_cbranch_vccz cA_sc3_rk
  s_add_u32 s30, s30, 1
  s_cmp_lt_u32 s30, 400000
  s_cbranch_scc1 cA_sc3_rv
  s_branch cA_abort
cA_sc3_rk:
  s_mov_b32 s62, 1
  v_mov_b32 v36, 0
  v_mov_b32 v37, 0
  v_mov_b32 v38, 0
  v_mov_b32 v39, 0
  v_mov_b32 v40, 0
  v_mov_b32 v41, 0
  v_mov_b32 v42, 0
  v_mov_b32 v43, 0
  v_mov_b32 v44, 0
  v_mov_b32 v45, 0
  v_mov_b32 v46, 0
  v_mov_b32 v47, 0
  v_mov_b32 v48, 0
  v_mov_b32 v49, 0
  v_mov_b32 v50, 0
  v_mov_b32 v51, 0
  v_mov_b32 v52, 0
  v_mov_b32 v53, 0
  v_mov_b32 v54, 0
  v_mov_b32 v55, 0
  v_mov_b32 v56, 0
  v_mov_b32 v57, 0
  v_mov_b32 v58, 0
  v_mov_b32 v59, 0
  v_mov_b32 v60, 0
  v_mov_b32 v61, 0
  v_mov_b32 v62, 0
  v_mov_b32 v63, 0
  v_mov_b32 v88, 0
  v_mov_b32 v89, 0
  v_mov_b32 v90, 0
  v_mov_b32 v91, 0
  v_mov_b32 v92, 0
  v_mov_b32 v93, 0
  v_mov_b32 v94, 0
  v_mov_b32 v95, 0
  v_mov_b32 v64, 0
  v_mov_b32 v65, 0
  s_add_u32 s31, s31, 1
  ds_read_b128 v[96:99], v117 offset:0
  ds_read_b128 v[100:103], v117 offset:1024
  ds_read_b128 v[104:107], v117 offset:14336
  ds_read_b128 v[108:111], v117 offset:15360
  v_smfmac_f32_16x16x64_bf16 v[36:39], v[8:11], a[0:7], v3
  v_smfmac_f32_16x16x64_bf16 v[40:43], v[8:11], a[56:63], v3
  v_smfmac_f32_16x16x64_bf16 v[44:47], v[8:11], a[112:119], v3
  v_smfmac_f32_16x16x64_bf16 v[48:51], v[8:11], a[168:175], v3
  v_smfmac_f32_16x16x64_bf16 v[52:55], v[8:11], a[224:231], v3
  v_smfmac_f32_16x16x64_bf16 v[56:59], v[8:11], v[144:151], v3
  v_smfmac_f32_16x16x64_bf16 v[60:63], v[8:11], v[200:207], v3
  v_smfmac_f32_16x16x64_bf16 v[36:39], v[12:15], a[8:15], v3
  v_smfmac_f32_16x16x64_bf16 v[40:43], v[12:15], a[64:71], v3
  v_smfmac_f32_16x16x64_bf16 v[44:47], v[12:15], a[120:127], v3
  v_smfmac_f32_16x16x64_bf16 v[48:51], v[12:15], a[176:183], v3
  v_smfmac_f32_16x16x64_bf16 v[52:55], v[12:15], a[232:239], v3
  v_smfmac_f32_16x16x64_bf16 v[56:59], v[12:15], v[152:159], v3
  v_smfmac_f32_16x16x64_bf16 v[60:63], v[12:15], v[208:215], v3
  v_smfmac_f32_16x16x64_bf16 v[36:39], v[16:19], a[16:23], v3
  v_smfmac_f32_16x16x64_bf16 v[40:43], v[16:19], a[72:79], v3
  v_smfmac_f32_16x16x64_bf16 v[44:47], v[16:19], a[128:135], v3
  v_smfmac_f32_16x16x64_bf16 v[48:51], v[16:19], a[184:191], v3
  v_smfmac_f32_16x16x64_bf16 v[52:55], v[16:19], a[240:247], v3
  v_smfmac_f32_16x16x64_bf16 v[56:59], v[16:19], v[160:167], v3
  v_smfmac_f32_16x16x64_bf16 v[60:63], v[16:19], v[216:223], v3
  v_smfmac_f32_16x16x64_bf16 v[36:39], v[20:23], a[24:31], v3
  v_smfmac_f32_16x16x64_bf16 v[40:43], v[20:23], a[80:87], v3
  v_smfmac_f32_16x16x64_bf16 v[44:47], v[20:23], a[136:143], v3
  v_smfmac_f32_16x16x64_bf16 v[48:51], v[20:23], a[192:199], v3
  v_smfmac_f32_16x16x64_bf16 v[52:55], v[20:23], a[248:255], v3
  v_smfmac_f32_16x16x64_bf16 v[56:59], v[20:23], v[168:175], v3
  v_smfmac_f32_16x16x64_bf16 v[60:63], v[20:23], v[224:231], v3
  s_xor_b32 s58, s25, 28672
  s_add_u32 s59, s24, 28672
  s_add_u32 m0, s58, 21504
  s_branch cA_sc3_ph2
.p2align 6

cA_va0_loop:
  s_add_u32 s23, s20, 4096
  s_add_u32 s21, s20, 20480
  s_mov_b32 s30, 0
  s_cmp_lg_u32 s19, s38
  s_cbranch_scc1 cA_va0_vok
  s_branch cA_va0_voc
cA_va0_vow:
  s_sub_u32 s22, s39, s35
  v_lshlrev_b32 v63, 7, v2
  v_min_u32 v63, s22, v63
  buffer_load_dword v63, v63, s[8:11], s35 offen sc1
  s_waitcnt vmcnt(0)
cA_va0_voc:
  v_readfirstlane_b32 s22, v63
  s_cmp_eq_u32 s22, 56
  s_cbranch_scc1 cA_va0_vod
  s_sleep 1
  s_add_u32 s30, s30, 1
  s_cmp_lt_u32 s30, 400000
  s_cbranch_scc1 cA_va0_vow
  s_branch cA_abort
cA_va0_vod:
  s_add_u32 s35, s35, 2048
  s_add_u32 s38, s19, 8
  s_and_b32 s38, s38, -8
  s_cmp_eq_u32 s19, 0
  s_cselect_b32 s38, 4, s38
  v_cmp_ne_u32 vcc, 56, v63
  s_nop 3
  s_cmp_eq_u64 vcc, 0
  s_cselect_b32 s38, 99, s38
cA_va0_vok:
  s_cmp_eq_u32 s19, 63
  s_cbranch_scc1 cA_done
  s_barrier
  s_add_u32 s22, s25, 0
  buffer_load_dwordx4 v[80:83], v6, s[8:11], s22 offen offset:0 sc1
  buffer_load_dwordx4 v[84:87], v6, s[8:11], s22 offen offset:1792 sc1
  s_add_u32 s22, s25, 3584
  buffer_load_dwordx4 v[88:91], v6, s[8:11], s22 offen offset:0 sc1
  buffer_load_dwordx4 v[92:95], v6, s[8:11], s22 offen offset:1792 sc1
  s_add_u32 s22, s25, 7168
  buffer_load_dwordx4 v[96:99], v6, s[8:11], s22 offen offset:0 sc1
  buffer_load_dwordx4 v[100:103], v6, s[8:11], s22 offen offset:1792 sc1
  s_add_u32 s22, s25, 10752
  buffer_load_dwordx4 v[104:107], v6, s[8:11], s22 offen offset:0 sc1
  buffer_load_dwordx4 v[108:111], v6, s[8:11], s22 offen offset:1792 sc1
  s_add_u32 s22, s25, 14336
  buffer_load_dwordx4 v[112:115], v6, s[8:11], s22 offen offset:0 sc1
  buffer_load_dwordx4 v[116:119], v6, s[8:11], s22 offen offset:1792 sc1
  s_add_u32 s22, s25, 17920
  buffer_load_dwordx4 v[120:123], v6, s[8:11], s22 offen offset:0 sc1
  buffer_load_dwordx4 v[124:127], v6, s[8:11], s22 offen offset:1792 sc1
  s_add_u32 s22, s19, 1
  s_cmp_lg_u32 s22, s38
  s_cbranch_scc1 cA_va0_nk
  s_sub_u32 s22, s39, s35
  v_lshlrev_b32 v63, 7, v2
  v_min_u32 v63, s22, v63
  buffer_load_dword v63, v63, s[8:11], s35 offen sc1
cA_va0_nk:
  s_barrier
  ds_read_b128 v[8:11], v0 offset:8192
  ds_read_b128 v[12:15], v0 offset:9216
  ds_read_b128 v[16:19], v0 offset:10240
  ds_read_b128 v[20:23], v0 offset:11264
  ds_read_b128 v[24:27], v0 offset:12288
  ds_read_b128 v[28:31], v0 offset:13312
  ds_read_b128 v[32:35], v0 offset:14336
  s_waitcnt lgkmcnt(0)
  v_smfmac_f32_16x16x64_bf16 v[36:39], v[8:11], a[0:7], v3
  s_add_u32 s22, s25, 21504
  buffer_load_dwordx4 v[128:131], v6, s[8:11], s22 offen offset:0 sc1
  v_smfmac_f32_16x16x64_bf16 v[36:39], v[12:15], a[8:15], v3
  v_smfmac_f32_16x16x64_bf16 v[36:39], v[16:19], a[16:23], v3
  s_add_u32 s22, s25, 21504
  buffer_load_dwordx4 v[132:135], v6, s[8:11], s22 offen offset:1792 sc1
  v_smfmac_f32_16x16x64_bf16 v[36:39], v[20:23], a[24:31], v3
  v_smfmac_f32_16x16x64_bf16 v[36:39], v[24:27], a[32:39], v3
  s_add_u32 s22, s25, 25088
  buffer_load_dwordx4 v[136:139], v6, s[8:11], s22 offen offset:0 sc1
  v_smfmac_f32_16x16x64_bf16 v[36:39], v[28:31], a[40:47], v3
  v_smfmac_f32_16x16x64_bf16 v[36:39], v[32:35], a[48:55], v3
  s_add_u32 s22, s25, 25088
  buffer_load_dwordx4 v[140:143], v6, s[8:11], s22 offen offset:1792 sc1
  v_smfmac_f32_16x16x64_bf16 v[40:43], v[8:11], a[56:63], v3
  v_smfmac_f32_16x16x64_bf16 v[40:43], v[12:15], a[64:71], v3
  v_smfmac_f32_16x16x64_bf16 v[40:43], v[16:19], a[72:79], v3
  v_add_f32 v36, v36, v37
  v_smfmac_f32_16x16x64_bf16 v[40:43], v[20:23], a[80:87], v3
  v_add_f32 v38, v38, v39
  v_smfmac_f32_16x16x64_bf16 v[40:43], v[24:27], a[88:95], v3
  v_cvt_pk_bf16_f32 v36, v36, v38
  v_smfmac_f32_16x16x64_bf16 v[40:43], v[28:31], a[96:103], v3
  ds_write_b32 v60, v36
  v_smfmac_f32_16x16x64_bf16 v[40:43], v[32:35], a[104:111], v3
  v_smfmac_f32_16x16x64_bf16 v[44:47], v[8:11], a[112:119], v3
  v_smfmac_f32_16x16x64_bf16 v[44:47], v[12:15], a[120:127], v3
  v_smfmac_f32_16x16x64_bf16 v[44:47], v[16:19], a[128:135], v3
  v_add_f32 v40, v40, v41
  v_smfmac_f32_16x16x64_bf16 v[44:47], v[20:23], a[136:143], v3
  v_add_f32 v42, v42, v43
  v_smfmac_f32_16x16x64_bf16 v[44:47], v[24:27], a[144:151], v3
  v_cvt_pk_bf16_f32 v40, v40, v42
  v_smfmac_f32_16x16x64_bf16 v[44:47], v[28:31], a[152:159], v3
  ds_write_b32 v61, v40
  v_smfmac_f32_16x16x64_bf16 v[44:47], v[32:35], a[160:167], v3
  v_smfmac_f32_16x16x64_bf16 v[48:51], v[8:11], a[168:175], v3
  v_smfmac_f32_16x16x64_bf16 v[48:51], v[12:15], a[176:183], v3
  v_smfmac_f32_16x16x64_bf16 v[48:51], v[16:19], a[184:191], v3
  v_add_f32 v44, v44, v45
  v_smfmac_f32_16x16x64_bf16 v[48:51], v[20:23], a[192:199], v3
  v_add_f32 v46, v46, v47
  v_smfmac_f32_16x16x64_bf16 v[48:51], v[24:27], a[200:207], v3
  v_cvt_pk_bf16_f32 v44, v44, v46
  v_smfmac_f32_16x16x64_bf16 v[48:51], v[28:31], a[208:215], v3
  ds_write_b32 v62, v44
  v_smfmac_f32_16x16x64_bf16 v[48:51], v[32:35], a[216:223], v3
  v_smfmac_f32_16x16x64_bf16 v[52:55], v[8:11], a[224:231], v3
  v_smfmac_f32_16x16x64_bf16 v[52:55], v[12:15], a[232:239], v3
  v_smfmac_f32_16x16x64_bf16 v[52:55], v[16:19], a[240:247], v3
  v_add_f32 v48, v48, v49
  v_smfmac_f32_16x16x64_bf16 v[52:55], v[20:23], a[248:255], v3
  v_add_f32 v50, v50, v51
  v_smfmac_f32_16x16x64_bf16 v[52:55], v[24:27], v[176:183], v3
  v_cvt_pk_bf16_f32 v48, v48, v50
  v_smfmac_f32_16x16x64_bf16 v[52:55], v[28:31], v[184:191], v3
  ds_write_b32 v170, v48
  v_smfmac_f32_16x16x64_bf16 v[52:55], v[32:35], v[192:199], v3
  v_smfmac_f32_16x16x64_bf16 v[56:59], v[8:11], v[200:207], v3
  v_smfmac_f32_16x16x64_bf16 v[56:59], v[12:15], v[208:215], v3
  v_smfmac_f32_16x16x64_bf16 v[56:59], v[16:19], v[216:223], v3
  v_add_f32 v52, v52, v53
  v_smfmac_f32_16x16x64_bf16 v[56:59], v[20:23], v[224:231], v3
  v_add_f32 v54, v54, v55
  v_smfmac_f32_16x16x64_bf16 v[56:59], v[24:27], v[232:239], v3
  v_cvt_pk_bf16_f32 v52, v52, v54
  v_smfmac_f32_16x16x64_bf16 v[56:59], v[28:31], v[240:247], v3
  ds_write_b32 v171, v52
  v_smfmac_f32_16x16x64_bf16 v[56:59], v[32:35], v[248:255], v3
  s_nop 7
  v_add_f32 v56, v56, v57
  v_add_f32 v58, v58, v59
  v_cvt_pk_bf16_f32 v56, v56, v58
  ds_write_b32 v172, v56
  buffer_load_dword v164, v4, s[8:11], s20 offen sc1
  s_waitcnt lgkmcnt(0)
  v_mov_b32 v36, 0
  v_mov_b32 v37, 0
  v_mov_b32 v38, 0
  v_mov_b32 v39, 0
  v_mov_b32 v40, 0
  v_mov_b32 v41, 0
  v_mov_b32 v42, 0
  v_mov_b32 v43, 0
  buffer_load_dword v165, v4, s[8:11], s20 offen sc1
  v_mov_b32 v44, 0
  v_mov_b32 v45, 0
  v_mov_b32 v46, 0
  v_mov_b32 v47, 0
  v_mov_b32 v48, 0
  v_mov_b32 v49, 0
  v_mov_b32 v50, 0
  v_mov_b32 v51, 0
  buffer_load_dword v166, v4, s[8:11], s20 offen sc1
  v_mov_b32 v52, 0
  v_mov_b32 v53, 0
  v_mov_b32 v54, 0
  v_mov_b32 v55, 0
  v_mov_b32 v56, 0
  v_mov_b32 v57, 0
  v_mov_b32 v58, 0
  v_mov_b32 v59, 0
  buffer_load_dword v167, v4, s[8:11], s20 offen sc1
  s_cmp_eq_u32 s19, 63
  s_cbranch_scc1 cA_va0_last
  s_add_u32 s22, s20, 9216
  s_add_u32 s34, s20, 13312
  s_add_u32 s36, s20, 7168
  s_mov_b32 s37, 0
  v_mov_b32 v156, 0
  v_mov_b32 v157, 0
  v_mov_b32 v158, 0
  v_mov_b32 v159, 0
  buffer_load_dword v168, v4, s[8:11], s20 offen sc1
cA_va0_fw_l:
  s_waitcnt vmcnt(4)
  v_cmp_eq_u32 vcc, -1, v164
  s_cbranch_vccz cA_va0_fw_d
  buffer_load_dword v164, v4, s[8:11], s20 offen sc1
  s_waitcnt vmcnt(4)
  v_cmp_eq_u32 vcc, -1, v165
  s_cbranch_vccz cA_va0_fw_d
  buffer_load_dword v165, v4, s[8:11], s20 offen sc1
  s_waitcnt vmcnt(4)
  v_cmp_eq_u32 vcc, -1, v166
  s_cbranch_vccz cA_va0_fw_d
  buffer_load_dword v166, v4, s[8:11], s20 offen sc1
  s_waitcnt vmcnt(4)
  v_cmp_eq_u32 vcc, -1, v167
  s_cbranch_vccz cA_va0_fw_d
  buffer_load_dword v167, v4, s[8:11], s20 offen sc1
  s_waitcnt vmcnt(4)
  v_cmp_eq_u32 vcc, -1, v168
  s_cbranch_vccz cA_va0_fw_d
  buffer_load_dword v168, v4, s[8:11], s20 offen sc1
  s_add_u32 s30, s30, 1
  s_cmp_lt_u32 s30, 400000
  s_cbranch_scc1 cA_va0_fw_l
  s_branch cA_abort
cA_va0_fw_d:
  s_waitcnt lgkmcnt(0)
  buffer_load_dwordx4 v[8:11], v5, s[8:11], s22 offen offset:0
  buffer_load_dwordx4 v[12:15], v5, s[8:11], s22 offen offset:1024
  buffer_load_dwordx4 v[16:19], v5, s[8:11], s22 offen offset:2048
  buffer_load_dwordx4 v[20:23], v5, s[8:11], s22 offen offset:3072
  buffer_load_dwordx4 v[24:27], v5, s[8:11], s34 offen offset:0
  buffer_load_dwordx4 v[28:31], v5, s[8:11], s34 offen offset:1024
  buffer_load_dwordx4 v[32:35], v5, s[8:11], s34 offen offset:2048
  buffer_load_dwordx4 v[144:147], v5, s[8:11], s34 offen offset:3072
  buffer_load_dwordx4 v[148:151], v2, s[8:11], s36 offen offset:0
  buffer_load_dwordx4 v[152:155], v2, s[8:11], s36 offen offset:1024
  s_barrier
  ds_read_b128 v[64:67], v2 offset:0
  ds_read_b128 v[68:71], v2 offset:1024
  ds_read_b128 v[72:75], v2 offset:2048
  ds_read_b128 v[76:79], v2 offset:3072
  s_waitcnt vmcnt(9)
  v_smfmac_f32_16x16x64_bf16 v[156:159], v[8:11], v[80:87], v3
  s_waitcnt vmcnt(8)
  v_smfmac_f32_16x16x64_bf16 v[156:159], v[12:15], v[88:95], v3
  s_waitcnt vmcnt(7)
  v_smfmac_f32_16x16x64_bf16 v[156:159], v[16:19], v[96:103], v3
  s_waitcnt vmcnt(6)
  v_smfmac_f32_16x16x64_bf16 v[156:159], v[20:23], v[104:111], v3
  s_waitcnt vmcnt(5)
  v_smfmac_f32_16x16x64_bf16 v[156:159], v[24:27], v[112:119], v3
  s_waitcnt vmcnt(4)
  v_smfmac_f32_16x16x64_bf16 v[156:159], v[28:31], v[120:127], v3
  s_waitcnt vmcnt(3)
  v_smfmac_f32_16x16x64_bf16 v[156:159], v[32:35], v[128:135], v3
  s_waitcnt vmcnt(2)
  v_smfmac_f32_16x16x64_bf16 v[156:159], v[144:147], v[136:143], v3
  s_waitcnt vmcnt(1) lgkmcnt(0)
  v_smfmac_f32_16x16x64_bf16 v[156:159], v[148:151], v[64:71], v3
  s_waitcnt vmcnt(0)
  v_smfmac_f32_16x16x64_bf16 v[156:159], v[152:155], v[72:79], v3
cA_va0_ep:
  s_nop 7
  v_add_f32 v160, v156, v157
  v_add_f32 v161, v158, v159
  v_cmp_u_f32 vcc, v160, v161
  v_mov_b32_dpp v162, v160 row_ror:8 row_mask:0xf bank_mask:0xf
  v_mov_b32_dpp v160, v161 row_ror:8 row_mask:0xf bank_mask:0xc
  s_cbranch_vccnz cA_va0_rp
  v_mov_b32_dpp v161, v162 quad_perm:[0,1,2,3] row_mask:0xf bank_mask:0x3
  v_cvt_pk_bf16_f32 v160, v160, v161
cA_va0_pc:
  buffer_store_dword v160, v1, s[8:11], s21 offen
  s_cmp_lg_u32 s19, 62
  s_cbranch_scc1 cA_va0_nl
  s_mov_b32 s22, 88531968
  buffer_store_dword v160, v1, s[8:11], s22 offen sc1
  s_mov_b64 exec, -1
  s_branch cA_done
cA_va0_nl:
  s_mov_b64 exec, -1
  s_add_u32 s25, s25, 28672
  s_add_u32 s19, s19, 1
  s_mov_b32 s20, s21
  s_branch cA_va0_loop
cA_va0_last:
  s_waitcnt lgkmcnt(0)
  s_barrier
  s_branch cA_done
cA_va0_rp:
  s_cmp_eq_u32 s37, 0
  s_cbranch_scc1 cA_va0_rv
  v_mov_b32_dpp v161, v162 quad_perm:[0,1,2,3] row_mask:0xf bank_mask:0x3
  v_cvt_pk_bf16_f32 v160, v160, v161
  v_min_u32 v160, -2, v160
  s_branch cA_va0_pc
cA_va0_rv:
  buffer_load_dwordx4 v[8:11], v5, s[8:11], s22 offen offset:0 sc1
  buffer_load_dwordx4 v[12:15], v5, s[8:11], s22 offen offset:1024 sc1
  buffer_load_dwordx4 v[16:19], v5, s[8:11], s22 offen offset:2048 sc1
  buffer_load_dwordx4 v[20:23], v5, s[8:11], s22 offen offset:3072 sc1
  buffer_load_dwordx4 v[24:27], v5, s[8:11], s34 offen offset:0 sc1
  buffer_load_dwordx4 v[28:31], v5, s[8:11], s34 offen offset:1024 sc1
  buffer_load_dwordx4 v[32:35], v5, s[8:11], s34 offen offset:2048 sc1
  buffer_load_dwordx4 v[144:147], v5, s[8:11], s34 offen offset:3072 sc1
  buffer_load_dwordx4 v[148:151], v2, s[8:11], s36 offen offset:0 sc1
  buffer_load_dwordx4 v[152:155], v2, s[8:11], s36 offen offset:1024 sc1
  s_waitcnt vmcnt(0)
  v_max3_u32 v175, v8, v9, v10
  v_max3_u32 v175, v175, v11, v12
  v_max3_u32 v175, v175, v13, v14
  v_max3_u32 v175, v175, v15, v16
  v_max3_u32 v175, v175, v17, v18
  v_max3_u32 v175, v175, v19, v20
  v_max3_u32 v175, v175, v21, v22
  v_max3_u32 v175, v175, v23, v24
  v_max3_u32 v175, v175, v25, v26
  v_max3_u32 v175, v175, v27, v28
  v_max3_u32 v175, v175, v29, v30
  v_max3_u32 v175, v175, v31, v32
  v_max3_u32 v175, v175, v33, v34
  v_max3_u32 v175, v175, v35, v144
  v_max3_u32 v175, v175, v145, v146
  v_max3_u32 v175, v175, v147, v148
  v_max3_u32 v175, v175, v149, v150
  v_max3_u32 v175, v175, v151, v152
  v_max3_u32 v175, v175, v153, v154
  v_max_u32 v175, v175, v155
  v_cmp_eq_u32 vcc, -1, v175
  s_cbranch_vccz cA_va0_rk
  s_add_u32 s30, s30, 1
  s_cmp_lt_u32 s30, 400000
  s_cbranch_scc1 cA_va0_rv
  s_branch cA_abort
cA_va0_rk:
  s_mov_b32 s37, 1
  s_add_u32 s31, s31, 0x10000
  v_mov_b32 v156, 0
  v_mov_b32 v157, 0
  v_mov_b32 v158, 0
  v_mov_b32 v159, 0
  s_nop 1
  v_smfmac_f32_16x16x64_bf16 v[156:159], v[8:11], v[80:87], v3
  v_smfmac_f32_16x16x64_bf16 v[156:159], v[12:15], v[88:95], v3
  v_smfmac_f32_16x16x64_bf16 v[156:159], v[16:19], v[96:103], v3
  v_smfmac_f32_16x16x64_bf16 v[156:159], v[20:23], v[104:111], v3
  v_smfmac_f32_16x16x64_bf16 v[156:159], v[24:27], v[112:119], v3
  v_smfmac_f32_16x16x64_bf16 v[156:159], v[28:31], v[120:127], v3
  v_smfmac_f32_16x16x64_bf16 v[156:159], v[32:35], v[128:135], v3
  v_smfmac_f32_16x16x64_bf16 v[156:159], v[144:147], v[136:143], v3
  v_smfmac_f32_16x16x64_bf16 v[156:159], v[148:151], v[64:71], v3
  v_smfmac_f32_16x16x64_bf16 v[156:159], v[152:155], v[72:79], v3
  s_nop 7
  s_branch cA_va0_ep
.p2align 6

cA_va1_loop:
  s_add_u32 s23, s20, 4096
  s_add_u32 s21, s20, 20480
  s_mov_b32 s30, 0
  s_cmp_lg_u32 s19, s38
  s_cbranch_scc1 cA_va1_vok
  s_branch cA_va1_voc
cA_va1_vow:
  s_sub_u32 s22, s39, s35
  v_lshlrev_b32 v63, 7, v2
  v_min_u32 v63, s22, v63
  buffer_load_dword v63, v63, s[8:11], s35 offen sc1
  s_waitcnt vmcnt(0)
cA_va1_voc:
  v_readfirstlane_b32 s22, v63
  s_cmp_eq_u32 s22, 56
  s_cbranch_scc1 cA_va1_vod
  s_sleep 1
  s_add_u32 s30, s30, 1
  s_cmp_lt_u32 s30, 400000
  s_cbranch_scc1 cA_va1_vow
  s_branch cA_abort
cA_va1_vod:
  s_add_u32 s35, s35, 2048
  s_add_u32 s38, s19, 8
  s_and_b32 s38, s38, -8
  s_cmp_eq_u32 s19, 0
  s_cselect_b32 s38, 4, s38
  v_cmp_ne_u32 vcc, 56, v63
  s_nop 3
  s_cmp_eq_u64 vcc, 0
  s_cselect_b32 s38, 99, s38
cA_va1_vok:
  s_cmp_eq_u32 s19, 63
  s_cbranch_scc1 cA_done
  s_barrier
  s_add_u32 s22, s25, 0
  buffer_load_dwordx4 v[80:83], v6, s[8:11], s22 offen offset:0 sc1
  buffer_load_dwordx4 v[84:87], v6, s[8:11], s22 offen offset:1792 sc1
  s_add_u32 s22, s25, 3584
  buffer_load_dwordx4 v[88:91], v6, s[8:11], s22 offen offset:0 sc1
  buffer_load_dwordx4 v[92:95], v6, s[8:11], s22 offen offset:1792 sc1
  s_add_u32 s22, s25, 7168
  buffer_load_dwordx4 v[96:99], v6, s[8:11], s22 offen offset:0 sc1
  buffer_load_dwordx4 v[100:103], v6, s[8:11], s22 offen offset:1792 sc1
  s_add_u32 s22, s25, 10752
  buffer_load_dwordx4 v[104:107], v6, s[8:11], s22 offen offset:0 sc1
  buffer_load_dwordx4 v[108:111], v6, s[8:11], s22 offen offset:1792 sc1
  s_add_u32 s22, s25, 14336
  buffer_load_dwordx4 v[112:115], v6, s[8:11], s22 offen offset:0 sc1
  buffer_load_dwordx4 v[116:119], v6, s[8:11], s22 offen offset:1792 sc1
  s_add_u32 s22, s25, 17920
  buffer_load_dwordx4 v[120:123], v6, s[8:11], s22 offen offset:0 sc1
  buffer_load_dwordx4 v[124:127], v6, s[8:11], s22 offen offset:1792 sc1
  s_add_u32 s22, s19, 1
  s_cmp_lg_u32 s22, s38
  s_cbranch_scc1 cA_va1_nk
  s_sub_u32 s22, s39, s35
  v_lshlrev_b32 v63, 7, v2
  v_min_u32 v63, s22, v63
  buffer_load_dword v63, v63, s[8:11], s35 offen sc1
cA_va1_nk:
  s_barrier
  ds_read_b128 v[8:11], v0 offset:8192
  ds_read_b128 v[12:15], v0 offset:9216
  ds_read_b128 v[16:19], v0 offset:10240
  ds_read_b128 v[20:23], v0 offset:11264
  ds_read_b128 v[24:27], v0 offset:12288
  ds_read_b128 v[28:31], v0 offset:13312
  ds_read_b128 v[32:35], v0 offset:14336
  s_waitcnt lgkmcnt(0)
  v_smfmac_f32_16x16x64_bf16 v[36:39], v[8:11], a[0:7], v3
  s_add_u32 s22, s25, 21504
  buffer_load_dwordx4 v[128:131], v6, s[8:11], s22 offen offset:0 sc1
  v_smfmac_f32_16x16x64_bf16 v[36:39], v[12:15], a[8:15], v3
  v_smfmac_f32_16x16x64_bf16 v[36:39], v[16:19], a[16:23], v3
  s_add_u32 s22, s25, 21504
  buffer_load_dwordx4 v[132:135], v6, s[8:11], s22 offen offset:1792 sc1
  v_smfmac_f32_16x16x64_bf16 v[36:39], v[20:23], a[24:31], v3
  v_smfmac_f32_16x16x64_bf16 v[36:39], v[24:27], a[32:39], v3
  s_add_u32 s22, s25, 25088
  buffer_load_dwordx4 v[136:139], v6, s[8:11], s22 offen offset:0 sc1
  v_smfmac_f32_16x16x64_bf16 v[36:39], v[28:31], a[40:47], v3
  v_smfmac_f32_16x16x64_bf16 v[36:39], v[32:35], a[48:55], v3
  s_add_u32 s22, s25, 25088
  buffer_load_dwordx4 v[140:143], v6, s[8:11], s22 offen offset:1792 sc1
  v_smfmac_f32_16x16x64_bf16 v[40:43], v[8:11], a[56:63], v3
  v_smfmac_f32_16x16x64_bf16 v[40:43], v[12:15], a[64:71], v3
  v_smfmac_f32_16x16x64_bf16 v[40:43], v[16:19], a[72:79], v3
  v_add_f32 v36, v36, v37
  v_smfmac_f32_16x16x64_bf16 v[40:43], v[20:23], a[80:87], v3
  v_add_f32 v38, v38, v39
  v_smfmac_f32_16x16x64_bf16 v[40:43], v[24:27], a[88:95], v3
  v_cvt_pk_bf16_f32 v36, v36, v38
  v_smfmac_f32_16x16x64_bf16 v[40:43], v[28:31], a[96:103], v3
  ds_write_b32 v60, v36
  v_smfmac_f32_16x16x64_bf16 v[40:43], v[32:35], a[104:111], v3
  v_smfmac_f32_16x16x64_bf16 v[44:47], v[8:11], a[112:119], v3
  v_smfmac_f32_16x16x64_bf16 v[44:47], v[12:15], a[120:127], v3
  v_smfmac_f32_16x16x64_bf16 v[44:47], v[16:19], a[128:135], v3
  v_add_f32 v40, v40, v41
  v_smfmac_f32_16x16x64_bf16 v[44:47], v[20:23], a[136:143], v3
  v_add_f32 v42, v42, v43
  v_smfmac_f32_16x16x64_bf16 v[44:47], v[24:27], a[144:151], v3
  v_cvt_pk_bf16_f32 v40, v40, v42
  v_smfmac_f32_16x16x64_bf16 v[44:47], v[28:31], a[152:159], v3
  ds_write_b32 v61, v40
  v_smfmac_f32_16x16x64_bf16 v[44:47], v[32:35], a[160:167], v3
  v_smfmac_f32_16x16x64_bf16 v[48:51], v[8:11], a[168:175], v3
  v_smfmac_f32_16x16x64_bf16 v[48:51], v[12:15], a[176:183], v3
  v_smfmac_f32_16x16x64_bf16 v[48:51], v[16:19], a[184:191], v3
  v_add_f32 v44, v44, v45
  v_smfmac_f32_16x16x64_bf16 v[48:51], v[20:23], a[192:199], v3
  v_add_f32 v46, v46, v47
  v_smfmac_f32_16x16x64_bf16 v[48:51], v[24:27], a[200:207], v3
  v_cvt_pk_bf16_f32 v44, v44, v46
  v_smfmac_f32_16x16x64_bf16 v[48:51], v[28:31], a[208:215], v3
  ds_write_b32 v62, v44
  v_smfmac_f32_16x16x64_bf16 v[48:51], v[32:35], a[216:223], v3
  v_smfmac_f32_16x16x64_bf16 v[52:55], v[8:11], a[224:231], v3
  v_smfmac_f32_16x16x64_bf16 v[52:55], v[12:15], a[232:239], v3
  v_smfmac_f32_16x16x64_bf16 v[52:55], v[16:19], a[240:247], v3
  v_add_f32 v48, v48, v49
  v_smfmac_f32_16x16x64_bf16 v[52:55], v[20:23], a[248:255], v3
  v_add_f32 v50, v50, v51
  v_smfmac_f32_16x16x64_bf16 v[52:55], v[24:27], v[176:183], v3
  v_cvt_pk_bf16_f32 v48, v48, v50
  v_smfmac_f32_16x16x64_bf16 v[52:55], v[28:31], v[184:191], v3
  ds_write_b32 v170, v48
  v_smfmac_f32_16x16x64_bf16 v[52:55], v[32:35], v[192:199], v3
  v_smfmac_f32_16x16x64_bf16 v[56:59], v[8:11], v[200:207], v3
  v_smfmac_f32_16x16x64_bf16 v[56:59], v[12:15], v[208:215], v3
  v_smfmac_f32_16x16x64_bf16 v[56:59], v[16:19], v[216:223], v3
  v_add_f32 v52, v52, v53
  v_smfmac_f32_16x16x64_bf16 v[56:59], v[20:23], v[224:231], v3
  v_add_f32 v54, v54, v55
  v_smfmac_f32_16x16x64_bf16 v[56:59], v[24:27], v[232:239], v3
  v_cvt_pk_bf16_f32 v52, v52, v54
  v_smfmac_f32_16x16x64_bf16 v[56:59], v[28:31], v[240:247], v3
  ds_write_b32 v171, v52
  v_smfmac_f32_16x16x64_bf16 v[56:59], v[32:35], v[248:255], v3
  s_nop 7
  v_add_f32 v56, v56, v57
  v_add_f32 v58, v58, v59
  v_cvt_pk_bf16_f32 v56, v56, v58
  ds_write_b32 v172, v56
  s_waitcnt lgkmcnt(0)
  v_mov_b32 v36, 0
  v_mov_b32 v37, 0
  v_mov_b32 v38, 0
  v_mov_b32 v39, 0
  v_mov_b32 v40, 0
  v_mov_b32 v41, 0
  v_mov_b32 v42, 0
  v_mov_b32 v43, 0
  v_mov_b32 v44, 0
  v_mov_b32 v45, 0
  v_mov_b32 v46, 0
  v_mov_b32 v47, 0
  v_mov_b32 v48, 0
  v_mov_b32 v49, 0
  v_mov_b32 v50, 0
  v_mov_b32 v51, 0
  v_mov_b32 v52, 0
  v_mov_b32 v53, 0
  v_mov_b32 v54, 0
  v_mov_b32 v55, 0
  v_mov_b32 v56, 0
  v_mov_b32 v57, 0
  v_mov_b32 v58, 0
  v_mov_b32 v59, 0
  s_cmp_eq_u32 s19, 63
  s_cbranch_scc1 cA_va1_last
  s_add_u32 s22, s20, 9216
  s_add_u32 s34, s20, 13312
  s_add_u32 s36, s20, 7168
  s_mov_b32 s37, 0
  v_mov_b32 v156, 0
  v_mov_b32 v157, 0
  v_mov_b32 v158, 0
  v_mov_b32 v159, 0
  s_barrier
  s_waitcnt lgkmcnt(0)
  buffer_load_dwordx4 v[8:11], v5, s[8:11], s22 offen offset:0
  buffer_load_dwordx4 v[12:15], v5, s[8:11], s22 offen offset:1024
  buffer_load_dwordx4 v[16:19], v5, s[8:11], s22 offen offset:2048
  buffer_load_dwordx4 v[20:23], v5, s[8:11], s22 offen offset:3072
  buffer_load_dwordx4 v[24:27], v5, s[8:11], s34 offen offset:0
  buffer_load_dwordx4 v[28:31], v5, s[8:11], s34 offen offset:1024
  buffer_load_dwordx4 v[32:35], v5, s[8:11], s34 offen offset:2048
  buffer_load_dwordx4 v[144:147], v5, s[8:11], s34 offen offset:3072
  s_sub_u32 s23, s21, 4
  s_mov_b64 exec, 65535
  buffer_store_dword v2, v7, s[8:11], s23 offen
  s_mov_b64 exec, -1
  buffer_load_dwordx4 v[148:151], v2, s[8:11], s36 offen offset:0
  buffer_load_dwordx4 v[152:155], v2, s[8:11], s36 offen offset:1024
  ds_read_b128 v[64:67], v2 offset:4096
  ds_read_b128 v[68:71], v2 offset:5120
  ds_read_b128 v[72:75], v2 offset:6144
  ds_read_b128 v[76:79], v2 offset:7168
  s_waitcnt vmcnt(10)
  v_smfmac_f32_16x16x64_bf16 v[156:159], v[8:11], v[80:87], v3
  s_waitcnt vmcnt(9)
  v_smfmac_f32_16x16x64_bf16 v[156:159], v[12:15], v[88:95], v3
  s_waitcnt vmcnt(8)
  v_smfmac_f32_16x16x64_bf16 v[156:159], v[16:19], v[96:103], v3
  s_waitcnt vmcnt(7)
  v_smfmac_f32_16x16x64_bf16 v[156:159], v[20:23], v[104:111], v3
  s_waitcnt vmcnt(6)
  v_smfmac_f32_16x16x64_bf16 v[156:159], v[24:27], v[112:119], v3
  s_mov_b64 exec, 65535
  buffer_store_dword v2, v7, s[8:11], s21 offen
  s_mov_b64 exec, -1
  s_waitcnt vmcnt(6)
  v_smfmac_f32_16x16x64_bf16 v[156:159], v[28:31], v[120:127], v3
  s_waitcnt vmcnt(5)
  v_smfmac_f32_16x16x64_bf16 v[156:159], v[32:35], v[128:135], v3
  s_waitcnt vmcnt(4)
  v_smfmac_f32_16x16x64_bf16 v[156:159], v[144:147], v[136:143], v3
  s_waitcnt vmcnt(2) lgkmcnt(0)
  v_smfmac_f32_16x16x64_bf16 v[156:159], v[148:151], v[64:71], v3
  s_waitcnt vmcnt(1)
  v_smfmac_f32_16x16x64_bf16 v[156:159], v[152:155], v[72:79], v3
cA_va1_ep:
  s_nop 7
  v_add_f32 v160, v156, v157
  v_add_f32 v161, v158, v159
  v_cmp_u_f32 vcc, v160, v161
  v_mov_b32_dpp v162, v160 row_ror:8 row_mask:0xf bank_mask:0xf
  v_mov_b32_dpp v160, v161 row_ror:8 row_mask:0xf bank_mask:0xc
  s_cbranch_vccnz cA_va1_rp
  v_mov_b32_dpp v161, v162 quad_perm:[0,1,2,3] row_mask:0xf bank_mask:0x3
  v_cvt_pk_bf16_f32 v160, v160, v161
cA_va1_pc:
  s_mov_b64 exec, s[26:27]
  buffer_store_dword v160, v1, s[8:11], s21 offen
  s_cmp_lg_u32 s19, 62
  s_cbranch_scc1 cA_va1_nl
  s_mov_b32 s22, 88531968
  buffer_store_dword v160, v1, s[8:11], s22 offen sc1
  s_mov_b64 exec, -1
  s_branch cA_done
cA_va1_nl:
  s_mov_b64 exec, -1
  s_cmp_lg_u32 s19, 0
  s_cbranch_scc1 cA_va1_s0
  v_add_u32 v7, 512, v7
  v_lshl_add_u32 v7, v2, 3, v7
  s_mov_b64 exec, 65535
  buffer_store_dword v2, v7, s[8:11], s21 offen
  buffer_store_dword v2, v7, s[8:11], s23 offen
  s_mov_b64 exec, -1
cA_va1_s0:
  s_add_u32 s25, s25, 28672
  s_add_u32 s19, s19, 1
  s_mov_b32 s20, s21
  s_branch cA_va1_loop
cA_va1_last:
  s_waitcnt lgkmcnt(0)
  s_barrier
  s_branch cA_done
cA_va1_rp:
  s_cmp_eq_u32 s37, 0
  s_cbranch_scc1 cA_va1_rv
  v_mov_b32_dpp v161, v162 quad_perm:[0,1,2,3] row_mask:0xf bank_mask:0x3
  v_cvt_pk_bf16_f32 v160, v160, v161
  v_min_u32 v160, -2, v160
  s_branch cA_va1_pc
cA_va1_rv:
  buffer_load_dwordx4 v[8:11], v5, s[8:11], s22 offen offset:0 sc1
  buffer_load_dwordx4 v[12:15], v5, s[8:11], s22 offen offset:1024 sc1
  buffer_load_dwordx4 v[16:19], v5, s[8:11], s22 offen offset:2048 sc1
  buffer_load_dwordx4 v[20:23], v5, s[8:11], s22 offen offset:3072 sc1
  buffer_load_dwordx4 v[24:27], v5, s[8:11], s34 offen offset:0 sc1
  buffer_load_dwordx4 v[28:31], v5, s[8:11], s34 offen offset:1024 sc1
  buffer_load_dwordx4 v[32:35], v5, s[8:11], s34 offen offset:2048 sc1
  buffer_load_dwordx4 v[144:147], v5, s[8:11], s34 offen offset:3072 sc1
  buffer_load_dwordx4 v[148:151], v2, s[8:11], s36 offen offset:0 sc1
  buffer_load_dwordx4 v[152:155], v2, s[8:11], s36 offen offset:1024 sc1
  s_waitcnt vmcnt(0)
  v_max3_u32 v175, v8, v9, v10
  v_max3_u32 v175, v175, v11, v12
  v_max3_u32 v175, v175, v13, v14
  v_max3_u32 v175, v175, v15, v16
  v_max3_u32 v175, v175, v17, v18
  v_max3_u32 v175, v175, v19, v20
  v_max3_u32 v175, v175, v21, v22
  v_max3_u32 v175, v175, v23, v24
  v_max3_u32 v175, v175, v25, v26
  v_max3_u32 v175, v175, v27, v28
  v_max3_u32 v175, v175, v29, v30
  v_max3_u32 v175, v175, v31, v32
  v_max3_u32 v175, v175, v33, v34
  v_max3_u32 v175, v175, v35, v144
  v_max3_u32 v175, v175, v145, v146
  v_max3_u32 v175, v175, v147, v148
  v_max3_u32 v175, v175, v149, v150
  v_max3_u32 v175, v175, v151, v152
  v_max3_u32 v175, v175, v153, v154
  v_max_u32 v175, v175, v155
  v_cmp_eq_u32 vcc, -1, v175
  s_cbranch_vccz cA_va1_rk
  s_add_u32 s30, s30, 1
  s_cmp_lt_u32 s30, 400000
  s_cbranch_scc1 cA_va1_rv
  s_branch cA_abort
cA_va1_rk:
  s_mov_b32 s37, 1
  s_add_u32 s31, s31, 0x10000
  v_mov_b32 v156, 0
  v_mov_b32 v157, 0
  v_mov_b32 v158, 0
  v_mov_b32 v159, 0
  s_nop 1
  v_smfmac_f32_16x16x64_bf16 v[156:159], v[8:11], v[80:87], v3
  v_smfmac_f32_16x16x64_bf16 v[156:159], v[12:15], v[88:95], v3
  v_smfmac_f32_16x16x64_bf16 v[156:159], v[16:19], v[96:103], v3
  v_smfmac_f32_16x16x64_bf16 v[156:159], v[20:23], v[104:111], v3
  v_smfmac_f32_16x16x64_bf16 v[156:159], v[24:27], v[112:119], v3
  v_smfmac_f32_16x16x64_bf16 v[156:159], v[28:31], v[120:127], v3
  v_smfmac_f32_16x16x64_bf16 v[156:159], v[32:35], v[128:135], v3
  v_smfmac_f32_16x16x64_bf16 v[156:159], v[144:147], v[136:143], v3
  v_smfmac_f32_16x16x64_bf16 v[156:159], v[148:151], v[64:71], v3
  v_smfmac_f32_16x16x64_bf16 v[156:159], v[152:155], v[72:79], v3
  s_nop 7
  s_branch cA_va1_ep
.p2align 6

cA_va2_loop:
  s_add_u32 s23, s20, 4096
  s_add_u32 s21, s20, 20480
  v_mov_b32 v36, 0
  v_mov_b32 v37, 0
  v_mov_b32 v38, 0
  v_mov_b32 v39, 0
  v_mov_b32 v40, 0
  v_mov_b32 v41, 0
  v_mov_b32 v42, 0
  v_mov_b32 v43, 0
  v_mov_b32 v44, 0
  v_mov_b32 v45, 0
  v_mov_b32 v46, 0
  v_mov_b32 v47, 0
  v_mov_b32 v48, 0
  v_mov_b32 v49, 0
  v_mov_b32 v50, 0
  v_mov_b32 v51, 0
  v_mov_b32 v52, 0
  v_mov_b32 v53, 0
  v_mov_b32 v54, 0
  v_mov_b32 v55, 0
  v_mov_b32 v56, 0
  v_mov_b32 v57, 0
  v_mov_b32 v58, 0
  v_mov_b32 v59, 0
  v_mov_b32 v60, 0
  v_mov_b32 v61, 0
  v_mov_b32 v62, 0
  v_mov_b32 v63, 0
  v_mov_b32 v64, 0
  v_mov_b32 v65, 0
  v_mov_b32 v66, 0
  v_mov_b32 v67, 0
  s_mov_b32 s30, 0
  buffer_load_dword v76, v119, s[8:11], s20 offen sc1
  buffer_load_dword v77, v119, s[8:11], s20 offen sc1
  buffer_load_dword v78, v119, s[8:11], s20 offen sc1
cA_va2_fp_l:
  s_waitcnt vmcnt(2)
  v_cmp_eq_u32 vcc, -1, v76
  s_cbranch_vccz cA_va2_fp_d
  buffer_load_dword v76, v119, s[8:11], s20 offen sc1
  s_waitcnt vmcnt(2)
  v_cmp_eq_u32 vcc, -1, v77
  s_cbranch_vccz cA_va2_fp_d
  buffer_load_dword v77, v119, s[8:11], s20 offen sc1
  s_waitcnt vmcnt(2)
  v_cmp_eq_u32 vcc, -1, v78
  s_cbranch_vccz cA_va2_fp_d
  buffer_load_dword v78, v119, s[8:11], s20 offen sc1
  s_add_u32 s30, s30, 1
  s_cmp_lt_u32 s30, 400000
  s_cbranch_scc1 cA_va2_fp_l
  s_branch cA_abort
cA_va2_fp_d:
  buffer_load_dwordx4 v[8:11], v2, s[8:11], s20 offen offset:0 sc1
  buffer_load_dwordx4 v[12:15], v2, s[8:11], s20 offen offset:1024 sc1
  buffer_load_dwordx4 v[16:19], v2, s[8:11], s20 offen offset:2048 sc1
  buffer_load_dwordx4 v[20:23], v2, s[8:11], s20 offen offset:3072 sc1
  s_barrier
cA_va2_ld:
  s_waitcnt vmcnt(0)
  v_max3_u32 v84, v8, v9, v10
  v_max3_u32 v84, v84, v11, v12
  v_max3_u32 v84, v84, v13, v14
  v_max3_u32 v84, v84, v15, v16
  v_max3_u32 v84, v84, v17, v18
  v_max3_u32 v84, v84, v19, v20
  v_max3_u32 v84, v84, v21, v22
  v_max_u32 v84, v84, v23
  v_cmp_eq_u32 vcc, -1, v84
  ds_write_b128 v2, v[8:11] offset:8192
  ds_write_b128 v2, v[12:15] offset:9216
  ds_write_b128 v2, v[16:19] offset:10240
  ds_write_b128 v2, v[20:23] offset:11264
  s_cbranch_vccnz cA_va2_retry
  s_waitcnt lgkmcnt(0)
  s_barrier
  ds_read_b128 v[8:11], v5 offset:8192
  ds_read_b128 v[12:15], v5 offset:9216
  ds_read_b128 v[16:19], v5 offset:10240
  ds_read_b128 v[20:23], v5 offset:11264
  ds_read_b128 v[24:27], v5 offset:12288
  ds_read_b128 v[28:31], v5 offset:13312
  ds_read_b128 v[32:35], v5 offset:14336
  ds_read_b128 v[92:95], v0
  s_waitcnt lgkmcnt(0)
  s_mov_b64 exec, s[26:27]
  buffer_store_dwordx4 v[92:95], v2, s[8:11], s36 offen sc1
  s_mov_b64 exec, -1
  s_add_u32 s36, s36, 7168
  s_cmp_eq_u32 s19, 63
  s_cbranch_scc1 cA_done
  ds_read_b128 v[76:79], v1 offset:0
  ds_read_b128 v[80:83], v1 offset:1024
  ds_read_b128 v[84:87], v1 offset:2048
  ds_read_b128 v[88:91], v1 offset:3072
  ds_read_b128 v[92:95], v1 offset:4096
  ds_read_b128 v[96:99], v1 offset:5120
  v_smfmac_f32_16x16x64_bf16 v[60:63], v[8:11], v[200:207], v3
  v_smfmac_f32_16x16x64_bf16 v[60:63], v[12:15], v[208:215], v3
  s_waitcnt lgkmcnt(4)
  v_smfmac_f32_16x16x64_bf16 v[64:67], v[8:11], v[76:83], v3
  ds_read_b128 v[76:79], v1 offset:6144
  ds_read_b128 v[80:83], v1 offset:7168
  v_smfmac_f32_16x16x64_bf16 v[60:63], v[16:19], v[216:223], v3
  v_smfmac_f32_16x16x64_bf16 v[60:63], v[20:23], v[224:231], v3
  s_waitcnt lgkmcnt(4)
  v_smfmac_f32_16x16x64_bf16 v[64:67], v[12:15], v[84:91], v3
  ds_read_b128 v[84:87], v1 offset:8192
  ds_read_b128 v[88:91], v1 offset:9216
  v_smfmac_f32_16x16x64_bf16 v[60:63], v[24:27], v[232:239], v3
  v_smfmac_f32_16x16x64_bf16 v[60:63], v[28:31], v[240:247], v3
  s_waitcnt lgkmcnt(4)
  v_smfmac_f32_16x16x64_bf16 v[64:67], v[16:19], v[92:99], v3
  ds_read_b128 v[92:95], v1 offset:10240
  ds_read_b128 v[96:99], v1 offset:11264
  v_smfmac_f32_16x16x64_bf16 v[60:63], v[32:35], v[248:255], v3
  v_smfmac_f32_16x16x64_bf16 v[36:39], v[8:11], a[0:7], v3
  s_waitcnt lgkmcnt(4)
  v_smfmac_f32_16x16x64_bf16 v[64:67], v[20:23], v[76:83], v3
  ds_read_b128 v[76:79], v1 offset:12288
  ds_read_b128 v[80:83], v1 offset:13312
  v_smfmac_f32_16x16x64_bf16 v[36:39], v[12:15], a[8:15], v3
  v_add_f32 v60, v60, v61
  v_smfmac_f32_16x16x64_bf16 v[36:39], v[16:19], a[16:23], v3
  v_add_f32 v62, v62, v63
  s_waitcnt lgkmcnt(4)
  v_smfmac_f32_16x16x64_bf16 v[64:67], v[24:27], v[84:91], v3
  v_cvt_pk_bf16_f32 v60, v60, v62
  v_smfmac_f32_16x16x64_bf16 v[36:39], v[20:23], a[24:31], v3
  ds_write_b32 v106, v60
  v_smfmac_f32_16x16x64_bf16 v[36:39], v[24:27], a[32:39], v3
  s_waitcnt lgkmcnt(2)
  v_smfmac_f32_16x16x64_bf16 v[64:67], v[28:31], v[92:99], v3
  v_smfmac_f32_16x16x64_bf16 v[36:39], v[28:31], a[40:47], v3
  v_smfmac_f32_16x16x64_bf16 v[36:39], v[32:35], a[48:55], v3
  s_waitcnt lgkmcnt(0)
  v_smfmac_f32_16x16x64_bf16 v[64:67], v[32:35], v[76:83], v3
  v_smfmac_f32_16x16x64_bf16 v[40:43], v[8:11], a[56:63], v3
  v_smfmac_f32_16x16x64_bf16 v[40:43], v[12:15], a[64:71], v3
  v_add_f32 v36, v36, v37
  v_smfmac_f32_16x16x64_bf16 v[40:43], v[16:19], a[72:79], v3
  v_add_f32 v38, v38, v39
  v_smfmac_f32_16x16x64_bf16 v[40:43], v[20:23], a[80:87], v3
  v_cvt_pk_bf16_f32 v36, v36, v38
  v_smfmac_f32_16x16x64_bf16 v[40:43], v[24:27], a[88:95], v3
  ds_write_b32 v100, v36
  v_smfmac_f32_16x16x64_bf16 v[40:43], v[28:31], a[96:103], v3
  v_add_f32 v64, v64, v65
  v_smfmac_f32_16x16x64_bf16 v[40:43], v[32:35], a[104:111], v3
  v_add_f32 v66, v66, v67
  v_smfmac_f32_16x16x64_bf16 v[44:47], v[8:11], a[112:119], v3
  v_cvt_pk_bf16_f32 v64, v64, v66
  v_smfmac_f32_16x16x64_bf16 v[44:47], v[12:15], a[120:127], v3
  ds_write_b32 v107, v64
  v_smfmac_f32_16x16x64_bf16 v[44:47], v[16:19], a[128:135], v3
  v_add_f32 v40, v40, v41
  v_smfmac_f32_16x16x64_bf16 v[44:47], v[20:23], a[136:143], v3
  v_add_f32 v42, v42, v43
  v_smfmac_f32_16x16x64_bf16 v[44:47], v[24:27], a[144:151], v3
  v_cvt_pk_bf16_f32 v40, v40, v42
  v_smfmac_f32_16x16x64_bf16 v[44:47], v[28:31], a[152:159], v3
  ds_write_b32 v101, v40
  v_smfmac_f32_16x16x64_bf16 v[44:47], v[32:35], a[160:167], v3
  v_smfmac_f32_16x16x64_bf16 v[48:51], v[8:11], a[168:175], v3
  v_smfmac_f32_16x16x64_bf16 v[48:51], v[12:15], a[176:183], v3
  v_smfmac_f32_16x16x64_bf16 v[48:51], v[16:19], a[184:191], v3
  v_add_f32 v44, v44, v45
  v_smfmac_f32_16x16x64_bf16 v[48:51], v[20:23], a[192:199], v3
  v_add_f32 v46, v46, v47
  v_smfmac_f32_16x16x64_bf16 v[48:51], v[24:27], a[200:207], v3
  v_cvt_pk_bf16_f32 v44, v44, v46
  v_smfmac_f32_16x16x64_bf16 v[48:51], v[28:31], a[208:215], v3
  ds_write_b32 v102, v44
  v_smfmac_f32_16x16x64_bf16 v[48:51], v[32:35], a[216:223], v3
  v_smfmac_f32_16x16x64_bf16 v[52:55], v[8:11], a[224:231], v3
  v_smfmac_f32_16x16x64_bf16 v[52:55], v[12:15], a[232:239], v3
  v_smfmac_f32_16x16x64_bf16 v[52:55], v[16:19], a[240:247], v3
  v_add_f32 v48, v48, v49
  v_smfmac_f32_16x16x64_bf16 v[52:55], v[20:23], a[248:255], v3
  v_add_f32 v50, v50, v51
  v_smfmac_f32_16x16x64_bf16 v[52:55], v[24:27], v[120:127], v3
  v_cvt_pk_bf16_f32 v48, v48, v50
  v_smfmac_f32_16x16x64_bf16 v[52:55], v[28:31], v[128:135], v3
  ds_write_b32 v103, v48
  v_smfmac_f32_16x16x64_bf16 v[52:55], v[32:35], v[136:143], v3
  v_smfmac_f32_16x16x64_bf16 v[56:59], v[8:11], v[144:151], v3
  v_smfmac_f32_16x16x64_bf16 v[56:59], v[12:15], v[152:159], v3
  v_smfmac_f32_16x16x64_bf16 v[56:59], v[16:19], v[160:167], v3
  v_add_f32 v52, v52, v53
  v_smfmac_f32_16x16x64_bf16 v[56:59], v[20:23], v[168:175], v3
  v_add_f32 v54, v54, v55
  v_smfmac_f32_16x16x64_bf16 v[56:59], v[24:27], v[176:183], v3
  v_cvt_pk_bf16_f32 v52, v52, v54
  v_smfmac_f32_16x16x64_bf16 v[56:59], v[28:31], v[184:191], v3
  ds_write_b32 v104, v52
  v_smfmac_f32_16x16x64_bf16 v[56:59], v[32:35], v[192:199], v3
  s_nop 7
  v_add_f32 v56, v56, v57
  v_add_f32 v58, v58, v59
  v_cvt_pk_bf16_f32 v56, v56, v58
  ds_write_b32 v105, v56
  s_waitcnt lgkmcnt(0)
  s_barrier
  s_cmp_eq_u32 s19, 62
  s_cbranch_scc1 cA_done
  s_waitcnt vmcnt(0) lgkmcnt(0)
  s_add_u32 s19, s19, 1
  s_mov_b32 s20, s21
  s_branch cA_va2_loop
cA_va2_retry:
  s_waitcnt lgkmcnt(0)
  buffer_load_dwordx4 v[8:11], v2, s[8:11], s20 offen offset:0 sc1
  buffer_load_dwordx4 v[12:15], v2, s[8:11], s20 offen offset:1024 sc1
  buffer_load_dwordx4 v[16:19], v2, s[8:11], s20 offen offset:2048 sc1
  buffer_load_dwordx4 v[20:23], v2, s[8:11], s20 offen offset:3072 sc1
  s_add_u32 s31, s31, 1
  s_add_u32 s30, s30, 1
  s_cmp_lt_u32 s30, 400000
  s_cbranch_scc1 cA_va2_ld
  s_branch cA_abort
cA_va2_last:
  s_waitcnt lgkmcnt(0)
  buffer_store_dwordx4 v[100:103], v2, s[8:11], s24 offen offset:0 sc1
  buffer_store_dwordx4 v[104:107], v2, s[8:11], s24 offen offset:1024 sc1
  buffer_store_dwordx4 v[108:111], v2, s[8:11], s24 offen offset:2048 sc1
  buffer_store_dwordx4 v[4:7], v2, s[8:11], s24 offen offset:3072 sc1
  s_add_u32 s24, s24, 8192
  s_waitcnt vmcnt(0)
  s_mov_b64 exec, 1
  buffer_store_dword v117, v2, s[8:11], s34 offen sc1
  s_mov_b64 exec, -1
  s_add_u32 s34, s34, 8
  s_mov_b64 exec, 1
  buffer_store_dword v117, v2, s[8:11], s34 offen sc1
  s_mov_b64 exec, -1
  s_add_u32 s34, s34, 8
  s_branch cA_done
.p2align 6

cA_va3_loop:
  s_add_u32 s23, s20, 4096
  s_add_u32 s21, s20, 20480
  v_mov_b32 v36, 0
  v_mov_b32 v37, 0
  v_mov_b32 v38, 0
  v_mov_b32 v39, 0
  v_mov_b32 v40, 0
  v_mov_b32 v41, 0
  v_mov_b32 v42, 0
  v_mov_b32 v43, 0
  v_mov_b32 v44, 0
  v_mov_b32 v45, 0
  v_mov_b32 v46, 0
  v_mov_b32 v47, 0
  v_mov_b32 v48, 0
  v_mov_b32 v49, 0
  v_mov_b32 v50, 0
  v_mov_b32 v51, 0
  v_mov_b32 v52, 0
  v_mov_b32 v53, 0
  v_mov_b32 v54, 0
  v_mov_b32 v55, 0
  v_mov_b32 v56, 0
  v_mov_b32 v57, 0
  v_mov_b32 v58, 0
  v_mov_b32 v59, 0
  v_mov_b32 v60, 0
  v_mov_b32 v61, 0
  v_mov_b32 v62, 0
  v_mov_b32 v63, 0
  v_mov_b32 v64, 0
  v_mov_b32 v65, 0
  v_mov_b32 v66, 0
  v_mov_b32 v67, 0
  s_mov_b32 s30, 0
  buffer_load_dword v76, v119, s[8:11], s20 offen sc1
  buffer_load_dword v77, v119, s[8:11], s20 offen sc1
  buffer_load_dword v78, v119, s[8:11], s20 offen sc1
cA_va3_fp_l:
  s_waitcnt vmcnt(2)
  v_cmp_eq_u32 vcc, -1, v76
  s_cbranch_vccz cA_va3_fp_d
  buffer_load_dword v76, v119, s[8:11], s20 offen sc1
  s_waitcnt vmcnt(2)
  v_cmp_eq_u32 vcc, -1, v77
  s_cbranch_vccz cA_va3_fp_d
  buffer_load_dword v77, v119, s[8:11], s20 offen sc1
  s_waitcnt vmcnt(2)
  v_cmp_eq_u32 vcc, -1, v78
  s_cbranch_vccz cA_va3_fp_d
  buffer_load_dword v78, v119, s[8:11], s20 offen sc1
  s_add_u32 s30, s30, 1
  s_cmp_lt_u32 s30, 400000
  s_cbranch_scc1 cA_va3_fp_l
  s_branch cA_abort
cA_va3_fp_d:
  buffer_load_dwordx4 v[24:27], v2, s[8:11], s23 offen offset:0 sc1
  buffer_load_dwordx4 v[28:31], v2, s[8:11], s23 offen offset:1024 sc1
  buffer_load_dwordx4 v[32:35], v2, s[8:11], s23 offen offset:2048 sc1
  s_barrier
cA_va3_ld:
  s_waitcnt vmcnt(0)
  v_max3_u32 v84, v24, v25, v26
  v_max3_u32 v84, v84, v27, v28
  v_max3_u32 v84, v84, v29, v30
  v_max3_u32 v84, v84, v31, v32
  v_max3_u32 v84, v84, v33, v34
  v_max_u32 v84, v84, v35
  v_cmp_eq_u32 vcc, -1, v84
  ds_write_b128 v2, v[24:27] offset:12288
  ds_write_b128 v2, v[28:31] offset:13312
  ds_write_b128 v2, v[32:35] offset:14336
  s_cbranch_vccnz cA_va3_retry
  s_waitcnt lgkmcnt(0)
  s_barrier
  ds_read_b128 v[8:11], v5 offset:8192
  ds_read_b128 v[12:15], v5 offset:9216
  ds_read_b128 v[16:19], v5 offset:10240
  ds_read_b128 v[20:23], v5 offset:11264
  ds_read_b128 v[24:27], v5 offset:12288
  ds_read_b128 v[28:31], v5 offset:13312
  ds_read_b128 v[32:35], v5 offset:14336
  s_waitcnt lgkmcnt(0)
  s_cmp_eq_u32 s19, 63
  s_cbranch_scc1 cA_done
  ds_read_b128 v[76:79], v1 offset:0
  ds_read_b128 v[80:83], v1 offset:1024
  ds_read_b128 v[84:87], v1 offset:2048
  ds_read_b128 v[88:91], v1 offset:3072
  ds_read_b128 v[92:95], v1 offset:4096
  ds_read_b128 v[96:99], v1 offset:5120
  v_smfmac_f32_16x16x64_bf16 v[60:63], v[8:11], v[200:207], v3
  v_smfmac_f32_16x16x64_bf16 v[60:63], v[12:15], v[208:215], v3
  s_waitcnt lgkmcnt(4)
  v_smfmac_f32_16x16x64_bf16 v[64:67], v[8:11], v[76:83], v3
  ds_read_b128 v[76:79], v1 offset:6144
  ds_read_b128 v[80:83], v1 offset:7168
  v_smfmac_f32_16x16x64_bf16 v[60:63], v[16:19], v[216:223], v3
  v_smfmac_f32_16x16x64_bf16 v[60:63], v[20:23], v[224:231], v3
  s_waitcnt lgkmcnt(4)
  v_smfmac_f32_16x16x64_bf16 v[64:67], v[12:15], v[84:91], v3
  ds_read_b128 v[84:87], v1 offset:8192
  ds_read_b128 v[88:91], v1 offset:9216
  v_smfmac_f32_16x16x64_bf16 v[60:63], v[24:27], v[232:239], v3
  v_smfmac_f32_16x16x64_bf16 v[60:63], v[28:31], v[240:247], v3
  s_waitcnt lgkmcnt(4)
  v_smfmac_f32_16x16x64_bf16 v[64:67], v[16:19], v[92:99], v3
  ds_read_b128 v[92:95], v1 offset:10240
  ds_read_b128 v[96:99], v1 offset:11264
  v_smfmac_f32_16x16x64_bf16 v[60:63], v[32:35], v[248:255], v3
  v_smfmac_f32_16x16x64_bf16 v[36:39], v[8:11], a[0:7], v3
  s_waitcnt lgkmcnt(4)
  v_smfmac_f32_16x16x64_bf16 v[64:67], v[20:23], v[76:83], v3
  ds_read_b128 v[76:79], v1 offset:12288
  ds_read_b128 v[80:83], v1 offset:13312
  v_smfmac_f32_16x16x64_bf16 v[36:39], v[12:15], a[8:15], v3
  v_add_f32 v60, v60, v61
  v_smfmac_f32_16x16x64_bf16 v[36:39], v[16:19], a[16:23], v3
  v_add_f32 v62, v62, v63
  s_waitcnt lgkmcnt(4)
  v_smfmac_f32_16x16x64_bf16 v[64:67], v[24:27], v[84:91], v3
  v_cvt_pk_bf16_f32 v60, v60, v62
  v_smfmac_f32_16x16x64_bf16 v[36:39], v[20:23], a[24:31], v3
  ds_write_b32 v106, v60
  v_smfmac_f32_16x16x64_bf16 v[36:39], v[24:27], a[32:39], v3
  s_waitcnt lgkmcnt(2)
  v_smfmac_f32_16x16x64_bf16 v[64:67], v[28:31], v[92:99], v3
  v_smfmac_f32_16x16x64_bf16 v[36:39], v[28:31], a[40:47], v3
  v_smfmac_f32_16x16x64_bf16 v[36:39], v[32:35], a[48:55], v3
  s_waitcnt lgkmcnt(0)
  v_smfmac_f32_16x16x64_bf16 v[64:67], v[32:35], v[76:83], v3
  v_smfmac_f32_16x16x64_bf16 v[40:43], v[8:11], a[56:63], v3
  v_smfmac_f32_16x16x64_bf16 v[40:43], v[12:15], a[64:71], v3
  v_add_f32 v36, v36, v37
  v_smfmac_f32_16x16x64_bf16 v[40:43], v[16:19], a[72:79], v3
  v_add_f32 v38, v38, v39
  v_smfmac_f32_16x16x64_bf16 v[40:43], v[20:23], a[80:87], v3
  v_cvt_pk_bf16_f32 v36, v36, v38
  v_smfmac_f32_16x16x64_bf16 v[40:43], v[24:27], a[88:95], v3
  ds_write_b32 v100, v36
  v_smfmac_f32_16x16x64_bf16 v[40:43], v[28:31], a[96:103], v3
  v_add_f32 v64, v64, v65
  v_smfmac_f32_16x16x64_bf16 v[40:43], v[32:35], a[104:111], v3
  v_add_f32 v66, v66, v67
  v_smfmac_f32_16x16x64_bf16 v[44:47], v[8:11], a[112:119], v3
  v_cvt_pk_bf16_f32 v64, v64, v66
  v_smfmac_f32_16x16x64_bf16 v[44:47], v[12:15], a[120:127], v3
  ds_write_b32 v107, v64
  v_smfmac_f32_16x16x64_bf16 v[44:47], v[16:19], a[128:135], v3
  v_add_f32 v40, v40, v41
  v_smfmac_f32_16x16x64_bf16 v[44:47], v[20:23], a[136:143], v3
  v_add_f32 v42, v42, v43
  v_smfmac_f32_16x16x64_bf16 v[44:47], v[24:27], a[144:151], v3
  v_cvt_pk_bf16_f32 v40, v40, v42
  v_smfmac_f32_16x16x64_bf16 v[44:47], v[28:31], a[152:159], v3
  ds_write_b32 v101, v40
  v_smfmac_f32_16x16x64_bf16 v[44:47], v[32:35], a[160:167], v3
  v_smfmac_f32_16x16x64_bf16 v[48:51], v[8:11], a[168:175], v3
  v_smfmac_f32_16x16x64_bf16 v[48:51], v[12:15], a[176:183], v3
  v_smfmac_f32_16x16x64_bf16 v[48:51], v[16:19], a[184:191], v3
  v_add_f32 v44, v44, v45
  v_smfmac_f32_16x16x64_bf16 v[48:51], v[20:23], a[192:199], v3
  v_add_f32 v46, v46, v47
  v_smfmac_f32_16x16x64_bf16 v[48:51], v[24:27], a[200:207], v3
  v_cvt_pk_bf16_f32 v44, v44, v46
  v_smfmac_f32_16x16x64_bf16 v[48:51], v[28:31], a[208:215], v3
  ds_write_b32 v102, v44
  v_smfmac_f32_16x16x64_bf16 v[48:51], v[32:35], a[216:223], v3
  v_smfmac_f32_16x16x64_bf16 v[52:55], v[8:11], a[224:231], v3
  v_smfmac_f32_16x16x64_bf16 v[52:55], v[12:15], a[232:239], v3
  v_smfmac_f32_16x16x64_bf16 v[52:55], v[16:19], a[240:247], v3
  v_add_f32 v48, v48, v49
  v_smfmac_f32_16x16x64_bf16 v[52:55], v[20:23], a[248:255], v3
  v_add_f32 v50, v50, v51
  v_smfmac_f32_16x16x64_bf16 v[52:55], v[24:27], v[120:127], v3
  v_cvt_pk_bf16_f32 v48, v48, v50
  v_smfmac_f32_16x16x64_bf16 v[52:55], v[28:31], v[128:135], v3
  ds_write_b32 v103, v48
  v_smfmac_f32_16x16x64_bf16 v[52:55], v[32:35], v[136:143], v3
  v_smfmac_f32_16x16x64_bf16 v[56:59], v[8:11], v[144:151], v3
  v_smfmac_f32_16x16x64_bf16 v[56:59], v[12:15], v[152:159], v3
  v_smfmac_f32_16x16x64_bf16 v[56:59], v[16:19], v[160:167], v3
  v_add_f32 v52, v52, v53
  v_smfmac_f32_16x16x64_bf16 v[56:59], v[20:23], v[168:175], v3
  v_add_f32 v54, v54, v55
  v_smfmac_f32_16x16x64_bf16 v[56:59], v[24:27], v[176:183], v3
  v_cvt_pk_bf16_f32 v52, v52, v54
  v_smfmac_f32_16x16x64_bf16 v[56:59], v[28:31], v[184:191], v3
  ds_write_b32 v104, v52
  v_smfmac_f32_16x16x64_bf16 v[56:59], v[32:35], v[192:199], v3
  s_nop 7
  v_add_f32 v56, v56, v57
  v_add_f32 v58, v58, v59
  v_cvt_pk_bf16_f32 v56, v56, v58
  ds_write_b32 v105, v56
  s_waitcnt lgkmcnt(0)
  s_barrier
  s_cmp_eq_u32 s19, 62
  s_cbranch_scc1 cA_done
  s_waitcnt vmcnt(0) lgkmcnt(0)
  s_add_u32 s19, s19, 1
  s_mov_b32 s20, s21
  s_branch cA_va3_loop
cA_va3_retry:
  s_waitcnt lgkmcnt(0)
  buffer_load_dwordx4 v[24:27], v2, s[8:11], s23 offen offset:0 sc1
  buffer_load_dwordx4 v[28:31], v2, s[8:11], s23 offen offset:1024 sc1
  buffer_load_dwordx4 v[32:35], v2, s[8:11], s23 offen offset:2048 sc1
  s_add_u32 s31, s31, 1
  s_add_u32 s30, s30, 1
  s_cmp_lt_u32 s30, 400000
  s_cbranch_scc1 cA_va3_ld
  s_branch cA_abort
cA_va3_last:
  s_waitcnt lgkmcnt(0)
  buffer_store_dwordx4 v[100:103], v2, s[8:11], s24 offen offset:0 sc1
  buffer_store_dwordx4 v[104:107], v2, s[8:11], s24 offen offset:1024 sc1
  buffer_store_dwordx4 v[108:111], v2, s[8:11], s24 offen offset:2048 sc1
  buffer_store_dwordx4 v[4:7], v2, s[8:11], s24 offen offset:3072 sc1
  s_add_u32 s24, s24, 8192
  s_waitcnt vmcnt(0)
  s_mov_b64 exec, 1
  buffer_store_dword v117, v2, s[8:11], s34 offen sc1
  s_mov_b64 exec, -1
  s_add_u32 s34, s34, 8
  s_mov_b64 exec, 1
  buffer_store_dword v117, v2, s[8:11], s34 offen sc1
  s_mov_b64 exec, -1
  s_add_u32 s34, s34, 8
  s_branch cA_done
cA_abort:
  v_mov_b32 v4, 0xdead
  v_mov_b32 v5, 16
  buffer_store_dword v4, v5, s[12:15], 0 offen
  s_branch ch_end
cA_done:
  s_branch ch_end
.p2align 6

cB_sc0_loop:
  s_add_u32 s23, s20, 4096
  s_add_u32 s21, s20, 20480
  s_mov_b32 s30, 0
  s_mov_b32 s62, 0
  buffer_load_dword v68, v0, s[8:11], s20 offen sc1
  v_mov_b32 v48, 0
  v_mov_b32 v49, 0
  v_mov_b32 v50, 0
  v_mov_b32 v51, 0
  v_mov_b32 v52, 0
  v_mov_b32 v53, 0
  v_mov_b32 v54, 0
  v_mov_b32 v55, 0
  buffer_load_dword v69, v0, s[8:11], s20 offen sc1
  v_mov_b32 v56, 0
  v_mov_b32 v57, 0
  v_mov_b32 v58, 0
  v_mov_b32 v59, 0
  v_mov_b32 v60, 0
  v_mov_b32 v61, 0
  v_mov_b32 v62, 0
  v_mov_b32 v63, 0
  buffer_load_dword v70, v0, s[8:11], s20 offen sc1
  v_mov_b32 v88, 0
  v_mov_b32 v89, 0
  v_mov_b32 v90, 0
  v_mov_b32 v91, 0
  v_mov_b32 v92, 0
  v_mov_b32 v93, 0
  v_mov_b32 v94, 0
  v_mov_b32 v95, 0
  buffer_load_dword v71, v0, s[8:11], s20 offen sc1
  v_mov_b32 v66, 0
  v_mov_b32 v67, 0
  buffer_load_dword v72, v0, s[8:11], s20 offen sc1
cB_sc0_fp_l:
  s_waitcnt vmcnt(4)
  v_cmp_eq_u32 vcc, -1, v68
  s_cbranch_vccz cB_sc0_fp_d
  buffer_load_dword v68, v0, s[8:11], s20 offen sc1
  s_waitcnt vmcnt(4)
  v_cmp_eq_u32 vcc, -1, v69
  s_cbranch_vccz cB_sc0_fp_d
  buffer_load_dword v69, v0, s[8:11], s20 offen sc1
  s_waitcnt vmcnt(4)
  v_cmp_eq_u32 vcc, -1, v70
  s_cbranch_vccz cB_sc0_fp_d
  buffer_load_dword v70, v0, s[8:11], s20 offen sc1
  s_waitcnt vmcnt(4)
  v_cmp_eq_u32 vcc, -1, v71
  s_cbranch_vccz cB_sc0_fp_d
  buffer_load_dword v71, v0, s[8:11], s20 offen sc1
  s_waitcnt vmcnt(4)
  v_cmp_eq_u32 vcc, -1, v72
  s_cbranch_vccz cB_sc0_fp_d
  buffer_load_dword v72, v0, s[8:11], s20 offen sc1
  s_add_u32 s30, s30, 1
  s_cmp_lt_u32 s30, 400000
  s_cbranch_scc1 cB_sc0_fp_l
  s_branch cB_abort
cB_sc0_fp_d:
  buffer_load_dwordx4 v[8:11], v2, s[8:11], s20 offen offset:0 sc1
  s_barrier
  s_branch cB_sc0_ld1
cB_sc0_ld:
  buffer_load_dwordx4 v[8:11], v2, s[8:11], s20 offen offset:0 sc1
cB_sc0_ld1:
  v_mov_b32 v36, 0
  v_mov_b32 v37, 0
  v_mov_b32 v38, 0
  v_mov_b32 v39, 0
  buffer_load_dwordx4 v[12:15], v2, s[8:11], s20 offen offset:1024 sc1
  v_mov_b32 v40, 0
  v_mov_b32 v41, 0
  v_mov_b32 v42, 0
  v_mov_b32 v43, 0
  buffer_load_dwordx4 v[16:19], v2, s[8:11], s20 offen offset:2048 sc1
  v_mov_b32 v44, 0
  v_mov_b32 v45, 0
  v_mov_b32 v46, 0
  v_mov_b32 v47, 0
  ds_read_b128 v[96:99], v117 offset:0
  ds_read_b128 v[100:103], v117 offset:1024
  ds_read_b128 v[104:107], v117 offset:14336
  ds_read_b128 v[108:111], v117 offset:15360
  s_waitcnt vmcnt(2)
  v_smfmac_f32_16x16x64_bf16 v[36:39], v[8:11], a[0:7], v3
  v_smfmac_f32_16x16x64_bf16 v[40:43], v[8:11], a[56:63], v3
  buffer_load_dwordx4 v[20:23], v2, s[8:11], s20 offen offset:3072 sc1
  v_smfmac_f32_16x16x64_bf16 v[44:47], v[8:11], a[112:119], v3
  v_smfmac_f32_16x16x64_bf16 v[48:51], v[8:11], a[168:175], v3
  v_smfmac_f32_16x16x64_bf16 v[52:55], v[8:11], a[224:231], v3
  buffer_load_dwordx4 v[24:27], v2, s[8:11], s23 offen offset:0 sc1
  v_smfmac_f32_16x16x64_bf16 v[56:59], v[8:11], v[144:151], v3
  v_smfmac_f32_16x16x64_bf16 v[60:63], v[8:11], v[200:207], v3
  s_waitcnt vmcnt(3)
  v_smfmac_f32_16x16x64_bf16 v[36:39], v[12:15], a[8:15], v3
  v_smfmac_f32_16x16x64_bf16 v[40:43], v[12:15], a[64:71], v3
  buffer_load_dwordx4 v[28:31], v2, s[8:11], s23 offen offset:1024 sc1
  v_smfmac_f32_16x16x64_bf16 v[44:47], v[12:15], a[120:127], v3
  v_smfmac_f32_16x16x64_bf16 v[48:51], v[12:15], a[176:183], v3
  v_smfmac_f32_16x16x64_bf16 v[52:55], v[12:15], a[232:239], v3
  buffer_load_dwordx4 v[32:35], v2, s[8:11], s23 offen offset:2048 sc1
  v_smfmac_f32_16x16x64_bf16 v[56:59], v[12:15], v[152:159], v3
  v_smfmac_f32_16x16x64_bf16 v[60:63], v[12:15], v[208:215], v3
  s_xor_b32 s58, s25, 28672
  s_add_u32 s59, s24, 28672
  s_add_u32 m0, s58, 0
  s_waitcnt vmcnt(4)
  v_smfmac_f32_16x16x64_bf16 v[36:39], v[16:19], a[16:23], v3
  buffer_load_dwordx4 v2, s[8:11], s59 offen offset:0 sc1 lds
  v_smfmac_f32_16x16x64_bf16 v[40:43], v[16:19], a[72:79], v3
  v_smfmac_f32_16x16x64_bf16 v[44:47], v[16:19], a[128:135], v3
  v_smfmac_f32_16x16x64_bf16 v[48:51], v[16:19], a[184:191], v3
  v_smfmac_f32_16x16x64_bf16 v[52:55], v[16:19], a[240:247], v3
  buffer_load_dwordx4 v2, s[8:11], s59 offen offset:1024 sc1 lds
  v_smfmac_f32_16x16x64_bf16 v[56:59], v[16:19], v[160:167], v3
  v_smfmac_f32_16x16x64_bf16 v[60:63], v[16:19], v[216:223], v3
  s_waitcnt vmcnt(5)
  v_smfmac_f32_16x16x64_bf16 v[36:39], v[20:23], a[24:31], v3
  v_smfmac_f32_16x16x64_bf16 v[40:43], v[20:23], a[80:87], v3
  buffer_load_dwordx4 v2, s[8:11], s59 offen offset:2048 sc1 lds
  v_smfmac_f32_16x16x64_bf16 v[44:47], v[20:23], a[136:143], v3
  v_smfmac_f32_16x16x64_bf16 v[48:51], v[20:23], a[192:199], v3
  v_smfmac_f32_16x16x64_bf16 v[52:55], v[20:23], a[248:255], v3
  v_smfmac_f32_16x16x64_bf16 v[56:59], v[20:23], v[168:175], v3
  buffer_load_dwordx4 v2, s[8:11], s59 offen offset:3072 sc1 lds
  v_smfmac_f32_16x16x64_bf16 v[60:63], v[20:23], v[224:231], v3
  s_waitcnt vmcnt(4)
cB_sc0_ph2:
  v_smfmac_f32_16x16x64_bf16 v[60:63], v[24:27], v[232:239], v3
  ds_read_b128 v[12:15], v116 offset:0
  ds_read_b128 v[16:19], v116 offset:1024
  v_smfmac_f32_16x16x64_bf16 v[60:63], v[28:31], v[240:247], v3
  v_smfmac_f32_16x16x64_bf16 v[60:63], v[32:35], v[248:255], v3
  v_mov_b32 v80, v24
  v_smfmac_f32_16x16x64_bf16 v[52:55], v[24:27], v[120:127], v3
  v_mov_b32 v81, v25
  v_smfmac_f32_16x16x64_bf16 v[52:55], v[28:31], v[128:135], v3
  v_mov_b32 v82, v32
  v_smfmac_f32_16x16x64_bf16 v[52:55], v[32:35], v[136:143], v3
  v_cvt_pk_bf16_f32 v64, v60, v61
  v_smfmac_f32_16x16x64_bf16 v[56:59], v[24:27], v[176:183], v3
  v_cvt_pk_bf16_f32 v65, v62, v63
  v_smfmac_f32_16x16x64_bf16 v[56:59], v[28:31], v[184:191], v3
  v_mov_b32 v83, v33
  v_mfma_f32_16x16x32_bf16 v[68:71], v[64:67], v[4:7], 0
  v_smfmac_f32_16x16x64_bf16 v[56:59], v[32:35], v[192:199], v3
  v_cvt_pk_bf16_f32 v64, v52, v53
  v_smfmac_f32_16x16x64_bf16 v[36:39], v[24:27], a[32:39], v3
  v_cvt_pk_bf16_f32 v65, v54, v55
  v_smfmac_f32_16x16x64_bf16 v[36:39], v[28:31], a[40:47], v3
  v_cvt_pk_bf16_f32 v78, v68, v69
  v_smfmac_f32_16x16x64_bf16 v[36:39], v[32:35], a[48:55], v3
  v_cvt_pk_bf16_f32 v79, v70, v71
  v_cvt_pk_bf16_f32 v66, v56, v57
  v_smfmac_f32_16x16x64_bf16 v[40:43], v[24:27], a[88:95], v3
  v_cvt_pk_bf16_f32 v67, v58, v59
  v_smfmac_f32_16x16x64_bf16 v[40:43], v[28:31], a[96:103], v3
  v_mfma_f32_16x16x32_bf16 v[72:75], v[64:67], v[4:7], 0
  ds_read_b128 v[52:55], v116 offset:14336
  ds_read_b128 v[56:59], v116 offset:15360
  v_smfmac_f32_16x16x64_bf16 v[40:43], v[32:35], a[104:111], v3
  v_cvt_pk_bf16_f32 v64, v36, v37
  v_smfmac_f32_16x16x64_bf16 v[44:47], v[24:27], a[144:151], v3
  v_cvt_pk_bf16_f32 v65, v38, v39
  v_smfmac_f32_16x16x64_bf16 v[44:47], v[28:31], a[152:159], v3
  v_cvt_pk_bf16_f32 v76, v72, v73
  v_smfmac_f32_16x16x64_bf16 v[44:47], v[32:35], a[160:167], v3
  v_cvt_pk_bf16_f32 v77, v74, v75
  v_cvt_pk_bf16_f32 v66, v40, v41
  v_smfmac_f32_16x16x64_bf16 v[48:51], v[24:27], a[200:207], v3
  v_cvt_pk_bf16_f32 v67, v42, v43
  v_smfmac_f32_16x16x64_bf16 v[48:51], v[28:31], a[208:215], v3
  v_mfma_f32_16x16x32_bf16 v[68:71], v[64:67], v[4:7], 0
  v_smfmac_f32_16x16x64_bf16 v[48:51], v[32:35], a[216:223], v3
  v_cvt_pk_bf16_f32 v64, v44, v45
  v_mfma_f32_16x16x32_bf16 v[84:87], v[80:83], v[76:79], 0
  v_cvt_pk_bf16_f32 v65, v46, v47
  s_waitcnt lgkmcnt(0)
  v_smfmac_f32_16x16x64_bf16 v[88:91], v[76:79], v[96:103], v118
  v_cvt_pk_bf16_f32 v60, v68, v69
  v_cvt_pk_bf16_f32 v61, v70, v71
  v_cvt_pk_bf16_f32 v66, v48, v49
  v_cvt_pk_bf16_f32 v67, v50, v51
  s_nop 1
  v_mfma_f32_16x16x32_bf16 v[72:75], v[64:67], v[4:7], 0
  v_smfmac_f32_16x16x64_bf16 v[92:95], v[76:79], v[104:111], v118
  s_nop 4
  v_cvt_pk_bf16_f32 v62, v72, v73
  v_cvt_pk_bf16_f32 v63, v74, v75
  s_nop 1
  v_mfma_f32_16x16x32_bf16 v[84:87], v[8:11], v[60:63], v[84:87]
  v_smfmac_f32_16x16x64_bf16 v[88:91], v[60:63], v[12:19], v118
  v_smfmac_f32_16x16x64_bf16 v[92:95], v[60:63], v[52:59], v118
  s_nop 1
  v_permlane32_swap_b32 v84, v86
  v_permlane32_swap_b32 v85, v87
  s_nop 0
  v_add_f32 v88, v88, v89
  v_add_f32_dpp v84, v86, v84 quad_perm:[1,0,3,2] row_mask:0xf bank_mask:0xf
  v_add_f32_dpp v85, v87, v85 quad_perm:[1,0,3,2] row_mask:0xf bank_mask:0xf
  v_add_f32 v89, v90, v91
  ds_write2_b32 v113, v84, v85 offset0:0 offset1:4
  ds_write2_b32 v112, v88, v89 offset0:0 offset1:128
  v_add_f32 v90, v92, v93
  v_add_f32 v91, v94, v95
  ds_write2_b32 v112, v90, v91 offset0:64 offset1:192
  v_cmp_u_f32 vcc, v88, v89
  s_cbranch_vccnz cB_sc0_retry
cB_sc0_cont:
  s_waitcnt lgkmcnt(0)
  s_barrier
  ds_read_b128 v[36:39], v114
  ds_read_b128 v[44:47], v115
  s_waitcnt lgkmcnt(0)
  v_add_f32 v36, v36, v38
  v_add_f32 v37, v37, v39
  v_add_f32 v44, v44, v45
  buffer_store_dword v2, v119, s[8:11], s20 offen sc1
  v_add_f32 v46, v46, v47
  v_add_f32 v44, v44, v46
  v_add_f32 v36, v36, v37
  v_exp_f32 v49, v44
  v_exp_f32 v48, v36
  v_add_f32 v50, abs(v36), abs(v44)
  v_fma_f32 v39, v49, s37, v48
  v_cmp_ngt_f32 vcc, s56, v50
  v_cndmask_b32 v41, v48, v49, s[38:39]
  v_add_f32_dpp v39, v39, v39 quad_perm:[1,0,3,2] row_mask:0xf bank_mask:0xf
  v_cndmask_b32 v40, v49, v48, s[38:39]
  v_mov_b32_dpp v46, v41 quad_perm:[1,0,3,2] row_mask:0xf bank_mask:0xf
  v_add_f32_dpp v39, v39, v39 quad_perm:[2,3,0,1] row_mask:0xf bank_mask:0xf
  v_cndmask_b32 v42, v46, v40, s[38:39]
  v_cndmask_b32 v43, v40, v46, s[38:39]
  v_add_f32_dpp v39, v39, v39 row_half_mirror row_mask:0xf bank_mask:0xf
  s_cbranch_vccnz cB_sc0_slow
  s_nop 0
  v_add_f32_dpp v47, v39, v39 row_mirror row_mask:0xf bank_mask:0xf
  v_add_f32_dpp v39, v39, v39 row_mirror row_mask:0xf bank_mask:0xf
  s_nop 1
  v_permlane16_swap_b32 v39, v47
  v_add_f32 v39, v39, v47
  v_rcp_f32 v39, v39
  s_mov_b64 exec, s[28:29]
  v_mul_f32 v42, v42, v39
  v_mul_f32 v43, v43, v39
  v_cvt_pk_bf16_f32 v42, v42, v43
cB_sc0_pst:
  buffer_store_dword v42, v1, s[8:11], s20 offen sc1
  s_mov_b64 exec, -1
  s_barrier
  s_cmp_lg_u32 s19, 0
  s_cbranch_scc1 cB_sc0_s0
  s_sub_u32 s36, s36, 64
  v_subrev_u32 v119, 64, v119
  v_lshl_add_u32 v56, v2, 3, s36
  s_mov_b64 exec, 15
  buffer_store_dword v2, v56, s[8:11], s20 offen sc1
  s_mov_b64 exec, -1
cB_sc0_s0:
  s_add_u32 s24, s24, 28672
  s_add_u32 s35, s35, 28672
  s_xor_b32 s25, s25, 28672
  s_add_u32 m0, s25, 0
  s_add_u32 m0, s25, 4096
  s_add_u32 s22, s24, 4096
  buffer_load_dwordx4 v2, s[8:11], s22 offen offset:0 sc1 lds
  buffer_load_dwordx4 v2, s[8:11], s22 offen offset:1024 sc1 lds
  buffer_load_dwordx4 v2, s[8:11], s22 offen offset:2048 sc1 lds
  v_xor_b32 v116, 28672, v116
  v_add_u32 v117, s57, v117
  s_sub_u32 s57, 0, s57
  s_add_u32 s19, s19, 1
  s_mov_b32 s20, s21
  s_cmp_lt_u32 s19, 63
  s_cbranch_scc1 cB_sc0_loop
  s_branch cB_done
cB_sc0_slow:
  v_max_f32 v50, v36, v44
  s_nop 1
  v_max_f32_dpp v50, v50, v50 quad_perm:[1,0,3,2] row_mask:0xf bank_mask:0xf
  s_nop 1
  v_max_f32_dpp v50, v50, v50 quad_perm:[2,3,0,1] row_mask:0xf bank_mask:0xf
  s_nop 1
  v_max_f32_dpp v50, v50, v50 row_half_mirror row_mask:0xf bank_mask:0xf
  s_nop 1
  v_max_f32_dpp v50, v50, v50 row_mirror row_mask:0xf bank_mask:0xf
  v_mov_b32 v47, v50
  s_nop 1
  v_permlane16_swap_b32 v50, v47
  v_max_f32 v50, v50, v47
  v_sub_f32 v48, v36, v50
  v_sub_f32 v49, v44, v50
  v_exp_f32 v48, v48
  v_exp_f32 v49, v49
  s_add_u32 s31, s31, 0x100
  v_fma_f32 v39, v49, s37, v48
  v_cndmask_b32 v41, v48, v49, s[38:39]
  s_nop 0
  v_add_f32_dpp v39, v39, v39 quad_perm:[1,0,3,2] row_mask:0xf bank_mask:0xf
  v_cndmask_b32 v40, v49, v48, s[38:39]
  v_mov_b32_dpp v46, v41 quad_perm:[1,0,3,2] row_mask:0xf bank_mask:0xf
  v_add_f32_dpp v39, v39, v39 quad_perm:[2,3,0,1] row_mask:0xf bank_mask:0xf
  v_cndmask_b32 v42, v46, v40, s[38:39]
  v_cndmask_b32 v43, v40, v46, s[38:39]
  v_add_f32_dpp v39, v39, v39 row_half_mirror row_mask:0xf bank_mask:0xf
  s_nop 1
  v_add_f32_dpp v47, v39, v39 row_mirror row_mask:0xf bank_mask:0xf
  v_add_f32_dpp v39, v39, v39 row_mirror row_mask:0xf bank_mask:0xf
  s_nop 1
  v_permlane16_swap_b32 v39, v47
  v_add_f32 v39, v39, v47
  v_rcp_f32 v39, v39
  s_mov_b64 exec, s[28:29]
  v_mul_f32 v42, v42, v39
  v_mul_f32 v43, v43, v39
  v_cvt_pk_bf16_f32 v42, v42, v43
  v_min_u32 v42, -2, v42
  s_branch cB_sc0_pst
cB_sc0_retry:
  s_cmp_lg_u32 s62, 0
  s_cbranch_scc1 cB_sc0_cont
  s_waitcnt vmcnt(0) lgkmcnt(0)
cB_sc0_rv:
  buffer_load_dwordx4 v[8:11], v2, s[8:11], s20 offen offset:0 sc1
  buffer_load_dwordx4 v[12:15], v2, s[8:11], s20 offen offset:1024 sc1
  buffer_load_dwordx4 v[16:19], v2, s[8:11], s20 offen offset:2048 sc1
  buffer_load_dwordx4 v[20:23], v2, s[8:11], s20 offen offset:3072 sc1
  buffer_load_dwordx4 v[24:27], v2, s[8:11], s23 offen offset:0 sc1
  buffer_load_dwordx4 v[28:31], v2, s[8:11], s23 offen offset:1024 sc1
  buffer_load_dwordx4 v[32:35], v2, s[8:11], s23 offen offset:2048 sc1
  s_waitcnt vmcnt(0)
  v_max3_u32 v68, v8, v9, v10
  v_max3_u32 v68, v68, v11, v12
  v_max3_u32 v68, v68, v13, v14
  v_max3_u32 v68, v68, v15, v16
  v_max3_u32 v68, v68, v17, v18
  v_max3_u32 v68, v68, v19, v20
  v_max3_u32 v68, v68, v21, v22
  v_max3_u32 v68, v68, v23, v24
  v_max3_u32 v68, v68, v25, v26
  v_max3_u32 v68, v68, v27, v28
  v_max3_u32 v68, v68, v29, v30
  v_max3_u32 v68, v68, v31, v32
  v_max3_u32 v68, v68, v33, v34
  v_max_u32 v68, v68, v35
  v_cmp_eq_u32 vcc, -1, v68
  s_cbranch_vccz cB_sc0_rk
  s_add_u32 s30, s30, 1
  s_cmp_lt_u32 s30, 400000
  s_cbranch_scc1 cB_sc0_rv
  s_branch cB_abort
cB_sc0_rk:
  s_mov_b32 s62, 1
  v_mov_b32 v36, 0
  v_mov_b32 v37, 0
  v_mov_b32 v38, 0
  v_mov_b32 v39, 0
  v_mov_b32 v40, 0
  v_mov_b32 v41, 0
  v_mov_b32 v42, 0
  v_mov_b32 v43, 0
  v_mov_b32 v44, 0
  v_mov_b32 v45, 0
  v_mov_b32 v46, 0
  v_mov_b32 v47, 0
  v_mov_b32 v48, 0
  v_mov_b32 v49, 0
  v_mov_b32 v50, 0
  v_mov_b32 v51, 0
  v_mov_b32 v52, 0
  v_mov_b32 v53, 0
  v_mov_b32 v54, 0
  v_mov_b32 v55, 0
  v_mov_b32 v56, 0
  v_mov_b32 v57, 0
  v_mov_b32 v58, 0
  v_mov_b32 v59, 0
  v_mov_b32 v60, 0
  v_mov_b32 v61, 0
  v_mov_b32 v62, 0
  v_mov_b32 v63, 0
  v_mov_b32 v88, 0
  v_mov_b32 v89, 0
  v_mov_b32 v90, 0
  v_mov_b32 v91, 0
  v_mov_b32 v92, 0
  v_mov_b32 v93, 0
  v_mov_b32 v94, 0
  v_mov_b32 v95, 0
  v_mov_b32 v66, 0
  v_mov_b32 v67, 0
  s_add_u32 s31, s31, 1
  ds_read_b128 v[96:99], v117 offset:0
  ds_read_b128 v[100:103], v117 offset:1024
  ds_read_b128 v[104:107], v117 offset:14336
  ds_read_b128 v[108:111], v117 offset:15360
  v_smfmac_f32_16x16x64_bf16 v[36:39], v[8:11], a[0:7], v3
  v_smfmac_f32_16x16x64_bf16 v[40:43], v[8:11], a[56:63], v3
  v_smfmac_f32_16x16x64_bf16 v[44:47], v[8:11], a[112:119], v3
  v_smfmac_f32_16x16x64_bf16 v[48:51], v[8:11], a[168:175], v3
  v_smfmac_f32_16x16x64_bf16 v[52:55], v[8:11], a[224:231], v3
  v_smfmac_f32_16x16x64_bf16 v[56:59], v[8:11], v[144:151], v3
  v_smfmac_f32_16x16x64_bf16 v[60:63], v[8:11], v[200:207], v3
  v_smfmac_f32_16x16x64_bf16 v[36:39], v[12:15], a[8:15], v3
  v_smfmac_f32_16x16x64_bf16 v[40:43], v[12:15], a[64:71], v3
  v_smfmac_f32_16x16x64_bf16 v[44:47], v[12:15], a[120:127], v3
  v_smfmac_f32_16x16x64_bf16 v[48:51], v[12:15], a[176:183], v3
  v_smfmac_f32_16x16x64_bf16 v[52:55], v[12:15], a[232:239], v3
  v_smfmac_f32_16x16x64_bf16 v[56:59], v[12:15], v[152:159], v3
  v_smfmac_f32_16x16x64_bf16 v[60:63], v[12:15], v[208:215], v3
  v_smfmac_f32_16x16x64_bf16 v[36:39], v[16:19], a[16:23], v3
  v_smfmac_f32_16x16x64_bf16 v[40:43], v[16:19], a[72:79], v3
  v_smfmac_f32_16x16x64_bf16 v[44:47], v[16:19], a[128:135], v3
  v_smfmac_f32_16x16x64_bf16 v[48:51], v[16:19], a[184:191], v3
  v_smfmac_f32_16x16x64_bf16 v[52:55], v[16:19], a[240:247], v3
  v_smfmac_f32_16x16x64_bf16 v[56:59], v[16:19], v[160:167], v3
  v_smfmac_f32_16x16x64_bf16 v[60:63], v[16:19], v[216:223], v3
  v_smfmac_f32_16x16x64_bf16 v[36:39], v[20:23], a[24:31], v3
  v_smfmac_f32_16x16x64_bf16 v[40:43], v[20:23], a[80:87], v3
  v_smfmac_f32_16x16x64_bf16 v[44:47], v[20:23], a[136:143], v3
  v_smfmac_f32_16x16x64_bf16 v[48:51], v[20:23], a[192:199], v3
  v_smfmac_f32_16x16x64_bf16 v[52:55], v[20:23], a[248:255], v3
  v_smfmac_f32_16x16x64_bf16 v[56:59], v[20:23], v[168:175], v3
  v_smfmac_f32_16x16x64_bf16 v[60:63], v[20:23], v[224:231], v3
  s_xor_b32 s58, s25, 28672
  s_add_u32 s59, s24, 28672
  s_add_u32 m0, s58, 0
  s_branch cB_sc0_ph2
.p2align 6

cB_sc1_loop:
  s_add_u32 s23, s20, 4096
  s_add_u32 s21, s20, 20480
  s_mov_b32 s30, 0
  s_mov_b32 s62, 0
  s_waitcnt vmcnt(0)
  s_barrier
cB_sc1_ld:
  buffer_load_dwordx4 v[8:11], v2, s[8:11], s20 offen offset:0 sc1
  v_mov_b32 v36, 0
  v_mov_b32 v37, 0
  v_mov_b32 v38, 0
  v_mov_b32 v39, 0
  buffer_load_dwordx4 v[12:15], v2, s[8:11], s20 offen offset:1024 sc1
  v_mov_b32 v40, 0
  v_mov_b32 v41, 0
  v_mov_b32 v42, 0
  v_mov_b32 v43, 0
  buffer_load_dwordx4 v[16:19], v2, s[8:11], s20 offen offset:2048 sc1
  v_mov_b32 v44, 0
  v_mov_b32 v45, 0
  v_mov_b32 v46, 0
  v_mov_b32 v47, 0
  ds_read_b128 v[96:99], v117 offset:0
  ds_read_b128 v[100:103], v117 offset:1024
  ds_read_b128 v[104:107], v117 offset:14336
  ds_read_b128 v[108:111], v117 offset:15360
  s_waitcnt vmcnt(2)
  v_smfmac_f32_16x16x64_bf16 v[36:39], v[8:11], a[0:7], v3
  v_smfmac_f32_16x16x64_bf16 v[40:43], v[8:11], a[56:63], v3
  buffer_load_dwordx4 v[20:23], v2, s[8:11], s20 offen offset:3072 sc1
  v_smfmac_f32_16x16x64_bf16 v[44:47], v[8:11], a[112:119], v3
  v_smfmac_f32_16x16x64_bf16 v[48:51], v[8:11], a[168:175], v3
  v_smfmac_f32_16x16x64_bf16 v[52:55], v[8:11], a[224:231], v3
  buffer_load_dwordx4 v[24:27], v2, s[8:11], s23 offen offset:0 sc1
  v_smfmac_f32_16x16x64_bf16 v[56:59], v[8:11], v[144:151], v3
  v_smfmac_f32_16x16x64_bf16 v[60:63], v[8:11], v[200:207], v3
  s_waitcnt vmcnt(3)
  v_smfmac_f32_16x16x64_bf16 v[36:39], v[12:15], a[8:15], v3
  v_smfmac_f32_16x16x64_bf16 v[40:43], v[12:15], a[64:71], v3
  buffer_load_dwordx4 v[28:31], v2, s[8:11], s23 offen offset:1024 sc1
  v_smfmac_f32_16x16x64_bf16 v[44:47], v[12:15], a[120:127], v3
  v_smfmac_f32_16x16x64_bf16 v[48:51], v[12:15], a[176:183], v3
  v_smfmac_f32_16x16x64_bf16 v[52:55], v[12:15], a[232:239], v3
  buffer_load_dwordx4 v[32:35], v2, s[8:11], s23 offen offset:2048 sc1
  v_smfmac_f32_16x16x64_bf16 v[56:59], v[12:15], v[152:159], v3
  v_smfmac_f32_16x16x64_bf16 v[60:63], v[12:15], v[208:215], v3
  s_waitcnt vmcnt(4)
  v_smfmac_f32_16x16x64_bf16 v[36:39], v[16:19], a[16:23], v3
  s_xor_b32 s58, s25, 28672
  s_add_u32 s59, s24, 28672
  s_add_u32 m0, s58, 7168
  v_smfmac_f32_16x16x64_bf16 v[40:43], v[16:19], a[72:79], v3
  buffer_load_dwordx4 v2, s[8:11], s59 offen offset:0 sc1 lds
  v_smfmac_f32_16x16x64_bf16 v[44:47], v[16:19], a[128:135], v3
  v_smfmac_f32_16x16x64_bf16 v[48:51], v[16:19], a[184:191], v3
  v_smfmac_f32_16x16x64_bf16 v[52:55], v[16:19], a[240:247], v3
  v_smfmac_f32_16x16x64_bf16 v[56:59], v[16:19], v[160:167], v3
  buffer_load_dwordx4 v2, s[8:11], s59 offen offset:1024 sc1 lds
  v_smfmac_f32_16x16x64_bf16 v[60:63], v[16:19], v[216:223], v3
  s_waitcnt vmcnt(5)
  v_smfmac_f32_16x16x64_bf16 v[36:39], v[20:23], a[24:31], v3
  v_smfmac_f32_16x16x64_bf16 v[40:43], v[20:23], a[80:87], v3
  v_smfmac_f32_16x16x64_bf16 v[44:47], v[20:23], a[136:143], v3
  buffer_load_dwordx4 v2, s[8:11], s59 offen offset:2048 sc1 lds
  v_smfmac_f32_16x16x64_bf16 v[48:51], v[20:23], a[192:199], v3
  v_smfmac_f32_16x16x64_bf16 v[52:55], v[20:23], a[248:255], v3
  v_smfmac_f32_16x16x64_bf16 v[56:59], v[20:23], v[168:175], v3
  v_smfmac_f32_16x16x64_bf16 v[60:63], v[20:23], v[224:231], v3
  buffer_load_dwordx4 v2, s[8:11], s59 offen offset:3072 sc1 lds
  s_waitcnt vmcnt(4)
cB_sc1_ph2:
  v_smfmac_f32_16x16x64_bf16 v[60:63], v[24:27], v[232:239], v3
  ds_read_b128 v[16:19], v116 offset:2048
  ds_read_b128 v[20:23], v116 offset:3072
  v_smfmac_f32_16x16x64_bf16 v[60:63], v[28:31], v[240:247], v3
  buffer_load_dword v119, v0, s[8:11], s20 offen sc1
  v_smfmac_f32_16x16x64_bf16 v[60:63], v[32:35], v[248:255], v3
  v_mov_b32 v80, v26
  v_smfmac_f32_16x16x64_bf16 v[52:55], v[24:27], v[120:127], v3
  v_mov_b32 v81, v27
  v_smfmac_f32_16x16x64_bf16 v[52:55], v[28:31], v[128:135], v3
  v_mov_b32 v82, v32
  v_smfmac_f32_16x16x64_bf16 v[52:55], v[32:35], v[136:143], v3
  v_cvt_pk_bf16_f32 v66, v60, v61
  v_smfmac_f32_16x16x64_bf16 v[56:59], v[24:27], v[176:183], v3
  v_cvt_pk_bf16_f32 v67, v62, v63
  v_smfmac_f32_16x16x64_bf16 v[56:59], v[28:31], v[184:191], v3
  v_mov_b32 v83, v33
  v_mfma_f32_16x16x32_bf16 v[68:71], v[64:67], v[4:7], 0
  v_smfmac_f32_16x16x64_bf16 v[56:59], v[32:35], v[192:199], v3
  v_cvt_pk_bf16_f32 v64, v52, v53
  v_smfmac_f32_16x16x64_bf16 v[36:39], v[24:27], a[32:39], v3
  v_cvt_pk_bf16_f32 v65, v54, v55
  v_smfmac_f32_16x16x64_bf16 v[36:39], v[28:31], a[40:47], v3
  v_cvt_pk_bf16_f32 v78, v68, v69
  v_smfmac_f32_16x16x64_bf16 v[36:39], v[32:35], a[48:55], v3
  v_cvt_pk_bf16_f32 v79, v70, v71
  v_cvt_pk_bf16_f32 v66, v56, v57
  v_smfmac_f32_16x16x64_bf16 v[40:43], v[24:27], a[88:95], v3
  v_cvt_pk_bf16_f32 v67, v58, v59
  v_smfmac_f32_16x16x64_bf16 v[40:43], v[28:31], a[96:103], v3
  v_mfma_f32_16x16x32_bf16 v[72:75], v[64:67], v[4:7], 0
  ds_read_b128 v[52:55], v116 offset:16384
  ds_read_b128 v[56:59], v116 offset:17408
  v_smfmac_f32_16x16x64_bf16 v[40:43], v[32:35], a[104:111], v3
  v_cvt_pk_bf16_f32 v64, v36, v37
  v_smfmac_f32_16x16x64_bf16 v[44:47], v[24:27], a[144:151], v3
  v_cvt_pk_bf16_f32 v65, v38, v39
  v_smfmac_f32_16x16x64_bf16 v[44:47], v[28:31], a[152:159], v3
  v_cvt_pk_bf16_f32 v76, v72, v73
  v_smfmac_f32_16x16x64_bf16 v[44:47], v[32:35], a[160:167], v3
  v_cvt_pk_bf16_f32 v77, v74, v75
  v_cvt_pk_bf16_f32 v66, v40, v41
  v_smfmac_f32_16x16x64_bf16 v[48:51], v[24:27], a[200:207], v3
  v_cvt_pk_bf16_f32 v67, v42, v43
  v_smfmac_f32_16x16x64_bf16 v[48:51], v[28:31], a[208:215], v3
  v_mfma_f32_16x16x32_bf16 v[68:71], v[64:67], v[4:7], 0
  v_smfmac_f32_16x16x64_bf16 v[48:51], v[32:35], a[216:223], v3
  v_cvt_pk_bf16_f32 v64, v44, v45
  v_mfma_f32_16x16x32_bf16 v[84:87], v[80:83], v[76:79], 0
  v_cvt_pk_bf16_f32 v65, v46, v47
  s_waitcnt lgkmcnt(0)
  v_smfmac_f32_16x16x64_bf16 v[88:91], v[76:79], v[96:103], v118
  v_cvt_pk_bf16_f32 v60, v68, v69
  v_cvt_pk_bf16_f32 v61, v70, v71
  v_cvt_pk_bf16_f32 v66, v48, v49
  v_cvt_pk_bf16_f32 v67, v50, v51
  s_nop 1
  v_mfma_f32_16x16x32_bf16 v[72:75], v[64:67], v[4:7], 0
  v_smfmac_f32_16x16x64_bf16 v[92:95], v[76:79], v[104:111], v118
  s_nop 4
  v_cvt_pk_bf16_f32 v62, v72, v73
  v_cvt_pk_bf16_f32 v63, v74, v75
  s_nop 1
  v_mfma_f32_16x16x32_bf16 v[84:87], v[12:15], v[60:63], v[84:87]
  v_smfmac_f32_16x16x64_bf16 v[88:91], v[60:63], v[16:23], v118
  v_smfmac_f32_16x16x64_bf16 v[92:95], v[60:63], v[52:59], v118
  s_nop 1
  v_permlane32_swap_b32 v84, v86
  v_permlane32_swap_b32 v85, v87
  s_nop 0
  v_add_f32 v88, v88, v89
  v_add_f32_dpp v84, v86, v84 quad_perm:[1,0,3,2] row_mask:0xf bank_mask:0xf
  v_add_f32_dpp v85, v87, v85 quad_perm:[1,0,3,2] row_mask:0xf bank_mask:0xf
  v_add_f32 v89, v90, v91
  ds_write2_b32 v113, v84, v85 offset0:0 offset1:4
  ds_write2_b32 v112, v88, v89 offset0:0 offset1:128
  v_add_f32 v90, v92, v93
  v_add_f32 v91, v94, v95
  ds_write2_b32 v112, v90, v91 offset0:64 offset1:192
  v_cmp_u_f32 vcc, v88, v89
  s_cbranch_vccnz cB_sc1_retry
cB_sc1_cont:
  s_waitcnt lgkmcnt(0)
  s_barrier
  ds_read_b128 v[36:39], v114
  ds_read_b128 v[44:47], v115
  s_waitcnt lgkmcnt(0)
  v_add_f32 v36, v36, v38
  v_add_f32 v37, v37, v39
  v_add_f32 v44, v44, v45
  v_add_f32 v46, v46, v47
  v_add_f32 v44, v44, v46
  v_add_f32 v36, v36, v37
  v_exp_f32 v49, v44
  v_exp_f32 v48, v36
  v_add_f32 v50, abs(v36), abs(v44)
  v_fma_f32 v39, v49, s37, v48
  v_cmp_ngt_f32 vcc, s56, v50
  v_cndmask_b32 v41, v48, v49, s[38:39]
  v_add_f32_dpp v39, v39, v39 quad_perm:[1,0,3,2] row_mask:0xf bank_mask:0xf
  v_cndmask_b32 v40, v49, v48, s[38:39]
  v_mov_b32_dpp v46, v41 quad_perm:[1,0,3,2] row_mask:0xf bank_mask:0xf
  v_add_f32_dpp v39, v39, v39 quad_perm:[2,3,0,1] row_mask:0xf bank_mask:0xf
  v_cndmask_b32 v42, v46, v40, s[38:39]
  v_cndmask_b32 v43, v40, v46, s[38:39]
  v_add_f32_dpp v39, v39, v39 row_half_mirror row_mask:0xf bank_mask:0xf
  s_cbranch_vccnz cB_sc1_slow
  s_nop 0
  v_add_f32_dpp v47, v39, v39 row_mirror row_mask:0xf bank_mask:0xf
  v_add_f32_dpp v39, v39, v39 row_mirror row_mask:0xf bank_mask:0xf
  s_nop 1
  v_permlane16_swap_b32 v39, v47
  v_add_f32 v39, v39, v47
  v_rcp_f32 v39, v39
  s_mov_b64 exec, s[28:29]
  v_mul_f32 v42, v42, v39
  v_mul_f32 v43, v43, v39
  v_cvt_pk_bf16_f32 v42, v42, v43
cB_sc1_pst:
  buffer_store_dword v42, v1, s[8:11], s20 offen sc1
  s_mov_b64 exec, -1
  s_barrier
  s_add_u32 s24, s24, 28672
  s_add_u32 s35, s35, 28672
  s_xor_b32 s25, s25, 28672
  s_add_u32 m0, s25, 7168
  s_add_u32 m0, s25, 11264
  s_add_u32 s22, s24, 4096
  buffer_load_dwordx4 v2, s[8:11], s22 offen offset:0 sc1 lds
  v_mov_b32 v48, 0
  v_mov_b32 v49, 0
  v_mov_b32 v50, 0
  v_mov_b32 v51, 0
  v_mov_b32 v52, 0
  v_mov_b32 v53, 0
  buffer_load_dwordx4 v2, s[8:11], s22 offen offset:1024 sc1 lds
  v_mov_b32 v54, 0
  v_mov_b32 v55, 0
  v_mov_b32 v56, 0
  v_mov_b32 v57, 0
  v_mov_b32 v58, 0
  v_mov_b32 v59, 0
  buffer_load_dwordx4 v2, s[8:11], s22 offen offset:2048 sc1 lds
  v_mov_b32 v60, 0
  v_mov_b32 v61, 0
  v_mov_b32 v62, 0
  v_mov_b32 v63, 0
  v_mov_b32 v88, 0
  v_mov_b32 v89, 0
  v_mov_b32 v90, 0
  v_mov_b32 v91, 0
  v_mov_b32 v92, 0
  v_mov_b32 v93, 0
  v_mov_b32 v94, 0
  v_mov_b32 v95, 0
  v_mov_b32 v64, 0
  v_mov_b32 v65, 0
  v_xor_b32 v116, 28672, v116
  v_add_u32 v117, s57, v117
  s_sub_u32 s57, 0, s57
  s_add_u32 s19, s19, 1
  s_mov_b32 s20, s21
  s_cmp_lt_u32 s19, 63
  s_cbranch_scc1 cB_sc1_loop
  s_branch cB_done
cB_sc1_slow:
  v_max_f32 v50, v36, v44
  s_nop 1
  v_max_f32_dpp v50, v50, v50 quad_perm:[1,0,3,2] row_mask:0xf bank_mask:0xf
  s_nop 1
  v_max_f32_dpp v50, v50, v50 quad_perm:[2,3,0,1] row_mask:0xf bank_mask:0xf
  s_nop 1
  v_max_f32_dpp v50, v50, v50 row_half_mirror row_mask:0xf bank_mask:0xf
  s_nop 1
  v_max_f32_dpp v50, v50, v50 row_mirror row_mask:0xf bank_mask:0xf
  v_mov_b32 v47, v50
  s_nop 1
  v_permlane16_swap_b32 v50, v47
  v_max_f32 v50, v50, v47
  v_sub_f32 v48, v36, v50
  v_sub_f32 v49, v44, v50
  v_exp_f32 v48, v48
  v_exp_f32 v49, v49
  s_add_u32 s31, s31, 0x100
  v_fma_f32 v39, v49, s37, v48
  v_cndmask_b32 v41, v48, v49, s[38:39]
  s_nop 0
  v_add_f32_dpp v39, v39, v39 quad_perm:[1,0,3,2] row_mask:0xf bank_mask:0xf
  v_cndmask_b32 v40, v49, v48, s[38:39]
  v_mov_b32_dpp v46, v41 quad_perm:[1,0,3,2] row_mask:0xf bank_mask:0xf
  v_add_f32_dpp v39, v39, v39 quad_perm:[2,3,0,1] row_mask:0xf bank_mask:0xf
  v_cndmask_b32 v42, v46, v40, s[38:39]
  v_cndmask_b32 v43, v40, v46, s[38:39]
  v_add_f32_dpp v39, v39, v39 row_half_mirror row_mask:0xf bank_mask:0xf
  s_nop 1
  v_add_f32_dpp v47, v39, v39 row_mirror row_mask:0xf bank_mask:0xf
  v_add_f32_dpp v39, v39, v39 row_mirror row_mask:0xf bank_mask:0xf
  s_nop 1
  v_permlane16_swap_b32 v39, v47
  v_add_f32 v39, v39, v47
  v_rcp_f32 v39, v39
  s_mov_b64 exec, s[28:29]
  v_mul_f32 v42, v42, v39
  v_mul_f32 v43, v43, v39
  v_cvt_pk_bf16_f32 v42, v42, v43
  v_min_u32 v42, -2, v42
  s_branch cB_sc1_pst
cB_sc1_retry:
  s_cmp_lg_u32 s62, 0
  s_cbranch_scc1 cB_sc1_cont
  s_waitcnt vmcnt(0) lgkmcnt(0)
cB_sc1_rv:
  buffer_load_dwordx4 v[8:11], v2, s[8:11], s20 offen offset:0 sc1
  buffer_load_dwordx4 v[12:15], v2, s[8:11], s20 offen offset:1024 sc1
  buffer_load_dwordx4 v[16:19], v2, s[8:11], s20 offen offset:2048 sc1
  buffer_load_dwordx4 v[20:23], v2, s[8:11], s20 offen offset:3072 sc1
  buffer_load_dwordx4 v[24:27], v2, s[8:11], s23 offen offset:0 sc1
  buffer_load_dwordx4 v[28:31], v2, s[8:11], s23 offen offset:1024 sc1
  buffer_load_dwordx4 v[32:35], v2, s[8:11], s23 offen offset:2048 sc1
  s_waitcnt vmcnt(0)
  v_max3_u32 v68, v8, v9, v10
  v_max3_u32 v68, v68, v11, v12
  v_max3_u32 v68, v68, v13, v14
  v_max3_u32 v68, v68, v15, v16
  v_max3_u32 v68, v68, v17, v18
  v_max3_u32 v68, v68, v19, v20
  v_max3_u32 v68, v68, v21, v22
  v_max3_u32 v68, v68, v23, v24
  v_max3_u32 v68, v68, v25, v26
  v_max3_u32 v68, v68, v27, v28
  v_max3_u32 v68, v68, v29, v30
  v_max3_u32 v68, v68, v31, v32
  v_max3_u32 v68, v68, v33, v34
  v_max_u32 v68, v68, v35
  v_cmp_eq_u32 vcc, -1, v68
  s_cbranch_vccz cB_sc1_rk
  s_add_u32 s30, s30, 1
  s_cmp_lt_u32 s30, 400000
  s_cbranch_scc1 cB_sc1_rv
  s_branch cB_abort
cB_sc1_rk:
  s_mov_b32 s62, 1
  v_mov_b32 v36, 0
  v_mov_b32 v37, 0
  v_mov_b32 v38, 0
  v_mov_b32 v39, 0
  v_mov_b32 v40, 0
  v_mov_b32 v41, 0
  v_mov_b32 v42, 0
  v_mov_b32 v43, 0
  v_mov_b32 v44, 0
  v_mov_b32 v45, 0
  v_mov_b32 v46, 0
  v_mov_b32 v47, 0
  v_mov_b32 v48, 0
  v_mov_b32 v49, 0
  v_mov_b32 v50, 0
  v_mov_b32 v51, 0
  v_mov_b32 v52, 0
  v_mov_b32 v53, 0
  v_mov_b32 v54, 0
  v_mov_b32 v55, 0
  v_mov_b32 v56, 0
  v_mov_b32 v57, 0
  v_mov_b32 v58, 0
  v_mov_b32 v59, 0
  v_mov_b32 v60, 0
  v_mov_b32 v61, 0
  v_mov_b32 v62, 0
  v_mov_b32 v63, 0
  v_mov_b32 v88, 0
  v_mov_b32 v89, 0
  v_mov_b32 v90, 0
  v_mov_b32 v91, 0
  v_mov_b32 v92, 0
  v_mov_b32 v93, 0
  v_mov_b32 v94, 0
  v_mov_b32 v95, 0
  v_mov_b32 v64, 0
  v_mov_b32 v65, 0
  s_add_u32 s31, s31, 1
  ds_read_b128 v[96:99], v117 offset:0
  ds_read_b128 v[100:103], v117 offset:1024
  ds_read_b128 v[104:107], v117 offset:14336
  ds_read_b128 v[108:111], v117 offset:15360
  v_smfmac_f32_16x16x64_bf16 v[36:39], v[8:11], a[0:7], v3
  v_smfmac_f32_16x16x64_bf16 v[40:43], v[8:11], a[56:63], v3
  v_smfmac_f32_16x16x64_bf16 v[44:47], v[8:11], a[112:119], v3
  v_smfmac_f32_16x16x64_bf16 v[48:51], v[8:11], a[168:175], v3
  v_smfmac_f32_16x16x64_bf16 v[52:55], v[8:11], a[224:231], v3
  v_smfmac_f32_16x16x64_bf16 v[56:59], v[8:11], v[144:151], v3
  v_smfmac_f32_16x16x64_bf16 v[60:63], v[8:11], v[200:207], v3
  v_smfmac_f32_16x16x64_bf16 v[36:39], v[12:15], a[8:15], v3
  v_smfmac_f32_16x16x64_bf16 v[40:43], v[12:15], a[64:71], v3
  v_smfmac_f32_16x16x64_bf16 v[44:47], v[12:15], a[120:127], v3
  v_smfmac_f32_16x16x64_bf16 v[48:51], v[12:15], a[176:183], v3
  v_smfmac_f32_16x16x64_bf16 v[52:55], v[12:15], a[232:239], v3
  v_smfmac_f32_16x16x64_bf16 v[56:59], v[12:15], v[152:159], v3
  v_smfmac_f32_16x16x64_bf16 v[60:63], v[12:15], v[208:215], v3
  v_smfmac_f32_16x16x64_bf16 v[36:39], v[16:19], a[16:23], v3
  v_smfmac_f32_16x16x64_bf16 v[40:43], v[16:19], a[72:79], v3
  v_smfmac_f32_16x16x64_bf16 v[44:47], v[16:19], a[128:135], v3
  v_smfmac_f32_16x16x64_bf16 v[48:51], v[16:19], a[184:191], v3
  v_smfmac_f32_16x16x64_bf16 v[52:55], v[16:19], a[240:247], v3
  v_smfmac_f32_16x16x64_bf16 v[56:59], v[16:19], v[160:167], v3
  v_smfmac_f32_16x16x64_bf16 v[60:63], v[16:19], v[216:223], v3
  v_smfmac_f32_16x16x64_bf16 v[36:39], v[20:23], a[24:31], v3
  v_smfmac_f32_16x16x64_bf16 v[40:43], v[20:23], a[80:87], v3
  v_smfmac_f32_16x16x64_bf16 v[44:47], v[20:23], a[136:143], v3
  v_smfmac_f32_16x16x64_bf16 v[48:51], v[20:23], a[192:199], v3
  v_smfmac_f32_16x16x64_bf16 v[52:55], v[20:23], a[248:255], v3
  v_smfmac_f32_16x16x64_bf16 v[56:59], v[20:23], v[168:175], v3
  v_smfmac_f32_16x16x64_bf16 v[60:63], v[20:23], v[224:231], v3
  s_xor_b32 s58, s25, 28672
  s_add_u32 s59, s24, 28672
  s_add_u32 m0, s58, 7168
  s_branch cB_sc1_ph2
.p2align 6

cB_sc2_loop:
  s_add_u32 s23, s20, 4096
  s_add_u32 s21, s20, 20480
  s_mov_b32 s30, 0
  s_mov_b32 s62, 0
  s_waitcnt vmcnt(0)
  s_barrier
cB_sc2_ld:
  buffer_load_dwordx4 v[8:11], v2, s[8:11], s20 offen offset:0 sc1
  v_mov_b32 v36, 0
  v_mov_b32 v37, 0
  v_mov_b32 v38, 0
  v_mov_b32 v39, 0
  buffer_load_dwordx4 v[12:15], v2, s[8:11], s20 offen offset:1024 sc1
  v_mov_b32 v40, 0
  v_mov_b32 v41, 0
  v_mov_b32 v42, 0
  v_mov_b32 v43, 0
  buffer_load_dwordx4 v[16:19], v2, s[8:11], s20 offen offset:2048 sc1
  v_mov_b32 v44, 0
  v_mov_b32 v45, 0
  v_mov_b32 v46, 0
  v_mov_b32 v47, 0
  ds_read_b128 v[96:99], v117 offset:0
  ds_read_b128 v[100:103], v117 offset:1024
  ds_read_b128 v[104:107], v117 offset:14336
  ds_read_b128 v[108:111], v117 offset:15360
  s_waitcnt vmcnt(2)
  v_smfmac_f32_16x16x64_bf16 v[36:39], v[8:11], a[0:7], v3
  v_smfmac_f32_16x16x64_bf16 v[40:43], v[8:11], a[56:63], v3
  buffer_load_dwordx4 v[20:23], v2, s[8:11], s20 offen offset:3072 sc1
  v_smfmac_f32_16x16x64_bf16 v[44:47], v[8:11], a[112:119], v3
  v_smfmac_f32_16x16x64_bf16 v[48:51], v[8:11], a[168:175], v3
  v_smfmac_f32_16x16x64_bf16 v[52:55], v[8:11], a[224:231], v3
  buffer_load_dwordx4 v[24:27], v2, s[8:11], s23 offen offset:0 sc1
  v_smfmac_f32_16x16x64_bf16 v[56:59], v[8:11], v[144:151], v3
  v_smfmac_f32_16x16x64_bf16 v[60:63], v[8:11], v[200:207], v3
  s_waitcnt vmcnt(3)
  v_smfmac_f32_16x16x64_bf16 v[36:39], v[12:15], a[8:15], v3
  v_smfmac_f32_16x16x64_bf16 v[40:43], v[12:15], a[64:71], v3
  buffer_load_dwordx4 v[28:31], v2, s[8:11], s23 offen offset:1024 sc1
  v_smfmac_f32_16x16x64_bf16 v[44:47], v[12:15], a[120:127], v3
  v_smfmac_f32_16x16x64_bf16 v[48:51], v[12:15], a[176:183], v3
  v_smfmac_f32_16x16x64_bf16 v[52:55], v[12:15], a[232:239], v3
  buffer_load_dwordx4 v[32:35], v2, s[8:11], s23 offen offset:2048 sc1
  v_smfmac_f32_16x16x64_bf16 v[56:59], v[12:15], v[152:159], v3
  v_smfmac_f32_16x16x64_bf16 v[60:63], v[12:15], v[208:215], v3
  s_waitcnt vmcnt(4)
  v_smfmac_f32_16x16x64_bf16 v[36:39], v[16:19], a[16:23], v3
  v_smfmac_f32_16x16x64_bf16 v[40:43], v[16:19], a[72:79], v3
  s_xor_b32 s58, s25, 28672
  s_add_u32 s59, s24, 28672
  s_add_u32 m0, s58, 14336
  v_smfmac_f32_16x16x64_bf16 v[44:47], v[16:19], a[128:135], v3
  buffer_load_dwordx4 v2, s[8:11], s59 offen offset:0 sc1 lds
  v_smfmac_f32_16x16x64_bf16 v[48:51], v[16:19], a[184:191], v3
  v_smfmac_f32_16x16x64_bf16 v[52:55], v[16:19], a[240:247], v3
  v_smfmac_f32_16x16x64_bf16 v[56:59], v[16:19], v[160:167], v3
  v_smfmac_f32_16x16x64_bf16 v[60:63], v[16:19], v[216:223], v3
  buffer_load_dwordx4 v2, s[8:11], s59 offen offset:1024 sc1 lds
  s_waitcnt vmcnt(5)
  v_smfmac_f32_16x16x64_bf16 v[36:39], v[20:23], a[24:31], v3
  v_smfmac_f32_16x16x64_bf16 v[40:43], v[20:23], a[80:87], v3
  v_smfmac_f32_16x16x64_bf16 v[44:47], v[20:23], a[136:143], v3
  v_smfmac_f32_16x16x64_bf16 v[48:51], v[20:23], a[192:199], v3
  buffer_load_dwordx4 v2, s[8:11], s59 offen offset:2048 sc1 lds
  v_smfmac_f32_16x16x64_bf16 v[52:55], v[20:23], a[248:255], v3
  v_smfmac_f32_16x16x64_bf16 v[56:59], v[20:23], v[168:175], v3
  v_smfmac_f32_16x16x64_bf16 v[60:63], v[20:23], v[224:231], v3
  s_waitcnt vmcnt(3)
cB_sc2_ph2:
  v_smfmac_f32_16x16x64_bf16 v[60:63], v[24:27], v[232:239], v3
  buffer_load_dwordx4 v2, s[8:11], s59 offen offset:3072 sc1 lds
  ds_read_b128 v[8:11], v116 offset:4096
  ds_read_b128 v[12:15], v116 offset:5120
  v_smfmac_f32_16x16x64_bf16 v[60:63], v[28:31], v[240:247], v3
  buffer_load_dword v119, v0, s[8:11], s24 offen sc1
  v_smfmac_f32_16x16x64_bf16 v[60:63], v[32:35], v[248:255], v3
  v_mov_b32 v80, v28
  v_smfmac_f32_16x16x64_bf16 v[52:55], v[24:27], v[120:127], v3
  v_mov_b32 v81, v29
  v_smfmac_f32_16x16x64_bf16 v[52:55], v[28:31], v[128:135], v3
  v_mov_b32 v82, v34
  v_smfmac_f32_16x16x64_bf16 v[52:55], v[32:35], v[136:143], v3
  v_cvt_pk_bf16_f32 v64, v60, v61
  v_smfmac_f32_16x16x64_bf16 v[56:59], v[24:27], v[176:183], v3
  v_cvt_pk_bf16_f32 v65, v62, v63
  v_smfmac_f32_16x16x64_bf16 v[56:59], v[28:31], v[184:191], v3
  v_mov_b32 v83, v35
  v_mfma_f32_16x16x32_bf16 v[68:71], v[64:67], v[4:7], 0
  v_smfmac_f32_16x16x64_bf16 v[56:59], v[32:35], v[192:199], v3
  v_cvt_pk_bf16_f32 v64, v52, v53
  v_smfmac_f32_16x16x64_bf16 v[36:39], v[24:27], a[32:39], v3
  v_cvt_pk_bf16_f32 v65, v54, v55
  v_smfmac_f32_16x16x64_bf16 v[36:39], v[28:31], a[40:47], v3
  v_cvt_pk_bf16_f32 v78, v68, v69
  v_smfmac_f32_16x16x64_bf16 v[36:39], v[32:35], a[48:55], v3
  v_cvt_pk_bf16_f32 v79, v70, v71
  v_cvt_pk_bf16_f32 v66, v56, v57
  v_smfmac_f32_16x16x64_bf16 v[40:43], v[24:27], a[88:95], v3
  v_cvt_pk_bf16_f32 v67, v58, v59
  v_smfmac_f32_16x16x64_bf16 v[40:43], v[28:31], a[96:103], v3
  v_mfma_f32_16x16x32_bf16 v[72:75], v[64:67], v[4:7], 0
  ds_read_b128 v[52:55], v116 offset:18432
  ds_read_b128 v[56:59], v116 offset:19456
  v_smfmac_f32_16x16x64_bf16 v[40:43], v[32:35], a[104:111], v3
  v_cvt_pk_bf16_f32 v64, v36, v37
  v_smfmac_f32_16x16x64_bf16 v[44:47], v[24:27], a[144:151], v3
  v_cvt_pk_bf16_f32 v65, v38, v39
  v_smfmac_f32_16x16x64_bf16 v[44:47], v[28:31], a[152:159], v3
  v_cvt_pk_bf16_f32 v76, v72, v73
  v_smfmac_f32_16x16x64_bf16 v[44:47], v[32:35], a[160:167], v3
  v_cvt_pk_bf16_f32 v77, v74, v75
  v_cvt_pk_bf16_f32 v66, v40, v41
  v_smfmac_f32_16x16x64_bf16 v[48:51], v[24:27], a[200:207], v3
  v_cvt_pk_bf16_f32 v67, v42, v43
  v_smfmac_f32_16x16x64_bf16 v[48:51], v[28:31], a[208:215], v3
  v_mfma_f32_16x16x32_bf16 v[68:71], v[64:67], v[4:7], 0
  v_smfmac_f32_16x16x64_bf16 v[48:51], v[32:35], a[216:223], v3
  v_cvt_pk_bf16_f32 v64, v44, v45
  v_mfma_f32_16x16x32_bf16 v[84:87], v[80:83], v[76:79], 0
  v_cvt_pk_bf16_f32 v65, v46, v47
  s_waitcnt lgkmcnt(0)
  v_smfmac_f32_16x16x64_bf16 v[88:91], v[76:79], v[96:103], v118
  v_cvt_pk_bf16_f32 v60, v68, v69
  v_cvt_pk_bf16_f32 v61, v70, v71
  v_cvt_pk_bf16_f32 v66, v48, v49
  v_cvt_pk_bf16_f32 v67, v50, v51
  s_nop 1
  v_mfma_f32_16x16x32_bf16 v[72:75], v[64:67], v[4:7], 0
  v_smfmac_f32_16x16x64_bf16 v[92:95], v[76:79], v[104:111], v118
  s_nop 4
  v_cvt_pk_bf16_f32 v62, v72, v73
  v_cvt_pk_bf16_f32 v63, v74, v75
  s_nop 1
  v_mfma_f32_16x16x32_bf16 v[84:87], v[16:19], v[60:63], v[84:87]
  v_smfmac_f32_16x16x64_bf16 v[88:91], v[60:63], v[8:15], v118
  v_smfmac_f32_16x16x64_bf16 v[92:95], v[60:63], v[52:59], v118
  s_nop 1
  v_permlane32_swap_b32 v84, v86
  v_permlane32_swap_b32 v85, v87
  s_nop 0
  v_add_f32 v88, v88, v89
  v_add_f32_dpp v84, v86, v84 quad_perm:[1,0,3,2] row_mask:0xf bank_mask:0xf
  v_add_f32_dpp v85, v87, v85 quad_perm:[1,0,3,2] row_mask:0xf bank_mask:0xf
  v_add_f32 v89, v90, v91
  ds_write2_b32 v113, v84, v85 offset0:0 offset1:4
  ds_write2_b32 v112, v88, v89 offset0:0 offset1:128
  v_add_f32 v90, v92, v93
  v_add_f32 v91, v94, v95
  ds_write2_b32 v112, v90, v91 offset0:64 offset1:192
  v_cmp_u_f32 vcc, v88, v89
  s_cbranch_vccnz cB_sc2_retry
cB_sc2_cont:
  s_waitcnt lgkmcnt(0)
  s_barrier
  ds_read_b128 v[36:39], v114
  ds_read_b128 v[44:47], v115
  s_waitcnt lgkmcnt(0)
  v_add_f32 v36, v36, v38
  v_add_f32 v37, v37, v39
  v_add_f32 v44, v44, v45
  v_add_f32 v46, v46, v47
  v_add_f32 v44, v44, v46
  v_add_f32 v36, v36, v37
  v_exp_f32 v49, v44
  v_exp_f32 v48, v36
  v_add_f32 v50, abs(v36), abs(v44)
  v_fma_f32 v39, v49, s37, v48
  v_cmp_ngt_f32 vcc, s56, v50
  v_cndmask_b32 v41, v48, v49, s[38:39]
  v_add_f32_dpp v39, v39, v39 quad_perm:[1,0,3,2] row_mask:0xf bank_mask:0xf
  v_cndmask_b32 v40, v49, v48, s[38:39]
  v_mov_b32_dpp v46, v41 quad_perm:[1,0,3,2] row_mask:0xf bank_mask:0xf
  v_add_f32_dpp v39, v39, v39 quad_perm:[2,3,0,1] row_mask:0xf bank_mask:0xf
  v_cndmask_b32 v42, v46, v40, s[38:39]
  v_cndmask_b32 v43, v40, v46, s[38:39]
  v_add_f32_dpp v39, v39, v39 row_half_mirror row_mask:0xf bank_mask:0xf
  s_cbranch_vccnz cB_sc2_slow
  s_nop 0
  v_add_f32_dpp v47, v39, v39 row_mirror row_mask:0xf bank_mask:0xf
  v_add_f32_dpp v39, v39, v39 row_mirror row_mask:0xf bank_mask:0xf
  s_nop 1
  v_permlane16_swap_b32 v39, v47
  v_add_f32 v39, v39, v47
  v_rcp_f32 v39, v39
  s_mov_b64 exec, s[28:29]
  v_mul_f32 v42, v42, v39
  v_mul_f32 v43, v43, v39
  v_cvt_pk_bf16_f32 v42, v42, v43
cB_sc2_pst:
  buffer_store_dword v42, v1, s[8:11], s20 offen sc1
  s_mov_b64 exec, -1
  s_barrier
  s_add_u32 s24, s24, 28672
  s_add_u32 s35, s35, 28672
  s_xor_b32 s25, s25, 28672
  s_add_u32 m0, s25, 14336
  s_add_u32 m0, s25, 18432
  s_add_u32 s22, s24, 4096
  buffer_load_dwordx4 v2, s[8:11], s22 offen offset:0 sc1 lds
  v_mov_b32 v48, 0
  v_mov_b32 v49, 0
  v_mov_b32 v50, 0
  v_mov_b32 v51, 0
  v_mov_b32 v52, 0
  v_mov_b32 v53, 0
  buffer_load_dwordx4 v2, s[8:11], s22 offen offset:1024 sc1 lds
  v_mov_b32 v54, 0
  v_mov_b32 v55, 0
  v_mov_b32 v56, 0
  v_mov_b32 v57, 0
  v_mov_b32 v58, 0
  v_mov_b32 v59, 0
  buffer_load_dwordx4 v2, s[8:11], s22 offen offset:2048 sc1 lds
  v_mov_b32 v60, 0
  v_mov_b32 v61, 0
  v_mov_b32 v62, 0
  v_mov_b32 v63, 0
  v_mov_b32 v88, 0
  v_mov_b32 v89, 0
  v_mov_b32 v90, 0
  v_mov_b32 v91, 0
  v_mov_b32 v92, 0
  v_mov_b32 v93, 0
  v_mov_b32 v94, 0
  v_mov_b32 v95, 0
  v_mov_b32 v66, 0
  v_mov_b32 v67, 0
  v_xor_b32 v116, 28672, v116
  v_add_u32 v117, s57, v117
  s_sub_u32 s57, 0, s57
  s_add_u32 s19, s19, 1
  s_mov_b32 s20, s21
  s_cmp_lt_u32 s19, 63
  s_cbranch_scc1 cB_sc2_loop
  s_branch cB_done
cB_sc2_slow:
  v_max_f32 v50, v36, v44
  s_nop 1
  v_max_f32_dpp v50, v50, v50 quad_perm:[1,0,3,2] row_mask:0xf bank_mask:0xf
  s_nop 1
  v_max_f32_dpp v50, v50, v50 quad_perm:[2,3,0,1] row_mask:0xf bank_mask:0xf
  s_nop 1
  v_max_f32_dpp v50, v50, v50 row_half_mirror row_mask:0xf bank_mask:0xf
  s_nop 1
  v_max_f32_dpp v50, v50, v50 row_mirror row_mask:0xf bank_mask:0xf
  v_mov_b32 v47, v50
  s_nop 1
  v_permlane16_swap_b32 v50, v47
  v_max_f32 v50, v50, v47
  v_sub_f32 v48, v36, v50
  v_sub_f32 v49, v44, v50
  v_exp_f32 v48, v48
  v_exp_f32 v49, v49
  s_add_u32 s31, s31, 0x100
  v_fma_f32 v39, v49, s37, v48
  v_cndmask_b32 v41, v48, v49, s[38:39]
  s_nop 0
  v_add_f32_dpp v39, v39, v39 quad_perm:[1,0,3,2] row_mask:0xf bank_mask:0xf
  v_cndmask_b32 v40, v49, v48, s[38:39]
  v_mov_b32_dpp v46, v41 quad_perm:[1,0,3,2] row_mask:0xf bank_mask:0xf
  v_add_f32_dpp v39, v39, v39 quad_perm:[2,3,0,1] row_mask:0xf bank_mask:0xf
  v_cndmask_b32 v42, v46, v40, s[38:39]
  v_cndmask_b32 v43, v40, v46, s[38:39]
  v_add_f32_dpp v39, v39, v39 row_half_mirror row_mask:0xf bank_mask:0xf
  s_nop 1
  v_add_f32_dpp v47, v39, v39 row_mirror row_mask:0xf bank_mask:0xf
  v_add_f32_dpp v39, v39, v39 row_mirror row_mask:0xf bank_mask:0xf
  s_nop 1
  v_permlane16_swap_b32 v39, v47
  v_add_f32 v39, v39, v47
  v_rcp_f32 v39, v39
  s_mov_b64 exec, s[28:29]
  v_mul_f32 v42, v42, v39
  v_mul_f32 v43, v43, v39
  v_cvt_pk_bf16_f32 v42, v42, v43
  v_min_u32 v42, -2, v42
  s_branch cB_sc2_pst
cB_sc2_retry:
  s_cmp_lg_u32 s62, 0
  s_cbranch_scc1 cB_sc2_cont
  s_waitcnt vmcnt(0) lgkmcnt(0)
cB_sc2_rv:
  buffer_load_dwordx4 v[8:11], v2, s[8:11], s20 offen offset:0 sc1
  buffer_load_dwordx4 v[12:15], v2, s[8:11], s20 offen offset:1024 sc1
  buffer_load_dwordx4 v[16:19], v2, s[8:11], s20 offen offset:2048 sc1
  buffer_load_dwordx4 v[20:23], v2, s[8:11], s20 offen offset:3072 sc1
  buffer_load_dwordx4 v[24:27], v2, s[8:11], s23 offen offset:0 sc1
  buffer_load_dwordx4 v[28:31], v2, s[8:11], s23 offen offset:1024 sc1
  buffer_load_dwordx4 v[32:35], v2, s[8:11], s23 offen offset:2048 sc1
  s_waitcnt vmcnt(0)
  v_max3_u32 v68, v8, v9, v10
  v_max3_u32 v68, v68, v11, v12
  v_max3_u32 v68, v68, v13, v14
  v_max3_u32 v68, v68, v15, v16
  v_max3_u32 v68, v68, v17, v18
  v_max3_u32 v68, v68, v19, v20
  v_max3_u32 v68, v68, v21, v22
  v_max3_u32 v68, v68, v23, v24
  v_max3_u32 v68, v68, v25, v26
  v_max3_u32 v68, v68, v27, v28
  v_max3_u32 v68, v68, v29, v30
  v_max3_u32 v68, v68, v31, v32
  v_max3_u32 v68, v68, v33, v34
  v_max_u32 v68, v68, v35
  v_cmp_eq_u32 vcc, -1, v68
  s_cbranch_vccz cB_sc2_rk
  s_add_u32 s30, s30, 1
  s_cmp_lt_u32 s30, 400000
  s_cbranch_scc1 cB_sc2_rv
  s_branch cB_abort
cB_sc2_rk:
  s_mov_b32 s62, 1
  v_mov_b32 v36, 0
  v_mov_b32 v37, 0
  v_mov_b32 v38, 0
  v_mov_b32 v39, 0
  v_mov_b32 v40, 0
  v_mov_b32 v41, 0
  v_mov_b32 v42, 0
  v_mov_b32 v43, 0
  v_mov_b32 v44, 0
  v_mov_b32 v45, 0
  v_mov_b32 v46, 0
  v_mov_b32 v47, 0
  v_mov_b32 v48, 0
  v_mov_b32 v49, 0
  v_mov_b32 v50, 0
  v_mov_b32 v51, 0
  v_mov_b32 v52, 0
  v_mov_b32 v53, 0
  v_mov_b32 v54, 0
  v_mov_b32 v55, 0
  v_mov_b32 v56, 0
  v_mov_b32 v57, 0
  v_mov_b32 v58, 0
  v_mov_b32 v59, 0
  v_mov_b32 v60, 0
  v_mov_b32 v61, 0
  v_mov_b32 v62, 0
  v_mov_b32 v63, 0
  v_mov_b32 v88, 0
  v_mov_b32 v89, 0
  v_mov_b32 v90, 0
  v_mov_b32 v91, 0
  v_mov_b32 v92, 0
  v_mov_b32 v93, 0
  v_mov_b32 v94, 0
  v_mov_b32 v95, 0
  v_mov_b32 v66, 0
  v_mov_b32 v67, 0
  s_add_u32 s31, s31, 1
  ds_read_b128 v[96:99], v117 offset:0
  ds_read_b128 v[100:103], v117 offset:1024
  ds_read_b128 v[104:107], v117 offset:14336
  ds_read_b128 v[108:111], v117 offset:15360
  v_smfmac_f32_16x16x64_bf16 v[36:39], v[8:11], a[0:7], v3
  v_smfmac_f32_16x16x64_bf16 v[40:43], v[8:11], a[56:63], v3
  v_smfmac_f32_16x16x64_bf16 v[44:47], v[8:11], a[112:119], v3
  v_smfmac_f32_16x16x64_bf16 v[48:51], v[8:11], a[168:175], v3
  v_smfmac_f32_16x16x64_bf16 v[52:55], v[8:11], a[224:231], v3
  v_smfmac_f32_16x16x64_bf16 v[56:59], v[8:11], v[144:151], v3
  v_smfmac_f32_16x16x64_bf16 v[60:63], v[8:11], v[200:207], v3
  v_smfmac_f32_16x16x64_bf16 v[36:39], v[12:15], a[8:15], v3
  v_smfmac_f32_16x16x64_bf16 v[40:43], v[12:15], a[64:71], v3
  v_smfmac_f32_16x16x64_bf16 v[44:47], v[12:15], a[120:127], v3
  v_smfmac_f32_16x16x64_bf16 v[48:51], v[12:15], a[176:183], v3
  v_smfmac_f32_16x16x64_bf16 v[52:55], v[12:15], a[232:239], v3
  v_smfmac_f32_16x16x64_bf16 v[56:59], v[12:15], v[152:159], v3
  v_smfmac_f32_16x16x64_bf16 v[60:63], v[12:15], v[208:215], v3
  v_smfmac_f32_16x16x64_bf16 v[36:39], v[16:19], a[16:23], v3
  v_smfmac_f32_16x16x64_bf16 v[40:43], v[16:19], a[72:79], v3
  v_smfmac_f32_16x16x64_bf16 v[44:47], v[16:19], a[128:135], v3
  v_smfmac_f32_16x16x64_bf16 v[48:51], v[16:19], a[184:191], v3
  v_smfmac_f32_16x16x64_bf16 v[52:55], v[16:19], a[240:247], v3
  v_smfmac_f32_16x16x64_bf16 v[56:59], v[16:19], v[160:167], v3
  v_smfmac_f32_16x16x64_bf16 v[60:63], v[16:19], v[216:223], v3
  v_smfmac_f32_16x16x64_bf16 v[36:39], v[20:23], a[24:31], v3
  v_smfmac_f32_16x16x64_bf16 v[40:43], v[20:23], a[80:87], v3
  v_smfmac_f32_16x16x64_bf16 v[44:47], v[20:23], a[136:143], v3
  v_smfmac_f32_16x16x64_bf16 v[48:51], v[20:23], a[192:199], v3
  v_smfmac_f32_16x16x64_bf16 v[52:55], v[20:23], a[248:255], v3
  v_smfmac_f32_16x16x64_bf16 v[56:59], v[20:23], v[168:175], v3
  v_smfmac_f32_16x16x64_bf16 v[60:63], v[20:23], v[224:231], v3
  s_xor_b32 s58, s25, 28672
  s_add_u32 s59, s24, 28672
  s_add_u32 m0, s58, 14336
  s_branch cB_sc2_ph2
.p2align 6

cB_sc3_loop:
  s_add_u32 s23, s20, 4096
  s_add_u32 s21, s20, 20480
  s_mov_b32 s30, 0
  s_mov_b32 s62, 0
  s_waitcnt vmcnt(0)
  s_barrier
cB_sc3_ld:
  buffer_load_dwordx4 v[8:11], v2, s[8:11], s20 offen offset:0 sc1
  v_mov_b32 v36, 0
  v_mov_b32 v37, 0
  v_mov_b32 v38, 0
  v_mov_b32 v39, 0
  buffer_load_dwordx4 v[12:15], v2, s[8:11], s20 offen offset:1024 sc1
  v_mov_b32 v40, 0
  v_mov_b32 v41, 0
  v_mov_b32 v42, 0
  v_mov_b32 v43, 0
  buffer_load_dwordx4 v[16:19], v2, s[8:11], s20 offen offset:2048 sc1
  v_mov_b32 v44, 0
  v_mov_b32 v45, 0
  v_mov_b32 v46, 0
  v_mov_b32 v47, 0
  ds_read_b128 v[96:99], v117 offset:0
  ds_read_b128 v[100:103], v117 offset:1024
  ds_read_b128 v[104:107], v117 offset:14336
  ds_read_b128 v[108:111], v117 offset:15360
  s_waitcnt vmcnt(2)
  v_smfmac_f32_16x16x64_bf16 v[36:39], v[8:11], a[0:7], v3
  v_smfmac_f32_16x16x64_bf16 v[40:43], v[8:11], a[56:63], v3
  buffer_load_dwordx4 v[20:23], v2, s[8:11], s20 offen offset:3072 sc1
  v_smfmac_f32_16x16x64_bf16 v[44:47], v[8:11], a[112:119], v3
  v_smfmac_f32_16x16x64_bf16 v[48:51], v[8:11], a[168:175], v3
  v_smfmac_f32_16x16x64_bf16 v[52:55], v[8:11], a[224:231], v3
  buffer_load_dwordx4 v[24:27], v2, s[8:11], s23 offen offset:0 sc1
  v_smfmac_f32_16x16x64_bf16 v[56:59], v[8:11], v[144:151], v3
  v_smfmac_f32_16x16x64_bf16 v[60:63], v[8:11], v[200:207], v3
  s_waitcnt vmcnt(3)
  v_smfmac_f32_16x16x64_bf16 v[36:39], v[12:15], a[8:15], v3
  v_smfmac_f32_16x16x64_bf16 v[40:43], v[12:15], a[64:71], v3
  buffer_load_dwordx4 v[28:31], v2, s[8:11], s23 offen offset:1024 sc1
  v_smfmac_f32_16x16x64_bf16 v[44:47], v[12:15], a[120:127], v3
  v_smfmac_f32_16x16x64_bf16 v[48:51], v[12:15], a[176:183], v3
  v_smfmac_f32_16x16x64_bf16 v[52:55], v[12:15], a[232:239], v3
  buffer_load_dwordx4 v[32:35], v2, s[8:11], s23 offen offset:2048 sc1
  v_smfmac_f32_16x16x64_bf16 v[56:59], v[12:15], v[152:159], v3
  v_smfmac_f32_16x16x64_bf16 v[60:63], v[12:15], v[208:215], v3
  s_waitcnt vmcnt(4)
  v_smfmac_f32_16x16x64_bf16 v[36:39], v[16:19], a[16:23], v3
  v_smfmac_f32_16x16x64_bf16 v[40:43], v[16:19], a[72:79], v3
  v_smfmac_f32_16x16x64_bf16 v[44:47], v[16:19], a[128:135], v3
  s_xor_b32 s58, s25, 28672
  s_add_u32 s59, s24, 28672
  s_add_u32 m0, s58, 21504
  v_smfmac_f32_16x16x64_bf16 v[48:51], v[16:19], a[184:191], v3
  buffer_load_dwordx4 v2, s[8:11], s59 offen offset:0 sc1 lds
  v_smfmac_f32_16x16x64_bf16 v[52:55], v[16:19], a[240:247], v3
  v_smfmac_f32_16x16x64_bf16 v[56:59], v[16:19], v[160:167], v3
  v_smfmac_f32_16x16x64_bf16 v[60:63], v[16:19], v[216:223], v3
  s_waitcnt vmcnt(4)
  v_smfmac_f32_16x16x64_bf16 v[36:39], v[20:23], a[24:31], v3
  buffer_load_dwordx4 v2, s[8:11], s59 offen offset:1024 sc1 lds
  v_smfmac_f32_16x16x64_bf16 v[40:43], v[20:23], a[80:87], v3
  v_smfmac_f32_16x16x64_bf16 v[44:47], v[20:23], a[136:143], v3
  v_smfmac_f32_16x16x64_bf16 v[48:51], v[20:23], a[192:199], v3
  v_smfmac_f32_16x16x64_bf16 v[52:55], v[20:23], a[248:255], v3
  buffer_load_dwordx4 v2, s[8:11], s59 offen offset:2048 sc1 lds
  v_smfmac_f32_16x16x64_bf16 v[56:59], v[20:23], v[168:175], v3
  v_smfmac_f32_16x16x64_bf16 v[60:63], v[20:23], v[224:231], v3
  s_waitcnt vmcnt(3)
cB_sc3_ph2:
  v_smfmac_f32_16x16x64_bf16 v[60:63], v[24:27], v[232:239], v3
  ds_read_b128 v[8:11], v116 offset:6144
  ds_read_b128 v[12:15], v116 offset:7168
  v_smfmac_f32_16x16x64_bf16 v[60:63], v[28:31], v[240:247], v3
  buffer_load_dwordx4 v2, s[8:11], s59 offen offset:3072 sc1 lds
  v_smfmac_f32_16x16x64_bf16 v[60:63], v[32:35], v[248:255], v3
  v_mov_b32 v80, v30
  v_smfmac_f32_16x16x64_bf16 v[52:55], v[24:27], v[120:127], v3
  v_mov_b32 v81, v31
  v_smfmac_f32_16x16x64_bf16 v[52:55], v[28:31], v[128:135], v3
  v_mov_b32 v82, v34
  v_smfmac_f32_16x16x64_bf16 v[52:55], v[32:35], v[136:143], v3
  v_cvt_pk_bf16_f32 v66, v60, v61
  v_smfmac_f32_16x16x64_bf16 v[56:59], v[24:27], v[176:183], v3
  v_cvt_pk_bf16_f32 v67, v62, v63
  v_smfmac_f32_16x16x64_bf16 v[56:59], v[28:31], v[184:191], v3
  v_mov_b32 v83, v35
  v_mfma_f32_16x16x32_bf16 v[68:71], v[64:67], v[4:7], 0
  v_smfmac_f32_16x16x64_bf16 v[56:59], v[32:35], v[192:199], v3
  v_cvt_pk_bf16_f32 v64, v52, v53
  v_smfmac_f32_16x16x64_bf16 v[36:39], v[24:27], a[32:39], v3
  v_cvt_pk_bf16_f32 v65, v54, v55
  v_smfmac_f32_16x16x64_bf16 v[36:39], v[28:31], a[40:47], v3
  v_cvt_pk_bf16_f32 v78, v68, v69
  v_smfmac_f32_16x16x64_bf16 v[36:39], v[32:35], a[48:55], v3
  v_cvt_pk_bf16_f32 v79, v70, v71
  v_cvt_pk_bf16_f32 v66, v56, v57
  v_smfmac_f32_16x16x64_bf16 v[40:43], v[24:27], a[88:95], v3
  v_cvt_pk_bf16_f32 v67, v58, v59
  v_smfmac_f32_16x16x64_bf16 v[40:43], v[28:31], a[96:103], v3
  v_mfma_f32_16x16x32_bf16 v[72:75], v[64:67], v[4:7], 0
  ds_read_b128 v[52:55], v116 offset:20480
  ds_read_b128 v[56:59], v116 offset:21504
  v_smfmac_f32_16x16x64_bf16 v[40:43], v[32:35], a[104:111], v3
  v_cvt_pk_bf16_f32 v64, v36, v37
  v_smfmac_f32_16x16x64_bf16 v[44:47], v[24:27], a[144:151], v3
  v_cvt_pk_bf16_f32 v65, v38, v39
  v_smfmac_f32_16x16x64_bf16 v[44:47], v[28:31], a[152:159], v3
  v_cvt_pk_bf16_f32 v76, v72, v73
  v_smfmac_f32_16x16x64_bf16 v[44:47], v[32:35], a[160:167], v3
  v_cvt_pk_bf16_f32 v77, v74, v75
  v_cvt_pk_bf16_f32 v66, v40, v41
  v_smfmac_f32_16x16x64_bf16 v[48:51], v[24:27], a[200:207], v3
  v_cvt_pk_bf16_f32 v67, v42, v43
  v_smfmac_f32_16x16x64_bf16 v[48:51], v[28:31], a[208:215], v3
  v_mfma_f32_16x16x32_bf16 v[68:71], v[64:67], v[4:7], 0
  v_smfmac_f32_16x16x64_bf16 v[48:51], v[32:35], a[216:223], v3
  v_cvt_pk_bf16_f32 v64, v44, v45
  v_mfma_f32_16x16x32_bf16 v[84:87], v[80:83], v[76:79], 0
  v_cvt_pk_bf16_f32 v65, v46, v47
  s_waitcnt lgkmcnt(0)
  v_smfmac_f32_16x16x64_bf16 v[88:91], v[76:79], v[96:103], v118
  v_cvt_pk_bf16_f32 v60, v68, v69
  v_cvt_pk_bf16_f32 v61, v70, v71
  v_cvt_pk_bf16_f32 v66, v48, v49
  v_cvt_pk_bf16_f32 v67, v50, v51
  s_nop 1
  v_mfma_f32_16x16x32_bf16 v[72:75], v[64:67], v[4:7], 0
  v_smfmac_f32_16x16x64_bf16 v[92:95], v[76:79], v[104:111], v118
  s_nop 4
  v_cvt_pk_bf16_f32 v62, v72, v73
  v_cvt_pk_bf16_f32 v63, v74, v75
  s_nop 1
  v_mfma_f32_16x16x32_bf16 v[84:87], v[20:23], v[60:63], v[84:87]
  v_smfmac_f32_16x16x64_bf16 v[88:91], v[60:63], v[8:15], v118
  v_smfmac_f32_16x16x64_bf16 v[92:95], v[60:63], v[52:59], v118
  s_nop 1
  v_permlane32_swap_b32 v84, v86
  v_permlane32_swap_b32 v85, v87
  s_nop 0
  v_add_f32 v88, v88, v89
  v_add_f32_dpp v84, v86, v84 quad_perm:[1,0,3,2] row_mask:0xf bank_mask:0xf
  v_add_f32_dpp v85, v87, v85 quad_perm:[1,0,3,2] row_mask:0xf bank_mask:0xf
  v_add_f32 v89, v90, v91
  ds_write2_b32 v113, v84, v85 offset0:0 offset1:4
  ds_write2_b32 v112, v88, v89 offset0:0 offset1:128
  v_add_f32 v90, v92, v93
  v_add_f32 v91, v94, v95
  ds_write2_b32 v112, v90, v91 offset0:64 offset1:192
  v_cmp_u_f32 vcc, v88, v89
  s_cbranch_vccnz cB_sc3_retry
cB_sc3_cont:
  s_waitcnt lgkmcnt(0)
  s_barrier
  ds_read_b128 v[36:39], v114
  ds_read_b128 v[44:47], v115
  s_waitcnt lgkmcnt(0)
  v_add_f32 v36, v36, v38
  v_add_f32 v37, v37, v39
  v_add_f32 v44, v44, v45
  v_add_f32 v46, v46, v47
  v_add_f32 v44, v44, v46
  v_add_f32 v36, v36, v37
  v_exp_f32 v49, v44
  v_exp_f32 v48, v36
  v_add_f32 v50, abs(v36), abs(v44)
  v_fma_f32 v39, v49, s37, v48
  v_cmp_ngt_f32 vcc, s56, v50
  v_cndmask_b32 v41, v48, v49, s[38:39]
  v_add_f32_dpp v39, v39, v39 quad_perm:[1,0,3,2] row_mask:0xf bank_mask:0xf
  v_cndmask_b32 v40, v49, v48, s[38:39]
  v_mov_b32_dpp v46, v41 quad_perm:[1,0,3,2] row_mask:0xf bank_mask:0xf
  v_add_f32_dpp v39, v39, v39 quad_perm:[2,3,0,1] row_mask:0xf bank_mask:0xf
  v_cndmask_b32 v42, v46, v40, s[38:39]
  v_cndmask_b32 v43, v40, v46, s[38:39]
  v_add_f32_dpp v39, v39, v39 row_half_mirror row_mask:0xf bank_mask:0xf
  s_cbranch_vccnz cB_sc3_slow
  s_nop 0
  v_add_f32_dpp v47, v39, v39 row_mirror row_mask:0xf bank_mask:0xf
  v_add_f32_dpp v39, v39, v39 row_mirror row_mask:0xf bank_mask:0xf
  s_nop 1
  v_permlane16_swap_b32 v39, v47
  v_add_f32 v39, v39, v47
  v_rcp_f32 v39, v39
  s_mov_b64 exec, s[28:29]
  v_mul_f32 v42, v42, v39
  v_mul_f32 v43, v43, v39
  v_cvt_pk_bf16_f32 v42, v42, v43
cB_sc3_pst:
  buffer_store_dword v42, v1, s[8:11], s20 offen sc1
  s_mov_b64 exec, -1
  s_barrier
  s_add_u32 s24, s24, 28672
  s_add_u32 s35, s35, 28672
  s_xor_b32 s25, s25, 28672
  s_add_u32 m0, s25, 21504
  s_add_u32 m0, s25, 25600
  s_add_u32 s22, s24, 4096
  buffer_load_dwordx4 v2, s[8:11], s22 offen offset:0 sc1 lds
  v_mov_b32 v48, 0
  v_mov_b32 v49, 0
  v_mov_b32 v50, 0
  v_mov_b32 v51, 0
  v_mov_b32 v52, 0
  v_mov_b32 v53, 0
  buffer_load_dwordx4 v2, s[8:11], s22 offen offset:1024 sc1 lds
  v_mov_b32 v54, 0
  v_mov_b32 v55, 0
  v_mov_b32 v56, 0
  v_mov_b32 v57, 0
  v_mov_b32 v58, 0
  v_mov_b32 v59, 0
  buffer_load_dwordx4 v2, s[8:11], s22 offen offset:2048 sc1 lds
  v_mov_b32 v60, 0
  v_mov_b32 v61, 0
  v_mov_b32 v62, 0
  v_mov_b32 v63, 0
  v_mov_b32 v88, 0
  v_mov_b32 v89, 0
  v_mov_b32 v90, 0
  v_mov_b32 v91, 0
  v_mov_b32 v92, 0
  v_mov_b32 v93, 0
  v_mov_b32 v94, 0
  v_mov_b32 v95, 0
  v_mov_b32 v64, 0
  v_mov_b32 v65, 0
  v_xor_b32 v116, 28672, v116
  v_add_u32 v117, s57, v117
  s_sub_u32 s57, 0, s57
  s_add_u32 s19, s19, 1
  s_mov_b32 s20, s21
  s_cmp_lt_u32 s19, 63
  s_cbranch_scc1 cB_sc3_loop
  s_branch cB_done
cB_sc3_slow:
  v_max_f32 v50, v36, v44
  s_nop 1
  v_max_f32_dpp v50, v50, v50 quad_perm:[1,0,3,2] row_mask:0xf bank_mask:0xf
  s_nop 1
  v_max_f32_dpp v50, v50, v50 quad_perm:[2,3,0,1] row_mask:0xf bank_mask:0xf
  s_nop 1
  v_max_f32_dpp v50, v50, v50 row_half_mirror row_mask:0xf bank_mask:0xf
  s_nop 1
  v_max_f32_dpp v50, v50, v50 row_mirror row_mask:0xf bank_mask:0xf
  v_mov_b32 v47, v50
  s_nop 1
  v_permlane16_swap_b32 v50, v47
  v_max_f32 v50, v50, v47
  v_sub_f32 v48, v36, v50
  v_sub_f32 v49, v44, v50
  v_exp_f32 v48, v48
  v_exp_f32 v49, v49
  s_add_u32 s31, s31, 0x100
  v_fma_f32 v39, v49, s37, v48
  v_cndmask_b32 v41, v48, v49, s[38:39]
  s_nop 0
  v_add_f32_dpp v39, v39, v39 quad_perm:[1,0,3,2] row_mask:0xf bank_mask:0xf
  v_cndmask_b32 v40, v49, v48, s[38:39]
  v_mov_b32_dpp v46, v41 quad_perm:[1,0,3,2] row_mask:0xf bank_mask:0xf
  v_add_f32_dpp v39, v39, v39 quad_perm:[2,3,0,1] row_mask:0xf bank_mask:0xf
  v_cndmask_b32 v42, v46, v40, s[38:39]
  v_cndmask_b32 v43, v40, v46, s[38:39]
  v_add_f32_dpp v39, v39, v39 row_half_mirror row_mask:0xf bank_mask:0xf
  s_nop 1
  v_add_f32_dpp v47, v39, v39 row_mirror row_mask:0xf bank_mask:0xf
  v_add_f32_dpp v39, v39, v39 row_mirror row_mask:0xf bank_mask:0xf
  s_nop 1
  v_permlane16_swap_b32 v39, v47
  v_add_f32 v39, v39, v47
  v_rcp_f32 v39, v39
  s_mov_b64 exec, s[28:29]
  v_mul_f32 v42, v42, v39
  v_mul_f32 v43, v43, v39
  v_cvt_pk_bf16_f32 v42, v42, v43
  v_min_u32 v42, -2, v42
  s_branch cB_sc3_pst
cB_sc3_retry:
  s_cmp_lg_u32 s62, 0
  s_cbranch_scc1 cB_sc3_cont
  s_waitcnt vmcnt(0) lgkmcnt(0)
cB_sc3_rv:
  buffer_load_dwordx4 v[8:11], v2, s[8:11], s20 offen offset:0 sc1
  buffer_load_dwordx4 v[12:15], v2, s[8:11], s20 offen offset:1024 sc1
  buffer_load_dwordx4 v[16:19], v2, s[8:11], s20 offen offset:2048 sc1
  buffer_load_dwordx4 v[20:23], v2, s[8:11], s20 offen offset:3072 sc1
  buffer_load_dwordx4 v[24:27], v2, s[8:11], s23 offen offset:0 sc1
  buffer_load_dwordx4 v[28:31], v2, s[8:11], s23 offen offset:1024 sc1
  buffer_load_dwordx4 v[32:35], v2, s[8:11], s23 offen offset:2048 sc1
  s_waitcnt vmcnt(0)
  v_max3_u32 v68, v8, v9, v10
  v_max3_u32 v68, v68, v11, v12
  v_max3_u32 v68, v68, v13, v14
  v_max3_u32 v68, v68, v15, v16
  v_max3_u32 v68, v68, v17, v18
  v_max3_u32 v68, v68, v19, v20
  v_max3_u32 v68, v68, v21, v22
  v_max3_u32 v68, v68, v23, v24
  v_max3_u32 v68, v68, v25, v26
  v_max3_u32 v68, v68, v27, v28
  v_max3_u32 v68, v68, v29, v30
  v_max3_u32 v68, v68, v31, v32
  v_max3_u32 v68, v68, v33, v34
  v_max_u32 v68, v68, v35
  v_cmp_eq_u32 vcc, -1, v68
  s_cbranch_vccz cB_sc3_rk
  s_add_u32 s30, s30, 1
  s_cmp_lt_u32 s30, 400000
  s_cbranch_scc1 cB_sc3_rv
  s_branch cB_abort
cB_sc3_rk:
  s_mov_b32 s62, 1
  v_mov_b32 v36, 0
  v_mov_b32 v37, 0
  v_mov_b32 v38, 0
  v_mov_b32 v39, 0
  v_mov_b32 v40, 0
  v_mov_b32 v41, 0
  v_mov_b32 v42, 0
  v_mov_b32 v43, 0
  v_mov_b32 v44, 0
  v_mov_b32 v45, 0
  v_mov_b32 v46, 0
  v_mov_b32 v47, 0
  v_mov_b32 v48, 0
  v_mov_b32 v49, 0
  v_mov_b32 v50, 0
  v_mov_b32 v51, 0
  v_mov_b32 v52, 0
  v_mov_b32 v53, 0
  v_mov_b32 v54, 0
  v_mov_b32 v55, 0
  v_mov_b32 v56, 0
  v_mov_b32 v57, 0
  v_mov_b32 v58, 0
  v_mov_b32 v59, 0
  v_mov_b32 v60, 0
  v_mov_b32 v61, 0
  v_mov_b32 v62, 0
  v_mov_b32 v63, 0
  v_mov_b32 v88, 0
  v_mov_b32 v89, 0
  v_mov_b32 v90, 0
  v_mov_b32 v91, 0
  v_mov_b32 v92, 0
  v_mov_b32 v93, 0
  v_mov_b32 v94, 0
  v_mov_b32 v95, 0
  v_mov_b32 v64, 0
  v_mov_b32 v65, 0
  s_add_u32 s31, s31, 1
  ds_read_b128 v[96:99], v117 offset:0
  ds_read_b128 v[100:103], v117 offset:1024
  ds_read_b128 v[104:107], v117 offset:14336
  ds_read_b128 v[108:111], v117 offset:15360
  v_smfmac_f32_16x16x64_bf16 v[36:39], v[8:11], a[0:7], v3
  v_smfmac_f32_16x16x64_bf16 v[40:43], v[8:11], a[56:63], v3
  v_smfmac_f32_16x16x64_bf16 v[44:47], v[8:11], a[112:119], v3
  v_smfmac_f32_16x16x64_bf16 v[48:51], v[8:11], a[168:175], v3
  v_smfmac_f32_16x16x64_bf16 v[52:55], v[8:11], a[224:231], v3
  v_smfmac_f32_16x16x64_bf16 v[56:59], v[8:11], v[144:151], v3
  v_smfmac_f32_16x16x64_bf16 v[60:63], v[8:11], v[200:207], v3
  v_smfmac_f32_16x16x64_bf16 v[36:39], v[12:15], a[8:15], v3
  v_smfmac_f32_16x16x64_bf16 v[40:43], v[12:15], a[64:71], v3
  v_smfmac_f32_16x16x64_bf16 v[44:47], v[12:15], a[120:127], v3
  v_smfmac_f32_16x16x64_bf16 v[48:51], v[12:15], a[176:183], v3
  v_smfmac_f32_16x16x64_bf16 v[52:55], v[12:15], a[232:239], v3
  v_smfmac_f32_16x16x64_bf16 v[56:59], v[12:15], v[152:159], v3
  v_smfmac_f32_16x16x64_bf16 v[60:63], v[12:15], v[208:215], v3
  v_smfmac_f32_16x16x64_bf16 v[36:39], v[16:19], a[16:23], v3
  v_smfmac_f32_16x16x64_bf16 v[40:43], v[16:19], a[72:79], v3
  v_smfmac_f32_16x16x64_bf16 v[44:47], v[16:19], a[128:135], v3
  v_smfmac_f32_16x16x64_bf16 v[48:51], v[16:19], a[184:191], v3
  v_smfmac_f32_16x16x64_bf16 v[52:55], v[16:19], a[240:247], v3
  v_smfmac_f32_16x16x64_bf16 v[56:59], v[16:19], v[160:167], v3
  v_smfmac_f32_16x16x64_bf16 v[60:63], v[16:19], v[216:223], v3
  v_smfmac_f32_16x16x64_bf16 v[36:39], v[20:23], a[24:31], v3
  v_smfmac_f32_16x16x64_bf16 v[40:43], v[20:23], a[80:87], v3
  v_smfmac_f32_16x16x64_bf16 v[44:47], v[20:23], a[136:143], v3
  v_smfmac_f32_16x16x64_bf16 v[48:51], v[20:23], a[192:199], v3
  v_smfmac_f32_16x16x64_bf16 v[52:55], v[20:23], a[248:255], v3
  v_smfmac_f32_16x16x64_bf16 v[56:59], v[20:23], v[168:175], v3
  v_smfmac_f32_16x16x64_bf16 v[60:63], v[20:23], v[224:231], v3
  s_xor_b32 s58, s25, 28672
  s_add_u32 s59, s24, 28672
  s_add_u32 m0, s58, 21504
  s_branch cB_sc3_ph2
.p2align 6

cB_va0_loop:
  s_add_u32 s23, s20, 4096
  s_add_u32 s21, s20, 20480
  s_mov_b32 s30, 0
  s_cmp_lg_u32 s19, s38
  s_cbranch_scc1 cB_va0_vok
  s_branch cB_va0_voc
cB_va0_vow:
  s_sub_u32 s22, s39, s35
  v_lshlrev_b32 v63, 7, v2
  v_min_u32 v63, s22, v63
  buffer_load_dword v63, v63, s[8:11], s35 offen sc1
  s_waitcnt vmcnt(0)
cB_va0_voc:
  v_readfirstlane_b32 s22, v63
  s_cmp_eq_u32 s22, 56
  s_cbranch_scc1 cB_va0_vod
  s_sleep 1
  s_add_u32 s30, s30, 1
  s_cmp_lt_u32 s30, 400000
  s_cbranch_scc1 cB_va0_vow
  s_branch cB_abort
cB_va0_vod:
  s_add_u32 s35, s35, 2048
  s_add_u32 s38, s19, 8
  s_and_b32 s38, s38, -8
  s_cmp_eq_u32 s19, 0
  s_cselect_b32 s38, 4, s38
  v_cmp_ne_u32 vcc, 56, v63
  s_nop 3
  s_cmp_eq_u64 vcc, 0
  s_cselect_b32 s38, 99, s38
cB_va0_vok:
  s_cmp_eq_u32 s19, 63
  s_cbranch_scc1 cB_done
  s_barrier
  s_add_u32 s22, s25, 0
  buffer_load_dwordx4 v[80:83], v6, s[8:11], s22 offen offset:0 sc1
  buffer_load_dwordx4 v[84:87], v6, s[8:11], s22 offen offset:1792 sc1
  s_add_u32 s22, s25, 3584
  buffer_load_dwordx4 v[88:91], v6, s[8:11], s22 offen offset:0 sc1
  buffer_load_dwordx4 v[92:95], v6, s[8:11], s22 offen offset:1792 sc1
  s_add_u32 s22, s25, 7168
  buffer_load_dwordx4 v[96:99], v6, s[8:11], s22 offen offset:0 sc1
  buffer_load_dwordx4 v[100:103], v6, s[8:11], s22 offen offset:1792 sc1
  s_add_u32 s22, s25, 10752
  buffer_load_dwordx4 v[104:107], v6, s[8:11], s22 offen offset:0 sc1
  buffer_load_dwordx4 v[108:111], v6, s[8:11], s22 offen offset:1792 sc1
  s_add_u32 s22, s25, 14336
  buffer_load_dwordx4 v[112:115], v6, s[8:11], s22 offen offset:0 sc1
  buffer_load_dwordx4 v[116:119], v6, s[8:11], s22 offen offset:1792 sc1
  s_add_u32 s22, s25, 17920
  buffer_load_dwordx4 v[120:123], v6, s[8:11], s22 offen offset:0 sc1
  buffer_load_dwordx4 v[124:127], v6, s[8:11], s22 offen offset:1792 sc1
  s_add_u32 s22, s19, 1
  s_cmp_lg_u32 s22, s38
  s_cbranch_scc1 cB_va0_nk
  s_sub_u32 s22, s39, s35
  v_lshlrev_b32 v63, 7, v2
  v_min_u32 v63, s22, v63
  buffer_load_dword v63, v63, s[8:11], s35 offen sc1
cB_va0_nk:
  s_barrier
  ds_read_b128 v[8:11], v0 offset:8192
  ds_read_b128 v[12:15], v0 offset:9216
  ds_read_b128 v[16:19], v0 offset:10240
  ds_read_b128 v[20:23], v0 offset:11264
  ds_read_b128 v[24:27], v0 offset:12288
  ds_read_b128 v[28:31], v0 offset:13312
  ds_read_b128 v[32:35], v0 offset:14336
  s_waitcnt lgkmcnt(0)
  v_smfmac_f32_16x16x64_bf16 v[36:39], v[8:11], a[0:7], v3
  s_add_u32 s22, s25, 21504
  buffer_load_dwordx4 v[128:131], v6, s[8:11], s22 offen offset:0 sc1
  v_smfmac_f32_16x16x64_bf16 v[36:39], v[12:15], a[8:15], v3
  v_smfmac_f32_16x16x64_bf16 v[36:39], v[16:19], a[16:23], v3
  s_add_u32 s22, s25, 21504
  buffer_load_dwordx4 v[132:135], v6, s[8:11], s22 offen offset:1792 sc1
  v_smfmac_f32_16x16x64_bf16 v[36:39], v[20:23], a[24:31], v3
  v_smfmac_f32_16x16x64_bf16 v[36:39], v[24:27], a[32:39], v3
  s_add_u32 s22, s25, 25088
  buffer_load_dwordx4 v[136:139], v6, s[8:11], s22 offen offset:0 sc1
  v_smfmac_f32_16x16x64_bf16 v[36:39], v[28:31], a[40:47], v3
  v_smfmac_f32_16x16x64_bf16 v[36:39], v[32:35], a[48:55], v3
  s_add_u32 s22, s25, 25088
  buffer_load_dwordx4 v[140:143], v6, s[8:11], s22 offen offset:1792 sc1
  v_smfmac_f32_16x16x64_bf16 v[40:43], v[8:11], a[56:63], v3
  v_smfmac_f32_16x16x64_bf16 v[40:43], v[12:15], a[64:71], v3
  v_smfmac_f32_16x16x64_bf16 v[40:43], v[16:19], a[72:79], v3
  v_add_f32 v36, v36, v37
  v_smfmac_f32_16x16x64_bf16 v[40:43], v[20:23], a[80:87], v3
  v_add_f32 v38, v38, v39
  v_smfmac_f32_16x16x64_bf16 v[40:43], v[24:27], a[88:95], v3
  v_cvt_pk_bf16_f32 v36, v36, v38
  v_smfmac_f32_16x16x64_bf16 v[40:43], v[28:31], a[96:103], v3
  ds_write_b32 v60, v36
  v_smfmac_f32_16x16x64_bf16 v[40:43], v[32:35], a[104:111], v3
  v_smfmac_f32_16x16x64_bf16 v[44:47], v[8:11], a[112:119], v3
  v_smfmac_f32_16x16x64_bf16 v[44:47], v[12:15], a[120:127], v3
  v_smfmac_f32_16x16x64_bf16 v[44:47], v[16:19], a[128:135], v3
  v_add_f32 v40, v40, v41
  v_smfmac_f32_16x16x64_bf16 v[44:47], v[20:23], a[136:143], v3
  v_add_f32 v42, v42, v43
  v_smfmac_f32_16x16x64_bf16 v[44:47], v[24:27], a[144:151], v3
  v_cvt_pk_bf16_f32 v40, v40, v42
  v_smfmac_f32_16x16x64_bf16 v[44:47], v[28:31], a[152:159], v3
  ds_write_b32 v61, v40
  v_smfmac_f32_16x16x64_bf16 v[44:47], v[32:35], a[160:167], v3
  v_smfmac_f32_16x16x64_bf16 v[48:51], v[8:11], a[168:175], v3
  v_smfmac_f32_16x16x64_bf16 v[48:51], v[12:15], a[176:183], v3
  v_smfmac_f32_16x16x64_bf16 v[48:51], v[16:19], a[184:191], v3
  v_add_f32 v44, v44, v45
  v_smfmac_f32_16x16x64_bf16 v[48:51], v[20:23], a[192:199], v3
  v_add_f32 v46, v46, v47
  v_smfmac_f32_16x16x64_bf16 v[48:51], v[24:27], a[200:207], v3
  v_cvt_pk_bf16_f32 v44, v44, v46
  v_smfmac_f32_16x16x64_bf16 v[48:51], v[28:31], a[208:215], v3
  ds_write_b32 v62, v44
  v_smfmac_f32_16x16x64_bf16 v[48:51], v[32:35], a[216:223], v3
  v_smfmac_f32_16x16x64_bf16 v[52:55], v[8:11], a[224:231], v3
  v_smfmac_f32_16x16x64_bf16 v[52:55], v[12:15], a[232:239], v3
  v_smfmac_f32_16x16x64_bf16 v[52:55], v[16:19], a[240:247], v3
  v_add_f32 v48, v48, v49
  v_smfmac_f32_16x16x64_bf16 v[52:55], v[20:23], a[248:255], v3
  v_add_f32 v50, v50, v51
  v_smfmac_f32_16x16x64_bf16 v[52:55], v[24:27], v[176:183], v3
  v_cvt_pk_bf16_f32 v48, v48, v50
  v_smfmac_f32_16x16x64_bf16 v[52:55], v[28:31], v[184:191], v3
  ds_write_b32 v170, v48
  v_smfmac_f32_16x16x64_bf16 v[52:55], v[32:35], v[192:199], v3
  v_smfmac_f32_16x16x64_bf16 v[56:59], v[8:11], v[200:207], v3
  v_smfmac_f32_16x16x64_bf16 v[56:59], v[12:15], v[208:215], v3
  v_smfmac_f32_16x16x64_bf16 v[56:59], v[16:19], v[216:223], v3
  v_add_f32 v52, v52, v53
  v_smfmac_f32_16x16x64_bf16 v[56:59], v[20:23], v[224:231], v3
  v_add_f32 v54, v54, v55
  v_smfmac_f32_16x16x64_bf16 v[56:59], v[24:27], v[232:239], v3
  v_cvt_pk_bf16_f32 v52, v52, v54
  v_smfmac_f32_16x16x64_bf16 v[56:59], v[28:31], v[240:247], v3
  ds_write_b32 v171, v52
  v_smfmac_f32_16x16x64_bf16 v[56:59], v[32:35], v[248:255], v3
  s_nop 7
  v_add_f32 v56, v56, v57
  v_add_f32 v58, v58, v59
  v_cvt_pk_bf16_f32 v56, v56, v58
  ds_write_b32 v172, v56
  buffer_load_dword v164, v4, s[8:11], s20 offen sc1
  s_waitcnt lgkmcnt(0)
  v_mov_b32 v36, 0
  v_mov_b32 v37, 0
  v_mov_b32 v38, 0
  v_mov_b32 v39, 0
  v_mov_b32 v40, 0
  v_mov_b32 v41, 0
  v_mov_b32 v42, 0
  v_mov_b32 v43, 0
  buffer_load_dword v165, v4, s[8:11], s20 offen sc1
  v_mov_b32 v44, 0
  v_mov_b32 v45, 0
  v_mov_b32 v46, 0
  v_mov_b32 v47, 0
  v_mov_b32 v48, 0
  v_mov_b32 v49, 0
  v_mov_b32 v50, 0
  v_mov_b32 v51, 0
  buffer_load_dword v166, v4, s[8:11], s20 offen sc1
  v_mov_b32 v52, 0
  v_mov_b32 v53, 0
  v_mov_b32 v54, 0
  v_mov_b32 v55, 0
  v_mov_b32 v56, 0
  v_mov_b32 v57, 0
  v_mov_b32 v58, 0
  v_mov_b32 v59, 0
  buffer_load_dword v167, v4, s[8:11], s20 offen sc1
  s_cmp_eq_u32 s19, 63
  s_cbranch_scc1 cB_va0_last
  s_add_u32 s22, s20, 9216
  s_add_u32 s34, s20, 13312
  s_add_u32 s36, s20, 7168
  s_mov_b32 s37, 0
  v_mov_b32 v156, 0
  v_mov_b32 v157, 0
  v_mov_b32 v158, 0
  v_mov_b32 v159, 0
  buffer_load_dword v168, v4, s[8:11], s20 offen sc1
cB_va0_fw_l:
  s_waitcnt vmcnt(4)
  v_cmp_eq_u32 vcc, -1, v164
  s_cbranch_vccz cB_va0_fw_d
  buffer_load_dword v164, v4, s[8:11], s20 offen sc1
  s_waitcnt vmcnt(4)
  v_cmp_eq_u32 vcc, -1, v165
  s_cbranch_vccz cB_va0_fw_d
  buffer_load_dword v165, v4, s[8:11], s20 offen sc1
  s_waitcnt vmcnt(4)
  v_cmp_eq_u32 vcc, -1, v166
  s_cbranch_vccz cB_va0_fw_d
  buffer_load_dword v166, v4, s[8:11], s20 offen sc1
  s_waitcnt vmcnt(4)
  v_cmp_eq_u32 vcc, -1, v167
  s_cbranch_vccz cB_va0_fw_d
  buffer_load_dword v167, v4, s[8:11], s20 offen sc1
  s_waitcnt vmcnt(4)
  v_cmp_eq_u32 vcc, -1, v168
  s_cbranch_vccz cB_va0_fw_d
  buffer_load_dword v168, v4, s[8:11], s20 offen sc1
  s_add_u32 s30, s30, 1
  s_cmp_lt_u32 s30, 400000
  s_cbranch_scc1 cB_va0_fw_l
  s_branch cB_abort
cB_va0_fw_d:
  s_waitcnt lgkmcnt(0)
  buffer_load_dwordx4 v[8:11], v5, s[8:11], s22 offen offset:0 sc1
  buffer_load_dwordx4 v[12:15], v5, s[8:11], s22 offen offset:1024 sc1
  buffer_load_dwordx4 v[16:19], v5, s[8:11], s22 offen offset:2048 sc1
  buffer_load_dwordx4 v[20:23], v5, s[8:11], s22 offen offset:3072 sc1
  buffer_load_dwordx4 v[24:27], v5, s[8:11], s34 offen offset:0 sc1
  buffer_load_dwordx4 v[28:31], v5, s[8:11], s34 offen offset:1024 sc1
  buffer_load_dwordx4 v[32:35], v5, s[8:11], s34 offen offset:2048 sc1
  buffer_load_dwordx4 v[144:147], v5, s[8:11], s34 offen offset:3072 sc1
  buffer_load_dwordx4 v[148:151], v2, s[8:11], s36 offen offset:0 sc1
  buffer_load_dwordx4 v[152:155], v2, s[8:11], s36 offen offset:1024 sc1
  s_barrier
  ds_read_b128 v[64:67], v2 offset:0
  ds_read_b128 v[68:71], v2 offset:1024
  ds_read_b128 v[72:75], v2 offset:2048
  ds_read_b128 v[76:79], v2 offset:3072
  s_waitcnt vmcnt(9)
  v_smfmac_f32_16x16x64_bf16 v[156:159], v[8:11], v[80:87], v3
  s_waitcnt vmcnt(8)
  v_smfmac_f32_16x16x64_bf16 v[156:159], v[12:15], v[88:95], v3
  s_waitcnt vmcnt(7)
  v_smfmac_f32_16x16x64_bf16 v[156:159], v[16:19], v[96:103], v3
  s_waitcnt vmcnt(6)
  v_smfmac_f32_16x16x64_bf16 v[156:159], v[20:23], v[104:111], v3
  s_waitcnt vmcnt(5)
  v_smfmac_f32_16x16x64_bf16 v[156:159], v[24:27], v[112:119], v3
  s_waitcnt vmcnt(4)
  v_smfmac_f32_16x16x64_bf16 v[156:159], v[28:31], v[120:127], v3
  s_waitcnt vmcnt(3)
  v_smfmac_f32_16x16x64_bf16 v[156:159], v[32:35], v[128:135], v3
  s_waitcnt vmcnt(2)
  v_smfmac_f32_16x16x64_bf16 v[156:159], v[144:147], v[136:143], v3
  s_waitcnt vmcnt(1) lgkmcnt(0)
  v_smfmac_f32_16x16x64_bf16 v[156:159], v[148:151], v[64:71], v3
  s_waitcnt vmcnt(0)
  v_smfmac_f32_16x16x64_bf16 v[156:159], v[152:155], v[72:79], v3
cB_va0_ep:
  s_nop 7
  v_add_f32 v160, v156, v157
  v_add_f32 v161, v158, v159
  v_cmp_u_f32 vcc, v160, v161
  v_mov_b32_dpp v162, v160 row_ror:8 row_mask:0xf bank_mask:0xf
  v_mov_b32_dpp v160, v161 row_ror:8 row_mask:0xf bank_mask:0xc
  s_cbranch_vccnz cB_va0_rp
  v_mov_b32_dpp v161, v162 quad_perm:[0,1,2,3] row_mask:0xf bank_mask:0x3
  v_cvt_pk_bf16_f32 v160, v160, v161
cB_va0_pc:
  buffer_store_dword v160, v1, s[8:11], s21 offen sc1
  s_cmp_lg_u32 s19, 62
  s_cbranch_scc1 cB_va0_nl
  s_mov_b32 s22, 88531968
  buffer_store_dword v160, v1, s[8:11], s22 offen sc1
  s_mov_b64 exec, -1
  s_branch cB_done
cB_va0_nl:
  s_mov_b64 exec, -1
  s_add_u32 s25, s25, 28672
  s_add_u32 s19, s19, 1
  s_mov_b32 s20, s21
  s_branch cB_va0_loop
cB_va0_last:
  s_waitcnt lgkmcnt(0)
  s_barrier
  s_branch cB_done
cB_va0_rp:
  s_cmp_eq_u32 s37, 0
  s_cbranch_scc1 cB_va0_rv
  v_mov_b32_dpp v161, v162 quad_perm:[0,1,2,3] row_mask:0xf bank_mask:0x3
  v_cvt_pk_bf16_f32 v160, v160, v161
  v_min_u32 v160, -2, v160
  s_branch cB_va0_pc
cB_va0_rv:
  buffer_load_dwordx4 v[8:11], v5, s[8:11], s22 offen offset:0 sc1
  buffer_load_dwordx4 v[12:15], v5, s[8:11], s22 offen offset:1024 sc1
  buffer_load_dwordx4 v[16:19], v5, s[8:11], s22 offen offset:2048 sc1
  buffer_load_dwordx4 v[20:23], v5, s[8:11], s22 offen offset:3072 sc1
  buffer_load_dwordx4 v[24:27], v5, s[8:11], s34 offen offset:0 sc1
  buffer_load_dwordx4 v[28:31], v5, s[8:11], s34 offen offset:1024 sc1
  buffer_load_dwordx4 v[32:35], v5, s[8:11], s34 offen offset:2048 sc1
  buffer_load_dwordx4 v[144:147], v5, s[8:11], s34 offen offset:3072 sc1
  buffer_load_dwordx4 v[148:151], v2, s[8:11], s36 offen offset:0 sc1
  buffer_load_dwordx4 v[152:155], v2, s[8:11], s36 offen offset:1024 sc1
  s_waitcnt vmcnt(0)
  v_max3_u32 v175, v8, v9, v10
  v_max3_u32 v175, v175, v11, v12
  v_max3_u32 v175, v175, v13, v14
  v_max3_u32 v175, v175, v15, v16
  v_max3_u32 v175, v175, v17, v18
  v_max3_u32 v175, v175, v19, v20
  v_max3_u32 v175, v175, v21, v22
  v_max3_u32 v175, v175, v23, v24
  v_max3_u32 v175, v175, v25, v26
  v_max3_u32 v175, v175, v27, v28
  v_max3_u32 v175, v175, v29, v30
  v_max3_u32 v175, v175, v31, v32
  v_max3_u32 v175, v175, v33, v34
  v_max3_u32 v175, v175, v35, v144
  v_max3_u32 v175, v175, v145, v146
  v_max3_u32 v175, v175, v147, v148
  v_max3_u32 v175, v175, v149, v150
  v_max3_u32 v175, v175, v151, v152
  v_max3_u32 v175, v175, v153, v154
  v_max_u32 v175, v175, v155
  v_cmp_eq_u32 vcc, -1, v175
  s_cbranch_vccz cB_va0_rk
  s_add_u32 s30, s30, 1
  s_cmp_lt_u32 s30, 400000
  s_cbranch_scc1 cB_va0_rv
  s_branch cB_abort
cB_va0_rk:
  s_mov_b32 s37, 1
  s_add_u32 s31, s31, 0x10000
  v_mov_b32 v156, 0
  v_mov_b32 v157, 0
  v_mov_b32 v158, 0
  v_mov_b32 v159, 0
  s_nop 1
  v_smfmac_f32_16x16x64_bf16 v[156:159], v[8:11], v[80:87], v3
  v_smfmac_f32_16x16x64_bf16 v[156:159], v[12:15], v[88:95], v3
  v_smfmac_f32_16x16x64_bf16 v[156:159], v[16:19], v[96:103], v3
  v_smfmac_f32_16x16x64_bf16 v[156:159], v[20:23], v[104:111], v3
  v_smfmac_f32_16x16x64_bf16 v[156:159], v[24:27], v[112:119], v3
  v_smfmac_f32_16x16x64_bf16 v[156:159], v[28:31], v[120:127], v3
  v_smfmac_f32_16x16x64_bf16 v[156:159], v[32:35], v[128:135], v3
  v_smfmac_f32_16x16x64_bf16 v[156:159], v[144:147], v[136:143], v3
  v_smfmac_f32_16x16x64_bf16 v[156:159], v[148:151], v[64:71], v3
  v_smfmac_f32_16x16x64_bf16 v[156:159], v[152:155], v[72:79], v3
  s_nop 7
  s_branch cB_va0_ep
.p2align 6

cB_va1_loop:
  s_add_u32 s23, s20, 4096
  s_add_u32 s21, s20, 20480
  s_mov_b32 s30, 0
  s_cmp_lg_u32 s19, s38
  s_cbranch_scc1 cB_va1_vok
  s_branch cB_va1_voc
cB_va1_vow:
  s_sub_u32 s22, s39, s35
  v_lshlrev_b32 v63, 7, v2
  v_min_u32 v63, s22, v63
  buffer_load_dword v63, v63, s[8:11], s35 offen sc1
  s_waitcnt vmcnt(0)
cB_va1_voc:
  v_readfirstlane_b32 s22, v63
  s_cmp_eq_u32 s22, 56
  s_cbranch_scc1 cB_va1_vod
  s_sleep 1
  s_add_u32 s30, s30, 1
  s_cmp_lt_u32 s30, 400000
  s_cbranch_scc1 cB_va1_vow
  s_branch cB_abort
cB_va1_vod:
  s_add_u32 s35, s35, 2048
  s_add_u32 s38, s19, 8
  s_and_b32 s38, s38, -8
  s_cmp_eq_u32 s19, 0
  s_cselect_b32 s38, 4, s38
  v_cmp_ne_u32 vcc, 56, v63
  s_nop 3
  s_cmp_eq_u64 vcc, 0
  s_cselect_b32 s38, 99, s38
cB_va1_vok:
  s_cmp_eq_u32 s19, 63
  s_cbranch_scc1 cB_done
  s_barrier
  s_add_u32 s22, s25, 0
  buffer_load_dwordx4 v[80:83], v6, s[8:11], s22 offen offset:0 sc1
  buffer_load_dwordx4 v[84:87], v6, s[8:11], s22 offen offset:1792 sc1
  s_add_u32 s22, s25, 3584
  buffer_load_dwordx4 v[88:91], v6, s[8:11], s22 offen offset:0 sc1
  buffer_load_dwordx4 v[92:95], v6, s[8:11], s22 offen offset:1792 sc1
  s_add_u32 s22, s25, 7168
  buffer_load_dwordx4 v[96:99], v6, s[8:11], s22 offen offset:0 sc1
  buffer_load_dwordx4 v[100:103], v6, s[8:11], s22 offen offset:1792 sc1
  s_add_u32 s22, s25, 10752
  buffer_load_dwordx4 v[104:107], v6, s[8:11], s22 offen offset:0 sc1
  buffer_load_dwordx4 v[108:111], v6, s[8:11], s22 offen offset:1792 sc1
  s_add_u32 s22, s25, 14336
  buffer_load_dwordx4 v[112:115], v6, s[8:11], s22 offen offset:0 sc1
  buffer_load_dwordx4 v[116:119], v6, s[8:11], s22 offen offset:1792 sc1
  s_add_u32 s22, s25, 17920
  buffer_load_dwordx4 v[120:123], v6, s[8:11], s22 offen offset:0 sc1
  buffer_load_dwordx4 v[124:127], v6, s[8:11], s22 offen offset:1792 sc1
  s_add_u32 s22, s19, 1
  s_cmp_lg_u32 s22, s38
  s_cbranch_scc1 cB_va1_nk
  s_sub_u32 s22, s39, s35
  v_lshlrev_b32 v63, 7, v2
  v_min_u32 v63, s22, v63
  buffer_load_dword v63, v63, s[8:11], s35 offen sc1
cB_va1_nk:
  s_barrier
  ds_read_b128 v[8:11], v0 offset:8192
  ds_read_b128 v[12:15], v0 offset:9216
  ds_read_b128 v[16:19], v0 offset:10240
  ds_read_b128 v[20:23], v0 offset:11264
  ds_read_b128 v[24:27], v0 offset:12288
  ds_read_b128 v[28:31], v0 offset:13312
  ds_read_b128 v[32:35], v0 offset:14336
  s_waitcnt lgkmcnt(0)
  v_smfmac_f32_16x16x64_bf16 v[36:39], v[8:11], a[0:7], v3
  s_add_u32 s22, s25, 21504
  buffer_load_dwordx4 v[128:131], v6, s[8:11], s22 offen offset:0 sc1
  v_smfmac_f32_16x16x64_bf16 v[36:39], v[12:15], a[8:15], v3
  v_smfmac_f32_16x16x64_bf16 v[36:39], v[16:19], a[16:23], v3
  s_add_u32 s22, s25, 21504
  buffer_load_dwordx4 v[132:135], v6, s[8:11], s22 offen offset:1792 sc1
  v_smfmac_f32_16x16x64_bf16 v[36:39], v[20:23], a[24:31], v3
  v_smfmac_f32_16x16x64_bf16 v[36:39], v[24:27], a[32:39], v3
  s_add_u32 s22, s25, 25088
  buffer_load_dwordx4 v[136:139], v6, s[8:11], s22 offen offset:0 sc1
  v_smfmac_f32_16x16x64_bf16 v[36:39], v[28:31], a[40:47], v3
  v_smfmac_f32_16x16x64_bf16 v[36:39], v[32:35], a[48:55], v3
  s_add_u32 s22, s25, 25088
  buffer_load_dwordx4 v[140:143], v6, s[8:11], s22 offen offset:1792 sc1
  v_smfmac_f32_16x16x64_bf16 v[40:43], v[8:11], a[56:63], v3
  v_smfmac_f32_16x16x64_bf16 v[40:43], v[12:15], a[64:71], v3
  v_smfmac_f32_16x16x64_bf16 v[40:43], v[16:19], a[72:79], v3
  v_add_f32 v36, v36, v37
  v_smfmac_f32_16x16x64_bf16 v[40:43], v[20:23], a[80:87], v3
  v_add_f32 v38, v38, v39
  v_smfmac_f32_16x16x64_bf16 v[40:43], v[24:27], a[88:95], v3
  v_cvt_pk_bf16_f32 v36, v36, v38
  v_smfmac_f32_16x16x64_bf16 v[40:43], v[28:31], a[96:103], v3
  ds_write_b32 v60, v36
  v_smfmac_f32_16x16x64_bf16 v[40:43], v[32:35], a[104:111], v3
  v_smfmac_f32_16x16x64_bf16 v[44:47], v[8:11], a[112:119], v3
  v_smfmac_f32_16x16x64_bf16 v[44:47], v[12:15], a[120:127], v3
  v_smfmac_f32_16x16x64_bf16 v[44:47], v[16:19], a[128:135], v3
  v_add_f32 v40, v40, v41
  v_smfmac_f32_16x16x64_bf16 v[44:47], v[20:23], a[136:143], v3
  v_add_f32 v42, v42, v43
  v_smfmac_f32_16x16x64_bf16 v[44:47], v[24:27], a[144:151], v3
  v_cvt_pk_bf16_f32 v40, v40, v42
  v_smfmac_f32_16x16x64_bf16 v[44:47], v[28:31], a[152:159], v3
  ds_write_b32 v61, v40
  v_smfmac_f32_16x16x64_bf16 v[44:47], v[32:35], a[160:167], v3
  v_smfmac_f32_16x16x64_bf16 v[48:51], v[8:11], a[168:175], v3
  v_smfmac_f32_16x16x64_bf16 v[48:51], v[12:15], a[176:183], v3
  v_smfmac_f32_16x16x64_bf16 v[48:51], v[16:19], a[184:191], v3
  v_add_f32 v44, v44, v45
  v_smfmac_f32_16x16x64_bf16 v[48:51], v[20:23], a[192:199], v3
  v_add_f32 v46, v46, v47
  v_smfmac_f32_16x16x64_bf16 v[48:51], v[24:27], a[200:207], v3
  v_cvt_pk_bf16_f32 v44, v44, v46
  v_smfmac_f32_16x16x64_bf16 v[48:51], v[28:31], a[208:215], v3
  ds_write_b32 v62, v44
  v_smfmac_f32_16x16x64_bf16 v[48:51], v[32:35], a[216:223], v3
  v_smfmac_f32_16x16x64_bf16 v[52:55], v[8:11], a[224:231], v3
  v_smfmac_f32_16x16x64_bf16 v[52:55], v[12:15], a[232:239], v3
  v_smfmac_f32_16x16x64_bf16 v[52:55], v[16:19], a[240:247], v3
  v_add_f32 v48, v48, v49
  v_smfmac_f32_16x16x64_bf16 v[52:55], v[20:23], a[248:255], v3
  v_add_f32 v50, v50, v51
  v_smfmac_f32_16x16x64_bf16 v[52:55], v[24:27], v[176:183], v3
  v_cvt_pk_bf16_f32 v48, v48, v50
  v_smfmac_f32_16x16x64_bf16 v[52:55], v[28:31], v[184:191], v3
  ds_write_b32 v170, v48
  v_smfmac_f32_16x16x64_bf16 v[52:55], v[32:35], v[192:199], v3
  v_smfmac_f32_16x16x64_bf16 v[56:59], v[8:11], v[200:207], v3
  v_smfmac_f32_16x16x64_bf16 v[56:59], v[12:15], v[208:215], v3
  v_smfmac_f32_16x16x64_bf16 v[56:59], v[16:19], v[216:223], v3
  v_add_f32 v52, v52, v53
  v_smfmac_f32_16x16x64_bf16 v[56:59], v[20:23], v[224:231], v3
  v_add_f32 v54, v54, v55
  v_smfmac_f32_16x16x64_bf16 v[56:59], v[24:27], v[232:239], v3
  v_cvt_pk_bf16_f32 v52, v52, v54
  v_smfmac_f32_16x16x64_bf16 v[56:59], v[28:31], v[240:247], v3
  ds_write_b32 v171, v52
  v_smfmac_f32_16x16x64_bf16 v[56:59], v[32:35], v[248:255], v3
  s_nop 7
  v_add_f32 v56, v56, v57
  v_add_f32 v58, v58, v59
  v_cvt_pk_bf16_f32 v56, v56, v58
  ds_write_b32 v172, v56
  s_waitcnt lgkmcnt(0)
  v_mov_b32 v36, 0
  v_mov_b32 v37, 0
  v_mov_b32 v38, 0
  v_mov_b32 v39, 0
  v_mov_b32 v40, 0
  v_mov_b32 v41, 0
  v_mov_b32 v42, 0
  v_mov_b32 v43, 0
  v_mov_b32 v44, 0
  v_mov_b32 v45, 0
  v_mov_b32 v46, 0
  v_mov_b32 v47, 0
  v_mov_b32 v48, 0
  v_mov_b32 v49, 0
  v_mov_b32 v50, 0
  v_mov_b32 v51, 0
  v_mov_b32 v52, 0
  v_mov_b32 v53, 0
  v_mov_b32 v54, 0
  v_mov_b32 v55, 0
  v_mov_b32 v56, 0
  v_mov_b32 v57, 0
  v_mov_b32 v58, 0
  v_mov_b32 v59, 0
  s_cmp_eq_u32 s19, 63
  s_cbranch_scc1 cB_va1_last
  s_add_u32 s22, s20, 9216
  s_add_u32 s34, s20, 13312
  s_add_u32 s36, s20, 7168
  s_mov_b32 s37, 0
  v_mov_b32 v156, 0
  v_mov_b32 v157, 0
  v_mov_b32 v158, 0
  v_mov_b32 v159, 0
  s_barrier
  s_waitcnt lgkmcnt(0)
  buffer_load_dwordx4 v[8:11], v5, s[8:11], s22 offen offset:0 sc1
  buffer_load_dwordx4 v[12:15], v5, s[8:11], s22 offen offset:1024 sc1
  buffer_load_dwordx4 v[16:19], v5, s[8:11], s22 offen offset:2048 sc1
  buffer_load_dwordx4 v[20:23], v5, s[8:11], s22 offen offset:3072 sc1
  buffer_load_dwordx4 v[24:27], v5, s[8:11], s34 offen offset:0 sc1
  buffer_load_dwordx4 v[28:31], v5, s[8:11], s34 offen offset:1024 sc1
  buffer_load_dwordx4 v[32:35], v5, s[8:11], s34 offen offset:2048 sc1
  buffer_load_dwordx4 v[144:147], v5, s[8:11], s34 offen offset:3072 sc1
  s_sub_u32 s23, s21, 4
  s_mov_b64 exec, 65535
  buffer_store_dword v2, v7, s[8:11], s23 offen sc1
  s_mov_b64 exec, -1
  buffer_load_dwordx4 v[148:151], v2, s[8:11], s36 offen offset:0 sc1
  buffer_load_dwordx4 v[152:155], v2, s[8:11], s36 offen offset:1024 sc1
  ds_read_b128 v[64:67], v2 offset:4096
  ds_read_b128 v[68:71], v2 offset:5120
  ds_read_b128 v[72:75], v2 offset:6144
  ds_read_b128 v[76:79], v2 offset:7168
  s_waitcnt vmcnt(10)
  v_smfmac_f32_16x16x64_bf16 v[156:159], v[8:11], v[80:87], v3
  s_waitcnt vmcnt(9)
  v_smfmac_f32_16x16x64_bf16 v[156:159], v[12:15], v[88:95], v3
  s_waitcnt vmcnt(8)
  v_smfmac_f32_16x16x64_bf16 v[156:159], v[16:19], v[96:103], v3
  s_waitcnt vmcnt(7)
  v_smfmac_f32_16x16x64_bf16 v[156:159], v[20:23], v[104:111], v3
  s_waitcnt vmcnt(6)
  v_smfmac_f32_16x16x64_bf16 v[156:159], v[24:27], v[112:119], v3
  s_mov_b64 exec, 65535
  buffer_store_dword v2, v7, s[8:11], s21 offen sc1
  s_mov_b64 exec, -1
  s_waitcnt vmcnt(6)
  v_smfmac_f32_16x16x64_bf16 v[156:159], v[28:31], v[120:127], v3
  s_waitcnt vmcnt(5)
  v_smfmac_f32_16x16x64_bf16 v[156:159], v[32:35], v[128:135], v3
  s_waitcnt vmcnt(4)
  v_smfmac_f32_16x16x64_bf16 v[156:159], v[144:147], v[136:143], v3
  s_waitcnt vmcnt(2) lgkmcnt(0)
  v_smfmac_f32_16x16x64_bf16 v[156:159], v[148:151], v[64:71], v3
  s_waitcnt vmcnt(1)
  v_smfmac_f32_16x16x64_bf16 v[156:159], v[152:155], v[72:79], v3
cB_va1_ep:
  s_nop 7
  v_add_f32 v160, v156, v157
  v_add_f32 v161, v158, v159
  v_cmp_u_f32 vcc, v160, v161
  v_mov_b32_dpp v162, v160 row_ror:8 row_mask:0xf bank_mask:0xf
  v_mov_b32_dpp v160, v161 row_ror:8 row_mask:0xf bank_mask:0xc
  s_cbranch_vccnz cB_va1_rp
  v_mov_b32_dpp v161, v162 quad_perm:[0,1,2,3] row_mask:0xf bank_mask:0x3
  v_cvt_pk_bf16_f32 v160, v160, v161
cB_va1_pc:
  s_mov_b64 exec, s[26:27]
  buffer_store_dword v160, v1, s[8:11], s21 offen sc1
  s_cmp_lg_u32 s19, 62
  s_cbranch_scc1 cB_va1_nl
  s_mov_b32 s22, 88531968
  buffer_store_dword v160, v1, s[8:11], s22 offen sc1
  s_mov_b64 exec, -1
  s_branch cB_done
cB_va1_nl:
  s_mov_b64 exec, -1
  s_cmp_lg_u32 s19, 0
  s_cbranch_scc1 cB_va1_s0
  v_add_u32 v7, 512, v7
  v_lshl_add_u32 v7, v2, 3, v7
  s_mov_b64 exec, 65535
  buffer_store_dword v2, v7, s[8:11], s21 offen sc1
  buffer_store_dword v2, v7, s[8:11], s23 offen sc1
  s_mov_b64 exec, -1
cB_va1_s0:
  s_add_u32 s25, s25, 28672
  s_add_u32 s19, s19, 1
  s_mov_b32 s20, s21
  s_branch cB_va1_loop
cB_va1_last:
  s_waitcnt lgkmcnt(0)
  s_barrier
  s_branch cB_done
cB_va1_rp:
  s_cmp_eq_u32 s37, 0
  s_cbranch_scc1 cB_va1_rv
  v_mov_b32_dpp v161, v162 quad_perm:[0,1,2,3] row_mask:0xf bank_mask:0x3
  v_cvt_pk_bf16_f32 v160, v160, v161
  v_min_u32 v160, -2, v160
  s_branch cB_va1_pc
cB_va1_rv:
  buffer_load_dwordx4 v[8:11], v5, s[8:11], s22 offen offset:0 sc1
  buffer_load_dwordx4 v[12:15], v5, s[8:11], s22 offen offset:1024 sc1
  buffer_load_dwordx4 v[16:19], v5, s[8:11], s22 offen offset:2048 sc1
  buffer_load_dwordx4 v[20:23], v5, s[8:11], s22 offen offset:3072 sc1
  buffer_load_dwordx4 v[24:27], v5, s[8:11], s34 offen offset:0 sc1
  buffer_load_dwordx4 v[28:31], v5, s[8:11], s34 offen offset:1024 sc1
  buffer_load_dwordx4 v[32:35], v5, s[8:11], s34 offen offset:2048 sc1
  buffer_load_dwordx4 v[144:147], v5, s[8:11], s34 offen offset:3072 sc1
  buffer_load_dwordx4 v[148:151], v2, s[8:11], s36 offen offset:0 sc1
  buffer_load_dwordx4 v[152:155], v2, s[8:11], s36 offen offset:1024 sc1
  s_waitcnt vmcnt(0)
  v_max3_u32 v175, v8, v9, v10
  v_max3_u32 v175, v175, v11, v12
  v_max3_u32 v175, v175, v13, v14
  v_max3_u32 v175, v175, v15, v16
  v_max3_u32 v175, v175, v17, v18
  v_max3_u32 v175, v175, v19, v20
  v_max3_u32 v175, v175, v21, v22
  v_max3_u32 v175, v175, v23, v24
  v_max3_u32 v175, v175, v25, v26
  v_max3_u32 v175, v175, v27, v28
  v_max3_u32 v175, v175, v29, v30
  v_max3_u32 v175, v175, v31, v32
  v_max3_u32 v175, v175, v33, v34
  v_max3_u32 v175, v175, v35, v144
  v_max3_u32 v175, v175, v145, v146
  v_max3_u32 v175, v175, v147, v148
  v_max3_u32 v175, v175, v149, v150
  v_max3_u32 v175, v175, v151, v152
  v_max3_u32 v175, v175, v153, v154
  v_max_u32 v175, v175, v155
  v_cmp_eq_u32 vcc, -1, v175
  s_cbranch_vccz cB_va1_rk
  s_add_u32 s30, s30, 1
  s_cmp_lt_u32 s30, 400000
  s_cbranch_scc1 cB_va1_rv
  s_branch cB_abort
cB_va1_rk:
  s_mov_b32 s37, 1
  s_add_u32 s31, s31, 0x10000
  v_mov_b32 v156, 0
  v_mov_b32 v157, 0
  v_mov_b32 v158, 0
  v_mov_b32 v159, 0
  s_nop 1
  v_smfmac_f32_16x16x64_bf16 v[156:159], v[8:11], v[80:87], v3
  v_smfmac_f32_16x16x64_bf16 v[156:159], v[12:15], v[88:95], v3
  v_smfmac_f32_16x16x64_bf16 v[156:159], v[16:19], v[96:103], v3
  v_smfmac_f32_16x16x64_bf16 v[156:159], v[20:23], v[104:111], v3
  v_smfmac_f32_16x16x64_bf16 v[156:159], v[24:27], v[112:119], v3
  v_smfmac_f32_16x16x64_bf16 v[156:159], v[28:31], v[120:127], v3
  v_smfmac_f32_16x16x64_bf16 v[156:159], v[32:35], v[128:135], v3
  v_smfmac_f32_16x16x64_bf16 v[156:159], v[144:147], v[136:143], v3
  v_smfmac_f32_16x16x64_bf16 v[156:159], v[148:151], v[64:71], v3
  v_smfmac_f32_16x16x64_bf16 v[156:159], v[152:155], v[72:79], v3
  s_nop 7
  s_branch cB_va1_ep
.p2align 6

cB_va2_loop:
  s_add_u32 s23, s20, 4096
  s_add_u32 s21, s20, 20480
  v_mov_b32 v36, 0
  v_mov_b32 v37, 0
  v_mov_b32 v38, 0
  v_mov_b32 v39, 0
  v_mov_b32 v40, 0
  v_mov_b32 v41, 0
  v_mov_b32 v42, 0
  v_mov_b32 v43, 0
  v_mov_b32 v44, 0
  v_mov_b32 v45, 0
  v_mov_b32 v46, 0
  v_mov_b32 v47, 0
  v_mov_b32 v48, 0
  v_mov_b32 v49, 0
  v_mov_b32 v50, 0
  v_mov_b32 v51, 0
  v_mov_b32 v52, 0
  v_mov_b32 v53, 0
  v_mov_b32 v54, 0
  v_mov_b32 v55, 0
  v_mov_b32 v56, 0
  v_mov_b32 v57, 0
  v_mov_b32 v58, 0
  v_mov_b32 v59, 0
  v_mov_b32 v60, 0
  v_mov_b32 v61, 0
  v_mov_b32 v62, 0
  v_mov_b32 v63, 0
  v_mov_b32 v64, 0
  v_mov_b32 v65, 0
  v_mov_b32 v66, 0
  v_mov_b32 v67, 0
  s_mov_b32 s30, 0
  buffer_load_dword v76, v119, s[8:11], s20 offen sc1
  buffer_load_dword v77, v119, s[8:11], s20 offen sc1
  buffer_load_dword v78, v119, s[8:11], s20 offen sc1
cB_va2_fp_l:
  s_waitcnt vmcnt(2)
  v_cmp_eq_u32 vcc, -1, v76
  s_cbranch_vccz cB_va2_fp_d
  buffer_load_dword v76, v119, s[8:11], s20 offen sc1
  s_waitcnt vmcnt(2)
  v_cmp_eq_u32 vcc, -1, v77
  s_cbranch_vccz cB_va2_fp_d
  buffer_load_dword v77, v119, s[8:11], s20 offen sc1
  s_waitcnt vmcnt(2)
  v_cmp_eq_u32 vcc, -1, v78
  s_cbranch_vccz cB_va2_fp_d
  buffer_load_dword v78, v119, s[8:11], s20 offen sc1
  s_add_u32 s30, s30, 1
  s_cmp_lt_u32 s30, 400000
  s_cbranch_scc1 cB_va2_fp_l
  s_branch cB_abort
cB_va2_fp_d:
  buffer_load_dwordx4 v[8:11], v2, s[8:11], s20 offen offset:0 sc1
  buffer_load_dwordx4 v[12:15], v2, s[8:11], s20 offen offset:1024 sc1
  buffer_load_dwordx4 v[16:19], v2, s[8:11], s20 offen offset:2048 sc1
  buffer_load_dwordx4 v[20:23], v2, s[8:11], s20 offen offset:3072 sc1
  s_barrier
cB_va2_ld:
  s_waitcnt vmcnt(0)
  v_max3_u32 v84, v8, v9, v10
  v_max3_u32 v84, v84, v11, v12
  v_max3_u32 v84, v84, v13, v14
  v_max3_u32 v84, v84, v15, v16
  v_max3_u32 v84, v84, v17, v18
  v_max3_u32 v84, v84, v19, v20
  v_max3_u32 v84, v84, v21, v22
  v_max_u32 v84, v84, v23
  v_cmp_eq_u32 vcc, -1, v84
  ds_write_b128 v2, v[8:11] offset:8192
  ds_write_b128 v2, v[12:15] offset:9216
  ds_write_b128 v2, v[16:19] offset:10240
  ds_write_b128 v2, v[20:23] offset:11264
  s_cbranch_vccnz cB_va2_retry
  s_waitcnt lgkmcnt(0)
  s_barrier
  ds_read_b128 v[8:11], v5 offset:8192
  ds_read_b128 v[12:15], v5 offset:9216
  ds_read_b128 v[16:19], v5 offset:10240
  ds_read_b128 v[20:23], v5 offset:11264
  ds_read_b128 v[24:27], v5 offset:12288
  ds_read_b128 v[28:31], v5 offset:13312
  ds_read_b128 v[32:35], v5 offset:14336
  ds_read_b128 v[92:95], v0
  s_waitcnt lgkmcnt(0)
  s_mov_b64 exec, s[26:27]
  buffer_store_dwordx4 v[92:95], v2, s[8:11], s36 offen sc1
  s_mov_b64 exec, -1
  s_add_u32 s36, s36, 7168
  s_cmp_eq_u32 s19, 63
  s_cbranch_scc1 cB_done
  ds_read_b128 v[76:79], v1 offset:0
  ds_read_b128 v[80:83], v1 offset:1024
  ds_read_b128 v[84:87], v1 offset:2048
  ds_read_b128 v[88:91], v1 offset:3072
  ds_read_b128 v[92:95], v1 offset:4096
  ds_read_b128 v[96:99], v1 offset:5120
  v_smfmac_f32_16x16x64_bf16 v[60:63], v[8:11], v[200:207], v3
  v_smfmac_f32_16x16x64_bf16 v[60:63], v[12:15], v[208:215], v3
  s_waitcnt lgkmcnt(4)
  v_smfmac_f32_16x16x64_bf16 v[64:67], v[8:11], v[76:83], v3
  ds_read_b128 v[76:79], v1 offset:6144
  ds_read_b128 v[80:83], v1 offset:7168
  v_smfmac_f32_16x16x64_bf16 v[60:63], v[16:19], v[216:223], v3
  v_smfmac_f32_16x16x64_bf16 v[60:63], v[20:23], v[224:231], v3
  s_waitcnt lgkmcnt(4)
  v_smfmac_f32_16x16x64_bf16 v[64:67], v[12:15], v[84:91], v3
  ds_read_b128 v[84:87], v1 offset:8192
  ds_read_b128 v[88:91], v1 offset:9216
  v_smfmac_f32_16x16x64_bf16 v[60:63], v[24:27], v[232:239], v3
  v_smfmac_f32_16x16x64_bf16 v[60:63], v[28:31], v[240:247], v3
  s_waitcnt lgkmcnt(4)
  v_smfmac_f32_16x16x64_bf16 v[64:67], v[16:19], v[92:99], v3
  ds_read_b128 v[92:95], v1 offset:10240
  ds_read_b128 v[96:99], v1 offset:11264
  v_smfmac_f32_16x16x64_bf16 v[60:63], v[32:35], v[248:255], v3
  v_smfmac_f32_16x16x64_bf16 v[36:39], v[8:11], a[0:7], v3
  s_waitcnt lgkmcnt(4)
  v_smfmac_f32_16x16x64_bf16 v[64:67], v[20:23], v[76:83], v3
  ds_read_b128 v[76:79], v1 offset:12288
  ds_read_b128 v[80:83], v1 offset:13312
  v_smfmac_f32_16x16x64_bf16 v[36:39], v[12:15], a[8:15], v3
  v_add_f32 v60, v60, v61
  v_smfmac_f32_16x16x64_bf16 v[36:39], v[16:19], a[16:23], v3
  v_add_f32 v62, v62, v63
  s_waitcnt lgkmcnt(4)
  v_smfmac_f32_16x16x64_bf16 v[64:67], v[24:27], v[84:91], v3
  v_cvt_pk_bf16_f32 v60, v60, v62
  v_smfmac_f32_16x16x64_bf16 v[36:39], v[20:23], a[24:31], v3
  ds_write_b32 v106, v60
  v_smfmac_f32_16x16x64_bf16 v[36:39], v[24:27], a[32:39], v3
  s_waitcnt lgkmcnt(2)
  v_smfmac_f32_16x16x64_bf16 v[64:67], v[28:31], v[92:99], v3
  v_smfmac_f32_16x16x64_bf16 v[36:39], v[28:31], a[40:47], v3
  v_smfmac_f32_16x16x64_bf16 v[36:39], v[32:35], a[48:55], v3
  s_waitcnt lgkmcnt(0)
  v_smfmac_f32_16x16x64_bf16 v[64:67], v[32:35], v[76:83], v3
  v_smfmac_f32_16x16x64_bf16 v[40:43], v[8:11], a[56:63], v3
  v_smfmac_f32_16x16x64_bf16 v[40:43], v[12:15], a[64:71], v3
  v_add_f32 v36, v36, v37
  v_smfmac_f32_16x16x64_bf16 v[40:43], v[16:19], a[72:79], v3
  v_add_f32 v38, v38, v39
  v_smfmac_f32_16x16x64_bf16 v[40:43], v[20:23], a[80:87], v3
  v_cvt_pk_bf16_f32 v36, v36, v38
  v_smfmac_f32_16x16x64_bf16 v[40:43], v[24:27], a[88:95], v3
  ds_write_b32 v100, v36
  v_smfmac_f32_16x16x64_bf16 v[40:43], v[28:31], a[96:103], v3
  v_add_f32 v64, v64, v65
  v_smfmac_f32_16x16x64_bf16 v[40:43], v[32:35], a[104:111], v3
  v_add_f32 v66, v66, v67
  v_smfmac_f32_16x16x64_bf16 v[44:47], v[8:11], a[112:119], v3
  v_cvt_pk_bf16_f32 v64, v64, v66
  v_smfmac_f32_16x16x64_bf16 v[44:47], v[12:15], a[120:127], v3
  ds_write_b32 v107, v64
  v_smfmac_f32_16x16x64_bf16 v[44:47], v[16:19], a[128:135], v3
  v_add_f32 v40, v40, v41
  v_smfmac_f32_16x16x64_bf16 v[44:47], v[20:23], a[136:143], v3
  v_add_f32 v42, v42, v43
  v_smfmac_f32_16x16x64_bf16 v[44:47], v[24:27], a[144:151], v3
  v_cvt_pk_bf16_f32 v40, v40, v42
  v_smfmac_f32_16x16x64_bf16 v[44:47], v[28:31], a[152:159], v3
  ds_write_b32 v101, v40
  v_smfmac_f32_16x16x64_bf16 v[44:47], v[32:35], a[160:167], v3
  v_smfmac_f32_16x16x64_bf16 v[48:51], v[8:11], a[168:175], v3
  v_smfmac_f32_16x16x64_bf16 v[48:51], v[12:15], a[176:183], v3
  v_smfmac_f32_16x16x64_bf16 v[48:51], v[16:19], a[184:191], v3
  v_add_f32 v44, v44, v45
  v_smfmac_f32_16x16x64_bf16 v[48:51], v[20:23], a[192:199], v3
  v_add_f32 v46, v46, v47
  v_smfmac_f32_16x16x64_bf16 v[48:51], v[24:27], a[200:207], v3
  v_cvt_pk_bf16_f32 v44, v44, v46
  v_smfmac_f32_16x16x64_bf16 v[48:51], v[28:31], a[208:215], v3
  ds_write_b32 v102, v44
  v_smfmac_f32_16x16x64_bf16 v[48:51], v[32:35], a[216:223], v3
  v_smfmac_f32_16x16x64_bf16 v[52:55], v[8:11], a[224:231], v3
  v_smfmac_f32_16x16x64_bf16 v[52:55], v[12:15], a[232:239], v3
  v_smfmac_f32_16x16x64_bf16 v[52:55], v[16:19], a[240:247], v3
  v_add_f32 v48, v48, v49
  v_smfmac_f32_16x16x64_bf16 v[52:55], v[20:23], a[248:255], v3
  v_add_f32 v50, v50, v51
  v_smfmac_f32_16x16x64_bf16 v[52:55], v[24:27], v[120:127], v3
  v_cvt_pk_bf16_f32 v48, v48, v50
  v_smfmac_f32_16x16x64_bf16 v[52:55], v[28:31], v[128:135], v3
  ds_write_b32 v103, v48
  v_smfmac_f32_16x16x64_bf16 v[52:55], v[32:35], v[136:143], v3
  v_smfmac_f32_16x16x64_bf16 v[56:59], v[8:11], v[144:151], v3
  v_smfmac_f32_16x16x64_bf16 v[56:59], v[12:15], v[152:159], v3
  v_smfmac_f32_16x16x64_bf16 v[56:59], v[16:19], v[160:167], v3
  v_add_f32 v52, v52, v53
  v_smfmac_f32_16x16x64_bf16 v[56:59], v[20:23], v[168:175], v3
  v_add_f32 v54, v54, v55
  v_smfmac_f32_16x16x64_bf16 v[56:59], v[24:27], v[176:183], v3
  v_cvt_pk_bf16_f32 v52, v52, v54
  v_smfmac_f32_16x16x64_bf16 v[56:59], v[28:31], v[184:191], v3
  ds_write_b32 v104, v52
  v_smfmac_f32_16x16x64_bf16 v[56:59], v[32:35], v[192:199], v3
  s_nop 7
  v_add_f32 v56, v56, v57
  v_add_f32 v58, v58, v59
  v_cvt_pk_bf16_f32 v56, v56, v58
  ds_write_b32 v105, v56
  s_waitcnt lgkmcnt(0)
  s_barrier
  s_cmp_eq_u32 s19, 62
  s_cbranch_scc1 cB_done
  s_waitcnt vmcnt(0) lgkmcnt(0)
  s_add_u32 s19, s19, 1
  s_mov_b32 s20, s21
  s_branch cB_va2_loop
cB_va2_retry:
  s_waitcnt lgkmcnt(0)
  buffer_load_dwordx4 v[8:11], v2, s[8:11], s20 offen offset:0 sc1
  buffer_load_dwordx4 v[12:15], v2, s[8:11], s20 offen offset:1024 sc1
  buffer_load_dwordx4 v[16:19], v2, s[8:11], s20 offen offset:2048 sc1
  buffer_load_dwordx4 v[20:23], v2, s[8:11], s20 offen offset:3072 sc1
  s_add_u32 s31, s31, 1
  s_add_u32 s30, s30, 1
  s_cmp_lt_u32 s30, 400000
  s_cbranch_scc1 cB_va2_ld
  s_branch cB_abort
cB_va2_last:
  s_waitcnt lgkmcnt(0)
  buffer_store_dwordx4 v[100:103], v2, s[8:11], s24 offen offset:0 sc1
  buffer_store_dwordx4 v[104:107], v2, s[8:11], s24 offen offset:1024 sc1
  buffer_store_dwordx4 v[108:111], v2, s[8:11], s24 offen offset:2048 sc1
  buffer_store_dwordx4 v[4:7], v2, s[8:11], s24 offen offset:3072 sc1
  s_add_u32 s24, s24, 8192
  s_waitcnt vmcnt(0)
  s_mov_b64 exec, 1
  buffer_store_dword v117, v2, s[8:11], s34 offen sc1
  s_mov_b64 exec, -1
  s_add_u32 s34, s34, 8
  s_mov_b64 exec, 1
  buffer_store_dword v117, v2, s[8:11], s34 offen sc1
  s_mov_b64 exec, -1
  s_add_u32 s34, s34, 8
  s_branch cB_done
.p2align 6

cB_va3_loop:
  s_add_u32 s23, s20, 4096
  s_add_u32 s21, s20, 20480
  v_mov_b32 v36, 0
  v_mov_b32 v37, 0
  v_mov_b32 v38, 0
  v_mov_b32 v39, 0
  v_mov_b32 v40, 0
  v_mov_b32 v41, 0
  v_mov_b32 v42, 0
  v_mov_b32 v43, 0
  v_mov_b32 v44, 0
  v_mov_b32 v45, 0
  v_mov_b32 v46, 0
  v_mov_b32 v47, 0
  v_mov_b32 v48, 0
  v_mov_b32 v49, 0
  v_mov_b32 v50, 0
  v_mov_b32 v51, 0
  v_mov_b32 v52, 0
  v_mov_b32 v53, 0
  v_mov_b32 v54, 0
  v_mov_b32 v55, 0
  v_mov_b32 v56, 0
  v_mov_b32 v57, 0
  v_mov_b32 v58, 0
  v_mov_b32 v59, 0
  v_mov_b32 v60, 0
  v_mov_b32 v61, 0
  v_mov_b32 v62, 0
  v_mov_b32 v63, 0
  v_mov_b32 v64, 0
  v_mov_b32 v65, 0
  v_mov_b32 v66, 0
  v_mov_b32 v67, 0
  s_mov_b32 s30, 0
  buffer_load_dword v76, v119, s[8:11], s20 offen sc1
  buffer_load_dword v77, v119, s[8:11], s20 offen sc1
  buffer_load_dword v78, v119, s[8:11], s20 offen sc1
cB_va3_fp_l:
  s_waitcnt vmcnt(2)
  v_cmp_eq_u32 vcc, -1, v76
  s_cbranch_vccz cB_va3_fp_d
  buffer_load_dword v76, v119, s[8:11], s20 offen sc1
  s_waitcnt vmcnt(2)
  v_cmp_eq_u32 vcc, -1, v77
  s_cbranch_vccz cB_va3_fp_d
  buffer_load_dword v77, v119, s[8:11], s20 offen sc1
  s_waitcnt vmcnt(2)
  v_cmp_eq_u32 vcc, -1, v78
  s_cbranch_vccz cB_va3_fp_d
  buffer_load_dword v78, v119, s[8:11], s20 offen sc1
  s_add_u32 s30, s30, 1
  s_cmp_lt_u32 s30, 400000
  s_cbranch_scc1 cB_va3_fp_l
  s_branch cB_abort
cB_va3_fp_d:
  buffer_load_dwordx4 v[24:27], v2, s[8:11], s23 offen offset:0 sc1
  buffer_load_dwordx4 v[28:31], v2, s[8:11], s23 offen offset:1024 sc1
  buffer_load_dwordx4 v[32:35], v2, s[8:11], s23 offen offset:2048 sc1
  s_barrier
cB_va3_ld:
  s_waitcnt vmcnt(0)
  v_max3_u32 v84, v24, v25, v26
  v_max3_u32 v84, v84, v27, v28
  v_max3_u32 v84, v84, v29, v30
  v_max3_u32 v84, v84, v31, v32
  v_max3_u32 v84, v84, v33, v34
  v_max_u32 v84, v84, v35
  v_cmp_eq_u32 vcc, -1, v84
  ds_write_b128 v2, v[24:27] offset:12288
  ds_write_b128 v2, v[28:31] offset:13312
  ds_write_b128 v2, v[32:35] offset:14336
  s_cbranch_vccnz cB_va3_retry
  s_waitcnt lgkmcnt(0)
  s_barrier
  ds_read_b128 v[8:11], v5 offset:8192
  ds_read_b128 v[12:15], v5 offset:9216
  ds_read_b128 v[16:19], v5 offset:10240
  ds_read_b128 v[20:23], v5 offset:11264
  ds_read_b128 v[24:27], v5 offset:12288
  ds_read_b128 v[28:31], v5 offset:13312
  ds_read_b128 v[32:35], v5 offset:14336
  s_waitcnt lgkmcnt(0)
  s_cmp_eq_u32 s19, 63
  s_cbranch_scc1 cB_done
  ds_read_b128 v[76:79], v1 offset:0
  ds_read_b128 v[80:83], v1 offset:1024
  ds_read_b128 v[84:87], v1 offset:2048
  ds_read_b128 v[88:91], v1 offset:3072
  ds_read_b128 v[92:95], v1 offset:4096
  ds_read_b128 v[96:99], v1 offset:5120
  v_smfmac_f32_16x16x64_bf16 v[60:63], v[8:11], v[200:207], v3
  v_smfmac_f32_16x16x64_bf16 v[60:63], v[12:15], v[208:215], v3
  s_waitcnt lgkmcnt(4)
  v_smfmac_f32_16x16x64_bf16 v[64:67], v[8:11], v[76:83], v3
  ds_read_b128 v[76:79], v1 offset:6144
  ds_read_b128 v[80:83], v1 offset:7168
  v_smfmac_f32_16x16x64_bf16 v[60:63], v[16:19], v[216:223], v3
  v_smfmac_f32_16x16x64_bf16 v[60:63], v[20:23], v[224:231], v3
  s_waitcnt lgkmcnt(4)
  v_smfmac_f32_16x16x64_bf16 v[64:67], v[12:15], v[84:91], v3
  ds_read_b128 v[84:87], v1 offset:8192
  ds_read_b128 v[88:91], v1 offset:9216
  v_smfmac_f32_16x16x64_bf16 v[60:63], v[24:27], v[232:239], v3
  v_smfmac_f32_16x16x64_bf16 v[60:63], v[28:31], v[240:247], v3
  s_waitcnt lgkmcnt(4)
  v_smfmac_f32_16x16x64_bf16 v[64:67], v[16:19], v[92:99], v3
  ds_read_b128 v[92:95], v1 offset:10240
  ds_read_b128 v[96:99], v1 offset:11264
  v_smfmac_f32_16x16x64_bf16 v[60:63], v[32:35], v[248:255], v3
  v_smfmac_f32_16x16x64_bf16 v[36:39], v[8:11], a[0:7], v3
  s_waitcnt lgkmcnt(4)
  v_smfmac_f32_16x16x64_bf16 v[64:67], v[20:23], v[76:83], v3
  ds_read_b128 v[76:79], v1 offset:12288
  ds_read_b128 v[80:83], v1 offset:13312
  v_smfmac_f32_16x16x64_bf16 v[36:39], v[12:15], a[8:15], v3
  v_add_f32 v60, v60, v61
  v_smfmac_f32_16x16x64_bf16 v[36:39], v[16:19], a[16:23], v3
  v_add_f32 v62, v62, v63
  s_waitcnt lgkmcnt(4)
  v_smfmac_f32_16x16x64_bf16 v[64:67], v[24:27], v[84:91], v3
  v_cvt_pk_bf16_f32 v60, v60, v62
  v_smfmac_f32_16x16x64_bf16 v[36:39], v[20:23], a[24:31], v3
  ds_write_b32 v106, v60
  v_smfmac_f32_16x16x64_bf16 v[36:39], v[24:27], a[32:39], v3
  s_waitcnt lgkmcnt(2)
  v_smfmac_f32_16x16x64_bf16 v[64:67], v[28:31], v[92:99], v3
  v_smfmac_f32_16x16x64_bf16 v[36:39], v[28:31], a[40:47], v3
  v_smfmac_f32_16x16x64_bf16 v[36:39], v[32:35], a[48:55], v3
  s_waitcnt lgkmcnt(0)
  v_smfmac_f32_16x16x64_bf16 v[64:67], v[32:35], v[76:83], v3
  v_smfmac_f32_16x16x64_bf16 v[40:43], v[8:11], a[56:63], v3
  v_smfmac_f32_16x16x64_bf16 v[40:43], v[12:15], a[64:71], v3
  v_add_f32 v36, v36, v37
  v_smfmac_f32_16x16x64_bf16 v[40:43], v[16:19], a[72:79], v3
  v_add_f32 v38, v38, v39
  v_smfmac_f32_16x16x64_bf16 v[40:43], v[20:23], a[80:87], v3
  v_cvt_pk_bf16_f32 v36, v36, v38
  v_smfmac_f32_16x16x64_bf16 v[40:43], v[24:27], a[88:95], v3
  ds_write_b32 v100, v36
  v_smfmac_f32_16x16x64_bf16 v[40:43], v[28:31], a[96:103], v3
  v_add_f32 v64, v64, v65
  v_smfmac_f32_16x16x64_bf16 v[40:43], v[32:35], a[104:111], v3
  v_add_f32 v66, v66, v67
  v_smfmac_f32_16x16x64_bf16 v[44:47], v[8:11], a[112:119], v3
  v_cvt_pk_bf16_f32 v64, v64, v66
  v_smfmac_f32_16x16x64_bf16 v[44:47], v[12:15], a[120:127], v3
  ds_write_b32 v107, v64
  v_smfmac_f32_16x16x64_bf16 v[44:47], v[16:19], a[128:135], v3
  v_add_f32 v40, v40, v41
  v_smfmac_f32_16x16x64_bf16 v[44:47], v[20:23], a[136:143], v3
  v_add_f32 v42, v42, v43
  v_smfmac_f32_16x16x64_bf16 v[44:47], v[24:27], a[144:151], v3
  v_cvt_pk_bf16_f32 v40, v40, v42
  v_smfmac_f32_16x16x64_bf16 v[44:47], v[28:31], a[152:159], v3
  ds_write_b32 v101, v40
  v_smfmac_f32_16x16x64_bf16 v[44:47], v[32:35], a[160:167], v3
  v_smfmac_f32_16x16x64_bf16 v[48:51], v[8:11], a[168:175], v3
  v_smfmac_f32_16x16x64_bf16 v[48:51], v[12:15], a[176:183], v3
  v_smfmac_f32_16x16x64_bf16 v[48:51], v[16:19], a[184:191], v3
  v_add_f32 v44, v44, v45
  v_smfmac_f32_16x16x64_bf16 v[48:51], v[20:23], a[192:199], v3
  v_add_f32 v46, v46, v47
  v_smfmac_f32_16x16x64_bf16 v[48:51], v[24:27], a[200:207], v3
  v_cvt_pk_bf16_f32 v44, v44, v46
  v_smfmac_f32_16x16x64_bf16 v[48:51], v[28:31], a[208:215], v3
  ds_write_b32 v102, v44
  v_smfmac_f32_16x16x64_bf16 v[48:51], v[32:35], a[216:223], v3
  v_smfmac_f32_16x16x64_bf16 v[52:55], v[8:11], a[224:231], v3
  v_smfmac_f32_16x16x64_bf16 v[52:55], v[12:15], a[232:239], v3
  v_smfmac_f32_16x16x64_bf16 v[52:55], v[16:19], a[240:247], v3
  v_add_f32 v48, v48, v49
  v_smfmac_f32_16x16x64_bf16 v[52:55], v[20:23], a[248:255], v3
  v_add_f32 v50, v50, v51
  v_smfmac_f32_16x16x64_bf16 v[52:55], v[24:27], v[120:127], v3
  v_cvt_pk_bf16_f32 v48, v48, v50
  v_smfmac_f32_16x16x64_bf16 v[52:55], v[28:31], v[128:135], v3
  ds_write_b32 v103, v48
  v_smfmac_f32_16x16x64_bf16 v[52:55], v[32:35], v[136:143], v3
  v_smfmac_f32_16x16x64_bf16 v[56:59], v[8:11], v[144:151], v3
  v_smfmac_f32_16x16x64_bf16 v[56:59], v[12:15], v[152:159], v3
  v_smfmac_f32_16x16x64_bf16 v[56:59], v[16:19], v[160:167], v3
  v_add_f32 v52, v52, v53
  v_smfmac_f32_16x16x64_bf16 v[56:59], v[20:23], v[168:175], v3
  v_add_f32 v54, v54, v55
  v_smfmac_f32_16x16x64_bf16 v[56:59], v[24:27], v[176:183], v3
  v_cvt_pk_bf16_f32 v52, v52, v54
  v_smfmac_f32_16x16x64_bf16 v[56:59], v[28:31], v[184:191], v3
  ds_write_b32 v104, v52
  v_smfmac_f32_16x16x64_bf16 v[56:59], v[32:35], v[192:199], v3
  s_nop 7
  v_add_f32 v56, v56, v57
  v_add_f32 v58, v58, v59
  v_cvt_pk_bf16_f32 v56, v56, v58
  ds_write_b32 v105, v56
  s_waitcnt lgkmcnt(0)
  s_barrier
  s_cmp_eq_u32 s19, 62
  s_cbranch_scc1 cB_done
  s_waitcnt vmcnt(0) lgkmcnt(0)
  s_add_u32 s19, s19, 1
  s_mov_b32 s20, s21
  s_branch cB_va3_loop
cB_va3_retry:
  s_waitcnt lgkmcnt(0)
  buffer_load_dwordx4 v[24:27], v2, s[8:11], s23 offen offset:0 sc1
  buffer_load_dwordx4 v[28:31], v2, s[8:11], s23 offen offset:1024 sc1
  buffer_load_dwordx4 v[32:35], v2, s[8:11], s23 offen offset:2048 sc1
  s_add_u32 s31, s31, 1
  s_add_u32 s30, s30, 1
  s_cmp_lt_u32 s30, 400000
  s_cbranch_scc1 cB_va3_ld
  s_branch cB_abort
cB_va3_last:
  s_waitcnt lgkmcnt(0)
  buffer_store_dwordx4 v[100:103], v2, s[8:11], s24 offen offset:0 sc1
  buffer_store_dwordx4 v[104:107], v2, s[8:11], s24 offen offset:1024 sc1
  buffer_store_dwordx4 v[108:111], v2, s[8:11], s24 offen offset:2048 sc1
  buffer_store_dwordx4 v[4:7], v2, s[8:11], s24 offen offset:3072 sc1
  s_add_u32 s24, s24, 8192
  s_waitcnt vmcnt(0)
  s_mov_b64 exec, 1
  buffer_store_dword v117, v2, s[8:11], s34 offen sc1
  s_mov_b64 exec, -1
  s_add_u32 s34, s34, 8
  s_mov_b64 exec, 1
  buffer_store_dword v117, v2, s[8:11], s34 offen sc1
  s_mov_b64 exec, -1
  s_add_u32 s34, s34, 8
  s_branch cB_done
cB_abort:
  v_mov_b32 v4, 0xdead
  v_mov_b32 v5, 16
  buffer_store_dword v4, v5, s[12:15], 0 offen
  s_branch ch_end
cB_done:
  s_branch ch_end
m_reclaim:
  s_waitcnt vmcnt(0)
  s_lshr_b32 s20, s3, 5
  s_cmp_lg_u32 s16, 0
  s_cbranch_scc1 w0_25
  s_mov_b32 s21, 0
  s_mov_b64 exec, 1
rc_l:
  s_cmp_lg_u32 s70, -1
  s_cbranch_scc1 rc_t
  s_add_u32 s20, s20, 1
  s_cmp_lt_u32 s20, 8
  s_cselect_b32 s20, s20, 0
  s_mov_b32 s70, 0
  s_mov_b32 s3, -1
  s_add_u32 s21, s21, 1
  s_cmp_ge_u32 s21, 9
  s_cbranch_scc1 rc_d
rc_t:
  s_ff0_i32_b32 s22, s70
  s_lshl_b32 s23, 1, s22
  s_and_b32 s71, s20, 4
  s_mul_i32 s71, s71, 12
  s_lshl_b32 s3, s20, 2
  s_add_u32 s3, s3, s71
  v_mov_b32 v242, s23
  v_mov_b32 v243, 32
  buffer_atomic_or v242, v243, s[12:15], s3 offen sc0
  s_waitcnt vmcnt(0)
  v_readfirstlane_b32 s70, v242
  s_lshl_b32 s3, s20, 5
  s_add_u32 s3, s3, s22
  s_bitcmp1_b32 s70, s22
  s_cbranch_scc1 rc_l
rc_d:
  s_mov_b64 exec, -1
  v_mov_b32 v242, s3
w0_25:
  v_mov_b32 v250, 160000
  s_add_u32 s101, s101, 1
  s_barrier
  s_mov_b64 exec, 1
  s_cmp_lg_u32 s16, 0
  s_cbranch_scc1 w0_26
  ds_write_b32 v250, v242 offset:0
  s_waitcnt lgkmcnt(0)
  v_mov_b32 v242, s101
  ds_write_b32 v250, v242 offset:16
  s_waitcnt lgkmcnt(0)
w0_26:
  s_mov_b64 exec, -1
  s_barrier
  ds_read_b32 v242, v250 offset:0
  ds_read_b32 v250, v250 offset:16
  s_waitcnt lgkmcnt(0)
  v_readfirstlane_b32 s3, v242
  v_cmp_ne_u32 vcc, s101, v250
  s_cbranch_vccnz ch_end
  s_cmp_lg_u32 s3, -1
  s_cbranch_scc1 m_start
  v_mov_b32 v250, 0
  s_branch wk_ask
m_bjob:
  v_and_b32 v1, 63, v0
  v_lshlrev_b32 v2, 4, v1
  v_lshrrev_b32 v3, 4, v1
  v_and_b32 v4, 15, v1
  s_sub_u32 s18, s3, 32
  s_mul_i32 s17, s18, 4682
  s_lshr_b32 s17, s17, 16
  s_mul_i32 s20, s17, 14
  s_sub_u32 s19, s18, s20
  s_cmp_ge_u32 s19, 7
  s_cselect_b32 s31, 7, 0
  s_sub_u32 s19, s19, s31
  s_mov_b32 s60, s44
  s_and_b32 s61, s45, 0xffff
  s_mov_b32 s62, 3670016
  s_mov_b32 s63, 0x20000
  s_mov_b32 s56, s46
  s_and_b32 s57, s47, 0xffff
  s_mov_b32 s58, 3670016
  s_mov_b32 s59, 0x20000
  s_lshl_b32 s30, s16, 13
  s_mul_i32 s27, s17, 229376
  s_lshl_b32 s29, s19, 7
  s_add_u32 s27, s27, s29
  v_lshrrev_b32 v7, 3, v1
  v_and_b32 v8, 7, v1
  v_and_b32 v9, 2, v7
  v_xor_b32 v8, v8, v9
  s_lshl_b32 s29, s16, 6
  v_add_u32 v7, s29, v7
  v_mul_u32_u24 v7, 896, v7
  v_lshl_add_u32 v7, v8, 4, v7
  v_xor_b32 v8, 64, v7
  s_add_u32 m0, s30, 0
  s_add_u32 s22, s27, 0
  buffer_load_dwordx4 v7, s[56:59], s22 offen offset:0 lds
  s_add_u32 s22, s27, 6144
  buffer_load_dwordx4 v8, s[56:59], s22 offen offset:1024 lds
  s_add_u32 s22, s27, 12288
  buffer_load_dwordx4 v7, s[56:59], s22 offen offset:2048 lds
  s_add_u32 s22, s27, 18432
  buffer_load_dwordx4 v8, s[56:59], s22 offen offset:3072 lds
  s_add_u32 m0, s30, 4096
  s_add_u32 s22, s27, 28672
  buffer_load_dwordx4 v7, s[56:59], s22 offen offset:0 lds
  s_add_u32 s22, s27, 34816
  buffer_load_dwordx4 v8, s[56:59], s22 offen offset:1024 lds
  s_add_u32 s22, s27, 40960
  buffer_load_dwordx4 v7, s[56:59], s22 offen offset:2048 lds
  s_add_u32 s22, s27, 47104
  buffer_load_dwordx4 v8, s[56:59], s22 offen offset:3072 lds
  v_lshrrev_b32 v5, 5, v1
  v_and_b32 v6, 31, v1
  s_lshl_b32 s25, s16, 15
  s_add_u32 s25, s25, 32768
  s_lshl_b32 s26, s17, 9
  s_add_u32 s28, s19, s16
  s_cmp_ge_u32 s28, 7
  s_cselect_b32 s20, 7, 0
  s_sub_u32 s28, s28, s20
  s_add_u32 s28, s28, s31
  s_add_u32 s29, s19, s16
  s_add_u32 s29, s29, 4
  s_cmp_ge_u32 s29, 7
  s_cselect_b32 s20, 7, 0
  s_sub_u32 s29, s29, s20
  s_add_u32 s29, s29, s31
  s_lshl_b32 s32, s28, 18
  s_add_u32 s32, s32, s26
  s_lshl_b32 s33, s29, 18
  s_add_u32 s33, s33, s26
  v_xor_b32 v8, v6, v5
  v_lshlrev_b32 v8, 4, v8
  v_lshl_add_u32 v8, v5, 13, v8
  v_xor_b32 v12, 0, v8
  v_xor_b32 v13, 32, v8
  v_add_u32 v13, 15360, v13
  v_xor_b32 v14, 0, v8
  v_add_u32 v14, 30720, v14
  v_xor_b32 v15, 32, v8
  v_add_u32 v15, 46080, v15
  s_add_u32 s20, s16, 0
  s_and_b32 s20, s20, 3
  s_mul_i32 s21, s20, 65600
  s_lshl_b32 s20, s20, 12
  s_add_u32 s48, s20, s25
  s_mov_b32 m0, s48
  v_xor_b32 v16, s21, v12
  buffer_load_dwordx4 v16, s[60:63], s32 offen offset:0 lds
  v_xor_b32 v17, s21, v13
  buffer_load_dwordx4 v17, s[60:63], s32 offen offset:1024 lds
  v_xor_b32 v18, s21, v14
  buffer_load_dwordx4 v18, s[60:63], s32 offen offset:2048 lds
  v_xor_b32 v19, s21, v15
  buffer_load_dwordx4 v19, s[60:63], s32 offen offset:3072 lds
  s_add_u32 s20, s16, 1
  s_and_b32 s20, s20, 3
  s_mul_i32 s21, s20, 65600
  s_lshl_b32 s20, s20, 12
  s_add_u32 s49, s20, s25
  s_mov_b32 m0, s49
  v_xor_b32 v20, s21, v12
  buffer_load_dwordx4 v20, s[60:63], s32 offen offset:0 lds
  v_xor_b32 v21, s21, v13
  buffer_load_dwordx4 v21, s[60:63], s32 offen offset:1024 lds
  v_xor_b32 v22, s21, v14
  buffer_load_dwordx4 v22, s[60:63], s32 offen offset:2048 lds
  v_xor_b32 v23, s21, v15
  buffer_load_dwordx4 v23, s[60:63], s32 offen offset:3072 lds
  s_add_u32 s20, s16, 2
  s_and_b32 s20, s20, 3
  s_mul_i32 s21, s20, 65600
  s_lshl_b32 s20, s20, 12
  s_add_u32 s50, s20, s25
  s_mov_b32 m0, s50
  v_xor_b32 v24, s21, v12
  buffer_load_dwordx4 v24, s[60:63], s32 offen offset:0 lds
  v_xor_b32 v25, s21, v13
  buffer_load_dwordx4 v25, s[60:63], s32 offen offset:1024 lds
  v_xor_b32 v26, s21, v14
  buffer_load_dwordx4 v26, s[60:63], s32 offen offset:2048 lds
  v_xor_b32 v27, s21, v15
  buffer_load_dwordx4 v27, s[60:63], s32 offen offset:3072 lds
  s_add_u32 s20, s16, 3
  s_and_b32 s20, s20, 3
  s_mul_i32 s21, s20, 65600
  s_lshl_b32 s20, s20, 12
  s_add_u32 s51, s20, s25
  s_mov_b32 m0, s51
  v_xor_b32 v28, s21, v12
  buffer_load_dwordx4 v28, s[60:63], s32 offen offset:0 lds
  v_xor_b32 v29, s21, v13
  buffer_load_dwordx4 v29, s[60:63], s32 offen offset:1024 lds
  v_xor_b32 v30, s21, v14
  buffer_load_dwordx4 v30, s[60:63], s32 offen offset:2048 lds
  v_xor_b32 v31, s21, v15
  buffer_load_dwordx4 v31, s[60:63], s32 offen offset:3072 lds
  s_cmp_lg_u32 s66, 0
  s_cbranch_scc1 bj_ci
  s_cmp_lg_u32 s16, 0
  s_cbranch_scc1 w0_27
  s_lshr_b32 s70, s3, 5
  s_and_b32 s71, s70, 4
  s_mul_i32 s71, s71, 12
  s_lshl_b32 s70, s70, 2
  s_add_u32 s70, s70, s71
  s_lshl_b32 s71, 1, s3
  v_mov_b32 v44, s71
  v_mov_b32 v45, 32
  s_mov_b64 exec, 1
  buffer_atomic_or v44, v45, s[12:15], s70 offen sc0
  buffer_load_dwordx2 v[46:47], v45, s[12:15], 0 offen offset:96 sc1
  s_mov_b64 exec, -1
w0_27:
bj_ci:
  s_lshl_b32 s30, s19, 6
  s_add_u32 s30, s30, 0
  s_cmp_lt_u32 s19, 4
  s_cselect_b32 s20, 0, 256
  s_sub_u32 s30, s30, s20
  v_add_u32 v8, s30, v4
  s_lshr_b32 s20, s20, 4
  s_cmp_lt_u32 s19, 4
  s_movk_i32 s21, 5462
  s_cselect_b32 s21, 4096, s21
  s_cselect_b32 s30, 16, 12
  v_mul_u32_u24 v10, s21, v8
  v_lshrrev_b32 v10, 16, v10
  v_mul_u32_u24 v11, s30, v10
  v_sub_u32 v32, v8, v11
  v_add_u32 v32, s20, v32
  s_lshl_b32 s30, s17, 4
  s_mul_i32 s20, s17, 12
  s_add_u32 s20, s20, 240
  s_cmp_lt_u32 s19, 4
  s_cselect_b32 s30, s30, s20
  v_add_u32 v32, s30, v32
  v_lshrrev_b32 v33, 4, v32
  v_and_b32 v32, 15, v32
  s_mov_b32 s30, 401408
  v_mul_lo_u32 v10, v10, s30
  v_mul_u32_u24 v33, 14336, v33
  v_add_u32 v10, v10, v33
  v_lshl_add_u32 v10, v3, 8, v10
  v_lshl_add_u32 v10, v32, 4, v10
  v_add_u32 v12, 6422528, v10
  s_lshl_b32 s30, s19, 6
  s_add_u32 s30, s30, 16
  s_cmp_lt_u32 s19, 4
  s_cselect_b32 s20, 0, 256
  s_sub_u32 s30, s30, s20
  v_add_u32 v8, s30, v4
  s_lshr_b32 s20, s20, 4
  s_cmp_lt_u32 s19, 4
  s_movk_i32 s21, 5462
  s_cselect_b32 s21, 4096, s21
  s_cselect_b32 s30, 16, 12
  v_mul_u32_u24 v10, s21, v8
  v_lshrrev_b32 v10, 16, v10
  v_mul_u32_u24 v11, s30, v10
  v_sub_u32 v32, v8, v11
  v_add_u32 v32, s20, v32
  s_lshl_b32 s30, s17, 4
  s_mul_i32 s20, s17, 12
  s_add_u32 s20, s20, 240
  s_cmp_lt_u32 s19, 4
  s_cselect_b32 s30, s30, s20
  v_add_u32 v32, s30, v32
  v_lshrrev_b32 v33, 4, v32
  v_and_b32 v32, 15, v32
  s_mov_b32 s30, 401408
  v_mul_lo_u32 v10, v10, s30
  v_mul_u32_u24 v33, 14336, v33
  v_add_u32 v10, v10, v33
  v_lshl_add_u32 v10, v3, 8, v10
  v_lshl_add_u32 v10, v32, 4, v10
  v_add_u32 v13, 6422528, v10
  s_lshl_b32 s30, s19, 6
  s_add_u32 s30, s30, 32
  s_cmp_lt_u32 s19, 4
  s_cselect_b32 s20, 0, 256
  s_sub_u32 s30, s30, s20
  v_add_u32 v8, s30, v4
  s_lshr_b32 s20, s20, 4
  s_cmp_lt_u32 s19, 4
  s_movk_i32 s21, 5462
  s_cselect_b32 s21, 4096, s21
  s_cselect_b32 s30, 16, 12
  v_mul_u32_u24 v10, s21, v8
  v_lshrrev_b32 v10, 16, v10
  v_mul_u32_u24 v11, s30, v10
  v_sub_u32 v32, v8, v11
  v_add_u32 v32, s20, v32
  s_lshl_b32 s30, s17, 4
  s_mul_i32 s20, s17, 12
  s_add_u32 s20, s20, 240
  s_cmp_lt_u32 s19, 4
  s_cselect_b32 s30, s30, s20
  v_add_u32 v32, s30, v32
  v_lshrrev_b32 v33, 4, v32
  v_and_b32 v32, 15, v32
  s_mov_b32 s30, 401408
  v_mul_lo_u32 v10, v10, s30
  v_mul_u32_u24 v33, 14336, v33
  v_add_u32 v10, v10, v33
  v_lshl_add_u32 v10, v3, 8, v10
  v_lshl_add_u32 v10, v32, 4, v10
  v_add_u32 v14, 6422528, v10
  s_lshl_b32 s30, s19, 6
  s_add_u32 s30, s30, 48
  s_cmp_lt_u32 s19, 4
  s_cselect_b32 s20, 0, 256
  s_sub_u32 s30, s30, s20
  v_add_u32 v8, s30, v4
  s_lshr_b32 s20, s20, 4
  s_cmp_lt_u32 s19, 4
  s_movk_i32 s21, 5462
  s_cselect_b32 s21, 4096, s21
  s_cselect_b32 s30, 16, 12
  v_mul_u32_u24 v10, s21, v8
  v_lshrrev_b32 v10, 16, v10
  v_mul_u32_u24 v11, s30, v10
  v_sub_u32 v32, v8, v11
  v_add_u32 v32, s20, v32
  s_lshl_b32 s30, s17, 4
  s_mul_i32 s20, s17, 12
  s_add_u32 s20, s20, 240
  s_cmp_lt_u32 s19, 4
  s_cselect_b32 s30, s30, s20
  v_add_u32 v32, s30, v32
  v_lshrrev_b32 v33, 4, v32
  v_and_b32 v32, 15, v32
  s_mov_b32 s30, 401408
  v_mul_lo_u32 v10, v10, s30
  v_mul_u32_u24 v33, 14336, v33
  v_add_u32 v10, v10, v33
  v_lshl_add_u32 v10, v3, 8, v10
  v_lshl_add_u32 v10, v32, 4, v10
  v_add_u32 v15, 6422528, v10
  v_lshrrev_b32 v7, 2, v4
  v_lshlrev_b32 v7, 3, v7
  v_and_b32 v8, 3, v4
  v_add_u32 v7, v7, v8
  v_xor_b32 v10, v3, v4
  v_lshlrev_b32 v10, 4, v10
  v_lshl_add_u32 v10, v7, 9, v10
  v_add_u32 v10, s25, v10
  v_xor_b32 v32, 0, v10
  v_xor_b32 v33, 64, v10
  v_xor_b32 v34, 128, v10
  v_xor_b32 v35, 192, v10
  v_lshrrev_b32 v7, 2, v4
  v_lshl_add_u32 v7, v3, 3, v7
  v_lshlrev_b32 v7, 7, v7
  v_and_b32 v8, 3, v4
  v_lshl_add_u32 v7, v8, 3, v7
  v_lshrrev_b32 v8, 3, v4
  v_lshl_add_u32 v7, v8, 5, v7
  v_and_b32 v8, 1, v3
  v_lshl_add_u32 v7, v8, 6, v7
  s_waitcnt vmcnt(16)
  s_barrier
  s_cmp_eq_u32 s16, 3
  s_cbranch_scc1 bj_np0
  s_add_u32 m0, s48, 16384
  s_nop 0
  buffer_load_dwordx4 v16, s[60:63], s33 offen offset:0 lds
  buffer_load_dwordx4 v17, s[60:63], s33 offen offset:1024 lds
  buffer_load_dwordx4 v18, s[60:63], s33 offen offset:2048 lds
  buffer_load_dwordx4 v19, s[60:63], s33 offen offset:3072 lds
bj_np0:
  v_xor_b32 v9, 0, v7
  ds_read_b64_tr_b16 v[128:129], v9 offset:0
  ds_read_b64_tr_b16 v[130:131], v9 offset:512
  ds_read_b64_tr_b16 v[132:133], v9 offset:4096
  ds_read_b64_tr_b16 v[134:135], v9 offset:4608
  ds_read_b64_tr_b16 v[136:137], v9 offset:8192
  ds_read_b64_tr_b16 v[138:139], v9 offset:8704
  ds_read_b64_tr_b16 v[140:141], v9 offset:12288
  ds_read_b64_tr_b16 v[142:143], v9 offset:12800
  s_waitcnt lgkmcnt(6)
  ds_read_b64_tr_b16 v[144:145], v9 offset:16384
  ds_read_b64_tr_b16 v[146:147], v9 offset:16896
  ds_read_b64_tr_b16 v[148:149], v9 offset:20480
  ds_read_b64_tr_b16 v[150:151], v9 offset:20992
  ds_read_b64_tr_b16 v[152:153], v9 offset:24576
  ds_read_b64_tr_b16 v[154:155], v9 offset:25088
  ds_read_b64_tr_b16 v[156:157], v9 offset:28672
  ds_read_b64_tr_b16 v[158:159], v9 offset:29184
  s_waitcnt lgkmcnt(6)
  s_cmp_eq_u32 s16, 3
  s_cbranch_scc1 bj_np1
  s_add_u32 m0, s49, 16384
  s_nop 0
  buffer_load_dwordx4 v20, s[60:63], s33 offen offset:0 lds
  buffer_load_dwordx4 v21, s[60:63], s33 offen offset:1024 lds
  buffer_load_dwordx4 v22, s[60:63], s33 offen offset:2048 lds
  buffer_load_dwordx4 v23, s[60:63], s33 offen offset:3072 lds
bj_np1:
  v_xor_b32 v9, 32, v7
  ds_read_b64_tr_b16 v[160:161], v9 offset:0
  ds_read_b64_tr_b16 v[162:163], v9 offset:512
  ds_read_b64_tr_b16 v[164:165], v9 offset:4096
  ds_read_b64_tr_b16 v[166:167], v9 offset:4608
  ds_read_b64_tr_b16 v[168:169], v9 offset:8192
  ds_read_b64_tr_b16 v[170:171], v9 offset:8704
  ds_read_b64_tr_b16 v[172:173], v9 offset:12288
  ds_read_b64_tr_b16 v[174:175], v9 offset:12800
  s_waitcnt lgkmcnt(6)
  ds_read_b64_tr_b16 v[176:177], v9 offset:16384
  ds_read_b64_tr_b16 v[178:179], v9 offset:16896
  ds_read_b64_tr_b16 v[180:181], v9 offset:20480
  ds_read_b64_tr_b16 v[182:183], v9 offset:20992
  ds_read_b64_tr_b16 v[184:185], v9 offset:24576
  ds_read_b64_tr_b16 v[186:187], v9 offset:25088
  ds_read_b64_tr_b16 v[188:189], v9 offset:28672
  ds_read_b64_tr_b16 v[190:191], v9 offset:29184
  s_waitcnt lgkmcnt(6)
  s_cmp_eq_u32 s16, 3
  s_cbranch_scc1 bj_np2
  s_add_u32 m0, s50, 16384
  s_nop 0
  buffer_load_dwordx4 v24, s[60:63], s33 offen offset:0 lds
  buffer_load_dwordx4 v25, s[60:63], s33 offen offset:1024 lds
  buffer_load_dwordx4 v26, s[60:63], s33 offen offset:2048 lds
  buffer_load_dwordx4 v27, s[60:63], s33 offen offset:3072 lds
bj_np2:
  v_xor_b32 v9, 64, v7
  ds_read_b64_tr_b16 v[192:193], v9 offset:0
  ds_read_b64_tr_b16 v[194:195], v9 offset:512
  ds_read_b64_tr_b16 v[196:197], v9 offset:4096
  ds_read_b64_tr_b16 v[198:199], v9 offset:4608
  ds_read_b64_tr_b16 v[200:201], v9 offset:8192
  ds_read_b64_tr_b16 v[202:203], v9 offset:8704
  ds_read_b64_tr_b16 v[204:205], v9 offset:12288
  ds_read_b64_tr_b16 v[206:207], v9 offset:12800
  s_waitcnt lgkmcnt(6)
  ds_read_b64_tr_b16 v[208:209], v9 offset:16384
  ds_read_b64_tr_b16 v[210:211], v9 offset:16896
  ds_read_b64_tr_b16 v[212:213], v9 offset:20480
  ds_read_b64_tr_b16 v[214:215], v9 offset:20992
  ds_read_b64_tr_b16 v[216:217], v9 offset:24576
  ds_read_b64_tr_b16 v[218:219], v9 offset:25088
  ds_read_b64_tr_b16 v[220:221], v9 offset:28672
  ds_read_b64_tr_b16 v[222:223], v9 offset:29184
  s_waitcnt lgkmcnt(6)
  s_cmp_eq_u32 s16, 3
  s_cbranch_scc1 bj_np3
  s_add_u32 m0, s51, 16384
  s_nop 0
  buffer_load_dwordx4 v28, s[60:63], s33 offen offset:0 lds
  buffer_load_dwordx4 v29, s[60:63], s33 offen offset:1024 lds
  buffer_load_dwordx4 v30, s[60:63], s33 offen offset:2048 lds
  buffer_load_dwordx4 v31, s[60:63], s33 offen offset:3072 lds
bj_np3:
  v_xor_b32 v9, 96, v7
  ds_read_b64_tr_b16 v[224:225], v9 offset:0
  ds_read_b64_tr_b16 v[226:227], v9 offset:512
  ds_read_b64_tr_b16 v[228:229], v9 offset:4096
  ds_read_b64_tr_b16 v[230:231], v9 offset:4608
  ds_read_b64_tr_b16 v[232:233], v9 offset:8192
  ds_read_b64_tr_b16 v[234:235], v9 offset:8704
  ds_read_b64_tr_b16 v[236:237], v9 offset:12288
  ds_read_b64_tr_b16 v[238:239], v9 offset:12800
  s_waitcnt lgkmcnt(6)
  ds_read_b64_tr_b16 v[240:241], v9 offset:16384
  ds_read_b64_tr_b16 v[242:243], v9 offset:16896
  ds_read_b64_tr_b16 v[244:245], v9 offset:20480
  ds_read_b64_tr_b16 v[246:247], v9 offset:20992
  ds_read_b64_tr_b16 v[248:249], v9 offset:24576
  ds_read_b64_tr_b16 v[250:251], v9 offset:25088
  ds_read_b64_tr_b16 v[252:253], v9 offset:28672
  ds_read_b64_tr_b16 v[254:255], v9 offset:29184
  s_waitcnt lgkmcnt(6)
  s_mov_b32 s52, s36
  s_and_b32 s53, s37, 0xffff
  s_mov_b32 s54, 1835008
  s_mov_b32 s55, 0x20000
  s_lshl_b32 s20, s18, 8
  v_add_u32 v95, s20, v0
  s_mov_b32 s21, 9586981
  v_mul_hi_u32 v6, v95, s21
  v_mul_u32_u24 v7, 448, v6
  v_sub_u32 v7, v95, v7
  v_lshrrev_b32 v8, 4, v7
  v_and_b32 v7, 15, v7
  v_lshl_add_u32 v9, v6, 4, v7
  v_mul_u32_u24 v9, 896, v9
  v_lshl_add_u32 v9, v8, 5, v9
  buffer_load_dwordx4 v[84:87], v9, s[52:55], 0 offen
  buffer_load_dwordx4 v[88:91], v9, s[52:55], 0 offen offset:16
  v_mul_u32_u24 v6, 14336, v6
  v_lshl_add_u32 v6, v7, 4, v6
  v_lshl_add_u32 v92, v8, 9, v6
  v_lshrrev_b32 v7, 2, v8
  v_lshl_add_u32 v6, v7, 11, v6
  v_and_b32 v7, 3, v8
  v_lshl_add_u32 v93, v7, 8, v6
  s_mov_b32 s72, s38
  s_and_b32 s73, s39, 0xffff
  s_mov_b32 s74, 7168
  s_mov_b32 s75, 0x20000
  v_min_u32 v6, 223, v0
  v_lshrrev_b32 v7, 3, v6
  v_and_b32 v6, 7, v6
  v_mul_u32_u24 v9, 896, v6
  v_lshl_add_u32 v9, v7, 5, v9
  buffer_load_dwordx4 v[36:39], v9, s[72:75], 0 offen
  buffer_load_dwordx4 v[40:43], v9, s[72:75], 0 offen offset:16
  v_lshlrev_b32 v7, 8, v7
  v_lshl_add_u32 v94, v6, 4, v7
  s_lshl_b32 s26, s17, 9
  s_waitcnt vmcnt(20) lgkmcnt(0)
  s_cmp_lg_u32 s16, 3
  s_cbranch_scc1 w3_28
  s_waitcnt vmcnt(4)
w3_28:
  ds_read_b128 v[52:55], v32 offset:0
  ds_read_b128 v[56:59], v33 offset:0
  ds_read_b128 v[60:63], v34 offset:0
  ds_read_b128 v[64:67], v35 offset:0
  s_waitcnt lgkmcnt(3)
  v_mfma_f32_16x16x32_bf16 v[96:99], v[52:55], v[128:131], 0
  v_mfma_f32_16x16x32_bf16 v[100:103], v[52:55], v[160:163], 0
  v_mfma_f32_16x16x32_bf16 v[104:107], v[52:55], v[192:195], 0
  v_mfma_f32_16x16x32_bf16 v[108:111], v[52:55], v[224:227], 0
  ds_read_b128 v[52:55], v32 offset:256
  s_waitcnt lgkmcnt(3)
  v_mfma_f32_16x16x32_bf16 v[96:99], v[56:59], v[132:135], v[96:99]
  v_mfma_f32_16x16x32_bf16 v[100:103], v[56:59], v[164:167], v[100:103]
  v_mfma_f32_16x16x32_bf16 v[104:107], v[56:59], v[196:199], v[104:107]
  v_mfma_f32_16x16x32_bf16 v[108:111], v[56:59], v[228:231], v[108:111]
  ds_read_b128 v[56:59], v33 offset:256
  s_waitcnt lgkmcnt(3)
  v_mfma_f32_16x16x32_bf16 v[96:99], v[60:63], v[136:139], v[96:99]
  v_mfma_f32_16x16x32_bf16 v[100:103], v[60:63], v[168:171], v[100:103]
  v_mfma_f32_16x16x32_bf16 v[104:107], v[60:63], v[200:203], v[104:107]
  v_mfma_f32_16x16x32_bf16 v[108:111], v[60:63], v[232:235], v[108:111]
  ds_read_b128 v[60:63], v34 offset:256
  s_waitcnt lgkmcnt(3)
  v_mfma_f32_16x16x32_bf16 v[96:99], v[64:67], v[140:143], v[96:99]
  v_mfma_f32_16x16x32_bf16 v[100:103], v[64:67], v[172:175], v[100:103]
  v_mfma_f32_16x16x32_bf16 v[104:107], v[64:67], v[204:207], v[104:107]
  v_mfma_f32_16x16x32_bf16 v[108:111], v[64:67], v[236:239], v[108:111]
  ds_read_b128 v[64:67], v35 offset:256
  s_waitcnt lgkmcnt(3)
  v_mfma_f32_16x16x32_bf16 v[96:99], v[52:55], v[144:147], v[96:99]
  v_mfma_f32_16x16x32_bf16 v[100:103], v[52:55], v[176:179], v[100:103]
  v_mfma_f32_16x16x32_bf16 v[104:107], v[52:55], v[208:211], v[104:107]
  v_mfma_f32_16x16x32_bf16 v[108:111], v[52:55], v[240:243], v[108:111]
  ds_read_b128 v[52:55], v32 offset:2048
  s_waitcnt lgkmcnt(3)
  v_mfma_f32_16x16x32_bf16 v[96:99], v[56:59], v[148:151], v[96:99]
  v_mfma_f32_16x16x32_bf16 v[100:103], v[56:59], v[180:183], v[100:103]
  v_mfma_f32_16x16x32_bf16 v[104:107], v[56:59], v[212:215], v[104:107]
  v_mfma_f32_16x16x32_bf16 v[108:111], v[56:59], v[244:247], v[108:111]
  ds_read_b128 v[56:59], v33 offset:2048
  s_waitcnt lgkmcnt(3)
  v_mfma_f32_16x16x32_bf16 v[96:99], v[60:63], v[152:155], v[96:99]
  v_mfma_f32_16x16x32_bf16 v[100:103], v[60:63], v[184:187], v[100:103]
  v_mfma_f32_16x16x32_bf16 v[104:107], v[60:63], v[216:219], v[104:107]
  v_mfma_f32_16x16x32_bf16 v[108:111], v[60:63], v[248:251], v[108:111]
  ds_read_b128 v[60:63], v34 offset:2048
  s_waitcnt lgkmcnt(3)
  v_mfma_f32_16x16x32_bf16 v[96:99], v[64:67], v[156:159], v[96:99]
  v_mfma_f32_16x16x32_bf16 v[100:103], v[64:67], v[188:191], v[100:103]
  v_mfma_f32_16x16x32_bf16 v[104:107], v[64:67], v[220:223], v[104:107]
  v_mfma_f32_16x16x32_bf16 v[108:111], v[64:67], v[252:255], v[108:111]
  ds_read_b128 v[64:67], v35 offset:2048
  s_waitcnt lgkmcnt(3)
  v_mfma_f32_16x16x32_bf16 v[112:115], v[52:55], v[128:131], 0
  v_mfma_f32_16x16x32_bf16 v[116:119], v[52:55], v[160:163], 0
  v_mfma_f32_16x16x32_bf16 v[120:123], v[52:55], v[192:195], 0
  v_mfma_f32_16x16x32_bf16 v[124:127], v[52:55], v[224:227], 0
  ds_read_b128 v[52:55], v32 offset:2304
  s_waitcnt lgkmcnt(3)
  v_mfma_f32_16x16x32_bf16 v[112:115], v[56:59], v[132:135], v[112:115]
  v_mfma_f32_16x16x32_bf16 v[116:119], v[56:59], v[164:167], v[116:119]
  v_mfma_f32_16x16x32_bf16 v[120:123], v[56:59], v[196:199], v[120:123]
  v_mfma_f32_16x16x32_bf16 v[124:127], v[56:59], v[228:231], v[124:127]
  ds_read_b128 v[56:59], v33 offset:2304
  s_waitcnt lgkmcnt(3)
  v_mfma_f32_16x16x32_bf16 v[112:115], v[60:63], v[136:139], v[112:115]
  v_mfma_f32_16x16x32_bf16 v[116:119], v[60:63], v[168:171], v[116:119]
  v_mfma_f32_16x16x32_bf16 v[120:123], v[60:63], v[200:203], v[120:123]
  v_mfma_f32_16x16x32_bf16 v[124:127], v[60:63], v[232:235], v[124:127]
  ds_read_b128 v[60:63], v34 offset:2304
  s_waitcnt lgkmcnt(3)
  v_mfma_f32_16x16x32_bf16 v[112:115], v[64:67], v[140:143], v[112:115]
  v_mfma_f32_16x16x32_bf16 v[116:119], v[64:67], v[172:175], v[116:119]
  v_mfma_f32_16x16x32_bf16 v[120:123], v[64:67], v[204:207], v[120:123]
  v_mfma_f32_16x16x32_bf16 v[124:127], v[64:67], v[236:239], v[124:127]
  ds_read_b128 v[64:67], v35 offset:2304
  s_waitcnt lgkmcnt(3)
  v_mfma_f32_16x16x32_bf16 v[112:115], v[52:55], v[144:147], v[112:115]
  v_mfma_f32_16x16x32_bf16 v[116:119], v[52:55], v[176:179], v[116:119]
  v_mfma_f32_16x16x32_bf16 v[120:123], v[52:55], v[208:211], v[120:123]
  v_mfma_f32_16x16x32_bf16 v[124:127], v[52:55], v[240:243], v[124:127]
  s_waitcnt lgkmcnt(2)
  v_mfma_f32_16x16x32_bf16 v[112:115], v[56:59], v[148:151], v[112:115]
  v_mfma_f32_16x16x32_bf16 v[116:119], v[56:59], v[180:183], v[116:119]
  v_mfma_f32_16x16x32_bf16 v[120:123], v[56:59], v[212:215], v[120:123]
  v_mfma_f32_16x16x32_bf16 v[124:127], v[56:59], v[244:247], v[124:127]
  s_waitcnt lgkmcnt(1)
  v_mfma_f32_16x16x32_bf16 v[112:115], v[60:63], v[152:155], v[112:115]
  v_mfma_f32_16x16x32_bf16 v[116:119], v[60:63], v[184:187], v[116:119]
  v_mfma_f32_16x16x32_bf16 v[120:123], v[60:63], v[216:219], v[120:123]
  v_mfma_f32_16x16x32_bf16 v[124:127], v[60:63], v[248:251], v[124:127]
  s_waitcnt lgkmcnt(0)
  v_mfma_f32_16x16x32_bf16 v[112:115], v[64:67], v[156:159], v[112:115]
  v_mfma_f32_16x16x32_bf16 v[116:119], v[64:67], v[188:191], v[116:119]
  v_mfma_f32_16x16x32_bf16 v[120:123], v[64:67], v[220:223], v[120:123]
  v_mfma_f32_16x16x32_bf16 v[124:127], v[64:67], v[252:255], v[124:127]
  s_lshl_b32 s30, s28, 10
  v_cvt_pk_bf16_f32 v68, v96, v97
  v_cvt_pk_bf16_f32 v69, v98, v99
  v_cvt_pk_bf16_f32 v70, v112, v113
  v_cvt_pk_bf16_f32 v71, v114, v115
  buffer_store_dwordx4 v[68:71], v12, s[8:11], s30 offen sc1
  v_cvt_pk_bf16_f32 v72, v100, v101
  v_cvt_pk_bf16_f32 v73, v102, v103
  v_cvt_pk_bf16_f32 v74, v116, v117
  v_cvt_pk_bf16_f32 v75, v118, v119
  buffer_store_dwordx4 v[72:75], v13, s[8:11], s30 offen sc1
  v_cvt_pk_bf16_f32 v76, v104, v105
  v_cvt_pk_bf16_f32 v77, v106, v107
  v_cvt_pk_bf16_f32 v78, v120, v121
  v_cvt_pk_bf16_f32 v79, v122, v123
  buffer_store_dwordx4 v[76:79], v14, s[8:11], s30 offen sc1
  v_cvt_pk_bf16_f32 v80, v108, v109
  v_cvt_pk_bf16_f32 v81, v110, v111
  v_cvt_pk_bf16_f32 v82, v124, v125
  v_cvt_pk_bf16_f32 v83, v126, v127
  buffer_store_dwordx4 v[80:83], v15, s[8:11], s30 offen sc1
  s_cmp_eq_u32 s16, 3
  s_cbranch_scc1 bj_w3
  s_waitcnt vmcnt(8)
  ds_read_b128 v[52:55], v32 offset:16384
  ds_read_b128 v[56:59], v33 offset:16384
  ds_read_b128 v[60:63], v34 offset:16384
  ds_read_b128 v[64:67], v35 offset:16384
  s_waitcnt lgkmcnt(3)
  v_mfma_f32_16x16x32_bf16 v[96:99], v[52:55], v[128:131], 0
  v_mfma_f32_16x16x32_bf16 v[100:103], v[52:55], v[160:163], 0
  v_mfma_f32_16x16x32_bf16 v[104:107], v[52:55], v[192:195], 0
  v_mfma_f32_16x16x32_bf16 v[108:111], v[52:55], v[224:227], 0
  ds_read_b128 v[52:55], v32 offset:16640
  s_waitcnt lgkmcnt(3)
  v_mfma_f32_16x16x32_bf16 v[96:99], v[56:59], v[132:135], v[96:99]
  v_mfma_f32_16x16x32_bf16 v[100:103], v[56:59], v[164:167], v[100:103]
  v_mfma_f32_16x16x32_bf16 v[104:107], v[56:59], v[196:199], v[104:107]
  v_mfma_f32_16x16x32_bf16 v[108:111], v[56:59], v[228:231], v[108:111]
  ds_read_b128 v[56:59], v33 offset:16640
  s_waitcnt lgkmcnt(3)
  v_mfma_f32_16x16x32_bf16 v[96:99], v[60:63], v[136:139], v[96:99]
  v_mfma_f32_16x16x32_bf16 v[100:103], v[60:63], v[168:171], v[100:103]
  v_mfma_f32_16x16x32_bf16 v[104:107], v[60:63], v[200:203], v[104:107]
  v_mfma_f32_16x16x32_bf16 v[108:111], v[60:63], v[232:235], v[108:111]
  ds_read_b128 v[60:63], v34 offset:16640
  s_waitcnt lgkmcnt(3)
  v_mfma_f32_16x16x32_bf16 v[96:99], v[64:67], v[140:143], v[96:99]
  v_mfma_f32_16x16x32_bf16 v[100:103], v[64:67], v[172:175], v[100:103]
  v_mfma_f32_16x16x32_bf16 v[104:107], v[64:67], v[204:207], v[104:107]
  v_mfma_f32_16x16x32_bf16 v[108:111], v[64:67], v[236:239], v[108:111]
  ds_read_b128 v[64:67], v35 offset:16640
  s_waitcnt lgkmcnt(3)
  v_mfma_f32_16x16x32_bf16 v[96:99], v[52:55], v[144:147], v[96:99]
  v_mfma_f32_16x16x32_bf16 v[100:103], v[52:55], v[176:179], v[100:103]
  v_mfma_f32_16x16x32_bf16 v[104:107], v[52:55], v[208:211], v[104:107]
  v_mfma_f32_16x16x32_bf16 v[108:111], v[52:55], v[240:243], v[108:111]
  ds_read_b128 v[52:55], v32 offset:18432
  s_waitcnt lgkmcnt(3)
  v_mfma_f32_16x16x32_bf16 v[96:99], v[56:59], v[148:151], v[96:99]
  v_mfma_f32_16x16x32_bf16 v[100:103], v[56:59], v[180:183], v[100:103]
  v_mfma_f32_16x16x32_bf16 v[104:107], v[56:59], v[212:215], v[104:107]
  v_mfma_f32_16x16x32_bf16 v[108:111], v[56:59], v[244:247], v[108:111]
  ds_read_b128 v[56:59], v33 offset:18432
  s_waitcnt lgkmcnt(3)
  v_mfma_f32_16x16x32_bf16 v[96:99], v[60:63], v[152:155], v[96:99]
  v_mfma_f32_16x16x32_bf16 v[100:103], v[60:63], v[184:187], v[100:103]
  v_mfma_f32_16x16x32_bf16 v[104:107], v[60:63], v[216:219], v[104:107]
  v_mfma_f32_16x16x32_bf16 v[108:111], v[60:63], v[248:251], v[108:111]
  ds_read_b128 v[60:63], v34 offset:18432
  s_waitcnt lgkmcnt(3)
  v_mfma_f32_16x16x32_bf16 v[96:99], v[64:67], v[156:159], v[96:99]
  v_mfma_f32_16x16x32_bf16 v[100:103], v[64:67], v[188:191], v[100:103]
  v_mfma_f32_16x16x32_bf16 v[104:107], v[64:67], v[220:223], v[104:107]
  v_mfma_f32_16x16x32_bf16 v[108:111], v[64:67], v[252:255], v[108:111]
  ds_read_b128 v[64:67], v35 offset:18432
  s_waitcnt lgkmcnt(3)
  v_mfma_f32_16x16x32_bf16 v[112:115], v[52:55], v[128:131], 0
  v_mfma_f32_16x16x32_bf16 v[116:119], v[52:55], v[160:163], 0
  v_mfma_f32_16x16x32_bf16 v[120:123], v[52:55], v[192:195], 0
  v_mfma_f32_16x16x32_bf16 v[124:127], v[52:55], v[224:227], 0
  ds_read_b128 v[52:55], v32 offset:18688
  s_waitcnt lgkmcnt(3)
  v_mfma_f32_16x16x32_bf16 v[112:115], v[56:59], v[132:135], v[112:115]
  v_mfma_f32_16x16x32_bf16 v[116:119], v[56:59], v[164:167], v[116:119]
  v_mfma_f32_16x16x32_bf16 v[120:123], v[56:59], v[196:199], v[120:123]
  v_mfma_f32_16x16x32_bf16 v[124:127], v[56:59], v[228:231], v[124:127]
  ds_read_b128 v[56:59], v33 offset:18688
  s_waitcnt lgkmcnt(3)
  v_mfma_f32_16x16x32_bf16 v[112:115], v[60:63], v[136:139], v[112:115]
  v_mfma_f32_16x16x32_bf16 v[116:119], v[60:63], v[168:171], v[116:119]
  v_mfma_f32_16x16x32_bf16 v[120:123], v[60:63], v[200:203], v[120:123]
  v_mfma_f32_16x16x32_bf16 v[124:127], v[60:63], v[232:235], v[124:127]
  ds_read_b128 v[60:63], v34 offset:18688
  s_waitcnt lgkmcnt(3)
  v_mfma_f32_16x16x32_bf16 v[112:115], v[64:67], v[140:143], v[112:115]
  v_mfma_f32_16x16x32_bf16 v[116:119], v[64:67], v[172:175], v[116:119]
  v_mfma_f32_16x16x32_bf16 v[120:123], v[64:67], v[204:207], v[120:123]
  v_mfma_f32_16x16x32_bf16 v[124:127], v[64:67], v[236:239], v[124:127]
  ds_read_b128 v[64:67], v35 offset:18688
  s_waitcnt lgkmcnt(3)
  v_mfma_f32_16x16x32_bf16 v[112:115], v[52:55], v[144:147], v[112:115]
  v_mfma_f32_16x16x32_bf16 v[116:119], v[52:55], v[176:179], v[116:119]
  v_mfma_f32_16x16x32_bf16 v[120:123], v[52:55], v[208:211], v[120:123]
  v_mfma_f32_16x16x32_bf16 v[124:127], v[52:55], v[240:243], v[124:127]
  s_waitcnt lgkmcnt(2)
  v_mfma_f32_16x16x32_bf16 v[112:115], v[56:59], v[148:151], v[112:115]
  v_mfma_f32_16x16x32_bf16 v[116:119], v[56:59], v[180:183], v[116:119]
  v_mfma_f32_16x16x32_bf16 v[120:123], v[56:59], v[212:215], v[120:123]
  v_mfma_f32_16x16x32_bf16 v[124:127], v[56:59], v[244:247], v[124:127]
  s_waitcnt lgkmcnt(1)
  v_mfma_f32_16x16x32_bf16 v[112:115], v[60:63], v[152:155], v[112:115]
  v_mfma_f32_16x16x32_bf16 v[116:119], v[60:63], v[184:187], v[116:119]
  v_mfma_f32_16x16x32_bf16 v[120:123], v[60:63], v[216:219], v[120:123]
  v_mfma_f32_16x16x32_bf16 v[124:127], v[60:63], v[248:251], v[124:127]
  s_waitcnt lgkmcnt(0)
  v_mfma_f32_16x16x32_bf16 v[112:115], v[64:67], v[156:159], v[112:115]
  v_mfma_f32_16x16x32_bf16 v[116:119], v[64:67], v[188:191], v[116:119]
  v_mfma_f32_16x16x32_bf16 v[120:123], v[64:67], v[220:223], v[120:123]
  v_mfma_f32_16x16x32_bf16 v[124:127], v[64:67], v[252:255], v[124:127]
  s_lshl_b32 s30, s29, 10
  v_cvt_pk_bf16_f32 v68, v96, v97
  v_cvt_pk_bf16_f32 v69, v98, v99
  v_cvt_pk_bf16_f32 v70, v112, v113
  v_cvt_pk_bf16_f32 v71, v114, v115
  buffer_store_dwordx4 v[68:71], v12, s[8:11], s30 offen sc1
  v_cvt_pk_bf16_f32 v72, v100, v101
  v_cvt_pk_bf16_f32 v73, v102, v103
  v_cvt_pk_bf16_f32 v74, v116, v117
  v_cvt_pk_bf16_f32 v75, v118, v119
  buffer_store_dwordx4 v[72:75], v13, s[8:11], s30 offen sc1
  v_cvt_pk_bf16_f32 v76, v104, v105
  v_cvt_pk_bf16_f32 v77, v106, v107
  v_cvt_pk_bf16_f32 v78, v120, v121
  v_cvt_pk_bf16_f32 v79, v122, v123
  buffer_store_dwordx4 v[76:79], v14, s[8:11], s30 offen sc1
  v_cvt_pk_bf16_f32 v80, v108, v109
  v_cvt_pk_bf16_f32 v81, v110, v111
  v_cvt_pk_bf16_f32 v82, v124, v125
  v_cvt_pk_bf16_f32 v83, v126, v127
  buffer_store_dwordx4 v[80:83], v15, s[8:11], s30 offen sc1
bj_w3:
  s_lshl_b32 s77, s19, 8
  s_lshl_b32 s21, s17, 4
  s_add_u32 s77, s77, s21
  s_cmp_lg_u32 s31, 0
  s_cselect_b32 s21, 8, 0
  s_add_u32 s77, s77, s21
  s_add_u32 s77, s77, 88604672
  s_add_u32 s78, s77, 2048
  s_cmp_lg_u32 s66, 0
  s_cbranch_scc1 bj_cf
  s_cmp_lg_u32 s16, 0
  s_cbranch_scc1 w0_29
  s_waitcnt vmcnt(8)
  v_readfirstlane_b32 s70, v46
  s_cmp_lg_u32 s70, 0
  s_cbranch_scc1 bj_nz
  v_mov_b32 v45, 128
  v_mov_b32 v46, s88
  v_mov_b32 v47, s89
  v_mov_b32 v48, 0
  v_mov_b32 v49, 0
  s_mov_b64 exec, 1
  buffer_atomic_cmpswap_x2 v[46:49], v45, s[12:15], 0 offen sc0
  s_mov_b64 exec, -1
  s_waitcnt vmcnt(0)
  v_readfirstlane_b32 s70, v46
  s_cmp_lg_u32 s70, 0
  s_cbranch_scc1 bj_nz
  v_mov_b32 v46, s88
  v_mov_b32 v47, s89
bj_nz:
w0_29:
  v_mov_b32 v45, 160000
  s_add_u32 s101, s101, 1
  s_barrier
  s_mov_b64 exec, 1
  s_cmp_lg_u32 s16, 0
  s_cbranch_scc1 w0_30
  ds_write_b32 v45, v44 offset:0
  ds_write_b32 v45, v46 offset:4
  ds_write_b32 v45, v47 offset:8
  s_waitcnt lgkmcnt(0)
  v_mov_b32 v44, s101
  ds_write_b32 v45, v44 offset:16
  s_waitcnt lgkmcnt(0)
w0_30:
  s_mov_b64 exec, -1
  s_barrier
  ds_read_b32 v44, v45 offset:0
  ds_read_b32 v46, v45 offset:4
  ds_read_b32 v47, v45 offset:8
  ds_read_b32 v45, v45 offset:16
  s_waitcnt lgkmcnt(0)
  v_readfirstlane_b32 s70, v44
  v_readfirstlane_b32 s88, v46
  v_readfirstlane_b32 s89, v47
  v_cmp_ne_u32 vcc, s101, v45
  s_cbranch_vccnz ch_end
  s_mov_b32 s66, 1
  s_bitcmp1_b32 s70, s3
  s_cbranch_scc1 m_reclaim
bj_cf:
  s_barrier
  s_mov_b32 s56, s40
  s_and_b32 s57, s41, 0xffff
  s_mov_b32 s58, 3670016
  s_mov_b32 s59, 0x20000
  s_mov_b32 s60, s42
  s_and_b32 s61, s43, 0xffff
  s_mov_b32 s62, 3670016
  s_mov_b32 s63, 0x20000
  s_add_u32 s28, s31, s19
  v_lshrrev_b32 v5, 5, v1
  v_and_b32 v6, 31, v1
  v_xor_b32 v6, v6, v5
  v_lshlrev_b32 v6, 4, v6
  v_lshl_add_u32 v6, v5, 13, v6
  s_lshl_b32 s20, s16, 6
  v_xor_b32 v7, s20, v6
  s_lshl_b32 s22, s28, 18
  s_lshl_b32 s21, s16, 16
  s_add_u32 s22, s22, s21
  s_add_u32 s22, s22, s26
  s_lshl_b32 m0, s16, 12
  v_xor_b32 v8, 0, v7
  buffer_load_dwordx4 v8, s[56:59], s22 offen offset:0 lds
  v_xor_b32 v8, 32, v7
  v_add_u32 v8, 15360, v8
  buffer_load_dwordx4 v8, s[56:59], s22 offen offset:1024 lds
  v_xor_b32 v8, 0, v7
  v_add_u32 v8, 30720, v8
  buffer_load_dwordx4 v8, s[56:59], s22 offen offset:2048 lds
  v_xor_b32 v8, 32, v7
  v_add_u32 v8, 46080, v8
  buffer_load_dwordx4 v8, s[56:59], s22 offen offset:3072 lds
  v_xor_b32 v16, 0, v6
  v_xor_b32 v17, 32, v6
  v_add_u32 v17, 31744, v17
  v_xor_b32 v18, 64, v6
  v_add_u32 v18, 129024, v18
  v_xor_b32 v19, 96, v6
  v_add_u32 v19, 160768, v19
  v_xor_b32 v20, 128, v6
  v_add_u32 v20, 262144, v20
  v_xor_b32 v21, 160, v6
  v_add_u32 v21, 293888, v21
  v_xor_b32 v22, 192, v6
  v_add_u32 v22, 391168, v22
  v_xor_b32 v23, 224, v6
  v_add_u32 v23, 422912, v23
  s_lshr_b32 s20, s16, 1
  s_lshl_b32 s20, s20, 16
  s_and_b32 s21, s16, 1
  s_lshl_b32 s21, s21, 14
  s_add_u32 s20, s20, s21
  s_add_u32 s29, s20, s26
  s_mul_i32 s25, s16, 24576
  s_add_u32 s25, s25, 16384
  s_add_u32 s22, s29, 2097152
  s_add_u32 m0, s25, 0
  s_nop 0
  buffer_load_dwordx4 v16, s[60:63], s22 offen offset:0 lds
  buffer_load_dwordx4 v17, s[60:63], s22 offen offset:1024 lds
  buffer_load_dwordx4 v18, s[60:63], s22 offen offset:2048 lds
  buffer_load_dwordx4 v19, s[60:63], s22 offen offset:3072 lds
  s_add_u32 m0, s25, 4096
  s_nop 0
  buffer_load_dwordx4 v20, s[60:63], s22 offen offset:0 lds
  buffer_load_dwordx4 v21, s[60:63], s22 offen offset:1024 lds
  buffer_load_dwordx4 v22, s[60:63], s22 offen offset:2048 lds
  buffer_load_dwordx4 v23, s[60:63], s22 offen offset:3072 lds
  s_waitcnt vmcnt(12)
  s_barrier
  s_cmp_lg_u32 s16, 0
  s_cbranch_scc1 pub_31
  v_mul_u32_u24 v50, 2048, v1
  v_mov_b32 v48, s88
  v_mov_b32 v49, s89
  s_mov_b64 exec, 1
  buffer_store_dwordx2 v[48:49], v50, s[8:11], s77 offen sc1
  s_mov_b64 exec, -1
pub_31:
  s_cmp_ge_u32 s18, 70
  s_cbranch_scc1 bk_nm
  s_mov_b32 s20, 71565312
  buffer_store_dwordx4 v[84:87], v92, s[8:11], s20 offen sc1
  buffer_store_dwordx4 v[88:91], v92, s[8:11], s20 offen offset:256 sc1
  s_cmp_lg_u32 s18, 0
  s_cbranch_scc1 bk_nm
  v_min_u32 v104, -2, v36
  v_min_u32 v108, -2, v37
  v_min_u32 v105, -2, v38
  v_min_u32 v109, -2, v39
  v_min_u32 v106, -2, v40
  v_min_u32 v110, -2, v41
  v_min_u32 v107, -2, v42
  v_min_u32 v111, -2, v43
  s_mov_b32 s20, 88657920
  s_mov_b32 s21, 88080384
  buffer_store_dwordx4 v[104:107], v94, s[8:11], s20 offen sc1
  buffer_store_dwordx4 v[108:111], v94, s[8:11], s20 offen offset:128 sc1
  buffer_store_dwordx4 v[104:107], v94, s[8:11], s21 offen sc1
  buffer_store_dwordx4 v[108:111], v94, s[8:11], s21 offen offset:128 sc1
bk_nm:
  s_mov_b32 s23, 88657920
  v_add_u32 v6, 448, v95
  v_subrev_u32 v7, 1152, v6
  v_mov_b32 v52, -1
  v_mov_b32 v9, 0
  v_cmp_gt_u32 vcc, 128, v7
  s_nop 1
  v_cndmask_b32 v52, v52, v9, vcc
  v_mov_b32 v53, v52
  v_mov_b32 v54, v52
  v_mov_b32 v55, v52
  v_lshlrev_b32 v8, 4, v6
  v_mov_b32 v9, 0x10000000
  v_cmp_lt_u32 vcc, 25599, v6
  s_nop 1
  v_cndmask_b32 v8, v8, v9, vcc
  buffer_store_dwordx4 v[52:55], v8, s[8:11], s23 offen sc1
  s_mov_b32 s23, 87957504
  v_add_u32 v6, 448, v95
  v_cmp_gt_u32 vcc, 7680, v95
  s_nop 1
  v_cndmask_b32 v6, v6, v95, vcc
  v_subrev_u32 v7, 36352, v6
  v_mov_b32 v56, -1
  v_mov_b32 v9, 0
  v_cmp_gt_u32 vcc, 1048576, v7
  s_nop 1
  v_cndmask_b32 v56, v56, v9, vcc
  v_mov_b32 v57, v56
  v_mov_b32 v58, v56
  v_mov_b32 v59, v56
  v_lshlrev_b32 v8, 4, v6
  v_mov_b32 v9, 0x10000000
  v_cmp_lt_u32 vcc, 40319, v6
  s_nop 1
  v_cndmask_b32 v8, v8, v9, vcc
  buffer_store_dwordx4 v[56:59], v8, s[8:11], s23 offen sc1
  s_add_u32 s22, s29, 2621440
  s_add_u32 m0, s25, 8192
  s_nop 0
  buffer_load_dwordx4 v16, s[60:63], s22 offen offset:0 lds
  buffer_load_dwordx4 v17, s[60:63], s22 offen offset:1024 lds
  buffer_load_dwordx4 v18, s[60:63], s22 offen offset:2048 lds
  buffer_load_dwordx4 v19, s[60:63], s22 offen offset:3072 lds
  s_add_u32 m0, s25, 12288
  s_nop 0
  buffer_load_dwordx4 v20, s[60:63], s22 offen offset:0 lds
  buffer_load_dwordx4 v21, s[60:63], s22 offen offset:1024 lds
  buffer_load_dwordx4 v22, s[60:63], s22 offen offset:2048 lds
  buffer_load_dwordx4 v23, s[60:63], s22 offen offset:3072 lds
  s_add_u32 s22, s29, 3145728
  s_add_u32 m0, s25, 16384
  s_nop 0
  buffer_load_dwordx4 v16, s[60:63], s22 offen offset:0 lds
  buffer_load_dwordx4 v17, s[60:63], s22 offen offset:1024 lds
  buffer_load_dwordx4 v18, s[60:63], s22 offen offset:2048 lds
  buffer_load_dwordx4 v19, s[60:63], s22 offen offset:3072 lds
  s_add_u32 m0, s25, 20480
  s_nop 0
  buffer_load_dwordx4 v20, s[60:63], s22 offen offset:0 lds
  buffer_load_dwordx4 v21, s[60:63], s22 offen offset:1024 lds
  buffer_load_dwordx4 v22, s[60:63], s22 offen offset:2048 lds
  buffer_load_dwordx4 v23, s[60:63], s22 offen offset:3072 lds
  v_mov_b32 v250, s68
  s_or_b32 s20, s69, s16
  s_cbranch_scc1 bj_ht
  s_cmp_lg_u32 s16, 0
  s_cbranch_scc1 w0_32
  v_mov_b32 v250, 1
  v_mov_b32 v251, 192
  s_mov_b64 exec, 1
  buffer_atomic_add v250, v251, s[12:15], 0 offen sc0
  s_mov_b64 exec, -1
w0_32:
  s_branch bj_h2
bj_ht:
  buffer_load_dword v251, off, s[8:11], s77
bj_h2:
  v_lshrrev_b32 v7, 2, v4
  v_lshlrev_b32 v7, 3, v7
  v_and_b32 v8, 3, v4
  v_add_u32 v7, v7, v8
  v_xor_b32 v10, v3, v4
  v_lshlrev_b32 v10, 4, v10
  v_lshl_add_u32 v11, v4, 9, v10
  v_add_u32 v11, s25, v11
  v_lshl_add_u32 v10, v7, 9, v10
  v_xor_b32 v32, 0, v10
  v_xor_b32 v36, 0, v11
  v_xor_b32 v33, 64, v10
  v_xor_b32 v37, 64, v11
  v_xor_b32 v34, 128, v10
  v_xor_b32 v38, 128, v11
  v_xor_b32 v35, 192, v10
  v_xor_b32 v39, 192, v11
  s_mul_i32 s30, s17, 401408
  s_mul_i32 s20, s16, 14336
  s_add_u32 s30, s30, s20
  s_lshl_b32 s20, s28, 10
  s_add_u32 s30, s30, s20
  s_mov_b32 s24, 1035512379
  s_lshl_b32 s20, s17, 7
  s_lshl_b32 s28, s28, 3
  s_add_u32 s28, s28, s20
  s_add_u32 s28, s28, 88639488
  s_waitcnt vmcnt(1)
  s_barrier
  s_cmp_lg_u32 s16, 0
  s_cbranch_scc1 w0_33
  v_mul_u32_u24 v50, 2048, v1
  v_mov_b32 v48, s88
  v_mov_b32 v49, s89
  s_mov_b64 exec, 511
  buffer_store_dwordx2 v[48:49], v50, s[8:11], s78 offen sc1
  s_mov_b64 exec, -1
w0_33:
  ds_read_b128 v[128:131], v32 offset:0
  ds_read_b128 v[132:135], v32 offset:2048
  ds_read_b128 v[136:139], v36 offset:0
  ds_read_b128 v[140:143], v36 offset:8192
  ds_read_b128 v[144:147], v36 offset:16384
  ds_read_b128 v[148:151], v33 offset:0
  ds_read_b128 v[152:155], v33 offset:2048
  ds_read_b128 v[156:159], v37 offset:0
  ds_read_b128 v[160:163], v37 offset:8192
  ds_read_b128 v[164:167], v37 offset:16384
  ds_read_b128 v[168:171], v34 offset:0
  ds_read_b128 v[172:175], v34 offset:2048
  ds_read_b128 v[176:179], v38 offset:0
  ds_read_b128 v[180:183], v38 offset:8192
  ds_read_b128 v[184:187], v38 offset:16384
  s_waitcnt lgkmcnt(10)
  v_mfma_f32_16x16x32_bf16 v[96:99], v[128:131], v[136:139], 0
  v_mfma_f32_16x16x32_bf16 v[100:103], v[132:135], v[136:139], 0
  v_mfma_f32_16x16x32_bf16 v[104:107], v[128:131], v[140:143], 0
  v_mfma_f32_16x16x32_bf16 v[108:111], v[132:135], v[140:143], 0
  v_mfma_f32_16x16x32_bf16 v[112:115], v[128:131], v[144:147], 0
  v_mfma_f32_16x16x32_bf16 v[116:119], v[132:135], v[144:147], 0
  ds_read_b128 v[128:131], v35 offset:0
  ds_read_b128 v[132:135], v35 offset:2048
  ds_read_b128 v[136:139], v39 offset:0
  ds_read_b128 v[140:143], v39 offset:8192
  ds_read_b128 v[144:147], v39 offset:16384
  s_waitcnt lgkmcnt(10)
  v_mfma_f32_16x16x32_bf16 v[96:99], v[148:151], v[156:159], v[96:99]
  v_mfma_f32_16x16x32_bf16 v[100:103], v[152:155], v[156:159], v[100:103]
  v_mfma_f32_16x16x32_bf16 v[104:107], v[148:151], v[160:163], v[104:107]
  v_mfma_f32_16x16x32_bf16 v[108:111], v[152:155], v[160:163], v[108:111]
  v_mfma_f32_16x16x32_bf16 v[112:115], v[148:151], v[164:167], v[112:115]
  v_mfma_f32_16x16x32_bf16 v[116:119], v[152:155], v[164:167], v[116:119]
  ds_read_b128 v[148:151], v32 offset:256
  ds_read_b128 v[152:155], v32 offset:2304
  ds_read_b128 v[156:159], v36 offset:256
  ds_read_b128 v[160:163], v36 offset:8448
  ds_read_b128 v[164:167], v36 offset:16640
  s_waitcnt lgkmcnt(10)
  v_mfma_f32_16x16x32_bf16 v[96:99], v[168:171], v[176:179], v[96:99]
  v_mfma_f32_16x16x32_bf16 v[100:103], v[172:175], v[176:179], v[100:103]
  v_mfma_f32_16x16x32_bf16 v[104:107], v[168:171], v[180:183], v[104:107]
  v_mfma_f32_16x16x32_bf16 v[108:111], v[172:175], v[180:183], v[108:111]
  v_mfma_f32_16x16x32_bf16 v[112:115], v[168:171], v[184:187], v[112:115]
  v_mfma_f32_16x16x32_bf16 v[116:119], v[172:175], v[184:187], v[116:119]
  ds_read_b128 v[168:171], v33 offset:256
  ds_read_b128 v[172:175], v33 offset:2304
  ds_read_b128 v[176:179], v37 offset:256
  ds_read_b128 v[180:183], v37 offset:8448
  ds_read_b128 v[184:187], v37 offset:16640
  s_waitcnt lgkmcnt(10)
  v_mfma_f32_16x16x32_bf16 v[96:99], v[128:131], v[136:139], v[96:99]
  v_mfma_f32_16x16x32_bf16 v[100:103], v[132:135], v[136:139], v[100:103]
  v_mfma_f32_16x16x32_bf16 v[104:107], v[128:131], v[140:143], v[104:107]
  v_mfma_f32_16x16x32_bf16 v[108:111], v[132:135], v[140:143], v[108:111]
  v_mfma_f32_16x16x32_bf16 v[112:115], v[128:131], v[144:147], v[112:115]
  v_mfma_f32_16x16x32_bf16 v[116:119], v[132:135], v[144:147], v[116:119]
  ds_read_b128 v[128:131], v34 offset:256
  ds_read_b128 v[132:135], v34 offset:2304
  ds_read_b128 v[136:139], v38 offset:256
  ds_read_b128 v[140:143], v38 offset:8448
  ds_read_b128 v[144:147], v38 offset:16640
  s_waitcnt lgkmcnt(10)
  v_mfma_f32_16x16x32_bf16 v[96:99], v[148:151], v[156:159], v[96:99]
  v_mfma_f32_16x16x32_bf16 v[100:103], v[152:155], v[156:159], v[100:103]
  v_mfma_f32_16x16x32_bf16 v[104:107], v[148:151], v[160:163], v[104:107]
  v_mfma_f32_16x16x32_bf16 v[108:111], v[152:155], v[160:163], v[108:111]
  v_mfma_f32_16x16x32_bf16 v[112:115], v[148:151], v[164:167], v[112:115]
  v_mfma_f32_16x16x32_bf16 v[116:119], v[152:155], v[164:167], v[116:119]
  ds_read_b128 v[148:151], v35 offset:256
  ds_read_b128 v[152:155], v35 offset:2304
  ds_read_b128 v[156:159], v39 offset:256
  ds_read_b128 v[160:163], v39 offset:8448
  ds_read_b128 v[164:167], v39 offset:16640
  s_waitcnt lgkmcnt(10)
  v_mfma_f32_16x16x32_bf16 v[96:99], v[168:171], v[176:179], v[96:99]
  v_mfma_f32_16x16x32_bf16 v[100:103], v[172:175], v[176:179], v[100:103]
  v_mfma_f32_16x16x32_bf16 v[104:107], v[168:171], v[180:183], v[104:107]
  v_mfma_f32_16x16x32_bf16 v[108:111], v[172:175], v[180:183], v[108:111]
  v_mfma_f32_16x16x32_bf16 v[112:115], v[168:171], v[184:187], v[112:115]
  v_mfma_f32_16x16x32_bf16 v[116:119], v[172:175], v[184:187], v[116:119]
  s_waitcnt lgkmcnt(5)
  v_mfma_f32_16x16x32_bf16 v[96:99], v[128:131], v[136:139], v[96:99]
  v_mfma_f32_16x16x32_bf16 v[100:103], v[132:135], v[136:139], v[100:103]
  v_mfma_f32_16x16x32_bf16 v[104:107], v[128:131], v[140:143], v[104:107]
  v_mfma_f32_16x16x32_bf16 v[108:111], v[132:135], v[140:143], v[108:111]
  v_mfma_f32_16x16x32_bf16 v[112:115], v[128:131], v[144:147], v[112:115]
  v_mfma_f32_16x16x32_bf16 v[116:119], v[132:135], v[144:147], v[116:119]
  s_waitcnt lgkmcnt(0)
  v_mfma_f32_16x16x32_bf16 v[96:99], v[148:151], v[156:159], v[96:99]
  v_mfma_f32_16x16x32_bf16 v[100:103], v[152:155], v[156:159], v[100:103]
  v_mfma_f32_16x16x32_bf16 v[104:107], v[148:151], v[160:163], v[104:107]
  v_mfma_f32_16x16x32_bf16 v[108:111], v[152:155], v[160:163], v[108:111]
  v_mfma_f32_16x16x32_bf16 v[112:115], v[148:151], v[164:167], v[112:115]
  v_mfma_f32_16x16x32_bf16 v[116:119], v[152:155], v[164:167], v[116:119]
  v_mul_f32 v96, s24, v96
  v_mul_f32 v97, s24, v97
  v_mul_f32 v98, s24, v98
  v_mul_f32 v99, s24, v99
  v_mul_f32 v100, s24, v100
  v_mul_f32 v101, s24, v101
  v_mul_f32 v102, s24, v102
  v_mul_f32 v103, s24, v103
  v_cvt_pk_bf16_f32 v68, v96, v97
  v_cvt_pk_bf16_f32 v69, v98, v99
  v_cvt_pk_bf16_f32 v70, v100, v101
  v_cvt_pk_bf16_f32 v71, v102, v103
  s_add_u32 s20, s30, 229376
  buffer_store_dwordx4 v[68:71], v2, s[8:11], s20 offen sc1
  v_mul_f32 v104, s24, v104
  v_mul_f32 v105, s24, v105
  v_mul_f32 v106, s24, v106
  v_mul_f32 v107, s24, v107
  v_mul_f32 v108, s24, v108
  v_mul_f32 v109, s24, v109
  v_mul_f32 v110, s24, v110
  v_mul_f32 v111, s24, v111
  v_cvt_pk_bf16_f32 v72, v104, v105
  v_cvt_pk_bf16_f32 v73, v106, v107
  v_cvt_pk_bf16_f32 v74, v108, v109
  v_cvt_pk_bf16_f32 v75, v110, v111
  s_add_u32 s20, s30, 286720
  buffer_store_dwordx4 v[72:75], v2, s[8:11], s20 offen sc1
  v_mul_f32 v112, s24, v112
  v_mul_f32 v113, s24, v113
  v_mul_f32 v114, s24, v114
  v_mul_f32 v115, s24, v115
  v_mul_f32 v116, s24, v116
  v_mul_f32 v117, s24, v117
  v_mul_f32 v118, s24, v118
  v_mul_f32 v119, s24, v119
  v_cvt_pk_bf16_f32 v76, v112, v113
  v_cvt_pk_bf16_f32 v77, v114, v115
  v_cvt_pk_bf16_f32 v78, v116, v117
  v_cvt_pk_bf16_f32 v79, v118, v119
  s_add_u32 s20, s30, 344064
  buffer_store_dwordx4 v[76:79], v2, s[8:11], s20 offen sc1
  s_waitcnt vmcnt(0)
  s_barrier
  s_cmp_lg_u32 s16, 0
  s_cbranch_scc1 pub_34
  v_mul_u32_u24 v26, 2048, v1
  v_mov_b32 v24, s88
  v_mov_b32 v25, s89
  s_mov_b64 exec, 1
  buffer_store_dwordx2 v[24:25], v26, s[8:11], s28 offen sc1
  s_mov_b64 exec, -1
pub_34:
  v_mov_b32 v6, 160000
  s_add_u32 s101, s101, 1
  s_barrier
  s_mov_b64 exec, 1
  s_cmp_lg_u32 s16, 0
  s_cbranch_scc1 w0_35
  ds_write_b32 v6, v250 offset:0
  s_waitcnt lgkmcnt(0)
  v_mov_b32 v250, s101
  ds_write_b32 v6, v250 offset:16
  s_waitcnt lgkmcnt(0)
w0_35:
  s_mov_b64 exec, -1
  s_barrier
  ds_read_b32 v250, v6 offset:0
  ds_read_b32 v6, v6 offset:16
  s_waitcnt lgkmcnt(0)
  v_readfirstlane_b32 s3, v250
  v_cmp_ne_u32 vcc, s101, v6
  s_cbranch_vccnz ch_end
  s_branch wk_have
wk_loop:
  s_waitcnt vmcnt(0) lgkmcnt(0)
  s_cmp_eq_u32 s96, 1
  s_cbranch_scc1 wk_ask
  s_mov_b32 s96, 1
  s_cmp_lg_u32 s16, 0
  s_cbranch_scc1 w0_36
  s_mov_b32 s30, 0
  v_mov_b32 v243, 32
sf_l:
  buffer_load_dword v242, v243, s[12:15], 0 offen sc1
  s_waitcnt vmcnt(0)
  v_readfirstlane_b32 s70, v242
  s_cmp_eq_u32 s70, -1
  s_cbranch_scc1 sf_d
  s_sleep 16
  s_add_u32 s30, s30, 1
  s_cmp_lt_u32 s30, 64
  s_cbranch_scc1 sf_l
  s_mov_b32 s20, 0
  s_mov_b32 s21, 0
  s_mov_b64 exec, 1
sf_c_l:
  s_cmp_lg_u32 s70, -1
  s_cbranch_scc1 sf_c_t
  s_add_u32 s20, s20, 1
  s_cmp_lt_u32 s20, 8
  s_cselect_b32 s20, s20, 0
  s_mov_b32 s70, 0
  s_mov_b32 s3, -1
  s_add_u32 s21, s21, 1
  s_cmp_ge_u32 s21, 1
  s_cbranch_scc1 sf_c_d
sf_c_t:
  s_ff0_i32_b32 s22, s70
  s_lshl_b32 s23, 1, s22
  s_and_b32 s71, s20, 4
  s_mul_i32 s71, s71, 12
  s_lshl_b32 s3, s20, 2
  s_add_u32 s3, s3, s71
  v_mov_b32 v242, s23
  v_mov_b32 v243, 32
  buffer_atomic_or v242, v243, s[12:15], s3 offen sc0
  s_waitcnt vmcnt(0)
  v_readfirstlane_b32 s70, v242
  s_lshl_b32 s3, s20, 5
  s_add_u32 s3, s3, s22
  s_bitcmp1_b32 s70, s22
  s_cbranch_scc1 sf_c_l
sf_c_d:
  s_mov_b64 exec, -1
  v_mov_b32 v242, s3
sf_d:
w0_36:
  v_mov_b32 v243, 160000
  s_add_u32 s101, s101, 1
  s_barrier
  s_mov_b64 exec, 1
  s_cmp_lg_u32 s16, 0
  s_cbranch_scc1 w0_37
  ds_write_b32 v243, v242 offset:0
  s_waitcnt lgkmcnt(0)
  v_mov_b32 v242, s101
  ds_write_b32 v243, v242 offset:16
  s_waitcnt lgkmcnt(0)
w0_37:
  s_mov_b64 exec, -1
  s_barrier
  ds_read_b32 v242, v243 offset:0
  ds_read_b32 v243, v243 offset:16
  s_waitcnt lgkmcnt(0)
  v_readfirstlane_b32 s3, v242
  v_cmp_ne_u32 vcc, s101, v243
  s_cbranch_vccnz ch_end
  s_cmp_eq_u32 s3, -1
  s_cbranch_scc1 wk_ask
  s_load_dwordx8 s[36:43], s[0:1], 56
  s_load_dwordx4 s[44:47], s[0:1], 88
  s_getreg_b32 s67, hwreg(HW_REG_XCC_ID)
  s_and_b32 s67, s67, 7
  s_mov_b32 s66, 1
  s_waitcnt lgkmcnt(0)
  s_branch m_start
wk_ask:
  v_readfirstlane_b32 s22, v250
  s_cmp_ge_u32 s22, 1440
  s_cbranch_scc1 wk_next
  s_cmp_lg_u32 s16, 0
  s_cbranch_scc1 w0_38
  v_mov_b32 v250, 1
  v_mov_b32 v251, 192
  s_mov_b64 exec, 1
  buffer_atomic_add v250, v251, s[12:15], 0 offen sc0
  s_mov_b64 exec, -1
w0_38:
wk_next:
  s_waitcnt vmcnt(0)
  v_mov_b32 v6, 160000
  s_add_u32 s101, s101, 1
  s_barrier
  s_mov_b64 exec, 1
  s_cmp_lg_u32 s16, 0
  s_cbranch_scc1 w0_39
  ds_write_b32 v6, v250 offset:0
  s_waitcnt lgkmcnt(0)
  v_mov_b32 v250, s101
  ds_write_b32 v6, v250 offset:16
  s_waitcnt lgkmcnt(0)
w0_39:
  s_mov_b64 exec, -1
  s_barrier
  ds_read_b32 v250, v6 offset:0
  ds_read_b32 v6, v6 offset:16
  s_waitcnt lgkmcnt(0)
  v_readfirstlane_b32 s3, v250
  v_cmp_ne_u32 vcc, s101, v6
  s_cbranch_vccnz ch_end
wk_have:
  s_cmp_ge_u32 s3, 1440
  s_cbranch_scc1 ch_end
  v_mov_b32 v250, 0
  v_mov_b32 v251, 192
  v_and_b32 v1, 63, v0
  v_lshlrev_b32 v2, 4, v1
  v_lshrrev_b32 v3, 4, v1
  v_and_b32 v4, 15, v1
  s_cmp_lg_u32 s97, 0
  s_cbranch_scc1 wk_go
  s_mov_b32 s68, s3
  s_mov_b32 s69, 1
  s_cmp_lg_u32 s16, 0
  s_cbranch_scc1 w0_40
  s_add_u32 s20, s67, 1
  s_lshl_b32 s22, s20, 11
  s_add_u32 s22, s22, 88606720
  v_add_u32 v24, 1024, v2
  v_min_u32 v24, 1776, v24
  s_mov_b32 s30, 0
wk_af:
  buffer_load_dwordx4 v[28:31], v2, s[8:11], s22 offen sc1
  buffer_load_dwordx4 v[32:35], v24, s[8:11], s22 offen sc1
  s_waitcnt vmcnt(0)
  v_cmp_ne_u64 vcc, s[88:89], v[28:29]
  s_cbranch_vccnz wk_af_no
  v_cmp_ne_u64 vcc, s[88:89], v[30:31]
  s_cbranch_vccnz wk_af_no
  v_cmp_ne_u64 vcc, s[88:89], v[32:33]
  s_cbranch_vccnz wk_af_no
  v_cmp_ne_u64 vcc, s[88:89], v[34:35]
  s_cbranch_vccnz wk_af_no
  s_branch wk_af_ok
wk_af_no:
  s_sleep 4
  s_add_u32 s30, s30, 1
  s_and_b32 s20, s30, 63
  s_cbranch_scc1 wk_ns
  s_mov_b32 s20, 1
  s_mov_b32 s70, 0
  s_mov_b32 s21, 0
  s_mov_b64 exec, 1
wk_st_l:
  s_cmp_lg_u32 s70, -1
  s_cbranch_scc1 wk_st_t
  s_add_u32 s20, s20, 1
  s_cmp_lt_u32 s20, 8
  s_cselect_b32 s20, s20, 1
  s_mov_b32 s70, 0
  s_mov_b32 s3, -1
  s_add_u32 s21, s21, 1
  s_cmp_ge_u32 s21, 7
  s_cbranch_scc1 wk_st_d
wk_st_t:
  s_ff0_i32_b32 s22, s70
  s_lshl_b32 s23, 1, s22
  s_and_b32 s71, s20, 4
  s_mul_i32 s71, s71, 12
  s_lshl_b32 s3, s20, 2
  s_add_u32 s3, s3, s71
  v_mov_b32 v242, s23
  v_mov_b32 v243, 32
  buffer_atomic_or v242, v243, s[12:15], s3 offen sc0
  s_waitcnt vmcnt(0)
  v_readfirstlane_b32 s70, v242
  s_lshl_b32 s3, s20, 5
  s_add_u32 s3, s3, s22
  s_bitcmp1_b32 s70, s22
  s_cbranch_scc1 wk_st_l
wk_st_d:
  s_mov_b64 exec, -1
  v_mov_b32 v242, s3
  s_cmp_lg_u32 s3, -1
  s_cbranch_scc1 wk_pd
  s_add_u32 s20, s67, 1
  s_lshl_b32 s22, s20, 11
  s_add_u32 s22, s22, 88606720
wk_ns:
  s_cmp_lt_u32 s30, 50000
  s_cbranch_scc1 wk_af
  s_branch cA_abort
wk_af_ok:
  v_mov_b32 v242, -1
wk_pd:
w0_40:
  v_mov_b32 v243, 160000
  s_add_u32 s101, s101, 1
  s_barrier
  s_mov_b64 exec, 1
  s_cmp_lg_u32 s16, 0
  s_cbranch_scc1 w0_41
  ds_write_b32 v243, v242 offset:0
  s_waitcnt lgkmcnt(0)
  v_mov_b32 v242, s101
  ds_write_b32 v243, v242 offset:16
  s_waitcnt lgkmcnt(0)
w0_41:
  s_mov_b64 exec, -1
  s_barrier
  ds_read_b32 v242, v243 offset:0
  ds_read_b32 v243, v243 offset:16
  s_waitcnt lgkmcnt(0)
  v_readfirstlane_b32 s3, v242
  v_cmp_ne_u32 vcc, s101, v243
  s_cbranch_vccnz ch_end
  s_cmp_lg_u32 s3, -1
  s_cbranch_scc1 m_bjob
  s_mov_b32 s3, s68
  s_mov_b32 s97, 1
wk_go:
  s_cmp_lt_u32 s3, 368
  s_cbranch_scc1 wk_g2
  s_sub_u32 s20, s3, 496
  s_cmp_lt_u32 s20, 128
  s_cbranch_scc1 wk_g2
  s_cmp_eq_u32 s97, 2
  s_cbranch_scc1 wk_g2
  s_getreg_b32 s20, hwreg(HW_REG_XCC_ID)
  s_and_b32 s20, s20, 7
  s_cmp_lg_u32 s16, 0
  s_cbranch_scc1 w0_42
  s_lshl_b32 s22, s20, 11
  s_add_u32 s22, s22, 88641536
  v_add_u32 v24, 1024, v2
  v_min_u32 v24, 1776, v24
  s_mov_b32 s30, 0
wk_i2:
  buffer_load_dwordx4 v[28:31], v2, s[8:11], s22 offen sc1
  buffer_load_dwordx4 v[32:35], v24, s[8:11], s22 offen sc1
  s_waitcnt vmcnt(0)
  v_cmp_ne_u64 vcc, s[88:89], v[28:29]
  s_cbranch_vccnz wk_i2_no
  v_cmp_ne_u64 vcc, s[88:89], v[30:31]
  s_cbranch_vccnz wk_i2_no
  v_cmp_ne_u64 vcc, s[88:89], v[32:33]
  s_cbranch_vccnz wk_i2_no
  v_cmp_ne_u64 vcc, s[88:89], v[34:35]
  s_cbranch_vccnz wk_i2_no
  s_branch wk_i2_ok
wk_i2_no:
  s_sleep 4
  s_add_u32 s30, s30, 1
  s_cmp_lt_u32 s30, 50000
  s_cbranch_scc1 wk_i2
  s_branch cA_abort
wk_i2_ok:
w0_42:
  v_mov_b32 v242, 0
  v_mov_b32 v243, 160000
  s_add_u32 s101, s101, 1
  s_barrier
  s_mov_b64 exec, 1
  s_cmp_lg_u32 s16, 0
  s_cbranch_scc1 w0_43
  ds_write_b32 v243, v242 offset:0
  s_waitcnt lgkmcnt(0)
  v_mov_b32 v242, s101
  ds_write_b32 v243, v242 offset:16
  s_waitcnt lgkmcnt(0)
w0_43:
  s_mov_b64 exec, -1
  s_barrier
  ds_read_b32 v242, v243 offset:0
  ds_read_b32 v243, v243 offset:16
  s_waitcnt lgkmcnt(0)
  v_readfirstlane_b32 s20, v242
  v_cmp_ne_u32 vcc, s101, v243
  s_cbranch_vccnz ch_end
  s_mov_b32 s97, 2
wk_g2:
  s_cmp_ge_u32 s3, 864
  s_cbranch_scc1 wk_tok
  s_cmp_ge_u32 s3, 752
  s_cbranch_scc1 wk_s4d
  s_cmp_ge_u32 s3, 624
  s_cbranch_scc1 wk_f
  s_cmp_ge_u32 s3, 496
  s_cbranch_scc1 wk_a
  s_cmp_ge_u32 s3, 432
  s_cbranch_scc1 wk_vf
  s_cmp_ge_u32 s3, 368
  s_cbranch_scc1 wk_vh
  s_cmp_ge_u32 s3, 256
  s_cbranch_scc1 wk_v7
  s_cmp_ge_u32 s3, 224
  s_cbranch_scc1 wk_srv
  s_sub_u32 s20, s3, 0
  s_cmp_ge_u32 s20, 112
  s_cselect_b32 s18, 1, 0
  s_cselect_b32 s21, 112, 0
  s_sub_u32 s20, s20, s21
  s_and_b32 s17, s20, 15
  s_add_u32 s17, s17, 16
  s_lshr_b32 s34, s20, 4
  s_lshl_b32 s34, s34, 1
  s_add_u32 s35, s34, 2
  s_cmp_eq_u32 s18, 0
  s_cbranch_scc1 wf_nw
  s_and_b32 s20, s3, 3
  s_lshl_b32 s20, s20, 3
  s_add_u32 s20, s20, 8
  s_cmp_eq_u32 s16, 0
  s_cselect_b32 s20, 0, s20
  s_cmp_ge_u32 s16, 2
  s_cselect_b32 s20, 112, s20
  s_load_dwordx2 s[72:73], s[0:1], s20
  s_lshr_b32 s21, s3, 2
  s_lshl_b32 s21, s21, 12
  s_mov_b32 s74, 229376
  s_lshl_b32 s22, s3, 13
  s_cmp_eq_u32 s16, 0
  s_cselect_b32 s21, s22, s21
  s_cselect_b32 s74, 1835008, s74
  s_lshl_b32 s22, s3, 1
  s_add_u32 s22, s22, s16
  s_sub_u32 s22, s22, 2
  s_lshl_b32 s22, s22, 13
  s_cmp_ge_u32 s16, 2
  s_cselect_b32 s21, s22, s21
  s_cselect_b32 s74, 3670016, s74
  v_lshlrev_b32 v6, 3, v2
  s_cmp_lt_u32 s16, 2
  s_cbranch_scc1 lw_44
  s_lshl_b32 s21, s3, 6
  v_add_u32 v6, s21, v1
  v_mul_u32_u24 v7, 37450, v6
  v_lshrrev_b32 v7, 18, v7
  v_add_u32 v7, 1, v7
  v_mul_u32_u24 v7, 7, v7
  v_add_u32 v6, v6, v7
  v_lshlrev_b32 v6, 7, v6
  s_mov_b32 s21, 0
  s_cmp_eq_u32 s16, 3
  s_cselect_b32 s74, 0, s74
lw_44:
  s_cmp_eq_u32 s16, 1
  s_cselect_b32 exec_hi, 0, -1
  s_waitcnt lgkmcnt(0)
  s_and_b32 s73, s73, 0xffff
  s_mov_b32 s75, 0x20000
  buffer_load_dword v7, v6, s[72:75], s21 offen
  s_mov_b64 exec, -1
  s_sub_u32 s3, s3, 112
  s_and_b32 s20, s3, 3
  s_lshl_b32 s20, s20, 3
  s_add_u32 s20, s20, 8
  s_cmp_eq_u32 s16, 0
  s_cselect_b32 s20, 0, s20
  s_cmp_ge_u32 s16, 2
  s_cselect_b32 s20, 112, s20
  s_load_dwordx2 s[72:73], s[0:1], s20
  s_lshr_b32 s21, s3, 2
  s_lshl_b32 s21, s21, 12
  s_mov_b32 s74, 229376
  s_lshl_b32 s22, s3, 13
  s_cmp_eq_u32 s16, 0
  s_cselect_b32 s21, s22, s21
  s_cselect_b32 s74, 1835008, s74
  s_lshl_b32 s22, s3, 1
  s_add_u32 s22, s22, s16
  s_sub_u32 s22, s22, 2
  s_lshl_b32 s22, s22, 13
  s_cmp_ge_u32 s16, 2
  s_cselect_b32 s21, s22, s21
  s_cselect_b32 s74, 3670016, s74
  v_lshlrev_b32 v6, 3, v2
  s_cmp_lt_u32 s16, 2
  s_cbranch_scc1 lw_45
  s_lshl_b32 s21, s3, 6
  v_add_u32 v6, s21, v1
  v_mul_u32_u24 v7, 37450, v6
  v_lshrrev_b32 v7, 18, v7
  v_add_u32 v7, 1, v7
  v_mul_u32_u24 v7, 7, v7
  v_add_u32 v6, v6, v7
  v_lshlrev_b32 v6, 7, v6
  s_mov_b32 s21, 0
  s_cmp_eq_u32 s16, 3
  s_cselect_b32 s74, 0, s74
lw_45:
  s_cmp_eq_u32 s16, 1
  s_cselect_b32 exec_hi, 0, -1
  s_waitcnt lgkmcnt(0)
  s_and_b32 s73, s73, 0xffff
  s_mov_b32 s75, 0x20000
  buffer_load_dword v7, v6, s[72:75], s21 offen
  s_mov_b64 exec, -1
  s_add_u32 s3, s3, 112
wf_nw:
  s_lshl_b32 s20, s18, 3
  s_lshl_b32 s21, s16, 1
  s_add_u32 s20, s20, s21
  s_mul_i32 s21, s20, 14336
  s_add_u32 s21, s21, 71565312
  s_add_u32 s22, s21, 0
  buffer_load_dwordx4 a[0:3], v2, s[8:11], s22 offen offset:0 sc1
  buffer_load_dwordx4 a[4:7], v2, s[8:11], s22 offen offset:1024 sc1
  buffer_load_dwordx4 a[8:11], v2, s[8:11], s22 offen offset:2048 sc1
  buffer_load_dwordx4 a[12:15], v2, s[8:11], s22 offen offset:3072 sc1
  s_add_u32 s22, s21, 4096
  buffer_load_dwordx4 a[16:19], v2, s[8:11], s22 offen offset:0 sc1
  buffer_load_dwordx4 a[20:23], v2, s[8:11], s22 offen offset:1024 sc1
  buffer_load_dwordx4 a[24:27], v2, s[8:11], s22 offen offset:2048 sc1
  buffer_load_dwordx4 a[28:31], v2, s[8:11], s22 offen offset:3072 sc1
  s_add_u32 s22, s21, 8192
  buffer_load_dwordx4 a[32:35], v2, s[8:11], s22 offen offset:0 sc1
  buffer_load_dwordx4 a[36:39], v2, s[8:11], s22 offen offset:1024 sc1
  buffer_load_dwordx4 a[40:43], v2, s[8:11], s22 offen offset:2048 sc1
  buffer_load_dwordx4 a[44:47], v2, s[8:11], s22 offen offset:3072 sc1
  s_add_u32 s22, s21, 12288
  buffer_load_dwordx4 a[48:51], v2, s[8:11], s22 offen offset:0 sc1
  buffer_load_dwordx4 a[52:55], v2, s[8:11], s22 offen offset:1024 sc1
  buffer_load_dwordx4 a[56:59], v2, s[8:11], s22 offen offset:2048 sc1
  buffer_load_dwordx4 a[60:63], v2, s[8:11], s22 offen offset:3072 sc1
  s_add_u32 s22, s21, 16384
  buffer_load_dwordx4 a[64:67], v2, s[8:11], s22 offen offset:0 sc1
  buffer_load_dwordx4 a[68:71], v2, s[8:11], s22 offen offset:1024 sc1
  buffer_load_dwordx4 a[72:75], v2, s[8:11], s22 offen offset:2048 sc1
  buffer_load_dwordx4 a[76:79], v2, s[8:11], s22 offen offset:3072 sc1
  s_add_u32 s22, s21, 20480
  buffer_load_dwordx4 a[80:83], v2, s[8:11], s22 offen offset:0 sc1
  buffer_load_dwordx4 a[84:87], v2, s[8:11], s22 offen offset:1024 sc1
  buffer_load_dwordx4 a[88:91], v2, s[8:11], s22 offen offset:2048 sc1
  buffer_load_dwordx4 a[92:95], v2, s[8:11], s22 offen offset:3072 sc1
  s_add_u32 s22, s21, 24576
  buffer_load_dwordx4 a[96:99], v2, s[8:11], s22 offen offset:0 sc1
  buffer_load_dwordx4 a[100:103], v2, s[8:11], s22 offen offset:1024 sc1
  buffer_load_dwordx4 a[104:107], v2, s[8:11], s22 offen offset:2048 sc1
  buffer_load_dwordx4 a[108:111], v2, s[8:11], s22 offen offset:3072 sc1
  s_waitcnt vmcnt(40)
  s_mul_i32 s23, s17, 401408
  s_and_b32 s22, s16, 1
  s_mul_i32 s22, s22, 7168
  s_add_u32 s23, s23, s22
  s_add_u32 s23, s23, 0
  s_lshr_b32 s22, s16, 1
  s_mul_i32 s22, s22, 14336
  s_add_u32 s23, s23, s22
  s_mul_i32 s27, s16, 7168
  s_lshr_b32 s28, s20, 1
wf_vo:
  s_sub_u32 s29, s17, 16
  s_lshl_b32 s29, s29, 6
  s_add_u32 s29, s29, s28
  s_mul_i32 s29, s29, 28672
  s_add_u32 s29, s29, 42205184
  v_lshlrev_b32 v6, 4, v3
  v_mad_u32_u24 v7, v3, 12, 64
  s_mov_b32 s31, 0
  s_lshl_b32 s24, s34, 1
  s_mul_i32 s24, s24, 14336
  s_add_u32 s24, s24, s23
  s_cmp_lt_u32 s34, s35
  s_cselect_b32 s24, s24, 0x10000000
  s_add_u32 m0, s31, s27
  s_nop 0
  buffer_load_dwordx4 v2, s[8:11], s24 offen offset:0 sc1 lds
  buffer_load_dwordx4 v2, s[8:11], s24 offen offset:1024 sc1 lds
  buffer_load_dwordx4 v2, s[8:11], s24 offen offset:2048 sc1 lds
  buffer_load_dwordx4 v2, s[8:11], s24 offen offset:3072 sc1 lds
  s_add_u32 m0, m0, 4096
  s_add_u32 s24, s24, 4096
  buffer_load_dwordx4 v2, s[8:11], s24 offen offset:0 sc1 lds
  buffer_load_dwordx4 v2, s[8:11], s24 offen offset:1024 sc1 lds
  buffer_load_dwordx4 v2, s[8:11], s24 offen offset:2048 sc1 lds
  s_add_u32 s30, s34, 1
  s_mov_b32 s31, 28672
  s_lshl_b32 s24, s30, 1
  s_mul_i32 s24, s24, 14336
  s_add_u32 s24, s24, s23
  s_cmp_lt_u32 s30, s35
  s_cselect_b32 s24, s24, 0x10000000
  s_add_u32 m0, s31, s27
  s_nop 0
  buffer_load_dwordx4 v2, s[8:11], s24 offen offset:0 sc1 lds
  buffer_load_dwordx4 v2, s[8:11], s24 offen offset:1024 sc1 lds
  buffer_load_dwordx4 v2, s[8:11], s24 offen offset:2048 sc1 lds
  buffer_load_dwordx4 v2, s[8:11], s24 offen offset:3072 sc1 lds
  s_add_u32 m0, m0, 4096
  s_add_u32 s24, s24, 4096
  buffer_load_dwordx4 v2, s[8:11], s24 offen offset:0 sc1 lds
  buffer_load_dwordx4 v2, s[8:11], s24 offen offset:1024 sc1 lds
  buffer_load_dwordx4 v2, s[8:11], s24 offen offset:2048 sc1 lds
  s_mov_b32 s19, s34
  s_mov_b32 s32, 0
  s_mov_b32 s33, 57344
  s_waitcnt vmcnt(7)
  s_branch wf_vo_in
wf_vo_loop:
  s_waitcnt vmcnt(9)
wf_vo_in:
  s_barrier
  s_add_u32 s30, s19, 2
  s_lshl_b32 s24, s30, 1
  s_mul_i32 s24, s24, 14336
  s_add_u32 s24, s24, s23
  s_cmp_lt_u32 s30, s35
  s_cselect_b32 s24, s24, 0x10000000
  s_add_u32 m0, s33, s27
  s_nop 0
  buffer_load_dwordx4 v2, s[8:11], s24 offen offset:0 sc1 lds
  buffer_load_dwordx4 v2, s[8:11], s24 offen offset:1024 sc1 lds
  buffer_load_dwordx4 v2, s[8:11], s24 offen offset:2048 sc1 lds
  buffer_load_dwordx4 v2, s[8:11], s24 offen offset:3072 sc1 lds
  s_add_u32 m0, m0, 4096
  s_add_u32 s24, s24, 4096
  buffer_load_dwordx4 v2, s[8:11], s24 offen offset:0 sc1 lds
  buffer_load_dwordx4 v2, s[8:11], s24 offen offset:1024 sc1 lds
  buffer_load_dwordx4 v2, s[8:11], s24 offen offset:2048 sc1 lds
  v_add_u32 v5, s32, v2
  ds_read_b128 v[8:11], v5 offset:0
  ds_read_b128 v[12:15], v5 offset:14336
  ds_read_b128 v[16:19], v5 offset:1024
  ds_read_b128 v[20:23], v5 offset:15360
  ds_read_b128 v[24:27], v5 offset:2048
  ds_read_b128 v[28:31], v5 offset:16384
  ds_read_b128 v[32:35], v5 offset:3072
  s_waitcnt lgkmcnt(6)
  v_mfma_f32_16x16x32_bf16 v[40:43], a[0:3], v[8:11], 0
  v_mfma_f32_16x16x32_bf16 v[44:47], a[56:59], v[8:11], 0
  ds_read_b128 v[36:39], v5 offset:17408
  s_waitcnt lgkmcnt(6)
  v_mfma_f32_16x16x32_bf16 v[56:59], a[0:3], v[12:15], 0
  v_mfma_f32_16x16x32_bf16 v[60:63], a[56:59], v[12:15], 0
  ds_read_b128 v[8:11], v5 offset:4096
  s_waitcnt lgkmcnt(6)
  v_mfma_f32_16x16x32_bf16 v[40:43], a[4:7], v[16:19], v[40:43]
  v_mfma_f32_16x16x32_bf16 v[44:47], a[60:63], v[16:19], v[44:47]
  ds_read_b128 v[12:15], v5 offset:18432
  s_waitcnt lgkmcnt(6)
  v_mfma_f32_16x16x32_bf16 v[56:59], a[4:7], v[20:23], v[56:59]
  v_mfma_f32_16x16x32_bf16 v[60:63], a[60:63], v[20:23], v[60:63]
  ds_read_b128 v[16:19], v5 offset:5120
  s_waitcnt lgkmcnt(6)
  v_mfma_f32_16x16x32_bf16 v[40:43], a[8:11], v[24:27], v[40:43]
  v_mfma_f32_16x16x32_bf16 v[44:47], a[64:67], v[24:27], v[44:47]
  ds_read_b128 v[20:23], v5 offset:19456
  s_waitcnt lgkmcnt(6)
  v_mfma_f32_16x16x32_bf16 v[56:59], a[8:11], v[28:31], v[56:59]
  v_mfma_f32_16x16x32_bf16 v[60:63], a[64:67], v[28:31], v[60:63]
  ds_read_b128 v[24:27], v5 offset:6144
  s_waitcnt lgkmcnt(6)
  v_mfma_f32_16x16x32_bf16 v[40:43], a[12:15], v[32:35], v[40:43]
  v_mfma_f32_16x16x32_bf16 v[44:47], a[68:71], v[32:35], v[44:47]
  ds_read_b128 v[28:31], v5 offset:20480
  s_waitcnt lgkmcnt(6)
  v_mfma_f32_16x16x32_bf16 v[56:59], a[12:15], v[36:39], v[56:59]
  v_mfma_f32_16x16x32_bf16 v[60:63], a[68:71], v[36:39], v[60:63]
  ds_read_b128 v[32:35], v5 offset:7168
  s_waitcnt lgkmcnt(6)
  v_mfma_f32_16x16x32_bf16 v[40:43], a[16:19], v[8:11], v[40:43]
  v_mfma_f32_16x16x32_bf16 v[44:47], a[72:75], v[8:11], v[44:47]
  ds_read_b128 v[36:39], v5 offset:21504
  s_waitcnt lgkmcnt(6)
  v_mfma_f32_16x16x32_bf16 v[56:59], a[16:19], v[12:15], v[56:59]
  v_mfma_f32_16x16x32_bf16 v[60:63], a[72:75], v[12:15], v[60:63]
  ds_read_b128 v[8:11], v5 offset:8192
  s_waitcnt lgkmcnt(6)
  v_mfma_f32_16x16x32_bf16 v[40:43], a[20:23], v[16:19], v[40:43]
  v_mfma_f32_16x16x32_bf16 v[44:47], a[76:79], v[16:19], v[44:47]
  ds_read_b128 v[12:15], v5 offset:22528
  s_waitcnt lgkmcnt(6)
  v_mfma_f32_16x16x32_bf16 v[56:59], a[20:23], v[20:23], v[56:59]
  v_mfma_f32_16x16x32_bf16 v[60:63], a[76:79], v[20:23], v[60:63]
  ds_read_b128 v[16:19], v5 offset:9216
  s_waitcnt lgkmcnt(6)
  v_mfma_f32_16x16x32_bf16 v[40:43], a[24:27], v[24:27], v[40:43]
  v_mfma_f32_16x16x32_bf16 v[44:47], a[80:83], v[24:27], v[44:47]
  ds_read_b128 v[20:23], v5 offset:23552
  s_waitcnt lgkmcnt(6)
  v_mfma_f32_16x16x32_bf16 v[56:59], a[24:27], v[28:31], v[56:59]
  v_mfma_f32_16x16x32_bf16 v[60:63], a[80:83], v[28:31], v[60:63]
  ds_read_b128 v[24:27], v5 offset:10240
  s_waitcnt lgkmcnt(6)
  v_mfma_f32_16x16x32_bf16 v[40:43], a[28:31], v[32:35], v[40:43]
  v_mfma_f32_16x16x32_bf16 v[44:47], a[84:87], v[32:35], v[44:47]
  ds_read_b128 v[28:31], v5 offset:24576
  s_waitcnt lgkmcnt(6)
  v_mfma_f32_16x16x32_bf16 v[56:59], a[28:31], v[36:39], v[56:59]
  v_mfma_f32_16x16x32_bf16 v[60:63], a[84:87], v[36:39], v[60:63]
  ds_read_b128 v[32:35], v5 offset:11264
  s_waitcnt lgkmcnt(6)
  v_mfma_f32_16x16x32_bf16 v[40:43], a[32:35], v[8:11], v[40:43]
  v_mfma_f32_16x16x32_bf16 v[44:47], a[88:91], v[8:11], v[44:47]
  ds_read_b128 v[36:39], v5 offset:25600
  s_waitcnt lgkmcnt(6)
  v_mfma_f32_16x16x32_bf16 v[56:59], a[32:35], v[12:15], v[56:59]
  v_mfma_f32_16x16x32_bf16 v[60:63], a[88:91], v[12:15], v[60:63]
  ds_read_b128 v[8:11], v5 offset:12288
  s_waitcnt lgkmcnt(6)
  v_mfma_f32_16x16x32_bf16 v[40:43], a[36:39], v[16:19], v[40:43]
  v_mfma_f32_16x16x32_bf16 v[44:47], a[92:95], v[16:19], v[44:47]
  ds_read_b128 v[12:15], v5 offset:26624
  s_waitcnt lgkmcnt(6)
  v_mfma_f32_16x16x32_bf16 v[56:59], a[36:39], v[20:23], v[56:59]
  v_mfma_f32_16x16x32_bf16 v[60:63], a[92:95], v[20:23], v[60:63]
  ds_read_b128 v[16:19], v5 offset:13312
  s_waitcnt lgkmcnt(6)
  v_mfma_f32_16x16x32_bf16 v[40:43], a[40:43], v[24:27], v[40:43]
  v_mfma_f32_16x16x32_bf16 v[44:47], a[96:99], v[24:27], v[44:47]
  ds_read_b128 v[20:23], v5 offset:27648
  s_waitcnt lgkmcnt(6)
  v_mfma_f32_16x16x32_bf16 v[56:59], a[40:43], v[28:31], v[56:59]
  v_mfma_f32_16x16x32_bf16 v[60:63], a[96:99], v[28:31], v[60:63]
  s_waitcnt lgkmcnt(5)
  v_mfma_f32_16x16x32_bf16 v[40:43], a[44:47], v[32:35], v[40:43]
  v_mfma_f32_16x16x32_bf16 v[44:47], a[100:103], v[32:35], v[44:47]
  s_waitcnt lgkmcnt(4)
  v_mfma_f32_16x16x32_bf16 v[56:59], a[44:47], v[36:39], v[56:59]
  v_mfma_f32_16x16x32_bf16 v[60:63], a[100:103], v[36:39], v[60:63]
  s_waitcnt lgkmcnt(3)
  v_mfma_f32_16x16x32_bf16 v[40:43], a[48:51], v[8:11], v[40:43]
  v_mfma_f32_16x16x32_bf16 v[44:47], a[104:107], v[8:11], v[44:47]
  s_waitcnt lgkmcnt(2)
  v_mfma_f32_16x16x32_bf16 v[56:59], a[48:51], v[12:15], v[56:59]
  v_mfma_f32_16x16x32_bf16 v[60:63], a[104:107], v[12:15], v[60:63]
  s_waitcnt lgkmcnt(1)
  v_mfma_f32_16x16x32_bf16 v[40:43], a[52:55], v[16:19], v[40:43]
  v_mfma_f32_16x16x32_bf16 v[44:47], a[108:111], v[16:19], v[44:47]
  s_waitcnt lgkmcnt(0)
  v_mfma_f32_16x16x32_bf16 v[56:59], a[52:55], v[20:23], v[56:59]
  v_mfma_f32_16x16x32_bf16 v[60:63], a[108:111], v[20:23], v[60:63]
  s_add_u32 s25, s29, 28672
  s_lshl_b32 s24, s19, 5
  s_add_u32 s24, s24, 0
  v_add_u32 v88, s24, v4
  s_cmp_lt_u32 s19, 8
  s_cselect_b64 vcc, -1, 0
  s_cselect_b32 s24, 0, 256
  v_subrev_u32 v88, s24, v88
  s_movk_i32 s24, 5462
  s_cselect_b32 s24, 4096, s24
  v_mul_u32_u24 v89, s24, v88
  v_lshrrev_b32 v89, 16, v89
  s_movk_i32 s24, 100
  s_cselect_b32 s24, 96, s24
  v_mul_u32_u24 v89, s24, v89
  v_cndmask_b32 v92, v7, v6, vcc
  v_add3_u32 v88, v88, v89, v92
  v_lshlrev_b32 v90, 4, v88
  v_cvt_pk_bf16_f32 v72, v40, v41
  v_cvt_pk_bf16_f32 v73, v42, v43
  v_cvt_pk_bf16_f32 v74, v44, v45
  v_cvt_pk_bf16_f32 v75, v46, v47
  buffer_store_dwordx4 v[72:75], v90, s[8:11], s29 offen sc1
  s_lshl_b32 s24, s19, 5
  s_add_u32 s24, s24, 16
  v_add_u32 v88, s24, v4
  s_cmp_lt_u32 s19, 8
  s_cselect_b64 vcc, -1, 0
  s_cselect_b32 s24, 0, 256
  v_subrev_u32 v88, s24, v88
  s_movk_i32 s24, 5462
  s_cselect_b32 s24, 4096, s24
  v_mul_u32_u24 v89, s24, v88
  v_lshrrev_b32 v89, 16, v89
  s_movk_i32 s24, 100
  s_cselect_b32 s24, 96, s24
  v_mul_u32_u24 v89, s24, v89
  v_cndmask_b32 v92, v7, v6, vcc
  v_add3_u32 v88, v88, v89, v92
  v_lshlrev_b32 v91, 4, v88
  v_cvt_pk_bf16_f32 v80, v56, v57
  v_cvt_pk_bf16_f32 v81, v58, v59
  v_cvt_pk_bf16_f32 v82, v60, v61
  v_cvt_pk_bf16_f32 v83, v62, v63
  buffer_store_dwordx4 v[80:83], v91, s[8:11], s29 offen sc1
  s_mov_b32 s33, s32
  s_add_u32 s32, s32, 28672
  s_cmp_eq_u32 s32, 86016
  s_cselect_b32 s32, 0, s32
  s_add_u32 s19, s19, 1
  s_cmp_lt_u32 s19, s35
  s_cbranch_scc1 wf_vo_loop
  s_branch wf_done
wf_done:
  s_lshr_b32 s20, s18, 1
  s_lshl_b32 s20, s20, 4
  s_and_b32 s21, s17, 15
  s_add_u32 s20, s20, s21
  s_lshl_b32 s20, s20, 7
  s_cmp_lt_u32 s17, 16
  s_cselect_b32 s21, 16384, 0
  s_add_u32 s20, s20, s21
  s_add_u32 s20, s20, 88541184
  s_sub_u32 s21, s35, s34
  s_lshr_b32 s21, s21, 1
  v_mov_b32 v5, s21
  v_mov_b32 v6, 0
  s_waitcnt vmcnt(0)
  s_mov_b64 exec, 1
  s_cmp_lg_u32 s18, 0
  s_cbranch_scc1 wf_h1
  v_mov_b32 v7, 2
  s_sub_u32 s21, s20, 2048
  buffer_atomic_add v7, v6, s[8:11], s21 offen
wf_h1:
  buffer_atomic_add v5, v6, s[8:11], s20 offen
  s_mov_b64 exec, -1
  s_load_dwordx8 s[36:43], s[0:1], 56
  s_load_dwordx4 s[44:47], s[0:1], 88
  s_waitcnt lgkmcnt(0)
  s_mov_b32 s52, s36
  s_and_b32 s53, s37, 0xffff
  s_mov_b32 s54, 1835008
  s_mov_b32 s55, 0x20000
  s_lshl_b32 s20, s3, 8
  v_add_u32 v95, s20, v0
  s_mov_b32 s21, 9586981
  v_mul_hi_u32 v6, v95, s21
  v_mul_u32_u24 v7, 448, v6
  v_sub_u32 v7, v95, v7
  v_lshrrev_b32 v8, 4, v7
  v_and_b32 v7, 15, v7
  v_lshl_add_u32 v9, v6, 4, v7
  v_mul_u32_u24 v9, 896, v9
  v_lshl_add_u32 v9, v8, 5, v9
  buffer_load_dwordx4 v[84:87], v9, s[52:55], 0 offen
  buffer_load_dwordx4 v[88:91], v9, s[52:55], 0 offen offset:16
  v_mul_u32_u24 v6, 14336, v6
  v_lshl_add_u32 v6, v7, 4, v6
  v_lshl_add_u32 v92, v8, 9, v6
  v_lshrrev_b32 v7, 2, v8
  v_lshl_add_u32 v6, v7, 11, v6
  v_and_b32 v7, 3, v8
  v_lshl_add_u32 v93, v7, 8, v6
  v_mov_b32 v52, -1
  v_mov_b32 v53, -1
  v_mov_b32 v54, -1
  v_mov_b32 v55, -1
  s_mov_b32 s23, 89067520
  v_lshlrev_b32 v8, 4, v95
  buffer_store_dwordx4 v[52:55], v8, s[8:11], s23 offen sc1
  v_add_u32 v8, 917504, v8
  v_mov_b32 v9, 0x10000000
  v_cmp_lt_u32 vcc, 1535, v95
  s_nop 1
  v_cndmask_b32 v8, v8, v9, vcc
  buffer_store_dwordx4 v[52:55], v8, s[8:11], s23 offen sc1
  s_waitcnt vmcnt(1)
  v_mov_b32 v96, v84
  v_mov_b32 v100, v85
  v_mov_b32 v97, v86
  v_mov_b32 v101, v87
  v_mov_b32 v98, v88
  v_mov_b32 v102, v89
  v_mov_b32 v99, v90
  v_mov_b32 v103, v91
  s_mov_b32 s20, 71565312
  s_mov_b32 s21, 73400320
  buffer_store_dwordx4 v[96:99], v93, s[8:11], s21 offen sc1
  buffer_store_dwordx4 v[100:103], v93, s[8:11], s21 offen offset:1024 sc1
  s_cmp_lt_u32 s3, 70
  s_cbranch_scc1 i2_nx
  buffer_store_dwordx4 v[84:87], v92, s[8:11], s20 offen sc1
  buffer_store_dwordx4 v[88:91], v92, s[8:11], s20 offen offset:256 sc1
i2_nx:
  s_lshl_b32 s20, s3, 3
  s_add_u32 s20, s20, 88641536
  s_waitcnt vmcnt(0)
  s_barrier
  s_cmp_lg_u32 s16, 0
  s_cbranch_scc1 pub_46
  v_mul_u32_u24 v26, 2048, v1
  v_mov_b32 v24, s88
  v_mov_b32 v25, s89
  s_mov_b64 exec, 255
  buffer_store_dwordx2 v[24:25], v26, s[8:11], s20 offen sc1
  s_mov_b64 exec, -1
pub_46:
  s_branch wk_loop
wk_v7:
  s_sub_u32 s20, s3, 256
  s_mov_b32 s18, 1
  s_and_b32 s17, s20, 15
  s_add_u32 s17, s17, 16
  s_lshr_b32 s34, s20, 4
  s_lshl_b32 s34, s34, 1
  s_add_u32 s35, s34, 2
  s_branch wk_gemm
wk_vh:
  s_sub_u32 s20, s3, 368
  s_and_b32 s17, s20, 15
  s_add_u32 s17, s17, 16
  s_lshr_b32 s18, s20, 5
  s_add_u32 s18, s18, 2
  s_bitcmp1_b32 s20, 4
  s_cselect_b32 s34, 7, 0
  s_add_u32 s35, s34, 7
  s_branch wk_gemm
wk_vf:
  s_cmp_lg_u32 s16, 0
  s_cbranch_scc1 w0_47
  s_getreg_b32 s20, hwreg(HW_REG_XCC_ID)
  s_sub_u32 s20, s20, 1
  s_and_b32 s20, s20, 7
  s_mov_b64 exec, 1
vx_l:
  s_cmp_ge_u32 s20, 8
  s_cselect_b32 s20, 0, s20
  s_lshl_b32 s21, s20, 7
  s_add_u32 s21, s21, 88600576
  v_mov_b32 v242, 1
  buffer_atomic_add v242, off, s[8:11], s21 sc0
  s_waitcnt vmcnt(0)
  v_readfirstlane_b32 s21, v242
  s_lshl_b32 s22, s20, 3
  s_add_u32 s20, s20, 1
  s_cmp_ge_u32 s21, 8
  s_cbranch_scc1 vx_l
  v_add_u32 v242, s22, v242
  s_mov_b64 exec, -1
w0_47:
  v_mov_b32 v243, 160000
  s_add_u32 s101, s101, 1
  s_barrier
  s_mov_b64 exec, 1
  s_cmp_lg_u32 s16, 0
  s_cbranch_scc1 w0_48
  ds_write_b32 v243, v242 offset:0
  s_waitcnt lgkmcnt(0)
  v_mov_b32 v242, s101
  ds_write_b32 v243, v242 offset:16
  s_waitcnt lgkmcnt(0)
w0_48:
  s_mov_b64 exec, -1
  s_barrier
  ds_read_b32 v242, v243 offset:0
  ds_read_b32 v243, v243 offset:16
  s_waitcnt lgkmcnt(0)
  v_readfirstlane_b32 s3, v242
  v_cmp_ne_u32 vcc, s101, v243
  s_cbranch_vccnz ch_end
  s_lshr_b32 s17, s3, 2
  s_and_b32 s18, s3, 3
  s_add_u32 s17, s17, 16
  s_add_u32 s18, s18, 4
  s_mov_b32 s34, 0
  s_mov_b32 s35, 14
  s_branch wk_gemm
wk_f:
  s_cmp_lg_u32 s16, 0
  s_cbranch_scc1 w0_49
  s_getreg_b32 s20, hwreg(HW_REG_XCC_ID)
  s_sub_u32 s20, s20, 1
  s_and_b32 s20, s20, 7
  s_mov_b64 exec, 1
fx_l:
  s_cmp_ge_u32 s20, 8
  s_cselect_b32 s20, 0, s20
  s_lshl_b32 s21, s20, 7
  s_add_u32 s21, s21, 88601600
  v_mov_b32 v242, 1
  buffer_atomic_add v242, off, s[8:11], s21 sc0
  s_waitcnt vmcnt(0)
  v_readfirstlane_b32 s21, v242
  s_lshl_b32 s22, s20, 4
  s_add_u32 s20, s20, 1
  s_cmp_ge_u32 s21, 16
  s_cbranch_scc1 fx_l
  v_add_u32 v242, s22, v242
  s_mov_b64 exec, -1
w0_49:
  v_mov_b32 v243, 160000
  s_add_u32 s101, s101, 1
  s_barrier
  s_mov_b64 exec, 1
  s_cmp_lg_u32 s16, 0
  s_cbranch_scc1 w0_50
  ds_write_b32 v243, v242 offset:0
  s_waitcnt lgkmcnt(0)
  v_mov_b32 v242, s101
  ds_write_b32 v243, v242 offset:16
  s_waitcnt lgkmcnt(0)
w0_50:
  s_mov_b64 exec, -1
  s_barrier
  ds_read_b32 v242, v243 offset:0
  ds_read_b32 v243, v243 offset:16
  s_waitcnt lgkmcnt(0)
  v_readfirstlane_b32 s3, v242
  v_cmp_ne_u32 vcc, s101, v243
  s_cbranch_vccnz ch_end
  s_lshr_b32 s17, s3, 3
  s_and_b32 s18, s3, 7
  s_mov_b32 s34, 0
  s_mov_b32 s35, 14
  s_lshl_b32 s22, s17, 7
  s_add_u32 s22, s22, 88637440
  s_add_u32 s23, s22, 2048
  v_min_u32 v24, 48, v2
  v_min_u32 v25, 96, v2
  s_mov_b32 s30, 0
wk_aw:
  buffer_load_dwordx4 v[28:31], v24, s[8:11], s22 offen sc1
  buffer_load_dwordx4 v[32:35], v25, s[8:11], s23 offen sc1
  s_waitcnt vmcnt(0)
  v_cmp_ne_u64 vcc, s[88:89], v[28:29]
  s_cbranch_vccnz wk_aw_no
  v_cmp_ne_u64 vcc, s[88:89], v[30:31]
  s_cbranch_vccnz wk_aw_no
  v_cmp_ne_u64 vcc, s[88:89], v[32:33]
  s_cbranch_vccnz wk_aw_no
  v_cmp_ne_u64 vcc, s[88:89], v[34:35]
  s_cbranch_vccnz wk_aw_no
  s_branch wk_aw_ok
wk_aw_no:
  s_sleep 6
  s_add_u32 s30, s30, 1
  s_cmp_lt_u32 s30, 50000
  s_cbranch_scc1 wk_aw
  s_branch cA_abort
wk_aw_ok:
wk_gemm:
  s_lshl_b32 s20, s18, 4
  s_lshl_b32 s21, s16, 2
  s_add_u32 s20, s20, s21
  s_mul_i32 s21, s20, 14336
  s_add_u32 s21, s21, 71565312
  s_add_u32 s22, s21, 0
  buffer_load_dwordx4 a[0:3], v2, s[8:11], s22 offen offset:0 sc1
  buffer_load_dwordx4 a[4:7], v2, s[8:11], s22 offen offset:1024 sc1
  buffer_load_dwordx4 a[8:11], v2, s[8:11], s22 offen offset:2048 sc1
  buffer_load_dwordx4 a[12:15], v2, s[8:11], s22 offen offset:3072 sc1
  s_add_u32 s22, s21, 4096
  buffer_load_dwordx4 a[16:19], v2, s[8:11], s22 offen offset:0 sc1
  buffer_load_dwordx4 a[20:23], v2, s[8:11], s22 offen offset:1024 sc1
  buffer_load_dwordx4 a[24:27], v2, s[8:11], s22 offen offset:2048 sc1
  buffer_load_dwordx4 a[28:31], v2, s[8:11], s22 offen offset:3072 sc1
  s_add_u32 s22, s21, 8192
  buffer_load_dwordx4 a[32:35], v2, s[8:11], s22 offen offset:0 sc1
  buffer_load_dwordx4 a[36:39], v2, s[8:11], s22 offen offset:1024 sc1
  buffer_load_dwordx4 a[40:43], v2, s[8:11], s22 offen offset:2048 sc1
  buffer_load_dwordx4 a[44:47], v2, s[8:11], s22 offen offset:3072 sc1
  s_add_u32 s22, s21, 12288
  buffer_load_dwordx4 a[48:51], v2, s[8:11], s22 offen offset:0 sc1
  buffer_load_dwordx4 a[52:55], v2, s[8:11], s22 offen offset:1024 sc1
  buffer_load_dwordx4 a[56:59], v2, s[8:11], s22 offen offset:2048 sc1
  buffer_load_dwordx4 a[60:63], v2, s[8:11], s22 offen offset:3072 sc1
  s_add_u32 s22, s21, 16384
  buffer_load_dwordx4 a[64:67], v2, s[8:11], s22 offen offset:0 sc1
  buffer_load_dwordx4 a[68:71], v2, s[8:11], s22 offen offset:1024 sc1
  buffer_load_dwordx4 a[72:75], v2, s[8:11], s22 offen offset:2048 sc1
  buffer_load_dwordx4 a[76:79], v2, s[8:11], s22 offen offset:3072 sc1
  s_add_u32 s22, s21, 20480
  buffer_load_dwordx4 a[80:83], v2, s[8:11], s22 offen offset:0 sc1
  buffer_load_dwordx4 a[84:87], v2, s[8:11], s22 offen offset:1024 sc1
  buffer_load_dwordx4 a[88:91], v2, s[8:11], s22 offen offset:2048 sc1
  buffer_load_dwordx4 a[92:95], v2, s[8:11], s22 offen offset:3072 sc1
  s_add_u32 s22, s21, 24576
  buffer_load_dwordx4 a[96:99], v2, s[8:11], s22 offen offset:0 sc1
  buffer_load_dwordx4 a[100:103], v2, s[8:11], s22 offen offset:1024 sc1
  buffer_load_dwordx4 a[104:107], v2, s[8:11], s22 offen offset:2048 sc1
  buffer_load_dwordx4 a[108:111], v2, s[8:11], s22 offen offset:3072 sc1
  s_add_u32 s22, s21, 28672
  buffer_load_dwordx4 a[112:115], v2, s[8:11], s22 offen offset:0 sc1
  buffer_load_dwordx4 a[116:119], v2, s[8:11], s22 offen offset:1024 sc1
  buffer_load_dwordx4 a[120:123], v2, s[8:11], s22 offen offset:2048 sc1
  buffer_load_dwordx4 a[124:127], v2, s[8:11], s22 offen offset:3072 sc1
  s_add_u32 s22, s21, 32768
  buffer_load_dwordx4 a[128:131], v2, s[8:11], s22 offen offset:0 sc1
  buffer_load_dwordx4 a[132:135], v2, s[8:11], s22 offen offset:1024 sc1
  buffer_load_dwordx4 a[136:139], v2, s[8:11], s22 offen offset:2048 sc1
  buffer_load_dwordx4 a[140:143], v2, s[8:11], s22 offen offset:3072 sc1
  s_add_u32 s22, s21, 36864
  buffer_load_dwordx4 a[144:147], v2, s[8:11], s22 offen offset:0 sc1
  buffer_load_dwordx4 a[148:151], v2, s[8:11], s22 offen offset:1024 sc1
  buffer_load_dwordx4 a[152:155], v2, s[8:11], s22 offen offset:2048 sc1
  buffer_load_dwordx4 a[156:159], v2, s[8:11], s22 offen offset:3072 sc1
  s_add_u32 s22, s21, 40960
  buffer_load_dwordx4 a[160:163], v2, s[8:11], s22 offen offset:0 sc1
  buffer_load_dwordx4 a[164:167], v2, s[8:11], s22 offen offset:1024 sc1
  buffer_load_dwordx4 a[168:171], v2, s[8:11], s22 offen offset:2048 sc1
  buffer_load_dwordx4 a[172:175], v2, s[8:11], s22 offen offset:3072 sc1
  s_add_u32 s22, s21, 45056
  buffer_load_dwordx4 a[176:179], v2, s[8:11], s22 offen offset:0 sc1
  buffer_load_dwordx4 a[180:183], v2, s[8:11], s22 offen offset:1024 sc1
  buffer_load_dwordx4 a[184:187], v2, s[8:11], s22 offen offset:2048 sc1
  buffer_load_dwordx4 a[188:191], v2, s[8:11], s22 offen offset:3072 sc1
  s_add_u32 s22, s21, 49152
  buffer_load_dwordx4 a[192:195], v2, s[8:11], s22 offen offset:0 sc1
  buffer_load_dwordx4 a[196:199], v2, s[8:11], s22 offen offset:1024 sc1
  buffer_load_dwordx4 a[200:203], v2, s[8:11], s22 offen offset:2048 sc1
  buffer_load_dwordx4 a[204:207], v2, s[8:11], s22 offen offset:3072 sc1
  s_add_u32 s22, s21, 53248
  buffer_load_dwordx4 a[208:211], v2, s[8:11], s22 offen offset:0 sc1
  buffer_load_dwordx4 a[212:215], v2, s[8:11], s22 offen offset:1024 sc1
  buffer_load_dwordx4 a[216:219], v2, s[8:11], s22 offen offset:2048 sc1
  buffer_load_dwordx4 a[220:223], v2, s[8:11], s22 offen offset:3072 sc1
  s_waitcnt vmcnt(40)
  s_mul_i32 s23, s17, 401408
  s_and_b32 s22, s16, 1
  s_mul_i32 s22, s22, 7168
  s_add_u32 s23, s23, s22
  s_add_u32 s23, s23, 0
  s_lshr_b32 s22, s16, 1
  s_mul_i32 s22, s22, 14336
  s_add_u32 s23, s23, s22
  s_mul_i32 s27, s16, 7168
  s_lshr_b32 s28, s20, 1
  s_cmp_lt_u32 s17, 16
  s_cbranch_scc0 wg_vo
  s_add_u32 s23, s23, s22
  s_lshl_b32 s29, s28, 4
  s_add_u32 s29, s29, s17
  s_mul_i32 s29, s29, 28672
  s_add_u32 s29, s29, 12845056
  s_mov_b32 s31, 0
  s_lshr_b32 s24, s34, 1
  s_lshl_b32 s24, s24, 2
  s_and_b32 s25, s34, 1
  s_add_u32 s24, s24, s25
  s_mul_i32 s24, s24, 14336
  s_add_u32 s24, s24, s23
  s_cmp_lt_u32 s34, s35
  s_cselect_b32 s24, s24, 0x10000000
  s_add_u32 m0, s31, s27
  s_nop 0
  buffer_load_dwordx4 v2, s[8:11], s24 offen offset:0 sc1 lds
  buffer_load_dwordx4 v2, s[8:11], s24 offen offset:1024 sc1 lds
  buffer_load_dwordx4 v2, s[8:11], s24 offen offset:2048 sc1 lds
  buffer_load_dwordx4 v2, s[8:11], s24 offen offset:3072 sc1 lds
  s_add_u32 m0, m0, 4096
  s_add_u32 s24, s24, 4096
  buffer_load_dwordx4 v2, s[8:11], s24 offen offset:0 sc1 lds
  buffer_load_dwordx4 v2, s[8:11], s24 offen offset:1024 sc1 lds
  buffer_load_dwordx4 v2, s[8:11], s24 offen offset:2048 sc1 lds
  s_add_u32 s30, s34, 1
  s_mov_b32 s31, 28672
  s_lshr_b32 s24, s30, 1
  s_lshl_b32 s24, s24, 2
  s_and_b32 s25, s30, 1
  s_add_u32 s24, s24, s25
  s_mul_i32 s24, s24, 14336
  s_add_u32 s24, s24, s23
  s_cmp_lt_u32 s30, s35
  s_cselect_b32 s24, s24, 0x10000000
  s_add_u32 m0, s31, s27
  s_nop 0
  buffer_load_dwordx4 v2, s[8:11], s24 offen offset:0 sc1 lds
  buffer_load_dwordx4 v2, s[8:11], s24 offen offset:1024 sc1 lds
  buffer_load_dwordx4 v2, s[8:11], s24 offen offset:2048 sc1 lds
  buffer_load_dwordx4 v2, s[8:11], s24 offen offset:3072 sc1 lds
  s_add_u32 m0, m0, 4096
  s_add_u32 s24, s24, 4096
  buffer_load_dwordx4 v2, s[8:11], s24 offen offset:0 sc1 lds
  buffer_load_dwordx4 v2, s[8:11], s24 offen offset:1024 sc1 lds
  buffer_load_dwordx4 v2, s[8:11], s24 offen offset:2048 sc1 lds
  s_mov_b32 s19, s34
  s_mov_b32 s32, 0
  s_mov_b32 s33, 57344
  s_waitcnt vmcnt(7)
  s_branch wg_f_in
wg_f_loop:
  s_waitcnt vmcnt(11)
wg_f_in:
  s_barrier
  s_add_u32 s30, s19, 2
  s_lshr_b32 s24, s30, 1
  s_lshl_b32 s24, s24, 2
  s_and_b32 s25, s30, 1
  s_add_u32 s24, s24, s25
  s_mul_i32 s24, s24, 14336
  s_add_u32 s24, s24, s23
  s_cmp_lt_u32 s30, s35
  s_cselect_b32 s24, s24, 0x10000000
  s_add_u32 m0, s33, s27
  s_nop 0
  buffer_load_dwordx4 v2, s[8:11], s24 offen offset:0 sc1 lds
  buffer_load_dwordx4 v2, s[8:11], s24 offen offset:1024 sc1 lds
  buffer_load_dwordx4 v2, s[8:11], s24 offen offset:2048 sc1 lds
  buffer_load_dwordx4 v2, s[8:11], s24 offen offset:3072 sc1 lds
  s_add_u32 m0, m0, 4096
  s_add_u32 s24, s24, 4096
  buffer_load_dwordx4 v2, s[8:11], s24 offen offset:0 sc1 lds
  buffer_load_dwordx4 v2, s[8:11], s24 offen offset:1024 sc1 lds
  buffer_load_dwordx4 v2, s[8:11], s24 offen offset:2048 sc1 lds
  v_add_u32 v5, s32, v2
  ds_read_b128 v[8:11], v5 offset:0
  ds_read_b128 v[12:15], v5 offset:14336
  ds_read_b128 v[16:19], v5 offset:1024
  ds_read_b128 v[20:23], v5 offset:15360
  ds_read_b128 v[24:27], v5 offset:2048
  ds_read_b128 v[28:31], v5 offset:16384
  ds_read_b128 v[32:35], v5 offset:3072
  s_waitcnt lgkmcnt(6)
  v_mfma_f32_16x16x32_bf16 v[40:43], v[8:11], a[0:3], 0
  v_mfma_f32_16x16x32_bf16 v[44:47], v[8:11], a[56:59], 0
  v_mfma_f32_16x16x32_bf16 v[48:51], v[8:11], a[112:115], 0
  v_mfma_f32_16x16x32_bf16 v[52:55], v[8:11], a[168:171], 0
  ds_read_b128 v[36:39], v5 offset:17408
  s_waitcnt lgkmcnt(6)
  v_mfma_f32_16x16x32_bf16 v[56:59], v[12:15], a[0:3], 0
  v_mfma_f32_16x16x32_bf16 v[60:63], v[12:15], a[56:59], 0
  v_mfma_f32_16x16x32_bf16 v[64:67], v[12:15], a[112:115], 0
  v_mfma_f32_16x16x32_bf16 v[68:71], v[12:15], a[168:171], 0
  ds_read_b128 v[8:11], v5 offset:4096
  s_waitcnt lgkmcnt(6)
  v_mfma_f32_16x16x32_bf16 v[40:43], v[16:19], a[4:7], v[40:43]
  v_mfma_f32_16x16x32_bf16 v[44:47], v[16:19], a[60:63], v[44:47]
  v_mfma_f32_16x16x32_bf16 v[48:51], v[16:19], a[116:119], v[48:51]
  v_mfma_f32_16x16x32_bf16 v[52:55], v[16:19], a[172:175], v[52:55]
  ds_read_b128 v[12:15], v5 offset:18432
  s_waitcnt lgkmcnt(6)
  v_mfma_f32_16x16x32_bf16 v[56:59], v[20:23], a[4:7], v[56:59]
  v_mfma_f32_16x16x32_bf16 v[60:63], v[20:23], a[60:63], v[60:63]
  v_mfma_f32_16x16x32_bf16 v[64:67], v[20:23], a[116:119], v[64:67]
  v_mfma_f32_16x16x32_bf16 v[68:71], v[20:23], a[172:175], v[68:71]
  ds_read_b128 v[16:19], v5 offset:5120
  s_waitcnt lgkmcnt(6)
  v_mfma_f32_16x16x32_bf16 v[40:43], v[24:27], a[8:11], v[40:43]
  v_mfma_f32_16x16x32_bf16 v[44:47], v[24:27], a[64:67], v[44:47]
  v_mfma_f32_16x16x32_bf16 v[48:51], v[24:27], a[120:123], v[48:51]
  v_mfma_f32_16x16x32_bf16 v[52:55], v[24:27], a[176:179], v[52:55]
  ds_read_b128 v[20:23], v5 offset:19456
  s_waitcnt lgkmcnt(6)
  v_mfma_f32_16x16x32_bf16 v[56:59], v[28:31], a[8:11], v[56:59]
  v_mfma_f32_16x16x32_bf16 v[60:63], v[28:31], a[64:67], v[60:63]
  v_mfma_f32_16x16x32_bf16 v[64:67], v[28:31], a[120:123], v[64:67]
  v_mfma_f32_16x16x32_bf16 v[68:71], v[28:31], a[176:179], v[68:71]
  ds_read_b128 v[24:27], v5 offset:6144
  s_waitcnt lgkmcnt(6)
  v_mfma_f32_16x16x32_bf16 v[40:43], v[32:35], a[12:15], v[40:43]
  v_mfma_f32_16x16x32_bf16 v[44:47], v[32:35], a[68:71], v[44:47]
  v_mfma_f32_16x16x32_bf16 v[48:51], v[32:35], a[124:127], v[48:51]
  v_mfma_f32_16x16x32_bf16 v[52:55], v[32:35], a[180:183], v[52:55]
  ds_read_b128 v[28:31], v5 offset:20480
  s_waitcnt lgkmcnt(6)
  v_mfma_f32_16x16x32_bf16 v[56:59], v[36:39], a[12:15], v[56:59]
  v_mfma_f32_16x16x32_bf16 v[60:63], v[36:39], a[68:71], v[60:63]
  v_mfma_f32_16x16x32_bf16 v[64:67], v[36:39], a[124:127], v[64:67]
  v_mfma_f32_16x16x32_bf16 v[68:71], v[36:39], a[180:183], v[68:71]
  ds_read_b128 v[32:35], v5 offset:7168
  s_waitcnt lgkmcnt(6)
  v_mfma_f32_16x16x32_bf16 v[40:43], v[8:11], a[16:19], v[40:43]
  v_mfma_f32_16x16x32_bf16 v[44:47], v[8:11], a[72:75], v[44:47]
  v_mfma_f32_16x16x32_bf16 v[48:51], v[8:11], a[128:131], v[48:51]
  v_mfma_f32_16x16x32_bf16 v[52:55], v[8:11], a[184:187], v[52:55]
  ds_read_b128 v[36:39], v5 offset:21504
  s_waitcnt lgkmcnt(6)
  v_mfma_f32_16x16x32_bf16 v[56:59], v[12:15], a[16:19], v[56:59]
  v_mfma_f32_16x16x32_bf16 v[60:63], v[12:15], a[72:75], v[60:63]
  v_mfma_f32_16x16x32_bf16 v[64:67], v[12:15], a[128:131], v[64:67]
  v_mfma_f32_16x16x32_bf16 v[68:71], v[12:15], a[184:187], v[68:71]
  ds_read_b128 v[8:11], v5 offset:8192
  s_waitcnt lgkmcnt(6)
  v_mfma_f32_16x16x32_bf16 v[40:43], v[16:19], a[20:23], v[40:43]
  v_mfma_f32_16x16x32_bf16 v[44:47], v[16:19], a[76:79], v[44:47]
  v_mfma_f32_16x16x32_bf16 v[48:51], v[16:19], a[132:135], v[48:51]
  v_mfma_f32_16x16x32_bf16 v[52:55], v[16:19], a[188:191], v[52:55]
  ds_read_b128 v[12:15], v5 offset:22528
  s_waitcnt lgkmcnt(6)
  v_mfma_f32_16x16x32_bf16 v[56:59], v[20:23], a[20:23], v[56:59]
  v_mfma_f32_16x16x32_bf16 v[60:63], v[20:23], a[76:79], v[60:63]
  v_mfma_f32_16x16x32_bf16 v[64:67], v[20:23], a[132:135], v[64:67]
  v_mfma_f32_16x16x32_bf16 v[68:71], v[20:23], a[188:191], v[68:71]
  ds_read_b128 v[16:19], v5 offset:9216
  s_waitcnt lgkmcnt(6)
  v_mfma_f32_16x16x32_bf16 v[40:43], v[24:27], a[24:27], v[40:43]
  v_mfma_f32_16x16x32_bf16 v[44:47], v[24:27], a[80:83], v[44:47]
  v_mfma_f32_16x16x32_bf16 v[48:51], v[24:27], a[136:139], v[48:51]
  v_mfma_f32_16x16x32_bf16 v[52:55], v[24:27], a[192:195], v[52:55]
  ds_read_b128 v[20:23], v5 offset:23552
  s_waitcnt lgkmcnt(6)
  v_mfma_f32_16x16x32_bf16 v[56:59], v[28:31], a[24:27], v[56:59]
  v_mfma_f32_16x16x32_bf16 v[60:63], v[28:31], a[80:83], v[60:63]
  v_mfma_f32_16x16x32_bf16 v[64:67], v[28:31], a[136:139], v[64:67]
  v_mfma_f32_16x16x32_bf16 v[68:71], v[28:31], a[192:195], v[68:71]
  ds_read_b128 v[24:27], v5 offset:10240
  s_waitcnt lgkmcnt(6)
  v_mfma_f32_16x16x32_bf16 v[40:43], v[32:35], a[28:31], v[40:43]
  v_mfma_f32_16x16x32_bf16 v[44:47], v[32:35], a[84:87], v[44:47]
  v_mfma_f32_16x16x32_bf16 v[48:51], v[32:35], a[140:143], v[48:51]
  v_mfma_f32_16x16x32_bf16 v[52:55], v[32:35], a[196:199], v[52:55]
  ds_read_b128 v[28:31], v5 offset:24576
  s_waitcnt lgkmcnt(6)
  v_mfma_f32_16x16x32_bf16 v[56:59], v[36:39], a[28:31], v[56:59]
  v_mfma_f32_16x16x32_bf16 v[60:63], v[36:39], a[84:87], v[60:63]
  v_mfma_f32_16x16x32_bf16 v[64:67], v[36:39], a[140:143], v[64:67]
  v_mfma_f32_16x16x32_bf16 v[68:71], v[36:39], a[196:199], v[68:71]
  ds_read_b128 v[32:35], v5 offset:11264
  s_waitcnt lgkmcnt(6)
  v_mfma_f32_16x16x32_bf16 v[40:43], v[8:11], a[32:35], v[40:43]
  v_mfma_f32_16x16x32_bf16 v[44:47], v[8:11], a[88:91], v[44:47]
  v_mfma_f32_16x16x32_bf16 v[48:51], v[8:11], a[144:147], v[48:51]
  v_mfma_f32_16x16x32_bf16 v[52:55], v[8:11], a[200:203], v[52:55]
  ds_read_b128 v[36:39], v5 offset:25600
  s_waitcnt lgkmcnt(6)
  v_mfma_f32_16x16x32_bf16 v[56:59], v[12:15], a[32:35], v[56:59]
  v_mfma_f32_16x16x32_bf16 v[60:63], v[12:15], a[88:91], v[60:63]
  v_mfma_f32_16x16x32_bf16 v[64:67], v[12:15], a[144:147], v[64:67]
  v_mfma_f32_16x16x32_bf16 v[68:71], v[12:15], a[200:203], v[68:71]
  ds_read_b128 v[8:11], v5 offset:12288
  s_waitcnt lgkmcnt(6)
  v_mfma_f32_16x16x32_bf16 v[40:43], v[16:19], a[36:39], v[40:43]
  v_mfma_f32_16x16x32_bf16 v[44:47], v[16:19], a[92:95], v[44:47]
  v_mfma_f32_16x16x32_bf16 v[48:51], v[16:19], a[148:151], v[48:51]
  v_mfma_f32_16x16x32_bf16 v[52:55], v[16:19], a[204:207], v[52:55]
  ds_read_b128 v[12:15], v5 offset:26624
  s_waitcnt lgkmcnt(6)
  v_mfma_f32_16x16x32_bf16 v[56:59], v[20:23], a[36:39], v[56:59]
  v_mfma_f32_16x16x32_bf16 v[60:63], v[20:23], a[92:95], v[60:63]
  v_mfma_f32_16x16x32_bf16 v[64:67], v[20:23], a[148:151], v[64:67]
  v_mfma_f32_16x16x32_bf16 v[68:71], v[20:23], a[204:207], v[68:71]
  ds_read_b128 v[16:19], v5 offset:13312
  s_waitcnt lgkmcnt(6)
  v_mfma_f32_16x16x32_bf16 v[40:43], v[24:27], a[40:43], v[40:43]
  v_mfma_f32_16x16x32_bf16 v[44:47], v[24:27], a[96:99], v[44:47]
  v_mfma_f32_16x16x32_bf16 v[48:51], v[24:27], a[152:155], v[48:51]
  v_mfma_f32_16x16x32_bf16 v[52:55], v[24:27], a[208:211], v[52:55]
  ds_read_b128 v[20:23], v5 offset:27648
  s_waitcnt lgkmcnt(6)
  v_mfma_f32_16x16x32_bf16 v[56:59], v[28:31], a[40:43], v[56:59]
  v_mfma_f32_16x16x32_bf16 v[60:63], v[28:31], a[96:99], v[60:63]
  v_mfma_f32_16x16x32_bf16 v[64:67], v[28:31], a[152:155], v[64:67]
  v_mfma_f32_16x16x32_bf16 v[68:71], v[28:31], a[208:211], v[68:71]
  s_waitcnt lgkmcnt(5)
  v_mfma_f32_16x16x32_bf16 v[40:43], v[32:35], a[44:47], v[40:43]
  v_mfma_f32_16x16x32_bf16 v[44:47], v[32:35], a[100:103], v[44:47]
  v_mfma_f32_16x16x32_bf16 v[48:51], v[32:35], a[156:159], v[48:51]
  v_mfma_f32_16x16x32_bf16 v[52:55], v[32:35], a[212:215], v[52:55]
  s_waitcnt lgkmcnt(4)
  v_mfma_f32_16x16x32_bf16 v[56:59], v[36:39], a[44:47], v[56:59]
  v_mfma_f32_16x16x32_bf16 v[60:63], v[36:39], a[100:103], v[60:63]
  v_mfma_f32_16x16x32_bf16 v[64:67], v[36:39], a[156:159], v[64:67]
  v_mfma_f32_16x16x32_bf16 v[68:71], v[36:39], a[212:215], v[68:71]
  s_waitcnt lgkmcnt(3)
  v_mfma_f32_16x16x32_bf16 v[40:43], v[8:11], a[48:51], v[40:43]
  v_mfma_f32_16x16x32_bf16 v[44:47], v[8:11], a[104:107], v[44:47]
  v_mfma_f32_16x16x32_bf16 v[48:51], v[8:11], a[160:163], v[48:51]
  v_mfma_f32_16x16x32_bf16 v[52:55], v[8:11], a[216:219], v[52:55]
  s_waitcnt lgkmcnt(2)
  v_mfma_f32_16x16x32_bf16 v[56:59], v[12:15], a[48:51], v[56:59]
  v_mfma_f32_16x16x32_bf16 v[60:63], v[12:15], a[104:107], v[60:63]
  v_mfma_f32_16x16x32_bf16 v[64:67], v[12:15], a[160:163], v[64:67]
  v_mfma_f32_16x16x32_bf16 v[68:71], v[12:15], a[216:219], v[68:71]
  s_waitcnt lgkmcnt(1)
  v_mfma_f32_16x16x32_bf16 v[40:43], v[16:19], a[52:55], v[40:43]
  v_mfma_f32_16x16x32_bf16 v[44:47], v[16:19], a[108:111], v[44:47]
  v_mfma_f32_16x16x32_bf16 v[48:51], v[16:19], a[164:167], v[48:51]
  v_mfma_f32_16x16x32_bf16 v[52:55], v[16:19], a[220:223], v[52:55]
  s_waitcnt lgkmcnt(0)
  v_mfma_f32_16x16x32_bf16 v[56:59], v[20:23], a[52:55], v[56:59]
  v_mfma_f32_16x16x32_bf16 v[60:63], v[20:23], a[108:111], v[60:63]
  v_mfma_f32_16x16x32_bf16 v[64:67], v[20:23], a[164:167], v[64:67]
  v_mfma_f32_16x16x32_bf16 v[68:71], v[20:23], a[220:223], v[68:71]
  s_lshl_b32 s24, s19, 10
  s_add_u32 s24, s24, s29
  v_cvt_pk_bf16_f32 v72, v40, v41
  v_cvt_pk_bf16_f32 v73, v42, v43
  v_cvt_pk_bf16_f32 v74, v56, v57
  v_cvt_pk_bf16_f32 v75, v58, v59
  s_add_u32 s25, s24, 0
  buffer_store_dwordx4 v[72:75], v2, s[8:11], s25 offen sc1
  v_cvt_pk_bf16_f32 v76, v44, v45
  v_cvt_pk_bf16_f32 v77, v46, v47
  v_cvt_pk_bf16_f32 v78, v60, v61
  v_cvt_pk_bf16_f32 v79, v62, v63
  s_add_u32 s25, s24, 14336
  buffer_store_dwordx4 v[76:79], v2, s[8:11], s25 offen sc1
  v_cvt_pk_bf16_f32 v80, v48, v49
  v_cvt_pk_bf16_f32 v81, v50, v51
  v_cvt_pk_bf16_f32 v82, v64, v65
  v_cvt_pk_bf16_f32 v83, v66, v67
  s_add_u32 s25, s24, 458752
  buffer_store_dwordx4 v[80:83], v2, s[8:11], s25 offen sc1
  v_cvt_pk_bf16_f32 v84, v52, v53
  v_cvt_pk_bf16_f32 v85, v54, v55
  v_cvt_pk_bf16_f32 v86, v68, v69
  v_cvt_pk_bf16_f32 v87, v70, v71
  s_add_u32 s25, s24, 473088
  buffer_store_dwordx4 v[84:87], v2, s[8:11], s25 offen sc1
  s_mov_b32 s33, s32
  s_add_u32 s32, s32, 28672
  s_cmp_eq_u32 s32, 86016
  s_cselect_b32 s32, 0, s32
  s_add_u32 s19, s19, 1
  s_cmp_lt_u32 s19, s35
  s_cbranch_scc1 wg_f_loop
  s_branch wg_done
wg_vo:
  s_sub_u32 s29, s17, 16
  s_lshl_b32 s29, s29, 6
  s_add_u32 s29, s29, s28
  s_mul_i32 s29, s29, 28672
  s_add_u32 s29, s29, 42205184
  v_lshlrev_b32 v6, 4, v3
  v_mad_u32_u24 v7, v3, 12, 64
  s_mov_b32 s31, 0
  s_lshl_b32 s24, s34, 1
  s_mul_i32 s24, s24, 14336
  s_add_u32 s24, s24, s23
  s_cmp_lt_u32 s34, s35
  s_cselect_b32 s24, s24, 0x10000000
  s_add_u32 m0, s31, s27
  s_nop 0
  buffer_load_dwordx4 v2, s[8:11], s24 offen offset:0 sc1 lds
  buffer_load_dwordx4 v2, s[8:11], s24 offen offset:1024 sc1 lds
  buffer_load_dwordx4 v2, s[8:11], s24 offen offset:2048 sc1 lds
  buffer_load_dwordx4 v2, s[8:11], s24 offen offset:3072 sc1 lds
  s_add_u32 m0, m0, 4096
  s_add_u32 s24, s24, 4096
  buffer_load_dwordx4 v2, s[8:11], s24 offen offset:0 sc1 lds
  buffer_load_dwordx4 v2, s[8:11], s24 offen offset:1024 sc1 lds
  buffer_load_dwordx4 v2, s[8:11], s24 offen offset:2048 sc1 lds
  s_add_u32 s30, s34, 1
  s_mov_b32 s31, 28672
  s_lshl_b32 s24, s30, 1
  s_mul_i32 s24, s24, 14336
  s_add_u32 s24, s24, s23
  s_cmp_lt_u32 s30, s35
  s_cselect_b32 s24, s24, 0x10000000
  s_add_u32 m0, s31, s27
  s_nop 0
  buffer_load_dwordx4 v2, s[8:11], s24 offen offset:0 sc1 lds
  buffer_load_dwordx4 v2, s[8:11], s24 offen offset:1024 sc1 lds
  buffer_load_dwordx4 v2, s[8:11], s24 offen offset:2048 sc1 lds
  buffer_load_dwordx4 v2, s[8:11], s24 offen offset:3072 sc1 lds
  s_add_u32 m0, m0, 4096
  s_add_u32 s24, s24, 4096
  buffer_load_dwordx4 v2, s[8:11], s24 offen offset:0 sc1 lds
  buffer_load_dwordx4 v2, s[8:11], s24 offen offset:1024 sc1 lds
  buffer_load_dwordx4 v2, s[8:11], s24 offen offset:2048 sc1 lds
  s_mov_b32 s19, s34
  s_mov_b32 s32, 0
  s_mov_b32 s33, 57344
  s_waitcnt vmcnt(7)
  s_branch wg_vo_in
wg_vo_loop:
  s_waitcnt vmcnt(11)
wg_vo_in:
  s_barrier
  s_add_u32 s30, s19, 2
  s_lshl_b32 s24, s30, 1
  s_mul_i32 s24, s24, 14336
  s_add_u32 s24, s24, s23
  s_cmp_lt_u32 s30, s35
  s_cselect_b32 s24, s24, 0x10000000
  s_add_u32 m0, s33, s27
  s_nop 0
  buffer_load_dwordx4 v2, s[8:11], s24 offen offset:0 sc1 lds
  buffer_load_dwordx4 v2, s[8:11], s24 offen offset:1024 sc1 lds
  buffer_load_dwordx4 v2, s[8:11], s24 offen offset:2048 sc1 lds
  buffer_load_dwordx4 v2, s[8:11], s24 offen offset:3072 sc1 lds
  s_add_u32 m0, m0, 4096
  s_add_u32 s24, s24, 4096
  buffer_load_dwordx4 v2, s[8:11], s24 offen offset:0 sc1 lds
  buffer_load_dwordx4 v2, s[8:11], s24 offen offset:1024 sc1 lds
  buffer_load_dwordx4 v2, s[8:11], s24 offen offset:2048 sc1 lds
  v_add_u32 v5, s32, v2
  ds_read_b128 v[8:11], v5 offset:0
  ds_read_b128 v[12:15], v5 offset:14336
  ds_read_b128 v[16:19], v5 offset:1024
  ds_read_b128 v[20:23], v5 offset:15360
  ds_read_b128 v[24:27], v5 offset:2048
  ds_read_b128 v[28:31], v5 offset:16384
  ds_read_b128 v[32:35], v5 offset:3072
  s_waitcnt lgkmcnt(6)
  v_mfma_f32_16x16x32_bf16 v[40:43], a[0:3], v[8:11], 0
  v_mfma_f32_16x16x32_bf16 v[44:47], a[56:59], v[8:11], 0
  v_mfma_f32_16x16x32_bf16 v[48:51], a[112:115], v[8:11], 0
  v_mfma_f32_16x16x32_bf16 v[52:55], a[168:171], v[8:11], 0
  ds_read_b128 v[36:39], v5 offset:17408
  s_waitcnt lgkmcnt(6)
  v_mfma_f32_16x16x32_bf16 v[56:59], a[0:3], v[12:15], 0
  v_mfma_f32_16x16x32_bf16 v[60:63], a[56:59], v[12:15], 0
  v_mfma_f32_16x16x32_bf16 v[64:67], a[112:115], v[12:15], 0
  v_mfma_f32_16x16x32_bf16 v[68:71], a[168:171], v[12:15], 0
  ds_read_b128 v[8:11], v5 offset:4096
  s_waitcnt lgkmcnt(6)
  v_mfma_f32_16x16x32_bf16 v[40:43], a[4:7], v[16:19], v[40:43]
  v_mfma_f32_16x16x32_bf16 v[44:47], a[60:63], v[16:19], v[44:47]
  v_mfma_f32_16x16x32_bf16 v[48:51], a[116:119], v[16:19], v[48:51]
  v_mfma_f32_16x16x32_bf16 v[52:55], a[172:175], v[16:19], v[52:55]
  ds_read_b128 v[12:15], v5 offset:18432
  s_waitcnt lgkmcnt(6)
  v_mfma_f32_16x16x32_bf16 v[56:59], a[4:7], v[20:23], v[56:59]
  v_mfma_f32_16x16x32_bf16 v[60:63], a[60:63], v[20:23], v[60:63]
  v_mfma_f32_16x16x32_bf16 v[64:67], a[116:119], v[20:23], v[64:67]
  v_mfma_f32_16x16x32_bf16 v[68:71], a[172:175], v[20:23], v[68:71]
  ds_read_b128 v[16:19], v5 offset:5120
  s_waitcnt lgkmcnt(6)
  v_mfma_f32_16x16x32_bf16 v[40:43], a[8:11], v[24:27], v[40:43]
  v_mfma_f32_16x16x32_bf16 v[44:47], a[64:67], v[24:27], v[44:47]
  v_mfma_f32_16x16x32_bf16 v[48:51], a[120:123], v[24:27], v[48:51]
  v_mfma_f32_16x16x32_bf16 v[52:55], a[176:179], v[24:27], v[52:55]
  ds_read_b128 v[20:23], v5 offset:19456
  s_waitcnt lgkmcnt(6)
  v_mfma_f32_16x16x32_bf16 v[56:59], a[8:11], v[28:31], v[56:59]
  v_mfma_f32_16x16x32_bf16 v[60:63], a[64:67], v[28:31], v[60:63]
  v_mfma_f32_16x16x32_bf16 v[64:67], a[120:123], v[28:31], v[64:67]
  v_mfma_f32_16x16x32_bf16 v[68:71], a[176:179], v[28:31], v[68:71]
  ds_read_b128 v[24:27], v5 offset:6144
  s_waitcnt lgkmcnt(6)
  v_mfma_f32_16x16x32_bf16 v[40:43], a[12:15], v[32:35], v[40:43]
  v_mfma_f32_16x16x32_bf16 v[44:47], a[68:71], v[32:35], v[44:47]
  v_mfma_f32_16x16x32_bf16 v[48:51], a[124:127], v[32:35], v[48:51]
  v_mfma_f32_16x16x32_bf16 v[52:55], a[180:183], v[32:35], v[52:55]
  ds_read_b128 v[28:31], v5 offset:20480
  s_waitcnt lgkmcnt(6)
  v_mfma_f32_16x16x32_bf16 v[56:59], a[12:15], v[36:39], v[56:59]
  v_mfma_f32_16x16x32_bf16 v[60:63], a[68:71], v[36:39], v[60:63]
  v_mfma_f32_16x16x32_bf16 v[64:67], a[124:127], v[36:39], v[64:67]
  v_mfma_f32_16x16x32_bf16 v[68:71], a[180:183], v[36:39], v[68:71]
  ds_read_b128 v[32:35], v5 offset:7168
  s_waitcnt lgkmcnt(6)
  v_mfma_f32_16x16x32_bf16 v[40:43], a[16:19], v[8:11], v[40:43]
  v_mfma_f32_16x16x32_bf16 v[44:47], a[72:75], v[8:11], v[44:47]
  v_mfma_f32_16x16x32_bf16 v[48:51], a[128:131], v[8:11], v[48:51]
  v_mfma_f32_16x16x32_bf16 v[52:55], a[184:187], v[8:11], v[52:55]
  ds_read_b128 v[36:39], v5 offset:21504
  s_waitcnt lgkmcnt(6)
  v_mfma_f32_16x16x32_bf16 v[56:59], a[16:19], v[12:15], v[56:59]
  v_mfma_f32_16x16x32_bf16 v[60:63], a[72:75], v[12:15], v[60:63]
  v_mfma_f32_16x16x32_bf16 v[64:67], a[128:131], v[12:15], v[64:67]
  v_mfma_f32_16x16x32_bf16 v[68:71], a[184:187], v[12:15], v[68:71]
  ds_read_b128 v[8:11], v5 offset:8192
  s_waitcnt lgkmcnt(6)
  v_mfma_f32_16x16x32_bf16 v[40:43], a[20:23], v[16:19], v[40:43]
  v_mfma_f32_16x16x32_bf16 v[44:47], a[76:79], v[16:19], v[44:47]
  v_mfma_f32_16x16x32_bf16 v[48:51], a[132:135], v[16:19], v[48:51]
  v_mfma_f32_16x16x32_bf16 v[52:55], a[188:191], v[16:19], v[52:55]
  ds_read_b128 v[12:15], v5 offset:22528
  s_waitcnt lgkmcnt(6)
  v_mfma_f32_16x16x32_bf16 v[56:59], a[20:23], v[20:23], v[56:59]
  v_mfma_f32_16x16x32_bf16 v[60:63], a[76:79], v[20:23], v[60:63]
  v_mfma_f32_16x16x32_bf16 v[64:67], a[132:135], v[20:23], v[64:67]
  v_mfma_f32_16x16x32_bf16 v[68:71], a[188:191], v[20:23], v[68:71]
  ds_read_b128 v[16:19], v5 offset:9216
  s_waitcnt lgkmcnt(6)
  v_mfma_f32_16x16x32_bf16 v[40:43], a[24:27], v[24:27], v[40:43]
  v_mfma_f32_16x16x32_bf16 v[44:47], a[80:83], v[24:27], v[44:47]
  v_mfma_f32_16x16x32_bf16 v[48:51], a[136:139], v[24:27], v[48:51]
  v_mfma_f32_16x16x32_bf16 v[52:55], a[192:195], v[24:27], v[52:55]
  ds_read_b128 v[20:23], v5 offset:23552
  s_waitcnt lgkmcnt(6)
  v_mfma_f32_16x16x32_bf16 v[56:59], a[24:27], v[28:31], v[56:59]
  v_mfma_f32_16x16x32_bf16 v[60:63], a[80:83], v[28:31], v[60:63]
  v_mfma_f32_16x16x32_bf16 v[64:67], a[136:139], v[28:31], v[64:67]
  v_mfma_f32_16x16x32_bf16 v[68:71], a[192:195], v[28:31], v[68:71]
  ds_read_b128 v[24:27], v5 offset:10240
  s_waitcnt lgkmcnt(6)
  v_mfma_f32_16x16x32_bf16 v[40:43], a[28:31], v[32:35], v[40:43]
  v_mfma_f32_16x16x32_bf16 v[44:47], a[84:87], v[32:35], v[44:47]
  v_mfma_f32_16x16x32_bf16 v[48:51], a[140:143], v[32:35], v[48:51]
  v_mfma_f32_16x16x32_bf16 v[52:55], a[196:199], v[32:35], v[52:55]
  ds_read_b128 v[28:31], v5 offset:24576
  s_waitcnt lgkmcnt(6)
  v_mfma_f32_16x16x32_bf16 v[56:59], a[28:31], v[36:39], v[56:59]
  v_mfma_f32_16x16x32_bf16 v[60:63], a[84:87], v[36:39], v[60:63]
  v_mfma_f32_16x16x32_bf16 v[64:67], a[140:143], v[36:39], v[64:67]
  v_mfma_f32_16x16x32_bf16 v[68:71], a[196:199], v[36:39], v[68:71]
  ds_read_b128 v[32:35], v5 offset:11264
  s_waitcnt lgkmcnt(6)
  v_mfma_f32_16x16x32_bf16 v[40:43], a[32:35], v[8:11], v[40:43]
  v_mfma_f32_16x16x32_bf16 v[44:47], a[88:91], v[8:11], v[44:47]
  v_mfma_f32_16x16x32_bf16 v[48:51], a[144:147], v[8:11], v[48:51]
  v_mfma_f32_16x16x32_bf16 v[52:55], a[200:203], v[8:11], v[52:55]
  ds_read_b128 v[36:39], v5 offset:25600
  s_waitcnt lgkmcnt(6)
  v_mfma_f32_16x16x32_bf16 v[56:59], a[32:35], v[12:15], v[56:59]
  v_mfma_f32_16x16x32_bf16 v[60:63], a[88:91], v[12:15], v[60:63]
  v_mfma_f32_16x16x32_bf16 v[64:67], a[144:147], v[12:15], v[64:67]
  v_mfma_f32_16x16x32_bf16 v[68:71], a[200:203], v[12:15], v[68:71]
  ds_read_b128 v[8:11], v5 offset:12288
  s_waitcnt lgkmcnt(6)
  v_mfma_f32_16x16x32_bf16 v[40:43], a[36:39], v[16:19], v[40:43]
  v_mfma_f32_16x16x32_bf16 v[44:47], a[92:95], v[16:19], v[44:47]
  v_mfma_f32_16x16x32_bf16 v[48:51], a[148:151], v[16:19], v[48:51]
  v_mfma_f32_16x16x32_bf16 v[52:55], a[204:207], v[16:19], v[52:55]
  ds_read_b128 v[12:15], v5 offset:26624
  s_waitcnt lgkmcnt(6)
  v_mfma_f32_16x16x32_bf16 v[56:59], a[36:39], v[20:23], v[56:59]
  v_mfma_f32_16x16x32_bf16 v[60:63], a[92:95], v[20:23], v[60:63]
  v_mfma_f32_16x16x32_bf16 v[64:67], a[148:151], v[20:23], v[64:67]
  v_mfma_f32_16x16x32_bf16 v[68:71], a[204:207], v[20:23], v[68:71]
  ds_read_b128 v[16:19], v5 offset:13312
  s_waitcnt lgkmcnt(6)
  v_mfma_f32_16x16x32_bf16 v[40:43], a[40:43], v[24:27], v[40:43]
  v_mfma_f32_16x16x32_bf16 v[44:47], a[96:99], v[24:27], v[44:47]
  v_mfma_f32_16x16x32_bf16 v[48:51], a[152:155], v[24:27], v[48:51]
  v_mfma_f32_16x16x32_bf16 v[52:55], a[208:211], v[24:27], v[52:55]
  ds_read_b128 v[20:23], v5 offset:27648
  s_waitcnt lgkmcnt(6)
  v_mfma_f32_16x16x32_bf16 v[56:59], a[40:43], v[28:31], v[56:59]
  v_mfma_f32_16x16x32_bf16 v[60:63], a[96:99], v[28:31], v[60:63]
  v_mfma_f32_16x16x32_bf16 v[64:67], a[152:155], v[28:31], v[64:67]
  v_mfma_f32_16x16x32_bf16 v[68:71], a[208:211], v[28:31], v[68:71]
  s_waitcnt lgkmcnt(5)
  v_mfma_f32_16x16x32_bf16 v[40:43], a[44:47], v[32:35], v[40:43]
  v_mfma_f32_16x16x32_bf16 v[44:47], a[100:103], v[32:35], v[44:47]
  v_mfma_f32_16x16x32_bf16 v[48:51], a[156:159], v[32:35], v[48:51]
  v_mfma_f32_16x16x32_bf16 v[52:55], a[212:215], v[32:35], v[52:55]
  s_waitcnt lgkmcnt(4)
  v_mfma_f32_16x16x32_bf16 v[56:59], a[44:47], v[36:39], v[56:59]
  v_mfma_f32_16x16x32_bf16 v[60:63], a[100:103], v[36:39], v[60:63]
  v_mfma_f32_16x16x32_bf16 v[64:67], a[156:159], v[36:39], v[64:67]
  v_mfma_f32_16x16x32_bf16 v[68:71], a[212:215], v[36:39], v[68:71]
  s_waitcnt lgkmcnt(3)
  v_mfma_f32_16x16x32_bf16 v[40:43], a[48:51], v[8:11], v[40:43]
  v_mfma_f32_16x16x32_bf16 v[44:47], a[104:107], v[8:11], v[44:47]
  v_mfma_f32_16x16x32_bf16 v[48:51], a[160:163], v[8:11], v[48:51]
  v_mfma_f32_16x16x32_bf16 v[52:55], a[216:219], v[8:11], v[52:55]
  s_waitcnt lgkmcnt(2)
  v_mfma_f32_16x16x32_bf16 v[56:59], a[48:51], v[12:15], v[56:59]
  v_mfma_f32_16x16x32_bf16 v[60:63], a[104:107], v[12:15], v[60:63]
  v_mfma_f32_16x16x32_bf16 v[64:67], a[160:163], v[12:15], v[64:67]
  v_mfma_f32_16x16x32_bf16 v[68:71], a[216:219], v[12:15], v[68:71]
  s_waitcnt lgkmcnt(1)
  v_mfma_f32_16x16x32_bf16 v[40:43], a[52:55], v[16:19], v[40:43]
  v_mfma_f32_16x16x32_bf16 v[44:47], a[108:111], v[16:19], v[44:47]
  v_mfma_f32_16x16x32_bf16 v[48:51], a[164:167], v[16:19], v[48:51]
  v_mfma_f32_16x16x32_bf16 v[52:55], a[220:223], v[16:19], v[52:55]
  s_waitcnt lgkmcnt(0)
  v_mfma_f32_16x16x32_bf16 v[56:59], a[52:55], v[20:23], v[56:59]
  v_mfma_f32_16x16x32_bf16 v[60:63], a[108:111], v[20:23], v[60:63]
  v_mfma_f32_16x16x32_bf16 v[64:67], a[164:167], v[20:23], v[64:67]
  v_mfma_f32_16x16x32_bf16 v[68:71], a[220:223], v[20:23], v[68:71]
  s_add_u32 s25, s29, 28672
  s_lshl_b32 s24, s19, 5
  s_add_u32 s24, s24, 0
  v_add_u32 v88, s24, v4
  s_cmp_lt_u32 s19, 8
  s_cselect_b64 vcc, -1, 0
  s_cselect_b32 s24, 0, 256
  v_subrev_u32 v88, s24, v88
  s_movk_i32 s24, 5462
  s_cselect_b32 s24, 4096, s24
  v_mul_u32_u24 v89, s24, v88
  v_lshrrev_b32 v89, 16, v89
  s_movk_i32 s24, 100
  s_cselect_b32 s24, 96, s24
  v_mul_u32_u24 v89, s24, v89
  v_cndmask_b32 v92, v7, v6, vcc
  v_add3_u32 v88, v88, v89, v92
  v_lshlrev_b32 v90, 4, v88
  v_cvt_pk_bf16_f32 v72, v40, v41
  v_cvt_pk_bf16_f32 v73, v42, v43
  v_cvt_pk_bf16_f32 v74, v44, v45
  v_cvt_pk_bf16_f32 v75, v46, v47
  buffer_store_dwordx4 v[72:75], v90, s[8:11], s29 offen sc1
  v_cvt_pk_bf16_f32 v76, v48, v49
  v_cvt_pk_bf16_f32 v77, v50, v51
  v_cvt_pk_bf16_f32 v78, v52, v53
  v_cvt_pk_bf16_f32 v79, v54, v55
  buffer_store_dwordx4 v[76:79], v90, s[8:11], s25 offen sc1
  s_lshl_b32 s24, s19, 5
  s_add_u32 s24, s24, 16
  v_add_u32 v88, s24, v4
  s_cmp_lt_u32 s19, 8
  s_cselect_b64 vcc, -1, 0
  s_cselect_b32 s24, 0, 256
  v_subrev_u32 v88, s24, v88
  s_movk_i32 s24, 5462
  s_cselect_b32 s24, 4096, s24
  v_mul_u32_u24 v89, s24, v88
  v_lshrrev_b32 v89, 16, v89
  s_movk_i32 s24, 100
  s_cselect_b32 s24, 96, s24
  v_mul_u32_u24 v89, s24, v89
  v_cndmask_b32 v92, v7, v6, vcc
  v_add3_u32 v88, v88, v89, v92
  v_lshlrev_b32 v91, 4, v88
  v_cvt_pk_bf16_f32 v80, v56, v57
  v_cvt_pk_bf16_f32 v81, v58, v59
  v_cvt_pk_bf16_f32 v82, v60, v61
  v_cvt_pk_bf16_f32 v83, v62, v63
  buffer_store_dwordx4 v[80:83], v91, s[8:11], s29 offen sc1
  v_cvt_pk_bf16_f32 v84, v64, v65
  v_cvt_pk_bf16_f32 v85, v66, v67
  v_cvt_pk_bf16_f32 v86, v68, v69
  v_cvt_pk_bf16_f32 v87, v70, v71
  buffer_store_dwordx4 v[84:87], v91, s[8:11], s25 offen sc1
  s_mov_b32 s33, s32
  s_add_u32 s32, s32, 28672
  s_cmp_eq_u32 s32, 86016
  s_cselect_b32 s32, 0, s32
  s_add_u32 s19, s19, 1
  s_cmp_lt_u32 s19, s35
  s_cbranch_scc1 wg_vo_loop
  s_branch wg_done
wg_done:
  s_lshl_b32 s20, s18, 4
  s_and_b32 s21, s17, 15
  s_add_u32 s20, s20, s21
  s_lshl_b32 s20, s20, 7
  s_cmp_lt_u32 s17, 16
  s_cselect_b32 s21, 16384, 0
  s_add_u32 s20, s20, s21
  s_add_u32 s20, s20, 88541184
  s_sub_u32 s21, s35, s34
  v_mov_b32 v5, s21
  v_mov_b32 v6, 0
  s_waitcnt vmcnt(0)
  s_mov_b64 exec, 1
  buffer_atomic_add v5, v6, s[8:11], s20 offen
  s_mov_b64 exec, -1
  s_branch wk_loop
wk_a:
  s_cmp_lg_u32 s16, 0
  s_cbranch_scc1 w0_51
  s_getreg_b32 s20, hwreg(HW_REG_XCC_ID)
  s_sub_u32 s20, s20, 1
  s_and_b32 s20, s20, 7
  s_mov_b64 exec, 1
ax_l:
  s_cmp_ge_u32 s20, 8
  s_cselect_b32 s20, 0, s20
  s_lshl_b32 s21, s20, 7
  s_add_u32 s21, s21, 88599552
  v_mov_b32 v242, 1
  buffer_atomic_add v242, off, s[8:11], s21 sc0
  s_waitcnt vmcnt(0)
  v_readfirstlane_b32 s21, v242
  s_lshl_b32 s22, s20, 4
  s_add_u32 s20, s20, 1
  s_cmp_ge_u32 s21, 16
  s_cbranch_scc1 ax_l
  v_add_u32 v242, s22, v242
  s_mov_b64 exec, -1
w0_51:
  v_mov_b32 v243, 160000
  s_add_u32 s101, s101, 1
  s_barrier
  s_mov_b64 exec, 1
  s_cmp_lg_u32 s16, 0
  s_cbranch_scc1 w0_52
  ds_write_b32 v243, v242 offset:0
  s_waitcnt lgkmcnt(0)
  v_mov_b32 v242, s101
  ds_write_b32 v243, v242 offset:16
  s_waitcnt lgkmcnt(0)
w0_52:
  s_mov_b64 exec, -1
  s_barrier
  ds_read_b32 v242, v243 offset:0
  ds_read_b32 v243, v243 offset:16
  s_waitcnt lgkmcnt(0)
  v_readfirstlane_b32 s3, v242
  v_cmp_ne_u32 vcc, s101, v243
  s_cbranch_vccnz ch_end
  s_load_dwordx8 s[36:43], s[0:1], 56
  s_load_dwordx4 s[44:47], s[0:1], 88
  s_lshr_b32 s17, s3, 3
  s_and_b32 s19, s3, 3
  s_bitcmp1_b32 s3, 2
  s_cselect_b32 s31, 7, 0
  s_waitcnt lgkmcnt(0)
  s_mov_b32 s60, s40
  s_and_b32 s61, s41, 0xffff
  s_mov_b32 s62, 3670016
  s_mov_b32 s63, 0x20000
  s_mov_b32 s56, s42
  s_and_b32 s57, s43, 0xffff
  s_mov_b32 s58, 3670016
  s_mov_b32 s59, 0x20000
  s_lshl_b32 s30, s16, 13
  s_lshl_b32 s27, s19, 19
  s_lshl_b32 s29, s16, 17
  s_add_u32 s27, s27, s29
  s_lshl_b32 s29, s17, 9
  s_add_u32 s27, s27, s29
  v_lshrrev_b32 v5, 5, v1
  v_and_b32 v6, 31, v1
  v_xor_b32 v6, v6, v5
  v_lshlrev_b32 v6, 4, v6
  v_lshl_add_u32 v6, v5, 13, v6
  s_add_u32 m0, s30, 0
  s_add_u32 s22, s27, 0
  v_xor_b32 v7, 0, v6
  buffer_load_dwordx4 v7, s[56:59], s22 offen offset:0 lds
  s_add_u32 s22, s27, 15360
  v_xor_b32 v7, 32, v6
  buffer_load_dwordx4 v7, s[56:59], s22 offen offset:1024 lds
  s_add_u32 s22, s27, 30720
  v_xor_b32 v7, 64, v6
  buffer_load_dwordx4 v7, s[56:59], s22 offen offset:2048 lds
  s_add_u32 s22, s27, 46080
  v_xor_b32 v7, 96, v6
  buffer_load_dwordx4 v7, s[56:59], s22 offen offset:3072 lds
  s_add_u32 m0, s30, 4096
  s_add_u32 s22, s27, 65536
  v_xor_b32 v7, 128, v6
  buffer_load_dwordx4 v7, s[56:59], s22 offen offset:0 lds
  s_add_u32 s22, s27, 80896
  v_xor_b32 v7, 160, v6
  buffer_load_dwordx4 v7, s[56:59], s22 offen offset:1024 lds
  s_add_u32 s22, s27, 96256
  v_xor_b32 v7, 192, v6
  buffer_load_dwordx4 v7, s[56:59], s22 offen offset:2048 lds
  s_add_u32 s22, s27, 111616
  v_xor_b32 v7, 224, v6
  buffer_load_dwordx4 v7, s[56:59], s22 offen offset:3072 lds
  v_lshrrev_b32 v5, 5, v1
  v_and_b32 v6, 31, v1
  s_lshl_b32 s25, s16, 15
  s_add_u32 s25, s25, 32768
  s_lshl_b32 s26, s17, 9
  s_add_u32 s28, s19, s16
  s_cmp_ge_u32 s28, 7
  s_cselect_b32 s20, 7, 0
  s_sub_u32 s28, s28, s20
  s_add_u32 s28, s28, s31
  s_add_u32 s29, s19, s16
  s_add_u32 s29, s29, 4
  s_cmp_ge_u32 s29, 7
  s_cselect_b32 s20, 7, 0
  s_sub_u32 s29, s29, s20
  s_add_u32 s29, s29, s31
  s_lshl_b32 s32, s28, 18
  s_add_u32 s32, s32, s26
  s_lshl_b32 s33, s29, 18
  s_add_u32 s33, s33, s26
  v_xor_b32 v8, v6, v5
  v_lshlrev_b32 v8, 4, v8
  v_lshl_add_u32 v8, v5, 13, v8
  v_xor_b32 v12, 0, v8
  v_xor_b32 v13, 32, v8
  v_add_u32 v13, 15360, v13
  v_xor_b32 v14, 0, v8
  v_add_u32 v14, 30720, v14
  v_xor_b32 v15, 32, v8
  v_add_u32 v15, 46080, v15
  s_add_u32 s20, s16, 0
  s_and_b32 s20, s20, 3
  s_mul_i32 s21, s20, 65600
  s_lshl_b32 s20, s20, 12
  s_add_u32 s48, s20, s25
  s_mov_b32 m0, s48
  v_xor_b32 v16, s21, v12
  buffer_load_dwordx4 v16, s[60:63], s32 offen offset:0 lds
  v_xor_b32 v17, s21, v13
  buffer_load_dwordx4 v17, s[60:63], s32 offen offset:1024 lds
  v_xor_b32 v18, s21, v14
  buffer_load_dwordx4 v18, s[60:63], s32 offen offset:2048 lds
  v_xor_b32 v19, s21, v15
  buffer_load_dwordx4 v19, s[60:63], s32 offen offset:3072 lds
  s_add_u32 s20, s16, 1
  s_and_b32 s20, s20, 3
  s_mul_i32 s21, s20, 65600
  s_lshl_b32 s20, s20, 12
  s_add_u32 s49, s20, s25
  s_mov_b32 m0, s49
  v_xor_b32 v20, s21, v12
  buffer_load_dwordx4 v20, s[60:63], s32 offen offset:0 lds
  v_xor_b32 v21, s21, v13
  buffer_load_dwordx4 v21, s[60:63], s32 offen offset:1024 lds
  v_xor_b32 v22, s21, v14
  buffer_load_dwordx4 v22, s[60:63], s32 offen offset:2048 lds
  v_xor_b32 v23, s21, v15
  buffer_load_dwordx4 v23, s[60:63], s32 offen offset:3072 lds
  s_add_u32 s20, s16, 2
  s_and_b32 s20, s20, 3
  s_mul_i32 s21, s20, 65600
  s_lshl_b32 s20, s20, 12
  s_add_u32 s50, s20, s25
  s_mov_b32 m0, s50
  v_xor_b32 v24, s21, v12
  buffer_load_dwordx4 v24, s[60:63], s32 offen offset:0 lds
  v_xor_b32 v25, s21, v13
  buffer_load_dwordx4 v25, s[60:63], s32 offen offset:1024 lds
  v_xor_b32 v26, s21, v14
  buffer_load_dwordx4 v26, s[60:63], s32 offen offset:2048 lds
  v_xor_b32 v27, s21, v15
  buffer_load_dwordx4 v27, s[60:63], s32 offen offset:3072 lds
  s_add_u32 s20, s16, 3
  s_and_b32 s20, s20, 3
  s_mul_i32 s21, s20, 65600
  s_lshl_b32 s20, s20, 12
  s_add_u32 s51, s20, s25
  s_mov_b32 m0, s51
  v_xor_b32 v28, s21, v12
  buffer_load_dwordx4 v28, s[60:63], s32 offen offset:0 lds
  v_xor_b32 v29, s21, v13
  buffer_load_dwordx4 v29, s[60:63], s32 offen offset:1024 lds
  v_xor_b32 v30, s21, v14
  buffer_load_dwordx4 v30, s[60:63], s32 offen offset:2048 lds
  v_xor_b32 v31, s21, v15
  buffer_load_dwordx4 v31, s[60:63], s32 offen offset:3072 lds
  s_mul_i32 s30, s17, 401408
  s_mul_i32 s20, s19, 57344
  s_add_u32 s30, s30, s20
  v_add_u32 v12, s30, v2
  v_add_u32 v13, 14336, v12
  v_add_u32 v14, 28672, v12
  v_add_u32 v15, 43008, v12
  v_lshrrev_b32 v7, 2, v4
  v_lshlrev_b32 v7, 3, v7
  v_and_b32 v8, 3, v4
  v_add_u32 v7, v7, v8
  v_xor_b32 v10, v3, v4
  v_lshlrev_b32 v10, 4, v10
  v_lshl_add_u32 v10, v7, 9, v10
  v_add_u32 v10, s25, v10
  v_xor_b32 v32, 0, v10
  v_xor_b32 v33, 64, v10
  v_xor_b32 v34, 128, v10
  v_xor_b32 v35, 192, v10
  v_and_b32 v8, 2, v4
  v_lshlrev_b32 v8, 1, v8
  v_and_b32 v9, 1, v4
  v_add_u32 v8, v8, v9
  v_lshrrev_b32 v7, 2, v4
  v_lshl_add_u32 v7, v7, 4, v8
  v_xor_b32 v8, v8, v3
  v_lshlrev_b32 v8, 4, v8
  v_lshl_add_u32 v7, v7, 9, v8
  s_mov_b32 s24, 1035512379
  s_waitcnt vmcnt(16)
  s_barrier
  s_cmp_eq_u32 s16, 3
  s_cbranch_scc1 aj_np0
  s_add_u32 m0, s48, 16384
  s_nop 0
  buffer_load_dwordx4 v16, s[60:63], s33 offen offset:0 lds
  buffer_load_dwordx4 v17, s[60:63], s33 offen offset:1024 lds
  buffer_load_dwordx4 v18, s[60:63], s33 offen offset:2048 lds
  buffer_load_dwordx4 v19, s[60:63], s33 offen offset:3072 lds
aj_np0:
  v_xor_b32 v8, 0, v7
  ds_read_b128 v[128:131], v8 offset:0
  v_xor_b32 v9, 64, v7
  ds_read_b128 v[132:135], v9 offset:0
  v_xor_b32 v10, 128, v7
  ds_read_b128 v[136:139], v10 offset:0
  v_xor_b32 v11, 192, v7
  ds_read_b128 v[140:143], v11 offset:0
  ds_read_b128 v[144:147], v8 offset:256
  ds_read_b128 v[148:151], v9 offset:256
  ds_read_b128 v[152:155], v10 offset:256
  ds_read_b128 v[156:159], v11 offset:256
  s_waitcnt lgkmcnt(4)
  s_cmp_eq_u32 s16, 3
  s_cbranch_scc1 aj_np1
  s_add_u32 m0, s49, 16384
  s_nop 0
  buffer_load_dwordx4 v20, s[60:63], s33 offen offset:0 lds
  buffer_load_dwordx4 v21, s[60:63], s33 offen offset:1024 lds
  buffer_load_dwordx4 v22, s[60:63], s33 offen offset:2048 lds
  buffer_load_dwordx4 v23, s[60:63], s33 offen offset:3072 lds
aj_np1:
  v_xor_b32 v8, 32, v7
  ds_read_b128 v[160:163], v8 offset:1024
  v_xor_b32 v9, 96, v7
  ds_read_b128 v[164:167], v9 offset:1024
  v_xor_b32 v10, 160, v7
  ds_read_b128 v[168:171], v10 offset:1024
  v_xor_b32 v11, 224, v7
  ds_read_b128 v[172:175], v11 offset:1024
  ds_read_b128 v[176:179], v8 offset:1280
  ds_read_b128 v[180:183], v9 offset:1280
  ds_read_b128 v[184:187], v10 offset:1280
  ds_read_b128 v[188:191], v11 offset:1280
  s_waitcnt lgkmcnt(4)
  s_cmp_eq_u32 s16, 3
  s_cbranch_scc1 aj_np2
  s_add_u32 m0, s50, 16384
  s_nop 0
  buffer_load_dwordx4 v24, s[60:63], s33 offen offset:0 lds
  buffer_load_dwordx4 v25, s[60:63], s33 offen offset:1024 lds
  buffer_load_dwordx4 v26, s[60:63], s33 offen offset:2048 lds
  buffer_load_dwordx4 v27, s[60:63], s33 offen offset:3072 lds
aj_np2:
  v_xor_b32 v8, 128, v7
  ds_read_b128 v[192:195], v8 offset:4096
  v_xor_b32 v9, 192, v7
  ds_read_b128 v[196:199], v9 offset:4096
  v_xor_b32 v10, 0, v7
  ds_read_b128 v[200:203], v10 offset:4096
  v_xor_b32 v11, 64, v7
  ds_read_b128 v[204:207], v11 offset:4096
  ds_read_b128 v[208:211], v8 offset:4352
  ds_read_b128 v[212:215], v9 offset:4352
  ds_read_b128 v[216:219], v10 offset:4352
  ds_read_b128 v[220:223], v11 offset:4352
  s_waitcnt lgkmcnt(4)
  s_cmp_eq_u32 s16, 3
  s_cbranch_scc1 aj_np3
  s_add_u32 m0, s51, 16384
  s_nop 0
  buffer_load_dwordx4 v28, s[60:63], s33 offen offset:0 lds
  buffer_load_dwordx4 v29, s[60:63], s33 offen offset:1024 lds
  buffer_load_dwordx4 v30, s[60:63], s33 offen offset:2048 lds
  buffer_load_dwordx4 v31, s[60:63], s33 offen offset:3072 lds
aj_np3:
  v_xor_b32 v8, 160, v7
  ds_read_b128 v[224:227], v8 offset:5120
  v_xor_b32 v9, 224, v7
  ds_read_b128 v[228:231], v9 offset:5120
  v_xor_b32 v10, 32, v7
  ds_read_b128 v[232:235], v10 offset:5120
  v_xor_b32 v11, 96, v7
  ds_read_b128 v[236:239], v11 offset:5120
  ds_read_b128 v[240:243], v8 offset:5376
  ds_read_b128 v[244:247], v9 offset:5376
  ds_read_b128 v[248:251], v10 offset:5376
  ds_read_b128 v[252:255], v11 offset:5376
  s_waitcnt lgkmcnt(4)
  s_waitcnt vmcnt(16) lgkmcnt(0)
  s_cmp_lg_u32 s16, 3
  s_cbranch_scc1 w3_53
  s_waitcnt vmcnt(0)
w3_53:
  ds_read_b128 v[52:55], v32 offset:0
  ds_read_b128 v[56:59], v33 offset:0
  ds_read_b128 v[60:63], v34 offset:0
  ds_read_b128 v[64:67], v35 offset:0
  s_waitcnt lgkmcnt(3)
  v_mfma_f32_16x16x32_bf16 v[96:99], v[52:55], v[128:131], 0
  v_mfma_f32_16x16x32_bf16 v[100:103], v[52:55], v[160:163], 0
  v_mfma_f32_16x16x32_bf16 v[104:107], v[52:55], v[192:195], 0
  v_mfma_f32_16x16x32_bf16 v[108:111], v[52:55], v[224:227], 0
  ds_read_b128 v[52:55], v32 offset:256
  s_waitcnt lgkmcnt(3)
  v_mfma_f32_16x16x32_bf16 v[96:99], v[56:59], v[132:135], v[96:99]
  v_mfma_f32_16x16x32_bf16 v[100:103], v[56:59], v[164:167], v[100:103]
  v_mfma_f32_16x16x32_bf16 v[104:107], v[56:59], v[196:199], v[104:107]
  v_mfma_f32_16x16x32_bf16 v[108:111], v[56:59], v[228:231], v[108:111]
  ds_read_b128 v[56:59], v33 offset:256
  s_waitcnt lgkmcnt(3)
  v_mfma_f32_16x16x32_bf16 v[96:99], v[60:63], v[136:139], v[96:99]
  v_mfma_f32_16x16x32_bf16 v[100:103], v[60:63], v[168:171], v[100:103]
  v_mfma_f32_16x16x32_bf16 v[104:107], v[60:63], v[200:203], v[104:107]
  v_mfma_f32_16x16x32_bf16 v[108:111], v[60:63], v[232:235], v[108:111]
  ds_read_b128 v[60:63], v34 offset:256
  s_waitcnt lgkmcnt(3)
  v_mfma_f32_16x16x32_bf16 v[96:99], v[64:67], v[140:143], v[96:99]
  v_mfma_f32_16x16x32_bf16 v[100:103], v[64:67], v[172:175], v[100:103]
  v_mfma_f32_16x16x32_bf16 v[104:107], v[64:67], v[204:207], v[104:107]
  v_mfma_f32_16x16x32_bf16 v[108:111], v[64:67], v[236:239], v[108:111]
  ds_read_b128 v[64:67], v35 offset:256
  s_waitcnt lgkmcnt(3)
  v_mfma_f32_16x16x32_bf16 v[96:99], v[52:55], v[144:147], v[96:99]
  v_mfma_f32_16x16x32_bf16 v[100:103], v[52:55], v[176:179], v[100:103]
  v_mfma_f32_16x16x32_bf16 v[104:107], v[52:55], v[208:211], v[104:107]
  v_mfma_f32_16x16x32_bf16 v[108:111], v[52:55], v[240:243], v[108:111]
  ds_read_b128 v[52:55], v32 offset:2048
  s_waitcnt lgkmcnt(3)
  v_mfma_f32_16x16x32_bf16 v[96:99], v[56:59], v[148:151], v[96:99]
  v_mfma_f32_16x16x32_bf16 v[100:103], v[56:59], v[180:183], v[100:103]
  v_mfma_f32_16x16x32_bf16 v[104:107], v[56:59], v[212:215], v[104:107]
  v_mfma_f32_16x16x32_bf16 v[108:111], v[56:59], v[244:247], v[108:111]
  ds_read_b128 v[56:59], v33 offset:2048
  s_waitcnt lgkmcnt(3)
  v_mfma_f32_16x16x32_bf16 v[96:99], v[60:63], v[152:155], v[96:99]
  v_mfma_f32_16x16x32_bf16 v[100:103], v[60:63], v[184:187], v[100:103]
  v_mfma_f32_16x16x32_bf16 v[104:107], v[60:63], v[216:219], v[104:107]
  v_mfma_f32_16x16x32_bf16 v[108:111], v[60:63], v[248:251], v[108:111]
  ds_read_b128 v[60:63], v34 offset:2048
  s_waitcnt lgkmcnt(3)
  v_mfma_f32_16x16x32_bf16 v[96:99], v[64:67], v[156:159], v[96:99]
  v_mfma_f32_16x16x32_bf16 v[100:103], v[64:67], v[188:191], v[100:103]
  v_mfma_f32_16x16x32_bf16 v[104:107], v[64:67], v[220:223], v[104:107]
  v_mfma_f32_16x16x32_bf16 v[108:111], v[64:67], v[252:255], v[108:111]
  ds_read_b128 v[64:67], v35 offset:2048
  s_waitcnt lgkmcnt(3)
  v_mfma_f32_16x16x32_bf16 v[112:115], v[52:55], v[128:131], 0
  v_mfma_f32_16x16x32_bf16 v[116:119], v[52:55], v[160:163], 0
  v_mfma_f32_16x16x32_bf16 v[120:123], v[52:55], v[192:195], 0
  v_mfma_f32_16x16x32_bf16 v[124:127], v[52:55], v[224:227], 0
  ds_read_b128 v[52:55], v32 offset:2304
  s_waitcnt lgkmcnt(3)
  v_mfma_f32_16x16x32_bf16 v[112:115], v[56:59], v[132:135], v[112:115]
  v_mfma_f32_16x16x32_bf16 v[116:119], v[56:59], v[164:167], v[116:119]
  v_mfma_f32_16x16x32_bf16 v[120:123], v[56:59], v[196:199], v[120:123]
  v_mfma_f32_16x16x32_bf16 v[124:127], v[56:59], v[228:231], v[124:127]
  ds_read_b128 v[56:59], v33 offset:2304
  s_waitcnt lgkmcnt(3)
  v_mfma_f32_16x16x32_bf16 v[112:115], v[60:63], v[136:139], v[112:115]
  v_mfma_f32_16x16x32_bf16 v[116:119], v[60:63], v[168:171], v[116:119]
  v_mfma_f32_16x16x32_bf16 v[120:123], v[60:63], v[200:203], v[120:123]
  v_mfma_f32_16x16x32_bf16 v[124:127], v[60:63], v[232:235], v[124:127]
  ds_read_b128 v[60:63], v34 offset:2304
  s_waitcnt lgkmcnt(3)
  v_mfma_f32_16x16x32_bf16 v[112:115], v[64:67], v[140:143], v[112:115]
  v_mfma_f32_16x16x32_bf16 v[116:119], v[64:67], v[172:175], v[116:119]
  v_mfma_f32_16x16x32_bf16 v[120:123], v[64:67], v[204:207], v[120:123]
  v_mfma_f32_16x16x32_bf16 v[124:127], v[64:67], v[236:239], v[124:127]
  ds_read_b128 v[64:67], v35 offset:2304
  s_waitcnt lgkmcnt(3)
  v_mfma_f32_16x16x32_bf16 v[112:115], v[52:55], v[144:147], v[112:115]
  v_mfma_f32_16x16x32_bf16 v[116:119], v[52:55], v[176:179], v[116:119]
  v_mfma_f32_16x16x32_bf16 v[120:123], v[52:55], v[208:211], v[120:123]
  v_mfma_f32_16x16x32_bf16 v[124:127], v[52:55], v[240:243], v[124:127]
  s_waitcnt lgkmcnt(2)
  v_mfma_f32_16x16x32_bf16 v[112:115], v[56:59], v[148:151], v[112:115]
  v_mfma_f32_16x16x32_bf16 v[116:119], v[56:59], v[180:183], v[116:119]
  v_mfma_f32_16x16x32_bf16 v[120:123], v[56:59], v[212:215], v[120:123]
  v_mfma_f32_16x16x32_bf16 v[124:127], v[56:59], v[244:247], v[124:127]
  s_waitcnt lgkmcnt(1)
  v_mfma_f32_16x16x32_bf16 v[112:115], v[60:63], v[152:155], v[112:115]
  v_mfma_f32_16x16x32_bf16 v[116:119], v[60:63], v[184:187], v[116:119]
  v_mfma_f32_16x16x32_bf16 v[120:123], v[60:63], v[216:219], v[120:123]
  v_mfma_f32_16x16x32_bf16 v[124:127], v[60:63], v[248:251], v[124:127]
  s_waitcnt lgkmcnt(0)
  v_mfma_f32_16x16x32_bf16 v[112:115], v[64:67], v[156:159], v[112:115]
  v_mfma_f32_16x16x32_bf16 v[116:119], v[64:67], v[188:191], v[116:119]
  v_mfma_f32_16x16x32_bf16 v[120:123], v[64:67], v[220:223], v[120:123]
  v_mfma_f32_16x16x32_bf16 v[124:127], v[64:67], v[252:255], v[124:127]
  s_lshl_b32 s30, s28, 10
  v_mul_f32 v96, s24, v96
  v_mul_f32 v97, s24, v97
  v_mul_f32 v98, s24, v98
  v_mul_f32 v99, s24, v99
  v_cvt_pk_bf16_f32 v68, v96, v97
  v_cvt_pk_bf16_f32 v69, v98, v99
  v_mul_f32 v112, s24, v112
  v_mul_f32 v113, s24, v113
  v_mul_f32 v114, s24, v114
  v_mul_f32 v115, s24, v115
  v_cvt_pk_bf16_f32 v70, v112, v113
  v_cvt_pk_bf16_f32 v71, v114, v115
  buffer_store_dwordx4 v[68:71], v12, s[8:11], s30 offen sc1
  v_mul_f32 v100, s24, v100
  v_mul_f32 v101, s24, v101
  v_mul_f32 v102, s24, v102
  v_mul_f32 v103, s24, v103
  v_cvt_pk_bf16_f32 v72, v100, v101
  v_cvt_pk_bf16_f32 v73, v102, v103
  v_mul_f32 v116, s24, v116
  v_mul_f32 v117, s24, v117
  v_mul_f32 v118, s24, v118
  v_mul_f32 v119, s24, v119
  v_cvt_pk_bf16_f32 v74, v116, v117
  v_cvt_pk_bf16_f32 v75, v118, v119
  buffer_store_dwordx4 v[72:75], v13, s[8:11], s30 offen sc1
  v_mul_f32 v104, s24, v104
  v_mul_f32 v105, s24, v105
  v_mul_f32 v106, s24, v106
  v_mul_f32 v107, s24, v107
  v_cvt_pk_bf16_f32 v76, v104, v105
  v_cvt_pk_bf16_f32 v77, v106, v107
  v_mul_f32 v120, s24, v120
  v_mul_f32 v121, s24, v121
  v_mul_f32 v122, s24, v122
  v_mul_f32 v123, s24, v123
  v_cvt_pk_bf16_f32 v78, v120, v121
  v_cvt_pk_bf16_f32 v79, v122, v123
  buffer_store_dwordx4 v[76:79], v14, s[8:11], s30 offen sc1
  v_mul_f32 v108, s24, v108
  v_mul_f32 v109, s24, v109
  v_mul_f32 v110, s24, v110
  v_mul_f32 v111, s24, v111
  v_cvt_pk_bf16_f32 v80, v108, v109
  v_cvt_pk_bf16_f32 v81, v110, v111
  v_mul_f32 v124, s24, v124
  v_mul_f32 v125, s24, v125
  v_mul_f32 v126, s24, v126
  v_mul_f32 v127, s24, v127
  v_cvt_pk_bf16_f32 v82, v124, v125
  v_cvt_pk_bf16_f32 v83, v126, v127
  buffer_store_dwordx4 v[80:83], v15, s[8:11], s30 offen sc1
  s_cmp_eq_u32 s16, 3
  s_cbranch_scc1 aj_w3
  s_waitcnt vmcnt(4)
  ds_read_b128 v[52:55], v32 offset:16384
  ds_read_b128 v[56:59], v33 offset:16384
  ds_read_b128 v[60:63], v34 offset:16384
  ds_read_b128 v[64:67], v35 offset:16384
  s_waitcnt lgkmcnt(3)
  v_mfma_f32_16x16x32_bf16 v[96:99], v[52:55], v[128:131], 0
  v_mfma_f32_16x16x32_bf16 v[100:103], v[52:55], v[160:163], 0
  v_mfma_f32_16x16x32_bf16 v[104:107], v[52:55], v[192:195], 0
  v_mfma_f32_16x16x32_bf16 v[108:111], v[52:55], v[224:227], 0
  ds_read_b128 v[52:55], v32 offset:16640
  s_waitcnt lgkmcnt(3)
  v_mfma_f32_16x16x32_bf16 v[96:99], v[56:59], v[132:135], v[96:99]
  v_mfma_f32_16x16x32_bf16 v[100:103], v[56:59], v[164:167], v[100:103]
  v_mfma_f32_16x16x32_bf16 v[104:107], v[56:59], v[196:199], v[104:107]
  v_mfma_f32_16x16x32_bf16 v[108:111], v[56:59], v[228:231], v[108:111]
  ds_read_b128 v[56:59], v33 offset:16640
  s_waitcnt lgkmcnt(3)
  v_mfma_f32_16x16x32_bf16 v[96:99], v[60:63], v[136:139], v[96:99]
  v_mfma_f32_16x16x32_bf16 v[100:103], v[60:63], v[168:171], v[100:103]
  v_mfma_f32_16x16x32_bf16 v[104:107], v[60:63], v[200:203], v[104:107]
  v_mfma_f32_16x16x32_bf16 v[108:111], v[60:63], v[232:235], v[108:111]
  ds_read_b128 v[60:63], v34 offset:16640
  s_waitcnt lgkmcnt(3)
  v_mfma_f32_16x16x32_bf16 v[96:99], v[64:67], v[140:143], v[96:99]
  v_mfma_f32_16x16x32_bf16 v[100:103], v[64:67], v[172:175], v[100:103]
  v_mfma_f32_16x16x32_bf16 v[104:107], v[64:67], v[204:207], v[104:107]
  v_mfma_f32_16x16x32_bf16 v[108:111], v[64:67], v[236:239], v[108:111]
  ds_read_b128 v[64:67], v35 offset:16640
  s_waitcnt lgkmcnt(3)
  v_mfma_f32_16x16x32_bf16 v[96:99], v[52:55], v[144:147], v[96:99]
  v_mfma_f32_16x16x32_bf16 v[100:103], v[52:55], v[176:179], v[100:103]
  v_mfma_f32_16x16x32_bf16 v[104:107], v[52:55], v[208:211], v[104:107]
  v_mfma_f32_16x16x32_bf16 v[108:111], v[52:55], v[240:243], v[108:111]
  ds_read_b128 v[52:55], v32 offset:18432
  s_waitcnt lgkmcnt(3)
  v_mfma_f32_16x16x32_bf16 v[96:99], v[56:59], v[148:151], v[96:99]
  v_mfma_f32_16x16x32_bf16 v[100:103], v[56:59], v[180:183], v[100:103]
  v_mfma_f32_16x16x32_bf16 v[104:107], v[56:59], v[212:215], v[104:107]
  v_mfma_f32_16x16x32_bf16 v[108:111], v[56:59], v[244:247], v[108:111]
  ds_read_b128 v[56:59], v33 offset:18432
  s_waitcnt lgkmcnt(3)
  v_mfma_f32_16x16x32_bf16 v[96:99], v[60:63], v[152:155], v[96:99]
  v_mfma_f32_16x16x32_bf16 v[100:103], v[60:63], v[184:187], v[100:103]
  v_mfma_f32_16x16x32_bf16 v[104:107], v[60:63], v[216:219], v[104:107]
  v_mfma_f32_16x16x32_bf16 v[108:111], v[60:63], v[248:251], v[108:111]
  ds_read_b128 v[60:63], v34 offset:18432
  s_waitcnt lgkmcnt(3)
  v_mfma_f32_16x16x32_bf16 v[96:99], v[64:67], v[156:159], v[96:99]
  v_mfma_f32_16x16x32_bf16 v[100:103], v[64:67], v[188:191], v[100:103]
  v_mfma_f32_16x16x32_bf16 v[104:107], v[64:67], v[220:223], v[104:107]
  v_mfma_f32_16x16x32_bf16 v[108:111], v[64:67], v[252:255], v[108:111]
  ds_read_b128 v[64:67], v35 offset:18432
  s_waitcnt lgkmcnt(3)
  v_mfma_f32_16x16x32_bf16 v[112:115], v[52:55], v[128:131], 0
  v_mfma_f32_16x16x32_bf16 v[116:119], v[52:55], v[160:163], 0
  v_mfma_f32_16x16x32_bf16 v[120:123], v[52:55], v[192:195], 0
  v_mfma_f32_16x16x32_bf16 v[124:127], v[52:55], v[224:227], 0
  ds_read_b128 v[52:55], v32 offset:18688
  s_waitcnt lgkmcnt(3)
  v_mfma_f32_16x16x32_bf16 v[112:115], v[56:59], v[132:135], v[112:115]
  v_mfma_f32_16x16x32_bf16 v[116:119], v[56:59], v[164:167], v[116:119]
  v_mfma_f32_16x16x32_bf16 v[120:123], v[56:59], v[196:199], v[120:123]
  v_mfma_f32_16x16x32_bf16 v[124:127], v[56:59], v[228:231], v[124:127]
  ds_read_b128 v[56:59], v33 offset:18688
  s_waitcnt lgkmcnt(3)
  v_mfma_f32_16x16x32_bf16 v[112:115], v[60:63], v[136:139], v[112:115]
  v_mfma_f32_16x16x32_bf16 v[116:119], v[60:63], v[168:171], v[116:119]
  v_mfma_f32_16x16x32_bf16 v[120:123], v[60:63], v[200:203], v[120:123]
  v_mfma_f32_16x16x32_bf16 v[124:127], v[60:63], v[232:235], v[124:127]
  ds_read_b128 v[60:63], v34 offset:18688
  s_waitcnt lgkmcnt(3)
  v_mfma_f32_16x16x32_bf16 v[112:115], v[64:67], v[140:143], v[112:115]
  v_mfma_f32_16x16x32_bf16 v[116:119], v[64:67], v[172:175], v[116:119]
  v_mfma_f32_16x16x32_bf16 v[120:123], v[64:67], v[204:207], v[120:123]
  v_mfma_f32_16x16x32_bf16 v[124:127], v[64:67], v[236:239], v[124:127]
  ds_read_b128 v[64:67], v35 offset:18688
  s_waitcnt lgkmcnt(3)
  v_mfma_f32_16x16x32_bf16 v[112:115], v[52:55], v[144:147], v[112:115]
  v_mfma_f32_16x16x32_bf16 v[116:119], v[52:55], v[176:179], v[116:119]
  v_mfma_f32_16x16x32_bf16 v[120:123], v[52:55], v[208:211], v[120:123]
  v_mfma_f32_16x16x32_bf16 v[124:127], v[52:55], v[240:243], v[124:127]
  s_waitcnt lgkmcnt(2)
  v_mfma_f32_16x16x32_bf16 v[112:115], v[56:59], v[148:151], v[112:115]
  v_mfma_f32_16x16x32_bf16 v[116:119], v[56:59], v[180:183], v[116:119]
  v_mfma_f32_16x16x32_bf16 v[120:123], v[56:59], v[212:215], v[120:123]
  v_mfma_f32_16x16x32_bf16 v[124:127], v[56:59], v[244:247], v[124:127]
  s_waitcnt lgkmcnt(1)
  v_mfma_f32_16x16x32_bf16 v[112:115], v[60:63], v[152:155], v[112:115]
  v_mfma_f32_16x16x32_bf16 v[116:119], v[60:63], v[184:187], v[116:119]
  v_mfma_f32_16x16x32_bf16 v[120:123], v[60:63], v[216:219], v[120:123]
  v_mfma_f32_16x16x32_bf16 v[124:127], v[60:63], v[248:251], v[124:127]
  s_waitcnt lgkmcnt(0)
  v_mfma_f32_16x16x32_bf16 v[112:115], v[64:67], v[156:159], v[112:115]
  v_mfma_f32_16x16x32_bf16 v[116:119], v[64:67], v[188:191], v[116:119]
  v_mfma_f32_16x16x32_bf16 v[120:123], v[64:67], v[220:223], v[120:123]
  v_mfma_f32_16x16x32_bf16 v[124:127], v[64:67], v[252:255], v[124:127]
  s_lshl_b32 s30, s29, 10
  v_mul_f32 v96, s24, v96
  v_mul_f32 v97, s24, v97
  v_mul_f32 v98, s24, v98
  v_mul_f32 v99, s24, v99
  v_cvt_pk_bf16_f32 v68, v96, v97
  v_cvt_pk_bf16_f32 v69, v98, v99
  v_mul_f32 v112, s24, v112
  v_mul_f32 v113, s24, v113
  v_mul_f32 v114, s24, v114
  v_mul_f32 v115, s24, v115
  v_cvt_pk_bf16_f32 v70, v112, v113
  v_cvt_pk_bf16_f32 v71, v114, v115
  buffer_store_dwordx4 v[68:71], v12, s[8:11], s30 offen sc1
  v_mul_f32 v100, s24, v100
  v_mul_f32 v101, s24, v101
  v_mul_f32 v102, s24, v102
  v_mul_f32 v103, s24, v103
  v_cvt_pk_bf16_f32 v72, v100, v101
  v_cvt_pk_bf16_f32 v73, v102, v103
  v_mul_f32 v116, s24, v116
  v_mul_f32 v117, s24, v117
  v_mul_f32 v118, s24, v118
  v_mul_f32 v119, s24, v119
  v_cvt_pk_bf16_f32 v74, v116, v117
  v_cvt_pk_bf16_f32 v75, v118, v119
  buffer_store_dwordx4 v[72:75], v13, s[8:11], s30 offen sc1
  v_mul_f32 v104, s24, v104
  v_mul_f32 v105, s24, v105
  v_mul_f32 v106, s24, v106
  v_mul_f32 v107, s24, v107
  v_cvt_pk_bf16_f32 v76, v104, v105
  v_cvt_pk_bf16_f32 v77, v106, v107
  v_mul_f32 v120, s24, v120
  v_mul_f32 v121, s24, v121
  v_mul_f32 v122, s24, v122
  v_mul_f32 v123, s24, v123
  v_cvt_pk_bf16_f32 v78, v120, v121
  v_cvt_pk_bf16_f32 v79, v122, v123
  buffer_store_dwordx4 v[76:79], v14, s[8:11], s30 offen sc1
  v_mul_f32 v108, s24, v108
  v_mul_f32 v109, s24, v109
  v_mul_f32 v110, s24, v110
  v_mul_f32 v111, s24, v111
  v_cvt_pk_bf16_f32 v80, v108, v109
  v_cvt_pk_bf16_f32 v81, v110, v111
  v_mul_f32 v124, s24, v124
  v_mul_f32 v125, s24, v125
  v_mul_f32 v126, s24, v126
  v_mul_f32 v127, s24, v127
  v_cvt_pk_bf16_f32 v82, v124, v125
  v_cvt_pk_bf16_f32 v83, v126, v127
  buffer_store_dwordx4 v[80:83], v15, s[8:11], s30 offen sc1
aj_w3:
  s_lshl_b32 s28, s17, 7
  s_lshl_b32 s21, s19, 4
  s_add_u32 s28, s28, s21
  s_cmp_lg_u32 s31, 0
  s_cselect_b32 s21, 8, 0
  s_add_u32 s28, s28, s21
  s_add_u32 s28, s28, 88637440
  s_waitcnt vmcnt(0)
  s_barrier
  s_cmp_lg_u32 s16, 0
  s_cbranch_scc1 pub_54
  v_mul_u32_u24 v26, 2048, v1
  v_mov_b32 v24, s88
  v_mov_b32 v25, s89
  s_mov_b64 exec, 1
  buffer_store_dwordx2 v[24:25], v26, s[8:11], s28 offen sc1
  s_mov_b64 exec, -1
pub_54:
  v_mov_b32 v250, 0
  s_branch wk_loop
wk_srv:
  s_sub_u32 s3, s3, 224
  s_and_b32 s18, s3, 15
  s_lshr_b32 s19, s3, 4
  s_and_b32 s19, s19, 1
  s_mul_i32 s20, s18, 401408
  s_add_u32 s20, s20, 6422528
  s_mul_i32 s21, s16, 43008
  s_add_u32 s21, s21, s20
  s_mul_i32 s22, s16, 57344
  s_add_u32 s20, s20, s22
  s_add_u32 s22, s20, 0
  buffer_load_dwordx4 a[0:3], v2, s[8:11], s22 offen offset:0 sc1
  buffer_load_dwordx4 a[4:7], v2, s[8:11], s22 offen offset:1024 sc1
  buffer_load_dwordx4 a[8:11], v2, s[8:11], s22 offen offset:2048 sc1
  buffer_load_dwordx4 a[12:15], v2, s[8:11], s22 offen offset:3072 sc1
  s_add_u32 s22, s20, 4096
  buffer_load_dwordx4 a[16:19], v2, s[8:11], s22 offen offset:0 sc1
  buffer_load_dwordx4 a[20:23], v2, s[8:11], s22 offen offset:1024 sc1
  buffer_load_dwordx4 a[24:27], v2, s[8:11], s22 offen offset:2048 sc1
  buffer_load_dwordx4 a[28:31], v2, s[8:11], s22 offen offset:3072 sc1
  s_add_u32 s22, s20, 8192
  buffer_load_dwordx4 a[32:35], v2, s[8:11], s22 offen offset:0 sc1
  buffer_load_dwordx4 a[36:39], v2, s[8:11], s22 offen offset:1024 sc1
  buffer_load_dwordx4 a[40:43], v2, s[8:11], s22 offen offset:2048 sc1
  buffer_load_dwordx4 a[44:47], v2, s[8:11], s22 offen offset:3072 sc1
  s_add_u32 s22, s20, 12288
  buffer_load_dwordx4 a[48:51], v2, s[8:11], s22 offen offset:0 sc1
  buffer_load_dwordx4 a[52:55], v2, s[8:11], s22 offen offset:1024 sc1
  buffer_load_dwordx4 a[56:59], v2, s[8:11], s22 offen offset:2048 sc1
  buffer_load_dwordx4 a[60:63], v2, s[8:11], s22 offen offset:3072 sc1
  s_add_u32 s22, s20, 16384
  buffer_load_dwordx4 a[64:67], v2, s[8:11], s22 offen offset:0 sc1
  buffer_load_dwordx4 a[68:71], v2, s[8:11], s22 offen offset:1024 sc1
  buffer_load_dwordx4 a[72:75], v2, s[8:11], s22 offen offset:2048 sc1
  buffer_load_dwordx4 a[76:79], v2, s[8:11], s22 offen offset:3072 sc1
  s_add_u32 s22, s20, 20480
  buffer_load_dwordx4 a[80:83], v2, s[8:11], s22 offen offset:0 sc1
  buffer_load_dwordx4 a[84:87], v2, s[8:11], s22 offen offset:1024 sc1
  buffer_load_dwordx4 a[88:91], v2, s[8:11], s22 offen offset:2048 sc1
  buffer_load_dwordx4 a[92:95], v2, s[8:11], s22 offen offset:3072 sc1
  s_add_u32 s22, s20, 24576
  buffer_load_dwordx4 a[96:99], v2, s[8:11], s22 offen offset:0 sc1
  buffer_load_dwordx4 a[100:103], v2, s[8:11], s22 offen offset:1024 sc1
  buffer_load_dwordx4 a[104:107], v2, s[8:11], s22 offen offset:2048 sc1
  buffer_load_dwordx4 a[108:111], v2, s[8:11], s22 offen offset:3072 sc1
  s_add_u32 s22, s20, 28672
  buffer_load_dwordx4 a[112:115], v2, s[8:11], s22 offen offset:0 sc1
  buffer_load_dwordx4 a[116:119], v2, s[8:11], s22 offen offset:1024 sc1
  buffer_load_dwordx4 a[120:123], v2, s[8:11], s22 offen offset:2048 sc1
  buffer_load_dwordx4 a[124:127], v2, s[8:11], s22 offen offset:3072 sc1
  s_waitcnt vmcnt(24)
  s_add_u32 s22, s20, 32768
  buffer_load_dwordx4 a[128:131], v2, s[8:11], s22 offen offset:0 sc1
  buffer_load_dwordx4 a[132:135], v2, s[8:11], s22 offen offset:1024 sc1
  buffer_load_dwordx4 a[136:139], v2, s[8:11], s22 offen offset:2048 sc1
  buffer_load_dwordx4 a[140:143], v2, s[8:11], s22 offen offset:3072 sc1
  s_add_u32 s22, s20, 36864
  buffer_load_dwordx4 a[144:147], v2, s[8:11], s22 offen offset:0 sc1
  buffer_load_dwordx4 a[148:151], v2, s[8:11], s22 offen offset:1024 sc1
  buffer_load_dwordx4 a[152:155], v2, s[8:11], s22 offen offset:2048 sc1
  buffer_load_dwordx4 a[156:159], v2, s[8:11], s22 offen offset:3072 sc1
  s_add_u32 s22, s20, 40960
  buffer_load_dwordx4 a[160:163], v2, s[8:11], s22 offen offset:0 sc1
  buffer_load_dwordx4 a[164:167], v2, s[8:11], s22 offen offset:1024 sc1
  buffer_load_dwordx4 a[168:171], v2, s[8:11], s22 offen offset:2048 sc1
  buffer_load_dwordx4 a[172:175], v2, s[8:11], s22 offen offset:3072 sc1
  s_add_u32 s22, s20, 45056
  buffer_load_dwordx4 a[176:179], v2, s[8:11], s22 offen offset:0 sc1
  buffer_load_dwordx4 a[180:183], v2, s[8:11], s22 offen offset:1024 sc1
  buffer_load_dwordx4 a[184:187], v2, s[8:11], s22 offen offset:2048 sc1
  buffer_load_dwordx4 a[188:191], v2, s[8:11], s22 offen offset:3072 sc1
  s_add_u32 s22, s20, 49152
  buffer_load_dwordx4 a[192:195], v2, s[8:11], s22 offen offset:0 sc1
  buffer_load_dwordx4 a[196:199], v2, s[8:11], s22 offen offset:1024 sc1
  buffer_load_dwordx4 a[200:203], v2, s[8:11], s22 offen offset:2048 sc1
  buffer_load_dwordx4 a[204:207], v2, s[8:11], s22 offen offset:3072 sc1
  s_add_u32 s22, s20, 53248
  buffer_load_dwordx4 a[208:211], v2, s[8:11], s22 offen offset:0 sc1
  buffer_load_dwordx4 a[212:215], v2, s[8:11], s22 offen offset:1024 sc1
  buffer_load_dwordx4 a[216:219], v2, s[8:11], s22 offen offset:2048 sc1
  buffer_load_dwordx4 a[220:223], v2, s[8:11], s22 offen offset:3072 sc1
  s_add_u32 s22, s21, 229376
  buffer_load_dwordx4 a[224:227], v2, s[8:11], s22 offen offset:0 sc1
  buffer_load_dwordx4 a[228:231], v2, s[8:11], s22 offen offset:1024 sc1
  buffer_load_dwordx4 a[232:235], v2, s[8:11], s22 offen offset:2048 sc1
  buffer_load_dwordx4 a[236:239], v2, s[8:11], s22 offen offset:3072 sc1
  s_add_u32 s22, s21, 233472
  buffer_load_dwordx4 a[240:243], v2, s[8:11], s22 offen offset:0 sc1
  buffer_load_dwordx4 a[244:247], v2, s[8:11], s22 offen offset:1024 sc1
  buffer_load_dwordx4 a[248:251], v2, s[8:11], s22 offen offset:2048 sc1
  buffer_load_dwordx4 a[252:255], v2, s[8:11], s22 offen offset:3072 sc1
  s_waitcnt vmcnt(24)
  s_add_u32 s22, s21, 237568
  buffer_load_dwordx4 v[120:123], v2, s[8:11], s22 offen offset:0 sc1
  buffer_load_dwordx4 v[124:127], v2, s[8:11], s22 offen offset:1024 sc1
  buffer_load_dwordx4 v[128:131], v2, s[8:11], s22 offen offset:2048 sc1
  buffer_load_dwordx4 v[132:135], v2, s[8:11], s22 offen offset:3072 sc1
  s_add_u32 s22, s21, 241664
  buffer_load_dwordx4 v[136:139], v2, s[8:11], s22 offen offset:0 sc1
  buffer_load_dwordx4 v[140:143], v2, s[8:11], s22 offen offset:1024 sc1
  buffer_load_dwordx4 v[144:147], v2, s[8:11], s22 offen offset:2048 sc1
  buffer_load_dwordx4 v[148:151], v2, s[8:11], s22 offen offset:3072 sc1
  s_add_u32 s22, s21, 245760
  buffer_load_dwordx4 v[152:155], v2, s[8:11], s22 offen offset:0 sc1
  buffer_load_dwordx4 v[156:159], v2, s[8:11], s22 offen offset:1024 sc1
  buffer_load_dwordx4 v[160:163], v2, s[8:11], s22 offen offset:2048 sc1
  buffer_load_dwordx4 v[164:167], v2, s[8:11], s22 offen offset:3072 sc1
  s_add_u32 s22, s21, 249856
  buffer_load_dwordx4 v[168:171], v2, s[8:11], s22 offen offset:0 sc1
  buffer_load_dwordx4 v[172:175], v2, s[8:11], s22 offen offset:1024 sc1
  buffer_load_dwordx4 v[176:179], v2, s[8:11], s22 offen offset:2048 sc1
  buffer_load_dwordx4 v[180:183], v2, s[8:11], s22 offen offset:3072 sc1
  s_add_u32 s22, s21, 253952
  buffer_load_dwordx4 v[184:187], v2, s[8:11], s22 offen offset:0 sc1
  buffer_load_dwordx4 v[188:191], v2, s[8:11], s22 offen offset:1024 sc1
  buffer_load_dwordx4 v[192:195], v2, s[8:11], s22 offen offset:2048 sc1
  buffer_load_dwordx4 v[196:199], v2, s[8:11], s22 offen offset:3072 sc1
  s_add_u32 s22, s21, 258048
  buffer_load_dwordx4 v[200:203], v2, s[8:11], s22 offen offset:0 sc1
  buffer_load_dwordx4 v[204:207], v2, s[8:11], s22 offen offset:1024 sc1
  buffer_load_dwordx4 v[208:211], v2, s[8:11], s22 offen offset:2048 sc1
  buffer_load_dwordx4 v[212:215], v2, s[8:11], s22 offen offset:3072 sc1
  s_add_u32 s22, s21, 262144
  buffer_load_dwordx4 v[216:219], v2, s[8:11], s22 offen offset:0 sc1
  buffer_load_dwordx4 v[220:223], v2, s[8:11], s22 offen offset:1024 sc1
  buffer_load_dwordx4 v[224:227], v2, s[8:11], s22 offen offset:2048 sc1
  buffer_load_dwordx4 v[228:231], v2, s[8:11], s22 offen offset:3072 sc1
  s_add_u32 s22, s21, 266240
  buffer_load_dwordx4 v[232:235], v2, s[8:11], s22 offen offset:0 sc1
  buffer_load_dwordx4 v[236:239], v2, s[8:11], s22 offen offset:1024 sc1
  buffer_load_dwordx4 v[240:243], v2, s[8:11], s22 offen offset:2048 sc1
  buffer_load_dwordx4 v[244:247], v2, s[8:11], s22 offen offset:3072 sc1
  s_waitcnt vmcnt(24)
  s_add_u32 s22, s21, 270336
  buffer_load_dwordx4 v[248:251], v2, s[8:11], s22 offen offset:0 sc1
  buffer_load_dwordx4 v[252:255], v2, s[8:11], s22 offen offset:1024 sc1
  v_mov_b32 v5, 0x4444
  v_mov_b32 v6, 0xeeee
  v_cmp_lt_u32 vcc, 7, v4
  s_nop 1
  v_cndmask_b32 v5, v5, v6, vcc
  s_lshl_b32 s23, s16, 11
  v_lshrrev_b32 v80, 1, v3
  v_and_b32 v81, 1, v3
  v_add_u32 v83, 0, v80
  v_mov_b32 v84, v4
  v_mov_b32 v86, 0
  v_lshl_add_u32 v86, v83, 8, v86
  v_lshl_add_u32 v86, v84, 4, v86
  v_lshl_add_u32 v86, v81, 3, v86
  v_add_u32 v72, s23, v86
  v_add_u32 v83, 2, v80
  v_mov_b32 v84, v4
  v_mov_b32 v86, 0
  v_lshl_add_u32 v86, v83, 8, v86
  v_lshl_add_u32 v86, v84, 4, v86
  v_lshl_add_u32 v86, v81, 3, v86
  v_add_u32 v73, s23, v86
  v_lshl_add_u32 v82, v80, 4, v4
  v_mul_u32_u24 v83, 5462, v82
  v_lshrrev_b32 v83, 16, v83
  v_mul_u32_u24 v84, 12, v83
  v_sub_u32 v84, v82, v84
  v_mov_b32 v86, 1024
  v_lshl_add_u32 v86, v83, 8, v86
  v_lshl_add_u32 v86, v84, 4, v86
  v_lshl_add_u32 v86, v81, 3, v86
  v_add_u32 v74, s23, v86
  v_add_u32 v82, 32, v4
  v_mul_u32_u24 v83, 5462, v82
  v_lshrrev_b32 v83, 16, v83
  v_mul_u32_u24 v84, 12, v83
  v_sub_u32 v84, v82, v84
  v_mov_b32 v86, 1024
  v_lshl_add_u32 v86, v83, 8, v86
  v_lshl_add_u32 v86, v84, 4, v86
  v_lshl_add_u32 v86, v81, 3, v86
  v_add_u32 v75, s23, v86
  v_add_u32 v76, s23, v2
  s_mul_i32 s27, s18, 448
  v_mov_b32 v77, s27
  v_mov_b32 v78, 1
  s_mov_b32 s17, s19
  s_mul_i32 s24, s19, 7168
  s_add_u32 s24, s24, 88080384
  s_mul_i32 s25, s18, 65
  s_add_u32 s25, s25, s19
  s_lshl_b32 s25, s25, 13
  s_add_u32 s25, s25, s23
  s_add_u32 s25, s25, 76947456
  s_lshl_b32 s26, s18, 6
  s_add_u32 s26, s26, s19
  s_lshl_b32 s26, s26, 4
  s_lshl_b32 s27, s16, 2
  s_add_u32 s26, s26, s27
  s_add_u32 s26, s26, 88582144
  v_mov_b32 v87, -1
ws_loop:
  v_mov_b32 v36, 0
  v_mov_b32 v37, 0
  v_mov_b32 v38, 0
  v_mov_b32 v39, 0
  v_mov_b32 v40, 0
  v_mov_b32 v41, 0
  v_mov_b32 v42, 0
  v_mov_b32 v43, 0
  v_mov_b32 v44, 0
  v_mov_b32 v45, 0
  v_mov_b32 v46, 0
  v_mov_b32 v47, 0
  v_mov_b32 v48, 0
  v_mov_b32 v49, 0
  v_mov_b32 v50, 0
  v_mov_b32 v51, 0
  v_mov_b32 v52, 0
  v_mov_b32 v53, 0
  v_mov_b32 v54, 0
  v_mov_b32 v55, 0
  v_mov_b32 v56, 0
  v_mov_b32 v57, 0
  v_mov_b32 v58, 0
  v_mov_b32 v59, 0
  v_mov_b32 v60, 0
  v_mov_b32 v61, 0
  v_mov_b32 v62, 0
  v_mov_b32 v63, 0
  s_mov_b32 s30, 0
  v_cmp_eq_u32 vcc, -1, v87
  s_cbranch_vccz ws_fl
ws_pm:
  s_cmp_ge_u32 s17, 61
  s_cbranch_scc1 mp_55a
  v_mov_b32 v79, 0
  s_mov_b64 exec, 1
  buffer_atomic_or v79, v77, s[8:11], s24 offen sc0
  s_mov_b64 exec, -1
  s_branch mp_55b
mp_55a:
  buffer_load_dword v79, v77, s[8:11], s24 offen sc1
mp_55b:
  s_waitcnt vmcnt(0)
  v_cmp_eq_u32 vcc, -1, v79
  s_cbranch_vccnz ws_pr
ws_fl:
  s_add_u32 s22, s24, 4096
  buffer_load_dwordx4 v[8:11], v2, s[8:11], s24 offen offset:0 sc1
  buffer_load_dwordx4 v[12:15], v2, s[8:11], s24 offen offset:1024 sc1
  buffer_load_dwordx4 v[16:19], v2, s[8:11], s24 offen offset:2048 sc1
  buffer_load_dwordx4 v[20:23], v2, s[8:11], s24 offen offset:3072 sc1
  buffer_load_dwordx4 v[24:27], v2, s[8:11], s22 offen offset:0 sc1
  buffer_load_dwordx4 v[28:31], v2, s[8:11], s22 offen offset:1024 sc1
  buffer_load_dwordx4 v[32:35], v2, s[8:11], s22 offen offset:2048 sc1
  s_waitcnt vmcnt(0)
  v_max_u32 v79, v8, v9
  v_max3_u32 v79, v79, v10, v11
  v_max3_u32 v79, v79, v12, v13
  v_max3_u32 v79, v79, v14, v15
  v_max3_u32 v79, v79, v16, v17
  v_max3_u32 v79, v79, v18, v19
  v_max3_u32 v79, v79, v20, v21
  v_max3_u32 v79, v79, v22, v23
  v_max3_u32 v79, v79, v24, v25
  v_max3_u32 v79, v79, v26, v27
  v_max3_u32 v79, v79, v28, v29
  v_max3_u32 v79, v79, v30, v31
  v_max3_u32 v79, v79, v32, v33
  v_max3_u32 v79, v79, v34, v35
  v_cmp_eq_u32 vcc, -1, v79
  s_cbranch_vccz ws_pk
ws_pr:
  s_sleep 1
  s_cmp_ge_u32 s17, 61
  s_cbranch_scc1 ws_sh
  s_sleep 6
ws_sh:
  s_add_u32 s30, s30, 1
  s_cmp_lt_u32 s30, 30000
  s_cbranch_scc1 ws_pm
  s_branch cA_abort
ws_pk:
  s_cmp_ge_u32 s17, 62
  s_cbranch_scc1 ws_na
  s_add_u32 s22, s24, 14336
  s_cmp_ge_u32 s17, 61
  s_cbranch_scc1 mp_56a
  v_mov_b32 v87, 0
  s_mov_b64 exec, 1
  buffer_atomic_or v87, v77, s[8:11], s22 offen sc0
  s_mov_b64 exec, -1
  s_branch mp_56b
mp_56a:
  buffer_load_dword v87, v77, s[8:11], s22 offen sc1
mp_56b:
ws_na:
  v_smfmac_f32_16x16x64_bf16 v[36:39], v[8:11], a[0:7], v5
  v_smfmac_f32_16x16x64_bf16 v[36:39], v[12:15], a[8:15], v5
  v_smfmac_f32_16x16x64_bf16 v[36:39], v[16:19], a[16:23], v5
  v_smfmac_f32_16x16x64_bf16 v[36:39], v[20:23], a[24:31], v5
  v_smfmac_f32_16x16x64_bf16 v[36:39], v[24:27], a[32:39], v5
  v_smfmac_f32_16x16x64_bf16 v[36:39], v[28:31], a[40:47], v5
  v_smfmac_f32_16x16x64_bf16 v[36:39], v[32:35], a[48:55], v5
  v_smfmac_f32_16x16x64_bf16 v[40:43], v[8:11], a[56:63], v5
  v_smfmac_f32_16x16x64_bf16 v[40:43], v[12:15], a[64:71], v5
  v_smfmac_f32_16x16x64_bf16 v[40:43], v[16:19], a[72:79], v5
  v_smfmac_f32_16x16x64_bf16 v[40:43], v[20:23], a[80:87], v5
  v_smfmac_f32_16x16x64_bf16 v[40:43], v[24:27], a[88:95], v5
  v_smfmac_f32_16x16x64_bf16 v[40:43], v[28:31], a[96:103], v5
  v_smfmac_f32_16x16x64_bf16 v[40:43], v[32:35], a[104:111], v5
  v_smfmac_f32_16x16x64_bf16 v[44:47], v[8:11], a[112:119], v5
  v_smfmac_f32_16x16x64_bf16 v[44:47], v[12:15], a[120:127], v5
  v_smfmac_f32_16x16x64_bf16 v[44:47], v[16:19], a[128:135], v5
  v_smfmac_f32_16x16x64_bf16 v[44:47], v[20:23], a[136:143], v5
  v_smfmac_f32_16x16x64_bf16 v[44:47], v[24:27], a[144:151], v5
  v_smfmac_f32_16x16x64_bf16 v[44:47], v[28:31], a[152:159], v5
  v_smfmac_f32_16x16x64_bf16 v[44:47], v[32:35], a[160:167], v5
  v_smfmac_f32_16x16x64_bf16 v[48:51], v[8:11], a[168:175], v5
  v_smfmac_f32_16x16x64_bf16 v[48:51], v[12:15], a[176:183], v5
  v_smfmac_f32_16x16x64_bf16 v[48:51], v[16:19], a[184:191], v5
  v_smfmac_f32_16x16x64_bf16 v[48:51], v[20:23], a[192:199], v5
  v_smfmac_f32_16x16x64_bf16 v[48:51], v[24:27], a[200:207], v5
  v_smfmac_f32_16x16x64_bf16 v[48:51], v[28:31], a[208:215], v5
  v_smfmac_f32_16x16x64_bf16 v[48:51], v[32:35], a[216:223], v5
  v_smfmac_f32_16x16x64_bf16 v[52:55], v[8:11], a[224:231], v5
  v_smfmac_f32_16x16x64_bf16 v[52:55], v[12:15], a[232:239], v5
  v_smfmac_f32_16x16x64_bf16 v[52:55], v[16:19], a[240:247], v5
  v_smfmac_f32_16x16x64_bf16 v[52:55], v[20:23], a[248:255], v5
  v_smfmac_f32_16x16x64_bf16 v[52:55], v[24:27], v[120:127], v5
  v_smfmac_f32_16x16x64_bf16 v[52:55], v[28:31], v[128:135], v5
  v_smfmac_f32_16x16x64_bf16 v[52:55], v[32:35], v[136:143], v5
  v_smfmac_f32_16x16x64_bf16 v[56:59], v[8:11], v[144:151], v5
  v_smfmac_f32_16x16x64_bf16 v[56:59], v[12:15], v[152:159], v5
  v_smfmac_f32_16x16x64_bf16 v[56:59], v[16:19], v[160:167], v5
  v_smfmac_f32_16x16x64_bf16 v[56:59], v[20:23], v[168:175], v5
  v_smfmac_f32_16x16x64_bf16 v[56:59], v[24:27], v[176:183], v5
  v_smfmac_f32_16x16x64_bf16 v[56:59], v[28:31], v[184:191], v5
  v_smfmac_f32_16x16x64_bf16 v[56:59], v[32:35], v[192:199], v5
  v_smfmac_f32_16x16x64_bf16 v[60:63], v[8:11], v[200:207], v5
  v_smfmac_f32_16x16x64_bf16 v[60:63], v[12:15], v[208:215], v5
  v_smfmac_f32_16x16x64_bf16 v[60:63], v[16:19], v[216:223], v5
  v_smfmac_f32_16x16x64_bf16 v[60:63], v[20:23], v[224:231], v5
  v_smfmac_f32_16x16x64_bf16 v[60:63], v[24:27], v[232:239], v5
  v_smfmac_f32_16x16x64_bf16 v[60:63], v[28:31], v[240:247], v5
  v_smfmac_f32_16x16x64_bf16 v[60:63], v[32:35], v[248:255], v5
  v_permlane32_swap_b32 v36, v40
  v_permlane32_swap_b32 v37, v41
  v_permlane32_swap_b32 v38, v42
  v_permlane32_swap_b32 v39, v43
  v_add_f32 v36, v36, v40
  v_add_f32 v37, v37, v41
  v_add_f32 v38, v38, v42
  v_add_f32 v39, v39, v43
  v_cvt_pk_bf16_f32 v40, v36, v37
  v_cvt_pk_bf16_f32 v41, v38, v39
  ds_write_b64 v72, v[40:41]
  v_permlane32_swap_b32 v44, v48
  v_permlane32_swap_b32 v45, v49
  v_permlane32_swap_b32 v46, v50
  v_permlane32_swap_b32 v47, v51
  v_add_f32 v44, v44, v48
  v_add_f32 v45, v45, v49
  v_add_f32 v46, v46, v50
  v_add_f32 v47, v47, v51
  v_cvt_pk_bf16_f32 v48, v44, v45
  v_cvt_pk_bf16_f32 v49, v46, v47
  ds_write_b64 v73, v[48:49]
  v_permlane32_swap_b32 v52, v56
  v_permlane32_swap_b32 v53, v57
  v_permlane32_swap_b32 v54, v58
  v_permlane32_swap_b32 v55, v59
  v_add_f32 v52, v52, v56
  v_add_f32 v53, v53, v57
  v_add_f32 v54, v54, v58
  v_add_f32 v55, v55, v59
  v_cvt_pk_bf16_f32 v56, v52, v53
  v_cvt_pk_bf16_f32 v57, v54, v55
  ds_write_b64 v74, v[56:57]
  v_mov_b32 v64, v60
  v_mov_b32 v65, v61
  v_mov_b32 v66, v62
  v_mov_b32 v67, v63
  v_permlane32_swap_b32 v60, v64
  v_permlane32_swap_b32 v61, v65
  v_permlane32_swap_b32 v62, v66
  v_permlane32_swap_b32 v63, v67
  v_add_f32 v60, v60, v64
  v_add_f32 v61, v61, v65
  v_add_f32 v62, v62, v66
  v_add_f32 v63, v63, v67
  v_cvt_pk_bf16_f32 v64, v60, v61
  v_cvt_pk_bf16_f32 v65, v62, v63
  ds_write_b64 v75, v[64:65]
  s_waitcnt lgkmcnt(0)
  ds_read_b128 v[64:67], v76
  ds_read_b128 v[68:71], v76 offset:1024
  s_waitcnt lgkmcnt(0)
  buffer_store_dwordx4 v[64:67], v2, s[8:11], s25 offen sc1
  buffer_store_dwordx4 v[68:71], v2, s[8:11], s25 offen offset:1024 sc1
  s_waitcnt vmcnt(0)
  s_mov_b64 exec, 1
  buffer_store_dword v78, v2, s[8:11], s26 offen sc1
  s_mov_b64 exec, -1
  s_add_u32 s24, s24, 14336
  s_add_u32 s25, s25, 16384
  s_add_u32 s26, s26, 32
  s_add_u32 s17, s17, 2
  s_cmp_lt_u32 s17, 64
  s_cbranch_scc1 ws_loop
  v_mov_b32 v250, 0
  s_branch wk_loop
wk_s4d:
  s_cmp_lg_u32 s16, 0
  s_cbranch_scc1 w0_57
  s_getreg_b32 s20, hwreg(HW_REG_XCC_ID)
  s_sub_u32 s20, s20, 1
  s_and_b32 s20, s20, 7
  s_mov_b64 exec, 1
s4_l:
  s_cmp_ge_u32 s20, 7
  s_cselect_b32 s20, 0, s20
  s_lshl_b32 s21, s20, 7
  s_add_u32 s21, s21, 88598528
  v_mov_b32 v242, 1
  buffer_atomic_add v242, off, s[8:11], s21 sc0
  s_waitcnt vmcnt(0)
  v_readfirstlane_b32 s21, v242
  s_lshl_b32 s22, s20, 4
  s_add_u32 s20, s20, 1
  s_cmp_ge_u32 s21, 16
  s_cbranch_scc1 s4_l
  v_add_u32 v242, s22, v242
  s_mov_b64 exec, -1
w0_57:
  v_mov_b32 v243, 160000
  s_add_u32 s101, s101, 1
  s_barrier
  s_mov_b64 exec, 1
  s_cmp_lg_u32 s16, 0
  s_cbranch_scc1 w0_58
  ds_write_b32 v243, v242 offset:0
  s_waitcnt lgkmcnt(0)
  v_mov_b32 v242, s101
  ds_write_b32 v243, v242 offset:16
  s_waitcnt lgkmcnt(0)
w0_58:
  s_mov_b64 exec, -1
  s_barrier
  ds_read_b32 v242, v243 offset:0
  ds_read_b32 v243, v243 offset:16
  s_waitcnt lgkmcnt(0)
  v_readfirstlane_b32 s3, v242
  v_cmp_ne_u32 vcc, s101, v243
  s_cbranch_vccnz ch_end
  s_load_dwordx8 s[40:47], s[0:1], 0
  s_load_dwordx4 s[48:51], s[0:1], 32
  s_load_dwordx2 s[52:53], s[0:1], 48
  s_load_dwordx2 s[54:55], s[0:1], 112
  v_lshrrev_b32 v1, 6, v0
  s_nop 0
  v_readfirstlane_b32 s16, v1
  v_and_b32 v1, 63, v0
  v_lshrrev_b32 v3, 4, v1
  v_and_b32 v4, 15, v1
  s_mul_i32 s17, s16, 24576
  s_waitcnt lgkmcnt(0)
  s_mov_b32 s60, s40
  s_and_b32 s61, s41, 0xffff
  s_mov_b32 s62, 1835008
  s_mov_b32 s63, 0x20000
  s_mov_b32 s64, s42
  s_and_b32 s65, s43, 0xffff
  s_mov_b32 s66, 229376
  s_mov_b32 s67, 0x20000
  s_mov_b32 s68, s44
  s_and_b32 s69, s45, 0xffff
  s_mov_b32 s70, 229376
  s_mov_b32 s71, 0x20000
  s_mov_b32 s72, s46
  s_and_b32 s73, s47, 0xffff
  s_mov_b32 s74, 229376
  s_mov_b32 s75, 0x20000
  s_mov_b32 s76, s48
  s_and_b32 s77, s49, 0xffff
  s_mov_b32 s78, 229376
  s_mov_b32 s79, 0x20000
  s_mov_b32 s80, s50
  s_and_b32 s81, s51, 0xffff
  s_mov_b32 s82, 896
  s_mov_b32 s83, 0x20000
  s_mov_b32 s84, s52
  s_and_b32 s85, s53, 0xffff
  s_mov_b32 s86, 896
  s_mov_b32 s87, 0x20000
  s_mov_b32 s92, s54
  s_and_b32 s93, s55, 0xffff
  s_mov_b32 s94, 3670016
  s_mov_b32 s95, 0x20000
  v_lshlrev_b32 v5, 5, v1
  v_sub_u32 v5, 2047, v5
  s_add_u32 s18, s17, 13056
  v_subrev_u32 v6, 0, v5
  v_max_i32 v7, 0, v6
  v_cvt_f32_u32 v7, v7
  v_cvt_pk_bf16_f32 v8, v7, v7
  v_and_b32 v7, 0xffff0000, v8
  v_lshrrev_b32 v8, 23, v7
  v_subrev_u32 v8, 134, v8
  v_max_i32 v8, 0, v8
  v_cvt_u32_f32 v7, v7
  v_lshrrev_b32 v7, v8, v7
  v_lshl_add_u32 v7, v8, 8, v7
  v_lshl_add_u32 v200, v7, 2, s18
  v_subrev_u32 v6, 1, v5
  v_max_i32 v7, 0, v6
  v_cvt_f32_u32 v7, v7
  v_cvt_pk_bf16_f32 v8, v7, v7
  v_and_b32 v7, 0xffff0000, v8
  v_lshrrev_b32 v8, 23, v7
  v_subrev_u32 v8, 134, v8
  v_max_i32 v8, 0, v8
  v_cvt_u32_f32 v7, v7
  v_lshrrev_b32 v7, v8, v7
  v_lshl_add_u32 v7, v8, 8, v7
  v_lshl_add_u32 v201, v7, 2, s18
  v_subrev_u32 v6, 2, v5
  v_max_i32 v7, 0, v6
  v_cvt_f32_u32 v7, v7
  v_cvt_pk_bf16_f32 v8, v7, v7
  v_and_b32 v7, 0xffff0000, v8
  v_lshrrev_b32 v8, 23, v7
  v_subrev_u32 v8, 134, v8
  v_max_i32 v8, 0, v8
  v_cvt_u32_f32 v7, v7
  v_lshrrev_b32 v7, v8, v7
  v_lshl_add_u32 v7, v8, 8, v7
  v_lshl_add_u32 v202, v7, 2, s18
  v_subrev_u32 v6, 3, v5
  v_max_i32 v7, 0, v6
  v_cvt_f32_u32 v7, v7
  v_cvt_pk_bf16_f32 v8, v7, v7
  v_and_b32 v7, 0xffff0000, v8
  v_lshrrev_b32 v8, 23, v7
  v_subrev_u32 v8, 134, v8
  v_max_i32 v8, 0, v8
  v_cvt_u32_f32 v7, v7
  v_lshrrev_b32 v7, v8, v7
  v_lshl_add_u32 v7, v8, 8, v7
  v_lshl_add_u32 v203, v7, 2, s18
  v_subrev_u32 v6, 4, v5
  v_max_i32 v7, 0, v6
  v_cvt_f32_u32 v7, v7
  v_cvt_pk_bf16_f32 v8, v7, v7
  v_and_b32 v7, 0xffff0000, v8
  v_lshrrev_b32 v8, 23, v7
  v_subrev_u32 v8, 134, v8
  v_max_i32 v8, 0, v8
  v_cvt_u32_f32 v7, v7
  v_lshrrev_b32 v7, v8, v7
  v_lshl_add_u32 v7, v8, 8, v7
  v_lshl_add_u32 v204, v7, 2, s18
  v_subrev_u32 v6, 5, v5
  v_max_i32 v7, 0, v6
  v_cvt_f32_u32 v7, v7
  v_cvt_pk_bf16_f32 v8, v7, v7
  v_and_b32 v7, 0xffff0000, v8
  v_lshrrev_b32 v8, 23, v7
  v_subrev_u32 v8, 134, v8
  v_max_i32 v8, 0, v8
  v_cvt_u32_f32 v7, v7
  v_lshrrev_b32 v7, v8, v7
  v_lshl_add_u32 v7, v8, 8, v7
  v_lshl_add_u32 v205, v7, 2, s18
  v_subrev_u32 v6, 6, v5
  v_max_i32 v7, 0, v6
  v_cvt_f32_u32 v7, v7
  v_cvt_pk_bf16_f32 v8, v7, v7
  v_and_b32 v7, 0xffff0000, v8
  v_lshrrev_b32 v8, 23, v7
  v_subrev_u32 v8, 134, v8
  v_max_i32 v8, 0, v8
  v_cvt_u32_f32 v7, v7
  v_lshrrev_b32 v7, v8, v7
  v_lshl_add_u32 v7, v8, 8, v7
  v_lshl_add_u32 v206, v7, 2, s18
  v_subrev_u32 v6, 7, v5
  v_max_i32 v7, 0, v6
  v_cvt_f32_u32 v7, v7
  v_cvt_pk_bf16_f32 v8, v7, v7
  v_and_b32 v7, 0xffff0000, v8
  v_lshrrev_b32 v8, 23, v7
  v_subrev_u32 v8, 134, v8
  v_max_i32 v8, 0, v8
  v_cvt_u32_f32 v7, v7
  v_lshrrev_b32 v7, v8, v7
  v_lshl_add_u32 v7, v8, 8, v7
  v_lshl_add_u32 v207, v7, 2, s18
  v_subrev_u32 v6, 8, v5
  v_max_i32 v7, 0, v6
  v_cvt_f32_u32 v7, v7
  v_cvt_pk_bf16_f32 v8, v7, v7
  v_and_b32 v7, 0xffff0000, v8
  v_lshrrev_b32 v8, 23, v7
  v_subrev_u32 v8, 134, v8
  v_max_i32 v8, 0, v8
  v_cvt_u32_f32 v7, v7
  v_lshrrev_b32 v7, v8, v7
  v_lshl_add_u32 v7, v8, 8, v7
  v_lshl_add_u32 v208, v7, 2, s18
  v_subrev_u32 v6, 9, v5
  v_max_i32 v7, 0, v6
  v_cvt_f32_u32 v7, v7
  v_cvt_pk_bf16_f32 v8, v7, v7
  v_and_b32 v7, 0xffff0000, v8
  v_lshrrev_b32 v8, 23, v7
  v_subrev_u32 v8, 134, v8
  v_max_i32 v8, 0, v8
  v_cvt_u32_f32 v7, v7
  v_lshrrev_b32 v7, v8, v7
  v_lshl_add_u32 v7, v8, 8, v7
  v_lshl_add_u32 v209, v7, 2, s18
  v_subrev_u32 v6, 10, v5
  v_max_i32 v7, 0, v6
  v_cvt_f32_u32 v7, v7
  v_cvt_pk_bf16_f32 v8, v7, v7
  v_and_b32 v7, 0xffff0000, v8
  v_lshrrev_b32 v8, 23, v7
  v_subrev_u32 v8, 134, v8
  v_max_i32 v8, 0, v8
  v_cvt_u32_f32 v7, v7
  v_lshrrev_b32 v7, v8, v7
  v_lshl_add_u32 v7, v8, 8, v7
  v_lshl_add_u32 v210, v7, 2, s18
  v_subrev_u32 v6, 11, v5
  v_max_i32 v7, 0, v6
  v_cvt_f32_u32 v7, v7
  v_cvt_pk_bf16_f32 v8, v7, v7
  v_and_b32 v7, 0xffff0000, v8
  v_lshrrev_b32 v8, 23, v7
  v_subrev_u32 v8, 134, v8
  v_max_i32 v8, 0, v8
  v_cvt_u32_f32 v7, v7
  v_lshrrev_b32 v7, v8, v7
  v_lshl_add_u32 v7, v8, 8, v7
  v_lshl_add_u32 v211, v7, 2, s18
  v_subrev_u32 v6, 12, v5
  v_max_i32 v7, 0, v6
  v_cvt_f32_u32 v7, v7
  v_cvt_pk_bf16_f32 v8, v7, v7
  v_and_b32 v7, 0xffff0000, v8
  v_lshrrev_b32 v8, 23, v7
  v_subrev_u32 v8, 134, v8
  v_max_i32 v8, 0, v8
  v_cvt_u32_f32 v7, v7
  v_lshrrev_b32 v7, v8, v7
  v_lshl_add_u32 v7, v8, 8, v7
  v_lshl_add_u32 v212, v7, 2, s18
  v_subrev_u32 v6, 13, v5
  v_max_i32 v7, 0, v6
  v_cvt_f32_u32 v7, v7
  v_cvt_pk_bf16_f32 v8, v7, v7
  v_and_b32 v7, 0xffff0000, v8
  v_lshrrev_b32 v8, 23, v7
  v_subrev_u32 v8, 134, v8
  v_max_i32 v8, 0, v8
  v_cvt_u32_f32 v7, v7
  v_lshrrev_b32 v7, v8, v7
  v_lshl_add_u32 v7, v8, 8, v7
  v_lshl_add_u32 v213, v7, 2, s18
  v_subrev_u32 v6, 14, v5
  v_max_i32 v7, 0, v6
  v_cvt_f32_u32 v7, v7
  v_cvt_pk_bf16_f32 v8, v7, v7
  v_and_b32 v7, 0xffff0000, v8
  v_lshrrev_b32 v8, 23, v7
  v_subrev_u32 v8, 134, v8
  v_max_i32 v8, 0, v8
  v_cvt_u32_f32 v7, v7
  v_lshrrev_b32 v7, v8, v7
  v_lshl_add_u32 v7, v8, 8, v7
  v_lshl_add_u32 v214, v7, 2, s18
  v_subrev_u32 v6, 15, v5
  v_max_i32 v7, 0, v6
  v_cvt_f32_u32 v7, v7
  v_cvt_pk_bf16_f32 v8, v7, v7
  v_and_b32 v7, 0xffff0000, v8
  v_lshrrev_b32 v8, 23, v7
  v_subrev_u32 v8, 134, v8
  v_max_i32 v8, 0, v8
  v_cvt_u32_f32 v7, v7
  v_lshrrev_b32 v7, v8, v7
  v_lshl_add_u32 v7, v8, 8, v7
  v_lshl_add_u32 v215, v7, 2, s18
  v_subrev_u32 v6, 16, v5
  v_max_i32 v7, 0, v6
  v_cvt_f32_u32 v7, v7
  v_cvt_pk_bf16_f32 v8, v7, v7
  v_and_b32 v7, 0xffff0000, v8
  v_lshrrev_b32 v8, 23, v7
  v_subrev_u32 v8, 134, v8
  v_max_i32 v8, 0, v8
  v_cvt_u32_f32 v7, v7
  v_lshrrev_b32 v7, v8, v7
  v_lshl_add_u32 v7, v8, 8, v7
  v_lshl_add_u32 v216, v7, 2, s18
  v_subrev_u32 v6, 17, v5
  v_max_i32 v7, 0, v6
  v_cvt_f32_u32 v7, v7
  v_cvt_pk_bf16_f32 v8, v7, v7
  v_and_b32 v7, 0xffff0000, v8
  v_lshrrev_b32 v8, 23, v7
  v_subrev_u32 v8, 134, v8
  v_max_i32 v8, 0, v8
  v_cvt_u32_f32 v7, v7
  v_lshrrev_b32 v7, v8, v7
  v_lshl_add_u32 v7, v8, 8, v7
  v_lshl_add_u32 v217, v7, 2, s18
  v_subrev_u32 v6, 18, v5
  v_max_i32 v7, 0, v6
  v_cvt_f32_u32 v7, v7
  v_cvt_pk_bf16_f32 v8, v7, v7
  v_and_b32 v7, 0xffff0000, v8
  v_lshrrev_b32 v8, 23, v7
  v_subrev_u32 v8, 134, v8
  v_max_i32 v8, 0, v8
  v_cvt_u32_f32 v7, v7
  v_lshrrev_b32 v7, v8, v7
  v_lshl_add_u32 v7, v8, 8, v7
  v_lshl_add_u32 v218, v7, 2, s18
  v_subrev_u32 v6, 19, v5
  v_max_i32 v7, 0, v6
  v_cvt_f32_u32 v7, v7
  v_cvt_pk_bf16_f32 v8, v7, v7
  v_and_b32 v7, 0xffff0000, v8
  v_lshrrev_b32 v8, 23, v7
  v_subrev_u32 v8, 134, v8
  v_max_i32 v8, 0, v8
  v_cvt_u32_f32 v7, v7
  v_lshrrev_b32 v7, v8, v7
  v_lshl_add_u32 v7, v8, 8, v7
  v_lshl_add_u32 v219, v7, 2, s18
  v_subrev_u32 v6, 20, v5
  v_max_i32 v7, 0, v6
  v_cvt_f32_u32 v7, v7
  v_cvt_pk_bf16_f32 v8, v7, v7
  v_and_b32 v7, 0xffff0000, v8
  v_lshrrev_b32 v8, 23, v7
  v_subrev_u32 v8, 134, v8
  v_max_i32 v8, 0, v8
  v_cvt_u32_f32 v7, v7
  v_lshrrev_b32 v7, v8, v7
  v_lshl_add_u32 v7, v8, 8, v7
  v_lshl_add_u32 v220, v7, 2, s18
  v_subrev_u32 v6, 21, v5
  v_max_i32 v7, 0, v6
  v_cvt_f32_u32 v7, v7
  v_cvt_pk_bf16_f32 v8, v7, v7
  v_and_b32 v7, 0xffff0000, v8
  v_lshrrev_b32 v8, 23, v7
  v_subrev_u32 v8, 134, v8
  v_max_i32 v8, 0, v8
  v_cvt_u32_f32 v7, v7
  v_lshrrev_b32 v7, v8, v7
  v_lshl_add_u32 v7, v8, 8, v7
  v_lshl_add_u32 v221, v7, 2, s18
  v_subrev_u32 v6, 22, v5
  v_max_i32 v7, 0, v6
  v_cvt_f32_u32 v7, v7
  v_cvt_pk_bf16_f32 v8, v7, v7
  v_and_b32 v7, 0xffff0000, v8
  v_lshrrev_b32 v8, 23, v7
  v_subrev_u32 v8, 134, v8
  v_max_i32 v8, 0, v8
  v_cvt_u32_f32 v7, v7
  v_lshrrev_b32 v7, v8, v7
  v_lshl_add_u32 v7, v8, 8, v7
  v_lshl_add_u32 v222, v7, 2, s18
  v_subrev_u32 v6, 23, v5
  v_max_i32 v7, 0, v6
  v_cvt_f32_u32 v7, v7
  v_cvt_pk_bf16_f32 v8, v7, v7
  v_and_b32 v7, 0xffff0000, v8
  v_lshrrev_b32 v8, 23, v7
  v_subrev_u32 v8, 134, v8
  v_max_i32 v8, 0, v8
  v_cvt_u32_f32 v7, v7
  v_lshrrev_b32 v7, v8, v7
  v_lshl_add_u32 v7, v8, 8, v7
  v_lshl_add_u32 v223, v7, 2, s18
  v_subrev_u32 v6, 24, v5
  v_max_i32 v7, 0, v6
  v_cvt_f32_u32 v7, v7
  v_cvt_pk_bf16_f32 v8, v7, v7
  v_and_b32 v7, 0xffff0000, v8
  v_lshrrev_b32 v8, 23, v7
  v_subrev_u32 v8, 134, v8
  v_max_i32 v8, 0, v8
  v_cvt_u32_f32 v7, v7
  v_lshrrev_b32 v7, v8, v7
  v_lshl_add_u32 v7, v8, 8, v7
  v_lshl_add_u32 v224, v7, 2, s18
  v_subrev_u32 v6, 25, v5
  v_max_i32 v7, 0, v6
  v_cvt_f32_u32 v7, v7
  v_cvt_pk_bf16_f32 v8, v7, v7
  v_and_b32 v7, 0xffff0000, v8
  v_lshrrev_b32 v8, 23, v7
  v_subrev_u32 v8, 134, v8
  v_max_i32 v8, 0, v8
  v_cvt_u32_f32 v7, v7
  v_lshrrev_b32 v7, v8, v7
  v_lshl_add_u32 v7, v8, 8, v7
  v_lshl_add_u32 v225, v7, 2, s18
  v_subrev_u32 v6, 26, v5
  v_max_i32 v7, 0, v6
  v_cvt_f32_u32 v7, v7
  v_cvt_pk_bf16_f32 v8, v7, v7
  v_and_b32 v7, 0xffff0000, v8
  v_lshrrev_b32 v8, 23, v7
  v_subrev_u32 v8, 134, v8
  v_max_i32 v8, 0, v8
  v_cvt_u32_f32 v7, v7
  v_lshrrev_b32 v7, v8, v7
  v_lshl_add_u32 v7, v8, 8, v7
  v_lshl_add_u32 v226, v7, 2, s18
  v_subrev_u32 v6, 27, v5
  v_max_i32 v7, 0, v6
  v_cvt_f32_u32 v7, v7
  v_cvt_pk_bf16_f32 v8, v7, v7
  v_and_b32 v7, 0xffff0000, v8
  v_lshrrev_b32 v8, 23, v7
  v_subrev_u32 v8, 134, v8
  v_max_i32 v8, 0, v8
  v_cvt_u32_f32 v7, v7
  v_lshrrev_b32 v7, v8, v7
  v_lshl_add_u32 v7, v8, 8, v7
  v_lshl_add_u32 v227, v7, 2, s18
  v_subrev_u32 v6, 28, v5
  v_max_i32 v7, 0, v6
  v_cvt_f32_u32 v7, v7
  v_cvt_pk_bf16_f32 v8, v7, v7
  v_and_b32 v7, 0xffff0000, v8
  v_lshrrev_b32 v8, 23, v7
  v_subrev_u32 v8, 134, v8
  v_max_i32 v8, 0, v8
  v_cvt_u32_f32 v7, v7
  v_lshrrev_b32 v7, v8, v7
  v_lshl_add_u32 v7, v8, 8, v7
  v_lshl_add_u32 v228, v7, 2, s18
  v_subrev_u32 v6, 29, v5
  v_max_i32 v7, 0, v6
  v_cvt_f32_u32 v7, v7
  v_cvt_pk_bf16_f32 v8, v7, v7
  v_and_b32 v7, 0xffff0000, v8
  v_lshrrev_b32 v8, 23, v7
  v_subrev_u32 v8, 134, v8
  v_max_i32 v8, 0, v8
  v_cvt_u32_f32 v7, v7
  v_lshrrev_b32 v7, v8, v7
  v_lshl_add_u32 v7, v8, 8, v7
  v_lshl_add_u32 v229, v7, 2, s18
  v_subrev_u32 v6, 30, v5
  v_max_i32 v7, 0, v6
  v_cvt_f32_u32 v7, v7
  v_cvt_pk_bf16_f32 v8, v7, v7
  v_and_b32 v7, 0xffff0000, v8
  v_lshrrev_b32 v8, 23, v7
  v_subrev_u32 v8, 134, v8
  v_max_i32 v8, 0, v8
  v_cvt_u32_f32 v7, v7
  v_lshrrev_b32 v7, v8, v7
  v_lshl_add_u32 v7, v8, 8, v7
  v_lshl_add_u32 v230, v7, 2, s18
  v_subrev_u32 v6, 31, v5
  v_max_i32 v7, 0, v6
  v_cvt_f32_u32 v7, v7
  v_cvt_pk_bf16_f32 v8, v7, v7
  v_and_b32 v7, 0xffff0000, v8
  v_lshrrev_b32 v8, 23, v7
  v_subrev_u32 v8, 134, v8
  v_max_i32 v8, 0, v8
  v_cvt_u32_f32 v7, v7
  v_lshrrev_b32 v7, v8, v7
  v_lshl_add_u32 v7, v8, 8, v7
  v_lshl_add_u32 v231, v7, 2, s18
  v_subrev_u32 v6, 32, v5
  v_max_i32 v7, 0, v6
  v_cvt_f32_u32 v7, v7
  v_cvt_pk_bf16_f32 v8, v7, v7
  v_and_b32 v7, 0xffff0000, v8
  v_lshrrev_b32 v8, 23, v7
  v_subrev_u32 v8, 134, v8
  v_max_i32 v8, 0, v8
  v_cvt_u32_f32 v7, v7
  v_lshrrev_b32 v7, v8, v7
  v_lshl_add_u32 v7, v8, 8, v7
  v_mov_b32 v8, 1280
  v_cmp_gt_i32 vcc, 0, v6
  s_nop 1
  v_cndmask_b32 v7, v7, v8, vcc
  v_lshl_add_u32 v232, v7, 2, s18
  v_mov_b32 v8, 0
  v_mov_b32 v9, 0
  v_lshlrev_b32 v5, 3, v1
  v_add_u32 v5, s17, v5
  ds_write_b64 v5, v[8:9]
  v_and_b32 v6, 15, v1
  v_lshlrev_b32 v6, 3, v6
  v_add_u32 v6, s17, v6
  ds_write_b64 v6, v[8:9] offset:8704
  ds_write_b64 v6, v[8:9] offset:12928
  v_mov_b32 v6, s17
  ds_write_b64 v6, v[8:9] offset:18176
  s_lshl_b32 s19, s3, 2
  s_add_u32 s20, s19, s16
  s_lshl_b32 s21, s3, 3
  v_mul_u32_u24 v5, 3584, v0
  v_mul_u32_u24 v141, 1792, v0
  s_lshl_b32 s22, s20, 9
  v_lshlrev_b32 v6, 3, v1
  buffer_load_dwordx2 v[24:25], v6, s[64:67], s22 offen
  buffer_load_dwordx2 v[26:27], v6, s[68:71], s22 offen
  buffer_load_dwordx2 v[28:29], v6, s[72:75], s22 offen
  buffer_load_dwordx2 v[30:31], v6, s[76:79], s22 offen
  s_lshl_b32 s22, s20, 1
  v_mov_b32 v7, 0
  buffer_load_ushort v32, v7, s[80:83], s22 offen
  buffer_load_ushort v33, v7, s[84:87], s22 offen
  s_mov_b32 s24, 0x05040100
  s_mov_b32 s25, 0x07060302
  s_barrier
  s_waitcnt vmcnt(0)
  s_mov_b32 s26, 1069066811
  s_mov_b32 s27, 1042479491
  v_lshlrev_b32 v32, 16, v32
  v_lshlrev_b32 v33, 16, v33
  v_mul_f32 v32, s26, v32
  v_exp_f32 v32, v32
  s_nop 0
  v_cvt_pk_bf16_f32 v34, v32, v32
  v_and_b32 v32, 0xffff0000, v34
  v_lshlrev_b32 v37, 6, v1
  v_add_u32 v37, s17, v37
  v_lshlrev_b32 v40, 16, v24
  v_lshlrev_b32 v41, 16, v26
  v_lshlrev_b32 v42, 16, v28
  v_lshlrev_b32 v43, 16, v30
  v_mul_f32 v40, s26, v40
  v_exp_f32 v40, v40
  s_nop 0
  v_cvt_pk_bf16_f32 v34, v40, v40
  v_and_b32 v40, 0xffff0000, v34
  v_mul_f32 v40, v40, v32
  v_mul_f32 v40, s26, v40
  v_sub_f32 v40, 0, v40
  v_mul_f32 v41, v41, v32
  v_mul_f32 v41, s27, v41
  v_mul_f32 v42, v42, v32
  v_mul_f32 v43, v43, v32
  v_add_f32 v42, v42, v42
  v_add_f32 v43, v43, v43
  ds_write_b128 v37, v[40:43] offset:18240
  v_and_b32 v40, 0xffff0000, v24
  v_and_b32 v41, 0xffff0000, v26
  v_and_b32 v42, 0xffff0000, v28
  v_and_b32 v43, 0xffff0000, v30
  v_mul_f32 v40, s26, v40
  v_exp_f32 v40, v40
  s_nop 0
  v_cvt_pk_bf16_f32 v34, v40, v40
  v_and_b32 v40, 0xffff0000, v34
  v_mul_f32 v40, v40, v32
  v_mul_f32 v40, s26, v40
  v_sub_f32 v40, 0, v40
  v_mul_f32 v41, v41, v32
  v_mul_f32 v41, s27, v41
  v_mul_f32 v42, v42, v32
  v_mul_f32 v43, v43, v32
  v_add_f32 v42, v42, v42
  v_add_f32 v43, v43, v43
  ds_write_b128 v37, v[40:43] offset:18256
  v_lshlrev_b32 v40, 16, v25
  v_lshlrev_b32 v41, 16, v27
  v_lshlrev_b32 v42, 16, v29
  v_lshlrev_b32 v43, 16, v31
  v_mul_f32 v40, s26, v40
  v_exp_f32 v40, v40
  s_nop 0
  v_cvt_pk_bf16_f32 v34, v40, v40
  v_and_b32 v40, 0xffff0000, v34
  v_mul_f32 v40, v40, v32
  v_mul_f32 v40, s26, v40
  v_sub_f32 v40, 0, v40
  v_mul_f32 v41, v41, v32
  v_mul_f32 v41, s27, v41
  v_mul_f32 v42, v42, v32
  v_mul_f32 v43, v43, v32
  v_add_f32 v42, v42, v42
  v_add_f32 v43, v43, v43
  ds_write_b128 v37, v[40:43] offset:18272
  v_and_b32 v40, 0xffff0000, v25
  v_and_b32 v41, 0xffff0000, v27
  v_and_b32 v42, 0xffff0000, v29
  v_and_b32 v43, 0xffff0000, v31
  v_mul_f32 v40, s26, v40
  v_exp_f32 v40, v40
  s_nop 0
  v_cvt_pk_bf16_f32 v34, v40, v40
  v_and_b32 v40, 0xffff0000, v34
  v_mul_f32 v40, v40, v32
  v_mul_f32 v40, s26, v40
  v_sub_f32 v40, 0, v40
  v_mul_f32 v41, v41, v32
  v_mul_f32 v41, s27, v41
  v_mul_f32 v42, v42, v32
  v_mul_f32 v43, v43, v32
  v_add_f32 v42, v42, v42
  v_add_f32 v43, v43, v43
  ds_write_b128 v37, v[40:43] offset:18288
  v_cvt_f32_u32 v44, v4
  v_lshlrev_b32 v45, 4, v4
  v_cvt_f32_u32 v45, v45
  v_lshlrev_b32 v46, 4, v3
  v_add_u32 v46, s17, v46
  v_mov_b32 v48, 0
  v_mov_b32 v49, 0
  v_mov_b32 v50, 0
  v_mov_b32 v51, 0
  v_mov_b32 v52, 0
  v_mov_b32 v53, 0
  v_mov_b32 v54, 0
  v_mov_b32 v55, 0
  v_mov_b32 v56, 0
  v_mov_b32 v57, 0
  v_mov_b32 v58, 0
  v_mov_b32 v59, 0
  v_mov_b32 v60, 0
  v_mov_b32 v61, 0
  v_mov_b32 v62, 0
  v_mov_b32 v63, 0
  v_mov_b32 v64, 0
  v_mov_b32 v65, 0
  v_mov_b32 v66, 0
  v_mov_b32 v67, 0
  s_waitcnt lgkmcnt(0)
  ds_read_b128 v[68:71], v46 offset:18240
  s_add_u32 s22, s21, 0
  buffer_load_dwordx2 v[8:9], v5, s[60:63], s22 offen offset:0
  s_mov_b32 s28, 0
  s_call_b64 s[30:31], wk_kl
  s_mov_b32 s28, 0
  s_call_b64 s[30:31], wk_kl
  s_add_u32 s22, s21, 0
  buffer_load_dwordx2 v[10:11], v5, s[60:63], s22 offen offset:896
  s_mov_b32 s28, 0
  s_call_b64 s[30:31], wk_kl
  s_mov_b32 s28, 0
  s_call_b64 s[30:31], wk_kl
  s_add_u32 s22, s21, 0
  buffer_load_dwordx2 v[12:13], v5, s[60:63], s22 offen offset:1792
  s_mov_b32 s28, 0
  s_call_b64 s[30:31], wk_kl
  s_mov_b32 s28, 0
  s_call_b64 s[30:31], wk_kl
  s_add_u32 s22, s21, 0
  buffer_load_dwordx2 v[14:15], v5, s[60:63], s22 offen offset:2688
  s_mov_b32 s28, 0
  s_call_b64 s[30:31], wk_kl
  s_mov_b32 s28, 0
  s_call_b64 s[30:31], wk_kl
  s_add_u32 s22, s21, 917504
  buffer_load_dwordx2 v[16:17], v5, s[60:63], s22 offen offset:0
  s_mov_b32 s28, 0
  s_call_b64 s[30:31], wk_kl
  s_mov_b32 s28, 0
  s_call_b64 s[30:31], wk_kl
  s_add_u32 s22, s21, 917504
  buffer_load_dwordx2 v[18:19], v5, s[60:63], s22 offen offset:896
  s_mov_b32 s28, 0
  s_call_b64 s[30:31], wk_kl
  s_mov_b32 s28, 0
  s_call_b64 s[30:31], wk_kl
  s_add_u32 s22, s21, 917504
  buffer_load_dwordx2 v[20:21], v5, s[60:63], s22 offen offset:1792
  s_mov_b32 s28, 0
  s_call_b64 s[30:31], wk_kl
  s_mov_b32 s28, 0
  s_call_b64 s[30:31], wk_kl
  s_add_u32 s22, s21, 917504
  buffer_load_dwordx2 v[22:23], v5, s[60:63], s22 offen offset:2688
  s_mov_b32 s28, 0
  s_call_b64 s[30:31], wk_kl
  s_mov_b32 s28, 0
  s_call_b64 s[30:31], wk_kl
  s_branch wk_kd
wk_kl:
  s_waitcnt lgkmcnt(0)
  v_mov_b32 v72, v68
  v_mov_b32 v73, v69
  v_mov_b32 v74, v70
  v_mov_b32 v75, v71
  v_add_u32 v46, 64, v46
  ds_read_b128 v[68:71], v46 offset:18240
  v_mul_f32 v80, v72, v45
  v_mul_f32 v81, v73, v45
  v_exp_f32 v80, v80
  v_fract_f32 v81, v81
  v_cos_f32 v76, v81
  v_sin_f32 v77, v81
  v_mul_f32 v76, v76, v80
  v_mul_f32 v77, v77, v80
  v_mul_f32 v80, v72, v44
  v_mul_f32 v81, v73, v44
  v_exp_f32 v80, v80
  v_fract_f32 v81, v81
  v_cos_f32 v78, v81
  v_sin_f32 v79, v81
  v_mul_f32 v78, v78, v80
  v_mul_f32 v79, v79, v80
  v_mul_f32 v82, v74, v76
  v_mul_f32 v83, v74, v77
  v_fma_f32 v82, -v75, v77, v82
  v_fma_f32 v83, -v75, v76, -v83
  v_mul_f32 v86, v76, v76
  v_mul_f32 v87, v76, v77
  v_fma_f32 v86, -v77, v77, v86
  v_add_f32 v87, v87, v87
  v_mfma_f32_16x16x4_f32 v[48:51], v82, v78, v[48:51]
  v_mul_f32 v88, v78, v78
  v_mul_f32 v89, v78, v79
  v_fma_f32 v88, -v79, v79, v88
  v_add_f32 v89, v89, v89
  v_mfma_f32_16x16x4_f32 v[48:51], v83, v79, v[48:51]
  v_mul_f32 v84, v74, v86
  v_mul_f32 v85, v74, v87
  v_fma_f32 v84, -v75, v87, v84
  v_fma_f32 v85, -v75, v86, -v85
  v_mul_f32 v76, v86, v86
  v_mul_f32 v77, v86, v87
  v_fma_f32 v76, -v87, v87, v76
  v_add_f32 v77, v77, v77
  v_mfma_f32_16x16x4_f32 v[52:55], v84, v88, v[52:55]
  v_mul_f32 v78, v88, v88
  v_mul_f32 v79, v88, v89
  v_fma_f32 v78, -v89, v89, v78
  v_add_f32 v79, v79, v79
  v_mfma_f32_16x16x4_f32 v[52:55], v85, v89, v[52:55]
  v_mul_f32 v82, v74, v76
  v_mul_f32 v83, v74, v77
  v_fma_f32 v82, -v75, v77, v82
  v_fma_f32 v83, -v75, v76, -v83
  v_mul_f32 v86, v76, v76
  v_mul_f32 v87, v76, v77
  v_fma_f32 v86, -v77, v77, v86
  v_add_f32 v87, v87, v87
  v_mfma_f32_16x16x4_f32 v[56:59], v82, v78, v[56:59]
  v_mul_f32 v88, v78, v78
  v_mul_f32 v89, v78, v79
  v_fma_f32 v88, -v79, v79, v88
  v_add_f32 v89, v89, v89
  v_mfma_f32_16x16x4_f32 v[56:59], v83, v79, v[56:59]
  v_mul_f32 v84, v74, v86
  v_mul_f32 v85, v74, v87
  v_fma_f32 v84, -v75, v87, v84
  v_fma_f32 v85, -v75, v86, -v85
  v_mul_f32 v76, v86, v86
  v_mul_f32 v77, v86, v87
  v_fma_f32 v76, -v87, v87, v76
  v_add_f32 v77, v77, v77
  v_mfma_f32_16x16x4_f32 v[60:63], v84, v88, v[60:63]
  v_mfma_f32_16x16x4_f32 v[60:63], v85, v89, v[60:63]
  v_mul_f32 v82, v74, v76
  v_fma_f32 v82, -v75, v77, v82
  s_nop 1
  v_mfma_f32_16x16x4_f32 v[64:67], v82, v88, v[64:67]
  s_add_u32 s28, s28, 1
  s_cmp_lt_u32 s28, 4
  s_cbranch_scc1 wk_kl
  s_setpc_b64 s[30:31]
wk_kd:
  s_nop 15
  s_nop 3
  s_waitcnt vmcnt(0)
  v_lshlrev_b32 v6, 3, v0
  v_perm_b32 v34, v10, v8, s24
  v_perm_b32 v35, v14, v12, s24
  v_add_u32 v36, 512, v6
  ds_write_b64 v36, v[34:35]
  v_perm_b32 v34, v10, v8, s25
  v_perm_b32 v35, v14, v12, s25
  v_add_u32 v36, 25088, v6
  ds_write_b64 v36, v[34:35]
  v_perm_b32 v34, v11, v9, s24
  v_perm_b32 v35, v15, v13, s24
  v_add_u32 v36, 49664, v6
  ds_write_b64 v36, v[34:35]
  v_perm_b32 v34, v11, v9, s25
  v_perm_b32 v35, v15, v13, s25
  v_add_u32 v36, 74240, v6
  ds_write_b64 v36, v[34:35]
  v_perm_b32 v34, v18, v16, s24
  v_perm_b32 v35, v22, v20, s24
  v_add_u32 v36, 2560, v6
  ds_write_b64 v36, v[34:35]
  v_perm_b32 v34, v18, v16, s25
  v_perm_b32 v35, v22, v20, s25
  v_add_u32 v36, 27136, v6
  ds_write_b64 v36, v[34:35]
  v_perm_b32 v34, v19, v17, s24
  v_perm_b32 v35, v23, v21, s24
  v_add_u32 v36, 51712, v6
  ds_write_b64 v36, v[34:35]
  v_perm_b32 v34, v19, v17, s25
  v_perm_b32 v35, v23, v21, s25
  v_add_u32 v36, 76288, v6
  ds_write_b64 v36, v[34:35]
  v_lshlrev_b32 v46, 8, v3
  v_lshl_add_u32 v46, v4, 2, v46
  v_add_u32 v46, s17, v46
  ds_write_b32 v46, v48 offset:13056
  ds_write_b32 v46, v49 offset:13120
  ds_write_b32 v46, v50 offset:13184
  ds_write_b32 v46, v51 offset:13248
  s_waitcnt lgkmcnt(8)
  ds_write_b32 v46, v52 offset:14080
  ds_write_b32 v46, v53 offset:14144
  ds_write_b32 v46, v54 offset:14208
  ds_write_b32 v46, v55 offset:14272
  s_waitcnt lgkmcnt(8)
  ds_write_b32 v46, v56 offset:15104
  ds_write_b32 v46, v57 offset:15168
  ds_write_b32 v46, v58 offset:15232
  ds_write_b32 v46, v59 offset:15296
  s_waitcnt lgkmcnt(8)
  ds_write_b32 v46, v60 offset:16128
  ds_write_b32 v46, v61 offset:16192
  ds_write_b32 v46, v62 offset:16256
  ds_write_b32 v46, v63 offset:16320
  s_waitcnt lgkmcnt(8)
  ds_write_b32 v46, v64 offset:17152
  ds_write_b32 v46, v65 offset:17216
  ds_write_b32 v46, v66 offset:17280
  ds_write_b32 v46, v67 offset:17344
  s_waitcnt lgkmcnt(8)
  s_waitcnt lgkmcnt(0)
  ds_read_b32 v48, v200
  ds_read_b32 v49, v201
  ds_read_b32 v50, v202
  ds_read_b32 v51, v203
  ds_read_b32 v52, v204
  ds_read_b32 v53, v205
  ds_read_b32 v54, v206
  ds_read_b32 v55, v207
  s_waitcnt lgkmcnt(4)
  ds_read_b32 v56, v208
  ds_read_b32 v57, v209
  ds_read_b32 v58, v210
  ds_read_b32 v59, v211
  ds_read_b32 v60, v212
  ds_read_b32 v61, v213
  ds_read_b32 v62, v214
  ds_read_b32 v63, v215
  s_waitcnt lgkmcnt(4)
  ds_read_b32 v64, v216
  ds_read_b32 v65, v217
  ds_read_b32 v66, v218
  ds_read_b32 v67, v219
  ds_read_b32 v68, v220
  ds_read_b32 v69, v221
  ds_read_b32 v70, v222
  ds_read_b32 v71, v223
  s_waitcnt lgkmcnt(4)
  ds_read_b32 v72, v224
  ds_read_b32 v73, v225
  ds_read_b32 v74, v226
  ds_read_b32 v75, v227
  ds_read_b32 v76, v228
  ds_read_b32 v77, v229
  ds_read_b32 v78, v230
  ds_read_b32 v79, v231
  s_waitcnt lgkmcnt(4)
  ds_read_b32 v80, v232
  s_waitcnt lgkmcnt(0)
  v_lshlrev_b32 v46, 6, v1
  v_add_u32 v46, s17, v46
  v_cvt_pk_bf16_f32 v84, v48, v49
  v_cvt_pk_bf16_f32 v88, v49, v50
  v_cvt_pk_bf16_f32 v85, v50, v51
  v_cvt_pk_bf16_f32 v89, v51, v52
  v_cvt_pk_bf16_f32 v86, v52, v53
  v_cvt_pk_bf16_f32 v90, v53, v54
  v_cvt_pk_bf16_f32 v87, v54, v55
  v_cvt_pk_bf16_f32 v91, v55, v56
  ds_write_b128 v46, v[84:87] offset:4608
  ds_write_b128 v46, v[88:91] offset:8832
  s_waitcnt lgkmcnt(0)
  v_cvt_pk_bf16_f32 v84, v56, v57
  v_cvt_pk_bf16_f32 v88, v57, v58
  v_cvt_pk_bf16_f32 v85, v58, v59
  v_cvt_pk_bf16_f32 v89, v59, v60
  v_cvt_pk_bf16_f32 v86, v60, v61
  v_cvt_pk_bf16_f32 v90, v61, v62
  v_cvt_pk_bf16_f32 v87, v62, v63
  v_cvt_pk_bf16_f32 v91, v63, v64
  ds_write_b128 v46, v[84:87] offset:4624
  ds_write_b128 v46, v[88:91] offset:8848
  s_waitcnt lgkmcnt(0)
  v_cvt_pk_bf16_f32 v84, v64, v65
  v_cvt_pk_bf16_f32 v88, v65, v66
  v_cvt_pk_bf16_f32 v85, v66, v67
  v_cvt_pk_bf16_f32 v89, v67, v68
  v_cvt_pk_bf16_f32 v86, v68, v69
  v_cvt_pk_bf16_f32 v90, v69, v70
  v_cvt_pk_bf16_f32 v87, v70, v71
  v_cvt_pk_bf16_f32 v91, v71, v72
  ds_write_b128 v46, v[84:87] offset:4640
  ds_write_b128 v46, v[88:91] offset:8864
  s_waitcnt lgkmcnt(0)
  v_cvt_pk_bf16_f32 v84, v72, v73
  v_cvt_pk_bf16_f32 v88, v73, v74
  v_cvt_pk_bf16_f32 v85, v74, v75
  v_cvt_pk_bf16_f32 v89, v75, v76
  v_cvt_pk_bf16_f32 v86, v76, v77
  v_cvt_pk_bf16_f32 v90, v77, v78
  v_cvt_pk_bf16_f32 v87, v78, v79
  v_cvt_pk_bf16_f32 v91, v79, v80
  ds_write_b128 v46, v[84:87] offset:4656
  ds_write_b128 v46, v[88:91] offset:8880
  s_waitcnt lgkmcnt(0)
  s_barrier
  v_lshrrev_b32 v47, 1, v3
  v_sub_u32 v46, v4, v47
  v_add_u32 v46, 1, v46
  v_lshlrev_b32 v46, 5, v46
  v_and_b32 v48, 1, v3
  v_lshl_add_u32 v46, v48, 4, v46
  v_add_u32 v46, s17, v46
  ds_read_b128 a[0:3], v46 offset:32
  ds_read_b128 a[4:7], v46 offset:96
  ds_read_b128 a[8:11], v46 offset:160
  ds_read_b128 a[12:15], v46 offset:224
  ds_read_b128 a[16:19], v46 offset:288
  ds_read_b128 a[20:23], v46 offset:352
  ds_read_b128 a[24:27], v46 offset:416
  ds_read_b128 a[28:31], v46 offset:480
  s_waitcnt lgkmcnt(4)
  ds_read_b128 a[32:35], v46 offset:544
  ds_read_b128 a[36:39], v46 offset:608
  ds_read_b128 a[40:43], v46 offset:672
  ds_read_b128 a[44:47], v46 offset:736
  ds_read_b128 a[48:51], v46 offset:800
  ds_read_b128 a[52:55], v46 offset:864
  ds_read_b128 a[56:59], v46 offset:928
  ds_read_b128 a[60:63], v46 offset:992
  s_waitcnt lgkmcnt(4)
  ds_read_b128 a[64:67], v46 offset:1056
  ds_read_b128 a[68:71], v46 offset:1120
  ds_read_b128 a[72:75], v46 offset:1184
  ds_read_b128 a[76:79], v46 offset:1248
  ds_read_b128 a[80:83], v46 offset:1312
  ds_read_b128 a[84:87], v46 offset:1376
  ds_read_b128 a[88:91], v46 offset:1440
  ds_read_b128 a[92:95], v46 offset:1504
  s_waitcnt lgkmcnt(4)
  ds_read_b128 a[96:99], v46 offset:1568
  ds_read_b128 a[100:103], v46 offset:1632
  ds_read_b128 a[104:107], v46 offset:1696
  ds_read_b128 a[108:111], v46 offset:1760
  ds_read_b128 a[112:115], v46 offset:1824
  ds_read_b128 a[116:119], v46 offset:1888
  ds_read_b128 a[120:123], v46 offset:1952
  ds_read_b128 a[124:127], v46 offset:2016
  s_waitcnt lgkmcnt(4)
  ds_read_b128 a[128:131], v46 offset:2080
  ds_read_b128 a[132:135], v46 offset:2144
  ds_read_b128 a[136:139], v46 offset:2208
  ds_read_b128 a[140:143], v46 offset:2272
  ds_read_b128 a[144:147], v46 offset:2336
  ds_read_b128 a[148:151], v46 offset:2400
  ds_read_b128 a[152:155], v46 offset:2464
  ds_read_b128 a[156:159], v46 offset:2528
  s_waitcnt lgkmcnt(4)
  ds_read_b128 a[160:163], v46 offset:2592
  ds_read_b128 a[164:167], v46 offset:2656
  ds_read_b128 a[168:171], v46 offset:2720
  ds_read_b128 a[172:175], v46 offset:2784
  ds_read_b128 a[176:179], v46 offset:2848
  ds_read_b128 a[180:183], v46 offset:2912
  ds_read_b128 a[184:187], v46 offset:2976
  ds_read_b128 a[188:191], v46 offset:3040
  s_waitcnt lgkmcnt(4)
  ds_read_b128 a[192:195], v46 offset:3104
  ds_read_b128 a[196:199], v46 offset:3168
  ds_read_b128 a[200:203], v46 offset:3232
  ds_read_b128 a[204:207], v46 offset:3296
  ds_read_b128 a[208:211], v46 offset:3360
  ds_read_b128 a[212:215], v46 offset:3424
  ds_read_b128 a[216:219], v46 offset:3488
  ds_read_b128 a[220:223], v46 offset:3552
  s_waitcnt lgkmcnt(4)
  ds_read_b128 a[224:227], v46 offset:3616
  ds_read_b128 a[228:231], v46 offset:3680
  ds_read_b128 a[232:235], v46 offset:3744
  ds_read_b128 a[236:239], v46 offset:3808
  ds_read_b128 a[240:243], v46 offset:3872
  ds_read_b128 a[244:247], v46 offset:3936
  ds_read_b128 a[248:251], v46 offset:4000
  ds_read_b128 a[252:255], v46 offset:4064
  s_waitcnt lgkmcnt(4)
  v_lshlrev_b32 v49, 4, v47
  v_add_u32 v49, v49, v4
  v_sub_u32 v49, 2047, v49
  v_lshl_add_u32 v49, v48, 3, v49
  v_and_b32 v50, 1, v49
  v_lshrrev_b32 v49, 1, v49
  v_lshlrev_b32 v49, 2, v49
  v_mul_u32_u24 v50, 4224, v50
  v_add3_u32 v49, v49, v50, s17
  v_add_u32 v49, 4608, v49
  v_subrev_u32 v52, 896, v49
  v_subrev_u32 v53, 1856, v49
  v_subrev_u32 v54, 2816, v49
  v_subrev_u32 v55, 3776, v49
  v_subrev_u32 v56, 4736, v49
  s_waitcnt lgkmcnt(0)
  ds_read2_b32 v[92:93], v52 offset0:224 offset1:225
  ds_read2_b32 v[94:95], v52 offset0:226 offset1:227
  ds_read2_b32 v[96:97], v52 offset0:208 offset1:209
  ds_read2_b32 v[98:99], v52 offset0:210 offset1:211
  ds_read2_b32 v[100:101], v52 offset0:192 offset1:193
  ds_read2_b32 v[102:103], v52 offset0:194 offset1:195
  ds_read2_b32 v[104:105], v52 offset0:176 offset1:177
  ds_read2_b32 v[106:107], v52 offset0:178 offset1:179
  s_waitcnt lgkmcnt(6)
  v_mfma_f32_16x16x32_bf16 v[60:63], v[92:95], a[28:31], 0
  v_mfma_f32_16x16x32_bf16 v[64:67], v[92:95], a[60:63], 0
  v_mfma_f32_16x16x32_bf16 v[68:71], v[92:95], a[92:95], 0
  v_mfma_f32_16x16x32_bf16 v[72:75], v[92:95], a[124:127], 0
  v_mfma_f32_16x16x32_bf16 v[76:79], v[92:95], a[156:159], 0
  v_mfma_f32_16x16x32_bf16 v[80:83], v[92:95], a[188:191], 0
  v_mfma_f32_16x16x32_bf16 v[84:87], v[92:95], a[220:223], 0
  v_mfma_f32_16x16x32_bf16 v[88:91], v[92:95], a[252:255], 0
  ds_read2_b32 v[92:93], v52 offset0:160 offset1:161
  ds_read2_b32 v[94:95], v52 offset0:162 offset1:163
  s_waitcnt lgkmcnt(6)
  v_mfma_f32_16x16x32_bf16 v[60:63], v[96:99], a[24:27], v[60:63]
  v_mfma_f32_16x16x32_bf16 v[64:67], v[96:99], a[56:59], v[64:67]
  v_mfma_f32_16x16x32_bf16 v[68:71], v[96:99], a[88:91], v[68:71]
  v_mfma_f32_16x16x32_bf16 v[72:75], v[96:99], a[120:123], v[72:75]
  v_mfma_f32_16x16x32_bf16 v[76:79], v[96:99], a[152:155], v[76:79]
  v_mfma_f32_16x16x32_bf16 v[80:83], v[96:99], a[184:187], v[80:83]
  v_mfma_f32_16x16x32_bf16 v[84:87], v[96:99], a[216:219], v[84:87]
  v_mfma_f32_16x16x32_bf16 v[88:91], v[96:99], a[248:251], v[88:91]
  ds_read2_b32 v[96:97], v52 offset0:144 offset1:145
  ds_read2_b32 v[98:99], v52 offset0:146 offset1:147
  s_waitcnt lgkmcnt(6)
  v_mfma_f32_16x16x32_bf16 v[60:63], v[100:103], a[20:23], v[60:63]
  v_mfma_f32_16x16x32_bf16 v[64:67], v[100:103], a[52:55], v[64:67]
  v_mfma_f32_16x16x32_bf16 v[68:71], v[100:103], a[84:87], v[68:71]
  v_mfma_f32_16x16x32_bf16 v[72:75], v[100:103], a[116:119], v[72:75]
  v_mfma_f32_16x16x32_bf16 v[76:79], v[100:103], a[148:151], v[76:79]
  v_mfma_f32_16x16x32_bf16 v[80:83], v[100:103], a[180:183], v[80:83]
  v_mfma_f32_16x16x32_bf16 v[84:87], v[100:103], a[212:215], v[84:87]
  v_mfma_f32_16x16x32_bf16 v[88:91], v[100:103], a[244:247], v[88:91]
  ds_read2_b32 v[100:101], v52 offset0:128 offset1:129
  ds_read2_b32 v[102:103], v52 offset0:130 offset1:131
  s_waitcnt lgkmcnt(6)
  v_mfma_f32_16x16x32_bf16 v[60:63], v[104:107], a[16:19], v[60:63]
  v_mfma_f32_16x16x32_bf16 v[64:67], v[104:107], a[48:51], v[64:67]
  v_mfma_f32_16x16x32_bf16 v[68:71], v[104:107], a[80:83], v[68:71]
  v_mfma_f32_16x16x32_bf16 v[72:75], v[104:107], a[112:115], v[72:75]
  v_mfma_f32_16x16x32_bf16 v[76:79], v[104:107], a[144:147], v[76:79]
  v_mfma_f32_16x16x32_bf16 v[80:83], v[104:107], a[176:179], v[80:83]
  v_mfma_f32_16x16x32_bf16 v[84:87], v[104:107], a[208:211], v[84:87]
  v_mfma_f32_16x16x32_bf16 v[88:91], v[104:107], a[240:243], v[88:91]
  ds_read2_b32 v[104:105], v52 offset0:112 offset1:113
  ds_read2_b32 v[106:107], v52 offset0:114 offset1:115
  s_waitcnt lgkmcnt(6)
  v_mfma_f32_16x16x32_bf16 v[60:63], v[92:95], a[12:15], v[60:63]
  v_mfma_f32_16x16x32_bf16 v[64:67], v[92:95], a[44:47], v[64:67]
  v_mfma_f32_16x16x32_bf16 v[68:71], v[92:95], a[76:79], v[68:71]
  v_mfma_f32_16x16x32_bf16 v[72:75], v[92:95], a[108:111], v[72:75]
  v_mfma_f32_16x16x32_bf16 v[76:79], v[92:95], a[140:143], v[76:79]
  v_mfma_f32_16x16x32_bf16 v[80:83], v[92:95], a[172:175], v[80:83]
  v_mfma_f32_16x16x32_bf16 v[84:87], v[92:95], a[204:207], v[84:87]
  v_mfma_f32_16x16x32_bf16 v[88:91], v[92:95], a[236:239], v[88:91]
  ds_read2_b32 v[92:93], v52 offset0:96 offset1:97
  ds_read2_b32 v[94:95], v52 offset0:98 offset1:99
  s_waitcnt lgkmcnt(6)
  v_mfma_f32_16x16x32_bf16 v[60:63], v[96:99], a[8:11], v[60:63]
  v_mfma_f32_16x16x32_bf16 v[64:67], v[96:99], a[40:43], v[64:67]
  v_mfma_f32_16x16x32_bf16 v[68:71], v[96:99], a[72:75], v[68:71]
  v_mfma_f32_16x16x32_bf16 v[72:75], v[96:99], a[104:107], v[72:75]
  v_mfma_f32_16x16x32_bf16 v[76:79], v[96:99], a[136:139], v[76:79]
  v_mfma_f32_16x16x32_bf16 v[80:83], v[96:99], a[168:171], v[80:83]
  v_mfma_f32_16x16x32_bf16 v[84:87], v[96:99], a[200:203], v[84:87]
  v_mfma_f32_16x16x32_bf16 v[88:91], v[96:99], a[232:235], v[88:91]
  ds_read2_b32 v[96:97], v52 offset0:80 offset1:81
  ds_read2_b32 v[98:99], v52 offset0:82 offset1:83
  s_waitcnt lgkmcnt(6)
  v_mfma_f32_16x16x32_bf16 v[60:63], v[100:103], a[4:7], v[60:63]
  v_mfma_f32_16x16x32_bf16 v[64:67], v[100:103], a[36:39], v[64:67]
  v_mfma_f32_16x16x32_bf16 v[68:71], v[100:103], a[68:71], v[68:71]
  v_mfma_f32_16x16x32_bf16 v[72:75], v[100:103], a[100:103], v[72:75]
  v_mfma_f32_16x16x32_bf16 v[76:79], v[100:103], a[132:135], v[76:79]
  v_mfma_f32_16x16x32_bf16 v[80:83], v[100:103], a[164:167], v[80:83]
  v_mfma_f32_16x16x32_bf16 v[84:87], v[100:103], a[196:199], v[84:87]
  v_mfma_f32_16x16x32_bf16 v[88:91], v[100:103], a[228:231], v[88:91]
  ds_read2_b32 v[100:101], v52 offset0:64 offset1:65
  ds_read2_b32 v[102:103], v52 offset0:66 offset1:67
  s_waitcnt lgkmcnt(6)
  v_mfma_f32_16x16x32_bf16 v[60:63], v[104:107], a[0:3], v[60:63]
  v_mfma_f32_16x16x32_bf16 v[64:67], v[104:107], a[32:35], v[64:67]
  v_mfma_f32_16x16x32_bf16 v[68:71], v[104:107], a[64:67], v[68:71]
  v_mfma_f32_16x16x32_bf16 v[72:75], v[104:107], a[96:99], v[72:75]
  v_mfma_f32_16x16x32_bf16 v[76:79], v[104:107], a[128:131], v[76:79]
  v_mfma_f32_16x16x32_bf16 v[80:83], v[104:107], a[160:163], v[80:83]
  v_mfma_f32_16x16x32_bf16 v[84:87], v[104:107], a[192:195], v[84:87]
  v_mfma_f32_16x16x32_bf16 v[88:91], v[104:107], a[224:227], v[88:91]
  ds_read2_b32 v[104:105], v52 offset0:48 offset1:49
  ds_read2_b32 v[106:107], v52 offset0:50 offset1:51
  s_waitcnt lgkmcnt(6)
  v_mfma_f32_16x16x32_bf16 v[64:67], v[92:95], a[28:31], v[64:67]
  v_mfma_f32_16x16x32_bf16 v[68:71], v[92:95], a[60:63], v[68:71]
  v_mfma_f32_16x16x32_bf16 v[72:75], v[92:95], a[92:95], v[72:75]
  v_mfma_f32_16x16x32_bf16 v[76:79], v[92:95], a[124:127], v[76:79]
  v_mfma_f32_16x16x32_bf16 v[80:83], v[92:95], a[156:159], v[80:83]
  v_mfma_f32_16x16x32_bf16 v[84:87], v[92:95], a[188:191], v[84:87]
  v_mfma_f32_16x16x32_bf16 v[88:91], v[92:95], a[220:223], v[88:91]
  ds_read2_b32 v[92:93], v52 offset0:32 offset1:33
  ds_read2_b32 v[94:95], v52 offset0:34 offset1:35
  s_waitcnt lgkmcnt(6)
  v_mfma_f32_16x16x32_bf16 v[64:67], v[96:99], a[24:27], v[64:67]
  v_mfma_f32_16x16x32_bf16 v[68:71], v[96:99], a[56:59], v[68:71]
  v_mfma_f32_16x16x32_bf16 v[72:75], v[96:99], a[88:91], v[72:75]
  v_mfma_f32_16x16x32_bf16 v[76:79], v[96:99], a[120:123], v[76:79]
  v_mfma_f32_16x16x32_bf16 v[80:83], v[96:99], a[152:155], v[80:83]
  v_mfma_f32_16x16x32_bf16 v[84:87], v[96:99], a[184:187], v[84:87]
  v_mfma_f32_16x16x32_bf16 v[88:91], v[96:99], a[216:219], v[88:91]
  ds_read2_b32 v[96:97], v52 offset0:16 offset1:17
  ds_read2_b32 v[98:99], v52 offset0:18 offset1:19
  s_waitcnt lgkmcnt(6)
  v_mfma_f32_16x16x32_bf16 v[64:67], v[100:103], a[20:23], v[64:67]
  v_mfma_f32_16x16x32_bf16 v[68:71], v[100:103], a[52:55], v[68:71]
  v_mfma_f32_16x16x32_bf16 v[72:75], v[100:103], a[84:87], v[72:75]
  v_mfma_f32_16x16x32_bf16 v[76:79], v[100:103], a[116:119], v[76:79]
  v_mfma_f32_16x16x32_bf16 v[80:83], v[100:103], a[148:151], v[80:83]
  v_mfma_f32_16x16x32_bf16 v[84:87], v[100:103], a[180:183], v[84:87]
  v_mfma_f32_16x16x32_bf16 v[88:91], v[100:103], a[212:215], v[88:91]
  ds_read2_b32 v[100:101], v52 offset0:0 offset1:1
  ds_read2_b32 v[102:103], v52 offset0:2 offset1:3
  s_waitcnt lgkmcnt(6)
  v_mfma_f32_16x16x32_bf16 v[64:67], v[104:107], a[16:19], v[64:67]
  v_mfma_f32_16x16x32_bf16 v[68:71], v[104:107], a[48:51], v[68:71]
  v_mfma_f32_16x16x32_bf16 v[72:75], v[104:107], a[80:83], v[72:75]
  v_mfma_f32_16x16x32_bf16 v[76:79], v[104:107], a[112:115], v[76:79]
  v_mfma_f32_16x16x32_bf16 v[80:83], v[104:107], a[144:147], v[80:83]
  v_mfma_f32_16x16x32_bf16 v[84:87], v[104:107], a[176:179], v[84:87]
  v_mfma_f32_16x16x32_bf16 v[88:91], v[104:107], a[208:211], v[88:91]
  ds_read2_b32 v[104:105], v53 offset0:224 offset1:225
  ds_read2_b32 v[106:107], v53 offset0:226 offset1:227
  s_waitcnt lgkmcnt(6)
  v_mfma_f32_16x16x32_bf16 v[64:67], v[92:95], a[12:15], v[64:67]
  v_mfma_f32_16x16x32_bf16 v[68:71], v[92:95], a[44:47], v[68:71]
  v_mfma_f32_16x16x32_bf16 v[72:75], v[92:95], a[76:79], v[72:75]
  v_mfma_f32_16x16x32_bf16 v[76:79], v[92:95], a[108:111], v[76:79]
  v_mfma_f32_16x16x32_bf16 v[80:83], v[92:95], a[140:143], v[80:83]
  v_mfma_f32_16x16x32_bf16 v[84:87], v[92:95], a[172:175], v[84:87]
  v_mfma_f32_16x16x32_bf16 v[88:91], v[92:95], a[204:207], v[88:91]
  ds_read2_b32 v[92:93], v53 offset0:208 offset1:209
  ds_read2_b32 v[94:95], v53 offset0:210 offset1:211
  s_waitcnt lgkmcnt(6)
  v_mfma_f32_16x16x32_bf16 v[64:67], v[96:99], a[8:11], v[64:67]
  v_mfma_f32_16x16x32_bf16 v[68:71], v[96:99], a[40:43], v[68:71]
  v_mfma_f32_16x16x32_bf16 v[72:75], v[96:99], a[72:75], v[72:75]
  v_mfma_f32_16x16x32_bf16 v[76:79], v[96:99], a[104:107], v[76:79]
  v_mfma_f32_16x16x32_bf16 v[80:83], v[96:99], a[136:139], v[80:83]
  v_mfma_f32_16x16x32_bf16 v[84:87], v[96:99], a[168:171], v[84:87]
  v_mfma_f32_16x16x32_bf16 v[88:91], v[96:99], a[200:203], v[88:91]
  ds_read2_b32 v[96:97], v53 offset0:192 offset1:193
  ds_read2_b32 v[98:99], v53 offset0:194 offset1:195
  s_waitcnt lgkmcnt(6)
  v_mfma_f32_16x16x32_bf16 v[64:67], v[100:103], a[4:7], v[64:67]
  v_mfma_f32_16x16x32_bf16 v[68:71], v[100:103], a[36:39], v[68:71]
  v_mfma_f32_16x16x32_bf16 v[72:75], v[100:103], a[68:71], v[72:75]
  v_mfma_f32_16x16x32_bf16 v[76:79], v[100:103], a[100:103], v[76:79]
  v_mfma_f32_16x16x32_bf16 v[80:83], v[100:103], a[132:135], v[80:83]
  v_mfma_f32_16x16x32_bf16 v[84:87], v[100:103], a[164:167], v[84:87]
  v_mfma_f32_16x16x32_bf16 v[88:91], v[100:103], a[196:199], v[88:91]
  ds_read2_b32 v[100:101], v53 offset0:176 offset1:177
  ds_read2_b32 v[102:103], v53 offset0:178 offset1:179
  s_waitcnt lgkmcnt(6)
  v_mfma_f32_16x16x32_bf16 v[64:67], v[104:107], a[0:3], v[64:67]
  v_mfma_f32_16x16x32_bf16 v[68:71], v[104:107], a[32:35], v[68:71]
  v_mfma_f32_16x16x32_bf16 v[72:75], v[104:107], a[64:67], v[72:75]
  v_mfma_f32_16x16x32_bf16 v[76:79], v[104:107], a[96:99], v[76:79]
  v_mfma_f32_16x16x32_bf16 v[80:83], v[104:107], a[128:131], v[80:83]
  v_mfma_f32_16x16x32_bf16 v[84:87], v[104:107], a[160:163], v[84:87]
  v_mfma_f32_16x16x32_bf16 v[88:91], v[104:107], a[192:195], v[88:91]
  ds_read2_b32 v[104:105], v53 offset0:160 offset1:161
  ds_read2_b32 v[106:107], v53 offset0:162 offset1:163
  s_waitcnt lgkmcnt(6)
  v_mfma_f32_16x16x32_bf16 v[68:71], v[92:95], a[28:31], v[68:71]
  v_mfma_f32_16x16x32_bf16 v[72:75], v[92:95], a[60:63], v[72:75]
  v_mfma_f32_16x16x32_bf16 v[76:79], v[92:95], a[92:95], v[76:79]
  v_mfma_f32_16x16x32_bf16 v[80:83], v[92:95], a[124:127], v[80:83]
  v_mfma_f32_16x16x32_bf16 v[84:87], v[92:95], a[156:159], v[84:87]
  v_mfma_f32_16x16x32_bf16 v[88:91], v[92:95], a[188:191], v[88:91]
  ds_read2_b32 v[92:93], v53 offset0:144 offset1:145
  ds_read2_b32 v[94:95], v53 offset0:146 offset1:147
  s_waitcnt lgkmcnt(6)
  v_mfma_f32_16x16x32_bf16 v[68:71], v[96:99], a[24:27], v[68:71]
  v_mfma_f32_16x16x32_bf16 v[72:75], v[96:99], a[56:59], v[72:75]
  v_mfma_f32_16x16x32_bf16 v[76:79], v[96:99], a[88:91], v[76:79]
  v_mfma_f32_16x16x32_bf16 v[80:83], v[96:99], a[120:123], v[80:83]
  v_mfma_f32_16x16x32_bf16 v[84:87], v[96:99], a[152:155], v[84:87]
  v_mfma_f32_16x16x32_bf16 v[88:91], v[96:99], a[184:187], v[88:91]
  ds_read2_b32 v[96:97], v53 offset0:128 offset1:129
  ds_read2_b32 v[98:99], v53 offset0:130 offset1:131
  s_waitcnt lgkmcnt(6)
  v_mfma_f32_16x16x32_bf16 v[68:71], v[100:103], a[20:23], v[68:71]
  v_mfma_f32_16x16x32_bf16 v[72:75], v[100:103], a[52:55], v[72:75]
  v_mfma_f32_16x16x32_bf16 v[76:79], v[100:103], a[84:87], v[76:79]
  v_mfma_f32_16x16x32_bf16 v[80:83], v[100:103], a[116:119], v[80:83]
  v_mfma_f32_16x16x32_bf16 v[84:87], v[100:103], a[148:151], v[84:87]
  v_mfma_f32_16x16x32_bf16 v[88:91], v[100:103], a[180:183], v[88:91]
  ds_read2_b32 v[100:101], v53 offset0:112 offset1:113
  ds_read2_b32 v[102:103], v53 offset0:114 offset1:115
  s_waitcnt lgkmcnt(6)
  v_mfma_f32_16x16x32_bf16 v[68:71], v[104:107], a[16:19], v[68:71]
  v_mfma_f32_16x16x32_bf16 v[72:75], v[104:107], a[48:51], v[72:75]
  v_mfma_f32_16x16x32_bf16 v[76:79], v[104:107], a[80:83], v[76:79]
  v_mfma_f32_16x16x32_bf16 v[80:83], v[104:107], a[112:115], v[80:83]
  v_mfma_f32_16x16x32_bf16 v[84:87], v[104:107], a[144:147], v[84:87]
  v_mfma_f32_16x16x32_bf16 v[88:91], v[104:107], a[176:179], v[88:91]
  ds_read2_b32 v[104:105], v53 offset0:96 offset1:97
  ds_read2_b32 v[106:107], v53 offset0:98 offset1:99
  s_waitcnt lgkmcnt(6)
  v_mfma_f32_16x16x32_bf16 v[68:71], v[92:95], a[12:15], v[68:71]
  v_mfma_f32_16x16x32_bf16 v[72:75], v[92:95], a[44:47], v[72:75]
  v_mfma_f32_16x16x32_bf16 v[76:79], v[92:95], a[76:79], v[76:79]
  v_mfma_f32_16x16x32_bf16 v[80:83], v[92:95], a[108:111], v[80:83]
  v_mfma_f32_16x16x32_bf16 v[84:87], v[92:95], a[140:143], v[84:87]
  v_mfma_f32_16x16x32_bf16 v[88:91], v[92:95], a[172:175], v[88:91]
  ds_read2_b32 v[92:93], v53 offset0:80 offset1:81
  ds_read2_b32 v[94:95], v53 offset0:82 offset1:83
  s_waitcnt lgkmcnt(6)
  v_mfma_f32_16x16x32_bf16 v[68:71], v[96:99], a[8:11], v[68:71]
  v_mfma_f32_16x16x32_bf16 v[72:75], v[96:99], a[40:43], v[72:75]
  v_mfma_f32_16x16x32_bf16 v[76:79], v[96:99], a[72:75], v[76:79]
  v_mfma_f32_16x16x32_bf16 v[80:83], v[96:99], a[104:107], v[80:83]
  v_mfma_f32_16x16x32_bf16 v[84:87], v[96:99], a[136:139], v[84:87]
  v_mfma_f32_16x16x32_bf16 v[88:91], v[96:99], a[168:171], v[88:91]
  ds_read2_b32 v[96:97], v53 offset0:64 offset1:65
  ds_read2_b32 v[98:99], v53 offset0:66 offset1:67
  s_waitcnt lgkmcnt(6)
  v_mfma_f32_16x16x32_bf16 v[68:71], v[100:103], a[4:7], v[68:71]
  v_mfma_f32_16x16x32_bf16 v[72:75], v[100:103], a[36:39], v[72:75]
  v_mfma_f32_16x16x32_bf16 v[76:79], v[100:103], a[68:71], v[76:79]
  v_mfma_f32_16x16x32_bf16 v[80:83], v[100:103], a[100:103], v[80:83]
  v_mfma_f32_16x16x32_bf16 v[84:87], v[100:103], a[132:135], v[84:87]
  v_mfma_f32_16x16x32_bf16 v[88:91], v[100:103], a[164:167], v[88:91]
  ds_read2_b32 v[100:101], v53 offset0:48 offset1:49
  ds_read2_b32 v[102:103], v53 offset0:50 offset1:51
  s_waitcnt lgkmcnt(6)
  v_mfma_f32_16x16x32_bf16 v[68:71], v[104:107], a[0:3], v[68:71]
  v_mfma_f32_16x16x32_bf16 v[72:75], v[104:107], a[32:35], v[72:75]
  v_mfma_f32_16x16x32_bf16 v[76:79], v[104:107], a[64:67], v[76:79]
  v_mfma_f32_16x16x32_bf16 v[80:83], v[104:107], a[96:99], v[80:83]
  v_mfma_f32_16x16x32_bf16 v[84:87], v[104:107], a[128:131], v[84:87]
  v_mfma_f32_16x16x32_bf16 v[88:91], v[104:107], a[160:163], v[88:91]
  ds_read2_b32 v[104:105], v53 offset0:32 offset1:33
  ds_read2_b32 v[106:107], v53 offset0:34 offset1:35
  s_waitcnt lgkmcnt(6)
  v_mfma_f32_16x16x32_bf16 v[72:75], v[92:95], a[28:31], v[72:75]
  v_mfma_f32_16x16x32_bf16 v[76:79], v[92:95], a[60:63], v[76:79]
  v_mfma_f32_16x16x32_bf16 v[80:83], v[92:95], a[92:95], v[80:83]
  v_mfma_f32_16x16x32_bf16 v[84:87], v[92:95], a[124:127], v[84:87]
  v_mfma_f32_16x16x32_bf16 v[88:91], v[92:95], a[156:159], v[88:91]
  ds_read2_b32 v[92:93], v53 offset0:16 offset1:17
  ds_read2_b32 v[94:95], v53 offset0:18 offset1:19
  s_waitcnt lgkmcnt(6)
  v_mfma_f32_16x16x32_bf16 v[72:75], v[96:99], a[24:27], v[72:75]
  v_mfma_f32_16x16x32_bf16 v[76:79], v[96:99], a[56:59], v[76:79]
  v_mfma_f32_16x16x32_bf16 v[80:83], v[96:99], a[88:91], v[80:83]
  v_mfma_f32_16x16x32_bf16 v[84:87], v[96:99], a[120:123], v[84:87]
  v_mfma_f32_16x16x32_bf16 v[88:91], v[96:99], a[152:155], v[88:91]
  ds_read2_b32 v[96:97], v53 offset0:0 offset1:1
  ds_read2_b32 v[98:99], v53 offset0:2 offset1:3
  s_waitcnt lgkmcnt(6)
  v_mfma_f32_16x16x32_bf16 v[72:75], v[100:103], a[20:23], v[72:75]
  v_mfma_f32_16x16x32_bf16 v[76:79], v[100:103], a[52:55], v[76:79]
  v_mfma_f32_16x16x32_bf16 v[80:83], v[100:103], a[84:87], v[80:83]
  v_mfma_f32_16x16x32_bf16 v[84:87], v[100:103], a[116:119], v[84:87]
  v_mfma_f32_16x16x32_bf16 v[88:91], v[100:103], a[148:151], v[88:91]
  ds_read2_b32 v[100:101], v54 offset0:224 offset1:225
  ds_read2_b32 v[102:103], v54 offset0:226 offset1:227
  s_waitcnt lgkmcnt(6)
  v_mfma_f32_16x16x32_bf16 v[72:75], v[104:107], a[16:19], v[72:75]
  v_mfma_f32_16x16x32_bf16 v[76:79], v[104:107], a[48:51], v[76:79]
  v_mfma_f32_16x16x32_bf16 v[80:83], v[104:107], a[80:83], v[80:83]
  v_mfma_f32_16x16x32_bf16 v[84:87], v[104:107], a[112:115], v[84:87]
  v_mfma_f32_16x16x32_bf16 v[88:91], v[104:107], a[144:147], v[88:91]
  ds_read2_b32 v[104:105], v54 offset0:208 offset1:209
  ds_read2_b32 v[106:107], v54 offset0:210 offset1:211
  s_waitcnt lgkmcnt(6)
  v_mfma_f32_16x16x32_bf16 v[72:75], v[92:95], a[12:15], v[72:75]
  v_mfma_f32_16x16x32_bf16 v[76:79], v[92:95], a[44:47], v[76:79]
  v_mfma_f32_16x16x32_bf16 v[80:83], v[92:95], a[76:79], v[80:83]
  v_mfma_f32_16x16x32_bf16 v[84:87], v[92:95], a[108:111], v[84:87]
  v_mfma_f32_16x16x32_bf16 v[88:91], v[92:95], a[140:143], v[88:91]
  ds_read2_b32 v[92:93], v54 offset0:192 offset1:193
  ds_read2_b32 v[94:95], v54 offset0:194 offset1:195
  s_waitcnt lgkmcnt(6)
  v_mfma_f32_16x16x32_bf16 v[72:75], v[96:99], a[8:11], v[72:75]
  v_mfma_f32_16x16x32_bf16 v[76:79], v[96:99], a[40:43], v[76:79]
  v_mfma_f32_16x16x32_bf16 v[80:83], v[96:99], a[72:75], v[80:83]
  v_mfma_f32_16x16x32_bf16 v[84:87], v[96:99], a[104:107], v[84:87]
  v_mfma_f32_16x16x32_bf16 v[88:91], v[96:99], a[136:139], v[88:91]
  ds_read2_b32 v[96:97], v54 offset0:176 offset1:177
  ds_read2_b32 v[98:99], v54 offset0:178 offset1:179
  s_waitcnt lgkmcnt(6)
  v_mfma_f32_16x16x32_bf16 v[72:75], v[100:103], a[4:7], v[72:75]
  v_mfma_f32_16x16x32_bf16 v[76:79], v[100:103], a[36:39], v[76:79]
  v_mfma_f32_16x16x32_bf16 v[80:83], v[100:103], a[68:71], v[80:83]
  v_mfma_f32_16x16x32_bf16 v[84:87], v[100:103], a[100:103], v[84:87]
  v_mfma_f32_16x16x32_bf16 v[88:91], v[100:103], a[132:135], v[88:91]
  ds_read2_b32 v[100:101], v54 offset0:160 offset1:161
  ds_read2_b32 v[102:103], v54 offset0:162 offset1:163
  s_waitcnt lgkmcnt(6)
  v_mfma_f32_16x16x32_bf16 v[72:75], v[104:107], a[0:3], v[72:75]
  v_mfma_f32_16x16x32_bf16 v[76:79], v[104:107], a[32:35], v[76:79]
  v_mfma_f32_16x16x32_bf16 v[80:83], v[104:107], a[64:67], v[80:83]
  v_mfma_f32_16x16x32_bf16 v[84:87], v[104:107], a[96:99], v[84:87]
  v_mfma_f32_16x16x32_bf16 v[88:91], v[104:107], a[128:131], v[88:91]
  ds_read2_b32 v[104:105], v54 offset0:144 offset1:145
  ds_read2_b32 v[106:107], v54 offset0:146 offset1:147
  s_waitcnt lgkmcnt(6)
  v_mfma_f32_16x16x32_bf16 v[76:79], v[92:95], a[28:31], v[76:79]
  v_mfma_f32_16x16x32_bf16 v[80:83], v[92:95], a[60:63], v[80:83]
  v_mfma_f32_16x16x32_bf16 v[84:87], v[92:95], a[92:95], v[84:87]
  v_mfma_f32_16x16x32_bf16 v[88:91], v[92:95], a[124:127], v[88:91]
  ds_read2_b32 v[92:93], v54 offset0:128 offset1:129
  ds_read2_b32 v[94:95], v54 offset0:130 offset1:131
  s_waitcnt lgkmcnt(6)
  v_mfma_f32_16x16x32_bf16 v[76:79], v[96:99], a[24:27], v[76:79]
  v_mfma_f32_16x16x32_bf16 v[80:83], v[96:99], a[56:59], v[80:83]
  v_mfma_f32_16x16x32_bf16 v[84:87], v[96:99], a[88:91], v[84:87]
  v_mfma_f32_16x16x32_bf16 v[88:91], v[96:99], a[120:123], v[88:91]
  ds_read2_b32 v[96:97], v54 offset0:112 offset1:113
  ds_read2_b32 v[98:99], v54 offset0:114 offset1:115
  s_waitcnt lgkmcnt(6)
  v_mfma_f32_16x16x32_bf16 v[76:79], v[100:103], a[20:23], v[76:79]
  v_mfma_f32_16x16x32_bf16 v[80:83], v[100:103], a[52:55], v[80:83]
  v_mfma_f32_16x16x32_bf16 v[84:87], v[100:103], a[84:87], v[84:87]
  v_mfma_f32_16x16x32_bf16 v[88:91], v[100:103], a[116:119], v[88:91]
  ds_read2_b32 v[100:101], v54 offset0:96 offset1:97
  ds_read2_b32 v[102:103], v54 offset0:98 offset1:99
  s_waitcnt lgkmcnt(6)
  v_mfma_f32_16x16x32_bf16 v[76:79], v[104:107], a[16:19], v[76:79]
  v_mfma_f32_16x16x32_bf16 v[80:83], v[104:107], a[48:51], v[80:83]
  v_mfma_f32_16x16x32_bf16 v[84:87], v[104:107], a[80:83], v[84:87]
  v_mfma_f32_16x16x32_bf16 v[88:91], v[104:107], a[112:115], v[88:91]
  ds_read2_b32 v[104:105], v54 offset0:80 offset1:81
  ds_read2_b32 v[106:107], v54 offset0:82 offset1:83
  s_waitcnt lgkmcnt(6)
  v_mfma_f32_16x16x32_bf16 v[76:79], v[92:95], a[12:15], v[76:79]
  v_mfma_f32_16x16x32_bf16 v[80:83], v[92:95], a[44:47], v[80:83]
  v_mfma_f32_16x16x32_bf16 v[84:87], v[92:95], a[76:79], v[84:87]
  v_mfma_f32_16x16x32_bf16 v[88:91], v[92:95], a[108:111], v[88:91]
  ds_read2_b32 v[92:93], v54 offset0:64 offset1:65
  ds_read2_b32 v[94:95], v54 offset0:66 offset1:67
  s_waitcnt lgkmcnt(6)
  v_mfma_f32_16x16x32_bf16 v[76:79], v[96:99], a[8:11], v[76:79]
  v_mfma_f32_16x16x32_bf16 v[80:83], v[96:99], a[40:43], v[80:83]
  v_mfma_f32_16x16x32_bf16 v[84:87], v[96:99], a[72:75], v[84:87]
  v_mfma_f32_16x16x32_bf16 v[88:91], v[96:99], a[104:107], v[88:91]
  ds_read2_b32 v[96:97], v54 offset0:48 offset1:49
  ds_read2_b32 v[98:99], v54 offset0:50 offset1:51
  s_waitcnt lgkmcnt(6)
  v_mfma_f32_16x16x32_bf16 v[76:79], v[100:103], a[4:7], v[76:79]
  v_mfma_f32_16x16x32_bf16 v[80:83], v[100:103], a[36:39], v[80:83]
  v_mfma_f32_16x16x32_bf16 v[84:87], v[100:103], a[68:71], v[84:87]
  v_mfma_f32_16x16x32_bf16 v[88:91], v[100:103], a[100:103], v[88:91]
  ds_read2_b32 v[100:101], v54 offset0:32 offset1:33
  ds_read2_b32 v[102:103], v54 offset0:34 offset1:35
  s_waitcnt lgkmcnt(6)
  v_mfma_f32_16x16x32_bf16 v[76:79], v[104:107], a[0:3], v[76:79]
  v_mfma_f32_16x16x32_bf16 v[80:83], v[104:107], a[32:35], v[80:83]
  v_mfma_f32_16x16x32_bf16 v[84:87], v[104:107], a[64:67], v[84:87]
  v_mfma_f32_16x16x32_bf16 v[88:91], v[104:107], a[96:99], v[88:91]
  ds_read2_b32 v[104:105], v54 offset0:16 offset1:17
  ds_read2_b32 v[106:107], v54 offset0:18 offset1:19
  s_waitcnt lgkmcnt(6)
  v_mfma_f32_16x16x32_bf16 v[80:83], v[92:95], a[28:31], v[80:83]
  v_mfma_f32_16x16x32_bf16 v[84:87], v[92:95], a[60:63], v[84:87]
  v_mfma_f32_16x16x32_bf16 v[88:91], v[92:95], a[92:95], v[88:91]
  ds_read2_b32 v[92:93], v54 offset0:0 offset1:1
  ds_read2_b32 v[94:95], v54 offset0:2 offset1:3
  s_waitcnt lgkmcnt(6)
  v_mfma_f32_16x16x32_bf16 v[80:83], v[96:99], a[24:27], v[80:83]
  v_mfma_f32_16x16x32_bf16 v[84:87], v[96:99], a[56:59], v[84:87]
  v_mfma_f32_16x16x32_bf16 v[88:91], v[96:99], a[88:91], v[88:91]
  ds_read2_b32 v[96:97], v55 offset0:224 offset1:225
  ds_read2_b32 v[98:99], v55 offset0:226 offset1:227
  s_waitcnt lgkmcnt(6)
  v_mfma_f32_16x16x32_bf16 v[80:83], v[100:103], a[20:23], v[80:83]
  v_mfma_f32_16x16x32_bf16 v[84:87], v[100:103], a[52:55], v[84:87]
  v_mfma_f32_16x16x32_bf16 v[88:91], v[100:103], a[84:87], v[88:91]
  ds_read2_b32 v[100:101], v55 offset0:208 offset1:209
  ds_read2_b32 v[102:103], v55 offset0:210 offset1:211
  s_waitcnt lgkmcnt(6)
  v_mfma_f32_16x16x32_bf16 v[80:83], v[104:107], a[16:19], v[80:83]
  v_mfma_f32_16x16x32_bf16 v[84:87], v[104:107], a[48:51], v[84:87]
  v_mfma_f32_16x16x32_bf16 v[88:91], v[104:107], a[80:83], v[88:91]
  ds_read2_b32 v[104:105], v55 offset0:192 offset1:193
  ds_read2_b32 v[106:107], v55 offset0:194 offset1:195
  s_waitcnt lgkmcnt(6)
  v_mfma_f32_16x16x32_bf16 v[80:83], v[92:95], a[12:15], v[80:83]
  v_mfma_f32_16x16x32_bf16 v[84:87], v[92:95], a[44:47], v[84:87]
  v_mfma_f32_16x16x32_bf16 v[88:91], v[92:95], a[76:79], v[88:91]
  ds_read2_b32 v[92:93], v55 offset0:176 offset1:177
  ds_read2_b32 v[94:95], v55 offset0:178 offset1:179
  s_waitcnt lgkmcnt(6)
  v_mfma_f32_16x16x32_bf16 v[80:83], v[96:99], a[8:11], v[80:83]
  v_mfma_f32_16x16x32_bf16 v[84:87], v[96:99], a[40:43], v[84:87]
  v_mfma_f32_16x16x32_bf16 v[88:91], v[96:99], a[72:75], v[88:91]
  ds_read2_b32 v[96:97], v55 offset0:160 offset1:161
  ds_read2_b32 v[98:99], v55 offset0:162 offset1:163
  s_waitcnt lgkmcnt(6)
  v_mfma_f32_16x16x32_bf16 v[80:83], v[100:103], a[4:7], v[80:83]
  v_mfma_f32_16x16x32_bf16 v[84:87], v[100:103], a[36:39], v[84:87]
  v_mfma_f32_16x16x32_bf16 v[88:91], v[100:103], a[68:71], v[88:91]
  ds_read2_b32 v[100:101], v55 offset0:144 offset1:145
  ds_read2_b32 v[102:103], v55 offset0:146 offset1:147
  s_waitcnt lgkmcnt(6)
  v_mfma_f32_16x16x32_bf16 v[80:83], v[104:107], a[0:3], v[80:83]
  v_mfma_f32_16x16x32_bf16 v[84:87], v[104:107], a[32:35], v[84:87]
  v_mfma_f32_16x16x32_bf16 v[88:91], v[104:107], a[64:67], v[88:91]
  ds_read2_b32 v[104:105], v55 offset0:128 offset1:129
  ds_read2_b32 v[106:107], v55 offset0:130 offset1:131
  s_waitcnt lgkmcnt(6)
  v_mfma_f32_16x16x32_bf16 v[84:87], v[92:95], a[28:31], v[84:87]
  v_mfma_f32_16x16x32_bf16 v[88:91], v[92:95], a[60:63], v[88:91]
  ds_read2_b32 v[92:93], v55 offset0:112 offset1:113
  ds_read2_b32 v[94:95], v55 offset0:114 offset1:115
  s_waitcnt lgkmcnt(6)
  v_mfma_f32_16x16x32_bf16 v[84:87], v[96:99], a[24:27], v[84:87]
  v_mfma_f32_16x16x32_bf16 v[88:91], v[96:99], a[56:59], v[88:91]
  ds_read2_b32 v[96:97], v55 offset0:96 offset1:97
  ds_read2_b32 v[98:99], v55 offset0:98 offset1:99
  s_waitcnt lgkmcnt(6)
  v_mfma_f32_16x16x32_bf16 v[84:87], v[100:103], a[20:23], v[84:87]
  v_mfma_f32_16x16x32_bf16 v[88:91], v[100:103], a[52:55], v[88:91]
  ds_read2_b32 v[100:101], v55 offset0:80 offset1:81
  ds_read2_b32 v[102:103], v55 offset0:82 offset1:83
  s_waitcnt lgkmcnt(6)
  v_mfma_f32_16x16x32_bf16 v[84:87], v[104:107], a[16:19], v[84:87]
  v_mfma_f32_16x16x32_bf16 v[88:91], v[104:107], a[48:51], v[88:91]
  ds_read2_b32 v[104:105], v55 offset0:64 offset1:65
  ds_read2_b32 v[106:107], v55 offset0:66 offset1:67
  s_waitcnt lgkmcnt(6)
  v_mfma_f32_16x16x32_bf16 v[84:87], v[92:95], a[12:15], v[84:87]
  v_mfma_f32_16x16x32_bf16 v[88:91], v[92:95], a[44:47], v[88:91]
  ds_read2_b32 v[92:93], v55 offset0:48 offset1:49
  ds_read2_b32 v[94:95], v55 offset0:50 offset1:51
  s_waitcnt lgkmcnt(6)
  v_mfma_f32_16x16x32_bf16 v[84:87], v[96:99], a[8:11], v[84:87]
  v_mfma_f32_16x16x32_bf16 v[88:91], v[96:99], a[40:43], v[88:91]
  ds_read2_b32 v[96:97], v55 offset0:32 offset1:33
  ds_read2_b32 v[98:99], v55 offset0:34 offset1:35
  s_waitcnt lgkmcnt(6)
  v_mfma_f32_16x16x32_bf16 v[84:87], v[100:103], a[4:7], v[84:87]
  v_mfma_f32_16x16x32_bf16 v[88:91], v[100:103], a[36:39], v[88:91]
  ds_read2_b32 v[100:101], v55 offset0:16 offset1:17
  ds_read2_b32 v[102:103], v55 offset0:18 offset1:19
  s_waitcnt lgkmcnt(6)
  v_mfma_f32_16x16x32_bf16 v[84:87], v[104:107], a[0:3], v[84:87]
  v_mfma_f32_16x16x32_bf16 v[88:91], v[104:107], a[32:35], v[88:91]
  ds_read2_b32 v[104:105], v55 offset0:0 offset1:1
  ds_read2_b32 v[106:107], v55 offset0:2 offset1:3
  s_waitcnt lgkmcnt(6)
  v_mfma_f32_16x16x32_bf16 v[88:91], v[92:95], a[28:31], v[88:91]
  ds_read2_b32 v[92:93], v56 offset0:224 offset1:225
  ds_read2_b32 v[94:95], v56 offset0:226 offset1:227
  s_waitcnt lgkmcnt(6)
  v_mfma_f32_16x16x32_bf16 v[88:91], v[96:99], a[24:27], v[88:91]
  ds_read2_b32 v[96:97], v56 offset0:208 offset1:209
  ds_read2_b32 v[98:99], v56 offset0:210 offset1:211
  s_waitcnt lgkmcnt(6)
  v_mfma_f32_16x16x32_bf16 v[88:91], v[100:103], a[20:23], v[88:91]
  ds_read2_b32 v[100:101], v56 offset0:192 offset1:193
  ds_read2_b32 v[102:103], v56 offset0:194 offset1:195
  s_waitcnt lgkmcnt(6)
  v_mfma_f32_16x16x32_bf16 v[88:91], v[104:107], a[16:19], v[88:91]
  ds_read2_b32 v[104:105], v56 offset0:176 offset1:177
  ds_read2_b32 v[106:107], v56 offset0:178 offset1:179
  s_waitcnt lgkmcnt(6)
  v_mfma_f32_16x16x32_bf16 v[88:91], v[92:95], a[12:15], v[88:91]
  s_waitcnt lgkmcnt(4)
  v_mfma_f32_16x16x32_bf16 v[88:91], v[96:99], a[8:11], v[88:91]
  s_waitcnt lgkmcnt(2)
  v_mfma_f32_16x16x32_bf16 v[88:91], v[100:103], a[4:7], v[88:91]
  s_waitcnt lgkmcnt(0)
  v_mfma_f32_16x16x32_bf16 v[88:91], v[104:107], a[0:3], v[88:91]
  v_lshlrev_b32 v46, 5, v4
  v_lshl_add_u32 v46, v3, 3, v46
  v_add_u32 v46, s17, v46
  ds_read_b64 v[108:109], v46 offset:512
  ds_read_b64 v[110:111], v46 offset:1024
  ds_read_b64 v[112:113], v46 offset:1536
  ds_read_b64 v[114:115], v46 offset:2048
  ds_read_b64 v[116:117], v46 offset:2560
  ds_read_b64 v[118:119], v46 offset:3072
  ds_read_b64 v[120:121], v46 offset:3584
  ds_read_b64 v[122:123], v46 offset:4096
  s_waitcnt lgkmcnt(0)
  v_lshlrev_b32 v124, 16, v108
  v_and_b32 v125, 0xffff0000, v108
  v_lshlrev_b32 v126, 16, v109
  v_and_b32 v127, 0xffff0000, v109
  v_mul_f32 v124, v124, v33
  v_mul_f32 v125, v125, v33
  v_mul_f32 v126, v126, v33
  v_mul_f32 v127, v127, v33
  v_cvt_pk_bf16_f32 v128, v124, v125
  v_cvt_pk_bf16_f32 v129, v126, v127
  v_cvt_pk_bf16_f32 v130, v60, v61
  v_cvt_pk_bf16_f32 v131, v62, v63
  v_lshlrev_b32 v124, 16, v128
  v_and_b32 v125, 0xffff0000, v128
  v_lshlrev_b32 v132, 16, v130
  v_and_b32 v133, 0xffff0000, v130
  v_lshlrev_b32 v126, 16, v129
  v_and_b32 v127, 0xffff0000, v129
  v_lshlrev_b32 v134, 16, v131
  v_and_b32 v135, 0xffff0000, v131
  v_add_f32 v124, v124, v132
  v_add_f32 v125, v125, v133
  v_add_f32 v126, v126, v134
  v_add_f32 v127, v127, v135
  v_cvt_pk_bf16_f32 v108, v124, v125
  v_cvt_pk_bf16_f32 v109, v126, v127
  ds_write_b64 v46, v[108:109] offset:512
  v_lshlrev_b32 v124, 16, v110
  v_and_b32 v125, 0xffff0000, v110
  v_lshlrev_b32 v126, 16, v111
  v_and_b32 v127, 0xffff0000, v111
  v_mul_f32 v124, v124, v33
  v_mul_f32 v125, v125, v33
  v_mul_f32 v126, v126, v33
  v_mul_f32 v127, v127, v33
  v_cvt_pk_bf16_f32 v128, v124, v125
  v_cvt_pk_bf16_f32 v129, v126, v127
  v_cvt_pk_bf16_f32 v130, v64, v65
  v_cvt_pk_bf16_f32 v131, v66, v67
  v_lshlrev_b32 v124, 16, v128
  v_and_b32 v125, 0xffff0000, v128
  v_lshlrev_b32 v132, 16, v130
  v_and_b32 v133, 0xffff0000, v130
  v_lshlrev_b32 v126, 16, v129
  v_and_b32 v127, 0xffff0000, v129
  v_lshlrev_b32 v134, 16, v131
  v_and_b32 v135, 0xffff0000, v131
  v_add_f32 v124, v124, v132
  v_add_f32 v125, v125, v133
  v_add_f32 v126, v126, v134
  v_add_f32 v127, v127, v135
  v_cvt_pk_bf16_f32 v110, v124, v125
  v_cvt_pk_bf16_f32 v111, v126, v127
  ds_write_b64 v46, v[110:111] offset:1024
  v_lshlrev_b32 v124, 16, v112
  v_and_b32 v125, 0xffff0000, v112
  v_lshlrev_b32 v126, 16, v113
  v_and_b32 v127, 0xffff0000, v113
  v_mul_f32 v124, v124, v33
  v_mul_f32 v125, v125, v33
  v_mul_f32 v126, v126, v33
  v_mul_f32 v127, v127, v33
  v_cvt_pk_bf16_f32 v128, v124, v125
  v_cvt_pk_bf16_f32 v129, v126, v127
  v_cvt_pk_bf16_f32 v130, v68, v69
  v_cvt_pk_bf16_f32 v131, v70, v71
  v_lshlrev_b32 v124, 16, v128
  v_and_b32 v125, 0xffff0000, v128
  v_lshlrev_b32 v132, 16, v130
  v_and_b32 v133, 0xffff0000, v130
  v_lshlrev_b32 v126, 16, v129
  v_and_b32 v127, 0xffff0000, v129
  v_lshlrev_b32 v134, 16, v131
  v_and_b32 v135, 0xffff0000, v131
  v_add_f32 v124, v124, v132
  v_add_f32 v125, v125, v133
  v_add_f32 v126, v126, v134
  v_add_f32 v127, v127, v135
  v_cvt_pk_bf16_f32 v112, v124, v125
  v_cvt_pk_bf16_f32 v113, v126, v127
  ds_write_b64 v46, v[112:113] offset:1536
  v_lshlrev_b32 v124, 16, v114
  v_and_b32 v125, 0xffff0000, v114
  v_lshlrev_b32 v126, 16, v115
  v_and_b32 v127, 0xffff0000, v115
  v_mul_f32 v124, v124, v33
  v_mul_f32 v125, v125, v33
  v_mul_f32 v126, v126, v33
  v_mul_f32 v127, v127, v33
  v_cvt_pk_bf16_f32 v128, v124, v125
  v_cvt_pk_bf16_f32 v129, v126, v127
  v_cvt_pk_bf16_f32 v130, v72, v73
  v_cvt_pk_bf16_f32 v131, v74, v75
  v_lshlrev_b32 v124, 16, v128
  v_and_b32 v125, 0xffff0000, v128
  v_lshlrev_b32 v132, 16, v130
  v_and_b32 v133, 0xffff0000, v130
  v_lshlrev_b32 v126, 16, v129
  v_and_b32 v127, 0xffff0000, v129
  v_lshlrev_b32 v134, 16, v131
  v_and_b32 v135, 0xffff0000, v131
  v_add_f32 v124, v124, v132
  v_add_f32 v125, v125, v133
  v_add_f32 v126, v126, v134
  v_add_f32 v127, v127, v135
  v_cvt_pk_bf16_f32 v114, v124, v125
  v_cvt_pk_bf16_f32 v115, v126, v127
  ds_write_b64 v46, v[114:115] offset:2048
  v_lshlrev_b32 v124, 16, v116
  v_and_b32 v125, 0xffff0000, v116
  v_lshlrev_b32 v126, 16, v117
  v_and_b32 v127, 0xffff0000, v117
  v_mul_f32 v124, v124, v33
  v_mul_f32 v125, v125, v33
  v_mul_f32 v126, v126, v33
  v_mul_f32 v127, v127, v33
  v_cvt_pk_bf16_f32 v128, v124, v125
  v_cvt_pk_bf16_f32 v129, v126, v127
  v_cvt_pk_bf16_f32 v130, v76, v77
  v_cvt_pk_bf16_f32 v131, v78, v79
  v_lshlrev_b32 v124, 16, v128
  v_and_b32 v125, 0xffff0000, v128
  v_lshlrev_b32 v132, 16, v130
  v_and_b32 v133, 0xffff0000, v130
  v_lshlrev_b32 v126, 16, v129
  v_and_b32 v127, 0xffff0000, v129
  v_lshlrev_b32 v134, 16, v131
  v_and_b32 v135, 0xffff0000, v131
  v_add_f32 v124, v124, v132
  v_add_f32 v125, v125, v133
  v_add_f32 v126, v126, v134
  v_add_f32 v127, v127, v135
  v_cvt_pk_bf16_f32 v116, v124, v125
  v_cvt_pk_bf16_f32 v117, v126, v127
  ds_write_b64 v46, v[116:117] offset:2560
  v_lshlrev_b32 v124, 16, v118
  v_and_b32 v125, 0xffff0000, v118
  v_lshlrev_b32 v126, 16, v119
  v_and_b32 v127, 0xffff0000, v119
  v_mul_f32 v124, v124, v33
  v_mul_f32 v125, v125, v33
  v_mul_f32 v126, v126, v33
  v_mul_f32 v127, v127, v33
  v_cvt_pk_bf16_f32 v128, v124, v125
  v_cvt_pk_bf16_f32 v129, v126, v127
  v_cvt_pk_bf16_f32 v130, v80, v81
  v_cvt_pk_bf16_f32 v131, v82, v83
  v_lshlrev_b32 v124, 16, v128
  v_and_b32 v125, 0xffff0000, v128
  v_lshlrev_b32 v132, 16, v130
  v_and_b32 v133, 0xffff0000, v130
  v_lshlrev_b32 v126, 16, v129
  v_and_b32 v127, 0xffff0000, v129
  v_lshlrev_b32 v134, 16, v131
  v_and_b32 v135, 0xffff0000, v131
  v_add_f32 v124, v124, v132
  v_add_f32 v125, v125, v133
  v_add_f32 v126, v126, v134
  v_add_f32 v127, v127, v135
  v_cvt_pk_bf16_f32 v118, v124, v125
  v_cvt_pk_bf16_f32 v119, v126, v127
  ds_write_b64 v46, v[118:119] offset:3072
  v_lshlrev_b32 v124, 16, v120
  v_and_b32 v125, 0xffff0000, v120
  v_lshlrev_b32 v126, 16, v121
  v_and_b32 v127, 0xffff0000, v121
  v_mul_f32 v124, v124, v33
  v_mul_f32 v125, v125, v33
  v_mul_f32 v126, v126, v33
  v_mul_f32 v127, v127, v33
  v_cvt_pk_bf16_f32 v128, v124, v125
  v_cvt_pk_bf16_f32 v129, v126, v127
  v_cvt_pk_bf16_f32 v130, v84, v85
  v_cvt_pk_bf16_f32 v131, v86, v87
  v_lshlrev_b32 v124, 16, v128
  v_and_b32 v125, 0xffff0000, v128
  v_lshlrev_b32 v132, 16, v130
  v_and_b32 v133, 0xffff0000, v130
  v_lshlrev_b32 v126, 16, v129
  v_and_b32 v127, 0xffff0000, v129
  v_lshlrev_b32 v134, 16, v131
  v_and_b32 v135, 0xffff0000, v131
  v_add_f32 v124, v124, v132
  v_add_f32 v125, v125, v133
  v_add_f32 v126, v126, v134
  v_add_f32 v127, v127, v135
  v_cvt_pk_bf16_f32 v120, v124, v125
  v_cvt_pk_bf16_f32 v121, v126, v127
  ds_write_b64 v46, v[120:121] offset:3584
  v_lshlrev_b32 v124, 16, v122
  v_and_b32 v125, 0xffff0000, v122
  v_lshlrev_b32 v126, 16, v123
  v_and_b32 v127, 0xffff0000, v123
  v_mul_f32 v124, v124, v33
  v_mul_f32 v125, v125, v33
  v_mul_f32 v126, v126, v33
  v_mul_f32 v127, v127, v33
  v_cvt_pk_bf16_f32 v128, v124, v125
  v_cvt_pk_bf16_f32 v129, v126, v127
  v_cvt_pk_bf16_f32 v130, v88, v89
  v_cvt_pk_bf16_f32 v131, v90, v91
  v_lshlrev_b32 v124, 16, v128
  v_and_b32 v125, 0xffff0000, v128
  v_lshlrev_b32 v132, 16, v130
  v_and_b32 v133, 0xffff0000, v130
  v_lshlrev_b32 v126, 16, v129
  v_and_b32 v127, 0xffff0000, v129
  v_lshlrev_b32 v134, 16, v131
  v_and_b32 v135, 0xffff0000, v131
  v_add_f32 v124, v124, v132
  v_add_f32 v125, v125, v133
  v_add_f32 v126, v126, v134
  v_add_f32 v127, v127, v135
  v_cvt_pk_bf16_f32 v122, v124, v125
  v_cvt_pk_bf16_f32 v123, v126, v127
  ds_write_b64 v46, v[122:123] offset:4096
  s_waitcnt lgkmcnt(0)
  s_barrier
  v_lshlrev_b32 v6, 3, v0
  v_lshlrev_b32 v5, 4, v0
  v_add_u32 v36, 512, v6
  ds_read_b64 v[8:9], v36
  v_add_u32 v36, 25088, v6
  ds_read_b64 v[10:11], v36
  v_add_u32 v36, 49664, v6
  ds_read_b64 v[12:13], v36
  v_add_u32 v36, 74240, v6
  ds_read_b64 v[14:15], v36
  s_waitcnt lgkmcnt(0)
  s_add_u32 s22, s21, 0
  s_add_u32 s23, s22, 3584
  v_perm_b32 v16, v10, v8, s24
  v_perm_b32 v17, v14, v12, s24
  s_lshl_b32 s22, s21, 11
  s_add_u32 s22, s22, 90177536
  v_perm_b32 v18, v10, v8, s25
  v_perm_b32 v19, v14, v12, s25
  buffer_store_dwordx4 v[16:19], v5, s[8:11], s22 offen sc1
  v_perm_b32 v20, v11, v9, s24
  v_perm_b32 v21, v15, v13, s24
  v_perm_b32 v22, v11, v9, s25
  v_perm_b32 v23, v15, v13, s25
  s_add_u32 s22, s22, 4096
  buffer_store_dwordx4 v[20:23], v5, s[8:11], s22 offen sc1
  v_add_u32 v36, 2560, v6
  ds_read_b64 v[8:9], v36
  v_add_u32 v36, 27136, v6
  ds_read_b64 v[10:11], v36
  v_add_u32 v36, 51712, v6
  ds_read_b64 v[12:13], v36
  v_add_u32 v36, 76288, v6
  ds_read_b64 v[14:15], v36
  s_waitcnt lgkmcnt(0)
  s_add_u32 s22, s21, 1835008
  s_add_u32 s23, s22, 3584
  v_perm_b32 v24, v10, v8, s24
  v_perm_b32 v25, v14, v12, s24
  s_lshl_b32 s22, s21, 11
  s_add_u32 s22, s22, 90185728
  v_perm_b32 v26, v10, v8, s25
  v_perm_b32 v27, v14, v12, s25
  buffer_store_dwordx4 v[24:27], v5, s[8:11], s22 offen sc1
  v_perm_b32 v28, v11, v9, s24
  v_perm_b32 v29, v15, v13, s24
  v_perm_b32 v30, v11, v9, s25
  v_perm_b32 v31, v15, v13, s25
  s_add_u32 s22, s22, 4096
  buffer_store_dwordx4 v[28:31], v5, s[8:11], s22 offen sc1
  s_waitcnt vmcnt(0)
  s_barrier
  s_cmp_lg_u32 s16, 0
  s_cbranch_scc1 wk_nc
  v_mov_b32 v5, 1
  s_mov_b32 s22, 88599424
  s_mov_b64 exec, 1
  buffer_atomic_add v5, off, s[8:11], s22
  s_mov_b64 exec, -1
wk_nc:
  s_branch wk_loop
wk_tok:
  s_sub_u32 s3, s3, 864
  s_cmp_lt_u32 s3, 512
  s_cbranch_scc1 wk_tk
  s_sub_u32 s3, s3, 64
  s_cmp_ge_i32 s3, 512
  s_cbranch_scc1 wk_tk
  s_sub_u32 s18, s3, 448
  s_mov_b32 s20, 88599424
  v_mov_b32 v8, 0
  s_mov_b32 s30, 0
wk_cw:
  buffer_load_dword v9, v8, s[8:11], s20 offen sc1
  s_waitcnt vmcnt(0)
  v_cmp_ne_u32 vcc, 112, v9
  s_cbranch_vccz wk_cw_ok
  s_sleep 32
  s_add_u32 s30, s30, 1
  s_cmp_lt_u32 s30, 50000
  s_cbranch_scc1 wk_cw
  s_branch cA_abort
wk_cw_ok:
  v_lshlrev_b32 v5, 14, v3
  v_and_b32 v6, 1, v4
  v_lshl_add_u32 v5, v6, 12, v5
  v_lshrrev_b32 v6, 1, v4
  v_lshl_add_u32 v5, v6, 4, v5
  s_mul_i32 s20, s16, 458752
  s_lshl_b32 s21, s18, 7
  s_add_u32 s20, s20, s21
  s_and_b32 s21, s18, 32
  s_lshl_b32 s21, s21, 7
  s_add_u32 s20, s20, s21
  s_add_u32 s20, s20, 90177536
  buffer_load_dwordx4 v[8:11], v5, s[8:11], s20 offen sc1
  s_add_u32 s20, s20, 65536
  buffer_load_dwordx4 v[12:15], v5, s[8:11], s20 offen sc1
  s_add_u32 s20, s20, 65536
  buffer_load_dwordx4 v[16:19], v5, s[8:11], s20 offen sc1
  s_add_u32 s20, s20, 65536
  buffer_load_dwordx4 v[20:23], v5, s[8:11], s20 offen sc1
  s_add_u32 s20, s20, 65536
  buffer_load_dwordx4 v[24:27], v5, s[8:11], s20 offen sc1
  s_add_u32 s20, s20, 65536
  buffer_load_dwordx4 v[28:31], v5, s[8:11], s20 offen sc1
  s_add_u32 s20, s20, 65536
  buffer_load_dwordx4 v[32:35], v5, s[8:11], s20 offen sc1
  s_add_u32 s20, s20, 65536
  v_mul_u32_u24 v6, 1824, v4
  v_lshl_add_u32 v6, v3, 3, v6
  s_mul_i32 s20, s16, 224
  v_add_u32 v6, s20, v6
  s_movk_i32 s22, 912
  v_add_u32 v36, 0, v0
  v_mul_u32_u24 v37, 18725, v36
  v_lshrrev_b32 v37, 20, v37
  v_mul_u32_u24 v38, 56, v37
  v_sub_u32 v36, v36, v38
  v_lshlrev_b32 v36, 4, v36
  v_mad_u32_u24 v40, v37, s22, v36
  v_mul_u32_u24 v37, 1792, v37
  v_add_u32 v48, v37, v36
  v_add_u32 v36, 256, v0
  v_mul_u32_u24 v37, 18725, v36
  v_lshrrev_b32 v37, 20, v37
  v_mul_u32_u24 v38, 56, v37
  v_sub_u32 v36, v36, v38
  v_lshlrev_b32 v36, 4, v36
  v_mad_u32_u24 v41, v37, s22, v36
  v_mul_u32_u24 v37, 1792, v37
  v_add_u32 v49, v37, v36
  v_add_u32 v36, 512, v0
  v_mul_u32_u24 v37, 18725, v36
  v_lshrrev_b32 v37, 20, v37
  v_mul_u32_u24 v38, 56, v37
  v_sub_u32 v36, v36, v38
  v_lshlrev_b32 v36, 4, v36
  v_mad_u32_u24 v42, v37, s22, v36
  v_mul_u32_u24 v37, 1792, v37
  v_add_u32 v50, v37, v36
  v_add_u32 v36, 768, v0
  v_mul_u32_u24 v37, 18725, v36
  v_lshrrev_b32 v37, 20, v37
  v_mul_u32_u24 v38, 56, v37
  v_sub_u32 v36, v36, v38
  v_lshlrev_b32 v36, 4, v36
  v_mad_u32_u24 v43, v37, s22, v36
  v_mul_u32_u24 v37, 1792, v37
  v_add_u32 v51, v37, v36
  v_add_u32 v36, 1024, v0
  v_mul_u32_u24 v37, 18725, v36
  v_lshrrev_b32 v37, 20, v37
  v_mul_u32_u24 v38, 56, v37
  v_sub_u32 v36, v36, v38
  v_lshlrev_b32 v36, 4, v36
  v_mad_u32_u24 v44, v37, s22, v36
  v_mul_u32_u24 v37, 1792, v37
  v_add_u32 v52, v37, v36
  v_add_u32 v36, 1280, v0
  v_mul_u32_u24 v37, 18725, v36
  v_lshrrev_b32 v37, 20, v37
  v_mul_u32_u24 v38, 56, v37
  v_sub_u32 v36, v36, v38
  v_lshlrev_b32 v36, 4, v36
  v_mad_u32_u24 v45, v37, s22, v36
  v_mul_u32_u24 v37, 1792, v37
  v_add_u32 v53, v37, v36
  v_add_u32 v36, 1536, v0
  v_mul_u32_u24 v37, 18725, v36
  v_lshrrev_b32 v37, 20, v37
  v_mul_u32_u24 v38, 56, v37
  v_sub_u32 v36, v36, v38
  v_lshlrev_b32 v36, 4, v36
  v_mad_u32_u24 v46, v37, s22, v36
  v_mul_u32_u24 v37, 1792, v37
  v_add_u32 v54, v37, v36
  s_waitcnt vmcnt(6)
  ds_write_b64 v6, v[8:9] offset:0
  ds_write_b64 v6, v[10:11] offset:912
  s_waitcnt vmcnt(5)
  ds_write_b64 v6, v[12:13] offset:32
  ds_write_b64 v6, v[14:15] offset:944
  s_waitcnt vmcnt(4)
  ds_write_b64 v6, v[16:17] offset:64
  ds_write_b64 v6, v[18:19] offset:976
  s_waitcnt vmcnt(3)
  ds_write_b64 v6, v[20:21] offset:96
  ds_write_b64 v6, v[22:23] offset:1008
  s_waitcnt vmcnt(2)
  ds_write_b64 v6, v[24:25] offset:128
  ds_write_b64 v6, v[26:27] offset:1040
  s_waitcnt vmcnt(1)
  ds_write_b64 v6, v[28:29] offset:160
  ds_write_b64 v6, v[30:31] offset:1072
  s_waitcnt vmcnt(0)
  ds_write_b64 v6, v[32:33] offset:192
  ds_write_b64 v6, v[34:35] offset:1104
  s_waitcnt lgkmcnt(0)
  s_barrier
  s_mul_i32 s20, s18, 57344
  ds_read_b128 v[8:11], v40
  ds_read_b128 v[12:15], v41
  ds_read_b128 v[16:19], v42
  ds_read_b128 v[20:23], v43
  ds_read_b128 v[24:27], v44
  ds_read_b128 v[28:31], v45
  ds_read_b128 v[32:35], v46
  s_waitcnt lgkmcnt(6)
  buffer_store_dwordx4 v[8:11], v48, s[92:95], s20 offen
  s_waitcnt lgkmcnt(5)
  buffer_store_dwordx4 v[12:15], v49, s[92:95], s20 offen
  s_waitcnt lgkmcnt(4)
  buffer_store_dwordx4 v[16:19], v50, s[92:95], s20 offen
  s_waitcnt lgkmcnt(3)
  buffer_store_dwordx4 v[20:23], v51, s[92:95], s20 offen
  s_waitcnt lgkmcnt(2)
  buffer_store_dwordx4 v[24:27], v52, s[92:95], s20 offen
  s_waitcnt lgkmcnt(1)
  buffer_store_dwordx4 v[28:31], v53, s[92:95], s20 offen
  s_waitcnt lgkmcnt(0)
  buffer_store_dwordx4 v[32:35], v54, s[92:95], s20 offen
  s_branch wk_loop
wk_tk:
  s_and_b32 s18, s3, 3
  s_lshr_b32 s17, s3, 2
  s_cmp_lt_u32 s17, 8
  s_cbranch_scc1 wk_tokp
  s_sub_u32 s17, s17, 64
  s_cmp_ge_i32 s17, 56
  s_cbranch_scc1 wk_toko
  s_add_u32 s20, s17, 56
  s_lshr_b32 s17, s20, 1
  s_bitcmp0_b32 s20, 0
  s_cbranch_scc1 wk_toko
  s_add_u32 s17, s17, 8
wk_tokp:
  s_lshl_b32 s20, s18, 2
  s_add_u32 s20, s20, s16
  s_lshl_b32 s21, s17, 4
  s_add_u32 s21, s21, s20
  s_mul_i32 s21, s21, 28672
  s_add_u32 s21, s21, 12845056
  s_mul_i32 s23, s17, 28672
  s_add_u32 s23, s23, 73400320
  s_mul_i32 s24, s17, 7168
  s_add_u32 s24, s24, 88080384
  s_lshr_b32 s25, s17, 3
  s_lshl_b32 s25, s25, 4
  s_add_u32 s25, s25, s20
  s_lshl_b32 s25, s25, 7
  s_add_u32 s25, s25, 88557568
  v_mov_b32 v60, 0
  s_mov_b32 s30, 0
wp_wf:
  buffer_load_dword v61, v60, s[8:11], s25 offen sc1
  s_waitcnt vmcnt(0)
  v_cmp_ne_u32 vcc, 56, v61
  s_cbranch_vccz wp_wf_ok
  s_sleep 1
  s_cmp_ge_u32 s17, 61
  s_cbranch_scc1 wp_wf_bo
  s_sleep 4
  s_cmp_ge_u32 s17, 56
  s_cbranch_scc1 wp_wf_bo
  s_sleep 40
wp_wf_bo:
  s_add_u32 s30, s30, 1
  s_cmp_lt_u32 s30, 30000
  s_cbranch_scc1 wp_wf
  s_branch wp_abort
wp_wf_ok:
  s_add_u32 s22, s21, 0
  buffer_load_dwordx4 a[0:3], v2, s[8:11], s22 offen offset:0 sc1
  buffer_load_dwordx4 a[4:7], v2, s[8:11], s22 offen offset:1024 sc1
  buffer_load_dwordx4 a[8:11], v2, s[8:11], s22 offen offset:2048 sc1
  buffer_load_dwordx4 a[12:15], v2, s[8:11], s22 offen offset:3072 sc1
  s_add_u32 s22, s21, 4096
  buffer_load_dwordx4 a[16:19], v2, s[8:11], s22 offen offset:0 sc1
  buffer_load_dwordx4 a[20:23], v2, s[8:11], s22 offen offset:1024 sc1
  buffer_load_dwordx4 a[24:27], v2, s[8:11], s22 offen offset:2048 sc1
  buffer_load_dwordx4 a[28:31], v2, s[8:11], s22 offen offset:3072 sc1
  s_add_u32 s22, s21, 8192
  buffer_load_dwordx4 a[32:35], v2, s[8:11], s22 offen offset:0 sc1
  buffer_load_dwordx4 a[36:39], v2, s[8:11], s22 offen offset:1024 sc1
  buffer_load_dwordx4 a[40:43], v2, s[8:11], s22 offen offset:2048 sc1
  buffer_load_dwordx4 a[44:47], v2, s[8:11], s22 offen offset:3072 sc1
  s_add_u32 s22, s21, 12288
  buffer_load_dwordx4 a[48:51], v2, s[8:11], s22 offen offset:0 sc1
  buffer_load_dwordx4 a[52:55], v2, s[8:11], s22 offen offset:1024 sc1
  buffer_load_dwordx4 a[56:59], v2, s[8:11], s22 offen offset:2048 sc1
  buffer_load_dwordx4 a[60:63], v2, s[8:11], s22 offen offset:3072 sc1
  s_add_u32 s22, s21, 16384
  buffer_load_dwordx4 a[64:67], v2, s[8:11], s22 offen offset:0 sc1
  buffer_load_dwordx4 a[68:71], v2, s[8:11], s22 offen offset:1024 sc1
  buffer_load_dwordx4 a[72:75], v2, s[8:11], s22 offen offset:2048 sc1
  buffer_load_dwordx4 a[76:79], v2, s[8:11], s22 offen offset:3072 sc1
  s_add_u32 s22, s21, 20480
  buffer_load_dwordx4 a[80:83], v2, s[8:11], s22 offen offset:0 sc1
  buffer_load_dwordx4 a[84:87], v2, s[8:11], s22 offen offset:1024 sc1
  buffer_load_dwordx4 a[88:91], v2, s[8:11], s22 offen offset:2048 sc1
  buffer_load_dwordx4 a[92:95], v2, s[8:11], s22 offen offset:3072 sc1
  s_add_u32 s22, s21, 24576
  buffer_load_dwordx4 a[96:99], v2, s[8:11], s22 offen offset:0 sc1
  buffer_load_dwordx4 a[100:103], v2, s[8:11], s22 offen offset:1024 sc1
  buffer_load_dwordx4 a[104:107], v2, s[8:11], s22 offen offset:2048 sc1
  buffer_load_dwordx4 a[108:111], v2, s[8:11], s22 offen offset:3072 sc1
  s_add_u32 s22, s23, 0
  buffer_load_dwordx4 a[112:115], v2, s[8:11], s22 offen offset:0 sc1
  buffer_load_dwordx4 a[116:119], v2, s[8:11], s22 offen offset:1024 sc1
  buffer_load_dwordx4 a[120:123], v2, s[8:11], s22 offen offset:2048 sc1
  buffer_load_dwordx4 a[124:127], v2, s[8:11], s22 offen offset:3072 sc1
  s_add_u32 s22, s23, 4096
  buffer_load_dwordx4 a[128:131], v2, s[8:11], s22 offen offset:0 sc1
  buffer_load_dwordx4 a[132:135], v2, s[8:11], s22 offen offset:1024 sc1
  buffer_load_dwordx4 a[136:139], v2, s[8:11], s22 offen offset:2048 sc1
  buffer_load_dwordx4 a[140:143], v2, s[8:11], s22 offen offset:3072 sc1
  s_add_u32 s22, s23, 8192
  buffer_load_dwordx4 a[144:147], v2, s[8:11], s22 offen offset:0 sc1
  buffer_load_dwordx4 a[148:151], v2, s[8:11], s22 offen offset:1024 sc1
  buffer_load_dwordx4 a[152:155], v2, s[8:11], s22 offen offset:2048 sc1
  buffer_load_dwordx4 a[156:159], v2, s[8:11], s22 offen offset:3072 sc1
  s_add_u32 s22, s23, 12288
  buffer_load_dwordx4 a[160:163], v2, s[8:11], s22 offen offset:0 sc1
  buffer_load_dwordx4 a[164:167], v2, s[8:11], s22 offen offset:1024 sc1
  buffer_load_dwordx4 a[168:171], v2, s[8:11], s22 offen offset:2048 sc1
  buffer_load_dwordx4 a[172:175], v2, s[8:11], s22 offen offset:3072 sc1
  s_add_u32 s22, s23, 16384
  buffer_load_dwordx4 a[176:179], v2, s[8:11], s22 offen offset:0 sc1
  buffer_load_dwordx4 a[180:183], v2, s[8:11], s22 offen offset:1024 sc1
  buffer_load_dwordx4 a[184:187], v2, s[8:11], s22 offen offset:2048 sc1
  buffer_load_dwordx4 a[188:191], v2, s[8:11], s22 offen offset:3072 sc1
  s_add_u32 s22, s23, 20480
  buffer_load_dwordx4 a[192:195], v2, s[8:11], s22 offen offset:0 sc1
  buffer_load_dwordx4 a[196:199], v2, s[8:11], s22 offen offset:1024 sc1
  buffer_load_dwordx4 a[200:203], v2, s[8:11], s22 offen offset:2048 sc1
  buffer_load_dwordx4 a[204:207], v2, s[8:11], s22 offen offset:3072 sc1
  s_add_u32 s22, s23, 24576
  buffer_load_dwordx4 a[208:211], v2, s[8:11], s22 offen offset:0 sc1
  buffer_load_dwordx4 a[212:215], v2, s[8:11], s22 offen offset:1024 sc1
  buffer_load_dwordx4 a[216:219], v2, s[8:11], s22 offen offset:2048 sc1
  buffer_load_dwordx4 a[220:223], v2, s[8:11], s22 offen offset:3072 sc1
  v_lshl_add_u32 v5, v3, 2, 0
  v_cmp_le_u32 s[40:41], v5, v4
  v_lshl_add_u32 v5, v3, 2, 1
  v_cmp_le_u32 s[42:43], v5, v4
  v_lshl_add_u32 v5, v3, 2, 2
  v_cmp_le_u32 s[44:45], v5, v4
  v_lshl_add_u32 v5, v3, 2, 3
  v_cmp_le_u32 s[46:47], v5, v4
  v_cmp_gt_u32 s[48:49], 2, v3
  v_mov_b32 v6, 0xff800000
  s_waitcnt vmcnt(0)
  v_mfma_f32_16x16x32_bf16 v[8:11], a[112:115], a[0:3], 0
  v_mfma_f32_16x16x32_bf16 v[12:15], a[112:115], a[56:59], 0
  v_mfma_f32_16x16x32_bf16 v[16:19], a[168:171], a[56:59], 0
  v_mfma_f32_16x16x32_bf16 v[8:11], a[116:119], a[4:7], v[8:11]
  v_mfma_f32_16x16x32_bf16 v[12:15], a[116:119], a[60:63], v[12:15]
  v_mfma_f32_16x16x32_bf16 v[16:19], a[172:175], a[60:63], v[16:19]
  v_mfma_f32_16x16x32_bf16 v[8:11], a[120:123], a[8:11], v[8:11]
  v_mfma_f32_16x16x32_bf16 v[12:15], a[120:123], a[64:67], v[12:15]
  v_mfma_f32_16x16x32_bf16 v[16:19], a[176:179], a[64:67], v[16:19]
  v_mfma_f32_16x16x32_bf16 v[8:11], a[124:127], a[12:15], v[8:11]
  v_mfma_f32_16x16x32_bf16 v[12:15], a[124:127], a[68:71], v[12:15]
  v_mfma_f32_16x16x32_bf16 v[16:19], a[180:183], a[68:71], v[16:19]
  v_mfma_f32_16x16x32_bf16 v[8:11], a[128:131], a[16:19], v[8:11]
  v_mfma_f32_16x16x32_bf16 v[12:15], a[128:131], a[72:75], v[12:15]
  v_mfma_f32_16x16x32_bf16 v[16:19], a[184:187], a[72:75], v[16:19]
  v_mfma_f32_16x16x32_bf16 v[8:11], a[132:135], a[20:23], v[8:11]
  v_mfma_f32_16x16x32_bf16 v[12:15], a[132:135], a[76:79], v[12:15]
  v_mfma_f32_16x16x32_bf16 v[16:19], a[188:191], a[76:79], v[16:19]
  v_mfma_f32_16x16x32_bf16 v[8:11], a[136:139], a[24:27], v[8:11]
  v_mfma_f32_16x16x32_bf16 v[12:15], a[136:139], a[80:83], v[12:15]
  v_mfma_f32_16x16x32_bf16 v[16:19], a[192:195], a[80:83], v[16:19]
  v_mfma_f32_16x16x32_bf16 v[8:11], a[140:143], a[28:31], v[8:11]
  v_mfma_f32_16x16x32_bf16 v[12:15], a[140:143], a[84:87], v[12:15]
  v_mfma_f32_16x16x32_bf16 v[16:19], a[196:199], a[84:87], v[16:19]
  v_mfma_f32_16x16x32_bf16 v[8:11], a[144:147], a[32:35], v[8:11]
  v_mfma_f32_16x16x32_bf16 v[12:15], a[144:147], a[88:91], v[12:15]
  v_mfma_f32_16x16x32_bf16 v[16:19], a[200:203], a[88:91], v[16:19]
  v_mfma_f32_16x16x32_bf16 v[8:11], a[148:151], a[36:39], v[8:11]
  v_mfma_f32_16x16x32_bf16 v[12:15], a[148:151], a[92:95], v[12:15]
  v_mfma_f32_16x16x32_bf16 v[16:19], a[204:207], a[92:95], v[16:19]
  v_mfma_f32_16x16x32_bf16 v[8:11], a[152:155], a[40:43], v[8:11]
  v_mfma_f32_16x16x32_bf16 v[12:15], a[152:155], a[96:99], v[12:15]
  v_mfma_f32_16x16x32_bf16 v[16:19], a[208:211], a[96:99], v[16:19]
  v_mfma_f32_16x16x32_bf16 v[8:11], a[156:159], a[44:47], v[8:11]
  v_mfma_f32_16x16x32_bf16 v[12:15], a[156:159], a[100:103], v[12:15]
  v_mfma_f32_16x16x32_bf16 v[16:19], a[212:215], a[100:103], v[16:19]
  v_mfma_f32_16x16x32_bf16 v[8:11], a[160:163], a[48:51], v[8:11]
  v_mfma_f32_16x16x32_bf16 v[12:15], a[160:163], a[104:107], v[12:15]
  v_mfma_f32_16x16x32_bf16 v[16:19], a[216:219], a[104:107], v[16:19]
  v_mfma_f32_16x16x32_bf16 v[8:11], a[164:167], a[52:55], v[8:11]
  v_mfma_f32_16x16x32_bf16 v[12:15], a[164:167], a[108:111], v[12:15]
  v_mfma_f32_16x16x32_bf16 v[16:19], a[220:223], a[108:111], v[16:19]
  s_mul_i32 s22, s20, 448
  v_mov_b32 v62, s22
  s_mov_b32 s30, 0
wp_pm:
  s_cmp_ge_u32 s17, 64
  s_cbranch_scc1 wp_pf
  s_cmp_ge_u32 s17, 61
  s_cbranch_scc1 mp_59a
  v_mov_b32 v61, 0
  s_mov_b64 exec, 1
  buffer_atomic_or v61, v62, s[8:11], s24 offen sc0
  s_mov_b64 exec, -1
  s_branch mp_59b
mp_59a:
  buffer_load_dword v61, v62, s[8:11], s24 offen sc1
mp_59b:
  s_waitcnt vmcnt(0)
  v_cmp_eq_u32 vcc, -1, v61
  s_cbranch_vccnz wp_pr
wp_pf:
  s_add_u32 s22, s24, 4096
  buffer_load_dwordx4 v[64:67], v2, s[8:11], s24 offen offset:0 sc1
  buffer_load_dwordx4 v[68:71], v2, s[8:11], s24 offen offset:1024 sc1
  buffer_load_dwordx4 v[72:75], v2, s[8:11], s24 offen offset:2048 sc1
  buffer_load_dwordx4 v[76:79], v2, s[8:11], s24 offen offset:3072 sc1
  buffer_load_dwordx4 v[80:83], v2, s[8:11], s22 offen offset:0 sc1
  buffer_load_dwordx4 v[84:87], v2, s[8:11], s22 offen offset:1024 sc1
  buffer_load_dwordx4 v[88:91], v2, s[8:11], s22 offen offset:2048 sc1
  s_waitcnt vmcnt(0)
  v_max_u32 v61, v64, v65
  v_max3_u32 v61, v61, v66, v67
  v_max3_u32 v61, v61, v68, v69
  v_max3_u32 v61, v61, v70, v71
  v_max3_u32 v61, v61, v72, v73
  v_max3_u32 v61, v61, v74, v75
  v_max3_u32 v61, v61, v76, v77
  v_max3_u32 v61, v61, v78, v79
  v_max3_u32 v61, v61, v80, v81
  v_max3_u32 v61, v61, v82, v83
  v_max3_u32 v61, v61, v84, v85
  v_max3_u32 v61, v61, v86, v87
  v_max3_u32 v61, v61, v88, v89
  v_max3_u32 v61, v61, v90, v91
  v_cmp_eq_u32 vcc, -1, v61
  s_cbranch_vccz wp_pk
wp_pr:
  s_sleep 1
  s_cmp_ge_u32 s17, 61
  s_cbranch_scc1 wp_pm_bo
  s_sleep 4
  s_cmp_ge_u32 s17, 56
  s_cbranch_scc1 wp_pm_bo
  s_sleep 40
wp_pm_bo:
  s_add_u32 s30, s30, 1
  s_cmp_lt_u32 s30, 30000
  s_cbranch_scc1 wp_pm
  s_branch wp_abort
wp_pk:
  s_cmp_lt_u32 s17, 56
  s_cbranch_scc1 pk_60
  buffer_load_dword v250, v251, s[12:15], 0 offen sc1
pk_60:
  v_mfma_f32_16x16x32_bf16 v[20:23], v[64:67], a[0:3], 0
  v_mfma_f32_16x16x32_bf16 v[24:27], v[64:67], a[4:7], 0
  v_mfma_f32_16x16x32_bf16 v[28:31], v[64:67], a[56:59], 0
  v_mfma_f32_16x16x32_bf16 v[32:35], v[64:67], a[60:63], 0
  v_mfma_f32_16x16x32_bf16 v[20:23], v[68:71], a[8:11], v[20:23]
  v_mfma_f32_16x16x32_bf16 v[24:27], v[68:71], a[12:15], v[24:27]
  v_mfma_f32_16x16x32_bf16 v[28:31], v[68:71], a[64:67], v[28:31]
  v_mfma_f32_16x16x32_bf16 v[32:35], v[68:71], a[68:71], v[32:35]
  v_mfma_f32_16x16x32_bf16 v[20:23], v[72:75], a[16:19], v[20:23]
  v_mfma_f32_16x16x32_bf16 v[24:27], v[72:75], a[20:23], v[24:27]
  v_mfma_f32_16x16x32_bf16 v[28:31], v[72:75], a[72:75], v[28:31]
  v_mfma_f32_16x16x32_bf16 v[32:35], v[72:75], a[76:79], v[32:35]
  v_mfma_f32_16x16x32_bf16 v[20:23], v[76:79], a[24:27], v[20:23]
  v_mfma_f32_16x16x32_bf16 v[24:27], v[76:79], a[28:31], v[24:27]
  v_mfma_f32_16x16x32_bf16 v[28:31], v[76:79], a[80:83], v[28:31]
  v_mfma_f32_16x16x32_bf16 v[32:35], v[76:79], a[84:87], v[32:35]
  v_mfma_f32_16x16x32_bf16 v[20:23], v[80:83], a[32:35], v[20:23]
  v_mfma_f32_16x16x32_bf16 v[24:27], v[80:83], a[36:39], v[24:27]
  v_mfma_f32_16x16x32_bf16 v[28:31], v[80:83], a[88:91], v[28:31]
  v_mfma_f32_16x16x32_bf16 v[32:35], v[80:83], a[92:95], v[32:35]
  v_mfma_f32_16x16x32_bf16 v[20:23], v[84:87], a[40:43], v[20:23]
  v_mfma_f32_16x16x32_bf16 v[24:27], v[84:87], a[44:47], v[24:27]
  v_mfma_f32_16x16x32_bf16 v[28:31], v[84:87], a[96:99], v[28:31]
  v_mfma_f32_16x16x32_bf16 v[32:35], v[84:87], a[100:103], v[32:35]
  v_mfma_f32_16x16x32_bf16 v[20:23], v[88:91], a[48:51], v[20:23]
  v_mfma_f32_16x16x32_bf16 v[24:27], v[88:91], a[52:55], v[24:27]
  v_mfma_f32_16x16x32_bf16 v[28:31], v[88:91], a[104:107], v[28:31]
  v_mfma_f32_16x16x32_bf16 v[32:35], v[88:91], a[108:111], v[32:35]
  s_lshl_b32 s25, s17, 1
  s_mul_i32 s25, s25, 20480
  s_add_u32 s25, s25, 85458944
  s_lshl_b32 s26, s20, 10
  s_add_u32 s26, s26, s25
  s_lshl_b32 s27, s18, 10
  s_add_u32 s27, s27, s25
  s_lshr_b32 s28, s16, 1
  s_lshl_b32 s28, s28, 3
  s_add_u32 s27, s27, s28
  s_add_u32 s27, s27, 16384
  s_and_b32 s28, s16, 1
  s_cmp_eq_u32 s28, 0
  s_cselect_b32 s50, -1, 0
  s_cselect_b32 s51, 0, -1
  v_cndmask_b32 v8, v6, v8, s[40:41]
  v_cndmask_b32 v9, v6, v9, s[42:43]
  v_cndmask_b32 v10, v6, v10, s[44:45]
  v_cndmask_b32 v11, v6, v11, s[46:47]
  v_cndmask_b32 v20, v24, v20, s[48:49]
  v_cndmask_b32 v21, v25, v21, s[48:49]
  v_cndmask_b32 v22, v26, v22, s[48:49]
  v_cndmask_b32 v23, v27, v23, s[48:49]
  v_mov_b32 v24, v20
  v_mov_b32 v25, v21
  v_mov_b32 v26, v22
  v_mov_b32 v27, v23
  v_permlane32_swap_b32 v20, v24
  v_permlane32_swap_b32 v21, v25
  v_permlane32_swap_b32 v22, v26
  v_permlane32_swap_b32 v23, v27
  v_add_f32 v20, v20, v24
  v_add_f32 v21, v21, v25
  v_add_f32 v22, v22, v26
  v_add_f32 v23, v23, v27
  v_max3_f32 v40, v8, v9, v10
  v_max3_f32 v40, v40, v11, v20
  v_max3_f32 v40, v40, v21, v22
  v_max_f32 v40, v40, v23
  v_mov_b32 v41, v40
  s_nop 1
  v_permlane16_swap_b32 v40, v41
  v_max_f32 v40, v40, v41
  v_mov_b32 v41, v40
  s_nop 1
  v_permlane32_swap_b32 v40, v41
  v_max_f32 v40, v40, v41
  v_sub_f32 v8, v8, v40
  v_sub_f32 v9, v9, v40
  v_sub_f32 v10, v10, v40
  v_sub_f32 v11, v11, v40
  v_sub_f32 v20, v20, v40
  v_sub_f32 v21, v21, v40
  v_sub_f32 v22, v22, v40
  v_sub_f32 v23, v23, v40
  v_exp_f32 v8, v8
  v_exp_f32 v9, v9
  v_exp_f32 v10, v10
  v_exp_f32 v11, v11
  v_exp_f32 v20, v20
  v_exp_f32 v21, v21
  v_exp_f32 v22, v22
  v_exp_f32 v23, v23
  v_add_f32 v42, v20, v21
  v_add_f32 v43, v22, v23
  v_add_f32 v42, v42, v43
  v_mul_f32 v42, 0.5, v42
  v_add_f32 v42, v42, v8
  v_add_f32 v42, v42, v9
  v_add_f32 v42, v42, v10
  v_add_f32 v42, v42, v11
  v_mov_b32 v41, v42
  s_nop 1
  v_permlane16_swap_b32 v42, v41
  v_add_f32 v42, v42, v41
  v_mov_b32 v41, v42
  s_nop 1
  v_permlane32_swap_b32 v42, v41
  v_add_f32 v42, v42, v41
  v_rcp_f32 v42, v42
  s_nop 0
  v_mul_f32 v8, v8, v42
  v_mul_f32 v9, v9, v42
  v_mul_f32 v10, v10, v42
  v_mul_f32 v11, v11, v42
  v_mul_f32 v20, v20, v42
  v_mul_f32 v21, v21, v42
  v_mul_f32 v22, v22, v42
  v_mul_f32 v23, v23, v42
  v_cvt_pk_bf16_f32 v44, v8, v9
  v_cvt_pk_bf16_f32 v45, v10, v11
  v_mov_b32 v46, 0
  v_mov_b32 v47, 0
  v_cvt_pk_bf16_f32 v48, v20, v21
  v_cvt_pk_bf16_f32 v49, v22, v23
  v_min_u32 v44, -2, v44
  v_min_u32 v45, -2, v45
  v_min_u32 v46, -2, v46
  v_min_u32 v47, -2, v47
  v_min_u32 v48, -2, v48
  v_min_u32 v49, -2, v49
  buffer_store_dwordx4 v[44:47], v2, s[8:11], s26 offen sc1
  s_mov_b64 exec, s[50:51]
  buffer_store_dwordx2 v[48:49], v2, s[8:11], s27 offen sc1
  s_mov_b64 exec, -1
  s_add_u32 s26, s26, 20480
  s_add_u32 s27, s27, 20480
  v_cndmask_b32 v16, v6, v16, s[40:41]
  v_cndmask_b32 v17, v6, v17, s[42:43]
  v_cndmask_b32 v18, v6, v18, s[44:45]
  v_cndmask_b32 v19, v6, v19, s[46:47]
  v_cndmask_b32 v28, v32, v28, s[48:49]
  v_cndmask_b32 v29, v33, v29, s[48:49]
  v_cndmask_b32 v30, v34, v30, s[48:49]
  v_cndmask_b32 v31, v35, v31, s[48:49]
  v_mov_b32 v32, v28
  v_mov_b32 v33, v29
  v_mov_b32 v34, v30
  v_mov_b32 v35, v31
  v_permlane32_swap_b32 v28, v32
  v_permlane32_swap_b32 v29, v33
  v_permlane32_swap_b32 v30, v34
  v_permlane32_swap_b32 v31, v35
  v_add_f32 v28, v28, v32
  v_add_f32 v29, v29, v33
  v_add_f32 v30, v30, v34
  v_add_f32 v31, v31, v35
  v_max3_f32 v40, v12, v13, v14
  v_max3_f32 v40, v40, v15, v16
  v_max3_f32 v40, v40, v17, v18
  v_max3_f32 v40, v40, v19, v28
  v_max3_f32 v40, v40, v29, v30
  v_max_f32 v40, v40, v31
  v_mov_b32 v41, v40
  s_nop 1
  v_permlane16_swap_b32 v40, v41
  v_max_f32 v40, v40, v41
  v_mov_b32 v41, v40
  s_nop 1
  v_permlane32_swap_b32 v40, v41
  v_max_f32 v40, v40, v41
  v_sub_f32 v12, v12, v40
  v_sub_f32 v13, v13, v40
  v_sub_f32 v14, v14, v40
  v_sub_f32 v15, v15, v40
  v_sub_f32 v16, v16, v40
  v_sub_f32 v17, v17, v40
  v_sub_f32 v18, v18, v40
  v_sub_f32 v19, v19, v40
  v_sub_f32 v28, v28, v40
  v_sub_f32 v29, v29, v40
  v_sub_f32 v30, v30, v40
  v_sub_f32 v31, v31, v40
  v_exp_f32 v12, v12
  v_exp_f32 v13, v13
  v_exp_f32 v14, v14
  v_exp_f32 v15, v15
  v_exp_f32 v16, v16
  v_exp_f32 v17, v17
  v_exp_f32 v18, v18
  v_exp_f32 v19, v19
  v_exp_f32 v28, v28
  v_exp_f32 v29, v29
  v_exp_f32 v30, v30
  v_exp_f32 v31, v31
  v_add_f32 v42, v28, v29
  v_add_f32 v43, v30, v31
  v_add_f32 v42, v42, v43
  v_mul_f32 v42, 0.5, v42
  v_add_f32 v42, v42, v12
  v_add_f32 v42, v42, v13
  v_add_f32 v42, v42, v14
  v_add_f32 v42, v42, v15
  v_add_f32 v42, v42, v16
  v_add_f32 v42, v42, v17
  v_add_f32 v42, v42, v18
  v_add_f32 v42, v42, v19
  v_mov_b32 v41, v42
  s_nop 1
  v_permlane16_swap_b32 v42, v41
  v_add_f32 v42, v42, v41
  v_mov_b32 v41, v42
  s_nop 1
  v_permlane32_swap_b32 v42, v41
  v_add_f32 v42, v42, v41
  v_rcp_f32 v42, v42
  s_nop 0
  v_mul_f32 v12, v12, v42
  v_mul_f32 v13, v13, v42
  v_mul_f32 v14, v14, v42
  v_mul_f32 v15, v15, v42
  v_mul_f32 v16, v16, v42
  v_mul_f32 v17, v17, v42
  v_mul_f32 v18, v18, v42
  v_mul_f32 v19, v19, v42
  v_mul_f32 v28, v28, v42
  v_mul_f32 v29, v29, v42
  v_mul_f32 v30, v30, v42
  v_mul_f32 v31, v31, v42
  v_cvt_pk_bf16_f32 v52, v12, v13
  v_cvt_pk_bf16_f32 v53, v14, v15
  v_cvt_pk_bf16_f32 v54, v16, v17
  v_cvt_pk_bf16_f32 v55, v18, v19
  v_cvt_pk_bf16_f32 v56, v28, v29
  v_cvt_pk_bf16_f32 v57, v30, v31
  v_min_u32 v52, -2, v52
  v_min_u32 v53, -2, v53
  v_min_u32 v54, -2, v54
  v_min_u32 v55, -2, v55
  v_min_u32 v56, -2, v56
  v_min_u32 v57, -2, v57
  buffer_store_dwordx4 v[52:55], v2, s[8:11], s26 offen sc1
  s_mov_b64 exec, s[50:51]
  buffer_store_dwordx2 v[56:57], v2, s[8:11], s27 offen sc1
  s_mov_b64 exec, -1
  s_lshl_b32 s25, s17, 7
  s_add_u32 s25, s25, 88573952
  v_mov_b32 v5, 1
  v_mov_b32 v6, 0
  s_waitcnt vmcnt(0)
  s_mov_b64 exec, 1
  buffer_atomic_add v5, v6, s[8:11], s25 offen
  s_mov_b64 exec, -1
  s_branch wk_loop
wk_toko:
  s_lshl_b32 s20, s18, 2
  s_add_u32 s20, s20, s16
  s_mul_i32 s24, s20, 65
  s_add_u32 s24, s24, s17
  s_lshl_b32 s24, s24, 13
  s_add_u32 s24, s24, 76947456
  s_lshl_b32 s21, s20, 6
  s_add_u32 s21, s21, s17
  s_mul_i32 s21, s21, 28672
  s_add_u32 s21, s21, 42205184
  s_lshl_b32 s25, s17, 1
  s_mul_i32 s25, s25, 20480
  s_add_u32 s25, s25, 85458944
  v_lshrrev_b32 v8, 5, v1
  v_and_b32 v9, 31, v1
  v_lshrrev_b32 v10, 4, v9
  v_min_u32 v5, 27, v9
  v_and_b32 v5, 15, v5
  v_lshlrev_b32 v6, 1, v10
  v_sub_u32 v6, 8, v6
  v_lshlrev_b32 v7, 10, v10
  v_lshl_add_u32 v7, v5, 4, v7
  v_lshlrev_b32 v6, 5, v6
  v_mad_u32_u24 v5, v8, v6, v7
  v_lshl_add_u32 v63, v6, 1, v5
  v_lshl_add_u32 v7, v8, 3, v7
  v_mul_u32_u24 v6, 20480, v10
  v_lshl_add_u32 v6, v8, 8, v6
  v_lshl_add_u32 v6, v4, 4, v6
  s_lshr_b32 s26, s17, 3
  s_lshl_b32 s26, s26, 4
  s_add_u32 s26, s26, s20
  s_lshl_b32 s26, s26, 7
  s_add_u32 s26, s26, 88541184
  v_mov_b32 v60, 0
  s_mov_b32 s30, 0
wo_wv:
  buffer_load_dword v61, v60, s[8:11], s26 offen sc1
  s_waitcnt vmcnt(0)
  v_cmp_ne_u32 vcc, 56, v61
  s_cbranch_vccz wo_wv_ok
  s_sleep 1
  s_cmp_ge_u32 s17, 61
  s_cbranch_scc1 wo_wv_bo
  s_sleep 4
  s_cmp_ge_u32 s17, 56
  s_cbranch_scc1 wo_wv_bo
  s_sleep 40
wo_wv_bo:
  s_add_u32 s30, s30, 1
  s_cmp_lt_u32 s30, 30000
  s_cbranch_scc1 wo_wv
  s_branch wo_abort
wo_wv_ok:
  s_add_u32 s22, s21, 0
  buffer_load_dwordx4 a[0:3], v5, s[8:11], s22 offen offset:0 sc1
  buffer_load_dwordx4 a[4:7], v63, s[8:11], s22 offen offset:0 sc1
  buffer_load_dwordx4 a[8:11], v5, s[8:11], s22 offen offset:1792 sc1
  buffer_load_dwordx4 a[12:15], v63, s[8:11], s22 offen offset:1792 sc1
  s_add_u32 s22, s21, 3584
  buffer_load_dwordx4 a[16:19], v5, s[8:11], s22 offen offset:0 sc1
  buffer_load_dwordx4 a[20:23], v63, s[8:11], s22 offen offset:0 sc1
  buffer_load_dwordx4 a[24:27], v5, s[8:11], s22 offen offset:1792 sc1
  buffer_load_dwordx4 a[28:31], v63, s[8:11], s22 offen offset:1792 sc1
  s_add_u32 s22, s21, 7168
  buffer_load_dwordx4 a[32:35], v5, s[8:11], s22 offen offset:0 sc1
  buffer_load_dwordx4 a[36:39], v63, s[8:11], s22 offen offset:0 sc1
  buffer_load_dwordx4 a[40:43], v5, s[8:11], s22 offen offset:1792 sc1
  buffer_load_dwordx4 a[44:47], v63, s[8:11], s22 offen offset:1792 sc1
  s_add_u32 s22, s21, 10752
  buffer_load_dwordx4 a[48:51], v5, s[8:11], s22 offen offset:0 sc1
  buffer_load_dwordx4 a[52:55], v63, s[8:11], s22 offen offset:0 sc1
  buffer_load_dwordx4 a[56:59], v5, s[8:11], s22 offen offset:1792 sc1
  buffer_load_dwordx4 a[60:63], v63, s[8:11], s22 offen offset:1792 sc1
  s_add_u32 s22, s21, 14336
  buffer_load_dwordx4 a[64:67], v5, s[8:11], s22 offen offset:0 sc1
  buffer_load_dwordx4 a[68:71], v63, s[8:11], s22 offen offset:0 sc1
  buffer_load_dwordx4 a[72:75], v5, s[8:11], s22 offen offset:1792 sc1
  buffer_load_dwordx4 a[76:79], v63, s[8:11], s22 offen offset:1792 sc1
  s_add_u32 s22, s21, 17920
  buffer_load_dwordx4 a[80:83], v5, s[8:11], s22 offen offset:0 sc1
  buffer_load_dwordx4 a[84:87], v63, s[8:11], s22 offen offset:0 sc1
  buffer_load_dwordx4 a[88:91], v5, s[8:11], s22 offen offset:1792 sc1
  buffer_load_dwordx4 a[92:95], v63, s[8:11], s22 offen offset:1792 sc1
  s_add_u32 s22, s21, 21504
  buffer_load_dwordx4 a[96:99], v5, s[8:11], s22 offen offset:0 sc1
  buffer_load_dwordx4 a[100:103], v63, s[8:11], s22 offen offset:0 sc1
  buffer_load_dwordx4 a[104:107], v5, s[8:11], s22 offen offset:1792 sc1
  buffer_load_dwordx4 a[108:111], v63, s[8:11], s22 offen offset:1792 sc1
  s_add_u32 s22, s21, 25088
  buffer_load_dwordx4 a[112:115], v5, s[8:11], s22 offen offset:0 sc1
  buffer_load_dwordx4 a[116:119], v63, s[8:11], s22 offen offset:0 sc1
  buffer_load_dwordx4 a[120:123], v5, s[8:11], s22 offen offset:1792 sc1
  buffer_load_dwordx4 a[124:127], v63, s[8:11], s22 offen offset:1792 sc1
  s_cmp_ge_u32 s17, 61
  s_cbranch_scc1 wo_lm
  s_lshl_b32 s26, s17, 7
  s_add_u32 s26, s26, 88573952
  v_mov_b32 v60, 0
  s_mov_b32 s30, 0
wo_wp:
  buffer_load_dword v61, v60, s[8:11], s26 offen sc1
  s_waitcnt vmcnt(0)
  v_cmp_ne_u32 vcc, 16, v61
  s_cbranch_vccz wo_wp_ok
  s_sleep 2
  s_cmp_ge_u32 s17, 61
  s_cbranch_scc1 wo_wp_bo
  s_sleep 4
  s_cmp_ge_u32 s17, 56
  s_cbranch_scc1 wo_wp_bo
  s_sleep 40
wo_wp_bo:
  s_add_u32 s30, s30, 1
  s_cmp_lt_u32 s30, 30000
  s_cbranch_scc1 wo_wp
  s_branch wo_abort
wo_wp_ok:
  s_branch wo_lp
wo_lm:
  s_mul_i32 s26, s17, 7168
  s_add_u32 s26, s26, 88080384
  v_mov_b32 v60, 0
  s_mov_b32 s30, 0
wo_wm:
  buffer_load_dword v61, v60, s[8:11], s26 offen sc1
  s_waitcnt vmcnt(0)
  v_cmp_eq_u32 vcc, -1, v61
  s_cbranch_vccz wo_wm_ok
  s_sleep 2
  s_cmp_ge_u32 s17, 61
  s_cbranch_scc1 wo_wm_bo
  s_sleep 4
  s_cmp_ge_u32 s17, 56
  s_cbranch_scc1 wo_wm_bo
  s_sleep 40
wo_wm_bo:
  s_add_u32 s30, s30, 1
  s_cmp_lt_u32 s30, 30000
  s_cbranch_scc1 wo_wm
  s_branch wo_abort
wo_wm_ok:
wo_lp:
  s_mul_i32 s26, s16, 10240
  s_add_u32 s27, s25, s26
  v_add_u32 v11, s26, v2
  s_lshl_b32 s26, s20, 6
  s_add_u32 s26, s26, s17
  s_lshl_b32 s26, s26, 4
  s_add_u32 s26, s26, 88582144
  v_lshlrev_b32 v60, 2, v3
  s_mov_b32 s30, 0
wo_pl:
  s_add_u32 s22, s27, 0
  buffer_load_dwordx4 v[128:131], v2, s[8:11], s22 offen offset:0 sc1
  buffer_load_dwordx4 v[132:135], v2, s[8:11], s22 offen offset:1024 sc1
  buffer_load_dwordx4 v[136:139], v2, s[8:11], s22 offen offset:2048 sc1
  buffer_load_dwordx4 v[140:143], v2, s[8:11], s22 offen offset:3072 sc1
  s_add_u32 s22, s27, 4096
  buffer_load_dwordx4 v[144:147], v2, s[8:11], s22 offen offset:0 sc1
  buffer_load_dwordx4 v[148:151], v2, s[8:11], s22 offen offset:1024 sc1
  buffer_load_dwordx4 v[152:155], v2, s[8:11], s22 offen offset:2048 sc1
  buffer_load_dwordx4 v[156:159], v2, s[8:11], s22 offen offset:3072 sc1
  s_add_u32 s22, s27, 8192
  buffer_load_dwordx4 v[160:163], v2, s[8:11], s22 offen offset:0 sc1
  buffer_load_dwordx4 v[164:167], v2, s[8:11], s22 offen offset:1024 sc1
  buffer_load_dword v61, v60, s[8:11], s26 offen sc1
  s_waitcnt vmcnt(1)
  v_max_u32 v62, v128, v129
  v_max3_u32 v62, v62, v130, v131
  v_max3_u32 v62, v62, v132, v133
  v_max3_u32 v62, v62, v134, v135
  v_max3_u32 v62, v62, v136, v137
  v_max3_u32 v62, v62, v138, v139
  v_max3_u32 v62, v62, v140, v141
  v_max3_u32 v62, v62, v142, v143
  v_max3_u32 v62, v62, v144, v145
  v_max3_u32 v62, v62, v146, v147
  v_max3_u32 v62, v62, v148, v149
  v_max3_u32 v62, v62, v150, v151
  v_max3_u32 v62, v62, v152, v153
  v_max3_u32 v62, v62, v154, v155
  v_max3_u32 v62, v62, v156, v157
  v_max3_u32 v62, v62, v158, v159
  v_max3_u32 v62, v62, v160, v161
  v_max3_u32 v62, v62, v162, v163
  v_max3_u32 v62, v62, v164, v165
  v_max3_u32 v62, v62, v166, v167
  v_cmp_eq_u32 vcc, -1, v62
  s_cbranch_vccz wo_pk
  s_add_u32 s30, s30, 1
  s_cmp_lt_u32 s30, 30000
  s_cbranch_scc1 wo_pl
  s_branch wo_abort
wo_pk:
  ds_write_b128 v11, v[128:131] offset:0
  ds_write_b128 v11, v[132:135] offset:1024
  ds_write_b128 v11, v[136:139] offset:2048
  ds_write_b128 v11, v[140:143] offset:3072
  ds_write_b128 v11, v[144:147] offset:4096
  ds_write_b128 v11, v[148:151] offset:5120
  ds_write_b128 v11, v[152:155] offset:6144
  ds_write_b128 v11, v[156:159] offset:7168
  ds_write_b128 v11, v[160:163] offset:8192
  ds_write_b128 v11, v[164:167] offset:9216
  s_waitcnt vmcnt(0)
  v_cmp_ne_u32 vcc, 1, v61
  s_mov_b32 s28, 0
  s_cbranch_vccnz wo_nt
  s_add_u32 s22, s24, 0
  buffer_load_dwordx2 v[28:29], v7, s[8:11], s22 offen offset:0 sc1
  buffer_load_dwordx2 v[30:31], v7, s[8:11], s22 offen offset:512 sc1
  buffer_load_dwordx2 v[32:33], v7, s[8:11], s22 offen offset:256 sc1
  buffer_load_dwordx2 v[34:35], v7, s[8:11], s22 offen offset:768 sc1
  buffer_load_dwordx2 v[36:37], v7, s[8:11], s22 offen offset:2048 sc1
  buffer_load_dwordx2 v[38:39], v7, s[8:11], s22 offen offset:2560 sc1
  buffer_load_dwordx2 v[40:41], v7, s[8:11], s22 offen offset:2304 sc1
  buffer_load_dwordx2 v[42:43], v7, s[8:11], s22 offen offset:2816 sc1
  s_add_u32 s22, s24, 4096
  buffer_load_dwordx2 v[44:45], v7, s[8:11], s22 offen offset:0 sc1
  buffer_load_dwordx2 v[46:47], v7, s[8:11], s22 offen offset:512 sc1
  buffer_load_dwordx2 v[48:49], v7, s[8:11], s22 offen offset:256 sc1
  buffer_load_dwordx2 v[50:51], v7, s[8:11], s22 offen offset:768 sc1
  buffer_load_dwordx2 v[52:53], v7, s[8:11], s22 offen offset:2048 sc1
  buffer_load_dwordx2 v[54:55], v7, s[8:11], s22 offen offset:2560 sc1
  buffer_load_dwordx2 v[56:57], v7, s[8:11], s22 offen offset:2304 sc1
  buffer_load_dwordx2 v[58:59], v7, s[8:11], s22 offen offset:2816 sc1
  s_mov_b32 s28, 1
wo_nt:
  s_cmp_lt_u32 s17, 56
  s_cbranch_scc1 pk_61
  buffer_load_dword v250, v251, s[12:15], 0 offen sc1
pk_61:
  s_waitcnt lgkmcnt(0)
  s_barrier
  buffer_load_dword v61, v60, s[8:11], s26 offen sc1
  ds_read_b128 v[64:67], v6 offset:0
  ds_read_b128 v[68:71], v6 offset:512
  ds_read_b128 v[72:75], v6 offset:1024
  ds_read_b128 v[76:79], v6 offset:1536
  ds_read_b128 v[80:83], v6 offset:2048
  ds_read_b128 v[84:87], v6 offset:2560
  ds_read_b128 v[88:91], v6 offset:3072
  s_waitcnt lgkmcnt(6)
  v_mfma_f32_32x32x16_bf16 v[12:27], a[0:3], v[64:67], 0
  ds_read_b128 v[92:95], v6 offset:3584
  s_waitcnt lgkmcnt(6)
  v_mfma_f32_32x32x16_bf16 v[12:27], a[4:7], v[68:71], v[12:27]
  ds_read_b128 v[64:67], v6 offset:4096
  s_waitcnt lgkmcnt(6)
  v_mfma_f32_32x32x16_bf16 v[12:27], a[8:11], v[72:75], v[12:27]
  ds_read_b128 v[68:71], v6 offset:4608
  s_waitcnt lgkmcnt(6)
  v_mfma_f32_32x32x16_bf16 v[12:27], a[12:15], v[76:79], v[12:27]
  ds_read_b128 v[72:75], v6 offset:5120
  s_waitcnt lgkmcnt(6)
  v_mfma_f32_32x32x16_bf16 v[12:27], a[16:19], v[80:83], v[12:27]
  ds_read_b128 v[76:79], v6 offset:5632
  s_waitcnt lgkmcnt(6)
  v_mfma_f32_32x32x16_bf16 v[12:27], a[20:23], v[84:87], v[12:27]
  ds_read_b128 v[80:83], v6 offset:6144
  s_waitcnt lgkmcnt(6)
  v_mfma_f32_32x32x16_bf16 v[12:27], a[24:27], v[88:91], v[12:27]
  ds_read_b128 v[84:87], v6 offset:6656
  s_waitcnt lgkmcnt(6)
  v_mfma_f32_32x32x16_bf16 v[12:27], a[28:31], v[92:95], v[12:27]
  ds_read_b128 v[88:91], v6 offset:7168
  s_waitcnt lgkmcnt(6)
  v_mfma_f32_32x32x16_bf16 v[12:27], a[32:35], v[64:67], v[12:27]
  ds_read_b128 v[92:95], v6 offset:7680
  s_waitcnt lgkmcnt(6)
  v_mfma_f32_32x32x16_bf16 v[12:27], a[36:39], v[68:71], v[12:27]
  ds_read_b128 v[64:67], v6 offset:8192
  s_waitcnt lgkmcnt(6)
  v_mfma_f32_32x32x16_bf16 v[12:27], a[40:43], v[72:75], v[12:27]
  ds_read_b128 v[68:71], v6 offset:8704
  s_waitcnt lgkmcnt(6)
  v_mfma_f32_32x32x16_bf16 v[12:27], a[44:47], v[76:79], v[12:27]
  ds_read_b128 v[72:75], v6 offset:9216
  s_waitcnt lgkmcnt(6)
  v_mfma_f32_32x32x16_bf16 v[12:27], a[48:51], v[80:83], v[12:27]
  ds_read_b128 v[76:79], v6 offset:9728
  s_waitcnt lgkmcnt(6)
  v_mfma_f32_32x32x16_bf16 v[12:27], a[52:55], v[84:87], v[12:27]
  ds_read_b128 v[80:83], v6 offset:10240
  s_waitcnt lgkmcnt(6)
  v_mfma_f32_32x32x16_bf16 v[12:27], a[56:59], v[88:91], v[12:27]
  ds_read_b128 v[84:87], v6 offset:10752
  s_waitcnt lgkmcnt(6)
  v_mfma_f32_32x32x16_bf16 v[12:27], a[60:63], v[92:95], v[12:27]
  ds_read_b128 v[88:91], v6 offset:11264
  s_waitcnt lgkmcnt(6)
  v_mfma_f32_32x32x16_bf16 v[12:27], a[64:67], v[64:67], v[12:27]
  ds_read_b128 v[92:95], v6 offset:11776
  s_waitcnt lgkmcnt(6)
  v_mfma_f32_32x32x16_bf16 v[12:27], a[68:71], v[68:71], v[12:27]
  ds_read_b128 v[64:67], v6 offset:12288
  s_waitcnt lgkmcnt(6)
  v_mfma_f32_32x32x16_bf16 v[12:27], a[72:75], v[72:75], v[12:27]
  ds_read_b128 v[68:71], v6 offset:12800
  s_waitcnt lgkmcnt(6)
  v_mfma_f32_32x32x16_bf16 v[12:27], a[76:79], v[76:79], v[12:27]
  s_cmp_lg_u32 s28, 0
  s_cbranch_scc1 wo_h2
  s_waitcnt vmcnt(0)
  v_cmp_ne_u32 vcc, 1, v61
  s_cbranch_vccnz wo_h2
  s_add_u32 s22, s24, 0
  buffer_load_dwordx2 v[28:29], v7, s[8:11], s22 offen offset:0 sc1
  buffer_load_dwordx2 v[30:31], v7, s[8:11], s22 offen offset:512 sc1
  buffer_load_dwordx2 v[32:33], v7, s[8:11], s22 offen offset:256 sc1
  buffer_load_dwordx2 v[34:35], v7, s[8:11], s22 offen offset:768 sc1
  buffer_load_dwordx2 v[36:37], v7, s[8:11], s22 offen offset:2048 sc1
  buffer_load_dwordx2 v[38:39], v7, s[8:11], s22 offen offset:2560 sc1
  buffer_load_dwordx2 v[40:41], v7, s[8:11], s22 offen offset:2304 sc1
  buffer_load_dwordx2 v[42:43], v7, s[8:11], s22 offen offset:2816 sc1
  s_add_u32 s22, s24, 4096
  buffer_load_dwordx2 v[44:45], v7, s[8:11], s22 offen offset:0 sc1
  buffer_load_dwordx2 v[46:47], v7, s[8:11], s22 offen offset:512 sc1
  buffer_load_dwordx2 v[48:49], v7, s[8:11], s22 offen offset:256 sc1
  buffer_load_dwordx2 v[50:51], v7, s[8:11], s22 offen offset:768 sc1
  buffer_load_dwordx2 v[52:53], v7, s[8:11], s22 offen offset:2048 sc1
  buffer_load_dwordx2 v[54:55], v7, s[8:11], s22 offen offset:2560 sc1
  buffer_load_dwordx2 v[56:57], v7, s[8:11], s22 offen offset:2304 sc1
  buffer_load_dwordx2 v[58:59], v7, s[8:11], s22 offen offset:2816 sc1
  s_mov_b32 s28, 1
wo_h2:
  ds_read_b128 v[72:75], v6 offset:13312
  s_waitcnt lgkmcnt(6)
  v_mfma_f32_32x32x16_bf16 v[12:27], a[80:83], v[80:83], v[12:27]
  ds_read_b128 v[76:79], v6 offset:13824
  s_waitcnt lgkmcnt(6)
  v_mfma_f32_32x32x16_bf16 v[12:27], a[84:87], v[84:87], v[12:27]
  ds_read_b128 v[80:83], v6 offset:14336
  s_waitcnt lgkmcnt(6)
  v_mfma_f32_32x32x16_bf16 v[12:27], a[88:91], v[88:91], v[12:27]
  ds_read_b128 v[84:87], v6 offset:14848
  s_waitcnt lgkmcnt(6)
  v_mfma_f32_32x32x16_bf16 v[12:27], a[92:95], v[92:95], v[12:27]
  ds_read_b128 v[88:91], v6 offset:15360
  s_waitcnt lgkmcnt(6)
  v_mfma_f32_32x32x16_bf16 v[12:27], a[96:99], v[64:67], v[12:27]
  ds_read_b128 v[92:95], v6 offset:15872
  s_waitcnt lgkmcnt(6)
  v_mfma_f32_32x32x16_bf16 v[12:27], a[100:103], v[68:71], v[12:27]
  ds_read_b128 v[64:67], v6 offset:16384
  s_waitcnt lgkmcnt(6)
  v_mfma_f32_32x32x16_bf16 v[12:27], a[104:107], v[72:75], v[12:27]
  ds_read_b128 v[68:71], v6 offset:16896
  s_waitcnt lgkmcnt(6)
  v_mfma_f32_32x32x16_bf16 v[12:27], a[108:111], v[76:79], v[12:27]
  ds_read_b128 v[72:75], v6 offset:17408
  s_waitcnt lgkmcnt(6)
  v_mfma_f32_32x32x16_bf16 v[12:27], a[112:115], v[80:83], v[12:27]
  ds_read_b128 v[76:79], v6 offset:17920
  s_waitcnt lgkmcnt(6)
  v_mfma_f32_32x32x16_bf16 v[12:27], a[116:119], v[84:87], v[12:27]
  ds_read_b128 v[80:83], v6 offset:18432
  s_waitcnt lgkmcnt(6)
  v_mfma_f32_32x32x16_bf16 v[12:27], a[120:123], v[88:91], v[12:27]
  ds_read_b128 v[84:87], v6 offset:18944
  s_waitcnt lgkmcnt(6)
  v_mfma_f32_32x32x16_bf16 v[12:27], a[124:127], v[92:95], v[12:27]
  s_cmp_lg_u32 s28, 0
  s_cbranch_scc1 wo_ht
  v_lshlrev_b32 v60, 2, v3
  s_mov_b32 s30, 0
wo_wt:
  buffer_load_dword v61, v60, s[8:11], s26 offen sc1
  s_waitcnt vmcnt(0)
  v_cmp_ne_u32 vcc, 1, v61
  s_cbranch_vccz wo_wt_ok
  s_sleep 1
  s_cmp_ge_u32 s17, 61
  s_cbranch_scc1 wo_wt_bo
  s_sleep 4
  s_cmp_ge_u32 s17, 56
  s_cbranch_scc1 wo_wt_bo
  s_sleep 40
wo_wt_bo:
  s_add_u32 s30, s30, 1
  s_cmp_lt_u32 s30, 30000
  s_cbranch_scc1 wo_wt
  s_branch wo_abort
wo_wt_ok:
  s_add_u32 s22, s24, 0
  buffer_load_dwordx2 v[28:29], v7, s[8:11], s22 offen offset:0 sc1
  buffer_load_dwordx2 v[30:31], v7, s[8:11], s22 offen offset:512 sc1
  buffer_load_dwordx2 v[32:33], v7, s[8:11], s22 offen offset:256 sc1
  buffer_load_dwordx2 v[34:35], v7, s[8:11], s22 offen offset:768 sc1
  buffer_load_dwordx2 v[36:37], v7, s[8:11], s22 offen offset:2048 sc1
  buffer_load_dwordx2 v[38:39], v7, s[8:11], s22 offen offset:2560 sc1
  buffer_load_dwordx2 v[40:41], v7, s[8:11], s22 offen offset:2304 sc1
  buffer_load_dwordx2 v[42:43], v7, s[8:11], s22 offen offset:2816 sc1
  s_add_u32 s22, s24, 4096
  buffer_load_dwordx2 v[44:45], v7, s[8:11], s22 offen offset:0 sc1
  buffer_load_dwordx2 v[46:47], v7, s[8:11], s22 offen offset:512 sc1
  buffer_load_dwordx2 v[48:49], v7, s[8:11], s22 offen offset:256 sc1
  buffer_load_dwordx2 v[50:51], v7, s[8:11], s22 offen offset:768 sc1
  buffer_load_dwordx2 v[52:53], v7, s[8:11], s22 offen offset:2048 sc1
  buffer_load_dwordx2 v[54:55], v7, s[8:11], s22 offen offset:2560 sc1
  buffer_load_dwordx2 v[56:57], v7, s[8:11], s22 offen offset:2304 sc1
  buffer_load_dwordx2 v[58:59], v7, s[8:11], s22 offen offset:2816 sc1
wo_ht:
  ds_read_b128 v[88:91], v6 offset:19456
  s_waitcnt lgkmcnt(6) vmcnt(0)
  v_mfma_f32_32x32x16_bf16 v[12:27], v[28:31], v[64:67], v[12:27]
  ds_read_b128 v[92:95], v6 offset:19968
  s_waitcnt lgkmcnt(6)
  v_mfma_f32_32x32x16_bf16 v[12:27], v[32:35], v[68:71], v[12:27]
  s_waitcnt lgkmcnt(5)
  v_mfma_f32_32x32x16_bf16 v[12:27], v[36:39], v[72:75], v[12:27]
  s_waitcnt lgkmcnt(4)
  v_mfma_f32_32x32x16_bf16 v[12:27], v[40:43], v[76:79], v[12:27]
  s_waitcnt lgkmcnt(3)
  v_mfma_f32_32x32x16_bf16 v[12:27], v[44:47], v[80:83], v[12:27]
  s_waitcnt lgkmcnt(2)
  v_mfma_f32_32x32x16_bf16 v[12:27], v[48:51], v[84:87], v[12:27]
  s_waitcnt lgkmcnt(1)
  v_mfma_f32_32x32x16_bf16 v[12:27], v[52:55], v[88:91], v[12:27]
  s_waitcnt lgkmcnt(0)
  v_mfma_f32_32x32x16_bf16 v[12:27], v[56:59], v[92:95], v[12:27]
  v_mul_u32_u24 v9, 240, v9
  s_movk_i32 s23, 240
  v_lshl_add_u32 v8, v8, 3, v9
  s_mul_i32 s22, s16, 24
  v_add_u32 v7, s22, v8
  s_lshl_b32 s22, s16, 5
  v_add_u32 v8, s22, v8
  v_min_u32 v11, 223, v0
  v_mul_u32_u24 v9, 4682, v11
  v_lshrrev_b32 v9, 16, v9
  v_mul_u32_u24 v10, 14, v9
  v_sub_u32 v10, v11, v10
  v_cmp_gt_u32 vcc, 8, v10
  v_lshlrev_b32 v10, 4, v10
  v_mad_u32_u24 v11, v9, s23, v10
  v_mul_u32_u24 v9, 1792, v9
  v_add_u32 v10, v9, v10
  s_lshl_b32 s22, s18, 7
  s_mul_i32 s27, s18, 96
  s_add_u32 s27, s27, 384
  v_mov_b32 v9, s22
  v_mov_b32 v5, s27
  v_cndmask_b32 v9, v5, v9, vcc
  v_add_u32 v10, v9, v10
  s_mul_i32 s26, s17, 57344
  s_add_u32 s26, s26, 896
  s_add_u32 s27, s26, 28672
  v_cvt_pk_bf16_f32 v96, v12, v13
  v_cvt_pk_bf16_f32 v97, v14, v15
  ds_write_b64 v8, v[96:97] offset:49152
  v_cvt_pk_bf16_f32 v98, v16, v17
  v_cvt_pk_bf16_f32 v99, v18, v19
  ds_write_b64 v8, v[98:99] offset:49168
  v_cvt_pk_bf16_f32 v100, v20, v21
  v_cvt_pk_bf16_f32 v101, v22, v23
  ds_write_b64 v7, v[100:101] offset:49280
  v_cvt_pk_bf16_f32 v102, v24, v25
  v_cvt_pk_bf16_f32 v103, v26, v27
  s_mov_b32 exec_hi, 0
  ds_write_b64 v7, v[102:103] offset:49296
  s_mov_b64 exec, -1
  s_waitcnt lgkmcnt(0)
  s_barrier
  ds_read_b128 v[104:107], v11 offset:49152
  ds_read_b128 v[108:111], v11 offset:52992
  s_cmp_lg_u32 s16, 3
  s_cselect_b32 exec_hi, -1, 0
  s_waitcnt lgkmcnt(1)
  buffer_store_dwordx4 v[104:107], v10, s[92:95], s26 offen
  s_waitcnt lgkmcnt(0)
  buffer_store_dwordx4 v[108:111], v10, s[92:95], s27 offen
  s_mov_b64 exec, -1
  v_readfirstlane_b32 s22, v250
  s_cmp_ge_u32 s22, 1440
  s_cbranch_scc1 ch_end
  s_branch wk_loop
wp_abort:
wo_abort:
  s_branch cA_abort
ch_end:
  s_endpgm

.section .rodata,"a"
.p2align 6
.amdhsa_kernel main_kernel
  .amdhsa_next_free_vgpr 512
  .amdhsa_next_free_sgpr 102
  .amdhsa_accum_offset 256
  .amdhsa_group_segment_fixed_size 0
  .amdhsa_kernarg_size 136
  .amdhsa_user_sgpr_count 2
  .amdhsa_user_sgpr_kernarg_segment_ptr 1
  .amdhsa_system_sgpr_workgroup_id_x 1
.end_amdhsa_kernel
```
